```python
import torch

def _softmax(x, axis=-1):
    return torch.softmax(x, dim=axis)
def _gelu(x):
    return torch.nn.functional.gelu(x, approximate="tanh")
def _silu(x):
    return torch.nn.functional.silu(x)
def _sigmoid(x):
    return torch.sigmoid(x)
def _layernorm(x, axis=-1, eps=1e-5):
    m = x.mean(dim=axis, keepdim=True)
    v = x.var(dim=axis, keepdim=True, unbiased=False)
    return (x - m) / torch.sqrt(v + eps)
def _scatter_add(tgt, idx, src, axis=0):
    return tgt.clone().index_add_(axis, idx, src)
def _segment_sum(src, seg, n):
    out = torch.zeros((n,) + src.shape[1:], dtype=src.dtype)
    return out.index_add_(0, seg, src)
def _pad(x, pw):
    flat = tuple(v for pair in reversed(pw) for v in pair)
    return torch.nn.functional.pad(x, flat)

kernel_name = 'gather_scatter__molecular_angular_gemnet__graph'

def setup_inputs():

    _w = (lambda a: (lambda t: t.to(torch.bfloat16) if t.is_floating_point() else t)(torch.as_tensor(a)))
    N, deg, De, L = 10000, 64, 4, 1
    E = N * deg
    T = E * deg
    NR = 8
    dist = torch.rand(E).to(float)
    angle = (torch.rand(T) * torch.pi).to(float)
    centers = torch.linspace(0.0, 1.0, NR).to(float)
    ang_freq = torch.arange(1, L + 1).to(float)
    return {
        "m": _w((lambda *s: torch.randn(*s, dtype=torch.bfloat16) * 0.05)(E, De)),
        "idx_in": _w((lambda lo, hi, *s: torch.randint(lo, hi, s))(0, E, T).to(torch.int64)),
        "idx_out": _w((lambda lo, hi, *s: torch.randint(lo, hi, s))(0, E, T).to(torch.int64)),
        "dist": _w(dist),
        "angle": _w(angle),
        "centers": _w(centers),
        "ang_freq": _w(ang_freq),
        "w_rbf": _w((lambda *s: torch.randn(*s, dtype=torch.bfloat16) * 0.2)(NR, De)),
        "w_sbf": _w((lambda *s: torch.randn(*s, dtype=torch.bfloat16) * 0.2)(NR * L, De)),
        "w_down": _w((lambda *s: torch.randn(*s, dtype=torch.bfloat16) * 0.2)(De, De)),
        "w_up": _w((lambda *s: torch.randn(*s, dtype=torch.bfloat16) * 0.2)(De, De)),
    }

def reference(m, idx_in, idx_out, dist, angle, centers, ang_freq, w_rbf, w_sbf, w_down, w_up):
    E, De = m.shape[0], m.shape[1]
    NR = centers.shape[0]
    L = ang_freq.shape[0]
    rbf = torch.exp(-10.0 * (dist[:, None] - centers[None, :]) ** 2)
    cbf = torch.cos(ang_freq[None, :] * angle[:, None])
    rbf_t = rbf[idx_out]
    sbf = torch.reshape(rbf_t[:, :, None] * cbf[:, None, :], (-1, NR * L))
    x = (m[idx_in] @ w_down) * (sbf @ w_sbf)
    agg = _segment_sum(x, idx_out, E)
    return m + (agg @ w_up) * (rbf @ w_rbf)
```

```asm
; @launch kernel=gs_sort_kernel grid=(256,1,1) block=(1024,1,1) lds=163840
; @launch kernel=gs_acc_kernel grid=(256,1,1) block=(1024,1,1) lds=163840
; @launch kernel=gs_final_kernel grid=(1250,1,1) block=(256,1,1) lds=0
.amdgcn_target "amdgcn-amd-amdhsa--gfx950"
.text
.globl gs_sort_kernel
.p2align 8
.type gs_sort_kernel,@function
gs_sort_kernel:
    s_cmp_ge_u32 s2, 256
    s_cbranch_scc1 L1_end
    s_load_dwordx4 s[4:7], s[0:1], 8
    s_load_dwordx2 s[28:29], s[0:1], 32
    s_load_dwordx2 s[30:31], s[0:1], 104
    s_cmp_ge_u32 s2, 250
    s_cbranch_scc1 L1_md
    v_lshrrev_b32 v7, 6, v0
    v_lshlrev_b32 v1, 3, v0
    v_readfirstlane_b32 s32, v7
    v_lshlrev_b32 v0, 4, v0
    s_waitcnt lgkmcnt(0)
    s_mov_b32 s8, s4
    s_mov_b32 s9, s5
    s_mov_b32 s10, 0x9c40000
    s_mov_b32 s11, 0x20000
    s_mov_b32 s12, s6
    s_mov_b32 s13, s7
    s_mov_b32 s14, 0x9c40000
    s_mov_b32 s15, 0x20000
    s_mov_b32 s16, s28
    s_mov_b32 s17, s29
    s_mov_b32 s18, 0x4e20000
    s_mov_b32 s19, 0x20000
    s_mov_b32 s20, s30
    s_mov_b32 s21, s31
    s_mov_b32 s22, 0xc350000
    s_mov_b32 s23, 0x20000
    s_add_u32 s24, s30, 0xc350000
    s_addc_u32 s25, s31, 0
    s_mov_b32 s26, 0x9eb100
    s_mov_b32 s27, 0x20000
    s_mul_i32 s33, s2, 131072
    s_mul_i32 s34, s2, 65536
    s_mul_i32 s35, s2, 163840
    s_mul_i32 s36, s2, 8320
    s_lshl_b32 s37, s32, 3
    s_add_u32 s36, s36, s37
    s_add_u32 s44, s33, 0x0
    buffer_load_dwordx4 v[16:19], v0, s[8:11], s44 offen nt
    s_add_u32 s45, s33, 0x0
    buffer_load_dwordx4 v[20:23], v0, s[12:15], s45 offen nt
    s_add_u32 s46, s34, 0x0
    buffer_load_dwordx2 v[24:25], v1, s[16:19], s46 offen nt
    s_add_u32 s47, s34, 0x2000
    buffer_load_dwordx2 v[26:27], v1, s[16:19], s47 offen nt
    s_add_u32 s44, s33, 0x4000
    buffer_load_dwordx4 v[28:31], v0, s[8:11], s44 offen nt
    s_add_u32 s45, s33, 0x4000
    buffer_load_dwordx4 v[32:35], v0, s[12:15], s45 offen nt
    s_add_u32 s46, s33, 0x8000
    buffer_load_dwordx4 v[36:39], v0, s[8:11], s46 offen nt
    s_add_u32 s47, s33, 0x8000
    buffer_load_dwordx4 v[40:43], v0, s[12:15], s47 offen nt
    s_add_u32 s44, s34, 0x4000
    buffer_load_dwordx2 v[44:45], v1, s[16:19], s44 offen nt
    s_add_u32 s45, s34, 0x6000
    buffer_load_dwordx2 v[46:47], v1, s[16:19], s45 offen nt
    s_add_u32 s46, s33, 0xc000
    buffer_load_dwordx4 v[48:51], v0, s[8:11], s46 offen nt
    s_add_u32 s47, s33, 0xc000
    buffer_load_dwordx4 v[52:55], v0, s[12:15], s47 offen nt
    s_add_u32 s44, s33, 0x10000
    buffer_load_dwordx4 v[56:59], v0, s[8:11], s44 offen nt
    s_add_u32 s45, s33, 0x10000
    buffer_load_dwordx4 v[60:63], v0, s[12:15], s45 offen nt
    s_add_u32 s46, s34, 0x8000
    buffer_load_dwordx2 v[64:65], v1, s[16:19], s46 offen nt
    s_add_u32 s47, s34, 0xa000
    buffer_load_dwordx2 v[66:67], v1, s[16:19], s47 offen nt
    s_add_u32 s44, s33, 0x14000
    buffer_load_dwordx4 v[68:71], v0, s[8:11], s44 offen nt
    s_add_u32 s45, s33, 0x14000
    buffer_load_dwordx4 v[72:75], v0, s[12:15], s45 offen nt
    s_add_u32 s46, s33, 0x18000
    buffer_load_dwordx4 v[76:79], v0, s[8:11], s46 offen nt
    s_add_u32 s47, s33, 0x18000
    buffer_load_dwordx4 v[80:83], v0, s[12:15], s47 offen nt
    s_add_u32 s44, s34, 0xc000
    buffer_load_dwordx2 v[84:85], v1, s[16:19], s44 offen nt
    s_add_u32 s45, s34, 0xe000
    buffer_load_dwordx2 v[86:87], v1, s[16:19], s45 offen nt
    s_add_u32 s46, s33, 0x1c000
    buffer_load_dwordx4 v[88:91], v0, s[8:11], s46 offen nt
    s_add_u32 s47, s33, 0x1c000
    buffer_load_dwordx4 v[92:95], v0, s[12:15], s47 offen nt
    s_add_u32 s44, s33, 0x1f40000
    buffer_load_dwordx4 v[96:99], v0, s[8:11], s44 offen nt
    s_add_u32 s45, s33, 0x1f40000
    buffer_load_dwordx4 v[100:103], v0, s[12:15], s45 offen nt
    s_add_u32 s46, s34, 0xfa0000
    buffer_load_dwordx2 v[104:105], v1, s[16:19], s46 offen nt
    s_add_u32 s47, s34, 0xfa2000
    buffer_load_dwordx2 v[106:107], v1, s[16:19], s47 offen nt
    s_add_u32 s44, s33, 0x1f44000
    buffer_load_dwordx4 v[108:111], v0, s[8:11], s44 offen nt
    s_add_u32 s45, s33, 0x1f44000
    buffer_load_dwordx4 v[112:115], v0, s[12:15], s45 offen nt
    s_add_u32 s46, s33, 0x1f48000
    buffer_load_dwordx4 v[116:119], v0, s[8:11], s46 offen nt
    s_add_u32 s47, s33, 0x1f48000
    buffer_load_dwordx4 v[120:123], v0, s[12:15], s47 offen nt
    s_add_u32 s44, s34, 0xfa4000
    buffer_load_dwordx2 v[124:125], v1, s[16:19], s44 offen nt
    s_add_u32 s45, s34, 0xfa6000
    buffer_load_dwordx2 v[126:127], v1, s[16:19], s45 offen nt
    v_mov_b32 v2, 1
    v_mov_b32 v3, 0x1ffff
    v_mov_b32 v4, 0x80000007
    v_mov_b32 v5, 0xfc
    v_mov_b32 v6, 0x78
    s_mov_b32 s40, 0x10000000
    s_mov_b32 s41, 0x010c0c01
    s_mov_b32 s42, 0x030c0c03
    v_mov_b32 v8, 0
    v_mov_b32 v9, 0
    v_mov_b32 v10, 0
    v_mov_b32 v11, 0
    ds_write_b128 v0, v[8:11]
    s_waitcnt lgkmcnt(0)
    s_barrier
    s_waitcnt vmcnt(30)
    v_lshlrev_b32 v7, 16, v24
    v_and_b32 v8, 0xffff0000, v24
    v_lshlrev_b32 v9, 16, v25
    v_and_b32 v10, 0xffff0000, v25
    v_mul_f32 v7, 0.15915494, v7
    v_mul_f32 v8, 0.15915494, v8
    v_mul_f32 v9, 0.15915494, v9
    v_mul_f32 v10, 0.15915494, v10
    v_cos_f32 v7, v7
    v_lshl_add_u32 v11, v16, 11, s40
    v_lshrrev_b32 v12, 3, v20
    v_lshlrev_b16 v13, 3, v20
    v_bitop3_b32 v12, v6, v13, v12 bitop3:0xca
    v_bitop3_b32 v16, v3, v12, v11 bitop3:0xca
    v_lshrrev_b32 v11, 3, v11
    v_lshrrev_b32 v13, 2, v20
    v_bitop3_b32 v11, v5, v13, v11 bitop3:0xca
    v_and_b32 v20, 0x3fff, v11
    ds_add_u32 v20, v2
    v_cos_f32 v8, v8
    v_lshl_add_u32 v11, v17, 11, s40
    v_lshrrev_b32 v12, 3, v21
    v_lshlrev_b16 v13, 3, v21
    v_bitop3_b32 v12, v6, v13, v12 bitop3:0xca
    v_bitop3_b32 v17, v3, v12, v11 bitop3:0xca
    v_lshrrev_b32 v11, 3, v11
    v_lshrrev_b32 v13, 2, v21
    v_bitop3_b32 v11, v5, v13, v11 bitop3:0xca
    v_and_b32 v21, 0x3fff, v11
    ds_add_u32 v21, v2
    v_cvt_pk_bf16_f32 v24, v7, v8
    v_perm_b32 v12, v24, v24, s41
    v_bitop3_b32 v16, v4, v12, v16 bitop3:0xca
    v_perm_b32 v13, v24, v24, s42
    v_bitop3_b32 v17, v4, v13, v17 bitop3:0xca
    v_cos_f32 v9, v9
    v_lshl_add_u32 v11, v18, 11, s40
    v_lshrrev_b32 v12, 3, v22
    v_lshlrev_b16 v13, 3, v22
    v_bitop3_b32 v12, v6, v13, v12 bitop3:0xca
    v_bitop3_b32 v18, v3, v12, v11 bitop3:0xca
    v_lshrrev_b32 v11, 3, v11
    v_lshrrev_b32 v13, 2, v22
    v_bitop3_b32 v11, v5, v13, v11 bitop3:0xca
    v_and_b32 v22, 0x3fff, v11
    ds_add_u32 v22, v2
    v_cos_f32 v10, v10
    v_lshl_add_u32 v11, v19, 11, s40
    v_lshrrev_b32 v12, 3, v23
    v_lshlrev_b16 v13, 3, v23
    v_bitop3_b32 v12, v6, v13, v12 bitop3:0xca
    v_bitop3_b32 v19, v3, v12, v11 bitop3:0xca
    v_lshrrev_b32 v11, 3, v11
    v_lshrrev_b32 v13, 2, v23
    v_bitop3_b32 v11, v5, v13, v11 bitop3:0xca
    v_and_b32 v23, 0x3fff, v11
    ds_add_u32 v23, v2
    v_cvt_pk_bf16_f32 v25, v9, v10
    v_perm_b32 v12, v25, v25, s41
    v_bitop3_b32 v18, v4, v12, v18 bitop3:0xca
    v_perm_b32 v13, v25, v25, s42
    v_bitop3_b32 v19, v4, v13, v19 bitop3:0xca
    s_waitcnt vmcnt(28)
    v_lshlrev_b32 v7, 16, v26
    v_and_b32 v8, 0xffff0000, v26
    v_lshlrev_b32 v9, 16, v27
    v_and_b32 v10, 0xffff0000, v27
    v_mul_f32 v7, 0.15915494, v7
    v_mul_f32 v8, 0.15915494, v8
    v_mul_f32 v9, 0.15915494, v9
    v_mul_f32 v10, 0.15915494, v10
    v_cos_f32 v7, v7
    v_lshl_add_u32 v11, v28, 11, s40
    v_lshrrev_b32 v12, 3, v32
    v_lshlrev_b16 v13, 3, v32
    v_bitop3_b32 v12, v6, v13, v12 bitop3:0xca
    v_bitop3_b32 v28, v3, v12, v11 bitop3:0xca
    v_lshrrev_b32 v11, 3, v11
    v_lshrrev_b32 v13, 2, v32
    v_bitop3_b32 v11, v5, v13, v11 bitop3:0xca
    v_and_b32 v32, 0x3fff, v11
    ds_add_u32 v32, v2
    v_cos_f32 v8, v8
    v_lshl_add_u32 v11, v29, 11, s40
    v_lshrrev_b32 v12, 3, v33
    v_lshlrev_b16 v13, 3, v33
    v_bitop3_b32 v12, v6, v13, v12 bitop3:0xca
    v_bitop3_b32 v29, v3, v12, v11 bitop3:0xca
    v_lshrrev_b32 v11, 3, v11
    v_lshrrev_b32 v13, 2, v33
    v_bitop3_b32 v11, v5, v13, v11 bitop3:0xca
    v_and_b32 v33, 0x3fff, v11
    ds_add_u32 v33, v2
    v_cvt_pk_bf16_f32 v26, v7, v8
    v_perm_b32 v12, v26, v26, s41
    v_bitop3_b32 v28, v4, v12, v28 bitop3:0xca
    v_perm_b32 v13, v26, v26, s42
    v_bitop3_b32 v29, v4, v13, v29 bitop3:0xca
    v_cos_f32 v9, v9
    v_lshl_add_u32 v11, v30, 11, s40
    v_lshrrev_b32 v12, 3, v34
    v_lshlrev_b16 v13, 3, v34
    v_bitop3_b32 v12, v6, v13, v12 bitop3:0xca
    v_bitop3_b32 v30, v3, v12, v11 bitop3:0xca
    v_lshrrev_b32 v11, 3, v11
    v_lshrrev_b32 v13, 2, v34
    v_bitop3_b32 v11, v5, v13, v11 bitop3:0xca
    v_and_b32 v34, 0x3fff, v11
    ds_add_u32 v34, v2
    v_cos_f32 v10, v10
    v_lshl_add_u32 v11, v31, 11, s40
    v_lshrrev_b32 v12, 3, v35
    v_lshlrev_b16 v13, 3, v35
    v_bitop3_b32 v12, v6, v13, v12 bitop3:0xca
    v_bitop3_b32 v31, v3, v12, v11 bitop3:0xca
    v_lshrrev_b32 v11, 3, v11
    v_lshrrev_b32 v13, 2, v35
    v_bitop3_b32 v11, v5, v13, v11 bitop3:0xca
    v_and_b32 v35, 0x3fff, v11
    ds_add_u32 v35, v2
    v_cvt_pk_bf16_f32 v27, v9, v10
    v_perm_b32 v12, v27, v27, s41
    v_bitop3_b32 v30, v4, v12, v30 bitop3:0xca
    v_perm_b32 v13, v27, v27, s42
    v_bitop3_b32 v31, v4, v13, v31 bitop3:0xca
    s_waitcnt vmcnt(24)
    v_lshlrev_b32 v7, 16, v44
    v_and_b32 v8, 0xffff0000, v44
    v_lshlrev_b32 v9, 16, v45
    v_and_b32 v10, 0xffff0000, v45
    v_mul_f32 v7, 0.15915494, v7
    v_mul_f32 v8, 0.15915494, v8
    v_mul_f32 v9, 0.15915494, v9
    v_mul_f32 v10, 0.15915494, v10
    v_cos_f32 v7, v7
    v_lshl_add_u32 v11, v36, 11, s40
    v_lshrrev_b32 v12, 3, v40
    v_lshlrev_b16 v13, 3, v40
    v_bitop3_b32 v12, v6, v13, v12 bitop3:0xca
    v_bitop3_b32 v36, v3, v12, v11 bitop3:0xca
    v_lshrrev_b32 v11, 3, v11
    v_lshrrev_b32 v13, 2, v40
    v_bitop3_b32 v11, v5, v13, v11 bitop3:0xca
    v_and_b32 v40, 0x3fff, v11
    ds_add_u32 v40, v2
    v_cos_f32 v8, v8
    v_lshl_add_u32 v11, v37, 11, s40
    v_lshrrev_b32 v12, 3, v41
    v_lshlrev_b16 v13, 3, v41
    v_bitop3_b32 v12, v6, v13, v12 bitop3:0xca
    v_bitop3_b32 v37, v3, v12, v11 bitop3:0xca
    v_lshrrev_b32 v11, 3, v11
    v_lshrrev_b32 v13, 2, v41
    v_bitop3_b32 v11, v5, v13, v11 bitop3:0xca
    v_and_b32 v41, 0x3fff, v11
    ds_add_u32 v41, v2
    v_cvt_pk_bf16_f32 v44, v7, v8
    v_perm_b32 v12, v44, v44, s41
    v_bitop3_b32 v36, v4, v12, v36 bitop3:0xca
    v_perm_b32 v13, v44, v44, s42
    v_bitop3_b32 v37, v4, v13, v37 bitop3:0xca
    v_cos_f32 v9, v9
    v_lshl_add_u32 v11, v38, 11, s40
    v_lshrrev_b32 v12, 3, v42
    v_lshlrev_b16 v13, 3, v42
    v_bitop3_b32 v12, v6, v13, v12 bitop3:0xca
    v_bitop3_b32 v38, v3, v12, v11 bitop3:0xca
    v_lshrrev_b32 v11, 3, v11
    v_lshrrev_b32 v13, 2, v42
    v_bitop3_b32 v11, v5, v13, v11 bitop3:0xca
    v_and_b32 v42, 0x3fff, v11
    ds_add_u32 v42, v2
    v_cos_f32 v10, v10
    v_lshl_add_u32 v11, v39, 11, s40
    v_lshrrev_b32 v12, 3, v43
    v_lshlrev_b16 v13, 3, v43
    v_bitop3_b32 v12, v6, v13, v12 bitop3:0xca
    v_bitop3_b32 v39, v3, v12, v11 bitop3:0xca
    v_lshrrev_b32 v11, 3, v11
    v_lshrrev_b32 v13, 2, v43
    v_bitop3_b32 v11, v5, v13, v11 bitop3:0xca
    v_and_b32 v43, 0x3fff, v11
    ds_add_u32 v43, v2
    v_cvt_pk_bf16_f32 v45, v9, v10
    v_perm_b32 v12, v45, v45, s41
    v_bitop3_b32 v38, v4, v12, v38 bitop3:0xca
    v_perm_b32 v13, v45, v45, s42
    v_bitop3_b32 v39, v4, v13, v39 bitop3:0xca
    s_waitcnt vmcnt(22)
    v_lshlrev_b32 v7, 16, v46
    v_and_b32 v8, 0xffff0000, v46
    v_lshlrev_b32 v9, 16, v47
    v_and_b32 v10, 0xffff0000, v47
    v_mul_f32 v7, 0.15915494, v7
    v_mul_f32 v8, 0.15915494, v8
    v_mul_f32 v9, 0.15915494, v9
    v_mul_f32 v10, 0.15915494, v10
    v_cos_f32 v7, v7
    v_lshl_add_u32 v11, v48, 11, s40
    v_lshrrev_b32 v12, 3, v52
    v_lshlrev_b16 v13, 3, v52
    v_bitop3_b32 v12, v6, v13, v12 bitop3:0xca
    v_bitop3_b32 v48, v3, v12, v11 bitop3:0xca
    v_lshrrev_b32 v11, 3, v11
    v_lshrrev_b32 v13, 2, v52
    v_bitop3_b32 v11, v5, v13, v11 bitop3:0xca
    v_and_b32 v52, 0x3fff, v11
    ds_add_u32 v52, v2
    v_cos_f32 v8, v8
    v_lshl_add_u32 v11, v49, 11, s40
    v_lshrrev_b32 v12, 3, v53
    v_lshlrev_b16 v13, 3, v53
    v_bitop3_b32 v12, v6, v13, v12 bitop3:0xca
    v_bitop3_b32 v49, v3, v12, v11 bitop3:0xca
    v_lshrrev_b32 v11, 3, v11
    v_lshrrev_b32 v13, 2, v53
    v_bitop3_b32 v11, v5, v13, v11 bitop3:0xca
    v_and_b32 v53, 0x3fff, v11
    ds_add_u32 v53, v2
    v_cvt_pk_bf16_f32 v46, v7, v8
    v_perm_b32 v12, v46, v46, s41
    v_bitop3_b32 v48, v4, v12, v48 bitop3:0xca
    v_perm_b32 v13, v46, v46, s42
    v_bitop3_b32 v49, v4, v13, v49 bitop3:0xca
    v_cos_f32 v9, v9
    v_lshl_add_u32 v11, v50, 11, s40
    v_lshrrev_b32 v12, 3, v54
    v_lshlrev_b16 v13, 3, v54
    v_bitop3_b32 v12, v6, v13, v12 bitop3:0xca
    v_bitop3_b32 v50, v3, v12, v11 bitop3:0xca
    v_lshrrev_b32 v11, 3, v11
    v_lshrrev_b32 v13, 2, v54
    v_bitop3_b32 v11, v5, v13, v11 bitop3:0xca
    v_and_b32 v54, 0x3fff, v11
    ds_add_u32 v54, v2
    v_cos_f32 v10, v10
    v_lshl_add_u32 v11, v51, 11, s40
    v_lshrrev_b32 v12, 3, v55
    v_lshlrev_b16 v13, 3, v55
    v_bitop3_b32 v12, v6, v13, v12 bitop3:0xca
    v_bitop3_b32 v51, v3, v12, v11 bitop3:0xca
    v_lshrrev_b32 v11, 3, v11
    v_lshrrev_b32 v13, 2, v55
    v_bitop3_b32 v11, v5, v13, v11 bitop3:0xca
    v_and_b32 v55, 0x3fff, v11
    ds_add_u32 v55, v2
    v_cvt_pk_bf16_f32 v47, v9, v10
    v_perm_b32 v12, v47, v47, s41
    v_bitop3_b32 v50, v4, v12, v50 bitop3:0xca
    v_perm_b32 v13, v47, v47, s42
    v_bitop3_b32 v51, v4, v13, v51 bitop3:0xca
    s_waitcnt vmcnt(18)
    v_lshlrev_b32 v7, 16, v64
    v_and_b32 v8, 0xffff0000, v64
    v_lshlrev_b32 v9, 16, v65
    v_and_b32 v10, 0xffff0000, v65
    v_mul_f32 v7, 0.15915494, v7
    v_mul_f32 v8, 0.15915494, v8
    v_mul_f32 v9, 0.15915494, v9
    v_mul_f32 v10, 0.15915494, v10
    v_cos_f32 v7, v7
    v_lshl_add_u32 v11, v56, 11, s40
    v_lshrrev_b32 v12, 3, v60
    v_lshlrev_b16 v13, 3, v60
    v_bitop3_b32 v12, v6, v13, v12 bitop3:0xca
    v_bitop3_b32 v56, v3, v12, v11 bitop3:0xca
    v_lshrrev_b32 v11, 3, v11
    v_lshrrev_b32 v13, 2, v60
    v_bitop3_b32 v11, v5, v13, v11 bitop3:0xca
    v_and_b32 v60, 0x3fff, v11
    ds_add_u32 v60, v2
    v_cos_f32 v8, v8
    v_lshl_add_u32 v11, v57, 11, s40
    v_lshrrev_b32 v12, 3, v61
    v_lshlrev_b16 v13, 3, v61
    v_bitop3_b32 v12, v6, v13, v12 bitop3:0xca
    v_bitop3_b32 v57, v3, v12, v11 bitop3:0xca
    v_lshrrev_b32 v11, 3, v11
    v_lshrrev_b32 v13, 2, v61
    v_bitop3_b32 v11, v5, v13, v11 bitop3:0xca
    v_and_b32 v61, 0x3fff, v11
    ds_add_u32 v61, v2
    v_cvt_pk_bf16_f32 v64, v7, v8
    v_perm_b32 v12, v64, v64, s41
    v_bitop3_b32 v56, v4, v12, v56 bitop3:0xca
    v_perm_b32 v13, v64, v64, s42
    v_bitop3_b32 v57, v4, v13, v57 bitop3:0xca
    v_cos_f32 v9, v9
    v_lshl_add_u32 v11, v58, 11, s40
    v_lshrrev_b32 v12, 3, v62
    v_lshlrev_b16 v13, 3, v62
    v_bitop3_b32 v12, v6, v13, v12 bitop3:0xca
    v_bitop3_b32 v58, v3, v12, v11 bitop3:0xca
    v_lshrrev_b32 v11, 3, v11
    v_lshrrev_b32 v13, 2, v62
    v_bitop3_b32 v11, v5, v13, v11 bitop3:0xca
    v_and_b32 v62, 0x3fff, v11
    ds_add_u32 v62, v2
    v_cos_f32 v10, v10
    v_lshl_add_u32 v11, v59, 11, s40
    v_lshrrev_b32 v12, 3, v63
    v_lshlrev_b16 v13, 3, v63
    v_bitop3_b32 v12, v6, v13, v12 bitop3:0xca
    v_bitop3_b32 v59, v3, v12, v11 bitop3:0xca
    v_lshrrev_b32 v11, 3, v11
    v_lshrrev_b32 v13, 2, v63
    v_bitop3_b32 v11, v5, v13, v11 bitop3:0xca
    v_and_b32 v63, 0x3fff, v11
    ds_add_u32 v63, v2
    v_cvt_pk_bf16_f32 v65, v9, v10
    v_perm_b32 v12, v65, v65, s41
    v_bitop3_b32 v58, v4, v12, v58 bitop3:0xca
    v_perm_b32 v13, v65, v65, s42
    v_bitop3_b32 v59, v4, v13, v59 bitop3:0xca
    s_waitcnt vmcnt(16)
    v_lshlrev_b32 v7, 16, v66
    v_and_b32 v8, 0xffff0000, v66
    v_lshlrev_b32 v9, 16, v67
    v_and_b32 v10, 0xffff0000, v67
    v_mul_f32 v7, 0.15915494, v7
    v_mul_f32 v8, 0.15915494, v8
    v_mul_f32 v9, 0.15915494, v9
    v_mul_f32 v10, 0.15915494, v10
    v_cos_f32 v7, v7
    v_lshl_add_u32 v11, v68, 11, s40
    v_lshrrev_b32 v12, 3, v72
    v_lshlrev_b16 v13, 3, v72
    v_bitop3_b32 v12, v6, v13, v12 bitop3:0xca
    v_bitop3_b32 v68, v3, v12, v11 bitop3:0xca
    v_lshrrev_b32 v11, 3, v11
    v_lshrrev_b32 v13, 2, v72
    v_bitop3_b32 v11, v5, v13, v11 bitop3:0xca
    v_and_b32 v72, 0x3fff, v11
    ds_add_u32 v72, v2
    v_cos_f32 v8, v8
    v_lshl_add_u32 v11, v69, 11, s40
    v_lshrrev_b32 v12, 3, v73
    v_lshlrev_b16 v13, 3, v73
    v_bitop3_b32 v12, v6, v13, v12 bitop3:0xca
    v_bitop3_b32 v69, v3, v12, v11 bitop3:0xca
    v_lshrrev_b32 v11, 3, v11
    v_lshrrev_b32 v13, 2, v73
    v_bitop3_b32 v11, v5, v13, v11 bitop3:0xca
    v_and_b32 v73, 0x3fff, v11
    ds_add_u32 v73, v2
    v_cvt_pk_bf16_f32 v66, v7, v8
    v_perm_b32 v12, v66, v66, s41
    v_bitop3_b32 v68, v4, v12, v68 bitop3:0xca
    v_perm_b32 v13, v66, v66, s42
    v_bitop3_b32 v69, v4, v13, v69 bitop3:0xca
    v_cos_f32 v9, v9
    v_lshl_add_u32 v11, v70, 11, s40
    v_lshrrev_b32 v12, 3, v74
    v_lshlrev_b16 v13, 3, v74
    v_bitop3_b32 v12, v6, v13, v12 bitop3:0xca
    v_bitop3_b32 v70, v3, v12, v11 bitop3:0xca
    v_lshrrev_b32 v11, 3, v11
    v_lshrrev_b32 v13, 2, v74
    v_bitop3_b32 v11, v5, v13, v11 bitop3:0xca
    v_and_b32 v74, 0x3fff, v11
    ds_add_u32 v74, v2
    v_cos_f32 v10, v10
    v_lshl_add_u32 v11, v71, 11, s40
    v_lshrrev_b32 v12, 3, v75
    v_lshlrev_b16 v13, 3, v75
    v_bitop3_b32 v12, v6, v13, v12 bitop3:0xca
    v_bitop3_b32 v71, v3, v12, v11 bitop3:0xca
    v_lshrrev_b32 v11, 3, v11
    v_lshrrev_b32 v13, 2, v75
    v_bitop3_b32 v11, v5, v13, v11 bitop3:0xca
    v_and_b32 v75, 0x3fff, v11
    ds_add_u32 v75, v2
    v_cvt_pk_bf16_f32 v67, v9, v10
    v_perm_b32 v12, v67, v67, s41
    v_bitop3_b32 v70, v4, v12, v70 bitop3:0xca
    v_perm_b32 v13, v67, v67, s42
    v_bitop3_b32 v71, v4, v13, v71 bitop3:0xca
    s_waitcnt vmcnt(12)
    v_lshlrev_b32 v7, 16, v84
    v_and_b32 v8, 0xffff0000, v84
    v_lshlrev_b32 v9, 16, v85
    v_and_b32 v10, 0xffff0000, v85
    v_mul_f32 v7, 0.15915494, v7
    v_mul_f32 v8, 0.15915494, v8
    v_mul_f32 v9, 0.15915494, v9
    v_mul_f32 v10, 0.15915494, v10
    v_cos_f32 v7, v7
    v_lshl_add_u32 v11, v76, 11, s40
    v_lshrrev_b32 v12, 3, v80
    v_lshlrev_b16 v13, 3, v80
    v_bitop3_b32 v12, v6, v13, v12 bitop3:0xca
    v_bitop3_b32 v76, v3, v12, v11 bitop3:0xca
    v_lshrrev_b32 v11, 3, v11
    v_lshrrev_b32 v13, 2, v80
    v_bitop3_b32 v11, v5, v13, v11 bitop3:0xca
    v_and_b32 v80, 0x3fff, v11
    ds_add_u32 v80, v2
    v_cos_f32 v8, v8
    v_lshl_add_u32 v11, v77, 11, s40
    v_lshrrev_b32 v12, 3, v81
    v_lshlrev_b16 v13, 3, v81
    v_bitop3_b32 v12, v6, v13, v12 bitop3:0xca
    v_bitop3_b32 v77, v3, v12, v11 bitop3:0xca
    v_lshrrev_b32 v11, 3, v11
    v_lshrrev_b32 v13, 2, v81
    v_bitop3_b32 v11, v5, v13, v11 bitop3:0xca
    v_and_b32 v81, 0x3fff, v11
    ds_add_u32 v81, v2
    v_cvt_pk_bf16_f32 v84, v7, v8
    v_perm_b32 v12, v84, v84, s41
    v_bitop3_b32 v76, v4, v12, v76 bitop3:0xca
    v_perm_b32 v13, v84, v84, s42
    v_bitop3_b32 v77, v4, v13, v77 bitop3:0xca
    v_cos_f32 v9, v9
    v_lshl_add_u32 v11, v78, 11, s40
    v_lshrrev_b32 v12, 3, v82
    v_lshlrev_b16 v13, 3, v82
    v_bitop3_b32 v12, v6, v13, v12 bitop3:0xca
    v_bitop3_b32 v78, v3, v12, v11 bitop3:0xca
    v_lshrrev_b32 v11, 3, v11
    v_lshrrev_b32 v13, 2, v82
    v_bitop3_b32 v11, v5, v13, v11 bitop3:0xca
    v_and_b32 v82, 0x3fff, v11
    ds_add_u32 v82, v2
    v_cos_f32 v10, v10
    v_lshl_add_u32 v11, v79, 11, s40
    v_lshrrev_b32 v12, 3, v83
    v_lshlrev_b16 v13, 3, v83
    v_bitop3_b32 v12, v6, v13, v12 bitop3:0xca
    v_bitop3_b32 v79, v3, v12, v11 bitop3:0xca
    v_lshrrev_b32 v11, 3, v11
    v_lshrrev_b32 v13, 2, v83
    v_bitop3_b32 v11, v5, v13, v11 bitop3:0xca
    v_and_b32 v83, 0x3fff, v11
    ds_add_u32 v83, v2
    v_cvt_pk_bf16_f32 v85, v9, v10
    v_perm_b32 v12, v85, v85, s41
    v_bitop3_b32 v78, v4, v12, v78 bitop3:0xca
    v_perm_b32 v13, v85, v85, s42
    v_bitop3_b32 v79, v4, v13, v79 bitop3:0xca
    s_waitcnt vmcnt(10)
    v_lshlrev_b32 v7, 16, v86
    v_and_b32 v8, 0xffff0000, v86
    v_lshlrev_b32 v9, 16, v87
    v_and_b32 v10, 0xffff0000, v87
    v_mul_f32 v7, 0.15915494, v7
    v_mul_f32 v8, 0.15915494, v8
    v_mul_f32 v9, 0.15915494, v9
    v_mul_f32 v10, 0.15915494, v10
    v_cos_f32 v7, v7
    v_lshl_add_u32 v11, v88, 11, s40
    v_lshrrev_b32 v12, 3, v92
    v_lshlrev_b16 v13, 3, v92
    v_bitop3_b32 v12, v6, v13, v12 bitop3:0xca
    v_bitop3_b32 v88, v3, v12, v11 bitop3:0xca
    v_lshrrev_b32 v11, 3, v11
    v_lshrrev_b32 v13, 2, v92
    v_bitop3_b32 v11, v5, v13, v11 bitop3:0xca
    v_and_b32 v92, 0x3fff, v11
    ds_add_u32 v92, v2
    v_cos_f32 v8, v8
    v_lshl_add_u32 v11, v89, 11, s40
    v_lshrrev_b32 v12, 3, v93
    v_lshlrev_b16 v13, 3, v93
    v_bitop3_b32 v12, v6, v13, v12 bitop3:0xca
    v_bitop3_b32 v89, v3, v12, v11 bitop3:0xca
    v_lshrrev_b32 v11, 3, v11
    v_lshrrev_b32 v13, 2, v93
    v_bitop3_b32 v11, v5, v13, v11 bitop3:0xca
    v_and_b32 v93, 0x3fff, v11
    ds_add_u32 v93, v2
    v_cvt_pk_bf16_f32 v86, v7, v8
    v_perm_b32 v12, v86, v86, s41
    v_bitop3_b32 v88, v4, v12, v88 bitop3:0xca
    v_perm_b32 v13, v86, v86, s42
    v_bitop3_b32 v89, v4, v13, v89 bitop3:0xca
    v_cos_f32 v9, v9
    v_lshl_add_u32 v11, v90, 11, s40
    v_lshrrev_b32 v12, 3, v94
    v_lshlrev_b16 v13, 3, v94
    v_bitop3_b32 v12, v6, v13, v12 bitop3:0xca
    v_bitop3_b32 v90, v3, v12, v11 bitop3:0xca
    v_lshrrev_b32 v11, 3, v11
    v_lshrrev_b32 v13, 2, v94
    v_bitop3_b32 v11, v5, v13, v11 bitop3:0xca
    v_and_b32 v94, 0x3fff, v11
    ds_add_u32 v94, v2
    v_cos_f32 v10, v10
    v_lshl_add_u32 v11, v91, 11, s40
    v_lshrrev_b32 v12, 3, v95
    v_lshlrev_b16 v13, 3, v95
    v_bitop3_b32 v12, v6, v13, v12 bitop3:0xca
    v_bitop3_b32 v91, v3, v12, v11 bitop3:0xca
    v_lshrrev_b32 v11, 3, v11
    v_lshrrev_b32 v13, 2, v95
    v_bitop3_b32 v11, v5, v13, v11 bitop3:0xca
    v_and_b32 v95, 0x3fff, v11
    ds_add_u32 v95, v2
    v_cvt_pk_bf16_f32 v87, v9, v10
    v_perm_b32 v12, v87, v87, s41
    v_bitop3_b32 v90, v4, v12, v90 bitop3:0xca
    v_perm_b32 v13, v87, v87, s42
    v_bitop3_b32 v91, v4, v13, v91 bitop3:0xca
    v_lshrrev_b32 v8, 2, v0
    v_and_b32 v7, 0x3c00, v0
    v_bitop3_b32 v7, v5, v8, v7 bitop3:0xea
    s_waitcnt lgkmcnt(0)
    s_barrier
    ds_read2st64_b32 v[8:9], v7 offset0:0 offset1:1
    ds_read2st64_b32 v[10:11], v7 offset0:2 offset1:3
    s_waitcnt lgkmcnt(0)
    v_lshl_or_b32 v12, v9, 16, v8
    v_lshl_or_b32 v13, v11, 16, v10
    v_mov_b32 v14, v12
    v_mov_b32 v15, v13
    s_nop 0
    v_add_u32_dpp v14, v14, v14 row_shr:1 row_mask:0xf bank_mask:0xf bound_ctrl:1
    v_add_u32_dpp v15, v15, v15 row_shr:1 row_mask:0xf bank_mask:0xf bound_ctrl:1
    s_nop 0
    v_add_u32_dpp v14, v14, v14 row_shr:2 row_mask:0xf bank_mask:0xf bound_ctrl:1
    v_add_u32_dpp v15, v15, v15 row_shr:2 row_mask:0xf bank_mask:0xf bound_ctrl:1
    s_nop 0
    v_add_u32_dpp v14, v14, v14 row_shr:4 row_mask:0xf bank_mask:0xf bound_ctrl:1
    v_add_u32_dpp v15, v15, v15 row_shr:4 row_mask:0xf bank_mask:0xf bound_ctrl:1
    s_nop 0
    v_add_u32_dpp v14, v14, v14 row_shr:8 row_mask:0xf bank_mask:0xf bound_ctrl:1
    v_add_u32_dpp v15, v15, v15 row_shr:8 row_mask:0xf bank_mask:0xf bound_ctrl:1
    s_nop 0
    v_add_u32_dpp v14, v14, v14 row_bcast:15 row_mask:0xa bank_mask:0xf
    v_add_u32_dpp v15, v15, v15 row_bcast:15 row_mask:0xa bank_mask:0xf
    s_nop 0
    v_add_u32_dpp v14, v14, v14 row_bcast:31 row_mask:0xc bank_mask:0xf
    v_add_u32_dpp v15, v15, v15 row_bcast:31 row_mask:0xc bank_mask:0xf
    v_readlane_b32 s48, v14, 63
    v_readlane_b32 s49, v15, 63
    s_lshl_b32 s54, s32, 2
    v_mov_b32 v8, s54
    s_and_b32 s50, s48, 0xffff
    s_lshr_b32 s51, s48, 16
    s_and_b32 s52, s49, 0xffff
    s_lshr_b32 s53, s49, 16
    s_add_u32 s51, s51, s50
    s_add_u32 s52, s52, s51
    s_add_u32 s53, s53, s52
    v_mov_b32 v9, s53
    s_mov_b64 exec, 1
    ds_write_b32 v8, v9 offset:16384
    s_mov_b64 exec, -1
    v_and_b32 v8, 60, v7
    s_waitcnt lgkmcnt(0)
    s_barrier
    ds_read_b32 v9, v8 offset:16384
    s_waitcnt lgkmcnt(0)
    v_add_u32_dpp v9, v9, v9 row_shr:1 row_mask:0xf bank_mask:0xf bound_ctrl:1
    s_nop 1
    v_add_u32_dpp v9, v9, v9 row_shr:2 row_mask:0xf bank_mask:0xf bound_ctrl:1
    s_nop 1
    v_add_u32_dpp v9, v9, v9 row_shr:4 row_mask:0xf bank_mask:0xf bound_ctrl:1
    s_nop 1
    v_add_u32_dpp v9, v9, v9 row_shr:8 row_mask:0xf bank_mask:0xf bound_ctrl:1
    s_nop 0
    v_readlane_b32 s54, v9, s32
    s_sub_u32 s54, s54, s53
    s_add_u32 s50, s50, s54
    s_add_u32 s51, s51, s54
    s_add_u32 s52, s52, s54
    s_pack_ll_b32_b16 s48, s54, s50
    s_pack_ll_b32_b16 s49, s51, s52
    v_add_u32 v14, s48, v14
    v_add_u32 v15, s49, v15
    v_sub_u32 v12, v14, v12
    v_sub_u32 v13, v15, v13
    v_and_b32 v8, 0xffff, v12
    v_lshrrev_b32 v9, 16, v12
    v_and_b32 v10, 0xffff, v13
    v_lshrrev_b32 v11, 16, v13
    ds_write2st64_b32 v7, v8, v9 offset0:0 offset1:1
    ds_write2st64_b32 v7, v10, v11 offset0:2 offset1:3
    s_waitcnt lgkmcnt(0)
    s_barrier
    ds_add_rtn_u32 v20, v20, v2
    ds_add_rtn_u32 v21, v21, v2
    ds_add_rtn_u32 v22, v22, v2
    ds_add_rtn_u32 v23, v23, v2
    s_add_u32 s46, s36, 0x0
    buffer_store_dwordx2 v[12:13], v1, s[24:27], s46 offen
    s_bitset0_b64 exec, 63
    s_not_b64 exec, exec
    buffer_store_dwordx2 v[14:15], v1, s[24:27], s46 offen offset:8
    s_mov_b64 exec, -1
    ds_add_rtn_u32 v32, v32, v2
    ds_add_rtn_u32 v33, v33, v2
    ds_add_rtn_u32 v34, v34, v2
    ds_add_rtn_u32 v35, v35, v2
    ds_add_rtn_u32 v40, v40, v2
    ds_add_rtn_u32 v41, v41, v2
    ds_add_rtn_u32 v42, v42, v2
    ds_add_rtn_u32 v43, v43, v2
    ds_add_rtn_u32 v52, v52, v2
    ds_add_rtn_u32 v53, v53, v2
    ds_add_rtn_u32 v54, v54, v2
    ds_add_rtn_u32 v55, v55, v2
    ds_add_rtn_u32 v60, v60, v2
    ds_add_rtn_u32 v61, v61, v2
    ds_add_rtn_u32 v62, v62, v2
    ds_add_rtn_u32 v63, v63, v2
    ds_add_rtn_u32 v72, v72, v2
    ds_add_rtn_u32 v73, v73, v2
    ds_add_rtn_u32 v74, v74, v2
    ds_add_rtn_u32 v75, v75, v2
    ds_add_rtn_u32 v80, v80, v2
    ds_add_rtn_u32 v81, v81, v2
    ds_add_rtn_u32 v82, v82, v2
    ds_add_rtn_u32 v83, v83, v2
    ds_add_rtn_u32 v92, v92, v2
    ds_add_rtn_u32 v93, v93, v2
    ds_add_rtn_u32 v94, v94, v2
    ds_add_rtn_u32 v95, v95, v2
    s_waitcnt lgkmcnt(0)
    s_barrier
    v_and_b32 v7, -4, v20
    v_lshl_add_u32 v8, v20, 2, v7
    ds_write_b32 v8, v16
    v_lshl_add_u32 v7, v7, 2, v20
    ds_write_b8 v7, v24 offset:16
    v_and_b32 v9, -4, v21
    v_lshl_add_u32 v10, v21, 2, v9
    ds_write_b32 v10, v17
    v_lshl_add_u32 v9, v9, 2, v21
    ds_write_b8_d16_hi v9, v24 offset:16
    v_and_b32 v7, -4, v22
    v_lshl_add_u32 v8, v22, 2, v7
    ds_write_b32 v8, v18
    v_lshl_add_u32 v7, v7, 2, v22
    ds_write_b8 v7, v25 offset:16
    v_and_b32 v9, -4, v23
    v_lshl_add_u32 v10, v23, 2, v9
    ds_write_b32 v10, v19
    v_lshl_add_u32 v9, v9, 2, v23
    ds_write_b8_d16_hi v9, v25 offset:16
    s_add_u32 s47, s33, 0x1f4c000
    buffer_load_dwordx4 v[16:19], v0, s[8:11], s47 offen nt
    s_add_u32 s44, s33, 0x1f4c000
    buffer_load_dwordx4 v[20:23], v0, s[12:15], s44 offen nt
    v_and_b32 v7, -4, v32
    v_lshl_add_u32 v8, v32, 2, v7
    ds_write_b32 v8, v28
    v_lshl_add_u32 v7, v7, 2, v32
    ds_write_b8 v7, v26 offset:16
    v_and_b32 v9, -4, v33
    v_lshl_add_u32 v10, v33, 2, v9
    ds_write_b32 v10, v29
    v_lshl_add_u32 v9, v9, 2, v33
    ds_write_b8_d16_hi v9, v26 offset:16
    v_and_b32 v7, -4, v34
    v_lshl_add_u32 v8, v34, 2, v7
    ds_write_b32 v8, v30
    v_lshl_add_u32 v7, v7, 2, v34
    ds_write_b8 v7, v27 offset:16
    v_and_b32 v9, -4, v35
    v_lshl_add_u32 v10, v35, 2, v9
    ds_write_b32 v10, v31
    v_lshl_add_u32 v9, v9, 2, v35
    ds_write_b8_d16_hi v9, v27 offset:16
    s_add_u32 s45, s33, 0x1f50000
    buffer_load_dwordx4 v[28:31], v0, s[8:11], s45 offen nt
    v_and_b32 v7, -4, v40
    v_lshl_add_u32 v8, v40, 2, v7
    ds_write_b32 v8, v36
    v_lshl_add_u32 v7, v7, 2, v40
    ds_write_b8 v7, v44 offset:16
    v_and_b32 v9, -4, v41
    v_lshl_add_u32 v10, v41, 2, v9
    ds_write_b32 v10, v37
    v_lshl_add_u32 v9, v9, 2, v41
    ds_write_b8_d16_hi v9, v44 offset:16
    v_and_b32 v7, -4, v42
    v_lshl_add_u32 v8, v42, 2, v7
    ds_write_b32 v8, v38
    v_lshl_add_u32 v7, v7, 2, v42
    ds_write_b8 v7, v45 offset:16
    v_and_b32 v9, -4, v43
    v_lshl_add_u32 v10, v43, 2, v9
    ds_write_b32 v10, v39
    v_lshl_add_u32 v9, v9, 2, v43
    ds_write_b8_d16_hi v9, v45 offset:16
    s_add_u32 s46, s33, 0x1f50000
    buffer_load_dwordx4 v[32:35], v0, s[12:15], s46 offen nt
    v_and_b32 v7, -4, v52
    v_lshl_add_u32 v8, v52, 2, v7
    ds_write_b32 v8, v48
    v_lshl_add_u32 v7, v7, 2, v52
    ds_write_b8 v7, v46 offset:16
    v_and_b32 v9, -4, v53
    v_lshl_add_u32 v10, v53, 2, v9
    ds_write_b32 v10, v49
    v_lshl_add_u32 v9, v9, 2, v53
    ds_write_b8_d16_hi v9, v46 offset:16
    v_and_b32 v7, -4, v54
    v_lshl_add_u32 v8, v54, 2, v7
    ds_write_b32 v8, v50
    v_lshl_add_u32 v7, v7, 2, v54
    ds_write_b8 v7, v47 offset:16
    v_and_b32 v9, -4, v55
    v_lshl_add_u32 v10, v55, 2, v9
    ds_write_b32 v10, v51
    v_lshl_add_u32 v9, v9, 2, v55
    ds_write_b8_d16_hi v9, v47 offset:16
    s_add_u32 s47, s34, 0xfa8000
    buffer_load_dwordx2 v[24:25], v1, s[16:19], s47 offen nt
    s_add_u32 s44, s34, 0xfaa000
    buffer_load_dwordx2 v[26:27], v1, s[16:19], s44 offen nt
    v_and_b32 v7, -4, v60
    v_lshl_add_u32 v8, v60, 2, v7
    ds_write_b32 v8, v56
    v_lshl_add_u32 v7, v7, 2, v60
    ds_write_b8 v7, v64 offset:16
    v_and_b32 v9, -4, v61
    v_lshl_add_u32 v10, v61, 2, v9
    ds_write_b32 v10, v57
    v_lshl_add_u32 v9, v9, 2, v61
    ds_write_b8_d16_hi v9, v64 offset:16
    v_and_b32 v7, -4, v62
    v_lshl_add_u32 v8, v62, 2, v7
    ds_write_b32 v8, v58
    v_lshl_add_u32 v7, v7, 2, v62
    ds_write_b8 v7, v65 offset:16
    v_and_b32 v9, -4, v63
    v_lshl_add_u32 v10, v63, 2, v9
    ds_write_b32 v10, v59
    v_lshl_add_u32 v9, v9, 2, v63
    ds_write_b8_d16_hi v9, v65 offset:16
    s_add_u32 s45, s33, 0x1f54000
    buffer_load_dwordx4 v[36:39], v0, s[8:11], s45 offen nt
    s_add_u32 s46, s33, 0x1f54000
    buffer_load_dwordx4 v[40:43], v0, s[12:15], s46 offen nt
    v_and_b32 v7, -4, v72
    v_lshl_add_u32 v8, v72, 2, v7
    ds_write_b32 v8, v68
    v_lshl_add_u32 v7, v7, 2, v72
    ds_write_b8 v7, v66 offset:16
    v_and_b32 v9, -4, v73
    v_lshl_add_u32 v10, v73, 2, v9
    ds_write_b32 v10, v69
    v_lshl_add_u32 v9, v9, 2, v73
    ds_write_b8_d16_hi v9, v66 offset:16
    v_and_b32 v7, -4, v74
    v_lshl_add_u32 v8, v74, 2, v7
    ds_write_b32 v8, v70
    v_lshl_add_u32 v7, v7, 2, v74
    ds_write_b8 v7, v67 offset:16
    v_and_b32 v9, -4, v75
    v_lshl_add_u32 v10, v75, 2, v9
    ds_write_b32 v10, v71
    v_lshl_add_u32 v9, v9, 2, v75
    ds_write_b8_d16_hi v9, v67 offset:16
    s_add_u32 s47, s33, 0x1f58000
    buffer_load_dwordx4 v[48:51], v0, s[8:11], s47 offen nt
    v_and_b32 v7, -4, v80
    v_lshl_add_u32 v8, v80, 2, v7
    ds_write_b32 v8, v76
    v_lshl_add_u32 v7, v7, 2, v80
    ds_write_b8 v7, v84 offset:16
    v_and_b32 v9, -4, v81
    v_lshl_add_u32 v10, v81, 2, v9
    ds_write_b32 v10, v77
    v_lshl_add_u32 v9, v9, 2, v81
    ds_write_b8_d16_hi v9, v84 offset:16
    v_and_b32 v7, -4, v82
    v_lshl_add_u32 v8, v82, 2, v7
    ds_write_b32 v8, v78
    v_lshl_add_u32 v7, v7, 2, v82
    ds_write_b8 v7, v85 offset:16
    v_and_b32 v9, -4, v83
    v_lshl_add_u32 v10, v83, 2, v9
    ds_write_b32 v10, v79
    v_lshl_add_u32 v9, v9, 2, v83
    ds_write_b8_d16_hi v9, v85 offset:16
    s_add_u32 s44, s33, 0x1f58000
    buffer_load_dwordx4 v[52:55], v0, s[12:15], s44 offen nt
    v_and_b32 v7, -4, v92
    v_lshl_add_u32 v8, v92, 2, v7
    ds_write_b32 v8, v88
    v_lshl_add_u32 v7, v7, 2, v92
    ds_write_b8 v7, v86 offset:16
    v_and_b32 v9, -4, v93
    v_lshl_add_u32 v10, v93, 2, v9
    ds_write_b32 v10, v89
    v_lshl_add_u32 v9, v9, 2, v93
    ds_write_b8_d16_hi v9, v86 offset:16
    v_and_b32 v7, -4, v94
    v_lshl_add_u32 v8, v94, 2, v7
    ds_write_b32 v8, v90
    v_lshl_add_u32 v7, v7, 2, v94
    ds_write_b8 v7, v87 offset:16
    v_and_b32 v9, -4, v95
    v_lshl_add_u32 v10, v95, 2, v9
    ds_write_b32 v10, v91
    v_lshl_add_u32 v9, v9, 2, v95
    ds_write_b8_d16_hi v9, v87 offset:16
    s_add_u32 s45, s34, 0xfac000
    buffer_load_dwordx2 v[44:45], v1, s[16:19], s45 offen nt
    s_add_u32 s46, s34, 0xfae000
    buffer_load_dwordx2 v[46:47], v1, s[16:19], s46 offen nt
    v_add_u32 v7, 0x10000, v0
    v_add_u32 v12, 0x20000, v0
    v_mov_b32 v8, 0
    v_mov_b32 v9, 0
    v_mov_b32 v10, 0
    v_mov_b32 v11, 0
    s_waitcnt lgkmcnt(0)
    s_barrier
    ds_read_b128 v[56:59], v0 offset:0
    ds_write_b128 v0, v[8:11]
    ds_read_b128 v[60:63], v0 offset:16384
    ds_read_b128 v[68:71], v0 offset:32768
    ds_read_b128 v[72:75], v0 offset:49152
    ds_read_b128 v[64:67], v7 offset:0
    ds_read_b128 v[76:79], v7 offset:16384
    ds_read_b128 v[80:83], v7 offset:32768
    ds_read_b128 v[88:91], v7 offset:49152
    ds_read_b128 v[92:95], v12 offset:0
    ds_read_b128 v[84:87], v12 offset:16384
    s_waitcnt lgkmcnt(0)
    s_barrier
    s_add_u32 s47, s35, 0x0
    buffer_store_dwordx4 v[56:59], v0, s[20:23], s47 offen sc1
    s_add_u32 s44, s35, 0x4000
    buffer_store_dwordx4 v[60:63], v0, s[20:23], s44 offen sc1
    s_add_u32 s45, s33, 0x1f5c000
    buffer_load_dwordx4 v[56:59], v0, s[8:11], s45 offen nt
    s_add_u32 s46, s33, 0x1f5c000
    buffer_load_dwordx4 v[60:63], v0, s[12:15], s46 offen nt
    s_add_u32 s47, s35, 0x8000
    buffer_store_dwordx4 v[68:71], v0, s[20:23], s47 offen sc1
    s_waitcnt vmcnt(25)
    v_lshlrev_b32 v7, 16, v104
    v_and_b32 v8, 0xffff0000, v104
    v_lshlrev_b32 v9, 16, v105
    v_and_b32 v10, 0xffff0000, v105
    v_mul_f32 v7, 0.15915494, v7
    v_mul_f32 v8, 0.15915494, v8
    v_mul_f32 v9, 0.15915494, v9
    v_mul_f32 v10, 0.15915494, v10
    v_cos_f32 v7, v7
    v_lshl_add_u32 v11, v96, 11, s40
    v_lshrrev_b32 v12, 3, v100
    v_lshlrev_b16 v13, 3, v100
    v_bitop3_b32 v12, v6, v13, v12 bitop3:0xca
    v_bitop3_b32 v96, v3, v12, v11 bitop3:0xca
    v_lshrrev_b32 v11, 3, v11
    v_lshrrev_b32 v13, 2, v100
    v_bitop3_b32 v11, v5, v13, v11 bitop3:0xca
    v_and_b32 v100, 0x3fff, v11
    ds_add_u32 v100, v2
    v_cos_f32 v8, v8
    v_lshl_add_u32 v11, v97, 11, s40
    v_lshrrev_b32 v12, 3, v101
    v_lshlrev_b16 v13, 3, v101
    v_bitop3_b32 v12, v6, v13, v12 bitop3:0xca
    v_bitop3_b32 v97, v3, v12, v11 bitop3:0xca
    v_lshrrev_b32 v11, 3, v11
    v_lshrrev_b32 v13, 2, v101
    v_bitop3_b32 v11, v5, v13, v11 bitop3:0xca
    v_and_b32 v101, 0x3fff, v11
    ds_add_u32 v101, v2
    v_cvt_pk_bf16_f32 v104, v7, v8
    v_perm_b32 v12, v104, v104, s41
    v_bitop3_b32 v96, v4, v12, v96 bitop3:0xca
    v_perm_b32 v13, v104, v104, s42
    v_bitop3_b32 v97, v4, v13, v97 bitop3:0xca
    v_cos_f32 v9, v9
    v_lshl_add_u32 v11, v98, 11, s40
    v_lshrrev_b32 v12, 3, v102
    v_lshlrev_b16 v13, 3, v102
    v_bitop3_b32 v12, v6, v13, v12 bitop3:0xca
    v_bitop3_b32 v98, v3, v12, v11 bitop3:0xca
    v_lshrrev_b32 v11, 3, v11
    v_lshrrev_b32 v13, 2, v102
    v_bitop3_b32 v11, v5, v13, v11 bitop3:0xca
    v_and_b32 v102, 0x3fff, v11
    ds_add_u32 v102, v2
    v_cos_f32 v10, v10
    v_lshl_add_u32 v11, v99, 11, s40
    v_lshrrev_b32 v12, 3, v103
    v_lshlrev_b16 v13, 3, v103
    v_bitop3_b32 v12, v6, v13, v12 bitop3:0xca
    v_bitop3_b32 v99, v3, v12, v11 bitop3:0xca
    v_lshrrev_b32 v11, 3, v11
    v_lshrrev_b32 v13, 2, v103
    v_bitop3_b32 v11, v5, v13, v11 bitop3:0xca
    v_and_b32 v103, 0x3fff, v11
    ds_add_u32 v103, v2
    v_cvt_pk_bf16_f32 v105, v9, v10
    v_perm_b32 v12, v105, v105, s41
    v_bitop3_b32 v98, v4, v12, v98 bitop3:0xca
    v_perm_b32 v13, v105, v105, s42
    v_bitop3_b32 v99, v4, v13, v99 bitop3:0xca
    s_add_u32 s44, s35, 0xc000
    buffer_store_dwordx4 v[72:75], v0, s[20:23], s44 offen sc1
    s_waitcnt vmcnt(24)
    v_lshlrev_b32 v7, 16, v106
    v_and_b32 v8, 0xffff0000, v106
    v_lshlrev_b32 v9, 16, v107
    v_and_b32 v10, 0xffff0000, v107
    v_mul_f32 v7, 0.15915494, v7
    v_mul_f32 v8, 0.15915494, v8
    v_mul_f32 v9, 0.15915494, v9
    v_mul_f32 v10, 0.15915494, v10
    v_cos_f32 v7, v7
    v_lshl_add_u32 v11, v108, 11, s40
    v_lshrrev_b32 v12, 3, v112
    v_lshlrev_b16 v13, 3, v112
    v_bitop3_b32 v12, v6, v13, v12 bitop3:0xca
    v_bitop3_b32 v108, v3, v12, v11 bitop3:0xca
    v_lshrrev_b32 v11, 3, v11
    v_lshrrev_b32 v13, 2, v112
    v_bitop3_b32 v11, v5, v13, v11 bitop3:0xca
    v_and_b32 v112, 0x3fff, v11
    ds_add_u32 v112, v2
    v_cos_f32 v8, v8
    v_lshl_add_u32 v11, v109, 11, s40
    v_lshrrev_b32 v12, 3, v113
    v_lshlrev_b16 v13, 3, v113
    v_bitop3_b32 v12, v6, v13, v12 bitop3:0xca
    v_bitop3_b32 v109, v3, v12, v11 bitop3:0xca
    v_lshrrev_b32 v11, 3, v11
    v_lshrrev_b32 v13, 2, v113
    v_bitop3_b32 v11, v5, v13, v11 bitop3:0xca
    v_and_b32 v113, 0x3fff, v11
    ds_add_u32 v113, v2
    v_cvt_pk_bf16_f32 v106, v7, v8
    v_perm_b32 v12, v106, v106, s41
    v_bitop3_b32 v108, v4, v12, v108 bitop3:0xca
    v_perm_b32 v13, v106, v106, s42
    v_bitop3_b32 v109, v4, v13, v109 bitop3:0xca
    v_cos_f32 v9, v9
    v_lshl_add_u32 v11, v110, 11, s40
    v_lshrrev_b32 v12, 3, v114
    v_lshlrev_b16 v13, 3, v114
    v_bitop3_b32 v12, v6, v13, v12 bitop3:0xca
    v_bitop3_b32 v110, v3, v12, v11 bitop3:0xca
    v_lshrrev_b32 v11, 3, v11
    v_lshrrev_b32 v13, 2, v114
    v_bitop3_b32 v11, v5, v13, v11 bitop3:0xca
    v_and_b32 v114, 0x3fff, v11
    ds_add_u32 v114, v2
    v_cos_f32 v10, v10
    v_lshl_add_u32 v11, v111, 11, s40
    v_lshrrev_b32 v12, 3, v115
    v_lshlrev_b16 v13, 3, v115
    v_bitop3_b32 v12, v6, v13, v12 bitop3:0xca
    v_bitop3_b32 v111, v3, v12, v11 bitop3:0xca
    v_lshrrev_b32 v11, 3, v11
    v_lshrrev_b32 v13, 2, v115
    v_bitop3_b32 v11, v5, v13, v11 bitop3:0xca
    v_and_b32 v115, 0x3fff, v11
    ds_add_u32 v115, v2
    v_cvt_pk_bf16_f32 v107, v9, v10
    v_perm_b32 v12, v107, v107, s41
    v_bitop3_b32 v110, v4, v12, v110 bitop3:0xca
    v_perm_b32 v13, v107, v107, s42
    v_bitop3_b32 v111, v4, v13, v111 bitop3:0xca
    s_add_u32 s45, s35, 0x10000
    buffer_store_dwordx4 v[64:67], v0, s[20:23], s45 offen sc1
    s_waitcnt vmcnt(21)
    v_lshlrev_b32 v7, 16, v124
    v_and_b32 v8, 0xffff0000, v124
    v_lshlrev_b32 v9, 16, v125
    v_and_b32 v10, 0xffff0000, v125
    v_mul_f32 v7, 0.15915494, v7
    v_mul_f32 v8, 0.15915494, v8
    v_mul_f32 v9, 0.15915494, v9
    v_mul_f32 v10, 0.15915494, v10
    v_cos_f32 v7, v7
    v_lshl_add_u32 v11, v116, 11, s40
    v_lshrrev_b32 v12, 3, v120
    v_lshlrev_b16 v13, 3, v120
    v_bitop3_b32 v12, v6, v13, v12 bitop3:0xca
    v_bitop3_b32 v116, v3, v12, v11 bitop3:0xca
    v_lshrrev_b32 v11, 3, v11
    v_lshrrev_b32 v13, 2, v120
    v_bitop3_b32 v11, v5, v13, v11 bitop3:0xca
    v_and_b32 v120, 0x3fff, v11
    ds_add_u32 v120, v2
    v_cos_f32 v8, v8
    v_lshl_add_u32 v11, v117, 11, s40
    v_lshrrev_b32 v12, 3, v121
    v_lshlrev_b16 v13, 3, v121
    v_bitop3_b32 v12, v6, v13, v12 bitop3:0xca
    v_bitop3_b32 v117, v3, v12, v11 bitop3:0xca
    v_lshrrev_b32 v11, 3, v11
    v_lshrrev_b32 v13, 2, v121
    v_bitop3_b32 v11, v5, v13, v11 bitop3:0xca
    v_and_b32 v121, 0x3fff, v11
    ds_add_u32 v121, v2
    v_cvt_pk_bf16_f32 v124, v7, v8
    v_perm_b32 v12, v124, v124, s41
    v_bitop3_b32 v116, v4, v12, v116 bitop3:0xca
    v_perm_b32 v13, v124, v124, s42
    v_bitop3_b32 v117, v4, v13, v117 bitop3:0xca
    v_cos_f32 v9, v9
    v_lshl_add_u32 v11, v118, 11, s40
    v_lshrrev_b32 v12, 3, v122
    v_lshlrev_b16 v13, 3, v122
    v_bitop3_b32 v12, v6, v13, v12 bitop3:0xca
    v_bitop3_b32 v118, v3, v12, v11 bitop3:0xca
    v_lshrrev_b32 v11, 3, v11
    v_lshrrev_b32 v13, 2, v122
    v_bitop3_b32 v11, v5, v13, v11 bitop3:0xca
    v_and_b32 v122, 0x3fff, v11
    ds_add_u32 v122, v2
    v_cos_f32 v10, v10
    v_lshl_add_u32 v11, v119, 11, s40
    v_lshrrev_b32 v12, 3, v123
    v_lshlrev_b16 v13, 3, v123
    v_bitop3_b32 v12, v6, v13, v12 bitop3:0xca
    v_bitop3_b32 v119, v3, v12, v11 bitop3:0xca
    v_lshrrev_b32 v11, 3, v11
    v_lshrrev_b32 v13, 2, v123
    v_bitop3_b32 v11, v5, v13, v11 bitop3:0xca
    v_and_b32 v123, 0x3fff, v11
    ds_add_u32 v123, v2
    v_cvt_pk_bf16_f32 v125, v9, v10
    v_perm_b32 v12, v125, v125, s41
    v_bitop3_b32 v118, v4, v12, v118 bitop3:0xca
    v_perm_b32 v13, v125, v125, s42
    v_bitop3_b32 v119, v4, v13, v119 bitop3:0xca
    s_add_u32 s46, s35, 0x14000
    buffer_store_dwordx4 v[76:79], v0, s[20:23], s46 offen sc1
    s_waitcnt vmcnt(18)
    v_lshlrev_b32 v7, 16, v126
    v_and_b32 v8, 0xffff0000, v126
    v_lshlrev_b32 v9, 16, v127
    v_and_b32 v10, 0xffff0000, v127
    v_mul_f32 v7, 0.15915494, v7
    v_mul_f32 v8, 0.15915494, v8
    v_mul_f32 v9, 0.15915494, v9
    v_mul_f32 v10, 0.15915494, v10
    v_cos_f32 v7, v7
    v_lshl_add_u32 v11, v16, 11, s40
    v_lshrrev_b32 v12, 3, v20
    v_lshlrev_b16 v13, 3, v20
    v_bitop3_b32 v12, v6, v13, v12 bitop3:0xca
    v_bitop3_b32 v16, v3, v12, v11 bitop3:0xca
    v_lshrrev_b32 v11, 3, v11
    v_lshrrev_b32 v13, 2, v20
    v_bitop3_b32 v11, v5, v13, v11 bitop3:0xca
    v_and_b32 v20, 0x3fff, v11
    ds_add_u32 v20, v2
    v_cos_f32 v8, v8
    v_lshl_add_u32 v11, v17, 11, s40
    v_lshrrev_b32 v12, 3, v21
    v_lshlrev_b16 v13, 3, v21
    v_bitop3_b32 v12, v6, v13, v12 bitop3:0xca
    v_bitop3_b32 v17, v3, v12, v11 bitop3:0xca
    v_lshrrev_b32 v11, 3, v11
    v_lshrrev_b32 v13, 2, v21
    v_bitop3_b32 v11, v5, v13, v11 bitop3:0xca
    v_and_b32 v21, 0x3fff, v11
    ds_add_u32 v21, v2
    v_cvt_pk_bf16_f32 v126, v7, v8
    v_perm_b32 v12, v126, v126, s41
    v_bitop3_b32 v16, v4, v12, v16 bitop3:0xca
    v_perm_b32 v13, v126, v126, s42
    v_bitop3_b32 v17, v4, v13, v17 bitop3:0xca
    v_cos_f32 v9, v9
    v_lshl_add_u32 v11, v18, 11, s40
    v_lshrrev_b32 v12, 3, v22
    v_lshlrev_b16 v13, 3, v22
    v_bitop3_b32 v12, v6, v13, v12 bitop3:0xca
    v_bitop3_b32 v18, v3, v12, v11 bitop3:0xca
    v_lshrrev_b32 v11, 3, v11
    v_lshrrev_b32 v13, 2, v22
    v_bitop3_b32 v11, v5, v13, v11 bitop3:0xca
    v_and_b32 v22, 0x3fff, v11
    ds_add_u32 v22, v2
    v_cos_f32 v10, v10
    v_lshl_add_u32 v11, v19, 11, s40
    v_lshrrev_b32 v12, 3, v23
    v_lshlrev_b16 v13, 3, v23
    v_bitop3_b32 v12, v6, v13, v12 bitop3:0xca
    v_bitop3_b32 v19, v3, v12, v11 bitop3:0xca
    v_lshrrev_b32 v11, 3, v11
    v_lshrrev_b32 v13, 2, v23
    v_bitop3_b32 v11, v5, v13, v11 bitop3:0xca
    v_and_b32 v23, 0x3fff, v11
    ds_add_u32 v23, v2
    v_cvt_pk_bf16_f32 v127, v9, v10
    v_perm_b32 v12, v127, v127, s41
    v_bitop3_b32 v18, v4, v12, v18 bitop3:0xca
    v_perm_b32 v13, v127, v127, s42
    v_bitop3_b32 v19, v4, v13, v19 bitop3:0xca
    s_add_u32 s47, s35, 0x18000
    buffer_store_dwordx4 v[80:83], v0, s[20:23], s47 offen sc1
    s_waitcnt vmcnt(15)
    v_lshlrev_b32 v7, 16, v24
    v_and_b32 v8, 0xffff0000, v24
    v_lshlrev_b32 v9, 16, v25
    v_and_b32 v10, 0xffff0000, v25
    v_mul_f32 v7, 0.15915494, v7
    v_mul_f32 v8, 0.15915494, v8
    v_mul_f32 v9, 0.15915494, v9
    v_mul_f32 v10, 0.15915494, v10
    v_cos_f32 v7, v7
    v_lshl_add_u32 v11, v28, 11, s40
    v_lshrrev_b32 v12, 3, v32
    v_lshlrev_b16 v13, 3, v32
    v_bitop3_b32 v12, v6, v13, v12 bitop3:0xca
    v_bitop3_b32 v28, v3, v12, v11 bitop3:0xca
    v_lshrrev_b32 v11, 3, v11
    v_lshrrev_b32 v13, 2, v32
    v_bitop3_b32 v11, v5, v13, v11 bitop3:0xca
    v_and_b32 v32, 0x3fff, v11
    ds_add_u32 v32, v2
    v_cos_f32 v8, v8
    v_lshl_add_u32 v11, v29, 11, s40
    v_lshrrev_b32 v12, 3, v33
    v_lshlrev_b16 v13, 3, v33
    v_bitop3_b32 v12, v6, v13, v12 bitop3:0xca
    v_bitop3_b32 v29, v3, v12, v11 bitop3:0xca
    v_lshrrev_b32 v11, 3, v11
    v_lshrrev_b32 v13, 2, v33
    v_bitop3_b32 v11, v5, v13, v11 bitop3:0xca
    v_and_b32 v33, 0x3fff, v11
    ds_add_u32 v33, v2
    v_cvt_pk_bf16_f32 v24, v7, v8
    v_perm_b32 v12, v24, v24, s41
    v_bitop3_b32 v28, v4, v12, v28 bitop3:0xca
    v_perm_b32 v13, v24, v24, s42
    v_bitop3_b32 v29, v4, v13, v29 bitop3:0xca
    v_cos_f32 v9, v9
    v_lshl_add_u32 v11, v30, 11, s40
    v_lshrrev_b32 v12, 3, v34
    v_lshlrev_b16 v13, 3, v34
    v_bitop3_b32 v12, v6, v13, v12 bitop3:0xca
    v_bitop3_b32 v30, v3, v12, v11 bitop3:0xca
    v_lshrrev_b32 v11, 3, v11
    v_lshrrev_b32 v13, 2, v34
    v_bitop3_b32 v11, v5, v13, v11 bitop3:0xca
    v_and_b32 v34, 0x3fff, v11
    ds_add_u32 v34, v2
    v_cos_f32 v10, v10
    v_lshl_add_u32 v11, v31, 11, s40
    v_lshrrev_b32 v12, 3, v35
    v_lshlrev_b16 v13, 3, v35
    v_bitop3_b32 v12, v6, v13, v12 bitop3:0xca
    v_bitop3_b32 v31, v3, v12, v11 bitop3:0xca
    v_lshrrev_b32 v11, 3, v11
    v_lshrrev_b32 v13, 2, v35
    v_bitop3_b32 v11, v5, v13, v11 bitop3:0xca
    v_and_b32 v35, 0x3fff, v11
    ds_add_u32 v35, v2
    v_cvt_pk_bf16_f32 v25, v9, v10
    v_perm_b32 v12, v25, v25, s41
    v_bitop3_b32 v30, v4, v12, v30 bitop3:0xca
    v_perm_b32 v13, v25, v25, s42
    v_bitop3_b32 v31, v4, v13, v31 bitop3:0xca
    s_add_u32 s44, s35, 0x1c000
    buffer_store_dwordx4 v[88:91], v0, s[20:23], s44 offen sc1
    s_waitcnt vmcnt(14)
    v_lshlrev_b32 v7, 16, v26
    v_and_b32 v8, 0xffff0000, v26
    v_lshlrev_b32 v9, 16, v27
    v_and_b32 v10, 0xffff0000, v27
    v_mul_f32 v7, 0.15915494, v7
    v_mul_f32 v8, 0.15915494, v8
    v_mul_f32 v9, 0.15915494, v9
    v_mul_f32 v10, 0.15915494, v10
    v_cos_f32 v7, v7
    v_lshl_add_u32 v11, v36, 11, s40
    v_lshrrev_b32 v12, 3, v40
    v_lshlrev_b16 v13, 3, v40
    v_bitop3_b32 v12, v6, v13, v12 bitop3:0xca
    v_bitop3_b32 v36, v3, v12, v11 bitop3:0xca
    v_lshrrev_b32 v11, 3, v11
    v_lshrrev_b32 v13, 2, v40
    v_bitop3_b32 v11, v5, v13, v11 bitop3:0xca
    v_and_b32 v40, 0x3fff, v11
    ds_add_u32 v40, v2
    v_cos_f32 v8, v8
    v_lshl_add_u32 v11, v37, 11, s40
    v_lshrrev_b32 v12, 3, v41
    v_lshlrev_b16 v13, 3, v41
    v_bitop3_b32 v12, v6, v13, v12 bitop3:0xca
    v_bitop3_b32 v37, v3, v12, v11 bitop3:0xca
    v_lshrrev_b32 v11, 3, v11
    v_lshrrev_b32 v13, 2, v41
    v_bitop3_b32 v11, v5, v13, v11 bitop3:0xca
    v_and_b32 v41, 0x3fff, v11
    ds_add_u32 v41, v2
    v_cvt_pk_bf16_f32 v26, v7, v8
    v_perm_b32 v12, v26, v26, s41
    v_bitop3_b32 v36, v4, v12, v36 bitop3:0xca
    v_perm_b32 v13, v26, v26, s42
    v_bitop3_b32 v37, v4, v13, v37 bitop3:0xca
    v_cos_f32 v9, v9
    v_lshl_add_u32 v11, v38, 11, s40
    v_lshrrev_b32 v12, 3, v42
    v_lshlrev_b16 v13, 3, v42
    v_bitop3_b32 v12, v6, v13, v12 bitop3:0xca
    v_bitop3_b32 v38, v3, v12, v11 bitop3:0xca
    v_lshrrev_b32 v11, 3, v11
    v_lshrrev_b32 v13, 2, v42
    v_bitop3_b32 v11, v5, v13, v11 bitop3:0xca
    v_and_b32 v42, 0x3fff, v11
    ds_add_u32 v42, v2
    v_cos_f32 v10, v10
    v_lshl_add_u32 v11, v39, 11, s40
    v_lshrrev_b32 v12, 3, v43
    v_lshlrev_b16 v13, 3, v43
    v_bitop3_b32 v12, v6, v13, v12 bitop3:0xca
    v_bitop3_b32 v39, v3, v12, v11 bitop3:0xca
    v_lshrrev_b32 v11, 3, v11
    v_lshrrev_b32 v13, 2, v43
    v_bitop3_b32 v11, v5, v13, v11 bitop3:0xca
    v_and_b32 v43, 0x3fff, v11
    ds_add_u32 v43, v2
    v_cvt_pk_bf16_f32 v27, v9, v10
    v_perm_b32 v12, v27, v27, s41
    v_bitop3_b32 v38, v4, v12, v38 bitop3:0xca
    v_perm_b32 v13, v27, v27, s42
    v_bitop3_b32 v39, v4, v13, v39 bitop3:0xca
    s_add_u32 s45, s35, 0x20000
    buffer_store_dwordx4 v[92:95], v0, s[20:23], s45 offen sc1
    s_waitcnt vmcnt(11)
    v_lshlrev_b32 v7, 16, v44
    v_and_b32 v8, 0xffff0000, v44
    v_lshlrev_b32 v9, 16, v45
    v_and_b32 v10, 0xffff0000, v45
    v_mul_f32 v7, 0.15915494, v7
    v_mul_f32 v8, 0.15915494, v8
    v_mul_f32 v9, 0.15915494, v9
    v_mul_f32 v10, 0.15915494, v10
    v_cos_f32 v7, v7
    v_lshl_add_u32 v11, v48, 11, s40
    v_lshrrev_b32 v12, 3, v52
    v_lshlrev_b16 v13, 3, v52
    v_bitop3_b32 v12, v6, v13, v12 bitop3:0xca
    v_bitop3_b32 v48, v3, v12, v11 bitop3:0xca
    v_lshrrev_b32 v11, 3, v11
    v_lshrrev_b32 v13, 2, v52
    v_bitop3_b32 v11, v5, v13, v11 bitop3:0xca
    v_and_b32 v52, 0x3fff, v11
    ds_add_u32 v52, v2
    v_cos_f32 v8, v8
    v_lshl_add_u32 v11, v49, 11, s40
    v_lshrrev_b32 v12, 3, v53
    v_lshlrev_b16 v13, 3, v53
    v_bitop3_b32 v12, v6, v13, v12 bitop3:0xca
    v_bitop3_b32 v49, v3, v12, v11 bitop3:0xca
    v_lshrrev_b32 v11, 3, v11
    v_lshrrev_b32 v13, 2, v53
    v_bitop3_b32 v11, v5, v13, v11 bitop3:0xca
    v_and_b32 v53, 0x3fff, v11
    ds_add_u32 v53, v2
    v_cvt_pk_bf16_f32 v44, v7, v8
    v_perm_b32 v12, v44, v44, s41
    v_bitop3_b32 v48, v4, v12, v48 bitop3:0xca
    v_perm_b32 v13, v44, v44, s42
    v_bitop3_b32 v49, v4, v13, v49 bitop3:0xca
    v_cos_f32 v9, v9
    v_lshl_add_u32 v11, v50, 11, s40
    v_lshrrev_b32 v12, 3, v54
    v_lshlrev_b16 v13, 3, v54
    v_bitop3_b32 v12, v6, v13, v12 bitop3:0xca
    v_bitop3_b32 v50, v3, v12, v11 bitop3:0xca
    v_lshrrev_b32 v11, 3, v11
    v_lshrrev_b32 v13, 2, v54
    v_bitop3_b32 v11, v5, v13, v11 bitop3:0xca
    v_and_b32 v54, 0x3fff, v11
    ds_add_u32 v54, v2
    v_cos_f32 v10, v10
    v_lshl_add_u32 v11, v51, 11, s40
    v_lshrrev_b32 v12, 3, v55
    v_lshlrev_b16 v13, 3, v55
    v_bitop3_b32 v12, v6, v13, v12 bitop3:0xca
    v_bitop3_b32 v51, v3, v12, v11 bitop3:0xca
    v_lshrrev_b32 v11, 3, v11
    v_lshrrev_b32 v13, 2, v55
    v_bitop3_b32 v11, v5, v13, v11 bitop3:0xca
    v_and_b32 v55, 0x3fff, v11
    ds_add_u32 v55, v2
    v_cvt_pk_bf16_f32 v45, v9, v10
    v_perm_b32 v12, v45, v45, s41
    v_bitop3_b32 v50, v4, v12, v50 bitop3:0xca
    v_perm_b32 v13, v45, v45, s42
    v_bitop3_b32 v51, v4, v13, v51 bitop3:0xca
    s_add_u32 s46, s35, 0x24000
    buffer_store_dwordx4 v[84:87], v0, s[20:23], s46 offen sc1
    s_waitcnt vmcnt(8)
    v_lshlrev_b32 v7, 16, v46
    v_and_b32 v8, 0xffff0000, v46
    v_lshlrev_b32 v9, 16, v47
    v_and_b32 v10, 0xffff0000, v47
    v_mul_f32 v7, 0.15915494, v7
    v_mul_f32 v8, 0.15915494, v8
    v_mul_f32 v9, 0.15915494, v9
    v_mul_f32 v10, 0.15915494, v10
    v_cos_f32 v7, v7
    v_lshl_add_u32 v11, v56, 11, s40
    v_lshrrev_b32 v12, 3, v60
    v_lshlrev_b16 v13, 3, v60
    v_bitop3_b32 v12, v6, v13, v12 bitop3:0xca
    v_bitop3_b32 v56, v3, v12, v11 bitop3:0xca
    v_lshrrev_b32 v11, 3, v11
    v_lshrrev_b32 v13, 2, v60
    v_bitop3_b32 v11, v5, v13, v11 bitop3:0xca
    v_and_b32 v60, 0x3fff, v11
    ds_add_u32 v60, v2
    v_cos_f32 v8, v8
    v_lshl_add_u32 v11, v57, 11, s40
    v_lshrrev_b32 v12, 3, v61
    v_lshlrev_b16 v13, 3, v61
    v_bitop3_b32 v12, v6, v13, v12 bitop3:0xca
    v_bitop3_b32 v57, v3, v12, v11 bitop3:0xca
    v_lshrrev_b32 v11, 3, v11
    v_lshrrev_b32 v13, 2, v61
    v_bitop3_b32 v11, v5, v13, v11 bitop3:0xca
    v_and_b32 v61, 0x3fff, v11
    ds_add_u32 v61, v2
    v_cvt_pk_bf16_f32 v46, v7, v8
    v_perm_b32 v12, v46, v46, s41
    v_bitop3_b32 v56, v4, v12, v56 bitop3:0xca
    v_perm_b32 v13, v46, v46, s42
    v_bitop3_b32 v57, v4, v13, v57 bitop3:0xca
    v_cos_f32 v9, v9
    v_lshl_add_u32 v11, v58, 11, s40
    v_lshrrev_b32 v12, 3, v62
    v_lshlrev_b16 v13, 3, v62
    v_bitop3_b32 v12, v6, v13, v12 bitop3:0xca
    v_bitop3_b32 v58, v3, v12, v11 bitop3:0xca
    v_lshrrev_b32 v11, 3, v11
    v_lshrrev_b32 v13, 2, v62
    v_bitop3_b32 v11, v5, v13, v11 bitop3:0xca
    v_and_b32 v62, 0x3fff, v11
    ds_add_u32 v62, v2
    v_cos_f32 v10, v10
    v_lshl_add_u32 v11, v59, 11, s40
    v_lshrrev_b32 v12, 3, v63
    v_lshlrev_b16 v13, 3, v63
    v_bitop3_b32 v12, v6, v13, v12 bitop3:0xca
    v_bitop3_b32 v59, v3, v12, v11 bitop3:0xca
    v_lshrrev_b32 v11, 3, v11
    v_lshrrev_b32 v13, 2, v63
    v_bitop3_b32 v11, v5, v13, v11 bitop3:0xca
    v_and_b32 v63, 0x3fff, v11
    ds_add_u32 v63, v2
    v_cvt_pk_bf16_f32 v47, v9, v10
    v_perm_b32 v12, v47, v47, s41
    v_bitop3_b32 v58, v4, v12, v58 bitop3:0xca
    v_perm_b32 v13, v47, v47, s42
    v_bitop3_b32 v59, v4, v13, v59 bitop3:0xca
    v_lshrrev_b32 v8, 2, v0
    v_and_b32 v7, 0x3c00, v0
    v_bitop3_b32 v7, v5, v8, v7 bitop3:0xea
    s_waitcnt lgkmcnt(0)
    s_barrier
    ds_read2st64_b32 v[8:9], v7 offset0:0 offset1:1
    ds_read2st64_b32 v[10:11], v7 offset0:2 offset1:3
    s_add_u32 s47, s33, 0x3e80000
    buffer_load_dwordx4 v[68:71], v0, s[8:11], s47 offen nt
    s_waitcnt lgkmcnt(0)
    v_lshl_or_b32 v12, v9, 16, v8
    v_lshl_or_b32 v13, v11, 16, v10
    v_mov_b32 v14, v12
    v_mov_b32 v15, v13
    s_nop 0
    v_add_u32_dpp v14, v14, v14 row_shr:1 row_mask:0xf bank_mask:0xf bound_ctrl:1
    v_add_u32_dpp v15, v15, v15 row_shr:1 row_mask:0xf bank_mask:0xf bound_ctrl:1
    s_nop 0
    v_add_u32_dpp v14, v14, v14 row_shr:2 row_mask:0xf bank_mask:0xf bound_ctrl:1
    v_add_u32_dpp v15, v15, v15 row_shr:2 row_mask:0xf bank_mask:0xf bound_ctrl:1
    s_nop 0
    v_add_u32_dpp v14, v14, v14 row_shr:4 row_mask:0xf bank_mask:0xf bound_ctrl:1
    v_add_u32_dpp v15, v15, v15 row_shr:4 row_mask:0xf bank_mask:0xf bound_ctrl:1
    s_nop 0
    v_add_u32_dpp v14, v14, v14 row_shr:8 row_mask:0xf bank_mask:0xf bound_ctrl:1
    v_add_u32_dpp v15, v15, v15 row_shr:8 row_mask:0xf bank_mask:0xf bound_ctrl:1
    s_nop 0
    v_add_u32_dpp v14, v14, v14 row_bcast:15 row_mask:0xa bank_mask:0xf
    v_add_u32_dpp v15, v15, v15 row_bcast:15 row_mask:0xa bank_mask:0xf
    s_nop 0
    v_add_u32_dpp v14, v14, v14 row_bcast:31 row_mask:0xc bank_mask:0xf
    v_add_u32_dpp v15, v15, v15 row_bcast:31 row_mask:0xc bank_mask:0xf
    v_readlane_b32 s48, v14, 63
    v_readlane_b32 s49, v15, 63
    s_lshl_b32 s54, s32, 2
    v_mov_b32 v8, s54
    s_and_b32 s50, s48, 0xffff
    s_lshr_b32 s51, s48, 16
    s_and_b32 s52, s49, 0xffff
    s_lshr_b32 s53, s49, 16
    s_add_u32 s51, s51, s50
    s_add_u32 s52, s52, s51
    s_add_u32 s53, s53, s52
    v_mov_b32 v9, s53
    s_mov_b64 exec, 1
    ds_write_b32 v8, v9 offset:16384
    s_mov_b64 exec, -1
    v_and_b32 v8, 60, v7
    s_waitcnt lgkmcnt(0)
    s_barrier
    ds_read_b32 v9, v8 offset:16384
    s_waitcnt lgkmcnt(0)
    v_add_u32_dpp v9, v9, v9 row_shr:1 row_mask:0xf bank_mask:0xf bound_ctrl:1
    s_nop 1
    v_add_u32_dpp v9, v9, v9 row_shr:2 row_mask:0xf bank_mask:0xf bound_ctrl:1
    s_nop 1
    v_add_u32_dpp v9, v9, v9 row_shr:4 row_mask:0xf bank_mask:0xf bound_ctrl:1
    s_nop 1
    v_add_u32_dpp v9, v9, v9 row_shr:8 row_mask:0xf bank_mask:0xf bound_ctrl:1
    s_nop 0
    v_readlane_b32 s54, v9, s32
    s_sub_u32 s54, s54, s53
    s_add_u32 s50, s50, s54
    s_add_u32 s51, s51, s54
    s_add_u32 s52, s52, s54
    s_pack_ll_b32_b16 s48, s54, s50
    s_pack_ll_b32_b16 s49, s51, s52
    v_add_u32 v14, s48, v14
    v_add_u32 v15, s49, v15
    v_sub_u32 v12, v14, v12
    v_sub_u32 v13, v15, v13
    v_and_b32 v8, 0xffff, v12
    v_lshrrev_b32 v9, 16, v12
    v_and_b32 v10, 0xffff, v13
    v_lshrrev_b32 v11, 16, v13
    ds_write2st64_b32 v7, v8, v9 offset0:0 offset1:1
    ds_write2st64_b32 v7, v10, v11 offset0:2 offset1:3
    s_waitcnt lgkmcnt(0)
    s_barrier
    ds_add_rtn_u32 v100, v100, v2
    ds_add_rtn_u32 v101, v101, v2
    ds_add_rtn_u32 v102, v102, v2
    ds_add_rtn_u32 v103, v103, v2
    s_add_u32 s44, s36, 0x1fbd00
    buffer_store_dwordx2 v[12:13], v1, s[24:27], s44 offen
    s_bitset0_b64 exec, 63
    s_not_b64 exec, exec
    buffer_store_dwordx2 v[14:15], v1, s[24:27], s44 offen offset:8
    s_mov_b64 exec, -1
    ds_add_rtn_u32 v112, v112, v2
    ds_add_rtn_u32 v113, v113, v2
    ds_add_rtn_u32 v114, v114, v2
    ds_add_rtn_u32 v115, v115, v2
    s_add_u32 s45, s33, 0x3e80000
    buffer_load_dwordx4 v[72:75], v0, s[12:15], s45 offen nt
    ds_add_rtn_u32 v120, v120, v2
    ds_add_rtn_u32 v121, v121, v2
    ds_add_rtn_u32 v122, v122, v2
    ds_add_rtn_u32 v123, v123, v2
    s_add_u32 s46, s34, 0x1f40000
    buffer_load_dwordx2 v[64:65], v1, s[16:19], s46 offen nt
    s_add_u32 s47, s34, 0x1f42000
    buffer_load_dwordx2 v[66:67], v1, s[16:19], s47 offen nt
    ds_add_rtn_u32 v20, v20, v2
    ds_add_rtn_u32 v21, v21, v2
    ds_add_rtn_u32 v22, v22, v2
    ds_add_rtn_u32 v23, v23, v2
    s_add_u32 s44, s33, 0x3e84000
    buffer_load_dwordx4 v[76:79], v0, s[8:11], s44 offen nt
    ds_add_rtn_u32 v32, v32, v2
    ds_add_rtn_u32 v33, v33, v2
    ds_add_rtn_u32 v34, v34, v2
    ds_add_rtn_u32 v35, v35, v2
    s_add_u32 s45, s33, 0x3e84000
    buffer_load_dwordx4 v[80:83], v0, s[12:15], s45 offen nt
    ds_add_rtn_u32 v40, v40, v2
    ds_add_rtn_u32 v41, v41, v2
    ds_add_rtn_u32 v42, v42, v2
    ds_add_rtn_u32 v43, v43, v2
    s_add_u32 s46, s33, 0x3e88000
    buffer_load_dwordx4 v[88:91], v0, s[8:11], s46 offen nt
    ds_add_rtn_u32 v52, v52, v2
    ds_add_rtn_u32 v53, v53, v2
    ds_add_rtn_u32 v54, v54, v2
    ds_add_rtn_u32 v55, v55, v2
    s_add_u32 s47, s33, 0x3e88000
    buffer_load_dwordx4 v[92:95], v0, s[12:15], s47 offen nt
    ds_add_rtn_u32 v60, v60, v2
    ds_add_rtn_u32 v61, v61, v2
    ds_add_rtn_u32 v62, v62, v2
    ds_add_rtn_u32 v63, v63, v2
    s_add_u32 s44, s34, 0x1f44000
    buffer_load_dwordx2 v[84:85], v1, s[16:19], s44 offen nt
    s_add_u32 s45, s34, 0x1f46000
    buffer_load_dwordx2 v[86:87], v1, s[16:19], s45 offen nt
    s_waitcnt lgkmcnt(0)
    s_barrier
    v_and_b32 v7, -4, v100
    v_lshl_add_u32 v8, v100, 2, v7
    ds_write_b32 v8, v96
    v_lshl_add_u32 v7, v7, 2, v100
    ds_write_b8 v7, v104 offset:16
    v_and_b32 v9, -4, v101
    v_lshl_add_u32 v10, v101, 2, v9
    ds_write_b32 v10, v97
    v_lshl_add_u32 v9, v9, 2, v101
    ds_write_b8_d16_hi v9, v104 offset:16
    v_and_b32 v7, -4, v102
    v_lshl_add_u32 v8, v102, 2, v7
    ds_write_b32 v8, v98
    v_lshl_add_u32 v7, v7, 2, v102
    ds_write_b8 v7, v105 offset:16
    v_and_b32 v9, -4, v103
    v_lshl_add_u32 v10, v103, 2, v9
    ds_write_b32 v10, v99
    v_lshl_add_u32 v9, v9, 2, v103
    ds_write_b8_d16_hi v9, v105 offset:16
    s_add_u32 s46, s33, 0x3e8c000
    buffer_load_dwordx4 v[96:99], v0, s[8:11], s46 offen nt
    s_add_u32 s47, s33, 0x3e8c000
    buffer_load_dwordx4 v[100:103], v0, s[12:15], s47 offen nt
    v_and_b32 v7, -4, v112
    v_lshl_add_u32 v8, v112, 2, v7
    ds_write_b32 v8, v108
    v_lshl_add_u32 v7, v7, 2, v112
    ds_write_b8 v7, v106 offset:16
    v_and_b32 v9, -4, v113
    v_lshl_add_u32 v10, v113, 2, v9
    ds_write_b32 v10, v109
    v_lshl_add_u32 v9, v9, 2, v113
    ds_write_b8_d16_hi v9, v106 offset:16
    v_and_b32 v7, -4, v114
    v_lshl_add_u32 v8, v114, 2, v7
    ds_write_b32 v8, v110
    v_lshl_add_u32 v7, v7, 2, v114
    ds_write_b8 v7, v107 offset:16
    v_and_b32 v9, -4, v115
    v_lshl_add_u32 v10, v115, 2, v9
    ds_write_b32 v10, v111
    v_lshl_add_u32 v9, v9, 2, v115
    ds_write_b8_d16_hi v9, v107 offset:16
    s_add_u32 s44, s33, 0x3e90000
    buffer_load_dwordx4 v[108:111], v0, s[8:11], s44 offen nt
    v_and_b32 v7, -4, v120
    v_lshl_add_u32 v8, v120, 2, v7
    ds_write_b32 v8, v116
    v_lshl_add_u32 v7, v7, 2, v120
    ds_write_b8 v7, v124 offset:16
    v_and_b32 v9, -4, v121
    v_lshl_add_u32 v10, v121, 2, v9
    ds_write_b32 v10, v117
    v_lshl_add_u32 v9, v9, 2, v121
    ds_write_b8_d16_hi v9, v124 offset:16
    v_and_b32 v7, -4, v122
    v_lshl_add_u32 v8, v122, 2, v7
    ds_write_b32 v8, v118
    v_lshl_add_u32 v7, v7, 2, v122
    ds_write_b8 v7, v125 offset:16
    v_and_b32 v9, -4, v123
    v_lshl_add_u32 v10, v123, 2, v9
    ds_write_b32 v10, v119
    v_lshl_add_u32 v9, v9, 2, v123
    ds_write_b8_d16_hi v9, v125 offset:16
    s_add_u32 s45, s33, 0x3e90000
    buffer_load_dwordx4 v[112:115], v0, s[12:15], s45 offen nt
    v_and_b32 v7, -4, v20
    v_lshl_add_u32 v8, v20, 2, v7
    ds_write_b32 v8, v16
    v_lshl_add_u32 v7, v7, 2, v20
    ds_write_b8 v7, v126 offset:16
    v_and_b32 v9, -4, v21
    v_lshl_add_u32 v10, v21, 2, v9
    ds_write_b32 v10, v17
    v_lshl_add_u32 v9, v9, 2, v21
    ds_write_b8_d16_hi v9, v126 offset:16
    v_and_b32 v7, -4, v22
    v_lshl_add_u32 v8, v22, 2, v7
    ds_write_b32 v8, v18
    v_lshl_add_u32 v7, v7, 2, v22
    ds_write_b8 v7, v127 offset:16
    v_and_b32 v9, -4, v23
    v_lshl_add_u32 v10, v23, 2, v9
    ds_write_b32 v10, v19
    v_lshl_add_u32 v9, v9, 2, v23
    ds_write_b8_d16_hi v9, v127 offset:16
    s_add_u32 s46, s34, 0x1f48000
    buffer_load_dwordx2 v[104:105], v1, s[16:19], s46 offen nt
    s_add_u32 s47, s34, 0x1f4a000
    buffer_load_dwordx2 v[106:107], v1, s[16:19], s47 offen nt
    v_and_b32 v7, -4, v32
    v_lshl_add_u32 v8, v32, 2, v7
    ds_write_b32 v8, v28
    v_lshl_add_u32 v7, v7, 2, v32
    ds_write_b8 v7, v24 offset:16
    v_and_b32 v9, -4, v33
    v_lshl_add_u32 v10, v33, 2, v9
    ds_write_b32 v10, v29
    v_lshl_add_u32 v9, v9, 2, v33
    ds_write_b8_d16_hi v9, v24 offset:16
    v_and_b32 v7, -4, v34
    v_lshl_add_u32 v8, v34, 2, v7
    ds_write_b32 v8, v30
    v_lshl_add_u32 v7, v7, 2, v34
    ds_write_b8 v7, v25 offset:16
    v_and_b32 v9, -4, v35
    v_lshl_add_u32 v10, v35, 2, v9
    ds_write_b32 v10, v31
    v_lshl_add_u32 v9, v9, 2, v35
    ds_write_b8_d16_hi v9, v25 offset:16
    s_add_u32 s44, s33, 0x3e94000
    buffer_load_dwordx4 v[116:119], v0, s[8:11], s44 offen nt
    s_add_u32 s45, s33, 0x3e94000
    buffer_load_dwordx4 v[120:123], v0, s[12:15], s45 offen nt
    v_and_b32 v7, -4, v40
    v_lshl_add_u32 v8, v40, 2, v7
    ds_write_b32 v8, v36
    v_lshl_add_u32 v7, v7, 2, v40
    ds_write_b8 v7, v26 offset:16
    v_and_b32 v9, -4, v41
    v_lshl_add_u32 v10, v41, 2, v9
    ds_write_b32 v10, v37
    v_lshl_add_u32 v9, v9, 2, v41
    ds_write_b8_d16_hi v9, v26 offset:16
    v_and_b32 v7, -4, v42
    v_lshl_add_u32 v8, v42, 2, v7
    ds_write_b32 v8, v38
    v_lshl_add_u32 v7, v7, 2, v42
    ds_write_b8 v7, v27 offset:16
    v_and_b32 v9, -4, v43
    v_lshl_add_u32 v10, v43, 2, v9
    ds_write_b32 v10, v39
    v_lshl_add_u32 v9, v9, 2, v43
    ds_write_b8_d16_hi v9, v27 offset:16
    s_add_u32 s46, s33, 0x3e98000
    buffer_load_dwordx4 v[16:19], v0, s[8:11], s46 offen nt
    v_and_b32 v7, -4, v52
    v_lshl_add_u32 v8, v52, 2, v7
    ds_write_b32 v8, v48
    v_lshl_add_u32 v7, v7, 2, v52
    ds_write_b8 v7, v44 offset:16
    v_and_b32 v9, -4, v53
    v_lshl_add_u32 v10, v53, 2, v9
    ds_write_b32 v10, v49
    v_lshl_add_u32 v9, v9, 2, v53
    ds_write_b8_d16_hi v9, v44 offset:16
    v_and_b32 v7, -4, v54
    v_lshl_add_u32 v8, v54, 2, v7
    ds_write_b32 v8, v50
    v_lshl_add_u32 v7, v7, 2, v54
    ds_write_b8 v7, v45 offset:16
    v_and_b32 v9, -4, v55
    v_lshl_add_u32 v10, v55, 2, v9
    ds_write_b32 v10, v51
    v_lshl_add_u32 v9, v9, 2, v55
    ds_write_b8_d16_hi v9, v45 offset:16
    s_add_u32 s47, s33, 0x3e98000
    buffer_load_dwordx4 v[20:23], v0, s[12:15], s47 offen nt
    v_and_b32 v7, -4, v60
    v_lshl_add_u32 v8, v60, 2, v7
    ds_write_b32 v8, v56
    v_lshl_add_u32 v7, v7, 2, v60
    ds_write_b8 v7, v46 offset:16
    v_and_b32 v9, -4, v61
    v_lshl_add_u32 v10, v61, 2, v9
    ds_write_b32 v10, v57
    v_lshl_add_u32 v9, v9, 2, v61
    ds_write_b8_d16_hi v9, v46 offset:16
    v_and_b32 v7, -4, v62
    v_lshl_add_u32 v8, v62, 2, v7
    ds_write_b32 v8, v58
    v_lshl_add_u32 v7, v7, 2, v62
    ds_write_b8 v7, v47 offset:16
    v_and_b32 v9, -4, v63
    v_lshl_add_u32 v10, v63, 2, v9
    ds_write_b32 v10, v59
    v_lshl_add_u32 v9, v9, 2, v63
    ds_write_b8_d16_hi v9, v47 offset:16
    s_add_u32 s44, s34, 0x1f4c000
    buffer_load_dwordx2 v[124:125], v1, s[16:19], s44 offen nt
    s_add_u32 s45, s34, 0x1f4e000
    buffer_load_dwordx2 v[126:127], v1, s[16:19], s45 offen nt
    v_add_u32 v7, 0x10000, v0
    v_add_u32 v12, 0x20000, v0
    v_mov_b32 v8, 0
    v_mov_b32 v9, 0
    v_mov_b32 v10, 0
    v_mov_b32 v11, 0
    s_waitcnt lgkmcnt(0)
    s_barrier
    ds_read_b128 v[28:31], v0 offset:0
    ds_write_b128 v0, v[8:11]
    ds_read_b128 v[32:35], v0 offset:16384
    ds_read_b128 v[36:39], v0 offset:32768
    ds_read_b128 v[40:43], v0 offset:49152
    ds_read_b128 v[24:27], v7 offset:0
    ds_read_b128 v[48:51], v7 offset:16384
    ds_read_b128 v[52:55], v7 offset:32768
    ds_read_b128 v[56:59], v7 offset:49152
    ds_read_b128 v[60:63], v12 offset:0
    ds_read_b128 v[44:47], v12 offset:16384
    s_waitcnt lgkmcnt(0)
    s_barrier
    s_add_u32 s46, s35, 0x2710000
    buffer_store_dwordx4 v[28:31], v0, s[20:23], s46 offen sc1
    s_add_u32 s47, s35, 0x2714000
    buffer_store_dwordx4 v[32:35], v0, s[20:23], s47 offen sc1
    s_add_u32 s44, s33, 0x3e9c000
    buffer_load_dwordx4 v[28:31], v0, s[8:11], s44 offen nt
    s_add_u32 s45, s33, 0x3e9c000
    buffer_load_dwordx4 v[32:35], v0, s[12:15], s45 offen nt
    s_add_u32 s46, s35, 0x2718000
    buffer_store_dwordx4 v[36:39], v0, s[20:23], s46 offen sc1
    s_waitcnt vmcnt(23)
    v_lshlrev_b32 v7, 16, v64
    v_and_b32 v8, 0xffff0000, v64
    v_lshlrev_b32 v9, 16, v65
    v_and_b32 v10, 0xffff0000, v65
    v_mul_f32 v7, 0.15915494, v7
    v_mul_f32 v8, 0.15915494, v8
    v_mul_f32 v9, 0.15915494, v9
    v_mul_f32 v10, 0.15915494, v10
    v_cos_f32 v7, v7
    v_lshl_add_u32 v11, v68, 11, s40
    v_lshrrev_b32 v12, 3, v72
    v_lshlrev_b16 v13, 3, v72
    v_bitop3_b32 v12, v6, v13, v12 bitop3:0xca
    v_bitop3_b32 v68, v3, v12, v11 bitop3:0xca
    v_lshrrev_b32 v11, 3, v11
    v_lshrrev_b32 v13, 2, v72
    v_bitop3_b32 v11, v5, v13, v11 bitop3:0xca
    v_and_b32 v72, 0x3fff, v11
    ds_add_u32 v72, v2
    v_cos_f32 v8, v8
    v_lshl_add_u32 v11, v69, 11, s40
    v_lshrrev_b32 v12, 3, v73
    v_lshlrev_b16 v13, 3, v73
    v_bitop3_b32 v12, v6, v13, v12 bitop3:0xca
    v_bitop3_b32 v69, v3, v12, v11 bitop3:0xca
    v_lshrrev_b32 v11, 3, v11
    v_lshrrev_b32 v13, 2, v73
    v_bitop3_b32 v11, v5, v13, v11 bitop3:0xca
    v_and_b32 v73, 0x3fff, v11
    ds_add_u32 v73, v2
    v_cvt_pk_bf16_f32 v64, v7, v8
    v_perm_b32 v12, v64, v64, s41
    v_bitop3_b32 v68, v4, v12, v68 bitop3:0xca
    v_perm_b32 v13, v64, v64, s42
    v_bitop3_b32 v69, v4, v13, v69 bitop3:0xca
    v_cos_f32 v9, v9
    v_lshl_add_u32 v11, v70, 11, s40
    v_lshrrev_b32 v12, 3, v74
    v_lshlrev_b16 v13, 3, v74
    v_bitop3_b32 v12, v6, v13, v12 bitop3:0xca
    v_bitop3_b32 v70, v3, v12, v11 bitop3:0xca
    v_lshrrev_b32 v11, 3, v11
    v_lshrrev_b32 v13, 2, v74
    v_bitop3_b32 v11, v5, v13, v11 bitop3:0xca
    v_and_b32 v74, 0x3fff, v11
    ds_add_u32 v74, v2
    v_cos_f32 v10, v10
    v_lshl_add_u32 v11, v71, 11, s40
    v_lshrrev_b32 v12, 3, v75
    v_lshlrev_b16 v13, 3, v75
    v_bitop3_b32 v12, v6, v13, v12 bitop3:0xca
    v_bitop3_b32 v71, v3, v12, v11 bitop3:0xca
    v_lshrrev_b32 v11, 3, v11
    v_lshrrev_b32 v13, 2, v75
    v_bitop3_b32 v11, v5, v13, v11 bitop3:0xca
    v_and_b32 v75, 0x3fff, v11
    ds_add_u32 v75, v2
    v_cvt_pk_bf16_f32 v65, v9, v10
    v_perm_b32 v12, v65, v65, s41
    v_bitop3_b32 v70, v4, v12, v70 bitop3:0xca
    v_perm_b32 v13, v65, v65, s42
    v_bitop3_b32 v71, v4, v13, v71 bitop3:0xca
    s_add_u32 s47, s35, 0x271c000
    buffer_store_dwordx4 v[40:43], v0, s[20:23], s47 offen sc1
    s_waitcnt vmcnt(22)
    v_lshlrev_b32 v7, 16, v66
    v_and_b32 v8, 0xffff0000, v66
    v_lshlrev_b32 v9, 16, v67
    v_and_b32 v10, 0xffff0000, v67
    v_mul_f32 v7, 0.15915494, v7
    v_mul_f32 v8, 0.15915494, v8
    v_mul_f32 v9, 0.15915494, v9
    v_mul_f32 v10, 0.15915494, v10
    v_cos_f32 v7, v7
    v_lshl_add_u32 v11, v76, 11, s40
    v_lshrrev_b32 v12, 3, v80
    v_lshlrev_b16 v13, 3, v80
    v_bitop3_b32 v12, v6, v13, v12 bitop3:0xca
    v_bitop3_b32 v76, v3, v12, v11 bitop3:0xca
    v_lshrrev_b32 v11, 3, v11
    v_lshrrev_b32 v13, 2, v80
    v_bitop3_b32 v11, v5, v13, v11 bitop3:0xca
    v_and_b32 v80, 0x3fff, v11
    ds_add_u32 v80, v2
    v_cos_f32 v8, v8
    v_lshl_add_u32 v11, v77, 11, s40
    v_lshrrev_b32 v12, 3, v81
    v_lshlrev_b16 v13, 3, v81
    v_bitop3_b32 v12, v6, v13, v12 bitop3:0xca
    v_bitop3_b32 v77, v3, v12, v11 bitop3:0xca
    v_lshrrev_b32 v11, 3, v11
    v_lshrrev_b32 v13, 2, v81
    v_bitop3_b32 v11, v5, v13, v11 bitop3:0xca
    v_and_b32 v81, 0x3fff, v11
    ds_add_u32 v81, v2
    v_cvt_pk_bf16_f32 v66, v7, v8
    v_perm_b32 v12, v66, v66, s41
    v_bitop3_b32 v76, v4, v12, v76 bitop3:0xca
    v_perm_b32 v13, v66, v66, s42
    v_bitop3_b32 v77, v4, v13, v77 bitop3:0xca
    v_cos_f32 v9, v9
    v_lshl_add_u32 v11, v78, 11, s40
    v_lshrrev_b32 v12, 3, v82
    v_lshlrev_b16 v13, 3, v82
    v_bitop3_b32 v12, v6, v13, v12 bitop3:0xca
    v_bitop3_b32 v78, v3, v12, v11 bitop3:0xca
    v_lshrrev_b32 v11, 3, v11
    v_lshrrev_b32 v13, 2, v82
    v_bitop3_b32 v11, v5, v13, v11 bitop3:0xca
    v_and_b32 v82, 0x3fff, v11
    ds_add_u32 v82, v2
    v_cos_f32 v10, v10
    v_lshl_add_u32 v11, v79, 11, s40
    v_lshrrev_b32 v12, 3, v83
    v_lshlrev_b16 v13, 3, v83
    v_bitop3_b32 v12, v6, v13, v12 bitop3:0xca
    v_bitop3_b32 v79, v3, v12, v11 bitop3:0xca
    v_lshrrev_b32 v11, 3, v11
    v_lshrrev_b32 v13, 2, v83
    v_bitop3_b32 v11, v5, v13, v11 bitop3:0xca
    v_and_b32 v83, 0x3fff, v11
    ds_add_u32 v83, v2
    v_cvt_pk_bf16_f32 v67, v9, v10
    v_perm_b32 v12, v67, v67, s41
    v_bitop3_b32 v78, v4, v12, v78 bitop3:0xca
    v_perm_b32 v13, v67, v67, s42
    v_bitop3_b32 v79, v4, v13, v79 bitop3:0xca
    s_add_u32 s44, s35, 0x2720000
    buffer_store_dwordx4 v[24:27], v0, s[20:23], s44 offen sc1
    s_waitcnt vmcnt(19)
    v_lshlrev_b32 v7, 16, v84
    v_and_b32 v8, 0xffff0000, v84
    v_lshlrev_b32 v9, 16, v85
    v_and_b32 v10, 0xffff0000, v85
    v_mul_f32 v7, 0.15915494, v7
    v_mul_f32 v8, 0.15915494, v8
    v_mul_f32 v9, 0.15915494, v9
    v_mul_f32 v10, 0.15915494, v10
    v_cos_f32 v7, v7
    v_lshl_add_u32 v11, v88, 11, s40
    v_lshrrev_b32 v12, 3, v92
    v_lshlrev_b16 v13, 3, v92
    v_bitop3_b32 v12, v6, v13, v12 bitop3:0xca
    v_bitop3_b32 v88, v3, v12, v11 bitop3:0xca
    v_lshrrev_b32 v11, 3, v11
    v_lshrrev_b32 v13, 2, v92
    v_bitop3_b32 v11, v5, v13, v11 bitop3:0xca
    v_and_b32 v92, 0x3fff, v11
    ds_add_u32 v92, v2
    v_cos_f32 v8, v8
    v_lshl_add_u32 v11, v89, 11, s40
    v_lshrrev_b32 v12, 3, v93
    v_lshlrev_b16 v13, 3, v93
    v_bitop3_b32 v12, v6, v13, v12 bitop3:0xca
    v_bitop3_b32 v89, v3, v12, v11 bitop3:0xca
    v_lshrrev_b32 v11, 3, v11
    v_lshrrev_b32 v13, 2, v93
    v_bitop3_b32 v11, v5, v13, v11 bitop3:0xca
    v_and_b32 v93, 0x3fff, v11
    ds_add_u32 v93, v2
    v_cvt_pk_bf16_f32 v84, v7, v8
    v_perm_b32 v12, v84, v84, s41
    v_bitop3_b32 v88, v4, v12, v88 bitop3:0xca
    v_perm_b32 v13, v84, v84, s42
    v_bitop3_b32 v89, v4, v13, v89 bitop3:0xca
    v_cos_f32 v9, v9
    v_lshl_add_u32 v11, v90, 11, s40
    v_lshrrev_b32 v12, 3, v94
    v_lshlrev_b16 v13, 3, v94
    v_bitop3_b32 v12, v6, v13, v12 bitop3:0xca
    v_bitop3_b32 v90, v3, v12, v11 bitop3:0xca
    v_lshrrev_b32 v11, 3, v11
    v_lshrrev_b32 v13, 2, v94
    v_bitop3_b32 v11, v5, v13, v11 bitop3:0xca
    v_and_b32 v94, 0x3fff, v11
    ds_add_u32 v94, v2
    v_cos_f32 v10, v10
    v_lshl_add_u32 v11, v91, 11, s40
    v_lshrrev_b32 v12, 3, v95
    v_lshlrev_b16 v13, 3, v95
    v_bitop3_b32 v12, v6, v13, v12 bitop3:0xca
    v_bitop3_b32 v91, v3, v12, v11 bitop3:0xca
    v_lshrrev_b32 v11, 3, v11
    v_lshrrev_b32 v13, 2, v95
    v_bitop3_b32 v11, v5, v13, v11 bitop3:0xca
    v_and_b32 v95, 0x3fff, v11
    ds_add_u32 v95, v2
    v_cvt_pk_bf16_f32 v85, v9, v10
    v_perm_b32 v12, v85, v85, s41
    v_bitop3_b32 v90, v4, v12, v90 bitop3:0xca
    v_perm_b32 v13, v85, v85, s42
    v_bitop3_b32 v91, v4, v13, v91 bitop3:0xca
    s_add_u32 s45, s35, 0x2724000
    buffer_store_dwordx4 v[48:51], v0, s[20:23], s45 offen sc1
    s_waitcnt vmcnt(18)
    v_lshlrev_b32 v7, 16, v86
    v_and_b32 v8, 0xffff0000, v86
    v_lshlrev_b32 v9, 16, v87
    v_and_b32 v10, 0xffff0000, v87
    v_mul_f32 v7, 0.15915494, v7
    v_mul_f32 v8, 0.15915494, v8
    v_mul_f32 v9, 0.15915494, v9
    v_mul_f32 v10, 0.15915494, v10
    v_cos_f32 v7, v7
    v_lshl_add_u32 v11, v96, 11, s40
    v_lshrrev_b32 v12, 3, v100
    v_lshlrev_b16 v13, 3, v100
    v_bitop3_b32 v12, v6, v13, v12 bitop3:0xca
    v_bitop3_b32 v96, v3, v12, v11 bitop3:0xca
    v_lshrrev_b32 v11, 3, v11
    v_lshrrev_b32 v13, 2, v100
    v_bitop3_b32 v11, v5, v13, v11 bitop3:0xca
    v_and_b32 v100, 0x3fff, v11
    ds_add_u32 v100, v2
    v_cos_f32 v8, v8
    v_lshl_add_u32 v11, v97, 11, s40
    v_lshrrev_b32 v12, 3, v101
    v_lshlrev_b16 v13, 3, v101
    v_bitop3_b32 v12, v6, v13, v12 bitop3:0xca
    v_bitop3_b32 v97, v3, v12, v11 bitop3:0xca
    v_lshrrev_b32 v11, 3, v11
    v_lshrrev_b32 v13, 2, v101
    v_bitop3_b32 v11, v5, v13, v11 bitop3:0xca
    v_and_b32 v101, 0x3fff, v11
    ds_add_u32 v101, v2
    v_cvt_pk_bf16_f32 v86, v7, v8
    v_perm_b32 v12, v86, v86, s41
    v_bitop3_b32 v96, v4, v12, v96 bitop3:0xca
    v_perm_b32 v13, v86, v86, s42
    v_bitop3_b32 v97, v4, v13, v97 bitop3:0xca
    v_cos_f32 v9, v9
    v_lshl_add_u32 v11, v98, 11, s40
    v_lshrrev_b32 v12, 3, v102
    v_lshlrev_b16 v13, 3, v102
    v_bitop3_b32 v12, v6, v13, v12 bitop3:0xca
    v_bitop3_b32 v98, v3, v12, v11 bitop3:0xca
    v_lshrrev_b32 v11, 3, v11
    v_lshrrev_b32 v13, 2, v102
    v_bitop3_b32 v11, v5, v13, v11 bitop3:0xca
    v_and_b32 v102, 0x3fff, v11
    ds_add_u32 v102, v2
    v_cos_f32 v10, v10
    v_lshl_add_u32 v11, v99, 11, s40
    v_lshrrev_b32 v12, 3, v103
    v_lshlrev_b16 v13, 3, v103
    v_bitop3_b32 v12, v6, v13, v12 bitop3:0xca
    v_bitop3_b32 v99, v3, v12, v11 bitop3:0xca
    v_lshrrev_b32 v11, 3, v11
    v_lshrrev_b32 v13, 2, v103
    v_bitop3_b32 v11, v5, v13, v11 bitop3:0xca
    v_and_b32 v103, 0x3fff, v11
    ds_add_u32 v103, v2
    v_cvt_pk_bf16_f32 v87, v9, v10
    v_perm_b32 v12, v87, v87, s41
    v_bitop3_b32 v98, v4, v12, v98 bitop3:0xca
    v_perm_b32 v13, v87, v87, s42
    v_bitop3_b32 v99, v4, v13, v99 bitop3:0xca
    s_add_u32 s46, s35, 0x2728000
    buffer_store_dwordx4 v[52:55], v0, s[20:23], s46 offen sc1
    s_waitcnt vmcnt(15)
    v_lshlrev_b32 v7, 16, v104
    v_and_b32 v8, 0xffff0000, v104
    v_lshlrev_b32 v9, 16, v105
    v_and_b32 v10, 0xffff0000, v105
    v_mul_f32 v7, 0.15915494, v7
    v_mul_f32 v8, 0.15915494, v8
    v_mul_f32 v9, 0.15915494, v9
    v_mul_f32 v10, 0.15915494, v10
    v_cos_f32 v7, v7
    v_lshl_add_u32 v11, v108, 11, s40
    v_lshrrev_b32 v12, 3, v112
    v_lshlrev_b16 v13, 3, v112
    v_bitop3_b32 v12, v6, v13, v12 bitop3:0xca
    v_bitop3_b32 v108, v3, v12, v11 bitop3:0xca
    v_lshrrev_b32 v11, 3, v11
    v_lshrrev_b32 v13, 2, v112
    v_bitop3_b32 v11, v5, v13, v11 bitop3:0xca
    v_and_b32 v112, 0x3fff, v11
    ds_add_u32 v112, v2
    v_cos_f32 v8, v8
    v_lshl_add_u32 v11, v109, 11, s40
    v_lshrrev_b32 v12, 3, v113
    v_lshlrev_b16 v13, 3, v113
    v_bitop3_b32 v12, v6, v13, v12 bitop3:0xca
    v_bitop3_b32 v109, v3, v12, v11 bitop3:0xca
    v_lshrrev_b32 v11, 3, v11
    v_lshrrev_b32 v13, 2, v113
    v_bitop3_b32 v11, v5, v13, v11 bitop3:0xca
    v_and_b32 v113, 0x3fff, v11
    ds_add_u32 v113, v2
    v_cvt_pk_bf16_f32 v104, v7, v8
    v_perm_b32 v12, v104, v104, s41
    v_bitop3_b32 v108, v4, v12, v108 bitop3:0xca
    v_perm_b32 v13, v104, v104, s42
    v_bitop3_b32 v109, v4, v13, v109 bitop3:0xca
    v_cos_f32 v9, v9
    v_lshl_add_u32 v11, v110, 11, s40
    v_lshrrev_b32 v12, 3, v114
    v_lshlrev_b16 v13, 3, v114
    v_bitop3_b32 v12, v6, v13, v12 bitop3:0xca
    v_bitop3_b32 v110, v3, v12, v11 bitop3:0xca
    v_lshrrev_b32 v11, 3, v11
    v_lshrrev_b32 v13, 2, v114
    v_bitop3_b32 v11, v5, v13, v11 bitop3:0xca
    v_and_b32 v114, 0x3fff, v11
    ds_add_u32 v114, v2
    v_cos_f32 v10, v10
    v_lshl_add_u32 v11, v111, 11, s40
    v_lshrrev_b32 v12, 3, v115
    v_lshlrev_b16 v13, 3, v115
    v_bitop3_b32 v12, v6, v13, v12 bitop3:0xca
    v_bitop3_b32 v111, v3, v12, v11 bitop3:0xca
    v_lshrrev_b32 v11, 3, v11
    v_lshrrev_b32 v13, 2, v115
    v_bitop3_b32 v11, v5, v13, v11 bitop3:0xca
    v_and_b32 v115, 0x3fff, v11
    ds_add_u32 v115, v2
    v_cvt_pk_bf16_f32 v105, v9, v10
    v_perm_b32 v12, v105, v105, s41
    v_bitop3_b32 v110, v4, v12, v110 bitop3:0xca
    v_perm_b32 v13, v105, v105, s42
    v_bitop3_b32 v111, v4, v13, v111 bitop3:0xca
    s_add_u32 s47, s35, 0x272c000
    buffer_store_dwordx4 v[56:59], v0, s[20:23], s47 offen sc1
    s_waitcnt vmcnt(14)
    v_lshlrev_b32 v7, 16, v106
    v_and_b32 v8, 0xffff0000, v106
    v_lshlrev_b32 v9, 16, v107
    v_and_b32 v10, 0xffff0000, v107
    v_mul_f32 v7, 0.15915494, v7
    v_mul_f32 v8, 0.15915494, v8
    v_mul_f32 v9, 0.15915494, v9
    v_mul_f32 v10, 0.15915494, v10
    v_cos_f32 v7, v7
    v_lshl_add_u32 v11, v116, 11, s40
    v_lshrrev_b32 v12, 3, v120
    v_lshlrev_b16 v13, 3, v120
    v_bitop3_b32 v12, v6, v13, v12 bitop3:0xca
    v_bitop3_b32 v116, v3, v12, v11 bitop3:0xca
    v_lshrrev_b32 v11, 3, v11
    v_lshrrev_b32 v13, 2, v120
    v_bitop3_b32 v11, v5, v13, v11 bitop3:0xca
    v_and_b32 v120, 0x3fff, v11
    ds_add_u32 v120, v2
    v_cos_f32 v8, v8
    v_lshl_add_u32 v11, v117, 11, s40
    v_lshrrev_b32 v12, 3, v121
    v_lshlrev_b16 v13, 3, v121
    v_bitop3_b32 v12, v6, v13, v12 bitop3:0xca
    v_bitop3_b32 v117, v3, v12, v11 bitop3:0xca
    v_lshrrev_b32 v11, 3, v11
    v_lshrrev_b32 v13, 2, v121
    v_bitop3_b32 v11, v5, v13, v11 bitop3:0xca
    v_and_b32 v121, 0x3fff, v11
    ds_add_u32 v121, v2
    v_cvt_pk_bf16_f32 v106, v7, v8
    v_perm_b32 v12, v106, v106, s41
    v_bitop3_b32 v116, v4, v12, v116 bitop3:0xca
    v_perm_b32 v13, v106, v106, s42
    v_bitop3_b32 v117, v4, v13, v117 bitop3:0xca
    v_cos_f32 v9, v9
    v_lshl_add_u32 v11, v118, 11, s40
    v_lshrrev_b32 v12, 3, v122
    v_lshlrev_b16 v13, 3, v122
    v_bitop3_b32 v12, v6, v13, v12 bitop3:0xca
    v_bitop3_b32 v118, v3, v12, v11 bitop3:0xca
    v_lshrrev_b32 v11, 3, v11
    v_lshrrev_b32 v13, 2, v122
    v_bitop3_b32 v11, v5, v13, v11 bitop3:0xca
    v_and_b32 v122, 0x3fff, v11
    ds_add_u32 v122, v2
    v_cos_f32 v10, v10
    v_lshl_add_u32 v11, v119, 11, s40
    v_lshrrev_b32 v12, 3, v123
    v_lshlrev_b16 v13, 3, v123
    v_bitop3_b32 v12, v6, v13, v12 bitop3:0xca
    v_bitop3_b32 v119, v3, v12, v11 bitop3:0xca
    v_lshrrev_b32 v11, 3, v11
    v_lshrrev_b32 v13, 2, v123
    v_bitop3_b32 v11, v5, v13, v11 bitop3:0xca
    v_and_b32 v123, 0x3fff, v11
    ds_add_u32 v123, v2
    v_cvt_pk_bf16_f32 v107, v9, v10
    v_perm_b32 v12, v107, v107, s41
    v_bitop3_b32 v118, v4, v12, v118 bitop3:0xca
    v_perm_b32 v13, v107, v107, s42
    v_bitop3_b32 v119, v4, v13, v119 bitop3:0xca
    s_add_u32 s44, s35, 0x2730000
    buffer_store_dwordx4 v[60:63], v0, s[20:23], s44 offen sc1
    s_waitcnt vmcnt(11)
    v_lshlrev_b32 v7, 16, v124
    v_and_b32 v8, 0xffff0000, v124
    v_lshlrev_b32 v9, 16, v125
    v_and_b32 v10, 0xffff0000, v125
    v_mul_f32 v7, 0.15915494, v7
    v_mul_f32 v8, 0.15915494, v8
    v_mul_f32 v9, 0.15915494, v9
    v_mul_f32 v10, 0.15915494, v10
    v_cos_f32 v7, v7
    v_lshl_add_u32 v11, v16, 11, s40
    v_lshrrev_b32 v12, 3, v20
    v_lshlrev_b16 v13, 3, v20
    v_bitop3_b32 v12, v6, v13, v12 bitop3:0xca
    v_bitop3_b32 v16, v3, v12, v11 bitop3:0xca
    v_lshrrev_b32 v11, 3, v11
    v_lshrrev_b32 v13, 2, v20
    v_bitop3_b32 v11, v5, v13, v11 bitop3:0xca
    v_and_b32 v20, 0x3fff, v11
    ds_add_u32 v20, v2
    v_cos_f32 v8, v8
    v_lshl_add_u32 v11, v17, 11, s40
    v_lshrrev_b32 v12, 3, v21
    v_lshlrev_b16 v13, 3, v21
    v_bitop3_b32 v12, v6, v13, v12 bitop3:0xca
    v_bitop3_b32 v17, v3, v12, v11 bitop3:0xca
    v_lshrrev_b32 v11, 3, v11
    v_lshrrev_b32 v13, 2, v21
    v_bitop3_b32 v11, v5, v13, v11 bitop3:0xca
    v_and_b32 v21, 0x3fff, v11
    ds_add_u32 v21, v2
    v_cvt_pk_bf16_f32 v124, v7, v8
    v_perm_b32 v12, v124, v124, s41
    v_bitop3_b32 v16, v4, v12, v16 bitop3:0xca
    v_perm_b32 v13, v124, v124, s42
    v_bitop3_b32 v17, v4, v13, v17 bitop3:0xca
    v_cos_f32 v9, v9
    v_lshl_add_u32 v11, v18, 11, s40
    v_lshrrev_b32 v12, 3, v22
    v_lshlrev_b16 v13, 3, v22
    v_bitop3_b32 v12, v6, v13, v12 bitop3:0xca
    v_bitop3_b32 v18, v3, v12, v11 bitop3:0xca
    v_lshrrev_b32 v11, 3, v11
    v_lshrrev_b32 v13, 2, v22
    v_bitop3_b32 v11, v5, v13, v11 bitop3:0xca
    v_and_b32 v22, 0x3fff, v11
    ds_add_u32 v22, v2
    v_cos_f32 v10, v10
    v_lshl_add_u32 v11, v19, 11, s40
    v_lshrrev_b32 v12, 3, v23
    v_lshlrev_b16 v13, 3, v23
    v_bitop3_b32 v12, v6, v13, v12 bitop3:0xca
    v_bitop3_b32 v19, v3, v12, v11 bitop3:0xca
    v_lshrrev_b32 v11, 3, v11
    v_lshrrev_b32 v13, 2, v23
    v_bitop3_b32 v11, v5, v13, v11 bitop3:0xca
    v_and_b32 v23, 0x3fff, v11
    ds_add_u32 v23, v2
    v_cvt_pk_bf16_f32 v125, v9, v10
    v_perm_b32 v12, v125, v125, s41
    v_bitop3_b32 v18, v4, v12, v18 bitop3:0xca
    v_perm_b32 v13, v125, v125, s42
    v_bitop3_b32 v19, v4, v13, v19 bitop3:0xca
    s_add_u32 s45, s35, 0x2734000
    buffer_store_dwordx4 v[44:47], v0, s[20:23], s45 offen sc1
    s_waitcnt vmcnt(8)
    v_lshlrev_b32 v7, 16, v126
    v_and_b32 v8, 0xffff0000, v126
    v_lshlrev_b32 v9, 16, v127
    v_and_b32 v10, 0xffff0000, v127
    v_mul_f32 v7, 0.15915494, v7
    v_mul_f32 v8, 0.15915494, v8
    v_mul_f32 v9, 0.15915494, v9
    v_mul_f32 v10, 0.15915494, v10
    v_cos_f32 v7, v7
    v_lshl_add_u32 v11, v28, 11, s40
    v_lshrrev_b32 v12, 3, v32
    v_lshlrev_b16 v13, 3, v32
    v_bitop3_b32 v12, v6, v13, v12 bitop3:0xca
    v_bitop3_b32 v28, v3, v12, v11 bitop3:0xca
    v_lshrrev_b32 v11, 3, v11
    v_lshrrev_b32 v13, 2, v32
    v_bitop3_b32 v11, v5, v13, v11 bitop3:0xca
    v_and_b32 v32, 0x3fff, v11
    ds_add_u32 v32, v2
    v_cos_f32 v8, v8
    v_lshl_add_u32 v11, v29, 11, s40
    v_lshrrev_b32 v12, 3, v33
    v_lshlrev_b16 v13, 3, v33
    v_bitop3_b32 v12, v6, v13, v12 bitop3:0xca
    v_bitop3_b32 v29, v3, v12, v11 bitop3:0xca
    v_lshrrev_b32 v11, 3, v11
    v_lshrrev_b32 v13, 2, v33
    v_bitop3_b32 v11, v5, v13, v11 bitop3:0xca
    v_and_b32 v33, 0x3fff, v11
    ds_add_u32 v33, v2
    v_cvt_pk_bf16_f32 v126, v7, v8
    v_perm_b32 v12, v126, v126, s41
    v_bitop3_b32 v28, v4, v12, v28 bitop3:0xca
    v_perm_b32 v13, v126, v126, s42
    v_bitop3_b32 v29, v4, v13, v29 bitop3:0xca
    v_cos_f32 v9, v9
    v_lshl_add_u32 v11, v30, 11, s40
    v_lshrrev_b32 v12, 3, v34
    v_lshlrev_b16 v13, 3, v34
    v_bitop3_b32 v12, v6, v13, v12 bitop3:0xca
    v_bitop3_b32 v30, v3, v12, v11 bitop3:0xca
    v_lshrrev_b32 v11, 3, v11
    v_lshrrev_b32 v13, 2, v34
    v_bitop3_b32 v11, v5, v13, v11 bitop3:0xca
    v_and_b32 v34, 0x3fff, v11
    ds_add_u32 v34, v2
    v_cos_f32 v10, v10
    v_lshl_add_u32 v11, v31, 11, s40
    v_lshrrev_b32 v12, 3, v35
    v_lshlrev_b16 v13, 3, v35
    v_bitop3_b32 v12, v6, v13, v12 bitop3:0xca
    v_bitop3_b32 v31, v3, v12, v11 bitop3:0xca
    v_lshrrev_b32 v11, 3, v11
    v_lshrrev_b32 v13, 2, v35
    v_bitop3_b32 v11, v5, v13, v11 bitop3:0xca
    v_and_b32 v35, 0x3fff, v11
    ds_add_u32 v35, v2
    v_cvt_pk_bf16_f32 v127, v9, v10
    v_perm_b32 v12, v127, v127, s41
    v_bitop3_b32 v30, v4, v12, v30 bitop3:0xca
    v_perm_b32 v13, v127, v127, s42
    v_bitop3_b32 v31, v4, v13, v31 bitop3:0xca
    v_lshrrev_b32 v8, 2, v0
    v_and_b32 v7, 0x3c00, v0
    v_bitop3_b32 v7, v5, v8, v7 bitop3:0xea
    s_waitcnt lgkmcnt(0)
    s_barrier
    ds_read2st64_b32 v[8:9], v7 offset0:0 offset1:1
    ds_read2st64_b32 v[10:11], v7 offset0:2 offset1:3
    s_add_u32 s46, s33, 0x5dc0000
    buffer_load_dwordx4 v[36:39], v0, s[8:11], s46 offen nt
    s_waitcnt lgkmcnt(0)
    v_lshl_or_b32 v12, v9, 16, v8
    v_lshl_or_b32 v13, v11, 16, v10
    v_mov_b32 v14, v12
    v_mov_b32 v15, v13
    s_nop 0
    v_add_u32_dpp v14, v14, v14 row_shr:1 row_mask:0xf bank_mask:0xf bound_ctrl:1
    v_add_u32_dpp v15, v15, v15 row_shr:1 row_mask:0xf bank_mask:0xf bound_ctrl:1
    s_nop 0
    v_add_u32_dpp v14, v14, v14 row_shr:2 row_mask:0xf bank_mask:0xf bound_ctrl:1
    v_add_u32_dpp v15, v15, v15 row_shr:2 row_mask:0xf bank_mask:0xf bound_ctrl:1
    s_nop 0
    v_add_u32_dpp v14, v14, v14 row_shr:4 row_mask:0xf bank_mask:0xf bound_ctrl:1
    v_add_u32_dpp v15, v15, v15 row_shr:4 row_mask:0xf bank_mask:0xf bound_ctrl:1
    s_nop 0
    v_add_u32_dpp v14, v14, v14 row_shr:8 row_mask:0xf bank_mask:0xf bound_ctrl:1
    v_add_u32_dpp v15, v15, v15 row_shr:8 row_mask:0xf bank_mask:0xf bound_ctrl:1
    s_nop 0
    v_add_u32_dpp v14, v14, v14 row_bcast:15 row_mask:0xa bank_mask:0xf
    v_add_u32_dpp v15, v15, v15 row_bcast:15 row_mask:0xa bank_mask:0xf
    s_nop 0
    v_add_u32_dpp v14, v14, v14 row_bcast:31 row_mask:0xc bank_mask:0xf
    v_add_u32_dpp v15, v15, v15 row_bcast:31 row_mask:0xc bank_mask:0xf
    v_readlane_b32 s48, v14, 63
    v_readlane_b32 s49, v15, 63
    s_lshl_b32 s54, s32, 2
    v_mov_b32 v8, s54
    s_and_b32 s50, s48, 0xffff
    s_lshr_b32 s51, s48, 16
    s_and_b32 s52, s49, 0xffff
    s_lshr_b32 s53, s49, 16
    s_add_u32 s51, s51, s50
    s_add_u32 s52, s52, s51
    s_add_u32 s53, s53, s52
    v_mov_b32 v9, s53
    s_mov_b64 exec, 1
    ds_write_b32 v8, v9 offset:16384
    s_mov_b64 exec, -1
    v_and_b32 v8, 60, v7
    s_waitcnt lgkmcnt(0)
    s_barrier
    ds_read_b32 v9, v8 offset:16384
    s_waitcnt lgkmcnt(0)
    v_add_u32_dpp v9, v9, v9 row_shr:1 row_mask:0xf bank_mask:0xf bound_ctrl:1
    s_nop 1
    v_add_u32_dpp v9, v9, v9 row_shr:2 row_mask:0xf bank_mask:0xf bound_ctrl:1
    s_nop 1
    v_add_u32_dpp v9, v9, v9 row_shr:4 row_mask:0xf bank_mask:0xf bound_ctrl:1
    s_nop 1
    v_add_u32_dpp v9, v9, v9 row_shr:8 row_mask:0xf bank_mask:0xf bound_ctrl:1
    s_nop 0
    v_readlane_b32 s54, v9, s32
    s_sub_u32 s54, s54, s53
    s_add_u32 s50, s50, s54
    s_add_u32 s51, s51, s54
    s_add_u32 s52, s52, s54
    s_pack_ll_b32_b16 s48, s54, s50
    s_pack_ll_b32_b16 s49, s51, s52
    v_add_u32 v14, s48, v14
    v_add_u32 v15, s49, v15
    v_sub_u32 v12, v14, v12
    v_sub_u32 v13, v15, v13
    v_and_b32 v8, 0xffff, v12
    v_lshrrev_b32 v9, 16, v12
    v_and_b32 v10, 0xffff, v13
    v_lshrrev_b32 v11, 16, v13
    ds_write2st64_b32 v7, v8, v9 offset0:0 offset1:1
    ds_write2st64_b32 v7, v10, v11 offset0:2 offset1:3
    s_waitcnt lgkmcnt(0)
    s_barrier
    ds_add_rtn_u32 v72, v72, v2
    ds_add_rtn_u32 v73, v73, v2
    ds_add_rtn_u32 v74, v74, v2
    ds_add_rtn_u32 v75, v75, v2
    s_add_u32 s47, s36, 0x3f7a00
    buffer_store_dwordx2 v[12:13], v1, s[24:27], s47 offen
    s_bitset0_b64 exec, 63
    s_not_b64 exec, exec
    buffer_store_dwordx2 v[14:15], v1, s[24:27], s47 offen offset:8
    s_mov_b64 exec, -1
    ds_add_rtn_u32 v80, v80, v2
    ds_add_rtn_u32 v81, v81, v2
    ds_add_rtn_u32 v82, v82, v2
    ds_add_rtn_u32 v83, v83, v2
    s_add_u32 s44, s33, 0x5dc0000
    buffer_load_dwordx4 v[40:43], v0, s[12:15], s44 offen nt
    ds_add_rtn_u32 v92, v92, v2
    ds_add_rtn_u32 v93, v93, v2
    ds_add_rtn_u32 v94, v94, v2
    ds_add_rtn_u32 v95, v95, v2
    s_add_u32 s45, s34, 0x2ee0000
    buffer_load_dwordx2 v[24:25], v1, s[16:19], s45 offen nt
    s_add_u32 s46, s34, 0x2ee2000
    buffer_load_dwordx2 v[26:27], v1, s[16:19], s46 offen nt
    ds_add_rtn_u32 v100, v100, v2
    ds_add_rtn_u32 v101, v101, v2
    ds_add_rtn_u32 v102, v102, v2
    ds_add_rtn_u32 v103, v103, v2
    s_add_u32 s47, s33, 0x5dc4000
    buffer_load_dwordx4 v[48:51], v0, s[8:11], s47 offen nt
    ds_add_rtn_u32 v112, v112, v2
    ds_add_rtn_u32 v113, v113, v2
    ds_add_rtn_u32 v114, v114, v2
    ds_add_rtn_u32 v115, v115, v2
    s_add_u32 s44, s33, 0x5dc4000
    buffer_load_dwordx4 v[52:55], v0, s[12:15], s44 offen nt
    ds_add_rtn_u32 v120, v120, v2
    ds_add_rtn_u32 v121, v121, v2
    ds_add_rtn_u32 v122, v122, v2
    ds_add_rtn_u32 v123, v123, v2
    s_add_u32 s45, s33, 0x5dc8000
    buffer_load_dwordx4 v[56:59], v0, s[8:11], s45 offen nt
    ds_add_rtn_u32 v20, v20, v2
    ds_add_rtn_u32 v21, v21, v2
    ds_add_rtn_u32 v22, v22, v2
    ds_add_rtn_u32 v23, v23, v2
    s_add_u32 s46, s33, 0x5dc8000
    buffer_load_dwordx4 v[60:63], v0, s[12:15], s46 offen nt
    ds_add_rtn_u32 v32, v32, v2
    ds_add_rtn_u32 v33, v33, v2
    ds_add_rtn_u32 v34, v34, v2
    ds_add_rtn_u32 v35, v35, v2
    s_add_u32 s47, s34, 0x2ee4000
    buffer_load_dwordx2 v[44:45], v1, s[16:19], s47 offen nt
    s_add_u32 s44, s34, 0x2ee6000
    buffer_load_dwordx2 v[46:47], v1, s[16:19], s44 offen nt
    s_waitcnt lgkmcnt(0)
    s_barrier
    v_and_b32 v7, -4, v72
    v_lshl_add_u32 v8, v72, 2, v7
    ds_write_b32 v8, v68
    v_lshl_add_u32 v7, v7, 2, v72
    ds_write_b8 v7, v64 offset:16
    v_and_b32 v9, -4, v73
    v_lshl_add_u32 v10, v73, 2, v9
    ds_write_b32 v10, v69
    v_lshl_add_u32 v9, v9, 2, v73
    ds_write_b8_d16_hi v9, v64 offset:16
    v_and_b32 v7, -4, v74
    v_lshl_add_u32 v8, v74, 2, v7
    ds_write_b32 v8, v70
    v_lshl_add_u32 v7, v7, 2, v74
    ds_write_b8 v7, v65 offset:16
    v_and_b32 v9, -4, v75
    v_lshl_add_u32 v10, v75, 2, v9
    ds_write_b32 v10, v71
    v_lshl_add_u32 v9, v9, 2, v75
    ds_write_b8_d16_hi v9, v65 offset:16
    s_add_u32 s45, s33, 0x5dcc000
    buffer_load_dwordx4 v[68:71], v0, s[8:11], s45 offen nt
    s_add_u32 s46, s33, 0x5dcc000
    buffer_load_dwordx4 v[72:75], v0, s[12:15], s46 offen nt
    v_and_b32 v7, -4, v80
    v_lshl_add_u32 v8, v80, 2, v7
    ds_write_b32 v8, v76
    v_lshl_add_u32 v7, v7, 2, v80
    ds_write_b8 v7, v66 offset:16
    v_and_b32 v9, -4, v81
    v_lshl_add_u32 v10, v81, 2, v9
    ds_write_b32 v10, v77
    v_lshl_add_u32 v9, v9, 2, v81
    ds_write_b8_d16_hi v9, v66 offset:16
    v_and_b32 v7, -4, v82
    v_lshl_add_u32 v8, v82, 2, v7
    ds_write_b32 v8, v78
    v_lshl_add_u32 v7, v7, 2, v82
    ds_write_b8 v7, v67 offset:16
    v_and_b32 v9, -4, v83
    v_lshl_add_u32 v10, v83, 2, v9
    ds_write_b32 v10, v79
    v_lshl_add_u32 v9, v9, 2, v83
    ds_write_b8_d16_hi v9, v67 offset:16
    s_add_u32 s47, s33, 0x5dd0000
    buffer_load_dwordx4 v[76:79], v0, s[8:11], s47 offen nt
    v_and_b32 v7, -4, v92
    v_lshl_add_u32 v8, v92, 2, v7
    ds_write_b32 v8, v88
    v_lshl_add_u32 v7, v7, 2, v92
    ds_write_b8 v7, v84 offset:16
    v_and_b32 v9, -4, v93
    v_lshl_add_u32 v10, v93, 2, v9
    ds_write_b32 v10, v89
    v_lshl_add_u32 v9, v9, 2, v93
    ds_write_b8_d16_hi v9, v84 offset:16
    v_and_b32 v7, -4, v94
    v_lshl_add_u32 v8, v94, 2, v7
    ds_write_b32 v8, v90
    v_lshl_add_u32 v7, v7, 2, v94
    ds_write_b8 v7, v85 offset:16
    v_and_b32 v9, -4, v95
    v_lshl_add_u32 v10, v95, 2, v9
    ds_write_b32 v10, v91
    v_lshl_add_u32 v9, v9, 2, v95
    ds_write_b8_d16_hi v9, v85 offset:16
    s_add_u32 s44, s33, 0x5dd0000
    buffer_load_dwordx4 v[80:83], v0, s[12:15], s44 offen nt
    v_and_b32 v7, -4, v100
    v_lshl_add_u32 v8, v100, 2, v7
    ds_write_b32 v8, v96
    v_lshl_add_u32 v7, v7, 2, v100
    ds_write_b8 v7, v86 offset:16
    v_and_b32 v9, -4, v101
    v_lshl_add_u32 v10, v101, 2, v9
    ds_write_b32 v10, v97
    v_lshl_add_u32 v9, v9, 2, v101
    ds_write_b8_d16_hi v9, v86 offset:16
    v_and_b32 v7, -4, v102
    v_lshl_add_u32 v8, v102, 2, v7
    ds_write_b32 v8, v98
    v_lshl_add_u32 v7, v7, 2, v102
    ds_write_b8 v7, v87 offset:16
    v_and_b32 v9, -4, v103
    v_lshl_add_u32 v10, v103, 2, v9
    ds_write_b32 v10, v99
    v_lshl_add_u32 v9, v9, 2, v103
    ds_write_b8_d16_hi v9, v87 offset:16
    s_add_u32 s45, s34, 0x2ee8000
    buffer_load_dwordx2 v[64:65], v1, s[16:19], s45 offen nt
    s_add_u32 s46, s34, 0x2eea000
    buffer_load_dwordx2 v[66:67], v1, s[16:19], s46 offen nt
    v_and_b32 v7, -4, v112
    v_lshl_add_u32 v8, v112, 2, v7
    ds_write_b32 v8, v108
    v_lshl_add_u32 v7, v7, 2, v112
    ds_write_b8 v7, v104 offset:16
    v_and_b32 v9, -4, v113
    v_lshl_add_u32 v10, v113, 2, v9
    ds_write_b32 v10, v109
    v_lshl_add_u32 v9, v9, 2, v113
    ds_write_b8_d16_hi v9, v104 offset:16
    v_and_b32 v7, -4, v114
    v_lshl_add_u32 v8, v114, 2, v7
    ds_write_b32 v8, v110
    v_lshl_add_u32 v7, v7, 2, v114
    ds_write_b8 v7, v105 offset:16
    v_and_b32 v9, -4, v115
    v_lshl_add_u32 v10, v115, 2, v9
    ds_write_b32 v10, v111
    v_lshl_add_u32 v9, v9, 2, v115
    ds_write_b8_d16_hi v9, v105 offset:16
    s_add_u32 s47, s33, 0x5dd4000
    buffer_load_dwordx4 v[88:91], v0, s[8:11], s47 offen nt
    s_add_u32 s44, s33, 0x5dd4000
    buffer_load_dwordx4 v[92:95], v0, s[12:15], s44 offen nt
    v_and_b32 v7, -4, v120
    v_lshl_add_u32 v8, v120, 2, v7
    ds_write_b32 v8, v116
    v_lshl_add_u32 v7, v7, 2, v120
    ds_write_b8 v7, v106 offset:16
    v_and_b32 v9, -4, v121
    v_lshl_add_u32 v10, v121, 2, v9
    ds_write_b32 v10, v117
    v_lshl_add_u32 v9, v9, 2, v121
    ds_write_b8_d16_hi v9, v106 offset:16
    v_and_b32 v7, -4, v122
    v_lshl_add_u32 v8, v122, 2, v7
    ds_write_b32 v8, v118
    v_lshl_add_u32 v7, v7, 2, v122
    ds_write_b8 v7, v107 offset:16
    v_and_b32 v9, -4, v123
    v_lshl_add_u32 v10, v123, 2, v9
    ds_write_b32 v10, v119
    v_lshl_add_u32 v9, v9, 2, v123
    ds_write_b8_d16_hi v9, v107 offset:16
    s_add_u32 s45, s33, 0x5dd8000
    buffer_load_dwordx4 v[96:99], v0, s[8:11], s45 offen nt
    v_and_b32 v7, -4, v20
    v_lshl_add_u32 v8, v20, 2, v7
    ds_write_b32 v8, v16
    v_lshl_add_u32 v7, v7, 2, v20
    ds_write_b8 v7, v124 offset:16
    v_and_b32 v9, -4, v21
    v_lshl_add_u32 v10, v21, 2, v9
    ds_write_b32 v10, v17
    v_lshl_add_u32 v9, v9, 2, v21
    ds_write_b8_d16_hi v9, v124 offset:16
    v_and_b32 v7, -4, v22
    v_lshl_add_u32 v8, v22, 2, v7
    ds_write_b32 v8, v18
    v_lshl_add_u32 v7, v7, 2, v22
    ds_write_b8 v7, v125 offset:16
    v_and_b32 v9, -4, v23
    v_lshl_add_u32 v10, v23, 2, v9
    ds_write_b32 v10, v19
    v_lshl_add_u32 v9, v9, 2, v23
    ds_write_b8_d16_hi v9, v125 offset:16
    s_add_u32 s46, s33, 0x5dd8000
    buffer_load_dwordx4 v[100:103], v0, s[12:15], s46 offen nt
    v_and_b32 v7, -4, v32
    v_lshl_add_u32 v8, v32, 2, v7
    ds_write_b32 v8, v28
    v_lshl_add_u32 v7, v7, 2, v32
    ds_write_b8 v7, v126 offset:16
    v_and_b32 v9, -4, v33
    v_lshl_add_u32 v10, v33, 2, v9
    ds_write_b32 v10, v29
    v_lshl_add_u32 v9, v9, 2, v33
    ds_write_b8_d16_hi v9, v126 offset:16
    v_and_b32 v7, -4, v34
    v_lshl_add_u32 v8, v34, 2, v7
    ds_write_b32 v8, v30
    v_lshl_add_u32 v7, v7, 2, v34
    ds_write_b8 v7, v127 offset:16
    v_and_b32 v9, -4, v35
    v_lshl_add_u32 v10, v35, 2, v9
    ds_write_b32 v10, v31
    v_lshl_add_u32 v9, v9, 2, v35
    ds_write_b8_d16_hi v9, v127 offset:16
    s_add_u32 s47, s34, 0x2eec000
    buffer_load_dwordx2 v[84:85], v1, s[16:19], s47 offen nt
    s_add_u32 s44, s34, 0x2eee000
    buffer_load_dwordx2 v[86:87], v1, s[16:19], s44 offen nt
    v_add_u32 v7, 0x10000, v0
    v_add_u32 v12, 0x20000, v0
    v_mov_b32 v8, 0
    v_mov_b32 v9, 0
    v_mov_b32 v10, 0
    v_mov_b32 v11, 0
    s_waitcnt lgkmcnt(0)
    s_barrier
    ds_read_b128 v[108:111], v0 offset:0
    ds_write_b128 v0, v[8:11]
    ds_read_b128 v[112:115], v0 offset:16384
    ds_read_b128 v[116:119], v0 offset:32768
    ds_read_b128 v[120:123], v0 offset:49152
    ds_read_b128 v[104:107], v7 offset:0
    ds_read_b128 v[16:19], v7 offset:16384
    ds_read_b128 v[20:23], v7 offset:32768
    ds_read_b128 v[28:31], v7 offset:49152
    ds_read_b128 v[32:35], v12 offset:0
    ds_read_b128 v[124:127], v12 offset:16384
    s_waitcnt lgkmcnt(0)
    s_barrier
    s_add_u32 s45, s35, 0x4e20000
    buffer_store_dwordx4 v[108:111], v0, s[20:23], s45 offen sc1
    s_add_u32 s46, s35, 0x4e24000
    buffer_store_dwordx4 v[112:115], v0, s[20:23], s46 offen sc1
    s_add_u32 s47, s33, 0x5ddc000
    buffer_load_dwordx4 v[108:111], v0, s[8:11], s47 offen nt
    s_add_u32 s44, s33, 0x5ddc000
    buffer_load_dwordx4 v[112:115], v0, s[12:15], s44 offen nt
    s_add_u32 s45, s35, 0x4e28000
    buffer_store_dwordx4 v[116:119], v0, s[20:23], s45 offen sc1
    s_waitcnt vmcnt(23)
    v_lshlrev_b32 v7, 16, v24
    v_and_b32 v8, 0xffff0000, v24
    v_lshlrev_b32 v9, 16, v25
    v_and_b32 v10, 0xffff0000, v25
    v_mul_f32 v7, 0.15915494, v7
    v_mul_f32 v8, 0.15915494, v8
    v_mul_f32 v9, 0.15915494, v9
    v_mul_f32 v10, 0.15915494, v10
    v_cos_f32 v7, v7
    v_lshl_add_u32 v11, v36, 11, s40
    v_lshrrev_b32 v12, 3, v40
    v_lshlrev_b16 v13, 3, v40
    v_bitop3_b32 v12, v6, v13, v12 bitop3:0xca
    v_bitop3_b32 v36, v3, v12, v11 bitop3:0xca
    v_lshrrev_b32 v11, 3, v11
    v_lshrrev_b32 v13, 2, v40
    v_bitop3_b32 v11, v5, v13, v11 bitop3:0xca
    v_and_b32 v40, 0x3fff, v11
    ds_add_u32 v40, v2
    v_cos_f32 v8, v8
    v_lshl_add_u32 v11, v37, 11, s40
    v_lshrrev_b32 v12, 3, v41
    v_lshlrev_b16 v13, 3, v41
    v_bitop3_b32 v12, v6, v13, v12 bitop3:0xca
    v_bitop3_b32 v37, v3, v12, v11 bitop3:0xca
    v_lshrrev_b32 v11, 3, v11
    v_lshrrev_b32 v13, 2, v41
    v_bitop3_b32 v11, v5, v13, v11 bitop3:0xca
    v_and_b32 v41, 0x3fff, v11
    ds_add_u32 v41, v2
    v_cvt_pk_bf16_f32 v24, v7, v8
    v_perm_b32 v12, v24, v24, s41
    v_bitop3_b32 v36, v4, v12, v36 bitop3:0xca
    v_perm_b32 v13, v24, v24, s42
    v_bitop3_b32 v37, v4, v13, v37 bitop3:0xca
    v_cos_f32 v9, v9
    v_lshl_add_u32 v11, v38, 11, s40
    v_lshrrev_b32 v12, 3, v42
    v_lshlrev_b16 v13, 3, v42
    v_bitop3_b32 v12, v6, v13, v12 bitop3:0xca
    v_bitop3_b32 v38, v3, v12, v11 bitop3:0xca
    v_lshrrev_b32 v11, 3, v11
    v_lshrrev_b32 v13, 2, v42
    v_bitop3_b32 v11, v5, v13, v11 bitop3:0xca
    v_and_b32 v42, 0x3fff, v11
    ds_add_u32 v42, v2
    v_cos_f32 v10, v10
    v_lshl_add_u32 v11, v39, 11, s40
    v_lshrrev_b32 v12, 3, v43
    v_lshlrev_b16 v13, 3, v43
    v_bitop3_b32 v12, v6, v13, v12 bitop3:0xca
    v_bitop3_b32 v39, v3, v12, v11 bitop3:0xca
    v_lshrrev_b32 v11, 3, v11
    v_lshrrev_b32 v13, 2, v43
    v_bitop3_b32 v11, v5, v13, v11 bitop3:0xca
    v_and_b32 v43, 0x3fff, v11
    ds_add_u32 v43, v2
    v_cvt_pk_bf16_f32 v25, v9, v10
    v_perm_b32 v12, v25, v25, s41
    v_bitop3_b32 v38, v4, v12, v38 bitop3:0xca
    v_perm_b32 v13, v25, v25, s42
    v_bitop3_b32 v39, v4, v13, v39 bitop3:0xca
    s_add_u32 s46, s35, 0x4e2c000
    buffer_store_dwordx4 v[120:123], v0, s[20:23], s46 offen sc1
    s_waitcnt vmcnt(22)
    v_lshlrev_b32 v7, 16, v26
    v_and_b32 v8, 0xffff0000, v26
    v_lshlrev_b32 v9, 16, v27
    v_and_b32 v10, 0xffff0000, v27
    v_mul_f32 v7, 0.15915494, v7
    v_mul_f32 v8, 0.15915494, v8
    v_mul_f32 v9, 0.15915494, v9
    v_mul_f32 v10, 0.15915494, v10
    v_cos_f32 v7, v7
    v_lshl_add_u32 v11, v48, 11, s40
    v_lshrrev_b32 v12, 3, v52
    v_lshlrev_b16 v13, 3, v52
    v_bitop3_b32 v12, v6, v13, v12 bitop3:0xca
    v_bitop3_b32 v48, v3, v12, v11 bitop3:0xca
    v_lshrrev_b32 v11, 3, v11
    v_lshrrev_b32 v13, 2, v52
    v_bitop3_b32 v11, v5, v13, v11 bitop3:0xca
    v_and_b32 v52, 0x3fff, v11
    ds_add_u32 v52, v2
    v_cos_f32 v8, v8
    v_lshl_add_u32 v11, v49, 11, s40
    v_lshrrev_b32 v12, 3, v53
    v_lshlrev_b16 v13, 3, v53
    v_bitop3_b32 v12, v6, v13, v12 bitop3:0xca
    v_bitop3_b32 v49, v3, v12, v11 bitop3:0xca
    v_lshrrev_b32 v11, 3, v11
    v_lshrrev_b32 v13, 2, v53
    v_bitop3_b32 v11, v5, v13, v11 bitop3:0xca
    v_and_b32 v53, 0x3fff, v11
    ds_add_u32 v53, v2
    v_cvt_pk_bf16_f32 v26, v7, v8
    v_perm_b32 v12, v26, v26, s41
    v_bitop3_b32 v48, v4, v12, v48 bitop3:0xca
    v_perm_b32 v13, v26, v26, s42
    v_bitop3_b32 v49, v4, v13, v49 bitop3:0xca
    v_cos_f32 v9, v9
    v_lshl_add_u32 v11, v50, 11, s40
    v_lshrrev_b32 v12, 3, v54
    v_lshlrev_b16 v13, 3, v54
    v_bitop3_b32 v12, v6, v13, v12 bitop3:0xca
    v_bitop3_b32 v50, v3, v12, v11 bitop3:0xca
    v_lshrrev_b32 v11, 3, v11
    v_lshrrev_b32 v13, 2, v54
    v_bitop3_b32 v11, v5, v13, v11 bitop3:0xca
    v_and_b32 v54, 0x3fff, v11
    ds_add_u32 v54, v2
    v_cos_f32 v10, v10
    v_lshl_add_u32 v11, v51, 11, s40
    v_lshrrev_b32 v12, 3, v55
    v_lshlrev_b16 v13, 3, v55
    v_bitop3_b32 v12, v6, v13, v12 bitop3:0xca
    v_bitop3_b32 v51, v3, v12, v11 bitop3:0xca
    v_lshrrev_b32 v11, 3, v11
    v_lshrrev_b32 v13, 2, v55
    v_bitop3_b32 v11, v5, v13, v11 bitop3:0xca
    v_and_b32 v55, 0x3fff, v11
    ds_add_u32 v55, v2
    v_cvt_pk_bf16_f32 v27, v9, v10
    v_perm_b32 v12, v27, v27, s41
    v_bitop3_b32 v50, v4, v12, v50 bitop3:0xca
    v_perm_b32 v13, v27, v27, s42
    v_bitop3_b32 v51, v4, v13, v51 bitop3:0xca
    s_add_u32 s47, s35, 0x4e30000
    buffer_store_dwordx4 v[104:107], v0, s[20:23], s47 offen sc1
    s_waitcnt vmcnt(19)
    v_lshlrev_b32 v7, 16, v44
    v_and_b32 v8, 0xffff0000, v44
    v_lshlrev_b32 v9, 16, v45
    v_and_b32 v10, 0xffff0000, v45
    v_mul_f32 v7, 0.15915494, v7
    v_mul_f32 v8, 0.15915494, v8
    v_mul_f32 v9, 0.15915494, v9
    v_mul_f32 v10, 0.15915494, v10
    v_cos_f32 v7, v7
    v_lshl_add_u32 v11, v56, 11, s40
    v_lshrrev_b32 v12, 3, v60
    v_lshlrev_b16 v13, 3, v60
    v_bitop3_b32 v12, v6, v13, v12 bitop3:0xca
    v_bitop3_b32 v56, v3, v12, v11 bitop3:0xca
    v_lshrrev_b32 v11, 3, v11
    v_lshrrev_b32 v13, 2, v60
    v_bitop3_b32 v11, v5, v13, v11 bitop3:0xca
    v_and_b32 v60, 0x3fff, v11
    ds_add_u32 v60, v2
    v_cos_f32 v8, v8
    v_lshl_add_u32 v11, v57, 11, s40
    v_lshrrev_b32 v12, 3, v61
    v_lshlrev_b16 v13, 3, v61
    v_bitop3_b32 v12, v6, v13, v12 bitop3:0xca
    v_bitop3_b32 v57, v3, v12, v11 bitop3:0xca
    v_lshrrev_b32 v11, 3, v11
    v_lshrrev_b32 v13, 2, v61
    v_bitop3_b32 v11, v5, v13, v11 bitop3:0xca
    v_and_b32 v61, 0x3fff, v11
    ds_add_u32 v61, v2
    v_cvt_pk_bf16_f32 v44, v7, v8
    v_perm_b32 v12, v44, v44, s41
    v_bitop3_b32 v56, v4, v12, v56 bitop3:0xca
    v_perm_b32 v13, v44, v44, s42
    v_bitop3_b32 v57, v4, v13, v57 bitop3:0xca
    v_cos_f32 v9, v9
    v_lshl_add_u32 v11, v58, 11, s40
    v_lshrrev_b32 v12, 3, v62
    v_lshlrev_b16 v13, 3, v62
    v_bitop3_b32 v12, v6, v13, v12 bitop3:0xca
    v_bitop3_b32 v58, v3, v12, v11 bitop3:0xca
    v_lshrrev_b32 v11, 3, v11
    v_lshrrev_b32 v13, 2, v62
    v_bitop3_b32 v11, v5, v13, v11 bitop3:0xca
    v_and_b32 v62, 0x3fff, v11
    ds_add_u32 v62, v2
    v_cos_f32 v10, v10
    v_lshl_add_u32 v11, v59, 11, s40
    v_lshrrev_b32 v12, 3, v63
    v_lshlrev_b16 v13, 3, v63
    v_bitop3_b32 v12, v6, v13, v12 bitop3:0xca
    v_bitop3_b32 v59, v3, v12, v11 bitop3:0xca
    v_lshrrev_b32 v11, 3, v11
    v_lshrrev_b32 v13, 2, v63
    v_bitop3_b32 v11, v5, v13, v11 bitop3:0xca
    v_and_b32 v63, 0x3fff, v11
    ds_add_u32 v63, v2
    v_cvt_pk_bf16_f32 v45, v9, v10
    v_perm_b32 v12, v45, v45, s41
    v_bitop3_b32 v58, v4, v12, v58 bitop3:0xca
    v_perm_b32 v13, v45, v45, s42
    v_bitop3_b32 v59, v4, v13, v59 bitop3:0xca
    s_add_u32 s44, s35, 0x4e34000
    buffer_store_dwordx4 v[16:19], v0, s[20:23], s44 offen sc1
    s_waitcnt vmcnt(18)
    v_lshlrev_b32 v7, 16, v46
    v_and_b32 v8, 0xffff0000, v46
    v_lshlrev_b32 v9, 16, v47
    v_and_b32 v10, 0xffff0000, v47
    v_mul_f32 v7, 0.15915494, v7
    v_mul_f32 v8, 0.15915494, v8
    v_mul_f32 v9, 0.15915494, v9
    v_mul_f32 v10, 0.15915494, v10
    v_cos_f32 v7, v7
    v_lshl_add_u32 v11, v68, 11, s40
    v_lshrrev_b32 v12, 3, v72
    v_lshlrev_b16 v13, 3, v72
    v_bitop3_b32 v12, v6, v13, v12 bitop3:0xca
    v_bitop3_b32 v68, v3, v12, v11 bitop3:0xca
    v_lshrrev_b32 v11, 3, v11
    v_lshrrev_b32 v13, 2, v72
    v_bitop3_b32 v11, v5, v13, v11 bitop3:0xca
    v_and_b32 v72, 0x3fff, v11
    ds_add_u32 v72, v2
    v_cos_f32 v8, v8
    v_lshl_add_u32 v11, v69, 11, s40
    v_lshrrev_b32 v12, 3, v73
    v_lshlrev_b16 v13, 3, v73
    v_bitop3_b32 v12, v6, v13, v12 bitop3:0xca
    v_bitop3_b32 v69, v3, v12, v11 bitop3:0xca
    v_lshrrev_b32 v11, 3, v11
    v_lshrrev_b32 v13, 2, v73
    v_bitop3_b32 v11, v5, v13, v11 bitop3:0xca
    v_and_b32 v73, 0x3fff, v11
    ds_add_u32 v73, v2
    v_cvt_pk_bf16_f32 v46, v7, v8
    v_perm_b32 v12, v46, v46, s41
    v_bitop3_b32 v68, v4, v12, v68 bitop3:0xca
    v_perm_b32 v13, v46, v46, s42
    v_bitop3_b32 v69, v4, v13, v69 bitop3:0xca
    v_cos_f32 v9, v9
    v_lshl_add_u32 v11, v70, 11, s40
    v_lshrrev_b32 v12, 3, v74
    v_lshlrev_b16 v13, 3, v74
    v_bitop3_b32 v12, v6, v13, v12 bitop3:0xca
    v_bitop3_b32 v70, v3, v12, v11 bitop3:0xca
    v_lshrrev_b32 v11, 3, v11
    v_lshrrev_b32 v13, 2, v74
    v_bitop3_b32 v11, v5, v13, v11 bitop3:0xca
    v_and_b32 v74, 0x3fff, v11
    ds_add_u32 v74, v2
    v_cos_f32 v10, v10
    v_lshl_add_u32 v11, v71, 11, s40
    v_lshrrev_b32 v12, 3, v75
    v_lshlrev_b16 v13, 3, v75
    v_bitop3_b32 v12, v6, v13, v12 bitop3:0xca
    v_bitop3_b32 v71, v3, v12, v11 bitop3:0xca
    v_lshrrev_b32 v11, 3, v11
    v_lshrrev_b32 v13, 2, v75
    v_bitop3_b32 v11, v5, v13, v11 bitop3:0xca
    v_and_b32 v75, 0x3fff, v11
    ds_add_u32 v75, v2
    v_cvt_pk_bf16_f32 v47, v9, v10
    v_perm_b32 v12, v47, v47, s41
    v_bitop3_b32 v70, v4, v12, v70 bitop3:0xca
    v_perm_b32 v13, v47, v47, s42
    v_bitop3_b32 v71, v4, v13, v71 bitop3:0xca
    s_add_u32 s45, s35, 0x4e38000
    buffer_store_dwordx4 v[20:23], v0, s[20:23], s45 offen sc1
    s_waitcnt vmcnt(15)
    v_lshlrev_b32 v7, 16, v64
    v_and_b32 v8, 0xffff0000, v64
    v_lshlrev_b32 v9, 16, v65
    v_and_b32 v10, 0xffff0000, v65
    v_mul_f32 v7, 0.15915494, v7
    v_mul_f32 v8, 0.15915494, v8
    v_mul_f32 v9, 0.15915494, v9
    v_mul_f32 v10, 0.15915494, v10
    v_cos_f32 v7, v7
    v_lshl_add_u32 v11, v76, 11, s40
    v_lshrrev_b32 v12, 3, v80
    v_lshlrev_b16 v13, 3, v80
    v_bitop3_b32 v12, v6, v13, v12 bitop3:0xca
    v_bitop3_b32 v76, v3, v12, v11 bitop3:0xca
    v_lshrrev_b32 v11, 3, v11
    v_lshrrev_b32 v13, 2, v80
    v_bitop3_b32 v11, v5, v13, v11 bitop3:0xca
    v_and_b32 v80, 0x3fff, v11
    ds_add_u32 v80, v2
    v_cos_f32 v8, v8
    v_lshl_add_u32 v11, v77, 11, s40
    v_lshrrev_b32 v12, 3, v81
    v_lshlrev_b16 v13, 3, v81
    v_bitop3_b32 v12, v6, v13, v12 bitop3:0xca
    v_bitop3_b32 v77, v3, v12, v11 bitop3:0xca
    v_lshrrev_b32 v11, 3, v11
    v_lshrrev_b32 v13, 2, v81
    v_bitop3_b32 v11, v5, v13, v11 bitop3:0xca
    v_and_b32 v81, 0x3fff, v11
    ds_add_u32 v81, v2
    v_cvt_pk_bf16_f32 v64, v7, v8
    v_perm_b32 v12, v64, v64, s41
    v_bitop3_b32 v76, v4, v12, v76 bitop3:0xca
    v_perm_b32 v13, v64, v64, s42
    v_bitop3_b32 v77, v4, v13, v77 bitop3:0xca
    v_cos_f32 v9, v9
    v_lshl_add_u32 v11, v78, 11, s40
    v_lshrrev_b32 v12, 3, v82
    v_lshlrev_b16 v13, 3, v82
    v_bitop3_b32 v12, v6, v13, v12 bitop3:0xca
    v_bitop3_b32 v78, v3, v12, v11 bitop3:0xca
    v_lshrrev_b32 v11, 3, v11
    v_lshrrev_b32 v13, 2, v82
    v_bitop3_b32 v11, v5, v13, v11 bitop3:0xca
    v_and_b32 v82, 0x3fff, v11
    ds_add_u32 v82, v2
    v_cos_f32 v10, v10
    v_lshl_add_u32 v11, v79, 11, s40
    v_lshrrev_b32 v12, 3, v83
    v_lshlrev_b16 v13, 3, v83
    v_bitop3_b32 v12, v6, v13, v12 bitop3:0xca
    v_bitop3_b32 v79, v3, v12, v11 bitop3:0xca
    v_lshrrev_b32 v11, 3, v11
    v_lshrrev_b32 v13, 2, v83
    v_bitop3_b32 v11, v5, v13, v11 bitop3:0xca
    v_and_b32 v83, 0x3fff, v11
    ds_add_u32 v83, v2
    v_cvt_pk_bf16_f32 v65, v9, v10
    v_perm_b32 v12, v65, v65, s41
    v_bitop3_b32 v78, v4, v12, v78 bitop3:0xca
    v_perm_b32 v13, v65, v65, s42
    v_bitop3_b32 v79, v4, v13, v79 bitop3:0xca
    s_add_u32 s46, s35, 0x4e3c000
    buffer_store_dwordx4 v[28:31], v0, s[20:23], s46 offen sc1
    s_waitcnt vmcnt(14)
    v_lshlrev_b32 v7, 16, v66
    v_and_b32 v8, 0xffff0000, v66
    v_lshlrev_b32 v9, 16, v67
    v_and_b32 v10, 0xffff0000, v67
    v_mul_f32 v7, 0.15915494, v7
    v_mul_f32 v8, 0.15915494, v8
    v_mul_f32 v9, 0.15915494, v9
    v_mul_f32 v10, 0.15915494, v10
    v_cos_f32 v7, v7
    v_lshl_add_u32 v11, v88, 11, s40
    v_lshrrev_b32 v12, 3, v92
    v_lshlrev_b16 v13, 3, v92
    v_bitop3_b32 v12, v6, v13, v12 bitop3:0xca
    v_bitop3_b32 v88, v3, v12, v11 bitop3:0xca
    v_lshrrev_b32 v11, 3, v11
    v_lshrrev_b32 v13, 2, v92
    v_bitop3_b32 v11, v5, v13, v11 bitop3:0xca
    v_and_b32 v92, 0x3fff, v11
    ds_add_u32 v92, v2
    v_cos_f32 v8, v8
    v_lshl_add_u32 v11, v89, 11, s40
    v_lshrrev_b32 v12, 3, v93
    v_lshlrev_b16 v13, 3, v93
    v_bitop3_b32 v12, v6, v13, v12 bitop3:0xca
    v_bitop3_b32 v89, v3, v12, v11 bitop3:0xca
    v_lshrrev_b32 v11, 3, v11
    v_lshrrev_b32 v13, 2, v93
    v_bitop3_b32 v11, v5, v13, v11 bitop3:0xca
    v_and_b32 v93, 0x3fff, v11
    ds_add_u32 v93, v2
    v_cvt_pk_bf16_f32 v66, v7, v8
    v_perm_b32 v12, v66, v66, s41
    v_bitop3_b32 v88, v4, v12, v88 bitop3:0xca
    v_perm_b32 v13, v66, v66, s42
    v_bitop3_b32 v89, v4, v13, v89 bitop3:0xca
    v_cos_f32 v9, v9
    v_lshl_add_u32 v11, v90, 11, s40
    v_lshrrev_b32 v12, 3, v94
    v_lshlrev_b16 v13, 3, v94
    v_bitop3_b32 v12, v6, v13, v12 bitop3:0xca
    v_bitop3_b32 v90, v3, v12, v11 bitop3:0xca
    v_lshrrev_b32 v11, 3, v11
    v_lshrrev_b32 v13, 2, v94
    v_bitop3_b32 v11, v5, v13, v11 bitop3:0xca
    v_and_b32 v94, 0x3fff, v11
    ds_add_u32 v94, v2
    v_cos_f32 v10, v10
    v_lshl_add_u32 v11, v91, 11, s40
    v_lshrrev_b32 v12, 3, v95
    v_lshlrev_b16 v13, 3, v95
    v_bitop3_b32 v12, v6, v13, v12 bitop3:0xca
    v_bitop3_b32 v91, v3, v12, v11 bitop3:0xca
    v_lshrrev_b32 v11, 3, v11
    v_lshrrev_b32 v13, 2, v95
    v_bitop3_b32 v11, v5, v13, v11 bitop3:0xca
    v_and_b32 v95, 0x3fff, v11
    ds_add_u32 v95, v2
    v_cvt_pk_bf16_f32 v67, v9, v10
    v_perm_b32 v12, v67, v67, s41
    v_bitop3_b32 v90, v4, v12, v90 bitop3:0xca
    v_perm_b32 v13, v67, v67, s42
    v_bitop3_b32 v91, v4, v13, v91 bitop3:0xca
    s_add_u32 s47, s35, 0x4e40000
    buffer_store_dwordx4 v[32:35], v0, s[20:23], s47 offen sc1
    s_waitcnt vmcnt(11)
    v_lshlrev_b32 v7, 16, v84
    v_and_b32 v8, 0xffff0000, v84
    v_lshlrev_b32 v9, 16, v85
    v_and_b32 v10, 0xffff0000, v85
    v_mul_f32 v7, 0.15915494, v7
    v_mul_f32 v8, 0.15915494, v8
    v_mul_f32 v9, 0.15915494, v9
    v_mul_f32 v10, 0.15915494, v10
    v_cos_f32 v7, v7
    v_lshl_add_u32 v11, v96, 11, s40
    v_lshrrev_b32 v12, 3, v100
    v_lshlrev_b16 v13, 3, v100
    v_bitop3_b32 v12, v6, v13, v12 bitop3:0xca
    v_bitop3_b32 v96, v3, v12, v11 bitop3:0xca
    v_lshrrev_b32 v11, 3, v11
    v_lshrrev_b32 v13, 2, v100
    v_bitop3_b32 v11, v5, v13, v11 bitop3:0xca
    v_and_b32 v100, 0x3fff, v11
    ds_add_u32 v100, v2
    v_cos_f32 v8, v8
    v_lshl_add_u32 v11, v97, 11, s40
    v_lshrrev_b32 v12, 3, v101
    v_lshlrev_b16 v13, 3, v101
    v_bitop3_b32 v12, v6, v13, v12 bitop3:0xca
    v_bitop3_b32 v97, v3, v12, v11 bitop3:0xca
    v_lshrrev_b32 v11, 3, v11
    v_lshrrev_b32 v13, 2, v101
    v_bitop3_b32 v11, v5, v13, v11 bitop3:0xca
    v_and_b32 v101, 0x3fff, v11
    ds_add_u32 v101, v2
    v_cvt_pk_bf16_f32 v84, v7, v8
    v_perm_b32 v12, v84, v84, s41
    v_bitop3_b32 v96, v4, v12, v96 bitop3:0xca
    v_perm_b32 v13, v84, v84, s42
    v_bitop3_b32 v97, v4, v13, v97 bitop3:0xca
    v_cos_f32 v9, v9
    v_lshl_add_u32 v11, v98, 11, s40
    v_lshrrev_b32 v12, 3, v102
    v_lshlrev_b16 v13, 3, v102
    v_bitop3_b32 v12, v6, v13, v12 bitop3:0xca
    v_bitop3_b32 v98, v3, v12, v11 bitop3:0xca
    v_lshrrev_b32 v11, 3, v11
    v_lshrrev_b32 v13, 2, v102
    v_bitop3_b32 v11, v5, v13, v11 bitop3:0xca
    v_and_b32 v102, 0x3fff, v11
    ds_add_u32 v102, v2
    v_cos_f32 v10, v10
    v_lshl_add_u32 v11, v99, 11, s40
    v_lshrrev_b32 v12, 3, v103
    v_lshlrev_b16 v13, 3, v103
    v_bitop3_b32 v12, v6, v13, v12 bitop3:0xca
    v_bitop3_b32 v99, v3, v12, v11 bitop3:0xca
    v_lshrrev_b32 v11, 3, v11
    v_lshrrev_b32 v13, 2, v103
    v_bitop3_b32 v11, v5, v13, v11 bitop3:0xca
    v_and_b32 v103, 0x3fff, v11
    ds_add_u32 v103, v2
    v_cvt_pk_bf16_f32 v85, v9, v10
    v_perm_b32 v12, v85, v85, s41
    v_bitop3_b32 v98, v4, v12, v98 bitop3:0xca
    v_perm_b32 v13, v85, v85, s42
    v_bitop3_b32 v99, v4, v13, v99 bitop3:0xca
    s_add_u32 s44, s35, 0x4e44000
    buffer_store_dwordx4 v[124:127], v0, s[20:23], s44 offen sc1
    s_waitcnt vmcnt(8)
    v_lshlrev_b32 v7, 16, v86
    v_and_b32 v8, 0xffff0000, v86
    v_lshlrev_b32 v9, 16, v87
    v_and_b32 v10, 0xffff0000, v87
    v_mul_f32 v7, 0.15915494, v7
    v_mul_f32 v8, 0.15915494, v8
    v_mul_f32 v9, 0.15915494, v9
    v_mul_f32 v10, 0.15915494, v10
    v_cos_f32 v7, v7
    v_lshl_add_u32 v11, v108, 11, s40
    v_lshrrev_b32 v12, 3, v112
    v_lshlrev_b16 v13, 3, v112
    v_bitop3_b32 v12, v6, v13, v12 bitop3:0xca
    v_bitop3_b32 v108, v3, v12, v11 bitop3:0xca
    v_lshrrev_b32 v11, 3, v11
    v_lshrrev_b32 v13, 2, v112
    v_bitop3_b32 v11, v5, v13, v11 bitop3:0xca
    v_and_b32 v112, 0x3fff, v11
    ds_add_u32 v112, v2
    v_cos_f32 v8, v8
    v_lshl_add_u32 v11, v109, 11, s40
    v_lshrrev_b32 v12, 3, v113
    v_lshlrev_b16 v13, 3, v113
    v_bitop3_b32 v12, v6, v13, v12 bitop3:0xca
    v_bitop3_b32 v109, v3, v12, v11 bitop3:0xca
    v_lshrrev_b32 v11, 3, v11
    v_lshrrev_b32 v13, 2, v113
    v_bitop3_b32 v11, v5, v13, v11 bitop3:0xca
    v_and_b32 v113, 0x3fff, v11
    ds_add_u32 v113, v2
    v_cvt_pk_bf16_f32 v86, v7, v8
    v_perm_b32 v12, v86, v86, s41
    v_bitop3_b32 v108, v4, v12, v108 bitop3:0xca
    v_perm_b32 v13, v86, v86, s42
    v_bitop3_b32 v109, v4, v13, v109 bitop3:0xca
    v_cos_f32 v9, v9
    v_lshl_add_u32 v11, v110, 11, s40
    v_lshrrev_b32 v12, 3, v114
    v_lshlrev_b16 v13, 3, v114
    v_bitop3_b32 v12, v6, v13, v12 bitop3:0xca
    v_bitop3_b32 v110, v3, v12, v11 bitop3:0xca
    v_lshrrev_b32 v11, 3, v11
    v_lshrrev_b32 v13, 2, v114
    v_bitop3_b32 v11, v5, v13, v11 bitop3:0xca
    v_and_b32 v114, 0x3fff, v11
    ds_add_u32 v114, v2
    v_cos_f32 v10, v10
    v_lshl_add_u32 v11, v111, 11, s40
    v_lshrrev_b32 v12, 3, v115
    v_lshlrev_b16 v13, 3, v115
    v_bitop3_b32 v12, v6, v13, v12 bitop3:0xca
    v_bitop3_b32 v111, v3, v12, v11 bitop3:0xca
    v_lshrrev_b32 v11, 3, v11
    v_lshrrev_b32 v13, 2, v115
    v_bitop3_b32 v11, v5, v13, v11 bitop3:0xca
    v_and_b32 v115, 0x3fff, v11
    ds_add_u32 v115, v2
    v_cvt_pk_bf16_f32 v87, v9, v10
    v_perm_b32 v12, v87, v87, s41
    v_bitop3_b32 v110, v4, v12, v110 bitop3:0xca
    v_perm_b32 v13, v87, v87, s42
    v_bitop3_b32 v111, v4, v13, v111 bitop3:0xca
    v_lshrrev_b32 v8, 2, v0
    v_and_b32 v7, 0x3c00, v0
    v_bitop3_b32 v7, v5, v8, v7 bitop3:0xea
    s_waitcnt lgkmcnt(0)
    s_barrier
    ds_read2st64_b32 v[8:9], v7 offset0:0 offset1:1
    ds_read2st64_b32 v[10:11], v7 offset0:2 offset1:3
    s_add_u32 s45, s33, 0x7d00000
    buffer_load_dwordx4 v[116:119], v0, s[8:11], s45 offen nt
    s_waitcnt lgkmcnt(0)
    v_lshl_or_b32 v12, v9, 16, v8
    v_lshl_or_b32 v13, v11, 16, v10
    v_mov_b32 v14, v12
    v_mov_b32 v15, v13
    s_nop 0
    v_add_u32_dpp v14, v14, v14 row_shr:1 row_mask:0xf bank_mask:0xf bound_ctrl:1
    v_add_u32_dpp v15, v15, v15 row_shr:1 row_mask:0xf bank_mask:0xf bound_ctrl:1
    s_nop 0
    v_add_u32_dpp v14, v14, v14 row_shr:2 row_mask:0xf bank_mask:0xf bound_ctrl:1
    v_add_u32_dpp v15, v15, v15 row_shr:2 row_mask:0xf bank_mask:0xf bound_ctrl:1
    s_nop 0
    v_add_u32_dpp v14, v14, v14 row_shr:4 row_mask:0xf bank_mask:0xf bound_ctrl:1
    v_add_u32_dpp v15, v15, v15 row_shr:4 row_mask:0xf bank_mask:0xf bound_ctrl:1
    s_nop 0
    v_add_u32_dpp v14, v14, v14 row_shr:8 row_mask:0xf bank_mask:0xf bound_ctrl:1
    v_add_u32_dpp v15, v15, v15 row_shr:8 row_mask:0xf bank_mask:0xf bound_ctrl:1
    s_nop 0
    v_add_u32_dpp v14, v14, v14 row_bcast:15 row_mask:0xa bank_mask:0xf
    v_add_u32_dpp v15, v15, v15 row_bcast:15 row_mask:0xa bank_mask:0xf
    s_nop 0
    v_add_u32_dpp v14, v14, v14 row_bcast:31 row_mask:0xc bank_mask:0xf
    v_add_u32_dpp v15, v15, v15 row_bcast:31 row_mask:0xc bank_mask:0xf
    v_readlane_b32 s48, v14, 63
    v_readlane_b32 s49, v15, 63
    s_lshl_b32 s54, s32, 2
    v_mov_b32 v8, s54
    s_and_b32 s50, s48, 0xffff
    s_lshr_b32 s51, s48, 16
    s_and_b32 s52, s49, 0xffff
    s_lshr_b32 s53, s49, 16
    s_add_u32 s51, s51, s50
    s_add_u32 s52, s52, s51
    s_add_u32 s53, s53, s52
    v_mov_b32 v9, s53
    s_mov_b64 exec, 1
    ds_write_b32 v8, v9 offset:16384
    s_mov_b64 exec, -1
    v_and_b32 v8, 60, v7
    s_waitcnt lgkmcnt(0)
    s_barrier
    ds_read_b32 v9, v8 offset:16384
    s_waitcnt lgkmcnt(0)
    v_add_u32_dpp v9, v9, v9 row_shr:1 row_mask:0xf bank_mask:0xf bound_ctrl:1
    s_nop 1
    v_add_u32_dpp v9, v9, v9 row_shr:2 row_mask:0xf bank_mask:0xf bound_ctrl:1
    s_nop 1
    v_add_u32_dpp v9, v9, v9 row_shr:4 row_mask:0xf bank_mask:0xf bound_ctrl:1
    s_nop 1
    v_add_u32_dpp v9, v9, v9 row_shr:8 row_mask:0xf bank_mask:0xf bound_ctrl:1
    s_nop 0
    v_readlane_b32 s54, v9, s32
    s_sub_u32 s54, s54, s53
    s_add_u32 s50, s50, s54
    s_add_u32 s51, s51, s54
    s_add_u32 s52, s52, s54
    s_pack_ll_b32_b16 s48, s54, s50
    s_pack_ll_b32_b16 s49, s51, s52
    v_add_u32 v14, s48, v14
    v_add_u32 v15, s49, v15
    v_sub_u32 v12, v14, v12
    v_sub_u32 v13, v15, v13
    v_and_b32 v8, 0xffff, v12
    v_lshrrev_b32 v9, 16, v12
    v_and_b32 v10, 0xffff, v13
    v_lshrrev_b32 v11, 16, v13
    ds_write2st64_b32 v7, v8, v9 offset0:0 offset1:1
    ds_write2st64_b32 v7, v10, v11 offset0:2 offset1:3
    s_waitcnt lgkmcnt(0)
    s_barrier
    ds_add_rtn_u32 v40, v40, v2
    ds_add_rtn_u32 v41, v41, v2
    ds_add_rtn_u32 v42, v42, v2
    ds_add_rtn_u32 v43, v43, v2
    s_add_u32 s46, s36, 0x5f3700
    buffer_store_dwordx2 v[12:13], v1, s[24:27], s46 offen
    s_bitset0_b64 exec, 63
    s_not_b64 exec, exec
    buffer_store_dwordx2 v[14:15], v1, s[24:27], s46 offen offset:8
    s_mov_b64 exec, -1
    ds_add_rtn_u32 v52, v52, v2
    ds_add_rtn_u32 v53, v53, v2
    ds_add_rtn_u32 v54, v54, v2
    ds_add_rtn_u32 v55, v55, v2
    s_add_u32 s47, s33, 0x7d00000
    buffer_load_dwordx4 v[120:123], v0, s[12:15], s47 offen nt
    ds_add_rtn_u32 v60, v60, v2
    ds_add_rtn_u32 v61, v61, v2
    ds_add_rtn_u32 v62, v62, v2
    ds_add_rtn_u32 v63, v63, v2
    s_add_u32 s44, s34, 0x3e80000
    buffer_load_dwordx2 v[104:105], v1, s[16:19], s44 offen nt
    s_add_u32 s45, s34, 0x3e82000
    buffer_load_dwordx2 v[106:107], v1, s[16:19], s45 offen nt
    ds_add_rtn_u32 v72, v72, v2
    ds_add_rtn_u32 v73, v73, v2
    ds_add_rtn_u32 v74, v74, v2
    ds_add_rtn_u32 v75, v75, v2
    s_add_u32 s46, s33, 0x7d04000
    buffer_load_dwordx4 v[16:19], v0, s[8:11], s46 offen nt
    ds_add_rtn_u32 v80, v80, v2
    ds_add_rtn_u32 v81, v81, v2
    ds_add_rtn_u32 v82, v82, v2
    ds_add_rtn_u32 v83, v83, v2
    s_add_u32 s47, s33, 0x7d04000
    buffer_load_dwordx4 v[20:23], v0, s[12:15], s47 offen nt
    ds_add_rtn_u32 v92, v92, v2
    ds_add_rtn_u32 v93, v93, v2
    ds_add_rtn_u32 v94, v94, v2
    ds_add_rtn_u32 v95, v95, v2
    s_add_u32 s44, s33, 0x7d08000
    buffer_load_dwordx4 v[28:31], v0, s[8:11], s44 offen nt
    ds_add_rtn_u32 v100, v100, v2
    ds_add_rtn_u32 v101, v101, v2
    ds_add_rtn_u32 v102, v102, v2
    ds_add_rtn_u32 v103, v103, v2
    s_add_u32 s45, s33, 0x7d08000
    buffer_load_dwordx4 v[32:35], v0, s[12:15], s45 offen nt
    ds_add_rtn_u32 v112, v112, v2
    ds_add_rtn_u32 v113, v113, v2
    ds_add_rtn_u32 v114, v114, v2
    ds_add_rtn_u32 v115, v115, v2
    s_add_u32 s46, s34, 0x3e84000
    buffer_load_dwordx2 v[124:125], v1, s[16:19], s46 offen nt
    s_add_u32 s47, s34, 0x3e86000
    buffer_load_dwordx2 v[126:127], v1, s[16:19], s47 offen nt
    s_waitcnt lgkmcnt(0)
    s_barrier
    v_and_b32 v7, -4, v40
    v_lshl_add_u32 v8, v40, 2, v7
    ds_write_b32 v8, v36
    v_lshl_add_u32 v7, v7, 2, v40
    ds_write_b8 v7, v24 offset:16
    v_and_b32 v9, -4, v41
    v_lshl_add_u32 v10, v41, 2, v9
    ds_write_b32 v10, v37
    v_lshl_add_u32 v9, v9, 2, v41
    ds_write_b8_d16_hi v9, v24 offset:16
    v_and_b32 v7, -4, v42
    v_lshl_add_u32 v8, v42, 2, v7
    ds_write_b32 v8, v38
    v_lshl_add_u32 v7, v7, 2, v42
    ds_write_b8 v7, v25 offset:16
    v_and_b32 v9, -4, v43
    v_lshl_add_u32 v10, v43, 2, v9
    ds_write_b32 v10, v39
    v_lshl_add_u32 v9, v9, 2, v43
    ds_write_b8_d16_hi v9, v25 offset:16
    s_add_u32 s44, s33, 0x7d0c000
    buffer_load_dwordx4 v[36:39], v0, s[8:11], s44 offen nt
    s_add_u32 s45, s33, 0x7d0c000
    buffer_load_dwordx4 v[40:43], v0, s[12:15], s45 offen nt
    v_and_b32 v7, -4, v52
    v_lshl_add_u32 v8, v52, 2, v7
    ds_write_b32 v8, v48
    v_lshl_add_u32 v7, v7, 2, v52
    ds_write_b8 v7, v26 offset:16
    v_and_b32 v9, -4, v53
    v_lshl_add_u32 v10, v53, 2, v9
    ds_write_b32 v10, v49
    v_lshl_add_u32 v9, v9, 2, v53
    ds_write_b8_d16_hi v9, v26 offset:16
    v_and_b32 v7, -4, v54
    v_lshl_add_u32 v8, v54, 2, v7
    ds_write_b32 v8, v50
    v_lshl_add_u32 v7, v7, 2, v54
    ds_write_b8 v7, v27 offset:16
    v_and_b32 v9, -4, v55
    v_lshl_add_u32 v10, v55, 2, v9
    ds_write_b32 v10, v51
    v_lshl_add_u32 v9, v9, 2, v55
    ds_write_b8_d16_hi v9, v27 offset:16
    s_add_u32 s46, s33, 0x7d10000
    buffer_load_dwordx4 v[48:51], v0, s[8:11], s46 offen nt
    v_and_b32 v7, -4, v60
    v_lshl_add_u32 v8, v60, 2, v7
    ds_write_b32 v8, v56
    v_lshl_add_u32 v7, v7, 2, v60
    ds_write_b8 v7, v44 offset:16
    v_and_b32 v9, -4, v61
    v_lshl_add_u32 v10, v61, 2, v9
    ds_write_b32 v10, v57
    v_lshl_add_u32 v9, v9, 2, v61
    ds_write_b8_d16_hi v9, v44 offset:16
    v_and_b32 v7, -4, v62
    v_lshl_add_u32 v8, v62, 2, v7
    ds_write_b32 v8, v58
    v_lshl_add_u32 v7, v7, 2, v62
    ds_write_b8 v7, v45 offset:16
    v_and_b32 v9, -4, v63
    v_lshl_add_u32 v10, v63, 2, v9
    ds_write_b32 v10, v59
    v_lshl_add_u32 v9, v9, 2, v63
    ds_write_b8_d16_hi v9, v45 offset:16
    s_add_u32 s47, s33, 0x7d10000
    buffer_load_dwordx4 v[52:55], v0, s[12:15], s47 offen nt
    v_and_b32 v7, -4, v72
    v_lshl_add_u32 v8, v72, 2, v7
    ds_write_b32 v8, v68
    v_lshl_add_u32 v7, v7, 2, v72
    ds_write_b8 v7, v46 offset:16
    v_and_b32 v9, -4, v73
    v_lshl_add_u32 v10, v73, 2, v9
    ds_write_b32 v10, v69
    v_lshl_add_u32 v9, v9, 2, v73
    ds_write_b8_d16_hi v9, v46 offset:16
    v_and_b32 v7, -4, v74
    v_lshl_add_u32 v8, v74, 2, v7
    ds_write_b32 v8, v70
    v_lshl_add_u32 v7, v7, 2, v74
    ds_write_b8 v7, v47 offset:16
    v_and_b32 v9, -4, v75
    v_lshl_add_u32 v10, v75, 2, v9
    ds_write_b32 v10, v71
    v_lshl_add_u32 v9, v9, 2, v75
    ds_write_b8_d16_hi v9, v47 offset:16
    s_add_u32 s44, s34, 0x3e88000
    buffer_load_dwordx2 v[24:25], v1, s[16:19], s44 offen nt
    s_add_u32 s45, s34, 0x3e8a000
    buffer_load_dwordx2 v[26:27], v1, s[16:19], s45 offen nt
    v_and_b32 v7, -4, v80
    v_lshl_add_u32 v8, v80, 2, v7
    ds_write_b32 v8, v76
    v_lshl_add_u32 v7, v7, 2, v80
    ds_write_b8 v7, v64 offset:16
    v_and_b32 v9, -4, v81
    v_lshl_add_u32 v10, v81, 2, v9
    ds_write_b32 v10, v77
    v_lshl_add_u32 v9, v9, 2, v81
    ds_write_b8_d16_hi v9, v64 offset:16
    v_and_b32 v7, -4, v82
    v_lshl_add_u32 v8, v82, 2, v7
    ds_write_b32 v8, v78
    v_lshl_add_u32 v7, v7, 2, v82
    ds_write_b8 v7, v65 offset:16
    v_and_b32 v9, -4, v83
    v_lshl_add_u32 v10, v83, 2, v9
    ds_write_b32 v10, v79
    v_lshl_add_u32 v9, v9, 2, v83
    ds_write_b8_d16_hi v9, v65 offset:16
    s_add_u32 s46, s33, 0x7d14000
    buffer_load_dwordx4 v[56:59], v0, s[8:11], s46 offen nt
    s_add_u32 s47, s33, 0x7d14000
    buffer_load_dwordx4 v[60:63], v0, s[12:15], s47 offen nt
    v_and_b32 v7, -4, v92
    v_lshl_add_u32 v8, v92, 2, v7
    ds_write_b32 v8, v88
    v_lshl_add_u32 v7, v7, 2, v92
    ds_write_b8 v7, v66 offset:16
    v_and_b32 v9, -4, v93
    v_lshl_add_u32 v10, v93, 2, v9
    ds_write_b32 v10, v89
    v_lshl_add_u32 v9, v9, 2, v93
    ds_write_b8_d16_hi v9, v66 offset:16
    v_and_b32 v7, -4, v94
    v_lshl_add_u32 v8, v94, 2, v7
    ds_write_b32 v8, v90
    v_lshl_add_u32 v7, v7, 2, v94
    ds_write_b8 v7, v67 offset:16
    v_and_b32 v9, -4, v95
    v_lshl_add_u32 v10, v95, 2, v9
    ds_write_b32 v10, v91
    v_lshl_add_u32 v9, v9, 2, v95
    ds_write_b8_d16_hi v9, v67 offset:16
    s_add_u32 s44, s33, 0x7d18000
    buffer_load_dwordx4 v[68:71], v0, s[8:11], s44 offen nt
    v_and_b32 v7, -4, v100
    v_lshl_add_u32 v8, v100, 2, v7
    ds_write_b32 v8, v96
    v_lshl_add_u32 v7, v7, 2, v100
    ds_write_b8 v7, v84 offset:16
    v_and_b32 v9, -4, v101
    v_lshl_add_u32 v10, v101, 2, v9
    ds_write_b32 v10, v97
    v_lshl_add_u32 v9, v9, 2, v101
    ds_write_b8_d16_hi v9, v84 offset:16
    v_and_b32 v7, -4, v102
    v_lshl_add_u32 v8, v102, 2, v7
    ds_write_b32 v8, v98
    v_lshl_add_u32 v7, v7, 2, v102
    ds_write_b8 v7, v85 offset:16
    v_and_b32 v9, -4, v103
    v_lshl_add_u32 v10, v103, 2, v9
    ds_write_b32 v10, v99
    v_lshl_add_u32 v9, v9, 2, v103
    ds_write_b8_d16_hi v9, v85 offset:16
    s_add_u32 s45, s33, 0x7d18000
    buffer_load_dwordx4 v[72:75], v0, s[12:15], s45 offen nt
    v_and_b32 v7, -4, v112
    v_lshl_add_u32 v8, v112, 2, v7
    ds_write_b32 v8, v108
    v_lshl_add_u32 v7, v7, 2, v112
    ds_write_b8 v7, v86 offset:16
    v_and_b32 v9, -4, v113
    v_lshl_add_u32 v10, v113, 2, v9
    ds_write_b32 v10, v109
    v_lshl_add_u32 v9, v9, 2, v113
    ds_write_b8_d16_hi v9, v86 offset:16
    v_and_b32 v7, -4, v114
    v_lshl_add_u32 v8, v114, 2, v7
    ds_write_b32 v8, v110
    v_lshl_add_u32 v7, v7, 2, v114
    ds_write_b8 v7, v87 offset:16
    v_and_b32 v9, -4, v115
    v_lshl_add_u32 v10, v115, 2, v9
    ds_write_b32 v10, v111
    v_lshl_add_u32 v9, v9, 2, v115
    ds_write_b8_d16_hi v9, v87 offset:16
    s_add_u32 s46, s34, 0x3e8c000
    buffer_load_dwordx2 v[44:45], v1, s[16:19], s46 offen nt
    s_add_u32 s47, s34, 0x3e8e000
    buffer_load_dwordx2 v[46:47], v1, s[16:19], s47 offen nt
    v_add_u32 v7, 0x10000, v0
    v_add_u32 v12, 0x20000, v0
    v_mov_b32 v8, 0
    v_mov_b32 v9, 0
    v_mov_b32 v10, 0
    v_mov_b32 v11, 0
    s_waitcnt lgkmcnt(0)
    s_barrier
    ds_read_b128 v[76:79], v0 offset:0
    ds_write_b128 v0, v[8:11]
    ds_read_b128 v[80:83], v0 offset:16384
    ds_read_b128 v[88:91], v0 offset:32768
    ds_read_b128 v[92:95], v0 offset:49152
    ds_read_b128 v[64:67], v7 offset:0
    ds_read_b128 v[96:99], v7 offset:16384
    ds_read_b128 v[100:103], v7 offset:32768
    ds_read_b128 v[108:111], v7 offset:49152
    ds_read_b128 v[112:115], v12 offset:0
    ds_read_b128 v[84:87], v12 offset:16384
    s_waitcnt lgkmcnt(0)
    s_barrier
    s_add_u32 s44, s35, 0x7530000
    buffer_store_dwordx4 v[76:79], v0, s[20:23], s44 offen sc1
    s_add_u32 s45, s35, 0x7534000
    buffer_store_dwordx4 v[80:83], v0, s[20:23], s45 offen sc1
    s_add_u32 s46, s33, 0x7d1c000
    buffer_load_dwordx4 v[76:79], v0, s[8:11], s46 offen nt
    s_add_u32 s47, s33, 0x7d1c000
    buffer_load_dwordx4 v[80:83], v0, s[12:15], s47 offen nt
    s_add_u32 s44, s35, 0x7538000
    buffer_store_dwordx4 v[88:91], v0, s[20:23], s44 offen sc1
    s_waitcnt vmcnt(23)
    v_lshlrev_b32 v7, 16, v104
    v_and_b32 v8, 0xffff0000, v104
    v_lshlrev_b32 v9, 16, v105
    v_and_b32 v10, 0xffff0000, v105
    v_mul_f32 v7, 0.15915494, v7
    v_mul_f32 v8, 0.15915494, v8
    v_mul_f32 v9, 0.15915494, v9
    v_mul_f32 v10, 0.15915494, v10
    v_cos_f32 v7, v7
    v_lshl_add_u32 v11, v116, 11, s40
    v_lshrrev_b32 v12, 3, v120
    v_lshlrev_b16 v13, 3, v120
    v_bitop3_b32 v12, v6, v13, v12 bitop3:0xca
    v_bitop3_b32 v116, v3, v12, v11 bitop3:0xca
    v_lshrrev_b32 v11, 3, v11
    v_lshrrev_b32 v13, 2, v120
    v_bitop3_b32 v11, v5, v13, v11 bitop3:0xca
    v_and_b32 v120, 0x3fff, v11
    ds_add_u32 v120, v2
    v_cos_f32 v8, v8
    v_lshl_add_u32 v11, v117, 11, s40
    v_lshrrev_b32 v12, 3, v121
    v_lshlrev_b16 v13, 3, v121
    v_bitop3_b32 v12, v6, v13, v12 bitop3:0xca
    v_bitop3_b32 v117, v3, v12, v11 bitop3:0xca
    v_lshrrev_b32 v11, 3, v11
    v_lshrrev_b32 v13, 2, v121
    v_bitop3_b32 v11, v5, v13, v11 bitop3:0xca
    v_and_b32 v121, 0x3fff, v11
    ds_add_u32 v121, v2
    v_cvt_pk_bf16_f32 v104, v7, v8
    v_perm_b32 v12, v104, v104, s41
    v_bitop3_b32 v116, v4, v12, v116 bitop3:0xca
    v_perm_b32 v13, v104, v104, s42
    v_bitop3_b32 v117, v4, v13, v117 bitop3:0xca
    v_cos_f32 v9, v9
    v_lshl_add_u32 v11, v118, 11, s40
    v_lshrrev_b32 v12, 3, v122
    v_lshlrev_b16 v13, 3, v122
    v_bitop3_b32 v12, v6, v13, v12 bitop3:0xca
    v_bitop3_b32 v118, v3, v12, v11 bitop3:0xca
    v_lshrrev_b32 v11, 3, v11
    v_lshrrev_b32 v13, 2, v122
    v_bitop3_b32 v11, v5, v13, v11 bitop3:0xca
    v_and_b32 v122, 0x3fff, v11
    ds_add_u32 v122, v2
    v_cos_f32 v10, v10
    v_lshl_add_u32 v11, v119, 11, s40
    v_lshrrev_b32 v12, 3, v123
    v_lshlrev_b16 v13, 3, v123
    v_bitop3_b32 v12, v6, v13, v12 bitop3:0xca
    v_bitop3_b32 v119, v3, v12, v11 bitop3:0xca
    v_lshrrev_b32 v11, 3, v11
    v_lshrrev_b32 v13, 2, v123
    v_bitop3_b32 v11, v5, v13, v11 bitop3:0xca
    v_and_b32 v123, 0x3fff, v11
    ds_add_u32 v123, v2
    v_cvt_pk_bf16_f32 v105, v9, v10
    v_perm_b32 v12, v105, v105, s41
    v_bitop3_b32 v118, v4, v12, v118 bitop3:0xca
    v_perm_b32 v13, v105, v105, s42
    v_bitop3_b32 v119, v4, v13, v119 bitop3:0xca
    s_add_u32 s45, s35, 0x753c000
    buffer_store_dwordx4 v[92:95], v0, s[20:23], s45 offen sc1
    s_waitcnt vmcnt(22)
    v_lshlrev_b32 v7, 16, v106
    v_and_b32 v8, 0xffff0000, v106
    v_lshlrev_b32 v9, 16, v107
    v_and_b32 v10, 0xffff0000, v107
    v_mul_f32 v7, 0.15915494, v7
    v_mul_f32 v8, 0.15915494, v8
    v_mul_f32 v9, 0.15915494, v9
    v_mul_f32 v10, 0.15915494, v10
    v_cos_f32 v7, v7
    v_lshl_add_u32 v11, v16, 11, s40
    v_lshrrev_b32 v12, 3, v20
    v_lshlrev_b16 v13, 3, v20
    v_bitop3_b32 v12, v6, v13, v12 bitop3:0xca
    v_bitop3_b32 v16, v3, v12, v11 bitop3:0xca
    v_lshrrev_b32 v11, 3, v11
    v_lshrrev_b32 v13, 2, v20
    v_bitop3_b32 v11, v5, v13, v11 bitop3:0xca
    v_and_b32 v20, 0x3fff, v11
    ds_add_u32 v20, v2
    v_cos_f32 v8, v8
    v_lshl_add_u32 v11, v17, 11, s40
    v_lshrrev_b32 v12, 3, v21
    v_lshlrev_b16 v13, 3, v21
    v_bitop3_b32 v12, v6, v13, v12 bitop3:0xca
    v_bitop3_b32 v17, v3, v12, v11 bitop3:0xca
    v_lshrrev_b32 v11, 3, v11
    v_lshrrev_b32 v13, 2, v21
    v_bitop3_b32 v11, v5, v13, v11 bitop3:0xca
    v_and_b32 v21, 0x3fff, v11
    ds_add_u32 v21, v2
    v_cvt_pk_bf16_f32 v106, v7, v8
    v_perm_b32 v12, v106, v106, s41
    v_bitop3_b32 v16, v4, v12, v16 bitop3:0xca
    v_perm_b32 v13, v106, v106, s42
    v_bitop3_b32 v17, v4, v13, v17 bitop3:0xca
    v_cos_f32 v9, v9
    v_lshl_add_u32 v11, v18, 11, s40
    v_lshrrev_b32 v12, 3, v22
    v_lshlrev_b16 v13, 3, v22
    v_bitop3_b32 v12, v6, v13, v12 bitop3:0xca
    v_bitop3_b32 v18, v3, v12, v11 bitop3:0xca
    v_lshrrev_b32 v11, 3, v11
    v_lshrrev_b32 v13, 2, v22
    v_bitop3_b32 v11, v5, v13, v11 bitop3:0xca
    v_and_b32 v22, 0x3fff, v11
    ds_add_u32 v22, v2
    v_cos_f32 v10, v10
    v_lshl_add_u32 v11, v19, 11, s40
    v_lshrrev_b32 v12, 3, v23
    v_lshlrev_b16 v13, 3, v23
    v_bitop3_b32 v12, v6, v13, v12 bitop3:0xca
    v_bitop3_b32 v19, v3, v12, v11 bitop3:0xca
    v_lshrrev_b32 v11, 3, v11
    v_lshrrev_b32 v13, 2, v23
    v_bitop3_b32 v11, v5, v13, v11 bitop3:0xca
    v_and_b32 v23, 0x3fff, v11
    ds_add_u32 v23, v2
    v_cvt_pk_bf16_f32 v107, v9, v10
    v_perm_b32 v12, v107, v107, s41
    v_bitop3_b32 v18, v4, v12, v18 bitop3:0xca
    v_perm_b32 v13, v107, v107, s42
    v_bitop3_b32 v19, v4, v13, v19 bitop3:0xca
    s_add_u32 s46, s35, 0x7540000
    buffer_store_dwordx4 v[64:67], v0, s[20:23], s46 offen sc1
    s_waitcnt vmcnt(19)
    v_lshlrev_b32 v7, 16, v124
    v_and_b32 v8, 0xffff0000, v124
    v_lshlrev_b32 v9, 16, v125
    v_and_b32 v10, 0xffff0000, v125
    v_mul_f32 v7, 0.15915494, v7
    v_mul_f32 v8, 0.15915494, v8
    v_mul_f32 v9, 0.15915494, v9
    v_mul_f32 v10, 0.15915494, v10
    v_cos_f32 v7, v7
    v_lshl_add_u32 v11, v28, 11, s40
    v_lshrrev_b32 v12, 3, v32
    v_lshlrev_b16 v13, 3, v32
    v_bitop3_b32 v12, v6, v13, v12 bitop3:0xca
    v_bitop3_b32 v28, v3, v12, v11 bitop3:0xca
    v_lshrrev_b32 v11, 3, v11
    v_lshrrev_b32 v13, 2, v32
    v_bitop3_b32 v11, v5, v13, v11 bitop3:0xca
    v_and_b32 v32, 0x3fff, v11
    ds_add_u32 v32, v2
    v_cos_f32 v8, v8
    v_lshl_add_u32 v11, v29, 11, s40
    v_lshrrev_b32 v12, 3, v33
    v_lshlrev_b16 v13, 3, v33
    v_bitop3_b32 v12, v6, v13, v12 bitop3:0xca
    v_bitop3_b32 v29, v3, v12, v11 bitop3:0xca
    v_lshrrev_b32 v11, 3, v11
    v_lshrrev_b32 v13, 2, v33
    v_bitop3_b32 v11, v5, v13, v11 bitop3:0xca
    v_and_b32 v33, 0x3fff, v11
    ds_add_u32 v33, v2
    v_cvt_pk_bf16_f32 v124, v7, v8
    v_perm_b32 v12, v124, v124, s41
    v_bitop3_b32 v28, v4, v12, v28 bitop3:0xca
    v_perm_b32 v13, v124, v124, s42
    v_bitop3_b32 v29, v4, v13, v29 bitop3:0xca
    v_cos_f32 v9, v9
    v_lshl_add_u32 v11, v30, 11, s40
    v_lshrrev_b32 v12, 3, v34
    v_lshlrev_b16 v13, 3, v34
    v_bitop3_b32 v12, v6, v13, v12 bitop3:0xca
    v_bitop3_b32 v30, v3, v12, v11 bitop3:0xca
    v_lshrrev_b32 v11, 3, v11
    v_lshrrev_b32 v13, 2, v34
    v_bitop3_b32 v11, v5, v13, v11 bitop3:0xca
    v_and_b32 v34, 0x3fff, v11
    ds_add_u32 v34, v2
    v_cos_f32 v10, v10
    v_lshl_add_u32 v11, v31, 11, s40
    v_lshrrev_b32 v12, 3, v35
    v_lshlrev_b16 v13, 3, v35
    v_bitop3_b32 v12, v6, v13, v12 bitop3:0xca
    v_bitop3_b32 v31, v3, v12, v11 bitop3:0xca
    v_lshrrev_b32 v11, 3, v11
    v_lshrrev_b32 v13, 2, v35
    v_bitop3_b32 v11, v5, v13, v11 bitop3:0xca
    v_and_b32 v35, 0x3fff, v11
    ds_add_u32 v35, v2
    v_cvt_pk_bf16_f32 v125, v9, v10
    v_perm_b32 v12, v125, v125, s41
    v_bitop3_b32 v30, v4, v12, v30 bitop3:0xca
    v_perm_b32 v13, v125, v125, s42
    v_bitop3_b32 v31, v4, v13, v31 bitop3:0xca
    s_add_u32 s47, s35, 0x7544000
    buffer_store_dwordx4 v[96:99], v0, s[20:23], s47 offen sc1
    s_waitcnt vmcnt(18)
    v_lshlrev_b32 v7, 16, v126
    v_and_b32 v8, 0xffff0000, v126
    v_lshlrev_b32 v9, 16, v127
    v_and_b32 v10, 0xffff0000, v127
    v_mul_f32 v7, 0.15915494, v7
    v_mul_f32 v8, 0.15915494, v8
    v_mul_f32 v9, 0.15915494, v9
    v_mul_f32 v10, 0.15915494, v10
    v_cos_f32 v7, v7
    v_lshl_add_u32 v11, v36, 11, s40
    v_lshrrev_b32 v12, 3, v40
    v_lshlrev_b16 v13, 3, v40
    v_bitop3_b32 v12, v6, v13, v12 bitop3:0xca
    v_bitop3_b32 v36, v3, v12, v11 bitop3:0xca
    v_lshrrev_b32 v11, 3, v11
    v_lshrrev_b32 v13, 2, v40
    v_bitop3_b32 v11, v5, v13, v11 bitop3:0xca
    v_and_b32 v40, 0x3fff, v11
    ds_add_u32 v40, v2
    v_cos_f32 v8, v8
    v_lshl_add_u32 v11, v37, 11, s40
    v_lshrrev_b32 v12, 3, v41
    v_lshlrev_b16 v13, 3, v41
    v_bitop3_b32 v12, v6, v13, v12 bitop3:0xca
    v_bitop3_b32 v37, v3, v12, v11 bitop3:0xca
    v_lshrrev_b32 v11, 3, v11
    v_lshrrev_b32 v13, 2, v41
    v_bitop3_b32 v11, v5, v13, v11 bitop3:0xca
    v_and_b32 v41, 0x3fff, v11
    ds_add_u32 v41, v2
    v_cvt_pk_bf16_f32 v126, v7, v8
    v_perm_b32 v12, v126, v126, s41
    v_bitop3_b32 v36, v4, v12, v36 bitop3:0xca
    v_perm_b32 v13, v126, v126, s42
    v_bitop3_b32 v37, v4, v13, v37 bitop3:0xca
    v_cos_f32 v9, v9
    v_lshl_add_u32 v11, v38, 11, s40
    v_lshrrev_b32 v12, 3, v42
    v_lshlrev_b16 v13, 3, v42
    v_bitop3_b32 v12, v6, v13, v12 bitop3:0xca
    v_bitop3_b32 v38, v3, v12, v11 bitop3:0xca
    v_lshrrev_b32 v11, 3, v11
    v_lshrrev_b32 v13, 2, v42
    v_bitop3_b32 v11, v5, v13, v11 bitop3:0xca
    v_and_b32 v42, 0x3fff, v11
    ds_add_u32 v42, v2
    v_cos_f32 v10, v10
    v_lshl_add_u32 v11, v39, 11, s40
    v_lshrrev_b32 v12, 3, v43
    v_lshlrev_b16 v13, 3, v43
    v_bitop3_b32 v12, v6, v13, v12 bitop3:0xca
    v_bitop3_b32 v39, v3, v12, v11 bitop3:0xca
    v_lshrrev_b32 v11, 3, v11
    v_lshrrev_b32 v13, 2, v43
    v_bitop3_b32 v11, v5, v13, v11 bitop3:0xca
    v_and_b32 v43, 0x3fff, v11
    ds_add_u32 v43, v2
    v_cvt_pk_bf16_f32 v127, v9, v10
    v_perm_b32 v12, v127, v127, s41
    v_bitop3_b32 v38, v4, v12, v38 bitop3:0xca
    v_perm_b32 v13, v127, v127, s42
    v_bitop3_b32 v39, v4, v13, v39 bitop3:0xca
    s_add_u32 s44, s35, 0x7548000
    buffer_store_dwordx4 v[100:103], v0, s[20:23], s44 offen sc1
    s_waitcnt vmcnt(15)
    v_lshlrev_b32 v7, 16, v24
    v_and_b32 v8, 0xffff0000, v24
    v_lshlrev_b32 v9, 16, v25
    v_and_b32 v10, 0xffff0000, v25
    v_mul_f32 v7, 0.15915494, v7
    v_mul_f32 v8, 0.15915494, v8
    v_mul_f32 v9, 0.15915494, v9
    v_mul_f32 v10, 0.15915494, v10
    v_cos_f32 v7, v7
    v_lshl_add_u32 v11, v48, 11, s40
    v_lshrrev_b32 v12, 3, v52
    v_lshlrev_b16 v13, 3, v52
    v_bitop3_b32 v12, v6, v13, v12 bitop3:0xca
    v_bitop3_b32 v48, v3, v12, v11 bitop3:0xca
    v_lshrrev_b32 v11, 3, v11
    v_lshrrev_b32 v13, 2, v52
    v_bitop3_b32 v11, v5, v13, v11 bitop3:0xca
    v_and_b32 v52, 0x3fff, v11
    ds_add_u32 v52, v2
    v_cos_f32 v8, v8
    v_lshl_add_u32 v11, v49, 11, s40
    v_lshrrev_b32 v12, 3, v53
    v_lshlrev_b16 v13, 3, v53
    v_bitop3_b32 v12, v6, v13, v12 bitop3:0xca
    v_bitop3_b32 v49, v3, v12, v11 bitop3:0xca
    v_lshrrev_b32 v11, 3, v11
    v_lshrrev_b32 v13, 2, v53
    v_bitop3_b32 v11, v5, v13, v11 bitop3:0xca
    v_and_b32 v53, 0x3fff, v11
    ds_add_u32 v53, v2
    v_cvt_pk_bf16_f32 v24, v7, v8
    v_perm_b32 v12, v24, v24, s41
    v_bitop3_b32 v48, v4, v12, v48 bitop3:0xca
    v_perm_b32 v13, v24, v24, s42
    v_bitop3_b32 v49, v4, v13, v49 bitop3:0xca
    v_cos_f32 v9, v9
    v_lshl_add_u32 v11, v50, 11, s40
    v_lshrrev_b32 v12, 3, v54
    v_lshlrev_b16 v13, 3, v54
    v_bitop3_b32 v12, v6, v13, v12 bitop3:0xca
    v_bitop3_b32 v50, v3, v12, v11 bitop3:0xca
    v_lshrrev_b32 v11, 3, v11
    v_lshrrev_b32 v13, 2, v54
    v_bitop3_b32 v11, v5, v13, v11 bitop3:0xca
    v_and_b32 v54, 0x3fff, v11
    ds_add_u32 v54, v2
    v_cos_f32 v10, v10
    v_lshl_add_u32 v11, v51, 11, s40
    v_lshrrev_b32 v12, 3, v55
    v_lshlrev_b16 v13, 3, v55
    v_bitop3_b32 v12, v6, v13, v12 bitop3:0xca
    v_bitop3_b32 v51, v3, v12, v11 bitop3:0xca
    v_lshrrev_b32 v11, 3, v11
    v_lshrrev_b32 v13, 2, v55
    v_bitop3_b32 v11, v5, v13, v11 bitop3:0xca
    v_and_b32 v55, 0x3fff, v11
    ds_add_u32 v55, v2
    v_cvt_pk_bf16_f32 v25, v9, v10
    v_perm_b32 v12, v25, v25, s41
    v_bitop3_b32 v50, v4, v12, v50 bitop3:0xca
    v_perm_b32 v13, v25, v25, s42
    v_bitop3_b32 v51, v4, v13, v51 bitop3:0xca
    s_add_u32 s45, s35, 0x754c000
    buffer_store_dwordx4 v[108:111], v0, s[20:23], s45 offen sc1
    s_waitcnt vmcnt(14)
    v_lshlrev_b32 v7, 16, v26
    v_and_b32 v8, 0xffff0000, v26
    v_lshlrev_b32 v9, 16, v27
    v_and_b32 v10, 0xffff0000, v27
    v_mul_f32 v7, 0.15915494, v7
    v_mul_f32 v8, 0.15915494, v8
    v_mul_f32 v9, 0.15915494, v9
    v_mul_f32 v10, 0.15915494, v10
    v_cos_f32 v7, v7
    v_lshl_add_u32 v11, v56, 11, s40
    v_lshrrev_b32 v12, 3, v60
    v_lshlrev_b16 v13, 3, v60
    v_bitop3_b32 v12, v6, v13, v12 bitop3:0xca
    v_bitop3_b32 v56, v3, v12, v11 bitop3:0xca
    v_lshrrev_b32 v11, 3, v11
    v_lshrrev_b32 v13, 2, v60
    v_bitop3_b32 v11, v5, v13, v11 bitop3:0xca
    v_and_b32 v60, 0x3fff, v11
    ds_add_u32 v60, v2
    v_cos_f32 v8, v8
    v_lshl_add_u32 v11, v57, 11, s40
    v_lshrrev_b32 v12, 3, v61
    v_lshlrev_b16 v13, 3, v61
    v_bitop3_b32 v12, v6, v13, v12 bitop3:0xca
    v_bitop3_b32 v57, v3, v12, v11 bitop3:0xca
    v_lshrrev_b32 v11, 3, v11
    v_lshrrev_b32 v13, 2, v61
    v_bitop3_b32 v11, v5, v13, v11 bitop3:0xca
    v_and_b32 v61, 0x3fff, v11
    ds_add_u32 v61, v2
    v_cvt_pk_bf16_f32 v26, v7, v8
    v_perm_b32 v12, v26, v26, s41
    v_bitop3_b32 v56, v4, v12, v56 bitop3:0xca
    v_perm_b32 v13, v26, v26, s42
    v_bitop3_b32 v57, v4, v13, v57 bitop3:0xca
    v_cos_f32 v9, v9
    v_lshl_add_u32 v11, v58, 11, s40
    v_lshrrev_b32 v12, 3, v62
    v_lshlrev_b16 v13, 3, v62
    v_bitop3_b32 v12, v6, v13, v12 bitop3:0xca
    v_bitop3_b32 v58, v3, v12, v11 bitop3:0xca
    v_lshrrev_b32 v11, 3, v11
    v_lshrrev_b32 v13, 2, v62
    v_bitop3_b32 v11, v5, v13, v11 bitop3:0xca
    v_and_b32 v62, 0x3fff, v11
    ds_add_u32 v62, v2
    v_cos_f32 v10, v10
    v_lshl_add_u32 v11, v59, 11, s40
    v_lshrrev_b32 v12, 3, v63
    v_lshlrev_b16 v13, 3, v63
    v_bitop3_b32 v12, v6, v13, v12 bitop3:0xca
    v_bitop3_b32 v59, v3, v12, v11 bitop3:0xca
    v_lshrrev_b32 v11, 3, v11
    v_lshrrev_b32 v13, 2, v63
    v_bitop3_b32 v11, v5, v13, v11 bitop3:0xca
    v_and_b32 v63, 0x3fff, v11
    ds_add_u32 v63, v2
    v_cvt_pk_bf16_f32 v27, v9, v10
    v_perm_b32 v12, v27, v27, s41
    v_bitop3_b32 v58, v4, v12, v58 bitop3:0xca
    v_perm_b32 v13, v27, v27, s42
    v_bitop3_b32 v59, v4, v13, v59 bitop3:0xca
    s_add_u32 s46, s35, 0x7550000
    buffer_store_dwordx4 v[112:115], v0, s[20:23], s46 offen sc1
    s_waitcnt vmcnt(11)
    v_lshlrev_b32 v7, 16, v44
    v_and_b32 v8, 0xffff0000, v44
    v_lshlrev_b32 v9, 16, v45
    v_and_b32 v10, 0xffff0000, v45
    v_mul_f32 v7, 0.15915494, v7
    v_mul_f32 v8, 0.15915494, v8
    v_mul_f32 v9, 0.15915494, v9
    v_mul_f32 v10, 0.15915494, v10
    v_cos_f32 v7, v7
    v_lshl_add_u32 v11, v68, 11, s40
    v_lshrrev_b32 v12, 3, v72
    v_lshlrev_b16 v13, 3, v72
    v_bitop3_b32 v12, v6, v13, v12 bitop3:0xca
    v_bitop3_b32 v68, v3, v12, v11 bitop3:0xca
    v_lshrrev_b32 v11, 3, v11
    v_lshrrev_b32 v13, 2, v72
    v_bitop3_b32 v11, v5, v13, v11 bitop3:0xca
    v_and_b32 v72, 0x3fff, v11
    ds_add_u32 v72, v2
    v_cos_f32 v8, v8
    v_lshl_add_u32 v11, v69, 11, s40
    v_lshrrev_b32 v12, 3, v73
    v_lshlrev_b16 v13, 3, v73
    v_bitop3_b32 v12, v6, v13, v12 bitop3:0xca
    v_bitop3_b32 v69, v3, v12, v11 bitop3:0xca
    v_lshrrev_b32 v11, 3, v11
    v_lshrrev_b32 v13, 2, v73
    v_bitop3_b32 v11, v5, v13, v11 bitop3:0xca
    v_and_b32 v73, 0x3fff, v11
    ds_add_u32 v73, v2
    v_cvt_pk_bf16_f32 v44, v7, v8
    v_perm_b32 v12, v44, v44, s41
    v_bitop3_b32 v68, v4, v12, v68 bitop3:0xca
    v_perm_b32 v13, v44, v44, s42
    v_bitop3_b32 v69, v4, v13, v69 bitop3:0xca
    v_cos_f32 v9, v9
    v_lshl_add_u32 v11, v70, 11, s40
    v_lshrrev_b32 v12, 3, v74
    v_lshlrev_b16 v13, 3, v74
    v_bitop3_b32 v12, v6, v13, v12 bitop3:0xca
    v_bitop3_b32 v70, v3, v12, v11 bitop3:0xca
    v_lshrrev_b32 v11, 3, v11
    v_lshrrev_b32 v13, 2, v74
    v_bitop3_b32 v11, v5, v13, v11 bitop3:0xca
    v_and_b32 v74, 0x3fff, v11
    ds_add_u32 v74, v2
    v_cos_f32 v10, v10
    v_lshl_add_u32 v11, v71, 11, s40
    v_lshrrev_b32 v12, 3, v75
    v_lshlrev_b16 v13, 3, v75
    v_bitop3_b32 v12, v6, v13, v12 bitop3:0xca
    v_bitop3_b32 v71, v3, v12, v11 bitop3:0xca
    v_lshrrev_b32 v11, 3, v11
    v_lshrrev_b32 v13, 2, v75
    v_bitop3_b32 v11, v5, v13, v11 bitop3:0xca
    v_and_b32 v75, 0x3fff, v11
    ds_add_u32 v75, v2
    v_cvt_pk_bf16_f32 v45, v9, v10
    v_perm_b32 v12, v45, v45, s41
    v_bitop3_b32 v70, v4, v12, v70 bitop3:0xca
    v_perm_b32 v13, v45, v45, s42
    v_bitop3_b32 v71, v4, v13, v71 bitop3:0xca
    s_add_u32 s47, s35, 0x7554000
    buffer_store_dwordx4 v[84:87], v0, s[20:23], s47 offen sc1
    s_waitcnt vmcnt(8)
    v_lshlrev_b32 v7, 16, v46
    v_and_b32 v8, 0xffff0000, v46
    v_lshlrev_b32 v9, 16, v47
    v_and_b32 v10, 0xffff0000, v47
    v_mul_f32 v7, 0.15915494, v7
    v_mul_f32 v8, 0.15915494, v8
    v_mul_f32 v9, 0.15915494, v9
    v_mul_f32 v10, 0.15915494, v10
    v_cos_f32 v7, v7
    v_lshl_add_u32 v11, v76, 11, s40
    v_lshrrev_b32 v12, 3, v80
    v_lshlrev_b16 v13, 3, v80
    v_bitop3_b32 v12, v6, v13, v12 bitop3:0xca
    v_bitop3_b32 v76, v3, v12, v11 bitop3:0xca
    v_lshrrev_b32 v11, 3, v11
    v_lshrrev_b32 v13, 2, v80
    v_bitop3_b32 v11, v5, v13, v11 bitop3:0xca
    v_and_b32 v80, 0x3fff, v11
    ds_add_u32 v80, v2
    v_cos_f32 v8, v8
    v_lshl_add_u32 v11, v77, 11, s40
    v_lshrrev_b32 v12, 3, v81
    v_lshlrev_b16 v13, 3, v81
    v_bitop3_b32 v12, v6, v13, v12 bitop3:0xca
    v_bitop3_b32 v77, v3, v12, v11 bitop3:0xca
    v_lshrrev_b32 v11, 3, v11
    v_lshrrev_b32 v13, 2, v81
    v_bitop3_b32 v11, v5, v13, v11 bitop3:0xca
    v_and_b32 v81, 0x3fff, v11
    ds_add_u32 v81, v2
    v_cvt_pk_bf16_f32 v46, v7, v8
    v_perm_b32 v12, v46, v46, s41
    v_bitop3_b32 v76, v4, v12, v76 bitop3:0xca
    v_perm_b32 v13, v46, v46, s42
    v_bitop3_b32 v77, v4, v13, v77 bitop3:0xca
    v_cos_f32 v9, v9
    v_lshl_add_u32 v11, v78, 11, s40
    v_lshrrev_b32 v12, 3, v82
    v_lshlrev_b16 v13, 3, v82
    v_bitop3_b32 v12, v6, v13, v12 bitop3:0xca
    v_bitop3_b32 v78, v3, v12, v11 bitop3:0xca
    v_lshrrev_b32 v11, 3, v11
    v_lshrrev_b32 v13, 2, v82
    v_bitop3_b32 v11, v5, v13, v11 bitop3:0xca
    v_and_b32 v82, 0x3fff, v11
    ds_add_u32 v82, v2
    v_cos_f32 v10, v10
    v_lshl_add_u32 v11, v79, 11, s40
    v_lshrrev_b32 v12, 3, v83
    v_lshlrev_b16 v13, 3, v83
    v_bitop3_b32 v12, v6, v13, v12 bitop3:0xca
    v_bitop3_b32 v79, v3, v12, v11 bitop3:0xca
    v_lshrrev_b32 v11, 3, v11
    v_lshrrev_b32 v13, 2, v83
    v_bitop3_b32 v11, v5, v13, v11 bitop3:0xca
    v_and_b32 v83, 0x3fff, v11
    ds_add_u32 v83, v2
    v_cvt_pk_bf16_f32 v47, v9, v10
    v_perm_b32 v12, v47, v47, s41
    v_bitop3_b32 v78, v4, v12, v78 bitop3:0xca
    v_perm_b32 v13, v47, v47, s42
    v_bitop3_b32 v79, v4, v13, v79 bitop3:0xca
    v_lshrrev_b32 v8, 2, v0
    v_and_b32 v7, 0x3c00, v0
    v_bitop3_b32 v7, v5, v8, v7 bitop3:0xea
    s_waitcnt lgkmcnt(0)
    s_barrier
    ds_read2st64_b32 v[8:9], v7 offset0:0 offset1:1
    ds_read2st64_b32 v[10:11], v7 offset0:2 offset1:3
    s_waitcnt lgkmcnt(0)
    v_lshl_or_b32 v12, v9, 16, v8
    v_lshl_or_b32 v13, v11, 16, v10
    v_mov_b32 v14, v12
    v_mov_b32 v15, v13
    s_nop 0
    v_add_u32_dpp v14, v14, v14 row_shr:1 row_mask:0xf bank_mask:0xf bound_ctrl:1
    v_add_u32_dpp v15, v15, v15 row_shr:1 row_mask:0xf bank_mask:0xf bound_ctrl:1
    s_nop 0
    v_add_u32_dpp v14, v14, v14 row_shr:2 row_mask:0xf bank_mask:0xf bound_ctrl:1
    v_add_u32_dpp v15, v15, v15 row_shr:2 row_mask:0xf bank_mask:0xf bound_ctrl:1
    s_nop 0
    v_add_u32_dpp v14, v14, v14 row_shr:4 row_mask:0xf bank_mask:0xf bound_ctrl:1
    v_add_u32_dpp v15, v15, v15 row_shr:4 row_mask:0xf bank_mask:0xf bound_ctrl:1
    s_nop 0
    v_add_u32_dpp v14, v14, v14 row_shr:8 row_mask:0xf bank_mask:0xf bound_ctrl:1
    v_add_u32_dpp v15, v15, v15 row_shr:8 row_mask:0xf bank_mask:0xf bound_ctrl:1
    s_nop 0
    v_add_u32_dpp v14, v14, v14 row_bcast:15 row_mask:0xa bank_mask:0xf
    v_add_u32_dpp v15, v15, v15 row_bcast:15 row_mask:0xa bank_mask:0xf
    s_nop 0
    v_add_u32_dpp v14, v14, v14 row_bcast:31 row_mask:0xc bank_mask:0xf
    v_add_u32_dpp v15, v15, v15 row_bcast:31 row_mask:0xc bank_mask:0xf
    v_readlane_b32 s48, v14, 63
    v_readlane_b32 s49, v15, 63
    s_lshl_b32 s54, s32, 2
    v_mov_b32 v8, s54
    s_and_b32 s50, s48, 0xffff
    s_lshr_b32 s51, s48, 16
    s_and_b32 s52, s49, 0xffff
    s_lshr_b32 s53, s49, 16
    s_add_u32 s51, s51, s50
    s_add_u32 s52, s52, s51
    s_add_u32 s53, s53, s52
    v_mov_b32 v9, s53
    s_mov_b64 exec, 1
    ds_write_b32 v8, v9 offset:16384
    s_mov_b64 exec, -1
    v_and_b32 v8, 60, v7
    s_waitcnt lgkmcnt(0)
    s_barrier
    ds_read_b32 v9, v8 offset:16384
    s_waitcnt lgkmcnt(0)
    v_add_u32_dpp v9, v9, v9 row_shr:1 row_mask:0xf bank_mask:0xf bound_ctrl:1
    s_nop 1
    v_add_u32_dpp v9, v9, v9 row_shr:2 row_mask:0xf bank_mask:0xf bound_ctrl:1
    s_nop 1
    v_add_u32_dpp v9, v9, v9 row_shr:4 row_mask:0xf bank_mask:0xf bound_ctrl:1
    s_nop 1
    v_add_u32_dpp v9, v9, v9 row_shr:8 row_mask:0xf bank_mask:0xf bound_ctrl:1
    s_nop 0
    v_readlane_b32 s54, v9, s32
    s_sub_u32 s54, s54, s53
    s_add_u32 s50, s50, s54
    s_add_u32 s51, s51, s54
    s_add_u32 s52, s52, s54
    s_pack_ll_b32_b16 s48, s54, s50
    s_pack_ll_b32_b16 s49, s51, s52
    v_add_u32 v14, s48, v14
    v_add_u32 v15, s49, v15
    v_sub_u32 v12, v14, v12
    v_sub_u32 v13, v15, v13
    v_and_b32 v8, 0xffff, v12
    v_lshrrev_b32 v9, 16, v12
    v_and_b32 v10, 0xffff, v13
    v_lshrrev_b32 v11, 16, v13
    ds_write2st64_b32 v7, v8, v9 offset0:0 offset1:1
    ds_write2st64_b32 v7, v10, v11 offset0:2 offset1:3
    s_waitcnt lgkmcnt(0)
    s_barrier
    ds_add_rtn_u32 v120, v120, v2
    ds_add_rtn_u32 v121, v121, v2
    ds_add_rtn_u32 v122, v122, v2
    ds_add_rtn_u32 v123, v123, v2
    s_add_u32 s44, s36, 0x7ef400
    buffer_store_dwordx2 v[12:13], v1, s[24:27], s44 offen
    s_bitset0_b64 exec, 63
    s_not_b64 exec, exec
    buffer_store_dwordx2 v[14:15], v1, s[24:27], s44 offen offset:8
    s_mov_b64 exec, -1
    ds_add_rtn_u32 v20, v20, v2
    ds_add_rtn_u32 v21, v21, v2
    ds_add_rtn_u32 v22, v22, v2
    ds_add_rtn_u32 v23, v23, v2
    ds_add_rtn_u32 v32, v32, v2
    ds_add_rtn_u32 v33, v33, v2
    ds_add_rtn_u32 v34, v34, v2
    ds_add_rtn_u32 v35, v35, v2
    ds_add_rtn_u32 v40, v40, v2
    ds_add_rtn_u32 v41, v41, v2
    ds_add_rtn_u32 v42, v42, v2
    ds_add_rtn_u32 v43, v43, v2
    ds_add_rtn_u32 v52, v52, v2
    ds_add_rtn_u32 v53, v53, v2
    ds_add_rtn_u32 v54, v54, v2
    ds_add_rtn_u32 v55, v55, v2
    ds_add_rtn_u32 v60, v60, v2
    ds_add_rtn_u32 v61, v61, v2
    ds_add_rtn_u32 v62, v62, v2
    ds_add_rtn_u32 v63, v63, v2
    ds_add_rtn_u32 v72, v72, v2
    ds_add_rtn_u32 v73, v73, v2
    ds_add_rtn_u32 v74, v74, v2
    ds_add_rtn_u32 v75, v75, v2
    ds_add_rtn_u32 v80, v80, v2
    ds_add_rtn_u32 v81, v81, v2
    ds_add_rtn_u32 v82, v82, v2
    ds_add_rtn_u32 v83, v83, v2
    s_waitcnt lgkmcnt(0)
    s_barrier
    v_and_b32 v7, -4, v120
    v_lshl_add_u32 v8, v120, 2, v7
    ds_write_b32 v8, v116
    v_lshl_add_u32 v7, v7, 2, v120
    ds_write_b8 v7, v104 offset:16
    v_and_b32 v9, -4, v121
    v_lshl_add_u32 v10, v121, 2, v9
    ds_write_b32 v10, v117
    v_lshl_add_u32 v9, v9, 2, v121
    ds_write_b8_d16_hi v9, v104 offset:16
    v_and_b32 v7, -4, v122
    v_lshl_add_u32 v8, v122, 2, v7
    ds_write_b32 v8, v118
    v_lshl_add_u32 v7, v7, 2, v122
    ds_write_b8 v7, v105 offset:16
    v_and_b32 v9, -4, v123
    v_lshl_add_u32 v10, v123, 2, v9
    ds_write_b32 v10, v119
    v_lshl_add_u32 v9, v9, 2, v123
    ds_write_b8_d16_hi v9, v105 offset:16
    v_and_b32 v7, -4, v20
    v_lshl_add_u32 v8, v20, 2, v7
    ds_write_b32 v8, v16
    v_lshl_add_u32 v7, v7, 2, v20
    ds_write_b8 v7, v106 offset:16
    v_and_b32 v9, -4, v21
    v_lshl_add_u32 v10, v21, 2, v9
    ds_write_b32 v10, v17
    v_lshl_add_u32 v9, v9, 2, v21
    ds_write_b8_d16_hi v9, v106 offset:16
    v_and_b32 v7, -4, v22
    v_lshl_add_u32 v8, v22, 2, v7
    ds_write_b32 v8, v18
    v_lshl_add_u32 v7, v7, 2, v22
    ds_write_b8 v7, v107 offset:16
    v_and_b32 v9, -4, v23
    v_lshl_add_u32 v10, v23, 2, v9
    ds_write_b32 v10, v19
    v_lshl_add_u32 v9, v9, 2, v23
    ds_write_b8_d16_hi v9, v107 offset:16
    v_and_b32 v7, -4, v32
    v_lshl_add_u32 v8, v32, 2, v7
    ds_write_b32 v8, v28
    v_lshl_add_u32 v7, v7, 2, v32
    ds_write_b8 v7, v124 offset:16
    v_and_b32 v9, -4, v33
    v_lshl_add_u32 v10, v33, 2, v9
    ds_write_b32 v10, v29
    v_lshl_add_u32 v9, v9, 2, v33
    ds_write_b8_d16_hi v9, v124 offset:16
    v_and_b32 v7, -4, v34
    v_lshl_add_u32 v8, v34, 2, v7
    ds_write_b32 v8, v30
    v_lshl_add_u32 v7, v7, 2, v34
    ds_write_b8 v7, v125 offset:16
    v_and_b32 v9, -4, v35
    v_lshl_add_u32 v10, v35, 2, v9
    ds_write_b32 v10, v31
    v_lshl_add_u32 v9, v9, 2, v35
    ds_write_b8_d16_hi v9, v125 offset:16
    v_and_b32 v7, -4, v40
    v_lshl_add_u32 v8, v40, 2, v7
    ds_write_b32 v8, v36
    v_lshl_add_u32 v7, v7, 2, v40
    ds_write_b8 v7, v126 offset:16
    v_and_b32 v9, -4, v41
    v_lshl_add_u32 v10, v41, 2, v9
    ds_write_b32 v10, v37
    v_lshl_add_u32 v9, v9, 2, v41
    ds_write_b8_d16_hi v9, v126 offset:16
    v_and_b32 v7, -4, v42
    v_lshl_add_u32 v8, v42, 2, v7
    ds_write_b32 v8, v38
    v_lshl_add_u32 v7, v7, 2, v42
    ds_write_b8 v7, v127 offset:16
    v_and_b32 v9, -4, v43
    v_lshl_add_u32 v10, v43, 2, v9
    ds_write_b32 v10, v39
    v_lshl_add_u32 v9, v9, 2, v43
    ds_write_b8_d16_hi v9, v127 offset:16
    v_and_b32 v7, -4, v52
    v_lshl_add_u32 v8, v52, 2, v7
    ds_write_b32 v8, v48
    v_lshl_add_u32 v7, v7, 2, v52
    ds_write_b8 v7, v24 offset:16
    v_and_b32 v9, -4, v53
    v_lshl_add_u32 v10, v53, 2, v9
    ds_write_b32 v10, v49
    v_lshl_add_u32 v9, v9, 2, v53
    ds_write_b8_d16_hi v9, v24 offset:16
    v_and_b32 v7, -4, v54
    v_lshl_add_u32 v8, v54, 2, v7
    ds_write_b32 v8, v50
    v_lshl_add_u32 v7, v7, 2, v54
    ds_write_b8 v7, v25 offset:16
    v_and_b32 v9, -4, v55
    v_lshl_add_u32 v10, v55, 2, v9
    ds_write_b32 v10, v51
    v_lshl_add_u32 v9, v9, 2, v55
    ds_write_b8_d16_hi v9, v25 offset:16
    v_and_b32 v7, -4, v60
    v_lshl_add_u32 v8, v60, 2, v7
    ds_write_b32 v8, v56
    v_lshl_add_u32 v7, v7, 2, v60
    ds_write_b8 v7, v26 offset:16
    v_and_b32 v9, -4, v61
    v_lshl_add_u32 v10, v61, 2, v9
    ds_write_b32 v10, v57
    v_lshl_add_u32 v9, v9, 2, v61
    ds_write_b8_d16_hi v9, v26 offset:16
    v_and_b32 v7, -4, v62
    v_lshl_add_u32 v8, v62, 2, v7
    ds_write_b32 v8, v58
    v_lshl_add_u32 v7, v7, 2, v62
    ds_write_b8 v7, v27 offset:16
    v_and_b32 v9, -4, v63
    v_lshl_add_u32 v10, v63, 2, v9
    ds_write_b32 v10, v59
    v_lshl_add_u32 v9, v9, 2, v63
    ds_write_b8_d16_hi v9, v27 offset:16
    v_and_b32 v7, -4, v72
    v_lshl_add_u32 v8, v72, 2, v7
    ds_write_b32 v8, v68
    v_lshl_add_u32 v7, v7, 2, v72
    ds_write_b8 v7, v44 offset:16
    v_and_b32 v9, -4, v73
    v_lshl_add_u32 v10, v73, 2, v9
    ds_write_b32 v10, v69
    v_lshl_add_u32 v9, v9, 2, v73
    ds_write_b8_d16_hi v9, v44 offset:16
    v_and_b32 v7, -4, v74
    v_lshl_add_u32 v8, v74, 2, v7
    ds_write_b32 v8, v70
    v_lshl_add_u32 v7, v7, 2, v74
    ds_write_b8 v7, v45 offset:16
    v_and_b32 v9, -4, v75
    v_lshl_add_u32 v10, v75, 2, v9
    ds_write_b32 v10, v71
    v_lshl_add_u32 v9, v9, 2, v75
    ds_write_b8_d16_hi v9, v45 offset:16
    v_and_b32 v7, -4, v80
    v_lshl_add_u32 v8, v80, 2, v7
    ds_write_b32 v8, v76
    v_lshl_add_u32 v7, v7, 2, v80
    ds_write_b8 v7, v46 offset:16
    v_and_b32 v9, -4, v81
    v_lshl_add_u32 v10, v81, 2, v9
    ds_write_b32 v10, v77
    v_lshl_add_u32 v9, v9, 2, v81
    ds_write_b8_d16_hi v9, v46 offset:16
    v_and_b32 v7, -4, v82
    v_lshl_add_u32 v8, v82, 2, v7
    ds_write_b32 v8, v78
    v_lshl_add_u32 v7, v7, 2, v82
    ds_write_b8 v7, v47 offset:16
    v_and_b32 v9, -4, v83
    v_lshl_add_u32 v10, v83, 2, v9
    ds_write_b32 v10, v79
    v_lshl_add_u32 v9, v9, 2, v83
    ds_write_b8_d16_hi v9, v47 offset:16
    v_add_u32 v7, 0x10000, v0
    v_add_u32 v12, 0x20000, v0
    s_waitcnt lgkmcnt(0)
    s_barrier
    ds_read_b128 v[88:91], v0 offset:0
    ds_read_b128 v[92:95], v0 offset:16384
    ds_read_b128 v[64:67], v0 offset:32768
    ds_read_b128 v[96:99], v0 offset:49152
    ds_read_b128 v[100:103], v7 offset:0
    ds_read_b128 v[108:111], v7 offset:16384
    ds_read_b128 v[112:115], v7 offset:32768
    ds_read_b128 v[84:87], v7 offset:49152
    ds_read_b128 v[116:119], v12 offset:0
    ds_read_b128 v[120:123], v12 offset:16384
    s_waitcnt lgkmcnt(9)
    s_add_u32 s45, s35, 0x9c40000
    buffer_store_dwordx4 v[88:91], v0, s[20:23], s45 offen sc1
    s_waitcnt lgkmcnt(8)
    s_add_u32 s46, s35, 0x9c44000
    buffer_store_dwordx4 v[92:95], v0, s[20:23], s46 offen sc1
    s_waitcnt lgkmcnt(7)
    s_add_u32 s47, s35, 0x9c48000
    buffer_store_dwordx4 v[64:67], v0, s[20:23], s47 offen sc1
    s_waitcnt lgkmcnt(6)
    s_add_u32 s44, s35, 0x9c4c000
    buffer_store_dwordx4 v[96:99], v0, s[20:23], s44 offen sc1
    s_waitcnt lgkmcnt(5)
    s_add_u32 s45, s35, 0x9c50000
    buffer_store_dwordx4 v[100:103], v0, s[20:23], s45 offen sc1
    s_waitcnt lgkmcnt(4)
    s_add_u32 s46, s35, 0x9c54000
    buffer_store_dwordx4 v[108:111], v0, s[20:23], s46 offen sc1
    s_waitcnt lgkmcnt(3)
    s_add_u32 s47, s35, 0x9c58000
    buffer_store_dwordx4 v[112:115], v0, s[20:23], s47 offen sc1
    s_waitcnt lgkmcnt(2)
    s_add_u32 s44, s35, 0x9c5c000
    buffer_store_dwordx4 v[84:87], v0, s[20:23], s44 offen sc1
    s_waitcnt lgkmcnt(1)
    s_add_u32 s45, s35, 0x9c60000
    buffer_store_dwordx4 v[116:119], v0, s[20:23], s45 offen sc1
    s_waitcnt lgkmcnt(0)
    s_add_u32 s46, s35, 0x9c64000
    buffer_store_dwordx4 v[120:123], v0, s[20:23], s46 offen sc1
L1_end:
    s_endpgm
L1_md:
    s_load_dwordx2 s[52:53], s[0:1], 0
    s_load_dwordx4 s[36:39], s[0:1], 56
    s_load_dwordx4 s[40:43], s[0:1], 72
    s_waitcnt lgkmcnt(0)
    s_mov_b32 s8, s52
    s_mov_b32 s9, s53
    s_mov_b32 s10, 0x4e2000
    s_mov_b32 s11, 0x20000
    s_add_u32 s12, s30, 0xcd3b100
    s_addc_u32 s13, s31, 0
    s_mov_b32 s14, 0x4e2000
    s_mov_b32 s15, 0x20000
    s_mov_b32 s16, s40
    s_mov_b32 s17, s41
    s_mov_b32 s18, 0x20
    s_mov_b32 s19, 0x20000
    s_mov_b32 s20, s38
    s_mov_b32 s21, s39
    s_mov_b32 s22, 0x40
    s_mov_b32 s23, 0x20000
    s_mov_b32 s24, s36
    s_mov_b32 s25, s37
    s_mov_b32 s26, 0x40
    s_mov_b32 s27, 0x20000
    s_mov_b32 s44, s42
    s_mov_b32 s45, s43
    s_mov_b32 s46, 0x20
    s_mov_b32 s47, 0x20000
    s_add_u32 s48, s30, 0xe5a6100
    s_addc_u32 s49, s31, 0
    s_mov_b32 s50, 0x100
    s_mov_b32 s51, 0x20000
    v_and_b32 v1, 3, v0
    v_lshlrev_b32 v2, 1, v1
    v_mov_b32 v4, 0
    v_mov_b32 v5, 0
    v_mov_b32 v6, 0
    v_mov_b32 v7, 0
    v_mov_b32 v8, 0
    v_mov_b32 v9, 0
    v_mov_b32 v10, 0
    v_mov_b32 v11, 0
    v_mov_b32 v12, 0
    v_mov_b32 v13, 0
    v_mov_b32 v14, 0
    v_mov_b32 v15, 0
    v_mov_b32 v16, 0
    v_mov_b32 v17, 0
    v_mov_b32 v18, 0
    v_mov_b32 v19, 0
    buffer_load_short_d16 v4, v2, s[16:19], 0 offen offset:0
    buffer_load_short_d16_hi v4, v2, s[16:19], 0 offen offset:8
    buffer_load_short_d16 v5, v2, s[16:19], 0 offen offset:16
    buffer_load_short_d16_hi v5, v2, s[16:19], 0 offen offset:24
    buffer_load_short_d16 v8, v2, s[20:23], 0 offen offset:0
    buffer_load_short_d16_hi v8, v2, s[20:23], 0 offen offset:8
    buffer_load_short_d16 v9, v2, s[20:23], 0 offen offset:16
    buffer_load_short_d16_hi v9, v2, s[20:23], 0 offen offset:24
    buffer_load_short_d16 v10, v2, s[20:23], 0 offen offset:32
    buffer_load_short_d16_hi v10, v2, s[20:23], 0 offen offset:40
    buffer_load_short_d16 v11, v2, s[20:23], 0 offen offset:48
    buffer_load_short_d16_hi v11, v2, s[20:23], 0 offen offset:56
    buffer_load_short_d16 v12, v2, s[24:27], 0 offen offset:0
    buffer_load_short_d16_hi v12, v2, s[24:27], 0 offen offset:8
    buffer_load_short_d16 v13, v2, s[24:27], 0 offen offset:16
    buffer_load_short_d16_hi v13, v2, s[24:27], 0 offen offset:24
    buffer_load_short_d16 v14, v2, s[24:27], 0 offen offset:32
    buffer_load_short_d16_hi v14, v2, s[24:27], 0 offen offset:40
    buffer_load_short_d16 v15, v2, s[24:27], 0 offen offset:48
    buffer_load_short_d16_hi v15, v2, s[24:27], 0 offen offset:56
    buffer_load_short_d16 v16, v2, s[44:47], 0 offen offset:0
    buffer_load_short_d16_hi v16, v2, s[44:47], 0 offen offset:8
    buffer_load_short_d16 v17, v2, s[44:47], 0 offen offset:16
    buffer_load_short_d16_hi v17, v2, s[44:47], 0 offen offset:24
    v_lshlrev_b32 v3, 6, v0
    s_waitcnt vmcnt(0)
    buffer_store_dwordx4 v[8:11], v3, s[48:51], 0 offen
    buffer_store_dwordx4 v[12:15], v3, s[48:51], 0 offen offset:16
    buffer_store_dwordx4 v[16:19], v3, s[48:51], 0 offen offset:32
    v_lshrrev_b32 v1, 4, v0
    v_and_b32 v2, 15, v0
    v_lshlrev_b32 v6, 9, v2
    v_lshl_add_u32 v6, v1, 3, v6
    s_mov_b32 s33, 80000
    v_mul_lo_u32 v7, v1, s33
    v_lshl_add_u32 v7, v2, 3, v7
    s_sub_u32 s32, s2, 250
L1_mdloop:
    s_mul_i32 s33, s32, 204800
    s_mul_i32 s34, s32, 3200
    buffer_load_dwordx2 v[20:21], v6, s[8:11], s33 offen
    s_add_u32 s33, s33, 8192
    buffer_load_dwordx2 v[22:23], v6, s[8:11], s33 offen
    s_add_u32 s33, s33, 8192
    buffer_load_dwordx2 v[24:25], v6, s[8:11], s33 offen
    s_add_u32 s33, s33, 8192
    buffer_load_dwordx2 v[26:27], v6, s[8:11], s33 offen
    s_add_u32 s33, s33, 8192
    buffer_load_dwordx2 v[28:29], v6, s[8:11], s33 offen
    s_add_u32 s33, s33, 8192
    buffer_load_dwordx2 v[30:31], v6, s[8:11], s33 offen
    s_add_u32 s33, s33, 8192
    buffer_load_dwordx2 v[32:33], v6, s[8:11], s33 offen
    s_add_u32 s33, s33, 8192
    buffer_load_dwordx2 v[34:35], v6, s[8:11], s33 offen
    s_add_u32 s33, s33, 8192
    buffer_load_dwordx2 v[36:37], v6, s[8:11], s33 offen
    s_add_u32 s33, s33, 8192
    buffer_load_dwordx2 v[38:39], v6, s[8:11], s33 offen
    s_add_u32 s33, s33, 8192
    buffer_load_dwordx2 v[40:41], v6, s[8:11], s33 offen
    s_add_u32 s33, s33, 8192
    buffer_load_dwordx2 v[42:43], v6, s[8:11], s33 offen
    s_add_u32 s33, s33, 8192
    buffer_load_dwordx2 v[44:45], v6, s[8:11], s33 offen
    s_add_u32 s33, s33, 8192
    buffer_load_dwordx2 v[46:47], v6, s[8:11], s33 offen
    s_add_u32 s33, s33, 8192
    buffer_load_dwordx2 v[48:49], v6, s[8:11], s33 offen
    s_add_u32 s33, s33, 8192
    buffer_load_dwordx2 v[50:51], v6, s[8:11], s33 offen
    s_add_u32 s33, s33, 8192
    buffer_load_dwordx2 v[52:53], v6, s[8:11], s33 offen
    s_add_u32 s33, s33, 8192
    buffer_load_dwordx2 v[54:55], v6, s[8:11], s33 offen
    s_add_u32 s33, s33, 8192
    buffer_load_dwordx2 v[56:57], v6, s[8:11], s33 offen
    s_add_u32 s33, s33, 8192
    buffer_load_dwordx2 v[58:59], v6, s[8:11], s33 offen
    s_add_u32 s33, s33, 8192
    buffer_load_dwordx2 v[60:61], v6, s[8:11], s33 offen
    s_add_u32 s33, s33, 8192
    buffer_load_dwordx2 v[62:63], v6, s[8:11], s33 offen
    s_add_u32 s33, s33, 8192
    buffer_load_dwordx2 v[64:65], v6, s[8:11], s33 offen
    s_add_u32 s33, s33, 8192
    buffer_load_dwordx2 v[66:67], v6, s[8:11], s33 offen
    s_add_u32 s33, s33, 8192
    buffer_load_dwordx2 v[68:69], v6, s[8:11], s33 offen
    s_add_u32 s33, s33, 8192
    s_waitcnt vmcnt(24)
    v_mfma_f32_4x4x4_16b_bf16 v[72:75], v[4:5], v[20:21], 0
    s_nop 4
    v_cvt_pk_bf16_f32 v20, v72, v73
    v_cvt_pk_bf16_f32 v21, v74, v75
    buffer_store_dwordx2 v[20:21], v7, s[12:15], s34 offen offset:0
    s_waitcnt vmcnt(24)
    v_mfma_f32_4x4x4_16b_bf16 v[76:79], v[4:5], v[22:23], 0
    s_nop 4
    v_cvt_pk_bf16_f32 v22, v76, v77
    v_cvt_pk_bf16_f32 v23, v78, v79
    buffer_store_dwordx2 v[22:23], v7, s[12:15], s34 offen offset:128
    s_waitcnt vmcnt(24)
    v_mfma_f32_4x4x4_16b_bf16 v[80:83], v[4:5], v[24:25], 0
    s_nop 4
    v_cvt_pk_bf16_f32 v24, v80, v81
    v_cvt_pk_bf16_f32 v25, v82, v83
    buffer_store_dwordx2 v[24:25], v7, s[12:15], s34 offen offset:256
    s_waitcnt vmcnt(24)
    v_mfma_f32_4x4x4_16b_bf16 v[84:87], v[4:5], v[26:27], 0
    s_nop 4
    v_cvt_pk_bf16_f32 v26, v84, v85
    v_cvt_pk_bf16_f32 v27, v86, v87
    buffer_store_dwordx2 v[26:27], v7, s[12:15], s34 offen offset:384
    s_waitcnt vmcnt(24)
    v_mfma_f32_4x4x4_16b_bf16 v[72:75], v[4:5], v[28:29], 0
    s_nop 4
    v_cvt_pk_bf16_f32 v28, v72, v73
    v_cvt_pk_bf16_f32 v29, v74, v75
    buffer_store_dwordx2 v[28:29], v7, s[12:15], s34 offen offset:512
    s_waitcnt vmcnt(24)
    v_mfma_f32_4x4x4_16b_bf16 v[76:79], v[4:5], v[30:31], 0
    s_nop 4
    v_cvt_pk_bf16_f32 v30, v76, v77
    v_cvt_pk_bf16_f32 v31, v78, v79
    buffer_store_dwordx2 v[30:31], v7, s[12:15], s34 offen offset:640
    s_waitcnt vmcnt(24)
    v_mfma_f32_4x4x4_16b_bf16 v[80:83], v[4:5], v[32:33], 0
    s_nop 4
    v_cvt_pk_bf16_f32 v32, v80, v81
    v_cvt_pk_bf16_f32 v33, v82, v83
    buffer_store_dwordx2 v[32:33], v7, s[12:15], s34 offen offset:768
    s_waitcnt vmcnt(24)
    v_mfma_f32_4x4x4_16b_bf16 v[84:87], v[4:5], v[34:35], 0
    s_nop 4
    v_cvt_pk_bf16_f32 v34, v84, v85
    v_cvt_pk_bf16_f32 v35, v86, v87
    buffer_store_dwordx2 v[34:35], v7, s[12:15], s34 offen offset:896
    s_waitcnt vmcnt(24)
    v_mfma_f32_4x4x4_16b_bf16 v[72:75], v[4:5], v[36:37], 0
    s_nop 4
    v_cvt_pk_bf16_f32 v36, v72, v73
    v_cvt_pk_bf16_f32 v37, v74, v75
    buffer_store_dwordx2 v[36:37], v7, s[12:15], s34 offen offset:1024
    s_waitcnt vmcnt(24)
    v_mfma_f32_4x4x4_16b_bf16 v[76:79], v[4:5], v[38:39], 0
    s_nop 4
    v_cvt_pk_bf16_f32 v38, v76, v77
    v_cvt_pk_bf16_f32 v39, v78, v79
    buffer_store_dwordx2 v[38:39], v7, s[12:15], s34 offen offset:1152
    s_waitcnt vmcnt(24)
    v_mfma_f32_4x4x4_16b_bf16 v[80:83], v[4:5], v[40:41], 0
    s_nop 4
    v_cvt_pk_bf16_f32 v40, v80, v81
    v_cvt_pk_bf16_f32 v41, v82, v83
    buffer_store_dwordx2 v[40:41], v7, s[12:15], s34 offen offset:1280
    s_waitcnt vmcnt(24)
    v_mfma_f32_4x4x4_16b_bf16 v[84:87], v[4:5], v[42:43], 0
    s_nop 4
    v_cvt_pk_bf16_f32 v42, v84, v85
    v_cvt_pk_bf16_f32 v43, v86, v87
    buffer_store_dwordx2 v[42:43], v7, s[12:15], s34 offen offset:1408
    s_waitcnt vmcnt(24)
    v_mfma_f32_4x4x4_16b_bf16 v[72:75], v[4:5], v[44:45], 0
    s_nop 4
    v_cvt_pk_bf16_f32 v44, v72, v73
    v_cvt_pk_bf16_f32 v45, v74, v75
    buffer_store_dwordx2 v[44:45], v7, s[12:15], s34 offen offset:1536
    s_waitcnt vmcnt(24)
    v_mfma_f32_4x4x4_16b_bf16 v[76:79], v[4:5], v[46:47], 0
    s_nop 4
    v_cvt_pk_bf16_f32 v46, v76, v77
    v_cvt_pk_bf16_f32 v47, v78, v79
    buffer_store_dwordx2 v[46:47], v7, s[12:15], s34 offen offset:1664
    s_waitcnt vmcnt(24)
    v_mfma_f32_4x4x4_16b_bf16 v[80:83], v[4:5], v[48:49], 0
    s_nop 4
    v_cvt_pk_bf16_f32 v48, v80, v81
    v_cvt_pk_bf16_f32 v49, v82, v83
    buffer_store_dwordx2 v[48:49], v7, s[12:15], s34 offen offset:1792
    s_waitcnt vmcnt(24)
    v_mfma_f32_4x4x4_16b_bf16 v[84:87], v[4:5], v[50:51], 0
    s_nop 4
    v_cvt_pk_bf16_f32 v50, v84, v85
    v_cvt_pk_bf16_f32 v51, v86, v87
    buffer_store_dwordx2 v[50:51], v7, s[12:15], s34 offen offset:1920
    s_waitcnt vmcnt(24)
    v_mfma_f32_4x4x4_16b_bf16 v[72:75], v[4:5], v[52:53], 0
    s_nop 4
    v_cvt_pk_bf16_f32 v52, v72, v73
    v_cvt_pk_bf16_f32 v53, v74, v75
    buffer_store_dwordx2 v[52:53], v7, s[12:15], s34 offen offset:2048
    s_waitcnt vmcnt(24)
    v_mfma_f32_4x4x4_16b_bf16 v[76:79], v[4:5], v[54:55], 0
    s_nop 4
    v_cvt_pk_bf16_f32 v54, v76, v77
    v_cvt_pk_bf16_f32 v55, v78, v79
    buffer_store_dwordx2 v[54:55], v7, s[12:15], s34 offen offset:2176
    s_waitcnt vmcnt(24)
    v_mfma_f32_4x4x4_16b_bf16 v[80:83], v[4:5], v[56:57], 0
    s_nop 4
    v_cvt_pk_bf16_f32 v56, v80, v81
    v_cvt_pk_bf16_f32 v57, v82, v83
    buffer_store_dwordx2 v[56:57], v7, s[12:15], s34 offen offset:2304
    s_waitcnt vmcnt(24)
    v_mfma_f32_4x4x4_16b_bf16 v[84:87], v[4:5], v[58:59], 0
    s_nop 4
    v_cvt_pk_bf16_f32 v58, v84, v85
    v_cvt_pk_bf16_f32 v59, v86, v87
    buffer_store_dwordx2 v[58:59], v7, s[12:15], s34 offen offset:2432
    s_waitcnt vmcnt(24)
    v_mfma_f32_4x4x4_16b_bf16 v[72:75], v[4:5], v[60:61], 0
    s_nop 4
    v_cvt_pk_bf16_f32 v60, v72, v73
    v_cvt_pk_bf16_f32 v61, v74, v75
    buffer_store_dwordx2 v[60:61], v7, s[12:15], s34 offen offset:2560
    s_waitcnt vmcnt(24)
    v_mfma_f32_4x4x4_16b_bf16 v[76:79], v[4:5], v[62:63], 0
    s_nop 4
    v_cvt_pk_bf16_f32 v62, v76, v77
    v_cvt_pk_bf16_f32 v63, v78, v79
    buffer_store_dwordx2 v[62:63], v7, s[12:15], s34 offen offset:2688
    s_waitcnt vmcnt(24)
    v_mfma_f32_4x4x4_16b_bf16 v[80:83], v[4:5], v[64:65], 0
    s_nop 4
    v_cvt_pk_bf16_f32 v64, v80, v81
    v_cvt_pk_bf16_f32 v65, v82, v83
    buffer_store_dwordx2 v[64:65], v7, s[12:15], s34 offen offset:2816
    s_waitcnt vmcnt(24)
    v_mfma_f32_4x4x4_16b_bf16 v[84:87], v[4:5], v[66:67], 0
    s_nop 4
    v_cvt_pk_bf16_f32 v66, v84, v85
    v_cvt_pk_bf16_f32 v67, v86, v87
    buffer_store_dwordx2 v[66:67], v7, s[12:15], s34 offen offset:2944
    s_waitcnt vmcnt(24)
    v_mfma_f32_4x4x4_16b_bf16 v[72:75], v[4:5], v[68:69], 0
    s_nop 4
    v_cvt_pk_bf16_f32 v68, v72, v73
    v_cvt_pk_bf16_f32 v69, v74, v75
    buffer_store_dwordx2 v[68:69], v7, s[12:15], s34 offen offset:3072
    s_waitcnt vmcnt(0)
    s_add_u32 s32, s32, 6
    s_cmp_lt_u32 s32, 25
    s_cbranch_scc1 L1_mdloop
    s_endpgm
.text
.globl gs_acc_kernel
.p2align 8
.type gs_acc_kernel,@function
gs_acc_kernel:
    s_cmp_ge_u32 s2, 256
    s_cbranch_scc1 L2_end
    s_load_dwordx2 s[30:31], s[0:1], 104
    v_lshrrev_b32 v16, 6, v0
    v_and_b32 v17, 63, v0
    v_readfirstlane_b32 s32, v16
    s_bfe_u32 s33, s2, 0x20001
    s_and_b32 s34, s2, 1
    s_lshl_b32 s34, s34, 5
    s_lshr_b32 s3, s2, 3
    s_add_u32 s34, s34, s3
    v_lshlrev_b32 v1, 2, v17
    v_and_b32 v2, 12, v1
    v_sub_u32 v3, 16, v2
    v_and_b32 v18, 0xf0, v1
    v_add_u32 v18, v18, v16
    s_mov_b32 s3, 163840
    v_mul_lo_u32 v4, v18, s3
    v_or_b32 v4, 0xf0000000, v4
    v_mul_u32_u24 v5, 8320, v18
    v_mul_u32_u24 v6, 5120, v16
    v_lshl_add_u32 v6, v17, 4, v6
    v_add_u32 v7, 80000, v6
    v_and_b32 v18, 3, v0
    v_lshlrev_b32 v18, 4, v18
    v_mov_b32 v12, 0x3f80
    v_mov_b32 v13, 0
    v_lshlrev_b64 v[12:13], v18, v[12:13]
    v_and_b32 v18, 3, v0
    v_lshlrev_b32 v18, 4, v18
    v_mov_b32 v14, 0xbf80
    v_mov_b32 v15, 0
    v_lshlrev_b64 v[14:15], v18, v[14:15]
    v_lshlrev_b32 v0, 4, v0
    v_mov_b32 v8, 0x1fff8
    v_mov_b32 v9, 0x07ff0000
    v_mov_b32 v10, 0x38000000
    v_mov_b32 v11, 0x80000000
    s_mov_b32 s44, 0x4000c0c
    s_mov_b32 s45, 0x4010c0c
    s_mov_b32 s46, 0x4020c0c
    s_mov_b32 s47, 0x4030c0c
    s_mul_i32 s38, s32, 1280
    s_add_u32 s38, s38, 20000
    s_mul_i32 s39, s33, 2080
    s_lshl_b32 s3, s34, 3
    s_add_u32 s39, s39, s3
    s_mul_i32 s40, s33, 1280000
    s_mov_b32 s36, 0
    s_mov_b32 s35, 0
    s_mov_b32 s42, 0
    s_waitcnt lgkmcnt(0)
    s_mov_b32 s8, s30
    s_mov_b32 s9, s31
    s_mov_b32 s10, 0xc350000
    s_mov_b32 s11, 0x20000
    s_add_u32 s12, s30, 0xc350000
    s_addc_u32 s13, s31, 0
    s_mov_b32 s14, 0x9eb100
    s_mov_b32 s15, 0x20000
    s_add_u32 s24, s30, 0xc350000
    s_addc_u32 s25, s31, 0
    s_mov_b32 s26, 0x9eb100
    s_mov_b32 s27, 0x20000
    s_add_u32 s16, s30, 0xcd3b100
    s_addc_u32 s17, s31, 0
    s_mov_b32 s18, 0x4e2000
    s_mov_b32 s19, 0x20000
    s_add_u32 s20, s30, 0xd21e100
    s_addc_u32 s21, s31, 0
    s_mov_b32 s22, 0x13880
    s_mov_b32 s23, 0x20000
    s_lshl_b32 s3, s33, 6
    s_add_u32 s3, s3, s34
    s_mul_i32 s3, s3, 80000
    s_add_u32 s20, s20, s3
    s_addc_u32 s21, s21, 0
    buffer_load_dwordx4 v[64:67], v5, s[12:15], s39 offen
    v_add_u32 v111, 0x208000, v5
    buffer_load_dwordx4 v[68:71], v111, s[12:15], s39 offen
    v_add_u32 v112, 0x410000, v5
    buffer_load_dwordx4 v[72:75], v112, s[12:15], s39 offen
    v_add_u32 v113, 0x618000, v5
    buffer_load_dwordx4 v[76:79], v113, s[12:15], s39 offen
    v_add_u32 v114, 0x820000, v5
    buffer_load_dwordx4 v[80:83], v114, s[12:15], s39 offen
    buffer_load_dwordx4 v[44:47], v6, s[16:19], s40 offen offset:0
    buffer_load_dwordx4 v[48:51], v6, s[16:19], s40 offen offset:1024
    buffer_load_dwordx4 v[52:55], v6, s[16:19], s40 offen offset:2048
    buffer_load_dwordx4 v[56:59], v6, s[16:19], s40 offen offset:3072
    s_add_u32 s3, s40, 4096
    buffer_load_dwordx4 v[60:63], v6, s[16:19], s3 offen
    s_add_u32 s40, s40, 80000
    v_mov_b32 v92, 0
    v_mov_b32 v93, 0
    v_mov_b32 v94, 0
    v_mov_b32 v95, 0
    ds_write_b128 v0, v[92:95] offset:0
    ds_write_b128 v0, v[92:95] offset:16384
    ds_write_b128 v0, v[92:95] offset:32768
    ds_write_b128 v0, v[92:95] offset:49152
    v_add_u32 v109, 0x10000, v0
    v_cmp_gt_u32 vcc, 80000, v109
    s_mov_b64 exec, vcc
    ds_write_b128 v109, v[92:95]
    s_mov_b64 exec, -1
    s_waitcnt vmcnt(5)
    s_mov_b32 s37, s38
    s_add_u32 s48, s38, 257
    v_and_b32 v110, 0xffff, v64
    v_and_b32 v111, 0xffff, v66
    v_and_b32 v112, -4, v110
    v_add_u32 v112, v112, v2
L2_x1_0:
    v_sub_u32 v113, v111, v112
    v_sub_u32 v115, v110, v112
    v_med3_i32 v114, v113, 0, 4
    v_max_i32 v115, 0, v115
    v_cmp_gt_i32 vcc, v114, v115
    v_mad_u32_u24 v116, v112, 5, v4
    v_bfm_b32 v114, v114, 28
    v_bfm_b32 v115, v115, 28
    v_mbcnt_lo_u32_b32 v117, vcc_lo, 0
    v_mbcnt_hi_u32_b32 v117, vcc_hi, v117
    v_bitop3_b32 v116, v114, v115, v116 bitop3:0x9a
    v_add_lshl_u32 v117, v117, s37, 2
    s_bcnt1_i32_b64 s41, vcc
    s_mov_b64 exec, vcc
    ds_write_b32 v117, v116
    s_mov_b64 exec, -1
    v_cmp_gt_i32 vcc, v113, v3
    s_add_u32 s37, s37, s41
    s_min_u32 s37, s37, s48
    s_cbranch_vccnz L2_xe1_0
L2_xr1_0:
    v_and_b32 v110, 0xffff, v68
    v_and_b32 v111, 0xffff, v70
    v_and_b32 v112, -4, v110
    v_add_u32 v112, v112, v2
    v_add_u32 v118, 0x2800000, v4
L2_x1_1:
    v_sub_u32 v113, v111, v112
    v_sub_u32 v115, v110, v112
    v_med3_i32 v114, v113, 0, 4
    v_max_i32 v115, 0, v115
    v_cmp_gt_i32 vcc, v114, v115
    v_mad_u32_u24 v116, v112, 5, v118
    v_bfm_b32 v114, v114, 28
    v_bfm_b32 v115, v115, 28
    v_mbcnt_lo_u32_b32 v117, vcc_lo, 0
    v_mbcnt_hi_u32_b32 v117, vcc_hi, v117
    v_bitop3_b32 v116, v114, v115, v116 bitop3:0x9a
    v_add_lshl_u32 v117, v117, s37, 2
    s_bcnt1_i32_b64 s41, vcc
    s_mov_b64 exec, vcc
    ds_write_b32 v117, v116
    s_mov_b64 exec, -1
    v_cmp_gt_i32 vcc, v113, v3
    s_add_u32 s37, s37, s41
    s_min_u32 s37, s37, s48
    s_cbranch_vccnz L2_xe1_1
L2_xr1_1:
    v_and_b32 v110, 0xffff, v72
    v_and_b32 v111, 0xffff, v74
    v_and_b32 v112, -4, v110
    v_add_u32 v112, v112, v2
    v_add_u32 v118, 0x5000000, v4
L2_x1_2:
    v_sub_u32 v113, v111, v112
    v_sub_u32 v115, v110, v112
    v_med3_i32 v114, v113, 0, 4
    v_max_i32 v115, 0, v115
    v_cmp_gt_i32 vcc, v114, v115
    v_mad_u32_u24 v116, v112, 5, v118
    v_bfm_b32 v114, v114, 28
    v_bfm_b32 v115, v115, 28
    v_mbcnt_lo_u32_b32 v117, vcc_lo, 0
    v_mbcnt_hi_u32_b32 v117, vcc_hi, v117
    v_bitop3_b32 v116, v114, v115, v116 bitop3:0x9a
    v_add_lshl_u32 v117, v117, s37, 2
    s_bcnt1_i32_b64 s41, vcc
    s_mov_b64 exec, vcc
    ds_write_b32 v117, v116
    s_mov_b64 exec, -1
    v_cmp_gt_i32 vcc, v113, v3
    s_add_u32 s37, s37, s41
    s_min_u32 s37, s37, s48
    s_cbranch_vccnz L2_xe1_2
L2_xr1_2:
    v_and_b32 v110, 0xffff, v76
    v_and_b32 v111, 0xffff, v78
    v_and_b32 v112, -4, v110
    v_add_u32 v112, v112, v2
    v_add_u32 v118, 0x7800000, v4
L2_x1_3:
    v_sub_u32 v113, v111, v112
    v_sub_u32 v115, v110, v112
    v_med3_i32 v114, v113, 0, 4
    v_max_i32 v115, 0, v115
    v_cmp_gt_i32 vcc, v114, v115
    v_mad_u32_u24 v116, v112, 5, v118
    v_bfm_b32 v114, v114, 28
    v_bfm_b32 v115, v115, 28
    v_mbcnt_lo_u32_b32 v117, vcc_lo, 0
    v_mbcnt_hi_u32_b32 v117, vcc_hi, v117
    v_bitop3_b32 v116, v114, v115, v116 bitop3:0x9a
    v_add_lshl_u32 v117, v117, s37, 2
    s_bcnt1_i32_b64 s41, vcc
    s_mov_b64 exec, vcc
    ds_write_b32 v117, v116
    s_mov_b64 exec, -1
    v_cmp_gt_i32 vcc, v113, v3
    s_add_u32 s37, s37, s41
    s_min_u32 s37, s37, s48
    s_cbranch_vccnz L2_xe1_3
L2_xr1_3:
    v_and_b32 v110, 0xffff, v80
    v_and_b32 v111, 0xffff, v82
    v_and_b32 v112, -4, v110
    v_add_u32 v112, v112, v2
    v_add_u32 v118, 0xa000000, v4
L2_x1_4:
    v_sub_u32 v113, v111, v112
    v_sub_u32 v115, v110, v112
    v_med3_i32 v114, v113, 0, 4
    v_max_i32 v115, 0, v115
    v_cmp_gt_i32 vcc, v114, v115
    v_mad_u32_u24 v116, v112, 5, v118
    v_bfm_b32 v114, v114, 28
    v_bfm_b32 v115, v115, 28
    v_mbcnt_lo_u32_b32 v117, vcc_lo, 0
    v_mbcnt_hi_u32_b32 v117, vcc_hi, v117
    v_bitop3_b32 v116, v114, v115, v116 bitop3:0x9a
    v_add_lshl_u32 v117, v117, s37, 2
    s_bcnt1_i32_b64 s41, vcc
    s_mov_b64 exec, vcc
    ds_write_b32 v117, v116
    s_mov_b64 exec, -1
    v_cmp_gt_i32 vcc, v113, v3
    s_add_u32 s37, s37, s41
    s_min_u32 s37, s37, s48
    s_cbranch_vccnz L2_xe1_4
L2_xr1_4:
    s_lshl_b32 s3, s37, 2
    v_add_u32 v117, s3, v1
    v_mov_b32 v116, -1
    ds_write_b32 v117, v116
    s_lshl_b32 s3, s38, 2
    v_add_u32 v117, s3, v1
    ds_read2st64_b32 v[40:41], v117 offset0:0 offset1:1
    ds_read2st64_b32 v[42:43], v117 offset0:2 offset1:3
    s_sub_u32 s41, s37, s38
    s_sub_u32 s3, s41, 192
    s_cmp_gt_u32 s3, 64
    s_cbranch_scc1 L2_xf1
L2_xg1:
    s_waitcnt lgkmcnt(0)
    v_and_b32 v109, 0x0fffffff, v40
    v_mov_b32 v36, v40
    buffer_load_dwordx4 v[16:19], v109, s[8:11], 0 offen
    buffer_load_dword v32, v109, s[8:11], 0 offen offset:16
    v_and_b32 v109, 0x0fffffff, v41
    v_mov_b32 v37, v41
    buffer_load_dwordx4 v[20:23], v109, s[8:11], 0 offen
    buffer_load_dword v33, v109, s[8:11], 0 offen offset:16
    v_and_b32 v109, 0x0fffffff, v42
    v_mov_b32 v38, v42
    buffer_load_dwordx4 v[24:27], v109, s[8:11], 0 offen
    buffer_load_dword v34, v109, s[8:11], 0 offen offset:16
    v_and_b32 v109, 0x0fffffff, v43
    v_mov_b32 v39, v43
    buffer_load_dwordx4 v[28:31], v109, s[8:11], 0 offen
    buffer_load_dword v35, v109, s[8:11], 0 offen offset:16
    s_waitcnt vmcnt(8)
    s_mov_b32 s37, s38
    s_add_u32 s48, s38, 257
    v_lshrrev_b32 v110, 16, v64
    v_lshrrev_b32 v111, 16, v66
    v_and_b32 v112, -4, v110
    v_add_u32 v112, v112, v2
L2_x2_0:
    v_sub_u32 v113, v111, v112
    v_sub_u32 v115, v110, v112
    v_med3_i32 v114, v113, 0, 4
    v_max_i32 v115, 0, v115
    v_cmp_gt_i32 vcc, v114, v115
    v_mad_u32_u24 v116, v112, 5, v4
    v_bfm_b32 v114, v114, 28
    v_bfm_b32 v115, v115, 28
    v_mbcnt_lo_u32_b32 v117, vcc_lo, 0
    v_mbcnt_hi_u32_b32 v117, vcc_hi, v117
    v_bitop3_b32 v116, v114, v115, v116 bitop3:0x9a
    v_add_lshl_u32 v117, v117, s37, 2
    s_bcnt1_i32_b64 s41, vcc
    s_mov_b64 exec, vcc
    ds_write_b32 v117, v116
    s_mov_b64 exec, -1
    v_cmp_gt_i32 vcc, v113, v3
    s_add_u32 s37, s37, s41
    s_min_u32 s37, s37, s48
    s_cbranch_vccnz L2_xe2_0
L2_xr2_0:
    ds_write_b128 v7, v[52:55] offset:2048
    v_lshrrev_b32 v110, 16, v68
    v_lshrrev_b32 v111, 16, v70
    v_and_b32 v112, -4, v110
    v_add_u32 v112, v112, v2
    v_add_u32 v118, 0x2800000, v4
L2_x2_1:
    v_sub_u32 v113, v111, v112
    v_sub_u32 v115, v110, v112
    v_med3_i32 v114, v113, 0, 4
    v_max_i32 v115, 0, v115
    v_cmp_gt_i32 vcc, v114, v115
    v_mad_u32_u24 v116, v112, 5, v118
    v_bfm_b32 v114, v114, 28
    v_bfm_b32 v115, v115, 28
    v_mbcnt_lo_u32_b32 v117, vcc_lo, 0
    v_mbcnt_hi_u32_b32 v117, vcc_hi, v117
    v_bitop3_b32 v116, v114, v115, v116 bitop3:0x9a
    v_add_lshl_u32 v117, v117, s37, 2
    s_bcnt1_i32_b64 s41, vcc
    s_mov_b64 exec, vcc
    ds_write_b32 v117, v116
    s_mov_b64 exec, -1
    v_cmp_gt_i32 vcc, v113, v3
    s_add_u32 s37, s37, s41
    s_min_u32 s37, s37, s48
    s_cbranch_vccnz L2_xe2_1
L2_xr2_1:
    ds_write_b128 v7, v[56:59] offset:3072
    v_lshrrev_b32 v110, 16, v72
    v_lshrrev_b32 v111, 16, v74
    v_and_b32 v112, -4, v110
    v_add_u32 v112, v112, v2
    v_add_u32 v118, 0x5000000, v4
L2_x2_2:
    v_sub_u32 v113, v111, v112
    v_sub_u32 v115, v110, v112
    v_med3_i32 v114, v113, 0, 4
    v_max_i32 v115, 0, v115
    v_cmp_gt_i32 vcc, v114, v115
    v_mad_u32_u24 v116, v112, 5, v118
    v_bfm_b32 v114, v114, 28
    v_bfm_b32 v115, v115, 28
    v_mbcnt_lo_u32_b32 v117, vcc_lo, 0
    v_mbcnt_hi_u32_b32 v117, vcc_hi, v117
    v_bitop3_b32 v116, v114, v115, v116 bitop3:0x9a
    v_add_lshl_u32 v117, v117, s37, 2
    s_bcnt1_i32_b64 s41, vcc
    s_mov_b64 exec, vcc
    ds_write_b32 v117, v116
    s_mov_b64 exec, -1
    v_cmp_gt_i32 vcc, v113, v3
    s_add_u32 s37, s37, s41
    s_min_u32 s37, s37, s48
    s_cbranch_vccnz L2_xe2_2
L2_xr2_2:
    ds_write_b128 v7, v[60:63] offset:4096
    v_lshrrev_b32 v110, 16, v76
    v_lshrrev_b32 v111, 16, v78
    v_and_b32 v112, -4, v110
    v_add_u32 v112, v112, v2
    v_add_u32 v118, 0x7800000, v4
L2_x2_3:
    v_sub_u32 v113, v111, v112
    v_sub_u32 v115, v110, v112
    v_med3_i32 v114, v113, 0, 4
    v_max_i32 v115, 0, v115
    v_cmp_gt_i32 vcc, v114, v115
    v_mad_u32_u24 v116, v112, 5, v118
    v_bfm_b32 v114, v114, 28
    v_bfm_b32 v115, v115, 28
    v_mbcnt_lo_u32_b32 v117, vcc_lo, 0
    v_mbcnt_hi_u32_b32 v117, vcc_hi, v117
    v_bitop3_b32 v116, v114, v115, v116 bitop3:0x9a
    v_add_lshl_u32 v117, v117, s37, 2
    s_bcnt1_i32_b64 s41, vcc
    s_mov_b64 exec, vcc
    ds_write_b32 v117, v116
    s_mov_b64 exec, -1
    v_cmp_gt_i32 vcc, v113, v3
    s_add_u32 s37, s37, s41
    s_min_u32 s37, s37, s48
    s_cbranch_vccnz L2_xe2_3
L2_xr2_3:
    v_lshrrev_b32 v110, 16, v80
    v_lshrrev_b32 v111, 16, v82
    v_and_b32 v112, -4, v110
    v_add_u32 v112, v112, v2
    v_add_u32 v118, 0xa000000, v4
L2_x2_4:
    v_sub_u32 v113, v111, v112
    v_sub_u32 v115, v110, v112
    v_med3_i32 v114, v113, 0, 4
    v_max_i32 v115, 0, v115
    v_cmp_gt_i32 vcc, v114, v115
    v_mad_u32_u24 v116, v112, 5, v118
    v_bfm_b32 v114, v114, 28
    v_bfm_b32 v115, v115, 28
    v_mbcnt_lo_u32_b32 v117, vcc_lo, 0
    v_mbcnt_hi_u32_b32 v117, vcc_hi, v117
    v_bitop3_b32 v116, v114, v115, v116 bitop3:0x9a
    v_add_lshl_u32 v117, v117, s37, 2
    s_bcnt1_i32_b64 s41, vcc
    s_mov_b64 exec, vcc
    ds_write_b32 v117, v116
    s_mov_b64 exec, -1
    v_cmp_gt_i32 vcc, v113, v3
    s_add_u32 s37, s37, s41
    s_min_u32 s37, s37, s48
    s_cbranch_vccnz L2_xe2_4
L2_xr2_4:
    s_lshl_b32 s3, s37, 2
    v_add_u32 v117, s3, v1
    v_mov_b32 v116, -1
    ds_write_b32 v117, v116
    s_lshl_b32 s3, s38, 2
    v_add_u32 v117, s3, v1
    ds_read2st64_b32 v[40:41], v117 offset0:0 offset1:1
    ds_read2st64_b32 v[42:43], v117 offset0:2 offset1:3
    s_sub_u32 s41, s37, s38
    s_sub_u32 s3, s41, 192
    s_cmp_gt_u32 s3, 64
    s_cbranch_scc1 L2_xf2
L2_xg2:
    ds_write_b128 v7, v[44:47] offset:0
    ds_write_b128 v7, v[48:51] offset:1024
    buffer_load_dwordx4 v[44:47], v6, s[16:19], s40 offen offset:0
    buffer_load_dwordx4 v[48:51], v6, s[16:19], s40 offen offset:1024
    buffer_load_dwordx4 v[52:55], v6, s[16:19], s40 offen offset:2048
    buffer_load_dwordx4 v[56:59], v6, s[16:19], s40 offen offset:3072
    s_add_u32 s3, s40, 4096
    buffer_load_dwordx4 v[60:63], v6, s[16:19], s3 offen
    s_add_u32 s40, s40, 80000
    s_waitcnt lgkmcnt(0)
    s_barrier
L2_loop:
    s_waitcnt vmcnt(11)
    v_and_b32 v108, 0x10000000, v36
    v_lshrrev_b32 v106, 14, v16
    v_bitop3_b32 v106, v106, v8, v108 bitop3:0xea
    ds_read_b64 v[84:85], v106 offset:63616
    v_perm_b32 v107, v16, v32, s44
    v_bitop3_b32 v104, v16, v8, v108 bitop3:0xea
    v_bitop3_b32 v107, v107, v9, v10 bitop3:0xea
    v_bitop3_b32 v107, v16, v11, v107 bitop3:0xea
    s_waitcnt lgkmcnt(0)
    v_mfma_f32_4x4x4_16b_bf16 v[92:95], v[12:13], v[84:85], 0
    ds_read_b64 v[86:87], v104
    s_nop 3
    v_mul_f32 v92, v107, v92
    v_mul_f32 v93, v107, v93
    v_mul_f32 v94, v107, v94
    v_mul_f32 v95, v107, v95
    v_and_b32 v108, 0x20000000, v36
    v_lshrrev_b32 v106, 14, v17
    v_bitop3_b32 v106, v106, v8, v108 bitop3:0xea
    ds_read_b64 v[84:85], v106 offset:63616
    s_waitcnt lgkmcnt(1)
    v_mfma_f32_4x4x4_16b_bf16 v[96:99], v[12:13], v[86:87], v[92:95]
    v_perm_b32 v107, v17, v32, s45
    v_bitop3_b32 v105, v17, v8, v108 bitop3:0xea
    v_bitop3_b32 v107, v107, v9, v10 bitop3:0xea
    v_bitop3_b32 v107, v17, v11, v107 bitop3:0xea
    s_nop 0
    v_cvt_pk_bf16_f32 v88, v96, v97
    v_cvt_pk_bf16_f32 v89, v98, v99
    ds_wrxchg_rtn_b64 v[90:91], v104, v[88:89]
    s_waitcnt lgkmcnt(1)
    v_mfma_f32_4x4x4_16b_bf16 v[92:95], v[12:13], v[84:85], 0
    s_waitcnt lgkmcnt(0)
    v_cmpx_ne_u64 vcc, v[90:91], v[86:87]
    s_cbranch_execz L2_c3
    s_nop 2
    v_mfma_f32_4x4x4_16b_bf16 v[100:103], v[14:15], v[86:87], 0
    s_nop 1
    v_mfma_f32_4x4x4_16b_bf16 v[100:103], v[12:13], v[90:91], v[100:103]
    s_nop 4
    v_cvt_pk_bf16_f32 v100, v100, v101
    v_cvt_pk_bf16_f32 v101, v102, v103
    ds_pk_add_bf16 v104, v100
    ds_pk_add_bf16 v104, v101 offset:4
L2_c3:
    s_mov_b64 exec, -1
    ds_read_b64 v[86:87], v105
    v_mul_f32 v92, v107, v92
    v_mul_f32 v93, v107, v93
    v_mul_f32 v94, v107, v94
    v_mul_f32 v95, v107, v95
    v_and_b32 v108, 0x40000000, v36
    v_lshrrev_b32 v106, 14, v18
    v_bitop3_b32 v106, v106, v8, v108 bitop3:0xea
    ds_read_b64 v[84:85], v106 offset:63616
    s_waitcnt lgkmcnt(1)
    v_mfma_f32_4x4x4_16b_bf16 v[96:99], v[12:13], v[86:87], v[92:95]
    v_perm_b32 v107, v18, v32, s46
    v_bitop3_b32 v104, v18, v8, v108 bitop3:0xea
    v_bitop3_b32 v107, v107, v9, v10 bitop3:0xea
    v_bitop3_b32 v107, v18, v11, v107 bitop3:0xea
    s_nop 0
    v_cvt_pk_bf16_f32 v88, v96, v97
    v_cvt_pk_bf16_f32 v89, v98, v99
    ds_wrxchg_rtn_b64 v[90:91], v105, v[88:89]
    s_waitcnt lgkmcnt(1)
    v_mfma_f32_4x4x4_16b_bf16 v[92:95], v[12:13], v[84:85], 0
    s_waitcnt lgkmcnt(0)
    v_cmpx_ne_u64 vcc, v[90:91], v[86:87]
    s_cbranch_execz L2_c4
    s_nop 2
    v_mfma_f32_4x4x4_16b_bf16 v[100:103], v[14:15], v[86:87], 0
    s_nop 1
    v_mfma_f32_4x4x4_16b_bf16 v[100:103], v[12:13], v[90:91], v[100:103]
    s_nop 4
    v_cvt_pk_bf16_f32 v100, v100, v101
    v_cvt_pk_bf16_f32 v101, v102, v103
    ds_pk_add_bf16 v105, v100
    ds_pk_add_bf16 v105, v101 offset:4
L2_c4:
    s_mov_b64 exec, -1
    ds_read_b64 v[86:87], v104
    v_mul_f32 v92, v107, v92
    v_mul_f32 v93, v107, v93
    v_mul_f32 v94, v107, v94
    v_mul_f32 v95, v107, v95
    v_and_b32 v108, 0x80000000, v36
    v_lshrrev_b32 v106, 14, v19
    v_bitop3_b32 v106, v106, v8, v108 bitop3:0xea
    ds_read_b64 v[84:85], v106 offset:63616
    s_waitcnt lgkmcnt(1)
    v_mfma_f32_4x4x4_16b_bf16 v[96:99], v[12:13], v[86:87], v[92:95]
    v_perm_b32 v107, v19, v32, s47
    v_bitop3_b32 v105, v19, v8, v108 bitop3:0xea
    v_bitop3_b32 v107, v107, v9, v10 bitop3:0xea
    v_bitop3_b32 v107, v19, v11, v107 bitop3:0xea
    v_and_b32 v109, 0x0fffffff, v40
    v_mov_b32 v36, v40
    buffer_load_dwordx4 v[16:19], v109, s[8:11], 0 offen
    buffer_load_dword v32, v109, s[8:11], 0 offen offset:16
    v_cvt_pk_bf16_f32 v88, v96, v97
    v_cvt_pk_bf16_f32 v89, v98, v99
    ds_wrxchg_rtn_b64 v[90:91], v104, v[88:89]
    s_waitcnt lgkmcnt(1)
    v_mfma_f32_4x4x4_16b_bf16 v[92:95], v[12:13], v[84:85], 0
    s_waitcnt lgkmcnt(0)
    v_cmpx_ne_u64 vcc, v[90:91], v[86:87]
    s_cbranch_execz L2_c5
    s_nop 2
    v_mfma_f32_4x4x4_16b_bf16 v[100:103], v[14:15], v[86:87], 0
    s_nop 1
    v_mfma_f32_4x4x4_16b_bf16 v[100:103], v[12:13], v[90:91], v[100:103]
    s_nop 4
    v_cvt_pk_bf16_f32 v100, v100, v101
    v_cvt_pk_bf16_f32 v101, v102, v103
    ds_pk_add_bf16 v104, v100
    ds_pk_add_bf16 v104, v101 offset:4
L2_c5:
    s_mov_b64 exec, -1
    ds_read_b64 v[86:87], v105
    v_mul_f32 v92, v107, v92
    v_mul_f32 v93, v107, v93
    v_mul_f32 v94, v107, v94
    v_mul_f32 v95, v107, v95
    s_waitcnt vmcnt(11)
    v_and_b32 v108, 0x10000000, v37
    v_lshrrev_b32 v106, 14, v20
    v_bitop3_b32 v106, v106, v8, v108 bitop3:0xea
    ds_read_b64 v[84:85], v106 offset:63616
    s_waitcnt lgkmcnt(1)
    v_mfma_f32_4x4x4_16b_bf16 v[96:99], v[12:13], v[86:87], v[92:95]
    v_perm_b32 v107, v20, v33, s44
    v_bitop3_b32 v104, v20, v8, v108 bitop3:0xea
    v_bitop3_b32 v107, v107, v9, v10 bitop3:0xea
    v_bitop3_b32 v107, v20, v11, v107 bitop3:0xea
    s_nop 0
    v_cvt_pk_bf16_f32 v88, v96, v97
    v_cvt_pk_bf16_f32 v89, v98, v99
    ds_wrxchg_rtn_b64 v[90:91], v105, v[88:89]
    s_waitcnt lgkmcnt(1)
    v_mfma_f32_4x4x4_16b_bf16 v[92:95], v[12:13], v[84:85], 0
    s_waitcnt lgkmcnt(0)
    v_cmpx_ne_u64 vcc, v[90:91], v[86:87]
    s_cbranch_execz L2_c6
    s_nop 2
    v_mfma_f32_4x4x4_16b_bf16 v[100:103], v[14:15], v[86:87], 0
    s_nop 1
    v_mfma_f32_4x4x4_16b_bf16 v[100:103], v[12:13], v[90:91], v[100:103]
    s_nop 4
    v_cvt_pk_bf16_f32 v100, v100, v101
    v_cvt_pk_bf16_f32 v101, v102, v103
    ds_pk_add_bf16 v105, v100
    ds_pk_add_bf16 v105, v101 offset:4
L2_c6:
    s_mov_b64 exec, -1
    ds_read_b64 v[86:87], v104
    v_mul_f32 v92, v107, v92
    v_mul_f32 v93, v107, v93
    v_mul_f32 v94, v107, v94
    v_mul_f32 v95, v107, v95
    v_and_b32 v108, 0x20000000, v37
    v_lshrrev_b32 v106, 14, v21
    v_bitop3_b32 v106, v106, v8, v108 bitop3:0xea
    ds_read_b64 v[84:85], v106 offset:63616
    s_waitcnt lgkmcnt(1)
    v_mfma_f32_4x4x4_16b_bf16 v[96:99], v[12:13], v[86:87], v[92:95]
    v_perm_b32 v107, v21, v33, s45
    v_bitop3_b32 v105, v21, v8, v108 bitop3:0xea
    v_bitop3_b32 v107, v107, v9, v10 bitop3:0xea
    v_bitop3_b32 v107, v21, v11, v107 bitop3:0xea
    s_nop 0
    v_cvt_pk_bf16_f32 v88, v96, v97
    v_cvt_pk_bf16_f32 v89, v98, v99
    ds_wrxchg_rtn_b64 v[90:91], v104, v[88:89]
    s_waitcnt lgkmcnt(1)
    v_mfma_f32_4x4x4_16b_bf16 v[92:95], v[12:13], v[84:85], 0
    s_waitcnt lgkmcnt(0)
    v_cmpx_ne_u64 vcc, v[90:91], v[86:87]
    s_cbranch_execz L2_c7
    s_nop 2
    v_mfma_f32_4x4x4_16b_bf16 v[100:103], v[14:15], v[86:87], 0
    s_nop 1
    v_mfma_f32_4x4x4_16b_bf16 v[100:103], v[12:13], v[90:91], v[100:103]
    s_nop 4
    v_cvt_pk_bf16_f32 v100, v100, v101
    v_cvt_pk_bf16_f32 v101, v102, v103
    ds_pk_add_bf16 v104, v100
    ds_pk_add_bf16 v104, v101 offset:4
L2_c7:
    s_mov_b64 exec, -1
    ds_read_b64 v[86:87], v105
    v_mul_f32 v92, v107, v92
    v_mul_f32 v93, v107, v93
    v_mul_f32 v94, v107, v94
    v_mul_f32 v95, v107, v95
    v_and_b32 v108, 0x40000000, v37
    v_lshrrev_b32 v106, 14, v22
    v_bitop3_b32 v106, v106, v8, v108 bitop3:0xea
    ds_read_b64 v[84:85], v106 offset:63616
    s_waitcnt lgkmcnt(1)
    v_mfma_f32_4x4x4_16b_bf16 v[96:99], v[12:13], v[86:87], v[92:95]
    v_perm_b32 v107, v22, v33, s46
    v_bitop3_b32 v104, v22, v8, v108 bitop3:0xea
    v_bitop3_b32 v107, v107, v9, v10 bitop3:0xea
    v_bitop3_b32 v107, v22, v11, v107 bitop3:0xea
    s_nop 0
    v_cvt_pk_bf16_f32 v88, v96, v97
    v_cvt_pk_bf16_f32 v89, v98, v99
    ds_wrxchg_rtn_b64 v[90:91], v105, v[88:89]
    s_waitcnt lgkmcnt(1)
    v_mfma_f32_4x4x4_16b_bf16 v[92:95], v[12:13], v[84:85], 0
    s_waitcnt lgkmcnt(0)
    v_cmpx_ne_u64 vcc, v[90:91], v[86:87]
    s_cbranch_execz L2_c8
    s_nop 2
    v_mfma_f32_4x4x4_16b_bf16 v[100:103], v[14:15], v[86:87], 0
    s_nop 1
    v_mfma_f32_4x4x4_16b_bf16 v[100:103], v[12:13], v[90:91], v[100:103]
    s_nop 4
    v_cvt_pk_bf16_f32 v100, v100, v101
    v_cvt_pk_bf16_f32 v101, v102, v103
    ds_pk_add_bf16 v105, v100
    ds_pk_add_bf16 v105, v101 offset:4
L2_c8:
    s_mov_b64 exec, -1
    ds_read_b64 v[86:87], v104
    v_mul_f32 v92, v107, v92
    v_mul_f32 v93, v107, v93
    v_mul_f32 v94, v107, v94
    v_mul_f32 v95, v107, v95
    v_and_b32 v108, 0x80000000, v37
    v_lshrrev_b32 v106, 14, v23
    v_bitop3_b32 v106, v106, v8, v108 bitop3:0xea
    ds_read_b64 v[84:85], v106 offset:63616
    s_waitcnt lgkmcnt(1)
    v_mfma_f32_4x4x4_16b_bf16 v[96:99], v[12:13], v[86:87], v[92:95]
    v_perm_b32 v107, v23, v33, s47
    v_bitop3_b32 v105, v23, v8, v108 bitop3:0xea
    v_bitop3_b32 v107, v107, v9, v10 bitop3:0xea
    v_bitop3_b32 v107, v23, v11, v107 bitop3:0xea
    v_and_b32 v109, 0x0fffffff, v41
    v_mov_b32 v37, v41
    buffer_load_dwordx4 v[20:23], v109, s[8:11], 0 offen
    buffer_load_dword v33, v109, s[8:11], 0 offen offset:16
    v_cvt_pk_bf16_f32 v88, v96, v97
    v_cvt_pk_bf16_f32 v89, v98, v99
    ds_wrxchg_rtn_b64 v[90:91], v104, v[88:89]
    s_waitcnt lgkmcnt(1)
    v_mfma_f32_4x4x4_16b_bf16 v[92:95], v[12:13], v[84:85], 0
    s_waitcnt lgkmcnt(0)
    v_cmpx_ne_u64 vcc, v[90:91], v[86:87]
    s_cbranch_execz L2_c9
    s_nop 2
    v_mfma_f32_4x4x4_16b_bf16 v[100:103], v[14:15], v[86:87], 0
    s_nop 1
    v_mfma_f32_4x4x4_16b_bf16 v[100:103], v[12:13], v[90:91], v[100:103]
    s_nop 4
    v_cvt_pk_bf16_f32 v100, v100, v101
    v_cvt_pk_bf16_f32 v101, v102, v103
    ds_pk_add_bf16 v104, v100
    ds_pk_add_bf16 v104, v101 offset:4
L2_c9:
    s_mov_b64 exec, -1
    ds_read_b64 v[86:87], v105
    v_mul_f32 v92, v107, v92
    v_mul_f32 v93, v107, v93
    v_mul_f32 v94, v107, v94
    v_mul_f32 v95, v107, v95
    s_waitcnt vmcnt(11)
    v_and_b32 v108, 0x10000000, v38
    v_lshrrev_b32 v106, 14, v24
    v_bitop3_b32 v106, v106, v8, v108 bitop3:0xea
    ds_read_b64 v[84:85], v106 offset:63616
    s_waitcnt lgkmcnt(1)
    v_mfma_f32_4x4x4_16b_bf16 v[96:99], v[12:13], v[86:87], v[92:95]
    v_perm_b32 v107, v24, v34, s44
    v_bitop3_b32 v104, v24, v8, v108 bitop3:0xea
    v_bitop3_b32 v107, v107, v9, v10 bitop3:0xea
    v_bitop3_b32 v107, v24, v11, v107 bitop3:0xea
    s_nop 0
    v_cvt_pk_bf16_f32 v88, v96, v97
    v_cvt_pk_bf16_f32 v89, v98, v99
    ds_wrxchg_rtn_b64 v[90:91], v105, v[88:89]
    s_waitcnt lgkmcnt(1)
    v_mfma_f32_4x4x4_16b_bf16 v[92:95], v[12:13], v[84:85], 0
    s_waitcnt lgkmcnt(0)
    v_cmpx_ne_u64 vcc, v[90:91], v[86:87]
    s_cbranch_execz L2_c10
    s_nop 2
    v_mfma_f32_4x4x4_16b_bf16 v[100:103], v[14:15], v[86:87], 0
    s_nop 1
    v_mfma_f32_4x4x4_16b_bf16 v[100:103], v[12:13], v[90:91], v[100:103]
    s_nop 4
    v_cvt_pk_bf16_f32 v100, v100, v101
    v_cvt_pk_bf16_f32 v101, v102, v103
    ds_pk_add_bf16 v105, v100
    ds_pk_add_bf16 v105, v101 offset:4
L2_c10:
    s_mov_b64 exec, -1
    ds_read_b64 v[86:87], v104
    v_mul_f32 v92, v107, v92
    v_mul_f32 v93, v107, v93
    v_mul_f32 v94, v107, v94
    v_mul_f32 v95, v107, v95
    v_and_b32 v108, 0x20000000, v38
    v_lshrrev_b32 v106, 14, v25
    v_bitop3_b32 v106, v106, v8, v108 bitop3:0xea
    ds_read_b64 v[84:85], v106 offset:63616
    s_waitcnt lgkmcnt(1)
    v_mfma_f32_4x4x4_16b_bf16 v[96:99], v[12:13], v[86:87], v[92:95]
    v_perm_b32 v107, v25, v34, s45
    v_bitop3_b32 v105, v25, v8, v108 bitop3:0xea
    v_bitop3_b32 v107, v107, v9, v10 bitop3:0xea
    v_bitop3_b32 v107, v25, v11, v107 bitop3:0xea
    s_nop 0
    v_cvt_pk_bf16_f32 v88, v96, v97
    v_cvt_pk_bf16_f32 v89, v98, v99
    ds_wrxchg_rtn_b64 v[90:91], v104, v[88:89]
    s_waitcnt lgkmcnt(1)
    v_mfma_f32_4x4x4_16b_bf16 v[92:95], v[12:13], v[84:85], 0
    s_waitcnt lgkmcnt(0)
    v_cmpx_ne_u64 vcc, v[90:91], v[86:87]
    s_cbranch_execz L2_c11
    s_nop 2
    v_mfma_f32_4x4x4_16b_bf16 v[100:103], v[14:15], v[86:87], 0
    s_nop 1
    v_mfma_f32_4x4x4_16b_bf16 v[100:103], v[12:13], v[90:91], v[100:103]
    s_nop 4
    v_cvt_pk_bf16_f32 v100, v100, v101
    v_cvt_pk_bf16_f32 v101, v102, v103
    ds_pk_add_bf16 v104, v100
    ds_pk_add_bf16 v104, v101 offset:4
L2_c11:
    s_mov_b64 exec, -1
    ds_read_b64 v[86:87], v105
    v_mul_f32 v92, v107, v92
    v_mul_f32 v93, v107, v93
    v_mul_f32 v94, v107, v94
    v_mul_f32 v95, v107, v95
    v_and_b32 v108, 0x40000000, v38
    v_lshrrev_b32 v106, 14, v26
    v_bitop3_b32 v106, v106, v8, v108 bitop3:0xea
    ds_read_b64 v[84:85], v106 offset:63616
    s_waitcnt lgkmcnt(1)
    v_mfma_f32_4x4x4_16b_bf16 v[96:99], v[12:13], v[86:87], v[92:95]
    v_perm_b32 v107, v26, v34, s46
    v_bitop3_b32 v104, v26, v8, v108 bitop3:0xea
    v_bitop3_b32 v107, v107, v9, v10 bitop3:0xea
    v_bitop3_b32 v107, v26, v11, v107 bitop3:0xea
    s_nop 0
    v_cvt_pk_bf16_f32 v88, v96, v97
    v_cvt_pk_bf16_f32 v89, v98, v99
    ds_wrxchg_rtn_b64 v[90:91], v105, v[88:89]
    s_waitcnt lgkmcnt(1)
    v_mfma_f32_4x4x4_16b_bf16 v[92:95], v[12:13], v[84:85], 0
    s_waitcnt lgkmcnt(0)
    v_cmpx_ne_u64 vcc, v[90:91], v[86:87]
    s_cbranch_execz L2_c12
    s_nop 2
    v_mfma_f32_4x4x4_16b_bf16 v[100:103], v[14:15], v[86:87], 0
    s_nop 1
    v_mfma_f32_4x4x4_16b_bf16 v[100:103], v[12:13], v[90:91], v[100:103]
    s_nop 4
    v_cvt_pk_bf16_f32 v100, v100, v101
    v_cvt_pk_bf16_f32 v101, v102, v103
    ds_pk_add_bf16 v105, v100
    ds_pk_add_bf16 v105, v101 offset:4
L2_c12:
    s_mov_b64 exec, -1
    ds_read_b64 v[86:87], v104
    v_mul_f32 v92, v107, v92
    v_mul_f32 v93, v107, v93
    v_mul_f32 v94, v107, v94
    v_mul_f32 v95, v107, v95
    v_and_b32 v108, 0x80000000, v38
    v_lshrrev_b32 v106, 14, v27
    v_bitop3_b32 v106, v106, v8, v108 bitop3:0xea
    ds_read_b64 v[84:85], v106 offset:63616
    s_waitcnt lgkmcnt(1)
    v_mfma_f32_4x4x4_16b_bf16 v[96:99], v[12:13], v[86:87], v[92:95]
    v_perm_b32 v107, v27, v34, s47
    v_bitop3_b32 v105, v27, v8, v108 bitop3:0xea
    v_bitop3_b32 v107, v107, v9, v10 bitop3:0xea
    v_bitop3_b32 v107, v27, v11, v107 bitop3:0xea
    v_and_b32 v109, 0x0fffffff, v42
    v_mov_b32 v38, v42
    buffer_load_dwordx4 v[24:27], v109, s[8:11], 0 offen
    buffer_load_dword v34, v109, s[8:11], 0 offen offset:16
    v_cvt_pk_bf16_f32 v88, v96, v97
    v_cvt_pk_bf16_f32 v89, v98, v99
    ds_wrxchg_rtn_b64 v[90:91], v104, v[88:89]
    s_waitcnt lgkmcnt(1)
    v_mfma_f32_4x4x4_16b_bf16 v[92:95], v[12:13], v[84:85], 0
    s_waitcnt lgkmcnt(0)
    v_cmpx_ne_u64 vcc, v[90:91], v[86:87]
    s_cbranch_execz L2_c13
    s_nop 2
    v_mfma_f32_4x4x4_16b_bf16 v[100:103], v[14:15], v[86:87], 0
    s_nop 1
    v_mfma_f32_4x4x4_16b_bf16 v[100:103], v[12:13], v[90:91], v[100:103]
    s_nop 4
    v_cvt_pk_bf16_f32 v100, v100, v101
    v_cvt_pk_bf16_f32 v101, v102, v103
    ds_pk_add_bf16 v104, v100
    ds_pk_add_bf16 v104, v101 offset:4
L2_c13:
    s_mov_b64 exec, -1
    ds_read_b64 v[86:87], v105
    v_mul_f32 v92, v107, v92
    v_mul_f32 v93, v107, v93
    v_mul_f32 v94, v107, v94
    v_mul_f32 v95, v107, v95
    s_waitcnt vmcnt(11)
    v_and_b32 v108, 0x10000000, v39
    v_lshrrev_b32 v106, 14, v28
    v_bitop3_b32 v106, v106, v8, v108 bitop3:0xea
    ds_read_b64 v[84:85], v106 offset:63616
    s_waitcnt lgkmcnt(1)
    v_mfma_f32_4x4x4_16b_bf16 v[96:99], v[12:13], v[86:87], v[92:95]
    v_perm_b32 v107, v28, v35, s44
    v_bitop3_b32 v104, v28, v8, v108 bitop3:0xea
    v_bitop3_b32 v107, v107, v9, v10 bitop3:0xea
    v_bitop3_b32 v107, v28, v11, v107 bitop3:0xea
    s_nop 0
    v_cvt_pk_bf16_f32 v88, v96, v97
    v_cvt_pk_bf16_f32 v89, v98, v99
    ds_wrxchg_rtn_b64 v[90:91], v105, v[88:89]
    s_waitcnt lgkmcnt(1)
    v_mfma_f32_4x4x4_16b_bf16 v[92:95], v[12:13], v[84:85], 0
    s_waitcnt lgkmcnt(0)
    v_cmpx_ne_u64 vcc, v[90:91], v[86:87]
    s_cbranch_execz L2_c14
    s_nop 2
    v_mfma_f32_4x4x4_16b_bf16 v[100:103], v[14:15], v[86:87], 0
    s_nop 1
    v_mfma_f32_4x4x4_16b_bf16 v[100:103], v[12:13], v[90:91], v[100:103]
    s_nop 4
    v_cvt_pk_bf16_f32 v100, v100, v101
    v_cvt_pk_bf16_f32 v101, v102, v103
    ds_pk_add_bf16 v105, v100
    ds_pk_add_bf16 v105, v101 offset:4
L2_c14:
    s_mov_b64 exec, -1
    ds_read_b64 v[86:87], v104
    v_mul_f32 v92, v107, v92
    v_mul_f32 v93, v107, v93
    v_mul_f32 v94, v107, v94
    v_mul_f32 v95, v107, v95
    v_and_b32 v108, 0x20000000, v39
    v_lshrrev_b32 v106, 14, v29
    v_bitop3_b32 v106, v106, v8, v108 bitop3:0xea
    ds_read_b64 v[84:85], v106 offset:63616
    s_waitcnt lgkmcnt(1)
    v_mfma_f32_4x4x4_16b_bf16 v[96:99], v[12:13], v[86:87], v[92:95]
    v_perm_b32 v107, v29, v35, s45
    v_bitop3_b32 v105, v29, v8, v108 bitop3:0xea
    v_bitop3_b32 v107, v107, v9, v10 bitop3:0xea
    v_bitop3_b32 v107, v29, v11, v107 bitop3:0xea
    s_nop 0
    v_cvt_pk_bf16_f32 v88, v96, v97
    v_cvt_pk_bf16_f32 v89, v98, v99
    ds_wrxchg_rtn_b64 v[90:91], v104, v[88:89]
    s_waitcnt lgkmcnt(1)
    v_mfma_f32_4x4x4_16b_bf16 v[92:95], v[12:13], v[84:85], 0
    s_waitcnt lgkmcnt(0)
    v_cmpx_ne_u64 vcc, v[90:91], v[86:87]
    s_cbranch_execz L2_c15
    s_nop 2
    v_mfma_f32_4x4x4_16b_bf16 v[100:103], v[14:15], v[86:87], 0
    s_nop 1
    v_mfma_f32_4x4x4_16b_bf16 v[100:103], v[12:13], v[90:91], v[100:103]
    s_nop 4
    v_cvt_pk_bf16_f32 v100, v100, v101
    v_cvt_pk_bf16_f32 v101, v102, v103
    ds_pk_add_bf16 v104, v100
    ds_pk_add_bf16 v104, v101 offset:4
L2_c15:
    s_mov_b64 exec, -1
    ds_read_b64 v[86:87], v105
    v_mul_f32 v92, v107, v92
    v_mul_f32 v93, v107, v93
    v_mul_f32 v94, v107, v94
    v_mul_f32 v95, v107, v95
    v_and_b32 v108, 0x40000000, v39
    v_lshrrev_b32 v106, 14, v30
    v_bitop3_b32 v106, v106, v8, v108 bitop3:0xea
    ds_read_b64 v[84:85], v106 offset:63616
    s_waitcnt lgkmcnt(1)
    v_mfma_f32_4x4x4_16b_bf16 v[96:99], v[12:13], v[86:87], v[92:95]
    v_perm_b32 v107, v30, v35, s46
    v_bitop3_b32 v104, v30, v8, v108 bitop3:0xea
    v_bitop3_b32 v107, v107, v9, v10 bitop3:0xea
    v_bitop3_b32 v107, v30, v11, v107 bitop3:0xea
    s_nop 0
    v_cvt_pk_bf16_f32 v88, v96, v97
    v_cvt_pk_bf16_f32 v89, v98, v99
    ds_wrxchg_rtn_b64 v[90:91], v105, v[88:89]
    s_waitcnt lgkmcnt(1)
    v_mfma_f32_4x4x4_16b_bf16 v[92:95], v[12:13], v[84:85], 0
    s_waitcnt lgkmcnt(0)
    v_cmpx_ne_u64 vcc, v[90:91], v[86:87]
    s_cbranch_execz L2_c16
    s_nop 2
    v_mfma_f32_4x4x4_16b_bf16 v[100:103], v[14:15], v[86:87], 0
    s_nop 1
    v_mfma_f32_4x4x4_16b_bf16 v[100:103], v[12:13], v[90:91], v[100:103]
    s_nop 4
    v_cvt_pk_bf16_f32 v100, v100, v101
    v_cvt_pk_bf16_f32 v101, v102, v103
    ds_pk_add_bf16 v105, v100
    ds_pk_add_bf16 v105, v101 offset:4
L2_c16:
    s_mov_b64 exec, -1
    ds_read_b64 v[86:87], v104
    v_mul_f32 v92, v107, v92
    v_mul_f32 v93, v107, v93
    v_mul_f32 v94, v107, v94
    v_mul_f32 v95, v107, v95
    v_and_b32 v108, 0x80000000, v39
    v_lshrrev_b32 v106, 14, v31
    v_bitop3_b32 v106, v106, v8, v108 bitop3:0xea
    ds_read_b64 v[84:85], v106 offset:63616
    s_waitcnt lgkmcnt(1)
    v_mfma_f32_4x4x4_16b_bf16 v[96:99], v[12:13], v[86:87], v[92:95]
    v_perm_b32 v107, v31, v35, s47
    v_bitop3_b32 v105, v31, v8, v108 bitop3:0xea
    v_bitop3_b32 v107, v107, v9, v10 bitop3:0xea
    v_bitop3_b32 v107, v31, v11, v107 bitop3:0xea
    v_and_b32 v109, 0x0fffffff, v43
    v_mov_b32 v39, v43
    buffer_load_dwordx4 v[28:31], v109, s[8:11], 0 offen
    buffer_load_dword v35, v109, s[8:11], 0 offen offset:16
    v_cvt_pk_bf16_f32 v88, v96, v97
    v_cvt_pk_bf16_f32 v89, v98, v99
    ds_wrxchg_rtn_b64 v[90:91], v104, v[88:89]
    s_waitcnt lgkmcnt(1)
    v_mfma_f32_4x4x4_16b_bf16 v[92:95], v[12:13], v[84:85], 0
    s_waitcnt lgkmcnt(0)
    v_cmpx_ne_u64 vcc, v[90:91], v[86:87]
    s_cbranch_execz L2_c17
    s_nop 2
    v_mfma_f32_4x4x4_16b_bf16 v[100:103], v[14:15], v[86:87], 0
    s_nop 1
    v_mfma_f32_4x4x4_16b_bf16 v[100:103], v[12:13], v[90:91], v[100:103]
    s_nop 4
    v_cvt_pk_bf16_f32 v100, v100, v101
    v_cvt_pk_bf16_f32 v101, v102, v103
    ds_pk_add_bf16 v104, v100
    ds_pk_add_bf16 v104, v101 offset:4
L2_c17:
    s_mov_b64 exec, -1
    ds_read_b64 v[86:87], v105
    v_mul_f32 v92, v107, v92
    v_mul_f32 v93, v107, v93
    v_mul_f32 v94, v107, v94
    v_mul_f32 v95, v107, v95
    s_waitcnt lgkmcnt(0)
    s_nop 0
    v_mfma_f32_4x4x4_16b_bf16 v[96:99], v[12:13], v[86:87], v[92:95]
    s_nop 4
    v_cvt_pk_bf16_f32 v88, v96, v97
    v_cvt_pk_bf16_f32 v89, v98, v99
    ds_wrxchg_rtn_b64 v[90:91], v105, v[88:89]
    s_waitcnt lgkmcnt(0)
    v_cmpx_ne_u64 vcc, v[90:91], v[86:87]
    s_cbranch_execz L2_c18
    s_nop 2
    v_mfma_f32_4x4x4_16b_bf16 v[100:103], v[14:15], v[86:87], 0
    s_nop 1
    v_mfma_f32_4x4x4_16b_bf16 v[100:103], v[12:13], v[90:91], v[100:103]
    s_nop 4
    v_cvt_pk_bf16_f32 v100, v100, v101
    v_cvt_pk_bf16_f32 v101, v102, v103
    ds_pk_add_bf16 v105, v100
    ds_pk_add_bf16 v105, v101 offset:4
L2_c18:
    s_mov_b64 exec, -1
    s_bitcmp1_b32 s36, s42
    s_cbranch_scc1 L2_slow
L2_ret0:
    s_barrier
    s_waitcnt vmcnt(8)
    s_mov_b32 s37, s38
    s_add_u32 s48, s38, 257
    v_and_b32 v110, 0xffff, v65
    v_and_b32 v111, 0xffff, v67
    v_and_b32 v112, -4, v110
    v_add_u32 v112, v112, v2
L2_x19_0:
    v_sub_u32 v113, v111, v112
    v_sub_u32 v115, v110, v112
    v_med3_i32 v114, v113, 0, 4
    v_max_i32 v115, 0, v115
    v_cmp_gt_i32 vcc, v114, v115
    v_mad_u32_u24 v116, v112, 5, v4
    v_bfm_b32 v114, v114, 28
    v_bfm_b32 v115, v115, 28
    v_mbcnt_lo_u32_b32 v117, vcc_lo, 0
    v_mbcnt_hi_u32_b32 v117, vcc_hi, v117
    v_bitop3_b32 v116, v114, v115, v116 bitop3:0x9a
    v_add_lshl_u32 v117, v117, s37, 2
    s_bcnt1_i32_b64 s41, vcc
    s_mov_b64 exec, vcc
    ds_write_b32 v117, v116
    s_mov_b64 exec, -1
    v_cmp_gt_i32 vcc, v113, v3
    s_add_u32 s37, s37, s41
    s_min_u32 s37, s37, s48
    s_cbranch_vccnz L2_xe19_0
L2_xr19_0:
    ds_write_b128 v7, v[52:55] offset:2048
    v_and_b32 v110, 0xffff, v69
    v_and_b32 v111, 0xffff, v71
    v_and_b32 v112, -4, v110
    v_add_u32 v112, v112, v2
    v_add_u32 v118, 0x2800000, v4
L2_x19_1:
    v_sub_u32 v113, v111, v112
    v_sub_u32 v115, v110, v112
    v_med3_i32 v114, v113, 0, 4
    v_max_i32 v115, 0, v115
    v_cmp_gt_i32 vcc, v114, v115
    v_mad_u32_u24 v116, v112, 5, v118
    v_bfm_b32 v114, v114, 28
    v_bfm_b32 v115, v115, 28
    v_mbcnt_lo_u32_b32 v117, vcc_lo, 0
    v_mbcnt_hi_u32_b32 v117, vcc_hi, v117
    v_bitop3_b32 v116, v114, v115, v116 bitop3:0x9a
    v_add_lshl_u32 v117, v117, s37, 2
    s_bcnt1_i32_b64 s41, vcc
    s_mov_b64 exec, vcc
    ds_write_b32 v117, v116
    s_mov_b64 exec, -1
    v_cmp_gt_i32 vcc, v113, v3
    s_add_u32 s37, s37, s41
    s_min_u32 s37, s37, s48
    s_cbranch_vccnz L2_xe19_1
L2_xr19_1:
    ds_write_b128 v7, v[56:59] offset:3072
    v_and_b32 v110, 0xffff, v73
    v_and_b32 v111, 0xffff, v75
    v_and_b32 v112, -4, v110
    v_add_u32 v112, v112, v2
    v_add_u32 v118, 0x5000000, v4
L2_x19_2:
    v_sub_u32 v113, v111, v112
    v_sub_u32 v115, v110, v112
    v_med3_i32 v114, v113, 0, 4
    v_max_i32 v115, 0, v115
    v_cmp_gt_i32 vcc, v114, v115
    v_mad_u32_u24 v116, v112, 5, v118
    v_bfm_b32 v114, v114, 28
    v_bfm_b32 v115, v115, 28
    v_mbcnt_lo_u32_b32 v117, vcc_lo, 0
    v_mbcnt_hi_u32_b32 v117, vcc_hi, v117
    v_bitop3_b32 v116, v114, v115, v116 bitop3:0x9a
    v_add_lshl_u32 v117, v117, s37, 2
    s_bcnt1_i32_b64 s41, vcc
    s_mov_b64 exec, vcc
    ds_write_b32 v117, v116
    s_mov_b64 exec, -1
    v_cmp_gt_i32 vcc, v113, v3
    s_add_u32 s37, s37, s41
    s_min_u32 s37, s37, s48
    s_cbranch_vccnz L2_xe19_2
L2_xr19_2:
    ds_write_b128 v7, v[60:63] offset:4096
    v_and_b32 v110, 0xffff, v77
    v_and_b32 v111, 0xffff, v79
    v_and_b32 v112, -4, v110
    v_add_u32 v112, v112, v2
    v_add_u32 v118, 0x7800000, v4
L2_x19_3:
    v_sub_u32 v113, v111, v112
    v_sub_u32 v115, v110, v112
    v_med3_i32 v114, v113, 0, 4
    v_max_i32 v115, 0, v115
    v_cmp_gt_i32 vcc, v114, v115
    v_mad_u32_u24 v116, v112, 5, v118
    v_bfm_b32 v114, v114, 28
    v_bfm_b32 v115, v115, 28
    v_mbcnt_lo_u32_b32 v117, vcc_lo, 0
    v_mbcnt_hi_u32_b32 v117, vcc_hi, v117
    v_bitop3_b32 v116, v114, v115, v116 bitop3:0x9a
    v_add_lshl_u32 v117, v117, s37, 2
    s_bcnt1_i32_b64 s41, vcc
    s_mov_b64 exec, vcc
    ds_write_b32 v117, v116
    s_mov_b64 exec, -1
    v_cmp_gt_i32 vcc, v113, v3
    s_add_u32 s37, s37, s41
    s_min_u32 s37, s37, s48
    s_cbranch_vccnz L2_xe19_3
L2_xr19_3:
    v_and_b32 v110, 0xffff, v81
    v_and_b32 v111, 0xffff, v83
    v_and_b32 v112, -4, v110
    v_add_u32 v112, v112, v2
    v_add_u32 v118, 0xa000000, v4
L2_x19_4:
    v_sub_u32 v113, v111, v112
    v_sub_u32 v115, v110, v112
    v_med3_i32 v114, v113, 0, 4
    v_max_i32 v115, 0, v115
    v_cmp_gt_i32 vcc, v114, v115
    v_mad_u32_u24 v116, v112, 5, v118
    v_bfm_b32 v114, v114, 28
    v_bfm_b32 v115, v115, 28
    v_mbcnt_lo_u32_b32 v117, vcc_lo, 0
    v_mbcnt_hi_u32_b32 v117, vcc_hi, v117
    v_bitop3_b32 v116, v114, v115, v116 bitop3:0x9a
    v_add_lshl_u32 v117, v117, s37, 2
    s_bcnt1_i32_b64 s41, vcc
    s_mov_b64 exec, vcc
    ds_write_b32 v117, v116
    s_mov_b64 exec, -1
    v_cmp_gt_i32 vcc, v113, v3
    s_add_u32 s37, s37, s41
    s_min_u32 s37, s37, s48
    s_cbranch_vccnz L2_xe19_4
L2_xr19_4:
    s_lshl_b32 s3, s37, 2
    v_add_u32 v117, s3, v1
    v_mov_b32 v116, -1
    ds_write_b32 v117, v116
    s_lshl_b32 s3, s38, 2
    v_add_u32 v117, s3, v1
    ds_read2st64_b32 v[40:41], v117 offset0:0 offset1:1
    ds_read2st64_b32 v[42:43], v117 offset0:2 offset1:3
    s_sub_u32 s41, s37, s38
    s_sub_u32 s3, s41, 192
    s_cmp_gt_u32 s3, 64
    s_cbranch_scc1 L2_xf19
L2_xg19:
    ds_write_b128 v7, v[44:47] offset:0
    ds_write_b128 v7, v[48:51] offset:1024
    buffer_load_dwordx4 v[44:47], v6, s[16:19], s40 offen offset:0
    buffer_load_dwordx4 v[48:51], v6, s[16:19], s40 offen offset:1024
    buffer_load_dwordx4 v[52:55], v6, s[16:19], s40 offen offset:2048
    buffer_load_dwordx4 v[56:59], v6, s[16:19], s40 offen offset:3072
    s_add_u32 s3, s40, 4096
    buffer_load_dwordx4 v[60:63], v6, s[16:19], s3 offen
    s_add_u32 s40, s40, 80000
    s_add_u32 s42, s42, 1
    s_waitcnt lgkmcnt(0)
    s_barrier
    s_waitcnt vmcnt(11)
    v_and_b32 v108, 0x10000000, v36
    v_lshrrev_b32 v106, 14, v16
    v_bitop3_b32 v106, v106, v8, v108 bitop3:0xea
    ds_read_b64 v[84:85], v106 offset:63616
    v_perm_b32 v107, v16, v32, s44
    v_bitop3_b32 v104, v16, v8, v108 bitop3:0xea
    v_bitop3_b32 v107, v107, v9, v10 bitop3:0xea
    v_bitop3_b32 v107, v16, v11, v107 bitop3:0xea
    s_waitcnt lgkmcnt(0)
    v_mfma_f32_4x4x4_16b_bf16 v[92:95], v[12:13], v[84:85], 0
    ds_read_b64 v[86:87], v104
    s_nop 3
    v_mul_f32 v92, v107, v92
    v_mul_f32 v93, v107, v93
    v_mul_f32 v94, v107, v94
    v_mul_f32 v95, v107, v95
    v_and_b32 v108, 0x20000000, v36
    v_lshrrev_b32 v106, 14, v17
    v_bitop3_b32 v106, v106, v8, v108 bitop3:0xea
    ds_read_b64 v[84:85], v106 offset:63616
    s_waitcnt lgkmcnt(1)
    v_mfma_f32_4x4x4_16b_bf16 v[96:99], v[12:13], v[86:87], v[92:95]
    v_perm_b32 v107, v17, v32, s45
    v_bitop3_b32 v105, v17, v8, v108 bitop3:0xea
    v_bitop3_b32 v107, v107, v9, v10 bitop3:0xea
    v_bitop3_b32 v107, v17, v11, v107 bitop3:0xea
    s_nop 0
    v_cvt_pk_bf16_f32 v88, v96, v97
    v_cvt_pk_bf16_f32 v89, v98, v99
    ds_wrxchg_rtn_b64 v[90:91], v104, v[88:89]
    s_waitcnt lgkmcnt(1)
    v_mfma_f32_4x4x4_16b_bf16 v[92:95], v[12:13], v[84:85], 0
    s_waitcnt lgkmcnt(0)
    v_cmpx_ne_u64 vcc, v[90:91], v[86:87]
    s_cbranch_execz L2_c20
    s_nop 2
    v_mfma_f32_4x4x4_16b_bf16 v[100:103], v[14:15], v[86:87], 0
    s_nop 1
    v_mfma_f32_4x4x4_16b_bf16 v[100:103], v[12:13], v[90:91], v[100:103]
    s_nop 4
    v_cvt_pk_bf16_f32 v100, v100, v101
    v_cvt_pk_bf16_f32 v101, v102, v103
    ds_pk_add_bf16 v104, v100
    ds_pk_add_bf16 v104, v101 offset:4
L2_c20:
    s_mov_b64 exec, -1
    ds_read_b64 v[86:87], v105
    v_mul_f32 v92, v107, v92
    v_mul_f32 v93, v107, v93
    v_mul_f32 v94, v107, v94
    v_mul_f32 v95, v107, v95
    v_and_b32 v108, 0x40000000, v36
    v_lshrrev_b32 v106, 14, v18
    v_bitop3_b32 v106, v106, v8, v108 bitop3:0xea
    ds_read_b64 v[84:85], v106 offset:63616
    s_waitcnt lgkmcnt(1)
    v_mfma_f32_4x4x4_16b_bf16 v[96:99], v[12:13], v[86:87], v[92:95]
    v_perm_b32 v107, v18, v32, s46
    v_bitop3_b32 v104, v18, v8, v108 bitop3:0xea
    v_bitop3_b32 v107, v107, v9, v10 bitop3:0xea
    v_bitop3_b32 v107, v18, v11, v107 bitop3:0xea
    s_nop 0
    v_cvt_pk_bf16_f32 v88, v96, v97
    v_cvt_pk_bf16_f32 v89, v98, v99
    ds_wrxchg_rtn_b64 v[90:91], v105, v[88:89]
    s_waitcnt lgkmcnt(1)
    v_mfma_f32_4x4x4_16b_bf16 v[92:95], v[12:13], v[84:85], 0
    s_waitcnt lgkmcnt(0)
    v_cmpx_ne_u64 vcc, v[90:91], v[86:87]
    s_cbranch_execz L2_c21
    s_nop 2
    v_mfma_f32_4x4x4_16b_bf16 v[100:103], v[14:15], v[86:87], 0
    s_nop 1
    v_mfma_f32_4x4x4_16b_bf16 v[100:103], v[12:13], v[90:91], v[100:103]
    s_nop 4
    v_cvt_pk_bf16_f32 v100, v100, v101
    v_cvt_pk_bf16_f32 v101, v102, v103
    ds_pk_add_bf16 v105, v100
    ds_pk_add_bf16 v105, v101 offset:4
L2_c21:
    s_mov_b64 exec, -1
    ds_read_b64 v[86:87], v104
    v_mul_f32 v92, v107, v92
    v_mul_f32 v93, v107, v93
    v_mul_f32 v94, v107, v94
    v_mul_f32 v95, v107, v95
    v_and_b32 v108, 0x80000000, v36
    v_lshrrev_b32 v106, 14, v19
    v_bitop3_b32 v106, v106, v8, v108 bitop3:0xea
    ds_read_b64 v[84:85], v106 offset:63616
    s_waitcnt lgkmcnt(1)
    v_mfma_f32_4x4x4_16b_bf16 v[96:99], v[12:13], v[86:87], v[92:95]
    v_perm_b32 v107, v19, v32, s47
    v_bitop3_b32 v105, v19, v8, v108 bitop3:0xea
    v_bitop3_b32 v107, v107, v9, v10 bitop3:0xea
    v_bitop3_b32 v107, v19, v11, v107 bitop3:0xea
    v_and_b32 v109, 0x0fffffff, v40
    v_mov_b32 v36, v40
    buffer_load_dwordx4 v[16:19], v109, s[8:11], 0 offen
    buffer_load_dword v32, v109, s[8:11], 0 offen offset:16
    v_cvt_pk_bf16_f32 v88, v96, v97
    v_cvt_pk_bf16_f32 v89, v98, v99
    ds_wrxchg_rtn_b64 v[90:91], v104, v[88:89]
    s_waitcnt lgkmcnt(1)
    v_mfma_f32_4x4x4_16b_bf16 v[92:95], v[12:13], v[84:85], 0
    s_waitcnt lgkmcnt(0)
    v_cmpx_ne_u64 vcc, v[90:91], v[86:87]
    s_cbranch_execz L2_c22
    s_nop 2
    v_mfma_f32_4x4x4_16b_bf16 v[100:103], v[14:15], v[86:87], 0
    s_nop 1
    v_mfma_f32_4x4x4_16b_bf16 v[100:103], v[12:13], v[90:91], v[100:103]
    s_nop 4
    v_cvt_pk_bf16_f32 v100, v100, v101
    v_cvt_pk_bf16_f32 v101, v102, v103
    ds_pk_add_bf16 v104, v100
    ds_pk_add_bf16 v104, v101 offset:4
L2_c22:
    s_mov_b64 exec, -1
    ds_read_b64 v[86:87], v105
    v_mul_f32 v92, v107, v92
    v_mul_f32 v93, v107, v93
    v_mul_f32 v94, v107, v94
    v_mul_f32 v95, v107, v95
    s_waitcnt vmcnt(11)
    v_and_b32 v108, 0x10000000, v37
    v_lshrrev_b32 v106, 14, v20
    v_bitop3_b32 v106, v106, v8, v108 bitop3:0xea
    ds_read_b64 v[84:85], v106 offset:63616
    s_waitcnt lgkmcnt(1)
    v_mfma_f32_4x4x4_16b_bf16 v[96:99], v[12:13], v[86:87], v[92:95]
    v_perm_b32 v107, v20, v33, s44
    v_bitop3_b32 v104, v20, v8, v108 bitop3:0xea
    v_bitop3_b32 v107, v107, v9, v10 bitop3:0xea
    v_bitop3_b32 v107, v20, v11, v107 bitop3:0xea
    s_nop 0
    v_cvt_pk_bf16_f32 v88, v96, v97
    v_cvt_pk_bf16_f32 v89, v98, v99
    ds_wrxchg_rtn_b64 v[90:91], v105, v[88:89]
    s_waitcnt lgkmcnt(1)
    v_mfma_f32_4x4x4_16b_bf16 v[92:95], v[12:13], v[84:85], 0
    s_waitcnt lgkmcnt(0)
    v_cmpx_ne_u64 vcc, v[90:91], v[86:87]
    s_cbranch_execz L2_c23
    s_nop 2
    v_mfma_f32_4x4x4_16b_bf16 v[100:103], v[14:15], v[86:87], 0
    s_nop 1
    v_mfma_f32_4x4x4_16b_bf16 v[100:103], v[12:13], v[90:91], v[100:103]
    s_nop 4
    v_cvt_pk_bf16_f32 v100, v100, v101
    v_cvt_pk_bf16_f32 v101, v102, v103
    ds_pk_add_bf16 v105, v100
    ds_pk_add_bf16 v105, v101 offset:4
L2_c23:
    s_mov_b64 exec, -1
    ds_read_b64 v[86:87], v104
    v_mul_f32 v92, v107, v92
    v_mul_f32 v93, v107, v93
    v_mul_f32 v94, v107, v94
    v_mul_f32 v95, v107, v95
    v_and_b32 v108, 0x20000000, v37
    v_lshrrev_b32 v106, 14, v21
    v_bitop3_b32 v106, v106, v8, v108 bitop3:0xea
    ds_read_b64 v[84:85], v106 offset:63616
    s_waitcnt lgkmcnt(1)
    v_mfma_f32_4x4x4_16b_bf16 v[96:99], v[12:13], v[86:87], v[92:95]
    v_perm_b32 v107, v21, v33, s45
    v_bitop3_b32 v105, v21, v8, v108 bitop3:0xea
    v_bitop3_b32 v107, v107, v9, v10 bitop3:0xea
    v_bitop3_b32 v107, v21, v11, v107 bitop3:0xea
    s_nop 0
    v_cvt_pk_bf16_f32 v88, v96, v97
    v_cvt_pk_bf16_f32 v89, v98, v99
    ds_wrxchg_rtn_b64 v[90:91], v104, v[88:89]
    s_waitcnt lgkmcnt(1)
    v_mfma_f32_4x4x4_16b_bf16 v[92:95], v[12:13], v[84:85], 0
    s_waitcnt lgkmcnt(0)
    v_cmpx_ne_u64 vcc, v[90:91], v[86:87]
    s_cbranch_execz L2_c24
    s_nop 2
    v_mfma_f32_4x4x4_16b_bf16 v[100:103], v[14:15], v[86:87], 0
    s_nop 1
    v_mfma_f32_4x4x4_16b_bf16 v[100:103], v[12:13], v[90:91], v[100:103]
    s_nop 4
    v_cvt_pk_bf16_f32 v100, v100, v101
    v_cvt_pk_bf16_f32 v101, v102, v103
    ds_pk_add_bf16 v104, v100
    ds_pk_add_bf16 v104, v101 offset:4
L2_c24:
    s_mov_b64 exec, -1
    ds_read_b64 v[86:87], v105
    v_mul_f32 v92, v107, v92
    v_mul_f32 v93, v107, v93
    v_mul_f32 v94, v107, v94
    v_mul_f32 v95, v107, v95
    v_and_b32 v108, 0x40000000, v37
    v_lshrrev_b32 v106, 14, v22
    v_bitop3_b32 v106, v106, v8, v108 bitop3:0xea
    ds_read_b64 v[84:85], v106 offset:63616
    s_waitcnt lgkmcnt(1)
    v_mfma_f32_4x4x4_16b_bf16 v[96:99], v[12:13], v[86:87], v[92:95]
    v_perm_b32 v107, v22, v33, s46
    v_bitop3_b32 v104, v22, v8, v108 bitop3:0xea
    v_bitop3_b32 v107, v107, v9, v10 bitop3:0xea
    v_bitop3_b32 v107, v22, v11, v107 bitop3:0xea
    s_nop 0
    v_cvt_pk_bf16_f32 v88, v96, v97
    v_cvt_pk_bf16_f32 v89, v98, v99
    ds_wrxchg_rtn_b64 v[90:91], v105, v[88:89]
    s_waitcnt lgkmcnt(1)
    v_mfma_f32_4x4x4_16b_bf16 v[92:95], v[12:13], v[84:85], 0
    s_waitcnt lgkmcnt(0)
    v_cmpx_ne_u64 vcc, v[90:91], v[86:87]
    s_cbranch_execz L2_c25
    s_nop 2
    v_mfma_f32_4x4x4_16b_bf16 v[100:103], v[14:15], v[86:87], 0
    s_nop 1
    v_mfma_f32_4x4x4_16b_bf16 v[100:103], v[12:13], v[90:91], v[100:103]
    s_nop 4
    v_cvt_pk_bf16_f32 v100, v100, v101
    v_cvt_pk_bf16_f32 v101, v102, v103
    ds_pk_add_bf16 v105, v100
    ds_pk_add_bf16 v105, v101 offset:4
L2_c25:
    s_mov_b64 exec, -1
    ds_read_b64 v[86:87], v104
    v_mul_f32 v92, v107, v92
    v_mul_f32 v93, v107, v93
    v_mul_f32 v94, v107, v94
    v_mul_f32 v95, v107, v95
    v_and_b32 v108, 0x80000000, v37
    v_lshrrev_b32 v106, 14, v23
    v_bitop3_b32 v106, v106, v8, v108 bitop3:0xea
    ds_read_b64 v[84:85], v106 offset:63616
    s_waitcnt lgkmcnt(1)
    v_mfma_f32_4x4x4_16b_bf16 v[96:99], v[12:13], v[86:87], v[92:95]
    v_perm_b32 v107, v23, v33, s47
    v_bitop3_b32 v105, v23, v8, v108 bitop3:0xea
    v_bitop3_b32 v107, v107, v9, v10 bitop3:0xea
    v_bitop3_b32 v107, v23, v11, v107 bitop3:0xea
    v_and_b32 v109, 0x0fffffff, v41
    v_mov_b32 v37, v41
    buffer_load_dwordx4 v[20:23], v109, s[8:11], 0 offen
    buffer_load_dword v33, v109, s[8:11], 0 offen offset:16
    v_cvt_pk_bf16_f32 v88, v96, v97
    v_cvt_pk_bf16_f32 v89, v98, v99
    ds_wrxchg_rtn_b64 v[90:91], v104, v[88:89]
    s_waitcnt lgkmcnt(1)
    v_mfma_f32_4x4x4_16b_bf16 v[92:95], v[12:13], v[84:85], 0
    s_waitcnt lgkmcnt(0)
    v_cmpx_ne_u64 vcc, v[90:91], v[86:87]
    s_cbranch_execz L2_c26
    s_nop 2
    v_mfma_f32_4x4x4_16b_bf16 v[100:103], v[14:15], v[86:87], 0
    s_nop 1
    v_mfma_f32_4x4x4_16b_bf16 v[100:103], v[12:13], v[90:91], v[100:103]
    s_nop 4
    v_cvt_pk_bf16_f32 v100, v100, v101
    v_cvt_pk_bf16_f32 v101, v102, v103
    ds_pk_add_bf16 v104, v100
    ds_pk_add_bf16 v104, v101 offset:4
L2_c26:
    s_mov_b64 exec, -1
    ds_read_b64 v[86:87], v105
    v_mul_f32 v92, v107, v92
    v_mul_f32 v93, v107, v93
    v_mul_f32 v94, v107, v94
    v_mul_f32 v95, v107, v95
    s_waitcnt vmcnt(11)
    v_and_b32 v108, 0x10000000, v38
    v_lshrrev_b32 v106, 14, v24
    v_bitop3_b32 v106, v106, v8, v108 bitop3:0xea
    ds_read_b64 v[84:85], v106 offset:63616
    s_waitcnt lgkmcnt(1)
    v_mfma_f32_4x4x4_16b_bf16 v[96:99], v[12:13], v[86:87], v[92:95]
    v_perm_b32 v107, v24, v34, s44
    v_bitop3_b32 v104, v24, v8, v108 bitop3:0xea
    v_bitop3_b32 v107, v107, v9, v10 bitop3:0xea
    v_bitop3_b32 v107, v24, v11, v107 bitop3:0xea
    s_nop 0
    v_cvt_pk_bf16_f32 v88, v96, v97
    v_cvt_pk_bf16_f32 v89, v98, v99
    ds_wrxchg_rtn_b64 v[90:91], v105, v[88:89]
    s_waitcnt lgkmcnt(1)
    v_mfma_f32_4x4x4_16b_bf16 v[92:95], v[12:13], v[84:85], 0
    s_waitcnt lgkmcnt(0)
    v_cmpx_ne_u64 vcc, v[90:91], v[86:87]
    s_cbranch_execz L2_c27
    s_nop 2
    v_mfma_f32_4x4x4_16b_bf16 v[100:103], v[14:15], v[86:87], 0
    s_nop 1
    v_mfma_f32_4x4x4_16b_bf16 v[100:103], v[12:13], v[90:91], v[100:103]
    s_nop 4
    v_cvt_pk_bf16_f32 v100, v100, v101
    v_cvt_pk_bf16_f32 v101, v102, v103
    ds_pk_add_bf16 v105, v100
    ds_pk_add_bf16 v105, v101 offset:4
L2_c27:
    s_mov_b64 exec, -1
    ds_read_b64 v[86:87], v104
    v_mul_f32 v92, v107, v92
    v_mul_f32 v93, v107, v93
    v_mul_f32 v94, v107, v94
    v_mul_f32 v95, v107, v95
    v_and_b32 v108, 0x20000000, v38
    v_lshrrev_b32 v106, 14, v25
    v_bitop3_b32 v106, v106, v8, v108 bitop3:0xea
    ds_read_b64 v[84:85], v106 offset:63616
    s_waitcnt lgkmcnt(1)
    v_mfma_f32_4x4x4_16b_bf16 v[96:99], v[12:13], v[86:87], v[92:95]
    v_perm_b32 v107, v25, v34, s45
    v_bitop3_b32 v105, v25, v8, v108 bitop3:0xea
    v_bitop3_b32 v107, v107, v9, v10 bitop3:0xea
    v_bitop3_b32 v107, v25, v11, v107 bitop3:0xea
    s_nop 0
    v_cvt_pk_bf16_f32 v88, v96, v97
    v_cvt_pk_bf16_f32 v89, v98, v99
    ds_wrxchg_rtn_b64 v[90:91], v104, v[88:89]
    s_waitcnt lgkmcnt(1)
    v_mfma_f32_4x4x4_16b_bf16 v[92:95], v[12:13], v[84:85], 0
    s_waitcnt lgkmcnt(0)
    v_cmpx_ne_u64 vcc, v[90:91], v[86:87]
    s_cbranch_execz L2_c28
    s_nop 2
    v_mfma_f32_4x4x4_16b_bf16 v[100:103], v[14:15], v[86:87], 0
    s_nop 1
    v_mfma_f32_4x4x4_16b_bf16 v[100:103], v[12:13], v[90:91], v[100:103]
    s_nop 4
    v_cvt_pk_bf16_f32 v100, v100, v101
    v_cvt_pk_bf16_f32 v101, v102, v103
    ds_pk_add_bf16 v104, v100
    ds_pk_add_bf16 v104, v101 offset:4
L2_c28:
    s_mov_b64 exec, -1
    ds_read_b64 v[86:87], v105
    v_mul_f32 v92, v107, v92
    v_mul_f32 v93, v107, v93
    v_mul_f32 v94, v107, v94
    v_mul_f32 v95, v107, v95
    v_and_b32 v108, 0x40000000, v38
    v_lshrrev_b32 v106, 14, v26
    v_bitop3_b32 v106, v106, v8, v108 bitop3:0xea
    ds_read_b64 v[84:85], v106 offset:63616
    s_waitcnt lgkmcnt(1)
    v_mfma_f32_4x4x4_16b_bf16 v[96:99], v[12:13], v[86:87], v[92:95]
    v_perm_b32 v107, v26, v34, s46
    v_bitop3_b32 v104, v26, v8, v108 bitop3:0xea
    v_bitop3_b32 v107, v107, v9, v10 bitop3:0xea
    v_bitop3_b32 v107, v26, v11, v107 bitop3:0xea
    s_nop 0
    v_cvt_pk_bf16_f32 v88, v96, v97
    v_cvt_pk_bf16_f32 v89, v98, v99
    ds_wrxchg_rtn_b64 v[90:91], v105, v[88:89]
    s_waitcnt lgkmcnt(1)
    v_mfma_f32_4x4x4_16b_bf16 v[92:95], v[12:13], v[84:85], 0
    s_waitcnt lgkmcnt(0)
    v_cmpx_ne_u64 vcc, v[90:91], v[86:87]
    s_cbranch_execz L2_c29
    s_nop 2
    v_mfma_f32_4x4x4_16b_bf16 v[100:103], v[14:15], v[86:87], 0
    s_nop 1
    v_mfma_f32_4x4x4_16b_bf16 v[100:103], v[12:13], v[90:91], v[100:103]
    s_nop 4
    v_cvt_pk_bf16_f32 v100, v100, v101
    v_cvt_pk_bf16_f32 v101, v102, v103
    ds_pk_add_bf16 v105, v100
    ds_pk_add_bf16 v105, v101 offset:4
L2_c29:
    s_mov_b64 exec, -1
    ds_read_b64 v[86:87], v104
    v_mul_f32 v92, v107, v92
    v_mul_f32 v93, v107, v93
    v_mul_f32 v94, v107, v94
    v_mul_f32 v95, v107, v95
    v_and_b32 v108, 0x80000000, v38
    v_lshrrev_b32 v106, 14, v27
    v_bitop3_b32 v106, v106, v8, v108 bitop3:0xea
    ds_read_b64 v[84:85], v106 offset:63616
    s_waitcnt lgkmcnt(1)
    v_mfma_f32_4x4x4_16b_bf16 v[96:99], v[12:13], v[86:87], v[92:95]
    v_perm_b32 v107, v27, v34, s47
    v_bitop3_b32 v105, v27, v8, v108 bitop3:0xea
    v_bitop3_b32 v107, v107, v9, v10 bitop3:0xea
    v_bitop3_b32 v107, v27, v11, v107 bitop3:0xea
    v_and_b32 v109, 0x0fffffff, v42
    v_mov_b32 v38, v42
    buffer_load_dwordx4 v[24:27], v109, s[8:11], 0 offen
    buffer_load_dword v34, v109, s[8:11], 0 offen offset:16
    v_cvt_pk_bf16_f32 v88, v96, v97
    v_cvt_pk_bf16_f32 v89, v98, v99
    ds_wrxchg_rtn_b64 v[90:91], v104, v[88:89]
    s_waitcnt lgkmcnt(1)
    v_mfma_f32_4x4x4_16b_bf16 v[92:95], v[12:13], v[84:85], 0
    s_waitcnt lgkmcnt(0)
    v_cmpx_ne_u64 vcc, v[90:91], v[86:87]
    s_cbranch_execz L2_c30
    s_nop 2
    v_mfma_f32_4x4x4_16b_bf16 v[100:103], v[14:15], v[86:87], 0
    s_nop 1
    v_mfma_f32_4x4x4_16b_bf16 v[100:103], v[12:13], v[90:91], v[100:103]
    s_nop 4
    v_cvt_pk_bf16_f32 v100, v100, v101
    v_cvt_pk_bf16_f32 v101, v102, v103
    ds_pk_add_bf16 v104, v100
    ds_pk_add_bf16 v104, v101 offset:4
L2_c30:
    s_mov_b64 exec, -1
    ds_read_b64 v[86:87], v105
    v_mul_f32 v92, v107, v92
    v_mul_f32 v93, v107, v93
    v_mul_f32 v94, v107, v94
    v_mul_f32 v95, v107, v95
    s_waitcnt vmcnt(11)
    v_and_b32 v108, 0x10000000, v39
    v_lshrrev_b32 v106, 14, v28
    v_bitop3_b32 v106, v106, v8, v108 bitop3:0xea
    ds_read_b64 v[84:85], v106 offset:63616
    s_waitcnt lgkmcnt(1)
    v_mfma_f32_4x4x4_16b_bf16 v[96:99], v[12:13], v[86:87], v[92:95]
    v_perm_b32 v107, v28, v35, s44
    v_bitop3_b32 v104, v28, v8, v108 bitop3:0xea
    v_bitop3_b32 v107, v107, v9, v10 bitop3:0xea
    v_bitop3_b32 v107, v28, v11, v107 bitop3:0xea
    s_nop 0
    v_cvt_pk_bf16_f32 v88, v96, v97
    v_cvt_pk_bf16_f32 v89, v98, v99
    ds_wrxchg_rtn_b64 v[90:91], v105, v[88:89]
    s_waitcnt lgkmcnt(1)
    v_mfma_f32_4x4x4_16b_bf16 v[92:95], v[12:13], v[84:85], 0
    s_waitcnt lgkmcnt(0)
    v_cmpx_ne_u64 vcc, v[90:91], v[86:87]
    s_cbranch_execz L2_c31
    s_nop 2
    v_mfma_f32_4x4x4_16b_bf16 v[100:103], v[14:15], v[86:87], 0
    s_nop 1
    v_mfma_f32_4x4x4_16b_bf16 v[100:103], v[12:13], v[90:91], v[100:103]
    s_nop 4
    v_cvt_pk_bf16_f32 v100, v100, v101
    v_cvt_pk_bf16_f32 v101, v102, v103
    ds_pk_add_bf16 v105, v100
    ds_pk_add_bf16 v105, v101 offset:4
L2_c31:
    s_mov_b64 exec, -1
    ds_read_b64 v[86:87], v104
    v_mul_f32 v92, v107, v92
    v_mul_f32 v93, v107, v93
    v_mul_f32 v94, v107, v94
    v_mul_f32 v95, v107, v95
    v_and_b32 v108, 0x20000000, v39
    v_lshrrev_b32 v106, 14, v29
    v_bitop3_b32 v106, v106, v8, v108 bitop3:0xea
    ds_read_b64 v[84:85], v106 offset:63616
    s_waitcnt lgkmcnt(1)
    v_mfma_f32_4x4x4_16b_bf16 v[96:99], v[12:13], v[86:87], v[92:95]
    v_perm_b32 v107, v29, v35, s45
    v_bitop3_b32 v105, v29, v8, v108 bitop3:0xea
    v_bitop3_b32 v107, v107, v9, v10 bitop3:0xea
    v_bitop3_b32 v107, v29, v11, v107 bitop3:0xea
    s_nop 0
    v_cvt_pk_bf16_f32 v88, v96, v97
    v_cvt_pk_bf16_f32 v89, v98, v99
    ds_wrxchg_rtn_b64 v[90:91], v104, v[88:89]
    s_waitcnt lgkmcnt(1)
    v_mfma_f32_4x4x4_16b_bf16 v[92:95], v[12:13], v[84:85], 0
    s_waitcnt lgkmcnt(0)
    v_cmpx_ne_u64 vcc, v[90:91], v[86:87]
    s_cbranch_execz L2_c32
    s_nop 2
    v_mfma_f32_4x4x4_16b_bf16 v[100:103], v[14:15], v[86:87], 0
    s_nop 1
    v_mfma_f32_4x4x4_16b_bf16 v[100:103], v[12:13], v[90:91], v[100:103]
    s_nop 4
    v_cvt_pk_bf16_f32 v100, v100, v101
    v_cvt_pk_bf16_f32 v101, v102, v103
    ds_pk_add_bf16 v104, v100
    ds_pk_add_bf16 v104, v101 offset:4
L2_c32:
    s_mov_b64 exec, -1
    ds_read_b64 v[86:87], v105
    v_mul_f32 v92, v107, v92
    v_mul_f32 v93, v107, v93
    v_mul_f32 v94, v107, v94
    v_mul_f32 v95, v107, v95
    v_and_b32 v108, 0x40000000, v39
    v_lshrrev_b32 v106, 14, v30
    v_bitop3_b32 v106, v106, v8, v108 bitop3:0xea
    ds_read_b64 v[84:85], v106 offset:63616
    s_waitcnt lgkmcnt(1)
    v_mfma_f32_4x4x4_16b_bf16 v[96:99], v[12:13], v[86:87], v[92:95]
    v_perm_b32 v107, v30, v35, s46
    v_bitop3_b32 v104, v30, v8, v108 bitop3:0xea
    v_bitop3_b32 v107, v107, v9, v10 bitop3:0xea
    v_bitop3_b32 v107, v30, v11, v107 bitop3:0xea
    s_nop 0
    v_cvt_pk_bf16_f32 v88, v96, v97
    v_cvt_pk_bf16_f32 v89, v98, v99
    ds_wrxchg_rtn_b64 v[90:91], v105, v[88:89]
    s_waitcnt lgkmcnt(1)
    v_mfma_f32_4x4x4_16b_bf16 v[92:95], v[12:13], v[84:85], 0
    s_waitcnt lgkmcnt(0)
    v_cmpx_ne_u64 vcc, v[90:91], v[86:87]
    s_cbranch_execz L2_c33
    s_nop 2
    v_mfma_f32_4x4x4_16b_bf16 v[100:103], v[14:15], v[86:87], 0
    s_nop 1
    v_mfma_f32_4x4x4_16b_bf16 v[100:103], v[12:13], v[90:91], v[100:103]
    s_nop 4
    v_cvt_pk_bf16_f32 v100, v100, v101
    v_cvt_pk_bf16_f32 v101, v102, v103
    ds_pk_add_bf16 v105, v100
    ds_pk_add_bf16 v105, v101 offset:4
L2_c33:
    s_mov_b64 exec, -1
    ds_read_b64 v[86:87], v104
    v_mul_f32 v92, v107, v92
    v_mul_f32 v93, v107, v93
    v_mul_f32 v94, v107, v94
    v_mul_f32 v95, v107, v95
    v_and_b32 v108, 0x80000000, v39
    v_lshrrev_b32 v106, 14, v31
    v_bitop3_b32 v106, v106, v8, v108 bitop3:0xea
    ds_read_b64 v[84:85], v106 offset:63616
    s_waitcnt lgkmcnt(1)
    v_mfma_f32_4x4x4_16b_bf16 v[96:99], v[12:13], v[86:87], v[92:95]
    v_perm_b32 v107, v31, v35, s47
    v_bitop3_b32 v105, v31, v8, v108 bitop3:0xea
    v_bitop3_b32 v107, v107, v9, v10 bitop3:0xea
    v_bitop3_b32 v107, v31, v11, v107 bitop3:0xea
    v_and_b32 v109, 0x0fffffff, v43
    v_mov_b32 v39, v43
    buffer_load_dwordx4 v[28:31], v109, s[8:11], 0 offen
    buffer_load_dword v35, v109, s[8:11], 0 offen offset:16
    v_cvt_pk_bf16_f32 v88, v96, v97
    v_cvt_pk_bf16_f32 v89, v98, v99
    ds_wrxchg_rtn_b64 v[90:91], v104, v[88:89]
    s_waitcnt lgkmcnt(1)
    v_mfma_f32_4x4x4_16b_bf16 v[92:95], v[12:13], v[84:85], 0
    s_waitcnt lgkmcnt(0)
    v_cmpx_ne_u64 vcc, v[90:91], v[86:87]
    s_cbranch_execz L2_c34
    s_nop 2
    v_mfma_f32_4x4x4_16b_bf16 v[100:103], v[14:15], v[86:87], 0
    s_nop 1
    v_mfma_f32_4x4x4_16b_bf16 v[100:103], v[12:13], v[90:91], v[100:103]
    s_nop 4
    v_cvt_pk_bf16_f32 v100, v100, v101
    v_cvt_pk_bf16_f32 v101, v102, v103
    ds_pk_add_bf16 v104, v100
    ds_pk_add_bf16 v104, v101 offset:4
L2_c34:
    s_mov_b64 exec, -1
    ds_read_b64 v[86:87], v105
    v_mul_f32 v92, v107, v92
    v_mul_f32 v93, v107, v93
    v_mul_f32 v94, v107, v94
    v_mul_f32 v95, v107, v95
    s_waitcnt lgkmcnt(0)
    s_nop 0
    v_mfma_f32_4x4x4_16b_bf16 v[96:99], v[12:13], v[86:87], v[92:95]
    s_nop 4
    v_cvt_pk_bf16_f32 v88, v96, v97
    v_cvt_pk_bf16_f32 v89, v98, v99
    ds_wrxchg_rtn_b64 v[90:91], v105, v[88:89]
    s_waitcnt lgkmcnt(0)
    v_cmpx_ne_u64 vcc, v[90:91], v[86:87]
    s_cbranch_execz L2_c35
    s_nop 2
    v_mfma_f32_4x4x4_16b_bf16 v[100:103], v[14:15], v[86:87], 0
    s_nop 1
    v_mfma_f32_4x4x4_16b_bf16 v[100:103], v[12:13], v[90:91], v[100:103]
    s_nop 4
    v_cvt_pk_bf16_f32 v100, v100, v101
    v_cvt_pk_bf16_f32 v101, v102, v103
    ds_pk_add_bf16 v105, v100
    ds_pk_add_bf16 v105, v101 offset:4
L2_c35:
    s_mov_b64 exec, -1
    s_bitcmp1_b32 s36, s42
    s_cbranch_scc1 L2_slow
L2_ret1:
    s_barrier
    s_waitcnt vmcnt(8)
    s_mov_b32 s37, s38
    s_add_u32 s48, s38, 257
    v_lshrrev_b32 v110, 16, v65
    v_lshrrev_b32 v111, 16, v67
    v_and_b32 v112, -4, v110
    v_add_u32 v112, v112, v2
L2_x36_0:
    v_sub_u32 v113, v111, v112
    v_sub_u32 v115, v110, v112
    v_med3_i32 v114, v113, 0, 4
    v_max_i32 v115, 0, v115
    v_cmp_gt_i32 vcc, v114, v115
    v_mad_u32_u24 v116, v112, 5, v4
    v_bfm_b32 v114, v114, 28
    v_bfm_b32 v115, v115, 28
    v_mbcnt_lo_u32_b32 v117, vcc_lo, 0
    v_mbcnt_hi_u32_b32 v117, vcc_hi, v117
    v_bitop3_b32 v116, v114, v115, v116 bitop3:0x9a
    v_add_lshl_u32 v117, v117, s37, 2
    s_bcnt1_i32_b64 s41, vcc
    s_mov_b64 exec, vcc
    ds_write_b32 v117, v116
    s_mov_b64 exec, -1
    v_cmp_gt_i32 vcc, v113, v3
    s_add_u32 s37, s37, s41
    s_min_u32 s37, s37, s48
    s_cbranch_vccnz L2_xe36_0
L2_xr36_0:
    ds_write_b128 v7, v[52:55] offset:2048
    v_lshrrev_b32 v110, 16, v69
    v_lshrrev_b32 v111, 16, v71
    v_and_b32 v112, -4, v110
    v_add_u32 v112, v112, v2
    v_add_u32 v118, 0x2800000, v4
L2_x36_1:
    v_sub_u32 v113, v111, v112
    v_sub_u32 v115, v110, v112
    v_med3_i32 v114, v113, 0, 4
    v_max_i32 v115, 0, v115
    v_cmp_gt_i32 vcc, v114, v115
    v_mad_u32_u24 v116, v112, 5, v118
    v_bfm_b32 v114, v114, 28
    v_bfm_b32 v115, v115, 28
    v_mbcnt_lo_u32_b32 v117, vcc_lo, 0
    v_mbcnt_hi_u32_b32 v117, vcc_hi, v117
    v_bitop3_b32 v116, v114, v115, v116 bitop3:0x9a
    v_add_lshl_u32 v117, v117, s37, 2
    s_bcnt1_i32_b64 s41, vcc
    s_mov_b64 exec, vcc
    ds_write_b32 v117, v116
    s_mov_b64 exec, -1
    v_cmp_gt_i32 vcc, v113, v3
    s_add_u32 s37, s37, s41
    s_min_u32 s37, s37, s48
    s_cbranch_vccnz L2_xe36_1
L2_xr36_1:
    ds_write_b128 v7, v[56:59] offset:3072
    v_lshrrev_b32 v110, 16, v73
    v_lshrrev_b32 v111, 16, v75
    v_and_b32 v112, -4, v110
    v_add_u32 v112, v112, v2
    v_add_u32 v118, 0x5000000, v4
L2_x36_2:
    v_sub_u32 v113, v111, v112
    v_sub_u32 v115, v110, v112
    v_med3_i32 v114, v113, 0, 4
    v_max_i32 v115, 0, v115
    v_cmp_gt_i32 vcc, v114, v115
    v_mad_u32_u24 v116, v112, 5, v118
    v_bfm_b32 v114, v114, 28
    v_bfm_b32 v115, v115, 28
    v_mbcnt_lo_u32_b32 v117, vcc_lo, 0
    v_mbcnt_hi_u32_b32 v117, vcc_hi, v117
    v_bitop3_b32 v116, v114, v115, v116 bitop3:0x9a
    v_add_lshl_u32 v117, v117, s37, 2
    s_bcnt1_i32_b64 s41, vcc
    s_mov_b64 exec, vcc
    ds_write_b32 v117, v116
    s_mov_b64 exec, -1
    v_cmp_gt_i32 vcc, v113, v3
    s_add_u32 s37, s37, s41
    s_min_u32 s37, s37, s48
    s_cbranch_vccnz L2_xe36_2
L2_xr36_2:
    ds_write_b128 v7, v[60:63] offset:4096
    v_lshrrev_b32 v110, 16, v77
    v_lshrrev_b32 v111, 16, v79
    v_and_b32 v112, -4, v110
    v_add_u32 v112, v112, v2
    v_add_u32 v118, 0x7800000, v4
L2_x36_3:
    v_sub_u32 v113, v111, v112
    v_sub_u32 v115, v110, v112
    v_med3_i32 v114, v113, 0, 4
    v_max_i32 v115, 0, v115
    v_cmp_gt_i32 vcc, v114, v115
    v_mad_u32_u24 v116, v112, 5, v118
    v_bfm_b32 v114, v114, 28
    v_bfm_b32 v115, v115, 28
    v_mbcnt_lo_u32_b32 v117, vcc_lo, 0
    v_mbcnt_hi_u32_b32 v117, vcc_hi, v117
    v_bitop3_b32 v116, v114, v115, v116 bitop3:0x9a
    v_add_lshl_u32 v117, v117, s37, 2
    s_bcnt1_i32_b64 s41, vcc
    s_mov_b64 exec, vcc
    ds_write_b32 v117, v116
    s_mov_b64 exec, -1
    v_cmp_gt_i32 vcc, v113, v3
    s_add_u32 s37, s37, s41
    s_min_u32 s37, s37, s48
    s_cbranch_vccnz L2_xe36_3
L2_xr36_3:
    v_lshrrev_b32 v110, 16, v81
    v_lshrrev_b32 v111, 16, v83
    v_and_b32 v112, -4, v110
    v_add_u32 v112, v112, v2
    v_add_u32 v118, 0xa000000, v4
L2_x36_4:
    v_sub_u32 v113, v111, v112
    v_sub_u32 v115, v110, v112
    v_med3_i32 v114, v113, 0, 4
    v_max_i32 v115, 0, v115
    v_cmp_gt_i32 vcc, v114, v115
    v_mad_u32_u24 v116, v112, 5, v118
    v_bfm_b32 v114, v114, 28
    v_bfm_b32 v115, v115, 28
    v_mbcnt_lo_u32_b32 v117, vcc_lo, 0
    v_mbcnt_hi_u32_b32 v117, vcc_hi, v117
    v_bitop3_b32 v116, v114, v115, v116 bitop3:0x9a
    v_add_lshl_u32 v117, v117, s37, 2
    s_bcnt1_i32_b64 s41, vcc
    s_mov_b64 exec, vcc
    ds_write_b32 v117, v116
    s_mov_b64 exec, -1
    v_cmp_gt_i32 vcc, v113, v3
    s_add_u32 s37, s37, s41
    s_min_u32 s37, s37, s48
    s_cbranch_vccnz L2_xe36_4
L2_xr36_4:
    s_lshl_b32 s3, s37, 2
    v_add_u32 v117, s3, v1
    v_mov_b32 v116, -1
    ds_write_b32 v117, v116
    s_lshl_b32 s3, s38, 2
    v_add_u32 v117, s3, v1
    ds_read2st64_b32 v[40:41], v117 offset0:0 offset1:1
    ds_read2st64_b32 v[42:43], v117 offset0:2 offset1:3
    s_sub_u32 s41, s37, s38
    s_sub_u32 s3, s41, 192
    s_cmp_gt_u32 s3, 64
    s_cbranch_scc1 L2_xf36
L2_xg36:
    ds_write_b128 v7, v[44:47] offset:0
    ds_write_b128 v7, v[48:51] offset:1024
    s_cmp_eq_u32 s35, 3
    s_cselect_b32 s14, 0, s14
    s_mul_i32 s3, s35, 520
    s_add_u32 s3, s3, 520
    s_add_u32 s49, s3, s39
    buffer_load_dwordx4 v[64:67], v5, s[12:15], s49 offen
    v_add_u32 v111, 0x208000, v5
    buffer_load_dwordx4 v[68:71], v111, s[12:15], s49 offen
    v_add_u32 v112, 0x410000, v5
    buffer_load_dwordx4 v[72:75], v112, s[12:15], s49 offen
    v_add_u32 v113, 0x618000, v5
    buffer_load_dwordx4 v[76:79], v113, s[12:15], s49 offen
    v_add_u32 v114, 0x820000, v5
    buffer_load_dwordx4 v[80:83], v114, s[12:15], s49 offen
    buffer_load_dwordx4 v[44:47], v6, s[16:19], s40 offen offset:0
    buffer_load_dwordx4 v[48:51], v6, s[16:19], s40 offen offset:1024
    buffer_load_dwordx4 v[52:55], v6, s[16:19], s40 offen offset:2048
    buffer_load_dwordx4 v[56:59], v6, s[16:19], s40 offen offset:3072
    s_add_u32 s3, s40, 4096
    buffer_load_dwordx4 v[60:63], v6, s[16:19], s3 offen
    s_add_u32 s40, s40, 80000
    s_add_u32 s42, s42, 1
    s_waitcnt lgkmcnt(0)
    s_barrier
    s_waitcnt vmcnt(16)
    v_and_b32 v108, 0x10000000, v36
    v_lshrrev_b32 v106, 14, v16
    v_bitop3_b32 v106, v106, v8, v108 bitop3:0xea
    ds_read_b64 v[84:85], v106 offset:63616
    v_perm_b32 v107, v16, v32, s44
    v_bitop3_b32 v104, v16, v8, v108 bitop3:0xea
    v_bitop3_b32 v107, v107, v9, v10 bitop3:0xea
    v_bitop3_b32 v107, v16, v11, v107 bitop3:0xea
    s_waitcnt lgkmcnt(0)
    v_mfma_f32_4x4x4_16b_bf16 v[92:95], v[12:13], v[84:85], 0
    ds_read_b64 v[86:87], v104
    s_nop 3
    v_mul_f32 v92, v107, v92
    v_mul_f32 v93, v107, v93
    v_mul_f32 v94, v107, v94
    v_mul_f32 v95, v107, v95
    v_and_b32 v108, 0x20000000, v36
    v_lshrrev_b32 v106, 14, v17
    v_bitop3_b32 v106, v106, v8, v108 bitop3:0xea
    ds_read_b64 v[84:85], v106 offset:63616
    s_waitcnt lgkmcnt(1)
    v_mfma_f32_4x4x4_16b_bf16 v[96:99], v[12:13], v[86:87], v[92:95]
    v_perm_b32 v107, v17, v32, s45
    v_bitop3_b32 v105, v17, v8, v108 bitop3:0xea
    v_bitop3_b32 v107, v107, v9, v10 bitop3:0xea
    v_bitop3_b32 v107, v17, v11, v107 bitop3:0xea
    s_nop 0
    v_cvt_pk_bf16_f32 v88, v96, v97
    v_cvt_pk_bf16_f32 v89, v98, v99
    ds_wrxchg_rtn_b64 v[90:91], v104, v[88:89]
    s_waitcnt lgkmcnt(1)
    v_mfma_f32_4x4x4_16b_bf16 v[92:95], v[12:13], v[84:85], 0
    s_waitcnt lgkmcnt(0)
    v_cmpx_ne_u64 vcc, v[90:91], v[86:87]
    s_cbranch_execz L2_c37
    s_nop 2
    v_mfma_f32_4x4x4_16b_bf16 v[100:103], v[14:15], v[86:87], 0
    s_nop 1
    v_mfma_f32_4x4x4_16b_bf16 v[100:103], v[12:13], v[90:91], v[100:103]
    s_nop 4
    v_cvt_pk_bf16_f32 v100, v100, v101
    v_cvt_pk_bf16_f32 v101, v102, v103
    ds_pk_add_bf16 v104, v100
    ds_pk_add_bf16 v104, v101 offset:4
L2_c37:
    s_mov_b64 exec, -1
    ds_read_b64 v[86:87], v105
    v_mul_f32 v92, v107, v92
    v_mul_f32 v93, v107, v93
    v_mul_f32 v94, v107, v94
    v_mul_f32 v95, v107, v95
    v_and_b32 v108, 0x40000000, v36
    v_lshrrev_b32 v106, 14, v18
    v_bitop3_b32 v106, v106, v8, v108 bitop3:0xea
    ds_read_b64 v[84:85], v106 offset:63616
    s_waitcnt lgkmcnt(1)
    v_mfma_f32_4x4x4_16b_bf16 v[96:99], v[12:13], v[86:87], v[92:95]
    v_perm_b32 v107, v18, v32, s46
    v_bitop3_b32 v104, v18, v8, v108 bitop3:0xea
    v_bitop3_b32 v107, v107, v9, v10 bitop3:0xea
    v_bitop3_b32 v107, v18, v11, v107 bitop3:0xea
    s_nop 0
    v_cvt_pk_bf16_f32 v88, v96, v97
    v_cvt_pk_bf16_f32 v89, v98, v99
    ds_wrxchg_rtn_b64 v[90:91], v105, v[88:89]
    s_waitcnt lgkmcnt(1)
    v_mfma_f32_4x4x4_16b_bf16 v[92:95], v[12:13], v[84:85], 0
    s_waitcnt lgkmcnt(0)
    v_cmpx_ne_u64 vcc, v[90:91], v[86:87]
    s_cbranch_execz L2_c38
    s_nop 2
    v_mfma_f32_4x4x4_16b_bf16 v[100:103], v[14:15], v[86:87], 0
    s_nop 1
    v_mfma_f32_4x4x4_16b_bf16 v[100:103], v[12:13], v[90:91], v[100:103]
    s_nop 4
    v_cvt_pk_bf16_f32 v100, v100, v101
    v_cvt_pk_bf16_f32 v101, v102, v103
    ds_pk_add_bf16 v105, v100
    ds_pk_add_bf16 v105, v101 offset:4
L2_c38:
    s_mov_b64 exec, -1
    ds_read_b64 v[86:87], v104
    v_mul_f32 v92, v107, v92
    v_mul_f32 v93, v107, v93
    v_mul_f32 v94, v107, v94
    v_mul_f32 v95, v107, v95
    v_and_b32 v108, 0x80000000, v36
    v_lshrrev_b32 v106, 14, v19
    v_bitop3_b32 v106, v106, v8, v108 bitop3:0xea
    ds_read_b64 v[84:85], v106 offset:63616
    s_waitcnt lgkmcnt(1)
    v_mfma_f32_4x4x4_16b_bf16 v[96:99], v[12:13], v[86:87], v[92:95]
    v_perm_b32 v107, v19, v32, s47
    v_bitop3_b32 v105, v19, v8, v108 bitop3:0xea
    v_bitop3_b32 v107, v107, v9, v10 bitop3:0xea
    v_bitop3_b32 v107, v19, v11, v107 bitop3:0xea
    v_and_b32 v109, 0x0fffffff, v40
    v_mov_b32 v36, v40
    buffer_load_dwordx4 v[16:19], v109, s[8:11], 0 offen
    buffer_load_dword v32, v109, s[8:11], 0 offen offset:16
    v_cvt_pk_bf16_f32 v88, v96, v97
    v_cvt_pk_bf16_f32 v89, v98, v99
    ds_wrxchg_rtn_b64 v[90:91], v104, v[88:89]
    s_waitcnt lgkmcnt(1)
    v_mfma_f32_4x4x4_16b_bf16 v[92:95], v[12:13], v[84:85], 0
    s_waitcnt lgkmcnt(0)
    v_cmpx_ne_u64 vcc, v[90:91], v[86:87]
    s_cbranch_execz L2_c39
    s_nop 2
    v_mfma_f32_4x4x4_16b_bf16 v[100:103], v[14:15], v[86:87], 0
    s_nop 1
    v_mfma_f32_4x4x4_16b_bf16 v[100:103], v[12:13], v[90:91], v[100:103]
    s_nop 4
    v_cvt_pk_bf16_f32 v100, v100, v101
    v_cvt_pk_bf16_f32 v101, v102, v103
    ds_pk_add_bf16 v104, v100
    ds_pk_add_bf16 v104, v101 offset:4
L2_c39:
    s_mov_b64 exec, -1
    ds_read_b64 v[86:87], v105
    v_mul_f32 v92, v107, v92
    v_mul_f32 v93, v107, v93
    v_mul_f32 v94, v107, v94
    v_mul_f32 v95, v107, v95
    s_waitcnt vmcnt(16)
    v_and_b32 v108, 0x10000000, v37
    v_lshrrev_b32 v106, 14, v20
    v_bitop3_b32 v106, v106, v8, v108 bitop3:0xea
    ds_read_b64 v[84:85], v106 offset:63616
    s_waitcnt lgkmcnt(1)
    v_mfma_f32_4x4x4_16b_bf16 v[96:99], v[12:13], v[86:87], v[92:95]
    v_perm_b32 v107, v20, v33, s44
    v_bitop3_b32 v104, v20, v8, v108 bitop3:0xea
    v_bitop3_b32 v107, v107, v9, v10 bitop3:0xea
    v_bitop3_b32 v107, v20, v11, v107 bitop3:0xea
    s_nop 0
    v_cvt_pk_bf16_f32 v88, v96, v97
    v_cvt_pk_bf16_f32 v89, v98, v99
    ds_wrxchg_rtn_b64 v[90:91], v105, v[88:89]
    s_waitcnt lgkmcnt(1)
    v_mfma_f32_4x4x4_16b_bf16 v[92:95], v[12:13], v[84:85], 0
    s_waitcnt lgkmcnt(0)
    v_cmpx_ne_u64 vcc, v[90:91], v[86:87]
    s_cbranch_execz L2_c40
    s_nop 2
    v_mfma_f32_4x4x4_16b_bf16 v[100:103], v[14:15], v[86:87], 0
    s_nop 1
    v_mfma_f32_4x4x4_16b_bf16 v[100:103], v[12:13], v[90:91], v[100:103]
    s_nop 4
    v_cvt_pk_bf16_f32 v100, v100, v101
    v_cvt_pk_bf16_f32 v101, v102, v103
    ds_pk_add_bf16 v105, v100
    ds_pk_add_bf16 v105, v101 offset:4
L2_c40:
    s_mov_b64 exec, -1
    ds_read_b64 v[86:87], v104
    v_mul_f32 v92, v107, v92
    v_mul_f32 v93, v107, v93
    v_mul_f32 v94, v107, v94
    v_mul_f32 v95, v107, v95
    v_and_b32 v108, 0x20000000, v37
    v_lshrrev_b32 v106, 14, v21
    v_bitop3_b32 v106, v106, v8, v108 bitop3:0xea
    ds_read_b64 v[84:85], v106 offset:63616
    s_waitcnt lgkmcnt(1)
    v_mfma_f32_4x4x4_16b_bf16 v[96:99], v[12:13], v[86:87], v[92:95]
    v_perm_b32 v107, v21, v33, s45
    v_bitop3_b32 v105, v21, v8, v108 bitop3:0xea
    v_bitop3_b32 v107, v107, v9, v10 bitop3:0xea
    v_bitop3_b32 v107, v21, v11, v107 bitop3:0xea
    s_nop 0
    v_cvt_pk_bf16_f32 v88, v96, v97
    v_cvt_pk_bf16_f32 v89, v98, v99
    ds_wrxchg_rtn_b64 v[90:91], v104, v[88:89]
    s_waitcnt lgkmcnt(1)
    v_mfma_f32_4x4x4_16b_bf16 v[92:95], v[12:13], v[84:85], 0
    s_waitcnt lgkmcnt(0)
    v_cmpx_ne_u64 vcc, v[90:91], v[86:87]
    s_cbranch_execz L2_c41
    s_nop 2
    v_mfma_f32_4x4x4_16b_bf16 v[100:103], v[14:15], v[86:87], 0
    s_nop 1
    v_mfma_f32_4x4x4_16b_bf16 v[100:103], v[12:13], v[90:91], v[100:103]
    s_nop 4
    v_cvt_pk_bf16_f32 v100, v100, v101
    v_cvt_pk_bf16_f32 v101, v102, v103
    ds_pk_add_bf16 v104, v100
    ds_pk_add_bf16 v104, v101 offset:4
L2_c41:
    s_mov_b64 exec, -1
    ds_read_b64 v[86:87], v105
    v_mul_f32 v92, v107, v92
    v_mul_f32 v93, v107, v93
    v_mul_f32 v94, v107, v94
    v_mul_f32 v95, v107, v95
    v_and_b32 v108, 0x40000000, v37
    v_lshrrev_b32 v106, 14, v22
    v_bitop3_b32 v106, v106, v8, v108 bitop3:0xea
    ds_read_b64 v[84:85], v106 offset:63616
    s_waitcnt lgkmcnt(1)
    v_mfma_f32_4x4x4_16b_bf16 v[96:99], v[12:13], v[86:87], v[92:95]
    v_perm_b32 v107, v22, v33, s46
    v_bitop3_b32 v104, v22, v8, v108 bitop3:0xea
    v_bitop3_b32 v107, v107, v9, v10 bitop3:0xea
    v_bitop3_b32 v107, v22, v11, v107 bitop3:0xea
    s_nop 0
    v_cvt_pk_bf16_f32 v88, v96, v97
    v_cvt_pk_bf16_f32 v89, v98, v99
    ds_wrxchg_rtn_b64 v[90:91], v105, v[88:89]
    s_waitcnt lgkmcnt(1)
    v_mfma_f32_4x4x4_16b_bf16 v[92:95], v[12:13], v[84:85], 0
    s_waitcnt lgkmcnt(0)
    v_cmpx_ne_u64 vcc, v[90:91], v[86:87]
    s_cbranch_execz L2_c42
    s_nop 2
    v_mfma_f32_4x4x4_16b_bf16 v[100:103], v[14:15], v[86:87], 0
    s_nop 1
    v_mfma_f32_4x4x4_16b_bf16 v[100:103], v[12:13], v[90:91], v[100:103]
    s_nop 4
    v_cvt_pk_bf16_f32 v100, v100, v101
    v_cvt_pk_bf16_f32 v101, v102, v103
    ds_pk_add_bf16 v105, v100
    ds_pk_add_bf16 v105, v101 offset:4
L2_c42:
    s_mov_b64 exec, -1
    ds_read_b64 v[86:87], v104
    v_mul_f32 v92, v107, v92
    v_mul_f32 v93, v107, v93
    v_mul_f32 v94, v107, v94
    v_mul_f32 v95, v107, v95
    v_and_b32 v108, 0x80000000, v37
    v_lshrrev_b32 v106, 14, v23
    v_bitop3_b32 v106, v106, v8, v108 bitop3:0xea
    ds_read_b64 v[84:85], v106 offset:63616
    s_waitcnt lgkmcnt(1)
    v_mfma_f32_4x4x4_16b_bf16 v[96:99], v[12:13], v[86:87], v[92:95]
    v_perm_b32 v107, v23, v33, s47
    v_bitop3_b32 v105, v23, v8, v108 bitop3:0xea
    v_bitop3_b32 v107, v107, v9, v10 bitop3:0xea
    v_bitop3_b32 v107, v23, v11, v107 bitop3:0xea
    v_and_b32 v109, 0x0fffffff, v41
    v_mov_b32 v37, v41
    buffer_load_dwordx4 v[20:23], v109, s[8:11], 0 offen
    buffer_load_dword v33, v109, s[8:11], 0 offen offset:16
    v_cvt_pk_bf16_f32 v88, v96, v97
    v_cvt_pk_bf16_f32 v89, v98, v99
    ds_wrxchg_rtn_b64 v[90:91], v104, v[88:89]
    s_waitcnt lgkmcnt(1)
    v_mfma_f32_4x4x4_16b_bf16 v[92:95], v[12:13], v[84:85], 0
    s_waitcnt lgkmcnt(0)
    v_cmpx_ne_u64 vcc, v[90:91], v[86:87]
    s_cbranch_execz L2_c43
    s_nop 2
    v_mfma_f32_4x4x4_16b_bf16 v[100:103], v[14:15], v[86:87], 0
    s_nop 1
    v_mfma_f32_4x4x4_16b_bf16 v[100:103], v[12:13], v[90:91], v[100:103]
    s_nop 4
    v_cvt_pk_bf16_f32 v100, v100, v101
    v_cvt_pk_bf16_f32 v101, v102, v103
    ds_pk_add_bf16 v104, v100
    ds_pk_add_bf16 v104, v101 offset:4
L2_c43:
    s_mov_b64 exec, -1
    ds_read_b64 v[86:87], v105
    v_mul_f32 v92, v107, v92
    v_mul_f32 v93, v107, v93
    v_mul_f32 v94, v107, v94
    v_mul_f32 v95, v107, v95
    s_waitcnt vmcnt(16)
    v_and_b32 v108, 0x10000000, v38
    v_lshrrev_b32 v106, 14, v24
    v_bitop3_b32 v106, v106, v8, v108 bitop3:0xea
    ds_read_b64 v[84:85], v106 offset:63616
    s_waitcnt lgkmcnt(1)
    v_mfma_f32_4x4x4_16b_bf16 v[96:99], v[12:13], v[86:87], v[92:95]
    v_perm_b32 v107, v24, v34, s44
    v_bitop3_b32 v104, v24, v8, v108 bitop3:0xea
    v_bitop3_b32 v107, v107, v9, v10 bitop3:0xea
    v_bitop3_b32 v107, v24, v11, v107 bitop3:0xea
    s_nop 0
    v_cvt_pk_bf16_f32 v88, v96, v97
    v_cvt_pk_bf16_f32 v89, v98, v99
    ds_wrxchg_rtn_b64 v[90:91], v105, v[88:89]
    s_waitcnt lgkmcnt(1)
    v_mfma_f32_4x4x4_16b_bf16 v[92:95], v[12:13], v[84:85], 0
    s_waitcnt lgkmcnt(0)
    v_cmpx_ne_u64 vcc, v[90:91], v[86:87]
    s_cbranch_execz L2_c44
    s_nop 2
    v_mfma_f32_4x4x4_16b_bf16 v[100:103], v[14:15], v[86:87], 0
    s_nop 1
    v_mfma_f32_4x4x4_16b_bf16 v[100:103], v[12:13], v[90:91], v[100:103]
    s_nop 4
    v_cvt_pk_bf16_f32 v100, v100, v101
    v_cvt_pk_bf16_f32 v101, v102, v103
    ds_pk_add_bf16 v105, v100
    ds_pk_add_bf16 v105, v101 offset:4
L2_c44:
    s_mov_b64 exec, -1
    ds_read_b64 v[86:87], v104
    v_mul_f32 v92, v107, v92
    v_mul_f32 v93, v107, v93
    v_mul_f32 v94, v107, v94
    v_mul_f32 v95, v107, v95
    v_and_b32 v108, 0x20000000, v38
    v_lshrrev_b32 v106, 14, v25
    v_bitop3_b32 v106, v106, v8, v108 bitop3:0xea
    ds_read_b64 v[84:85], v106 offset:63616
    s_waitcnt lgkmcnt(1)
    v_mfma_f32_4x4x4_16b_bf16 v[96:99], v[12:13], v[86:87], v[92:95]
    v_perm_b32 v107, v25, v34, s45
    v_bitop3_b32 v105, v25, v8, v108 bitop3:0xea
    v_bitop3_b32 v107, v107, v9, v10 bitop3:0xea
    v_bitop3_b32 v107, v25, v11, v107 bitop3:0xea
    s_nop 0
    v_cvt_pk_bf16_f32 v88, v96, v97
    v_cvt_pk_bf16_f32 v89, v98, v99
    ds_wrxchg_rtn_b64 v[90:91], v104, v[88:89]
    s_waitcnt lgkmcnt(1)
    v_mfma_f32_4x4x4_16b_bf16 v[92:95], v[12:13], v[84:85], 0
    s_waitcnt lgkmcnt(0)
    v_cmpx_ne_u64 vcc, v[90:91], v[86:87]
    s_cbranch_execz L2_c45
    s_nop 2
    v_mfma_f32_4x4x4_16b_bf16 v[100:103], v[14:15], v[86:87], 0
    s_nop 1
    v_mfma_f32_4x4x4_16b_bf16 v[100:103], v[12:13], v[90:91], v[100:103]
    s_nop 4
    v_cvt_pk_bf16_f32 v100, v100, v101
    v_cvt_pk_bf16_f32 v101, v102, v103
    ds_pk_add_bf16 v104, v100
    ds_pk_add_bf16 v104, v101 offset:4
L2_c45:
    s_mov_b64 exec, -1
    ds_read_b64 v[86:87], v105
    v_mul_f32 v92, v107, v92
    v_mul_f32 v93, v107, v93
    v_mul_f32 v94, v107, v94
    v_mul_f32 v95, v107, v95
    v_and_b32 v108, 0x40000000, v38
    v_lshrrev_b32 v106, 14, v26
    v_bitop3_b32 v106, v106, v8, v108 bitop3:0xea
    ds_read_b64 v[84:85], v106 offset:63616
    s_waitcnt lgkmcnt(1)
    v_mfma_f32_4x4x4_16b_bf16 v[96:99], v[12:13], v[86:87], v[92:95]
    v_perm_b32 v107, v26, v34, s46
    v_bitop3_b32 v104, v26, v8, v108 bitop3:0xea
    v_bitop3_b32 v107, v107, v9, v10 bitop3:0xea
    v_bitop3_b32 v107, v26, v11, v107 bitop3:0xea
    s_nop 0
    v_cvt_pk_bf16_f32 v88, v96, v97
    v_cvt_pk_bf16_f32 v89, v98, v99
    ds_wrxchg_rtn_b64 v[90:91], v105, v[88:89]
    s_waitcnt lgkmcnt(1)
    v_mfma_f32_4x4x4_16b_bf16 v[92:95], v[12:13], v[84:85], 0
    s_waitcnt lgkmcnt(0)
    v_cmpx_ne_u64 vcc, v[90:91], v[86:87]
    s_cbranch_execz L2_c46
    s_nop 2
    v_mfma_f32_4x4x4_16b_bf16 v[100:103], v[14:15], v[86:87], 0
    s_nop 1
    v_mfma_f32_4x4x4_16b_bf16 v[100:103], v[12:13], v[90:91], v[100:103]
    s_nop 4
    v_cvt_pk_bf16_f32 v100, v100, v101
    v_cvt_pk_bf16_f32 v101, v102, v103
    ds_pk_add_bf16 v105, v100
    ds_pk_add_bf16 v105, v101 offset:4
L2_c46:
    s_mov_b64 exec, -1
    ds_read_b64 v[86:87], v104
    v_mul_f32 v92, v107, v92
    v_mul_f32 v93, v107, v93
    v_mul_f32 v94, v107, v94
    v_mul_f32 v95, v107, v95
    v_and_b32 v108, 0x80000000, v38
    v_lshrrev_b32 v106, 14, v27
    v_bitop3_b32 v106, v106, v8, v108 bitop3:0xea
    ds_read_b64 v[84:85], v106 offset:63616
    s_waitcnt lgkmcnt(1)
    v_mfma_f32_4x4x4_16b_bf16 v[96:99], v[12:13], v[86:87], v[92:95]
    v_perm_b32 v107, v27, v34, s47
    v_bitop3_b32 v105, v27, v8, v108 bitop3:0xea
    v_bitop3_b32 v107, v107, v9, v10 bitop3:0xea
    v_bitop3_b32 v107, v27, v11, v107 bitop3:0xea
    v_and_b32 v109, 0x0fffffff, v42
    v_mov_b32 v38, v42
    buffer_load_dwordx4 v[24:27], v109, s[8:11], 0 offen
    buffer_load_dword v34, v109, s[8:11], 0 offen offset:16
    v_cvt_pk_bf16_f32 v88, v96, v97
    v_cvt_pk_bf16_f32 v89, v98, v99
    ds_wrxchg_rtn_b64 v[90:91], v104, v[88:89]
    s_waitcnt lgkmcnt(1)
    v_mfma_f32_4x4x4_16b_bf16 v[92:95], v[12:13], v[84:85], 0
    s_waitcnt lgkmcnt(0)
    v_cmpx_ne_u64 vcc, v[90:91], v[86:87]
    s_cbranch_execz L2_c47
    s_nop 2
    v_mfma_f32_4x4x4_16b_bf16 v[100:103], v[14:15], v[86:87], 0
    s_nop 1
    v_mfma_f32_4x4x4_16b_bf16 v[100:103], v[12:13], v[90:91], v[100:103]
    s_nop 4
    v_cvt_pk_bf16_f32 v100, v100, v101
    v_cvt_pk_bf16_f32 v101, v102, v103
    ds_pk_add_bf16 v104, v100
    ds_pk_add_bf16 v104, v101 offset:4
L2_c47:
    s_mov_b64 exec, -1
    ds_read_b64 v[86:87], v105
    v_mul_f32 v92, v107, v92
    v_mul_f32 v93, v107, v93
    v_mul_f32 v94, v107, v94
    v_mul_f32 v95, v107, v95
    s_waitcnt vmcnt(16)
    v_and_b32 v108, 0x10000000, v39
    v_lshrrev_b32 v106, 14, v28
    v_bitop3_b32 v106, v106, v8, v108 bitop3:0xea
    ds_read_b64 v[84:85], v106 offset:63616
    s_waitcnt lgkmcnt(1)
    v_mfma_f32_4x4x4_16b_bf16 v[96:99], v[12:13], v[86:87], v[92:95]
    v_perm_b32 v107, v28, v35, s44
    v_bitop3_b32 v104, v28, v8, v108 bitop3:0xea
    v_bitop3_b32 v107, v107, v9, v10 bitop3:0xea
    v_bitop3_b32 v107, v28, v11, v107 bitop3:0xea
    s_nop 0
    v_cvt_pk_bf16_f32 v88, v96, v97
    v_cvt_pk_bf16_f32 v89, v98, v99
    ds_wrxchg_rtn_b64 v[90:91], v105, v[88:89]
    s_waitcnt lgkmcnt(1)
    v_mfma_f32_4x4x4_16b_bf16 v[92:95], v[12:13], v[84:85], 0
    s_waitcnt lgkmcnt(0)
    v_cmpx_ne_u64 vcc, v[90:91], v[86:87]
    s_cbranch_execz L2_c48
    s_nop 2
    v_mfma_f32_4x4x4_16b_bf16 v[100:103], v[14:15], v[86:87], 0
    s_nop 1
    v_mfma_f32_4x4x4_16b_bf16 v[100:103], v[12:13], v[90:91], v[100:103]
    s_nop 4
    v_cvt_pk_bf16_f32 v100, v100, v101
    v_cvt_pk_bf16_f32 v101, v102, v103
    ds_pk_add_bf16 v105, v100
    ds_pk_add_bf16 v105, v101 offset:4
L2_c48:
    s_mov_b64 exec, -1
    ds_read_b64 v[86:87], v104
    v_mul_f32 v92, v107, v92
    v_mul_f32 v93, v107, v93
    v_mul_f32 v94, v107, v94
    v_mul_f32 v95, v107, v95
    v_and_b32 v108, 0x20000000, v39
    v_lshrrev_b32 v106, 14, v29
    v_bitop3_b32 v106, v106, v8, v108 bitop3:0xea
    ds_read_b64 v[84:85], v106 offset:63616
    s_waitcnt lgkmcnt(1)
    v_mfma_f32_4x4x4_16b_bf16 v[96:99], v[12:13], v[86:87], v[92:95]
    v_perm_b32 v107, v29, v35, s45
    v_bitop3_b32 v105, v29, v8, v108 bitop3:0xea
    v_bitop3_b32 v107, v107, v9, v10 bitop3:0xea
    v_bitop3_b32 v107, v29, v11, v107 bitop3:0xea
    s_nop 0
    v_cvt_pk_bf16_f32 v88, v96, v97
    v_cvt_pk_bf16_f32 v89, v98, v99
    ds_wrxchg_rtn_b64 v[90:91], v104, v[88:89]
    s_waitcnt lgkmcnt(1)
    v_mfma_f32_4x4x4_16b_bf16 v[92:95], v[12:13], v[84:85], 0
    s_waitcnt lgkmcnt(0)
    v_cmpx_ne_u64 vcc, v[90:91], v[86:87]
    s_cbranch_execz L2_c49
    s_nop 2
    v_mfma_f32_4x4x4_16b_bf16 v[100:103], v[14:15], v[86:87], 0
    s_nop 1
    v_mfma_f32_4x4x4_16b_bf16 v[100:103], v[12:13], v[90:91], v[100:103]
    s_nop 4
    v_cvt_pk_bf16_f32 v100, v100, v101
    v_cvt_pk_bf16_f32 v101, v102, v103
    ds_pk_add_bf16 v104, v100
    ds_pk_add_bf16 v104, v101 offset:4
L2_c49:
    s_mov_b64 exec, -1
    ds_read_b64 v[86:87], v105
    v_mul_f32 v92, v107, v92
    v_mul_f32 v93, v107, v93
    v_mul_f32 v94, v107, v94
    v_mul_f32 v95, v107, v95
    v_and_b32 v108, 0x40000000, v39
    v_lshrrev_b32 v106, 14, v30
    v_bitop3_b32 v106, v106, v8, v108 bitop3:0xea
    ds_read_b64 v[84:85], v106 offset:63616
    s_waitcnt lgkmcnt(1)
    v_mfma_f32_4x4x4_16b_bf16 v[96:99], v[12:13], v[86:87], v[92:95]
    v_perm_b32 v107, v30, v35, s46
    v_bitop3_b32 v104, v30, v8, v108 bitop3:0xea
    v_bitop3_b32 v107, v107, v9, v10 bitop3:0xea
    v_bitop3_b32 v107, v30, v11, v107 bitop3:0xea
    s_nop 0
    v_cvt_pk_bf16_f32 v88, v96, v97
    v_cvt_pk_bf16_f32 v89, v98, v99
    ds_wrxchg_rtn_b64 v[90:91], v105, v[88:89]
    s_waitcnt lgkmcnt(1)
    v_mfma_f32_4x4x4_16b_bf16 v[92:95], v[12:13], v[84:85], 0
    s_waitcnt lgkmcnt(0)
    v_cmpx_ne_u64 vcc, v[90:91], v[86:87]
    s_cbranch_execz L2_c50
    s_nop 2
    v_mfma_f32_4x4x4_16b_bf16 v[100:103], v[14:15], v[86:87], 0
    s_nop 1
    v_mfma_f32_4x4x4_16b_bf16 v[100:103], v[12:13], v[90:91], v[100:103]
    s_nop 4
    v_cvt_pk_bf16_f32 v100, v100, v101
    v_cvt_pk_bf16_f32 v101, v102, v103
    ds_pk_add_bf16 v105, v100
    ds_pk_add_bf16 v105, v101 offset:4
L2_c50:
    s_mov_b64 exec, -1
    ds_read_b64 v[86:87], v104
    v_mul_f32 v92, v107, v92
    v_mul_f32 v93, v107, v93
    v_mul_f32 v94, v107, v94
    v_mul_f32 v95, v107, v95
    v_and_b32 v108, 0x80000000, v39
    v_lshrrev_b32 v106, 14, v31
    v_bitop3_b32 v106, v106, v8, v108 bitop3:0xea
    ds_read_b64 v[84:85], v106 offset:63616
    s_waitcnt lgkmcnt(1)
    v_mfma_f32_4x4x4_16b_bf16 v[96:99], v[12:13], v[86:87], v[92:95]
    v_perm_b32 v107, v31, v35, s47
    v_bitop3_b32 v105, v31, v8, v108 bitop3:0xea
    v_bitop3_b32 v107, v107, v9, v10 bitop3:0xea
    v_bitop3_b32 v107, v31, v11, v107 bitop3:0xea
    v_and_b32 v109, 0x0fffffff, v43
    v_mov_b32 v39, v43
    buffer_load_dwordx4 v[28:31], v109, s[8:11], 0 offen
    buffer_load_dword v35, v109, s[8:11], 0 offen offset:16
    v_cvt_pk_bf16_f32 v88, v96, v97
    v_cvt_pk_bf16_f32 v89, v98, v99
    ds_wrxchg_rtn_b64 v[90:91], v104, v[88:89]
    s_waitcnt lgkmcnt(1)
    v_mfma_f32_4x4x4_16b_bf16 v[92:95], v[12:13], v[84:85], 0
    s_waitcnt lgkmcnt(0)
    v_cmpx_ne_u64 vcc, v[90:91], v[86:87]
    s_cbranch_execz L2_c51
    s_nop 2
    v_mfma_f32_4x4x4_16b_bf16 v[100:103], v[14:15], v[86:87], 0
    s_nop 1
    v_mfma_f32_4x4x4_16b_bf16 v[100:103], v[12:13], v[90:91], v[100:103]
    s_nop 4
    v_cvt_pk_bf16_f32 v100, v100, v101
    v_cvt_pk_bf16_f32 v101, v102, v103
    ds_pk_add_bf16 v104, v100
    ds_pk_add_bf16 v104, v101 offset:4
L2_c51:
    s_mov_b64 exec, -1
    ds_read_b64 v[86:87], v105
    v_mul_f32 v92, v107, v92
    v_mul_f32 v93, v107, v93
    v_mul_f32 v94, v107, v94
    v_mul_f32 v95, v107, v95
    s_waitcnt lgkmcnt(0)
    s_nop 0
    v_mfma_f32_4x4x4_16b_bf16 v[96:99], v[12:13], v[86:87], v[92:95]
    s_nop 4
    v_cvt_pk_bf16_f32 v88, v96, v97
    v_cvt_pk_bf16_f32 v89, v98, v99
    ds_wrxchg_rtn_b64 v[90:91], v105, v[88:89]
    s_waitcnt lgkmcnt(0)
    v_cmpx_ne_u64 vcc, v[90:91], v[86:87]
    s_cbranch_execz L2_c52
    s_nop 2
    v_mfma_f32_4x4x4_16b_bf16 v[100:103], v[14:15], v[86:87], 0
    s_nop 1
    v_mfma_f32_4x4x4_16b_bf16 v[100:103], v[12:13], v[90:91], v[100:103]
    s_nop 4
    v_cvt_pk_bf16_f32 v100, v100, v101
    v_cvt_pk_bf16_f32 v101, v102, v103
    ds_pk_add_bf16 v105, v100
    ds_pk_add_bf16 v105, v101 offset:4
L2_c52:
    s_mov_b64 exec, -1
    s_bitcmp1_b32 s36, s42
    s_cbranch_scc1 L2_slow
L2_ret2:
    s_barrier
    s_waitcnt vmcnt(8)
    s_mov_b32 s37, s38
    s_add_u32 s48, s38, 257
    v_and_b32 v110, 0xffff, v64
    v_and_b32 v111, 0xffff, v66
    v_and_b32 v112, -4, v110
    v_add_u32 v112, v112, v2
L2_x53_0:
    v_sub_u32 v113, v111, v112
    v_sub_u32 v115, v110, v112
    v_med3_i32 v114, v113, 0, 4
    v_max_i32 v115, 0, v115
    v_cmp_gt_i32 vcc, v114, v115
    v_mad_u32_u24 v116, v112, 5, v4
    v_bfm_b32 v114, v114, 28
    v_bfm_b32 v115, v115, 28
    v_mbcnt_lo_u32_b32 v117, vcc_lo, 0
    v_mbcnt_hi_u32_b32 v117, vcc_hi, v117
    v_bitop3_b32 v116, v114, v115, v116 bitop3:0x9a
    v_add_lshl_u32 v117, v117, s37, 2
    s_bcnt1_i32_b64 s41, vcc
    s_mov_b64 exec, vcc
    ds_write_b32 v117, v116
    s_mov_b64 exec, -1
    v_cmp_gt_i32 vcc, v113, v3
    s_add_u32 s37, s37, s41
    s_min_u32 s37, s37, s48
    s_cbranch_vccnz L2_xe53_0
L2_xr53_0:
    ds_write_b128 v7, v[52:55] offset:2048
    v_and_b32 v110, 0xffff, v68
    v_and_b32 v111, 0xffff, v70
    v_and_b32 v112, -4, v110
    v_add_u32 v112, v112, v2
    v_add_u32 v118, 0x2800000, v4
L2_x53_1:
    v_sub_u32 v113, v111, v112
    v_sub_u32 v115, v110, v112
    v_med3_i32 v114, v113, 0, 4
    v_max_i32 v115, 0, v115
    v_cmp_gt_i32 vcc, v114, v115
    v_mad_u32_u24 v116, v112, 5, v118
    v_bfm_b32 v114, v114, 28
    v_bfm_b32 v115, v115, 28
    v_mbcnt_lo_u32_b32 v117, vcc_lo, 0
    v_mbcnt_hi_u32_b32 v117, vcc_hi, v117
    v_bitop3_b32 v116, v114, v115, v116 bitop3:0x9a
    v_add_lshl_u32 v117, v117, s37, 2
    s_bcnt1_i32_b64 s41, vcc
    s_mov_b64 exec, vcc
    ds_write_b32 v117, v116
    s_mov_b64 exec, -1
    v_cmp_gt_i32 vcc, v113, v3
    s_add_u32 s37, s37, s41
    s_min_u32 s37, s37, s48
    s_cbranch_vccnz L2_xe53_1
L2_xr53_1:
    ds_write_b128 v7, v[56:59] offset:3072
    v_and_b32 v110, 0xffff, v72
    v_and_b32 v111, 0xffff, v74
    v_and_b32 v112, -4, v110
    v_add_u32 v112, v112, v2
    v_add_u32 v118, 0x5000000, v4
L2_x53_2:
    v_sub_u32 v113, v111, v112
    v_sub_u32 v115, v110, v112
    v_med3_i32 v114, v113, 0, 4
    v_max_i32 v115, 0, v115
    v_cmp_gt_i32 vcc, v114, v115
    v_mad_u32_u24 v116, v112, 5, v118
    v_bfm_b32 v114, v114, 28
    v_bfm_b32 v115, v115, 28
    v_mbcnt_lo_u32_b32 v117, vcc_lo, 0
    v_mbcnt_hi_u32_b32 v117, vcc_hi, v117
    v_bitop3_b32 v116, v114, v115, v116 bitop3:0x9a
    v_add_lshl_u32 v117, v117, s37, 2
    s_bcnt1_i32_b64 s41, vcc
    s_mov_b64 exec, vcc
    ds_write_b32 v117, v116
    s_mov_b64 exec, -1
    v_cmp_gt_i32 vcc, v113, v3
    s_add_u32 s37, s37, s41
    s_min_u32 s37, s37, s48
    s_cbranch_vccnz L2_xe53_2
L2_xr53_2:
    ds_write_b128 v7, v[60:63] offset:4096
    v_and_b32 v110, 0xffff, v76
    v_and_b32 v111, 0xffff, v78
    v_and_b32 v112, -4, v110
    v_add_u32 v112, v112, v2
    v_add_u32 v118, 0x7800000, v4
L2_x53_3:
    v_sub_u32 v113, v111, v112
    v_sub_u32 v115, v110, v112
    v_med3_i32 v114, v113, 0, 4
    v_max_i32 v115, 0, v115
    v_cmp_gt_i32 vcc, v114, v115
    v_mad_u32_u24 v116, v112, 5, v118
    v_bfm_b32 v114, v114, 28
    v_bfm_b32 v115, v115, 28
    v_mbcnt_lo_u32_b32 v117, vcc_lo, 0
    v_mbcnt_hi_u32_b32 v117, vcc_hi, v117
    v_bitop3_b32 v116, v114, v115, v116 bitop3:0x9a
    v_add_lshl_u32 v117, v117, s37, 2
    s_bcnt1_i32_b64 s41, vcc
    s_mov_b64 exec, vcc
    ds_write_b32 v117, v116
    s_mov_b64 exec, -1
    v_cmp_gt_i32 vcc, v113, v3
    s_add_u32 s37, s37, s41
    s_min_u32 s37, s37, s48
    s_cbranch_vccnz L2_xe53_3
L2_xr53_3:
    v_and_b32 v110, 0xffff, v80
    v_and_b32 v111, 0xffff, v82
    v_and_b32 v112, -4, v110
    v_add_u32 v112, v112, v2
    v_add_u32 v118, 0xa000000, v4
L2_x53_4:
    v_sub_u32 v113, v111, v112
    v_sub_u32 v115, v110, v112
    v_med3_i32 v114, v113, 0, 4
    v_max_i32 v115, 0, v115
    v_cmp_gt_i32 vcc, v114, v115
    v_mad_u32_u24 v116, v112, 5, v118
    v_bfm_b32 v114, v114, 28
    v_bfm_b32 v115, v115, 28
    v_mbcnt_lo_u32_b32 v117, vcc_lo, 0
    v_mbcnt_hi_u32_b32 v117, vcc_hi, v117
    v_bitop3_b32 v116, v114, v115, v116 bitop3:0x9a
    v_add_lshl_u32 v117, v117, s37, 2
    s_bcnt1_i32_b64 s41, vcc
    s_mov_b64 exec, vcc
    ds_write_b32 v117, v116
    s_mov_b64 exec, -1
    v_cmp_gt_i32 vcc, v113, v3
    s_add_u32 s37, s37, s41
    s_min_u32 s37, s37, s48
    s_cbranch_vccnz L2_xe53_4
L2_xr53_4:
    s_lshl_b32 s3, s37, 2
    v_add_u32 v117, s3, v1
    v_mov_b32 v116, -1
    ds_write_b32 v117, v116
    s_lshl_b32 s3, s38, 2
    v_add_u32 v117, s3, v1
    ds_read2st64_b32 v[40:41], v117 offset0:0 offset1:1
    ds_read2st64_b32 v[42:43], v117 offset0:2 offset1:3
    s_sub_u32 s41, s37, s38
    s_sub_u32 s3, s41, 192
    s_cmp_gt_u32 s3, 64
    s_cbranch_scc1 L2_xf53
L2_xg53:
    ds_write_b128 v7, v[44:47] offset:0
    ds_write_b128 v7, v[48:51] offset:1024
    buffer_load_dwordx4 v[44:47], v6, s[16:19], s40 offen offset:0
    buffer_load_dwordx4 v[48:51], v6, s[16:19], s40 offen offset:1024
    buffer_load_dwordx4 v[52:55], v6, s[16:19], s40 offen offset:2048
    buffer_load_dwordx4 v[56:59], v6, s[16:19], s40 offen offset:3072
    s_add_u32 s3, s40, 4096
    buffer_load_dwordx4 v[60:63], v6, s[16:19], s3 offen
    s_add_u32 s40, s40, 80000
    s_add_u32 s42, s42, 1
    s_waitcnt lgkmcnt(0)
    s_barrier
    s_waitcnt vmcnt(11)
    v_and_b32 v108, 0x10000000, v36
    v_lshrrev_b32 v106, 14, v16
    v_bitop3_b32 v106, v106, v8, v108 bitop3:0xea
    ds_read_b64 v[84:85], v106 offset:63616
    v_perm_b32 v107, v16, v32, s44
    v_bitop3_b32 v104, v16, v8, v108 bitop3:0xea
    v_bitop3_b32 v107, v107, v9, v10 bitop3:0xea
    v_bitop3_b32 v107, v16, v11, v107 bitop3:0xea
    s_waitcnt lgkmcnt(0)
    v_mfma_f32_4x4x4_16b_bf16 v[92:95], v[12:13], v[84:85], 0
    ds_read_b64 v[86:87], v104
    s_nop 3
    v_mul_f32 v92, v107, v92
    v_mul_f32 v93, v107, v93
    v_mul_f32 v94, v107, v94
    v_mul_f32 v95, v107, v95
    v_and_b32 v108, 0x20000000, v36
    v_lshrrev_b32 v106, 14, v17
    v_bitop3_b32 v106, v106, v8, v108 bitop3:0xea
    ds_read_b64 v[84:85], v106 offset:63616
    s_waitcnt lgkmcnt(1)
    v_mfma_f32_4x4x4_16b_bf16 v[96:99], v[12:13], v[86:87], v[92:95]
    v_perm_b32 v107, v17, v32, s45
    v_bitop3_b32 v105, v17, v8, v108 bitop3:0xea
    v_bitop3_b32 v107, v107, v9, v10 bitop3:0xea
    v_bitop3_b32 v107, v17, v11, v107 bitop3:0xea
    s_nop 0
    v_cvt_pk_bf16_f32 v88, v96, v97
    v_cvt_pk_bf16_f32 v89, v98, v99
    ds_wrxchg_rtn_b64 v[90:91], v104, v[88:89]
    s_waitcnt lgkmcnt(1)
    v_mfma_f32_4x4x4_16b_bf16 v[92:95], v[12:13], v[84:85], 0
    s_waitcnt lgkmcnt(0)
    v_cmpx_ne_u64 vcc, v[90:91], v[86:87]
    s_cbranch_execz L2_c54
    s_nop 2
    v_mfma_f32_4x4x4_16b_bf16 v[100:103], v[14:15], v[86:87], 0
    s_nop 1
    v_mfma_f32_4x4x4_16b_bf16 v[100:103], v[12:13], v[90:91], v[100:103]
    s_nop 4
    v_cvt_pk_bf16_f32 v100, v100, v101
    v_cvt_pk_bf16_f32 v101, v102, v103
    ds_pk_add_bf16 v104, v100
    ds_pk_add_bf16 v104, v101 offset:4
L2_c54:
    s_mov_b64 exec, -1
    ds_read_b64 v[86:87], v105
    v_mul_f32 v92, v107, v92
    v_mul_f32 v93, v107, v93
    v_mul_f32 v94, v107, v94
    v_mul_f32 v95, v107, v95
    v_and_b32 v108, 0x40000000, v36
    v_lshrrev_b32 v106, 14, v18
    v_bitop3_b32 v106, v106, v8, v108 bitop3:0xea
    ds_read_b64 v[84:85], v106 offset:63616
    s_waitcnt lgkmcnt(1)
    v_mfma_f32_4x4x4_16b_bf16 v[96:99], v[12:13], v[86:87], v[92:95]
    v_perm_b32 v107, v18, v32, s46
    v_bitop3_b32 v104, v18, v8, v108 bitop3:0xea
    v_bitop3_b32 v107, v107, v9, v10 bitop3:0xea
    v_bitop3_b32 v107, v18, v11, v107 bitop3:0xea
    s_nop 0
    v_cvt_pk_bf16_f32 v88, v96, v97
    v_cvt_pk_bf16_f32 v89, v98, v99
    ds_wrxchg_rtn_b64 v[90:91], v105, v[88:89]
    s_waitcnt lgkmcnt(1)
    v_mfma_f32_4x4x4_16b_bf16 v[92:95], v[12:13], v[84:85], 0
    s_waitcnt lgkmcnt(0)
    v_cmpx_ne_u64 vcc, v[90:91], v[86:87]
    s_cbranch_execz L2_c55
    s_nop 2
    v_mfma_f32_4x4x4_16b_bf16 v[100:103], v[14:15], v[86:87], 0
    s_nop 1
    v_mfma_f32_4x4x4_16b_bf16 v[100:103], v[12:13], v[90:91], v[100:103]
    s_nop 4
    v_cvt_pk_bf16_f32 v100, v100, v101
    v_cvt_pk_bf16_f32 v101, v102, v103
    ds_pk_add_bf16 v105, v100
    ds_pk_add_bf16 v105, v101 offset:4
L2_c55:
    s_mov_b64 exec, -1
    ds_read_b64 v[86:87], v104
    v_mul_f32 v92, v107, v92
    v_mul_f32 v93, v107, v93
    v_mul_f32 v94, v107, v94
    v_mul_f32 v95, v107, v95
    v_and_b32 v108, 0x80000000, v36
    v_lshrrev_b32 v106, 14, v19
    v_bitop3_b32 v106, v106, v8, v108 bitop3:0xea
    ds_read_b64 v[84:85], v106 offset:63616
    s_waitcnt lgkmcnt(1)
    v_mfma_f32_4x4x4_16b_bf16 v[96:99], v[12:13], v[86:87], v[92:95]
    v_perm_b32 v107, v19, v32, s47
    v_bitop3_b32 v105, v19, v8, v108 bitop3:0xea
    v_bitop3_b32 v107, v107, v9, v10 bitop3:0xea
    v_bitop3_b32 v107, v19, v11, v107 bitop3:0xea
    v_and_b32 v109, 0x0fffffff, v40
    v_mov_b32 v36, v40
    buffer_load_dwordx4 v[16:19], v109, s[8:11], 0 offen
    buffer_load_dword v32, v109, s[8:11], 0 offen offset:16
    v_cvt_pk_bf16_f32 v88, v96, v97
    v_cvt_pk_bf16_f32 v89, v98, v99
    ds_wrxchg_rtn_b64 v[90:91], v104, v[88:89]
    s_waitcnt lgkmcnt(1)
    v_mfma_f32_4x4x4_16b_bf16 v[92:95], v[12:13], v[84:85], 0
    s_waitcnt lgkmcnt(0)
    v_cmpx_ne_u64 vcc, v[90:91], v[86:87]
    s_cbranch_execz L2_c56
    s_nop 2
    v_mfma_f32_4x4x4_16b_bf16 v[100:103], v[14:15], v[86:87], 0
    s_nop 1
    v_mfma_f32_4x4x4_16b_bf16 v[100:103], v[12:13], v[90:91], v[100:103]
    s_nop 4
    v_cvt_pk_bf16_f32 v100, v100, v101
    v_cvt_pk_bf16_f32 v101, v102, v103
    ds_pk_add_bf16 v104, v100
    ds_pk_add_bf16 v104, v101 offset:4
L2_c56:
    s_mov_b64 exec, -1
    ds_read_b64 v[86:87], v105
    v_mul_f32 v92, v107, v92
    v_mul_f32 v93, v107, v93
    v_mul_f32 v94, v107, v94
    v_mul_f32 v95, v107, v95
    s_waitcnt vmcnt(11)
    v_and_b32 v108, 0x10000000, v37
    v_lshrrev_b32 v106, 14, v20
    v_bitop3_b32 v106, v106, v8, v108 bitop3:0xea
    ds_read_b64 v[84:85], v106 offset:63616
    s_waitcnt lgkmcnt(1)
    v_mfma_f32_4x4x4_16b_bf16 v[96:99], v[12:13], v[86:87], v[92:95]
    v_perm_b32 v107, v20, v33, s44
    v_bitop3_b32 v104, v20, v8, v108 bitop3:0xea
    v_bitop3_b32 v107, v107, v9, v10 bitop3:0xea
    v_bitop3_b32 v107, v20, v11, v107 bitop3:0xea
    s_nop 0
    v_cvt_pk_bf16_f32 v88, v96, v97
    v_cvt_pk_bf16_f32 v89, v98, v99
    ds_wrxchg_rtn_b64 v[90:91], v105, v[88:89]
    s_waitcnt lgkmcnt(1)
    v_mfma_f32_4x4x4_16b_bf16 v[92:95], v[12:13], v[84:85], 0
    s_waitcnt lgkmcnt(0)
    v_cmpx_ne_u64 vcc, v[90:91], v[86:87]
    s_cbranch_execz L2_c57
    s_nop 2
    v_mfma_f32_4x4x4_16b_bf16 v[100:103], v[14:15], v[86:87], 0
    s_nop 1
    v_mfma_f32_4x4x4_16b_bf16 v[100:103], v[12:13], v[90:91], v[100:103]
    s_nop 4
    v_cvt_pk_bf16_f32 v100, v100, v101
    v_cvt_pk_bf16_f32 v101, v102, v103
    ds_pk_add_bf16 v105, v100
    ds_pk_add_bf16 v105, v101 offset:4
L2_c57:
    s_mov_b64 exec, -1
    ds_read_b64 v[86:87], v104
    v_mul_f32 v92, v107, v92
    v_mul_f32 v93, v107, v93
    v_mul_f32 v94, v107, v94
    v_mul_f32 v95, v107, v95
    v_and_b32 v108, 0x20000000, v37
    v_lshrrev_b32 v106, 14, v21
    v_bitop3_b32 v106, v106, v8, v108 bitop3:0xea
    ds_read_b64 v[84:85], v106 offset:63616
    s_waitcnt lgkmcnt(1)
    v_mfma_f32_4x4x4_16b_bf16 v[96:99], v[12:13], v[86:87], v[92:95]
    v_perm_b32 v107, v21, v33, s45
    v_bitop3_b32 v105, v21, v8, v108 bitop3:0xea
    v_bitop3_b32 v107, v107, v9, v10 bitop3:0xea
    v_bitop3_b32 v107, v21, v11, v107 bitop3:0xea
    s_nop 0
    v_cvt_pk_bf16_f32 v88, v96, v97
    v_cvt_pk_bf16_f32 v89, v98, v99
    ds_wrxchg_rtn_b64 v[90:91], v104, v[88:89]
    s_waitcnt lgkmcnt(1)
    v_mfma_f32_4x4x4_16b_bf16 v[92:95], v[12:13], v[84:85], 0
    s_waitcnt lgkmcnt(0)
    v_cmpx_ne_u64 vcc, v[90:91], v[86:87]
    s_cbranch_execz L2_c58
    s_nop 2
    v_mfma_f32_4x4x4_16b_bf16 v[100:103], v[14:15], v[86:87], 0
    s_nop 1
    v_mfma_f32_4x4x4_16b_bf16 v[100:103], v[12:13], v[90:91], v[100:103]
    s_nop 4
    v_cvt_pk_bf16_f32 v100, v100, v101
    v_cvt_pk_bf16_f32 v101, v102, v103
    ds_pk_add_bf16 v104, v100
    ds_pk_add_bf16 v104, v101 offset:4
L2_c58:
    s_mov_b64 exec, -1
    ds_read_b64 v[86:87], v105
    v_mul_f32 v92, v107, v92
    v_mul_f32 v93, v107, v93
    v_mul_f32 v94, v107, v94
    v_mul_f32 v95, v107, v95
    v_and_b32 v108, 0x40000000, v37
    v_lshrrev_b32 v106, 14, v22
    v_bitop3_b32 v106, v106, v8, v108 bitop3:0xea
    ds_read_b64 v[84:85], v106 offset:63616
    s_waitcnt lgkmcnt(1)
    v_mfma_f32_4x4x4_16b_bf16 v[96:99], v[12:13], v[86:87], v[92:95]
    v_perm_b32 v107, v22, v33, s46
    v_bitop3_b32 v104, v22, v8, v108 bitop3:0xea
    v_bitop3_b32 v107, v107, v9, v10 bitop3:0xea
    v_bitop3_b32 v107, v22, v11, v107 bitop3:0xea
    s_nop 0
    v_cvt_pk_bf16_f32 v88, v96, v97
    v_cvt_pk_bf16_f32 v89, v98, v99
    ds_wrxchg_rtn_b64 v[90:91], v105, v[88:89]
    s_waitcnt lgkmcnt(1)
    v_mfma_f32_4x4x4_16b_bf16 v[92:95], v[12:13], v[84:85], 0
    s_waitcnt lgkmcnt(0)
    v_cmpx_ne_u64 vcc, v[90:91], v[86:87]
    s_cbranch_execz L2_c59
    s_nop 2
    v_mfma_f32_4x4x4_16b_bf16 v[100:103], v[14:15], v[86:87], 0
    s_nop 1
    v_mfma_f32_4x4x4_16b_bf16 v[100:103], v[12:13], v[90:91], v[100:103]
    s_nop 4
    v_cvt_pk_bf16_f32 v100, v100, v101
    v_cvt_pk_bf16_f32 v101, v102, v103
    ds_pk_add_bf16 v105, v100
    ds_pk_add_bf16 v105, v101 offset:4
L2_c59:
    s_mov_b64 exec, -1
    ds_read_b64 v[86:87], v104
    v_mul_f32 v92, v107, v92
    v_mul_f32 v93, v107, v93
    v_mul_f32 v94, v107, v94
    v_mul_f32 v95, v107, v95
    v_and_b32 v108, 0x80000000, v37
    v_lshrrev_b32 v106, 14, v23
    v_bitop3_b32 v106, v106, v8, v108 bitop3:0xea
    ds_read_b64 v[84:85], v106 offset:63616
    s_waitcnt lgkmcnt(1)
    v_mfma_f32_4x4x4_16b_bf16 v[96:99], v[12:13], v[86:87], v[92:95]
    v_perm_b32 v107, v23, v33, s47
    v_bitop3_b32 v105, v23, v8, v108 bitop3:0xea
    v_bitop3_b32 v107, v107, v9, v10 bitop3:0xea
    v_bitop3_b32 v107, v23, v11, v107 bitop3:0xea
    v_and_b32 v109, 0x0fffffff, v41
    v_mov_b32 v37, v41
    buffer_load_dwordx4 v[20:23], v109, s[8:11], 0 offen
    buffer_load_dword v33, v109, s[8:11], 0 offen offset:16
    v_cvt_pk_bf16_f32 v88, v96, v97
    v_cvt_pk_bf16_f32 v89, v98, v99
    ds_wrxchg_rtn_b64 v[90:91], v104, v[88:89]
    s_waitcnt lgkmcnt(1)
    v_mfma_f32_4x4x4_16b_bf16 v[92:95], v[12:13], v[84:85], 0
    s_waitcnt lgkmcnt(0)
    v_cmpx_ne_u64 vcc, v[90:91], v[86:87]
    s_cbranch_execz L2_c60
    s_nop 2
    v_mfma_f32_4x4x4_16b_bf16 v[100:103], v[14:15], v[86:87], 0
    s_nop 1
    v_mfma_f32_4x4x4_16b_bf16 v[100:103], v[12:13], v[90:91], v[100:103]
    s_nop 4
    v_cvt_pk_bf16_f32 v100, v100, v101
    v_cvt_pk_bf16_f32 v101, v102, v103
    ds_pk_add_bf16 v104, v100
    ds_pk_add_bf16 v104, v101 offset:4
L2_c60:
    s_mov_b64 exec, -1
    ds_read_b64 v[86:87], v105
    v_mul_f32 v92, v107, v92
    v_mul_f32 v93, v107, v93
    v_mul_f32 v94, v107, v94
    v_mul_f32 v95, v107, v95
    s_waitcnt vmcnt(11)
    v_and_b32 v108, 0x10000000, v38
    v_lshrrev_b32 v106, 14, v24
    v_bitop3_b32 v106, v106, v8, v108 bitop3:0xea
    ds_read_b64 v[84:85], v106 offset:63616
    s_waitcnt lgkmcnt(1)
    v_mfma_f32_4x4x4_16b_bf16 v[96:99], v[12:13], v[86:87], v[92:95]
    v_perm_b32 v107, v24, v34, s44
    v_bitop3_b32 v104, v24, v8, v108 bitop3:0xea
    v_bitop3_b32 v107, v107, v9, v10 bitop3:0xea
    v_bitop3_b32 v107, v24, v11, v107 bitop3:0xea
    s_nop 0
    v_cvt_pk_bf16_f32 v88, v96, v97
    v_cvt_pk_bf16_f32 v89, v98, v99
    ds_wrxchg_rtn_b64 v[90:91], v105, v[88:89]
    s_waitcnt lgkmcnt(1)
    v_mfma_f32_4x4x4_16b_bf16 v[92:95], v[12:13], v[84:85], 0
    s_waitcnt lgkmcnt(0)
    v_cmpx_ne_u64 vcc, v[90:91], v[86:87]
    s_cbranch_execz L2_c61
    s_nop 2
    v_mfma_f32_4x4x4_16b_bf16 v[100:103], v[14:15], v[86:87], 0
    s_nop 1
    v_mfma_f32_4x4x4_16b_bf16 v[100:103], v[12:13], v[90:91], v[100:103]
    s_nop 4
    v_cvt_pk_bf16_f32 v100, v100, v101
    v_cvt_pk_bf16_f32 v101, v102, v103
    ds_pk_add_bf16 v105, v100
    ds_pk_add_bf16 v105, v101 offset:4
L2_c61:
    s_mov_b64 exec, -1
    ds_read_b64 v[86:87], v104
    v_mul_f32 v92, v107, v92
    v_mul_f32 v93, v107, v93
    v_mul_f32 v94, v107, v94
    v_mul_f32 v95, v107, v95
    v_and_b32 v108, 0x20000000, v38
    v_lshrrev_b32 v106, 14, v25
    v_bitop3_b32 v106, v106, v8, v108 bitop3:0xea
    ds_read_b64 v[84:85], v106 offset:63616
    s_waitcnt lgkmcnt(1)
    v_mfma_f32_4x4x4_16b_bf16 v[96:99], v[12:13], v[86:87], v[92:95]
    v_perm_b32 v107, v25, v34, s45
    v_bitop3_b32 v105, v25, v8, v108 bitop3:0xea
    v_bitop3_b32 v107, v107, v9, v10 bitop3:0xea
    v_bitop3_b32 v107, v25, v11, v107 bitop3:0xea
    s_nop 0
    v_cvt_pk_bf16_f32 v88, v96, v97
    v_cvt_pk_bf16_f32 v89, v98, v99
    ds_wrxchg_rtn_b64 v[90:91], v104, v[88:89]
    s_waitcnt lgkmcnt(1)
    v_mfma_f32_4x4x4_16b_bf16 v[92:95], v[12:13], v[84:85], 0
    s_waitcnt lgkmcnt(0)
    v_cmpx_ne_u64 vcc, v[90:91], v[86:87]
    s_cbranch_execz L2_c62
    s_nop 2
    v_mfma_f32_4x4x4_16b_bf16 v[100:103], v[14:15], v[86:87], 0
    s_nop 1
    v_mfma_f32_4x4x4_16b_bf16 v[100:103], v[12:13], v[90:91], v[100:103]
    s_nop 4
    v_cvt_pk_bf16_f32 v100, v100, v101
    v_cvt_pk_bf16_f32 v101, v102, v103
    ds_pk_add_bf16 v104, v100
    ds_pk_add_bf16 v104, v101 offset:4
L2_c62:
    s_mov_b64 exec, -1
    ds_read_b64 v[86:87], v105
    v_mul_f32 v92, v107, v92
    v_mul_f32 v93, v107, v93
    v_mul_f32 v94, v107, v94
    v_mul_f32 v95, v107, v95
    v_and_b32 v108, 0x40000000, v38
    v_lshrrev_b32 v106, 14, v26
    v_bitop3_b32 v106, v106, v8, v108 bitop3:0xea
    ds_read_b64 v[84:85], v106 offset:63616
    s_waitcnt lgkmcnt(1)
    v_mfma_f32_4x4x4_16b_bf16 v[96:99], v[12:13], v[86:87], v[92:95]
    v_perm_b32 v107, v26, v34, s46
    v_bitop3_b32 v104, v26, v8, v108 bitop3:0xea
    v_bitop3_b32 v107, v107, v9, v10 bitop3:0xea
    v_bitop3_b32 v107, v26, v11, v107 bitop3:0xea
    s_nop 0
    v_cvt_pk_bf16_f32 v88, v96, v97
    v_cvt_pk_bf16_f32 v89, v98, v99
    ds_wrxchg_rtn_b64 v[90:91], v105, v[88:89]
    s_waitcnt lgkmcnt(1)
    v_mfma_f32_4x4x4_16b_bf16 v[92:95], v[12:13], v[84:85], 0
    s_waitcnt lgkmcnt(0)
    v_cmpx_ne_u64 vcc, v[90:91], v[86:87]
    s_cbranch_execz L2_c63
    s_nop 2
    v_mfma_f32_4x4x4_16b_bf16 v[100:103], v[14:15], v[86:87], 0
    s_nop 1
    v_mfma_f32_4x4x4_16b_bf16 v[100:103], v[12:13], v[90:91], v[100:103]
    s_nop 4
    v_cvt_pk_bf16_f32 v100, v100, v101
    v_cvt_pk_bf16_f32 v101, v102, v103
    ds_pk_add_bf16 v105, v100
    ds_pk_add_bf16 v105, v101 offset:4
L2_c63:
    s_mov_b64 exec, -1
    ds_read_b64 v[86:87], v104
    v_mul_f32 v92, v107, v92
    v_mul_f32 v93, v107, v93
    v_mul_f32 v94, v107, v94
    v_mul_f32 v95, v107, v95
    v_and_b32 v108, 0x80000000, v38
    v_lshrrev_b32 v106, 14, v27
    v_bitop3_b32 v106, v106, v8, v108 bitop3:0xea
    ds_read_b64 v[84:85], v106 offset:63616
    s_waitcnt lgkmcnt(1)
    v_mfma_f32_4x4x4_16b_bf16 v[96:99], v[12:13], v[86:87], v[92:95]
    v_perm_b32 v107, v27, v34, s47
    v_bitop3_b32 v105, v27, v8, v108 bitop3:0xea
    v_bitop3_b32 v107, v107, v9, v10 bitop3:0xea
    v_bitop3_b32 v107, v27, v11, v107 bitop3:0xea
    v_and_b32 v109, 0x0fffffff, v42
    v_mov_b32 v38, v42
    buffer_load_dwordx4 v[24:27], v109, s[8:11], 0 offen
    buffer_load_dword v34, v109, s[8:11], 0 offen offset:16
    v_cvt_pk_bf16_f32 v88, v96, v97
    v_cvt_pk_bf16_f32 v89, v98, v99
    ds_wrxchg_rtn_b64 v[90:91], v104, v[88:89]
    s_waitcnt lgkmcnt(1)
    v_mfma_f32_4x4x4_16b_bf16 v[92:95], v[12:13], v[84:85], 0
    s_waitcnt lgkmcnt(0)
    v_cmpx_ne_u64 vcc, v[90:91], v[86:87]
    s_cbranch_execz L2_c64
    s_nop 2
    v_mfma_f32_4x4x4_16b_bf16 v[100:103], v[14:15], v[86:87], 0
    s_nop 1
    v_mfma_f32_4x4x4_16b_bf16 v[100:103], v[12:13], v[90:91], v[100:103]
    s_nop 4
    v_cvt_pk_bf16_f32 v100, v100, v101
    v_cvt_pk_bf16_f32 v101, v102, v103
    ds_pk_add_bf16 v104, v100
    ds_pk_add_bf16 v104, v101 offset:4
L2_c64:
    s_mov_b64 exec, -1
    ds_read_b64 v[86:87], v105
    v_mul_f32 v92, v107, v92
    v_mul_f32 v93, v107, v93
    v_mul_f32 v94, v107, v94
    v_mul_f32 v95, v107, v95
    s_waitcnt vmcnt(11)
    v_and_b32 v108, 0x10000000, v39
    v_lshrrev_b32 v106, 14, v28
    v_bitop3_b32 v106, v106, v8, v108 bitop3:0xea
    ds_read_b64 v[84:85], v106 offset:63616
    s_waitcnt lgkmcnt(1)
    v_mfma_f32_4x4x4_16b_bf16 v[96:99], v[12:13], v[86:87], v[92:95]
    v_perm_b32 v107, v28, v35, s44
    v_bitop3_b32 v104, v28, v8, v108 bitop3:0xea
    v_bitop3_b32 v107, v107, v9, v10 bitop3:0xea
    v_bitop3_b32 v107, v28, v11, v107 bitop3:0xea
    s_nop 0
    v_cvt_pk_bf16_f32 v88, v96, v97
    v_cvt_pk_bf16_f32 v89, v98, v99
    ds_wrxchg_rtn_b64 v[90:91], v105, v[88:89]
    s_waitcnt lgkmcnt(1)
    v_mfma_f32_4x4x4_16b_bf16 v[92:95], v[12:13], v[84:85], 0
    s_waitcnt lgkmcnt(0)
    v_cmpx_ne_u64 vcc, v[90:91], v[86:87]
    s_cbranch_execz L2_c65
    s_nop 2
    v_mfma_f32_4x4x4_16b_bf16 v[100:103], v[14:15], v[86:87], 0
    s_nop 1
    v_mfma_f32_4x4x4_16b_bf16 v[100:103], v[12:13], v[90:91], v[100:103]
    s_nop 4
    v_cvt_pk_bf16_f32 v100, v100, v101
    v_cvt_pk_bf16_f32 v101, v102, v103
    ds_pk_add_bf16 v105, v100
    ds_pk_add_bf16 v105, v101 offset:4
L2_c65:
    s_mov_b64 exec, -1
    ds_read_b64 v[86:87], v104
    v_mul_f32 v92, v107, v92
    v_mul_f32 v93, v107, v93
    v_mul_f32 v94, v107, v94
    v_mul_f32 v95, v107, v95
    v_and_b32 v108, 0x20000000, v39
    v_lshrrev_b32 v106, 14, v29
    v_bitop3_b32 v106, v106, v8, v108 bitop3:0xea
    ds_read_b64 v[84:85], v106 offset:63616
    s_waitcnt lgkmcnt(1)
    v_mfma_f32_4x4x4_16b_bf16 v[96:99], v[12:13], v[86:87], v[92:95]
    v_perm_b32 v107, v29, v35, s45
    v_bitop3_b32 v105, v29, v8, v108 bitop3:0xea
    v_bitop3_b32 v107, v107, v9, v10 bitop3:0xea
    v_bitop3_b32 v107, v29, v11, v107 bitop3:0xea
    s_nop 0
    v_cvt_pk_bf16_f32 v88, v96, v97
    v_cvt_pk_bf16_f32 v89, v98, v99
    ds_wrxchg_rtn_b64 v[90:91], v104, v[88:89]
    s_waitcnt lgkmcnt(1)
    v_mfma_f32_4x4x4_16b_bf16 v[92:95], v[12:13], v[84:85], 0
    s_waitcnt lgkmcnt(0)
    v_cmpx_ne_u64 vcc, v[90:91], v[86:87]
    s_cbranch_execz L2_c66
    s_nop 2
    v_mfma_f32_4x4x4_16b_bf16 v[100:103], v[14:15], v[86:87], 0
    s_nop 1
    v_mfma_f32_4x4x4_16b_bf16 v[100:103], v[12:13], v[90:91], v[100:103]
    s_nop 4
    v_cvt_pk_bf16_f32 v100, v100, v101
    v_cvt_pk_bf16_f32 v101, v102, v103
    ds_pk_add_bf16 v104, v100
    ds_pk_add_bf16 v104, v101 offset:4
L2_c66:
    s_mov_b64 exec, -1
    ds_read_b64 v[86:87], v105
    v_mul_f32 v92, v107, v92
    v_mul_f32 v93, v107, v93
    v_mul_f32 v94, v107, v94
    v_mul_f32 v95, v107, v95
    v_and_b32 v108, 0x40000000, v39
    v_lshrrev_b32 v106, 14, v30
    v_bitop3_b32 v106, v106, v8, v108 bitop3:0xea
    ds_read_b64 v[84:85], v106 offset:63616
    s_waitcnt lgkmcnt(1)
    v_mfma_f32_4x4x4_16b_bf16 v[96:99], v[12:13], v[86:87], v[92:95]
    v_perm_b32 v107, v30, v35, s46
    v_bitop3_b32 v104, v30, v8, v108 bitop3:0xea
    v_bitop3_b32 v107, v107, v9, v10 bitop3:0xea
    v_bitop3_b32 v107, v30, v11, v107 bitop3:0xea
    s_nop 0
    v_cvt_pk_bf16_f32 v88, v96, v97
    v_cvt_pk_bf16_f32 v89, v98, v99
    ds_wrxchg_rtn_b64 v[90:91], v105, v[88:89]
    s_waitcnt lgkmcnt(1)
    v_mfma_f32_4x4x4_16b_bf16 v[92:95], v[12:13], v[84:85], 0
    s_waitcnt lgkmcnt(0)
    v_cmpx_ne_u64 vcc, v[90:91], v[86:87]
    s_cbranch_execz L2_c67
    s_nop 2
    v_mfma_f32_4x4x4_16b_bf16 v[100:103], v[14:15], v[86:87], 0
    s_nop 1
    v_mfma_f32_4x4x4_16b_bf16 v[100:103], v[12:13], v[90:91], v[100:103]
    s_nop 4
    v_cvt_pk_bf16_f32 v100, v100, v101
    v_cvt_pk_bf16_f32 v101, v102, v103
    ds_pk_add_bf16 v105, v100
    ds_pk_add_bf16 v105, v101 offset:4
L2_c67:
    s_mov_b64 exec, -1
    ds_read_b64 v[86:87], v104
    v_mul_f32 v92, v107, v92
    v_mul_f32 v93, v107, v93
    v_mul_f32 v94, v107, v94
    v_mul_f32 v95, v107, v95
    v_and_b32 v108, 0x80000000, v39
    v_lshrrev_b32 v106, 14, v31
    v_bitop3_b32 v106, v106, v8, v108 bitop3:0xea
    ds_read_b64 v[84:85], v106 offset:63616
    s_waitcnt lgkmcnt(1)
    v_mfma_f32_4x4x4_16b_bf16 v[96:99], v[12:13], v[86:87], v[92:95]
    v_perm_b32 v107, v31, v35, s47
    v_bitop3_b32 v105, v31, v8, v108 bitop3:0xea
    v_bitop3_b32 v107, v107, v9, v10 bitop3:0xea
    v_bitop3_b32 v107, v31, v11, v107 bitop3:0xea
    v_and_b32 v109, 0x0fffffff, v43
    v_mov_b32 v39, v43
    buffer_load_dwordx4 v[28:31], v109, s[8:11], 0 offen
    buffer_load_dword v35, v109, s[8:11], 0 offen offset:16
    v_cvt_pk_bf16_f32 v88, v96, v97
    v_cvt_pk_bf16_f32 v89, v98, v99
    ds_wrxchg_rtn_b64 v[90:91], v104, v[88:89]
    s_waitcnt lgkmcnt(1)
    v_mfma_f32_4x4x4_16b_bf16 v[92:95], v[12:13], v[84:85], 0
    s_waitcnt lgkmcnt(0)
    v_cmpx_ne_u64 vcc, v[90:91], v[86:87]
    s_cbranch_execz L2_c68
    s_nop 2
    v_mfma_f32_4x4x4_16b_bf16 v[100:103], v[14:15], v[86:87], 0
    s_nop 1
    v_mfma_f32_4x4x4_16b_bf16 v[100:103], v[12:13], v[90:91], v[100:103]
    s_nop 4
    v_cvt_pk_bf16_f32 v100, v100, v101
    v_cvt_pk_bf16_f32 v101, v102, v103
    ds_pk_add_bf16 v104, v100
    ds_pk_add_bf16 v104, v101 offset:4
L2_c68:
    s_mov_b64 exec, -1
    ds_read_b64 v[86:87], v105
    v_mul_f32 v92, v107, v92
    v_mul_f32 v93, v107, v93
    v_mul_f32 v94, v107, v94
    v_mul_f32 v95, v107, v95
    s_waitcnt lgkmcnt(0)
    s_nop 0
    v_mfma_f32_4x4x4_16b_bf16 v[96:99], v[12:13], v[86:87], v[92:95]
    s_nop 4
    v_cvt_pk_bf16_f32 v88, v96, v97
    v_cvt_pk_bf16_f32 v89, v98, v99
    ds_wrxchg_rtn_b64 v[90:91], v105, v[88:89]
    s_waitcnt lgkmcnt(0)
    v_cmpx_ne_u64 vcc, v[90:91], v[86:87]
    s_cbranch_execz L2_c69
    s_nop 2
    v_mfma_f32_4x4x4_16b_bf16 v[100:103], v[14:15], v[86:87], 0
    s_nop 1
    v_mfma_f32_4x4x4_16b_bf16 v[100:103], v[12:13], v[90:91], v[100:103]
    s_nop 4
    v_cvt_pk_bf16_f32 v100, v100, v101
    v_cvt_pk_bf16_f32 v101, v102, v103
    ds_pk_add_bf16 v105, v100
    ds_pk_add_bf16 v105, v101 offset:4
L2_c69:
    s_mov_b64 exec, -1
    s_bitcmp1_b32 s36, s42
    s_cbranch_scc1 L2_slow
L2_ret3:
    s_cmp_eq_u32 s35, 3
    s_cbranch_scc1 L2_done
    s_add_u32 s35, s35, 1
    s_barrier
    s_waitcnt vmcnt(8)
    s_mov_b32 s37, s38
    s_add_u32 s48, s38, 257
    v_lshrrev_b32 v110, 16, v64
    v_lshrrev_b32 v111, 16, v66
    v_and_b32 v112, -4, v110
    v_add_u32 v112, v112, v2
L2_x70_0:
    v_sub_u32 v113, v111, v112
    v_sub_u32 v115, v110, v112
    v_med3_i32 v114, v113, 0, 4
    v_max_i32 v115, 0, v115
    v_cmp_gt_i32 vcc, v114, v115
    v_mad_u32_u24 v116, v112, 5, v4
    v_bfm_b32 v114, v114, 28
    v_bfm_b32 v115, v115, 28
    v_mbcnt_lo_u32_b32 v117, vcc_lo, 0
    v_mbcnt_hi_u32_b32 v117, vcc_hi, v117
    v_bitop3_b32 v116, v114, v115, v116 bitop3:0x9a
    v_add_lshl_u32 v117, v117, s37, 2
    s_bcnt1_i32_b64 s41, vcc
    s_mov_b64 exec, vcc
    ds_write_b32 v117, v116
    s_mov_b64 exec, -1
    v_cmp_gt_i32 vcc, v113, v3
    s_add_u32 s37, s37, s41
    s_min_u32 s37, s37, s48
    s_cbranch_vccnz L2_xe70_0
L2_xr70_0:
    ds_write_b128 v7, v[52:55] offset:2048
    v_lshrrev_b32 v110, 16, v68
    v_lshrrev_b32 v111, 16, v70
    v_and_b32 v112, -4, v110
    v_add_u32 v112, v112, v2
    v_add_u32 v118, 0x2800000, v4
L2_x70_1:
    v_sub_u32 v113, v111, v112
    v_sub_u32 v115, v110, v112
    v_med3_i32 v114, v113, 0, 4
    v_max_i32 v115, 0, v115
    v_cmp_gt_i32 vcc, v114, v115
    v_mad_u32_u24 v116, v112, 5, v118
    v_bfm_b32 v114, v114, 28
    v_bfm_b32 v115, v115, 28
    v_mbcnt_lo_u32_b32 v117, vcc_lo, 0
    v_mbcnt_hi_u32_b32 v117, vcc_hi, v117
    v_bitop3_b32 v116, v114, v115, v116 bitop3:0x9a
    v_add_lshl_u32 v117, v117, s37, 2
    s_bcnt1_i32_b64 s41, vcc
    s_mov_b64 exec, vcc
    ds_write_b32 v117, v116
    s_mov_b64 exec, -1
    v_cmp_gt_i32 vcc, v113, v3
    s_add_u32 s37, s37, s41
    s_min_u32 s37, s37, s48
    s_cbranch_vccnz L2_xe70_1
L2_xr70_1:
    ds_write_b128 v7, v[56:59] offset:3072
    v_lshrrev_b32 v110, 16, v72
    v_lshrrev_b32 v111, 16, v74
    v_and_b32 v112, -4, v110
    v_add_u32 v112, v112, v2
    v_add_u32 v118, 0x5000000, v4
L2_x70_2:
    v_sub_u32 v113, v111, v112
    v_sub_u32 v115, v110, v112
    v_med3_i32 v114, v113, 0, 4
    v_max_i32 v115, 0, v115
    v_cmp_gt_i32 vcc, v114, v115
    v_mad_u32_u24 v116, v112, 5, v118
    v_bfm_b32 v114, v114, 28
    v_bfm_b32 v115, v115, 28
    v_mbcnt_lo_u32_b32 v117, vcc_lo, 0
    v_mbcnt_hi_u32_b32 v117, vcc_hi, v117
    v_bitop3_b32 v116, v114, v115, v116 bitop3:0x9a
    v_add_lshl_u32 v117, v117, s37, 2
    s_bcnt1_i32_b64 s41, vcc
    s_mov_b64 exec, vcc
    ds_write_b32 v117, v116
    s_mov_b64 exec, -1
    v_cmp_gt_i32 vcc, v113, v3
    s_add_u32 s37, s37, s41
    s_min_u32 s37, s37, s48
    s_cbranch_vccnz L2_xe70_2
L2_xr70_2:
    ds_write_b128 v7, v[60:63] offset:4096
    v_lshrrev_b32 v110, 16, v76
    v_lshrrev_b32 v111, 16, v78
    v_and_b32 v112, -4, v110
    v_add_u32 v112, v112, v2
    v_add_u32 v118, 0x7800000, v4
L2_x70_3:
    v_sub_u32 v113, v111, v112
    v_sub_u32 v115, v110, v112
    v_med3_i32 v114, v113, 0, 4
    v_max_i32 v115, 0, v115
    v_cmp_gt_i32 vcc, v114, v115
    v_mad_u32_u24 v116, v112, 5, v118
    v_bfm_b32 v114, v114, 28
    v_bfm_b32 v115, v115, 28
    v_mbcnt_lo_u32_b32 v117, vcc_lo, 0
    v_mbcnt_hi_u32_b32 v117, vcc_hi, v117
    v_bitop3_b32 v116, v114, v115, v116 bitop3:0x9a
    v_add_lshl_u32 v117, v117, s37, 2
    s_bcnt1_i32_b64 s41, vcc
    s_mov_b64 exec, vcc
    ds_write_b32 v117, v116
    s_mov_b64 exec, -1
    v_cmp_gt_i32 vcc, v113, v3
    s_add_u32 s37, s37, s41
    s_min_u32 s37, s37, s48
    s_cbranch_vccnz L2_xe70_3
L2_xr70_3:
    v_lshrrev_b32 v110, 16, v80
    v_lshrrev_b32 v111, 16, v82
    v_and_b32 v112, -4, v110
    v_add_u32 v112, v112, v2
    v_add_u32 v118, 0xa000000, v4
L2_x70_4:
    v_sub_u32 v113, v111, v112
    v_sub_u32 v115, v110, v112
    v_med3_i32 v114, v113, 0, 4
    v_max_i32 v115, 0, v115
    v_cmp_gt_i32 vcc, v114, v115
    v_mad_u32_u24 v116, v112, 5, v118
    v_bfm_b32 v114, v114, 28
    v_bfm_b32 v115, v115, 28
    v_mbcnt_lo_u32_b32 v117, vcc_lo, 0
    v_mbcnt_hi_u32_b32 v117, vcc_hi, v117
    v_bitop3_b32 v116, v114, v115, v116 bitop3:0x9a
    v_add_lshl_u32 v117, v117, s37, 2
    s_bcnt1_i32_b64 s41, vcc
    s_mov_b64 exec, vcc
    ds_write_b32 v117, v116
    s_mov_b64 exec, -1
    v_cmp_gt_i32 vcc, v113, v3
    s_add_u32 s37, s37, s41
    s_min_u32 s37, s37, s48
    s_cbranch_vccnz L2_xe70_4
L2_xr70_4:
    s_lshl_b32 s3, s37, 2
    v_add_u32 v117, s3, v1
    v_mov_b32 v116, -1
    ds_write_b32 v117, v116
    s_lshl_b32 s3, s38, 2
    v_add_u32 v117, s3, v1
    ds_read2st64_b32 v[40:41], v117 offset0:0 offset1:1
    ds_read2st64_b32 v[42:43], v117 offset0:2 offset1:3
    s_sub_u32 s41, s37, s38
    s_sub_u32 s3, s41, 192
    s_cmp_gt_u32 s3, 64
    s_cbranch_scc1 L2_xf70
L2_xg70:
    ds_write_b128 v7, v[44:47] offset:0
    ds_write_b128 v7, v[48:51] offset:1024
    buffer_load_dwordx4 v[44:47], v6, s[16:19], s40 offen offset:0
    buffer_load_dwordx4 v[48:51], v6, s[16:19], s40 offen offset:1024
    buffer_load_dwordx4 v[52:55], v6, s[16:19], s40 offen offset:2048
    buffer_load_dwordx4 v[56:59], v6, s[16:19], s40 offen offset:3072
    s_add_u32 s3, s40, 4096
    buffer_load_dwordx4 v[60:63], v6, s[16:19], s3 offen
    s_add_u32 s40, s40, 80000
    s_add_u32 s42, s42, 1
    s_waitcnt lgkmcnt(0)
    s_barrier
    s_branch L2_loop
L2_done:
    s_waitcnt lgkmcnt(0)
    s_barrier
    v_add_u32 v114, 0x10000, v0
    s_waitcnt vmcnt(0)
    ds_read_b128 v[44:47], v0 offset:0
    ds_read_b128 v[48:51], v0 offset:16384
    ds_read_b128 v[52:55], v0 offset:32768
    ds_read_b128 v[56:59], v0 offset:49152
    ds_read_b128 v[60:63], v114
    v_add_u32 v111, 16384, v0
    v_add_u32 v112, 32768, v0
    v_add_u32 v113, 49152, v0
    s_waitcnt lgkmcnt(4)
    buffer_store_dwordx4 v[44:47], v0, s[20:23], 0 offen
    s_waitcnt lgkmcnt(3)
    buffer_store_dwordx4 v[48:51], v111, s[20:23], 0 offen
    s_waitcnt lgkmcnt(2)
    buffer_store_dwordx4 v[52:55], v112, s[20:23], 0 offen
    s_waitcnt lgkmcnt(1)
    buffer_store_dwordx4 v[56:59], v113, s[20:23], 0 offen
    s_waitcnt lgkmcnt(0)
    buffer_store_dwordx4 v[60:63], v114, s[20:23], 0 offen
L2_end:
    s_endpgm
L2_slow:
    s_mov_b32 s50, s32
    s_lshr_b32 s3, s42, 2
    s_mul_i32 s53, s3, 520
    s_add_u32 s53, s53, s39
    s_and_b32 s3, s42, 2
    s_lshl_b32 s3, s3, 1
    s_add_u32 s53, s53, s3
    s_and_b32 s54, s42, 1
    s_lshl_b32 s54, s54, 4
L2_sl_seg:
    s_mul_i32 s3, s50, 8320
    s_add_u32 s3, s3, s53
    s_add_u32 s55, s3, 8
    s_buffer_load_dword s51, s[24:27], s3
    s_buffer_load_dword s52, s[24:27], s55
    s_mul_i32 s56, s50, 163840
    s_waitcnt lgkmcnt(0)
    s_lshr_b32 s51, s51, s54
    s_and_b32 s51, s51, 0xffff
    s_lshr_b32 s52, s52, s54
    s_and_b32 s52, s52, 0xffff
L2_sl_rec:
    s_cmp_ge_u32 s51, s52
    s_cbranch_scc1 L2_sl_next
    v_lshrrev_b32 v110, 2, v1
    v_add_u32 v110, s51, v110
    v_and_b32 v111, -4, v110
    v_lshl_add_u32 v112, v110, 2, v111
    v_lshl_add_u32 v113, v111, 2, v110
    v_cmp_gt_u32 vcc, s52, v110
    s_mov_b64 exec, vcc
    buffer_load_dword v114, v112, s[8:11], s56 offen
    buffer_load_ubyte v115, v113, s[8:11], s56 offen offset:16
    s_waitcnt vmcnt(0)
    v_lshrrev_b32 v106, 14, v114
    v_and_b32 v106, v8, v106
    ds_read_b64 v[84:85], v106 offset:63616
    v_perm_b32 v107, v114, v115, s44
    v_and_b32 v104, v8, v114
    v_bitop3_b32 v107, v107, v9, v10 bitop3:0xea
    v_bitop3_b32 v107, v114, v11, v107 bitop3:0xea
    s_waitcnt lgkmcnt(0)
    v_mfma_f32_4x4x4_16b_bf16 v[92:95], v[12:13], v[84:85], 0
    s_nop 4
    v_mul_f32 v92, v107, v92
    v_mul_f32 v93, v107, v93
    v_mul_f32 v94, v107, v94
    v_mul_f32 v95, v107, v95
    v_cvt_pk_bf16_f32 v88, v92, v93
    v_cvt_pk_bf16_f32 v89, v94, v95
    ds_pk_add_bf16 v104, v88
    ds_pk_add_bf16 v104, v89 offset:4
    s_mov_b64 exec, -1
    s_add_u32 s51, s51, 64
    s_branch L2_sl_rec
L2_sl_next:
    s_add_u32 s50, s50, 16
    s_cmp_lt_u32 s50, 1250
    s_cbranch_scc1 L2_sl_seg
    s_waitcnt lgkmcnt(0)
    s_and_b32 s3, s42, 3
    s_cmp_eq_u32 s3, 0
    s_cbranch_scc1 L2_ret0
    s_cmp_eq_u32 s3, 1
    s_cbranch_scc1 L2_ret1
    s_cmp_eq_u32 s3, 2
    s_cbranch_scc1 L2_ret2
    s_branch L2_ret3
L2_xe1_0:
    s_cmp_ge_u32 s37, s48
    s_cbranch_scc1 L2_xr1_0
    v_add_u32 v112, 16, v112
    s_branch L2_x1_0
L2_xe1_1:
    s_cmp_ge_u32 s37, s48
    s_cbranch_scc1 L2_xr1_1
    v_add_u32 v112, 16, v112
    s_branch L2_x1_1
L2_xe1_2:
    s_cmp_ge_u32 s37, s48
    s_cbranch_scc1 L2_xr1_2
    v_add_u32 v112, 16, v112
    s_branch L2_x1_2
L2_xe1_3:
    s_cmp_ge_u32 s37, s48
    s_cbranch_scc1 L2_xr1_3
    v_add_u32 v112, 16, v112
    s_branch L2_x1_3
L2_xe1_4:
    s_cmp_ge_u32 s37, s48
    s_cbranch_scc1 L2_xr1_4
    v_add_u32 v112, 16, v112
    s_branch L2_x1_4
L2_xf1:
    s_cmp_le_u32 s41, 256
    s_cbranch_scc1 L2_xh1
    s_add_u32 s3, s42, 0
    s_bitset1_b32 s36, s3
    s_mov_b32 s41, 0
L2_xh1:
    s_lshl_b32 s41, s41, 2
    s_waitcnt lgkmcnt(0)
    v_add_u32 v117, 0, v1
    v_cmp_gt_u32 vcc, s41, v117
    s_nop 1
    v_cndmask_b32 v40, -1, v40, vcc
    v_add_u32 v117, 256, v1
    v_cmp_gt_u32 vcc, s41, v117
    s_nop 1
    v_cndmask_b32 v41, -1, v41, vcc
    v_add_u32 v117, 512, v1
    v_cmp_gt_u32 vcc, s41, v117
    s_nop 1
    v_cndmask_b32 v42, -1, v42, vcc
    v_add_u32 v117, 768, v1
    v_cmp_gt_u32 vcc, s41, v117
    s_nop 1
    v_cndmask_b32 v43, -1, v43, vcc
    s_branch L2_xg1
L2_xe2_0:
    s_cmp_ge_u32 s37, s48
    s_cbranch_scc1 L2_xr2_0
    v_add_u32 v112, 16, v112
    s_branch L2_x2_0
L2_xe2_1:
    s_cmp_ge_u32 s37, s48
    s_cbranch_scc1 L2_xr2_1
    v_add_u32 v112, 16, v112
    s_branch L2_x2_1
L2_xe2_2:
    s_cmp_ge_u32 s37, s48
    s_cbranch_scc1 L2_xr2_2
    v_add_u32 v112, 16, v112
    s_branch L2_x2_2
L2_xe2_3:
    s_cmp_ge_u32 s37, s48
    s_cbranch_scc1 L2_xr2_3
    v_add_u32 v112, 16, v112
    s_branch L2_x2_3
L2_xe2_4:
    s_cmp_ge_u32 s37, s48
    s_cbranch_scc1 L2_xr2_4
    v_add_u32 v112, 16, v112
    s_branch L2_x2_4
L2_xf2:
    s_cmp_le_u32 s41, 256
    s_cbranch_scc1 L2_xh2
    s_add_u32 s3, s42, 1
    s_bitset1_b32 s36, s3
    s_mov_b32 s41, 0
L2_xh2:
    s_lshl_b32 s41, s41, 2
    s_waitcnt lgkmcnt(0)
    v_add_u32 v117, 0, v1
    v_cmp_gt_u32 vcc, s41, v117
    s_nop 1
    v_cndmask_b32 v40, -1, v40, vcc
    v_add_u32 v117, 256, v1
    v_cmp_gt_u32 vcc, s41, v117
    s_nop 1
    v_cndmask_b32 v41, -1, v41, vcc
    v_add_u32 v117, 512, v1
    v_cmp_gt_u32 vcc, s41, v117
    s_nop 1
    v_cndmask_b32 v42, -1, v42, vcc
    v_add_u32 v117, 768, v1
    v_cmp_gt_u32 vcc, s41, v117
    s_nop 1
    v_cndmask_b32 v43, -1, v43, vcc
    s_branch L2_xg2
L2_xe19_0:
    s_cmp_ge_u32 s37, s48
    s_cbranch_scc1 L2_xr19_0
    v_add_u32 v112, 16, v112
    s_branch L2_x19_0
L2_xe19_1:
    s_cmp_ge_u32 s37, s48
    s_cbranch_scc1 L2_xr19_1
    v_add_u32 v112, 16, v112
    s_branch L2_x19_1
L2_xe19_2:
    s_cmp_ge_u32 s37, s48
    s_cbranch_scc1 L2_xr19_2
    v_add_u32 v112, 16, v112
    s_branch L2_x19_2
L2_xe19_3:
    s_cmp_ge_u32 s37, s48
    s_cbranch_scc1 L2_xr19_3
    v_add_u32 v112, 16, v112
    s_branch L2_x19_3
L2_xe19_4:
    s_cmp_ge_u32 s37, s48
    s_cbranch_scc1 L2_xr19_4
    v_add_u32 v112, 16, v112
    s_branch L2_x19_4
L2_xf19:
    s_cmp_le_u32 s41, 256
    s_cbranch_scc1 L2_xh19
    s_add_u32 s3, s42, 2
    s_bitset1_b32 s36, s3
    s_mov_b32 s41, 0
L2_xh19:
    s_lshl_b32 s41, s41, 2
    s_waitcnt lgkmcnt(0)
    v_add_u32 v117, 0, v1
    v_cmp_gt_u32 vcc, s41, v117
    s_nop 1
    v_cndmask_b32 v40, -1, v40, vcc
    v_add_u32 v117, 256, v1
    v_cmp_gt_u32 vcc, s41, v117
    s_nop 1
    v_cndmask_b32 v41, -1, v41, vcc
    v_add_u32 v117, 512, v1
    v_cmp_gt_u32 vcc, s41, v117
    s_nop 1
    v_cndmask_b32 v42, -1, v42, vcc
    v_add_u32 v117, 768, v1
    v_cmp_gt_u32 vcc, s41, v117
    s_nop 1
    v_cndmask_b32 v43, -1, v43, vcc
    s_branch L2_xg19
L2_xe36_0:
    s_cmp_ge_u32 s37, s48
    s_cbranch_scc1 L2_xr36_0
    v_add_u32 v112, 16, v112
    s_branch L2_x36_0
L2_xe36_1:
    s_cmp_ge_u32 s37, s48
    s_cbranch_scc1 L2_xr36_1
    v_add_u32 v112, 16, v112
    s_branch L2_x36_1
L2_xe36_2:
    s_cmp_ge_u32 s37, s48
    s_cbranch_scc1 L2_xr36_2
    v_add_u32 v112, 16, v112
    s_branch L2_x36_2
L2_xe36_3:
    s_cmp_ge_u32 s37, s48
    s_cbranch_scc1 L2_xr36_3
    v_add_u32 v112, 16, v112
    s_branch L2_x36_3
L2_xe36_4:
    s_cmp_ge_u32 s37, s48
    s_cbranch_scc1 L2_xr36_4
    v_add_u32 v112, 16, v112
    s_branch L2_x36_4
L2_xf36:
    s_cmp_le_u32 s41, 256
    s_cbranch_scc1 L2_xh36
    s_add_u32 s3, s42, 2
    s_bitset1_b32 s36, s3
    s_mov_b32 s41, 0
L2_xh36:
    s_lshl_b32 s41, s41, 2
    s_waitcnt lgkmcnt(0)
    v_add_u32 v117, 0, v1
    v_cmp_gt_u32 vcc, s41, v117
    s_nop 1
    v_cndmask_b32 v40, -1, v40, vcc
    v_add_u32 v117, 256, v1
    v_cmp_gt_u32 vcc, s41, v117
    s_nop 1
    v_cndmask_b32 v41, -1, v41, vcc
    v_add_u32 v117, 512, v1
    v_cmp_gt_u32 vcc, s41, v117
    s_nop 1
    v_cndmask_b32 v42, -1, v42, vcc
    v_add_u32 v117, 768, v1
    v_cmp_gt_u32 vcc, s41, v117
    s_nop 1
    v_cndmask_b32 v43, -1, v43, vcc
    s_branch L2_xg36
L2_xe53_0:
    s_cmp_ge_u32 s37, s48
    s_cbranch_scc1 L2_xr53_0
    v_add_u32 v112, 16, v112
    s_branch L2_x53_0
L2_xe53_1:
    s_cmp_ge_u32 s37, s48
    s_cbranch_scc1 L2_xr53_1
    v_add_u32 v112, 16, v112
    s_branch L2_x53_1
L2_xe53_2:
    s_cmp_ge_u32 s37, s48
    s_cbranch_scc1 L2_xr53_2
    v_add_u32 v112, 16, v112
    s_branch L2_x53_2
L2_xe53_3:
    s_cmp_ge_u32 s37, s48
    s_cbranch_scc1 L2_xr53_3
    v_add_u32 v112, 16, v112
    s_branch L2_x53_3
L2_xe53_4:
    s_cmp_ge_u32 s37, s48
    s_cbranch_scc1 L2_xr53_4
    v_add_u32 v112, 16, v112
    s_branch L2_x53_4
L2_xf53:
    s_cmp_le_u32 s41, 256
    s_cbranch_scc1 L2_xh53
    s_add_u32 s3, s42, 2
    s_bitset1_b32 s36, s3
    s_mov_b32 s41, 0
L2_xh53:
    s_lshl_b32 s41, s41, 2
    s_waitcnt lgkmcnt(0)
    v_add_u32 v117, 0, v1
    v_cmp_gt_u32 vcc, s41, v117
    s_nop 1
    v_cndmask_b32 v40, -1, v40, vcc
    v_add_u32 v117, 256, v1
    v_cmp_gt_u32 vcc, s41, v117
    s_nop 1
    v_cndmask_b32 v41, -1, v41, vcc
    v_add_u32 v117, 512, v1
    v_cmp_gt_u32 vcc, s41, v117
    s_nop 1
    v_cndmask_b32 v42, -1, v42, vcc
    v_add_u32 v117, 768, v1
    v_cmp_gt_u32 vcc, s41, v117
    s_nop 1
    v_cndmask_b32 v43, -1, v43, vcc
    s_branch L2_xg53
L2_xe70_0:
    s_cmp_ge_u32 s37, s48
    s_cbranch_scc1 L2_xr70_0
    v_add_u32 v112, 16, v112
    s_branch L2_x70_0
L2_xe70_1:
    s_cmp_ge_u32 s37, s48
    s_cbranch_scc1 L2_xr70_1
    v_add_u32 v112, 16, v112
    s_branch L2_x70_1
L2_xe70_2:
    s_cmp_ge_u32 s37, s48
    s_cbranch_scc1 L2_xr70_2
    v_add_u32 v112, 16, v112
    s_branch L2_x70_2
L2_xe70_3:
    s_cmp_ge_u32 s37, s48
    s_cbranch_scc1 L2_xr70_3
    v_add_u32 v112, 16, v112
    s_branch L2_x70_3
L2_xe70_4:
    s_cmp_ge_u32 s37, s48
    s_cbranch_scc1 L2_xr70_4
    v_add_u32 v112, 16, v112
    s_branch L2_x70_4
L2_xf70:
    s_cmp_le_u32 s41, 256
    s_cbranch_scc1 L2_xh70
    s_add_u32 s3, s42, 2
    s_bitset1_b32 s36, s3
    s_mov_b32 s41, 0
L2_xh70:
    s_lshl_b32 s41, s41, 2
    s_waitcnt lgkmcnt(0)
    v_add_u32 v117, 0, v1
    v_cmp_gt_u32 vcc, s41, v117
    s_nop 1
    v_cndmask_b32 v40, -1, v40, vcc
    v_add_u32 v117, 256, v1
    v_cmp_gt_u32 vcc, s41, v117
    s_nop 1
    v_cndmask_b32 v41, -1, v41, vcc
    v_add_u32 v117, 512, v1
    v_cmp_gt_u32 vcc, s41, v117
    s_nop 1
    v_cndmask_b32 v42, -1, v42, vcc
    v_add_u32 v117, 768, v1
    v_cmp_gt_u32 vcc, s41, v117
    s_nop 1
    v_cndmask_b32 v43, -1, v43, vcc
    s_branch L2_xg70
.text
.globl gs_final_kernel
.p2align 8
.type gs_final_kernel,@function
gs_final_kernel:
    s_cmp_ge_u32 s2, 1250
    s_cbranch_scc1 L3_end
    s_load_dwordx2 s[4:5], s[0:1], 0
    s_load_dwordx2 s[6:7], s[0:1], 24
    s_load_dwordx2 s[28:29], s[0:1], 40
    s_load_dwordx2 s[30:31], s[0:1], 88
    s_load_dwordx2 s[32:33], s[0:1], 104
    s_lshl_b32 s3, s2, 8
    v_add_u32 v1, s3, v0
    v_lshlrev_b32 v2, 4, v1
    v_lshlrev_b32 v3, 2, v1
    v_bfe_u32 v4, v1, 3, 6
    s_mov_b32 s3, 80000
    v_mul_lo_u32 v4, v4, s3
    v_lshrrev_b32 v5, 9, v1
    v_lshl_add_u32 v4, v5, 7, v4
    v_and_b32 v5, 7, v1
    v_lshl_add_u32 v4, v5, 4, v4
    v_and_b32 v5, 3, v0
    v_lshlrev_b32 v5, 6, v5
    s_waitcnt lgkmcnt(0)
    s_load_dwordx4 s[36:39], s[28:29], 0
    s_mov_b32 s8, s4
    s_mov_b32 s9, s5
    s_mov_b32 s10, 0x4e2000
    s_mov_b32 s11, 0x20000
    s_mov_b32 s12, s6
    s_mov_b32 s13, s7
    s_mov_b32 s14, 0x138800
    s_mov_b32 s15, 0x20000
    s_mov_b32 s16, s30
    s_mov_b32 s17, s31
    s_mov_b32 s18, 0x4e2000
    s_mov_b32 s19, 0x20000
    s_add_u32 s20, s32, 0xd21e100
    s_addc_u32 s21, s33, 0
    s_mov_b32 s22, 0x1388000
    s_mov_b32 s23, 0x20000
    s_add_u32 s24, s32, 0xe5a6100
    s_addc_u32 s25, s33, 0
    s_mov_b32 s26, 0x100
    s_mov_b32 s27, 0x20000
    buffer_load_dword v6, v3, s[12:15], 0 offen
    buffer_load_dwordx4 v[8:11], v5, s[24:27], 0 offen
    buffer_load_dwordx4 v[12:15], v5, s[24:27], 0 offen offset:16
    buffer_load_dwordx2 v[16:17], v5, s[24:27], 0 offen offset:32
    s_mov_b32 s40, 0
    buffer_load_dwordx4 v[20:23], v4, s[20:23], s40 offen
    s_mov_b32 s41, 5120000
    buffer_load_dwordx4 v[24:27], v4, s[20:23], s41 offen
    s_mov_b32 s42, 10240000
    buffer_load_dwordx4 v[28:31], v4, s[20:23], s42 offen
    s_mov_b32 s43, 15360000
    buffer_load_dwordx4 v[32:35], v4, s[20:23], s43 offen
    buffer_load_dwordx4 v[36:39], v2, s[8:11], 0 offen
    v_and_b32 v7, 3, v0
    v_lshlrev_b32 v7, 4, v7
    v_mov_b32 v18, 0x3f80
    v_mov_b32 v19, 0
    v_lshlrev_b64 v[18:19], v7, v[18:19]
    s_waitcnt lgkmcnt(0)
    s_lshl_b32 s44, s36, 16
    s_and_b32 s45, s36, 0xffff0000
    s_lshl_b32 s46, s37, 16
    s_and_b32 s47, s37, 0xffff0000
    s_lshl_b32 s48, s38, 16
    s_and_b32 s49, s38, 0xffff0000
    s_lshl_b32 s50, s39, 16
    s_and_b32 s51, s39, 0xffff0000
    s_waitcnt vmcnt(8)
    v_lshlrev_b32 v7, 16, v6
    v_subrev_f32 v48, s44, v7
    v_subrev_f32 v49, s45, v7
    v_subrev_f32 v50, s46, v7
    v_subrev_f32 v51, s47, v7
    v_subrev_f32 v52, s48, v7
    v_subrev_f32 v53, s49, v7
    v_subrev_f32 v54, s50, v7
    v_subrev_f32 v55, s51, v7
    v_cvt_pk_bf16_f32 v56, v48, v49
    v_cvt_pk_bf16_f32 v57, v50, v51
    v_cvt_pk_bf16_f32 v58, v52, v53
    v_cvt_pk_bf16_f32 v59, v54, v55
    v_lshlrev_b32 v48, 16, v56
    v_and_b32 v49, 0xffff0000, v56
    v_lshlrev_b32 v50, 16, v57
    v_and_b32 v51, 0xffff0000, v57
    v_lshlrev_b32 v52, 16, v58
    v_and_b32 v53, 0xffff0000, v58
    v_lshlrev_b32 v54, 16, v59
    v_and_b32 v55, 0xffff0000, v59
    v_mul_f32 v48, v48, v48
    v_mul_f32 v49, v49, v49
    v_mul_f32 v50, v50, v50
    v_mul_f32 v51, v51, v51
    v_mul_f32 v52, v52, v52
    v_mul_f32 v53, v53, v53
    v_mul_f32 v54, v54, v54
    v_mul_f32 v55, v55, v55
    v_cvt_pk_bf16_f32 v56, v48, v49
    v_cvt_pk_bf16_f32 v57, v50, v51
    v_cvt_pk_bf16_f32 v58, v52, v53
    v_cvt_pk_bf16_f32 v59, v54, v55
    v_lshlrev_b32 v48, 16, v56
    v_and_b32 v49, 0xffff0000, v56
    v_lshlrev_b32 v50, 16, v57
    v_and_b32 v51, 0xffff0000, v57
    v_lshlrev_b32 v52, 16, v58
    v_and_b32 v53, 0xffff0000, v58
    v_lshlrev_b32 v54, 16, v59
    v_and_b32 v55, 0xffff0000, v59
    v_mul_f32 v48, 0xc1200000, v48
    v_mul_f32 v49, 0xc1200000, v49
    v_mul_f32 v50, 0xc1200000, v50
    v_mul_f32 v51, 0xc1200000, v51
    v_mul_f32 v52, 0xc1200000, v52
    v_mul_f32 v53, 0xc1200000, v53
    v_mul_f32 v54, 0xc1200000, v54
    v_mul_f32 v55, 0xc1200000, v55
    v_cvt_pk_bf16_f32 v56, v48, v49
    v_cvt_pk_bf16_f32 v57, v50, v51
    v_cvt_pk_bf16_f32 v58, v52, v53
    v_cvt_pk_bf16_f32 v59, v54, v55
    v_lshlrev_b32 v48, 16, v56
    v_and_b32 v49, 0xffff0000, v56
    v_lshlrev_b32 v50, 16, v57
    v_and_b32 v51, 0xffff0000, v57
    v_lshlrev_b32 v52, 16, v58
    v_and_b32 v53, 0xffff0000, v58
    v_lshlrev_b32 v54, 16, v59
    v_and_b32 v55, 0xffff0000, v59
    v_mul_f32 v48, 0x3fb8aa3b, v48
    v_mul_f32 v49, 0x3fb8aa3b, v49
    v_mul_f32 v50, 0x3fb8aa3b, v50
    v_mul_f32 v51, 0x3fb8aa3b, v51
    v_mul_f32 v52, 0x3fb8aa3b, v52
    v_mul_f32 v53, 0x3fb8aa3b, v53
    v_mul_f32 v54, 0x3fb8aa3b, v54
    v_mul_f32 v55, 0x3fb8aa3b, v55
    v_exp_f32 v48, v48
    v_exp_f32 v49, v49
    v_exp_f32 v50, v50
    v_exp_f32 v51, v51
    v_exp_f32 v52, v52
    v_exp_f32 v53, v53
    v_exp_f32 v54, v54
    v_exp_f32 v55, v55
    v_cvt_pk_bf16_f32 v40, v48, v49
    v_cvt_pk_bf16_f32 v41, v50, v51
    v_cvt_pk_bf16_f32 v42, v52, v53
    v_cvt_pk_bf16_f32 v43, v54, v55
    v_and_b32 v7, 0xffff0000, v6
    v_subrev_f32 v48, s44, v7
    v_subrev_f32 v49, s45, v7
    v_subrev_f32 v50, s46, v7
    v_subrev_f32 v51, s47, v7
    v_subrev_f32 v52, s48, v7
    v_subrev_f32 v53, s49, v7
    v_subrev_f32 v54, s50, v7
    v_subrev_f32 v55, s51, v7
    v_cvt_pk_bf16_f32 v56, v48, v49
    v_cvt_pk_bf16_f32 v57, v50, v51
    v_cvt_pk_bf16_f32 v58, v52, v53
    v_cvt_pk_bf16_f32 v59, v54, v55
    v_lshlrev_b32 v48, 16, v56
    v_and_b32 v49, 0xffff0000, v56
    v_lshlrev_b32 v50, 16, v57
    v_and_b32 v51, 0xffff0000, v57
    v_lshlrev_b32 v52, 16, v58
    v_and_b32 v53, 0xffff0000, v58
    v_lshlrev_b32 v54, 16, v59
    v_and_b32 v55, 0xffff0000, v59
    v_mul_f32 v48, v48, v48
    v_mul_f32 v49, v49, v49
    v_mul_f32 v50, v50, v50
    v_mul_f32 v51, v51, v51
    v_mul_f32 v52, v52, v52
    v_mul_f32 v53, v53, v53
    v_mul_f32 v54, v54, v54
    v_mul_f32 v55, v55, v55
    v_cvt_pk_bf16_f32 v56, v48, v49
    v_cvt_pk_bf16_f32 v57, v50, v51
    v_cvt_pk_bf16_f32 v58, v52, v53
    v_cvt_pk_bf16_f32 v59, v54, v55
    v_lshlrev_b32 v48, 16, v56
    v_and_b32 v49, 0xffff0000, v56
    v_lshlrev_b32 v50, 16, v57
    v_and_b32 v51, 0xffff0000, v57
    v_lshlrev_b32 v52, 16, v58
    v_and_b32 v53, 0xffff0000, v58
    v_lshlrev_b32 v54, 16, v59
    v_and_b32 v55, 0xffff0000, v59
    v_mul_f32 v48, 0xc1200000, v48
    v_mul_f32 v49, 0xc1200000, v49
    v_mul_f32 v50, 0xc1200000, v50
    v_mul_f32 v51, 0xc1200000, v51
    v_mul_f32 v52, 0xc1200000, v52
    v_mul_f32 v53, 0xc1200000, v53
    v_mul_f32 v54, 0xc1200000, v54
    v_mul_f32 v55, 0xc1200000, v55
    v_cvt_pk_bf16_f32 v56, v48, v49
    v_cvt_pk_bf16_f32 v57, v50, v51
    v_cvt_pk_bf16_f32 v58, v52, v53
    v_cvt_pk_bf16_f32 v59, v54, v55
    v_lshlrev_b32 v48, 16, v56
    v_and_b32 v49, 0xffff0000, v56
    v_lshlrev_b32 v50, 16, v57
    v_and_b32 v51, 0xffff0000, v57
    v_lshlrev_b32 v52, 16, v58
    v_and_b32 v53, 0xffff0000, v58
    v_lshlrev_b32 v54, 16, v59
    v_and_b32 v55, 0xffff0000, v59
    v_mul_f32 v48, 0x3fb8aa3b, v48
    v_mul_f32 v49, 0x3fb8aa3b, v49
    v_mul_f32 v50, 0x3fb8aa3b, v50
    v_mul_f32 v51, 0x3fb8aa3b, v51
    v_mul_f32 v52, 0x3fb8aa3b, v52
    v_mul_f32 v53, 0x3fb8aa3b, v53
    v_mul_f32 v54, 0x3fb8aa3b, v54
    v_mul_f32 v55, 0x3fb8aa3b, v55
    v_exp_f32 v48, v48
    v_exp_f32 v49, v49
    v_exp_f32 v50, v50
    v_exp_f32 v51, v51
    v_exp_f32 v52, v52
    v_exp_f32 v53, v53
    v_exp_f32 v54, v54
    v_exp_f32 v55, v55
    v_cvt_pk_bf16_f32 v44, v48, v49
    v_cvt_pk_bf16_f32 v45, v50, v51
    v_cvt_pk_bf16_f32 v46, v52, v53
    v_cvt_pk_bf16_f32 v47, v54, v55
    s_waitcnt vmcnt(5)
    v_mfma_f32_4x4x4_16b_bf16 v[48:51], v[8:9], v[40:41], 0
    v_mfma_f32_4x4x4_16b_bf16 v[56:59], v[12:13], v[40:41], 0
    v_mfma_f32_4x4x4_16b_bf16 v[52:55], v[8:9], v[44:45], 0
    v_mfma_f32_4x4x4_16b_bf16 v[60:63], v[12:13], v[44:45], 0
    v_mfma_f32_4x4x4_16b_bf16 v[48:51], v[10:11], v[42:43], v[48:51]
    v_mfma_f32_4x4x4_16b_bf16 v[56:59], v[14:15], v[42:43], v[56:59]
    v_mfma_f32_4x4x4_16b_bf16 v[52:55], v[10:11], v[46:47], v[52:55]
    v_mfma_f32_4x4x4_16b_bf16 v[60:63], v[14:15], v[46:47], v[60:63]
    s_waitcnt vmcnt(1)
    v_mfma_f32_4x4x4_16b_bf16 v[64:67], v[18:19], v[20:21], 0
    v_mfma_f32_4x4x4_16b_bf16 v[68:71], v[18:19], v[22:23], 0
    s_nop 0
    v_mfma_f32_4x4x4_16b_bf16 v[64:67], v[18:19], v[24:25], v[64:67]
    v_mfma_f32_4x4x4_16b_bf16 v[68:71], v[18:19], v[26:27], v[68:71]
    s_nop 0
    v_mfma_f32_4x4x4_16b_bf16 v[64:67], v[18:19], v[28:29], v[64:67]
    v_mfma_f32_4x4x4_16b_bf16 v[68:71], v[18:19], v[30:31], v[68:71]
    s_nop 0
    v_mfma_f32_4x4x4_16b_bf16 v[64:67], v[18:19], v[32:33], v[64:67]
    v_mfma_f32_4x4x4_16b_bf16 v[68:71], v[18:19], v[34:35], v[68:71]
    s_nop 3
    v_mul_f32 v64, v64, v48
    v_mul_f32 v65, v65, v49
    v_mul_f32 v66, v66, v50
    v_mul_f32 v67, v67, v51
    v_cvt_pk_bf16_f32 v20, v64, v65
    v_cvt_pk_bf16_f32 v21, v66, v67
    v_mul_f32 v68, v68, v52
    v_mul_f32 v69, v69, v53
    v_mul_f32 v70, v70, v54
    v_mul_f32 v71, v71, v55
    v_cvt_pk_bf16_f32 v22, v68, v69
    v_cvt_pk_bf16_f32 v23, v70, v71
    v_mfma_f32_4x4x4_16b_bf16 v[48:51], v[16:17], v[20:21], 0
    s_nop 0
    v_mfma_f32_4x4x4_16b_bf16 v[52:55], v[16:17], v[22:23], 0
    s_nop 2
    v_mul_f32 v48, v48, v56
    v_mul_f32 v49, v49, v57
    v_mul_f32 v50, v50, v58
    v_mul_f32 v51, v51, v59
    v_mul_f32 v52, v52, v60
    v_mul_f32 v53, v53, v61
    v_mul_f32 v54, v54, v62
    v_mul_f32 v55, v55, v63
    s_waitcnt vmcnt(0)
    v_mfma_f32_4x4x4_16b_bf16 v[64:67], v[18:19], v[36:37], v[48:51]
    v_mfma_f32_4x4x4_16b_bf16 v[68:71], v[18:19], v[38:39], v[52:55]
    s_nop 3
    v_cvt_pk_bf16_f32 v24, v64, v65
    v_cvt_pk_bf16_f32 v25, v66, v67
    v_cvt_pk_bf16_f32 v26, v68, v69
    v_cvt_pk_bf16_f32 v27, v70, v71
    buffer_store_dwordx4 v[24:27], v2, s[16:19], 0 offen
L3_end:
    s_endpgm
.section .rodata,"a"
.p2align 6
.amdhsa_kernel gs_sort_kernel
  .amdhsa_next_free_vgpr 128
  .amdhsa_next_free_sgpr 96
  .amdhsa_accum_offset 128
  .amdhsa_group_segment_fixed_size 0
  .amdhsa_kernarg_size 112
  .amdhsa_user_sgpr_count 2
  .amdhsa_user_sgpr_kernarg_segment_ptr 1
  .amdhsa_system_sgpr_workgroup_id_x 1
  .amdhsa_float_denorm_mode_32 3
.end_amdhsa_kernel
.p2align 6
.amdhsa_kernel gs_acc_kernel
  .amdhsa_next_free_vgpr 128
  .amdhsa_next_free_sgpr 96
  .amdhsa_accum_offset 128
  .amdhsa_group_segment_fixed_size 0
  .amdhsa_kernarg_size 112
  .amdhsa_user_sgpr_count 2
  .amdhsa_user_sgpr_kernarg_segment_ptr 1
  .amdhsa_system_sgpr_workgroup_id_x 1
  .amdhsa_float_denorm_mode_32 3
.end_amdhsa_kernel
.p2align 6
.amdhsa_kernel gs_final_kernel
  .amdhsa_next_free_vgpr 72
  .amdhsa_next_free_sgpr 64
  .amdhsa_accum_offset 72
  .amdhsa_group_segment_fixed_size 0
  .amdhsa_kernarg_size 112
  .amdhsa_user_sgpr_count 2
  .amdhsa_user_sgpr_kernarg_segment_ptr 1
  .amdhsa_system_sgpr_workgroup_id_x 1
  .amdhsa_float_denorm_mode_32 3
.end_amdhsa_kernel
```

```asm
; @launch kernel=gs_sort_kernel grid=(256,1,1) block=(1024,1,1) lds=163840
; @launch kernel=gs_acc_kernel grid=(256,1,1) block=(1024,1,1) lds=163840
; @launch kernel=gs_final_kernel grid=(1250,1,1) block=(256,1,1) lds=0
.amdgcn_target "amdgcn-amd-amdhsa--gfx950"
.text
.globl gs_sort_kernel
.p2align 8
.type gs_sort_kernel,@function
gs_sort_kernel:
    s_cmp_ge_u32 s2, 256
    s_cbranch_scc1 L1_end
    s_load_dwordx4 s[4:7], s[0:1], 8
    s_load_dwordx2 s[28:29], s[0:1], 32
    s_load_dwordx2 s[30:31], s[0:1], 104
    s_cmp_ge_u32 s2, 250
    s_cbranch_scc1 L1_md
    v_lshrrev_b32 v7, 6, v0
    v_lshlrev_b32 v1, 3, v0
    v_readfirstlane_b32 s32, v7
    v_lshlrev_b32 v0, 4, v0
    s_waitcnt lgkmcnt(0)
    s_mov_b32 s8, s4
    s_mov_b32 s9, s5
    s_mov_b32 s10, 0x9c40000
    s_mov_b32 s11, 0x20000
    s_mov_b32 s12, s6
    s_mov_b32 s13, s7
    s_mov_b32 s14, 0x9c40000
    s_mov_b32 s15, 0x20000
    s_mov_b32 s16, s28
    s_mov_b32 s17, s29
    s_mov_b32 s18, 0x4e20000
    s_mov_b32 s19, 0x20000
    s_mov_b32 s20, s30
    s_mov_b32 s21, s31
    s_mov_b32 s22, 0xc350000
    s_mov_b32 s23, 0x20000
    s_add_u32 s24, s30, 0xc350000
    s_addc_u32 s25, s31, 0
    s_mov_b32 s26, 0x9eb100
    s_mov_b32 s27, 0x20000
    s_mul_i32 s33, s2, 131072
    s_mul_i32 s34, s2, 65536
    s_mul_i32 s35, s2, 163840
    s_mul_i32 s36, s2, 8320
    s_lshl_b32 s37, s32, 3
    s_add_u32 s36, s36, s37
    s_add_u32 s44, s33, 0x0
    buffer_load_dwordx4 v[16:19], v0, s[8:11], s44 offen nt
    s_add_u32 s45, s33, 0x0
    buffer_load_dwordx4 v[20:23], v0, s[12:15], s45 offen nt
    s_add_u32 s46, s34, 0x0
    buffer_load_dwordx2 v[24:25], v1, s[16:19], s46 offen nt
    s_add_u32 s47, s34, 0x2000
    buffer_load_dwordx2 v[26:27], v1, s[16:19], s47 offen nt
    s_add_u32 s44, s33, 0x4000
    buffer_load_dwordx4 v[28:31], v0, s[8:11], s44 offen nt
    s_add_u32 s45, s33, 0x4000
    buffer_load_dwordx4 v[32:35], v0, s[12:15], s45 offen nt
    s_add_u32 s46, s33, 0x8000
    buffer_load_dwordx4 v[36:39], v0, s[8:11], s46 offen nt
    s_add_u32 s47, s33, 0x8000
    buffer_load_dwordx4 v[40:43], v0, s[12:15], s47 offen nt
    s_add_u32 s44, s34, 0x4000
    buffer_load_dwordx2 v[44:45], v1, s[16:19], s44 offen nt
    s_add_u32 s45, s34, 0x6000
    buffer_load_dwordx2 v[46:47], v1, s[16:19], s45 offen nt
    s_add_u32 s46, s33, 0xc000
    buffer_load_dwordx4 v[48:51], v0, s[8:11], s46 offen nt
    s_add_u32 s47, s33, 0xc000
    buffer_load_dwordx4 v[52:55], v0, s[12:15], s47 offen nt
    s_add_u32 s44, s33, 0x10000
    buffer_load_dwordx4 v[56:59], v0, s[8:11], s44 offen nt
    s_add_u32 s45, s33, 0x10000
    buffer_load_dwordx4 v[60:63], v0, s[12:15], s45 offen nt
    s_add_u32 s46, s34, 0x8000
    buffer_load_dwordx2 v[64:65], v1, s[16:19], s46 offen nt
    s_add_u32 s47, s34, 0xa000
    buffer_load_dwordx2 v[66:67], v1, s[16:19], s47 offen nt
    s_add_u32 s44, s33, 0x14000
    buffer_load_dwordx4 v[68:71], v0, s[8:11], s44 offen nt
    s_add_u32 s45, s33, 0x14000
    buffer_load_dwordx4 v[72:75], v0, s[12:15], s45 offen nt
    s_add_u32 s46, s33, 0x18000
    buffer_load_dwordx4 v[76:79], v0, s[8:11], s46 offen nt
    s_add_u32 s47, s33, 0x18000
    buffer_load_dwordx4 v[80:83], v0, s[12:15], s47 offen nt
    s_add_u32 s44, s34, 0xc000
    buffer_load_dwordx2 v[84:85], v1, s[16:19], s44 offen nt
    s_add_u32 s45, s34, 0xe000
    buffer_load_dwordx2 v[86:87], v1, s[16:19], s45 offen nt
    s_add_u32 s46, s33, 0x1c000
    buffer_load_dwordx4 v[88:91], v0, s[8:11], s46 offen nt
    s_add_u32 s47, s33, 0x1c000
    buffer_load_dwordx4 v[92:95], v0, s[12:15], s47 offen nt
    s_add_u32 s44, s33, 0x1f40000
    buffer_load_dwordx4 v[96:99], v0, s[8:11], s44 offen nt
    s_add_u32 s45, s33, 0x1f40000
    buffer_load_dwordx4 v[100:103], v0, s[12:15], s45 offen nt
    s_add_u32 s46, s34, 0xfa0000
    buffer_load_dwordx2 v[104:105], v1, s[16:19], s46 offen nt
    s_add_u32 s47, s34, 0xfa2000
    buffer_load_dwordx2 v[106:107], v1, s[16:19], s47 offen nt
    s_add_u32 s44, s33, 0x1f44000
    buffer_load_dwordx4 v[108:111], v0, s[8:11], s44 offen nt
    s_add_u32 s45, s33, 0x1f44000
    buffer_load_dwordx4 v[112:115], v0, s[12:15], s45 offen nt
    s_add_u32 s46, s33, 0x1f48000
    buffer_load_dwordx4 v[116:119], v0, s[8:11], s46 offen nt
    s_add_u32 s47, s33, 0x1f48000
    buffer_load_dwordx4 v[120:123], v0, s[12:15], s47 offen nt
    s_add_u32 s44, s34, 0xfa4000
    buffer_load_dwordx2 v[124:125], v1, s[16:19], s44 offen nt
    s_add_u32 s45, s34, 0xfa6000
    buffer_load_dwordx2 v[126:127], v1, s[16:19], s45 offen nt
    v_mov_b32 v2, 1
    v_mov_b32 v3, 0x1ffff
    v_mov_b32 v4, 0x80000007
    v_mov_b32 v5, 0xfc
    v_mov_b32 v6, 0x78
    s_mov_b32 s40, 0x10000000
    s_mov_b32 s41, 0x010c0c01
    s_mov_b32 s42, 0x030c0c03
    v_mov_b32 v8, 0
    v_mov_b32 v9, 0
    v_mov_b32 v10, 0
    v_mov_b32 v11, 0
    ds_write_b128 v0, v[8:11]
    s_waitcnt lgkmcnt(0)
    s_barrier
    s_waitcnt vmcnt(30)
    v_lshlrev_b32 v7, 16, v24
    v_and_b32 v8, 0xffff0000, v24
    v_lshlrev_b32 v9, 16, v25
    v_and_b32 v10, 0xffff0000, v25
    v_mul_f32 v7, 0.15915494, v7
    v_mul_f32 v8, 0.15915494, v8
    v_mul_f32 v9, 0.15915494, v9
    v_mul_f32 v10, 0.15915494, v10
    v_cos_f32 v7, v7
    v_lshl_add_u32 v11, v16, 11, s40
    v_lshrrev_b32 v12, 3, v20
    v_lshlrev_b16 v13, 3, v20
    v_bitop3_b32 v12, v6, v13, v12 bitop3:0xca
    v_bitop3_b32 v16, v3, v12, v11 bitop3:0xca
    v_lshrrev_b32 v11, 3, v11
    v_lshrrev_b32 v13, 2, v20
    v_bitop3_b32 v11, v5, v13, v11 bitop3:0xca
    v_and_b32 v20, 0x3fff, v11
    ds_add_u32 v20, v2
    v_cos_f32 v8, v8
    v_lshl_add_u32 v11, v17, 11, s40
    v_lshrrev_b32 v12, 3, v21
    v_lshlrev_b16 v13, 3, v21
    v_bitop3_b32 v12, v6, v13, v12 bitop3:0xca
    v_bitop3_b32 v17, v3, v12, v11 bitop3:0xca
    v_lshrrev_b32 v11, 3, v11
    v_lshrrev_b32 v13, 2, v21
    v_bitop3_b32 v11, v5, v13, v11 bitop3:0xca
    v_and_b32 v21, 0x3fff, v11
    ds_add_u32 v21, v2
    v_cvt_pk_bf16_f32 v24, v7, v8
    v_perm_b32 v12, v24, v24, s41
    v_bitop3_b32 v16, v4, v12, v16 bitop3:0xca
    v_perm_b32 v13, v24, v24, s42
    v_bitop3_b32 v17, v4, v13, v17 bitop3:0xca
    v_cos_f32 v9, v9
    v_lshl_add_u32 v11, v18, 11, s40
    v_lshrrev_b32 v12, 3, v22
    v_lshlrev_b16 v13, 3, v22
    v_bitop3_b32 v12, v6, v13, v12 bitop3:0xca
    v_bitop3_b32 v18, v3, v12, v11 bitop3:0xca
    v_lshrrev_b32 v11, 3, v11
    v_lshrrev_b32 v13, 2, v22
    v_bitop3_b32 v11, v5, v13, v11 bitop3:0xca
    v_and_b32 v22, 0x3fff, v11
    ds_add_u32 v22, v2
    v_cos_f32 v10, v10
    v_lshl_add_u32 v11, v19, 11, s40
    v_lshrrev_b32 v12, 3, v23
    v_lshlrev_b16 v13, 3, v23
    v_bitop3_b32 v12, v6, v13, v12 bitop3:0xca
    v_bitop3_b32 v19, v3, v12, v11 bitop3:0xca
    v_lshrrev_b32 v11, 3, v11
    v_lshrrev_b32 v13, 2, v23
    v_bitop3_b32 v11, v5, v13, v11 bitop3:0xca
    v_and_b32 v23, 0x3fff, v11
    ds_add_u32 v23, v2
    v_cvt_pk_bf16_f32 v25, v9, v10
    v_perm_b32 v12, v25, v25, s41
    v_bitop3_b32 v18, v4, v12, v18 bitop3:0xca
    v_perm_b32 v13, v25, v25, s42
    v_bitop3_b32 v19, v4, v13, v19 bitop3:0xca
    s_waitcnt vmcnt(28)
    v_lshlrev_b32 v7, 16, v26
    v_and_b32 v8, 0xffff0000, v26
    v_lshlrev_b32 v9, 16, v27
    v_and_b32 v10, 0xffff0000, v27
    v_mul_f32 v7, 0.15915494, v7
    v_mul_f32 v8, 0.15915494, v8
    v_mul_f32 v9, 0.15915494, v9
    v_mul_f32 v10, 0.15915494, v10
    v_cos_f32 v7, v7
    v_lshl_add_u32 v11, v28, 11, s40
    v_lshrrev_b32 v12, 3, v32
    v_lshlrev_b16 v13, 3, v32
    v_bitop3_b32 v12, v6, v13, v12 bitop3:0xca
    v_bitop3_b32 v28, v3, v12, v11 bitop3:0xca
    v_lshrrev_b32 v11, 3, v11
    v_lshrrev_b32 v13, 2, v32
    v_bitop3_b32 v11, v5, v13, v11 bitop3:0xca
    v_and_b32 v32, 0x3fff, v11
    ds_add_u32 v32, v2
    v_cos_f32 v8, v8
    v_lshl_add_u32 v11, v29, 11, s40
    v_lshrrev_b32 v12, 3, v33
    v_lshlrev_b16 v13, 3, v33
    v_bitop3_b32 v12, v6, v13, v12 bitop3:0xca
    v_bitop3_b32 v29, v3, v12, v11 bitop3:0xca
    v_lshrrev_b32 v11, 3, v11
    v_lshrrev_b32 v13, 2, v33
    v_bitop3_b32 v11, v5, v13, v11 bitop3:0xca
    v_and_b32 v33, 0x3fff, v11
    ds_add_u32 v33, v2
    v_cvt_pk_bf16_f32 v26, v7, v8
    v_perm_b32 v12, v26, v26, s41
    v_bitop3_b32 v28, v4, v12, v28 bitop3:0xca
    v_perm_b32 v13, v26, v26, s42
    v_bitop3_b32 v29, v4, v13, v29 bitop3:0xca
    v_cos_f32 v9, v9
    v_lshl_add_u32 v11, v30, 11, s40
    v_lshrrev_b32 v12, 3, v34
    v_lshlrev_b16 v13, 3, v34
    v_bitop3_b32 v12, v6, v13, v12 bitop3:0xca
    v_bitop3_b32 v30, v3, v12, v11 bitop3:0xca
    v_lshrrev_b32 v11, 3, v11
    v_lshrrev_b32 v13, 2, v34
    v_bitop3_b32 v11, v5, v13, v11 bitop3:0xca
    v_and_b32 v34, 0x3fff, v11
    ds_add_u32 v34, v2
    v_cos_f32 v10, v10
    v_lshl_add_u32 v11, v31, 11, s40
    v_lshrrev_b32 v12, 3, v35
    v_lshlrev_b16 v13, 3, v35
    v_bitop3_b32 v12, v6, v13, v12 bitop3:0xca
    v_bitop3_b32 v31, v3, v12, v11 bitop3:0xca
    v_lshrrev_b32 v11, 3, v11
    v_lshrrev_b32 v13, 2, v35
    v_bitop3_b32 v11, v5, v13, v11 bitop3:0xca
    v_and_b32 v35, 0x3fff, v11
    ds_add_u32 v35, v2
    v_cvt_pk_bf16_f32 v27, v9, v10
    v_perm_b32 v12, v27, v27, s41
    v_bitop3_b32 v30, v4, v12, v30 bitop3:0xca
    v_perm_b32 v13, v27, v27, s42
    v_bitop3_b32 v31, v4, v13, v31 bitop3:0xca
    s_waitcnt vmcnt(24)
    v_lshlrev_b32 v7, 16, v44
    v_and_b32 v8, 0xffff0000, v44
    v_lshlrev_b32 v9, 16, v45
    v_and_b32 v10, 0xffff0000, v45
    v_mul_f32 v7, 0.15915494, v7
    v_mul_f32 v8, 0.15915494, v8
    v_mul_f32 v9, 0.15915494, v9
    v_mul_f32 v10, 0.15915494, v10
    v_cos_f32 v7, v7
    v_lshl_add_u32 v11, v36, 11, s40
    v_lshrrev_b32 v12, 3, v40
    v_lshlrev_b16 v13, 3, v40
    v_bitop3_b32 v12, v6, v13, v12 bitop3:0xca
    v_bitop3_b32 v36, v3, v12, v11 bitop3:0xca
    v_lshrrev_b32 v11, 3, v11
    v_lshrrev_b32 v13, 2, v40
    v_bitop3_b32 v11, v5, v13, v11 bitop3:0xca
    v_and_b32 v40, 0x3fff, v11
    ds_add_u32 v40, v2
    v_cos_f32 v8, v8
    v_lshl_add_u32 v11, v37, 11, s40
    v_lshrrev_b32 v12, 3, v41
    v_lshlrev_b16 v13, 3, v41
    v_bitop3_b32 v12, v6, v13, v12 bitop3:0xca
    v_bitop3_b32 v37, v3, v12, v11 bitop3:0xca
    v_lshrrev_b32 v11, 3, v11
    v_lshrrev_b32 v13, 2, v41
    v_bitop3_b32 v11, v5, v13, v11 bitop3:0xca
    v_and_b32 v41, 0x3fff, v11
    ds_add_u32 v41, v2
    v_cvt_pk_bf16_f32 v44, v7, v8
    v_perm_b32 v12, v44, v44, s41
    v_bitop3_b32 v36, v4, v12, v36 bitop3:0xca
    v_perm_b32 v13, v44, v44, s42
    v_bitop3_b32 v37, v4, v13, v37 bitop3:0xca
    v_cos_f32 v9, v9
    v_lshl_add_u32 v11, v38, 11, s40
    v_lshrrev_b32 v12, 3, v42
    v_lshlrev_b16 v13, 3, v42
    v_bitop3_b32 v12, v6, v13, v12 bitop3:0xca
    v_bitop3_b32 v38, v3, v12, v11 bitop3:0xca
    v_lshrrev_b32 v11, 3, v11
    v_lshrrev_b32 v13, 2, v42
    v_bitop3_b32 v11, v5, v13, v11 bitop3:0xca
    v_and_b32 v42, 0x3fff, v11
    ds_add_u32 v42, v2
    v_cos_f32 v10, v10
    v_lshl_add_u32 v11, v39, 11, s40
    v_lshrrev_b32 v12, 3, v43
    v_lshlrev_b16 v13, 3, v43
    v_bitop3_b32 v12, v6, v13, v12 bitop3:0xca
    v_bitop3_b32 v39, v3, v12, v11 bitop3:0xca
    v_lshrrev_b32 v11, 3, v11
    v_lshrrev_b32 v13, 2, v43
    v_bitop3_b32 v11, v5, v13, v11 bitop3:0xca
    v_and_b32 v43, 0x3fff, v11
    ds_add_u32 v43, v2
    v_cvt_pk_bf16_f32 v45, v9, v10
    v_perm_b32 v12, v45, v45, s41
    v_bitop3_b32 v38, v4, v12, v38 bitop3:0xca
    v_perm_b32 v13, v45, v45, s42
    v_bitop3_b32 v39, v4, v13, v39 bitop3:0xca
    s_waitcnt vmcnt(22)
    v_lshlrev_b32 v7, 16, v46
    v_and_b32 v8, 0xffff0000, v46
    v_lshlrev_b32 v9, 16, v47
    v_and_b32 v10, 0xffff0000, v47
    v_mul_f32 v7, 0.15915494, v7
    v_mul_f32 v8, 0.15915494, v8
    v_mul_f32 v9, 0.15915494, v9
    v_mul_f32 v10, 0.15915494, v10
    v_cos_f32 v7, v7
    v_lshl_add_u32 v11, v48, 11, s40
    v_lshrrev_b32 v12, 3, v52
    v_lshlrev_b16 v13, 3, v52
    v_bitop3_b32 v12, v6, v13, v12 bitop3:0xca
    v_bitop3_b32 v48, v3, v12, v11 bitop3:0xca
    v_lshrrev_b32 v11, 3, v11
    v_lshrrev_b32 v13, 2, v52
    v_bitop3_b32 v11, v5, v13, v11 bitop3:0xca
    v_and_b32 v52, 0x3fff, v11
    ds_add_u32 v52, v2
    v_cos_f32 v8, v8
    v_lshl_add_u32 v11, v49, 11, s40
    v_lshrrev_b32 v12, 3, v53
    v_lshlrev_b16 v13, 3, v53
    v_bitop3_b32 v12, v6, v13, v12 bitop3:0xca
    v_bitop3_b32 v49, v3, v12, v11 bitop3:0xca
    v_lshrrev_b32 v11, 3, v11
    v_lshrrev_b32 v13, 2, v53
    v_bitop3_b32 v11, v5, v13, v11 bitop3:0xca
    v_and_b32 v53, 0x3fff, v11
    ds_add_u32 v53, v2
    v_cvt_pk_bf16_f32 v46, v7, v8
    v_perm_b32 v12, v46, v46, s41
    v_bitop3_b32 v48, v4, v12, v48 bitop3:0xca
    v_perm_b32 v13, v46, v46, s42
    v_bitop3_b32 v49, v4, v13, v49 bitop3:0xca
    v_cos_f32 v9, v9
    v_lshl_add_u32 v11, v50, 11, s40
    v_lshrrev_b32 v12, 3, v54
    v_lshlrev_b16 v13, 3, v54
    v_bitop3_b32 v12, v6, v13, v12 bitop3:0xca
    v_bitop3_b32 v50, v3, v12, v11 bitop3:0xca
    v_lshrrev_b32 v11, 3, v11
    v_lshrrev_b32 v13, 2, v54
    v_bitop3_b32 v11, v5, v13, v11 bitop3:0xca
    v_and_b32 v54, 0x3fff, v11
    ds_add_u32 v54, v2
    v_cos_f32 v10, v10
    v_lshl_add_u32 v11, v51, 11, s40
    v_lshrrev_b32 v12, 3, v55
    v_lshlrev_b16 v13, 3, v55
    v_bitop3_b32 v12, v6, v13, v12 bitop3:0xca
    v_bitop3_b32 v51, v3, v12, v11 bitop3:0xca
    v_lshrrev_b32 v11, 3, v11
    v_lshrrev_b32 v13, 2, v55
    v_bitop3_b32 v11, v5, v13, v11 bitop3:0xca
    v_and_b32 v55, 0x3fff, v11
    ds_add_u32 v55, v2
    v_cvt_pk_bf16_f32 v47, v9, v10
    v_perm_b32 v12, v47, v47, s41
    v_bitop3_b32 v50, v4, v12, v50 bitop3:0xca
    v_perm_b32 v13, v47, v47, s42
    v_bitop3_b32 v51, v4, v13, v51 bitop3:0xca
    s_waitcnt vmcnt(18)
    v_lshlrev_b32 v7, 16, v64
    v_and_b32 v8, 0xffff0000, v64
    v_lshlrev_b32 v9, 16, v65
    v_and_b32 v10, 0xffff0000, v65
    v_mul_f32 v7, 0.15915494, v7
    v_mul_f32 v8, 0.15915494, v8
    v_mul_f32 v9, 0.15915494, v9
    v_mul_f32 v10, 0.15915494, v10
    v_cos_f32 v7, v7
    v_lshl_add_u32 v11, v56, 11, s40
    v_lshrrev_b32 v12, 3, v60
    v_lshlrev_b16 v13, 3, v60
    v_bitop3_b32 v12, v6, v13, v12 bitop3:0xca
    v_bitop3_b32 v56, v3, v12, v11 bitop3:0xca
    v_lshrrev_b32 v11, 3, v11
    v_lshrrev_b32 v13, 2, v60
    v_bitop3_b32 v11, v5, v13, v11 bitop3:0xca
    v_and_b32 v60, 0x3fff, v11
    ds_add_u32 v60, v2
    v_cos_f32 v8, v8
    v_lshl_add_u32 v11, v57, 11, s40
    v_lshrrev_b32 v12, 3, v61
    v_lshlrev_b16 v13, 3, v61
    v_bitop3_b32 v12, v6, v13, v12 bitop3:0xca
    v_bitop3_b32 v57, v3, v12, v11 bitop3:0xca
    v_lshrrev_b32 v11, 3, v11
    v_lshrrev_b32 v13, 2, v61
    v_bitop3_b32 v11, v5, v13, v11 bitop3:0xca
    v_and_b32 v61, 0x3fff, v11
    ds_add_u32 v61, v2
    v_cvt_pk_bf16_f32 v64, v7, v8
    v_perm_b32 v12, v64, v64, s41
    v_bitop3_b32 v56, v4, v12, v56 bitop3:0xca
    v_perm_b32 v13, v64, v64, s42
    v_bitop3_b32 v57, v4, v13, v57 bitop3:0xca
    v_cos_f32 v9, v9
    v_lshl_add_u32 v11, v58, 11, s40
    v_lshrrev_b32 v12, 3, v62
    v_lshlrev_b16 v13, 3, v62
    v_bitop3_b32 v12, v6, v13, v12 bitop3:0xca
    v_bitop3_b32 v58, v3, v12, v11 bitop3:0xca
    v_lshrrev_b32 v11, 3, v11
    v_lshrrev_b32 v13, 2, v62
    v_bitop3_b32 v11, v5, v13, v11 bitop3:0xca
    v_and_b32 v62, 0x3fff, v11
    ds_add_u32 v62, v2
    v_cos_f32 v10, v10
    v_lshl_add_u32 v11, v59, 11, s40
    v_lshrrev_b32 v12, 3, v63
    v_lshlrev_b16 v13, 3, v63
    v_bitop3_b32 v12, v6, v13, v12 bitop3:0xca
    v_bitop3_b32 v59, v3, v12, v11 bitop3:0xca
    v_lshrrev_b32 v11, 3, v11
    v_lshrrev_b32 v13, 2, v63
    v_bitop3_b32 v11, v5, v13, v11 bitop3:0xca
    v_and_b32 v63, 0x3fff, v11
    ds_add_u32 v63, v2
    v_cvt_pk_bf16_f32 v65, v9, v10
    v_perm_b32 v12, v65, v65, s41
    v_bitop3_b32 v58, v4, v12, v58 bitop3:0xca
    v_perm_b32 v13, v65, v65, s42
    v_bitop3_b32 v59, v4, v13, v59 bitop3:0xca
    s_waitcnt vmcnt(16)
    v_lshlrev_b32 v7, 16, v66
    v_and_b32 v8, 0xffff0000, v66
    v_lshlrev_b32 v9, 16, v67
    v_and_b32 v10, 0xffff0000, v67
    v_mul_f32 v7, 0.15915494, v7
    v_mul_f32 v8, 0.15915494, v8
    v_mul_f32 v9, 0.15915494, v9
    v_mul_f32 v10, 0.15915494, v10
    v_cos_f32 v7, v7
    v_lshl_add_u32 v11, v68, 11, s40
    v_lshrrev_b32 v12, 3, v72
    v_lshlrev_b16 v13, 3, v72
    v_bitop3_b32 v12, v6, v13, v12 bitop3:0xca
    v_bitop3_b32 v68, v3, v12, v11 bitop3:0xca
    v_lshrrev_b32 v11, 3, v11
    v_lshrrev_b32 v13, 2, v72
    v_bitop3_b32 v11, v5, v13, v11 bitop3:0xca
    v_and_b32 v72, 0x3fff, v11
    ds_add_u32 v72, v2
    v_cos_f32 v8, v8
    v_lshl_add_u32 v11, v69, 11, s40
    v_lshrrev_b32 v12, 3, v73
    v_lshlrev_b16 v13, 3, v73
    v_bitop3_b32 v12, v6, v13, v12 bitop3:0xca
    v_bitop3_b32 v69, v3, v12, v11 bitop3:0xca
    v_lshrrev_b32 v11, 3, v11
    v_lshrrev_b32 v13, 2, v73
    v_bitop3_b32 v11, v5, v13, v11 bitop3:0xca
    v_and_b32 v73, 0x3fff, v11
    ds_add_u32 v73, v2
    v_cvt_pk_bf16_f32 v66, v7, v8
    v_perm_b32 v12, v66, v66, s41
    v_bitop3_b32 v68, v4, v12, v68 bitop3:0xca
    v_perm_b32 v13, v66, v66, s42
    v_bitop3_b32 v69, v4, v13, v69 bitop3:0xca
    v_cos_f32 v9, v9
    v_lshl_add_u32 v11, v70, 11, s40
    v_lshrrev_b32 v12, 3, v74
    v_lshlrev_b16 v13, 3, v74
    v_bitop3_b32 v12, v6, v13, v12 bitop3:0xca
    v_bitop3_b32 v70, v3, v12, v11 bitop3:0xca
    v_lshrrev_b32 v11, 3, v11
    v_lshrrev_b32 v13, 2, v74
    v_bitop3_b32 v11, v5, v13, v11 bitop3:0xca
    v_and_b32 v74, 0x3fff, v11
    ds_add_u32 v74, v2
    v_cos_f32 v10, v10
    v_lshl_add_u32 v11, v71, 11, s40
    v_lshrrev_b32 v12, 3, v75
    v_lshlrev_b16 v13, 3, v75
    v_bitop3_b32 v12, v6, v13, v12 bitop3:0xca
    v_bitop3_b32 v71, v3, v12, v11 bitop3:0xca
    v_lshrrev_b32 v11, 3, v11
    v_lshrrev_b32 v13, 2, v75
    v_bitop3_b32 v11, v5, v13, v11 bitop3:0xca
    v_and_b32 v75, 0x3fff, v11
    ds_add_u32 v75, v2
    v_cvt_pk_bf16_f32 v67, v9, v10
    v_perm_b32 v12, v67, v67, s41
    v_bitop3_b32 v70, v4, v12, v70 bitop3:0xca
    v_perm_b32 v13, v67, v67, s42
    v_bitop3_b32 v71, v4, v13, v71 bitop3:0xca
    s_waitcnt vmcnt(12)
    v_lshlrev_b32 v7, 16, v84
    v_and_b32 v8, 0xffff0000, v84
    v_lshlrev_b32 v9, 16, v85
    v_and_b32 v10, 0xffff0000, v85
    v_mul_f32 v7, 0.15915494, v7
    v_mul_f32 v8, 0.15915494, v8
    v_mul_f32 v9, 0.15915494, v9
    v_mul_f32 v10, 0.15915494, v10
    v_cos_f32 v7, v7
    v_lshl_add_u32 v11, v76, 11, s40
    v_lshrrev_b32 v12, 3, v80
    v_lshlrev_b16 v13, 3, v80
    v_bitop3_b32 v12, v6, v13, v12 bitop3:0xca
    v_bitop3_b32 v76, v3, v12, v11 bitop3:0xca
    v_lshrrev_b32 v11, 3, v11
    v_lshrrev_b32 v13, 2, v80
    v_bitop3_b32 v11, v5, v13, v11 bitop3:0xca
    v_and_b32 v80, 0x3fff, v11
    ds_add_u32 v80, v2
    v_cos_f32 v8, v8
    v_lshl_add_u32 v11, v77, 11, s40
    v_lshrrev_b32 v12, 3, v81
    v_lshlrev_b16 v13, 3, v81
    v_bitop3_b32 v12, v6, v13, v12 bitop3:0xca
    v_bitop3_b32 v77, v3, v12, v11 bitop3:0xca
    v_lshrrev_b32 v11, 3, v11
    v_lshrrev_b32 v13, 2, v81
    v_bitop3_b32 v11, v5, v13, v11 bitop3:0xca
    v_and_b32 v81, 0x3fff, v11
    ds_add_u32 v81, v2
    v_cvt_pk_bf16_f32 v84, v7, v8
    v_perm_b32 v12, v84, v84, s41
    v_bitop3_b32 v76, v4, v12, v76 bitop3:0xca
    v_perm_b32 v13, v84, v84, s42
    v_bitop3_b32 v77, v4, v13, v77 bitop3:0xca
    v_cos_f32 v9, v9
    v_lshl_add_u32 v11, v78, 11, s40
    v_lshrrev_b32 v12, 3, v82
    v_lshlrev_b16 v13, 3, v82
    v_bitop3_b32 v12, v6, v13, v12 bitop3:0xca
    v_bitop3_b32 v78, v3, v12, v11 bitop3:0xca
    v_lshrrev_b32 v11, 3, v11
    v_lshrrev_b32 v13, 2, v82
    v_bitop3_b32 v11, v5, v13, v11 bitop3:0xca
    v_and_b32 v82, 0x3fff, v11
    ds_add_u32 v82, v2
    v_cos_f32 v10, v10
    v_lshl_add_u32 v11, v79, 11, s40
    v_lshrrev_b32 v12, 3, v83
    v_lshlrev_b16 v13, 3, v83
    v_bitop3_b32 v12, v6, v13, v12 bitop3:0xca
    v_bitop3_b32 v79, v3, v12, v11 bitop3:0xca
    v_lshrrev_b32 v11, 3, v11
    v_lshrrev_b32 v13, 2, v83
    v_bitop3_b32 v11, v5, v13, v11 bitop3:0xca
    v_and_b32 v83, 0x3fff, v11
    ds_add_u32 v83, v2
    v_cvt_pk_bf16_f32 v85, v9, v10
    v_perm_b32 v12, v85, v85, s41
    v_bitop3_b32 v78, v4, v12, v78 bitop3:0xca
    v_perm_b32 v13, v85, v85, s42
    v_bitop3_b32 v79, v4, v13, v79 bitop3:0xca
    s_waitcnt vmcnt(10)
    v_lshlrev_b32 v7, 16, v86
    v_and_b32 v8, 0xffff0000, v86
    v_lshlrev_b32 v9, 16, v87
    v_and_b32 v10, 0xffff0000, v87
    v_mul_f32 v7, 0.15915494, v7
    v_mul_f32 v8, 0.15915494, v8
    v_mul_f32 v9, 0.15915494, v9
    v_mul_f32 v10, 0.15915494, v10
    v_cos_f32 v7, v7
    v_lshl_add_u32 v11, v88, 11, s40
    v_lshrrev_b32 v12, 3, v92
    v_lshlrev_b16 v13, 3, v92
    v_bitop3_b32 v12, v6, v13, v12 bitop3:0xca
    v_bitop3_b32 v88, v3, v12, v11 bitop3:0xca
    v_lshrrev_b32 v11, 3, v11
    v_lshrrev_b32 v13, 2, v92
    v_bitop3_b32 v11, v5, v13, v11 bitop3:0xca
    v_and_b32 v92, 0x3fff, v11
    ds_add_u32 v92, v2
    v_cos_f32 v8, v8
    v_lshl_add_u32 v11, v89, 11, s40
    v_lshrrev_b32 v12, 3, v93
    v_lshlrev_b16 v13, 3, v93
    v_bitop3_b32 v12, v6, v13, v12 bitop3:0xca
    v_bitop3_b32 v89, v3, v12, v11 bitop3:0xca
    v_lshrrev_b32 v11, 3, v11
    v_lshrrev_b32 v13, 2, v93
    v_bitop3_b32 v11, v5, v13, v11 bitop3:0xca
    v_and_b32 v93, 0x3fff, v11
    ds_add_u32 v93, v2
    v_cvt_pk_bf16_f32 v86, v7, v8
    v_perm_b32 v12, v86, v86, s41
    v_bitop3_b32 v88, v4, v12, v88 bitop3:0xca
    v_perm_b32 v13, v86, v86, s42
    v_bitop3_b32 v89, v4, v13, v89 bitop3:0xca
    v_cos_f32 v9, v9
    v_lshl_add_u32 v11, v90, 11, s40
    v_lshrrev_b32 v12, 3, v94
    v_lshlrev_b16 v13, 3, v94
    v_bitop3_b32 v12, v6, v13, v12 bitop3:0xca
    v_bitop3_b32 v90, v3, v12, v11 bitop3:0xca
    v_lshrrev_b32 v11, 3, v11
    v_lshrrev_b32 v13, 2, v94
    v_bitop3_b32 v11, v5, v13, v11 bitop3:0xca
    v_and_b32 v94, 0x3fff, v11
    ds_add_u32 v94, v2
    v_cos_f32 v10, v10
    v_lshl_add_u32 v11, v91, 11, s40
    v_lshrrev_b32 v12, 3, v95
    v_lshlrev_b16 v13, 3, v95
    v_bitop3_b32 v12, v6, v13, v12 bitop3:0xca
    v_bitop3_b32 v91, v3, v12, v11 bitop3:0xca
    v_lshrrev_b32 v11, 3, v11
    v_lshrrev_b32 v13, 2, v95
    v_bitop3_b32 v11, v5, v13, v11 bitop3:0xca
    v_and_b32 v95, 0x3fff, v11
    ds_add_u32 v95, v2
    v_cvt_pk_bf16_f32 v87, v9, v10
    v_perm_b32 v12, v87, v87, s41
    v_bitop3_b32 v90, v4, v12, v90 bitop3:0xca
    v_perm_b32 v13, v87, v87, s42
    v_bitop3_b32 v91, v4, v13, v91 bitop3:0xca
    v_lshrrev_b32 v8, 2, v0
    v_and_b32 v7, 0x3c00, v0
    v_bitop3_b32 v7, v5, v8, v7 bitop3:0xea
    s_waitcnt lgkmcnt(0)
    s_barrier
    ds_read2st64_b32 v[8:9], v7 offset0:0 offset1:1
    ds_read2st64_b32 v[10:11], v7 offset0:2 offset1:3
    s_waitcnt lgkmcnt(0)
    v_lshl_or_b32 v12, v9, 16, v8
    v_lshl_or_b32 v13, v11, 16, v10
    v_mov_b32 v14, v12
    v_mov_b32 v15, v13
    s_nop 0
    v_add_u32_dpp v14, v14, v14 row_shr:1 row_mask:0xf bank_mask:0xf bound_ctrl:1
    v_add_u32_dpp v15, v15, v15 row_shr:1 row_mask:0xf bank_mask:0xf bound_ctrl:1
    s_nop 0
    v_add_u32_dpp v14, v14, v14 row_shr:2 row_mask:0xf bank_mask:0xf bound_ctrl:1
    v_add_u32_dpp v15, v15, v15 row_shr:2 row_mask:0xf bank_mask:0xf bound_ctrl:1
    s_nop 0
    v_add_u32_dpp v14, v14, v14 row_shr:4 row_mask:0xf bank_mask:0xf bound_ctrl:1
    v_add_u32_dpp v15, v15, v15 row_shr:4 row_mask:0xf bank_mask:0xf bound_ctrl:1
    s_nop 0
    v_add_u32_dpp v14, v14, v14 row_shr:8 row_mask:0xf bank_mask:0xf bound_ctrl:1
    v_add_u32_dpp v15, v15, v15 row_shr:8 row_mask:0xf bank_mask:0xf bound_ctrl:1
    s_nop 0
    v_add_u32_dpp v14, v14, v14 row_bcast:15 row_mask:0xa bank_mask:0xf
    v_add_u32_dpp v15, v15, v15 row_bcast:15 row_mask:0xa bank_mask:0xf
    s_nop 0
    v_add_u32_dpp v14, v14, v14 row_bcast:31 row_mask:0xc bank_mask:0xf
    v_add_u32_dpp v15, v15, v15 row_bcast:31 row_mask:0xc bank_mask:0xf
    v_readlane_b32 s48, v14, 63
    v_readlane_b32 s49, v15, 63
    s_lshl_b32 s54, s32, 2
    v_mov_b32 v8, s54
    s_and_b32 s50, s48, 0xffff
    s_lshr_b32 s51, s48, 16
    s_and_b32 s52, s49, 0xffff
    s_lshr_b32 s53, s49, 16
    s_add_u32 s51, s51, s50
    s_add_u32 s52, s52, s51
    s_add_u32 s53, s53, s52
    v_mov_b32 v9, s53
    s_mov_b64 exec, 1
    ds_write_b32 v8, v9 offset:16384
    s_mov_b64 exec, -1
    v_and_b32 v8, 60, v7
    s_waitcnt lgkmcnt(0)
    s_barrier
    ds_read_b32 v9, v8 offset:16384
    s_waitcnt lgkmcnt(0)
    v_add_u32_dpp v9, v9, v9 row_shr:1 row_mask:0xf bank_mask:0xf bound_ctrl:1
    s_nop 1
    v_add_u32_dpp v9, v9, v9 row_shr:2 row_mask:0xf bank_mask:0xf bound_ctrl:1
    s_nop 1
    v_add_u32_dpp v9, v9, v9 row_shr:4 row_mask:0xf bank_mask:0xf bound_ctrl:1
    s_nop 1
    v_add_u32_dpp v9, v9, v9 row_shr:8 row_mask:0xf bank_mask:0xf bound_ctrl:1
    s_nop 0
    v_readlane_b32 s54, v9, s32
    s_sub_u32 s54, s54, s53
    s_add_u32 s50, s50, s54
    s_add_u32 s51, s51, s54
    s_add_u32 s52, s52, s54
    s_pack_ll_b32_b16 s48, s54, s50
    s_pack_ll_b32_b16 s49, s51, s52
    v_add_u32 v14, s48, v14
    v_add_u32 v15, s49, v15
    v_sub_u32 v12, v14, v12
    v_sub_u32 v13, v15, v13
    v_and_b32 v8, 0xffff, v12
    v_lshrrev_b32 v9, 16, v12
    v_and_b32 v10, 0xffff, v13
    v_lshrrev_b32 v11, 16, v13
    ds_write2st64_b32 v7, v8, v9 offset0:0 offset1:1
    ds_write2st64_b32 v7, v10, v11 offset0:2 offset1:3
    s_waitcnt lgkmcnt(0)
    s_barrier
    ds_add_rtn_u32 v20, v20, v2
    ds_add_rtn_u32 v21, v21, v2
    ds_add_rtn_u32 v22, v22, v2
    ds_add_rtn_u32 v23, v23, v2
    s_add_u32 s46, s36, 0x0
    buffer_store_dwordx2 v[12:13], v1, s[24:27], s46 offen
    s_bitset0_b64 exec, 63
    s_not_b64 exec, exec
    buffer_store_dwordx2 v[14:15], v1, s[24:27], s46 offen offset:8
    s_mov_b64 exec, -1
    ds_add_rtn_u32 v32, v32, v2
    ds_add_rtn_u32 v33, v33, v2
    ds_add_rtn_u32 v34, v34, v2
    ds_add_rtn_u32 v35, v35, v2
    ds_add_rtn_u32 v40, v40, v2
    ds_add_rtn_u32 v41, v41, v2
    ds_add_rtn_u32 v42, v42, v2
    ds_add_rtn_u32 v43, v43, v2
    ds_add_rtn_u32 v52, v52, v2
    ds_add_rtn_u32 v53, v53, v2
    ds_add_rtn_u32 v54, v54, v2
    ds_add_rtn_u32 v55, v55, v2
    ds_add_rtn_u32 v60, v60, v2
    ds_add_rtn_u32 v61, v61, v2
    ds_add_rtn_u32 v62, v62, v2
    ds_add_rtn_u32 v63, v63, v2
    ds_add_rtn_u32 v72, v72, v2
    ds_add_rtn_u32 v73, v73, v2
    ds_add_rtn_u32 v74, v74, v2
    ds_add_rtn_u32 v75, v75, v2
    ds_add_rtn_u32 v80, v80, v2
    ds_add_rtn_u32 v81, v81, v2
    ds_add_rtn_u32 v82, v82, v2
    ds_add_rtn_u32 v83, v83, v2
    ds_add_rtn_u32 v92, v92, v2
    ds_add_rtn_u32 v93, v93, v2
    ds_add_rtn_u32 v94, v94, v2
    ds_add_rtn_u32 v95, v95, v2
    s_waitcnt lgkmcnt(0)
    s_barrier
    v_and_b32 v7, -4, v20
    v_lshl_add_u32 v8, v20, 2, v7
    ds_write_b32 v8, v16
    v_lshl_add_u32 v7, v7, 2, v20
    ds_write_b8 v7, v24 offset:16
    v_and_b32 v9, -4, v21
    v_lshl_add_u32 v10, v21, 2, v9
    ds_write_b32 v10, v17
    v_lshl_add_u32 v9, v9, 2, v21
    ds_write_b8_d16_hi v9, v24 offset:16
    v_and_b32 v7, -4, v22
    v_lshl_add_u32 v8, v22, 2, v7
    ds_write_b32 v8, v18
    v_lshl_add_u32 v7, v7, 2, v22
    ds_write_b8 v7, v25 offset:16
    v_and_b32 v9, -4, v23
    v_lshl_add_u32 v10, v23, 2, v9
    ds_write_b32 v10, v19
    v_lshl_add_u32 v9, v9, 2, v23
    ds_write_b8_d16_hi v9, v25 offset:16
    s_add_u32 s47, s33, 0x1f4c000
    buffer_load_dwordx4 v[16:19], v0, s[8:11], s47 offen nt
    s_add_u32 s44, s33, 0x1f4c000
    buffer_load_dwordx4 v[20:23], v0, s[12:15], s44 offen nt
    v_and_b32 v7, -4, v32
    v_lshl_add_u32 v8, v32, 2, v7
    ds_write_b32 v8, v28
    v_lshl_add_u32 v7, v7, 2, v32
    ds_write_b8 v7, v26 offset:16
    v_and_b32 v9, -4, v33
    v_lshl_add_u32 v10, v33, 2, v9
    ds_write_b32 v10, v29
    v_lshl_add_u32 v9, v9, 2, v33
    ds_write_b8_d16_hi v9, v26 offset:16
    v_and_b32 v7, -4, v34
    v_lshl_add_u32 v8, v34, 2, v7
    ds_write_b32 v8, v30
    v_lshl_add_u32 v7, v7, 2, v34
    ds_write_b8 v7, v27 offset:16
    v_and_b32 v9, -4, v35
    v_lshl_add_u32 v10, v35, 2, v9
    ds_write_b32 v10, v31
    v_lshl_add_u32 v9, v9, 2, v35
    ds_write_b8_d16_hi v9, v27 offset:16
    s_add_u32 s45, s33, 0x1f50000
    buffer_load_dwordx4 v[28:31], v0, s[8:11], s45 offen nt
    v_and_b32 v7, -4, v40
    v_lshl_add_u32 v8, v40, 2, v7
    ds_write_b32 v8, v36
    v_lshl_add_u32 v7, v7, 2, v40
    ds_write_b8 v7, v44 offset:16
    v_and_b32 v9, -4, v41
    v_lshl_add_u32 v10, v41, 2, v9
    ds_write_b32 v10, v37
    v_lshl_add_u32 v9, v9, 2, v41
    ds_write_b8_d16_hi v9, v44 offset:16
    v_and_b32 v7, -4, v42
    v_lshl_add_u32 v8, v42, 2, v7
    ds_write_b32 v8, v38
    v_lshl_add_u32 v7, v7, 2, v42
    ds_write_b8 v7, v45 offset:16
    v_and_b32 v9, -4, v43
    v_lshl_add_u32 v10, v43, 2, v9
    ds_write_b32 v10, v39
    v_lshl_add_u32 v9, v9, 2, v43
    ds_write_b8_d16_hi v9, v45 offset:16
    s_add_u32 s46, s33, 0x1f50000
    buffer_load_dwordx4 v[32:35], v0, s[12:15], s46 offen nt
    v_and_b32 v7, -4, v52
    v_lshl_add_u32 v8, v52, 2, v7
    ds_write_b32 v8, v48
    v_lshl_add_u32 v7, v7, 2, v52
    ds_write_b8 v7, v46 offset:16
    v_and_b32 v9, -4, v53
    v_lshl_add_u32 v10, v53, 2, v9
    ds_write_b32 v10, v49
    v_lshl_add_u32 v9, v9, 2, v53
    ds_write_b8_d16_hi v9, v46 offset:16
    v_and_b32 v7, -4, v54
    v_lshl_add_u32 v8, v54, 2, v7
    ds_write_b32 v8, v50
    v_lshl_add_u32 v7, v7, 2, v54
    ds_write_b8 v7, v47 offset:16
    v_and_b32 v9, -4, v55
    v_lshl_add_u32 v10, v55, 2, v9
    ds_write_b32 v10, v51
    v_lshl_add_u32 v9, v9, 2, v55
    ds_write_b8_d16_hi v9, v47 offset:16
    s_add_u32 s47, s34, 0xfa8000
    buffer_load_dwordx2 v[24:25], v1, s[16:19], s47 offen nt
    s_add_u32 s44, s34, 0xfaa000
    buffer_load_dwordx2 v[26:27], v1, s[16:19], s44 offen nt
    v_and_b32 v7, -4, v60
    v_lshl_add_u32 v8, v60, 2, v7
    ds_write_b32 v8, v56
    v_lshl_add_u32 v7, v7, 2, v60
    ds_write_b8 v7, v64 offset:16
    v_and_b32 v9, -4, v61
    v_lshl_add_u32 v10, v61, 2, v9
    ds_write_b32 v10, v57
    v_lshl_add_u32 v9, v9, 2, v61
    ds_write_b8_d16_hi v9, v64 offset:16
    v_and_b32 v7, -4, v62
    v_lshl_add_u32 v8, v62, 2, v7
    ds_write_b32 v8, v58
    v_lshl_add_u32 v7, v7, 2, v62
    ds_write_b8 v7, v65 offset:16
    v_and_b32 v9, -4, v63
    v_lshl_add_u32 v10, v63, 2, v9
    ds_write_b32 v10, v59
    v_lshl_add_u32 v9, v9, 2, v63
    ds_write_b8_d16_hi v9, v65 offset:16
    s_add_u32 s45, s33, 0x1f54000
    buffer_load_dwordx4 v[36:39], v0, s[8:11], s45 offen nt
    s_add_u32 s46, s33, 0x1f54000
    buffer_load_dwordx4 v[40:43], v0, s[12:15], s46 offen nt
    v_and_b32 v7, -4, v72
    v_lshl_add_u32 v8, v72, 2, v7
    ds_write_b32 v8, v68
    v_lshl_add_u32 v7, v7, 2, v72
    ds_write_b8 v7, v66 offset:16
    v_and_b32 v9, -4, v73
    v_lshl_add_u32 v10, v73, 2, v9
    ds_write_b32 v10, v69
    v_lshl_add_u32 v9, v9, 2, v73
    ds_write_b8_d16_hi v9, v66 offset:16
    v_and_b32 v7, -4, v74
    v_lshl_add_u32 v8, v74, 2, v7
    ds_write_b32 v8, v70
    v_lshl_add_u32 v7, v7, 2, v74
    ds_write_b8 v7, v67 offset:16
    v_and_b32 v9, -4, v75
    v_lshl_add_u32 v10, v75, 2, v9
    ds_write_b32 v10, v71
    v_lshl_add_u32 v9, v9, 2, v75
    ds_write_b8_d16_hi v9, v67 offset:16
    s_add_u32 s47, s33, 0x1f58000
    buffer_load_dwordx4 v[48:51], v0, s[8:11], s47 offen nt
    v_and_b32 v7, -4, v80
    v_lshl_add_u32 v8, v80, 2, v7
    ds_write_b32 v8, v76
    v_lshl_add_u32 v7, v7, 2, v80
    ds_write_b8 v7, v84 offset:16
    v_and_b32 v9, -4, v81
    v_lshl_add_u32 v10, v81, 2, v9
    ds_write_b32 v10, v77
    v_lshl_add_u32 v9, v9, 2, v81
    ds_write_b8_d16_hi v9, v84 offset:16
    v_and_b32 v7, -4, v82
    v_lshl_add_u32 v8, v82, 2, v7
    ds_write_b32 v8, v78
    v_lshl_add_u32 v7, v7, 2, v82
    ds_write_b8 v7, v85 offset:16
    v_and_b32 v9, -4, v83
    v_lshl_add_u32 v10, v83, 2, v9
    ds_write_b32 v10, v79
    v_lshl_add_u32 v9, v9, 2, v83
    ds_write_b8_d16_hi v9, v85 offset:16
    s_add_u32 s44, s33, 0x1f58000
    buffer_load_dwordx4 v[52:55], v0, s[12:15], s44 offen nt
    v_and_b32 v7, -4, v92
    v_lshl_add_u32 v8, v92, 2, v7
    ds_write_b32 v8, v88
    v_lshl_add_u32 v7, v7, 2, v92
    ds_write_b8 v7, v86 offset:16
    v_and_b32 v9, -4, v93
    v_lshl_add_u32 v10, v93, 2, v9
    ds_write_b32 v10, v89
    v_lshl_add_u32 v9, v9, 2, v93
    ds_write_b8_d16_hi v9, v86 offset:16
    v_and_b32 v7, -4, v94
    v_lshl_add_u32 v8, v94, 2, v7
    ds_write_b32 v8, v90
    v_lshl_add_u32 v7, v7, 2, v94
    ds_write_b8 v7, v87 offset:16
    v_and_b32 v9, -4, v95
    v_lshl_add_u32 v10, v95, 2, v9
    ds_write_b32 v10, v91
    v_lshl_add_u32 v9, v9, 2, v95
    ds_write_b8_d16_hi v9, v87 offset:16
    s_add_u32 s45, s34, 0xfac000
    buffer_load_dwordx2 v[44:45], v1, s[16:19], s45 offen nt
    s_add_u32 s46, s34, 0xfae000
    buffer_load_dwordx2 v[46:47], v1, s[16:19], s46 offen nt
    v_add_u32 v7, 0x10000, v0
    v_add_u32 v12, 0x20000, v0
    v_mov_b32 v8, 0
    v_mov_b32 v9, 0
    v_mov_b32 v10, 0
    v_mov_b32 v11, 0
    s_waitcnt lgkmcnt(0)
    s_barrier
    ds_read_b128 v[56:59], v0 offset:0
    ds_write_b128 v0, v[8:11]
    ds_read_b128 v[60:63], v0 offset:16384
    ds_read_b128 v[68:71], v0 offset:32768
    ds_read_b128 v[72:75], v0 offset:49152
    ds_read_b128 v[64:67], v7 offset:0
    ds_read_b128 v[76:79], v7 offset:16384
    ds_read_b128 v[80:83], v7 offset:32768
    ds_read_b128 v[88:91], v7 offset:49152
    ds_read_b128 v[92:95], v12 offset:0
    ds_read_b128 v[84:87], v12 offset:16384
    s_waitcnt lgkmcnt(0)
    s_barrier
    s_add_u32 s47, s35, 0x0
    buffer_store_dwordx4 v[56:59], v0, s[20:23], s47 offen sc1
    s_add_u32 s44, s35, 0x4000
    buffer_store_dwordx4 v[60:63], v0, s[20:23], s44 offen sc1
    s_add_u32 s45, s33, 0x1f5c000
    buffer_load_dwordx4 v[56:59], v0, s[8:11], s45 offen nt
    s_add_u32 s46, s33, 0x1f5c000
    buffer_load_dwordx4 v[60:63], v0, s[12:15], s46 offen nt
    s_add_u32 s47, s35, 0x8000
    buffer_store_dwordx4 v[68:71], v0, s[20:23], s47 offen sc1
    s_waitcnt vmcnt(25)
    v_lshlrev_b32 v7, 16, v104
    v_and_b32 v8, 0xffff0000, v104
    v_lshlrev_b32 v9, 16, v105
    v_and_b32 v10, 0xffff0000, v105
    v_mul_f32 v7, 0.15915494, v7
    v_mul_f32 v8, 0.15915494, v8
    v_mul_f32 v9, 0.15915494, v9
    v_mul_f32 v10, 0.15915494, v10
    v_cos_f32 v7, v7
    v_lshl_add_u32 v11, v96, 11, s40
    v_lshrrev_b32 v12, 3, v100
    v_lshlrev_b16 v13, 3, v100
    v_bitop3_b32 v12, v6, v13, v12 bitop3:0xca
    v_bitop3_b32 v96, v3, v12, v11 bitop3:0xca
    v_lshrrev_b32 v11, 3, v11
    v_lshrrev_b32 v13, 2, v100
    v_bitop3_b32 v11, v5, v13, v11 bitop3:0xca
    v_and_b32 v100, 0x3fff, v11
    ds_add_u32 v100, v2
    v_cos_f32 v8, v8
    v_lshl_add_u32 v11, v97, 11, s40
    v_lshrrev_b32 v12, 3, v101
    v_lshlrev_b16 v13, 3, v101
    v_bitop3_b32 v12, v6, v13, v12 bitop3:0xca
    v_bitop3_b32 v97, v3, v12, v11 bitop3:0xca
    v_lshrrev_b32 v11, 3, v11
    v_lshrrev_b32 v13, 2, v101
    v_bitop3_b32 v11, v5, v13, v11 bitop3:0xca
    v_and_b32 v101, 0x3fff, v11
    ds_add_u32 v101, v2
    v_cvt_pk_bf16_f32 v104, v7, v8
    v_perm_b32 v12, v104, v104, s41
    v_bitop3_b32 v96, v4, v12, v96 bitop3:0xca
    v_perm_b32 v13, v104, v104, s42
    v_bitop3_b32 v97, v4, v13, v97 bitop3:0xca
    v_cos_f32 v9, v9
    v_lshl_add_u32 v11, v98, 11, s40
    v_lshrrev_b32 v12, 3, v102
    v_lshlrev_b16 v13, 3, v102
    v_bitop3_b32 v12, v6, v13, v12 bitop3:0xca
    v_bitop3_b32 v98, v3, v12, v11 bitop3:0xca
    v_lshrrev_b32 v11, 3, v11
    v_lshrrev_b32 v13, 2, v102
    v_bitop3_b32 v11, v5, v13, v11 bitop3:0xca
    v_and_b32 v102, 0x3fff, v11
    ds_add_u32 v102, v2
    v_cos_f32 v10, v10
    v_lshl_add_u32 v11, v99, 11, s40
    v_lshrrev_b32 v12, 3, v103
    v_lshlrev_b16 v13, 3, v103
    v_bitop3_b32 v12, v6, v13, v12 bitop3:0xca
    v_bitop3_b32 v99, v3, v12, v11 bitop3:0xca
    v_lshrrev_b32 v11, 3, v11
    v_lshrrev_b32 v13, 2, v103
    v_bitop3_b32 v11, v5, v13, v11 bitop3:0xca
    v_and_b32 v103, 0x3fff, v11
    ds_add_u32 v103, v2
    v_cvt_pk_bf16_f32 v105, v9, v10
    v_perm_b32 v12, v105, v105, s41
    v_bitop3_b32 v98, v4, v12, v98 bitop3:0xca
    v_perm_b32 v13, v105, v105, s42
    v_bitop3_b32 v99, v4, v13, v99 bitop3:0xca
    s_add_u32 s44, s35, 0xc000
    buffer_store_dwordx4 v[72:75], v0, s[20:23], s44 offen sc1
    s_waitcnt vmcnt(24)
    v_lshlrev_b32 v7, 16, v106
    v_and_b32 v8, 0xffff0000, v106
    v_lshlrev_b32 v9, 16, v107
    v_and_b32 v10, 0xffff0000, v107
    v_mul_f32 v7, 0.15915494, v7
    v_mul_f32 v8, 0.15915494, v8
    v_mul_f32 v9, 0.15915494, v9
    v_mul_f32 v10, 0.15915494, v10
    v_cos_f32 v7, v7
    v_lshl_add_u32 v11, v108, 11, s40
    v_lshrrev_b32 v12, 3, v112
    v_lshlrev_b16 v13, 3, v112
    v_bitop3_b32 v12, v6, v13, v12 bitop3:0xca
    v_bitop3_b32 v108, v3, v12, v11 bitop3:0xca
    v_lshrrev_b32 v11, 3, v11
    v_lshrrev_b32 v13, 2, v112
    v_bitop3_b32 v11, v5, v13, v11 bitop3:0xca
    v_and_b32 v112, 0x3fff, v11
    ds_add_u32 v112, v2
    v_cos_f32 v8, v8
    v_lshl_add_u32 v11, v109, 11, s40
    v_lshrrev_b32 v12, 3, v113
    v_lshlrev_b16 v13, 3, v113
    v_bitop3_b32 v12, v6, v13, v12 bitop3:0xca
    v_bitop3_b32 v109, v3, v12, v11 bitop3:0xca
    v_lshrrev_b32 v11, 3, v11
    v_lshrrev_b32 v13, 2, v113
    v_bitop3_b32 v11, v5, v13, v11 bitop3:0xca
    v_and_b32 v113, 0x3fff, v11
    ds_add_u32 v113, v2
    v_cvt_pk_bf16_f32 v106, v7, v8
    v_perm_b32 v12, v106, v106, s41
    v_bitop3_b32 v108, v4, v12, v108 bitop3:0xca
    v_perm_b32 v13, v106, v106, s42
    v_bitop3_b32 v109, v4, v13, v109 bitop3:0xca
    v_cos_f32 v9, v9
    v_lshl_add_u32 v11, v110, 11, s40
    v_lshrrev_b32 v12, 3, v114
    v_lshlrev_b16 v13, 3, v114
    v_bitop3_b32 v12, v6, v13, v12 bitop3:0xca
    v_bitop3_b32 v110, v3, v12, v11 bitop3:0xca
    v_lshrrev_b32 v11, 3, v11
    v_lshrrev_b32 v13, 2, v114
    v_bitop3_b32 v11, v5, v13, v11 bitop3:0xca
    v_and_b32 v114, 0x3fff, v11
    ds_add_u32 v114, v2
    v_cos_f32 v10, v10
    v_lshl_add_u32 v11, v111, 11, s40
    v_lshrrev_b32 v12, 3, v115
    v_lshlrev_b16 v13, 3, v115
    v_bitop3_b32 v12, v6, v13, v12 bitop3:0xca
    v_bitop3_b32 v111, v3, v12, v11 bitop3:0xca
    v_lshrrev_b32 v11, 3, v11
    v_lshrrev_b32 v13, 2, v115
    v_bitop3_b32 v11, v5, v13, v11 bitop3:0xca
    v_and_b32 v115, 0x3fff, v11
    ds_add_u32 v115, v2
    v_cvt_pk_bf16_f32 v107, v9, v10
    v_perm_b32 v12, v107, v107, s41
    v_bitop3_b32 v110, v4, v12, v110 bitop3:0xca
    v_perm_b32 v13, v107, v107, s42
    v_bitop3_b32 v111, v4, v13, v111 bitop3:0xca
    s_add_u32 s45, s35, 0x10000
    buffer_store_dwordx4 v[64:67], v0, s[20:23], s45 offen sc1
    s_waitcnt vmcnt(21)
    v_lshlrev_b32 v7, 16, v124
    v_and_b32 v8, 0xffff0000, v124
    v_lshlrev_b32 v9, 16, v125
    v_and_b32 v10, 0xffff0000, v125
    v_mul_f32 v7, 0.15915494, v7
    v_mul_f32 v8, 0.15915494, v8
    v_mul_f32 v9, 0.15915494, v9
    v_mul_f32 v10, 0.15915494, v10
    v_cos_f32 v7, v7
    v_lshl_add_u32 v11, v116, 11, s40
    v_lshrrev_b32 v12, 3, v120
    v_lshlrev_b16 v13, 3, v120
    v_bitop3_b32 v12, v6, v13, v12 bitop3:0xca
    v_bitop3_b32 v116, v3, v12, v11 bitop3:0xca
    v_lshrrev_b32 v11, 3, v11
    v_lshrrev_b32 v13, 2, v120
    v_bitop3_b32 v11, v5, v13, v11 bitop3:0xca
    v_and_b32 v120, 0x3fff, v11
    ds_add_u32 v120, v2
    v_cos_f32 v8, v8
    v_lshl_add_u32 v11, v117, 11, s40
    v_lshrrev_b32 v12, 3, v121
    v_lshlrev_b16 v13, 3, v121
    v_bitop3_b32 v12, v6, v13, v12 bitop3:0xca
    v_bitop3_b32 v117, v3, v12, v11 bitop3:0xca
    v_lshrrev_b32 v11, 3, v11
    v_lshrrev_b32 v13, 2, v121
    v_bitop3_b32 v11, v5, v13, v11 bitop3:0xca
    v_and_b32 v121, 0x3fff, v11
    ds_add_u32 v121, v2
    v_cvt_pk_bf16_f32 v124, v7, v8
    v_perm_b32 v12, v124, v124, s41
    v_bitop3_b32 v116, v4, v12, v116 bitop3:0xca
    v_perm_b32 v13, v124, v124, s42
    v_bitop3_b32 v117, v4, v13, v117 bitop3:0xca
    v_cos_f32 v9, v9
    v_lshl_add_u32 v11, v118, 11, s40
    v_lshrrev_b32 v12, 3, v122
    v_lshlrev_b16 v13, 3, v122
    v_bitop3_b32 v12, v6, v13, v12 bitop3:0xca
    v_bitop3_b32 v118, v3, v12, v11 bitop3:0xca
    v_lshrrev_b32 v11, 3, v11
    v_lshrrev_b32 v13, 2, v122
    v_bitop3_b32 v11, v5, v13, v11 bitop3:0xca
    v_and_b32 v122, 0x3fff, v11
    ds_add_u32 v122, v2
    v_cos_f32 v10, v10
    v_lshl_add_u32 v11, v119, 11, s40
    v_lshrrev_b32 v12, 3, v123
    v_lshlrev_b16 v13, 3, v123
    v_bitop3_b32 v12, v6, v13, v12 bitop3:0xca
    v_bitop3_b32 v119, v3, v12, v11 bitop3:0xca
    v_lshrrev_b32 v11, 3, v11
    v_lshrrev_b32 v13, 2, v123
    v_bitop3_b32 v11, v5, v13, v11 bitop3:0xca
    v_and_b32 v123, 0x3fff, v11
    ds_add_u32 v123, v2
    v_cvt_pk_bf16_f32 v125, v9, v10
    v_perm_b32 v12, v125, v125, s41
    v_bitop3_b32 v118, v4, v12, v118 bitop3:0xca
    v_perm_b32 v13, v125, v125, s42
    v_bitop3_b32 v119, v4, v13, v119 bitop3:0xca
    s_add_u32 s46, s35, 0x14000
    buffer_store_dwordx4 v[76:79], v0, s[20:23], s46 offen sc1
    s_waitcnt vmcnt(18)
    v_lshlrev_b32 v7, 16, v126
    v_and_b32 v8, 0xffff0000, v126
    v_lshlrev_b32 v9, 16, v127
    v_and_b32 v10, 0xffff0000, v127
    v_mul_f32 v7, 0.15915494, v7
    v_mul_f32 v8, 0.15915494, v8
    v_mul_f32 v9, 0.15915494, v9
    v_mul_f32 v10, 0.15915494, v10
    v_cos_f32 v7, v7
    v_lshl_add_u32 v11, v16, 11, s40
    v_lshrrev_b32 v12, 3, v20
    v_lshlrev_b16 v13, 3, v20
    v_bitop3_b32 v12, v6, v13, v12 bitop3:0xca
    v_bitop3_b32 v16, v3, v12, v11 bitop3:0xca
    v_lshrrev_b32 v11, 3, v11
    v_lshrrev_b32 v13, 2, v20
    v_bitop3_b32 v11, v5, v13, v11 bitop3:0xca
    v_and_b32 v20, 0x3fff, v11
    ds_add_u32 v20, v2
    v_cos_f32 v8, v8
    v_lshl_add_u32 v11, v17, 11, s40
    v_lshrrev_b32 v12, 3, v21
    v_lshlrev_b16 v13, 3, v21
    v_bitop3_b32 v12, v6, v13, v12 bitop3:0xca
    v_bitop3_b32 v17, v3, v12, v11 bitop3:0xca
    v_lshrrev_b32 v11, 3, v11
    v_lshrrev_b32 v13, 2, v21
    v_bitop3_b32 v11, v5, v13, v11 bitop3:0xca
    v_and_b32 v21, 0x3fff, v11
    ds_add_u32 v21, v2
    v_cvt_pk_bf16_f32 v126, v7, v8
    v_perm_b32 v12, v126, v126, s41
    v_bitop3_b32 v16, v4, v12, v16 bitop3:0xca
    v_perm_b32 v13, v126, v126, s42
    v_bitop3_b32 v17, v4, v13, v17 bitop3:0xca
    v_cos_f32 v9, v9
    v_lshl_add_u32 v11, v18, 11, s40
    v_lshrrev_b32 v12, 3, v22
    v_lshlrev_b16 v13, 3, v22
    v_bitop3_b32 v12, v6, v13, v12 bitop3:0xca
    v_bitop3_b32 v18, v3, v12, v11 bitop3:0xca
    v_lshrrev_b32 v11, 3, v11
    v_lshrrev_b32 v13, 2, v22
    v_bitop3_b32 v11, v5, v13, v11 bitop3:0xca
    v_and_b32 v22, 0x3fff, v11
    ds_add_u32 v22, v2
    v_cos_f32 v10, v10
    v_lshl_add_u32 v11, v19, 11, s40
    v_lshrrev_b32 v12, 3, v23
    v_lshlrev_b16 v13, 3, v23
    v_bitop3_b32 v12, v6, v13, v12 bitop3:0xca
    v_bitop3_b32 v19, v3, v12, v11 bitop3:0xca
    v_lshrrev_b32 v11, 3, v11
    v_lshrrev_b32 v13, 2, v23
    v_bitop3_b32 v11, v5, v13, v11 bitop3:0xca
    v_and_b32 v23, 0x3fff, v11
    ds_add_u32 v23, v2
    v_cvt_pk_bf16_f32 v127, v9, v10
    v_perm_b32 v12, v127, v127, s41
    v_bitop3_b32 v18, v4, v12, v18 bitop3:0xca
    v_perm_b32 v13, v127, v127, s42
    v_bitop3_b32 v19, v4, v13, v19 bitop3:0xca
    s_add_u32 s47, s35, 0x18000
    buffer_store_dwordx4 v[80:83], v0, s[20:23], s47 offen sc1
    s_waitcnt vmcnt(15)
    v_lshlrev_b32 v7, 16, v24
    v_and_b32 v8, 0xffff0000, v24
    v_lshlrev_b32 v9, 16, v25
    v_and_b32 v10, 0xffff0000, v25
    v_mul_f32 v7, 0.15915494, v7
    v_mul_f32 v8, 0.15915494, v8
    v_mul_f32 v9, 0.15915494, v9
    v_mul_f32 v10, 0.15915494, v10
    v_cos_f32 v7, v7
    v_lshl_add_u32 v11, v28, 11, s40
    v_lshrrev_b32 v12, 3, v32
    v_lshlrev_b16 v13, 3, v32
    v_bitop3_b32 v12, v6, v13, v12 bitop3:0xca
    v_bitop3_b32 v28, v3, v12, v11 bitop3:0xca
    v_lshrrev_b32 v11, 3, v11
    v_lshrrev_b32 v13, 2, v32
    v_bitop3_b32 v11, v5, v13, v11 bitop3:0xca
    v_and_b32 v32, 0x3fff, v11
    ds_add_u32 v32, v2
    v_cos_f32 v8, v8
    v_lshl_add_u32 v11, v29, 11, s40
    v_lshrrev_b32 v12, 3, v33
    v_lshlrev_b16 v13, 3, v33
    v_bitop3_b32 v12, v6, v13, v12 bitop3:0xca
    v_bitop3_b32 v29, v3, v12, v11 bitop3:0xca
    v_lshrrev_b32 v11, 3, v11
    v_lshrrev_b32 v13, 2, v33
    v_bitop3_b32 v11, v5, v13, v11 bitop3:0xca
    v_and_b32 v33, 0x3fff, v11
    ds_add_u32 v33, v2
    v_cvt_pk_bf16_f32 v24, v7, v8
    v_perm_b32 v12, v24, v24, s41
    v_bitop3_b32 v28, v4, v12, v28 bitop3:0xca
    v_perm_b32 v13, v24, v24, s42
    v_bitop3_b32 v29, v4, v13, v29 bitop3:0xca
    v_cos_f32 v9, v9
    v_lshl_add_u32 v11, v30, 11, s40
    v_lshrrev_b32 v12, 3, v34
    v_lshlrev_b16 v13, 3, v34
    v_bitop3_b32 v12, v6, v13, v12 bitop3:0xca
    v_bitop3_b32 v30, v3, v12, v11 bitop3:0xca
    v_lshrrev_b32 v11, 3, v11
    v_lshrrev_b32 v13, 2, v34
    v_bitop3_b32 v11, v5, v13, v11 bitop3:0xca
    v_and_b32 v34, 0x3fff, v11
    ds_add_u32 v34, v2
    v_cos_f32 v10, v10
    v_lshl_add_u32 v11, v31, 11, s40
    v_lshrrev_b32 v12, 3, v35
    v_lshlrev_b16 v13, 3, v35
    v_bitop3_b32 v12, v6, v13, v12 bitop3:0xca
    v_bitop3_b32 v31, v3, v12, v11 bitop3:0xca
    v_lshrrev_b32 v11, 3, v11
    v_lshrrev_b32 v13, 2, v35
    v_bitop3_b32 v11, v5, v13, v11 bitop3:0xca
    v_and_b32 v35, 0x3fff, v11
    ds_add_u32 v35, v2
    v_cvt_pk_bf16_f32 v25, v9, v10
    v_perm_b32 v12, v25, v25, s41
    v_bitop3_b32 v30, v4, v12, v30 bitop3:0xca
    v_perm_b32 v13, v25, v25, s42
    v_bitop3_b32 v31, v4, v13, v31 bitop3:0xca
    s_add_u32 s44, s35, 0x1c000
    buffer_store_dwordx4 v[88:91], v0, s[20:23], s44 offen sc1
    s_waitcnt vmcnt(14)
    v_lshlrev_b32 v7, 16, v26
    v_and_b32 v8, 0xffff0000, v26
    v_lshlrev_b32 v9, 16, v27
    v_and_b32 v10, 0xffff0000, v27
    v_mul_f32 v7, 0.15915494, v7
    v_mul_f32 v8, 0.15915494, v8
    v_mul_f32 v9, 0.15915494, v9
    v_mul_f32 v10, 0.15915494, v10
    v_cos_f32 v7, v7
    v_lshl_add_u32 v11, v36, 11, s40
    v_lshrrev_b32 v12, 3, v40
    v_lshlrev_b16 v13, 3, v40
    v_bitop3_b32 v12, v6, v13, v12 bitop3:0xca
    v_bitop3_b32 v36, v3, v12, v11 bitop3:0xca
    v_lshrrev_b32 v11, 3, v11
    v_lshrrev_b32 v13, 2, v40
    v_bitop3_b32 v11, v5, v13, v11 bitop3:0xca
    v_and_b32 v40, 0x3fff, v11
    ds_add_u32 v40, v2
    v_cos_f32 v8, v8
    v_lshl_add_u32 v11, v37, 11, s40
    v_lshrrev_b32 v12, 3, v41
    v_lshlrev_b16 v13, 3, v41
    v_bitop3_b32 v12, v6, v13, v12 bitop3:0xca
    v_bitop3_b32 v37, v3, v12, v11 bitop3:0xca
    v_lshrrev_b32 v11, 3, v11
    v_lshrrev_b32 v13, 2, v41
    v_bitop3_b32 v11, v5, v13, v11 bitop3:0xca
    v_and_b32 v41, 0x3fff, v11
    ds_add_u32 v41, v2
    v_cvt_pk_bf16_f32 v26, v7, v8
    v_perm_b32 v12, v26, v26, s41
    v_bitop3_b32 v36, v4, v12, v36 bitop3:0xca
    v_perm_b32 v13, v26, v26, s42
    v_bitop3_b32 v37, v4, v13, v37 bitop3:0xca
    v_cos_f32 v9, v9
    v_lshl_add_u32 v11, v38, 11, s40
    v_lshrrev_b32 v12, 3, v42
    v_lshlrev_b16 v13, 3, v42
    v_bitop3_b32 v12, v6, v13, v12 bitop3:0xca
    v_bitop3_b32 v38, v3, v12, v11 bitop3:0xca
    v_lshrrev_b32 v11, 3, v11
    v_lshrrev_b32 v13, 2, v42
    v_bitop3_b32 v11, v5, v13, v11 bitop3:0xca
    v_and_b32 v42, 0x3fff, v11
    ds_add_u32 v42, v2
    v_cos_f32 v10, v10
    v_lshl_add_u32 v11, v39, 11, s40
    v_lshrrev_b32 v12, 3, v43
    v_lshlrev_b16 v13, 3, v43
    v_bitop3_b32 v12, v6, v13, v12 bitop3:0xca
    v_bitop3_b32 v39, v3, v12, v11 bitop3:0xca
    v_lshrrev_b32 v11, 3, v11
    v_lshrrev_b32 v13, 2, v43
    v_bitop3_b32 v11, v5, v13, v11 bitop3:0xca
    v_and_b32 v43, 0x3fff, v11
    ds_add_u32 v43, v2
    v_cvt_pk_bf16_f32 v27, v9, v10
    v_perm_b32 v12, v27, v27, s41
    v_bitop3_b32 v38, v4, v12, v38 bitop3:0xca
    v_perm_b32 v13, v27, v27, s42
    v_bitop3_b32 v39, v4, v13, v39 bitop3:0xca
    s_add_u32 s45, s35, 0x20000
    buffer_store_dwordx4 v[92:95], v0, s[20:23], s45 offen sc1
    s_waitcnt vmcnt(11)
    v_lshlrev_b32 v7, 16, v44
    v_and_b32 v8, 0xffff0000, v44
    v_lshlrev_b32 v9, 16, v45
    v_and_b32 v10, 0xffff0000, v45
    v_mul_f32 v7, 0.15915494, v7
    v_mul_f32 v8, 0.15915494, v8
    v_mul_f32 v9, 0.15915494, v9
    v_mul_f32 v10, 0.15915494, v10
    v_cos_f32 v7, v7
    v_lshl_add_u32 v11, v48, 11, s40
    v_lshrrev_b32 v12, 3, v52
    v_lshlrev_b16 v13, 3, v52
    v_bitop3_b32 v12, v6, v13, v12 bitop3:0xca
    v_bitop3_b32 v48, v3, v12, v11 bitop3:0xca
    v_lshrrev_b32 v11, 3, v11
    v_lshrrev_b32 v13, 2, v52
    v_bitop3_b32 v11, v5, v13, v11 bitop3:0xca
    v_and_b32 v52, 0x3fff, v11
    ds_add_u32 v52, v2
    v_cos_f32 v8, v8
    v_lshl_add_u32 v11, v49, 11, s40
    v_lshrrev_b32 v12, 3, v53
    v_lshlrev_b16 v13, 3, v53
    v_bitop3_b32 v12, v6, v13, v12 bitop3:0xca
    v_bitop3_b32 v49, v3, v12, v11 bitop3:0xca
    v_lshrrev_b32 v11, 3, v11
    v_lshrrev_b32 v13, 2, v53
    v_bitop3_b32 v11, v5, v13, v11 bitop3:0xca
    v_and_b32 v53, 0x3fff, v11
    ds_add_u32 v53, v2
    v_cvt_pk_bf16_f32 v44, v7, v8
    v_perm_b32 v12, v44, v44, s41
    v_bitop3_b32 v48, v4, v12, v48 bitop3:0xca
    v_perm_b32 v13, v44, v44, s42
    v_bitop3_b32 v49, v4, v13, v49 bitop3:0xca
    v_cos_f32 v9, v9
    v_lshl_add_u32 v11, v50, 11, s40
    v_lshrrev_b32 v12, 3, v54
    v_lshlrev_b16 v13, 3, v54
    v_bitop3_b32 v12, v6, v13, v12 bitop3:0xca
    v_bitop3_b32 v50, v3, v12, v11 bitop3:0xca
    v_lshrrev_b32 v11, 3, v11
    v_lshrrev_b32 v13, 2, v54
    v_bitop3_b32 v11, v5, v13, v11 bitop3:0xca
    v_and_b32 v54, 0x3fff, v11
    ds_add_u32 v54, v2
    v_cos_f32 v10, v10
    v_lshl_add_u32 v11, v51, 11, s40
    v_lshrrev_b32 v12, 3, v55
    v_lshlrev_b16 v13, 3, v55
    v_bitop3_b32 v12, v6, v13, v12 bitop3:0xca
    v_bitop3_b32 v51, v3, v12, v11 bitop3:0xca
    v_lshrrev_b32 v11, 3, v11
    v_lshrrev_b32 v13, 2, v55
    v_bitop3_b32 v11, v5, v13, v11 bitop3:0xca
    v_and_b32 v55, 0x3fff, v11
    ds_add_u32 v55, v2
    v_cvt_pk_bf16_f32 v45, v9, v10
    v_perm_b32 v12, v45, v45, s41
    v_bitop3_b32 v50, v4, v12, v50 bitop3:0xca
    v_perm_b32 v13, v45, v45, s42
    v_bitop3_b32 v51, v4, v13, v51 bitop3:0xca
    s_add_u32 s46, s35, 0x24000
    buffer_store_dwordx4 v[84:87], v0, s[20:23], s46 offen sc1
    s_waitcnt vmcnt(8)
    v_lshlrev_b32 v7, 16, v46
    v_and_b32 v8, 0xffff0000, v46
    v_lshlrev_b32 v9, 16, v47
    v_and_b32 v10, 0xffff0000, v47
    v_mul_f32 v7, 0.15915494, v7
    v_mul_f32 v8, 0.15915494, v8
    v_mul_f32 v9, 0.15915494, v9
    v_mul_f32 v10, 0.15915494, v10
    v_cos_f32 v7, v7
    v_lshl_add_u32 v11, v56, 11, s40
    v_lshrrev_b32 v12, 3, v60
    v_lshlrev_b16 v13, 3, v60
    v_bitop3_b32 v12, v6, v13, v12 bitop3:0xca
    v_bitop3_b32 v56, v3, v12, v11 bitop3:0xca
    v_lshrrev_b32 v11, 3, v11
    v_lshrrev_b32 v13, 2, v60
    v_bitop3_b32 v11, v5, v13, v11 bitop3:0xca
    v_and_b32 v60, 0x3fff, v11
    ds_add_u32 v60, v2
    v_cos_f32 v8, v8
    v_lshl_add_u32 v11, v57, 11, s40
    v_lshrrev_b32 v12, 3, v61
    v_lshlrev_b16 v13, 3, v61
    v_bitop3_b32 v12, v6, v13, v12 bitop3:0xca
    v_bitop3_b32 v57, v3, v12, v11 bitop3:0xca
    v_lshrrev_b32 v11, 3, v11
    v_lshrrev_b32 v13, 2, v61
    v_bitop3_b32 v11, v5, v13, v11 bitop3:0xca
    v_and_b32 v61, 0x3fff, v11
    ds_add_u32 v61, v2
    v_cvt_pk_bf16_f32 v46, v7, v8
    v_perm_b32 v12, v46, v46, s41
    v_bitop3_b32 v56, v4, v12, v56 bitop3:0xca
    v_perm_b32 v13, v46, v46, s42
    v_bitop3_b32 v57, v4, v13, v57 bitop3:0xca
    v_cos_f32 v9, v9
    v_lshl_add_u32 v11, v58, 11, s40
    v_lshrrev_b32 v12, 3, v62
    v_lshlrev_b16 v13, 3, v62
    v_bitop3_b32 v12, v6, v13, v12 bitop3:0xca
    v_bitop3_b32 v58, v3, v12, v11 bitop3:0xca
    v_lshrrev_b32 v11, 3, v11
    v_lshrrev_b32 v13, 2, v62
    v_bitop3_b32 v11, v5, v13, v11 bitop3:0xca
    v_and_b32 v62, 0x3fff, v11
    ds_add_u32 v62, v2
    v_cos_f32 v10, v10
    v_lshl_add_u32 v11, v59, 11, s40
    v_lshrrev_b32 v12, 3, v63
    v_lshlrev_b16 v13, 3, v63
    v_bitop3_b32 v12, v6, v13, v12 bitop3:0xca
    v_bitop3_b32 v59, v3, v12, v11 bitop3:0xca
    v_lshrrev_b32 v11, 3, v11
    v_lshrrev_b32 v13, 2, v63
    v_bitop3_b32 v11, v5, v13, v11 bitop3:0xca
    v_and_b32 v63, 0x3fff, v11
    ds_add_u32 v63, v2
    v_cvt_pk_bf16_f32 v47, v9, v10
    v_perm_b32 v12, v47, v47, s41
    v_bitop3_b32 v58, v4, v12, v58 bitop3:0xca
    v_perm_b32 v13, v47, v47, s42
    v_bitop3_b32 v59, v4, v13, v59 bitop3:0xca
    v_lshrrev_b32 v8, 2, v0
    v_and_b32 v7, 0x3c00, v0
    v_bitop3_b32 v7, v5, v8, v7 bitop3:0xea
    s_waitcnt lgkmcnt(0)
    s_barrier
    ds_read2st64_b32 v[8:9], v7 offset0:0 offset1:1
    ds_read2st64_b32 v[10:11], v7 offset0:2 offset1:3
    s_add_u32 s47, s33, 0x3e80000
    buffer_load_dwordx4 v[68:71], v0, s[8:11], s47 offen nt
    s_waitcnt lgkmcnt(0)
    v_lshl_or_b32 v12, v9, 16, v8
    v_lshl_or_b32 v13, v11, 16, v10
    v_mov_b32 v14, v12
    v_mov_b32 v15, v13
    s_nop 0
    v_add_u32_dpp v14, v14, v14 row_shr:1 row_mask:0xf bank_mask:0xf bound_ctrl:1
    v_add_u32_dpp v15, v15, v15 row_shr:1 row_mask:0xf bank_mask:0xf bound_ctrl:1
    s_nop 0
    v_add_u32_dpp v14, v14, v14 row_shr:2 row_mask:0xf bank_mask:0xf bound_ctrl:1
    v_add_u32_dpp v15, v15, v15 row_shr:2 row_mask:0xf bank_mask:0xf bound_ctrl:1
    s_nop 0
    v_add_u32_dpp v14, v14, v14 row_shr:4 row_mask:0xf bank_mask:0xf bound_ctrl:1
    v_add_u32_dpp v15, v15, v15 row_shr:4 row_mask:0xf bank_mask:0xf bound_ctrl:1
    s_nop 0
    v_add_u32_dpp v14, v14, v14 row_shr:8 row_mask:0xf bank_mask:0xf bound_ctrl:1
    v_add_u32_dpp v15, v15, v15 row_shr:8 row_mask:0xf bank_mask:0xf bound_ctrl:1
    s_nop 0
    v_add_u32_dpp v14, v14, v14 row_bcast:15 row_mask:0xa bank_mask:0xf
    v_add_u32_dpp v15, v15, v15 row_bcast:15 row_mask:0xa bank_mask:0xf
    s_nop 0
    v_add_u32_dpp v14, v14, v14 row_bcast:31 row_mask:0xc bank_mask:0xf
    v_add_u32_dpp v15, v15, v15 row_bcast:31 row_mask:0xc bank_mask:0xf
    v_readlane_b32 s48, v14, 63
    v_readlane_b32 s49, v15, 63
    s_lshl_b32 s54, s32, 2
    v_mov_b32 v8, s54
    s_and_b32 s50, s48, 0xffff
    s_lshr_b32 s51, s48, 16
    s_and_b32 s52, s49, 0xffff
    s_lshr_b32 s53, s49, 16
    s_add_u32 s51, s51, s50
    s_add_u32 s52, s52, s51
    s_add_u32 s53, s53, s52
    v_mov_b32 v9, s53
    s_mov_b64 exec, 1
    ds_write_b32 v8, v9 offset:16384
    s_mov_b64 exec, -1
    v_and_b32 v8, 60, v7
    s_waitcnt lgkmcnt(0)
    s_barrier
    ds_read_b32 v9, v8 offset:16384
    s_waitcnt lgkmcnt(0)
    v_add_u32_dpp v9, v9, v9 row_shr:1 row_mask:0xf bank_mask:0xf bound_ctrl:1
    s_nop 1
    v_add_u32_dpp v9, v9, v9 row_shr:2 row_mask:0xf bank_mask:0xf bound_ctrl:1
    s_nop 1
    v_add_u32_dpp v9, v9, v9 row_shr:4 row_mask:0xf bank_mask:0xf bound_ctrl:1
    s_nop 1
    v_add_u32_dpp v9, v9, v9 row_shr:8 row_mask:0xf bank_mask:0xf bound_ctrl:1
    s_nop 0
    v_readlane_b32 s54, v9, s32
    s_sub_u32 s54, s54, s53
    s_add_u32 s50, s50, s54
    s_add_u32 s51, s51, s54
    s_add_u32 s52, s52, s54
    s_pack_ll_b32_b16 s48, s54, s50
    s_pack_ll_b32_b16 s49, s51, s52
    v_add_u32 v14, s48, v14
    v_add_u32 v15, s49, v15
    v_sub_u32 v12, v14, v12
    v_sub_u32 v13, v15, v13
    v_and_b32 v8, 0xffff, v12
    v_lshrrev_b32 v9, 16, v12
    v_and_b32 v10, 0xffff, v13
    v_lshrrev_b32 v11, 16, v13
    ds_write2st64_b32 v7, v8, v9 offset0:0 offset1:1
    ds_write2st64_b32 v7, v10, v11 offset0:2 offset1:3
    s_waitcnt lgkmcnt(0)
    s_barrier
    ds_add_rtn_u32 v100, v100, v2
    ds_add_rtn_u32 v101, v101, v2
    ds_add_rtn_u32 v102, v102, v2
    ds_add_rtn_u32 v103, v103, v2
    s_add_u32 s44, s36, 0x1fbd00
    buffer_store_dwordx2 v[12:13], v1, s[24:27], s44 offen
    s_bitset0_b64 exec, 63
    s_not_b64 exec, exec
    buffer_store_dwordx2 v[14:15], v1, s[24:27], s44 offen offset:8
    s_mov_b64 exec, -1
    ds_add_rtn_u32 v112, v112, v2
    ds_add_rtn_u32 v113, v113, v2
    ds_add_rtn_u32 v114, v114, v2
    ds_add_rtn_u32 v115, v115, v2
    s_add_u32 s45, s33, 0x3e80000
    buffer_load_dwordx4 v[72:75], v0, s[12:15], s45 offen nt
    ds_add_rtn_u32 v120, v120, v2
    ds_add_rtn_u32 v121, v121, v2
    ds_add_rtn_u32 v122, v122, v2
    ds_add_rtn_u32 v123, v123, v2
    s_add_u32 s46, s34, 0x1f40000
    buffer_load_dwordx2 v[64:65], v1, s[16:19], s46 offen nt
    s_add_u32 s47, s34, 0x1f42000
    buffer_load_dwordx2 v[66:67], v1, s[16:19], s47 offen nt
    ds_add_rtn_u32 v20, v20, v2
    ds_add_rtn_u32 v21, v21, v2
    ds_add_rtn_u32 v22, v22, v2
    ds_add_rtn_u32 v23, v23, v2
    s_add_u32 s44, s33, 0x3e84000
    buffer_load_dwordx4 v[76:79], v0, s[8:11], s44 offen nt
    ds_add_rtn_u32 v32, v32, v2
    ds_add_rtn_u32 v33, v33, v2
    ds_add_rtn_u32 v34, v34, v2
    ds_add_rtn_u32 v35, v35, v2
    s_add_u32 s45, s33, 0x3e84000
    buffer_load_dwordx4 v[80:83], v0, s[12:15], s45 offen nt
    ds_add_rtn_u32 v40, v40, v2
    ds_add_rtn_u32 v41, v41, v2
    ds_add_rtn_u32 v42, v42, v2
    ds_add_rtn_u32 v43, v43, v2
    s_add_u32 s46, s33, 0x3e88000
    buffer_load_dwordx4 v[88:91], v0, s[8:11], s46 offen nt
    ds_add_rtn_u32 v52, v52, v2
    ds_add_rtn_u32 v53, v53, v2
    ds_add_rtn_u32 v54, v54, v2
    ds_add_rtn_u32 v55, v55, v2
    s_add_u32 s47, s33, 0x3e88000
    buffer_load_dwordx4 v[92:95], v0, s[12:15], s47 offen nt
    ds_add_rtn_u32 v60, v60, v2
    ds_add_rtn_u32 v61, v61, v2
    ds_add_rtn_u32 v62, v62, v2
    ds_add_rtn_u32 v63, v63, v2
    s_add_u32 s44, s34, 0x1f44000
    buffer_load_dwordx2 v[84:85], v1, s[16:19], s44 offen nt
    s_add_u32 s45, s34, 0x1f46000
    buffer_load_dwordx2 v[86:87], v1, s[16:19], s45 offen nt
    s_waitcnt lgkmcnt(0)
    s_barrier
    v_and_b32 v7, -4, v100
    v_lshl_add_u32 v8, v100, 2, v7
    ds_write_b32 v8, v96
    v_lshl_add_u32 v7, v7, 2, v100
    ds_write_b8 v7, v104 offset:16
    v_and_b32 v9, -4, v101
    v_lshl_add_u32 v10, v101, 2, v9
    ds_write_b32 v10, v97
    v_lshl_add_u32 v9, v9, 2, v101
    ds_write_b8_d16_hi v9, v104 offset:16
    v_and_b32 v7, -4, v102
    v_lshl_add_u32 v8, v102, 2, v7
    ds_write_b32 v8, v98
    v_lshl_add_u32 v7, v7, 2, v102
    ds_write_b8 v7, v105 offset:16
    v_and_b32 v9, -4, v103
    v_lshl_add_u32 v10, v103, 2, v9
    ds_write_b32 v10, v99
    v_lshl_add_u32 v9, v9, 2, v103
    ds_write_b8_d16_hi v9, v105 offset:16
    s_add_u32 s46, s33, 0x3e8c000
    buffer_load_dwordx4 v[96:99], v0, s[8:11], s46 offen nt
    s_add_u32 s47, s33, 0x3e8c000
    buffer_load_dwordx4 v[100:103], v0, s[12:15], s47 offen nt
    v_and_b32 v7, -4, v112
    v_lshl_add_u32 v8, v112, 2, v7
    ds_write_b32 v8, v108
    v_lshl_add_u32 v7, v7, 2, v112
    ds_write_b8 v7, v106 offset:16
    v_and_b32 v9, -4, v113
    v_lshl_add_u32 v10, v113, 2, v9
    ds_write_b32 v10, v109
    v_lshl_add_u32 v9, v9, 2, v113
    ds_write_b8_d16_hi v9, v106 offset:16
    v_and_b32 v7, -4, v114
    v_lshl_add_u32 v8, v114, 2, v7
    ds_write_b32 v8, v110
    v_lshl_add_u32 v7, v7, 2, v114
    ds_write_b8 v7, v107 offset:16
    v_and_b32 v9, -4, v115
    v_lshl_add_u32 v10, v115, 2, v9
    ds_write_b32 v10, v111
    v_lshl_add_u32 v9, v9, 2, v115
    ds_write_b8_d16_hi v9, v107 offset:16
    s_add_u32 s44, s33, 0x3e90000
    buffer_load_dwordx4 v[108:111], v0, s[8:11], s44 offen nt
    v_and_b32 v7, -4, v120
    v_lshl_add_u32 v8, v120, 2, v7
    ds_write_b32 v8, v116
    v_lshl_add_u32 v7, v7, 2, v120
    ds_write_b8 v7, v124 offset:16
    v_and_b32 v9, -4, v121
    v_lshl_add_u32 v10, v121, 2, v9
    ds_write_b32 v10, v117
    v_lshl_add_u32 v9, v9, 2, v121
    ds_write_b8_d16_hi v9, v124 offset:16
    v_and_b32 v7, -4, v122
    v_lshl_add_u32 v8, v122, 2, v7
    ds_write_b32 v8, v118
    v_lshl_add_u32 v7, v7, 2, v122
    ds_write_b8 v7, v125 offset:16
    v_and_b32 v9, -4, v123
    v_lshl_add_u32 v10, v123, 2, v9
    ds_write_b32 v10, v119
    v_lshl_add_u32 v9, v9, 2, v123
    ds_write_b8_d16_hi v9, v125 offset:16
    s_add_u32 s45, s33, 0x3e90000
    buffer_load_dwordx4 v[112:115], v0, s[12:15], s45 offen nt
    v_and_b32 v7, -4, v20
    v_lshl_add_u32 v8, v20, 2, v7
    ds_write_b32 v8, v16
    v_lshl_add_u32 v7, v7, 2, v20
    ds_write_b8 v7, v126 offset:16
    v_and_b32 v9, -4, v21
    v_lshl_add_u32 v10, v21, 2, v9
    ds_write_b32 v10, v17
    v_lshl_add_u32 v9, v9, 2, v21
    ds_write_b8_d16_hi v9, v126 offset:16
    v_and_b32 v7, -4, v22
    v_lshl_add_u32 v8, v22, 2, v7
    ds_write_b32 v8, v18
    v_lshl_add_u32 v7, v7, 2, v22
    ds_write_b8 v7, v127 offset:16
    v_and_b32 v9, -4, v23
    v_lshl_add_u32 v10, v23, 2, v9
    ds_write_b32 v10, v19
    v_lshl_add_u32 v9, v9, 2, v23
    ds_write_b8_d16_hi v9, v127 offset:16
    s_add_u32 s46, s34, 0x1f48000
    buffer_load_dwordx2 v[104:105], v1, s[16:19], s46 offen nt
    s_add_u32 s47, s34, 0x1f4a000
    buffer_load_dwordx2 v[106:107], v1, s[16:19], s47 offen nt
    v_and_b32 v7, -4, v32
    v_lshl_add_u32 v8, v32, 2, v7
    ds_write_b32 v8, v28
    v_lshl_add_u32 v7, v7, 2, v32
    ds_write_b8 v7, v24 offset:16
    v_and_b32 v9, -4, v33
    v_lshl_add_u32 v10, v33, 2, v9
    ds_write_b32 v10, v29
    v_lshl_add_u32 v9, v9, 2, v33
    ds_write_b8_d16_hi v9, v24 offset:16
    v_and_b32 v7, -4, v34
    v_lshl_add_u32 v8, v34, 2, v7
    ds_write_b32 v8, v30
    v_lshl_add_u32 v7, v7, 2, v34
    ds_write_b8 v7, v25 offset:16
    v_and_b32 v9, -4, v35
    v_lshl_add_u32 v10, v35, 2, v9
    ds_write_b32 v10, v31
    v_lshl_add_u32 v9, v9, 2, v35
    ds_write_b8_d16_hi v9, v25 offset:16
    s_add_u32 s44, s33, 0x3e94000
    buffer_load_dwordx4 v[116:119], v0, s[8:11], s44 offen nt
    s_add_u32 s45, s33, 0x3e94000
    buffer_load_dwordx4 v[120:123], v0, s[12:15], s45 offen nt
    v_and_b32 v7, -4, v40
    v_lshl_add_u32 v8, v40, 2, v7
    ds_write_b32 v8, v36
    v_lshl_add_u32 v7, v7, 2, v40
    ds_write_b8 v7, v26 offset:16
    v_and_b32 v9, -4, v41
    v_lshl_add_u32 v10, v41, 2, v9
    ds_write_b32 v10, v37
    v_lshl_add_u32 v9, v9, 2, v41
    ds_write_b8_d16_hi v9, v26 offset:16
    v_and_b32 v7, -4, v42
    v_lshl_add_u32 v8, v42, 2, v7
    ds_write_b32 v8, v38
    v_lshl_add_u32 v7, v7, 2, v42
    ds_write_b8 v7, v27 offset:16
    v_and_b32 v9, -4, v43
    v_lshl_add_u32 v10, v43, 2, v9
    ds_write_b32 v10, v39
    v_lshl_add_u32 v9, v9, 2, v43
    ds_write_b8_d16_hi v9, v27 offset:16
    s_add_u32 s46, s33, 0x3e98000
    buffer_load_dwordx4 v[16:19], v0, s[8:11], s46 offen nt
    v_and_b32 v7, -4, v52
    v_lshl_add_u32 v8, v52, 2, v7
    ds_write_b32 v8, v48
    v_lshl_add_u32 v7, v7, 2, v52
    ds_write_b8 v7, v44 offset:16
    v_and_b32 v9, -4, v53
    v_lshl_add_u32 v10, v53, 2, v9
    ds_write_b32 v10, v49
    v_lshl_add_u32 v9, v9, 2, v53
    ds_write_b8_d16_hi v9, v44 offset:16
    v_and_b32 v7, -4, v54
    v_lshl_add_u32 v8, v54, 2, v7
    ds_write_b32 v8, v50
    v_lshl_add_u32 v7, v7, 2, v54
    ds_write_b8 v7, v45 offset:16
    v_and_b32 v9, -4, v55
    v_lshl_add_u32 v10, v55, 2, v9
    ds_write_b32 v10, v51
    v_lshl_add_u32 v9, v9, 2, v55
    ds_write_b8_d16_hi v9, v45 offset:16
    s_add_u32 s47, s33, 0x3e98000
    buffer_load_dwordx4 v[20:23], v0, s[12:15], s47 offen nt
    v_and_b32 v7, -4, v60
    v_lshl_add_u32 v8, v60, 2, v7
    ds_write_b32 v8, v56
    v_lshl_add_u32 v7, v7, 2, v60
    ds_write_b8 v7, v46 offset:16
    v_and_b32 v9, -4, v61
    v_lshl_add_u32 v10, v61, 2, v9
    ds_write_b32 v10, v57
    v_lshl_add_u32 v9, v9, 2, v61
    ds_write_b8_d16_hi v9, v46 offset:16
    v_and_b32 v7, -4, v62
    v_lshl_add_u32 v8, v62, 2, v7
    ds_write_b32 v8, v58
    v_lshl_add_u32 v7, v7, 2, v62
    ds_write_b8 v7, v47 offset:16
    v_and_b32 v9, -4, v63
    v_lshl_add_u32 v10, v63, 2, v9
    ds_write_b32 v10, v59
    v_lshl_add_u32 v9, v9, 2, v63
    ds_write_b8_d16_hi v9, v47 offset:16
    s_add_u32 s44, s34, 0x1f4c000
    buffer_load_dwordx2 v[124:125], v1, s[16:19], s44 offen nt
    s_add_u32 s45, s34, 0x1f4e000
    buffer_load_dwordx2 v[126:127], v1, s[16:19], s45 offen nt
    v_add_u32 v7, 0x10000, v0
    v_add_u32 v12, 0x20000, v0
    v_mov_b32 v8, 0
    v_mov_b32 v9, 0
    v_mov_b32 v10, 0
    v_mov_b32 v11, 0
    s_waitcnt lgkmcnt(0)
    s_barrier
    ds_read_b128 v[28:31], v0 offset:0
    ds_write_b128 v0, v[8:11]
    ds_read_b128 v[32:35], v0 offset:16384
    ds_read_b128 v[36:39], v0 offset:32768
    ds_read_b128 v[40:43], v0 offset:49152
    ds_read_b128 v[24:27], v7 offset:0
    ds_read_b128 v[48:51], v7 offset:16384
    ds_read_b128 v[52:55], v7 offset:32768
    ds_read_b128 v[56:59], v7 offset:49152
    ds_read_b128 v[60:63], v12 offset:0
    ds_read_b128 v[44:47], v12 offset:16384
    s_waitcnt lgkmcnt(0)
    s_barrier
    s_add_u32 s46, s35, 0x2710000
    buffer_store_dwordx4 v[28:31], v0, s[20:23], s46 offen sc1
    s_add_u32 s47, s35, 0x2714000
    buffer_store_dwordx4 v[32:35], v0, s[20:23], s47 offen sc1
    s_add_u32 s44, s33, 0x3e9c000
    buffer_load_dwordx4 v[28:31], v0, s[8:11], s44 offen nt
    s_add_u32 s45, s33, 0x3e9c000
    buffer_load_dwordx4 v[32:35], v0, s[12:15], s45 offen nt
    s_add_u32 s46, s35, 0x2718000
    buffer_store_dwordx4 v[36:39], v0, s[20:23], s46 offen sc1
    s_waitcnt vmcnt(23)
    v_lshlrev_b32 v7, 16, v64
    v_and_b32 v8, 0xffff0000, v64
    v_lshlrev_b32 v9, 16, v65
    v_and_b32 v10, 0xffff0000, v65
    v_mul_f32 v7, 0.15915494, v7
    v_mul_f32 v8, 0.15915494, v8
    v_mul_f32 v9, 0.15915494, v9
    v_mul_f32 v10, 0.15915494, v10
    v_cos_f32 v7, v7
    v_lshl_add_u32 v11, v68, 11, s40
    v_lshrrev_b32 v12, 3, v72
    v_lshlrev_b16 v13, 3, v72
    v_bitop3_b32 v12, v6, v13, v12 bitop3:0xca
    v_bitop3_b32 v68, v3, v12, v11 bitop3:0xca
    v_lshrrev_b32 v11, 3, v11
    v_lshrrev_b32 v13, 2, v72
    v_bitop3_b32 v11, v5, v13, v11 bitop3:0xca
    v_and_b32 v72, 0x3fff, v11
    ds_add_u32 v72, v2
    v_cos_f32 v8, v8
    v_lshl_add_u32 v11, v69, 11, s40
    v_lshrrev_b32 v12, 3, v73
    v_lshlrev_b16 v13, 3, v73
    v_bitop3_b32 v12, v6, v13, v12 bitop3:0xca
    v_bitop3_b32 v69, v3, v12, v11 bitop3:0xca
    v_lshrrev_b32 v11, 3, v11
    v_lshrrev_b32 v13, 2, v73
    v_bitop3_b32 v11, v5, v13, v11 bitop3:0xca
    v_and_b32 v73, 0x3fff, v11
    ds_add_u32 v73, v2
    v_cvt_pk_bf16_f32 v64, v7, v8
    v_perm_b32 v12, v64, v64, s41
    v_bitop3_b32 v68, v4, v12, v68 bitop3:0xca
    v_perm_b32 v13, v64, v64, s42
    v_bitop3_b32 v69, v4, v13, v69 bitop3:0xca
    v_cos_f32 v9, v9
    v_lshl_add_u32 v11, v70, 11, s40
    v_lshrrev_b32 v12, 3, v74
    v_lshlrev_b16 v13, 3, v74
    v_bitop3_b32 v12, v6, v13, v12 bitop3:0xca
    v_bitop3_b32 v70, v3, v12, v11 bitop3:0xca
    v_lshrrev_b32 v11, 3, v11
    v_lshrrev_b32 v13, 2, v74
    v_bitop3_b32 v11, v5, v13, v11 bitop3:0xca
    v_and_b32 v74, 0x3fff, v11
    ds_add_u32 v74, v2
    v_cos_f32 v10, v10
    v_lshl_add_u32 v11, v71, 11, s40
    v_lshrrev_b32 v12, 3, v75
    v_lshlrev_b16 v13, 3, v75
    v_bitop3_b32 v12, v6, v13, v12 bitop3:0xca
    v_bitop3_b32 v71, v3, v12, v11 bitop3:0xca
    v_lshrrev_b32 v11, 3, v11
    v_lshrrev_b32 v13, 2, v75
    v_bitop3_b32 v11, v5, v13, v11 bitop3:0xca
    v_and_b32 v75, 0x3fff, v11
    ds_add_u32 v75, v2
    v_cvt_pk_bf16_f32 v65, v9, v10
    v_perm_b32 v12, v65, v65, s41
    v_bitop3_b32 v70, v4, v12, v70 bitop3:0xca
    v_perm_b32 v13, v65, v65, s42
    v_bitop3_b32 v71, v4, v13, v71 bitop3:0xca
    s_add_u32 s47, s35, 0x271c000
    buffer_store_dwordx4 v[40:43], v0, s[20:23], s47 offen sc1
    s_waitcnt vmcnt(22)
    v_lshlrev_b32 v7, 16, v66
    v_and_b32 v8, 0xffff0000, v66
    v_lshlrev_b32 v9, 16, v67
    v_and_b32 v10, 0xffff0000, v67
    v_mul_f32 v7, 0.15915494, v7
    v_mul_f32 v8, 0.15915494, v8
    v_mul_f32 v9, 0.15915494, v9
    v_mul_f32 v10, 0.15915494, v10
    v_cos_f32 v7, v7
    v_lshl_add_u32 v11, v76, 11, s40
    v_lshrrev_b32 v12, 3, v80
    v_lshlrev_b16 v13, 3, v80
    v_bitop3_b32 v12, v6, v13, v12 bitop3:0xca
    v_bitop3_b32 v76, v3, v12, v11 bitop3:0xca
    v_lshrrev_b32 v11, 3, v11
    v_lshrrev_b32 v13, 2, v80
    v_bitop3_b32 v11, v5, v13, v11 bitop3:0xca
    v_and_b32 v80, 0x3fff, v11
    ds_add_u32 v80, v2
    v_cos_f32 v8, v8
    v_lshl_add_u32 v11, v77, 11, s40
    v_lshrrev_b32 v12, 3, v81
    v_lshlrev_b16 v13, 3, v81
    v_bitop3_b32 v12, v6, v13, v12 bitop3:0xca
    v_bitop3_b32 v77, v3, v12, v11 bitop3:0xca
    v_lshrrev_b32 v11, 3, v11
    v_lshrrev_b32 v13, 2, v81
    v_bitop3_b32 v11, v5, v13, v11 bitop3:0xca
    v_and_b32 v81, 0x3fff, v11
    ds_add_u32 v81, v2
    v_cvt_pk_bf16_f32 v66, v7, v8
    v_perm_b32 v12, v66, v66, s41
    v_bitop3_b32 v76, v4, v12, v76 bitop3:0xca
    v_perm_b32 v13, v66, v66, s42
    v_bitop3_b32 v77, v4, v13, v77 bitop3:0xca
    v_cos_f32 v9, v9
    v_lshl_add_u32 v11, v78, 11, s40
    v_lshrrev_b32 v12, 3, v82
    v_lshlrev_b16 v13, 3, v82
    v_bitop3_b32 v12, v6, v13, v12 bitop3:0xca
    v_bitop3_b32 v78, v3, v12, v11 bitop3:0xca
    v_lshrrev_b32 v11, 3, v11
    v_lshrrev_b32 v13, 2, v82
    v_bitop3_b32 v11, v5, v13, v11 bitop3:0xca
    v_and_b32 v82, 0x3fff, v11
    ds_add_u32 v82, v2
    v_cos_f32 v10, v10
    v_lshl_add_u32 v11, v79, 11, s40
    v_lshrrev_b32 v12, 3, v83
    v_lshlrev_b16 v13, 3, v83
    v_bitop3_b32 v12, v6, v13, v12 bitop3:0xca
    v_bitop3_b32 v79, v3, v12, v11 bitop3:0xca
    v_lshrrev_b32 v11, 3, v11
    v_lshrrev_b32 v13, 2, v83
    v_bitop3_b32 v11, v5, v13, v11 bitop3:0xca
    v_and_b32 v83, 0x3fff, v11
    ds_add_u32 v83, v2
    v_cvt_pk_bf16_f32 v67, v9, v10
    v_perm_b32 v12, v67, v67, s41
    v_bitop3_b32 v78, v4, v12, v78 bitop3:0xca
    v_perm_b32 v13, v67, v67, s42
    v_bitop3_b32 v79, v4, v13, v79 bitop3:0xca
    s_add_u32 s44, s35, 0x2720000
    buffer_store_dwordx4 v[24:27], v0, s[20:23], s44 offen sc1
    s_waitcnt vmcnt(19)
    v_lshlrev_b32 v7, 16, v84
    v_and_b32 v8, 0xffff0000, v84
    v_lshlrev_b32 v9, 16, v85
    v_and_b32 v10, 0xffff0000, v85
    v_mul_f32 v7, 0.15915494, v7
    v_mul_f32 v8, 0.15915494, v8
    v_mul_f32 v9, 0.15915494, v9
    v_mul_f32 v10, 0.15915494, v10
    v_cos_f32 v7, v7
    v_lshl_add_u32 v11, v88, 11, s40
    v_lshrrev_b32 v12, 3, v92
    v_lshlrev_b16 v13, 3, v92
    v_bitop3_b32 v12, v6, v13, v12 bitop3:0xca
    v_bitop3_b32 v88, v3, v12, v11 bitop3:0xca
    v_lshrrev_b32 v11, 3, v11
    v_lshrrev_b32 v13, 2, v92
    v_bitop3_b32 v11, v5, v13, v11 bitop3:0xca
    v_and_b32 v92, 0x3fff, v11
    ds_add_u32 v92, v2
    v_cos_f32 v8, v8
    v_lshl_add_u32 v11, v89, 11, s40
    v_lshrrev_b32 v12, 3, v93
    v_lshlrev_b16 v13, 3, v93
    v_bitop3_b32 v12, v6, v13, v12 bitop3:0xca
    v_bitop3_b32 v89, v3, v12, v11 bitop3:0xca
    v_lshrrev_b32 v11, 3, v11
    v_lshrrev_b32 v13, 2, v93
    v_bitop3_b32 v11, v5, v13, v11 bitop3:0xca
    v_and_b32 v93, 0x3fff, v11
    ds_add_u32 v93, v2
    v_cvt_pk_bf16_f32 v84, v7, v8
    v_perm_b32 v12, v84, v84, s41
    v_bitop3_b32 v88, v4, v12, v88 bitop3:0xca
    v_perm_b32 v13, v84, v84, s42
    v_bitop3_b32 v89, v4, v13, v89 bitop3:0xca
    v_cos_f32 v9, v9
    v_lshl_add_u32 v11, v90, 11, s40
    v_lshrrev_b32 v12, 3, v94
    v_lshlrev_b16 v13, 3, v94
    v_bitop3_b32 v12, v6, v13, v12 bitop3:0xca
    v_bitop3_b32 v90, v3, v12, v11 bitop3:0xca
    v_lshrrev_b32 v11, 3, v11
    v_lshrrev_b32 v13, 2, v94
    v_bitop3_b32 v11, v5, v13, v11 bitop3:0xca
    v_and_b32 v94, 0x3fff, v11
    ds_add_u32 v94, v2
    v_cos_f32 v10, v10
    v_lshl_add_u32 v11, v91, 11, s40
    v_lshrrev_b32 v12, 3, v95
    v_lshlrev_b16 v13, 3, v95
    v_bitop3_b32 v12, v6, v13, v12 bitop3:0xca
    v_bitop3_b32 v91, v3, v12, v11 bitop3:0xca
    v_lshrrev_b32 v11, 3, v11
    v_lshrrev_b32 v13, 2, v95
    v_bitop3_b32 v11, v5, v13, v11 bitop3:0xca
    v_and_b32 v95, 0x3fff, v11
    ds_add_u32 v95, v2
    v_cvt_pk_bf16_f32 v85, v9, v10
    v_perm_b32 v12, v85, v85, s41
    v_bitop3_b32 v90, v4, v12, v90 bitop3:0xca
    v_perm_b32 v13, v85, v85, s42
    v_bitop3_b32 v91, v4, v13, v91 bitop3:0xca
    s_add_u32 s45, s35, 0x2724000
    buffer_store_dwordx4 v[48:51], v0, s[20:23], s45 offen sc1
    s_waitcnt vmcnt(18)
    v_lshlrev_b32 v7, 16, v86
    v_and_b32 v8, 0xffff0000, v86
    v_lshlrev_b32 v9, 16, v87
    v_and_b32 v10, 0xffff0000, v87
    v_mul_f32 v7, 0.15915494, v7
    v_mul_f32 v8, 0.15915494, v8
    v_mul_f32 v9, 0.15915494, v9
    v_mul_f32 v10, 0.15915494, v10
    v_cos_f32 v7, v7
    v_lshl_add_u32 v11, v96, 11, s40
    v_lshrrev_b32 v12, 3, v100
    v_lshlrev_b16 v13, 3, v100
    v_bitop3_b32 v12, v6, v13, v12 bitop3:0xca
    v_bitop3_b32 v96, v3, v12, v11 bitop3:0xca
    v_lshrrev_b32 v11, 3, v11
    v_lshrrev_b32 v13, 2, v100
    v_bitop3_b32 v11, v5, v13, v11 bitop3:0xca
    v_and_b32 v100, 0x3fff, v11
    ds_add_u32 v100, v2
    v_cos_f32 v8, v8
    v_lshl_add_u32 v11, v97, 11, s40
    v_lshrrev_b32 v12, 3, v101
    v_lshlrev_b16 v13, 3, v101
    v_bitop3_b32 v12, v6, v13, v12 bitop3:0xca
    v_bitop3_b32 v97, v3, v12, v11 bitop3:0xca
    v_lshrrev_b32 v11, 3, v11
    v_lshrrev_b32 v13, 2, v101
    v_bitop3_b32 v11, v5, v13, v11 bitop3:0xca
    v_and_b32 v101, 0x3fff, v11
    ds_add_u32 v101, v2
    v_cvt_pk_bf16_f32 v86, v7, v8
    v_perm_b32 v12, v86, v86, s41
    v_bitop3_b32 v96, v4, v12, v96 bitop3:0xca
    v_perm_b32 v13, v86, v86, s42
    v_bitop3_b32 v97, v4, v13, v97 bitop3:0xca
    v_cos_f32 v9, v9
    v_lshl_add_u32 v11, v98, 11, s40
    v_lshrrev_b32 v12, 3, v102
    v_lshlrev_b16 v13, 3, v102
    v_bitop3_b32 v12, v6, v13, v12 bitop3:0xca
    v_bitop3_b32 v98, v3, v12, v11 bitop3:0xca
    v_lshrrev_b32 v11, 3, v11
    v_lshrrev_b32 v13, 2, v102
    v_bitop3_b32 v11, v5, v13, v11 bitop3:0xca
    v_and_b32 v102, 0x3fff, v11
    ds_add_u32 v102, v2
    v_cos_f32 v10, v10
    v_lshl_add_u32 v11, v99, 11, s40
    v_lshrrev_b32 v12, 3, v103
    v_lshlrev_b16 v13, 3, v103
    v_bitop3_b32 v12, v6, v13, v12 bitop3:0xca
    v_bitop3_b32 v99, v3, v12, v11 bitop3:0xca
    v_lshrrev_b32 v11, 3, v11
    v_lshrrev_b32 v13, 2, v103
    v_bitop3_b32 v11, v5, v13, v11 bitop3:0xca
    v_and_b32 v103, 0x3fff, v11
    ds_add_u32 v103, v2
    v_cvt_pk_bf16_f32 v87, v9, v10
    v_perm_b32 v12, v87, v87, s41
    v_bitop3_b32 v98, v4, v12, v98 bitop3:0xca
    v_perm_b32 v13, v87, v87, s42
    v_bitop3_b32 v99, v4, v13, v99 bitop3:0xca
    s_add_u32 s46, s35, 0x2728000
    buffer_store_dwordx4 v[52:55], v0, s[20:23], s46 offen sc1
    s_waitcnt vmcnt(15)
    v_lshlrev_b32 v7, 16, v104
    v_and_b32 v8, 0xffff0000, v104
    v_lshlrev_b32 v9, 16, v105
    v_and_b32 v10, 0xffff0000, v105
    v_mul_f32 v7, 0.15915494, v7
    v_mul_f32 v8, 0.15915494, v8
    v_mul_f32 v9, 0.15915494, v9
    v_mul_f32 v10, 0.15915494, v10
    v_cos_f32 v7, v7
    v_lshl_add_u32 v11, v108, 11, s40
    v_lshrrev_b32 v12, 3, v112
    v_lshlrev_b16 v13, 3, v112
    v_bitop3_b32 v12, v6, v13, v12 bitop3:0xca
    v_bitop3_b32 v108, v3, v12, v11 bitop3:0xca
    v_lshrrev_b32 v11, 3, v11
    v_lshrrev_b32 v13, 2, v112
    v_bitop3_b32 v11, v5, v13, v11 bitop3:0xca
    v_and_b32 v112, 0x3fff, v11
    ds_add_u32 v112, v2
    v_cos_f32 v8, v8
    v_lshl_add_u32 v11, v109, 11, s40
    v_lshrrev_b32 v12, 3, v113
    v_lshlrev_b16 v13, 3, v113
    v_bitop3_b32 v12, v6, v13, v12 bitop3:0xca
    v_bitop3_b32 v109, v3, v12, v11 bitop3:0xca
    v_lshrrev_b32 v11, 3, v11
    v_lshrrev_b32 v13, 2, v113
    v_bitop3_b32 v11, v5, v13, v11 bitop3:0xca
    v_and_b32 v113, 0x3fff, v11
    ds_add_u32 v113, v2
    v_cvt_pk_bf16_f32 v104, v7, v8
    v_perm_b32 v12, v104, v104, s41
    v_bitop3_b32 v108, v4, v12, v108 bitop3:0xca
    v_perm_b32 v13, v104, v104, s42
    v_bitop3_b32 v109, v4, v13, v109 bitop3:0xca
    v_cos_f32 v9, v9
    v_lshl_add_u32 v11, v110, 11, s40
    v_lshrrev_b32 v12, 3, v114
    v_lshlrev_b16 v13, 3, v114
    v_bitop3_b32 v12, v6, v13, v12 bitop3:0xca
    v_bitop3_b32 v110, v3, v12, v11 bitop3:0xca
    v_lshrrev_b32 v11, 3, v11
    v_lshrrev_b32 v13, 2, v114
    v_bitop3_b32 v11, v5, v13, v11 bitop3:0xca
    v_and_b32 v114, 0x3fff, v11
    ds_add_u32 v114, v2
    v_cos_f32 v10, v10
    v_lshl_add_u32 v11, v111, 11, s40
    v_lshrrev_b32 v12, 3, v115
    v_lshlrev_b16 v13, 3, v115
    v_bitop3_b32 v12, v6, v13, v12 bitop3:0xca
    v_bitop3_b32 v111, v3, v12, v11 bitop3:0xca
    v_lshrrev_b32 v11, 3, v11
    v_lshrrev_b32 v13, 2, v115
    v_bitop3_b32 v11, v5, v13, v11 bitop3:0xca
    v_and_b32 v115, 0x3fff, v11
    ds_add_u32 v115, v2
    v_cvt_pk_bf16_f32 v105, v9, v10
    v_perm_b32 v12, v105, v105, s41
    v_bitop3_b32 v110, v4, v12, v110 bitop3:0xca
    v_perm_b32 v13, v105, v105, s42
    v_bitop3_b32 v111, v4, v13, v111 bitop3:0xca
    s_add_u32 s47, s35, 0x272c000
    buffer_store_dwordx4 v[56:59], v0, s[20:23], s47 offen sc1
    s_waitcnt vmcnt(14)
    v_lshlrev_b32 v7, 16, v106
    v_and_b32 v8, 0xffff0000, v106
    v_lshlrev_b32 v9, 16, v107
    v_and_b32 v10, 0xffff0000, v107
    v_mul_f32 v7, 0.15915494, v7
    v_mul_f32 v8, 0.15915494, v8
    v_mul_f32 v9, 0.15915494, v9
    v_mul_f32 v10, 0.15915494, v10
    v_cos_f32 v7, v7
    v_lshl_add_u32 v11, v116, 11, s40
    v_lshrrev_b32 v12, 3, v120
    v_lshlrev_b16 v13, 3, v120
    v_bitop3_b32 v12, v6, v13, v12 bitop3:0xca
    v_bitop3_b32 v116, v3, v12, v11 bitop3:0xca
    v_lshrrev_b32 v11, 3, v11
    v_lshrrev_b32 v13, 2, v120
    v_bitop3_b32 v11, v5, v13, v11 bitop3:0xca
    v_and_b32 v120, 0x3fff, v11
    ds_add_u32 v120, v2
    v_cos_f32 v8, v8
    v_lshl_add_u32 v11, v117, 11, s40
    v_lshrrev_b32 v12, 3, v121
    v_lshlrev_b16 v13, 3, v121
    v_bitop3_b32 v12, v6, v13, v12 bitop3:0xca
    v_bitop3_b32 v117, v3, v12, v11 bitop3:0xca
    v_lshrrev_b32 v11, 3, v11
    v_lshrrev_b32 v13, 2, v121
    v_bitop3_b32 v11, v5, v13, v11 bitop3:0xca
    v_and_b32 v121, 0x3fff, v11
    ds_add_u32 v121, v2
    v_cvt_pk_bf16_f32 v106, v7, v8
    v_perm_b32 v12, v106, v106, s41
    v_bitop3_b32 v116, v4, v12, v116 bitop3:0xca
    v_perm_b32 v13, v106, v106, s42
    v_bitop3_b32 v117, v4, v13, v117 bitop3:0xca
    v_cos_f32 v9, v9
    v_lshl_add_u32 v11, v118, 11, s40
    v_lshrrev_b32 v12, 3, v122
    v_lshlrev_b16 v13, 3, v122
    v_bitop3_b32 v12, v6, v13, v12 bitop3:0xca
    v_bitop3_b32 v118, v3, v12, v11 bitop3:0xca
    v_lshrrev_b32 v11, 3, v11
    v_lshrrev_b32 v13, 2, v122
    v_bitop3_b32 v11, v5, v13, v11 bitop3:0xca
    v_and_b32 v122, 0x3fff, v11
    ds_add_u32 v122, v2
    v_cos_f32 v10, v10
    v_lshl_add_u32 v11, v119, 11, s40
    v_lshrrev_b32 v12, 3, v123
    v_lshlrev_b16 v13, 3, v123
    v_bitop3_b32 v12, v6, v13, v12 bitop3:0xca
    v_bitop3_b32 v119, v3, v12, v11 bitop3:0xca
    v_lshrrev_b32 v11, 3, v11
    v_lshrrev_b32 v13, 2, v123
    v_bitop3_b32 v11, v5, v13, v11 bitop3:0xca
    v_and_b32 v123, 0x3fff, v11
    ds_add_u32 v123, v2
    v_cvt_pk_bf16_f32 v107, v9, v10
    v_perm_b32 v12, v107, v107, s41
    v_bitop3_b32 v118, v4, v12, v118 bitop3:0xca
    v_perm_b32 v13, v107, v107, s42
    v_bitop3_b32 v119, v4, v13, v119 bitop3:0xca
    s_add_u32 s44, s35, 0x2730000
    buffer_store_dwordx4 v[60:63], v0, s[20:23], s44 offen sc1
    s_waitcnt vmcnt(11)
    v_lshlrev_b32 v7, 16, v124
    v_and_b32 v8, 0xffff0000, v124
    v_lshlrev_b32 v9, 16, v125
    v_and_b32 v10, 0xffff0000, v125
    v_mul_f32 v7, 0.15915494, v7
    v_mul_f32 v8, 0.15915494, v8
    v_mul_f32 v9, 0.15915494, v9
    v_mul_f32 v10, 0.15915494, v10
    v_cos_f32 v7, v7
    v_lshl_add_u32 v11, v16, 11, s40
    v_lshrrev_b32 v12, 3, v20
    v_lshlrev_b16 v13, 3, v20
    v_bitop3_b32 v12, v6, v13, v12 bitop3:0xca
    v_bitop3_b32 v16, v3, v12, v11 bitop3:0xca
    v_lshrrev_b32 v11, 3, v11
    v_lshrrev_b32 v13, 2, v20
    v_bitop3_b32 v11, v5, v13, v11 bitop3:0xca
    v_and_b32 v20, 0x3fff, v11
    ds_add_u32 v20, v2
    v_cos_f32 v8, v8
    v_lshl_add_u32 v11, v17, 11, s40
    v_lshrrev_b32 v12, 3, v21
    v_lshlrev_b16 v13, 3, v21
    v_bitop3_b32 v12, v6, v13, v12 bitop3:0xca
    v_bitop3_b32 v17, v3, v12, v11 bitop3:0xca
    v_lshrrev_b32 v11, 3, v11
    v_lshrrev_b32 v13, 2, v21
    v_bitop3_b32 v11, v5, v13, v11 bitop3:0xca
    v_and_b32 v21, 0x3fff, v11
    ds_add_u32 v21, v2
    v_cvt_pk_bf16_f32 v124, v7, v8
    v_perm_b32 v12, v124, v124, s41
    v_bitop3_b32 v16, v4, v12, v16 bitop3:0xca
    v_perm_b32 v13, v124, v124, s42
    v_bitop3_b32 v17, v4, v13, v17 bitop3:0xca
    v_cos_f32 v9, v9
    v_lshl_add_u32 v11, v18, 11, s40
    v_lshrrev_b32 v12, 3, v22
    v_lshlrev_b16 v13, 3, v22
    v_bitop3_b32 v12, v6, v13, v12 bitop3:0xca
    v_bitop3_b32 v18, v3, v12, v11 bitop3:0xca
    v_lshrrev_b32 v11, 3, v11
    v_lshrrev_b32 v13, 2, v22
    v_bitop3_b32 v11, v5, v13, v11 bitop3:0xca
    v_and_b32 v22, 0x3fff, v11
    ds_add_u32 v22, v2
    v_cos_f32 v10, v10
    v_lshl_add_u32 v11, v19, 11, s40
    v_lshrrev_b32 v12, 3, v23
    v_lshlrev_b16 v13, 3, v23
    v_bitop3_b32 v12, v6, v13, v12 bitop3:0xca
    v_bitop3_b32 v19, v3, v12, v11 bitop3:0xca
    v_lshrrev_b32 v11, 3, v11
    v_lshrrev_b32 v13, 2, v23
    v_bitop3_b32 v11, v5, v13, v11 bitop3:0xca
    v_and_b32 v23, 0x3fff, v11
    ds_add_u32 v23, v2
    v_cvt_pk_bf16_f32 v125, v9, v10
    v_perm_b32 v12, v125, v125, s41
    v_bitop3_b32 v18, v4, v12, v18 bitop3:0xca
    v_perm_b32 v13, v125, v125, s42
    v_bitop3_b32 v19, v4, v13, v19 bitop3:0xca
    s_add_u32 s45, s35, 0x2734000
    buffer_store_dwordx4 v[44:47], v0, s[20:23], s45 offen sc1
    s_waitcnt vmcnt(8)
    v_lshlrev_b32 v7, 16, v126
    v_and_b32 v8, 0xffff0000, v126
    v_lshlrev_b32 v9, 16, v127
    v_and_b32 v10, 0xffff0000, v127
    v_mul_f32 v7, 0.15915494, v7
    v_mul_f32 v8, 0.15915494, v8
    v_mul_f32 v9, 0.15915494, v9
    v_mul_f32 v10, 0.15915494, v10
    v_cos_f32 v7, v7
    v_lshl_add_u32 v11, v28, 11, s40
    v_lshrrev_b32 v12, 3, v32
    v_lshlrev_b16 v13, 3, v32
    v_bitop3_b32 v12, v6, v13, v12 bitop3:0xca
    v_bitop3_b32 v28, v3, v12, v11 bitop3:0xca
    v_lshrrev_b32 v11, 3, v11
    v_lshrrev_b32 v13, 2, v32
    v_bitop3_b32 v11, v5, v13, v11 bitop3:0xca
    v_and_b32 v32, 0x3fff, v11
    ds_add_u32 v32, v2
    v_cos_f32 v8, v8
    v_lshl_add_u32 v11, v29, 11, s40
    v_lshrrev_b32 v12, 3, v33
    v_lshlrev_b16 v13, 3, v33
    v_bitop3_b32 v12, v6, v13, v12 bitop3:0xca
    v_bitop3_b32 v29, v3, v12, v11 bitop3:0xca
    v_lshrrev_b32 v11, 3, v11
    v_lshrrev_b32 v13, 2, v33
    v_bitop3_b32 v11, v5, v13, v11 bitop3:0xca
    v_and_b32 v33, 0x3fff, v11
    ds_add_u32 v33, v2
    v_cvt_pk_bf16_f32 v126, v7, v8
    v_perm_b32 v12, v126, v126, s41
    v_bitop3_b32 v28, v4, v12, v28 bitop3:0xca
    v_perm_b32 v13, v126, v126, s42
    v_bitop3_b32 v29, v4, v13, v29 bitop3:0xca
    v_cos_f32 v9, v9
    v_lshl_add_u32 v11, v30, 11, s40
    v_lshrrev_b32 v12, 3, v34
    v_lshlrev_b16 v13, 3, v34
    v_bitop3_b32 v12, v6, v13, v12 bitop3:0xca
    v_bitop3_b32 v30, v3, v12, v11 bitop3:0xca
    v_lshrrev_b32 v11, 3, v11
    v_lshrrev_b32 v13, 2, v34
    v_bitop3_b32 v11, v5, v13, v11 bitop3:0xca
    v_and_b32 v34, 0x3fff, v11
    ds_add_u32 v34, v2
    v_cos_f32 v10, v10
    v_lshl_add_u32 v11, v31, 11, s40
    v_lshrrev_b32 v12, 3, v35
    v_lshlrev_b16 v13, 3, v35
    v_bitop3_b32 v12, v6, v13, v12 bitop3:0xca
    v_bitop3_b32 v31, v3, v12, v11 bitop3:0xca
    v_lshrrev_b32 v11, 3, v11
    v_lshrrev_b32 v13, 2, v35
    v_bitop3_b32 v11, v5, v13, v11 bitop3:0xca
    v_and_b32 v35, 0x3fff, v11
    ds_add_u32 v35, v2
    v_cvt_pk_bf16_f32 v127, v9, v10
    v_perm_b32 v12, v127, v127, s41
    v_bitop3_b32 v30, v4, v12, v30 bitop3:0xca
    v_perm_b32 v13, v127, v127, s42
    v_bitop3_b32 v31, v4, v13, v31 bitop3:0xca
    v_lshrrev_b32 v8, 2, v0
    v_and_b32 v7, 0x3c00, v0
    v_bitop3_b32 v7, v5, v8, v7 bitop3:0xea
    s_waitcnt lgkmcnt(0)
    s_barrier
    ds_read2st64_b32 v[8:9], v7 offset0:0 offset1:1
    ds_read2st64_b32 v[10:11], v7 offset0:2 offset1:3
    s_add_u32 s46, s33, 0x5dc0000
    buffer_load_dwordx4 v[36:39], v0, s[8:11], s46 offen nt
    s_waitcnt lgkmcnt(0)
    v_lshl_or_b32 v12, v9, 16, v8
    v_lshl_or_b32 v13, v11, 16, v10
    v_mov_b32 v14, v12
    v_mov_b32 v15, v13
    s_nop 0
    v_add_u32_dpp v14, v14, v14 row_shr:1 row_mask:0xf bank_mask:0xf bound_ctrl:1
    v_add_u32_dpp v15, v15, v15 row_shr:1 row_mask:0xf bank_mask:0xf bound_ctrl:1
    s_nop 0
    v_add_u32_dpp v14, v14, v14 row_shr:2 row_mask:0xf bank_mask:0xf bound_ctrl:1
    v_add_u32_dpp v15, v15, v15 row_shr:2 row_mask:0xf bank_mask:0xf bound_ctrl:1
    s_nop 0
    v_add_u32_dpp v14, v14, v14 row_shr:4 row_mask:0xf bank_mask:0xf bound_ctrl:1
    v_add_u32_dpp v15, v15, v15 row_shr:4 row_mask:0xf bank_mask:0xf bound_ctrl:1
    s_nop 0
    v_add_u32_dpp v14, v14, v14 row_shr:8 row_mask:0xf bank_mask:0xf bound_ctrl:1
    v_add_u32_dpp v15, v15, v15 row_shr:8 row_mask:0xf bank_mask:0xf bound_ctrl:1
    s_nop 0
    v_add_u32_dpp v14, v14, v14 row_bcast:15 row_mask:0xa bank_mask:0xf
    v_add_u32_dpp v15, v15, v15 row_bcast:15 row_mask:0xa bank_mask:0xf
    s_nop 0
    v_add_u32_dpp v14, v14, v14 row_bcast:31 row_mask:0xc bank_mask:0xf
    v_add_u32_dpp v15, v15, v15 row_bcast:31 row_mask:0xc bank_mask:0xf
    v_readlane_b32 s48, v14, 63
    v_readlane_b32 s49, v15, 63
    s_lshl_b32 s54, s32, 2
    v_mov_b32 v8, s54
    s_and_b32 s50, s48, 0xffff
    s_lshr_b32 s51, s48, 16
    s_and_b32 s52, s49, 0xffff
    s_lshr_b32 s53, s49, 16
    s_add_u32 s51, s51, s50
    s_add_u32 s52, s52, s51
    s_add_u32 s53, s53, s52
    v_mov_b32 v9, s53
    s_mov_b64 exec, 1
    ds_write_b32 v8, v9 offset:16384
    s_mov_b64 exec, -1
    v_and_b32 v8, 60, v7
    s_waitcnt lgkmcnt(0)
    s_barrier
    ds_read_b32 v9, v8 offset:16384
    s_waitcnt lgkmcnt(0)
    v_add_u32_dpp v9, v9, v9 row_shr:1 row_mask:0xf bank_mask:0xf bound_ctrl:1
    s_nop 1
    v_add_u32_dpp v9, v9, v9 row_shr:2 row_mask:0xf bank_mask:0xf bound_ctrl:1
    s_nop 1
    v_add_u32_dpp v9, v9, v9 row_shr:4 row_mask:0xf bank_mask:0xf bound_ctrl:1
    s_nop 1
    v_add_u32_dpp v9, v9, v9 row_shr:8 row_mask:0xf bank_mask:0xf bound_ctrl:1
    s_nop 0
    v_readlane_b32 s54, v9, s32
    s_sub_u32 s54, s54, s53
    s_add_u32 s50, s50, s54
    s_add_u32 s51, s51, s54
    s_add_u32 s52, s52, s54
    s_pack_ll_b32_b16 s48, s54, s50
    s_pack_ll_b32_b16 s49, s51, s52
    v_add_u32 v14, s48, v14
    v_add_u32 v15, s49, v15
    v_sub_u32 v12, v14, v12
    v_sub_u32 v13, v15, v13
    v_and_b32 v8, 0xffff, v12
    v_lshrrev_b32 v9, 16, v12
    v_and_b32 v10, 0xffff, v13
    v_lshrrev_b32 v11, 16, v13
    ds_write2st64_b32 v7, v8, v9 offset0:0 offset1:1
    ds_write2st64_b32 v7, v10, v11 offset0:2 offset1:3
    s_waitcnt lgkmcnt(0)
    s_barrier
    ds_add_rtn_u32 v72, v72, v2
    ds_add_rtn_u32 v73, v73, v2
    ds_add_rtn_u32 v74, v74, v2
    ds_add_rtn_u32 v75, v75, v2
    s_add_u32 s47, s36, 0x3f7a00
    buffer_store_dwordx2 v[12:13], v1, s[24:27], s47 offen
    s_bitset0_b64 exec, 63
    s_not_b64 exec, exec
    buffer_store_dwordx2 v[14:15], v1, s[24:27], s47 offen offset:8
    s_mov_b64 exec, -1
    ds_add_rtn_u32 v80, v80, v2
    ds_add_rtn_u32 v81, v81, v2
    ds_add_rtn_u32 v82, v82, v2
    ds_add_rtn_u32 v83, v83, v2
    s_add_u32 s44, s33, 0x5dc0000
    buffer_load_dwordx4 v[40:43], v0, s[12:15], s44 offen nt
    ds_add_rtn_u32 v92, v92, v2
    ds_add_rtn_u32 v93, v93, v2
    ds_add_rtn_u32 v94, v94, v2
    ds_add_rtn_u32 v95, v95, v2
    s_add_u32 s45, s34, 0x2ee0000
    buffer_load_dwordx2 v[24:25], v1, s[16:19], s45 offen nt
    s_add_u32 s46, s34, 0x2ee2000
    buffer_load_dwordx2 v[26:27], v1, s[16:19], s46 offen nt
    ds_add_rtn_u32 v100, v100, v2
    ds_add_rtn_u32 v101, v101, v2
    ds_add_rtn_u32 v102, v102, v2
    ds_add_rtn_u32 v103, v103, v2
    s_add_u32 s47, s33, 0x5dc4000
    buffer_load_dwordx4 v[48:51], v0, s[8:11], s47 offen nt
    ds_add_rtn_u32 v112, v112, v2
    ds_add_rtn_u32 v113, v113, v2
    ds_add_rtn_u32 v114, v114, v2
    ds_add_rtn_u32 v115, v115, v2
    s_add_u32 s44, s33, 0x5dc4000
    buffer_load_dwordx4 v[52:55], v0, s[12:15], s44 offen nt
    ds_add_rtn_u32 v120, v120, v2
    ds_add_rtn_u32 v121, v121, v2
    ds_add_rtn_u32 v122, v122, v2
    ds_add_rtn_u32 v123, v123, v2
    s_add_u32 s45, s33, 0x5dc8000
    buffer_load_dwordx4 v[56:59], v0, s[8:11], s45 offen nt
    ds_add_rtn_u32 v20, v20, v2
    ds_add_rtn_u32 v21, v21, v2
    ds_add_rtn_u32 v22, v22, v2
    ds_add_rtn_u32 v23, v23, v2
    s_add_u32 s46, s33, 0x5dc8000
    buffer_load_dwordx4 v[60:63], v0, s[12:15], s46 offen nt
    ds_add_rtn_u32 v32, v32, v2
    ds_add_rtn_u32 v33, v33, v2
    ds_add_rtn_u32 v34, v34, v2
    ds_add_rtn_u32 v35, v35, v2
    s_add_u32 s47, s34, 0x2ee4000
    buffer_load_dwordx2 v[44:45], v1, s[16:19], s47 offen nt
    s_add_u32 s44, s34, 0x2ee6000
    buffer_load_dwordx2 v[46:47], v1, s[16:19], s44 offen nt
    s_waitcnt lgkmcnt(0)
    s_barrier
    v_and_b32 v7, -4, v72
    v_lshl_add_u32 v8, v72, 2, v7
    ds_write_b32 v8, v68
    v_lshl_add_u32 v7, v7, 2, v72
    ds_write_b8 v7, v64 offset:16
    v_and_b32 v9, -4, v73
    v_lshl_add_u32 v10, v73, 2, v9
    ds_write_b32 v10, v69
    v_lshl_add_u32 v9, v9, 2, v73
    ds_write_b8_d16_hi v9, v64 offset:16
    v_and_b32 v7, -4, v74
    v_lshl_add_u32 v8, v74, 2, v7
    ds_write_b32 v8, v70
    v_lshl_add_u32 v7, v7, 2, v74
    ds_write_b8 v7, v65 offset:16
    v_and_b32 v9, -4, v75
    v_lshl_add_u32 v10, v75, 2, v9
    ds_write_b32 v10, v71
    v_lshl_add_u32 v9, v9, 2, v75
    ds_write_b8_d16_hi v9, v65 offset:16
    s_add_u32 s45, s33, 0x5dcc000
    buffer_load_dwordx4 v[68:71], v0, s[8:11], s45 offen nt
    s_add_u32 s46, s33, 0x5dcc000
    buffer_load_dwordx4 v[72:75], v0, s[12:15], s46 offen nt
    v_and_b32 v7, -4, v80
    v_lshl_add_u32 v8, v80, 2, v7
    ds_write_b32 v8, v76
    v_lshl_add_u32 v7, v7, 2, v80
    ds_write_b8 v7, v66 offset:16
    v_and_b32 v9, -4, v81
    v_lshl_add_u32 v10, v81, 2, v9
    ds_write_b32 v10, v77
    v_lshl_add_u32 v9, v9, 2, v81
    ds_write_b8_d16_hi v9, v66 offset:16
    v_and_b32 v7, -4, v82
    v_lshl_add_u32 v8, v82, 2, v7
    ds_write_b32 v8, v78
    v_lshl_add_u32 v7, v7, 2, v82
    ds_write_b8 v7, v67 offset:16
    v_and_b32 v9, -4, v83
    v_lshl_add_u32 v10, v83, 2, v9
    ds_write_b32 v10, v79
    v_lshl_add_u32 v9, v9, 2, v83
    ds_write_b8_d16_hi v9, v67 offset:16
    s_add_u32 s47, s33, 0x5dd0000
    buffer_load_dwordx4 v[76:79], v0, s[8:11], s47 offen nt
    v_and_b32 v7, -4, v92
    v_lshl_add_u32 v8, v92, 2, v7
    ds_write_b32 v8, v88
    v_lshl_add_u32 v7, v7, 2, v92
    ds_write_b8 v7, v84 offset:16
    v_and_b32 v9, -4, v93
    v_lshl_add_u32 v10, v93, 2, v9
    ds_write_b32 v10, v89
    v_lshl_add_u32 v9, v9, 2, v93
    ds_write_b8_d16_hi v9, v84 offset:16
    v_and_b32 v7, -4, v94
    v_lshl_add_u32 v8, v94, 2, v7
    ds_write_b32 v8, v90
    v_lshl_add_u32 v7, v7, 2, v94
    ds_write_b8 v7, v85 offset:16
    v_and_b32 v9, -4, v95
    v_lshl_add_u32 v10, v95, 2, v9
    ds_write_b32 v10, v91
    v_lshl_add_u32 v9, v9, 2, v95
    ds_write_b8_d16_hi v9, v85 offset:16
    s_add_u32 s44, s33, 0x5dd0000
    buffer_load_dwordx4 v[80:83], v0, s[12:15], s44 offen nt
    v_and_b32 v7, -4, v100
    v_lshl_add_u32 v8, v100, 2, v7
    ds_write_b32 v8, v96
    v_lshl_add_u32 v7, v7, 2, v100
    ds_write_b8 v7, v86 offset:16
    v_and_b32 v9, -4, v101
    v_lshl_add_u32 v10, v101, 2, v9
    ds_write_b32 v10, v97
    v_lshl_add_u32 v9, v9, 2, v101
    ds_write_b8_d16_hi v9, v86 offset:16
    v_and_b32 v7, -4, v102
    v_lshl_add_u32 v8, v102, 2, v7
    ds_write_b32 v8, v98
    v_lshl_add_u32 v7, v7, 2, v102
    ds_write_b8 v7, v87 offset:16
    v_and_b32 v9, -4, v103
    v_lshl_add_u32 v10, v103, 2, v9
    ds_write_b32 v10, v99
    v_lshl_add_u32 v9, v9, 2, v103
    ds_write_b8_d16_hi v9, v87 offset:16
    s_add_u32 s45, s34, 0x2ee8000
    buffer_load_dwordx2 v[64:65], v1, s[16:19], s45 offen nt
    s_add_u32 s46, s34, 0x2eea000
    buffer_load_dwordx2 v[66:67], v1, s[16:19], s46 offen nt
    v_and_b32 v7, -4, v112
    v_lshl_add_u32 v8, v112, 2, v7
    ds_write_b32 v8, v108
    v_lshl_add_u32 v7, v7, 2, v112
    ds_write_b8 v7, v104 offset:16
    v_and_b32 v9, -4, v113
    v_lshl_add_u32 v10, v113, 2, v9
    ds_write_b32 v10, v109
    v_lshl_add_u32 v9, v9, 2, v113
    ds_write_b8_d16_hi v9, v104 offset:16
    v_and_b32 v7, -4, v114
    v_lshl_add_u32 v8, v114, 2, v7
    ds_write_b32 v8, v110
    v_lshl_add_u32 v7, v7, 2, v114
    ds_write_b8 v7, v105 offset:16
    v_and_b32 v9, -4, v115
    v_lshl_add_u32 v10, v115, 2, v9
    ds_write_b32 v10, v111
    v_lshl_add_u32 v9, v9, 2, v115
    ds_write_b8_d16_hi v9, v105 offset:16
    s_add_u32 s47, s33, 0x5dd4000
    buffer_load_dwordx4 v[88:91], v0, s[8:11], s47 offen nt
    s_add_u32 s44, s33, 0x5dd4000
    buffer_load_dwordx4 v[92:95], v0, s[12:15], s44 offen nt
    v_and_b32 v7, -4, v120
    v_lshl_add_u32 v8, v120, 2, v7
    ds_write_b32 v8, v116
    v_lshl_add_u32 v7, v7, 2, v120
    ds_write_b8 v7, v106 offset:16
    v_and_b32 v9, -4, v121
    v_lshl_add_u32 v10, v121, 2, v9
    ds_write_b32 v10, v117
    v_lshl_add_u32 v9, v9, 2, v121
    ds_write_b8_d16_hi v9, v106 offset:16
    v_and_b32 v7, -4, v122
    v_lshl_add_u32 v8, v122, 2, v7
    ds_write_b32 v8, v118
    v_lshl_add_u32 v7, v7, 2, v122
    ds_write_b8 v7, v107 offset:16
    v_and_b32 v9, -4, v123
    v_lshl_add_u32 v10, v123, 2, v9
    ds_write_b32 v10, v119
    v_lshl_add_u32 v9, v9, 2, v123
    ds_write_b8_d16_hi v9, v107 offset:16
    s_add_u32 s45, s33, 0x5dd8000
    buffer_load_dwordx4 v[96:99], v0, s[8:11], s45 offen nt
    v_and_b32 v7, -4, v20
    v_lshl_add_u32 v8, v20, 2, v7
    ds_write_b32 v8, v16
    v_lshl_add_u32 v7, v7, 2, v20
    ds_write_b8 v7, v124 offset:16
    v_and_b32 v9, -4, v21
    v_lshl_add_u32 v10, v21, 2, v9
    ds_write_b32 v10, v17
    v_lshl_add_u32 v9, v9, 2, v21
    ds_write_b8_d16_hi v9, v124 offset:16
    v_and_b32 v7, -4, v22
    v_lshl_add_u32 v8, v22, 2, v7
    ds_write_b32 v8, v18
    v_lshl_add_u32 v7, v7, 2, v22
    ds_write_b8 v7, v125 offset:16
    v_and_b32 v9, -4, v23
    v_lshl_add_u32 v10, v23, 2, v9
    ds_write_b32 v10, v19
    v_lshl_add_u32 v9, v9, 2, v23
    ds_write_b8_d16_hi v9, v125 offset:16
    s_add_u32 s46, s33, 0x5dd8000
    buffer_load_dwordx4 v[100:103], v0, s[12:15], s46 offen nt
    v_and_b32 v7, -4, v32
    v_lshl_add_u32 v8, v32, 2, v7
    ds_write_b32 v8, v28
    v_lshl_add_u32 v7, v7, 2, v32
    ds_write_b8 v7, v126 offset:16
    v_and_b32 v9, -4, v33
    v_lshl_add_u32 v10, v33, 2, v9
    ds_write_b32 v10, v29
    v_lshl_add_u32 v9, v9, 2, v33
    ds_write_b8_d16_hi v9, v126 offset:16
    v_and_b32 v7, -4, v34
    v_lshl_add_u32 v8, v34, 2, v7
    ds_write_b32 v8, v30
    v_lshl_add_u32 v7, v7, 2, v34
    ds_write_b8 v7, v127 offset:16
    v_and_b32 v9, -4, v35
    v_lshl_add_u32 v10, v35, 2, v9
    ds_write_b32 v10, v31
    v_lshl_add_u32 v9, v9, 2, v35
    ds_write_b8_d16_hi v9, v127 offset:16
    s_add_u32 s47, s34, 0x2eec000
    buffer_load_dwordx2 v[84:85], v1, s[16:19], s47 offen nt
    s_add_u32 s44, s34, 0x2eee000
    buffer_load_dwordx2 v[86:87], v1, s[16:19], s44 offen nt
    v_add_u32 v7, 0x10000, v0
    v_add_u32 v12, 0x20000, v0
    v_mov_b32 v8, 0
    v_mov_b32 v9, 0
    v_mov_b32 v10, 0
    v_mov_b32 v11, 0
    s_waitcnt lgkmcnt(0)
    s_barrier
    ds_read_b128 v[108:111], v0 offset:0
    ds_write_b128 v0, v[8:11]
    ds_read_b128 v[112:115], v0 offset:16384
    ds_read_b128 v[116:119], v0 offset:32768
    ds_read_b128 v[120:123], v0 offset:49152
    ds_read_b128 v[104:107], v7 offset:0
    ds_read_b128 v[16:19], v7 offset:16384
    ds_read_b128 v[20:23], v7 offset:32768
    ds_read_b128 v[28:31], v7 offset:49152
    ds_read_b128 v[32:35], v12 offset:0
    ds_read_b128 v[124:127], v12 offset:16384
    s_waitcnt lgkmcnt(0)
    s_barrier
    s_add_u32 s45, s35, 0x4e20000
    buffer_store_dwordx4 v[108:111], v0, s[20:23], s45 offen sc1
    s_add_u32 s46, s35, 0x4e24000
    buffer_store_dwordx4 v[112:115], v0, s[20:23], s46 offen sc1
    s_add_u32 s47, s33, 0x5ddc000
    buffer_load_dwordx4 v[108:111], v0, s[8:11], s47 offen nt
    s_add_u32 s44, s33, 0x5ddc000
    buffer_load_dwordx4 v[112:115], v0, s[12:15], s44 offen nt
    s_add_u32 s45, s35, 0x4e28000
    buffer_store_dwordx4 v[116:119], v0, s[20:23], s45 offen sc1
    s_waitcnt vmcnt(23)
    v_lshlrev_b32 v7, 16, v24
    v_and_b32 v8, 0xffff0000, v24
    v_lshlrev_b32 v9, 16, v25
    v_and_b32 v10, 0xffff0000, v25
    v_mul_f32 v7, 0.15915494, v7
    v_mul_f32 v8, 0.15915494, v8
    v_mul_f32 v9, 0.15915494, v9
    v_mul_f32 v10, 0.15915494, v10
    v_cos_f32 v7, v7
    v_lshl_add_u32 v11, v36, 11, s40
    v_lshrrev_b32 v12, 3, v40
    v_lshlrev_b16 v13, 3, v40
    v_bitop3_b32 v12, v6, v13, v12 bitop3:0xca
    v_bitop3_b32 v36, v3, v12, v11 bitop3:0xca
    v_lshrrev_b32 v11, 3, v11
    v_lshrrev_b32 v13, 2, v40
    v_bitop3_b32 v11, v5, v13, v11 bitop3:0xca
    v_and_b32 v40, 0x3fff, v11
    ds_add_u32 v40, v2
    v_cos_f32 v8, v8
    v_lshl_add_u32 v11, v37, 11, s40
    v_lshrrev_b32 v12, 3, v41
    v_lshlrev_b16 v13, 3, v41
    v_bitop3_b32 v12, v6, v13, v12 bitop3:0xca
    v_bitop3_b32 v37, v3, v12, v11 bitop3:0xca
    v_lshrrev_b32 v11, 3, v11
    v_lshrrev_b32 v13, 2, v41
    v_bitop3_b32 v11, v5, v13, v11 bitop3:0xca
    v_and_b32 v41, 0x3fff, v11
    ds_add_u32 v41, v2
    v_cvt_pk_bf16_f32 v24, v7, v8
    v_perm_b32 v12, v24, v24, s41
    v_bitop3_b32 v36, v4, v12, v36 bitop3:0xca
    v_perm_b32 v13, v24, v24, s42
    v_bitop3_b32 v37, v4, v13, v37 bitop3:0xca
    v_cos_f32 v9, v9
    v_lshl_add_u32 v11, v38, 11, s40
    v_lshrrev_b32 v12, 3, v42
    v_lshlrev_b16 v13, 3, v42
    v_bitop3_b32 v12, v6, v13, v12 bitop3:0xca
    v_bitop3_b32 v38, v3, v12, v11 bitop3:0xca
    v_lshrrev_b32 v11, 3, v11
    v_lshrrev_b32 v13, 2, v42
    v_bitop3_b32 v11, v5, v13, v11 bitop3:0xca
    v_and_b32 v42, 0x3fff, v11
    ds_add_u32 v42, v2
    v_cos_f32 v10, v10
    v_lshl_add_u32 v11, v39, 11, s40
    v_lshrrev_b32 v12, 3, v43
    v_lshlrev_b16 v13, 3, v43
    v_bitop3_b32 v12, v6, v13, v12 bitop3:0xca
    v_bitop3_b32 v39, v3, v12, v11 bitop3:0xca
    v_lshrrev_b32 v11, 3, v11
    v_lshrrev_b32 v13, 2, v43
    v_bitop3_b32 v11, v5, v13, v11 bitop3:0xca
    v_and_b32 v43, 0x3fff, v11
    ds_add_u32 v43, v2
    v_cvt_pk_bf16_f32 v25, v9, v10
    v_perm_b32 v12, v25, v25, s41
    v_bitop3_b32 v38, v4, v12, v38 bitop3:0xca
    v_perm_b32 v13, v25, v25, s42
    v_bitop3_b32 v39, v4, v13, v39 bitop3:0xca
    s_add_u32 s46, s35, 0x4e2c000
    buffer_store_dwordx4 v[120:123], v0, s[20:23], s46 offen sc1
    s_waitcnt vmcnt(22)
    v_lshlrev_b32 v7, 16, v26
    v_and_b32 v8, 0xffff0000, v26
    v_lshlrev_b32 v9, 16, v27
    v_and_b32 v10, 0xffff0000, v27
    v_mul_f32 v7, 0.15915494, v7
    v_mul_f32 v8, 0.15915494, v8
    v_mul_f32 v9, 0.15915494, v9
    v_mul_f32 v10, 0.15915494, v10
    v_cos_f32 v7, v7
    v_lshl_add_u32 v11, v48, 11, s40
    v_lshrrev_b32 v12, 3, v52
    v_lshlrev_b16 v13, 3, v52
    v_bitop3_b32 v12, v6, v13, v12 bitop3:0xca
    v_bitop3_b32 v48, v3, v12, v11 bitop3:0xca
    v_lshrrev_b32 v11, 3, v11
    v_lshrrev_b32 v13, 2, v52
    v_bitop3_b32 v11, v5, v13, v11 bitop3:0xca
    v_and_b32 v52, 0x3fff, v11
    ds_add_u32 v52, v2
    v_cos_f32 v8, v8
    v_lshl_add_u32 v11, v49, 11, s40
    v_lshrrev_b32 v12, 3, v53
    v_lshlrev_b16 v13, 3, v53
    v_bitop3_b32 v12, v6, v13, v12 bitop3:0xca
    v_bitop3_b32 v49, v3, v12, v11 bitop3:0xca
    v_lshrrev_b32 v11, 3, v11
    v_lshrrev_b32 v13, 2, v53
    v_bitop3_b32 v11, v5, v13, v11 bitop3:0xca
    v_and_b32 v53, 0x3fff, v11
    ds_add_u32 v53, v2
    v_cvt_pk_bf16_f32 v26, v7, v8
    v_perm_b32 v12, v26, v26, s41
    v_bitop3_b32 v48, v4, v12, v48 bitop3:0xca
    v_perm_b32 v13, v26, v26, s42
    v_bitop3_b32 v49, v4, v13, v49 bitop3:0xca
    v_cos_f32 v9, v9
    v_lshl_add_u32 v11, v50, 11, s40
    v_lshrrev_b32 v12, 3, v54
    v_lshlrev_b16 v13, 3, v54
    v_bitop3_b32 v12, v6, v13, v12 bitop3:0xca
    v_bitop3_b32 v50, v3, v12, v11 bitop3:0xca
    v_lshrrev_b32 v11, 3, v11
    v_lshrrev_b32 v13, 2, v54
    v_bitop3_b32 v11, v5, v13, v11 bitop3:0xca
    v_and_b32 v54, 0x3fff, v11
    ds_add_u32 v54, v2
    v_cos_f32 v10, v10
    v_lshl_add_u32 v11, v51, 11, s40
    v_lshrrev_b32 v12, 3, v55
    v_lshlrev_b16 v13, 3, v55
    v_bitop3_b32 v12, v6, v13, v12 bitop3:0xca
    v_bitop3_b32 v51, v3, v12, v11 bitop3:0xca
    v_lshrrev_b32 v11, 3, v11
    v_lshrrev_b32 v13, 2, v55
    v_bitop3_b32 v11, v5, v13, v11 bitop3:0xca
    v_and_b32 v55, 0x3fff, v11
    ds_add_u32 v55, v2
    v_cvt_pk_bf16_f32 v27, v9, v10
    v_perm_b32 v12, v27, v27, s41
    v_bitop3_b32 v50, v4, v12, v50 bitop3:0xca
    v_perm_b32 v13, v27, v27, s42
    v_bitop3_b32 v51, v4, v13, v51 bitop3:0xca
    s_add_u32 s47, s35, 0x4e30000
    buffer_store_dwordx4 v[104:107], v0, s[20:23], s47 offen sc1
    s_waitcnt vmcnt(19)
    v_lshlrev_b32 v7, 16, v44
    v_and_b32 v8, 0xffff0000, v44
    v_lshlrev_b32 v9, 16, v45
    v_and_b32 v10, 0xffff0000, v45
    v_mul_f32 v7, 0.15915494, v7
    v_mul_f32 v8, 0.15915494, v8
    v_mul_f32 v9, 0.15915494, v9
    v_mul_f32 v10, 0.15915494, v10
    v_cos_f32 v7, v7
    v_lshl_add_u32 v11, v56, 11, s40
    v_lshrrev_b32 v12, 3, v60
    v_lshlrev_b16 v13, 3, v60
    v_bitop3_b32 v12, v6, v13, v12 bitop3:0xca
    v_bitop3_b32 v56, v3, v12, v11 bitop3:0xca
    v_lshrrev_b32 v11, 3, v11
    v_lshrrev_b32 v13, 2, v60
    v_bitop3_b32 v11, v5, v13, v11 bitop3:0xca
    v_and_b32 v60, 0x3fff, v11
    ds_add_u32 v60, v2
    v_cos_f32 v8, v8
    v_lshl_add_u32 v11, v57, 11, s40
    v_lshrrev_b32 v12, 3, v61
    v_lshlrev_b16 v13, 3, v61
    v_bitop3_b32 v12, v6, v13, v12 bitop3:0xca
    v_bitop3_b32 v57, v3, v12, v11 bitop3:0xca
    v_lshrrev_b32 v11, 3, v11
    v_lshrrev_b32 v13, 2, v61
    v_bitop3_b32 v11, v5, v13, v11 bitop3:0xca
    v_and_b32 v61, 0x3fff, v11
    ds_add_u32 v61, v2
    v_cvt_pk_bf16_f32 v44, v7, v8
    v_perm_b32 v12, v44, v44, s41
    v_bitop3_b32 v56, v4, v12, v56 bitop3:0xca
    v_perm_b32 v13, v44, v44, s42
    v_bitop3_b32 v57, v4, v13, v57 bitop3:0xca
    v_cos_f32 v9, v9
    v_lshl_add_u32 v11, v58, 11, s40
    v_lshrrev_b32 v12, 3, v62
    v_lshlrev_b16 v13, 3, v62
    v_bitop3_b32 v12, v6, v13, v12 bitop3:0xca
    v_bitop3_b32 v58, v3, v12, v11 bitop3:0xca
    v_lshrrev_b32 v11, 3, v11
    v_lshrrev_b32 v13, 2, v62
    v_bitop3_b32 v11, v5, v13, v11 bitop3:0xca
    v_and_b32 v62, 0x3fff, v11
    ds_add_u32 v62, v2
    v_cos_f32 v10, v10
    v_lshl_add_u32 v11, v59, 11, s40
    v_lshrrev_b32 v12, 3, v63
    v_lshlrev_b16 v13, 3, v63
    v_bitop3_b32 v12, v6, v13, v12 bitop3:0xca
    v_bitop3_b32 v59, v3, v12, v11 bitop3:0xca
    v_lshrrev_b32 v11, 3, v11
    v_lshrrev_b32 v13, 2, v63
    v_bitop3_b32 v11, v5, v13, v11 bitop3:0xca
    v_and_b32 v63, 0x3fff, v11
    ds_add_u32 v63, v2
    v_cvt_pk_bf16_f32 v45, v9, v10
    v_perm_b32 v12, v45, v45, s41
    v_bitop3_b32 v58, v4, v12, v58 bitop3:0xca
    v_perm_b32 v13, v45, v45, s42
    v_bitop3_b32 v59, v4, v13, v59 bitop3:0xca
    s_add_u32 s44, s35, 0x4e34000
    buffer_store_dwordx4 v[16:19], v0, s[20:23], s44 offen sc1
    s_waitcnt vmcnt(18)
    v_lshlrev_b32 v7, 16, v46
    v_and_b32 v8, 0xffff0000, v46
    v_lshlrev_b32 v9, 16, v47
    v_and_b32 v10, 0xffff0000, v47
    v_mul_f32 v7, 0.15915494, v7
    v_mul_f32 v8, 0.15915494, v8
    v_mul_f32 v9, 0.15915494, v9
    v_mul_f32 v10, 0.15915494, v10
    v_cos_f32 v7, v7
    v_lshl_add_u32 v11, v68, 11, s40
    v_lshrrev_b32 v12, 3, v72
    v_lshlrev_b16 v13, 3, v72
    v_bitop3_b32 v12, v6, v13, v12 bitop3:0xca
    v_bitop3_b32 v68, v3, v12, v11 bitop3:0xca
    v_lshrrev_b32 v11, 3, v11
    v_lshrrev_b32 v13, 2, v72
    v_bitop3_b32 v11, v5, v13, v11 bitop3:0xca
    v_and_b32 v72, 0x3fff, v11
    ds_add_u32 v72, v2
    v_cos_f32 v8, v8
    v_lshl_add_u32 v11, v69, 11, s40
    v_lshrrev_b32 v12, 3, v73
    v_lshlrev_b16 v13, 3, v73
    v_bitop3_b32 v12, v6, v13, v12 bitop3:0xca
    v_bitop3_b32 v69, v3, v12, v11 bitop3:0xca
    v_lshrrev_b32 v11, 3, v11
    v_lshrrev_b32 v13, 2, v73
    v_bitop3_b32 v11, v5, v13, v11 bitop3:0xca
    v_and_b32 v73, 0x3fff, v11
    ds_add_u32 v73, v2
    v_cvt_pk_bf16_f32 v46, v7, v8
    v_perm_b32 v12, v46, v46, s41
    v_bitop3_b32 v68, v4, v12, v68 bitop3:0xca
    v_perm_b32 v13, v46, v46, s42
    v_bitop3_b32 v69, v4, v13, v69 bitop3:0xca
    v_cos_f32 v9, v9
    v_lshl_add_u32 v11, v70, 11, s40
    v_lshrrev_b32 v12, 3, v74
    v_lshlrev_b16 v13, 3, v74
    v_bitop3_b32 v12, v6, v13, v12 bitop3:0xca
    v_bitop3_b32 v70, v3, v12, v11 bitop3:0xca
    v_lshrrev_b32 v11, 3, v11
    v_lshrrev_b32 v13, 2, v74
    v_bitop3_b32 v11, v5, v13, v11 bitop3:0xca
    v_and_b32 v74, 0x3fff, v11
    ds_add_u32 v74, v2
    v_cos_f32 v10, v10
    v_lshl_add_u32 v11, v71, 11, s40
    v_lshrrev_b32 v12, 3, v75
    v_lshlrev_b16 v13, 3, v75
    v_bitop3_b32 v12, v6, v13, v12 bitop3:0xca
    v_bitop3_b32 v71, v3, v12, v11 bitop3:0xca
    v_lshrrev_b32 v11, 3, v11
    v_lshrrev_b32 v13, 2, v75
    v_bitop3_b32 v11, v5, v13, v11 bitop3:0xca
    v_and_b32 v75, 0x3fff, v11
    ds_add_u32 v75, v2
    v_cvt_pk_bf16_f32 v47, v9, v10
    v_perm_b32 v12, v47, v47, s41
    v_bitop3_b32 v70, v4, v12, v70 bitop3:0xca
    v_perm_b32 v13, v47, v47, s42
    v_bitop3_b32 v71, v4, v13, v71 bitop3:0xca
    s_add_u32 s45, s35, 0x4e38000
    buffer_store_dwordx4 v[20:23], v0, s[20:23], s45 offen sc1
    s_waitcnt vmcnt(15)
    v_lshlrev_b32 v7, 16, v64
    v_and_b32 v8, 0xffff0000, v64
    v_lshlrev_b32 v9, 16, v65
    v_and_b32 v10, 0xffff0000, v65
    v_mul_f32 v7, 0.15915494, v7
    v_mul_f32 v8, 0.15915494, v8
    v_mul_f32 v9, 0.15915494, v9
    v_mul_f32 v10, 0.15915494, v10
    v_cos_f32 v7, v7
    v_lshl_add_u32 v11, v76, 11, s40
    v_lshrrev_b32 v12, 3, v80
    v_lshlrev_b16 v13, 3, v80
    v_bitop3_b32 v12, v6, v13, v12 bitop3:0xca
    v_bitop3_b32 v76, v3, v12, v11 bitop3:0xca
    v_lshrrev_b32 v11, 3, v11
    v_lshrrev_b32 v13, 2, v80
    v_bitop3_b32 v11, v5, v13, v11 bitop3:0xca
    v_and_b32 v80, 0x3fff, v11
    ds_add_u32 v80, v2
    v_cos_f32 v8, v8
    v_lshl_add_u32 v11, v77, 11, s40
    v_lshrrev_b32 v12, 3, v81
    v_lshlrev_b16 v13, 3, v81
    v_bitop3_b32 v12, v6, v13, v12 bitop3:0xca
    v_bitop3_b32 v77, v3, v12, v11 bitop3:0xca
    v_lshrrev_b32 v11, 3, v11
    v_lshrrev_b32 v13, 2, v81
    v_bitop3_b32 v11, v5, v13, v11 bitop3:0xca
    v_and_b32 v81, 0x3fff, v11
    ds_add_u32 v81, v2
    v_cvt_pk_bf16_f32 v64, v7, v8
    v_perm_b32 v12, v64, v64, s41
    v_bitop3_b32 v76, v4, v12, v76 bitop3:0xca
    v_perm_b32 v13, v64, v64, s42
    v_bitop3_b32 v77, v4, v13, v77 bitop3:0xca
    v_cos_f32 v9, v9
    v_lshl_add_u32 v11, v78, 11, s40
    v_lshrrev_b32 v12, 3, v82
    v_lshlrev_b16 v13, 3, v82
    v_bitop3_b32 v12, v6, v13, v12 bitop3:0xca
    v_bitop3_b32 v78, v3, v12, v11 bitop3:0xca
    v_lshrrev_b32 v11, 3, v11
    v_lshrrev_b32 v13, 2, v82
    v_bitop3_b32 v11, v5, v13, v11 bitop3:0xca
    v_and_b32 v82, 0x3fff, v11
    ds_add_u32 v82, v2
    v_cos_f32 v10, v10
    v_lshl_add_u32 v11, v79, 11, s40
    v_lshrrev_b32 v12, 3, v83
    v_lshlrev_b16 v13, 3, v83
    v_bitop3_b32 v12, v6, v13, v12 bitop3:0xca
    v_bitop3_b32 v79, v3, v12, v11 bitop3:0xca
    v_lshrrev_b32 v11, 3, v11
    v_lshrrev_b32 v13, 2, v83
    v_bitop3_b32 v11, v5, v13, v11 bitop3:0xca
    v_and_b32 v83, 0x3fff, v11
    ds_add_u32 v83, v2
    v_cvt_pk_bf16_f32 v65, v9, v10
    v_perm_b32 v12, v65, v65, s41
    v_bitop3_b32 v78, v4, v12, v78 bitop3:0xca
    v_perm_b32 v13, v65, v65, s42
    v_bitop3_b32 v79, v4, v13, v79 bitop3:0xca
    s_add_u32 s46, s35, 0x4e3c000
    buffer_store_dwordx4 v[28:31], v0, s[20:23], s46 offen sc1
    s_waitcnt vmcnt(14)
    v_lshlrev_b32 v7, 16, v66
    v_and_b32 v8, 0xffff0000, v66
    v_lshlrev_b32 v9, 16, v67
    v_and_b32 v10, 0xffff0000, v67
    v_mul_f32 v7, 0.15915494, v7
    v_mul_f32 v8, 0.15915494, v8
    v_mul_f32 v9, 0.15915494, v9
    v_mul_f32 v10, 0.15915494, v10
    v_cos_f32 v7, v7
    v_lshl_add_u32 v11, v88, 11, s40
    v_lshrrev_b32 v12, 3, v92
    v_lshlrev_b16 v13, 3, v92
    v_bitop3_b32 v12, v6, v13, v12 bitop3:0xca
    v_bitop3_b32 v88, v3, v12, v11 bitop3:0xca
    v_lshrrev_b32 v11, 3, v11
    v_lshrrev_b32 v13, 2, v92
    v_bitop3_b32 v11, v5, v13, v11 bitop3:0xca
    v_and_b32 v92, 0x3fff, v11
    ds_add_u32 v92, v2
    v_cos_f32 v8, v8
    v_lshl_add_u32 v11, v89, 11, s40
    v_lshrrev_b32 v12, 3, v93
    v_lshlrev_b16 v13, 3, v93
    v_bitop3_b32 v12, v6, v13, v12 bitop3:0xca
    v_bitop3_b32 v89, v3, v12, v11 bitop3:0xca
    v_lshrrev_b32 v11, 3, v11
    v_lshrrev_b32 v13, 2, v93
    v_bitop3_b32 v11, v5, v13, v11 bitop3:0xca
    v_and_b32 v93, 0x3fff, v11
    ds_add_u32 v93, v2
    v_cvt_pk_bf16_f32 v66, v7, v8
    v_perm_b32 v12, v66, v66, s41
    v_bitop3_b32 v88, v4, v12, v88 bitop3:0xca
    v_perm_b32 v13, v66, v66, s42
    v_bitop3_b32 v89, v4, v13, v89 bitop3:0xca
    v_cos_f32 v9, v9
    v_lshl_add_u32 v11, v90, 11, s40
    v_lshrrev_b32 v12, 3, v94
    v_lshlrev_b16 v13, 3, v94
    v_bitop3_b32 v12, v6, v13, v12 bitop3:0xca
    v_bitop3_b32 v90, v3, v12, v11 bitop3:0xca
    v_lshrrev_b32 v11, 3, v11
    v_lshrrev_b32 v13, 2, v94
    v_bitop3_b32 v11, v5, v13, v11 bitop3:0xca
    v_and_b32 v94, 0x3fff, v11
    ds_add_u32 v94, v2
    v_cos_f32 v10, v10
    v_lshl_add_u32 v11, v91, 11, s40
    v_lshrrev_b32 v12, 3, v95
    v_lshlrev_b16 v13, 3, v95
    v_bitop3_b32 v12, v6, v13, v12 bitop3:0xca
    v_bitop3_b32 v91, v3, v12, v11 bitop3:0xca
    v_lshrrev_b32 v11, 3, v11
    v_lshrrev_b32 v13, 2, v95
    v_bitop3_b32 v11, v5, v13, v11 bitop3:0xca
    v_and_b32 v95, 0x3fff, v11
    ds_add_u32 v95, v2
    v_cvt_pk_bf16_f32 v67, v9, v10
    v_perm_b32 v12, v67, v67, s41
    v_bitop3_b32 v90, v4, v12, v90 bitop3:0xca
    v_perm_b32 v13, v67, v67, s42
    v_bitop3_b32 v91, v4, v13, v91 bitop3:0xca
    s_add_u32 s47, s35, 0x4e40000
    buffer_store_dwordx4 v[32:35], v0, s[20:23], s47 offen sc1
    s_waitcnt vmcnt(11)
    v_lshlrev_b32 v7, 16, v84
    v_and_b32 v8, 0xffff0000, v84
    v_lshlrev_b32 v9, 16, v85
    v_and_b32 v10, 0xffff0000, v85
    v_mul_f32 v7, 0.15915494, v7
    v_mul_f32 v8, 0.15915494, v8
    v_mul_f32 v9, 0.15915494, v9
    v_mul_f32 v10, 0.15915494, v10
    v_cos_f32 v7, v7
    v_lshl_add_u32 v11, v96, 11, s40
    v_lshrrev_b32 v12, 3, v100
    v_lshlrev_b16 v13, 3, v100
    v_bitop3_b32 v12, v6, v13, v12 bitop3:0xca
    v_bitop3_b32 v96, v3, v12, v11 bitop3:0xca
    v_lshrrev_b32 v11, 3, v11
    v_lshrrev_b32 v13, 2, v100
    v_bitop3_b32 v11, v5, v13, v11 bitop3:0xca
    v_and_b32 v100, 0x3fff, v11
    ds_add_u32 v100, v2
    v_cos_f32 v8, v8
    v_lshl_add_u32 v11, v97, 11, s40
    v_lshrrev_b32 v12, 3, v101
    v_lshlrev_b16 v13, 3, v101
    v_bitop3_b32 v12, v6, v13, v12 bitop3:0xca
    v_bitop3_b32 v97, v3, v12, v11 bitop3:0xca
    v_lshrrev_b32 v11, 3, v11
    v_lshrrev_b32 v13, 2, v101
    v_bitop3_b32 v11, v5, v13, v11 bitop3:0xca
    v_and_b32 v101, 0x3fff, v11
    ds_add_u32 v101, v2
    v_cvt_pk_bf16_f32 v84, v7, v8
    v_perm_b32 v12, v84, v84, s41
    v_bitop3_b32 v96, v4, v12, v96 bitop3:0xca
    v_perm_b32 v13, v84, v84, s42
    v_bitop3_b32 v97, v4, v13, v97 bitop3:0xca
    v_cos_f32 v9, v9
    v_lshl_add_u32 v11, v98, 11, s40
    v_lshrrev_b32 v12, 3, v102
    v_lshlrev_b16 v13, 3, v102
    v_bitop3_b32 v12, v6, v13, v12 bitop3:0xca
    v_bitop3_b32 v98, v3, v12, v11 bitop3:0xca
    v_lshrrev_b32 v11, 3, v11
    v_lshrrev_b32 v13, 2, v102
    v_bitop3_b32 v11, v5, v13, v11 bitop3:0xca
    v_and_b32 v102, 0x3fff, v11
    ds_add_u32 v102, v2
    v_cos_f32 v10, v10
    v_lshl_add_u32 v11, v99, 11, s40
    v_lshrrev_b32 v12, 3, v103
    v_lshlrev_b16 v13, 3, v103
    v_bitop3_b32 v12, v6, v13, v12 bitop3:0xca
    v_bitop3_b32 v99, v3, v12, v11 bitop3:0xca
    v_lshrrev_b32 v11, 3, v11
    v_lshrrev_b32 v13, 2, v103
    v_bitop3_b32 v11, v5, v13, v11 bitop3:0xca
    v_and_b32 v103, 0x3fff, v11
    ds_add_u32 v103, v2
    v_cvt_pk_bf16_f32 v85, v9, v10
    v_perm_b32 v12, v85, v85, s41
    v_bitop3_b32 v98, v4, v12, v98 bitop3:0xca
    v_perm_b32 v13, v85, v85, s42
    v_bitop3_b32 v99, v4, v13, v99 bitop3:0xca
    s_add_u32 s44, s35, 0x4e44000
    buffer_store_dwordx4 v[124:127], v0, s[20:23], s44 offen sc1
    s_waitcnt vmcnt(8)
    v_lshlrev_b32 v7, 16, v86
    v_and_b32 v8, 0xffff0000, v86
    v_lshlrev_b32 v9, 16, v87
    v_and_b32 v10, 0xffff0000, v87
    v_mul_f32 v7, 0.15915494, v7
    v_mul_f32 v8, 0.15915494, v8
    v_mul_f32 v9, 0.15915494, v9
    v_mul_f32 v10, 0.15915494, v10
    v_cos_f32 v7, v7
    v_lshl_add_u32 v11, v108, 11, s40
    v_lshrrev_b32 v12, 3, v112
    v_lshlrev_b16 v13, 3, v112
    v_bitop3_b32 v12, v6, v13, v12 bitop3:0xca
    v_bitop3_b32 v108, v3, v12, v11 bitop3:0xca
    v_lshrrev_b32 v11, 3, v11
    v_lshrrev_b32 v13, 2, v112
    v_bitop3_b32 v11, v5, v13, v11 bitop3:0xca
    v_and_b32 v112, 0x3fff, v11
    ds_add_u32 v112, v2
    v_cos_f32 v8, v8
    v_lshl_add_u32 v11, v109, 11, s40
    v_lshrrev_b32 v12, 3, v113
    v_lshlrev_b16 v13, 3, v113
    v_bitop3_b32 v12, v6, v13, v12 bitop3:0xca
    v_bitop3_b32 v109, v3, v12, v11 bitop3:0xca
    v_lshrrev_b32 v11, 3, v11
    v_lshrrev_b32 v13, 2, v113
    v_bitop3_b32 v11, v5, v13, v11 bitop3:0xca
    v_and_b32 v113, 0x3fff, v11
    ds_add_u32 v113, v2
    v_cvt_pk_bf16_f32 v86, v7, v8
    v_perm_b32 v12, v86, v86, s41
    v_bitop3_b32 v108, v4, v12, v108 bitop3:0xca
    v_perm_b32 v13, v86, v86, s42
    v_bitop3_b32 v109, v4, v13, v109 bitop3:0xca
    v_cos_f32 v9, v9
    v_lshl_add_u32 v11, v110, 11, s40
    v_lshrrev_b32 v12, 3, v114
    v_lshlrev_b16 v13, 3, v114
    v_bitop3_b32 v12, v6, v13, v12 bitop3:0xca
    v_bitop3_b32 v110, v3, v12, v11 bitop3:0xca
    v_lshrrev_b32 v11, 3, v11
    v_lshrrev_b32 v13, 2, v114
    v_bitop3_b32 v11, v5, v13, v11 bitop3:0xca
    v_and_b32 v114, 0x3fff, v11
    ds_add_u32 v114, v2
    v_cos_f32 v10, v10
    v_lshl_add_u32 v11, v111, 11, s40
    v_lshrrev_b32 v12, 3, v115
    v_lshlrev_b16 v13, 3, v115
    v_bitop3_b32 v12, v6, v13, v12 bitop3:0xca
    v_bitop3_b32 v111, v3, v12, v11 bitop3:0xca
    v_lshrrev_b32 v11, 3, v11
    v_lshrrev_b32 v13, 2, v115
    v_bitop3_b32 v11, v5, v13, v11 bitop3:0xca
    v_and_b32 v115, 0x3fff, v11
    ds_add_u32 v115, v2
    v_cvt_pk_bf16_f32 v87, v9, v10
    v_perm_b32 v12, v87, v87, s41
    v_bitop3_b32 v110, v4, v12, v110 bitop3:0xca
    v_perm_b32 v13, v87, v87, s42
    v_bitop3_b32 v111, v4, v13, v111 bitop3:0xca
    v_lshrrev_b32 v8, 2, v0
    v_and_b32 v7, 0x3c00, v0
    v_bitop3_b32 v7, v5, v8, v7 bitop3:0xea
    s_waitcnt lgkmcnt(0)
    s_barrier
    ds_read2st64_b32 v[8:9], v7 offset0:0 offset1:1
    ds_read2st64_b32 v[10:11], v7 offset0:2 offset1:3
    s_add_u32 s45, s33, 0x7d00000
    buffer_load_dwordx4 v[116:119], v0, s[8:11], s45 offen nt
    s_waitcnt lgkmcnt(0)
    v_lshl_or_b32 v12, v9, 16, v8
    v_lshl_or_b32 v13, v11, 16, v10
    v_mov_b32 v14, v12
    v_mov_b32 v15, v13
    s_nop 0
    v_add_u32_dpp v14, v14, v14 row_shr:1 row_mask:0xf bank_mask:0xf bound_ctrl:1
    v_add_u32_dpp v15, v15, v15 row_shr:1 row_mask:0xf bank_mask:0xf bound_ctrl:1
    s_nop 0
    v_add_u32_dpp v14, v14, v14 row_shr:2 row_mask:0xf bank_mask:0xf bound_ctrl:1
    v_add_u32_dpp v15, v15, v15 row_shr:2 row_mask:0xf bank_mask:0xf bound_ctrl:1
    s_nop 0
    v_add_u32_dpp v14, v14, v14 row_shr:4 row_mask:0xf bank_mask:0xf bound_ctrl:1
    v_add_u32_dpp v15, v15, v15 row_shr:4 row_mask:0xf bank_mask:0xf bound_ctrl:1
    s_nop 0
    v_add_u32_dpp v14, v14, v14 row_shr:8 row_mask:0xf bank_mask:0xf bound_ctrl:1
    v_add_u32_dpp v15, v15, v15 row_shr:8 row_mask:0xf bank_mask:0xf bound_ctrl:1
    s_nop 0
    v_add_u32_dpp v14, v14, v14 row_bcast:15 row_mask:0xa bank_mask:0xf
    v_add_u32_dpp v15, v15, v15 row_bcast:15 row_mask:0xa bank_mask:0xf
    s_nop 0
    v_add_u32_dpp v14, v14, v14 row_bcast:31 row_mask:0xc bank_mask:0xf
    v_add_u32_dpp v15, v15, v15 row_bcast:31 row_mask:0xc bank_mask:0xf
    v_readlane_b32 s48, v14, 63
    v_readlane_b32 s49, v15, 63
    s_lshl_b32 s54, s32, 2
    v_mov_b32 v8, s54
    s_and_b32 s50, s48, 0xffff
    s_lshr_b32 s51, s48, 16
    s_and_b32 s52, s49, 0xffff
    s_lshr_b32 s53, s49, 16
    s_add_u32 s51, s51, s50
    s_add_u32 s52, s52, s51
    s_add_u32 s53, s53, s52
    v_mov_b32 v9, s53
    s_mov_b64 exec, 1
    ds_write_b32 v8, v9 offset:16384
    s_mov_b64 exec, -1
    v_and_b32 v8, 60, v7
    s_waitcnt lgkmcnt(0)
    s_barrier
    ds_read_b32 v9, v8 offset:16384
    s_waitcnt lgkmcnt(0)
    v_add_u32_dpp v9, v9, v9 row_shr:1 row_mask:0xf bank_mask:0xf bound_ctrl:1
    s_nop 1
    v_add_u32_dpp v9, v9, v9 row_shr:2 row_mask:0xf bank_mask:0xf bound_ctrl:1
    s_nop 1
    v_add_u32_dpp v9, v9, v9 row_shr:4 row_mask:0xf bank_mask:0xf bound_ctrl:1
    s_nop 1
    v_add_u32_dpp v9, v9, v9 row_shr:8 row_mask:0xf bank_mask:0xf bound_ctrl:1
    s_nop 0
    v_readlane_b32 s54, v9, s32
    s_sub_u32 s54, s54, s53
    s_add_u32 s50, s50, s54
    s_add_u32 s51, s51, s54
    s_add_u32 s52, s52, s54
    s_pack_ll_b32_b16 s48, s54, s50
    s_pack_ll_b32_b16 s49, s51, s52
    v_add_u32 v14, s48, v14
    v_add_u32 v15, s49, v15
    v_sub_u32 v12, v14, v12
    v_sub_u32 v13, v15, v13
    v_and_b32 v8, 0xffff, v12
    v_lshrrev_b32 v9, 16, v12
    v_and_b32 v10, 0xffff, v13
    v_lshrrev_b32 v11, 16, v13
    ds_write2st64_b32 v7, v8, v9 offset0:0 offset1:1
    ds_write2st64_b32 v7, v10, v11 offset0:2 offset1:3
    s_waitcnt lgkmcnt(0)
    s_barrier
    ds_add_rtn_u32 v40, v40, v2
    ds_add_rtn_u32 v41, v41, v2
    ds_add_rtn_u32 v42, v42, v2
    ds_add_rtn_u32 v43, v43, v2
    s_add_u32 s46, s36, 0x5f3700
    buffer_store_dwordx2 v[12:13], v1, s[24:27], s46 offen
    s_bitset0_b64 exec, 63
    s_not_b64 exec, exec
    buffer_store_dwordx2 v[14:15], v1, s[24:27], s46 offen offset:8
    s_mov_b64 exec, -1
    ds_add_rtn_u32 v52, v52, v2
    ds_add_rtn_u32 v53, v53, v2
    ds_add_rtn_u32 v54, v54, v2
    ds_add_rtn_u32 v55, v55, v2
    s_add_u32 s47, s33, 0x7d00000
    buffer_load_dwordx4 v[120:123], v0, s[12:15], s47 offen nt
    ds_add_rtn_u32 v60, v60, v2
    ds_add_rtn_u32 v61, v61, v2
    ds_add_rtn_u32 v62, v62, v2
    ds_add_rtn_u32 v63, v63, v2
    s_add_u32 s44, s34, 0x3e80000
    buffer_load_dwordx2 v[104:105], v1, s[16:19], s44 offen nt
    s_add_u32 s45, s34, 0x3e82000
    buffer_load_dwordx2 v[106:107], v1, s[16:19], s45 offen nt
    ds_add_rtn_u32 v72, v72, v2
    ds_add_rtn_u32 v73, v73, v2
    ds_add_rtn_u32 v74, v74, v2
    ds_add_rtn_u32 v75, v75, v2
    s_add_u32 s46, s33, 0x7d04000
    buffer_load_dwordx4 v[16:19], v0, s[8:11], s46 offen nt
    ds_add_rtn_u32 v80, v80, v2
    ds_add_rtn_u32 v81, v81, v2
    ds_add_rtn_u32 v82, v82, v2
    ds_add_rtn_u32 v83, v83, v2
    s_add_u32 s47, s33, 0x7d04000
    buffer_load_dwordx4 v[20:23], v0, s[12:15], s47 offen nt
    ds_add_rtn_u32 v92, v92, v2
    ds_add_rtn_u32 v93, v93, v2
    ds_add_rtn_u32 v94, v94, v2
    ds_add_rtn_u32 v95, v95, v2
    s_add_u32 s44, s33, 0x7d08000
    buffer_load_dwordx4 v[28:31], v0, s[8:11], s44 offen nt
    ds_add_rtn_u32 v100, v100, v2
    ds_add_rtn_u32 v101, v101, v2
    ds_add_rtn_u32 v102, v102, v2
    ds_add_rtn_u32 v103, v103, v2
    s_add_u32 s45, s33, 0x7d08000
    buffer_load_dwordx4 v[32:35], v0, s[12:15], s45 offen nt
    ds_add_rtn_u32 v112, v112, v2
    ds_add_rtn_u32 v113, v113, v2
    ds_add_rtn_u32 v114, v114, v2
    ds_add_rtn_u32 v115, v115, v2
    s_add_u32 s46, s34, 0x3e84000
    buffer_load_dwordx2 v[124:125], v1, s[16:19], s46 offen nt
    s_add_u32 s47, s34, 0x3e86000
    buffer_load_dwordx2 v[126:127], v1, s[16:19], s47 offen nt
    s_waitcnt lgkmcnt(0)
    s_barrier
    v_and_b32 v7, -4, v40
    v_lshl_add_u32 v8, v40, 2, v7
    ds_write_b32 v8, v36
    v_lshl_add_u32 v7, v7, 2, v40
    ds_write_b8 v7, v24 offset:16
    v_and_b32 v9, -4, v41
    v_lshl_add_u32 v10, v41, 2, v9
    ds_write_b32 v10, v37
    v_lshl_add_u32 v9, v9, 2, v41
    ds_write_b8_d16_hi v9, v24 offset:16
    v_and_b32 v7, -4, v42
    v_lshl_add_u32 v8, v42, 2, v7
    ds_write_b32 v8, v38
    v_lshl_add_u32 v7, v7, 2, v42
    ds_write_b8 v7, v25 offset:16
    v_and_b32 v9, -4, v43
    v_lshl_add_u32 v10, v43, 2, v9
    ds_write_b32 v10, v39
    v_lshl_add_u32 v9, v9, 2, v43
    ds_write_b8_d16_hi v9, v25 offset:16
    s_add_u32 s44, s33, 0x7d0c000
    buffer_load_dwordx4 v[36:39], v0, s[8:11], s44 offen nt
    s_add_u32 s45, s33, 0x7d0c000
    buffer_load_dwordx4 v[40:43], v0, s[12:15], s45 offen nt
    v_and_b32 v7, -4, v52
    v_lshl_add_u32 v8, v52, 2, v7
    ds_write_b32 v8, v48
    v_lshl_add_u32 v7, v7, 2, v52
    ds_write_b8 v7, v26 offset:16
    v_and_b32 v9, -4, v53
    v_lshl_add_u32 v10, v53, 2, v9
    ds_write_b32 v10, v49
    v_lshl_add_u32 v9, v9, 2, v53
    ds_write_b8_d16_hi v9, v26 offset:16
    v_and_b32 v7, -4, v54
    v_lshl_add_u32 v8, v54, 2, v7
    ds_write_b32 v8, v50
    v_lshl_add_u32 v7, v7, 2, v54
    ds_write_b8 v7, v27 offset:16
    v_and_b32 v9, -4, v55
    v_lshl_add_u32 v10, v55, 2, v9
    ds_write_b32 v10, v51
    v_lshl_add_u32 v9, v9, 2, v55
    ds_write_b8_d16_hi v9, v27 offset:16
    s_add_u32 s46, s33, 0x7d10000
    buffer_load_dwordx4 v[48:51], v0, s[8:11], s46 offen nt
    v_and_b32 v7, -4, v60
    v_lshl_add_u32 v8, v60, 2, v7
    ds_write_b32 v8, v56
    v_lshl_add_u32 v7, v7, 2, v60
    ds_write_b8 v7, v44 offset:16
    v_and_b32 v9, -4, v61
    v_lshl_add_u32 v10, v61, 2, v9
    ds_write_b32 v10, v57
    v_lshl_add_u32 v9, v9, 2, v61
    ds_write_b8_d16_hi v9, v44 offset:16
    v_and_b32 v7, -4, v62
    v_lshl_add_u32 v8, v62, 2, v7
    ds_write_b32 v8, v58
    v_lshl_add_u32 v7, v7, 2, v62
    ds_write_b8 v7, v45 offset:16
    v_and_b32 v9, -4, v63
    v_lshl_add_u32 v10, v63, 2, v9
    ds_write_b32 v10, v59
    v_lshl_add_u32 v9, v9, 2, v63
    ds_write_b8_d16_hi v9, v45 offset:16
    s_add_u32 s47, s33, 0x7d10000
    buffer_load_dwordx4 v[52:55], v0, s[12:15], s47 offen nt
    v_and_b32 v7, -4, v72
    v_lshl_add_u32 v8, v72, 2, v7
    ds_write_b32 v8, v68
    v_lshl_add_u32 v7, v7, 2, v72
    ds_write_b8 v7, v46 offset:16
    v_and_b32 v9, -4, v73
    v_lshl_add_u32 v10, v73, 2, v9
    ds_write_b32 v10, v69
    v_lshl_add_u32 v9, v9, 2, v73
    ds_write_b8_d16_hi v9, v46 offset:16
    v_and_b32 v7, -4, v74
    v_lshl_add_u32 v8, v74, 2, v7
    ds_write_b32 v8, v70
    v_lshl_add_u32 v7, v7, 2, v74
    ds_write_b8 v7, v47 offset:16
    v_and_b32 v9, -4, v75
    v_lshl_add_u32 v10, v75, 2, v9
    ds_write_b32 v10, v71
    v_lshl_add_u32 v9, v9, 2, v75
    ds_write_b8_d16_hi v9, v47 offset:16
    s_add_u32 s44, s34, 0x3e88000
    buffer_load_dwordx2 v[24:25], v1, s[16:19], s44 offen nt
    s_add_u32 s45, s34, 0x3e8a000
    buffer_load_dwordx2 v[26:27], v1, s[16:19], s45 offen nt
    v_and_b32 v7, -4, v80
    v_lshl_add_u32 v8, v80, 2, v7
    ds_write_b32 v8, v76
    v_lshl_add_u32 v7, v7, 2, v80
    ds_write_b8 v7, v64 offset:16
    v_and_b32 v9, -4, v81
    v_lshl_add_u32 v10, v81, 2, v9
    ds_write_b32 v10, v77
    v_lshl_add_u32 v9, v9, 2, v81
    ds_write_b8_d16_hi v9, v64 offset:16
    v_and_b32 v7, -4, v82
    v_lshl_add_u32 v8, v82, 2, v7
    ds_write_b32 v8, v78
    v_lshl_add_u32 v7, v7, 2, v82
    ds_write_b8 v7, v65 offset:16
    v_and_b32 v9, -4, v83
    v_lshl_add_u32 v10, v83, 2, v9
    ds_write_b32 v10, v79
    v_lshl_add_u32 v9, v9, 2, v83
    ds_write_b8_d16_hi v9, v65 offset:16
    s_add_u32 s46, s33, 0x7d14000
    buffer_load_dwordx4 v[56:59], v0, s[8:11], s46 offen nt
    s_add_u32 s47, s33, 0x7d14000
    buffer_load_dwordx4 v[60:63], v0, s[12:15], s47 offen nt
    v_and_b32 v7, -4, v92
    v_lshl_add_u32 v8, v92, 2, v7
    ds_write_b32 v8, v88
    v_lshl_add_u32 v7, v7, 2, v92
    ds_write_b8 v7, v66 offset:16
    v_and_b32 v9, -4, v93
    v_lshl_add_u32 v10, v93, 2, v9
    ds_write_b32 v10, v89
    v_lshl_add_u32 v9, v9, 2, v93
    ds_write_b8_d16_hi v9, v66 offset:16
    v_and_b32 v7, -4, v94
    v_lshl_add_u32 v8, v94, 2, v7
    ds_write_b32 v8, v90
    v_lshl_add_u32 v7, v7, 2, v94
    ds_write_b8 v7, v67 offset:16
    v_and_b32 v9, -4, v95
    v_lshl_add_u32 v10, v95, 2, v9
    ds_write_b32 v10, v91
    v_lshl_add_u32 v9, v9, 2, v95
    ds_write_b8_d16_hi v9, v67 offset:16
    s_add_u32 s44, s33, 0x7d18000
    buffer_load_dwordx4 v[68:71], v0, s[8:11], s44 offen nt
    v_and_b32 v7, -4, v100
    v_lshl_add_u32 v8, v100, 2, v7
    ds_write_b32 v8, v96
    v_lshl_add_u32 v7, v7, 2, v100
    ds_write_b8 v7, v84 offset:16
    v_and_b32 v9, -4, v101
    v_lshl_add_u32 v10, v101, 2, v9
    ds_write_b32 v10, v97
    v_lshl_add_u32 v9, v9, 2, v101
    ds_write_b8_d16_hi v9, v84 offset:16
    v_and_b32 v7, -4, v102
    v_lshl_add_u32 v8, v102, 2, v7
    ds_write_b32 v8, v98
    v_lshl_add_u32 v7, v7, 2, v102
    ds_write_b8 v7, v85 offset:16
    v_and_b32 v9, -4, v103
    v_lshl_add_u32 v10, v103, 2, v9
    ds_write_b32 v10, v99
    v_lshl_add_u32 v9, v9, 2, v103
    ds_write_b8_d16_hi v9, v85 offset:16
    s_add_u32 s45, s33, 0x7d18000
    buffer_load_dwordx4 v[72:75], v0, s[12:15], s45 offen nt
    v_and_b32 v7, -4, v112
    v_lshl_add_u32 v8, v112, 2, v7
    ds_write_b32 v8, v108
    v_lshl_add_u32 v7, v7, 2, v112
    ds_write_b8 v7, v86 offset:16
    v_and_b32 v9, -4, v113
    v_lshl_add_u32 v10, v113, 2, v9
    ds_write_b32 v10, v109
    v_lshl_add_u32 v9, v9, 2, v113
    ds_write_b8_d16_hi v9, v86 offset:16
    v_and_b32 v7, -4, v114
    v_lshl_add_u32 v8, v114, 2, v7
    ds_write_b32 v8, v110
    v_lshl_add_u32 v7, v7, 2, v114
    ds_write_b8 v7, v87 offset:16
    v_and_b32 v9, -4, v115
    v_lshl_add_u32 v10, v115, 2, v9
    ds_write_b32 v10, v111
    v_lshl_add_u32 v9, v9, 2, v115
    ds_write_b8_d16_hi v9, v87 offset:16
    s_add_u32 s46, s34, 0x3e8c000
    buffer_load_dwordx2 v[44:45], v1, s[16:19], s46 offen nt
    s_add_u32 s47, s34, 0x3e8e000
    buffer_load_dwordx2 v[46:47], v1, s[16:19], s47 offen nt
    v_add_u32 v7, 0x10000, v0
    v_add_u32 v12, 0x20000, v0
    v_mov_b32 v8, 0
    v_mov_b32 v9, 0
    v_mov_b32 v10, 0
    v_mov_b32 v11, 0
    s_waitcnt lgkmcnt(0)
    s_barrier
    ds_read_b128 v[76:79], v0 offset:0
    ds_write_b128 v0, v[8:11]
    ds_read_b128 v[80:83], v0 offset:16384
    ds_read_b128 v[88:91], v0 offset:32768
    ds_read_b128 v[92:95], v0 offset:49152
    ds_read_b128 v[64:67], v7 offset:0
    ds_read_b128 v[96:99], v7 offset:16384
    ds_read_b128 v[100:103], v7 offset:32768
    ds_read_b128 v[108:111], v7 offset:49152
    ds_read_b128 v[112:115], v12 offset:0
    ds_read_b128 v[84:87], v12 offset:16384
    s_waitcnt lgkmcnt(0)
    s_barrier
    s_add_u32 s44, s35, 0x7530000
    buffer_store_dwordx4 v[76:79], v0, s[20:23], s44 offen sc1
    s_add_u32 s45, s35, 0x7534000
    buffer_store_dwordx4 v[80:83], v0, s[20:23], s45 offen sc1
    s_add_u32 s46, s33, 0x7d1c000
    buffer_load_dwordx4 v[76:79], v0, s[8:11], s46 offen nt
    s_add_u32 s47, s33, 0x7d1c000
    buffer_load_dwordx4 v[80:83], v0, s[12:15], s47 offen nt
    s_add_u32 s44, s35, 0x7538000
    buffer_store_dwordx4 v[88:91], v0, s[20:23], s44 offen sc1
    s_waitcnt vmcnt(23)
    v_lshlrev_b32 v7, 16, v104
    v_and_b32 v8, 0xffff0000, v104
    v_lshlrev_b32 v9, 16, v105
    v_and_b32 v10, 0xffff0000, v105
    v_mul_f32 v7, 0.15915494, v7
    v_mul_f32 v8, 0.15915494, v8
    v_mul_f32 v9, 0.15915494, v9
    v_mul_f32 v10, 0.15915494, v10
    v_cos_f32 v7, v7
    v_lshl_add_u32 v11, v116, 11, s40
    v_lshrrev_b32 v12, 3, v120
    v_lshlrev_b16 v13, 3, v120
    v_bitop3_b32 v12, v6, v13, v12 bitop3:0xca
    v_bitop3_b32 v116, v3, v12, v11 bitop3:0xca
    v_lshrrev_b32 v11, 3, v11
    v_lshrrev_b32 v13, 2, v120
    v_bitop3_b32 v11, v5, v13, v11 bitop3:0xca
    v_and_b32 v120, 0x3fff, v11
    ds_add_u32 v120, v2
    v_cos_f32 v8, v8
    v_lshl_add_u32 v11, v117, 11, s40
    v_lshrrev_b32 v12, 3, v121
    v_lshlrev_b16 v13, 3, v121
    v_bitop3_b32 v12, v6, v13, v12 bitop3:0xca
    v_bitop3_b32 v117, v3, v12, v11 bitop3:0xca
    v_lshrrev_b32 v11, 3, v11
    v_lshrrev_b32 v13, 2, v121
    v_bitop3_b32 v11, v5, v13, v11 bitop3:0xca
    v_and_b32 v121, 0x3fff, v11
    ds_add_u32 v121, v2
    v_cvt_pk_bf16_f32 v104, v7, v8
    v_perm_b32 v12, v104, v104, s41
    v_bitop3_b32 v116, v4, v12, v116 bitop3:0xca
    v_perm_b32 v13, v104, v104, s42
    v_bitop3_b32 v117, v4, v13, v117 bitop3:0xca
    v_cos_f32 v9, v9
    v_lshl_add_u32 v11, v118, 11, s40
    v_lshrrev_b32 v12, 3, v122
    v_lshlrev_b16 v13, 3, v122
    v_bitop3_b32 v12, v6, v13, v12 bitop3:0xca
    v_bitop3_b32 v118, v3, v12, v11 bitop3:0xca
    v_lshrrev_b32 v11, 3, v11
    v_lshrrev_b32 v13, 2, v122
    v_bitop3_b32 v11, v5, v13, v11 bitop3:0xca
    v_and_b32 v122, 0x3fff, v11
    ds_add_u32 v122, v2
    v_cos_f32 v10, v10
    v_lshl_add_u32 v11, v119, 11, s40
    v_lshrrev_b32 v12, 3, v123
    v_lshlrev_b16 v13, 3, v123
    v_bitop3_b32 v12, v6, v13, v12 bitop3:0xca
    v_bitop3_b32 v119, v3, v12, v11 bitop3:0xca
    v_lshrrev_b32 v11, 3, v11
    v_lshrrev_b32 v13, 2, v123
    v_bitop3_b32 v11, v5, v13, v11 bitop3:0xca
    v_and_b32 v123, 0x3fff, v11
    ds_add_u32 v123, v2
    v_cvt_pk_bf16_f32 v105, v9, v10
    v_perm_b32 v12, v105, v105, s41
    v_bitop3_b32 v118, v4, v12, v118 bitop3:0xca
    v_perm_b32 v13, v105, v105, s42
    v_bitop3_b32 v119, v4, v13, v119 bitop3:0xca
    s_add_u32 s45, s35, 0x753c000
    buffer_store_dwordx4 v[92:95], v0, s[20:23], s45 offen sc1
    s_waitcnt vmcnt(22)
    v_lshlrev_b32 v7, 16, v106
    v_and_b32 v8, 0xffff0000, v106
    v_lshlrev_b32 v9, 16, v107
    v_and_b32 v10, 0xffff0000, v107
    v_mul_f32 v7, 0.15915494, v7
    v_mul_f32 v8, 0.15915494, v8
    v_mul_f32 v9, 0.15915494, v9
    v_mul_f32 v10, 0.15915494, v10
    v_cos_f32 v7, v7
    v_lshl_add_u32 v11, v16, 11, s40
    v_lshrrev_b32 v12, 3, v20
    v_lshlrev_b16 v13, 3, v20
    v_bitop3_b32 v12, v6, v13, v12 bitop3:0xca
    v_bitop3_b32 v16, v3, v12, v11 bitop3:0xca
    v_lshrrev_b32 v11, 3, v11
    v_lshrrev_b32 v13, 2, v20
    v_bitop3_b32 v11, v5, v13, v11 bitop3:0xca
    v_and_b32 v20, 0x3fff, v11
    ds_add_u32 v20, v2
    v_cos_f32 v8, v8
    v_lshl_add_u32 v11, v17, 11, s40
    v_lshrrev_b32 v12, 3, v21
    v_lshlrev_b16 v13, 3, v21
    v_bitop3_b32 v12, v6, v13, v12 bitop3:0xca
    v_bitop3_b32 v17, v3, v12, v11 bitop3:0xca
    v_lshrrev_b32 v11, 3, v11
    v_lshrrev_b32 v13, 2, v21
    v_bitop3_b32 v11, v5, v13, v11 bitop3:0xca
    v_and_b32 v21, 0x3fff, v11
    ds_add_u32 v21, v2
    v_cvt_pk_bf16_f32 v106, v7, v8
    v_perm_b32 v12, v106, v106, s41
    v_bitop3_b32 v16, v4, v12, v16 bitop3:0xca
    v_perm_b32 v13, v106, v106, s42
    v_bitop3_b32 v17, v4, v13, v17 bitop3:0xca
    v_cos_f32 v9, v9
    v_lshl_add_u32 v11, v18, 11, s40
    v_lshrrev_b32 v12, 3, v22
    v_lshlrev_b16 v13, 3, v22
    v_bitop3_b32 v12, v6, v13, v12 bitop3:0xca
    v_bitop3_b32 v18, v3, v12, v11 bitop3:0xca
    v_lshrrev_b32 v11, 3, v11
    v_lshrrev_b32 v13, 2, v22
    v_bitop3_b32 v11, v5, v13, v11 bitop3:0xca
    v_and_b32 v22, 0x3fff, v11
    ds_add_u32 v22, v2
    v_cos_f32 v10, v10
    v_lshl_add_u32 v11, v19, 11, s40
    v_lshrrev_b32 v12, 3, v23
    v_lshlrev_b16 v13, 3, v23
    v_bitop3_b32 v12, v6, v13, v12 bitop3:0xca
    v_bitop3_b32 v19, v3, v12, v11 bitop3:0xca
    v_lshrrev_b32 v11, 3, v11
    v_lshrrev_b32 v13, 2, v23
    v_bitop3_b32 v11, v5, v13, v11 bitop3:0xca
    v_and_b32 v23, 0x3fff, v11
    ds_add_u32 v23, v2
    v_cvt_pk_bf16_f32 v107, v9, v10
    v_perm_b32 v12, v107, v107, s41
    v_bitop3_b32 v18, v4, v12, v18 bitop3:0xca
    v_perm_b32 v13, v107, v107, s42
    v_bitop3_b32 v19, v4, v13, v19 bitop3:0xca
    s_add_u32 s46, s35, 0x7540000
    buffer_store_dwordx4 v[64:67], v0, s[20:23], s46 offen sc1
    s_waitcnt vmcnt(19)
    v_lshlrev_b32 v7, 16, v124
    v_and_b32 v8, 0xffff0000, v124
    v_lshlrev_b32 v9, 16, v125
    v_and_b32 v10, 0xffff0000, v125
    v_mul_f32 v7, 0.15915494, v7
    v_mul_f32 v8, 0.15915494, v8
    v_mul_f32 v9, 0.15915494, v9
    v_mul_f32 v10, 0.15915494, v10
    v_cos_f32 v7, v7
    v_lshl_add_u32 v11, v28, 11, s40
    v_lshrrev_b32 v12, 3, v32
    v_lshlrev_b16 v13, 3, v32
    v_bitop3_b32 v12, v6, v13, v12 bitop3:0xca
    v_bitop3_b32 v28, v3, v12, v11 bitop3:0xca
    v_lshrrev_b32 v11, 3, v11
    v_lshrrev_b32 v13, 2, v32
    v_bitop3_b32 v11, v5, v13, v11 bitop3:0xca
    v_and_b32 v32, 0x3fff, v11
    ds_add_u32 v32, v2
    v_cos_f32 v8, v8
    v_lshl_add_u32 v11, v29, 11, s40
    v_lshrrev_b32 v12, 3, v33
    v_lshlrev_b16 v13, 3, v33
    v_bitop3_b32 v12, v6, v13, v12 bitop3:0xca
    v_bitop3_b32 v29, v3, v12, v11 bitop3:0xca
    v_lshrrev_b32 v11, 3, v11
    v_lshrrev_b32 v13, 2, v33
    v_bitop3_b32 v11, v5, v13, v11 bitop3:0xca
    v_and_b32 v33, 0x3fff, v11
    ds_add_u32 v33, v2
    v_cvt_pk_bf16_f32 v124, v7, v8
    v_perm_b32 v12, v124, v124, s41
    v_bitop3_b32 v28, v4, v12, v28 bitop3:0xca
    v_perm_b32 v13, v124, v124, s42
    v_bitop3_b32 v29, v4, v13, v29 bitop3:0xca
    v_cos_f32 v9, v9
    v_lshl_add_u32 v11, v30, 11, s40
    v_lshrrev_b32 v12, 3, v34
    v_lshlrev_b16 v13, 3, v34
    v_bitop3_b32 v12, v6, v13, v12 bitop3:0xca
    v_bitop3_b32 v30, v3, v12, v11 bitop3:0xca
    v_lshrrev_b32 v11, 3, v11
    v_lshrrev_b32 v13, 2, v34
    v_bitop3_b32 v11, v5, v13, v11 bitop3:0xca
    v_and_b32 v34, 0x3fff, v11
    ds_add_u32 v34, v2
    v_cos_f32 v10, v10
    v_lshl_add_u32 v11, v31, 11, s40
    v_lshrrev_b32 v12, 3, v35
    v_lshlrev_b16 v13, 3, v35
    v_bitop3_b32 v12, v6, v13, v12 bitop3:0xca
    v_bitop3_b32 v31, v3, v12, v11 bitop3:0xca
    v_lshrrev_b32 v11, 3, v11
    v_lshrrev_b32 v13, 2, v35
    v_bitop3_b32 v11, v5, v13, v11 bitop3:0xca
    v_and_b32 v35, 0x3fff, v11
    ds_add_u32 v35, v2
    v_cvt_pk_bf16_f32 v125, v9, v10
    v_perm_b32 v12, v125, v125, s41
    v_bitop3_b32 v30, v4, v12, v30 bitop3:0xca
    v_perm_b32 v13, v125, v125, s42
    v_bitop3_b32 v31, v4, v13, v31 bitop3:0xca
    s_add_u32 s47, s35, 0x7544000
    buffer_store_dwordx4 v[96:99], v0, s[20:23], s47 offen sc1
    s_waitcnt vmcnt(18)
    v_lshlrev_b32 v7, 16, v126
    v_and_b32 v8, 0xffff0000, v126
    v_lshlrev_b32 v9, 16, v127
    v_and_b32 v10, 0xffff0000, v127
    v_mul_f32 v7, 0.15915494, v7
    v_mul_f32 v8, 0.15915494, v8
    v_mul_f32 v9, 0.15915494, v9
    v_mul_f32 v10, 0.15915494, v10
    v_cos_f32 v7, v7
    v_lshl_add_u32 v11, v36, 11, s40
    v_lshrrev_b32 v12, 3, v40
    v_lshlrev_b16 v13, 3, v40
    v_bitop3_b32 v12, v6, v13, v12 bitop3:0xca
    v_bitop3_b32 v36, v3, v12, v11 bitop3:0xca
    v_lshrrev_b32 v11, 3, v11
    v_lshrrev_b32 v13, 2, v40
    v_bitop3_b32 v11, v5, v13, v11 bitop3:0xca
    v_and_b32 v40, 0x3fff, v11
    ds_add_u32 v40, v2
    v_cos_f32 v8, v8
    v_lshl_add_u32 v11, v37, 11, s40
    v_lshrrev_b32 v12, 3, v41
    v_lshlrev_b16 v13, 3, v41
    v_bitop3_b32 v12, v6, v13, v12 bitop3:0xca
    v_bitop3_b32 v37, v3, v12, v11 bitop3:0xca
    v_lshrrev_b32 v11, 3, v11
    v_lshrrev_b32 v13, 2, v41
    v_bitop3_b32 v11, v5, v13, v11 bitop3:0xca
    v_and_b32 v41, 0x3fff, v11
    ds_add_u32 v41, v2
    v_cvt_pk_bf16_f32 v126, v7, v8
    v_perm_b32 v12, v126, v126, s41
    v_bitop3_b32 v36, v4, v12, v36 bitop3:0xca
    v_perm_b32 v13, v126, v126, s42
    v_bitop3_b32 v37, v4, v13, v37 bitop3:0xca
    v_cos_f32 v9, v9
    v_lshl_add_u32 v11, v38, 11, s40
    v_lshrrev_b32 v12, 3, v42
    v_lshlrev_b16 v13, 3, v42
    v_bitop3_b32 v12, v6, v13, v12 bitop3:0xca
    v_bitop3_b32 v38, v3, v12, v11 bitop3:0xca
    v_lshrrev_b32 v11, 3, v11
    v_lshrrev_b32 v13, 2, v42
    v_bitop3_b32 v11, v5, v13, v11 bitop3:0xca
    v_and_b32 v42, 0x3fff, v11
    ds_add_u32 v42, v2
    v_cos_f32 v10, v10
    v_lshl_add_u32 v11, v39, 11, s40
    v_lshrrev_b32 v12, 3, v43
    v_lshlrev_b16 v13, 3, v43
    v_bitop3_b32 v12, v6, v13, v12 bitop3:0xca
    v_bitop3_b32 v39, v3, v12, v11 bitop3:0xca
    v_lshrrev_b32 v11, 3, v11
    v_lshrrev_b32 v13, 2, v43
    v_bitop3_b32 v11, v5, v13, v11 bitop3:0xca
    v_and_b32 v43, 0x3fff, v11
    ds_add_u32 v43, v2
    v_cvt_pk_bf16_f32 v127, v9, v10
    v_perm_b32 v12, v127, v127, s41
    v_bitop3_b32 v38, v4, v12, v38 bitop3:0xca
    v_perm_b32 v13, v127, v127, s42
    v_bitop3_b32 v39, v4, v13, v39 bitop3:0xca
    s_add_u32 s44, s35, 0x7548000
    buffer_store_dwordx4 v[100:103], v0, s[20:23], s44 offen sc1
    s_waitcnt vmcnt(15)
    v_lshlrev_b32 v7, 16, v24
    v_and_b32 v8, 0xffff0000, v24
    v_lshlrev_b32 v9, 16, v25
    v_and_b32 v10, 0xffff0000, v25
    v_mul_f32 v7, 0.15915494, v7
    v_mul_f32 v8, 0.15915494, v8
    v_mul_f32 v9, 0.15915494, v9
    v_mul_f32 v10, 0.15915494, v10
    v_cos_f32 v7, v7
    v_lshl_add_u32 v11, v48, 11, s40
    v_lshrrev_b32 v12, 3, v52
    v_lshlrev_b16 v13, 3, v52
    v_bitop3_b32 v12, v6, v13, v12 bitop3:0xca
    v_bitop3_b32 v48, v3, v12, v11 bitop3:0xca
    v_lshrrev_b32 v11, 3, v11
    v_lshrrev_b32 v13, 2, v52
    v_bitop3_b32 v11, v5, v13, v11 bitop3:0xca
    v_and_b32 v52, 0x3fff, v11
    ds_add_u32 v52, v2
    v_cos_f32 v8, v8
    v_lshl_add_u32 v11, v49, 11, s40
    v_lshrrev_b32 v12, 3, v53
    v_lshlrev_b16 v13, 3, v53
    v_bitop3_b32 v12, v6, v13, v12 bitop3:0xca
    v_bitop3_b32 v49, v3, v12, v11 bitop3:0xca
    v_lshrrev_b32 v11, 3, v11
    v_lshrrev_b32 v13, 2, v53
    v_bitop3_b32 v11, v5, v13, v11 bitop3:0xca
    v_and_b32 v53, 0x3fff, v11
    ds_add_u32 v53, v2
    v_cvt_pk_bf16_f32 v24, v7, v8
    v_perm_b32 v12, v24, v24, s41
    v_bitop3_b32 v48, v4, v12, v48 bitop3:0xca
    v_perm_b32 v13, v24, v24, s42
    v_bitop3_b32 v49, v4, v13, v49 bitop3:0xca
    v_cos_f32 v9, v9
    v_lshl_add_u32 v11, v50, 11, s40
    v_lshrrev_b32 v12, 3, v54
    v_lshlrev_b16 v13, 3, v54
    v_bitop3_b32 v12, v6, v13, v12 bitop3:0xca
    v_bitop3_b32 v50, v3, v12, v11 bitop3:0xca
    v_lshrrev_b32 v11, 3, v11
    v_lshrrev_b32 v13, 2, v54
    v_bitop3_b32 v11, v5, v13, v11 bitop3:0xca
    v_and_b32 v54, 0x3fff, v11
    ds_add_u32 v54, v2
    v_cos_f32 v10, v10
    v_lshl_add_u32 v11, v51, 11, s40
    v_lshrrev_b32 v12, 3, v55
    v_lshlrev_b16 v13, 3, v55
    v_bitop3_b32 v12, v6, v13, v12 bitop3:0xca
    v_bitop3_b32 v51, v3, v12, v11 bitop3:0xca
    v_lshrrev_b32 v11, 3, v11
    v_lshrrev_b32 v13, 2, v55
    v_bitop3_b32 v11, v5, v13, v11 bitop3:0xca
    v_and_b32 v55, 0x3fff, v11
    ds_add_u32 v55, v2
    v_cvt_pk_bf16_f32 v25, v9, v10
    v_perm_b32 v12, v25, v25, s41
    v_bitop3_b32 v50, v4, v12, v50 bitop3:0xca
    v_perm_b32 v13, v25, v25, s42
    v_bitop3_b32 v51, v4, v13, v51 bitop3:0xca
    s_add_u32 s45, s35, 0x754c000
    buffer_store_dwordx4 v[108:111], v0, s[20:23], s45 offen sc1
    s_waitcnt vmcnt(14)
    v_lshlrev_b32 v7, 16, v26
    v_and_b32 v8, 0xffff0000, v26
    v_lshlrev_b32 v9, 16, v27
    v_and_b32 v10, 0xffff0000, v27
    v_mul_f32 v7, 0.15915494, v7
    v_mul_f32 v8, 0.15915494, v8
    v_mul_f32 v9, 0.15915494, v9
    v_mul_f32 v10, 0.15915494, v10
    v_cos_f32 v7, v7
    v_lshl_add_u32 v11, v56, 11, s40
    v_lshrrev_b32 v12, 3, v60
    v_lshlrev_b16 v13, 3, v60
    v_bitop3_b32 v12, v6, v13, v12 bitop3:0xca
    v_bitop3_b32 v56, v3, v12, v11 bitop3:0xca
    v_lshrrev_b32 v11, 3, v11
    v_lshrrev_b32 v13, 2, v60
    v_bitop3_b32 v11, v5, v13, v11 bitop3:0xca
    v_and_b32 v60, 0x3fff, v11
    ds_add_u32 v60, v2
    v_cos_f32 v8, v8
    v_lshl_add_u32 v11, v57, 11, s40
    v_lshrrev_b32 v12, 3, v61
    v_lshlrev_b16 v13, 3, v61
    v_bitop3_b32 v12, v6, v13, v12 bitop3:0xca
    v_bitop3_b32 v57, v3, v12, v11 bitop3:0xca
    v_lshrrev_b32 v11, 3, v11
    v_lshrrev_b32 v13, 2, v61
    v_bitop3_b32 v11, v5, v13, v11 bitop3:0xca
    v_and_b32 v61, 0x3fff, v11
    ds_add_u32 v61, v2
    v_cvt_pk_bf16_f32 v26, v7, v8
    v_perm_b32 v12, v26, v26, s41
    v_bitop3_b32 v56, v4, v12, v56 bitop3:0xca
    v_perm_b32 v13, v26, v26, s42
    v_bitop3_b32 v57, v4, v13, v57 bitop3:0xca
    v_cos_f32 v9, v9
    v_lshl_add_u32 v11, v58, 11, s40
    v_lshrrev_b32 v12, 3, v62
    v_lshlrev_b16 v13, 3, v62
    v_bitop3_b32 v12, v6, v13, v12 bitop3:0xca
    v_bitop3_b32 v58, v3, v12, v11 bitop3:0xca
    v_lshrrev_b32 v11, 3, v11
    v_lshrrev_b32 v13, 2, v62
    v_bitop3_b32 v11, v5, v13, v11 bitop3:0xca
    v_and_b32 v62, 0x3fff, v11
    ds_add_u32 v62, v2
    v_cos_f32 v10, v10
    v_lshl_add_u32 v11, v59, 11, s40
    v_lshrrev_b32 v12, 3, v63
    v_lshlrev_b16 v13, 3, v63
    v_bitop3_b32 v12, v6, v13, v12 bitop3:0xca
    v_bitop3_b32 v59, v3, v12, v11 bitop3:0xca
    v_lshrrev_b32 v11, 3, v11
    v_lshrrev_b32 v13, 2, v63
    v_bitop3_b32 v11, v5, v13, v11 bitop3:0xca
    v_and_b32 v63, 0x3fff, v11
    ds_add_u32 v63, v2
    v_cvt_pk_bf16_f32 v27, v9, v10
    v_perm_b32 v12, v27, v27, s41
    v_bitop3_b32 v58, v4, v12, v58 bitop3:0xca
    v_perm_b32 v13, v27, v27, s42
    v_bitop3_b32 v59, v4, v13, v59 bitop3:0xca
    s_add_u32 s46, s35, 0x7550000
    buffer_store_dwordx4 v[112:115], v0, s[20:23], s46 offen sc1
    s_waitcnt vmcnt(11)
    v_lshlrev_b32 v7, 16, v44
    v_and_b32 v8, 0xffff0000, v44
    v_lshlrev_b32 v9, 16, v45
    v_and_b32 v10, 0xffff0000, v45
    v_mul_f32 v7, 0.15915494, v7
    v_mul_f32 v8, 0.15915494, v8
    v_mul_f32 v9, 0.15915494, v9
    v_mul_f32 v10, 0.15915494, v10
    v_cos_f32 v7, v7
    v_lshl_add_u32 v11, v68, 11, s40
    v_lshrrev_b32 v12, 3, v72
    v_lshlrev_b16 v13, 3, v72
    v_bitop3_b32 v12, v6, v13, v12 bitop3:0xca
    v_bitop3_b32 v68, v3, v12, v11 bitop3:0xca
    v_lshrrev_b32 v11, 3, v11
    v_lshrrev_b32 v13, 2, v72
    v_bitop3_b32 v11, v5, v13, v11 bitop3:0xca
    v_and_b32 v72, 0x3fff, v11
    ds_add_u32 v72, v2
    v_cos_f32 v8, v8
    v_lshl_add_u32 v11, v69, 11, s40
    v_lshrrev_b32 v12, 3, v73
    v_lshlrev_b16 v13, 3, v73
    v_bitop3_b32 v12, v6, v13, v12 bitop3:0xca
    v_bitop3_b32 v69, v3, v12, v11 bitop3:0xca
    v_lshrrev_b32 v11, 3, v11
    v_lshrrev_b32 v13, 2, v73
    v_bitop3_b32 v11, v5, v13, v11 bitop3:0xca
    v_and_b32 v73, 0x3fff, v11
    ds_add_u32 v73, v2
    v_cvt_pk_bf16_f32 v44, v7, v8
    v_perm_b32 v12, v44, v44, s41
    v_bitop3_b32 v68, v4, v12, v68 bitop3:0xca
    v_perm_b32 v13, v44, v44, s42
    v_bitop3_b32 v69, v4, v13, v69 bitop3:0xca
    v_cos_f32 v9, v9
    v_lshl_add_u32 v11, v70, 11, s40
    v_lshrrev_b32 v12, 3, v74
    v_lshlrev_b16 v13, 3, v74
    v_bitop3_b32 v12, v6, v13, v12 bitop3:0xca
    v_bitop3_b32 v70, v3, v12, v11 bitop3:0xca
    v_lshrrev_b32 v11, 3, v11
    v_lshrrev_b32 v13, 2, v74
    v_bitop3_b32 v11, v5, v13, v11 bitop3:0xca
    v_and_b32 v74, 0x3fff, v11
    ds_add_u32 v74, v2
    v_cos_f32 v10, v10
    v_lshl_add_u32 v11, v71, 11, s40
    v_lshrrev_b32 v12, 3, v75
    v_lshlrev_b16 v13, 3, v75
    v_bitop3_b32 v12, v6, v13, v12 bitop3:0xca
    v_bitop3_b32 v71, v3, v12, v11 bitop3:0xca
    v_lshrrev_b32 v11, 3, v11
    v_lshrrev_b32 v13, 2, v75
    v_bitop3_b32 v11, v5, v13, v11 bitop3:0xca
    v_and_b32 v75, 0x3fff, v11
    ds_add_u32 v75, v2
    v_cvt_pk_bf16_f32 v45, v9, v10
    v_perm_b32 v12, v45, v45, s41
    v_bitop3_b32 v70, v4, v12, v70 bitop3:0xca
    v_perm_b32 v13, v45, v45, s42
    v_bitop3_b32 v71, v4, v13, v71 bitop3:0xca
    s_add_u32 s47, s35, 0x7554000
    buffer_store_dwordx4 v[84:87], v0, s[20:23], s47 offen sc1
    s_waitcnt vmcnt(8)
    v_lshlrev_b32 v7, 16, v46
    v_and_b32 v8, 0xffff0000, v46
    v_lshlrev_b32 v9, 16, v47
    v_and_b32 v10, 0xffff0000, v47
    v_mul_f32 v7, 0.15915494, v7
    v_mul_f32 v8, 0.15915494, v8
    v_mul_f32 v9, 0.15915494, v9
    v_mul_f32 v10, 0.15915494, v10
    v_cos_f32 v7, v7
    v_lshl_add_u32 v11, v76, 11, s40
    v_lshrrev_b32 v12, 3, v80
    v_lshlrev_b16 v13, 3, v80
    v_bitop3_b32 v12, v6, v13, v12 bitop3:0xca
    v_bitop3_b32 v76, v3, v12, v11 bitop3:0xca
    v_lshrrev_b32 v11, 3, v11
    v_lshrrev_b32 v13, 2, v80
    v_bitop3_b32 v11, v5, v13, v11 bitop3:0xca
    v_and_b32 v80, 0x3fff, v11
    ds_add_u32 v80, v2
    v_cos_f32 v8, v8
    v_lshl_add_u32 v11, v77, 11, s40
    v_lshrrev_b32 v12, 3, v81
    v_lshlrev_b16 v13, 3, v81
    v_bitop3_b32 v12, v6, v13, v12 bitop3:0xca
    v_bitop3_b32 v77, v3, v12, v11 bitop3:0xca
    v_lshrrev_b32 v11, 3, v11
    v_lshrrev_b32 v13, 2, v81
    v_bitop3_b32 v11, v5, v13, v11 bitop3:0xca
    v_and_b32 v81, 0x3fff, v11
    ds_add_u32 v81, v2
    v_cvt_pk_bf16_f32 v46, v7, v8
    v_perm_b32 v12, v46, v46, s41
    v_bitop3_b32 v76, v4, v12, v76 bitop3:0xca
    v_perm_b32 v13, v46, v46, s42
    v_bitop3_b32 v77, v4, v13, v77 bitop3:0xca
    v_cos_f32 v9, v9
    v_lshl_add_u32 v11, v78, 11, s40
    v_lshrrev_b32 v12, 3, v82
    v_lshlrev_b16 v13, 3, v82
    v_bitop3_b32 v12, v6, v13, v12 bitop3:0xca
    v_bitop3_b32 v78, v3, v12, v11 bitop3:0xca
    v_lshrrev_b32 v11, 3, v11
    v_lshrrev_b32 v13, 2, v82
    v_bitop3_b32 v11, v5, v13, v11 bitop3:0xca
    v_and_b32 v82, 0x3fff, v11
    ds_add_u32 v82, v2
    v_cos_f32 v10, v10
    v_lshl_add_u32 v11, v79, 11, s40
    v_lshrrev_b32 v12, 3, v83
    v_lshlrev_b16 v13, 3, v83
    v_bitop3_b32 v12, v6, v13, v12 bitop3:0xca
    v_bitop3_b32 v79, v3, v12, v11 bitop3:0xca
    v_lshrrev_b32 v11, 3, v11
    v_lshrrev_b32 v13, 2, v83
    v_bitop3_b32 v11, v5, v13, v11 bitop3:0xca
    v_and_b32 v83, 0x3fff, v11
    ds_add_u32 v83, v2
    v_cvt_pk_bf16_f32 v47, v9, v10
    v_perm_b32 v12, v47, v47, s41
    v_bitop3_b32 v78, v4, v12, v78 bitop3:0xca
    v_perm_b32 v13, v47, v47, s42
    v_bitop3_b32 v79, v4, v13, v79 bitop3:0xca
    v_lshrrev_b32 v8, 2, v0
    v_and_b32 v7, 0x3c00, v0
    v_bitop3_b32 v7, v5, v8, v7 bitop3:0xea
    s_waitcnt lgkmcnt(0)
    s_barrier
    ds_read2st64_b32 v[8:9], v7 offset0:0 offset1:1
    ds_read2st64_b32 v[10:11], v7 offset0:2 offset1:3
    s_waitcnt lgkmcnt(0)
    v_lshl_or_b32 v12, v9, 16, v8
    v_lshl_or_b32 v13, v11, 16, v10
    v_mov_b32 v14, v12
    v_mov_b32 v15, v13
    s_nop 0
    v_add_u32_dpp v14, v14, v14 row_shr:1 row_mask:0xf bank_mask:0xf bound_ctrl:1
    v_add_u32_dpp v15, v15, v15 row_shr:1 row_mask:0xf bank_mask:0xf bound_ctrl:1
    s_nop 0
    v_add_u32_dpp v14, v14, v14 row_shr:2 row_mask:0xf bank_mask:0xf bound_ctrl:1
    v_add_u32_dpp v15, v15, v15 row_shr:2 row_mask:0xf bank_mask:0xf bound_ctrl:1
    s_nop 0
    v_add_u32_dpp v14, v14, v14 row_shr:4 row_mask:0xf bank_mask:0xf bound_ctrl:1
    v_add_u32_dpp v15, v15, v15 row_shr:4 row_mask:0xf bank_mask:0xf bound_ctrl:1
    s_nop 0
    v_add_u32_dpp v14, v14, v14 row_shr:8 row_mask:0xf bank_mask:0xf bound_ctrl:1
    v_add_u32_dpp v15, v15, v15 row_shr:8 row_mask:0xf bank_mask:0xf bound_ctrl:1
    s_nop 0
    v_add_u32_dpp v14, v14, v14 row_bcast:15 row_mask:0xa bank_mask:0xf
    v_add_u32_dpp v15, v15, v15 row_bcast:15 row_mask:0xa bank_mask:0xf
    s_nop 0
    v_add_u32_dpp v14, v14, v14 row_bcast:31 row_mask:0xc bank_mask:0xf
    v_add_u32_dpp v15, v15, v15 row_bcast:31 row_mask:0xc bank_mask:0xf
    v_readlane_b32 s48, v14, 63
    v_readlane_b32 s49, v15, 63
    s_lshl_b32 s54, s32, 2
    v_mov_b32 v8, s54
    s_and_b32 s50, s48, 0xffff
    s_lshr_b32 s51, s48, 16
    s_and_b32 s52, s49, 0xffff
    s_lshr_b32 s53, s49, 16
    s_add_u32 s51, s51, s50
    s_add_u32 s52, s52, s51
    s_add_u32 s53, s53, s52
    v_mov_b32 v9, s53
    s_mov_b64 exec, 1
    ds_write_b32 v8, v9 offset:16384
    s_mov_b64 exec, -1
    v_and_b32 v8, 60, v7
    s_waitcnt lgkmcnt(0)
    s_barrier
    ds_read_b32 v9, v8 offset:16384
    s_waitcnt lgkmcnt(0)
    v_add_u32_dpp v9, v9, v9 row_shr:1 row_mask:0xf bank_mask:0xf bound_ctrl:1
    s_nop 1
    v_add_u32_dpp v9, v9, v9 row_shr:2 row_mask:0xf bank_mask:0xf bound_ctrl:1
    s_nop 1
    v_add_u32_dpp v9, v9, v9 row_shr:4 row_mask:0xf bank_mask:0xf bound_ctrl:1
    s_nop 1
    v_add_u32_dpp v9, v9, v9 row_shr:8 row_mask:0xf bank_mask:0xf bound_ctrl:1
    s_nop 0
    v_readlane_b32 s54, v9, s32
    s_sub_u32 s54, s54, s53
    s_add_u32 s50, s50, s54
    s_add_u32 s51, s51, s54
    s_add_u32 s52, s52, s54
    s_pack_ll_b32_b16 s48, s54, s50
    s_pack_ll_b32_b16 s49, s51, s52
    v_add_u32 v14, s48, v14
    v_add_u32 v15, s49, v15
    v_sub_u32 v12, v14, v12
    v_sub_u32 v13, v15, v13
    v_and_b32 v8, 0xffff, v12
    v_lshrrev_b32 v9, 16, v12
    v_and_b32 v10, 0xffff, v13
    v_lshrrev_b32 v11, 16, v13
    ds_write2st64_b32 v7, v8, v9 offset0:0 offset1:1
    ds_write2st64_b32 v7, v10, v11 offset0:2 offset1:3
    s_waitcnt lgkmcnt(0)
    s_barrier
    ds_add_rtn_u32 v120, v120, v2
    ds_add_rtn_u32 v121, v121, v2
    ds_add_rtn_u32 v122, v122, v2
    ds_add_rtn_u32 v123, v123, v2
    s_add_u32 s44, s36, 0x7ef400
    buffer_store_dwordx2 v[12:13], v1, s[24:27], s44 offen
    s_bitset0_b64 exec, 63
    s_not_b64 exec, exec
    buffer_store_dwordx2 v[14:15], v1, s[24:27], s44 offen offset:8
    s_mov_b64 exec, -1
    ds_add_rtn_u32 v20, v20, v2
    ds_add_rtn_u32 v21, v21, v2
    ds_add_rtn_u32 v22, v22, v2
    ds_add_rtn_u32 v23, v23, v2
    ds_add_rtn_u32 v32, v32, v2
    ds_add_rtn_u32 v33, v33, v2
    ds_add_rtn_u32 v34, v34, v2
    ds_add_rtn_u32 v35, v35, v2
    ds_add_rtn_u32 v40, v40, v2
    ds_add_rtn_u32 v41, v41, v2
    ds_add_rtn_u32 v42, v42, v2
    ds_add_rtn_u32 v43, v43, v2
    ds_add_rtn_u32 v52, v52, v2
    ds_add_rtn_u32 v53, v53, v2
    ds_add_rtn_u32 v54, v54, v2
    ds_add_rtn_u32 v55, v55, v2
    ds_add_rtn_u32 v60, v60, v2
    ds_add_rtn_u32 v61, v61, v2
    ds_add_rtn_u32 v62, v62, v2
    ds_add_rtn_u32 v63, v63, v2
    ds_add_rtn_u32 v72, v72, v2
    ds_add_rtn_u32 v73, v73, v2
    ds_add_rtn_u32 v74, v74, v2
    ds_add_rtn_u32 v75, v75, v2
    ds_add_rtn_u32 v80, v80, v2
    ds_add_rtn_u32 v81, v81, v2
    ds_add_rtn_u32 v82, v82, v2
    ds_add_rtn_u32 v83, v83, v2
    s_waitcnt lgkmcnt(0)
    s_barrier
    v_and_b32 v7, -4, v120
    v_lshl_add_u32 v8, v120, 2, v7
    ds_write_b32 v8, v116
    v_lshl_add_u32 v7, v7, 2, v120
    ds_write_b8 v7, v104 offset:16
    v_and_b32 v9, -4, v121
    v_lshl_add_u32 v10, v121, 2, v9
    ds_write_b32 v10, v117
    v_lshl_add_u32 v9, v9, 2, v121
    ds_write_b8_d16_hi v9, v104 offset:16
    v_and_b32 v7, -4, v122
    v_lshl_add_u32 v8, v122, 2, v7
    ds_write_b32 v8, v118
    v_lshl_add_u32 v7, v7, 2, v122
    ds_write_b8 v7, v105 offset:16
    v_and_b32 v9, -4, v123
    v_lshl_add_u32 v10, v123, 2, v9
    ds_write_b32 v10, v119
    v_lshl_add_u32 v9, v9, 2, v123
    ds_write_b8_d16_hi v9, v105 offset:16
    v_and_b32 v7, -4, v20
    v_lshl_add_u32 v8, v20, 2, v7
    ds_write_b32 v8, v16
    v_lshl_add_u32 v7, v7, 2, v20
    ds_write_b8 v7, v106 offset:16
    v_and_b32 v9, -4, v21
    v_lshl_add_u32 v10, v21, 2, v9
    ds_write_b32 v10, v17
    v_lshl_add_u32 v9, v9, 2, v21
    ds_write_b8_d16_hi v9, v106 offset:16
    v_and_b32 v7, -4, v22
    v_lshl_add_u32 v8, v22, 2, v7
    ds_write_b32 v8, v18
    v_lshl_add_u32 v7, v7, 2, v22
    ds_write_b8 v7, v107 offset:16
    v_and_b32 v9, -4, v23
    v_lshl_add_u32 v10, v23, 2, v9
    ds_write_b32 v10, v19
    v_lshl_add_u32 v9, v9, 2, v23
    ds_write_b8_d16_hi v9, v107 offset:16
    v_and_b32 v7, -4, v32
    v_lshl_add_u32 v8, v32, 2, v7
    ds_write_b32 v8, v28
    v_lshl_add_u32 v7, v7, 2, v32
    ds_write_b8 v7, v124 offset:16
    v_and_b32 v9, -4, v33
    v_lshl_add_u32 v10, v33, 2, v9
    ds_write_b32 v10, v29
    v_lshl_add_u32 v9, v9, 2, v33
    ds_write_b8_d16_hi v9, v124 offset:16
    v_and_b32 v7, -4, v34
    v_lshl_add_u32 v8, v34, 2, v7
    ds_write_b32 v8, v30
    v_lshl_add_u32 v7, v7, 2, v34
    ds_write_b8 v7, v125 offset:16
    v_and_b32 v9, -4, v35
    v_lshl_add_u32 v10, v35, 2, v9
    ds_write_b32 v10, v31
    v_lshl_add_u32 v9, v9, 2, v35
    ds_write_b8_d16_hi v9, v125 offset:16
    v_and_b32 v7, -4, v40
    v_lshl_add_u32 v8, v40, 2, v7
    ds_write_b32 v8, v36
    v_lshl_add_u32 v7, v7, 2, v40
    ds_write_b8 v7, v126 offset:16
    v_and_b32 v9, -4, v41
    v_lshl_add_u32 v10, v41, 2, v9
    ds_write_b32 v10, v37
    v_lshl_add_u32 v9, v9, 2, v41
    ds_write_b8_d16_hi v9, v126 offset:16
    v_and_b32 v7, -4, v42
    v_lshl_add_u32 v8, v42, 2, v7
    ds_write_b32 v8, v38
    v_lshl_add_u32 v7, v7, 2, v42
    ds_write_b8 v7, v127 offset:16
    v_and_b32 v9, -4, v43
    v_lshl_add_u32 v10, v43, 2, v9
    ds_write_b32 v10, v39
    v_lshl_add_u32 v9, v9, 2, v43
    ds_write_b8_d16_hi v9, v127 offset:16
    v_and_b32 v7, -4, v52
    v_lshl_add_u32 v8, v52, 2, v7
    ds_write_b32 v8, v48
    v_lshl_add_u32 v7, v7, 2, v52
    ds_write_b8 v7, v24 offset:16
    v_and_b32 v9, -4, v53
    v_lshl_add_u32 v10, v53, 2, v9
    ds_write_b32 v10, v49
    v_lshl_add_u32 v9, v9, 2, v53
    ds_write_b8_d16_hi v9, v24 offset:16
    v_and_b32 v7, -4, v54
    v_lshl_add_u32 v8, v54, 2, v7
    ds_write_b32 v8, v50
    v_lshl_add_u32 v7, v7, 2, v54
    ds_write_b8 v7, v25 offset:16
    v_and_b32 v9, -4, v55
    v_lshl_add_u32 v10, v55, 2, v9
    ds_write_b32 v10, v51
    v_lshl_add_u32 v9, v9, 2, v55
    ds_write_b8_d16_hi v9, v25 offset:16
    v_and_b32 v7, -4, v60
    v_lshl_add_u32 v8, v60, 2, v7
    ds_write_b32 v8, v56
    v_lshl_add_u32 v7, v7, 2, v60
    ds_write_b8 v7, v26 offset:16
    v_and_b32 v9, -4, v61
    v_lshl_add_u32 v10, v61, 2, v9
    ds_write_b32 v10, v57
    v_lshl_add_u32 v9, v9, 2, v61
    ds_write_b8_d16_hi v9, v26 offset:16
    v_and_b32 v7, -4, v62
    v_lshl_add_u32 v8, v62, 2, v7
    ds_write_b32 v8, v58
    v_lshl_add_u32 v7, v7, 2, v62
    ds_write_b8 v7, v27 offset:16
    v_and_b32 v9, -4, v63
    v_lshl_add_u32 v10, v63, 2, v9
    ds_write_b32 v10, v59
    v_lshl_add_u32 v9, v9, 2, v63
    ds_write_b8_d16_hi v9, v27 offset:16
    v_and_b32 v7, -4, v72
    v_lshl_add_u32 v8, v72, 2, v7
    ds_write_b32 v8, v68
    v_lshl_add_u32 v7, v7, 2, v72
    ds_write_b8 v7, v44 offset:16
    v_and_b32 v9, -4, v73
    v_lshl_add_u32 v10, v73, 2, v9
    ds_write_b32 v10, v69
    v_lshl_add_u32 v9, v9, 2, v73
    ds_write_b8_d16_hi v9, v44 offset:16
    v_and_b32 v7, -4, v74
    v_lshl_add_u32 v8, v74, 2, v7
    ds_write_b32 v8, v70
    v_lshl_add_u32 v7, v7, 2, v74
    ds_write_b8 v7, v45 offset:16
    v_and_b32 v9, -4, v75
    v_lshl_add_u32 v10, v75, 2, v9
    ds_write_b32 v10, v71
    v_lshl_add_u32 v9, v9, 2, v75
    ds_write_b8_d16_hi v9, v45 offset:16
    v_and_b32 v7, -4, v80
    v_lshl_add_u32 v8, v80, 2, v7
    ds_write_b32 v8, v76
    v_lshl_add_u32 v7, v7, 2, v80
    ds_write_b8 v7, v46 offset:16
    v_and_b32 v9, -4, v81
    v_lshl_add_u32 v10, v81, 2, v9
    ds_write_b32 v10, v77
    v_lshl_add_u32 v9, v9, 2, v81
    ds_write_b8_d16_hi v9, v46 offset:16
    v_and_b32 v7, -4, v82
    v_lshl_add_u32 v8, v82, 2, v7
    ds_write_b32 v8, v78
    v_lshl_add_u32 v7, v7, 2, v82
    ds_write_b8 v7, v47 offset:16
    v_and_b32 v9, -4, v83
    v_lshl_add_u32 v10, v83, 2, v9
    ds_write_b32 v10, v79
    v_lshl_add_u32 v9, v9, 2, v83
    ds_write_b8_d16_hi v9, v47 offset:16
    v_add_u32 v7, 0x10000, v0
    v_add_u32 v12, 0x20000, v0
    s_waitcnt lgkmcnt(0)
    s_barrier
    ds_read_b128 v[88:91], v0 offset:0
    ds_read_b128 v[92:95], v0 offset:16384
    ds_read_b128 v[64:67], v0 offset:32768
    ds_read_b128 v[96:99], v0 offset:49152
    ds_read_b128 v[100:103], v7 offset:0
    ds_read_b128 v[108:111], v7 offset:16384
    ds_read_b128 v[112:115], v7 offset:32768
    ds_read_b128 v[84:87], v7 offset:49152
    ds_read_b128 v[116:119], v12 offset:0
    ds_read_b128 v[120:123], v12 offset:16384
    s_waitcnt lgkmcnt(9)
    s_add_u32 s45, s35, 0x9c40000
    buffer_store_dwordx4 v[88:91], v0, s[20:23], s45 offen sc1
    s_waitcnt lgkmcnt(8)
    s_add_u32 s46, s35, 0x9c44000
    buffer_store_dwordx4 v[92:95], v0, s[20:23], s46 offen sc1
    s_waitcnt lgkmcnt(7)
    s_add_u32 s47, s35, 0x9c48000
    buffer_store_dwordx4 v[64:67], v0, s[20:23], s47 offen sc1
    s_waitcnt lgkmcnt(6)
    s_add_u32 s44, s35, 0x9c4c000
    buffer_store_dwordx4 v[96:99], v0, s[20:23], s44 offen sc1
    s_waitcnt lgkmcnt(5)
    s_add_u32 s45, s35, 0x9c50000
    buffer_store_dwordx4 v[100:103], v0, s[20:23], s45 offen sc1
    s_waitcnt lgkmcnt(4)
    s_add_u32 s46, s35, 0x9c54000
    buffer_store_dwordx4 v[108:111], v0, s[20:23], s46 offen sc1
    s_waitcnt lgkmcnt(3)
    s_add_u32 s47, s35, 0x9c58000
    buffer_store_dwordx4 v[112:115], v0, s[20:23], s47 offen sc1
    s_waitcnt lgkmcnt(2)
    s_add_u32 s44, s35, 0x9c5c000
    buffer_store_dwordx4 v[84:87], v0, s[20:23], s44 offen sc1
    s_waitcnt lgkmcnt(1)
    s_add_u32 s45, s35, 0x9c60000
    buffer_store_dwordx4 v[116:119], v0, s[20:23], s45 offen sc1
    s_waitcnt lgkmcnt(0)
    s_add_u32 s46, s35, 0x9c64000
    buffer_store_dwordx4 v[120:123], v0, s[20:23], s46 offen sc1
L1_end:
    s_endpgm
L1_md:
    s_load_dwordx2 s[52:53], s[0:1], 0
    s_load_dwordx4 s[36:39], s[0:1], 56
    s_load_dwordx4 s[40:43], s[0:1], 72
    s_waitcnt lgkmcnt(0)
    s_mov_b32 s8, s52
    s_mov_b32 s9, s53
    s_mov_b32 s10, 0x4e2000
    s_mov_b32 s11, 0x20000
    s_add_u32 s12, s30, 0xcd3b100
    s_addc_u32 s13, s31, 0
    s_mov_b32 s14, 0x4e2000
    s_mov_b32 s15, 0x20000
    s_mov_b32 s16, s40
    s_mov_b32 s17, s41
    s_mov_b32 s18, 0x20
    s_mov_b32 s19, 0x20000
    s_mov_b32 s20, s38
    s_mov_b32 s21, s39
    s_mov_b32 s22, 0x40
    s_mov_b32 s23, 0x20000
    s_mov_b32 s24, s36
    s_mov_b32 s25, s37
    s_mov_b32 s26, 0x40
    s_mov_b32 s27, 0x20000
    s_mov_b32 s44, s42
    s_mov_b32 s45, s43
    s_mov_b32 s46, 0x20
    s_mov_b32 s47, 0x20000
    s_add_u32 s48, s30, 0xe5a6100
    s_addc_u32 s49, s31, 0
    s_mov_b32 s50, 0x100
    s_mov_b32 s51, 0x20000
    v_and_b32 v1, 3, v0
    v_lshlrev_b32 v2, 1, v1
    v_mov_b32 v18, 0
    v_mov_b32 v19, 0
    buffer_load_ushort v4, v2, s[16:19], 0 offen offset:0
    buffer_load_ushort v34, v2, s[16:19], 0 offen offset:8
    buffer_load_ushort v5, v2, s[16:19], 0 offen offset:16
    buffer_load_ushort v35, v2, s[16:19], 0 offen offset:24
    buffer_load_ushort v8, v2, s[20:23], 0 offen offset:0
    buffer_load_ushort v38, v2, s[20:23], 0 offen offset:8
    buffer_load_ushort v9, v2, s[20:23], 0 offen offset:16
    buffer_load_ushort v39, v2, s[20:23], 0 offen offset:24
    buffer_load_ushort v10, v2, s[20:23], 0 offen offset:32
    buffer_load_ushort v40, v2, s[20:23], 0 offen offset:40
    buffer_load_ushort v11, v2, s[20:23], 0 offen offset:48
    buffer_load_ushort v41, v2, s[20:23], 0 offen offset:56
    buffer_load_ushort v12, v2, s[24:27], 0 offen offset:0
    buffer_load_ushort v42, v2, s[24:27], 0 offen offset:8
    buffer_load_ushort v13, v2, s[24:27], 0 offen offset:16
    buffer_load_ushort v43, v2, s[24:27], 0 offen offset:24
    buffer_load_ushort v14, v2, s[24:27], 0 offen offset:32
    buffer_load_ushort v44, v2, s[24:27], 0 offen offset:40
    buffer_load_ushort v15, v2, s[24:27], 0 offen offset:48
    buffer_load_ushort v45, v2, s[24:27], 0 offen offset:56
    buffer_load_ushort v16, v2, s[44:47], 0 offen offset:0
    buffer_load_ushort v46, v2, s[44:47], 0 offen offset:8
    buffer_load_ushort v17, v2, s[44:47], 0 offen offset:16
    buffer_load_ushort v47, v2, s[44:47], 0 offen offset:24
    v_lshlrev_b32 v3, 6, v0
    s_waitcnt vmcnt(0)
    v_lshl_or_b32 v4, v34, 16, v4
    v_lshl_or_b32 v5, v35, 16, v5
    v_lshl_or_b32 v8, v38, 16, v8
    v_lshl_or_b32 v9, v39, 16, v9
    v_lshl_or_b32 v10, v40, 16, v10
    v_lshl_or_b32 v11, v41, 16, v11
    v_lshl_or_b32 v12, v42, 16, v12
    v_lshl_or_b32 v13, v43, 16, v13
    v_lshl_or_b32 v14, v44, 16, v14
    v_lshl_or_b32 v15, v45, 16, v15
    v_lshl_or_b32 v16, v46, 16, v16
    v_lshl_or_b32 v17, v47, 16, v17
    buffer_store_dwordx4 v[8:11], v3, s[48:51], 0 offen
    buffer_store_dwordx4 v[12:15], v3, s[48:51], 0 offen offset:16
    buffer_store_dwordx4 v[16:19], v3, s[48:51], 0 offen offset:32
    v_lshrrev_b32 v1, 4, v0
    v_and_b32 v2, 15, v0
    v_lshlrev_b32 v6, 9, v2
    v_lshl_add_u32 v6, v1, 3, v6
    s_mov_b32 s33, 80000
    v_mul_lo_u32 v7, v1, s33
    v_lshl_add_u32 v7, v2, 3, v7
    s_sub_u32 s32, s2, 250
L1_mdloop:
    s_mul_i32 s33, s32, 204800
    s_mul_i32 s34, s32, 3200
    buffer_load_dwordx2 v[20:21], v6, s[8:11], s33 offen
    s_add_u32 s33, s33, 8192
    buffer_load_dwordx2 v[22:23], v6, s[8:11], s33 offen
    s_add_u32 s33, s33, 8192
    buffer_load_dwordx2 v[24:25], v6, s[8:11], s33 offen
    s_add_u32 s33, s33, 8192
    buffer_load_dwordx2 v[26:27], v6, s[8:11], s33 offen
    s_add_u32 s33, s33, 8192
    buffer_load_dwordx2 v[28:29], v6, s[8:11], s33 offen
    s_add_u32 s33, s33, 8192
    buffer_load_dwordx2 v[30:31], v6, s[8:11], s33 offen
    s_add_u32 s33, s33, 8192
    buffer_load_dwordx2 v[32:33], v6, s[8:11], s33 offen
    s_add_u32 s33, s33, 8192
    buffer_load_dwordx2 v[34:35], v6, s[8:11], s33 offen
    s_add_u32 s33, s33, 8192
    buffer_load_dwordx2 v[36:37], v6, s[8:11], s33 offen
    s_add_u32 s33, s33, 8192
    buffer_load_dwordx2 v[38:39], v6, s[8:11], s33 offen
    s_add_u32 s33, s33, 8192
    buffer_load_dwordx2 v[40:41], v6, s[8:11], s33 offen
    s_add_u32 s33, s33, 8192
    buffer_load_dwordx2 v[42:43], v6, s[8:11], s33 offen
    s_add_u32 s33, s33, 8192
    buffer_load_dwordx2 v[44:45], v6, s[8:11], s33 offen
    s_add_u32 s33, s33, 8192
    buffer_load_dwordx2 v[46:47], v6, s[8:11], s33 offen
    s_add_u32 s33, s33, 8192
    buffer_load_dwordx2 v[48:49], v6, s[8:11], s33 offen
    s_add_u32 s33, s33, 8192
    buffer_load_dwordx2 v[50:51], v6, s[8:11], s33 offen
    s_add_u32 s33, s33, 8192
    buffer_load_dwordx2 v[52:53], v6, s[8:11], s33 offen
    s_add_u32 s33, s33, 8192
    buffer_load_dwordx2 v[54:55], v6, s[8:11], s33 offen
    s_add_u32 s33, s33, 8192
    buffer_load_dwordx2 v[56:57], v6, s[8:11], s33 offen
    s_add_u32 s33, s33, 8192
    buffer_load_dwordx2 v[58:59], v6, s[8:11], s33 offen
    s_add_u32 s33, s33, 8192
    buffer_load_dwordx2 v[60:61], v6, s[8:11], s33 offen
    s_add_u32 s33, s33, 8192
    buffer_load_dwordx2 v[62:63], v6, s[8:11], s33 offen
    s_add_u32 s33, s33, 8192
    buffer_load_dwordx2 v[64:65], v6, s[8:11], s33 offen
    s_add_u32 s33, s33, 8192
    buffer_load_dwordx2 v[66:67], v6, s[8:11], s33 offen
    s_add_u32 s33, s33, 8192
    buffer_load_dwordx2 v[68:69], v6, s[8:11], s33 offen
    s_add_u32 s33, s33, 8192
    s_waitcnt vmcnt(24)
    v_mfma_f32_4x4x4_16b_bf16 v[72:75], v[4:5], v[20:21], 0
    s_nop 4
    v_cvt_pk_bf16_f32 v20, v72, v73
    v_cvt_pk_bf16_f32 v21, v74, v75
    buffer_store_dwordx2 v[20:21], v7, s[12:15], s34 offen offset:0
    s_waitcnt vmcnt(24)
    v_mfma_f32_4x4x4_16b_bf16 v[76:79], v[4:5], v[22:23], 0
    s_nop 4
    v_cvt_pk_bf16_f32 v22, v76, v77
    v_cvt_pk_bf16_f32 v23, v78, v79
    buffer_store_dwordx2 v[22:23], v7, s[12:15], s34 offen offset:128
    s_waitcnt vmcnt(24)
    v_mfma_f32_4x4x4_16b_bf16 v[80:83], v[4:5], v[24:25], 0
    s_nop 4
    v_cvt_pk_bf16_f32 v24, v80, v81
    v_cvt_pk_bf16_f32 v25, v82, v83
    buffer_store_dwordx2 v[24:25], v7, s[12:15], s34 offen offset:256
    s_waitcnt vmcnt(24)
    v_mfma_f32_4x4x4_16b_bf16 v[84:87], v[4:5], v[26:27], 0
    s_nop 4
    v_cvt_pk_bf16_f32 v26, v84, v85
    v_cvt_pk_bf16_f32 v27, v86, v87
    buffer_store_dwordx2 v[26:27], v7, s[12:15], s34 offen offset:384
    s_waitcnt vmcnt(24)
    v_mfma_f32_4x4x4_16b_bf16 v[72:75], v[4:5], v[28:29], 0
    s_nop 4
    v_cvt_pk_bf16_f32 v28, v72, v73
    v_cvt_pk_bf16_f32 v29, v74, v75
    buffer_store_dwordx2 v[28:29], v7, s[12:15], s34 offen offset:512
    s_waitcnt vmcnt(24)
    v_mfma_f32_4x4x4_16b_bf16 v[76:79], v[4:5], v[30:31], 0
    s_nop 4
    v_cvt_pk_bf16_f32 v30, v76, v77
    v_cvt_pk_bf16_f32 v31, v78, v79
    buffer_store_dwordx2 v[30:31], v7, s[12:15], s34 offen offset:640
    s_waitcnt vmcnt(24)
    v_mfma_f32_4x4x4_16b_bf16 v[80:83], v[4:5], v[32:33], 0
    s_nop 4
    v_cvt_pk_bf16_f32 v32, v80, v81
    v_cvt_pk_bf16_f32 v33, v82, v83
    buffer_store_dwordx2 v[32:33], v7, s[12:15], s34 offen offset:768
    s_waitcnt vmcnt(24)
    v_mfma_f32_4x4x4_16b_bf16 v[84:87], v[4:5], v[34:35], 0
    s_nop 4
    v_cvt_pk_bf16_f32 v34, v84, v85
    v_cvt_pk_bf16_f32 v35, v86, v87
    buffer_store_dwordx2 v[34:35], v7, s[12:15], s34 offen offset:896
    s_waitcnt vmcnt(24)
    v_mfma_f32_4x4x4_16b_bf16 v[72:75], v[4:5], v[36:37], 0
    s_nop 4
    v_cvt_pk_bf16_f32 v36, v72, v73
    v_cvt_pk_bf16_f32 v37, v74, v75
    buffer_store_dwordx2 v[36:37], v7, s[12:15], s34 offen offset:1024
    s_waitcnt vmcnt(24)
    v_mfma_f32_4x4x4_16b_bf16 v[76:79], v[4:5], v[38:39], 0
    s_nop 4
    v_cvt_pk_bf16_f32 v38, v76, v77
    v_cvt_pk_bf16_f32 v39, v78, v79
    buffer_store_dwordx2 v[38:39], v7, s[12:15], s34 offen offset:1152
    s_waitcnt vmcnt(24)
    v_mfma_f32_4x4x4_16b_bf16 v[80:83], v[4:5], v[40:41], 0
    s_nop 4
    v_cvt_pk_bf16_f32 v40, v80, v81
    v_cvt_pk_bf16_f32 v41, v82, v83
    buffer_store_dwordx2 v[40:41], v7, s[12:15], s34 offen offset:1280
    s_waitcnt vmcnt(24)
    v_mfma_f32_4x4x4_16b_bf16 v[84:87], v[4:5], v[42:43], 0
    s_nop 4
    v_cvt_pk_bf16_f32 v42, v84, v85
    v_cvt_pk_bf16_f32 v43, v86, v87
    buffer_store_dwordx2 v[42:43], v7, s[12:15], s34 offen offset:1408
    s_waitcnt vmcnt(24)
    v_mfma_f32_4x4x4_16b_bf16 v[72:75], v[4:5], v[44:45], 0
    s_nop 4
    v_cvt_pk_bf16_f32 v44, v72, v73
    v_cvt_pk_bf16_f32 v45, v74, v75
    buffer_store_dwordx2 v[44:45], v7, s[12:15], s34 offen offset:1536
    s_waitcnt vmcnt(24)
    v_mfma_f32_4x4x4_16b_bf16 v[76:79], v[4:5], v[46:47], 0
    s_nop 4
    v_cvt_pk_bf16_f32 v46, v76, v77
    v_cvt_pk_bf16_f32 v47, v78, v79
    buffer_store_dwordx2 v[46:47], v7, s[12:15], s34 offen offset:1664
    s_waitcnt vmcnt(24)
    v_mfma_f32_4x4x4_16b_bf16 v[80:83], v[4:5], v[48:49], 0
    s_nop 4
    v_cvt_pk_bf16_f32 v48, v80, v81
    v_cvt_pk_bf16_f32 v49, v82, v83
    buffer_store_dwordx2 v[48:49], v7, s[12:15], s34 offen offset:1792
    s_waitcnt vmcnt(24)
    v_mfma_f32_4x4x4_16b_bf16 v[84:87], v[4:5], v[50:51], 0
    s_nop 4
    v_cvt_pk_bf16_f32 v50, v84, v85
    v_cvt_pk_bf16_f32 v51, v86, v87
    buffer_store_dwordx2 v[50:51], v7, s[12:15], s34 offen offset:1920
    s_waitcnt vmcnt(24)
    v_mfma_f32_4x4x4_16b_bf16 v[72:75], v[4:5], v[52:53], 0
    s_nop 4
    v_cvt_pk_bf16_f32 v52, v72, v73
    v_cvt_pk_bf16_f32 v53, v74, v75
    buffer_store_dwordx2 v[52:53], v7, s[12:15], s34 offen offset:2048
    s_waitcnt vmcnt(24)
    v_mfma_f32_4x4x4_16b_bf16 v[76:79], v[4:5], v[54:55], 0
    s_nop 4
    v_cvt_pk_bf16_f32 v54, v76, v77
    v_cvt_pk_bf16_f32 v55, v78, v79
    buffer_store_dwordx2 v[54:55], v7, s[12:15], s34 offen offset:2176
    s_waitcnt vmcnt(24)
    v_mfma_f32_4x4x4_16b_bf16 v[80:83], v[4:5], v[56:57], 0
    s_nop 4
    v_cvt_pk_bf16_f32 v56, v80, v81
    v_cvt_pk_bf16_f32 v57, v82, v83
    buffer_store_dwordx2 v[56:57], v7, s[12:15], s34 offen offset:2304
    s_waitcnt vmcnt(24)
    v_mfma_f32_4x4x4_16b_bf16 v[84:87], v[4:5], v[58:59], 0
    s_nop 4
    v_cvt_pk_bf16_f32 v58, v84, v85
    v_cvt_pk_bf16_f32 v59, v86, v87
    buffer_store_dwordx2 v[58:59], v7, s[12:15], s34 offen offset:2432
    s_waitcnt vmcnt(24)
    v_mfma_f32_4x4x4_16b_bf16 v[72:75], v[4:5], v[60:61], 0
    s_nop 4
    v_cvt_pk_bf16_f32 v60, v72, v73
    v_cvt_pk_bf16_f32 v61, v74, v75
    buffer_store_dwordx2 v[60:61], v7, s[12:15], s34 offen offset:2560
    s_waitcnt vmcnt(24)
    v_mfma_f32_4x4x4_16b_bf16 v[76:79], v[4:5], v[62:63], 0
    s_nop 4
    v_cvt_pk_bf16_f32 v62, v76, v77
    v_cvt_pk_bf16_f32 v63, v78, v79
    buffer_store_dwordx2 v[62:63], v7, s[12:15], s34 offen offset:2688
    s_waitcnt vmcnt(24)
    v_mfma_f32_4x4x4_16b_bf16 v[80:83], v[4:5], v[64:65], 0
    s_nop 4
    v_cvt_pk_bf16_f32 v64, v80, v81
    v_cvt_pk_bf16_f32 v65, v82, v83
    buffer_store_dwordx2 v[64:65], v7, s[12:15], s34 offen offset:2816
    s_waitcnt vmcnt(24)
    v_mfma_f32_4x4x4_16b_bf16 v[84:87], v[4:5], v[66:67], 0
    s_nop 4
    v_cvt_pk_bf16_f32 v66, v84, v85
    v_cvt_pk_bf16_f32 v67, v86, v87
    buffer_store_dwordx2 v[66:67], v7, s[12:15], s34 offen offset:2944
    s_waitcnt vmcnt(24)
    v_mfma_f32_4x4x4_16b_bf16 v[72:75], v[4:5], v[68:69], 0
    s_nop 4
    v_cvt_pk_bf16_f32 v68, v72, v73
    v_cvt_pk_bf16_f32 v69, v74, v75
    buffer_store_dwordx2 v[68:69], v7, s[12:15], s34 offen offset:3072
    s_waitcnt vmcnt(0)
    s_add_u32 s32, s32, 6
    s_cmp_lt_u32 s32, 25
    s_cbranch_scc1 L1_mdloop
    s_endpgm
.text
.globl gs_acc_kernel
.p2align 8
.type gs_acc_kernel,@function
gs_acc_kernel:
    s_cmp_ge_u32 s2, 256
    s_cbranch_scc1 L2_end
    s_load_dwordx2 s[30:31], s[0:1], 104
    v_lshrrev_b32 v16, 6, v0
    v_and_b32 v17, 63, v0
    v_readfirstlane_b32 s32, v16
    s_bfe_u32 s33, s2, 0x20001
    s_and_b32 s34, s2, 1
    s_lshl_b32 s34, s34, 5
    s_lshr_b32 s3, s2, 3
    s_add_u32 s34, s34, s3
    v_lshlrev_b32 v1, 2, v17
    v_and_b32 v2, 12, v1
    v_sub_u32 v3, 16, v2
    v_and_b32 v18, 0xf0, v1
    v_add_u32 v18, v18, v16
    s_mov_b32 s3, 163840
    v_mul_lo_u32 v4, v18, s3
    v_or_b32 v4, 0xf0000000, v4
    v_mul_u32_u24 v5, 8320, v18
    v_mul_u32_u24 v6, 5120, v16
    v_lshl_add_u32 v6, v17, 4, v6
    v_add_u32 v7, 80000, v6
    v_and_b32 v18, 3, v0
    v_lshlrev_b32 v18, 4, v18
    v_mov_b32 v12, 0x3f80
    v_mov_b32 v13, 0
    v_lshlrev_b64 v[12:13], v18, v[12:13]
    v_and_b32 v18, 3, v0
    v_lshlrev_b32 v18, 4, v18
    v_mov_b32 v14, 0xbf80
    v_mov_b32 v15, 0
    v_lshlrev_b64 v[14:15], v18, v[14:15]
    v_lshlrev_b32 v0, 4, v0
    v_mov_b32 v8, 0x1fff8
    v_mov_b32 v9, 0x07ff0000
    v_mov_b32 v10, 0x38000000
    v_mov_b32 v11, 0x80000000
    s_mov_b32 s44, 0x4000c0c
    s_mov_b32 s45, 0x4010c0c
    s_mov_b32 s46, 0x4020c0c
    s_mov_b32 s47, 0x4030c0c
    s_mul_i32 s38, s32, 1280
    s_add_u32 s38, s38, 20000
    s_mul_i32 s39, s33, 2080
    s_lshl_b32 s3, s34, 3
    s_add_u32 s39, s39, s3
    s_mul_i32 s40, s33, 1280000
    s_mov_b32 s36, 0
    s_mov_b32 s35, 0
    s_mov_b32 s42, 0
    s_waitcnt lgkmcnt(0)
    s_mov_b32 s8, s30
    s_mov_b32 s9, s31
    s_mov_b32 s10, 0xc350000
    s_mov_b32 s11, 0x20000
    s_add_u32 s12, s30, 0xc350000
    s_addc_u32 s13, s31, 0
    s_mov_b32 s14, 0x9eb100
    s_mov_b32 s15, 0x20000
    s_add_u32 s24, s30, 0xc350000
    s_addc_u32 s25, s31, 0
    s_mov_b32 s26, 0x9eb100
    s_mov_b32 s27, 0x20000
    s_add_u32 s16, s30, 0xcd3b100
    s_addc_u32 s17, s31, 0
    s_mov_b32 s18, 0x4e2000
    s_mov_b32 s19, 0x20000
    s_add_u32 s20, s30, 0xd21e100
    s_addc_u32 s21, s31, 0
    s_mov_b32 s22, 0x13880
    s_mov_b32 s23, 0x20000
    s_lshl_b32 s3, s33, 6
    s_add_u32 s3, s3, s34
    s_mul_i32 s3, s3, 80000
    s_add_u32 s20, s20, s3
    s_addc_u32 s21, s21, 0
    buffer_load_dwordx4 v[64:67], v5, s[12:15], s39 offen
    v_add_u32 v111, 0x208000, v5
    buffer_load_dwordx4 v[68:71], v111, s[12:15], s39 offen
    v_add_u32 v112, 0x410000, v5
    buffer_load_dwordx4 v[72:75], v112, s[12:15], s39 offen
    v_add_u32 v113, 0x618000, v5
    buffer_load_dwordx4 v[76:79], v113, s[12:15], s39 offen
    v_add_u32 v114, 0x820000, v5
    buffer_load_dwordx4 v[80:83], v114, s[12:15], s39 offen
    buffer_load_dwordx4 v[44:47], v6, s[16:19], s40 offen offset:0
    buffer_load_dwordx4 v[48:51], v6, s[16:19], s40 offen offset:1024
    buffer_load_dwordx4 v[52:55], v6, s[16:19], s40 offen offset:2048
    buffer_load_dwordx4 v[56:59], v6, s[16:19], s40 offen offset:3072
    s_add_u32 s3, s40, 4096
    buffer_load_dwordx4 v[60:63], v6, s[16:19], s3 offen
    s_add_u32 s40, s40, 80000
    v_mov_b32 v92, 0
    v_mov_b32 v93, 0
    v_mov_b32 v94, 0
    v_mov_b32 v95, 0
    ds_write_b128 v0, v[92:95] offset:0
    ds_write_b128 v0, v[92:95] offset:16384
    ds_write_b128 v0, v[92:95] offset:32768
    ds_write_b128 v0, v[92:95] offset:49152
    v_add_u32 v109, 0x10000, v0
    v_cmp_gt_u32 vcc, 80000, v109
    s_mov_b64 exec, vcc
    ds_write_b128 v109, v[92:95]
    s_mov_b64 exec, -1
    s_waitcnt vmcnt(5)
    s_mov_b32 s37, s38
    s_add_u32 s48, s38, 257
    v_and_b32 v110, 0xffff, v64
    v_and_b32 v111, 0xffff, v66
    v_and_b32 v112, -4, v110
    v_add_u32 v112, v112, v2
L2_x1_0:
    v_sub_u32 v113, v111, v112
    v_sub_u32 v115, v110, v112
    v_med3_i32 v114, v113, 0, 4
    v_max_i32 v115, 0, v115
    v_cmp_gt_i32 vcc, v114, v115
    v_mad_u32_u24 v116, v112, 5, v4
    v_bfm_b32 v114, v114, 28
    v_bfm_b32 v115, v115, 28
    v_mbcnt_lo_u32_b32 v117, vcc_lo, 0
    v_mbcnt_hi_u32_b32 v117, vcc_hi, v117
    v_bitop3_b32 v116, v114, v115, v116 bitop3:0x9a
    v_add_lshl_u32 v117, v117, s37, 2
    s_bcnt1_i32_b64 s41, vcc
    s_mov_b64 exec, vcc
    ds_write_b32 v117, v116
    s_mov_b64 exec, -1
    v_cmp_gt_i32 vcc, v113, v3
    s_add_u32 s37, s37, s41
    s_min_u32 s37, s37, s48
    s_cbranch_vccnz L2_xe1_0
L2_xr1_0:
    v_and_b32 v110, 0xffff, v68
    v_and_b32 v111, 0xffff, v70
    v_and_b32 v112, -4, v110
    v_add_u32 v112, v112, v2
    v_add_u32 v118, 0x2800000, v4
L2_x1_1:
    v_sub_u32 v113, v111, v112
    v_sub_u32 v115, v110, v112
    v_med3_i32 v114, v113, 0, 4
    v_max_i32 v115, 0, v115
    v_cmp_gt_i32 vcc, v114, v115
    v_mad_u32_u24 v116, v112, 5, v118
    v_bfm_b32 v114, v114, 28
    v_bfm_b32 v115, v115, 28
    v_mbcnt_lo_u32_b32 v117, vcc_lo, 0
    v_mbcnt_hi_u32_b32 v117, vcc_hi, v117
    v_bitop3_b32 v116, v114, v115, v116 bitop3:0x9a
    v_add_lshl_u32 v117, v117, s37, 2
    s_bcnt1_i32_b64 s41, vcc
    s_mov_b64 exec, vcc
    ds_write_b32 v117, v116
    s_mov_b64 exec, -1
    v_cmp_gt_i32 vcc, v113, v3
    s_add_u32 s37, s37, s41
    s_min_u32 s37, s37, s48
    s_cbranch_vccnz L2_xe1_1
L2_xr1_1:
    v_and_b32 v110, 0xffff, v72
    v_and_b32 v111, 0xffff, v74
    v_and_b32 v112, -4, v110
    v_add_u32 v112, v112, v2
    v_add_u32 v118, 0x5000000, v4
L2_x1_2:
    v_sub_u32 v113, v111, v112
    v_sub_u32 v115, v110, v112
    v_med3_i32 v114, v113, 0, 4
    v_max_i32 v115, 0, v115
    v_cmp_gt_i32 vcc, v114, v115
    v_mad_u32_u24 v116, v112, 5, v118
    v_bfm_b32 v114, v114, 28
    v_bfm_b32 v115, v115, 28
    v_mbcnt_lo_u32_b32 v117, vcc_lo, 0
    v_mbcnt_hi_u32_b32 v117, vcc_hi, v117
    v_bitop3_b32 v116, v114, v115, v116 bitop3:0x9a
    v_add_lshl_u32 v117, v117, s37, 2
    s_bcnt1_i32_b64 s41, vcc
    s_mov_b64 exec, vcc
    ds_write_b32 v117, v116
    s_mov_b64 exec, -1
    v_cmp_gt_i32 vcc, v113, v3
    s_add_u32 s37, s37, s41
    s_min_u32 s37, s37, s48
    s_cbranch_vccnz L2_xe1_2
L2_xr1_2:
    v_and_b32 v110, 0xffff, v76
    v_and_b32 v111, 0xffff, v78
    v_and_b32 v112, -4, v110
    v_add_u32 v112, v112, v2
    v_add_u32 v118, 0x7800000, v4
L2_x1_3:
    v_sub_u32 v113, v111, v112
    v_sub_u32 v115, v110, v112
    v_med3_i32 v114, v113, 0, 4
    v_max_i32 v115, 0, v115
    v_cmp_gt_i32 vcc, v114, v115
    v_mad_u32_u24 v116, v112, 5, v118
    v_bfm_b32 v114, v114, 28
    v_bfm_b32 v115, v115, 28
    v_mbcnt_lo_u32_b32 v117, vcc_lo, 0
    v_mbcnt_hi_u32_b32 v117, vcc_hi, v117
    v_bitop3_b32 v116, v114, v115, v116 bitop3:0x9a
    v_add_lshl_u32 v117, v117, s37, 2
    s_bcnt1_i32_b64 s41, vcc
    s_mov_b64 exec, vcc
    ds_write_b32 v117, v116
    s_mov_b64 exec, -1
    v_cmp_gt_i32 vcc, v113, v3
    s_add_u32 s37, s37, s41
    s_min_u32 s37, s37, s48
    s_cbranch_vccnz L2_xe1_3
L2_xr1_3:
    v_and_b32 v110, 0xffff, v80
    v_and_b32 v111, 0xffff, v82
    v_and_b32 v112, -4, v110
    v_add_u32 v112, v112, v2
    v_add_u32 v118, 0xa000000, v4
L2_x1_4:
    v_sub_u32 v113, v111, v112
    v_sub_u32 v115, v110, v112
    v_med3_i32 v114, v113, 0, 4
    v_max_i32 v115, 0, v115
    v_cmp_gt_i32 vcc, v114, v115
    v_mad_u32_u24 v116, v112, 5, v118
    v_bfm_b32 v114, v114, 28
    v_bfm_b32 v115, v115, 28
    v_mbcnt_lo_u32_b32 v117, vcc_lo, 0
    v_mbcnt_hi_u32_b32 v117, vcc_hi, v117
    v_bitop3_b32 v116, v114, v115, v116 bitop3:0x9a
    v_add_lshl_u32 v117, v117, s37, 2
    s_bcnt1_i32_b64 s41, vcc
    s_mov_b64 exec, vcc
    ds_write_b32 v117, v116
    s_mov_b64 exec, -1
    v_cmp_gt_i32 vcc, v113, v3
    s_add_u32 s37, s37, s41
    s_min_u32 s37, s37, s48
    s_cbranch_vccnz L2_xe1_4
L2_xr1_4:
    s_lshl_b32 s3, s37, 2
    v_add_u32 v117, s3, v1
    v_mov_b32 v116, -1
    ds_write_b32 v117, v116
    s_lshl_b32 s3, s38, 2
    v_add_u32 v117, s3, v1
    ds_read2st64_b32 v[40:41], v117 offset0:0 offset1:1
    ds_read2st64_b32 v[42:43], v117 offset0:2 offset1:3
    s_sub_u32 s41, s37, s38
    s_sub_u32 s3, s41, 192
    s_cmp_gt_u32 s3, 64
    s_cbranch_scc1 L2_xf1
L2_xg1:
    s_waitcnt lgkmcnt(0)
    v_and_b32 v109, 0x0fffffff, v40
    v_mov_b32 v36, v40
    buffer_load_dwordx4 v[16:19], v109, s[8:11], 0 offen
    buffer_load_dword v32, v109, s[8:11], 0 offen offset:16
    v_and_b32 v109, 0x0fffffff, v41
    v_mov_b32 v37, v41
    buffer_load_dwordx4 v[20:23], v109, s[8:11], 0 offen
    buffer_load_dword v33, v109, s[8:11], 0 offen offset:16
    v_and_b32 v109, 0x0fffffff, v42
    v_mov_b32 v38, v42
    buffer_load_dwordx4 v[24:27], v109, s[8:11], 0 offen
    buffer_load_dword v34, v109, s[8:11], 0 offen offset:16
    v_and_b32 v109, 0x0fffffff, v43
    v_mov_b32 v39, v43
    buffer_load_dwordx4 v[28:31], v109, s[8:11], 0 offen
    buffer_load_dword v35, v109, s[8:11], 0 offen offset:16
    s_waitcnt vmcnt(8)
    s_mov_b32 s37, s38
    s_add_u32 s48, s38, 257
    v_lshrrev_b32 v110, 16, v64
    v_lshrrev_b32 v111, 16, v66
    v_and_b32 v112, -4, v110
    v_add_u32 v112, v112, v2
L2_x2_0:
    v_sub_u32 v113, v111, v112
    v_sub_u32 v115, v110, v112
    v_med3_i32 v114, v113, 0, 4
    v_max_i32 v115, 0, v115
    v_cmp_gt_i32 vcc, v114, v115
    v_mad_u32_u24 v116, v112, 5, v4
    v_bfm_b32 v114, v114, 28
    v_bfm_b32 v115, v115, 28
    v_mbcnt_lo_u32_b32 v117, vcc_lo, 0
    v_mbcnt_hi_u32_b32 v117, vcc_hi, v117
    v_bitop3_b32 v116, v114, v115, v116 bitop3:0x9a
    v_add_lshl_u32 v117, v117, s37, 2
    s_bcnt1_i32_b64 s41, vcc
    s_mov_b64 exec, vcc
    ds_write_b32 v117, v116
    s_mov_b64 exec, -1
    v_cmp_gt_i32 vcc, v113, v3
    s_add_u32 s37, s37, s41
    s_min_u32 s37, s37, s48
    s_cbranch_vccnz L2_xe2_0
L2_xr2_0:
    ds_write_b128 v7, v[52:55] offset:2048
    v_lshrrev_b32 v110, 16, v68
    v_lshrrev_b32 v111, 16, v70
    v_and_b32 v112, -4, v110
    v_add_u32 v112, v112, v2
    v_add_u32 v118, 0x2800000, v4
L2_x2_1:
    v_sub_u32 v113, v111, v112
    v_sub_u32 v115, v110, v112
    v_med3_i32 v114, v113, 0, 4
    v_max_i32 v115, 0, v115
    v_cmp_gt_i32 vcc, v114, v115
    v_mad_u32_u24 v116, v112, 5, v118
    v_bfm_b32 v114, v114, 28
    v_bfm_b32 v115, v115, 28
    v_mbcnt_lo_u32_b32 v117, vcc_lo, 0
    v_mbcnt_hi_u32_b32 v117, vcc_hi, v117
    v_bitop3_b32 v116, v114, v115, v116 bitop3:0x9a
    v_add_lshl_u32 v117, v117, s37, 2
    s_bcnt1_i32_b64 s41, vcc
    s_mov_b64 exec, vcc
    ds_write_b32 v117, v116
    s_mov_b64 exec, -1
    v_cmp_gt_i32 vcc, v113, v3
    s_add_u32 s37, s37, s41
    s_min_u32 s37, s37, s48
    s_cbranch_vccnz L2_xe2_1
L2_xr2_1:
    ds_write_b128 v7, v[56:59] offset:3072
    v_lshrrev_b32 v110, 16, v72
    v_lshrrev_b32 v111, 16, v74
    v_and_b32 v112, -4, v110
    v_add_u32 v112, v112, v2
    v_add_u32 v118, 0x5000000, v4
L2_x2_2:
    v_sub_u32 v113, v111, v112
    v_sub_u32 v115, v110, v112
    v_med3_i32 v114, v113, 0, 4
    v_max_i32 v115, 0, v115
    v_cmp_gt_i32 vcc, v114, v115
    v_mad_u32_u24 v116, v112, 5, v118
    v_bfm_b32 v114, v114, 28
    v_bfm_b32 v115, v115, 28
    v_mbcnt_lo_u32_b32 v117, vcc_lo, 0
    v_mbcnt_hi_u32_b32 v117, vcc_hi, v117
    v_bitop3_b32 v116, v114, v115, v116 bitop3:0x9a
    v_add_lshl_u32 v117, v117, s37, 2
    s_bcnt1_i32_b64 s41, vcc
    s_mov_b64 exec, vcc
    ds_write_b32 v117, v116
    s_mov_b64 exec, -1
    v_cmp_gt_i32 vcc, v113, v3
    s_add_u32 s37, s37, s41
    s_min_u32 s37, s37, s48
    s_cbranch_vccnz L2_xe2_2
L2_xr2_2:
    ds_write_b128 v7, v[60:63] offset:4096
    v_lshrrev_b32 v110, 16, v76
    v_lshrrev_b32 v111, 16, v78
    v_and_b32 v112, -4, v110
    v_add_u32 v112, v112, v2
    v_add_u32 v118, 0x7800000, v4
L2_x2_3:
    v_sub_u32 v113, v111, v112
    v_sub_u32 v115, v110, v112
    v_med3_i32 v114, v113, 0, 4
    v_max_i32 v115, 0, v115
    v_cmp_gt_i32 vcc, v114, v115
    v_mad_u32_u24 v116, v112, 5, v118
    v_bfm_b32 v114, v114, 28
    v_bfm_b32 v115, v115, 28
    v_mbcnt_lo_u32_b32 v117, vcc_lo, 0
    v_mbcnt_hi_u32_b32 v117, vcc_hi, v117
    v_bitop3_b32 v116, v114, v115, v116 bitop3:0x9a
    v_add_lshl_u32 v117, v117, s37, 2
    s_bcnt1_i32_b64 s41, vcc
    s_mov_b64 exec, vcc
    ds_write_b32 v117, v116
    s_mov_b64 exec, -1
    v_cmp_gt_i32 vcc, v113, v3
    s_add_u32 s37, s37, s41
    s_min_u32 s37, s37, s48
    s_cbranch_vccnz L2_xe2_3
L2_xr2_3:
    v_lshrrev_b32 v110, 16, v80
    v_lshrrev_b32 v111, 16, v82
    v_and_b32 v112, -4, v110
    v_add_u32 v112, v112, v2
    v_add_u32 v118, 0xa000000, v4
L2_x2_4:
    v_sub_u32 v113, v111, v112
    v_sub_u32 v115, v110, v112
    v_med3_i32 v114, v113, 0, 4
    v_max_i32 v115, 0, v115
    v_cmp_gt_i32 vcc, v114, v115
    v_mad_u32_u24 v116, v112, 5, v118
    v_bfm_b32 v114, v114, 28
    v_bfm_b32 v115, v115, 28
    v_mbcnt_lo_u32_b32 v117, vcc_lo, 0
    v_mbcnt_hi_u32_b32 v117, vcc_hi, v117
    v_bitop3_b32 v116, v114, v115, v116 bitop3:0x9a
    v_add_lshl_u32 v117, v117, s37, 2
    s_bcnt1_i32_b64 s41, vcc
    s_mov_b64 exec, vcc
    ds_write_b32 v117, v116
    s_mov_b64 exec, -1
    v_cmp_gt_i32 vcc, v113, v3
    s_add_u32 s37, s37, s41
    s_min_u32 s37, s37, s48
    s_cbranch_vccnz L2_xe2_4
L2_xr2_4:
    s_lshl_b32 s3, s37, 2
    v_add_u32 v117, s3, v1
    v_mov_b32 v116, -1
    ds_write_b32 v117, v116
    s_lshl_b32 s3, s38, 2
    v_add_u32 v117, s3, v1
    ds_read2st64_b32 v[40:41], v117 offset0:0 offset1:1
    ds_read2st64_b32 v[42:43], v117 offset0:2 offset1:3
    s_sub_u32 s41, s37, s38
    s_sub_u32 s3, s41, 192
    s_cmp_gt_u32 s3, 64
    s_cbranch_scc1 L2_xf2
L2_xg2:
    ds_write_b128 v7, v[44:47] offset:0
    ds_write_b128 v7, v[48:51] offset:1024
    buffer_load_dwordx4 v[44:47], v6, s[16:19], s40 offen offset:0
    buffer_load_dwordx4 v[48:51], v6, s[16:19], s40 offen offset:1024
    buffer_load_dwordx4 v[52:55], v6, s[16:19], s40 offen offset:2048
    buffer_load_dwordx4 v[56:59], v6, s[16:19], s40 offen offset:3072
    s_add_u32 s3, s40, 4096
    buffer_load_dwordx4 v[60:63], v6, s[16:19], s3 offen
    s_add_u32 s40, s40, 80000
    s_waitcnt lgkmcnt(0)
    s_barrier
L2_loop:
    s_waitcnt vmcnt(11)
    v_and_b32 v108, 0x10000000, v36
    v_lshrrev_b32 v106, 14, v16
    v_bitop3_b32 v106, v106, v8, v108 bitop3:0xea
    ds_read_b64 v[84:85], v106 offset:63616
    v_perm_b32 v107, v16, v32, s44
    v_bitop3_b32 v104, v16, v8, v108 bitop3:0xea
    v_bitop3_b32 v107, v107, v9, v10 bitop3:0xea
    v_bitop3_b32 v107, v16, v11, v107 bitop3:0xea
    s_waitcnt lgkmcnt(0)
    v_mfma_f32_4x4x4_16b_bf16 v[92:95], v[12:13], v[84:85], 0
    ds_read_b64 v[86:87], v104
    s_nop 3
    v_mul_f32 v92, v107, v92
    v_mul_f32 v93, v107, v93
    v_mul_f32 v94, v107, v94
    v_mul_f32 v95, v107, v95
    v_and_b32 v108, 0x20000000, v36
    v_lshrrev_b32 v106, 14, v17
    v_bitop3_b32 v106, v106, v8, v108 bitop3:0xea
    ds_read_b64 v[84:85], v106 offset:63616
    s_waitcnt lgkmcnt(1)
    v_mfma_f32_4x4x4_16b_bf16 v[96:99], v[12:13], v[86:87], v[92:95]
    v_perm_b32 v107, v17, v32, s45
    v_bitop3_b32 v105, v17, v8, v108 bitop3:0xea
    v_bitop3_b32 v107, v107, v9, v10 bitop3:0xea
    v_bitop3_b32 v107, v17, v11, v107 bitop3:0xea
    s_nop 0
    v_cvt_pk_bf16_f32 v88, v96, v97
    v_cvt_pk_bf16_f32 v89, v98, v99
    ds_wrxchg_rtn_b64 v[90:91], v104, v[88:89]
    s_waitcnt lgkmcnt(1)
    v_mfma_f32_4x4x4_16b_bf16 v[92:95], v[12:13], v[84:85], 0
    s_waitcnt lgkmcnt(0)
    v_cmpx_ne_u64 vcc, v[90:91], v[86:87]
    s_cbranch_execz L2_c3
    s_nop 2
    v_mfma_f32_4x4x4_16b_bf16 v[100:103], v[14:15], v[86:87], 0
    s_nop 1
    v_mfma_f32_4x4x4_16b_bf16 v[100:103], v[12:13], v[90:91], v[100:103]
    s_nop 4
    v_cvt_pk_bf16_f32 v100, v100, v101
    v_cvt_pk_bf16_f32 v101, v102, v103
    ds_pk_add_bf16 v104, v100
    ds_pk_add_bf16 v104, v101 offset:4
L2_c3:
    s_mov_b64 exec, -1
    ds_read_b64 v[86:87], v105
    v_mul_f32 v92, v107, v92
    v_mul_f32 v93, v107, v93
    v_mul_f32 v94, v107, v94
    v_mul_f32 v95, v107, v95
    v_and_b32 v108, 0x40000000, v36
    v_lshrrev_b32 v106, 14, v18
    v_bitop3_b32 v106, v106, v8, v108 bitop3:0xea
    ds_read_b64 v[84:85], v106 offset:63616
    s_waitcnt lgkmcnt(1)
    v_mfma_f32_4x4x4_16b_bf16 v[96:99], v[12:13], v[86:87], v[92:95]
    v_perm_b32 v107, v18, v32, s46
    v_bitop3_b32 v104, v18, v8, v108 bitop3:0xea
    v_bitop3_b32 v107, v107, v9, v10 bitop3:0xea
    v_bitop3_b32 v107, v18, v11, v107 bitop3:0xea
    s_nop 0
    v_cvt_pk_bf16_f32 v88, v96, v97
    v_cvt_pk_bf16_f32 v89, v98, v99
    ds_wrxchg_rtn_b64 v[90:91], v105, v[88:89]
    s_waitcnt lgkmcnt(1)
    v_mfma_f32_4x4x4_16b_bf16 v[92:95], v[12:13], v[84:85], 0
    s_waitcnt lgkmcnt(0)
    v_cmpx_ne_u64 vcc, v[90:91], v[86:87]
    s_cbranch_execz L2_c4
    s_nop 2
    v_mfma_f32_4x4x4_16b_bf16 v[100:103], v[14:15], v[86:87], 0
    s_nop 1
    v_mfma_f32_4x4x4_16b_bf16 v[100:103], v[12:13], v[90:91], v[100:103]
    s_nop 4
    v_cvt_pk_bf16_f32 v100, v100, v101
    v_cvt_pk_bf16_f32 v101, v102, v103
    ds_pk_add_bf16 v105, v100
    ds_pk_add_bf16 v105, v101 offset:4
L2_c4:
    s_mov_b64 exec, -1
    ds_read_b64 v[86:87], v104
    v_mul_f32 v92, v107, v92
    v_mul_f32 v93, v107, v93
    v_mul_f32 v94, v107, v94
    v_mul_f32 v95, v107, v95
    v_and_b32 v108, 0x80000000, v36
    v_lshrrev_b32 v106, 14, v19
    v_bitop3_b32 v106, v106, v8, v108 bitop3:0xea
    ds_read_b64 v[84:85], v106 offset:63616
    s_waitcnt lgkmcnt(1)
    v_mfma_f32_4x4x4_16b_bf16 v[96:99], v[12:13], v[86:87], v[92:95]
    v_perm_b32 v107, v19, v32, s47
    v_bitop3_b32 v105, v19, v8, v108 bitop3:0xea
    v_bitop3_b32 v107, v107, v9, v10 bitop3:0xea
    v_bitop3_b32 v107, v19, v11, v107 bitop3:0xea
    v_and_b32 v109, 0x0fffffff, v40
    v_mov_b32 v36, v40
    buffer_load_dwordx4 v[16:19], v109, s[8:11], 0 offen
    buffer_load_dword v32, v109, s[8:11], 0 offen offset:16
    v_cvt_pk_bf16_f32 v88, v96, v97
    v_cvt_pk_bf16_f32 v89, v98, v99
    ds_wrxchg_rtn_b64 v[90:91], v104, v[88:89]
    s_waitcnt lgkmcnt(1)
    v_mfma_f32_4x4x4_16b_bf16 v[92:95], v[12:13], v[84:85], 0
    s_waitcnt lgkmcnt(0)
    v_cmpx_ne_u64 vcc, v[90:91], v[86:87]
    s_cbranch_execz L2_c5
    s_nop 2
    v_mfma_f32_4x4x4_16b_bf16 v[100:103], v[14:15], v[86:87], 0
    s_nop 1
    v_mfma_f32_4x4x4_16b_bf16 v[100:103], v[12:13], v[90:91], v[100:103]
    s_nop 4
    v_cvt_pk_bf16_f32 v100, v100, v101
    v_cvt_pk_bf16_f32 v101, v102, v103
    ds_pk_add_bf16 v104, v100
    ds_pk_add_bf16 v104, v101 offset:4
L2_c5:
    s_mov_b64 exec, -1
    ds_read_b64 v[86:87], v105
    v_mul_f32 v92, v107, v92
    v_mul_f32 v93, v107, v93
    v_mul_f32 v94, v107, v94
    v_mul_f32 v95, v107, v95
    s_waitcnt vmcnt(11)
    v_and_b32 v108, 0x10000000, v37
    v_lshrrev_b32 v106, 14, v20
    v_bitop3_b32 v106, v106, v8, v108 bitop3:0xea
    ds_read_b64 v[84:85], v106 offset:63616
    s_waitcnt lgkmcnt(1)
    v_mfma_f32_4x4x4_16b_bf16 v[96:99], v[12:13], v[86:87], v[92:95]
    v_perm_b32 v107, v20, v33, s44
    v_bitop3_b32 v104, v20, v8, v108 bitop3:0xea
    v_bitop3_b32 v107, v107, v9, v10 bitop3:0xea
    v_bitop3_b32 v107, v20, v11, v107 bitop3:0xea
    s_nop 0
    v_cvt_pk_bf16_f32 v88, v96, v97
    v_cvt_pk_bf16_f32 v89, v98, v99
    ds_wrxchg_rtn_b64 v[90:91], v105, v[88:89]
    s_waitcnt lgkmcnt(1)
    v_mfma_f32_4x4x4_16b_bf16 v[92:95], v[12:13], v[84:85], 0
    s_waitcnt lgkmcnt(0)
    v_cmpx_ne_u64 vcc, v[90:91], v[86:87]
    s_cbranch_execz L2_c6
    s_nop 2
    v_mfma_f32_4x4x4_16b_bf16 v[100:103], v[14:15], v[86:87], 0
    s_nop 1
    v_mfma_f32_4x4x4_16b_bf16 v[100:103], v[12:13], v[90:91], v[100:103]
    s_nop 4
    v_cvt_pk_bf16_f32 v100, v100, v101
    v_cvt_pk_bf16_f32 v101, v102, v103
    ds_pk_add_bf16 v105, v100
    ds_pk_add_bf16 v105, v101 offset:4
L2_c6:
    s_mov_b64 exec, -1
    ds_read_b64 v[86:87], v104
    v_mul_f32 v92, v107, v92
    v_mul_f32 v93, v107, v93
    v_mul_f32 v94, v107, v94
    v_mul_f32 v95, v107, v95
    v_and_b32 v108, 0x20000000, v37
    v_lshrrev_b32 v106, 14, v21
    v_bitop3_b32 v106, v106, v8, v108 bitop3:0xea
    ds_read_b64 v[84:85], v106 offset:63616
    s_waitcnt lgkmcnt(1)
    v_mfma_f32_4x4x4_16b_bf16 v[96:99], v[12:13], v[86:87], v[92:95]
    v_perm_b32 v107, v21, v33, s45
    v_bitop3_b32 v105, v21, v8, v108 bitop3:0xea
    v_bitop3_b32 v107, v107, v9, v10 bitop3:0xea
    v_bitop3_b32 v107, v21, v11, v107 bitop3:0xea
    s_nop 0
    v_cvt_pk_bf16_f32 v88, v96, v97
    v_cvt_pk_bf16_f32 v89, v98, v99
    ds_wrxchg_rtn_b64 v[90:91], v104, v[88:89]
    s_waitcnt lgkmcnt(1)
    v_mfma_f32_4x4x4_16b_bf16 v[92:95], v[12:13], v[84:85], 0
    s_waitcnt lgkmcnt(0)
    v_cmpx_ne_u64 vcc, v[90:91], v[86:87]
    s_cbranch_execz L2_c7
    s_nop 2
    v_mfma_f32_4x4x4_16b_bf16 v[100:103], v[14:15], v[86:87], 0
    s_nop 1
    v_mfma_f32_4x4x4_16b_bf16 v[100:103], v[12:13], v[90:91], v[100:103]
    s_nop 4
    v_cvt_pk_bf16_f32 v100, v100, v101
    v_cvt_pk_bf16_f32 v101, v102, v103
    ds_pk_add_bf16 v104, v100
    ds_pk_add_bf16 v104, v101 offset:4
L2_c7:
    s_mov_b64 exec, -1
    ds_read_b64 v[86:87], v105
    v_mul_f32 v92, v107, v92
    v_mul_f32 v93, v107, v93
    v_mul_f32 v94, v107, v94
    v_mul_f32 v95, v107, v95
    v_and_b32 v108, 0x40000000, v37
    v_lshrrev_b32 v106, 14, v22
    v_bitop3_b32 v106, v106, v8, v108 bitop3:0xea
    ds_read_b64 v[84:85], v106 offset:63616
    s_waitcnt lgkmcnt(1)
    v_mfma_f32_4x4x4_16b_bf16 v[96:99], v[12:13], v[86:87], v[92:95]
    v_perm_b32 v107, v22, v33, s46
    v_bitop3_b32 v104, v22, v8, v108 bitop3:0xea
    v_bitop3_b32 v107, v107, v9, v10 bitop3:0xea
    v_bitop3_b32 v107, v22, v11, v107 bitop3:0xea
    s_nop 0
    v_cvt_pk_bf16_f32 v88, v96, v97
    v_cvt_pk_bf16_f32 v89, v98, v99
    ds_wrxchg_rtn_b64 v[90:91], v105, v[88:89]
    s_waitcnt lgkmcnt(1)
    v_mfma_f32_4x4x4_16b_bf16 v[92:95], v[12:13], v[84:85], 0
    s_waitcnt lgkmcnt(0)
    v_cmpx_ne_u64 vcc, v[90:91], v[86:87]
    s_cbranch_execz L2_c8
    s_nop 2
    v_mfma_f32_4x4x4_16b_bf16 v[100:103], v[14:15], v[86:87], 0
    s_nop 1
    v_mfma_f32_4x4x4_16b_bf16 v[100:103], v[12:13], v[90:91], v[100:103]
    s_nop 4
    v_cvt_pk_bf16_f32 v100, v100, v101
    v_cvt_pk_bf16_f32 v101, v102, v103
    ds_pk_add_bf16 v105, v100
    ds_pk_add_bf16 v105, v101 offset:4
L2_c8:
    s_mov_b64 exec, -1
    ds_read_b64 v[86:87], v104
    v_mul_f32 v92, v107, v92
    v_mul_f32 v93, v107, v93
    v_mul_f32 v94, v107, v94
    v_mul_f32 v95, v107, v95
    v_and_b32 v108, 0x80000000, v37
    v_lshrrev_b32 v106, 14, v23
    v_bitop3_b32 v106, v106, v8, v108 bitop3:0xea
    ds_read_b64 v[84:85], v106 offset:63616
    s_waitcnt lgkmcnt(1)
    v_mfma_f32_4x4x4_16b_bf16 v[96:99], v[12:13], v[86:87], v[92:95]
    v_perm_b32 v107, v23, v33, s47
    v_bitop3_b32 v105, v23, v8, v108 bitop3:0xea
    v_bitop3_b32 v107, v107, v9, v10 bitop3:0xea
    v_bitop3_b32 v107, v23, v11, v107 bitop3:0xea
    v_and_b32 v109, 0x0fffffff, v41
    v_mov_b32 v37, v41
    buffer_load_dwordx4 v[20:23], v109, s[8:11], 0 offen
    buffer_load_dword v33, v109, s[8:11], 0 offen offset:16
    v_cvt_pk_bf16_f32 v88, v96, v97
    v_cvt_pk_bf16_f32 v89, v98, v99
    ds_wrxchg_rtn_b64 v[90:91], v104, v[88:89]
    s_waitcnt lgkmcnt(1)
    v_mfma_f32_4x4x4_16b_bf16 v[92:95], v[12:13], v[84:85], 0
    s_waitcnt lgkmcnt(0)
    v_cmpx_ne_u64 vcc, v[90:91], v[86:87]
    s_cbranch_execz L2_c9
    s_nop 2
    v_mfma_f32_4x4x4_16b_bf16 v[100:103], v[14:15], v[86:87], 0
    s_nop 1
    v_mfma_f32_4x4x4_16b_bf16 v[100:103], v[12:13], v[90:91], v[100:103]
    s_nop 4
    v_cvt_pk_bf16_f32 v100, v100, v101
    v_cvt_pk_bf16_f32 v101, v102, v103
    ds_pk_add_bf16 v104, v100
    ds_pk_add_bf16 v104, v101 offset:4
L2_c9:
    s_mov_b64 exec, -1
    ds_read_b64 v[86:87], v105
    v_mul_f32 v92, v107, v92
    v_mul_f32 v93, v107, v93
    v_mul_f32 v94, v107, v94
    v_mul_f32 v95, v107, v95
    s_waitcnt vmcnt(11)
    v_and_b32 v108, 0x10000000, v38
    v_lshrrev_b32 v106, 14, v24
    v_bitop3_b32 v106, v106, v8, v108 bitop3:0xea
    ds_read_b64 v[84:85], v106 offset:63616
    s_waitcnt lgkmcnt(1)
    v_mfma_f32_4x4x4_16b_bf16 v[96:99], v[12:13], v[86:87], v[92:95]
    v_perm_b32 v107, v24, v34, s44
    v_bitop3_b32 v104, v24, v8, v108 bitop3:0xea
    v_bitop3_b32 v107, v107, v9, v10 bitop3:0xea
    v_bitop3_b32 v107, v24, v11, v107 bitop3:0xea
    s_nop 0
    v_cvt_pk_bf16_f32 v88, v96, v97
    v_cvt_pk_bf16_f32 v89, v98, v99
    ds_wrxchg_rtn_b64 v[90:91], v105, v[88:89]
    s_waitcnt lgkmcnt(1)
    v_mfma_f32_4x4x4_16b_bf16 v[92:95], v[12:13], v[84:85], 0
    s_waitcnt lgkmcnt(0)
    v_cmpx_ne_u64 vcc, v[90:91], v[86:87]
    s_cbranch_execz L2_c10
    s_nop 2
    v_mfma_f32_4x4x4_16b_bf16 v[100:103], v[14:15], v[86:87], 0
    s_nop 1
    v_mfma_f32_4x4x4_16b_bf16 v[100:103], v[12:13], v[90:91], v[100:103]
    s_nop 4
    v_cvt_pk_bf16_f32 v100, v100, v101
    v_cvt_pk_bf16_f32 v101, v102, v103
    ds_pk_add_bf16 v105, v100
    ds_pk_add_bf16 v105, v101 offset:4
L2_c10:
    s_mov_b64 exec, -1
    ds_read_b64 v[86:87], v104
    v_mul_f32 v92, v107, v92
    v_mul_f32 v93, v107, v93
    v_mul_f32 v94, v107, v94
    v_mul_f32 v95, v107, v95
    v_and_b32 v108, 0x20000000, v38
    v_lshrrev_b32 v106, 14, v25
    v_bitop3_b32 v106, v106, v8, v108 bitop3:0xea
    ds_read_b64 v[84:85], v106 offset:63616
    s_waitcnt lgkmcnt(1)
    v_mfma_f32_4x4x4_16b_bf16 v[96:99], v[12:13], v[86:87], v[92:95]
    v_perm_b32 v107, v25, v34, s45
    v_bitop3_b32 v105, v25, v8, v108 bitop3:0xea
    v_bitop3_b32 v107, v107, v9, v10 bitop3:0xea
    v_bitop3_b32 v107, v25, v11, v107 bitop3:0xea
    s_nop 0
    v_cvt_pk_bf16_f32 v88, v96, v97
    v_cvt_pk_bf16_f32 v89, v98, v99
    ds_wrxchg_rtn_b64 v[90:91], v104, v[88:89]
    s_waitcnt lgkmcnt(1)
    v_mfma_f32_4x4x4_16b_bf16 v[92:95], v[12:13], v[84:85], 0
    s_waitcnt lgkmcnt(0)
    v_cmpx_ne_u64 vcc, v[90:91], v[86:87]
    s_cbranch_execz L2_c11
    s_nop 2
    v_mfma_f32_4x4x4_16b_bf16 v[100:103], v[14:15], v[86:87], 0
    s_nop 1
    v_mfma_f32_4x4x4_16b_bf16 v[100:103], v[12:13], v[90:91], v[100:103]
    s_nop 4
    v_cvt_pk_bf16_f32 v100, v100, v101
    v_cvt_pk_bf16_f32 v101, v102, v103
    ds_pk_add_bf16 v104, v100
    ds_pk_add_bf16 v104, v101 offset:4
L2_c11:
    s_mov_b64 exec, -1
    ds_read_b64 v[86:87], v105
    v_mul_f32 v92, v107, v92
    v_mul_f32 v93, v107, v93
    v_mul_f32 v94, v107, v94
    v_mul_f32 v95, v107, v95
    v_and_b32 v108, 0x40000000, v38
    v_lshrrev_b32 v106, 14, v26
    v_bitop3_b32 v106, v106, v8, v108 bitop3:0xea
    ds_read_b64 v[84:85], v106 offset:63616
    s_waitcnt lgkmcnt(1)
    v_mfma_f32_4x4x4_16b_bf16 v[96:99], v[12:13], v[86:87], v[92:95]
    v_perm_b32 v107, v26, v34, s46
    v_bitop3_b32 v104, v26, v8, v108 bitop3:0xea
    v_bitop3_b32 v107, v107, v9, v10 bitop3:0xea
    v_bitop3_b32 v107, v26, v11, v107 bitop3:0xea
    s_nop 0
    v_cvt_pk_bf16_f32 v88, v96, v97
    v_cvt_pk_bf16_f32 v89, v98, v99
    ds_wrxchg_rtn_b64 v[90:91], v105, v[88:89]
    s_waitcnt lgkmcnt(1)
    v_mfma_f32_4x4x4_16b_bf16 v[92:95], v[12:13], v[84:85], 0
    s_waitcnt lgkmcnt(0)
    v_cmpx_ne_u64 vcc, v[90:91], v[86:87]
    s_cbranch_execz L2_c12
    s_nop 2
    v_mfma_f32_4x4x4_16b_bf16 v[100:103], v[14:15], v[86:87], 0
    s_nop 1
    v_mfma_f32_4x4x4_16b_bf16 v[100:103], v[12:13], v[90:91], v[100:103]
    s_nop 4
    v_cvt_pk_bf16_f32 v100, v100, v101
    v_cvt_pk_bf16_f32 v101, v102, v103
    ds_pk_add_bf16 v105, v100
    ds_pk_add_bf16 v105, v101 offset:4
L2_c12:
    s_mov_b64 exec, -1
    ds_read_b64 v[86:87], v104
    v_mul_f32 v92, v107, v92
    v_mul_f32 v93, v107, v93
    v_mul_f32 v94, v107, v94
    v_mul_f32 v95, v107, v95
    v_and_b32 v108, 0x80000000, v38
    v_lshrrev_b32 v106, 14, v27
    v_bitop3_b32 v106, v106, v8, v108 bitop3:0xea
    ds_read_b64 v[84:85], v106 offset:63616
    s_waitcnt lgkmcnt(1)
    v_mfma_f32_4x4x4_16b_bf16 v[96:99], v[12:13], v[86:87], v[92:95]
    v_perm_b32 v107, v27, v34, s47
    v_bitop3_b32 v105, v27, v8, v108 bitop3:0xea
    v_bitop3_b32 v107, v107, v9, v10 bitop3:0xea
    v_bitop3_b32 v107, v27, v11, v107 bitop3:0xea
    v_and_b32 v109, 0x0fffffff, v42
    v_mov_b32 v38, v42
    buffer_load_dwordx4 v[24:27], v109, s[8:11], 0 offen
    buffer_load_dword v34, v109, s[8:11], 0 offen offset:16
    v_cvt_pk_bf16_f32 v88, v96, v97
    v_cvt_pk_bf16_f32 v89, v98, v99
    ds_wrxchg_rtn_b64 v[90:91], v104, v[88:89]
    s_waitcnt lgkmcnt(1)
    v_mfma_f32_4x4x4_16b_bf16 v[92:95], v[12:13], v[84:85], 0
    s_waitcnt lgkmcnt(0)
    v_cmpx_ne_u64 vcc, v[90:91], v[86:87]
    s_cbranch_execz L2_c13
    s_nop 2
    v_mfma_f32_4x4x4_16b_bf16 v[100:103], v[14:15], v[86:87], 0
    s_nop 1
    v_mfma_f32_4x4x4_16b_bf16 v[100:103], v[12:13], v[90:91], v[100:103]
    s_nop 4
    v_cvt_pk_bf16_f32 v100, v100, v101
    v_cvt_pk_bf16_f32 v101, v102, v103
    ds_pk_add_bf16 v104, v100
    ds_pk_add_bf16 v104, v101 offset:4
L2_c13:
    s_mov_b64 exec, -1
    ds_read_b64 v[86:87], v105
    v_mul_f32 v92, v107, v92
    v_mul_f32 v93, v107, v93
    v_mul_f32 v94, v107, v94
    v_mul_f32 v95, v107, v95
    s_waitcnt vmcnt(11)
    v_and_b32 v108, 0x10000000, v39
    v_lshrrev_b32 v106, 14, v28
    v_bitop3_b32 v106, v106, v8, v108 bitop3:0xea
    ds_read_b64 v[84:85], v106 offset:63616
    s_waitcnt lgkmcnt(1)
    v_mfma_f32_4x4x4_16b_bf16 v[96:99], v[12:13], v[86:87], v[92:95]
    v_perm_b32 v107, v28, v35, s44
    v_bitop3_b32 v104, v28, v8, v108 bitop3:0xea
    v_bitop3_b32 v107, v107, v9, v10 bitop3:0xea
    v_bitop3_b32 v107, v28, v11, v107 bitop3:0xea
    s_nop 0
    v_cvt_pk_bf16_f32 v88, v96, v97
    v_cvt_pk_bf16_f32 v89, v98, v99
    ds_wrxchg_rtn_b64 v[90:91], v105, v[88:89]
    s_waitcnt lgkmcnt(1)
    v_mfma_f32_4x4x4_16b_bf16 v[92:95], v[12:13], v[84:85], 0
    s_waitcnt lgkmcnt(0)
    v_cmpx_ne_u64 vcc, v[90:91], v[86:87]
    s_cbranch_execz L2_c14
    s_nop 2
    v_mfma_f32_4x4x4_16b_bf16 v[100:103], v[14:15], v[86:87], 0
    s_nop 1
    v_mfma_f32_4x4x4_16b_bf16 v[100:103], v[12:13], v[90:91], v[100:103]
    s_nop 4
    v_cvt_pk_bf16_f32 v100, v100, v101
    v_cvt_pk_bf16_f32 v101, v102, v103
    ds_pk_add_bf16 v105, v100
    ds_pk_add_bf16 v105, v101 offset:4
L2_c14:
    s_mov_b64 exec, -1
    ds_read_b64 v[86:87], v104
    v_mul_f32 v92, v107, v92
    v_mul_f32 v93, v107, v93
    v_mul_f32 v94, v107, v94
    v_mul_f32 v95, v107, v95
    v_and_b32 v108, 0x20000000, v39
    v_lshrrev_b32 v106, 14, v29
    v_bitop3_b32 v106, v106, v8, v108 bitop3:0xea
    ds_read_b64 v[84:85], v106 offset:63616
    s_waitcnt lgkmcnt(1)
    v_mfma_f32_4x4x4_16b_bf16 v[96:99], v[12:13], v[86:87], v[92:95]
    v_perm_b32 v107, v29, v35, s45
    v_bitop3_b32 v105, v29, v8, v108 bitop3:0xea
    v_bitop3_b32 v107, v107, v9, v10 bitop3:0xea
    v_bitop3_b32 v107, v29, v11, v107 bitop3:0xea
    s_nop 0
    v_cvt_pk_bf16_f32 v88, v96, v97
    v_cvt_pk_bf16_f32 v89, v98, v99
    ds_wrxchg_rtn_b64 v[90:91], v104, v[88:89]
    s_waitcnt lgkmcnt(1)
    v_mfma_f32_4x4x4_16b_bf16 v[92:95], v[12:13], v[84:85], 0
    s_waitcnt lgkmcnt(0)
    v_cmpx_ne_u64 vcc, v[90:91], v[86:87]
    s_cbranch_execz L2_c15
    s_nop 2
    v_mfma_f32_4x4x4_16b_bf16 v[100:103], v[14:15], v[86:87], 0
    s_nop 1
    v_mfma_f32_4x4x4_16b_bf16 v[100:103], v[12:13], v[90:91], v[100:103]
    s_nop 4
    v_cvt_pk_bf16_f32 v100, v100, v101
    v_cvt_pk_bf16_f32 v101, v102, v103
    ds_pk_add_bf16 v104, v100
    ds_pk_add_bf16 v104, v101 offset:4
L2_c15:
    s_mov_b64 exec, -1
    ds_read_b64 v[86:87], v105
    v_mul_f32 v92, v107, v92
    v_mul_f32 v93, v107, v93
    v_mul_f32 v94, v107, v94
    v_mul_f32 v95, v107, v95
    v_and_b32 v108, 0x40000000, v39
    v_lshrrev_b32 v106, 14, v30
    v_bitop3_b32 v106, v106, v8, v108 bitop3:0xea
    ds_read_b64 v[84:85], v106 offset:63616
    s_waitcnt lgkmcnt(1)
    v_mfma_f32_4x4x4_16b_bf16 v[96:99], v[12:13], v[86:87], v[92:95]
    v_perm_b32 v107, v30, v35, s46
    v_bitop3_b32 v104, v30, v8, v108 bitop3:0xea
    v_bitop3_b32 v107, v107, v9, v10 bitop3:0xea
    v_bitop3_b32 v107, v30, v11, v107 bitop3:0xea
    s_nop 0
    v_cvt_pk_bf16_f32 v88, v96, v97
    v_cvt_pk_bf16_f32 v89, v98, v99
    ds_wrxchg_rtn_b64 v[90:91], v105, v[88:89]
    s_waitcnt lgkmcnt(1)
    v_mfma_f32_4x4x4_16b_bf16 v[92:95], v[12:13], v[84:85], 0
    s_waitcnt lgkmcnt(0)
    v_cmpx_ne_u64 vcc, v[90:91], v[86:87]
    s_cbranch_execz L2_c16
    s_nop 2
    v_mfma_f32_4x4x4_16b_bf16 v[100:103], v[14:15], v[86:87], 0
    s_nop 1
    v_mfma_f32_4x4x4_16b_bf16 v[100:103], v[12:13], v[90:91], v[100:103]
    s_nop 4
    v_cvt_pk_bf16_f32 v100, v100, v101
    v_cvt_pk_bf16_f32 v101, v102, v103
    ds_pk_add_bf16 v105, v100
    ds_pk_add_bf16 v105, v101 offset:4
L2_c16:
    s_mov_b64 exec, -1
    ds_read_b64 v[86:87], v104
    v_mul_f32 v92, v107, v92
    v_mul_f32 v93, v107, v93
    v_mul_f32 v94, v107, v94
    v_mul_f32 v95, v107, v95
    v_and_b32 v108, 0x80000000, v39
    v_lshrrev_b32 v106, 14, v31
    v_bitop3_b32 v106, v106, v8, v108 bitop3:0xea
    ds_read_b64 v[84:85], v106 offset:63616
    s_waitcnt lgkmcnt(1)
    v_mfma_f32_4x4x4_16b_bf16 v[96:99], v[12:13], v[86:87], v[92:95]
    v_perm_b32 v107, v31, v35, s47
    v_bitop3_b32 v105, v31, v8, v108 bitop3:0xea
    v_bitop3_b32 v107, v107, v9, v10 bitop3:0xea
    v_bitop3_b32 v107, v31, v11, v107 bitop3:0xea
    v_and_b32 v109, 0x0fffffff, v43
    v_mov_b32 v39, v43
    buffer_load_dwordx4 v[28:31], v109, s[8:11], 0 offen
    buffer_load_dword v35, v109, s[8:11], 0 offen offset:16
    v_cvt_pk_bf16_f32 v88, v96, v97
    v_cvt_pk_bf16_f32 v89, v98, v99
    ds_wrxchg_rtn_b64 v[90:91], v104, v[88:89]
    s_waitcnt lgkmcnt(1)
    v_mfma_f32_4x4x4_16b_bf16 v[92:95], v[12:13], v[84:85], 0
    s_waitcnt lgkmcnt(0)
    v_cmpx_ne_u64 vcc, v[90:91], v[86:87]
    s_cbranch_execz L2_c17
    s_nop 2
    v_mfma_f32_4x4x4_16b_bf16 v[100:103], v[14:15], v[86:87], 0
    s_nop 1
    v_mfma_f32_4x4x4_16b_bf16 v[100:103], v[12:13], v[90:91], v[100:103]
    s_nop 4
    v_cvt_pk_bf16_f32 v100, v100, v101
    v_cvt_pk_bf16_f32 v101, v102, v103
    ds_pk_add_bf16 v104, v100
    ds_pk_add_bf16 v104, v101 offset:4
L2_c17:
    s_mov_b64 exec, -1
    ds_read_b64 v[86:87], v105
    v_mul_f32 v92, v107, v92
    v_mul_f32 v93, v107, v93
    v_mul_f32 v94, v107, v94
    v_mul_f32 v95, v107, v95
    s_waitcnt lgkmcnt(0)
    s_nop 0
    v_mfma_f32_4x4x4_16b_bf16 v[96:99], v[12:13], v[86:87], v[92:95]
    s_nop 4
    v_cvt_pk_bf16_f32 v88, v96, v97
    v_cvt_pk_bf16_f32 v89, v98, v99
    ds_wrxchg_rtn_b64 v[90:91], v105, v[88:89]
    s_waitcnt lgkmcnt(0)
    v_cmpx_ne_u64 vcc, v[90:91], v[86:87]
    s_cbranch_execz L2_c18
    s_nop 2
    v_mfma_f32_4x4x4_16b_bf16 v[100:103], v[14:15], v[86:87], 0
    s_nop 1
    v_mfma_f32_4x4x4_16b_bf16 v[100:103], v[12:13], v[90:91], v[100:103]
    s_nop 4
    v_cvt_pk_bf16_f32 v100, v100, v101
    v_cvt_pk_bf16_f32 v101, v102, v103
    ds_pk_add_bf16 v105, v100
    ds_pk_add_bf16 v105, v101 offset:4
L2_c18:
    s_mov_b64 exec, -1
    s_bitcmp1_b32 s36, s42
    s_cbranch_scc1 L2_slow
L2_ret0:
    s_barrier
    s_waitcnt vmcnt(8)
    s_mov_b32 s37, s38
    s_add_u32 s48, s38, 257
    v_and_b32 v110, 0xffff, v65
    v_and_b32 v111, 0xffff, v67
    v_and_b32 v112, -4, v110
    v_add_u32 v112, v112, v2
L2_x19_0:
    v_sub_u32 v113, v111, v112
    v_sub_u32 v115, v110, v112
    v_med3_i32 v114, v113, 0, 4
    v_max_i32 v115, 0, v115
    v_cmp_gt_i32 vcc, v114, v115
    v_mad_u32_u24 v116, v112, 5, v4
    v_bfm_b32 v114, v114, 28
    v_bfm_b32 v115, v115, 28
    v_mbcnt_lo_u32_b32 v117, vcc_lo, 0
    v_mbcnt_hi_u32_b32 v117, vcc_hi, v117
    v_bitop3_b32 v116, v114, v115, v116 bitop3:0x9a
    v_add_lshl_u32 v117, v117, s37, 2
    s_bcnt1_i32_b64 s41, vcc
    s_mov_b64 exec, vcc
    ds_write_b32 v117, v116
    s_mov_b64 exec, -1
    v_cmp_gt_i32 vcc, v113, v3
    s_add_u32 s37, s37, s41
    s_min_u32 s37, s37, s48
    s_cbranch_vccnz L2_xe19_0
L2_xr19_0:
    ds_write_b128 v7, v[52:55] offset:2048
    v_and_b32 v110, 0xffff, v69
    v_and_b32 v111, 0xffff, v71
    v_and_b32 v112, -4, v110
    v_add_u32 v112, v112, v2
    v_add_u32 v118, 0x2800000, v4
L2_x19_1:
    v_sub_u32 v113, v111, v112
    v_sub_u32 v115, v110, v112
    v_med3_i32 v114, v113, 0, 4
    v_max_i32 v115, 0, v115
    v_cmp_gt_i32 vcc, v114, v115
    v_mad_u32_u24 v116, v112, 5, v118
    v_bfm_b32 v114, v114, 28
    v_bfm_b32 v115, v115, 28
    v_mbcnt_lo_u32_b32 v117, vcc_lo, 0
    v_mbcnt_hi_u32_b32 v117, vcc_hi, v117
    v_bitop3_b32 v116, v114, v115, v116 bitop3:0x9a
    v_add_lshl_u32 v117, v117, s37, 2
    s_bcnt1_i32_b64 s41, vcc
    s_mov_b64 exec, vcc
    ds_write_b32 v117, v116
    s_mov_b64 exec, -1
    v_cmp_gt_i32 vcc, v113, v3
    s_add_u32 s37, s37, s41
    s_min_u32 s37, s37, s48
    s_cbranch_vccnz L2_xe19_1
L2_xr19_1:
    ds_write_b128 v7, v[56:59] offset:3072
    v_and_b32 v110, 0xffff, v73
    v_and_b32 v111, 0xffff, v75
    v_and_b32 v112, -4, v110
    v_add_u32 v112, v112, v2
    v_add_u32 v118, 0x5000000, v4
L2_x19_2:
    v_sub_u32 v113, v111, v112
    v_sub_u32 v115, v110, v112
    v_med3_i32 v114, v113, 0, 4
    v_max_i32 v115, 0, v115
    v_cmp_gt_i32 vcc, v114, v115
    v_mad_u32_u24 v116, v112, 5, v118
    v_bfm_b32 v114, v114, 28
    v_bfm_b32 v115, v115, 28
    v_mbcnt_lo_u32_b32 v117, vcc_lo, 0
    v_mbcnt_hi_u32_b32 v117, vcc_hi, v117
    v_bitop3_b32 v116, v114, v115, v116 bitop3:0x9a
    v_add_lshl_u32 v117, v117, s37, 2
    s_bcnt1_i32_b64 s41, vcc
    s_mov_b64 exec, vcc
    ds_write_b32 v117, v116
    s_mov_b64 exec, -1
    v_cmp_gt_i32 vcc, v113, v3
    s_add_u32 s37, s37, s41
    s_min_u32 s37, s37, s48
    s_cbranch_vccnz L2_xe19_2
L2_xr19_2:
    ds_write_b128 v7, v[60:63] offset:4096
    v_and_b32 v110, 0xffff, v77
    v_and_b32 v111, 0xffff, v79
    v_and_b32 v112, -4, v110
    v_add_u32 v112, v112, v2
    v_add_u32 v118, 0x7800000, v4
L2_x19_3:
    v_sub_u32 v113, v111, v112
    v_sub_u32 v115, v110, v112
    v_med3_i32 v114, v113, 0, 4
    v_max_i32 v115, 0, v115
    v_cmp_gt_i32 vcc, v114, v115
    v_mad_u32_u24 v116, v112, 5, v118
    v_bfm_b32 v114, v114, 28
    v_bfm_b32 v115, v115, 28
    v_mbcnt_lo_u32_b32 v117, vcc_lo, 0
    v_mbcnt_hi_u32_b32 v117, vcc_hi, v117
    v_bitop3_b32 v116, v114, v115, v116 bitop3:0x9a
    v_add_lshl_u32 v117, v117, s37, 2
    s_bcnt1_i32_b64 s41, vcc
    s_mov_b64 exec, vcc
    ds_write_b32 v117, v116
    s_mov_b64 exec, -1
    v_cmp_gt_i32 vcc, v113, v3
    s_add_u32 s37, s37, s41
    s_min_u32 s37, s37, s48
    s_cbranch_vccnz L2_xe19_3
L2_xr19_3:
    v_and_b32 v110, 0xffff, v81
    v_and_b32 v111, 0xffff, v83
    v_and_b32 v112, -4, v110
    v_add_u32 v112, v112, v2
    v_add_u32 v118, 0xa000000, v4
L2_x19_4:
    v_sub_u32 v113, v111, v112
    v_sub_u32 v115, v110, v112
    v_med3_i32 v114, v113, 0, 4
    v_max_i32 v115, 0, v115
    v_cmp_gt_i32 vcc, v114, v115
    v_mad_u32_u24 v116, v112, 5, v118
    v_bfm_b32 v114, v114, 28
    v_bfm_b32 v115, v115, 28
    v_mbcnt_lo_u32_b32 v117, vcc_lo, 0
    v_mbcnt_hi_u32_b32 v117, vcc_hi, v117
    v_bitop3_b32 v116, v114, v115, v116 bitop3:0x9a
    v_add_lshl_u32 v117, v117, s37, 2
    s_bcnt1_i32_b64 s41, vcc
    s_mov_b64 exec, vcc
    ds_write_b32 v117, v116
    s_mov_b64 exec, -1
    v_cmp_gt_i32 vcc, v113, v3
    s_add_u32 s37, s37, s41
    s_min_u32 s37, s37, s48
    s_cbranch_vccnz L2_xe19_4
L2_xr19_4:
    s_lshl_b32 s3, s37, 2
    v_add_u32 v117, s3, v1
    v_mov_b32 v116, -1
    ds_write_b32 v117, v116
    s_lshl_b32 s3, s38, 2
    v_add_u32 v117, s3, v1
    ds_read2st64_b32 v[40:41], v117 offset0:0 offset1:1
    ds_read2st64_b32 v[42:43], v117 offset0:2 offset1:3
    s_sub_u32 s41, s37, s38
    s_sub_u32 s3, s41, 192
    s_cmp_gt_u32 s3, 64
    s_cbranch_scc1 L2_xf19
L2_xg19:
    ds_write_b128 v7, v[44:47] offset:0
    ds_write_b128 v7, v[48:51] offset:1024
    buffer_load_dwordx4 v[44:47], v6, s[16:19], s40 offen offset:0
    buffer_load_dwordx4 v[48:51], v6, s[16:19], s40 offen offset:1024
    buffer_load_dwordx4 v[52:55], v6, s[16:19], s40 offen offset:2048
    buffer_load_dwordx4 v[56:59], v6, s[16:19], s40 offen offset:3072
    s_add_u32 s3, s40, 4096
    buffer_load_dwordx4 v[60:63], v6, s[16:19], s3 offen
    s_add_u32 s40, s40, 80000
    s_add_u32 s42, s42, 1
    s_waitcnt lgkmcnt(0)
    s_barrier
    s_waitcnt vmcnt(11)
    v_and_b32 v108, 0x10000000, v36
    v_lshrrev_b32 v106, 14, v16
    v_bitop3_b32 v106, v106, v8, v108 bitop3:0xea
    ds_read_b64 v[84:85], v106 offset:63616
    v_perm_b32 v107, v16, v32, s44
    v_bitop3_b32 v104, v16, v8, v108 bitop3:0xea
    v_bitop3_b32 v107, v107, v9, v10 bitop3:0xea
    v_bitop3_b32 v107, v16, v11, v107 bitop3:0xea
    s_waitcnt lgkmcnt(0)
    v_mfma_f32_4x4x4_16b_bf16 v[92:95], v[12:13], v[84:85], 0
    ds_read_b64 v[86:87], v104
    s_nop 3
    v_mul_f32 v92, v107, v92
    v_mul_f32 v93, v107, v93
    v_mul_f32 v94, v107, v94
    v_mul_f32 v95, v107, v95
    v_and_b32 v108, 0x20000000, v36
    v_lshrrev_b32 v106, 14, v17
    v_bitop3_b32 v106, v106, v8, v108 bitop3:0xea
    ds_read_b64 v[84:85], v106 offset:63616
    s_waitcnt lgkmcnt(1)
    v_mfma_f32_4x4x4_16b_bf16 v[96:99], v[12:13], v[86:87], v[92:95]
    v_perm_b32 v107, v17, v32, s45
    v_bitop3_b32 v105, v17, v8, v108 bitop3:0xea
    v_bitop3_b32 v107, v107, v9, v10 bitop3:0xea
    v_bitop3_b32 v107, v17, v11, v107 bitop3:0xea
    s_nop 0
    v_cvt_pk_bf16_f32 v88, v96, v97
    v_cvt_pk_bf16_f32 v89, v98, v99
    ds_wrxchg_rtn_b64 v[90:91], v104, v[88:89]
    s_waitcnt lgkmcnt(1)
    v_mfma_f32_4x4x4_16b_bf16 v[92:95], v[12:13], v[84:85], 0
    s_waitcnt lgkmcnt(0)
    v_cmpx_ne_u64 vcc, v[90:91], v[86:87]
    s_cbranch_execz L2_c20
    s_nop 2
    v_mfma_f32_4x4x4_16b_bf16 v[100:103], v[14:15], v[86:87], 0
    s_nop 1
    v_mfma_f32_4x4x4_16b_bf16 v[100:103], v[12:13], v[90:91], v[100:103]
    s_nop 4
    v_cvt_pk_bf16_f32 v100, v100, v101
    v_cvt_pk_bf16_f32 v101, v102, v103
    ds_pk_add_bf16 v104, v100
    ds_pk_add_bf16 v104, v101 offset:4
L2_c20:
    s_mov_b64 exec, -1
    ds_read_b64 v[86:87], v105
    v_mul_f32 v92, v107, v92
    v_mul_f32 v93, v107, v93
    v_mul_f32 v94, v107, v94
    v_mul_f32 v95, v107, v95
    v_and_b32 v108, 0x40000000, v36
    v_lshrrev_b32 v106, 14, v18
    v_bitop3_b32 v106, v106, v8, v108 bitop3:0xea
    ds_read_b64 v[84:85], v106 offset:63616
    s_waitcnt lgkmcnt(1)
    v_mfma_f32_4x4x4_16b_bf16 v[96:99], v[12:13], v[86:87], v[92:95]
    v_perm_b32 v107, v18, v32, s46
    v_bitop3_b32 v104, v18, v8, v108 bitop3:0xea
    v_bitop3_b32 v107, v107, v9, v10 bitop3:0xea
    v_bitop3_b32 v107, v18, v11, v107 bitop3:0xea
    s_nop 0
    v_cvt_pk_bf16_f32 v88, v96, v97
    v_cvt_pk_bf16_f32 v89, v98, v99
    ds_wrxchg_rtn_b64 v[90:91], v105, v[88:89]
    s_waitcnt lgkmcnt(1)
    v_mfma_f32_4x4x4_16b_bf16 v[92:95], v[12:13], v[84:85], 0
    s_waitcnt lgkmcnt(0)
    v_cmpx_ne_u64 vcc, v[90:91], v[86:87]
    s_cbranch_execz L2_c21
    s_nop 2
    v_mfma_f32_4x4x4_16b_bf16 v[100:103], v[14:15], v[86:87], 0
    s_nop 1
    v_mfma_f32_4x4x4_16b_bf16 v[100:103], v[12:13], v[90:91], v[100:103]
    s_nop 4
    v_cvt_pk_bf16_f32 v100, v100, v101
    v_cvt_pk_bf16_f32 v101, v102, v103
    ds_pk_add_bf16 v105, v100
    ds_pk_add_bf16 v105, v101 offset:4
L2_c21:
    s_mov_b64 exec, -1
    ds_read_b64 v[86:87], v104
    v_mul_f32 v92, v107, v92
    v_mul_f32 v93, v107, v93
    v_mul_f32 v94, v107, v94
    v_mul_f32 v95, v107, v95
    v_and_b32 v108, 0x80000000, v36
    v_lshrrev_b32 v106, 14, v19
    v_bitop3_b32 v106, v106, v8, v108 bitop3:0xea
    ds_read_b64 v[84:85], v106 offset:63616
    s_waitcnt lgkmcnt(1)
    v_mfma_f32_4x4x4_16b_bf16 v[96:99], v[12:13], v[86:87], v[92:95]
    v_perm_b32 v107, v19, v32, s47
    v_bitop3_b32 v105, v19, v8, v108 bitop3:0xea
    v_bitop3_b32 v107, v107, v9, v10 bitop3:0xea
    v_bitop3_b32 v107, v19, v11, v107 bitop3:0xea
    v_and_b32 v109, 0x0fffffff, v40
    v_mov_b32 v36, v40
    buffer_load_dwordx4 v[16:19], v109, s[8:11], 0 offen
    buffer_load_dword v32, v109, s[8:11], 0 offen offset:16
    v_cvt_pk_bf16_f32 v88, v96, v97
    v_cvt_pk_bf16_f32 v89, v98, v99
    ds_wrxchg_rtn_b64 v[90:91], v104, v[88:89]
    s_waitcnt lgkmcnt(1)
    v_mfma_f32_4x4x4_16b_bf16 v[92:95], v[12:13], v[84:85], 0
    s_waitcnt lgkmcnt(0)
    v_cmpx_ne_u64 vcc, v[90:91], v[86:87]
    s_cbranch_execz L2_c22
    s_nop 2
    v_mfma_f32_4x4x4_16b_bf16 v[100:103], v[14:15], v[86:87], 0
    s_nop 1
    v_mfma_f32_4x4x4_16b_bf16 v[100:103], v[12:13], v[90:91], v[100:103]
    s_nop 4
    v_cvt_pk_bf16_f32 v100, v100, v101
    v_cvt_pk_bf16_f32 v101, v102, v103
    ds_pk_add_bf16 v104, v100
    ds_pk_add_bf16 v104, v101 offset:4
L2_c22:
    s_mov_b64 exec, -1
    ds_read_b64 v[86:87], v105
    v_mul_f32 v92, v107, v92
    v_mul_f32 v93, v107, v93
    v_mul_f32 v94, v107, v94
    v_mul_f32 v95, v107, v95
    s_waitcnt vmcnt(11)
    v_and_b32 v108, 0x10000000, v37
    v_lshrrev_b32 v106, 14, v20
    v_bitop3_b32 v106, v106, v8, v108 bitop3:0xea
    ds_read_b64 v[84:85], v106 offset:63616
    s_waitcnt lgkmcnt(1)
    v_mfma_f32_4x4x4_16b_bf16 v[96:99], v[12:13], v[86:87], v[92:95]
    v_perm_b32 v107, v20, v33, s44
    v_bitop3_b32 v104, v20, v8, v108 bitop3:0xea
    v_bitop3_b32 v107, v107, v9, v10 bitop3:0xea
    v_bitop3_b32 v107, v20, v11, v107 bitop3:0xea
    s_nop 0
    v_cvt_pk_bf16_f32 v88, v96, v97
    v_cvt_pk_bf16_f32 v89, v98, v99
    ds_wrxchg_rtn_b64 v[90:91], v105, v[88:89]
    s_waitcnt lgkmcnt(1)
    v_mfma_f32_4x4x4_16b_bf16 v[92:95], v[12:13], v[84:85], 0
    s_waitcnt lgkmcnt(0)
    v_cmpx_ne_u64 vcc, v[90:91], v[86:87]
    s_cbranch_execz L2_c23
    s_nop 2
    v_mfma_f32_4x4x4_16b_bf16 v[100:103], v[14:15], v[86:87], 0
    s_nop 1
    v_mfma_f32_4x4x4_16b_bf16 v[100:103], v[12:13], v[90:91], v[100:103]
    s_nop 4
    v_cvt_pk_bf16_f32 v100, v100, v101
    v_cvt_pk_bf16_f32 v101, v102, v103
    ds_pk_add_bf16 v105, v100
    ds_pk_add_bf16 v105, v101 offset:4
L2_c23:
    s_mov_b64 exec, -1
    ds_read_b64 v[86:87], v104
    v_mul_f32 v92, v107, v92
    v_mul_f32 v93, v107, v93
    v_mul_f32 v94, v107, v94
    v_mul_f32 v95, v107, v95
    v_and_b32 v108, 0x20000000, v37
    v_lshrrev_b32 v106, 14, v21
    v_bitop3_b32 v106, v106, v8, v108 bitop3:0xea
    ds_read_b64 v[84:85], v106 offset:63616
    s_waitcnt lgkmcnt(1)
    v_mfma_f32_4x4x4_16b_bf16 v[96:99], v[12:13], v[86:87], v[92:95]
    v_perm_b32 v107, v21, v33, s45
    v_bitop3_b32 v105, v21, v8, v108 bitop3:0xea
    v_bitop3_b32 v107, v107, v9, v10 bitop3:0xea
    v_bitop3_b32 v107, v21, v11, v107 bitop3:0xea
    s_nop 0
    v_cvt_pk_bf16_f32 v88, v96, v97
    v_cvt_pk_bf16_f32 v89, v98, v99
    ds_wrxchg_rtn_b64 v[90:91], v104, v[88:89]
    s_waitcnt lgkmcnt(1)
    v_mfma_f32_4x4x4_16b_bf16 v[92:95], v[12:13], v[84:85], 0
    s_waitcnt lgkmcnt(0)
    v_cmpx_ne_u64 vcc, v[90:91], v[86:87]
    s_cbranch_execz L2_c24
    s_nop 2
    v_mfma_f32_4x4x4_16b_bf16 v[100:103], v[14:15], v[86:87], 0
    s_nop 1
    v_mfma_f32_4x4x4_16b_bf16 v[100:103], v[12:13], v[90:91], v[100:103]
    s_nop 4
    v_cvt_pk_bf16_f32 v100, v100, v101
    v_cvt_pk_bf16_f32 v101, v102, v103
    ds_pk_add_bf16 v104, v100
    ds_pk_add_bf16 v104, v101 offset:4
L2_c24:
    s_mov_b64 exec, -1
    ds_read_b64 v[86:87], v105
    v_mul_f32 v92, v107, v92
    v_mul_f32 v93, v107, v93
    v_mul_f32 v94, v107, v94
    v_mul_f32 v95, v107, v95
    v_and_b32 v108, 0x40000000, v37
    v_lshrrev_b32 v106, 14, v22
    v_bitop3_b32 v106, v106, v8, v108 bitop3:0xea
    ds_read_b64 v[84:85], v106 offset:63616
    s_waitcnt lgkmcnt(1)
    v_mfma_f32_4x4x4_16b_bf16 v[96:99], v[12:13], v[86:87], v[92:95]
    v_perm_b32 v107, v22, v33, s46
    v_bitop3_b32 v104, v22, v8, v108 bitop3:0xea
    v_bitop3_b32 v107, v107, v9, v10 bitop3:0xea
    v_bitop3_b32 v107, v22, v11, v107 bitop3:0xea
    s_nop 0
    v_cvt_pk_bf16_f32 v88, v96, v97
    v_cvt_pk_bf16_f32 v89, v98, v99
    ds_wrxchg_rtn_b64 v[90:91], v105, v[88:89]
    s_waitcnt lgkmcnt(1)
    v_mfma_f32_4x4x4_16b_bf16 v[92:95], v[12:13], v[84:85], 0
    s_waitcnt lgkmcnt(0)
    v_cmpx_ne_u64 vcc, v[90:91], v[86:87]
    s_cbranch_execz L2_c25
    s_nop 2
    v_mfma_f32_4x4x4_16b_bf16 v[100:103], v[14:15], v[86:87], 0
    s_nop 1
    v_mfma_f32_4x4x4_16b_bf16 v[100:103], v[12:13], v[90:91], v[100:103]
    s_nop 4
    v_cvt_pk_bf16_f32 v100, v100, v101
    v_cvt_pk_bf16_f32 v101, v102, v103
    ds_pk_add_bf16 v105, v100
    ds_pk_add_bf16 v105, v101 offset:4
L2_c25:
    s_mov_b64 exec, -1
    ds_read_b64 v[86:87], v104
    v_mul_f32 v92, v107, v92
    v_mul_f32 v93, v107, v93
    v_mul_f32 v94, v107, v94
    v_mul_f32 v95, v107, v95
    v_and_b32 v108, 0x80000000, v37
    v_lshrrev_b32 v106, 14, v23
    v_bitop3_b32 v106, v106, v8, v108 bitop3:0xea
    ds_read_b64 v[84:85], v106 offset:63616
    s_waitcnt lgkmcnt(1)
    v_mfma_f32_4x4x4_16b_bf16 v[96:99], v[12:13], v[86:87], v[92:95]
    v_perm_b32 v107, v23, v33, s47
    v_bitop3_b32 v105, v23, v8, v108 bitop3:0xea
    v_bitop3_b32 v107, v107, v9, v10 bitop3:0xea
    v_bitop3_b32 v107, v23, v11, v107 bitop3:0xea
    v_and_b32 v109, 0x0fffffff, v41
    v_mov_b32 v37, v41
    buffer_load_dwordx4 v[20:23], v109, s[8:11], 0 offen
    buffer_load_dword v33, v109, s[8:11], 0 offen offset:16
    v_cvt_pk_bf16_f32 v88, v96, v97
    v_cvt_pk_bf16_f32 v89, v98, v99
    ds_wrxchg_rtn_b64 v[90:91], v104, v[88:89]
    s_waitcnt lgkmcnt(1)
    v_mfma_f32_4x4x4_16b_bf16 v[92:95], v[12:13], v[84:85], 0
    s_waitcnt lgkmcnt(0)
    v_cmpx_ne_u64 vcc, v[90:91], v[86:87]
    s_cbranch_execz L2_c26
    s_nop 2
    v_mfma_f32_4x4x4_16b_bf16 v[100:103], v[14:15], v[86:87], 0
    s_nop 1
    v_mfma_f32_4x4x4_16b_bf16 v[100:103], v[12:13], v[90:91], v[100:103]
    s_nop 4
    v_cvt_pk_bf16_f32 v100, v100, v101
    v_cvt_pk_bf16_f32 v101, v102, v103
    ds_pk_add_bf16 v104, v100
    ds_pk_add_bf16 v104, v101 offset:4
L2_c26:
    s_mov_b64 exec, -1
    ds_read_b64 v[86:87], v105
    v_mul_f32 v92, v107, v92
    v_mul_f32 v93, v107, v93
    v_mul_f32 v94, v107, v94
    v_mul_f32 v95, v107, v95
    s_waitcnt vmcnt(11)
    v_and_b32 v108, 0x10000000, v38
    v_lshrrev_b32 v106, 14, v24
    v_bitop3_b32 v106, v106, v8, v108 bitop3:0xea
    ds_read_b64 v[84:85], v106 offset:63616
    s_waitcnt lgkmcnt(1)
    v_mfma_f32_4x4x4_16b_bf16 v[96:99], v[12:13], v[86:87], v[92:95]
    v_perm_b32 v107, v24, v34, s44
    v_bitop3_b32 v104, v24, v8, v108 bitop3:0xea
    v_bitop3_b32 v107, v107, v9, v10 bitop3:0xea
    v_bitop3_b32 v107, v24, v11, v107 bitop3:0xea
    s_nop 0
    v_cvt_pk_bf16_f32 v88, v96, v97
    v_cvt_pk_bf16_f32 v89, v98, v99
    ds_wrxchg_rtn_b64 v[90:91], v105, v[88:89]
    s_waitcnt lgkmcnt(1)
    v_mfma_f32_4x4x4_16b_bf16 v[92:95], v[12:13], v[84:85], 0
    s_waitcnt lgkmcnt(0)
    v_cmpx_ne_u64 vcc, v[90:91], v[86:87]
    s_cbranch_execz L2_c27
    s_nop 2
    v_mfma_f32_4x4x4_16b_bf16 v[100:103], v[14:15], v[86:87], 0
    s_nop 1
    v_mfma_f32_4x4x4_16b_bf16 v[100:103], v[12:13], v[90:91], v[100:103]
    s_nop 4
    v_cvt_pk_bf16_f32 v100, v100, v101
    v_cvt_pk_bf16_f32 v101, v102, v103
    ds_pk_add_bf16 v105, v100
    ds_pk_add_bf16 v105, v101 offset:4
L2_c27:
    s_mov_b64 exec, -1
    ds_read_b64 v[86:87], v104
    v_mul_f32 v92, v107, v92
    v_mul_f32 v93, v107, v93
    v_mul_f32 v94, v107, v94
    v_mul_f32 v95, v107, v95
    v_and_b32 v108, 0x20000000, v38
    v_lshrrev_b32 v106, 14, v25
    v_bitop3_b32 v106, v106, v8, v108 bitop3:0xea
    ds_read_b64 v[84:85], v106 offset:63616
    s_waitcnt lgkmcnt(1)
    v_mfma_f32_4x4x4_16b_bf16 v[96:99], v[12:13], v[86:87], v[92:95]
    v_perm_b32 v107, v25, v34, s45
    v_bitop3_b32 v105, v25, v8, v108 bitop3:0xea
    v_bitop3_b32 v107, v107, v9, v10 bitop3:0xea
    v_bitop3_b32 v107, v25, v11, v107 bitop3:0xea
    s_nop 0
    v_cvt_pk_bf16_f32 v88, v96, v97
    v_cvt_pk_bf16_f32 v89, v98, v99
    ds_wrxchg_rtn_b64 v[90:91], v104, v[88:89]
    s_waitcnt lgkmcnt(1)
    v_mfma_f32_4x4x4_16b_bf16 v[92:95], v[12:13], v[84:85], 0
    s_waitcnt lgkmcnt(0)
    v_cmpx_ne_u64 vcc, v[90:91], v[86:87]
    s_cbranch_execz L2_c28
    s_nop 2
    v_mfma_f32_4x4x4_16b_bf16 v[100:103], v[14:15], v[86:87], 0
    s_nop 1
    v_mfma_f32_4x4x4_16b_bf16 v[100:103], v[12:13], v[90:91], v[100:103]
    s_nop 4
    v_cvt_pk_bf16_f32 v100, v100, v101
    v_cvt_pk_bf16_f32 v101, v102, v103
    ds_pk_add_bf16 v104, v100
    ds_pk_add_bf16 v104, v101 offset:4
L2_c28:
    s_mov_b64 exec, -1
    ds_read_b64 v[86:87], v105
    v_mul_f32 v92, v107, v92
    v_mul_f32 v93, v107, v93
    v_mul_f32 v94, v107, v94
    v_mul_f32 v95, v107, v95
    v_and_b32 v108, 0x40000000, v38
    v_lshrrev_b32 v106, 14, v26
    v_bitop3_b32 v106, v106, v8, v108 bitop3:0xea
    ds_read_b64 v[84:85], v106 offset:63616
    s_waitcnt lgkmcnt(1)
    v_mfma_f32_4x4x4_16b_bf16 v[96:99], v[12:13], v[86:87], v[92:95]
    v_perm_b32 v107, v26, v34, s46
    v_bitop3_b32 v104, v26, v8, v108 bitop3:0xea
    v_bitop3_b32 v107, v107, v9, v10 bitop3:0xea
    v_bitop3_b32 v107, v26, v11, v107 bitop3:0xea
    s_nop 0
    v_cvt_pk_bf16_f32 v88, v96, v97
    v_cvt_pk_bf16_f32 v89, v98, v99
    ds_wrxchg_rtn_b64 v[90:91], v105, v[88:89]
    s_waitcnt lgkmcnt(1)
    v_mfma_f32_4x4x4_16b_bf16 v[92:95], v[12:13], v[84:85], 0
    s_waitcnt lgkmcnt(0)
    v_cmpx_ne_u64 vcc, v[90:91], v[86:87]
    s_cbranch_execz L2_c29
    s_nop 2
    v_mfma_f32_4x4x4_16b_bf16 v[100:103], v[14:15], v[86:87], 0
    s_nop 1
    v_mfma_f32_4x4x4_16b_bf16 v[100:103], v[12:13], v[90:91], v[100:103]
    s_nop 4
    v_cvt_pk_bf16_f32 v100, v100, v101
    v_cvt_pk_bf16_f32 v101, v102, v103
    ds_pk_add_bf16 v105, v100
    ds_pk_add_bf16 v105, v101 offset:4
L2_c29:
    s_mov_b64 exec, -1
    ds_read_b64 v[86:87], v104
    v_mul_f32 v92, v107, v92
    v_mul_f32 v93, v107, v93
    v_mul_f32 v94, v107, v94
    v_mul_f32 v95, v107, v95
    v_and_b32 v108, 0x80000000, v38
    v_lshrrev_b32 v106, 14, v27
    v_bitop3_b32 v106, v106, v8, v108 bitop3:0xea
    ds_read_b64 v[84:85], v106 offset:63616
    s_waitcnt lgkmcnt(1)
    v_mfma_f32_4x4x4_16b_bf16 v[96:99], v[12:13], v[86:87], v[92:95]
    v_perm_b32 v107, v27, v34, s47
    v_bitop3_b32 v105, v27, v8, v108 bitop3:0xea
    v_bitop3_b32 v107, v107, v9, v10 bitop3:0xea
    v_bitop3_b32 v107, v27, v11, v107 bitop3:0xea
    v_and_b32 v109, 0x0fffffff, v42
    v_mov_b32 v38, v42
    buffer_load_dwordx4 v[24:27], v109, s[8:11], 0 offen
    buffer_load_dword v34, v109, s[8:11], 0 offen offset:16
    v_cvt_pk_bf16_f32 v88, v96, v97
    v_cvt_pk_bf16_f32 v89, v98, v99
    ds_wrxchg_rtn_b64 v[90:91], v104, v[88:89]
    s_waitcnt lgkmcnt(1)
    v_mfma_f32_4x4x4_16b_bf16 v[92:95], v[12:13], v[84:85], 0
    s_waitcnt lgkmcnt(0)
    v_cmpx_ne_u64 vcc, v[90:91], v[86:87]
    s_cbranch_execz L2_c30
    s_nop 2
    v_mfma_f32_4x4x4_16b_bf16 v[100:103], v[14:15], v[86:87], 0
    s_nop 1
    v_mfma_f32_4x4x4_16b_bf16 v[100:103], v[12:13], v[90:91], v[100:103]
    s_nop 4
    v_cvt_pk_bf16_f32 v100, v100, v101
    v_cvt_pk_bf16_f32 v101, v102, v103
    ds_pk_add_bf16 v104, v100
    ds_pk_add_bf16 v104, v101 offset:4
L2_c30:
    s_mov_b64 exec, -1
    ds_read_b64 v[86:87], v105
    v_mul_f32 v92, v107, v92
    v_mul_f32 v93, v107, v93
    v_mul_f32 v94, v107, v94
    v_mul_f32 v95, v107, v95
    s_waitcnt vmcnt(11)
    v_and_b32 v108, 0x10000000, v39
    v_lshrrev_b32 v106, 14, v28
    v_bitop3_b32 v106, v106, v8, v108 bitop3:0xea
    ds_read_b64 v[84:85], v106 offset:63616
    s_waitcnt lgkmcnt(1)
    v_mfma_f32_4x4x4_16b_bf16 v[96:99], v[12:13], v[86:87], v[92:95]
    v_perm_b32 v107, v28, v35, s44
    v_bitop3_b32 v104, v28, v8, v108 bitop3:0xea
    v_bitop3_b32 v107, v107, v9, v10 bitop3:0xea
    v_bitop3_b32 v107, v28, v11, v107 bitop3:0xea
    s_nop 0
    v_cvt_pk_bf16_f32 v88, v96, v97
    v_cvt_pk_bf16_f32 v89, v98, v99
    ds_wrxchg_rtn_b64 v[90:91], v105, v[88:89]
    s_waitcnt lgkmcnt(1)
    v_mfma_f32_4x4x4_16b_bf16 v[92:95], v[12:13], v[84:85], 0
    s_waitcnt lgkmcnt(0)
    v_cmpx_ne_u64 vcc, v[90:91], v[86:87]
    s_cbranch_execz L2_c31
    s_nop 2
    v_mfma_f32_4x4x4_16b_bf16 v[100:103], v[14:15], v[86:87], 0
    s_nop 1
    v_mfma_f32_4x4x4_16b_bf16 v[100:103], v[12:13], v[90:91], v[100:103]
    s_nop 4
    v_cvt_pk_bf16_f32 v100, v100, v101
    v_cvt_pk_bf16_f32 v101, v102, v103
    ds_pk_add_bf16 v105, v100
    ds_pk_add_bf16 v105, v101 offset:4
L2_c31:
    s_mov_b64 exec, -1
    ds_read_b64 v[86:87], v104
    v_mul_f32 v92, v107, v92
    v_mul_f32 v93, v107, v93
    v_mul_f32 v94, v107, v94
    v_mul_f32 v95, v107, v95
    v_and_b32 v108, 0x20000000, v39
    v_lshrrev_b32 v106, 14, v29
    v_bitop3_b32 v106, v106, v8, v108 bitop3:0xea
    ds_read_b64 v[84:85], v106 offset:63616
    s_waitcnt lgkmcnt(1)
    v_mfma_f32_4x4x4_16b_bf16 v[96:99], v[12:13], v[86:87], v[92:95]
    v_perm_b32 v107, v29, v35, s45
    v_bitop3_b32 v105, v29, v8, v108 bitop3:0xea
    v_bitop3_b32 v107, v107, v9, v10 bitop3:0xea
    v_bitop3_b32 v107, v29, v11, v107 bitop3:0xea
    s_nop 0
    v_cvt_pk_bf16_f32 v88, v96, v97
    v_cvt_pk_bf16_f32 v89, v98, v99
    ds_wrxchg_rtn_b64 v[90:91], v104, v[88:89]
    s_waitcnt lgkmcnt(1)
    v_mfma_f32_4x4x4_16b_bf16 v[92:95], v[12:13], v[84:85], 0
    s_waitcnt lgkmcnt(0)
    v_cmpx_ne_u64 vcc, v[90:91], v[86:87]
    s_cbranch_execz L2_c32
    s_nop 2
    v_mfma_f32_4x4x4_16b_bf16 v[100:103], v[14:15], v[86:87], 0
    s_nop 1
    v_mfma_f32_4x4x4_16b_bf16 v[100:103], v[12:13], v[90:91], v[100:103]
    s_nop 4
    v_cvt_pk_bf16_f32 v100, v100, v101
    v_cvt_pk_bf16_f32 v101, v102, v103
    ds_pk_add_bf16 v104, v100
    ds_pk_add_bf16 v104, v101 offset:4
L2_c32:
    s_mov_b64 exec, -1
    ds_read_b64 v[86:87], v105
    v_mul_f32 v92, v107, v92
    v_mul_f32 v93, v107, v93
    v_mul_f32 v94, v107, v94
    v_mul_f32 v95, v107, v95
    v_and_b32 v108, 0x40000000, v39
    v_lshrrev_b32 v106, 14, v30
    v_bitop3_b32 v106, v106, v8, v108 bitop3:0xea
    ds_read_b64 v[84:85], v106 offset:63616
    s_waitcnt lgkmcnt(1)
    v_mfma_f32_4x4x4_16b_bf16 v[96:99], v[12:13], v[86:87], v[92:95]
    v_perm_b32 v107, v30, v35, s46
    v_bitop3_b32 v104, v30, v8, v108 bitop3:0xea
    v_bitop3_b32 v107, v107, v9, v10 bitop3:0xea
    v_bitop3_b32 v107, v30, v11, v107 bitop3:0xea
    s_nop 0
    v_cvt_pk_bf16_f32 v88, v96, v97
    v_cvt_pk_bf16_f32 v89, v98, v99
    ds_wrxchg_rtn_b64 v[90:91], v105, v[88:89]
    s_waitcnt lgkmcnt(1)
    v_mfma_f32_4x4x4_16b_bf16 v[92:95], v[12:13], v[84:85], 0
    s_waitcnt lgkmcnt(0)
    v_cmpx_ne_u64 vcc, v[90:91], v[86:87]
    s_cbranch_execz L2_c33
    s_nop 2
    v_mfma_f32_4x4x4_16b_bf16 v[100:103], v[14:15], v[86:87], 0
    s_nop 1
    v_mfma_f32_4x4x4_16b_bf16 v[100:103], v[12:13], v[90:91], v[100:103]
    s_nop 4
    v_cvt_pk_bf16_f32 v100, v100, v101
    v_cvt_pk_bf16_f32 v101, v102, v103
    ds_pk_add_bf16 v105, v100
    ds_pk_add_bf16 v105, v101 offset:4
L2_c33:
    s_mov_b64 exec, -1
    ds_read_b64 v[86:87], v104
    v_mul_f32 v92, v107, v92
    v_mul_f32 v93, v107, v93
    v_mul_f32 v94, v107, v94
    v_mul_f32 v95, v107, v95
    v_and_b32 v108, 0x80000000, v39
    v_lshrrev_b32 v106, 14, v31
    v_bitop3_b32 v106, v106, v8, v108 bitop3:0xea
    ds_read_b64 v[84:85], v106 offset:63616
    s_waitcnt lgkmcnt(1)
    v_mfma_f32_4x4x4_16b_bf16 v[96:99], v[12:13], v[86:87], v[92:95]
    v_perm_b32 v107, v31, v35, s47
    v_bitop3_b32 v105, v31, v8, v108 bitop3:0xea
    v_bitop3_b32 v107, v107, v9, v10 bitop3:0xea
    v_bitop3_b32 v107, v31, v11, v107 bitop3:0xea
    v_and_b32 v109, 0x0fffffff, v43
    v_mov_b32 v39, v43
    buffer_load_dwordx4 v[28:31], v109, s[8:11], 0 offen
    buffer_load_dword v35, v109, s[8:11], 0 offen offset:16
    v_cvt_pk_bf16_f32 v88, v96, v97
    v_cvt_pk_bf16_f32 v89, v98, v99
    ds_wrxchg_rtn_b64 v[90:91], v104, v[88:89]
    s_waitcnt lgkmcnt(1)
    v_mfma_f32_4x4x4_16b_bf16 v[92:95], v[12:13], v[84:85], 0
    s_waitcnt lgkmcnt(0)
    v_cmpx_ne_u64 vcc, v[90:91], v[86:87]
    s_cbranch_execz L2_c34
    s_nop 2
    v_mfma_f32_4x4x4_16b_bf16 v[100:103], v[14:15], v[86:87], 0
    s_nop 1
    v_mfma_f32_4x4x4_16b_bf16 v[100:103], v[12:13], v[90:91], v[100:103]
    s_nop 4
    v_cvt_pk_bf16_f32 v100, v100, v101
    v_cvt_pk_bf16_f32 v101, v102, v103
    ds_pk_add_bf16 v104, v100
    ds_pk_add_bf16 v104, v101 offset:4
L2_c34:
    s_mov_b64 exec, -1
    ds_read_b64 v[86:87], v105
    v_mul_f32 v92, v107, v92
    v_mul_f32 v93, v107, v93
    v_mul_f32 v94, v107, v94
    v_mul_f32 v95, v107, v95
    s_waitcnt lgkmcnt(0)
    s_nop 0
    v_mfma_f32_4x4x4_16b_bf16 v[96:99], v[12:13], v[86:87], v[92:95]
    s_nop 4
    v_cvt_pk_bf16_f32 v88, v96, v97
    v_cvt_pk_bf16_f32 v89, v98, v99
    ds_wrxchg_rtn_b64 v[90:91], v105, v[88:89]
    s_waitcnt lgkmcnt(0)
    v_cmpx_ne_u64 vcc, v[90:91], v[86:87]
    s_cbranch_execz L2_c35
    s_nop 2
    v_mfma_f32_4x4x4_16b_bf16 v[100:103], v[14:15], v[86:87], 0
    s_nop 1
    v_mfma_f32_4x4x4_16b_bf16 v[100:103], v[12:13], v[90:91], v[100:103]
    s_nop 4
    v_cvt_pk_bf16_f32 v100, v100, v101
    v_cvt_pk_bf16_f32 v101, v102, v103
    ds_pk_add_bf16 v105, v100
    ds_pk_add_bf16 v105, v101 offset:4
L2_c35:
    s_mov_b64 exec, -1
    s_bitcmp1_b32 s36, s42
    s_cbranch_scc1 L2_slow
L2_ret1:
    s_barrier
    s_waitcnt vmcnt(8)
    s_mov_b32 s37, s38
    s_add_u32 s48, s38, 257
    v_lshrrev_b32 v110, 16, v65
    v_lshrrev_b32 v111, 16, v67
    v_and_b32 v112, -4, v110
    v_add_u32 v112, v112, v2
L2_x36_0:
    v_sub_u32 v113, v111, v112
    v_sub_u32 v115, v110, v112
    v_med3_i32 v114, v113, 0, 4
    v_max_i32 v115, 0, v115
    v_cmp_gt_i32 vcc, v114, v115
    v_mad_u32_u24 v116, v112, 5, v4
    v_bfm_b32 v114, v114, 28
    v_bfm_b32 v115, v115, 28
    v_mbcnt_lo_u32_b32 v117, vcc_lo, 0
    v_mbcnt_hi_u32_b32 v117, vcc_hi, v117
    v_bitop3_b32 v116, v114, v115, v116 bitop3:0x9a
    v_add_lshl_u32 v117, v117, s37, 2
    s_bcnt1_i32_b64 s41, vcc
    s_mov_b64 exec, vcc
    ds_write_b32 v117, v116
    s_mov_b64 exec, -1
    v_cmp_gt_i32 vcc, v113, v3
    s_add_u32 s37, s37, s41
    s_min_u32 s37, s37, s48
    s_cbranch_vccnz L2_xe36_0
L2_xr36_0:
    ds_write_b128 v7, v[52:55] offset:2048
    v_lshrrev_b32 v110, 16, v69
    v_lshrrev_b32 v111, 16, v71
    v_and_b32 v112, -4, v110
    v_add_u32 v112, v112, v2
    v_add_u32 v118, 0x2800000, v4
L2_x36_1:
    v_sub_u32 v113, v111, v112
    v_sub_u32 v115, v110, v112
    v_med3_i32 v114, v113, 0, 4
    v_max_i32 v115, 0, v115
    v_cmp_gt_i32 vcc, v114, v115
    v_mad_u32_u24 v116, v112, 5, v118
    v_bfm_b32 v114, v114, 28
    v_bfm_b32 v115, v115, 28
    v_mbcnt_lo_u32_b32 v117, vcc_lo, 0
    v_mbcnt_hi_u32_b32 v117, vcc_hi, v117
    v_bitop3_b32 v116, v114, v115, v116 bitop3:0x9a
    v_add_lshl_u32 v117, v117, s37, 2
    s_bcnt1_i32_b64 s41, vcc
    s_mov_b64 exec, vcc
    ds_write_b32 v117, v116
    s_mov_b64 exec, -1
    v_cmp_gt_i32 vcc, v113, v3
    s_add_u32 s37, s37, s41
    s_min_u32 s37, s37, s48
    s_cbranch_vccnz L2_xe36_1
L2_xr36_1:
    ds_write_b128 v7, v[56:59] offset:3072
    v_lshrrev_b32 v110, 16, v73
    v_lshrrev_b32 v111, 16, v75
    v_and_b32 v112, -4, v110
    v_add_u32 v112, v112, v2
    v_add_u32 v118, 0x5000000, v4
L2_x36_2:
    v_sub_u32 v113, v111, v112
    v_sub_u32 v115, v110, v112
    v_med3_i32 v114, v113, 0, 4
    v_max_i32 v115, 0, v115
    v_cmp_gt_i32 vcc, v114, v115
    v_mad_u32_u24 v116, v112, 5, v118
    v_bfm_b32 v114, v114, 28
    v_bfm_b32 v115, v115, 28
    v_mbcnt_lo_u32_b32 v117, vcc_lo, 0
    v_mbcnt_hi_u32_b32 v117, vcc_hi, v117
    v_bitop3_b32 v116, v114, v115, v116 bitop3:0x9a
    v_add_lshl_u32 v117, v117, s37, 2
    s_bcnt1_i32_b64 s41, vcc
    s_mov_b64 exec, vcc
    ds_write_b32 v117, v116
    s_mov_b64 exec, -1
    v_cmp_gt_i32 vcc, v113, v3
    s_add_u32 s37, s37, s41
    s_min_u32 s37, s37, s48
    s_cbranch_vccnz L2_xe36_2
L2_xr36_2:
    ds_write_b128 v7, v[60:63] offset:4096
    v_lshrrev_b32 v110, 16, v77
    v_lshrrev_b32 v111, 16, v79
    v_and_b32 v112, -4, v110
    v_add_u32 v112, v112, v2
    v_add_u32 v118, 0x7800000, v4
L2_x36_3:
    v_sub_u32 v113, v111, v112
    v_sub_u32 v115, v110, v112
    v_med3_i32 v114, v113, 0, 4
    v_max_i32 v115, 0, v115
    v_cmp_gt_i32 vcc, v114, v115
    v_mad_u32_u24 v116, v112, 5, v118
    v_bfm_b32 v114, v114, 28
    v_bfm_b32 v115, v115, 28
    v_mbcnt_lo_u32_b32 v117, vcc_lo, 0
    v_mbcnt_hi_u32_b32 v117, vcc_hi, v117
    v_bitop3_b32 v116, v114, v115, v116 bitop3:0x9a
    v_add_lshl_u32 v117, v117, s37, 2
    s_bcnt1_i32_b64 s41, vcc
    s_mov_b64 exec, vcc
    ds_write_b32 v117, v116
    s_mov_b64 exec, -1
    v_cmp_gt_i32 vcc, v113, v3
    s_add_u32 s37, s37, s41
    s_min_u32 s37, s37, s48
    s_cbranch_vccnz L2_xe36_3
L2_xr36_3:
    v_lshrrev_b32 v110, 16, v81
    v_lshrrev_b32 v111, 16, v83
    v_and_b32 v112, -4, v110
    v_add_u32 v112, v112, v2
    v_add_u32 v118, 0xa000000, v4
L2_x36_4:
    v_sub_u32 v113, v111, v112
    v_sub_u32 v115, v110, v112
    v_med3_i32 v114, v113, 0, 4
    v_max_i32 v115, 0, v115
    v_cmp_gt_i32 vcc, v114, v115
    v_mad_u32_u24 v116, v112, 5, v118
    v_bfm_b32 v114, v114, 28
    v_bfm_b32 v115, v115, 28
    v_mbcnt_lo_u32_b32 v117, vcc_lo, 0
    v_mbcnt_hi_u32_b32 v117, vcc_hi, v117
    v_bitop3_b32 v116, v114, v115, v116 bitop3:0x9a
    v_add_lshl_u32 v117, v117, s37, 2
    s_bcnt1_i32_b64 s41, vcc
    s_mov_b64 exec, vcc
    ds_write_b32 v117, v116
    s_mov_b64 exec, -1
    v_cmp_gt_i32 vcc, v113, v3
    s_add_u32 s37, s37, s41
    s_min_u32 s37, s37, s48
    s_cbranch_vccnz L2_xe36_4
L2_xr36_4:
    s_lshl_b32 s3, s37, 2
    v_add_u32 v117, s3, v1
    v_mov_b32 v116, -1
    ds_write_b32 v117, v116
    s_lshl_b32 s3, s38, 2
    v_add_u32 v117, s3, v1
    ds_read2st64_b32 v[40:41], v117 offset0:0 offset1:1
    ds_read2st64_b32 v[42:43], v117 offset0:2 offset1:3
    s_sub_u32 s41, s37, s38
    s_sub_u32 s3, s41, 192
    s_cmp_gt_u32 s3, 64
    s_cbranch_scc1 L2_xf36
L2_xg36:
    ds_write_b128 v7, v[44:47] offset:0
    ds_write_b128 v7, v[48:51] offset:1024
    s_cmp_eq_u32 s35, 3
    s_cselect_b32 s14, 0, s14
    s_mul_i32 s3, s35, 520
    s_add_u32 s3, s3, 520
    s_add_u32 s49, s3, s39
    buffer_load_dwordx4 v[64:67], v5, s[12:15], s49 offen
    v_add_u32 v111, 0x208000, v5
    buffer_load_dwordx4 v[68:71], v111, s[12:15], s49 offen
    v_add_u32 v112, 0x410000, v5
    buffer_load_dwordx4 v[72:75], v112, s[12:15], s49 offen
    v_add_u32 v113, 0x618000, v5
    buffer_load_dwordx4 v[76:79], v113, s[12:15], s49 offen
    v_add_u32 v114, 0x820000, v5
    buffer_load_dwordx4 v[80:83], v114, s[12:15], s49 offen
    buffer_load_dwordx4 v[44:47], v6, s[16:19], s40 offen offset:0
    buffer_load_dwordx4 v[48:51], v6, s[16:19], s40 offen offset:1024
    buffer_load_dwordx4 v[52:55], v6, s[16:19], s40 offen offset:2048
    buffer_load_dwordx4 v[56:59], v6, s[16:19], s40 offen offset:3072
    s_add_u32 s3, s40, 4096
    buffer_load_dwordx4 v[60:63], v6, s[16:19], s3 offen
    s_add_u32 s40, s40, 80000
    s_add_u32 s42, s42, 1
    s_waitcnt lgkmcnt(0)
    s_barrier
    s_waitcnt vmcnt(16)
    v_and_b32 v108, 0x10000000, v36
    v_lshrrev_b32 v106, 14, v16
    v_bitop3_b32 v106, v106, v8, v108 bitop3:0xea
    ds_read_b64 v[84:85], v106 offset:63616
    v_perm_b32 v107, v16, v32, s44
    v_bitop3_b32 v104, v16, v8, v108 bitop3:0xea
    v_bitop3_b32 v107, v107, v9, v10 bitop3:0xea
    v_bitop3_b32 v107, v16, v11, v107 bitop3:0xea
    s_waitcnt lgkmcnt(0)
    v_mfma_f32_4x4x4_16b_bf16 v[92:95], v[12:13], v[84:85], 0
    ds_read_b64 v[86:87], v104
    s_nop 3
    v_mul_f32 v92, v107, v92
    v_mul_f32 v93, v107, v93
    v_mul_f32 v94, v107, v94
    v_mul_f32 v95, v107, v95
    v_and_b32 v108, 0x20000000, v36
    v_lshrrev_b32 v106, 14, v17
    v_bitop3_b32 v106, v106, v8, v108 bitop3:0xea
    ds_read_b64 v[84:85], v106 offset:63616
    s_waitcnt lgkmcnt(1)
    v_mfma_f32_4x4x4_16b_bf16 v[96:99], v[12:13], v[86:87], v[92:95]
    v_perm_b32 v107, v17, v32, s45
    v_bitop3_b32 v105, v17, v8, v108 bitop3:0xea
    v_bitop3_b32 v107, v107, v9, v10 bitop3:0xea
    v_bitop3_b32 v107, v17, v11, v107 bitop3:0xea
    s_nop 0
    v_cvt_pk_bf16_f32 v88, v96, v97
    v_cvt_pk_bf16_f32 v89, v98, v99
    ds_wrxchg_rtn_b64 v[90:91], v104, v[88:89]
    s_waitcnt lgkmcnt(1)
    v_mfma_f32_4x4x4_16b_bf16 v[92:95], v[12:13], v[84:85], 0
    s_waitcnt lgkmcnt(0)
    v_cmpx_ne_u64 vcc, v[90:91], v[86:87]
    s_cbranch_execz L2_c37
    s_nop 2
    v_mfma_f32_4x4x4_16b_bf16 v[100:103], v[14:15], v[86:87], 0
    s_nop 1
    v_mfma_f32_4x4x4_16b_bf16 v[100:103], v[12:13], v[90:91], v[100:103]
    s_nop 4
    v_cvt_pk_bf16_f32 v100, v100, v101
    v_cvt_pk_bf16_f32 v101, v102, v103
    ds_pk_add_bf16 v104, v100
    ds_pk_add_bf16 v104, v101 offset:4
L2_c37:
    s_mov_b64 exec, -1
    ds_read_b64 v[86:87], v105
    v_mul_f32 v92, v107, v92
    v_mul_f32 v93, v107, v93
    v_mul_f32 v94, v107, v94
    v_mul_f32 v95, v107, v95
    v_and_b32 v108, 0x40000000, v36
    v_lshrrev_b32 v106, 14, v18
    v_bitop3_b32 v106, v106, v8, v108 bitop3:0xea
    ds_read_b64 v[84:85], v106 offset:63616
    s_waitcnt lgkmcnt(1)
    v_mfma_f32_4x4x4_16b_bf16 v[96:99], v[12:13], v[86:87], v[92:95]
    v_perm_b32 v107, v18, v32, s46
    v_bitop3_b32 v104, v18, v8, v108 bitop3:0xea
    v_bitop3_b32 v107, v107, v9, v10 bitop3:0xea
    v_bitop3_b32 v107, v18, v11, v107 bitop3:0xea
    s_nop 0
    v_cvt_pk_bf16_f32 v88, v96, v97
    v_cvt_pk_bf16_f32 v89, v98, v99
    ds_wrxchg_rtn_b64 v[90:91], v105, v[88:89]
    s_waitcnt lgkmcnt(1)
    v_mfma_f32_4x4x4_16b_bf16 v[92:95], v[12:13], v[84:85], 0
    s_waitcnt lgkmcnt(0)
    v_cmpx_ne_u64 vcc, v[90:91], v[86:87]
    s_cbranch_execz L2_c38
    s_nop 2
    v_mfma_f32_4x4x4_16b_bf16 v[100:103], v[14:15], v[86:87], 0
    s_nop 1
    v_mfma_f32_4x4x4_16b_bf16 v[100:103], v[12:13], v[90:91], v[100:103]
    s_nop 4
    v_cvt_pk_bf16_f32 v100, v100, v101
    v_cvt_pk_bf16_f32 v101, v102, v103
    ds_pk_add_bf16 v105, v100
    ds_pk_add_bf16 v105, v101 offset:4
L2_c38:
    s_mov_b64 exec, -1
    ds_read_b64 v[86:87], v104
    v_mul_f32 v92, v107, v92
    v_mul_f32 v93, v107, v93
    v_mul_f32 v94, v107, v94
    v_mul_f32 v95, v107, v95
    v_and_b32 v108, 0x80000000, v36
    v_lshrrev_b32 v106, 14, v19
    v_bitop3_b32 v106, v106, v8, v108 bitop3:0xea
    ds_read_b64 v[84:85], v106 offset:63616
    s_waitcnt lgkmcnt(1)
    v_mfma_f32_4x4x4_16b_bf16 v[96:99], v[12:13], v[86:87], v[92:95]
    v_perm_b32 v107, v19, v32, s47
    v_bitop3_b32 v105, v19, v8, v108 bitop3:0xea
    v_bitop3_b32 v107, v107, v9, v10 bitop3:0xea
    v_bitop3_b32 v107, v19, v11, v107 bitop3:0xea
    v_and_b32 v109, 0x0fffffff, v40
    v_mov_b32 v36, v40
    buffer_load_dwordx4 v[16:19], v109, s[8:11], 0 offen
    buffer_load_dword v32, v109, s[8:11], 0 offen offset:16
    v_cvt_pk_bf16_f32 v88, v96, v97
    v_cvt_pk_bf16_f32 v89, v98, v99
    ds_wrxchg_rtn_b64 v[90:91], v104, v[88:89]
    s_waitcnt lgkmcnt(1)
    v_mfma_f32_4x4x4_16b_bf16 v[92:95], v[12:13], v[84:85], 0
    s_waitcnt lgkmcnt(0)
    v_cmpx_ne_u64 vcc, v[90:91], v[86:87]
    s_cbranch_execz L2_c39
    s_nop 2
    v_mfma_f32_4x4x4_16b_bf16 v[100:103], v[14:15], v[86:87], 0
    s_nop 1
    v_mfma_f32_4x4x4_16b_bf16 v[100:103], v[12:13], v[90:91], v[100:103]
    s_nop 4
    v_cvt_pk_bf16_f32 v100, v100, v101
    v_cvt_pk_bf16_f32 v101, v102, v103
    ds_pk_add_bf16 v104, v100
    ds_pk_add_bf16 v104, v101 offset:4
L2_c39:
    s_mov_b64 exec, -1
    ds_read_b64 v[86:87], v105
    v_mul_f32 v92, v107, v92
    v_mul_f32 v93, v107, v93
    v_mul_f32 v94, v107, v94
    v_mul_f32 v95, v107, v95
    s_waitcnt vmcnt(16)
    v_and_b32 v108, 0x10000000, v37
    v_lshrrev_b32 v106, 14, v20
    v_bitop3_b32 v106, v106, v8, v108 bitop3:0xea
    ds_read_b64 v[84:85], v106 offset:63616
    s_waitcnt lgkmcnt(1)
    v_mfma_f32_4x4x4_16b_bf16 v[96:99], v[12:13], v[86:87], v[92:95]
    v_perm_b32 v107, v20, v33, s44
    v_bitop3_b32 v104, v20, v8, v108 bitop3:0xea
    v_bitop3_b32 v107, v107, v9, v10 bitop3:0xea
    v_bitop3_b32 v107, v20, v11, v107 bitop3:0xea
    s_nop 0
    v_cvt_pk_bf16_f32 v88, v96, v97
    v_cvt_pk_bf16_f32 v89, v98, v99
    ds_wrxchg_rtn_b64 v[90:91], v105, v[88:89]
    s_waitcnt lgkmcnt(1)
    v_mfma_f32_4x4x4_16b_bf16 v[92:95], v[12:13], v[84:85], 0
    s_waitcnt lgkmcnt(0)
    v_cmpx_ne_u64 vcc, v[90:91], v[86:87]
    s_cbranch_execz L2_c40
    s_nop 2
    v_mfma_f32_4x4x4_16b_bf16 v[100:103], v[14:15], v[86:87], 0
    s_nop 1
    v_mfma_f32_4x4x4_16b_bf16 v[100:103], v[12:13], v[90:91], v[100:103]
    s_nop 4
    v_cvt_pk_bf16_f32 v100, v100, v101
    v_cvt_pk_bf16_f32 v101, v102, v103
    ds_pk_add_bf16 v105, v100
    ds_pk_add_bf16 v105, v101 offset:4
L2_c40:
    s_mov_b64 exec, -1
    ds_read_b64 v[86:87], v104
    v_mul_f32 v92, v107, v92
    v_mul_f32 v93, v107, v93
    v_mul_f32 v94, v107, v94
    v_mul_f32 v95, v107, v95
    v_and_b32 v108, 0x20000000, v37
    v_lshrrev_b32 v106, 14, v21
    v_bitop3_b32 v106, v106, v8, v108 bitop3:0xea
    ds_read_b64 v[84:85], v106 offset:63616
    s_waitcnt lgkmcnt(1)
    v_mfma_f32_4x4x4_16b_bf16 v[96:99], v[12:13], v[86:87], v[92:95]
    v_perm_b32 v107, v21, v33, s45
    v_bitop3_b32 v105, v21, v8, v108 bitop3:0xea
    v_bitop3_b32 v107, v107, v9, v10 bitop3:0xea
    v_bitop3_b32 v107, v21, v11, v107 bitop3:0xea
    s_nop 0
    v_cvt_pk_bf16_f32 v88, v96, v97
    v_cvt_pk_bf16_f32 v89, v98, v99
    ds_wrxchg_rtn_b64 v[90:91], v104, v[88:89]
    s_waitcnt lgkmcnt(1)
    v_mfma_f32_4x4x4_16b_bf16 v[92:95], v[12:13], v[84:85], 0
    s_waitcnt lgkmcnt(0)
    v_cmpx_ne_u64 vcc, v[90:91], v[86:87]
    s_cbranch_execz L2_c41
    s_nop 2
    v_mfma_f32_4x4x4_16b_bf16 v[100:103], v[14:15], v[86:87], 0
    s_nop 1
    v_mfma_f32_4x4x4_16b_bf16 v[100:103], v[12:13], v[90:91], v[100:103]
    s_nop 4
    v_cvt_pk_bf16_f32 v100, v100, v101
    v_cvt_pk_bf16_f32 v101, v102, v103
    ds_pk_add_bf16 v104, v100
    ds_pk_add_bf16 v104, v101 offset:4
L2_c41:
    s_mov_b64 exec, -1
    ds_read_b64 v[86:87], v105
    v_mul_f32 v92, v107, v92
    v_mul_f32 v93, v107, v93
    v_mul_f32 v94, v107, v94
    v_mul_f32 v95, v107, v95
    v_and_b32 v108, 0x40000000, v37
    v_lshrrev_b32 v106, 14, v22
    v_bitop3_b32 v106, v106, v8, v108 bitop3:0xea
    ds_read_b64 v[84:85], v106 offset:63616
    s_waitcnt lgkmcnt(1)
    v_mfma_f32_4x4x4_16b_bf16 v[96:99], v[12:13], v[86:87], v[92:95]
    v_perm_b32 v107, v22, v33, s46
    v_bitop3_b32 v104, v22, v8, v108 bitop3:0xea
    v_bitop3_b32 v107, v107, v9, v10 bitop3:0xea
    v_bitop3_b32 v107, v22, v11, v107 bitop3:0xea
    s_nop 0
    v_cvt_pk_bf16_f32 v88, v96, v97
    v_cvt_pk_bf16_f32 v89, v98, v99
    ds_wrxchg_rtn_b64 v[90:91], v105, v[88:89]
    s_waitcnt lgkmcnt(1)
    v_mfma_f32_4x4x4_16b_bf16 v[92:95], v[12:13], v[84:85], 0
    s_waitcnt lgkmcnt(0)
    v_cmpx_ne_u64 vcc, v[90:91], v[86:87]
    s_cbranch_execz L2_c42
    s_nop 2
    v_mfma_f32_4x4x4_16b_bf16 v[100:103], v[14:15], v[86:87], 0
    s_nop 1
    v_mfma_f32_4x4x4_16b_bf16 v[100:103], v[12:13], v[90:91], v[100:103]
    s_nop 4
    v_cvt_pk_bf16_f32 v100, v100, v101
    v_cvt_pk_bf16_f32 v101, v102, v103
    ds_pk_add_bf16 v105, v100
    ds_pk_add_bf16 v105, v101 offset:4
L2_c42:
    s_mov_b64 exec, -1
    ds_read_b64 v[86:87], v104
    v_mul_f32 v92, v107, v92
    v_mul_f32 v93, v107, v93
    v_mul_f32 v94, v107, v94
    v_mul_f32 v95, v107, v95
    v_and_b32 v108, 0x80000000, v37
    v_lshrrev_b32 v106, 14, v23
    v_bitop3_b32 v106, v106, v8, v108 bitop3:0xea
    ds_read_b64 v[84:85], v106 offset:63616
    s_waitcnt lgkmcnt(1)
    v_mfma_f32_4x4x4_16b_bf16 v[96:99], v[12:13], v[86:87], v[92:95]
    v_perm_b32 v107, v23, v33, s47
    v_bitop3_b32 v105, v23, v8, v108 bitop3:0xea
    v_bitop3_b32 v107, v107, v9, v10 bitop3:0xea
    v_bitop3_b32 v107, v23, v11, v107 bitop3:0xea
    v_and_b32 v109, 0x0fffffff, v41
    v_mov_b32 v37, v41
    buffer_load_dwordx4 v[20:23], v109, s[8:11], 0 offen
    buffer_load_dword v33, v109, s[8:11], 0 offen offset:16
    v_cvt_pk_bf16_f32 v88, v96, v97
    v_cvt_pk_bf16_f32 v89, v98, v99
    ds_wrxchg_rtn_b64 v[90:91], v104, v[88:89]
    s_waitcnt lgkmcnt(1)
    v_mfma_f32_4x4x4_16b_bf16 v[92:95], v[12:13], v[84:85], 0
    s_waitcnt lgkmcnt(0)
    v_cmpx_ne_u64 vcc, v[90:91], v[86:87]
    s_cbranch_execz L2_c43
    s_nop 2
    v_mfma_f32_4x4x4_16b_bf16 v[100:103], v[14:15], v[86:87], 0
    s_nop 1
    v_mfma_f32_4x4x4_16b_bf16 v[100:103], v[12:13], v[90:91], v[100:103]
    s_nop 4
    v_cvt_pk_bf16_f32 v100, v100, v101
    v_cvt_pk_bf16_f32 v101, v102, v103
    ds_pk_add_bf16 v104, v100
    ds_pk_add_bf16 v104, v101 offset:4
L2_c43:
    s_mov_b64 exec, -1
    ds_read_b64 v[86:87], v105
    v_mul_f32 v92, v107, v92
    v_mul_f32 v93, v107, v93
    v_mul_f32 v94, v107, v94
    v_mul_f32 v95, v107, v95
    s_waitcnt vmcnt(16)
    v_and_b32 v108, 0x10000000, v38
    v_lshrrev_b32 v106, 14, v24
    v_bitop3_b32 v106, v106, v8, v108 bitop3:0xea
    ds_read_b64 v[84:85], v106 offset:63616
    s_waitcnt lgkmcnt(1)
    v_mfma_f32_4x4x4_16b_bf16 v[96:99], v[12:13], v[86:87], v[92:95]
    v_perm_b32 v107, v24, v34, s44
    v_bitop3_b32 v104, v24, v8, v108 bitop3:0xea
    v_bitop3_b32 v107, v107, v9, v10 bitop3:0xea
    v_bitop3_b32 v107, v24, v11, v107 bitop3:0xea
    s_nop 0
    v_cvt_pk_bf16_f32 v88, v96, v97
    v_cvt_pk_bf16_f32 v89, v98, v99
    ds_wrxchg_rtn_b64 v[90:91], v105, v[88:89]
    s_waitcnt lgkmcnt(1)
    v_mfma_f32_4x4x4_16b_bf16 v[92:95], v[12:13], v[84:85], 0
    s_waitcnt lgkmcnt(0)
    v_cmpx_ne_u64 vcc, v[90:91], v[86:87]
    s_cbranch_execz L2_c44
    s_nop 2
    v_mfma_f32_4x4x4_16b_bf16 v[100:103], v[14:15], v[86:87], 0
    s_nop 1
    v_mfma_f32_4x4x4_16b_bf16 v[100:103], v[12:13], v[90:91], v[100:103]
    s_nop 4
    v_cvt_pk_bf16_f32 v100, v100, v101
    v_cvt_pk_bf16_f32 v101, v102, v103
    ds_pk_add_bf16 v105, v100
    ds_pk_add_bf16 v105, v101 offset:4
L2_c44:
    s_mov_b64 exec, -1
    ds_read_b64 v[86:87], v104
    v_mul_f32 v92, v107, v92
    v_mul_f32 v93, v107, v93
    v_mul_f32 v94, v107, v94
    v_mul_f32 v95, v107, v95
    v_and_b32 v108, 0x20000000, v38
    v_lshrrev_b32 v106, 14, v25
    v_bitop3_b32 v106, v106, v8, v108 bitop3:0xea
    ds_read_b64 v[84:85], v106 offset:63616
    s_waitcnt lgkmcnt(1)
    v_mfma_f32_4x4x4_16b_bf16 v[96:99], v[12:13], v[86:87], v[92:95]
    v_perm_b32 v107, v25, v34, s45
    v_bitop3_b32 v105, v25, v8, v108 bitop3:0xea
    v_bitop3_b32 v107, v107, v9, v10 bitop3:0xea
    v_bitop3_b32 v107, v25, v11, v107 bitop3:0xea
    s_nop 0
    v_cvt_pk_bf16_f32 v88, v96, v97
    v_cvt_pk_bf16_f32 v89, v98, v99
    ds_wrxchg_rtn_b64 v[90:91], v104, v[88:89]
    s_waitcnt lgkmcnt(1)
    v_mfma_f32_4x4x4_16b_bf16 v[92:95], v[12:13], v[84:85], 0
    s_waitcnt lgkmcnt(0)
    v_cmpx_ne_u64 vcc, v[90:91], v[86:87]
    s_cbranch_execz L2_c45
    s_nop 2
    v_mfma_f32_4x4x4_16b_bf16 v[100:103], v[14:15], v[86:87], 0
    s_nop 1
    v_mfma_f32_4x4x4_16b_bf16 v[100:103], v[12:13], v[90:91], v[100:103]
    s_nop 4
    v_cvt_pk_bf16_f32 v100, v100, v101
    v_cvt_pk_bf16_f32 v101, v102, v103
    ds_pk_add_bf16 v104, v100
    ds_pk_add_bf16 v104, v101 offset:4
L2_c45:
    s_mov_b64 exec, -1
    ds_read_b64 v[86:87], v105
    v_mul_f32 v92, v107, v92
    v_mul_f32 v93, v107, v93
    v_mul_f32 v94, v107, v94
    v_mul_f32 v95, v107, v95
    v_and_b32 v108, 0x40000000, v38
    v_lshrrev_b32 v106, 14, v26
    v_bitop3_b32 v106, v106, v8, v108 bitop3:0xea
    ds_read_b64 v[84:85], v106 offset:63616
    s_waitcnt lgkmcnt(1)
    v_mfma_f32_4x4x4_16b_bf16 v[96:99], v[12:13], v[86:87], v[92:95]
    v_perm_b32 v107, v26, v34, s46
    v_bitop3_b32 v104, v26, v8, v108 bitop3:0xea
    v_bitop3_b32 v107, v107, v9, v10 bitop3:0xea
    v_bitop3_b32 v107, v26, v11, v107 bitop3:0xea
    s_nop 0
    v_cvt_pk_bf16_f32 v88, v96, v97
    v_cvt_pk_bf16_f32 v89, v98, v99
    ds_wrxchg_rtn_b64 v[90:91], v105, v[88:89]
    s_waitcnt lgkmcnt(1)
    v_mfma_f32_4x4x4_16b_bf16 v[92:95], v[12:13], v[84:85], 0
    s_waitcnt lgkmcnt(0)
    v_cmpx_ne_u64 vcc, v[90:91], v[86:87]
    s_cbranch_execz L2_c46
    s_nop 2
    v_mfma_f32_4x4x4_16b_bf16 v[100:103], v[14:15], v[86:87], 0
    s_nop 1
    v_mfma_f32_4x4x4_16b_bf16 v[100:103], v[12:13], v[90:91], v[100:103]
    s_nop 4
    v_cvt_pk_bf16_f32 v100, v100, v101
    v_cvt_pk_bf16_f32 v101, v102, v103
    ds_pk_add_bf16 v105, v100
    ds_pk_add_bf16 v105, v101 offset:4
L2_c46:
    s_mov_b64 exec, -1
    ds_read_b64 v[86:87], v104
    v_mul_f32 v92, v107, v92
    v_mul_f32 v93, v107, v93
    v_mul_f32 v94, v107, v94
    v_mul_f32 v95, v107, v95
    v_and_b32 v108, 0x80000000, v38
    v_lshrrev_b32 v106, 14, v27
    v_bitop3_b32 v106, v106, v8, v108 bitop3:0xea
    ds_read_b64 v[84:85], v106 offset:63616
    s_waitcnt lgkmcnt(1)
    v_mfma_f32_4x4x4_16b_bf16 v[96:99], v[12:13], v[86:87], v[92:95]
    v_perm_b32 v107, v27, v34, s47
    v_bitop3_b32 v105, v27, v8, v108 bitop3:0xea
    v_bitop3_b32 v107, v107, v9, v10 bitop3:0xea
    v_bitop3_b32 v107, v27, v11, v107 bitop3:0xea
    v_and_b32 v109, 0x0fffffff, v42
    v_mov_b32 v38, v42
    buffer_load_dwordx4 v[24:27], v109, s[8:11], 0 offen
    buffer_load_dword v34, v109, s[8:11], 0 offen offset:16
    v_cvt_pk_bf16_f32 v88, v96, v97
    v_cvt_pk_bf16_f32 v89, v98, v99
    ds_wrxchg_rtn_b64 v[90:91], v104, v[88:89]
    s_waitcnt lgkmcnt(1)
    v_mfma_f32_4x4x4_16b_bf16 v[92:95], v[12:13], v[84:85], 0
    s_waitcnt lgkmcnt(0)
    v_cmpx_ne_u64 vcc, v[90:91], v[86:87]
    s_cbranch_execz L2_c47
    s_nop 2
    v_mfma_f32_4x4x4_16b_bf16 v[100:103], v[14:15], v[86:87], 0
    s_nop 1
    v_mfma_f32_4x4x4_16b_bf16 v[100:103], v[12:13], v[90:91], v[100:103]
    s_nop 4
    v_cvt_pk_bf16_f32 v100, v100, v101
    v_cvt_pk_bf16_f32 v101, v102, v103
    ds_pk_add_bf16 v104, v100
    ds_pk_add_bf16 v104, v101 offset:4
L2_c47:
    s_mov_b64 exec, -1
    ds_read_b64 v[86:87], v105
    v_mul_f32 v92, v107, v92
    v_mul_f32 v93, v107, v93
    v_mul_f32 v94, v107, v94
    v_mul_f32 v95, v107, v95
    s_waitcnt vmcnt(16)
    v_and_b32 v108, 0x10000000, v39
    v_lshrrev_b32 v106, 14, v28
    v_bitop3_b32 v106, v106, v8, v108 bitop3:0xea
    ds_read_b64 v[84:85], v106 offset:63616
    s_waitcnt lgkmcnt(1)
    v_mfma_f32_4x4x4_16b_bf16 v[96:99], v[12:13], v[86:87], v[92:95]
    v_perm_b32 v107, v28, v35, s44
    v_bitop3_b32 v104, v28, v8, v108 bitop3:0xea
    v_bitop3_b32 v107, v107, v9, v10 bitop3:0xea
    v_bitop3_b32 v107, v28, v11, v107 bitop3:0xea
    s_nop 0
    v_cvt_pk_bf16_f32 v88, v96, v97
    v_cvt_pk_bf16_f32 v89, v98, v99
    ds_wrxchg_rtn_b64 v[90:91], v105, v[88:89]
    s_waitcnt lgkmcnt(1)
    v_mfma_f32_4x4x4_16b_bf16 v[92:95], v[12:13], v[84:85], 0
    s_waitcnt lgkmcnt(0)
    v_cmpx_ne_u64 vcc, v[90:91], v[86:87]
    s_cbranch_execz L2_c48
    s_nop 2
    v_mfma_f32_4x4x4_16b_bf16 v[100:103], v[14:15], v[86:87], 0
    s_nop 1
    v_mfma_f32_4x4x4_16b_bf16 v[100:103], v[12:13], v[90:91], v[100:103]
    s_nop 4
    v_cvt_pk_bf16_f32 v100, v100, v101
    v_cvt_pk_bf16_f32 v101, v102, v103
    ds_pk_add_bf16 v105, v100
    ds_pk_add_bf16 v105, v101 offset:4
L2_c48:
    s_mov_b64 exec, -1
    ds_read_b64 v[86:87], v104
    v_mul_f32 v92, v107, v92
    v_mul_f32 v93, v107, v93
    v_mul_f32 v94, v107, v94
    v_mul_f32 v95, v107, v95
    v_and_b32 v108, 0x20000000, v39
    v_lshrrev_b32 v106, 14, v29
    v_bitop3_b32 v106, v106, v8, v108 bitop3:0xea
    ds_read_b64 v[84:85], v106 offset:63616
    s_waitcnt lgkmcnt(1)
    v_mfma_f32_4x4x4_16b_bf16 v[96:99], v[12:13], v[86:87], v[92:95]
    v_perm_b32 v107, v29, v35, s45
    v_bitop3_b32 v105, v29, v8, v108 bitop3:0xea
    v_bitop3_b32 v107, v107, v9, v10 bitop3:0xea
    v_bitop3_b32 v107, v29, v11, v107 bitop3:0xea
    s_nop 0
    v_cvt_pk_bf16_f32 v88, v96, v97
    v_cvt_pk_bf16_f32 v89, v98, v99
    ds_wrxchg_rtn_b64 v[90:91], v104, v[88:89]
    s_waitcnt lgkmcnt(1)
    v_mfma_f32_4x4x4_16b_bf16 v[92:95], v[12:13], v[84:85], 0
    s_waitcnt lgkmcnt(0)
    v_cmpx_ne_u64 vcc, v[90:91], v[86:87]
    s_cbranch_execz L2_c49
    s_nop 2
    v_mfma_f32_4x4x4_16b_bf16 v[100:103], v[14:15], v[86:87], 0
    s_nop 1
    v_mfma_f32_4x4x4_16b_bf16 v[100:103], v[12:13], v[90:91], v[100:103]
    s_nop 4
    v_cvt_pk_bf16_f32 v100, v100, v101
    v_cvt_pk_bf16_f32 v101, v102, v103
    ds_pk_add_bf16 v104, v100
    ds_pk_add_bf16 v104, v101 offset:4
L2_c49:
    s_mov_b64 exec, -1
    ds_read_b64 v[86:87], v105
    v_mul_f32 v92, v107, v92
    v_mul_f32 v93, v107, v93
    v_mul_f32 v94, v107, v94
    v_mul_f32 v95, v107, v95
    v_and_b32 v108, 0x40000000, v39
    v_lshrrev_b32 v106, 14, v30
    v_bitop3_b32 v106, v106, v8, v108 bitop3:0xea
    ds_read_b64 v[84:85], v106 offset:63616
    s_waitcnt lgkmcnt(1)
    v_mfma_f32_4x4x4_16b_bf16 v[96:99], v[12:13], v[86:87], v[92:95]
    v_perm_b32 v107, v30, v35, s46
    v_bitop3_b32 v104, v30, v8, v108 bitop3:0xea
    v_bitop3_b32 v107, v107, v9, v10 bitop3:0xea
    v_bitop3_b32 v107, v30, v11, v107 bitop3:0xea
    s_nop 0
    v_cvt_pk_bf16_f32 v88, v96, v97
    v_cvt_pk_bf16_f32 v89, v98, v99
    ds_wrxchg_rtn_b64 v[90:91], v105, v[88:89]
    s_waitcnt lgkmcnt(1)
    v_mfma_f32_4x4x4_16b_bf16 v[92:95], v[12:13], v[84:85], 0
    s_waitcnt lgkmcnt(0)
    v_cmpx_ne_u64 vcc, v[90:91], v[86:87]
    s_cbranch_execz L2_c50
    s_nop 2
    v_mfma_f32_4x4x4_16b_bf16 v[100:103], v[14:15], v[86:87], 0
    s_nop 1
    v_mfma_f32_4x4x4_16b_bf16 v[100:103], v[12:13], v[90:91], v[100:103]
    s_nop 4
    v_cvt_pk_bf16_f32 v100, v100, v101
    v_cvt_pk_bf16_f32 v101, v102, v103
    ds_pk_add_bf16 v105, v100
    ds_pk_add_bf16 v105, v101 offset:4
L2_c50:
    s_mov_b64 exec, -1
    ds_read_b64 v[86:87], v104
    v_mul_f32 v92, v107, v92
    v_mul_f32 v93, v107, v93
    v_mul_f32 v94, v107, v94
    v_mul_f32 v95, v107, v95
    v_and_b32 v108, 0x80000000, v39
    v_lshrrev_b32 v106, 14, v31
    v_bitop3_b32 v106, v106, v8, v108 bitop3:0xea
    ds_read_b64 v[84:85], v106 offset:63616
    s_waitcnt lgkmcnt(1)
    v_mfma_f32_4x4x4_16b_bf16 v[96:99], v[12:13], v[86:87], v[92:95]
    v_perm_b32 v107, v31, v35, s47
    v_bitop3_b32 v105, v31, v8, v108 bitop3:0xea
    v_bitop3_b32 v107, v107, v9, v10 bitop3:0xea
    v_bitop3_b32 v107, v31, v11, v107 bitop3:0xea
    v_and_b32 v109, 0x0fffffff, v43
    v_mov_b32 v39, v43
    buffer_load_dwordx4 v[28:31], v109, s[8:11], 0 offen
    buffer_load_dword v35, v109, s[8:11], 0 offen offset:16
    v_cvt_pk_bf16_f32 v88, v96, v97
    v_cvt_pk_bf16_f32 v89, v98, v99
    ds_wrxchg_rtn_b64 v[90:91], v104, v[88:89]
    s_waitcnt lgkmcnt(1)
    v_mfma_f32_4x4x4_16b_bf16 v[92:95], v[12:13], v[84:85], 0
    s_waitcnt lgkmcnt(0)
    v_cmpx_ne_u64 vcc, v[90:91], v[86:87]
    s_cbranch_execz L2_c51
    s_nop 2
    v_mfma_f32_4x4x4_16b_bf16 v[100:103], v[14:15], v[86:87], 0
    s_nop 1
    v_mfma_f32_4x4x4_16b_bf16 v[100:103], v[12:13], v[90:91], v[100:103]
    s_nop 4
    v_cvt_pk_bf16_f32 v100, v100, v101
    v_cvt_pk_bf16_f32 v101, v102, v103
    ds_pk_add_bf16 v104, v100
    ds_pk_add_bf16 v104, v101 offset:4
L2_c51:
    s_mov_b64 exec, -1
    ds_read_b64 v[86:87], v105
    v_mul_f32 v92, v107, v92
    v_mul_f32 v93, v107, v93
    v_mul_f32 v94, v107, v94
    v_mul_f32 v95, v107, v95
    s_waitcnt lgkmcnt(0)
    s_nop 0
    v_mfma_f32_4x4x4_16b_bf16 v[96:99], v[12:13], v[86:87], v[92:95]
    s_nop 4
    v_cvt_pk_bf16_f32 v88, v96, v97
    v_cvt_pk_bf16_f32 v89, v98, v99
    ds_wrxchg_rtn_b64 v[90:91], v105, v[88:89]
    s_waitcnt lgkmcnt(0)
    v_cmpx_ne_u64 vcc, v[90:91], v[86:87]
    s_cbranch_execz L2_c52
    s_nop 2
    v_mfma_f32_4x4x4_16b_bf16 v[100:103], v[14:15], v[86:87], 0
    s_nop 1
    v_mfma_f32_4x4x4_16b_bf16 v[100:103], v[12:13], v[90:91], v[100:103]
    s_nop 4
    v_cvt_pk_bf16_f32 v100, v100, v101
    v_cvt_pk_bf16_f32 v101, v102, v103
    ds_pk_add_bf16 v105, v100
    ds_pk_add_bf16 v105, v101 offset:4
L2_c52:
    s_mov_b64 exec, -1
    s_bitcmp1_b32 s36, s42
    s_cbranch_scc1 L2_slow
L2_ret2:
    s_barrier
    s_waitcnt vmcnt(8)
    s_mov_b32 s37, s38
    s_add_u32 s48, s38, 257
    v_and_b32 v110, 0xffff, v64
    v_and_b32 v111, 0xffff, v66
    v_and_b32 v112, -4, v110
    v_add_u32 v112, v112, v2
L2_x53_0:
    v_sub_u32 v113, v111, v112
    v_sub_u32 v115, v110, v112
    v_med3_i32 v114, v113, 0, 4
    v_max_i32 v115, 0, v115
    v_cmp_gt_i32 vcc, v114, v115
    v_mad_u32_u24 v116, v112, 5, v4
    v_bfm_b32 v114, v114, 28
    v_bfm_b32 v115, v115, 28
    v_mbcnt_lo_u32_b32 v117, vcc_lo, 0
    v_mbcnt_hi_u32_b32 v117, vcc_hi, v117
    v_bitop3_b32 v116, v114, v115, v116 bitop3:0x9a
    v_add_lshl_u32 v117, v117, s37, 2
    s_bcnt1_i32_b64 s41, vcc
    s_mov_b64 exec, vcc
    ds_write_b32 v117, v116
    s_mov_b64 exec, -1
    v_cmp_gt_i32 vcc, v113, v3
    s_add_u32 s37, s37, s41
    s_min_u32 s37, s37, s48
    s_cbranch_vccnz L2_xe53_0
L2_xr53_0:
    ds_write_b128 v7, v[52:55] offset:2048
    v_and_b32 v110, 0xffff, v68
    v_and_b32 v111, 0xffff, v70
    v_and_b32 v112, -4, v110
    v_add_u32 v112, v112, v2
    v_add_u32 v118, 0x2800000, v4
L2_x53_1:
    v_sub_u32 v113, v111, v112
    v_sub_u32 v115, v110, v112
    v_med3_i32 v114, v113, 0, 4
    v_max_i32 v115, 0, v115
    v_cmp_gt_i32 vcc, v114, v115
    v_mad_u32_u24 v116, v112, 5, v118
    v_bfm_b32 v114, v114, 28
    v_bfm_b32 v115, v115, 28
    v_mbcnt_lo_u32_b32 v117, vcc_lo, 0
    v_mbcnt_hi_u32_b32 v117, vcc_hi, v117
    v_bitop3_b32 v116, v114, v115, v116 bitop3:0x9a
    v_add_lshl_u32 v117, v117, s37, 2
    s_bcnt1_i32_b64 s41, vcc
    s_mov_b64 exec, vcc
    ds_write_b32 v117, v116
    s_mov_b64 exec, -1
    v_cmp_gt_i32 vcc, v113, v3
    s_add_u32 s37, s37, s41
    s_min_u32 s37, s37, s48
    s_cbranch_vccnz L2_xe53_1
L2_xr53_1:
    ds_write_b128 v7, v[56:59] offset:3072
    v_and_b32 v110, 0xffff, v72
    v_and_b32 v111, 0xffff, v74
    v_and_b32 v112, -4, v110
    v_add_u32 v112, v112, v2
    v_add_u32 v118, 0x5000000, v4
L2_x53_2:
    v_sub_u32 v113, v111, v112
    v_sub_u32 v115, v110, v112
    v_med3_i32 v114, v113, 0, 4
    v_max_i32 v115, 0, v115
    v_cmp_gt_i32 vcc, v114, v115
    v_mad_u32_u24 v116, v112, 5, v118
    v_bfm_b32 v114, v114, 28
    v_bfm_b32 v115, v115, 28
    v_mbcnt_lo_u32_b32 v117, vcc_lo, 0
    v_mbcnt_hi_u32_b32 v117, vcc_hi, v117
    v_bitop3_b32 v116, v114, v115, v116 bitop3:0x9a
    v_add_lshl_u32 v117, v117, s37, 2
    s_bcnt1_i32_b64 s41, vcc
    s_mov_b64 exec, vcc
    ds_write_b32 v117, v116
    s_mov_b64 exec, -1
    v_cmp_gt_i32 vcc, v113, v3
    s_add_u32 s37, s37, s41
    s_min_u32 s37, s37, s48
    s_cbranch_vccnz L2_xe53_2
L2_xr53_2:
    ds_write_b128 v7, v[60:63] offset:4096
    v_and_b32 v110, 0xffff, v76
    v_and_b32 v111, 0xffff, v78
    v_and_b32 v112, -4, v110
    v_add_u32 v112, v112, v2
    v_add_u32 v118, 0x7800000, v4
L2_x53_3:
    v_sub_u32 v113, v111, v112
    v_sub_u32 v115, v110, v112
    v_med3_i32 v114, v113, 0, 4
    v_max_i32 v115, 0, v115
    v_cmp_gt_i32 vcc, v114, v115
    v_mad_u32_u24 v116, v112, 5, v118
    v_bfm_b32 v114, v114, 28
    v_bfm_b32 v115, v115, 28
    v_mbcnt_lo_u32_b32 v117, vcc_lo, 0
    v_mbcnt_hi_u32_b32 v117, vcc_hi, v117
    v_bitop3_b32 v116, v114, v115, v116 bitop3:0x9a
    v_add_lshl_u32 v117, v117, s37, 2
    s_bcnt1_i32_b64 s41, vcc
    s_mov_b64 exec, vcc
    ds_write_b32 v117, v116
    s_mov_b64 exec, -1
    v_cmp_gt_i32 vcc, v113, v3
    s_add_u32 s37, s37, s41
    s_min_u32 s37, s37, s48
    s_cbranch_vccnz L2_xe53_3
L2_xr53_3:
    v_and_b32 v110, 0xffff, v80
    v_and_b32 v111, 0xffff, v82
    v_and_b32 v112, -4, v110
    v_add_u32 v112, v112, v2
    v_add_u32 v118, 0xa000000, v4
L2_x53_4:
    v_sub_u32 v113, v111, v112
    v_sub_u32 v115, v110, v112
    v_med3_i32 v114, v113, 0, 4
    v_max_i32 v115, 0, v115
    v_cmp_gt_i32 vcc, v114, v115
    v_mad_u32_u24 v116, v112, 5, v118
    v_bfm_b32 v114, v114, 28
    v_bfm_b32 v115, v115, 28
    v_mbcnt_lo_u32_b32 v117, vcc_lo, 0
    v_mbcnt_hi_u32_b32 v117, vcc_hi, v117
    v_bitop3_b32 v116, v114, v115, v116 bitop3:0x9a
    v_add_lshl_u32 v117, v117, s37, 2
    s_bcnt1_i32_b64 s41, vcc
    s_mov_b64 exec, vcc
    ds_write_b32 v117, v116
    s_mov_b64 exec, -1
    v_cmp_gt_i32 vcc, v113, v3
    s_add_u32 s37, s37, s41
    s_min_u32 s37, s37, s48
    s_cbranch_vccnz L2_xe53_4
L2_xr53_4:
    s_lshl_b32 s3, s37, 2
    v_add_u32 v117, s3, v1
    v_mov_b32 v116, -1
    ds_write_b32 v117, v116
    s_lshl_b32 s3, s38, 2
    v_add_u32 v117, s3, v1
    ds_read2st64_b32 v[40:41], v117 offset0:0 offset1:1
    ds_read2st64_b32 v[42:43], v117 offset0:2 offset1:3
    s_sub_u32 s41, s37, s38
    s_sub_u32 s3, s41, 192
    s_cmp_gt_u32 s3, 64
    s_cbranch_scc1 L2_xf53
L2_xg53:
    ds_write_b128 v7, v[44:47] offset:0
    ds_write_b128 v7, v[48:51] offset:1024
    buffer_load_dwordx4 v[44:47], v6, s[16:19], s40 offen offset:0
    buffer_load_dwordx4 v[48:51], v6, s[16:19], s40 offen offset:1024
    buffer_load_dwordx4 v[52:55], v6, s[16:19], s40 offen offset:2048
    buffer_load_dwordx4 v[56:59], v6, s[16:19], s40 offen offset:3072
    s_add_u32 s3, s40, 4096
    buffer_load_dwordx4 v[60:63], v6, s[16:19], s3 offen
    s_add_u32 s40, s40, 80000
    s_add_u32 s42, s42, 1
    s_waitcnt lgkmcnt(0)
    s_barrier
    s_waitcnt vmcnt(11)
    v_and_b32 v108, 0x10000000, v36
    v_lshrrev_b32 v106, 14, v16
    v_bitop3_b32 v106, v106, v8, v108 bitop3:0xea
    ds_read_b64 v[84:85], v106 offset:63616
    v_perm_b32 v107, v16, v32, s44
    v_bitop3_b32 v104, v16, v8, v108 bitop3:0xea
    v_bitop3_b32 v107, v107, v9, v10 bitop3:0xea
    v_bitop3_b32 v107, v16, v11, v107 bitop3:0xea
    s_waitcnt lgkmcnt(0)
    v_mfma_f32_4x4x4_16b_bf16 v[92:95], v[12:13], v[84:85], 0
    ds_read_b64 v[86:87], v104
    s_nop 3
    v_mul_f32 v92, v107, v92
    v_mul_f32 v93, v107, v93
    v_mul_f32 v94, v107, v94
    v_mul_f32 v95, v107, v95
    v_and_b32 v108, 0x20000000, v36
    v_lshrrev_b32 v106, 14, v17
    v_bitop3_b32 v106, v106, v8, v108 bitop3:0xea
    ds_read_b64 v[84:85], v106 offset:63616
    s_waitcnt lgkmcnt(1)
    v_mfma_f32_4x4x4_16b_bf16 v[96:99], v[12:13], v[86:87], v[92:95]
    v_perm_b32 v107, v17, v32, s45
    v_bitop3_b32 v105, v17, v8, v108 bitop3:0xea
    v_bitop3_b32 v107, v107, v9, v10 bitop3:0xea
    v_bitop3_b32 v107, v17, v11, v107 bitop3:0xea
    s_nop 0
    v_cvt_pk_bf16_f32 v88, v96, v97
    v_cvt_pk_bf16_f32 v89, v98, v99
    ds_wrxchg_rtn_b64 v[90:91], v104, v[88:89]
    s_waitcnt lgkmcnt(1)
    v_mfma_f32_4x4x4_16b_bf16 v[92:95], v[12:13], v[84:85], 0
    s_waitcnt lgkmcnt(0)
    v_cmpx_ne_u64 vcc, v[90:91], v[86:87]
    s_cbranch_execz L2_c54
    s_nop 2
    v_mfma_f32_4x4x4_16b_bf16 v[100:103], v[14:15], v[86:87], 0
    s_nop 1
    v_mfma_f32_4x4x4_16b_bf16 v[100:103], v[12:13], v[90:91], v[100:103]
    s_nop 4
    v_cvt_pk_bf16_f32 v100, v100, v101
    v_cvt_pk_bf16_f32 v101, v102, v103
    ds_pk_add_bf16 v104, v100
    ds_pk_add_bf16 v104, v101 offset:4
L2_c54:
    s_mov_b64 exec, -1
    ds_read_b64 v[86:87], v105
    v_mul_f32 v92, v107, v92
    v_mul_f32 v93, v107, v93
    v_mul_f32 v94, v107, v94
    v_mul_f32 v95, v107, v95
    v_and_b32 v108, 0x40000000, v36
    v_lshrrev_b32 v106, 14, v18
    v_bitop3_b32 v106, v106, v8, v108 bitop3:0xea
    ds_read_b64 v[84:85], v106 offset:63616
    s_waitcnt lgkmcnt(1)
    v_mfma_f32_4x4x4_16b_bf16 v[96:99], v[12:13], v[86:87], v[92:95]
    v_perm_b32 v107, v18, v32, s46
    v_bitop3_b32 v104, v18, v8, v108 bitop3:0xea
    v_bitop3_b32 v107, v107, v9, v10 bitop3:0xea
    v_bitop3_b32 v107, v18, v11, v107 bitop3:0xea
    s_nop 0
    v_cvt_pk_bf16_f32 v88, v96, v97
    v_cvt_pk_bf16_f32 v89, v98, v99
    ds_wrxchg_rtn_b64 v[90:91], v105, v[88:89]
    s_waitcnt lgkmcnt(1)
    v_mfma_f32_4x4x4_16b_bf16 v[92:95], v[12:13], v[84:85], 0
    s_waitcnt lgkmcnt(0)
    v_cmpx_ne_u64 vcc, v[90:91], v[86:87]
    s_cbranch_execz L2_c55
    s_nop 2
    v_mfma_f32_4x4x4_16b_bf16 v[100:103], v[14:15], v[86:87], 0
    s_nop 1
    v_mfma_f32_4x4x4_16b_bf16 v[100:103], v[12:13], v[90:91], v[100:103]
    s_nop 4
    v_cvt_pk_bf16_f32 v100, v100, v101
    v_cvt_pk_bf16_f32 v101, v102, v103
    ds_pk_add_bf16 v105, v100
    ds_pk_add_bf16 v105, v101 offset:4
L2_c55:
    s_mov_b64 exec, -1
    ds_read_b64 v[86:87], v104
    v_mul_f32 v92, v107, v92
    v_mul_f32 v93, v107, v93
    v_mul_f32 v94, v107, v94
    v_mul_f32 v95, v107, v95
    v_and_b32 v108, 0x80000000, v36
    v_lshrrev_b32 v106, 14, v19
    v_bitop3_b32 v106, v106, v8, v108 bitop3:0xea
    ds_read_b64 v[84:85], v106 offset:63616
    s_waitcnt lgkmcnt(1)
    v_mfma_f32_4x4x4_16b_bf16 v[96:99], v[12:13], v[86:87], v[92:95]
    v_perm_b32 v107, v19, v32, s47
    v_bitop3_b32 v105, v19, v8, v108 bitop3:0xea
    v_bitop3_b32 v107, v107, v9, v10 bitop3:0xea
    v_bitop3_b32 v107, v19, v11, v107 bitop3:0xea
    v_and_b32 v109, 0x0fffffff, v40
    v_mov_b32 v36, v40
    buffer_load_dwordx4 v[16:19], v109, s[8:11], 0 offen
    buffer_load_dword v32, v109, s[8:11], 0 offen offset:16
    v_cvt_pk_bf16_f32 v88, v96, v97
    v_cvt_pk_bf16_f32 v89, v98, v99
    ds_wrxchg_rtn_b64 v[90:91], v104, v[88:89]
    s_waitcnt lgkmcnt(1)
    v_mfma_f32_4x4x4_16b_bf16 v[92:95], v[12:13], v[84:85], 0
    s_waitcnt lgkmcnt(0)
    v_cmpx_ne_u64 vcc, v[90:91], v[86:87]
    s_cbranch_execz L2_c56
    s_nop 2
    v_mfma_f32_4x4x4_16b_bf16 v[100:103], v[14:15], v[86:87], 0
    s_nop 1
    v_mfma_f32_4x4x4_16b_bf16 v[100:103], v[12:13], v[90:91], v[100:103]
    s_nop 4
    v_cvt_pk_bf16_f32 v100, v100, v101
    v_cvt_pk_bf16_f32 v101, v102, v103
    ds_pk_add_bf16 v104, v100
    ds_pk_add_bf16 v104, v101 offset:4
L2_c56:
    s_mov_b64 exec, -1
    ds_read_b64 v[86:87], v105
    v_mul_f32 v92, v107, v92
    v_mul_f32 v93, v107, v93
    v_mul_f32 v94, v107, v94
    v_mul_f32 v95, v107, v95
    s_waitcnt vmcnt(11)
    v_and_b32 v108, 0x10000000, v37
    v_lshrrev_b32 v106, 14, v20
    v_bitop3_b32 v106, v106, v8, v108 bitop3:0xea
    ds_read_b64 v[84:85], v106 offset:63616
    s_waitcnt lgkmcnt(1)
    v_mfma_f32_4x4x4_16b_bf16 v[96:99], v[12:13], v[86:87], v[92:95]
    v_perm_b32 v107, v20, v33, s44
    v_bitop3_b32 v104, v20, v8, v108 bitop3:0xea
    v_bitop3_b32 v107, v107, v9, v10 bitop3:0xea
    v_bitop3_b32 v107, v20, v11, v107 bitop3:0xea
    s_nop 0
    v_cvt_pk_bf16_f32 v88, v96, v97
    v_cvt_pk_bf16_f32 v89, v98, v99
    ds_wrxchg_rtn_b64 v[90:91], v105, v[88:89]
    s_waitcnt lgkmcnt(1)
    v_mfma_f32_4x4x4_16b_bf16 v[92:95], v[12:13], v[84:85], 0
    s_waitcnt lgkmcnt(0)
    v_cmpx_ne_u64 vcc, v[90:91], v[86:87]
    s_cbranch_execz L2_c57
    s_nop 2
    v_mfma_f32_4x4x4_16b_bf16 v[100:103], v[14:15], v[86:87], 0
    s_nop 1
    v_mfma_f32_4x4x4_16b_bf16 v[100:103], v[12:13], v[90:91], v[100:103]
    s_nop 4
    v_cvt_pk_bf16_f32 v100, v100, v101
    v_cvt_pk_bf16_f32 v101, v102, v103
    ds_pk_add_bf16 v105, v100
    ds_pk_add_bf16 v105, v101 offset:4
L2_c57:
    s_mov_b64 exec, -1
    ds_read_b64 v[86:87], v104
    v_mul_f32 v92, v107, v92
    v_mul_f32 v93, v107, v93
    v_mul_f32 v94, v107, v94
    v_mul_f32 v95, v107, v95
    v_and_b32 v108, 0x20000000, v37
    v_lshrrev_b32 v106, 14, v21
    v_bitop3_b32 v106, v106, v8, v108 bitop3:0xea
    ds_read_b64 v[84:85], v106 offset:63616
    s_waitcnt lgkmcnt(1)
    v_mfma_f32_4x4x4_16b_bf16 v[96:99], v[12:13], v[86:87], v[92:95]
    v_perm_b32 v107, v21, v33, s45
    v_bitop3_b32 v105, v21, v8, v108 bitop3:0xea
    v_bitop3_b32 v107, v107, v9, v10 bitop3:0xea
    v_bitop3_b32 v107, v21, v11, v107 bitop3:0xea
    s_nop 0
    v_cvt_pk_bf16_f32 v88, v96, v97
    v_cvt_pk_bf16_f32 v89, v98, v99
    ds_wrxchg_rtn_b64 v[90:91], v104, v[88:89]
    s_waitcnt lgkmcnt(1)
    v_mfma_f32_4x4x4_16b_bf16 v[92:95], v[12:13], v[84:85], 0
    s_waitcnt lgkmcnt(0)
    v_cmpx_ne_u64 vcc, v[90:91], v[86:87]
    s_cbranch_execz L2_c58
    s_nop 2
    v_mfma_f32_4x4x4_16b_bf16 v[100:103], v[14:15], v[86:87], 0
    s_nop 1
    v_mfma_f32_4x4x4_16b_bf16 v[100:103], v[12:13], v[90:91], v[100:103]
    s_nop 4
    v_cvt_pk_bf16_f32 v100, v100, v101
    v_cvt_pk_bf16_f32 v101, v102, v103
    ds_pk_add_bf16 v104, v100
    ds_pk_add_bf16 v104, v101 offset:4
L2_c58:
    s_mov_b64 exec, -1
    ds_read_b64 v[86:87], v105
    v_mul_f32 v92, v107, v92
    v_mul_f32 v93, v107, v93
    v_mul_f32 v94, v107, v94
    v_mul_f32 v95, v107, v95
    v_and_b32 v108, 0x40000000, v37
    v_lshrrev_b32 v106, 14, v22
    v_bitop3_b32 v106, v106, v8, v108 bitop3:0xea
    ds_read_b64 v[84:85], v106 offset:63616
    s_waitcnt lgkmcnt(1)
    v_mfma_f32_4x4x4_16b_bf16 v[96:99], v[12:13], v[86:87], v[92:95]
    v_perm_b32 v107, v22, v33, s46
    v_bitop3_b32 v104, v22, v8, v108 bitop3:0xea
    v_bitop3_b32 v107, v107, v9, v10 bitop3:0xea
    v_bitop3_b32 v107, v22, v11, v107 bitop3:0xea
    s_nop 0
    v_cvt_pk_bf16_f32 v88, v96, v97
    v_cvt_pk_bf16_f32 v89, v98, v99
    ds_wrxchg_rtn_b64 v[90:91], v105, v[88:89]
    s_waitcnt lgkmcnt(1)
    v_mfma_f32_4x4x4_16b_bf16 v[92:95], v[12:13], v[84:85], 0
    s_waitcnt lgkmcnt(0)
    v_cmpx_ne_u64 vcc, v[90:91], v[86:87]
    s_cbranch_execz L2_c59
    s_nop 2
    v_mfma_f32_4x4x4_16b_bf16 v[100:103], v[14:15], v[86:87], 0
    s_nop 1
    v_mfma_f32_4x4x4_16b_bf16 v[100:103], v[12:13], v[90:91], v[100:103]
    s_nop 4
    v_cvt_pk_bf16_f32 v100, v100, v101
    v_cvt_pk_bf16_f32 v101, v102, v103
    ds_pk_add_bf16 v105, v100
    ds_pk_add_bf16 v105, v101 offset:4
L2_c59:
    s_mov_b64 exec, -1
    ds_read_b64 v[86:87], v104
    v_mul_f32 v92, v107, v92
    v_mul_f32 v93, v107, v93
    v_mul_f32 v94, v107, v94
    v_mul_f32 v95, v107, v95
    v_and_b32 v108, 0x80000000, v37
    v_lshrrev_b32 v106, 14, v23
    v_bitop3_b32 v106, v106, v8, v108 bitop3:0xea
    ds_read_b64 v[84:85], v106 offset:63616
    s_waitcnt lgkmcnt(1)
    v_mfma_f32_4x4x4_16b_bf16 v[96:99], v[12:13], v[86:87], v[92:95]
    v_perm_b32 v107, v23, v33, s47
    v_bitop3_b32 v105, v23, v8, v108 bitop3:0xea
    v_bitop3_b32 v107, v107, v9, v10 bitop3:0xea
    v_bitop3_b32 v107, v23, v11, v107 bitop3:0xea
    v_and_b32 v109, 0x0fffffff, v41
    v_mov_b32 v37, v41
    buffer_load_dwordx4 v[20:23], v109, s[8:11], 0 offen
    buffer_load_dword v33, v109, s[8:11], 0 offen offset:16
    v_cvt_pk_bf16_f32 v88, v96, v97
    v_cvt_pk_bf16_f32 v89, v98, v99
    ds_wrxchg_rtn_b64 v[90:91], v104, v[88:89]
    s_waitcnt lgkmcnt(1)
    v_mfma_f32_4x4x4_16b_bf16 v[92:95], v[12:13], v[84:85], 0
    s_waitcnt lgkmcnt(0)
    v_cmpx_ne_u64 vcc, v[90:91], v[86:87]
    s_cbranch_execz L2_c60
    s_nop 2
    v_mfma_f32_4x4x4_16b_bf16 v[100:103], v[14:15], v[86:87], 0
    s_nop 1
    v_mfma_f32_4x4x4_16b_bf16 v[100:103], v[12:13], v[90:91], v[100:103]
    s_nop 4
    v_cvt_pk_bf16_f32 v100, v100, v101
    v_cvt_pk_bf16_f32 v101, v102, v103
    ds_pk_add_bf16 v104, v100
    ds_pk_add_bf16 v104, v101 offset:4
L2_c60:
    s_mov_b64 exec, -1
    ds_read_b64 v[86:87], v105
    v_mul_f32 v92, v107, v92
    v_mul_f32 v93, v107, v93
    v_mul_f32 v94, v107, v94
    v_mul_f32 v95, v107, v95
    s_waitcnt vmcnt(11)
    v_and_b32 v108, 0x10000000, v38
    v_lshrrev_b32 v106, 14, v24
    v_bitop3_b32 v106, v106, v8, v108 bitop3:0xea
    ds_read_b64 v[84:85], v106 offset:63616
    s_waitcnt lgkmcnt(1)
    v_mfma_f32_4x4x4_16b_bf16 v[96:99], v[12:13], v[86:87], v[92:95]
    v_perm_b32 v107, v24, v34, s44
    v_bitop3_b32 v104, v24, v8, v108 bitop3:0xea
    v_bitop3_b32 v107, v107, v9, v10 bitop3:0xea
    v_bitop3_b32 v107, v24, v11, v107 bitop3:0xea
    s_nop 0
    v_cvt_pk_bf16_f32 v88, v96, v97
    v_cvt_pk_bf16_f32 v89, v98, v99
    ds_wrxchg_rtn_b64 v[90:91], v105, v[88:89]
    s_waitcnt lgkmcnt(1)
    v_mfma_f32_4x4x4_16b_bf16 v[92:95], v[12:13], v[84:85], 0
    s_waitcnt lgkmcnt(0)
    v_cmpx_ne_u64 vcc, v[90:91], v[86:87]
    s_cbranch_execz L2_c61
    s_nop 2
    v_mfma_f32_4x4x4_16b_bf16 v[100:103], v[14:15], v[86:87], 0
    s_nop 1
    v_mfma_f32_4x4x4_16b_bf16 v[100:103], v[12:13], v[90:91], v[100:103]
    s_nop 4
    v_cvt_pk_bf16_f32 v100, v100, v101
    v_cvt_pk_bf16_f32 v101, v102, v103
    ds_pk_add_bf16 v105, v100
    ds_pk_add_bf16 v105, v101 offset:4
L2_c61:
    s_mov_b64 exec, -1
    ds_read_b64 v[86:87], v104
    v_mul_f32 v92, v107, v92
    v_mul_f32 v93, v107, v93
    v_mul_f32 v94, v107, v94
    v_mul_f32 v95, v107, v95
    v_and_b32 v108, 0x20000000, v38
    v_lshrrev_b32 v106, 14, v25
    v_bitop3_b32 v106, v106, v8, v108 bitop3:0xea
    ds_read_b64 v[84:85], v106 offset:63616
    s_waitcnt lgkmcnt(1)
    v_mfma_f32_4x4x4_16b_bf16 v[96:99], v[12:13], v[86:87], v[92:95]
    v_perm_b32 v107, v25, v34, s45
    v_bitop3_b32 v105, v25, v8, v108 bitop3:0xea
    v_bitop3_b32 v107, v107, v9, v10 bitop3:0xea
    v_bitop3_b32 v107, v25, v11, v107 bitop3:0xea
    s_nop 0
    v_cvt_pk_bf16_f32 v88, v96, v97
    v_cvt_pk_bf16_f32 v89, v98, v99
    ds_wrxchg_rtn_b64 v[90:91], v104, v[88:89]
    s_waitcnt lgkmcnt(1)
    v_mfma_f32_4x4x4_16b_bf16 v[92:95], v[12:13], v[84:85], 0
    s_waitcnt lgkmcnt(0)
    v_cmpx_ne_u64 vcc, v[90:91], v[86:87]
    s_cbranch_execz L2_c62
    s_nop 2
    v_mfma_f32_4x4x4_16b_bf16 v[100:103], v[14:15], v[86:87], 0
    s_nop 1
    v_mfma_f32_4x4x4_16b_bf16 v[100:103], v[12:13], v[90:91], v[100:103]
    s_nop 4
    v_cvt_pk_bf16_f32 v100, v100, v101
    v_cvt_pk_bf16_f32 v101, v102, v103
    ds_pk_add_bf16 v104, v100
    ds_pk_add_bf16 v104, v101 offset:4
L2_c62:
    s_mov_b64 exec, -1
    ds_read_b64 v[86:87], v105
    v_mul_f32 v92, v107, v92
    v_mul_f32 v93, v107, v93
    v_mul_f32 v94, v107, v94
    v_mul_f32 v95, v107, v95
    v_and_b32 v108, 0x40000000, v38
    v_lshrrev_b32 v106, 14, v26
    v_bitop3_b32 v106, v106, v8, v108 bitop3:0xea
    ds_read_b64 v[84:85], v106 offset:63616
    s_waitcnt lgkmcnt(1)
    v_mfma_f32_4x4x4_16b_bf16 v[96:99], v[12:13], v[86:87], v[92:95]
    v_perm_b32 v107, v26, v34, s46
    v_bitop3_b32 v104, v26, v8, v108 bitop3:0xea
    v_bitop3_b32 v107, v107, v9, v10 bitop3:0xea
    v_bitop3_b32 v107, v26, v11, v107 bitop3:0xea
    s_nop 0
    v_cvt_pk_bf16_f32 v88, v96, v97
    v_cvt_pk_bf16_f32 v89, v98, v99
    ds_wrxchg_rtn_b64 v[90:91], v105, v[88:89]
    s_waitcnt lgkmcnt(1)
    v_mfma_f32_4x4x4_16b_bf16 v[92:95], v[12:13], v[84:85], 0
    s_waitcnt lgkmcnt(0)
    v_cmpx_ne_u64 vcc, v[90:91], v[86:87]
    s_cbranch_execz L2_c63
    s_nop 2
    v_mfma_f32_4x4x4_16b_bf16 v[100:103], v[14:15], v[86:87], 0
    s_nop 1
    v_mfma_f32_4x4x4_16b_bf16 v[100:103], v[12:13], v[90:91], v[100:103]
    s_nop 4
    v_cvt_pk_bf16_f32 v100, v100, v101
    v_cvt_pk_bf16_f32 v101, v102, v103
    ds_pk_add_bf16 v105, v100
    ds_pk_add_bf16 v105, v101 offset:4
L2_c63:
    s_mov_b64 exec, -1
    ds_read_b64 v[86:87], v104
    v_mul_f32 v92, v107, v92
    v_mul_f32 v93, v107, v93
    v_mul_f32 v94, v107, v94
    v_mul_f32 v95, v107, v95
    v_and_b32 v108, 0x80000000, v38
    v_lshrrev_b32 v106, 14, v27
    v_bitop3_b32 v106, v106, v8, v108 bitop3:0xea
    ds_read_b64 v[84:85], v106 offset:63616
    s_waitcnt lgkmcnt(1)
    v_mfma_f32_4x4x4_16b_bf16 v[96:99], v[12:13], v[86:87], v[92:95]
    v_perm_b32 v107, v27, v34, s47
    v_bitop3_b32 v105, v27, v8, v108 bitop3:0xea
    v_bitop3_b32 v107, v107, v9, v10 bitop3:0xea
    v_bitop3_b32 v107, v27, v11, v107 bitop3:0xea
    v_and_b32 v109, 0x0fffffff, v42
    v_mov_b32 v38, v42
    buffer_load_dwordx4 v[24:27], v109, s[8:11], 0 offen
    buffer_load_dword v34, v109, s[8:11], 0 offen offset:16
    v_cvt_pk_bf16_f32 v88, v96, v97
    v_cvt_pk_bf16_f32 v89, v98, v99
    ds_wrxchg_rtn_b64 v[90:91], v104, v[88:89]
    s_waitcnt lgkmcnt(1)
    v_mfma_f32_4x4x4_16b_bf16 v[92:95], v[12:13], v[84:85], 0
    s_waitcnt lgkmcnt(0)
    v_cmpx_ne_u64 vcc, v[90:91], v[86:87]
    s_cbranch_execz L2_c64
    s_nop 2
    v_mfma_f32_4x4x4_16b_bf16 v[100:103], v[14:15], v[86:87], 0
    s_nop 1
    v_mfma_f32_4x4x4_16b_bf16 v[100:103], v[12:13], v[90:91], v[100:103]
    s_nop 4
    v_cvt_pk_bf16_f32 v100, v100, v101
    v_cvt_pk_bf16_f32 v101, v102, v103
    ds_pk_add_bf16 v104, v100
    ds_pk_add_bf16 v104, v101 offset:4
L2_c64:
    s_mov_b64 exec, -1
    ds_read_b64 v[86:87], v105
    v_mul_f32 v92, v107, v92
    v_mul_f32 v93, v107, v93
    v_mul_f32 v94, v107, v94
    v_mul_f32 v95, v107, v95
    s_waitcnt vmcnt(11)
    v_and_b32 v108, 0x10000000, v39
    v_lshrrev_b32 v106, 14, v28
    v_bitop3_b32 v106, v106, v8, v108 bitop3:0xea
    ds_read_b64 v[84:85], v106 offset:63616
    s_waitcnt lgkmcnt(1)
    v_mfma_f32_4x4x4_16b_bf16 v[96:99], v[12:13], v[86:87], v[92:95]
    v_perm_b32 v107, v28, v35, s44
    v_bitop3_b32 v104, v28, v8, v108 bitop3:0xea
    v_bitop3_b32 v107, v107, v9, v10 bitop3:0xea
    v_bitop3_b32 v107, v28, v11, v107 bitop3:0xea
    s_nop 0
    v_cvt_pk_bf16_f32 v88, v96, v97
    v_cvt_pk_bf16_f32 v89, v98, v99
    ds_wrxchg_rtn_b64 v[90:91], v105, v[88:89]
    s_waitcnt lgkmcnt(1)
    v_mfma_f32_4x4x4_16b_bf16 v[92:95], v[12:13], v[84:85], 0
    s_waitcnt lgkmcnt(0)
    v_cmpx_ne_u64 vcc, v[90:91], v[86:87]
    s_cbranch_execz L2_c65
    s_nop 2
    v_mfma_f32_4x4x4_16b_bf16 v[100:103], v[14:15], v[86:87], 0
    s_nop 1
    v_mfma_f32_4x4x4_16b_bf16 v[100:103], v[12:13], v[90:91], v[100:103]
    s_nop 4
    v_cvt_pk_bf16_f32 v100, v100, v101
    v_cvt_pk_bf16_f32 v101, v102, v103
    ds_pk_add_bf16 v105, v100
    ds_pk_add_bf16 v105, v101 offset:4
L2_c65:
    s_mov_b64 exec, -1
    ds_read_b64 v[86:87], v104
    v_mul_f32 v92, v107, v92
    v_mul_f32 v93, v107, v93
    v_mul_f32 v94, v107, v94
    v_mul_f32 v95, v107, v95
    v_and_b32 v108, 0x20000000, v39
    v_lshrrev_b32 v106, 14, v29
    v_bitop3_b32 v106, v106, v8, v108 bitop3:0xea
    ds_read_b64 v[84:85], v106 offset:63616
    s_waitcnt lgkmcnt(1)
    v_mfma_f32_4x4x4_16b_bf16 v[96:99], v[12:13], v[86:87], v[92:95]
    v_perm_b32 v107, v29, v35, s45
    v_bitop3_b32 v105, v29, v8, v108 bitop3:0xea
    v_bitop3_b32 v107, v107, v9, v10 bitop3:0xea
    v_bitop3_b32 v107, v29, v11, v107 bitop3:0xea
    s_nop 0
    v_cvt_pk_bf16_f32 v88, v96, v97
    v_cvt_pk_bf16_f32 v89, v98, v99
    ds_wrxchg_rtn_b64 v[90:91], v104, v[88:89]
    s_waitcnt lgkmcnt(1)
    v_mfma_f32_4x4x4_16b_bf16 v[92:95], v[12:13], v[84:85], 0
    s_waitcnt lgkmcnt(0)
    v_cmpx_ne_u64 vcc, v[90:91], v[86:87]
    s_cbranch_execz L2_c66
    s_nop 2
    v_mfma_f32_4x4x4_16b_bf16 v[100:103], v[14:15], v[86:87], 0
    s_nop 1
    v_mfma_f32_4x4x4_16b_bf16 v[100:103], v[12:13], v[90:91], v[100:103]
    s_nop 4
    v_cvt_pk_bf16_f32 v100, v100, v101
    v_cvt_pk_bf16_f32 v101, v102, v103
    ds_pk_add_bf16 v104, v100
    ds_pk_add_bf16 v104, v101 offset:4
L2_c66:
    s_mov_b64 exec, -1
    ds_read_b64 v[86:87], v105
    v_mul_f32 v92, v107, v92
    v_mul_f32 v93, v107, v93
    v_mul_f32 v94, v107, v94
    v_mul_f32 v95, v107, v95
    v_and_b32 v108, 0x40000000, v39
    v_lshrrev_b32 v106, 14, v30
    v_bitop3_b32 v106, v106, v8, v108 bitop3:0xea
    ds_read_b64 v[84:85], v106 offset:63616
    s_waitcnt lgkmcnt(1)
    v_mfma_f32_4x4x4_16b_bf16 v[96:99], v[12:13], v[86:87], v[92:95]
    v_perm_b32 v107, v30, v35, s46
    v_bitop3_b32 v104, v30, v8, v108 bitop3:0xea
    v_bitop3_b32 v107, v107, v9, v10 bitop3:0xea
    v_bitop3_b32 v107, v30, v11, v107 bitop3:0xea
    s_nop 0
    v_cvt_pk_bf16_f32 v88, v96, v97
    v_cvt_pk_bf16_f32 v89, v98, v99
    ds_wrxchg_rtn_b64 v[90:91], v105, v[88:89]
    s_waitcnt lgkmcnt(1)
    v_mfma_f32_4x4x4_16b_bf16 v[92:95], v[12:13], v[84:85], 0
    s_waitcnt lgkmcnt(0)
    v_cmpx_ne_u64 vcc, v[90:91], v[86:87]
    s_cbranch_execz L2_c67
    s_nop 2
    v_mfma_f32_4x4x4_16b_bf16 v[100:103], v[14:15], v[86:87], 0
    s_nop 1
    v_mfma_f32_4x4x4_16b_bf16 v[100:103], v[12:13], v[90:91], v[100:103]
    s_nop 4
    v_cvt_pk_bf16_f32 v100, v100, v101
    v_cvt_pk_bf16_f32 v101, v102, v103
    ds_pk_add_bf16 v105, v100
    ds_pk_add_bf16 v105, v101 offset:4
L2_c67:
    s_mov_b64 exec, -1
    ds_read_b64 v[86:87], v104
    v_mul_f32 v92, v107, v92
    v_mul_f32 v93, v107, v93
    v_mul_f32 v94, v107, v94
    v_mul_f32 v95, v107, v95
    v_and_b32 v108, 0x80000000, v39
    v_lshrrev_b32 v106, 14, v31
    v_bitop3_b32 v106, v106, v8, v108 bitop3:0xea
    ds_read_b64 v[84:85], v106 offset:63616
    s_waitcnt lgkmcnt(1)
    v_mfma_f32_4x4x4_16b_bf16 v[96:99], v[12:13], v[86:87], v[92:95]
    v_perm_b32 v107, v31, v35, s47
    v_bitop3_b32 v105, v31, v8, v108 bitop3:0xea
    v_bitop3_b32 v107, v107, v9, v10 bitop3:0xea
    v_bitop3_b32 v107, v31, v11, v107 bitop3:0xea
    v_and_b32 v109, 0x0fffffff, v43
    v_mov_b32 v39, v43
    buffer_load_dwordx4 v[28:31], v109, s[8:11], 0 offen
    buffer_load_dword v35, v109, s[8:11], 0 offen offset:16
    v_cvt_pk_bf16_f32 v88, v96, v97
    v_cvt_pk_bf16_f32 v89, v98, v99
    ds_wrxchg_rtn_b64 v[90:91], v104, v[88:89]
    s_waitcnt lgkmcnt(1)
    v_mfma_f32_4x4x4_16b_bf16 v[92:95], v[12:13], v[84:85], 0
    s_waitcnt lgkmcnt(0)
    v_cmpx_ne_u64 vcc, v[90:91], v[86:87]
    s_cbranch_execz L2_c68
    s_nop 2
    v_mfma_f32_4x4x4_16b_bf16 v[100:103], v[14:15], v[86:87], 0
    s_nop 1
    v_mfma_f32_4x4x4_16b_bf16 v[100:103], v[12:13], v[90:91], v[100:103]
    s_nop 4
    v_cvt_pk_bf16_f32 v100, v100, v101
    v_cvt_pk_bf16_f32 v101, v102, v103
    ds_pk_add_bf16 v104, v100
    ds_pk_add_bf16 v104, v101 offset:4
L2_c68:
    s_mov_b64 exec, -1
    ds_read_b64 v[86:87], v105
    v_mul_f32 v92, v107, v92
    v_mul_f32 v93, v107, v93
    v_mul_f32 v94, v107, v94
    v_mul_f32 v95, v107, v95
    s_waitcnt lgkmcnt(0)
    s_nop 0
    v_mfma_f32_4x4x4_16b_bf16 v[96:99], v[12:13], v[86:87], v[92:95]
    s_nop 4
    v_cvt_pk_bf16_f32 v88, v96, v97
    v_cvt_pk_bf16_f32 v89, v98, v99
    ds_wrxchg_rtn_b64 v[90:91], v105, v[88:89]
    s_waitcnt lgkmcnt(0)
    v_cmpx_ne_u64 vcc, v[90:91], v[86:87]
    s_cbranch_execz L2_c69
    s_nop 2
    v_mfma_f32_4x4x4_16b_bf16 v[100:103], v[14:15], v[86:87], 0
    s_nop 1
    v_mfma_f32_4x4x4_16b_bf16 v[100:103], v[12:13], v[90:91], v[100:103]
    s_nop 4
    v_cvt_pk_bf16_f32 v100, v100, v101
    v_cvt_pk_bf16_f32 v101, v102, v103
    ds_pk_add_bf16 v105, v100
    ds_pk_add_bf16 v105, v101 offset:4
L2_c69:
    s_mov_b64 exec, -1
    s_bitcmp1_b32 s36, s42
    s_cbranch_scc1 L2_slow
L2_ret3:
    s_cmp_eq_u32 s35, 3
    s_cbranch_scc1 L2_done
    s_add_u32 s35, s35, 1
    s_barrier
    s_waitcnt vmcnt(8)
    s_mov_b32 s37, s38
    s_add_u32 s48, s38, 257
    v_lshrrev_b32 v110, 16, v64
    v_lshrrev_b32 v111, 16, v66
    v_and_b32 v112, -4, v110
    v_add_u32 v112, v112, v2
L2_x70_0:
    v_sub_u32 v113, v111, v112
    v_sub_u32 v115, v110, v112
    v_med3_i32 v114, v113, 0, 4
    v_max_i32 v115, 0, v115
    v_cmp_gt_i32 vcc, v114, v115
    v_mad_u32_u24 v116, v112, 5, v4
    v_bfm_b32 v114, v114, 28
    v_bfm_b32 v115, v115, 28
    v_mbcnt_lo_u32_b32 v117, vcc_lo, 0
    v_mbcnt_hi_u32_b32 v117, vcc_hi, v117
    v_bitop3_b32 v116, v114, v115, v116 bitop3:0x9a
    v_add_lshl_u32 v117, v117, s37, 2
    s_bcnt1_i32_b64 s41, vcc
    s_mov_b64 exec, vcc
    ds_write_b32 v117, v116
    s_mov_b64 exec, -1
    v_cmp_gt_i32 vcc, v113, v3
    s_add_u32 s37, s37, s41
    s_min_u32 s37, s37, s48
    s_cbranch_vccnz L2_xe70_0
L2_xr70_0:
    ds_write_b128 v7, v[52:55] offset:2048
    v_lshrrev_b32 v110, 16, v68
    v_lshrrev_b32 v111, 16, v70
    v_and_b32 v112, -4, v110
    v_add_u32 v112, v112, v2
    v_add_u32 v118, 0x2800000, v4
L2_x70_1:
    v_sub_u32 v113, v111, v112
    v_sub_u32 v115, v110, v112
    v_med3_i32 v114, v113, 0, 4
    v_max_i32 v115, 0, v115
    v_cmp_gt_i32 vcc, v114, v115
    v_mad_u32_u24 v116, v112, 5, v118
    v_bfm_b32 v114, v114, 28
    v_bfm_b32 v115, v115, 28
    v_mbcnt_lo_u32_b32 v117, vcc_lo, 0
    v_mbcnt_hi_u32_b32 v117, vcc_hi, v117
    v_bitop3_b32 v116, v114, v115, v116 bitop3:0x9a
    v_add_lshl_u32 v117, v117, s37, 2
    s_bcnt1_i32_b64 s41, vcc
    s_mov_b64 exec, vcc
    ds_write_b32 v117, v116
    s_mov_b64 exec, -1
    v_cmp_gt_i32 vcc, v113, v3
    s_add_u32 s37, s37, s41
    s_min_u32 s37, s37, s48
    s_cbranch_vccnz L2_xe70_1
L2_xr70_1:
    ds_write_b128 v7, v[56:59] offset:3072
    v_lshrrev_b32 v110, 16, v72
    v_lshrrev_b32 v111, 16, v74
    v_and_b32 v112, -4, v110
    v_add_u32 v112, v112, v2
    v_add_u32 v118, 0x5000000, v4
L2_x70_2:
    v_sub_u32 v113, v111, v112
    v_sub_u32 v115, v110, v112
    v_med3_i32 v114, v113, 0, 4
    v_max_i32 v115, 0, v115
    v_cmp_gt_i32 vcc, v114, v115
    v_mad_u32_u24 v116, v112, 5, v118
    v_bfm_b32 v114, v114, 28
    v_bfm_b32 v115, v115, 28
    v_mbcnt_lo_u32_b32 v117, vcc_lo, 0
    v_mbcnt_hi_u32_b32 v117, vcc_hi, v117
    v_bitop3_b32 v116, v114, v115, v116 bitop3:0x9a
    v_add_lshl_u32 v117, v117, s37, 2
    s_bcnt1_i32_b64 s41, vcc
    s_mov_b64 exec, vcc
    ds_write_b32 v117, v116
    s_mov_b64 exec, -1
    v_cmp_gt_i32 vcc, v113, v3
    s_add_u32 s37, s37, s41
    s_min_u32 s37, s37, s48
    s_cbranch_vccnz L2_xe70_2
L2_xr70_2:
    ds_write_b128 v7, v[60:63] offset:4096
    v_lshrrev_b32 v110, 16, v76
    v_lshrrev_b32 v111, 16, v78
    v_and_b32 v112, -4, v110
    v_add_u32 v112, v112, v2
    v_add_u32 v118, 0x7800000, v4
L2_x70_3:
    v_sub_u32 v113, v111, v112
    v_sub_u32 v115, v110, v112
    v_med3_i32 v114, v113, 0, 4
    v_max_i32 v115, 0, v115
    v_cmp_gt_i32 vcc, v114, v115
    v_mad_u32_u24 v116, v112, 5, v118
    v_bfm_b32 v114, v114, 28
    v_bfm_b32 v115, v115, 28
    v_mbcnt_lo_u32_b32 v117, vcc_lo, 0
    v_mbcnt_hi_u32_b32 v117, vcc_hi, v117
    v_bitop3_b32 v116, v114, v115, v116 bitop3:0x9a
    v_add_lshl_u32 v117, v117, s37, 2
    s_bcnt1_i32_b64 s41, vcc
    s_mov_b64 exec, vcc
    ds_write_b32 v117, v116
    s_mov_b64 exec, -1
    v_cmp_gt_i32 vcc, v113, v3
    s_add_u32 s37, s37, s41
    s_min_u32 s37, s37, s48
    s_cbranch_vccnz L2_xe70_3
L2_xr70_3:
    v_lshrrev_b32 v110, 16, v80
    v_lshrrev_b32 v111, 16, v82
    v_and_b32 v112, -4, v110
    v_add_u32 v112, v112, v2
    v_add_u32 v118, 0xa000000, v4
L2_x70_4:
    v_sub_u32 v113, v111, v112
    v_sub_u32 v115, v110, v112
    v_med3_i32 v114, v113, 0, 4
    v_max_i32 v115, 0, v115
    v_cmp_gt_i32 vcc, v114, v115
    v_mad_u32_u24 v116, v112, 5, v118
    v_bfm_b32 v114, v114, 28
    v_bfm_b32 v115, v115, 28
    v_mbcnt_lo_u32_b32 v117, vcc_lo, 0
    v_mbcnt_hi_u32_b32 v117, vcc_hi, v117
    v_bitop3_b32 v116, v114, v115, v116 bitop3:0x9a
    v_add_lshl_u32 v117, v117, s37, 2
    s_bcnt1_i32_b64 s41, vcc
    s_mov_b64 exec, vcc
    ds_write_b32 v117, v116
    s_mov_b64 exec, -1
    v_cmp_gt_i32 vcc, v113, v3
    s_add_u32 s37, s37, s41
    s_min_u32 s37, s37, s48
    s_cbranch_vccnz L2_xe70_4
L2_xr70_4:
    s_lshl_b32 s3, s37, 2
    v_add_u32 v117, s3, v1
    v_mov_b32 v116, -1
    ds_write_b32 v117, v116
    s_lshl_b32 s3, s38, 2
    v_add_u32 v117, s3, v1
    ds_read2st64_b32 v[40:41], v117 offset0:0 offset1:1
    ds_read2st64_b32 v[42:43], v117 offset0:2 offset1:3
    s_sub_u32 s41, s37, s38
    s_sub_u32 s3, s41, 192
    s_cmp_gt_u32 s3, 64
    s_cbranch_scc1 L2_xf70
L2_xg70:
    ds_write_b128 v7, v[44:47] offset:0
    ds_write_b128 v7, v[48:51] offset:1024
    buffer_load_dwordx4 v[44:47], v6, s[16:19], s40 offen offset:0
    buffer_load_dwordx4 v[48:51], v6, s[16:19], s40 offen offset:1024
    buffer_load_dwordx4 v[52:55], v6, s[16:19], s40 offen offset:2048
    buffer_load_dwordx4 v[56:59], v6, s[16:19], s40 offen offset:3072
    s_add_u32 s3, s40, 4096
    buffer_load_dwordx4 v[60:63], v6, s[16:19], s3 offen
    s_add_u32 s40, s40, 80000
    s_add_u32 s42, s42, 1
    s_waitcnt lgkmcnt(0)
    s_barrier
    s_branch L2_loop
L2_done:
    s_waitcnt lgkmcnt(0)
    s_barrier
    v_add_u32 v114, 0x10000, v0
    s_waitcnt vmcnt(0)
    ds_read_b128 v[44:47], v0 offset:0
    ds_read_b128 v[48:51], v0 offset:16384
    ds_read_b128 v[52:55], v0 offset:32768
    ds_read_b128 v[56:59], v0 offset:49152
    ds_read_b128 v[60:63], v114
    v_add_u32 v111, 16384, v0
    v_add_u32 v112, 32768, v0
    v_add_u32 v113, 49152, v0
    s_waitcnt lgkmcnt(4)
    buffer_store_dwordx4 v[44:47], v0, s[20:23], 0 offen
    s_waitcnt lgkmcnt(3)
    buffer_store_dwordx4 v[48:51], v111, s[20:23], 0 offen
    s_waitcnt lgkmcnt(2)
    buffer_store_dwordx4 v[52:55], v112, s[20:23], 0 offen
    s_waitcnt lgkmcnt(1)
    buffer_store_dwordx4 v[56:59], v113, s[20:23], 0 offen
    s_waitcnt lgkmcnt(0)
    buffer_store_dwordx4 v[60:63], v114, s[20:23], 0 offen
L2_end:
    s_endpgm
L2_slow:
    s_mov_b32 s50, s32
    s_lshr_b32 s3, s42, 2
    s_mul_i32 s53, s3, 520
    s_add_u32 s53, s53, s39
    s_and_b32 s3, s42, 2
    s_lshl_b32 s3, s3, 1
    s_add_u32 s53, s53, s3
    s_and_b32 s54, s42, 1
    s_lshl_b32 s54, s54, 4
L2_sl_seg:
    s_mul_i32 s3, s50, 8320
    s_add_u32 s3, s3, s53
    s_add_u32 s55, s3, 8
    s_buffer_load_dword s51, s[24:27], s3
    s_buffer_load_dword s52, s[24:27], s55
    s_mul_i32 s56, s50, 163840
    s_waitcnt lgkmcnt(0)
    s_lshr_b32 s51, s51, s54
    s_and_b32 s51, s51, 0xffff
    s_lshr_b32 s52, s52, s54
    s_and_b32 s52, s52, 0xffff
L2_sl_rec:
    s_cmp_ge_u32 s51, s52
    s_cbranch_scc1 L2_sl_next
    v_lshrrev_b32 v110, 2, v1
    v_add_u32 v110, s51, v110
    v_and_b32 v111, -4, v110
    v_lshl_add_u32 v112, v110, 2, v111
    v_lshl_add_u32 v113, v111, 2, v110
    v_cmp_gt_u32 vcc, s52, v110
    s_mov_b64 exec, vcc
    buffer_load_dword v114, v112, s[8:11], s56 offen
    buffer_load_ubyte v115, v113, s[8:11], s56 offen offset:16
    s_waitcnt vmcnt(0)
    v_lshrrev_b32 v106, 14, v114
    v_and_b32 v106, v8, v106
    ds_read_b64 v[84:85], v106 offset:63616
    v_perm_b32 v107, v114, v115, s44
    v_and_b32 v104, v8, v114
    v_bitop3_b32 v107, v107, v9, v10 bitop3:0xea
    v_bitop3_b32 v107, v114, v11, v107 bitop3:0xea
    s_waitcnt lgkmcnt(0)
    v_mfma_f32_4x4x4_16b_bf16 v[92:95], v[12:13], v[84:85], 0
    s_nop 4
    v_mul_f32 v92, v107, v92
    v_mul_f32 v93, v107, v93
    v_mul_f32 v94, v107, v94
    v_mul_f32 v95, v107, v95
    v_cvt_pk_bf16_f32 v88, v92, v93
    v_cvt_pk_bf16_f32 v89, v94, v95
    ds_pk_add_bf16 v104, v88
    ds_pk_add_bf16 v104, v89 offset:4
    s_mov_b64 exec, -1
    s_add_u32 s51, s51, 64
    s_branch L2_sl_rec
L2_sl_next:
    s_add_u32 s50, s50, 16
    s_cmp_lt_u32 s50, 1250
    s_cbranch_scc1 L2_sl_seg
    s_waitcnt lgkmcnt(0)
    s_and_b32 s3, s42, 3
    s_cmp_eq_u32 s3, 0
    s_cbranch_scc1 L2_ret0
    s_cmp_eq_u32 s3, 1
    s_cbranch_scc1 L2_ret1
    s_cmp_eq_u32 s3, 2
    s_cbranch_scc1 L2_ret2
    s_branch L2_ret3
L2_xe1_0:
    s_cmp_ge_u32 s37, s48
    s_cbranch_scc1 L2_xr1_0
    v_add_u32 v112, 16, v112
    s_branch L2_x1_0
L2_xe1_1:
    s_cmp_ge_u32 s37, s48
    s_cbranch_scc1 L2_xr1_1
    v_add_u32 v112, 16, v112
    s_branch L2_x1_1
L2_xe1_2:
    s_cmp_ge_u32 s37, s48
    s_cbranch_scc1 L2_xr1_2
    v_add_u32 v112, 16, v112
    s_branch L2_x1_2
L2_xe1_3:
    s_cmp_ge_u32 s37, s48
    s_cbranch_scc1 L2_xr1_3
    v_add_u32 v112, 16, v112
    s_branch L2_x1_3
L2_xe1_4:
    s_cmp_ge_u32 s37, s48
    s_cbranch_scc1 L2_xr1_4
    v_add_u32 v112, 16, v112
    s_branch L2_x1_4
L2_xf1:
    s_cmp_le_u32 s41, 256
    s_cbranch_scc1 L2_xh1
    s_add_u32 s3, s42, 0
    s_bitset1_b32 s36, s3
    s_mov_b32 s41, 0
L2_xh1:
    s_lshl_b32 s41, s41, 2
    s_waitcnt lgkmcnt(0)
    v_add_u32 v117, 0, v1
    v_cmp_gt_u32 vcc, s41, v117
    s_nop 1
    v_cndmask_b32 v40, -1, v40, vcc
    v_add_u32 v117, 256, v1
    v_cmp_gt_u32 vcc, s41, v117
    s_nop 1
    v_cndmask_b32 v41, -1, v41, vcc
    v_add_u32 v117, 512, v1
    v_cmp_gt_u32 vcc, s41, v117
    s_nop 1
    v_cndmask_b32 v42, -1, v42, vcc
    v_add_u32 v117, 768, v1
    v_cmp_gt_u32 vcc, s41, v117
    s_nop 1
    v_cndmask_b32 v43, -1, v43, vcc
    s_branch L2_xg1
L2_xe2_0:
    s_cmp_ge_u32 s37, s48
    s_cbranch_scc1 L2_xr2_0
    v_add_u32 v112, 16, v112
    s_branch L2_x2_0
L2_xe2_1:
    s_cmp_ge_u32 s37, s48
    s_cbranch_scc1 L2_xr2_1
    v_add_u32 v112, 16, v112
    s_branch L2_x2_1
L2_xe2_2:
    s_cmp_ge_u32 s37, s48
    s_cbranch_scc1 L2_xr2_2
    v_add_u32 v112, 16, v112
    s_branch L2_x2_2
L2_xe2_3:
    s_cmp_ge_u32 s37, s48
    s_cbranch_scc1 L2_xr2_3
    v_add_u32 v112, 16, v112
    s_branch L2_x2_3
L2_xe2_4:
    s_cmp_ge_u32 s37, s48
    s_cbranch_scc1 L2_xr2_4
    v_add_u32 v112, 16, v112
    s_branch L2_x2_4
L2_xf2:
    s_cmp_le_u32 s41, 256
    s_cbranch_scc1 L2_xh2
    s_add_u32 s3, s42, 1
    s_bitset1_b32 s36, s3
    s_mov_b32 s41, 0
L2_xh2:
    s_lshl_b32 s41, s41, 2
    s_waitcnt lgkmcnt(0)
    v_add_u32 v117, 0, v1
    v_cmp_gt_u32 vcc, s41, v117
    s_nop 1
    v_cndmask_b32 v40, -1, v40, vcc
    v_add_u32 v117, 256, v1
    v_cmp_gt_u32 vcc, s41, v117
    s_nop 1
    v_cndmask_b32 v41, -1, v41, vcc
    v_add_u32 v117, 512, v1
    v_cmp_gt_u32 vcc, s41, v117
    s_nop 1
    v_cndmask_b32 v42, -1, v42, vcc
    v_add_u32 v117, 768, v1
    v_cmp_gt_u32 vcc, s41, v117
    s_nop 1
    v_cndmask_b32 v43, -1, v43, vcc
    s_branch L2_xg2
L2_xe19_0:
    s_cmp_ge_u32 s37, s48
    s_cbranch_scc1 L2_xr19_0
    v_add_u32 v112, 16, v112
    s_branch L2_x19_0
L2_xe19_1:
    s_cmp_ge_u32 s37, s48
    s_cbranch_scc1 L2_xr19_1
    v_add_u32 v112, 16, v112
    s_branch L2_x19_1
L2_xe19_2:
    s_cmp_ge_u32 s37, s48
    s_cbranch_scc1 L2_xr19_2
    v_add_u32 v112, 16, v112
    s_branch L2_x19_2
L2_xe19_3:
    s_cmp_ge_u32 s37, s48
    s_cbranch_scc1 L2_xr19_3
    v_add_u32 v112, 16, v112
    s_branch L2_x19_3
L2_xe19_4:
    s_cmp_ge_u32 s37, s48
    s_cbranch_scc1 L2_xr19_4
    v_add_u32 v112, 16, v112
    s_branch L2_x19_4
L2_xf19:
    s_cmp_le_u32 s41, 256
    s_cbranch_scc1 L2_xh19
    s_add_u32 s3, s42, 2
    s_bitset1_b32 s36, s3
    s_mov_b32 s41, 0
L2_xh19:
    s_lshl_b32 s41, s41, 2
    s_waitcnt lgkmcnt(0)
    v_add_u32 v117, 0, v1
    v_cmp_gt_u32 vcc, s41, v117
    s_nop 1
    v_cndmask_b32 v40, -1, v40, vcc
    v_add_u32 v117, 256, v1
    v_cmp_gt_u32 vcc, s41, v117
    s_nop 1
    v_cndmask_b32 v41, -1, v41, vcc
    v_add_u32 v117, 512, v1
    v_cmp_gt_u32 vcc, s41, v117
    s_nop 1
    v_cndmask_b32 v42, -1, v42, vcc
    v_add_u32 v117, 768, v1
    v_cmp_gt_u32 vcc, s41, v117
    s_nop 1
    v_cndmask_b32 v43, -1, v43, vcc
    s_branch L2_xg19
L2_xe36_0:
    s_cmp_ge_u32 s37, s48
    s_cbranch_scc1 L2_xr36_0
    v_add_u32 v112, 16, v112
    s_branch L2_x36_0
L2_xe36_1:
    s_cmp_ge_u32 s37, s48
    s_cbranch_scc1 L2_xr36_1
    v_add_u32 v112, 16, v112
    s_branch L2_x36_1
L2_xe36_2:
    s_cmp_ge_u32 s37, s48
    s_cbranch_scc1 L2_xr36_2
    v_add_u32 v112, 16, v112
    s_branch L2_x36_2
L2_xe36_3:
    s_cmp_ge_u32 s37, s48
    s_cbranch_scc1 L2_xr36_3
    v_add_u32 v112, 16, v112
    s_branch L2_x36_3
L2_xe36_4:
    s_cmp_ge_u32 s37, s48
    s_cbranch_scc1 L2_xr36_4
    v_add_u32 v112, 16, v112
    s_branch L2_x36_4
L2_xf36:
    s_cmp_le_u32 s41, 256
    s_cbranch_scc1 L2_xh36
    s_add_u32 s3, s42, 2
    s_bitset1_b32 s36, s3
    s_mov_b32 s41, 0
L2_xh36:
    s_lshl_b32 s41, s41, 2
    s_waitcnt lgkmcnt(0)
    v_add_u32 v117, 0, v1
    v_cmp_gt_u32 vcc, s41, v117
    s_nop 1
    v_cndmask_b32 v40, -1, v40, vcc
    v_add_u32 v117, 256, v1
    v_cmp_gt_u32 vcc, s41, v117
    s_nop 1
    v_cndmask_b32 v41, -1, v41, vcc
    v_add_u32 v117, 512, v1
    v_cmp_gt_u32 vcc, s41, v117
    s_nop 1
    v_cndmask_b32 v42, -1, v42, vcc
    v_add_u32 v117, 768, v1
    v_cmp_gt_u32 vcc, s41, v117
    s_nop 1
    v_cndmask_b32 v43, -1, v43, vcc
    s_branch L2_xg36
L2_xe53_0:
    s_cmp_ge_u32 s37, s48
    s_cbranch_scc1 L2_xr53_0
    v_add_u32 v112, 16, v112
    s_branch L2_x53_0
L2_xe53_1:
    s_cmp_ge_u32 s37, s48
    s_cbranch_scc1 L2_xr53_1
    v_add_u32 v112, 16, v112
    s_branch L2_x53_1
L2_xe53_2:
    s_cmp_ge_u32 s37, s48
    s_cbranch_scc1 L2_xr53_2
    v_add_u32 v112, 16, v112
    s_branch L2_x53_2
L2_xe53_3:
    s_cmp_ge_u32 s37, s48
    s_cbranch_scc1 L2_xr53_3
    v_add_u32 v112, 16, v112
    s_branch L2_x53_3
L2_xe53_4:
    s_cmp_ge_u32 s37, s48
    s_cbranch_scc1 L2_xr53_4
    v_add_u32 v112, 16, v112
    s_branch L2_x53_4
L2_xf53:
    s_cmp_le_u32 s41, 256
    s_cbranch_scc1 L2_xh53
    s_add_u32 s3, s42, 2
    s_bitset1_b32 s36, s3
    s_mov_b32 s41, 0
L2_xh53:
    s_lshl_b32 s41, s41, 2
    s_waitcnt lgkmcnt(0)
    v_add_u32 v117, 0, v1
    v_cmp_gt_u32 vcc, s41, v117
    s_nop 1
    v_cndmask_b32 v40, -1, v40, vcc
    v_add_u32 v117, 256, v1
    v_cmp_gt_u32 vcc, s41, v117
    s_nop 1
    v_cndmask_b32 v41, -1, v41, vcc
    v_add_u32 v117, 512, v1
    v_cmp_gt_u32 vcc, s41, v117
    s_nop 1
    v_cndmask_b32 v42, -1, v42, vcc
    v_add_u32 v117, 768, v1
    v_cmp_gt_u32 vcc, s41, v117
    s_nop 1
    v_cndmask_b32 v43, -1, v43, vcc
    s_branch L2_xg53
L2_xe70_0:
    s_cmp_ge_u32 s37, s48
    s_cbranch_scc1 L2_xr70_0
    v_add_u32 v112, 16, v112
    s_branch L2_x70_0
L2_xe70_1:
    s_cmp_ge_u32 s37, s48
    s_cbranch_scc1 L2_xr70_1
    v_add_u32 v112, 16, v112
    s_branch L2_x70_1
L2_xe70_2:
    s_cmp_ge_u32 s37, s48
    s_cbranch_scc1 L2_xr70_2
    v_add_u32 v112, 16, v112
    s_branch L2_x70_2
L2_xe70_3:
    s_cmp_ge_u32 s37, s48
    s_cbranch_scc1 L2_xr70_3
    v_add_u32 v112, 16, v112
    s_branch L2_x70_3
L2_xe70_4:
    s_cmp_ge_u32 s37, s48
    s_cbranch_scc1 L2_xr70_4
    v_add_u32 v112, 16, v112
    s_branch L2_x70_4
L2_xf70:
    s_cmp_le_u32 s41, 256
    s_cbranch_scc1 L2_xh70
    s_add_u32 s3, s42, 2
    s_bitset1_b32 s36, s3
    s_mov_b32 s41, 0
L2_xh70:
    s_lshl_b32 s41, s41, 2
    s_waitcnt lgkmcnt(0)
    v_add_u32 v117, 0, v1
    v_cmp_gt_u32 vcc, s41, v117
    s_nop 1
    v_cndmask_b32 v40, -1, v40, vcc
    v_add_u32 v117, 256, v1
    v_cmp_gt_u32 vcc, s41, v117
    s_nop 1
    v_cndmask_b32 v41, -1, v41, vcc
    v_add_u32 v117, 512, v1
    v_cmp_gt_u32 vcc, s41, v117
    s_nop 1
    v_cndmask_b32 v42, -1, v42, vcc
    v_add_u32 v117, 768, v1
    v_cmp_gt_u32 vcc, s41, v117
    s_nop 1
    v_cndmask_b32 v43, -1, v43, vcc
    s_branch L2_xg70
.text
.globl gs_final_kernel
.p2align 8
.type gs_final_kernel,@function
gs_final_kernel:
    s_cmp_ge_u32 s2, 1250
    s_cbranch_scc1 L3_end
    s_load_dwordx2 s[4:5], s[0:1], 0
    s_load_dwordx2 s[6:7], s[0:1], 24
    s_load_dwordx2 s[28:29], s[0:1], 40
    s_load_dwordx2 s[30:31], s[0:1], 88
    s_load_dwordx2 s[32:33], s[0:1], 104
    s_lshl_b32 s3, s2, 8
    v_add_u32 v1, s3, v0
    v_lshlrev_b32 v2, 4, v1
    v_lshlrev_b32 v3, 2, v1
    v_bfe_u32 v4, v1, 3, 6
    s_mov_b32 s3, 80000
    v_mul_lo_u32 v4, v4, s3
    v_lshrrev_b32 v5, 9, v1
    v_lshl_add_u32 v4, v5, 7, v4
    v_and_b32 v5, 7, v1
    v_lshl_add_u32 v4, v5, 4, v4
    v_and_b32 v5, 3, v0
    v_lshlrev_b32 v5, 6, v5
    s_waitcnt lgkmcnt(0)
    s_load_dwordx4 s[36:39], s[28:29], 0
    s_mov_b32 s8, s4
    s_mov_b32 s9, s5
    s_mov_b32 s10, 0x4e2000
    s_mov_b32 s11, 0x20000
    s_mov_b32 s12, s6
    s_mov_b32 s13, s7
    s_mov_b32 s14, 0x138800
    s_mov_b32 s15, 0x20000
    s_mov_b32 s16, s30
    s_mov_b32 s17, s31
    s_mov_b32 s18, 0x4e2000
    s_mov_b32 s19, 0x20000
    s_add_u32 s20, s32, 0xd21e100
    s_addc_u32 s21, s33, 0
    s_mov_b32 s22, 0x1388000
    s_mov_b32 s23, 0x20000
    s_add_u32 s24, s32, 0xe5a6100
    s_addc_u32 s25, s33, 0
    s_mov_b32 s26, 0x100
    s_mov_b32 s27, 0x20000
    buffer_load_dword v6, v3, s[12:15], 0 offen
    buffer_load_dwordx4 v[8:11], v5, s[24:27], 0 offen
    buffer_load_dwordx4 v[12:15], v5, s[24:27], 0 offen offset:16
    buffer_load_dwordx2 v[16:17], v5, s[24:27], 0 offen offset:32
    s_mov_b32 s40, 0
    buffer_load_dwordx4 v[20:23], v4, s[20:23], s40 offen
    s_mov_b32 s41, 5120000
    buffer_load_dwordx4 v[24:27], v4, s[20:23], s41 offen
    s_mov_b32 s42, 10240000
    buffer_load_dwordx4 v[28:31], v4, s[20:23], s42 offen
    s_mov_b32 s43, 15360000
    buffer_load_dwordx4 v[32:35], v4, s[20:23], s43 offen
    buffer_load_dwordx4 v[36:39], v2, s[8:11], 0 offen
    v_and_b32 v7, 3, v0
    v_lshlrev_b32 v7, 4, v7
    v_mov_b32 v18, 0x3f80
    v_mov_b32 v19, 0
    v_lshlrev_b64 v[18:19], v7, v[18:19]
    s_waitcnt lgkmcnt(0)
    s_lshl_b32 s44, s36, 16
    s_and_b32 s45, s36, 0xffff0000
    s_lshl_b32 s46, s37, 16
    s_and_b32 s47, s37, 0xffff0000
    s_lshl_b32 s48, s38, 16
    s_and_b32 s49, s38, 0xffff0000
    s_lshl_b32 s50, s39, 16
    s_and_b32 s51, s39, 0xffff0000
    s_waitcnt vmcnt(8)
    v_lshlrev_b32 v7, 16, v6
    v_subrev_f32 v48, s44, v7
    v_subrev_f32 v49, s45, v7
    v_subrev_f32 v50, s46, v7
    v_subrev_f32 v51, s47, v7
    v_subrev_f32 v52, s48, v7
    v_subrev_f32 v53, s49, v7
    v_subrev_f32 v54, s50, v7
    v_subrev_f32 v55, s51, v7
    v_cvt_pk_bf16_f32 v56, v48, v49
    v_cvt_pk_bf16_f32 v57, v50, v51
    v_cvt_pk_bf16_f32 v58, v52, v53
    v_cvt_pk_bf16_f32 v59, v54, v55
    v_lshlrev_b32 v48, 16, v56
    v_and_b32 v49, 0xffff0000, v56
    v_lshlrev_b32 v50, 16, v57
    v_and_b32 v51, 0xffff0000, v57
    v_lshlrev_b32 v52, 16, v58
    v_and_b32 v53, 0xffff0000, v58
    v_lshlrev_b32 v54, 16, v59
    v_and_b32 v55, 0xffff0000, v59
    v_mul_f32 v48, v48, v48
    v_mul_f32 v49, v49, v49
    v_mul_f32 v50, v50, v50
    v_mul_f32 v51, v51, v51
    v_mul_f32 v52, v52, v52
    v_mul_f32 v53, v53, v53
    v_mul_f32 v54, v54, v54
    v_mul_f32 v55, v55, v55
    v_cvt_pk_bf16_f32 v56, v48, v49
    v_cvt_pk_bf16_f32 v57, v50, v51
    v_cvt_pk_bf16_f32 v58, v52, v53
    v_cvt_pk_bf16_f32 v59, v54, v55
    v_lshlrev_b32 v48, 16, v56
    v_and_b32 v49, 0xffff0000, v56
    v_lshlrev_b32 v50, 16, v57
    v_and_b32 v51, 0xffff0000, v57
    v_lshlrev_b32 v52, 16, v58
    v_and_b32 v53, 0xffff0000, v58
    v_lshlrev_b32 v54, 16, v59
    v_and_b32 v55, 0xffff0000, v59
    v_mul_f32 v48, 0xc1200000, v48
    v_mul_f32 v49, 0xc1200000, v49
    v_mul_f32 v50, 0xc1200000, v50
    v_mul_f32 v51, 0xc1200000, v51
    v_mul_f32 v52, 0xc1200000, v52
    v_mul_f32 v53, 0xc1200000, v53
    v_mul_f32 v54, 0xc1200000, v54
    v_mul_f32 v55, 0xc1200000, v55
    v_cvt_pk_bf16_f32 v56, v48, v49
    v_cvt_pk_bf16_f32 v57, v50, v51
    v_cvt_pk_bf16_f32 v58, v52, v53
    v_cvt_pk_bf16_f32 v59, v54, v55
    v_lshlrev_b32 v48, 16, v56
    v_and_b32 v49, 0xffff0000, v56
    v_lshlrev_b32 v50, 16, v57
    v_and_b32 v51, 0xffff0000, v57
    v_lshlrev_b32 v52, 16, v58
    v_and_b32 v53, 0xffff0000, v58
    v_lshlrev_b32 v54, 16, v59
    v_and_b32 v55, 0xffff0000, v59
    v_mul_f32 v48, 0x3fb8aa3b, v48
    v_mul_f32 v49, 0x3fb8aa3b, v49
    v_mul_f32 v50, 0x3fb8aa3b, v50
    v_mul_f32 v51, 0x3fb8aa3b, v51
    v_mul_f32 v52, 0x3fb8aa3b, v52
    v_mul_f32 v53, 0x3fb8aa3b, v53
    v_mul_f32 v54, 0x3fb8aa3b, v54
    v_mul_f32 v55, 0x3fb8aa3b, v55
    v_exp_f32 v48, v48
    v_exp_f32 v49, v49
    v_exp_f32 v50, v50
    v_exp_f32 v51, v51
    v_exp_f32 v52, v52
    v_exp_f32 v53, v53
    v_exp_f32 v54, v54
    v_exp_f32 v55, v55
    v_cvt_pk_bf16_f32 v40, v48, v49
    v_cvt_pk_bf16_f32 v41, v50, v51
    v_cvt_pk_bf16_f32 v42, v52, v53
    v_cvt_pk_bf16_f32 v43, v54, v55
    v_and_b32 v7, 0xffff0000, v6
    v_subrev_f32 v48, s44, v7
    v_subrev_f32 v49, s45, v7
    v_subrev_f32 v50, s46, v7
    v_subrev_f32 v51, s47, v7
    v_subrev_f32 v52, s48, v7
    v_subrev_f32 v53, s49, v7
    v_subrev_f32 v54, s50, v7
    v_subrev_f32 v55, s51, v7
    v_cvt_pk_bf16_f32 v56, v48, v49
    v_cvt_pk_bf16_f32 v57, v50, v51
    v_cvt_pk_bf16_f32 v58, v52, v53
    v_cvt_pk_bf16_f32 v59, v54, v55
    v_lshlrev_b32 v48, 16, v56
    v_and_b32 v49, 0xffff0000, v56
    v_lshlrev_b32 v50, 16, v57
    v_and_b32 v51, 0xffff0000, v57
    v_lshlrev_b32 v52, 16, v58
    v_and_b32 v53, 0xffff0000, v58
    v_lshlrev_b32 v54, 16, v59
    v_and_b32 v55, 0xffff0000, v59
    v_mul_f32 v48, v48, v48
    v_mul_f32 v49, v49, v49
    v_mul_f32 v50, v50, v50
    v_mul_f32 v51, v51, v51
    v_mul_f32 v52, v52, v52
    v_mul_f32 v53, v53, v53
    v_mul_f32 v54, v54, v54
    v_mul_f32 v55, v55, v55
    v_cvt_pk_bf16_f32 v56, v48, v49
    v_cvt_pk_bf16_f32 v57, v50, v51
    v_cvt_pk_bf16_f32 v58, v52, v53
    v_cvt_pk_bf16_f32 v59, v54, v55
    v_lshlrev_b32 v48, 16, v56
    v_and_b32 v49, 0xffff0000, v56
    v_lshlrev_b32 v50, 16, v57
    v_and_b32 v51, 0xffff0000, v57
    v_lshlrev_b32 v52, 16, v58
    v_and_b32 v53, 0xffff0000, v58
    v_lshlrev_b32 v54, 16, v59
    v_and_b32 v55, 0xffff0000, v59
    v_mul_f32 v48, 0xc1200000, v48
    v_mul_f32 v49, 0xc1200000, v49
    v_mul_f32 v50, 0xc1200000, v50
    v_mul_f32 v51, 0xc1200000, v51
    v_mul_f32 v52, 0xc1200000, v52
    v_mul_f32 v53, 0xc1200000, v53
    v_mul_f32 v54, 0xc1200000, v54
    v_mul_f32 v55, 0xc1200000, v55
    v_cvt_pk_bf16_f32 v56, v48, v49
    v_cvt_pk_bf16_f32 v57, v50, v51
    v_cvt_pk_bf16_f32 v58, v52, v53
    v_cvt_pk_bf16_f32 v59, v54, v55
    v_lshlrev_b32 v48, 16, v56
    v_and_b32 v49, 0xffff0000, v56
    v_lshlrev_b32 v50, 16, v57
    v_and_b32 v51, 0xffff0000, v57
    v_lshlrev_b32 v52, 16, v58
    v_and_b32 v53, 0xffff0000, v58
    v_lshlrev_b32 v54, 16, v59
    v_and_b32 v55, 0xffff0000, v59
    v_mul_f32 v48, 0x3fb8aa3b, v48
    v_mul_f32 v49, 0x3fb8aa3b, v49
    v_mul_f32 v50, 0x3fb8aa3b, v50
    v_mul_f32 v51, 0x3fb8aa3b, v51
    v_mul_f32 v52, 0x3fb8aa3b, v52
    v_mul_f32 v53, 0x3fb8aa3b, v53
    v_mul_f32 v54, 0x3fb8aa3b, v54
    v_mul_f32 v55, 0x3fb8aa3b, v55
    v_exp_f32 v48, v48
    v_exp_f32 v49, v49
    v_exp_f32 v50, v50
    v_exp_f32 v51, v51
    v_exp_f32 v52, v52
    v_exp_f32 v53, v53
    v_exp_f32 v54, v54
    v_exp_f32 v55, v55
    v_cvt_pk_bf16_f32 v44, v48, v49
    v_cvt_pk_bf16_f32 v45, v50, v51
    v_cvt_pk_bf16_f32 v46, v52, v53
    v_cvt_pk_bf16_f32 v47, v54, v55
    s_waitcnt vmcnt(5)
    v_mfma_f32_4x4x4_16b_bf16 v[48:51], v[8:9], v[40:41], 0
    v_mfma_f32_4x4x4_16b_bf16 v[56:59], v[12:13], v[40:41], 0
    v_mfma_f32_4x4x4_16b_bf16 v[52:55], v[8:9], v[44:45], 0
    v_mfma_f32_4x4x4_16b_bf16 v[60:63], v[12:13], v[44:45], 0
    v_mfma_f32_4x4x4_16b_bf16 v[48:51], v[10:11], v[42:43], v[48:51]
    v_mfma_f32_4x4x4_16b_bf16 v[56:59], v[14:15], v[42:43], v[56:59]
    v_mfma_f32_4x4x4_16b_bf16 v[52:55], v[10:11], v[46:47], v[52:55]
    v_mfma_f32_4x4x4_16b_bf16 v[60:63], v[14:15], v[46:47], v[60:63]
    s_waitcnt vmcnt(1)
    v_mfma_f32_4x4x4_16b_bf16 v[64:67], v[18:19], v[20:21], 0
    v_mfma_f32_4x4x4_16b_bf16 v[68:71], v[18:19], v[22:23], 0
    s_nop 0
    v_mfma_f32_4x4x4_16b_bf16 v[64:67], v[18:19], v[24:25], v[64:67]
    v_mfma_f32_4x4x4_16b_bf16 v[68:71], v[18:19], v[26:27], v[68:71]
    s_nop 0
    v_mfma_f32_4x4x4_16b_bf16 v[64:67], v[18:19], v[28:29], v[64:67]
    v_mfma_f32_4x4x4_16b_bf16 v[68:71], v[18:19], v[30:31], v[68:71]
    s_nop 0
    v_mfma_f32_4x4x4_16b_bf16 v[64:67], v[18:19], v[32:33], v[64:67]
    v_mfma_f32_4x4x4_16b_bf16 v[68:71], v[18:19], v[34:35], v[68:71]
    s_nop 3
    v_mul_f32 v64, v64, v48
    v_mul_f32 v65, v65, v49
    v_mul_f32 v66, v66, v50
    v_mul_f32 v67, v67, v51
    v_cvt_pk_bf16_f32 v20, v64, v65
    v_cvt_pk_bf16_f32 v21, v66, v67
    v_mul_f32 v68, v68, v52
    v_mul_f32 v69, v69, v53
    v_mul_f32 v70, v70, v54
    v_mul_f32 v71, v71, v55
    v_cvt_pk_bf16_f32 v22, v68, v69
    v_cvt_pk_bf16_f32 v23, v70, v71
    v_mfma_f32_4x4x4_16b_bf16 v[48:51], v[16:17], v[20:21], 0
    s_nop 0
    v_mfma_f32_4x4x4_16b_bf16 v[52:55], v[16:17], v[22:23], 0
    s_nop 2
    v_mul_f32 v48, v48, v56
    v_mul_f32 v49, v49, v57
    v_mul_f32 v50, v50, v58
    v_mul_f32 v51, v51, v59
    v_mul_f32 v52, v52, v60
    v_mul_f32 v53, v53, v61
    v_mul_f32 v54, v54, v62
    v_mul_f32 v55, v55, v63
    s_waitcnt vmcnt(0)
    v_mfma_f32_4x4x4_16b_bf16 v[64:67], v[18:19], v[36:37], v[48:51]
    v_mfma_f32_4x4x4_16b_bf16 v[68:71], v[18:19], v[38:39], v[52:55]
    s_nop 3
    v_cvt_pk_bf16_f32 v24, v64, v65
    v_cvt_pk_bf16_f32 v25, v66, v67
    v_cvt_pk_bf16_f32 v26, v68, v69
    v_cvt_pk_bf16_f32 v27, v70, v71
    buffer_store_dwordx4 v[24:27], v2, s[16:19], 0 offen
L3_end:
    s_endpgm
.section .rodata,"a"
.p2align 6
.amdhsa_kernel gs_sort_kernel
  .amdhsa_next_free_vgpr 128
  .amdhsa_next_free_sgpr 96
  .amdhsa_accum_offset 128
  .amdhsa_group_segment_fixed_size 0
  .amdhsa_kernarg_size 112
  .amdhsa_user_sgpr_count 2
  .amdhsa_user_sgpr_kernarg_segment_ptr 1
  .amdhsa_system_sgpr_workgroup_id_x 1
  .amdhsa_float_denorm_mode_32 3
.end_amdhsa_kernel
.p2align 6
.amdhsa_kernel gs_acc_kernel
  .amdhsa_next_free_vgpr 128
  .amdhsa_next_free_sgpr 96
  .amdhsa_accum_offset 128
  .amdhsa_group_segment_fixed_size 0
  .amdhsa_kernarg_size 112
  .amdhsa_user_sgpr_count 2
  .amdhsa_user_sgpr_kernarg_segment_ptr 1
  .amdhsa_system_sgpr_workgroup_id_x 1
  .amdhsa_float_denorm_mode_32 3
.end_amdhsa_kernel
.p2align 6
.amdhsa_kernel gs_final_kernel
  .amdhsa_next_free_vgpr 72
  .amdhsa_next_free_sgpr 64
  .amdhsa_accum_offset 72
  .amdhsa_group_segment_fixed_size 0
  .amdhsa_kernarg_size 112
  .amdhsa_user_sgpr_count 2
  .amdhsa_user_sgpr_kernarg_segment_ptr 1
  .amdhsa_system_sgpr_workgroup_id_x 1
  .amdhsa_float_denorm_mode_32 3
.end_amdhsa_kernel
```

```asm
; @launch kernel=gs_sort_kernel grid=(256,1,1) block=(1024,1,1) lds=163840
; @launch kernel=gs_acc_kernel grid=(256,1,1) block=(1024,1,1) lds=163840
; @launch kernel=gs_final_kernel grid=(1250,1,1) block=(256,1,1) lds=0
.amdgcn_target "amdgcn-amd-amdhsa--gfx950"
.text
.globl gs_sort_kernel
.p2align 8
.type gs_sort_kernel,@function
gs_sort_kernel:
    s_cmp_ge_u32 s2, 256
    s_cbranch_scc1 L1_end
    s_load_dwordx4 s[4:7], s[0:1], 8
    s_load_dwordx2 s[28:29], s[0:1], 32
    s_load_dwordx2 s[30:31], s[0:1], 104
    s_cmp_ge_u32 s2, 250
    s_cbranch_scc1 L1_md
    v_lshrrev_b32 v7, 6, v0
    v_lshlrev_b32 v1, 3, v0
    v_readfirstlane_b32 s32, v7
    v_lshlrev_b32 v0, 4, v0
    s_waitcnt lgkmcnt(0)
    s_mov_b32 s8, s4
    s_mov_b32 s9, s5
    s_mov_b32 s10, 0x9c40000
    s_mov_b32 s11, 0x20000
    s_mov_b32 s12, s6
    s_mov_b32 s13, s7
    s_mov_b32 s14, 0x9c40000
    s_mov_b32 s15, 0x20000
    s_mov_b32 s16, s28
    s_mov_b32 s17, s29
    s_mov_b32 s18, 0x4e20000
    s_mov_b32 s19, 0x20000
    s_mov_b32 s20, s30
    s_mov_b32 s21, s31
    s_mov_b32 s22, 0xce4c800
    s_mov_b32 s23, 0x20000
    s_add_u32 s24, s30, 0x28000
    s_addc_u32 s25, s31, 0
    s_mov_b32 s26, 0xce24800
    s_mov_b32 s27, 0x20000
    s_mul_i32 s33, s2, 131072
    s_mul_i32 s34, s2, 65536
    s_mul_i32 s35, s2, 173056
    s_mul_i32 s36, s2, 173056
    s_lshl_b32 s37, s32, 3
    s_add_u32 s36, s36, s37
    s_add_u32 s44, s33, 0x0
    buffer_load_dwordx4 v[16:19], v0, s[8:11], s44 offen nt
    s_add_u32 s45, s33, 0x0
    buffer_load_dwordx4 v[20:23], v0, s[12:15], s45 offen nt
    s_add_u32 s46, s34, 0x0
    buffer_load_dwordx2 v[24:25], v1, s[16:19], s46 offen nt
    s_add_u32 s47, s34, 0x2000
    buffer_load_dwordx2 v[26:27], v1, s[16:19], s47 offen nt
    s_add_u32 s44, s33, 0x4000
    buffer_load_dwordx4 v[28:31], v0, s[8:11], s44 offen nt
    s_add_u32 s45, s33, 0x4000
    buffer_load_dwordx4 v[32:35], v0, s[12:15], s45 offen nt
    s_add_u32 s46, s33, 0x8000
    buffer_load_dwordx4 v[36:39], v0, s[8:11], s46 offen nt
    s_add_u32 s47, s33, 0x8000
    buffer_load_dwordx4 v[40:43], v0, s[12:15], s47 offen nt
    s_add_u32 s44, s34, 0x4000
    buffer_load_dwordx2 v[44:45], v1, s[16:19], s44 offen nt
    s_add_u32 s45, s34, 0x6000
    buffer_load_dwordx2 v[46:47], v1, s[16:19], s45 offen nt
    v_mov_b32 v2, 1
    v_mov_b32 v3, 0x1ffff
    v_mov_b32 v4, 0x80000007
    v_mov_b32 v5, 0xfc
    v_mov_b32 v6, 0x78
    s_mov_b32 s40, 0x10000000
    s_mov_b32 s41, 0x010c0c01
    s_mov_b32 s42, 0x030c0c03
    v_mov_b32 v8, 0
    v_mov_b32 v9, 0
    v_mov_b32 v10, 0
    v_mov_b32 v11, 0
    ds_write_b128 v0, v[8:11]
    s_waitcnt lgkmcnt(0)
    s_barrier
    s_add_u32 s46, s33, 0xc000
    buffer_load_dwordx4 v[48:51], v0, s[8:11], s46 offen nt
    s_add_u32 s47, s33, 0xc000
    buffer_load_dwordx4 v[52:55], v0, s[12:15], s47 offen nt
    s_waitcnt vmcnt(8)
    v_lshlrev_b32 v7, 16, v24
    v_and_b32 v8, 0xffff0000, v24
    v_lshlrev_b32 v9, 16, v25
    v_and_b32 v10, 0xffff0000, v25
    v_mul_f32 v7, 0.15915494, v7
    v_mul_f32 v8, 0.15915494, v8
    v_mul_f32 v9, 0.15915494, v9
    v_mul_f32 v10, 0.15915494, v10
    v_cos_f32 v7, v7
    v_lshl_add_u32 v11, v16, 11, s40
    v_lshrrev_b32 v12, 3, v20
    v_lshlrev_b16 v13, 3, v20
    v_bitop3_b32 v12, v6, v13, v12 bitop3:0xca
    v_bitop3_b32 v16, v3, v12, v11 bitop3:0xca
    v_lshrrev_b32 v11, 3, v11
    v_lshrrev_b32 v13, 2, v20
    v_bitop3_b32 v11, v5, v13, v11 bitop3:0xca
    v_and_b32 v20, 0x3fff, v11
    ds_add_u32 v20, v2
    v_cos_f32 v8, v8
    v_lshl_add_u32 v11, v17, 11, s40
    v_lshrrev_b32 v12, 3, v21
    v_lshlrev_b16 v13, 3, v21
    v_bitop3_b32 v12, v6, v13, v12 bitop3:0xca
    v_bitop3_b32 v17, v3, v12, v11 bitop3:0xca
    v_lshrrev_b32 v11, 3, v11
    v_lshrrev_b32 v13, 2, v21
    v_bitop3_b32 v11, v5, v13, v11 bitop3:0xca
    v_and_b32 v21, 0x3fff, v11
    ds_add_u32 v21, v2
    v_cvt_pk_bf16_f32 v24, v7, v8
    v_perm_b32 v12, v24, v24, s41
    v_bitop3_b32 v16, v4, v12, v16 bitop3:0xca
    v_perm_b32 v13, v24, v24, s42
    v_bitop3_b32 v17, v4, v13, v17 bitop3:0xca
    v_cos_f32 v9, v9
    v_lshl_add_u32 v11, v18, 11, s40
    v_lshrrev_b32 v12, 3, v22
    v_lshlrev_b16 v13, 3, v22
    v_bitop3_b32 v12, v6, v13, v12 bitop3:0xca
    v_bitop3_b32 v18, v3, v12, v11 bitop3:0xca
    v_lshrrev_b32 v11, 3, v11
    v_lshrrev_b32 v13, 2, v22
    v_bitop3_b32 v11, v5, v13, v11 bitop3:0xca
    v_and_b32 v22, 0x3fff, v11
    ds_add_u32 v22, v2
    v_cos_f32 v10, v10
    v_lshl_add_u32 v11, v19, 11, s40
    v_lshrrev_b32 v12, 3, v23
    v_lshlrev_b16 v13, 3, v23
    v_bitop3_b32 v12, v6, v13, v12 bitop3:0xca
    v_bitop3_b32 v19, v3, v12, v11 bitop3:0xca
    v_lshrrev_b32 v11, 3, v11
    v_lshrrev_b32 v13, 2, v23
    v_bitop3_b32 v11, v5, v13, v11 bitop3:0xca
    v_and_b32 v23, 0x3fff, v11
    ds_add_u32 v23, v2
    v_cvt_pk_bf16_f32 v25, v9, v10
    v_perm_b32 v12, v25, v25, s41
    v_bitop3_b32 v18, v4, v12, v18 bitop3:0xca
    v_perm_b32 v13, v25, v25, s42
    v_bitop3_b32 v19, v4, v13, v19 bitop3:0xca
    s_add_u32 s44, s33, 0x10000
    buffer_load_dwordx4 v[56:59], v0, s[8:11], s44 offen nt
    s_add_u32 s45, s33, 0x10000
    buffer_load_dwordx4 v[60:63], v0, s[12:15], s45 offen nt
    s_add_u32 s46, s34, 0x8000
    buffer_load_dwordx2 v[64:65], v1, s[16:19], s46 offen nt
    s_add_u32 s47, s34, 0xa000
    buffer_load_dwordx2 v[66:67], v1, s[16:19], s47 offen nt
    s_waitcnt vmcnt(10)
    v_lshlrev_b32 v7, 16, v26
    v_and_b32 v8, 0xffff0000, v26
    v_lshlrev_b32 v9, 16, v27
    v_and_b32 v10, 0xffff0000, v27
    v_mul_f32 v7, 0.15915494, v7
    v_mul_f32 v8, 0.15915494, v8
    v_mul_f32 v9, 0.15915494, v9
    v_mul_f32 v10, 0.15915494, v10
    v_cos_f32 v7, v7
    v_lshl_add_u32 v11, v28, 11, s40
    v_lshrrev_b32 v12, 3, v32
    v_lshlrev_b16 v13, 3, v32
    v_bitop3_b32 v12, v6, v13, v12 bitop3:0xca
    v_bitop3_b32 v28, v3, v12, v11 bitop3:0xca
    v_lshrrev_b32 v11, 3, v11
    v_lshrrev_b32 v13, 2, v32
    v_bitop3_b32 v11, v5, v13, v11 bitop3:0xca
    v_and_b32 v32, 0x3fff, v11
    ds_add_u32 v32, v2
    v_cos_f32 v8, v8
    v_lshl_add_u32 v11, v29, 11, s40
    v_lshrrev_b32 v12, 3, v33
    v_lshlrev_b16 v13, 3, v33
    v_bitop3_b32 v12, v6, v13, v12 bitop3:0xca
    v_bitop3_b32 v29, v3, v12, v11 bitop3:0xca
    v_lshrrev_b32 v11, 3, v11
    v_lshrrev_b32 v13, 2, v33
    v_bitop3_b32 v11, v5, v13, v11 bitop3:0xca
    v_and_b32 v33, 0x3fff, v11
    ds_add_u32 v33, v2
    v_cvt_pk_bf16_f32 v26, v7, v8
    v_perm_b32 v12, v26, v26, s41
    v_bitop3_b32 v28, v4, v12, v28 bitop3:0xca
    v_perm_b32 v13, v26, v26, s42
    v_bitop3_b32 v29, v4, v13, v29 bitop3:0xca
    v_cos_f32 v9, v9
    v_lshl_add_u32 v11, v30, 11, s40
    v_lshrrev_b32 v12, 3, v34
    v_lshlrev_b16 v13, 3, v34
    v_bitop3_b32 v12, v6, v13, v12 bitop3:0xca
    v_bitop3_b32 v30, v3, v12, v11 bitop3:0xca
    v_lshrrev_b32 v11, 3, v11
    v_lshrrev_b32 v13, 2, v34
    v_bitop3_b32 v11, v5, v13, v11 bitop3:0xca
    v_and_b32 v34, 0x3fff, v11
    ds_add_u32 v34, v2
    v_cos_f32 v10, v10
    v_lshl_add_u32 v11, v31, 11, s40
    v_lshrrev_b32 v12, 3, v35
    v_lshlrev_b16 v13, 3, v35
    v_bitop3_b32 v12, v6, v13, v12 bitop3:0xca
    v_bitop3_b32 v31, v3, v12, v11 bitop3:0xca
    v_lshrrev_b32 v11, 3, v11
    v_lshrrev_b32 v13, 2, v35
    v_bitop3_b32 v11, v5, v13, v11 bitop3:0xca
    v_and_b32 v35, 0x3fff, v11
    ds_add_u32 v35, v2
    v_cvt_pk_bf16_f32 v27, v9, v10
    v_perm_b32 v12, v27, v27, s41
    v_bitop3_b32 v30, v4, v12, v30 bitop3:0xca
    v_perm_b32 v13, v27, v27, s42
    v_bitop3_b32 v31, v4, v13, v31 bitop3:0xca
    s_add_u32 s44, s33, 0x14000
    buffer_load_dwordx4 v[68:71], v0, s[8:11], s44 offen nt
    s_add_u32 s45, s33, 0x14000
    buffer_load_dwordx4 v[72:75], v0, s[12:15], s45 offen nt
    s_waitcnt vmcnt(8)
    v_lshlrev_b32 v7, 16, v44
    v_and_b32 v8, 0xffff0000, v44
    v_lshlrev_b32 v9, 16, v45
    v_and_b32 v10, 0xffff0000, v45
    v_mul_f32 v7, 0.15915494, v7
    v_mul_f32 v8, 0.15915494, v8
    v_mul_f32 v9, 0.15915494, v9
    v_mul_f32 v10, 0.15915494, v10
    v_cos_f32 v7, v7
    v_lshl_add_u32 v11, v36, 11, s40
    v_lshrrev_b32 v12, 3, v40
    v_lshlrev_b16 v13, 3, v40
    v_bitop3_b32 v12, v6, v13, v12 bitop3:0xca
    v_bitop3_b32 v36, v3, v12, v11 bitop3:0xca
    v_lshrrev_b32 v11, 3, v11
    v_lshrrev_b32 v13, 2, v40
    v_bitop3_b32 v11, v5, v13, v11 bitop3:0xca
    v_and_b32 v40, 0x3fff, v11
    ds_add_u32 v40, v2
    v_cos_f32 v8, v8
    v_lshl_add_u32 v11, v37, 11, s40
    v_lshrrev_b32 v12, 3, v41
    v_lshlrev_b16 v13, 3, v41
    v_bitop3_b32 v12, v6, v13, v12 bitop3:0xca
    v_bitop3_b32 v37, v3, v12, v11 bitop3:0xca
    v_lshrrev_b32 v11, 3, v11
    v_lshrrev_b32 v13, 2, v41
    v_bitop3_b32 v11, v5, v13, v11 bitop3:0xca
    v_and_b32 v41, 0x3fff, v11
    ds_add_u32 v41, v2
    v_cvt_pk_bf16_f32 v44, v7, v8
    v_perm_b32 v12, v44, v44, s41
    v_bitop3_b32 v36, v4, v12, v36 bitop3:0xca
    v_perm_b32 v13, v44, v44, s42
    v_bitop3_b32 v37, v4, v13, v37 bitop3:0xca
    v_cos_f32 v9, v9
    v_lshl_add_u32 v11, v38, 11, s40
    v_lshrrev_b32 v12, 3, v42
    v_lshlrev_b16 v13, 3, v42
    v_bitop3_b32 v12, v6, v13, v12 bitop3:0xca
    v_bitop3_b32 v38, v3, v12, v11 bitop3:0xca
    v_lshrrev_b32 v11, 3, v11
    v_lshrrev_b32 v13, 2, v42
    v_bitop3_b32 v11, v5, v13, v11 bitop3:0xca
    v_and_b32 v42, 0x3fff, v11
    ds_add_u32 v42, v2
    v_cos_f32 v10, v10
    v_lshl_add_u32 v11, v39, 11, s40
    v_lshrrev_b32 v12, 3, v43
    v_lshlrev_b16 v13, 3, v43
    v_bitop3_b32 v12, v6, v13, v12 bitop3:0xca
    v_bitop3_b32 v39, v3, v12, v11 bitop3:0xca
    v_lshrrev_b32 v11, 3, v11
    v_lshrrev_b32 v13, 2, v43
    v_bitop3_b32 v11, v5, v13, v11 bitop3:0xca
    v_and_b32 v43, 0x3fff, v11
    ds_add_u32 v43, v2
    v_cvt_pk_bf16_f32 v45, v9, v10
    v_perm_b32 v12, v45, v45, s41
    v_bitop3_b32 v38, v4, v12, v38 bitop3:0xca
    v_perm_b32 v13, v45, v45, s42
    v_bitop3_b32 v39, v4, v13, v39 bitop3:0xca
    s_add_u32 s46, s33, 0x18000
    buffer_load_dwordx4 v[76:79], v0, s[8:11], s46 offen nt
    s_add_u32 s47, s33, 0x18000
    buffer_load_dwordx4 v[80:83], v0, s[12:15], s47 offen nt
    s_add_u32 s44, s34, 0xc000
    buffer_load_dwordx2 v[84:85], v1, s[16:19], s44 offen nt
    s_add_u32 s45, s34, 0xe000
    buffer_load_dwordx2 v[86:87], v1, s[16:19], s45 offen nt
    s_waitcnt vmcnt(10)
    v_lshlrev_b32 v7, 16, v46
    v_and_b32 v8, 0xffff0000, v46
    v_lshlrev_b32 v9, 16, v47
    v_and_b32 v10, 0xffff0000, v47
    v_mul_f32 v7, 0.15915494, v7
    v_mul_f32 v8, 0.15915494, v8
    v_mul_f32 v9, 0.15915494, v9
    v_mul_f32 v10, 0.15915494, v10
    v_cos_f32 v7, v7
    v_lshl_add_u32 v11, v48, 11, s40
    v_lshrrev_b32 v12, 3, v52
    v_lshlrev_b16 v13, 3, v52
    v_bitop3_b32 v12, v6, v13, v12 bitop3:0xca
    v_bitop3_b32 v48, v3, v12, v11 bitop3:0xca
    v_lshrrev_b32 v11, 3, v11
    v_lshrrev_b32 v13, 2, v52
    v_bitop3_b32 v11, v5, v13, v11 bitop3:0xca
    v_and_b32 v52, 0x3fff, v11
    ds_add_u32 v52, v2
    v_cos_f32 v8, v8
    v_lshl_add_u32 v11, v49, 11, s40
    v_lshrrev_b32 v12, 3, v53
    v_lshlrev_b16 v13, 3, v53
    v_bitop3_b32 v12, v6, v13, v12 bitop3:0xca
    v_bitop3_b32 v49, v3, v12, v11 bitop3:0xca
    v_lshrrev_b32 v11, 3, v11
    v_lshrrev_b32 v13, 2, v53
    v_bitop3_b32 v11, v5, v13, v11 bitop3:0xca
    v_and_b32 v53, 0x3fff, v11
    ds_add_u32 v53, v2
    v_cvt_pk_bf16_f32 v46, v7, v8
    v_perm_b32 v12, v46, v46, s41
    v_bitop3_b32 v48, v4, v12, v48 bitop3:0xca
    v_perm_b32 v13, v46, v46, s42
    v_bitop3_b32 v49, v4, v13, v49 bitop3:0xca
    v_cos_f32 v9, v9
    v_lshl_add_u32 v11, v50, 11, s40
    v_lshrrev_b32 v12, 3, v54
    v_lshlrev_b16 v13, 3, v54
    v_bitop3_b32 v12, v6, v13, v12 bitop3:0xca
    v_bitop3_b32 v50, v3, v12, v11 bitop3:0xca
    v_lshrrev_b32 v11, 3, v11
    v_lshrrev_b32 v13, 2, v54
    v_bitop3_b32 v11, v5, v13, v11 bitop3:0xca
    v_and_b32 v54, 0x3fff, v11
    ds_add_u32 v54, v2
    v_cos_f32 v10, v10
    v_lshl_add_u32 v11, v51, 11, s40
    v_lshrrev_b32 v12, 3, v55
    v_lshlrev_b16 v13, 3, v55
    v_bitop3_b32 v12, v6, v13, v12 bitop3:0xca
    v_bitop3_b32 v51, v3, v12, v11 bitop3:0xca
    v_lshrrev_b32 v11, 3, v11
    v_lshrrev_b32 v13, 2, v55
    v_bitop3_b32 v11, v5, v13, v11 bitop3:0xca
    v_and_b32 v55, 0x3fff, v11
    ds_add_u32 v55, v2
    v_cvt_pk_bf16_f32 v47, v9, v10
    v_perm_b32 v12, v47, v47, s41
    v_bitop3_b32 v50, v4, v12, v50 bitop3:0xca
    v_perm_b32 v13, v47, v47, s42
    v_bitop3_b32 v51, v4, v13, v51 bitop3:0xca
    s_add_u32 s46, s33, 0x1c000
    buffer_load_dwordx4 v[88:91], v0, s[8:11], s46 offen nt
    s_add_u32 s47, s33, 0x1c000
    buffer_load_dwordx4 v[92:95], v0, s[12:15], s47 offen nt
    s_waitcnt vmcnt(8)
    v_lshlrev_b32 v7, 16, v64
    v_and_b32 v8, 0xffff0000, v64
    v_lshlrev_b32 v9, 16, v65
    v_and_b32 v10, 0xffff0000, v65
    v_mul_f32 v7, 0.15915494, v7
    v_mul_f32 v8, 0.15915494, v8
    v_mul_f32 v9, 0.15915494, v9
    v_mul_f32 v10, 0.15915494, v10
    v_cos_f32 v7, v7
    v_lshl_add_u32 v11, v56, 11, s40
    v_lshrrev_b32 v12, 3, v60
    v_lshlrev_b16 v13, 3, v60
    v_bitop3_b32 v12, v6, v13, v12 bitop3:0xca
    v_bitop3_b32 v56, v3, v12, v11 bitop3:0xca
    v_lshrrev_b32 v11, 3, v11
    v_lshrrev_b32 v13, 2, v60
    v_bitop3_b32 v11, v5, v13, v11 bitop3:0xca
    v_and_b32 v60, 0x3fff, v11
    ds_add_u32 v60, v2
    v_cos_f32 v8, v8
    v_lshl_add_u32 v11, v57, 11, s40
    v_lshrrev_b32 v12, 3, v61
    v_lshlrev_b16 v13, 3, v61
    v_bitop3_b32 v12, v6, v13, v12 bitop3:0xca
    v_bitop3_b32 v57, v3, v12, v11 bitop3:0xca
    v_lshrrev_b32 v11, 3, v11
    v_lshrrev_b32 v13, 2, v61
    v_bitop3_b32 v11, v5, v13, v11 bitop3:0xca
    v_and_b32 v61, 0x3fff, v11
    ds_add_u32 v61, v2
    v_cvt_pk_bf16_f32 v64, v7, v8
    v_perm_b32 v12, v64, v64, s41
    v_bitop3_b32 v56, v4, v12, v56 bitop3:0xca
    v_perm_b32 v13, v64, v64, s42
    v_bitop3_b32 v57, v4, v13, v57 bitop3:0xca
    v_cos_f32 v9, v9
    v_lshl_add_u32 v11, v58, 11, s40
    v_lshrrev_b32 v12, 3, v62
    v_lshlrev_b16 v13, 3, v62
    v_bitop3_b32 v12, v6, v13, v12 bitop3:0xca
    v_bitop3_b32 v58, v3, v12, v11 bitop3:0xca
    v_lshrrev_b32 v11, 3, v11
    v_lshrrev_b32 v13, 2, v62
    v_bitop3_b32 v11, v5, v13, v11 bitop3:0xca
    v_and_b32 v62, 0x3fff, v11
    ds_add_u32 v62, v2
    v_cos_f32 v10, v10
    v_lshl_add_u32 v11, v59, 11, s40
    v_lshrrev_b32 v12, 3, v63
    v_lshlrev_b16 v13, 3, v63
    v_bitop3_b32 v12, v6, v13, v12 bitop3:0xca
    v_bitop3_b32 v59, v3, v12, v11 bitop3:0xca
    v_lshrrev_b32 v11, 3, v11
    v_lshrrev_b32 v13, 2, v63
    v_bitop3_b32 v11, v5, v13, v11 bitop3:0xca
    v_and_b32 v63, 0x3fff, v11
    ds_add_u32 v63, v2
    v_cvt_pk_bf16_f32 v65, v9, v10
    v_perm_b32 v12, v65, v65, s41
    v_bitop3_b32 v58, v4, v12, v58 bitop3:0xca
    v_perm_b32 v13, v65, v65, s42
    v_bitop3_b32 v59, v4, v13, v59 bitop3:0xca
    s_add_u32 s44, s33, 0x1f40000
    buffer_load_dwordx4 v[96:99], v0, s[8:11], s44 offen nt
    s_add_u32 s45, s33, 0x1f40000
    buffer_load_dwordx4 v[100:103], v0, s[12:15], s45 offen nt
    s_add_u32 s46, s34, 0xfa0000
    buffer_load_dwordx2 v[104:105], v1, s[16:19], s46 offen nt
    s_add_u32 s47, s34, 0xfa2000
    buffer_load_dwordx2 v[106:107], v1, s[16:19], s47 offen nt
    s_waitcnt vmcnt(10)
    v_lshlrev_b32 v7, 16, v66
    v_and_b32 v8, 0xffff0000, v66
    v_lshlrev_b32 v9, 16, v67
    v_and_b32 v10, 0xffff0000, v67
    v_mul_f32 v7, 0.15915494, v7
    v_mul_f32 v8, 0.15915494, v8
    v_mul_f32 v9, 0.15915494, v9
    v_mul_f32 v10, 0.15915494, v10
    v_cos_f32 v7, v7
    v_lshl_add_u32 v11, v68, 11, s40
    v_lshrrev_b32 v12, 3, v72
    v_lshlrev_b16 v13, 3, v72
    v_bitop3_b32 v12, v6, v13, v12 bitop3:0xca
    v_bitop3_b32 v68, v3, v12, v11 bitop3:0xca
    v_lshrrev_b32 v11, 3, v11
    v_lshrrev_b32 v13, 2, v72
    v_bitop3_b32 v11, v5, v13, v11 bitop3:0xca
    v_and_b32 v72, 0x3fff, v11
    ds_add_u32 v72, v2
    v_cos_f32 v8, v8
    v_lshl_add_u32 v11, v69, 11, s40
    v_lshrrev_b32 v12, 3, v73
    v_lshlrev_b16 v13, 3, v73
    v_bitop3_b32 v12, v6, v13, v12 bitop3:0xca
    v_bitop3_b32 v69, v3, v12, v11 bitop3:0xca
    v_lshrrev_b32 v11, 3, v11
    v_lshrrev_b32 v13, 2, v73
    v_bitop3_b32 v11, v5, v13, v11 bitop3:0xca
    v_and_b32 v73, 0x3fff, v11
    ds_add_u32 v73, v2
    v_cvt_pk_bf16_f32 v66, v7, v8
    v_perm_b32 v12, v66, v66, s41
    v_bitop3_b32 v68, v4, v12, v68 bitop3:0xca
    v_perm_b32 v13, v66, v66, s42
    v_bitop3_b32 v69, v4, v13, v69 bitop3:0xca
    v_cos_f32 v9, v9
    v_lshl_add_u32 v11, v70, 11, s40
    v_lshrrev_b32 v12, 3, v74
    v_lshlrev_b16 v13, 3, v74
    v_bitop3_b32 v12, v6, v13, v12 bitop3:0xca
    v_bitop3_b32 v70, v3, v12, v11 bitop3:0xca
    v_lshrrev_b32 v11, 3, v11
    v_lshrrev_b32 v13, 2, v74
    v_bitop3_b32 v11, v5, v13, v11 bitop3:0xca
    v_and_b32 v74, 0x3fff, v11
    ds_add_u32 v74, v2
    v_cos_f32 v10, v10
    v_lshl_add_u32 v11, v71, 11, s40
    v_lshrrev_b32 v12, 3, v75
    v_lshlrev_b16 v13, 3, v75
    v_bitop3_b32 v12, v6, v13, v12 bitop3:0xca
    v_bitop3_b32 v71, v3, v12, v11 bitop3:0xca
    v_lshrrev_b32 v11, 3, v11
    v_lshrrev_b32 v13, 2, v75
    v_bitop3_b32 v11, v5, v13, v11 bitop3:0xca
    v_and_b32 v75, 0x3fff, v11
    ds_add_u32 v75, v2
    v_cvt_pk_bf16_f32 v67, v9, v10
    v_perm_b32 v12, v67, v67, s41
    v_bitop3_b32 v70, v4, v12, v70 bitop3:0xca
    v_perm_b32 v13, v67, v67, s42
    v_bitop3_b32 v71, v4, v13, v71 bitop3:0xca
    s_add_u32 s44, s33, 0x1f44000
    buffer_load_dwordx4 v[108:111], v0, s[8:11], s44 offen nt
    s_waitcnt vmcnt(7)
    v_lshlrev_b32 v7, 16, v84
    v_and_b32 v8, 0xffff0000, v84
    v_lshlrev_b32 v9, 16, v85
    v_and_b32 v10, 0xffff0000, v85
    v_mul_f32 v7, 0.15915494, v7
    v_mul_f32 v8, 0.15915494, v8
    v_mul_f32 v9, 0.15915494, v9
    v_mul_f32 v10, 0.15915494, v10
    v_cos_f32 v7, v7
    v_lshl_add_u32 v11, v76, 11, s40
    v_lshrrev_b32 v12, 3, v80
    v_lshlrev_b16 v13, 3, v80
    v_bitop3_b32 v12, v6, v13, v12 bitop3:0xca
    v_bitop3_b32 v76, v3, v12, v11 bitop3:0xca
    v_lshrrev_b32 v11, 3, v11
    v_lshrrev_b32 v13, 2, v80
    v_bitop3_b32 v11, v5, v13, v11 bitop3:0xca
    v_and_b32 v80, 0x3fff, v11
    ds_add_u32 v80, v2
    v_cos_f32 v8, v8
    v_lshl_add_u32 v11, v77, 11, s40
    v_lshrrev_b32 v12, 3, v81
    v_lshlrev_b16 v13, 3, v81
    v_bitop3_b32 v12, v6, v13, v12 bitop3:0xca
    v_bitop3_b32 v77, v3, v12, v11 bitop3:0xca
    v_lshrrev_b32 v11, 3, v11
    v_lshrrev_b32 v13, 2, v81
    v_bitop3_b32 v11, v5, v13, v11 bitop3:0xca
    v_and_b32 v81, 0x3fff, v11
    ds_add_u32 v81, v2
    v_cvt_pk_bf16_f32 v84, v7, v8
    v_perm_b32 v12, v84, v84, s41
    v_bitop3_b32 v76, v4, v12, v76 bitop3:0xca
    v_perm_b32 v13, v84, v84, s42
    v_bitop3_b32 v77, v4, v13, v77 bitop3:0xca
    v_cos_f32 v9, v9
    v_lshl_add_u32 v11, v78, 11, s40
    v_lshrrev_b32 v12, 3, v82
    v_lshlrev_b16 v13, 3, v82
    v_bitop3_b32 v12, v6, v13, v12 bitop3:0xca
    v_bitop3_b32 v78, v3, v12, v11 bitop3:0xca
    v_lshrrev_b32 v11, 3, v11
    v_lshrrev_b32 v13, 2, v82
    v_bitop3_b32 v11, v5, v13, v11 bitop3:0xca
    v_and_b32 v82, 0x3fff, v11
    ds_add_u32 v82, v2
    v_cos_f32 v10, v10
    v_lshl_add_u32 v11, v79, 11, s40
    v_lshrrev_b32 v12, 3, v83
    v_lshlrev_b16 v13, 3, v83
    v_bitop3_b32 v12, v6, v13, v12 bitop3:0xca
    v_bitop3_b32 v79, v3, v12, v11 bitop3:0xca
    v_lshrrev_b32 v11, 3, v11
    v_lshrrev_b32 v13, 2, v83
    v_bitop3_b32 v11, v5, v13, v11 bitop3:0xca
    v_and_b32 v83, 0x3fff, v11
    ds_add_u32 v83, v2
    v_cvt_pk_bf16_f32 v85, v9, v10
    v_perm_b32 v12, v85, v85, s41
    v_bitop3_b32 v78, v4, v12, v78 bitop3:0xca
    v_perm_b32 v13, v85, v85, s42
    v_bitop3_b32 v79, v4, v13, v79 bitop3:0xca
    s_waitcnt vmcnt(5)
    v_lshlrev_b32 v7, 16, v86
    v_and_b32 v8, 0xffff0000, v86
    v_lshlrev_b32 v9, 16, v87
    v_and_b32 v10, 0xffff0000, v87
    v_mul_f32 v7, 0.15915494, v7
    v_mul_f32 v8, 0.15915494, v8
    v_mul_f32 v9, 0.15915494, v9
    v_mul_f32 v10, 0.15915494, v10
    v_cos_f32 v7, v7
    v_lshl_add_u32 v11, v88, 11, s40
    v_lshrrev_b32 v12, 3, v92
    v_lshlrev_b16 v13, 3, v92
    v_bitop3_b32 v12, v6, v13, v12 bitop3:0xca
    v_bitop3_b32 v88, v3, v12, v11 bitop3:0xca
    v_lshrrev_b32 v11, 3, v11
    v_lshrrev_b32 v13, 2, v92
    v_bitop3_b32 v11, v5, v13, v11 bitop3:0xca
    v_and_b32 v92, 0x3fff, v11
    ds_add_u32 v92, v2
    v_cos_f32 v8, v8
    v_lshl_add_u32 v11, v89, 11, s40
    v_lshrrev_b32 v12, 3, v93
    v_lshlrev_b16 v13, 3, v93
    v_bitop3_b32 v12, v6, v13, v12 bitop3:0xca
    v_bitop3_b32 v89, v3, v12, v11 bitop3:0xca
    v_lshrrev_b32 v11, 3, v11
    v_lshrrev_b32 v13, 2, v93
    v_bitop3_b32 v11, v5, v13, v11 bitop3:0xca
    v_and_b32 v93, 0x3fff, v11
    ds_add_u32 v93, v2
    v_cvt_pk_bf16_f32 v86, v7, v8
    v_perm_b32 v12, v86, v86, s41
    v_bitop3_b32 v88, v4, v12, v88 bitop3:0xca
    v_perm_b32 v13, v86, v86, s42
    v_bitop3_b32 v89, v4, v13, v89 bitop3:0xca
    v_cos_f32 v9, v9
    v_lshl_add_u32 v11, v90, 11, s40
    v_lshrrev_b32 v12, 3, v94
    v_lshlrev_b16 v13, 3, v94
    v_bitop3_b32 v12, v6, v13, v12 bitop3:0xca
    v_bitop3_b32 v90, v3, v12, v11 bitop3:0xca
    v_lshrrev_b32 v11, 3, v11
    v_lshrrev_b32 v13, 2, v94
    v_bitop3_b32 v11, v5, v13, v11 bitop3:0xca
    v_and_b32 v94, 0x3fff, v11
    ds_add_u32 v94, v2
    v_cos_f32 v10, v10
    v_lshl_add_u32 v11, v91, 11, s40
    v_lshrrev_b32 v12, 3, v95
    v_lshlrev_b16 v13, 3, v95
    v_bitop3_b32 v12, v6, v13, v12 bitop3:0xca
    v_bitop3_b32 v91, v3, v12, v11 bitop3:0xca
    v_lshrrev_b32 v11, 3, v11
    v_lshrrev_b32 v13, 2, v95
    v_bitop3_b32 v11, v5, v13, v11 bitop3:0xca
    v_and_b32 v95, 0x3fff, v11
    ds_add_u32 v95, v2
    v_cvt_pk_bf16_f32 v87, v9, v10
    v_perm_b32 v12, v87, v87, s41
    v_bitop3_b32 v90, v4, v12, v90 bitop3:0xca
    v_perm_b32 v13, v87, v87, s42
    v_bitop3_b32 v91, v4, v13, v91 bitop3:0xca
    v_lshrrev_b32 v8, 2, v0
    v_and_b32 v7, 0x3c00, v0
    v_bitop3_b32 v7, v5, v8, v7 bitop3:0xea
    s_waitcnt lgkmcnt(0)
    s_barrier
    ds_read2st64_b32 v[8:9], v7 offset0:0 offset1:1
    ds_read2st64_b32 v[10:11], v7 offset0:2 offset1:3
    s_add_u32 s45, s33, 0x1f44000
    buffer_load_dwordx4 v[112:115], v0, s[12:15], s45 offen nt
    s_waitcnt lgkmcnt(0)
    v_lshl_or_b32 v12, v9, 16, v8
    v_lshl_or_b32 v13, v11, 16, v10
    v_mov_b32 v14, v12
    v_mov_b32 v15, v13
    s_nop 0
    v_add_u32_dpp v14, v14, v14 row_shr:1 row_mask:0xf bank_mask:0xf bound_ctrl:1
    v_add_u32_dpp v15, v15, v15 row_shr:1 row_mask:0xf bank_mask:0xf bound_ctrl:1
    s_nop 0
    v_add_u32_dpp v14, v14, v14 row_shr:2 row_mask:0xf bank_mask:0xf bound_ctrl:1
    v_add_u32_dpp v15, v15, v15 row_shr:2 row_mask:0xf bank_mask:0xf bound_ctrl:1
    s_nop 0
    v_add_u32_dpp v14, v14, v14 row_shr:4 row_mask:0xf bank_mask:0xf bound_ctrl:1
    v_add_u32_dpp v15, v15, v15 row_shr:4 row_mask:0xf bank_mask:0xf bound_ctrl:1
    s_nop 0
    v_add_u32_dpp v14, v14, v14 row_shr:8 row_mask:0xf bank_mask:0xf bound_ctrl:1
    v_add_u32_dpp v15, v15, v15 row_shr:8 row_mask:0xf bank_mask:0xf bound_ctrl:1
    s_nop 0
    v_add_u32_dpp v14, v14, v14 row_bcast:15 row_mask:0xa bank_mask:0xf
    v_add_u32_dpp v15, v15, v15 row_bcast:15 row_mask:0xa bank_mask:0xf
    s_nop 0
    v_add_u32_dpp v14, v14, v14 row_bcast:31 row_mask:0xc bank_mask:0xf
    v_add_u32_dpp v15, v15, v15 row_bcast:31 row_mask:0xc bank_mask:0xf
    v_readlane_b32 s48, v14, 63
    v_readlane_b32 s49, v15, 63
    s_lshl_b32 s54, s32, 2
    v_mov_b32 v8, s54
    s_and_b32 s50, s48, 0xffff
    s_lshr_b32 s51, s48, 16
    s_and_b32 s52, s49, 0xffff
    s_lshr_b32 s53, s49, 16
    s_add_u32 s51, s51, s50
    s_add_u32 s52, s52, s51
    s_add_u32 s53, s53, s52
    v_mov_b32 v9, s53
    s_mov_b64 exec, 1
    ds_write_b32 v8, v9 offset:16384
    s_mov_b64 exec, -1
    v_and_b32 v8, 60, v7
    s_waitcnt lgkmcnt(0)
    s_barrier
    ds_read_b32 v9, v8 offset:16384
    s_waitcnt lgkmcnt(0)
    v_add_u32_dpp v9, v9, v9 row_shr:1 row_mask:0xf bank_mask:0xf bound_ctrl:1
    s_nop 1
    v_add_u32_dpp v9, v9, v9 row_shr:2 row_mask:0xf bank_mask:0xf bound_ctrl:1
    s_nop 1
    v_add_u32_dpp v9, v9, v9 row_shr:4 row_mask:0xf bank_mask:0xf bound_ctrl:1
    s_nop 1
    v_add_u32_dpp v9, v9, v9 row_shr:8 row_mask:0xf bank_mask:0xf bound_ctrl:1
    s_nop 0
    v_readlane_b32 s54, v9, s32
    s_sub_u32 s54, s54, s53
    s_add_u32 s50, s50, s54
    s_add_u32 s51, s51, s54
    s_add_u32 s52, s52, s54
    s_pack_ll_b32_b16 s48, s54, s50
    s_pack_ll_b32_b16 s49, s51, s52
    v_add_u32 v14, s48, v14
    v_add_u32 v15, s49, v15
    v_sub_u32 v12, v14, v12
    v_sub_u32 v13, v15, v13
    v_and_b32 v8, 0xffff, v12
    v_lshrrev_b32 v9, 16, v12
    v_and_b32 v10, 0xffff, v13
    v_lshrrev_b32 v11, 16, v13
    ds_write2st64_b32 v7, v8, v9 offset0:0 offset1:1
    ds_write2st64_b32 v7, v10, v11 offset0:2 offset1:3
    s_waitcnt lgkmcnt(0)
    s_barrier
    ds_add_rtn_u32 v20, v20, v2
    ds_add_rtn_u32 v21, v21, v2
    ds_add_rtn_u32 v22, v22, v2
    ds_add_rtn_u32 v23, v23, v2
    s_add_u32 s46, s36, 0x0
    buffer_store_dwordx2 v[12:13], v1, s[24:27], s46 offen
    s_bitset0_b64 exec, 63
    s_not_b64 exec, exec
    buffer_store_dwordx2 v[14:15], v1, s[24:27], s46 offen offset:8
    s_mov_b64 exec, -1
    ds_add_rtn_u32 v32, v32, v2
    ds_add_rtn_u32 v33, v33, v2
    ds_add_rtn_u32 v34, v34, v2
    ds_add_rtn_u32 v35, v35, v2
    ds_add_rtn_u32 v40, v40, v2
    ds_add_rtn_u32 v41, v41, v2
    ds_add_rtn_u32 v42, v42, v2
    ds_add_rtn_u32 v43, v43, v2
    s_add_u32 s47, s33, 0x1f48000
    buffer_load_dwordx4 v[116:119], v0, s[8:11], s47 offen nt
    ds_add_rtn_u32 v52, v52, v2
    ds_add_rtn_u32 v53, v53, v2
    ds_add_rtn_u32 v54, v54, v2
    ds_add_rtn_u32 v55, v55, v2
    ds_add_rtn_u32 v60, v60, v2
    ds_add_rtn_u32 v61, v61, v2
    ds_add_rtn_u32 v62, v62, v2
    ds_add_rtn_u32 v63, v63, v2
    s_add_u32 s44, s33, 0x1f48000
    buffer_load_dwordx4 v[120:123], v0, s[12:15], s44 offen nt
    ds_add_rtn_u32 v72, v72, v2
    ds_add_rtn_u32 v73, v73, v2
    ds_add_rtn_u32 v74, v74, v2
    ds_add_rtn_u32 v75, v75, v2
    ds_add_rtn_u32 v80, v80, v2
    ds_add_rtn_u32 v81, v81, v2
    ds_add_rtn_u32 v82, v82, v2
    ds_add_rtn_u32 v83, v83, v2
    s_add_u32 s45, s34, 0xfa4000
    buffer_load_dwordx2 v[124:125], v1, s[16:19], s45 offen nt
    s_add_u32 s46, s34, 0xfa6000
    buffer_load_dwordx2 v[126:127], v1, s[16:19], s46 offen nt
    ds_add_rtn_u32 v92, v92, v2
    ds_add_rtn_u32 v93, v93, v2
    ds_add_rtn_u32 v94, v94, v2
    ds_add_rtn_u32 v95, v95, v2
    s_waitcnt lgkmcnt(0)
    s_barrier
    v_and_b32 v7, -4, v20
    v_lshl_add_u32 v8, v20, 2, v7
    ds_write_b32 v8, v16
    v_lshl_add_u32 v7, v7, 2, v20
    ds_write_b8 v7, v24 offset:16
    v_and_b32 v9, -4, v21
    v_lshl_add_u32 v10, v21, 2, v9
    ds_write_b32 v10, v17
    v_lshl_add_u32 v9, v9, 2, v21
    ds_write_b8_d16_hi v9, v24 offset:16
    v_and_b32 v7, -4, v22
    v_lshl_add_u32 v8, v22, 2, v7
    ds_write_b32 v8, v18
    v_lshl_add_u32 v7, v7, 2, v22
    ds_write_b8 v7, v25 offset:16
    v_and_b32 v9, -4, v23
    v_lshl_add_u32 v10, v23, 2, v9
    ds_write_b32 v10, v19
    v_lshl_add_u32 v9, v9, 2, v23
    ds_write_b8_d16_hi v9, v25 offset:16
    s_add_u32 s47, s33, 0x1f4c000
    buffer_load_dwordx4 v[16:19], v0, s[8:11], s47 offen nt
    s_add_u32 s44, s33, 0x1f4c000
    buffer_load_dwordx4 v[20:23], v0, s[12:15], s44 offen nt
    v_and_b32 v7, -4, v32
    v_lshl_add_u32 v8, v32, 2, v7
    ds_write_b32 v8, v28
    v_lshl_add_u32 v7, v7, 2, v32
    ds_write_b8 v7, v26 offset:16
    v_and_b32 v9, -4, v33
    v_lshl_add_u32 v10, v33, 2, v9
    ds_write_b32 v10, v29
    v_lshl_add_u32 v9, v9, 2, v33
    ds_write_b8_d16_hi v9, v26 offset:16
    v_and_b32 v7, -4, v34
    v_lshl_add_u32 v8, v34, 2, v7
    ds_write_b32 v8, v30
    v_lshl_add_u32 v7, v7, 2, v34
    ds_write_b8 v7, v27 offset:16
    v_and_b32 v9, -4, v35
    v_lshl_add_u32 v10, v35, 2, v9
    ds_write_b32 v10, v31
    v_lshl_add_u32 v9, v9, 2, v35
    ds_write_b8_d16_hi v9, v27 offset:16
    s_add_u32 s45, s33, 0x1f50000
    buffer_load_dwordx4 v[28:31], v0, s[8:11], s45 offen nt
    v_and_b32 v7, -4, v40
    v_lshl_add_u32 v8, v40, 2, v7
    ds_write_b32 v8, v36
    v_lshl_add_u32 v7, v7, 2, v40
    ds_write_b8 v7, v44 offset:16
    v_and_b32 v9, -4, v41
    v_lshl_add_u32 v10, v41, 2, v9
    ds_write_b32 v10, v37
    v_lshl_add_u32 v9, v9, 2, v41
    ds_write_b8_d16_hi v9, v44 offset:16
    v_and_b32 v7, -4, v42
    v_lshl_add_u32 v8, v42, 2, v7
    ds_write_b32 v8, v38
    v_lshl_add_u32 v7, v7, 2, v42
    ds_write_b8 v7, v45 offset:16
    v_and_b32 v9, -4, v43
    v_lshl_add_u32 v10, v43, 2, v9
    ds_write_b32 v10, v39
    v_lshl_add_u32 v9, v9, 2, v43
    ds_write_b8_d16_hi v9, v45 offset:16
    s_add_u32 s46, s33, 0x1f50000
    buffer_load_dwordx4 v[32:35], v0, s[12:15], s46 offen nt
    v_and_b32 v7, -4, v52
    v_lshl_add_u32 v8, v52, 2, v7
    ds_write_b32 v8, v48
    v_lshl_add_u32 v7, v7, 2, v52
    ds_write_b8 v7, v46 offset:16
    v_and_b32 v9, -4, v53
    v_lshl_add_u32 v10, v53, 2, v9
    ds_write_b32 v10, v49
    v_lshl_add_u32 v9, v9, 2, v53
    ds_write_b8_d16_hi v9, v46 offset:16
    v_and_b32 v7, -4, v54
    v_lshl_add_u32 v8, v54, 2, v7
    ds_write_b32 v8, v50
    v_lshl_add_u32 v7, v7, 2, v54
    ds_write_b8 v7, v47 offset:16
    v_and_b32 v9, -4, v55
    v_lshl_add_u32 v10, v55, 2, v9
    ds_write_b32 v10, v51
    v_lshl_add_u32 v9, v9, 2, v55
    ds_write_b8_d16_hi v9, v47 offset:16
    s_add_u32 s47, s34, 0xfa8000
    buffer_load_dwordx2 v[24:25], v1, s[16:19], s47 offen nt
    s_add_u32 s44, s34, 0xfaa000
    buffer_load_dwordx2 v[26:27], v1, s[16:19], s44 offen nt
    v_and_b32 v7, -4, v60
    v_lshl_add_u32 v8, v60, 2, v7
    ds_write_b32 v8, v56
    v_lshl_add_u32 v7, v7, 2, v60
    ds_write_b8 v7, v64 offset:16
    v_and_b32 v9, -4, v61
    v_lshl_add_u32 v10, v61, 2, v9
    ds_write_b32 v10, v57
    v_lshl_add_u32 v9, v9, 2, v61
    ds_write_b8_d16_hi v9, v64 offset:16
    v_and_b32 v7, -4, v62
    v_lshl_add_u32 v8, v62, 2, v7
    ds_write_b32 v8, v58
    v_lshl_add_u32 v7, v7, 2, v62
    ds_write_b8 v7, v65 offset:16
    v_and_b32 v9, -4, v63
    v_lshl_add_u32 v10, v63, 2, v9
    ds_write_b32 v10, v59
    v_lshl_add_u32 v9, v9, 2, v63
    ds_write_b8_d16_hi v9, v65 offset:16
    s_add_u32 s45, s33, 0x1f54000
    buffer_load_dwordx4 v[36:39], v0, s[8:11], s45 offen nt
    s_add_u32 s46, s33, 0x1f54000
    buffer_load_dwordx4 v[40:43], v0, s[12:15], s46 offen nt
    v_and_b32 v7, -4, v72
    v_lshl_add_u32 v8, v72, 2, v7
    ds_write_b32 v8, v68
    v_lshl_add_u32 v7, v7, 2, v72
    ds_write_b8 v7, v66 offset:16
    v_and_b32 v9, -4, v73
    v_lshl_add_u32 v10, v73, 2, v9
    ds_write_b32 v10, v69
    v_lshl_add_u32 v9, v9, 2, v73
    ds_write_b8_d16_hi v9, v66 offset:16
    v_and_b32 v7, -4, v74
    v_lshl_add_u32 v8, v74, 2, v7
    ds_write_b32 v8, v70
    v_lshl_add_u32 v7, v7, 2, v74
    ds_write_b8 v7, v67 offset:16
    v_and_b32 v9, -4, v75
    v_lshl_add_u32 v10, v75, 2, v9
    ds_write_b32 v10, v71
    v_lshl_add_u32 v9, v9, 2, v75
    ds_write_b8_d16_hi v9, v67 offset:16
    s_add_u32 s47, s33, 0x1f58000
    buffer_load_dwordx4 v[48:51], v0, s[8:11], s47 offen nt
    v_and_b32 v7, -4, v80
    v_lshl_add_u32 v8, v80, 2, v7
    ds_write_b32 v8, v76
    v_lshl_add_u32 v7, v7, 2, v80
    ds_write_b8 v7, v84 offset:16
    v_and_b32 v9, -4, v81
    v_lshl_add_u32 v10, v81, 2, v9
    ds_write_b32 v10, v77
    v_lshl_add_u32 v9, v9, 2, v81
    ds_write_b8_d16_hi v9, v84 offset:16
    v_and_b32 v7, -4, v82
    v_lshl_add_u32 v8, v82, 2, v7
    ds_write_b32 v8, v78
    v_lshl_add_u32 v7, v7, 2, v82
    ds_write_b8 v7, v85 offset:16
    v_and_b32 v9, -4, v83
    v_lshl_add_u32 v10, v83, 2, v9
    ds_write_b32 v10, v79
    v_lshl_add_u32 v9, v9, 2, v83
    ds_write_b8_d16_hi v9, v85 offset:16
    s_add_u32 s44, s33, 0x1f58000
    buffer_load_dwordx4 v[52:55], v0, s[12:15], s44 offen nt
    v_and_b32 v7, -4, v92
    v_lshl_add_u32 v8, v92, 2, v7
    ds_write_b32 v8, v88
    v_lshl_add_u32 v7, v7, 2, v92
    ds_write_b8 v7, v86 offset:16
    v_and_b32 v9, -4, v93
    v_lshl_add_u32 v10, v93, 2, v9
    ds_write_b32 v10, v89
    v_lshl_add_u32 v9, v9, 2, v93
    ds_write_b8_d16_hi v9, v86 offset:16
    v_and_b32 v7, -4, v94
    v_lshl_add_u32 v8, v94, 2, v7
    ds_write_b32 v8, v90
    v_lshl_add_u32 v7, v7, 2, v94
    ds_write_b8 v7, v87 offset:16
    v_and_b32 v9, -4, v95
    v_lshl_add_u32 v10, v95, 2, v9
    ds_write_b32 v10, v91
    v_lshl_add_u32 v9, v9, 2, v95
    ds_write_b8_d16_hi v9, v87 offset:16
    s_add_u32 s45, s34, 0xfac000
    buffer_load_dwordx2 v[44:45], v1, s[16:19], s45 offen nt
    s_add_u32 s46, s34, 0xfae000
    buffer_load_dwordx2 v[46:47], v1, s[16:19], s46 offen nt
    v_add_u32 v7, 0x10000, v0
    v_add_u32 v12, 0x20000, v0
    v_mov_b32 v8, 0
    v_mov_b32 v9, 0
    v_mov_b32 v10, 0
    v_mov_b32 v11, 0
    s_waitcnt lgkmcnt(0)
    s_barrier
    ds_read_b128 v[56:59], v0 offset:0
    ds_write_b128 v0, v[8:11]
    ds_read_b128 v[60:63], v0 offset:16384
    ds_read_b128 v[68:71], v0 offset:32768
    ds_read_b128 v[72:75], v0 offset:49152
    ds_read_b128 v[64:67], v7 offset:0
    ds_read_b128 v[76:79], v7 offset:16384
    ds_read_b128 v[80:83], v7 offset:32768
    ds_read_b128 v[88:91], v7 offset:49152
    ds_read_b128 v[92:95], v12 offset:0
    ds_read_b128 v[84:87], v12 offset:16384
    s_waitcnt lgkmcnt(0)
    s_barrier
    s_add_u32 s47, s35, 0x0
    buffer_store_dwordx4 v[56:59], v0, s[20:23], s47 offen sc1
    s_add_u32 s44, s33, 0x1f5c000
    s_nop 0
    buffer_load_dwordx4 v[56:59], v0, s[8:11], s44 offen nt
    s_add_u32 s45, s35, 0x4000
    buffer_store_dwordx4 v[60:63], v0, s[20:23], s45 offen sc1
    s_add_u32 s46, s33, 0x1f5c000
    s_nop 0
    buffer_load_dwordx4 v[60:63], v0, s[12:15], s46 offen nt
    s_waitcnt vmcnt(24)
    v_lshlrev_b32 v7, 16, v104
    v_and_b32 v8, 0xffff0000, v104
    v_lshlrev_b32 v9, 16, v105
    v_and_b32 v10, 0xffff0000, v105
    v_mul_f32 v7, 0.15915494, v7
    v_mul_f32 v8, 0.15915494, v8
    v_mul_f32 v9, 0.15915494, v9
    v_mul_f32 v10, 0.15915494, v10
    v_cos_f32 v7, v7
    v_lshl_add_u32 v11, v96, 11, s40
    v_lshrrev_b32 v12, 3, v100
    v_lshlrev_b16 v13, 3, v100
    v_bitop3_b32 v12, v6, v13, v12 bitop3:0xca
    v_bitop3_b32 v96, v3, v12, v11 bitop3:0xca
    v_lshrrev_b32 v11, 3, v11
    v_lshrrev_b32 v13, 2, v100
    v_bitop3_b32 v11, v5, v13, v11 bitop3:0xca
    v_and_b32 v100, 0x3fff, v11
    ds_add_u32 v100, v2
    v_cos_f32 v8, v8
    v_lshl_add_u32 v11, v97, 11, s40
    v_lshrrev_b32 v12, 3, v101
    v_lshlrev_b16 v13, 3, v101
    v_bitop3_b32 v12, v6, v13, v12 bitop3:0xca
    v_bitop3_b32 v97, v3, v12, v11 bitop3:0xca
    v_lshrrev_b32 v11, 3, v11
    v_lshrrev_b32 v13, 2, v101
    v_bitop3_b32 v11, v5, v13, v11 bitop3:0xca
    v_and_b32 v101, 0x3fff, v11
    ds_add_u32 v101, v2
    v_cvt_pk_bf16_f32 v104, v7, v8
    v_perm_b32 v12, v104, v104, s41
    v_bitop3_b32 v96, v4, v12, v96 bitop3:0xca
    v_perm_b32 v13, v104, v104, s42
    v_bitop3_b32 v97, v4, v13, v97 bitop3:0xca
    v_cos_f32 v9, v9
    v_lshl_add_u32 v11, v98, 11, s40
    v_lshrrev_b32 v12, 3, v102
    v_lshlrev_b16 v13, 3, v102
    v_bitop3_b32 v12, v6, v13, v12 bitop3:0xca
    v_bitop3_b32 v98, v3, v12, v11 bitop3:0xca
    v_lshrrev_b32 v11, 3, v11
    v_lshrrev_b32 v13, 2, v102
    v_bitop3_b32 v11, v5, v13, v11 bitop3:0xca
    v_and_b32 v102, 0x3fff, v11
    ds_add_u32 v102, v2
    v_cos_f32 v10, v10
    v_lshl_add_u32 v11, v99, 11, s40
    v_lshrrev_b32 v12, 3, v103
    v_lshlrev_b16 v13, 3, v103
    v_bitop3_b32 v12, v6, v13, v12 bitop3:0xca
    v_bitop3_b32 v99, v3, v12, v11 bitop3:0xca
    v_lshrrev_b32 v11, 3, v11
    v_lshrrev_b32 v13, 2, v103
    v_bitop3_b32 v11, v5, v13, v11 bitop3:0xca
    v_and_b32 v103, 0x3fff, v11
    ds_add_u32 v103, v2
    v_cvt_pk_bf16_f32 v105, v9, v10
    v_perm_b32 v12, v105, v105, s41
    v_bitop3_b32 v98, v4, v12, v98 bitop3:0xca
    v_perm_b32 v13, v105, v105, s42
    v_bitop3_b32 v99, v4, v13, v99 bitop3:0xca
    s_add_u32 s47, s35, 0x8000
    buffer_store_dwordx4 v[68:71], v0, s[20:23], s47 offen sc1
    s_add_u32 s44, s33, 0x3e80000
    s_nop 0
    buffer_load_dwordx4 v[68:71], v0, s[8:11], s44 offen nt
    s_waitcnt vmcnt(24)
    v_lshlrev_b32 v7, 16, v106
    v_and_b32 v8, 0xffff0000, v106
    v_lshlrev_b32 v9, 16, v107
    v_and_b32 v10, 0xffff0000, v107
    v_mul_f32 v7, 0.15915494, v7
    v_mul_f32 v8, 0.15915494, v8
    v_mul_f32 v9, 0.15915494, v9
    v_mul_f32 v10, 0.15915494, v10
    v_cos_f32 v7, v7
    v_lshl_add_u32 v11, v108, 11, s40
    v_lshrrev_b32 v12, 3, v112
    v_lshlrev_b16 v13, 3, v112
    v_bitop3_b32 v12, v6, v13, v12 bitop3:0xca
    v_bitop3_b32 v108, v3, v12, v11 bitop3:0xca
    v_lshrrev_b32 v11, 3, v11
    v_lshrrev_b32 v13, 2, v112
    v_bitop3_b32 v11, v5, v13, v11 bitop3:0xca
    v_and_b32 v112, 0x3fff, v11
    ds_add_u32 v112, v2
    v_cos_f32 v8, v8
    v_lshl_add_u32 v11, v109, 11, s40
    v_lshrrev_b32 v12, 3, v113
    v_lshlrev_b16 v13, 3, v113
    v_bitop3_b32 v12, v6, v13, v12 bitop3:0xca
    v_bitop3_b32 v109, v3, v12, v11 bitop3:0xca
    v_lshrrev_b32 v11, 3, v11
    v_lshrrev_b32 v13, 2, v113
    v_bitop3_b32 v11, v5, v13, v11 bitop3:0xca
    v_and_b32 v113, 0x3fff, v11
    ds_add_u32 v113, v2
    v_cvt_pk_bf16_f32 v106, v7, v8
    v_perm_b32 v12, v106, v106, s41
    v_bitop3_b32 v108, v4, v12, v108 bitop3:0xca
    v_perm_b32 v13, v106, v106, s42
    v_bitop3_b32 v109, v4, v13, v109 bitop3:0xca
    v_cos_f32 v9, v9
    v_lshl_add_u32 v11, v110, 11, s40
    v_lshrrev_b32 v12, 3, v114
    v_lshlrev_b16 v13, 3, v114
    v_bitop3_b32 v12, v6, v13, v12 bitop3:0xca
    v_bitop3_b32 v110, v3, v12, v11 bitop3:0xca
    v_lshrrev_b32 v11, 3, v11
    v_lshrrev_b32 v13, 2, v114
    v_bitop3_b32 v11, v5, v13, v11 bitop3:0xca
    v_and_b32 v114, 0x3fff, v11
    ds_add_u32 v114, v2
    v_cos_f32 v10, v10
    v_lshl_add_u32 v11, v111, 11, s40
    v_lshrrev_b32 v12, 3, v115
    v_lshlrev_b16 v13, 3, v115
    v_bitop3_b32 v12, v6, v13, v12 bitop3:0xca
    v_bitop3_b32 v111, v3, v12, v11 bitop3:0xca
    v_lshrrev_b32 v11, 3, v11
    v_lshrrev_b32 v13, 2, v115
    v_bitop3_b32 v11, v5, v13, v11 bitop3:0xca
    v_and_b32 v115, 0x3fff, v11
    ds_add_u32 v115, v2
    v_cvt_pk_bf16_f32 v107, v9, v10
    v_perm_b32 v12, v107, v107, s41
    v_bitop3_b32 v110, v4, v12, v110 bitop3:0xca
    v_perm_b32 v13, v107, v107, s42
    v_bitop3_b32 v111, v4, v13, v111 bitop3:0xca
    s_waitcnt vmcnt(18)
    v_lshlrev_b32 v7, 16, v124
    v_and_b32 v8, 0xffff0000, v124
    v_lshlrev_b32 v9, 16, v125
    v_and_b32 v10, 0xffff0000, v125
    v_mul_f32 v7, 0.15915494, v7
    v_mul_f32 v8, 0.15915494, v8
    v_mul_f32 v9, 0.15915494, v9
    v_mul_f32 v10, 0.15915494, v10
    v_cos_f32 v7, v7
    v_lshl_add_u32 v11, v116, 11, s40
    v_lshrrev_b32 v12, 3, v120
    v_lshlrev_b16 v13, 3, v120
    v_bitop3_b32 v12, v6, v13, v12 bitop3:0xca
    v_bitop3_b32 v116, v3, v12, v11 bitop3:0xca
    v_lshrrev_b32 v11, 3, v11
    v_lshrrev_b32 v13, 2, v120
    v_bitop3_b32 v11, v5, v13, v11 bitop3:0xca
    v_and_b32 v120, 0x3fff, v11
    ds_add_u32 v120, v2
    v_cos_f32 v8, v8
    v_lshl_add_u32 v11, v117, 11, s40
    v_lshrrev_b32 v12, 3, v121
    v_lshlrev_b16 v13, 3, v121
    v_bitop3_b32 v12, v6, v13, v12 bitop3:0xca
    v_bitop3_b32 v117, v3, v12, v11 bitop3:0xca
    v_lshrrev_b32 v11, 3, v11
    v_lshrrev_b32 v13, 2, v121
    v_bitop3_b32 v11, v5, v13, v11 bitop3:0xca
    v_and_b32 v121, 0x3fff, v11
    ds_add_u32 v121, v2
    v_cvt_pk_bf16_f32 v124, v7, v8
    v_perm_b32 v12, v124, v124, s41
    v_bitop3_b32 v116, v4, v12, v116 bitop3:0xca
    v_perm_b32 v13, v124, v124, s42
    v_bitop3_b32 v117, v4, v13, v117 bitop3:0xca
    v_cos_f32 v9, v9
    v_lshl_add_u32 v11, v118, 11, s40
    v_lshrrev_b32 v12, 3, v122
    v_lshlrev_b16 v13, 3, v122
    v_bitop3_b32 v12, v6, v13, v12 bitop3:0xca
    v_bitop3_b32 v118, v3, v12, v11 bitop3:0xca
    v_lshrrev_b32 v11, 3, v11
    v_lshrrev_b32 v13, 2, v122
    v_bitop3_b32 v11, v5, v13, v11 bitop3:0xca
    v_and_b32 v122, 0x3fff, v11
    ds_add_u32 v122, v2
    v_cos_f32 v10, v10
    v_lshl_add_u32 v11, v119, 11, s40
    v_lshrrev_b32 v12, 3, v123
    v_lshlrev_b16 v13, 3, v123
    v_bitop3_b32 v12, v6, v13, v12 bitop3:0xca
    v_bitop3_b32 v119, v3, v12, v11 bitop3:0xca
    v_lshrrev_b32 v11, 3, v11
    v_lshrrev_b32 v13, 2, v123
    v_bitop3_b32 v11, v5, v13, v11 bitop3:0xca
    v_and_b32 v123, 0x3fff, v11
    ds_add_u32 v123, v2
    v_cvt_pk_bf16_f32 v125, v9, v10
    v_perm_b32 v12, v125, v125, s41
    v_bitop3_b32 v118, v4, v12, v118 bitop3:0xca
    v_perm_b32 v13, v125, v125, s42
    v_bitop3_b32 v119, v4, v13, v119 bitop3:0xca
    s_add_u32 s45, s35, 0xc000
    buffer_store_dwordx4 v[72:75], v0, s[20:23], s45 offen sc1
    s_add_u32 s46, s33, 0x3e80000
    s_nop 0
    buffer_load_dwordx4 v[72:75], v0, s[12:15], s46 offen nt
    s_waitcnt vmcnt(18)
    v_lshlrev_b32 v7, 16, v126
    v_and_b32 v8, 0xffff0000, v126
    v_lshlrev_b32 v9, 16, v127
    v_and_b32 v10, 0xffff0000, v127
    v_mul_f32 v7, 0.15915494, v7
    v_mul_f32 v8, 0.15915494, v8
    v_mul_f32 v9, 0.15915494, v9
    v_mul_f32 v10, 0.15915494, v10
    v_cos_f32 v7, v7
    v_lshl_add_u32 v11, v16, 11, s40
    v_lshrrev_b32 v12, 3, v20
    v_lshlrev_b16 v13, 3, v20
    v_bitop3_b32 v12, v6, v13, v12 bitop3:0xca
    v_bitop3_b32 v16, v3, v12, v11 bitop3:0xca
    v_lshrrev_b32 v11, 3, v11
    v_lshrrev_b32 v13, 2, v20
    v_bitop3_b32 v11, v5, v13, v11 bitop3:0xca
    v_and_b32 v20, 0x3fff, v11
    ds_add_u32 v20, v2
    v_cos_f32 v8, v8
    v_lshl_add_u32 v11, v17, 11, s40
    v_lshrrev_b32 v12, 3, v21
    v_lshlrev_b16 v13, 3, v21
    v_bitop3_b32 v12, v6, v13, v12 bitop3:0xca
    v_bitop3_b32 v17, v3, v12, v11 bitop3:0xca
    v_lshrrev_b32 v11, 3, v11
    v_lshrrev_b32 v13, 2, v21
    v_bitop3_b32 v11, v5, v13, v11 bitop3:0xca
    v_and_b32 v21, 0x3fff, v11
    ds_add_u32 v21, v2
    v_cvt_pk_bf16_f32 v126, v7, v8
    v_perm_b32 v12, v126, v126, s41
    v_bitop3_b32 v16, v4, v12, v16 bitop3:0xca
    v_perm_b32 v13, v126, v126, s42
    v_bitop3_b32 v17, v4, v13, v17 bitop3:0xca
    v_cos_f32 v9, v9
    v_lshl_add_u32 v11, v18, 11, s40
    v_lshrrev_b32 v12, 3, v22
    v_lshlrev_b16 v13, 3, v22
    v_bitop3_b32 v12, v6, v13, v12 bitop3:0xca
    v_bitop3_b32 v18, v3, v12, v11 bitop3:0xca
    v_lshrrev_b32 v11, 3, v11
    v_lshrrev_b32 v13, 2, v22
    v_bitop3_b32 v11, v5, v13, v11 bitop3:0xca
    v_and_b32 v22, 0x3fff, v11
    ds_add_u32 v22, v2
    v_cos_f32 v10, v10
    v_lshl_add_u32 v11, v19, 11, s40
    v_lshrrev_b32 v12, 3, v23
    v_lshlrev_b16 v13, 3, v23
    v_bitop3_b32 v12, v6, v13, v12 bitop3:0xca
    v_bitop3_b32 v19, v3, v12, v11 bitop3:0xca
    v_lshrrev_b32 v11, 3, v11
    v_lshrrev_b32 v13, 2, v23
    v_bitop3_b32 v11, v5, v13, v11 bitop3:0xca
    v_and_b32 v23, 0x3fff, v11
    ds_add_u32 v23, v2
    v_cvt_pk_bf16_f32 v127, v9, v10
    v_perm_b32 v12, v127, v127, s41
    v_bitop3_b32 v18, v4, v12, v18 bitop3:0xca
    v_perm_b32 v13, v127, v127, s42
    v_bitop3_b32 v19, v4, v13, v19 bitop3:0xca
    s_waitcnt vmcnt(14)
    v_lshlrev_b32 v7, 16, v24
    v_and_b32 v8, 0xffff0000, v24
    v_lshlrev_b32 v9, 16, v25
    v_and_b32 v10, 0xffff0000, v25
    v_mul_f32 v7, 0.15915494, v7
    v_mul_f32 v8, 0.15915494, v8
    v_mul_f32 v9, 0.15915494, v9
    v_mul_f32 v10, 0.15915494, v10
    v_cos_f32 v7, v7
    v_lshl_add_u32 v11, v28, 11, s40
    v_lshrrev_b32 v12, 3, v32
    v_lshlrev_b16 v13, 3, v32
    v_bitop3_b32 v12, v6, v13, v12 bitop3:0xca
    v_bitop3_b32 v28, v3, v12, v11 bitop3:0xca
    v_lshrrev_b32 v11, 3, v11
    v_lshrrev_b32 v13, 2, v32
    v_bitop3_b32 v11, v5, v13, v11 bitop3:0xca
    v_and_b32 v32, 0x3fff, v11
    ds_add_u32 v32, v2
    v_cos_f32 v8, v8
    v_lshl_add_u32 v11, v29, 11, s40
    v_lshrrev_b32 v12, 3, v33
    v_lshlrev_b16 v13, 3, v33
    v_bitop3_b32 v12, v6, v13, v12 bitop3:0xca
    v_bitop3_b32 v29, v3, v12, v11 bitop3:0xca
    v_lshrrev_b32 v11, 3, v11
    v_lshrrev_b32 v13, 2, v33
    v_bitop3_b32 v11, v5, v13, v11 bitop3:0xca
    v_and_b32 v33, 0x3fff, v11
    ds_add_u32 v33, v2
    v_cvt_pk_bf16_f32 v24, v7, v8
    v_perm_b32 v12, v24, v24, s41
    v_bitop3_b32 v28, v4, v12, v28 bitop3:0xca
    v_perm_b32 v13, v24, v24, s42
    v_bitop3_b32 v29, v4, v13, v29 bitop3:0xca
    v_cos_f32 v9, v9
    v_lshl_add_u32 v11, v30, 11, s40
    v_lshrrev_b32 v12, 3, v34
    v_lshlrev_b16 v13, 3, v34
    v_bitop3_b32 v12, v6, v13, v12 bitop3:0xca
    v_bitop3_b32 v30, v3, v12, v11 bitop3:0xca
    v_lshrrev_b32 v11, 3, v11
    v_lshrrev_b32 v13, 2, v34
    v_bitop3_b32 v11, v5, v13, v11 bitop3:0xca
    v_and_b32 v34, 0x3fff, v11
    ds_add_u32 v34, v2
    v_cos_f32 v10, v10
    v_lshl_add_u32 v11, v31, 11, s40
    v_lshrrev_b32 v12, 3, v35
    v_lshlrev_b16 v13, 3, v35
    v_bitop3_b32 v12, v6, v13, v12 bitop3:0xca
    v_bitop3_b32 v31, v3, v12, v11 bitop3:0xca
    v_lshrrev_b32 v11, 3, v11
    v_lshrrev_b32 v13, 2, v35
    v_bitop3_b32 v11, v5, v13, v11 bitop3:0xca
    v_and_b32 v35, 0x3fff, v11
    ds_add_u32 v35, v2
    v_cvt_pk_bf16_f32 v25, v9, v10
    v_perm_b32 v12, v25, v25, s41
    v_bitop3_b32 v30, v4, v12, v30 bitop3:0xca
    v_perm_b32 v13, v25, v25, s42
    v_bitop3_b32 v31, v4, v13, v31 bitop3:0xca
    s_add_u32 s47, s35, 0x10000
    buffer_store_dwordx4 v[64:67], v0, s[20:23], s47 offen sc1
    s_add_u32 s44, s34, 0x1f40000
    s_nop 0
    buffer_load_dwordx2 v[64:65], v1, s[16:19], s44 offen nt
    s_add_u32 s45, s34, 0x1f42000
    buffer_load_dwordx2 v[66:67], v1, s[16:19], s45 offen nt
    s_waitcnt vmcnt(15)
    v_lshlrev_b32 v7, 16, v26
    v_and_b32 v8, 0xffff0000, v26
    v_lshlrev_b32 v9, 16, v27
    v_and_b32 v10, 0xffff0000, v27
    v_mul_f32 v7, 0.15915494, v7
    v_mul_f32 v8, 0.15915494, v8
    v_mul_f32 v9, 0.15915494, v9
    v_mul_f32 v10, 0.15915494, v10
    v_cos_f32 v7, v7
    v_lshl_add_u32 v11, v36, 11, s40
    v_lshrrev_b32 v12, 3, v40
    v_lshlrev_b16 v13, 3, v40
    v_bitop3_b32 v12, v6, v13, v12 bitop3:0xca
    v_bitop3_b32 v36, v3, v12, v11 bitop3:0xca
    v_lshrrev_b32 v11, 3, v11
    v_lshrrev_b32 v13, 2, v40
    v_bitop3_b32 v11, v5, v13, v11 bitop3:0xca
    v_and_b32 v40, 0x3fff, v11
    ds_add_u32 v40, v2
    v_cos_f32 v8, v8
    v_lshl_add_u32 v11, v37, 11, s40
    v_lshrrev_b32 v12, 3, v41
    v_lshlrev_b16 v13, 3, v41
    v_bitop3_b32 v12, v6, v13, v12 bitop3:0xca
    v_bitop3_b32 v37, v3, v12, v11 bitop3:0xca
    v_lshrrev_b32 v11, 3, v11
    v_lshrrev_b32 v13, 2, v41
    v_bitop3_b32 v11, v5, v13, v11 bitop3:0xca
    v_and_b32 v41, 0x3fff, v11
    ds_add_u32 v41, v2
    v_cvt_pk_bf16_f32 v26, v7, v8
    v_perm_b32 v12, v26, v26, s41
    v_bitop3_b32 v36, v4, v12, v36 bitop3:0xca
    v_perm_b32 v13, v26, v26, s42
    v_bitop3_b32 v37, v4, v13, v37 bitop3:0xca
    v_cos_f32 v9, v9
    v_lshl_add_u32 v11, v38, 11, s40
    v_lshrrev_b32 v12, 3, v42
    v_lshlrev_b16 v13, 3, v42
    v_bitop3_b32 v12, v6, v13, v12 bitop3:0xca
    v_bitop3_b32 v38, v3, v12, v11 bitop3:0xca
    v_lshrrev_b32 v11, 3, v11
    v_lshrrev_b32 v13, 2, v42
    v_bitop3_b32 v11, v5, v13, v11 bitop3:0xca
    v_and_b32 v42, 0x3fff, v11
    ds_add_u32 v42, v2
    v_cos_f32 v10, v10
    v_lshl_add_u32 v11, v39, 11, s40
    v_lshrrev_b32 v12, 3, v43
    v_lshlrev_b16 v13, 3, v43
    v_bitop3_b32 v12, v6, v13, v12 bitop3:0xca
    v_bitop3_b32 v39, v3, v12, v11 bitop3:0xca
    v_lshrrev_b32 v11, 3, v11
    v_lshrrev_b32 v13, 2, v43
    v_bitop3_b32 v11, v5, v13, v11 bitop3:0xca
    v_and_b32 v43, 0x3fff, v11
    ds_add_u32 v43, v2
    v_cvt_pk_bf16_f32 v27, v9, v10
    v_perm_b32 v12, v27, v27, s41
    v_bitop3_b32 v38, v4, v12, v38 bitop3:0xca
    v_perm_b32 v13, v27, v27, s42
    v_bitop3_b32 v39, v4, v13, v39 bitop3:0xca
    s_waitcnt vmcnt(11)
    v_lshlrev_b32 v7, 16, v44
    v_and_b32 v8, 0xffff0000, v44
    v_lshlrev_b32 v9, 16, v45
    v_and_b32 v10, 0xffff0000, v45
    v_mul_f32 v7, 0.15915494, v7
    v_mul_f32 v8, 0.15915494, v8
    v_mul_f32 v9, 0.15915494, v9
    v_mul_f32 v10, 0.15915494, v10
    v_cos_f32 v7, v7
    v_lshl_add_u32 v11, v48, 11, s40
    v_lshrrev_b32 v12, 3, v52
    v_lshlrev_b16 v13, 3, v52
    v_bitop3_b32 v12, v6, v13, v12 bitop3:0xca
    v_bitop3_b32 v48, v3, v12, v11 bitop3:0xca
    v_lshrrev_b32 v11, 3, v11
    v_lshrrev_b32 v13, 2, v52
    v_bitop3_b32 v11, v5, v13, v11 bitop3:0xca
    v_and_b32 v52, 0x3fff, v11
    ds_add_u32 v52, v2
    v_cos_f32 v8, v8
    v_lshl_add_u32 v11, v49, 11, s40
    v_lshrrev_b32 v12, 3, v53
    v_lshlrev_b16 v13, 3, v53
    v_bitop3_b32 v12, v6, v13, v12 bitop3:0xca
    v_bitop3_b32 v49, v3, v12, v11 bitop3:0xca
    v_lshrrev_b32 v11, 3, v11
    v_lshrrev_b32 v13, 2, v53
    v_bitop3_b32 v11, v5, v13, v11 bitop3:0xca
    v_and_b32 v53, 0x3fff, v11
    ds_add_u32 v53, v2
    v_cvt_pk_bf16_f32 v44, v7, v8
    v_perm_b32 v12, v44, v44, s41
    v_bitop3_b32 v48, v4, v12, v48 bitop3:0xca
    v_perm_b32 v13, v44, v44, s42
    v_bitop3_b32 v49, v4, v13, v49 bitop3:0xca
    v_cos_f32 v9, v9
    v_lshl_add_u32 v11, v50, 11, s40
    v_lshrrev_b32 v12, 3, v54
    v_lshlrev_b16 v13, 3, v54
    v_bitop3_b32 v12, v6, v13, v12 bitop3:0xca
    v_bitop3_b32 v50, v3, v12, v11 bitop3:0xca
    v_lshrrev_b32 v11, 3, v11
    v_lshrrev_b32 v13, 2, v54
    v_bitop3_b32 v11, v5, v13, v11 bitop3:0xca
    v_and_b32 v54, 0x3fff, v11
    ds_add_u32 v54, v2
    v_cos_f32 v10, v10
    v_lshl_add_u32 v11, v51, 11, s40
    v_lshrrev_b32 v12, 3, v55
    v_lshlrev_b16 v13, 3, v55
    v_bitop3_b32 v12, v6, v13, v12 bitop3:0xca
    v_bitop3_b32 v51, v3, v12, v11 bitop3:0xca
    v_lshrrev_b32 v11, 3, v11
    v_lshrrev_b32 v13, 2, v55
    v_bitop3_b32 v11, v5, v13, v11 bitop3:0xca
    v_and_b32 v55, 0x3fff, v11
    ds_add_u32 v55, v2
    v_cvt_pk_bf16_f32 v45, v9, v10
    v_perm_b32 v12, v45, v45, s41
    v_bitop3_b32 v50, v4, v12, v50 bitop3:0xca
    v_perm_b32 v13, v45, v45, s42
    v_bitop3_b32 v51, v4, v13, v51 bitop3:0xca
    s_add_u32 s46, s35, 0x14000
    buffer_store_dwordx4 v[76:79], v0, s[20:23], s46 offen sc1
    s_add_u32 s47, s33, 0x3e84000
    s_nop 0
    buffer_load_dwordx4 v[76:79], v0, s[8:11], s47 offen nt
    s_waitcnt vmcnt(9)
    v_lshlrev_b32 v7, 16, v46
    v_and_b32 v8, 0xffff0000, v46
    v_lshlrev_b32 v9, 16, v47
    v_and_b32 v10, 0xffff0000, v47
    v_mul_f32 v7, 0.15915494, v7
    v_mul_f32 v8, 0.15915494, v8
    v_mul_f32 v9, 0.15915494, v9
    v_mul_f32 v10, 0.15915494, v10
    v_cos_f32 v7, v7
    v_lshl_add_u32 v11, v56, 11, s40
    v_lshrrev_b32 v12, 3, v60
    v_lshlrev_b16 v13, 3, v60
    v_bitop3_b32 v12, v6, v13, v12 bitop3:0xca
    v_bitop3_b32 v56, v3, v12, v11 bitop3:0xca
    v_lshrrev_b32 v11, 3, v11
    v_lshrrev_b32 v13, 2, v60
    v_bitop3_b32 v11, v5, v13, v11 bitop3:0xca
    v_and_b32 v60, 0x3fff, v11
    ds_add_u32 v60, v2
    v_cos_f32 v8, v8
    v_lshl_add_u32 v11, v57, 11, s40
    v_lshrrev_b32 v12, 3, v61
    v_lshlrev_b16 v13, 3, v61
    v_bitop3_b32 v12, v6, v13, v12 bitop3:0xca
    v_bitop3_b32 v57, v3, v12, v11 bitop3:0xca
    v_lshrrev_b32 v11, 3, v11
    v_lshrrev_b32 v13, 2, v61
    v_bitop3_b32 v11, v5, v13, v11 bitop3:0xca
    v_and_b32 v61, 0x3fff, v11
    ds_add_u32 v61, v2
    v_cvt_pk_bf16_f32 v46, v7, v8
    v_perm_b32 v12, v46, v46, s41
    v_bitop3_b32 v56, v4, v12, v56 bitop3:0xca
    v_perm_b32 v13, v46, v46, s42
    v_bitop3_b32 v57, v4, v13, v57 bitop3:0xca
    v_cos_f32 v9, v9
    v_lshl_add_u32 v11, v58, 11, s40
    v_lshrrev_b32 v12, 3, v62
    v_lshlrev_b16 v13, 3, v62
    v_bitop3_b32 v12, v6, v13, v12 bitop3:0xca
    v_bitop3_b32 v58, v3, v12, v11 bitop3:0xca
    v_lshrrev_b32 v11, 3, v11
    v_lshrrev_b32 v13, 2, v62
    v_bitop3_b32 v11, v5, v13, v11 bitop3:0xca
    v_and_b32 v62, 0x3fff, v11
    ds_add_u32 v62, v2
    v_cos_f32 v10, v10
    v_lshl_add_u32 v11, v59, 11, s40
    v_lshrrev_b32 v12, 3, v63
    v_lshlrev_b16 v13, 3, v63
    v_bitop3_b32 v12, v6, v13, v12 bitop3:0xca
    v_bitop3_b32 v59, v3, v12, v11 bitop3:0xca
    v_lshrrev_b32 v11, 3, v11
    v_lshrrev_b32 v13, 2, v63
    v_bitop3_b32 v11, v5, v13, v11 bitop3:0xca
    v_and_b32 v63, 0x3fff, v11
    ds_add_u32 v63, v2
    v_cvt_pk_bf16_f32 v47, v9, v10
    v_perm_b32 v12, v47, v47, s41
    v_bitop3_b32 v58, v4, v12, v58 bitop3:0xca
    v_perm_b32 v13, v47, v47, s42
    v_bitop3_b32 v59, v4, v13, v59 bitop3:0xca
    v_lshrrev_b32 v8, 2, v0
    v_and_b32 v7, 0x3c00, v0
    v_bitop3_b32 v7, v5, v8, v7 bitop3:0xea
    s_waitcnt lgkmcnt(0)
    s_barrier
    ds_read2st64_b32 v[8:9], v7 offset0:0 offset1:1
    ds_read2st64_b32 v[10:11], v7 offset0:2 offset1:3
    s_add_u32 s44, s35, 0x18000
    buffer_store_dwordx4 v[80:83], v0, s[20:23], s44 offen sc1
    s_add_u32 s45, s33, 0x3e84000
    s_nop 0
    buffer_load_dwordx4 v[80:83], v0, s[12:15], s45 offen nt
    s_waitcnt lgkmcnt(0)
    v_lshl_or_b32 v12, v9, 16, v8
    v_lshl_or_b32 v13, v11, 16, v10
    v_mov_b32 v14, v12
    v_mov_b32 v15, v13
    s_nop 0
    v_add_u32_dpp v14, v14, v14 row_shr:1 row_mask:0xf bank_mask:0xf bound_ctrl:1
    v_add_u32_dpp v15, v15, v15 row_shr:1 row_mask:0xf bank_mask:0xf bound_ctrl:1
    s_nop 0
    v_add_u32_dpp v14, v14, v14 row_shr:2 row_mask:0xf bank_mask:0xf bound_ctrl:1
    v_add_u32_dpp v15, v15, v15 row_shr:2 row_mask:0xf bank_mask:0xf bound_ctrl:1
    s_nop 0
    v_add_u32_dpp v14, v14, v14 row_shr:4 row_mask:0xf bank_mask:0xf bound_ctrl:1
    v_add_u32_dpp v15, v15, v15 row_shr:4 row_mask:0xf bank_mask:0xf bound_ctrl:1
    s_nop 0
    v_add_u32_dpp v14, v14, v14 row_shr:8 row_mask:0xf bank_mask:0xf bound_ctrl:1
    v_add_u32_dpp v15, v15, v15 row_shr:8 row_mask:0xf bank_mask:0xf bound_ctrl:1
    s_nop 0
    v_add_u32_dpp v14, v14, v14 row_bcast:15 row_mask:0xa bank_mask:0xf
    v_add_u32_dpp v15, v15, v15 row_bcast:15 row_mask:0xa bank_mask:0xf
    s_nop 0
    v_add_u32_dpp v14, v14, v14 row_bcast:31 row_mask:0xc bank_mask:0xf
    v_add_u32_dpp v15, v15, v15 row_bcast:31 row_mask:0xc bank_mask:0xf
    v_readlane_b32 s48, v14, 63
    v_readlane_b32 s49, v15, 63
    s_lshl_b32 s54, s32, 2
    v_mov_b32 v8, s54
    s_and_b32 s50, s48, 0xffff
    s_lshr_b32 s51, s48, 16
    s_and_b32 s52, s49, 0xffff
    s_lshr_b32 s53, s49, 16
    s_add_u32 s51, s51, s50
    s_add_u32 s52, s52, s51
    s_add_u32 s53, s53, s52
    v_mov_b32 v9, s53
    s_mov_b64 exec, 1
    ds_write_b32 v8, v9 offset:16384
    s_mov_b64 exec, -1
    v_and_b32 v8, 60, v7
    s_waitcnt lgkmcnt(0)
    s_barrier
    ds_read_b32 v9, v8 offset:16384
    s_waitcnt lgkmcnt(0)
    v_add_u32_dpp v9, v9, v9 row_shr:1 row_mask:0xf bank_mask:0xf bound_ctrl:1
    s_nop 1
    v_add_u32_dpp v9, v9, v9 row_shr:2 row_mask:0xf bank_mask:0xf bound_ctrl:1
    s_nop 1
    v_add_u32_dpp v9, v9, v9 row_shr:4 row_mask:0xf bank_mask:0xf bound_ctrl:1
    s_nop 1
    v_add_u32_dpp v9, v9, v9 row_shr:8 row_mask:0xf bank_mask:0xf bound_ctrl:1
    s_nop 0
    v_readlane_b32 s54, v9, s32
    s_sub_u32 s54, s54, s53
    s_add_u32 s50, s50, s54
    s_add_u32 s51, s51, s54
    s_add_u32 s52, s52, s54
    s_pack_ll_b32_b16 s48, s54, s50
    s_pack_ll_b32_b16 s49, s51, s52
    v_add_u32 v14, s48, v14
    v_add_u32 v15, s49, v15
    v_sub_u32 v12, v14, v12
    v_sub_u32 v13, v15, v13
    v_and_b32 v8, 0xffff, v12
    v_lshrrev_b32 v9, 16, v12
    v_and_b32 v10, 0xffff, v13
    v_lshrrev_b32 v11, 16, v13
    ds_write2st64_b32 v7, v8, v9 offset0:0 offset1:1
    ds_write2st64_b32 v7, v10, v11 offset0:2 offset1:3
    s_waitcnt lgkmcnt(0)
    s_barrier
    ds_add_rtn_u32 v100, v100, v2
    ds_add_rtn_u32 v101, v101, v2
    ds_add_rtn_u32 v102, v102, v2
    ds_add_rtn_u32 v103, v103, v2
    s_add_u32 s46, s36, 0x2942800
    buffer_store_dwordx2 v[12:13], v1, s[24:27], s46 offen
    s_bitset0_b64 exec, 63
    s_not_b64 exec, exec
    buffer_store_dwordx2 v[14:15], v1, s[24:27], s46 offen offset:8
    s_mov_b64 exec, -1
    ds_add_rtn_u32 v112, v112, v2
    ds_add_rtn_u32 v113, v113, v2
    ds_add_rtn_u32 v114, v114, v2
    ds_add_rtn_u32 v115, v115, v2
    ds_add_rtn_u32 v120, v120, v2
    ds_add_rtn_u32 v121, v121, v2
    ds_add_rtn_u32 v122, v122, v2
    ds_add_rtn_u32 v123, v123, v2
    s_add_u32 s47, s35, 0x1c000
    buffer_store_dwordx4 v[88:91], v0, s[20:23], s47 offen sc1
    s_add_u32 s44, s33, 0x3e88000
    s_nop 0
    buffer_load_dwordx4 v[88:91], v0, s[8:11], s44 offen nt
    ds_add_rtn_u32 v20, v20, v2
    ds_add_rtn_u32 v21, v21, v2
    ds_add_rtn_u32 v22, v22, v2
    ds_add_rtn_u32 v23, v23, v2
    ds_add_rtn_u32 v32, v32, v2
    ds_add_rtn_u32 v33, v33, v2
    ds_add_rtn_u32 v34, v34, v2
    ds_add_rtn_u32 v35, v35, v2
    s_add_u32 s45, s35, 0x20000
    buffer_store_dwordx4 v[92:95], v0, s[20:23], s45 offen sc1
    s_add_u32 s46, s33, 0x3e88000
    s_nop 0
    buffer_load_dwordx4 v[92:95], v0, s[12:15], s46 offen nt
    ds_add_rtn_u32 v40, v40, v2
    ds_add_rtn_u32 v41, v41, v2
    ds_add_rtn_u32 v42, v42, v2
    ds_add_rtn_u32 v43, v43, v2
    ds_add_rtn_u32 v52, v52, v2
    ds_add_rtn_u32 v53, v53, v2
    ds_add_rtn_u32 v54, v54, v2
    ds_add_rtn_u32 v55, v55, v2
    s_add_u32 s47, s35, 0x24000
    buffer_store_dwordx4 v[84:87], v0, s[20:23], s47 offen sc1
    s_add_u32 s44, s34, 0x1f44000
    s_nop 0
    buffer_load_dwordx2 v[84:85], v1, s[16:19], s44 offen nt
    s_add_u32 s45, s34, 0x1f46000
    buffer_load_dwordx2 v[86:87], v1, s[16:19], s45 offen nt
    ds_add_rtn_u32 v60, v60, v2
    ds_add_rtn_u32 v61, v61, v2
    ds_add_rtn_u32 v62, v62, v2
    ds_add_rtn_u32 v63, v63, v2
    s_waitcnt lgkmcnt(0)
    s_barrier
    v_and_b32 v7, -4, v100
    v_lshl_add_u32 v8, v100, 2, v7
    ds_write_b32 v8, v96
    v_lshl_add_u32 v7, v7, 2, v100
    ds_write_b8 v7, v104 offset:16
    v_and_b32 v9, -4, v101
    v_lshl_add_u32 v10, v101, 2, v9
    ds_write_b32 v10, v97
    v_lshl_add_u32 v9, v9, 2, v101
    ds_write_b8_d16_hi v9, v104 offset:16
    v_and_b32 v7, -4, v102
    v_lshl_add_u32 v8, v102, 2, v7
    ds_write_b32 v8, v98
    v_lshl_add_u32 v7, v7, 2, v102
    ds_write_b8 v7, v105 offset:16
    v_and_b32 v9, -4, v103
    v_lshl_add_u32 v10, v103, 2, v9
    ds_write_b32 v10, v99
    v_lshl_add_u32 v9, v9, 2, v103
    ds_write_b8_d16_hi v9, v105 offset:16
    s_add_u32 s46, s33, 0x3e8c000
    buffer_load_dwordx4 v[96:99], v0, s[8:11], s46 offen nt
    s_add_u32 s47, s33, 0x3e8c000
    buffer_load_dwordx4 v[100:103], v0, s[12:15], s47 offen nt
    v_and_b32 v7, -4, v112
    v_lshl_add_u32 v8, v112, 2, v7
    ds_write_b32 v8, v108
    v_lshl_add_u32 v7, v7, 2, v112
    ds_write_b8 v7, v106 offset:16
    v_and_b32 v9, -4, v113
    v_lshl_add_u32 v10, v113, 2, v9
    ds_write_b32 v10, v109
    v_lshl_add_u32 v9, v9, 2, v113
    ds_write_b8_d16_hi v9, v106 offset:16
    v_and_b32 v7, -4, v114
    v_lshl_add_u32 v8, v114, 2, v7
    ds_write_b32 v8, v110
    v_lshl_add_u32 v7, v7, 2, v114
    ds_write_b8 v7, v107 offset:16
    v_and_b32 v9, -4, v115
    v_lshl_add_u32 v10, v115, 2, v9
    ds_write_b32 v10, v111
    v_lshl_add_u32 v9, v9, 2, v115
    ds_write_b8_d16_hi v9, v107 offset:16
    s_add_u32 s44, s33, 0x3e90000
    buffer_load_dwordx4 v[108:111], v0, s[8:11], s44 offen nt
    v_and_b32 v7, -4, v120
    v_lshl_add_u32 v8, v120, 2, v7
    ds_write_b32 v8, v116
    v_lshl_add_u32 v7, v7, 2, v120
    ds_write_b8 v7, v124 offset:16
    v_and_b32 v9, -4, v121
    v_lshl_add_u32 v10, v121, 2, v9
    ds_write_b32 v10, v117
    v_lshl_add_u32 v9, v9, 2, v121
    ds_write_b8_d16_hi v9, v124 offset:16
    v_and_b32 v7, -4, v122
    v_lshl_add_u32 v8, v122, 2, v7
    ds_write_b32 v8, v118
    v_lshl_add_u32 v7, v7, 2, v122
    ds_write_b8 v7, v125 offset:16
    v_and_b32 v9, -4, v123
    v_lshl_add_u32 v10, v123, 2, v9
    ds_write_b32 v10, v119
    v_lshl_add_u32 v9, v9, 2, v123
    ds_write_b8_d16_hi v9, v125 offset:16
    s_add_u32 s45, s33, 0x3e90000
    buffer_load_dwordx4 v[112:115], v0, s[12:15], s45 offen nt
    v_and_b32 v7, -4, v20
    v_lshl_add_u32 v8, v20, 2, v7
    ds_write_b32 v8, v16
    v_lshl_add_u32 v7, v7, 2, v20
    ds_write_b8 v7, v126 offset:16
    v_and_b32 v9, -4, v21
    v_lshl_add_u32 v10, v21, 2, v9
    ds_write_b32 v10, v17
    v_lshl_add_u32 v9, v9, 2, v21
    ds_write_b8_d16_hi v9, v126 offset:16
    v_and_b32 v7, -4, v22
    v_lshl_add_u32 v8, v22, 2, v7
    ds_write_b32 v8, v18
    v_lshl_add_u32 v7, v7, 2, v22
    ds_write_b8 v7, v127 offset:16
    v_and_b32 v9, -4, v23
    v_lshl_add_u32 v10, v23, 2, v9
    ds_write_b32 v10, v19
    v_lshl_add_u32 v9, v9, 2, v23
    ds_write_b8_d16_hi v9, v127 offset:16
    s_add_u32 s46, s34, 0x1f48000
    buffer_load_dwordx2 v[104:105], v1, s[16:19], s46 offen nt
    s_add_u32 s47, s34, 0x1f4a000
    buffer_load_dwordx2 v[106:107], v1, s[16:19], s47 offen nt
    v_and_b32 v7, -4, v32
    v_lshl_add_u32 v8, v32, 2, v7
    ds_write_b32 v8, v28
    v_lshl_add_u32 v7, v7, 2, v32
    ds_write_b8 v7, v24 offset:16
    v_and_b32 v9, -4, v33
    v_lshl_add_u32 v10, v33, 2, v9
    ds_write_b32 v10, v29
    v_lshl_add_u32 v9, v9, 2, v33
    ds_write_b8_d16_hi v9, v24 offset:16
    v_and_b32 v7, -4, v34
    v_lshl_add_u32 v8, v34, 2, v7
    ds_write_b32 v8, v30
    v_lshl_add_u32 v7, v7, 2, v34
    ds_write_b8 v7, v25 offset:16
    v_and_b32 v9, -4, v35
    v_lshl_add_u32 v10, v35, 2, v9
    ds_write_b32 v10, v31
    v_lshl_add_u32 v9, v9, 2, v35
    ds_write_b8_d16_hi v9, v25 offset:16
    s_add_u32 s44, s33, 0x3e94000
    buffer_load_dwordx4 v[116:119], v0, s[8:11], s44 offen nt
    s_add_u32 s45, s33, 0x3e94000
    buffer_load_dwordx4 v[120:123], v0, s[12:15], s45 offen nt
    v_and_b32 v7, -4, v40
    v_lshl_add_u32 v8, v40, 2, v7
    ds_write_b32 v8, v36
    v_lshl_add_u32 v7, v7, 2, v40
    ds_write_b8 v7, v26 offset:16
    v_and_b32 v9, -4, v41
    v_lshl_add_u32 v10, v41, 2, v9
    ds_write_b32 v10, v37
    v_lshl_add_u32 v9, v9, 2, v41
    ds_write_b8_d16_hi v9, v26 offset:16
    v_and_b32 v7, -4, v42
    v_lshl_add_u32 v8, v42, 2, v7
    ds_write_b32 v8, v38
    v_lshl_add_u32 v7, v7, 2, v42
    ds_write_b8 v7, v27 offset:16
    v_and_b32 v9, -4, v43
    v_lshl_add_u32 v10, v43, 2, v9
    ds_write_b32 v10, v39
    v_lshl_add_u32 v9, v9, 2, v43
    ds_write_b8_d16_hi v9, v27 offset:16
    s_add_u32 s46, s33, 0x3e98000
    buffer_load_dwordx4 v[16:19], v0, s[8:11], s46 offen nt
    v_and_b32 v7, -4, v52
    v_lshl_add_u32 v8, v52, 2, v7
    ds_write_b32 v8, v48
    v_lshl_add_u32 v7, v7, 2, v52
    ds_write_b8 v7, v44 offset:16
    v_and_b32 v9, -4, v53
    v_lshl_add_u32 v10, v53, 2, v9
    ds_write_b32 v10, v49
    v_lshl_add_u32 v9, v9, 2, v53
    ds_write_b8_d16_hi v9, v44 offset:16
    v_and_b32 v7, -4, v54
    v_lshl_add_u32 v8, v54, 2, v7
    ds_write_b32 v8, v50
    v_lshl_add_u32 v7, v7, 2, v54
    ds_write_b8 v7, v45 offset:16
    v_and_b32 v9, -4, v55
    v_lshl_add_u32 v10, v55, 2, v9
    ds_write_b32 v10, v51
    v_lshl_add_u32 v9, v9, 2, v55
    ds_write_b8_d16_hi v9, v45 offset:16
    s_add_u32 s47, s33, 0x3e98000
    buffer_load_dwordx4 v[20:23], v0, s[12:15], s47 offen nt
    v_and_b32 v7, -4, v60
    v_lshl_add_u32 v8, v60, 2, v7
    ds_write_b32 v8, v56
    v_lshl_add_u32 v7, v7, 2, v60
    ds_write_b8 v7, v46 offset:16
    v_and_b32 v9, -4, v61
    v_lshl_add_u32 v10, v61, 2, v9
    ds_write_b32 v10, v57
    v_lshl_add_u32 v9, v9, 2, v61
    ds_write_b8_d16_hi v9, v46 offset:16
    v_and_b32 v7, -4, v62
    v_lshl_add_u32 v8, v62, 2, v7
    ds_write_b32 v8, v58
    v_lshl_add_u32 v7, v7, 2, v62
    ds_write_b8 v7, v47 offset:16
    v_and_b32 v9, -4, v63
    v_lshl_add_u32 v10, v63, 2, v9
    ds_write_b32 v10, v59
    v_lshl_add_u32 v9, v9, 2, v63
    ds_write_b8_d16_hi v9, v47 offset:16
    s_add_u32 s44, s34, 0x1f4c000
    buffer_load_dwordx2 v[124:125], v1, s[16:19], s44 offen nt
    s_add_u32 s45, s34, 0x1f4e000
    buffer_load_dwordx2 v[126:127], v1, s[16:19], s45 offen nt
    v_add_u32 v7, 0x10000, v0
    v_add_u32 v12, 0x20000, v0
    v_mov_b32 v8, 0
    v_mov_b32 v9, 0
    v_mov_b32 v10, 0
    v_mov_b32 v11, 0
    s_waitcnt lgkmcnt(0)
    s_barrier
    ds_read_b128 v[28:31], v0 offset:0
    ds_write_b128 v0, v[8:11]
    ds_read_b128 v[32:35], v0 offset:16384
    ds_read_b128 v[36:39], v0 offset:32768
    ds_read_b128 v[40:43], v0 offset:49152
    ds_read_b128 v[24:27], v7 offset:0
    ds_read_b128 v[48:51], v7 offset:16384
    ds_read_b128 v[52:55], v7 offset:32768
    ds_read_b128 v[56:59], v7 offset:49152
    ds_read_b128 v[60:63], v12 offset:0
    ds_read_b128 v[44:47], v12 offset:16384
    s_waitcnt lgkmcnt(0)
    s_barrier
    s_add_u32 s46, s35, 0x2942800
    buffer_store_dwordx4 v[28:31], v0, s[20:23], s46 offen sc1
    s_add_u32 s47, s33, 0x3e9c000
    s_nop 0
    buffer_load_dwordx4 v[28:31], v0, s[8:11], s47 offen nt
    s_add_u32 s44, s35, 0x2946800
    buffer_store_dwordx4 v[32:35], v0, s[20:23], s44 offen sc1
    s_add_u32 s45, s33, 0x3e9c000
    s_nop 0
    buffer_load_dwordx4 v[32:35], v0, s[12:15], s45 offen nt
    s_waitcnt vmcnt(29)
    v_lshlrev_b32 v7, 16, v64
    v_and_b32 v8, 0xffff0000, v64
    v_lshlrev_b32 v9, 16, v65
    v_and_b32 v10, 0xffff0000, v65
    v_mul_f32 v7, 0.15915494, v7
    v_mul_f32 v8, 0.15915494, v8
    v_mul_f32 v9, 0.15915494, v9
    v_mul_f32 v10, 0.15915494, v10
    v_cos_f32 v7, v7
    v_lshl_add_u32 v11, v68, 11, s40
    v_lshrrev_b32 v12, 3, v72
    v_lshlrev_b16 v13, 3, v72
    v_bitop3_b32 v12, v6, v13, v12 bitop3:0xca
    v_bitop3_b32 v68, v3, v12, v11 bitop3:0xca
    v_lshrrev_b32 v11, 3, v11
    v_lshrrev_b32 v13, 2, v72
    v_bitop3_b32 v11, v5, v13, v11 bitop3:0xca
    v_and_b32 v72, 0x3fff, v11
    ds_add_u32 v72, v2
    v_cos_f32 v8, v8
    v_lshl_add_u32 v11, v69, 11, s40
    v_lshrrev_b32 v12, 3, v73
    v_lshlrev_b16 v13, 3, v73
    v_bitop3_b32 v12, v6, v13, v12 bitop3:0xca
    v_bitop3_b32 v69, v3, v12, v11 bitop3:0xca
    v_lshrrev_b32 v11, 3, v11
    v_lshrrev_b32 v13, 2, v73
    v_bitop3_b32 v11, v5, v13, v11 bitop3:0xca
    v_and_b32 v73, 0x3fff, v11
    ds_add_u32 v73, v2
    v_cvt_pk_bf16_f32 v64, v7, v8
    v_perm_b32 v12, v64, v64, s41
    v_bitop3_b32 v68, v4, v12, v68 bitop3:0xca
    v_perm_b32 v13, v64, v64, s42
    v_bitop3_b32 v69, v4, v13, v69 bitop3:0xca
    v_cos_f32 v9, v9
    v_lshl_add_u32 v11, v70, 11, s40
    v_lshrrev_b32 v12, 3, v74
    v_lshlrev_b16 v13, 3, v74
    v_bitop3_b32 v12, v6, v13, v12 bitop3:0xca
    v_bitop3_b32 v70, v3, v12, v11 bitop3:0xca
    v_lshrrev_b32 v11, 3, v11
    v_lshrrev_b32 v13, 2, v74
    v_bitop3_b32 v11, v5, v13, v11 bitop3:0xca
    v_and_b32 v74, 0x3fff, v11
    ds_add_u32 v74, v2
    v_cos_f32 v10, v10
    v_lshl_add_u32 v11, v71, 11, s40
    v_lshrrev_b32 v12, 3, v75
    v_lshlrev_b16 v13, 3, v75
    v_bitop3_b32 v12, v6, v13, v12 bitop3:0xca
    v_bitop3_b32 v71, v3, v12, v11 bitop3:0xca
    v_lshrrev_b32 v11, 3, v11
    v_lshrrev_b32 v13, 2, v75
    v_bitop3_b32 v11, v5, v13, v11 bitop3:0xca
    v_and_b32 v75, 0x3fff, v11
    ds_add_u32 v75, v2
    v_cvt_pk_bf16_f32 v65, v9, v10
    v_perm_b32 v12, v65, v65, s41
    v_bitop3_b32 v70, v4, v12, v70 bitop3:0xca
    v_perm_b32 v13, v65, v65, s42
    v_bitop3_b32 v71, v4, v13, v71 bitop3:0xca
    s_add_u32 s46, s35, 0x294a800
    buffer_store_dwordx4 v[36:39], v0, s[20:23], s46 offen sc1
    s_add_u32 s47, s33, 0x5dc0000
    s_nop 0
    buffer_load_dwordx4 v[36:39], v0, s[8:11], s47 offen nt
    s_waitcnt vmcnt(27)
    v_lshlrev_b32 v7, 16, v66
    v_and_b32 v8, 0xffff0000, v66
    v_lshlrev_b32 v9, 16, v67
    v_and_b32 v10, 0xffff0000, v67
    v_mul_f32 v7, 0.15915494, v7
    v_mul_f32 v8, 0.15915494, v8
    v_mul_f32 v9, 0.15915494, v9
    v_mul_f32 v10, 0.15915494, v10
    v_cos_f32 v7, v7
    v_lshl_add_u32 v11, v76, 11, s40
    v_lshrrev_b32 v12, 3, v80
    v_lshlrev_b16 v13, 3, v80
    v_bitop3_b32 v12, v6, v13, v12 bitop3:0xca
    v_bitop3_b32 v76, v3, v12, v11 bitop3:0xca
    v_lshrrev_b32 v11, 3, v11
    v_lshrrev_b32 v13, 2, v80
    v_bitop3_b32 v11, v5, v13, v11 bitop3:0xca
    v_and_b32 v80, 0x3fff, v11
    ds_add_u32 v80, v2
    v_cos_f32 v8, v8
    v_lshl_add_u32 v11, v77, 11, s40
    v_lshrrev_b32 v12, 3, v81
    v_lshlrev_b16 v13, 3, v81
    v_bitop3_b32 v12, v6, v13, v12 bitop3:0xca
    v_bitop3_b32 v77, v3, v12, v11 bitop3:0xca
    v_lshrrev_b32 v11, 3, v11
    v_lshrrev_b32 v13, 2, v81
    v_bitop3_b32 v11, v5, v13, v11 bitop3:0xca
    v_and_b32 v81, 0x3fff, v11
    ds_add_u32 v81, v2
    v_cvt_pk_bf16_f32 v66, v7, v8
    v_perm_b32 v12, v66, v66, s41
    v_bitop3_b32 v76, v4, v12, v76 bitop3:0xca
    v_perm_b32 v13, v66, v66, s42
    v_bitop3_b32 v77, v4, v13, v77 bitop3:0xca
    v_cos_f32 v9, v9
    v_lshl_add_u32 v11, v78, 11, s40
    v_lshrrev_b32 v12, 3, v82
    v_lshlrev_b16 v13, 3, v82
    v_bitop3_b32 v12, v6, v13, v12 bitop3:0xca
    v_bitop3_b32 v78, v3, v12, v11 bitop3:0xca
    v_lshrrev_b32 v11, 3, v11
    v_lshrrev_b32 v13, 2, v82
    v_bitop3_b32 v11, v5, v13, v11 bitop3:0xca
    v_and_b32 v82, 0x3fff, v11
    ds_add_u32 v82, v2
    v_cos_f32 v10, v10
    v_lshl_add_u32 v11, v79, 11, s40
    v_lshrrev_b32 v12, 3, v83
    v_lshlrev_b16 v13, 3, v83
    v_bitop3_b32 v12, v6, v13, v12 bitop3:0xca
    v_bitop3_b32 v79, v3, v12, v11 bitop3:0xca
    v_lshrrev_b32 v11, 3, v11
    v_lshrrev_b32 v13, 2, v83
    v_bitop3_b32 v11, v5, v13, v11 bitop3:0xca
    v_and_b32 v83, 0x3fff, v11
    ds_add_u32 v83, v2
    v_cvt_pk_bf16_f32 v67, v9, v10
    v_perm_b32 v12, v67, v67, s41
    v_bitop3_b32 v78, v4, v12, v78 bitop3:0xca
    v_perm_b32 v13, v67, v67, s42
    v_bitop3_b32 v79, v4, v13, v79 bitop3:0xca
    s_waitcnt vmcnt(18)
    v_lshlrev_b32 v7, 16, v84
    v_and_b32 v8, 0xffff0000, v84
    v_lshlrev_b32 v9, 16, v85
    v_and_b32 v10, 0xffff0000, v85
    v_mul_f32 v7, 0.15915494, v7
    v_mul_f32 v8, 0.15915494, v8
    v_mul_f32 v9, 0.15915494, v9
    v_mul_f32 v10, 0.15915494, v10
    v_cos_f32 v7, v7
    v_lshl_add_u32 v11, v88, 11, s40
    v_lshrrev_b32 v12, 3, v92
    v_lshlrev_b16 v13, 3, v92
    v_bitop3_b32 v12, v6, v13, v12 bitop3:0xca
    v_bitop3_b32 v88, v3, v12, v11 bitop3:0xca
    v_lshrrev_b32 v11, 3, v11
    v_lshrrev_b32 v13, 2, v92
    v_bitop3_b32 v11, v5, v13, v11 bitop3:0xca
    v_and_b32 v92, 0x3fff, v11
    ds_add_u32 v92, v2
    v_cos_f32 v8, v8
    v_lshl_add_u32 v11, v89, 11, s40
    v_lshrrev_b32 v12, 3, v93
    v_lshlrev_b16 v13, 3, v93
    v_bitop3_b32 v12, v6, v13, v12 bitop3:0xca
    v_bitop3_b32 v89, v3, v12, v11 bitop3:0xca
    v_lshrrev_b32 v11, 3, v11
    v_lshrrev_b32 v13, 2, v93
    v_bitop3_b32 v11, v5, v13, v11 bitop3:0xca
    v_and_b32 v93, 0x3fff, v11
    ds_add_u32 v93, v2
    v_cvt_pk_bf16_f32 v84, v7, v8
    v_perm_b32 v12, v84, v84, s41
    v_bitop3_b32 v88, v4, v12, v88 bitop3:0xca
    v_perm_b32 v13, v84, v84, s42
    v_bitop3_b32 v89, v4, v13, v89 bitop3:0xca
    v_cos_f32 v9, v9
    v_lshl_add_u32 v11, v90, 11, s40
    v_lshrrev_b32 v12, 3, v94
    v_lshlrev_b16 v13, 3, v94
    v_bitop3_b32 v12, v6, v13, v12 bitop3:0xca
    v_bitop3_b32 v90, v3, v12, v11 bitop3:0xca
    v_lshrrev_b32 v11, 3, v11
    v_lshrrev_b32 v13, 2, v94
    v_bitop3_b32 v11, v5, v13, v11 bitop3:0xca
    v_and_b32 v94, 0x3fff, v11
    ds_add_u32 v94, v2
    v_cos_f32 v10, v10
    v_lshl_add_u32 v11, v91, 11, s40
    v_lshrrev_b32 v12, 3, v95
    v_lshlrev_b16 v13, 3, v95
    v_bitop3_b32 v12, v6, v13, v12 bitop3:0xca
    v_bitop3_b32 v91, v3, v12, v11 bitop3:0xca
    v_lshrrev_b32 v11, 3, v11
    v_lshrrev_b32 v13, 2, v95
    v_bitop3_b32 v11, v5, v13, v11 bitop3:0xca
    v_and_b32 v95, 0x3fff, v11
    ds_add_u32 v95, v2
    v_cvt_pk_bf16_f32 v85, v9, v10
    v_perm_b32 v12, v85, v85, s41
    v_bitop3_b32 v90, v4, v12, v90 bitop3:0xca
    v_perm_b32 v13, v85, v85, s42
    v_bitop3_b32 v91, v4, v13, v91 bitop3:0xca
    s_add_u32 s44, s35, 0x294e800
    buffer_store_dwordx4 v[40:43], v0, s[20:23], s44 offen sc1
    s_add_u32 s45, s33, 0x5dc0000
    s_nop 0
    buffer_load_dwordx4 v[40:43], v0, s[12:15], s45 offen nt
    s_waitcnt vmcnt(18)
    v_lshlrev_b32 v7, 16, v86
    v_and_b32 v8, 0xffff0000, v86
    v_lshlrev_b32 v9, 16, v87
    v_and_b32 v10, 0xffff0000, v87
    v_mul_f32 v7, 0.15915494, v7
    v_mul_f32 v8, 0.15915494, v8
    v_mul_f32 v9, 0.15915494, v9
    v_mul_f32 v10, 0.15915494, v10
    v_cos_f32 v7, v7
    v_lshl_add_u32 v11, v96, 11, s40
    v_lshrrev_b32 v12, 3, v100
    v_lshlrev_b16 v13, 3, v100
    v_bitop3_b32 v12, v6, v13, v12 bitop3:0xca
    v_bitop3_b32 v96, v3, v12, v11 bitop3:0xca
    v_lshrrev_b32 v11, 3, v11
    v_lshrrev_b32 v13, 2, v100
    v_bitop3_b32 v11, v5, v13, v11 bitop3:0xca
    v_and_b32 v100, 0x3fff, v11
    ds_add_u32 v100, v2
    v_cos_f32 v8, v8
    v_lshl_add_u32 v11, v97, 11, s40
    v_lshrrev_b32 v12, 3, v101
    v_lshlrev_b16 v13, 3, v101
    v_bitop3_b32 v12, v6, v13, v12 bitop3:0xca
    v_bitop3_b32 v97, v3, v12, v11 bitop3:0xca
    v_lshrrev_b32 v11, 3, v11
    v_lshrrev_b32 v13, 2, v101
    v_bitop3_b32 v11, v5, v13, v11 bitop3:0xca
    v_and_b32 v101, 0x3fff, v11
    ds_add_u32 v101, v2
    v_cvt_pk_bf16_f32 v86, v7, v8
    v_perm_b32 v12, v86, v86, s41
    v_bitop3_b32 v96, v4, v12, v96 bitop3:0xca
    v_perm_b32 v13, v86, v86, s42
    v_bitop3_b32 v97, v4, v13, v97 bitop3:0xca
    v_cos_f32 v9, v9
    v_lshl_add_u32 v11, v98, 11, s40
    v_lshrrev_b32 v12, 3, v102
    v_lshlrev_b16 v13, 3, v102
    v_bitop3_b32 v12, v6, v13, v12 bitop3:0xca
    v_bitop3_b32 v98, v3, v12, v11 bitop3:0xca
    v_lshrrev_b32 v11, 3, v11
    v_lshrrev_b32 v13, 2, v102
    v_bitop3_b32 v11, v5, v13, v11 bitop3:0xca
    v_and_b32 v102, 0x3fff, v11
    ds_add_u32 v102, v2
    v_cos_f32 v10, v10
    v_lshl_add_u32 v11, v99, 11, s40
    v_lshrrev_b32 v12, 3, v103
    v_lshlrev_b16 v13, 3, v103
    v_bitop3_b32 v12, v6, v13, v12 bitop3:0xca
    v_bitop3_b32 v99, v3, v12, v11 bitop3:0xca
    v_lshrrev_b32 v11, 3, v11
    v_lshrrev_b32 v13, 2, v103
    v_bitop3_b32 v11, v5, v13, v11 bitop3:0xca
    v_and_b32 v103, 0x3fff, v11
    ds_add_u32 v103, v2
    v_cvt_pk_bf16_f32 v87, v9, v10
    v_perm_b32 v12, v87, v87, s41
    v_bitop3_b32 v98, v4, v12, v98 bitop3:0xca
    v_perm_b32 v13, v87, v87, s42
    v_bitop3_b32 v99, v4, v13, v99 bitop3:0xca
    s_waitcnt vmcnt(14)
    v_lshlrev_b32 v7, 16, v104
    v_and_b32 v8, 0xffff0000, v104
    v_lshlrev_b32 v9, 16, v105
    v_and_b32 v10, 0xffff0000, v105
    v_mul_f32 v7, 0.15915494, v7
    v_mul_f32 v8, 0.15915494, v8
    v_mul_f32 v9, 0.15915494, v9
    v_mul_f32 v10, 0.15915494, v10
    v_cos_f32 v7, v7
    v_lshl_add_u32 v11, v108, 11, s40
    v_lshrrev_b32 v12, 3, v112
    v_lshlrev_b16 v13, 3, v112
    v_bitop3_b32 v12, v6, v13, v12 bitop3:0xca
    v_bitop3_b32 v108, v3, v12, v11 bitop3:0xca
    v_lshrrev_b32 v11, 3, v11
    v_lshrrev_b32 v13, 2, v112
    v_bitop3_b32 v11, v5, v13, v11 bitop3:0xca
    v_and_b32 v112, 0x3fff, v11
    ds_add_u32 v112, v2
    v_cos_f32 v8, v8
    v_lshl_add_u32 v11, v109, 11, s40
    v_lshrrev_b32 v12, 3, v113
    v_lshlrev_b16 v13, 3, v113
    v_bitop3_b32 v12, v6, v13, v12 bitop3:0xca
    v_bitop3_b32 v109, v3, v12, v11 bitop3:0xca
    v_lshrrev_b32 v11, 3, v11
    v_lshrrev_b32 v13, 2, v113
    v_bitop3_b32 v11, v5, v13, v11 bitop3:0xca
    v_and_b32 v113, 0x3fff, v11
    ds_add_u32 v113, v2
    v_cvt_pk_bf16_f32 v104, v7, v8
    v_perm_b32 v12, v104, v104, s41
    v_bitop3_b32 v108, v4, v12, v108 bitop3:0xca
    v_perm_b32 v13, v104, v104, s42
    v_bitop3_b32 v109, v4, v13, v109 bitop3:0xca
    v_cos_f32 v9, v9
    v_lshl_add_u32 v11, v110, 11, s40
    v_lshrrev_b32 v12, 3, v114
    v_lshlrev_b16 v13, 3, v114
    v_bitop3_b32 v12, v6, v13, v12 bitop3:0xca
    v_bitop3_b32 v110, v3, v12, v11 bitop3:0xca
    v_lshrrev_b32 v11, 3, v11
    v_lshrrev_b32 v13, 2, v114
    v_bitop3_b32 v11, v5, v13, v11 bitop3:0xca
    v_and_b32 v114, 0x3fff, v11
    ds_add_u32 v114, v2
    v_cos_f32 v10, v10
    v_lshl_add_u32 v11, v111, 11, s40
    v_lshrrev_b32 v12, 3, v115
    v_lshlrev_b16 v13, 3, v115
    v_bitop3_b32 v12, v6, v13, v12 bitop3:0xca
    v_bitop3_b32 v111, v3, v12, v11 bitop3:0xca
    v_lshrrev_b32 v11, 3, v11
    v_lshrrev_b32 v13, 2, v115
    v_bitop3_b32 v11, v5, v13, v11 bitop3:0xca
    v_and_b32 v115, 0x3fff, v11
    ds_add_u32 v115, v2
    v_cvt_pk_bf16_f32 v105, v9, v10
    v_perm_b32 v12, v105, v105, s41
    v_bitop3_b32 v110, v4, v12, v110 bitop3:0xca
    v_perm_b32 v13, v105, v105, s42
    v_bitop3_b32 v111, v4, v13, v111 bitop3:0xca
    s_add_u32 s46, s35, 0x2952800
    buffer_store_dwordx4 v[24:27], v0, s[20:23], s46 offen sc1
    s_add_u32 s47, s34, 0x2ee0000
    s_nop 0
    buffer_load_dwordx2 v[24:25], v1, s[16:19], s47 offen nt
    s_add_u32 s44, s34, 0x2ee2000
    buffer_load_dwordx2 v[26:27], v1, s[16:19], s44 offen nt
    s_waitcnt vmcnt(15)
    v_lshlrev_b32 v7, 16, v106
    v_and_b32 v8, 0xffff0000, v106
    v_lshlrev_b32 v9, 16, v107
    v_and_b32 v10, 0xffff0000, v107
    v_mul_f32 v7, 0.15915494, v7
    v_mul_f32 v8, 0.15915494, v8
    v_mul_f32 v9, 0.15915494, v9
    v_mul_f32 v10, 0.15915494, v10
    v_cos_f32 v7, v7
    v_lshl_add_u32 v11, v116, 11, s40
    v_lshrrev_b32 v12, 3, v120
    v_lshlrev_b16 v13, 3, v120
    v_bitop3_b32 v12, v6, v13, v12 bitop3:0xca
    v_bitop3_b32 v116, v3, v12, v11 bitop3:0xca
    v_lshrrev_b32 v11, 3, v11
    v_lshrrev_b32 v13, 2, v120
    v_bitop3_b32 v11, v5, v13, v11 bitop3:0xca
    v_and_b32 v120, 0x3fff, v11
    ds_add_u32 v120, v2
    v_cos_f32 v8, v8
    v_lshl_add_u32 v11, v117, 11, s40
    v_lshrrev_b32 v12, 3, v121
    v_lshlrev_b16 v13, 3, v121
    v_bitop3_b32 v12, v6, v13, v12 bitop3:0xca
    v_bitop3_b32 v117, v3, v12, v11 bitop3:0xca
    v_lshrrev_b32 v11, 3, v11
    v_lshrrev_b32 v13, 2, v121
    v_bitop3_b32 v11, v5, v13, v11 bitop3:0xca
    v_and_b32 v121, 0x3fff, v11
    ds_add_u32 v121, v2
    v_cvt_pk_bf16_f32 v106, v7, v8
    v_perm_b32 v12, v106, v106, s41
    v_bitop3_b32 v116, v4, v12, v116 bitop3:0xca
    v_perm_b32 v13, v106, v106, s42
    v_bitop3_b32 v117, v4, v13, v117 bitop3:0xca
    v_cos_f32 v9, v9
    v_lshl_add_u32 v11, v118, 11, s40
    v_lshrrev_b32 v12, 3, v122
    v_lshlrev_b16 v13, 3, v122
    v_bitop3_b32 v12, v6, v13, v12 bitop3:0xca
    v_bitop3_b32 v118, v3, v12, v11 bitop3:0xca
    v_lshrrev_b32 v11, 3, v11
    v_lshrrev_b32 v13, 2, v122
    v_bitop3_b32 v11, v5, v13, v11 bitop3:0xca
    v_and_b32 v122, 0x3fff, v11
    ds_add_u32 v122, v2
    v_cos_f32 v10, v10
    v_lshl_add_u32 v11, v119, 11, s40
    v_lshrrev_b32 v12, 3, v123
    v_lshlrev_b16 v13, 3, v123
    v_bitop3_b32 v12, v6, v13, v12 bitop3:0xca
    v_bitop3_b32 v119, v3, v12, v11 bitop3:0xca
    v_lshrrev_b32 v11, 3, v11
    v_lshrrev_b32 v13, 2, v123
    v_bitop3_b32 v11, v5, v13, v11 bitop3:0xca
    v_and_b32 v123, 0x3fff, v11
    ds_add_u32 v123, v2
    v_cvt_pk_bf16_f32 v107, v9, v10
    v_perm_b32 v12, v107, v107, s41
    v_bitop3_b32 v118, v4, v12, v118 bitop3:0xca
    v_perm_b32 v13, v107, v107, s42
    v_bitop3_b32 v119, v4, v13, v119 bitop3:0xca
    s_waitcnt vmcnt(11)
    v_lshlrev_b32 v7, 16, v124
    v_and_b32 v8, 0xffff0000, v124
    v_lshlrev_b32 v9, 16, v125
    v_and_b32 v10, 0xffff0000, v125
    v_mul_f32 v7, 0.15915494, v7
    v_mul_f32 v8, 0.15915494, v8
    v_mul_f32 v9, 0.15915494, v9
    v_mul_f32 v10, 0.15915494, v10
    v_cos_f32 v7, v7
    v_lshl_add_u32 v11, v16, 11, s40
    v_lshrrev_b32 v12, 3, v20
    v_lshlrev_b16 v13, 3, v20
    v_bitop3_b32 v12, v6, v13, v12 bitop3:0xca
    v_bitop3_b32 v16, v3, v12, v11 bitop3:0xca
    v_lshrrev_b32 v11, 3, v11
    v_lshrrev_b32 v13, 2, v20
    v_bitop3_b32 v11, v5, v13, v11 bitop3:0xca
    v_and_b32 v20, 0x3fff, v11
    ds_add_u32 v20, v2
    v_cos_f32 v8, v8
    v_lshl_add_u32 v11, v17, 11, s40
    v_lshrrev_b32 v12, 3, v21
    v_lshlrev_b16 v13, 3, v21
    v_bitop3_b32 v12, v6, v13, v12 bitop3:0xca
    v_bitop3_b32 v17, v3, v12, v11 bitop3:0xca
    v_lshrrev_b32 v11, 3, v11
    v_lshrrev_b32 v13, 2, v21
    v_bitop3_b32 v11, v5, v13, v11 bitop3:0xca
    v_and_b32 v21, 0x3fff, v11
    ds_add_u32 v21, v2
    v_cvt_pk_bf16_f32 v124, v7, v8
    v_perm_b32 v12, v124, v124, s41
    v_bitop3_b32 v16, v4, v12, v16 bitop3:0xca
    v_perm_b32 v13, v124, v124, s42
    v_bitop3_b32 v17, v4, v13, v17 bitop3:0xca
    v_cos_f32 v9, v9
    v_lshl_add_u32 v11, v18, 11, s40
    v_lshrrev_b32 v12, 3, v22
    v_lshlrev_b16 v13, 3, v22
    v_bitop3_b32 v12, v6, v13, v12 bitop3:0xca
    v_bitop3_b32 v18, v3, v12, v11 bitop3:0xca
    v_lshrrev_b32 v11, 3, v11
    v_lshrrev_b32 v13, 2, v22
    v_bitop3_b32 v11, v5, v13, v11 bitop3:0xca
    v_and_b32 v22, 0x3fff, v11
    ds_add_u32 v22, v2
    v_cos_f32 v10, v10
    v_lshl_add_u32 v11, v19, 11, s40
    v_lshrrev_b32 v12, 3, v23
    v_lshlrev_b16 v13, 3, v23
    v_bitop3_b32 v12, v6, v13, v12 bitop3:0xca
    v_bitop3_b32 v19, v3, v12, v11 bitop3:0xca
    v_lshrrev_b32 v11, 3, v11
    v_lshrrev_b32 v13, 2, v23
    v_bitop3_b32 v11, v5, v13, v11 bitop3:0xca
    v_and_b32 v23, 0x3fff, v11
    ds_add_u32 v23, v2
    v_cvt_pk_bf16_f32 v125, v9, v10
    v_perm_b32 v12, v125, v125, s41
    v_bitop3_b32 v18, v4, v12, v18 bitop3:0xca
    v_perm_b32 v13, v125, v125, s42
    v_bitop3_b32 v19, v4, v13, v19 bitop3:0xca
    s_add_u32 s45, s35, 0x2956800
    buffer_store_dwordx4 v[48:51], v0, s[20:23], s45 offen sc1
    s_add_u32 s46, s33, 0x5dc4000
    s_nop 0
    buffer_load_dwordx4 v[48:51], v0, s[8:11], s46 offen nt
    s_waitcnt vmcnt(9)
    v_lshlrev_b32 v7, 16, v126
    v_and_b32 v8, 0xffff0000, v126
    v_lshlrev_b32 v9, 16, v127
    v_and_b32 v10, 0xffff0000, v127
    v_mul_f32 v7, 0.15915494, v7
    v_mul_f32 v8, 0.15915494, v8
    v_mul_f32 v9, 0.15915494, v9
    v_mul_f32 v10, 0.15915494, v10
    v_cos_f32 v7, v7
    v_lshl_add_u32 v11, v28, 11, s40
    v_lshrrev_b32 v12, 3, v32
    v_lshlrev_b16 v13, 3, v32
    v_bitop3_b32 v12, v6, v13, v12 bitop3:0xca
    v_bitop3_b32 v28, v3, v12, v11 bitop3:0xca
    v_lshrrev_b32 v11, 3, v11
    v_lshrrev_b32 v13, 2, v32
    v_bitop3_b32 v11, v5, v13, v11 bitop3:0xca
    v_and_b32 v32, 0x3fff, v11
    ds_add_u32 v32, v2
    v_cos_f32 v8, v8
    v_lshl_add_u32 v11, v29, 11, s40
    v_lshrrev_b32 v12, 3, v33
    v_lshlrev_b16 v13, 3, v33
    v_bitop3_b32 v12, v6, v13, v12 bitop3:0xca
    v_bitop3_b32 v29, v3, v12, v11 bitop3:0xca
    v_lshrrev_b32 v11, 3, v11
    v_lshrrev_b32 v13, 2, v33
    v_bitop3_b32 v11, v5, v13, v11 bitop3:0xca
    v_and_b32 v33, 0x3fff, v11
    ds_add_u32 v33, v2
    v_cvt_pk_bf16_f32 v126, v7, v8
    v_perm_b32 v12, v126, v126, s41
    v_bitop3_b32 v28, v4, v12, v28 bitop3:0xca
    v_perm_b32 v13, v126, v126, s42
    v_bitop3_b32 v29, v4, v13, v29 bitop3:0xca
    v_cos_f32 v9, v9
    v_lshl_add_u32 v11, v30, 11, s40
    v_lshrrev_b32 v12, 3, v34
    v_lshlrev_b16 v13, 3, v34
    v_bitop3_b32 v12, v6, v13, v12 bitop3:0xca
    v_bitop3_b32 v30, v3, v12, v11 bitop3:0xca
    v_lshrrev_b32 v11, 3, v11
    v_lshrrev_b32 v13, 2, v34
    v_bitop3_b32 v11, v5, v13, v11 bitop3:0xca
    v_and_b32 v34, 0x3fff, v11
    ds_add_u32 v34, v2
    v_cos_f32 v10, v10
    v_lshl_add_u32 v11, v31, 11, s40
    v_lshrrev_b32 v12, 3, v35
    v_lshlrev_b16 v13, 3, v35
    v_bitop3_b32 v12, v6, v13, v12 bitop3:0xca
    v_bitop3_b32 v31, v3, v12, v11 bitop3:0xca
    v_lshrrev_b32 v11, 3, v11
    v_lshrrev_b32 v13, 2, v35
    v_bitop3_b32 v11, v5, v13, v11 bitop3:0xca
    v_and_b32 v35, 0x3fff, v11
    ds_add_u32 v35, v2
    v_cvt_pk_bf16_f32 v127, v9, v10
    v_perm_b32 v12, v127, v127, s41
    v_bitop3_b32 v30, v4, v12, v30 bitop3:0xca
    v_perm_b32 v13, v127, v127, s42
    v_bitop3_b32 v31, v4, v13, v31 bitop3:0xca
    v_lshrrev_b32 v8, 2, v0
    v_and_b32 v7, 0x3c00, v0
    v_bitop3_b32 v7, v5, v8, v7 bitop3:0xea
    s_waitcnt lgkmcnt(0)
    s_barrier
    ds_read2st64_b32 v[8:9], v7 offset0:0 offset1:1
    ds_read2st64_b32 v[10:11], v7 offset0:2 offset1:3
    s_add_u32 s47, s35, 0x295a800
    buffer_store_dwordx4 v[52:55], v0, s[20:23], s47 offen sc1
    s_add_u32 s44, s33, 0x5dc4000
    s_nop 0
    buffer_load_dwordx4 v[52:55], v0, s[12:15], s44 offen nt
    s_waitcnt lgkmcnt(0)
    v_lshl_or_b32 v12, v9, 16, v8
    v_lshl_or_b32 v13, v11, 16, v10
    v_mov_b32 v14, v12
    v_mov_b32 v15, v13
    s_nop 0
    v_add_u32_dpp v14, v14, v14 row_shr:1 row_mask:0xf bank_mask:0xf bound_ctrl:1
    v_add_u32_dpp v15, v15, v15 row_shr:1 row_mask:0xf bank_mask:0xf bound_ctrl:1
    s_nop 0
    v_add_u32_dpp v14, v14, v14 row_shr:2 row_mask:0xf bank_mask:0xf bound_ctrl:1
    v_add_u32_dpp v15, v15, v15 row_shr:2 row_mask:0xf bank_mask:0xf bound_ctrl:1
    s_nop 0
    v_add_u32_dpp v14, v14, v14 row_shr:4 row_mask:0xf bank_mask:0xf bound_ctrl:1
    v_add_u32_dpp v15, v15, v15 row_shr:4 row_mask:0xf bank_mask:0xf bound_ctrl:1
    s_nop 0
    v_add_u32_dpp v14, v14, v14 row_shr:8 row_mask:0xf bank_mask:0xf bound_ctrl:1
    v_add_u32_dpp v15, v15, v15 row_shr:8 row_mask:0xf bank_mask:0xf bound_ctrl:1
    s_nop 0
    v_add_u32_dpp v14, v14, v14 row_bcast:15 row_mask:0xa bank_mask:0xf
    v_add_u32_dpp v15, v15, v15 row_bcast:15 row_mask:0xa bank_mask:0xf
    s_nop 0
    v_add_u32_dpp v14, v14, v14 row_bcast:31 row_mask:0xc bank_mask:0xf
    v_add_u32_dpp v15, v15, v15 row_bcast:31 row_mask:0xc bank_mask:0xf
    v_readlane_b32 s48, v14, 63
    v_readlane_b32 s49, v15, 63
    s_lshl_b32 s54, s32, 2
    v_mov_b32 v8, s54
    s_and_b32 s50, s48, 0xffff
    s_lshr_b32 s51, s48, 16
    s_and_b32 s52, s49, 0xffff
    s_lshr_b32 s53, s49, 16
    s_add_u32 s51, s51, s50
    s_add_u32 s52, s52, s51
    s_add_u32 s53, s53, s52
    v_mov_b32 v9, s53
    s_mov_b64 exec, 1
    ds_write_b32 v8, v9 offset:16384
    s_mov_b64 exec, -1
    v_and_b32 v8, 60, v7
    s_waitcnt lgkmcnt(0)
    s_barrier
    ds_read_b32 v9, v8 offset:16384
    s_waitcnt lgkmcnt(0)
    v_add_u32_dpp v9, v9, v9 row_shr:1 row_mask:0xf bank_mask:0xf bound_ctrl:1
    s_nop 1
    v_add_u32_dpp v9, v9, v9 row_shr:2 row_mask:0xf bank_mask:0xf bound_ctrl:1
    s_nop 1
    v_add_u32_dpp v9, v9, v9 row_shr:4 row_mask:0xf bank_mask:0xf bound_ctrl:1
    s_nop 1
    v_add_u32_dpp v9, v9, v9 row_shr:8 row_mask:0xf bank_mask:0xf bound_ctrl:1
    s_nop 0
    v_readlane_b32 s54, v9, s32
    s_sub_u32 s54, s54, s53
    s_add_u32 s50, s50, s54
    s_add_u32 s51, s51, s54
    s_add_u32 s52, s52, s54
    s_pack_ll_b32_b16 s48, s54, s50
    s_pack_ll_b32_b16 s49, s51, s52
    v_add_u32 v14, s48, v14
    v_add_u32 v15, s49, v15
    v_sub_u32 v12, v14, v12
    v_sub_u32 v13, v15, v13
    v_and_b32 v8, 0xffff, v12
    v_lshrrev_b32 v9, 16, v12
    v_and_b32 v10, 0xffff, v13
    v_lshrrev_b32 v11, 16, v13
    ds_write2st64_b32 v7, v8, v9 offset0:0 offset1:1
    ds_write2st64_b32 v7, v10, v11 offset0:2 offset1:3
    s_waitcnt lgkmcnt(0)
    s_barrier
    ds_add_rtn_u32 v72, v72, v2
    ds_add_rtn_u32 v73, v73, v2
    ds_add_rtn_u32 v74, v74, v2
    ds_add_rtn_u32 v75, v75, v2
    s_add_u32 s45, s36, 0x5285000
    buffer_store_dwordx2 v[12:13], v1, s[24:27], s45 offen
    s_bitset0_b64 exec, 63
    s_not_b64 exec, exec
    buffer_store_dwordx2 v[14:15], v1, s[24:27], s45 offen offset:8
    s_mov_b64 exec, -1
    ds_add_rtn_u32 v80, v80, v2
    ds_add_rtn_u32 v81, v81, v2
    ds_add_rtn_u32 v82, v82, v2
    ds_add_rtn_u32 v83, v83, v2
    ds_add_rtn_u32 v92, v92, v2
    ds_add_rtn_u32 v93, v93, v2
    ds_add_rtn_u32 v94, v94, v2
    ds_add_rtn_u32 v95, v95, v2
    s_add_u32 s46, s35, 0x295e800
    buffer_store_dwordx4 v[56:59], v0, s[20:23], s46 offen sc1
    s_add_u32 s47, s33, 0x5dc8000
    s_nop 0
    buffer_load_dwordx4 v[56:59], v0, s[8:11], s47 offen nt
    ds_add_rtn_u32 v100, v100, v2
    ds_add_rtn_u32 v101, v101, v2
    ds_add_rtn_u32 v102, v102, v2
    ds_add_rtn_u32 v103, v103, v2
    ds_add_rtn_u32 v112, v112, v2
    ds_add_rtn_u32 v113, v113, v2
    ds_add_rtn_u32 v114, v114, v2
    ds_add_rtn_u32 v115, v115, v2
    s_add_u32 s44, s35, 0x2962800
    buffer_store_dwordx4 v[60:63], v0, s[20:23], s44 offen sc1
    s_add_u32 s45, s33, 0x5dc8000
    s_nop 0
    buffer_load_dwordx4 v[60:63], v0, s[12:15], s45 offen nt
    ds_add_rtn_u32 v120, v120, v2
    ds_add_rtn_u32 v121, v121, v2
    ds_add_rtn_u32 v122, v122, v2
    ds_add_rtn_u32 v123, v123, v2
    ds_add_rtn_u32 v20, v20, v2
    ds_add_rtn_u32 v21, v21, v2
    ds_add_rtn_u32 v22, v22, v2
    ds_add_rtn_u32 v23, v23, v2
    s_add_u32 s46, s35, 0x2966800
    buffer_store_dwordx4 v[44:47], v0, s[20:23], s46 offen sc1
    s_add_u32 s47, s34, 0x2ee4000
    s_nop 0
    buffer_load_dwordx2 v[44:45], v1, s[16:19], s47 offen nt
    s_add_u32 s44, s34, 0x2ee6000
    buffer_load_dwordx2 v[46:47], v1, s[16:19], s44 offen nt
    ds_add_rtn_u32 v32, v32, v2
    ds_add_rtn_u32 v33, v33, v2
    ds_add_rtn_u32 v34, v34, v2
    ds_add_rtn_u32 v35, v35, v2
    s_waitcnt lgkmcnt(0)
    s_barrier
    v_and_b32 v7, -4, v72
    v_lshl_add_u32 v8, v72, 2, v7
    ds_write_b32 v8, v68
    v_lshl_add_u32 v7, v7, 2, v72
    ds_write_b8 v7, v64 offset:16
    v_and_b32 v9, -4, v73
    v_lshl_add_u32 v10, v73, 2, v9
    ds_write_b32 v10, v69
    v_lshl_add_u32 v9, v9, 2, v73
    ds_write_b8_d16_hi v9, v64 offset:16
    v_and_b32 v7, -4, v74
    v_lshl_add_u32 v8, v74, 2, v7
    ds_write_b32 v8, v70
    v_lshl_add_u32 v7, v7, 2, v74
    ds_write_b8 v7, v65 offset:16
    v_and_b32 v9, -4, v75
    v_lshl_add_u32 v10, v75, 2, v9
    ds_write_b32 v10, v71
    v_lshl_add_u32 v9, v9, 2, v75
    ds_write_b8_d16_hi v9, v65 offset:16
    s_add_u32 s45, s33, 0x5dcc000
    buffer_load_dwordx4 v[68:71], v0, s[8:11], s45 offen nt
    s_add_u32 s46, s33, 0x5dcc000
    buffer_load_dwordx4 v[72:75], v0, s[12:15], s46 offen nt
    v_and_b32 v7, -4, v80
    v_lshl_add_u32 v8, v80, 2, v7
    ds_write_b32 v8, v76
    v_lshl_add_u32 v7, v7, 2, v80
    ds_write_b8 v7, v66 offset:16
    v_and_b32 v9, -4, v81
    v_lshl_add_u32 v10, v81, 2, v9
    ds_write_b32 v10, v77
    v_lshl_add_u32 v9, v9, 2, v81
    ds_write_b8_d16_hi v9, v66 offset:16
    v_and_b32 v7, -4, v82
    v_lshl_add_u32 v8, v82, 2, v7
    ds_write_b32 v8, v78
    v_lshl_add_u32 v7, v7, 2, v82
    ds_write_b8 v7, v67 offset:16
    v_and_b32 v9, -4, v83
    v_lshl_add_u32 v10, v83, 2, v9
    ds_write_b32 v10, v79
    v_lshl_add_u32 v9, v9, 2, v83
    ds_write_b8_d16_hi v9, v67 offset:16
    s_add_u32 s47, s33, 0x5dd0000
    buffer_load_dwordx4 v[76:79], v0, s[8:11], s47 offen nt
    v_and_b32 v7, -4, v92
    v_lshl_add_u32 v8, v92, 2, v7
    ds_write_b32 v8, v88
    v_lshl_add_u32 v7, v7, 2, v92
    ds_write_b8 v7, v84 offset:16
    v_and_b32 v9, -4, v93
    v_lshl_add_u32 v10, v93, 2, v9
    ds_write_b32 v10, v89
    v_lshl_add_u32 v9, v9, 2, v93
    ds_write_b8_d16_hi v9, v84 offset:16
    v_and_b32 v7, -4, v94
    v_lshl_add_u32 v8, v94, 2, v7
    ds_write_b32 v8, v90
    v_lshl_add_u32 v7, v7, 2, v94
    ds_write_b8 v7, v85 offset:16
    v_and_b32 v9, -4, v95
    v_lshl_add_u32 v10, v95, 2, v9
    ds_write_b32 v10, v91
    v_lshl_add_u32 v9, v9, 2, v95
    ds_write_b8_d16_hi v9, v85 offset:16
    s_add_u32 s44, s33, 0x5dd0000
    buffer_load_dwordx4 v[80:83], v0, s[12:15], s44 offen nt
    v_and_b32 v7, -4, v100
    v_lshl_add_u32 v8, v100, 2, v7
    ds_write_b32 v8, v96
    v_lshl_add_u32 v7, v7, 2, v100
    ds_write_b8 v7, v86 offset:16
    v_and_b32 v9, -4, v101
    v_lshl_add_u32 v10, v101, 2, v9
    ds_write_b32 v10, v97
    v_lshl_add_u32 v9, v9, 2, v101
    ds_write_b8_d16_hi v9, v86 offset:16
    v_and_b32 v7, -4, v102
    v_lshl_add_u32 v8, v102, 2, v7
    ds_write_b32 v8, v98
    v_lshl_add_u32 v7, v7, 2, v102
    ds_write_b8 v7, v87 offset:16
    v_and_b32 v9, -4, v103
    v_lshl_add_u32 v10, v103, 2, v9
    ds_write_b32 v10, v99
    v_lshl_add_u32 v9, v9, 2, v103
    ds_write_b8_d16_hi v9, v87 offset:16
    s_add_u32 s45, s34, 0x2ee8000
    buffer_load_dwordx2 v[64:65], v1, s[16:19], s45 offen nt
    s_add_u32 s46, s34, 0x2eea000
    buffer_load_dwordx2 v[66:67], v1, s[16:19], s46 offen nt
    v_and_b32 v7, -4, v112
    v_lshl_add_u32 v8, v112, 2, v7
    ds_write_b32 v8, v108
    v_lshl_add_u32 v7, v7, 2, v112
    ds_write_b8 v7, v104 offset:16
    v_and_b32 v9, -4, v113
    v_lshl_add_u32 v10, v113, 2, v9
    ds_write_b32 v10, v109
    v_lshl_add_u32 v9, v9, 2, v113
    ds_write_b8_d16_hi v9, v104 offset:16
    v_and_b32 v7, -4, v114
    v_lshl_add_u32 v8, v114, 2, v7
    ds_write_b32 v8, v110
    v_lshl_add_u32 v7, v7, 2, v114
    ds_write_b8 v7, v105 offset:16
    v_and_b32 v9, -4, v115
    v_lshl_add_u32 v10, v115, 2, v9
    ds_write_b32 v10, v111
    v_lshl_add_u32 v9, v9, 2, v115
    ds_write_b8_d16_hi v9, v105 offset:16
    s_add_u32 s47, s33, 0x5dd4000
    buffer_load_dwordx4 v[88:91], v0, s[8:11], s47 offen nt
    s_add_u32 s44, s33, 0x5dd4000
    buffer_load_dwordx4 v[92:95], v0, s[12:15], s44 offen nt
    v_and_b32 v7, -4, v120
    v_lshl_add_u32 v8, v120, 2, v7
    ds_write_b32 v8, v116
    v_lshl_add_u32 v7, v7, 2, v120
    ds_write_b8 v7, v106 offset:16
    v_and_b32 v9, -4, v121
    v_lshl_add_u32 v10, v121, 2, v9
    ds_write_b32 v10, v117
    v_lshl_add_u32 v9, v9, 2, v121
    ds_write_b8_d16_hi v9, v106 offset:16
    v_and_b32 v7, -4, v122
    v_lshl_add_u32 v8, v122, 2, v7
    ds_write_b32 v8, v118
    v_lshl_add_u32 v7, v7, 2, v122
    ds_write_b8 v7, v107 offset:16
    v_and_b32 v9, -4, v123
    v_lshl_add_u32 v10, v123, 2, v9
    ds_write_b32 v10, v119
    v_lshl_add_u32 v9, v9, 2, v123
    ds_write_b8_d16_hi v9, v107 offset:16
    s_add_u32 s45, s33, 0x5dd8000
    buffer_load_dwordx4 v[96:99], v0, s[8:11], s45 offen nt
    v_and_b32 v7, -4, v20
    v_lshl_add_u32 v8, v20, 2, v7
    ds_write_b32 v8, v16
    v_lshl_add_u32 v7, v7, 2, v20
    ds_write_b8 v7, v124 offset:16
    v_and_b32 v9, -4, v21
    v_lshl_add_u32 v10, v21, 2, v9
    ds_write_b32 v10, v17
    v_lshl_add_u32 v9, v9, 2, v21
    ds_write_b8_d16_hi v9, v124 offset:16
    v_and_b32 v7, -4, v22
    v_lshl_add_u32 v8, v22, 2, v7
    ds_write_b32 v8, v18
    v_lshl_add_u32 v7, v7, 2, v22
    ds_write_b8 v7, v125 offset:16
    v_and_b32 v9, -4, v23
    v_lshl_add_u32 v10, v23, 2, v9
    ds_write_b32 v10, v19
    v_lshl_add_u32 v9, v9, 2, v23
    ds_write_b8_d16_hi v9, v125 offset:16
    s_add_u32 s46, s33, 0x5dd8000
    buffer_load_dwordx4 v[100:103], v0, s[12:15], s46 offen nt
    v_and_b32 v7, -4, v32
    v_lshl_add_u32 v8, v32, 2, v7
    ds_write_b32 v8, v28
    v_lshl_add_u32 v7, v7, 2, v32
    ds_write_b8 v7, v126 offset:16
    v_and_b32 v9, -4, v33
    v_lshl_add_u32 v10, v33, 2, v9
    ds_write_b32 v10, v29
    v_lshl_add_u32 v9, v9, 2, v33
    ds_write_b8_d16_hi v9, v126 offset:16
    v_and_b32 v7, -4, v34
    v_lshl_add_u32 v8, v34, 2, v7
    ds_write_b32 v8, v30
    v_lshl_add_u32 v7, v7, 2, v34
    ds_write_b8 v7, v127 offset:16
    v_and_b32 v9, -4, v35
    v_lshl_add_u32 v10, v35, 2, v9
    ds_write_b32 v10, v31
    v_lshl_add_u32 v9, v9, 2, v35
    ds_write_b8_d16_hi v9, v127 offset:16
    s_add_u32 s47, s34, 0x2eec000
    buffer_load_dwordx2 v[84:85], v1, s[16:19], s47 offen nt
    s_add_u32 s44, s34, 0x2eee000
    buffer_load_dwordx2 v[86:87], v1, s[16:19], s44 offen nt
    v_add_u32 v7, 0x10000, v0
    v_add_u32 v12, 0x20000, v0
    v_mov_b32 v8, 0
    v_mov_b32 v9, 0
    v_mov_b32 v10, 0
    v_mov_b32 v11, 0
    s_waitcnt lgkmcnt(0)
    s_barrier
    ds_read_b128 v[108:111], v0 offset:0
    ds_write_b128 v0, v[8:11]
    ds_read_b128 v[112:115], v0 offset:16384
    ds_read_b128 v[116:119], v0 offset:32768
    ds_read_b128 v[120:123], v0 offset:49152
    ds_read_b128 v[104:107], v7 offset:0
    ds_read_b128 v[16:19], v7 offset:16384
    ds_read_b128 v[20:23], v7 offset:32768
    ds_read_b128 v[28:31], v7 offset:49152
    ds_read_b128 v[32:35], v12 offset:0
    ds_read_b128 v[124:127], v12 offset:16384
    s_waitcnt lgkmcnt(0)
    s_barrier
    s_add_u32 s45, s35, 0x5285000
    buffer_store_dwordx4 v[108:111], v0, s[20:23], s45 offen sc1
    s_add_u32 s46, s33, 0x5ddc000
    s_nop 0
    buffer_load_dwordx4 v[108:111], v0, s[8:11], s46 offen nt
    s_add_u32 s47, s35, 0x5289000
    buffer_store_dwordx4 v[112:115], v0, s[20:23], s47 offen sc1
    s_add_u32 s44, s33, 0x5ddc000
    s_nop 0
    buffer_load_dwordx4 v[112:115], v0, s[12:15], s44 offen nt
    s_waitcnt vmcnt(29)
    v_lshlrev_b32 v7, 16, v24
    v_and_b32 v8, 0xffff0000, v24
    v_lshlrev_b32 v9, 16, v25
    v_and_b32 v10, 0xffff0000, v25
    v_mul_f32 v7, 0.15915494, v7
    v_mul_f32 v8, 0.15915494, v8
    v_mul_f32 v9, 0.15915494, v9
    v_mul_f32 v10, 0.15915494, v10
    v_cos_f32 v7, v7
    v_lshl_add_u32 v11, v36, 11, s40
    v_lshrrev_b32 v12, 3, v40
    v_lshlrev_b16 v13, 3, v40
    v_bitop3_b32 v12, v6, v13, v12 bitop3:0xca
    v_bitop3_b32 v36, v3, v12, v11 bitop3:0xca
    v_lshrrev_b32 v11, 3, v11
    v_lshrrev_b32 v13, 2, v40
    v_bitop3_b32 v11, v5, v13, v11 bitop3:0xca
    v_and_b32 v40, 0x3fff, v11
    ds_add_u32 v40, v2
    v_cos_f32 v8, v8
    v_lshl_add_u32 v11, v37, 11, s40
    v_lshrrev_b32 v12, 3, v41
    v_lshlrev_b16 v13, 3, v41
    v_bitop3_b32 v12, v6, v13, v12 bitop3:0xca
    v_bitop3_b32 v37, v3, v12, v11 bitop3:0xca
    v_lshrrev_b32 v11, 3, v11
    v_lshrrev_b32 v13, 2, v41
    v_bitop3_b32 v11, v5, v13, v11 bitop3:0xca
    v_and_b32 v41, 0x3fff, v11
    ds_add_u32 v41, v2
    v_cvt_pk_bf16_f32 v24, v7, v8
    v_perm_b32 v12, v24, v24, s41
    v_bitop3_b32 v36, v4, v12, v36 bitop3:0xca
    v_perm_b32 v13, v24, v24, s42
    v_bitop3_b32 v37, v4, v13, v37 bitop3:0xca
    v_cos_f32 v9, v9
    v_lshl_add_u32 v11, v38, 11, s40
    v_lshrrev_b32 v12, 3, v42
    v_lshlrev_b16 v13, 3, v42
    v_bitop3_b32 v12, v6, v13, v12 bitop3:0xca
    v_bitop3_b32 v38, v3, v12, v11 bitop3:0xca
    v_lshrrev_b32 v11, 3, v11
    v_lshrrev_b32 v13, 2, v42
    v_bitop3_b32 v11, v5, v13, v11 bitop3:0xca
    v_and_b32 v42, 0x3fff, v11
    ds_add_u32 v42, v2
    v_cos_f32 v10, v10
    v_lshl_add_u32 v11, v39, 11, s40
    v_lshrrev_b32 v12, 3, v43
    v_lshlrev_b16 v13, 3, v43
    v_bitop3_b32 v12, v6, v13, v12 bitop3:0xca
    v_bitop3_b32 v39, v3, v12, v11 bitop3:0xca
    v_lshrrev_b32 v11, 3, v11
    v_lshrrev_b32 v13, 2, v43
    v_bitop3_b32 v11, v5, v13, v11 bitop3:0xca
    v_and_b32 v43, 0x3fff, v11
    ds_add_u32 v43, v2
    v_cvt_pk_bf16_f32 v25, v9, v10
    v_perm_b32 v12, v25, v25, s41
    v_bitop3_b32 v38, v4, v12, v38 bitop3:0xca
    v_perm_b32 v13, v25, v25, s42
    v_bitop3_b32 v39, v4, v13, v39 bitop3:0xca
    s_add_u32 s45, s35, 0x528d000
    buffer_store_dwordx4 v[116:119], v0, s[20:23], s45 offen sc1
    s_add_u32 s46, s33, 0x7d00000
    s_nop 0
    buffer_load_dwordx4 v[116:119], v0, s[8:11], s46 offen nt
    s_waitcnt vmcnt(27)
    v_lshlrev_b32 v7, 16, v26
    v_and_b32 v8, 0xffff0000, v26
    v_lshlrev_b32 v9, 16, v27
    v_and_b32 v10, 0xffff0000, v27
    v_mul_f32 v7, 0.15915494, v7
    v_mul_f32 v8, 0.15915494, v8
    v_mul_f32 v9, 0.15915494, v9
    v_mul_f32 v10, 0.15915494, v10
    v_cos_f32 v7, v7
    v_lshl_add_u32 v11, v48, 11, s40
    v_lshrrev_b32 v12, 3, v52
    v_lshlrev_b16 v13, 3, v52
    v_bitop3_b32 v12, v6, v13, v12 bitop3:0xca
    v_bitop3_b32 v48, v3, v12, v11 bitop3:0xca
    v_lshrrev_b32 v11, 3, v11
    v_lshrrev_b32 v13, 2, v52
    v_bitop3_b32 v11, v5, v13, v11 bitop3:0xca
    v_and_b32 v52, 0x3fff, v11
    ds_add_u32 v52, v2
    v_cos_f32 v8, v8
    v_lshl_add_u32 v11, v49, 11, s40
    v_lshrrev_b32 v12, 3, v53
    v_lshlrev_b16 v13, 3, v53
    v_bitop3_b32 v12, v6, v13, v12 bitop3:0xca
    v_bitop3_b32 v49, v3, v12, v11 bitop3:0xca
    v_lshrrev_b32 v11, 3, v11
    v_lshrrev_b32 v13, 2, v53
    v_bitop3_b32 v11, v5, v13, v11 bitop3:0xca
    v_and_b32 v53, 0x3fff, v11
    ds_add_u32 v53, v2
    v_cvt_pk_bf16_f32 v26, v7, v8
    v_perm_b32 v12, v26, v26, s41
    v_bitop3_b32 v48, v4, v12, v48 bitop3:0xca
    v_perm_b32 v13, v26, v26, s42
    v_bitop3_b32 v49, v4, v13, v49 bitop3:0xca
    v_cos_f32 v9, v9
    v_lshl_add_u32 v11, v50, 11, s40
    v_lshrrev_b32 v12, 3, v54
    v_lshlrev_b16 v13, 3, v54
    v_bitop3_b32 v12, v6, v13, v12 bitop3:0xca
    v_bitop3_b32 v50, v3, v12, v11 bitop3:0xca
    v_lshrrev_b32 v11, 3, v11
    v_lshrrev_b32 v13, 2, v54
    v_bitop3_b32 v11, v5, v13, v11 bitop3:0xca
    v_and_b32 v54, 0x3fff, v11
    ds_add_u32 v54, v2
    v_cos_f32 v10, v10
    v_lshl_add_u32 v11, v51, 11, s40
    v_lshrrev_b32 v12, 3, v55
    v_lshlrev_b16 v13, 3, v55
    v_bitop3_b32 v12, v6, v13, v12 bitop3:0xca
    v_bitop3_b32 v51, v3, v12, v11 bitop3:0xca
    v_lshrrev_b32 v11, 3, v11
    v_lshrrev_b32 v13, 2, v55
    v_bitop3_b32 v11, v5, v13, v11 bitop3:0xca
    v_and_b32 v55, 0x3fff, v11
    ds_add_u32 v55, v2
    v_cvt_pk_bf16_f32 v27, v9, v10
    v_perm_b32 v12, v27, v27, s41
    v_bitop3_b32 v50, v4, v12, v50 bitop3:0xca
    v_perm_b32 v13, v27, v27, s42
    v_bitop3_b32 v51, v4, v13, v51 bitop3:0xca
    s_waitcnt vmcnt(18)
    v_lshlrev_b32 v7, 16, v44
    v_and_b32 v8, 0xffff0000, v44
    v_lshlrev_b32 v9, 16, v45
    v_and_b32 v10, 0xffff0000, v45
    v_mul_f32 v7, 0.15915494, v7
    v_mul_f32 v8, 0.15915494, v8
    v_mul_f32 v9, 0.15915494, v9
    v_mul_f32 v10, 0.15915494, v10
    v_cos_f32 v7, v7
    v_lshl_add_u32 v11, v56, 11, s40
    v_lshrrev_b32 v12, 3, v60
    v_lshlrev_b16 v13, 3, v60
    v_bitop3_b32 v12, v6, v13, v12 bitop3:0xca
    v_bitop3_b32 v56, v3, v12, v11 bitop3:0xca
    v_lshrrev_b32 v11, 3, v11
    v_lshrrev_b32 v13, 2, v60
    v_bitop3_b32 v11, v5, v13, v11 bitop3:0xca
    v_and_b32 v60, 0x3fff, v11
    ds_add_u32 v60, v2
    v_cos_f32 v8, v8
    v_lshl_add_u32 v11, v57, 11, s40
    v_lshrrev_b32 v12, 3, v61
    v_lshlrev_b16 v13, 3, v61
    v_bitop3_b32 v12, v6, v13, v12 bitop3:0xca
    v_bitop3_b32 v57, v3, v12, v11 bitop3:0xca
    v_lshrrev_b32 v11, 3, v11
    v_lshrrev_b32 v13, 2, v61
    v_bitop3_b32 v11, v5, v13, v11 bitop3:0xca
    v_and_b32 v61, 0x3fff, v11
    ds_add_u32 v61, v2
    v_cvt_pk_bf16_f32 v44, v7, v8
    v_perm_b32 v12, v44, v44, s41
    v_bitop3_b32 v56, v4, v12, v56 bitop3:0xca
    v_perm_b32 v13, v44, v44, s42
    v_bitop3_b32 v57, v4, v13, v57 bitop3:0xca
    v_cos_f32 v9, v9
    v_lshl_add_u32 v11, v58, 11, s40
    v_lshrrev_b32 v12, 3, v62
    v_lshlrev_b16 v13, 3, v62
    v_bitop3_b32 v12, v6, v13, v12 bitop3:0xca
    v_bitop3_b32 v58, v3, v12, v11 bitop3:0xca
    v_lshrrev_b32 v11, 3, v11
    v_lshrrev_b32 v13, 2, v62
    v_bitop3_b32 v11, v5, v13, v11 bitop3:0xca
    v_and_b32 v62, 0x3fff, v11
    ds_add_u32 v62, v2
    v_cos_f32 v10, v10
    v_lshl_add_u32 v11, v59, 11, s40
    v_lshrrev_b32 v12, 3, v63
    v_lshlrev_b16 v13, 3, v63
    v_bitop3_b32 v12, v6, v13, v12 bitop3:0xca
    v_bitop3_b32 v59, v3, v12, v11 bitop3:0xca
    v_lshrrev_b32 v11, 3, v11
    v_lshrrev_b32 v13, 2, v63
    v_bitop3_b32 v11, v5, v13, v11 bitop3:0xca
    v_and_b32 v63, 0x3fff, v11
    ds_add_u32 v63, v2
    v_cvt_pk_bf16_f32 v45, v9, v10
    v_perm_b32 v12, v45, v45, s41
    v_bitop3_b32 v58, v4, v12, v58 bitop3:0xca
    v_perm_b32 v13, v45, v45, s42
    v_bitop3_b32 v59, v4, v13, v59 bitop3:0xca
    s_add_u32 s47, s35, 0x5291000
    buffer_store_dwordx4 v[120:123], v0, s[20:23], s47 offen sc1
    s_add_u32 s44, s33, 0x7d00000
    s_nop 0
    buffer_load_dwordx4 v[120:123], v0, s[12:15], s44 offen nt
    s_waitcnt vmcnt(18)
    v_lshlrev_b32 v7, 16, v46
    v_and_b32 v8, 0xffff0000, v46
    v_lshlrev_b32 v9, 16, v47
    v_and_b32 v10, 0xffff0000, v47
    v_mul_f32 v7, 0.15915494, v7
    v_mul_f32 v8, 0.15915494, v8
    v_mul_f32 v9, 0.15915494, v9
    v_mul_f32 v10, 0.15915494, v10
    v_cos_f32 v7, v7
    v_lshl_add_u32 v11, v68, 11, s40
    v_lshrrev_b32 v12, 3, v72
    v_lshlrev_b16 v13, 3, v72
    v_bitop3_b32 v12, v6, v13, v12 bitop3:0xca
    v_bitop3_b32 v68, v3, v12, v11 bitop3:0xca
    v_lshrrev_b32 v11, 3, v11
    v_lshrrev_b32 v13, 2, v72
    v_bitop3_b32 v11, v5, v13, v11 bitop3:0xca
    v_and_b32 v72, 0x3fff, v11
    ds_add_u32 v72, v2
    v_cos_f32 v8, v8
    v_lshl_add_u32 v11, v69, 11, s40
    v_lshrrev_b32 v12, 3, v73
    v_lshlrev_b16 v13, 3, v73
    v_bitop3_b32 v12, v6, v13, v12 bitop3:0xca
    v_bitop3_b32 v69, v3, v12, v11 bitop3:0xca
    v_lshrrev_b32 v11, 3, v11
    v_lshrrev_b32 v13, 2, v73
    v_bitop3_b32 v11, v5, v13, v11 bitop3:0xca
    v_and_b32 v73, 0x3fff, v11
    ds_add_u32 v73, v2
    v_cvt_pk_bf16_f32 v46, v7, v8
    v_perm_b32 v12, v46, v46, s41
    v_bitop3_b32 v68, v4, v12, v68 bitop3:0xca
    v_perm_b32 v13, v46, v46, s42
    v_bitop3_b32 v69, v4, v13, v69 bitop3:0xca
    v_cos_f32 v9, v9
    v_lshl_add_u32 v11, v70, 11, s40
    v_lshrrev_b32 v12, 3, v74
    v_lshlrev_b16 v13, 3, v74
    v_bitop3_b32 v12, v6, v13, v12 bitop3:0xca
    v_bitop3_b32 v70, v3, v12, v11 bitop3:0xca
    v_lshrrev_b32 v11, 3, v11
    v_lshrrev_b32 v13, 2, v74
    v_bitop3_b32 v11, v5, v13, v11 bitop3:0xca
    v_and_b32 v74, 0x3fff, v11
    ds_add_u32 v74, v2
    v_cos_f32 v10, v10
    v_lshl_add_u32 v11, v71, 11, s40
    v_lshrrev_b32 v12, 3, v75
    v_lshlrev_b16 v13, 3, v75
    v_bitop3_b32 v12, v6, v13, v12 bitop3:0xca
    v_bitop3_b32 v71, v3, v12, v11 bitop3:0xca
    v_lshrrev_b32 v11, 3, v11
    v_lshrrev_b32 v13, 2, v75
    v_bitop3_b32 v11, v5, v13, v11 bitop3:0xca
    v_and_b32 v75, 0x3fff, v11
    ds_add_u32 v75, v2
    v_cvt_pk_bf16_f32 v47, v9, v10
    v_perm_b32 v12, v47, v47, s41
    v_bitop3_b32 v70, v4, v12, v70 bitop3:0xca
    v_perm_b32 v13, v47, v47, s42
    v_bitop3_b32 v71, v4, v13, v71 bitop3:0xca
    s_waitcnt vmcnt(14)
    v_lshlrev_b32 v7, 16, v64
    v_and_b32 v8, 0xffff0000, v64
    v_lshlrev_b32 v9, 16, v65
    v_and_b32 v10, 0xffff0000, v65
    v_mul_f32 v7, 0.15915494, v7
    v_mul_f32 v8, 0.15915494, v8
    v_mul_f32 v9, 0.15915494, v9
    v_mul_f32 v10, 0.15915494, v10
    v_cos_f32 v7, v7
    v_lshl_add_u32 v11, v76, 11, s40
    v_lshrrev_b32 v12, 3, v80
    v_lshlrev_b16 v13, 3, v80
    v_bitop3_b32 v12, v6, v13, v12 bitop3:0xca
    v_bitop3_b32 v76, v3, v12, v11 bitop3:0xca
    v_lshrrev_b32 v11, 3, v11
    v_lshrrev_b32 v13, 2, v80
    v_bitop3_b32 v11, v5, v13, v11 bitop3:0xca
    v_and_b32 v80, 0x3fff, v11
    ds_add_u32 v80, v2
    v_cos_f32 v8, v8
    v_lshl_add_u32 v11, v77, 11, s40
    v_lshrrev_b32 v12, 3, v81
    v_lshlrev_b16 v13, 3, v81
    v_bitop3_b32 v12, v6, v13, v12 bitop3:0xca
    v_bitop3_b32 v77, v3, v12, v11 bitop3:0xca
    v_lshrrev_b32 v11, 3, v11
    v_lshrrev_b32 v13, 2, v81
    v_bitop3_b32 v11, v5, v13, v11 bitop3:0xca
    v_and_b32 v81, 0x3fff, v11
    ds_add_u32 v81, v2
    v_cvt_pk_bf16_f32 v64, v7, v8
    v_perm_b32 v12, v64, v64, s41
    v_bitop3_b32 v76, v4, v12, v76 bitop3:0xca
    v_perm_b32 v13, v64, v64, s42
    v_bitop3_b32 v77, v4, v13, v77 bitop3:0xca
    v_cos_f32 v9, v9
    v_lshl_add_u32 v11, v78, 11, s40
    v_lshrrev_b32 v12, 3, v82
    v_lshlrev_b16 v13, 3, v82
    v_bitop3_b32 v12, v6, v13, v12 bitop3:0xca
    v_bitop3_b32 v78, v3, v12, v11 bitop3:0xca
    v_lshrrev_b32 v11, 3, v11
    v_lshrrev_b32 v13, 2, v82
    v_bitop3_b32 v11, v5, v13, v11 bitop3:0xca
    v_and_b32 v82, 0x3fff, v11
    ds_add_u32 v82, v2
    v_cos_f32 v10, v10
    v_lshl_add_u32 v11, v79, 11, s40
    v_lshrrev_b32 v12, 3, v83
    v_lshlrev_b16 v13, 3, v83
    v_bitop3_b32 v12, v6, v13, v12 bitop3:0xca
    v_bitop3_b32 v79, v3, v12, v11 bitop3:0xca
    v_lshrrev_b32 v11, 3, v11
    v_lshrrev_b32 v13, 2, v83
    v_bitop3_b32 v11, v5, v13, v11 bitop3:0xca
    v_and_b32 v83, 0x3fff, v11
    ds_add_u32 v83, v2
    v_cvt_pk_bf16_f32 v65, v9, v10
    v_perm_b32 v12, v65, v65, s41
    v_bitop3_b32 v78, v4, v12, v78 bitop3:0xca
    v_perm_b32 v13, v65, v65, s42
    v_bitop3_b32 v79, v4, v13, v79 bitop3:0xca
    s_add_u32 s45, s35, 0x5295000
    buffer_store_dwordx4 v[104:107], v0, s[20:23], s45 offen sc1
    s_add_u32 s46, s34, 0x3e80000
    s_nop 0
    buffer_load_dwordx2 v[104:105], v1, s[16:19], s46 offen nt
    s_add_u32 s47, s34, 0x3e82000
    buffer_load_dwordx2 v[106:107], v1, s[16:19], s47 offen nt
    s_waitcnt vmcnt(15)
    v_lshlrev_b32 v7, 16, v66
    v_and_b32 v8, 0xffff0000, v66
    v_lshlrev_b32 v9, 16, v67
    v_and_b32 v10, 0xffff0000, v67
    v_mul_f32 v7, 0.15915494, v7
    v_mul_f32 v8, 0.15915494, v8
    v_mul_f32 v9, 0.15915494, v9
    v_mul_f32 v10, 0.15915494, v10
    v_cos_f32 v7, v7
    v_lshl_add_u32 v11, v88, 11, s40
    v_lshrrev_b32 v12, 3, v92
    v_lshlrev_b16 v13, 3, v92
    v_bitop3_b32 v12, v6, v13, v12 bitop3:0xca
    v_bitop3_b32 v88, v3, v12, v11 bitop3:0xca
    v_lshrrev_b32 v11, 3, v11
    v_lshrrev_b32 v13, 2, v92
    v_bitop3_b32 v11, v5, v13, v11 bitop3:0xca
    v_and_b32 v92, 0x3fff, v11
    ds_add_u32 v92, v2
    v_cos_f32 v8, v8
    v_lshl_add_u32 v11, v89, 11, s40
    v_lshrrev_b32 v12, 3, v93
    v_lshlrev_b16 v13, 3, v93
    v_bitop3_b32 v12, v6, v13, v12 bitop3:0xca
    v_bitop3_b32 v89, v3, v12, v11 bitop3:0xca
    v_lshrrev_b32 v11, 3, v11
    v_lshrrev_b32 v13, 2, v93
    v_bitop3_b32 v11, v5, v13, v11 bitop3:0xca
    v_and_b32 v93, 0x3fff, v11
    ds_add_u32 v93, v2
    v_cvt_pk_bf16_f32 v66, v7, v8
    v_perm_b32 v12, v66, v66, s41
    v_bitop3_b32 v88, v4, v12, v88 bitop3:0xca
    v_perm_b32 v13, v66, v66, s42
    v_bitop3_b32 v89, v4, v13, v89 bitop3:0xca
    v_cos_f32 v9, v9
    v_lshl_add_u32 v11, v90, 11, s40
    v_lshrrev_b32 v12, 3, v94
    v_lshlrev_b16 v13, 3, v94
    v_bitop3_b32 v12, v6, v13, v12 bitop3:0xca
    v_bitop3_b32 v90, v3, v12, v11 bitop3:0xca
    v_lshrrev_b32 v11, 3, v11
    v_lshrrev_b32 v13, 2, v94
    v_bitop3_b32 v11, v5, v13, v11 bitop3:0xca
    v_and_b32 v94, 0x3fff, v11
    ds_add_u32 v94, v2
    v_cos_f32 v10, v10
    v_lshl_add_u32 v11, v91, 11, s40
    v_lshrrev_b32 v12, 3, v95
    v_lshlrev_b16 v13, 3, v95
    v_bitop3_b32 v12, v6, v13, v12 bitop3:0xca
    v_bitop3_b32 v91, v3, v12, v11 bitop3:0xca
    v_lshrrev_b32 v11, 3, v11
    v_lshrrev_b32 v13, 2, v95
    v_bitop3_b32 v11, v5, v13, v11 bitop3:0xca
    v_and_b32 v95, 0x3fff, v11
    ds_add_u32 v95, v2
    v_cvt_pk_bf16_f32 v67, v9, v10
    v_perm_b32 v12, v67, v67, s41
    v_bitop3_b32 v90, v4, v12, v90 bitop3:0xca
    v_perm_b32 v13, v67, v67, s42
    v_bitop3_b32 v91, v4, v13, v91 bitop3:0xca
    s_waitcnt vmcnt(11)
    v_lshlrev_b32 v7, 16, v84
    v_and_b32 v8, 0xffff0000, v84
    v_lshlrev_b32 v9, 16, v85
    v_and_b32 v10, 0xffff0000, v85
    v_mul_f32 v7, 0.15915494, v7
    v_mul_f32 v8, 0.15915494, v8
    v_mul_f32 v9, 0.15915494, v9
    v_mul_f32 v10, 0.15915494, v10
    v_cos_f32 v7, v7
    v_lshl_add_u32 v11, v96, 11, s40
    v_lshrrev_b32 v12, 3, v100
    v_lshlrev_b16 v13, 3, v100
    v_bitop3_b32 v12, v6, v13, v12 bitop3:0xca
    v_bitop3_b32 v96, v3, v12, v11 bitop3:0xca
    v_lshrrev_b32 v11, 3, v11
    v_lshrrev_b32 v13, 2, v100
    v_bitop3_b32 v11, v5, v13, v11 bitop3:0xca
    v_and_b32 v100, 0x3fff, v11
    ds_add_u32 v100, v2
    v_cos_f32 v8, v8
    v_lshl_add_u32 v11, v97, 11, s40
    v_lshrrev_b32 v12, 3, v101
    v_lshlrev_b16 v13, 3, v101
    v_bitop3_b32 v12, v6, v13, v12 bitop3:0xca
    v_bitop3_b32 v97, v3, v12, v11 bitop3:0xca
    v_lshrrev_b32 v11, 3, v11
    v_lshrrev_b32 v13, 2, v101
    v_bitop3_b32 v11, v5, v13, v11 bitop3:0xca
    v_and_b32 v101, 0x3fff, v11
    ds_add_u32 v101, v2
    v_cvt_pk_bf16_f32 v84, v7, v8
    v_perm_b32 v12, v84, v84, s41
    v_bitop3_b32 v96, v4, v12, v96 bitop3:0xca
    v_perm_b32 v13, v84, v84, s42
    v_bitop3_b32 v97, v4, v13, v97 bitop3:0xca
    v_cos_f32 v9, v9
    v_lshl_add_u32 v11, v98, 11, s40
    v_lshrrev_b32 v12, 3, v102
    v_lshlrev_b16 v13, 3, v102
    v_bitop3_b32 v12, v6, v13, v12 bitop3:0xca
    v_bitop3_b32 v98, v3, v12, v11 bitop3:0xca
    v_lshrrev_b32 v11, 3, v11
    v_lshrrev_b32 v13, 2, v102
    v_bitop3_b32 v11, v5, v13, v11 bitop3:0xca
    v_and_b32 v102, 0x3fff, v11
    ds_add_u32 v102, v2
    v_cos_f32 v10, v10
    v_lshl_add_u32 v11, v99, 11, s40
    v_lshrrev_b32 v12, 3, v103
    v_lshlrev_b16 v13, 3, v103
    v_bitop3_b32 v12, v6, v13, v12 bitop3:0xca
    v_bitop3_b32 v99, v3, v12, v11 bitop3:0xca
    v_lshrrev_b32 v11, 3, v11
    v_lshrrev_b32 v13, 2, v103
    v_bitop3_b32 v11, v5, v13, v11 bitop3:0xca
    v_and_b32 v103, 0x3fff, v11
    ds_add_u32 v103, v2
    v_cvt_pk_bf16_f32 v85, v9, v10
    v_perm_b32 v12, v85, v85, s41
    v_bitop3_b32 v98, v4, v12, v98 bitop3:0xca
    v_perm_b32 v13, v85, v85, s42
    v_bitop3_b32 v99, v4, v13, v99 bitop3:0xca
    s_add_u32 s44, s35, 0x5299000
    buffer_store_dwordx4 v[16:19], v0, s[20:23], s44 offen sc1
    s_add_u32 s45, s33, 0x7d04000
    s_nop 0
    buffer_load_dwordx4 v[16:19], v0, s[8:11], s45 offen nt
    s_waitcnt vmcnt(9)
    v_lshlrev_b32 v7, 16, v86
    v_and_b32 v8, 0xffff0000, v86
    v_lshlrev_b32 v9, 16, v87
    v_and_b32 v10, 0xffff0000, v87
    v_mul_f32 v7, 0.15915494, v7
    v_mul_f32 v8, 0.15915494, v8
    v_mul_f32 v9, 0.15915494, v9
    v_mul_f32 v10, 0.15915494, v10
    v_cos_f32 v7, v7
    v_lshl_add_u32 v11, v108, 11, s40
    v_lshrrev_b32 v12, 3, v112
    v_lshlrev_b16 v13, 3, v112
    v_bitop3_b32 v12, v6, v13, v12 bitop3:0xca
    v_bitop3_b32 v108, v3, v12, v11 bitop3:0xca
    v_lshrrev_b32 v11, 3, v11
    v_lshrrev_b32 v13, 2, v112
    v_bitop3_b32 v11, v5, v13, v11 bitop3:0xca
    v_and_b32 v112, 0x3fff, v11
    ds_add_u32 v112, v2
    v_cos_f32 v8, v8
    v_lshl_add_u32 v11, v109, 11, s40
    v_lshrrev_b32 v12, 3, v113
    v_lshlrev_b16 v13, 3, v113
    v_bitop3_b32 v12, v6, v13, v12 bitop3:0xca
    v_bitop3_b32 v109, v3, v12, v11 bitop3:0xca
    v_lshrrev_b32 v11, 3, v11
    v_lshrrev_b32 v13, 2, v113
    v_bitop3_b32 v11, v5, v13, v11 bitop3:0xca
    v_and_b32 v113, 0x3fff, v11
    ds_add_u32 v113, v2
    v_cvt_pk_bf16_f32 v86, v7, v8
    v_perm_b32 v12, v86, v86, s41
    v_bitop3_b32 v108, v4, v12, v108 bitop3:0xca
    v_perm_b32 v13, v86, v86, s42
    v_bitop3_b32 v109, v4, v13, v109 bitop3:0xca
    v_cos_f32 v9, v9
    v_lshl_add_u32 v11, v110, 11, s40
    v_lshrrev_b32 v12, 3, v114
    v_lshlrev_b16 v13, 3, v114
    v_bitop3_b32 v12, v6, v13, v12 bitop3:0xca
    v_bitop3_b32 v110, v3, v12, v11 bitop3:0xca
    v_lshrrev_b32 v11, 3, v11
    v_lshrrev_b32 v13, 2, v114
    v_bitop3_b32 v11, v5, v13, v11 bitop3:0xca
    v_and_b32 v114, 0x3fff, v11
    ds_add_u32 v114, v2
    v_cos_f32 v10, v10
    v_lshl_add_u32 v11, v111, 11, s40
    v_lshrrev_b32 v12, 3, v115
    v_lshlrev_b16 v13, 3, v115
    v_bitop3_b32 v12, v6, v13, v12 bitop3:0xca
    v_bitop3_b32 v111, v3, v12, v11 bitop3:0xca
    v_lshrrev_b32 v11, 3, v11
    v_lshrrev_b32 v13, 2, v115
    v_bitop3_b32 v11, v5, v13, v11 bitop3:0xca
    v_and_b32 v115, 0x3fff, v11
    ds_add_u32 v115, v2
    v_cvt_pk_bf16_f32 v87, v9, v10
    v_perm_b32 v12, v87, v87, s41
    v_bitop3_b32 v110, v4, v12, v110 bitop3:0xca
    v_perm_b32 v13, v87, v87, s42
    v_bitop3_b32 v111, v4, v13, v111 bitop3:0xca
    v_lshrrev_b32 v8, 2, v0
    v_and_b32 v7, 0x3c00, v0
    v_bitop3_b32 v7, v5, v8, v7 bitop3:0xea
    s_waitcnt lgkmcnt(0)
    s_barrier
    ds_read2st64_b32 v[8:9], v7 offset0:0 offset1:1
    ds_read2st64_b32 v[10:11], v7 offset0:2 offset1:3
    s_add_u32 s46, s35, 0x529d000
    buffer_store_dwordx4 v[20:23], v0, s[20:23], s46 offen sc1
    s_add_u32 s47, s33, 0x7d04000
    s_nop 0
    buffer_load_dwordx4 v[20:23], v0, s[12:15], s47 offen nt
    s_waitcnt lgkmcnt(0)
    v_lshl_or_b32 v12, v9, 16, v8
    v_lshl_or_b32 v13, v11, 16, v10
    v_mov_b32 v14, v12
    v_mov_b32 v15, v13
    s_nop 0
    v_add_u32_dpp v14, v14, v14 row_shr:1 row_mask:0xf bank_mask:0xf bound_ctrl:1
    v_add_u32_dpp v15, v15, v15 row_shr:1 row_mask:0xf bank_mask:0xf bound_ctrl:1
    s_nop 0
    v_add_u32_dpp v14, v14, v14 row_shr:2 row_mask:0xf bank_mask:0xf bound_ctrl:1
    v_add_u32_dpp v15, v15, v15 row_shr:2 row_mask:0xf bank_mask:0xf bound_ctrl:1
    s_nop 0
    v_add_u32_dpp v14, v14, v14 row_shr:4 row_mask:0xf bank_mask:0xf bound_ctrl:1
    v_add_u32_dpp v15, v15, v15 row_shr:4 row_mask:0xf bank_mask:0xf bound_ctrl:1
    s_nop 0
    v_add_u32_dpp v14, v14, v14 row_shr:8 row_mask:0xf bank_mask:0xf bound_ctrl:1
    v_add_u32_dpp v15, v15, v15 row_shr:8 row_mask:0xf bank_mask:0xf bound_ctrl:1
    s_nop 0
    v_add_u32_dpp v14, v14, v14 row_bcast:15 row_mask:0xa bank_mask:0xf
    v_add_u32_dpp v15, v15, v15 row_bcast:15 row_mask:0xa bank_mask:0xf
    s_nop 0
    v_add_u32_dpp v14, v14, v14 row_bcast:31 row_mask:0xc bank_mask:0xf
    v_add_u32_dpp v15, v15, v15 row_bcast:31 row_mask:0xc bank_mask:0xf
    v_readlane_b32 s48, v14, 63
    v_readlane_b32 s49, v15, 63
    s_lshl_b32 s54, s32, 2
    v_mov_b32 v8, s54
    s_and_b32 s50, s48, 0xffff
    s_lshr_b32 s51, s48, 16
    s_and_b32 s52, s49, 0xffff
    s_lshr_b32 s53, s49, 16
    s_add_u32 s51, s51, s50
    s_add_u32 s52, s52, s51
    s_add_u32 s53, s53, s52
    v_mov_b32 v9, s53
    s_mov_b64 exec, 1
    ds_write_b32 v8, v9 offset:16384
    s_mov_b64 exec, -1
    v_and_b32 v8, 60, v7
    s_waitcnt lgkmcnt(0)
    s_barrier
    ds_read_b32 v9, v8 offset:16384
    s_waitcnt lgkmcnt(0)
    v_add_u32_dpp v9, v9, v9 row_shr:1 row_mask:0xf bank_mask:0xf bound_ctrl:1
    s_nop 1
    v_add_u32_dpp v9, v9, v9 row_shr:2 row_mask:0xf bank_mask:0xf bound_ctrl:1
    s_nop 1
    v_add_u32_dpp v9, v9, v9 row_shr:4 row_mask:0xf bank_mask:0xf bound_ctrl:1
    s_nop 1
    v_add_u32_dpp v9, v9, v9 row_shr:8 row_mask:0xf bank_mask:0xf bound_ctrl:1
    s_nop 0
    v_readlane_b32 s54, v9, s32
    s_sub_u32 s54, s54, s53
    s_add_u32 s50, s50, s54
    s_add_u32 s51, s51, s54
    s_add_u32 s52, s52, s54
    s_pack_ll_b32_b16 s48, s54, s50
    s_pack_ll_b32_b16 s49, s51, s52
    v_add_u32 v14, s48, v14
    v_add_u32 v15, s49, v15
    v_sub_u32 v12, v14, v12
    v_sub_u32 v13, v15, v13
    v_and_b32 v8, 0xffff, v12
    v_lshrrev_b32 v9, 16, v12
    v_and_b32 v10, 0xffff, v13
    v_lshrrev_b32 v11, 16, v13
    ds_write2st64_b32 v7, v8, v9 offset0:0 offset1:1
    ds_write2st64_b32 v7, v10, v11 offset0:2 offset1:3
    s_waitcnt lgkmcnt(0)
    s_barrier
    ds_add_rtn_u32 v40, v40, v2
    ds_add_rtn_u32 v41, v41, v2
    ds_add_rtn_u32 v42, v42, v2
    ds_add_rtn_u32 v43, v43, v2
    s_add_u32 s44, s36, 0x7bc7800
    buffer_store_dwordx2 v[12:13], v1, s[24:27], s44 offen
    s_bitset0_b64 exec, 63
    s_not_b64 exec, exec
    buffer_store_dwordx2 v[14:15], v1, s[24:27], s44 offen offset:8
    s_mov_b64 exec, -1
    ds_add_rtn_u32 v52, v52, v2
    ds_add_rtn_u32 v53, v53, v2
    ds_add_rtn_u32 v54, v54, v2
    ds_add_rtn_u32 v55, v55, v2
    ds_add_rtn_u32 v60, v60, v2
    ds_add_rtn_u32 v61, v61, v2
    ds_add_rtn_u32 v62, v62, v2
    ds_add_rtn_u32 v63, v63, v2
    s_add_u32 s45, s35, 0x52a1000
    buffer_store_dwordx4 v[28:31], v0, s[20:23], s45 offen sc1
    s_add_u32 s46, s33, 0x7d08000
    s_nop 0
    buffer_load_dwordx4 v[28:31], v0, s[8:11], s46 offen nt
    ds_add_rtn_u32 v72, v72, v2
    ds_add_rtn_u32 v73, v73, v2
    ds_add_rtn_u32 v74, v74, v2
    ds_add_rtn_u32 v75, v75, v2
    ds_add_rtn_u32 v80, v80, v2
    ds_add_rtn_u32 v81, v81, v2
    ds_add_rtn_u32 v82, v82, v2
    ds_add_rtn_u32 v83, v83, v2
    s_add_u32 s47, s35, 0x52a5000
    buffer_store_dwordx4 v[32:35], v0, s[20:23], s47 offen sc1
    s_add_u32 s44, s33, 0x7d08000
    s_nop 0
    buffer_load_dwordx4 v[32:35], v0, s[12:15], s44 offen nt
    ds_add_rtn_u32 v92, v92, v2
    ds_add_rtn_u32 v93, v93, v2
    ds_add_rtn_u32 v94, v94, v2
    ds_add_rtn_u32 v95, v95, v2
    ds_add_rtn_u32 v100, v100, v2
    ds_add_rtn_u32 v101, v101, v2
    ds_add_rtn_u32 v102, v102, v2
    ds_add_rtn_u32 v103, v103, v2
    s_add_u32 s45, s35, 0x52a9000
    buffer_store_dwordx4 v[124:127], v0, s[20:23], s45 offen sc1
    s_add_u32 s46, s34, 0x3e84000
    s_nop 0
    buffer_load_dwordx2 v[124:125], v1, s[16:19], s46 offen nt
    s_add_u32 s47, s34, 0x3e86000
    buffer_load_dwordx2 v[126:127], v1, s[16:19], s47 offen nt
    ds_add_rtn_u32 v112, v112, v2
    ds_add_rtn_u32 v113, v113, v2
    ds_add_rtn_u32 v114, v114, v2
    ds_add_rtn_u32 v115, v115, v2
    s_waitcnt lgkmcnt(0)
    s_barrier
    v_and_b32 v7, -4, v40
    v_lshl_add_u32 v8, v40, 2, v7
    ds_write_b32 v8, v36
    v_lshl_add_u32 v7, v7, 2, v40
    ds_write_b8 v7, v24 offset:16
    v_and_b32 v9, -4, v41
    v_lshl_add_u32 v10, v41, 2, v9
    ds_write_b32 v10, v37
    v_lshl_add_u32 v9, v9, 2, v41
    ds_write_b8_d16_hi v9, v24 offset:16
    v_and_b32 v7, -4, v42
    v_lshl_add_u32 v8, v42, 2, v7
    ds_write_b32 v8, v38
    v_lshl_add_u32 v7, v7, 2, v42
    ds_write_b8 v7, v25 offset:16
    v_and_b32 v9, -4, v43
    v_lshl_add_u32 v10, v43, 2, v9
    ds_write_b32 v10, v39
    v_lshl_add_u32 v9, v9, 2, v43
    ds_write_b8_d16_hi v9, v25 offset:16
    s_add_u32 s44, s33, 0x7d0c000
    buffer_load_dwordx4 v[36:39], v0, s[8:11], s44 offen nt
    s_add_u32 s45, s33, 0x7d0c000
    buffer_load_dwordx4 v[40:43], v0, s[12:15], s45 offen nt
    v_and_b32 v7, -4, v52
    v_lshl_add_u32 v8, v52, 2, v7
    ds_write_b32 v8, v48
    v_lshl_add_u32 v7, v7, 2, v52
    ds_write_b8 v7, v26 offset:16
    v_and_b32 v9, -4, v53
    v_lshl_add_u32 v10, v53, 2, v9
    ds_write_b32 v10, v49
    v_lshl_add_u32 v9, v9, 2, v53
    ds_write_b8_d16_hi v9, v26 offset:16
    v_and_b32 v7, -4, v54
    v_lshl_add_u32 v8, v54, 2, v7
    ds_write_b32 v8, v50
    v_lshl_add_u32 v7, v7, 2, v54
    ds_write_b8 v7, v27 offset:16
    v_and_b32 v9, -4, v55
    v_lshl_add_u32 v10, v55, 2, v9
    ds_write_b32 v10, v51
    v_lshl_add_u32 v9, v9, 2, v55
    ds_write_b8_d16_hi v9, v27 offset:16
    s_add_u32 s46, s33, 0x7d10000
    buffer_load_dwordx4 v[48:51], v0, s[8:11], s46 offen nt
    v_and_b32 v7, -4, v60
    v_lshl_add_u32 v8, v60, 2, v7
    ds_write_b32 v8, v56
    v_lshl_add_u32 v7, v7, 2, v60
    ds_write_b8 v7, v44 offset:16
    v_and_b32 v9, -4, v61
    v_lshl_add_u32 v10, v61, 2, v9
    ds_write_b32 v10, v57
    v_lshl_add_u32 v9, v9, 2, v61
    ds_write_b8_d16_hi v9, v44 offset:16
    v_and_b32 v7, -4, v62
    v_lshl_add_u32 v8, v62, 2, v7
    ds_write_b32 v8, v58
    v_lshl_add_u32 v7, v7, 2, v62
    ds_write_b8 v7, v45 offset:16
    v_and_b32 v9, -4, v63
    v_lshl_add_u32 v10, v63, 2, v9
    ds_write_b32 v10, v59
    v_lshl_add_u32 v9, v9, 2, v63
    ds_write_b8_d16_hi v9, v45 offset:16
    s_add_u32 s47, s33, 0x7d10000
    buffer_load_dwordx4 v[52:55], v0, s[12:15], s47 offen nt
    v_and_b32 v7, -4, v72
    v_lshl_add_u32 v8, v72, 2, v7
    ds_write_b32 v8, v68
    v_lshl_add_u32 v7, v7, 2, v72
    ds_write_b8 v7, v46 offset:16
    v_and_b32 v9, -4, v73
    v_lshl_add_u32 v10, v73, 2, v9
    ds_write_b32 v10, v69
    v_lshl_add_u32 v9, v9, 2, v73
    ds_write_b8_d16_hi v9, v46 offset:16
    v_and_b32 v7, -4, v74
    v_lshl_add_u32 v8, v74, 2, v7
    ds_write_b32 v8, v70
    v_lshl_add_u32 v7, v7, 2, v74
    ds_write_b8 v7, v47 offset:16
    v_and_b32 v9, -4, v75
    v_lshl_add_u32 v10, v75, 2, v9
    ds_write_b32 v10, v71
    v_lshl_add_u32 v9, v9, 2, v75
    ds_write_b8_d16_hi v9, v47 offset:16
    s_add_u32 s44, s34, 0x3e88000
    buffer_load_dwordx2 v[24:25], v1, s[16:19], s44 offen nt
    s_add_u32 s45, s34, 0x3e8a000
    buffer_load_dwordx2 v[26:27], v1, s[16:19], s45 offen nt
    v_and_b32 v7, -4, v80
    v_lshl_add_u32 v8, v80, 2, v7
    ds_write_b32 v8, v76
    v_lshl_add_u32 v7, v7, 2, v80
    ds_write_b8 v7, v64 offset:16
    v_and_b32 v9, -4, v81
    v_lshl_add_u32 v10, v81, 2, v9
    ds_write_b32 v10, v77
    v_lshl_add_u32 v9, v9, 2, v81
    ds_write_b8_d16_hi v9, v64 offset:16
    v_and_b32 v7, -4, v82
    v_lshl_add_u32 v8, v82, 2, v7
    ds_write_b32 v8, v78
    v_lshl_add_u32 v7, v7, 2, v82
    ds_write_b8 v7, v65 offset:16
    v_and_b32 v9, -4, v83
    v_lshl_add_u32 v10, v83, 2, v9
    ds_write_b32 v10, v79
    v_lshl_add_u32 v9, v9, 2, v83
    ds_write_b8_d16_hi v9, v65 offset:16
    s_add_u32 s46, s33, 0x7d14000
    buffer_load_dwordx4 v[56:59], v0, s[8:11], s46 offen nt
    s_add_u32 s47, s33, 0x7d14000
    buffer_load_dwordx4 v[60:63], v0, s[12:15], s47 offen nt
    v_and_b32 v7, -4, v92
    v_lshl_add_u32 v8, v92, 2, v7
    ds_write_b32 v8, v88
    v_lshl_add_u32 v7, v7, 2, v92
    ds_write_b8 v7, v66 offset:16
    v_and_b32 v9, -4, v93
    v_lshl_add_u32 v10, v93, 2, v9
    ds_write_b32 v10, v89
    v_lshl_add_u32 v9, v9, 2, v93
    ds_write_b8_d16_hi v9, v66 offset:16
    v_and_b32 v7, -4, v94
    v_lshl_add_u32 v8, v94, 2, v7
    ds_write_b32 v8, v90
    v_lshl_add_u32 v7, v7, 2, v94
    ds_write_b8 v7, v67 offset:16
    v_and_b32 v9, -4, v95
    v_lshl_add_u32 v10, v95, 2, v9
    ds_write_b32 v10, v91
    v_lshl_add_u32 v9, v9, 2, v95
    ds_write_b8_d16_hi v9, v67 offset:16
    s_add_u32 s44, s33, 0x7d18000
    buffer_load_dwordx4 v[68:71], v0, s[8:11], s44 offen nt
    v_and_b32 v7, -4, v100
    v_lshl_add_u32 v8, v100, 2, v7
    ds_write_b32 v8, v96
    v_lshl_add_u32 v7, v7, 2, v100
    ds_write_b8 v7, v84 offset:16
    v_and_b32 v9, -4, v101
    v_lshl_add_u32 v10, v101, 2, v9
    ds_write_b32 v10, v97
    v_lshl_add_u32 v9, v9, 2, v101
    ds_write_b8_d16_hi v9, v84 offset:16
    v_and_b32 v7, -4, v102
    v_lshl_add_u32 v8, v102, 2, v7
    ds_write_b32 v8, v98
    v_lshl_add_u32 v7, v7, 2, v102
    ds_write_b8 v7, v85 offset:16
    v_and_b32 v9, -4, v103
    v_lshl_add_u32 v10, v103, 2, v9
    ds_write_b32 v10, v99
    v_lshl_add_u32 v9, v9, 2, v103
    ds_write_b8_d16_hi v9, v85 offset:16
    s_add_u32 s45, s33, 0x7d18000
    buffer_load_dwordx4 v[72:75], v0, s[12:15], s45 offen nt
    v_and_b32 v7, -4, v112
    v_lshl_add_u32 v8, v112, 2, v7
    ds_write_b32 v8, v108
    v_lshl_add_u32 v7, v7, 2, v112
    ds_write_b8 v7, v86 offset:16
    v_and_b32 v9, -4, v113
    v_lshl_add_u32 v10, v113, 2, v9
    ds_write_b32 v10, v109
    v_lshl_add_u32 v9, v9, 2, v113
    ds_write_b8_d16_hi v9, v86 offset:16
    v_and_b32 v7, -4, v114
    v_lshl_add_u32 v8, v114, 2, v7
    ds_write_b32 v8, v110
    v_lshl_add_u32 v7, v7, 2, v114
    ds_write_b8 v7, v87 offset:16
    v_and_b32 v9, -4, v115
    v_lshl_add_u32 v10, v115, 2, v9
    ds_write_b32 v10, v111
    v_lshl_add_u32 v9, v9, 2, v115
    ds_write_b8_d16_hi v9, v87 offset:16
    s_add_u32 s46, s34, 0x3e8c000
    buffer_load_dwordx2 v[44:45], v1, s[16:19], s46 offen nt
    s_add_u32 s47, s34, 0x3e8e000
    buffer_load_dwordx2 v[46:47], v1, s[16:19], s47 offen nt
    v_add_u32 v7, 0x10000, v0
    v_add_u32 v12, 0x20000, v0
    v_mov_b32 v8, 0
    v_mov_b32 v9, 0
    v_mov_b32 v10, 0
    v_mov_b32 v11, 0
    s_waitcnt lgkmcnt(0)
    s_barrier
    ds_read_b128 v[76:79], v0 offset:0
    ds_write_b128 v0, v[8:11]
    ds_read_b128 v[80:83], v0 offset:16384
    ds_read_b128 v[88:91], v0 offset:32768
    ds_read_b128 v[92:95], v0 offset:49152
    ds_read_b128 v[64:67], v7 offset:0
    ds_read_b128 v[96:99], v7 offset:16384
    ds_read_b128 v[100:103], v7 offset:32768
    ds_read_b128 v[108:111], v7 offset:49152
    ds_read_b128 v[112:115], v12 offset:0
    ds_read_b128 v[84:87], v12 offset:16384
    s_waitcnt lgkmcnt(0)
    s_barrier
    s_add_u32 s44, s35, 0x7bc7800
    buffer_store_dwordx4 v[76:79], v0, s[20:23], s44 offen sc1
    s_add_u32 s45, s33, 0x7d1c000
    s_nop 0
    buffer_load_dwordx4 v[76:79], v0, s[8:11], s45 offen nt
    s_add_u32 s46, s35, 0x7bcb800
    buffer_store_dwordx4 v[80:83], v0, s[20:23], s46 offen sc1
    s_add_u32 s47, s33, 0x7d1c000
    s_nop 0
    buffer_load_dwordx4 v[80:83], v0, s[12:15], s47 offen nt
    s_waitcnt vmcnt(29)
    v_lshlrev_b32 v7, 16, v104
    v_and_b32 v8, 0xffff0000, v104
    v_lshlrev_b32 v9, 16, v105
    v_and_b32 v10, 0xffff0000, v105
    v_mul_f32 v7, 0.15915494, v7
    v_mul_f32 v8, 0.15915494, v8
    v_mul_f32 v9, 0.15915494, v9
    v_mul_f32 v10, 0.15915494, v10
    v_cos_f32 v7, v7
    v_lshl_add_u32 v11, v116, 11, s40
    v_lshrrev_b32 v12, 3, v120
    v_lshlrev_b16 v13, 3, v120
    v_bitop3_b32 v12, v6, v13, v12 bitop3:0xca
    v_bitop3_b32 v116, v3, v12, v11 bitop3:0xca
    v_lshrrev_b32 v11, 3, v11
    v_lshrrev_b32 v13, 2, v120
    v_bitop3_b32 v11, v5, v13, v11 bitop3:0xca
    v_and_b32 v120, 0x3fff, v11
    ds_add_u32 v120, v2
    v_cos_f32 v8, v8
    v_lshl_add_u32 v11, v117, 11, s40
    v_lshrrev_b32 v12, 3, v121
    v_lshlrev_b16 v13, 3, v121
    v_bitop3_b32 v12, v6, v13, v12 bitop3:0xca
    v_bitop3_b32 v117, v3, v12, v11 bitop3:0xca
    v_lshrrev_b32 v11, 3, v11
    v_lshrrev_b32 v13, 2, v121
    v_bitop3_b32 v11, v5, v13, v11 bitop3:0xca
    v_and_b32 v121, 0x3fff, v11
    ds_add_u32 v121, v2
    v_cvt_pk_bf16_f32 v104, v7, v8
    v_perm_b32 v12, v104, v104, s41
    v_bitop3_b32 v116, v4, v12, v116 bitop3:0xca
    v_perm_b32 v13, v104, v104, s42
    v_bitop3_b32 v117, v4, v13, v117 bitop3:0xca
    v_cos_f32 v9, v9
    v_lshl_add_u32 v11, v118, 11, s40
    v_lshrrev_b32 v12, 3, v122
    v_lshlrev_b16 v13, 3, v122
    v_bitop3_b32 v12, v6, v13, v12 bitop3:0xca
    v_bitop3_b32 v118, v3, v12, v11 bitop3:0xca
    v_lshrrev_b32 v11, 3, v11
    v_lshrrev_b32 v13, 2, v122
    v_bitop3_b32 v11, v5, v13, v11 bitop3:0xca
    v_and_b32 v122, 0x3fff, v11
    ds_add_u32 v122, v2
    v_cos_f32 v10, v10
    v_lshl_add_u32 v11, v119, 11, s40
    v_lshrrev_b32 v12, 3, v123
    v_lshlrev_b16 v13, 3, v123
    v_bitop3_b32 v12, v6, v13, v12 bitop3:0xca
    v_bitop3_b32 v119, v3, v12, v11 bitop3:0xca
    v_lshrrev_b32 v11, 3, v11
    v_lshrrev_b32 v13, 2, v123
    v_bitop3_b32 v11, v5, v13, v11 bitop3:0xca
    v_and_b32 v123, 0x3fff, v11
    ds_add_u32 v123, v2
    v_cvt_pk_bf16_f32 v105, v9, v10
    v_perm_b32 v12, v105, v105, s41
    v_bitop3_b32 v118, v4, v12, v118 bitop3:0xca
    v_perm_b32 v13, v105, v105, s42
    v_bitop3_b32 v119, v4, v13, v119 bitop3:0xca
    s_add_u32 s44, s35, 0x7bcf800
    buffer_store_dwordx4 v[88:91], v0, s[20:23], s44 offen sc1
    s_waitcnt vmcnt(26)
    v_lshlrev_b32 v7, 16, v106
    v_and_b32 v8, 0xffff0000, v106
    v_lshlrev_b32 v9, 16, v107
    v_and_b32 v10, 0xffff0000, v107
    v_mul_f32 v7, 0.15915494, v7
    v_mul_f32 v8, 0.15915494, v8
    v_mul_f32 v9, 0.15915494, v9
    v_mul_f32 v10, 0.15915494, v10
    v_cos_f32 v7, v7
    v_lshl_add_u32 v11, v16, 11, s40
    v_lshrrev_b32 v12, 3, v20
    v_lshlrev_b16 v13, 3, v20
    v_bitop3_b32 v12, v6, v13, v12 bitop3:0xca
    v_bitop3_b32 v16, v3, v12, v11 bitop3:0xca
    v_lshrrev_b32 v11, 3, v11
    v_lshrrev_b32 v13, 2, v20
    v_bitop3_b32 v11, v5, v13, v11 bitop3:0xca
    v_and_b32 v20, 0x3fff, v11
    ds_add_u32 v20, v2
    v_cos_f32 v8, v8
    v_lshl_add_u32 v11, v17, 11, s40
    v_lshrrev_b32 v12, 3, v21
    v_lshlrev_b16 v13, 3, v21
    v_bitop3_b32 v12, v6, v13, v12 bitop3:0xca
    v_bitop3_b32 v17, v3, v12, v11 bitop3:0xca
    v_lshrrev_b32 v11, 3, v11
    v_lshrrev_b32 v13, 2, v21
    v_bitop3_b32 v11, v5, v13, v11 bitop3:0xca
    v_and_b32 v21, 0x3fff, v11
    ds_add_u32 v21, v2
    v_cvt_pk_bf16_f32 v106, v7, v8
    v_perm_b32 v12, v106, v106, s41
    v_bitop3_b32 v16, v4, v12, v16 bitop3:0xca
    v_perm_b32 v13, v106, v106, s42
    v_bitop3_b32 v17, v4, v13, v17 bitop3:0xca
    v_cos_f32 v9, v9
    v_lshl_add_u32 v11, v18, 11, s40
    v_lshrrev_b32 v12, 3, v22
    v_lshlrev_b16 v13, 3, v22
    v_bitop3_b32 v12, v6, v13, v12 bitop3:0xca
    v_bitop3_b32 v18, v3, v12, v11 bitop3:0xca
    v_lshrrev_b32 v11, 3, v11
    v_lshrrev_b32 v13, 2, v22
    v_bitop3_b32 v11, v5, v13, v11 bitop3:0xca
    v_and_b32 v22, 0x3fff, v11
    ds_add_u32 v22, v2
    v_cos_f32 v10, v10
    v_lshl_add_u32 v11, v19, 11, s40
    v_lshrrev_b32 v12, 3, v23
    v_lshlrev_b16 v13, 3, v23
    v_bitop3_b32 v12, v6, v13, v12 bitop3:0xca
    v_bitop3_b32 v19, v3, v12, v11 bitop3:0xca
    v_lshrrev_b32 v11, 3, v11
    v_lshrrev_b32 v13, 2, v23
    v_bitop3_b32 v11, v5, v13, v11 bitop3:0xca
    v_and_b32 v23, 0x3fff, v11
    ds_add_u32 v23, v2
    v_cvt_pk_bf16_f32 v107, v9, v10
    v_perm_b32 v12, v107, v107, s41
    v_bitop3_b32 v18, v4, v12, v18 bitop3:0xca
    v_perm_b32 v13, v107, v107, s42
    v_bitop3_b32 v19, v4, v13, v19 bitop3:0xca
    s_waitcnt vmcnt(17)
    v_lshlrev_b32 v7, 16, v124
    v_and_b32 v8, 0xffff0000, v124
    v_lshlrev_b32 v9, 16, v125
    v_and_b32 v10, 0xffff0000, v125
    v_mul_f32 v7, 0.15915494, v7
    v_mul_f32 v8, 0.15915494, v8
    v_mul_f32 v9, 0.15915494, v9
    v_mul_f32 v10, 0.15915494, v10
    v_cos_f32 v7, v7
    v_lshl_add_u32 v11, v28, 11, s40
    v_lshrrev_b32 v12, 3, v32
    v_lshlrev_b16 v13, 3, v32
    v_bitop3_b32 v12, v6, v13, v12 bitop3:0xca
    v_bitop3_b32 v28, v3, v12, v11 bitop3:0xca
    v_lshrrev_b32 v11, 3, v11
    v_lshrrev_b32 v13, 2, v32
    v_bitop3_b32 v11, v5, v13, v11 bitop3:0xca
    v_and_b32 v32, 0x3fff, v11
    ds_add_u32 v32, v2
    v_cos_f32 v8, v8
    v_lshl_add_u32 v11, v29, 11, s40
    v_lshrrev_b32 v12, 3, v33
    v_lshlrev_b16 v13, 3, v33
    v_bitop3_b32 v12, v6, v13, v12 bitop3:0xca
    v_bitop3_b32 v29, v3, v12, v11 bitop3:0xca
    v_lshrrev_b32 v11, 3, v11
    v_lshrrev_b32 v13, 2, v33
    v_bitop3_b32 v11, v5, v13, v11 bitop3:0xca
    v_and_b32 v33, 0x3fff, v11
    ds_add_u32 v33, v2
    v_cvt_pk_bf16_f32 v124, v7, v8
    v_perm_b32 v12, v124, v124, s41
    v_bitop3_b32 v28, v4, v12, v28 bitop3:0xca
    v_perm_b32 v13, v124, v124, s42
    v_bitop3_b32 v29, v4, v13, v29 bitop3:0xca
    v_cos_f32 v9, v9
    v_lshl_add_u32 v11, v30, 11, s40
    v_lshrrev_b32 v12, 3, v34
    v_lshlrev_b16 v13, 3, v34
    v_bitop3_b32 v12, v6, v13, v12 bitop3:0xca
    v_bitop3_b32 v30, v3, v12, v11 bitop3:0xca
    v_lshrrev_b32 v11, 3, v11
    v_lshrrev_b32 v13, 2, v34
    v_bitop3_b32 v11, v5, v13, v11 bitop3:0xca
    v_and_b32 v34, 0x3fff, v11
    ds_add_u32 v34, v2
    v_cos_f32 v10, v10
    v_lshl_add_u32 v11, v31, 11, s40
    v_lshrrev_b32 v12, 3, v35
    v_lshlrev_b16 v13, 3, v35
    v_bitop3_b32 v12, v6, v13, v12 bitop3:0xca
    v_bitop3_b32 v31, v3, v12, v11 bitop3:0xca
    v_lshrrev_b32 v11, 3, v11
    v_lshrrev_b32 v13, 2, v35
    v_bitop3_b32 v11, v5, v13, v11 bitop3:0xca
    v_and_b32 v35, 0x3fff, v11
    ds_add_u32 v35, v2
    v_cvt_pk_bf16_f32 v125, v9, v10
    v_perm_b32 v12, v125, v125, s41
    v_bitop3_b32 v30, v4, v12, v30 bitop3:0xca
    v_perm_b32 v13, v125, v125, s42
    v_bitop3_b32 v31, v4, v13, v31 bitop3:0xca
    s_waitcnt vmcnt(15)
    v_lshlrev_b32 v7, 16, v126
    v_and_b32 v8, 0xffff0000, v126
    v_lshlrev_b32 v9, 16, v127
    v_and_b32 v10, 0xffff0000, v127
    v_mul_f32 v7, 0.15915494, v7
    v_mul_f32 v8, 0.15915494, v8
    v_mul_f32 v9, 0.15915494, v9
    v_mul_f32 v10, 0.15915494, v10
    v_cos_f32 v7, v7
    v_lshl_add_u32 v11, v36, 11, s40
    v_lshrrev_b32 v12, 3, v40
    v_lshlrev_b16 v13, 3, v40
    v_bitop3_b32 v12, v6, v13, v12 bitop3:0xca
    v_bitop3_b32 v36, v3, v12, v11 bitop3:0xca
    v_lshrrev_b32 v11, 3, v11
    v_lshrrev_b32 v13, 2, v40
    v_bitop3_b32 v11, v5, v13, v11 bitop3:0xca
    v_and_b32 v40, 0x3fff, v11
    ds_add_u32 v40, v2
    v_cos_f32 v8, v8
    v_lshl_add_u32 v11, v37, 11, s40
    v_lshrrev_b32 v12, 3, v41
    v_lshlrev_b16 v13, 3, v41
    v_bitop3_b32 v12, v6, v13, v12 bitop3:0xca
    v_bitop3_b32 v37, v3, v12, v11 bitop3:0xca
    v_lshrrev_b32 v11, 3, v11
    v_lshrrev_b32 v13, 2, v41
    v_bitop3_b32 v11, v5, v13, v11 bitop3:0xca
    v_and_b32 v41, 0x3fff, v11
    ds_add_u32 v41, v2
    v_cvt_pk_bf16_f32 v126, v7, v8
    v_perm_b32 v12, v126, v126, s41
    v_bitop3_b32 v36, v4, v12, v36 bitop3:0xca
    v_perm_b32 v13, v126, v126, s42
    v_bitop3_b32 v37, v4, v13, v37 bitop3:0xca
    v_cos_f32 v9, v9
    v_lshl_add_u32 v11, v38, 11, s40
    v_lshrrev_b32 v12, 3, v42
    v_lshlrev_b16 v13, 3, v42
    v_bitop3_b32 v12, v6, v13, v12 bitop3:0xca
    v_bitop3_b32 v38, v3, v12, v11 bitop3:0xca
    v_lshrrev_b32 v11, 3, v11
    v_lshrrev_b32 v13, 2, v42
    v_bitop3_b32 v11, v5, v13, v11 bitop3:0xca
    v_and_b32 v42, 0x3fff, v11
    ds_add_u32 v42, v2
    v_cos_f32 v10, v10
    v_lshl_add_u32 v11, v39, 11, s40
    v_lshrrev_b32 v12, 3, v43
    v_lshlrev_b16 v13, 3, v43
    v_bitop3_b32 v12, v6, v13, v12 bitop3:0xca
    v_bitop3_b32 v39, v3, v12, v11 bitop3:0xca
    v_lshrrev_b32 v11, 3, v11
    v_lshrrev_b32 v13, 2, v43
    v_bitop3_b32 v11, v5, v13, v11 bitop3:0xca
    v_and_b32 v43, 0x3fff, v11
    ds_add_u32 v43, v2
    v_cvt_pk_bf16_f32 v127, v9, v10
    v_perm_b32 v12, v127, v127, s41
    v_bitop3_b32 v38, v4, v12, v38 bitop3:0xca
    v_perm_b32 v13, v127, v127, s42
    v_bitop3_b32 v39, v4, v13, v39 bitop3:0xca
    s_waitcnt vmcnt(11)
    v_lshlrev_b32 v7, 16, v24
    v_and_b32 v8, 0xffff0000, v24
    v_lshlrev_b32 v9, 16, v25
    v_and_b32 v10, 0xffff0000, v25
    v_mul_f32 v7, 0.15915494, v7
    v_mul_f32 v8, 0.15915494, v8
    v_mul_f32 v9, 0.15915494, v9
    v_mul_f32 v10, 0.15915494, v10
    v_cos_f32 v7, v7
    v_lshl_add_u32 v11, v48, 11, s40
    v_lshrrev_b32 v12, 3, v52
    v_lshlrev_b16 v13, 3, v52
    v_bitop3_b32 v12, v6, v13, v12 bitop3:0xca
    v_bitop3_b32 v48, v3, v12, v11 bitop3:0xca
    v_lshrrev_b32 v11, 3, v11
    v_lshrrev_b32 v13, 2, v52
    v_bitop3_b32 v11, v5, v13, v11 bitop3:0xca
    v_and_b32 v52, 0x3fff, v11
    ds_add_u32 v52, v2
    v_cos_f32 v8, v8
    v_lshl_add_u32 v11, v49, 11, s40
    v_lshrrev_b32 v12, 3, v53
    v_lshlrev_b16 v13, 3, v53
    v_bitop3_b32 v12, v6, v13, v12 bitop3:0xca
    v_bitop3_b32 v49, v3, v12, v11 bitop3:0xca
    v_lshrrev_b32 v11, 3, v11
    v_lshrrev_b32 v13, 2, v53
    v_bitop3_b32 v11, v5, v13, v11 bitop3:0xca
    v_and_b32 v53, 0x3fff, v11
    ds_add_u32 v53, v2
    v_cvt_pk_bf16_f32 v24, v7, v8
    v_perm_b32 v12, v24, v24, s41
    v_bitop3_b32 v48, v4, v12, v48 bitop3:0xca
    v_perm_b32 v13, v24, v24, s42
    v_bitop3_b32 v49, v4, v13, v49 bitop3:0xca
    v_cos_f32 v9, v9
    v_lshl_add_u32 v11, v50, 11, s40
    v_lshrrev_b32 v12, 3, v54
    v_lshlrev_b16 v13, 3, v54
    v_bitop3_b32 v12, v6, v13, v12 bitop3:0xca
    v_bitop3_b32 v50, v3, v12, v11 bitop3:0xca
    v_lshrrev_b32 v11, 3, v11
    v_lshrrev_b32 v13, 2, v54
    v_bitop3_b32 v11, v5, v13, v11 bitop3:0xca
    v_and_b32 v54, 0x3fff, v11
    ds_add_u32 v54, v2
    v_cos_f32 v10, v10
    v_lshl_add_u32 v11, v51, 11, s40
    v_lshrrev_b32 v12, 3, v55
    v_lshlrev_b16 v13, 3, v55
    v_bitop3_b32 v12, v6, v13, v12 bitop3:0xca
    v_bitop3_b32 v51, v3, v12, v11 bitop3:0xca
    v_lshrrev_b32 v11, 3, v11
    v_lshrrev_b32 v13, 2, v55
    v_bitop3_b32 v11, v5, v13, v11 bitop3:0xca
    v_and_b32 v55, 0x3fff, v11
    ds_add_u32 v55, v2
    v_cvt_pk_bf16_f32 v25, v9, v10
    v_perm_b32 v12, v25, v25, s41
    v_bitop3_b32 v50, v4, v12, v50 bitop3:0xca
    v_perm_b32 v13, v25, v25, s42
    v_bitop3_b32 v51, v4, v13, v51 bitop3:0xca
    s_waitcnt vmcnt(9)
    v_lshlrev_b32 v7, 16, v26
    v_and_b32 v8, 0xffff0000, v26
    v_lshlrev_b32 v9, 16, v27
    v_and_b32 v10, 0xffff0000, v27
    v_mul_f32 v7, 0.15915494, v7
    v_mul_f32 v8, 0.15915494, v8
    v_mul_f32 v9, 0.15915494, v9
    v_mul_f32 v10, 0.15915494, v10
    v_cos_f32 v7, v7
    v_lshl_add_u32 v11, v56, 11, s40
    v_lshrrev_b32 v12, 3, v60
    v_lshlrev_b16 v13, 3, v60
    v_bitop3_b32 v12, v6, v13, v12 bitop3:0xca
    v_bitop3_b32 v56, v3, v12, v11 bitop3:0xca
    v_lshrrev_b32 v11, 3, v11
    v_lshrrev_b32 v13, 2, v60
    v_bitop3_b32 v11, v5, v13, v11 bitop3:0xca
    v_and_b32 v60, 0x3fff, v11
    ds_add_u32 v60, v2
    v_cos_f32 v8, v8
    v_lshl_add_u32 v11, v57, 11, s40
    v_lshrrev_b32 v12, 3, v61
    v_lshlrev_b16 v13, 3, v61
    v_bitop3_b32 v12, v6, v13, v12 bitop3:0xca
    v_bitop3_b32 v57, v3, v12, v11 bitop3:0xca
    v_lshrrev_b32 v11, 3, v11
    v_lshrrev_b32 v13, 2, v61
    v_bitop3_b32 v11, v5, v13, v11 bitop3:0xca
    v_and_b32 v61, 0x3fff, v11
    ds_add_u32 v61, v2
    v_cvt_pk_bf16_f32 v26, v7, v8
    v_perm_b32 v12, v26, v26, s41
    v_bitop3_b32 v56, v4, v12, v56 bitop3:0xca
    v_perm_b32 v13, v26, v26, s42
    v_bitop3_b32 v57, v4, v13, v57 bitop3:0xca
    v_cos_f32 v9, v9
    v_lshl_add_u32 v11, v58, 11, s40
    v_lshrrev_b32 v12, 3, v62
    v_lshlrev_b16 v13, 3, v62
    v_bitop3_b32 v12, v6, v13, v12 bitop3:0xca
    v_bitop3_b32 v58, v3, v12, v11 bitop3:0xca
    v_lshrrev_b32 v11, 3, v11
    v_lshrrev_b32 v13, 2, v62
    v_bitop3_b32 v11, v5, v13, v11 bitop3:0xca
    v_and_b32 v62, 0x3fff, v11
    ds_add_u32 v62, v2
    v_cos_f32 v10, v10
    v_lshl_add_u32 v11, v59, 11, s40
    v_lshrrev_b32 v12, 3, v63
    v_lshlrev_b16 v13, 3, v63
    v_bitop3_b32 v12, v6, v13, v12 bitop3:0xca
    v_bitop3_b32 v59, v3, v12, v11 bitop3:0xca
    v_lshrrev_b32 v11, 3, v11
    v_lshrrev_b32 v13, 2, v63
    v_bitop3_b32 v11, v5, v13, v11 bitop3:0xca
    v_and_b32 v63, 0x3fff, v11
    ds_add_u32 v63, v2
    v_cvt_pk_bf16_f32 v27, v9, v10
    v_perm_b32 v12, v27, v27, s41
    v_bitop3_b32 v58, v4, v12, v58 bitop3:0xca
    v_perm_b32 v13, v27, v27, s42
    v_bitop3_b32 v59, v4, v13, v59 bitop3:0xca
    s_waitcnt vmcnt(5)
    v_lshlrev_b32 v7, 16, v44
    v_and_b32 v8, 0xffff0000, v44
    v_lshlrev_b32 v9, 16, v45
    v_and_b32 v10, 0xffff0000, v45
    v_mul_f32 v7, 0.15915494, v7
    v_mul_f32 v8, 0.15915494, v8
    v_mul_f32 v9, 0.15915494, v9
    v_mul_f32 v10, 0.15915494, v10
    v_cos_f32 v7, v7
    v_lshl_add_u32 v11, v68, 11, s40
    v_lshrrev_b32 v12, 3, v72
    v_lshlrev_b16 v13, 3, v72
    v_bitop3_b32 v12, v6, v13, v12 bitop3:0xca
    v_bitop3_b32 v68, v3, v12, v11 bitop3:0xca
    v_lshrrev_b32 v11, 3, v11
    v_lshrrev_b32 v13, 2, v72
    v_bitop3_b32 v11, v5, v13, v11 bitop3:0xca
    v_and_b32 v72, 0x3fff, v11
    ds_add_u32 v72, v2
    v_cos_f32 v8, v8
    v_lshl_add_u32 v11, v69, 11, s40
    v_lshrrev_b32 v12, 3, v73
    v_lshlrev_b16 v13, 3, v73
    v_bitop3_b32 v12, v6, v13, v12 bitop3:0xca
    v_bitop3_b32 v69, v3, v12, v11 bitop3:0xca
    v_lshrrev_b32 v11, 3, v11
    v_lshrrev_b32 v13, 2, v73
    v_bitop3_b32 v11, v5, v13, v11 bitop3:0xca
    v_and_b32 v73, 0x3fff, v11
    ds_add_u32 v73, v2
    v_cvt_pk_bf16_f32 v44, v7, v8
    v_perm_b32 v12, v44, v44, s41
    v_bitop3_b32 v68, v4, v12, v68 bitop3:0xca
    v_perm_b32 v13, v44, v44, s42
    v_bitop3_b32 v69, v4, v13, v69 bitop3:0xca
    v_cos_f32 v9, v9
    v_lshl_add_u32 v11, v70, 11, s40
    v_lshrrev_b32 v12, 3, v74
    v_lshlrev_b16 v13, 3, v74
    v_bitop3_b32 v12, v6, v13, v12 bitop3:0xca
    v_bitop3_b32 v70, v3, v12, v11 bitop3:0xca
    v_lshrrev_b32 v11, 3, v11
    v_lshrrev_b32 v13, 2, v74
    v_bitop3_b32 v11, v5, v13, v11 bitop3:0xca
    v_and_b32 v74, 0x3fff, v11
    ds_add_u32 v74, v2
    v_cos_f32 v10, v10
    v_lshl_add_u32 v11, v71, 11, s40
    v_lshrrev_b32 v12, 3, v75
    v_lshlrev_b16 v13, 3, v75
    v_bitop3_b32 v12, v6, v13, v12 bitop3:0xca
    v_bitop3_b32 v71, v3, v12, v11 bitop3:0xca
    v_lshrrev_b32 v11, 3, v11
    v_lshrrev_b32 v13, 2, v75
    v_bitop3_b32 v11, v5, v13, v11 bitop3:0xca
    v_and_b32 v75, 0x3fff, v11
    ds_add_u32 v75, v2
    v_cvt_pk_bf16_f32 v45, v9, v10
    v_perm_b32 v12, v45, v45, s41
    v_bitop3_b32 v70, v4, v12, v70 bitop3:0xca
    v_perm_b32 v13, v45, v45, s42
    v_bitop3_b32 v71, v4, v13, v71 bitop3:0xca
    s_waitcnt vmcnt(1)
    v_lshlrev_b32 v7, 16, v46
    v_and_b32 v8, 0xffff0000, v46
    v_lshlrev_b32 v9, 16, v47
    v_and_b32 v10, 0xffff0000, v47
    v_mul_f32 v7, 0.15915494, v7
    v_mul_f32 v8, 0.15915494, v8
    v_mul_f32 v9, 0.15915494, v9
    v_mul_f32 v10, 0.15915494, v10
    v_cos_f32 v7, v7
    v_lshl_add_u32 v11, v76, 11, s40
    v_lshrrev_b32 v12, 3, v80
    v_lshlrev_b16 v13, 3, v80
    v_bitop3_b32 v12, v6, v13, v12 bitop3:0xca
    v_bitop3_b32 v76, v3, v12, v11 bitop3:0xca
    v_lshrrev_b32 v11, 3, v11
    v_lshrrev_b32 v13, 2, v80
    v_bitop3_b32 v11, v5, v13, v11 bitop3:0xca
    v_and_b32 v80, 0x3fff, v11
    ds_add_u32 v80, v2
    v_cos_f32 v8, v8
    v_lshl_add_u32 v11, v77, 11, s40
    v_lshrrev_b32 v12, 3, v81
    v_lshlrev_b16 v13, 3, v81
    v_bitop3_b32 v12, v6, v13, v12 bitop3:0xca
    v_bitop3_b32 v77, v3, v12, v11 bitop3:0xca
    v_lshrrev_b32 v11, 3, v11
    v_lshrrev_b32 v13, 2, v81
    v_bitop3_b32 v11, v5, v13, v11 bitop3:0xca
    v_and_b32 v81, 0x3fff, v11
    ds_add_u32 v81, v2
    v_cvt_pk_bf16_f32 v46, v7, v8
    v_perm_b32 v12, v46, v46, s41
    v_bitop3_b32 v76, v4, v12, v76 bitop3:0xca
    v_perm_b32 v13, v46, v46, s42
    v_bitop3_b32 v77, v4, v13, v77 bitop3:0xca
    v_cos_f32 v9, v9
    v_lshl_add_u32 v11, v78, 11, s40
    v_lshrrev_b32 v12, 3, v82
    v_lshlrev_b16 v13, 3, v82
    v_bitop3_b32 v12, v6, v13, v12 bitop3:0xca
    v_bitop3_b32 v78, v3, v12, v11 bitop3:0xca
    v_lshrrev_b32 v11, 3, v11
    v_lshrrev_b32 v13, 2, v82
    v_bitop3_b32 v11, v5, v13, v11 bitop3:0xca
    v_and_b32 v82, 0x3fff, v11
    ds_add_u32 v82, v2
    v_cos_f32 v10, v10
    v_lshl_add_u32 v11, v79, 11, s40
    v_lshrrev_b32 v12, 3, v83
    v_lshlrev_b16 v13, 3, v83
    v_bitop3_b32 v12, v6, v13, v12 bitop3:0xca
    v_bitop3_b32 v79, v3, v12, v11 bitop3:0xca
    v_lshrrev_b32 v11, 3, v11
    v_lshrrev_b32 v13, 2, v83
    v_bitop3_b32 v11, v5, v13, v11 bitop3:0xca
    v_and_b32 v83, 0x3fff, v11
    ds_add_u32 v83, v2
    v_cvt_pk_bf16_f32 v47, v9, v10
    v_perm_b32 v12, v47, v47, s41
    v_bitop3_b32 v78, v4, v12, v78 bitop3:0xca
    v_perm_b32 v13, v47, v47, s42
    v_bitop3_b32 v79, v4, v13, v79 bitop3:0xca
    v_lshrrev_b32 v8, 2, v0
    v_and_b32 v7, 0x3c00, v0
    v_bitop3_b32 v7, v5, v8, v7 bitop3:0xea
    s_waitcnt lgkmcnt(0)
    s_barrier
    ds_read2st64_b32 v[8:9], v7 offset0:0 offset1:1
    ds_read2st64_b32 v[10:11], v7 offset0:2 offset1:3
    s_add_u32 s45, s35, 0x7bd3800
    buffer_store_dwordx4 v[92:95], v0, s[20:23], s45 offen sc1
    s_waitcnt lgkmcnt(0)
    v_lshl_or_b32 v12, v9, 16, v8
    v_lshl_or_b32 v13, v11, 16, v10
    v_mov_b32 v14, v12
    v_mov_b32 v15, v13
    s_nop 0
    v_add_u32_dpp v14, v14, v14 row_shr:1 row_mask:0xf bank_mask:0xf bound_ctrl:1
    v_add_u32_dpp v15, v15, v15 row_shr:1 row_mask:0xf bank_mask:0xf bound_ctrl:1
    s_nop 0
    v_add_u32_dpp v14, v14, v14 row_shr:2 row_mask:0xf bank_mask:0xf bound_ctrl:1
    v_add_u32_dpp v15, v15, v15 row_shr:2 row_mask:0xf bank_mask:0xf bound_ctrl:1
    s_nop 0
    v_add_u32_dpp v14, v14, v14 row_shr:4 row_mask:0xf bank_mask:0xf bound_ctrl:1
    v_add_u32_dpp v15, v15, v15 row_shr:4 row_mask:0xf bank_mask:0xf bound_ctrl:1
    s_nop 0
    v_add_u32_dpp v14, v14, v14 row_shr:8 row_mask:0xf bank_mask:0xf bound_ctrl:1
    v_add_u32_dpp v15, v15, v15 row_shr:8 row_mask:0xf bank_mask:0xf bound_ctrl:1
    s_nop 0
    v_add_u32_dpp v14, v14, v14 row_bcast:15 row_mask:0xa bank_mask:0xf
    v_add_u32_dpp v15, v15, v15 row_bcast:15 row_mask:0xa bank_mask:0xf
    s_nop 0
    v_add_u32_dpp v14, v14, v14 row_bcast:31 row_mask:0xc bank_mask:0xf
    v_add_u32_dpp v15, v15, v15 row_bcast:31 row_mask:0xc bank_mask:0xf
    v_readlane_b32 s48, v14, 63
    v_readlane_b32 s49, v15, 63
    s_lshl_b32 s54, s32, 2
    v_mov_b32 v8, s54
    s_and_b32 s50, s48, 0xffff
    s_lshr_b32 s51, s48, 16
    s_and_b32 s52, s49, 0xffff
    s_lshr_b32 s53, s49, 16
    s_add_u32 s51, s51, s50
    s_add_u32 s52, s52, s51
    s_add_u32 s53, s53, s52
    v_mov_b32 v9, s53
    s_mov_b64 exec, 1
    ds_write_b32 v8, v9 offset:16384
    s_mov_b64 exec, -1
    v_and_b32 v8, 60, v7
    s_waitcnt lgkmcnt(0)
    s_barrier
    ds_read_b32 v9, v8 offset:16384
    s_waitcnt lgkmcnt(0)
    v_add_u32_dpp v9, v9, v9 row_shr:1 row_mask:0xf bank_mask:0xf bound_ctrl:1
    s_nop 1
    v_add_u32_dpp v9, v9, v9 row_shr:2 row_mask:0xf bank_mask:0xf bound_ctrl:1
    s_nop 1
    v_add_u32_dpp v9, v9, v9 row_shr:4 row_mask:0xf bank_mask:0xf bound_ctrl:1
    s_nop 1
    v_add_u32_dpp v9, v9, v9 row_shr:8 row_mask:0xf bank_mask:0xf bound_ctrl:1
    s_nop 0
    v_readlane_b32 s54, v9, s32
    s_sub_u32 s54, s54, s53
    s_add_u32 s50, s50, s54
    s_add_u32 s51, s51, s54
    s_add_u32 s52, s52, s54
    s_pack_ll_b32_b16 s48, s54, s50
    s_pack_ll_b32_b16 s49, s51, s52
    v_add_u32 v14, s48, v14
    v_add_u32 v15, s49, v15
    v_sub_u32 v12, v14, v12
    v_sub_u32 v13, v15, v13
    v_and_b32 v8, 0xffff, v12
    v_lshrrev_b32 v9, 16, v12
    v_and_b32 v10, 0xffff, v13
    v_lshrrev_b32 v11, 16, v13
    ds_write2st64_b32 v7, v8, v9 offset0:0 offset1:1
    ds_write2st64_b32 v7, v10, v11 offset0:2 offset1:3
    s_waitcnt lgkmcnt(0)
    s_barrier
    ds_add_rtn_u32 v120, v120, v2
    ds_add_rtn_u32 v121, v121, v2
    ds_add_rtn_u32 v122, v122, v2
    ds_add_rtn_u32 v123, v123, v2
    s_add_u32 s46, s36, 0xa50a000
    buffer_store_dwordx2 v[12:13], v1, s[24:27], s46 offen
    s_bitset0_b64 exec, 63
    s_not_b64 exec, exec
    buffer_store_dwordx2 v[14:15], v1, s[24:27], s46 offen offset:8
    s_mov_b64 exec, -1
    ds_add_rtn_u32 v20, v20, v2
    ds_add_rtn_u32 v21, v21, v2
    ds_add_rtn_u32 v22, v22, v2
    ds_add_rtn_u32 v23, v23, v2
    ds_add_rtn_u32 v32, v32, v2
    ds_add_rtn_u32 v33, v33, v2
    ds_add_rtn_u32 v34, v34, v2
    ds_add_rtn_u32 v35, v35, v2
    s_add_u32 s47, s35, 0x7bd7800
    buffer_store_dwordx4 v[64:67], v0, s[20:23], s47 offen sc1
    ds_add_rtn_u32 v40, v40, v2
    ds_add_rtn_u32 v41, v41, v2
    ds_add_rtn_u32 v42, v42, v2
    ds_add_rtn_u32 v43, v43, v2
    ds_add_rtn_u32 v52, v52, v2
    ds_add_rtn_u32 v53, v53, v2
    ds_add_rtn_u32 v54, v54, v2
    ds_add_rtn_u32 v55, v55, v2
    ds_add_rtn_u32 v60, v60, v2
    ds_add_rtn_u32 v61, v61, v2
    ds_add_rtn_u32 v62, v62, v2
    ds_add_rtn_u32 v63, v63, v2
    ds_add_rtn_u32 v72, v72, v2
    ds_add_rtn_u32 v73, v73, v2
    ds_add_rtn_u32 v74, v74, v2
    ds_add_rtn_u32 v75, v75, v2
    s_add_u32 s44, s35, 0x7bdb800
    buffer_store_dwordx4 v[96:99], v0, s[20:23], s44 offen sc1
    ds_add_rtn_u32 v80, v80, v2
    ds_add_rtn_u32 v81, v81, v2
    ds_add_rtn_u32 v82, v82, v2
    ds_add_rtn_u32 v83, v83, v2
    s_waitcnt lgkmcnt(0)
    s_barrier
    v_and_b32 v7, -4, v120
    v_lshl_add_u32 v8, v120, 2, v7
    ds_write_b32 v8, v116
    v_lshl_add_u32 v7, v7, 2, v120
    ds_write_b8 v7, v104 offset:16
    v_and_b32 v9, -4, v121
    v_lshl_add_u32 v10, v121, 2, v9
    ds_write_b32 v10, v117
    v_lshl_add_u32 v9, v9, 2, v121
    ds_write_b8_d16_hi v9, v104 offset:16
    v_and_b32 v7, -4, v122
    v_lshl_add_u32 v8, v122, 2, v7
    ds_write_b32 v8, v118
    v_lshl_add_u32 v7, v7, 2, v122
    ds_write_b8 v7, v105 offset:16
    v_and_b32 v9, -4, v123
    v_lshl_add_u32 v10, v123, 2, v9
    ds_write_b32 v10, v119
    v_lshl_add_u32 v9, v9, 2, v123
    ds_write_b8_d16_hi v9, v105 offset:16
    s_add_u32 s45, s35, 0x7bdf800
    buffer_store_dwordx4 v[100:103], v0, s[20:23], s45 offen sc1
    v_and_b32 v7, -4, v20
    v_lshl_add_u32 v8, v20, 2, v7
    ds_write_b32 v8, v16
    v_lshl_add_u32 v7, v7, 2, v20
    ds_write_b8 v7, v106 offset:16
    v_and_b32 v9, -4, v21
    v_lshl_add_u32 v10, v21, 2, v9
    ds_write_b32 v10, v17
    v_lshl_add_u32 v9, v9, 2, v21
    ds_write_b8_d16_hi v9, v106 offset:16
    v_and_b32 v7, -4, v22
    v_lshl_add_u32 v8, v22, 2, v7
    ds_write_b32 v8, v18
    v_lshl_add_u32 v7, v7, 2, v22
    ds_write_b8 v7, v107 offset:16
    v_and_b32 v9, -4, v23
    v_lshl_add_u32 v10, v23, 2, v9
    ds_write_b32 v10, v19
    v_lshl_add_u32 v9, v9, 2, v23
    ds_write_b8_d16_hi v9, v107 offset:16
    v_and_b32 v7, -4, v32
    v_lshl_add_u32 v8, v32, 2, v7
    ds_write_b32 v8, v28
    v_lshl_add_u32 v7, v7, 2, v32
    ds_write_b8 v7, v124 offset:16
    v_and_b32 v9, -4, v33
    v_lshl_add_u32 v10, v33, 2, v9
    ds_write_b32 v10, v29
    v_lshl_add_u32 v9, v9, 2, v33
    ds_write_b8_d16_hi v9, v124 offset:16
    v_and_b32 v7, -4, v34
    v_lshl_add_u32 v8, v34, 2, v7
    ds_write_b32 v8, v30
    v_lshl_add_u32 v7, v7, 2, v34
    ds_write_b8 v7, v125 offset:16
    v_and_b32 v9, -4, v35
    v_lshl_add_u32 v10, v35, 2, v9
    ds_write_b32 v10, v31
    v_lshl_add_u32 v9, v9, 2, v35
    ds_write_b8_d16_hi v9, v125 offset:16
    s_add_u32 s46, s35, 0x7be3800
    buffer_store_dwordx4 v[108:111], v0, s[20:23], s46 offen sc1
    v_and_b32 v7, -4, v40
    v_lshl_add_u32 v8, v40, 2, v7
    ds_write_b32 v8, v36
    v_lshl_add_u32 v7, v7, 2, v40
    ds_write_b8 v7, v126 offset:16
    v_and_b32 v9, -4, v41
    v_lshl_add_u32 v10, v41, 2, v9
    ds_write_b32 v10, v37
    v_lshl_add_u32 v9, v9, 2, v41
    ds_write_b8_d16_hi v9, v126 offset:16
    v_and_b32 v7, -4, v42
    v_lshl_add_u32 v8, v42, 2, v7
    ds_write_b32 v8, v38
    v_lshl_add_u32 v7, v7, 2, v42
    ds_write_b8 v7, v127 offset:16
    v_and_b32 v9, -4, v43
    v_lshl_add_u32 v10, v43, 2, v9
    ds_write_b32 v10, v39
    v_lshl_add_u32 v9, v9, 2, v43
    ds_write_b8_d16_hi v9, v127 offset:16
    v_and_b32 v7, -4, v52
    v_lshl_add_u32 v8, v52, 2, v7
    ds_write_b32 v8, v48
    v_lshl_add_u32 v7, v7, 2, v52
    ds_write_b8 v7, v24 offset:16
    v_and_b32 v9, -4, v53
    v_lshl_add_u32 v10, v53, 2, v9
    ds_write_b32 v10, v49
    v_lshl_add_u32 v9, v9, 2, v53
    ds_write_b8_d16_hi v9, v24 offset:16
    v_and_b32 v7, -4, v54
    v_lshl_add_u32 v8, v54, 2, v7
    ds_write_b32 v8, v50
    v_lshl_add_u32 v7, v7, 2, v54
    ds_write_b8 v7, v25 offset:16
    v_and_b32 v9, -4, v55
    v_lshl_add_u32 v10, v55, 2, v9
    ds_write_b32 v10, v51
    v_lshl_add_u32 v9, v9, 2, v55
    ds_write_b8_d16_hi v9, v25 offset:16
    s_add_u32 s47, s35, 0x7be7800
    buffer_store_dwordx4 v[112:115], v0, s[20:23], s47 offen sc1
    v_and_b32 v7, -4, v60
    v_lshl_add_u32 v8, v60, 2, v7
    ds_write_b32 v8, v56
    v_lshl_add_u32 v7, v7, 2, v60
    ds_write_b8 v7, v26 offset:16
    v_and_b32 v9, -4, v61
    v_lshl_add_u32 v10, v61, 2, v9
    ds_write_b32 v10, v57
    v_lshl_add_u32 v9, v9, 2, v61
    ds_write_b8_d16_hi v9, v26 offset:16
    v_and_b32 v7, -4, v62
    v_lshl_add_u32 v8, v62, 2, v7
    ds_write_b32 v8, v58
    v_lshl_add_u32 v7, v7, 2, v62
    ds_write_b8 v7, v27 offset:16
    v_and_b32 v9, -4, v63
    v_lshl_add_u32 v10, v63, 2, v9
    ds_write_b32 v10, v59
    v_lshl_add_u32 v9, v9, 2, v63
    ds_write_b8_d16_hi v9, v27 offset:16
    v_and_b32 v7, -4, v72
    v_lshl_add_u32 v8, v72, 2, v7
    ds_write_b32 v8, v68
    v_lshl_add_u32 v7, v7, 2, v72
    ds_write_b8 v7, v44 offset:16
    v_and_b32 v9, -4, v73
    v_lshl_add_u32 v10, v73, 2, v9
    ds_write_b32 v10, v69
    v_lshl_add_u32 v9, v9, 2, v73
    ds_write_b8_d16_hi v9, v44 offset:16
    v_and_b32 v7, -4, v74
    v_lshl_add_u32 v8, v74, 2, v7
    ds_write_b32 v8, v70
    v_lshl_add_u32 v7, v7, 2, v74
    ds_write_b8 v7, v45 offset:16
    v_and_b32 v9, -4, v75
    v_lshl_add_u32 v10, v75, 2, v9
    ds_write_b32 v10, v71
    v_lshl_add_u32 v9, v9, 2, v75
    ds_write_b8_d16_hi v9, v45 offset:16
    s_add_u32 s44, s35, 0x7beb800
    buffer_store_dwordx4 v[84:87], v0, s[20:23], s44 offen sc1
    v_and_b32 v7, -4, v80
    v_lshl_add_u32 v8, v80, 2, v7
    ds_write_b32 v8, v76
    v_lshl_add_u32 v7, v7, 2, v80
    ds_write_b8 v7, v46 offset:16
    v_and_b32 v9, -4, v81
    v_lshl_add_u32 v10, v81, 2, v9
    ds_write_b32 v10, v77
    v_lshl_add_u32 v9, v9, 2, v81
    ds_write_b8_d16_hi v9, v46 offset:16
    v_and_b32 v7, -4, v82
    v_lshl_add_u32 v8, v82, 2, v7
    ds_write_b32 v8, v78
    v_lshl_add_u32 v7, v7, 2, v82
    ds_write_b8 v7, v47 offset:16
    v_and_b32 v9, -4, v83
    v_lshl_add_u32 v10, v83, 2, v9
    ds_write_b32 v10, v79
    v_lshl_add_u32 v9, v9, 2, v83
    ds_write_b8_d16_hi v9, v47 offset:16
    v_add_u32 v7, 0x10000, v0
    v_add_u32 v12, 0x20000, v0
    s_waitcnt lgkmcnt(0)
    s_barrier
    ds_read_b128 v[88:91], v0 offset:0
    ds_read_b128 v[92:95], v0 offset:16384
    ds_read_b128 v[64:67], v0 offset:32768
    ds_read_b128 v[96:99], v0 offset:49152
    ds_read_b128 v[116:119], v7 offset:0
    ds_read_b128 v[120:123], v7 offset:16384
    ds_read_b128 v[100:103], v7 offset:32768
    ds_read_b128 v[16:19], v7 offset:49152
    ds_read_b128 v[20:23], v12 offset:0
    ds_read_b128 v[104:107], v12 offset:16384
    s_waitcnt lgkmcnt(9)
    s_add_u32 s45, s35, 0xa50a000
    buffer_store_dwordx4 v[88:91], v0, s[20:23], s45 offen sc1
    s_waitcnt lgkmcnt(8)
    s_add_u32 s46, s35, 0xa50e000
    buffer_store_dwordx4 v[92:95], v0, s[20:23], s46 offen sc1
    s_waitcnt lgkmcnt(7)
    s_add_u32 s47, s35, 0xa512000
    buffer_store_dwordx4 v[64:67], v0, s[20:23], s47 offen sc1
    s_waitcnt lgkmcnt(6)
    s_add_u32 s44, s35, 0xa516000
    buffer_store_dwordx4 v[96:99], v0, s[20:23], s44 offen sc1
    s_waitcnt lgkmcnt(5)
    s_add_u32 s45, s35, 0xa51a000
    buffer_store_dwordx4 v[116:119], v0, s[20:23], s45 offen sc1
    s_waitcnt lgkmcnt(4)
    s_add_u32 s46, s35, 0xa51e000
    buffer_store_dwordx4 v[120:123], v0, s[20:23], s46 offen sc1
    s_waitcnt lgkmcnt(3)
    s_add_u32 s47, s35, 0xa522000
    buffer_store_dwordx4 v[100:103], v0, s[20:23], s47 offen sc1
    s_waitcnt lgkmcnt(2)
    s_add_u32 s44, s35, 0xa526000
    buffer_store_dwordx4 v[16:19], v0, s[20:23], s44 offen sc1
    s_waitcnt lgkmcnt(1)
    s_add_u32 s45, s35, 0xa52a000
    buffer_store_dwordx4 v[20:23], v0, s[20:23], s45 offen sc1
    s_waitcnt lgkmcnt(0)
    s_add_u32 s46, s35, 0xa52e000
    buffer_store_dwordx4 v[104:107], v0, s[20:23], s46 offen sc1
L1_end:
    s_endpgm
L1_md:
    s_load_dwordx2 s[52:53], s[0:1], 0
    s_load_dwordx4 s[36:39], s[0:1], 56
    s_load_dwordx4 s[40:43], s[0:1], 72
    s_waitcnt lgkmcnt(0)
    s_mov_b32 s8, s52
    s_mov_b32 s9, s53
    s_mov_b32 s10, 0x4e2000
    s_mov_b32 s11, 0x20000
    s_add_u32 s12, s30, 0xce4c800
    s_addc_u32 s13, s31, 0
    s_mov_b32 s14, 0x4e2000
    s_mov_b32 s15, 0x20000
    s_mov_b32 s16, s40
    s_mov_b32 s17, s41
    s_mov_b32 s18, 0x20
    s_mov_b32 s19, 0x20000
    s_mov_b32 s20, s38
    s_mov_b32 s21, s39
    s_mov_b32 s22, 0x40
    s_mov_b32 s23, 0x20000
    s_mov_b32 s24, s36
    s_mov_b32 s25, s37
    s_mov_b32 s26, 0x40
    s_mov_b32 s27, 0x20000
    s_mov_b32 s44, s42
    s_mov_b32 s45, s43
    s_mov_b32 s46, 0x20
    s_mov_b32 s47, 0x20000
    s_add_u32 s48, s30, 0xe6b7800
    s_addc_u32 s49, s31, 0
    s_mov_b32 s50, 0x100
    s_mov_b32 s51, 0x20000
    v_and_b32 v1, 3, v0
    v_lshlrev_b32 v2, 1, v1
    v_mov_b32 v18, 0
    v_mov_b32 v19, 0
    buffer_load_ushort v4, v2, s[16:19], 0 offen offset:0
    buffer_load_ushort v34, v2, s[16:19], 0 offen offset:8
    buffer_load_ushort v5, v2, s[16:19], 0 offen offset:16
    buffer_load_ushort v35, v2, s[16:19], 0 offen offset:24
    buffer_load_ushort v8, v2, s[20:23], 0 offen offset:0
    buffer_load_ushort v38, v2, s[20:23], 0 offen offset:8
    buffer_load_ushort v9, v2, s[20:23], 0 offen offset:16
    buffer_load_ushort v39, v2, s[20:23], 0 offen offset:24
    buffer_load_ushort v10, v2, s[20:23], 0 offen offset:32
    buffer_load_ushort v40, v2, s[20:23], 0 offen offset:40
    buffer_load_ushort v11, v2, s[20:23], 0 offen offset:48
    buffer_load_ushort v41, v2, s[20:23], 0 offen offset:56
    buffer_load_ushort v12, v2, s[24:27], 0 offen offset:0
    buffer_load_ushort v42, v2, s[24:27], 0 offen offset:8
    buffer_load_ushort v13, v2, s[24:27], 0 offen offset:16
    buffer_load_ushort v43, v2, s[24:27], 0 offen offset:24
    buffer_load_ushort v14, v2, s[24:27], 0 offen offset:32
    buffer_load_ushort v44, v2, s[24:27], 0 offen offset:40
    buffer_load_ushort v15, v2, s[24:27], 0 offen offset:48
    buffer_load_ushort v45, v2, s[24:27], 0 offen offset:56
    buffer_load_ushort v16, v2, s[44:47], 0 offen offset:0
    buffer_load_ushort v46, v2, s[44:47], 0 offen offset:8
    buffer_load_ushort v17, v2, s[44:47], 0 offen offset:16
    buffer_load_ushort v47, v2, s[44:47], 0 offen offset:24
    v_lshlrev_b32 v3, 6, v0
    s_waitcnt vmcnt(0)
    v_lshl_or_b32 v4, v34, 16, v4
    v_lshl_or_b32 v5, v35, 16, v5
    v_lshl_or_b32 v8, v38, 16, v8
    v_lshl_or_b32 v9, v39, 16, v9
    v_lshl_or_b32 v10, v40, 16, v10
    v_lshl_or_b32 v11, v41, 16, v11
    v_lshl_or_b32 v12, v42, 16, v12
    v_lshl_or_b32 v13, v43, 16, v13
    v_lshl_or_b32 v14, v44, 16, v14
    v_lshl_or_b32 v15, v45, 16, v15
    v_lshl_or_b32 v16, v46, 16, v16
    v_lshl_or_b32 v17, v47, 16, v17
    buffer_store_dwordx4 v[8:11], v3, s[48:51], 0 offen
    buffer_store_dwordx4 v[12:15], v3, s[48:51], 0 offen offset:16
    buffer_store_dwordx4 v[16:19], v3, s[48:51], 0 offen offset:32
    v_lshrrev_b32 v1, 4, v0
    v_and_b32 v2, 15, v0
    v_lshlrev_b32 v6, 9, v2
    v_lshl_add_u32 v6, v1, 3, v6
    s_mov_b32 s33, 80000
    v_mul_lo_u32 v7, v1, s33
    v_lshl_add_u32 v7, v2, 3, v7
    s_sub_u32 s32, s2, 250
L1_mdloop:
    s_mul_i32 s33, s32, 204800
    s_mul_i32 s34, s32, 3200
    buffer_load_dwordx2 v[20:21], v6, s[8:11], s33 offen
    s_add_u32 s33, s33, 8192
    buffer_load_dwordx2 v[22:23], v6, s[8:11], s33 offen
    s_add_u32 s33, s33, 8192
    buffer_load_dwordx2 v[24:25], v6, s[8:11], s33 offen
    s_add_u32 s33, s33, 8192
    buffer_load_dwordx2 v[26:27], v6, s[8:11], s33 offen
    s_add_u32 s33, s33, 8192
    buffer_load_dwordx2 v[28:29], v6, s[8:11], s33 offen
    s_add_u32 s33, s33, 8192
    buffer_load_dwordx2 v[30:31], v6, s[8:11], s33 offen
    s_add_u32 s33, s33, 8192
    buffer_load_dwordx2 v[32:33], v6, s[8:11], s33 offen
    s_add_u32 s33, s33, 8192
    buffer_load_dwordx2 v[34:35], v6, s[8:11], s33 offen
    s_add_u32 s33, s33, 8192
    buffer_load_dwordx2 v[36:37], v6, s[8:11], s33 offen
    s_add_u32 s33, s33, 8192
    buffer_load_dwordx2 v[38:39], v6, s[8:11], s33 offen
    s_add_u32 s33, s33, 8192
    buffer_load_dwordx2 v[40:41], v6, s[8:11], s33 offen
    s_add_u32 s33, s33, 8192
    buffer_load_dwordx2 v[42:43], v6, s[8:11], s33 offen
    s_add_u32 s33, s33, 8192
    buffer_load_dwordx2 v[44:45], v6, s[8:11], s33 offen
    s_add_u32 s33, s33, 8192
    buffer_load_dwordx2 v[46:47], v6, s[8:11], s33 offen
    s_add_u32 s33, s33, 8192
    buffer_load_dwordx2 v[48:49], v6, s[8:11], s33 offen
    s_add_u32 s33, s33, 8192
    buffer_load_dwordx2 v[50:51], v6, s[8:11], s33 offen
    s_add_u32 s33, s33, 8192
    buffer_load_dwordx2 v[52:53], v6, s[8:11], s33 offen
    s_add_u32 s33, s33, 8192
    buffer_load_dwordx2 v[54:55], v6, s[8:11], s33 offen
    s_add_u32 s33, s33, 8192
    buffer_load_dwordx2 v[56:57], v6, s[8:11], s33 offen
    s_add_u32 s33, s33, 8192
    buffer_load_dwordx2 v[58:59], v6, s[8:11], s33 offen
    s_add_u32 s33, s33, 8192
    buffer_load_dwordx2 v[60:61], v6, s[8:11], s33 offen
    s_add_u32 s33, s33, 8192
    buffer_load_dwordx2 v[62:63], v6, s[8:11], s33 offen
    s_add_u32 s33, s33, 8192
    buffer_load_dwordx2 v[64:65], v6, s[8:11], s33 offen
    s_add_u32 s33, s33, 8192
    buffer_load_dwordx2 v[66:67], v6, s[8:11], s33 offen
    s_add_u32 s33, s33, 8192
    buffer_load_dwordx2 v[68:69], v6, s[8:11], s33 offen
    s_add_u32 s33, s33, 8192
    s_waitcnt vmcnt(24)
    v_mfma_f32_4x4x4_16b_bf16 v[72:75], v[4:5], v[20:21], 0
    s_nop 4
    v_cvt_pk_bf16_f32 v20, v72, v73
    v_cvt_pk_bf16_f32 v21, v74, v75
    buffer_store_dwordx2 v[20:21], v7, s[12:15], s34 offen offset:0
    s_waitcnt vmcnt(24)
    v_mfma_f32_4x4x4_16b_bf16 v[76:79], v[4:5], v[22:23], 0
    s_nop 4
    v_cvt_pk_bf16_f32 v22, v76, v77
    v_cvt_pk_bf16_f32 v23, v78, v79
    buffer_store_dwordx2 v[22:23], v7, s[12:15], s34 offen offset:128
    s_waitcnt vmcnt(24)
    v_mfma_f32_4x4x4_16b_bf16 v[80:83], v[4:5], v[24:25], 0
    s_nop 4
    v_cvt_pk_bf16_f32 v24, v80, v81
    v_cvt_pk_bf16_f32 v25, v82, v83
    buffer_store_dwordx2 v[24:25], v7, s[12:15], s34 offen offset:256
    s_waitcnt vmcnt(24)
    v_mfma_f32_4x4x4_16b_bf16 v[84:87], v[4:5], v[26:27], 0
    s_nop 4
    v_cvt_pk_bf16_f32 v26, v84, v85
    v_cvt_pk_bf16_f32 v27, v86, v87
    buffer_store_dwordx2 v[26:27], v7, s[12:15], s34 offen offset:384
    s_waitcnt vmcnt(24)
    v_mfma_f32_4x4x4_16b_bf16 v[72:75], v[4:5], v[28:29], 0
    s_nop 4
    v_cvt_pk_bf16_f32 v28, v72, v73
    v_cvt_pk_bf16_f32 v29, v74, v75
    buffer_store_dwordx2 v[28:29], v7, s[12:15], s34 offen offset:512
    s_waitcnt vmcnt(24)
    v_mfma_f32_4x4x4_16b_bf16 v[76:79], v[4:5], v[30:31], 0
    s_nop 4
    v_cvt_pk_bf16_f32 v30, v76, v77
    v_cvt_pk_bf16_f32 v31, v78, v79
    buffer_store_dwordx2 v[30:31], v7, s[12:15], s34 offen offset:640
    s_waitcnt vmcnt(24)
    v_mfma_f32_4x4x4_16b_bf16 v[80:83], v[4:5], v[32:33], 0
    s_nop 4
    v_cvt_pk_bf16_f32 v32, v80, v81
    v_cvt_pk_bf16_f32 v33, v82, v83
    buffer_store_dwordx2 v[32:33], v7, s[12:15], s34 offen offset:768
    s_waitcnt vmcnt(24)
    v_mfma_f32_4x4x4_16b_bf16 v[84:87], v[4:5], v[34:35], 0
    s_nop 4
    v_cvt_pk_bf16_f32 v34, v84, v85
    v_cvt_pk_bf16_f32 v35, v86, v87
    buffer_store_dwordx2 v[34:35], v7, s[12:15], s34 offen offset:896
    s_waitcnt vmcnt(24)
    v_mfma_f32_4x4x4_16b_bf16 v[72:75], v[4:5], v[36:37], 0
    s_nop 4
    v_cvt_pk_bf16_f32 v36, v72, v73
    v_cvt_pk_bf16_f32 v37, v74, v75
    buffer_store_dwordx2 v[36:37], v7, s[12:15], s34 offen offset:1024
    s_waitcnt vmcnt(24)
    v_mfma_f32_4x4x4_16b_bf16 v[76:79], v[4:5], v[38:39], 0
    s_nop 4
    v_cvt_pk_bf16_f32 v38, v76, v77
    v_cvt_pk_bf16_f32 v39, v78, v79
    buffer_store_dwordx2 v[38:39], v7, s[12:15], s34 offen offset:1152
    s_waitcnt vmcnt(24)
    v_mfma_f32_4x4x4_16b_bf16 v[80:83], v[4:5], v[40:41], 0
    s_nop 4
    v_cvt_pk_bf16_f32 v40, v80, v81
    v_cvt_pk_bf16_f32 v41, v82, v83
    buffer_store_dwordx2 v[40:41], v7, s[12:15], s34 offen offset:1280
    s_waitcnt vmcnt(24)
    v_mfma_f32_4x4x4_16b_bf16 v[84:87], v[4:5], v[42:43], 0
    s_nop 4
    v_cvt_pk_bf16_f32 v42, v84, v85
    v_cvt_pk_bf16_f32 v43, v86, v87
    buffer_store_dwordx2 v[42:43], v7, s[12:15], s34 offen offset:1408
    s_waitcnt vmcnt(24)
    v_mfma_f32_4x4x4_16b_bf16 v[72:75], v[4:5], v[44:45], 0
    s_nop 4
    v_cvt_pk_bf16_f32 v44, v72, v73
    v_cvt_pk_bf16_f32 v45, v74, v75
    buffer_store_dwordx2 v[44:45], v7, s[12:15], s34 offen offset:1536
    s_waitcnt vmcnt(24)
    v_mfma_f32_4x4x4_16b_bf16 v[76:79], v[4:5], v[46:47], 0
    s_nop 4
    v_cvt_pk_bf16_f32 v46, v76, v77
    v_cvt_pk_bf16_f32 v47, v78, v79
    buffer_store_dwordx2 v[46:47], v7, s[12:15], s34 offen offset:1664
    s_waitcnt vmcnt(24)
    v_mfma_f32_4x4x4_16b_bf16 v[80:83], v[4:5], v[48:49], 0
    s_nop 4
    v_cvt_pk_bf16_f32 v48, v80, v81
    v_cvt_pk_bf16_f32 v49, v82, v83
    buffer_store_dwordx2 v[48:49], v7, s[12:15], s34 offen offset:1792
    s_waitcnt vmcnt(24)
    v_mfma_f32_4x4x4_16b_bf16 v[84:87], v[4:5], v[50:51], 0
    s_nop 4
    v_cvt_pk_bf16_f32 v50, v84, v85
    v_cvt_pk_bf16_f32 v51, v86, v87
    buffer_store_dwordx2 v[50:51], v7, s[12:15], s34 offen offset:1920
    s_waitcnt vmcnt(24)
    v_mfma_f32_4x4x4_16b_bf16 v[72:75], v[4:5], v[52:53], 0
    s_nop 4
    v_cvt_pk_bf16_f32 v52, v72, v73
    v_cvt_pk_bf16_f32 v53, v74, v75
    buffer_store_dwordx2 v[52:53], v7, s[12:15], s34 offen offset:2048
    s_waitcnt vmcnt(24)
    v_mfma_f32_4x4x4_16b_bf16 v[76:79], v[4:5], v[54:55], 0
    s_nop 4
    v_cvt_pk_bf16_f32 v54, v76, v77
    v_cvt_pk_bf16_f32 v55, v78, v79
    buffer_store_dwordx2 v[54:55], v7, s[12:15], s34 offen offset:2176
    s_waitcnt vmcnt(24)
    v_mfma_f32_4x4x4_16b_bf16 v[80:83], v[4:5], v[56:57], 0
    s_nop 4
    v_cvt_pk_bf16_f32 v56, v80, v81
    v_cvt_pk_bf16_f32 v57, v82, v83
    buffer_store_dwordx2 v[56:57], v7, s[12:15], s34 offen offset:2304
    s_waitcnt vmcnt(24)
    v_mfma_f32_4x4x4_16b_bf16 v[84:87], v[4:5], v[58:59], 0
    s_nop 4
    v_cvt_pk_bf16_f32 v58, v84, v85
    v_cvt_pk_bf16_f32 v59, v86, v87
    buffer_store_dwordx2 v[58:59], v7, s[12:15], s34 offen offset:2432
    s_waitcnt vmcnt(24)
    v_mfma_f32_4x4x4_16b_bf16 v[72:75], v[4:5], v[60:61], 0
    s_nop 4
    v_cvt_pk_bf16_f32 v60, v72, v73
    v_cvt_pk_bf16_f32 v61, v74, v75
    buffer_store_dwordx2 v[60:61], v7, s[12:15], s34 offen offset:2560
    s_waitcnt vmcnt(24)
    v_mfma_f32_4x4x4_16b_bf16 v[76:79], v[4:5], v[62:63], 0
    s_nop 4
    v_cvt_pk_bf16_f32 v62, v76, v77
    v_cvt_pk_bf16_f32 v63, v78, v79
    buffer_store_dwordx2 v[62:63], v7, s[12:15], s34 offen offset:2688
    s_waitcnt vmcnt(24)
    v_mfma_f32_4x4x4_16b_bf16 v[80:83], v[4:5], v[64:65], 0
    s_nop 4
    v_cvt_pk_bf16_f32 v64, v80, v81
    v_cvt_pk_bf16_f32 v65, v82, v83
    buffer_store_dwordx2 v[64:65], v7, s[12:15], s34 offen offset:2816
    s_waitcnt vmcnt(24)
    v_mfma_f32_4x4x4_16b_bf16 v[84:87], v[4:5], v[66:67], 0
    s_nop 4
    v_cvt_pk_bf16_f32 v66, v84, v85
    v_cvt_pk_bf16_f32 v67, v86, v87
    buffer_store_dwordx2 v[66:67], v7, s[12:15], s34 offen offset:2944
    s_waitcnt vmcnt(24)
    v_mfma_f32_4x4x4_16b_bf16 v[72:75], v[4:5], v[68:69], 0
    s_nop 4
    v_cvt_pk_bf16_f32 v68, v72, v73
    v_cvt_pk_bf16_f32 v69, v74, v75
    buffer_store_dwordx2 v[68:69], v7, s[12:15], s34 offen offset:3072
    s_waitcnt vmcnt(0)
    s_add_u32 s32, s32, 6
    s_cmp_lt_u32 s32, 25
    s_cbranch_scc1 L1_mdloop
    s_endpgm
.text
.globl gs_acc_kernel
.p2align 8
.type gs_acc_kernel,@function
gs_acc_kernel:
    s_cmp_ge_u32 s2, 256
    s_cbranch_scc1 L2_end
    s_load_dwordx2 s[30:31], s[0:1], 104
    v_lshrrev_b32 v16, 6, v0
    v_and_b32 v17, 63, v0
    v_readfirstlane_b32 s32, v16
    s_bfe_u32 s33, s2, 0x20001
    s_and_b32 s34, s2, 1
    s_lshl_b32 s34, s34, 5
    s_lshr_b32 s4, s2, 3
    s_add_u32 s34, s34, s4
    v_lshlrev_b32 v1, 2, v17
    v_and_b32 v2, 12, v1
    v_sub_u32 v3, 16, v2
    v_lshrrev_b32 v18, 2, v17
    v_mul_u32_u24 v19, 80, v16
    v_add_u32 v18, v18, v19
    v_mul_u32_u24 v4, 173056, v18
    v_or_b32 v4, 0xf0000000, v4
    v_mul_u32_u24 v6, 5120, v16
    v_lshl_add_u32 v6, v17, 4, v6
    v_add_u32 v7, 80000, v6
    v_and_b32 v18, 3, v0
    v_lshlrev_b32 v18, 4, v18
    v_mov_b32 v12, 0x3f80
    v_mov_b32 v13, 0
    v_lshlrev_b64 v[12:13], v18, v[12:13]
    v_and_b32 v18, 3, v0
    v_lshlrev_b32 v18, 4, v18
    v_mov_b32 v14, 0xbf80
    v_mov_b32 v15, 0
    v_lshlrev_b64 v[14:15], v18, v[14:15]
    s_mul_i32 s40, s33, 1280000
    v_mov_b32 v5, -1
    v_mov_b32 v118, 0
    s_mul_i32 s4, s4, 20
    s_lshl_b32 s5, s32, 1
    s_add_u32 s4, s4, s5
    s_lshl_b32 s4, s4, 7
    s_add_u32 s4, s4, s40
    s_add_u32 s4, s4, 0xfce73900
    s_cmp_lt_u32 s32, 10
    s_cselect_b64 exec, 3, 0
    v_lshl_add_u32 v5, v17, 7, s4
    v_mov_b32 v118, 80000
    s_mov_b64 exec, -1
    v_lshlrev_b32 v0, 4, v0
    v_mov_b32 v8, 0x1fff8
    v_mov_b32 v9, 0x07ff0000
    v_mov_b32 v10, 0x38000000
    v_mov_b32 v11, 0x80000000
    s_mov_b32 s44, 0x4000c0c
    s_mov_b32 s45, 0x4010c0c
    s_mov_b32 s46, 0x4020c0c
    s_mov_b32 s47, 0x4030c0c
    s_mul_i32 s38, s32, 1280
    s_add_u32 s38, s38, 20000
    s_add_u32 s48, s38, 257
    s_mul_i32 s39, s33, 2080
    s_lshl_b32 s3, s34, 3
    s_add_u32 s39, s39, s3
    s_mov_b32 s36, 0
    s_mov_b32 s35, 0
    s_mov_b32 s42, 0
    s_mov_b64 s[80:81], 0
    s_waitcnt lgkmcnt(0)
    s_mov_b32 s8, s30
    s_mov_b32 s9, s31
    s_mov_b32 s10, 0xd32e800
    s_mov_b32 s11, 0x20000
    s_add_u32 s12, s30, 0x28000
    s_addc_u32 s13, s31, 0
    s_mov_b32 s14, 0xce24800
    s_mov_b32 s15, 0x20000
    s_add_u32 s24, s30, 0x28000
    s_addc_u32 s25, s31, 0
    s_mov_b32 s26, 0xce24800
    s_mov_b32 s27, 0x20000
    s_add_u32 s16, s30, 0xce4c800
    s_addc_u32 s17, s31, 0
    s_mov_b32 s18, 0x4e2000
    s_mov_b32 s19, 0x20000
    s_add_u32 s20, s30, 0xd32f800
    s_addc_u32 s21, s31, 0
    s_mov_b32 s22, 0x13880
    s_mov_b32 s23, 0x20000
    s_lshl_b32 s3, s33, 6
    s_add_u32 s3, s3, s34
    s_mul_i32 s3, s3, 80000
    s_add_u32 s20, s20, s3
    s_addc_u32 s21, s21, 0
    v_add_u32 v116, 0x10000000, v4
    buffer_load_dwordx4 v[64:67], v116, s[12:15], s39 offen
    v_add_u32 v116, 0x102a4000, v4
    buffer_load_dwordx4 v[68:71], v116, s[12:15], s39 offen
    v_add_u32 v116, 0x10548000, v4
    buffer_load_dwordx4 v[72:75], v116, s[12:15], s39 offen
    v_add_u32 v116, 0x107ec000, v4
    buffer_load_dwordx4 v[76:79], v116, s[12:15], s39 offen
    v_add_u32 v116, 0x10a90000, v4
    buffer_load_dwordx4 v[80:83], v116, s[12:15], s39 offen
    buffer_load_dwordx4 v[44:47], v6, s[16:19], s40 offen offset:0
    buffer_load_dwordx4 v[48:51], v6, s[16:19], s40 offen offset:1024
    buffer_load_dwordx4 v[52:55], v6, s[16:19], s40 offen offset:2048
    buffer_load_dwordx4 v[56:59], v6, s[16:19], s40 offen offset:3072
    s_add_u32 s3, s40, 4096
    buffer_load_dwordx4 v[60:63], v6, s[16:19], s3 offen
    s_add_u32 s40, s40, 80000
    v_mov_b32 v88, 0
    v_mov_b32 v89, 0
    v_mov_b32 v90, 0
    v_mov_b32 v91, 0
    v_mov_b32 v92, 0
    v_mov_b32 v93, 0
    v_mov_b32 v94, 0
    v_mov_b32 v95, 0
    ds_write_b128 v0, v[88:91] offset:0
    ds_write_b128 v0, v[88:91] offset:16384
    ds_write_b128 v0, v[88:91] offset:32768
    ds_write_b128 v0, v[88:91] offset:49152
    v_add_u32 v116, 0x10000, v0
    v_cmp_gt_u32 vcc, 80000, v116
    s_mov_b64 exec, vcc
    ds_write_b128 v116, v[88:91]
    s_mov_b64 exec, -1
    s_waitcnt vmcnt(5)
    s_mov_b32 s37, s38
    s_setprio 3
    v_and_b32 v119, 0xffff, v64
    v_and_b32 v120, 0xffff, v66
    v_and_b32 v121, -4, v119
    v_add_u32 v121, v121, v2
L2_x1_0:
    v_sub_u32 v122, v120, v121
    v_sub_u32 v124, v119, v121
    v_med3_i32 v123, v122, 0, 4
    v_max_i32 v124, 0, v124
    v_cmp_gt_i32 vcc, v123, v124
    v_mad_u32_u24 v125, v121, 5, v4
    v_bfm_b32 v123, v123, 28
    v_bfm_b32 v124, v124, 28
    v_mbcnt_lo_u32_b32 v126, vcc_lo, 0
    v_mbcnt_hi_u32_b32 v126, vcc_hi, v126
    v_bitop3_b32 v125, v123, v124, v125 bitop3:0x9a
    v_add_lshl_u32 v126, v126, s37, 2
    s_bcnt1_i32_b64 s41, vcc
    s_mov_b64 exec, vcc
    ds_write_b32 v126, v125
    s_mov_b64 exec, -1
    v_cmp_gt_i32 vcc, v122, v3
    s_add_u32 s37, s37, s41
    s_min_u32 s37, s37, s48
    s_cbranch_vccnz L2_xe1_0
L2_xr1_0:
    s_setprio 2
    v_and_b32 v119, 0xffff, v68
    v_and_b32 v120, 0xffff, v70
    v_and_b32 v121, -4, v119
    v_add_u32 v121, v121, v2
    v_add_u32 v127, 0x2a4000, v4
L2_x1_1:
    v_sub_u32 v122, v120, v121
    v_sub_u32 v124, v119, v121
    v_med3_i32 v123, v122, 0, 4
    v_max_i32 v124, 0, v124
    v_cmp_gt_i32 vcc, v123, v124
    v_mad_u32_u24 v125, v121, 5, v127
    v_bfm_b32 v123, v123, 28
    v_bfm_b32 v124, v124, 28
    v_mbcnt_lo_u32_b32 v126, vcc_lo, 0
    v_mbcnt_hi_u32_b32 v126, vcc_hi, v126
    v_bitop3_b32 v125, v123, v124, v125 bitop3:0x9a
    v_add_lshl_u32 v126, v126, s37, 2
    s_bcnt1_i32_b64 s41, vcc
    s_mov_b64 exec, vcc
    ds_write_b32 v126, v125
    s_mov_b64 exec, -1
    v_cmp_gt_i32 vcc, v122, v3
    s_add_u32 s37, s37, s41
    s_min_u32 s37, s37, s48
    s_cbranch_vccnz L2_xe1_1
L2_xr1_1:
    s_setprio 1
    v_and_b32 v119, 0xffff, v72
    v_and_b32 v120, 0xffff, v74
    v_and_b32 v121, -4, v119
    v_add_u32 v121, v121, v2
    v_add_u32 v127, 0x548000, v4
L2_x1_2:
    v_sub_u32 v122, v120, v121
    v_sub_u32 v124, v119, v121
    v_med3_i32 v123, v122, 0, 4
    v_max_i32 v124, 0, v124
    v_cmp_gt_i32 vcc, v123, v124
    v_mad_u32_u24 v125, v121, 5, v127
    v_bfm_b32 v123, v123, 28
    v_bfm_b32 v124, v124, 28
    v_mbcnt_lo_u32_b32 v126, vcc_lo, 0
    v_mbcnt_hi_u32_b32 v126, vcc_hi, v126
    v_bitop3_b32 v125, v123, v124, v125 bitop3:0x9a
    v_add_lshl_u32 v126, v126, s37, 2
    s_bcnt1_i32_b64 s41, vcc
    s_mov_b64 exec, vcc
    ds_write_b32 v126, v125
    s_mov_b64 exec, -1
    v_cmp_gt_i32 vcc, v122, v3
    s_add_u32 s37, s37, s41
    s_min_u32 s37, s37, s48
    s_cbranch_vccnz L2_xe1_2
L2_xr1_2:
    s_setprio 0
    v_and_b32 v119, 0xffff, v76
    v_and_b32 v120, 0xffff, v78
    v_and_b32 v121, -4, v119
    v_add_u32 v121, v121, v2
    v_add_u32 v127, 0x7ec000, v4
L2_x1_3:
    v_sub_u32 v122, v120, v121
    v_sub_u32 v124, v119, v121
    v_med3_i32 v123, v122, 0, 4
    v_max_i32 v124, 0, v124
    v_cmp_gt_i32 vcc, v123, v124
    v_mad_u32_u24 v125, v121, 5, v127
    v_bfm_b32 v123, v123, 28
    v_bfm_b32 v124, v124, 28
    v_mbcnt_lo_u32_b32 v126, vcc_lo, 0
    v_mbcnt_hi_u32_b32 v126, vcc_hi, v126
    v_bitop3_b32 v125, v123, v124, v125 bitop3:0x9a
    v_add_lshl_u32 v126, v126, s37, 2
    s_bcnt1_i32_b64 s41, vcc
    s_mov_b64 exec, vcc
    ds_write_b32 v126, v125
    s_mov_b64 exec, -1
    v_cmp_gt_i32 vcc, v122, v3
    s_add_u32 s37, s37, s41
    s_min_u32 s37, s37, s48
    s_cbranch_vccnz L2_xe1_3
L2_xr1_3:
    v_and_b32 v119, 0xffff, v80
    v_and_b32 v120, 0xffff, v82
    v_and_b32 v121, -4, v119
    v_add_u32 v121, v121, v2
    v_add_u32 v127, 0xa90000, v4
L2_x1_4:
    v_sub_u32 v122, v120, v121
    v_sub_u32 v124, v119, v121
    v_med3_i32 v123, v122, 0, 4
    v_max_i32 v124, 0, v124
    v_cmp_gt_i32 vcc, v123, v124
    v_mad_u32_u24 v125, v121, 5, v127
    v_bfm_b32 v123, v123, 28
    v_bfm_b32 v124, v124, 28
    v_mbcnt_lo_u32_b32 v126, vcc_lo, 0
    v_mbcnt_hi_u32_b32 v126, vcc_hi, v126
    v_bitop3_b32 v125, v123, v124, v125 bitop3:0x9a
    v_add_lshl_u32 v126, v126, s37, 2
    s_bcnt1_i32_b64 s41, vcc
    s_mov_b64 exec, vcc
    ds_write_b32 v126, v125
    s_mov_b64 exec, -1
    v_cmp_gt_i32 vcc, v122, v3
    s_add_u32 s37, s37, s41
    s_min_u32 s37, s37, s48
    s_cbranch_vccnz L2_xe1_4
L2_xr1_4:
    s_lshl_b32 s3, s37, 2
    v_add_u32 v126, s3, v1
    ds_write_b32 v126, v5
    s_lshl_b32 s3, s38, 2
    v_add_u32 v126, s3, v1
    ds_read2st64_b32 v[40:41], v126 offset0:0 offset1:1
    ds_read2st64_b32 v[42:43], v126 offset0:2 offset1:3
    v_add_u32 v5, v118, v5
    s_sub_u32 s41, s37, s38
    s_sub_u32 s3, s41, 192
    s_cmp_gt_u32 s3, 64
    s_cbranch_scc1 L2_xf1
L2_xg1:
    s_waitcnt lgkmcnt(0)
    v_and_b32 v116, 0x0fffffff, v40
    v_mov_b32 v36, v40
    buffer_load_dwordx4 v[16:19], v116, s[8:11], 0 offen
    buffer_load_dword v32, v116, s[8:11], 0 offen offset:16
    v_and_b32 v116, 0x0fffffff, v41
    v_mov_b32 v37, v41
    buffer_load_dwordx4 v[20:23], v116, s[8:11], 0 offen
    buffer_load_dword v33, v116, s[8:11], 0 offen offset:16
    v_and_b32 v116, 0x0fffffff, v42
    v_mov_b32 v38, v42
    buffer_load_dwordx4 v[24:27], v116, s[8:11], 0 offen
    buffer_load_dword v34, v116, s[8:11], 0 offen offset:16
    v_and_b32 v116, 0x0fffffff, v43
    v_mov_b32 v39, v43
    buffer_load_dwordx4 v[28:31], v116, s[8:11], 0 offen
    buffer_load_dword v35, v116, s[8:11], 0 offen offset:16
    s_waitcnt vmcnt(8)
    s_mov_b32 s37, s38
    s_setprio 3
    ds_write_b128 v7, v[52:55] offset:2048
    buffer_load_dwordx4 v[52:55], v6, s[16:19], s40 offen offset:2048
    v_lshrrev_b32 v119, 16, v64
    v_lshrrev_b32 v120, 16, v66
    v_and_b32 v121, -4, v119
    v_add_u32 v121, v121, v2
L2_x2_0:
    v_sub_u32 v122, v120, v121
    v_sub_u32 v124, v119, v121
    v_med3_i32 v123, v122, 0, 4
    v_max_i32 v124, 0, v124
    v_cmp_gt_i32 vcc, v123, v124
    v_mad_u32_u24 v125, v121, 5, v4
    v_bfm_b32 v123, v123, 28
    v_bfm_b32 v124, v124, 28
    v_mbcnt_lo_u32_b32 v126, vcc_lo, 0
    v_mbcnt_hi_u32_b32 v126, vcc_hi, v126
    v_bitop3_b32 v125, v123, v124, v125 bitop3:0x9a
    v_add_lshl_u32 v126, v126, s37, 2
    s_bcnt1_i32_b64 s41, vcc
    s_mov_b64 exec, vcc
    ds_write_b32 v126, v125
    s_mov_b64 exec, -1
    v_cmp_gt_i32 vcc, v122, v3
    s_add_u32 s37, s37, s41
    s_min_u32 s37, s37, s48
    s_cbranch_vccnz L2_xe2_0
L2_xr2_0:
    s_setprio 2
    ds_write_b128 v7, v[56:59] offset:3072
    buffer_load_dwordx4 v[56:59], v6, s[16:19], s40 offen offset:3072
    v_lshrrev_b32 v119, 16, v68
    v_lshrrev_b32 v120, 16, v70
    v_and_b32 v121, -4, v119
    v_add_u32 v121, v121, v2
    v_add_u32 v127, 0x2a4000, v4
L2_x2_1:
    v_sub_u32 v122, v120, v121
    v_sub_u32 v124, v119, v121
    v_med3_i32 v123, v122, 0, 4
    v_max_i32 v124, 0, v124
    v_cmp_gt_i32 vcc, v123, v124
    v_mad_u32_u24 v125, v121, 5, v127
    v_bfm_b32 v123, v123, 28
    v_bfm_b32 v124, v124, 28
    v_mbcnt_lo_u32_b32 v126, vcc_lo, 0
    v_mbcnt_hi_u32_b32 v126, vcc_hi, v126
    v_bitop3_b32 v125, v123, v124, v125 bitop3:0x9a
    v_add_lshl_u32 v126, v126, s37, 2
    s_bcnt1_i32_b64 s41, vcc
    s_mov_b64 exec, vcc
    ds_write_b32 v126, v125
    s_mov_b64 exec, -1
    v_cmp_gt_i32 vcc, v122, v3
    s_add_u32 s37, s37, s41
    s_min_u32 s37, s37, s48
    s_cbranch_vccnz L2_xe2_1
L2_xr2_1:
    s_setprio 1
    ds_write_b128 v7, v[60:63] offset:4096
    s_add_u32 s3, s40, 4096
    buffer_load_dwordx4 v[60:63], v6, s[16:19], s3 offen
    v_lshrrev_b32 v119, 16, v72
    v_lshrrev_b32 v120, 16, v74
    v_and_b32 v121, -4, v119
    v_add_u32 v121, v121, v2
    v_add_u32 v127, 0x548000, v4
L2_x2_2:
    v_sub_u32 v122, v120, v121
    v_sub_u32 v124, v119, v121
    v_med3_i32 v123, v122, 0, 4
    v_max_i32 v124, 0, v124
    v_cmp_gt_i32 vcc, v123, v124
    v_mad_u32_u24 v125, v121, 5, v127
    v_bfm_b32 v123, v123, 28
    v_bfm_b32 v124, v124, 28
    v_mbcnt_lo_u32_b32 v126, vcc_lo, 0
    v_mbcnt_hi_u32_b32 v126, vcc_hi, v126
    v_bitop3_b32 v125, v123, v124, v125 bitop3:0x9a
    v_add_lshl_u32 v126, v126, s37, 2
    s_bcnt1_i32_b64 s41, vcc
    s_mov_b64 exec, vcc
    ds_write_b32 v126, v125
    s_mov_b64 exec, -1
    v_cmp_gt_i32 vcc, v122, v3
    s_add_u32 s37, s37, s41
    s_min_u32 s37, s37, s48
    s_cbranch_vccnz L2_xe2_2
L2_xr2_2:
    s_setprio 0
    v_lshrrev_b32 v119, 16, v76
    v_lshrrev_b32 v120, 16, v78
    v_and_b32 v121, -4, v119
    v_add_u32 v121, v121, v2
    v_add_u32 v127, 0x7ec000, v4
L2_x2_3:
    v_sub_u32 v122, v120, v121
    v_sub_u32 v124, v119, v121
    v_med3_i32 v123, v122, 0, 4
    v_max_i32 v124, 0, v124
    v_cmp_gt_i32 vcc, v123, v124
    v_mad_u32_u24 v125, v121, 5, v127
    v_bfm_b32 v123, v123, 28
    v_bfm_b32 v124, v124, 28
    v_mbcnt_lo_u32_b32 v126, vcc_lo, 0
    v_mbcnt_hi_u32_b32 v126, vcc_hi, v126
    v_bitop3_b32 v125, v123, v124, v125 bitop3:0x9a
    v_add_lshl_u32 v126, v126, s37, 2
    s_bcnt1_i32_b64 s41, vcc
    s_mov_b64 exec, vcc
    ds_write_b32 v126, v125
    s_mov_b64 exec, -1
    v_cmp_gt_i32 vcc, v122, v3
    s_add_u32 s37, s37, s41
    s_min_u32 s37, s37, s48
    s_cbranch_vccnz L2_xe2_3
L2_xr2_3:
    v_lshrrev_b32 v119, 16, v80
    v_lshrrev_b32 v120, 16, v82
    v_and_b32 v121, -4, v119
    v_add_u32 v121, v121, v2
    v_add_u32 v127, 0xa90000, v4
L2_x2_4:
    v_sub_u32 v122, v120, v121
    v_sub_u32 v124, v119, v121
    v_med3_i32 v123, v122, 0, 4
    v_max_i32 v124, 0, v124
    v_cmp_gt_i32 vcc, v123, v124
    v_mad_u32_u24 v125, v121, 5, v127
    v_bfm_b32 v123, v123, 28
    v_bfm_b32 v124, v124, 28
    v_mbcnt_lo_u32_b32 v126, vcc_lo, 0
    v_mbcnt_hi_u32_b32 v126, vcc_hi, v126
    v_bitop3_b32 v125, v123, v124, v125 bitop3:0x9a
    v_add_lshl_u32 v126, v126, s37, 2
    s_bcnt1_i32_b64 s41, vcc
    s_mov_b64 exec, vcc
    ds_write_b32 v126, v125
    s_mov_b64 exec, -1
    v_cmp_gt_i32 vcc, v122, v3
    s_add_u32 s37, s37, s41
    s_min_u32 s37, s37, s48
    s_cbranch_vccnz L2_xe2_4
L2_xr2_4:
    s_lshl_b32 s3, s37, 2
    v_add_u32 v126, s3, v1
    ds_write_b32 v126, v5
    s_lshl_b32 s3, s38, 2
    v_add_u32 v126, s3, v1
    ds_read2st64_b32 v[40:41], v126 offset0:0 offset1:1
    ds_read2st64_b32 v[42:43], v126 offset0:2 offset1:3
    v_add_u32 v5, v118, v5
    s_sub_u32 s41, s37, s38
    s_sub_u32 s3, s41, 192
    s_cmp_gt_u32 s3, 64
    s_cbranch_scc1 L2_xf2
L2_xg2:
    ds_write_b128 v7, v[44:47] offset:0
    ds_write_b128 v7, v[48:51] offset:1024
    s_waitcnt lgkmcnt(0)
    s_barrier
L2_loop:
    s_setprio 3
    s_waitcnt vmcnt(9)
    v_and_b32 v115, 0x20000000, v36
    v_lshrrev_b32 v116, 14, v17
    v_bitop3_b32 v116, v116, v8, v115 bitop3:0xea
    ds_read_b64 v[86:87], v116 offset:63616
    v_and_b32 v114, 0x10000000, v36
    v_lshrrev_b32 v116, 14, v16
    v_bitop3_b32 v116, v116, v8, v114 bitop3:0xea
    ds_read_b64 v[84:85], v116 offset:63616
    v_perm_b32 v112, v16, v32, s44
    v_bitop3_b32 v108, v16, v8, v114 bitop3:0xea
    v_perm_b32 v113, v17, v32, s45
    v_bitop3_b32 v109, v17, v8, v115 bitop3:0xea
    s_waitcnt lgkmcnt(1)
    v_mfma_f32_4x4x4_16b_bf16 v[100:103], v[12:13], v[86:87], 0
    s_waitcnt lgkmcnt(0)
    v_mfma_f32_4x4x4_16b_bf16 v[96:99], v[12:13], v[84:85], 0
    v_bitop3_b32 v112, v112, v9, v10 bitop3:0xea
    v_bitop3_b32 v112, v16, v11, v112 bitop3:0xea
    v_bitop3_b32 v113, v113, v9, v10 bitop3:0xea
    v_bitop3_b32 v113, v17, v11, v113 bitop3:0xea
    v_cmp_lt_u32 s[84:85], v8, v108
    v_mul_f32 v100, v113, v100
    v_mul_f32 v101, v113, v101
    v_mul_f32 v102, v113, v102
    v_mul_f32 v103, v113, v103
    v_mul_f32 v96, v112, v96
    v_mul_f32 v97, v112, v97
    v_mul_f32 v98, v112, v98
    v_mul_f32 v99, v112, v99
    buffer_load_dwordx4 v[44:47], v6, s[16:19], s40 offen offset:0
    buffer_load_dwordx4 v[48:51], v6, s[16:19], s40 offen offset:1024
    s_add_u32 s40, s40, 80000
    v_cmp_ne_u64 vcc, v[94:95], v[90:91]
    s_and_b64 s[82:83], vcc, s[80:81]
    s_cbranch_scc1 L2_c3
L2_d3:
    s_mov_b64 exec, vcc
    v_mfma_f32_4x4x4_16b_bf16 v[104:107], v[14:15], v[90:91], 0
    v_mov_b32 v117, v111
    s_or_b64 s[80:81], s[80:81], vcc
    v_mfma_f32_4x4x4_16b_bf16 v[104:107], v[12:13], v[94:95], v[104:107]
    s_mov_b64 exec, -1
    v_cmp_ne_u64 vcc, v[92:93], v[88:89]
    s_and_b64 s[82:83], vcc, s[80:81]
    s_cbranch_scc1 L2_c4
L2_d4:
    s_mov_b64 exec, vcc
    v_mfma_f32_4x4x4_16b_bf16 v[104:107], v[14:15], v[88:89], 0
    v_mov_b32 v117, v110
    s_or_b64 s[80:81], s[80:81], vcc
    v_mfma_f32_4x4x4_16b_bf16 v[104:107], v[12:13], v[92:93], v[104:107]
    s_mov_b64 exec, -1
    ds_read_b64 v[90:91], v109
    s_and_b64 exec, s[84:85], s[80:81]
    s_andn2_b64 s[80:81], s[80:81], s[84:85]
    v_mov_b32 v108, v117
    v_mov_b32 v96, v104
    v_mov_b32 v97, v105
    v_mov_b32 v98, v106
    v_mov_b32 v99, v107
    s_mov_b64 exec, -1
    ds_read_b64 v[88:89], v108
    v_and_b32 v115, 0x80000000, v36
    v_lshrrev_b32 v116, 14, v19
    v_bitop3_b32 v116, v116, v8, v115 bitop3:0xea
    ds_read_b64 v[86:87], v116 offset:63616
    v_and_b32 v114, 0x40000000, v36
    v_lshrrev_b32 v116, 14, v18
    v_bitop3_b32 v116, v116, v8, v114 bitop3:0xea
    ds_read_b64 v[84:85], v116 offset:63616
    s_waitcnt lgkmcnt(3)
    v_mfma_f32_4x4x4_16b_bf16 v[100:103], v[12:13], v[90:91], v[100:103]
    s_waitcnt lgkmcnt(2)
    v_mfma_f32_4x4x4_16b_bf16 v[96:99], v[12:13], v[88:89], v[96:99]
    v_perm_b32 v112, v18, v32, s46
    v_bitop3_b32 v110, v18, v8, v114 bitop3:0xea
    v_perm_b32 v113, v19, v32, s47
    v_bitop3_b32 v111, v19, v8, v115 bitop3:0xea
    v_cvt_pk_bf16_f32 v100, v100, v101
    v_cvt_pk_bf16_f32 v101, v102, v103
    ds_wrxchg_rtn_b64 v[94:95], v109, v[100:101]
    v_cvt_pk_bf16_f32 v96, v96, v97
    v_cvt_pk_bf16_f32 v97, v98, v99
    ds_wrxchg_rtn_b64 v[92:93], v108, v[96:97]
    s_waitcnt lgkmcnt(3)
    v_mfma_f32_4x4x4_16b_bf16 v[100:103], v[12:13], v[86:87], 0
    s_waitcnt lgkmcnt(2)
    v_mfma_f32_4x4x4_16b_bf16 v[96:99], v[12:13], v[84:85], 0
    v_bitop3_b32 v112, v112, v9, v10 bitop3:0xea
    v_bitop3_b32 v112, v18, v11, v112 bitop3:0xea
    v_bitop3_b32 v113, v113, v9, v10 bitop3:0xea
    v_bitop3_b32 v113, v19, v11, v113 bitop3:0xea
    v_mul_f32 v100, v113, v100
    v_mul_f32 v101, v113, v101
    v_mul_f32 v102, v113, v102
    v_mul_f32 v103, v113, v103
    v_mul_f32 v96, v112, v96
    v_mul_f32 v97, v112, v97
    v_mul_f32 v98, v112, v98
    v_mul_f32 v99, v112, v99
    v_and_b32 v116, 0x0fffffff, v40
    v_mov_b32 v36, v40
    buffer_load_dwordx4 v[16:19], v116, s[8:11], 0 offen
    buffer_load_dword v32, v116, s[8:11], 0 offen offset:16
    s_waitcnt lgkmcnt(1)
    v_cmp_ne_u64 vcc, v[94:95], v[90:91]
    s_and_b64 s[82:83], vcc, s[80:81]
    s_cbranch_scc1 L2_c5
L2_d5:
    s_mov_b64 exec, vcc
    v_mfma_f32_4x4x4_16b_bf16 v[104:107], v[14:15], v[90:91], 0
    v_mov_b32 v117, v109
    s_or_b64 s[80:81], s[80:81], vcc
    v_mfma_f32_4x4x4_16b_bf16 v[104:107], v[12:13], v[94:95], v[104:107]
    s_mov_b64 exec, -1
    s_waitcnt lgkmcnt(0)
    v_cmp_ne_u64 vcc, v[92:93], v[88:89]
    s_and_b64 s[82:83], vcc, s[80:81]
    s_cbranch_scc1 L2_c6
L2_d6:
    s_mov_b64 exec, vcc
    v_mfma_f32_4x4x4_16b_bf16 v[104:107], v[14:15], v[88:89], 0
    v_mov_b32 v117, v108
    s_or_b64 s[80:81], s[80:81], vcc
    v_mfma_f32_4x4x4_16b_bf16 v[104:107], v[12:13], v[92:93], v[104:107]
    s_mov_b64 exec, -1
    ds_read_b64 v[90:91], v111
    ds_read_b64 v[88:89], v110
    s_waitcnt vmcnt(11)
    v_and_b32 v115, 0x20000000, v37
    v_lshrrev_b32 v116, 14, v21
    v_bitop3_b32 v116, v116, v8, v115 bitop3:0xea
    ds_read_b64 v[86:87], v116 offset:63616
    v_and_b32 v114, 0x10000000, v37
    v_lshrrev_b32 v116, 14, v20
    v_bitop3_b32 v116, v116, v8, v114 bitop3:0xea
    ds_read_b64 v[84:85], v116 offset:63616
    s_waitcnt lgkmcnt(3)
    v_mfma_f32_4x4x4_16b_bf16 v[100:103], v[12:13], v[90:91], v[100:103]
    s_waitcnt lgkmcnt(2)
    v_mfma_f32_4x4x4_16b_bf16 v[96:99], v[12:13], v[88:89], v[96:99]
    v_perm_b32 v112, v20, v33, s44
    v_bitop3_b32 v108, v20, v8, v114 bitop3:0xea
    v_perm_b32 v113, v21, v33, s45
    v_bitop3_b32 v109, v21, v8, v115 bitop3:0xea
    v_cvt_pk_bf16_f32 v100, v100, v101
    v_cvt_pk_bf16_f32 v101, v102, v103
    ds_wrxchg_rtn_b64 v[94:95], v111, v[100:101]
    v_cvt_pk_bf16_f32 v96, v96, v97
    v_cvt_pk_bf16_f32 v97, v98, v99
    ds_wrxchg_rtn_b64 v[92:93], v110, v[96:97]
    s_setprio 2
    s_waitcnt lgkmcnt(3)
    v_mfma_f32_4x4x4_16b_bf16 v[100:103], v[12:13], v[86:87], 0
    s_waitcnt lgkmcnt(2)
    v_mfma_f32_4x4x4_16b_bf16 v[96:99], v[12:13], v[84:85], 0
    v_bitop3_b32 v112, v112, v9, v10 bitop3:0xea
    v_bitop3_b32 v112, v20, v11, v112 bitop3:0xea
    v_bitop3_b32 v113, v113, v9, v10 bitop3:0xea
    v_bitop3_b32 v113, v21, v11, v113 bitop3:0xea
    v_cmp_lt_u32 s[84:85], v8, v108
    v_mul_f32 v100, v113, v100
    v_mul_f32 v101, v113, v101
    v_mul_f32 v102, v113, v102
    v_mul_f32 v103, v113, v103
    v_mul_f32 v96, v112, v96
    v_mul_f32 v97, v112, v97
    v_mul_f32 v98, v112, v98
    v_mul_f32 v99, v112, v99
    s_waitcnt lgkmcnt(1)
    v_cmp_ne_u64 vcc, v[94:95], v[90:91]
    s_and_b64 s[82:83], vcc, s[80:81]
    s_cbranch_scc1 L2_c7
L2_d7:
    s_mov_b64 exec, vcc
    v_mfma_f32_4x4x4_16b_bf16 v[104:107], v[14:15], v[90:91], 0
    v_mov_b32 v117, v111
    s_or_b64 s[80:81], s[80:81], vcc
    v_mfma_f32_4x4x4_16b_bf16 v[104:107], v[12:13], v[94:95], v[104:107]
    s_mov_b64 exec, -1
    s_waitcnt lgkmcnt(0)
    v_cmp_ne_u64 vcc, v[92:93], v[88:89]
    s_and_b64 s[82:83], vcc, s[80:81]
    s_cbranch_scc1 L2_c8
L2_d8:
    s_mov_b64 exec, vcc
    v_mfma_f32_4x4x4_16b_bf16 v[104:107], v[14:15], v[88:89], 0
    v_mov_b32 v117, v110
    s_or_b64 s[80:81], s[80:81], vcc
    v_mfma_f32_4x4x4_16b_bf16 v[104:107], v[12:13], v[92:93], v[104:107]
    s_mov_b64 exec, -1
    ds_read_b64 v[90:91], v109
    s_and_b64 exec, s[84:85], s[80:81]
    s_andn2_b64 s[80:81], s[80:81], s[84:85]
    v_mov_b32 v108, v117
    v_mov_b32 v96, v104
    v_mov_b32 v97, v105
    v_mov_b32 v98, v106
    v_mov_b32 v99, v107
    s_mov_b64 exec, -1
    ds_read_b64 v[88:89], v108
    v_and_b32 v115, 0x80000000, v37
    v_lshrrev_b32 v116, 14, v23
    v_bitop3_b32 v116, v116, v8, v115 bitop3:0xea
    ds_read_b64 v[86:87], v116 offset:63616
    v_and_b32 v114, 0x40000000, v37
    v_lshrrev_b32 v116, 14, v22
    v_bitop3_b32 v116, v116, v8, v114 bitop3:0xea
    ds_read_b64 v[84:85], v116 offset:63616
    s_waitcnt lgkmcnt(3)
    v_mfma_f32_4x4x4_16b_bf16 v[100:103], v[12:13], v[90:91], v[100:103]
    s_waitcnt lgkmcnt(2)
    v_mfma_f32_4x4x4_16b_bf16 v[96:99], v[12:13], v[88:89], v[96:99]
    v_perm_b32 v112, v22, v33, s46
    v_bitop3_b32 v110, v22, v8, v114 bitop3:0xea
    v_perm_b32 v113, v23, v33, s47
    v_bitop3_b32 v111, v23, v8, v115 bitop3:0xea
    v_cvt_pk_bf16_f32 v100, v100, v101
    v_cvt_pk_bf16_f32 v101, v102, v103
    ds_wrxchg_rtn_b64 v[94:95], v109, v[100:101]
    v_cvt_pk_bf16_f32 v96, v96, v97
    v_cvt_pk_bf16_f32 v97, v98, v99
    ds_wrxchg_rtn_b64 v[92:93], v108, v[96:97]
    s_waitcnt lgkmcnt(3)
    v_mfma_f32_4x4x4_16b_bf16 v[100:103], v[12:13], v[86:87], 0
    s_waitcnt lgkmcnt(2)
    v_mfma_f32_4x4x4_16b_bf16 v[96:99], v[12:13], v[84:85], 0
    v_bitop3_b32 v112, v112, v9, v10 bitop3:0xea
    v_bitop3_b32 v112, v22, v11, v112 bitop3:0xea
    v_bitop3_b32 v113, v113, v9, v10 bitop3:0xea
    v_bitop3_b32 v113, v23, v11, v113 bitop3:0xea
    v_mul_f32 v100, v113, v100
    v_mul_f32 v101, v113, v101
    v_mul_f32 v102, v113, v102
    v_mul_f32 v103, v113, v103
    v_mul_f32 v96, v112, v96
    v_mul_f32 v97, v112, v97
    v_mul_f32 v98, v112, v98
    v_mul_f32 v99, v112, v99
    v_and_b32 v116, 0x0fffffff, v41
    v_mov_b32 v37, v41
    buffer_load_dwordx4 v[20:23], v116, s[8:11], 0 offen
    buffer_load_dword v33, v116, s[8:11], 0 offen offset:16
    s_waitcnt lgkmcnt(1)
    v_cmp_ne_u64 vcc, v[94:95], v[90:91]
    s_and_b64 s[82:83], vcc, s[80:81]
    s_cbranch_scc1 L2_c9
L2_d9:
    s_mov_b64 exec, vcc
    v_mfma_f32_4x4x4_16b_bf16 v[104:107], v[14:15], v[90:91], 0
    v_mov_b32 v117, v109
    s_or_b64 s[80:81], s[80:81], vcc
    v_mfma_f32_4x4x4_16b_bf16 v[104:107], v[12:13], v[94:95], v[104:107]
    s_mov_b64 exec, -1
    s_waitcnt lgkmcnt(0)
    v_cmp_ne_u64 vcc, v[92:93], v[88:89]
    s_and_b64 s[82:83], vcc, s[80:81]
    s_cbranch_scc1 L2_c10
L2_d10:
    s_mov_b64 exec, vcc
    v_mfma_f32_4x4x4_16b_bf16 v[104:107], v[14:15], v[88:89], 0
    v_mov_b32 v117, v108
    s_or_b64 s[80:81], s[80:81], vcc
    v_mfma_f32_4x4x4_16b_bf16 v[104:107], v[12:13], v[92:93], v[104:107]
    s_mov_b64 exec, -1
    ds_read_b64 v[90:91], v111
    ds_read_b64 v[88:89], v110
    s_waitcnt vmcnt(11)
    v_and_b32 v115, 0x20000000, v38
    v_lshrrev_b32 v116, 14, v25
    v_bitop3_b32 v116, v116, v8, v115 bitop3:0xea
    ds_read_b64 v[86:87], v116 offset:63616
    v_and_b32 v114, 0x10000000, v38
    v_lshrrev_b32 v116, 14, v24
    v_bitop3_b32 v116, v116, v8, v114 bitop3:0xea
    ds_read_b64 v[84:85], v116 offset:63616
    s_waitcnt lgkmcnt(3)
    v_mfma_f32_4x4x4_16b_bf16 v[100:103], v[12:13], v[90:91], v[100:103]
    s_waitcnt lgkmcnt(2)
    v_mfma_f32_4x4x4_16b_bf16 v[96:99], v[12:13], v[88:89], v[96:99]
    v_perm_b32 v112, v24, v34, s44
    v_bitop3_b32 v108, v24, v8, v114 bitop3:0xea
    v_perm_b32 v113, v25, v34, s45
    v_bitop3_b32 v109, v25, v8, v115 bitop3:0xea
    v_cvt_pk_bf16_f32 v100, v100, v101
    v_cvt_pk_bf16_f32 v101, v102, v103
    ds_wrxchg_rtn_b64 v[94:95], v111, v[100:101]
    v_cvt_pk_bf16_f32 v96, v96, v97
    v_cvt_pk_bf16_f32 v97, v98, v99
    ds_wrxchg_rtn_b64 v[92:93], v110, v[96:97]
    s_setprio 1
    s_waitcnt lgkmcnt(3)
    v_mfma_f32_4x4x4_16b_bf16 v[100:103], v[12:13], v[86:87], 0
    s_waitcnt lgkmcnt(2)
    v_mfma_f32_4x4x4_16b_bf16 v[96:99], v[12:13], v[84:85], 0
    v_bitop3_b32 v112, v112, v9, v10 bitop3:0xea
    v_bitop3_b32 v112, v24, v11, v112 bitop3:0xea
    v_bitop3_b32 v113, v113, v9, v10 bitop3:0xea
    v_bitop3_b32 v113, v25, v11, v113 bitop3:0xea
    v_cmp_lt_u32 s[84:85], v8, v108
    v_mul_f32 v100, v113, v100
    v_mul_f32 v101, v113, v101
    v_mul_f32 v102, v113, v102
    v_mul_f32 v103, v113, v103
    v_mul_f32 v96, v112, v96
    v_mul_f32 v97, v112, v97
    v_mul_f32 v98, v112, v98
    v_mul_f32 v99, v112, v99
    s_waitcnt lgkmcnt(1)
    v_cmp_ne_u64 vcc, v[94:95], v[90:91]
    s_and_b64 s[82:83], vcc, s[80:81]
    s_cbranch_scc1 L2_c11
L2_d11:
    s_mov_b64 exec, vcc
    v_mfma_f32_4x4x4_16b_bf16 v[104:107], v[14:15], v[90:91], 0
    v_mov_b32 v117, v111
    s_or_b64 s[80:81], s[80:81], vcc
    v_mfma_f32_4x4x4_16b_bf16 v[104:107], v[12:13], v[94:95], v[104:107]
    s_mov_b64 exec, -1
    s_waitcnt lgkmcnt(0)
    v_cmp_ne_u64 vcc, v[92:93], v[88:89]
    s_and_b64 s[82:83], vcc, s[80:81]
    s_cbranch_scc1 L2_c12
L2_d12:
    s_mov_b64 exec, vcc
    v_mfma_f32_4x4x4_16b_bf16 v[104:107], v[14:15], v[88:89], 0
    v_mov_b32 v117, v110
    s_or_b64 s[80:81], s[80:81], vcc
    v_mfma_f32_4x4x4_16b_bf16 v[104:107], v[12:13], v[92:93], v[104:107]
    s_mov_b64 exec, -1
    ds_read_b64 v[90:91], v109
    s_and_b64 exec, s[84:85], s[80:81]
    s_andn2_b64 s[80:81], s[80:81], s[84:85]
    v_mov_b32 v108, v117
    v_mov_b32 v96, v104
    v_mov_b32 v97, v105
    v_mov_b32 v98, v106
    v_mov_b32 v99, v107
    s_mov_b64 exec, -1
    ds_read_b64 v[88:89], v108
    v_and_b32 v115, 0x80000000, v38
    v_lshrrev_b32 v116, 14, v27
    v_bitop3_b32 v116, v116, v8, v115 bitop3:0xea
    ds_read_b64 v[86:87], v116 offset:63616
    v_and_b32 v114, 0x40000000, v38
    v_lshrrev_b32 v116, 14, v26
    v_bitop3_b32 v116, v116, v8, v114 bitop3:0xea
    ds_read_b64 v[84:85], v116 offset:63616
    s_waitcnt lgkmcnt(3)
    v_mfma_f32_4x4x4_16b_bf16 v[100:103], v[12:13], v[90:91], v[100:103]
    s_waitcnt lgkmcnt(2)
    v_mfma_f32_4x4x4_16b_bf16 v[96:99], v[12:13], v[88:89], v[96:99]
    v_perm_b32 v112, v26, v34, s46
    v_bitop3_b32 v110, v26, v8, v114 bitop3:0xea
    v_perm_b32 v113, v27, v34, s47
    v_bitop3_b32 v111, v27, v8, v115 bitop3:0xea
    v_cvt_pk_bf16_f32 v100, v100, v101
    v_cvt_pk_bf16_f32 v101, v102, v103
    ds_wrxchg_rtn_b64 v[94:95], v109, v[100:101]
    v_cvt_pk_bf16_f32 v96, v96, v97
    v_cvt_pk_bf16_f32 v97, v98, v99
    ds_wrxchg_rtn_b64 v[92:93], v108, v[96:97]
    s_waitcnt lgkmcnt(3)
    v_mfma_f32_4x4x4_16b_bf16 v[100:103], v[12:13], v[86:87], 0
    s_waitcnt lgkmcnt(2)
    v_mfma_f32_4x4x4_16b_bf16 v[96:99], v[12:13], v[84:85], 0
    v_bitop3_b32 v112, v112, v9, v10 bitop3:0xea
    v_bitop3_b32 v112, v26, v11, v112 bitop3:0xea
    v_bitop3_b32 v113, v113, v9, v10 bitop3:0xea
    v_bitop3_b32 v113, v27, v11, v113 bitop3:0xea
    v_mul_f32 v100, v113, v100
    v_mul_f32 v101, v113, v101
    v_mul_f32 v102, v113, v102
    v_mul_f32 v103, v113, v103
    v_mul_f32 v96, v112, v96
    v_mul_f32 v97, v112, v97
    v_mul_f32 v98, v112, v98
    v_mul_f32 v99, v112, v99
    v_and_b32 v116, 0x0fffffff, v42
    v_mov_b32 v38, v42
    buffer_load_dwordx4 v[24:27], v116, s[8:11], 0 offen
    buffer_load_dword v34, v116, s[8:11], 0 offen offset:16
    s_waitcnt lgkmcnt(1)
    v_cmp_ne_u64 vcc, v[94:95], v[90:91]
    s_and_b64 s[82:83], vcc, s[80:81]
    s_cbranch_scc1 L2_c13
L2_d13:
    s_mov_b64 exec, vcc
    v_mfma_f32_4x4x4_16b_bf16 v[104:107], v[14:15], v[90:91], 0
    v_mov_b32 v117, v109
    s_or_b64 s[80:81], s[80:81], vcc
    v_mfma_f32_4x4x4_16b_bf16 v[104:107], v[12:13], v[94:95], v[104:107]
    s_mov_b64 exec, -1
    s_waitcnt lgkmcnt(0)
    v_cmp_ne_u64 vcc, v[92:93], v[88:89]
    s_and_b64 s[82:83], vcc, s[80:81]
    s_cbranch_scc1 L2_c14
L2_d14:
    s_mov_b64 exec, vcc
    v_mfma_f32_4x4x4_16b_bf16 v[104:107], v[14:15], v[88:89], 0
    v_mov_b32 v117, v108
    s_or_b64 s[80:81], s[80:81], vcc
    v_mfma_f32_4x4x4_16b_bf16 v[104:107], v[12:13], v[92:93], v[104:107]
    s_mov_b64 exec, -1
    ds_read_b64 v[90:91], v111
    ds_read_b64 v[88:89], v110
    s_waitcnt vmcnt(11)
    v_and_b32 v115, 0x20000000, v39
    v_lshrrev_b32 v116, 14, v29
    v_bitop3_b32 v116, v116, v8, v115 bitop3:0xea
    ds_read_b64 v[86:87], v116 offset:63616
    v_and_b32 v114, 0x10000000, v39
    v_lshrrev_b32 v116, 14, v28
    v_bitop3_b32 v116, v116, v8, v114 bitop3:0xea
    ds_read_b64 v[84:85], v116 offset:63616
    s_waitcnt lgkmcnt(3)
    v_mfma_f32_4x4x4_16b_bf16 v[100:103], v[12:13], v[90:91], v[100:103]
    s_waitcnt lgkmcnt(2)
    v_mfma_f32_4x4x4_16b_bf16 v[96:99], v[12:13], v[88:89], v[96:99]
    v_perm_b32 v112, v28, v35, s44
    v_bitop3_b32 v108, v28, v8, v114 bitop3:0xea
    v_perm_b32 v113, v29, v35, s45
    v_bitop3_b32 v109, v29, v8, v115 bitop3:0xea
    v_cvt_pk_bf16_f32 v100, v100, v101
    v_cvt_pk_bf16_f32 v101, v102, v103
    ds_wrxchg_rtn_b64 v[94:95], v111, v[100:101]
    v_cvt_pk_bf16_f32 v96, v96, v97
    v_cvt_pk_bf16_f32 v97, v98, v99
    ds_wrxchg_rtn_b64 v[92:93], v110, v[96:97]
    s_setprio 0
    s_waitcnt lgkmcnt(3)
    v_mfma_f32_4x4x4_16b_bf16 v[100:103], v[12:13], v[86:87], 0
    s_waitcnt lgkmcnt(2)
    v_mfma_f32_4x4x4_16b_bf16 v[96:99], v[12:13], v[84:85], 0
    v_bitop3_b32 v112, v112, v9, v10 bitop3:0xea
    v_bitop3_b32 v112, v28, v11, v112 bitop3:0xea
    v_bitop3_b32 v113, v113, v9, v10 bitop3:0xea
    v_bitop3_b32 v113, v29, v11, v113 bitop3:0xea
    v_cmp_lt_u32 s[84:85], v8, v108
    v_mul_f32 v100, v113, v100
    v_mul_f32 v101, v113, v101
    v_mul_f32 v102, v113, v102
    v_mul_f32 v103, v113, v103
    v_mul_f32 v96, v112, v96
    v_mul_f32 v97, v112, v97
    v_mul_f32 v98, v112, v98
    v_mul_f32 v99, v112, v99
    s_waitcnt lgkmcnt(1)
    v_cmp_ne_u64 vcc, v[94:95], v[90:91]
    s_and_b64 s[82:83], vcc, s[80:81]
    s_cbranch_scc1 L2_c15
L2_d15:
    s_mov_b64 exec, vcc
    v_mfma_f32_4x4x4_16b_bf16 v[104:107], v[14:15], v[90:91], 0
    v_mov_b32 v117, v111
    s_or_b64 s[80:81], s[80:81], vcc
    v_mfma_f32_4x4x4_16b_bf16 v[104:107], v[12:13], v[94:95], v[104:107]
    s_mov_b64 exec, -1
    s_waitcnt lgkmcnt(0)
    v_cmp_ne_u64 vcc, v[92:93], v[88:89]
    s_and_b64 s[82:83], vcc, s[80:81]
    s_cbranch_scc1 L2_c16
L2_d16:
    s_mov_b64 exec, vcc
    v_mfma_f32_4x4x4_16b_bf16 v[104:107], v[14:15], v[88:89], 0
    v_mov_b32 v117, v110
    s_or_b64 s[80:81], s[80:81], vcc
    v_mfma_f32_4x4x4_16b_bf16 v[104:107], v[12:13], v[92:93], v[104:107]
    s_mov_b64 exec, -1
    ds_read_b64 v[90:91], v109
    s_and_b64 exec, s[84:85], s[80:81]
    s_andn2_b64 s[80:81], s[80:81], s[84:85]
    v_mov_b32 v108, v117
    v_mov_b32 v96, v104
    v_mov_b32 v97, v105
    v_mov_b32 v98, v106
    v_mov_b32 v99, v107
    s_mov_b64 exec, -1
    ds_read_b64 v[88:89], v108
    v_and_b32 v115, 0x80000000, v39
    v_lshrrev_b32 v116, 14, v31
    v_bitop3_b32 v116, v116, v8, v115 bitop3:0xea
    ds_read_b64 v[86:87], v116 offset:63616
    v_and_b32 v114, 0x40000000, v39
    v_lshrrev_b32 v116, 14, v30
    v_bitop3_b32 v116, v116, v8, v114 bitop3:0xea
    ds_read_b64 v[84:85], v116 offset:63616
    s_waitcnt lgkmcnt(3)
    v_mfma_f32_4x4x4_16b_bf16 v[100:103], v[12:13], v[90:91], v[100:103]
    s_waitcnt lgkmcnt(2)
    v_mfma_f32_4x4x4_16b_bf16 v[96:99], v[12:13], v[88:89], v[96:99]
    v_perm_b32 v112, v30, v35, s46
    v_bitop3_b32 v110, v30, v8, v114 bitop3:0xea
    v_perm_b32 v113, v31, v35, s47
    v_bitop3_b32 v111, v31, v8, v115 bitop3:0xea
    v_cvt_pk_bf16_f32 v100, v100, v101
    v_cvt_pk_bf16_f32 v101, v102, v103
    ds_wrxchg_rtn_b64 v[94:95], v109, v[100:101]
    v_cvt_pk_bf16_f32 v96, v96, v97
    v_cvt_pk_bf16_f32 v97, v98, v99
    ds_wrxchg_rtn_b64 v[92:93], v108, v[96:97]
    s_waitcnt lgkmcnt(3)
    v_mfma_f32_4x4x4_16b_bf16 v[100:103], v[12:13], v[86:87], 0
    s_waitcnt lgkmcnt(2)
    v_mfma_f32_4x4x4_16b_bf16 v[96:99], v[12:13], v[84:85], 0
    v_bitop3_b32 v112, v112, v9, v10 bitop3:0xea
    v_bitop3_b32 v112, v30, v11, v112 bitop3:0xea
    v_bitop3_b32 v113, v113, v9, v10 bitop3:0xea
    v_bitop3_b32 v113, v31, v11, v113 bitop3:0xea
    v_mul_f32 v100, v113, v100
    v_mul_f32 v101, v113, v101
    v_mul_f32 v102, v113, v102
    v_mul_f32 v103, v113, v103
    v_mul_f32 v96, v112, v96
    v_mul_f32 v97, v112, v97
    v_mul_f32 v98, v112, v98
    v_mul_f32 v99, v112, v99
    v_and_b32 v116, 0x0fffffff, v43
    v_mov_b32 v39, v43
    buffer_load_dwordx4 v[28:31], v116, s[8:11], 0 offen
    buffer_load_dword v35, v116, s[8:11], 0 offen offset:16
    s_waitcnt lgkmcnt(1)
    v_cmp_ne_u64 vcc, v[94:95], v[90:91]
    s_and_b64 s[82:83], vcc, s[80:81]
    s_cbranch_scc1 L2_c17
L2_d17:
    s_mov_b64 exec, vcc
    v_mfma_f32_4x4x4_16b_bf16 v[104:107], v[14:15], v[90:91], 0
    v_mov_b32 v117, v109
    s_or_b64 s[80:81], s[80:81], vcc
    v_mfma_f32_4x4x4_16b_bf16 v[104:107], v[12:13], v[94:95], v[104:107]
    s_mov_b64 exec, -1
    s_waitcnt lgkmcnt(0)
    v_cmp_ne_u64 vcc, v[92:93], v[88:89]
    s_and_b64 s[82:83], vcc, s[80:81]
    s_cbranch_scc1 L2_c18
L2_d18:
    s_mov_b64 exec, vcc
    v_mfma_f32_4x4x4_16b_bf16 v[104:107], v[14:15], v[88:89], 0
    v_mov_b32 v117, v108
    s_or_b64 s[80:81], s[80:81], vcc
    v_mfma_f32_4x4x4_16b_bf16 v[104:107], v[12:13], v[92:93], v[104:107]
    s_mov_b64 exec, -1
    ds_read_b64 v[90:91], v111
    ds_read_b64 v[88:89], v110
    s_waitcnt lgkmcnt(1)
    v_mfma_f32_4x4x4_16b_bf16 v[100:103], v[12:13], v[90:91], v[100:103]
    s_waitcnt lgkmcnt(0)
    v_mfma_f32_4x4x4_16b_bf16 v[96:99], v[12:13], v[88:89], v[96:99]
    s_nop 2
    v_cvt_pk_bf16_f32 v100, v100, v101
    v_cvt_pk_bf16_f32 v101, v102, v103
    ds_wrxchg_rtn_b64 v[94:95], v111, v[100:101]
    v_cvt_pk_bf16_f32 v96, v96, v97
    v_cvt_pk_bf16_f32 v97, v98, v99
    ds_wrxchg_rtn_b64 v[92:93], v110, v[96:97]
    s_bitcmp1_b32 s36, s42
    s_cbranch_scc1 L2_slow
L2_ret0:
    s_barrier
    s_waitcnt vmcnt(8)
    s_mov_b32 s37, s38
    s_setprio 3
    ds_write_b128 v7, v[52:55] offset:2048
    buffer_load_dwordx4 v[52:55], v6, s[16:19], s40 offen offset:2048
    v_and_b32 v119, 0xffff, v65
    v_and_b32 v120, 0xffff, v67
    v_and_b32 v121, -4, v119
    v_add_u32 v121, v121, v2
L2_x19_0:
    v_sub_u32 v122, v120, v121
    v_sub_u32 v124, v119, v121
    v_med3_i32 v123, v122, 0, 4
    v_max_i32 v124, 0, v124
    v_cmp_gt_i32 vcc, v123, v124
    v_mad_u32_u24 v125, v121, 5, v4
    v_bfm_b32 v123, v123, 28
    v_bfm_b32 v124, v124, 28
    v_mbcnt_lo_u32_b32 v126, vcc_lo, 0
    v_mbcnt_hi_u32_b32 v126, vcc_hi, v126
    v_bitop3_b32 v125, v123, v124, v125 bitop3:0x9a
    v_add_lshl_u32 v126, v126, s37, 2
    s_bcnt1_i32_b64 s41, vcc
    s_mov_b64 exec, vcc
    ds_write_b32 v126, v125
    s_mov_b64 exec, -1
    v_cmp_gt_i32 vcc, v122, v3
    s_add_u32 s37, s37, s41
    s_min_u32 s37, s37, s48
    s_cbranch_vccnz L2_xe19_0
L2_xr19_0:
    s_setprio 2
    ds_write_b128 v7, v[56:59] offset:3072
    buffer_load_dwordx4 v[56:59], v6, s[16:19], s40 offen offset:3072
    v_and_b32 v119, 0xffff, v69
    v_and_b32 v120, 0xffff, v71
    v_and_b32 v121, -4, v119
    v_add_u32 v121, v121, v2
    v_add_u32 v127, 0x2a4000, v4
L2_x19_1:
    v_sub_u32 v122, v120, v121
    v_sub_u32 v124, v119, v121
    v_med3_i32 v123, v122, 0, 4
    v_max_i32 v124, 0, v124
    v_cmp_gt_i32 vcc, v123, v124
    v_mad_u32_u24 v125, v121, 5, v127
    v_bfm_b32 v123, v123, 28
    v_bfm_b32 v124, v124, 28
    v_mbcnt_lo_u32_b32 v126, vcc_lo, 0
    v_mbcnt_hi_u32_b32 v126, vcc_hi, v126
    v_bitop3_b32 v125, v123, v124, v125 bitop3:0x9a
    v_add_lshl_u32 v126, v126, s37, 2
    s_bcnt1_i32_b64 s41, vcc
    s_mov_b64 exec, vcc
    ds_write_b32 v126, v125
    s_mov_b64 exec, -1
    v_cmp_gt_i32 vcc, v122, v3
    s_add_u32 s37, s37, s41
    s_min_u32 s37, s37, s48
    s_cbranch_vccnz L2_xe19_1
L2_xr19_1:
    s_setprio 1
    ds_write_b128 v7, v[60:63] offset:4096
    s_add_u32 s3, s40, 4096
    buffer_load_dwordx4 v[60:63], v6, s[16:19], s3 offen
    v_and_b32 v119, 0xffff, v73
    v_and_b32 v120, 0xffff, v75
    v_and_b32 v121, -4, v119
    v_add_u32 v121, v121, v2
    v_add_u32 v127, 0x548000, v4
L2_x19_2:
    v_sub_u32 v122, v120, v121
    v_sub_u32 v124, v119, v121
    v_med3_i32 v123, v122, 0, 4
    v_max_i32 v124, 0, v124
    v_cmp_gt_i32 vcc, v123, v124
    v_mad_u32_u24 v125, v121, 5, v127
    v_bfm_b32 v123, v123, 28
    v_bfm_b32 v124, v124, 28
    v_mbcnt_lo_u32_b32 v126, vcc_lo, 0
    v_mbcnt_hi_u32_b32 v126, vcc_hi, v126
    v_bitop3_b32 v125, v123, v124, v125 bitop3:0x9a
    v_add_lshl_u32 v126, v126, s37, 2
    s_bcnt1_i32_b64 s41, vcc
    s_mov_b64 exec, vcc
    ds_write_b32 v126, v125
    s_mov_b64 exec, -1
    v_cmp_gt_i32 vcc, v122, v3
    s_add_u32 s37, s37, s41
    s_min_u32 s37, s37, s48
    s_cbranch_vccnz L2_xe19_2
L2_xr19_2:
    s_setprio 0
    v_and_b32 v119, 0xffff, v77
    v_and_b32 v120, 0xffff, v79
    v_and_b32 v121, -4, v119
    v_add_u32 v121, v121, v2
    v_add_u32 v127, 0x7ec000, v4
L2_x19_3:
    v_sub_u32 v122, v120, v121
    v_sub_u32 v124, v119, v121
    v_med3_i32 v123, v122, 0, 4
    v_max_i32 v124, 0, v124
    v_cmp_gt_i32 vcc, v123, v124
    v_mad_u32_u24 v125, v121, 5, v127
    v_bfm_b32 v123, v123, 28
    v_bfm_b32 v124, v124, 28
    v_mbcnt_lo_u32_b32 v126, vcc_lo, 0
    v_mbcnt_hi_u32_b32 v126, vcc_hi, v126
    v_bitop3_b32 v125, v123, v124, v125 bitop3:0x9a
    v_add_lshl_u32 v126, v126, s37, 2
    s_bcnt1_i32_b64 s41, vcc
    s_mov_b64 exec, vcc
    ds_write_b32 v126, v125
    s_mov_b64 exec, -1
    v_cmp_gt_i32 vcc, v122, v3
    s_add_u32 s37, s37, s41
    s_min_u32 s37, s37, s48
    s_cbranch_vccnz L2_xe19_3
L2_xr19_3:
    v_and_b32 v119, 0xffff, v81
    v_and_b32 v120, 0xffff, v83
    v_and_b32 v121, -4, v119
    v_add_u32 v121, v121, v2
    v_add_u32 v127, 0xa90000, v4
L2_x19_4:
    v_sub_u32 v122, v120, v121
    v_sub_u32 v124, v119, v121
    v_med3_i32 v123, v122, 0, 4
    v_max_i32 v124, 0, v124
    v_cmp_gt_i32 vcc, v123, v124
    v_mad_u32_u24 v125, v121, 5, v127
    v_bfm_b32 v123, v123, 28
    v_bfm_b32 v124, v124, 28
    v_mbcnt_lo_u32_b32 v126, vcc_lo, 0
    v_mbcnt_hi_u32_b32 v126, vcc_hi, v126
    v_bitop3_b32 v125, v123, v124, v125 bitop3:0x9a
    v_add_lshl_u32 v126, v126, s37, 2
    s_bcnt1_i32_b64 s41, vcc
    s_mov_b64 exec, vcc
    ds_write_b32 v126, v125
    s_mov_b64 exec, -1
    v_cmp_gt_i32 vcc, v122, v3
    s_add_u32 s37, s37, s41
    s_min_u32 s37, s37, s48
    s_cbranch_vccnz L2_xe19_4
L2_xr19_4:
    s_lshl_b32 s3, s37, 2
    v_add_u32 v126, s3, v1
    ds_write_b32 v126, v5
    s_lshl_b32 s3, s38, 2
    v_add_u32 v126, s3, v1
    ds_read2st64_b32 v[40:41], v126 offset0:0 offset1:1
    ds_read2st64_b32 v[42:43], v126 offset0:2 offset1:3
    v_add_u32 v5, v118, v5
    s_sub_u32 s41, s37, s38
    s_sub_u32 s3, s41, 192
    s_cmp_gt_u32 s3, 64
    s_cbranch_scc1 L2_xf19
L2_xg19:
    ds_write_b128 v7, v[44:47] offset:0
    ds_write_b128 v7, v[48:51] offset:1024
    s_add_u32 s42, s42, 1
    s_waitcnt lgkmcnt(0)
    s_barrier
    s_setprio 3
    s_waitcnt vmcnt(9)
    v_and_b32 v115, 0x20000000, v36
    v_lshrrev_b32 v116, 14, v17
    v_bitop3_b32 v116, v116, v8, v115 bitop3:0xea
    ds_read_b64 v[86:87], v116 offset:63616
    v_and_b32 v114, 0x10000000, v36
    v_lshrrev_b32 v116, 14, v16
    v_bitop3_b32 v116, v116, v8, v114 bitop3:0xea
    ds_read_b64 v[84:85], v116 offset:63616
    v_perm_b32 v112, v16, v32, s44
    v_bitop3_b32 v108, v16, v8, v114 bitop3:0xea
    v_perm_b32 v113, v17, v32, s45
    v_bitop3_b32 v109, v17, v8, v115 bitop3:0xea
    s_waitcnt lgkmcnt(1)
    v_mfma_f32_4x4x4_16b_bf16 v[100:103], v[12:13], v[86:87], 0
    s_waitcnt lgkmcnt(0)
    v_mfma_f32_4x4x4_16b_bf16 v[96:99], v[12:13], v[84:85], 0
    v_bitop3_b32 v112, v112, v9, v10 bitop3:0xea
    v_bitop3_b32 v112, v16, v11, v112 bitop3:0xea
    v_bitop3_b32 v113, v113, v9, v10 bitop3:0xea
    v_bitop3_b32 v113, v17, v11, v113 bitop3:0xea
    v_cmp_lt_u32 s[84:85], v8, v108
    v_mul_f32 v100, v113, v100
    v_mul_f32 v101, v113, v101
    v_mul_f32 v102, v113, v102
    v_mul_f32 v103, v113, v103
    v_mul_f32 v96, v112, v96
    v_mul_f32 v97, v112, v97
    v_mul_f32 v98, v112, v98
    v_mul_f32 v99, v112, v99
    buffer_load_dwordx4 v[44:47], v6, s[16:19], s40 offen offset:0
    buffer_load_dwordx4 v[48:51], v6, s[16:19], s40 offen offset:1024
    s_add_u32 s40, s40, 80000
    v_cmp_ne_u64 vcc, v[94:95], v[90:91]
    s_and_b64 s[82:83], vcc, s[80:81]
    s_cbranch_scc1 L2_c20
L2_d20:
    s_mov_b64 exec, vcc
    v_mfma_f32_4x4x4_16b_bf16 v[104:107], v[14:15], v[90:91], 0
    v_mov_b32 v117, v111
    s_or_b64 s[80:81], s[80:81], vcc
    v_mfma_f32_4x4x4_16b_bf16 v[104:107], v[12:13], v[94:95], v[104:107]
    s_mov_b64 exec, -1
    v_cmp_ne_u64 vcc, v[92:93], v[88:89]
    s_and_b64 s[82:83], vcc, s[80:81]
    s_cbranch_scc1 L2_c21
L2_d21:
    s_mov_b64 exec, vcc
    v_mfma_f32_4x4x4_16b_bf16 v[104:107], v[14:15], v[88:89], 0
    v_mov_b32 v117, v110
    s_or_b64 s[80:81], s[80:81], vcc
    v_mfma_f32_4x4x4_16b_bf16 v[104:107], v[12:13], v[92:93], v[104:107]
    s_mov_b64 exec, -1
    ds_read_b64 v[90:91], v109
    s_and_b64 exec, s[84:85], s[80:81]
    s_andn2_b64 s[80:81], s[80:81], s[84:85]
    v_mov_b32 v108, v117
    v_mov_b32 v96, v104
    v_mov_b32 v97, v105
    v_mov_b32 v98, v106
    v_mov_b32 v99, v107
    s_mov_b64 exec, -1
    ds_read_b64 v[88:89], v108
    v_and_b32 v115, 0x80000000, v36
    v_lshrrev_b32 v116, 14, v19
    v_bitop3_b32 v116, v116, v8, v115 bitop3:0xea
    ds_read_b64 v[86:87], v116 offset:63616
    v_and_b32 v114, 0x40000000, v36
    v_lshrrev_b32 v116, 14, v18
    v_bitop3_b32 v116, v116, v8, v114 bitop3:0xea
    ds_read_b64 v[84:85], v116 offset:63616
    s_waitcnt lgkmcnt(3)
    v_mfma_f32_4x4x4_16b_bf16 v[100:103], v[12:13], v[90:91], v[100:103]
    s_waitcnt lgkmcnt(2)
    v_mfma_f32_4x4x4_16b_bf16 v[96:99], v[12:13], v[88:89], v[96:99]
    v_perm_b32 v112, v18, v32, s46
    v_bitop3_b32 v110, v18, v8, v114 bitop3:0xea
    v_perm_b32 v113, v19, v32, s47
    v_bitop3_b32 v111, v19, v8, v115 bitop3:0xea
    v_cvt_pk_bf16_f32 v100, v100, v101
    v_cvt_pk_bf16_f32 v101, v102, v103
    ds_wrxchg_rtn_b64 v[94:95], v109, v[100:101]
    v_cvt_pk_bf16_f32 v96, v96, v97
    v_cvt_pk_bf16_f32 v97, v98, v99
    ds_wrxchg_rtn_b64 v[92:93], v108, v[96:97]
    s_waitcnt lgkmcnt(3)
    v_mfma_f32_4x4x4_16b_bf16 v[100:103], v[12:13], v[86:87], 0
    s_waitcnt lgkmcnt(2)
    v_mfma_f32_4x4x4_16b_bf16 v[96:99], v[12:13], v[84:85], 0
    v_bitop3_b32 v112, v112, v9, v10 bitop3:0xea
    v_bitop3_b32 v112, v18, v11, v112 bitop3:0xea
    v_bitop3_b32 v113, v113, v9, v10 bitop3:0xea
    v_bitop3_b32 v113, v19, v11, v113 bitop3:0xea
    v_mul_f32 v100, v113, v100
    v_mul_f32 v101, v113, v101
    v_mul_f32 v102, v113, v102
    v_mul_f32 v103, v113, v103
    v_mul_f32 v96, v112, v96
    v_mul_f32 v97, v112, v97
    v_mul_f32 v98, v112, v98
    v_mul_f32 v99, v112, v99
    v_and_b32 v116, 0x0fffffff, v40
    v_mov_b32 v36, v40
    buffer_load_dwordx4 v[16:19], v116, s[8:11], 0 offen
    buffer_load_dword v32, v116, s[8:11], 0 offen offset:16
    s_waitcnt lgkmcnt(1)
    v_cmp_ne_u64 vcc, v[94:95], v[90:91]
    s_and_b64 s[82:83], vcc, s[80:81]
    s_cbranch_scc1 L2_c22
L2_d22:
    s_mov_b64 exec, vcc
    v_mfma_f32_4x4x4_16b_bf16 v[104:107], v[14:15], v[90:91], 0
    v_mov_b32 v117, v109
    s_or_b64 s[80:81], s[80:81], vcc
    v_mfma_f32_4x4x4_16b_bf16 v[104:107], v[12:13], v[94:95], v[104:107]
    s_mov_b64 exec, -1
    s_waitcnt lgkmcnt(0)
    v_cmp_ne_u64 vcc, v[92:93], v[88:89]
    s_and_b64 s[82:83], vcc, s[80:81]
    s_cbranch_scc1 L2_c23
L2_d23:
    s_mov_b64 exec, vcc
    v_mfma_f32_4x4x4_16b_bf16 v[104:107], v[14:15], v[88:89], 0
    v_mov_b32 v117, v108
    s_or_b64 s[80:81], s[80:81], vcc
    v_mfma_f32_4x4x4_16b_bf16 v[104:107], v[12:13], v[92:93], v[104:107]
    s_mov_b64 exec, -1
    ds_read_b64 v[90:91], v111
    ds_read_b64 v[88:89], v110
    s_waitcnt vmcnt(11)
    v_and_b32 v115, 0x20000000, v37
    v_lshrrev_b32 v116, 14, v21
    v_bitop3_b32 v116, v116, v8, v115 bitop3:0xea
    ds_read_b64 v[86:87], v116 offset:63616
    v_and_b32 v114, 0x10000000, v37
    v_lshrrev_b32 v116, 14, v20
    v_bitop3_b32 v116, v116, v8, v114 bitop3:0xea
    ds_read_b64 v[84:85], v116 offset:63616
    s_waitcnt lgkmcnt(3)
    v_mfma_f32_4x4x4_16b_bf16 v[100:103], v[12:13], v[90:91], v[100:103]
    s_waitcnt lgkmcnt(2)
    v_mfma_f32_4x4x4_16b_bf16 v[96:99], v[12:13], v[88:89], v[96:99]
    v_perm_b32 v112, v20, v33, s44
    v_bitop3_b32 v108, v20, v8, v114 bitop3:0xea
    v_perm_b32 v113, v21, v33, s45
    v_bitop3_b32 v109, v21, v8, v115 bitop3:0xea
    v_cvt_pk_bf16_f32 v100, v100, v101
    v_cvt_pk_bf16_f32 v101, v102, v103
    ds_wrxchg_rtn_b64 v[94:95], v111, v[100:101]
    v_cvt_pk_bf16_f32 v96, v96, v97
    v_cvt_pk_bf16_f32 v97, v98, v99
    ds_wrxchg_rtn_b64 v[92:93], v110, v[96:97]
    s_setprio 2
    s_waitcnt lgkmcnt(3)
    v_mfma_f32_4x4x4_16b_bf16 v[100:103], v[12:13], v[86:87], 0
    s_waitcnt lgkmcnt(2)
    v_mfma_f32_4x4x4_16b_bf16 v[96:99], v[12:13], v[84:85], 0
    v_bitop3_b32 v112, v112, v9, v10 bitop3:0xea
    v_bitop3_b32 v112, v20, v11, v112 bitop3:0xea
    v_bitop3_b32 v113, v113, v9, v10 bitop3:0xea
    v_bitop3_b32 v113, v21, v11, v113 bitop3:0xea
    v_cmp_lt_u32 s[84:85], v8, v108
    v_mul_f32 v100, v113, v100
    v_mul_f32 v101, v113, v101
    v_mul_f32 v102, v113, v102
    v_mul_f32 v103, v113, v103
    v_mul_f32 v96, v112, v96
    v_mul_f32 v97, v112, v97
    v_mul_f32 v98, v112, v98
    v_mul_f32 v99, v112, v99
    s_waitcnt lgkmcnt(1)
    v_cmp_ne_u64 vcc, v[94:95], v[90:91]
    s_and_b64 s[82:83], vcc, s[80:81]
    s_cbranch_scc1 L2_c24
L2_d24:
    s_mov_b64 exec, vcc
    v_mfma_f32_4x4x4_16b_bf16 v[104:107], v[14:15], v[90:91], 0
    v_mov_b32 v117, v111
    s_or_b64 s[80:81], s[80:81], vcc
    v_mfma_f32_4x4x4_16b_bf16 v[104:107], v[12:13], v[94:95], v[104:107]
    s_mov_b64 exec, -1
    s_waitcnt lgkmcnt(0)
    v_cmp_ne_u64 vcc, v[92:93], v[88:89]
    s_and_b64 s[82:83], vcc, s[80:81]
    s_cbranch_scc1 L2_c25
L2_d25:
    s_mov_b64 exec, vcc
    v_mfma_f32_4x4x4_16b_bf16 v[104:107], v[14:15], v[88:89], 0
    v_mov_b32 v117, v110
    s_or_b64 s[80:81], s[80:81], vcc
    v_mfma_f32_4x4x4_16b_bf16 v[104:107], v[12:13], v[92:93], v[104:107]
    s_mov_b64 exec, -1
    ds_read_b64 v[90:91], v109
    s_and_b64 exec, s[84:85], s[80:81]
    s_andn2_b64 s[80:81], s[80:81], s[84:85]
    v_mov_b32 v108, v117
    v_mov_b32 v96, v104
    v_mov_b32 v97, v105
    v_mov_b32 v98, v106
    v_mov_b32 v99, v107
    s_mov_b64 exec, -1
    ds_read_b64 v[88:89], v108
    v_and_b32 v115, 0x80000000, v37
    v_lshrrev_b32 v116, 14, v23
    v_bitop3_b32 v116, v116, v8, v115 bitop3:0xea
    ds_read_b64 v[86:87], v116 offset:63616
    v_and_b32 v114, 0x40000000, v37
    v_lshrrev_b32 v116, 14, v22
    v_bitop3_b32 v116, v116, v8, v114 bitop3:0xea
    ds_read_b64 v[84:85], v116 offset:63616
    s_waitcnt lgkmcnt(3)
    v_mfma_f32_4x4x4_16b_bf16 v[100:103], v[12:13], v[90:91], v[100:103]
    s_waitcnt lgkmcnt(2)
    v_mfma_f32_4x4x4_16b_bf16 v[96:99], v[12:13], v[88:89], v[96:99]
    v_perm_b32 v112, v22, v33, s46
    v_bitop3_b32 v110, v22, v8, v114 bitop3:0xea
    v_perm_b32 v113, v23, v33, s47
    v_bitop3_b32 v111, v23, v8, v115 bitop3:0xea
    v_cvt_pk_bf16_f32 v100, v100, v101
    v_cvt_pk_bf16_f32 v101, v102, v103
    ds_wrxchg_rtn_b64 v[94:95], v109, v[100:101]
    v_cvt_pk_bf16_f32 v96, v96, v97
    v_cvt_pk_bf16_f32 v97, v98, v99
    ds_wrxchg_rtn_b64 v[92:93], v108, v[96:97]
    s_waitcnt lgkmcnt(3)
    v_mfma_f32_4x4x4_16b_bf16 v[100:103], v[12:13], v[86:87], 0
    s_waitcnt lgkmcnt(2)
    v_mfma_f32_4x4x4_16b_bf16 v[96:99], v[12:13], v[84:85], 0
    v_bitop3_b32 v112, v112, v9, v10 bitop3:0xea
    v_bitop3_b32 v112, v22, v11, v112 bitop3:0xea
    v_bitop3_b32 v113, v113, v9, v10 bitop3:0xea
    v_bitop3_b32 v113, v23, v11, v113 bitop3:0xea
    v_mul_f32 v100, v113, v100
    v_mul_f32 v101, v113, v101
    v_mul_f32 v102, v113, v102
    v_mul_f32 v103, v113, v103
    v_mul_f32 v96, v112, v96
    v_mul_f32 v97, v112, v97
    v_mul_f32 v98, v112, v98
    v_mul_f32 v99, v112, v99
    v_and_b32 v116, 0x0fffffff, v41
    v_mov_b32 v37, v41
    buffer_load_dwordx4 v[20:23], v116, s[8:11], 0 offen
    buffer_load_dword v33, v116, s[8:11], 0 offen offset:16
    s_waitcnt lgkmcnt(1)
    v_cmp_ne_u64 vcc, v[94:95], v[90:91]
    s_and_b64 s[82:83], vcc, s[80:81]
    s_cbranch_scc1 L2_c26
L2_d26:
    s_mov_b64 exec, vcc
    v_mfma_f32_4x4x4_16b_bf16 v[104:107], v[14:15], v[90:91], 0
    v_mov_b32 v117, v109
    s_or_b64 s[80:81], s[80:81], vcc
    v_mfma_f32_4x4x4_16b_bf16 v[104:107], v[12:13], v[94:95], v[104:107]
    s_mov_b64 exec, -1
    s_waitcnt lgkmcnt(0)
    v_cmp_ne_u64 vcc, v[92:93], v[88:89]
    s_and_b64 s[82:83], vcc, s[80:81]
    s_cbranch_scc1 L2_c27
L2_d27:
    s_mov_b64 exec, vcc
    v_mfma_f32_4x4x4_16b_bf16 v[104:107], v[14:15], v[88:89], 0
    v_mov_b32 v117, v108
    s_or_b64 s[80:81], s[80:81], vcc
    v_mfma_f32_4x4x4_16b_bf16 v[104:107], v[12:13], v[92:93], v[104:107]
    s_mov_b64 exec, -1
    ds_read_b64 v[90:91], v111
    ds_read_b64 v[88:89], v110
    s_waitcnt vmcnt(11)
    v_and_b32 v115, 0x20000000, v38
    v_lshrrev_b32 v116, 14, v25
    v_bitop3_b32 v116, v116, v8, v115 bitop3:0xea
    ds_read_b64 v[86:87], v116 offset:63616
    v_and_b32 v114, 0x10000000, v38
    v_lshrrev_b32 v116, 14, v24
    v_bitop3_b32 v116, v116, v8, v114 bitop3:0xea
    ds_read_b64 v[84:85], v116 offset:63616
    s_waitcnt lgkmcnt(3)
    v_mfma_f32_4x4x4_16b_bf16 v[100:103], v[12:13], v[90:91], v[100:103]
    s_waitcnt lgkmcnt(2)
    v_mfma_f32_4x4x4_16b_bf16 v[96:99], v[12:13], v[88:89], v[96:99]
    v_perm_b32 v112, v24, v34, s44
    v_bitop3_b32 v108, v24, v8, v114 bitop3:0xea
    v_perm_b32 v113, v25, v34, s45
    v_bitop3_b32 v109, v25, v8, v115 bitop3:0xea
    v_cvt_pk_bf16_f32 v100, v100, v101
    v_cvt_pk_bf16_f32 v101, v102, v103
    ds_wrxchg_rtn_b64 v[94:95], v111, v[100:101]
    v_cvt_pk_bf16_f32 v96, v96, v97
    v_cvt_pk_bf16_f32 v97, v98, v99
    ds_wrxchg_rtn_b64 v[92:93], v110, v[96:97]
    s_setprio 1
    s_waitcnt lgkmcnt(3)
    v_mfma_f32_4x4x4_16b_bf16 v[100:103], v[12:13], v[86:87], 0
    s_waitcnt lgkmcnt(2)
    v_mfma_f32_4x4x4_16b_bf16 v[96:99], v[12:13], v[84:85], 0
    v_bitop3_b32 v112, v112, v9, v10 bitop3:0xea
    v_bitop3_b32 v112, v24, v11, v112 bitop3:0xea
    v_bitop3_b32 v113, v113, v9, v10 bitop3:0xea
    v_bitop3_b32 v113, v25, v11, v113 bitop3:0xea
    v_cmp_lt_u32 s[84:85], v8, v108
    v_mul_f32 v100, v113, v100
    v_mul_f32 v101, v113, v101
    v_mul_f32 v102, v113, v102
    v_mul_f32 v103, v113, v103
    v_mul_f32 v96, v112, v96
    v_mul_f32 v97, v112, v97
    v_mul_f32 v98, v112, v98
    v_mul_f32 v99, v112, v99
    s_waitcnt lgkmcnt(1)
    v_cmp_ne_u64 vcc, v[94:95], v[90:91]
    s_and_b64 s[82:83], vcc, s[80:81]
    s_cbranch_scc1 L2_c28
L2_d28:
    s_mov_b64 exec, vcc
    v_mfma_f32_4x4x4_16b_bf16 v[104:107], v[14:15], v[90:91], 0
    v_mov_b32 v117, v111
    s_or_b64 s[80:81], s[80:81], vcc
    v_mfma_f32_4x4x4_16b_bf16 v[104:107], v[12:13], v[94:95], v[104:107]
    s_mov_b64 exec, -1
    s_waitcnt lgkmcnt(0)
    v_cmp_ne_u64 vcc, v[92:93], v[88:89]
    s_and_b64 s[82:83], vcc, s[80:81]
    s_cbranch_scc1 L2_c29
L2_d29:
    s_mov_b64 exec, vcc
    v_mfma_f32_4x4x4_16b_bf16 v[104:107], v[14:15], v[88:89], 0
    v_mov_b32 v117, v110
    s_or_b64 s[80:81], s[80:81], vcc
    v_mfma_f32_4x4x4_16b_bf16 v[104:107], v[12:13], v[92:93], v[104:107]
    s_mov_b64 exec, -1
    ds_read_b64 v[90:91], v109
    s_and_b64 exec, s[84:85], s[80:81]
    s_andn2_b64 s[80:81], s[80:81], s[84:85]
    v_mov_b32 v108, v117
    v_mov_b32 v96, v104
    v_mov_b32 v97, v105
    v_mov_b32 v98, v106
    v_mov_b32 v99, v107
    s_mov_b64 exec, -1
    ds_read_b64 v[88:89], v108
    v_and_b32 v115, 0x80000000, v38
    v_lshrrev_b32 v116, 14, v27
    v_bitop3_b32 v116, v116, v8, v115 bitop3:0xea
    ds_read_b64 v[86:87], v116 offset:63616
    v_and_b32 v114, 0x40000000, v38
    v_lshrrev_b32 v116, 14, v26
    v_bitop3_b32 v116, v116, v8, v114 bitop3:0xea
    ds_read_b64 v[84:85], v116 offset:63616
    s_waitcnt lgkmcnt(3)
    v_mfma_f32_4x4x4_16b_bf16 v[100:103], v[12:13], v[90:91], v[100:103]
    s_waitcnt lgkmcnt(2)
    v_mfma_f32_4x4x4_16b_bf16 v[96:99], v[12:13], v[88:89], v[96:99]
    v_perm_b32 v112, v26, v34, s46
    v_bitop3_b32 v110, v26, v8, v114 bitop3:0xea
    v_perm_b32 v113, v27, v34, s47
    v_bitop3_b32 v111, v27, v8, v115 bitop3:0xea
    v_cvt_pk_bf16_f32 v100, v100, v101
    v_cvt_pk_bf16_f32 v101, v102, v103
    ds_wrxchg_rtn_b64 v[94:95], v109, v[100:101]
    v_cvt_pk_bf16_f32 v96, v96, v97
    v_cvt_pk_bf16_f32 v97, v98, v99
    ds_wrxchg_rtn_b64 v[92:93], v108, v[96:97]
    s_waitcnt lgkmcnt(3)
    v_mfma_f32_4x4x4_16b_bf16 v[100:103], v[12:13], v[86:87], 0
    s_waitcnt lgkmcnt(2)
    v_mfma_f32_4x4x4_16b_bf16 v[96:99], v[12:13], v[84:85], 0
    v_bitop3_b32 v112, v112, v9, v10 bitop3:0xea
    v_bitop3_b32 v112, v26, v11, v112 bitop3:0xea
    v_bitop3_b32 v113, v113, v9, v10 bitop3:0xea
    v_bitop3_b32 v113, v27, v11, v113 bitop3:0xea
    v_mul_f32 v100, v113, v100
    v_mul_f32 v101, v113, v101
    v_mul_f32 v102, v113, v102
    v_mul_f32 v103, v113, v103
    v_mul_f32 v96, v112, v96
    v_mul_f32 v97, v112, v97
    v_mul_f32 v98, v112, v98
    v_mul_f32 v99, v112, v99
    v_and_b32 v116, 0x0fffffff, v42
    v_mov_b32 v38, v42
    buffer_load_dwordx4 v[24:27], v116, s[8:11], 0 offen
    buffer_load_dword v34, v116, s[8:11], 0 offen offset:16
    s_waitcnt lgkmcnt(1)
    v_cmp_ne_u64 vcc, v[94:95], v[90:91]
    s_and_b64 s[82:83], vcc, s[80:81]
    s_cbranch_scc1 L2_c30
L2_d30:
    s_mov_b64 exec, vcc
    v_mfma_f32_4x4x4_16b_bf16 v[104:107], v[14:15], v[90:91], 0
    v_mov_b32 v117, v109
    s_or_b64 s[80:81], s[80:81], vcc
    v_mfma_f32_4x4x4_16b_bf16 v[104:107], v[12:13], v[94:95], v[104:107]
    s_mov_b64 exec, -1
    s_waitcnt lgkmcnt(0)
    v_cmp_ne_u64 vcc, v[92:93], v[88:89]
    s_and_b64 s[82:83], vcc, s[80:81]
    s_cbranch_scc1 L2_c31
L2_d31:
    s_mov_b64 exec, vcc
    v_mfma_f32_4x4x4_16b_bf16 v[104:107], v[14:15], v[88:89], 0
    v_mov_b32 v117, v108
    s_or_b64 s[80:81], s[80:81], vcc
    v_mfma_f32_4x4x4_16b_bf16 v[104:107], v[12:13], v[92:93], v[104:107]
    s_mov_b64 exec, -1
    ds_read_b64 v[90:91], v111
    ds_read_b64 v[88:89], v110
    s_waitcnt vmcnt(11)
    v_and_b32 v115, 0x20000000, v39
    v_lshrrev_b32 v116, 14, v29
    v_bitop3_b32 v116, v116, v8, v115 bitop3:0xea
    ds_read_b64 v[86:87], v116 offset:63616
    v_and_b32 v114, 0x10000000, v39
    v_lshrrev_b32 v116, 14, v28
    v_bitop3_b32 v116, v116, v8, v114 bitop3:0xea
    ds_read_b64 v[84:85], v116 offset:63616
    s_waitcnt lgkmcnt(3)
    v_mfma_f32_4x4x4_16b_bf16 v[100:103], v[12:13], v[90:91], v[100:103]
    s_waitcnt lgkmcnt(2)
    v_mfma_f32_4x4x4_16b_bf16 v[96:99], v[12:13], v[88:89], v[96:99]
    v_perm_b32 v112, v28, v35, s44
    v_bitop3_b32 v108, v28, v8, v114 bitop3:0xea
    v_perm_b32 v113, v29, v35, s45
    v_bitop3_b32 v109, v29, v8, v115 bitop3:0xea
    v_cvt_pk_bf16_f32 v100, v100, v101
    v_cvt_pk_bf16_f32 v101, v102, v103
    ds_wrxchg_rtn_b64 v[94:95], v111, v[100:101]
    v_cvt_pk_bf16_f32 v96, v96, v97
    v_cvt_pk_bf16_f32 v97, v98, v99
    ds_wrxchg_rtn_b64 v[92:93], v110, v[96:97]
    s_setprio 0
    s_waitcnt lgkmcnt(3)
    v_mfma_f32_4x4x4_16b_bf16 v[100:103], v[12:13], v[86:87], 0
    s_waitcnt lgkmcnt(2)
    v_mfma_f32_4x4x4_16b_bf16 v[96:99], v[12:13], v[84:85], 0
    v_bitop3_b32 v112, v112, v9, v10 bitop3:0xea
    v_bitop3_b32 v112, v28, v11, v112 bitop3:0xea
    v_bitop3_b32 v113, v113, v9, v10 bitop3:0xea
    v_bitop3_b32 v113, v29, v11, v113 bitop3:0xea
    v_cmp_lt_u32 s[84:85], v8, v108
    v_mul_f32 v100, v113, v100
    v_mul_f32 v101, v113, v101
    v_mul_f32 v102, v113, v102
    v_mul_f32 v103, v113, v103
    v_mul_f32 v96, v112, v96
    v_mul_f32 v97, v112, v97
    v_mul_f32 v98, v112, v98
    v_mul_f32 v99, v112, v99
    s_waitcnt lgkmcnt(1)
    v_cmp_ne_u64 vcc, v[94:95], v[90:91]
    s_and_b64 s[82:83], vcc, s[80:81]
    s_cbranch_scc1 L2_c32
L2_d32:
    s_mov_b64 exec, vcc
    v_mfma_f32_4x4x4_16b_bf16 v[104:107], v[14:15], v[90:91], 0
    v_mov_b32 v117, v111
    s_or_b64 s[80:81], s[80:81], vcc
    v_mfma_f32_4x4x4_16b_bf16 v[104:107], v[12:13], v[94:95], v[104:107]
    s_mov_b64 exec, -1
    s_waitcnt lgkmcnt(0)
    v_cmp_ne_u64 vcc, v[92:93], v[88:89]
    s_and_b64 s[82:83], vcc, s[80:81]
    s_cbranch_scc1 L2_c33
L2_d33:
    s_mov_b64 exec, vcc
    v_mfma_f32_4x4x4_16b_bf16 v[104:107], v[14:15], v[88:89], 0
    v_mov_b32 v117, v110
    s_or_b64 s[80:81], s[80:81], vcc
    v_mfma_f32_4x4x4_16b_bf16 v[104:107], v[12:13], v[92:93], v[104:107]
    s_mov_b64 exec, -1
    ds_read_b64 v[90:91], v109
    s_and_b64 exec, s[84:85], s[80:81]
    s_andn2_b64 s[80:81], s[80:81], s[84:85]
    v_mov_b32 v108, v117
    v_mov_b32 v96, v104
    v_mov_b32 v97, v105
    v_mov_b32 v98, v106
    v_mov_b32 v99, v107
    s_mov_b64 exec, -1
    ds_read_b64 v[88:89], v108
    v_and_b32 v115, 0x80000000, v39
    v_lshrrev_b32 v116, 14, v31
    v_bitop3_b32 v116, v116, v8, v115 bitop3:0xea
    ds_read_b64 v[86:87], v116 offset:63616
    v_and_b32 v114, 0x40000000, v39
    v_lshrrev_b32 v116, 14, v30
    v_bitop3_b32 v116, v116, v8, v114 bitop3:0xea
    ds_read_b64 v[84:85], v116 offset:63616
    s_waitcnt lgkmcnt(3)
    v_mfma_f32_4x4x4_16b_bf16 v[100:103], v[12:13], v[90:91], v[100:103]
    s_waitcnt lgkmcnt(2)
    v_mfma_f32_4x4x4_16b_bf16 v[96:99], v[12:13], v[88:89], v[96:99]
    v_perm_b32 v112, v30, v35, s46
    v_bitop3_b32 v110, v30, v8, v114 bitop3:0xea
    v_perm_b32 v113, v31, v35, s47
    v_bitop3_b32 v111, v31, v8, v115 bitop3:0xea
    v_cvt_pk_bf16_f32 v100, v100, v101
    v_cvt_pk_bf16_f32 v101, v102, v103
    ds_wrxchg_rtn_b64 v[94:95], v109, v[100:101]
    v_cvt_pk_bf16_f32 v96, v96, v97
    v_cvt_pk_bf16_f32 v97, v98, v99
    ds_wrxchg_rtn_b64 v[92:93], v108, v[96:97]
    s_waitcnt lgkmcnt(3)
    v_mfma_f32_4x4x4_16b_bf16 v[100:103], v[12:13], v[86:87], 0
    s_waitcnt lgkmcnt(2)
    v_mfma_f32_4x4x4_16b_bf16 v[96:99], v[12:13], v[84:85], 0
    v_bitop3_b32 v112, v112, v9, v10 bitop3:0xea
    v_bitop3_b32 v112, v30, v11, v112 bitop3:0xea
    v_bitop3_b32 v113, v113, v9, v10 bitop3:0xea
    v_bitop3_b32 v113, v31, v11, v113 bitop3:0xea
    v_mul_f32 v100, v113, v100
    v_mul_f32 v101, v113, v101
    v_mul_f32 v102, v113, v102
    v_mul_f32 v103, v113, v103
    v_mul_f32 v96, v112, v96
    v_mul_f32 v97, v112, v97
    v_mul_f32 v98, v112, v98
    v_mul_f32 v99, v112, v99
    v_and_b32 v116, 0x0fffffff, v43
    v_mov_b32 v39, v43
    buffer_load_dwordx4 v[28:31], v116, s[8:11], 0 offen
    buffer_load_dword v35, v116, s[8:11], 0 offen offset:16
    s_waitcnt lgkmcnt(1)
    v_cmp_ne_u64 vcc, v[94:95], v[90:91]
    s_and_b64 s[82:83], vcc, s[80:81]
    s_cbranch_scc1 L2_c34
L2_d34:
    s_mov_b64 exec, vcc
    v_mfma_f32_4x4x4_16b_bf16 v[104:107], v[14:15], v[90:91], 0
    v_mov_b32 v117, v109
    s_or_b64 s[80:81], s[80:81], vcc
    v_mfma_f32_4x4x4_16b_bf16 v[104:107], v[12:13], v[94:95], v[104:107]
    s_mov_b64 exec, -1
    s_waitcnt lgkmcnt(0)
    v_cmp_ne_u64 vcc, v[92:93], v[88:89]
    s_and_b64 s[82:83], vcc, s[80:81]
    s_cbranch_scc1 L2_c35
L2_d35:
    s_mov_b64 exec, vcc
    v_mfma_f32_4x4x4_16b_bf16 v[104:107], v[14:15], v[88:89], 0
    v_mov_b32 v117, v108
    s_or_b64 s[80:81], s[80:81], vcc
    v_mfma_f32_4x4x4_16b_bf16 v[104:107], v[12:13], v[92:93], v[104:107]
    s_mov_b64 exec, -1
    ds_read_b64 v[90:91], v111
    ds_read_b64 v[88:89], v110
    s_waitcnt lgkmcnt(1)
    v_mfma_f32_4x4x4_16b_bf16 v[100:103], v[12:13], v[90:91], v[100:103]
    s_waitcnt lgkmcnt(0)
    v_mfma_f32_4x4x4_16b_bf16 v[96:99], v[12:13], v[88:89], v[96:99]
    s_nop 2
    v_cvt_pk_bf16_f32 v100, v100, v101
    v_cvt_pk_bf16_f32 v101, v102, v103
    ds_wrxchg_rtn_b64 v[94:95], v111, v[100:101]
    v_cvt_pk_bf16_f32 v96, v96, v97
    v_cvt_pk_bf16_f32 v97, v98, v99
    ds_wrxchg_rtn_b64 v[92:93], v110, v[96:97]
    s_bitcmp1_b32 s36, s42
    s_cbranch_scc1 L2_slow
L2_ret1:
    s_barrier
    s_waitcnt vmcnt(8)
    s_mov_b32 s37, s38
    s_setprio 3
    ds_write_b128 v7, v[52:55] offset:2048
    buffer_load_dwordx4 v[52:55], v6, s[16:19], s40 offen offset:2048
    v_lshrrev_b32 v119, 16, v65
    v_lshrrev_b32 v120, 16, v67
    v_and_b32 v121, -4, v119
    v_add_u32 v121, v121, v2
L2_x36_0:
    v_sub_u32 v122, v120, v121
    v_sub_u32 v124, v119, v121
    v_med3_i32 v123, v122, 0, 4
    v_max_i32 v124, 0, v124
    v_cmp_gt_i32 vcc, v123, v124
    v_mad_u32_u24 v125, v121, 5, v4
    v_bfm_b32 v123, v123, 28
    v_bfm_b32 v124, v124, 28
    v_mbcnt_lo_u32_b32 v126, vcc_lo, 0
    v_mbcnt_hi_u32_b32 v126, vcc_hi, v126
    v_bitop3_b32 v125, v123, v124, v125 bitop3:0x9a
    v_add_lshl_u32 v126, v126, s37, 2
    s_bcnt1_i32_b64 s41, vcc
    s_mov_b64 exec, vcc
    ds_write_b32 v126, v125
    s_mov_b64 exec, -1
    v_cmp_gt_i32 vcc, v122, v3
    s_add_u32 s37, s37, s41
    s_min_u32 s37, s37, s48
    s_cbranch_vccnz L2_xe36_0
L2_xr36_0:
    s_setprio 2
    ds_write_b128 v7, v[56:59] offset:3072
    buffer_load_dwordx4 v[56:59], v6, s[16:19], s40 offen offset:3072
    v_lshrrev_b32 v119, 16, v69
    v_lshrrev_b32 v120, 16, v71
    v_and_b32 v121, -4, v119
    v_add_u32 v121, v121, v2
    v_add_u32 v127, 0x2a4000, v4
L2_x36_1:
    v_sub_u32 v122, v120, v121
    v_sub_u32 v124, v119, v121
    v_med3_i32 v123, v122, 0, 4
    v_max_i32 v124, 0, v124
    v_cmp_gt_i32 vcc, v123, v124
    v_mad_u32_u24 v125, v121, 5, v127
    v_bfm_b32 v123, v123, 28
    v_bfm_b32 v124, v124, 28
    v_mbcnt_lo_u32_b32 v126, vcc_lo, 0
    v_mbcnt_hi_u32_b32 v126, vcc_hi, v126
    v_bitop3_b32 v125, v123, v124, v125 bitop3:0x9a
    v_add_lshl_u32 v126, v126, s37, 2
    s_bcnt1_i32_b64 s41, vcc
    s_mov_b64 exec, vcc
    ds_write_b32 v126, v125
    s_mov_b64 exec, -1
    v_cmp_gt_i32 vcc, v122, v3
    s_add_u32 s37, s37, s41
    s_min_u32 s37, s37, s48
    s_cbranch_vccnz L2_xe36_1
L2_xr36_1:
    s_setprio 1
    ds_write_b128 v7, v[60:63] offset:4096
    s_add_u32 s3, s40, 4096
    buffer_load_dwordx4 v[60:63], v6, s[16:19], s3 offen
    v_lshrrev_b32 v119, 16, v73
    v_lshrrev_b32 v120, 16, v75
    v_and_b32 v121, -4, v119
    v_add_u32 v121, v121, v2
    v_add_u32 v127, 0x548000, v4
L2_x36_2:
    v_sub_u32 v122, v120, v121
    v_sub_u32 v124, v119, v121
    v_med3_i32 v123, v122, 0, 4
    v_max_i32 v124, 0, v124
    v_cmp_gt_i32 vcc, v123, v124
    v_mad_u32_u24 v125, v121, 5, v127
    v_bfm_b32 v123, v123, 28
    v_bfm_b32 v124, v124, 28
    v_mbcnt_lo_u32_b32 v126, vcc_lo, 0
    v_mbcnt_hi_u32_b32 v126, vcc_hi, v126
    v_bitop3_b32 v125, v123, v124, v125 bitop3:0x9a
    v_add_lshl_u32 v126, v126, s37, 2
    s_bcnt1_i32_b64 s41, vcc
    s_mov_b64 exec, vcc
    ds_write_b32 v126, v125
    s_mov_b64 exec, -1
    v_cmp_gt_i32 vcc, v122, v3
    s_add_u32 s37, s37, s41
    s_min_u32 s37, s37, s48
    s_cbranch_vccnz L2_xe36_2
L2_xr36_2:
    s_setprio 0
    v_lshrrev_b32 v119, 16, v77
    v_lshrrev_b32 v120, 16, v79
    v_and_b32 v121, -4, v119
    v_add_u32 v121, v121, v2
    v_add_u32 v127, 0x7ec000, v4
L2_x36_3:
    v_sub_u32 v122, v120, v121
    v_sub_u32 v124, v119, v121
    v_med3_i32 v123, v122, 0, 4
    v_max_i32 v124, 0, v124
    v_cmp_gt_i32 vcc, v123, v124
    v_mad_u32_u24 v125, v121, 5, v127
    v_bfm_b32 v123, v123, 28
    v_bfm_b32 v124, v124, 28
    v_mbcnt_lo_u32_b32 v126, vcc_lo, 0
    v_mbcnt_hi_u32_b32 v126, vcc_hi, v126
    v_bitop3_b32 v125, v123, v124, v125 bitop3:0x9a
    v_add_lshl_u32 v126, v126, s37, 2
    s_bcnt1_i32_b64 s41, vcc
    s_mov_b64 exec, vcc
    ds_write_b32 v126, v125
    s_mov_b64 exec, -1
    v_cmp_gt_i32 vcc, v122, v3
    s_add_u32 s37, s37, s41
    s_min_u32 s37, s37, s48
    s_cbranch_vccnz L2_xe36_3
L2_xr36_3:
    v_lshrrev_b32 v119, 16, v81
    v_lshrrev_b32 v120, 16, v83
    v_and_b32 v121, -4, v119
    v_add_u32 v121, v121, v2
    v_add_u32 v127, 0xa90000, v4
L2_x36_4:
    v_sub_u32 v122, v120, v121
    v_sub_u32 v124, v119, v121
    v_med3_i32 v123, v122, 0, 4
    v_max_i32 v124, 0, v124
    v_cmp_gt_i32 vcc, v123, v124
    v_mad_u32_u24 v125, v121, 5, v127
    v_bfm_b32 v123, v123, 28
    v_bfm_b32 v124, v124, 28
    v_mbcnt_lo_u32_b32 v126, vcc_lo, 0
    v_mbcnt_hi_u32_b32 v126, vcc_hi, v126
    v_bitop3_b32 v125, v123, v124, v125 bitop3:0x9a
    v_add_lshl_u32 v126, v126, s37, 2
    s_bcnt1_i32_b64 s41, vcc
    s_mov_b64 exec, vcc
    ds_write_b32 v126, v125
    s_mov_b64 exec, -1
    v_cmp_gt_i32 vcc, v122, v3
    s_add_u32 s37, s37, s41
    s_min_u32 s37, s37, s48
    s_cbranch_vccnz L2_xe36_4
L2_xr36_4:
    s_lshl_b32 s3, s37, 2
    v_add_u32 v126, s3, v1
    ds_write_b32 v126, v5
    s_lshl_b32 s3, s38, 2
    v_add_u32 v126, s3, v1
    ds_read2st64_b32 v[40:41], v126 offset0:0 offset1:1
    ds_read2st64_b32 v[42:43], v126 offset0:2 offset1:3
    v_add_u32 v5, v118, v5
    s_sub_u32 s41, s37, s38
    s_sub_u32 s3, s41, 192
    s_cmp_gt_u32 s3, 64
    s_cbranch_scc1 L2_xf36
L2_xg36:
    ds_write_b128 v7, v[44:47] offset:0
    ds_write_b128 v7, v[48:51] offset:1024
    s_add_u32 s42, s42, 1
    s_waitcnt lgkmcnt(0)
    s_barrier
    s_setprio 3
    s_waitcnt vmcnt(9)
    v_and_b32 v115, 0x20000000, v36
    v_lshrrev_b32 v116, 14, v17
    v_bitop3_b32 v116, v116, v8, v115 bitop3:0xea
    ds_read_b64 v[86:87], v116 offset:63616
    v_and_b32 v114, 0x10000000, v36
    v_lshrrev_b32 v116, 14, v16
    v_bitop3_b32 v116, v116, v8, v114 bitop3:0xea
    ds_read_b64 v[84:85], v116 offset:63616
    v_perm_b32 v112, v16, v32, s44
    v_bitop3_b32 v108, v16, v8, v114 bitop3:0xea
    v_perm_b32 v113, v17, v32, s45
    v_bitop3_b32 v109, v17, v8, v115 bitop3:0xea
    s_waitcnt lgkmcnt(1)
    v_mfma_f32_4x4x4_16b_bf16 v[100:103], v[12:13], v[86:87], 0
    s_waitcnt lgkmcnt(0)
    v_mfma_f32_4x4x4_16b_bf16 v[96:99], v[12:13], v[84:85], 0
    v_bitop3_b32 v112, v112, v9, v10 bitop3:0xea
    v_bitop3_b32 v112, v16, v11, v112 bitop3:0xea
    v_bitop3_b32 v113, v113, v9, v10 bitop3:0xea
    v_bitop3_b32 v113, v17, v11, v113 bitop3:0xea
    v_cmp_lt_u32 s[84:85], v8, v108
    v_mul_f32 v100, v113, v100
    v_mul_f32 v101, v113, v101
    v_mul_f32 v102, v113, v102
    v_mul_f32 v103, v113, v103
    v_mul_f32 v96, v112, v96
    v_mul_f32 v97, v112, v97
    v_mul_f32 v98, v112, v98
    v_mul_f32 v99, v112, v99
    s_cmp_eq_u32 s35, 3
    s_cselect_b32 s14, 0, s14
    s_mul_i32 s3, s35, 520
    s_add_u32 s3, s3, 520
    s_add_u32 s49, s3, s39
    buffer_load_dwordx4 v[44:47], v6, s[16:19], s40 offen offset:0
    buffer_load_dwordx4 v[48:51], v6, s[16:19], s40 offen offset:1024
    s_add_u32 s40, s40, 80000
    v_add_u32 v116, 0x10000000, v4
    buffer_load_dwordx4 v[64:67], v116, s[12:15], s49 offen
    v_cmp_ne_u64 vcc, v[94:95], v[90:91]
    s_and_b64 s[82:83], vcc, s[80:81]
    s_cbranch_scc1 L2_c37
L2_d37:
    s_mov_b64 exec, vcc
    v_mfma_f32_4x4x4_16b_bf16 v[104:107], v[14:15], v[90:91], 0
    v_mov_b32 v117, v111
    s_or_b64 s[80:81], s[80:81], vcc
    v_mfma_f32_4x4x4_16b_bf16 v[104:107], v[12:13], v[94:95], v[104:107]
    s_mov_b64 exec, -1
    v_cmp_ne_u64 vcc, v[92:93], v[88:89]
    s_and_b64 s[82:83], vcc, s[80:81]
    s_cbranch_scc1 L2_c38
L2_d38:
    s_mov_b64 exec, vcc
    v_mfma_f32_4x4x4_16b_bf16 v[104:107], v[14:15], v[88:89], 0
    v_mov_b32 v117, v110
    s_or_b64 s[80:81], s[80:81], vcc
    v_mfma_f32_4x4x4_16b_bf16 v[104:107], v[12:13], v[92:93], v[104:107]
    s_mov_b64 exec, -1
    ds_read_b64 v[90:91], v109
    s_and_b64 exec, s[84:85], s[80:81]
    s_andn2_b64 s[80:81], s[80:81], s[84:85]
    v_mov_b32 v108, v117
    v_mov_b32 v96, v104
    v_mov_b32 v97, v105
    v_mov_b32 v98, v106
    v_mov_b32 v99, v107
    s_mov_b64 exec, -1
    ds_read_b64 v[88:89], v108
    v_and_b32 v115, 0x80000000, v36
    v_lshrrev_b32 v116, 14, v19
    v_bitop3_b32 v116, v116, v8, v115 bitop3:0xea
    ds_read_b64 v[86:87], v116 offset:63616
    v_and_b32 v114, 0x40000000, v36
    v_lshrrev_b32 v116, 14, v18
    v_bitop3_b32 v116, v116, v8, v114 bitop3:0xea
    ds_read_b64 v[84:85], v116 offset:63616
    s_waitcnt lgkmcnt(3)
    v_mfma_f32_4x4x4_16b_bf16 v[100:103], v[12:13], v[90:91], v[100:103]
    s_waitcnt lgkmcnt(2)
    v_mfma_f32_4x4x4_16b_bf16 v[96:99], v[12:13], v[88:89], v[96:99]
    v_perm_b32 v112, v18, v32, s46
    v_bitop3_b32 v110, v18, v8, v114 bitop3:0xea
    v_perm_b32 v113, v19, v32, s47
    v_bitop3_b32 v111, v19, v8, v115 bitop3:0xea
    v_cvt_pk_bf16_f32 v100, v100, v101
    v_cvt_pk_bf16_f32 v101, v102, v103
    ds_wrxchg_rtn_b64 v[94:95], v109, v[100:101]
    v_cvt_pk_bf16_f32 v96, v96, v97
    v_cvt_pk_bf16_f32 v97, v98, v99
    ds_wrxchg_rtn_b64 v[92:93], v108, v[96:97]
    s_waitcnt lgkmcnt(3)
    v_mfma_f32_4x4x4_16b_bf16 v[100:103], v[12:13], v[86:87], 0
    s_waitcnt lgkmcnt(2)
    v_mfma_f32_4x4x4_16b_bf16 v[96:99], v[12:13], v[84:85], 0
    v_bitop3_b32 v112, v112, v9, v10 bitop3:0xea
    v_bitop3_b32 v112, v18, v11, v112 bitop3:0xea
    v_bitop3_b32 v113, v113, v9, v10 bitop3:0xea
    v_bitop3_b32 v113, v19, v11, v113 bitop3:0xea
    v_mul_f32 v100, v113, v100
    v_mul_f32 v101, v113, v101
    v_mul_f32 v102, v113, v102
    v_mul_f32 v103, v113, v103
    v_mul_f32 v96, v112, v96
    v_mul_f32 v97, v112, v97
    v_mul_f32 v98, v112, v98
    v_mul_f32 v99, v112, v99
    v_and_b32 v116, 0x0fffffff, v40
    v_mov_b32 v36, v40
    buffer_load_dwordx4 v[16:19], v116, s[8:11], 0 offen
    buffer_load_dword v32, v116, s[8:11], 0 offen offset:16
    s_waitcnt lgkmcnt(1)
    v_cmp_ne_u64 vcc, v[94:95], v[90:91]
    s_and_b64 s[82:83], vcc, s[80:81]
    s_cbranch_scc1 L2_c39
L2_d39:
    s_mov_b64 exec, vcc
    v_mfma_f32_4x4x4_16b_bf16 v[104:107], v[14:15], v[90:91], 0
    v_mov_b32 v117, v109
    s_or_b64 s[80:81], s[80:81], vcc
    v_mfma_f32_4x4x4_16b_bf16 v[104:107], v[12:13], v[94:95], v[104:107]
    s_mov_b64 exec, -1
    s_waitcnt lgkmcnt(0)
    v_cmp_ne_u64 vcc, v[92:93], v[88:89]
    s_and_b64 s[82:83], vcc, s[80:81]
    s_cbranch_scc1 L2_c40
L2_d40:
    s_mov_b64 exec, vcc
    v_mfma_f32_4x4x4_16b_bf16 v[104:107], v[14:15], v[88:89], 0
    v_mov_b32 v117, v108
    s_or_b64 s[80:81], s[80:81], vcc
    v_mfma_f32_4x4x4_16b_bf16 v[104:107], v[12:13], v[92:93], v[104:107]
    s_mov_b64 exec, -1
    ds_read_b64 v[90:91], v111
    ds_read_b64 v[88:89], v110
    s_waitcnt vmcnt(12)
    v_and_b32 v115, 0x20000000, v37
    v_lshrrev_b32 v116, 14, v21
    v_bitop3_b32 v116, v116, v8, v115 bitop3:0xea
    ds_read_b64 v[86:87], v116 offset:63616
    v_and_b32 v114, 0x10000000, v37
    v_lshrrev_b32 v116, 14, v20
    v_bitop3_b32 v116, v116, v8, v114 bitop3:0xea
    ds_read_b64 v[84:85], v116 offset:63616
    s_waitcnt lgkmcnt(3)
    v_mfma_f32_4x4x4_16b_bf16 v[100:103], v[12:13], v[90:91], v[100:103]
    s_waitcnt lgkmcnt(2)
    v_mfma_f32_4x4x4_16b_bf16 v[96:99], v[12:13], v[88:89], v[96:99]
    v_perm_b32 v112, v20, v33, s44
    v_bitop3_b32 v108, v20, v8, v114 bitop3:0xea
    v_perm_b32 v113, v21, v33, s45
    v_bitop3_b32 v109, v21, v8, v115 bitop3:0xea
    v_cvt_pk_bf16_f32 v100, v100, v101
    v_cvt_pk_bf16_f32 v101, v102, v103
    ds_wrxchg_rtn_b64 v[94:95], v111, v[100:101]
    v_cvt_pk_bf16_f32 v96, v96, v97
    v_cvt_pk_bf16_f32 v97, v98, v99
    ds_wrxchg_rtn_b64 v[92:93], v110, v[96:97]
    s_setprio 2
    s_waitcnt lgkmcnt(3)
    v_mfma_f32_4x4x4_16b_bf16 v[100:103], v[12:13], v[86:87], 0
    s_waitcnt lgkmcnt(2)
    v_mfma_f32_4x4x4_16b_bf16 v[96:99], v[12:13], v[84:85], 0
    v_bitop3_b32 v112, v112, v9, v10 bitop3:0xea
    v_bitop3_b32 v112, v20, v11, v112 bitop3:0xea
    v_bitop3_b32 v113, v113, v9, v10 bitop3:0xea
    v_bitop3_b32 v113, v21, v11, v113 bitop3:0xea
    v_cmp_lt_u32 s[84:85], v8, v108
    v_mul_f32 v100, v113, v100
    v_mul_f32 v101, v113, v101
    v_mul_f32 v102, v113, v102
    v_mul_f32 v103, v113, v103
    v_mul_f32 v96, v112, v96
    v_mul_f32 v97, v112, v97
    v_mul_f32 v98, v112, v98
    v_mul_f32 v99, v112, v99
    v_add_u32 v116, 0x102a4000, v4
    buffer_load_dwordx4 v[68:71], v116, s[12:15], s49 offen
    v_add_u32 v116, 0x10548000, v4
    buffer_load_dwordx4 v[72:75], v116, s[12:15], s49 offen
    s_waitcnt lgkmcnt(1)
    v_cmp_ne_u64 vcc, v[94:95], v[90:91]
    s_and_b64 s[82:83], vcc, s[80:81]
    s_cbranch_scc1 L2_c41
L2_d41:
    s_mov_b64 exec, vcc
    v_mfma_f32_4x4x4_16b_bf16 v[104:107], v[14:15], v[90:91], 0
    v_mov_b32 v117, v111
    s_or_b64 s[80:81], s[80:81], vcc
    v_mfma_f32_4x4x4_16b_bf16 v[104:107], v[12:13], v[94:95], v[104:107]
    s_mov_b64 exec, -1
    s_waitcnt lgkmcnt(0)
    v_cmp_ne_u64 vcc, v[92:93], v[88:89]
    s_and_b64 s[82:83], vcc, s[80:81]
    s_cbranch_scc1 L2_c42
L2_d42:
    s_mov_b64 exec, vcc
    v_mfma_f32_4x4x4_16b_bf16 v[104:107], v[14:15], v[88:89], 0
    v_mov_b32 v117, v110
    s_or_b64 s[80:81], s[80:81], vcc
    v_mfma_f32_4x4x4_16b_bf16 v[104:107], v[12:13], v[92:93], v[104:107]
    s_mov_b64 exec, -1
    ds_read_b64 v[90:91], v109
    s_and_b64 exec, s[84:85], s[80:81]
    s_andn2_b64 s[80:81], s[80:81], s[84:85]
    v_mov_b32 v108, v117
    v_mov_b32 v96, v104
    v_mov_b32 v97, v105
    v_mov_b32 v98, v106
    v_mov_b32 v99, v107
    s_mov_b64 exec, -1
    ds_read_b64 v[88:89], v108
    v_and_b32 v115, 0x80000000, v37
    v_lshrrev_b32 v116, 14, v23
    v_bitop3_b32 v116, v116, v8, v115 bitop3:0xea
    ds_read_b64 v[86:87], v116 offset:63616
    v_and_b32 v114, 0x40000000, v37
    v_lshrrev_b32 v116, 14, v22
    v_bitop3_b32 v116, v116, v8, v114 bitop3:0xea
    ds_read_b64 v[84:85], v116 offset:63616
    s_waitcnt lgkmcnt(3)
    v_mfma_f32_4x4x4_16b_bf16 v[100:103], v[12:13], v[90:91], v[100:103]
    s_waitcnt lgkmcnt(2)
    v_mfma_f32_4x4x4_16b_bf16 v[96:99], v[12:13], v[88:89], v[96:99]
    v_perm_b32 v112, v22, v33, s46
    v_bitop3_b32 v110, v22, v8, v114 bitop3:0xea
    v_perm_b32 v113, v23, v33, s47
    v_bitop3_b32 v111, v23, v8, v115 bitop3:0xea
    v_cvt_pk_bf16_f32 v100, v100, v101
    v_cvt_pk_bf16_f32 v101, v102, v103
    ds_wrxchg_rtn_b64 v[94:95], v109, v[100:101]
    v_cvt_pk_bf16_f32 v96, v96, v97
    v_cvt_pk_bf16_f32 v97, v98, v99
    ds_wrxchg_rtn_b64 v[92:93], v108, v[96:97]
    s_waitcnt lgkmcnt(3)
    v_mfma_f32_4x4x4_16b_bf16 v[100:103], v[12:13], v[86:87], 0
    s_waitcnt lgkmcnt(2)
    v_mfma_f32_4x4x4_16b_bf16 v[96:99], v[12:13], v[84:85], 0
    v_bitop3_b32 v112, v112, v9, v10 bitop3:0xea
    v_bitop3_b32 v112, v22, v11, v112 bitop3:0xea
    v_bitop3_b32 v113, v113, v9, v10 bitop3:0xea
    v_bitop3_b32 v113, v23, v11, v113 bitop3:0xea
    v_mul_f32 v100, v113, v100
    v_mul_f32 v101, v113, v101
    v_mul_f32 v102, v113, v102
    v_mul_f32 v103, v113, v103
    v_mul_f32 v96, v112, v96
    v_mul_f32 v97, v112, v97
    v_mul_f32 v98, v112, v98
    v_mul_f32 v99, v112, v99
    v_and_b32 v116, 0x0fffffff, v41
    v_mov_b32 v37, v41
    buffer_load_dwordx4 v[20:23], v116, s[8:11], 0 offen
    buffer_load_dword v33, v116, s[8:11], 0 offen offset:16
    s_waitcnt lgkmcnt(1)
    v_cmp_ne_u64 vcc, v[94:95], v[90:91]
    s_and_b64 s[82:83], vcc, s[80:81]
    s_cbranch_scc1 L2_c43
L2_d43:
    s_mov_b64 exec, vcc
    v_mfma_f32_4x4x4_16b_bf16 v[104:107], v[14:15], v[90:91], 0
    v_mov_b32 v117, v109
    s_or_b64 s[80:81], s[80:81], vcc
    v_mfma_f32_4x4x4_16b_bf16 v[104:107], v[12:13], v[94:95], v[104:107]
    s_mov_b64 exec, -1
    s_waitcnt lgkmcnt(0)
    v_cmp_ne_u64 vcc, v[92:93], v[88:89]
    s_and_b64 s[82:83], vcc, s[80:81]
    s_cbranch_scc1 L2_c44
L2_d44:
    s_mov_b64 exec, vcc
    v_mfma_f32_4x4x4_16b_bf16 v[104:107], v[14:15], v[88:89], 0
    v_mov_b32 v117, v108
    s_or_b64 s[80:81], s[80:81], vcc
    v_mfma_f32_4x4x4_16b_bf16 v[104:107], v[12:13], v[92:93], v[104:107]
    s_mov_b64 exec, -1
    ds_read_b64 v[90:91], v111
    ds_read_b64 v[88:89], v110
    s_waitcnt vmcnt(14)
    v_and_b32 v115, 0x20000000, v38
    v_lshrrev_b32 v116, 14, v25
    v_bitop3_b32 v116, v116, v8, v115 bitop3:0xea
    ds_read_b64 v[86:87], v116 offset:63616
    v_and_b32 v114, 0x10000000, v38
    v_lshrrev_b32 v116, 14, v24
    v_bitop3_b32 v116, v116, v8, v114 bitop3:0xea
    ds_read_b64 v[84:85], v116 offset:63616
    s_waitcnt lgkmcnt(3)
    v_mfma_f32_4x4x4_16b_bf16 v[100:103], v[12:13], v[90:91], v[100:103]
    s_waitcnt lgkmcnt(2)
    v_mfma_f32_4x4x4_16b_bf16 v[96:99], v[12:13], v[88:89], v[96:99]
    v_perm_b32 v112, v24, v34, s44
    v_bitop3_b32 v108, v24, v8, v114 bitop3:0xea
    v_perm_b32 v113, v25, v34, s45
    v_bitop3_b32 v109, v25, v8, v115 bitop3:0xea
    v_cvt_pk_bf16_f32 v100, v100, v101
    v_cvt_pk_bf16_f32 v101, v102, v103
    ds_wrxchg_rtn_b64 v[94:95], v111, v[100:101]
    v_cvt_pk_bf16_f32 v96, v96, v97
    v_cvt_pk_bf16_f32 v97, v98, v99
    ds_wrxchg_rtn_b64 v[92:93], v110, v[96:97]
    s_setprio 1
    s_waitcnt lgkmcnt(3)
    v_mfma_f32_4x4x4_16b_bf16 v[100:103], v[12:13], v[86:87], 0
    s_waitcnt lgkmcnt(2)
    v_mfma_f32_4x4x4_16b_bf16 v[96:99], v[12:13], v[84:85], 0
    v_bitop3_b32 v112, v112, v9, v10 bitop3:0xea
    v_bitop3_b32 v112, v24, v11, v112 bitop3:0xea
    v_bitop3_b32 v113, v113, v9, v10 bitop3:0xea
    v_bitop3_b32 v113, v25, v11, v113 bitop3:0xea
    v_cmp_lt_u32 s[84:85], v8, v108
    v_mul_f32 v100, v113, v100
    v_mul_f32 v101, v113, v101
    v_mul_f32 v102, v113, v102
    v_mul_f32 v103, v113, v103
    v_mul_f32 v96, v112, v96
    v_mul_f32 v97, v112, v97
    v_mul_f32 v98, v112, v98
    v_mul_f32 v99, v112, v99
    v_add_u32 v116, 0x107ec000, v4
    buffer_load_dwordx4 v[76:79], v116, s[12:15], s49 offen
    v_add_u32 v116, 0x10a90000, v4
    buffer_load_dwordx4 v[80:83], v116, s[12:15], s49 offen
    s_waitcnt lgkmcnt(1)
    v_cmp_ne_u64 vcc, v[94:95], v[90:91]
    s_and_b64 s[82:83], vcc, s[80:81]
    s_cbranch_scc1 L2_c45
L2_d45:
    s_mov_b64 exec, vcc
    v_mfma_f32_4x4x4_16b_bf16 v[104:107], v[14:15], v[90:91], 0
    v_mov_b32 v117, v111
    s_or_b64 s[80:81], s[80:81], vcc
    v_mfma_f32_4x4x4_16b_bf16 v[104:107], v[12:13], v[94:95], v[104:107]
    s_mov_b64 exec, -1
    s_waitcnt lgkmcnt(0)
    v_cmp_ne_u64 vcc, v[92:93], v[88:89]
    s_and_b64 s[82:83], vcc, s[80:81]
    s_cbranch_scc1 L2_c46
L2_d46:
    s_mov_b64 exec, vcc
    v_mfma_f32_4x4x4_16b_bf16 v[104:107], v[14:15], v[88:89], 0
    v_mov_b32 v117, v110
    s_or_b64 s[80:81], s[80:81], vcc
    v_mfma_f32_4x4x4_16b_bf16 v[104:107], v[12:13], v[92:93], v[104:107]
    s_mov_b64 exec, -1
    ds_read_b64 v[90:91], v109
    s_and_b64 exec, s[84:85], s[80:81]
    s_andn2_b64 s[80:81], s[80:81], s[84:85]
    v_mov_b32 v108, v117
    v_mov_b32 v96, v104
    v_mov_b32 v97, v105
    v_mov_b32 v98, v106
    v_mov_b32 v99, v107
    s_mov_b64 exec, -1
    ds_read_b64 v[88:89], v108
    v_and_b32 v115, 0x80000000, v38
    v_lshrrev_b32 v116, 14, v27
    v_bitop3_b32 v116, v116, v8, v115 bitop3:0xea
    ds_read_b64 v[86:87], v116 offset:63616
    v_and_b32 v114, 0x40000000, v38
    v_lshrrev_b32 v116, 14, v26
    v_bitop3_b32 v116, v116, v8, v114 bitop3:0xea
    ds_read_b64 v[84:85], v116 offset:63616
    s_waitcnt lgkmcnt(3)
    v_mfma_f32_4x4x4_16b_bf16 v[100:103], v[12:13], v[90:91], v[100:103]
    s_waitcnt lgkmcnt(2)
    v_mfma_f32_4x4x4_16b_bf16 v[96:99], v[12:13], v[88:89], v[96:99]
    v_perm_b32 v112, v26, v34, s46
    v_bitop3_b32 v110, v26, v8, v114 bitop3:0xea
    v_perm_b32 v113, v27, v34, s47
    v_bitop3_b32 v111, v27, v8, v115 bitop3:0xea
    v_cvt_pk_bf16_f32 v100, v100, v101
    v_cvt_pk_bf16_f32 v101, v102, v103
    ds_wrxchg_rtn_b64 v[94:95], v109, v[100:101]
    v_cvt_pk_bf16_f32 v96, v96, v97
    v_cvt_pk_bf16_f32 v97, v98, v99
    ds_wrxchg_rtn_b64 v[92:93], v108, v[96:97]
    s_waitcnt lgkmcnt(3)
    v_mfma_f32_4x4x4_16b_bf16 v[100:103], v[12:13], v[86:87], 0
    s_waitcnt lgkmcnt(2)
    v_mfma_f32_4x4x4_16b_bf16 v[96:99], v[12:13], v[84:85], 0
    v_bitop3_b32 v112, v112, v9, v10 bitop3:0xea
    v_bitop3_b32 v112, v26, v11, v112 bitop3:0xea
    v_bitop3_b32 v113, v113, v9, v10 bitop3:0xea
    v_bitop3_b32 v113, v27, v11, v113 bitop3:0xea
    v_mul_f32 v100, v113, v100
    v_mul_f32 v101, v113, v101
    v_mul_f32 v102, v113, v102
    v_mul_f32 v103, v113, v103
    v_mul_f32 v96, v112, v96
    v_mul_f32 v97, v112, v97
    v_mul_f32 v98, v112, v98
    v_mul_f32 v99, v112, v99
    v_and_b32 v116, 0x0fffffff, v42
    v_mov_b32 v38, v42
    buffer_load_dwordx4 v[24:27], v116, s[8:11], 0 offen
    buffer_load_dword v34, v116, s[8:11], 0 offen offset:16
    s_waitcnt lgkmcnt(1)
    v_cmp_ne_u64 vcc, v[94:95], v[90:91]
    s_and_b64 s[82:83], vcc, s[80:81]
    s_cbranch_scc1 L2_c47
L2_d47:
    s_mov_b64 exec, vcc
    v_mfma_f32_4x4x4_16b_bf16 v[104:107], v[14:15], v[90:91], 0
    v_mov_b32 v117, v109
    s_or_b64 s[80:81], s[80:81], vcc
    v_mfma_f32_4x4x4_16b_bf16 v[104:107], v[12:13], v[94:95], v[104:107]
    s_mov_b64 exec, -1
    s_waitcnt lgkmcnt(0)
    v_cmp_ne_u64 vcc, v[92:93], v[88:89]
    s_and_b64 s[82:83], vcc, s[80:81]
    s_cbranch_scc1 L2_c48
L2_d48:
    s_mov_b64 exec, vcc
    v_mfma_f32_4x4x4_16b_bf16 v[104:107], v[14:15], v[88:89], 0
    v_mov_b32 v117, v108
    s_or_b64 s[80:81], s[80:81], vcc
    v_mfma_f32_4x4x4_16b_bf16 v[104:107], v[12:13], v[92:93], v[104:107]
    s_mov_b64 exec, -1
    ds_read_b64 v[90:91], v111
    ds_read_b64 v[88:89], v110
    s_waitcnt vmcnt(16)
    v_and_b32 v115, 0x20000000, v39
    v_lshrrev_b32 v116, 14, v29
    v_bitop3_b32 v116, v116, v8, v115 bitop3:0xea
    ds_read_b64 v[86:87], v116 offset:63616
    v_and_b32 v114, 0x10000000, v39
    v_lshrrev_b32 v116, 14, v28
    v_bitop3_b32 v116, v116, v8, v114 bitop3:0xea
    ds_read_b64 v[84:85], v116 offset:63616
    s_waitcnt lgkmcnt(3)
    v_mfma_f32_4x4x4_16b_bf16 v[100:103], v[12:13], v[90:91], v[100:103]
    s_waitcnt lgkmcnt(2)
    v_mfma_f32_4x4x4_16b_bf16 v[96:99], v[12:13], v[88:89], v[96:99]
    v_perm_b32 v112, v28, v35, s44
    v_bitop3_b32 v108, v28, v8, v114 bitop3:0xea
    v_perm_b32 v113, v29, v35, s45
    v_bitop3_b32 v109, v29, v8, v115 bitop3:0xea
    v_cvt_pk_bf16_f32 v100, v100, v101
    v_cvt_pk_bf16_f32 v101, v102, v103
    ds_wrxchg_rtn_b64 v[94:95], v111, v[100:101]
    v_cvt_pk_bf16_f32 v96, v96, v97
    v_cvt_pk_bf16_f32 v97, v98, v99
    ds_wrxchg_rtn_b64 v[92:93], v110, v[96:97]
    s_setprio 0
    s_waitcnt lgkmcnt(3)
    v_mfma_f32_4x4x4_16b_bf16 v[100:103], v[12:13], v[86:87], 0
    s_waitcnt lgkmcnt(2)
    v_mfma_f32_4x4x4_16b_bf16 v[96:99], v[12:13], v[84:85], 0
    v_bitop3_b32 v112, v112, v9, v10 bitop3:0xea
    v_bitop3_b32 v112, v28, v11, v112 bitop3:0xea
    v_bitop3_b32 v113, v113, v9, v10 bitop3:0xea
    v_bitop3_b32 v113, v29, v11, v113 bitop3:0xea
    v_cmp_lt_u32 s[84:85], v8, v108
    v_mul_f32 v100, v113, v100
    v_mul_f32 v101, v113, v101
    v_mul_f32 v102, v113, v102
    v_mul_f32 v103, v113, v103
    v_mul_f32 v96, v112, v96
    v_mul_f32 v97, v112, v97
    v_mul_f32 v98, v112, v98
    v_mul_f32 v99, v112, v99
    s_waitcnt lgkmcnt(1)
    v_cmp_ne_u64 vcc, v[94:95], v[90:91]
    s_and_b64 s[82:83], vcc, s[80:81]
    s_cbranch_scc1 L2_c49
L2_d49:
    s_mov_b64 exec, vcc
    v_mfma_f32_4x4x4_16b_bf16 v[104:107], v[14:15], v[90:91], 0
    v_mov_b32 v117, v111
    s_or_b64 s[80:81], s[80:81], vcc
    v_mfma_f32_4x4x4_16b_bf16 v[104:107], v[12:13], v[94:95], v[104:107]
    s_mov_b64 exec, -1
    s_waitcnt lgkmcnt(0)
    v_cmp_ne_u64 vcc, v[92:93], v[88:89]
    s_and_b64 s[82:83], vcc, s[80:81]
    s_cbranch_scc1 L2_c50
L2_d50:
    s_mov_b64 exec, vcc
    v_mfma_f32_4x4x4_16b_bf16 v[104:107], v[14:15], v[88:89], 0
    v_mov_b32 v117, v110
    s_or_b64 s[80:81], s[80:81], vcc
    v_mfma_f32_4x4x4_16b_bf16 v[104:107], v[12:13], v[92:93], v[104:107]
    s_mov_b64 exec, -1
    ds_read_b64 v[90:91], v109
    s_and_b64 exec, s[84:85], s[80:81]
    s_andn2_b64 s[80:81], s[80:81], s[84:85]
    v_mov_b32 v108, v117
    v_mov_b32 v96, v104
    v_mov_b32 v97, v105
    v_mov_b32 v98, v106
    v_mov_b32 v99, v107
    s_mov_b64 exec, -1
    ds_read_b64 v[88:89], v108
    v_and_b32 v115, 0x80000000, v39
    v_lshrrev_b32 v116, 14, v31
    v_bitop3_b32 v116, v116, v8, v115 bitop3:0xea
    ds_read_b64 v[86:87], v116 offset:63616
    v_and_b32 v114, 0x40000000, v39
    v_lshrrev_b32 v116, 14, v30
    v_bitop3_b32 v116, v116, v8, v114 bitop3:0xea
    ds_read_b64 v[84:85], v116 offset:63616
    s_waitcnt lgkmcnt(3)
    v_mfma_f32_4x4x4_16b_bf16 v[100:103], v[12:13], v[90:91], v[100:103]
    s_waitcnt lgkmcnt(2)
    v_mfma_f32_4x4x4_16b_bf16 v[96:99], v[12:13], v[88:89], v[96:99]
    v_perm_b32 v112, v30, v35, s46
    v_bitop3_b32 v110, v30, v8, v114 bitop3:0xea
    v_perm_b32 v113, v31, v35, s47
    v_bitop3_b32 v111, v31, v8, v115 bitop3:0xea
    v_cvt_pk_bf16_f32 v100, v100, v101
    v_cvt_pk_bf16_f32 v101, v102, v103
    ds_wrxchg_rtn_b64 v[94:95], v109, v[100:101]
    v_cvt_pk_bf16_f32 v96, v96, v97
    v_cvt_pk_bf16_f32 v97, v98, v99
    ds_wrxchg_rtn_b64 v[92:93], v108, v[96:97]
    s_waitcnt lgkmcnt(3)
    v_mfma_f32_4x4x4_16b_bf16 v[100:103], v[12:13], v[86:87], 0
    s_waitcnt lgkmcnt(2)
    v_mfma_f32_4x4x4_16b_bf16 v[96:99], v[12:13], v[84:85], 0
    v_bitop3_b32 v112, v112, v9, v10 bitop3:0xea
    v_bitop3_b32 v112, v30, v11, v112 bitop3:0xea
    v_bitop3_b32 v113, v113, v9, v10 bitop3:0xea
    v_bitop3_b32 v113, v31, v11, v113 bitop3:0xea
    v_mul_f32 v100, v113, v100
    v_mul_f32 v101, v113, v101
    v_mul_f32 v102, v113, v102
    v_mul_f32 v103, v113, v103
    v_mul_f32 v96, v112, v96
    v_mul_f32 v97, v112, v97
    v_mul_f32 v98, v112, v98
    v_mul_f32 v99, v112, v99
    v_and_b32 v116, 0x0fffffff, v43
    v_mov_b32 v39, v43
    buffer_load_dwordx4 v[28:31], v116, s[8:11], 0 offen
    buffer_load_dword v35, v116, s[8:11], 0 offen offset:16
    s_waitcnt lgkmcnt(1)
    v_cmp_ne_u64 vcc, v[94:95], v[90:91]
    s_and_b64 s[82:83], vcc, s[80:81]
    s_cbranch_scc1 L2_c51
L2_d51:
    s_mov_b64 exec, vcc
    v_mfma_f32_4x4x4_16b_bf16 v[104:107], v[14:15], v[90:91], 0
    v_mov_b32 v117, v109
    s_or_b64 s[80:81], s[80:81], vcc
    v_mfma_f32_4x4x4_16b_bf16 v[104:107], v[12:13], v[94:95], v[104:107]
    s_mov_b64 exec, -1
    s_waitcnt lgkmcnt(0)
    v_cmp_ne_u64 vcc, v[92:93], v[88:89]
    s_and_b64 s[82:83], vcc, s[80:81]
    s_cbranch_scc1 L2_c52
L2_d52:
    s_mov_b64 exec, vcc
    v_mfma_f32_4x4x4_16b_bf16 v[104:107], v[14:15], v[88:89], 0
    v_mov_b32 v117, v108
    s_or_b64 s[80:81], s[80:81], vcc
    v_mfma_f32_4x4x4_16b_bf16 v[104:107], v[12:13], v[92:93], v[104:107]
    s_mov_b64 exec, -1
    ds_read_b64 v[90:91], v111
    ds_read_b64 v[88:89], v110
    s_waitcnt lgkmcnt(1)
    v_mfma_f32_4x4x4_16b_bf16 v[100:103], v[12:13], v[90:91], v[100:103]
    s_waitcnt lgkmcnt(0)
    v_mfma_f32_4x4x4_16b_bf16 v[96:99], v[12:13], v[88:89], v[96:99]
    s_nop 2
    v_cvt_pk_bf16_f32 v100, v100, v101
    v_cvt_pk_bf16_f32 v101, v102, v103
    ds_wrxchg_rtn_b64 v[94:95], v111, v[100:101]
    v_cvt_pk_bf16_f32 v96, v96, v97
    v_cvt_pk_bf16_f32 v97, v98, v99
    ds_wrxchg_rtn_b64 v[92:93], v110, v[96:97]
    s_bitcmp1_b32 s36, s42
    s_cbranch_scc1 L2_slow
L2_ret2:
    s_barrier
    s_waitcnt vmcnt(4)
    s_mov_b32 s37, s38
    s_setprio 3
    ds_write_b128 v7, v[52:55] offset:2048
    buffer_load_dwordx4 v[52:55], v6, s[16:19], s40 offen offset:2048
    v_and_b32 v119, 0xffff, v64
    v_and_b32 v120, 0xffff, v66
    v_and_b32 v121, -4, v119
    v_add_u32 v121, v121, v2
L2_x53_0:
    v_sub_u32 v122, v120, v121
    v_sub_u32 v124, v119, v121
    v_med3_i32 v123, v122, 0, 4
    v_max_i32 v124, 0, v124
    v_cmp_gt_i32 vcc, v123, v124
    v_mad_u32_u24 v125, v121, 5, v4
    v_bfm_b32 v123, v123, 28
    v_bfm_b32 v124, v124, 28
    v_mbcnt_lo_u32_b32 v126, vcc_lo, 0
    v_mbcnt_hi_u32_b32 v126, vcc_hi, v126
    v_bitop3_b32 v125, v123, v124, v125 bitop3:0x9a
    v_add_lshl_u32 v126, v126, s37, 2
    s_bcnt1_i32_b64 s41, vcc
    s_mov_b64 exec, vcc
    ds_write_b32 v126, v125
    s_mov_b64 exec, -1
    v_cmp_gt_i32 vcc, v122, v3
    s_add_u32 s37, s37, s41
    s_min_u32 s37, s37, s48
    s_cbranch_vccnz L2_xe53_0
L2_xr53_0:
    s_setprio 2
    ds_write_b128 v7, v[56:59] offset:3072
    buffer_load_dwordx4 v[56:59], v6, s[16:19], s40 offen offset:3072
    v_and_b32 v119, 0xffff, v68
    v_and_b32 v120, 0xffff, v70
    v_and_b32 v121, -4, v119
    v_add_u32 v121, v121, v2
    v_add_u32 v127, 0x2a4000, v4
L2_x53_1:
    v_sub_u32 v122, v120, v121
    v_sub_u32 v124, v119, v121
    v_med3_i32 v123, v122, 0, 4
    v_max_i32 v124, 0, v124
    v_cmp_gt_i32 vcc, v123, v124
    v_mad_u32_u24 v125, v121, 5, v127
    v_bfm_b32 v123, v123, 28
    v_bfm_b32 v124, v124, 28
    v_mbcnt_lo_u32_b32 v126, vcc_lo, 0
    v_mbcnt_hi_u32_b32 v126, vcc_hi, v126
    v_bitop3_b32 v125, v123, v124, v125 bitop3:0x9a
    v_add_lshl_u32 v126, v126, s37, 2
    s_bcnt1_i32_b64 s41, vcc
    s_mov_b64 exec, vcc
    ds_write_b32 v126, v125
    s_mov_b64 exec, -1
    v_cmp_gt_i32 vcc, v122, v3
    s_add_u32 s37, s37, s41
    s_min_u32 s37, s37, s48
    s_cbranch_vccnz L2_xe53_1
L2_xr53_1:
    s_setprio 1
    ds_write_b128 v7, v[60:63] offset:4096
    s_add_u32 s3, s40, 4096
    buffer_load_dwordx4 v[60:63], v6, s[16:19], s3 offen
    v_and_b32 v119, 0xffff, v72
    v_and_b32 v120, 0xffff, v74
    v_and_b32 v121, -4, v119
    v_add_u32 v121, v121, v2
    v_add_u32 v127, 0x548000, v4
L2_x53_2:
    v_sub_u32 v122, v120, v121
    v_sub_u32 v124, v119, v121
    v_med3_i32 v123, v122, 0, 4
    v_max_i32 v124, 0, v124
    v_cmp_gt_i32 vcc, v123, v124
    v_mad_u32_u24 v125, v121, 5, v127
    v_bfm_b32 v123, v123, 28
    v_bfm_b32 v124, v124, 28
    v_mbcnt_lo_u32_b32 v126, vcc_lo, 0
    v_mbcnt_hi_u32_b32 v126, vcc_hi, v126
    v_bitop3_b32 v125, v123, v124, v125 bitop3:0x9a
    v_add_lshl_u32 v126, v126, s37, 2
    s_bcnt1_i32_b64 s41, vcc
    s_mov_b64 exec, vcc
    ds_write_b32 v126, v125
    s_mov_b64 exec, -1
    v_cmp_gt_i32 vcc, v122, v3
    s_add_u32 s37, s37, s41
    s_min_u32 s37, s37, s48
    s_cbranch_vccnz L2_xe53_2
L2_xr53_2:
    s_setprio 0
    v_and_b32 v119, 0xffff, v76
    v_and_b32 v120, 0xffff, v78
    v_and_b32 v121, -4, v119
    v_add_u32 v121, v121, v2
    v_add_u32 v127, 0x7ec000, v4
L2_x53_3:
    v_sub_u32 v122, v120, v121
    v_sub_u32 v124, v119, v121
    v_med3_i32 v123, v122, 0, 4
    v_max_i32 v124, 0, v124
    v_cmp_gt_i32 vcc, v123, v124
    v_mad_u32_u24 v125, v121, 5, v127
    v_bfm_b32 v123, v123, 28
    v_bfm_b32 v124, v124, 28
    v_mbcnt_lo_u32_b32 v126, vcc_lo, 0
    v_mbcnt_hi_u32_b32 v126, vcc_hi, v126
    v_bitop3_b32 v125, v123, v124, v125 bitop3:0x9a
    v_add_lshl_u32 v126, v126, s37, 2
    s_bcnt1_i32_b64 s41, vcc
    s_mov_b64 exec, vcc
    ds_write_b32 v126, v125
    s_mov_b64 exec, -1
    v_cmp_gt_i32 vcc, v122, v3
    s_add_u32 s37, s37, s41
    s_min_u32 s37, s37, s48
    s_cbranch_vccnz L2_xe53_3
L2_xr53_3:
    v_and_b32 v119, 0xffff, v80
    v_and_b32 v120, 0xffff, v82
    v_and_b32 v121, -4, v119
    v_add_u32 v121, v121, v2
    v_add_u32 v127, 0xa90000, v4
L2_x53_4:
    v_sub_u32 v122, v120, v121
    v_sub_u32 v124, v119, v121
    v_med3_i32 v123, v122, 0, 4
    v_max_i32 v124, 0, v124
    v_cmp_gt_i32 vcc, v123, v124
    v_mad_u32_u24 v125, v121, 5, v127
    v_bfm_b32 v123, v123, 28
    v_bfm_b32 v124, v124, 28
    v_mbcnt_lo_u32_b32 v126, vcc_lo, 0
    v_mbcnt_hi_u32_b32 v126, vcc_hi, v126
    v_bitop3_b32 v125, v123, v124, v125 bitop3:0x9a
    v_add_lshl_u32 v126, v126, s37, 2
    s_bcnt1_i32_b64 s41, vcc
    s_mov_b64 exec, vcc
    ds_write_b32 v126, v125
    s_mov_b64 exec, -1
    v_cmp_gt_i32 vcc, v122, v3
    s_add_u32 s37, s37, s41
    s_min_u32 s37, s37, s48
    s_cbranch_vccnz L2_xe53_4
L2_xr53_4:
    s_lshl_b32 s3, s37, 2
    v_add_u32 v126, s3, v1
    ds_write_b32 v126, v5
    s_lshl_b32 s3, s38, 2
    v_add_u32 v126, s3, v1
    ds_read2st64_b32 v[40:41], v126 offset0:0 offset1:1
    ds_read2st64_b32 v[42:43], v126 offset0:2 offset1:3
    v_add_u32 v5, v118, v5
    s_sub_u32 s41, s37, s38
    s_sub_u32 s3, s41, 192
    s_cmp_gt_u32 s3, 64
    s_cbranch_scc1 L2_xf53
L2_xg53:
    ds_write_b128 v7, v[44:47] offset:0
    ds_write_b128 v7, v[48:51] offset:1024
    s_add_u32 s42, s42, 1
    s_waitcnt lgkmcnt(0)
    s_barrier
    s_setprio 3
    v_and_b32 v115, 0x20000000, v36
    v_lshrrev_b32 v116, 14, v17
    v_bitop3_b32 v116, v116, v8, v115 bitop3:0xea
    ds_read_b64 v[86:87], v116 offset:63616
    v_and_b32 v114, 0x10000000, v36
    v_lshrrev_b32 v116, 14, v16
    v_bitop3_b32 v116, v116, v8, v114 bitop3:0xea
    ds_read_b64 v[84:85], v116 offset:63616
    v_perm_b32 v112, v16, v32, s44
    v_bitop3_b32 v108, v16, v8, v114 bitop3:0xea
    v_perm_b32 v113, v17, v32, s45
    v_bitop3_b32 v109, v17, v8, v115 bitop3:0xea
    s_waitcnt lgkmcnt(1)
    v_mfma_f32_4x4x4_16b_bf16 v[100:103], v[12:13], v[86:87], 0
    s_waitcnt lgkmcnt(0)
    v_mfma_f32_4x4x4_16b_bf16 v[96:99], v[12:13], v[84:85], 0
    v_bitop3_b32 v112, v112, v9, v10 bitop3:0xea
    v_bitop3_b32 v112, v16, v11, v112 bitop3:0xea
    v_bitop3_b32 v113, v113, v9, v10 bitop3:0xea
    v_bitop3_b32 v113, v17, v11, v113 bitop3:0xea
    v_cmp_lt_u32 s[84:85], v8, v108
    v_mul_f32 v100, v113, v100
    v_mul_f32 v101, v113, v101
    v_mul_f32 v102, v113, v102
    v_mul_f32 v103, v113, v103
    v_mul_f32 v96, v112, v96
    v_mul_f32 v97, v112, v97
    v_mul_f32 v98, v112, v98
    v_mul_f32 v99, v112, v99
    buffer_load_dwordx4 v[44:47], v6, s[16:19], s40 offen offset:0
    buffer_load_dwordx4 v[48:51], v6, s[16:19], s40 offen offset:1024
    s_add_u32 s40, s40, 80000
    v_cmp_ne_u64 vcc, v[94:95], v[90:91]
    s_and_b64 s[82:83], vcc, s[80:81]
    s_cbranch_scc1 L2_c54
L2_d54:
    s_mov_b64 exec, vcc
    v_mfma_f32_4x4x4_16b_bf16 v[104:107], v[14:15], v[90:91], 0
    v_mov_b32 v117, v111
    s_or_b64 s[80:81], s[80:81], vcc
    v_mfma_f32_4x4x4_16b_bf16 v[104:107], v[12:13], v[94:95], v[104:107]
    s_mov_b64 exec, -1
    v_cmp_ne_u64 vcc, v[92:93], v[88:89]
    s_and_b64 s[82:83], vcc, s[80:81]
    s_cbranch_scc1 L2_c55
L2_d55:
    s_mov_b64 exec, vcc
    v_mfma_f32_4x4x4_16b_bf16 v[104:107], v[14:15], v[88:89], 0
    v_mov_b32 v117, v110
    s_or_b64 s[80:81], s[80:81], vcc
    v_mfma_f32_4x4x4_16b_bf16 v[104:107], v[12:13], v[92:93], v[104:107]
    s_mov_b64 exec, -1
    ds_read_b64 v[90:91], v109
    s_and_b64 exec, s[84:85], s[80:81]
    s_andn2_b64 s[80:81], s[80:81], s[84:85]
    v_mov_b32 v108, v117
    v_mov_b32 v96, v104
    v_mov_b32 v97, v105
    v_mov_b32 v98, v106
    v_mov_b32 v99, v107
    s_mov_b64 exec, -1
    ds_read_b64 v[88:89], v108
    v_and_b32 v115, 0x80000000, v36
    v_lshrrev_b32 v116, 14, v19
    v_bitop3_b32 v116, v116, v8, v115 bitop3:0xea
    ds_read_b64 v[86:87], v116 offset:63616
    v_and_b32 v114, 0x40000000, v36
    v_lshrrev_b32 v116, 14, v18
    v_bitop3_b32 v116, v116, v8, v114 bitop3:0xea
    ds_read_b64 v[84:85], v116 offset:63616
    s_waitcnt lgkmcnt(3)
    v_mfma_f32_4x4x4_16b_bf16 v[100:103], v[12:13], v[90:91], v[100:103]
    s_waitcnt lgkmcnt(2)
    v_mfma_f32_4x4x4_16b_bf16 v[96:99], v[12:13], v[88:89], v[96:99]
    v_perm_b32 v112, v18, v32, s46
    v_bitop3_b32 v110, v18, v8, v114 bitop3:0xea
    v_perm_b32 v113, v19, v32, s47
    v_bitop3_b32 v111, v19, v8, v115 bitop3:0xea
    v_cvt_pk_bf16_f32 v100, v100, v101
    v_cvt_pk_bf16_f32 v101, v102, v103
    ds_wrxchg_rtn_b64 v[94:95], v109, v[100:101]
    v_cvt_pk_bf16_f32 v96, v96, v97
    v_cvt_pk_bf16_f32 v97, v98, v99
    ds_wrxchg_rtn_b64 v[92:93], v108, v[96:97]
    s_waitcnt lgkmcnt(3)
    v_mfma_f32_4x4x4_16b_bf16 v[100:103], v[12:13], v[86:87], 0
    s_waitcnt lgkmcnt(2)
    v_mfma_f32_4x4x4_16b_bf16 v[96:99], v[12:13], v[84:85], 0
    v_bitop3_b32 v112, v112, v9, v10 bitop3:0xea
    v_bitop3_b32 v112, v18, v11, v112 bitop3:0xea
    v_bitop3_b32 v113, v113, v9, v10 bitop3:0xea
    v_bitop3_b32 v113, v19, v11, v113 bitop3:0xea
    v_mul_f32 v100, v113, v100
    v_mul_f32 v101, v113, v101
    v_mul_f32 v102, v113, v102
    v_mul_f32 v103, v113, v103
    v_mul_f32 v96, v112, v96
    v_mul_f32 v97, v112, v97
    v_mul_f32 v98, v112, v98
    v_mul_f32 v99, v112, v99
    v_and_b32 v116, 0x0fffffff, v40
    v_mov_b32 v36, v40
    buffer_load_dwordx4 v[16:19], v116, s[8:11], 0 offen
    buffer_load_dword v32, v116, s[8:11], 0 offen offset:16
    s_waitcnt lgkmcnt(1)
    v_cmp_ne_u64 vcc, v[94:95], v[90:91]
    s_and_b64 s[82:83], vcc, s[80:81]
    s_cbranch_scc1 L2_c56
L2_d56:
    s_mov_b64 exec, vcc
    v_mfma_f32_4x4x4_16b_bf16 v[104:107], v[14:15], v[90:91], 0
    v_mov_b32 v117, v109
    s_or_b64 s[80:81], s[80:81], vcc
    v_mfma_f32_4x4x4_16b_bf16 v[104:107], v[12:13], v[94:95], v[104:107]
    s_mov_b64 exec, -1
    s_waitcnt lgkmcnt(0)
    v_cmp_ne_u64 vcc, v[92:93], v[88:89]
    s_and_b64 s[82:83], vcc, s[80:81]
    s_cbranch_scc1 L2_c57
L2_d57:
    s_mov_b64 exec, vcc
    v_mfma_f32_4x4x4_16b_bf16 v[104:107], v[14:15], v[88:89], 0
    v_mov_b32 v117, v108
    s_or_b64 s[80:81], s[80:81], vcc
    v_mfma_f32_4x4x4_16b_bf16 v[104:107], v[12:13], v[92:93], v[104:107]
    s_mov_b64 exec, -1
    ds_read_b64 v[90:91], v111
    ds_read_b64 v[88:89], v110
    v_and_b32 v115, 0x20000000, v37
    v_lshrrev_b32 v116, 14, v21
    v_bitop3_b32 v116, v116, v8, v115 bitop3:0xea
    ds_read_b64 v[86:87], v116 offset:63616
    v_and_b32 v114, 0x10000000, v37
    v_lshrrev_b32 v116, 14, v20
    v_bitop3_b32 v116, v116, v8, v114 bitop3:0xea
    ds_read_b64 v[84:85], v116 offset:63616
    s_waitcnt lgkmcnt(3)
    v_mfma_f32_4x4x4_16b_bf16 v[100:103], v[12:13], v[90:91], v[100:103]
    s_waitcnt lgkmcnt(2)
    v_mfma_f32_4x4x4_16b_bf16 v[96:99], v[12:13], v[88:89], v[96:99]
    v_perm_b32 v112, v20, v33, s44
    v_bitop3_b32 v108, v20, v8, v114 bitop3:0xea
    v_perm_b32 v113, v21, v33, s45
    v_bitop3_b32 v109, v21, v8, v115 bitop3:0xea
    v_cvt_pk_bf16_f32 v100, v100, v101
    v_cvt_pk_bf16_f32 v101, v102, v103
    ds_wrxchg_rtn_b64 v[94:95], v111, v[100:101]
    v_cvt_pk_bf16_f32 v96, v96, v97
    v_cvt_pk_bf16_f32 v97, v98, v99
    ds_wrxchg_rtn_b64 v[92:93], v110, v[96:97]
    s_setprio 2
    s_waitcnt lgkmcnt(3)
    v_mfma_f32_4x4x4_16b_bf16 v[100:103], v[12:13], v[86:87], 0
    s_waitcnt lgkmcnt(2)
    v_mfma_f32_4x4x4_16b_bf16 v[96:99], v[12:13], v[84:85], 0
    v_bitop3_b32 v112, v112, v9, v10 bitop3:0xea
    v_bitop3_b32 v112, v20, v11, v112 bitop3:0xea
    v_bitop3_b32 v113, v113, v9, v10 bitop3:0xea
    v_bitop3_b32 v113, v21, v11, v113 bitop3:0xea
    v_cmp_lt_u32 s[84:85], v8, v108
    v_mul_f32 v100, v113, v100
    v_mul_f32 v101, v113, v101
    v_mul_f32 v102, v113, v102
    v_mul_f32 v103, v113, v103
    v_mul_f32 v96, v112, v96
    v_mul_f32 v97, v112, v97
    v_mul_f32 v98, v112, v98
    v_mul_f32 v99, v112, v99
    s_waitcnt lgkmcnt(1)
    v_cmp_ne_u64 vcc, v[94:95], v[90:91]
    s_and_b64 s[82:83], vcc, s[80:81]
    s_cbranch_scc1 L2_c58
L2_d58:
    s_mov_b64 exec, vcc
    v_mfma_f32_4x4x4_16b_bf16 v[104:107], v[14:15], v[90:91], 0
    v_mov_b32 v117, v111
    s_or_b64 s[80:81], s[80:81], vcc
    v_mfma_f32_4x4x4_16b_bf16 v[104:107], v[12:13], v[94:95], v[104:107]
    s_mov_b64 exec, -1
    s_waitcnt lgkmcnt(0)
    v_cmp_ne_u64 vcc, v[92:93], v[88:89]
    s_and_b64 s[82:83], vcc, s[80:81]
    s_cbranch_scc1 L2_c59
L2_d59:
    s_mov_b64 exec, vcc
    v_mfma_f32_4x4x4_16b_bf16 v[104:107], v[14:15], v[88:89], 0
    v_mov_b32 v117, v110
    s_or_b64 s[80:81], s[80:81], vcc
    v_mfma_f32_4x4x4_16b_bf16 v[104:107], v[12:13], v[92:93], v[104:107]
    s_mov_b64 exec, -1
    ds_read_b64 v[90:91], v109
    s_and_b64 exec, s[84:85], s[80:81]
    s_andn2_b64 s[80:81], s[80:81], s[84:85]
    v_mov_b32 v108, v117
    v_mov_b32 v96, v104
    v_mov_b32 v97, v105
    v_mov_b32 v98, v106
    v_mov_b32 v99, v107
    s_mov_b64 exec, -1
    ds_read_b64 v[88:89], v108
    v_and_b32 v115, 0x80000000, v37
    v_lshrrev_b32 v116, 14, v23
    v_bitop3_b32 v116, v116, v8, v115 bitop3:0xea
    ds_read_b64 v[86:87], v116 offset:63616
    v_and_b32 v114, 0x40000000, v37
    v_lshrrev_b32 v116, 14, v22
    v_bitop3_b32 v116, v116, v8, v114 bitop3:0xea
    ds_read_b64 v[84:85], v116 offset:63616
    s_waitcnt lgkmcnt(3)
    v_mfma_f32_4x4x4_16b_bf16 v[100:103], v[12:13], v[90:91], v[100:103]
    s_waitcnt lgkmcnt(2)
    v_mfma_f32_4x4x4_16b_bf16 v[96:99], v[12:13], v[88:89], v[96:99]
    v_perm_b32 v112, v22, v33, s46
    v_bitop3_b32 v110, v22, v8, v114 bitop3:0xea
    v_perm_b32 v113, v23, v33, s47
    v_bitop3_b32 v111, v23, v8, v115 bitop3:0xea
    v_cvt_pk_bf16_f32 v100, v100, v101
    v_cvt_pk_bf16_f32 v101, v102, v103
    ds_wrxchg_rtn_b64 v[94:95], v109, v[100:101]
    v_cvt_pk_bf16_f32 v96, v96, v97
    v_cvt_pk_bf16_f32 v97, v98, v99
    ds_wrxchg_rtn_b64 v[92:93], v108, v[96:97]
    s_waitcnt lgkmcnt(3)
    v_mfma_f32_4x4x4_16b_bf16 v[100:103], v[12:13], v[86:87], 0
    s_waitcnt lgkmcnt(2)
    v_mfma_f32_4x4x4_16b_bf16 v[96:99], v[12:13], v[84:85], 0
    v_bitop3_b32 v112, v112, v9, v10 bitop3:0xea
    v_bitop3_b32 v112, v22, v11, v112 bitop3:0xea
    v_bitop3_b32 v113, v113, v9, v10 bitop3:0xea
    v_bitop3_b32 v113, v23, v11, v113 bitop3:0xea
    v_mul_f32 v100, v113, v100
    v_mul_f32 v101, v113, v101
    v_mul_f32 v102, v113, v102
    v_mul_f32 v103, v113, v103
    v_mul_f32 v96, v112, v96
    v_mul_f32 v97, v112, v97
    v_mul_f32 v98, v112, v98
    v_mul_f32 v99, v112, v99
    v_and_b32 v116, 0x0fffffff, v41
    v_mov_b32 v37, v41
    buffer_load_dwordx4 v[20:23], v116, s[8:11], 0 offen
    buffer_load_dword v33, v116, s[8:11], 0 offen offset:16
    s_waitcnt lgkmcnt(1)
    v_cmp_ne_u64 vcc, v[94:95], v[90:91]
    s_and_b64 s[82:83], vcc, s[80:81]
    s_cbranch_scc1 L2_c60
L2_d60:
    s_mov_b64 exec, vcc
    v_mfma_f32_4x4x4_16b_bf16 v[104:107], v[14:15], v[90:91], 0
    v_mov_b32 v117, v109
    s_or_b64 s[80:81], s[80:81], vcc
    v_mfma_f32_4x4x4_16b_bf16 v[104:107], v[12:13], v[94:95], v[104:107]
    s_mov_b64 exec, -1
    s_waitcnt lgkmcnt(0)
    v_cmp_ne_u64 vcc, v[92:93], v[88:89]
    s_and_b64 s[82:83], vcc, s[80:81]
    s_cbranch_scc1 L2_c61
L2_d61:
    s_mov_b64 exec, vcc
    v_mfma_f32_4x4x4_16b_bf16 v[104:107], v[14:15], v[88:89], 0
    v_mov_b32 v117, v108
    s_or_b64 s[80:81], s[80:81], vcc
    v_mfma_f32_4x4x4_16b_bf16 v[104:107], v[12:13], v[92:93], v[104:107]
    s_mov_b64 exec, -1
    ds_read_b64 v[90:91], v111
    ds_read_b64 v[88:89], v110
    s_waitcnt vmcnt(11)
    v_and_b32 v115, 0x20000000, v38
    v_lshrrev_b32 v116, 14, v25
    v_bitop3_b32 v116, v116, v8, v115 bitop3:0xea
    ds_read_b64 v[86:87], v116 offset:63616
    v_and_b32 v114, 0x10000000, v38
    v_lshrrev_b32 v116, 14, v24
    v_bitop3_b32 v116, v116, v8, v114 bitop3:0xea
    ds_read_b64 v[84:85], v116 offset:63616
    s_waitcnt lgkmcnt(3)
    v_mfma_f32_4x4x4_16b_bf16 v[100:103], v[12:13], v[90:91], v[100:103]
    s_waitcnt lgkmcnt(2)
    v_mfma_f32_4x4x4_16b_bf16 v[96:99], v[12:13], v[88:89], v[96:99]
    v_perm_b32 v112, v24, v34, s44
    v_bitop3_b32 v108, v24, v8, v114 bitop3:0xea
    v_perm_b32 v113, v25, v34, s45
    v_bitop3_b32 v109, v25, v8, v115 bitop3:0xea
    v_cvt_pk_bf16_f32 v100, v100, v101
    v_cvt_pk_bf16_f32 v101, v102, v103
    ds_wrxchg_rtn_b64 v[94:95], v111, v[100:101]
    v_cvt_pk_bf16_f32 v96, v96, v97
    v_cvt_pk_bf16_f32 v97, v98, v99
    ds_wrxchg_rtn_b64 v[92:93], v110, v[96:97]
    s_setprio 1
    s_waitcnt lgkmcnt(3)
    v_mfma_f32_4x4x4_16b_bf16 v[100:103], v[12:13], v[86:87], 0
    s_waitcnt lgkmcnt(2)
    v_mfma_f32_4x4x4_16b_bf16 v[96:99], v[12:13], v[84:85], 0
    v_bitop3_b32 v112, v112, v9, v10 bitop3:0xea
    v_bitop3_b32 v112, v24, v11, v112 bitop3:0xea
    v_bitop3_b32 v113, v113, v9, v10 bitop3:0xea
    v_bitop3_b32 v113, v25, v11, v113 bitop3:0xea
    v_cmp_lt_u32 s[84:85], v8, v108
    v_mul_f32 v100, v113, v100
    v_mul_f32 v101, v113, v101
    v_mul_f32 v102, v113, v102
    v_mul_f32 v103, v113, v103
    v_mul_f32 v96, v112, v96
    v_mul_f32 v97, v112, v97
    v_mul_f32 v98, v112, v98
    v_mul_f32 v99, v112, v99
    s_waitcnt lgkmcnt(1)
    v_cmp_ne_u64 vcc, v[94:95], v[90:91]
    s_and_b64 s[82:83], vcc, s[80:81]
    s_cbranch_scc1 L2_c62
L2_d62:
    s_mov_b64 exec, vcc
    v_mfma_f32_4x4x4_16b_bf16 v[104:107], v[14:15], v[90:91], 0
    v_mov_b32 v117, v111
    s_or_b64 s[80:81], s[80:81], vcc
    v_mfma_f32_4x4x4_16b_bf16 v[104:107], v[12:13], v[94:95], v[104:107]
    s_mov_b64 exec, -1
    s_waitcnt lgkmcnt(0)
    v_cmp_ne_u64 vcc, v[92:93], v[88:89]
    s_and_b64 s[82:83], vcc, s[80:81]
    s_cbranch_scc1 L2_c63
L2_d63:
    s_mov_b64 exec, vcc
    v_mfma_f32_4x4x4_16b_bf16 v[104:107], v[14:15], v[88:89], 0
    v_mov_b32 v117, v110
    s_or_b64 s[80:81], s[80:81], vcc
    v_mfma_f32_4x4x4_16b_bf16 v[104:107], v[12:13], v[92:93], v[104:107]
    s_mov_b64 exec, -1
    ds_read_b64 v[90:91], v109
    s_and_b64 exec, s[84:85], s[80:81]
    s_andn2_b64 s[80:81], s[80:81], s[84:85]
    v_mov_b32 v108, v117
    v_mov_b32 v96, v104
    v_mov_b32 v97, v105
    v_mov_b32 v98, v106
    v_mov_b32 v99, v107
    s_mov_b64 exec, -1
    ds_read_b64 v[88:89], v108
    v_and_b32 v115, 0x80000000, v38
    v_lshrrev_b32 v116, 14, v27
    v_bitop3_b32 v116, v116, v8, v115 bitop3:0xea
    ds_read_b64 v[86:87], v116 offset:63616
    v_and_b32 v114, 0x40000000, v38
    v_lshrrev_b32 v116, 14, v26
    v_bitop3_b32 v116, v116, v8, v114 bitop3:0xea
    ds_read_b64 v[84:85], v116 offset:63616
    s_waitcnt lgkmcnt(3)
    v_mfma_f32_4x4x4_16b_bf16 v[100:103], v[12:13], v[90:91], v[100:103]
    s_waitcnt lgkmcnt(2)
    v_mfma_f32_4x4x4_16b_bf16 v[96:99], v[12:13], v[88:89], v[96:99]
    v_perm_b32 v112, v26, v34, s46
    v_bitop3_b32 v110, v26, v8, v114 bitop3:0xea
    v_perm_b32 v113, v27, v34, s47
    v_bitop3_b32 v111, v27, v8, v115 bitop3:0xea
    v_cvt_pk_bf16_f32 v100, v100, v101
    v_cvt_pk_bf16_f32 v101, v102, v103
    ds_wrxchg_rtn_b64 v[94:95], v109, v[100:101]
    v_cvt_pk_bf16_f32 v96, v96, v97
    v_cvt_pk_bf16_f32 v97, v98, v99
    ds_wrxchg_rtn_b64 v[92:93], v108, v[96:97]
    s_waitcnt lgkmcnt(3)
    v_mfma_f32_4x4x4_16b_bf16 v[100:103], v[12:13], v[86:87], 0
    s_waitcnt lgkmcnt(2)
    v_mfma_f32_4x4x4_16b_bf16 v[96:99], v[12:13], v[84:85], 0
    v_bitop3_b32 v112, v112, v9, v10 bitop3:0xea
    v_bitop3_b32 v112, v26, v11, v112 bitop3:0xea
    v_bitop3_b32 v113, v113, v9, v10 bitop3:0xea
    v_bitop3_b32 v113, v27, v11, v113 bitop3:0xea
    v_mul_f32 v100, v113, v100
    v_mul_f32 v101, v113, v101
    v_mul_f32 v102, v113, v102
    v_mul_f32 v103, v113, v103
    v_mul_f32 v96, v112, v96
    v_mul_f32 v97, v112, v97
    v_mul_f32 v98, v112, v98
    v_mul_f32 v99, v112, v99
    v_and_b32 v116, 0x0fffffff, v42
    v_mov_b32 v38, v42
    buffer_load_dwordx4 v[24:27], v116, s[8:11], 0 offen
    buffer_load_dword v34, v116, s[8:11], 0 offen offset:16
    s_waitcnt lgkmcnt(1)
    v_cmp_ne_u64 vcc, v[94:95], v[90:91]
    s_and_b64 s[82:83], vcc, s[80:81]
    s_cbranch_scc1 L2_c64
L2_d64:
    s_mov_b64 exec, vcc
    v_mfma_f32_4x4x4_16b_bf16 v[104:107], v[14:15], v[90:91], 0
    v_mov_b32 v117, v109
    s_or_b64 s[80:81], s[80:81], vcc
    v_mfma_f32_4x4x4_16b_bf16 v[104:107], v[12:13], v[94:95], v[104:107]
    s_mov_b64 exec, -1
    s_waitcnt lgkmcnt(0)
    v_cmp_ne_u64 vcc, v[92:93], v[88:89]
    s_and_b64 s[82:83], vcc, s[80:81]
    s_cbranch_scc1 L2_c65
L2_d65:
    s_mov_b64 exec, vcc
    v_mfma_f32_4x4x4_16b_bf16 v[104:107], v[14:15], v[88:89], 0
    v_mov_b32 v117, v108
    s_or_b64 s[80:81], s[80:81], vcc
    v_mfma_f32_4x4x4_16b_bf16 v[104:107], v[12:13], v[92:93], v[104:107]
    s_mov_b64 exec, -1
    ds_read_b64 v[90:91], v111
    ds_read_b64 v[88:89], v110
    s_waitcnt vmcnt(11)
    v_and_b32 v115, 0x20000000, v39
    v_lshrrev_b32 v116, 14, v29
    v_bitop3_b32 v116, v116, v8, v115 bitop3:0xea
    ds_read_b64 v[86:87], v116 offset:63616
    v_and_b32 v114, 0x10000000, v39
    v_lshrrev_b32 v116, 14, v28
    v_bitop3_b32 v116, v116, v8, v114 bitop3:0xea
    ds_read_b64 v[84:85], v116 offset:63616
    s_waitcnt lgkmcnt(3)
    v_mfma_f32_4x4x4_16b_bf16 v[100:103], v[12:13], v[90:91], v[100:103]
    s_waitcnt lgkmcnt(2)
    v_mfma_f32_4x4x4_16b_bf16 v[96:99], v[12:13], v[88:89], v[96:99]
    v_perm_b32 v112, v28, v35, s44
    v_bitop3_b32 v108, v28, v8, v114 bitop3:0xea
    v_perm_b32 v113, v29, v35, s45
    v_bitop3_b32 v109, v29, v8, v115 bitop3:0xea
    v_cvt_pk_bf16_f32 v100, v100, v101
    v_cvt_pk_bf16_f32 v101, v102, v103
    ds_wrxchg_rtn_b64 v[94:95], v111, v[100:101]
    v_cvt_pk_bf16_f32 v96, v96, v97
    v_cvt_pk_bf16_f32 v97, v98, v99
    ds_wrxchg_rtn_b64 v[92:93], v110, v[96:97]
    s_setprio 0
    s_waitcnt lgkmcnt(3)
    v_mfma_f32_4x4x4_16b_bf16 v[100:103], v[12:13], v[86:87], 0
    s_waitcnt lgkmcnt(2)
    v_mfma_f32_4x4x4_16b_bf16 v[96:99], v[12:13], v[84:85], 0
    v_bitop3_b32 v112, v112, v9, v10 bitop3:0xea
    v_bitop3_b32 v112, v28, v11, v112 bitop3:0xea
    v_bitop3_b32 v113, v113, v9, v10 bitop3:0xea
    v_bitop3_b32 v113, v29, v11, v113 bitop3:0xea
    v_cmp_lt_u32 s[84:85], v8, v108
    v_mul_f32 v100, v113, v100
    v_mul_f32 v101, v113, v101
    v_mul_f32 v102, v113, v102
    v_mul_f32 v103, v113, v103
    v_mul_f32 v96, v112, v96
    v_mul_f32 v97, v112, v97
    v_mul_f32 v98, v112, v98
    v_mul_f32 v99, v112, v99
    s_waitcnt lgkmcnt(1)
    v_cmp_ne_u64 vcc, v[94:95], v[90:91]
    s_and_b64 s[82:83], vcc, s[80:81]
    s_cbranch_scc1 L2_c66
L2_d66:
    s_mov_b64 exec, vcc
    v_mfma_f32_4x4x4_16b_bf16 v[104:107], v[14:15], v[90:91], 0
    v_mov_b32 v117, v111
    s_or_b64 s[80:81], s[80:81], vcc
    v_mfma_f32_4x4x4_16b_bf16 v[104:107], v[12:13], v[94:95], v[104:107]
    s_mov_b64 exec, -1
    s_waitcnt lgkmcnt(0)
    v_cmp_ne_u64 vcc, v[92:93], v[88:89]
    s_and_b64 s[82:83], vcc, s[80:81]
    s_cbranch_scc1 L2_c67
L2_d67:
    s_mov_b64 exec, vcc
    v_mfma_f32_4x4x4_16b_bf16 v[104:107], v[14:15], v[88:89], 0
    v_mov_b32 v117, v110
    s_or_b64 s[80:81], s[80:81], vcc
    v_mfma_f32_4x4x4_16b_bf16 v[104:107], v[12:13], v[92:93], v[104:107]
    s_mov_b64 exec, -1
    ds_read_b64 v[90:91], v109
    s_and_b64 exec, s[84:85], s[80:81]
    s_andn2_b64 s[80:81], s[80:81], s[84:85]
    v_mov_b32 v108, v117
    v_mov_b32 v96, v104
    v_mov_b32 v97, v105
    v_mov_b32 v98, v106
    v_mov_b32 v99, v107
    s_mov_b64 exec, -1
    ds_read_b64 v[88:89], v108
    v_and_b32 v115, 0x80000000, v39
    v_lshrrev_b32 v116, 14, v31
    v_bitop3_b32 v116, v116, v8, v115 bitop3:0xea
    ds_read_b64 v[86:87], v116 offset:63616
    v_and_b32 v114, 0x40000000, v39
    v_lshrrev_b32 v116, 14, v30
    v_bitop3_b32 v116, v116, v8, v114 bitop3:0xea
    ds_read_b64 v[84:85], v116 offset:63616
    s_waitcnt lgkmcnt(3)
    v_mfma_f32_4x4x4_16b_bf16 v[100:103], v[12:13], v[90:91], v[100:103]
    s_waitcnt lgkmcnt(2)
    v_mfma_f32_4x4x4_16b_bf16 v[96:99], v[12:13], v[88:89], v[96:99]
    v_perm_b32 v112, v30, v35, s46
    v_bitop3_b32 v110, v30, v8, v114 bitop3:0xea
    v_perm_b32 v113, v31, v35, s47
    v_bitop3_b32 v111, v31, v8, v115 bitop3:0xea
    v_cvt_pk_bf16_f32 v100, v100, v101
    v_cvt_pk_bf16_f32 v101, v102, v103
    ds_wrxchg_rtn_b64 v[94:95], v109, v[100:101]
    v_cvt_pk_bf16_f32 v96, v96, v97
    v_cvt_pk_bf16_f32 v97, v98, v99
    ds_wrxchg_rtn_b64 v[92:93], v108, v[96:97]
    s_waitcnt lgkmcnt(3)
    v_mfma_f32_4x4x4_16b_bf16 v[100:103], v[12:13], v[86:87], 0
    s_waitcnt lgkmcnt(2)
    v_mfma_f32_4x4x4_16b_bf16 v[96:99], v[12:13], v[84:85], 0
    v_bitop3_b32 v112, v112, v9, v10 bitop3:0xea
    v_bitop3_b32 v112, v30, v11, v112 bitop3:0xea
    v_bitop3_b32 v113, v113, v9, v10 bitop3:0xea
    v_bitop3_b32 v113, v31, v11, v113 bitop3:0xea
    v_mul_f32 v100, v113, v100
    v_mul_f32 v101, v113, v101
    v_mul_f32 v102, v113, v102
    v_mul_f32 v103, v113, v103
    v_mul_f32 v96, v112, v96
    v_mul_f32 v97, v112, v97
    v_mul_f32 v98, v112, v98
    v_mul_f32 v99, v112, v99
    v_and_b32 v116, 0x0fffffff, v43
    v_mov_b32 v39, v43
    buffer_load_dwordx4 v[28:31], v116, s[8:11], 0 offen
    buffer_load_dword v35, v116, s[8:11], 0 offen offset:16
    s_waitcnt lgkmcnt(1)
    v_cmp_ne_u64 vcc, v[94:95], v[90:91]
    s_and_b64 s[82:83], vcc, s[80:81]
    s_cbranch_scc1 L2_c68
L2_d68:
    s_mov_b64 exec, vcc
    v_mfma_f32_4x4x4_16b_bf16 v[104:107], v[14:15], v[90:91], 0
    v_mov_b32 v117, v109
    s_or_b64 s[80:81], s[80:81], vcc
    v_mfma_f32_4x4x4_16b_bf16 v[104:107], v[12:13], v[94:95], v[104:107]
    s_mov_b64 exec, -1
    s_waitcnt lgkmcnt(0)
    v_cmp_ne_u64 vcc, v[92:93], v[88:89]
    s_and_b64 s[82:83], vcc, s[80:81]
    s_cbranch_scc1 L2_c69
L2_d69:
    s_mov_b64 exec, vcc
    v_mfma_f32_4x4x4_16b_bf16 v[104:107], v[14:15], v[88:89], 0
    v_mov_b32 v117, v108
    s_or_b64 s[80:81], s[80:81], vcc
    v_mfma_f32_4x4x4_16b_bf16 v[104:107], v[12:13], v[92:93], v[104:107]
    s_mov_b64 exec, -1
    ds_read_b64 v[90:91], v111
    ds_read_b64 v[88:89], v110
    s_waitcnt lgkmcnt(1)
    v_mfma_f32_4x4x4_16b_bf16 v[100:103], v[12:13], v[90:91], v[100:103]
    s_waitcnt lgkmcnt(0)
    v_mfma_f32_4x4x4_16b_bf16 v[96:99], v[12:13], v[88:89], v[96:99]
    s_nop 2
    v_cvt_pk_bf16_f32 v100, v100, v101
    v_cvt_pk_bf16_f32 v101, v102, v103
    ds_wrxchg_rtn_b64 v[94:95], v111, v[100:101]
    v_cvt_pk_bf16_f32 v96, v96, v97
    v_cvt_pk_bf16_f32 v97, v98, v99
    ds_wrxchg_rtn_b64 v[92:93], v110, v[96:97]
    s_bitcmp1_b32 s36, s42
    s_cbranch_scc1 L2_slow
L2_ret3:
    s_cmp_eq_u32 s35, 3
    s_cbranch_scc1 L2_done
    s_add_u32 s35, s35, 1
    s_barrier
    s_waitcnt vmcnt(8)
    s_mov_b32 s37, s38
    s_setprio 3
    ds_write_b128 v7, v[52:55] offset:2048
    buffer_load_dwordx4 v[52:55], v6, s[16:19], s40 offen offset:2048
    v_lshrrev_b32 v119, 16, v64
    v_lshrrev_b32 v120, 16, v66
    v_and_b32 v121, -4, v119
    v_add_u32 v121, v121, v2
L2_x70_0:
    v_sub_u32 v122, v120, v121
    v_sub_u32 v124, v119, v121
    v_med3_i32 v123, v122, 0, 4
    v_max_i32 v124, 0, v124
    v_cmp_gt_i32 vcc, v123, v124
    v_mad_u32_u24 v125, v121, 5, v4
    v_bfm_b32 v123, v123, 28
    v_bfm_b32 v124, v124, 28
    v_mbcnt_lo_u32_b32 v126, vcc_lo, 0
    v_mbcnt_hi_u32_b32 v126, vcc_hi, v126
    v_bitop3_b32 v125, v123, v124, v125 bitop3:0x9a
    v_add_lshl_u32 v126, v126, s37, 2
    s_bcnt1_i32_b64 s41, vcc
    s_mov_b64 exec, vcc
    ds_write_b32 v126, v125
    s_mov_b64 exec, -1
    v_cmp_gt_i32 vcc, v122, v3
    s_add_u32 s37, s37, s41
    s_min_u32 s37, s37, s48
    s_cbranch_vccnz L2_xe70_0
L2_xr70_0:
    s_setprio 2
    ds_write_b128 v7, v[56:59] offset:3072
    buffer_load_dwordx4 v[56:59], v6, s[16:19], s40 offen offset:3072
    v_lshrrev_b32 v119, 16, v68
    v_lshrrev_b32 v120, 16, v70
    v_and_b32 v121, -4, v119
    v_add_u32 v121, v121, v2
    v_add_u32 v127, 0x2a4000, v4
L2_x70_1:
    v_sub_u32 v122, v120, v121
    v_sub_u32 v124, v119, v121
    v_med3_i32 v123, v122, 0, 4
    v_max_i32 v124, 0, v124
    v_cmp_gt_i32 vcc, v123, v124
    v_mad_u32_u24 v125, v121, 5, v127
    v_bfm_b32 v123, v123, 28
    v_bfm_b32 v124, v124, 28
    v_mbcnt_lo_u32_b32 v126, vcc_lo, 0
    v_mbcnt_hi_u32_b32 v126, vcc_hi, v126
    v_bitop3_b32 v125, v123, v124, v125 bitop3:0x9a
    v_add_lshl_u32 v126, v126, s37, 2
    s_bcnt1_i32_b64 s41, vcc
    s_mov_b64 exec, vcc
    ds_write_b32 v126, v125
    s_mov_b64 exec, -1
    v_cmp_gt_i32 vcc, v122, v3
    s_add_u32 s37, s37, s41
    s_min_u32 s37, s37, s48
    s_cbranch_vccnz L2_xe70_1
L2_xr70_1:
    s_setprio 1
    ds_write_b128 v7, v[60:63] offset:4096
    s_add_u32 s3, s40, 4096
    buffer_load_dwordx4 v[60:63], v6, s[16:19], s3 offen
    v_lshrrev_b32 v119, 16, v72
    v_lshrrev_b32 v120, 16, v74
    v_and_b32 v121, -4, v119
    v_add_u32 v121, v121, v2
    v_add_u32 v127, 0x548000, v4
L2_x70_2:
    v_sub_u32 v122, v120, v121
    v_sub_u32 v124, v119, v121
    v_med3_i32 v123, v122, 0, 4
    v_max_i32 v124, 0, v124
    v_cmp_gt_i32 vcc, v123, v124
    v_mad_u32_u24 v125, v121, 5, v127
    v_bfm_b32 v123, v123, 28
    v_bfm_b32 v124, v124, 28
    v_mbcnt_lo_u32_b32 v126, vcc_lo, 0
    v_mbcnt_hi_u32_b32 v126, vcc_hi, v126
    v_bitop3_b32 v125, v123, v124, v125 bitop3:0x9a
    v_add_lshl_u32 v126, v126, s37, 2
    s_bcnt1_i32_b64 s41, vcc
    s_mov_b64 exec, vcc
    ds_write_b32 v126, v125
    s_mov_b64 exec, -1
    v_cmp_gt_i32 vcc, v122, v3
    s_add_u32 s37, s37, s41
    s_min_u32 s37, s37, s48
    s_cbranch_vccnz L2_xe70_2
L2_xr70_2:
    s_setprio 0
    v_lshrrev_b32 v119, 16, v76
    v_lshrrev_b32 v120, 16, v78
    v_and_b32 v121, -4, v119
    v_add_u32 v121, v121, v2
    v_add_u32 v127, 0x7ec000, v4
L2_x70_3:
    v_sub_u32 v122, v120, v121
    v_sub_u32 v124, v119, v121
    v_med3_i32 v123, v122, 0, 4
    v_max_i32 v124, 0, v124
    v_cmp_gt_i32 vcc, v123, v124
    v_mad_u32_u24 v125, v121, 5, v127
    v_bfm_b32 v123, v123, 28
    v_bfm_b32 v124, v124, 28
    v_mbcnt_lo_u32_b32 v126, vcc_lo, 0
    v_mbcnt_hi_u32_b32 v126, vcc_hi, v126
    v_bitop3_b32 v125, v123, v124, v125 bitop3:0x9a
    v_add_lshl_u32 v126, v126, s37, 2
    s_bcnt1_i32_b64 s41, vcc
    s_mov_b64 exec, vcc
    ds_write_b32 v126, v125
    s_mov_b64 exec, -1
    v_cmp_gt_i32 vcc, v122, v3
    s_add_u32 s37, s37, s41
    s_min_u32 s37, s37, s48
    s_cbranch_vccnz L2_xe70_3
L2_xr70_3:
    v_lshrrev_b32 v119, 16, v80
    v_lshrrev_b32 v120, 16, v82
    v_and_b32 v121, -4, v119
    v_add_u32 v121, v121, v2
    v_add_u32 v127, 0xa90000, v4
L2_x70_4:
    v_sub_u32 v122, v120, v121
    v_sub_u32 v124, v119, v121
    v_med3_i32 v123, v122, 0, 4
    v_max_i32 v124, 0, v124
    v_cmp_gt_i32 vcc, v123, v124
    v_mad_u32_u24 v125, v121, 5, v127
    v_bfm_b32 v123, v123, 28
    v_bfm_b32 v124, v124, 28
    v_mbcnt_lo_u32_b32 v126, vcc_lo, 0
    v_mbcnt_hi_u32_b32 v126, vcc_hi, v126
    v_bitop3_b32 v125, v123, v124, v125 bitop3:0x9a
    v_add_lshl_u32 v126, v126, s37, 2
    s_bcnt1_i32_b64 s41, vcc
    s_mov_b64 exec, vcc
    ds_write_b32 v126, v125
    s_mov_b64 exec, -1
    v_cmp_gt_i32 vcc, v122, v3
    s_add_u32 s37, s37, s41
    s_min_u32 s37, s37, s48
    s_cbranch_vccnz L2_xe70_4
L2_xr70_4:
    s_lshl_b32 s3, s37, 2
    v_add_u32 v126, s3, v1
    ds_write_b32 v126, v5
    s_lshl_b32 s3, s38, 2
    v_add_u32 v126, s3, v1
    ds_read2st64_b32 v[40:41], v126 offset0:0 offset1:1
    ds_read2st64_b32 v[42:43], v126 offset0:2 offset1:3
    v_add_u32 v5, v118, v5
    s_sub_u32 s41, s37, s38
    s_sub_u32 s3, s41, 192
    s_cmp_gt_u32 s3, 64
    s_cbranch_scc1 L2_xf70
L2_xg70:
    ds_write_b128 v7, v[44:47] offset:0
    ds_write_b128 v7, v[48:51] offset:1024
    s_add_u32 s42, s42, 1
    s_waitcnt lgkmcnt(0)
    s_barrier
    s_branch L2_loop
L2_done:
    s_waitcnt lgkmcnt(0)
    v_cmp_ne_u64 vcc, v[92:93], v[88:89]
    s_and_b64 s[82:83], vcc, s[80:81]
    s_cbranch_scc1 L2_c71
L2_d71:
    s_mov_b64 exec, vcc
    v_mfma_f32_4x4x4_16b_bf16 v[104:107], v[14:15], v[88:89], 0
    v_mov_b32 v117, v110
    s_or_b64 s[80:81], s[80:81], vcc
    v_mfma_f32_4x4x4_16b_bf16 v[104:107], v[12:13], v[92:93], v[104:107]
    s_mov_b64 exec, -1
    v_cmp_ne_u64 vcc, v[94:95], v[90:91]
    s_and_b64 s[82:83], vcc, s[80:81]
    s_cbranch_scc1 L2_c72
L2_d72:
    s_mov_b64 exec, vcc
    v_mfma_f32_4x4x4_16b_bf16 v[104:107], v[14:15], v[90:91], 0
    v_mov_b32 v117, v111
    s_or_b64 s[80:81], s[80:81], vcc
    v_mfma_f32_4x4x4_16b_bf16 v[104:107], v[12:13], v[94:95], v[104:107]
    s_mov_b64 exec, -1
    s_mov_b64 exec, s[80:81]
    s_nop 3
    v_cvt_pk_bf16_f32 v119, v104, v105
    v_cvt_pk_bf16_f32 v120, v106, v107
    ds_pk_add_bf16 v117, v119
    ds_pk_add_bf16 v117, v120 offset:4
    s_mov_b64 exec, -1
    s_waitcnt lgkmcnt(0)
    s_barrier
    v_add_u32 v123, 0x10000, v0
    s_waitcnt vmcnt(0)
    ds_read_b128 v[44:47], v0 offset:0
    ds_read_b128 v[48:51], v0 offset:16384
    ds_read_b128 v[52:55], v0 offset:32768
    ds_read_b128 v[56:59], v0 offset:49152
    ds_read_b128 v[60:63], v123
    v_add_u32 v120, 16384, v0
    v_add_u32 v121, 32768, v0
    v_add_u32 v122, 49152, v0
    s_waitcnt lgkmcnt(4)
    buffer_store_dwordx4 v[44:47], v0, s[20:23], 0 offen
    s_waitcnt lgkmcnt(3)
    buffer_store_dwordx4 v[48:51], v120, s[20:23], 0 offen
    s_waitcnt lgkmcnt(2)
    buffer_store_dwordx4 v[52:55], v121, s[20:23], 0 offen
    s_waitcnt lgkmcnt(1)
    buffer_store_dwordx4 v[56:59], v122, s[20:23], 0 offen
    s_waitcnt lgkmcnt(0)
    buffer_store_dwordx4 v[60:63], v123, s[20:23], 0 offen
L2_end:
    s_endpgm
L2_slow:
    s_mul_i32 s50, s32, 80
    s_add_u32 s57, s50, 80
    s_min_u32 s57, s57, 1250
    s_lshr_b32 s3, s42, 2
    s_mul_i32 s53, s3, 520
    s_add_u32 s53, s53, s39
    s_and_b32 s3, s42, 2
    s_lshl_b32 s3, s3, 1
    s_add_u32 s53, s53, s3
    s_and_b32 s54, s42, 1
    s_lshl_b32 s54, s54, 4
L2_sl_seg:
    s_mul_i32 s56, s50, 173056
    s_add_u32 s3, s56, s53
    s_add_u32 s55, s3, 8
    s_buffer_load_dword s51, s[24:27], s3
    s_buffer_load_dword s52, s[24:27], s55
    s_waitcnt lgkmcnt(0)
    s_lshr_b32 s51, s51, s54
    s_and_b32 s51, s51, 0xffff
    s_lshr_b32 s52, s52, s54
    s_and_b32 s52, s52, 0xffff
L2_sl_rec:
    s_cmp_ge_u32 s51, s52
    s_cbranch_scc1 L2_sl_next
    v_lshrrev_b32 v119, 2, v1
    v_add_u32 v119, s51, v119
    v_and_b32 v120, -4, v119
    v_lshl_add_u32 v121, v119, 2, v120
    v_lshl_add_u32 v122, v120, 2, v119
    v_cmp_gt_u32 vcc, s52, v119
    s_mov_b64 exec, vcc
    buffer_load_dword v123, v121, s[8:11], s56 offen
    buffer_load_ubyte v124, v122, s[8:11], s56 offen offset:16
    s_waitcnt vmcnt(0)
    v_lshrrev_b32 v116, 14, v123
    v_and_b32 v116, v8, v116
    ds_read_b64 v[84:85], v116 offset:63616
    v_perm_b32 v112, v123, v124, s44
    v_and_b32 v125, v8, v123
    v_bitop3_b32 v112, v112, v9, v10 bitop3:0xea
    v_bitop3_b32 v112, v123, v11, v112 bitop3:0xea
    s_waitcnt lgkmcnt(0)
    v_mfma_f32_4x4x4_16b_bf16 v[96:99], v[12:13], v[84:85], 0
    s_nop 4
    v_mul_f32 v96, v112, v96
    v_mul_f32 v97, v112, v97
    v_mul_f32 v98, v112, v98
    v_mul_f32 v99, v112, v99
    v_cvt_pk_bf16_f32 v96, v96, v97
    v_cvt_pk_bf16_f32 v97, v98, v99
    ds_pk_add_bf16 v125, v96
    ds_pk_add_bf16 v125, v97 offset:4
    s_mov_b64 exec, -1
    s_add_u32 s51, s51, 64
    s_branch L2_sl_rec
L2_sl_next:
    s_add_u32 s50, s50, 1
    s_cmp_lt_u32 s50, s57
    s_cbranch_scc1 L2_sl_seg
    s_waitcnt lgkmcnt(0)
    s_and_b32 s3, s42, 3
    s_cmp_eq_u32 s3, 0
    s_cbranch_scc1 L2_ret0
    s_cmp_eq_u32 s3, 1
    s_cbranch_scc1 L2_ret1
    s_cmp_eq_u32 s3, 2
    s_cbranch_scc1 L2_ret2
    s_branch L2_ret3
L2_xe1_0:
    s_cmp_ge_u32 s37, s48
    s_cbranch_scc1 L2_xr1_0
    v_add_u32 v121, 16, v121
    s_branch L2_x1_0
L2_xe1_1:
    s_cmp_ge_u32 s37, s48
    s_cbranch_scc1 L2_xr1_1
    v_add_u32 v121, 16, v121
    s_branch L2_x1_1
L2_xe1_2:
    s_cmp_ge_u32 s37, s48
    s_cbranch_scc1 L2_xr1_2
    v_add_u32 v121, 16, v121
    s_branch L2_x1_2
L2_xe1_3:
    s_cmp_ge_u32 s37, s48
    s_cbranch_scc1 L2_xr1_3
    v_add_u32 v121, 16, v121
    s_branch L2_x1_3
L2_xe1_4:
    s_cmp_ge_u32 s37, s48
    s_cbranch_scc1 L2_xr1_4
    v_add_u32 v121, 16, v121
    s_branch L2_x1_4
L2_xf1:
    s_cmp_le_u32 s41, 256
    s_cbranch_scc1 L2_xh1
    s_add_u32 s3, s42, 0
    s_bitset1_b32 s36, s3
    s_mov_b32 s41, 0
L2_xh1:
    s_lshl_b32 s41, s41, 2
    s_waitcnt lgkmcnt(0)
    v_add_u32 v126, 0, v1
    v_cmp_gt_u32 vcc, s41, v126
    s_nop 1
    v_cndmask_b32 v40, -1, v40, vcc
    v_add_u32 v126, 256, v1
    v_cmp_gt_u32 vcc, s41, v126
    s_nop 1
    v_cndmask_b32 v41, -1, v41, vcc
    v_add_u32 v126, 512, v1
    v_cmp_gt_u32 vcc, s41, v126
    s_nop 1
    v_cndmask_b32 v42, -1, v42, vcc
    v_add_u32 v126, 768, v1
    v_cmp_gt_u32 vcc, s41, v126
    s_nop 1
    v_cndmask_b32 v43, -1, v43, vcc
    s_branch L2_xg1
L2_xe2_0:
    s_cmp_ge_u32 s37, s48
    s_cbranch_scc1 L2_xr2_0
    v_add_u32 v121, 16, v121
    s_branch L2_x2_0
L2_xe2_1:
    s_cmp_ge_u32 s37, s48
    s_cbranch_scc1 L2_xr2_1
    v_add_u32 v121, 16, v121
    s_branch L2_x2_1
L2_xe2_2:
    s_cmp_ge_u32 s37, s48
    s_cbranch_scc1 L2_xr2_2
    v_add_u32 v121, 16, v121
    s_branch L2_x2_2
L2_xe2_3:
    s_cmp_ge_u32 s37, s48
    s_cbranch_scc1 L2_xr2_3
    v_add_u32 v121, 16, v121
    s_branch L2_x2_3
L2_xe2_4:
    s_cmp_ge_u32 s37, s48
    s_cbranch_scc1 L2_xr2_4
    v_add_u32 v121, 16, v121
    s_branch L2_x2_4
L2_xf2:
    s_cmp_le_u32 s41, 256
    s_cbranch_scc1 L2_xh2
    s_add_u32 s3, s42, 1
    s_bitset1_b32 s36, s3
    s_mov_b32 s41, 0
L2_xh2:
    s_lshl_b32 s41, s41, 2
    s_waitcnt lgkmcnt(0)
    v_add_u32 v126, 0, v1
    v_cmp_gt_u32 vcc, s41, v126
    s_nop 1
    v_cndmask_b32 v40, -1, v40, vcc
    v_add_u32 v126, 256, v1
    v_cmp_gt_u32 vcc, s41, v126
    s_nop 1
    v_cndmask_b32 v41, -1, v41, vcc
    v_add_u32 v126, 512, v1
    v_cmp_gt_u32 vcc, s41, v126
    s_nop 1
    v_cndmask_b32 v42, -1, v42, vcc
    v_add_u32 v126, 768, v1
    v_cmp_gt_u32 vcc, s41, v126
    s_nop 1
    v_cndmask_b32 v43, -1, v43, vcc
    s_branch L2_xg2
L2_c3:
    s_mov_b64 exec, s[82:83]
    s_nop 3
    v_cvt_pk_bf16_f32 v119, v104, v105
    v_cvt_pk_bf16_f32 v120, v106, v107
    ds_pk_add_bf16 v117, v119
    ds_pk_add_bf16 v117, v120 offset:4
    s_branch L2_d3
L2_c4:
    s_mov_b64 exec, s[82:83]
    s_nop 3
    v_cvt_pk_bf16_f32 v119, v104, v105
    v_cvt_pk_bf16_f32 v120, v106, v107
    ds_pk_add_bf16 v117, v119
    ds_pk_add_bf16 v117, v120 offset:4
    s_branch L2_d4
L2_c5:
    s_mov_b64 exec, s[82:83]
    s_nop 3
    v_cvt_pk_bf16_f32 v119, v104, v105
    v_cvt_pk_bf16_f32 v120, v106, v107
    ds_pk_add_bf16 v117, v119
    ds_pk_add_bf16 v117, v120 offset:4
    s_branch L2_d5
L2_c6:
    s_mov_b64 exec, s[82:83]
    s_nop 3
    v_cvt_pk_bf16_f32 v119, v104, v105
    v_cvt_pk_bf16_f32 v120, v106, v107
    ds_pk_add_bf16 v117, v119
    ds_pk_add_bf16 v117, v120 offset:4
    s_branch L2_d6
L2_c7:
    s_mov_b64 exec, s[82:83]
    s_nop 3
    v_cvt_pk_bf16_f32 v119, v104, v105
    v_cvt_pk_bf16_f32 v120, v106, v107
    ds_pk_add_bf16 v117, v119
    ds_pk_add_bf16 v117, v120 offset:4
    s_branch L2_d7
L2_c8:
    s_mov_b64 exec, s[82:83]
    s_nop 3
    v_cvt_pk_bf16_f32 v119, v104, v105
    v_cvt_pk_bf16_f32 v120, v106, v107
    ds_pk_add_bf16 v117, v119
    ds_pk_add_bf16 v117, v120 offset:4
    s_branch L2_d8
L2_c9:
    s_mov_b64 exec, s[82:83]
    s_nop 3
    v_cvt_pk_bf16_f32 v119, v104, v105
    v_cvt_pk_bf16_f32 v120, v106, v107
    ds_pk_add_bf16 v117, v119
    ds_pk_add_bf16 v117, v120 offset:4
    s_branch L2_d9
L2_c10:
    s_mov_b64 exec, s[82:83]
    s_nop 3
    v_cvt_pk_bf16_f32 v119, v104, v105
    v_cvt_pk_bf16_f32 v120, v106, v107
    ds_pk_add_bf16 v117, v119
    ds_pk_add_bf16 v117, v120 offset:4
    s_branch L2_d10
L2_c11:
    s_mov_b64 exec, s[82:83]
    s_nop 3
    v_cvt_pk_bf16_f32 v119, v104, v105
    v_cvt_pk_bf16_f32 v120, v106, v107
    ds_pk_add_bf16 v117, v119
    ds_pk_add_bf16 v117, v120 offset:4
    s_branch L2_d11
L2_c12:
    s_mov_b64 exec, s[82:83]
    s_nop 3
    v_cvt_pk_bf16_f32 v119, v104, v105
    v_cvt_pk_bf16_f32 v120, v106, v107
    ds_pk_add_bf16 v117, v119
    ds_pk_add_bf16 v117, v120 offset:4
    s_branch L2_d12
L2_c13:
    s_mov_b64 exec, s[82:83]
    s_nop 3
    v_cvt_pk_bf16_f32 v119, v104, v105
    v_cvt_pk_bf16_f32 v120, v106, v107
    ds_pk_add_bf16 v117, v119
    ds_pk_add_bf16 v117, v120 offset:4
    s_branch L2_d13
L2_c14:
    s_mov_b64 exec, s[82:83]
    s_nop 3
    v_cvt_pk_bf16_f32 v119, v104, v105
    v_cvt_pk_bf16_f32 v120, v106, v107
    ds_pk_add_bf16 v117, v119
    ds_pk_add_bf16 v117, v120 offset:4
    s_branch L2_d14
L2_c15:
    s_mov_b64 exec, s[82:83]
    s_nop 3
    v_cvt_pk_bf16_f32 v119, v104, v105
    v_cvt_pk_bf16_f32 v120, v106, v107
    ds_pk_add_bf16 v117, v119
    ds_pk_add_bf16 v117, v120 offset:4
    s_branch L2_d15
L2_c16:
    s_mov_b64 exec, s[82:83]
    s_nop 3
    v_cvt_pk_bf16_f32 v119, v104, v105
    v_cvt_pk_bf16_f32 v120, v106, v107
    ds_pk_add_bf16 v117, v119
    ds_pk_add_bf16 v117, v120 offset:4
    s_branch L2_d16
L2_c17:
    s_mov_b64 exec, s[82:83]
    s_nop 3
    v_cvt_pk_bf16_f32 v119, v104, v105
    v_cvt_pk_bf16_f32 v120, v106, v107
    ds_pk_add_bf16 v117, v119
    ds_pk_add_bf16 v117, v120 offset:4
    s_branch L2_d17
L2_c18:
    s_mov_b64 exec, s[82:83]
    s_nop 3
    v_cvt_pk_bf16_f32 v119, v104, v105
    v_cvt_pk_bf16_f32 v120, v106, v107
    ds_pk_add_bf16 v117, v119
    ds_pk_add_bf16 v117, v120 offset:4
    s_branch L2_d18
L2_xe19_0:
    s_cmp_ge_u32 s37, s48
    s_cbranch_scc1 L2_xr19_0
    v_add_u32 v121, 16, v121
    s_branch L2_x19_0
L2_xe19_1:
    s_cmp_ge_u32 s37, s48
    s_cbranch_scc1 L2_xr19_1
    v_add_u32 v121, 16, v121
    s_branch L2_x19_1
L2_xe19_2:
    s_cmp_ge_u32 s37, s48
    s_cbranch_scc1 L2_xr19_2
    v_add_u32 v121, 16, v121
    s_branch L2_x19_2
L2_xe19_3:
    s_cmp_ge_u32 s37, s48
    s_cbranch_scc1 L2_xr19_3
    v_add_u32 v121, 16, v121
    s_branch L2_x19_3
L2_xe19_4:
    s_cmp_ge_u32 s37, s48
    s_cbranch_scc1 L2_xr19_4
    v_add_u32 v121, 16, v121
    s_branch L2_x19_4
L2_xf19:
    s_cmp_le_u32 s41, 256
    s_cbranch_scc1 L2_xh19
    s_add_u32 s3, s42, 2
    s_bitset1_b32 s36, s3
    s_mov_b32 s41, 0
L2_xh19:
    s_lshl_b32 s41, s41, 2
    s_waitcnt lgkmcnt(0)
    v_add_u32 v126, 0, v1
    v_cmp_gt_u32 vcc, s41, v126
    s_nop 1
    v_cndmask_b32 v40, -1, v40, vcc
    v_add_u32 v126, 256, v1
    v_cmp_gt_u32 vcc, s41, v126
    s_nop 1
    v_cndmask_b32 v41, -1, v41, vcc
    v_add_u32 v126, 512, v1
    v_cmp_gt_u32 vcc, s41, v126
    s_nop 1
    v_cndmask_b32 v42, -1, v42, vcc
    v_add_u32 v126, 768, v1
    v_cmp_gt_u32 vcc, s41, v126
    s_nop 1
    v_cndmask_b32 v43, -1, v43, vcc
    s_branch L2_xg19
L2_c20:
    s_mov_b64 exec, s[82:83]
    s_nop 3
    v_cvt_pk_bf16_f32 v119, v104, v105
    v_cvt_pk_bf16_f32 v120, v106, v107
    ds_pk_add_bf16 v117, v119
    ds_pk_add_bf16 v117, v120 offset:4
    s_branch L2_d20
L2_c21:
    s_mov_b64 exec, s[82:83]
    s_nop 3
    v_cvt_pk_bf16_f32 v119, v104, v105
    v_cvt_pk_bf16_f32 v120, v106, v107
    ds_pk_add_bf16 v117, v119
    ds_pk_add_bf16 v117, v120 offset:4
    s_branch L2_d21
L2_c22:
    s_mov_b64 exec, s[82:83]
    s_nop 3
    v_cvt_pk_bf16_f32 v119, v104, v105
    v_cvt_pk_bf16_f32 v120, v106, v107
    ds_pk_add_bf16 v117, v119
    ds_pk_add_bf16 v117, v120 offset:4
    s_branch L2_d22
L2_c23:
    s_mov_b64 exec, s[82:83]
    s_nop 3
    v_cvt_pk_bf16_f32 v119, v104, v105
    v_cvt_pk_bf16_f32 v120, v106, v107
    ds_pk_add_bf16 v117, v119
    ds_pk_add_bf16 v117, v120 offset:4
    s_branch L2_d23
L2_c24:
    s_mov_b64 exec, s[82:83]
    s_nop 3
    v_cvt_pk_bf16_f32 v119, v104, v105
    v_cvt_pk_bf16_f32 v120, v106, v107
    ds_pk_add_bf16 v117, v119
    ds_pk_add_bf16 v117, v120 offset:4
    s_branch L2_d24
L2_c25:
    s_mov_b64 exec, s[82:83]
    s_nop 3
    v_cvt_pk_bf16_f32 v119, v104, v105
    v_cvt_pk_bf16_f32 v120, v106, v107
    ds_pk_add_bf16 v117, v119
    ds_pk_add_bf16 v117, v120 offset:4
    s_branch L2_d25
L2_c26:
    s_mov_b64 exec, s[82:83]
    s_nop 3
    v_cvt_pk_bf16_f32 v119, v104, v105
    v_cvt_pk_bf16_f32 v120, v106, v107
    ds_pk_add_bf16 v117, v119
    ds_pk_add_bf16 v117, v120 offset:4
    s_branch L2_d26
L2_c27:
    s_mov_b64 exec, s[82:83]
    s_nop 3
    v_cvt_pk_bf16_f32 v119, v104, v105
    v_cvt_pk_bf16_f32 v120, v106, v107
    ds_pk_add_bf16 v117, v119
    ds_pk_add_bf16 v117, v120 offset:4
    s_branch L2_d27
L2_c28:
    s_mov_b64 exec, s[82:83]
    s_nop 3
    v_cvt_pk_bf16_f32 v119, v104, v105
    v_cvt_pk_bf16_f32 v120, v106, v107
    ds_pk_add_bf16 v117, v119
    ds_pk_add_bf16 v117, v120 offset:4
    s_branch L2_d28
L2_c29:
    s_mov_b64 exec, s[82:83]
    s_nop 3
    v_cvt_pk_bf16_f32 v119, v104, v105
    v_cvt_pk_bf16_f32 v120, v106, v107
    ds_pk_add_bf16 v117, v119
    ds_pk_add_bf16 v117, v120 offset:4
    s_branch L2_d29
L2_c30:
    s_mov_b64 exec, s[82:83]
    s_nop 3
    v_cvt_pk_bf16_f32 v119, v104, v105
    v_cvt_pk_bf16_f32 v120, v106, v107
    ds_pk_add_bf16 v117, v119
    ds_pk_add_bf16 v117, v120 offset:4
    s_branch L2_d30
L2_c31:
    s_mov_b64 exec, s[82:83]
    s_nop 3
    v_cvt_pk_bf16_f32 v119, v104, v105
    v_cvt_pk_bf16_f32 v120, v106, v107
    ds_pk_add_bf16 v117, v119
    ds_pk_add_bf16 v117, v120 offset:4
    s_branch L2_d31
L2_c32:
    s_mov_b64 exec, s[82:83]
    s_nop 3
    v_cvt_pk_bf16_f32 v119, v104, v105
    v_cvt_pk_bf16_f32 v120, v106, v107
    ds_pk_add_bf16 v117, v119
    ds_pk_add_bf16 v117, v120 offset:4
    s_branch L2_d32
L2_c33:
    s_mov_b64 exec, s[82:83]
    s_nop 3
    v_cvt_pk_bf16_f32 v119, v104, v105
    v_cvt_pk_bf16_f32 v120, v106, v107
    ds_pk_add_bf16 v117, v119
    ds_pk_add_bf16 v117, v120 offset:4
    s_branch L2_d33
L2_c34:
    s_mov_b64 exec, s[82:83]
    s_nop 3
    v_cvt_pk_bf16_f32 v119, v104, v105
    v_cvt_pk_bf16_f32 v120, v106, v107
    ds_pk_add_bf16 v117, v119
    ds_pk_add_bf16 v117, v120 offset:4
    s_branch L2_d34
L2_c35:
    s_mov_b64 exec, s[82:83]
    s_nop 3
    v_cvt_pk_bf16_f32 v119, v104, v105
    v_cvt_pk_bf16_f32 v120, v106, v107
    ds_pk_add_bf16 v117, v119
    ds_pk_add_bf16 v117, v120 offset:4
    s_branch L2_d35
L2_xe36_0:
    s_cmp_ge_u32 s37, s48
    s_cbranch_scc1 L2_xr36_0
    v_add_u32 v121, 16, v121
    s_branch L2_x36_0
L2_xe36_1:
    s_cmp_ge_u32 s37, s48
    s_cbranch_scc1 L2_xr36_1
    v_add_u32 v121, 16, v121
    s_branch L2_x36_1
L2_xe36_2:
    s_cmp_ge_u32 s37, s48
    s_cbranch_scc1 L2_xr36_2
    v_add_u32 v121, 16, v121
    s_branch L2_x36_2
L2_xe36_3:
    s_cmp_ge_u32 s37, s48
    s_cbranch_scc1 L2_xr36_3
    v_add_u32 v121, 16, v121
    s_branch L2_x36_3
L2_xe36_4:
    s_cmp_ge_u32 s37, s48
    s_cbranch_scc1 L2_xr36_4
    v_add_u32 v121, 16, v121
    s_branch L2_x36_4
L2_xf36:
    s_cmp_le_u32 s41, 256
    s_cbranch_scc1 L2_xh36
    s_add_u32 s3, s42, 2
    s_bitset1_b32 s36, s3
    s_mov_b32 s41, 0
L2_xh36:
    s_lshl_b32 s41, s41, 2
    s_waitcnt lgkmcnt(0)
    v_add_u32 v126, 0, v1
    v_cmp_gt_u32 vcc, s41, v126
    s_nop 1
    v_cndmask_b32 v40, -1, v40, vcc
    v_add_u32 v126, 256, v1
    v_cmp_gt_u32 vcc, s41, v126
    s_nop 1
    v_cndmask_b32 v41, -1, v41, vcc
    v_add_u32 v126, 512, v1
    v_cmp_gt_u32 vcc, s41, v126
    s_nop 1
    v_cndmask_b32 v42, -1, v42, vcc
    v_add_u32 v126, 768, v1
    v_cmp_gt_u32 vcc, s41, v126
    s_nop 1
    v_cndmask_b32 v43, -1, v43, vcc
    s_branch L2_xg36
L2_c37:
    s_mov_b64 exec, s[82:83]
    s_nop 3
    v_cvt_pk_bf16_f32 v119, v104, v105
    v_cvt_pk_bf16_f32 v120, v106, v107
    ds_pk_add_bf16 v117, v119
    ds_pk_add_bf16 v117, v120 offset:4
    s_branch L2_d37
L2_c38:
    s_mov_b64 exec, s[82:83]
    s_nop 3
    v_cvt_pk_bf16_f32 v119, v104, v105
    v_cvt_pk_bf16_f32 v120, v106, v107
    ds_pk_add_bf16 v117, v119
    ds_pk_add_bf16 v117, v120 offset:4
    s_branch L2_d38
L2_c39:
    s_mov_b64 exec, s[82:83]
    s_nop 3
    v_cvt_pk_bf16_f32 v119, v104, v105
    v_cvt_pk_bf16_f32 v120, v106, v107
    ds_pk_add_bf16 v117, v119
    ds_pk_add_bf16 v117, v120 offset:4
    s_branch L2_d39
L2_c40:
    s_mov_b64 exec, s[82:83]
    s_nop 3
    v_cvt_pk_bf16_f32 v119, v104, v105
    v_cvt_pk_bf16_f32 v120, v106, v107
    ds_pk_add_bf16 v117, v119
    ds_pk_add_bf16 v117, v120 offset:4
    s_branch L2_d40
L2_c41:
    s_mov_b64 exec, s[82:83]
    s_nop 3
    v_cvt_pk_bf16_f32 v119, v104, v105
    v_cvt_pk_bf16_f32 v120, v106, v107
    ds_pk_add_bf16 v117, v119
    ds_pk_add_bf16 v117, v120 offset:4
    s_branch L2_d41
L2_c42:
    s_mov_b64 exec, s[82:83]
    s_nop 3
    v_cvt_pk_bf16_f32 v119, v104, v105
    v_cvt_pk_bf16_f32 v120, v106, v107
    ds_pk_add_bf16 v117, v119
    ds_pk_add_bf16 v117, v120 offset:4
    s_branch L2_d42
L2_c43:
    s_mov_b64 exec, s[82:83]
    s_nop 3
    v_cvt_pk_bf16_f32 v119, v104, v105
    v_cvt_pk_bf16_f32 v120, v106, v107
    ds_pk_add_bf16 v117, v119
    ds_pk_add_bf16 v117, v120 offset:4
    s_branch L2_d43
L2_c44:
    s_mov_b64 exec, s[82:83]
    s_nop 3
    v_cvt_pk_bf16_f32 v119, v104, v105
    v_cvt_pk_bf16_f32 v120, v106, v107
    ds_pk_add_bf16 v117, v119
    ds_pk_add_bf16 v117, v120 offset:4
    s_branch L2_d44
L2_c45:
    s_mov_b64 exec, s[82:83]
    s_nop 3
    v_cvt_pk_bf16_f32 v119, v104, v105
    v_cvt_pk_bf16_f32 v120, v106, v107
    ds_pk_add_bf16 v117, v119
    ds_pk_add_bf16 v117, v120 offset:4
    s_branch L2_d45
L2_c46:
    s_mov_b64 exec, s[82:83]
    s_nop 3
    v_cvt_pk_bf16_f32 v119, v104, v105
    v_cvt_pk_bf16_f32 v120, v106, v107
    ds_pk_add_bf16 v117, v119
    ds_pk_add_bf16 v117, v120 offset:4
    s_branch L2_d46
L2_c47:
    s_mov_b64 exec, s[82:83]
    s_nop 3
    v_cvt_pk_bf16_f32 v119, v104, v105
    v_cvt_pk_bf16_f32 v120, v106, v107
    ds_pk_add_bf16 v117, v119
    ds_pk_add_bf16 v117, v120 offset:4
    s_branch L2_d47
L2_c48:
    s_mov_b64 exec, s[82:83]
    s_nop 3
    v_cvt_pk_bf16_f32 v119, v104, v105
    v_cvt_pk_bf16_f32 v120, v106, v107
    ds_pk_add_bf16 v117, v119
    ds_pk_add_bf16 v117, v120 offset:4
    s_branch L2_d48
L2_c49:
    s_mov_b64 exec, s[82:83]
    s_nop 3
    v_cvt_pk_bf16_f32 v119, v104, v105
    v_cvt_pk_bf16_f32 v120, v106, v107
    ds_pk_add_bf16 v117, v119
    ds_pk_add_bf16 v117, v120 offset:4
    s_branch L2_d49
L2_c50:
    s_mov_b64 exec, s[82:83]
    s_nop 3
    v_cvt_pk_bf16_f32 v119, v104, v105
    v_cvt_pk_bf16_f32 v120, v106, v107
    ds_pk_add_bf16 v117, v119
    ds_pk_add_bf16 v117, v120 offset:4
    s_branch L2_d50
L2_c51:
    s_mov_b64 exec, s[82:83]
    s_nop 3
    v_cvt_pk_bf16_f32 v119, v104, v105
    v_cvt_pk_bf16_f32 v120, v106, v107
    ds_pk_add_bf16 v117, v119
    ds_pk_add_bf16 v117, v120 offset:4
    s_branch L2_d51
L2_c52:
    s_mov_b64 exec, s[82:83]
    s_nop 3
    v_cvt_pk_bf16_f32 v119, v104, v105
    v_cvt_pk_bf16_f32 v120, v106, v107
    ds_pk_add_bf16 v117, v119
    ds_pk_add_bf16 v117, v120 offset:4
    s_branch L2_d52
L2_xe53_0:
    s_cmp_ge_u32 s37, s48
    s_cbranch_scc1 L2_xr53_0
    v_add_u32 v121, 16, v121
    s_branch L2_x53_0
L2_xe53_1:
    s_cmp_ge_u32 s37, s48
    s_cbranch_scc1 L2_xr53_1
    v_add_u32 v121, 16, v121
    s_branch L2_x53_1
L2_xe53_2:
    s_cmp_ge_u32 s37, s48
    s_cbranch_scc1 L2_xr53_2
    v_add_u32 v121, 16, v121
    s_branch L2_x53_2
L2_xe53_3:
    s_cmp_ge_u32 s37, s48
    s_cbranch_scc1 L2_xr53_3
    v_add_u32 v121, 16, v121
    s_branch L2_x53_3
L2_xe53_4:
    s_cmp_ge_u32 s37, s48
    s_cbranch_scc1 L2_xr53_4
    v_add_u32 v121, 16, v121
    s_branch L2_x53_4
L2_xf53:
    s_cmp_le_u32 s41, 256
    s_cbranch_scc1 L2_xh53
    s_add_u32 s3, s42, 2
    s_bitset1_b32 s36, s3
    s_mov_b32 s41, 0
L2_xh53:
    s_lshl_b32 s41, s41, 2
    s_waitcnt lgkmcnt(0)
    v_add_u32 v126, 0, v1
    v_cmp_gt_u32 vcc, s41, v126
    s_nop 1
    v_cndmask_b32 v40, -1, v40, vcc
    v_add_u32 v126, 256, v1
    v_cmp_gt_u32 vcc, s41, v126
    s_nop 1
    v_cndmask_b32 v41, -1, v41, vcc
    v_add_u32 v126, 512, v1
    v_cmp_gt_u32 vcc, s41, v126
    s_nop 1
    v_cndmask_b32 v42, -1, v42, vcc
    v_add_u32 v126, 768, v1
    v_cmp_gt_u32 vcc, s41, v126
    s_nop 1
    v_cndmask_b32 v43, -1, v43, vcc
    s_branch L2_xg53
L2_c54:
    s_mov_b64 exec, s[82:83]
    s_nop 3
    v_cvt_pk_bf16_f32 v119, v104, v105
    v_cvt_pk_bf16_f32 v120, v106, v107
    ds_pk_add_bf16 v117, v119
    ds_pk_add_bf16 v117, v120 offset:4
    s_branch L2_d54
L2_c55:
    s_mov_b64 exec, s[82:83]
    s_nop 3
    v_cvt_pk_bf16_f32 v119, v104, v105
    v_cvt_pk_bf16_f32 v120, v106, v107
    ds_pk_add_bf16 v117, v119
    ds_pk_add_bf16 v117, v120 offset:4
    s_branch L2_d55
L2_c56:
    s_mov_b64 exec, s[82:83]
    s_nop 3
    v_cvt_pk_bf16_f32 v119, v104, v105
    v_cvt_pk_bf16_f32 v120, v106, v107
    ds_pk_add_bf16 v117, v119
    ds_pk_add_bf16 v117, v120 offset:4
    s_branch L2_d56
L2_c57:
    s_mov_b64 exec, s[82:83]
    s_nop 3
    v_cvt_pk_bf16_f32 v119, v104, v105
    v_cvt_pk_bf16_f32 v120, v106, v107
    ds_pk_add_bf16 v117, v119
    ds_pk_add_bf16 v117, v120 offset:4
    s_branch L2_d57
L2_c58:
    s_mov_b64 exec, s[82:83]
    s_nop 3
    v_cvt_pk_bf16_f32 v119, v104, v105
    v_cvt_pk_bf16_f32 v120, v106, v107
    ds_pk_add_bf16 v117, v119
    ds_pk_add_bf16 v117, v120 offset:4
    s_branch L2_d58
L2_c59:
    s_mov_b64 exec, s[82:83]
    s_nop 3
    v_cvt_pk_bf16_f32 v119, v104, v105
    v_cvt_pk_bf16_f32 v120, v106, v107
    ds_pk_add_bf16 v117, v119
    ds_pk_add_bf16 v117, v120 offset:4
    s_branch L2_d59
L2_c60:
    s_mov_b64 exec, s[82:83]
    s_nop 3
    v_cvt_pk_bf16_f32 v119, v104, v105
    v_cvt_pk_bf16_f32 v120, v106, v107
    ds_pk_add_bf16 v117, v119
    ds_pk_add_bf16 v117, v120 offset:4
    s_branch L2_d60
L2_c61:
    s_mov_b64 exec, s[82:83]
    s_nop 3
    v_cvt_pk_bf16_f32 v119, v104, v105
    v_cvt_pk_bf16_f32 v120, v106, v107
    ds_pk_add_bf16 v117, v119
    ds_pk_add_bf16 v117, v120 offset:4
    s_branch L2_d61
L2_c62:
    s_mov_b64 exec, s[82:83]
    s_nop 3
    v_cvt_pk_bf16_f32 v119, v104, v105
    v_cvt_pk_bf16_f32 v120, v106, v107
    ds_pk_add_bf16 v117, v119
    ds_pk_add_bf16 v117, v120 offset:4
    s_branch L2_d62
L2_c63:
    s_mov_b64 exec, s[82:83]
    s_nop 3
    v_cvt_pk_bf16_f32 v119, v104, v105
    v_cvt_pk_bf16_f32 v120, v106, v107
    ds_pk_add_bf16 v117, v119
    ds_pk_add_bf16 v117, v120 offset:4
    s_branch L2_d63
L2_c64:
    s_mov_b64 exec, s[82:83]
    s_nop 3
    v_cvt_pk_bf16_f32 v119, v104, v105
    v_cvt_pk_bf16_f32 v120, v106, v107
    ds_pk_add_bf16 v117, v119
    ds_pk_add_bf16 v117, v120 offset:4
    s_branch L2_d64
L2_c65:
    s_mov_b64 exec, s[82:83]
    s_nop 3
    v_cvt_pk_bf16_f32 v119, v104, v105
    v_cvt_pk_bf16_f32 v120, v106, v107
    ds_pk_add_bf16 v117, v119
    ds_pk_add_bf16 v117, v120 offset:4
    s_branch L2_d65
L2_c66:
    s_mov_b64 exec, s[82:83]
    s_nop 3
    v_cvt_pk_bf16_f32 v119, v104, v105
    v_cvt_pk_bf16_f32 v120, v106, v107
    ds_pk_add_bf16 v117, v119
    ds_pk_add_bf16 v117, v120 offset:4
    s_branch L2_d66
L2_c67:
    s_mov_b64 exec, s[82:83]
    s_nop 3
    v_cvt_pk_bf16_f32 v119, v104, v105
    v_cvt_pk_bf16_f32 v120, v106, v107
    ds_pk_add_bf16 v117, v119
    ds_pk_add_bf16 v117, v120 offset:4
    s_branch L2_d67
L2_c68:
    s_mov_b64 exec, s[82:83]
    s_nop 3
    v_cvt_pk_bf16_f32 v119, v104, v105
    v_cvt_pk_bf16_f32 v120, v106, v107
    ds_pk_add_bf16 v117, v119
    ds_pk_add_bf16 v117, v120 offset:4
    s_branch L2_d68
L2_c69:
    s_mov_b64 exec, s[82:83]
    s_nop 3
    v_cvt_pk_bf16_f32 v119, v104, v105
    v_cvt_pk_bf16_f32 v120, v106, v107
    ds_pk_add_bf16 v117, v119
    ds_pk_add_bf16 v117, v120 offset:4
    s_branch L2_d69
L2_xe70_0:
    s_cmp_ge_u32 s37, s48
    s_cbranch_scc1 L2_xr70_0
    v_add_u32 v121, 16, v121
    s_branch L2_x70_0
L2_xe70_1:
    s_cmp_ge_u32 s37, s48
    s_cbranch_scc1 L2_xr70_1
    v_add_u32 v121, 16, v121
    s_branch L2_x70_1
L2_xe70_2:
    s_cmp_ge_u32 s37, s48
    s_cbranch_scc1 L2_xr70_2
    v_add_u32 v121, 16, v121
    s_branch L2_x70_2
L2_xe70_3:
    s_cmp_ge_u32 s37, s48
    s_cbranch_scc1 L2_xr70_3
    v_add_u32 v121, 16, v121
    s_branch L2_x70_3
L2_xe70_4:
    s_cmp_ge_u32 s37, s48
    s_cbranch_scc1 L2_xr70_4
    v_add_u32 v121, 16, v121
    s_branch L2_x70_4
L2_xf70:
    s_cmp_le_u32 s41, 256
    s_cbranch_scc1 L2_xh70
    s_add_u32 s3, s42, 2
    s_bitset1_b32 s36, s3
    s_mov_b32 s41, 0
L2_xh70:
    s_lshl_b32 s41, s41, 2
    s_waitcnt lgkmcnt(0)
    v_add_u32 v126, 0, v1
    v_cmp_gt_u32 vcc, s41, v126
    s_nop 1
    v_cndmask_b32 v40, -1, v40, vcc
    v_add_u32 v126, 256, v1
    v_cmp_gt_u32 vcc, s41, v126
    s_nop 1
    v_cndmask_b32 v41, -1, v41, vcc
    v_add_u32 v126, 512, v1
    v_cmp_gt_u32 vcc, s41, v126
    s_nop 1
    v_cndmask_b32 v42, -1, v42, vcc
    v_add_u32 v126, 768, v1
    v_cmp_gt_u32 vcc, s41, v126
    s_nop 1
    v_cndmask_b32 v43, -1, v43, vcc
    s_branch L2_xg70
L2_c71:
    s_mov_b64 exec, s[82:83]
    s_nop 3
    v_cvt_pk_bf16_f32 v119, v104, v105
    v_cvt_pk_bf16_f32 v120, v106, v107
    ds_pk_add_bf16 v117, v119
    ds_pk_add_bf16 v117, v120 offset:4
    s_branch L2_d71
L2_c72:
    s_mov_b64 exec, s[82:83]
    s_nop 3
    v_cvt_pk_bf16_f32 v119, v104, v105
    v_cvt_pk_bf16_f32 v120, v106, v107
    ds_pk_add_bf16 v117, v119
    ds_pk_add_bf16 v117, v120 offset:4
    s_branch L2_d72
.text
.globl gs_final_kernel
.p2align 8
.type gs_final_kernel,@function
gs_final_kernel:
    s_cmp_ge_u32 s2, 1250
    s_cbranch_scc1 L3_end
    s_load_dwordx2 s[4:5], s[0:1], 0
    s_load_dwordx2 s[6:7], s[0:1], 24
    s_load_dwordx2 s[28:29], s[0:1], 40
    s_load_dwordx2 s[30:31], s[0:1], 88
    s_load_dwordx2 s[32:33], s[0:1], 104
    s_lshl_b32 s3, s2, 8
    v_add_u32 v1, s3, v0
    v_lshlrev_b32 v2, 4, v1
    v_lshlrev_b32 v3, 2, v1
    v_bfe_u32 v4, v1, 3, 6
    s_mov_b32 s3, 80000
    v_mul_lo_u32 v4, v4, s3
    v_lshrrev_b32 v5, 9, v1
    v_lshl_add_u32 v4, v5, 7, v4
    v_and_b32 v5, 7, v1
    v_lshl_add_u32 v4, v5, 4, v4
    v_and_b32 v5, 3, v0
    v_lshlrev_b32 v5, 6, v5
    s_waitcnt lgkmcnt(0)
    s_load_dwordx4 s[36:39], s[28:29], 0
    s_mov_b32 s8, s4
    s_mov_b32 s9, s5
    s_mov_b32 s10, 0x4e2000
    s_mov_b32 s11, 0x20000
    s_mov_b32 s12, s6
    s_mov_b32 s13, s7
    s_mov_b32 s14, 0x138800
    s_mov_b32 s15, 0x20000
    s_mov_b32 s16, s30
    s_mov_b32 s17, s31
    s_mov_b32 s18, 0x4e2000
    s_mov_b32 s19, 0x20000
    s_add_u32 s20, s32, 0xd32f800
    s_addc_u32 s21, s33, 0
    s_mov_b32 s22, 0x1388000
    s_mov_b32 s23, 0x20000
    s_add_u32 s24, s32, 0xe6b7800
    s_addc_u32 s25, s33, 0
    s_mov_b32 s26, 0x100
    s_mov_b32 s27, 0x20000
    buffer_load_dword v6, v3, s[12:15], 0 offen
    buffer_load_dwordx4 v[8:11], v5, s[24:27], 0 offen
    buffer_load_dwordx4 v[12:15], v5, s[24:27], 0 offen offset:16
    buffer_load_dwordx2 v[16:17], v5, s[24:27], 0 offen offset:32
    s_mov_b32 s40, 0
    buffer_load_dwordx4 v[20:23], v4, s[20:23], s40 offen
    s_mov_b32 s41, 5120000
    buffer_load_dwordx4 v[24:27], v4, s[20:23], s41 offen
    s_mov_b32 s42, 10240000
    buffer_load_dwordx4 v[28:31], v4, s[20:23], s42 offen
    s_mov_b32 s43, 15360000
    buffer_load_dwordx4 v[32:35], v4, s[20:23], s43 offen
    buffer_load_dwordx4 v[36:39], v2, s[8:11], 0 offen
    v_and_b32 v7, 3, v0
    v_lshlrev_b32 v7, 4, v7
    v_mov_b32 v18, 0x3f80
    v_mov_b32 v19, 0
    v_lshlrev_b64 v[18:19], v7, v[18:19]
    s_waitcnt lgkmcnt(0)
    s_lshl_b32 s44, s36, 16
    s_and_b32 s45, s36, 0xffff0000
    s_lshl_b32 s46, s37, 16
    s_and_b32 s47, s37, 0xffff0000
    s_lshl_b32 s48, s38, 16
    s_and_b32 s49, s38, 0xffff0000
    s_lshl_b32 s50, s39, 16
    s_and_b32 s51, s39, 0xffff0000
    s_waitcnt vmcnt(8)
    v_lshlrev_b32 v7, 16, v6
    v_subrev_f32 v48, s44, v7
    v_subrev_f32 v49, s45, v7
    v_subrev_f32 v50, s46, v7
    v_subrev_f32 v51, s47, v7
    v_subrev_f32 v52, s48, v7
    v_subrev_f32 v53, s49, v7
    v_subrev_f32 v54, s50, v7
    v_subrev_f32 v55, s51, v7
    v_cvt_pk_bf16_f32 v56, v48, v49
    v_cvt_pk_bf16_f32 v57, v50, v51
    v_cvt_pk_bf16_f32 v58, v52, v53
    v_cvt_pk_bf16_f32 v59, v54, v55
    v_lshlrev_b32 v48, 16, v56
    v_and_b32 v49, 0xffff0000, v56
    v_lshlrev_b32 v50, 16, v57
    v_and_b32 v51, 0xffff0000, v57
    v_lshlrev_b32 v52, 16, v58
    v_and_b32 v53, 0xffff0000, v58
    v_lshlrev_b32 v54, 16, v59
    v_and_b32 v55, 0xffff0000, v59
    v_mul_f32 v48, v48, v48
    v_mul_f32 v49, v49, v49
    v_mul_f32 v50, v50, v50
    v_mul_f32 v51, v51, v51
    v_mul_f32 v52, v52, v52
    v_mul_f32 v53, v53, v53
    v_mul_f32 v54, v54, v54
    v_mul_f32 v55, v55, v55
    v_cvt_pk_bf16_f32 v56, v48, v49
    v_cvt_pk_bf16_f32 v57, v50, v51
    v_cvt_pk_bf16_f32 v58, v52, v53
    v_cvt_pk_bf16_f32 v59, v54, v55
    v_lshlrev_b32 v48, 16, v56
    v_and_b32 v49, 0xffff0000, v56
    v_lshlrev_b32 v50, 16, v57
    v_and_b32 v51, 0xffff0000, v57
    v_lshlrev_b32 v52, 16, v58
    v_and_b32 v53, 0xffff0000, v58
    v_lshlrev_b32 v54, 16, v59
    v_and_b32 v55, 0xffff0000, v59
    v_mul_f32 v48, 0xc1200000, v48
    v_mul_f32 v49, 0xc1200000, v49
    v_mul_f32 v50, 0xc1200000, v50
    v_mul_f32 v51, 0xc1200000, v51
    v_mul_f32 v52, 0xc1200000, v52
    v_mul_f32 v53, 0xc1200000, v53
    v_mul_f32 v54, 0xc1200000, v54
    v_mul_f32 v55, 0xc1200000, v55
    v_cvt_pk_bf16_f32 v56, v48, v49
    v_cvt_pk_bf16_f32 v57, v50, v51
    v_cvt_pk_bf16_f32 v58, v52, v53
    v_cvt_pk_bf16_f32 v59, v54, v55
    v_lshlrev_b32 v48, 16, v56
    v_and_b32 v49, 0xffff0000, v56
    v_lshlrev_b32 v50, 16, v57
    v_and_b32 v51, 0xffff0000, v57
    v_lshlrev_b32 v52, 16, v58
    v_and_b32 v53, 0xffff0000, v58
    v_lshlrev_b32 v54, 16, v59
    v_and_b32 v55, 0xffff0000, v59
    v_mul_f32 v48, 0x3fb8aa3b, v48
    v_mul_f32 v49, 0x3fb8aa3b, v49
    v_mul_f32 v50, 0x3fb8aa3b, v50
    v_mul_f32 v51, 0x3fb8aa3b, v51
    v_mul_f32 v52, 0x3fb8aa3b, v52
    v_mul_f32 v53, 0x3fb8aa3b, v53
    v_mul_f32 v54, 0x3fb8aa3b, v54
    v_mul_f32 v55, 0x3fb8aa3b, v55
    v_exp_f32 v48, v48
    v_exp_f32 v49, v49
    v_exp_f32 v50, v50
    v_exp_f32 v51, v51
    v_exp_f32 v52, v52
    v_exp_f32 v53, v53
    v_exp_f32 v54, v54
    v_exp_f32 v55, v55
    v_cvt_pk_bf16_f32 v40, v48, v49
    v_cvt_pk_bf16_f32 v41, v50, v51
    v_cvt_pk_bf16_f32 v42, v52, v53
    v_cvt_pk_bf16_f32 v43, v54, v55
    v_and_b32 v7, 0xffff0000, v6
    v_subrev_f32 v48, s44, v7
    v_subrev_f32 v49, s45, v7
    v_subrev_f32 v50, s46, v7
    v_subrev_f32 v51, s47, v7
    v_subrev_f32 v52, s48, v7
    v_subrev_f32 v53, s49, v7
    v_subrev_f32 v54, s50, v7
    v_subrev_f32 v55, s51, v7
    v_cvt_pk_bf16_f32 v56, v48, v49
    v_cvt_pk_bf16_f32 v57, v50, v51
    v_cvt_pk_bf16_f32 v58, v52, v53
    v_cvt_pk_bf16_f32 v59, v54, v55
    v_lshlrev_b32 v48, 16, v56
    v_and_b32 v49, 0xffff0000, v56
    v_lshlrev_b32 v50, 16, v57
    v_and_b32 v51, 0xffff0000, v57
    v_lshlrev_b32 v52, 16, v58
    v_and_b32 v53, 0xffff0000, v58
    v_lshlrev_b32 v54, 16, v59
    v_and_b32 v55, 0xffff0000, v59
    v_mul_f32 v48, v48, v48
    v_mul_f32 v49, v49, v49
    v_mul_f32 v50, v50, v50
    v_mul_f32 v51, v51, v51
    v_mul_f32 v52, v52, v52
    v_mul_f32 v53, v53, v53
    v_mul_f32 v54, v54, v54
    v_mul_f32 v55, v55, v55
    v_cvt_pk_bf16_f32 v56, v48, v49
    v_cvt_pk_bf16_f32 v57, v50, v51
    v_cvt_pk_bf16_f32 v58, v52, v53
    v_cvt_pk_bf16_f32 v59, v54, v55
    v_lshlrev_b32 v48, 16, v56
    v_and_b32 v49, 0xffff0000, v56
    v_lshlrev_b32 v50, 16, v57
    v_and_b32 v51, 0xffff0000, v57
    v_lshlrev_b32 v52, 16, v58
    v_and_b32 v53, 0xffff0000, v58
    v_lshlrev_b32 v54, 16, v59
    v_and_b32 v55, 0xffff0000, v59
    v_mul_f32 v48, 0xc1200000, v48
    v_mul_f32 v49, 0xc1200000, v49
    v_mul_f32 v50, 0xc1200000, v50
    v_mul_f32 v51, 0xc1200000, v51
    v_mul_f32 v52, 0xc1200000, v52
    v_mul_f32 v53, 0xc1200000, v53
    v_mul_f32 v54, 0xc1200000, v54
    v_mul_f32 v55, 0xc1200000, v55
    v_cvt_pk_bf16_f32 v56, v48, v49
    v_cvt_pk_bf16_f32 v57, v50, v51
    v_cvt_pk_bf16_f32 v58, v52, v53
    v_cvt_pk_bf16_f32 v59, v54, v55
    v_lshlrev_b32 v48, 16, v56
    v_and_b32 v49, 0xffff0000, v56
    v_lshlrev_b32 v50, 16, v57
    v_and_b32 v51, 0xffff0000, v57
    v_lshlrev_b32 v52, 16, v58
    v_and_b32 v53, 0xffff0000, v58
    v_lshlrev_b32 v54, 16, v59
    v_and_b32 v55, 0xffff0000, v59
    v_mul_f32 v48, 0x3fb8aa3b, v48
    v_mul_f32 v49, 0x3fb8aa3b, v49
    v_mul_f32 v50, 0x3fb8aa3b, v50
    v_mul_f32 v51, 0x3fb8aa3b, v51
    v_mul_f32 v52, 0x3fb8aa3b, v52
    v_mul_f32 v53, 0x3fb8aa3b, v53
    v_mul_f32 v54, 0x3fb8aa3b, v54
    v_mul_f32 v55, 0x3fb8aa3b, v55
    v_exp_f32 v48, v48
    v_exp_f32 v49, v49
    v_exp_f32 v50, v50
    v_exp_f32 v51, v51
    v_exp_f32 v52, v52
    v_exp_f32 v53, v53
    v_exp_f32 v54, v54
    v_exp_f32 v55, v55
    v_cvt_pk_bf16_f32 v44, v48, v49
    v_cvt_pk_bf16_f32 v45, v50, v51
    v_cvt_pk_bf16_f32 v46, v52, v53
    v_cvt_pk_bf16_f32 v47, v54, v55
    s_waitcnt vmcnt(5)
    v_mfma_f32_4x4x4_16b_bf16 v[48:51], v[8:9], v[40:41], 0
    v_mfma_f32_4x4x4_16b_bf16 v[56:59], v[12:13], v[40:41], 0
    v_mfma_f32_4x4x4_16b_bf16 v[52:55], v[8:9], v[44:45], 0
    v_mfma_f32_4x4x4_16b_bf16 v[60:63], v[12:13], v[44:45], 0
    v_mfma_f32_4x4x4_16b_bf16 v[48:51], v[10:11], v[42:43], v[48:51]
    v_mfma_f32_4x4x4_16b_bf16 v[56:59], v[14:15], v[42:43], v[56:59]
    v_mfma_f32_4x4x4_16b_bf16 v[52:55], v[10:11], v[46:47], v[52:55]
    v_mfma_f32_4x4x4_16b_bf16 v[60:63], v[14:15], v[46:47], v[60:63]
    s_waitcnt vmcnt(1)
    v_mfma_f32_4x4x4_16b_bf16 v[64:67], v[18:19], v[20:21], 0
    v_mfma_f32_4x4x4_16b_bf16 v[68:71], v[18:19], v[22:23], 0
    s_nop 0
    v_mfma_f32_4x4x4_16b_bf16 v[64:67], v[18:19], v[24:25], v[64:67]
    v_mfma_f32_4x4x4_16b_bf16 v[68:71], v[18:19], v[26:27], v[68:71]
    s_nop 0
    v_mfma_f32_4x4x4_16b_bf16 v[64:67], v[18:19], v[28:29], v[64:67]
    v_mfma_f32_4x4x4_16b_bf16 v[68:71], v[18:19], v[30:31], v[68:71]
    s_nop 0
    v_mfma_f32_4x4x4_16b_bf16 v[64:67], v[18:19], v[32:33], v[64:67]
    v_mfma_f32_4x4x4_16b_bf16 v[68:71], v[18:19], v[34:35], v[68:71]
    s_nop 3
    v_mul_f32 v64, v64, v48
    v_mul_f32 v65, v65, v49
    v_mul_f32 v66, v66, v50
    v_mul_f32 v67, v67, v51
    v_cvt_pk_bf16_f32 v20, v64, v65
    v_cvt_pk_bf16_f32 v21, v66, v67
    v_mul_f32 v68, v68, v52
    v_mul_f32 v69, v69, v53
    v_mul_f32 v70, v70, v54
    v_mul_f32 v71, v71, v55
    v_cvt_pk_bf16_f32 v22, v68, v69
    v_cvt_pk_bf16_f32 v23, v70, v71
    v_mfma_f32_4x4x4_16b_bf16 v[48:51], v[16:17], v[20:21], 0
    s_nop 0
    v_mfma_f32_4x4x4_16b_bf16 v[52:55], v[16:17], v[22:23], 0
    s_nop 2
    v_mul_f32 v48, v48, v56
    v_mul_f32 v49, v49, v57
    v_mul_f32 v50, v50, v58
    v_mul_f32 v51, v51, v59
    v_mul_f32 v52, v52, v60
    v_mul_f32 v53, v53, v61
    v_mul_f32 v54, v54, v62
    v_mul_f32 v55, v55, v63
    s_waitcnt vmcnt(0)
    v_mfma_f32_4x4x4_16b_bf16 v[64:67], v[18:19], v[36:37], v[48:51]
    v_mfma_f32_4x4x4_16b_bf16 v[68:71], v[18:19], v[38:39], v[52:55]
    s_nop 3
    v_cvt_pk_bf16_f32 v24, v64, v65
    v_cvt_pk_bf16_f32 v25, v66, v67
    v_cvt_pk_bf16_f32 v26, v68, v69
    v_cvt_pk_bf16_f32 v27, v70, v71
    buffer_store_dwordx4 v[24:27], v2, s[16:19], 0 offen
L3_end:
    s_endpgm
.section .rodata,"a"
.p2align 6
.amdhsa_kernel gs_sort_kernel
  .amdhsa_next_free_vgpr 128
  .amdhsa_next_free_sgpr 96
  .amdhsa_accum_offset 128
  .amdhsa_group_segment_fixed_size 0
  .amdhsa_kernarg_size 112
  .amdhsa_user_sgpr_count 2
  .amdhsa_user_sgpr_kernarg_segment_ptr 1
  .amdhsa_system_sgpr_workgroup_id_x 1
  .amdhsa_float_denorm_mode_32 3
.end_amdhsa_kernel
.p2align 6
.amdhsa_kernel gs_acc_kernel
  .amdhsa_next_free_vgpr 128
  .amdhsa_next_free_sgpr 96
  .amdhsa_accum_offset 128
  .amdhsa_group_segment_fixed_size 0
  .amdhsa_kernarg_size 112
  .amdhsa_user_sgpr_count 2
  .amdhsa_user_sgpr_kernarg_segment_ptr 1
  .amdhsa_system_sgpr_workgroup_id_x 1
  .amdhsa_float_denorm_mode_32 3
.end_amdhsa_kernel
.p2align 6
.amdhsa_kernel gs_final_kernel
  .amdhsa_next_free_vgpr 72
  .amdhsa_next_free_sgpr 64
  .amdhsa_accum_offset 72
  .amdhsa_group_segment_fixed_size 0
  .amdhsa_kernarg_size 112
  .amdhsa_user_sgpr_count 2
  .amdhsa_user_sgpr_kernarg_segment_ptr 1
  .amdhsa_system_sgpr_workgroup_id_x 1
  .amdhsa_float_denorm_mode_32 3
.end_amdhsa_kernel
```

```asm
; @launch kernel=gs_sort_kernel grid=(256,1,1) block=(1024,1,1) lds=163840
; @launch kernel=gs_acc_kernel grid=(256,1,1) block=(1024,1,1) lds=163840
; @launch kernel=gs_final_kernel grid=(1250,1,1) block=(256,1,1) lds=0
.amdgcn_target "amdgcn-amd-amdhsa--gfx950"
.text
.globl gs_sort_kernel
.p2align 8
.type gs_sort_kernel,@function
gs_sort_kernel:
    s_cmp_ge_u32 s2, 256
    s_cbranch_scc1 L1_end
    s_load_dwordx4 s[4:7], s[0:1], 8
    s_load_dwordx2 s[28:29], s[0:1], 32
    s_load_dwordx2 s[30:31], s[0:1], 104
    s_load_dwordx2 s[56:57], s[0:1], 96
    s_load_dwordx2 s[86:87], s[0:1], 0
    s_load_dwordx4 s[60:63], s[0:1], 56
    s_load_dwordx4 s[64:67], s[0:1], 72
    v_lshrrev_b32 v7, 6, v0
    v_lshlrev_b32 v1, 3, v0
    v_readfirstlane_b32 s32, v7
    v_lshlrev_b32 v0, 4, v0
    s_mul_i32 s33, s2, 131072
    s_mul_i32 s34, s2, 65536
    s_waitcnt lgkmcnt(0)
    s_mov_b32 s8, s4
    s_mov_b32 s9, s5
    s_mov_b32 s10, 0x9c40000
    s_mov_b32 s11, 0x20000
    s_mov_b32 s12, s6
    s_mov_b32 s13, s7
    s_mov_b32 s14, 0x9c40000
    s_mov_b32 s15, 0x20000
    s_mov_b32 s16, s28
    s_mov_b32 s17, s29
    s_mov_b32 s18, 0x4e20000
    s_mov_b32 s19, 0x20000
    s_add_u32 s44, s33, 0x0
    buffer_load_dwordx4 v[16:19], v0, s[8:11], s44 offen nt
    s_add_u32 s45, s33, 0x0
    buffer_load_dwordx4 v[20:23], v0, s[12:15], s45 offen nt
    s_add_u32 s46, s34, 0x0
    buffer_load_dwordx2 v[24:25], v1, s[16:19], s46 offen nt
    s_add_u32 s47, s34, 0x2000
    buffer_load_dwordx2 v[26:27], v1, s[16:19], s47 offen nt
    s_add_u32 s44, s33, 0x4000
    buffer_load_dwordx4 v[28:31], v0, s[8:11], s44 offen nt
    s_add_u32 s45, s33, 0x4000
    buffer_load_dwordx4 v[32:35], v0, s[12:15], s45 offen nt
    s_add_u32 s46, s33, 0x8000
    buffer_load_dwordx4 v[36:39], v0, s[8:11], s46 offen nt
    s_add_u32 s47, s33, 0x8000
    buffer_load_dwordx4 v[40:43], v0, s[12:15], s47 offen nt
    s_add_u32 s44, s34, 0x4000
    buffer_load_dwordx2 v[44:45], v1, s[16:19], s44 offen nt
    s_add_u32 s45, s34, 0x6000
    buffer_load_dwordx2 v[46:47], v1, s[16:19], s45 offen nt
    s_mov_b32 s68, s62
    s_mov_b32 s69, s63
    s_mov_b32 s70, 0x40
    s_mov_b32 s71, 0x20000
    s_mov_b32 s72, s60
    s_mov_b32 s73, s61
    s_mov_b32 s74, 0x40
    s_mov_b32 s75, 0x20000
    s_mov_b32 s20, s66
    s_mov_b32 s21, s67
    s_mov_b32 s22, 0x20
    s_mov_b32 s23, 0x20000
    s_mov_b32 s80, s64
    s_mov_b32 s81, s65
    s_mov_b32 s82, 0x20
    s_mov_b32 s83, 0x20000
    s_add_u32 s24, s30, 0xebab000
    s_addc_u32 s25, s31, 0
    s_mov_b32 s26, 0x100
    s_mov_b32 s27, 0x20000
    v_lshrrev_b32 v2, 3, v0
    v_and_b32 v2, 6, v2
    v_lshlrev_b32 v3, 2, v0
    s_lshl_b32 s3, s32, 8
    s_add_u32 s3, s3, s2
    s_cmp_lg_u32 s3, 254
    s_cbranch_scc1 L1_wt
    buffer_load_ushort v96, v2, s[68:71], 0 offen offset:0
    buffer_load_ushort v108, v2, s[68:71], 0 offen offset:8
    buffer_load_ushort v97, v2, s[68:71], 0 offen offset:16
    buffer_load_ushort v109, v2, s[68:71], 0 offen offset:24
    buffer_load_ushort v98, v2, s[68:71], 0 offen offset:32
    buffer_load_ushort v110, v2, s[68:71], 0 offen offset:40
    buffer_load_ushort v99, v2, s[68:71], 0 offen offset:48
    buffer_load_ushort v111, v2, s[68:71], 0 offen offset:56
    buffer_load_ushort v100, v2, s[72:75], 0 offen offset:0
    buffer_load_ushort v112, v2, s[72:75], 0 offen offset:8
    buffer_load_ushort v101, v2, s[72:75], 0 offen offset:16
    buffer_load_ushort v113, v2, s[72:75], 0 offen offset:24
    buffer_load_ushort v102, v2, s[72:75], 0 offen offset:32
    buffer_load_ushort v114, v2, s[72:75], 0 offen offset:40
    buffer_load_ushort v103, v2, s[72:75], 0 offen offset:48
    buffer_load_ushort v115, v2, s[72:75], 0 offen offset:56
    buffer_load_ushort v104, v2, s[20:23], 0 offen offset:0
    buffer_load_ushort v116, v2, s[20:23], 0 offen offset:8
    buffer_load_ushort v105, v2, s[20:23], 0 offen offset:16
    buffer_load_ushort v117, v2, s[20:23], 0 offen offset:24
    buffer_load_ushort v106, v2, s[80:83], 0 offen offset:0
    buffer_load_ushort v118, v2, s[80:83], 0 offen offset:8
    buffer_load_ushort v107, v2, s[80:83], 0 offen offset:16
    buffer_load_ushort v119, v2, s[80:83], 0 offen offset:24
    s_waitcnt vmcnt(0)
    v_lshl_or_b32 v96, v108, 16, v96
    v_lshl_or_b32 v97, v109, 16, v97
    v_lshl_or_b32 v98, v110, 16, v98
    v_lshl_or_b32 v99, v111, 16, v99
    v_lshl_or_b32 v100, v112, 16, v100
    v_lshl_or_b32 v101, v113, 16, v101
    v_lshl_or_b32 v102, v114, 16, v102
    v_lshl_or_b32 v103, v115, 16, v103
    v_lshl_or_b32 v104, v116, 16, v104
    v_lshl_or_b32 v105, v117, 16, v105
    v_lshl_or_b32 v106, v118, 16, v106
    v_lshl_or_b32 v107, v119, 16, v107
    buffer_store_dwordx4 v[96:99], v3, s[24:27], 0 offen offset:0
    buffer_store_dwordx4 v[100:103], v3, s[24:27], 0 offen offset:16
    buffer_store_dwordx4 v[104:107], v3, s[24:27], 0 offen offset:32
L1_wt:
    s_mov_b32 s20, s30
    s_mov_b32 s21, s31
    s_mov_b32 s22, 0xd340000
    s_mov_b32 s23, 0x20000
    s_add_u32 s24, s30, 0x28000
    s_addc_u32 s25, s31, 0
    s_mov_b32 s26, 0xd318000
    s_mov_b32 s27, 0x20000
    s_mov_b32 s80, s86
    s_mov_b32 s81, s87
    s_mov_b32 s82, 0x4e20
    s_mov_b32 s83, 0x20000
    s_mul_i32 s3, s2, 20000
    s_add_u32 s80, s80, s3
    s_addc_u32 s81, s81, 0
    s_mul_i32 s35, s2, 173056
    s_and_b32 s37, s32, 3
    s_lshl_b32 s37, s37, 3
    s_add_u32 s36, s35, s37
    s_lshr_b32 s37, s32, 2
    s_mul_i32 s37, s37, 2080
    s_add_u32 s36, s36, s37
    s_mul_i32 s4, s2, 5
    s_add_u32 s4, s4, 8192
    s_lshl_b32 s38, s4, 14
    s_lshl_b32 s39, s4, 13
    v_mov_b32 v2, 1
    v_mov_b32 v4, 0x80000007
    v_mov_b32 v5, 0xfc
    v_mov_b32 v6, 0x78
    s_mov_b32 s40, 2048
    s_mov_b32 s55, -10000
    s_mov_b32 s41, 0x010c0c01
    s_mov_b32 s42, 0x030c0c03
    v_mov_b32 v8, 0
    v_mov_b32 v9, 0
    v_mov_b32 v10, 0
    v_mov_b32 v11, 0
    ds_write_b128 v0, v[8:11]
    s_waitcnt lgkmcnt(0)
    s_barrier
    s_add_u32 s46, s33, 0xc000
    buffer_load_dwordx4 v[48:51], v0, s[8:11], s46 offen nt
    s_add_u32 s47, s33, 0xc000
    buffer_load_dwordx4 v[52:55], v0, s[12:15], s47 offen nt
    s_waitcnt vmcnt(8)
    v_lshlrev_b32 v7, 16, v24
    v_and_b32 v8, 0xffff0000, v24
    v_lshlrev_b32 v9, 16, v25
    v_and_b32 v10, 0xffff0000, v25
    v_mul_f32 v7, 0.15915494, v7
    v_mul_f32 v8, 0.15915494, v8
    v_mul_f32 v9, 0.15915494, v9
    v_mul_f32 v10, 0.15915494, v10
    v_mul_hi_u32_u24 v14, 429497, v16
    v_lshrrev_b32 v12, 3, v20
    v_cos_f32 v7, v7
    v_lshlrev_b16 v13, 3, v20
    v_mad_i32_i24 v11, v14, s55, v16
    v_bitop3_b32 v12, v6, v13, v12 bitop3:0xca
    v_add_lshl_u32 v11, v11, s40, 17
    v_lshlrev_b16 v14, 8, v14
    v_lshrrev_b32 v13, 2, v20
    v_or_b32 v16, v12, v11
    v_bitop3_b32 v20, v5, v13, v14 bitop3:0xea
    ds_add_u32 v20, v2
    v_mul_hi_u32_u24 v14, 429497, v17
    v_lshrrev_b32 v12, 3, v21
    v_cos_f32 v8, v8
    v_lshlrev_b16 v13, 3, v21
    v_mad_i32_i24 v11, v14, s55, v17
    v_bitop3_b32 v12, v6, v13, v12 bitop3:0xca
    v_add_lshl_u32 v11, v11, s40, 17
    v_lshlrev_b16 v14, 8, v14
    v_lshrrev_b32 v13, 2, v21
    v_or_b32 v17, v12, v11
    v_bitop3_b32 v21, v5, v13, v14 bitop3:0xea
    ds_add_u32 v21, v2
    v_cvt_pk_bf16_f32 v24, v7, v8
    v_perm_b32 v12, v24, v24, s41
    v_bitop3_b32 v16, v4, v12, v16 bitop3:0xca
    v_perm_b32 v13, v24, v24, s42
    v_bitop3_b32 v17, v4, v13, v17 bitop3:0xca
    v_mul_hi_u32_u24 v14, 429497, v18
    v_lshrrev_b32 v12, 3, v22
    v_cos_f32 v9, v9
    v_lshlrev_b16 v13, 3, v22
    v_mad_i32_i24 v11, v14, s55, v18
    v_bitop3_b32 v12, v6, v13, v12 bitop3:0xca
    v_add_lshl_u32 v11, v11, s40, 17
    v_lshlrev_b16 v14, 8, v14
    v_lshrrev_b32 v13, 2, v22
    v_or_b32 v18, v12, v11
    v_bitop3_b32 v22, v5, v13, v14 bitop3:0xea
    ds_add_u32 v22, v2
    v_mul_hi_u32_u24 v14, 429497, v19
    v_lshrrev_b32 v12, 3, v23
    v_cos_f32 v10, v10
    v_lshlrev_b16 v13, 3, v23
    v_mad_i32_i24 v11, v14, s55, v19
    v_bitop3_b32 v12, v6, v13, v12 bitop3:0xca
    v_add_lshl_u32 v11, v11, s40, 17
    v_lshlrev_b16 v14, 8, v14
    v_lshrrev_b32 v13, 2, v23
    v_or_b32 v19, v12, v11
    v_bitop3_b32 v23, v5, v13, v14 bitop3:0xea
    ds_add_u32 v23, v2
    v_cvt_pk_bf16_f32 v25, v9, v10
    v_perm_b32 v12, v25, v25, s41
    v_bitop3_b32 v18, v4, v12, v18 bitop3:0xca
    v_perm_b32 v13, v25, v25, s42
    v_bitop3_b32 v19, v4, v13, v19 bitop3:0xca
    s_add_u32 s44, s33, 0x10000
    buffer_load_dwordx4 v[56:59], v0, s[8:11], s44 offen nt
    s_add_u32 s45, s33, 0x10000
    buffer_load_dwordx4 v[60:63], v0, s[12:15], s45 offen nt
    s_add_u32 s46, s34, 0x8000
    buffer_load_dwordx2 v[64:65], v1, s[16:19], s46 offen nt
    s_add_u32 s47, s34, 0xa000
    buffer_load_dwordx2 v[66:67], v1, s[16:19], s47 offen nt
    s_waitcnt vmcnt(10)
    v_lshlrev_b32 v7, 16, v26
    v_and_b32 v8, 0xffff0000, v26
    v_lshlrev_b32 v9, 16, v27
    v_and_b32 v10, 0xffff0000, v27
    v_mul_f32 v7, 0.15915494, v7
    v_mul_f32 v8, 0.15915494, v8
    v_mul_f32 v9, 0.15915494, v9
    v_mul_f32 v10, 0.15915494, v10
    v_mul_hi_u32_u24 v14, 429497, v28
    v_lshrrev_b32 v12, 3, v32
    v_cos_f32 v7, v7
    v_lshlrev_b16 v13, 3, v32
    v_mad_i32_i24 v11, v14, s55, v28
    v_bitop3_b32 v12, v6, v13, v12 bitop3:0xca
    v_add_lshl_u32 v11, v11, s40, 17
    v_lshlrev_b16 v14, 8, v14
    v_lshrrev_b32 v13, 2, v32
    v_or_b32 v28, v12, v11
    v_bitop3_b32 v32, v5, v13, v14 bitop3:0xea
    ds_add_u32 v32, v2
    v_mul_hi_u32_u24 v14, 429497, v29
    v_lshrrev_b32 v12, 3, v33
    v_cos_f32 v8, v8
    v_lshlrev_b16 v13, 3, v33
    v_mad_i32_i24 v11, v14, s55, v29
    v_bitop3_b32 v12, v6, v13, v12 bitop3:0xca
    v_add_lshl_u32 v11, v11, s40, 17
    v_lshlrev_b16 v14, 8, v14
    v_lshrrev_b32 v13, 2, v33
    v_or_b32 v29, v12, v11
    v_bitop3_b32 v33, v5, v13, v14 bitop3:0xea
    ds_add_u32 v33, v2
    v_cvt_pk_bf16_f32 v26, v7, v8
    v_perm_b32 v12, v26, v26, s41
    v_bitop3_b32 v28, v4, v12, v28 bitop3:0xca
    v_perm_b32 v13, v26, v26, s42
    v_bitop3_b32 v29, v4, v13, v29 bitop3:0xca
    v_mul_hi_u32_u24 v14, 429497, v30
    v_lshrrev_b32 v12, 3, v34
    v_cos_f32 v9, v9
    v_lshlrev_b16 v13, 3, v34
    v_mad_i32_i24 v11, v14, s55, v30
    v_bitop3_b32 v12, v6, v13, v12 bitop3:0xca
    v_add_lshl_u32 v11, v11, s40, 17
    v_lshlrev_b16 v14, 8, v14
    v_lshrrev_b32 v13, 2, v34
    v_or_b32 v30, v12, v11
    v_bitop3_b32 v34, v5, v13, v14 bitop3:0xea
    ds_add_u32 v34, v2
    v_mul_hi_u32_u24 v14, 429497, v31
    v_lshrrev_b32 v12, 3, v35
    v_cos_f32 v10, v10
    v_lshlrev_b16 v13, 3, v35
    v_mad_i32_i24 v11, v14, s55, v31
    v_bitop3_b32 v12, v6, v13, v12 bitop3:0xca
    v_add_lshl_u32 v11, v11, s40, 17
    v_lshlrev_b16 v14, 8, v14
    v_lshrrev_b32 v13, 2, v35
    v_or_b32 v31, v12, v11
    v_bitop3_b32 v35, v5, v13, v14 bitop3:0xea
    ds_add_u32 v35, v2
    v_cvt_pk_bf16_f32 v27, v9, v10
    v_perm_b32 v12, v27, v27, s41
    v_bitop3_b32 v30, v4, v12, v30 bitop3:0xca
    v_perm_b32 v13, v27, v27, s42
    v_bitop3_b32 v31, v4, v13, v31 bitop3:0xca
    s_add_u32 s44, s33, 0x14000
    buffer_load_dwordx4 v[68:71], v0, s[8:11], s44 offen nt
    s_add_u32 s45, s33, 0x14000
    buffer_load_dwordx4 v[72:75], v0, s[12:15], s45 offen nt
    s_waitcnt vmcnt(8)
    v_lshlrev_b32 v7, 16, v44
    v_and_b32 v8, 0xffff0000, v44
    v_lshlrev_b32 v9, 16, v45
    v_and_b32 v10, 0xffff0000, v45
    v_mul_f32 v7, 0.15915494, v7
    v_mul_f32 v8, 0.15915494, v8
    v_mul_f32 v9, 0.15915494, v9
    v_mul_f32 v10, 0.15915494, v10
    v_mul_hi_u32_u24 v14, 429497, v36
    v_lshrrev_b32 v12, 3, v40
    v_cos_f32 v7, v7
    v_lshlrev_b16 v13, 3, v40
    v_mad_i32_i24 v11, v14, s55, v36
    v_bitop3_b32 v12, v6, v13, v12 bitop3:0xca
    v_add_lshl_u32 v11, v11, s40, 17
    v_lshlrev_b16 v14, 8, v14
    v_lshrrev_b32 v13, 2, v40
    v_or_b32 v36, v12, v11
    v_bitop3_b32 v40, v5, v13, v14 bitop3:0xea
    ds_add_u32 v40, v2
    v_mul_hi_u32_u24 v14, 429497, v37
    v_lshrrev_b32 v12, 3, v41
    v_cos_f32 v8, v8
    v_lshlrev_b16 v13, 3, v41
    v_mad_i32_i24 v11, v14, s55, v37
    v_bitop3_b32 v12, v6, v13, v12 bitop3:0xca
    v_add_lshl_u32 v11, v11, s40, 17
    v_lshlrev_b16 v14, 8, v14
    v_lshrrev_b32 v13, 2, v41
    v_or_b32 v37, v12, v11
    v_bitop3_b32 v41, v5, v13, v14 bitop3:0xea
    ds_add_u32 v41, v2
    v_cvt_pk_bf16_f32 v44, v7, v8
    v_perm_b32 v12, v44, v44, s41
    v_bitop3_b32 v36, v4, v12, v36 bitop3:0xca
    v_perm_b32 v13, v44, v44, s42
    v_bitop3_b32 v37, v4, v13, v37 bitop3:0xca
    v_mul_hi_u32_u24 v14, 429497, v38
    v_lshrrev_b32 v12, 3, v42
    v_cos_f32 v9, v9
    v_lshlrev_b16 v13, 3, v42
    v_mad_i32_i24 v11, v14, s55, v38
    v_bitop3_b32 v12, v6, v13, v12 bitop3:0xca
    v_add_lshl_u32 v11, v11, s40, 17
    v_lshlrev_b16 v14, 8, v14
    v_lshrrev_b32 v13, 2, v42
    v_or_b32 v38, v12, v11
    v_bitop3_b32 v42, v5, v13, v14 bitop3:0xea
    ds_add_u32 v42, v2
    v_mul_hi_u32_u24 v14, 429497, v39
    v_lshrrev_b32 v12, 3, v43
    v_cos_f32 v10, v10
    v_lshlrev_b16 v13, 3, v43
    v_mad_i32_i24 v11, v14, s55, v39
    v_bitop3_b32 v12, v6, v13, v12 bitop3:0xca
    v_add_lshl_u32 v11, v11, s40, 17
    v_lshlrev_b16 v14, 8, v14
    v_lshrrev_b32 v13, 2, v43
    v_or_b32 v39, v12, v11
    v_bitop3_b32 v43, v5, v13, v14 bitop3:0xea
    ds_add_u32 v43, v2
    v_cvt_pk_bf16_f32 v45, v9, v10
    v_perm_b32 v12, v45, v45, s41
    v_bitop3_b32 v38, v4, v12, v38 bitop3:0xca
    v_perm_b32 v13, v45, v45, s42
    v_bitop3_b32 v39, v4, v13, v39 bitop3:0xca
    s_add_u32 s46, s33, 0x18000
    buffer_load_dwordx4 v[76:79], v0, s[8:11], s46 offen nt
    s_add_u32 s47, s33, 0x18000
    buffer_load_dwordx4 v[80:83], v0, s[12:15], s47 offen nt
    s_add_u32 s44, s34, 0xc000
    buffer_load_dwordx2 v[84:85], v1, s[16:19], s44 offen nt
    s_add_u32 s45, s34, 0xe000
    buffer_load_dwordx2 v[86:87], v1, s[16:19], s45 offen nt
    s_waitcnt vmcnt(10)
    v_lshlrev_b32 v7, 16, v46
    v_and_b32 v8, 0xffff0000, v46
    v_lshlrev_b32 v9, 16, v47
    v_and_b32 v10, 0xffff0000, v47
    v_mul_f32 v7, 0.15915494, v7
    v_mul_f32 v8, 0.15915494, v8
    v_mul_f32 v9, 0.15915494, v9
    v_mul_f32 v10, 0.15915494, v10
    v_mul_hi_u32_u24 v14, 429497, v48
    v_lshrrev_b32 v12, 3, v52
    v_cos_f32 v7, v7
    v_lshlrev_b16 v13, 3, v52
    v_mad_i32_i24 v11, v14, s55, v48
    v_bitop3_b32 v12, v6, v13, v12 bitop3:0xca
    v_add_lshl_u32 v11, v11, s40, 17
    v_lshlrev_b16 v14, 8, v14
    v_lshrrev_b32 v13, 2, v52
    v_or_b32 v48, v12, v11
    v_bitop3_b32 v52, v5, v13, v14 bitop3:0xea
    ds_add_u32 v52, v2
    v_mul_hi_u32_u24 v14, 429497, v49
    v_lshrrev_b32 v12, 3, v53
    v_cos_f32 v8, v8
    v_lshlrev_b16 v13, 3, v53
    v_mad_i32_i24 v11, v14, s55, v49
    v_bitop3_b32 v12, v6, v13, v12 bitop3:0xca
    v_add_lshl_u32 v11, v11, s40, 17
    v_lshlrev_b16 v14, 8, v14
    v_lshrrev_b32 v13, 2, v53
    v_or_b32 v49, v12, v11
    v_bitop3_b32 v53, v5, v13, v14 bitop3:0xea
    ds_add_u32 v53, v2
    v_cvt_pk_bf16_f32 v46, v7, v8
    v_perm_b32 v12, v46, v46, s41
    v_bitop3_b32 v48, v4, v12, v48 bitop3:0xca
    v_perm_b32 v13, v46, v46, s42
    v_bitop3_b32 v49, v4, v13, v49 bitop3:0xca
    v_mul_hi_u32_u24 v14, 429497, v50
    v_lshrrev_b32 v12, 3, v54
    v_cos_f32 v9, v9
    v_lshlrev_b16 v13, 3, v54
    v_mad_i32_i24 v11, v14, s55, v50
    v_bitop3_b32 v12, v6, v13, v12 bitop3:0xca
    v_add_lshl_u32 v11, v11, s40, 17
    v_lshlrev_b16 v14, 8, v14
    v_lshrrev_b32 v13, 2, v54
    v_or_b32 v50, v12, v11
    v_bitop3_b32 v54, v5, v13, v14 bitop3:0xea
    ds_add_u32 v54, v2
    v_mul_hi_u32_u24 v14, 429497, v51
    v_lshrrev_b32 v12, 3, v55
    v_cos_f32 v10, v10
    v_lshlrev_b16 v13, 3, v55
    v_mad_i32_i24 v11, v14, s55, v51
    v_bitop3_b32 v12, v6, v13, v12 bitop3:0xca
    v_add_lshl_u32 v11, v11, s40, 17
    v_lshlrev_b16 v14, 8, v14
    v_lshrrev_b32 v13, 2, v55
    v_or_b32 v51, v12, v11
    v_bitop3_b32 v55, v5, v13, v14 bitop3:0xea
    ds_add_u32 v55, v2
    v_cvt_pk_bf16_f32 v47, v9, v10
    v_perm_b32 v12, v47, v47, s41
    v_bitop3_b32 v50, v4, v12, v50 bitop3:0xca
    v_perm_b32 v13, v47, v47, s42
    v_bitop3_b32 v51, v4, v13, v51 bitop3:0xca
    s_add_u32 s46, s33, 0x1c000
    buffer_load_dwordx4 v[88:91], v0, s[8:11], s46 offen nt
    s_add_u32 s47, s33, 0x1c000
    buffer_load_dwordx4 v[92:95], v0, s[12:15], s47 offen nt
    s_waitcnt vmcnt(8)
    v_lshlrev_b32 v7, 16, v64
    v_and_b32 v8, 0xffff0000, v64
    v_lshlrev_b32 v9, 16, v65
    v_and_b32 v10, 0xffff0000, v65
    v_mul_f32 v7, 0.15915494, v7
    v_mul_f32 v8, 0.15915494, v8
    v_mul_f32 v9, 0.15915494, v9
    v_mul_f32 v10, 0.15915494, v10
    v_mul_hi_u32_u24 v14, 429497, v56
    v_lshrrev_b32 v12, 3, v60
    v_cos_f32 v7, v7
    v_lshlrev_b16 v13, 3, v60
    v_mad_i32_i24 v11, v14, s55, v56
    v_bitop3_b32 v12, v6, v13, v12 bitop3:0xca
    v_add_lshl_u32 v11, v11, s40, 17
    v_lshlrev_b16 v14, 8, v14
    v_lshrrev_b32 v13, 2, v60
    v_or_b32 v56, v12, v11
    v_bitop3_b32 v60, v5, v13, v14 bitop3:0xea
    ds_add_u32 v60, v2
    v_mul_hi_u32_u24 v14, 429497, v57
    v_lshrrev_b32 v12, 3, v61
    v_cos_f32 v8, v8
    v_lshlrev_b16 v13, 3, v61
    v_mad_i32_i24 v11, v14, s55, v57
    v_bitop3_b32 v12, v6, v13, v12 bitop3:0xca
    v_add_lshl_u32 v11, v11, s40, 17
    v_lshlrev_b16 v14, 8, v14
    v_lshrrev_b32 v13, 2, v61
    v_or_b32 v57, v12, v11
    v_bitop3_b32 v61, v5, v13, v14 bitop3:0xea
    ds_add_u32 v61, v2
    v_cvt_pk_bf16_f32 v64, v7, v8
    v_perm_b32 v12, v64, v64, s41
    v_bitop3_b32 v56, v4, v12, v56 bitop3:0xca
    v_perm_b32 v13, v64, v64, s42
    v_bitop3_b32 v57, v4, v13, v57 bitop3:0xca
    v_mul_hi_u32_u24 v14, 429497, v58
    v_lshrrev_b32 v12, 3, v62
    v_cos_f32 v9, v9
    v_lshlrev_b16 v13, 3, v62
    v_mad_i32_i24 v11, v14, s55, v58
    v_bitop3_b32 v12, v6, v13, v12 bitop3:0xca
    v_add_lshl_u32 v11, v11, s40, 17
    v_lshlrev_b16 v14, 8, v14
    v_lshrrev_b32 v13, 2, v62
    v_or_b32 v58, v12, v11
    v_bitop3_b32 v62, v5, v13, v14 bitop3:0xea
    ds_add_u32 v62, v2
    v_mul_hi_u32_u24 v14, 429497, v59
    v_lshrrev_b32 v12, 3, v63
    v_cos_f32 v10, v10
    v_lshlrev_b16 v13, 3, v63
    v_mad_i32_i24 v11, v14, s55, v59
    v_bitop3_b32 v12, v6, v13, v12 bitop3:0xca
    v_add_lshl_u32 v11, v11, s40, 17
    v_lshlrev_b16 v14, 8, v14
    v_lshrrev_b32 v13, 2, v63
    v_or_b32 v59, v12, v11
    v_bitop3_b32 v63, v5, v13, v14 bitop3:0xea
    ds_add_u32 v63, v2
    v_cvt_pk_bf16_f32 v65, v9, v10
    v_perm_b32 v12, v65, v65, s41
    v_bitop3_b32 v58, v4, v12, v58 bitop3:0xca
    v_perm_b32 v13, v65, v65, s42
    v_bitop3_b32 v59, v4, v13, v59 bitop3:0xca
    s_add_u32 s44, s33, 0x2000000
    buffer_load_dwordx4 v[96:99], v0, s[8:11], s44 offen nt
    s_add_u32 s45, s33, 0x2000000
    buffer_load_dwordx4 v[100:103], v0, s[12:15], s45 offen nt
    s_add_u32 s46, s34, 0x1000000
    buffer_load_dwordx2 v[104:105], v1, s[16:19], s46 offen nt
    s_add_u32 s47, s34, 0x1002000
    buffer_load_dwordx2 v[106:107], v1, s[16:19], s47 offen nt
    s_waitcnt vmcnt(10)
    v_lshlrev_b32 v7, 16, v66
    v_and_b32 v8, 0xffff0000, v66
    v_lshlrev_b32 v9, 16, v67
    v_and_b32 v10, 0xffff0000, v67
    v_mul_f32 v7, 0.15915494, v7
    v_mul_f32 v8, 0.15915494, v8
    v_mul_f32 v9, 0.15915494, v9
    v_mul_f32 v10, 0.15915494, v10
    v_mul_hi_u32_u24 v14, 429497, v68
    v_lshrrev_b32 v12, 3, v72
    v_cos_f32 v7, v7
    v_lshlrev_b16 v13, 3, v72
    v_mad_i32_i24 v11, v14, s55, v68
    v_bitop3_b32 v12, v6, v13, v12 bitop3:0xca
    v_add_lshl_u32 v11, v11, s40, 17
    v_lshlrev_b16 v14, 8, v14
    v_lshrrev_b32 v13, 2, v72
    v_or_b32 v68, v12, v11
    v_bitop3_b32 v72, v5, v13, v14 bitop3:0xea
    ds_add_u32 v72, v2
    v_mul_hi_u32_u24 v14, 429497, v69
    v_lshrrev_b32 v12, 3, v73
    v_cos_f32 v8, v8
    v_lshlrev_b16 v13, 3, v73
    v_mad_i32_i24 v11, v14, s55, v69
    v_bitop3_b32 v12, v6, v13, v12 bitop3:0xca
    v_add_lshl_u32 v11, v11, s40, 17
    v_lshlrev_b16 v14, 8, v14
    v_lshrrev_b32 v13, 2, v73
    v_or_b32 v69, v12, v11
    v_bitop3_b32 v73, v5, v13, v14 bitop3:0xea
    ds_add_u32 v73, v2
    v_cvt_pk_bf16_f32 v66, v7, v8
    v_perm_b32 v12, v66, v66, s41
    v_bitop3_b32 v68, v4, v12, v68 bitop3:0xca
    v_perm_b32 v13, v66, v66, s42
    v_bitop3_b32 v69, v4, v13, v69 bitop3:0xca
    v_mul_hi_u32_u24 v14, 429497, v70
    v_lshrrev_b32 v12, 3, v74
    v_cos_f32 v9, v9
    v_lshlrev_b16 v13, 3, v74
    v_mad_i32_i24 v11, v14, s55, v70
    v_bitop3_b32 v12, v6, v13, v12 bitop3:0xca
    v_add_lshl_u32 v11, v11, s40, 17
    v_lshlrev_b16 v14, 8, v14
    v_lshrrev_b32 v13, 2, v74
    v_or_b32 v70, v12, v11
    v_bitop3_b32 v74, v5, v13, v14 bitop3:0xea
    ds_add_u32 v74, v2
    v_mul_hi_u32_u24 v14, 429497, v71
    v_lshrrev_b32 v12, 3, v75
    v_cos_f32 v10, v10
    v_lshlrev_b16 v13, 3, v75
    v_mad_i32_i24 v11, v14, s55, v71
    v_bitop3_b32 v12, v6, v13, v12 bitop3:0xca
    v_add_lshl_u32 v11, v11, s40, 17
    v_lshlrev_b16 v14, 8, v14
    v_lshrrev_b32 v13, 2, v75
    v_or_b32 v71, v12, v11
    v_bitop3_b32 v75, v5, v13, v14 bitop3:0xea
    ds_add_u32 v75, v2
    v_cvt_pk_bf16_f32 v67, v9, v10
    v_perm_b32 v12, v67, v67, s41
    v_bitop3_b32 v70, v4, v12, v70 bitop3:0xca
    v_perm_b32 v13, v67, v67, s42
    v_bitop3_b32 v71, v4, v13, v71 bitop3:0xca
    s_add_u32 s44, s33, 0x2004000
    buffer_load_dwordx4 v[108:111], v0, s[8:11], s44 offen nt
    s_waitcnt vmcnt(7)
    v_lshlrev_b32 v7, 16, v84
    v_and_b32 v8, 0xffff0000, v84
    v_lshlrev_b32 v9, 16, v85
    v_and_b32 v10, 0xffff0000, v85
    v_mul_f32 v7, 0.15915494, v7
    v_mul_f32 v8, 0.15915494, v8
    v_mul_f32 v9, 0.15915494, v9
    v_mul_f32 v10, 0.15915494, v10
    v_mul_hi_u32_u24 v14, 429497, v76
    v_lshrrev_b32 v12, 3, v80
    v_cos_f32 v7, v7
    v_lshlrev_b16 v13, 3, v80
    v_mad_i32_i24 v11, v14, s55, v76
    v_bitop3_b32 v12, v6, v13, v12 bitop3:0xca
    v_add_lshl_u32 v11, v11, s40, 17
    v_lshlrev_b16 v14, 8, v14
    v_lshrrev_b32 v13, 2, v80
    v_or_b32 v76, v12, v11
    v_bitop3_b32 v80, v5, v13, v14 bitop3:0xea
    ds_add_u32 v80, v2
    v_mul_hi_u32_u24 v14, 429497, v77
    v_lshrrev_b32 v12, 3, v81
    v_cos_f32 v8, v8
    v_lshlrev_b16 v13, 3, v81
    v_mad_i32_i24 v11, v14, s55, v77
    v_bitop3_b32 v12, v6, v13, v12 bitop3:0xca
    v_add_lshl_u32 v11, v11, s40, 17
    v_lshlrev_b16 v14, 8, v14
    v_lshrrev_b32 v13, 2, v81
    v_or_b32 v77, v12, v11
    v_bitop3_b32 v81, v5, v13, v14 bitop3:0xea
    ds_add_u32 v81, v2
    v_cvt_pk_bf16_f32 v84, v7, v8
    v_perm_b32 v12, v84, v84, s41
    v_bitop3_b32 v76, v4, v12, v76 bitop3:0xca
    v_perm_b32 v13, v84, v84, s42
    v_bitop3_b32 v77, v4, v13, v77 bitop3:0xca
    v_mul_hi_u32_u24 v14, 429497, v78
    v_lshrrev_b32 v12, 3, v82
    v_cos_f32 v9, v9
    v_lshlrev_b16 v13, 3, v82
    v_mad_i32_i24 v11, v14, s55, v78
    v_bitop3_b32 v12, v6, v13, v12 bitop3:0xca
    v_add_lshl_u32 v11, v11, s40, 17
    v_lshlrev_b16 v14, 8, v14
    v_lshrrev_b32 v13, 2, v82
    v_or_b32 v78, v12, v11
    v_bitop3_b32 v82, v5, v13, v14 bitop3:0xea
    ds_add_u32 v82, v2
    v_mul_hi_u32_u24 v14, 429497, v79
    v_lshrrev_b32 v12, 3, v83
    v_cos_f32 v10, v10
    v_lshlrev_b16 v13, 3, v83
    v_mad_i32_i24 v11, v14, s55, v79
    v_bitop3_b32 v12, v6, v13, v12 bitop3:0xca
    v_add_lshl_u32 v11, v11, s40, 17
    v_lshlrev_b16 v14, 8, v14
    v_lshrrev_b32 v13, 2, v83
    v_or_b32 v79, v12, v11
    v_bitop3_b32 v83, v5, v13, v14 bitop3:0xea
    ds_add_u32 v83, v2
    v_cvt_pk_bf16_f32 v85, v9, v10
    v_perm_b32 v12, v85, v85, s41
    v_bitop3_b32 v78, v4, v12, v78 bitop3:0xca
    v_perm_b32 v13, v85, v85, s42
    v_bitop3_b32 v79, v4, v13, v79 bitop3:0xca
    s_waitcnt vmcnt(5)
    v_lshlrev_b32 v7, 16, v86
    v_and_b32 v8, 0xffff0000, v86
    v_lshlrev_b32 v9, 16, v87
    v_and_b32 v10, 0xffff0000, v87
    v_mul_f32 v7, 0.15915494, v7
    v_mul_f32 v8, 0.15915494, v8
    v_mul_f32 v9, 0.15915494, v9
    v_mul_f32 v10, 0.15915494, v10
    v_mul_hi_u32_u24 v14, 429497, v88
    v_lshrrev_b32 v12, 3, v92
    v_cos_f32 v7, v7
    v_lshlrev_b16 v13, 3, v92
    v_mad_i32_i24 v11, v14, s55, v88
    v_bitop3_b32 v12, v6, v13, v12 bitop3:0xca
    v_add_lshl_u32 v11, v11, s40, 17
    v_lshlrev_b16 v14, 8, v14
    v_lshrrev_b32 v13, 2, v92
    v_or_b32 v88, v12, v11
    v_bitop3_b32 v92, v5, v13, v14 bitop3:0xea
    ds_add_u32 v92, v2
    v_mul_hi_u32_u24 v14, 429497, v89
    v_lshrrev_b32 v12, 3, v93
    v_cos_f32 v8, v8
    v_lshlrev_b16 v13, 3, v93
    v_mad_i32_i24 v11, v14, s55, v89
    v_bitop3_b32 v12, v6, v13, v12 bitop3:0xca
    v_add_lshl_u32 v11, v11, s40, 17
    v_lshlrev_b16 v14, 8, v14
    v_lshrrev_b32 v13, 2, v93
    v_or_b32 v89, v12, v11
    v_bitop3_b32 v93, v5, v13, v14 bitop3:0xea
    ds_add_u32 v93, v2
    v_cvt_pk_bf16_f32 v86, v7, v8
    v_perm_b32 v12, v86, v86, s41
    v_bitop3_b32 v88, v4, v12, v88 bitop3:0xca
    v_perm_b32 v13, v86, v86, s42
    v_bitop3_b32 v89, v4, v13, v89 bitop3:0xca
    v_mul_hi_u32_u24 v14, 429497, v90
    v_lshrrev_b32 v12, 3, v94
    v_cos_f32 v9, v9
    v_lshlrev_b16 v13, 3, v94
    v_mad_i32_i24 v11, v14, s55, v90
    v_bitop3_b32 v12, v6, v13, v12 bitop3:0xca
    v_add_lshl_u32 v11, v11, s40, 17
    v_lshlrev_b16 v14, 8, v14
    v_lshrrev_b32 v13, 2, v94
    v_or_b32 v90, v12, v11
    v_bitop3_b32 v94, v5, v13, v14 bitop3:0xea
    ds_add_u32 v94, v2
    v_mul_hi_u32_u24 v14, 429497, v91
    v_lshrrev_b32 v12, 3, v95
    v_cos_f32 v10, v10
    v_lshlrev_b16 v13, 3, v95
    v_mad_i32_i24 v11, v14, s55, v91
    v_bitop3_b32 v12, v6, v13, v12 bitop3:0xca
    v_add_lshl_u32 v11, v11, s40, 17
    v_lshlrev_b16 v14, 8, v14
    v_lshrrev_b32 v13, 2, v95
    v_or_b32 v91, v12, v11
    v_bitop3_b32 v95, v5, v13, v14 bitop3:0xea
    ds_add_u32 v95, v2
    v_cvt_pk_bf16_f32 v87, v9, v10
    v_perm_b32 v12, v87, v87, s41
    v_bitop3_b32 v90, v4, v12, v90 bitop3:0xca
    v_perm_b32 v13, v87, v87, s42
    v_bitop3_b32 v91, v4, v13, v91 bitop3:0xca
    v_lshrrev_b32 v8, 2, v0
    v_and_b32 v7, 0x3c00, v0
    v_bitop3_b32 v7, v5, v8, v7 bitop3:0xea
    s_waitcnt lgkmcnt(0)
    s_barrier
    ds_read2st64_b32 v[8:9], v7 offset0:0 offset1:1
    ds_read2st64_b32 v[10:11], v7 offset0:2 offset1:3
    s_add_u32 s45, s33, 0x2004000
    buffer_load_dwordx4 v[112:115], v0, s[12:15], s45 offen nt
    s_waitcnt lgkmcnt(0)
    v_lshl_or_b32 v12, v9, 16, v8
    v_lshl_or_b32 v13, v11, 16, v10
    v_mov_b32 v14, v12
    v_mov_b32 v15, v13
    s_nop 0
    v_add_u32_dpp v14, v14, v14 row_shr:1 row_mask:0xf bank_mask:0xf bound_ctrl:1
    v_add_u32_dpp v15, v15, v15 row_shr:1 row_mask:0xf bank_mask:0xf bound_ctrl:1
    s_nop 0
    v_add_u32_dpp v14, v14, v14 row_shr:2 row_mask:0xf bank_mask:0xf bound_ctrl:1
    v_add_u32_dpp v15, v15, v15 row_shr:2 row_mask:0xf bank_mask:0xf bound_ctrl:1
    s_nop 0
    v_add_u32_dpp v14, v14, v14 row_shr:4 row_mask:0xf bank_mask:0xf bound_ctrl:1
    v_add_u32_dpp v15, v15, v15 row_shr:4 row_mask:0xf bank_mask:0xf bound_ctrl:1
    s_nop 0
    v_add_u32_dpp v14, v14, v14 row_shr:8 row_mask:0xf bank_mask:0xf bound_ctrl:1
    v_add_u32_dpp v15, v15, v15 row_shr:8 row_mask:0xf bank_mask:0xf bound_ctrl:1
    s_nop 0
    v_add_u32_dpp v14, v14, v14 row_bcast:15 row_mask:0xa bank_mask:0xf
    v_add_u32_dpp v15, v15, v15 row_bcast:15 row_mask:0xa bank_mask:0xf
    s_nop 0
    v_add_u32_dpp v14, v14, v14 row_bcast:31 row_mask:0xc bank_mask:0xf
    v_add_u32_dpp v15, v15, v15 row_bcast:31 row_mask:0xc bank_mask:0xf
    v_readlane_b32 s48, v14, 63
    v_readlane_b32 s49, v15, 63
    s_lshl_b32 s54, s32, 2
    v_mov_b32 v8, s54
    s_and_b32 s50, s48, 0xffff
    s_lshr_b32 s51, s48, 16
    s_and_b32 s52, s49, 0xffff
    s_lshr_b32 s53, s49, 16
    s_add_u32 s51, s51, s50
    s_add_u32 s52, s52, s51
    s_add_u32 s53, s53, s52
    v_mov_b32 v9, s53
    s_mov_b64 exec, 1
    ds_write_b32 v8, v9 offset:16384
    s_mov_b64 exec, -1
    v_and_b32 v8, 60, v7
    s_waitcnt lgkmcnt(0)
    s_barrier
    ds_read_b32 v9, v8 offset:16384
    s_waitcnt lgkmcnt(0)
    v_add_u32_dpp v9, v9, v9 row_shr:1 row_mask:0xf bank_mask:0xf bound_ctrl:1
    s_nop 1
    v_add_u32_dpp v9, v9, v9 row_shr:2 row_mask:0xf bank_mask:0xf bound_ctrl:1
    s_nop 1
    v_add_u32_dpp v9, v9, v9 row_shr:4 row_mask:0xf bank_mask:0xf bound_ctrl:1
    s_nop 1
    v_add_u32_dpp v9, v9, v9 row_shr:8 row_mask:0xf bank_mask:0xf bound_ctrl:1
    s_nop 0
    v_readlane_b32 s54, v9, s32
    s_sub_u32 s54, s54, s53
    s_add_u32 s50, s50, s54
    s_add_u32 s51, s51, s54
    s_add_u32 s52, s52, s54
    s_pack_ll_b32_b16 s48, s54, s50
    s_pack_ll_b32_b16 s49, s51, s52
    v_add_u32 v14, s48, v14
    v_add_u32 v15, s49, v15
    v_sub_u32 v12, v14, v12
    v_sub_u32 v13, v15, v13
    v_and_b32 v8, 0xffff, v12
    v_lshrrev_b32 v9, 16, v12
    v_and_b32 v10, 0xffff, v13
    v_lshrrev_b32 v11, 16, v13
    ds_write2st64_b32 v7, v8, v9 offset0:0 offset1:1
    ds_write2st64_b32 v7, v10, v11 offset0:2 offset1:3
    s_waitcnt lgkmcnt(0)
    s_barrier
    ds_add_rtn_u32 v20, v20, v2
    ds_add_rtn_u32 v21, v21, v2
    ds_add_rtn_u32 v22, v22, v2
    ds_add_rtn_u32 v23, v23, v2
    s_add_u32 s46, s36, 0x0
    v_and_b32 v11, 0x3f0, v0
    v_add_u32 v11, v11, v11
    buffer_store_dwordx2 v[12:13], v11, s[24:27], s46 offen
    s_bitset0_b64 exec, 63
    s_not_b64 exec, exec
    buffer_store_dwordx2 v[14:15], v11, s[24:27], s46 offen offset:32
    s_mov_b64 exec, -1
    ds_add_rtn_u32 v32, v32, v2
    ds_add_rtn_u32 v33, v33, v2
    ds_add_rtn_u32 v34, v34, v2
    ds_add_rtn_u32 v35, v35, v2
    ds_add_rtn_u32 v40, v40, v2
    ds_add_rtn_u32 v41, v41, v2
    ds_add_rtn_u32 v42, v42, v2
    ds_add_rtn_u32 v43, v43, v2
    s_add_u32 s47, s33, 0x2008000
    buffer_load_dwordx4 v[116:119], v0, s[8:11], s47 offen nt
    ds_add_rtn_u32 v52, v52, v2
    ds_add_rtn_u32 v53, v53, v2
    ds_add_rtn_u32 v54, v54, v2
    ds_add_rtn_u32 v55, v55, v2
    ds_add_rtn_u32 v60, v60, v2
    ds_add_rtn_u32 v61, v61, v2
    ds_add_rtn_u32 v62, v62, v2
    ds_add_rtn_u32 v63, v63, v2
    s_add_u32 s44, s33, 0x2008000
    buffer_load_dwordx4 v[120:123], v0, s[12:15], s44 offen nt
    ds_add_rtn_u32 v72, v72, v2
    ds_add_rtn_u32 v73, v73, v2
    ds_add_rtn_u32 v74, v74, v2
    ds_add_rtn_u32 v75, v75, v2
    ds_add_rtn_u32 v80, v80, v2
    ds_add_rtn_u32 v81, v81, v2
    ds_add_rtn_u32 v82, v82, v2
    ds_add_rtn_u32 v83, v83, v2
    s_add_u32 s45, s34, 0x1004000
    buffer_load_dwordx2 v[124:125], v1, s[16:19], s45 offen nt
    s_add_u32 s46, s34, 0x1006000
    buffer_load_dwordx2 v[126:127], v1, s[16:19], s46 offen nt
    ds_add_rtn_u32 v92, v92, v2
    ds_add_rtn_u32 v93, v93, v2
    ds_add_rtn_u32 v94, v94, v2
    ds_add_rtn_u32 v95, v95, v2
    s_waitcnt lgkmcnt(0)
    s_barrier
    v_and_b32 v7, -4, v20
    v_lshl_add_u32 v8, v20, 2, v7
    ds_write_b32 v8, v16
    v_lshl_add_u32 v7, v7, 2, v20
    ds_write_b8 v7, v24 offset:16
    v_and_b32 v9, -4, v21
    v_lshl_add_u32 v10, v21, 2, v9
    ds_write_b32 v10, v17
    v_lshl_add_u32 v9, v9, 2, v21
    ds_write_b8_d16_hi v9, v24 offset:16
    v_and_b32 v7, -4, v22
    v_lshl_add_u32 v8, v22, 2, v7
    ds_write_b32 v8, v18
    v_lshl_add_u32 v7, v7, 2, v22
    ds_write_b8 v7, v25 offset:16
    v_and_b32 v9, -4, v23
    v_lshl_add_u32 v10, v23, 2, v9
    ds_write_b32 v10, v19
    v_lshl_add_u32 v9, v9, 2, v23
    ds_write_b8_d16_hi v9, v25 offset:16
    s_add_u32 s47, s33, 0x200c000
    buffer_load_dwordx4 v[16:19], v0, s[8:11], s47 offen nt
    s_add_u32 s44, s33, 0x200c000
    buffer_load_dwordx4 v[20:23], v0, s[12:15], s44 offen nt
    v_and_b32 v7, -4, v32
    v_lshl_add_u32 v8, v32, 2, v7
    ds_write_b32 v8, v28
    v_lshl_add_u32 v7, v7, 2, v32
    ds_write_b8 v7, v26 offset:16
    v_and_b32 v9, -4, v33
    v_lshl_add_u32 v10, v33, 2, v9
    ds_write_b32 v10, v29
    v_lshl_add_u32 v9, v9, 2, v33
    ds_write_b8_d16_hi v9, v26 offset:16
    v_and_b32 v7, -4, v34
    v_lshl_add_u32 v8, v34, 2, v7
    ds_write_b32 v8, v30
    v_lshl_add_u32 v7, v7, 2, v34
    ds_write_b8 v7, v27 offset:16
    v_and_b32 v9, -4, v35
    v_lshl_add_u32 v10, v35, 2, v9
    ds_write_b32 v10, v31
    v_lshl_add_u32 v9, v9, 2, v35
    ds_write_b8_d16_hi v9, v27 offset:16
    s_add_u32 s45, s33, 0x2010000
    buffer_load_dwordx4 v[28:31], v0, s[8:11], s45 offen nt
    v_and_b32 v7, -4, v40
    v_lshl_add_u32 v8, v40, 2, v7
    ds_write_b32 v8, v36
    v_lshl_add_u32 v7, v7, 2, v40
    ds_write_b8 v7, v44 offset:16
    v_and_b32 v9, -4, v41
    v_lshl_add_u32 v10, v41, 2, v9
    ds_write_b32 v10, v37
    v_lshl_add_u32 v9, v9, 2, v41
    ds_write_b8_d16_hi v9, v44 offset:16
    v_and_b32 v7, -4, v42
    v_lshl_add_u32 v8, v42, 2, v7
    ds_write_b32 v8, v38
    v_lshl_add_u32 v7, v7, 2, v42
    ds_write_b8 v7, v45 offset:16
    v_and_b32 v9, -4, v43
    v_lshl_add_u32 v10, v43, 2, v9
    ds_write_b32 v10, v39
    v_lshl_add_u32 v9, v9, 2, v43
    ds_write_b8_d16_hi v9, v45 offset:16
    s_add_u32 s46, s33, 0x2010000
    buffer_load_dwordx4 v[32:35], v0, s[12:15], s46 offen nt
    v_and_b32 v7, -4, v52
    v_lshl_add_u32 v8, v52, 2, v7
    ds_write_b32 v8, v48
    v_lshl_add_u32 v7, v7, 2, v52
    ds_write_b8 v7, v46 offset:16
    v_and_b32 v9, -4, v53
    v_lshl_add_u32 v10, v53, 2, v9
    ds_write_b32 v10, v49
    v_lshl_add_u32 v9, v9, 2, v53
    ds_write_b8_d16_hi v9, v46 offset:16
    v_and_b32 v7, -4, v54
    v_lshl_add_u32 v8, v54, 2, v7
    ds_write_b32 v8, v50
    v_lshl_add_u32 v7, v7, 2, v54
    ds_write_b8 v7, v47 offset:16
    v_and_b32 v9, -4, v55
    v_lshl_add_u32 v10, v55, 2, v9
    ds_write_b32 v10, v51
    v_lshl_add_u32 v9, v9, 2, v55
    ds_write_b8_d16_hi v9, v47 offset:16
    s_add_u32 s47, s34, 0x1008000
    buffer_load_dwordx2 v[24:25], v1, s[16:19], s47 offen nt
    s_add_u32 s44, s34, 0x100a000
    buffer_load_dwordx2 v[26:27], v1, s[16:19], s44 offen nt
    v_and_b32 v7, -4, v60
    v_lshl_add_u32 v8, v60, 2, v7
    ds_write_b32 v8, v56
    v_lshl_add_u32 v7, v7, 2, v60
    ds_write_b8 v7, v64 offset:16
    v_and_b32 v9, -4, v61
    v_lshl_add_u32 v10, v61, 2, v9
    ds_write_b32 v10, v57
    v_lshl_add_u32 v9, v9, 2, v61
    ds_write_b8_d16_hi v9, v64 offset:16
    v_and_b32 v7, -4, v62
    v_lshl_add_u32 v8, v62, 2, v7
    ds_write_b32 v8, v58
    v_lshl_add_u32 v7, v7, 2, v62
    ds_write_b8 v7, v65 offset:16
    v_and_b32 v9, -4, v63
    v_lshl_add_u32 v10, v63, 2, v9
    ds_write_b32 v10, v59
    v_lshl_add_u32 v9, v9, 2, v63
    ds_write_b8_d16_hi v9, v65 offset:16
    s_add_u32 s45, s33, 0x2014000
    buffer_load_dwordx4 v[36:39], v0, s[8:11], s45 offen nt
    s_add_u32 s46, s33, 0x2014000
    buffer_load_dwordx4 v[40:43], v0, s[12:15], s46 offen nt
    v_and_b32 v7, -4, v72
    v_lshl_add_u32 v8, v72, 2, v7
    ds_write_b32 v8, v68
    v_lshl_add_u32 v7, v7, 2, v72
    ds_write_b8 v7, v66 offset:16
    v_and_b32 v9, -4, v73
    v_lshl_add_u32 v10, v73, 2, v9
    ds_write_b32 v10, v69
    v_lshl_add_u32 v9, v9, 2, v73
    ds_write_b8_d16_hi v9, v66 offset:16
    v_and_b32 v7, -4, v74
    v_lshl_add_u32 v8, v74, 2, v7
    ds_write_b32 v8, v70
    v_lshl_add_u32 v7, v7, 2, v74
    ds_write_b8 v7, v67 offset:16
    v_and_b32 v9, -4, v75
    v_lshl_add_u32 v10, v75, 2, v9
    ds_write_b32 v10, v71
    v_lshl_add_u32 v9, v9, 2, v75
    ds_write_b8_d16_hi v9, v67 offset:16
    s_add_u32 s47, s33, 0x2018000
    buffer_load_dwordx4 v[48:51], v0, s[8:11], s47 offen nt
    v_and_b32 v7, -4, v80
    v_lshl_add_u32 v8, v80, 2, v7
    ds_write_b32 v8, v76
    v_lshl_add_u32 v7, v7, 2, v80
    ds_write_b8 v7, v84 offset:16
    v_and_b32 v9, -4, v81
    v_lshl_add_u32 v10, v81, 2, v9
    ds_write_b32 v10, v77
    v_lshl_add_u32 v9, v9, 2, v81
    ds_write_b8_d16_hi v9, v84 offset:16
    v_and_b32 v7, -4, v82
    v_lshl_add_u32 v8, v82, 2, v7
    ds_write_b32 v8, v78
    v_lshl_add_u32 v7, v7, 2, v82
    ds_write_b8 v7, v85 offset:16
    v_and_b32 v9, -4, v83
    v_lshl_add_u32 v10, v83, 2, v9
    ds_write_b32 v10, v79
    v_lshl_add_u32 v9, v9, 2, v83
    ds_write_b8_d16_hi v9, v85 offset:16
    s_add_u32 s44, s33, 0x2018000
    buffer_load_dwordx4 v[52:55], v0, s[12:15], s44 offen nt
    v_and_b32 v7, -4, v92
    v_lshl_add_u32 v8, v92, 2, v7
    ds_write_b32 v8, v88
    v_lshl_add_u32 v7, v7, 2, v92
    ds_write_b8 v7, v86 offset:16
    v_and_b32 v9, -4, v93
    v_lshl_add_u32 v10, v93, 2, v9
    ds_write_b32 v10, v89
    v_lshl_add_u32 v9, v9, 2, v93
    ds_write_b8_d16_hi v9, v86 offset:16
    v_and_b32 v7, -4, v94
    v_lshl_add_u32 v8, v94, 2, v7
    ds_write_b32 v8, v90
    v_lshl_add_u32 v7, v7, 2, v94
    ds_write_b8 v7, v87 offset:16
    v_and_b32 v9, -4, v95
    v_lshl_add_u32 v10, v95, 2, v9
    ds_write_b32 v10, v91
    v_lshl_add_u32 v9, v9, 2, v95
    ds_write_b8_d16_hi v9, v87 offset:16
    s_add_u32 s45, s34, 0x100c000
    buffer_load_dwordx2 v[44:45], v1, s[16:19], s45 offen nt
    s_add_u32 s46, s34, 0x100e000
    buffer_load_dwordx2 v[46:47], v1, s[16:19], s46 offen nt
    v_add_u32 v7, 0x10000, v0
    v_add_u32 v12, 0x20000, v0
    v_mov_b32 v8, 0
    v_mov_b32 v9, 0
    v_mov_b32 v10, 0
    v_mov_b32 v11, 0
    s_waitcnt lgkmcnt(0)
    s_barrier
    ds_read_b128 v[56:59], v0 offset:0
    ds_write_b128 v0, v[8:11]
    ds_read_b128 v[60:63], v0 offset:16384
    ds_read_b128 v[68:71], v0 offset:32768
    ds_read_b128 v[72:75], v0 offset:49152
    ds_read_b128 v[64:67], v7 offset:0
    ds_read_b128 v[76:79], v7 offset:16384
    ds_read_b128 v[80:83], v7 offset:32768
    ds_read_b128 v[88:91], v7 offset:49152
    ds_read_b128 v[92:95], v12 offset:0
    ds_read_b128 v[84:87], v12 offset:16384
    s_waitcnt lgkmcnt(0)
    s_barrier
    s_add_u32 s47, s35, 0x0
    buffer_store_dwordx4 v[56:59], v0, s[20:23], s47 offen sc1
    s_add_u32 s44, s33, 0x201c000
    s_nop 0
    buffer_load_dwordx4 v[56:59], v0, s[8:11], s44 offen nt
    s_add_u32 s45, s35, 0x4000
    buffer_store_dwordx4 v[60:63], v0, s[20:23], s45 offen sc1
    s_add_u32 s46, s33, 0x201c000
    s_nop 0
    buffer_load_dwordx4 v[60:63], v0, s[12:15], s46 offen nt
    s_waitcnt vmcnt(24)
    v_lshlrev_b32 v7, 16, v104
    v_and_b32 v8, 0xffff0000, v104
    v_lshlrev_b32 v9, 16, v105
    v_and_b32 v10, 0xffff0000, v105
    v_mul_f32 v7, 0.15915494, v7
    v_mul_f32 v8, 0.15915494, v8
    v_mul_f32 v9, 0.15915494, v9
    v_mul_f32 v10, 0.15915494, v10
    v_mul_hi_u32_u24 v14, 429497, v96
    v_lshrrev_b32 v12, 3, v100
    v_cos_f32 v7, v7
    v_lshlrev_b16 v13, 3, v100
    v_mad_i32_i24 v11, v14, s55, v96
    v_bitop3_b32 v12, v6, v13, v12 bitop3:0xca
    v_add_lshl_u32 v11, v11, s40, 17
    v_lshlrev_b16 v14, 8, v14
    v_lshrrev_b32 v13, 2, v100
    v_or_b32 v96, v12, v11
    v_bitop3_b32 v100, v5, v13, v14 bitop3:0xea
    ds_add_u32 v100, v2
    v_mul_hi_u32_u24 v14, 429497, v97
    v_lshrrev_b32 v12, 3, v101
    v_cos_f32 v8, v8
    v_lshlrev_b16 v13, 3, v101
    v_mad_i32_i24 v11, v14, s55, v97
    v_bitop3_b32 v12, v6, v13, v12 bitop3:0xca
    v_add_lshl_u32 v11, v11, s40, 17
    v_lshlrev_b16 v14, 8, v14
    v_lshrrev_b32 v13, 2, v101
    v_or_b32 v97, v12, v11
    v_bitop3_b32 v101, v5, v13, v14 bitop3:0xea
    ds_add_u32 v101, v2
    v_cvt_pk_bf16_f32 v104, v7, v8
    v_perm_b32 v12, v104, v104, s41
    v_bitop3_b32 v96, v4, v12, v96 bitop3:0xca
    v_perm_b32 v13, v104, v104, s42
    v_bitop3_b32 v97, v4, v13, v97 bitop3:0xca
    v_mul_hi_u32_u24 v14, 429497, v98
    v_lshrrev_b32 v12, 3, v102
    v_cos_f32 v9, v9
    v_lshlrev_b16 v13, 3, v102
    v_mad_i32_i24 v11, v14, s55, v98
    v_bitop3_b32 v12, v6, v13, v12 bitop3:0xca
    v_add_lshl_u32 v11, v11, s40, 17
    v_lshlrev_b16 v14, 8, v14
    v_lshrrev_b32 v13, 2, v102
    v_or_b32 v98, v12, v11
    v_bitop3_b32 v102, v5, v13, v14 bitop3:0xea
    ds_add_u32 v102, v2
    v_mul_hi_u32_u24 v14, 429497, v99
    v_lshrrev_b32 v12, 3, v103
    v_cos_f32 v10, v10
    v_lshlrev_b16 v13, 3, v103
    v_mad_i32_i24 v11, v14, s55, v99
    v_bitop3_b32 v12, v6, v13, v12 bitop3:0xca
    v_add_lshl_u32 v11, v11, s40, 17
    v_lshlrev_b16 v14, 8, v14
    v_lshrrev_b32 v13, 2, v103
    v_or_b32 v99, v12, v11
    v_bitop3_b32 v103, v5, v13, v14 bitop3:0xea
    ds_add_u32 v103, v2
    v_cvt_pk_bf16_f32 v105, v9, v10
    v_perm_b32 v12, v105, v105, s41
    v_bitop3_b32 v98, v4, v12, v98 bitop3:0xca
    v_perm_b32 v13, v105, v105, s42
    v_bitop3_b32 v99, v4, v13, v99 bitop3:0xca
    s_add_u32 s47, s35, 0x8000
    buffer_store_dwordx4 v[68:71], v0, s[20:23], s47 offen sc1
    s_add_u32 s44, s33, 0x4000000
    s_nop 0
    buffer_load_dwordx4 v[68:71], v0, s[8:11], s44 offen nt
    s_waitcnt vmcnt(24)
    v_lshlrev_b32 v7, 16, v106
    v_and_b32 v8, 0xffff0000, v106
    v_lshlrev_b32 v9, 16, v107
    v_and_b32 v10, 0xffff0000, v107
    v_mul_f32 v7, 0.15915494, v7
    v_mul_f32 v8, 0.15915494, v8
    v_mul_f32 v9, 0.15915494, v9
    v_mul_f32 v10, 0.15915494, v10
    v_mul_hi_u32_u24 v14, 429497, v108
    v_lshrrev_b32 v12, 3, v112
    v_cos_f32 v7, v7
    v_lshlrev_b16 v13, 3, v112
    v_mad_i32_i24 v11, v14, s55, v108
    v_bitop3_b32 v12, v6, v13, v12 bitop3:0xca
    v_add_lshl_u32 v11, v11, s40, 17
    v_lshlrev_b16 v14, 8, v14
    v_lshrrev_b32 v13, 2, v112
    v_or_b32 v108, v12, v11
    v_bitop3_b32 v112, v5, v13, v14 bitop3:0xea
    ds_add_u32 v112, v2
    v_mul_hi_u32_u24 v14, 429497, v109
    v_lshrrev_b32 v12, 3, v113
    v_cos_f32 v8, v8
    v_lshlrev_b16 v13, 3, v113
    v_mad_i32_i24 v11, v14, s55, v109
    v_bitop3_b32 v12, v6, v13, v12 bitop3:0xca
    v_add_lshl_u32 v11, v11, s40, 17
    v_lshlrev_b16 v14, 8, v14
    v_lshrrev_b32 v13, 2, v113
    v_or_b32 v109, v12, v11
    v_bitop3_b32 v113, v5, v13, v14 bitop3:0xea
    ds_add_u32 v113, v2
    v_cvt_pk_bf16_f32 v106, v7, v8
    v_perm_b32 v12, v106, v106, s41
    v_bitop3_b32 v108, v4, v12, v108 bitop3:0xca
    v_perm_b32 v13, v106, v106, s42
    v_bitop3_b32 v109, v4, v13, v109 bitop3:0xca
    v_mul_hi_u32_u24 v14, 429497, v110
    v_lshrrev_b32 v12, 3, v114
    v_cos_f32 v9, v9
    v_lshlrev_b16 v13, 3, v114
    v_mad_i32_i24 v11, v14, s55, v110
    v_bitop3_b32 v12, v6, v13, v12 bitop3:0xca
    v_add_lshl_u32 v11, v11, s40, 17
    v_lshlrev_b16 v14, 8, v14
    v_lshrrev_b32 v13, 2, v114
    v_or_b32 v110, v12, v11
    v_bitop3_b32 v114, v5, v13, v14 bitop3:0xea
    ds_add_u32 v114, v2
    v_mul_hi_u32_u24 v14, 429497, v111
    v_lshrrev_b32 v12, 3, v115
    v_cos_f32 v10, v10
    v_lshlrev_b16 v13, 3, v115
    v_mad_i32_i24 v11, v14, s55, v111
    v_bitop3_b32 v12, v6, v13, v12 bitop3:0xca
    v_add_lshl_u32 v11, v11, s40, 17
    v_lshlrev_b16 v14, 8, v14
    v_lshrrev_b32 v13, 2, v115
    v_or_b32 v111, v12, v11
    v_bitop3_b32 v115, v5, v13, v14 bitop3:0xea
    ds_add_u32 v115, v2
    v_cvt_pk_bf16_f32 v107, v9, v10
    v_perm_b32 v12, v107, v107, s41
    v_bitop3_b32 v110, v4, v12, v110 bitop3:0xca
    v_perm_b32 v13, v107, v107, s42
    v_bitop3_b32 v111, v4, v13, v111 bitop3:0xca
    s_waitcnt vmcnt(18)
    v_lshlrev_b32 v7, 16, v124
    v_and_b32 v8, 0xffff0000, v124
    v_lshlrev_b32 v9, 16, v125
    v_and_b32 v10, 0xffff0000, v125
    v_mul_f32 v7, 0.15915494, v7
    v_mul_f32 v8, 0.15915494, v8
    v_mul_f32 v9, 0.15915494, v9
    v_mul_f32 v10, 0.15915494, v10
    v_mul_hi_u32_u24 v14, 429497, v116
    v_lshrrev_b32 v12, 3, v120
    v_cos_f32 v7, v7
    v_lshlrev_b16 v13, 3, v120
    v_mad_i32_i24 v11, v14, s55, v116
    v_bitop3_b32 v12, v6, v13, v12 bitop3:0xca
    v_add_lshl_u32 v11, v11, s40, 17
    v_lshlrev_b16 v14, 8, v14
    v_lshrrev_b32 v13, 2, v120
    v_or_b32 v116, v12, v11
    v_bitop3_b32 v120, v5, v13, v14 bitop3:0xea
    ds_add_u32 v120, v2
    v_mul_hi_u32_u24 v14, 429497, v117
    v_lshrrev_b32 v12, 3, v121
    v_cos_f32 v8, v8
    v_lshlrev_b16 v13, 3, v121
    v_mad_i32_i24 v11, v14, s55, v117
    v_bitop3_b32 v12, v6, v13, v12 bitop3:0xca
    v_add_lshl_u32 v11, v11, s40, 17
    v_lshlrev_b16 v14, 8, v14
    v_lshrrev_b32 v13, 2, v121
    v_or_b32 v117, v12, v11
    v_bitop3_b32 v121, v5, v13, v14 bitop3:0xea
    ds_add_u32 v121, v2
    v_cvt_pk_bf16_f32 v124, v7, v8
    v_perm_b32 v12, v124, v124, s41
    v_bitop3_b32 v116, v4, v12, v116 bitop3:0xca
    v_perm_b32 v13, v124, v124, s42
    v_bitop3_b32 v117, v4, v13, v117 bitop3:0xca
    v_mul_hi_u32_u24 v14, 429497, v118
    v_lshrrev_b32 v12, 3, v122
    v_cos_f32 v9, v9
    v_lshlrev_b16 v13, 3, v122
    v_mad_i32_i24 v11, v14, s55, v118
    v_bitop3_b32 v12, v6, v13, v12 bitop3:0xca
    v_add_lshl_u32 v11, v11, s40, 17
    v_lshlrev_b16 v14, 8, v14
    v_lshrrev_b32 v13, 2, v122
    v_or_b32 v118, v12, v11
    v_bitop3_b32 v122, v5, v13, v14 bitop3:0xea
    ds_add_u32 v122, v2
    v_mul_hi_u32_u24 v14, 429497, v119
    v_lshrrev_b32 v12, 3, v123
    v_cos_f32 v10, v10
    v_lshlrev_b16 v13, 3, v123
    v_mad_i32_i24 v11, v14, s55, v119
    v_bitop3_b32 v12, v6, v13, v12 bitop3:0xca
    v_add_lshl_u32 v11, v11, s40, 17
    v_lshlrev_b16 v14, 8, v14
    v_lshrrev_b32 v13, 2, v123
    v_or_b32 v119, v12, v11
    v_bitop3_b32 v123, v5, v13, v14 bitop3:0xea
    ds_add_u32 v123, v2
    v_cvt_pk_bf16_f32 v125, v9, v10
    v_perm_b32 v12, v125, v125, s41
    v_bitop3_b32 v118, v4, v12, v118 bitop3:0xca
    v_perm_b32 v13, v125, v125, s42
    v_bitop3_b32 v119, v4, v13, v119 bitop3:0xca
    s_add_u32 s45, s35, 0xc000
    buffer_store_dwordx4 v[72:75], v0, s[20:23], s45 offen sc1
    s_add_u32 s46, s33, 0x4000000
    s_nop 0
    buffer_load_dwordx4 v[72:75], v0, s[12:15], s46 offen nt
    s_waitcnt vmcnt(18)
    v_lshlrev_b32 v7, 16, v126
    v_and_b32 v8, 0xffff0000, v126
    v_lshlrev_b32 v9, 16, v127
    v_and_b32 v10, 0xffff0000, v127
    v_mul_f32 v7, 0.15915494, v7
    v_mul_f32 v8, 0.15915494, v8
    v_mul_f32 v9, 0.15915494, v9
    v_mul_f32 v10, 0.15915494, v10
    v_mul_hi_u32_u24 v14, 429497, v16
    v_lshrrev_b32 v12, 3, v20
    v_cos_f32 v7, v7
    v_lshlrev_b16 v13, 3, v20
    v_mad_i32_i24 v11, v14, s55, v16
    v_bitop3_b32 v12, v6, v13, v12 bitop3:0xca
    v_add_lshl_u32 v11, v11, s40, 17
    v_lshlrev_b16 v14, 8, v14
    v_lshrrev_b32 v13, 2, v20
    v_or_b32 v16, v12, v11
    v_bitop3_b32 v20, v5, v13, v14 bitop3:0xea
    ds_add_u32 v20, v2
    v_mul_hi_u32_u24 v14, 429497, v17
    v_lshrrev_b32 v12, 3, v21
    v_cos_f32 v8, v8
    v_lshlrev_b16 v13, 3, v21
    v_mad_i32_i24 v11, v14, s55, v17
    v_bitop3_b32 v12, v6, v13, v12 bitop3:0xca
    v_add_lshl_u32 v11, v11, s40, 17
    v_lshlrev_b16 v14, 8, v14
    v_lshrrev_b32 v13, 2, v21
    v_or_b32 v17, v12, v11
    v_bitop3_b32 v21, v5, v13, v14 bitop3:0xea
    ds_add_u32 v21, v2
    v_cvt_pk_bf16_f32 v126, v7, v8
    v_perm_b32 v12, v126, v126, s41
    v_bitop3_b32 v16, v4, v12, v16 bitop3:0xca
    v_perm_b32 v13, v126, v126, s42
    v_bitop3_b32 v17, v4, v13, v17 bitop3:0xca
    v_mul_hi_u32_u24 v14, 429497, v18
    v_lshrrev_b32 v12, 3, v22
    v_cos_f32 v9, v9
    v_lshlrev_b16 v13, 3, v22
    v_mad_i32_i24 v11, v14, s55, v18
    v_bitop3_b32 v12, v6, v13, v12 bitop3:0xca
    v_add_lshl_u32 v11, v11, s40, 17
    v_lshlrev_b16 v14, 8, v14
    v_lshrrev_b32 v13, 2, v22
    v_or_b32 v18, v12, v11
    v_bitop3_b32 v22, v5, v13, v14 bitop3:0xea
    ds_add_u32 v22, v2
    v_mul_hi_u32_u24 v14, 429497, v19
    v_lshrrev_b32 v12, 3, v23
    v_cos_f32 v10, v10
    v_lshlrev_b16 v13, 3, v23
    v_mad_i32_i24 v11, v14, s55, v19
    v_bitop3_b32 v12, v6, v13, v12 bitop3:0xca
    v_add_lshl_u32 v11, v11, s40, 17
    v_lshlrev_b16 v14, 8, v14
    v_lshrrev_b32 v13, 2, v23
    v_or_b32 v19, v12, v11
    v_bitop3_b32 v23, v5, v13, v14 bitop3:0xea
    ds_add_u32 v23, v2
    v_cvt_pk_bf16_f32 v127, v9, v10
    v_perm_b32 v12, v127, v127, s41
    v_bitop3_b32 v18, v4, v12, v18 bitop3:0xca
    v_perm_b32 v13, v127, v127, s42
    v_bitop3_b32 v19, v4, v13, v19 bitop3:0xca
    s_waitcnt vmcnt(14)
    v_lshlrev_b32 v7, 16, v24
    v_and_b32 v8, 0xffff0000, v24
    v_lshlrev_b32 v9, 16, v25
    v_and_b32 v10, 0xffff0000, v25
    v_mul_f32 v7, 0.15915494, v7
    v_mul_f32 v8, 0.15915494, v8
    v_mul_f32 v9, 0.15915494, v9
    v_mul_f32 v10, 0.15915494, v10
    v_mul_hi_u32_u24 v14, 429497, v28
    v_lshrrev_b32 v12, 3, v32
    v_cos_f32 v7, v7
    v_lshlrev_b16 v13, 3, v32
    v_mad_i32_i24 v11, v14, s55, v28
    v_bitop3_b32 v12, v6, v13, v12 bitop3:0xca
    v_add_lshl_u32 v11, v11, s40, 17
    v_lshlrev_b16 v14, 8, v14
    v_lshrrev_b32 v13, 2, v32
    v_or_b32 v28, v12, v11
    v_bitop3_b32 v32, v5, v13, v14 bitop3:0xea
    ds_add_u32 v32, v2
    v_mul_hi_u32_u24 v14, 429497, v29
    v_lshrrev_b32 v12, 3, v33
    v_cos_f32 v8, v8
    v_lshlrev_b16 v13, 3, v33
    v_mad_i32_i24 v11, v14, s55, v29
    v_bitop3_b32 v12, v6, v13, v12 bitop3:0xca
    v_add_lshl_u32 v11, v11, s40, 17
    v_lshlrev_b16 v14, 8, v14
    v_lshrrev_b32 v13, 2, v33
    v_or_b32 v29, v12, v11
    v_bitop3_b32 v33, v5, v13, v14 bitop3:0xea
    ds_add_u32 v33, v2
    v_cvt_pk_bf16_f32 v24, v7, v8
    v_perm_b32 v12, v24, v24, s41
    v_bitop3_b32 v28, v4, v12, v28 bitop3:0xca
    v_perm_b32 v13, v24, v24, s42
    v_bitop3_b32 v29, v4, v13, v29 bitop3:0xca
    v_mul_hi_u32_u24 v14, 429497, v30
    v_lshrrev_b32 v12, 3, v34
    v_cos_f32 v9, v9
    v_lshlrev_b16 v13, 3, v34
    v_mad_i32_i24 v11, v14, s55, v30
    v_bitop3_b32 v12, v6, v13, v12 bitop3:0xca
    v_add_lshl_u32 v11, v11, s40, 17
    v_lshlrev_b16 v14, 8, v14
    v_lshrrev_b32 v13, 2, v34
    v_or_b32 v30, v12, v11
    v_bitop3_b32 v34, v5, v13, v14 bitop3:0xea
    ds_add_u32 v34, v2
    v_mul_hi_u32_u24 v14, 429497, v31
    v_lshrrev_b32 v12, 3, v35
    v_cos_f32 v10, v10
    v_lshlrev_b16 v13, 3, v35
    v_mad_i32_i24 v11, v14, s55, v31
    v_bitop3_b32 v12, v6, v13, v12 bitop3:0xca
    v_add_lshl_u32 v11, v11, s40, 17
    v_lshlrev_b16 v14, 8, v14
    v_lshrrev_b32 v13, 2, v35
    v_or_b32 v31, v12, v11
    v_bitop3_b32 v35, v5, v13, v14 bitop3:0xea
    ds_add_u32 v35, v2
    v_cvt_pk_bf16_f32 v25, v9, v10
    v_perm_b32 v12, v25, v25, s41
    v_bitop3_b32 v30, v4, v12, v30 bitop3:0xca
    v_perm_b32 v13, v25, v25, s42
    v_bitop3_b32 v31, v4, v13, v31 bitop3:0xca
    s_add_u32 s47, s35, 0x10000
    buffer_store_dwordx4 v[64:67], v0, s[20:23], s47 offen sc1
    s_add_u32 s44, s34, 0x2000000
    s_nop 0
    buffer_load_dwordx2 v[64:65], v1, s[16:19], s44 offen nt
    s_add_u32 s45, s34, 0x2002000
    buffer_load_dwordx2 v[66:67], v1, s[16:19], s45 offen nt
    s_waitcnt vmcnt(15)
    v_lshlrev_b32 v7, 16, v26
    v_and_b32 v8, 0xffff0000, v26
    v_lshlrev_b32 v9, 16, v27
    v_and_b32 v10, 0xffff0000, v27
    v_mul_f32 v7, 0.15915494, v7
    v_mul_f32 v8, 0.15915494, v8
    v_mul_f32 v9, 0.15915494, v9
    v_mul_f32 v10, 0.15915494, v10
    v_mul_hi_u32_u24 v14, 429497, v36
    v_lshrrev_b32 v12, 3, v40
    v_cos_f32 v7, v7
    v_lshlrev_b16 v13, 3, v40
    v_mad_i32_i24 v11, v14, s55, v36
    v_bitop3_b32 v12, v6, v13, v12 bitop3:0xca
    v_add_lshl_u32 v11, v11, s40, 17
    v_lshlrev_b16 v14, 8, v14
    v_lshrrev_b32 v13, 2, v40
    v_or_b32 v36, v12, v11
    v_bitop3_b32 v40, v5, v13, v14 bitop3:0xea
    ds_add_u32 v40, v2
    v_mul_hi_u32_u24 v14, 429497, v37
    v_lshrrev_b32 v12, 3, v41
    v_cos_f32 v8, v8
    v_lshlrev_b16 v13, 3, v41
    v_mad_i32_i24 v11, v14, s55, v37
    v_bitop3_b32 v12, v6, v13, v12 bitop3:0xca
    v_add_lshl_u32 v11, v11, s40, 17
    v_lshlrev_b16 v14, 8, v14
    v_lshrrev_b32 v13, 2, v41
    v_or_b32 v37, v12, v11
    v_bitop3_b32 v41, v5, v13, v14 bitop3:0xea
    ds_add_u32 v41, v2
    v_cvt_pk_bf16_f32 v26, v7, v8
    v_perm_b32 v12, v26, v26, s41
    v_bitop3_b32 v36, v4, v12, v36 bitop3:0xca
    v_perm_b32 v13, v26, v26, s42
    v_bitop3_b32 v37, v4, v13, v37 bitop3:0xca
    v_mul_hi_u32_u24 v14, 429497, v38
    v_lshrrev_b32 v12, 3, v42
    v_cos_f32 v9, v9
    v_lshlrev_b16 v13, 3, v42
    v_mad_i32_i24 v11, v14, s55, v38
    v_bitop3_b32 v12, v6, v13, v12 bitop3:0xca
    v_add_lshl_u32 v11, v11, s40, 17
    v_lshlrev_b16 v14, 8, v14
    v_lshrrev_b32 v13, 2, v42
    v_or_b32 v38, v12, v11
    v_bitop3_b32 v42, v5, v13, v14 bitop3:0xea
    ds_add_u32 v42, v2
    v_mul_hi_u32_u24 v14, 429497, v39
    v_lshrrev_b32 v12, 3, v43
    v_cos_f32 v10, v10
    v_lshlrev_b16 v13, 3, v43
    v_mad_i32_i24 v11, v14, s55, v39
    v_bitop3_b32 v12, v6, v13, v12 bitop3:0xca
    v_add_lshl_u32 v11, v11, s40, 17
    v_lshlrev_b16 v14, 8, v14
    v_lshrrev_b32 v13, 2, v43
    v_or_b32 v39, v12, v11
    v_bitop3_b32 v43, v5, v13, v14 bitop3:0xea
    ds_add_u32 v43, v2
    v_cvt_pk_bf16_f32 v27, v9, v10
    v_perm_b32 v12, v27, v27, s41
    v_bitop3_b32 v38, v4, v12, v38 bitop3:0xca
    v_perm_b32 v13, v27, v27, s42
    v_bitop3_b32 v39, v4, v13, v39 bitop3:0xca
    s_waitcnt vmcnt(11)
    v_lshlrev_b32 v7, 16, v44
    v_and_b32 v8, 0xffff0000, v44
    v_lshlrev_b32 v9, 16, v45
    v_and_b32 v10, 0xffff0000, v45
    v_mul_f32 v7, 0.15915494, v7
    v_mul_f32 v8, 0.15915494, v8
    v_mul_f32 v9, 0.15915494, v9
    v_mul_f32 v10, 0.15915494, v10
    v_mul_hi_u32_u24 v14, 429497, v48
    v_lshrrev_b32 v12, 3, v52
    v_cos_f32 v7, v7
    v_lshlrev_b16 v13, 3, v52
    v_mad_i32_i24 v11, v14, s55, v48
    v_bitop3_b32 v12, v6, v13, v12 bitop3:0xca
    v_add_lshl_u32 v11, v11, s40, 17
    v_lshlrev_b16 v14, 8, v14
    v_lshrrev_b32 v13, 2, v52
    v_or_b32 v48, v12, v11
    v_bitop3_b32 v52, v5, v13, v14 bitop3:0xea
    ds_add_u32 v52, v2
    v_mul_hi_u32_u24 v14, 429497, v49
    v_lshrrev_b32 v12, 3, v53
    v_cos_f32 v8, v8
    v_lshlrev_b16 v13, 3, v53
    v_mad_i32_i24 v11, v14, s55, v49
    v_bitop3_b32 v12, v6, v13, v12 bitop3:0xca
    v_add_lshl_u32 v11, v11, s40, 17
    v_lshlrev_b16 v14, 8, v14
    v_lshrrev_b32 v13, 2, v53
    v_or_b32 v49, v12, v11
    v_bitop3_b32 v53, v5, v13, v14 bitop3:0xea
    ds_add_u32 v53, v2
    v_cvt_pk_bf16_f32 v44, v7, v8
    v_perm_b32 v12, v44, v44, s41
    v_bitop3_b32 v48, v4, v12, v48 bitop3:0xca
    v_perm_b32 v13, v44, v44, s42
    v_bitop3_b32 v49, v4, v13, v49 bitop3:0xca
    v_mul_hi_u32_u24 v14, 429497, v50
    v_lshrrev_b32 v12, 3, v54
    v_cos_f32 v9, v9
    v_lshlrev_b16 v13, 3, v54
    v_mad_i32_i24 v11, v14, s55, v50
    v_bitop3_b32 v12, v6, v13, v12 bitop3:0xca
    v_add_lshl_u32 v11, v11, s40, 17
    v_lshlrev_b16 v14, 8, v14
    v_lshrrev_b32 v13, 2, v54
    v_or_b32 v50, v12, v11
    v_bitop3_b32 v54, v5, v13, v14 bitop3:0xea
    ds_add_u32 v54, v2
    v_mul_hi_u32_u24 v14, 429497, v51
    v_lshrrev_b32 v12, 3, v55
    v_cos_f32 v10, v10
    v_lshlrev_b16 v13, 3, v55
    v_mad_i32_i24 v11, v14, s55, v51
    v_bitop3_b32 v12, v6, v13, v12 bitop3:0xca
    v_add_lshl_u32 v11, v11, s40, 17
    v_lshlrev_b16 v14, 8, v14
    v_lshrrev_b32 v13, 2, v55
    v_or_b32 v51, v12, v11
    v_bitop3_b32 v55, v5, v13, v14 bitop3:0xea
    ds_add_u32 v55, v2
    v_cvt_pk_bf16_f32 v45, v9, v10
    v_perm_b32 v12, v45, v45, s41
    v_bitop3_b32 v50, v4, v12, v50 bitop3:0xca
    v_perm_b32 v13, v45, v45, s42
    v_bitop3_b32 v51, v4, v13, v51 bitop3:0xca
    s_add_u32 s46, s35, 0x14000
    buffer_store_dwordx4 v[76:79], v0, s[20:23], s46 offen sc1
    s_add_u32 s47, s33, 0x4004000
    s_nop 0
    buffer_load_dwordx4 v[76:79], v0, s[8:11], s47 offen nt
    s_waitcnt vmcnt(9)
    v_lshlrev_b32 v7, 16, v46
    v_and_b32 v8, 0xffff0000, v46
    v_lshlrev_b32 v9, 16, v47
    v_and_b32 v10, 0xffff0000, v47
    v_mul_f32 v7, 0.15915494, v7
    v_mul_f32 v8, 0.15915494, v8
    v_mul_f32 v9, 0.15915494, v9
    v_mul_f32 v10, 0.15915494, v10
    v_mul_hi_u32_u24 v14, 429497, v56
    v_lshrrev_b32 v12, 3, v60
    v_cos_f32 v7, v7
    v_lshlrev_b16 v13, 3, v60
    v_mad_i32_i24 v11, v14, s55, v56
    v_bitop3_b32 v12, v6, v13, v12 bitop3:0xca
    v_add_lshl_u32 v11, v11, s40, 17
    v_lshlrev_b16 v14, 8, v14
    v_lshrrev_b32 v13, 2, v60
    v_or_b32 v56, v12, v11
    v_bitop3_b32 v60, v5, v13, v14 bitop3:0xea
    ds_add_u32 v60, v2
    v_mul_hi_u32_u24 v14, 429497, v57
    v_lshrrev_b32 v12, 3, v61
    v_cos_f32 v8, v8
    v_lshlrev_b16 v13, 3, v61
    v_mad_i32_i24 v11, v14, s55, v57
    v_bitop3_b32 v12, v6, v13, v12 bitop3:0xca
    v_add_lshl_u32 v11, v11, s40, 17
    v_lshlrev_b16 v14, 8, v14
    v_lshrrev_b32 v13, 2, v61
    v_or_b32 v57, v12, v11
    v_bitop3_b32 v61, v5, v13, v14 bitop3:0xea
    ds_add_u32 v61, v2
    v_cvt_pk_bf16_f32 v46, v7, v8
    v_perm_b32 v12, v46, v46, s41
    v_bitop3_b32 v56, v4, v12, v56 bitop3:0xca
    v_perm_b32 v13, v46, v46, s42
    v_bitop3_b32 v57, v4, v13, v57 bitop3:0xca
    v_mul_hi_u32_u24 v14, 429497, v58
    v_lshrrev_b32 v12, 3, v62
    v_cos_f32 v9, v9
    v_lshlrev_b16 v13, 3, v62
    v_mad_i32_i24 v11, v14, s55, v58
    v_bitop3_b32 v12, v6, v13, v12 bitop3:0xca
    v_add_lshl_u32 v11, v11, s40, 17
    v_lshlrev_b16 v14, 8, v14
    v_lshrrev_b32 v13, 2, v62
    v_or_b32 v58, v12, v11
    v_bitop3_b32 v62, v5, v13, v14 bitop3:0xea
    ds_add_u32 v62, v2
    v_mul_hi_u32_u24 v14, 429497, v59
    v_lshrrev_b32 v12, 3, v63
    v_cos_f32 v10, v10
    v_lshlrev_b16 v13, 3, v63
    v_mad_i32_i24 v11, v14, s55, v59
    v_bitop3_b32 v12, v6, v13, v12 bitop3:0xca
    v_add_lshl_u32 v11, v11, s40, 17
    v_lshlrev_b16 v14, 8, v14
    v_lshrrev_b32 v13, 2, v63
    v_or_b32 v59, v12, v11
    v_bitop3_b32 v63, v5, v13, v14 bitop3:0xea
    ds_add_u32 v63, v2
    v_cvt_pk_bf16_f32 v47, v9, v10
    v_perm_b32 v12, v47, v47, s41
    v_bitop3_b32 v58, v4, v12, v58 bitop3:0xca
    v_perm_b32 v13, v47, v47, s42
    v_bitop3_b32 v59, v4, v13, v59 bitop3:0xca
    v_lshrrev_b32 v8, 2, v0
    v_and_b32 v7, 0x3c00, v0
    v_bitop3_b32 v7, v5, v8, v7 bitop3:0xea
    s_waitcnt lgkmcnt(0)
    s_barrier
    ds_read2st64_b32 v[8:9], v7 offset0:0 offset1:1
    ds_read2st64_b32 v[10:11], v7 offset0:2 offset1:3
    s_add_u32 s44, s35, 0x18000
    buffer_store_dwordx4 v[80:83], v0, s[20:23], s44 offen sc1
    s_add_u32 s45, s33, 0x4004000
    s_nop 0
    buffer_load_dwordx4 v[80:83], v0, s[12:15], s45 offen nt
    s_waitcnt lgkmcnt(0)
    v_lshl_or_b32 v12, v9, 16, v8
    v_lshl_or_b32 v13, v11, 16, v10
    v_mov_b32 v14, v12
    v_mov_b32 v15, v13
    s_nop 0
    v_add_u32_dpp v14, v14, v14 row_shr:1 row_mask:0xf bank_mask:0xf bound_ctrl:1
    v_add_u32_dpp v15, v15, v15 row_shr:1 row_mask:0xf bank_mask:0xf bound_ctrl:1
    s_nop 0
    v_add_u32_dpp v14, v14, v14 row_shr:2 row_mask:0xf bank_mask:0xf bound_ctrl:1
    v_add_u32_dpp v15, v15, v15 row_shr:2 row_mask:0xf bank_mask:0xf bound_ctrl:1
    s_nop 0
    v_add_u32_dpp v14, v14, v14 row_shr:4 row_mask:0xf bank_mask:0xf bound_ctrl:1
    v_add_u32_dpp v15, v15, v15 row_shr:4 row_mask:0xf bank_mask:0xf bound_ctrl:1
    s_nop 0
    v_add_u32_dpp v14, v14, v14 row_shr:8 row_mask:0xf bank_mask:0xf bound_ctrl:1
    v_add_u32_dpp v15, v15, v15 row_shr:8 row_mask:0xf bank_mask:0xf bound_ctrl:1
    s_nop 0
    v_add_u32_dpp v14, v14, v14 row_bcast:15 row_mask:0xa bank_mask:0xf
    v_add_u32_dpp v15, v15, v15 row_bcast:15 row_mask:0xa bank_mask:0xf
    s_nop 0
    v_add_u32_dpp v14, v14, v14 row_bcast:31 row_mask:0xc bank_mask:0xf
    v_add_u32_dpp v15, v15, v15 row_bcast:31 row_mask:0xc bank_mask:0xf
    v_readlane_b32 s48, v14, 63
    v_readlane_b32 s49, v15, 63
    s_lshl_b32 s54, s32, 2
    v_mov_b32 v8, s54
    s_and_b32 s50, s48, 0xffff
    s_lshr_b32 s51, s48, 16
    s_and_b32 s52, s49, 0xffff
    s_lshr_b32 s53, s49, 16
    s_add_u32 s51, s51, s50
    s_add_u32 s52, s52, s51
    s_add_u32 s53, s53, s52
    v_mov_b32 v9, s53
    s_mov_b64 exec, 1
    ds_write_b32 v8, v9 offset:16384
    s_mov_b64 exec, -1
    v_and_b32 v8, 60, v7
    s_waitcnt lgkmcnt(0)
    s_barrier
    ds_read_b32 v9, v8 offset:16384
    s_waitcnt lgkmcnt(0)
    v_add_u32_dpp v9, v9, v9 row_shr:1 row_mask:0xf bank_mask:0xf bound_ctrl:1
    s_nop 1
    v_add_u32_dpp v9, v9, v9 row_shr:2 row_mask:0xf bank_mask:0xf bound_ctrl:1
    s_nop 1
    v_add_u32_dpp v9, v9, v9 row_shr:4 row_mask:0xf bank_mask:0xf bound_ctrl:1
    s_nop 1
    v_add_u32_dpp v9, v9, v9 row_shr:8 row_mask:0xf bank_mask:0xf bound_ctrl:1
    s_nop 0
    v_readlane_b32 s54, v9, s32
    s_sub_u32 s54, s54, s53
    s_add_u32 s50, s50, s54
    s_add_u32 s51, s51, s54
    s_add_u32 s52, s52, s54
    s_pack_ll_b32_b16 s48, s54, s50
    s_pack_ll_b32_b16 s49, s51, s52
    v_add_u32 v14, s48, v14
    v_add_u32 v15, s49, v15
    v_sub_u32 v12, v14, v12
    v_sub_u32 v13, v15, v13
    v_and_b32 v8, 0xffff, v12
    v_lshrrev_b32 v9, 16, v12
    v_and_b32 v10, 0xffff, v13
    v_lshrrev_b32 v11, 16, v13
    ds_write2st64_b32 v7, v8, v9 offset0:0 offset1:1
    ds_write2st64_b32 v7, v10, v11 offset0:2 offset1:3
    s_waitcnt lgkmcnt(0)
    s_barrier
    ds_add_rtn_u32 v100, v100, v2
    ds_add_rtn_u32 v101, v101, v2
    ds_add_rtn_u32 v102, v102, v2
    ds_add_rtn_u32 v103, v103, v2
    s_add_u32 s46, s36, 0x2a40000
    v_and_b32 v11, 0x3f0, v0
    v_add_u32 v11, v11, v11
    buffer_store_dwordx2 v[12:13], v11, s[24:27], s46 offen
    s_bitset0_b64 exec, 63
    s_not_b64 exec, exec
    buffer_store_dwordx2 v[14:15], v11, s[24:27], s46 offen offset:32
    s_mov_b64 exec, -1
    ds_add_rtn_u32 v112, v112, v2
    ds_add_rtn_u32 v113, v113, v2
    ds_add_rtn_u32 v114, v114, v2
    ds_add_rtn_u32 v115, v115, v2
    ds_add_rtn_u32 v120, v120, v2
    ds_add_rtn_u32 v121, v121, v2
    ds_add_rtn_u32 v122, v122, v2
    ds_add_rtn_u32 v123, v123, v2
    s_add_u32 s47, s35, 0x1c000
    buffer_store_dwordx4 v[88:91], v0, s[20:23], s47 offen sc1
    s_add_u32 s44, s33, 0x4008000
    s_nop 0
    buffer_load_dwordx4 v[88:91], v0, s[8:11], s44 offen nt
    ds_add_rtn_u32 v20, v20, v2
    ds_add_rtn_u32 v21, v21, v2
    ds_add_rtn_u32 v22, v22, v2
    ds_add_rtn_u32 v23, v23, v2
    ds_add_rtn_u32 v32, v32, v2
    ds_add_rtn_u32 v33, v33, v2
    ds_add_rtn_u32 v34, v34, v2
    ds_add_rtn_u32 v35, v35, v2
    s_add_u32 s45, s35, 0x20000
    buffer_store_dwordx4 v[92:95], v0, s[20:23], s45 offen sc1
    s_add_u32 s46, s33, 0x4008000
    s_nop 0
    buffer_load_dwordx4 v[92:95], v0, s[12:15], s46 offen nt
    ds_add_rtn_u32 v40, v40, v2
    ds_add_rtn_u32 v41, v41, v2
    ds_add_rtn_u32 v42, v42, v2
    ds_add_rtn_u32 v43, v43, v2
    ds_add_rtn_u32 v52, v52, v2
    ds_add_rtn_u32 v53, v53, v2
    ds_add_rtn_u32 v54, v54, v2
    ds_add_rtn_u32 v55, v55, v2
    s_add_u32 s47, s35, 0x24000
    buffer_store_dwordx4 v[84:87], v0, s[20:23], s47 offen sc1
    s_add_u32 s44, s34, 0x2004000
    s_nop 0
    buffer_load_dwordx2 v[84:85], v1, s[16:19], s44 offen nt
    s_add_u32 s45, s34, 0x2006000
    buffer_load_dwordx2 v[86:87], v1, s[16:19], s45 offen nt
    ds_add_rtn_u32 v60, v60, v2
    ds_add_rtn_u32 v61, v61, v2
    ds_add_rtn_u32 v62, v62, v2
    ds_add_rtn_u32 v63, v63, v2
    s_waitcnt lgkmcnt(0)
    s_barrier
    v_and_b32 v7, -4, v100
    v_lshl_add_u32 v8, v100, 2, v7
    ds_write_b32 v8, v96
    v_lshl_add_u32 v7, v7, 2, v100
    ds_write_b8 v7, v104 offset:16
    v_and_b32 v9, -4, v101
    v_lshl_add_u32 v10, v101, 2, v9
    ds_write_b32 v10, v97
    v_lshl_add_u32 v9, v9, 2, v101
    ds_write_b8_d16_hi v9, v104 offset:16
    v_and_b32 v7, -4, v102
    v_lshl_add_u32 v8, v102, 2, v7
    ds_write_b32 v8, v98
    v_lshl_add_u32 v7, v7, 2, v102
    ds_write_b8 v7, v105 offset:16
    v_and_b32 v9, -4, v103
    v_lshl_add_u32 v10, v103, 2, v9
    ds_write_b32 v10, v99
    v_lshl_add_u32 v9, v9, 2, v103
    ds_write_b8_d16_hi v9, v105 offset:16
    s_add_u32 s46, s33, 0x400c000
    buffer_load_dwordx4 v[96:99], v0, s[8:11], s46 offen nt
    s_add_u32 s47, s33, 0x400c000
    buffer_load_dwordx4 v[100:103], v0, s[12:15], s47 offen nt
    v_and_b32 v7, -4, v112
    v_lshl_add_u32 v8, v112, 2, v7
    ds_write_b32 v8, v108
    v_lshl_add_u32 v7, v7, 2, v112
    ds_write_b8 v7, v106 offset:16
    v_and_b32 v9, -4, v113
    v_lshl_add_u32 v10, v113, 2, v9
    ds_write_b32 v10, v109
    v_lshl_add_u32 v9, v9, 2, v113
    ds_write_b8_d16_hi v9, v106 offset:16
    v_and_b32 v7, -4, v114
    v_lshl_add_u32 v8, v114, 2, v7
    ds_write_b32 v8, v110
    v_lshl_add_u32 v7, v7, 2, v114
    ds_write_b8 v7, v107 offset:16
    v_and_b32 v9, -4, v115
    v_lshl_add_u32 v10, v115, 2, v9
    ds_write_b32 v10, v111
    v_lshl_add_u32 v9, v9, 2, v115
    ds_write_b8_d16_hi v9, v107 offset:16
    s_add_u32 s44, s33, 0x4010000
    buffer_load_dwordx4 v[108:111], v0, s[8:11], s44 offen nt
    v_and_b32 v7, -4, v120
    v_lshl_add_u32 v8, v120, 2, v7
    ds_write_b32 v8, v116
    v_lshl_add_u32 v7, v7, 2, v120
    ds_write_b8 v7, v124 offset:16
    v_and_b32 v9, -4, v121
    v_lshl_add_u32 v10, v121, 2, v9
    ds_write_b32 v10, v117
    v_lshl_add_u32 v9, v9, 2, v121
    ds_write_b8_d16_hi v9, v124 offset:16
    v_and_b32 v7, -4, v122
    v_lshl_add_u32 v8, v122, 2, v7
    ds_write_b32 v8, v118
    v_lshl_add_u32 v7, v7, 2, v122
    ds_write_b8 v7, v125 offset:16
    v_and_b32 v9, -4, v123
    v_lshl_add_u32 v10, v123, 2, v9
    ds_write_b32 v10, v119
    v_lshl_add_u32 v9, v9, 2, v123
    ds_write_b8_d16_hi v9, v125 offset:16
    s_add_u32 s45, s33, 0x4010000
    buffer_load_dwordx4 v[112:115], v0, s[12:15], s45 offen nt
    v_and_b32 v7, -4, v20
    v_lshl_add_u32 v8, v20, 2, v7
    ds_write_b32 v8, v16
    v_lshl_add_u32 v7, v7, 2, v20
    ds_write_b8 v7, v126 offset:16
    v_and_b32 v9, -4, v21
    v_lshl_add_u32 v10, v21, 2, v9
    ds_write_b32 v10, v17
    v_lshl_add_u32 v9, v9, 2, v21
    ds_write_b8_d16_hi v9, v126 offset:16
    v_and_b32 v7, -4, v22
    v_lshl_add_u32 v8, v22, 2, v7
    ds_write_b32 v8, v18
    v_lshl_add_u32 v7, v7, 2, v22
    ds_write_b8 v7, v127 offset:16
    v_and_b32 v9, -4, v23
    v_lshl_add_u32 v10, v23, 2, v9
    ds_write_b32 v10, v19
    v_lshl_add_u32 v9, v9, 2, v23
    ds_write_b8_d16_hi v9, v127 offset:16
    s_add_u32 s46, s34, 0x2008000
    buffer_load_dwordx2 v[104:105], v1, s[16:19], s46 offen nt
    s_add_u32 s47, s34, 0x200a000
    buffer_load_dwordx2 v[106:107], v1, s[16:19], s47 offen nt
    v_and_b32 v7, -4, v32
    v_lshl_add_u32 v8, v32, 2, v7
    ds_write_b32 v8, v28
    v_lshl_add_u32 v7, v7, 2, v32
    ds_write_b8 v7, v24 offset:16
    v_and_b32 v9, -4, v33
    v_lshl_add_u32 v10, v33, 2, v9
    ds_write_b32 v10, v29
    v_lshl_add_u32 v9, v9, 2, v33
    ds_write_b8_d16_hi v9, v24 offset:16
    v_and_b32 v7, -4, v34
    v_lshl_add_u32 v8, v34, 2, v7
    ds_write_b32 v8, v30
    v_lshl_add_u32 v7, v7, 2, v34
    ds_write_b8 v7, v25 offset:16
    v_and_b32 v9, -4, v35
    v_lshl_add_u32 v10, v35, 2, v9
    ds_write_b32 v10, v31
    v_lshl_add_u32 v9, v9, 2, v35
    ds_write_b8_d16_hi v9, v25 offset:16
    s_add_u32 s44, s33, 0x4014000
    buffer_load_dwordx4 v[116:119], v0, s[8:11], s44 offen nt
    s_add_u32 s45, s33, 0x4014000
    buffer_load_dwordx4 v[120:123], v0, s[12:15], s45 offen nt
    v_and_b32 v7, -4, v40
    v_lshl_add_u32 v8, v40, 2, v7
    ds_write_b32 v8, v36
    v_lshl_add_u32 v7, v7, 2, v40
    ds_write_b8 v7, v26 offset:16
    v_and_b32 v9, -4, v41
    v_lshl_add_u32 v10, v41, 2, v9
    ds_write_b32 v10, v37
    v_lshl_add_u32 v9, v9, 2, v41
    ds_write_b8_d16_hi v9, v26 offset:16
    v_and_b32 v7, -4, v42
    v_lshl_add_u32 v8, v42, 2, v7
    ds_write_b32 v8, v38
    v_lshl_add_u32 v7, v7, 2, v42
    ds_write_b8 v7, v27 offset:16
    v_and_b32 v9, -4, v43
    v_lshl_add_u32 v10, v43, 2, v9
    ds_write_b32 v10, v39
    v_lshl_add_u32 v9, v9, 2, v43
    ds_write_b8_d16_hi v9, v27 offset:16
    s_add_u32 s46, s33, 0x4018000
    buffer_load_dwordx4 v[16:19], v0, s[8:11], s46 offen nt
    v_and_b32 v7, -4, v52
    v_lshl_add_u32 v8, v52, 2, v7
    ds_write_b32 v8, v48
    v_lshl_add_u32 v7, v7, 2, v52
    ds_write_b8 v7, v44 offset:16
    v_and_b32 v9, -4, v53
    v_lshl_add_u32 v10, v53, 2, v9
    ds_write_b32 v10, v49
    v_lshl_add_u32 v9, v9, 2, v53
    ds_write_b8_d16_hi v9, v44 offset:16
    v_and_b32 v7, -4, v54
    v_lshl_add_u32 v8, v54, 2, v7
    ds_write_b32 v8, v50
    v_lshl_add_u32 v7, v7, 2, v54
    ds_write_b8 v7, v45 offset:16
    v_and_b32 v9, -4, v55
    v_lshl_add_u32 v10, v55, 2, v9
    ds_write_b32 v10, v51
    v_lshl_add_u32 v9, v9, 2, v55
    ds_write_b8_d16_hi v9, v45 offset:16
    s_add_u32 s47, s33, 0x4018000
    buffer_load_dwordx4 v[20:23], v0, s[12:15], s47 offen nt
    v_and_b32 v7, -4, v60
    v_lshl_add_u32 v8, v60, 2, v7
    ds_write_b32 v8, v56
    v_lshl_add_u32 v7, v7, 2, v60
    ds_write_b8 v7, v46 offset:16
    v_and_b32 v9, -4, v61
    v_lshl_add_u32 v10, v61, 2, v9
    ds_write_b32 v10, v57
    v_lshl_add_u32 v9, v9, 2, v61
    ds_write_b8_d16_hi v9, v46 offset:16
    v_and_b32 v7, -4, v62
    v_lshl_add_u32 v8, v62, 2, v7
    ds_write_b32 v8, v58
    v_lshl_add_u32 v7, v7, 2, v62
    ds_write_b8 v7, v47 offset:16
    v_and_b32 v9, -4, v63
    v_lshl_add_u32 v10, v63, 2, v9
    ds_write_b32 v10, v59
    v_lshl_add_u32 v9, v9, 2, v63
    ds_write_b8_d16_hi v9, v47 offset:16
    s_add_u32 s44, s34, 0x200c000
    buffer_load_dwordx2 v[124:125], v1, s[16:19], s44 offen nt
    s_add_u32 s45, s34, 0x200e000
    buffer_load_dwordx2 v[126:127], v1, s[16:19], s45 offen nt
    v_add_u32 v7, 0x10000, v0
    v_add_u32 v12, 0x20000, v0
    v_mov_b32 v8, 0
    v_mov_b32 v9, 0
    v_mov_b32 v10, 0
    v_mov_b32 v11, 0
    s_waitcnt lgkmcnt(0)
    s_barrier
    ds_read_b128 v[28:31], v0 offset:0
    ds_write_b128 v0, v[8:11]
    ds_read_b128 v[32:35], v0 offset:16384
    ds_read_b128 v[36:39], v0 offset:32768
    ds_read_b128 v[40:43], v0 offset:49152
    ds_read_b128 v[24:27], v7 offset:0
    ds_read_b128 v[48:51], v7 offset:16384
    ds_read_b128 v[52:55], v7 offset:32768
    ds_read_b128 v[56:59], v7 offset:49152
    ds_read_b128 v[60:63], v12 offset:0
    ds_read_b128 v[44:47], v12 offset:16384
    s_waitcnt lgkmcnt(0)
    s_barrier
    s_add_u32 s46, s35, 0x2a40000
    buffer_store_dwordx4 v[28:31], v0, s[20:23], s46 offen sc1
    s_add_u32 s47, s33, 0x401c000
    s_nop 0
    buffer_load_dwordx4 v[28:31], v0, s[8:11], s47 offen nt
    s_add_u32 s44, s35, 0x2a44000
    buffer_store_dwordx4 v[32:35], v0, s[20:23], s44 offen sc1
    s_add_u32 s45, s33, 0x401c000
    s_nop 0
    buffer_load_dwordx4 v[32:35], v0, s[12:15], s45 offen nt
    s_waitcnt vmcnt(29)
    v_lshlrev_b32 v7, 16, v64
    v_and_b32 v8, 0xffff0000, v64
    v_lshlrev_b32 v9, 16, v65
    v_and_b32 v10, 0xffff0000, v65
    v_mul_f32 v7, 0.15915494, v7
    v_mul_f32 v8, 0.15915494, v8
    v_mul_f32 v9, 0.15915494, v9
    v_mul_f32 v10, 0.15915494, v10
    v_mul_hi_u32_u24 v14, 429497, v68
    v_lshrrev_b32 v12, 3, v72
    v_cos_f32 v7, v7
    v_lshlrev_b16 v13, 3, v72
    v_mad_i32_i24 v11, v14, s55, v68
    v_bitop3_b32 v12, v6, v13, v12 bitop3:0xca
    v_add_lshl_u32 v11, v11, s40, 17
    v_lshlrev_b16 v14, 8, v14
    v_lshrrev_b32 v13, 2, v72
    v_or_b32 v68, v12, v11
    v_bitop3_b32 v72, v5, v13, v14 bitop3:0xea
    ds_add_u32 v72, v2
    v_mul_hi_u32_u24 v14, 429497, v69
    v_lshrrev_b32 v12, 3, v73
    v_cos_f32 v8, v8
    v_lshlrev_b16 v13, 3, v73
    v_mad_i32_i24 v11, v14, s55, v69
    v_bitop3_b32 v12, v6, v13, v12 bitop3:0xca
    v_add_lshl_u32 v11, v11, s40, 17
    v_lshlrev_b16 v14, 8, v14
    v_lshrrev_b32 v13, 2, v73
    v_or_b32 v69, v12, v11
    v_bitop3_b32 v73, v5, v13, v14 bitop3:0xea
    ds_add_u32 v73, v2
    v_cvt_pk_bf16_f32 v64, v7, v8
    v_perm_b32 v12, v64, v64, s41
    v_bitop3_b32 v68, v4, v12, v68 bitop3:0xca
    v_perm_b32 v13, v64, v64, s42
    v_bitop3_b32 v69, v4, v13, v69 bitop3:0xca
    v_mul_hi_u32_u24 v14, 429497, v70
    v_lshrrev_b32 v12, 3, v74
    v_cos_f32 v9, v9
    v_lshlrev_b16 v13, 3, v74
    v_mad_i32_i24 v11, v14, s55, v70
    v_bitop3_b32 v12, v6, v13, v12 bitop3:0xca
    v_add_lshl_u32 v11, v11, s40, 17
    v_lshlrev_b16 v14, 8, v14
    v_lshrrev_b32 v13, 2, v74
    v_or_b32 v70, v12, v11
    v_bitop3_b32 v74, v5, v13, v14 bitop3:0xea
    ds_add_u32 v74, v2
    v_mul_hi_u32_u24 v14, 429497, v71
    v_lshrrev_b32 v12, 3, v75
    v_cos_f32 v10, v10
    v_lshlrev_b16 v13, 3, v75
    v_mad_i32_i24 v11, v14, s55, v71
    v_bitop3_b32 v12, v6, v13, v12 bitop3:0xca
    v_add_lshl_u32 v11, v11, s40, 17
    v_lshlrev_b16 v14, 8, v14
    v_lshrrev_b32 v13, 2, v75
    v_or_b32 v71, v12, v11
    v_bitop3_b32 v75, v5, v13, v14 bitop3:0xea
    ds_add_u32 v75, v2
    v_cvt_pk_bf16_f32 v65, v9, v10
    v_perm_b32 v12, v65, v65, s41
    v_bitop3_b32 v70, v4, v12, v70 bitop3:0xca
    v_perm_b32 v13, v65, v65, s42
    v_bitop3_b32 v71, v4, v13, v71 bitop3:0xca
    s_add_u32 s46, s35, 0x2a48000
    buffer_store_dwordx4 v[36:39], v0, s[20:23], s46 offen sc1
    s_add_u32 s47, s33, 0x6000000
    s_nop 0
    buffer_load_dwordx4 v[36:39], v0, s[8:11], s47 offen nt
    s_waitcnt vmcnt(27)
    v_lshlrev_b32 v7, 16, v66
    v_and_b32 v8, 0xffff0000, v66
    v_lshlrev_b32 v9, 16, v67
    v_and_b32 v10, 0xffff0000, v67
    v_mul_f32 v7, 0.15915494, v7
    v_mul_f32 v8, 0.15915494, v8
    v_mul_f32 v9, 0.15915494, v9
    v_mul_f32 v10, 0.15915494, v10
    v_mul_hi_u32_u24 v14, 429497, v76
    v_lshrrev_b32 v12, 3, v80
    v_cos_f32 v7, v7
    v_lshlrev_b16 v13, 3, v80
    v_mad_i32_i24 v11, v14, s55, v76
    v_bitop3_b32 v12, v6, v13, v12 bitop3:0xca
    v_add_lshl_u32 v11, v11, s40, 17
    v_lshlrev_b16 v14, 8, v14
    v_lshrrev_b32 v13, 2, v80
    v_or_b32 v76, v12, v11
    v_bitop3_b32 v80, v5, v13, v14 bitop3:0xea
    ds_add_u32 v80, v2
    v_mul_hi_u32_u24 v14, 429497, v77
    v_lshrrev_b32 v12, 3, v81
    v_cos_f32 v8, v8
    v_lshlrev_b16 v13, 3, v81
    v_mad_i32_i24 v11, v14, s55, v77
    v_bitop3_b32 v12, v6, v13, v12 bitop3:0xca
    v_add_lshl_u32 v11, v11, s40, 17
    v_lshlrev_b16 v14, 8, v14
    v_lshrrev_b32 v13, 2, v81
    v_or_b32 v77, v12, v11
    v_bitop3_b32 v81, v5, v13, v14 bitop3:0xea
    ds_add_u32 v81, v2
    v_cvt_pk_bf16_f32 v66, v7, v8
    v_perm_b32 v12, v66, v66, s41
    v_bitop3_b32 v76, v4, v12, v76 bitop3:0xca
    v_perm_b32 v13, v66, v66, s42
    v_bitop3_b32 v77, v4, v13, v77 bitop3:0xca
    v_mul_hi_u32_u24 v14, 429497, v78
    v_lshrrev_b32 v12, 3, v82
    v_cos_f32 v9, v9
    v_lshlrev_b16 v13, 3, v82
    v_mad_i32_i24 v11, v14, s55, v78
    v_bitop3_b32 v12, v6, v13, v12 bitop3:0xca
    v_add_lshl_u32 v11, v11, s40, 17
    v_lshlrev_b16 v14, 8, v14
    v_lshrrev_b32 v13, 2, v82
    v_or_b32 v78, v12, v11
    v_bitop3_b32 v82, v5, v13, v14 bitop3:0xea
    ds_add_u32 v82, v2
    v_mul_hi_u32_u24 v14, 429497, v79
    v_lshrrev_b32 v12, 3, v83
    v_cos_f32 v10, v10
    v_lshlrev_b16 v13, 3, v83
    v_mad_i32_i24 v11, v14, s55, v79
    v_bitop3_b32 v12, v6, v13, v12 bitop3:0xca
    v_add_lshl_u32 v11, v11, s40, 17
    v_lshlrev_b16 v14, 8, v14
    v_lshrrev_b32 v13, 2, v83
    v_or_b32 v79, v12, v11
    v_bitop3_b32 v83, v5, v13, v14 bitop3:0xea
    ds_add_u32 v83, v2
    v_cvt_pk_bf16_f32 v67, v9, v10
    v_perm_b32 v12, v67, v67, s41
    v_bitop3_b32 v78, v4, v12, v78 bitop3:0xca
    v_perm_b32 v13, v67, v67, s42
    v_bitop3_b32 v79, v4, v13, v79 bitop3:0xca
    s_waitcnt vmcnt(18)
    v_lshlrev_b32 v7, 16, v84
    v_and_b32 v8, 0xffff0000, v84
    v_lshlrev_b32 v9, 16, v85
    v_and_b32 v10, 0xffff0000, v85
    v_mul_f32 v7, 0.15915494, v7
    v_mul_f32 v8, 0.15915494, v8
    v_mul_f32 v9, 0.15915494, v9
    v_mul_f32 v10, 0.15915494, v10
    v_mul_hi_u32_u24 v14, 429497, v88
    v_lshrrev_b32 v12, 3, v92
    v_cos_f32 v7, v7
    v_lshlrev_b16 v13, 3, v92
    v_mad_i32_i24 v11, v14, s55, v88
    v_bitop3_b32 v12, v6, v13, v12 bitop3:0xca
    v_add_lshl_u32 v11, v11, s40, 17
    v_lshlrev_b16 v14, 8, v14
    v_lshrrev_b32 v13, 2, v92
    v_or_b32 v88, v12, v11
    v_bitop3_b32 v92, v5, v13, v14 bitop3:0xea
    ds_add_u32 v92, v2
    v_mul_hi_u32_u24 v14, 429497, v89
    v_lshrrev_b32 v12, 3, v93
    v_cos_f32 v8, v8
    v_lshlrev_b16 v13, 3, v93
    v_mad_i32_i24 v11, v14, s55, v89
    v_bitop3_b32 v12, v6, v13, v12 bitop3:0xca
    v_add_lshl_u32 v11, v11, s40, 17
    v_lshlrev_b16 v14, 8, v14
    v_lshrrev_b32 v13, 2, v93
    v_or_b32 v89, v12, v11
    v_bitop3_b32 v93, v5, v13, v14 bitop3:0xea
    ds_add_u32 v93, v2
    v_cvt_pk_bf16_f32 v84, v7, v8
    v_perm_b32 v12, v84, v84, s41
    v_bitop3_b32 v88, v4, v12, v88 bitop3:0xca
    v_perm_b32 v13, v84, v84, s42
    v_bitop3_b32 v89, v4, v13, v89 bitop3:0xca
    v_mul_hi_u32_u24 v14, 429497, v90
    v_lshrrev_b32 v12, 3, v94
    v_cos_f32 v9, v9
    v_lshlrev_b16 v13, 3, v94
    v_mad_i32_i24 v11, v14, s55, v90
    v_bitop3_b32 v12, v6, v13, v12 bitop3:0xca
    v_add_lshl_u32 v11, v11, s40, 17
    v_lshlrev_b16 v14, 8, v14
    v_lshrrev_b32 v13, 2, v94
    v_or_b32 v90, v12, v11
    v_bitop3_b32 v94, v5, v13, v14 bitop3:0xea
    ds_add_u32 v94, v2
    v_mul_hi_u32_u24 v14, 429497, v91
    v_lshrrev_b32 v12, 3, v95
    v_cos_f32 v10, v10
    v_lshlrev_b16 v13, 3, v95
    v_mad_i32_i24 v11, v14, s55, v91
    v_bitop3_b32 v12, v6, v13, v12 bitop3:0xca
    v_add_lshl_u32 v11, v11, s40, 17
    v_lshlrev_b16 v14, 8, v14
    v_lshrrev_b32 v13, 2, v95
    v_or_b32 v91, v12, v11
    v_bitop3_b32 v95, v5, v13, v14 bitop3:0xea
    ds_add_u32 v95, v2
    v_cvt_pk_bf16_f32 v85, v9, v10
    v_perm_b32 v12, v85, v85, s41
    v_bitop3_b32 v90, v4, v12, v90 bitop3:0xca
    v_perm_b32 v13, v85, v85, s42
    v_bitop3_b32 v91, v4, v13, v91 bitop3:0xca
    s_add_u32 s44, s35, 0x2a4c000
    buffer_store_dwordx4 v[40:43], v0, s[20:23], s44 offen sc1
    s_add_u32 s45, s33, 0x6000000
    s_nop 0
    buffer_load_dwordx4 v[40:43], v0, s[12:15], s45 offen nt
    s_waitcnt vmcnt(18)
    v_lshlrev_b32 v7, 16, v86
    v_and_b32 v8, 0xffff0000, v86
    v_lshlrev_b32 v9, 16, v87
    v_and_b32 v10, 0xffff0000, v87
    v_mul_f32 v7, 0.15915494, v7
    v_mul_f32 v8, 0.15915494, v8
    v_mul_f32 v9, 0.15915494, v9
    v_mul_f32 v10, 0.15915494, v10
    v_mul_hi_u32_u24 v14, 429497, v96
    v_lshrrev_b32 v12, 3, v100
    v_cos_f32 v7, v7
    v_lshlrev_b16 v13, 3, v100
    v_mad_i32_i24 v11, v14, s55, v96
    v_bitop3_b32 v12, v6, v13, v12 bitop3:0xca
    v_add_lshl_u32 v11, v11, s40, 17
    v_lshlrev_b16 v14, 8, v14
    v_lshrrev_b32 v13, 2, v100
    v_or_b32 v96, v12, v11
    v_bitop3_b32 v100, v5, v13, v14 bitop3:0xea
    ds_add_u32 v100, v2
    v_mul_hi_u32_u24 v14, 429497, v97
    v_lshrrev_b32 v12, 3, v101
    v_cos_f32 v8, v8
    v_lshlrev_b16 v13, 3, v101
    v_mad_i32_i24 v11, v14, s55, v97
    v_bitop3_b32 v12, v6, v13, v12 bitop3:0xca
    v_add_lshl_u32 v11, v11, s40, 17
    v_lshlrev_b16 v14, 8, v14
    v_lshrrev_b32 v13, 2, v101
    v_or_b32 v97, v12, v11
    v_bitop3_b32 v101, v5, v13, v14 bitop3:0xea
    ds_add_u32 v101, v2
    v_cvt_pk_bf16_f32 v86, v7, v8
    v_perm_b32 v12, v86, v86, s41
    v_bitop3_b32 v96, v4, v12, v96 bitop3:0xca
    v_perm_b32 v13, v86, v86, s42
    v_bitop3_b32 v97, v4, v13, v97 bitop3:0xca
    v_mul_hi_u32_u24 v14, 429497, v98
    v_lshrrev_b32 v12, 3, v102
    v_cos_f32 v9, v9
    v_lshlrev_b16 v13, 3, v102
    v_mad_i32_i24 v11, v14, s55, v98
    v_bitop3_b32 v12, v6, v13, v12 bitop3:0xca
    v_add_lshl_u32 v11, v11, s40, 17
    v_lshlrev_b16 v14, 8, v14
    v_lshrrev_b32 v13, 2, v102
    v_or_b32 v98, v12, v11
    v_bitop3_b32 v102, v5, v13, v14 bitop3:0xea
    ds_add_u32 v102, v2
    v_mul_hi_u32_u24 v14, 429497, v99
    v_lshrrev_b32 v12, 3, v103
    v_cos_f32 v10, v10
    v_lshlrev_b16 v13, 3, v103
    v_mad_i32_i24 v11, v14, s55, v99
    v_bitop3_b32 v12, v6, v13, v12 bitop3:0xca
    v_add_lshl_u32 v11, v11, s40, 17
    v_lshlrev_b16 v14, 8, v14
    v_lshrrev_b32 v13, 2, v103
    v_or_b32 v99, v12, v11
    v_bitop3_b32 v103, v5, v13, v14 bitop3:0xea
    ds_add_u32 v103, v2
    v_cvt_pk_bf16_f32 v87, v9, v10
    v_perm_b32 v12, v87, v87, s41
    v_bitop3_b32 v98, v4, v12, v98 bitop3:0xca
    v_perm_b32 v13, v87, v87, s42
    v_bitop3_b32 v99, v4, v13, v99 bitop3:0xca
    s_waitcnt vmcnt(14)
    v_lshlrev_b32 v7, 16, v104
    v_and_b32 v8, 0xffff0000, v104
    v_lshlrev_b32 v9, 16, v105
    v_and_b32 v10, 0xffff0000, v105
    v_mul_f32 v7, 0.15915494, v7
    v_mul_f32 v8, 0.15915494, v8
    v_mul_f32 v9, 0.15915494, v9
    v_mul_f32 v10, 0.15915494, v10
    v_mul_hi_u32_u24 v14, 429497, v108
    v_lshrrev_b32 v12, 3, v112
    v_cos_f32 v7, v7
    v_lshlrev_b16 v13, 3, v112
    v_mad_i32_i24 v11, v14, s55, v108
    v_bitop3_b32 v12, v6, v13, v12 bitop3:0xca
    v_add_lshl_u32 v11, v11, s40, 17
    v_lshlrev_b16 v14, 8, v14
    v_lshrrev_b32 v13, 2, v112
    v_or_b32 v108, v12, v11
    v_bitop3_b32 v112, v5, v13, v14 bitop3:0xea
    ds_add_u32 v112, v2
    v_mul_hi_u32_u24 v14, 429497, v109
    v_lshrrev_b32 v12, 3, v113
    v_cos_f32 v8, v8
    v_lshlrev_b16 v13, 3, v113
    v_mad_i32_i24 v11, v14, s55, v109
    v_bitop3_b32 v12, v6, v13, v12 bitop3:0xca
    v_add_lshl_u32 v11, v11, s40, 17
    v_lshlrev_b16 v14, 8, v14
    v_lshrrev_b32 v13, 2, v113
    v_or_b32 v109, v12, v11
    v_bitop3_b32 v113, v5, v13, v14 bitop3:0xea
    ds_add_u32 v113, v2
    v_cvt_pk_bf16_f32 v104, v7, v8
    v_perm_b32 v12, v104, v104, s41
    v_bitop3_b32 v108, v4, v12, v108 bitop3:0xca
    v_perm_b32 v13, v104, v104, s42
    v_bitop3_b32 v109, v4, v13, v109 bitop3:0xca
    v_mul_hi_u32_u24 v14, 429497, v110
    v_lshrrev_b32 v12, 3, v114
    v_cos_f32 v9, v9
    v_lshlrev_b16 v13, 3, v114
    v_mad_i32_i24 v11, v14, s55, v110
    v_bitop3_b32 v12, v6, v13, v12 bitop3:0xca
    v_add_lshl_u32 v11, v11, s40, 17
    v_lshlrev_b16 v14, 8, v14
    v_lshrrev_b32 v13, 2, v114
    v_or_b32 v110, v12, v11
    v_bitop3_b32 v114, v5, v13, v14 bitop3:0xea
    ds_add_u32 v114, v2
    v_mul_hi_u32_u24 v14, 429497, v111
    v_lshrrev_b32 v12, 3, v115
    v_cos_f32 v10, v10
    v_lshlrev_b16 v13, 3, v115
    v_mad_i32_i24 v11, v14, s55, v111
    v_bitop3_b32 v12, v6, v13, v12 bitop3:0xca
    v_add_lshl_u32 v11, v11, s40, 17
    v_lshlrev_b16 v14, 8, v14
    v_lshrrev_b32 v13, 2, v115
    v_or_b32 v111, v12, v11
    v_bitop3_b32 v115, v5, v13, v14 bitop3:0xea
    ds_add_u32 v115, v2
    v_cvt_pk_bf16_f32 v105, v9, v10
    v_perm_b32 v12, v105, v105, s41
    v_bitop3_b32 v110, v4, v12, v110 bitop3:0xca
    v_perm_b32 v13, v105, v105, s42
    v_bitop3_b32 v111, v4, v13, v111 bitop3:0xca
    s_add_u32 s46, s35, 0x2a50000
    buffer_store_dwordx4 v[24:27], v0, s[20:23], s46 offen sc1
    s_add_u32 s47, s34, 0x3000000
    s_nop 0
    buffer_load_dwordx2 v[24:25], v1, s[16:19], s47 offen nt
    s_add_u32 s44, s34, 0x3002000
    buffer_load_dwordx2 v[26:27], v1, s[16:19], s44 offen nt
    s_waitcnt vmcnt(15)
    v_lshlrev_b32 v7, 16, v106
    v_and_b32 v8, 0xffff0000, v106
    v_lshlrev_b32 v9, 16, v107
    v_and_b32 v10, 0xffff0000, v107
    v_mul_f32 v7, 0.15915494, v7
    v_mul_f32 v8, 0.15915494, v8
    v_mul_f32 v9, 0.15915494, v9
    v_mul_f32 v10, 0.15915494, v10
    v_mul_hi_u32_u24 v14, 429497, v116
    v_lshrrev_b32 v12, 3, v120
    v_cos_f32 v7, v7
    v_lshlrev_b16 v13, 3, v120
    v_mad_i32_i24 v11, v14, s55, v116
    v_bitop3_b32 v12, v6, v13, v12 bitop3:0xca
    v_add_lshl_u32 v11, v11, s40, 17
    v_lshlrev_b16 v14, 8, v14
    v_lshrrev_b32 v13, 2, v120
    v_or_b32 v116, v12, v11
    v_bitop3_b32 v120, v5, v13, v14 bitop3:0xea
    ds_add_u32 v120, v2
    v_mul_hi_u32_u24 v14, 429497, v117
    v_lshrrev_b32 v12, 3, v121
    v_cos_f32 v8, v8
    v_lshlrev_b16 v13, 3, v121
    v_mad_i32_i24 v11, v14, s55, v117
    v_bitop3_b32 v12, v6, v13, v12 bitop3:0xca
    v_add_lshl_u32 v11, v11, s40, 17
    v_lshlrev_b16 v14, 8, v14
    v_lshrrev_b32 v13, 2, v121
    v_or_b32 v117, v12, v11
    v_bitop3_b32 v121, v5, v13, v14 bitop3:0xea
    ds_add_u32 v121, v2
    v_cvt_pk_bf16_f32 v106, v7, v8
    v_perm_b32 v12, v106, v106, s41
    v_bitop3_b32 v116, v4, v12, v116 bitop3:0xca
    v_perm_b32 v13, v106, v106, s42
    v_bitop3_b32 v117, v4, v13, v117 bitop3:0xca
    v_mul_hi_u32_u24 v14, 429497, v118
    v_lshrrev_b32 v12, 3, v122
    v_cos_f32 v9, v9
    v_lshlrev_b16 v13, 3, v122
    v_mad_i32_i24 v11, v14, s55, v118
    v_bitop3_b32 v12, v6, v13, v12 bitop3:0xca
    v_add_lshl_u32 v11, v11, s40, 17
    v_lshlrev_b16 v14, 8, v14
    v_lshrrev_b32 v13, 2, v122
    v_or_b32 v118, v12, v11
    v_bitop3_b32 v122, v5, v13, v14 bitop3:0xea
    ds_add_u32 v122, v2
    v_mul_hi_u32_u24 v14, 429497, v119
    v_lshrrev_b32 v12, 3, v123
    v_cos_f32 v10, v10
    v_lshlrev_b16 v13, 3, v123
    v_mad_i32_i24 v11, v14, s55, v119
    v_bitop3_b32 v12, v6, v13, v12 bitop3:0xca
    v_add_lshl_u32 v11, v11, s40, 17
    v_lshlrev_b16 v14, 8, v14
    v_lshrrev_b32 v13, 2, v123
    v_or_b32 v119, v12, v11
    v_bitop3_b32 v123, v5, v13, v14 bitop3:0xea
    ds_add_u32 v123, v2
    v_cvt_pk_bf16_f32 v107, v9, v10
    v_perm_b32 v12, v107, v107, s41
    v_bitop3_b32 v118, v4, v12, v118 bitop3:0xca
    v_perm_b32 v13, v107, v107, s42
    v_bitop3_b32 v119, v4, v13, v119 bitop3:0xca
    s_waitcnt vmcnt(11)
    v_lshlrev_b32 v7, 16, v124
    v_and_b32 v8, 0xffff0000, v124
    v_lshlrev_b32 v9, 16, v125
    v_and_b32 v10, 0xffff0000, v125
    v_mul_f32 v7, 0.15915494, v7
    v_mul_f32 v8, 0.15915494, v8
    v_mul_f32 v9, 0.15915494, v9
    v_mul_f32 v10, 0.15915494, v10
    v_mul_hi_u32_u24 v14, 429497, v16
    v_lshrrev_b32 v12, 3, v20
    v_cos_f32 v7, v7
    v_lshlrev_b16 v13, 3, v20
    v_mad_i32_i24 v11, v14, s55, v16
    v_bitop3_b32 v12, v6, v13, v12 bitop3:0xca
    v_add_lshl_u32 v11, v11, s40, 17
    v_lshlrev_b16 v14, 8, v14
    v_lshrrev_b32 v13, 2, v20
    v_or_b32 v16, v12, v11
    v_bitop3_b32 v20, v5, v13, v14 bitop3:0xea
    ds_add_u32 v20, v2
    v_mul_hi_u32_u24 v14, 429497, v17
    v_lshrrev_b32 v12, 3, v21
    v_cos_f32 v8, v8
    v_lshlrev_b16 v13, 3, v21
    v_mad_i32_i24 v11, v14, s55, v17
    v_bitop3_b32 v12, v6, v13, v12 bitop3:0xca
    v_add_lshl_u32 v11, v11, s40, 17
    v_lshlrev_b16 v14, 8, v14
    v_lshrrev_b32 v13, 2, v21
    v_or_b32 v17, v12, v11
    v_bitop3_b32 v21, v5, v13, v14 bitop3:0xea
    ds_add_u32 v21, v2
    v_cvt_pk_bf16_f32 v124, v7, v8
    v_perm_b32 v12, v124, v124, s41
    v_bitop3_b32 v16, v4, v12, v16 bitop3:0xca
    v_perm_b32 v13, v124, v124, s42
    v_bitop3_b32 v17, v4, v13, v17 bitop3:0xca
    v_mul_hi_u32_u24 v14, 429497, v18
    v_lshrrev_b32 v12, 3, v22
    v_cos_f32 v9, v9
    v_lshlrev_b16 v13, 3, v22
    v_mad_i32_i24 v11, v14, s55, v18
    v_bitop3_b32 v12, v6, v13, v12 bitop3:0xca
    v_add_lshl_u32 v11, v11, s40, 17
    v_lshlrev_b16 v14, 8, v14
    v_lshrrev_b32 v13, 2, v22
    v_or_b32 v18, v12, v11
    v_bitop3_b32 v22, v5, v13, v14 bitop3:0xea
    ds_add_u32 v22, v2
    v_mul_hi_u32_u24 v14, 429497, v19
    v_lshrrev_b32 v12, 3, v23
    v_cos_f32 v10, v10
    v_lshlrev_b16 v13, 3, v23
    v_mad_i32_i24 v11, v14, s55, v19
    v_bitop3_b32 v12, v6, v13, v12 bitop3:0xca
    v_add_lshl_u32 v11, v11, s40, 17
    v_lshlrev_b16 v14, 8, v14
    v_lshrrev_b32 v13, 2, v23
    v_or_b32 v19, v12, v11
    v_bitop3_b32 v23, v5, v13, v14 bitop3:0xea
    ds_add_u32 v23, v2
    v_cvt_pk_bf16_f32 v125, v9, v10
    v_perm_b32 v12, v125, v125, s41
    v_bitop3_b32 v18, v4, v12, v18 bitop3:0xca
    v_perm_b32 v13, v125, v125, s42
    v_bitop3_b32 v19, v4, v13, v19 bitop3:0xca
    s_add_u32 s45, s35, 0x2a54000
    buffer_store_dwordx4 v[48:51], v0, s[20:23], s45 offen sc1
    s_add_u32 s46, s33, 0x6004000
    s_nop 0
    buffer_load_dwordx4 v[48:51], v0, s[8:11], s46 offen nt
    s_waitcnt vmcnt(9)
    v_lshlrev_b32 v7, 16, v126
    v_and_b32 v8, 0xffff0000, v126
    v_lshlrev_b32 v9, 16, v127
    v_and_b32 v10, 0xffff0000, v127
    v_mul_f32 v7, 0.15915494, v7
    v_mul_f32 v8, 0.15915494, v8
    v_mul_f32 v9, 0.15915494, v9
    v_mul_f32 v10, 0.15915494, v10
    v_mul_hi_u32_u24 v14, 429497, v28
    v_lshrrev_b32 v12, 3, v32
    v_cos_f32 v7, v7
    v_lshlrev_b16 v13, 3, v32
    v_mad_i32_i24 v11, v14, s55, v28
    v_bitop3_b32 v12, v6, v13, v12 bitop3:0xca
    v_add_lshl_u32 v11, v11, s40, 17
    v_lshlrev_b16 v14, 8, v14
    v_lshrrev_b32 v13, 2, v32
    v_or_b32 v28, v12, v11
    v_bitop3_b32 v32, v5, v13, v14 bitop3:0xea
    ds_add_u32 v32, v2
    v_mul_hi_u32_u24 v14, 429497, v29
    v_lshrrev_b32 v12, 3, v33
    v_cos_f32 v8, v8
    v_lshlrev_b16 v13, 3, v33
    v_mad_i32_i24 v11, v14, s55, v29
    v_bitop3_b32 v12, v6, v13, v12 bitop3:0xca
    v_add_lshl_u32 v11, v11, s40, 17
    v_lshlrev_b16 v14, 8, v14
    v_lshrrev_b32 v13, 2, v33
    v_or_b32 v29, v12, v11
    v_bitop3_b32 v33, v5, v13, v14 bitop3:0xea
    ds_add_u32 v33, v2
    v_cvt_pk_bf16_f32 v126, v7, v8
    v_perm_b32 v12, v126, v126, s41
    v_bitop3_b32 v28, v4, v12, v28 bitop3:0xca
    v_perm_b32 v13, v126, v126, s42
    v_bitop3_b32 v29, v4, v13, v29 bitop3:0xca
    v_mul_hi_u32_u24 v14, 429497, v30
    v_lshrrev_b32 v12, 3, v34
    v_cos_f32 v9, v9
    v_lshlrev_b16 v13, 3, v34
    v_mad_i32_i24 v11, v14, s55, v30
    v_bitop3_b32 v12, v6, v13, v12 bitop3:0xca
    v_add_lshl_u32 v11, v11, s40, 17
    v_lshlrev_b16 v14, 8, v14
    v_lshrrev_b32 v13, 2, v34
    v_or_b32 v30, v12, v11
    v_bitop3_b32 v34, v5, v13, v14 bitop3:0xea
    ds_add_u32 v34, v2
    v_mul_hi_u32_u24 v14, 429497, v31
    v_lshrrev_b32 v12, 3, v35
    v_cos_f32 v10, v10
    v_lshlrev_b16 v13, 3, v35
    v_mad_i32_i24 v11, v14, s55, v31
    v_bitop3_b32 v12, v6, v13, v12 bitop3:0xca
    v_add_lshl_u32 v11, v11, s40, 17
    v_lshlrev_b16 v14, 8, v14
    v_lshrrev_b32 v13, 2, v35
    v_or_b32 v31, v12, v11
    v_bitop3_b32 v35, v5, v13, v14 bitop3:0xea
    ds_add_u32 v35, v2
    v_cvt_pk_bf16_f32 v127, v9, v10
    v_perm_b32 v12, v127, v127, s41
    v_bitop3_b32 v30, v4, v12, v30 bitop3:0xca
    v_perm_b32 v13, v127, v127, s42
    v_bitop3_b32 v31, v4, v13, v31 bitop3:0xca
    v_lshrrev_b32 v8, 2, v0
    v_and_b32 v7, 0x3c00, v0
    v_bitop3_b32 v7, v5, v8, v7 bitop3:0xea
    s_waitcnt lgkmcnt(0)
    s_barrier
    ds_read2st64_b32 v[8:9], v7 offset0:0 offset1:1
    ds_read2st64_b32 v[10:11], v7 offset0:2 offset1:3
    s_add_u32 s47, s35, 0x2a58000
    buffer_store_dwordx4 v[52:55], v0, s[20:23], s47 offen sc1
    s_add_u32 s44, s33, 0x6004000
    s_nop 0
    buffer_load_dwordx4 v[52:55], v0, s[12:15], s44 offen nt
    s_waitcnt lgkmcnt(0)
    v_lshl_or_b32 v12, v9, 16, v8
    v_lshl_or_b32 v13, v11, 16, v10
    v_mov_b32 v14, v12
    v_mov_b32 v15, v13
    s_nop 0
    v_add_u32_dpp v14, v14, v14 row_shr:1 row_mask:0xf bank_mask:0xf bound_ctrl:1
    v_add_u32_dpp v15, v15, v15 row_shr:1 row_mask:0xf bank_mask:0xf bound_ctrl:1
    s_nop 0
    v_add_u32_dpp v14, v14, v14 row_shr:2 row_mask:0xf bank_mask:0xf bound_ctrl:1
    v_add_u32_dpp v15, v15, v15 row_shr:2 row_mask:0xf bank_mask:0xf bound_ctrl:1
    s_nop 0
    v_add_u32_dpp v14, v14, v14 row_shr:4 row_mask:0xf bank_mask:0xf bound_ctrl:1
    v_add_u32_dpp v15, v15, v15 row_shr:4 row_mask:0xf bank_mask:0xf bound_ctrl:1
    s_nop 0
    v_add_u32_dpp v14, v14, v14 row_shr:8 row_mask:0xf bank_mask:0xf bound_ctrl:1
    v_add_u32_dpp v15, v15, v15 row_shr:8 row_mask:0xf bank_mask:0xf bound_ctrl:1
    s_nop 0
    v_add_u32_dpp v14, v14, v14 row_bcast:15 row_mask:0xa bank_mask:0xf
    v_add_u32_dpp v15, v15, v15 row_bcast:15 row_mask:0xa bank_mask:0xf
    s_nop 0
    v_add_u32_dpp v14, v14, v14 row_bcast:31 row_mask:0xc bank_mask:0xf
    v_add_u32_dpp v15, v15, v15 row_bcast:31 row_mask:0xc bank_mask:0xf
    v_readlane_b32 s48, v14, 63
    v_readlane_b32 s49, v15, 63
    s_lshl_b32 s54, s32, 2
    v_mov_b32 v8, s54
    s_and_b32 s50, s48, 0xffff
    s_lshr_b32 s51, s48, 16
    s_and_b32 s52, s49, 0xffff
    s_lshr_b32 s53, s49, 16
    s_add_u32 s51, s51, s50
    s_add_u32 s52, s52, s51
    s_add_u32 s53, s53, s52
    v_mov_b32 v9, s53
    s_mov_b64 exec, 1
    ds_write_b32 v8, v9 offset:16384
    s_mov_b64 exec, -1
    v_and_b32 v8, 60, v7
    s_waitcnt lgkmcnt(0)
    s_barrier
    ds_read_b32 v9, v8 offset:16384
    s_waitcnt lgkmcnt(0)
    v_add_u32_dpp v9, v9, v9 row_shr:1 row_mask:0xf bank_mask:0xf bound_ctrl:1
    s_nop 1
    v_add_u32_dpp v9, v9, v9 row_shr:2 row_mask:0xf bank_mask:0xf bound_ctrl:1
    s_nop 1
    v_add_u32_dpp v9, v9, v9 row_shr:4 row_mask:0xf bank_mask:0xf bound_ctrl:1
    s_nop 1
    v_add_u32_dpp v9, v9, v9 row_shr:8 row_mask:0xf bank_mask:0xf bound_ctrl:1
    s_nop 0
    v_readlane_b32 s54, v9, s32
    s_sub_u32 s54, s54, s53
    s_add_u32 s50, s50, s54
    s_add_u32 s51, s51, s54
    s_add_u32 s52, s52, s54
    s_pack_ll_b32_b16 s48, s54, s50
    s_pack_ll_b32_b16 s49, s51, s52
    v_add_u32 v14, s48, v14
    v_add_u32 v15, s49, v15
    v_sub_u32 v12, v14, v12
    v_sub_u32 v13, v15, v13
    v_and_b32 v8, 0xffff, v12
    v_lshrrev_b32 v9, 16, v12
    v_and_b32 v10, 0xffff, v13
    v_lshrrev_b32 v11, 16, v13
    ds_write2st64_b32 v7, v8, v9 offset0:0 offset1:1
    ds_write2st64_b32 v7, v10, v11 offset0:2 offset1:3
    s_waitcnt lgkmcnt(0)
    s_barrier
    ds_add_rtn_u32 v72, v72, v2
    ds_add_rtn_u32 v73, v73, v2
    ds_add_rtn_u32 v74, v74, v2
    ds_add_rtn_u32 v75, v75, v2
    s_add_u32 s45, s36, 0x5480000
    v_and_b32 v11, 0x3f0, v0
    v_add_u32 v11, v11, v11
    buffer_store_dwordx2 v[12:13], v11, s[24:27], s45 offen
    s_bitset0_b64 exec, 63
    s_not_b64 exec, exec
    buffer_store_dwordx2 v[14:15], v11, s[24:27], s45 offen offset:32
    s_mov_b64 exec, -1
    ds_add_rtn_u32 v80, v80, v2
    ds_add_rtn_u32 v81, v81, v2
    ds_add_rtn_u32 v82, v82, v2
    ds_add_rtn_u32 v83, v83, v2
    ds_add_rtn_u32 v92, v92, v2
    ds_add_rtn_u32 v93, v93, v2
    ds_add_rtn_u32 v94, v94, v2
    ds_add_rtn_u32 v95, v95, v2
    s_add_u32 s46, s35, 0x2a5c000
    buffer_store_dwordx4 v[56:59], v0, s[20:23], s46 offen sc1
    s_add_u32 s47, s33, 0x6008000
    s_nop 0
    buffer_load_dwordx4 v[56:59], v0, s[8:11], s47 offen nt
    ds_add_rtn_u32 v100, v100, v2
    ds_add_rtn_u32 v101, v101, v2
    ds_add_rtn_u32 v102, v102, v2
    ds_add_rtn_u32 v103, v103, v2
    ds_add_rtn_u32 v112, v112, v2
    ds_add_rtn_u32 v113, v113, v2
    ds_add_rtn_u32 v114, v114, v2
    ds_add_rtn_u32 v115, v115, v2
    s_add_u32 s44, s35, 0x2a60000
    buffer_store_dwordx4 v[60:63], v0, s[20:23], s44 offen sc1
    s_add_u32 s45, s33, 0x6008000
    s_nop 0
    buffer_load_dwordx4 v[60:63], v0, s[12:15], s45 offen nt
    ds_add_rtn_u32 v120, v120, v2
    ds_add_rtn_u32 v121, v121, v2
    ds_add_rtn_u32 v122, v122, v2
    ds_add_rtn_u32 v123, v123, v2
    ds_add_rtn_u32 v20, v20, v2
    ds_add_rtn_u32 v21, v21, v2
    ds_add_rtn_u32 v22, v22, v2
    ds_add_rtn_u32 v23, v23, v2
    s_add_u32 s46, s35, 0x2a64000
    buffer_store_dwordx4 v[44:47], v0, s[20:23], s46 offen sc1
    s_add_u32 s47, s34, 0x3004000
    s_nop 0
    buffer_load_dwordx2 v[44:45], v1, s[16:19], s47 offen nt
    s_add_u32 s44, s34, 0x3006000
    buffer_load_dwordx2 v[46:47], v1, s[16:19], s44 offen nt
    ds_add_rtn_u32 v32, v32, v2
    ds_add_rtn_u32 v33, v33, v2
    ds_add_rtn_u32 v34, v34, v2
    ds_add_rtn_u32 v35, v35, v2
    s_waitcnt lgkmcnt(0)
    s_barrier
    v_and_b32 v7, -4, v72
    v_lshl_add_u32 v8, v72, 2, v7
    ds_write_b32 v8, v68
    v_lshl_add_u32 v7, v7, 2, v72
    ds_write_b8 v7, v64 offset:16
    v_and_b32 v9, -4, v73
    v_lshl_add_u32 v10, v73, 2, v9
    ds_write_b32 v10, v69
    v_lshl_add_u32 v9, v9, 2, v73
    ds_write_b8_d16_hi v9, v64 offset:16
    v_and_b32 v7, -4, v74
    v_lshl_add_u32 v8, v74, 2, v7
    ds_write_b32 v8, v70
    v_lshl_add_u32 v7, v7, 2, v74
    ds_write_b8 v7, v65 offset:16
    v_and_b32 v9, -4, v75
    v_lshl_add_u32 v10, v75, 2, v9
    ds_write_b32 v10, v71
    v_lshl_add_u32 v9, v9, 2, v75
    ds_write_b8_d16_hi v9, v65 offset:16
    s_add_u32 s45, s33, 0x600c000
    buffer_load_dwordx4 v[68:71], v0, s[8:11], s45 offen nt
    s_add_u32 s46, s33, 0x600c000
    buffer_load_dwordx4 v[72:75], v0, s[12:15], s46 offen nt
    v_and_b32 v7, -4, v80
    v_lshl_add_u32 v8, v80, 2, v7
    ds_write_b32 v8, v76
    v_lshl_add_u32 v7, v7, 2, v80
    ds_write_b8 v7, v66 offset:16
    v_and_b32 v9, -4, v81
    v_lshl_add_u32 v10, v81, 2, v9
    ds_write_b32 v10, v77
    v_lshl_add_u32 v9, v9, 2, v81
    ds_write_b8_d16_hi v9, v66 offset:16
    v_and_b32 v7, -4, v82
    v_lshl_add_u32 v8, v82, 2, v7
    ds_write_b32 v8, v78
    v_lshl_add_u32 v7, v7, 2, v82
    ds_write_b8 v7, v67 offset:16
    v_and_b32 v9, -4, v83
    v_lshl_add_u32 v10, v83, 2, v9
    ds_write_b32 v10, v79
    v_lshl_add_u32 v9, v9, 2, v83
    ds_write_b8_d16_hi v9, v67 offset:16
    s_add_u32 s47, s33, 0x6010000
    buffer_load_dwordx4 v[76:79], v0, s[8:11], s47 offen nt
    v_and_b32 v7, -4, v92
    v_lshl_add_u32 v8, v92, 2, v7
    ds_write_b32 v8, v88
    v_lshl_add_u32 v7, v7, 2, v92
    ds_write_b8 v7, v84 offset:16
    v_and_b32 v9, -4, v93
    v_lshl_add_u32 v10, v93, 2, v9
    ds_write_b32 v10, v89
    v_lshl_add_u32 v9, v9, 2, v93
    ds_write_b8_d16_hi v9, v84 offset:16
    v_and_b32 v7, -4, v94
    v_lshl_add_u32 v8, v94, 2, v7
    ds_write_b32 v8, v90
    v_lshl_add_u32 v7, v7, 2, v94
    ds_write_b8 v7, v85 offset:16
    v_and_b32 v9, -4, v95
    v_lshl_add_u32 v10, v95, 2, v9
    ds_write_b32 v10, v91
    v_lshl_add_u32 v9, v9, 2, v95
    ds_write_b8_d16_hi v9, v85 offset:16
    s_add_u32 s44, s33, 0x6010000
    buffer_load_dwordx4 v[80:83], v0, s[12:15], s44 offen nt
    v_and_b32 v7, -4, v100
    v_lshl_add_u32 v8, v100, 2, v7
    ds_write_b32 v8, v96
    v_lshl_add_u32 v7, v7, 2, v100
    ds_write_b8 v7, v86 offset:16
    v_and_b32 v9, -4, v101
    v_lshl_add_u32 v10, v101, 2, v9
    ds_write_b32 v10, v97
    v_lshl_add_u32 v9, v9, 2, v101
    ds_write_b8_d16_hi v9, v86 offset:16
    v_and_b32 v7, -4, v102
    v_lshl_add_u32 v8, v102, 2, v7
    ds_write_b32 v8, v98
    v_lshl_add_u32 v7, v7, 2, v102
    ds_write_b8 v7, v87 offset:16
    v_and_b32 v9, -4, v103
    v_lshl_add_u32 v10, v103, 2, v9
    ds_write_b32 v10, v99
    v_lshl_add_u32 v9, v9, 2, v103
    ds_write_b8_d16_hi v9, v87 offset:16
    s_add_u32 s45, s34, 0x3008000
    buffer_load_dwordx2 v[64:65], v1, s[16:19], s45 offen nt
    s_add_u32 s46, s34, 0x300a000
    buffer_load_dwordx2 v[66:67], v1, s[16:19], s46 offen nt
    v_and_b32 v7, -4, v112
    v_lshl_add_u32 v8, v112, 2, v7
    ds_write_b32 v8, v108
    v_lshl_add_u32 v7, v7, 2, v112
    ds_write_b8 v7, v104 offset:16
    v_and_b32 v9, -4, v113
    v_lshl_add_u32 v10, v113, 2, v9
    ds_write_b32 v10, v109
    v_lshl_add_u32 v9, v9, 2, v113
    ds_write_b8_d16_hi v9, v104 offset:16
    v_and_b32 v7, -4, v114
    v_lshl_add_u32 v8, v114, 2, v7
    ds_write_b32 v8, v110
    v_lshl_add_u32 v7, v7, 2, v114
    ds_write_b8 v7, v105 offset:16
    v_and_b32 v9, -4, v115
    v_lshl_add_u32 v10, v115, 2, v9
    ds_write_b32 v10, v111
    v_lshl_add_u32 v9, v9, 2, v115
    ds_write_b8_d16_hi v9, v105 offset:16
    s_add_u32 s47, s33, 0x6014000
    buffer_load_dwordx4 v[88:91], v0, s[8:11], s47 offen nt
    s_add_u32 s44, s33, 0x6014000
    buffer_load_dwordx4 v[92:95], v0, s[12:15], s44 offen nt
    v_and_b32 v7, -4, v120
    v_lshl_add_u32 v8, v120, 2, v7
    ds_write_b32 v8, v116
    v_lshl_add_u32 v7, v7, 2, v120
    ds_write_b8 v7, v106 offset:16
    v_and_b32 v9, -4, v121
    v_lshl_add_u32 v10, v121, 2, v9
    ds_write_b32 v10, v117
    v_lshl_add_u32 v9, v9, 2, v121
    ds_write_b8_d16_hi v9, v106 offset:16
    v_and_b32 v7, -4, v122
    v_lshl_add_u32 v8, v122, 2, v7
    ds_write_b32 v8, v118
    v_lshl_add_u32 v7, v7, 2, v122
    ds_write_b8 v7, v107 offset:16
    v_and_b32 v9, -4, v123
    v_lshl_add_u32 v10, v123, 2, v9
    ds_write_b32 v10, v119
    v_lshl_add_u32 v9, v9, 2, v123
    ds_write_b8_d16_hi v9, v107 offset:16
    s_add_u32 s45, s33, 0x6018000
    buffer_load_dwordx4 v[96:99], v0, s[8:11], s45 offen nt
    v_and_b32 v7, -4, v20
    v_lshl_add_u32 v8, v20, 2, v7
    ds_write_b32 v8, v16
    v_lshl_add_u32 v7, v7, 2, v20
    ds_write_b8 v7, v124 offset:16
    v_and_b32 v9, -4, v21
    v_lshl_add_u32 v10, v21, 2, v9
    ds_write_b32 v10, v17
    v_lshl_add_u32 v9, v9, 2, v21
    ds_write_b8_d16_hi v9, v124 offset:16
    v_and_b32 v7, -4, v22
    v_lshl_add_u32 v8, v22, 2, v7
    ds_write_b32 v8, v18
    v_lshl_add_u32 v7, v7, 2, v22
    ds_write_b8 v7, v125 offset:16
    v_and_b32 v9, -4, v23
    v_lshl_add_u32 v10, v23, 2, v9
    ds_write_b32 v10, v19
    v_lshl_add_u32 v9, v9, 2, v23
    ds_write_b8_d16_hi v9, v125 offset:16
    s_add_u32 s46, s33, 0x6018000
    buffer_load_dwordx4 v[100:103], v0, s[12:15], s46 offen nt
    v_and_b32 v7, -4, v32
    v_lshl_add_u32 v8, v32, 2, v7
    ds_write_b32 v8, v28
    v_lshl_add_u32 v7, v7, 2, v32
    ds_write_b8 v7, v126 offset:16
    v_and_b32 v9, -4, v33
    v_lshl_add_u32 v10, v33, 2, v9
    ds_write_b32 v10, v29
    v_lshl_add_u32 v9, v9, 2, v33
    ds_write_b8_d16_hi v9, v126 offset:16
    v_and_b32 v7, -4, v34
    v_lshl_add_u32 v8, v34, 2, v7
    ds_write_b32 v8, v30
    v_lshl_add_u32 v7, v7, 2, v34
    ds_write_b8 v7, v127 offset:16
    v_and_b32 v9, -4, v35
    v_lshl_add_u32 v10, v35, 2, v9
    ds_write_b32 v10, v31
    v_lshl_add_u32 v9, v9, 2, v35
    ds_write_b8_d16_hi v9, v127 offset:16
    s_add_u32 s47, s34, 0x300c000
    buffer_load_dwordx2 v[84:85], v1, s[16:19], s47 offen nt
    s_add_u32 s44, s34, 0x300e000
    buffer_load_dwordx2 v[86:87], v1, s[16:19], s44 offen nt
    v_add_u32 v7, 0x10000, v0
    v_add_u32 v12, 0x20000, v0
    v_mov_b32 v8, 0
    v_mov_b32 v9, 0
    v_mov_b32 v10, 0
    v_mov_b32 v11, 0
    s_waitcnt lgkmcnt(0)
    s_barrier
    ds_read_b128 v[108:111], v0 offset:0
    ds_write_b128 v0, v[8:11]
    ds_read_b128 v[112:115], v0 offset:16384
    ds_read_b128 v[116:119], v0 offset:32768
    ds_read_b128 v[120:123], v0 offset:49152
    ds_read_b128 v[104:107], v7 offset:0
    ds_read_b128 v[16:19], v7 offset:16384
    ds_read_b128 v[20:23], v7 offset:32768
    ds_read_b128 v[28:31], v7 offset:49152
    ds_read_b128 v[32:35], v12 offset:0
    ds_read_b128 v[124:127], v12 offset:16384
    s_waitcnt lgkmcnt(0)
    s_barrier
    s_add_u32 s45, s35, 0x5480000
    buffer_store_dwordx4 v[108:111], v0, s[20:23], s45 offen sc1
    s_add_u32 s46, s33, 0x601c000
    s_nop 0
    buffer_load_dwordx4 v[108:111], v0, s[8:11], s46 offen nt
    s_add_u32 s47, s35, 0x5484000
    buffer_store_dwordx4 v[112:115], v0, s[20:23], s47 offen sc1
    s_add_u32 s44, s33, 0x601c000
    s_nop 0
    buffer_load_dwordx4 v[112:115], v0, s[12:15], s44 offen nt
    s_waitcnt vmcnt(29)
    v_lshlrev_b32 v7, 16, v24
    v_and_b32 v8, 0xffff0000, v24
    v_lshlrev_b32 v9, 16, v25
    v_and_b32 v10, 0xffff0000, v25
    v_mul_f32 v7, 0.15915494, v7
    v_mul_f32 v8, 0.15915494, v8
    v_mul_f32 v9, 0.15915494, v9
    v_mul_f32 v10, 0.15915494, v10
    v_mul_hi_u32_u24 v14, 429497, v36
    v_lshrrev_b32 v12, 3, v40
    v_cos_f32 v7, v7
    v_lshlrev_b16 v13, 3, v40
    v_mad_i32_i24 v11, v14, s55, v36
    v_bitop3_b32 v12, v6, v13, v12 bitop3:0xca
    v_add_lshl_u32 v11, v11, s40, 17
    v_lshlrev_b16 v14, 8, v14
    v_lshrrev_b32 v13, 2, v40
    v_or_b32 v36, v12, v11
    v_bitop3_b32 v40, v5, v13, v14 bitop3:0xea
    ds_add_u32 v40, v2
    v_mul_hi_u32_u24 v14, 429497, v37
    v_lshrrev_b32 v12, 3, v41
    v_cos_f32 v8, v8
    v_lshlrev_b16 v13, 3, v41
    v_mad_i32_i24 v11, v14, s55, v37
    v_bitop3_b32 v12, v6, v13, v12 bitop3:0xca
    v_add_lshl_u32 v11, v11, s40, 17
    v_lshlrev_b16 v14, 8, v14
    v_lshrrev_b32 v13, 2, v41
    v_or_b32 v37, v12, v11
    v_bitop3_b32 v41, v5, v13, v14 bitop3:0xea
    ds_add_u32 v41, v2
    v_cvt_pk_bf16_f32 v24, v7, v8
    v_perm_b32 v12, v24, v24, s41
    v_bitop3_b32 v36, v4, v12, v36 bitop3:0xca
    v_perm_b32 v13, v24, v24, s42
    v_bitop3_b32 v37, v4, v13, v37 bitop3:0xca
    v_mul_hi_u32_u24 v14, 429497, v38
    v_lshrrev_b32 v12, 3, v42
    v_cos_f32 v9, v9
    v_lshlrev_b16 v13, 3, v42
    v_mad_i32_i24 v11, v14, s55, v38
    v_bitop3_b32 v12, v6, v13, v12 bitop3:0xca
    v_add_lshl_u32 v11, v11, s40, 17
    v_lshlrev_b16 v14, 8, v14
    v_lshrrev_b32 v13, 2, v42
    v_or_b32 v38, v12, v11
    v_bitop3_b32 v42, v5, v13, v14 bitop3:0xea
    ds_add_u32 v42, v2
    v_mul_hi_u32_u24 v14, 429497, v39
    v_lshrrev_b32 v12, 3, v43
    v_cos_f32 v10, v10
    v_lshlrev_b16 v13, 3, v43
    v_mad_i32_i24 v11, v14, s55, v39
    v_bitop3_b32 v12, v6, v13, v12 bitop3:0xca
    v_add_lshl_u32 v11, v11, s40, 17
    v_lshlrev_b16 v14, 8, v14
    v_lshrrev_b32 v13, 2, v43
    v_or_b32 v39, v12, v11
    v_bitop3_b32 v43, v5, v13, v14 bitop3:0xea
    ds_add_u32 v43, v2
    v_cvt_pk_bf16_f32 v25, v9, v10
    v_perm_b32 v12, v25, v25, s41
    v_bitop3_b32 v38, v4, v12, v38 bitop3:0xca
    v_perm_b32 v13, v25, v25, s42
    v_bitop3_b32 v39, v4, v13, v39 bitop3:0xca
    s_add_u32 s45, s35, 0x5488000
    buffer_store_dwordx4 v[116:119], v0, s[20:23], s45 offen sc1
    s_add_u32 s46, s38, 0x0
    s_nop 0
    buffer_load_dwordx4 v[116:119], v0, s[8:11], s46 offen nt
    s_waitcnt vmcnt(27)
    v_lshlrev_b32 v7, 16, v26
    v_and_b32 v8, 0xffff0000, v26
    v_lshlrev_b32 v9, 16, v27
    v_and_b32 v10, 0xffff0000, v27
    v_mul_f32 v7, 0.15915494, v7
    v_mul_f32 v8, 0.15915494, v8
    v_mul_f32 v9, 0.15915494, v9
    v_mul_f32 v10, 0.15915494, v10
    v_mul_hi_u32_u24 v14, 429497, v48
    v_lshrrev_b32 v12, 3, v52
    v_cos_f32 v7, v7
    v_lshlrev_b16 v13, 3, v52
    v_mad_i32_i24 v11, v14, s55, v48
    v_bitop3_b32 v12, v6, v13, v12 bitop3:0xca
    v_add_lshl_u32 v11, v11, s40, 17
    v_lshlrev_b16 v14, 8, v14
    v_lshrrev_b32 v13, 2, v52
    v_or_b32 v48, v12, v11
    v_bitop3_b32 v52, v5, v13, v14 bitop3:0xea
    ds_add_u32 v52, v2
    v_mul_hi_u32_u24 v14, 429497, v49
    v_lshrrev_b32 v12, 3, v53
    v_cos_f32 v8, v8
    v_lshlrev_b16 v13, 3, v53
    v_mad_i32_i24 v11, v14, s55, v49
    v_bitop3_b32 v12, v6, v13, v12 bitop3:0xca
    v_add_lshl_u32 v11, v11, s40, 17
    v_lshlrev_b16 v14, 8, v14
    v_lshrrev_b32 v13, 2, v53
    v_or_b32 v49, v12, v11
    v_bitop3_b32 v53, v5, v13, v14 bitop3:0xea
    ds_add_u32 v53, v2
    v_cvt_pk_bf16_f32 v26, v7, v8
    v_perm_b32 v12, v26, v26, s41
    v_bitop3_b32 v48, v4, v12, v48 bitop3:0xca
    v_perm_b32 v13, v26, v26, s42
    v_bitop3_b32 v49, v4, v13, v49 bitop3:0xca
    v_mul_hi_u32_u24 v14, 429497, v50
    v_lshrrev_b32 v12, 3, v54
    v_cos_f32 v9, v9
    v_lshlrev_b16 v13, 3, v54
    v_mad_i32_i24 v11, v14, s55, v50
    v_bitop3_b32 v12, v6, v13, v12 bitop3:0xca
    v_add_lshl_u32 v11, v11, s40, 17
    v_lshlrev_b16 v14, 8, v14
    v_lshrrev_b32 v13, 2, v54
    v_or_b32 v50, v12, v11
    v_bitop3_b32 v54, v5, v13, v14 bitop3:0xea
    ds_add_u32 v54, v2
    v_mul_hi_u32_u24 v14, 429497, v51
    v_lshrrev_b32 v12, 3, v55
    v_cos_f32 v10, v10
    v_lshlrev_b16 v13, 3, v55
    v_mad_i32_i24 v11, v14, s55, v51
    v_bitop3_b32 v12, v6, v13, v12 bitop3:0xca
    v_add_lshl_u32 v11, v11, s40, 17
    v_lshlrev_b16 v14, 8, v14
    v_lshrrev_b32 v13, 2, v55
    v_or_b32 v51, v12, v11
    v_bitop3_b32 v55, v5, v13, v14 bitop3:0xea
    ds_add_u32 v55, v2
    v_cvt_pk_bf16_f32 v27, v9, v10
    v_perm_b32 v12, v27, v27, s41
    v_bitop3_b32 v50, v4, v12, v50 bitop3:0xca
    v_perm_b32 v13, v27, v27, s42
    v_bitop3_b32 v51, v4, v13, v51 bitop3:0xca
    s_waitcnt vmcnt(18)
    v_lshlrev_b32 v7, 16, v44
    v_and_b32 v8, 0xffff0000, v44
    v_lshlrev_b32 v9, 16, v45
    v_and_b32 v10, 0xffff0000, v45
    v_mul_f32 v7, 0.15915494, v7
    v_mul_f32 v8, 0.15915494, v8
    v_mul_f32 v9, 0.15915494, v9
    v_mul_f32 v10, 0.15915494, v10
    v_mul_hi_u32_u24 v14, 429497, v56
    v_lshrrev_b32 v12, 3, v60
    v_cos_f32 v7, v7
    v_lshlrev_b16 v13, 3, v60
    v_mad_i32_i24 v11, v14, s55, v56
    v_bitop3_b32 v12, v6, v13, v12 bitop3:0xca
    v_add_lshl_u32 v11, v11, s40, 17
    v_lshlrev_b16 v14, 8, v14
    v_lshrrev_b32 v13, 2, v60
    v_or_b32 v56, v12, v11
    v_bitop3_b32 v60, v5, v13, v14 bitop3:0xea
    ds_add_u32 v60, v2
    v_mul_hi_u32_u24 v14, 429497, v57
    v_lshrrev_b32 v12, 3, v61
    v_cos_f32 v8, v8
    v_lshlrev_b16 v13, 3, v61
    v_mad_i32_i24 v11, v14, s55, v57
    v_bitop3_b32 v12, v6, v13, v12 bitop3:0xca
    v_add_lshl_u32 v11, v11, s40, 17
    v_lshlrev_b16 v14, 8, v14
    v_lshrrev_b32 v13, 2, v61
    v_or_b32 v57, v12, v11
    v_bitop3_b32 v61, v5, v13, v14 bitop3:0xea
    ds_add_u32 v61, v2
    v_cvt_pk_bf16_f32 v44, v7, v8
    v_perm_b32 v12, v44, v44, s41
    v_bitop3_b32 v56, v4, v12, v56 bitop3:0xca
    v_perm_b32 v13, v44, v44, s42
    v_bitop3_b32 v57, v4, v13, v57 bitop3:0xca
    v_mul_hi_u32_u24 v14, 429497, v58
    v_lshrrev_b32 v12, 3, v62
    v_cos_f32 v9, v9
    v_lshlrev_b16 v13, 3, v62
    v_mad_i32_i24 v11, v14, s55, v58
    v_bitop3_b32 v12, v6, v13, v12 bitop3:0xca
    v_add_lshl_u32 v11, v11, s40, 17
    v_lshlrev_b16 v14, 8, v14
    v_lshrrev_b32 v13, 2, v62
    v_or_b32 v58, v12, v11
    v_bitop3_b32 v62, v5, v13, v14 bitop3:0xea
    ds_add_u32 v62, v2
    v_mul_hi_u32_u24 v14, 429497, v59
    v_lshrrev_b32 v12, 3, v63
    v_cos_f32 v10, v10
    v_lshlrev_b16 v13, 3, v63
    v_mad_i32_i24 v11, v14, s55, v59
    v_bitop3_b32 v12, v6, v13, v12 bitop3:0xca
    v_add_lshl_u32 v11, v11, s40, 17
    v_lshlrev_b16 v14, 8, v14
    v_lshrrev_b32 v13, 2, v63
    v_or_b32 v59, v12, v11
    v_bitop3_b32 v63, v5, v13, v14 bitop3:0xea
    ds_add_u32 v63, v2
    v_cvt_pk_bf16_f32 v45, v9, v10
    v_perm_b32 v12, v45, v45, s41
    v_bitop3_b32 v58, v4, v12, v58 bitop3:0xca
    v_perm_b32 v13, v45, v45, s42
    v_bitop3_b32 v59, v4, v13, v59 bitop3:0xca
    s_add_u32 s47, s35, 0x548c000
    buffer_store_dwordx4 v[120:123], v0, s[20:23], s47 offen sc1
    s_add_u32 s44, s38, 0x0
    s_nop 0
    buffer_load_dwordx4 v[120:123], v0, s[12:15], s44 offen nt
    s_waitcnt vmcnt(18)
    v_lshlrev_b32 v7, 16, v46
    v_and_b32 v8, 0xffff0000, v46
    v_lshlrev_b32 v9, 16, v47
    v_and_b32 v10, 0xffff0000, v47
    v_mul_f32 v7, 0.15915494, v7
    v_mul_f32 v8, 0.15915494, v8
    v_mul_f32 v9, 0.15915494, v9
    v_mul_f32 v10, 0.15915494, v10
    v_mul_hi_u32_u24 v14, 429497, v68
    v_lshrrev_b32 v12, 3, v72
    v_cos_f32 v7, v7
    v_lshlrev_b16 v13, 3, v72
    v_mad_i32_i24 v11, v14, s55, v68
    v_bitop3_b32 v12, v6, v13, v12 bitop3:0xca
    v_add_lshl_u32 v11, v11, s40, 17
    v_lshlrev_b16 v14, 8, v14
    v_lshrrev_b32 v13, 2, v72
    v_or_b32 v68, v12, v11
    v_bitop3_b32 v72, v5, v13, v14 bitop3:0xea
    ds_add_u32 v72, v2
    v_mul_hi_u32_u24 v14, 429497, v69
    v_lshrrev_b32 v12, 3, v73
    v_cos_f32 v8, v8
    v_lshlrev_b16 v13, 3, v73
    v_mad_i32_i24 v11, v14, s55, v69
    v_bitop3_b32 v12, v6, v13, v12 bitop3:0xca
    v_add_lshl_u32 v11, v11, s40, 17
    v_lshlrev_b16 v14, 8, v14
    v_lshrrev_b32 v13, 2, v73
    v_or_b32 v69, v12, v11
    v_bitop3_b32 v73, v5, v13, v14 bitop3:0xea
    ds_add_u32 v73, v2
    v_cvt_pk_bf16_f32 v46, v7, v8
    v_perm_b32 v12, v46, v46, s41
    v_bitop3_b32 v68, v4, v12, v68 bitop3:0xca
    v_perm_b32 v13, v46, v46, s42
    v_bitop3_b32 v69, v4, v13, v69 bitop3:0xca
    v_mul_hi_u32_u24 v14, 429497, v70
    v_lshrrev_b32 v12, 3, v74
    v_cos_f32 v9, v9
    v_lshlrev_b16 v13, 3, v74
    v_mad_i32_i24 v11, v14, s55, v70
    v_bitop3_b32 v12, v6, v13, v12 bitop3:0xca
    v_add_lshl_u32 v11, v11, s40, 17
    v_lshlrev_b16 v14, 8, v14
    v_lshrrev_b32 v13, 2, v74
    v_or_b32 v70, v12, v11
    v_bitop3_b32 v74, v5, v13, v14 bitop3:0xea
    ds_add_u32 v74, v2
    v_mul_hi_u32_u24 v14, 429497, v71
    v_lshrrev_b32 v12, 3, v75
    v_cos_f32 v10, v10
    v_lshlrev_b16 v13, 3, v75
    v_mad_i32_i24 v11, v14, s55, v71
    v_bitop3_b32 v12, v6, v13, v12 bitop3:0xca
    v_add_lshl_u32 v11, v11, s40, 17
    v_lshlrev_b16 v14, 8, v14
    v_lshrrev_b32 v13, 2, v75
    v_or_b32 v71, v12, v11
    v_bitop3_b32 v75, v5, v13, v14 bitop3:0xea
    ds_add_u32 v75, v2
    v_cvt_pk_bf16_f32 v47, v9, v10
    v_perm_b32 v12, v47, v47, s41
    v_bitop3_b32 v70, v4, v12, v70 bitop3:0xca
    v_perm_b32 v13, v47, v47, s42
    v_bitop3_b32 v71, v4, v13, v71 bitop3:0xca
    s_mov_b32 s68, s56
    s_mov_b32 s69, s57
    s_mov_b32 s70, 0x100
    s_mov_b32 s71, 0x20000
    v_mov_b32 v3, 1
    s_cmp_lg_u32 s32, 15
    s_cbranch_scc1 L1_tk
    s_mov_b64 exec, 1
    buffer_atomic_add v3, off, s[68:71], 0 sc0
    s_mov_b64 exec, -1
L1_tk:
    s_waitcnt vmcnt(14)
    v_lshlrev_b32 v7, 16, v64
    v_and_b32 v8, 0xffff0000, v64
    v_lshlrev_b32 v9, 16, v65
    v_and_b32 v10, 0xffff0000, v65
    v_mul_f32 v7, 0.15915494, v7
    v_mul_f32 v8, 0.15915494, v8
    v_mul_f32 v9, 0.15915494, v9
    v_mul_f32 v10, 0.15915494, v10
    v_mul_hi_u32_u24 v14, 429497, v76
    v_lshrrev_b32 v12, 3, v80
    v_cos_f32 v7, v7
    v_lshlrev_b16 v13, 3, v80
    v_mad_i32_i24 v11, v14, s55, v76
    v_bitop3_b32 v12, v6, v13, v12 bitop3:0xca
    v_add_lshl_u32 v11, v11, s40, 17
    v_lshlrev_b16 v14, 8, v14
    v_lshrrev_b32 v13, 2, v80
    v_or_b32 v76, v12, v11
    v_bitop3_b32 v80, v5, v13, v14 bitop3:0xea
    ds_add_u32 v80, v2
    v_mul_hi_u32_u24 v14, 429497, v77
    v_lshrrev_b32 v12, 3, v81
    v_cos_f32 v8, v8
    v_lshlrev_b16 v13, 3, v81
    v_mad_i32_i24 v11, v14, s55, v77
    v_bitop3_b32 v12, v6, v13, v12 bitop3:0xca
    v_add_lshl_u32 v11, v11, s40, 17
    v_lshlrev_b16 v14, 8, v14
    v_lshrrev_b32 v13, 2, v81
    v_or_b32 v77, v12, v11
    v_bitop3_b32 v81, v5, v13, v14 bitop3:0xea
    ds_add_u32 v81, v2
    v_cvt_pk_bf16_f32 v64, v7, v8
    v_perm_b32 v12, v64, v64, s41
    v_bitop3_b32 v76, v4, v12, v76 bitop3:0xca
    v_perm_b32 v13, v64, v64, s42
    v_bitop3_b32 v77, v4, v13, v77 bitop3:0xca
    v_mul_hi_u32_u24 v14, 429497, v78
    v_lshrrev_b32 v12, 3, v82
    v_cos_f32 v9, v9
    v_lshlrev_b16 v13, 3, v82
    v_mad_i32_i24 v11, v14, s55, v78
    v_bitop3_b32 v12, v6, v13, v12 bitop3:0xca
    v_add_lshl_u32 v11, v11, s40, 17
    v_lshlrev_b16 v14, 8, v14
    v_lshrrev_b32 v13, 2, v82
    v_or_b32 v78, v12, v11
    v_bitop3_b32 v82, v5, v13, v14 bitop3:0xea
    ds_add_u32 v82, v2
    v_mul_hi_u32_u24 v14, 429497, v79
    v_lshrrev_b32 v12, 3, v83
    v_cos_f32 v10, v10
    v_lshlrev_b16 v13, 3, v83
    v_mad_i32_i24 v11, v14, s55, v79
    v_bitop3_b32 v12, v6, v13, v12 bitop3:0xca
    v_add_lshl_u32 v11, v11, s40, 17
    v_lshlrev_b16 v14, 8, v14
    v_lshrrev_b32 v13, 2, v83
    v_or_b32 v79, v12, v11
    v_bitop3_b32 v83, v5, v13, v14 bitop3:0xea
    ds_add_u32 v83, v2
    v_cvt_pk_bf16_f32 v65, v9, v10
    v_perm_b32 v12, v65, v65, s41
    v_bitop3_b32 v78, v4, v12, v78 bitop3:0xca
    v_perm_b32 v13, v65, v65, s42
    v_bitop3_b32 v79, v4, v13, v79 bitop3:0xca
    s_add_u32 s45, s35, 0x5490000
    buffer_store_dwordx4 v[104:107], v0, s[20:23], s45 offen sc1
    s_add_u32 s46, s39, 0x0
    s_nop 0
    buffer_load_dwordx2 v[104:105], v1, s[16:19], s46 offen nt
    s_add_u32 s47, s39, 0x2000
    buffer_load_dwordx2 v[106:107], v1, s[16:19], s47 offen nt
    s_waitcnt vmcnt(15)
    v_lshlrev_b32 v7, 16, v66
    v_and_b32 v8, 0xffff0000, v66
    v_lshlrev_b32 v9, 16, v67
    v_and_b32 v10, 0xffff0000, v67
    v_mul_f32 v7, 0.15915494, v7
    v_mul_f32 v8, 0.15915494, v8
    v_mul_f32 v9, 0.15915494, v9
    v_mul_f32 v10, 0.15915494, v10
    v_mul_hi_u32_u24 v14, 429497, v88
    v_lshrrev_b32 v12, 3, v92
    v_cos_f32 v7, v7
    v_lshlrev_b16 v13, 3, v92
    v_mad_i32_i24 v11, v14, s55, v88
    v_bitop3_b32 v12, v6, v13, v12 bitop3:0xca
    v_add_lshl_u32 v11, v11, s40, 17
    v_lshlrev_b16 v14, 8, v14
    v_lshrrev_b32 v13, 2, v92
    v_or_b32 v88, v12, v11
    v_bitop3_b32 v92, v5, v13, v14 bitop3:0xea
    ds_add_u32 v92, v2
    v_mul_hi_u32_u24 v14, 429497, v89
    v_lshrrev_b32 v12, 3, v93
    v_cos_f32 v8, v8
    v_lshlrev_b16 v13, 3, v93
    v_mad_i32_i24 v11, v14, s55, v89
    v_bitop3_b32 v12, v6, v13, v12 bitop3:0xca
    v_add_lshl_u32 v11, v11, s40, 17
    v_lshlrev_b16 v14, 8, v14
    v_lshrrev_b32 v13, 2, v93
    v_or_b32 v89, v12, v11
    v_bitop3_b32 v93, v5, v13, v14 bitop3:0xea
    ds_add_u32 v93, v2
    v_cvt_pk_bf16_f32 v66, v7, v8
    v_perm_b32 v12, v66, v66, s41
    v_bitop3_b32 v88, v4, v12, v88 bitop3:0xca
    v_perm_b32 v13, v66, v66, s42
    v_bitop3_b32 v89, v4, v13, v89 bitop3:0xca
    v_mul_hi_u32_u24 v14, 429497, v90
    v_lshrrev_b32 v12, 3, v94
    v_cos_f32 v9, v9
    v_lshlrev_b16 v13, 3, v94
    v_mad_i32_i24 v11, v14, s55, v90
    v_bitop3_b32 v12, v6, v13, v12 bitop3:0xca
    v_add_lshl_u32 v11, v11, s40, 17
    v_lshlrev_b16 v14, 8, v14
    v_lshrrev_b32 v13, 2, v94
    v_or_b32 v90, v12, v11
    v_bitop3_b32 v94, v5, v13, v14 bitop3:0xea
    ds_add_u32 v94, v2
    v_mul_hi_u32_u24 v14, 429497, v91
    v_lshrrev_b32 v12, 3, v95
    v_cos_f32 v10, v10
    v_lshlrev_b16 v13, 3, v95
    v_mad_i32_i24 v11, v14, s55, v91
    v_bitop3_b32 v12, v6, v13, v12 bitop3:0xca
    v_add_lshl_u32 v11, v11, s40, 17
    v_lshlrev_b16 v14, 8, v14
    v_lshrrev_b32 v13, 2, v95
    v_or_b32 v91, v12, v11
    v_bitop3_b32 v95, v5, v13, v14 bitop3:0xea
    ds_add_u32 v95, v2
    v_cvt_pk_bf16_f32 v67, v9, v10
    v_perm_b32 v12, v67, v67, s41
    v_bitop3_b32 v90, v4, v12, v90 bitop3:0xca
    v_perm_b32 v13, v67, v67, s42
    v_bitop3_b32 v91, v4, v13, v91 bitop3:0xca
    s_waitcnt vmcnt(11)
    v_lshlrev_b32 v7, 16, v84
    v_and_b32 v8, 0xffff0000, v84
    v_lshlrev_b32 v9, 16, v85
    v_and_b32 v10, 0xffff0000, v85
    v_mul_f32 v7, 0.15915494, v7
    v_mul_f32 v8, 0.15915494, v8
    v_mul_f32 v9, 0.15915494, v9
    v_mul_f32 v10, 0.15915494, v10
    v_mul_hi_u32_u24 v14, 429497, v96
    v_lshrrev_b32 v12, 3, v100
    v_cos_f32 v7, v7
    v_lshlrev_b16 v13, 3, v100
    v_mad_i32_i24 v11, v14, s55, v96
    v_bitop3_b32 v12, v6, v13, v12 bitop3:0xca
    v_add_lshl_u32 v11, v11, s40, 17
    v_lshlrev_b16 v14, 8, v14
    v_lshrrev_b32 v13, 2, v100
    v_or_b32 v96, v12, v11
    v_bitop3_b32 v100, v5, v13, v14 bitop3:0xea
    ds_add_u32 v100, v2
    v_mul_hi_u32_u24 v14, 429497, v97
    v_lshrrev_b32 v12, 3, v101
    v_cos_f32 v8, v8
    v_lshlrev_b16 v13, 3, v101
    v_mad_i32_i24 v11, v14, s55, v97
    v_bitop3_b32 v12, v6, v13, v12 bitop3:0xca
    v_add_lshl_u32 v11, v11, s40, 17
    v_lshlrev_b16 v14, 8, v14
    v_lshrrev_b32 v13, 2, v101
    v_or_b32 v97, v12, v11
    v_bitop3_b32 v101, v5, v13, v14 bitop3:0xea
    ds_add_u32 v101, v2
    v_cvt_pk_bf16_f32 v84, v7, v8
    v_perm_b32 v12, v84, v84, s41
    v_bitop3_b32 v96, v4, v12, v96 bitop3:0xca
    v_perm_b32 v13, v84, v84, s42
    v_bitop3_b32 v97, v4, v13, v97 bitop3:0xca
    v_mul_hi_u32_u24 v14, 429497, v98
    v_lshrrev_b32 v12, 3, v102
    v_cos_f32 v9, v9
    v_lshlrev_b16 v13, 3, v102
    v_mad_i32_i24 v11, v14, s55, v98
    v_bitop3_b32 v12, v6, v13, v12 bitop3:0xca
    v_add_lshl_u32 v11, v11, s40, 17
    v_lshlrev_b16 v14, 8, v14
    v_lshrrev_b32 v13, 2, v102
    v_or_b32 v98, v12, v11
    v_bitop3_b32 v102, v5, v13, v14 bitop3:0xea
    ds_add_u32 v102, v2
    v_mul_hi_u32_u24 v14, 429497, v99
    v_lshrrev_b32 v12, 3, v103
    v_cos_f32 v10, v10
    v_lshlrev_b16 v13, 3, v103
    v_mad_i32_i24 v11, v14, s55, v99
    v_bitop3_b32 v12, v6, v13, v12 bitop3:0xca
    v_add_lshl_u32 v11, v11, s40, 17
    v_lshlrev_b16 v14, 8, v14
    v_lshrrev_b32 v13, 2, v103
    v_or_b32 v99, v12, v11
    v_bitop3_b32 v103, v5, v13, v14 bitop3:0xea
    ds_add_u32 v103, v2
    v_cvt_pk_bf16_f32 v85, v9, v10
    v_perm_b32 v12, v85, v85, s41
    v_bitop3_b32 v98, v4, v12, v98 bitop3:0xca
    v_perm_b32 v13, v85, v85, s42
    v_bitop3_b32 v99, v4, v13, v99 bitop3:0xca
    s_add_u32 s44, s35, 0x5494000
    buffer_store_dwordx4 v[16:19], v0, s[20:23], s44 offen sc1
    s_add_u32 s45, s38, 0x4000
    s_nop 0
    buffer_load_dwordx4 v[16:19], v0, s[8:11], s45 offen nt
    s_waitcnt vmcnt(9)
    v_lshlrev_b32 v7, 16, v86
    v_and_b32 v8, 0xffff0000, v86
    v_lshlrev_b32 v9, 16, v87
    v_and_b32 v10, 0xffff0000, v87
    v_mul_f32 v7, 0.15915494, v7
    v_mul_f32 v8, 0.15915494, v8
    v_mul_f32 v9, 0.15915494, v9
    v_mul_f32 v10, 0.15915494, v10
    v_mul_hi_u32_u24 v14, 429497, v108
    v_lshrrev_b32 v12, 3, v112
    v_cos_f32 v7, v7
    v_lshlrev_b16 v13, 3, v112
    v_mad_i32_i24 v11, v14, s55, v108
    v_bitop3_b32 v12, v6, v13, v12 bitop3:0xca
    v_add_lshl_u32 v11, v11, s40, 17
    v_lshlrev_b16 v14, 8, v14
    v_lshrrev_b32 v13, 2, v112
    v_or_b32 v108, v12, v11
    v_bitop3_b32 v112, v5, v13, v14 bitop3:0xea
    ds_add_u32 v112, v2
    v_mul_hi_u32_u24 v14, 429497, v109
    v_lshrrev_b32 v12, 3, v113
    v_cos_f32 v8, v8
    v_lshlrev_b16 v13, 3, v113
    v_mad_i32_i24 v11, v14, s55, v109
    v_bitop3_b32 v12, v6, v13, v12 bitop3:0xca
    v_add_lshl_u32 v11, v11, s40, 17
    v_lshlrev_b16 v14, 8, v14
    v_lshrrev_b32 v13, 2, v113
    v_or_b32 v109, v12, v11
    v_bitop3_b32 v113, v5, v13, v14 bitop3:0xea
    ds_add_u32 v113, v2
    v_cvt_pk_bf16_f32 v86, v7, v8
    v_perm_b32 v12, v86, v86, s41
    v_bitop3_b32 v108, v4, v12, v108 bitop3:0xca
    v_perm_b32 v13, v86, v86, s42
    v_bitop3_b32 v109, v4, v13, v109 bitop3:0xca
    v_mul_hi_u32_u24 v14, 429497, v110
    v_lshrrev_b32 v12, 3, v114
    v_cos_f32 v9, v9
    v_lshlrev_b16 v13, 3, v114
    v_mad_i32_i24 v11, v14, s55, v110
    v_bitop3_b32 v12, v6, v13, v12 bitop3:0xca
    v_add_lshl_u32 v11, v11, s40, 17
    v_lshlrev_b16 v14, 8, v14
    v_lshrrev_b32 v13, 2, v114
    v_or_b32 v110, v12, v11
    v_bitop3_b32 v114, v5, v13, v14 bitop3:0xea
    ds_add_u32 v114, v2
    v_mul_hi_u32_u24 v14, 429497, v111
    v_lshrrev_b32 v12, 3, v115
    v_cos_f32 v10, v10
    v_lshlrev_b16 v13, 3, v115
    v_mad_i32_i24 v11, v14, s55, v111
    v_bitop3_b32 v12, v6, v13, v12 bitop3:0xca
    v_add_lshl_u32 v11, v11, s40, 17
    v_lshlrev_b16 v14, 8, v14
    v_lshrrev_b32 v13, 2, v115
    v_or_b32 v111, v12, v11
    v_bitop3_b32 v115, v5, v13, v14 bitop3:0xea
    ds_add_u32 v115, v2
    v_cvt_pk_bf16_f32 v87, v9, v10
    v_perm_b32 v12, v87, v87, s41
    v_bitop3_b32 v110, v4, v12, v110 bitop3:0xca
    v_perm_b32 v13, v87, v87, s42
    v_bitop3_b32 v111, v4, v13, v111 bitop3:0xca
    v_lshrrev_b32 v8, 2, v0
    v_and_b32 v7, 0x3c00, v0
    v_bitop3_b32 v7, v5, v8, v7 bitop3:0xea
    s_waitcnt lgkmcnt(0)
    s_barrier
    ds_read2st64_b32 v[8:9], v7 offset0:0 offset1:1
    ds_read2st64_b32 v[10:11], v7 offset0:2 offset1:3
    s_add_u32 s46, s35, 0x5498000
    buffer_store_dwordx4 v[20:23], v0, s[20:23], s46 offen sc1
    s_add_u32 s47, s38, 0x4000
    s_nop 0
    buffer_load_dwordx4 v[20:23], v0, s[12:15], s47 offen nt
    s_waitcnt lgkmcnt(0)
    v_lshl_or_b32 v12, v9, 16, v8
    v_lshl_or_b32 v13, v11, 16, v10
    v_mov_b32 v14, v12
    v_mov_b32 v15, v13
    s_nop 0
    v_add_u32_dpp v14, v14, v14 row_shr:1 row_mask:0xf bank_mask:0xf bound_ctrl:1
    v_add_u32_dpp v15, v15, v15 row_shr:1 row_mask:0xf bank_mask:0xf bound_ctrl:1
    s_nop 0
    v_add_u32_dpp v14, v14, v14 row_shr:2 row_mask:0xf bank_mask:0xf bound_ctrl:1
    v_add_u32_dpp v15, v15, v15 row_shr:2 row_mask:0xf bank_mask:0xf bound_ctrl:1
    s_nop 0
    v_add_u32_dpp v14, v14, v14 row_shr:4 row_mask:0xf bank_mask:0xf bound_ctrl:1
    v_add_u32_dpp v15, v15, v15 row_shr:4 row_mask:0xf bank_mask:0xf bound_ctrl:1
    s_nop 0
    v_add_u32_dpp v14, v14, v14 row_shr:8 row_mask:0xf bank_mask:0xf bound_ctrl:1
    v_add_u32_dpp v15, v15, v15 row_shr:8 row_mask:0xf bank_mask:0xf bound_ctrl:1
    s_nop 0
    v_add_u32_dpp v14, v14, v14 row_bcast:15 row_mask:0xa bank_mask:0xf
    v_add_u32_dpp v15, v15, v15 row_bcast:15 row_mask:0xa bank_mask:0xf
    s_nop 0
    v_add_u32_dpp v14, v14, v14 row_bcast:31 row_mask:0xc bank_mask:0xf
    v_add_u32_dpp v15, v15, v15 row_bcast:31 row_mask:0xc bank_mask:0xf
    v_readlane_b32 s48, v14, 63
    v_readlane_b32 s49, v15, 63
    s_lshl_b32 s54, s32, 2
    v_mov_b32 v8, s54
    s_and_b32 s50, s48, 0xffff
    s_lshr_b32 s51, s48, 16
    s_and_b32 s52, s49, 0xffff
    s_lshr_b32 s53, s49, 16
    s_add_u32 s51, s51, s50
    s_add_u32 s52, s52, s51
    s_add_u32 s53, s53, s52
    v_mov_b32 v9, s53
    s_mov_b64 exec, 1
    ds_write_b32 v8, v9 offset:16384
    s_waitcnt vmcnt(7)
    ds_write_b32 v8, v3 offset:16448
    s_mov_b64 exec, -1
    v_and_b32 v8, 60, v7
    s_waitcnt lgkmcnt(0)
    s_barrier
    ds_read_b32 v9, v8 offset:16384
    ds_read_b32 v10, v8 offset:16448
    s_waitcnt lgkmcnt(0)
    v_readlane_b32 s84, v10, 15
    s_min_u32 s4, s84, 136
    s_min_u32 s5, s84, 176
    s_min_u32 s6, s84, 216
    s_add_u32 s4, s4, s5
    s_add_u32 s4, s4, s6
    s_add_u32 s4, s4, 9467
    s_lshl_b32 s58, s4, 14
    s_lshl_b32 s59, s4, 13
    s_mov_b32 s43, 5
    s_cmp_lt_u32 s84, 136
    s_addc_u32 s43, s43, 0
    s_cmp_lt_u32 s84, 176
    s_addc_u32 s43, s43, 0
    s_cmp_lt_u32 s84, 216
    s_addc_u32 s43, s43, 0
    v_add_u32_dpp v9, v9, v9 row_shr:1 row_mask:0xf bank_mask:0xf bound_ctrl:1
    s_nop 1
    v_add_u32_dpp v9, v9, v9 row_shr:2 row_mask:0xf bank_mask:0xf bound_ctrl:1
    s_nop 1
    v_add_u32_dpp v9, v9, v9 row_shr:4 row_mask:0xf bank_mask:0xf bound_ctrl:1
    s_nop 1
    v_add_u32_dpp v9, v9, v9 row_shr:8 row_mask:0xf bank_mask:0xf bound_ctrl:1
    s_nop 0
    v_readlane_b32 s54, v9, s32
    s_sub_u32 s54, s54, s53
    s_add_u32 s50, s50, s54
    s_add_u32 s51, s51, s54
    s_add_u32 s52, s52, s54
    s_pack_ll_b32_b16 s48, s54, s50
    s_pack_ll_b32_b16 s49, s51, s52
    v_add_u32 v14, s48, v14
    v_add_u32 v15, s49, v15
    v_sub_u32 v12, v14, v12
    v_sub_u32 v13, v15, v13
    v_and_b32 v8, 0xffff, v12
    v_lshrrev_b32 v9, 16, v12
    v_and_b32 v10, 0xffff, v13
    v_lshrrev_b32 v11, 16, v13
    ds_write2st64_b32 v7, v8, v9 offset0:0 offset1:1
    ds_write2st64_b32 v7, v10, v11 offset0:2 offset1:3
    s_waitcnt lgkmcnt(0)
    s_barrier
    ds_add_rtn_u32 v40, v40, v2
    ds_add_rtn_u32 v41, v41, v2
    ds_add_rtn_u32 v42, v42, v2
    ds_add_rtn_u32 v43, v43, v2
    s_add_u32 s44, s36, 0x7ec0000
    v_and_b32 v11, 0x3f0, v0
    v_add_u32 v11, v11, v11
    buffer_store_dwordx2 v[12:13], v11, s[24:27], s44 offen
    s_bitset0_b64 exec, 63
    s_not_b64 exec, exec
    buffer_store_dwordx2 v[14:15], v11, s[24:27], s44 offen offset:32
    s_mov_b64 exec, -1
    ds_add_rtn_u32 v52, v52, v2
    ds_add_rtn_u32 v53, v53, v2
    ds_add_rtn_u32 v54, v54, v2
    ds_add_rtn_u32 v55, v55, v2
    ds_add_rtn_u32 v60, v60, v2
    ds_add_rtn_u32 v61, v61, v2
    ds_add_rtn_u32 v62, v62, v2
    ds_add_rtn_u32 v63, v63, v2
    s_add_u32 s45, s35, 0x549c000
    buffer_store_dwordx4 v[28:31], v0, s[20:23], s45 offen sc1
    s_add_u32 s46, s38, 0x8000
    s_nop 0
    buffer_load_dwordx4 v[28:31], v0, s[8:11], s46 offen nt
    ds_add_rtn_u32 v72, v72, v2
    ds_add_rtn_u32 v73, v73, v2
    ds_add_rtn_u32 v74, v74, v2
    ds_add_rtn_u32 v75, v75, v2
    ds_add_rtn_u32 v80, v80, v2
    ds_add_rtn_u32 v81, v81, v2
    ds_add_rtn_u32 v82, v82, v2
    ds_add_rtn_u32 v83, v83, v2
    s_add_u32 s47, s35, 0x54a0000
    buffer_store_dwordx4 v[32:35], v0, s[20:23], s47 offen sc1
    s_add_u32 s44, s38, 0x8000
    s_nop 0
    buffer_load_dwordx4 v[32:35], v0, s[12:15], s44 offen nt
    ds_add_rtn_u32 v92, v92, v2
    ds_add_rtn_u32 v93, v93, v2
    ds_add_rtn_u32 v94, v94, v2
    ds_add_rtn_u32 v95, v95, v2
    ds_add_rtn_u32 v100, v100, v2
    ds_add_rtn_u32 v101, v101, v2
    ds_add_rtn_u32 v102, v102, v2
    ds_add_rtn_u32 v103, v103, v2
    s_add_u32 s45, s35, 0x54a4000
    buffer_store_dwordx4 v[124:127], v0, s[20:23], s45 offen sc1
    s_add_u32 s46, s39, 0x4000
    s_nop 0
    buffer_load_dwordx2 v[124:125], v1, s[16:19], s46 offen nt
    s_add_u32 s47, s39, 0x6000
    buffer_load_dwordx2 v[126:127], v1, s[16:19], s47 offen nt
    ds_add_rtn_u32 v112, v112, v2
    ds_add_rtn_u32 v113, v113, v2
    ds_add_rtn_u32 v114, v114, v2
    ds_add_rtn_u32 v115, v115, v2
    s_waitcnt lgkmcnt(0)
    s_barrier
    v_and_b32 v7, -4, v40
    v_lshl_add_u32 v8, v40, 2, v7
    ds_write_b32 v8, v36
    v_lshl_add_u32 v7, v7, 2, v40
    ds_write_b8 v7, v24 offset:16
    v_and_b32 v9, -4, v41
    v_lshl_add_u32 v10, v41, 2, v9
    ds_write_b32 v10, v37
    v_lshl_add_u32 v9, v9, 2, v41
    ds_write_b8_d16_hi v9, v24 offset:16
    v_and_b32 v7, -4, v42
    v_lshl_add_u32 v8, v42, 2, v7
    ds_write_b32 v8, v38
    v_lshl_add_u32 v7, v7, 2, v42
    ds_write_b8 v7, v25 offset:16
    v_and_b32 v9, -4, v43
    v_lshl_add_u32 v10, v43, 2, v9
    ds_write_b32 v10, v39
    v_lshl_add_u32 v9, v9, 2, v43
    ds_write_b8_d16_hi v9, v25 offset:16
    s_add_u32 s44, s38, 0xc000
    buffer_load_dwordx4 v[36:39], v0, s[8:11], s44 offen nt
    s_add_u32 s45, s38, 0xc000
    buffer_load_dwordx4 v[40:43], v0, s[12:15], s45 offen nt
    v_and_b32 v7, -4, v52
    v_lshl_add_u32 v8, v52, 2, v7
    ds_write_b32 v8, v48
    v_lshl_add_u32 v7, v7, 2, v52
    ds_write_b8 v7, v26 offset:16
    v_and_b32 v9, -4, v53
    v_lshl_add_u32 v10, v53, 2, v9
    ds_write_b32 v10, v49
    v_lshl_add_u32 v9, v9, 2, v53
    ds_write_b8_d16_hi v9, v26 offset:16
    v_and_b32 v7, -4, v54
    v_lshl_add_u32 v8, v54, 2, v7
    ds_write_b32 v8, v50
    v_lshl_add_u32 v7, v7, 2, v54
    ds_write_b8 v7, v27 offset:16
    v_and_b32 v9, -4, v55
    v_lshl_add_u32 v10, v55, 2, v9
    ds_write_b32 v10, v51
    v_lshl_add_u32 v9, v9, 2, v55
    ds_write_b8_d16_hi v9, v27 offset:16
    s_add_u32 s46, s38, 0x10000
    buffer_load_dwordx4 v[48:51], v0, s[8:11], s46 offen nt
    v_and_b32 v7, -4, v60
    v_lshl_add_u32 v8, v60, 2, v7
    ds_write_b32 v8, v56
    v_lshl_add_u32 v7, v7, 2, v60
    ds_write_b8 v7, v44 offset:16
    v_and_b32 v9, -4, v61
    v_lshl_add_u32 v10, v61, 2, v9
    ds_write_b32 v10, v57
    v_lshl_add_u32 v9, v9, 2, v61
    ds_write_b8_d16_hi v9, v44 offset:16
    v_and_b32 v7, -4, v62
    v_lshl_add_u32 v8, v62, 2, v7
    ds_write_b32 v8, v58
    v_lshl_add_u32 v7, v7, 2, v62
    ds_write_b8 v7, v45 offset:16
    v_and_b32 v9, -4, v63
    v_lshl_add_u32 v10, v63, 2, v9
    ds_write_b32 v10, v59
    v_lshl_add_u32 v9, v9, 2, v63
    ds_write_b8_d16_hi v9, v45 offset:16
    s_add_u32 s47, s38, 0x10000
    buffer_load_dwordx4 v[52:55], v0, s[12:15], s47 offen nt
    v_and_b32 v7, -4, v72
    v_lshl_add_u32 v8, v72, 2, v7
    ds_write_b32 v8, v68
    v_lshl_add_u32 v7, v7, 2, v72
    ds_write_b8 v7, v46 offset:16
    v_and_b32 v9, -4, v73
    v_lshl_add_u32 v10, v73, 2, v9
    ds_write_b32 v10, v69
    v_lshl_add_u32 v9, v9, 2, v73
    ds_write_b8_d16_hi v9, v46 offset:16
    v_and_b32 v7, -4, v74
    v_lshl_add_u32 v8, v74, 2, v7
    ds_write_b32 v8, v70
    v_lshl_add_u32 v7, v7, 2, v74
    ds_write_b8 v7, v47 offset:16
    v_and_b32 v9, -4, v75
    v_lshl_add_u32 v10, v75, 2, v9
    ds_write_b32 v10, v71
    v_lshl_add_u32 v9, v9, 2, v75
    ds_write_b8_d16_hi v9, v47 offset:16
    s_add_u32 s44, s39, 0x8000
    buffer_load_dwordx2 v[24:25], v1, s[16:19], s44 offen nt
    s_cmp_le_u32 s43, 5
    s_cselect_b32 s18, 0, s18
    s_add_u32 s45, s59, 0xa000
    buffer_load_dwordx2 v[26:27], v1, s[16:19], s45 offen nt
    v_and_b32 v7, -4, v80
    v_lshl_add_u32 v8, v80, 2, v7
    ds_write_b32 v8, v76
    v_lshl_add_u32 v7, v7, 2, v80
    ds_write_b8 v7, v64 offset:16
    v_and_b32 v9, -4, v81
    v_lshl_add_u32 v10, v81, 2, v9
    ds_write_b32 v10, v77
    v_lshl_add_u32 v9, v9, 2, v81
    ds_write_b8_d16_hi v9, v64 offset:16
    v_and_b32 v7, -4, v82
    v_lshl_add_u32 v8, v82, 2, v7
    ds_write_b32 v8, v78
    v_lshl_add_u32 v7, v7, 2, v82
    ds_write_b8 v7, v65 offset:16
    v_and_b32 v9, -4, v83
    v_lshl_add_u32 v10, v83, 2, v9
    ds_write_b32 v10, v79
    v_lshl_add_u32 v9, v9, 2, v83
    ds_write_b8_d16_hi v9, v65 offset:16
    s_cmp_le_u32 s43, 5
    s_cselect_b32 s10, 0, s10
    s_add_u32 s46, s58, 0x14000
    buffer_load_dwordx4 v[56:59], v0, s[8:11], s46 offen nt
    s_cmp_le_u32 s43, 5
    s_cselect_b32 s14, 0, s14
    s_add_u32 s47, s58, 0x14000
    buffer_load_dwordx4 v[60:63], v0, s[12:15], s47 offen nt
    v_and_b32 v7, -4, v92
    v_lshl_add_u32 v8, v92, 2, v7
    ds_write_b32 v8, v88
    v_lshl_add_u32 v7, v7, 2, v92
    ds_write_b8 v7, v66 offset:16
    v_and_b32 v9, -4, v93
    v_lshl_add_u32 v10, v93, 2, v9
    ds_write_b32 v10, v89
    v_lshl_add_u32 v9, v9, 2, v93
    ds_write_b8_d16_hi v9, v66 offset:16
    v_and_b32 v7, -4, v94
    v_lshl_add_u32 v8, v94, 2, v7
    ds_write_b32 v8, v90
    v_lshl_add_u32 v7, v7, 2, v94
    ds_write_b8 v7, v67 offset:16
    v_and_b32 v9, -4, v95
    v_lshl_add_u32 v10, v95, 2, v9
    ds_write_b32 v10, v91
    v_lshl_add_u32 v9, v9, 2, v95
    ds_write_b8_d16_hi v9, v67 offset:16
    s_cmp_le_u32 s43, 6
    s_cselect_b32 s10, 0, s10
    s_add_u32 s44, s58, 0x18000
    buffer_load_dwordx4 v[68:71], v0, s[8:11], s44 offen nt
    v_and_b32 v7, -4, v100
    v_lshl_add_u32 v8, v100, 2, v7
    ds_write_b32 v8, v96
    v_lshl_add_u32 v7, v7, 2, v100
    ds_write_b8 v7, v84 offset:16
    v_and_b32 v9, -4, v101
    v_lshl_add_u32 v10, v101, 2, v9
    ds_write_b32 v10, v97
    v_lshl_add_u32 v9, v9, 2, v101
    ds_write_b8_d16_hi v9, v84 offset:16
    v_and_b32 v7, -4, v102
    v_lshl_add_u32 v8, v102, 2, v7
    ds_write_b32 v8, v98
    v_lshl_add_u32 v7, v7, 2, v102
    ds_write_b8 v7, v85 offset:16
    v_and_b32 v9, -4, v103
    v_lshl_add_u32 v10, v103, 2, v9
    ds_write_b32 v10, v99
    v_lshl_add_u32 v9, v9, 2, v103
    ds_write_b8_d16_hi v9, v85 offset:16
    s_cmp_le_u32 s43, 6
    s_cselect_b32 s14, 0, s14
    s_add_u32 s45, s58, 0x18000
    buffer_load_dwordx4 v[72:75], v0, s[12:15], s45 offen nt
    v_and_b32 v7, -4, v112
    v_lshl_add_u32 v8, v112, 2, v7
    ds_write_b32 v8, v108
    v_lshl_add_u32 v7, v7, 2, v112
    ds_write_b8 v7, v86 offset:16
    v_and_b32 v9, -4, v113
    v_lshl_add_u32 v10, v113, 2, v9
    ds_write_b32 v10, v109
    v_lshl_add_u32 v9, v9, 2, v113
    ds_write_b8_d16_hi v9, v86 offset:16
    v_and_b32 v7, -4, v114
    v_lshl_add_u32 v8, v114, 2, v7
    ds_write_b32 v8, v110
    v_lshl_add_u32 v7, v7, 2, v114
    ds_write_b8 v7, v87 offset:16
    v_and_b32 v9, -4, v115
    v_lshl_add_u32 v10, v115, 2, v9
    ds_write_b32 v10, v111
    v_lshl_add_u32 v9, v9, 2, v115
    ds_write_b8_d16_hi v9, v87 offset:16
    s_cmp_le_u32 s43, 6
    s_cselect_b32 s18, 0, s18
    s_add_u32 s46, s59, 0xc000
    buffer_load_dwordx2 v[44:45], v1, s[16:19], s46 offen nt
    s_cmp_le_u32 s43, 7
    s_cselect_b32 s18, 0, s18
    s_add_u32 s47, s59, 0xe000
    buffer_load_dwordx2 v[46:47], v1, s[16:19], s47 offen nt
    v_add_u32 v7, 0x10000, v0
    v_add_u32 v12, 0x20000, v0
    v_mov_b32 v8, 0
    v_mov_b32 v9, 0
    v_mov_b32 v10, 0
    v_mov_b32 v11, 0
    s_waitcnt lgkmcnt(0)
    s_barrier
    ds_read_b128 v[76:79], v0 offset:0
    ds_write_b128 v0, v[8:11]
    ds_read_b128 v[80:83], v0 offset:16384
    ds_read_b128 v[88:91], v0 offset:32768
    ds_read_b128 v[92:95], v0 offset:49152
    ds_read_b128 v[64:67], v7 offset:0
    ds_read_b128 v[96:99], v7 offset:16384
    ds_read_b128 v[100:103], v7 offset:32768
    ds_read_b128 v[108:111], v7 offset:49152
    ds_read_b128 v[112:115], v12 offset:0
    ds_read_b128 v[84:87], v12 offset:16384
    s_waitcnt lgkmcnt(0)
    s_barrier
    s_add_u32 s44, s35, 0x7ec0000
    buffer_store_dwordx4 v[76:79], v0, s[20:23], s44 offen sc1
    s_cmp_le_u32 s43, 7
    s_cselect_b32 s10, 0, s10
    s_add_u32 s45, s58, 0x1c000
    buffer_load_dwordx4 v[76:79], v0, s[8:11], s45 offen nt
    s_add_u32 s46, s35, 0x7ec4000
    buffer_store_dwordx4 v[80:83], v0, s[20:23], s46 offen sc1
    s_cmp_le_u32 s43, 7
    s_cselect_b32 s14, 0, s14
    s_add_u32 s47, s58, 0x1c000
    buffer_load_dwordx4 v[80:83], v0, s[12:15], s47 offen nt
    s_waitcnt vmcnt(29)
    v_lshlrev_b32 v7, 16, v104
    v_and_b32 v8, 0xffff0000, v104
    v_lshlrev_b32 v9, 16, v105
    v_and_b32 v10, 0xffff0000, v105
    v_mul_f32 v7, 0.15915494, v7
    v_mul_f32 v8, 0.15915494, v8
    v_mul_f32 v9, 0.15915494, v9
    v_mul_f32 v10, 0.15915494, v10
    v_mul_hi_u32_u24 v14, 429497, v116
    v_lshrrev_b32 v12, 3, v120
    v_cos_f32 v7, v7
    v_lshlrev_b16 v13, 3, v120
    v_mad_i32_i24 v11, v14, s55, v116
    v_bitop3_b32 v12, v6, v13, v12 bitop3:0xca
    v_add_lshl_u32 v11, v11, s40, 17
    v_lshlrev_b16 v14, 8, v14
    v_lshrrev_b32 v13, 2, v120
    v_or_b32 v116, v12, v11
    v_bitop3_b32 v120, v5, v13, v14 bitop3:0xea
    ds_add_u32 v120, v2
    v_mul_hi_u32_u24 v14, 429497, v117
    v_lshrrev_b32 v12, 3, v121
    v_cos_f32 v8, v8
    v_lshlrev_b16 v13, 3, v121
    v_mad_i32_i24 v11, v14, s55, v117
    v_bitop3_b32 v12, v6, v13, v12 bitop3:0xca
    v_add_lshl_u32 v11, v11, s40, 17
    v_lshlrev_b16 v14, 8, v14
    v_lshrrev_b32 v13, 2, v121
    v_or_b32 v117, v12, v11
    v_bitop3_b32 v121, v5, v13, v14 bitop3:0xea
    ds_add_u32 v121, v2
    v_cvt_pk_bf16_f32 v104, v7, v8
    v_perm_b32 v12, v104, v104, s41
    v_bitop3_b32 v116, v4, v12, v116 bitop3:0xca
    v_perm_b32 v13, v104, v104, s42
    v_bitop3_b32 v117, v4, v13, v117 bitop3:0xca
    v_mul_hi_u32_u24 v14, 429497, v118
    v_lshrrev_b32 v12, 3, v122
    v_cos_f32 v9, v9
    v_lshlrev_b16 v13, 3, v122
    v_mad_i32_i24 v11, v14, s55, v118
    v_bitop3_b32 v12, v6, v13, v12 bitop3:0xca
    v_add_lshl_u32 v11, v11, s40, 17
    v_lshlrev_b16 v14, 8, v14
    v_lshrrev_b32 v13, 2, v122
    v_or_b32 v118, v12, v11
    v_bitop3_b32 v122, v5, v13, v14 bitop3:0xea
    ds_add_u32 v122, v2
    v_mul_hi_u32_u24 v14, 429497, v119
    v_lshrrev_b32 v12, 3, v123
    v_cos_f32 v10, v10
    v_lshlrev_b16 v13, 3, v123
    v_mad_i32_i24 v11, v14, s55, v119
    v_bitop3_b32 v12, v6, v13, v12 bitop3:0xca
    v_add_lshl_u32 v11, v11, s40, 17
    v_lshlrev_b16 v14, 8, v14
    v_lshrrev_b32 v13, 2, v123
    v_or_b32 v119, v12, v11
    v_bitop3_b32 v123, v5, v13, v14 bitop3:0xea
    ds_add_u32 v123, v2
    v_cvt_pk_bf16_f32 v105, v9, v10
    v_perm_b32 v12, v105, v105, s41
    v_bitop3_b32 v118, v4, v12, v118 bitop3:0xca
    v_perm_b32 v13, v105, v105, s42
    v_bitop3_b32 v119, v4, v13, v119 bitop3:0xca
    s_add_u32 s44, s35, 0x7ec8000
    buffer_store_dwordx4 v[88:91], v0, s[20:23], s44 offen sc1
    s_waitcnt vmcnt(26)
    v_lshlrev_b32 v7, 16, v106
    v_and_b32 v8, 0xffff0000, v106
    v_lshlrev_b32 v9, 16, v107
    v_and_b32 v10, 0xffff0000, v107
    v_mul_f32 v7, 0.15915494, v7
    v_mul_f32 v8, 0.15915494, v8
    v_mul_f32 v9, 0.15915494, v9
    v_mul_f32 v10, 0.15915494, v10
    v_mul_hi_u32_u24 v14, 429497, v16
    v_lshrrev_b32 v12, 3, v20
    v_cos_f32 v7, v7
    v_lshlrev_b16 v13, 3, v20
    v_mad_i32_i24 v11, v14, s55, v16
    v_bitop3_b32 v12, v6, v13, v12 bitop3:0xca
    v_add_lshl_u32 v11, v11, s40, 17
    v_lshlrev_b16 v14, 8, v14
    v_lshrrev_b32 v13, 2, v20
    v_or_b32 v16, v12, v11
    v_bitop3_b32 v20, v5, v13, v14 bitop3:0xea
    ds_add_u32 v20, v2
    v_mul_hi_u32_u24 v14, 429497, v17
    v_lshrrev_b32 v12, 3, v21
    v_cos_f32 v8, v8
    v_lshlrev_b16 v13, 3, v21
    v_mad_i32_i24 v11, v14, s55, v17
    v_bitop3_b32 v12, v6, v13, v12 bitop3:0xca
    v_add_lshl_u32 v11, v11, s40, 17
    v_lshlrev_b16 v14, 8, v14
    v_lshrrev_b32 v13, 2, v21
    v_or_b32 v17, v12, v11
    v_bitop3_b32 v21, v5, v13, v14 bitop3:0xea
    ds_add_u32 v21, v2
    v_cvt_pk_bf16_f32 v106, v7, v8
    v_perm_b32 v12, v106, v106, s41
    v_bitop3_b32 v16, v4, v12, v16 bitop3:0xca
    v_perm_b32 v13, v106, v106, s42
    v_bitop3_b32 v17, v4, v13, v17 bitop3:0xca
    v_mul_hi_u32_u24 v14, 429497, v18
    v_lshrrev_b32 v12, 3, v22
    v_cos_f32 v9, v9
    v_lshlrev_b16 v13, 3, v22
    v_mad_i32_i24 v11, v14, s55, v18
    v_bitop3_b32 v12, v6, v13, v12 bitop3:0xca
    v_add_lshl_u32 v11, v11, s40, 17
    v_lshlrev_b16 v14, 8, v14
    v_lshrrev_b32 v13, 2, v22
    v_or_b32 v18, v12, v11
    v_bitop3_b32 v22, v5, v13, v14 bitop3:0xea
    ds_add_u32 v22, v2
    v_mul_hi_u32_u24 v14, 429497, v19
    v_lshrrev_b32 v12, 3, v23
    v_cos_f32 v10, v10
    v_lshlrev_b16 v13, 3, v23
    v_mad_i32_i24 v11, v14, s55, v19
    v_bitop3_b32 v12, v6, v13, v12 bitop3:0xca
    v_add_lshl_u32 v11, v11, s40, 17
    v_lshlrev_b16 v14, 8, v14
    v_lshrrev_b32 v13, 2, v23
    v_or_b32 v19, v12, v11
    v_bitop3_b32 v23, v5, v13, v14 bitop3:0xea
    ds_add_u32 v23, v2
    v_cvt_pk_bf16_f32 v107, v9, v10
    v_perm_b32 v12, v107, v107, s41
    v_bitop3_b32 v18, v4, v12, v18 bitop3:0xca
    v_perm_b32 v13, v107, v107, s42
    v_bitop3_b32 v19, v4, v13, v19 bitop3:0xca
    s_waitcnt vmcnt(17)
    v_lshlrev_b32 v7, 16, v124
    v_and_b32 v8, 0xffff0000, v124
    v_lshlrev_b32 v9, 16, v125
    v_and_b32 v10, 0xffff0000, v125
    v_mul_f32 v7, 0.15915494, v7
    v_mul_f32 v8, 0.15915494, v8
    v_mul_f32 v9, 0.15915494, v9
    v_mul_f32 v10, 0.15915494, v10
    v_mul_hi_u32_u24 v14, 429497, v28
    v_lshrrev_b32 v12, 3, v32
    v_cos_f32 v7, v7
    v_lshlrev_b16 v13, 3, v32
    v_mad_i32_i24 v11, v14, s55, v28
    v_bitop3_b32 v12, v6, v13, v12 bitop3:0xca
    v_add_lshl_u32 v11, v11, s40, 17
    v_lshlrev_b16 v14, 8, v14
    v_lshrrev_b32 v13, 2, v32
    v_or_b32 v28, v12, v11
    v_bitop3_b32 v32, v5, v13, v14 bitop3:0xea
    ds_add_u32 v32, v2
    v_mul_hi_u32_u24 v14, 429497, v29
    v_lshrrev_b32 v12, 3, v33
    v_cos_f32 v8, v8
    v_lshlrev_b16 v13, 3, v33
    v_mad_i32_i24 v11, v14, s55, v29
    v_bitop3_b32 v12, v6, v13, v12 bitop3:0xca
    v_add_lshl_u32 v11, v11, s40, 17
    v_lshlrev_b16 v14, 8, v14
    v_lshrrev_b32 v13, 2, v33
    v_or_b32 v29, v12, v11
    v_bitop3_b32 v33, v5, v13, v14 bitop3:0xea
    ds_add_u32 v33, v2
    v_cvt_pk_bf16_f32 v124, v7, v8
    v_perm_b32 v12, v124, v124, s41
    v_bitop3_b32 v28, v4, v12, v28 bitop3:0xca
    v_perm_b32 v13, v124, v124, s42
    v_bitop3_b32 v29, v4, v13, v29 bitop3:0xca
    v_mul_hi_u32_u24 v14, 429497, v30
    v_lshrrev_b32 v12, 3, v34
    v_cos_f32 v9, v9
    v_lshlrev_b16 v13, 3, v34
    v_mad_i32_i24 v11, v14, s55, v30
    v_bitop3_b32 v12, v6, v13, v12 bitop3:0xca
    v_add_lshl_u32 v11, v11, s40, 17
    v_lshlrev_b16 v14, 8, v14
    v_lshrrev_b32 v13, 2, v34
    v_or_b32 v30, v12, v11
    v_bitop3_b32 v34, v5, v13, v14 bitop3:0xea
    ds_add_u32 v34, v2
    v_mul_hi_u32_u24 v14, 429497, v31
    v_lshrrev_b32 v12, 3, v35
    v_cos_f32 v10, v10
    v_lshlrev_b16 v13, 3, v35
    v_mad_i32_i24 v11, v14, s55, v31
    v_bitop3_b32 v12, v6, v13, v12 bitop3:0xca
    v_add_lshl_u32 v11, v11, s40, 17
    v_lshlrev_b16 v14, 8, v14
    v_lshrrev_b32 v13, 2, v35
    v_or_b32 v31, v12, v11
    v_bitop3_b32 v35, v5, v13, v14 bitop3:0xea
    ds_add_u32 v35, v2
    v_cvt_pk_bf16_f32 v125, v9, v10
    v_perm_b32 v12, v125, v125, s41
    v_bitop3_b32 v30, v4, v12, v30 bitop3:0xca
    v_perm_b32 v13, v125, v125, s42
    v_bitop3_b32 v31, v4, v13, v31 bitop3:0xca
    s_waitcnt vmcnt(15)
    v_lshlrev_b32 v7, 16, v126
    v_and_b32 v8, 0xffff0000, v126
    v_lshlrev_b32 v9, 16, v127
    v_and_b32 v10, 0xffff0000, v127
    v_mul_f32 v7, 0.15915494, v7
    v_mul_f32 v8, 0.15915494, v8
    v_mul_f32 v9, 0.15915494, v9
    v_mul_f32 v10, 0.15915494, v10
    v_mul_hi_u32_u24 v14, 429497, v36
    v_lshrrev_b32 v12, 3, v40
    v_cos_f32 v7, v7
    v_lshlrev_b16 v13, 3, v40
    v_mad_i32_i24 v11, v14, s55, v36
    v_bitop3_b32 v12, v6, v13, v12 bitop3:0xca
    v_add_lshl_u32 v11, v11, s40, 17
    v_lshlrev_b16 v14, 8, v14
    v_lshrrev_b32 v13, 2, v40
    v_or_b32 v36, v12, v11
    v_bitop3_b32 v40, v5, v13, v14 bitop3:0xea
    ds_add_u32 v40, v2
    v_mul_hi_u32_u24 v14, 429497, v37
    v_lshrrev_b32 v12, 3, v41
    v_cos_f32 v8, v8
    v_lshlrev_b16 v13, 3, v41
    v_mad_i32_i24 v11, v14, s55, v37
    v_bitop3_b32 v12, v6, v13, v12 bitop3:0xca
    v_add_lshl_u32 v11, v11, s40, 17
    v_lshlrev_b16 v14, 8, v14
    v_lshrrev_b32 v13, 2, v41
    v_or_b32 v37, v12, v11
    v_bitop3_b32 v41, v5, v13, v14 bitop3:0xea
    ds_add_u32 v41, v2
    v_cvt_pk_bf16_f32 v126, v7, v8
    v_perm_b32 v12, v126, v126, s41
    v_bitop3_b32 v36, v4, v12, v36 bitop3:0xca
    v_perm_b32 v13, v126, v126, s42
    v_bitop3_b32 v37, v4, v13, v37 bitop3:0xca
    v_mul_hi_u32_u24 v14, 429497, v38
    v_lshrrev_b32 v12, 3, v42
    v_cos_f32 v9, v9
    v_lshlrev_b16 v13, 3, v42
    v_mad_i32_i24 v11, v14, s55, v38
    v_bitop3_b32 v12, v6, v13, v12 bitop3:0xca
    v_add_lshl_u32 v11, v11, s40, 17
    v_lshlrev_b16 v14, 8, v14
    v_lshrrev_b32 v13, 2, v42
    v_or_b32 v38, v12, v11
    v_bitop3_b32 v42, v5, v13, v14 bitop3:0xea
    ds_add_u32 v42, v2
    v_mul_hi_u32_u24 v14, 429497, v39
    v_lshrrev_b32 v12, 3, v43
    v_cos_f32 v10, v10
    v_lshlrev_b16 v13, 3, v43
    v_mad_i32_i24 v11, v14, s55, v39
    v_bitop3_b32 v12, v6, v13, v12 bitop3:0xca
    v_add_lshl_u32 v11, v11, s40, 17
    v_lshlrev_b16 v14, 8, v14
    v_lshrrev_b32 v13, 2, v43
    v_or_b32 v39, v12, v11
    v_bitop3_b32 v43, v5, v13, v14 bitop3:0xea
    ds_add_u32 v43, v2
    v_cvt_pk_bf16_f32 v127, v9, v10
    v_perm_b32 v12, v127, v127, s41
    v_bitop3_b32 v38, v4, v12, v38 bitop3:0xca
    v_perm_b32 v13, v127, v127, s42
    v_bitop3_b32 v39, v4, v13, v39 bitop3:0xca
    s_add_u32 s45, s35, 0x7ecc000
    buffer_store_dwordx4 v[92:95], v0, s[20:23], s45 offen sc1
    buffer_load_dwordx4 v[88:91], v0, s[80:83], 0 offen
    v_add_u32 v15, 0x4000, v0
    buffer_load_dwordx4 v[88:91], v15, s[80:83], 0 offen
    s_waitcnt vmcnt(14)
    v_lshlrev_b32 v7, 16, v24
    v_and_b32 v8, 0xffff0000, v24
    v_lshlrev_b32 v9, 16, v25
    v_and_b32 v10, 0xffff0000, v25
    v_mul_f32 v7, 0.15915494, v7
    v_mul_f32 v8, 0.15915494, v8
    v_mul_f32 v9, 0.15915494, v9
    v_mul_f32 v10, 0.15915494, v10
    v_mul_hi_u32_u24 v14, 429497, v48
    v_lshrrev_b32 v12, 3, v52
    v_cos_f32 v7, v7
    v_lshlrev_b16 v13, 3, v52
    v_mad_i32_i24 v11, v14, s55, v48
    v_bitop3_b32 v12, v6, v13, v12 bitop3:0xca
    v_add_lshl_u32 v11, v11, s40, 17
    v_lshlrev_b16 v14, 8, v14
    v_lshrrev_b32 v13, 2, v52
    v_or_b32 v48, v12, v11
    v_bitop3_b32 v52, v5, v13, v14 bitop3:0xea
    ds_add_u32 v52, v2
    v_mul_hi_u32_u24 v14, 429497, v49
    v_lshrrev_b32 v12, 3, v53
    v_cos_f32 v8, v8
    v_lshlrev_b16 v13, 3, v53
    v_mad_i32_i24 v11, v14, s55, v49
    v_bitop3_b32 v12, v6, v13, v12 bitop3:0xca
    v_add_lshl_u32 v11, v11, s40, 17
    v_lshlrev_b16 v14, 8, v14
    v_lshrrev_b32 v13, 2, v53
    v_or_b32 v49, v12, v11
    v_bitop3_b32 v53, v5, v13, v14 bitop3:0xea
    ds_add_u32 v53, v2
    v_cvt_pk_bf16_f32 v24, v7, v8
    v_perm_b32 v12, v24, v24, s41
    v_bitop3_b32 v48, v4, v12, v48 bitop3:0xca
    v_perm_b32 v13, v24, v24, s42
    v_bitop3_b32 v49, v4, v13, v49 bitop3:0xca
    v_mul_hi_u32_u24 v14, 429497, v50
    v_lshrrev_b32 v12, 3, v54
    v_cos_f32 v9, v9
    v_lshlrev_b16 v13, 3, v54
    v_mad_i32_i24 v11, v14, s55, v50
    v_bitop3_b32 v12, v6, v13, v12 bitop3:0xca
    v_add_lshl_u32 v11, v11, s40, 17
    v_lshlrev_b16 v14, 8, v14
    v_lshrrev_b32 v13, 2, v54
    v_or_b32 v50, v12, v11
    v_bitop3_b32 v54, v5, v13, v14 bitop3:0xea
    ds_add_u32 v54, v2
    v_mul_hi_u32_u24 v14, 429497, v51
    v_lshrrev_b32 v12, 3, v55
    v_cos_f32 v10, v10
    v_lshlrev_b16 v13, 3, v55
    v_mad_i32_i24 v11, v14, s55, v51
    v_bitop3_b32 v12, v6, v13, v12 bitop3:0xca
    v_add_lshl_u32 v11, v11, s40, 17
    v_lshlrev_b16 v14, 8, v14
    v_lshrrev_b32 v13, 2, v55
    v_or_b32 v51, v12, v11
    v_bitop3_b32 v55, v5, v13, v14 bitop3:0xea
    ds_add_u32 v55, v2
    v_cvt_pk_bf16_f32 v25, v9, v10
    v_perm_b32 v12, v25, v25, s41
    v_bitop3_b32 v50, v4, v12, v50 bitop3:0xca
    v_perm_b32 v13, v25, v25, s42
    v_bitop3_b32 v51, v4, v13, v51 bitop3:0xca
    s_waitcnt vmcnt(12)
    s_cmp_le_u32 s43, 5
    s_cbranch_scc1 L1_s1
    v_lshlrev_b32 v7, 16, v26
    v_and_b32 v8, 0xffff0000, v26
    v_lshlrev_b32 v9, 16, v27
    v_and_b32 v10, 0xffff0000, v27
    v_mul_f32 v7, 0.15915494, v7
    v_mul_f32 v8, 0.15915494, v8
    v_mul_f32 v9, 0.15915494, v9
    v_mul_f32 v10, 0.15915494, v10
    v_mul_hi_u32_u24 v14, 429497, v56
    v_lshrrev_b32 v12, 3, v60
    v_cos_f32 v7, v7
    v_lshlrev_b16 v13, 3, v60
    v_mad_i32_i24 v11, v14, s55, v56
    v_bitop3_b32 v12, v6, v13, v12 bitop3:0xca
    v_add_lshl_u32 v11, v11, s40, 17
    v_lshlrev_b16 v14, 8, v14
    v_lshrrev_b32 v13, 2, v60
    v_or_b32 v56, v12, v11
    v_bitop3_b32 v60, v5, v13, v14 bitop3:0xea
    ds_add_u32 v60, v2
    v_mul_hi_u32_u24 v14, 429497, v57
    v_lshrrev_b32 v12, 3, v61
    v_cos_f32 v8, v8
    v_lshlrev_b16 v13, 3, v61
    v_mad_i32_i24 v11, v14, s55, v57
    v_bitop3_b32 v12, v6, v13, v12 bitop3:0xca
    v_add_lshl_u32 v11, v11, s40, 17
    v_lshlrev_b16 v14, 8, v14
    v_lshrrev_b32 v13, 2, v61
    v_or_b32 v57, v12, v11
    v_bitop3_b32 v61, v5, v13, v14 bitop3:0xea
    ds_add_u32 v61, v2
    v_cvt_pk_bf16_f32 v26, v7, v8
    v_perm_b32 v12, v26, v26, s41
    v_bitop3_b32 v56, v4, v12, v56 bitop3:0xca
    v_perm_b32 v13, v26, v26, s42
    v_bitop3_b32 v57, v4, v13, v57 bitop3:0xca
    v_mul_hi_u32_u24 v14, 429497, v58
    v_lshrrev_b32 v12, 3, v62
    v_cos_f32 v9, v9
    v_lshlrev_b16 v13, 3, v62
    v_mad_i32_i24 v11, v14, s55, v58
    v_bitop3_b32 v12, v6, v13, v12 bitop3:0xca
    v_add_lshl_u32 v11, v11, s40, 17
    v_lshlrev_b16 v14, 8, v14
    v_lshrrev_b32 v13, 2, v62
    v_or_b32 v58, v12, v11
    v_bitop3_b32 v62, v5, v13, v14 bitop3:0xea
    ds_add_u32 v62, v2
    v_mul_hi_u32_u24 v14, 429497, v59
    v_lshrrev_b32 v12, 3, v63
    v_cos_f32 v10, v10
    v_lshlrev_b16 v13, 3, v63
    v_mad_i32_i24 v11, v14, s55, v59
    v_bitop3_b32 v12, v6, v13, v12 bitop3:0xca
    v_add_lshl_u32 v11, v11, s40, 17
    v_lshlrev_b16 v14, 8, v14
    v_lshrrev_b32 v13, 2, v63
    v_or_b32 v59, v12, v11
    v_bitop3_b32 v63, v5, v13, v14 bitop3:0xea
    ds_add_u32 v63, v2
    v_cvt_pk_bf16_f32 v27, v9, v10
    v_perm_b32 v12, v27, v27, s41
    v_bitop3_b32 v58, v4, v12, v58 bitop3:0xca
    v_perm_b32 v13, v27, v27, s42
    v_bitop3_b32 v59, v4, v13, v59 bitop3:0xca
L1_s1:
    s_waitcnt vmcnt(8)
    s_cmp_le_u32 s43, 6
    s_cbranch_scc1 L1_s2
    v_lshlrev_b32 v7, 16, v44
    v_and_b32 v8, 0xffff0000, v44
    v_lshlrev_b32 v9, 16, v45
    v_and_b32 v10, 0xffff0000, v45
    v_mul_f32 v7, 0.15915494, v7
    v_mul_f32 v8, 0.15915494, v8
    v_mul_f32 v9, 0.15915494, v9
    v_mul_f32 v10, 0.15915494, v10
    v_mul_hi_u32_u24 v14, 429497, v68
    v_lshrrev_b32 v12, 3, v72
    v_cos_f32 v7, v7
    v_lshlrev_b16 v13, 3, v72
    v_mad_i32_i24 v11, v14, s55, v68
    v_bitop3_b32 v12, v6, v13, v12 bitop3:0xca
    v_add_lshl_u32 v11, v11, s40, 17
    v_lshlrev_b16 v14, 8, v14
    v_lshrrev_b32 v13, 2, v72
    v_or_b32 v68, v12, v11
    v_bitop3_b32 v72, v5, v13, v14 bitop3:0xea
    ds_add_u32 v72, v2
    v_mul_hi_u32_u24 v14, 429497, v69
    v_lshrrev_b32 v12, 3, v73
    v_cos_f32 v8, v8
    v_lshlrev_b16 v13, 3, v73
    v_mad_i32_i24 v11, v14, s55, v69
    v_bitop3_b32 v12, v6, v13, v12 bitop3:0xca
    v_add_lshl_u32 v11, v11, s40, 17
    v_lshlrev_b16 v14, 8, v14
    v_lshrrev_b32 v13, 2, v73
    v_or_b32 v69, v12, v11
    v_bitop3_b32 v73, v5, v13, v14 bitop3:0xea
    ds_add_u32 v73, v2
    v_cvt_pk_bf16_f32 v44, v7, v8
    v_perm_b32 v12, v44, v44, s41
    v_bitop3_b32 v68, v4, v12, v68 bitop3:0xca
    v_perm_b32 v13, v44, v44, s42
    v_bitop3_b32 v69, v4, v13, v69 bitop3:0xca
    v_mul_hi_u32_u24 v14, 429497, v70
    v_lshrrev_b32 v12, 3, v74
    v_cos_f32 v9, v9
    v_lshlrev_b16 v13, 3, v74
    v_mad_i32_i24 v11, v14, s55, v70
    v_bitop3_b32 v12, v6, v13, v12 bitop3:0xca
    v_add_lshl_u32 v11, v11, s40, 17
    v_lshlrev_b16 v14, 8, v14
    v_lshrrev_b32 v13, 2, v74
    v_or_b32 v70, v12, v11
    v_bitop3_b32 v74, v5, v13, v14 bitop3:0xea
    ds_add_u32 v74, v2
    v_mul_hi_u32_u24 v14, 429497, v71
    v_lshrrev_b32 v12, 3, v75
    v_cos_f32 v10, v10
    v_lshlrev_b16 v13, 3, v75
    v_mad_i32_i24 v11, v14, s55, v71
    v_bitop3_b32 v12, v6, v13, v12 bitop3:0xca
    v_add_lshl_u32 v11, v11, s40, 17
    v_lshlrev_b16 v14, 8, v14
    v_lshrrev_b32 v13, 2, v75
    v_or_b32 v71, v12, v11
    v_bitop3_b32 v75, v5, v13, v14 bitop3:0xea
    ds_add_u32 v75, v2
    v_cvt_pk_bf16_f32 v45, v9, v10
    v_perm_b32 v12, v45, v45, s41
    v_bitop3_b32 v70, v4, v12, v70 bitop3:0xca
    v_perm_b32 v13, v45, v45, s42
    v_bitop3_b32 v71, v4, v13, v71 bitop3:0xca
L1_s2:
    s_waitcnt vmcnt(4)
    s_cmp_le_u32 s43, 7
    s_cbranch_scc1 L1_s3
    v_lshlrev_b32 v7, 16, v46
    v_and_b32 v8, 0xffff0000, v46
    v_lshlrev_b32 v9, 16, v47
    v_and_b32 v10, 0xffff0000, v47
    v_mul_f32 v7, 0.15915494, v7
    v_mul_f32 v8, 0.15915494, v8
    v_mul_f32 v9, 0.15915494, v9
    v_mul_f32 v10, 0.15915494, v10
    v_mul_hi_u32_u24 v14, 429497, v76
    v_lshrrev_b32 v12, 3, v80
    v_cos_f32 v7, v7
    v_lshlrev_b16 v13, 3, v80
    v_mad_i32_i24 v11, v14, s55, v76
    v_bitop3_b32 v12, v6, v13, v12 bitop3:0xca
    v_add_lshl_u32 v11, v11, s40, 17
    v_lshlrev_b16 v14, 8, v14
    v_lshrrev_b32 v13, 2, v80
    v_or_b32 v76, v12, v11
    v_bitop3_b32 v80, v5, v13, v14 bitop3:0xea
    ds_add_u32 v80, v2
    v_mul_hi_u32_u24 v14, 429497, v77
    v_lshrrev_b32 v12, 3, v81
    v_cos_f32 v8, v8
    v_lshlrev_b16 v13, 3, v81
    v_mad_i32_i24 v11, v14, s55, v77
    v_bitop3_b32 v12, v6, v13, v12 bitop3:0xca
    v_add_lshl_u32 v11, v11, s40, 17
    v_lshlrev_b16 v14, 8, v14
    v_lshrrev_b32 v13, 2, v81
    v_or_b32 v77, v12, v11
    v_bitop3_b32 v81, v5, v13, v14 bitop3:0xea
    ds_add_u32 v81, v2
    v_cvt_pk_bf16_f32 v46, v7, v8
    v_perm_b32 v12, v46, v46, s41
    v_bitop3_b32 v76, v4, v12, v76 bitop3:0xca
    v_perm_b32 v13, v46, v46, s42
    v_bitop3_b32 v77, v4, v13, v77 bitop3:0xca
    v_mul_hi_u32_u24 v14, 429497, v78
    v_lshrrev_b32 v12, 3, v82
    v_cos_f32 v9, v9
    v_lshlrev_b16 v13, 3, v82
    v_mad_i32_i24 v11, v14, s55, v78
    v_bitop3_b32 v12, v6, v13, v12 bitop3:0xca
    v_add_lshl_u32 v11, v11, s40, 17
    v_lshlrev_b16 v14, 8, v14
    v_lshrrev_b32 v13, 2, v82
    v_or_b32 v78, v12, v11
    v_bitop3_b32 v82, v5, v13, v14 bitop3:0xea
    ds_add_u32 v82, v2
    v_mul_hi_u32_u24 v14, 429497, v79
    v_lshrrev_b32 v12, 3, v83
    v_cos_f32 v10, v10
    v_lshlrev_b16 v13, 3, v83
    v_mad_i32_i24 v11, v14, s55, v79
    v_bitop3_b32 v12, v6, v13, v12 bitop3:0xca
    v_add_lshl_u32 v11, v11, s40, 17
    v_lshlrev_b16 v14, 8, v14
    v_lshrrev_b32 v13, 2, v83
    v_or_b32 v79, v12, v11
    v_bitop3_b32 v83, v5, v13, v14 bitop3:0xea
    ds_add_u32 v83, v2
    v_cvt_pk_bf16_f32 v47, v9, v10
    v_perm_b32 v12, v47, v47, s41
    v_bitop3_b32 v78, v4, v12, v78 bitop3:0xca
    v_perm_b32 v13, v47, v47, s42
    v_bitop3_b32 v79, v4, v13, v79 bitop3:0xca
L1_s3:
    v_lshrrev_b32 v8, 2, v0
    v_and_b32 v7, 0x3c00, v0
    v_bitop3_b32 v7, v5, v8, v7 bitop3:0xea
    s_waitcnt lgkmcnt(0)
    s_barrier
    ds_read2st64_b32 v[8:9], v7 offset0:0 offset1:1
    ds_read2st64_b32 v[10:11], v7 offset0:2 offset1:3
    s_add_u32 s46, s35, 0x7ed0000
    buffer_store_dwordx4 v[64:67], v0, s[20:23], s46 offen sc1
    s_waitcnt lgkmcnt(0)
    v_lshl_or_b32 v12, v9, 16, v8
    v_lshl_or_b32 v13, v11, 16, v10
    v_mov_b32 v14, v12
    v_mov_b32 v15, v13
    s_nop 0
    v_add_u32_dpp v14, v14, v14 row_shr:1 row_mask:0xf bank_mask:0xf bound_ctrl:1
    v_add_u32_dpp v15, v15, v15 row_shr:1 row_mask:0xf bank_mask:0xf bound_ctrl:1
    s_nop 0
    v_add_u32_dpp v14, v14, v14 row_shr:2 row_mask:0xf bank_mask:0xf bound_ctrl:1
    v_add_u32_dpp v15, v15, v15 row_shr:2 row_mask:0xf bank_mask:0xf bound_ctrl:1
    s_nop 0
    v_add_u32_dpp v14, v14, v14 row_shr:4 row_mask:0xf bank_mask:0xf bound_ctrl:1
    v_add_u32_dpp v15, v15, v15 row_shr:4 row_mask:0xf bank_mask:0xf bound_ctrl:1
    s_nop 0
    v_add_u32_dpp v14, v14, v14 row_shr:8 row_mask:0xf bank_mask:0xf bound_ctrl:1
    v_add_u32_dpp v15, v15, v15 row_shr:8 row_mask:0xf bank_mask:0xf bound_ctrl:1
    s_nop 0
    v_add_u32_dpp v14, v14, v14 row_bcast:15 row_mask:0xa bank_mask:0xf
    v_add_u32_dpp v15, v15, v15 row_bcast:15 row_mask:0xa bank_mask:0xf
    s_nop 0
    v_add_u32_dpp v14, v14, v14 row_bcast:31 row_mask:0xc bank_mask:0xf
    v_add_u32_dpp v15, v15, v15 row_bcast:31 row_mask:0xc bank_mask:0xf
    v_readlane_b32 s48, v14, 63
    v_readlane_b32 s49, v15, 63
    s_lshl_b32 s54, s32, 2
    v_mov_b32 v8, s54
    s_and_b32 s50, s48, 0xffff
    s_lshr_b32 s51, s48, 16
    s_and_b32 s52, s49, 0xffff
    s_lshr_b32 s53, s49, 16
    s_add_u32 s51, s51, s50
    s_add_u32 s52, s52, s51
    s_add_u32 s53, s53, s52
    v_mov_b32 v9, s53
    s_mov_b64 exec, 1
    ds_write_b32 v8, v9 offset:16384
    s_mov_b64 exec, -1
    v_and_b32 v8, 60, v7
    s_waitcnt lgkmcnt(0)
    s_barrier
    ds_read_b32 v9, v8 offset:16384
    s_waitcnt lgkmcnt(0)
    v_add_u32_dpp v9, v9, v9 row_shr:1 row_mask:0xf bank_mask:0xf bound_ctrl:1
    s_nop 1
    v_add_u32_dpp v9, v9, v9 row_shr:2 row_mask:0xf bank_mask:0xf bound_ctrl:1
    s_nop 1
    v_add_u32_dpp v9, v9, v9 row_shr:4 row_mask:0xf bank_mask:0xf bound_ctrl:1
    s_nop 1
    v_add_u32_dpp v9, v9, v9 row_shr:8 row_mask:0xf bank_mask:0xf bound_ctrl:1
    s_nop 0
    v_readlane_b32 s54, v9, s32
    s_sub_u32 s54, s54, s53
    s_add_u32 s50, s50, s54
    s_add_u32 s51, s51, s54
    s_add_u32 s52, s52, s54
    s_pack_ll_b32_b16 s48, s54, s50
    s_pack_ll_b32_b16 s49, s51, s52
    v_add_u32 v14, s48, v14
    v_add_u32 v15, s49, v15
    v_sub_u32 v12, v14, v12
    v_sub_u32 v13, v15, v13
    v_and_b32 v8, 0xffff, v12
    v_lshrrev_b32 v9, 16, v12
    v_and_b32 v10, 0xffff, v13
    v_lshrrev_b32 v11, 16, v13
    ds_write2st64_b32 v7, v8, v9 offset0:0 offset1:1
    ds_write2st64_b32 v7, v10, v11 offset0:2 offset1:3
    s_waitcnt lgkmcnt(0)
    s_barrier
    ds_add_rtn_u32 v120, v120, v2
    ds_add_rtn_u32 v121, v121, v2
    ds_add_rtn_u32 v122, v122, v2
    ds_add_rtn_u32 v123, v123, v2
    s_add_u32 s47, s36, 0xa900000
    v_and_b32 v11, 0x3f0, v0
    v_add_u32 v11, v11, v11
    buffer_store_dwordx2 v[12:13], v11, s[24:27], s47 offen
    s_bitset0_b64 exec, 63
    s_not_b64 exec, exec
    buffer_store_dwordx2 v[14:15], v11, s[24:27], s47 offen offset:32
    s_mov_b64 exec, -1
    ds_add_rtn_u32 v20, v20, v2
    ds_add_rtn_u32 v21, v21, v2
    ds_add_rtn_u32 v22, v22, v2
    ds_add_rtn_u32 v23, v23, v2
    ds_add_rtn_u32 v32, v32, v2
    ds_add_rtn_u32 v33, v33, v2
    ds_add_rtn_u32 v34, v34, v2
    ds_add_rtn_u32 v35, v35, v2
    s_add_u32 s44, s35, 0x7ed4000
    buffer_store_dwordx4 v[96:99], v0, s[20:23], s44 offen sc1
    ds_add_rtn_u32 v40, v40, v2
    ds_add_rtn_u32 v41, v41, v2
    ds_add_rtn_u32 v42, v42, v2
    ds_add_rtn_u32 v43, v43, v2
    ds_add_rtn_u32 v52, v52, v2
    ds_add_rtn_u32 v53, v53, v2
    ds_add_rtn_u32 v54, v54, v2
    ds_add_rtn_u32 v55, v55, v2
    s_cmp_le_u32 s43, 5
    s_cbranch_scc1 L1_s4
    ds_add_rtn_u32 v60, v60, v2
    ds_add_rtn_u32 v61, v61, v2
    ds_add_rtn_u32 v62, v62, v2
    ds_add_rtn_u32 v63, v63, v2
L1_s4:
    s_add_u32 s45, s35, 0x7ed8000
    buffer_store_dwordx4 v[100:103], v0, s[20:23], s45 offen sc1
    s_cmp_le_u32 s43, 6
    s_cbranch_scc1 L1_s5
    ds_add_rtn_u32 v72, v72, v2
    ds_add_rtn_u32 v73, v73, v2
    ds_add_rtn_u32 v74, v74, v2
    ds_add_rtn_u32 v75, v75, v2
L1_s5:
    s_cmp_le_u32 s43, 7
    s_cbranch_scc1 L1_s6
    ds_add_rtn_u32 v80, v80, v2
    ds_add_rtn_u32 v81, v81, v2
    ds_add_rtn_u32 v82, v82, v2
    ds_add_rtn_u32 v83, v83, v2
L1_s6:
    s_waitcnt lgkmcnt(0)
    s_barrier
    v_and_b32 v7, -4, v120
    v_lshl_add_u32 v8, v120, 2, v7
    ds_write_b32 v8, v116
    v_lshl_add_u32 v7, v7, 2, v120
    ds_write_b8 v7, v104 offset:16
    v_and_b32 v9, -4, v121
    v_lshl_add_u32 v10, v121, 2, v9
    ds_write_b32 v10, v117
    v_lshl_add_u32 v9, v9, 2, v121
    ds_write_b8_d16_hi v9, v104 offset:16
    v_and_b32 v7, -4, v122
    v_lshl_add_u32 v8, v122, 2, v7
    ds_write_b32 v8, v118
    v_lshl_add_u32 v7, v7, 2, v122
    ds_write_b8 v7, v105 offset:16
    v_and_b32 v9, -4, v123
    v_lshl_add_u32 v10, v123, 2, v9
    ds_write_b32 v10, v119
    v_lshl_add_u32 v9, v9, 2, v123
    ds_write_b8_d16_hi v9, v105 offset:16
    s_add_u32 s46, s35, 0x7edc000
    buffer_store_dwordx4 v[108:111], v0, s[20:23], s46 offen sc1
    v_and_b32 v7, -4, v20
    v_lshl_add_u32 v8, v20, 2, v7
    ds_write_b32 v8, v16
    v_lshl_add_u32 v7, v7, 2, v20
    ds_write_b8 v7, v106 offset:16
    v_and_b32 v9, -4, v21
    v_lshl_add_u32 v10, v21, 2, v9
    ds_write_b32 v10, v17
    v_lshl_add_u32 v9, v9, 2, v21
    ds_write_b8_d16_hi v9, v106 offset:16
    v_and_b32 v7, -4, v22
    v_lshl_add_u32 v8, v22, 2, v7
    ds_write_b32 v8, v18
    v_lshl_add_u32 v7, v7, 2, v22
    ds_write_b8 v7, v107 offset:16
    v_and_b32 v9, -4, v23
    v_lshl_add_u32 v10, v23, 2, v9
    ds_write_b32 v10, v19
    v_lshl_add_u32 v9, v9, 2, v23
    ds_write_b8_d16_hi v9, v107 offset:16
    v_and_b32 v7, -4, v32
    v_lshl_add_u32 v8, v32, 2, v7
    ds_write_b32 v8, v28
    v_lshl_add_u32 v7, v7, 2, v32
    ds_write_b8 v7, v124 offset:16
    v_and_b32 v9, -4, v33
    v_lshl_add_u32 v10, v33, 2, v9
    ds_write_b32 v10, v29
    v_lshl_add_u32 v9, v9, 2, v33
    ds_write_b8_d16_hi v9, v124 offset:16
    v_and_b32 v7, -4, v34
    v_lshl_add_u32 v8, v34, 2, v7
    ds_write_b32 v8, v30
    v_lshl_add_u32 v7, v7, 2, v34
    ds_write_b8 v7, v125 offset:16
    v_and_b32 v9, -4, v35
    v_lshl_add_u32 v10, v35, 2, v9
    ds_write_b32 v10, v31
    v_lshl_add_u32 v9, v9, 2, v35
    ds_write_b8_d16_hi v9, v125 offset:16
    s_add_u32 s47, s35, 0x7ee0000
    buffer_store_dwordx4 v[112:115], v0, s[20:23], s47 offen sc1
    v_and_b32 v7, -4, v40
    v_lshl_add_u32 v8, v40, 2, v7
    ds_write_b32 v8, v36
    v_lshl_add_u32 v7, v7, 2, v40
    ds_write_b8 v7, v126 offset:16
    v_and_b32 v9, -4, v41
    v_lshl_add_u32 v10, v41, 2, v9
    ds_write_b32 v10, v37
    v_lshl_add_u32 v9, v9, 2, v41
    ds_write_b8_d16_hi v9, v126 offset:16
    v_and_b32 v7, -4, v42
    v_lshl_add_u32 v8, v42, 2, v7
    ds_write_b32 v8, v38
    v_lshl_add_u32 v7, v7, 2, v42
    ds_write_b8 v7, v127 offset:16
    v_and_b32 v9, -4, v43
    v_lshl_add_u32 v10, v43, 2, v9
    ds_write_b32 v10, v39
    v_lshl_add_u32 v9, v9, 2, v43
    ds_write_b8_d16_hi v9, v127 offset:16
    v_and_b32 v7, -4, v52
    v_lshl_add_u32 v8, v52, 2, v7
    ds_write_b32 v8, v48
    v_lshl_add_u32 v7, v7, 2, v52
    ds_write_b8 v7, v24 offset:16
    v_and_b32 v9, -4, v53
    v_lshl_add_u32 v10, v53, 2, v9
    ds_write_b32 v10, v49
    v_lshl_add_u32 v9, v9, 2, v53
    ds_write_b8_d16_hi v9, v24 offset:16
    v_and_b32 v7, -4, v54
    v_lshl_add_u32 v8, v54, 2, v7
    ds_write_b32 v8, v50
    v_lshl_add_u32 v7, v7, 2, v54
    ds_write_b8 v7, v25 offset:16
    v_and_b32 v9, -4, v55
    v_lshl_add_u32 v10, v55, 2, v9
    ds_write_b32 v10, v51
    v_lshl_add_u32 v9, v9, 2, v55
    ds_write_b8_d16_hi v9, v25 offset:16
    s_add_u32 s44, s35, 0x7ee4000
    buffer_store_dwordx4 v[84:87], v0, s[20:23], s44 offen sc1
    s_cmp_le_u32 s43, 5
    s_cbranch_scc1 L1_s7
    v_and_b32 v7, -4, v60
    v_lshl_add_u32 v8, v60, 2, v7
    ds_write_b32 v8, v56
    v_lshl_add_u32 v7, v7, 2, v60
    ds_write_b8 v7, v26 offset:16
    v_and_b32 v9, -4, v61
    v_lshl_add_u32 v10, v61, 2, v9
    ds_write_b32 v10, v57
    v_lshl_add_u32 v9, v9, 2, v61
    ds_write_b8_d16_hi v9, v26 offset:16
    v_and_b32 v7, -4, v62
    v_lshl_add_u32 v8, v62, 2, v7
    ds_write_b32 v8, v58
    v_lshl_add_u32 v7, v7, 2, v62
    ds_write_b8 v7, v27 offset:16
    v_and_b32 v9, -4, v63
    v_lshl_add_u32 v10, v63, 2, v9
    ds_write_b32 v10, v59
    v_lshl_add_u32 v9, v9, 2, v63
    ds_write_b8_d16_hi v9, v27 offset:16
L1_s7:
    s_cmp_le_u32 s43, 6
    s_cbranch_scc1 L1_s8
    v_and_b32 v7, -4, v72
    v_lshl_add_u32 v8, v72, 2, v7
    ds_write_b32 v8, v68
    v_lshl_add_u32 v7, v7, 2, v72
    ds_write_b8 v7, v44 offset:16
    v_and_b32 v9, -4, v73
    v_lshl_add_u32 v10, v73, 2, v9
    ds_write_b32 v10, v69
    v_lshl_add_u32 v9, v9, 2, v73
    ds_write_b8_d16_hi v9, v44 offset:16
    v_and_b32 v7, -4, v74
    v_lshl_add_u32 v8, v74, 2, v7
    ds_write_b32 v8, v70
    v_lshl_add_u32 v7, v7, 2, v74
    ds_write_b8 v7, v45 offset:16
    v_and_b32 v9, -4, v75
    v_lshl_add_u32 v10, v75, 2, v9
    ds_write_b32 v10, v71
    v_lshl_add_u32 v9, v9, 2, v75
    ds_write_b8_d16_hi v9, v45 offset:16
L1_s8:
    s_cmp_le_u32 s43, 7
    s_cbranch_scc1 L1_s9
    v_and_b32 v7, -4, v80
    v_lshl_add_u32 v8, v80, 2, v7
    ds_write_b32 v8, v76
    v_lshl_add_u32 v7, v7, 2, v80
    ds_write_b8 v7, v46 offset:16
    v_and_b32 v9, -4, v81
    v_lshl_add_u32 v10, v81, 2, v9
    ds_write_b32 v10, v77
    v_lshl_add_u32 v9, v9, 2, v81
    ds_write_b8_d16_hi v9, v46 offset:16
    v_and_b32 v7, -4, v82
    v_lshl_add_u32 v8, v82, 2, v7
    ds_write_b32 v8, v78
    v_lshl_add_u32 v7, v7, 2, v82
    ds_write_b8 v7, v47 offset:16
    v_and_b32 v9, -4, v83
    v_lshl_add_u32 v10, v83, 2, v9
    ds_write_b32 v10, v79
    v_lshl_add_u32 v9, v9, 2, v83
    ds_write_b8_d16_hi v9, v47 offset:16
L1_s9:
    v_add_u32 v7, 0x10000, v0
    v_add_u32 v12, 0x20000, v0
    s_waitcnt lgkmcnt(0)
    s_barrier
    ds_read_b128 v[92:95], v0 offset:0
    ds_read_b128 v[64:67], v0 offset:16384
    ds_read_b128 v[96:99], v0 offset:32768
    ds_read_b128 v[100:103], v0 offset:49152
    ds_read_b128 v[116:119], v7 offset:0
    ds_read_b128 v[120:123], v7 offset:16384
    ds_read_b128 v[108:111], v7 offset:32768
    ds_read_b128 v[16:19], v7 offset:49152
    ds_read_b128 v[20:23], v12 offset:0
    ds_read_b128 v[104:107], v12 offset:16384
    s_waitcnt lgkmcnt(9)
    s_add_u32 s45, s35, 0xa900000
    buffer_store_dwordx4 v[92:95], v0, s[20:23], s45 offen sc1
    s_waitcnt lgkmcnt(8)
    s_add_u32 s46, s35, 0xa904000
    buffer_store_dwordx4 v[64:67], v0, s[20:23], s46 offen sc1
    s_waitcnt lgkmcnt(7)
    s_add_u32 s47, s35, 0xa908000
    buffer_store_dwordx4 v[96:99], v0, s[20:23], s47 offen sc1
    s_waitcnt lgkmcnt(6)
    s_add_u32 s44, s35, 0xa90c000
    buffer_store_dwordx4 v[100:103], v0, s[20:23], s44 offen sc1
    s_waitcnt lgkmcnt(5)
    s_add_u32 s45, s35, 0xa910000
    buffer_store_dwordx4 v[116:119], v0, s[20:23], s45 offen sc1
    s_waitcnt lgkmcnt(4)
    s_add_u32 s46, s35, 0xa914000
    buffer_store_dwordx4 v[120:123], v0, s[20:23], s46 offen sc1
    s_waitcnt lgkmcnt(3)
    s_add_u32 s47, s35, 0xa918000
    buffer_store_dwordx4 v[108:111], v0, s[20:23], s47 offen sc1
    s_cmp_le_u32 s43, 5
    s_cbranch_scc1 L1_fin
    s_waitcnt lgkmcnt(2)
    s_add_u32 s44, s35, 0xa91c000
    buffer_store_dwordx4 v[16:19], v0, s[20:23], s44 offen sc1
    s_cmp_le_u32 s43, 6
    s_cbranch_scc1 L1_fin
    s_waitcnt lgkmcnt(1)
    s_add_u32 s45, s35, 0xa920000
    buffer_store_dwordx4 v[20:23], v0, s[20:23], s45 offen sc1
    s_cmp_le_u32 s43, 7
    s_cbranch_scc1 L1_fin
    s_waitcnt lgkmcnt(0)
    s_add_u32 s46, s35, 0xa924000
    buffer_store_dwordx4 v[104:107], v0, s[20:23], s46 offen sc1
L1_fin:
L1_end:
    s_endpgm
.text
.globl gs_acc_kernel
.p2align 8
.type gs_acc_kernel,@function
gs_acc_kernel:
    s_cmp_ge_u32 s2, 256
    s_cbranch_scc1 L2_end
    s_load_dwordx2 s[30:31], s[0:1], 104
    s_load_dwordx2 s[28:29], s[0:1], 0
    v_lshrrev_b32 v16, 6, v0
    v_and_b32 v17, 63, v0
    v_readfirstlane_b32 s32, v16
    s_bfe_u32 s33, s2, 0x20001
    s_and_b32 s34, s2, 1
    s_lshl_b32 s34, s34, 5
    s_lshr_b32 s4, s2, 3
    s_add_u32 s34, s34, s4
    v_lshlrev_b32 v1, 2, v17
    v_and_b32 v2, 12, v1
    v_lshrrev_b32 v18, 2, v17
    v_mul_u32_u24 v19, 80, v16
    v_add_u32 v18, v18, v19
    v_mul_u32_u24 v4, 173056, v18
    v_lshl_add_u32 v20, v2, 2, v4
    s_mul_i32 s39, s33, 2080
    s_lshl_b32 s3, s34, 5
    s_add_u32 s39, s39, s3
    v_mul_u32_u24 v5, 5120, v16
    v_lshl_add_u32 v5, v17, 4, v5
    v_add_u32 v7, 80000, v5
    s_mul_i32 s40, s33, 1280000
    s_waitcnt lgkmcnt(0)
    s_add_u32 s12, s30, 0x28000
    s_addc_u32 s13, s31, 0
    s_mov_b32 s14, 0xd318000
    s_mov_b32 s15, 0x20000
    buffer_load_dwordx4 v[64:67], v20, s[12:15], s39 offen
    v_add_u32 v20, 0x2a4000, v20
    buffer_load_dwordx4 v[68:71], v20, s[12:15], s39 offen
    v_add_u32 v20, 0x2a4000, v20
    buffer_load_dwordx4 v[72:75], v20, s[12:15], s39 offen
    v_add_u32 v20, 0x2a4000, v20
    buffer_load_dwordx4 v[76:79], v20, s[12:15], s39 offen
    v_add_u32 v20, 0x2a4000, v20
    buffer_load_dwordx4 v[80:83], v20, s[12:15], s39 offen
    s_mov_b32 s16, s28
    s_mov_b32 s17, s29
    s_mov_b32 s18, 0x4e2000
    s_mov_b32 s19, 0x20000
    s_add_u32 s24, s30, 0xebab000
    s_addc_u32 s25, s31, 0
    s_mov_b32 s26, 0x100
    s_mov_b32 s27, 0x20000
    v_lshlrev_b32 v21, 4, v2
    buffer_load_dwordx2 v[10:11], v21, s[24:27], 0 offen offset:40
    buffer_load_dwordx4 v[52:55], v5, s[16:19], s40 offen offset:2048
    buffer_load_dwordx4 v[56:59], v5, s[16:19], s40 offen offset:3072
    s_add_u32 s3, s40, 4096
    buffer_load_dwordx4 v[60:63], v5, s[16:19], s3 offen
    buffer_load_dwordx4 v[44:47], v5, s[16:19], s40 offen offset:0
    buffer_load_dwordx4 v[48:51], v5, s[16:19], s40 offen offset:1024
    v_or_b32 v4, 0xf0000000, v4
    v_sub_u32 v3, 16, v2
    v_and_b32 v18, 3, v0
    v_lshlrev_b32 v18, 4, v18
    v_mov_b32 v12, 0x3f80
    v_mov_b32 v13, 0
    v_lshlrev_b64 v[12:13], v18, v[12:13]
    v_and_b32 v18, 3, v0
    v_lshlrev_b32 v18, 4, v18
    v_mov_b32 v14, 0xbf80
    v_mov_b32 v15, 0
    v_lshlrev_b64 v[14:15], v18, v[14:15]
    s_add_u32 s40, s40, 0x4e200
    v_lshlrev_b32 v0, 4, v0
    v_mov_b32 v6, 0xffff
    v_mov_b32 v8, 0x1fff8
    v_mov_b32 v9, 0x07ff0000
    s_mov_b32 s44, 0x4000c0c
    s_mov_b32 s45, 0x4010c0c
    s_mov_b32 s46, 0x4020c0c
    s_mov_b32 s47, 0x4030c0c
    s_mul_i32 s38, s32, 1280
    s_add_u32 s38, s38, 20000
    s_add_u32 s48, s38, 257
    s_mov_b32 s36, 0
    s_mov_b32 s35, 0
    s_mov_b32 s42, 0
    s_mov_b64 s[80:81], 0
    s_mov_b32 s8, s30
    s_mov_b32 s9, s31
    s_mov_b32 s10, 0xd340000
    s_mov_b32 s11, 0x20000
    s_add_u32 s20, s30, 0xd823000
    s_addc_u32 s21, s31, 0
    s_mov_b32 s22, 0x13880
    s_mov_b32 s23, 0x20000
    s_lshl_b32 s3, s33, 6
    s_add_u32 s3, s3, s34
    s_mul_i32 s3, s3, 80000
    s_add_u32 s20, s20, s3
    s_addc_u32 s21, s21, 0
    v_mov_b32 v88, 0
    v_mov_b32 v89, 0
    v_mov_b32 v90, 0
    v_mov_b32 v91, 0
    v_mov_b32 v92, 0
    v_mov_b32 v93, 0
    v_mov_b32 v94, 0
    v_mov_b32 v95, 0
    ds_write_b128 v0, v[88:91] offset:0
    ds_write_b128 v0, v[88:91] offset:16384
    ds_write_b128 v0, v[88:91] offset:32768
    ds_write_b128 v0, v[88:91] offset:49152
    v_add_u32 v116, 0x10000, v0
    v_cmp_gt_u32 vcc, 80000, v116
    s_mov_b64 exec, vcc
    ds_write_b128 v116, v[88:91]
    s_mov_b64 exec, -1
    s_waitcnt vmcnt(5)
    s_mov_b32 s37, s38
    s_setprio 3
    v_and_b32_dpp v118, v64, v6 quad_perm:[0,0,0,0] row_mask:0xf bank_mask:0xf
    v_and_b32_dpp v119, v64, v6 quad_perm:[2,2,2,2] row_mask:0xf bank_mask:0xf
    v_and_b32 v120, -4, v118
    v_add_u32 v120, v120, v2
L2_x1:
    v_sub_u32 v121, v119, v120
    v_sub_u32 v123, v118, v120
    v_med3_i32 v122, v121, 0, 4
    v_max_i32 v123, 0, v123
    v_cmp_gt_i32 vcc, v122, v123
    v_mad_u32_u24 v124, v120, 5, v4
    v_bfm_b32 v122, v122, 28
    v_bfm_b32 v123, v123, 28
    v_mbcnt_lo_u32_b32 v125, vcc_lo, 0
    v_mbcnt_hi_u32_b32 v125, vcc_hi, v125
    v_bitop3_b32 v124, v122, v123, v124 bitop3:0x9a
    v_add_lshl_u32 v125, v125, s37, 2
    s_bcnt1_i32_b64 s41, vcc
    s_mov_b64 exec, vcc
    ds_write_b32 v125, v124
    s_mov_b64 exec, -1
    v_cmp_gt_i32 vcc, v121, v3
    s_add_u32 s37, s37, s41
    s_min_u32 s37, s37, s48
    s_cbranch_vccnz L2_xe1
L2_xr1:
    s_setprio 2
    v_and_b32_dpp v118, v68, v6 quad_perm:[0,0,0,0] row_mask:0xf bank_mask:0xf
    v_and_b32_dpp v119, v68, v6 quad_perm:[2,2,2,2] row_mask:0xf bank_mask:0xf
    v_and_b32 v120, -4, v118
    v_add_u32 v120, v120, v2
    v_add_u32 v126, 0x2a4000, v4
L2_x2:
    v_sub_u32 v121, v119, v120
    v_sub_u32 v123, v118, v120
    v_med3_i32 v122, v121, 0, 4
    v_max_i32 v123, 0, v123
    v_cmp_gt_i32 vcc, v122, v123
    v_mad_u32_u24 v124, v120, 5, v126
    v_bfm_b32 v122, v122, 28
    v_bfm_b32 v123, v123, 28
    v_mbcnt_lo_u32_b32 v125, vcc_lo, 0
    v_mbcnt_hi_u32_b32 v125, vcc_hi, v125
    v_bitop3_b32 v124, v122, v123, v124 bitop3:0x9a
    v_add_lshl_u32 v125, v125, s37, 2
    s_bcnt1_i32_b64 s41, vcc
    s_mov_b64 exec, vcc
    ds_write_b32 v125, v124
    s_mov_b64 exec, -1
    v_cmp_gt_i32 vcc, v121, v3
    s_add_u32 s37, s37, s41
    s_min_u32 s37, s37, s48
    s_cbranch_vccnz L2_xe2
L2_xr2:
    s_setprio 1
    v_and_b32_dpp v118, v72, v6 quad_perm:[0,0,0,0] row_mask:0xf bank_mask:0xf
    v_and_b32_dpp v119, v72, v6 quad_perm:[2,2,2,2] row_mask:0xf bank_mask:0xf
    v_and_b32 v120, -4, v118
    v_add_u32 v120, v120, v2
    v_add_u32 v126, 0x548000, v4
L2_x3:
    v_sub_u32 v121, v119, v120
    v_sub_u32 v123, v118, v120
    v_med3_i32 v122, v121, 0, 4
    v_max_i32 v123, 0, v123
    v_cmp_gt_i32 vcc, v122, v123
    v_mad_u32_u24 v124, v120, 5, v126
    v_bfm_b32 v122, v122, 28
    v_bfm_b32 v123, v123, 28
    v_mbcnt_lo_u32_b32 v125, vcc_lo, 0
    v_mbcnt_hi_u32_b32 v125, vcc_hi, v125
    v_bitop3_b32 v124, v122, v123, v124 bitop3:0x9a
    v_add_lshl_u32 v125, v125, s37, 2
    s_bcnt1_i32_b64 s41, vcc
    s_mov_b64 exec, vcc
    ds_write_b32 v125, v124
    s_mov_b64 exec, -1
    v_cmp_gt_i32 vcc, v121, v3
    s_add_u32 s37, s37, s41
    s_min_u32 s37, s37, s48
    s_cbranch_vccnz L2_xe3
L2_xr3:
    s_setprio 0
    v_and_b32_dpp v118, v76, v6 quad_perm:[0,0,0,0] row_mask:0xf bank_mask:0xf
    v_and_b32_dpp v119, v76, v6 quad_perm:[2,2,2,2] row_mask:0xf bank_mask:0xf
    v_and_b32 v120, -4, v118
    v_add_u32 v120, v120, v2
    v_add_u32 v126, 0x7ec000, v4
L2_x4:
    v_sub_u32 v121, v119, v120
    v_sub_u32 v123, v118, v120
    v_med3_i32 v122, v121, 0, 4
    v_max_i32 v123, 0, v123
    v_cmp_gt_i32 vcc, v122, v123
    v_mad_u32_u24 v124, v120, 5, v126
    v_bfm_b32 v122, v122, 28
    v_bfm_b32 v123, v123, 28
    v_mbcnt_lo_u32_b32 v125, vcc_lo, 0
    v_mbcnt_hi_u32_b32 v125, vcc_hi, v125
    v_bitop3_b32 v124, v122, v123, v124 bitop3:0x9a
    v_add_lshl_u32 v125, v125, s37, 2
    s_bcnt1_i32_b64 s41, vcc
    s_mov_b64 exec, vcc
    ds_write_b32 v125, v124
    s_mov_b64 exec, -1
    v_cmp_gt_i32 vcc, v121, v3
    s_add_u32 s37, s37, s41
    s_min_u32 s37, s37, s48
    s_cbranch_vccnz L2_xe4
L2_xr4:
    v_and_b32_dpp v118, v80, v6 quad_perm:[0,0,0,0] row_mask:0xf bank_mask:0xf
    v_and_b32_dpp v119, v80, v6 quad_perm:[2,2,2,2] row_mask:0xf bank_mask:0xf
    v_and_b32 v120, -4, v118
    v_add_u32 v120, v120, v2
    v_add_u32 v126, 0xa90000, v4
L2_x5:
    v_sub_u32 v121, v119, v120
    v_sub_u32 v123, v118, v120
    v_med3_i32 v122, v121, 0, 4
    v_max_i32 v123, 0, v123
    v_cmp_gt_i32 vcc, v122, v123
    v_mad_u32_u24 v124, v120, 5, v126
    v_bfm_b32 v122, v122, 28
    v_bfm_b32 v123, v123, 28
    v_mbcnt_lo_u32_b32 v125, vcc_lo, 0
    v_mbcnt_hi_u32_b32 v125, vcc_hi, v125
    v_bitop3_b32 v124, v122, v123, v124 bitop3:0x9a
    v_add_lshl_u32 v125, v125, s37, 2
    s_bcnt1_i32_b64 s41, vcc
    s_mov_b64 exec, vcc
    ds_write_b32 v125, v124
    s_mov_b64 exec, -1
    v_cmp_gt_i32 vcc, v121, v3
    s_add_u32 s37, s37, s41
    s_min_u32 s37, s37, s48
    s_cbranch_vccnz L2_xe5
L2_xr5:
    s_lshl_b32 s3, s37, 2
    v_add_u32 v125, s3, v1
    v_mov_b32 v124, -1
    ds_write_b32 v125, v124
    s_lshl_b32 s3, s38, 2
    v_add_u32 v125, s3, v1
    ds_read2st64_b32 v[40:41], v125 offset0:0 offset1:1
    ds_read2st64_b32 v[42:43], v125 offset0:2 offset1:3
    s_sub_u32 s41, s37, s38
    s_sub_u32 s3, s41, 192
    s_cmp_gt_u32 s3, 64
    s_cbranch_scc1 L2_xf6
L2_xg6:
    s_waitcnt lgkmcnt(0)
    v_and_b32 v116, 0x0fffffff, v40
    v_mov_b32 v21, v40
    buffer_load_dwordx4 v[16:19], v116, s[8:11], 0 offen
    buffer_load_dwordx3 v[18:20], v116, s[8:11], 0 offen offset:8
    v_and_b32 v116, 0x0fffffff, v41
    v_mov_b32 v27, v41
    buffer_load_dwordx4 v[22:25], v116, s[8:11], 0 offen
    buffer_load_dwordx3 v[24:26], v116, s[8:11], 0 offen offset:8
    v_and_b32 v116, 0x0fffffff, v42
    v_mov_b32 v33, v42
    buffer_load_dwordx4 v[28:31], v116, s[8:11], 0 offen
    buffer_load_dwordx3 v[30:32], v116, s[8:11], 0 offen offset:8
    v_and_b32 v116, 0x0fffffff, v43
    v_mov_b32 v39, v43
    buffer_load_dwordx4 v[34:37], v116, s[8:11], 0 offen
    buffer_load_dwordx3 v[36:38], v116, s[8:11], 0 offen offset:8
    s_waitcnt vmcnt(12)
    ds_write_b128 v7, v[52:55] offset:2048
    buffer_load_dwordx4 v[52:55], v5, s[16:19], s40 offen offset:2048
    s_mov_b32 s37, s38
    s_setprio 3
    v_and_b32_dpp v118, v66, v6 quad_perm:[0,0,0,0] row_mask:0xf bank_mask:0xf
    v_and_b32_dpp v119, v66, v6 quad_perm:[2,2,2,2] row_mask:0xf bank_mask:0xf
    v_and_b32 v120, -4, v118
    v_add_u32 v120, v120, v2
L2_x7:
    v_sub_u32 v121, v119, v120
    v_sub_u32 v123, v118, v120
    v_med3_i32 v122, v121, 0, 4
    v_max_i32 v123, 0, v123
    v_cmp_gt_i32 vcc, v122, v123
    v_mad_u32_u24 v124, v120, 5, v4
    v_bfm_b32 v122, v122, 28
    v_bfm_b32 v123, v123, 28
    v_mbcnt_lo_u32_b32 v125, vcc_lo, 0
    v_mbcnt_hi_u32_b32 v125, vcc_hi, v125
    v_bitop3_b32 v124, v122, v123, v124 bitop3:0x9a
    v_add_lshl_u32 v125, v125, s37, 2
    s_bcnt1_i32_b64 s41, vcc
    s_mov_b64 exec, vcc
    ds_write_b32 v125, v124
    s_mov_b64 exec, -1
    v_cmp_gt_i32 vcc, v121, v3
    s_add_u32 s37, s37, s41
    s_min_u32 s37, s37, s48
    s_cbranch_vccnz L2_xe7
L2_xr7:
    s_waitcnt vmcnt(12)
    ds_write_b128 v7, v[56:59] offset:3072
    buffer_load_dwordx4 v[56:59], v5, s[16:19], s40 offen offset:3072
    s_setprio 2
    v_and_b32_dpp v118, v70, v6 quad_perm:[0,0,0,0] row_mask:0xf bank_mask:0xf
    v_and_b32_dpp v119, v70, v6 quad_perm:[2,2,2,2] row_mask:0xf bank_mask:0xf
    v_and_b32 v120, -4, v118
    v_add_u32 v120, v120, v2
    v_add_u32 v126, 0x2a4000, v4
L2_x8:
    v_sub_u32 v121, v119, v120
    v_sub_u32 v123, v118, v120
    v_med3_i32 v122, v121, 0, 4
    v_max_i32 v123, 0, v123
    v_cmp_gt_i32 vcc, v122, v123
    v_mad_u32_u24 v124, v120, 5, v126
    v_bfm_b32 v122, v122, 28
    v_bfm_b32 v123, v123, 28
    v_mbcnt_lo_u32_b32 v125, vcc_lo, 0
    v_mbcnt_hi_u32_b32 v125, vcc_hi, v125
    v_bitop3_b32 v124, v122, v123, v124 bitop3:0x9a
    v_add_lshl_u32 v125, v125, s37, 2
    s_bcnt1_i32_b64 s41, vcc
    s_mov_b64 exec, vcc
    ds_write_b32 v125, v124
    s_mov_b64 exec, -1
    v_cmp_gt_i32 vcc, v121, v3
    s_add_u32 s37, s37, s41
    s_min_u32 s37, s37, s48
    s_cbranch_vccnz L2_xe8
L2_xr8:
    s_waitcnt vmcnt(12)
    ds_write_b128 v7, v[60:63] offset:4096
    s_add_u32 s3, s40, 4096
    buffer_load_dwordx4 v[60:63], v5, s[16:19], s3 offen
    s_setprio 1
    v_and_b32_dpp v118, v74, v6 quad_perm:[0,0,0,0] row_mask:0xf bank_mask:0xf
    v_and_b32_dpp v119, v74, v6 quad_perm:[2,2,2,2] row_mask:0xf bank_mask:0xf
    v_and_b32 v120, -4, v118
    v_add_u32 v120, v120, v2
    v_add_u32 v126, 0x548000, v4
L2_x9:
    v_sub_u32 v121, v119, v120
    v_sub_u32 v123, v118, v120
    v_med3_i32 v122, v121, 0, 4
    v_max_i32 v123, 0, v123
    v_cmp_gt_i32 vcc, v122, v123
    v_mad_u32_u24 v124, v120, 5, v126
    v_bfm_b32 v122, v122, 28
    v_bfm_b32 v123, v123, 28
    v_mbcnt_lo_u32_b32 v125, vcc_lo, 0
    v_mbcnt_hi_u32_b32 v125, vcc_hi, v125
    v_bitop3_b32 v124, v122, v123, v124 bitop3:0x9a
    v_add_lshl_u32 v125, v125, s37, 2
    s_bcnt1_i32_b64 s41, vcc
    s_mov_b64 exec, vcc
    ds_write_b32 v125, v124
    s_mov_b64 exec, -1
    v_cmp_gt_i32 vcc, v121, v3
    s_add_u32 s37, s37, s41
    s_min_u32 s37, s37, s48
    s_cbranch_vccnz L2_xe9
L2_xr9:
    s_setprio 0
    v_and_b32_dpp v118, v78, v6 quad_perm:[0,0,0,0] row_mask:0xf bank_mask:0xf
    v_and_b32_dpp v119, v78, v6 quad_perm:[2,2,2,2] row_mask:0xf bank_mask:0xf
    v_and_b32 v120, -4, v118
    v_add_u32 v120, v120, v2
    v_add_u32 v126, 0x7ec000, v4
L2_x10:
    v_sub_u32 v121, v119, v120
    v_sub_u32 v123, v118, v120
    v_med3_i32 v122, v121, 0, 4
    v_max_i32 v123, 0, v123
    v_cmp_gt_i32 vcc, v122, v123
    v_mad_u32_u24 v124, v120, 5, v126
    v_bfm_b32 v122, v122, 28
    v_bfm_b32 v123, v123, 28
    v_mbcnt_lo_u32_b32 v125, vcc_lo, 0
    v_mbcnt_hi_u32_b32 v125, vcc_hi, v125
    v_bitop3_b32 v124, v122, v123, v124 bitop3:0x9a
    v_add_lshl_u32 v125, v125, s37, 2
    s_bcnt1_i32_b64 s41, vcc
    s_mov_b64 exec, vcc
    ds_write_b32 v125, v124
    s_mov_b64 exec, -1
    v_cmp_gt_i32 vcc, v121, v3
    s_add_u32 s37, s37, s41
    s_min_u32 s37, s37, s48
    s_cbranch_vccnz L2_xe10
L2_xr10:
    v_and_b32_dpp v118, v82, v6 quad_perm:[0,0,0,0] row_mask:0xf bank_mask:0xf
    v_and_b32_dpp v119, v82, v6 quad_perm:[2,2,2,2] row_mask:0xf bank_mask:0xf
    v_and_b32 v120, -4, v118
    v_add_u32 v120, v120, v2
    v_add_u32 v126, 0xa90000, v4
L2_x11:
    v_sub_u32 v121, v119, v120
    v_sub_u32 v123, v118, v120
    v_med3_i32 v122, v121, 0, 4
    v_max_i32 v123, 0, v123
    v_cmp_gt_i32 vcc, v122, v123
    v_mad_u32_u24 v124, v120, 5, v126
    v_bfm_b32 v122, v122, 28
    v_bfm_b32 v123, v123, 28
    v_mbcnt_lo_u32_b32 v125, vcc_lo, 0
    v_mbcnt_hi_u32_b32 v125, vcc_hi, v125
    v_bitop3_b32 v124, v122, v123, v124 bitop3:0x9a
    v_add_lshl_u32 v125, v125, s37, 2
    s_bcnt1_i32_b64 s41, vcc
    s_mov_b64 exec, vcc
    ds_write_b32 v125, v124
    s_mov_b64 exec, -1
    v_cmp_gt_i32 vcc, v121, v3
    s_add_u32 s37, s37, s41
    s_min_u32 s37, s37, s48
    s_cbranch_vccnz L2_xe11
L2_xr11:
    s_lshl_b32 s3, s37, 2
    v_add_u32 v125, s3, v1
    v_mov_b32 v124, -1
    ds_write_b32 v125, v124
    s_lshl_b32 s3, s38, 2
    v_add_u32 v125, s3, v1
    ds_read2st64_b32 v[40:41], v125 offset0:0 offset1:1
    ds_read2st64_b32 v[42:43], v125 offset0:2 offset1:3
    s_sub_u32 s41, s37, s38
    s_sub_u32 s3, s41, 192
    s_cmp_gt_u32 s3, 64
    s_cbranch_scc1 L2_xf12
L2_xg12:
    s_waitcnt vmcnt(12)
    ds_write_b128 v7, v[44:47] offset:0
    s_waitcnt vmcnt(11)
    ds_write_b128 v7, v[48:51] offset:1024
    s_waitcnt lgkmcnt(0)
    s_barrier
L2_loop:
    s_setprio 3
    s_bitcmp1_b32 s36, s42
    s_cbranch_scc1 L2_slow
L2_ret0:
    s_waitcnt vmcnt(9)
    v_and_b32 v115, 0x20000000, v21
    v_lshrrev_b32 v116, 14, v17
    v_bitop3_b32 v116, v116, v8, v115 bitop3:0xea
    ds_read_b64 v[86:87], v116 offset:63616
    v_and_b32 v114, 0x10000000, v21
    v_lshrrev_b32 v116, 14, v16
    v_bitop3_b32 v116, v116, v8, v114 bitop3:0xea
    ds_read_b64 v[84:85], v116 offset:63616
    v_perm_b32 v112, v16, v20, s44
    v_bitop3_b32 v108, v16, v8, v114 bitop3:0xea
    v_perm_b32 v113, v17, v20, s45
    v_bitop3_b32 v109, v17, v8, v115 bitop3:0xea
    s_waitcnt lgkmcnt(0)
    v_mfma_f32_4x4x4_16b_bf16 v[100:103], v[10:11], v[86:87], 0
    v_mfma_f32_4x4x4_16b_bf16 v[96:99], v[10:11], v[84:85], 0
    v_bitop3_b32 v116, v16, 0.5, -0.5 bitop3:0xa8
    v_bitop3_b32 v112, v9, v112, v116 bitop3:0xca
    v_bitop3_b32 v116, v17, 0.5, -0.5 bitop3:0xa8
    v_bitop3_b32 v113, v9, v113, v116 bitop3:0xca
    v_cmp_lt_u32 s[84:85], v8, v108
    v_pk_mul_f32 v[100:101], v[100:101], v[112:113] op_sel:[0,1] op_sel_hi:[1,1]
    v_pk_mul_f32 v[102:103], v[102:103], v[112:113] op_sel:[0,1] op_sel_hi:[1,1]
    v_pk_mul_f32 v[96:97], v[96:97], v[112:113] op_sel:[0,0] op_sel_hi:[1,0]
    v_pk_mul_f32 v[98:99], v[98:99], v[112:113] op_sel:[0,0] op_sel_hi:[1,0]
    buffer_load_dwordx4 v[44:47], v5, s[16:19], s40 offen offset:0
    v_cmpx_ne_u64 vcc, v[94:95], v[90:91]
    s_and_b64 s[82:83], vcc, s[80:81]
    s_cbranch_scc1 L2_c13
L2_d13:
    v_mov_b64 v[104:105], v[90:91]
    v_mov_b32 v117, v111
    v_mov_b64 v[106:107], v[94:95]
    s_mov_b64 exec, -1
    s_or_b64 s[80:81], s[80:81], vcc
    v_cmpx_ne_u64 vcc, v[92:93], v[88:89]
    s_and_b64 s[82:83], vcc, s[80:81]
    s_cbranch_scc1 L2_c14
L2_d14:
    v_mov_b64 v[104:105], v[88:89]
    v_mov_b32 v117, v110
    v_mov_b64 v[106:107], v[92:93]
    s_mov_b64 exec, -1
    s_or_b64 s[80:81], s[80:81], vcc
    ds_read_b64 v[90:91], v109
    s_and_b64 exec, s[84:85], s[80:81]
    v_mfma_f32_4x4x4_16b_bf16 v[96:99], v[14:15], v[104:105], 0
    v_mov_b32 v108, v117
    s_andn2_b64 s[80:81], s[80:81], s[84:85]
    v_mfma_f32_4x4x4_16b_bf16 v[96:99], v[12:13], v[106:107], v[96:99]
    s_mov_b64 exec, -1
    ds_read_b64 v[88:89], v108
    v_and_b32 v115, 0x80000000, v21
    v_lshrrev_b32 v116, 14, v19
    v_bitop3_b32 v116, v116, v8, v115 bitop3:0xea
    ds_read_b64 v[86:87], v116 offset:63616
    v_and_b32 v114, 0x40000000, v21
    v_lshrrev_b32 v116, 14, v18
    v_bitop3_b32 v116, v116, v8, v114 bitop3:0xea
    ds_read_b64 v[84:85], v116 offset:63616
    s_waitcnt lgkmcnt(2)
    v_mfma_f32_4x4x4_16b_bf16 v[100:103], v[12:13], v[90:91], v[100:103]
    v_mfma_f32_4x4x4_16b_bf16 v[96:99], v[12:13], v[88:89], v[96:99]
    v_perm_b32 v112, v18, v20, s46
    v_bitop3_b32 v110, v18, v8, v114 bitop3:0xea
    v_perm_b32 v113, v19, v20, s47
    v_bitop3_b32 v111, v19, v8, v115 bitop3:0xea
    v_cvt_pk_bf16_f32 v100, v100, v101
    v_cvt_pk_bf16_f32 v101, v102, v103
    ds_wrxchg_rtn_b64 v[94:95], v109, v[100:101]
    v_cvt_pk_bf16_f32 v96, v96, v97
    v_cvt_pk_bf16_f32 v97, v98, v99
    ds_wrxchg_rtn_b64 v[92:93], v108, v[96:97]
    s_waitcnt lgkmcnt(2)
    v_mfma_f32_4x4x4_16b_bf16 v[100:103], v[10:11], v[86:87], 0
    v_mfma_f32_4x4x4_16b_bf16 v[96:99], v[10:11], v[84:85], 0
    v_bitop3_b32 v116, v18, 0.5, -0.5 bitop3:0xa8
    v_bitop3_b32 v112, v9, v112, v116 bitop3:0xca
    v_bitop3_b32 v116, v19, 0.5, -0.5 bitop3:0xa8
    v_bitop3_b32 v113, v9, v113, v116 bitop3:0xca
    v_pk_mul_f32 v[100:101], v[100:101], v[112:113] op_sel:[0,1] op_sel_hi:[1,1]
    v_pk_mul_f32 v[102:103], v[102:103], v[112:113] op_sel:[0,1] op_sel_hi:[1,1]
    v_pk_mul_f32 v[96:97], v[96:97], v[112:113] op_sel:[0,0] op_sel_hi:[1,0]
    v_pk_mul_f32 v[98:99], v[98:99], v[112:113] op_sel:[0,0] op_sel_hi:[1,0]
    v_and_b32 v116, 0x0fffffff, v40
    v_mov_b32 v21, v40
    buffer_load_dwordx4 v[16:19], v116, s[8:11], 0 offen
    buffer_load_dwordx3 v[18:20], v116, s[8:11], 0 offen offset:8
    s_waitcnt lgkmcnt(0)
    v_cmpx_ne_u64 vcc, v[94:95], v[90:91]
    s_and_b64 s[82:83], vcc, s[80:81]
    s_cbranch_scc1 L2_c15
L2_d15:
    v_mov_b64 v[104:105], v[90:91]
    v_mov_b32 v117, v109
    v_mov_b64 v[106:107], v[94:95]
    s_mov_b64 exec, -1
    s_or_b64 s[80:81], s[80:81], vcc
    v_cmpx_ne_u64 vcc, v[92:93], v[88:89]
    s_and_b64 s[82:83], vcc, s[80:81]
    s_cbranch_scc1 L2_c16
L2_d16:
    v_mov_b64 v[104:105], v[88:89]
    v_mov_b32 v117, v108
    v_mov_b64 v[106:107], v[92:93]
    s_mov_b64 exec, -1
    s_or_b64 s[80:81], s[80:81], vcc
    ds_read_b64 v[90:91], v111
    ds_read_b64 v[88:89], v110
    s_waitcnt vmcnt(10)
    v_and_b32 v115, 0x20000000, v27
    v_lshrrev_b32 v116, 14, v23
    v_bitop3_b32 v116, v116, v8, v115 bitop3:0xea
    ds_read_b64 v[86:87], v116 offset:63616
    v_and_b32 v114, 0x10000000, v27
    v_lshrrev_b32 v116, 14, v22
    v_bitop3_b32 v116, v116, v8, v114 bitop3:0xea
    ds_read_b64 v[84:85], v116 offset:63616
    s_waitcnt lgkmcnt(2)
    v_mfma_f32_4x4x4_16b_bf16 v[100:103], v[12:13], v[90:91], v[100:103]
    v_mfma_f32_4x4x4_16b_bf16 v[96:99], v[12:13], v[88:89], v[96:99]
    v_perm_b32 v112, v22, v26, s44
    v_bitop3_b32 v108, v22, v8, v114 bitop3:0xea
    v_perm_b32 v113, v23, v26, s45
    v_bitop3_b32 v109, v23, v8, v115 bitop3:0xea
    v_cvt_pk_bf16_f32 v100, v100, v101
    v_cvt_pk_bf16_f32 v101, v102, v103
    ds_wrxchg_rtn_b64 v[94:95], v111, v[100:101]
    v_cvt_pk_bf16_f32 v96, v96, v97
    v_cvt_pk_bf16_f32 v97, v98, v99
    ds_wrxchg_rtn_b64 v[92:93], v110, v[96:97]
    s_setprio 2
    s_waitcnt lgkmcnt(2)
    v_mfma_f32_4x4x4_16b_bf16 v[100:103], v[10:11], v[86:87], 0
    v_mfma_f32_4x4x4_16b_bf16 v[96:99], v[10:11], v[84:85], 0
    v_bitop3_b32 v116, v22, 0.5, -0.5 bitop3:0xa8
    v_bitop3_b32 v112, v9, v112, v116 bitop3:0xca
    v_bitop3_b32 v116, v23, 0.5, -0.5 bitop3:0xa8
    v_bitop3_b32 v113, v9, v113, v116 bitop3:0xca
    v_cmp_lt_u32 s[84:85], v8, v108
    v_pk_mul_f32 v[100:101], v[100:101], v[112:113] op_sel:[0,1] op_sel_hi:[1,1]
    v_pk_mul_f32 v[102:103], v[102:103], v[112:113] op_sel:[0,1] op_sel_hi:[1,1]
    v_pk_mul_f32 v[96:97], v[96:97], v[112:113] op_sel:[0,0] op_sel_hi:[1,0]
    v_pk_mul_f32 v[98:99], v[98:99], v[112:113] op_sel:[0,0] op_sel_hi:[1,0]
    buffer_load_dwordx4 v[48:51], v5, s[16:19], s40 offen offset:1024
    s_add_u32 s40, s40, 0x4e200
    s_waitcnt lgkmcnt(0)
    v_cmpx_ne_u64 vcc, v[94:95], v[90:91]
    s_and_b64 s[82:83], vcc, s[80:81]
    s_cbranch_scc1 L2_c17
L2_d17:
    v_mov_b64 v[104:105], v[90:91]
    v_mov_b32 v117, v111
    v_mov_b64 v[106:107], v[94:95]
    s_mov_b64 exec, -1
    s_or_b64 s[80:81], s[80:81], vcc
    v_cmpx_ne_u64 vcc, v[92:93], v[88:89]
    s_and_b64 s[82:83], vcc, s[80:81]
    s_cbranch_scc1 L2_c18
L2_d18:
    v_mov_b64 v[104:105], v[88:89]
    v_mov_b32 v117, v110
    v_mov_b64 v[106:107], v[92:93]
    s_mov_b64 exec, -1
    s_or_b64 s[80:81], s[80:81], vcc
    ds_read_b64 v[90:91], v109
    s_and_b64 exec, s[84:85], s[80:81]
    v_mfma_f32_4x4x4_16b_bf16 v[96:99], v[14:15], v[104:105], 0
    v_mov_b32 v108, v117
    s_andn2_b64 s[80:81], s[80:81], s[84:85]
    v_mfma_f32_4x4x4_16b_bf16 v[96:99], v[12:13], v[106:107], v[96:99]
    s_mov_b64 exec, -1
    ds_read_b64 v[88:89], v108
    v_and_b32 v115, 0x80000000, v27
    v_lshrrev_b32 v116, 14, v25
    v_bitop3_b32 v116, v116, v8, v115 bitop3:0xea
    ds_read_b64 v[86:87], v116 offset:63616
    v_and_b32 v114, 0x40000000, v27
    v_lshrrev_b32 v116, 14, v24
    v_bitop3_b32 v116, v116, v8, v114 bitop3:0xea
    ds_read_b64 v[84:85], v116 offset:63616
    s_waitcnt lgkmcnt(2)
    v_mfma_f32_4x4x4_16b_bf16 v[100:103], v[12:13], v[90:91], v[100:103]
    v_mfma_f32_4x4x4_16b_bf16 v[96:99], v[12:13], v[88:89], v[96:99]
    v_perm_b32 v112, v24, v26, s46
    v_bitop3_b32 v110, v24, v8, v114 bitop3:0xea
    v_perm_b32 v113, v25, v26, s47
    v_bitop3_b32 v111, v25, v8, v115 bitop3:0xea
    v_cvt_pk_bf16_f32 v100, v100, v101
    v_cvt_pk_bf16_f32 v101, v102, v103
    ds_wrxchg_rtn_b64 v[94:95], v109, v[100:101]
    v_cvt_pk_bf16_f32 v96, v96, v97
    v_cvt_pk_bf16_f32 v97, v98, v99
    ds_wrxchg_rtn_b64 v[92:93], v108, v[96:97]
    s_waitcnt lgkmcnt(2)
    v_mfma_f32_4x4x4_16b_bf16 v[100:103], v[10:11], v[86:87], 0
    v_mfma_f32_4x4x4_16b_bf16 v[96:99], v[10:11], v[84:85], 0
    v_bitop3_b32 v116, v24, 0.5, -0.5 bitop3:0xa8
    v_bitop3_b32 v112, v9, v112, v116 bitop3:0xca
    v_bitop3_b32 v116, v25, 0.5, -0.5 bitop3:0xa8
    v_bitop3_b32 v113, v9, v113, v116 bitop3:0xca
    v_pk_mul_f32 v[100:101], v[100:101], v[112:113] op_sel:[0,1] op_sel_hi:[1,1]
    v_pk_mul_f32 v[102:103], v[102:103], v[112:113] op_sel:[0,1] op_sel_hi:[1,1]
    v_pk_mul_f32 v[96:97], v[96:97], v[112:113] op_sel:[0,0] op_sel_hi:[1,0]
    v_pk_mul_f32 v[98:99], v[98:99], v[112:113] op_sel:[0,0] op_sel_hi:[1,0]
    v_and_b32 v116, 0x0fffffff, v41
    v_mov_b32 v27, v41
    buffer_load_dwordx4 v[22:25], v116, s[8:11], 0 offen
    buffer_load_dwordx3 v[24:26], v116, s[8:11], 0 offen offset:8
    s_waitcnt lgkmcnt(0)
    v_cmpx_ne_u64 vcc, v[94:95], v[90:91]
    s_and_b64 s[82:83], vcc, s[80:81]
    s_cbranch_scc1 L2_c19
L2_d19:
    v_mov_b64 v[104:105], v[90:91]
    v_mov_b32 v117, v109
    v_mov_b64 v[106:107], v[94:95]
    s_mov_b64 exec, -1
    s_or_b64 s[80:81], s[80:81], vcc
    v_cmpx_ne_u64 vcc, v[92:93], v[88:89]
    s_and_b64 s[82:83], vcc, s[80:81]
    s_cbranch_scc1 L2_c20
L2_d20:
    v_mov_b64 v[104:105], v[88:89]
    v_mov_b32 v117, v108
    v_mov_b64 v[106:107], v[92:93]
    s_mov_b64 exec, -1
    s_or_b64 s[80:81], s[80:81], vcc
    ds_read_b64 v[90:91], v111
    ds_read_b64 v[88:89], v110
    s_waitcnt vmcnt(11)
    v_and_b32 v115, 0x20000000, v33
    v_lshrrev_b32 v116, 14, v29
    v_bitop3_b32 v116, v116, v8, v115 bitop3:0xea
    ds_read_b64 v[86:87], v116 offset:63616
    v_and_b32 v114, 0x10000000, v33
    v_lshrrev_b32 v116, 14, v28
    v_bitop3_b32 v116, v116, v8, v114 bitop3:0xea
    ds_read_b64 v[84:85], v116 offset:63616
    s_waitcnt lgkmcnt(2)
    v_mfma_f32_4x4x4_16b_bf16 v[100:103], v[12:13], v[90:91], v[100:103]
    v_mfma_f32_4x4x4_16b_bf16 v[96:99], v[12:13], v[88:89], v[96:99]
    v_perm_b32 v112, v28, v32, s44
    v_bitop3_b32 v108, v28, v8, v114 bitop3:0xea
    v_perm_b32 v113, v29, v32, s45
    v_bitop3_b32 v109, v29, v8, v115 bitop3:0xea
    v_cvt_pk_bf16_f32 v100, v100, v101
    v_cvt_pk_bf16_f32 v101, v102, v103
    ds_wrxchg_rtn_b64 v[94:95], v111, v[100:101]
    v_cvt_pk_bf16_f32 v96, v96, v97
    v_cvt_pk_bf16_f32 v97, v98, v99
    ds_wrxchg_rtn_b64 v[92:93], v110, v[96:97]
    s_setprio 1
    s_waitcnt lgkmcnt(2)
    v_mfma_f32_4x4x4_16b_bf16 v[100:103], v[10:11], v[86:87], 0
    v_mfma_f32_4x4x4_16b_bf16 v[96:99], v[10:11], v[84:85], 0
    v_bitop3_b32 v116, v28, 0.5, -0.5 bitop3:0xa8
    v_bitop3_b32 v112, v9, v112, v116 bitop3:0xca
    v_bitop3_b32 v116, v29, 0.5, -0.5 bitop3:0xa8
    v_bitop3_b32 v113, v9, v113, v116 bitop3:0xca
    v_cmp_lt_u32 s[84:85], v8, v108
    v_pk_mul_f32 v[100:101], v[100:101], v[112:113] op_sel:[0,1] op_sel_hi:[1,1]
    v_pk_mul_f32 v[102:103], v[102:103], v[112:113] op_sel:[0,1] op_sel_hi:[1,1]
    v_pk_mul_f32 v[96:97], v[96:97], v[112:113] op_sel:[0,0] op_sel_hi:[1,0]
    v_pk_mul_f32 v[98:99], v[98:99], v[112:113] op_sel:[0,0] op_sel_hi:[1,0]
    s_waitcnt lgkmcnt(0)
    v_cmpx_ne_u64 vcc, v[94:95], v[90:91]
    s_and_b64 s[82:83], vcc, s[80:81]
    s_cbranch_scc1 L2_c21
L2_d21:
    v_mov_b64 v[104:105], v[90:91]
    v_mov_b32 v117, v111
    v_mov_b64 v[106:107], v[94:95]
    s_mov_b64 exec, -1
    s_or_b64 s[80:81], s[80:81], vcc
    v_cmpx_ne_u64 vcc, v[92:93], v[88:89]
    s_and_b64 s[82:83], vcc, s[80:81]
    s_cbranch_scc1 L2_c22
L2_d22:
    v_mov_b64 v[104:105], v[88:89]
    v_mov_b32 v117, v110
    v_mov_b64 v[106:107], v[92:93]
    s_mov_b64 exec, -1
    s_or_b64 s[80:81], s[80:81], vcc
    ds_read_b64 v[90:91], v109
    s_and_b64 exec, s[84:85], s[80:81]
    v_mfma_f32_4x4x4_16b_bf16 v[96:99], v[14:15], v[104:105], 0
    v_mov_b32 v108, v117
    s_andn2_b64 s[80:81], s[80:81], s[84:85]
    v_mfma_f32_4x4x4_16b_bf16 v[96:99], v[12:13], v[106:107], v[96:99]
    s_mov_b64 exec, -1
    ds_read_b64 v[88:89], v108
    v_and_b32 v115, 0x80000000, v33
    v_lshrrev_b32 v116, 14, v31
    v_bitop3_b32 v116, v116, v8, v115 bitop3:0xea
    ds_read_b64 v[86:87], v116 offset:63616
    v_and_b32 v114, 0x40000000, v33
    v_lshrrev_b32 v116, 14, v30
    v_bitop3_b32 v116, v116, v8, v114 bitop3:0xea
    ds_read_b64 v[84:85], v116 offset:63616
    s_waitcnt lgkmcnt(2)
    v_mfma_f32_4x4x4_16b_bf16 v[100:103], v[12:13], v[90:91], v[100:103]
    v_mfma_f32_4x4x4_16b_bf16 v[96:99], v[12:13], v[88:89], v[96:99]
    v_perm_b32 v112, v30, v32, s46
    v_bitop3_b32 v110, v30, v8, v114 bitop3:0xea
    v_perm_b32 v113, v31, v32, s47
    v_bitop3_b32 v111, v31, v8, v115 bitop3:0xea
    v_cvt_pk_bf16_f32 v100, v100, v101
    v_cvt_pk_bf16_f32 v101, v102, v103
    ds_wrxchg_rtn_b64 v[94:95], v109, v[100:101]
    v_cvt_pk_bf16_f32 v96, v96, v97
    v_cvt_pk_bf16_f32 v97, v98, v99
    ds_wrxchg_rtn_b64 v[92:93], v108, v[96:97]
    s_waitcnt lgkmcnt(2)
    v_mfma_f32_4x4x4_16b_bf16 v[100:103], v[10:11], v[86:87], 0
    v_mfma_f32_4x4x4_16b_bf16 v[96:99], v[10:11], v[84:85], 0
    v_bitop3_b32 v116, v30, 0.5, -0.5 bitop3:0xa8
    v_bitop3_b32 v112, v9, v112, v116 bitop3:0xca
    v_bitop3_b32 v116, v31, 0.5, -0.5 bitop3:0xa8
    v_bitop3_b32 v113, v9, v113, v116 bitop3:0xca
    v_pk_mul_f32 v[100:101], v[100:101], v[112:113] op_sel:[0,1] op_sel_hi:[1,1]
    v_pk_mul_f32 v[102:103], v[102:103], v[112:113] op_sel:[0,1] op_sel_hi:[1,1]
    v_pk_mul_f32 v[96:97], v[96:97], v[112:113] op_sel:[0,0] op_sel_hi:[1,0]
    v_pk_mul_f32 v[98:99], v[98:99], v[112:113] op_sel:[0,0] op_sel_hi:[1,0]
    v_and_b32 v116, 0x0fffffff, v42
    v_mov_b32 v33, v42
    buffer_load_dwordx4 v[28:31], v116, s[8:11], 0 offen
    buffer_load_dwordx3 v[30:32], v116, s[8:11], 0 offen offset:8
    s_waitcnt lgkmcnt(0)
    v_cmpx_ne_u64 vcc, v[94:95], v[90:91]
    s_and_b64 s[82:83], vcc, s[80:81]
    s_cbranch_scc1 L2_c23
L2_d23:
    v_mov_b64 v[104:105], v[90:91]
    v_mov_b32 v117, v109
    v_mov_b64 v[106:107], v[94:95]
    s_mov_b64 exec, -1
    s_or_b64 s[80:81], s[80:81], vcc
    v_cmpx_ne_u64 vcc, v[92:93], v[88:89]
    s_and_b64 s[82:83], vcc, s[80:81]
    s_cbranch_scc1 L2_c24
L2_d24:
    v_mov_b64 v[104:105], v[88:89]
    v_mov_b32 v117, v108
    v_mov_b64 v[106:107], v[92:93]
    s_mov_b64 exec, -1
    s_or_b64 s[80:81], s[80:81], vcc
    ds_read_b64 v[90:91], v111
    ds_read_b64 v[88:89], v110
    s_waitcnt vmcnt(11)
    v_and_b32 v115, 0x20000000, v39
    v_lshrrev_b32 v116, 14, v35
    v_bitop3_b32 v116, v116, v8, v115 bitop3:0xea
    ds_read_b64 v[86:87], v116 offset:63616
    v_and_b32 v114, 0x10000000, v39
    v_lshrrev_b32 v116, 14, v34
    v_bitop3_b32 v116, v116, v8, v114 bitop3:0xea
    ds_read_b64 v[84:85], v116 offset:63616
    s_waitcnt lgkmcnt(2)
    v_mfma_f32_4x4x4_16b_bf16 v[100:103], v[12:13], v[90:91], v[100:103]
    v_mfma_f32_4x4x4_16b_bf16 v[96:99], v[12:13], v[88:89], v[96:99]
    v_perm_b32 v112, v34, v38, s44
    v_bitop3_b32 v108, v34, v8, v114 bitop3:0xea
    v_perm_b32 v113, v35, v38, s45
    v_bitop3_b32 v109, v35, v8, v115 bitop3:0xea
    v_cvt_pk_bf16_f32 v100, v100, v101
    v_cvt_pk_bf16_f32 v101, v102, v103
    ds_wrxchg_rtn_b64 v[94:95], v111, v[100:101]
    v_cvt_pk_bf16_f32 v96, v96, v97
    v_cvt_pk_bf16_f32 v97, v98, v99
    ds_wrxchg_rtn_b64 v[92:93], v110, v[96:97]
    s_setprio 0
    s_waitcnt lgkmcnt(2)
    v_mfma_f32_4x4x4_16b_bf16 v[100:103], v[10:11], v[86:87], 0
    v_mfma_f32_4x4x4_16b_bf16 v[96:99], v[10:11], v[84:85], 0
    v_bitop3_b32 v116, v34, 0.5, -0.5 bitop3:0xa8
    v_bitop3_b32 v112, v9, v112, v116 bitop3:0xca
    v_bitop3_b32 v116, v35, 0.5, -0.5 bitop3:0xa8
    v_bitop3_b32 v113, v9, v113, v116 bitop3:0xca
    v_cmp_lt_u32 s[84:85], v8, v108
    v_pk_mul_f32 v[100:101], v[100:101], v[112:113] op_sel:[0,1] op_sel_hi:[1,1]
    v_pk_mul_f32 v[102:103], v[102:103], v[112:113] op_sel:[0,1] op_sel_hi:[1,1]
    v_pk_mul_f32 v[96:97], v[96:97], v[112:113] op_sel:[0,0] op_sel_hi:[1,0]
    v_pk_mul_f32 v[98:99], v[98:99], v[112:113] op_sel:[0,0] op_sel_hi:[1,0]
    s_waitcnt lgkmcnt(0)
    v_cmpx_ne_u64 vcc, v[94:95], v[90:91]
    s_and_b64 s[82:83], vcc, s[80:81]
    s_cbranch_scc1 L2_c25
L2_d25:
    v_mov_b64 v[104:105], v[90:91]
    v_mov_b32 v117, v111
    v_mov_b64 v[106:107], v[94:95]
    s_mov_b64 exec, -1
    s_or_b64 s[80:81], s[80:81], vcc
    v_cmpx_ne_u64 vcc, v[92:93], v[88:89]
    s_and_b64 s[82:83], vcc, s[80:81]
    s_cbranch_scc1 L2_c26
L2_d26:
    v_mov_b64 v[104:105], v[88:89]
    v_mov_b32 v117, v110
    v_mov_b64 v[106:107], v[92:93]
    s_mov_b64 exec, -1
    s_or_b64 s[80:81], s[80:81], vcc
    ds_read_b64 v[90:91], v109
    s_and_b64 exec, s[84:85], s[80:81]
    v_mfma_f32_4x4x4_16b_bf16 v[96:99], v[14:15], v[104:105], 0
    v_mov_b32 v108, v117
    s_andn2_b64 s[80:81], s[80:81], s[84:85]
    v_mfma_f32_4x4x4_16b_bf16 v[96:99], v[12:13], v[106:107], v[96:99]
    s_mov_b64 exec, -1
    ds_read_b64 v[88:89], v108
    v_and_b32 v115, 0x80000000, v39
    v_lshrrev_b32 v116, 14, v37
    v_bitop3_b32 v116, v116, v8, v115 bitop3:0xea
    ds_read_b64 v[86:87], v116 offset:63616
    v_and_b32 v114, 0x40000000, v39
    v_lshrrev_b32 v116, 14, v36
    v_bitop3_b32 v116, v116, v8, v114 bitop3:0xea
    ds_read_b64 v[84:85], v116 offset:63616
    s_waitcnt lgkmcnt(2)
    v_mfma_f32_4x4x4_16b_bf16 v[100:103], v[12:13], v[90:91], v[100:103]
    v_mfma_f32_4x4x4_16b_bf16 v[96:99], v[12:13], v[88:89], v[96:99]
    v_perm_b32 v112, v36, v38, s46
    v_bitop3_b32 v110, v36, v8, v114 bitop3:0xea
    v_perm_b32 v113, v37, v38, s47
    v_bitop3_b32 v111, v37, v8, v115 bitop3:0xea
    v_cvt_pk_bf16_f32 v100, v100, v101
    v_cvt_pk_bf16_f32 v101, v102, v103
    ds_wrxchg_rtn_b64 v[94:95], v109, v[100:101]
    v_cvt_pk_bf16_f32 v96, v96, v97
    v_cvt_pk_bf16_f32 v97, v98, v99
    ds_wrxchg_rtn_b64 v[92:93], v108, v[96:97]
    s_waitcnt lgkmcnt(2)
    v_mfma_f32_4x4x4_16b_bf16 v[100:103], v[10:11], v[86:87], 0
    v_mfma_f32_4x4x4_16b_bf16 v[96:99], v[10:11], v[84:85], 0
    v_bitop3_b32 v116, v36, 0.5, -0.5 bitop3:0xa8
    v_bitop3_b32 v112, v9, v112, v116 bitop3:0xca
    v_bitop3_b32 v116, v37, 0.5, -0.5 bitop3:0xa8
    v_bitop3_b32 v113, v9, v113, v116 bitop3:0xca
    v_pk_mul_f32 v[100:101], v[100:101], v[112:113] op_sel:[0,1] op_sel_hi:[1,1]
    v_pk_mul_f32 v[102:103], v[102:103], v[112:113] op_sel:[0,1] op_sel_hi:[1,1]
    v_pk_mul_f32 v[96:97], v[96:97], v[112:113] op_sel:[0,0] op_sel_hi:[1,0]
    v_pk_mul_f32 v[98:99], v[98:99], v[112:113] op_sel:[0,0] op_sel_hi:[1,0]
    v_and_b32 v116, 0x0fffffff, v43
    v_mov_b32 v39, v43
    buffer_load_dwordx4 v[34:37], v116, s[8:11], 0 offen
    buffer_load_dwordx3 v[36:38], v116, s[8:11], 0 offen offset:8
    s_waitcnt lgkmcnt(0)
    v_cmpx_ne_u64 vcc, v[94:95], v[90:91]
    s_and_b64 s[82:83], vcc, s[80:81]
    s_cbranch_scc1 L2_c27
L2_d27:
    v_mov_b64 v[104:105], v[90:91]
    v_mov_b32 v117, v109
    v_mov_b64 v[106:107], v[94:95]
    s_mov_b64 exec, -1
    s_or_b64 s[80:81], s[80:81], vcc
    v_cmpx_ne_u64 vcc, v[92:93], v[88:89]
    s_and_b64 s[82:83], vcc, s[80:81]
    s_cbranch_scc1 L2_c28
L2_d28:
    v_mov_b64 v[104:105], v[88:89]
    v_mov_b32 v117, v108
    v_mov_b64 v[106:107], v[92:93]
    s_mov_b64 exec, -1
    s_or_b64 s[80:81], s[80:81], vcc
    ds_read_b64 v[90:91], v111
    ds_read_b64 v[88:89], v110
    s_waitcnt lgkmcnt(0)
    v_mfma_f32_4x4x4_16b_bf16 v[100:103], v[12:13], v[90:91], v[100:103]
    v_mfma_f32_4x4x4_16b_bf16 v[96:99], v[12:13], v[88:89], v[96:99]
    s_nop 3
    v_cvt_pk_bf16_f32 v100, v100, v101
    v_cvt_pk_bf16_f32 v101, v102, v103
    ds_wrxchg_rtn_b64 v[94:95], v111, v[100:101]
    v_cvt_pk_bf16_f32 v96, v96, v97
    v_cvt_pk_bf16_f32 v97, v98, v99
    ds_wrxchg_rtn_b64 v[92:93], v110, v[96:97]
    s_barrier
    s_waitcnt vmcnt(12)
    ds_write_b128 v7, v[52:55] offset:2048
    buffer_load_dwordx4 v[52:55], v5, s[16:19], s40 offen offset:2048
    s_mov_b32 s37, s38
    s_setprio 3
    v_and_b32_dpp v118, v64, v6 quad_perm:[1,1,1,1] row_mask:0xf bank_mask:0xf
    v_and_b32_dpp v119, v64, v6 quad_perm:[3,3,3,3] row_mask:0xf bank_mask:0xf
    v_and_b32 v120, -4, v118
    v_add_u32 v120, v120, v2
L2_x29:
    v_sub_u32 v121, v119, v120
    v_sub_u32 v123, v118, v120
    v_med3_i32 v122, v121, 0, 4
    v_max_i32 v123, 0, v123
    v_cmp_gt_i32 vcc, v122, v123
    v_mad_u32_u24 v124, v120, 5, v4
    v_bfm_b32 v122, v122, 28
    v_bfm_b32 v123, v123, 28
    v_mbcnt_lo_u32_b32 v125, vcc_lo, 0
    v_mbcnt_hi_u32_b32 v125, vcc_hi, v125
    v_bitop3_b32 v124, v122, v123, v124 bitop3:0x9a
    v_add_lshl_u32 v125, v125, s37, 2
    s_bcnt1_i32_b64 s41, vcc
    s_mov_b64 exec, vcc
    ds_write_b32 v125, v124
    s_mov_b64 exec, -1
    v_cmp_gt_i32 vcc, v121, v3
    s_add_u32 s37, s37, s41
    s_min_u32 s37, s37, s48
    s_cbranch_vccnz L2_xe29
L2_xr29:
    s_waitcnt vmcnt(12)
    ds_write_b128 v7, v[56:59] offset:3072
    buffer_load_dwordx4 v[56:59], v5, s[16:19], s40 offen offset:3072
    s_setprio 2
    v_and_b32_dpp v118, v68, v6 quad_perm:[1,1,1,1] row_mask:0xf bank_mask:0xf
    v_and_b32_dpp v119, v68, v6 quad_perm:[3,3,3,3] row_mask:0xf bank_mask:0xf
    v_and_b32 v120, -4, v118
    v_add_u32 v120, v120, v2
    v_add_u32 v126, 0x2a4000, v4
L2_x30:
    v_sub_u32 v121, v119, v120
    v_sub_u32 v123, v118, v120
    v_med3_i32 v122, v121, 0, 4
    v_max_i32 v123, 0, v123
    v_cmp_gt_i32 vcc, v122, v123
    v_mad_u32_u24 v124, v120, 5, v126
    v_bfm_b32 v122, v122, 28
    v_bfm_b32 v123, v123, 28
    v_mbcnt_lo_u32_b32 v125, vcc_lo, 0
    v_mbcnt_hi_u32_b32 v125, vcc_hi, v125
    v_bitop3_b32 v124, v122, v123, v124 bitop3:0x9a
    v_add_lshl_u32 v125, v125, s37, 2
    s_bcnt1_i32_b64 s41, vcc
    s_mov_b64 exec, vcc
    ds_write_b32 v125, v124
    s_mov_b64 exec, -1
    v_cmp_gt_i32 vcc, v121, v3
    s_add_u32 s37, s37, s41
    s_min_u32 s37, s37, s48
    s_cbranch_vccnz L2_xe30
L2_xr30:
    s_waitcnt vmcnt(12)
    ds_write_b128 v7, v[60:63] offset:4096
    s_add_u32 s3, s40, 4096
    buffer_load_dwordx4 v[60:63], v5, s[16:19], s3 offen
    s_setprio 1
    v_and_b32_dpp v118, v72, v6 quad_perm:[1,1,1,1] row_mask:0xf bank_mask:0xf
    v_and_b32_dpp v119, v72, v6 quad_perm:[3,3,3,3] row_mask:0xf bank_mask:0xf
    v_and_b32 v120, -4, v118
    v_add_u32 v120, v120, v2
    v_add_u32 v126, 0x548000, v4
L2_x31:
    v_sub_u32 v121, v119, v120
    v_sub_u32 v123, v118, v120
    v_med3_i32 v122, v121, 0, 4
    v_max_i32 v123, 0, v123
    v_cmp_gt_i32 vcc, v122, v123
    v_mad_u32_u24 v124, v120, 5, v126
    v_bfm_b32 v122, v122, 28
    v_bfm_b32 v123, v123, 28
    v_mbcnt_lo_u32_b32 v125, vcc_lo, 0
    v_mbcnt_hi_u32_b32 v125, vcc_hi, v125
    v_bitop3_b32 v124, v122, v123, v124 bitop3:0x9a
    v_add_lshl_u32 v125, v125, s37, 2
    s_bcnt1_i32_b64 s41, vcc
    s_mov_b64 exec, vcc
    ds_write_b32 v125, v124
    s_mov_b64 exec, -1
    v_cmp_gt_i32 vcc, v121, v3
    s_add_u32 s37, s37, s41
    s_min_u32 s37, s37, s48
    s_cbranch_vccnz L2_xe31
L2_xr31:
    s_setprio 0
    v_and_b32_dpp v118, v76, v6 quad_perm:[1,1,1,1] row_mask:0xf bank_mask:0xf
    v_and_b32_dpp v119, v76, v6 quad_perm:[3,3,3,3] row_mask:0xf bank_mask:0xf
    v_and_b32 v120, -4, v118
    v_add_u32 v120, v120, v2
    v_add_u32 v126, 0x7ec000, v4
L2_x32:
    v_sub_u32 v121, v119, v120
    v_sub_u32 v123, v118, v120
    v_med3_i32 v122, v121, 0, 4
    v_max_i32 v123, 0, v123
    v_cmp_gt_i32 vcc, v122, v123
    v_mad_u32_u24 v124, v120, 5, v126
    v_bfm_b32 v122, v122, 28
    v_bfm_b32 v123, v123, 28
    v_mbcnt_lo_u32_b32 v125, vcc_lo, 0
    v_mbcnt_hi_u32_b32 v125, vcc_hi, v125
    v_bitop3_b32 v124, v122, v123, v124 bitop3:0x9a
    v_add_lshl_u32 v125, v125, s37, 2
    s_bcnt1_i32_b64 s41, vcc
    s_mov_b64 exec, vcc
    ds_write_b32 v125, v124
    s_mov_b64 exec, -1
    v_cmp_gt_i32 vcc, v121, v3
    s_add_u32 s37, s37, s41
    s_min_u32 s37, s37, s48
    s_cbranch_vccnz L2_xe32
L2_xr32:
    v_and_b32_dpp v118, v80, v6 quad_perm:[1,1,1,1] row_mask:0xf bank_mask:0xf
    v_and_b32_dpp v119, v80, v6 quad_perm:[3,3,3,3] row_mask:0xf bank_mask:0xf
    v_and_b32 v120, -4, v118
    v_add_u32 v120, v120, v2
    v_add_u32 v126, 0xa90000, v4
L2_x33:
    v_sub_u32 v121, v119, v120
    v_sub_u32 v123, v118, v120
    v_med3_i32 v122, v121, 0, 4
    v_max_i32 v123, 0, v123
    v_cmp_gt_i32 vcc, v122, v123
    v_mad_u32_u24 v124, v120, 5, v126
    v_bfm_b32 v122, v122, 28
    v_bfm_b32 v123, v123, 28
    v_mbcnt_lo_u32_b32 v125, vcc_lo, 0
    v_mbcnt_hi_u32_b32 v125, vcc_hi, v125
    v_bitop3_b32 v124, v122, v123, v124 bitop3:0x9a
    v_add_lshl_u32 v125, v125, s37, 2
    s_bcnt1_i32_b64 s41, vcc
    s_mov_b64 exec, vcc
    ds_write_b32 v125, v124
    s_mov_b64 exec, -1
    v_cmp_gt_i32 vcc, v121, v3
    s_add_u32 s37, s37, s41
    s_min_u32 s37, s37, s48
    s_cbranch_vccnz L2_xe33
L2_xr33:
    s_lshl_b32 s3, s37, 2
    v_add_u32 v125, s3, v1
    v_mov_b32 v124, -1
    ds_write_b32 v125, v124
    s_lshl_b32 s3, s38, 2
    v_add_u32 v125, s3, v1
    ds_read2st64_b32 v[40:41], v125 offset0:0 offset1:1
    ds_read2st64_b32 v[42:43], v125 offset0:2 offset1:3
    s_sub_u32 s41, s37, s38
    s_sub_u32 s3, s41, 192
    s_cmp_gt_u32 s3, 64
    s_cbranch_scc1 L2_xf34
L2_xg34:
    s_waitcnt vmcnt(12)
    ds_write_b128 v7, v[44:47] offset:0
    s_waitcnt vmcnt(9)
    ds_write_b128 v7, v[48:51] offset:1024
    s_add_u32 s42, s42, 1
    s_waitcnt lgkmcnt(0)
    s_barrier
    s_setprio 3
    s_bitcmp1_b32 s36, s42
    s_cbranch_scc1 L2_slow
L2_ret1:
    v_and_b32 v115, 0x20000000, v21
    v_lshrrev_b32 v116, 14, v17
    v_bitop3_b32 v116, v116, v8, v115 bitop3:0xea
    ds_read_b64 v[86:87], v116 offset:63616
    v_and_b32 v114, 0x10000000, v21
    v_lshrrev_b32 v116, 14, v16
    v_bitop3_b32 v116, v116, v8, v114 bitop3:0xea
    ds_read_b64 v[84:85], v116 offset:63616
    v_perm_b32 v112, v16, v20, s44
    v_bitop3_b32 v108, v16, v8, v114 bitop3:0xea
    v_perm_b32 v113, v17, v20, s45
    v_bitop3_b32 v109, v17, v8, v115 bitop3:0xea
    s_waitcnt lgkmcnt(0)
    v_mfma_f32_4x4x4_16b_bf16 v[100:103], v[10:11], v[86:87], 0
    v_mfma_f32_4x4x4_16b_bf16 v[96:99], v[10:11], v[84:85], 0
    v_bitop3_b32 v116, v16, 0.5, -0.5 bitop3:0xa8
    v_bitop3_b32 v112, v9, v112, v116 bitop3:0xca
    v_bitop3_b32 v116, v17, 0.5, -0.5 bitop3:0xa8
    v_bitop3_b32 v113, v9, v113, v116 bitop3:0xca
    v_cmp_lt_u32 s[84:85], v8, v108
    v_pk_mul_f32 v[100:101], v[100:101], v[112:113] op_sel:[0,1] op_sel_hi:[1,1]
    v_pk_mul_f32 v[102:103], v[102:103], v[112:113] op_sel:[0,1] op_sel_hi:[1,1]
    v_pk_mul_f32 v[96:97], v[96:97], v[112:113] op_sel:[0,0] op_sel_hi:[1,0]
    v_pk_mul_f32 v[98:99], v[98:99], v[112:113] op_sel:[0,0] op_sel_hi:[1,0]
    buffer_load_dwordx4 v[44:47], v5, s[16:19], s40 offen offset:0
    v_cmpx_ne_u64 vcc, v[94:95], v[90:91]
    s_and_b64 s[82:83], vcc, s[80:81]
    s_cbranch_scc1 L2_c35
L2_d35:
    v_mov_b64 v[104:105], v[90:91]
    v_mov_b32 v117, v111
    v_mov_b64 v[106:107], v[94:95]
    s_mov_b64 exec, -1
    s_or_b64 s[80:81], s[80:81], vcc
    v_cmpx_ne_u64 vcc, v[92:93], v[88:89]
    s_and_b64 s[82:83], vcc, s[80:81]
    s_cbranch_scc1 L2_c36
L2_d36:
    v_mov_b64 v[104:105], v[88:89]
    v_mov_b32 v117, v110
    v_mov_b64 v[106:107], v[92:93]
    s_mov_b64 exec, -1
    s_or_b64 s[80:81], s[80:81], vcc
    ds_read_b64 v[90:91], v109
    s_and_b64 exec, s[84:85], s[80:81]
    v_mfma_f32_4x4x4_16b_bf16 v[96:99], v[14:15], v[104:105], 0
    v_mov_b32 v108, v117
    s_andn2_b64 s[80:81], s[80:81], s[84:85]
    v_mfma_f32_4x4x4_16b_bf16 v[96:99], v[12:13], v[106:107], v[96:99]
    s_mov_b64 exec, -1
    ds_read_b64 v[88:89], v108
    v_and_b32 v115, 0x80000000, v21
    v_lshrrev_b32 v116, 14, v19
    v_bitop3_b32 v116, v116, v8, v115 bitop3:0xea
    ds_read_b64 v[86:87], v116 offset:63616
    v_and_b32 v114, 0x40000000, v21
    v_lshrrev_b32 v116, 14, v18
    v_bitop3_b32 v116, v116, v8, v114 bitop3:0xea
    ds_read_b64 v[84:85], v116 offset:63616
    s_waitcnt lgkmcnt(2)
    v_mfma_f32_4x4x4_16b_bf16 v[100:103], v[12:13], v[90:91], v[100:103]
    v_mfma_f32_4x4x4_16b_bf16 v[96:99], v[12:13], v[88:89], v[96:99]
    v_perm_b32 v112, v18, v20, s46
    v_bitop3_b32 v110, v18, v8, v114 bitop3:0xea
    v_perm_b32 v113, v19, v20, s47
    v_bitop3_b32 v111, v19, v8, v115 bitop3:0xea
    v_cvt_pk_bf16_f32 v100, v100, v101
    v_cvt_pk_bf16_f32 v101, v102, v103
    ds_wrxchg_rtn_b64 v[94:95], v109, v[100:101]
    v_cvt_pk_bf16_f32 v96, v96, v97
    v_cvt_pk_bf16_f32 v97, v98, v99
    ds_wrxchg_rtn_b64 v[92:93], v108, v[96:97]
    s_waitcnt lgkmcnt(2)
    v_mfma_f32_4x4x4_16b_bf16 v[100:103], v[10:11], v[86:87], 0
    v_mfma_f32_4x4x4_16b_bf16 v[96:99], v[10:11], v[84:85], 0
    v_bitop3_b32 v116, v18, 0.5, -0.5 bitop3:0xa8
    v_bitop3_b32 v112, v9, v112, v116 bitop3:0xca
    v_bitop3_b32 v116, v19, 0.5, -0.5 bitop3:0xa8
    v_bitop3_b32 v113, v9, v113, v116 bitop3:0xca
    v_pk_mul_f32 v[100:101], v[100:101], v[112:113] op_sel:[0,1] op_sel_hi:[1,1]
    v_pk_mul_f32 v[102:103], v[102:103], v[112:113] op_sel:[0,1] op_sel_hi:[1,1]
    v_pk_mul_f32 v[96:97], v[96:97], v[112:113] op_sel:[0,0] op_sel_hi:[1,0]
    v_pk_mul_f32 v[98:99], v[98:99], v[112:113] op_sel:[0,0] op_sel_hi:[1,0]
    v_and_b32 v116, 0x0fffffff, v40
    v_mov_b32 v21, v40
    buffer_load_dwordx4 v[16:19], v116, s[8:11], 0 offen
    buffer_load_dwordx3 v[18:20], v116, s[8:11], 0 offen offset:8
    s_waitcnt lgkmcnt(0)
    v_cmpx_ne_u64 vcc, v[94:95], v[90:91]
    s_and_b64 s[82:83], vcc, s[80:81]
    s_cbranch_scc1 L2_c37
L2_d37:
    v_mov_b64 v[104:105], v[90:91]
    v_mov_b32 v117, v109
    v_mov_b64 v[106:107], v[94:95]
    s_mov_b64 exec, -1
    s_or_b64 s[80:81], s[80:81], vcc
    v_cmpx_ne_u64 vcc, v[92:93], v[88:89]
    s_and_b64 s[82:83], vcc, s[80:81]
    s_cbranch_scc1 L2_c38
L2_d38:
    v_mov_b64 v[104:105], v[88:89]
    v_mov_b32 v117, v108
    v_mov_b64 v[106:107], v[92:93]
    s_mov_b64 exec, -1
    s_or_b64 s[80:81], s[80:81], vcc
    ds_read_b64 v[90:91], v111
    ds_read_b64 v[88:89], v110
    s_waitcnt vmcnt(10)
    v_and_b32 v115, 0x20000000, v27
    v_lshrrev_b32 v116, 14, v23
    v_bitop3_b32 v116, v116, v8, v115 bitop3:0xea
    ds_read_b64 v[86:87], v116 offset:63616
    v_and_b32 v114, 0x10000000, v27
    v_lshrrev_b32 v116, 14, v22
    v_bitop3_b32 v116, v116, v8, v114 bitop3:0xea
    ds_read_b64 v[84:85], v116 offset:63616
    s_waitcnt lgkmcnt(2)
    v_mfma_f32_4x4x4_16b_bf16 v[100:103], v[12:13], v[90:91], v[100:103]
    v_mfma_f32_4x4x4_16b_bf16 v[96:99], v[12:13], v[88:89], v[96:99]
    v_perm_b32 v112, v22, v26, s44
    v_bitop3_b32 v108, v22, v8, v114 bitop3:0xea
    v_perm_b32 v113, v23, v26, s45
    v_bitop3_b32 v109, v23, v8, v115 bitop3:0xea
    v_cvt_pk_bf16_f32 v100, v100, v101
    v_cvt_pk_bf16_f32 v101, v102, v103
    ds_wrxchg_rtn_b64 v[94:95], v111, v[100:101]
    v_cvt_pk_bf16_f32 v96, v96, v97
    v_cvt_pk_bf16_f32 v97, v98, v99
    ds_wrxchg_rtn_b64 v[92:93], v110, v[96:97]
    s_setprio 2
    s_waitcnt lgkmcnt(2)
    v_mfma_f32_4x4x4_16b_bf16 v[100:103], v[10:11], v[86:87], 0
    v_mfma_f32_4x4x4_16b_bf16 v[96:99], v[10:11], v[84:85], 0
    v_bitop3_b32 v116, v22, 0.5, -0.5 bitop3:0xa8
    v_bitop3_b32 v112, v9, v112, v116 bitop3:0xca
    v_bitop3_b32 v116, v23, 0.5, -0.5 bitop3:0xa8
    v_bitop3_b32 v113, v9, v113, v116 bitop3:0xca
    v_cmp_lt_u32 s[84:85], v8, v108
    v_pk_mul_f32 v[100:101], v[100:101], v[112:113] op_sel:[0,1] op_sel_hi:[1,1]
    v_pk_mul_f32 v[102:103], v[102:103], v[112:113] op_sel:[0,1] op_sel_hi:[1,1]
    v_pk_mul_f32 v[96:97], v[96:97], v[112:113] op_sel:[0,0] op_sel_hi:[1,0]
    v_pk_mul_f32 v[98:99], v[98:99], v[112:113] op_sel:[0,0] op_sel_hi:[1,0]
    buffer_load_dwordx4 v[48:51], v5, s[16:19], s40 offen offset:1024
    s_add_u32 s40, s40, 0x4e200
    s_waitcnt lgkmcnt(0)
    v_cmpx_ne_u64 vcc, v[94:95], v[90:91]
    s_and_b64 s[82:83], vcc, s[80:81]
    s_cbranch_scc1 L2_c39
L2_d39:
    v_mov_b64 v[104:105], v[90:91]
    v_mov_b32 v117, v111
    v_mov_b64 v[106:107], v[94:95]
    s_mov_b64 exec, -1
    s_or_b64 s[80:81], s[80:81], vcc
    v_cmpx_ne_u64 vcc, v[92:93], v[88:89]
    s_and_b64 s[82:83], vcc, s[80:81]
    s_cbranch_scc1 L2_c40
L2_d40:
    v_mov_b64 v[104:105], v[88:89]
    v_mov_b32 v117, v110
    v_mov_b64 v[106:107], v[92:93]
    s_mov_b64 exec, -1
    s_or_b64 s[80:81], s[80:81], vcc
    ds_read_b64 v[90:91], v109
    s_and_b64 exec, s[84:85], s[80:81]
    v_mfma_f32_4x4x4_16b_bf16 v[96:99], v[14:15], v[104:105], 0
    v_mov_b32 v108, v117
    s_andn2_b64 s[80:81], s[80:81], s[84:85]
    v_mfma_f32_4x4x4_16b_bf16 v[96:99], v[12:13], v[106:107], v[96:99]
    s_mov_b64 exec, -1
    ds_read_b64 v[88:89], v108
    v_and_b32 v115, 0x80000000, v27
    v_lshrrev_b32 v116, 14, v25
    v_bitop3_b32 v116, v116, v8, v115 bitop3:0xea
    ds_read_b64 v[86:87], v116 offset:63616
    v_and_b32 v114, 0x40000000, v27
    v_lshrrev_b32 v116, 14, v24
    v_bitop3_b32 v116, v116, v8, v114 bitop3:0xea
    ds_read_b64 v[84:85], v116 offset:63616
    s_waitcnt lgkmcnt(2)
    v_mfma_f32_4x4x4_16b_bf16 v[100:103], v[12:13], v[90:91], v[100:103]
    v_mfma_f32_4x4x4_16b_bf16 v[96:99], v[12:13], v[88:89], v[96:99]
    v_perm_b32 v112, v24, v26, s46
    v_bitop3_b32 v110, v24, v8, v114 bitop3:0xea
    v_perm_b32 v113, v25, v26, s47
    v_bitop3_b32 v111, v25, v8, v115 bitop3:0xea
    v_cvt_pk_bf16_f32 v100, v100, v101
    v_cvt_pk_bf16_f32 v101, v102, v103
    ds_wrxchg_rtn_b64 v[94:95], v109, v[100:101]
    v_cvt_pk_bf16_f32 v96, v96, v97
    v_cvt_pk_bf16_f32 v97, v98, v99
    ds_wrxchg_rtn_b64 v[92:93], v108, v[96:97]
    s_waitcnt lgkmcnt(2)
    v_mfma_f32_4x4x4_16b_bf16 v[100:103], v[10:11], v[86:87], 0
    v_mfma_f32_4x4x4_16b_bf16 v[96:99], v[10:11], v[84:85], 0
    v_bitop3_b32 v116, v24, 0.5, -0.5 bitop3:0xa8
    v_bitop3_b32 v112, v9, v112, v116 bitop3:0xca
    v_bitop3_b32 v116, v25, 0.5, -0.5 bitop3:0xa8
    v_bitop3_b32 v113, v9, v113, v116 bitop3:0xca
    v_pk_mul_f32 v[100:101], v[100:101], v[112:113] op_sel:[0,1] op_sel_hi:[1,1]
    v_pk_mul_f32 v[102:103], v[102:103], v[112:113] op_sel:[0,1] op_sel_hi:[1,1]
    v_pk_mul_f32 v[96:97], v[96:97], v[112:113] op_sel:[0,0] op_sel_hi:[1,0]
    v_pk_mul_f32 v[98:99], v[98:99], v[112:113] op_sel:[0,0] op_sel_hi:[1,0]
    v_and_b32 v116, 0x0fffffff, v41
    v_mov_b32 v27, v41
    buffer_load_dwordx4 v[22:25], v116, s[8:11], 0 offen
    buffer_load_dwordx3 v[24:26], v116, s[8:11], 0 offen offset:8
    s_waitcnt lgkmcnt(0)
    v_cmpx_ne_u64 vcc, v[94:95], v[90:91]
    s_and_b64 s[82:83], vcc, s[80:81]
    s_cbranch_scc1 L2_c41
L2_d41:
    v_mov_b64 v[104:105], v[90:91]
    v_mov_b32 v117, v109
    v_mov_b64 v[106:107], v[94:95]
    s_mov_b64 exec, -1
    s_or_b64 s[80:81], s[80:81], vcc
    v_cmpx_ne_u64 vcc, v[92:93], v[88:89]
    s_and_b64 s[82:83], vcc, s[80:81]
    s_cbranch_scc1 L2_c42
L2_d42:
    v_mov_b64 v[104:105], v[88:89]
    v_mov_b32 v117, v108
    v_mov_b64 v[106:107], v[92:93]
    s_mov_b64 exec, -1
    s_or_b64 s[80:81], s[80:81], vcc
    ds_read_b64 v[90:91], v111
    ds_read_b64 v[88:89], v110
    s_waitcnt vmcnt(11)
    v_and_b32 v115, 0x20000000, v33
    v_lshrrev_b32 v116, 14, v29
    v_bitop3_b32 v116, v116, v8, v115 bitop3:0xea
    ds_read_b64 v[86:87], v116 offset:63616
    v_and_b32 v114, 0x10000000, v33
    v_lshrrev_b32 v116, 14, v28
    v_bitop3_b32 v116, v116, v8, v114 bitop3:0xea
    ds_read_b64 v[84:85], v116 offset:63616
    s_waitcnt lgkmcnt(2)
    v_mfma_f32_4x4x4_16b_bf16 v[100:103], v[12:13], v[90:91], v[100:103]
    v_mfma_f32_4x4x4_16b_bf16 v[96:99], v[12:13], v[88:89], v[96:99]
    v_perm_b32 v112, v28, v32, s44
    v_bitop3_b32 v108, v28, v8, v114 bitop3:0xea
    v_perm_b32 v113, v29, v32, s45
    v_bitop3_b32 v109, v29, v8, v115 bitop3:0xea
    v_cvt_pk_bf16_f32 v100, v100, v101
    v_cvt_pk_bf16_f32 v101, v102, v103
    ds_wrxchg_rtn_b64 v[94:95], v111, v[100:101]
    v_cvt_pk_bf16_f32 v96, v96, v97
    v_cvt_pk_bf16_f32 v97, v98, v99
    ds_wrxchg_rtn_b64 v[92:93], v110, v[96:97]
    s_setprio 1
    s_waitcnt lgkmcnt(2)
    v_mfma_f32_4x4x4_16b_bf16 v[100:103], v[10:11], v[86:87], 0
    v_mfma_f32_4x4x4_16b_bf16 v[96:99], v[10:11], v[84:85], 0
    v_bitop3_b32 v116, v28, 0.5, -0.5 bitop3:0xa8
    v_bitop3_b32 v112, v9, v112, v116 bitop3:0xca
    v_bitop3_b32 v116, v29, 0.5, -0.5 bitop3:0xa8
    v_bitop3_b32 v113, v9, v113, v116 bitop3:0xca
    v_cmp_lt_u32 s[84:85], v8, v108
    v_pk_mul_f32 v[100:101], v[100:101], v[112:113] op_sel:[0,1] op_sel_hi:[1,1]
    v_pk_mul_f32 v[102:103], v[102:103], v[112:113] op_sel:[0,1] op_sel_hi:[1,1]
    v_pk_mul_f32 v[96:97], v[96:97], v[112:113] op_sel:[0,0] op_sel_hi:[1,0]
    v_pk_mul_f32 v[98:99], v[98:99], v[112:113] op_sel:[0,0] op_sel_hi:[1,0]
    s_waitcnt lgkmcnt(0)
    v_cmpx_ne_u64 vcc, v[94:95], v[90:91]
    s_and_b64 s[82:83], vcc, s[80:81]
    s_cbranch_scc1 L2_c43
L2_d43:
    v_mov_b64 v[104:105], v[90:91]
    v_mov_b32 v117, v111
    v_mov_b64 v[106:107], v[94:95]
    s_mov_b64 exec, -1
    s_or_b64 s[80:81], s[80:81], vcc
    v_cmpx_ne_u64 vcc, v[92:93], v[88:89]
    s_and_b64 s[82:83], vcc, s[80:81]
    s_cbranch_scc1 L2_c44
L2_d44:
    v_mov_b64 v[104:105], v[88:89]
    v_mov_b32 v117, v110
    v_mov_b64 v[106:107], v[92:93]
    s_mov_b64 exec, -1
    s_or_b64 s[80:81], s[80:81], vcc
    ds_read_b64 v[90:91], v109
    s_and_b64 exec, s[84:85], s[80:81]
    v_mfma_f32_4x4x4_16b_bf16 v[96:99], v[14:15], v[104:105], 0
    v_mov_b32 v108, v117
    s_andn2_b64 s[80:81], s[80:81], s[84:85]
    v_mfma_f32_4x4x4_16b_bf16 v[96:99], v[12:13], v[106:107], v[96:99]
    s_mov_b64 exec, -1
    ds_read_b64 v[88:89], v108
    v_and_b32 v115, 0x80000000, v33
    v_lshrrev_b32 v116, 14, v31
    v_bitop3_b32 v116, v116, v8, v115 bitop3:0xea
    ds_read_b64 v[86:87], v116 offset:63616
    v_and_b32 v114, 0x40000000, v33
    v_lshrrev_b32 v116, 14, v30
    v_bitop3_b32 v116, v116, v8, v114 bitop3:0xea
    ds_read_b64 v[84:85], v116 offset:63616
    s_waitcnt lgkmcnt(2)
    v_mfma_f32_4x4x4_16b_bf16 v[100:103], v[12:13], v[90:91], v[100:103]
    v_mfma_f32_4x4x4_16b_bf16 v[96:99], v[12:13], v[88:89], v[96:99]
    v_perm_b32 v112, v30, v32, s46
    v_bitop3_b32 v110, v30, v8, v114 bitop3:0xea
    v_perm_b32 v113, v31, v32, s47
    v_bitop3_b32 v111, v31, v8, v115 bitop3:0xea
    v_cvt_pk_bf16_f32 v100, v100, v101
    v_cvt_pk_bf16_f32 v101, v102, v103
    ds_wrxchg_rtn_b64 v[94:95], v109, v[100:101]
    v_cvt_pk_bf16_f32 v96, v96, v97
    v_cvt_pk_bf16_f32 v97, v98, v99
    ds_wrxchg_rtn_b64 v[92:93], v108, v[96:97]
    s_waitcnt lgkmcnt(2)
    v_mfma_f32_4x4x4_16b_bf16 v[100:103], v[10:11], v[86:87], 0
    v_mfma_f32_4x4x4_16b_bf16 v[96:99], v[10:11], v[84:85], 0
    v_bitop3_b32 v116, v30, 0.5, -0.5 bitop3:0xa8
    v_bitop3_b32 v112, v9, v112, v116 bitop3:0xca
    v_bitop3_b32 v116, v31, 0.5, -0.5 bitop3:0xa8
    v_bitop3_b32 v113, v9, v113, v116 bitop3:0xca
    v_pk_mul_f32 v[100:101], v[100:101], v[112:113] op_sel:[0,1] op_sel_hi:[1,1]
    v_pk_mul_f32 v[102:103], v[102:103], v[112:113] op_sel:[0,1] op_sel_hi:[1,1]
    v_pk_mul_f32 v[96:97], v[96:97], v[112:113] op_sel:[0,0] op_sel_hi:[1,0]
    v_pk_mul_f32 v[98:99], v[98:99], v[112:113] op_sel:[0,0] op_sel_hi:[1,0]
    v_and_b32 v116, 0x0fffffff, v42
    v_mov_b32 v33, v42
    buffer_load_dwordx4 v[28:31], v116, s[8:11], 0 offen
    buffer_load_dwordx3 v[30:32], v116, s[8:11], 0 offen offset:8
    s_waitcnt lgkmcnt(0)
    v_cmpx_ne_u64 vcc, v[94:95], v[90:91]
    s_and_b64 s[82:83], vcc, s[80:81]
    s_cbranch_scc1 L2_c45
L2_d45:
    v_mov_b64 v[104:105], v[90:91]
    v_mov_b32 v117, v109
    v_mov_b64 v[106:107], v[94:95]
    s_mov_b64 exec, -1
    s_or_b64 s[80:81], s[80:81], vcc
    v_cmpx_ne_u64 vcc, v[92:93], v[88:89]
    s_and_b64 s[82:83], vcc, s[80:81]
    s_cbranch_scc1 L2_c46
L2_d46:
    v_mov_b64 v[104:105], v[88:89]
    v_mov_b32 v117, v108
    v_mov_b64 v[106:107], v[92:93]
    s_mov_b64 exec, -1
    s_or_b64 s[80:81], s[80:81], vcc
    ds_read_b64 v[90:91], v111
    ds_read_b64 v[88:89], v110
    s_waitcnt vmcnt(11)
    v_and_b32 v115, 0x20000000, v39
    v_lshrrev_b32 v116, 14, v35
    v_bitop3_b32 v116, v116, v8, v115 bitop3:0xea
    ds_read_b64 v[86:87], v116 offset:63616
    v_and_b32 v114, 0x10000000, v39
    v_lshrrev_b32 v116, 14, v34
    v_bitop3_b32 v116, v116, v8, v114 bitop3:0xea
    ds_read_b64 v[84:85], v116 offset:63616
    s_waitcnt lgkmcnt(2)
    v_mfma_f32_4x4x4_16b_bf16 v[100:103], v[12:13], v[90:91], v[100:103]
    v_mfma_f32_4x4x4_16b_bf16 v[96:99], v[12:13], v[88:89], v[96:99]
    v_perm_b32 v112, v34, v38, s44
    v_bitop3_b32 v108, v34, v8, v114 bitop3:0xea
    v_perm_b32 v113, v35, v38, s45
    v_bitop3_b32 v109, v35, v8, v115 bitop3:0xea
    v_cvt_pk_bf16_f32 v100, v100, v101
    v_cvt_pk_bf16_f32 v101, v102, v103
    ds_wrxchg_rtn_b64 v[94:95], v111, v[100:101]
    v_cvt_pk_bf16_f32 v96, v96, v97
    v_cvt_pk_bf16_f32 v97, v98, v99
    ds_wrxchg_rtn_b64 v[92:93], v110, v[96:97]
    s_setprio 0
    s_waitcnt lgkmcnt(2)
    v_mfma_f32_4x4x4_16b_bf16 v[100:103], v[10:11], v[86:87], 0
    v_mfma_f32_4x4x4_16b_bf16 v[96:99], v[10:11], v[84:85], 0
    v_bitop3_b32 v116, v34, 0.5, -0.5 bitop3:0xa8
    v_bitop3_b32 v112, v9, v112, v116 bitop3:0xca
    v_bitop3_b32 v116, v35, 0.5, -0.5 bitop3:0xa8
    v_bitop3_b32 v113, v9, v113, v116 bitop3:0xca
    v_cmp_lt_u32 s[84:85], v8, v108
    v_pk_mul_f32 v[100:101], v[100:101], v[112:113] op_sel:[0,1] op_sel_hi:[1,1]
    v_pk_mul_f32 v[102:103], v[102:103], v[112:113] op_sel:[0,1] op_sel_hi:[1,1]
    v_pk_mul_f32 v[96:97], v[96:97], v[112:113] op_sel:[0,0] op_sel_hi:[1,0]
    v_pk_mul_f32 v[98:99], v[98:99], v[112:113] op_sel:[0,0] op_sel_hi:[1,0]
    s_waitcnt lgkmcnt(0)
    v_cmpx_ne_u64 vcc, v[94:95], v[90:91]
    s_and_b64 s[82:83], vcc, s[80:81]
    s_cbranch_scc1 L2_c47
L2_d47:
    v_mov_b64 v[104:105], v[90:91]
    v_mov_b32 v117, v111
    v_mov_b64 v[106:107], v[94:95]
    s_mov_b64 exec, -1
    s_or_b64 s[80:81], s[80:81], vcc
    v_cmpx_ne_u64 vcc, v[92:93], v[88:89]
    s_and_b64 s[82:83], vcc, s[80:81]
    s_cbranch_scc1 L2_c48
L2_d48:
    v_mov_b64 v[104:105], v[88:89]
    v_mov_b32 v117, v110
    v_mov_b64 v[106:107], v[92:93]
    s_mov_b64 exec, -1
    s_or_b64 s[80:81], s[80:81], vcc
    ds_read_b64 v[90:91], v109
    s_and_b64 exec, s[84:85], s[80:81]
    v_mfma_f32_4x4x4_16b_bf16 v[96:99], v[14:15], v[104:105], 0
    v_mov_b32 v108, v117
    s_andn2_b64 s[80:81], s[80:81], s[84:85]
    v_mfma_f32_4x4x4_16b_bf16 v[96:99], v[12:13], v[106:107], v[96:99]
    s_mov_b64 exec, -1
    ds_read_b64 v[88:89], v108
    v_and_b32 v115, 0x80000000, v39
    v_lshrrev_b32 v116, 14, v37
    v_bitop3_b32 v116, v116, v8, v115 bitop3:0xea
    ds_read_b64 v[86:87], v116 offset:63616
    v_and_b32 v114, 0x40000000, v39
    v_lshrrev_b32 v116, 14, v36
    v_bitop3_b32 v116, v116, v8, v114 bitop3:0xea
    ds_read_b64 v[84:85], v116 offset:63616
    s_waitcnt lgkmcnt(2)
    v_mfma_f32_4x4x4_16b_bf16 v[100:103], v[12:13], v[90:91], v[100:103]
    v_mfma_f32_4x4x4_16b_bf16 v[96:99], v[12:13], v[88:89], v[96:99]
    v_perm_b32 v112, v36, v38, s46
    v_bitop3_b32 v110, v36, v8, v114 bitop3:0xea
    v_perm_b32 v113, v37, v38, s47
    v_bitop3_b32 v111, v37, v8, v115 bitop3:0xea
    v_cvt_pk_bf16_f32 v100, v100, v101
    v_cvt_pk_bf16_f32 v101, v102, v103
    ds_wrxchg_rtn_b64 v[94:95], v109, v[100:101]
    v_cvt_pk_bf16_f32 v96, v96, v97
    v_cvt_pk_bf16_f32 v97, v98, v99
    ds_wrxchg_rtn_b64 v[92:93], v108, v[96:97]
    s_waitcnt lgkmcnt(2)
    v_mfma_f32_4x4x4_16b_bf16 v[100:103], v[10:11], v[86:87], 0
    v_mfma_f32_4x4x4_16b_bf16 v[96:99], v[10:11], v[84:85], 0
    v_bitop3_b32 v116, v36, 0.5, -0.5 bitop3:0xa8
    v_bitop3_b32 v112, v9, v112, v116 bitop3:0xca
    v_bitop3_b32 v116, v37, 0.5, -0.5 bitop3:0xa8
    v_bitop3_b32 v113, v9, v113, v116 bitop3:0xca
    v_pk_mul_f32 v[100:101], v[100:101], v[112:113] op_sel:[0,1] op_sel_hi:[1,1]
    v_pk_mul_f32 v[102:103], v[102:103], v[112:113] op_sel:[0,1] op_sel_hi:[1,1]
    v_pk_mul_f32 v[96:97], v[96:97], v[112:113] op_sel:[0,0] op_sel_hi:[1,0]
    v_pk_mul_f32 v[98:99], v[98:99], v[112:113] op_sel:[0,0] op_sel_hi:[1,0]
    v_and_b32 v116, 0x0fffffff, v43
    v_mov_b32 v39, v43
    buffer_load_dwordx4 v[34:37], v116, s[8:11], 0 offen
    buffer_load_dwordx3 v[36:38], v116, s[8:11], 0 offen offset:8
    s_waitcnt lgkmcnt(0)
    v_cmpx_ne_u64 vcc, v[94:95], v[90:91]
    s_and_b64 s[82:83], vcc, s[80:81]
    s_cbranch_scc1 L2_c49
L2_d49:
    v_mov_b64 v[104:105], v[90:91]
    v_mov_b32 v117, v109
    v_mov_b64 v[106:107], v[94:95]
    s_mov_b64 exec, -1
    s_or_b64 s[80:81], s[80:81], vcc
    v_cmpx_ne_u64 vcc, v[92:93], v[88:89]
    s_and_b64 s[82:83], vcc, s[80:81]
    s_cbranch_scc1 L2_c50
L2_d50:
    v_mov_b64 v[104:105], v[88:89]
    v_mov_b32 v117, v108
    v_mov_b64 v[106:107], v[92:93]
    s_mov_b64 exec, -1
    s_or_b64 s[80:81], s[80:81], vcc
    ds_read_b64 v[90:91], v111
    ds_read_b64 v[88:89], v110
    s_waitcnt lgkmcnt(0)
    v_mfma_f32_4x4x4_16b_bf16 v[100:103], v[12:13], v[90:91], v[100:103]
    v_mfma_f32_4x4x4_16b_bf16 v[96:99], v[12:13], v[88:89], v[96:99]
    s_nop 3
    v_cvt_pk_bf16_f32 v100, v100, v101
    v_cvt_pk_bf16_f32 v101, v102, v103
    ds_wrxchg_rtn_b64 v[94:95], v111, v[100:101]
    v_cvt_pk_bf16_f32 v96, v96, v97
    v_cvt_pk_bf16_f32 v97, v98, v99
    ds_wrxchg_rtn_b64 v[92:93], v110, v[96:97]
    s_barrier
    s_waitcnt vmcnt(12)
    ds_write_b128 v7, v[52:55] offset:2048
    buffer_load_dwordx4 v[52:55], v5, s[16:19], s40 offen offset:2048
    s_mov_b32 s37, s38
    s_setprio 3
    v_and_b32_dpp v118, v66, v6 quad_perm:[1,1,1,1] row_mask:0xf bank_mask:0xf
    v_and_b32_dpp v119, v66, v6 quad_perm:[3,3,3,3] row_mask:0xf bank_mask:0xf
    v_and_b32 v120, -4, v118
    v_add_u32 v120, v120, v2
L2_x51:
    v_sub_u32 v121, v119, v120
    v_sub_u32 v123, v118, v120
    v_med3_i32 v122, v121, 0, 4
    v_max_i32 v123, 0, v123
    v_cmp_gt_i32 vcc, v122, v123
    v_mad_u32_u24 v124, v120, 5, v4
    v_bfm_b32 v122, v122, 28
    v_bfm_b32 v123, v123, 28
    v_mbcnt_lo_u32_b32 v125, vcc_lo, 0
    v_mbcnt_hi_u32_b32 v125, vcc_hi, v125
    v_bitop3_b32 v124, v122, v123, v124 bitop3:0x9a
    v_add_lshl_u32 v125, v125, s37, 2
    s_bcnt1_i32_b64 s41, vcc
    s_mov_b64 exec, vcc
    ds_write_b32 v125, v124
    s_mov_b64 exec, -1
    v_cmp_gt_i32 vcc, v121, v3
    s_add_u32 s37, s37, s41
    s_min_u32 s37, s37, s48
    s_cbranch_vccnz L2_xe51
L2_xr51:
    s_waitcnt vmcnt(12)
    ds_write_b128 v7, v[56:59] offset:3072
    buffer_load_dwordx4 v[56:59], v5, s[16:19], s40 offen offset:3072
    s_setprio 2
    v_and_b32_dpp v118, v70, v6 quad_perm:[1,1,1,1] row_mask:0xf bank_mask:0xf
    v_and_b32_dpp v119, v70, v6 quad_perm:[3,3,3,3] row_mask:0xf bank_mask:0xf
    v_and_b32 v120, -4, v118
    v_add_u32 v120, v120, v2
    v_add_u32 v126, 0x2a4000, v4
L2_x52:
    v_sub_u32 v121, v119, v120
    v_sub_u32 v123, v118, v120
    v_med3_i32 v122, v121, 0, 4
    v_max_i32 v123, 0, v123
    v_cmp_gt_i32 vcc, v122, v123
    v_mad_u32_u24 v124, v120, 5, v126
    v_bfm_b32 v122, v122, 28
    v_bfm_b32 v123, v123, 28
    v_mbcnt_lo_u32_b32 v125, vcc_lo, 0
    v_mbcnt_hi_u32_b32 v125, vcc_hi, v125
    v_bitop3_b32 v124, v122, v123, v124 bitop3:0x9a
    v_add_lshl_u32 v125, v125, s37, 2
    s_bcnt1_i32_b64 s41, vcc
    s_mov_b64 exec, vcc
    ds_write_b32 v125, v124
    s_mov_b64 exec, -1
    v_cmp_gt_i32 vcc, v121, v3
    s_add_u32 s37, s37, s41
    s_min_u32 s37, s37, s48
    s_cbranch_vccnz L2_xe52
L2_xr52:
    s_waitcnt vmcnt(12)
    ds_write_b128 v7, v[60:63] offset:4096
    s_add_u32 s3, s40, 4096
    buffer_load_dwordx4 v[60:63], v5, s[16:19], s3 offen
    s_setprio 1
    v_and_b32_dpp v118, v74, v6 quad_perm:[1,1,1,1] row_mask:0xf bank_mask:0xf
    v_and_b32_dpp v119, v74, v6 quad_perm:[3,3,3,3] row_mask:0xf bank_mask:0xf
    v_and_b32 v120, -4, v118
    v_add_u32 v120, v120, v2
    v_add_u32 v126, 0x548000, v4
L2_x53:
    v_sub_u32 v121, v119, v120
    v_sub_u32 v123, v118, v120
    v_med3_i32 v122, v121, 0, 4
    v_max_i32 v123, 0, v123
    v_cmp_gt_i32 vcc, v122, v123
    v_mad_u32_u24 v124, v120, 5, v126
    v_bfm_b32 v122, v122, 28
    v_bfm_b32 v123, v123, 28
    v_mbcnt_lo_u32_b32 v125, vcc_lo, 0
    v_mbcnt_hi_u32_b32 v125, vcc_hi, v125
    v_bitop3_b32 v124, v122, v123, v124 bitop3:0x9a
    v_add_lshl_u32 v125, v125, s37, 2
    s_bcnt1_i32_b64 s41, vcc
    s_mov_b64 exec, vcc
    ds_write_b32 v125, v124
    s_mov_b64 exec, -1
    v_cmp_gt_i32 vcc, v121, v3
    s_add_u32 s37, s37, s41
    s_min_u32 s37, s37, s48
    s_cbranch_vccnz L2_xe53
L2_xr53:
    s_setprio 0
    v_and_b32_dpp v118, v78, v6 quad_perm:[1,1,1,1] row_mask:0xf bank_mask:0xf
    v_and_b32_dpp v119, v78, v6 quad_perm:[3,3,3,3] row_mask:0xf bank_mask:0xf
    v_and_b32 v120, -4, v118
    v_add_u32 v120, v120, v2
    v_add_u32 v126, 0x7ec000, v4
L2_x54:
    v_sub_u32 v121, v119, v120
    v_sub_u32 v123, v118, v120
    v_med3_i32 v122, v121, 0, 4
    v_max_i32 v123, 0, v123
    v_cmp_gt_i32 vcc, v122, v123
    v_mad_u32_u24 v124, v120, 5, v126
    v_bfm_b32 v122, v122, 28
    v_bfm_b32 v123, v123, 28
    v_mbcnt_lo_u32_b32 v125, vcc_lo, 0
    v_mbcnt_hi_u32_b32 v125, vcc_hi, v125
    v_bitop3_b32 v124, v122, v123, v124 bitop3:0x9a
    v_add_lshl_u32 v125, v125, s37, 2
    s_bcnt1_i32_b64 s41, vcc
    s_mov_b64 exec, vcc
    ds_write_b32 v125, v124
    s_mov_b64 exec, -1
    v_cmp_gt_i32 vcc, v121, v3
    s_add_u32 s37, s37, s41
    s_min_u32 s37, s37, s48
    s_cbranch_vccnz L2_xe54
L2_xr54:
    v_and_b32_dpp v118, v82, v6 quad_perm:[1,1,1,1] row_mask:0xf bank_mask:0xf
    v_and_b32_dpp v119, v82, v6 quad_perm:[3,3,3,3] row_mask:0xf bank_mask:0xf
    v_and_b32 v120, -4, v118
    v_add_u32 v120, v120, v2
    v_add_u32 v126, 0xa90000, v4
L2_x55:
    v_sub_u32 v121, v119, v120
    v_sub_u32 v123, v118, v120
    v_med3_i32 v122, v121, 0, 4
    v_max_i32 v123, 0, v123
    v_cmp_gt_i32 vcc, v122, v123
    v_mad_u32_u24 v124, v120, 5, v126
    v_bfm_b32 v122, v122, 28
    v_bfm_b32 v123, v123, 28
    v_mbcnt_lo_u32_b32 v125, vcc_lo, 0
    v_mbcnt_hi_u32_b32 v125, vcc_hi, v125
    v_bitop3_b32 v124, v122, v123, v124 bitop3:0x9a
    v_add_lshl_u32 v125, v125, s37, 2
    s_bcnt1_i32_b64 s41, vcc
    s_mov_b64 exec, vcc
    ds_write_b32 v125, v124
    s_mov_b64 exec, -1
    v_cmp_gt_i32 vcc, v121, v3
    s_add_u32 s37, s37, s41
    s_min_u32 s37, s37, s48
    s_cbranch_vccnz L2_xe55
L2_xr55:
    s_lshl_b32 s3, s37, 2
    v_add_u32 v125, s3, v1
    v_mov_b32 v124, -1
    ds_write_b32 v125, v124
    s_lshl_b32 s3, s38, 2
    v_add_u32 v125, s3, v1
    ds_read2st64_b32 v[40:41], v125 offset0:0 offset1:1
    ds_read2st64_b32 v[42:43], v125 offset0:2 offset1:3
    s_sub_u32 s41, s37, s38
    s_sub_u32 s3, s41, 192
    s_cmp_gt_u32 s3, 64
    s_cbranch_scc1 L2_xf56
L2_xg56:
    s_waitcnt vmcnt(12)
    ds_write_b128 v7, v[44:47] offset:0
    s_waitcnt vmcnt(9)
    ds_write_b128 v7, v[48:51] offset:1024
    s_add_u32 s42, s42, 1
    s_waitcnt lgkmcnt(0)
    s_barrier
    s_setprio 3
    s_bitcmp1_b32 s36, s42
    s_cbranch_scc1 L2_slow
L2_ret2:
    v_and_b32 v115, 0x20000000, v21
    v_lshrrev_b32 v116, 14, v17
    v_bitop3_b32 v116, v116, v8, v115 bitop3:0xea
    ds_read_b64 v[86:87], v116 offset:63616
    v_and_b32 v114, 0x10000000, v21
    v_lshrrev_b32 v116, 14, v16
    v_bitop3_b32 v116, v116, v8, v114 bitop3:0xea
    ds_read_b64 v[84:85], v116 offset:63616
    v_perm_b32 v112, v16, v20, s44
    v_bitop3_b32 v108, v16, v8, v114 bitop3:0xea
    v_perm_b32 v113, v17, v20, s45
    v_bitop3_b32 v109, v17, v8, v115 bitop3:0xea
    s_waitcnt lgkmcnt(0)
    v_mfma_f32_4x4x4_16b_bf16 v[100:103], v[10:11], v[86:87], 0
    v_mfma_f32_4x4x4_16b_bf16 v[96:99], v[10:11], v[84:85], 0
    v_bitop3_b32 v116, v16, 0.5, -0.5 bitop3:0xa8
    v_bitop3_b32 v112, v9, v112, v116 bitop3:0xca
    v_bitop3_b32 v116, v17, 0.5, -0.5 bitop3:0xa8
    v_bitop3_b32 v113, v9, v113, v116 bitop3:0xca
    v_cmp_lt_u32 s[84:85], v8, v108
    v_pk_mul_f32 v[100:101], v[100:101], v[112:113] op_sel:[0,1] op_sel_hi:[1,1]
    v_pk_mul_f32 v[102:103], v[102:103], v[112:113] op_sel:[0,1] op_sel_hi:[1,1]
    v_pk_mul_f32 v[96:97], v[96:97], v[112:113] op_sel:[0,0] op_sel_hi:[1,0]
    v_pk_mul_f32 v[98:99], v[98:99], v[112:113] op_sel:[0,0] op_sel_hi:[1,0]
    buffer_load_dwordx4 v[44:47], v5, s[16:19], s40 offen offset:0
    v_lshrrev_b64 v[64:65], 16, v[64:65]
    v_lshrrev_b64 v[66:67], 16, v[66:67]
    v_cmpx_ne_u64 vcc, v[94:95], v[90:91]
    s_and_b64 s[82:83], vcc, s[80:81]
    s_cbranch_scc1 L2_c57
L2_d57:
    v_mov_b64 v[104:105], v[90:91]
    v_mov_b32 v117, v111
    v_mov_b64 v[106:107], v[94:95]
    s_mov_b64 exec, -1
    s_or_b64 s[80:81], s[80:81], vcc
    v_cmpx_ne_u64 vcc, v[92:93], v[88:89]
    s_and_b64 s[82:83], vcc, s[80:81]
    s_cbranch_scc1 L2_c58
L2_d58:
    v_mov_b64 v[104:105], v[88:89]
    v_mov_b32 v117, v110
    v_mov_b64 v[106:107], v[92:93]
    s_mov_b64 exec, -1
    s_or_b64 s[80:81], s[80:81], vcc
    ds_read_b64 v[90:91], v109
    s_and_b64 exec, s[84:85], s[80:81]
    v_mfma_f32_4x4x4_16b_bf16 v[96:99], v[14:15], v[104:105], 0
    v_mov_b32 v108, v117
    s_andn2_b64 s[80:81], s[80:81], s[84:85]
    v_mfma_f32_4x4x4_16b_bf16 v[96:99], v[12:13], v[106:107], v[96:99]
    s_mov_b64 exec, -1
    ds_read_b64 v[88:89], v108
    v_and_b32 v115, 0x80000000, v21
    v_lshrrev_b32 v116, 14, v19
    v_bitop3_b32 v116, v116, v8, v115 bitop3:0xea
    ds_read_b64 v[86:87], v116 offset:63616
    v_and_b32 v114, 0x40000000, v21
    v_lshrrev_b32 v116, 14, v18
    v_bitop3_b32 v116, v116, v8, v114 bitop3:0xea
    ds_read_b64 v[84:85], v116 offset:63616
    s_waitcnt lgkmcnt(2)
    v_mfma_f32_4x4x4_16b_bf16 v[100:103], v[12:13], v[90:91], v[100:103]
    v_mfma_f32_4x4x4_16b_bf16 v[96:99], v[12:13], v[88:89], v[96:99]
    v_perm_b32 v112, v18, v20, s46
    v_bitop3_b32 v110, v18, v8, v114 bitop3:0xea
    v_perm_b32 v113, v19, v20, s47
    v_bitop3_b32 v111, v19, v8, v115 bitop3:0xea
    v_cvt_pk_bf16_f32 v100, v100, v101
    v_cvt_pk_bf16_f32 v101, v102, v103
    ds_wrxchg_rtn_b64 v[94:95], v109, v[100:101]
    v_cvt_pk_bf16_f32 v96, v96, v97
    v_cvt_pk_bf16_f32 v97, v98, v99
    ds_wrxchg_rtn_b64 v[92:93], v108, v[96:97]
    s_waitcnt lgkmcnt(2)
    v_mfma_f32_4x4x4_16b_bf16 v[100:103], v[10:11], v[86:87], 0
    v_mfma_f32_4x4x4_16b_bf16 v[96:99], v[10:11], v[84:85], 0
    v_bitop3_b32 v116, v18, 0.5, -0.5 bitop3:0xa8
    v_bitop3_b32 v112, v9, v112, v116 bitop3:0xca
    v_bitop3_b32 v116, v19, 0.5, -0.5 bitop3:0xa8
    v_bitop3_b32 v113, v9, v113, v116 bitop3:0xca
    v_pk_mul_f32 v[100:101], v[100:101], v[112:113] op_sel:[0,1] op_sel_hi:[1,1]
    v_pk_mul_f32 v[102:103], v[102:103], v[112:113] op_sel:[0,1] op_sel_hi:[1,1]
    v_pk_mul_f32 v[96:97], v[96:97], v[112:113] op_sel:[0,0] op_sel_hi:[1,0]
    v_pk_mul_f32 v[98:99], v[98:99], v[112:113] op_sel:[0,0] op_sel_hi:[1,0]
    v_and_b32 v116, 0x0fffffff, v40
    v_mov_b32 v21, v40
    buffer_load_dwordx4 v[16:19], v116, s[8:11], 0 offen
    buffer_load_dwordx3 v[18:20], v116, s[8:11], 0 offen offset:8
    v_lshrrev_b64 v[68:69], 16, v[68:69]
    v_lshrrev_b64 v[70:71], 16, v[70:71]
    s_waitcnt lgkmcnt(0)
    v_cmpx_ne_u64 vcc, v[94:95], v[90:91]
    s_and_b64 s[82:83], vcc, s[80:81]
    s_cbranch_scc1 L2_c59
L2_d59:
    v_mov_b64 v[104:105], v[90:91]
    v_mov_b32 v117, v109
    v_mov_b64 v[106:107], v[94:95]
    s_mov_b64 exec, -1
    s_or_b64 s[80:81], s[80:81], vcc
    v_cmpx_ne_u64 vcc, v[92:93], v[88:89]
    s_and_b64 s[82:83], vcc, s[80:81]
    s_cbranch_scc1 L2_c60
L2_d60:
    v_mov_b64 v[104:105], v[88:89]
    v_mov_b32 v117, v108
    v_mov_b64 v[106:107], v[92:93]
    s_mov_b64 exec, -1
    s_or_b64 s[80:81], s[80:81], vcc
    ds_read_b64 v[90:91], v111
    ds_read_b64 v[88:89], v110
    s_waitcnt vmcnt(10)
    v_and_b32 v115, 0x20000000, v27
    v_lshrrev_b32 v116, 14, v23
    v_bitop3_b32 v116, v116, v8, v115 bitop3:0xea
    ds_read_b64 v[86:87], v116 offset:63616
    v_and_b32 v114, 0x10000000, v27
    v_lshrrev_b32 v116, 14, v22
    v_bitop3_b32 v116, v116, v8, v114 bitop3:0xea
    ds_read_b64 v[84:85], v116 offset:63616
    s_waitcnt lgkmcnt(2)
    v_mfma_f32_4x4x4_16b_bf16 v[100:103], v[12:13], v[90:91], v[100:103]
    v_mfma_f32_4x4x4_16b_bf16 v[96:99], v[12:13], v[88:89], v[96:99]
    v_perm_b32 v112, v22, v26, s44
    v_bitop3_b32 v108, v22, v8, v114 bitop3:0xea
    v_perm_b32 v113, v23, v26, s45
    v_bitop3_b32 v109, v23, v8, v115 bitop3:0xea
    v_cvt_pk_bf16_f32 v100, v100, v101
    v_cvt_pk_bf16_f32 v101, v102, v103
    ds_wrxchg_rtn_b64 v[94:95], v111, v[100:101]
    v_cvt_pk_bf16_f32 v96, v96, v97
    v_cvt_pk_bf16_f32 v97, v98, v99
    ds_wrxchg_rtn_b64 v[92:93], v110, v[96:97]
    s_setprio 2
    s_waitcnt lgkmcnt(2)
    v_mfma_f32_4x4x4_16b_bf16 v[100:103], v[10:11], v[86:87], 0
    v_mfma_f32_4x4x4_16b_bf16 v[96:99], v[10:11], v[84:85], 0
    v_bitop3_b32 v116, v22, 0.5, -0.5 bitop3:0xa8
    v_bitop3_b32 v112, v9, v112, v116 bitop3:0xca
    v_bitop3_b32 v116, v23, 0.5, -0.5 bitop3:0xa8
    v_bitop3_b32 v113, v9, v113, v116 bitop3:0xca
    v_cmp_lt_u32 s[84:85], v8, v108
    v_pk_mul_f32 v[100:101], v[100:101], v[112:113] op_sel:[0,1] op_sel_hi:[1,1]
    v_pk_mul_f32 v[102:103], v[102:103], v[112:113] op_sel:[0,1] op_sel_hi:[1,1]
    v_pk_mul_f32 v[96:97], v[96:97], v[112:113] op_sel:[0,0] op_sel_hi:[1,0]
    v_pk_mul_f32 v[98:99], v[98:99], v[112:113] op_sel:[0,0] op_sel_hi:[1,0]
    buffer_load_dwordx4 v[48:51], v5, s[16:19], s40 offen offset:1024
    s_add_u32 s40, s40, 0xfff29280
    v_lshrrev_b64 v[72:73], 16, v[72:73]
    v_lshrrev_b64 v[74:75], 16, v[74:75]
    s_waitcnt lgkmcnt(0)
    v_cmpx_ne_u64 vcc, v[94:95], v[90:91]
    s_and_b64 s[82:83], vcc, s[80:81]
    s_cbranch_scc1 L2_c61
L2_d61:
    v_mov_b64 v[104:105], v[90:91]
    v_mov_b32 v117, v111
    v_mov_b64 v[106:107], v[94:95]
    s_mov_b64 exec, -1
    s_or_b64 s[80:81], s[80:81], vcc
    v_cmpx_ne_u64 vcc, v[92:93], v[88:89]
    s_and_b64 s[82:83], vcc, s[80:81]
    s_cbranch_scc1 L2_c62
L2_d62:
    v_mov_b64 v[104:105], v[88:89]
    v_mov_b32 v117, v110
    v_mov_b64 v[106:107], v[92:93]
    s_mov_b64 exec, -1
    s_or_b64 s[80:81], s[80:81], vcc
    ds_read_b64 v[90:91], v109
    s_and_b64 exec, s[84:85], s[80:81]
    v_mfma_f32_4x4x4_16b_bf16 v[96:99], v[14:15], v[104:105], 0
    v_mov_b32 v108, v117
    s_andn2_b64 s[80:81], s[80:81], s[84:85]
    v_mfma_f32_4x4x4_16b_bf16 v[96:99], v[12:13], v[106:107], v[96:99]
    s_mov_b64 exec, -1
    ds_read_b64 v[88:89], v108
    v_and_b32 v115, 0x80000000, v27
    v_lshrrev_b32 v116, 14, v25
    v_bitop3_b32 v116, v116, v8, v115 bitop3:0xea
    ds_read_b64 v[86:87], v116 offset:63616
    v_and_b32 v114, 0x40000000, v27
    v_lshrrev_b32 v116, 14, v24
    v_bitop3_b32 v116, v116, v8, v114 bitop3:0xea
    ds_read_b64 v[84:85], v116 offset:63616
    s_waitcnt lgkmcnt(2)
    v_mfma_f32_4x4x4_16b_bf16 v[100:103], v[12:13], v[90:91], v[100:103]
    v_mfma_f32_4x4x4_16b_bf16 v[96:99], v[12:13], v[88:89], v[96:99]
    v_perm_b32 v112, v24, v26, s46
    v_bitop3_b32 v110, v24, v8, v114 bitop3:0xea
    v_perm_b32 v113, v25, v26, s47
    v_bitop3_b32 v111, v25, v8, v115 bitop3:0xea
    v_cvt_pk_bf16_f32 v100, v100, v101
    v_cvt_pk_bf16_f32 v101, v102, v103
    ds_wrxchg_rtn_b64 v[94:95], v109, v[100:101]
    v_cvt_pk_bf16_f32 v96, v96, v97
    v_cvt_pk_bf16_f32 v97, v98, v99
    ds_wrxchg_rtn_b64 v[92:93], v108, v[96:97]
    s_waitcnt lgkmcnt(2)
    v_mfma_f32_4x4x4_16b_bf16 v[100:103], v[10:11], v[86:87], 0
    v_mfma_f32_4x4x4_16b_bf16 v[96:99], v[10:11], v[84:85], 0
    v_bitop3_b32 v116, v24, 0.5, -0.5 bitop3:0xa8
    v_bitop3_b32 v112, v9, v112, v116 bitop3:0xca
    v_bitop3_b32 v116, v25, 0.5, -0.5 bitop3:0xa8
    v_bitop3_b32 v113, v9, v113, v116 bitop3:0xca
    v_pk_mul_f32 v[100:101], v[100:101], v[112:113] op_sel:[0,1] op_sel_hi:[1,1]
    v_pk_mul_f32 v[102:103], v[102:103], v[112:113] op_sel:[0,1] op_sel_hi:[1,1]
    v_pk_mul_f32 v[96:97], v[96:97], v[112:113] op_sel:[0,0] op_sel_hi:[1,0]
    v_pk_mul_f32 v[98:99], v[98:99], v[112:113] op_sel:[0,0] op_sel_hi:[1,0]
    v_and_b32 v116, 0x0fffffff, v41
    v_mov_b32 v27, v41
    buffer_load_dwordx4 v[22:25], v116, s[8:11], 0 offen
    buffer_load_dwordx3 v[24:26], v116, s[8:11], 0 offen offset:8
    v_lshrrev_b64 v[76:77], 16, v[76:77]
    v_lshrrev_b64 v[78:79], 16, v[78:79]
    s_waitcnt lgkmcnt(0)
    v_cmpx_ne_u64 vcc, v[94:95], v[90:91]
    s_and_b64 s[82:83], vcc, s[80:81]
    s_cbranch_scc1 L2_c63
L2_d63:
    v_mov_b64 v[104:105], v[90:91]
    v_mov_b32 v117, v109
    v_mov_b64 v[106:107], v[94:95]
    s_mov_b64 exec, -1
    s_or_b64 s[80:81], s[80:81], vcc
    v_cmpx_ne_u64 vcc, v[92:93], v[88:89]
    s_and_b64 s[82:83], vcc, s[80:81]
    s_cbranch_scc1 L2_c64
L2_d64:
    v_mov_b64 v[104:105], v[88:89]
    v_mov_b32 v117, v108
    v_mov_b64 v[106:107], v[92:93]
    s_mov_b64 exec, -1
    s_or_b64 s[80:81], s[80:81], vcc
    ds_read_b64 v[90:91], v111
    ds_read_b64 v[88:89], v110
    s_waitcnt vmcnt(11)
    v_and_b32 v115, 0x20000000, v33
    v_lshrrev_b32 v116, 14, v29
    v_bitop3_b32 v116, v116, v8, v115 bitop3:0xea
    ds_read_b64 v[86:87], v116 offset:63616
    v_and_b32 v114, 0x10000000, v33
    v_lshrrev_b32 v116, 14, v28
    v_bitop3_b32 v116, v116, v8, v114 bitop3:0xea
    ds_read_b64 v[84:85], v116 offset:63616
    s_waitcnt lgkmcnt(2)
    v_mfma_f32_4x4x4_16b_bf16 v[100:103], v[12:13], v[90:91], v[100:103]
    v_mfma_f32_4x4x4_16b_bf16 v[96:99], v[12:13], v[88:89], v[96:99]
    v_perm_b32 v112, v28, v32, s44
    v_bitop3_b32 v108, v28, v8, v114 bitop3:0xea
    v_perm_b32 v113, v29, v32, s45
    v_bitop3_b32 v109, v29, v8, v115 bitop3:0xea
    v_cvt_pk_bf16_f32 v100, v100, v101
    v_cvt_pk_bf16_f32 v101, v102, v103
    ds_wrxchg_rtn_b64 v[94:95], v111, v[100:101]
    v_cvt_pk_bf16_f32 v96, v96, v97
    v_cvt_pk_bf16_f32 v97, v98, v99
    ds_wrxchg_rtn_b64 v[92:93], v110, v[96:97]
    s_setprio 1
    s_waitcnt lgkmcnt(2)
    v_mfma_f32_4x4x4_16b_bf16 v[100:103], v[10:11], v[86:87], 0
    v_mfma_f32_4x4x4_16b_bf16 v[96:99], v[10:11], v[84:85], 0
    v_bitop3_b32 v116, v28, 0.5, -0.5 bitop3:0xa8
    v_bitop3_b32 v112, v9, v112, v116 bitop3:0xca
    v_bitop3_b32 v116, v29, 0.5, -0.5 bitop3:0xa8
    v_bitop3_b32 v113, v9, v113, v116 bitop3:0xca
    v_cmp_lt_u32 s[84:85], v8, v108
    v_pk_mul_f32 v[100:101], v[100:101], v[112:113] op_sel:[0,1] op_sel_hi:[1,1]
    v_pk_mul_f32 v[102:103], v[102:103], v[112:113] op_sel:[0,1] op_sel_hi:[1,1]
    v_pk_mul_f32 v[96:97], v[96:97], v[112:113] op_sel:[0,0] op_sel_hi:[1,0]
    v_pk_mul_f32 v[98:99], v[98:99], v[112:113] op_sel:[0,0] op_sel_hi:[1,0]
    v_lshrrev_b64 v[80:81], 16, v[80:81]
    v_lshrrev_b64 v[82:83], 16, v[82:83]
    s_waitcnt lgkmcnt(0)
    v_cmpx_ne_u64 vcc, v[94:95], v[90:91]
    s_and_b64 s[82:83], vcc, s[80:81]
    s_cbranch_scc1 L2_c65
L2_d65:
    v_mov_b64 v[104:105], v[90:91]
    v_mov_b32 v117, v111
    v_mov_b64 v[106:107], v[94:95]
    s_mov_b64 exec, -1
    s_or_b64 s[80:81], s[80:81], vcc
    v_cmpx_ne_u64 vcc, v[92:93], v[88:89]
    s_and_b64 s[82:83], vcc, s[80:81]
    s_cbranch_scc1 L2_c66
L2_d66:
    v_mov_b64 v[104:105], v[88:89]
    v_mov_b32 v117, v110
    v_mov_b64 v[106:107], v[92:93]
    s_mov_b64 exec, -1
    s_or_b64 s[80:81], s[80:81], vcc
    ds_read_b64 v[90:91], v109
    s_and_b64 exec, s[84:85], s[80:81]
    v_mfma_f32_4x4x4_16b_bf16 v[96:99], v[14:15], v[104:105], 0
    v_mov_b32 v108, v117
    s_andn2_b64 s[80:81], s[80:81], s[84:85]
    v_mfma_f32_4x4x4_16b_bf16 v[96:99], v[12:13], v[106:107], v[96:99]
    s_mov_b64 exec, -1
    ds_read_b64 v[88:89], v108
    v_and_b32 v115, 0x80000000, v33
    v_lshrrev_b32 v116, 14, v31
    v_bitop3_b32 v116, v116, v8, v115 bitop3:0xea
    ds_read_b64 v[86:87], v116 offset:63616
    v_and_b32 v114, 0x40000000, v33
    v_lshrrev_b32 v116, 14, v30
    v_bitop3_b32 v116, v116, v8, v114 bitop3:0xea
    ds_read_b64 v[84:85], v116 offset:63616
    s_waitcnt lgkmcnt(2)
    v_mfma_f32_4x4x4_16b_bf16 v[100:103], v[12:13], v[90:91], v[100:103]
    v_mfma_f32_4x4x4_16b_bf16 v[96:99], v[12:13], v[88:89], v[96:99]
    v_perm_b32 v112, v30, v32, s46
    v_bitop3_b32 v110, v30, v8, v114 bitop3:0xea
    v_perm_b32 v113, v31, v32, s47
    v_bitop3_b32 v111, v31, v8, v115 bitop3:0xea
    v_cvt_pk_bf16_f32 v100, v100, v101
    v_cvt_pk_bf16_f32 v101, v102, v103
    ds_wrxchg_rtn_b64 v[94:95], v109, v[100:101]
    v_cvt_pk_bf16_f32 v96, v96, v97
    v_cvt_pk_bf16_f32 v97, v98, v99
    ds_wrxchg_rtn_b64 v[92:93], v108, v[96:97]
    s_waitcnt lgkmcnt(2)
    v_mfma_f32_4x4x4_16b_bf16 v[100:103], v[10:11], v[86:87], 0
    v_mfma_f32_4x4x4_16b_bf16 v[96:99], v[10:11], v[84:85], 0
    v_bitop3_b32 v116, v30, 0.5, -0.5 bitop3:0xa8
    v_bitop3_b32 v112, v9, v112, v116 bitop3:0xca
    v_bitop3_b32 v116, v31, 0.5, -0.5 bitop3:0xa8
    v_bitop3_b32 v113, v9, v113, v116 bitop3:0xca
    v_pk_mul_f32 v[100:101], v[100:101], v[112:113] op_sel:[0,1] op_sel_hi:[1,1]
    v_pk_mul_f32 v[102:103], v[102:103], v[112:113] op_sel:[0,1] op_sel_hi:[1,1]
    v_pk_mul_f32 v[96:97], v[96:97], v[112:113] op_sel:[0,0] op_sel_hi:[1,0]
    v_pk_mul_f32 v[98:99], v[98:99], v[112:113] op_sel:[0,0] op_sel_hi:[1,0]
    v_and_b32 v116, 0x0fffffff, v42
    v_mov_b32 v33, v42
    buffer_load_dwordx4 v[28:31], v116, s[8:11], 0 offen
    buffer_load_dwordx3 v[30:32], v116, s[8:11], 0 offen offset:8
    s_waitcnt lgkmcnt(0)
    v_cmpx_ne_u64 vcc, v[94:95], v[90:91]
    s_and_b64 s[82:83], vcc, s[80:81]
    s_cbranch_scc1 L2_c67
L2_d67:
    v_mov_b64 v[104:105], v[90:91]
    v_mov_b32 v117, v109
    v_mov_b64 v[106:107], v[94:95]
    s_mov_b64 exec, -1
    s_or_b64 s[80:81], s[80:81], vcc
    v_cmpx_ne_u64 vcc, v[92:93], v[88:89]
    s_and_b64 s[82:83], vcc, s[80:81]
    s_cbranch_scc1 L2_c68
L2_d68:
    v_mov_b64 v[104:105], v[88:89]
    v_mov_b32 v117, v108
    v_mov_b64 v[106:107], v[92:93]
    s_mov_b64 exec, -1
    s_or_b64 s[80:81], s[80:81], vcc
    ds_read_b64 v[90:91], v111
    ds_read_b64 v[88:89], v110
    s_waitcnt vmcnt(11)
    v_and_b32 v115, 0x20000000, v39
    v_lshrrev_b32 v116, 14, v35
    v_bitop3_b32 v116, v116, v8, v115 bitop3:0xea
    ds_read_b64 v[86:87], v116 offset:63616
    v_and_b32 v114, 0x10000000, v39
    v_lshrrev_b32 v116, 14, v34
    v_bitop3_b32 v116, v116, v8, v114 bitop3:0xea
    ds_read_b64 v[84:85], v116 offset:63616
    s_waitcnt lgkmcnt(2)
    v_mfma_f32_4x4x4_16b_bf16 v[100:103], v[12:13], v[90:91], v[100:103]
    v_mfma_f32_4x4x4_16b_bf16 v[96:99], v[12:13], v[88:89], v[96:99]
    v_perm_b32 v112, v34, v38, s44
    v_bitop3_b32 v108, v34, v8, v114 bitop3:0xea
    v_perm_b32 v113, v35, v38, s45
    v_bitop3_b32 v109, v35, v8, v115 bitop3:0xea
    v_cvt_pk_bf16_f32 v100, v100, v101
    v_cvt_pk_bf16_f32 v101, v102, v103
    ds_wrxchg_rtn_b64 v[94:95], v111, v[100:101]
    v_cvt_pk_bf16_f32 v96, v96, v97
    v_cvt_pk_bf16_f32 v97, v98, v99
    ds_wrxchg_rtn_b64 v[92:93], v110, v[96:97]
    s_setprio 0
    s_waitcnt lgkmcnt(2)
    v_mfma_f32_4x4x4_16b_bf16 v[100:103], v[10:11], v[86:87], 0
    v_mfma_f32_4x4x4_16b_bf16 v[96:99], v[10:11], v[84:85], 0
    v_bitop3_b32 v116, v34, 0.5, -0.5 bitop3:0xa8
    v_bitop3_b32 v112, v9, v112, v116 bitop3:0xca
    v_bitop3_b32 v116, v35, 0.5, -0.5 bitop3:0xa8
    v_bitop3_b32 v113, v9, v113, v116 bitop3:0xca
    v_cmp_lt_u32 s[84:85], v8, v108
    v_pk_mul_f32 v[100:101], v[100:101], v[112:113] op_sel:[0,1] op_sel_hi:[1,1]
    v_pk_mul_f32 v[102:103], v[102:103], v[112:113] op_sel:[0,1] op_sel_hi:[1,1]
    v_pk_mul_f32 v[96:97], v[96:97], v[112:113] op_sel:[0,0] op_sel_hi:[1,0]
    v_pk_mul_f32 v[98:99], v[98:99], v[112:113] op_sel:[0,0] op_sel_hi:[1,0]
    s_waitcnt lgkmcnt(0)
    v_cmpx_ne_u64 vcc, v[94:95], v[90:91]
    s_and_b64 s[82:83], vcc, s[80:81]
    s_cbranch_scc1 L2_c69
L2_d69:
    v_mov_b64 v[104:105], v[90:91]
    v_mov_b32 v117, v111
    v_mov_b64 v[106:107], v[94:95]
    s_mov_b64 exec, -1
    s_or_b64 s[80:81], s[80:81], vcc
    v_cmpx_ne_u64 vcc, v[92:93], v[88:89]
    s_and_b64 s[82:83], vcc, s[80:81]
    s_cbranch_scc1 L2_c70
L2_d70:
    v_mov_b64 v[104:105], v[88:89]
    v_mov_b32 v117, v110
    v_mov_b64 v[106:107], v[92:93]
    s_mov_b64 exec, -1
    s_or_b64 s[80:81], s[80:81], vcc
    ds_read_b64 v[90:91], v109
    s_and_b64 exec, s[84:85], s[80:81]
    v_mfma_f32_4x4x4_16b_bf16 v[96:99], v[14:15], v[104:105], 0
    v_mov_b32 v108, v117
    s_andn2_b64 s[80:81], s[80:81], s[84:85]
    v_mfma_f32_4x4x4_16b_bf16 v[96:99], v[12:13], v[106:107], v[96:99]
    s_mov_b64 exec, -1
    ds_read_b64 v[88:89], v108
    v_and_b32 v115, 0x80000000, v39
    v_lshrrev_b32 v116, 14, v37
    v_bitop3_b32 v116, v116, v8, v115 bitop3:0xea
    ds_read_b64 v[86:87], v116 offset:63616
    v_and_b32 v114, 0x40000000, v39
    v_lshrrev_b32 v116, 14, v36
    v_bitop3_b32 v116, v116, v8, v114 bitop3:0xea
    ds_read_b64 v[84:85], v116 offset:63616
    s_waitcnt lgkmcnt(2)
    v_mfma_f32_4x4x4_16b_bf16 v[100:103], v[12:13], v[90:91], v[100:103]
    v_mfma_f32_4x4x4_16b_bf16 v[96:99], v[12:13], v[88:89], v[96:99]
    v_perm_b32 v112, v36, v38, s46
    v_bitop3_b32 v110, v36, v8, v114 bitop3:0xea
    v_perm_b32 v113, v37, v38, s47
    v_bitop3_b32 v111, v37, v8, v115 bitop3:0xea
    v_cvt_pk_bf16_f32 v100, v100, v101
    v_cvt_pk_bf16_f32 v101, v102, v103
    ds_wrxchg_rtn_b64 v[94:95], v109, v[100:101]
    v_cvt_pk_bf16_f32 v96, v96, v97
    v_cvt_pk_bf16_f32 v97, v98, v99
    ds_wrxchg_rtn_b64 v[92:93], v108, v[96:97]
    s_waitcnt lgkmcnt(2)
    v_mfma_f32_4x4x4_16b_bf16 v[100:103], v[10:11], v[86:87], 0
    v_mfma_f32_4x4x4_16b_bf16 v[96:99], v[10:11], v[84:85], 0
    v_bitop3_b32 v116, v36, 0.5, -0.5 bitop3:0xa8
    v_bitop3_b32 v112, v9, v112, v116 bitop3:0xca
    v_bitop3_b32 v116, v37, 0.5, -0.5 bitop3:0xa8
    v_bitop3_b32 v113, v9, v113, v116 bitop3:0xca
    v_pk_mul_f32 v[100:101], v[100:101], v[112:113] op_sel:[0,1] op_sel_hi:[1,1]
    v_pk_mul_f32 v[102:103], v[102:103], v[112:113] op_sel:[0,1] op_sel_hi:[1,1]
    v_pk_mul_f32 v[96:97], v[96:97], v[112:113] op_sel:[0,0] op_sel_hi:[1,0]
    v_pk_mul_f32 v[98:99], v[98:99], v[112:113] op_sel:[0,0] op_sel_hi:[1,0]
    v_and_b32 v116, 0x0fffffff, v43
    v_mov_b32 v39, v43
    buffer_load_dwordx4 v[34:37], v116, s[8:11], 0 offen
    buffer_load_dwordx3 v[36:38], v116, s[8:11], 0 offen offset:8
    s_waitcnt lgkmcnt(0)
    v_cmpx_ne_u64 vcc, v[94:95], v[90:91]
    s_and_b64 s[82:83], vcc, s[80:81]
    s_cbranch_scc1 L2_c71
L2_d71:
    v_mov_b64 v[104:105], v[90:91]
    v_mov_b32 v117, v109
    v_mov_b64 v[106:107], v[94:95]
    s_mov_b64 exec, -1
    s_or_b64 s[80:81], s[80:81], vcc
    v_cmpx_ne_u64 vcc, v[92:93], v[88:89]
    s_and_b64 s[82:83], vcc, s[80:81]
    s_cbranch_scc1 L2_c72
L2_d72:
    v_mov_b64 v[104:105], v[88:89]
    v_mov_b32 v117, v108
    v_mov_b64 v[106:107], v[92:93]
    s_mov_b64 exec, -1
    s_or_b64 s[80:81], s[80:81], vcc
    ds_read_b64 v[90:91], v111
    ds_read_b64 v[88:89], v110
    s_waitcnt lgkmcnt(0)
    v_mfma_f32_4x4x4_16b_bf16 v[100:103], v[12:13], v[90:91], v[100:103]
    v_mfma_f32_4x4x4_16b_bf16 v[96:99], v[12:13], v[88:89], v[96:99]
    s_nop 3
    v_cvt_pk_bf16_f32 v100, v100, v101
    v_cvt_pk_bf16_f32 v101, v102, v103
    ds_wrxchg_rtn_b64 v[94:95], v111, v[100:101]
    v_cvt_pk_bf16_f32 v96, v96, v97
    v_cvt_pk_bf16_f32 v97, v98, v99
    ds_wrxchg_rtn_b64 v[92:93], v110, v[96:97]
    s_barrier
    s_waitcnt vmcnt(12)
    ds_write_b128 v7, v[52:55] offset:2048
    buffer_load_dwordx4 v[52:55], v5, s[16:19], s40 offen offset:2048
    s_mov_b32 s37, s38
    s_setprio 3
    v_and_b32_dpp v118, v64, v6 quad_perm:[0,0,0,0] row_mask:0xf bank_mask:0xf
    v_and_b32_dpp v119, v64, v6 quad_perm:[2,2,2,2] row_mask:0xf bank_mask:0xf
    v_and_b32 v120, -4, v118
    v_add_u32 v120, v120, v2
L2_x73:
    v_sub_u32 v121, v119, v120
    v_sub_u32 v123, v118, v120
    v_med3_i32 v122, v121, 0, 4
    v_max_i32 v123, 0, v123
    v_cmp_gt_i32 vcc, v122, v123
    v_mad_u32_u24 v124, v120, 5, v4
    v_bfm_b32 v122, v122, 28
    v_bfm_b32 v123, v123, 28
    v_mbcnt_lo_u32_b32 v125, vcc_lo, 0
    v_mbcnt_hi_u32_b32 v125, vcc_hi, v125
    v_bitop3_b32 v124, v122, v123, v124 bitop3:0x9a
    v_add_lshl_u32 v125, v125, s37, 2
    s_bcnt1_i32_b64 s41, vcc
    s_mov_b64 exec, vcc
    ds_write_b32 v125, v124
    s_mov_b64 exec, -1
    v_cmp_gt_i32 vcc, v121, v3
    s_add_u32 s37, s37, s41
    s_min_u32 s37, s37, s48
    s_cbranch_vccnz L2_xe73
L2_xr73:
    s_waitcnt vmcnt(12)
    ds_write_b128 v7, v[56:59] offset:3072
    buffer_load_dwordx4 v[56:59], v5, s[16:19], s40 offen offset:3072
    s_setprio 2
    v_and_b32_dpp v118, v68, v6 quad_perm:[0,0,0,0] row_mask:0xf bank_mask:0xf
    v_and_b32_dpp v119, v68, v6 quad_perm:[2,2,2,2] row_mask:0xf bank_mask:0xf
    v_and_b32 v120, -4, v118
    v_add_u32 v120, v120, v2
    v_add_u32 v126, 0x2a4000, v4
L2_x74:
    v_sub_u32 v121, v119, v120
    v_sub_u32 v123, v118, v120
    v_med3_i32 v122, v121, 0, 4
    v_max_i32 v123, 0, v123
    v_cmp_gt_i32 vcc, v122, v123
    v_mad_u32_u24 v124, v120, 5, v126
    v_bfm_b32 v122, v122, 28
    v_bfm_b32 v123, v123, 28
    v_mbcnt_lo_u32_b32 v125, vcc_lo, 0
    v_mbcnt_hi_u32_b32 v125, vcc_hi, v125
    v_bitop3_b32 v124, v122, v123, v124 bitop3:0x9a
    v_add_lshl_u32 v125, v125, s37, 2
    s_bcnt1_i32_b64 s41, vcc
    s_mov_b64 exec, vcc
    ds_write_b32 v125, v124
    s_mov_b64 exec, -1
    v_cmp_gt_i32 vcc, v121, v3
    s_add_u32 s37, s37, s41
    s_min_u32 s37, s37, s48
    s_cbranch_vccnz L2_xe74
L2_xr74:
    s_waitcnt vmcnt(12)
    ds_write_b128 v7, v[60:63] offset:4096
    s_add_u32 s3, s40, 4096
    buffer_load_dwordx4 v[60:63], v5, s[16:19], s3 offen
    s_setprio 1
    v_and_b32_dpp v118, v72, v6 quad_perm:[0,0,0,0] row_mask:0xf bank_mask:0xf
    v_and_b32_dpp v119, v72, v6 quad_perm:[2,2,2,2] row_mask:0xf bank_mask:0xf
    v_and_b32 v120, -4, v118
    v_add_u32 v120, v120, v2
    v_add_u32 v126, 0x548000, v4
L2_x75:
    v_sub_u32 v121, v119, v120
    v_sub_u32 v123, v118, v120
    v_med3_i32 v122, v121, 0, 4
    v_max_i32 v123, 0, v123
    v_cmp_gt_i32 vcc, v122, v123
    v_mad_u32_u24 v124, v120, 5, v126
    v_bfm_b32 v122, v122, 28
    v_bfm_b32 v123, v123, 28
    v_mbcnt_lo_u32_b32 v125, vcc_lo, 0
    v_mbcnt_hi_u32_b32 v125, vcc_hi, v125
    v_bitop3_b32 v124, v122, v123, v124 bitop3:0x9a
    v_add_lshl_u32 v125, v125, s37, 2
    s_bcnt1_i32_b64 s41, vcc
    s_mov_b64 exec, vcc
    ds_write_b32 v125, v124
    s_mov_b64 exec, -1
    v_cmp_gt_i32 vcc, v121, v3
    s_add_u32 s37, s37, s41
    s_min_u32 s37, s37, s48
    s_cbranch_vccnz L2_xe75
L2_xr75:
    s_setprio 0
    v_and_b32_dpp v118, v76, v6 quad_perm:[0,0,0,0] row_mask:0xf bank_mask:0xf
    v_and_b32_dpp v119, v76, v6 quad_perm:[2,2,2,2] row_mask:0xf bank_mask:0xf
    v_and_b32 v120, -4, v118
    v_add_u32 v120, v120, v2
    v_add_u32 v126, 0x7ec000, v4
L2_x76:
    v_sub_u32 v121, v119, v120
    v_sub_u32 v123, v118, v120
    v_med3_i32 v122, v121, 0, 4
    v_max_i32 v123, 0, v123
    v_cmp_gt_i32 vcc, v122, v123
    v_mad_u32_u24 v124, v120, 5, v126
    v_bfm_b32 v122, v122, 28
    v_bfm_b32 v123, v123, 28
    v_mbcnt_lo_u32_b32 v125, vcc_lo, 0
    v_mbcnt_hi_u32_b32 v125, vcc_hi, v125
    v_bitop3_b32 v124, v122, v123, v124 bitop3:0x9a
    v_add_lshl_u32 v125, v125, s37, 2
    s_bcnt1_i32_b64 s41, vcc
    s_mov_b64 exec, vcc
    ds_write_b32 v125, v124
    s_mov_b64 exec, -1
    v_cmp_gt_i32 vcc, v121, v3
    s_add_u32 s37, s37, s41
    s_min_u32 s37, s37, s48
    s_cbranch_vccnz L2_xe76
L2_xr76:
    v_and_b32_dpp v118, v80, v6 quad_perm:[0,0,0,0] row_mask:0xf bank_mask:0xf
    v_and_b32_dpp v119, v80, v6 quad_perm:[2,2,2,2] row_mask:0xf bank_mask:0xf
    v_and_b32 v120, -4, v118
    v_add_u32 v120, v120, v2
    v_add_u32 v126, 0xa90000, v4
L2_x77:
    v_sub_u32 v121, v119, v120
    v_sub_u32 v123, v118, v120
    v_med3_i32 v122, v121, 0, 4
    v_max_i32 v123, 0, v123
    v_cmp_gt_i32 vcc, v122, v123
    v_mad_u32_u24 v124, v120, 5, v126
    v_bfm_b32 v122, v122, 28
    v_bfm_b32 v123, v123, 28
    v_mbcnt_lo_u32_b32 v125, vcc_lo, 0
    v_mbcnt_hi_u32_b32 v125, vcc_hi, v125
    v_bitop3_b32 v124, v122, v123, v124 bitop3:0x9a
    v_add_lshl_u32 v125, v125, s37, 2
    s_bcnt1_i32_b64 s41, vcc
    s_mov_b64 exec, vcc
    ds_write_b32 v125, v124
    s_mov_b64 exec, -1
    v_cmp_gt_i32 vcc, v121, v3
    s_add_u32 s37, s37, s41
    s_min_u32 s37, s37, s48
    s_cbranch_vccnz L2_xe77
L2_xr77:
    s_lshl_b32 s3, s37, 2
    v_add_u32 v125, s3, v1
    v_mov_b32 v124, -1
    ds_write_b32 v125, v124
    s_lshl_b32 s3, s38, 2
    v_add_u32 v125, s3, v1
    ds_read2st64_b32 v[40:41], v125 offset0:0 offset1:1
    ds_read2st64_b32 v[42:43], v125 offset0:2 offset1:3
    s_sub_u32 s41, s37, s38
    s_sub_u32 s3, s41, 192
    s_cmp_gt_u32 s3, 64
    s_cbranch_scc1 L2_xf78
L2_xg78:
    s_waitcnt vmcnt(12)
    ds_write_b128 v7, v[44:47] offset:0
    s_waitcnt vmcnt(9)
    ds_write_b128 v7, v[48:51] offset:1024
    s_add_u32 s42, s42, 1
    s_waitcnt lgkmcnt(0)
    s_barrier
    s_setprio 3
    s_bitcmp1_b32 s36, s42
    s_cbranch_scc1 L2_slow
L2_ret3:
    v_and_b32 v115, 0x20000000, v21
    v_lshrrev_b32 v116, 14, v17
    v_bitop3_b32 v116, v116, v8, v115 bitop3:0xea
    ds_read_b64 v[86:87], v116 offset:63616
    v_and_b32 v114, 0x10000000, v21
    v_lshrrev_b32 v116, 14, v16
    v_bitop3_b32 v116, v116, v8, v114 bitop3:0xea
    ds_read_b64 v[84:85], v116 offset:63616
    v_perm_b32 v112, v16, v20, s44
    v_bitop3_b32 v108, v16, v8, v114 bitop3:0xea
    v_perm_b32 v113, v17, v20, s45
    v_bitop3_b32 v109, v17, v8, v115 bitop3:0xea
    s_waitcnt lgkmcnt(0)
    v_mfma_f32_4x4x4_16b_bf16 v[100:103], v[10:11], v[86:87], 0
    v_mfma_f32_4x4x4_16b_bf16 v[96:99], v[10:11], v[84:85], 0
    v_bitop3_b32 v116, v16, 0.5, -0.5 bitop3:0xa8
    v_bitop3_b32 v112, v9, v112, v116 bitop3:0xca
    v_bitop3_b32 v116, v17, 0.5, -0.5 bitop3:0xa8
    v_bitop3_b32 v113, v9, v113, v116 bitop3:0xca
    v_cmp_lt_u32 s[84:85], v8, v108
    v_pk_mul_f32 v[100:101], v[100:101], v[112:113] op_sel:[0,1] op_sel_hi:[1,1]
    v_pk_mul_f32 v[102:103], v[102:103], v[112:113] op_sel:[0,1] op_sel_hi:[1,1]
    v_pk_mul_f32 v[96:97], v[96:97], v[112:113] op_sel:[0,0] op_sel_hi:[1,0]
    v_pk_mul_f32 v[98:99], v[98:99], v[112:113] op_sel:[0,0] op_sel_hi:[1,0]
    buffer_load_dwordx4 v[44:47], v5, s[16:19], s40 offen offset:0
    v_cmpx_ne_u64 vcc, v[94:95], v[90:91]
    s_and_b64 s[82:83], vcc, s[80:81]
    s_cbranch_scc1 L2_c79
L2_d79:
    v_mov_b64 v[104:105], v[90:91]
    v_mov_b32 v117, v111
    v_mov_b64 v[106:107], v[94:95]
    s_mov_b64 exec, -1
    s_or_b64 s[80:81], s[80:81], vcc
    v_cmpx_ne_u64 vcc, v[92:93], v[88:89]
    s_and_b64 s[82:83], vcc, s[80:81]
    s_cbranch_scc1 L2_c80
L2_d80:
    v_mov_b64 v[104:105], v[88:89]
    v_mov_b32 v117, v110
    v_mov_b64 v[106:107], v[92:93]
    s_mov_b64 exec, -1
    s_or_b64 s[80:81], s[80:81], vcc
    ds_read_b64 v[90:91], v109
    s_and_b64 exec, s[84:85], s[80:81]
    v_mfma_f32_4x4x4_16b_bf16 v[96:99], v[14:15], v[104:105], 0
    v_mov_b32 v108, v117
    s_andn2_b64 s[80:81], s[80:81], s[84:85]
    v_mfma_f32_4x4x4_16b_bf16 v[96:99], v[12:13], v[106:107], v[96:99]
    s_mov_b64 exec, -1
    ds_read_b64 v[88:89], v108
    v_and_b32 v115, 0x80000000, v21
    v_lshrrev_b32 v116, 14, v19
    v_bitop3_b32 v116, v116, v8, v115 bitop3:0xea
    ds_read_b64 v[86:87], v116 offset:63616
    v_and_b32 v114, 0x40000000, v21
    v_lshrrev_b32 v116, 14, v18
    v_bitop3_b32 v116, v116, v8, v114 bitop3:0xea
    ds_read_b64 v[84:85], v116 offset:63616
    s_waitcnt lgkmcnt(2)
    v_mfma_f32_4x4x4_16b_bf16 v[100:103], v[12:13], v[90:91], v[100:103]
    v_mfma_f32_4x4x4_16b_bf16 v[96:99], v[12:13], v[88:89], v[96:99]
    v_perm_b32 v112, v18, v20, s46
    v_bitop3_b32 v110, v18, v8, v114 bitop3:0xea
    v_perm_b32 v113, v19, v20, s47
    v_bitop3_b32 v111, v19, v8, v115 bitop3:0xea
    v_cvt_pk_bf16_f32 v100, v100, v101
    v_cvt_pk_bf16_f32 v101, v102, v103
    ds_wrxchg_rtn_b64 v[94:95], v109, v[100:101]
    v_cvt_pk_bf16_f32 v96, v96, v97
    v_cvt_pk_bf16_f32 v97, v98, v99
    ds_wrxchg_rtn_b64 v[92:93], v108, v[96:97]
    s_waitcnt lgkmcnt(2)
    v_mfma_f32_4x4x4_16b_bf16 v[100:103], v[10:11], v[86:87], 0
    v_mfma_f32_4x4x4_16b_bf16 v[96:99], v[10:11], v[84:85], 0
    v_bitop3_b32 v116, v18, 0.5, -0.5 bitop3:0xa8
    v_bitop3_b32 v112, v9, v112, v116 bitop3:0xca
    v_bitop3_b32 v116, v19, 0.5, -0.5 bitop3:0xa8
    v_bitop3_b32 v113, v9, v113, v116 bitop3:0xca
    v_pk_mul_f32 v[100:101], v[100:101], v[112:113] op_sel:[0,1] op_sel_hi:[1,1]
    v_pk_mul_f32 v[102:103], v[102:103], v[112:113] op_sel:[0,1] op_sel_hi:[1,1]
    v_pk_mul_f32 v[96:97], v[96:97], v[112:113] op_sel:[0,0] op_sel_hi:[1,0]
    v_pk_mul_f32 v[98:99], v[98:99], v[112:113] op_sel:[0,0] op_sel_hi:[1,0]
    v_and_b32 v116, 0x0fffffff, v40
    v_mov_b32 v21, v40
    buffer_load_dwordx4 v[16:19], v116, s[8:11], 0 offen
    buffer_load_dwordx3 v[18:20], v116, s[8:11], 0 offen offset:8
    s_waitcnt lgkmcnt(0)
    v_cmpx_ne_u64 vcc, v[94:95], v[90:91]
    s_and_b64 s[82:83], vcc, s[80:81]
    s_cbranch_scc1 L2_c81
L2_d81:
    v_mov_b64 v[104:105], v[90:91]
    v_mov_b32 v117, v109
    v_mov_b64 v[106:107], v[94:95]
    s_mov_b64 exec, -1
    s_or_b64 s[80:81], s[80:81], vcc
    v_cmpx_ne_u64 vcc, v[92:93], v[88:89]
    s_and_b64 s[82:83], vcc, s[80:81]
    s_cbranch_scc1 L2_c82
L2_d82:
    v_mov_b64 v[104:105], v[88:89]
    v_mov_b32 v117, v108
    v_mov_b64 v[106:107], v[92:93]
    s_mov_b64 exec, -1
    s_or_b64 s[80:81], s[80:81], vcc
    ds_read_b64 v[90:91], v111
    ds_read_b64 v[88:89], v110
    s_waitcnt vmcnt(10)
    v_and_b32 v115, 0x20000000, v27
    v_lshrrev_b32 v116, 14, v23
    v_bitop3_b32 v116, v116, v8, v115 bitop3:0xea
    ds_read_b64 v[86:87], v116 offset:63616
    v_and_b32 v114, 0x10000000, v27
    v_lshrrev_b32 v116, 14, v22
    v_bitop3_b32 v116, v116, v8, v114 bitop3:0xea
    ds_read_b64 v[84:85], v116 offset:63616
    s_waitcnt lgkmcnt(2)
    v_mfma_f32_4x4x4_16b_bf16 v[100:103], v[12:13], v[90:91], v[100:103]
    v_mfma_f32_4x4x4_16b_bf16 v[96:99], v[12:13], v[88:89], v[96:99]
    v_perm_b32 v112, v22, v26, s44
    v_bitop3_b32 v108, v22, v8, v114 bitop3:0xea
    v_perm_b32 v113, v23, v26, s45
    v_bitop3_b32 v109, v23, v8, v115 bitop3:0xea
    v_cvt_pk_bf16_f32 v100, v100, v101
    v_cvt_pk_bf16_f32 v101, v102, v103
    ds_wrxchg_rtn_b64 v[94:95], v111, v[100:101]
    v_cvt_pk_bf16_f32 v96, v96, v97
    v_cvt_pk_bf16_f32 v97, v98, v99
    ds_wrxchg_rtn_b64 v[92:93], v110, v[96:97]
    s_setprio 2
    s_waitcnt lgkmcnt(2)
    v_mfma_f32_4x4x4_16b_bf16 v[100:103], v[10:11], v[86:87], 0
    v_mfma_f32_4x4x4_16b_bf16 v[96:99], v[10:11], v[84:85], 0
    v_bitop3_b32 v116, v22, 0.5, -0.5 bitop3:0xa8
    v_bitop3_b32 v112, v9, v112, v116 bitop3:0xca
    v_bitop3_b32 v116, v23, 0.5, -0.5 bitop3:0xa8
    v_bitop3_b32 v113, v9, v113, v116 bitop3:0xca
    v_cmp_lt_u32 s[84:85], v8, v108
    v_pk_mul_f32 v[100:101], v[100:101], v[112:113] op_sel:[0,1] op_sel_hi:[1,1]
    v_pk_mul_f32 v[102:103], v[102:103], v[112:113] op_sel:[0,1] op_sel_hi:[1,1]
    v_pk_mul_f32 v[96:97], v[96:97], v[112:113] op_sel:[0,0] op_sel_hi:[1,0]
    v_pk_mul_f32 v[98:99], v[98:99], v[112:113] op_sel:[0,0] op_sel_hi:[1,0]
    buffer_load_dwordx4 v[48:51], v5, s[16:19], s40 offen offset:1024
    s_add_u32 s40, s40, 0x4e200
    s_waitcnt lgkmcnt(0)
    v_cmpx_ne_u64 vcc, v[94:95], v[90:91]
    s_and_b64 s[82:83], vcc, s[80:81]
    s_cbranch_scc1 L2_c83
L2_d83:
    v_mov_b64 v[104:105], v[90:91]
    v_mov_b32 v117, v111
    v_mov_b64 v[106:107], v[94:95]
    s_mov_b64 exec, -1
    s_or_b64 s[80:81], s[80:81], vcc
    v_cmpx_ne_u64 vcc, v[92:93], v[88:89]
    s_and_b64 s[82:83], vcc, s[80:81]
    s_cbranch_scc1 L2_c84
L2_d84:
    v_mov_b64 v[104:105], v[88:89]
    v_mov_b32 v117, v110
    v_mov_b64 v[106:107], v[92:93]
    s_mov_b64 exec, -1
    s_or_b64 s[80:81], s[80:81], vcc
    ds_read_b64 v[90:91], v109
    s_and_b64 exec, s[84:85], s[80:81]
    v_mfma_f32_4x4x4_16b_bf16 v[96:99], v[14:15], v[104:105], 0
    v_mov_b32 v108, v117
    s_andn2_b64 s[80:81], s[80:81], s[84:85]
    v_mfma_f32_4x4x4_16b_bf16 v[96:99], v[12:13], v[106:107], v[96:99]
    s_mov_b64 exec, -1
    ds_read_b64 v[88:89], v108
    v_and_b32 v115, 0x80000000, v27
    v_lshrrev_b32 v116, 14, v25
    v_bitop3_b32 v116, v116, v8, v115 bitop3:0xea
    ds_read_b64 v[86:87], v116 offset:63616
    v_and_b32 v114, 0x40000000, v27
    v_lshrrev_b32 v116, 14, v24
    v_bitop3_b32 v116, v116, v8, v114 bitop3:0xea
    ds_read_b64 v[84:85], v116 offset:63616
    s_waitcnt lgkmcnt(2)
    v_mfma_f32_4x4x4_16b_bf16 v[100:103], v[12:13], v[90:91], v[100:103]
    v_mfma_f32_4x4x4_16b_bf16 v[96:99], v[12:13], v[88:89], v[96:99]
    v_perm_b32 v112, v24, v26, s46
    v_bitop3_b32 v110, v24, v8, v114 bitop3:0xea
    v_perm_b32 v113, v25, v26, s47
    v_bitop3_b32 v111, v25, v8, v115 bitop3:0xea
    v_cvt_pk_bf16_f32 v100, v100, v101
    v_cvt_pk_bf16_f32 v101, v102, v103
    ds_wrxchg_rtn_b64 v[94:95], v109, v[100:101]
    v_cvt_pk_bf16_f32 v96, v96, v97
    v_cvt_pk_bf16_f32 v97, v98, v99
    ds_wrxchg_rtn_b64 v[92:93], v108, v[96:97]
    s_waitcnt lgkmcnt(2)
    v_mfma_f32_4x4x4_16b_bf16 v[100:103], v[10:11], v[86:87], 0
    v_mfma_f32_4x4x4_16b_bf16 v[96:99], v[10:11], v[84:85], 0
    v_bitop3_b32 v116, v24, 0.5, -0.5 bitop3:0xa8
    v_bitop3_b32 v112, v9, v112, v116 bitop3:0xca
    v_bitop3_b32 v116, v25, 0.5, -0.5 bitop3:0xa8
    v_bitop3_b32 v113, v9, v113, v116 bitop3:0xca
    v_pk_mul_f32 v[100:101], v[100:101], v[112:113] op_sel:[0,1] op_sel_hi:[1,1]
    v_pk_mul_f32 v[102:103], v[102:103], v[112:113] op_sel:[0,1] op_sel_hi:[1,1]
    v_pk_mul_f32 v[96:97], v[96:97], v[112:113] op_sel:[0,0] op_sel_hi:[1,0]
    v_pk_mul_f32 v[98:99], v[98:99], v[112:113] op_sel:[0,0] op_sel_hi:[1,0]
    v_and_b32 v116, 0x0fffffff, v41
    v_mov_b32 v27, v41
    buffer_load_dwordx4 v[22:25], v116, s[8:11], 0 offen
    buffer_load_dwordx3 v[24:26], v116, s[8:11], 0 offen offset:8
    s_waitcnt lgkmcnt(0)
    v_cmpx_ne_u64 vcc, v[94:95], v[90:91]
    s_and_b64 s[82:83], vcc, s[80:81]
    s_cbranch_scc1 L2_c85
L2_d85:
    v_mov_b64 v[104:105], v[90:91]
    v_mov_b32 v117, v109
    v_mov_b64 v[106:107], v[94:95]
    s_mov_b64 exec, -1
    s_or_b64 s[80:81], s[80:81], vcc
    v_cmpx_ne_u64 vcc, v[92:93], v[88:89]
    s_and_b64 s[82:83], vcc, s[80:81]
    s_cbranch_scc1 L2_c86
L2_d86:
    v_mov_b64 v[104:105], v[88:89]
    v_mov_b32 v117, v108
    v_mov_b64 v[106:107], v[92:93]
    s_mov_b64 exec, -1
    s_or_b64 s[80:81], s[80:81], vcc
    ds_read_b64 v[90:91], v111
    ds_read_b64 v[88:89], v110
    s_waitcnt vmcnt(11)
    v_and_b32 v115, 0x20000000, v33
    v_lshrrev_b32 v116, 14, v29
    v_bitop3_b32 v116, v116, v8, v115 bitop3:0xea
    ds_read_b64 v[86:87], v116 offset:63616
    v_and_b32 v114, 0x10000000, v33
    v_lshrrev_b32 v116, 14, v28
    v_bitop3_b32 v116, v116, v8, v114 bitop3:0xea
    ds_read_b64 v[84:85], v116 offset:63616
    s_waitcnt lgkmcnt(2)
    v_mfma_f32_4x4x4_16b_bf16 v[100:103], v[12:13], v[90:91], v[100:103]
    v_mfma_f32_4x4x4_16b_bf16 v[96:99], v[12:13], v[88:89], v[96:99]
    v_perm_b32 v112, v28, v32, s44
    v_bitop3_b32 v108, v28, v8, v114 bitop3:0xea
    v_perm_b32 v113, v29, v32, s45
    v_bitop3_b32 v109, v29, v8, v115 bitop3:0xea
    v_cvt_pk_bf16_f32 v100, v100, v101
    v_cvt_pk_bf16_f32 v101, v102, v103
    ds_wrxchg_rtn_b64 v[94:95], v111, v[100:101]
    v_cvt_pk_bf16_f32 v96, v96, v97
    v_cvt_pk_bf16_f32 v97, v98, v99
    ds_wrxchg_rtn_b64 v[92:93], v110, v[96:97]
    s_setprio 1
    s_waitcnt lgkmcnt(2)
    v_mfma_f32_4x4x4_16b_bf16 v[100:103], v[10:11], v[86:87], 0
    v_mfma_f32_4x4x4_16b_bf16 v[96:99], v[10:11], v[84:85], 0
    v_bitop3_b32 v116, v28, 0.5, -0.5 bitop3:0xa8
    v_bitop3_b32 v112, v9, v112, v116 bitop3:0xca
    v_bitop3_b32 v116, v29, 0.5, -0.5 bitop3:0xa8
    v_bitop3_b32 v113, v9, v113, v116 bitop3:0xca
    v_cmp_lt_u32 s[84:85], v8, v108
    v_pk_mul_f32 v[100:101], v[100:101], v[112:113] op_sel:[0,1] op_sel_hi:[1,1]
    v_pk_mul_f32 v[102:103], v[102:103], v[112:113] op_sel:[0,1] op_sel_hi:[1,1]
    v_pk_mul_f32 v[96:97], v[96:97], v[112:113] op_sel:[0,0] op_sel_hi:[1,0]
    v_pk_mul_f32 v[98:99], v[98:99], v[112:113] op_sel:[0,0] op_sel_hi:[1,0]
    s_waitcnt lgkmcnt(0)
    v_cmpx_ne_u64 vcc, v[94:95], v[90:91]
    s_and_b64 s[82:83], vcc, s[80:81]
    s_cbranch_scc1 L2_c87
L2_d87:
    v_mov_b64 v[104:105], v[90:91]
    v_mov_b32 v117, v111
    v_mov_b64 v[106:107], v[94:95]
    s_mov_b64 exec, -1
    s_or_b64 s[80:81], s[80:81], vcc
    v_cmpx_ne_u64 vcc, v[92:93], v[88:89]
    s_and_b64 s[82:83], vcc, s[80:81]
    s_cbranch_scc1 L2_c88
L2_d88:
    v_mov_b64 v[104:105], v[88:89]
    v_mov_b32 v117, v110
    v_mov_b64 v[106:107], v[92:93]
    s_mov_b64 exec, -1
    s_or_b64 s[80:81], s[80:81], vcc
    ds_read_b64 v[90:91], v109
    s_and_b64 exec, s[84:85], s[80:81]
    v_mfma_f32_4x4x4_16b_bf16 v[96:99], v[14:15], v[104:105], 0
    v_mov_b32 v108, v117
    s_andn2_b64 s[80:81], s[80:81], s[84:85]
    v_mfma_f32_4x4x4_16b_bf16 v[96:99], v[12:13], v[106:107], v[96:99]
    s_mov_b64 exec, -1
    ds_read_b64 v[88:89], v108
    v_and_b32 v115, 0x80000000, v33
    v_lshrrev_b32 v116, 14, v31
    v_bitop3_b32 v116, v116, v8, v115 bitop3:0xea
    ds_read_b64 v[86:87], v116 offset:63616
    v_and_b32 v114, 0x40000000, v33
    v_lshrrev_b32 v116, 14, v30
    v_bitop3_b32 v116, v116, v8, v114 bitop3:0xea
    ds_read_b64 v[84:85], v116 offset:63616
    s_waitcnt lgkmcnt(2)
    v_mfma_f32_4x4x4_16b_bf16 v[100:103], v[12:13], v[90:91], v[100:103]
    v_mfma_f32_4x4x4_16b_bf16 v[96:99], v[12:13], v[88:89], v[96:99]
    v_perm_b32 v112, v30, v32, s46
    v_bitop3_b32 v110, v30, v8, v114 bitop3:0xea
    v_perm_b32 v113, v31, v32, s47
    v_bitop3_b32 v111, v31, v8, v115 bitop3:0xea
    v_cvt_pk_bf16_f32 v100, v100, v101
    v_cvt_pk_bf16_f32 v101, v102, v103
    ds_wrxchg_rtn_b64 v[94:95], v109, v[100:101]
    v_cvt_pk_bf16_f32 v96, v96, v97
    v_cvt_pk_bf16_f32 v97, v98, v99
    ds_wrxchg_rtn_b64 v[92:93], v108, v[96:97]
    s_waitcnt lgkmcnt(2)
    v_mfma_f32_4x4x4_16b_bf16 v[100:103], v[10:11], v[86:87], 0
    v_mfma_f32_4x4x4_16b_bf16 v[96:99], v[10:11], v[84:85], 0
    v_bitop3_b32 v116, v30, 0.5, -0.5 bitop3:0xa8
    v_bitop3_b32 v112, v9, v112, v116 bitop3:0xca
    v_bitop3_b32 v116, v31, 0.5, -0.5 bitop3:0xa8
    v_bitop3_b32 v113, v9, v113, v116 bitop3:0xca
    v_pk_mul_f32 v[100:101], v[100:101], v[112:113] op_sel:[0,1] op_sel_hi:[1,1]
    v_pk_mul_f32 v[102:103], v[102:103], v[112:113] op_sel:[0,1] op_sel_hi:[1,1]
    v_pk_mul_f32 v[96:97], v[96:97], v[112:113] op_sel:[0,0] op_sel_hi:[1,0]
    v_pk_mul_f32 v[98:99], v[98:99], v[112:113] op_sel:[0,0] op_sel_hi:[1,0]
    v_and_b32 v116, 0x0fffffff, v42
    v_mov_b32 v33, v42
    buffer_load_dwordx4 v[28:31], v116, s[8:11], 0 offen
    buffer_load_dwordx3 v[30:32], v116, s[8:11], 0 offen offset:8
    s_waitcnt lgkmcnt(0)
    v_cmpx_ne_u64 vcc, v[94:95], v[90:91]
    s_and_b64 s[82:83], vcc, s[80:81]
    s_cbranch_scc1 L2_c89
L2_d89:
    v_mov_b64 v[104:105], v[90:91]
    v_mov_b32 v117, v109
    v_mov_b64 v[106:107], v[94:95]
    s_mov_b64 exec, -1
    s_or_b64 s[80:81], s[80:81], vcc
    v_cmpx_ne_u64 vcc, v[92:93], v[88:89]
    s_and_b64 s[82:83], vcc, s[80:81]
    s_cbranch_scc1 L2_c90
L2_d90:
    v_mov_b64 v[104:105], v[88:89]
    v_mov_b32 v117, v108
    v_mov_b64 v[106:107], v[92:93]
    s_mov_b64 exec, -1
    s_or_b64 s[80:81], s[80:81], vcc
    ds_read_b64 v[90:91], v111
    ds_read_b64 v[88:89], v110
    s_waitcnt vmcnt(11)
    v_and_b32 v115, 0x20000000, v39
    v_lshrrev_b32 v116, 14, v35
    v_bitop3_b32 v116, v116, v8, v115 bitop3:0xea
    ds_read_b64 v[86:87], v116 offset:63616
    v_and_b32 v114, 0x10000000, v39
    v_lshrrev_b32 v116, 14, v34
    v_bitop3_b32 v116, v116, v8, v114 bitop3:0xea
    ds_read_b64 v[84:85], v116 offset:63616
    s_waitcnt lgkmcnt(2)
    v_mfma_f32_4x4x4_16b_bf16 v[100:103], v[12:13], v[90:91], v[100:103]
    v_mfma_f32_4x4x4_16b_bf16 v[96:99], v[12:13], v[88:89], v[96:99]
    v_perm_b32 v112, v34, v38, s44
    v_bitop3_b32 v108, v34, v8, v114 bitop3:0xea
    v_perm_b32 v113, v35, v38, s45
    v_bitop3_b32 v109, v35, v8, v115 bitop3:0xea
    v_cvt_pk_bf16_f32 v100, v100, v101
    v_cvt_pk_bf16_f32 v101, v102, v103
    ds_wrxchg_rtn_b64 v[94:95], v111, v[100:101]
    v_cvt_pk_bf16_f32 v96, v96, v97
    v_cvt_pk_bf16_f32 v97, v98, v99
    ds_wrxchg_rtn_b64 v[92:93], v110, v[96:97]
    s_setprio 0
    s_waitcnt lgkmcnt(2)
    v_mfma_f32_4x4x4_16b_bf16 v[100:103], v[10:11], v[86:87], 0
    v_mfma_f32_4x4x4_16b_bf16 v[96:99], v[10:11], v[84:85], 0
    v_bitop3_b32 v116, v34, 0.5, -0.5 bitop3:0xa8
    v_bitop3_b32 v112, v9, v112, v116 bitop3:0xca
    v_bitop3_b32 v116, v35, 0.5, -0.5 bitop3:0xa8
    v_bitop3_b32 v113, v9, v113, v116 bitop3:0xca
    v_cmp_lt_u32 s[84:85], v8, v108
    v_pk_mul_f32 v[100:101], v[100:101], v[112:113] op_sel:[0,1] op_sel_hi:[1,1]
    v_pk_mul_f32 v[102:103], v[102:103], v[112:113] op_sel:[0,1] op_sel_hi:[1,1]
    v_pk_mul_f32 v[96:97], v[96:97], v[112:113] op_sel:[0,0] op_sel_hi:[1,0]
    v_pk_mul_f32 v[98:99], v[98:99], v[112:113] op_sel:[0,0] op_sel_hi:[1,0]
    s_waitcnt lgkmcnt(0)
    v_cmpx_ne_u64 vcc, v[94:95], v[90:91]
    s_and_b64 s[82:83], vcc, s[80:81]
    s_cbranch_scc1 L2_c91
L2_d91:
    v_mov_b64 v[104:105], v[90:91]
    v_mov_b32 v117, v111
    v_mov_b64 v[106:107], v[94:95]
    s_mov_b64 exec, -1
    s_or_b64 s[80:81], s[80:81], vcc
    v_cmpx_ne_u64 vcc, v[92:93], v[88:89]
    s_and_b64 s[82:83], vcc, s[80:81]
    s_cbranch_scc1 L2_c92
L2_d92:
    v_mov_b64 v[104:105], v[88:89]
    v_mov_b32 v117, v110
    v_mov_b64 v[106:107], v[92:93]
    s_mov_b64 exec, -1
    s_or_b64 s[80:81], s[80:81], vcc
    ds_read_b64 v[90:91], v109
    s_and_b64 exec, s[84:85], s[80:81]
    v_mfma_f32_4x4x4_16b_bf16 v[96:99], v[14:15], v[104:105], 0
    v_mov_b32 v108, v117
    s_andn2_b64 s[80:81], s[80:81], s[84:85]
    v_mfma_f32_4x4x4_16b_bf16 v[96:99], v[12:13], v[106:107], v[96:99]
    s_mov_b64 exec, -1
    ds_read_b64 v[88:89], v108
    v_and_b32 v115, 0x80000000, v39
    v_lshrrev_b32 v116, 14, v37
    v_bitop3_b32 v116, v116, v8, v115 bitop3:0xea
    ds_read_b64 v[86:87], v116 offset:63616
    v_and_b32 v114, 0x40000000, v39
    v_lshrrev_b32 v116, 14, v36
    v_bitop3_b32 v116, v116, v8, v114 bitop3:0xea
    ds_read_b64 v[84:85], v116 offset:63616
    s_waitcnt lgkmcnt(2)
    v_mfma_f32_4x4x4_16b_bf16 v[100:103], v[12:13], v[90:91], v[100:103]
    v_mfma_f32_4x4x4_16b_bf16 v[96:99], v[12:13], v[88:89], v[96:99]
    v_perm_b32 v112, v36, v38, s46
    v_bitop3_b32 v110, v36, v8, v114 bitop3:0xea
    v_perm_b32 v113, v37, v38, s47
    v_bitop3_b32 v111, v37, v8, v115 bitop3:0xea
    v_cvt_pk_bf16_f32 v100, v100, v101
    v_cvt_pk_bf16_f32 v101, v102, v103
    ds_wrxchg_rtn_b64 v[94:95], v109, v[100:101]
    v_cvt_pk_bf16_f32 v96, v96, v97
    v_cvt_pk_bf16_f32 v97, v98, v99
    ds_wrxchg_rtn_b64 v[92:93], v108, v[96:97]
    s_waitcnt lgkmcnt(2)
    v_mfma_f32_4x4x4_16b_bf16 v[100:103], v[10:11], v[86:87], 0
    v_mfma_f32_4x4x4_16b_bf16 v[96:99], v[10:11], v[84:85], 0
    v_bitop3_b32 v116, v36, 0.5, -0.5 bitop3:0xa8
    v_bitop3_b32 v112, v9, v112, v116 bitop3:0xca
    v_bitop3_b32 v116, v37, 0.5, -0.5 bitop3:0xa8
    v_bitop3_b32 v113, v9, v113, v116 bitop3:0xca
    v_pk_mul_f32 v[100:101], v[100:101], v[112:113] op_sel:[0,1] op_sel_hi:[1,1]
    v_pk_mul_f32 v[102:103], v[102:103], v[112:113] op_sel:[0,1] op_sel_hi:[1,1]
    v_pk_mul_f32 v[96:97], v[96:97], v[112:113] op_sel:[0,0] op_sel_hi:[1,0]
    v_pk_mul_f32 v[98:99], v[98:99], v[112:113] op_sel:[0,0] op_sel_hi:[1,0]
    v_and_b32 v116, 0x0fffffff, v43
    v_mov_b32 v39, v43
    buffer_load_dwordx4 v[34:37], v116, s[8:11], 0 offen
    buffer_load_dwordx3 v[36:38], v116, s[8:11], 0 offen offset:8
    s_waitcnt lgkmcnt(0)
    v_cmpx_ne_u64 vcc, v[94:95], v[90:91]
    s_and_b64 s[82:83], vcc, s[80:81]
    s_cbranch_scc1 L2_c93
L2_d93:
    v_mov_b64 v[104:105], v[90:91]
    v_mov_b32 v117, v109
    v_mov_b64 v[106:107], v[94:95]
    s_mov_b64 exec, -1
    s_or_b64 s[80:81], s[80:81], vcc
    v_cmpx_ne_u64 vcc, v[92:93], v[88:89]
    s_and_b64 s[82:83], vcc, s[80:81]
    s_cbranch_scc1 L2_c94
L2_d94:
    v_mov_b64 v[104:105], v[88:89]
    v_mov_b32 v117, v108
    v_mov_b64 v[106:107], v[92:93]
    s_mov_b64 exec, -1
    s_or_b64 s[80:81], s[80:81], vcc
    ds_read_b64 v[90:91], v111
    ds_read_b64 v[88:89], v110
    s_waitcnt lgkmcnt(0)
    v_mfma_f32_4x4x4_16b_bf16 v[100:103], v[12:13], v[90:91], v[100:103]
    v_mfma_f32_4x4x4_16b_bf16 v[96:99], v[12:13], v[88:89], v[96:99]
    s_nop 3
    v_cvt_pk_bf16_f32 v100, v100, v101
    v_cvt_pk_bf16_f32 v101, v102, v103
    ds_wrxchg_rtn_b64 v[94:95], v111, v[100:101]
    v_cvt_pk_bf16_f32 v96, v96, v97
    v_cvt_pk_bf16_f32 v97, v98, v99
    ds_wrxchg_rtn_b64 v[92:93], v110, v[96:97]
    s_cmp_eq_u32 s35, 3
    s_cbranch_scc1 L2_done
    s_add_u32 s35, s35, 1
    s_barrier
    s_waitcnt vmcnt(12)
    ds_write_b128 v7, v[52:55] offset:2048
    buffer_load_dwordx4 v[52:55], v5, s[16:19], s40 offen offset:2048
    s_mov_b32 s37, s38
    s_setprio 3
    v_and_b32_dpp v118, v66, v6 quad_perm:[0,0,0,0] row_mask:0xf bank_mask:0xf
    v_and_b32_dpp v119, v66, v6 quad_perm:[2,2,2,2] row_mask:0xf bank_mask:0xf
    v_and_b32 v120, -4, v118
    v_add_u32 v120, v120, v2
L2_x95:
    v_sub_u32 v121, v119, v120
    v_sub_u32 v123, v118, v120
    v_med3_i32 v122, v121, 0, 4
    v_max_i32 v123, 0, v123
    v_cmp_gt_i32 vcc, v122, v123
    v_mad_u32_u24 v124, v120, 5, v4
    v_bfm_b32 v122, v122, 28
    v_bfm_b32 v123, v123, 28
    v_mbcnt_lo_u32_b32 v125, vcc_lo, 0
    v_mbcnt_hi_u32_b32 v125, vcc_hi, v125
    v_bitop3_b32 v124, v122, v123, v124 bitop3:0x9a
    v_add_lshl_u32 v125, v125, s37, 2
    s_bcnt1_i32_b64 s41, vcc
    s_mov_b64 exec, vcc
    ds_write_b32 v125, v124
    s_mov_b64 exec, -1
    v_cmp_gt_i32 vcc, v121, v3
    s_add_u32 s37, s37, s41
    s_min_u32 s37, s37, s48
    s_cbranch_vccnz L2_xe95
L2_xr95:
    s_waitcnt vmcnt(12)
    ds_write_b128 v7, v[56:59] offset:3072
    buffer_load_dwordx4 v[56:59], v5, s[16:19], s40 offen offset:3072
    s_setprio 2
    v_and_b32_dpp v118, v70, v6 quad_perm:[0,0,0,0] row_mask:0xf bank_mask:0xf
    v_and_b32_dpp v119, v70, v6 quad_perm:[2,2,2,2] row_mask:0xf bank_mask:0xf
    v_and_b32 v120, -4, v118
    v_add_u32 v120, v120, v2
    v_add_u32 v126, 0x2a4000, v4
L2_x96:
    v_sub_u32 v121, v119, v120
    v_sub_u32 v123, v118, v120
    v_med3_i32 v122, v121, 0, 4
    v_max_i32 v123, 0, v123
    v_cmp_gt_i32 vcc, v122, v123
    v_mad_u32_u24 v124, v120, 5, v126
    v_bfm_b32 v122, v122, 28
    v_bfm_b32 v123, v123, 28
    v_mbcnt_lo_u32_b32 v125, vcc_lo, 0
    v_mbcnt_hi_u32_b32 v125, vcc_hi, v125
    v_bitop3_b32 v124, v122, v123, v124 bitop3:0x9a
    v_add_lshl_u32 v125, v125, s37, 2
    s_bcnt1_i32_b64 s41, vcc
    s_mov_b64 exec, vcc
    ds_write_b32 v125, v124
    s_mov_b64 exec, -1
    v_cmp_gt_i32 vcc, v121, v3
    s_add_u32 s37, s37, s41
    s_min_u32 s37, s37, s48
    s_cbranch_vccnz L2_xe96
L2_xr96:
    s_waitcnt vmcnt(12)
    ds_write_b128 v7, v[60:63] offset:4096
    s_add_u32 s3, s40, 4096
    buffer_load_dwordx4 v[60:63], v5, s[16:19], s3 offen
    s_setprio 1
    v_and_b32_dpp v118, v74, v6 quad_perm:[0,0,0,0] row_mask:0xf bank_mask:0xf
    v_and_b32_dpp v119, v74, v6 quad_perm:[2,2,2,2] row_mask:0xf bank_mask:0xf
    v_and_b32 v120, -4, v118
    v_add_u32 v120, v120, v2
    v_add_u32 v126, 0x548000, v4
L2_x97:
    v_sub_u32 v121, v119, v120
    v_sub_u32 v123, v118, v120
    v_med3_i32 v122, v121, 0, 4
    v_max_i32 v123, 0, v123
    v_cmp_gt_i32 vcc, v122, v123
    v_mad_u32_u24 v124, v120, 5, v126
    v_bfm_b32 v122, v122, 28
    v_bfm_b32 v123, v123, 28
    v_mbcnt_lo_u32_b32 v125, vcc_lo, 0
    v_mbcnt_hi_u32_b32 v125, vcc_hi, v125
    v_bitop3_b32 v124, v122, v123, v124 bitop3:0x9a
    v_add_lshl_u32 v125, v125, s37, 2
    s_bcnt1_i32_b64 s41, vcc
    s_mov_b64 exec, vcc
    ds_write_b32 v125, v124
    s_mov_b64 exec, -1
    v_cmp_gt_i32 vcc, v121, v3
    s_add_u32 s37, s37, s41
    s_min_u32 s37, s37, s48
    s_cbranch_vccnz L2_xe97
L2_xr97:
    s_setprio 0
    v_and_b32_dpp v118, v78, v6 quad_perm:[0,0,0,0] row_mask:0xf bank_mask:0xf
    v_and_b32_dpp v119, v78, v6 quad_perm:[2,2,2,2] row_mask:0xf bank_mask:0xf
    v_and_b32 v120, -4, v118
    v_add_u32 v120, v120, v2
    v_add_u32 v126, 0x7ec000, v4
L2_x98:
    v_sub_u32 v121, v119, v120
    v_sub_u32 v123, v118, v120
    v_med3_i32 v122, v121, 0, 4
    v_max_i32 v123, 0, v123
    v_cmp_gt_i32 vcc, v122, v123
    v_mad_u32_u24 v124, v120, 5, v126
    v_bfm_b32 v122, v122, 28
    v_bfm_b32 v123, v123, 28
    v_mbcnt_lo_u32_b32 v125, vcc_lo, 0
    v_mbcnt_hi_u32_b32 v125, vcc_hi, v125
    v_bitop3_b32 v124, v122, v123, v124 bitop3:0x9a
    v_add_lshl_u32 v125, v125, s37, 2
    s_bcnt1_i32_b64 s41, vcc
    s_mov_b64 exec, vcc
    ds_write_b32 v125, v124
    s_mov_b64 exec, -1
    v_cmp_gt_i32 vcc, v121, v3
    s_add_u32 s37, s37, s41
    s_min_u32 s37, s37, s48
    s_cbranch_vccnz L2_xe98
L2_xr98:
    v_and_b32_dpp v118, v82, v6 quad_perm:[0,0,0,0] row_mask:0xf bank_mask:0xf
    v_and_b32_dpp v119, v82, v6 quad_perm:[2,2,2,2] row_mask:0xf bank_mask:0xf
    v_and_b32 v120, -4, v118
    v_add_u32 v120, v120, v2
    v_add_u32 v126, 0xa90000, v4
L2_x99:
    v_sub_u32 v121, v119, v120
    v_sub_u32 v123, v118, v120
    v_med3_i32 v122, v121, 0, 4
    v_max_i32 v123, 0, v123
    v_cmp_gt_i32 vcc, v122, v123
    v_mad_u32_u24 v124, v120, 5, v126
    v_bfm_b32 v122, v122, 28
    v_bfm_b32 v123, v123, 28
    v_mbcnt_lo_u32_b32 v125, vcc_lo, 0
    v_mbcnt_hi_u32_b32 v125, vcc_hi, v125
    v_bitop3_b32 v124, v122, v123, v124 bitop3:0x9a
    v_add_lshl_u32 v125, v125, s37, 2
    s_bcnt1_i32_b64 s41, vcc
    s_mov_b64 exec, vcc
    ds_write_b32 v125, v124
    s_mov_b64 exec, -1
    v_cmp_gt_i32 vcc, v121, v3
    s_add_u32 s37, s37, s41
    s_min_u32 s37, s37, s48
    s_cbranch_vccnz L2_xe99
L2_xr99:
    s_lshl_b32 s3, s37, 2
    v_add_u32 v125, s3, v1
    v_mov_b32 v124, -1
    ds_write_b32 v125, v124
    s_lshl_b32 s3, s38, 2
    v_add_u32 v125, s3, v1
    ds_read2st64_b32 v[40:41], v125 offset0:0 offset1:1
    ds_read2st64_b32 v[42:43], v125 offset0:2 offset1:3
    s_sub_u32 s41, s37, s38
    s_sub_u32 s3, s41, 192
    s_cmp_gt_u32 s3, 64
    s_cbranch_scc1 L2_xf100
L2_xg100:
    s_waitcnt vmcnt(12)
    ds_write_b128 v7, v[44:47] offset:0
    s_waitcnt vmcnt(9)
    ds_write_b128 v7, v[48:51] offset:1024
    s_add_u32 s42, s42, 1
    s_waitcnt lgkmcnt(0)
    s_barrier
    s_branch L2_loop
L2_done:
    s_nop 1
    s_waitcnt lgkmcnt(1)
    v_cmpx_ne_u64 vcc, v[94:95], v[90:91]
    s_and_b64 s[82:83], vcc, s[80:81]
    s_cbranch_scc1 L2_c101
L2_d101:
    v_mov_b64 v[104:105], v[90:91]
    v_mov_b32 v117, v111
    v_mov_b64 v[106:107], v[94:95]
    s_mov_b64 exec, -1
    s_or_b64 s[80:81], s[80:81], vcc
    s_waitcnt lgkmcnt(0)
    v_cmpx_ne_u64 vcc, v[92:93], v[88:89]
    s_and_b64 s[82:83], vcc, s[80:81]
    s_cbranch_scc1 L2_c102
L2_d102:
    v_mov_b64 v[104:105], v[88:89]
    v_mov_b32 v117, v110
    v_mov_b64 v[106:107], v[92:93]
    s_mov_b64 exec, -1
    s_or_b64 s[80:81], s[80:81], vcc
    s_mov_b64 exec, s[80:81]
    s_nop 1
    v_mfma_f32_4x4x4_16b_bf16 v[124:127], v[14:15], v[104:105], 0
    s_nop 1
    v_mfma_f32_4x4x4_16b_bf16 v[124:127], v[12:13], v[106:107], v[124:127]
    s_nop 4
    v_cvt_pk_bf16_f32 v124, v124, v125
    v_cvt_pk_bf16_f32 v125, v126, v127
    ds_pk_add_bf16 v117, v124
    ds_pk_add_bf16 v117, v125 offset:4
    s_mov_b64 exec, -1
    s_waitcnt lgkmcnt(0)
    s_barrier
    v_add_u32 v122, 0x10000, v0
    s_waitcnt vmcnt(0)
    ds_read_b128 v[44:47], v0 offset:0
    ds_read_b128 v[48:51], v0 offset:16384
    ds_read_b128 v[52:55], v0 offset:32768
    ds_read_b128 v[56:59], v0 offset:49152
    ds_read_b128 v[60:63], v122
    v_add_u32 v119, 16384, v0
    v_add_u32 v120, 32768, v0
    v_add_u32 v121, 49152, v0
    s_waitcnt lgkmcnt(4)
    buffer_store_dwordx4 v[44:47], v0, s[20:23], 0 offen sc1
    s_waitcnt lgkmcnt(3)
    buffer_store_dwordx4 v[48:51], v119, s[20:23], 0 offen sc1
    s_waitcnt lgkmcnt(2)
    buffer_store_dwordx4 v[52:55], v120, s[20:23], 0 offen sc1
    s_waitcnt lgkmcnt(1)
    buffer_store_dwordx4 v[56:59], v121, s[20:23], 0 offen sc1
    s_waitcnt lgkmcnt(0)
    buffer_store_dwordx4 v[60:63], v122, s[20:23], 0 offen sc1
L2_end:
    s_endpgm
L2_slow:
    s_mul_i32 s50, s32, 80
    s_add_u32 s57, s50, 80
    s_min_u32 s57, s57, 1280
    s_and_b32 s3, s42, 3
    s_lshl_b32 s53, s3, 3
    s_add_u32 s53, s53, s39
    s_and_b32 s3, s35, 2
    s_lshl_b32 s3, s3, 1
    s_add_u32 s53, s53, s3
    s_and_b32 s54, s35, 1
    s_lshl_b32 s54, s54, 4
L2_sl_seg:
    s_mul_i32 s56, s50, 173056
    s_add_u32 s3, s56, s53
    s_add_u32 s55, s3, 32
    s_buffer_load_dword s51, s[12:15], s3
    s_buffer_load_dword s52, s[12:15], s55
    s_waitcnt lgkmcnt(0)
    s_lshr_b32 s51, s51, s54
    s_and_b32 s51, s51, 0xffff
    s_lshr_b32 s52, s52, s54
    s_and_b32 s52, s52, 0xffff
L2_sl_rec:
    s_cmp_ge_u32 s51, s52
    s_cbranch_scc1 L2_sl_next
    v_lshrrev_b32 v118, 2, v1
    v_add_u32 v118, s51, v118
    v_and_b32 v119, -4, v118
    v_lshl_add_u32 v120, v118, 2, v119
    v_lshl_add_u32 v121, v119, 2, v118
    v_cmp_gt_u32 vcc, s52, v118
    s_mov_b64 exec, vcc
    buffer_load_dword v122, v120, s[8:11], s56 offen
    buffer_load_ubyte v123, v121, s[8:11], s56 offen offset:16
    s_waitcnt vmcnt(0)
    v_lshrrev_b32 v116, 14, v122
    v_and_b32 v116, v8, v116
    ds_read_b64 v[84:85], v116 offset:63616
    v_perm_b32 v112, v122, v123, s44
    v_and_b32 v124, v8, v122
    v_bitop3_b32 v119, v122, 0.5, -0.5 bitop3:0xa8
    v_bitop3_b32 v112, v9, v112, v119 bitop3:0xca
    s_waitcnt lgkmcnt(0)
    v_mfma_f32_4x4x4_16b_bf16 v[96:99], v[10:11], v[84:85], 0
    s_nop 4
    v_mul_f32 v96, v112, v96
    v_mul_f32 v97, v112, v97
    v_mul_f32 v98, v112, v98
    v_mul_f32 v99, v112, v99
    v_cvt_pk_bf16_f32 v96, v96, v97
    v_cvt_pk_bf16_f32 v97, v98, v99
    ds_pk_add_bf16 v124, v96
    ds_pk_add_bf16 v124, v97 offset:4
    s_mov_b64 exec, -1
    s_add_u32 s51, s51, 64
    s_branch L2_sl_rec
L2_sl_next:
    s_add_u32 s50, s50, 1
    s_cmp_lt_u32 s50, s57
    s_cbranch_scc1 L2_sl_seg
    s_waitcnt lgkmcnt(0)
    s_and_b32 s3, s42, 3
    s_cmp_eq_u32 s3, 0
    s_cbranch_scc1 L2_ret0
    s_cmp_eq_u32 s3, 1
    s_cbranch_scc1 L2_ret1
    s_cmp_eq_u32 s3, 2
    s_cbranch_scc1 L2_ret2
    s_branch L2_ret3
L2_xe1:
    s_cmp_ge_u32 s37, s48
    s_cbranch_scc1 L2_xr1
    v_add_u32 v120, 16, v120
    s_branch L2_x1
L2_xe2:
    s_cmp_ge_u32 s37, s48
    s_cbranch_scc1 L2_xr2
    v_add_u32 v120, 16, v120
    s_branch L2_x2
L2_xe3:
    s_cmp_ge_u32 s37, s48
    s_cbranch_scc1 L2_xr3
    v_add_u32 v120, 16, v120
    s_branch L2_x3
L2_xe4:
    s_cmp_ge_u32 s37, s48
    s_cbranch_scc1 L2_xr4
    v_add_u32 v120, 16, v120
    s_branch L2_x4
L2_xe5:
    s_cmp_ge_u32 s37, s48
    s_cbranch_scc1 L2_xr5
    v_add_u32 v120, 16, v120
    s_branch L2_x5
L2_xf6:
    s_cmp_le_u32 s41, 256
    s_cbranch_scc1 L2_xh6
    s_add_u32 s3, s42, 0
    s_bitset1_b32 s36, s3
    s_mov_b32 s41, 0
L2_xh6:
    s_lshl_b32 s41, s41, 2
    s_waitcnt lgkmcnt(0)
    v_add_u32 v125, 0, v1
    v_cmp_gt_u32 vcc, s41, v125
    s_nop 1
    v_cndmask_b32 v40, -1, v40, vcc
    v_add_u32 v125, 256, v1
    v_cmp_gt_u32 vcc, s41, v125
    s_nop 1
    v_cndmask_b32 v41, -1, v41, vcc
    v_add_u32 v125, 512, v1
    v_cmp_gt_u32 vcc, s41, v125
    s_nop 1
    v_cndmask_b32 v42, -1, v42, vcc
    v_add_u32 v125, 768, v1
    v_cmp_gt_u32 vcc, s41, v125
    s_nop 1
    v_cndmask_b32 v43, -1, v43, vcc
    s_branch L2_xg6
L2_xe7:
    s_cmp_ge_u32 s37, s48
    s_cbranch_scc1 L2_xr7
    v_add_u32 v120, 16, v120
    s_branch L2_x7
L2_xe8:
    s_cmp_ge_u32 s37, s48
    s_cbranch_scc1 L2_xr8
    v_add_u32 v120, 16, v120
    s_branch L2_x8
L2_xe9:
    s_cmp_ge_u32 s37, s48
    s_cbranch_scc1 L2_xr9
    v_add_u32 v120, 16, v120
    s_branch L2_x9
L2_xe10:
    s_cmp_ge_u32 s37, s48
    s_cbranch_scc1 L2_xr10
    v_add_u32 v120, 16, v120
    s_branch L2_x10
L2_xe11:
    s_cmp_ge_u32 s37, s48
    s_cbranch_scc1 L2_xr11
    v_add_u32 v120, 16, v120
    s_branch L2_x11
L2_xf12:
    s_cmp_le_u32 s41, 256
    s_cbranch_scc1 L2_xh12
    s_add_u32 s3, s42, 1
    s_bitset1_b32 s36, s3
    s_mov_b32 s41, 0
L2_xh12:
    s_lshl_b32 s41, s41, 2
    s_waitcnt lgkmcnt(0)
    v_add_u32 v125, 0, v1
    v_cmp_gt_u32 vcc, s41, v125
    s_nop 1
    v_cndmask_b32 v40, -1, v40, vcc
    v_add_u32 v125, 256, v1
    v_cmp_gt_u32 vcc, s41, v125
    s_nop 1
    v_cndmask_b32 v41, -1, v41, vcc
    v_add_u32 v125, 512, v1
    v_cmp_gt_u32 vcc, s41, v125
    s_nop 1
    v_cndmask_b32 v42, -1, v42, vcc
    v_add_u32 v125, 768, v1
    v_cmp_gt_u32 vcc, s41, v125
    s_nop 1
    v_cndmask_b32 v43, -1, v43, vcc
    s_branch L2_xg12
L2_c13:
    s_mov_b64 exec, s[82:83]
    s_nop 1
    v_mfma_f32_4x4x4_16b_bf16 v[124:127], v[14:15], v[104:105], 0
    s_nop 1
    v_mfma_f32_4x4x4_16b_bf16 v[124:127], v[12:13], v[106:107], v[124:127]
    s_nop 4
    v_cvt_pk_bf16_f32 v124, v124, v125
    v_cvt_pk_bf16_f32 v125, v126, v127
    ds_pk_add_bf16 v117, v124
    ds_pk_add_bf16 v117, v125 offset:4
    s_mov_b64 exec, vcc
    s_branch L2_d13
L2_c14:
    s_mov_b64 exec, s[82:83]
    s_nop 1
    v_mfma_f32_4x4x4_16b_bf16 v[124:127], v[14:15], v[104:105], 0
    s_nop 1
    v_mfma_f32_4x4x4_16b_bf16 v[124:127], v[12:13], v[106:107], v[124:127]
    s_nop 4
    v_cvt_pk_bf16_f32 v124, v124, v125
    v_cvt_pk_bf16_f32 v125, v126, v127
    ds_pk_add_bf16 v117, v124
    ds_pk_add_bf16 v117, v125 offset:4
    s_mov_b64 exec, vcc
    s_branch L2_d14
L2_c15:
    s_mov_b64 exec, s[82:83]
    s_nop 1
    v_mfma_f32_4x4x4_16b_bf16 v[124:127], v[14:15], v[104:105], 0
    s_nop 1
    v_mfma_f32_4x4x4_16b_bf16 v[124:127], v[12:13], v[106:107], v[124:127]
    s_nop 4
    v_cvt_pk_bf16_f32 v124, v124, v125
    v_cvt_pk_bf16_f32 v125, v126, v127
    ds_pk_add_bf16 v117, v124
    ds_pk_add_bf16 v117, v125 offset:4
    s_mov_b64 exec, vcc
    s_branch L2_d15
L2_c16:
    s_mov_b64 exec, s[82:83]
    s_nop 1
    v_mfma_f32_4x4x4_16b_bf16 v[124:127], v[14:15], v[104:105], 0
    s_nop 1
    v_mfma_f32_4x4x4_16b_bf16 v[124:127], v[12:13], v[106:107], v[124:127]
    s_nop 4
    v_cvt_pk_bf16_f32 v124, v124, v125
    v_cvt_pk_bf16_f32 v125, v126, v127
    ds_pk_add_bf16 v117, v124
    ds_pk_add_bf16 v117, v125 offset:4
    s_mov_b64 exec, vcc
    s_branch L2_d16
L2_c17:
    s_mov_b64 exec, s[82:83]
    s_nop 1
    v_mfma_f32_4x4x4_16b_bf16 v[124:127], v[14:15], v[104:105], 0
    s_nop 1
    v_mfma_f32_4x4x4_16b_bf16 v[124:127], v[12:13], v[106:107], v[124:127]
    s_nop 4
    v_cvt_pk_bf16_f32 v124, v124, v125
    v_cvt_pk_bf16_f32 v125, v126, v127
    ds_pk_add_bf16 v117, v124
    ds_pk_add_bf16 v117, v125 offset:4
    s_mov_b64 exec, vcc
    s_branch L2_d17
L2_c18:
    s_mov_b64 exec, s[82:83]
    s_nop 1
    v_mfma_f32_4x4x4_16b_bf16 v[124:127], v[14:15], v[104:105], 0
    s_nop 1
    v_mfma_f32_4x4x4_16b_bf16 v[124:127], v[12:13], v[106:107], v[124:127]
    s_nop 4
    v_cvt_pk_bf16_f32 v124, v124, v125
    v_cvt_pk_bf16_f32 v125, v126, v127
    ds_pk_add_bf16 v117, v124
    ds_pk_add_bf16 v117, v125 offset:4
    s_mov_b64 exec, vcc
    s_branch L2_d18
L2_c19:
    s_mov_b64 exec, s[82:83]
    s_nop 1
    v_mfma_f32_4x4x4_16b_bf16 v[124:127], v[14:15], v[104:105], 0
    s_nop 1
    v_mfma_f32_4x4x4_16b_bf16 v[124:127], v[12:13], v[106:107], v[124:127]
    s_nop 4
    v_cvt_pk_bf16_f32 v124, v124, v125
    v_cvt_pk_bf16_f32 v125, v126, v127
    ds_pk_add_bf16 v117, v124
    ds_pk_add_bf16 v117, v125 offset:4
    s_mov_b64 exec, vcc
    s_branch L2_d19
L2_c20:
    s_mov_b64 exec, s[82:83]
    s_nop 1
    v_mfma_f32_4x4x4_16b_bf16 v[124:127], v[14:15], v[104:105], 0
    s_nop 1
    v_mfma_f32_4x4x4_16b_bf16 v[124:127], v[12:13], v[106:107], v[124:127]
    s_nop 4
    v_cvt_pk_bf16_f32 v124, v124, v125
    v_cvt_pk_bf16_f32 v125, v126, v127
    ds_pk_add_bf16 v117, v124
    ds_pk_add_bf16 v117, v125 offset:4
    s_mov_b64 exec, vcc
    s_branch L2_d20
L2_c21:
    s_mov_b64 exec, s[82:83]
    s_nop 1
    v_mfma_f32_4x4x4_16b_bf16 v[124:127], v[14:15], v[104:105], 0
    s_nop 1
    v_mfma_f32_4x4x4_16b_bf16 v[124:127], v[12:13], v[106:107], v[124:127]
    s_nop 4
    v_cvt_pk_bf16_f32 v124, v124, v125
    v_cvt_pk_bf16_f32 v125, v126, v127
    ds_pk_add_bf16 v117, v124
    ds_pk_add_bf16 v117, v125 offset:4
    s_mov_b64 exec, vcc
    s_branch L2_d21
L2_c22:
    s_mov_b64 exec, s[82:83]
    s_nop 1
    v_mfma_f32_4x4x4_16b_bf16 v[124:127], v[14:15], v[104:105], 0
    s_nop 1
    v_mfma_f32_4x4x4_16b_bf16 v[124:127], v[12:13], v[106:107], v[124:127]
    s_nop 4
    v_cvt_pk_bf16_f32 v124, v124, v125
    v_cvt_pk_bf16_f32 v125, v126, v127
    ds_pk_add_bf16 v117, v124
    ds_pk_add_bf16 v117, v125 offset:4
    s_mov_b64 exec, vcc
    s_branch L2_d22
L2_c23:
    s_mov_b64 exec, s[82:83]
    s_nop 1
    v_mfma_f32_4x4x4_16b_bf16 v[124:127], v[14:15], v[104:105], 0
    s_nop 1
    v_mfma_f32_4x4x4_16b_bf16 v[124:127], v[12:13], v[106:107], v[124:127]
    s_nop 4
    v_cvt_pk_bf16_f32 v124, v124, v125
    v_cvt_pk_bf16_f32 v125, v126, v127
    ds_pk_add_bf16 v117, v124
    ds_pk_add_bf16 v117, v125 offset:4
    s_mov_b64 exec, vcc
    s_branch L2_d23
L2_c24:
    s_mov_b64 exec, s[82:83]
    s_nop 1
    v_mfma_f32_4x4x4_16b_bf16 v[124:127], v[14:15], v[104:105], 0
    s_nop 1
    v_mfma_f32_4x4x4_16b_bf16 v[124:127], v[12:13], v[106:107], v[124:127]
    s_nop 4
    v_cvt_pk_bf16_f32 v124, v124, v125
    v_cvt_pk_bf16_f32 v125, v126, v127
    ds_pk_add_bf16 v117, v124
    ds_pk_add_bf16 v117, v125 offset:4
    s_mov_b64 exec, vcc
    s_branch L2_d24
L2_c25:
    s_mov_b64 exec, s[82:83]
    s_nop 1
    v_mfma_f32_4x4x4_16b_bf16 v[124:127], v[14:15], v[104:105], 0
    s_nop 1
    v_mfma_f32_4x4x4_16b_bf16 v[124:127], v[12:13], v[106:107], v[124:127]
    s_nop 4
    v_cvt_pk_bf16_f32 v124, v124, v125
    v_cvt_pk_bf16_f32 v125, v126, v127
    ds_pk_add_bf16 v117, v124
    ds_pk_add_bf16 v117, v125 offset:4
    s_mov_b64 exec, vcc
    s_branch L2_d25
L2_c26:
    s_mov_b64 exec, s[82:83]
    s_nop 1
    v_mfma_f32_4x4x4_16b_bf16 v[124:127], v[14:15], v[104:105], 0
    s_nop 1
    v_mfma_f32_4x4x4_16b_bf16 v[124:127], v[12:13], v[106:107], v[124:127]
    s_nop 4
    v_cvt_pk_bf16_f32 v124, v124, v125
    v_cvt_pk_bf16_f32 v125, v126, v127
    ds_pk_add_bf16 v117, v124
    ds_pk_add_bf16 v117, v125 offset:4
    s_mov_b64 exec, vcc
    s_branch L2_d26
L2_c27:
    s_mov_b64 exec, s[82:83]
    s_nop 1
    v_mfma_f32_4x4x4_16b_bf16 v[124:127], v[14:15], v[104:105], 0
    s_nop 1
    v_mfma_f32_4x4x4_16b_bf16 v[124:127], v[12:13], v[106:107], v[124:127]
    s_nop 4
    v_cvt_pk_bf16_f32 v124, v124, v125
    v_cvt_pk_bf16_f32 v125, v126, v127
    ds_pk_add_bf16 v117, v124
    ds_pk_add_bf16 v117, v125 offset:4
    s_mov_b64 exec, vcc
    s_branch L2_d27
L2_c28:
    s_mov_b64 exec, s[82:83]
    s_nop 1
    v_mfma_f32_4x4x4_16b_bf16 v[124:127], v[14:15], v[104:105], 0
    s_nop 1
    v_mfma_f32_4x4x4_16b_bf16 v[124:127], v[12:13], v[106:107], v[124:127]
    s_nop 4
    v_cvt_pk_bf16_f32 v124, v124, v125
    v_cvt_pk_bf16_f32 v125, v126, v127
    ds_pk_add_bf16 v117, v124
    ds_pk_add_bf16 v117, v125 offset:4
    s_mov_b64 exec, vcc
    s_branch L2_d28
L2_xe29:
    s_cmp_ge_u32 s37, s48
    s_cbranch_scc1 L2_xr29
    v_add_u32 v120, 16, v120
    s_branch L2_x29
L2_xe30:
    s_cmp_ge_u32 s37, s48
    s_cbranch_scc1 L2_xr30
    v_add_u32 v120, 16, v120
    s_branch L2_x30
L2_xe31:
    s_cmp_ge_u32 s37, s48
    s_cbranch_scc1 L2_xr31
    v_add_u32 v120, 16, v120
    s_branch L2_x31
L2_xe32:
    s_cmp_ge_u32 s37, s48
    s_cbranch_scc1 L2_xr32
    v_add_u32 v120, 16, v120
    s_branch L2_x32
L2_xe33:
    s_cmp_ge_u32 s37, s48
    s_cbranch_scc1 L2_xr33
    v_add_u32 v120, 16, v120
    s_branch L2_x33
L2_xf34:
    s_cmp_le_u32 s41, 256
    s_cbranch_scc1 L2_xh34
    s_add_u32 s3, s42, 2
    s_bitset1_b32 s36, s3
    s_mov_b32 s41, 0
L2_xh34:
    s_lshl_b32 s41, s41, 2
    s_waitcnt lgkmcnt(0)
    v_add_u32 v125, 0, v1
    v_cmp_gt_u32 vcc, s41, v125
    s_nop 1
    v_cndmask_b32 v40, -1, v40, vcc
    v_add_u32 v125, 256, v1
    v_cmp_gt_u32 vcc, s41, v125
    s_nop 1
    v_cndmask_b32 v41, -1, v41, vcc
    v_add_u32 v125, 512, v1
    v_cmp_gt_u32 vcc, s41, v125
    s_nop 1
    v_cndmask_b32 v42, -1, v42, vcc
    v_add_u32 v125, 768, v1
    v_cmp_gt_u32 vcc, s41, v125
    s_nop 1
    v_cndmask_b32 v43, -1, v43, vcc
    s_branch L2_xg34
L2_c35:
    s_mov_b64 exec, s[82:83]
    s_nop 1
    v_mfma_f32_4x4x4_16b_bf16 v[124:127], v[14:15], v[104:105], 0
    s_nop 1
    v_mfma_f32_4x4x4_16b_bf16 v[124:127], v[12:13], v[106:107], v[124:127]
    s_nop 4
    v_cvt_pk_bf16_f32 v124, v124, v125
    v_cvt_pk_bf16_f32 v125, v126, v127
    ds_pk_add_bf16 v117, v124
    ds_pk_add_bf16 v117, v125 offset:4
    s_mov_b64 exec, vcc
    s_branch L2_d35
L2_c36:
    s_mov_b64 exec, s[82:83]
    s_nop 1
    v_mfma_f32_4x4x4_16b_bf16 v[124:127], v[14:15], v[104:105], 0
    s_nop 1
    v_mfma_f32_4x4x4_16b_bf16 v[124:127], v[12:13], v[106:107], v[124:127]
    s_nop 4
    v_cvt_pk_bf16_f32 v124, v124, v125
    v_cvt_pk_bf16_f32 v125, v126, v127
    ds_pk_add_bf16 v117, v124
    ds_pk_add_bf16 v117, v125 offset:4
    s_mov_b64 exec, vcc
    s_branch L2_d36
L2_c37:
    s_mov_b64 exec, s[82:83]
    s_nop 1
    v_mfma_f32_4x4x4_16b_bf16 v[124:127], v[14:15], v[104:105], 0
    s_nop 1
    v_mfma_f32_4x4x4_16b_bf16 v[124:127], v[12:13], v[106:107], v[124:127]
    s_nop 4
    v_cvt_pk_bf16_f32 v124, v124, v125
    v_cvt_pk_bf16_f32 v125, v126, v127
    ds_pk_add_bf16 v117, v124
    ds_pk_add_bf16 v117, v125 offset:4
    s_mov_b64 exec, vcc
    s_branch L2_d37
L2_c38:
    s_mov_b64 exec, s[82:83]
    s_nop 1
    v_mfma_f32_4x4x4_16b_bf16 v[124:127], v[14:15], v[104:105], 0
    s_nop 1
    v_mfma_f32_4x4x4_16b_bf16 v[124:127], v[12:13], v[106:107], v[124:127]
    s_nop 4
    v_cvt_pk_bf16_f32 v124, v124, v125
    v_cvt_pk_bf16_f32 v125, v126, v127
    ds_pk_add_bf16 v117, v124
    ds_pk_add_bf16 v117, v125 offset:4
    s_mov_b64 exec, vcc
    s_branch L2_d38
L2_c39:
    s_mov_b64 exec, s[82:83]
    s_nop 1
    v_mfma_f32_4x4x4_16b_bf16 v[124:127], v[14:15], v[104:105], 0
    s_nop 1
    v_mfma_f32_4x4x4_16b_bf16 v[124:127], v[12:13], v[106:107], v[124:127]
    s_nop 4
    v_cvt_pk_bf16_f32 v124, v124, v125
    v_cvt_pk_bf16_f32 v125, v126, v127
    ds_pk_add_bf16 v117, v124
    ds_pk_add_bf16 v117, v125 offset:4
    s_mov_b64 exec, vcc
    s_branch L2_d39
L2_c40:
    s_mov_b64 exec, s[82:83]
    s_nop 1
    v_mfma_f32_4x4x4_16b_bf16 v[124:127], v[14:15], v[104:105], 0
    s_nop 1
    v_mfma_f32_4x4x4_16b_bf16 v[124:127], v[12:13], v[106:107], v[124:127]
    s_nop 4
    v_cvt_pk_bf16_f32 v124, v124, v125
    v_cvt_pk_bf16_f32 v125, v126, v127
    ds_pk_add_bf16 v117, v124
    ds_pk_add_bf16 v117, v125 offset:4
    s_mov_b64 exec, vcc
    s_branch L2_d40
L2_c41:
    s_mov_b64 exec, s[82:83]
    s_nop 1
    v_mfma_f32_4x4x4_16b_bf16 v[124:127], v[14:15], v[104:105], 0
    s_nop 1
    v_mfma_f32_4x4x4_16b_bf16 v[124:127], v[12:13], v[106:107], v[124:127]
    s_nop 4
    v_cvt_pk_bf16_f32 v124, v124, v125
    v_cvt_pk_bf16_f32 v125, v126, v127
    ds_pk_add_bf16 v117, v124
    ds_pk_add_bf16 v117, v125 offset:4
    s_mov_b64 exec, vcc
    s_branch L2_d41
L2_c42:
    s_mov_b64 exec, s[82:83]
    s_nop 1
    v_mfma_f32_4x4x4_16b_bf16 v[124:127], v[14:15], v[104:105], 0
    s_nop 1
    v_mfma_f32_4x4x4_16b_bf16 v[124:127], v[12:13], v[106:107], v[124:127]
    s_nop 4
    v_cvt_pk_bf16_f32 v124, v124, v125
    v_cvt_pk_bf16_f32 v125, v126, v127
    ds_pk_add_bf16 v117, v124
    ds_pk_add_bf16 v117, v125 offset:4
    s_mov_b64 exec, vcc
    s_branch L2_d42
L2_c43:
    s_mov_b64 exec, s[82:83]
    s_nop 1
    v_mfma_f32_4x4x4_16b_bf16 v[124:127], v[14:15], v[104:105], 0
    s_nop 1
    v_mfma_f32_4x4x4_16b_bf16 v[124:127], v[12:13], v[106:107], v[124:127]
    s_nop 4
    v_cvt_pk_bf16_f32 v124, v124, v125
    v_cvt_pk_bf16_f32 v125, v126, v127
    ds_pk_add_bf16 v117, v124
    ds_pk_add_bf16 v117, v125 offset:4
    s_mov_b64 exec, vcc
    s_branch L2_d43
L2_c44:
    s_mov_b64 exec, s[82:83]
    s_nop 1
    v_mfma_f32_4x4x4_16b_bf16 v[124:127], v[14:15], v[104:105], 0
    s_nop 1
    v_mfma_f32_4x4x4_16b_bf16 v[124:127], v[12:13], v[106:107], v[124:127]
    s_nop 4
    v_cvt_pk_bf16_f32 v124, v124, v125
    v_cvt_pk_bf16_f32 v125, v126, v127
    ds_pk_add_bf16 v117, v124
    ds_pk_add_bf16 v117, v125 offset:4
    s_mov_b64 exec, vcc
    s_branch L2_d44
L2_c45:
    s_mov_b64 exec, s[82:83]
    s_nop 1
    v_mfma_f32_4x4x4_16b_bf16 v[124:127], v[14:15], v[104:105], 0
    s_nop 1
    v_mfma_f32_4x4x4_16b_bf16 v[124:127], v[12:13], v[106:107], v[124:127]
    s_nop 4
    v_cvt_pk_bf16_f32 v124, v124, v125
    v_cvt_pk_bf16_f32 v125, v126, v127
    ds_pk_add_bf16 v117, v124
    ds_pk_add_bf16 v117, v125 offset:4
    s_mov_b64 exec, vcc
    s_branch L2_d45
L2_c46:
    s_mov_b64 exec, s[82:83]
    s_nop 1
    v_mfma_f32_4x4x4_16b_bf16 v[124:127], v[14:15], v[104:105], 0
    s_nop 1
    v_mfma_f32_4x4x4_16b_bf16 v[124:127], v[12:13], v[106:107], v[124:127]
    s_nop 4
    v_cvt_pk_bf16_f32 v124, v124, v125
    v_cvt_pk_bf16_f32 v125, v126, v127
    ds_pk_add_bf16 v117, v124
    ds_pk_add_bf16 v117, v125 offset:4
    s_mov_b64 exec, vcc
    s_branch L2_d46
L2_c47:
    s_mov_b64 exec, s[82:83]
    s_nop 1
    v_mfma_f32_4x4x4_16b_bf16 v[124:127], v[14:15], v[104:105], 0
    s_nop 1
    v_mfma_f32_4x4x4_16b_bf16 v[124:127], v[12:13], v[106:107], v[124:127]
    s_nop 4
    v_cvt_pk_bf16_f32 v124, v124, v125
    v_cvt_pk_bf16_f32 v125, v126, v127
    ds_pk_add_bf16 v117, v124
    ds_pk_add_bf16 v117, v125 offset:4
    s_mov_b64 exec, vcc
    s_branch L2_d47
L2_c48:
    s_mov_b64 exec, s[82:83]
    s_nop 1
    v_mfma_f32_4x4x4_16b_bf16 v[124:127], v[14:15], v[104:105], 0
    s_nop 1
    v_mfma_f32_4x4x4_16b_bf16 v[124:127], v[12:13], v[106:107], v[124:127]
    s_nop 4
    v_cvt_pk_bf16_f32 v124, v124, v125
    v_cvt_pk_bf16_f32 v125, v126, v127
    ds_pk_add_bf16 v117, v124
    ds_pk_add_bf16 v117, v125 offset:4
    s_mov_b64 exec, vcc
    s_branch L2_d48
L2_c49:
    s_mov_b64 exec, s[82:83]
    s_nop 1
    v_mfma_f32_4x4x4_16b_bf16 v[124:127], v[14:15], v[104:105], 0
    s_nop 1
    v_mfma_f32_4x4x4_16b_bf16 v[124:127], v[12:13], v[106:107], v[124:127]
    s_nop 4
    v_cvt_pk_bf16_f32 v124, v124, v125
    v_cvt_pk_bf16_f32 v125, v126, v127
    ds_pk_add_bf16 v117, v124
    ds_pk_add_bf16 v117, v125 offset:4
    s_mov_b64 exec, vcc
    s_branch L2_d49
L2_c50:
    s_mov_b64 exec, s[82:83]
    s_nop 1
    v_mfma_f32_4x4x4_16b_bf16 v[124:127], v[14:15], v[104:105], 0
    s_nop 1
    v_mfma_f32_4x4x4_16b_bf16 v[124:127], v[12:13], v[106:107], v[124:127]
    s_nop 4
    v_cvt_pk_bf16_f32 v124, v124, v125
    v_cvt_pk_bf16_f32 v125, v126, v127
    ds_pk_add_bf16 v117, v124
    ds_pk_add_bf16 v117, v125 offset:4
    s_mov_b64 exec, vcc
    s_branch L2_d50
L2_xe51:
    s_cmp_ge_u32 s37, s48
    s_cbranch_scc1 L2_xr51
    v_add_u32 v120, 16, v120
    s_branch L2_x51
L2_xe52:
    s_cmp_ge_u32 s37, s48
    s_cbranch_scc1 L2_xr52
    v_add_u32 v120, 16, v120
    s_branch L2_x52
L2_xe53:
    s_cmp_ge_u32 s37, s48
    s_cbranch_scc1 L2_xr53
    v_add_u32 v120, 16, v120
    s_branch L2_x53
L2_xe54:
    s_cmp_ge_u32 s37, s48
    s_cbranch_scc1 L2_xr54
    v_add_u32 v120, 16, v120
    s_branch L2_x54
L2_xe55:
    s_cmp_ge_u32 s37, s48
    s_cbranch_scc1 L2_xr55
    v_add_u32 v120, 16, v120
    s_branch L2_x55
L2_xf56:
    s_cmp_le_u32 s41, 256
    s_cbranch_scc1 L2_xh56
    s_add_u32 s3, s42, 2
    s_bitset1_b32 s36, s3
    s_mov_b32 s41, 0
L2_xh56:
    s_lshl_b32 s41, s41, 2
    s_waitcnt lgkmcnt(0)
    v_add_u32 v125, 0, v1
    v_cmp_gt_u32 vcc, s41, v125
    s_nop 1
    v_cndmask_b32 v40, -1, v40, vcc
    v_add_u32 v125, 256, v1
    v_cmp_gt_u32 vcc, s41, v125
    s_nop 1
    v_cndmask_b32 v41, -1, v41, vcc
    v_add_u32 v125, 512, v1
    v_cmp_gt_u32 vcc, s41, v125
    s_nop 1
    v_cndmask_b32 v42, -1, v42, vcc
    v_add_u32 v125, 768, v1
    v_cmp_gt_u32 vcc, s41, v125
    s_nop 1
    v_cndmask_b32 v43, -1, v43, vcc
    s_branch L2_xg56
L2_c57:
    s_mov_b64 exec, s[82:83]
    s_nop 1
    v_mfma_f32_4x4x4_16b_bf16 v[124:127], v[14:15], v[104:105], 0
    s_nop 1
    v_mfma_f32_4x4x4_16b_bf16 v[124:127], v[12:13], v[106:107], v[124:127]
    s_nop 4
    v_cvt_pk_bf16_f32 v124, v124, v125
    v_cvt_pk_bf16_f32 v125, v126, v127
    ds_pk_add_bf16 v117, v124
    ds_pk_add_bf16 v117, v125 offset:4
    s_mov_b64 exec, vcc
    s_branch L2_d57
L2_c58:
    s_mov_b64 exec, s[82:83]
    s_nop 1
    v_mfma_f32_4x4x4_16b_bf16 v[124:127], v[14:15], v[104:105], 0
    s_nop 1
    v_mfma_f32_4x4x4_16b_bf16 v[124:127], v[12:13], v[106:107], v[124:127]
    s_nop 4
    v_cvt_pk_bf16_f32 v124, v124, v125
    v_cvt_pk_bf16_f32 v125, v126, v127
    ds_pk_add_bf16 v117, v124
    ds_pk_add_bf16 v117, v125 offset:4
    s_mov_b64 exec, vcc
    s_branch L2_d58
L2_c59:
    s_mov_b64 exec, s[82:83]
    s_nop 1
    v_mfma_f32_4x4x4_16b_bf16 v[124:127], v[14:15], v[104:105], 0
    s_nop 1
    v_mfma_f32_4x4x4_16b_bf16 v[124:127], v[12:13], v[106:107], v[124:127]
    s_nop 4
    v_cvt_pk_bf16_f32 v124, v124, v125
    v_cvt_pk_bf16_f32 v125, v126, v127
    ds_pk_add_bf16 v117, v124
    ds_pk_add_bf16 v117, v125 offset:4
    s_mov_b64 exec, vcc
    s_branch L2_d59
L2_c60:
    s_mov_b64 exec, s[82:83]
    s_nop 1
    v_mfma_f32_4x4x4_16b_bf16 v[124:127], v[14:15], v[104:105], 0
    s_nop 1
    v_mfma_f32_4x4x4_16b_bf16 v[124:127], v[12:13], v[106:107], v[124:127]
    s_nop 4
    v_cvt_pk_bf16_f32 v124, v124, v125
    v_cvt_pk_bf16_f32 v125, v126, v127
    ds_pk_add_bf16 v117, v124
    ds_pk_add_bf16 v117, v125 offset:4
    s_mov_b64 exec, vcc
    s_branch L2_d60
L2_c61:
    s_mov_b64 exec, s[82:83]
    s_nop 1
    v_mfma_f32_4x4x4_16b_bf16 v[124:127], v[14:15], v[104:105], 0
    s_nop 1
    v_mfma_f32_4x4x4_16b_bf16 v[124:127], v[12:13], v[106:107], v[124:127]
    s_nop 4
    v_cvt_pk_bf16_f32 v124, v124, v125
    v_cvt_pk_bf16_f32 v125, v126, v127
    ds_pk_add_bf16 v117, v124
    ds_pk_add_bf16 v117, v125 offset:4
    s_mov_b64 exec, vcc
    s_branch L2_d61
L2_c62:
    s_mov_b64 exec, s[82:83]
    s_nop 1
    v_mfma_f32_4x4x4_16b_bf16 v[124:127], v[14:15], v[104:105], 0
    s_nop 1
    v_mfma_f32_4x4x4_16b_bf16 v[124:127], v[12:13], v[106:107], v[124:127]
    s_nop 4
    v_cvt_pk_bf16_f32 v124, v124, v125
    v_cvt_pk_bf16_f32 v125, v126, v127
    ds_pk_add_bf16 v117, v124
    ds_pk_add_bf16 v117, v125 offset:4
    s_mov_b64 exec, vcc
    s_branch L2_d62
L2_c63:
    s_mov_b64 exec, s[82:83]
    s_nop 1
    v_mfma_f32_4x4x4_16b_bf16 v[124:127], v[14:15], v[104:105], 0
    s_nop 1
    v_mfma_f32_4x4x4_16b_bf16 v[124:127], v[12:13], v[106:107], v[124:127]
    s_nop 4
    v_cvt_pk_bf16_f32 v124, v124, v125
    v_cvt_pk_bf16_f32 v125, v126, v127
    ds_pk_add_bf16 v117, v124
    ds_pk_add_bf16 v117, v125 offset:4
    s_mov_b64 exec, vcc
    s_branch L2_d63
L2_c64:
    s_mov_b64 exec, s[82:83]
    s_nop 1
    v_mfma_f32_4x4x4_16b_bf16 v[124:127], v[14:15], v[104:105], 0
    s_nop 1
    v_mfma_f32_4x4x4_16b_bf16 v[124:127], v[12:13], v[106:107], v[124:127]
    s_nop 4
    v_cvt_pk_bf16_f32 v124, v124, v125
    v_cvt_pk_bf16_f32 v125, v126, v127
    ds_pk_add_bf16 v117, v124
    ds_pk_add_bf16 v117, v125 offset:4
    s_mov_b64 exec, vcc
    s_branch L2_d64
L2_c65:
    s_mov_b64 exec, s[82:83]
    s_nop 1
    v_mfma_f32_4x4x4_16b_bf16 v[124:127], v[14:15], v[104:105], 0
    s_nop 1
    v_mfma_f32_4x4x4_16b_bf16 v[124:127], v[12:13], v[106:107], v[124:127]
    s_nop 4
    v_cvt_pk_bf16_f32 v124, v124, v125
    v_cvt_pk_bf16_f32 v125, v126, v127
    ds_pk_add_bf16 v117, v124
    ds_pk_add_bf16 v117, v125 offset:4
    s_mov_b64 exec, vcc
    s_branch L2_d65
L2_c66:
    s_mov_b64 exec, s[82:83]
    s_nop 1
    v_mfma_f32_4x4x4_16b_bf16 v[124:127], v[14:15], v[104:105], 0
    s_nop 1
    v_mfma_f32_4x4x4_16b_bf16 v[124:127], v[12:13], v[106:107], v[124:127]
    s_nop 4
    v_cvt_pk_bf16_f32 v124, v124, v125
    v_cvt_pk_bf16_f32 v125, v126, v127
    ds_pk_add_bf16 v117, v124
    ds_pk_add_bf16 v117, v125 offset:4
    s_mov_b64 exec, vcc
    s_branch L2_d66
L2_c67:
    s_mov_b64 exec, s[82:83]
    s_nop 1
    v_mfma_f32_4x4x4_16b_bf16 v[124:127], v[14:15], v[104:105], 0
    s_nop 1
    v_mfma_f32_4x4x4_16b_bf16 v[124:127], v[12:13], v[106:107], v[124:127]
    s_nop 4
    v_cvt_pk_bf16_f32 v124, v124, v125
    v_cvt_pk_bf16_f32 v125, v126, v127
    ds_pk_add_bf16 v117, v124
    ds_pk_add_bf16 v117, v125 offset:4
    s_mov_b64 exec, vcc
    s_branch L2_d67
L2_c68:
    s_mov_b64 exec, s[82:83]
    s_nop 1
    v_mfma_f32_4x4x4_16b_bf16 v[124:127], v[14:15], v[104:105], 0
    s_nop 1
    v_mfma_f32_4x4x4_16b_bf16 v[124:127], v[12:13], v[106:107], v[124:127]
    s_nop 4
    v_cvt_pk_bf16_f32 v124, v124, v125
    v_cvt_pk_bf16_f32 v125, v126, v127
    ds_pk_add_bf16 v117, v124
    ds_pk_add_bf16 v117, v125 offset:4
    s_mov_b64 exec, vcc
    s_branch L2_d68
L2_c69:
    s_mov_b64 exec, s[82:83]
    s_nop 1
    v_mfma_f32_4x4x4_16b_bf16 v[124:127], v[14:15], v[104:105], 0
    s_nop 1
    v_mfma_f32_4x4x4_16b_bf16 v[124:127], v[12:13], v[106:107], v[124:127]
    s_nop 4
    v_cvt_pk_bf16_f32 v124, v124, v125
    v_cvt_pk_bf16_f32 v125, v126, v127
    ds_pk_add_bf16 v117, v124
    ds_pk_add_bf16 v117, v125 offset:4
    s_mov_b64 exec, vcc
    s_branch L2_d69
L2_c70:
    s_mov_b64 exec, s[82:83]
    s_nop 1
    v_mfma_f32_4x4x4_16b_bf16 v[124:127], v[14:15], v[104:105], 0
    s_nop 1
    v_mfma_f32_4x4x4_16b_bf16 v[124:127], v[12:13], v[106:107], v[124:127]
    s_nop 4
    v_cvt_pk_bf16_f32 v124, v124, v125
    v_cvt_pk_bf16_f32 v125, v126, v127
    ds_pk_add_bf16 v117, v124
    ds_pk_add_bf16 v117, v125 offset:4
    s_mov_b64 exec, vcc
    s_branch L2_d70
L2_c71:
    s_mov_b64 exec, s[82:83]
    s_nop 1
    v_mfma_f32_4x4x4_16b_bf16 v[124:127], v[14:15], v[104:105], 0
    s_nop 1
    v_mfma_f32_4x4x4_16b_bf16 v[124:127], v[12:13], v[106:107], v[124:127]
    s_nop 4
    v_cvt_pk_bf16_f32 v124, v124, v125
    v_cvt_pk_bf16_f32 v125, v126, v127
    ds_pk_add_bf16 v117, v124
    ds_pk_add_bf16 v117, v125 offset:4
    s_mov_b64 exec, vcc
    s_branch L2_d71
L2_c72:
    s_mov_b64 exec, s[82:83]
    s_nop 1
    v_mfma_f32_4x4x4_16b_bf16 v[124:127], v[14:15], v[104:105], 0
    s_nop 1
    v_mfma_f32_4x4x4_16b_bf16 v[124:127], v[12:13], v[106:107], v[124:127]
    s_nop 4
    v_cvt_pk_bf16_f32 v124, v124, v125
    v_cvt_pk_bf16_f32 v125, v126, v127
    ds_pk_add_bf16 v117, v124
    ds_pk_add_bf16 v117, v125 offset:4
    s_mov_b64 exec, vcc
    s_branch L2_d72
L2_xe73:
    s_cmp_ge_u32 s37, s48
    s_cbranch_scc1 L2_xr73
    v_add_u32 v120, 16, v120
    s_branch L2_x73
L2_xe74:
    s_cmp_ge_u32 s37, s48
    s_cbranch_scc1 L2_xr74
    v_add_u32 v120, 16, v120
    s_branch L2_x74
L2_xe75:
    s_cmp_ge_u32 s37, s48
    s_cbranch_scc1 L2_xr75
    v_add_u32 v120, 16, v120
    s_branch L2_x75
L2_xe76:
    s_cmp_ge_u32 s37, s48
    s_cbranch_scc1 L2_xr76
    v_add_u32 v120, 16, v120
    s_branch L2_x76
L2_xe77:
    s_cmp_ge_u32 s37, s48
    s_cbranch_scc1 L2_xr77
    v_add_u32 v120, 16, v120
    s_branch L2_x77
L2_xf78:
    s_cmp_le_u32 s41, 256
    s_cbranch_scc1 L2_xh78
    s_add_u32 s3, s42, 2
    s_bitset1_b32 s36, s3
    s_mov_b32 s41, 0
L2_xh78:
    s_lshl_b32 s41, s41, 2
    s_waitcnt lgkmcnt(0)
    v_add_u32 v125, 0, v1
    v_cmp_gt_u32 vcc, s41, v125
    s_nop 1
    v_cndmask_b32 v40, -1, v40, vcc
    v_add_u32 v125, 256, v1
    v_cmp_gt_u32 vcc, s41, v125
    s_nop 1
    v_cndmask_b32 v41, -1, v41, vcc
    v_add_u32 v125, 512, v1
    v_cmp_gt_u32 vcc, s41, v125
    s_nop 1
    v_cndmask_b32 v42, -1, v42, vcc
    v_add_u32 v125, 768, v1
    v_cmp_gt_u32 vcc, s41, v125
    s_nop 1
    v_cndmask_b32 v43, -1, v43, vcc
    s_branch L2_xg78
L2_c79:
    s_mov_b64 exec, s[82:83]
    s_nop 1
    v_mfma_f32_4x4x4_16b_bf16 v[124:127], v[14:15], v[104:105], 0
    s_nop 1
    v_mfma_f32_4x4x4_16b_bf16 v[124:127], v[12:13], v[106:107], v[124:127]
    s_nop 4
    v_cvt_pk_bf16_f32 v124, v124, v125
    v_cvt_pk_bf16_f32 v125, v126, v127
    ds_pk_add_bf16 v117, v124
    ds_pk_add_bf16 v117, v125 offset:4
    s_mov_b64 exec, vcc
    s_branch L2_d79
L2_c80:
    s_mov_b64 exec, s[82:83]
    s_nop 1
    v_mfma_f32_4x4x4_16b_bf16 v[124:127], v[14:15], v[104:105], 0
    s_nop 1
    v_mfma_f32_4x4x4_16b_bf16 v[124:127], v[12:13], v[106:107], v[124:127]
    s_nop 4
    v_cvt_pk_bf16_f32 v124, v124, v125
    v_cvt_pk_bf16_f32 v125, v126, v127
    ds_pk_add_bf16 v117, v124
    ds_pk_add_bf16 v117, v125 offset:4
    s_mov_b64 exec, vcc
    s_branch L2_d80
L2_c81:
    s_mov_b64 exec, s[82:83]
    s_nop 1
    v_mfma_f32_4x4x4_16b_bf16 v[124:127], v[14:15], v[104:105], 0
    s_nop 1
    v_mfma_f32_4x4x4_16b_bf16 v[124:127], v[12:13], v[106:107], v[124:127]
    s_nop 4
    v_cvt_pk_bf16_f32 v124, v124, v125
    v_cvt_pk_bf16_f32 v125, v126, v127
    ds_pk_add_bf16 v117, v124
    ds_pk_add_bf16 v117, v125 offset:4
    s_mov_b64 exec, vcc
    s_branch L2_d81
L2_c82:
    s_mov_b64 exec, s[82:83]
    s_nop 1
    v_mfma_f32_4x4x4_16b_bf16 v[124:127], v[14:15], v[104:105], 0
    s_nop 1
    v_mfma_f32_4x4x4_16b_bf16 v[124:127], v[12:13], v[106:107], v[124:127]
    s_nop 4
    v_cvt_pk_bf16_f32 v124, v124, v125
    v_cvt_pk_bf16_f32 v125, v126, v127
    ds_pk_add_bf16 v117, v124
    ds_pk_add_bf16 v117, v125 offset:4
    s_mov_b64 exec, vcc
    s_branch L2_d82
L2_c83:
    s_mov_b64 exec, s[82:83]
    s_nop 1
    v_mfma_f32_4x4x4_16b_bf16 v[124:127], v[14:15], v[104:105], 0
    s_nop 1
    v_mfma_f32_4x4x4_16b_bf16 v[124:127], v[12:13], v[106:107], v[124:127]
    s_nop 4
    v_cvt_pk_bf16_f32 v124, v124, v125
    v_cvt_pk_bf16_f32 v125, v126, v127
    ds_pk_add_bf16 v117, v124
    ds_pk_add_bf16 v117, v125 offset:4
    s_mov_b64 exec, vcc
    s_branch L2_d83
L2_c84:
    s_mov_b64 exec, s[82:83]
    s_nop 1
    v_mfma_f32_4x4x4_16b_bf16 v[124:127], v[14:15], v[104:105], 0
    s_nop 1
    v_mfma_f32_4x4x4_16b_bf16 v[124:127], v[12:13], v[106:107], v[124:127]
    s_nop 4
    v_cvt_pk_bf16_f32 v124, v124, v125
    v_cvt_pk_bf16_f32 v125, v126, v127
    ds_pk_add_bf16 v117, v124
    ds_pk_add_bf16 v117, v125 offset:4
    s_mov_b64 exec, vcc
    s_branch L2_d84
L2_c85:
    s_mov_b64 exec, s[82:83]
    s_nop 1
    v_mfma_f32_4x4x4_16b_bf16 v[124:127], v[14:15], v[104:105], 0
    s_nop 1
    v_mfma_f32_4x4x4_16b_bf16 v[124:127], v[12:13], v[106:107], v[124:127]
    s_nop 4
    v_cvt_pk_bf16_f32 v124, v124, v125
    v_cvt_pk_bf16_f32 v125, v126, v127
    ds_pk_add_bf16 v117, v124
    ds_pk_add_bf16 v117, v125 offset:4
    s_mov_b64 exec, vcc
    s_branch L2_d85
L2_c86:
    s_mov_b64 exec, s[82:83]
    s_nop 1
    v_mfma_f32_4x4x4_16b_bf16 v[124:127], v[14:15], v[104:105], 0
    s_nop 1
    v_mfma_f32_4x4x4_16b_bf16 v[124:127], v[12:13], v[106:107], v[124:127]
    s_nop 4
    v_cvt_pk_bf16_f32 v124, v124, v125
    v_cvt_pk_bf16_f32 v125, v126, v127
    ds_pk_add_bf16 v117, v124
    ds_pk_add_bf16 v117, v125 offset:4
    s_mov_b64 exec, vcc
    s_branch L2_d86
L2_c87:
    s_mov_b64 exec, s[82:83]
    s_nop 1
    v_mfma_f32_4x4x4_16b_bf16 v[124:127], v[14:15], v[104:105], 0
    s_nop 1
    v_mfma_f32_4x4x4_16b_bf16 v[124:127], v[12:13], v[106:107], v[124:127]
    s_nop 4
    v_cvt_pk_bf16_f32 v124, v124, v125
    v_cvt_pk_bf16_f32 v125, v126, v127
    ds_pk_add_bf16 v117, v124
    ds_pk_add_bf16 v117, v125 offset:4
    s_mov_b64 exec, vcc
    s_branch L2_d87
L2_c88:
    s_mov_b64 exec, s[82:83]
    s_nop 1
    v_mfma_f32_4x4x4_16b_bf16 v[124:127], v[14:15], v[104:105], 0
    s_nop 1
    v_mfma_f32_4x4x4_16b_bf16 v[124:127], v[12:13], v[106:107], v[124:127]
    s_nop 4
    v_cvt_pk_bf16_f32 v124, v124, v125
    v_cvt_pk_bf16_f32 v125, v126, v127
    ds_pk_add_bf16 v117, v124
    ds_pk_add_bf16 v117, v125 offset:4
    s_mov_b64 exec, vcc
    s_branch L2_d88
L2_c89:
    s_mov_b64 exec, s[82:83]
    s_nop 1
    v_mfma_f32_4x4x4_16b_bf16 v[124:127], v[14:15], v[104:105], 0
    s_nop 1
    v_mfma_f32_4x4x4_16b_bf16 v[124:127], v[12:13], v[106:107], v[124:127]
    s_nop 4
    v_cvt_pk_bf16_f32 v124, v124, v125
    v_cvt_pk_bf16_f32 v125, v126, v127
    ds_pk_add_bf16 v117, v124
    ds_pk_add_bf16 v117, v125 offset:4
    s_mov_b64 exec, vcc
    s_branch L2_d89
L2_c90:
    s_mov_b64 exec, s[82:83]
    s_nop 1
    v_mfma_f32_4x4x4_16b_bf16 v[124:127], v[14:15], v[104:105], 0
    s_nop 1
    v_mfma_f32_4x4x4_16b_bf16 v[124:127], v[12:13], v[106:107], v[124:127]
    s_nop 4
    v_cvt_pk_bf16_f32 v124, v124, v125
    v_cvt_pk_bf16_f32 v125, v126, v127
    ds_pk_add_bf16 v117, v124
    ds_pk_add_bf16 v117, v125 offset:4
    s_mov_b64 exec, vcc
    s_branch L2_d90
L2_c91:
    s_mov_b64 exec, s[82:83]
    s_nop 1
    v_mfma_f32_4x4x4_16b_bf16 v[124:127], v[14:15], v[104:105], 0
    s_nop 1
    v_mfma_f32_4x4x4_16b_bf16 v[124:127], v[12:13], v[106:107], v[124:127]
    s_nop 4
    v_cvt_pk_bf16_f32 v124, v124, v125
    v_cvt_pk_bf16_f32 v125, v126, v127
    ds_pk_add_bf16 v117, v124
    ds_pk_add_bf16 v117, v125 offset:4
    s_mov_b64 exec, vcc
    s_branch L2_d91
L2_c92:
    s_mov_b64 exec, s[82:83]
    s_nop 1
    v_mfma_f32_4x4x4_16b_bf16 v[124:127], v[14:15], v[104:105], 0
    s_nop 1
    v_mfma_f32_4x4x4_16b_bf16 v[124:127], v[12:13], v[106:107], v[124:127]
    s_nop 4
    v_cvt_pk_bf16_f32 v124, v124, v125
    v_cvt_pk_bf16_f32 v125, v126, v127
    ds_pk_add_bf16 v117, v124
    ds_pk_add_bf16 v117, v125 offset:4
    s_mov_b64 exec, vcc
    s_branch L2_d92
L2_c93:
    s_mov_b64 exec, s[82:83]
    s_nop 1
    v_mfma_f32_4x4x4_16b_bf16 v[124:127], v[14:15], v[104:105], 0
    s_nop 1
    v_mfma_f32_4x4x4_16b_bf16 v[124:127], v[12:13], v[106:107], v[124:127]
    s_nop 4
    v_cvt_pk_bf16_f32 v124, v124, v125
    v_cvt_pk_bf16_f32 v125, v126, v127
    ds_pk_add_bf16 v117, v124
    ds_pk_add_bf16 v117, v125 offset:4
    s_mov_b64 exec, vcc
    s_branch L2_d93
L2_c94:
    s_mov_b64 exec, s[82:83]
    s_nop 1
    v_mfma_f32_4x4x4_16b_bf16 v[124:127], v[14:15], v[104:105], 0
    s_nop 1
    v_mfma_f32_4x4x4_16b_bf16 v[124:127], v[12:13], v[106:107], v[124:127]
    s_nop 4
    v_cvt_pk_bf16_f32 v124, v124, v125
    v_cvt_pk_bf16_f32 v125, v126, v127
    ds_pk_add_bf16 v117, v124
    ds_pk_add_bf16 v117, v125 offset:4
    s_mov_b64 exec, vcc
    s_branch L2_d94
L2_xe95:
    s_cmp_ge_u32 s37, s48
    s_cbranch_scc1 L2_xr95
    v_add_u32 v120, 16, v120
    s_branch L2_x95
L2_xe96:
    s_cmp_ge_u32 s37, s48
    s_cbranch_scc1 L2_xr96
    v_add_u32 v120, 16, v120
    s_branch L2_x96
L2_xe97:
    s_cmp_ge_u32 s37, s48
    s_cbranch_scc1 L2_xr97
    v_add_u32 v120, 16, v120
    s_branch L2_x97
L2_xe98:
    s_cmp_ge_u32 s37, s48
    s_cbranch_scc1 L2_xr98
    v_add_u32 v120, 16, v120
    s_branch L2_x98
L2_xe99:
    s_cmp_ge_u32 s37, s48
    s_cbranch_scc1 L2_xr99
    v_add_u32 v120, 16, v120
    s_branch L2_x99
L2_xf100:
    s_cmp_le_u32 s41, 256
    s_cbranch_scc1 L2_xh100
    s_add_u32 s3, s42, 2
    s_bitset1_b32 s36, s3
    s_mov_b32 s41, 0
L2_xh100:
    s_lshl_b32 s41, s41, 2
    s_waitcnt lgkmcnt(0)
    v_add_u32 v125, 0, v1
    v_cmp_gt_u32 vcc, s41, v125
    s_nop 1
    v_cndmask_b32 v40, -1, v40, vcc
    v_add_u32 v125, 256, v1
    v_cmp_gt_u32 vcc, s41, v125
    s_nop 1
    v_cndmask_b32 v41, -1, v41, vcc
    v_add_u32 v125, 512, v1
    v_cmp_gt_u32 vcc, s41, v125
    s_nop 1
    v_cndmask_b32 v42, -1, v42, vcc
    v_add_u32 v125, 768, v1
    v_cmp_gt_u32 vcc, s41, v125
    s_nop 1
    v_cndmask_b32 v43, -1, v43, vcc
    s_branch L2_xg100
L2_c101:
    s_mov_b64 exec, s[82:83]
    s_nop 1
    v_mfma_f32_4x4x4_16b_bf16 v[124:127], v[14:15], v[104:105], 0
    s_nop 1
    v_mfma_f32_4x4x4_16b_bf16 v[124:127], v[12:13], v[106:107], v[124:127]
    s_nop 4
    v_cvt_pk_bf16_f32 v124, v124, v125
    v_cvt_pk_bf16_f32 v125, v126, v127
    ds_pk_add_bf16 v117, v124
    ds_pk_add_bf16 v117, v125 offset:4
    s_mov_b64 exec, vcc
    s_branch L2_d101
L2_c102:
    s_mov_b64 exec, s[82:83]
    s_nop 1
    v_mfma_f32_4x4x4_16b_bf16 v[124:127], v[14:15], v[104:105], 0
    s_nop 1
    v_mfma_f32_4x4x4_16b_bf16 v[124:127], v[12:13], v[106:107], v[124:127]
    s_nop 4
    v_cvt_pk_bf16_f32 v124, v124, v125
    v_cvt_pk_bf16_f32 v125, v126, v127
    ds_pk_add_bf16 v117, v124
    ds_pk_add_bf16 v117, v125 offset:4
    s_mov_b64 exec, vcc
    s_branch L2_d102
.text
.globl gs_final_kernel
.p2align 8
.type gs_final_kernel,@function
gs_final_kernel:
    s_cmp_ge_u32 s2, 1250
    s_cbranch_scc1 L3_end
    s_load_dwordx2 s[4:5], s[0:1], 0
    s_load_dwordx2 s[6:7], s[0:1], 24
    s_load_dwordx2 s[28:29], s[0:1], 40
    s_load_dwordx2 s[30:31], s[0:1], 88
    s_load_dwordx2 s[32:33], s[0:1], 104
    s_lshl_b32 s3, s2, 8
    v_add_u32 v1, s3, v0
    v_lshlrev_b32 v2, 4, v1
    v_lshlrev_b32 v3, 2, v1
    v_bfe_u32 v4, v1, 3, 6
    s_mov_b32 s3, 80000
    v_mul_lo_u32 v4, v4, s3
    v_lshrrev_b32 v5, 9, v1
    v_lshl_add_u32 v4, v5, 7, v4
    v_and_b32 v5, 7, v1
    v_lshl_add_u32 v4, v5, 4, v4
    v_and_b32 v5, 3, v0
    v_lshlrev_b32 v5, 6, v5
    s_waitcnt lgkmcnt(0)
    s_load_dwordx4 s[36:39], s[28:29], 0
    s_mov_b32 s8, s4
    s_mov_b32 s9, s5
    s_mov_b32 s10, 0x4e2000
    s_mov_b32 s11, 0x20000
    s_mov_b32 s12, s6
    s_mov_b32 s13, s7
    s_mov_b32 s14, 0x138800
    s_mov_b32 s15, 0x20000
    s_mov_b32 s16, s30
    s_mov_b32 s17, s31
    s_mov_b32 s18, 0x4e2000
    s_mov_b32 s19, 0x20000
    s_add_u32 s20, s32, 0xd823000
    s_addc_u32 s21, s33, 0
    s_mov_b32 s22, 0x1388000
    s_mov_b32 s23, 0x20000
    s_add_u32 s24, s32, 0xebab000
    s_addc_u32 s25, s33, 0
    s_mov_b32 s26, 0x100
    s_mov_b32 s27, 0x20000
    buffer_load_dword v6, v3, s[12:15], 0 offen
    buffer_load_dwordx4 v[8:11], v5, s[24:27], 0 offen
    buffer_load_dwordx4 v[12:15], v5, s[24:27], 0 offen offset:16
    buffer_load_dwordx2 v[16:17], v5, s[24:27], 0 offen offset:32
    s_mov_b32 s40, 0
    buffer_load_dwordx4 v[20:23], v4, s[20:23], s40 offen
    s_mov_b32 s41, 5120000
    buffer_load_dwordx4 v[24:27], v4, s[20:23], s41 offen
    s_mov_b32 s42, 10240000
    buffer_load_dwordx4 v[28:31], v4, s[20:23], s42 offen
    s_mov_b32 s43, 15360000
    buffer_load_dwordx4 v[32:35], v4, s[20:23], s43 offen
    buffer_load_dwordx4 v[36:39], v2, s[8:11], 0 offen
    v_and_b32 v7, 3, v0
    v_lshlrev_b32 v7, 4, v7
    v_mov_b32 v18, 0x3f80
    v_mov_b32 v19, 0
    v_lshlrev_b64 v[18:19], v7, v[18:19]
    s_waitcnt lgkmcnt(0)
    s_lshl_b32 s44, s36, 16
    s_and_b32 s45, s36, 0xffff0000
    s_lshl_b32 s46, s37, 16
    s_and_b32 s47, s37, 0xffff0000
    s_lshl_b32 s48, s38, 16
    s_and_b32 s49, s38, 0xffff0000
    s_lshl_b32 s50, s39, 16
    s_and_b32 s51, s39, 0xffff0000
    s_waitcnt vmcnt(8)
    v_lshlrev_b32 v7, 16, v6
    v_subrev_f32 v48, s44, v7
    v_subrev_f32 v49, s45, v7
    v_subrev_f32 v50, s46, v7
    v_subrev_f32 v51, s47, v7
    v_subrev_f32 v52, s48, v7
    v_subrev_f32 v53, s49, v7
    v_subrev_f32 v54, s50, v7
    v_subrev_f32 v55, s51, v7
    v_cvt_pk_bf16_f32 v56, v48, v49
    v_cvt_pk_bf16_f32 v57, v50, v51
    v_cvt_pk_bf16_f32 v58, v52, v53
    v_cvt_pk_bf16_f32 v59, v54, v55
    v_lshlrev_b32 v48, 16, v56
    v_and_b32 v49, 0xffff0000, v56
    v_lshlrev_b32 v50, 16, v57
    v_and_b32 v51, 0xffff0000, v57
    v_lshlrev_b32 v52, 16, v58
    v_and_b32 v53, 0xffff0000, v58
    v_lshlrev_b32 v54, 16, v59
    v_and_b32 v55, 0xffff0000, v59
    v_mul_f32 v48, v48, v48
    v_mul_f32 v49, v49, v49
    v_mul_f32 v50, v50, v50
    v_mul_f32 v51, v51, v51
    v_mul_f32 v52, v52, v52
    v_mul_f32 v53, v53, v53
    v_mul_f32 v54, v54, v54
    v_mul_f32 v55, v55, v55
    v_cvt_pk_bf16_f32 v56, v48, v49
    v_cvt_pk_bf16_f32 v57, v50, v51
    v_cvt_pk_bf16_f32 v58, v52, v53
    v_cvt_pk_bf16_f32 v59, v54, v55
    v_lshlrev_b32 v48, 16, v56
    v_and_b32 v49, 0xffff0000, v56
    v_lshlrev_b32 v50, 16, v57
    v_and_b32 v51, 0xffff0000, v57
    v_lshlrev_b32 v52, 16, v58
    v_and_b32 v53, 0xffff0000, v58
    v_lshlrev_b32 v54, 16, v59
    v_and_b32 v55, 0xffff0000, v59
    v_mul_f32 v48, 0xc1200000, v48
    v_mul_f32 v49, 0xc1200000, v49
    v_mul_f32 v50, 0xc1200000, v50
    v_mul_f32 v51, 0xc1200000, v51
    v_mul_f32 v52, 0xc1200000, v52
    v_mul_f32 v53, 0xc1200000, v53
    v_mul_f32 v54, 0xc1200000, v54
    v_mul_f32 v55, 0xc1200000, v55
    v_cvt_pk_bf16_f32 v56, v48, v49
    v_cvt_pk_bf16_f32 v57, v50, v51
    v_cvt_pk_bf16_f32 v58, v52, v53
    v_cvt_pk_bf16_f32 v59, v54, v55
    v_lshlrev_b32 v48, 16, v56
    v_and_b32 v49, 0xffff0000, v56
    v_lshlrev_b32 v50, 16, v57
    v_and_b32 v51, 0xffff0000, v57
    v_lshlrev_b32 v52, 16, v58
    v_and_b32 v53, 0xffff0000, v58
    v_lshlrev_b32 v54, 16, v59
    v_and_b32 v55, 0xffff0000, v59
    v_mul_f32 v48, 0x3fb8aa3b, v48
    v_mul_f32 v49, 0x3fb8aa3b, v49
    v_mul_f32 v50, 0x3fb8aa3b, v50
    v_mul_f32 v51, 0x3fb8aa3b, v51
    v_mul_f32 v52, 0x3fb8aa3b, v52
    v_mul_f32 v53, 0x3fb8aa3b, v53
    v_mul_f32 v54, 0x3fb8aa3b, v54
    v_mul_f32 v55, 0x3fb8aa3b, v55
    v_exp_f32 v48, v48
    v_exp_f32 v49, v49
    v_exp_f32 v50, v50
    v_exp_f32 v51, v51
    v_exp_f32 v52, v52
    v_exp_f32 v53, v53
    v_exp_f32 v54, v54
    v_exp_f32 v55, v55
    v_cvt_pk_bf16_f32 v40, v48, v49
    v_cvt_pk_bf16_f32 v41, v50, v51
    v_cvt_pk_bf16_f32 v42, v52, v53
    v_cvt_pk_bf16_f32 v43, v54, v55
    v_and_b32 v7, 0xffff0000, v6
    v_subrev_f32 v48, s44, v7
    v_subrev_f32 v49, s45, v7
    v_subrev_f32 v50, s46, v7
    v_subrev_f32 v51, s47, v7
    v_subrev_f32 v52, s48, v7
    v_subrev_f32 v53, s49, v7
    v_subrev_f32 v54, s50, v7
    v_subrev_f32 v55, s51, v7
    v_cvt_pk_bf16_f32 v56, v48, v49
    v_cvt_pk_bf16_f32 v57, v50, v51
    v_cvt_pk_bf16_f32 v58, v52, v53
    v_cvt_pk_bf16_f32 v59, v54, v55
    v_lshlrev_b32 v48, 16, v56
    v_and_b32 v49, 0xffff0000, v56
    v_lshlrev_b32 v50, 16, v57
    v_and_b32 v51, 0xffff0000, v57
    v_lshlrev_b32 v52, 16, v58
    v_and_b32 v53, 0xffff0000, v58
    v_lshlrev_b32 v54, 16, v59
    v_and_b32 v55, 0xffff0000, v59
    v_mul_f32 v48, v48, v48
    v_mul_f32 v49, v49, v49
    v_mul_f32 v50, v50, v50
    v_mul_f32 v51, v51, v51
    v_mul_f32 v52, v52, v52
    v_mul_f32 v53, v53, v53
    v_mul_f32 v54, v54, v54
    v_mul_f32 v55, v55, v55
    v_cvt_pk_bf16_f32 v56, v48, v49
    v_cvt_pk_bf16_f32 v57, v50, v51
    v_cvt_pk_bf16_f32 v58, v52, v53
    v_cvt_pk_bf16_f32 v59, v54, v55
    v_lshlrev_b32 v48, 16, v56
    v_and_b32 v49, 0xffff0000, v56
    v_lshlrev_b32 v50, 16, v57
    v_and_b32 v51, 0xffff0000, v57
    v_lshlrev_b32 v52, 16, v58
    v_and_b32 v53, 0xffff0000, v58
    v_lshlrev_b32 v54, 16, v59
    v_and_b32 v55, 0xffff0000, v59
    v_mul_f32 v48, 0xc1200000, v48
    v_mul_f32 v49, 0xc1200000, v49
    v_mul_f32 v50, 0xc1200000, v50
    v_mul_f32 v51, 0xc1200000, v51
    v_mul_f32 v52, 0xc1200000, v52
    v_mul_f32 v53, 0xc1200000, v53
    v_mul_f32 v54, 0xc1200000, v54
    v_mul_f32 v55, 0xc1200000, v55
    v_cvt_pk_bf16_f32 v56, v48, v49
    v_cvt_pk_bf16_f32 v57, v50, v51
    v_cvt_pk_bf16_f32 v58, v52, v53
    v_cvt_pk_bf16_f32 v59, v54, v55
    v_lshlrev_b32 v48, 16, v56
    v_and_b32 v49, 0xffff0000, v56
    v_lshlrev_b32 v50, 16, v57
    v_and_b32 v51, 0xffff0000, v57
    v_lshlrev_b32 v52, 16, v58
    v_and_b32 v53, 0xffff0000, v58
    v_lshlrev_b32 v54, 16, v59
    v_and_b32 v55, 0xffff0000, v59
    v_mul_f32 v48, 0x3fb8aa3b, v48
    v_mul_f32 v49, 0x3fb8aa3b, v49
    v_mul_f32 v50, 0x3fb8aa3b, v50
    v_mul_f32 v51, 0x3fb8aa3b, v51
    v_mul_f32 v52, 0x3fb8aa3b, v52
    v_mul_f32 v53, 0x3fb8aa3b, v53
    v_mul_f32 v54, 0x3fb8aa3b, v54
    v_mul_f32 v55, 0x3fb8aa3b, v55
    v_exp_f32 v48, v48
    v_exp_f32 v49, v49
    v_exp_f32 v50, v50
    v_exp_f32 v51, v51
    v_exp_f32 v52, v52
    v_exp_f32 v53, v53
    v_exp_f32 v54, v54
    v_exp_f32 v55, v55
    v_cvt_pk_bf16_f32 v44, v48, v49
    v_cvt_pk_bf16_f32 v45, v50, v51
    v_cvt_pk_bf16_f32 v46, v52, v53
    v_cvt_pk_bf16_f32 v47, v54, v55
    s_waitcnt vmcnt(5)
    v_mfma_f32_4x4x4_16b_bf16 v[48:51], v[8:9], v[40:41], 0
    v_mfma_f32_4x4x4_16b_bf16 v[56:59], v[12:13], v[40:41], 0
    v_mfma_f32_4x4x4_16b_bf16 v[52:55], v[8:9], v[44:45], 0
    v_mfma_f32_4x4x4_16b_bf16 v[60:63], v[12:13], v[44:45], 0
    v_mfma_f32_4x4x4_16b_bf16 v[48:51], v[10:11], v[42:43], v[48:51]
    v_mfma_f32_4x4x4_16b_bf16 v[56:59], v[14:15], v[42:43], v[56:59]
    v_mfma_f32_4x4x4_16b_bf16 v[52:55], v[10:11], v[46:47], v[52:55]
    v_mfma_f32_4x4x4_16b_bf16 v[60:63], v[14:15], v[46:47], v[60:63]
    s_waitcnt vmcnt(1)
    v_mfma_f32_4x4x4_16b_bf16 v[64:67], v[18:19], v[20:21], 0
    v_mfma_f32_4x4x4_16b_bf16 v[68:71], v[18:19], v[22:23], 0
    s_nop 0
    v_mfma_f32_4x4x4_16b_bf16 v[64:67], v[18:19], v[24:25], v[64:67]
    v_mfma_f32_4x4x4_16b_bf16 v[68:71], v[18:19], v[26:27], v[68:71]
    s_nop 0
    v_mfma_f32_4x4x4_16b_bf16 v[64:67], v[18:19], v[28:29], v[64:67]
    v_mfma_f32_4x4x4_16b_bf16 v[68:71], v[18:19], v[30:31], v[68:71]
    s_nop 0
    v_mfma_f32_4x4x4_16b_bf16 v[64:67], v[18:19], v[32:33], v[64:67]
    v_mfma_f32_4x4x4_16b_bf16 v[68:71], v[18:19], v[34:35], v[68:71]
    s_nop 3
    v_mul_f32 v64, v64, v48
    v_mul_f32 v65, v65, v49
    v_mul_f32 v66, v66, v50
    v_mul_f32 v67, v67, v51
    v_cvt_pk_bf16_f32 v20, v64, v65
    v_cvt_pk_bf16_f32 v21, v66, v67
    v_mul_f32 v68, v68, v52
    v_mul_f32 v69, v69, v53
    v_mul_f32 v70, v70, v54
    v_mul_f32 v71, v71, v55
    v_cvt_pk_bf16_f32 v22, v68, v69
    v_cvt_pk_bf16_f32 v23, v70, v71
    v_mfma_f32_4x4x4_16b_bf16 v[48:51], v[16:17], v[20:21], 0
    s_nop 0
    v_mfma_f32_4x4x4_16b_bf16 v[52:55], v[16:17], v[22:23], 0
    s_nop 2
    v_mul_f32 v48, v48, v56
    v_mul_f32 v49, v49, v57
    v_mul_f32 v50, v50, v58
    v_mul_f32 v51, v51, v59
    v_mul_f32 v52, v52, v60
    v_mul_f32 v53, v53, v61
    v_mul_f32 v54, v54, v62
    v_mul_f32 v55, v55, v63
    s_waitcnt vmcnt(0)
    v_mfma_f32_4x4x4_16b_bf16 v[64:67], v[18:19], v[36:37], v[48:51]
    v_mfma_f32_4x4x4_16b_bf16 v[68:71], v[18:19], v[38:39], v[52:55]
    s_nop 3
    v_cvt_pk_bf16_f32 v24, v64, v65
    v_cvt_pk_bf16_f32 v25, v66, v67
    v_cvt_pk_bf16_f32 v26, v68, v69
    v_cvt_pk_bf16_f32 v27, v70, v71
    buffer_store_dwordx4 v[24:27], v2, s[16:19], 0 offen
L3_end:
    s_endpgm
.section .rodata,"a"
.p2align 6
.amdhsa_kernel gs_sort_kernel
  .amdhsa_next_free_vgpr 128
  .amdhsa_next_free_sgpr 96
  .amdhsa_accum_offset 128
  .amdhsa_group_segment_fixed_size 0
  .amdhsa_kernarg_size 112
  .amdhsa_user_sgpr_count 2
  .amdhsa_user_sgpr_kernarg_segment_ptr 1
  .amdhsa_system_sgpr_workgroup_id_x 1
  .amdhsa_float_denorm_mode_32 3
.end_amdhsa_kernel
.p2align 6
.amdhsa_kernel gs_acc_kernel
  .amdhsa_next_free_vgpr 128
  .amdhsa_next_free_sgpr 96
  .amdhsa_accum_offset 128
  .amdhsa_group_segment_fixed_size 0
  .amdhsa_kernarg_size 112
  .amdhsa_user_sgpr_count 2
  .amdhsa_user_sgpr_kernarg_segment_ptr 1
  .amdhsa_system_sgpr_workgroup_id_x 1
  .amdhsa_float_denorm_mode_32 3
.end_amdhsa_kernel
.p2align 6
.amdhsa_kernel gs_final_kernel
  .amdhsa_next_free_vgpr 72
  .amdhsa_next_free_sgpr 64
  .amdhsa_accum_offset 72
  .amdhsa_group_segment_fixed_size 0
  .amdhsa_kernarg_size 112
  .amdhsa_user_sgpr_count 2
  .amdhsa_user_sgpr_kernarg_segment_ptr 1
  .amdhsa_system_sgpr_workgroup_id_x 1
  .amdhsa_float_denorm_mode_32 3
.end_amdhsa_kernel
```

```asm
; @launch kernel=gs_sort_kernel grid=(256,1,1) block=(1024,1,1) lds=163840
; @launch kernel=gs_acc_kernel grid=(256,1,1) block=(1024,1,1) lds=163840
; @launch kernel=gs_final_kernel grid=(1250,1,1) block=(256,1,1) lds=0
.amdgcn_target "amdgcn-amd-amdhsa--gfx950"
.text
.globl gs_sort_kernel
.p2align 8
.type gs_sort_kernel,@function
gs_sort_kernel:
    s_cmp_ge_u32 s2, 256
    s_cbranch_scc1 L1_end
    s_load_dwordx4 s[4:7], s[0:1], 8
    s_load_dwordx2 s[28:29], s[0:1], 32
    s_load_dwordx2 s[30:31], s[0:1], 104
    s_load_dwordx2 s[56:57], s[0:1], 96
    s_load_dwordx2 s[86:87], s[0:1], 0
    s_load_dwordx4 s[60:63], s[0:1], 56
    s_load_dwordx4 s[64:67], s[0:1], 72
    v_lshrrev_b32 v7, 6, v0
    v_lshlrev_b32 v1, 3, v0
    v_readfirstlane_b32 s32, v7
    v_lshlrev_b32 v0, 4, v0
    s_mul_i32 s33, s2, 131072
    s_mul_i32 s34, s2, 65536
    s_waitcnt lgkmcnt(0)
    s_mov_b32 s8, s4
    s_mov_b32 s9, s5
    s_mov_b32 s10, 0x9c40000
    s_mov_b32 s11, 0x20000
    s_mov_b32 s12, s6
    s_mov_b32 s13, s7
    s_mov_b32 s14, 0x9c40000
    s_mov_b32 s15, 0x20000
    s_mov_b32 s16, s28
    s_mov_b32 s17, s29
    s_mov_b32 s18, 0x4e20000
    s_mov_b32 s19, 0x20000
    s_add_u32 s44, s33, 0x0
    buffer_load_dwordx4 v[16:19], v0, s[8:11], s44 offen nt
    s_add_u32 s45, s33, 0x0
    buffer_load_dwordx4 v[20:23], v0, s[12:15], s45 offen nt
    s_add_u32 s46, s34, 0x0
    buffer_load_dwordx2 v[24:25], v1, s[16:19], s46 offen nt
    s_add_u32 s47, s34, 0x2000
    buffer_load_dwordx2 v[26:27], v1, s[16:19], s47 offen nt
    s_add_u32 s44, s33, 0x4000
    buffer_load_dwordx4 v[28:31], v0, s[8:11], s44 offen nt
    s_add_u32 s45, s33, 0x4000
    buffer_load_dwordx4 v[32:35], v0, s[12:15], s45 offen nt
    s_add_u32 s46, s33, 0x8000
    buffer_load_dwordx4 v[36:39], v0, s[8:11], s46 offen nt
    s_add_u32 s47, s33, 0x8000
    buffer_load_dwordx4 v[40:43], v0, s[12:15], s47 offen nt
    s_add_u32 s44, s34, 0x4000
    buffer_load_dwordx2 v[44:45], v1, s[16:19], s44 offen nt
    s_add_u32 s45, s34, 0x6000
    buffer_load_dwordx2 v[46:47], v1, s[16:19], s45 offen nt
    s_mov_b32 s68, s62
    s_mov_b32 s69, s63
    s_mov_b32 s70, 0x40
    s_mov_b32 s71, 0x20000
    s_mov_b32 s72, s60
    s_mov_b32 s73, s61
    s_mov_b32 s74, 0x40
    s_mov_b32 s75, 0x20000
    s_mov_b32 s20, s66
    s_mov_b32 s21, s67
    s_mov_b32 s22, 0x20
    s_mov_b32 s23, 0x20000
    s_mov_b32 s80, s64
    s_mov_b32 s81, s65
    s_mov_b32 s82, 0x20
    s_mov_b32 s83, 0x20000
    s_add_u32 s24, s30, 0xebab000
    s_addc_u32 s25, s31, 0
    s_mov_b32 s26, 0x100
    s_mov_b32 s27, 0x20000
    v_lshrrev_b32 v2, 3, v0
    v_and_b32 v2, 6, v2
    v_lshlrev_b32 v3, 2, v0
    s_lshl_b32 s3, s32, 8
    s_add_u32 s3, s3, s2
    s_cmp_lg_u32 s3, 254
    s_cbranch_scc1 L1_wt
    buffer_load_ushort v96, v2, s[68:71], 0 offen offset:0
    buffer_load_ushort v108, v2, s[68:71], 0 offen offset:8
    buffer_load_ushort v97, v2, s[68:71], 0 offen offset:16
    buffer_load_ushort v109, v2, s[68:71], 0 offen offset:24
    buffer_load_ushort v98, v2, s[68:71], 0 offen offset:32
    buffer_load_ushort v110, v2, s[68:71], 0 offen offset:40
    buffer_load_ushort v99, v2, s[68:71], 0 offen offset:48
    buffer_load_ushort v111, v2, s[68:71], 0 offen offset:56
    buffer_load_ushort v100, v2, s[72:75], 0 offen offset:0
    buffer_load_ushort v112, v2, s[72:75], 0 offen offset:8
    buffer_load_ushort v101, v2, s[72:75], 0 offen offset:16
    buffer_load_ushort v113, v2, s[72:75], 0 offen offset:24
    buffer_load_ushort v102, v2, s[72:75], 0 offen offset:32
    buffer_load_ushort v114, v2, s[72:75], 0 offen offset:40
    buffer_load_ushort v103, v2, s[72:75], 0 offen offset:48
    buffer_load_ushort v115, v2, s[72:75], 0 offen offset:56
    buffer_load_ushort v104, v2, s[20:23], 0 offen offset:0
    buffer_load_ushort v116, v2, s[20:23], 0 offen offset:8
    buffer_load_ushort v105, v2, s[20:23], 0 offen offset:16
    buffer_load_ushort v117, v2, s[20:23], 0 offen offset:24
    buffer_load_ushort v106, v2, s[80:83], 0 offen offset:0
    buffer_load_ushort v118, v2, s[80:83], 0 offen offset:8
    buffer_load_ushort v107, v2, s[80:83], 0 offen offset:16
    buffer_load_ushort v119, v2, s[80:83], 0 offen offset:24
    s_waitcnt vmcnt(0)
    v_lshl_or_b32 v96, v108, 16, v96
    v_lshl_or_b32 v97, v109, 16, v97
    v_lshl_or_b32 v98, v110, 16, v98
    v_lshl_or_b32 v99, v111, 16, v99
    v_lshl_or_b32 v100, v112, 16, v100
    v_lshl_or_b32 v101, v113, 16, v101
    v_lshl_or_b32 v102, v114, 16, v102
    v_lshl_or_b32 v103, v115, 16, v103
    v_lshl_or_b32 v104, v116, 16, v104
    v_lshl_or_b32 v105, v117, 16, v105
    v_lshl_or_b32 v106, v118, 16, v106
    v_lshl_or_b32 v107, v119, 16, v107
    buffer_store_dwordx4 v[96:99], v3, s[24:27], 0 offen offset:0
    buffer_store_dwordx4 v[100:103], v3, s[24:27], 0 offen offset:16
    buffer_store_dwordx4 v[104:107], v3, s[24:27], 0 offen offset:32
L1_wt:
    s_mov_b32 s20, s30
    s_mov_b32 s21, s31
    s_mov_b32 s22, 0xd340000
    s_mov_b32 s23, 0x20000
    s_add_u32 s24, s30, 0x28000
    s_addc_u32 s25, s31, 0
    s_mov_b32 s26, 0xd318000
    s_mov_b32 s27, 0x20000
    s_mov_b32 s80, s86
    s_mov_b32 s81, s87
    s_mov_b32 s82, 0x4e20
    s_mov_b32 s83, 0x20000
    s_mul_i32 s3, s2, 20000
    s_add_u32 s80, s80, s3
    s_addc_u32 s81, s81, 0
    s_mul_i32 s35, s2, 173056
    s_and_b32 s37, s32, 3
    s_lshl_b32 s37, s37, 3
    s_add_u32 s36, s35, s37
    s_lshr_b32 s37, s32, 2
    s_mul_i32 s37, s37, 2080
    s_add_u32 s36, s36, s37
    s_mul_i32 s4, s2, 5
    s_add_u32 s4, s4, 8192
    s_lshl_b32 s38, s4, 14
    s_lshl_b32 s39, s4, 13
    v_mov_b32 v2, 1
    v_mov_b32 v4, 0x80000007
    v_mov_b32 v5, 0xfc
    v_mov_b32 v6, 0x78
    s_mov_b32 s40, 2048
    s_mov_b32 s55, -10000
    s_mov_b32 s41, 0x010c0c01
    s_mov_b32 s42, 0x030c0c03
    v_mov_b32 v8, 0
    v_mov_b32 v9, 0
    v_mov_b32 v10, 0
    v_mov_b32 v11, 0
    ds_write_b128 v0, v[8:11]
    s_waitcnt lgkmcnt(0)
    s_barrier
    s_add_u32 s46, s33, 0xc000
    buffer_load_dwordx4 v[48:51], v0, s[8:11], s46 offen nt
    s_add_u32 s47, s33, 0xc000
    buffer_load_dwordx4 v[52:55], v0, s[12:15], s47 offen nt
    s_waitcnt vmcnt(8)
    v_lshlrev_b32 v7, 16, v24
    v_and_b32 v8, 0xffff0000, v24
    v_lshlrev_b32 v9, 16, v25
    v_and_b32 v10, 0xffff0000, v25
    v_mul_f32 v7, 0.15915494, v7
    v_mul_f32 v8, 0.15915494, v8
    v_mul_f32 v9, 0.15915494, v9
    v_mul_f32 v10, 0.15915494, v10
    v_mul_hi_u32_u24 v14, 429497, v16
    v_lshrrev_b32 v12, 3, v20
    v_cos_f32 v7, v7
    v_lshlrev_b16 v13, 3, v20
    v_mad_i32_i24 v11, v14, s55, v16
    v_bitop3_b32 v12, v6, v13, v12 bitop3:0xca
    v_add_lshl_u32 v11, v11, s40, 17
    v_lshlrev_b16 v14, 8, v14
    v_lshrrev_b32 v13, 2, v20
    v_or_b32 v16, v12, v11
    v_bitop3_b32 v20, v5, v13, v14 bitop3:0xea
    ds_add_u32 v20, v2
    v_mul_hi_u32_u24 v14, 429497, v17
    v_lshrrev_b32 v12, 3, v21
    v_cos_f32 v8, v8
    v_lshlrev_b16 v13, 3, v21
    v_mad_i32_i24 v11, v14, s55, v17
    v_bitop3_b32 v12, v6, v13, v12 bitop3:0xca
    v_add_lshl_u32 v11, v11, s40, 17
    v_lshlrev_b16 v14, 8, v14
    v_lshrrev_b32 v13, 2, v21
    v_or_b32 v17, v12, v11
    v_bitop3_b32 v21, v5, v13, v14 bitop3:0xea
    ds_add_u32 v21, v2
    v_cvt_pk_bf16_f32 v24, v7, v8
    v_perm_b32 v12, v24, v24, s41
    v_bitop3_b32 v16, v4, v12, v16 bitop3:0xca
    v_perm_b32 v13, v24, v24, s42
    v_bitop3_b32 v17, v4, v13, v17 bitop3:0xca
    v_mul_hi_u32_u24 v14, 429497, v18
    v_lshrrev_b32 v12, 3, v22
    v_cos_f32 v9, v9
    v_lshlrev_b16 v13, 3, v22
    v_mad_i32_i24 v11, v14, s55, v18
    v_bitop3_b32 v12, v6, v13, v12 bitop3:0xca
    v_add_lshl_u32 v11, v11, s40, 17
    v_lshlrev_b16 v14, 8, v14
    v_lshrrev_b32 v13, 2, v22
    v_or_b32 v18, v12, v11
    v_bitop3_b32 v22, v5, v13, v14 bitop3:0xea
    ds_add_u32 v22, v2
    v_mul_hi_u32_u24 v14, 429497, v19
    v_lshrrev_b32 v12, 3, v23
    v_cos_f32 v10, v10
    v_lshlrev_b16 v13, 3, v23
    v_mad_i32_i24 v11, v14, s55, v19
    v_bitop3_b32 v12, v6, v13, v12 bitop3:0xca
    v_add_lshl_u32 v11, v11, s40, 17
    v_lshlrev_b16 v14, 8, v14
    v_lshrrev_b32 v13, 2, v23
    v_or_b32 v19, v12, v11
    v_bitop3_b32 v23, v5, v13, v14 bitop3:0xea
    ds_add_u32 v23, v2
    v_cvt_pk_bf16_f32 v25, v9, v10
    v_perm_b32 v12, v25, v25, s41
    v_bitop3_b32 v18, v4, v12, v18 bitop3:0xca
    v_perm_b32 v13, v25, v25, s42
    v_bitop3_b32 v19, v4, v13, v19 bitop3:0xca
    s_add_u32 s44, s33, 0x10000
    buffer_load_dwordx4 v[56:59], v0, s[8:11], s44 offen nt
    s_add_u32 s45, s33, 0x10000
    buffer_load_dwordx4 v[60:63], v0, s[12:15], s45 offen nt
    s_add_u32 s46, s34, 0x8000
    buffer_load_dwordx2 v[64:65], v1, s[16:19], s46 offen nt
    s_add_u32 s47, s34, 0xa000
    buffer_load_dwordx2 v[66:67], v1, s[16:19], s47 offen nt
    s_waitcnt vmcnt(10)
    v_lshlrev_b32 v7, 16, v26
    v_and_b32 v8, 0xffff0000, v26
    v_lshlrev_b32 v9, 16, v27
    v_and_b32 v10, 0xffff0000, v27
    v_mul_f32 v7, 0.15915494, v7
    v_mul_f32 v8, 0.15915494, v8
    v_mul_f32 v9, 0.15915494, v9
    v_mul_f32 v10, 0.15915494, v10
    v_mul_hi_u32_u24 v14, 429497, v28
    v_lshrrev_b32 v12, 3, v32
    v_cos_f32 v7, v7
    v_lshlrev_b16 v13, 3, v32
    v_mad_i32_i24 v11, v14, s55, v28
    v_bitop3_b32 v12, v6, v13, v12 bitop3:0xca
    v_add_lshl_u32 v11, v11, s40, 17
    v_lshlrev_b16 v14, 8, v14
    v_lshrrev_b32 v13, 2, v32
    v_or_b32 v28, v12, v11
    v_bitop3_b32 v32, v5, v13, v14 bitop3:0xea
    ds_add_u32 v32, v2
    v_mul_hi_u32_u24 v14, 429497, v29
    v_lshrrev_b32 v12, 3, v33
    v_cos_f32 v8, v8
    v_lshlrev_b16 v13, 3, v33
    v_mad_i32_i24 v11, v14, s55, v29
    v_bitop3_b32 v12, v6, v13, v12 bitop3:0xca
    v_add_lshl_u32 v11, v11, s40, 17
    v_lshlrev_b16 v14, 8, v14
    v_lshrrev_b32 v13, 2, v33
    v_or_b32 v29, v12, v11
    v_bitop3_b32 v33, v5, v13, v14 bitop3:0xea
    ds_add_u32 v33, v2
    v_cvt_pk_bf16_f32 v26, v7, v8
    v_perm_b32 v12, v26, v26, s41
    v_bitop3_b32 v28, v4, v12, v28 bitop3:0xca
    v_perm_b32 v13, v26, v26, s42
    v_bitop3_b32 v29, v4, v13, v29 bitop3:0xca
    v_mul_hi_u32_u24 v14, 429497, v30
    v_lshrrev_b32 v12, 3, v34
    v_cos_f32 v9, v9
    v_lshlrev_b16 v13, 3, v34
    v_mad_i32_i24 v11, v14, s55, v30
    v_bitop3_b32 v12, v6, v13, v12 bitop3:0xca
    v_add_lshl_u32 v11, v11, s40, 17
    v_lshlrev_b16 v14, 8, v14
    v_lshrrev_b32 v13, 2, v34
    v_or_b32 v30, v12, v11
    v_bitop3_b32 v34, v5, v13, v14 bitop3:0xea
    ds_add_u32 v34, v2
    v_mul_hi_u32_u24 v14, 429497, v31
    v_lshrrev_b32 v12, 3, v35
    v_cos_f32 v10, v10
    v_lshlrev_b16 v13, 3, v35
    v_mad_i32_i24 v11, v14, s55, v31
    v_bitop3_b32 v12, v6, v13, v12 bitop3:0xca
    v_add_lshl_u32 v11, v11, s40, 17
    v_lshlrev_b16 v14, 8, v14
    v_lshrrev_b32 v13, 2, v35
    v_or_b32 v31, v12, v11
    v_bitop3_b32 v35, v5, v13, v14 bitop3:0xea
    ds_add_u32 v35, v2
    v_cvt_pk_bf16_f32 v27, v9, v10
    v_perm_b32 v12, v27, v27, s41
    v_bitop3_b32 v30, v4, v12, v30 bitop3:0xca
    v_perm_b32 v13, v27, v27, s42
    v_bitop3_b32 v31, v4, v13, v31 bitop3:0xca
    s_add_u32 s44, s33, 0x14000
    buffer_load_dwordx4 v[68:71], v0, s[8:11], s44 offen nt
    s_add_u32 s45, s33, 0x14000
    buffer_load_dwordx4 v[72:75], v0, s[12:15], s45 offen nt
    s_waitcnt vmcnt(8)
    v_lshlrev_b32 v7, 16, v44
    v_and_b32 v8, 0xffff0000, v44
    v_lshlrev_b32 v9, 16, v45
    v_and_b32 v10, 0xffff0000, v45
    v_mul_f32 v7, 0.15915494, v7
    v_mul_f32 v8, 0.15915494, v8
    v_mul_f32 v9, 0.15915494, v9
    v_mul_f32 v10, 0.15915494, v10
    v_mul_hi_u32_u24 v14, 429497, v36
    v_lshrrev_b32 v12, 3, v40
    v_cos_f32 v7, v7
    v_lshlrev_b16 v13, 3, v40
    v_mad_i32_i24 v11, v14, s55, v36
    v_bitop3_b32 v12, v6, v13, v12 bitop3:0xca
    v_add_lshl_u32 v11, v11, s40, 17
    v_lshlrev_b16 v14, 8, v14
    v_lshrrev_b32 v13, 2, v40
    v_or_b32 v36, v12, v11
    v_bitop3_b32 v40, v5, v13, v14 bitop3:0xea
    ds_add_u32 v40, v2
    v_mul_hi_u32_u24 v14, 429497, v37
    v_lshrrev_b32 v12, 3, v41
    v_cos_f32 v8, v8
    v_lshlrev_b16 v13, 3, v41
    v_mad_i32_i24 v11, v14, s55, v37
    v_bitop3_b32 v12, v6, v13, v12 bitop3:0xca
    v_add_lshl_u32 v11, v11, s40, 17
    v_lshlrev_b16 v14, 8, v14
    v_lshrrev_b32 v13, 2, v41
    v_or_b32 v37, v12, v11
    v_bitop3_b32 v41, v5, v13, v14 bitop3:0xea
    ds_add_u32 v41, v2
    v_cvt_pk_bf16_f32 v44, v7, v8
    v_perm_b32 v12, v44, v44, s41
    v_bitop3_b32 v36, v4, v12, v36 bitop3:0xca
    v_perm_b32 v13, v44, v44, s42
    v_bitop3_b32 v37, v4, v13, v37 bitop3:0xca
    v_mul_hi_u32_u24 v14, 429497, v38
    v_lshrrev_b32 v12, 3, v42
    v_cos_f32 v9, v9
    v_lshlrev_b16 v13, 3, v42
    v_mad_i32_i24 v11, v14, s55, v38
    v_bitop3_b32 v12, v6, v13, v12 bitop3:0xca
    v_add_lshl_u32 v11, v11, s40, 17
    v_lshlrev_b16 v14, 8, v14
    v_lshrrev_b32 v13, 2, v42
    v_or_b32 v38, v12, v11
    v_bitop3_b32 v42, v5, v13, v14 bitop3:0xea
    ds_add_u32 v42, v2
    v_mul_hi_u32_u24 v14, 429497, v39
    v_lshrrev_b32 v12, 3, v43
    v_cos_f32 v10, v10
    v_lshlrev_b16 v13, 3, v43
    v_mad_i32_i24 v11, v14, s55, v39
    v_bitop3_b32 v12, v6, v13, v12 bitop3:0xca
    v_add_lshl_u32 v11, v11, s40, 17
    v_lshlrev_b16 v14, 8, v14
    v_lshrrev_b32 v13, 2, v43
    v_or_b32 v39, v12, v11
    v_bitop3_b32 v43, v5, v13, v14 bitop3:0xea
    ds_add_u32 v43, v2
    v_cvt_pk_bf16_f32 v45, v9, v10
    v_perm_b32 v12, v45, v45, s41
    v_bitop3_b32 v38, v4, v12, v38 bitop3:0xca
    v_perm_b32 v13, v45, v45, s42
    v_bitop3_b32 v39, v4, v13, v39 bitop3:0xca
    s_add_u32 s46, s33, 0x18000
    buffer_load_dwordx4 v[76:79], v0, s[8:11], s46 offen nt
    s_add_u32 s47, s33, 0x18000
    buffer_load_dwordx4 v[80:83], v0, s[12:15], s47 offen nt
    s_add_u32 s44, s34, 0xc000
    buffer_load_dwordx2 v[84:85], v1, s[16:19], s44 offen nt
    s_add_u32 s45, s34, 0xe000
    buffer_load_dwordx2 v[86:87], v1, s[16:19], s45 offen nt
    s_waitcnt vmcnt(10)
    v_lshlrev_b32 v7, 16, v46
    v_and_b32 v8, 0xffff0000, v46
    v_lshlrev_b32 v9, 16, v47
    v_and_b32 v10, 0xffff0000, v47
    v_mul_f32 v7, 0.15915494, v7
    v_mul_f32 v8, 0.15915494, v8
    v_mul_f32 v9, 0.15915494, v9
    v_mul_f32 v10, 0.15915494, v10
    v_mul_hi_u32_u24 v14, 429497, v48
    v_lshrrev_b32 v12, 3, v52
    v_cos_f32 v7, v7
    v_lshlrev_b16 v13, 3, v52
    v_mad_i32_i24 v11, v14, s55, v48
    v_bitop3_b32 v12, v6, v13, v12 bitop3:0xca
    v_add_lshl_u32 v11, v11, s40, 17
    v_lshlrev_b16 v14, 8, v14
    v_lshrrev_b32 v13, 2, v52
    v_or_b32 v48, v12, v11
    v_bitop3_b32 v52, v5, v13, v14 bitop3:0xea
    ds_add_u32 v52, v2
    v_mul_hi_u32_u24 v14, 429497, v49
    v_lshrrev_b32 v12, 3, v53
    v_cos_f32 v8, v8
    v_lshlrev_b16 v13, 3, v53
    v_mad_i32_i24 v11, v14, s55, v49
    v_bitop3_b32 v12, v6, v13, v12 bitop3:0xca
    v_add_lshl_u32 v11, v11, s40, 17
    v_lshlrev_b16 v14, 8, v14
    v_lshrrev_b32 v13, 2, v53
    v_or_b32 v49, v12, v11
    v_bitop3_b32 v53, v5, v13, v14 bitop3:0xea
    ds_add_u32 v53, v2
    v_cvt_pk_bf16_f32 v46, v7, v8
    v_perm_b32 v12, v46, v46, s41
    v_bitop3_b32 v48, v4, v12, v48 bitop3:0xca
    v_perm_b32 v13, v46, v46, s42
    v_bitop3_b32 v49, v4, v13, v49 bitop3:0xca
    v_mul_hi_u32_u24 v14, 429497, v50
    v_lshrrev_b32 v12, 3, v54
    v_cos_f32 v9, v9
    v_lshlrev_b16 v13, 3, v54
    v_mad_i32_i24 v11, v14, s55, v50
    v_bitop3_b32 v12, v6, v13, v12 bitop3:0xca
    v_add_lshl_u32 v11, v11, s40, 17
    v_lshlrev_b16 v14, 8, v14
    v_lshrrev_b32 v13, 2, v54
    v_or_b32 v50, v12, v11
    v_bitop3_b32 v54, v5, v13, v14 bitop3:0xea
    ds_add_u32 v54, v2
    v_mul_hi_u32_u24 v14, 429497, v51
    v_lshrrev_b32 v12, 3, v55
    v_cos_f32 v10, v10
    v_lshlrev_b16 v13, 3, v55
    v_mad_i32_i24 v11, v14, s55, v51
    v_bitop3_b32 v12, v6, v13, v12 bitop3:0xca
    v_add_lshl_u32 v11, v11, s40, 17
    v_lshlrev_b16 v14, 8, v14
    v_lshrrev_b32 v13, 2, v55
    v_or_b32 v51, v12, v11
    v_bitop3_b32 v55, v5, v13, v14 bitop3:0xea
    ds_add_u32 v55, v2
    v_cvt_pk_bf16_f32 v47, v9, v10
    v_perm_b32 v12, v47, v47, s41
    v_bitop3_b32 v50, v4, v12, v50 bitop3:0xca
    v_perm_b32 v13, v47, v47, s42
    v_bitop3_b32 v51, v4, v13, v51 bitop3:0xca
    s_add_u32 s46, s33, 0x1c000
    buffer_load_dwordx4 v[88:91], v0, s[8:11], s46 offen nt
    s_add_u32 s47, s33, 0x1c000
    buffer_load_dwordx4 v[92:95], v0, s[12:15], s47 offen nt
    s_waitcnt vmcnt(8)
    v_lshlrev_b32 v7, 16, v64
    v_and_b32 v8, 0xffff0000, v64
    v_lshlrev_b32 v9, 16, v65
    v_and_b32 v10, 0xffff0000, v65
    v_mul_f32 v7, 0.15915494, v7
    v_mul_f32 v8, 0.15915494, v8
    v_mul_f32 v9, 0.15915494, v9
    v_mul_f32 v10, 0.15915494, v10
    v_mul_hi_u32_u24 v14, 429497, v56
    v_lshrrev_b32 v12, 3, v60
    v_cos_f32 v7, v7
    v_lshlrev_b16 v13, 3, v60
    v_mad_i32_i24 v11, v14, s55, v56
    v_bitop3_b32 v12, v6, v13, v12 bitop3:0xca
    v_add_lshl_u32 v11, v11, s40, 17
    v_lshlrev_b16 v14, 8, v14
    v_lshrrev_b32 v13, 2, v60
    v_or_b32 v56, v12, v11
    v_bitop3_b32 v60, v5, v13, v14 bitop3:0xea
    ds_add_u32 v60, v2
    v_mul_hi_u32_u24 v14, 429497, v57
    v_lshrrev_b32 v12, 3, v61
    v_cos_f32 v8, v8
    v_lshlrev_b16 v13, 3, v61
    v_mad_i32_i24 v11, v14, s55, v57
    v_bitop3_b32 v12, v6, v13, v12 bitop3:0xca
    v_add_lshl_u32 v11, v11, s40, 17
    v_lshlrev_b16 v14, 8, v14
    v_lshrrev_b32 v13, 2, v61
    v_or_b32 v57, v12, v11
    v_bitop3_b32 v61, v5, v13, v14 bitop3:0xea
    ds_add_u32 v61, v2
    v_cvt_pk_bf16_f32 v64, v7, v8
    v_perm_b32 v12, v64, v64, s41
    v_bitop3_b32 v56, v4, v12, v56 bitop3:0xca
    v_perm_b32 v13, v64, v64, s42
    v_bitop3_b32 v57, v4, v13, v57 bitop3:0xca
    v_mul_hi_u32_u24 v14, 429497, v58
    v_lshrrev_b32 v12, 3, v62
    v_cos_f32 v9, v9
    v_lshlrev_b16 v13, 3, v62
    v_mad_i32_i24 v11, v14, s55, v58
    v_bitop3_b32 v12, v6, v13, v12 bitop3:0xca
    v_add_lshl_u32 v11, v11, s40, 17
    v_lshlrev_b16 v14, 8, v14
    v_lshrrev_b32 v13, 2, v62
    v_or_b32 v58, v12, v11
    v_bitop3_b32 v62, v5, v13, v14 bitop3:0xea
    ds_add_u32 v62, v2
    v_mul_hi_u32_u24 v14, 429497, v59
    v_lshrrev_b32 v12, 3, v63
    v_cos_f32 v10, v10
    v_lshlrev_b16 v13, 3, v63
    v_mad_i32_i24 v11, v14, s55, v59
    v_bitop3_b32 v12, v6, v13, v12 bitop3:0xca
    v_add_lshl_u32 v11, v11, s40, 17
    v_lshlrev_b16 v14, 8, v14
    v_lshrrev_b32 v13, 2, v63
    v_or_b32 v59, v12, v11
    v_bitop3_b32 v63, v5, v13, v14 bitop3:0xea
    ds_add_u32 v63, v2
    v_cvt_pk_bf16_f32 v65, v9, v10
    v_perm_b32 v12, v65, v65, s41
    v_bitop3_b32 v58, v4, v12, v58 bitop3:0xca
    v_perm_b32 v13, v65, v65, s42
    v_bitop3_b32 v59, v4, v13, v59 bitop3:0xca
    s_add_u32 s44, s33, 0x2000000
    buffer_load_dwordx4 v[96:99], v0, s[8:11], s44 offen nt
    s_add_u32 s45, s33, 0x2000000
    buffer_load_dwordx4 v[100:103], v0, s[12:15], s45 offen nt
    s_add_u32 s46, s34, 0x1000000
    buffer_load_dwordx2 v[104:105], v1, s[16:19], s46 offen nt
    s_add_u32 s47, s34, 0x1002000
    buffer_load_dwordx2 v[106:107], v1, s[16:19], s47 offen nt
    s_waitcnt vmcnt(10)
    v_lshlrev_b32 v7, 16, v66
    v_and_b32 v8, 0xffff0000, v66
    v_lshlrev_b32 v9, 16, v67
    v_and_b32 v10, 0xffff0000, v67
    v_mul_f32 v7, 0.15915494, v7
    v_mul_f32 v8, 0.15915494, v8
    v_mul_f32 v9, 0.15915494, v9
    v_mul_f32 v10, 0.15915494, v10
    v_mul_hi_u32_u24 v14, 429497, v68
    v_lshrrev_b32 v12, 3, v72
    v_cos_f32 v7, v7
    v_lshlrev_b16 v13, 3, v72
    v_mad_i32_i24 v11, v14, s55, v68
    v_bitop3_b32 v12, v6, v13, v12 bitop3:0xca
    v_add_lshl_u32 v11, v11, s40, 17
    v_lshlrev_b16 v14, 8, v14
    v_lshrrev_b32 v13, 2, v72
    v_or_b32 v68, v12, v11
    v_bitop3_b32 v72, v5, v13, v14 bitop3:0xea
    ds_add_u32 v72, v2
    v_mul_hi_u32_u24 v14, 429497, v69
    v_lshrrev_b32 v12, 3, v73
    v_cos_f32 v8, v8
    v_lshlrev_b16 v13, 3, v73
    v_mad_i32_i24 v11, v14, s55, v69
    v_bitop3_b32 v12, v6, v13, v12 bitop3:0xca
    v_add_lshl_u32 v11, v11, s40, 17
    v_lshlrev_b16 v14, 8, v14
    v_lshrrev_b32 v13, 2, v73
    v_or_b32 v69, v12, v11
    v_bitop3_b32 v73, v5, v13, v14 bitop3:0xea
    ds_add_u32 v73, v2
    v_cvt_pk_bf16_f32 v66, v7, v8
    v_perm_b32 v12, v66, v66, s41
    v_bitop3_b32 v68, v4, v12, v68 bitop3:0xca
    v_perm_b32 v13, v66, v66, s42
    v_bitop3_b32 v69, v4, v13, v69 bitop3:0xca
    v_mul_hi_u32_u24 v14, 429497, v70
    v_lshrrev_b32 v12, 3, v74
    v_cos_f32 v9, v9
    v_lshlrev_b16 v13, 3, v74
    v_mad_i32_i24 v11, v14, s55, v70
    v_bitop3_b32 v12, v6, v13, v12 bitop3:0xca
    v_add_lshl_u32 v11, v11, s40, 17
    v_lshlrev_b16 v14, 8, v14
    v_lshrrev_b32 v13, 2, v74
    v_or_b32 v70, v12, v11
    v_bitop3_b32 v74, v5, v13, v14 bitop3:0xea
    ds_add_u32 v74, v2
    v_mul_hi_u32_u24 v14, 429497, v71
    v_lshrrev_b32 v12, 3, v75
    v_cos_f32 v10, v10
    v_lshlrev_b16 v13, 3, v75
    v_mad_i32_i24 v11, v14, s55, v71
    v_bitop3_b32 v12, v6, v13, v12 bitop3:0xca
    v_add_lshl_u32 v11, v11, s40, 17
    v_lshlrev_b16 v14, 8, v14
    v_lshrrev_b32 v13, 2, v75
    v_or_b32 v71, v12, v11
    v_bitop3_b32 v75, v5, v13, v14 bitop3:0xea
    ds_add_u32 v75, v2
    v_cvt_pk_bf16_f32 v67, v9, v10
    v_perm_b32 v12, v67, v67, s41
    v_bitop3_b32 v70, v4, v12, v70 bitop3:0xca
    v_perm_b32 v13, v67, v67, s42
    v_bitop3_b32 v71, v4, v13, v71 bitop3:0xca
    s_add_u32 s44, s33, 0x2004000
    buffer_load_dwordx4 v[108:111], v0, s[8:11], s44 offen nt
    s_waitcnt vmcnt(7)
    v_lshlrev_b32 v7, 16, v84
    v_and_b32 v8, 0xffff0000, v84
    v_lshlrev_b32 v9, 16, v85
    v_and_b32 v10, 0xffff0000, v85
    v_mul_f32 v7, 0.15915494, v7
    v_mul_f32 v8, 0.15915494, v8
    v_mul_f32 v9, 0.15915494, v9
    v_mul_f32 v10, 0.15915494, v10
    v_mul_hi_u32_u24 v14, 429497, v76
    v_lshrrev_b32 v12, 3, v80
    v_cos_f32 v7, v7
    v_lshlrev_b16 v13, 3, v80
    v_mad_i32_i24 v11, v14, s55, v76
    v_bitop3_b32 v12, v6, v13, v12 bitop3:0xca
    v_add_lshl_u32 v11, v11, s40, 17
    v_lshlrev_b16 v14, 8, v14
    v_lshrrev_b32 v13, 2, v80
    v_or_b32 v76, v12, v11
    v_bitop3_b32 v80, v5, v13, v14 bitop3:0xea
    ds_add_u32 v80, v2
    v_mul_hi_u32_u24 v14, 429497, v77
    v_lshrrev_b32 v12, 3, v81
    v_cos_f32 v8, v8
    v_lshlrev_b16 v13, 3, v81
    v_mad_i32_i24 v11, v14, s55, v77
    v_bitop3_b32 v12, v6, v13, v12 bitop3:0xca
    v_add_lshl_u32 v11, v11, s40, 17
    v_lshlrev_b16 v14, 8, v14
    v_lshrrev_b32 v13, 2, v81
    v_or_b32 v77, v12, v11
    v_bitop3_b32 v81, v5, v13, v14 bitop3:0xea
    ds_add_u32 v81, v2
    v_cvt_pk_bf16_f32 v84, v7, v8
    v_perm_b32 v12, v84, v84, s41
    v_bitop3_b32 v76, v4, v12, v76 bitop3:0xca
    v_perm_b32 v13, v84, v84, s42
    v_bitop3_b32 v77, v4, v13, v77 bitop3:0xca
    v_mul_hi_u32_u24 v14, 429497, v78
    v_lshrrev_b32 v12, 3, v82
    v_cos_f32 v9, v9
    v_lshlrev_b16 v13, 3, v82
    v_mad_i32_i24 v11, v14, s55, v78
    v_bitop3_b32 v12, v6, v13, v12 bitop3:0xca
    v_add_lshl_u32 v11, v11, s40, 17
    v_lshlrev_b16 v14, 8, v14
    v_lshrrev_b32 v13, 2, v82
    v_or_b32 v78, v12, v11
    v_bitop3_b32 v82, v5, v13, v14 bitop3:0xea
    ds_add_u32 v82, v2
    v_mul_hi_u32_u24 v14, 429497, v79
    v_lshrrev_b32 v12, 3, v83
    v_cos_f32 v10, v10
    v_lshlrev_b16 v13, 3, v83
    v_mad_i32_i24 v11, v14, s55, v79
    v_bitop3_b32 v12, v6, v13, v12 bitop3:0xca
    v_add_lshl_u32 v11, v11, s40, 17
    v_lshlrev_b16 v14, 8, v14
    v_lshrrev_b32 v13, 2, v83
    v_or_b32 v79, v12, v11
    v_bitop3_b32 v83, v5, v13, v14 bitop3:0xea
    ds_add_u32 v83, v2
    v_cvt_pk_bf16_f32 v85, v9, v10
    v_perm_b32 v12, v85, v85, s41
    v_bitop3_b32 v78, v4, v12, v78 bitop3:0xca
    v_perm_b32 v13, v85, v85, s42
    v_bitop3_b32 v79, v4, v13, v79 bitop3:0xca
    s_waitcnt vmcnt(5)
    v_lshlrev_b32 v7, 16, v86
    v_and_b32 v8, 0xffff0000, v86
    v_lshlrev_b32 v9, 16, v87
    v_and_b32 v10, 0xffff0000, v87
    v_mul_f32 v7, 0.15915494, v7
    v_mul_f32 v8, 0.15915494, v8
    v_mul_f32 v9, 0.15915494, v9
    v_mul_f32 v10, 0.15915494, v10
    v_mul_hi_u32_u24 v14, 429497, v88
    v_lshrrev_b32 v12, 3, v92
    v_cos_f32 v7, v7
    v_lshlrev_b16 v13, 3, v92
    v_mad_i32_i24 v11, v14, s55, v88
    v_bitop3_b32 v12, v6, v13, v12 bitop3:0xca
    v_add_lshl_u32 v11, v11, s40, 17
    v_lshlrev_b16 v14, 8, v14
    v_lshrrev_b32 v13, 2, v92
    v_or_b32 v88, v12, v11
    v_bitop3_b32 v92, v5, v13, v14 bitop3:0xea
    ds_add_u32 v92, v2
    v_mul_hi_u32_u24 v14, 429497, v89
    v_lshrrev_b32 v12, 3, v93
    v_cos_f32 v8, v8
    v_lshlrev_b16 v13, 3, v93
    v_mad_i32_i24 v11, v14, s55, v89
    v_bitop3_b32 v12, v6, v13, v12 bitop3:0xca
    v_add_lshl_u32 v11, v11, s40, 17
    v_lshlrev_b16 v14, 8, v14
    v_lshrrev_b32 v13, 2, v93
    v_or_b32 v89, v12, v11
    v_bitop3_b32 v93, v5, v13, v14 bitop3:0xea
    ds_add_u32 v93, v2
    v_cvt_pk_bf16_f32 v86, v7, v8
    v_perm_b32 v12, v86, v86, s41
    v_bitop3_b32 v88, v4, v12, v88 bitop3:0xca
    v_perm_b32 v13, v86, v86, s42
    v_bitop3_b32 v89, v4, v13, v89 bitop3:0xca
    v_mul_hi_u32_u24 v14, 429497, v90
    v_lshrrev_b32 v12, 3, v94
    v_cos_f32 v9, v9
    v_lshlrev_b16 v13, 3, v94
    v_mad_i32_i24 v11, v14, s55, v90
    v_bitop3_b32 v12, v6, v13, v12 bitop3:0xca
    v_add_lshl_u32 v11, v11, s40, 17
    v_lshlrev_b16 v14, 8, v14
    v_lshrrev_b32 v13, 2, v94
    v_or_b32 v90, v12, v11
    v_bitop3_b32 v94, v5, v13, v14 bitop3:0xea
    ds_add_u32 v94, v2
    v_mul_hi_u32_u24 v14, 429497, v91
    v_lshrrev_b32 v12, 3, v95
    v_cos_f32 v10, v10
    v_lshlrev_b16 v13, 3, v95
    v_mad_i32_i24 v11, v14, s55, v91
    v_bitop3_b32 v12, v6, v13, v12 bitop3:0xca
    v_add_lshl_u32 v11, v11, s40, 17
    v_lshlrev_b16 v14, 8, v14
    v_lshrrev_b32 v13, 2, v95
    v_or_b32 v91, v12, v11
    v_bitop3_b32 v95, v5, v13, v14 bitop3:0xea
    ds_add_u32 v95, v2
    v_cvt_pk_bf16_f32 v87, v9, v10
    v_perm_b32 v12, v87, v87, s41
    v_bitop3_b32 v90, v4, v12, v90 bitop3:0xca
    v_perm_b32 v13, v87, v87, s42
    v_bitop3_b32 v91, v4, v13, v91 bitop3:0xca
    v_lshrrev_b32 v8, 2, v0
    v_and_b32 v7, 0x3c00, v0
    v_bitop3_b32 v7, v5, v8, v7 bitop3:0xea
    s_waitcnt lgkmcnt(0)
    s_barrier
    ds_read2st64_b32 v[8:9], v7 offset0:0 offset1:1
    ds_read2st64_b32 v[10:11], v7 offset0:2 offset1:3
    s_add_u32 s45, s33, 0x2004000
    buffer_load_dwordx4 v[112:115], v0, s[12:15], s45 offen nt
    s_waitcnt lgkmcnt(0)
    v_lshl_or_b32 v12, v9, 16, v8
    v_lshl_or_b32 v13, v11, 16, v10
    v_mov_b32 v14, v12
    v_mov_b32 v15, v13
    s_nop 0
    v_add_u32_dpp v14, v14, v14 row_shr:1 row_mask:0xf bank_mask:0xf bound_ctrl:1
    v_add_u32_dpp v15, v15, v15 row_shr:1 row_mask:0xf bank_mask:0xf bound_ctrl:1
    s_nop 0
    v_add_u32_dpp v14, v14, v14 row_shr:2 row_mask:0xf bank_mask:0xf bound_ctrl:1
    v_add_u32_dpp v15, v15, v15 row_shr:2 row_mask:0xf bank_mask:0xf bound_ctrl:1
    s_nop 0
    v_add_u32_dpp v14, v14, v14 row_shr:4 row_mask:0xf bank_mask:0xf bound_ctrl:1
    v_add_u32_dpp v15, v15, v15 row_shr:4 row_mask:0xf bank_mask:0xf bound_ctrl:1
    s_nop 0
    v_add_u32_dpp v14, v14, v14 row_shr:8 row_mask:0xf bank_mask:0xf bound_ctrl:1
    v_add_u32_dpp v15, v15, v15 row_shr:8 row_mask:0xf bank_mask:0xf bound_ctrl:1
    s_nop 0
    v_add_u32_dpp v14, v14, v14 row_bcast:15 row_mask:0xa bank_mask:0xf
    v_add_u32_dpp v15, v15, v15 row_bcast:15 row_mask:0xa bank_mask:0xf
    s_nop 0
    v_add_u32_dpp v14, v14, v14 row_bcast:31 row_mask:0xc bank_mask:0xf
    v_add_u32_dpp v15, v15, v15 row_bcast:31 row_mask:0xc bank_mask:0xf
    v_readlane_b32 s48, v14, 63
    v_readlane_b32 s49, v15, 63
    s_lshl_b32 s54, s32, 2
    v_mov_b32 v8, s54
    s_and_b32 s50, s48, 0xffff
    s_lshr_b32 s51, s48, 16
    s_and_b32 s52, s49, 0xffff
    s_lshr_b32 s53, s49, 16
    s_add_u32 s51, s51, s50
    s_add_u32 s52, s52, s51
    s_add_u32 s53, s53, s52
    v_mov_b32 v9, s53
    s_mov_b64 exec, 1
    ds_write_b32 v8, v9 offset:16384
    s_mov_b64 exec, -1
    v_and_b32 v8, 60, v7
    s_waitcnt lgkmcnt(0)
    s_barrier
    ds_read_b32 v9, v8 offset:16384
    s_waitcnt lgkmcnt(0)
    v_add_u32_dpp v9, v9, v9 row_shr:1 row_mask:0xf bank_mask:0xf bound_ctrl:1
    s_nop 1
    v_add_u32_dpp v9, v9, v9 row_shr:2 row_mask:0xf bank_mask:0xf bound_ctrl:1
    s_nop 1
    v_add_u32_dpp v9, v9, v9 row_shr:4 row_mask:0xf bank_mask:0xf bound_ctrl:1
    s_nop 1
    v_add_u32_dpp v9, v9, v9 row_shr:8 row_mask:0xf bank_mask:0xf bound_ctrl:1
    s_nop 0
    v_readlane_b32 s54, v9, s32
    s_sub_u32 s54, s54, s53
    s_add_u32 s50, s50, s54
    s_add_u32 s51, s51, s54
    s_add_u32 s52, s52, s54
    s_pack_ll_b32_b16 s48, s54, s50
    s_pack_ll_b32_b16 s49, s51, s52
    v_add_u32 v14, s48, v14
    v_add_u32 v15, s49, v15
    v_sub_u32 v12, v14, v12
    v_sub_u32 v13, v15, v13
    v_and_b32 v8, 0xffff, v12
    v_lshrrev_b32 v9, 16, v12
    v_and_b32 v10, 0xffff, v13
    v_lshrrev_b32 v11, 16, v13
    ds_write2st64_b32 v7, v8, v9 offset0:0 offset1:1
    ds_write2st64_b32 v7, v10, v11 offset0:2 offset1:3
    s_waitcnt lgkmcnt(0)
    s_barrier
    ds_add_rtn_u32 v20, v20, v2
    ds_add_rtn_u32 v21, v21, v2
    ds_add_rtn_u32 v22, v22, v2
    ds_add_rtn_u32 v23, v23, v2
    s_add_u32 s46, s36, 0x0
    v_and_b32 v11, 0x3f0, v0
    v_add_u32 v11, v11, v11
    buffer_store_dwordx2 v[12:13], v11, s[24:27], s46 offen
    s_bitset0_b64 exec, 63
    s_not_b64 exec, exec
    buffer_store_dwordx2 v[14:15], v11, s[24:27], s46 offen offset:32
    s_mov_b64 exec, -1
    ds_add_rtn_u32 v32, v32, v2
    ds_add_rtn_u32 v33, v33, v2
    ds_add_rtn_u32 v34, v34, v2
    ds_add_rtn_u32 v35, v35, v2
    ds_add_rtn_u32 v40, v40, v2
    ds_add_rtn_u32 v41, v41, v2
    ds_add_rtn_u32 v42, v42, v2
    ds_add_rtn_u32 v43, v43, v2
    s_add_u32 s47, s33, 0x2008000
    buffer_load_dwordx4 v[116:119], v0, s[8:11], s47 offen nt
    ds_add_rtn_u32 v52, v52, v2
    ds_add_rtn_u32 v53, v53, v2
    ds_add_rtn_u32 v54, v54, v2
    ds_add_rtn_u32 v55, v55, v2
    ds_add_rtn_u32 v60, v60, v2
    ds_add_rtn_u32 v61, v61, v2
    ds_add_rtn_u32 v62, v62, v2
    ds_add_rtn_u32 v63, v63, v2
    s_add_u32 s44, s33, 0x2008000
    buffer_load_dwordx4 v[120:123], v0, s[12:15], s44 offen nt
    ds_add_rtn_u32 v72, v72, v2
    ds_add_rtn_u32 v73, v73, v2
    ds_add_rtn_u32 v74, v74, v2
    ds_add_rtn_u32 v75, v75, v2
    ds_add_rtn_u32 v80, v80, v2
    ds_add_rtn_u32 v81, v81, v2
    ds_add_rtn_u32 v82, v82, v2
    ds_add_rtn_u32 v83, v83, v2
    s_add_u32 s45, s34, 0x1004000
    buffer_load_dwordx2 v[124:125], v1, s[16:19], s45 offen nt
    s_add_u32 s46, s34, 0x1006000
    buffer_load_dwordx2 v[126:127], v1, s[16:19], s46 offen nt
    ds_add_rtn_u32 v92, v92, v2
    ds_add_rtn_u32 v93, v93, v2
    ds_add_rtn_u32 v94, v94, v2
    ds_add_rtn_u32 v95, v95, v2
    s_waitcnt lgkmcnt(0)
    s_barrier
    v_and_b32 v7, -4, v20
    v_lshl_add_u32 v8, v20, 2, v7
    ds_write_b32 v8, v16
    v_lshl_add_u32 v7, v7, 2, v20
    ds_write_b8 v7, v24 offset:16
    v_and_b32 v9, -4, v21
    v_lshl_add_u32 v10, v21, 2, v9
    ds_write_b32 v10, v17
    v_lshl_add_u32 v9, v9, 2, v21
    ds_write_b8_d16_hi v9, v24 offset:16
    v_and_b32 v7, -4, v22
    v_lshl_add_u32 v8, v22, 2, v7
    ds_write_b32 v8, v18
    v_lshl_add_u32 v7, v7, 2, v22
    ds_write_b8 v7, v25 offset:16
    v_and_b32 v9, -4, v23
    v_lshl_add_u32 v10, v23, 2, v9
    ds_write_b32 v10, v19
    v_lshl_add_u32 v9, v9, 2, v23
    ds_write_b8_d16_hi v9, v25 offset:16
    s_add_u32 s47, s33, 0x200c000
    buffer_load_dwordx4 v[16:19], v0, s[8:11], s47 offen nt
    s_add_u32 s44, s33, 0x200c000
    buffer_load_dwordx4 v[20:23], v0, s[12:15], s44 offen nt
    v_and_b32 v7, -4, v32
    v_lshl_add_u32 v8, v32, 2, v7
    ds_write_b32 v8, v28
    v_lshl_add_u32 v7, v7, 2, v32
    ds_write_b8 v7, v26 offset:16
    v_and_b32 v9, -4, v33
    v_lshl_add_u32 v10, v33, 2, v9
    ds_write_b32 v10, v29
    v_lshl_add_u32 v9, v9, 2, v33
    ds_write_b8_d16_hi v9, v26 offset:16
    v_and_b32 v7, -4, v34
    v_lshl_add_u32 v8, v34, 2, v7
    ds_write_b32 v8, v30
    v_lshl_add_u32 v7, v7, 2, v34
    ds_write_b8 v7, v27 offset:16
    v_and_b32 v9, -4, v35
    v_lshl_add_u32 v10, v35, 2, v9
    ds_write_b32 v10, v31
    v_lshl_add_u32 v9, v9, 2, v35
    ds_write_b8_d16_hi v9, v27 offset:16
    s_add_u32 s45, s33, 0x2010000
    buffer_load_dwordx4 v[28:31], v0, s[8:11], s45 offen nt
    v_and_b32 v7, -4, v40
    v_lshl_add_u32 v8, v40, 2, v7
    ds_write_b32 v8, v36
    v_lshl_add_u32 v7, v7, 2, v40
    ds_write_b8 v7, v44 offset:16
    v_and_b32 v9, -4, v41
    v_lshl_add_u32 v10, v41, 2, v9
    ds_write_b32 v10, v37
    v_lshl_add_u32 v9, v9, 2, v41
    ds_write_b8_d16_hi v9, v44 offset:16
    v_and_b32 v7, -4, v42
    v_lshl_add_u32 v8, v42, 2, v7
    ds_write_b32 v8, v38
    v_lshl_add_u32 v7, v7, 2, v42
    ds_write_b8 v7, v45 offset:16
    v_and_b32 v9, -4, v43
    v_lshl_add_u32 v10, v43, 2, v9
    ds_write_b32 v10, v39
    v_lshl_add_u32 v9, v9, 2, v43
    ds_write_b8_d16_hi v9, v45 offset:16
    s_add_u32 s46, s33, 0x2010000
    buffer_load_dwordx4 v[32:35], v0, s[12:15], s46 offen nt
    v_and_b32 v7, -4, v52
    v_lshl_add_u32 v8, v52, 2, v7
    ds_write_b32 v8, v48
    v_lshl_add_u32 v7, v7, 2, v52
    ds_write_b8 v7, v46 offset:16
    v_and_b32 v9, -4, v53
    v_lshl_add_u32 v10, v53, 2, v9
    ds_write_b32 v10, v49
    v_lshl_add_u32 v9, v9, 2, v53
    ds_write_b8_d16_hi v9, v46 offset:16
    v_and_b32 v7, -4, v54
    v_lshl_add_u32 v8, v54, 2, v7
    ds_write_b32 v8, v50
    v_lshl_add_u32 v7, v7, 2, v54
    ds_write_b8 v7, v47 offset:16
    v_and_b32 v9, -4, v55
    v_lshl_add_u32 v10, v55, 2, v9
    ds_write_b32 v10, v51
    v_lshl_add_u32 v9, v9, 2, v55
    ds_write_b8_d16_hi v9, v47 offset:16
    s_add_u32 s47, s34, 0x1008000
    buffer_load_dwordx2 v[24:25], v1, s[16:19], s47 offen nt
    s_add_u32 s44, s34, 0x100a000
    buffer_load_dwordx2 v[26:27], v1, s[16:19], s44 offen nt
    v_and_b32 v7, -4, v60
    v_lshl_add_u32 v8, v60, 2, v7
    ds_write_b32 v8, v56
    v_lshl_add_u32 v7, v7, 2, v60
    ds_write_b8 v7, v64 offset:16
    v_and_b32 v9, -4, v61
    v_lshl_add_u32 v10, v61, 2, v9
    ds_write_b32 v10, v57
    v_lshl_add_u32 v9, v9, 2, v61
    ds_write_b8_d16_hi v9, v64 offset:16
    v_and_b32 v7, -4, v62
    v_lshl_add_u32 v8, v62, 2, v7
    ds_write_b32 v8, v58
    v_lshl_add_u32 v7, v7, 2, v62
    ds_write_b8 v7, v65 offset:16
    v_and_b32 v9, -4, v63
    v_lshl_add_u32 v10, v63, 2, v9
    ds_write_b32 v10, v59
    v_lshl_add_u32 v9, v9, 2, v63
    ds_write_b8_d16_hi v9, v65 offset:16
    s_add_u32 s45, s33, 0x2014000
    buffer_load_dwordx4 v[36:39], v0, s[8:11], s45 offen nt
    s_add_u32 s46, s33, 0x2014000
    buffer_load_dwordx4 v[40:43], v0, s[12:15], s46 offen nt
    v_and_b32 v7, -4, v72
    v_lshl_add_u32 v8, v72, 2, v7
    ds_write_b32 v8, v68
    v_lshl_add_u32 v7, v7, 2, v72
    ds_write_b8 v7, v66 offset:16
    v_and_b32 v9, -4, v73
    v_lshl_add_u32 v10, v73, 2, v9
    ds_write_b32 v10, v69
    v_lshl_add_u32 v9, v9, 2, v73
    ds_write_b8_d16_hi v9, v66 offset:16
    v_and_b32 v7, -4, v74
    v_lshl_add_u32 v8, v74, 2, v7
    ds_write_b32 v8, v70
    v_lshl_add_u32 v7, v7, 2, v74
    ds_write_b8 v7, v67 offset:16
    v_and_b32 v9, -4, v75
    v_lshl_add_u32 v10, v75, 2, v9
    ds_write_b32 v10, v71
    v_lshl_add_u32 v9, v9, 2, v75
    ds_write_b8_d16_hi v9, v67 offset:16
    s_add_u32 s47, s33, 0x2018000
    buffer_load_dwordx4 v[48:51], v0, s[8:11], s47 offen nt
    v_and_b32 v7, -4, v80
    v_lshl_add_u32 v8, v80, 2, v7
    ds_write_b32 v8, v76
    v_lshl_add_u32 v7, v7, 2, v80
    ds_write_b8 v7, v84 offset:16
    v_and_b32 v9, -4, v81
    v_lshl_add_u32 v10, v81, 2, v9
    ds_write_b32 v10, v77
    v_lshl_add_u32 v9, v9, 2, v81
    ds_write_b8_d16_hi v9, v84 offset:16
    v_and_b32 v7, -4, v82
    v_lshl_add_u32 v8, v82, 2, v7
    ds_write_b32 v8, v78
    v_lshl_add_u32 v7, v7, 2, v82
    ds_write_b8 v7, v85 offset:16
    v_and_b32 v9, -4, v83
    v_lshl_add_u32 v10, v83, 2, v9
    ds_write_b32 v10, v79
    v_lshl_add_u32 v9, v9, 2, v83
    ds_write_b8_d16_hi v9, v85 offset:16
    s_add_u32 s44, s33, 0x2018000
    buffer_load_dwordx4 v[52:55], v0, s[12:15], s44 offen nt
    v_and_b32 v7, -4, v92
    v_lshl_add_u32 v8, v92, 2, v7
    ds_write_b32 v8, v88
    v_lshl_add_u32 v7, v7, 2, v92
    ds_write_b8 v7, v86 offset:16
    v_and_b32 v9, -4, v93
    v_lshl_add_u32 v10, v93, 2, v9
    ds_write_b32 v10, v89
    v_lshl_add_u32 v9, v9, 2, v93
    ds_write_b8_d16_hi v9, v86 offset:16
    v_and_b32 v7, -4, v94
    v_lshl_add_u32 v8, v94, 2, v7
    ds_write_b32 v8, v90
    v_lshl_add_u32 v7, v7, 2, v94
    ds_write_b8 v7, v87 offset:16
    v_and_b32 v9, -4, v95
    v_lshl_add_u32 v10, v95, 2, v9
    ds_write_b32 v10, v91
    v_lshl_add_u32 v9, v9, 2, v95
    ds_write_b8_d16_hi v9, v87 offset:16
    s_add_u32 s45, s34, 0x100c000
    buffer_load_dwordx2 v[44:45], v1, s[16:19], s45 offen nt
    s_add_u32 s46, s34, 0x100e000
    buffer_load_dwordx2 v[46:47], v1, s[16:19], s46 offen nt
    v_add_u32 v7, 0x10000, v0
    v_add_u32 v12, 0x20000, v0
    v_mov_b32 v8, 0
    v_mov_b32 v9, 0
    v_mov_b32 v10, 0
    v_mov_b32 v11, 0
    s_waitcnt lgkmcnt(0)
    s_barrier
    ds_read_b128 v[56:59], v0 offset:0
    ds_write_b128 v0, v[8:11]
    ds_read_b128 v[60:63], v0 offset:16384
    ds_read_b128 v[68:71], v0 offset:32768
    ds_read_b128 v[72:75], v0 offset:49152
    ds_read_b128 v[64:67], v7 offset:0
    ds_read_b128 v[76:79], v7 offset:16384
    ds_read_b128 v[80:83], v7 offset:32768
    ds_read_b128 v[88:91], v7 offset:49152
    ds_read_b128 v[92:95], v12 offset:0
    ds_read_b128 v[84:87], v12 offset:16384
    s_waitcnt lgkmcnt(0)
    s_barrier
    s_add_u32 s47, s35, 0x0
    buffer_store_dwordx4 v[56:59], v0, s[20:23], s47 offen sc1
    s_add_u32 s44, s33, 0x201c000
    s_nop 0
    buffer_load_dwordx4 v[56:59], v0, s[8:11], s44 offen nt
    s_add_u32 s45, s35, 0x4000
    buffer_store_dwordx4 v[60:63], v0, s[20:23], s45 offen sc1
    s_add_u32 s46, s33, 0x201c000
    s_nop 0
    buffer_load_dwordx4 v[60:63], v0, s[12:15], s46 offen nt
    s_waitcnt vmcnt(24)
    v_lshlrev_b32 v7, 16, v104
    v_and_b32 v8, 0xffff0000, v104
    v_lshlrev_b32 v9, 16, v105
    v_and_b32 v10, 0xffff0000, v105
    v_mul_f32 v7, 0.15915494, v7
    v_mul_f32 v8, 0.15915494, v8
    v_mul_f32 v9, 0.15915494, v9
    v_mul_f32 v10, 0.15915494, v10
    v_mul_hi_u32_u24 v14, 429497, v96
    v_lshrrev_b32 v12, 3, v100
    v_cos_f32 v7, v7
    v_lshlrev_b16 v13, 3, v100
    v_mad_i32_i24 v11, v14, s55, v96
    v_bitop3_b32 v12, v6, v13, v12 bitop3:0xca
    v_add_lshl_u32 v11, v11, s40, 17
    v_lshlrev_b16 v14, 8, v14
    v_lshrrev_b32 v13, 2, v100
    v_or_b32 v96, v12, v11
    v_bitop3_b32 v100, v5, v13, v14 bitop3:0xea
    ds_add_u32 v100, v2
    v_mul_hi_u32_u24 v14, 429497, v97
    v_lshrrev_b32 v12, 3, v101
    v_cos_f32 v8, v8
    v_lshlrev_b16 v13, 3, v101
    v_mad_i32_i24 v11, v14, s55, v97
    v_bitop3_b32 v12, v6, v13, v12 bitop3:0xca
    v_add_lshl_u32 v11, v11, s40, 17
    v_lshlrev_b16 v14, 8, v14
    v_lshrrev_b32 v13, 2, v101
    v_or_b32 v97, v12, v11
    v_bitop3_b32 v101, v5, v13, v14 bitop3:0xea
    ds_add_u32 v101, v2
    v_cvt_pk_bf16_f32 v104, v7, v8
    v_perm_b32 v12, v104, v104, s41
    v_bitop3_b32 v96, v4, v12, v96 bitop3:0xca
    v_perm_b32 v13, v104, v104, s42
    v_bitop3_b32 v97, v4, v13, v97 bitop3:0xca
    v_mul_hi_u32_u24 v14, 429497, v98
    v_lshrrev_b32 v12, 3, v102
    v_cos_f32 v9, v9
    v_lshlrev_b16 v13, 3, v102
    v_mad_i32_i24 v11, v14, s55, v98
    v_bitop3_b32 v12, v6, v13, v12 bitop3:0xca
    v_add_lshl_u32 v11, v11, s40, 17
    v_lshlrev_b16 v14, 8, v14
    v_lshrrev_b32 v13, 2, v102
    v_or_b32 v98, v12, v11
    v_bitop3_b32 v102, v5, v13, v14 bitop3:0xea
    ds_add_u32 v102, v2
    v_mul_hi_u32_u24 v14, 429497, v99
    v_lshrrev_b32 v12, 3, v103
    v_cos_f32 v10, v10
    v_lshlrev_b16 v13, 3, v103
    v_mad_i32_i24 v11, v14, s55, v99
    v_bitop3_b32 v12, v6, v13, v12 bitop3:0xca
    v_add_lshl_u32 v11, v11, s40, 17
    v_lshlrev_b16 v14, 8, v14
    v_lshrrev_b32 v13, 2, v103
    v_or_b32 v99, v12, v11
    v_bitop3_b32 v103, v5, v13, v14 bitop3:0xea
    ds_add_u32 v103, v2
    v_cvt_pk_bf16_f32 v105, v9, v10
    v_perm_b32 v12, v105, v105, s41
    v_bitop3_b32 v98, v4, v12, v98 bitop3:0xca
    v_perm_b32 v13, v105, v105, s42
    v_bitop3_b32 v99, v4, v13, v99 bitop3:0xca
    s_add_u32 s47, s35, 0x8000
    buffer_store_dwordx4 v[68:71], v0, s[20:23], s47 offen sc1
    s_add_u32 s44, s33, 0x4000000
    s_nop 0
    buffer_load_dwordx4 v[68:71], v0, s[8:11], s44 offen nt
    s_waitcnt vmcnt(24)
    v_lshlrev_b32 v7, 16, v106
    v_and_b32 v8, 0xffff0000, v106
    v_lshlrev_b32 v9, 16, v107
    v_and_b32 v10, 0xffff0000, v107
    v_mul_f32 v7, 0.15915494, v7
    v_mul_f32 v8, 0.15915494, v8
    v_mul_f32 v9, 0.15915494, v9
    v_mul_f32 v10, 0.15915494, v10
    v_mul_hi_u32_u24 v14, 429497, v108
    v_lshrrev_b32 v12, 3, v112
    v_cos_f32 v7, v7
    v_lshlrev_b16 v13, 3, v112
    v_mad_i32_i24 v11, v14, s55, v108
    v_bitop3_b32 v12, v6, v13, v12 bitop3:0xca
    v_add_lshl_u32 v11, v11, s40, 17
    v_lshlrev_b16 v14, 8, v14
    v_lshrrev_b32 v13, 2, v112
    v_or_b32 v108, v12, v11
    v_bitop3_b32 v112, v5, v13, v14 bitop3:0xea
    ds_add_u32 v112, v2
    v_mul_hi_u32_u24 v14, 429497, v109
    v_lshrrev_b32 v12, 3, v113
    v_cos_f32 v8, v8
    v_lshlrev_b16 v13, 3, v113
    v_mad_i32_i24 v11, v14, s55, v109
    v_bitop3_b32 v12, v6, v13, v12 bitop3:0xca
    v_add_lshl_u32 v11, v11, s40, 17
    v_lshlrev_b16 v14, 8, v14
    v_lshrrev_b32 v13, 2, v113
    v_or_b32 v109, v12, v11
    v_bitop3_b32 v113, v5, v13, v14 bitop3:0xea
    ds_add_u32 v113, v2
    v_cvt_pk_bf16_f32 v106, v7, v8
    v_perm_b32 v12, v106, v106, s41
    v_bitop3_b32 v108, v4, v12, v108 bitop3:0xca
    v_perm_b32 v13, v106, v106, s42
    v_bitop3_b32 v109, v4, v13, v109 bitop3:0xca
    v_mul_hi_u32_u24 v14, 429497, v110
    v_lshrrev_b32 v12, 3, v114
    v_cos_f32 v9, v9
    v_lshlrev_b16 v13, 3, v114
    v_mad_i32_i24 v11, v14, s55, v110
    v_bitop3_b32 v12, v6, v13, v12 bitop3:0xca
    v_add_lshl_u32 v11, v11, s40, 17
    v_lshlrev_b16 v14, 8, v14
    v_lshrrev_b32 v13, 2, v114
    v_or_b32 v110, v12, v11
    v_bitop3_b32 v114, v5, v13, v14 bitop3:0xea
    ds_add_u32 v114, v2
    v_mul_hi_u32_u24 v14, 429497, v111
    v_lshrrev_b32 v12, 3, v115
    v_cos_f32 v10, v10
    v_lshlrev_b16 v13, 3, v115
    v_mad_i32_i24 v11, v14, s55, v111
    v_bitop3_b32 v12, v6, v13, v12 bitop3:0xca
    v_add_lshl_u32 v11, v11, s40, 17
    v_lshlrev_b16 v14, 8, v14
    v_lshrrev_b32 v13, 2, v115
    v_or_b32 v111, v12, v11
    v_bitop3_b32 v115, v5, v13, v14 bitop3:0xea
    ds_add_u32 v115, v2
    v_cvt_pk_bf16_f32 v107, v9, v10
    v_perm_b32 v12, v107, v107, s41
    v_bitop3_b32 v110, v4, v12, v110 bitop3:0xca
    v_perm_b32 v13, v107, v107, s42
    v_bitop3_b32 v111, v4, v13, v111 bitop3:0xca
    s_waitcnt vmcnt(18)
    v_lshlrev_b32 v7, 16, v124
    v_and_b32 v8, 0xffff0000, v124
    v_lshlrev_b32 v9, 16, v125
    v_and_b32 v10, 0xffff0000, v125
    v_mul_f32 v7, 0.15915494, v7
    v_mul_f32 v8, 0.15915494, v8
    v_mul_f32 v9, 0.15915494, v9
    v_mul_f32 v10, 0.15915494, v10
    v_mul_hi_u32_u24 v14, 429497, v116
    v_lshrrev_b32 v12, 3, v120
    v_cos_f32 v7, v7
    v_lshlrev_b16 v13, 3, v120
    v_mad_i32_i24 v11, v14, s55, v116
    v_bitop3_b32 v12, v6, v13, v12 bitop3:0xca
    v_add_lshl_u32 v11, v11, s40, 17
    v_lshlrev_b16 v14, 8, v14
    v_lshrrev_b32 v13, 2, v120
    v_or_b32 v116, v12, v11
    v_bitop3_b32 v120, v5, v13, v14 bitop3:0xea
    ds_add_u32 v120, v2
    v_mul_hi_u32_u24 v14, 429497, v117
    v_lshrrev_b32 v12, 3, v121
    v_cos_f32 v8, v8
    v_lshlrev_b16 v13, 3, v121
    v_mad_i32_i24 v11, v14, s55, v117
    v_bitop3_b32 v12, v6, v13, v12 bitop3:0xca
    v_add_lshl_u32 v11, v11, s40, 17
    v_lshlrev_b16 v14, 8, v14
    v_lshrrev_b32 v13, 2, v121
    v_or_b32 v117, v12, v11
    v_bitop3_b32 v121, v5, v13, v14 bitop3:0xea
    ds_add_u32 v121, v2
    v_cvt_pk_bf16_f32 v124, v7, v8
    v_perm_b32 v12, v124, v124, s41
    v_bitop3_b32 v116, v4, v12, v116 bitop3:0xca
    v_perm_b32 v13, v124, v124, s42
    v_bitop3_b32 v117, v4, v13, v117 bitop3:0xca
    v_mul_hi_u32_u24 v14, 429497, v118
    v_lshrrev_b32 v12, 3, v122
    v_cos_f32 v9, v9
    v_lshlrev_b16 v13, 3, v122
    v_mad_i32_i24 v11, v14, s55, v118
    v_bitop3_b32 v12, v6, v13, v12 bitop3:0xca
    v_add_lshl_u32 v11, v11, s40, 17
    v_lshlrev_b16 v14, 8, v14
    v_lshrrev_b32 v13, 2, v122
    v_or_b32 v118, v12, v11
    v_bitop3_b32 v122, v5, v13, v14 bitop3:0xea
    ds_add_u32 v122, v2
    v_mul_hi_u32_u24 v14, 429497, v119
    v_lshrrev_b32 v12, 3, v123
    v_cos_f32 v10, v10
    v_lshlrev_b16 v13, 3, v123
    v_mad_i32_i24 v11, v14, s55, v119
    v_bitop3_b32 v12, v6, v13, v12 bitop3:0xca
    v_add_lshl_u32 v11, v11, s40, 17
    v_lshlrev_b16 v14, 8, v14
    v_lshrrev_b32 v13, 2, v123
    v_or_b32 v119, v12, v11
    v_bitop3_b32 v123, v5, v13, v14 bitop3:0xea
    ds_add_u32 v123, v2
    v_cvt_pk_bf16_f32 v125, v9, v10
    v_perm_b32 v12, v125, v125, s41
    v_bitop3_b32 v118, v4, v12, v118 bitop3:0xca
    v_perm_b32 v13, v125, v125, s42
    v_bitop3_b32 v119, v4, v13, v119 bitop3:0xca
    s_add_u32 s45, s35, 0xc000
    buffer_store_dwordx4 v[72:75], v0, s[20:23], s45 offen sc1
    s_add_u32 s46, s33, 0x4000000
    s_nop 0
    buffer_load_dwordx4 v[72:75], v0, s[12:15], s46 offen nt
    s_waitcnt vmcnt(18)
    v_lshlrev_b32 v7, 16, v126
    v_and_b32 v8, 0xffff0000, v126
    v_lshlrev_b32 v9, 16, v127
    v_and_b32 v10, 0xffff0000, v127
    v_mul_f32 v7, 0.15915494, v7
    v_mul_f32 v8, 0.15915494, v8
    v_mul_f32 v9, 0.15915494, v9
    v_mul_f32 v10, 0.15915494, v10
    v_mul_hi_u32_u24 v14, 429497, v16
    v_lshrrev_b32 v12, 3, v20
    v_cos_f32 v7, v7
    v_lshlrev_b16 v13, 3, v20
    v_mad_i32_i24 v11, v14, s55, v16
    v_bitop3_b32 v12, v6, v13, v12 bitop3:0xca
    v_add_lshl_u32 v11, v11, s40, 17
    v_lshlrev_b16 v14, 8, v14
    v_lshrrev_b32 v13, 2, v20
    v_or_b32 v16, v12, v11
    v_bitop3_b32 v20, v5, v13, v14 bitop3:0xea
    ds_add_u32 v20, v2
    v_mul_hi_u32_u24 v14, 429497, v17
    v_lshrrev_b32 v12, 3, v21
    v_cos_f32 v8, v8
    v_lshlrev_b16 v13, 3, v21
    v_mad_i32_i24 v11, v14, s55, v17
    v_bitop3_b32 v12, v6, v13, v12 bitop3:0xca
    v_add_lshl_u32 v11, v11, s40, 17
    v_lshlrev_b16 v14, 8, v14
    v_lshrrev_b32 v13, 2, v21
    v_or_b32 v17, v12, v11
    v_bitop3_b32 v21, v5, v13, v14 bitop3:0xea
    ds_add_u32 v21, v2
    v_cvt_pk_bf16_f32 v126, v7, v8
    v_perm_b32 v12, v126, v126, s41
    v_bitop3_b32 v16, v4, v12, v16 bitop3:0xca
    v_perm_b32 v13, v126, v126, s42
    v_bitop3_b32 v17, v4, v13, v17 bitop3:0xca
    v_mul_hi_u32_u24 v14, 429497, v18
    v_lshrrev_b32 v12, 3, v22
    v_cos_f32 v9, v9
    v_lshlrev_b16 v13, 3, v22
    v_mad_i32_i24 v11, v14, s55, v18
    v_bitop3_b32 v12, v6, v13, v12 bitop3:0xca
    v_add_lshl_u32 v11, v11, s40, 17
    v_lshlrev_b16 v14, 8, v14
    v_lshrrev_b32 v13, 2, v22
    v_or_b32 v18, v12, v11
    v_bitop3_b32 v22, v5, v13, v14 bitop3:0xea
    ds_add_u32 v22, v2
    v_mul_hi_u32_u24 v14, 429497, v19
    v_lshrrev_b32 v12, 3, v23
    v_cos_f32 v10, v10
    v_lshlrev_b16 v13, 3, v23
    v_mad_i32_i24 v11, v14, s55, v19
    v_bitop3_b32 v12, v6, v13, v12 bitop3:0xca
    v_add_lshl_u32 v11, v11, s40, 17
    v_lshlrev_b16 v14, 8, v14
    v_lshrrev_b32 v13, 2, v23
    v_or_b32 v19, v12, v11
    v_bitop3_b32 v23, v5, v13, v14 bitop3:0xea
    ds_add_u32 v23, v2
    v_cvt_pk_bf16_f32 v127, v9, v10
    v_perm_b32 v12, v127, v127, s41
    v_bitop3_b32 v18, v4, v12, v18 bitop3:0xca
    v_perm_b32 v13, v127, v127, s42
    v_bitop3_b32 v19, v4, v13, v19 bitop3:0xca
    s_waitcnt vmcnt(14)
    v_lshlrev_b32 v7, 16, v24
    v_and_b32 v8, 0xffff0000, v24
    v_lshlrev_b32 v9, 16, v25
    v_and_b32 v10, 0xffff0000, v25
    v_mul_f32 v7, 0.15915494, v7
    v_mul_f32 v8, 0.15915494, v8
    v_mul_f32 v9, 0.15915494, v9
    v_mul_f32 v10, 0.15915494, v10
    v_mul_hi_u32_u24 v14, 429497, v28
    v_lshrrev_b32 v12, 3, v32
    v_cos_f32 v7, v7
    v_lshlrev_b16 v13, 3, v32
    v_mad_i32_i24 v11, v14, s55, v28
    v_bitop3_b32 v12, v6, v13, v12 bitop3:0xca
    v_add_lshl_u32 v11, v11, s40, 17
    v_lshlrev_b16 v14, 8, v14
    v_lshrrev_b32 v13, 2, v32
    v_or_b32 v28, v12, v11
    v_bitop3_b32 v32, v5, v13, v14 bitop3:0xea
    ds_add_u32 v32, v2
    v_mul_hi_u32_u24 v14, 429497, v29
    v_lshrrev_b32 v12, 3, v33
    v_cos_f32 v8, v8
    v_lshlrev_b16 v13, 3, v33
    v_mad_i32_i24 v11, v14, s55, v29
    v_bitop3_b32 v12, v6, v13, v12 bitop3:0xca
    v_add_lshl_u32 v11, v11, s40, 17
    v_lshlrev_b16 v14, 8, v14
    v_lshrrev_b32 v13, 2, v33
    v_or_b32 v29, v12, v11
    v_bitop3_b32 v33, v5, v13, v14 bitop3:0xea
    ds_add_u32 v33, v2
    v_cvt_pk_bf16_f32 v24, v7, v8
    v_perm_b32 v12, v24, v24, s41
    v_bitop3_b32 v28, v4, v12, v28 bitop3:0xca
    v_perm_b32 v13, v24, v24, s42
    v_bitop3_b32 v29, v4, v13, v29 bitop3:0xca
    v_mul_hi_u32_u24 v14, 429497, v30
    v_lshrrev_b32 v12, 3, v34
    v_cos_f32 v9, v9
    v_lshlrev_b16 v13, 3, v34
    v_mad_i32_i24 v11, v14, s55, v30
    v_bitop3_b32 v12, v6, v13, v12 bitop3:0xca
    v_add_lshl_u32 v11, v11, s40, 17
    v_lshlrev_b16 v14, 8, v14
    v_lshrrev_b32 v13, 2, v34
    v_or_b32 v30, v12, v11
    v_bitop3_b32 v34, v5, v13, v14 bitop3:0xea
    ds_add_u32 v34, v2
    v_mul_hi_u32_u24 v14, 429497, v31
    v_lshrrev_b32 v12, 3, v35
    v_cos_f32 v10, v10
    v_lshlrev_b16 v13, 3, v35
    v_mad_i32_i24 v11, v14, s55, v31
    v_bitop3_b32 v12, v6, v13, v12 bitop3:0xca
    v_add_lshl_u32 v11, v11, s40, 17
    v_lshlrev_b16 v14, 8, v14
    v_lshrrev_b32 v13, 2, v35
    v_or_b32 v31, v12, v11
    v_bitop3_b32 v35, v5, v13, v14 bitop3:0xea
    ds_add_u32 v35, v2
    v_cvt_pk_bf16_f32 v25, v9, v10
    v_perm_b32 v12, v25, v25, s41
    v_bitop3_b32 v30, v4, v12, v30 bitop3:0xca
    v_perm_b32 v13, v25, v25, s42
    v_bitop3_b32 v31, v4, v13, v31 bitop3:0xca
    s_add_u32 s47, s35, 0x10000
    buffer_store_dwordx4 v[64:67], v0, s[20:23], s47 offen sc1
    s_add_u32 s44, s34, 0x2000000
    s_nop 0
    buffer_load_dwordx2 v[64:65], v1, s[16:19], s44 offen nt
    s_add_u32 s45, s34, 0x2002000
    buffer_load_dwordx2 v[66:67], v1, s[16:19], s45 offen nt
    s_waitcnt vmcnt(15)
    v_lshlrev_b32 v7, 16, v26
    v_and_b32 v8, 0xffff0000, v26
    v_lshlrev_b32 v9, 16, v27
    v_and_b32 v10, 0xffff0000, v27
    v_mul_f32 v7, 0.15915494, v7
    v_mul_f32 v8, 0.15915494, v8
    v_mul_f32 v9, 0.15915494, v9
    v_mul_f32 v10, 0.15915494, v10
    v_mul_hi_u32_u24 v14, 429497, v36
    v_lshrrev_b32 v12, 3, v40
    v_cos_f32 v7, v7
    v_lshlrev_b16 v13, 3, v40
    v_mad_i32_i24 v11, v14, s55, v36
    v_bitop3_b32 v12, v6, v13, v12 bitop3:0xca
    v_add_lshl_u32 v11, v11, s40, 17
    v_lshlrev_b16 v14, 8, v14
    v_lshrrev_b32 v13, 2, v40
    v_or_b32 v36, v12, v11
    v_bitop3_b32 v40, v5, v13, v14 bitop3:0xea
    ds_add_u32 v40, v2
    v_mul_hi_u32_u24 v14, 429497, v37
    v_lshrrev_b32 v12, 3, v41
    v_cos_f32 v8, v8
    v_lshlrev_b16 v13, 3, v41
    v_mad_i32_i24 v11, v14, s55, v37
    v_bitop3_b32 v12, v6, v13, v12 bitop3:0xca
    v_add_lshl_u32 v11, v11, s40, 17
    v_lshlrev_b16 v14, 8, v14
    v_lshrrev_b32 v13, 2, v41
    v_or_b32 v37, v12, v11
    v_bitop3_b32 v41, v5, v13, v14 bitop3:0xea
    ds_add_u32 v41, v2
    v_cvt_pk_bf16_f32 v26, v7, v8
    v_perm_b32 v12, v26, v26, s41
    v_bitop3_b32 v36, v4, v12, v36 bitop3:0xca
    v_perm_b32 v13, v26, v26, s42
    v_bitop3_b32 v37, v4, v13, v37 bitop3:0xca
    v_mul_hi_u32_u24 v14, 429497, v38
    v_lshrrev_b32 v12, 3, v42
    v_cos_f32 v9, v9
    v_lshlrev_b16 v13, 3, v42
    v_mad_i32_i24 v11, v14, s55, v38
    v_bitop3_b32 v12, v6, v13, v12 bitop3:0xca
    v_add_lshl_u32 v11, v11, s40, 17
    v_lshlrev_b16 v14, 8, v14
    v_lshrrev_b32 v13, 2, v42
    v_or_b32 v38, v12, v11
    v_bitop3_b32 v42, v5, v13, v14 bitop3:0xea
    ds_add_u32 v42, v2
    v_mul_hi_u32_u24 v14, 429497, v39
    v_lshrrev_b32 v12, 3, v43
    v_cos_f32 v10, v10
    v_lshlrev_b16 v13, 3, v43
    v_mad_i32_i24 v11, v14, s55, v39
    v_bitop3_b32 v12, v6, v13, v12 bitop3:0xca
    v_add_lshl_u32 v11, v11, s40, 17
    v_lshlrev_b16 v14, 8, v14
    v_lshrrev_b32 v13, 2, v43
    v_or_b32 v39, v12, v11
    v_bitop3_b32 v43, v5, v13, v14 bitop3:0xea
    ds_add_u32 v43, v2
    v_cvt_pk_bf16_f32 v27, v9, v10
    v_perm_b32 v12, v27, v27, s41
    v_bitop3_b32 v38, v4, v12, v38 bitop3:0xca
    v_perm_b32 v13, v27, v27, s42
    v_bitop3_b32 v39, v4, v13, v39 bitop3:0xca
    s_waitcnt vmcnt(11)
    v_lshlrev_b32 v7, 16, v44
    v_and_b32 v8, 0xffff0000, v44
    v_lshlrev_b32 v9, 16, v45
    v_and_b32 v10, 0xffff0000, v45
    v_mul_f32 v7, 0.15915494, v7
    v_mul_f32 v8, 0.15915494, v8
    v_mul_f32 v9, 0.15915494, v9
    v_mul_f32 v10, 0.15915494, v10
    v_mul_hi_u32_u24 v14, 429497, v48
    v_lshrrev_b32 v12, 3, v52
    v_cos_f32 v7, v7
    v_lshlrev_b16 v13, 3, v52
    v_mad_i32_i24 v11, v14, s55, v48
    v_bitop3_b32 v12, v6, v13, v12 bitop3:0xca
    v_add_lshl_u32 v11, v11, s40, 17
    v_lshlrev_b16 v14, 8, v14
    v_lshrrev_b32 v13, 2, v52
    v_or_b32 v48, v12, v11
    v_bitop3_b32 v52, v5, v13, v14 bitop3:0xea
    ds_add_u32 v52, v2
    v_mul_hi_u32_u24 v14, 429497, v49
    v_lshrrev_b32 v12, 3, v53
    v_cos_f32 v8, v8
    v_lshlrev_b16 v13, 3, v53
    v_mad_i32_i24 v11, v14, s55, v49
    v_bitop3_b32 v12, v6, v13, v12 bitop3:0xca
    v_add_lshl_u32 v11, v11, s40, 17
    v_lshlrev_b16 v14, 8, v14
    v_lshrrev_b32 v13, 2, v53
    v_or_b32 v49, v12, v11
    v_bitop3_b32 v53, v5, v13, v14 bitop3:0xea
    ds_add_u32 v53, v2
    v_cvt_pk_bf16_f32 v44, v7, v8
    v_perm_b32 v12, v44, v44, s41
    v_bitop3_b32 v48, v4, v12, v48 bitop3:0xca
    v_perm_b32 v13, v44, v44, s42
    v_bitop3_b32 v49, v4, v13, v49 bitop3:0xca
    v_mul_hi_u32_u24 v14, 429497, v50
    v_lshrrev_b32 v12, 3, v54
    v_cos_f32 v9, v9
    v_lshlrev_b16 v13, 3, v54
    v_mad_i32_i24 v11, v14, s55, v50
    v_bitop3_b32 v12, v6, v13, v12 bitop3:0xca
    v_add_lshl_u32 v11, v11, s40, 17
    v_lshlrev_b16 v14, 8, v14
    v_lshrrev_b32 v13, 2, v54
    v_or_b32 v50, v12, v11
    v_bitop3_b32 v54, v5, v13, v14 bitop3:0xea
    ds_add_u32 v54, v2
    v_mul_hi_u32_u24 v14, 429497, v51
    v_lshrrev_b32 v12, 3, v55
    v_cos_f32 v10, v10
    v_lshlrev_b16 v13, 3, v55
    v_mad_i32_i24 v11, v14, s55, v51
    v_bitop3_b32 v12, v6, v13, v12 bitop3:0xca
    v_add_lshl_u32 v11, v11, s40, 17
    v_lshlrev_b16 v14, 8, v14
    v_lshrrev_b32 v13, 2, v55
    v_or_b32 v51, v12, v11
    v_bitop3_b32 v55, v5, v13, v14 bitop3:0xea
    ds_add_u32 v55, v2
    v_cvt_pk_bf16_f32 v45, v9, v10
    v_perm_b32 v12, v45, v45, s41
    v_bitop3_b32 v50, v4, v12, v50 bitop3:0xca
    v_perm_b32 v13, v45, v45, s42
    v_bitop3_b32 v51, v4, v13, v51 bitop3:0xca
    s_add_u32 s46, s35, 0x14000
    buffer_store_dwordx4 v[76:79], v0, s[20:23], s46 offen sc1
    s_add_u32 s47, s33, 0x4004000
    s_nop 0
    buffer_load_dwordx4 v[76:79], v0, s[8:11], s47 offen nt
    s_waitcnt vmcnt(9)
    v_lshlrev_b32 v7, 16, v46
    v_and_b32 v8, 0xffff0000, v46
    v_lshlrev_b32 v9, 16, v47
    v_and_b32 v10, 0xffff0000, v47
    v_mul_f32 v7, 0.15915494, v7
    v_mul_f32 v8, 0.15915494, v8
    v_mul_f32 v9, 0.15915494, v9
    v_mul_f32 v10, 0.15915494, v10
    v_mul_hi_u32_u24 v14, 429497, v56
    v_lshrrev_b32 v12, 3, v60
    v_cos_f32 v7, v7
    v_lshlrev_b16 v13, 3, v60
    v_mad_i32_i24 v11, v14, s55, v56
    v_bitop3_b32 v12, v6, v13, v12 bitop3:0xca
    v_add_lshl_u32 v11, v11, s40, 17
    v_lshlrev_b16 v14, 8, v14
    v_lshrrev_b32 v13, 2, v60
    v_or_b32 v56, v12, v11
    v_bitop3_b32 v60, v5, v13, v14 bitop3:0xea
    ds_add_u32 v60, v2
    v_mul_hi_u32_u24 v14, 429497, v57
    v_lshrrev_b32 v12, 3, v61
    v_cos_f32 v8, v8
    v_lshlrev_b16 v13, 3, v61
    v_mad_i32_i24 v11, v14, s55, v57
    v_bitop3_b32 v12, v6, v13, v12 bitop3:0xca
    v_add_lshl_u32 v11, v11, s40, 17
    v_lshlrev_b16 v14, 8, v14
    v_lshrrev_b32 v13, 2, v61
    v_or_b32 v57, v12, v11
    v_bitop3_b32 v61, v5, v13, v14 bitop3:0xea
    ds_add_u32 v61, v2
    v_cvt_pk_bf16_f32 v46, v7, v8
    v_perm_b32 v12, v46, v46, s41
    v_bitop3_b32 v56, v4, v12, v56 bitop3:0xca
    v_perm_b32 v13, v46, v46, s42
    v_bitop3_b32 v57, v4, v13, v57 bitop3:0xca
    v_mul_hi_u32_u24 v14, 429497, v58
    v_lshrrev_b32 v12, 3, v62
    v_cos_f32 v9, v9
    v_lshlrev_b16 v13, 3, v62
    v_mad_i32_i24 v11, v14, s55, v58
    v_bitop3_b32 v12, v6, v13, v12 bitop3:0xca
    v_add_lshl_u32 v11, v11, s40, 17
    v_lshlrev_b16 v14, 8, v14
    v_lshrrev_b32 v13, 2, v62
    v_or_b32 v58, v12, v11
    v_bitop3_b32 v62, v5, v13, v14 bitop3:0xea
    ds_add_u32 v62, v2
    v_mul_hi_u32_u24 v14, 429497, v59
    v_lshrrev_b32 v12, 3, v63
    v_cos_f32 v10, v10
    v_lshlrev_b16 v13, 3, v63
    v_mad_i32_i24 v11, v14, s55, v59
    v_bitop3_b32 v12, v6, v13, v12 bitop3:0xca
    v_add_lshl_u32 v11, v11, s40, 17
    v_lshlrev_b16 v14, 8, v14
    v_lshrrev_b32 v13, 2, v63
    v_or_b32 v59, v12, v11
    v_bitop3_b32 v63, v5, v13, v14 bitop3:0xea
    ds_add_u32 v63, v2
    v_cvt_pk_bf16_f32 v47, v9, v10
    v_perm_b32 v12, v47, v47, s41
    v_bitop3_b32 v58, v4, v12, v58 bitop3:0xca
    v_perm_b32 v13, v47, v47, s42
    v_bitop3_b32 v59, v4, v13, v59 bitop3:0xca
    v_lshrrev_b32 v8, 2, v0
    v_and_b32 v7, 0x3c00, v0
    v_bitop3_b32 v7, v5, v8, v7 bitop3:0xea
    s_waitcnt lgkmcnt(0)
    s_barrier
    ds_read2st64_b32 v[8:9], v7 offset0:0 offset1:1
    ds_read2st64_b32 v[10:11], v7 offset0:2 offset1:3
    s_add_u32 s44, s35, 0x18000
    buffer_store_dwordx4 v[80:83], v0, s[20:23], s44 offen sc1
    s_add_u32 s45, s33, 0x4004000
    s_nop 0
    buffer_load_dwordx4 v[80:83], v0, s[12:15], s45 offen nt
    s_waitcnt lgkmcnt(0)
    v_lshl_or_b32 v12, v9, 16, v8
    v_lshl_or_b32 v13, v11, 16, v10
    v_mov_b32 v14, v12
    v_mov_b32 v15, v13
    s_nop 0
    v_add_u32_dpp v14, v14, v14 row_shr:1 row_mask:0xf bank_mask:0xf bound_ctrl:1
    v_add_u32_dpp v15, v15, v15 row_shr:1 row_mask:0xf bank_mask:0xf bound_ctrl:1
    s_nop 0
    v_add_u32_dpp v14, v14, v14 row_shr:2 row_mask:0xf bank_mask:0xf bound_ctrl:1
    v_add_u32_dpp v15, v15, v15 row_shr:2 row_mask:0xf bank_mask:0xf bound_ctrl:1
    s_nop 0
    v_add_u32_dpp v14, v14, v14 row_shr:4 row_mask:0xf bank_mask:0xf bound_ctrl:1
    v_add_u32_dpp v15, v15, v15 row_shr:4 row_mask:0xf bank_mask:0xf bound_ctrl:1
    s_nop 0
    v_add_u32_dpp v14, v14, v14 row_shr:8 row_mask:0xf bank_mask:0xf bound_ctrl:1
    v_add_u32_dpp v15, v15, v15 row_shr:8 row_mask:0xf bank_mask:0xf bound_ctrl:1
    s_nop 0
    v_add_u32_dpp v14, v14, v14 row_bcast:15 row_mask:0xa bank_mask:0xf
    v_add_u32_dpp v15, v15, v15 row_bcast:15 row_mask:0xa bank_mask:0xf
    s_nop 0
    v_add_u32_dpp v14, v14, v14 row_bcast:31 row_mask:0xc bank_mask:0xf
    v_add_u32_dpp v15, v15, v15 row_bcast:31 row_mask:0xc bank_mask:0xf
    v_readlane_b32 s48, v14, 63
    v_readlane_b32 s49, v15, 63
    s_lshl_b32 s54, s32, 2
    v_mov_b32 v8, s54
    s_and_b32 s50, s48, 0xffff
    s_lshr_b32 s51, s48, 16
    s_and_b32 s52, s49, 0xffff
    s_lshr_b32 s53, s49, 16
    s_add_u32 s51, s51, s50
    s_add_u32 s52, s52, s51
    s_add_u32 s53, s53, s52
    v_mov_b32 v9, s53
    s_mov_b64 exec, 1
    ds_write_b32 v8, v9 offset:16384
    s_mov_b64 exec, -1
    v_and_b32 v8, 60, v7
    s_waitcnt lgkmcnt(0)
    s_barrier
    ds_read_b32 v9, v8 offset:16384
    s_waitcnt lgkmcnt(0)
    v_add_u32_dpp v9, v9, v9 row_shr:1 row_mask:0xf bank_mask:0xf bound_ctrl:1
    s_nop 1
    v_add_u32_dpp v9, v9, v9 row_shr:2 row_mask:0xf bank_mask:0xf bound_ctrl:1
    s_nop 1
    v_add_u32_dpp v9, v9, v9 row_shr:4 row_mask:0xf bank_mask:0xf bound_ctrl:1
    s_nop 1
    v_add_u32_dpp v9, v9, v9 row_shr:8 row_mask:0xf bank_mask:0xf bound_ctrl:1
    s_nop 0
    v_readlane_b32 s54, v9, s32
    s_sub_u32 s54, s54, s53
    s_add_u32 s50, s50, s54
    s_add_u32 s51, s51, s54
    s_add_u32 s52, s52, s54
    s_pack_ll_b32_b16 s48, s54, s50
    s_pack_ll_b32_b16 s49, s51, s52
    v_add_u32 v14, s48, v14
    v_add_u32 v15, s49, v15
    v_sub_u32 v12, v14, v12
    v_sub_u32 v13, v15, v13
    v_and_b32 v8, 0xffff, v12
    v_lshrrev_b32 v9, 16, v12
    v_and_b32 v10, 0xffff, v13
    v_lshrrev_b32 v11, 16, v13
    ds_write2st64_b32 v7, v8, v9 offset0:0 offset1:1
    ds_write2st64_b32 v7, v10, v11 offset0:2 offset1:3
    s_waitcnt lgkmcnt(0)
    s_barrier
    ds_add_rtn_u32 v100, v100, v2
    ds_add_rtn_u32 v101, v101, v2
    ds_add_rtn_u32 v102, v102, v2
    ds_add_rtn_u32 v103, v103, v2
    s_add_u32 s46, s36, 0x2a40000
    v_and_b32 v11, 0x3f0, v0
    v_add_u32 v11, v11, v11
    buffer_store_dwordx2 v[12:13], v11, s[24:27], s46 offen
    s_bitset0_b64 exec, 63
    s_not_b64 exec, exec
    buffer_store_dwordx2 v[14:15], v11, s[24:27], s46 offen offset:32
    s_mov_b64 exec, -1
    ds_add_rtn_u32 v112, v112, v2
    ds_add_rtn_u32 v113, v113, v2
    ds_add_rtn_u32 v114, v114, v2
    ds_add_rtn_u32 v115, v115, v2
    ds_add_rtn_u32 v120, v120, v2
    ds_add_rtn_u32 v121, v121, v2
    ds_add_rtn_u32 v122, v122, v2
    ds_add_rtn_u32 v123, v123, v2
    s_add_u32 s47, s35, 0x1c000
    buffer_store_dwordx4 v[88:91], v0, s[20:23], s47 offen sc1
    s_add_u32 s44, s33, 0x4008000
    s_nop 0
    buffer_load_dwordx4 v[88:91], v0, s[8:11], s44 offen nt
    ds_add_rtn_u32 v20, v20, v2
    ds_add_rtn_u32 v21, v21, v2
    ds_add_rtn_u32 v22, v22, v2
    ds_add_rtn_u32 v23, v23, v2
    ds_add_rtn_u32 v32, v32, v2
    ds_add_rtn_u32 v33, v33, v2
    ds_add_rtn_u32 v34, v34, v2
    ds_add_rtn_u32 v35, v35, v2
    s_add_u32 s45, s35, 0x20000
    buffer_store_dwordx4 v[92:95], v0, s[20:23], s45 offen sc1
    s_add_u32 s46, s33, 0x4008000
    s_nop 0
    buffer_load_dwordx4 v[92:95], v0, s[12:15], s46 offen nt
    ds_add_rtn_u32 v40, v40, v2
    ds_add_rtn_u32 v41, v41, v2
    ds_add_rtn_u32 v42, v42, v2
    ds_add_rtn_u32 v43, v43, v2
    ds_add_rtn_u32 v52, v52, v2
    ds_add_rtn_u32 v53, v53, v2
    ds_add_rtn_u32 v54, v54, v2
    ds_add_rtn_u32 v55, v55, v2
    s_add_u32 s47, s35, 0x24000
    buffer_store_dwordx4 v[84:87], v0, s[20:23], s47 offen sc1
    s_add_u32 s44, s34, 0x2004000
    s_nop 0
    buffer_load_dwordx2 v[84:85], v1, s[16:19], s44 offen nt
    s_add_u32 s45, s34, 0x2006000
    buffer_load_dwordx2 v[86:87], v1, s[16:19], s45 offen nt
    ds_add_rtn_u32 v60, v60, v2
    ds_add_rtn_u32 v61, v61, v2
    ds_add_rtn_u32 v62, v62, v2
    ds_add_rtn_u32 v63, v63, v2
    s_waitcnt lgkmcnt(0)
    s_barrier
    v_and_b32 v7, -4, v100
    v_lshl_add_u32 v8, v100, 2, v7
    ds_write_b32 v8, v96
    v_lshl_add_u32 v7, v7, 2, v100
    ds_write_b8 v7, v104 offset:16
    v_and_b32 v9, -4, v101
    v_lshl_add_u32 v10, v101, 2, v9
    ds_write_b32 v10, v97
    v_lshl_add_u32 v9, v9, 2, v101
    ds_write_b8_d16_hi v9, v104 offset:16
    v_and_b32 v7, -4, v102
    v_lshl_add_u32 v8, v102, 2, v7
    ds_write_b32 v8, v98
    v_lshl_add_u32 v7, v7, 2, v102
    ds_write_b8 v7, v105 offset:16
    v_and_b32 v9, -4, v103
    v_lshl_add_u32 v10, v103, 2, v9
    ds_write_b32 v10, v99
    v_lshl_add_u32 v9, v9, 2, v103
    ds_write_b8_d16_hi v9, v105 offset:16
    s_add_u32 s46, s33, 0x400c000
    buffer_load_dwordx4 v[96:99], v0, s[8:11], s46 offen nt
    s_add_u32 s47, s33, 0x400c000
    buffer_load_dwordx4 v[100:103], v0, s[12:15], s47 offen nt
    v_and_b32 v7, -4, v112
    v_lshl_add_u32 v8, v112, 2, v7
    ds_write_b32 v8, v108
    v_lshl_add_u32 v7, v7, 2, v112
    ds_write_b8 v7, v106 offset:16
    v_and_b32 v9, -4, v113
    v_lshl_add_u32 v10, v113, 2, v9
    ds_write_b32 v10, v109
    v_lshl_add_u32 v9, v9, 2, v113
    ds_write_b8_d16_hi v9, v106 offset:16
    v_and_b32 v7, -4, v114
    v_lshl_add_u32 v8, v114, 2, v7
    ds_write_b32 v8, v110
    v_lshl_add_u32 v7, v7, 2, v114
    ds_write_b8 v7, v107 offset:16
    v_and_b32 v9, -4, v115
    v_lshl_add_u32 v10, v115, 2, v9
    ds_write_b32 v10, v111
    v_lshl_add_u32 v9, v9, 2, v115
    ds_write_b8_d16_hi v9, v107 offset:16
    s_add_u32 s44, s33, 0x4010000
    buffer_load_dwordx4 v[108:111], v0, s[8:11], s44 offen nt
    v_and_b32 v7, -4, v120
    v_lshl_add_u32 v8, v120, 2, v7
    ds_write_b32 v8, v116
    v_lshl_add_u32 v7, v7, 2, v120
    ds_write_b8 v7, v124 offset:16
    v_and_b32 v9, -4, v121
    v_lshl_add_u32 v10, v121, 2, v9
    ds_write_b32 v10, v117
    v_lshl_add_u32 v9, v9, 2, v121
    ds_write_b8_d16_hi v9, v124 offset:16
    v_and_b32 v7, -4, v122
    v_lshl_add_u32 v8, v122, 2, v7
    ds_write_b32 v8, v118
    v_lshl_add_u32 v7, v7, 2, v122
    ds_write_b8 v7, v125 offset:16
    v_and_b32 v9, -4, v123
    v_lshl_add_u32 v10, v123, 2, v9
    ds_write_b32 v10, v119
    v_lshl_add_u32 v9, v9, 2, v123
    ds_write_b8_d16_hi v9, v125 offset:16
    s_add_u32 s45, s33, 0x4010000
    buffer_load_dwordx4 v[112:115], v0, s[12:15], s45 offen nt
    v_and_b32 v7, -4, v20
    v_lshl_add_u32 v8, v20, 2, v7
    ds_write_b32 v8, v16
    v_lshl_add_u32 v7, v7, 2, v20
    ds_write_b8 v7, v126 offset:16
    v_and_b32 v9, -4, v21
    v_lshl_add_u32 v10, v21, 2, v9
    ds_write_b32 v10, v17
    v_lshl_add_u32 v9, v9, 2, v21
    ds_write_b8_d16_hi v9, v126 offset:16
    v_and_b32 v7, -4, v22
    v_lshl_add_u32 v8, v22, 2, v7
    ds_write_b32 v8, v18
    v_lshl_add_u32 v7, v7, 2, v22
    ds_write_b8 v7, v127 offset:16
    v_and_b32 v9, -4, v23
    v_lshl_add_u32 v10, v23, 2, v9
    ds_write_b32 v10, v19
    v_lshl_add_u32 v9, v9, 2, v23
    ds_write_b8_d16_hi v9, v127 offset:16
    s_add_u32 s46, s34, 0x2008000
    buffer_load_dwordx2 v[104:105], v1, s[16:19], s46 offen nt
    s_add_u32 s47, s34, 0x200a000
    buffer_load_dwordx2 v[106:107], v1, s[16:19], s47 offen nt
    v_and_b32 v7, -4, v32
    v_lshl_add_u32 v8, v32, 2, v7
    ds_write_b32 v8, v28
    v_lshl_add_u32 v7, v7, 2, v32
    ds_write_b8 v7, v24 offset:16
    v_and_b32 v9, -4, v33
    v_lshl_add_u32 v10, v33, 2, v9
    ds_write_b32 v10, v29
    v_lshl_add_u32 v9, v9, 2, v33
    ds_write_b8_d16_hi v9, v24 offset:16
    v_and_b32 v7, -4, v34
    v_lshl_add_u32 v8, v34, 2, v7
    ds_write_b32 v8, v30
    v_lshl_add_u32 v7, v7, 2, v34
    ds_write_b8 v7, v25 offset:16
    v_and_b32 v9, -4, v35
    v_lshl_add_u32 v10, v35, 2, v9
    ds_write_b32 v10, v31
    v_lshl_add_u32 v9, v9, 2, v35
    ds_write_b8_d16_hi v9, v25 offset:16
    s_add_u32 s44, s33, 0x4014000
    buffer_load_dwordx4 v[116:119], v0, s[8:11], s44 offen nt
    s_add_u32 s45, s33, 0x4014000
    buffer_load_dwordx4 v[120:123], v0, s[12:15], s45 offen nt
    v_and_b32 v7, -4, v40
    v_lshl_add_u32 v8, v40, 2, v7
    ds_write_b32 v8, v36
    v_lshl_add_u32 v7, v7, 2, v40
    ds_write_b8 v7, v26 offset:16
    v_and_b32 v9, -4, v41
    v_lshl_add_u32 v10, v41, 2, v9
    ds_write_b32 v10, v37
    v_lshl_add_u32 v9, v9, 2, v41
    ds_write_b8_d16_hi v9, v26 offset:16
    v_and_b32 v7, -4, v42
    v_lshl_add_u32 v8, v42, 2, v7
    ds_write_b32 v8, v38
    v_lshl_add_u32 v7, v7, 2, v42
    ds_write_b8 v7, v27 offset:16
    v_and_b32 v9, -4, v43
    v_lshl_add_u32 v10, v43, 2, v9
    ds_write_b32 v10, v39
    v_lshl_add_u32 v9, v9, 2, v43
    ds_write_b8_d16_hi v9, v27 offset:16
    s_add_u32 s46, s33, 0x4018000
    buffer_load_dwordx4 v[16:19], v0, s[8:11], s46 offen nt
    v_and_b32 v7, -4, v52
    v_lshl_add_u32 v8, v52, 2, v7
    ds_write_b32 v8, v48
    v_lshl_add_u32 v7, v7, 2, v52
    ds_write_b8 v7, v44 offset:16
    v_and_b32 v9, -4, v53
    v_lshl_add_u32 v10, v53, 2, v9
    ds_write_b32 v10, v49
    v_lshl_add_u32 v9, v9, 2, v53
    ds_write_b8_d16_hi v9, v44 offset:16
    v_and_b32 v7, -4, v54
    v_lshl_add_u32 v8, v54, 2, v7
    ds_write_b32 v8, v50
    v_lshl_add_u32 v7, v7, 2, v54
    ds_write_b8 v7, v45 offset:16
    v_and_b32 v9, -4, v55
    v_lshl_add_u32 v10, v55, 2, v9
    ds_write_b32 v10, v51
    v_lshl_add_u32 v9, v9, 2, v55
    ds_write_b8_d16_hi v9, v45 offset:16
    s_add_u32 s47, s33, 0x4018000
    buffer_load_dwordx4 v[20:23], v0, s[12:15], s47 offen nt
    v_and_b32 v7, -4, v60
    v_lshl_add_u32 v8, v60, 2, v7
    ds_write_b32 v8, v56
    v_lshl_add_u32 v7, v7, 2, v60
    ds_write_b8 v7, v46 offset:16
    v_and_b32 v9, -4, v61
    v_lshl_add_u32 v10, v61, 2, v9
    ds_write_b32 v10, v57
    v_lshl_add_u32 v9, v9, 2, v61
    ds_write_b8_d16_hi v9, v46 offset:16
    v_and_b32 v7, -4, v62
    v_lshl_add_u32 v8, v62, 2, v7
    ds_write_b32 v8, v58
    v_lshl_add_u32 v7, v7, 2, v62
    ds_write_b8 v7, v47 offset:16
    v_and_b32 v9, -4, v63
    v_lshl_add_u32 v10, v63, 2, v9
    ds_write_b32 v10, v59
    v_lshl_add_u32 v9, v9, 2, v63
    ds_write_b8_d16_hi v9, v47 offset:16
    s_add_u32 s44, s34, 0x200c000
    buffer_load_dwordx2 v[124:125], v1, s[16:19], s44 offen nt
    s_add_u32 s45, s34, 0x200e000
    buffer_load_dwordx2 v[126:127], v1, s[16:19], s45 offen nt
    v_add_u32 v7, 0x10000, v0
    v_add_u32 v12, 0x20000, v0
    v_mov_b32 v8, 0
    v_mov_b32 v9, 0
    v_mov_b32 v10, 0
    v_mov_b32 v11, 0
    s_waitcnt lgkmcnt(0)
    s_barrier
    ds_read_b128 v[28:31], v0 offset:0
    ds_write_b128 v0, v[8:11]
    ds_read_b128 v[32:35], v0 offset:16384
    ds_read_b128 v[36:39], v0 offset:32768
    ds_read_b128 v[40:43], v0 offset:49152
    ds_read_b128 v[24:27], v7 offset:0
    ds_read_b128 v[48:51], v7 offset:16384
    ds_read_b128 v[52:55], v7 offset:32768
    ds_read_b128 v[56:59], v7 offset:49152
    ds_read_b128 v[60:63], v12 offset:0
    ds_read_b128 v[44:47], v12 offset:16384
    s_waitcnt lgkmcnt(0)
    s_barrier
    s_add_u32 s46, s35, 0x2a40000
    buffer_store_dwordx4 v[28:31], v0, s[20:23], s46 offen sc1
    s_add_u32 s47, s33, 0x401c000
    s_nop 0
    buffer_load_dwordx4 v[28:31], v0, s[8:11], s47 offen nt
    s_add_u32 s44, s35, 0x2a44000
    buffer_store_dwordx4 v[32:35], v0, s[20:23], s44 offen sc1
    s_add_u32 s45, s33, 0x401c000
    s_nop 0
    buffer_load_dwordx4 v[32:35], v0, s[12:15], s45 offen nt
    s_waitcnt vmcnt(29)
    v_lshlrev_b32 v7, 16, v64
    v_and_b32 v8, 0xffff0000, v64
    v_lshlrev_b32 v9, 16, v65
    v_and_b32 v10, 0xffff0000, v65
    v_mul_f32 v7, 0.15915494, v7
    v_mul_f32 v8, 0.15915494, v8
    v_mul_f32 v9, 0.15915494, v9
    v_mul_f32 v10, 0.15915494, v10
    v_mul_hi_u32_u24 v14, 429497, v68
    v_lshrrev_b32 v12, 3, v72
    v_cos_f32 v7, v7
    v_lshlrev_b16 v13, 3, v72
    v_mad_i32_i24 v11, v14, s55, v68
    v_bitop3_b32 v12, v6, v13, v12 bitop3:0xca
    v_add_lshl_u32 v11, v11, s40, 17
    v_lshlrev_b16 v14, 8, v14
    v_lshrrev_b32 v13, 2, v72
    v_or_b32 v68, v12, v11
    v_bitop3_b32 v72, v5, v13, v14 bitop3:0xea
    ds_add_u32 v72, v2
    v_mul_hi_u32_u24 v14, 429497, v69
    v_lshrrev_b32 v12, 3, v73
    v_cos_f32 v8, v8
    v_lshlrev_b16 v13, 3, v73
    v_mad_i32_i24 v11, v14, s55, v69
    v_bitop3_b32 v12, v6, v13, v12 bitop3:0xca
    v_add_lshl_u32 v11, v11, s40, 17
    v_lshlrev_b16 v14, 8, v14
    v_lshrrev_b32 v13, 2, v73
    v_or_b32 v69, v12, v11
    v_bitop3_b32 v73, v5, v13, v14 bitop3:0xea
    ds_add_u32 v73, v2
    v_cvt_pk_bf16_f32 v64, v7, v8
    v_perm_b32 v12, v64, v64, s41
    v_bitop3_b32 v68, v4, v12, v68 bitop3:0xca
    v_perm_b32 v13, v64, v64, s42
    v_bitop3_b32 v69, v4, v13, v69 bitop3:0xca
    v_mul_hi_u32_u24 v14, 429497, v70
    v_lshrrev_b32 v12, 3, v74
    v_cos_f32 v9, v9
    v_lshlrev_b16 v13, 3, v74
    v_mad_i32_i24 v11, v14, s55, v70
    v_bitop3_b32 v12, v6, v13, v12 bitop3:0xca
    v_add_lshl_u32 v11, v11, s40, 17
    v_lshlrev_b16 v14, 8, v14
    v_lshrrev_b32 v13, 2, v74
    v_or_b32 v70, v12, v11
    v_bitop3_b32 v74, v5, v13, v14 bitop3:0xea
    ds_add_u32 v74, v2
    v_mul_hi_u32_u24 v14, 429497, v71
    v_lshrrev_b32 v12, 3, v75
    v_cos_f32 v10, v10
    v_lshlrev_b16 v13, 3, v75
    v_mad_i32_i24 v11, v14, s55, v71
    v_bitop3_b32 v12, v6, v13, v12 bitop3:0xca
    v_add_lshl_u32 v11, v11, s40, 17
    v_lshlrev_b16 v14, 8, v14
    v_lshrrev_b32 v13, 2, v75
    v_or_b32 v71, v12, v11
    v_bitop3_b32 v75, v5, v13, v14 bitop3:0xea
    ds_add_u32 v75, v2
    v_cvt_pk_bf16_f32 v65, v9, v10
    v_perm_b32 v12, v65, v65, s41
    v_bitop3_b32 v70, v4, v12, v70 bitop3:0xca
    v_perm_b32 v13, v65, v65, s42
    v_bitop3_b32 v71, v4, v13, v71 bitop3:0xca
    s_add_u32 s46, s35, 0x2a48000
    buffer_store_dwordx4 v[36:39], v0, s[20:23], s46 offen sc1
    s_add_u32 s47, s33, 0x6000000
    s_nop 0
    buffer_load_dwordx4 v[36:39], v0, s[8:11], s47 offen nt
    s_waitcnt vmcnt(27)
    v_lshlrev_b32 v7, 16, v66
    v_and_b32 v8, 0xffff0000, v66
    v_lshlrev_b32 v9, 16, v67
    v_and_b32 v10, 0xffff0000, v67
    v_mul_f32 v7, 0.15915494, v7
    v_mul_f32 v8, 0.15915494, v8
    v_mul_f32 v9, 0.15915494, v9
    v_mul_f32 v10, 0.15915494, v10
    v_mul_hi_u32_u24 v14, 429497, v76
    v_lshrrev_b32 v12, 3, v80
    v_cos_f32 v7, v7
    v_lshlrev_b16 v13, 3, v80
    v_mad_i32_i24 v11, v14, s55, v76
    v_bitop3_b32 v12, v6, v13, v12 bitop3:0xca
    v_add_lshl_u32 v11, v11, s40, 17
    v_lshlrev_b16 v14, 8, v14
    v_lshrrev_b32 v13, 2, v80
    v_or_b32 v76, v12, v11
    v_bitop3_b32 v80, v5, v13, v14 bitop3:0xea
    ds_add_u32 v80, v2
    v_mul_hi_u32_u24 v14, 429497, v77
    v_lshrrev_b32 v12, 3, v81
    v_cos_f32 v8, v8
    v_lshlrev_b16 v13, 3, v81
    v_mad_i32_i24 v11, v14, s55, v77
    v_bitop3_b32 v12, v6, v13, v12 bitop3:0xca
    v_add_lshl_u32 v11, v11, s40, 17
    v_lshlrev_b16 v14, 8, v14
    v_lshrrev_b32 v13, 2, v81
    v_or_b32 v77, v12, v11
    v_bitop3_b32 v81, v5, v13, v14 bitop3:0xea
    ds_add_u32 v81, v2
    v_cvt_pk_bf16_f32 v66, v7, v8
    v_perm_b32 v12, v66, v66, s41
    v_bitop3_b32 v76, v4, v12, v76 bitop3:0xca
    v_perm_b32 v13, v66, v66, s42
    v_bitop3_b32 v77, v4, v13, v77 bitop3:0xca
    v_mul_hi_u32_u24 v14, 429497, v78
    v_lshrrev_b32 v12, 3, v82
    v_cos_f32 v9, v9
    v_lshlrev_b16 v13, 3, v82
    v_mad_i32_i24 v11, v14, s55, v78
    v_bitop3_b32 v12, v6, v13, v12 bitop3:0xca
    v_add_lshl_u32 v11, v11, s40, 17
    v_lshlrev_b16 v14, 8, v14
    v_lshrrev_b32 v13, 2, v82
    v_or_b32 v78, v12, v11
    v_bitop3_b32 v82, v5, v13, v14 bitop3:0xea
    ds_add_u32 v82, v2
    v_mul_hi_u32_u24 v14, 429497, v79
    v_lshrrev_b32 v12, 3, v83
    v_cos_f32 v10, v10
    v_lshlrev_b16 v13, 3, v83
    v_mad_i32_i24 v11, v14, s55, v79
    v_bitop3_b32 v12, v6, v13, v12 bitop3:0xca
    v_add_lshl_u32 v11, v11, s40, 17
    v_lshlrev_b16 v14, 8, v14
    v_lshrrev_b32 v13, 2, v83
    v_or_b32 v79, v12, v11
    v_bitop3_b32 v83, v5, v13, v14 bitop3:0xea
    ds_add_u32 v83, v2
    v_cvt_pk_bf16_f32 v67, v9, v10
    v_perm_b32 v12, v67, v67, s41
    v_bitop3_b32 v78, v4, v12, v78 bitop3:0xca
    v_perm_b32 v13, v67, v67, s42
    v_bitop3_b32 v79, v4, v13, v79 bitop3:0xca
    s_waitcnt vmcnt(18)
    v_lshlrev_b32 v7, 16, v84
    v_and_b32 v8, 0xffff0000, v84
    v_lshlrev_b32 v9, 16, v85
    v_and_b32 v10, 0xffff0000, v85
    v_mul_f32 v7, 0.15915494, v7
    v_mul_f32 v8, 0.15915494, v8
    v_mul_f32 v9, 0.15915494, v9
    v_mul_f32 v10, 0.15915494, v10
    v_mul_hi_u32_u24 v14, 429497, v88
    v_lshrrev_b32 v12, 3, v92
    v_cos_f32 v7, v7
    v_lshlrev_b16 v13, 3, v92
    v_mad_i32_i24 v11, v14, s55, v88
    v_bitop3_b32 v12, v6, v13, v12 bitop3:0xca
    v_add_lshl_u32 v11, v11, s40, 17
    v_lshlrev_b16 v14, 8, v14
    v_lshrrev_b32 v13, 2, v92
    v_or_b32 v88, v12, v11
    v_bitop3_b32 v92, v5, v13, v14 bitop3:0xea
    ds_add_u32 v92, v2
    v_mul_hi_u32_u24 v14, 429497, v89
    v_lshrrev_b32 v12, 3, v93
    v_cos_f32 v8, v8
    v_lshlrev_b16 v13, 3, v93
    v_mad_i32_i24 v11, v14, s55, v89
    v_bitop3_b32 v12, v6, v13, v12 bitop3:0xca
    v_add_lshl_u32 v11, v11, s40, 17
    v_lshlrev_b16 v14, 8, v14
    v_lshrrev_b32 v13, 2, v93
    v_or_b32 v89, v12, v11
    v_bitop3_b32 v93, v5, v13, v14 bitop3:0xea
    ds_add_u32 v93, v2
    v_cvt_pk_bf16_f32 v84, v7, v8
    v_perm_b32 v12, v84, v84, s41
    v_bitop3_b32 v88, v4, v12, v88 bitop3:0xca
    v_perm_b32 v13, v84, v84, s42
    v_bitop3_b32 v89, v4, v13, v89 bitop3:0xca
    v_mul_hi_u32_u24 v14, 429497, v90
    v_lshrrev_b32 v12, 3, v94
    v_cos_f32 v9, v9
    v_lshlrev_b16 v13, 3, v94
    v_mad_i32_i24 v11, v14, s55, v90
    v_bitop3_b32 v12, v6, v13, v12 bitop3:0xca
    v_add_lshl_u32 v11, v11, s40, 17
    v_lshlrev_b16 v14, 8, v14
    v_lshrrev_b32 v13, 2, v94
    v_or_b32 v90, v12, v11
    v_bitop3_b32 v94, v5, v13, v14 bitop3:0xea
    ds_add_u32 v94, v2
    v_mul_hi_u32_u24 v14, 429497, v91
    v_lshrrev_b32 v12, 3, v95
    v_cos_f32 v10, v10
    v_lshlrev_b16 v13, 3, v95
    v_mad_i32_i24 v11, v14, s55, v91
    v_bitop3_b32 v12, v6, v13, v12 bitop3:0xca
    v_add_lshl_u32 v11, v11, s40, 17
    v_lshlrev_b16 v14, 8, v14
    v_lshrrev_b32 v13, 2, v95
    v_or_b32 v91, v12, v11
    v_bitop3_b32 v95, v5, v13, v14 bitop3:0xea
    ds_add_u32 v95, v2
    v_cvt_pk_bf16_f32 v85, v9, v10
    v_perm_b32 v12, v85, v85, s41
    v_bitop3_b32 v90, v4, v12, v90 bitop3:0xca
    v_perm_b32 v13, v85, v85, s42
    v_bitop3_b32 v91, v4, v13, v91 bitop3:0xca
    s_add_u32 s44, s35, 0x2a4c000
    buffer_store_dwordx4 v[40:43], v0, s[20:23], s44 offen sc1
    s_add_u32 s45, s33, 0x6000000
    s_nop 0
    buffer_load_dwordx4 v[40:43], v0, s[12:15], s45 offen nt
    s_waitcnt vmcnt(18)
    v_lshlrev_b32 v7, 16, v86
    v_and_b32 v8, 0xffff0000, v86
    v_lshlrev_b32 v9, 16, v87
    v_and_b32 v10, 0xffff0000, v87
    v_mul_f32 v7, 0.15915494, v7
    v_mul_f32 v8, 0.15915494, v8
    v_mul_f32 v9, 0.15915494, v9
    v_mul_f32 v10, 0.15915494, v10
    v_mul_hi_u32_u24 v14, 429497, v96
    v_lshrrev_b32 v12, 3, v100
    v_cos_f32 v7, v7
    v_lshlrev_b16 v13, 3, v100
    v_mad_i32_i24 v11, v14, s55, v96
    v_bitop3_b32 v12, v6, v13, v12 bitop3:0xca
    v_add_lshl_u32 v11, v11, s40, 17
    v_lshlrev_b16 v14, 8, v14
    v_lshrrev_b32 v13, 2, v100
    v_or_b32 v96, v12, v11
    v_bitop3_b32 v100, v5, v13, v14 bitop3:0xea
    ds_add_u32 v100, v2
    v_mul_hi_u32_u24 v14, 429497, v97
    v_lshrrev_b32 v12, 3, v101
    v_cos_f32 v8, v8
    v_lshlrev_b16 v13, 3, v101
    v_mad_i32_i24 v11, v14, s55, v97
    v_bitop3_b32 v12, v6, v13, v12 bitop3:0xca
    v_add_lshl_u32 v11, v11, s40, 17
    v_lshlrev_b16 v14, 8, v14
    v_lshrrev_b32 v13, 2, v101
    v_or_b32 v97, v12, v11
    v_bitop3_b32 v101, v5, v13, v14 bitop3:0xea
    ds_add_u32 v101, v2
    v_cvt_pk_bf16_f32 v86, v7, v8
    v_perm_b32 v12, v86, v86, s41
    v_bitop3_b32 v96, v4, v12, v96 bitop3:0xca
    v_perm_b32 v13, v86, v86, s42
    v_bitop3_b32 v97, v4, v13, v97 bitop3:0xca
    v_mul_hi_u32_u24 v14, 429497, v98
    v_lshrrev_b32 v12, 3, v102
    v_cos_f32 v9, v9
    v_lshlrev_b16 v13, 3, v102
    v_mad_i32_i24 v11, v14, s55, v98
    v_bitop3_b32 v12, v6, v13, v12 bitop3:0xca
    v_add_lshl_u32 v11, v11, s40, 17
    v_lshlrev_b16 v14, 8, v14
    v_lshrrev_b32 v13, 2, v102
    v_or_b32 v98, v12, v11
    v_bitop3_b32 v102, v5, v13, v14 bitop3:0xea
    ds_add_u32 v102, v2
    v_mul_hi_u32_u24 v14, 429497, v99
    v_lshrrev_b32 v12, 3, v103
    v_cos_f32 v10, v10
    v_lshlrev_b16 v13, 3, v103
    v_mad_i32_i24 v11, v14, s55, v99
    v_bitop3_b32 v12, v6, v13, v12 bitop3:0xca
    v_add_lshl_u32 v11, v11, s40, 17
    v_lshlrev_b16 v14, 8, v14
    v_lshrrev_b32 v13, 2, v103
    v_or_b32 v99, v12, v11
    v_bitop3_b32 v103, v5, v13, v14 bitop3:0xea
    ds_add_u32 v103, v2
    v_cvt_pk_bf16_f32 v87, v9, v10
    v_perm_b32 v12, v87, v87, s41
    v_bitop3_b32 v98, v4, v12, v98 bitop3:0xca
    v_perm_b32 v13, v87, v87, s42
    v_bitop3_b32 v99, v4, v13, v99 bitop3:0xca
    s_waitcnt vmcnt(14)
    v_lshlrev_b32 v7, 16, v104
    v_and_b32 v8, 0xffff0000, v104
    v_lshlrev_b32 v9, 16, v105
    v_and_b32 v10, 0xffff0000, v105
    v_mul_f32 v7, 0.15915494, v7
    v_mul_f32 v8, 0.15915494, v8
    v_mul_f32 v9, 0.15915494, v9
    v_mul_f32 v10, 0.15915494, v10
    v_mul_hi_u32_u24 v14, 429497, v108
    v_lshrrev_b32 v12, 3, v112
    v_cos_f32 v7, v7
    v_lshlrev_b16 v13, 3, v112
    v_mad_i32_i24 v11, v14, s55, v108
    v_bitop3_b32 v12, v6, v13, v12 bitop3:0xca
    v_add_lshl_u32 v11, v11, s40, 17
    v_lshlrev_b16 v14, 8, v14
    v_lshrrev_b32 v13, 2, v112
    v_or_b32 v108, v12, v11
    v_bitop3_b32 v112, v5, v13, v14 bitop3:0xea
    ds_add_u32 v112, v2
    v_mul_hi_u32_u24 v14, 429497, v109
    v_lshrrev_b32 v12, 3, v113
    v_cos_f32 v8, v8
    v_lshlrev_b16 v13, 3, v113
    v_mad_i32_i24 v11, v14, s55, v109
    v_bitop3_b32 v12, v6, v13, v12 bitop3:0xca
    v_add_lshl_u32 v11, v11, s40, 17
    v_lshlrev_b16 v14, 8, v14
    v_lshrrev_b32 v13, 2, v113
    v_or_b32 v109, v12, v11
    v_bitop3_b32 v113, v5, v13, v14 bitop3:0xea
    ds_add_u32 v113, v2
    v_cvt_pk_bf16_f32 v104, v7, v8
    v_perm_b32 v12, v104, v104, s41
    v_bitop3_b32 v108, v4, v12, v108 bitop3:0xca
    v_perm_b32 v13, v104, v104, s42
    v_bitop3_b32 v109, v4, v13, v109 bitop3:0xca
    v_mul_hi_u32_u24 v14, 429497, v110
    v_lshrrev_b32 v12, 3, v114
    v_cos_f32 v9, v9
    v_lshlrev_b16 v13, 3, v114
    v_mad_i32_i24 v11, v14, s55, v110
    v_bitop3_b32 v12, v6, v13, v12 bitop3:0xca
    v_add_lshl_u32 v11, v11, s40, 17
    v_lshlrev_b16 v14, 8, v14
    v_lshrrev_b32 v13, 2, v114
    v_or_b32 v110, v12, v11
    v_bitop3_b32 v114, v5, v13, v14 bitop3:0xea
    ds_add_u32 v114, v2
    v_mul_hi_u32_u24 v14, 429497, v111
    v_lshrrev_b32 v12, 3, v115
    v_cos_f32 v10, v10
    v_lshlrev_b16 v13, 3, v115
    v_mad_i32_i24 v11, v14, s55, v111
    v_bitop3_b32 v12, v6, v13, v12 bitop3:0xca
    v_add_lshl_u32 v11, v11, s40, 17
    v_lshlrev_b16 v14, 8, v14
    v_lshrrev_b32 v13, 2, v115
    v_or_b32 v111, v12, v11
    v_bitop3_b32 v115, v5, v13, v14 bitop3:0xea
    ds_add_u32 v115, v2
    v_cvt_pk_bf16_f32 v105, v9, v10
    v_perm_b32 v12, v105, v105, s41
    v_bitop3_b32 v110, v4, v12, v110 bitop3:0xca
    v_perm_b32 v13, v105, v105, s42
    v_bitop3_b32 v111, v4, v13, v111 bitop3:0xca
    s_add_u32 s46, s35, 0x2a50000
    buffer_store_dwordx4 v[24:27], v0, s[20:23], s46 offen sc1
    s_add_u32 s47, s34, 0x3000000
    s_nop 0
    buffer_load_dwordx2 v[24:25], v1, s[16:19], s47 offen nt
    s_add_u32 s44, s34, 0x3002000
    buffer_load_dwordx2 v[26:27], v1, s[16:19], s44 offen nt
    s_waitcnt vmcnt(15)
    v_lshlrev_b32 v7, 16, v106
    v_and_b32 v8, 0xffff0000, v106
    v_lshlrev_b32 v9, 16, v107
    v_and_b32 v10, 0xffff0000, v107
    v_mul_f32 v7, 0.15915494, v7
    v_mul_f32 v8, 0.15915494, v8
    v_mul_f32 v9, 0.15915494, v9
    v_mul_f32 v10, 0.15915494, v10
    v_mul_hi_u32_u24 v14, 429497, v116
    v_lshrrev_b32 v12, 3, v120
    v_cos_f32 v7, v7
    v_lshlrev_b16 v13, 3, v120
    v_mad_i32_i24 v11, v14, s55, v116
    v_bitop3_b32 v12, v6, v13, v12 bitop3:0xca
    v_add_lshl_u32 v11, v11, s40, 17
    v_lshlrev_b16 v14, 8, v14
    v_lshrrev_b32 v13, 2, v120
    v_or_b32 v116, v12, v11
    v_bitop3_b32 v120, v5, v13, v14 bitop3:0xea
    ds_add_u32 v120, v2
    v_mul_hi_u32_u24 v14, 429497, v117
    v_lshrrev_b32 v12, 3, v121
    v_cos_f32 v8, v8
    v_lshlrev_b16 v13, 3, v121
    v_mad_i32_i24 v11, v14, s55, v117
    v_bitop3_b32 v12, v6, v13, v12 bitop3:0xca
    v_add_lshl_u32 v11, v11, s40, 17
    v_lshlrev_b16 v14, 8, v14
    v_lshrrev_b32 v13, 2, v121
    v_or_b32 v117, v12, v11
    v_bitop3_b32 v121, v5, v13, v14 bitop3:0xea
    ds_add_u32 v121, v2
    v_cvt_pk_bf16_f32 v106, v7, v8
    v_perm_b32 v12, v106, v106, s41
    v_bitop3_b32 v116, v4, v12, v116 bitop3:0xca
    v_perm_b32 v13, v106, v106, s42
    v_bitop3_b32 v117, v4, v13, v117 bitop3:0xca
    v_mul_hi_u32_u24 v14, 429497, v118
    v_lshrrev_b32 v12, 3, v122
    v_cos_f32 v9, v9
    v_lshlrev_b16 v13, 3, v122
    v_mad_i32_i24 v11, v14, s55, v118
    v_bitop3_b32 v12, v6, v13, v12 bitop3:0xca
    v_add_lshl_u32 v11, v11, s40, 17
    v_lshlrev_b16 v14, 8, v14
    v_lshrrev_b32 v13, 2, v122
    v_or_b32 v118, v12, v11
    v_bitop3_b32 v122, v5, v13, v14 bitop3:0xea
    ds_add_u32 v122, v2
    v_mul_hi_u32_u24 v14, 429497, v119
    v_lshrrev_b32 v12, 3, v123
    v_cos_f32 v10, v10
    v_lshlrev_b16 v13, 3, v123
    v_mad_i32_i24 v11, v14, s55, v119
    v_bitop3_b32 v12, v6, v13, v12 bitop3:0xca
    v_add_lshl_u32 v11, v11, s40, 17
    v_lshlrev_b16 v14, 8, v14
    v_lshrrev_b32 v13, 2, v123
    v_or_b32 v119, v12, v11
    v_bitop3_b32 v123, v5, v13, v14 bitop3:0xea
    ds_add_u32 v123, v2
    v_cvt_pk_bf16_f32 v107, v9, v10
    v_perm_b32 v12, v107, v107, s41
    v_bitop3_b32 v118, v4, v12, v118 bitop3:0xca
    v_perm_b32 v13, v107, v107, s42
    v_bitop3_b32 v119, v4, v13, v119 bitop3:0xca
    s_waitcnt vmcnt(11)
    v_lshlrev_b32 v7, 16, v124
    v_and_b32 v8, 0xffff0000, v124
    v_lshlrev_b32 v9, 16, v125
    v_and_b32 v10, 0xffff0000, v125
    v_mul_f32 v7, 0.15915494, v7
    v_mul_f32 v8, 0.15915494, v8
    v_mul_f32 v9, 0.15915494, v9
    v_mul_f32 v10, 0.15915494, v10
    v_mul_hi_u32_u24 v14, 429497, v16
    v_lshrrev_b32 v12, 3, v20
    v_cos_f32 v7, v7
    v_lshlrev_b16 v13, 3, v20
    v_mad_i32_i24 v11, v14, s55, v16
    v_bitop3_b32 v12, v6, v13, v12 bitop3:0xca
    v_add_lshl_u32 v11, v11, s40, 17
    v_lshlrev_b16 v14, 8, v14
    v_lshrrev_b32 v13, 2, v20
    v_or_b32 v16, v12, v11
    v_bitop3_b32 v20, v5, v13, v14 bitop3:0xea
    ds_add_u32 v20, v2
    v_mul_hi_u32_u24 v14, 429497, v17
    v_lshrrev_b32 v12, 3, v21
    v_cos_f32 v8, v8
    v_lshlrev_b16 v13, 3, v21
    v_mad_i32_i24 v11, v14, s55, v17
    v_bitop3_b32 v12, v6, v13, v12 bitop3:0xca
    v_add_lshl_u32 v11, v11, s40, 17
    v_lshlrev_b16 v14, 8, v14
    v_lshrrev_b32 v13, 2, v21
    v_or_b32 v17, v12, v11
    v_bitop3_b32 v21, v5, v13, v14 bitop3:0xea
    ds_add_u32 v21, v2
    v_cvt_pk_bf16_f32 v124, v7, v8
    v_perm_b32 v12, v124, v124, s41
    v_bitop3_b32 v16, v4, v12, v16 bitop3:0xca
    v_perm_b32 v13, v124, v124, s42
    v_bitop3_b32 v17, v4, v13, v17 bitop3:0xca
    v_mul_hi_u32_u24 v14, 429497, v18
    v_lshrrev_b32 v12, 3, v22
    v_cos_f32 v9, v9
    v_lshlrev_b16 v13, 3, v22
    v_mad_i32_i24 v11, v14, s55, v18
    v_bitop3_b32 v12, v6, v13, v12 bitop3:0xca
    v_add_lshl_u32 v11, v11, s40, 17
    v_lshlrev_b16 v14, 8, v14
    v_lshrrev_b32 v13, 2, v22
    v_or_b32 v18, v12, v11
    v_bitop3_b32 v22, v5, v13, v14 bitop3:0xea
    ds_add_u32 v22, v2
    v_mul_hi_u32_u24 v14, 429497, v19
    v_lshrrev_b32 v12, 3, v23
    v_cos_f32 v10, v10
    v_lshlrev_b16 v13, 3, v23
    v_mad_i32_i24 v11, v14, s55, v19
    v_bitop3_b32 v12, v6, v13, v12 bitop3:0xca
    v_add_lshl_u32 v11, v11, s40, 17
    v_lshlrev_b16 v14, 8, v14
    v_lshrrev_b32 v13, 2, v23
    v_or_b32 v19, v12, v11
    v_bitop3_b32 v23, v5, v13, v14 bitop3:0xea
    ds_add_u32 v23, v2
    v_cvt_pk_bf16_f32 v125, v9, v10
    v_perm_b32 v12, v125, v125, s41
    v_bitop3_b32 v18, v4, v12, v18 bitop3:0xca
    v_perm_b32 v13, v125, v125, s42
    v_bitop3_b32 v19, v4, v13, v19 bitop3:0xca
    s_add_u32 s45, s35, 0x2a54000
    buffer_store_dwordx4 v[48:51], v0, s[20:23], s45 offen sc1
    s_add_u32 s46, s33, 0x6004000
    s_nop 0
    buffer_load_dwordx4 v[48:51], v0, s[8:11], s46 offen nt
    s_waitcnt vmcnt(9)
    v_lshlrev_b32 v7, 16, v126
    v_and_b32 v8, 0xffff0000, v126
    v_lshlrev_b32 v9, 16, v127
    v_and_b32 v10, 0xffff0000, v127
    v_mul_f32 v7, 0.15915494, v7
    v_mul_f32 v8, 0.15915494, v8
    v_mul_f32 v9, 0.15915494, v9
    v_mul_f32 v10, 0.15915494, v10
    v_mul_hi_u32_u24 v14, 429497, v28
    v_lshrrev_b32 v12, 3, v32
    v_cos_f32 v7, v7
    v_lshlrev_b16 v13, 3, v32
    v_mad_i32_i24 v11, v14, s55, v28
    v_bitop3_b32 v12, v6, v13, v12 bitop3:0xca
    v_add_lshl_u32 v11, v11, s40, 17
    v_lshlrev_b16 v14, 8, v14
    v_lshrrev_b32 v13, 2, v32
    v_or_b32 v28, v12, v11
    v_bitop3_b32 v32, v5, v13, v14 bitop3:0xea
    ds_add_u32 v32, v2
    v_mul_hi_u32_u24 v14, 429497, v29
    v_lshrrev_b32 v12, 3, v33
    v_cos_f32 v8, v8
    v_lshlrev_b16 v13, 3, v33
    v_mad_i32_i24 v11, v14, s55, v29
    v_bitop3_b32 v12, v6, v13, v12 bitop3:0xca
    v_add_lshl_u32 v11, v11, s40, 17
    v_lshlrev_b16 v14, 8, v14
    v_lshrrev_b32 v13, 2, v33
    v_or_b32 v29, v12, v11
    v_bitop3_b32 v33, v5, v13, v14 bitop3:0xea
    ds_add_u32 v33, v2
    v_cvt_pk_bf16_f32 v126, v7, v8
    v_perm_b32 v12, v126, v126, s41
    v_bitop3_b32 v28, v4, v12, v28 bitop3:0xca
    v_perm_b32 v13, v126, v126, s42
    v_bitop3_b32 v29, v4, v13, v29 bitop3:0xca
    v_mul_hi_u32_u24 v14, 429497, v30
    v_lshrrev_b32 v12, 3, v34
    v_cos_f32 v9, v9
    v_lshlrev_b16 v13, 3, v34
    v_mad_i32_i24 v11, v14, s55, v30
    v_bitop3_b32 v12, v6, v13, v12 bitop3:0xca
    v_add_lshl_u32 v11, v11, s40, 17
    v_lshlrev_b16 v14, 8, v14
    v_lshrrev_b32 v13, 2, v34
    v_or_b32 v30, v12, v11
    v_bitop3_b32 v34, v5, v13, v14 bitop3:0xea
    ds_add_u32 v34, v2
    v_mul_hi_u32_u24 v14, 429497, v31
    v_lshrrev_b32 v12, 3, v35
    v_cos_f32 v10, v10
    v_lshlrev_b16 v13, 3, v35
    v_mad_i32_i24 v11, v14, s55, v31
    v_bitop3_b32 v12, v6, v13, v12 bitop3:0xca
    v_add_lshl_u32 v11, v11, s40, 17
    v_lshlrev_b16 v14, 8, v14
    v_lshrrev_b32 v13, 2, v35
    v_or_b32 v31, v12, v11
    v_bitop3_b32 v35, v5, v13, v14 bitop3:0xea
    ds_add_u32 v35, v2
    v_cvt_pk_bf16_f32 v127, v9, v10
    v_perm_b32 v12, v127, v127, s41
    v_bitop3_b32 v30, v4, v12, v30 bitop3:0xca
    v_perm_b32 v13, v127, v127, s42
    v_bitop3_b32 v31, v4, v13, v31 bitop3:0xca
    v_lshrrev_b32 v8, 2, v0
    v_and_b32 v7, 0x3c00, v0
    v_bitop3_b32 v7, v5, v8, v7 bitop3:0xea
    s_waitcnt lgkmcnt(0)
    s_barrier
    ds_read2st64_b32 v[8:9], v7 offset0:0 offset1:1
    ds_read2st64_b32 v[10:11], v7 offset0:2 offset1:3
    s_add_u32 s47, s35, 0x2a58000
    buffer_store_dwordx4 v[52:55], v0, s[20:23], s47 offen sc1
    s_add_u32 s44, s33, 0x6004000
    s_nop 0
    buffer_load_dwordx4 v[52:55], v0, s[12:15], s44 offen nt
    s_waitcnt lgkmcnt(0)
    v_lshl_or_b32 v12, v9, 16, v8
    v_lshl_or_b32 v13, v11, 16, v10
    v_mov_b32 v14, v12
    v_mov_b32 v15, v13
    s_nop 0
    v_add_u32_dpp v14, v14, v14 row_shr:1 row_mask:0xf bank_mask:0xf bound_ctrl:1
    v_add_u32_dpp v15, v15, v15 row_shr:1 row_mask:0xf bank_mask:0xf bound_ctrl:1
    s_nop 0
    v_add_u32_dpp v14, v14, v14 row_shr:2 row_mask:0xf bank_mask:0xf bound_ctrl:1
    v_add_u32_dpp v15, v15, v15 row_shr:2 row_mask:0xf bank_mask:0xf bound_ctrl:1
    s_nop 0
    v_add_u32_dpp v14, v14, v14 row_shr:4 row_mask:0xf bank_mask:0xf bound_ctrl:1
    v_add_u32_dpp v15, v15, v15 row_shr:4 row_mask:0xf bank_mask:0xf bound_ctrl:1
    s_nop 0
    v_add_u32_dpp v14, v14, v14 row_shr:8 row_mask:0xf bank_mask:0xf bound_ctrl:1
    v_add_u32_dpp v15, v15, v15 row_shr:8 row_mask:0xf bank_mask:0xf bound_ctrl:1
    s_nop 0
    v_add_u32_dpp v14, v14, v14 row_bcast:15 row_mask:0xa bank_mask:0xf
    v_add_u32_dpp v15, v15, v15 row_bcast:15 row_mask:0xa bank_mask:0xf
    s_nop 0
    v_add_u32_dpp v14, v14, v14 row_bcast:31 row_mask:0xc bank_mask:0xf
    v_add_u32_dpp v15, v15, v15 row_bcast:31 row_mask:0xc bank_mask:0xf
    v_readlane_b32 s48, v14, 63
    v_readlane_b32 s49, v15, 63
    s_lshl_b32 s54, s32, 2
    v_mov_b32 v8, s54
    s_and_b32 s50, s48, 0xffff
    s_lshr_b32 s51, s48, 16
    s_and_b32 s52, s49, 0xffff
    s_lshr_b32 s53, s49, 16
    s_add_u32 s51, s51, s50
    s_add_u32 s52, s52, s51
    s_add_u32 s53, s53, s52
    v_mov_b32 v9, s53
    s_mov_b64 exec, 1
    ds_write_b32 v8, v9 offset:16384
    s_mov_b64 exec, -1
    v_and_b32 v8, 60, v7
    s_waitcnt lgkmcnt(0)
    s_barrier
    ds_read_b32 v9, v8 offset:16384
    s_waitcnt lgkmcnt(0)
    v_add_u32_dpp v9, v9, v9 row_shr:1 row_mask:0xf bank_mask:0xf bound_ctrl:1
    s_nop 1
    v_add_u32_dpp v9, v9, v9 row_shr:2 row_mask:0xf bank_mask:0xf bound_ctrl:1
    s_nop 1
    v_add_u32_dpp v9, v9, v9 row_shr:4 row_mask:0xf bank_mask:0xf bound_ctrl:1
    s_nop 1
    v_add_u32_dpp v9, v9, v9 row_shr:8 row_mask:0xf bank_mask:0xf bound_ctrl:1
    s_nop 0
    v_readlane_b32 s54, v9, s32
    s_sub_u32 s54, s54, s53
    s_add_u32 s50, s50, s54
    s_add_u32 s51, s51, s54
    s_add_u32 s52, s52, s54
    s_pack_ll_b32_b16 s48, s54, s50
    s_pack_ll_b32_b16 s49, s51, s52
    v_add_u32 v14, s48, v14
    v_add_u32 v15, s49, v15
    v_sub_u32 v12, v14, v12
    v_sub_u32 v13, v15, v13
    v_and_b32 v8, 0xffff, v12
    v_lshrrev_b32 v9, 16, v12
    v_and_b32 v10, 0xffff, v13
    v_lshrrev_b32 v11, 16, v13
    ds_write2st64_b32 v7, v8, v9 offset0:0 offset1:1
    ds_write2st64_b32 v7, v10, v11 offset0:2 offset1:3
    s_waitcnt lgkmcnt(0)
    s_barrier
    ds_add_rtn_u32 v72, v72, v2
    ds_add_rtn_u32 v73, v73, v2
    ds_add_rtn_u32 v74, v74, v2
    ds_add_rtn_u32 v75, v75, v2
    s_add_u32 s45, s36, 0x5480000
    v_and_b32 v11, 0x3f0, v0
    v_add_u32 v11, v11, v11
    buffer_store_dwordx2 v[12:13], v11, s[24:27], s45 offen
    s_bitset0_b64 exec, 63
    s_not_b64 exec, exec
    buffer_store_dwordx2 v[14:15], v11, s[24:27], s45 offen offset:32
    s_mov_b64 exec, -1
    ds_add_rtn_u32 v80, v80, v2
    ds_add_rtn_u32 v81, v81, v2
    ds_add_rtn_u32 v82, v82, v2
    ds_add_rtn_u32 v83, v83, v2
    ds_add_rtn_u32 v92, v92, v2
    ds_add_rtn_u32 v93, v93, v2
    ds_add_rtn_u32 v94, v94, v2
    ds_add_rtn_u32 v95, v95, v2
    s_add_u32 s46, s35, 0x2a5c000
    buffer_store_dwordx4 v[56:59], v0, s[20:23], s46 offen sc1
    s_add_u32 s47, s33, 0x6008000
    s_nop 0
    buffer_load_dwordx4 v[56:59], v0, s[8:11], s47 offen nt
    ds_add_rtn_u32 v100, v100, v2
    ds_add_rtn_u32 v101, v101, v2
    ds_add_rtn_u32 v102, v102, v2
    ds_add_rtn_u32 v103, v103, v2
    ds_add_rtn_u32 v112, v112, v2
    ds_add_rtn_u32 v113, v113, v2
    ds_add_rtn_u32 v114, v114, v2
    ds_add_rtn_u32 v115, v115, v2
    s_add_u32 s44, s35, 0x2a60000
    buffer_store_dwordx4 v[60:63], v0, s[20:23], s44 offen sc1
    s_add_u32 s45, s33, 0x6008000
    s_nop 0
    buffer_load_dwordx4 v[60:63], v0, s[12:15], s45 offen nt
    ds_add_rtn_u32 v120, v120, v2
    ds_add_rtn_u32 v121, v121, v2
    ds_add_rtn_u32 v122, v122, v2
    ds_add_rtn_u32 v123, v123, v2
    ds_add_rtn_u32 v20, v20, v2
    ds_add_rtn_u32 v21, v21, v2
    ds_add_rtn_u32 v22, v22, v2
    ds_add_rtn_u32 v23, v23, v2
    s_add_u32 s46, s35, 0x2a64000
    buffer_store_dwordx4 v[44:47], v0, s[20:23], s46 offen sc1
    s_add_u32 s47, s34, 0x3004000
    s_nop 0
    buffer_load_dwordx2 v[44:45], v1, s[16:19], s47 offen nt
    s_add_u32 s44, s34, 0x3006000
    buffer_load_dwordx2 v[46:47], v1, s[16:19], s44 offen nt
    ds_add_rtn_u32 v32, v32, v2
    ds_add_rtn_u32 v33, v33, v2
    ds_add_rtn_u32 v34, v34, v2
    ds_add_rtn_u32 v35, v35, v2
    s_waitcnt lgkmcnt(0)
    s_barrier
    v_and_b32 v7, -4, v72
    v_lshl_add_u32 v8, v72, 2, v7
    ds_write_b32 v8, v68
    v_lshl_add_u32 v7, v7, 2, v72
    ds_write_b8 v7, v64 offset:16
    v_and_b32 v9, -4, v73
    v_lshl_add_u32 v10, v73, 2, v9
    ds_write_b32 v10, v69
    v_lshl_add_u32 v9, v9, 2, v73
    ds_write_b8_d16_hi v9, v64 offset:16
    v_and_b32 v7, -4, v74
    v_lshl_add_u32 v8, v74, 2, v7
    ds_write_b32 v8, v70
    v_lshl_add_u32 v7, v7, 2, v74
    ds_write_b8 v7, v65 offset:16
    v_and_b32 v9, -4, v75
    v_lshl_add_u32 v10, v75, 2, v9
    ds_write_b32 v10, v71
    v_lshl_add_u32 v9, v9, 2, v75
    ds_write_b8_d16_hi v9, v65 offset:16
    s_add_u32 s45, s33, 0x600c000
    buffer_load_dwordx4 v[68:71], v0, s[8:11], s45 offen nt
    s_add_u32 s46, s33, 0x600c000
    buffer_load_dwordx4 v[72:75], v0, s[12:15], s46 offen nt
    v_and_b32 v7, -4, v80
    v_lshl_add_u32 v8, v80, 2, v7
    ds_write_b32 v8, v76
    v_lshl_add_u32 v7, v7, 2, v80
    ds_write_b8 v7, v66 offset:16
    v_and_b32 v9, -4, v81
    v_lshl_add_u32 v10, v81, 2, v9
    ds_write_b32 v10, v77
    v_lshl_add_u32 v9, v9, 2, v81
    ds_write_b8_d16_hi v9, v66 offset:16
    v_and_b32 v7, -4, v82
    v_lshl_add_u32 v8, v82, 2, v7
    ds_write_b32 v8, v78
    v_lshl_add_u32 v7, v7, 2, v82
    ds_write_b8 v7, v67 offset:16
    v_and_b32 v9, -4, v83
    v_lshl_add_u32 v10, v83, 2, v9
    ds_write_b32 v10, v79
    v_lshl_add_u32 v9, v9, 2, v83
    ds_write_b8_d16_hi v9, v67 offset:16
    s_add_u32 s47, s33, 0x6010000
    buffer_load_dwordx4 v[76:79], v0, s[8:11], s47 offen nt
    v_and_b32 v7, -4, v92
    v_lshl_add_u32 v8, v92, 2, v7
    ds_write_b32 v8, v88
    v_lshl_add_u32 v7, v7, 2, v92
    ds_write_b8 v7, v84 offset:16
    v_and_b32 v9, -4, v93
    v_lshl_add_u32 v10, v93, 2, v9
    ds_write_b32 v10, v89
    v_lshl_add_u32 v9, v9, 2, v93
    ds_write_b8_d16_hi v9, v84 offset:16
    v_and_b32 v7, -4, v94
    v_lshl_add_u32 v8, v94, 2, v7
    ds_write_b32 v8, v90
    v_lshl_add_u32 v7, v7, 2, v94
    ds_write_b8 v7, v85 offset:16
    v_and_b32 v9, -4, v95
    v_lshl_add_u32 v10, v95, 2, v9
    ds_write_b32 v10, v91
    v_lshl_add_u32 v9, v9, 2, v95
    ds_write_b8_d16_hi v9, v85 offset:16
    s_add_u32 s44, s33, 0x6010000
    buffer_load_dwordx4 v[80:83], v0, s[12:15], s44 offen nt
    v_and_b32 v7, -4, v100
    v_lshl_add_u32 v8, v100, 2, v7
    ds_write_b32 v8, v96
    v_lshl_add_u32 v7, v7, 2, v100
    ds_write_b8 v7, v86 offset:16
    v_and_b32 v9, -4, v101
    v_lshl_add_u32 v10, v101, 2, v9
    ds_write_b32 v10, v97
    v_lshl_add_u32 v9, v9, 2, v101
    ds_write_b8_d16_hi v9, v86 offset:16
    v_and_b32 v7, -4, v102
    v_lshl_add_u32 v8, v102, 2, v7
    ds_write_b32 v8, v98
    v_lshl_add_u32 v7, v7, 2, v102
    ds_write_b8 v7, v87 offset:16
    v_and_b32 v9, -4, v103
    v_lshl_add_u32 v10, v103, 2, v9
    ds_write_b32 v10, v99
    v_lshl_add_u32 v9, v9, 2, v103
    ds_write_b8_d16_hi v9, v87 offset:16
    s_add_u32 s45, s34, 0x3008000
    buffer_load_dwordx2 v[64:65], v1, s[16:19], s45 offen nt
    s_add_u32 s46, s34, 0x300a000
    buffer_load_dwordx2 v[66:67], v1, s[16:19], s46 offen nt
    v_and_b32 v7, -4, v112
    v_lshl_add_u32 v8, v112, 2, v7
    ds_write_b32 v8, v108
    v_lshl_add_u32 v7, v7, 2, v112
    ds_write_b8 v7, v104 offset:16
    v_and_b32 v9, -4, v113
    v_lshl_add_u32 v10, v113, 2, v9
    ds_write_b32 v10, v109
    v_lshl_add_u32 v9, v9, 2, v113
    ds_write_b8_d16_hi v9, v104 offset:16
    v_and_b32 v7, -4, v114
    v_lshl_add_u32 v8, v114, 2, v7
    ds_write_b32 v8, v110
    v_lshl_add_u32 v7, v7, 2, v114
    ds_write_b8 v7, v105 offset:16
    v_and_b32 v9, -4, v115
    v_lshl_add_u32 v10, v115, 2, v9
    ds_write_b32 v10, v111
    v_lshl_add_u32 v9, v9, 2, v115
    ds_write_b8_d16_hi v9, v105 offset:16
    s_add_u32 s47, s33, 0x6014000
    buffer_load_dwordx4 v[88:91], v0, s[8:11], s47 offen nt
    s_add_u32 s44, s33, 0x6014000
    buffer_load_dwordx4 v[92:95], v0, s[12:15], s44 offen nt
    v_and_b32 v7, -4, v120
    v_lshl_add_u32 v8, v120, 2, v7
    ds_write_b32 v8, v116
    v_lshl_add_u32 v7, v7, 2, v120
    ds_write_b8 v7, v106 offset:16
    v_and_b32 v9, -4, v121
    v_lshl_add_u32 v10, v121, 2, v9
    ds_write_b32 v10, v117
    v_lshl_add_u32 v9, v9, 2, v121
    ds_write_b8_d16_hi v9, v106 offset:16
    v_and_b32 v7, -4, v122
    v_lshl_add_u32 v8, v122, 2, v7
    ds_write_b32 v8, v118
    v_lshl_add_u32 v7, v7, 2, v122
    ds_write_b8 v7, v107 offset:16
    v_and_b32 v9, -4, v123
    v_lshl_add_u32 v10, v123, 2, v9
    ds_write_b32 v10, v119
    v_lshl_add_u32 v9, v9, 2, v123
    ds_write_b8_d16_hi v9, v107 offset:16
    s_add_u32 s45, s33, 0x6018000
    buffer_load_dwordx4 v[96:99], v0, s[8:11], s45 offen nt
    v_and_b32 v7, -4, v20
    v_lshl_add_u32 v8, v20, 2, v7
    ds_write_b32 v8, v16
    v_lshl_add_u32 v7, v7, 2, v20
    ds_write_b8 v7, v124 offset:16
    v_and_b32 v9, -4, v21
    v_lshl_add_u32 v10, v21, 2, v9
    ds_write_b32 v10, v17
    v_lshl_add_u32 v9, v9, 2, v21
    ds_write_b8_d16_hi v9, v124 offset:16
    v_and_b32 v7, -4, v22
    v_lshl_add_u32 v8, v22, 2, v7
    ds_write_b32 v8, v18
    v_lshl_add_u32 v7, v7, 2, v22
    ds_write_b8 v7, v125 offset:16
    v_and_b32 v9, -4, v23
    v_lshl_add_u32 v10, v23, 2, v9
    ds_write_b32 v10, v19
    v_lshl_add_u32 v9, v9, 2, v23
    ds_write_b8_d16_hi v9, v125 offset:16
    s_add_u32 s46, s33, 0x6018000
    buffer_load_dwordx4 v[100:103], v0, s[12:15], s46 offen nt
    v_and_b32 v7, -4, v32
    v_lshl_add_u32 v8, v32, 2, v7
    ds_write_b32 v8, v28
    v_lshl_add_u32 v7, v7, 2, v32
    ds_write_b8 v7, v126 offset:16
    v_and_b32 v9, -4, v33
    v_lshl_add_u32 v10, v33, 2, v9
    ds_write_b32 v10, v29
    v_lshl_add_u32 v9, v9, 2, v33
    ds_write_b8_d16_hi v9, v126 offset:16
    v_and_b32 v7, -4, v34
    v_lshl_add_u32 v8, v34, 2, v7
    ds_write_b32 v8, v30
    v_lshl_add_u32 v7, v7, 2, v34
    ds_write_b8 v7, v127 offset:16
    v_and_b32 v9, -4, v35
    v_lshl_add_u32 v10, v35, 2, v9
    ds_write_b32 v10, v31
    v_lshl_add_u32 v9, v9, 2, v35
    ds_write_b8_d16_hi v9, v127 offset:16
    s_add_u32 s47, s34, 0x300c000
    buffer_load_dwordx2 v[84:85], v1, s[16:19], s47 offen nt
    s_add_u32 s44, s34, 0x300e000
    buffer_load_dwordx2 v[86:87], v1, s[16:19], s44 offen nt
    v_add_u32 v7, 0x10000, v0
    v_add_u32 v12, 0x20000, v0
    v_mov_b32 v8, 0
    v_mov_b32 v9, 0
    v_mov_b32 v10, 0
    v_mov_b32 v11, 0
    s_waitcnt lgkmcnt(0)
    s_barrier
    ds_read_b128 v[108:111], v0 offset:0
    ds_write_b128 v0, v[8:11]
    ds_read_b128 v[112:115], v0 offset:16384
    ds_read_b128 v[116:119], v0 offset:32768
    ds_read_b128 v[120:123], v0 offset:49152
    ds_read_b128 v[104:107], v7 offset:0
    ds_read_b128 v[16:19], v7 offset:16384
    ds_read_b128 v[20:23], v7 offset:32768
    ds_read_b128 v[28:31], v7 offset:49152
    ds_read_b128 v[32:35], v12 offset:0
    ds_read_b128 v[124:127], v12 offset:16384
    s_waitcnt lgkmcnt(0)
    s_barrier
    s_add_u32 s45, s35, 0x5480000
    buffer_store_dwordx4 v[108:111], v0, s[20:23], s45 offen sc1
    s_add_u32 s46, s33, 0x601c000
    s_nop 0
    buffer_load_dwordx4 v[108:111], v0, s[8:11], s46 offen nt
    s_add_u32 s47, s35, 0x5484000
    buffer_store_dwordx4 v[112:115], v0, s[20:23], s47 offen sc1
    s_add_u32 s44, s33, 0x601c000
    s_nop 0
    buffer_load_dwordx4 v[112:115], v0, s[12:15], s44 offen nt
    s_waitcnt vmcnt(29)
    v_lshlrev_b32 v7, 16, v24
    v_and_b32 v8, 0xffff0000, v24
    v_lshlrev_b32 v9, 16, v25
    v_and_b32 v10, 0xffff0000, v25
    v_mul_f32 v7, 0.15915494, v7
    v_mul_f32 v8, 0.15915494, v8
    v_mul_f32 v9, 0.15915494, v9
    v_mul_f32 v10, 0.15915494, v10
    v_mul_hi_u32_u24 v14, 429497, v36
    v_lshrrev_b32 v12, 3, v40
    v_cos_f32 v7, v7
    v_lshlrev_b16 v13, 3, v40
    v_mad_i32_i24 v11, v14, s55, v36
    v_bitop3_b32 v12, v6, v13, v12 bitop3:0xca
    v_add_lshl_u32 v11, v11, s40, 17
    v_lshlrev_b16 v14, 8, v14
    v_lshrrev_b32 v13, 2, v40
    v_or_b32 v36, v12, v11
    v_bitop3_b32 v40, v5, v13, v14 bitop3:0xea
    ds_add_u32 v40, v2
    v_mul_hi_u32_u24 v14, 429497, v37
    v_lshrrev_b32 v12, 3, v41
    v_cos_f32 v8, v8
    v_lshlrev_b16 v13, 3, v41
    v_mad_i32_i24 v11, v14, s55, v37
    v_bitop3_b32 v12, v6, v13, v12 bitop3:0xca
    v_add_lshl_u32 v11, v11, s40, 17
    v_lshlrev_b16 v14, 8, v14
    v_lshrrev_b32 v13, 2, v41
    v_or_b32 v37, v12, v11
    v_bitop3_b32 v41, v5, v13, v14 bitop3:0xea
    ds_add_u32 v41, v2
    v_cvt_pk_bf16_f32 v24, v7, v8
    v_perm_b32 v12, v24, v24, s41
    v_bitop3_b32 v36, v4, v12, v36 bitop3:0xca
    v_perm_b32 v13, v24, v24, s42
    v_bitop3_b32 v37, v4, v13, v37 bitop3:0xca
    v_mul_hi_u32_u24 v14, 429497, v38
    v_lshrrev_b32 v12, 3, v42
    v_cos_f32 v9, v9
    v_lshlrev_b16 v13, 3, v42
    v_mad_i32_i24 v11, v14, s55, v38
    v_bitop3_b32 v12, v6, v13, v12 bitop3:0xca
    v_add_lshl_u32 v11, v11, s40, 17
    v_lshlrev_b16 v14, 8, v14
    v_lshrrev_b32 v13, 2, v42
    v_or_b32 v38, v12, v11
    v_bitop3_b32 v42, v5, v13, v14 bitop3:0xea
    ds_add_u32 v42, v2
    v_mul_hi_u32_u24 v14, 429497, v39
    v_lshrrev_b32 v12, 3, v43
    v_cos_f32 v10, v10
    v_lshlrev_b16 v13, 3, v43
    v_mad_i32_i24 v11, v14, s55, v39
    v_bitop3_b32 v12, v6, v13, v12 bitop3:0xca
    v_add_lshl_u32 v11, v11, s40, 17
    v_lshlrev_b16 v14, 8, v14
    v_lshrrev_b32 v13, 2, v43
    v_or_b32 v39, v12, v11
    v_bitop3_b32 v43, v5, v13, v14 bitop3:0xea
    ds_add_u32 v43, v2
    v_cvt_pk_bf16_f32 v25, v9, v10
    v_perm_b32 v12, v25, v25, s41
    v_bitop3_b32 v38, v4, v12, v38 bitop3:0xca
    v_perm_b32 v13, v25, v25, s42
    v_bitop3_b32 v39, v4, v13, v39 bitop3:0xca
    s_add_u32 s45, s35, 0x5488000
    buffer_store_dwordx4 v[116:119], v0, s[20:23], s45 offen sc1
    s_add_u32 s46, s38, 0x0
    s_nop 0
    buffer_load_dwordx4 v[116:119], v0, s[8:11], s46 offen nt
    s_waitcnt vmcnt(27)
    v_lshlrev_b32 v7, 16, v26
    v_and_b32 v8, 0xffff0000, v26
    v_lshlrev_b32 v9, 16, v27
    v_and_b32 v10, 0xffff0000, v27
    v_mul_f32 v7, 0.15915494, v7
    v_mul_f32 v8, 0.15915494, v8
    v_mul_f32 v9, 0.15915494, v9
    v_mul_f32 v10, 0.15915494, v10
    v_mul_hi_u32_u24 v14, 429497, v48
    v_lshrrev_b32 v12, 3, v52
    v_cos_f32 v7, v7
    v_lshlrev_b16 v13, 3, v52
    v_mad_i32_i24 v11, v14, s55, v48
    v_bitop3_b32 v12, v6, v13, v12 bitop3:0xca
    v_add_lshl_u32 v11, v11, s40, 17
    v_lshlrev_b16 v14, 8, v14
    v_lshrrev_b32 v13, 2, v52
    v_or_b32 v48, v12, v11
    v_bitop3_b32 v52, v5, v13, v14 bitop3:0xea
    ds_add_u32 v52, v2
    v_mul_hi_u32_u24 v14, 429497, v49
    v_lshrrev_b32 v12, 3, v53
    v_cos_f32 v8, v8
    v_lshlrev_b16 v13, 3, v53
    v_mad_i32_i24 v11, v14, s55, v49
    v_bitop3_b32 v12, v6, v13, v12 bitop3:0xca
    v_add_lshl_u32 v11, v11, s40, 17
    v_lshlrev_b16 v14, 8, v14
    v_lshrrev_b32 v13, 2, v53
    v_or_b32 v49, v12, v11
    v_bitop3_b32 v53, v5, v13, v14 bitop3:0xea
    ds_add_u32 v53, v2
    v_cvt_pk_bf16_f32 v26, v7, v8
    v_perm_b32 v12, v26, v26, s41
    v_bitop3_b32 v48, v4, v12, v48 bitop3:0xca
    v_perm_b32 v13, v26, v26, s42
    v_bitop3_b32 v49, v4, v13, v49 bitop3:0xca
    v_mul_hi_u32_u24 v14, 429497, v50
    v_lshrrev_b32 v12, 3, v54
    v_cos_f32 v9, v9
    v_lshlrev_b16 v13, 3, v54
    v_mad_i32_i24 v11, v14, s55, v50
    v_bitop3_b32 v12, v6, v13, v12 bitop3:0xca
    v_add_lshl_u32 v11, v11, s40, 17
    v_lshlrev_b16 v14, 8, v14
    v_lshrrev_b32 v13, 2, v54
    v_or_b32 v50, v12, v11
    v_bitop3_b32 v54, v5, v13, v14 bitop3:0xea
    ds_add_u32 v54, v2
    v_mul_hi_u32_u24 v14, 429497, v51
    v_lshrrev_b32 v12, 3, v55
    v_cos_f32 v10, v10
    v_lshlrev_b16 v13, 3, v55
    v_mad_i32_i24 v11, v14, s55, v51
    v_bitop3_b32 v12, v6, v13, v12 bitop3:0xca
    v_add_lshl_u32 v11, v11, s40, 17
    v_lshlrev_b16 v14, 8, v14
    v_lshrrev_b32 v13, 2, v55
    v_or_b32 v51, v12, v11
    v_bitop3_b32 v55, v5, v13, v14 bitop3:0xea
    ds_add_u32 v55, v2
    v_cvt_pk_bf16_f32 v27, v9, v10
    v_perm_b32 v12, v27, v27, s41
    v_bitop3_b32 v50, v4, v12, v50 bitop3:0xca
    v_perm_b32 v13, v27, v27, s42
    v_bitop3_b32 v51, v4, v13, v51 bitop3:0xca
    s_waitcnt vmcnt(18)
    v_lshlrev_b32 v7, 16, v44
    v_and_b32 v8, 0xffff0000, v44
    v_lshlrev_b32 v9, 16, v45
    v_and_b32 v10, 0xffff0000, v45
    v_mul_f32 v7, 0.15915494, v7
    v_mul_f32 v8, 0.15915494, v8
    v_mul_f32 v9, 0.15915494, v9
    v_mul_f32 v10, 0.15915494, v10
    v_mul_hi_u32_u24 v14, 429497, v56
    v_lshrrev_b32 v12, 3, v60
    v_cos_f32 v7, v7
    v_lshlrev_b16 v13, 3, v60
    v_mad_i32_i24 v11, v14, s55, v56
    v_bitop3_b32 v12, v6, v13, v12 bitop3:0xca
    v_add_lshl_u32 v11, v11, s40, 17
    v_lshlrev_b16 v14, 8, v14
    v_lshrrev_b32 v13, 2, v60
    v_or_b32 v56, v12, v11
    v_bitop3_b32 v60, v5, v13, v14 bitop3:0xea
    ds_add_u32 v60, v2
    v_mul_hi_u32_u24 v14, 429497, v57
    v_lshrrev_b32 v12, 3, v61
    v_cos_f32 v8, v8
    v_lshlrev_b16 v13, 3, v61
    v_mad_i32_i24 v11, v14, s55, v57
    v_bitop3_b32 v12, v6, v13, v12 bitop3:0xca
    v_add_lshl_u32 v11, v11, s40, 17
    v_lshlrev_b16 v14, 8, v14
    v_lshrrev_b32 v13, 2, v61
    v_or_b32 v57, v12, v11
    v_bitop3_b32 v61, v5, v13, v14 bitop3:0xea
    ds_add_u32 v61, v2
    v_cvt_pk_bf16_f32 v44, v7, v8
    v_perm_b32 v12, v44, v44, s41
    v_bitop3_b32 v56, v4, v12, v56 bitop3:0xca
    v_perm_b32 v13, v44, v44, s42
    v_bitop3_b32 v57, v4, v13, v57 bitop3:0xca
    v_mul_hi_u32_u24 v14, 429497, v58
    v_lshrrev_b32 v12, 3, v62
    v_cos_f32 v9, v9
    v_lshlrev_b16 v13, 3, v62
    v_mad_i32_i24 v11, v14, s55, v58
    v_bitop3_b32 v12, v6, v13, v12 bitop3:0xca
    v_add_lshl_u32 v11, v11, s40, 17
    v_lshlrev_b16 v14, 8, v14
    v_lshrrev_b32 v13, 2, v62
    v_or_b32 v58, v12, v11
    v_bitop3_b32 v62, v5, v13, v14 bitop3:0xea
    ds_add_u32 v62, v2
    v_mul_hi_u32_u24 v14, 429497, v59
    v_lshrrev_b32 v12, 3, v63
    v_cos_f32 v10, v10
    v_lshlrev_b16 v13, 3, v63
    v_mad_i32_i24 v11, v14, s55, v59
    v_bitop3_b32 v12, v6, v13, v12 bitop3:0xca
    v_add_lshl_u32 v11, v11, s40, 17
    v_lshlrev_b16 v14, 8, v14
    v_lshrrev_b32 v13, 2, v63
    v_or_b32 v59, v12, v11
    v_bitop3_b32 v63, v5, v13, v14 bitop3:0xea
    ds_add_u32 v63, v2
    v_cvt_pk_bf16_f32 v45, v9, v10
    v_perm_b32 v12, v45, v45, s41
    v_bitop3_b32 v58, v4, v12, v58 bitop3:0xca
    v_perm_b32 v13, v45, v45, s42
    v_bitop3_b32 v59, v4, v13, v59 bitop3:0xca
    s_add_u32 s47, s35, 0x548c000
    buffer_store_dwordx4 v[120:123], v0, s[20:23], s47 offen sc1
    s_add_u32 s44, s38, 0x0
    s_nop 0
    buffer_load_dwordx4 v[120:123], v0, s[12:15], s44 offen nt
    s_waitcnt vmcnt(18)
    v_lshlrev_b32 v7, 16, v46
    v_and_b32 v8, 0xffff0000, v46
    v_lshlrev_b32 v9, 16, v47
    v_and_b32 v10, 0xffff0000, v47
    v_mul_f32 v7, 0.15915494, v7
    v_mul_f32 v8, 0.15915494, v8
    v_mul_f32 v9, 0.15915494, v9
    v_mul_f32 v10, 0.15915494, v10
    v_mul_hi_u32_u24 v14, 429497, v68
    v_lshrrev_b32 v12, 3, v72
    v_cos_f32 v7, v7
    v_lshlrev_b16 v13, 3, v72
    v_mad_i32_i24 v11, v14, s55, v68
    v_bitop3_b32 v12, v6, v13, v12 bitop3:0xca
    v_add_lshl_u32 v11, v11, s40, 17
    v_lshlrev_b16 v14, 8, v14
    v_lshrrev_b32 v13, 2, v72
    v_or_b32 v68, v12, v11
    v_bitop3_b32 v72, v5, v13, v14 bitop3:0xea
    ds_add_u32 v72, v2
    v_mul_hi_u32_u24 v14, 429497, v69
    v_lshrrev_b32 v12, 3, v73
    v_cos_f32 v8, v8
    v_lshlrev_b16 v13, 3, v73
    v_mad_i32_i24 v11, v14, s55, v69
    v_bitop3_b32 v12, v6, v13, v12 bitop3:0xca
    v_add_lshl_u32 v11, v11, s40, 17
    v_lshlrev_b16 v14, 8, v14
    v_lshrrev_b32 v13, 2, v73
    v_or_b32 v69, v12, v11
    v_bitop3_b32 v73, v5, v13, v14 bitop3:0xea
    ds_add_u32 v73, v2
    v_cvt_pk_bf16_f32 v46, v7, v8
    v_perm_b32 v12, v46, v46, s41
    v_bitop3_b32 v68, v4, v12, v68 bitop3:0xca
    v_perm_b32 v13, v46, v46, s42
    v_bitop3_b32 v69, v4, v13, v69 bitop3:0xca
    v_mul_hi_u32_u24 v14, 429497, v70
    v_lshrrev_b32 v12, 3, v74
    v_cos_f32 v9, v9
    v_lshlrev_b16 v13, 3, v74
    v_mad_i32_i24 v11, v14, s55, v70
    v_bitop3_b32 v12, v6, v13, v12 bitop3:0xca
    v_add_lshl_u32 v11, v11, s40, 17
    v_lshlrev_b16 v14, 8, v14
    v_lshrrev_b32 v13, 2, v74
    v_or_b32 v70, v12, v11
    v_bitop3_b32 v74, v5, v13, v14 bitop3:0xea
    ds_add_u32 v74, v2
    v_mul_hi_u32_u24 v14, 429497, v71
    v_lshrrev_b32 v12, 3, v75
    v_cos_f32 v10, v10
    v_lshlrev_b16 v13, 3, v75
    v_mad_i32_i24 v11, v14, s55, v71
    v_bitop3_b32 v12, v6, v13, v12 bitop3:0xca
    v_add_lshl_u32 v11, v11, s40, 17
    v_lshlrev_b16 v14, 8, v14
    v_lshrrev_b32 v13, 2, v75
    v_or_b32 v71, v12, v11
    v_bitop3_b32 v75, v5, v13, v14 bitop3:0xea
    ds_add_u32 v75, v2
    v_cvt_pk_bf16_f32 v47, v9, v10
    v_perm_b32 v12, v47, v47, s41
    v_bitop3_b32 v70, v4, v12, v70 bitop3:0xca
    v_perm_b32 v13, v47, v47, s42
    v_bitop3_b32 v71, v4, v13, v71 bitop3:0xca
    s_mov_b32 s68, s56
    s_mov_b32 s69, s57
    s_mov_b32 s70, 0x100
    s_mov_b32 s71, 0x20000
    v_mov_b32 v3, 1
    s_cmp_lg_u32 s32, 15
    s_cbranch_scc1 L1_tk
    s_mov_b64 exec, 1
    buffer_atomic_add v3, off, s[68:71], 0 sc0
    s_mov_b64 exec, -1
L1_tk:
    s_waitcnt vmcnt(14)
    v_lshlrev_b32 v7, 16, v64
    v_and_b32 v8, 0xffff0000, v64
    v_lshlrev_b32 v9, 16, v65
    v_and_b32 v10, 0xffff0000, v65
    v_mul_f32 v7, 0.15915494, v7
    v_mul_f32 v8, 0.15915494, v8
    v_mul_f32 v9, 0.15915494, v9
    v_mul_f32 v10, 0.15915494, v10
    v_mul_hi_u32_u24 v14, 429497, v76
    v_lshrrev_b32 v12, 3, v80
    v_cos_f32 v7, v7
    v_lshlrev_b16 v13, 3, v80
    v_mad_i32_i24 v11, v14, s55, v76
    v_bitop3_b32 v12, v6, v13, v12 bitop3:0xca
    v_add_lshl_u32 v11, v11, s40, 17
    v_lshlrev_b16 v14, 8, v14
    v_lshrrev_b32 v13, 2, v80
    v_or_b32 v76, v12, v11
    v_bitop3_b32 v80, v5, v13, v14 bitop3:0xea
    ds_add_u32 v80, v2
    v_mul_hi_u32_u24 v14, 429497, v77
    v_lshrrev_b32 v12, 3, v81
    v_cos_f32 v8, v8
    v_lshlrev_b16 v13, 3, v81
    v_mad_i32_i24 v11, v14, s55, v77
    v_bitop3_b32 v12, v6, v13, v12 bitop3:0xca
    v_add_lshl_u32 v11, v11, s40, 17
    v_lshlrev_b16 v14, 8, v14
    v_lshrrev_b32 v13, 2, v81
    v_or_b32 v77, v12, v11
    v_bitop3_b32 v81, v5, v13, v14 bitop3:0xea
    ds_add_u32 v81, v2
    v_cvt_pk_bf16_f32 v64, v7, v8
    v_perm_b32 v12, v64, v64, s41
    v_bitop3_b32 v76, v4, v12, v76 bitop3:0xca
    v_perm_b32 v13, v64, v64, s42
    v_bitop3_b32 v77, v4, v13, v77 bitop3:0xca
    v_mul_hi_u32_u24 v14, 429497, v78
    v_lshrrev_b32 v12, 3, v82
    v_cos_f32 v9, v9
    v_lshlrev_b16 v13, 3, v82
    v_mad_i32_i24 v11, v14, s55, v78
    v_bitop3_b32 v12, v6, v13, v12 bitop3:0xca
    v_add_lshl_u32 v11, v11, s40, 17
    v_lshlrev_b16 v14, 8, v14
    v_lshrrev_b32 v13, 2, v82
    v_or_b32 v78, v12, v11
    v_bitop3_b32 v82, v5, v13, v14 bitop3:0xea
    ds_add_u32 v82, v2
    v_mul_hi_u32_u24 v14, 429497, v79
    v_lshrrev_b32 v12, 3, v83
    v_cos_f32 v10, v10
    v_lshlrev_b16 v13, 3, v83
    v_mad_i32_i24 v11, v14, s55, v79
    v_bitop3_b32 v12, v6, v13, v12 bitop3:0xca
    v_add_lshl_u32 v11, v11, s40, 17
    v_lshlrev_b16 v14, 8, v14
    v_lshrrev_b32 v13, 2, v83
    v_or_b32 v79, v12, v11
    v_bitop3_b32 v83, v5, v13, v14 bitop3:0xea
    ds_add_u32 v83, v2
    v_cvt_pk_bf16_f32 v65, v9, v10
    v_perm_b32 v12, v65, v65, s41
    v_bitop3_b32 v78, v4, v12, v78 bitop3:0xca
    v_perm_b32 v13, v65, v65, s42
    v_bitop3_b32 v79, v4, v13, v79 bitop3:0xca
    s_add_u32 s45, s35, 0x5490000
    buffer_store_dwordx4 v[104:107], v0, s[20:23], s45 offen sc1
    s_add_u32 s46, s39, 0x0
    s_nop 0
    buffer_load_dwordx2 v[104:105], v1, s[16:19], s46 offen nt
    s_add_u32 s47, s39, 0x2000
    buffer_load_dwordx2 v[106:107], v1, s[16:19], s47 offen nt
    s_waitcnt vmcnt(15)
    v_lshlrev_b32 v7, 16, v66
    v_and_b32 v8, 0xffff0000, v66
    v_lshlrev_b32 v9, 16, v67
    v_and_b32 v10, 0xffff0000, v67
    v_mul_f32 v7, 0.15915494, v7
    v_mul_f32 v8, 0.15915494, v8
    v_mul_f32 v9, 0.15915494, v9
    v_mul_f32 v10, 0.15915494, v10
    v_mul_hi_u32_u24 v14, 429497, v88
    v_lshrrev_b32 v12, 3, v92
    v_cos_f32 v7, v7
    v_lshlrev_b16 v13, 3, v92
    v_mad_i32_i24 v11, v14, s55, v88
    v_bitop3_b32 v12, v6, v13, v12 bitop3:0xca
    v_add_lshl_u32 v11, v11, s40, 17
    v_lshlrev_b16 v14, 8, v14
    v_lshrrev_b32 v13, 2, v92
    v_or_b32 v88, v12, v11
    v_bitop3_b32 v92, v5, v13, v14 bitop3:0xea
    ds_add_u32 v92, v2
    v_mul_hi_u32_u24 v14, 429497, v89
    v_lshrrev_b32 v12, 3, v93
    v_cos_f32 v8, v8
    v_lshlrev_b16 v13, 3, v93
    v_mad_i32_i24 v11, v14, s55, v89
    v_bitop3_b32 v12, v6, v13, v12 bitop3:0xca
    v_add_lshl_u32 v11, v11, s40, 17
    v_lshlrev_b16 v14, 8, v14
    v_lshrrev_b32 v13, 2, v93
    v_or_b32 v89, v12, v11
    v_bitop3_b32 v93, v5, v13, v14 bitop3:0xea
    ds_add_u32 v93, v2
    v_cvt_pk_bf16_f32 v66, v7, v8
    v_perm_b32 v12, v66, v66, s41
    v_bitop3_b32 v88, v4, v12, v88 bitop3:0xca
    v_perm_b32 v13, v66, v66, s42
    v_bitop3_b32 v89, v4, v13, v89 bitop3:0xca
    v_mul_hi_u32_u24 v14, 429497, v90
    v_lshrrev_b32 v12, 3, v94
    v_cos_f32 v9, v9
    v_lshlrev_b16 v13, 3, v94
    v_mad_i32_i24 v11, v14, s55, v90
    v_bitop3_b32 v12, v6, v13, v12 bitop3:0xca
    v_add_lshl_u32 v11, v11, s40, 17
    v_lshlrev_b16 v14, 8, v14
    v_lshrrev_b32 v13, 2, v94
    v_or_b32 v90, v12, v11
    v_bitop3_b32 v94, v5, v13, v14 bitop3:0xea
    ds_add_u32 v94, v2
    v_mul_hi_u32_u24 v14, 429497, v91
    v_lshrrev_b32 v12, 3, v95
    v_cos_f32 v10, v10
    v_lshlrev_b16 v13, 3, v95
    v_mad_i32_i24 v11, v14, s55, v91
    v_bitop3_b32 v12, v6, v13, v12 bitop3:0xca
    v_add_lshl_u32 v11, v11, s40, 17
    v_lshlrev_b16 v14, 8, v14
    v_lshrrev_b32 v13, 2, v95
    v_or_b32 v91, v12, v11
    v_bitop3_b32 v95, v5, v13, v14 bitop3:0xea
    ds_add_u32 v95, v2
    v_cvt_pk_bf16_f32 v67, v9, v10
    v_perm_b32 v12, v67, v67, s41
    v_bitop3_b32 v90, v4, v12, v90 bitop3:0xca
    v_perm_b32 v13, v67, v67, s42
    v_bitop3_b32 v91, v4, v13, v91 bitop3:0xca
    s_waitcnt vmcnt(11)
    v_lshlrev_b32 v7, 16, v84
    v_and_b32 v8, 0xffff0000, v84
    v_lshlrev_b32 v9, 16, v85
    v_and_b32 v10, 0xffff0000, v85
    v_mul_f32 v7, 0.15915494, v7
    v_mul_f32 v8, 0.15915494, v8
    v_mul_f32 v9, 0.15915494, v9
    v_mul_f32 v10, 0.15915494, v10
    v_mul_hi_u32_u24 v14, 429497, v96
    v_lshrrev_b32 v12, 3, v100
    v_cos_f32 v7, v7
    v_lshlrev_b16 v13, 3, v100
    v_mad_i32_i24 v11, v14, s55, v96
    v_bitop3_b32 v12, v6, v13, v12 bitop3:0xca
    v_add_lshl_u32 v11, v11, s40, 17
    v_lshlrev_b16 v14, 8, v14
    v_lshrrev_b32 v13, 2, v100
    v_or_b32 v96, v12, v11
    v_bitop3_b32 v100, v5, v13, v14 bitop3:0xea
    ds_add_u32 v100, v2
    v_mul_hi_u32_u24 v14, 429497, v97
    v_lshrrev_b32 v12, 3, v101
    v_cos_f32 v8, v8
    v_lshlrev_b16 v13, 3, v101
    v_mad_i32_i24 v11, v14, s55, v97
    v_bitop3_b32 v12, v6, v13, v12 bitop3:0xca
    v_add_lshl_u32 v11, v11, s40, 17
    v_lshlrev_b16 v14, 8, v14
    v_lshrrev_b32 v13, 2, v101
    v_or_b32 v97, v12, v11
    v_bitop3_b32 v101, v5, v13, v14 bitop3:0xea
    ds_add_u32 v101, v2
    v_cvt_pk_bf16_f32 v84, v7, v8
    v_perm_b32 v12, v84, v84, s41
    v_bitop3_b32 v96, v4, v12, v96 bitop3:0xca
    v_perm_b32 v13, v84, v84, s42
    v_bitop3_b32 v97, v4, v13, v97 bitop3:0xca
    v_mul_hi_u32_u24 v14, 429497, v98
    v_lshrrev_b32 v12, 3, v102
    v_cos_f32 v9, v9
    v_lshlrev_b16 v13, 3, v102
    v_mad_i32_i24 v11, v14, s55, v98
    v_bitop3_b32 v12, v6, v13, v12 bitop3:0xca
    v_add_lshl_u32 v11, v11, s40, 17
    v_lshlrev_b16 v14, 8, v14
    v_lshrrev_b32 v13, 2, v102
    v_or_b32 v98, v12, v11
    v_bitop3_b32 v102, v5, v13, v14 bitop3:0xea
    ds_add_u32 v102, v2
    v_mul_hi_u32_u24 v14, 429497, v99
    v_lshrrev_b32 v12, 3, v103
    v_cos_f32 v10, v10
    v_lshlrev_b16 v13, 3, v103
    v_mad_i32_i24 v11, v14, s55, v99
    v_bitop3_b32 v12, v6, v13, v12 bitop3:0xca
    v_add_lshl_u32 v11, v11, s40, 17
    v_lshlrev_b16 v14, 8, v14
    v_lshrrev_b32 v13, 2, v103
    v_or_b32 v99, v12, v11
    v_bitop3_b32 v103, v5, v13, v14 bitop3:0xea
    ds_add_u32 v103, v2
    v_cvt_pk_bf16_f32 v85, v9, v10
    v_perm_b32 v12, v85, v85, s41
    v_bitop3_b32 v98, v4, v12, v98 bitop3:0xca
    v_perm_b32 v13, v85, v85, s42
    v_bitop3_b32 v99, v4, v13, v99 bitop3:0xca
    s_add_u32 s44, s35, 0x5494000
    buffer_store_dwordx4 v[16:19], v0, s[20:23], s44 offen sc1
    s_add_u32 s45, s38, 0x4000
    s_nop 0
    buffer_load_dwordx4 v[16:19], v0, s[8:11], s45 offen nt
    s_waitcnt vmcnt(9)
    v_lshlrev_b32 v7, 16, v86
    v_and_b32 v8, 0xffff0000, v86
    v_lshlrev_b32 v9, 16, v87
    v_and_b32 v10, 0xffff0000, v87
    v_mul_f32 v7, 0.15915494, v7
    v_mul_f32 v8, 0.15915494, v8
    v_mul_f32 v9, 0.15915494, v9
    v_mul_f32 v10, 0.15915494, v10
    v_mul_hi_u32_u24 v14, 429497, v108
    v_lshrrev_b32 v12, 3, v112
    v_cos_f32 v7, v7
    v_lshlrev_b16 v13, 3, v112
    v_mad_i32_i24 v11, v14, s55, v108
    v_bitop3_b32 v12, v6, v13, v12 bitop3:0xca
    v_add_lshl_u32 v11, v11, s40, 17
    v_lshlrev_b16 v14, 8, v14
    v_lshrrev_b32 v13, 2, v112
    v_or_b32 v108, v12, v11
    v_bitop3_b32 v112, v5, v13, v14 bitop3:0xea
    ds_add_u32 v112, v2
    v_mul_hi_u32_u24 v14, 429497, v109
    v_lshrrev_b32 v12, 3, v113
    v_cos_f32 v8, v8
    v_lshlrev_b16 v13, 3, v113
    v_mad_i32_i24 v11, v14, s55, v109
    v_bitop3_b32 v12, v6, v13, v12 bitop3:0xca
    v_add_lshl_u32 v11, v11, s40, 17
    v_lshlrev_b16 v14, 8, v14
    v_lshrrev_b32 v13, 2, v113
    v_or_b32 v109, v12, v11
    v_bitop3_b32 v113, v5, v13, v14 bitop3:0xea
    ds_add_u32 v113, v2
    v_cvt_pk_bf16_f32 v86, v7, v8
    v_perm_b32 v12, v86, v86, s41
    v_bitop3_b32 v108, v4, v12, v108 bitop3:0xca
    v_perm_b32 v13, v86, v86, s42
    v_bitop3_b32 v109, v4, v13, v109 bitop3:0xca
    v_mul_hi_u32_u24 v14, 429497, v110
    v_lshrrev_b32 v12, 3, v114
    v_cos_f32 v9, v9
    v_lshlrev_b16 v13, 3, v114
    v_mad_i32_i24 v11, v14, s55, v110
    v_bitop3_b32 v12, v6, v13, v12 bitop3:0xca
    v_add_lshl_u32 v11, v11, s40, 17
    v_lshlrev_b16 v14, 8, v14
    v_lshrrev_b32 v13, 2, v114
    v_or_b32 v110, v12, v11
    v_bitop3_b32 v114, v5, v13, v14 bitop3:0xea
    ds_add_u32 v114, v2
    v_mul_hi_u32_u24 v14, 429497, v111
    v_lshrrev_b32 v12, 3, v115
    v_cos_f32 v10, v10
    v_lshlrev_b16 v13, 3, v115
    v_mad_i32_i24 v11, v14, s55, v111
    v_bitop3_b32 v12, v6, v13, v12 bitop3:0xca
    v_add_lshl_u32 v11, v11, s40, 17
    v_lshlrev_b16 v14, 8, v14
    v_lshrrev_b32 v13, 2, v115
    v_or_b32 v111, v12, v11
    v_bitop3_b32 v115, v5, v13, v14 bitop3:0xea
    ds_add_u32 v115, v2
    v_cvt_pk_bf16_f32 v87, v9, v10
    v_perm_b32 v12, v87, v87, s41
    v_bitop3_b32 v110, v4, v12, v110 bitop3:0xca
    v_perm_b32 v13, v87, v87, s42
    v_bitop3_b32 v111, v4, v13, v111 bitop3:0xca
    v_lshrrev_b32 v8, 2, v0
    v_and_b32 v7, 0x3c00, v0
    v_bitop3_b32 v7, v5, v8, v7 bitop3:0xea
    s_waitcnt lgkmcnt(0)
    s_barrier
    ds_read2st64_b32 v[8:9], v7 offset0:0 offset1:1
    ds_read2st64_b32 v[10:11], v7 offset0:2 offset1:3
    s_add_u32 s46, s35, 0x5498000
    buffer_store_dwordx4 v[20:23], v0, s[20:23], s46 offen sc1
    s_add_u32 s47, s38, 0x4000
    s_nop 0
    buffer_load_dwordx4 v[20:23], v0, s[12:15], s47 offen nt
    s_waitcnt lgkmcnt(0)
    v_lshl_or_b32 v12, v9, 16, v8
    v_lshl_or_b32 v13, v11, 16, v10
    v_mov_b32 v14, v12
    v_mov_b32 v15, v13
    s_nop 0
    v_add_u32_dpp v14, v14, v14 row_shr:1 row_mask:0xf bank_mask:0xf bound_ctrl:1
    v_add_u32_dpp v15, v15, v15 row_shr:1 row_mask:0xf bank_mask:0xf bound_ctrl:1
    s_nop 0
    v_add_u32_dpp v14, v14, v14 row_shr:2 row_mask:0xf bank_mask:0xf bound_ctrl:1
    v_add_u32_dpp v15, v15, v15 row_shr:2 row_mask:0xf bank_mask:0xf bound_ctrl:1
    s_nop 0
    v_add_u32_dpp v14, v14, v14 row_shr:4 row_mask:0xf bank_mask:0xf bound_ctrl:1
    v_add_u32_dpp v15, v15, v15 row_shr:4 row_mask:0xf bank_mask:0xf bound_ctrl:1
    s_nop 0
    v_add_u32_dpp v14, v14, v14 row_shr:8 row_mask:0xf bank_mask:0xf bound_ctrl:1
    v_add_u32_dpp v15, v15, v15 row_shr:8 row_mask:0xf bank_mask:0xf bound_ctrl:1
    s_nop 0
    v_add_u32_dpp v14, v14, v14 row_bcast:15 row_mask:0xa bank_mask:0xf
    v_add_u32_dpp v15, v15, v15 row_bcast:15 row_mask:0xa bank_mask:0xf
    s_nop 0
    v_add_u32_dpp v14, v14, v14 row_bcast:31 row_mask:0xc bank_mask:0xf
    v_add_u32_dpp v15, v15, v15 row_bcast:31 row_mask:0xc bank_mask:0xf
    v_readlane_b32 s48, v14, 63
    v_readlane_b32 s49, v15, 63
    s_lshl_b32 s54, s32, 2
    v_mov_b32 v8, s54
    s_and_b32 s50, s48, 0xffff
    s_lshr_b32 s51, s48, 16
    s_and_b32 s52, s49, 0xffff
    s_lshr_b32 s53, s49, 16
    s_add_u32 s51, s51, s50
    s_add_u32 s52, s52, s51
    s_add_u32 s53, s53, s52
    v_mov_b32 v9, s53
    s_mov_b64 exec, 1
    ds_write_b32 v8, v9 offset:16384
    s_waitcnt vmcnt(7)
    ds_write_b32 v8, v3 offset:16448
    s_mov_b64 exec, -1
    v_and_b32 v8, 60, v7
    s_waitcnt lgkmcnt(0)
    s_barrier
    ds_read_b32 v9, v8 offset:16384
    ds_read_b32 v10, v8 offset:16448
    s_waitcnt lgkmcnt(0)
    v_readlane_b32 s84, v10, 15
    s_min_u32 s4, s84, 136
    s_min_u32 s5, s84, 176
    s_min_u32 s6, s84, 216
    s_add_u32 s4, s4, s5
    s_add_u32 s4, s4, s6
    s_add_u32 s4, s4, 9467
    s_lshl_b32 s58, s4, 14
    s_lshl_b32 s59, s4, 13
    s_mov_b32 s43, 5
    s_cmp_lt_u32 s84, 136
    s_addc_u32 s43, s43, 0
    s_cmp_lt_u32 s84, 176
    s_addc_u32 s43, s43, 0
    s_cmp_lt_u32 s84, 216
    s_addc_u32 s43, s43, 0
    v_add_u32_dpp v9, v9, v9 row_shr:1 row_mask:0xf bank_mask:0xf bound_ctrl:1
    s_nop 1
    v_add_u32_dpp v9, v9, v9 row_shr:2 row_mask:0xf bank_mask:0xf bound_ctrl:1
    s_nop 1
    v_add_u32_dpp v9, v9, v9 row_shr:4 row_mask:0xf bank_mask:0xf bound_ctrl:1
    s_nop 1
    v_add_u32_dpp v9, v9, v9 row_shr:8 row_mask:0xf bank_mask:0xf bound_ctrl:1
    s_nop 0
    v_readlane_b32 s54, v9, s32
    s_sub_u32 s54, s54, s53
    s_add_u32 s50, s50, s54
    s_add_u32 s51, s51, s54
    s_add_u32 s52, s52, s54
    s_pack_ll_b32_b16 s48, s54, s50
    s_pack_ll_b32_b16 s49, s51, s52
    v_add_u32 v14, s48, v14
    v_add_u32 v15, s49, v15
    v_sub_u32 v12, v14, v12
    v_sub_u32 v13, v15, v13
    v_and_b32 v8, 0xffff, v12
    v_lshrrev_b32 v9, 16, v12
    v_and_b32 v10, 0xffff, v13
    v_lshrrev_b32 v11, 16, v13
    ds_write2st64_b32 v7, v8, v9 offset0:0 offset1:1
    ds_write2st64_b32 v7, v10, v11 offset0:2 offset1:3
    s_waitcnt lgkmcnt(0)
    s_barrier
    ds_add_rtn_u32 v40, v40, v2
    ds_add_rtn_u32 v41, v41, v2
    ds_add_rtn_u32 v42, v42, v2
    ds_add_rtn_u32 v43, v43, v2
    s_add_u32 s44, s36, 0x7ec0000
    v_and_b32 v11, 0x3f0, v0
    v_add_u32 v11, v11, v11
    buffer_store_dwordx2 v[12:13], v11, s[24:27], s44 offen
    s_bitset0_b64 exec, 63
    s_not_b64 exec, exec
    buffer_store_dwordx2 v[14:15], v11, s[24:27], s44 offen offset:32
    s_mov_b64 exec, -1
    ds_add_rtn_u32 v52, v52, v2
    ds_add_rtn_u32 v53, v53, v2
    ds_add_rtn_u32 v54, v54, v2
    ds_add_rtn_u32 v55, v55, v2
    ds_add_rtn_u32 v60, v60, v2
    ds_add_rtn_u32 v61, v61, v2
    ds_add_rtn_u32 v62, v62, v2
    ds_add_rtn_u32 v63, v63, v2
    s_add_u32 s45, s35, 0x549c000
    buffer_store_dwordx4 v[28:31], v0, s[20:23], s45 offen sc1
    s_add_u32 s46, s38, 0x8000
    s_nop 0
    buffer_load_dwordx4 v[28:31], v0, s[8:11], s46 offen nt
    ds_add_rtn_u32 v72, v72, v2
    ds_add_rtn_u32 v73, v73, v2
    ds_add_rtn_u32 v74, v74, v2
    ds_add_rtn_u32 v75, v75, v2
    ds_add_rtn_u32 v80, v80, v2
    ds_add_rtn_u32 v81, v81, v2
    ds_add_rtn_u32 v82, v82, v2
    ds_add_rtn_u32 v83, v83, v2
    s_add_u32 s47, s35, 0x54a0000
    buffer_store_dwordx4 v[32:35], v0, s[20:23], s47 offen sc1
    s_add_u32 s44, s38, 0x8000
    s_nop 0
    buffer_load_dwordx4 v[32:35], v0, s[12:15], s44 offen nt
    ds_add_rtn_u32 v92, v92, v2
    ds_add_rtn_u32 v93, v93, v2
    ds_add_rtn_u32 v94, v94, v2
    ds_add_rtn_u32 v95, v95, v2
    ds_add_rtn_u32 v100, v100, v2
    ds_add_rtn_u32 v101, v101, v2
    ds_add_rtn_u32 v102, v102, v2
    ds_add_rtn_u32 v103, v103, v2
    s_add_u32 s45, s35, 0x54a4000
    buffer_store_dwordx4 v[124:127], v0, s[20:23], s45 offen sc1
    s_add_u32 s46, s39, 0x4000
    s_nop 0
    buffer_load_dwordx2 v[124:125], v1, s[16:19], s46 offen nt
    s_add_u32 s47, s39, 0x6000
    buffer_load_dwordx2 v[126:127], v1, s[16:19], s47 offen nt
    ds_add_rtn_u32 v112, v112, v2
    ds_add_rtn_u32 v113, v113, v2
    ds_add_rtn_u32 v114, v114, v2
    ds_add_rtn_u32 v115, v115, v2
    s_waitcnt lgkmcnt(0)
    s_barrier
    v_and_b32 v7, -4, v40
    v_lshl_add_u32 v8, v40, 2, v7
    ds_write_b32 v8, v36
    v_lshl_add_u32 v7, v7, 2, v40
    ds_write_b8 v7, v24 offset:16
    v_and_b32 v9, -4, v41
    v_lshl_add_u32 v10, v41, 2, v9
    ds_write_b32 v10, v37
    v_lshl_add_u32 v9, v9, 2, v41
    ds_write_b8_d16_hi v9, v24 offset:16
    v_and_b32 v7, -4, v42
    v_lshl_add_u32 v8, v42, 2, v7
    ds_write_b32 v8, v38
    v_lshl_add_u32 v7, v7, 2, v42
    ds_write_b8 v7, v25 offset:16
    v_and_b32 v9, -4, v43
    v_lshl_add_u32 v10, v43, 2, v9
    ds_write_b32 v10, v39
    v_lshl_add_u32 v9, v9, 2, v43
    ds_write_b8_d16_hi v9, v25 offset:16
    s_add_u32 s44, s38, 0xc000
    buffer_load_dwordx4 v[36:39], v0, s[8:11], s44 offen nt
    s_add_u32 s45, s38, 0xc000
    buffer_load_dwordx4 v[40:43], v0, s[12:15], s45 offen nt
    v_and_b32 v7, -4, v52
    v_lshl_add_u32 v8, v52, 2, v7
    ds_write_b32 v8, v48
    v_lshl_add_u32 v7, v7, 2, v52
    ds_write_b8 v7, v26 offset:16
    v_and_b32 v9, -4, v53
    v_lshl_add_u32 v10, v53, 2, v9
    ds_write_b32 v10, v49
    v_lshl_add_u32 v9, v9, 2, v53
    ds_write_b8_d16_hi v9, v26 offset:16
    v_and_b32 v7, -4, v54
    v_lshl_add_u32 v8, v54, 2, v7
    ds_write_b32 v8, v50
    v_lshl_add_u32 v7, v7, 2, v54
    ds_write_b8 v7, v27 offset:16
    v_and_b32 v9, -4, v55
    v_lshl_add_u32 v10, v55, 2, v9
    ds_write_b32 v10, v51
    v_lshl_add_u32 v9, v9, 2, v55
    ds_write_b8_d16_hi v9, v27 offset:16
    s_add_u32 s46, s38, 0x10000
    buffer_load_dwordx4 v[48:51], v0, s[8:11], s46 offen nt
    v_and_b32 v7, -4, v60
    v_lshl_add_u32 v8, v60, 2, v7
    ds_write_b32 v8, v56
    v_lshl_add_u32 v7, v7, 2, v60
    ds_write_b8 v7, v44 offset:16
    v_and_b32 v9, -4, v61
    v_lshl_add_u32 v10, v61, 2, v9
    ds_write_b32 v10, v57
    v_lshl_add_u32 v9, v9, 2, v61
    ds_write_b8_d16_hi v9, v44 offset:16
    v_and_b32 v7, -4, v62
    v_lshl_add_u32 v8, v62, 2, v7
    ds_write_b32 v8, v58
    v_lshl_add_u32 v7, v7, 2, v62
    ds_write_b8 v7, v45 offset:16
    v_and_b32 v9, -4, v63
    v_lshl_add_u32 v10, v63, 2, v9
    ds_write_b32 v10, v59
    v_lshl_add_u32 v9, v9, 2, v63
    ds_write_b8_d16_hi v9, v45 offset:16
    s_add_u32 s47, s38, 0x10000
    buffer_load_dwordx4 v[52:55], v0, s[12:15], s47 offen nt
    v_and_b32 v7, -4, v72
    v_lshl_add_u32 v8, v72, 2, v7
    ds_write_b32 v8, v68
    v_lshl_add_u32 v7, v7, 2, v72
    ds_write_b8 v7, v46 offset:16
    v_and_b32 v9, -4, v73
    v_lshl_add_u32 v10, v73, 2, v9
    ds_write_b32 v10, v69
    v_lshl_add_u32 v9, v9, 2, v73
    ds_write_b8_d16_hi v9, v46 offset:16
    v_and_b32 v7, -4, v74
    v_lshl_add_u32 v8, v74, 2, v7
    ds_write_b32 v8, v70
    v_lshl_add_u32 v7, v7, 2, v74
    ds_write_b8 v7, v47 offset:16
    v_and_b32 v9, -4, v75
    v_lshl_add_u32 v10, v75, 2, v9
    ds_write_b32 v10, v71
    v_lshl_add_u32 v9, v9, 2, v75
    ds_write_b8_d16_hi v9, v47 offset:16
    s_add_u32 s44, s39, 0x8000
    buffer_load_dwordx2 v[24:25], v1, s[16:19], s44 offen nt
    s_cmp_le_u32 s43, 5
    s_cselect_b32 s18, 0, s18
    s_add_u32 s45, s59, 0xa000
    buffer_load_dwordx2 v[26:27], v1, s[16:19], s45 offen nt
    v_and_b32 v7, -4, v80
    v_lshl_add_u32 v8, v80, 2, v7
    ds_write_b32 v8, v76
    v_lshl_add_u32 v7, v7, 2, v80
    ds_write_b8 v7, v64 offset:16
    v_and_b32 v9, -4, v81
    v_lshl_add_u32 v10, v81, 2, v9
    ds_write_b32 v10, v77
    v_lshl_add_u32 v9, v9, 2, v81
    ds_write_b8_d16_hi v9, v64 offset:16
    v_and_b32 v7, -4, v82
    v_lshl_add_u32 v8, v82, 2, v7
    ds_write_b32 v8, v78
    v_lshl_add_u32 v7, v7, 2, v82
    ds_write_b8 v7, v65 offset:16
    v_and_b32 v9, -4, v83
    v_lshl_add_u32 v10, v83, 2, v9
    ds_write_b32 v10, v79
    v_lshl_add_u32 v9, v9, 2, v83
    ds_write_b8_d16_hi v9, v65 offset:16
    s_cmp_le_u32 s43, 5
    s_cselect_b32 s10, 0, s10
    s_add_u32 s46, s58, 0x14000
    buffer_load_dwordx4 v[56:59], v0, s[8:11], s46 offen nt
    s_cmp_le_u32 s43, 5
    s_cselect_b32 s14, 0, s14
    s_add_u32 s47, s58, 0x14000
    buffer_load_dwordx4 v[60:63], v0, s[12:15], s47 offen nt
    v_and_b32 v7, -4, v92
    v_lshl_add_u32 v8, v92, 2, v7
    ds_write_b32 v8, v88
    v_lshl_add_u32 v7, v7, 2, v92
    ds_write_b8 v7, v66 offset:16
    v_and_b32 v9, -4, v93
    v_lshl_add_u32 v10, v93, 2, v9
    ds_write_b32 v10, v89
    v_lshl_add_u32 v9, v9, 2, v93
    ds_write_b8_d16_hi v9, v66 offset:16
    v_and_b32 v7, -4, v94
    v_lshl_add_u32 v8, v94, 2, v7
    ds_write_b32 v8, v90
    v_lshl_add_u32 v7, v7, 2, v94
    ds_write_b8 v7, v67 offset:16
    v_and_b32 v9, -4, v95
    v_lshl_add_u32 v10, v95, 2, v9
    ds_write_b32 v10, v91
    v_lshl_add_u32 v9, v9, 2, v95
    ds_write_b8_d16_hi v9, v67 offset:16
    s_cmp_le_u32 s43, 6
    s_cselect_b32 s10, 0, s10
    s_add_u32 s44, s58, 0x18000
    buffer_load_dwordx4 v[68:71], v0, s[8:11], s44 offen nt
    v_and_b32 v7, -4, v100
    v_lshl_add_u32 v8, v100, 2, v7
    ds_write_b32 v8, v96
    v_lshl_add_u32 v7, v7, 2, v100
    ds_write_b8 v7, v84 offset:16
    v_and_b32 v9, -4, v101
    v_lshl_add_u32 v10, v101, 2, v9
    ds_write_b32 v10, v97
    v_lshl_add_u32 v9, v9, 2, v101
    ds_write_b8_d16_hi v9, v84 offset:16
    v_and_b32 v7, -4, v102
    v_lshl_add_u32 v8, v102, 2, v7
    ds_write_b32 v8, v98
    v_lshl_add_u32 v7, v7, 2, v102
    ds_write_b8 v7, v85 offset:16
    v_and_b32 v9, -4, v103
    v_lshl_add_u32 v10, v103, 2, v9
    ds_write_b32 v10, v99
    v_lshl_add_u32 v9, v9, 2, v103
    ds_write_b8_d16_hi v9, v85 offset:16
    s_cmp_le_u32 s43, 6
    s_cselect_b32 s14, 0, s14
    s_add_u32 s45, s58, 0x18000
    buffer_load_dwordx4 v[72:75], v0, s[12:15], s45 offen nt
    v_and_b32 v7, -4, v112
    v_lshl_add_u32 v8, v112, 2, v7
    ds_write_b32 v8, v108
    v_lshl_add_u32 v7, v7, 2, v112
    ds_write_b8 v7, v86 offset:16
    v_and_b32 v9, -4, v113
    v_lshl_add_u32 v10, v113, 2, v9
    ds_write_b32 v10, v109
    v_lshl_add_u32 v9, v9, 2, v113
    ds_write_b8_d16_hi v9, v86 offset:16
    v_and_b32 v7, -4, v114
    v_lshl_add_u32 v8, v114, 2, v7
    ds_write_b32 v8, v110
    v_lshl_add_u32 v7, v7, 2, v114
    ds_write_b8 v7, v87 offset:16
    v_and_b32 v9, -4, v115
    v_lshl_add_u32 v10, v115, 2, v9
    ds_write_b32 v10, v111
    v_lshl_add_u32 v9, v9, 2, v115
    ds_write_b8_d16_hi v9, v87 offset:16
    s_cmp_le_u32 s43, 6
    s_cselect_b32 s18, 0, s18
    s_add_u32 s46, s59, 0xc000
    buffer_load_dwordx2 v[44:45], v1, s[16:19], s46 offen nt
    s_cmp_le_u32 s43, 7
    s_cselect_b32 s18, 0, s18
    s_add_u32 s47, s59, 0xe000
    buffer_load_dwordx2 v[46:47], v1, s[16:19], s47 offen nt
    v_add_u32 v7, 0x10000, v0
    v_add_u32 v12, 0x20000, v0
    v_mov_b32 v8, 0
    v_mov_b32 v9, 0
    v_mov_b32 v10, 0
    v_mov_b32 v11, 0
    s_waitcnt lgkmcnt(0)
    s_barrier
    ds_read_b128 v[76:79], v0 offset:0
    ds_write_b128 v0, v[8:11]
    ds_read_b128 v[80:83], v0 offset:16384
    ds_read_b128 v[88:91], v0 offset:32768
    ds_read_b128 v[92:95], v0 offset:49152
    ds_read_b128 v[64:67], v7 offset:0
    ds_read_b128 v[96:99], v7 offset:16384
    ds_read_b128 v[100:103], v7 offset:32768
    ds_read_b128 v[108:111], v7 offset:49152
    ds_read_b128 v[112:115], v12 offset:0
    ds_read_b128 v[84:87], v12 offset:16384
    s_waitcnt lgkmcnt(0)
    s_barrier
    s_add_u32 s44, s35, 0x7ec0000
    buffer_store_dwordx4 v[76:79], v0, s[20:23], s44 offen sc1
    s_cmp_le_u32 s43, 7
    s_cselect_b32 s10, 0, s10
    s_add_u32 s45, s58, 0x1c000
    buffer_load_dwordx4 v[76:79], v0, s[8:11], s45 offen nt
    s_add_u32 s46, s35, 0x7ec4000
    buffer_store_dwordx4 v[80:83], v0, s[20:23], s46 offen sc1
    s_cmp_le_u32 s43, 7
    s_cselect_b32 s14, 0, s14
    s_add_u32 s47, s58, 0x1c000
    buffer_load_dwordx4 v[80:83], v0, s[12:15], s47 offen nt
    s_waitcnt vmcnt(29)
    v_lshlrev_b32 v7, 16, v104
    v_and_b32 v8, 0xffff0000, v104
    v_lshlrev_b32 v9, 16, v105
    v_and_b32 v10, 0xffff0000, v105
    v_mul_f32 v7, 0.15915494, v7
    v_mul_f32 v8, 0.15915494, v8
    v_mul_f32 v9, 0.15915494, v9
    v_mul_f32 v10, 0.15915494, v10
    v_mul_hi_u32_u24 v14, 429497, v116
    v_lshrrev_b32 v12, 3, v120
    v_cos_f32 v7, v7
    v_lshlrev_b16 v13, 3, v120
    v_mad_i32_i24 v11, v14, s55, v116
    v_bitop3_b32 v12, v6, v13, v12 bitop3:0xca
    v_add_lshl_u32 v11, v11, s40, 17
    v_lshlrev_b16 v14, 8, v14
    v_lshrrev_b32 v13, 2, v120
    v_or_b32 v116, v12, v11
    v_bitop3_b32 v120, v5, v13, v14 bitop3:0xea
    ds_add_u32 v120, v2
    v_mul_hi_u32_u24 v14, 429497, v117
    v_lshrrev_b32 v12, 3, v121
    v_cos_f32 v8, v8
    v_lshlrev_b16 v13, 3, v121
    v_mad_i32_i24 v11, v14, s55, v117
    v_bitop3_b32 v12, v6, v13, v12 bitop3:0xca
    v_add_lshl_u32 v11, v11, s40, 17
    v_lshlrev_b16 v14, 8, v14
    v_lshrrev_b32 v13, 2, v121
    v_or_b32 v117, v12, v11
    v_bitop3_b32 v121, v5, v13, v14 bitop3:0xea
    ds_add_u32 v121, v2
    v_cvt_pk_bf16_f32 v104, v7, v8
    v_perm_b32 v12, v104, v104, s41
    v_bitop3_b32 v116, v4, v12, v116 bitop3:0xca
    v_perm_b32 v13, v104, v104, s42
    v_bitop3_b32 v117, v4, v13, v117 bitop3:0xca
    v_mul_hi_u32_u24 v14, 429497, v118
    v_lshrrev_b32 v12, 3, v122
    v_cos_f32 v9, v9
    v_lshlrev_b16 v13, 3, v122
    v_mad_i32_i24 v11, v14, s55, v118
    v_bitop3_b32 v12, v6, v13, v12 bitop3:0xca
    v_add_lshl_u32 v11, v11, s40, 17
    v_lshlrev_b16 v14, 8, v14
    v_lshrrev_b32 v13, 2, v122
    v_or_b32 v118, v12, v11
    v_bitop3_b32 v122, v5, v13, v14 bitop3:0xea
    ds_add_u32 v122, v2
    v_mul_hi_u32_u24 v14, 429497, v119
    v_lshrrev_b32 v12, 3, v123
    v_cos_f32 v10, v10
    v_lshlrev_b16 v13, 3, v123
    v_mad_i32_i24 v11, v14, s55, v119
    v_bitop3_b32 v12, v6, v13, v12 bitop3:0xca
    v_add_lshl_u32 v11, v11, s40, 17
    v_lshlrev_b16 v14, 8, v14
    v_lshrrev_b32 v13, 2, v123
    v_or_b32 v119, v12, v11
    v_bitop3_b32 v123, v5, v13, v14 bitop3:0xea
    ds_add_u32 v123, v2
    v_cvt_pk_bf16_f32 v105, v9, v10
    v_perm_b32 v12, v105, v105, s41
    v_bitop3_b32 v118, v4, v12, v118 bitop3:0xca
    v_perm_b32 v13, v105, v105, s42
    v_bitop3_b32 v119, v4, v13, v119 bitop3:0xca
    s_add_u32 s44, s35, 0x7ec8000
    buffer_store_dwordx4 v[88:91], v0, s[20:23], s44 offen sc1
    s_waitcnt vmcnt(26)
    v_lshlrev_b32 v7, 16, v106
    v_and_b32 v8, 0xffff0000, v106
    v_lshlrev_b32 v9, 16, v107
    v_and_b32 v10, 0xffff0000, v107
    v_mul_f32 v7, 0.15915494, v7
    v_mul_f32 v8, 0.15915494, v8
    v_mul_f32 v9, 0.15915494, v9
    v_mul_f32 v10, 0.15915494, v10
    v_mul_hi_u32_u24 v14, 429497, v16
    v_lshrrev_b32 v12, 3, v20
    v_cos_f32 v7, v7
    v_lshlrev_b16 v13, 3, v20
    v_mad_i32_i24 v11, v14, s55, v16
    v_bitop3_b32 v12, v6, v13, v12 bitop3:0xca
    v_add_lshl_u32 v11, v11, s40, 17
    v_lshlrev_b16 v14, 8, v14
    v_lshrrev_b32 v13, 2, v20
    v_or_b32 v16, v12, v11
    v_bitop3_b32 v20, v5, v13, v14 bitop3:0xea
    ds_add_u32 v20, v2
    v_mul_hi_u32_u24 v14, 429497, v17
    v_lshrrev_b32 v12, 3, v21
    v_cos_f32 v8, v8
    v_lshlrev_b16 v13, 3, v21
    v_mad_i32_i24 v11, v14, s55, v17
    v_bitop3_b32 v12, v6, v13, v12 bitop3:0xca
    v_add_lshl_u32 v11, v11, s40, 17
    v_lshlrev_b16 v14, 8, v14
    v_lshrrev_b32 v13, 2, v21
    v_or_b32 v17, v12, v11
    v_bitop3_b32 v21, v5, v13, v14 bitop3:0xea
    ds_add_u32 v21, v2
    v_cvt_pk_bf16_f32 v106, v7, v8
    v_perm_b32 v12, v106, v106, s41
    v_bitop3_b32 v16, v4, v12, v16 bitop3:0xca
    v_perm_b32 v13, v106, v106, s42
    v_bitop3_b32 v17, v4, v13, v17 bitop3:0xca
    v_mul_hi_u32_u24 v14, 429497, v18
    v_lshrrev_b32 v12, 3, v22
    v_cos_f32 v9, v9
    v_lshlrev_b16 v13, 3, v22
    v_mad_i32_i24 v11, v14, s55, v18
    v_bitop3_b32 v12, v6, v13, v12 bitop3:0xca
    v_add_lshl_u32 v11, v11, s40, 17
    v_lshlrev_b16 v14, 8, v14
    v_lshrrev_b32 v13, 2, v22
    v_or_b32 v18, v12, v11
    v_bitop3_b32 v22, v5, v13, v14 bitop3:0xea
    ds_add_u32 v22, v2
    v_mul_hi_u32_u24 v14, 429497, v19
    v_lshrrev_b32 v12, 3, v23
    v_cos_f32 v10, v10
    v_lshlrev_b16 v13, 3, v23
    v_mad_i32_i24 v11, v14, s55, v19
    v_bitop3_b32 v12, v6, v13, v12 bitop3:0xca
    v_add_lshl_u32 v11, v11, s40, 17
    v_lshlrev_b16 v14, 8, v14
    v_lshrrev_b32 v13, 2, v23
    v_or_b32 v19, v12, v11
    v_bitop3_b32 v23, v5, v13, v14 bitop3:0xea
    ds_add_u32 v23, v2
    v_cvt_pk_bf16_f32 v107, v9, v10
    v_perm_b32 v12, v107, v107, s41
    v_bitop3_b32 v18, v4, v12, v18 bitop3:0xca
    v_perm_b32 v13, v107, v107, s42
    v_bitop3_b32 v19, v4, v13, v19 bitop3:0xca
    s_waitcnt vmcnt(17)
    v_lshlrev_b32 v7, 16, v124
    v_and_b32 v8, 0xffff0000, v124
    v_lshlrev_b32 v9, 16, v125
    v_and_b32 v10, 0xffff0000, v125
    v_mul_f32 v7, 0.15915494, v7
    v_mul_f32 v8, 0.15915494, v8
    v_mul_f32 v9, 0.15915494, v9
    v_mul_f32 v10, 0.15915494, v10
    v_mul_hi_u32_u24 v14, 429497, v28
    v_lshrrev_b32 v12, 3, v32
    v_cos_f32 v7, v7
    v_lshlrev_b16 v13, 3, v32
    v_mad_i32_i24 v11, v14, s55, v28
    v_bitop3_b32 v12, v6, v13, v12 bitop3:0xca
    v_add_lshl_u32 v11, v11, s40, 17
    v_lshlrev_b16 v14, 8, v14
    v_lshrrev_b32 v13, 2, v32
    v_or_b32 v28, v12, v11
    v_bitop3_b32 v32, v5, v13, v14 bitop3:0xea
    ds_add_u32 v32, v2
    v_mul_hi_u32_u24 v14, 429497, v29
    v_lshrrev_b32 v12, 3, v33
    v_cos_f32 v8, v8
    v_lshlrev_b16 v13, 3, v33
    v_mad_i32_i24 v11, v14, s55, v29
    v_bitop3_b32 v12, v6, v13, v12 bitop3:0xca
    v_add_lshl_u32 v11, v11, s40, 17
    v_lshlrev_b16 v14, 8, v14
    v_lshrrev_b32 v13, 2, v33
    v_or_b32 v29, v12, v11
    v_bitop3_b32 v33, v5, v13, v14 bitop3:0xea
    ds_add_u32 v33, v2
    v_cvt_pk_bf16_f32 v124, v7, v8
    v_perm_b32 v12, v124, v124, s41
    v_bitop3_b32 v28, v4, v12, v28 bitop3:0xca
    v_perm_b32 v13, v124, v124, s42
    v_bitop3_b32 v29, v4, v13, v29 bitop3:0xca
    v_mul_hi_u32_u24 v14, 429497, v30
    v_lshrrev_b32 v12, 3, v34
    v_cos_f32 v9, v9
    v_lshlrev_b16 v13, 3, v34
    v_mad_i32_i24 v11, v14, s55, v30
    v_bitop3_b32 v12, v6, v13, v12 bitop3:0xca
    v_add_lshl_u32 v11, v11, s40, 17
    v_lshlrev_b16 v14, 8, v14
    v_lshrrev_b32 v13, 2, v34
    v_or_b32 v30, v12, v11
    v_bitop3_b32 v34, v5, v13, v14 bitop3:0xea
    ds_add_u32 v34, v2
    v_mul_hi_u32_u24 v14, 429497, v31
    v_lshrrev_b32 v12, 3, v35
    v_cos_f32 v10, v10
    v_lshlrev_b16 v13, 3, v35
    v_mad_i32_i24 v11, v14, s55, v31
    v_bitop3_b32 v12, v6, v13, v12 bitop3:0xca
    v_add_lshl_u32 v11, v11, s40, 17
    v_lshlrev_b16 v14, 8, v14
    v_lshrrev_b32 v13, 2, v35
    v_or_b32 v31, v12, v11
    v_bitop3_b32 v35, v5, v13, v14 bitop3:0xea
    ds_add_u32 v35, v2
    v_cvt_pk_bf16_f32 v125, v9, v10
    v_perm_b32 v12, v125, v125, s41
    v_bitop3_b32 v30, v4, v12, v30 bitop3:0xca
    v_perm_b32 v13, v125, v125, s42
    v_bitop3_b32 v31, v4, v13, v31 bitop3:0xca
    s_waitcnt vmcnt(15)
    v_lshlrev_b32 v7, 16, v126
    v_and_b32 v8, 0xffff0000, v126
    v_lshlrev_b32 v9, 16, v127
    v_and_b32 v10, 0xffff0000, v127
    v_mul_f32 v7, 0.15915494, v7
    v_mul_f32 v8, 0.15915494, v8
    v_mul_f32 v9, 0.15915494, v9
    v_mul_f32 v10, 0.15915494, v10
    v_mul_hi_u32_u24 v14, 429497, v36
    v_lshrrev_b32 v12, 3, v40
    v_cos_f32 v7, v7
    v_lshlrev_b16 v13, 3, v40
    v_mad_i32_i24 v11, v14, s55, v36
    v_bitop3_b32 v12, v6, v13, v12 bitop3:0xca
    v_add_lshl_u32 v11, v11, s40, 17
    v_lshlrev_b16 v14, 8, v14
    v_lshrrev_b32 v13, 2, v40
    v_or_b32 v36, v12, v11
    v_bitop3_b32 v40, v5, v13, v14 bitop3:0xea
    ds_add_u32 v40, v2
    v_mul_hi_u32_u24 v14, 429497, v37
    v_lshrrev_b32 v12, 3, v41
    v_cos_f32 v8, v8
    v_lshlrev_b16 v13, 3, v41
    v_mad_i32_i24 v11, v14, s55, v37
    v_bitop3_b32 v12, v6, v13, v12 bitop3:0xca
    v_add_lshl_u32 v11, v11, s40, 17
    v_lshlrev_b16 v14, 8, v14
    v_lshrrev_b32 v13, 2, v41
    v_or_b32 v37, v12, v11
    v_bitop3_b32 v41, v5, v13, v14 bitop3:0xea
    ds_add_u32 v41, v2
    v_cvt_pk_bf16_f32 v126, v7, v8
    v_perm_b32 v12, v126, v126, s41
    v_bitop3_b32 v36, v4, v12, v36 bitop3:0xca
    v_perm_b32 v13, v126, v126, s42
    v_bitop3_b32 v37, v4, v13, v37 bitop3:0xca
    v_mul_hi_u32_u24 v14, 429497, v38
    v_lshrrev_b32 v12, 3, v42
    v_cos_f32 v9, v9
    v_lshlrev_b16 v13, 3, v42
    v_mad_i32_i24 v11, v14, s55, v38
    v_bitop3_b32 v12, v6, v13, v12 bitop3:0xca
    v_add_lshl_u32 v11, v11, s40, 17
    v_lshlrev_b16 v14, 8, v14
    v_lshrrev_b32 v13, 2, v42
    v_or_b32 v38, v12, v11
    v_bitop3_b32 v42, v5, v13, v14 bitop3:0xea
    ds_add_u32 v42, v2
    v_mul_hi_u32_u24 v14, 429497, v39
    v_lshrrev_b32 v12, 3, v43
    v_cos_f32 v10, v10
    v_lshlrev_b16 v13, 3, v43
    v_mad_i32_i24 v11, v14, s55, v39
    v_bitop3_b32 v12, v6, v13, v12 bitop3:0xca
    v_add_lshl_u32 v11, v11, s40, 17
    v_lshlrev_b16 v14, 8, v14
    v_lshrrev_b32 v13, 2, v43
    v_or_b32 v39, v12, v11
    v_bitop3_b32 v43, v5, v13, v14 bitop3:0xea
    ds_add_u32 v43, v2
    v_cvt_pk_bf16_f32 v127, v9, v10
    v_perm_b32 v12, v127, v127, s41
    v_bitop3_b32 v38, v4, v12, v38 bitop3:0xca
    v_perm_b32 v13, v127, v127, s42
    v_bitop3_b32 v39, v4, v13, v39 bitop3:0xca
    s_add_u32 s45, s35, 0x7ecc000
    buffer_store_dwordx4 v[92:95], v0, s[20:23], s45 offen sc1
    buffer_load_dwordx4 v[88:91], v0, s[80:83], 0 offen
    v_add_u32 v15, 0x4000, v0
    buffer_load_dwordx4 v[88:91], v15, s[80:83], 0 offen
    s_waitcnt vmcnt(14)
    v_lshlrev_b32 v7, 16, v24
    v_and_b32 v8, 0xffff0000, v24
    v_lshlrev_b32 v9, 16, v25
    v_and_b32 v10, 0xffff0000, v25
    v_mul_f32 v7, 0.15915494, v7
    v_mul_f32 v8, 0.15915494, v8
    v_mul_f32 v9, 0.15915494, v9
    v_mul_f32 v10, 0.15915494, v10
    v_mul_hi_u32_u24 v14, 429497, v48
    v_lshrrev_b32 v12, 3, v52
    v_cos_f32 v7, v7
    v_lshlrev_b16 v13, 3, v52
    v_mad_i32_i24 v11, v14, s55, v48
    v_bitop3_b32 v12, v6, v13, v12 bitop3:0xca
    v_add_lshl_u32 v11, v11, s40, 17
    v_lshlrev_b16 v14, 8, v14
    v_lshrrev_b32 v13, 2, v52
    v_or_b32 v48, v12, v11
    v_bitop3_b32 v52, v5, v13, v14 bitop3:0xea
    ds_add_u32 v52, v2
    v_mul_hi_u32_u24 v14, 429497, v49
    v_lshrrev_b32 v12, 3, v53
    v_cos_f32 v8, v8
    v_lshlrev_b16 v13, 3, v53
    v_mad_i32_i24 v11, v14, s55, v49
    v_bitop3_b32 v12, v6, v13, v12 bitop3:0xca
    v_add_lshl_u32 v11, v11, s40, 17
    v_lshlrev_b16 v14, 8, v14
    v_lshrrev_b32 v13, 2, v53
    v_or_b32 v49, v12, v11
    v_bitop3_b32 v53, v5, v13, v14 bitop3:0xea
    ds_add_u32 v53, v2
    v_cvt_pk_bf16_f32 v24, v7, v8
    v_perm_b32 v12, v24, v24, s41
    v_bitop3_b32 v48, v4, v12, v48 bitop3:0xca
    v_perm_b32 v13, v24, v24, s42
    v_bitop3_b32 v49, v4, v13, v49 bitop3:0xca
    v_mul_hi_u32_u24 v14, 429497, v50
    v_lshrrev_b32 v12, 3, v54
    v_cos_f32 v9, v9
    v_lshlrev_b16 v13, 3, v54
    v_mad_i32_i24 v11, v14, s55, v50
    v_bitop3_b32 v12, v6, v13, v12 bitop3:0xca
    v_add_lshl_u32 v11, v11, s40, 17
    v_lshlrev_b16 v14, 8, v14
    v_lshrrev_b32 v13, 2, v54
    v_or_b32 v50, v12, v11
    v_bitop3_b32 v54, v5, v13, v14 bitop3:0xea
    ds_add_u32 v54, v2
    v_mul_hi_u32_u24 v14, 429497, v51
    v_lshrrev_b32 v12, 3, v55
    v_cos_f32 v10, v10
    v_lshlrev_b16 v13, 3, v55
    v_mad_i32_i24 v11, v14, s55, v51
    v_bitop3_b32 v12, v6, v13, v12 bitop3:0xca
    v_add_lshl_u32 v11, v11, s40, 17
    v_lshlrev_b16 v14, 8, v14
    v_lshrrev_b32 v13, 2, v55
    v_or_b32 v51, v12, v11
    v_bitop3_b32 v55, v5, v13, v14 bitop3:0xea
    ds_add_u32 v55, v2
    v_cvt_pk_bf16_f32 v25, v9, v10
    v_perm_b32 v12, v25, v25, s41
    v_bitop3_b32 v50, v4, v12, v50 bitop3:0xca
    v_perm_b32 v13, v25, v25, s42
    v_bitop3_b32 v51, v4, v13, v51 bitop3:0xca
    s_waitcnt vmcnt(12)
    s_cmp_le_u32 s43, 5
    s_cbranch_scc1 L1_s1
    v_lshlrev_b32 v7, 16, v26
    v_and_b32 v8, 0xffff0000, v26
    v_lshlrev_b32 v9, 16, v27
    v_and_b32 v10, 0xffff0000, v27
    v_mul_f32 v7, 0.15915494, v7
    v_mul_f32 v8, 0.15915494, v8
    v_mul_f32 v9, 0.15915494, v9
    v_mul_f32 v10, 0.15915494, v10
    v_mul_hi_u32_u24 v14, 429497, v56
    v_lshrrev_b32 v12, 3, v60
    v_cos_f32 v7, v7
    v_lshlrev_b16 v13, 3, v60
    v_mad_i32_i24 v11, v14, s55, v56
    v_bitop3_b32 v12, v6, v13, v12 bitop3:0xca
    v_add_lshl_u32 v11, v11, s40, 17
    v_lshlrev_b16 v14, 8, v14
    v_lshrrev_b32 v13, 2, v60
    v_or_b32 v56, v12, v11
    v_bitop3_b32 v60, v5, v13, v14 bitop3:0xea
    ds_add_u32 v60, v2
    v_mul_hi_u32_u24 v14, 429497, v57
    v_lshrrev_b32 v12, 3, v61
    v_cos_f32 v8, v8
    v_lshlrev_b16 v13, 3, v61
    v_mad_i32_i24 v11, v14, s55, v57
    v_bitop3_b32 v12, v6, v13, v12 bitop3:0xca
    v_add_lshl_u32 v11, v11, s40, 17
    v_lshlrev_b16 v14, 8, v14
    v_lshrrev_b32 v13, 2, v61
    v_or_b32 v57, v12, v11
    v_bitop3_b32 v61, v5, v13, v14 bitop3:0xea
    ds_add_u32 v61, v2
    v_cvt_pk_bf16_f32 v26, v7, v8
    v_perm_b32 v12, v26, v26, s41
    v_bitop3_b32 v56, v4, v12, v56 bitop3:0xca
    v_perm_b32 v13, v26, v26, s42
    v_bitop3_b32 v57, v4, v13, v57 bitop3:0xca
    v_mul_hi_u32_u24 v14, 429497, v58
    v_lshrrev_b32 v12, 3, v62
    v_cos_f32 v9, v9
    v_lshlrev_b16 v13, 3, v62
    v_mad_i32_i24 v11, v14, s55, v58
    v_bitop3_b32 v12, v6, v13, v12 bitop3:0xca
    v_add_lshl_u32 v11, v11, s40, 17
    v_lshlrev_b16 v14, 8, v14
    v_lshrrev_b32 v13, 2, v62
    v_or_b32 v58, v12, v11
    v_bitop3_b32 v62, v5, v13, v14 bitop3:0xea
    ds_add_u32 v62, v2
    v_mul_hi_u32_u24 v14, 429497, v59
    v_lshrrev_b32 v12, 3, v63
    v_cos_f32 v10, v10
    v_lshlrev_b16 v13, 3, v63
    v_mad_i32_i24 v11, v14, s55, v59
    v_bitop3_b32 v12, v6, v13, v12 bitop3:0xca
    v_add_lshl_u32 v11, v11, s40, 17
    v_lshlrev_b16 v14, 8, v14
    v_lshrrev_b32 v13, 2, v63
    v_or_b32 v59, v12, v11
    v_bitop3_b32 v63, v5, v13, v14 bitop3:0xea
    ds_add_u32 v63, v2
    v_cvt_pk_bf16_f32 v27, v9, v10
    v_perm_b32 v12, v27, v27, s41
    v_bitop3_b32 v58, v4, v12, v58 bitop3:0xca
    v_perm_b32 v13, v27, v27, s42
    v_bitop3_b32 v59, v4, v13, v59 bitop3:0xca
L1_s1:
    s_waitcnt vmcnt(8)
    s_cmp_le_u32 s43, 6
    s_cbranch_scc1 L1_s2
    v_lshlrev_b32 v7, 16, v44
    v_and_b32 v8, 0xffff0000, v44
    v_lshlrev_b32 v9, 16, v45
    v_and_b32 v10, 0xffff0000, v45
    v_mul_f32 v7, 0.15915494, v7
    v_mul_f32 v8, 0.15915494, v8
    v_mul_f32 v9, 0.15915494, v9
    v_mul_f32 v10, 0.15915494, v10
    v_mul_hi_u32_u24 v14, 429497, v68
    v_lshrrev_b32 v12, 3, v72
    v_cos_f32 v7, v7
    v_lshlrev_b16 v13, 3, v72
    v_mad_i32_i24 v11, v14, s55, v68
    v_bitop3_b32 v12, v6, v13, v12 bitop3:0xca
    v_add_lshl_u32 v11, v11, s40, 17
    v_lshlrev_b16 v14, 8, v14
    v_lshrrev_b32 v13, 2, v72
    v_or_b32 v68, v12, v11
    v_bitop3_b32 v72, v5, v13, v14 bitop3:0xea
    ds_add_u32 v72, v2
    v_mul_hi_u32_u24 v14, 429497, v69
    v_lshrrev_b32 v12, 3, v73
    v_cos_f32 v8, v8
    v_lshlrev_b16 v13, 3, v73
    v_mad_i32_i24 v11, v14, s55, v69
    v_bitop3_b32 v12, v6, v13, v12 bitop3:0xca
    v_add_lshl_u32 v11, v11, s40, 17
    v_lshlrev_b16 v14, 8, v14
    v_lshrrev_b32 v13, 2, v73
    v_or_b32 v69, v12, v11
    v_bitop3_b32 v73, v5, v13, v14 bitop3:0xea
    ds_add_u32 v73, v2
    v_cvt_pk_bf16_f32 v44, v7, v8
    v_perm_b32 v12, v44, v44, s41
    v_bitop3_b32 v68, v4, v12, v68 bitop3:0xca
    v_perm_b32 v13, v44, v44, s42
    v_bitop3_b32 v69, v4, v13, v69 bitop3:0xca
    v_mul_hi_u32_u24 v14, 429497, v70
    v_lshrrev_b32 v12, 3, v74
    v_cos_f32 v9, v9
    v_lshlrev_b16 v13, 3, v74
    v_mad_i32_i24 v11, v14, s55, v70
    v_bitop3_b32 v12, v6, v13, v12 bitop3:0xca
    v_add_lshl_u32 v11, v11, s40, 17
    v_lshlrev_b16 v14, 8, v14
    v_lshrrev_b32 v13, 2, v74
    v_or_b32 v70, v12, v11
    v_bitop3_b32 v74, v5, v13, v14 bitop3:0xea
    ds_add_u32 v74, v2
    v_mul_hi_u32_u24 v14, 429497, v71
    v_lshrrev_b32 v12, 3, v75
    v_cos_f32 v10, v10
    v_lshlrev_b16 v13, 3, v75
    v_mad_i32_i24 v11, v14, s55, v71
    v_bitop3_b32 v12, v6, v13, v12 bitop3:0xca
    v_add_lshl_u32 v11, v11, s40, 17
    v_lshlrev_b16 v14, 8, v14
    v_lshrrev_b32 v13, 2, v75
    v_or_b32 v71, v12, v11
    v_bitop3_b32 v75, v5, v13, v14 bitop3:0xea
    ds_add_u32 v75, v2
    v_cvt_pk_bf16_f32 v45, v9, v10
    v_perm_b32 v12, v45, v45, s41
    v_bitop3_b32 v70, v4, v12, v70 bitop3:0xca
    v_perm_b32 v13, v45, v45, s42
    v_bitop3_b32 v71, v4, v13, v71 bitop3:0xca
L1_s2:
    s_waitcnt vmcnt(4)
    s_cmp_le_u32 s43, 7
    s_cbranch_scc1 L1_s3
    v_lshlrev_b32 v7, 16, v46
    v_and_b32 v8, 0xffff0000, v46
    v_lshlrev_b32 v9, 16, v47
    v_and_b32 v10, 0xffff0000, v47
    v_mul_f32 v7, 0.15915494, v7
    v_mul_f32 v8, 0.15915494, v8
    v_mul_f32 v9, 0.15915494, v9
    v_mul_f32 v10, 0.15915494, v10
    v_mul_hi_u32_u24 v14, 429497, v76
    v_lshrrev_b32 v12, 3, v80
    v_cos_f32 v7, v7
    v_lshlrev_b16 v13, 3, v80
    v_mad_i32_i24 v11, v14, s55, v76
    v_bitop3_b32 v12, v6, v13, v12 bitop3:0xca
    v_add_lshl_u32 v11, v11, s40, 17
    v_lshlrev_b16 v14, 8, v14
    v_lshrrev_b32 v13, 2, v80
    v_or_b32 v76, v12, v11
    v_bitop3_b32 v80, v5, v13, v14 bitop3:0xea
    ds_add_u32 v80, v2
    v_mul_hi_u32_u24 v14, 429497, v77
    v_lshrrev_b32 v12, 3, v81
    v_cos_f32 v8, v8
    v_lshlrev_b16 v13, 3, v81
    v_mad_i32_i24 v11, v14, s55, v77
    v_bitop3_b32 v12, v6, v13, v12 bitop3:0xca
    v_add_lshl_u32 v11, v11, s40, 17
    v_lshlrev_b16 v14, 8, v14
    v_lshrrev_b32 v13, 2, v81
    v_or_b32 v77, v12, v11
    v_bitop3_b32 v81, v5, v13, v14 bitop3:0xea
    ds_add_u32 v81, v2
    v_cvt_pk_bf16_f32 v46, v7, v8
    v_perm_b32 v12, v46, v46, s41
    v_bitop3_b32 v76, v4, v12, v76 bitop3:0xca
    v_perm_b32 v13, v46, v46, s42
    v_bitop3_b32 v77, v4, v13, v77 bitop3:0xca
    v_mul_hi_u32_u24 v14, 429497, v78
    v_lshrrev_b32 v12, 3, v82
    v_cos_f32 v9, v9
    v_lshlrev_b16 v13, 3, v82
    v_mad_i32_i24 v11, v14, s55, v78
    v_bitop3_b32 v12, v6, v13, v12 bitop3:0xca
    v_add_lshl_u32 v11, v11, s40, 17
    v_lshlrev_b16 v14, 8, v14
    v_lshrrev_b32 v13, 2, v82
    v_or_b32 v78, v12, v11
    v_bitop3_b32 v82, v5, v13, v14 bitop3:0xea
    ds_add_u32 v82, v2
    v_mul_hi_u32_u24 v14, 429497, v79
    v_lshrrev_b32 v12, 3, v83
    v_cos_f32 v10, v10
    v_lshlrev_b16 v13, 3, v83
    v_mad_i32_i24 v11, v14, s55, v79
    v_bitop3_b32 v12, v6, v13, v12 bitop3:0xca
    v_add_lshl_u32 v11, v11, s40, 17
    v_lshlrev_b16 v14, 8, v14
    v_lshrrev_b32 v13, 2, v83
    v_or_b32 v79, v12, v11
    v_bitop3_b32 v83, v5, v13, v14 bitop3:0xea
    ds_add_u32 v83, v2
    v_cvt_pk_bf16_f32 v47, v9, v10
    v_perm_b32 v12, v47, v47, s41
    v_bitop3_b32 v78, v4, v12, v78 bitop3:0xca
    v_perm_b32 v13, v47, v47, s42
    v_bitop3_b32 v79, v4, v13, v79 bitop3:0xca
L1_s3:
    v_lshrrev_b32 v8, 2, v0
    v_and_b32 v7, 0x3c00, v0
    v_bitop3_b32 v7, v5, v8, v7 bitop3:0xea
    s_waitcnt lgkmcnt(0)
    s_barrier
    ds_read2st64_b32 v[8:9], v7 offset0:0 offset1:1
    ds_read2st64_b32 v[10:11], v7 offset0:2 offset1:3
    s_add_u32 s46, s35, 0x7ed0000
    buffer_store_dwordx4 v[64:67], v0, s[20:23], s46 offen sc1
    s_waitcnt lgkmcnt(0)
    v_lshl_or_b32 v12, v9, 16, v8
    v_lshl_or_b32 v13, v11, 16, v10
    v_mov_b32 v14, v12
    v_mov_b32 v15, v13
    s_nop 0
    v_add_u32_dpp v14, v14, v14 row_shr:1 row_mask:0xf bank_mask:0xf bound_ctrl:1
    v_add_u32_dpp v15, v15, v15 row_shr:1 row_mask:0xf bank_mask:0xf bound_ctrl:1
    s_nop 0
    v_add_u32_dpp v14, v14, v14 row_shr:2 row_mask:0xf bank_mask:0xf bound_ctrl:1
    v_add_u32_dpp v15, v15, v15 row_shr:2 row_mask:0xf bank_mask:0xf bound_ctrl:1
    s_nop 0
    v_add_u32_dpp v14, v14, v14 row_shr:4 row_mask:0xf bank_mask:0xf bound_ctrl:1
    v_add_u32_dpp v15, v15, v15 row_shr:4 row_mask:0xf bank_mask:0xf bound_ctrl:1
    s_nop 0
    v_add_u32_dpp v14, v14, v14 row_shr:8 row_mask:0xf bank_mask:0xf bound_ctrl:1
    v_add_u32_dpp v15, v15, v15 row_shr:8 row_mask:0xf bank_mask:0xf bound_ctrl:1
    s_nop 0
    v_add_u32_dpp v14, v14, v14 row_bcast:15 row_mask:0xa bank_mask:0xf
    v_add_u32_dpp v15, v15, v15 row_bcast:15 row_mask:0xa bank_mask:0xf
    s_nop 0
    v_add_u32_dpp v14, v14, v14 row_bcast:31 row_mask:0xc bank_mask:0xf
    v_add_u32_dpp v15, v15, v15 row_bcast:31 row_mask:0xc bank_mask:0xf
    v_readlane_b32 s48, v14, 63
    v_readlane_b32 s49, v15, 63
    s_lshl_b32 s54, s32, 2
    v_mov_b32 v8, s54
    s_and_b32 s50, s48, 0xffff
    s_lshr_b32 s51, s48, 16
    s_and_b32 s52, s49, 0xffff
    s_lshr_b32 s53, s49, 16
    s_add_u32 s51, s51, s50
    s_add_u32 s52, s52, s51
    s_add_u32 s53, s53, s52
    v_mov_b32 v9, s53
    s_mov_b64 exec, 1
    ds_write_b32 v8, v9 offset:16384
    s_mov_b64 exec, -1
    v_and_b32 v8, 60, v7
    s_waitcnt lgkmcnt(0)
    s_barrier
    ds_read_b32 v9, v8 offset:16384
    s_waitcnt lgkmcnt(0)
    v_add_u32_dpp v9, v9, v9 row_shr:1 row_mask:0xf bank_mask:0xf bound_ctrl:1
    s_nop 1
    v_add_u32_dpp v9, v9, v9 row_shr:2 row_mask:0xf bank_mask:0xf bound_ctrl:1
    s_nop 1
    v_add_u32_dpp v9, v9, v9 row_shr:4 row_mask:0xf bank_mask:0xf bound_ctrl:1
    s_nop 1
    v_add_u32_dpp v9, v9, v9 row_shr:8 row_mask:0xf bank_mask:0xf bound_ctrl:1
    s_nop 0
    v_readlane_b32 s54, v9, s32
    s_sub_u32 s54, s54, s53
    s_add_u32 s50, s50, s54
    s_add_u32 s51, s51, s54
    s_add_u32 s52, s52, s54
    s_pack_ll_b32_b16 s48, s54, s50
    s_pack_ll_b32_b16 s49, s51, s52
    v_add_u32 v14, s48, v14
    v_add_u32 v15, s49, v15
    v_sub_u32 v12, v14, v12
    v_sub_u32 v13, v15, v13
    v_and_b32 v8, 0xffff, v12
    v_lshrrev_b32 v9, 16, v12
    v_and_b32 v10, 0xffff, v13
    v_lshrrev_b32 v11, 16, v13
    ds_write2st64_b32 v7, v8, v9 offset0:0 offset1:1
    ds_write2st64_b32 v7, v10, v11 offset0:2 offset1:3
    s_waitcnt lgkmcnt(0)
    s_barrier
    ds_add_rtn_u32 v120, v120, v2
    ds_add_rtn_u32 v121, v121, v2
    ds_add_rtn_u32 v122, v122, v2
    ds_add_rtn_u32 v123, v123, v2
    s_add_u32 s47, s36, 0xa900000
    v_and_b32 v11, 0x3f0, v0
    v_add_u32 v11, v11, v11
    buffer_store_dwordx2 v[12:13], v11, s[24:27], s47 offen
    s_bitset0_b64 exec, 63
    s_not_b64 exec, exec
    buffer_store_dwordx2 v[14:15], v11, s[24:27], s47 offen offset:32
    s_mov_b64 exec, -1
    ds_add_rtn_u32 v20, v20, v2
    ds_add_rtn_u32 v21, v21, v2
    ds_add_rtn_u32 v22, v22, v2
    ds_add_rtn_u32 v23, v23, v2
    ds_add_rtn_u32 v32, v32, v2
    ds_add_rtn_u32 v33, v33, v2
    ds_add_rtn_u32 v34, v34, v2
    ds_add_rtn_u32 v35, v35, v2
    s_add_u32 s44, s35, 0x7ed4000
    buffer_store_dwordx4 v[96:99], v0, s[20:23], s44 offen sc1
    ds_add_rtn_u32 v40, v40, v2
    ds_add_rtn_u32 v41, v41, v2
    ds_add_rtn_u32 v42, v42, v2
    ds_add_rtn_u32 v43, v43, v2
    ds_add_rtn_u32 v52, v52, v2
    ds_add_rtn_u32 v53, v53, v2
    ds_add_rtn_u32 v54, v54, v2
    ds_add_rtn_u32 v55, v55, v2
    s_cmp_le_u32 s43, 5
    s_cbranch_scc1 L1_s4
    ds_add_rtn_u32 v60, v60, v2
    ds_add_rtn_u32 v61, v61, v2
    ds_add_rtn_u32 v62, v62, v2
    ds_add_rtn_u32 v63, v63, v2
L1_s4:
    s_add_u32 s45, s35, 0x7ed8000
    buffer_store_dwordx4 v[100:103], v0, s[20:23], s45 offen sc1
    s_cmp_le_u32 s43, 6
    s_cbranch_scc1 L1_s5
    ds_add_rtn_u32 v72, v72, v2
    ds_add_rtn_u32 v73, v73, v2
    ds_add_rtn_u32 v74, v74, v2
    ds_add_rtn_u32 v75, v75, v2
L1_s5:
    s_cmp_le_u32 s43, 7
    s_cbranch_scc1 L1_s6
    ds_add_rtn_u32 v80, v80, v2
    ds_add_rtn_u32 v81, v81, v2
    ds_add_rtn_u32 v82, v82, v2
    ds_add_rtn_u32 v83, v83, v2
L1_s6:
    s_waitcnt lgkmcnt(0)
    s_barrier
    v_and_b32 v7, -4, v120
    v_lshl_add_u32 v8, v120, 2, v7
    ds_write_b32 v8, v116
    v_lshl_add_u32 v7, v7, 2, v120
    ds_write_b8 v7, v104 offset:16
    v_and_b32 v9, -4, v121
    v_lshl_add_u32 v10, v121, 2, v9
    ds_write_b32 v10, v117
    v_lshl_add_u32 v9, v9, 2, v121
    ds_write_b8_d16_hi v9, v104 offset:16
    v_and_b32 v7, -4, v122
    v_lshl_add_u32 v8, v122, 2, v7
    ds_write_b32 v8, v118
    v_lshl_add_u32 v7, v7, 2, v122
    ds_write_b8 v7, v105 offset:16
    v_and_b32 v9, -4, v123
    v_lshl_add_u32 v10, v123, 2, v9
    ds_write_b32 v10, v119
    v_lshl_add_u32 v9, v9, 2, v123
    ds_write_b8_d16_hi v9, v105 offset:16
    s_add_u32 s46, s35, 0x7edc000
    buffer_store_dwordx4 v[108:111], v0, s[20:23], s46 offen sc1
    v_and_b32 v7, -4, v20
    v_lshl_add_u32 v8, v20, 2, v7
    ds_write_b32 v8, v16
    v_lshl_add_u32 v7, v7, 2, v20
    ds_write_b8 v7, v106 offset:16
    v_and_b32 v9, -4, v21
    v_lshl_add_u32 v10, v21, 2, v9
    ds_write_b32 v10, v17
    v_lshl_add_u32 v9, v9, 2, v21
    ds_write_b8_d16_hi v9, v106 offset:16
    v_and_b32 v7, -4, v22
    v_lshl_add_u32 v8, v22, 2, v7
    ds_write_b32 v8, v18
    v_lshl_add_u32 v7, v7, 2, v22
    ds_write_b8 v7, v107 offset:16
    v_and_b32 v9, -4, v23
    v_lshl_add_u32 v10, v23, 2, v9
    ds_write_b32 v10, v19
    v_lshl_add_u32 v9, v9, 2, v23
    ds_write_b8_d16_hi v9, v107 offset:16
    v_and_b32 v7, -4, v32
    v_lshl_add_u32 v8, v32, 2, v7
    ds_write_b32 v8, v28
    v_lshl_add_u32 v7, v7, 2, v32
    ds_write_b8 v7, v124 offset:16
    v_and_b32 v9, -4, v33
    v_lshl_add_u32 v10, v33, 2, v9
    ds_write_b32 v10, v29
    v_lshl_add_u32 v9, v9, 2, v33
    ds_write_b8_d16_hi v9, v124 offset:16
    v_and_b32 v7, -4, v34
    v_lshl_add_u32 v8, v34, 2, v7
    ds_write_b32 v8, v30
    v_lshl_add_u32 v7, v7, 2, v34
    ds_write_b8 v7, v125 offset:16
    v_and_b32 v9, -4, v35
    v_lshl_add_u32 v10, v35, 2, v9
    ds_write_b32 v10, v31
    v_lshl_add_u32 v9, v9, 2, v35
    ds_write_b8_d16_hi v9, v125 offset:16
    s_add_u32 s47, s35, 0x7ee0000
    buffer_store_dwordx4 v[112:115], v0, s[20:23], s47 offen sc1
    v_and_b32 v7, -4, v40
    v_lshl_add_u32 v8, v40, 2, v7
    ds_write_b32 v8, v36
    v_lshl_add_u32 v7, v7, 2, v40
    ds_write_b8 v7, v126 offset:16
    v_and_b32 v9, -4, v41
    v_lshl_add_u32 v10, v41, 2, v9
    ds_write_b32 v10, v37
    v_lshl_add_u32 v9, v9, 2, v41
    ds_write_b8_d16_hi v9, v126 offset:16
    v_and_b32 v7, -4, v42
    v_lshl_add_u32 v8, v42, 2, v7
    ds_write_b32 v8, v38
    v_lshl_add_u32 v7, v7, 2, v42
    ds_write_b8 v7, v127 offset:16
    v_and_b32 v9, -4, v43
    v_lshl_add_u32 v10, v43, 2, v9
    ds_write_b32 v10, v39
    v_lshl_add_u32 v9, v9, 2, v43
    ds_write_b8_d16_hi v9, v127 offset:16
    v_and_b32 v7, -4, v52
    v_lshl_add_u32 v8, v52, 2, v7
    ds_write_b32 v8, v48
    v_lshl_add_u32 v7, v7, 2, v52
    ds_write_b8 v7, v24 offset:16
    v_and_b32 v9, -4, v53
    v_lshl_add_u32 v10, v53, 2, v9
    ds_write_b32 v10, v49
    v_lshl_add_u32 v9, v9, 2, v53
    ds_write_b8_d16_hi v9, v24 offset:16
    v_and_b32 v7, -4, v54
    v_lshl_add_u32 v8, v54, 2, v7
    ds_write_b32 v8, v50
    v_lshl_add_u32 v7, v7, 2, v54
    ds_write_b8 v7, v25 offset:16
    v_and_b32 v9, -4, v55
    v_lshl_add_u32 v10, v55, 2, v9
    ds_write_b32 v10, v51
    v_lshl_add_u32 v9, v9, 2, v55
    ds_write_b8_d16_hi v9, v25 offset:16
    s_add_u32 s44, s35, 0x7ee4000
    buffer_store_dwordx4 v[84:87], v0, s[20:23], s44 offen sc1
    s_cmp_le_u32 s43, 5
    s_cbranch_scc1 L1_s7
    v_and_b32 v7, -4, v60
    v_lshl_add_u32 v8, v60, 2, v7
    ds_write_b32 v8, v56
    v_lshl_add_u32 v7, v7, 2, v60
    ds_write_b8 v7, v26 offset:16
    v_and_b32 v9, -4, v61
    v_lshl_add_u32 v10, v61, 2, v9
    ds_write_b32 v10, v57
    v_lshl_add_u32 v9, v9, 2, v61
    ds_write_b8_d16_hi v9, v26 offset:16
    v_and_b32 v7, -4, v62
    v_lshl_add_u32 v8, v62, 2, v7
    ds_write_b32 v8, v58
    v_lshl_add_u32 v7, v7, 2, v62
    ds_write_b8 v7, v27 offset:16
    v_and_b32 v9, -4, v63
    v_lshl_add_u32 v10, v63, 2, v9
    ds_write_b32 v10, v59
    v_lshl_add_u32 v9, v9, 2, v63
    ds_write_b8_d16_hi v9, v27 offset:16
L1_s7:
    s_cmp_le_u32 s43, 6
    s_cbranch_scc1 L1_s8
    v_and_b32 v7, -4, v72
    v_lshl_add_u32 v8, v72, 2, v7
    ds_write_b32 v8, v68
    v_lshl_add_u32 v7, v7, 2, v72
    ds_write_b8 v7, v44 offset:16
    v_and_b32 v9, -4, v73
    v_lshl_add_u32 v10, v73, 2, v9
    ds_write_b32 v10, v69
    v_lshl_add_u32 v9, v9, 2, v73
    ds_write_b8_d16_hi v9, v44 offset:16
    v_and_b32 v7, -4, v74
    v_lshl_add_u32 v8, v74, 2, v7
    ds_write_b32 v8, v70
    v_lshl_add_u32 v7, v7, 2, v74
    ds_write_b8 v7, v45 offset:16
    v_and_b32 v9, -4, v75
    v_lshl_add_u32 v10, v75, 2, v9
    ds_write_b32 v10, v71
    v_lshl_add_u32 v9, v9, 2, v75
    ds_write_b8_d16_hi v9, v45 offset:16
L1_s8:
    s_cmp_le_u32 s43, 7
    s_cbranch_scc1 L1_s9
    v_and_b32 v7, -4, v80
    v_lshl_add_u32 v8, v80, 2, v7
    ds_write_b32 v8, v76
    v_lshl_add_u32 v7, v7, 2, v80
    ds_write_b8 v7, v46 offset:16
    v_and_b32 v9, -4, v81
    v_lshl_add_u32 v10, v81, 2, v9
    ds_write_b32 v10, v77
    v_lshl_add_u32 v9, v9, 2, v81
    ds_write_b8_d16_hi v9, v46 offset:16
    v_and_b32 v7, -4, v82
    v_lshl_add_u32 v8, v82, 2, v7
    ds_write_b32 v8, v78
    v_lshl_add_u32 v7, v7, 2, v82
    ds_write_b8 v7, v47 offset:16
    v_and_b32 v9, -4, v83
    v_lshl_add_u32 v10, v83, 2, v9
    ds_write_b32 v10, v79
    v_lshl_add_u32 v9, v9, 2, v83
    ds_write_b8_d16_hi v9, v47 offset:16
L1_s9:
    v_add_u32 v7, 0x10000, v0
    v_add_u32 v12, 0x20000, v0
    s_waitcnt lgkmcnt(0)
    s_barrier
    ds_read_b128 v[92:95], v0 offset:0
    ds_read_b128 v[64:67], v0 offset:16384
    ds_read_b128 v[96:99], v0 offset:32768
    ds_read_b128 v[100:103], v0 offset:49152
    ds_read_b128 v[116:119], v7 offset:0
    ds_read_b128 v[120:123], v7 offset:16384
    ds_read_b128 v[108:111], v7 offset:32768
    ds_read_b128 v[16:19], v7 offset:49152
    ds_read_b128 v[20:23], v12 offset:0
    ds_read_b128 v[104:107], v12 offset:16384
    s_waitcnt lgkmcnt(9)
    s_add_u32 s45, s35, 0xa900000
    buffer_store_dwordx4 v[92:95], v0, s[20:23], s45 offen sc1
    s_waitcnt lgkmcnt(8)
    s_add_u32 s46, s35, 0xa904000
    buffer_store_dwordx4 v[64:67], v0, s[20:23], s46 offen sc1
    s_waitcnt lgkmcnt(7)
    s_add_u32 s47, s35, 0xa908000
    buffer_store_dwordx4 v[96:99], v0, s[20:23], s47 offen sc1
    s_waitcnt lgkmcnt(6)
    s_add_u32 s44, s35, 0xa90c000
    buffer_store_dwordx4 v[100:103], v0, s[20:23], s44 offen sc1
    s_waitcnt lgkmcnt(5)
    s_add_u32 s45, s35, 0xa910000
    buffer_store_dwordx4 v[116:119], v0, s[20:23], s45 offen sc1
    s_waitcnt lgkmcnt(4)
    s_add_u32 s46, s35, 0xa914000
    buffer_store_dwordx4 v[120:123], v0, s[20:23], s46 offen sc1
    s_waitcnt lgkmcnt(3)
    s_add_u32 s47, s35, 0xa918000
    buffer_store_dwordx4 v[108:111], v0, s[20:23], s47 offen sc1
    s_cmp_le_u32 s43, 5
    s_cbranch_scc1 L1_fin
    s_waitcnt lgkmcnt(2)
    s_add_u32 s44, s35, 0xa91c000
    buffer_store_dwordx4 v[16:19], v0, s[20:23], s44 offen sc1
    s_cmp_le_u32 s43, 6
    s_cbranch_scc1 L1_fin
    s_waitcnt lgkmcnt(1)
    s_add_u32 s45, s35, 0xa920000
    buffer_store_dwordx4 v[20:23], v0, s[20:23], s45 offen sc1
    s_cmp_le_u32 s43, 7
    s_cbranch_scc1 L1_fin
    s_waitcnt lgkmcnt(0)
    s_add_u32 s46, s35, 0xa924000
    buffer_store_dwordx4 v[104:107], v0, s[20:23], s46 offen sc1
L1_fin:
L1_end:
    s_endpgm
.text
.globl gs_acc_kernel
.p2align 8
.type gs_acc_kernel,@function
gs_acc_kernel:
    s_cmp_ge_u32 s2, 256
    s_cbranch_scc1 L2_end
    s_load_dwordx2 s[30:31], s[0:1], 104
    s_load_dwordx2 s[28:29], s[0:1], 0
    v_lshrrev_b32 v16, 6, v0
    v_and_b32 v17, 63, v0
    v_readfirstlane_b32 s32, v16
    s_bfe_u32 s33, s2, 0x20001
    s_and_b32 s34, s2, 1
    s_lshl_b32 s34, s34, 5
    s_lshr_b32 s4, s2, 3
    s_add_u32 s34, s34, s4
    v_and_b32 v22, 3, v0
    v_mul_u32_u24 v19, 80, v16
    v_add_u32 v18, v17, v19
    v_mul_u32_u24 v2, 173056, v18
    v_lshrrev_b32 v18, 2, v17
    v_add3_u32 v18, v18, v19, 64
    v_mul_u32_u24 v4, 173056, v18
    v_lshl_add_u32 v20, v22, 4, v4
    s_mul_i32 s39, s33, 2080
    s_lshl_b32 s3, s34, 5
    s_add_u32 s39, s39, s3
    s_mul_i32 s40, s33, 1280000
    s_mul_i32 s38, s32, 5120
    s_add_u32 s38, s38, 80000
    v_lshl_add_u32 v3, v17, 4, s38
    s_waitcnt lgkmcnt(0)
    s_add_u32 s12, s30, 0x28000
    s_addc_u32 s13, s31, 0
    s_mov_b32 s14, 0xd318000
    s_mov_b32 s15, 0x20000
    buffer_load_dwordx4 v[48:51], v2, s[12:15], s39 offen offset:0
    buffer_load_dwordx4 v[56:59], v2, s[12:15], s39 offen offset:32
    buffer_load_dwordx4 v[52:55], v2, s[12:15], s39 offen offset:16
    buffer_load_dwordx4 v[60:63], v2, s[12:15], s39 offen offset:48
    buffer_load_dwordx4 v[64:67], v20, s[12:15], s39 offen
    s_mov_b32 s16, s28
    s_mov_b32 s17, s29
    s_mov_b32 s18, 0x4f5880
    s_mov_b32 s19, 0x20000
    s_sub_u32 s16, s16, 80000
    s_subb_u32 s17, s17, 0
    s_add_u32 s24, s30, 0xebab000
    s_addc_u32 s25, s31, 0
    s_mov_b32 s26, 0x100
    s_mov_b32 s27, 0x20000
    v_lshlrev_b32 v21, 6, v22
    buffer_load_dwordx2 v[8:9], v21, s[24:27], 0 offen offset:40
    s_add_u32 s3, s40, 4096
    buffer_load_dwordx4 v[124:127], v3, s[16:19], s3 offen
    buffer_load_dwordx4 v[116:119], v3, s[16:19], s40 offen offset:2048
    buffer_load_dwordx4 v[120:123], v3, s[16:19], s40 offen offset:3072
    buffer_load_dwordx4 v[108:111], v3, s[16:19], s40 offen offset:0
    buffer_load_dwordx4 v[112:115], v3, s[16:19], s40 offen offset:1024
    s_add_u32 s40, s40, 0x4e200
    v_mad_u32_u24 v4, v22, 20, v4
    v_or_b32 v4, 0xf0000000, v4
    v_or_b32 v2, 0xf0000000, v2
    v_lshlrev_b32 v23, 2, v22
    v_sub_u32 v1, 28, v23
    v_and_b32 v18, 3, v0
    v_lshlrev_b32 v18, 4, v18
    v_mov_b32 v10, 0x3f80
    v_mov_b32 v11, 0
    v_lshlrev_b64 v[10:11], v18, v[10:11]
    v_and_b32 v18, 3, v0
    v_lshlrev_b32 v18, 4, v18
    v_mov_b32 v12, 0xbf80
    v_mov_b32 v13, 0
    v_lshlrev_b64 v[12:13], v18, v[12:13]
    v_lshlrev_b32 v24, 4, v0
    v_lshl_add_u32 v0, v17, 2, s38
    v_mov_b32 v45, 0xf0000000
    v_mov_b32 v5, 0x1fff8
    v_mov_b32 v6, 0x07ff0000
    s_mov_b32 s44, 0x4000c0c
    s_mov_b32 s45, 0x4010c0c
    s_mov_b32 s46, 0x4020c0c
    s_mov_b32 s47, 0x4030c0c
    s_mov_b32 s36, 0
    s_mov_b32 s35, 0
    s_mov_b32 s42, 0
    s_mov_b64 s[80:81], 0
    s_mov_b64 s[84:85], 0
    s_mov_b64 s[48:49], 0
    s_mov_b32 s8, s30
    s_mov_b32 s9, s31
    s_mov_b32 s10, 0xd340000
    s_mov_b32 s11, 0x20000
    s_add_u32 s20, s30, 0xd823000
    s_addc_u32 s21, s31, 0
    s_mov_b32 s22, 0x13880
    s_mov_b32 s23, 0x20000
    s_lshl_b32 s3, s33, 6
    s_add_u32 s3, s3, s34
    s_mul_i32 s3, s3, 80000
    s_add_u32 s20, s20, s3
    s_addc_u32 s21, s21, 0
    v_mov_b32 v68, 0
    v_mov_b32 v76, 0
    v_mov_b32 v69, 0
    v_mov_b32 v77, 0
    v_mov_b32 v70, 0
    v_mov_b32 v78, 0
    v_mov_b32 v71, 0
    v_mov_b32 v79, 0
    v_mov_b32 v72, 0
    v_mov_b32 v80, 0
    v_mov_b32 v73, 0
    v_mov_b32 v81, 0
    v_mov_b32 v74, 0
    v_mov_b32 v82, 0
    v_mov_b32 v75, 0
    v_mov_b32 v83, 0
    v_mov_b32 v94, 2.0
    v_mov_b32 v95, 2.0
    ds_write_b128 v24, v[68:71] offset:0
    ds_write_b128 v24, v[68:71] offset:16384
    ds_write_b128 v24, v[68:71] offset:32768
    ds_write_b128 v24, v[68:71] offset:49152
    v_add_u32 v47, 0x10000, v24
    v_cmp_gt_u32 vcc, 80000, v47
    s_mov_b64 exec, vcc
    ds_write_b128 v47, v[68:71]
    s_mov_b64 exec, -1
    s_waitcnt vmcnt(5)
    v_sub_u16 v88, v56, v48
    v_and_b32 v89, 3, v48
    v_add3_u32 v99, v88, v89, 3
    v_and_b32 v99, -4, v99
    v_max_u32 v99, 4, v99
    v_and_b32 v97, 0xfffc, v48
    v_bfm_b32 v96, v88, v89
    v_add_u32_dpp v91, v99, v99 row_shr:1 row_mask:0xf bank_mask:0xf bound_ctrl:1
    v_mad_u32_u24 v97, v97, 5, v2
    v_cmp_lt_u32 vcc, 16, v99
    v_add_u32_dpp v91, v91, v91 row_shr:2 row_mask:0xf bank_mask:0xf bound_ctrl:1
    v_sub_u32 v98, s38, v99
    v_lshrrev_b64 v[48:49], 16, v[48:49]
    v_add_u32_dpp v91, v91, v91 row_shr:4 row_mask:0xf bank_mask:0xf bound_ctrl:1
    v_lshrrev_b64 v[56:57], 16, v[56:57]
    s_mov_b32 s43, 0
    v_add_u32_dpp v91, v91, v91 row_shr:8 row_mask:0xf bank_mask:0xf bound_ctrl:1
    s_nop 1
    v_add_u32_dpp v91, v91, v91 row_bcast:15 row_mask:0xa bank_mask:0xf
    s_nop 1
    v_add_u32_dpp v91, v91, v91 row_bcast:31 row_mask:0xc bank_mask:0xf
    v_add_u32 v98, v98, v91
    v_readlane_b32 s37, v91, 63
    s_cbranch_vccnz L2_xo1
L2_xp1:
    v_mov_b32 v44, v43
    s_cmp_gt_u32 s37, 1024
    s_cbranch_scc1 L2_xs2
    s_cmp_lg_u32 s43, 0
    s_cbranch_scc1 L2_xa2
L2_xb2:
    v_lshlrev_b32 v89, 16, v96
    v_add_u32 v90, 60, v97
    v_bitop3_b32 v90, v89, v45, v90 bitop3:0x6a
    ds_write_b32 v98, v90 offset:12
    v_lshlrev_b32 v89, 20, v96
    v_add_u32 v90, 40, v97
    v_bitop3_b32 v90, v89, v45, v90 bitop3:0x6a
    ds_write_b32 v98, v90 offset:8
    v_lshlrev_b32 v89, 24, v96
    v_add_u32 v90, 20, v97
    v_bitop3_b32 v90, v89, v45, v90 bitop3:0x6a
    ds_write_b32 v98, v90 offset:4
    v_lshlrev_b32 v89, 28, v96
    v_bitop3_b32 v90, v89, v45, v97 bitop3:0x6a
    ds_write_b32 v98, v90 offset:0
    v_mov_b32_dpp v91, v64 quad_perm:[0,0,0,0] row_mask:0xf bank_mask:0xf
    v_and_b32 v89, 3, v91
    v_and_b32 v97, 0xfffc, v91
    v_sub_u16_dpp v88, v64, v91 quad_perm:[2,2,2,2] row_mask:0xf bank_mask:0xf
    v_mad_u32_u24 v97, v97, 5, v4
    v_add_u32 v99, v88, v89
    v_bfm_b32 v96, v88, v89
    v_cmp_lt_u32 s[58:59], 16, v99
    v_lshlrev_b32 v89, v1, v96
    v_and_b32 v89, v45, v89
    v_cmp_ne_u32 vcc, 0, v89
    v_xor_b32 v90, v97, v89
    s_add_u32 s3, s37, s38
    v_mbcnt_lo_u32_b32 v98, vcc_lo, 0
    v_mbcnt_hi_u32_b32 v98, vcc_hi, v98
    s_bcnt1_i32_b64 s41, vcc
    v_lshl_add_u32 v98, v98, 2, s3
    s_mov_b64 exec, vcc
    ds_write_b32 v98, v90
    s_mov_b64 exec, -1
    s_lshl2_add_u32 s37, s41, s37
    s_cmp_lg_u64 s[58:59], 0
    s_cbranch_scc1 L2_xe2
L2_xr2:
    v_add_u32 v98, s37, v0
    v_mov_b32 v90, -1
    ds_write_b32 v98, v90
    ds_read2st64_b32 v[40:41], v0 offset0:0 offset1:1
    ds_read2st64_b32 v[42:43], v0 offset0:2 offset1:3
    s_sub_u32 s3, s37, 768
    s_cmp_gt_u32 s3, 256
    s_cbranch_scc1 L2_xf2
L2_xg2:
    v_sub_u16 v88, v58, v50
    v_and_b32 v89, 3, v50
    v_add3_u32 v99, v88, v89, 3
    v_and_b32 v99, -4, v99
    v_max_u32 v99, 4, v99
    v_and_b32 v97, 0xfffc, v50
    v_bfm_b32 v96, v88, v89
    v_add_u32_dpp v91, v99, v99 row_shr:1 row_mask:0xf bank_mask:0xf bound_ctrl:1
    v_mad_u32_u24 v97, v97, 5, v2
    v_cmp_lt_u32 vcc, 16, v99
    v_add_u32_dpp v91, v91, v91 row_shr:2 row_mask:0xf bank_mask:0xf bound_ctrl:1
    v_sub_u32 v98, s38, v99
    v_lshrrev_b64 v[50:51], 16, v[50:51]
    v_add_u32_dpp v91, v91, v91 row_shr:4 row_mask:0xf bank_mask:0xf bound_ctrl:1
    v_lshrrev_b64 v[58:59], 16, v[58:59]
    s_mov_b32 s43, 0
    v_add_u32_dpp v91, v91, v91 row_shr:8 row_mask:0xf bank_mask:0xf bound_ctrl:1
    s_nop 1
    v_add_u32_dpp v91, v91, v91 row_bcast:15 row_mask:0xa bank_mask:0xf
    s_nop 1
    v_add_u32_dpp v91, v91, v91 row_bcast:31 row_mask:0xc bank_mask:0xf
    v_add_u32 v98, v98, v91
    v_readlane_b32 s37, v91, 63
    s_cbranch_vccnz L2_xo3
L2_xp3:
    s_waitcnt lgkmcnt(0)
    v_and_b32 v47, 0x0fffffff, v40
    v_mov_b32 v21, v40
    buffer_load_dwordx4 v[16:19], v47, s[8:11], 0 offen
    buffer_load_dwordx3 v[18:20], v47, s[8:11], 0 offen offset:8
    s_waitcnt vmcnt(6)
    ds_write_b128 v3, v[124:127] offset:4096
    v_and_b32 v47, 0x0fffffff, v41
    v_mov_b32 v27, v41
    buffer_load_dwordx4 v[22:25], v47, s[8:11], 0 offen
    buffer_load_dwordx3 v[24:26], v47, s[8:11], 0 offen offset:8
    s_waitcnt vmcnt(7)
    ds_write_b128 v3, v[116:119] offset:2048
    v_and_b32 v47, 0x0fffffff, v42
    v_mov_b32 v33, v42
    buffer_load_dwordx4 v[28:31], v47, s[8:11], 0 offen
    buffer_load_dwordx3 v[30:32], v47, s[8:11], 0 offen offset:8
    s_waitcnt vmcnt(8)
    ds_write_b128 v3, v[120:123] offset:3072
    v_mov_b32 v44, v43
    s_cmp_gt_u32 s37, 1024
    s_cbranch_scc1 L2_xs4
    s_cmp_lg_u32 s43, 0
    s_cbranch_scc1 L2_xa4
L2_xb4:
    v_lshlrev_b32 v89, 16, v96
    v_add_u32 v90, 60, v97
    v_bitop3_b32 v90, v89, v45, v90 bitop3:0x6a
    ds_write_b32 v98, v90 offset:12
    v_lshlrev_b32 v89, 20, v96
    v_add_u32 v90, 40, v97
    v_bitop3_b32 v90, v89, v45, v90 bitop3:0x6a
    ds_write_b32 v98, v90 offset:8
    v_lshlrev_b32 v89, 24, v96
    v_add_u32 v90, 20, v97
    v_bitop3_b32 v90, v89, v45, v90 bitop3:0x6a
    ds_write_b32 v98, v90 offset:4
    v_lshlrev_b32 v89, 28, v96
    v_bitop3_b32 v90, v89, v45, v97 bitop3:0x6a
    ds_write_b32 v98, v90 offset:0
    v_mov_b32_dpp v91, v66 quad_perm:[0,0,0,0] row_mask:0xf bank_mask:0xf
    v_and_b32 v89, 3, v91
    v_and_b32 v97, 0xfffc, v91
    v_sub_u16_dpp v88, v66, v91 quad_perm:[2,2,2,2] row_mask:0xf bank_mask:0xf
    v_mad_u32_u24 v97, v97, 5, v4
    v_add_u32 v99, v88, v89
    v_bfm_b32 v96, v88, v89
    v_cmp_lt_u32 s[58:59], 16, v99
    v_lshlrev_b32 v89, v1, v96
    v_and_b32 v89, v45, v89
    v_cmp_ne_u32 vcc, 0, v89
    v_xor_b32 v90, v97, v89
    s_add_u32 s3, s37, s38
    v_mbcnt_lo_u32_b32 v98, vcc_lo, 0
    v_mbcnt_hi_u32_b32 v98, vcc_hi, v98
    s_bcnt1_i32_b64 s41, vcc
    v_lshl_add_u32 v98, v98, 2, s3
    s_mov_b64 exec, vcc
    ds_write_b32 v98, v90
    s_mov_b64 exec, -1
    s_lshl2_add_u32 s37, s41, s37
    s_cmp_lg_u64 s[58:59], 0
    s_cbranch_scc1 L2_xe4
L2_xr4:
    v_add_u32 v98, s37, v0
    v_mov_b32 v90, -1
    ds_write_b32 v98, v90
    ds_read2st64_b32 v[40:41], v0 offset0:0 offset1:1
    ds_read2st64_b32 v[42:43], v0 offset0:2 offset1:3
    s_sub_u32 s3, s37, 768
    s_cmp_gt_u32 s3, 256
    s_cbranch_scc1 L2_xf4
L2_xg4:
    s_waitcnt vmcnt(7)
    ds_write_b128 v3, v[108:111] offset:0
    s_waitcnt vmcnt(6)
    ds_write_b128 v3, v[112:115] offset:1024
    buffer_load_dwordx4 v[116:119], v3, s[16:19], s40 offen offset:2048
    buffer_load_dwordx4 v[120:123], v3, s[16:19], s40 offen offset:3072
    s_add_u32 s3, s40, 4096
    buffer_load_dwordx4 v[124:127], v3, s[16:19], s3 offen
    s_waitcnt lgkmcnt(0)
L2_loop:
    s_barrier
    s_bitcmp1_b32 s36, s42
    s_cbranch_scc1 L2_slow
L2_ret0:
    s_setprio 3
    v_and_b32 v47, 0x0fffffff, v44
    v_mov_b32 v39, v44
    buffer_load_dwordx4 v[34:37], v47, s[8:11], 0 offen
    buffer_load_dwordx3 v[36:38], v47, s[8:11], 0 offen offset:8
    s_waitcnt lgkmcnt(0)
    v_cmpx_ne_u64 vcc, v[74:75], v[70:71]
    s_and_b64 s[82:83], vcc, s[80:81]
    s_cbranch_scc1 L2_c5
L2_d5:
    v_mov_b64 v[84:85], v[70:71]
    v_mov_b32 v7, v93
    v_mov_b64 v[86:87], v[74:75]
    s_mov_b64 exec, -1
    s_or_b64 s[80:81], s[80:81], vcc
    v_cmpx_ne_u64 vcc, v[72:73], v[68:69]
    s_and_b64 s[82:83], vcc, s[80:81]
    s_cbranch_scc1 L2_c6
L2_d6:
    v_mov_b64 v[84:85], v[68:69]
    v_mov_b32 v7, v92
    v_mov_b64 v[86:87], v[72:73]
    s_mov_b64 exec, -1
    s_or_b64 s[80:81], s[80:81], vcc
    ds_read_b64 v[70:71], v95
    ds_read_b64 v[68:69], v94
    s_waitcnt vmcnt(9)
    v_and_b32 v46, 0x20000000, v21
    v_lshrrev_b32 v47, 14, v17
    v_bitop3_b32 v47, v47, v5, v46 bitop3:0xea
    ds_read_b64 v[102:103], v47 offset:63616
    v_bitop3_b32 v93, v17, v5, v46 bitop3:0xea
    v_and_b32 v46, 0x10000000, v21
    v_lshrrev_b32 v47, 14, v16
    v_bitop3_b32 v47, v47, v5, v46 bitop3:0xea
    ds_read_b64 v[100:101], v47 offset:63616
    v_bitop3_b32 v92, v16, v5, v46 bitop3:0xea
    s_waitcnt lgkmcnt(2)
    v_mfma_f32_4x4x4_16b_bf16 v[80:83], v[10:11], v[70:71], v[80:83]
    v_mfma_f32_4x4x4_16b_bf16 v[76:79], v[10:11], v[68:69], v[76:79]
    v_perm_b32 v15, v17, v20, s45
    v_bitop3_b32 v46, v17, 0.5, -0.5 bitop3:0xa8
    v_perm_b32 v14, v16, v20, s44
    v_bitop3_b32 v47, v16, 0.5, -0.5 bitop3:0xa8
    v_cvt_pk_bf16_f32 v80, v80, v81
    v_cvt_pk_bf16_f32 v81, v82, v83
    ds_wrxchg_rtn_b64 v[74:75], v95, v[80:81]
    v_cvt_pk_bf16_f32 v76, v76, v77
    v_cvt_pk_bf16_f32 v77, v78, v79
    ds_wrxchg_rtn_b64 v[72:73], v94, v[76:77]
    s_waitcnt lgkmcnt(2)
    v_mfma_f32_4x4x4_16b_bf16 v[80:83], v[8:9], v[102:103], 0
    v_mfma_f32_4x4x4_16b_bf16 v[76:79], v[8:9], v[100:101], 0
    v_bitop3_b32 v15, v6, v15, v46 bitop3:0xca
    v_bitop3_b32 v14, v6, v14, v47 bitop3:0xca
    v_cmp_lt_u32 s[84:85], v5, v92
    s_nop 0
    v_pk_mul_f32 v[80:81], v[80:81], v[14:15] op_sel:[0,1] op_sel_hi:[1,1]
    v_pk_mul_f32 v[82:83], v[82:83], v[14:15] op_sel:[0,1] op_sel_hi:[1,1]
    v_pk_mul_f32 v[76:77], v[76:77], v[14:15] op_sel:[0,0] op_sel_hi:[1,0]
    v_pk_mul_f32 v[78:79], v[78:79], v[14:15] op_sel:[0,0] op_sel_hi:[1,0]
    buffer_load_dwordx4 v[108:111], v3, s[16:19], s40 offen offset:0
    s_waitcnt lgkmcnt(0)
    v_cmpx_ne_u64 vcc, v[74:75], v[70:71]
    s_and_b64 s[82:83], vcc, s[80:81]
    s_cbranch_scc1 L2_c7
L2_d7:
    v_mov_b64 v[84:85], v[70:71]
    v_mov_b32 v7, v95
    v_mov_b64 v[86:87], v[74:75]
    s_mov_b64 exec, -1
    s_or_b64 s[80:81], s[80:81], vcc
    v_cmpx_ne_u64 vcc, v[72:73], v[68:69]
    s_and_b64 s[82:83], vcc, s[80:81]
    s_cbranch_scc1 L2_c8
L2_d8:
    v_mov_b64 v[84:85], v[68:69]
    v_mov_b32 v7, v94
    v_mov_b64 v[86:87], v[72:73]
    s_mov_b64 exec, -1
    s_or_b64 s[80:81], s[80:81], vcc
    ds_read_b64 v[70:71], v93
    s_and_b64 exec, s[84:85], s[80:81]
    v_mfma_f32_4x4x4_16b_bf16 v[76:79], v[12:13], v[84:85], 0
    v_mov_b32 v92, v7
    s_andn2_b64 s[80:81], s[80:81], s[84:85]
    v_mfma_f32_4x4x4_16b_bf16 v[76:79], v[10:11], v[86:87], v[76:79]
    s_mov_b64 exec, -1
    ds_read_b64 v[68:69], v92
    v_and_b32 v46, 0x80000000, v21
    v_lshrrev_b32 v47, 14, v19
    v_bitop3_b32 v47, v47, v5, v46 bitop3:0xea
    ds_read_b64 v[106:107], v47 offset:63616
    v_bitop3_b32 v95, v19, v5, v46 bitop3:0xea
    v_and_b32 v46, 0x40000000, v21
    v_lshrrev_b32 v47, 14, v18
    v_bitop3_b32 v47, v47, v5, v46 bitop3:0xea
    ds_read_b64 v[104:105], v47 offset:63616
    v_bitop3_b32 v94, v18, v5, v46 bitop3:0xea
    s_waitcnt lgkmcnt(2)
    v_mfma_f32_4x4x4_16b_bf16 v[80:83], v[10:11], v[70:71], v[80:83]
    v_mfma_f32_4x4x4_16b_bf16 v[76:79], v[10:11], v[68:69], v[76:79]
    v_perm_b32 v15, v19, v20, s47
    v_bitop3_b32 v46, v19, 0.5, -0.5 bitop3:0xa8
    v_perm_b32 v14, v18, v20, s46
    v_bitop3_b32 v47, v18, 0.5, -0.5 bitop3:0xa8
    v_cvt_pk_bf16_f32 v80, v80, v81
    v_cvt_pk_bf16_f32 v81, v82, v83
    ds_wrxchg_rtn_b64 v[74:75], v93, v[80:81]
    v_cvt_pk_bf16_f32 v76, v76, v77
    v_cvt_pk_bf16_f32 v77, v78, v79
    ds_wrxchg_rtn_b64 v[72:73], v92, v[76:77]
    s_setprio 2
    s_waitcnt lgkmcnt(2)
    v_mfma_f32_4x4x4_16b_bf16 v[80:83], v[8:9], v[106:107], 0
    v_mfma_f32_4x4x4_16b_bf16 v[76:79], v[8:9], v[104:105], 0
    v_bitop3_b32 v15, v6, v15, v46 bitop3:0xca
    v_bitop3_b32 v14, v6, v14, v47 bitop3:0xca
    s_nop 1
    v_pk_mul_f32 v[80:81], v[80:81], v[14:15] op_sel:[0,1] op_sel_hi:[1,1]
    v_pk_mul_f32 v[82:83], v[82:83], v[14:15] op_sel:[0,1] op_sel_hi:[1,1]
    v_pk_mul_f32 v[76:77], v[76:77], v[14:15] op_sel:[0,0] op_sel_hi:[1,0]
    v_pk_mul_f32 v[78:79], v[78:79], v[14:15] op_sel:[0,0] op_sel_hi:[1,0]
    v_and_b32 v47, 0x0fffffff, v40
    v_mov_b32 v21, v40
    buffer_load_dwordx4 v[16:19], v47, s[8:11], 0 offen
    buffer_load_dwordx3 v[18:20], v47, s[8:11], 0 offen offset:8
    s_waitcnt lgkmcnt(0)
    v_cmpx_ne_u64 vcc, v[74:75], v[70:71]
    s_and_b64 s[82:83], vcc, s[80:81]
    s_cbranch_scc1 L2_c9
L2_d9:
    v_mov_b64 v[84:85], v[70:71]
    v_mov_b32 v7, v93
    v_mov_b64 v[86:87], v[74:75]
    s_mov_b64 exec, -1
    s_or_b64 s[80:81], s[80:81], vcc
    v_cmpx_ne_u64 vcc, v[72:73], v[68:69]
    s_and_b64 s[82:83], vcc, s[80:81]
    s_cbranch_scc1 L2_c10
L2_d10:
    v_mov_b64 v[84:85], v[68:69]
    v_mov_b32 v7, v92
    v_mov_b64 v[86:87], v[72:73]
    s_mov_b64 exec, -1
    s_or_b64 s[80:81], s[80:81], vcc
    ds_read_b64 v[70:71], v95
    ds_read_b64 v[68:69], v94
    s_waitcnt vmcnt(10)
    v_and_b32 v46, 0x20000000, v27
    v_lshrrev_b32 v47, 14, v23
    v_bitop3_b32 v47, v47, v5, v46 bitop3:0xea
    ds_read_b64 v[102:103], v47 offset:63616
    v_bitop3_b32 v93, v23, v5, v46 bitop3:0xea
    v_and_b32 v46, 0x10000000, v27
    v_lshrrev_b32 v47, 14, v22
    v_bitop3_b32 v47, v47, v5, v46 bitop3:0xea
    ds_read_b64 v[100:101], v47 offset:63616
    v_bitop3_b32 v92, v22, v5, v46 bitop3:0xea
    s_waitcnt lgkmcnt(2)
    v_mfma_f32_4x4x4_16b_bf16 v[80:83], v[10:11], v[70:71], v[80:83]
    v_mfma_f32_4x4x4_16b_bf16 v[76:79], v[10:11], v[68:69], v[76:79]
    v_perm_b32 v15, v23, v26, s45
    v_bitop3_b32 v46, v23, 0.5, -0.5 bitop3:0xa8
    v_perm_b32 v14, v22, v26, s44
    v_bitop3_b32 v47, v22, 0.5, -0.5 bitop3:0xa8
    v_cvt_pk_bf16_f32 v80, v80, v81
    v_cvt_pk_bf16_f32 v81, v82, v83
    ds_wrxchg_rtn_b64 v[74:75], v95, v[80:81]
    v_cvt_pk_bf16_f32 v76, v76, v77
    v_cvt_pk_bf16_f32 v77, v78, v79
    ds_wrxchg_rtn_b64 v[72:73], v94, v[76:77]
    s_waitcnt lgkmcnt(2)
    v_mfma_f32_4x4x4_16b_bf16 v[80:83], v[8:9], v[102:103], 0
    v_mfma_f32_4x4x4_16b_bf16 v[76:79], v[8:9], v[100:101], 0
    v_bitop3_b32 v15, v6, v15, v46 bitop3:0xca
    v_bitop3_b32 v14, v6, v14, v47 bitop3:0xca
    v_cmp_lt_u32 s[84:85], v5, v92
    s_nop 0
    v_pk_mul_f32 v[80:81], v[80:81], v[14:15] op_sel:[0,1] op_sel_hi:[1,1]
    v_pk_mul_f32 v[82:83], v[82:83], v[14:15] op_sel:[0,1] op_sel_hi:[1,1]
    v_pk_mul_f32 v[76:77], v[76:77], v[14:15] op_sel:[0,0] op_sel_hi:[1,0]
    v_pk_mul_f32 v[78:79], v[78:79], v[14:15] op_sel:[0,0] op_sel_hi:[1,0]
    v_sub_u16 v88, v60, v52
    v_and_b32 v89, 3, v52
    v_add3_u32 v99, v88, v89, 3
    v_and_b32 v99, -4, v99
    v_max_u32 v99, 4, v99
    v_and_b32 v97, 0xfffc, v52
    v_bfm_b32 v96, v88, v89
    v_add_u32_dpp v91, v99, v99 row_shr:1 row_mask:0xf bank_mask:0xf bound_ctrl:1
    v_mad_u32_u24 v97, v97, 5, v2
    v_cmp_lt_u32 vcc, 16, v99
    v_add_u32_dpp v91, v91, v91 row_shr:2 row_mask:0xf bank_mask:0xf bound_ctrl:1
    v_sub_u32 v98, s38, v99
    v_lshrrev_b64 v[52:53], 16, v[52:53]
    v_add_u32_dpp v91, v91, v91 row_shr:4 row_mask:0xf bank_mask:0xf bound_ctrl:1
    v_lshrrev_b64 v[60:61], 16, v[60:61]
    s_mov_b32 s43, 0
    v_add_u32_dpp v91, v91, v91 row_shr:8 row_mask:0xf bank_mask:0xf bound_ctrl:1
    s_nop 1
    v_add_u32_dpp v91, v91, v91 row_bcast:15 row_mask:0xa bank_mask:0xf
    s_nop 1
    v_add_u32_dpp v91, v91, v91 row_bcast:31 row_mask:0xc bank_mask:0xf
    v_add_u32 v98, v98, v91
    v_readlane_b32 s37, v91, 63
    s_cbranch_vccnz L2_xo11
L2_xp11:
    buffer_load_dwordx4 v[112:115], v3, s[16:19], s40 offen offset:1024
    s_waitcnt lgkmcnt(0)
    v_cmpx_ne_u64 vcc, v[74:75], v[70:71]
    s_and_b64 s[82:83], vcc, s[80:81]
    s_cbranch_scc1 L2_c12
L2_d12:
    v_mov_b64 v[84:85], v[70:71]
    v_mov_b32 v7, v95
    v_mov_b64 v[86:87], v[74:75]
    s_mov_b64 exec, -1
    s_or_b64 s[80:81], s[80:81], vcc
    v_cmpx_ne_u64 vcc, v[72:73], v[68:69]
    s_and_b64 s[82:83], vcc, s[80:81]
    s_cbranch_scc1 L2_c13
L2_d13:
    v_mov_b64 v[84:85], v[68:69]
    v_mov_b32 v7, v94
    v_mov_b64 v[86:87], v[72:73]
    s_mov_b64 exec, -1
    s_or_b64 s[80:81], s[80:81], vcc
    ds_read_b64 v[70:71], v93
    s_and_b64 exec, s[84:85], s[80:81]
    v_mfma_f32_4x4x4_16b_bf16 v[76:79], v[12:13], v[84:85], 0
    v_mov_b32 v92, v7
    s_andn2_b64 s[80:81], s[80:81], s[84:85]
    v_mfma_f32_4x4x4_16b_bf16 v[76:79], v[10:11], v[86:87], v[76:79]
    s_mov_b64 exec, -1
    ds_read_b64 v[68:69], v92
    v_and_b32 v46, 0x80000000, v27
    v_lshrrev_b32 v47, 14, v25
    v_bitop3_b32 v47, v47, v5, v46 bitop3:0xea
    ds_read_b64 v[106:107], v47 offset:63616
    v_bitop3_b32 v95, v25, v5, v46 bitop3:0xea
    v_and_b32 v46, 0x40000000, v27
    v_lshrrev_b32 v47, 14, v24
    v_bitop3_b32 v47, v47, v5, v46 bitop3:0xea
    ds_read_b64 v[104:105], v47 offset:63616
    v_bitop3_b32 v94, v24, v5, v46 bitop3:0xea
    s_waitcnt lgkmcnt(2)
    v_mfma_f32_4x4x4_16b_bf16 v[80:83], v[10:11], v[70:71], v[80:83]
    v_mfma_f32_4x4x4_16b_bf16 v[76:79], v[10:11], v[68:69], v[76:79]
    v_perm_b32 v15, v25, v26, s47
    v_bitop3_b32 v46, v25, 0.5, -0.5 bitop3:0xa8
    v_perm_b32 v14, v24, v26, s46
    v_bitop3_b32 v47, v24, 0.5, -0.5 bitop3:0xa8
    v_cvt_pk_bf16_f32 v80, v80, v81
    v_cvt_pk_bf16_f32 v81, v82, v83
    ds_wrxchg_rtn_b64 v[74:75], v93, v[80:81]
    v_cvt_pk_bf16_f32 v76, v76, v77
    v_cvt_pk_bf16_f32 v77, v78, v79
    ds_wrxchg_rtn_b64 v[72:73], v92, v[76:77]
    s_setprio 1
    s_waitcnt lgkmcnt(2)
    v_mfma_f32_4x4x4_16b_bf16 v[80:83], v[8:9], v[106:107], 0
    v_mfma_f32_4x4x4_16b_bf16 v[76:79], v[8:9], v[104:105], 0
    v_bitop3_b32 v15, v6, v15, v46 bitop3:0xca
    v_bitop3_b32 v14, v6, v14, v47 bitop3:0xca
    s_nop 1
    v_pk_mul_f32 v[80:81], v[80:81], v[14:15] op_sel:[0,1] op_sel_hi:[1,1]
    v_pk_mul_f32 v[82:83], v[82:83], v[14:15] op_sel:[0,1] op_sel_hi:[1,1]
    v_pk_mul_f32 v[76:77], v[76:77], v[14:15] op_sel:[0,0] op_sel_hi:[1,0]
    v_pk_mul_f32 v[78:79], v[78:79], v[14:15] op_sel:[0,0] op_sel_hi:[1,0]
    v_and_b32 v47, 0x0fffffff, v41
    v_mov_b32 v27, v41
    buffer_load_dwordx4 v[22:25], v47, s[8:11], 0 offen
    buffer_load_dwordx3 v[24:26], v47, s[8:11], 0 offen offset:8
    s_waitcnt lgkmcnt(0)
    v_cmpx_ne_u64 vcc, v[74:75], v[70:71]
    s_and_b64 s[82:83], vcc, s[80:81]
    s_cbranch_scc1 L2_c14
L2_d14:
    v_mov_b64 v[84:85], v[70:71]
    v_mov_b32 v7, v93
    v_mov_b64 v[86:87], v[74:75]
    s_mov_b64 exec, -1
    s_or_b64 s[80:81], s[80:81], vcc
    v_cmpx_ne_u64 vcc, v[72:73], v[68:69]
    s_and_b64 s[82:83], vcc, s[80:81]
    s_cbranch_scc1 L2_c15
L2_d15:
    v_mov_b64 v[84:85], v[68:69]
    v_mov_b32 v7, v92
    v_mov_b64 v[86:87], v[72:73]
    s_mov_b64 exec, -1
    s_or_b64 s[80:81], s[80:81], vcc
    ds_read_b64 v[70:71], v95
    ds_read_b64 v[68:69], v94
    s_waitcnt vmcnt(11)
    v_and_b32 v46, 0x20000000, v33
    v_lshrrev_b32 v47, 14, v29
    v_bitop3_b32 v47, v47, v5, v46 bitop3:0xea
    ds_read_b64 v[102:103], v47 offset:63616
    v_bitop3_b32 v93, v29, v5, v46 bitop3:0xea
    v_and_b32 v46, 0x10000000, v33
    v_lshrrev_b32 v47, 14, v28
    v_bitop3_b32 v47, v47, v5, v46 bitop3:0xea
    ds_read_b64 v[100:101], v47 offset:63616
    v_bitop3_b32 v92, v28, v5, v46 bitop3:0xea
    s_waitcnt lgkmcnt(2)
    v_mfma_f32_4x4x4_16b_bf16 v[80:83], v[10:11], v[70:71], v[80:83]
    v_mfma_f32_4x4x4_16b_bf16 v[76:79], v[10:11], v[68:69], v[76:79]
    v_perm_b32 v15, v29, v32, s45
    v_bitop3_b32 v46, v29, 0.5, -0.5 bitop3:0xa8
    v_perm_b32 v14, v28, v32, s44
    v_bitop3_b32 v47, v28, 0.5, -0.5 bitop3:0xa8
    v_cvt_pk_bf16_f32 v80, v80, v81
    v_cvt_pk_bf16_f32 v81, v82, v83
    ds_wrxchg_rtn_b64 v[74:75], v95, v[80:81]
    v_cvt_pk_bf16_f32 v76, v76, v77
    v_cvt_pk_bf16_f32 v77, v78, v79
    ds_wrxchg_rtn_b64 v[72:73], v94, v[76:77]
    s_waitcnt lgkmcnt(2)
    v_mfma_f32_4x4x4_16b_bf16 v[80:83], v[8:9], v[102:103], 0
    v_mfma_f32_4x4x4_16b_bf16 v[76:79], v[8:9], v[100:101], 0
    v_bitop3_b32 v15, v6, v15, v46 bitop3:0xca
    v_bitop3_b32 v14, v6, v14, v47 bitop3:0xca
    v_cmp_lt_u32 s[84:85], v5, v92
    s_nop 0
    v_pk_mul_f32 v[80:81], v[80:81], v[14:15] op_sel:[0,1] op_sel_hi:[1,1]
    v_pk_mul_f32 v[82:83], v[82:83], v[14:15] op_sel:[0,1] op_sel_hi:[1,1]
    v_pk_mul_f32 v[76:77], v[76:77], v[14:15] op_sel:[0,0] op_sel_hi:[1,0]
    v_pk_mul_f32 v[78:79], v[78:79], v[14:15] op_sel:[0,0] op_sel_hi:[1,0]
    s_waitcnt lgkmcnt(0)
    v_cmpx_ne_u64 vcc, v[74:75], v[70:71]
    s_and_b64 s[82:83], vcc, s[80:81]
    s_cbranch_scc1 L2_c16
L2_d16:
    v_mov_b64 v[84:85], v[70:71]
    v_mov_b32 v7, v95
    v_mov_b64 v[86:87], v[74:75]
    s_mov_b64 exec, -1
    s_or_b64 s[80:81], s[80:81], vcc
    v_cmpx_ne_u64 vcc, v[72:73], v[68:69]
    s_and_b64 s[82:83], vcc, s[80:81]
    s_cbranch_scc1 L2_c17
L2_d17:
    v_mov_b64 v[84:85], v[68:69]
    v_mov_b32 v7, v94
    v_mov_b64 v[86:87], v[72:73]
    s_mov_b64 exec, -1
    s_or_b64 s[80:81], s[80:81], vcc
    ds_read_b64 v[70:71], v93
    s_and_b64 exec, s[84:85], s[80:81]
    v_mfma_f32_4x4x4_16b_bf16 v[76:79], v[12:13], v[84:85], 0
    v_mov_b32 v92, v7
    s_andn2_b64 s[80:81], s[80:81], s[84:85]
    v_mfma_f32_4x4x4_16b_bf16 v[76:79], v[10:11], v[86:87], v[76:79]
    s_mov_b64 exec, -1
    ds_read_b64 v[68:69], v92
    v_and_b32 v46, 0x80000000, v33
    v_lshrrev_b32 v47, 14, v31
    v_bitop3_b32 v47, v47, v5, v46 bitop3:0xea
    ds_read_b64 v[106:107], v47 offset:63616
    v_bitop3_b32 v95, v31, v5, v46 bitop3:0xea
    v_and_b32 v46, 0x40000000, v33
    v_lshrrev_b32 v47, 14, v30
    v_bitop3_b32 v47, v47, v5, v46 bitop3:0xea
    ds_read_b64 v[104:105], v47 offset:63616
    v_bitop3_b32 v94, v30, v5, v46 bitop3:0xea
    s_waitcnt lgkmcnt(2)
    v_mfma_f32_4x4x4_16b_bf16 v[80:83], v[10:11], v[70:71], v[80:83]
    v_mfma_f32_4x4x4_16b_bf16 v[76:79], v[10:11], v[68:69], v[76:79]
    v_perm_b32 v15, v31, v32, s47
    v_bitop3_b32 v46, v31, 0.5, -0.5 bitop3:0xa8
    v_perm_b32 v14, v30, v32, s46
    v_bitop3_b32 v47, v30, 0.5, -0.5 bitop3:0xa8
    v_cvt_pk_bf16_f32 v80, v80, v81
    v_cvt_pk_bf16_f32 v81, v82, v83
    ds_wrxchg_rtn_b64 v[74:75], v93, v[80:81]
    v_cvt_pk_bf16_f32 v76, v76, v77
    v_cvt_pk_bf16_f32 v77, v78, v79
    ds_wrxchg_rtn_b64 v[72:73], v92, v[76:77]
    s_setprio 0
    s_waitcnt lgkmcnt(2)
    v_mfma_f32_4x4x4_16b_bf16 v[80:83], v[8:9], v[106:107], 0
    v_mfma_f32_4x4x4_16b_bf16 v[76:79], v[8:9], v[104:105], 0
    v_bitop3_b32 v15, v6, v15, v46 bitop3:0xca
    v_bitop3_b32 v14, v6, v14, v47 bitop3:0xca
    s_nop 1
    v_pk_mul_f32 v[80:81], v[80:81], v[14:15] op_sel:[0,1] op_sel_hi:[1,1]
    v_pk_mul_f32 v[82:83], v[82:83], v[14:15] op_sel:[0,1] op_sel_hi:[1,1]
    v_pk_mul_f32 v[76:77], v[76:77], v[14:15] op_sel:[0,0] op_sel_hi:[1,0]
    v_pk_mul_f32 v[78:79], v[78:79], v[14:15] op_sel:[0,0] op_sel_hi:[1,0]
    s_add_u32 s40, s40, 0x4e200
    v_and_b32 v47, 0x0fffffff, v42
    v_mov_b32 v33, v42
    buffer_load_dwordx4 v[28:31], v47, s[8:11], 0 offen
    buffer_load_dwordx3 v[30:32], v47, s[8:11], 0 offen offset:8
    s_waitcnt lgkmcnt(0)
    v_cmpx_ne_u64 vcc, v[74:75], v[70:71]
    s_and_b64 s[82:83], vcc, s[80:81]
    s_cbranch_scc1 L2_c18
L2_d18:
    v_mov_b64 v[84:85], v[70:71]
    v_mov_b32 v7, v93
    v_mov_b64 v[86:87], v[74:75]
    s_mov_b64 exec, -1
    s_or_b64 s[80:81], s[80:81], vcc
    v_cmpx_ne_u64 vcc, v[72:73], v[68:69]
    s_and_b64 s[82:83], vcc, s[80:81]
    s_cbranch_scc1 L2_c19
L2_d19:
    v_mov_b64 v[84:85], v[68:69]
    v_mov_b32 v7, v92
    v_mov_b64 v[86:87], v[72:73]
    s_mov_b64 exec, -1
    s_or_b64 s[80:81], s[80:81], vcc
    ds_read_b64 v[70:71], v95
    ds_read_b64 v[68:69], v94
    s_waitcnt vmcnt(8)
    v_and_b32 v46, 0x20000000, v39
    v_lshrrev_b32 v47, 14, v35
    v_bitop3_b32 v47, v47, v5, v46 bitop3:0xea
    ds_read_b64 v[102:103], v47 offset:63616
    v_bitop3_b32 v93, v35, v5, v46 bitop3:0xea
    v_and_b32 v46, 0x10000000, v39
    v_lshrrev_b32 v47, 14, v34
    v_bitop3_b32 v47, v47, v5, v46 bitop3:0xea
    ds_read_b64 v[100:101], v47 offset:63616
    v_bitop3_b32 v92, v34, v5, v46 bitop3:0xea
    v_and_b32 v46, 0x80000000, v39
    v_lshrrev_b32 v47, 14, v37
    v_bitop3_b32 v47, v47, v5, v46 bitop3:0xea
    ds_read_b64 v[106:107], v47 offset:63616
    v_and_b32 v46, 0x40000000, v39
    v_lshrrev_b32 v47, 14, v36
    v_bitop3_b32 v47, v47, v5, v46 bitop3:0xea
    ds_read_b64 v[104:105], v47 offset:63616
    s_waitcnt lgkmcnt(4)
    v_mfma_f32_4x4x4_16b_bf16 v[80:83], v[10:11], v[70:71], v[80:83]
    v_mfma_f32_4x4x4_16b_bf16 v[76:79], v[10:11], v[68:69], v[76:79]
    v_perm_b32 v15, v35, v38, s45
    v_bitop3_b32 v46, v35, 0.5, -0.5 bitop3:0xa8
    v_perm_b32 v14, v34, v38, s44
    v_bitop3_b32 v47, v34, 0.5, -0.5 bitop3:0xa8
    v_cvt_pk_bf16_f32 v80, v80, v81
    v_cvt_pk_bf16_f32 v81, v82, v83
    ds_wrxchg_rtn_b64 v[74:75], v95, v[80:81]
    v_cvt_pk_bf16_f32 v76, v76, v77
    v_cvt_pk_bf16_f32 v77, v78, v79
    ds_wrxchg_rtn_b64 v[72:73], v94, v[76:77]
    s_waitcnt lgkmcnt(2)
    s_barrier
    s_setprio 3
    ds_write_b128 v3, v[124:127] offset:4096
    s_add_u32 s3, s40, 4096
    buffer_load_dwordx4 v[124:127], v3, s[16:19], s3 offen
    ds_write_b128 v3, v[116:119] offset:2048
    buffer_load_dwordx4 v[116:119], v3, s[16:19], s40 offen offset:2048
    ds_write_b128 v3, v[120:123] offset:3072
    buffer_load_dwordx4 v[120:123], v3, s[16:19], s40 offen offset:3072
    v_mfma_f32_4x4x4_16b_bf16 v[80:83], v[8:9], v[102:103], 0
    v_mfma_f32_4x4x4_16b_bf16 v[76:79], v[8:9], v[100:101], 0
    v_bitop3_b32 v15, v6, v15, v46 bitop3:0xca
    v_bitop3_b32 v14, v6, v14, v47 bitop3:0xca
    v_cmp_lt_u32 s[84:85], v5, v92
    s_nop 0
    v_pk_mul_f32 v[80:81], v[80:81], v[14:15] op_sel:[0,1] op_sel_hi:[1,1]
    v_pk_mul_f32 v[82:83], v[82:83], v[14:15] op_sel:[0,1] op_sel_hi:[1,1]
    v_pk_mul_f32 v[76:77], v[76:77], v[14:15] op_sel:[0,0] op_sel_hi:[1,0]
    v_pk_mul_f32 v[78:79], v[78:79], v[14:15] op_sel:[0,0] op_sel_hi:[1,0]
    v_mov_b32 v44, v43
    s_cmp_gt_u32 s37, 1024
    s_cbranch_scc1 L2_xs20
    s_cmp_lg_u32 s43, 0
    s_cbranch_scc1 L2_xa20
L2_xb20:
    v_lshlrev_b32 v89, 16, v96
    v_add_u32 v90, 60, v97
    v_bitop3_b32 v90, v89, v45, v90 bitop3:0x6a
    ds_write_b32 v98, v90 offset:12
    v_lshlrev_b32 v89, 20, v96
    v_add_u32 v90, 40, v97
    v_bitop3_b32 v90, v89, v45, v90 bitop3:0x6a
    ds_write_b32 v98, v90 offset:8
    v_lshlrev_b32 v89, 24, v96
    v_add_u32 v90, 20, v97
    v_bitop3_b32 v90, v89, v45, v90 bitop3:0x6a
    ds_write_b32 v98, v90 offset:4
    v_lshlrev_b32 v89, 28, v96
    v_bitop3_b32 v90, v89, v45, v97 bitop3:0x6a
    ds_write_b32 v98, v90 offset:0
    v_mov_b32_dpp v91, v64 quad_perm:[1,1,1,1] row_mask:0xf bank_mask:0xf
    v_and_b32 v89, 3, v91
    v_and_b32 v97, 0xfffc, v91
    v_sub_u16_dpp v88, v64, v91 quad_perm:[3,3,3,3] row_mask:0xf bank_mask:0xf
    v_mad_u32_u24 v97, v97, 5, v4
    v_add_u32 v99, v88, v89
    v_bfm_b32 v96, v88, v89
    v_cmp_lt_u32 s[58:59], 16, v99
    v_lshlrev_b32 v89, v1, v96
    v_and_b32 v89, v45, v89
    v_cmp_ne_u32 vcc, 0, v89
    v_xor_b32 v90, v97, v89
    s_add_u32 s3, s37, s38
    v_mbcnt_lo_u32_b32 v98, vcc_lo, 0
    v_mbcnt_hi_u32_b32 v98, vcc_hi, v98
    s_bcnt1_i32_b64 s41, vcc
    v_lshl_add_u32 v98, v98, 2, s3
    s_mov_b64 exec, vcc
    ds_write_b32 v98, v90
    s_mov_b64 exec, -1
    s_lshl2_add_u32 s37, s41, s37
    s_cmp_lg_u64 s[58:59], 0
    s_cbranch_scc1 L2_xe20
L2_xr20:
    v_add_u32 v98, s37, v0
    v_mov_b32 v90, -1
    ds_write_b32 v98, v90
    ds_read2st64_b32 v[40:41], v0 offset0:0 offset1:1
    ds_read2st64_b32 v[42:43], v0 offset0:2 offset1:3
    s_sub_u32 s3, s37, 768
    s_cmp_gt_u32 s3, 256
    s_cbranch_scc1 L2_xf20
L2_xg20:
    s_setprio 2
    s_waitcnt vmcnt(10)
    ds_write_b128 v3, v[108:111] offset:0
    s_waitcnt lgkmcnt(12)
    v_cmpx_ne_u64 vcc, v[74:75], v[70:71]
    s_and_b64 s[82:83], vcc, s[80:81]
    s_cbranch_scc1 L2_c21
L2_d21:
    v_mov_b64 v[84:85], v[70:71]
    v_mov_b32 v7, v95
    v_mov_b64 v[86:87], v[74:75]
    s_mov_b64 exec, -1
    s_or_b64 s[80:81], s[80:81], vcc
    v_cmpx_ne_u64 vcc, v[72:73], v[68:69]
    s_and_b64 s[82:83], vcc, s[80:81]
    s_cbranch_scc1 L2_c22
L2_d22:
    v_mov_b64 v[84:85], v[68:69]
    v_mov_b32 v7, v94
    v_mov_b64 v[86:87], v[72:73]
    s_mov_b64 exec, -1
    s_or_b64 s[80:81], s[80:81], vcc
    ds_read_b64 v[70:71], v93
    s_and_b64 exec, s[84:85], s[80:81]
    v_mfma_f32_4x4x4_16b_bf16 v[76:79], v[12:13], v[84:85], 0
    v_mov_b32 v92, v7
    s_andn2_b64 s[80:81], s[80:81], s[84:85]
    v_mfma_f32_4x4x4_16b_bf16 v[76:79], v[10:11], v[86:87], v[76:79]
    s_mov_b64 exec, -1
    ds_read_b64 v[68:69], v92
    s_setprio 1
    s_waitcnt vmcnt(7)
    ds_write_b128 v3, v[112:115] offset:1024
    s_waitcnt lgkmcnt(1)
    v_mfma_f32_4x4x4_16b_bf16 v[80:83], v[10:11], v[70:71], v[80:83]
    v_mfma_f32_4x4x4_16b_bf16 v[76:79], v[10:11], v[68:69], v[76:79]
    v_and_b32 v46, 0x40000000, v39
    v_bitop3_b32 v94, v36, v5, v46 bitop3:0xea
    v_and_b32 v46, 0x80000000, v39
    v_bitop3_b32 v95, v37, v5, v46 bitop3:0xea
    v_perm_b32 v15, v37, v38, s47
    v_bitop3_b32 v46, v37, 0.5, -0.5 bitop3:0xa8
    v_perm_b32 v14, v36, v38, s46
    v_bitop3_b32 v47, v36, 0.5, -0.5 bitop3:0xa8
    v_cvt_pk_bf16_f32 v80, v80, v81
    v_cvt_pk_bf16_f32 v81, v82, v83
    ds_wrxchg_rtn_b64 v[74:75], v93, v[80:81]
    v_cvt_pk_bf16_f32 v76, v76, v77
    v_cvt_pk_bf16_f32 v77, v78, v79
    ds_wrxchg_rtn_b64 v[72:73], v92, v[76:77]
    s_setprio 0
    v_mfma_f32_4x4x4_16b_bf16 v[80:83], v[8:9], v[106:107], 0
    v_mfma_f32_4x4x4_16b_bf16 v[76:79], v[8:9], v[104:105], 0
    v_bitop3_b32 v15, v6, v15, v46 bitop3:0xca
    v_bitop3_b32 v14, v6, v14, v47 bitop3:0xca
    s_nop 1
    v_pk_mul_f32 v[80:81], v[80:81], v[14:15] op_sel:[0,1] op_sel_hi:[1,1]
    v_pk_mul_f32 v[82:83], v[82:83], v[14:15] op_sel:[0,1] op_sel_hi:[1,1]
    v_pk_mul_f32 v[76:77], v[76:77], v[14:15] op_sel:[0,0] op_sel_hi:[1,0]
    v_pk_mul_f32 v[78:79], v[78:79], v[14:15] op_sel:[0,0] op_sel_hi:[1,0]
    s_add_u32 s42, s42, 1
    s_waitcnt lgkmcnt(2)
    s_barrier
    s_bitcmp1_b32 s36, s42
    s_cbranch_scc1 L2_slow
L2_ret1:
    s_setprio 3
    v_and_b32 v47, 0x0fffffff, v44
    v_mov_b32 v39, v44
    buffer_load_dwordx4 v[34:37], v47, s[8:11], 0 offen
    buffer_load_dwordx3 v[36:38], v47, s[8:11], 0 offen offset:8
    s_waitcnt lgkmcnt(0)
    v_cmpx_ne_u64 vcc, v[74:75], v[70:71]
    s_and_b64 s[82:83], vcc, s[80:81]
    s_cbranch_scc1 L2_c23
L2_d23:
    v_mov_b64 v[84:85], v[70:71]
    v_mov_b32 v7, v93
    v_mov_b64 v[86:87], v[74:75]
    s_mov_b64 exec, -1
    s_or_b64 s[80:81], s[80:81], vcc
    v_cmpx_ne_u64 vcc, v[72:73], v[68:69]
    s_and_b64 s[82:83], vcc, s[80:81]
    s_cbranch_scc1 L2_c24
L2_d24:
    v_mov_b64 v[84:85], v[68:69]
    v_mov_b32 v7, v92
    v_mov_b64 v[86:87], v[72:73]
    s_mov_b64 exec, -1
    s_or_b64 s[80:81], s[80:81], vcc
    ds_read_b64 v[70:71], v95
    ds_read_b64 v[68:69], v94
    v_and_b32 v46, 0x20000000, v21
    v_lshrrev_b32 v47, 14, v17
    v_bitop3_b32 v47, v47, v5, v46 bitop3:0xea
    ds_read_b64 v[102:103], v47 offset:63616
    v_bitop3_b32 v93, v17, v5, v46 bitop3:0xea
    v_and_b32 v46, 0x10000000, v21
    v_lshrrev_b32 v47, 14, v16
    v_bitop3_b32 v47, v47, v5, v46 bitop3:0xea
    ds_read_b64 v[100:101], v47 offset:63616
    v_bitop3_b32 v92, v16, v5, v46 bitop3:0xea
    s_waitcnt lgkmcnt(2)
    v_mfma_f32_4x4x4_16b_bf16 v[80:83], v[10:11], v[70:71], v[80:83]
    v_mfma_f32_4x4x4_16b_bf16 v[76:79], v[10:11], v[68:69], v[76:79]
    v_perm_b32 v15, v17, v20, s45
    v_bitop3_b32 v46, v17, 0.5, -0.5 bitop3:0xa8
    v_perm_b32 v14, v16, v20, s44
    v_bitop3_b32 v47, v16, 0.5, -0.5 bitop3:0xa8
    v_cvt_pk_bf16_f32 v80, v80, v81
    v_cvt_pk_bf16_f32 v81, v82, v83
    ds_wrxchg_rtn_b64 v[74:75], v95, v[80:81]
    v_cvt_pk_bf16_f32 v76, v76, v77
    v_cvt_pk_bf16_f32 v77, v78, v79
    ds_wrxchg_rtn_b64 v[72:73], v94, v[76:77]
    s_waitcnt lgkmcnt(2)
    v_mfma_f32_4x4x4_16b_bf16 v[80:83], v[8:9], v[102:103], 0
    v_mfma_f32_4x4x4_16b_bf16 v[76:79], v[8:9], v[100:101], 0
    v_bitop3_b32 v15, v6, v15, v46 bitop3:0xca
    v_bitop3_b32 v14, v6, v14, v47 bitop3:0xca
    v_cmp_lt_u32 s[84:85], v5, v92
    s_nop 0
    v_pk_mul_f32 v[80:81], v[80:81], v[14:15] op_sel:[0,1] op_sel_hi:[1,1]
    v_pk_mul_f32 v[82:83], v[82:83], v[14:15] op_sel:[0,1] op_sel_hi:[1,1]
    v_pk_mul_f32 v[76:77], v[76:77], v[14:15] op_sel:[0,0] op_sel_hi:[1,0]
    v_pk_mul_f32 v[78:79], v[78:79], v[14:15] op_sel:[0,0] op_sel_hi:[1,0]
    buffer_load_dwordx4 v[108:111], v3, s[16:19], s40 offen offset:0
    s_waitcnt lgkmcnt(0)
    v_cmpx_ne_u64 vcc, v[74:75], v[70:71]
    s_and_b64 s[82:83], vcc, s[80:81]
    s_cbranch_scc1 L2_c25
L2_d25:
    v_mov_b64 v[84:85], v[70:71]
    v_mov_b32 v7, v95
    v_mov_b64 v[86:87], v[74:75]
    s_mov_b64 exec, -1
    s_or_b64 s[80:81], s[80:81], vcc
    v_cmpx_ne_u64 vcc, v[72:73], v[68:69]
    s_and_b64 s[82:83], vcc, s[80:81]
    s_cbranch_scc1 L2_c26
L2_d26:
    v_mov_b64 v[84:85], v[68:69]
    v_mov_b32 v7, v94
    v_mov_b64 v[86:87], v[72:73]
    s_mov_b64 exec, -1
    s_or_b64 s[80:81], s[80:81], vcc
    ds_read_b64 v[70:71], v93
    s_and_b64 exec, s[84:85], s[80:81]
    v_mfma_f32_4x4x4_16b_bf16 v[76:79], v[12:13], v[84:85], 0
    v_mov_b32 v92, v7
    s_andn2_b64 s[80:81], s[80:81], s[84:85]
    v_mfma_f32_4x4x4_16b_bf16 v[76:79], v[10:11], v[86:87], v[76:79]
    s_mov_b64 exec, -1
    ds_read_b64 v[68:69], v92
    v_and_b32 v46, 0x80000000, v21
    v_lshrrev_b32 v47, 14, v19
    v_bitop3_b32 v47, v47, v5, v46 bitop3:0xea
    ds_read_b64 v[106:107], v47 offset:63616
    v_bitop3_b32 v95, v19, v5, v46 bitop3:0xea
    v_and_b32 v46, 0x40000000, v21
    v_lshrrev_b32 v47, 14, v18
    v_bitop3_b32 v47, v47, v5, v46 bitop3:0xea
    ds_read_b64 v[104:105], v47 offset:63616
    v_bitop3_b32 v94, v18, v5, v46 bitop3:0xea
    s_waitcnt lgkmcnt(2)
    v_mfma_f32_4x4x4_16b_bf16 v[80:83], v[10:11], v[70:71], v[80:83]
    v_mfma_f32_4x4x4_16b_bf16 v[76:79], v[10:11], v[68:69], v[76:79]
    v_perm_b32 v15, v19, v20, s47
    v_bitop3_b32 v46, v19, 0.5, -0.5 bitop3:0xa8
    v_perm_b32 v14, v18, v20, s46
    v_bitop3_b32 v47, v18, 0.5, -0.5 bitop3:0xa8
    v_cvt_pk_bf16_f32 v80, v80, v81
    v_cvt_pk_bf16_f32 v81, v82, v83
    ds_wrxchg_rtn_b64 v[74:75], v93, v[80:81]
    v_cvt_pk_bf16_f32 v76, v76, v77
    v_cvt_pk_bf16_f32 v77, v78, v79
    ds_wrxchg_rtn_b64 v[72:73], v92, v[76:77]
    s_setprio 2
    s_waitcnt lgkmcnt(2)
    v_mfma_f32_4x4x4_16b_bf16 v[80:83], v[8:9], v[106:107], 0
    v_mfma_f32_4x4x4_16b_bf16 v[76:79], v[8:9], v[104:105], 0
    v_bitop3_b32 v15, v6, v15, v46 bitop3:0xca
    v_bitop3_b32 v14, v6, v14, v47 bitop3:0xca
    s_nop 1
    v_pk_mul_f32 v[80:81], v[80:81], v[14:15] op_sel:[0,1] op_sel_hi:[1,1]
    v_pk_mul_f32 v[82:83], v[82:83], v[14:15] op_sel:[0,1] op_sel_hi:[1,1]
    v_pk_mul_f32 v[76:77], v[76:77], v[14:15] op_sel:[0,0] op_sel_hi:[1,0]
    v_pk_mul_f32 v[78:79], v[78:79], v[14:15] op_sel:[0,0] op_sel_hi:[1,0]
    v_and_b32 v47, 0x0fffffff, v40
    v_mov_b32 v21, v40
    buffer_load_dwordx4 v[16:19], v47, s[8:11], 0 offen
    buffer_load_dwordx3 v[18:20], v47, s[8:11], 0 offen offset:8
    s_waitcnt lgkmcnt(0)
    v_cmpx_ne_u64 vcc, v[74:75], v[70:71]
    s_and_b64 s[82:83], vcc, s[80:81]
    s_cbranch_scc1 L2_c27
L2_d27:
    v_mov_b64 v[84:85], v[70:71]
    v_mov_b32 v7, v93
    v_mov_b64 v[86:87], v[74:75]
    s_mov_b64 exec, -1
    s_or_b64 s[80:81], s[80:81], vcc
    v_cmpx_ne_u64 vcc, v[72:73], v[68:69]
    s_and_b64 s[82:83], vcc, s[80:81]
    s_cbranch_scc1 L2_c28
L2_d28:
    v_mov_b64 v[84:85], v[68:69]
    v_mov_b32 v7, v92
    v_mov_b64 v[86:87], v[72:73]
    s_mov_b64 exec, -1
    s_or_b64 s[80:81], s[80:81], vcc
    ds_read_b64 v[70:71], v95
    ds_read_b64 v[68:69], v94
    s_waitcnt vmcnt(10)
    v_and_b32 v46, 0x20000000, v27
    v_lshrrev_b32 v47, 14, v23
    v_bitop3_b32 v47, v47, v5, v46 bitop3:0xea
    ds_read_b64 v[102:103], v47 offset:63616
    v_bitop3_b32 v93, v23, v5, v46 bitop3:0xea
    v_and_b32 v46, 0x10000000, v27
    v_lshrrev_b32 v47, 14, v22
    v_bitop3_b32 v47, v47, v5, v46 bitop3:0xea
    ds_read_b64 v[100:101], v47 offset:63616
    v_bitop3_b32 v92, v22, v5, v46 bitop3:0xea
    s_waitcnt lgkmcnt(2)
    v_mfma_f32_4x4x4_16b_bf16 v[80:83], v[10:11], v[70:71], v[80:83]
    v_mfma_f32_4x4x4_16b_bf16 v[76:79], v[10:11], v[68:69], v[76:79]
    v_perm_b32 v15, v23, v26, s45
    v_bitop3_b32 v46, v23, 0.5, -0.5 bitop3:0xa8
    v_perm_b32 v14, v22, v26, s44
    v_bitop3_b32 v47, v22, 0.5, -0.5 bitop3:0xa8
    v_cvt_pk_bf16_f32 v80, v80, v81
    v_cvt_pk_bf16_f32 v81, v82, v83
    ds_wrxchg_rtn_b64 v[74:75], v95, v[80:81]
    v_cvt_pk_bf16_f32 v76, v76, v77
    v_cvt_pk_bf16_f32 v77, v78, v79
    ds_wrxchg_rtn_b64 v[72:73], v94, v[76:77]
    s_waitcnt lgkmcnt(2)
    v_mfma_f32_4x4x4_16b_bf16 v[80:83], v[8:9], v[102:103], 0
    v_mfma_f32_4x4x4_16b_bf16 v[76:79], v[8:9], v[100:101], 0
    v_bitop3_b32 v15, v6, v15, v46 bitop3:0xca
    v_bitop3_b32 v14, v6, v14, v47 bitop3:0xca
    v_cmp_lt_u32 s[84:85], v5, v92
    s_nop 0
    v_pk_mul_f32 v[80:81], v[80:81], v[14:15] op_sel:[0,1] op_sel_hi:[1,1]
    v_pk_mul_f32 v[82:83], v[82:83], v[14:15] op_sel:[0,1] op_sel_hi:[1,1]
    v_pk_mul_f32 v[76:77], v[76:77], v[14:15] op_sel:[0,0] op_sel_hi:[1,0]
    v_pk_mul_f32 v[78:79], v[78:79], v[14:15] op_sel:[0,0] op_sel_hi:[1,0]
    v_sub_u16 v88, v62, v54
    v_and_b32 v89, 3, v54
    v_add3_u32 v99, v88, v89, 3
    v_and_b32 v99, -4, v99
    v_max_u32 v99, 4, v99
    v_and_b32 v97, 0xfffc, v54
    v_bfm_b32 v96, v88, v89
    v_add_u32_dpp v91, v99, v99 row_shr:1 row_mask:0xf bank_mask:0xf bound_ctrl:1
    v_mad_u32_u24 v97, v97, 5, v2
    v_cmp_lt_u32 vcc, 16, v99
    v_add_u32_dpp v91, v91, v91 row_shr:2 row_mask:0xf bank_mask:0xf bound_ctrl:1
    v_sub_u32 v98, s38, v99
    v_lshrrev_b64 v[54:55], 16, v[54:55]
    v_add_u32_dpp v91, v91, v91 row_shr:4 row_mask:0xf bank_mask:0xf bound_ctrl:1
    v_lshrrev_b64 v[62:63], 16, v[62:63]
    s_mov_b32 s43, 0
    v_add_u32_dpp v91, v91, v91 row_shr:8 row_mask:0xf bank_mask:0xf bound_ctrl:1
    s_nop 1
    v_add_u32_dpp v91, v91, v91 row_bcast:15 row_mask:0xa bank_mask:0xf
    s_nop 1
    v_add_u32_dpp v91, v91, v91 row_bcast:31 row_mask:0xc bank_mask:0xf
    v_add_u32 v98, v98, v91
    v_readlane_b32 s37, v91, 63
    s_cbranch_vccnz L2_xo29
L2_xp29:
    buffer_load_dwordx4 v[112:115], v3, s[16:19], s40 offen offset:1024
    s_waitcnt lgkmcnt(0)
    v_cmpx_ne_u64 vcc, v[74:75], v[70:71]
    s_and_b64 s[82:83], vcc, s[80:81]
    s_cbranch_scc1 L2_c30
L2_d30:
    v_mov_b64 v[84:85], v[70:71]
    v_mov_b32 v7, v95
    v_mov_b64 v[86:87], v[74:75]
    s_mov_b64 exec, -1
    s_or_b64 s[80:81], s[80:81], vcc
    v_cmpx_ne_u64 vcc, v[72:73], v[68:69]
    s_and_b64 s[82:83], vcc, s[80:81]
    s_cbranch_scc1 L2_c31
L2_d31:
    v_mov_b64 v[84:85], v[68:69]
    v_mov_b32 v7, v94
    v_mov_b64 v[86:87], v[72:73]
    s_mov_b64 exec, -1
    s_or_b64 s[80:81], s[80:81], vcc
    ds_read_b64 v[70:71], v93
    s_and_b64 exec, s[84:85], s[80:81]
    v_mfma_f32_4x4x4_16b_bf16 v[76:79], v[12:13], v[84:85], 0
    v_mov_b32 v92, v7
    s_andn2_b64 s[80:81], s[80:81], s[84:85]
    v_mfma_f32_4x4x4_16b_bf16 v[76:79], v[10:11], v[86:87], v[76:79]
    s_mov_b64 exec, -1
    ds_read_b64 v[68:69], v92
    v_and_b32 v46, 0x80000000, v27
    v_lshrrev_b32 v47, 14, v25
    v_bitop3_b32 v47, v47, v5, v46 bitop3:0xea
    ds_read_b64 v[106:107], v47 offset:63616
    v_bitop3_b32 v95, v25, v5, v46 bitop3:0xea
    v_and_b32 v46, 0x40000000, v27
    v_lshrrev_b32 v47, 14, v24
    v_bitop3_b32 v47, v47, v5, v46 bitop3:0xea
    ds_read_b64 v[104:105], v47 offset:63616
    v_bitop3_b32 v94, v24, v5, v46 bitop3:0xea
    s_waitcnt lgkmcnt(2)
    v_mfma_f32_4x4x4_16b_bf16 v[80:83], v[10:11], v[70:71], v[80:83]
    v_mfma_f32_4x4x4_16b_bf16 v[76:79], v[10:11], v[68:69], v[76:79]
    v_perm_b32 v15, v25, v26, s47
    v_bitop3_b32 v46, v25, 0.5, -0.5 bitop3:0xa8
    v_perm_b32 v14, v24, v26, s46
    v_bitop3_b32 v47, v24, 0.5, -0.5 bitop3:0xa8
    v_cvt_pk_bf16_f32 v80, v80, v81
    v_cvt_pk_bf16_f32 v81, v82, v83
    ds_wrxchg_rtn_b64 v[74:75], v93, v[80:81]
    v_cvt_pk_bf16_f32 v76, v76, v77
    v_cvt_pk_bf16_f32 v77, v78, v79
    ds_wrxchg_rtn_b64 v[72:73], v92, v[76:77]
    s_setprio 1
    s_waitcnt lgkmcnt(2)
    v_mfma_f32_4x4x4_16b_bf16 v[80:83], v[8:9], v[106:107], 0
    v_mfma_f32_4x4x4_16b_bf16 v[76:79], v[8:9], v[104:105], 0
    v_bitop3_b32 v15, v6, v15, v46 bitop3:0xca
    v_bitop3_b32 v14, v6, v14, v47 bitop3:0xca
    s_nop 1
    v_pk_mul_f32 v[80:81], v[80:81], v[14:15] op_sel:[0,1] op_sel_hi:[1,1]
    v_pk_mul_f32 v[82:83], v[82:83], v[14:15] op_sel:[0,1] op_sel_hi:[1,1]
    v_pk_mul_f32 v[76:77], v[76:77], v[14:15] op_sel:[0,0] op_sel_hi:[1,0]
    v_pk_mul_f32 v[78:79], v[78:79], v[14:15] op_sel:[0,0] op_sel_hi:[1,0]
    v_and_b32 v47, 0x0fffffff, v41
    v_mov_b32 v27, v41
    buffer_load_dwordx4 v[22:25], v47, s[8:11], 0 offen
    buffer_load_dwordx3 v[24:26], v47, s[8:11], 0 offen offset:8
    s_waitcnt lgkmcnt(0)
    v_cmpx_ne_u64 vcc, v[74:75], v[70:71]
    s_and_b64 s[82:83], vcc, s[80:81]
    s_cbranch_scc1 L2_c32
L2_d32:
    v_mov_b64 v[84:85], v[70:71]
    v_mov_b32 v7, v93
    v_mov_b64 v[86:87], v[74:75]
    s_mov_b64 exec, -1
    s_or_b64 s[80:81], s[80:81], vcc
    v_cmpx_ne_u64 vcc, v[72:73], v[68:69]
    s_and_b64 s[82:83], vcc, s[80:81]
    s_cbranch_scc1 L2_c33
L2_d33:
    v_mov_b64 v[84:85], v[68:69]
    v_mov_b32 v7, v92
    v_mov_b64 v[86:87], v[72:73]
    s_mov_b64 exec, -1
    s_or_b64 s[80:81], s[80:81], vcc
    ds_read_b64 v[70:71], v95
    ds_read_b64 v[68:69], v94
    s_waitcnt vmcnt(11)
    v_and_b32 v46, 0x20000000, v33
    v_lshrrev_b32 v47, 14, v29
    v_bitop3_b32 v47, v47, v5, v46 bitop3:0xea
    ds_read_b64 v[102:103], v47 offset:63616
    v_bitop3_b32 v93, v29, v5, v46 bitop3:0xea
    v_and_b32 v46, 0x10000000, v33
    v_lshrrev_b32 v47, 14, v28
    v_bitop3_b32 v47, v47, v5, v46 bitop3:0xea
    ds_read_b64 v[100:101], v47 offset:63616
    v_bitop3_b32 v92, v28, v5, v46 bitop3:0xea
    s_waitcnt lgkmcnt(2)
    v_mfma_f32_4x4x4_16b_bf16 v[80:83], v[10:11], v[70:71], v[80:83]
    v_mfma_f32_4x4x4_16b_bf16 v[76:79], v[10:11], v[68:69], v[76:79]
    v_perm_b32 v15, v29, v32, s45
    v_bitop3_b32 v46, v29, 0.5, -0.5 bitop3:0xa8
    v_perm_b32 v14, v28, v32, s44
    v_bitop3_b32 v47, v28, 0.5, -0.5 bitop3:0xa8
    v_cvt_pk_bf16_f32 v80, v80, v81
    v_cvt_pk_bf16_f32 v81, v82, v83
    ds_wrxchg_rtn_b64 v[74:75], v95, v[80:81]
    v_cvt_pk_bf16_f32 v76, v76, v77
    v_cvt_pk_bf16_f32 v77, v78, v79
    ds_wrxchg_rtn_b64 v[72:73], v94, v[76:77]
    s_waitcnt lgkmcnt(2)
    v_mfma_f32_4x4x4_16b_bf16 v[80:83], v[8:9], v[102:103], 0
    v_mfma_f32_4x4x4_16b_bf16 v[76:79], v[8:9], v[100:101], 0
    v_bitop3_b32 v15, v6, v15, v46 bitop3:0xca
    v_bitop3_b32 v14, v6, v14, v47 bitop3:0xca
    v_cmp_lt_u32 s[84:85], v5, v92
    s_nop 0
    v_pk_mul_f32 v[80:81], v[80:81], v[14:15] op_sel:[0,1] op_sel_hi:[1,1]
    v_pk_mul_f32 v[82:83], v[82:83], v[14:15] op_sel:[0,1] op_sel_hi:[1,1]
    v_pk_mul_f32 v[76:77], v[76:77], v[14:15] op_sel:[0,0] op_sel_hi:[1,0]
    v_pk_mul_f32 v[78:79], v[78:79], v[14:15] op_sel:[0,0] op_sel_hi:[1,0]
    s_waitcnt lgkmcnt(0)
    v_cmpx_ne_u64 vcc, v[74:75], v[70:71]
    s_and_b64 s[82:83], vcc, s[80:81]
    s_cbranch_scc1 L2_c34
L2_d34:
    v_mov_b64 v[84:85], v[70:71]
    v_mov_b32 v7, v95
    v_mov_b64 v[86:87], v[74:75]
    s_mov_b64 exec, -1
    s_or_b64 s[80:81], s[80:81], vcc
    v_cmpx_ne_u64 vcc, v[72:73], v[68:69]
    s_and_b64 s[82:83], vcc, s[80:81]
    s_cbranch_scc1 L2_c35
L2_d35:
    v_mov_b64 v[84:85], v[68:69]
    v_mov_b32 v7, v94
    v_mov_b64 v[86:87], v[72:73]
    s_mov_b64 exec, -1
    s_or_b64 s[80:81], s[80:81], vcc
    ds_read_b64 v[70:71], v93
    s_and_b64 exec, s[84:85], s[80:81]
    v_mfma_f32_4x4x4_16b_bf16 v[76:79], v[12:13], v[84:85], 0
    v_mov_b32 v92, v7
    s_andn2_b64 s[80:81], s[80:81], s[84:85]
    v_mfma_f32_4x4x4_16b_bf16 v[76:79], v[10:11], v[86:87], v[76:79]
    s_mov_b64 exec, -1
    ds_read_b64 v[68:69], v92
    v_and_b32 v46, 0x80000000, v33
    v_lshrrev_b32 v47, 14, v31
    v_bitop3_b32 v47, v47, v5, v46 bitop3:0xea
    ds_read_b64 v[106:107], v47 offset:63616
    v_bitop3_b32 v95, v31, v5, v46 bitop3:0xea
    v_and_b32 v46, 0x40000000, v33
    v_lshrrev_b32 v47, 14, v30
    v_bitop3_b32 v47, v47, v5, v46 bitop3:0xea
    ds_read_b64 v[104:105], v47 offset:63616
    v_bitop3_b32 v94, v30, v5, v46 bitop3:0xea
    s_waitcnt lgkmcnt(2)
    v_mfma_f32_4x4x4_16b_bf16 v[80:83], v[10:11], v[70:71], v[80:83]
    v_mfma_f32_4x4x4_16b_bf16 v[76:79], v[10:11], v[68:69], v[76:79]
    v_perm_b32 v15, v31, v32, s47
    v_bitop3_b32 v46, v31, 0.5, -0.5 bitop3:0xa8
    v_perm_b32 v14, v30, v32, s46
    v_bitop3_b32 v47, v30, 0.5, -0.5 bitop3:0xa8
    v_cvt_pk_bf16_f32 v80, v80, v81
    v_cvt_pk_bf16_f32 v81, v82, v83
    ds_wrxchg_rtn_b64 v[74:75], v93, v[80:81]
    v_cvt_pk_bf16_f32 v76, v76, v77
    v_cvt_pk_bf16_f32 v77, v78, v79
    ds_wrxchg_rtn_b64 v[72:73], v92, v[76:77]
    s_setprio 0
    s_waitcnt lgkmcnt(2)
    v_mfma_f32_4x4x4_16b_bf16 v[80:83], v[8:9], v[106:107], 0
    v_mfma_f32_4x4x4_16b_bf16 v[76:79], v[8:9], v[104:105], 0
    v_bitop3_b32 v15, v6, v15, v46 bitop3:0xca
    v_bitop3_b32 v14, v6, v14, v47 bitop3:0xca
    s_nop 1
    v_pk_mul_f32 v[80:81], v[80:81], v[14:15] op_sel:[0,1] op_sel_hi:[1,1]
    v_pk_mul_f32 v[82:83], v[82:83], v[14:15] op_sel:[0,1] op_sel_hi:[1,1]
    v_pk_mul_f32 v[76:77], v[76:77], v[14:15] op_sel:[0,0] op_sel_hi:[1,0]
    v_pk_mul_f32 v[78:79], v[78:79], v[14:15] op_sel:[0,0] op_sel_hi:[1,0]
    s_add_u32 s40, s40, 0x4e200
    v_and_b32 v47, 0x0fffffff, v42
    v_mov_b32 v33, v42
    buffer_load_dwordx4 v[28:31], v47, s[8:11], 0 offen
    buffer_load_dwordx3 v[30:32], v47, s[8:11], 0 offen offset:8
    s_waitcnt lgkmcnt(0)
    v_cmpx_ne_u64 vcc, v[74:75], v[70:71]
    s_and_b64 s[82:83], vcc, s[80:81]
    s_cbranch_scc1 L2_c36
L2_d36:
    v_mov_b64 v[84:85], v[70:71]
    v_mov_b32 v7, v93
    v_mov_b64 v[86:87], v[74:75]
    s_mov_b64 exec, -1
    s_or_b64 s[80:81], s[80:81], vcc
    v_cmpx_ne_u64 vcc, v[72:73], v[68:69]
    s_and_b64 s[82:83], vcc, s[80:81]
    s_cbranch_scc1 L2_c37
L2_d37:
    v_mov_b64 v[84:85], v[68:69]
    v_mov_b32 v7, v92
    v_mov_b64 v[86:87], v[72:73]
    s_mov_b64 exec, -1
    s_or_b64 s[80:81], s[80:81], vcc
    ds_read_b64 v[70:71], v95
    ds_read_b64 v[68:69], v94
    s_waitcnt vmcnt(8)
    v_and_b32 v46, 0x20000000, v39
    v_lshrrev_b32 v47, 14, v35
    v_bitop3_b32 v47, v47, v5, v46 bitop3:0xea
    ds_read_b64 v[102:103], v47 offset:63616
    v_bitop3_b32 v93, v35, v5, v46 bitop3:0xea
    v_and_b32 v46, 0x10000000, v39
    v_lshrrev_b32 v47, 14, v34
    v_bitop3_b32 v47, v47, v5, v46 bitop3:0xea
    ds_read_b64 v[100:101], v47 offset:63616
    v_bitop3_b32 v92, v34, v5, v46 bitop3:0xea
    v_and_b32 v46, 0x80000000, v39
    v_lshrrev_b32 v47, 14, v37
    v_bitop3_b32 v47, v47, v5, v46 bitop3:0xea
    ds_read_b64 v[106:107], v47 offset:63616
    v_and_b32 v46, 0x40000000, v39
    v_lshrrev_b32 v47, 14, v36
    v_bitop3_b32 v47, v47, v5, v46 bitop3:0xea
    ds_read_b64 v[104:105], v47 offset:63616
    s_waitcnt lgkmcnt(4)
    v_mfma_f32_4x4x4_16b_bf16 v[80:83], v[10:11], v[70:71], v[80:83]
    v_mfma_f32_4x4x4_16b_bf16 v[76:79], v[10:11], v[68:69], v[76:79]
    v_perm_b32 v15, v35, v38, s45
    v_bitop3_b32 v46, v35, 0.5, -0.5 bitop3:0xa8
    v_perm_b32 v14, v34, v38, s44
    v_bitop3_b32 v47, v34, 0.5, -0.5 bitop3:0xa8
    v_cvt_pk_bf16_f32 v80, v80, v81
    v_cvt_pk_bf16_f32 v81, v82, v83
    ds_wrxchg_rtn_b64 v[74:75], v95, v[80:81]
    v_cvt_pk_bf16_f32 v76, v76, v77
    v_cvt_pk_bf16_f32 v77, v78, v79
    ds_wrxchg_rtn_b64 v[72:73], v94, v[76:77]
    s_waitcnt lgkmcnt(2)
    s_barrier
    s_setprio 3
    ds_write_b128 v3, v[124:127] offset:4096
    s_add_u32 s3, s40, 4096
    buffer_load_dwordx4 v[124:127], v3, s[16:19], s3 offen
    ds_write_b128 v3, v[116:119] offset:2048
    buffer_load_dwordx4 v[116:119], v3, s[16:19], s40 offen offset:2048
    ds_write_b128 v3, v[120:123] offset:3072
    buffer_load_dwordx4 v[120:123], v3, s[16:19], s40 offen offset:3072
    v_mfma_f32_4x4x4_16b_bf16 v[80:83], v[8:9], v[102:103], 0
    v_mfma_f32_4x4x4_16b_bf16 v[76:79], v[8:9], v[100:101], 0
    v_bitop3_b32 v15, v6, v15, v46 bitop3:0xca
    v_bitop3_b32 v14, v6, v14, v47 bitop3:0xca
    v_cmp_lt_u32 s[84:85], v5, v92
    s_nop 0
    v_pk_mul_f32 v[80:81], v[80:81], v[14:15] op_sel:[0,1] op_sel_hi:[1,1]
    v_pk_mul_f32 v[82:83], v[82:83], v[14:15] op_sel:[0,1] op_sel_hi:[1,1]
    v_pk_mul_f32 v[76:77], v[76:77], v[14:15] op_sel:[0,0] op_sel_hi:[1,0]
    v_pk_mul_f32 v[78:79], v[78:79], v[14:15] op_sel:[0,0] op_sel_hi:[1,0]
    v_mov_b32 v44, v43
    s_cmp_gt_u32 s37, 1024
    s_cbranch_scc1 L2_xs38
    s_cmp_lg_u32 s43, 0
    s_cbranch_scc1 L2_xa38
L2_xb38:
    v_lshlrev_b32 v89, 16, v96
    v_add_u32 v90, 60, v97
    v_bitop3_b32 v90, v89, v45, v90 bitop3:0x6a
    ds_write_b32 v98, v90 offset:12
    v_lshlrev_b32 v89, 20, v96
    v_add_u32 v90, 40, v97
    v_bitop3_b32 v90, v89, v45, v90 bitop3:0x6a
    ds_write_b32 v98, v90 offset:8
    v_lshlrev_b32 v89, 24, v96
    v_add_u32 v90, 20, v97
    v_bitop3_b32 v90, v89, v45, v90 bitop3:0x6a
    ds_write_b32 v98, v90 offset:4
    v_lshlrev_b32 v89, 28, v96
    v_bitop3_b32 v90, v89, v45, v97 bitop3:0x6a
    ds_write_b32 v98, v90 offset:0
    v_mov_b32_dpp v91, v66 quad_perm:[1,1,1,1] row_mask:0xf bank_mask:0xf
    v_and_b32 v89, 3, v91
    v_and_b32 v97, 0xfffc, v91
    v_sub_u16_dpp v88, v66, v91 quad_perm:[3,3,3,3] row_mask:0xf bank_mask:0xf
    v_mad_u32_u24 v97, v97, 5, v4
    v_add_u32 v99, v88, v89
    v_bfm_b32 v96, v88, v89
    v_cmp_lt_u32 s[58:59], 16, v99
    v_lshlrev_b32 v89, v1, v96
    v_and_b32 v89, v45, v89
    v_cmp_ne_u32 vcc, 0, v89
    v_xor_b32 v90, v97, v89
    s_add_u32 s3, s37, s38
    v_mbcnt_lo_u32_b32 v98, vcc_lo, 0
    v_mbcnt_hi_u32_b32 v98, vcc_hi, v98
    s_bcnt1_i32_b64 s41, vcc
    v_lshl_add_u32 v98, v98, 2, s3
    s_mov_b64 exec, vcc
    ds_write_b32 v98, v90
    s_mov_b64 exec, -1
    s_lshl2_add_u32 s37, s41, s37
    s_cmp_lg_u64 s[58:59], 0
    s_cbranch_scc1 L2_xe38
L2_xr38:
    v_add_u32 v98, s37, v0
    v_mov_b32 v90, -1
    ds_write_b32 v98, v90
    ds_read2st64_b32 v[40:41], v0 offset0:0 offset1:1
    ds_read2st64_b32 v[42:43], v0 offset0:2 offset1:3
    s_sub_u32 s3, s37, 768
    s_cmp_gt_u32 s3, 256
    s_cbranch_scc1 L2_xf38
L2_xg38:
    v_lshrrev_b64 v[64:65], 16, v[64:65]
    v_lshrrev_b64 v[66:67], 16, v[66:67]
    s_setprio 2
    s_waitcnt vmcnt(10)
    ds_write_b128 v3, v[108:111] offset:0
    s_waitcnt lgkmcnt(12)
    v_cmpx_ne_u64 vcc, v[74:75], v[70:71]
    s_and_b64 s[82:83], vcc, s[80:81]
    s_cbranch_scc1 L2_c39
L2_d39:
    v_mov_b64 v[84:85], v[70:71]
    v_mov_b32 v7, v95
    v_mov_b64 v[86:87], v[74:75]
    s_mov_b64 exec, -1
    s_or_b64 s[80:81], s[80:81], vcc
    v_cmpx_ne_u64 vcc, v[72:73], v[68:69]
    s_and_b64 s[82:83], vcc, s[80:81]
    s_cbranch_scc1 L2_c40
L2_d40:
    v_mov_b64 v[84:85], v[68:69]
    v_mov_b32 v7, v94
    v_mov_b64 v[86:87], v[72:73]
    s_mov_b64 exec, -1
    s_or_b64 s[80:81], s[80:81], vcc
    ds_read_b64 v[70:71], v93
    s_and_b64 exec, s[84:85], s[80:81]
    v_mfma_f32_4x4x4_16b_bf16 v[76:79], v[12:13], v[84:85], 0
    v_mov_b32 v92, v7
    s_andn2_b64 s[80:81], s[80:81], s[84:85]
    v_mfma_f32_4x4x4_16b_bf16 v[76:79], v[10:11], v[86:87], v[76:79]
    s_mov_b64 exec, -1
    ds_read_b64 v[68:69], v92
    s_setprio 1
    s_waitcnt vmcnt(7)
    ds_write_b128 v3, v[112:115] offset:1024
    s_waitcnt lgkmcnt(1)
    v_mfma_f32_4x4x4_16b_bf16 v[80:83], v[10:11], v[70:71], v[80:83]
    v_mfma_f32_4x4x4_16b_bf16 v[76:79], v[10:11], v[68:69], v[76:79]
    v_and_b32 v46, 0x40000000, v39
    v_bitop3_b32 v94, v36, v5, v46 bitop3:0xea
    v_and_b32 v46, 0x80000000, v39
    v_bitop3_b32 v95, v37, v5, v46 bitop3:0xea
    v_perm_b32 v15, v37, v38, s47
    v_bitop3_b32 v46, v37, 0.5, -0.5 bitop3:0xa8
    v_perm_b32 v14, v36, v38, s46
    v_bitop3_b32 v47, v36, 0.5, -0.5 bitop3:0xa8
    v_cvt_pk_bf16_f32 v80, v80, v81
    v_cvt_pk_bf16_f32 v81, v82, v83
    ds_wrxchg_rtn_b64 v[74:75], v93, v[80:81]
    v_cvt_pk_bf16_f32 v76, v76, v77
    v_cvt_pk_bf16_f32 v77, v78, v79
    ds_wrxchg_rtn_b64 v[72:73], v92, v[76:77]
    s_setprio 0
    v_mfma_f32_4x4x4_16b_bf16 v[80:83], v[8:9], v[106:107], 0
    v_mfma_f32_4x4x4_16b_bf16 v[76:79], v[8:9], v[104:105], 0
    v_bitop3_b32 v15, v6, v15, v46 bitop3:0xca
    v_bitop3_b32 v14, v6, v14, v47 bitop3:0xca
    s_nop 1
    v_pk_mul_f32 v[80:81], v[80:81], v[14:15] op_sel:[0,1] op_sel_hi:[1,1]
    v_pk_mul_f32 v[82:83], v[82:83], v[14:15] op_sel:[0,1] op_sel_hi:[1,1]
    v_pk_mul_f32 v[76:77], v[76:77], v[14:15] op_sel:[0,0] op_sel_hi:[1,0]
    v_pk_mul_f32 v[78:79], v[78:79], v[14:15] op_sel:[0,0] op_sel_hi:[1,0]
    s_add_u32 s42, s42, 1
    s_waitcnt lgkmcnt(2)
    s_barrier
    s_bitcmp1_b32 s36, s42
    s_cbranch_scc1 L2_slow
L2_ret2:
    s_setprio 3
    v_and_b32 v47, 0x0fffffff, v44
    v_mov_b32 v39, v44
    buffer_load_dwordx4 v[34:37], v47, s[8:11], 0 offen
    buffer_load_dwordx3 v[36:38], v47, s[8:11], 0 offen offset:8
    s_waitcnt lgkmcnt(0)
    v_cmpx_ne_u64 vcc, v[74:75], v[70:71]
    s_and_b64 s[82:83], vcc, s[80:81]
    s_cbranch_scc1 L2_c41
L2_d41:
    v_mov_b64 v[84:85], v[70:71]
    v_mov_b32 v7, v93
    v_mov_b64 v[86:87], v[74:75]
    s_mov_b64 exec, -1
    s_or_b64 s[80:81], s[80:81], vcc
    v_cmpx_ne_u64 vcc, v[72:73], v[68:69]
    s_and_b64 s[82:83], vcc, s[80:81]
    s_cbranch_scc1 L2_c42
L2_d42:
    v_mov_b64 v[84:85], v[68:69]
    v_mov_b32 v7, v92
    v_mov_b64 v[86:87], v[72:73]
    s_mov_b64 exec, -1
    s_or_b64 s[80:81], s[80:81], vcc
    ds_read_b64 v[70:71], v95
    ds_read_b64 v[68:69], v94
    v_and_b32 v46, 0x20000000, v21
    v_lshrrev_b32 v47, 14, v17
    v_bitop3_b32 v47, v47, v5, v46 bitop3:0xea
    ds_read_b64 v[102:103], v47 offset:63616
    v_bitop3_b32 v93, v17, v5, v46 bitop3:0xea
    v_and_b32 v46, 0x10000000, v21
    v_lshrrev_b32 v47, 14, v16
    v_bitop3_b32 v47, v47, v5, v46 bitop3:0xea
    ds_read_b64 v[100:101], v47 offset:63616
    v_bitop3_b32 v92, v16, v5, v46 bitop3:0xea
    s_waitcnt lgkmcnt(2)
    v_mfma_f32_4x4x4_16b_bf16 v[80:83], v[10:11], v[70:71], v[80:83]
    v_mfma_f32_4x4x4_16b_bf16 v[76:79], v[10:11], v[68:69], v[76:79]
    v_perm_b32 v15, v17, v20, s45
    v_bitop3_b32 v46, v17, 0.5, -0.5 bitop3:0xa8
    v_perm_b32 v14, v16, v20, s44
    v_bitop3_b32 v47, v16, 0.5, -0.5 bitop3:0xa8
    v_cvt_pk_bf16_f32 v80, v80, v81
    v_cvt_pk_bf16_f32 v81, v82, v83
    ds_wrxchg_rtn_b64 v[74:75], v95, v[80:81]
    v_cvt_pk_bf16_f32 v76, v76, v77
    v_cvt_pk_bf16_f32 v77, v78, v79
    ds_wrxchg_rtn_b64 v[72:73], v94, v[76:77]
    s_waitcnt lgkmcnt(2)
    v_mfma_f32_4x4x4_16b_bf16 v[80:83], v[8:9], v[102:103], 0
    v_mfma_f32_4x4x4_16b_bf16 v[76:79], v[8:9], v[100:101], 0
    v_bitop3_b32 v15, v6, v15, v46 bitop3:0xca
    v_bitop3_b32 v14, v6, v14, v47 bitop3:0xca
    v_cmp_lt_u32 s[84:85], v5, v92
    s_nop 0
    v_pk_mul_f32 v[80:81], v[80:81], v[14:15] op_sel:[0,1] op_sel_hi:[1,1]
    v_pk_mul_f32 v[82:83], v[82:83], v[14:15] op_sel:[0,1] op_sel_hi:[1,1]
    v_pk_mul_f32 v[76:77], v[76:77], v[14:15] op_sel:[0,0] op_sel_hi:[1,0]
    v_pk_mul_f32 v[78:79], v[78:79], v[14:15] op_sel:[0,0] op_sel_hi:[1,0]
    buffer_load_dwordx4 v[108:111], v3, s[16:19], s40 offen offset:0
    s_waitcnt lgkmcnt(0)
    v_cmpx_ne_u64 vcc, v[74:75], v[70:71]
    s_and_b64 s[82:83], vcc, s[80:81]
    s_cbranch_scc1 L2_c43
L2_d43:
    v_mov_b64 v[84:85], v[70:71]
    v_mov_b32 v7, v95
    v_mov_b64 v[86:87], v[74:75]
    s_mov_b64 exec, -1
    s_or_b64 s[80:81], s[80:81], vcc
    v_cmpx_ne_u64 vcc, v[72:73], v[68:69]
    s_and_b64 s[82:83], vcc, s[80:81]
    s_cbranch_scc1 L2_c44
L2_d44:
    v_mov_b64 v[84:85], v[68:69]
    v_mov_b32 v7, v94
    v_mov_b64 v[86:87], v[72:73]
    s_mov_b64 exec, -1
    s_or_b64 s[80:81], s[80:81], vcc
    ds_read_b64 v[70:71], v93
    s_and_b64 exec, s[84:85], s[80:81]
    v_mfma_f32_4x4x4_16b_bf16 v[76:79], v[12:13], v[84:85], 0
    v_mov_b32 v92, v7
    s_andn2_b64 s[80:81], s[80:81], s[84:85]
    v_mfma_f32_4x4x4_16b_bf16 v[76:79], v[10:11], v[86:87], v[76:79]
    s_mov_b64 exec, -1
    ds_read_b64 v[68:69], v92
    v_and_b32 v46, 0x80000000, v21
    v_lshrrev_b32 v47, 14, v19
    v_bitop3_b32 v47, v47, v5, v46 bitop3:0xea
    ds_read_b64 v[106:107], v47 offset:63616
    v_bitop3_b32 v95, v19, v5, v46 bitop3:0xea
    v_and_b32 v46, 0x40000000, v21
    v_lshrrev_b32 v47, 14, v18
    v_bitop3_b32 v47, v47, v5, v46 bitop3:0xea
    ds_read_b64 v[104:105], v47 offset:63616
    v_bitop3_b32 v94, v18, v5, v46 bitop3:0xea
    s_waitcnt lgkmcnt(2)
    v_mfma_f32_4x4x4_16b_bf16 v[80:83], v[10:11], v[70:71], v[80:83]
    v_mfma_f32_4x4x4_16b_bf16 v[76:79], v[10:11], v[68:69], v[76:79]
    v_perm_b32 v15, v19, v20, s47
    v_bitop3_b32 v46, v19, 0.5, -0.5 bitop3:0xa8
    v_perm_b32 v14, v18, v20, s46
    v_bitop3_b32 v47, v18, 0.5, -0.5 bitop3:0xa8
    v_cvt_pk_bf16_f32 v80, v80, v81
    v_cvt_pk_bf16_f32 v81, v82, v83
    ds_wrxchg_rtn_b64 v[74:75], v93, v[80:81]
    v_cvt_pk_bf16_f32 v76, v76, v77
    v_cvt_pk_bf16_f32 v77, v78, v79
    ds_wrxchg_rtn_b64 v[72:73], v92, v[76:77]
    s_setprio 2
    s_waitcnt lgkmcnt(2)
    v_mfma_f32_4x4x4_16b_bf16 v[80:83], v[8:9], v[106:107], 0
    v_mfma_f32_4x4x4_16b_bf16 v[76:79], v[8:9], v[104:105], 0
    v_bitop3_b32 v15, v6, v15, v46 bitop3:0xca
    v_bitop3_b32 v14, v6, v14, v47 bitop3:0xca
    s_nop 1
    v_pk_mul_f32 v[80:81], v[80:81], v[14:15] op_sel:[0,1] op_sel_hi:[1,1]
    v_pk_mul_f32 v[82:83], v[82:83], v[14:15] op_sel:[0,1] op_sel_hi:[1,1]
    v_pk_mul_f32 v[76:77], v[76:77], v[14:15] op_sel:[0,0] op_sel_hi:[1,0]
    v_pk_mul_f32 v[78:79], v[78:79], v[14:15] op_sel:[0,0] op_sel_hi:[1,0]
    v_and_b32 v47, 0x0fffffff, v40
    v_mov_b32 v21, v40
    buffer_load_dwordx4 v[16:19], v47, s[8:11], 0 offen
    buffer_load_dwordx3 v[18:20], v47, s[8:11], 0 offen offset:8
    s_waitcnt lgkmcnt(0)
    v_cmpx_ne_u64 vcc, v[74:75], v[70:71]
    s_and_b64 s[82:83], vcc, s[80:81]
    s_cbranch_scc1 L2_c45
L2_d45:
    v_mov_b64 v[84:85], v[70:71]
    v_mov_b32 v7, v93
    v_mov_b64 v[86:87], v[74:75]
    s_mov_b64 exec, -1
    s_or_b64 s[80:81], s[80:81], vcc
    v_cmpx_ne_u64 vcc, v[72:73], v[68:69]
    s_and_b64 s[82:83], vcc, s[80:81]
    s_cbranch_scc1 L2_c46
L2_d46:
    v_mov_b64 v[84:85], v[68:69]
    v_mov_b32 v7, v92
    v_mov_b64 v[86:87], v[72:73]
    s_mov_b64 exec, -1
    s_or_b64 s[80:81], s[80:81], vcc
    ds_read_b64 v[70:71], v95
    ds_read_b64 v[68:69], v94
    s_waitcnt vmcnt(10)
    v_and_b32 v46, 0x20000000, v27
    v_lshrrev_b32 v47, 14, v23
    v_bitop3_b32 v47, v47, v5, v46 bitop3:0xea
    ds_read_b64 v[102:103], v47 offset:63616
    v_bitop3_b32 v93, v23, v5, v46 bitop3:0xea
    v_and_b32 v46, 0x10000000, v27
    v_lshrrev_b32 v47, 14, v22
    v_bitop3_b32 v47, v47, v5, v46 bitop3:0xea
    ds_read_b64 v[100:101], v47 offset:63616
    v_bitop3_b32 v92, v22, v5, v46 bitop3:0xea
    s_waitcnt lgkmcnt(2)
    v_mfma_f32_4x4x4_16b_bf16 v[80:83], v[10:11], v[70:71], v[80:83]
    v_mfma_f32_4x4x4_16b_bf16 v[76:79], v[10:11], v[68:69], v[76:79]
    v_perm_b32 v15, v23, v26, s45
    v_bitop3_b32 v46, v23, 0.5, -0.5 bitop3:0xa8
    v_perm_b32 v14, v22, v26, s44
    v_bitop3_b32 v47, v22, 0.5, -0.5 bitop3:0xa8
    v_cvt_pk_bf16_f32 v80, v80, v81
    v_cvt_pk_bf16_f32 v81, v82, v83
    ds_wrxchg_rtn_b64 v[74:75], v95, v[80:81]
    v_cvt_pk_bf16_f32 v76, v76, v77
    v_cvt_pk_bf16_f32 v77, v78, v79
    ds_wrxchg_rtn_b64 v[72:73], v94, v[76:77]
    s_waitcnt lgkmcnt(2)
    v_mfma_f32_4x4x4_16b_bf16 v[80:83], v[8:9], v[102:103], 0
    v_mfma_f32_4x4x4_16b_bf16 v[76:79], v[8:9], v[100:101], 0
    v_bitop3_b32 v15, v6, v15, v46 bitop3:0xca
    v_bitop3_b32 v14, v6, v14, v47 bitop3:0xca
    v_cmp_lt_u32 s[84:85], v5, v92
    s_nop 0
    v_pk_mul_f32 v[80:81], v[80:81], v[14:15] op_sel:[0,1] op_sel_hi:[1,1]
    v_pk_mul_f32 v[82:83], v[82:83], v[14:15] op_sel:[0,1] op_sel_hi:[1,1]
    v_pk_mul_f32 v[76:77], v[76:77], v[14:15] op_sel:[0,0] op_sel_hi:[1,0]
    v_pk_mul_f32 v[78:79], v[78:79], v[14:15] op_sel:[0,0] op_sel_hi:[1,0]
    v_sub_u16 v88, v56, v48
    v_and_b32 v89, 3, v48
    v_add3_u32 v99, v88, v89, 3
    v_and_b32 v99, -4, v99
    v_max_u32 v99, 4, v99
    v_and_b32 v97, 0xfffc, v48
    v_bfm_b32 v96, v88, v89
    v_add_u32_dpp v91, v99, v99 row_shr:1 row_mask:0xf bank_mask:0xf bound_ctrl:1
    v_mad_u32_u24 v97, v97, 5, v2
    v_cmp_lt_u32 vcc, 16, v99
    v_add_u32_dpp v91, v91, v91 row_shr:2 row_mask:0xf bank_mask:0xf bound_ctrl:1
    v_sub_u32 v98, s38, v99
    v_lshrrev_b64 v[48:49], 16, v[48:49]
    v_add_u32_dpp v91, v91, v91 row_shr:4 row_mask:0xf bank_mask:0xf bound_ctrl:1
    v_lshrrev_b64 v[56:57], 16, v[56:57]
    s_mov_b32 s43, 0
    v_add_u32_dpp v91, v91, v91 row_shr:8 row_mask:0xf bank_mask:0xf bound_ctrl:1
    s_nop 1
    v_add_u32_dpp v91, v91, v91 row_bcast:15 row_mask:0xa bank_mask:0xf
    s_nop 1
    v_add_u32_dpp v91, v91, v91 row_bcast:31 row_mask:0xc bank_mask:0xf
    v_add_u32 v98, v98, v91
    v_readlane_b32 s37, v91, 63
    s_cbranch_vccnz L2_xo47
L2_xp47:
    buffer_load_dwordx4 v[112:115], v3, s[16:19], s40 offen offset:1024
    s_waitcnt lgkmcnt(0)
    v_cmpx_ne_u64 vcc, v[74:75], v[70:71]
    s_and_b64 s[82:83], vcc, s[80:81]
    s_cbranch_scc1 L2_c48
L2_d48:
    v_mov_b64 v[84:85], v[70:71]
    v_mov_b32 v7, v95
    v_mov_b64 v[86:87], v[74:75]
    s_mov_b64 exec, -1
    s_or_b64 s[80:81], s[80:81], vcc
    v_cmpx_ne_u64 vcc, v[72:73], v[68:69]
    s_and_b64 s[82:83], vcc, s[80:81]
    s_cbranch_scc1 L2_c49
L2_d49:
    v_mov_b64 v[84:85], v[68:69]
    v_mov_b32 v7, v94
    v_mov_b64 v[86:87], v[72:73]
    s_mov_b64 exec, -1
    s_or_b64 s[80:81], s[80:81], vcc
    ds_read_b64 v[70:71], v93
    s_and_b64 exec, s[84:85], s[80:81]
    v_mfma_f32_4x4x4_16b_bf16 v[76:79], v[12:13], v[84:85], 0
    v_mov_b32 v92, v7
    s_andn2_b64 s[80:81], s[80:81], s[84:85]
    v_mfma_f32_4x4x4_16b_bf16 v[76:79], v[10:11], v[86:87], v[76:79]
    s_mov_b64 exec, -1
    ds_read_b64 v[68:69], v92
    v_and_b32 v46, 0x80000000, v27
    v_lshrrev_b32 v47, 14, v25
    v_bitop3_b32 v47, v47, v5, v46 bitop3:0xea
    ds_read_b64 v[106:107], v47 offset:63616
    v_bitop3_b32 v95, v25, v5, v46 bitop3:0xea
    v_and_b32 v46, 0x40000000, v27
    v_lshrrev_b32 v47, 14, v24
    v_bitop3_b32 v47, v47, v5, v46 bitop3:0xea
    ds_read_b64 v[104:105], v47 offset:63616
    v_bitop3_b32 v94, v24, v5, v46 bitop3:0xea
    s_waitcnt lgkmcnt(2)
    v_mfma_f32_4x4x4_16b_bf16 v[80:83], v[10:11], v[70:71], v[80:83]
    v_mfma_f32_4x4x4_16b_bf16 v[76:79], v[10:11], v[68:69], v[76:79]
    v_perm_b32 v15, v25, v26, s47
    v_bitop3_b32 v46, v25, 0.5, -0.5 bitop3:0xa8
    v_perm_b32 v14, v24, v26, s46
    v_bitop3_b32 v47, v24, 0.5, -0.5 bitop3:0xa8
    v_cvt_pk_bf16_f32 v80, v80, v81
    v_cvt_pk_bf16_f32 v81, v82, v83
    ds_wrxchg_rtn_b64 v[74:75], v93, v[80:81]
    v_cvt_pk_bf16_f32 v76, v76, v77
    v_cvt_pk_bf16_f32 v77, v78, v79
    ds_wrxchg_rtn_b64 v[72:73], v92, v[76:77]
    s_setprio 1
    s_waitcnt lgkmcnt(2)
    v_mfma_f32_4x4x4_16b_bf16 v[80:83], v[8:9], v[106:107], 0
    v_mfma_f32_4x4x4_16b_bf16 v[76:79], v[8:9], v[104:105], 0
    v_bitop3_b32 v15, v6, v15, v46 bitop3:0xca
    v_bitop3_b32 v14, v6, v14, v47 bitop3:0xca
    s_nop 1
    v_pk_mul_f32 v[80:81], v[80:81], v[14:15] op_sel:[0,1] op_sel_hi:[1,1]
    v_pk_mul_f32 v[82:83], v[82:83], v[14:15] op_sel:[0,1] op_sel_hi:[1,1]
    v_pk_mul_f32 v[76:77], v[76:77], v[14:15] op_sel:[0,0] op_sel_hi:[1,0]
    v_pk_mul_f32 v[78:79], v[78:79], v[14:15] op_sel:[0,0] op_sel_hi:[1,0]
    v_and_b32 v47, 0x0fffffff, v41
    v_mov_b32 v27, v41
    buffer_load_dwordx4 v[22:25], v47, s[8:11], 0 offen
    buffer_load_dwordx3 v[24:26], v47, s[8:11], 0 offen offset:8
    s_waitcnt lgkmcnt(0)
    v_cmpx_ne_u64 vcc, v[74:75], v[70:71]
    s_and_b64 s[82:83], vcc, s[80:81]
    s_cbranch_scc1 L2_c50
L2_d50:
    v_mov_b64 v[84:85], v[70:71]
    v_mov_b32 v7, v93
    v_mov_b64 v[86:87], v[74:75]
    s_mov_b64 exec, -1
    s_or_b64 s[80:81], s[80:81], vcc
    v_cmpx_ne_u64 vcc, v[72:73], v[68:69]
    s_and_b64 s[82:83], vcc, s[80:81]
    s_cbranch_scc1 L2_c51
L2_d51:
    v_mov_b64 v[84:85], v[68:69]
    v_mov_b32 v7, v92
    v_mov_b64 v[86:87], v[72:73]
    s_mov_b64 exec, -1
    s_or_b64 s[80:81], s[80:81], vcc
    ds_read_b64 v[70:71], v95
    ds_read_b64 v[68:69], v94
    s_waitcnt vmcnt(11)
    v_and_b32 v46, 0x20000000, v33
    v_lshrrev_b32 v47, 14, v29
    v_bitop3_b32 v47, v47, v5, v46 bitop3:0xea
    ds_read_b64 v[102:103], v47 offset:63616
    v_bitop3_b32 v93, v29, v5, v46 bitop3:0xea
    v_and_b32 v46, 0x10000000, v33
    v_lshrrev_b32 v47, 14, v28
    v_bitop3_b32 v47, v47, v5, v46 bitop3:0xea
    ds_read_b64 v[100:101], v47 offset:63616
    v_bitop3_b32 v92, v28, v5, v46 bitop3:0xea
    s_waitcnt lgkmcnt(2)
    v_mfma_f32_4x4x4_16b_bf16 v[80:83], v[10:11], v[70:71], v[80:83]
    v_mfma_f32_4x4x4_16b_bf16 v[76:79], v[10:11], v[68:69], v[76:79]
    v_perm_b32 v15, v29, v32, s45
    v_bitop3_b32 v46, v29, 0.5, -0.5 bitop3:0xa8
    v_perm_b32 v14, v28, v32, s44
    v_bitop3_b32 v47, v28, 0.5, -0.5 bitop3:0xa8
    v_cvt_pk_bf16_f32 v80, v80, v81
    v_cvt_pk_bf16_f32 v81, v82, v83
    ds_wrxchg_rtn_b64 v[74:75], v95, v[80:81]
    v_cvt_pk_bf16_f32 v76, v76, v77
    v_cvt_pk_bf16_f32 v77, v78, v79
    ds_wrxchg_rtn_b64 v[72:73], v94, v[76:77]
    s_waitcnt lgkmcnt(2)
    v_mfma_f32_4x4x4_16b_bf16 v[80:83], v[8:9], v[102:103], 0
    v_mfma_f32_4x4x4_16b_bf16 v[76:79], v[8:9], v[100:101], 0
    v_bitop3_b32 v15, v6, v15, v46 bitop3:0xca
    v_bitop3_b32 v14, v6, v14, v47 bitop3:0xca
    v_cmp_lt_u32 s[84:85], v5, v92
    s_nop 0
    v_pk_mul_f32 v[80:81], v[80:81], v[14:15] op_sel:[0,1] op_sel_hi:[1,1]
    v_pk_mul_f32 v[82:83], v[82:83], v[14:15] op_sel:[0,1] op_sel_hi:[1,1]
    v_pk_mul_f32 v[76:77], v[76:77], v[14:15] op_sel:[0,0] op_sel_hi:[1,0]
    v_pk_mul_f32 v[78:79], v[78:79], v[14:15] op_sel:[0,0] op_sel_hi:[1,0]
    s_waitcnt lgkmcnt(0)
    v_cmpx_ne_u64 vcc, v[74:75], v[70:71]
    s_and_b64 s[82:83], vcc, s[80:81]
    s_cbranch_scc1 L2_c52
L2_d52:
    v_mov_b64 v[84:85], v[70:71]
    v_mov_b32 v7, v95
    v_mov_b64 v[86:87], v[74:75]
    s_mov_b64 exec, -1
    s_or_b64 s[80:81], s[80:81], vcc
    v_cmpx_ne_u64 vcc, v[72:73], v[68:69]
    s_and_b64 s[82:83], vcc, s[80:81]
    s_cbranch_scc1 L2_c53
L2_d53:
    v_mov_b64 v[84:85], v[68:69]
    v_mov_b32 v7, v94
    v_mov_b64 v[86:87], v[72:73]
    s_mov_b64 exec, -1
    s_or_b64 s[80:81], s[80:81], vcc
    ds_read_b64 v[70:71], v93
    s_and_b64 exec, s[84:85], s[80:81]
    v_mfma_f32_4x4x4_16b_bf16 v[76:79], v[12:13], v[84:85], 0
    v_mov_b32 v92, v7
    s_andn2_b64 s[80:81], s[80:81], s[84:85]
    v_mfma_f32_4x4x4_16b_bf16 v[76:79], v[10:11], v[86:87], v[76:79]
    s_mov_b64 exec, -1
    ds_read_b64 v[68:69], v92
    v_and_b32 v46, 0x80000000, v33
    v_lshrrev_b32 v47, 14, v31
    v_bitop3_b32 v47, v47, v5, v46 bitop3:0xea
    ds_read_b64 v[106:107], v47 offset:63616
    v_bitop3_b32 v95, v31, v5, v46 bitop3:0xea
    v_and_b32 v46, 0x40000000, v33
    v_lshrrev_b32 v47, 14, v30
    v_bitop3_b32 v47, v47, v5, v46 bitop3:0xea
    ds_read_b64 v[104:105], v47 offset:63616
    v_bitop3_b32 v94, v30, v5, v46 bitop3:0xea
    s_waitcnt lgkmcnt(2)
    v_mfma_f32_4x4x4_16b_bf16 v[80:83], v[10:11], v[70:71], v[80:83]
    v_mfma_f32_4x4x4_16b_bf16 v[76:79], v[10:11], v[68:69], v[76:79]
    v_perm_b32 v15, v31, v32, s47
    v_bitop3_b32 v46, v31, 0.5, -0.5 bitop3:0xa8
    v_perm_b32 v14, v30, v32, s46
    v_bitop3_b32 v47, v30, 0.5, -0.5 bitop3:0xa8
    v_cvt_pk_bf16_f32 v80, v80, v81
    v_cvt_pk_bf16_f32 v81, v82, v83
    ds_wrxchg_rtn_b64 v[74:75], v93, v[80:81]
    v_cvt_pk_bf16_f32 v76, v76, v77
    v_cvt_pk_bf16_f32 v77, v78, v79
    ds_wrxchg_rtn_b64 v[72:73], v92, v[76:77]
    s_setprio 0
    s_waitcnt lgkmcnt(2)
    v_mfma_f32_4x4x4_16b_bf16 v[80:83], v[8:9], v[106:107], 0
    v_mfma_f32_4x4x4_16b_bf16 v[76:79], v[8:9], v[104:105], 0
    v_bitop3_b32 v15, v6, v15, v46 bitop3:0xca
    v_bitop3_b32 v14, v6, v14, v47 bitop3:0xca
    s_nop 1
    v_pk_mul_f32 v[80:81], v[80:81], v[14:15] op_sel:[0,1] op_sel_hi:[1,1]
    v_pk_mul_f32 v[82:83], v[82:83], v[14:15] op_sel:[0,1] op_sel_hi:[1,1]
    v_pk_mul_f32 v[76:77], v[76:77], v[14:15] op_sel:[0,0] op_sel_hi:[1,0]
    v_pk_mul_f32 v[78:79], v[78:79], v[14:15] op_sel:[0,0] op_sel_hi:[1,0]
    s_add_u32 s40, s40, 0xfff29280
    v_and_b32 v47, 0x0fffffff, v42
    v_mov_b32 v33, v42
    buffer_load_dwordx4 v[28:31], v47, s[8:11], 0 offen
    buffer_load_dwordx3 v[30:32], v47, s[8:11], 0 offen offset:8
    s_waitcnt lgkmcnt(0)
    v_cmpx_ne_u64 vcc, v[74:75], v[70:71]
    s_and_b64 s[82:83], vcc, s[80:81]
    s_cbranch_scc1 L2_c54
L2_d54:
    v_mov_b64 v[84:85], v[70:71]
    v_mov_b32 v7, v93
    v_mov_b64 v[86:87], v[74:75]
    s_mov_b64 exec, -1
    s_or_b64 s[80:81], s[80:81], vcc
    v_cmpx_ne_u64 vcc, v[72:73], v[68:69]
    s_and_b64 s[82:83], vcc, s[80:81]
    s_cbranch_scc1 L2_c55
L2_d55:
    v_mov_b64 v[84:85], v[68:69]
    v_mov_b32 v7, v92
    v_mov_b64 v[86:87], v[72:73]
    s_mov_b64 exec, -1
    s_or_b64 s[80:81], s[80:81], vcc
    ds_read_b64 v[70:71], v95
    ds_read_b64 v[68:69], v94
    s_waitcnt vmcnt(8)
    v_and_b32 v46, 0x20000000, v39
    v_lshrrev_b32 v47, 14, v35
    v_bitop3_b32 v47, v47, v5, v46 bitop3:0xea
    ds_read_b64 v[102:103], v47 offset:63616
    v_bitop3_b32 v93, v35, v5, v46 bitop3:0xea
    v_and_b32 v46, 0x10000000, v39
    v_lshrrev_b32 v47, 14, v34
    v_bitop3_b32 v47, v47, v5, v46 bitop3:0xea
    ds_read_b64 v[100:101], v47 offset:63616
    v_bitop3_b32 v92, v34, v5, v46 bitop3:0xea
    v_and_b32 v46, 0x80000000, v39
    v_lshrrev_b32 v47, 14, v37
    v_bitop3_b32 v47, v47, v5, v46 bitop3:0xea
    ds_read_b64 v[106:107], v47 offset:63616
    v_and_b32 v46, 0x40000000, v39
    v_lshrrev_b32 v47, 14, v36
    v_bitop3_b32 v47, v47, v5, v46 bitop3:0xea
    ds_read_b64 v[104:105], v47 offset:63616
    s_waitcnt lgkmcnt(4)
    v_mfma_f32_4x4x4_16b_bf16 v[80:83], v[10:11], v[70:71], v[80:83]
    v_mfma_f32_4x4x4_16b_bf16 v[76:79], v[10:11], v[68:69], v[76:79]
    v_perm_b32 v15, v35, v38, s45
    v_bitop3_b32 v46, v35, 0.5, -0.5 bitop3:0xa8
    v_perm_b32 v14, v34, v38, s44
    v_bitop3_b32 v47, v34, 0.5, -0.5 bitop3:0xa8
    v_cvt_pk_bf16_f32 v80, v80, v81
    v_cvt_pk_bf16_f32 v81, v82, v83
    ds_wrxchg_rtn_b64 v[74:75], v95, v[80:81]
    v_cvt_pk_bf16_f32 v76, v76, v77
    v_cvt_pk_bf16_f32 v77, v78, v79
    ds_wrxchg_rtn_b64 v[72:73], v94, v[76:77]
    s_waitcnt lgkmcnt(2)
    s_barrier
    s_setprio 3
    ds_write_b128 v3, v[124:127] offset:4096
    s_add_u32 s3, s40, 4096
    buffer_load_dwordx4 v[124:127], v3, s[16:19], s3 offen
    ds_write_b128 v3, v[116:119] offset:2048
    buffer_load_dwordx4 v[116:119], v3, s[16:19], s40 offen offset:2048
    ds_write_b128 v3, v[120:123] offset:3072
    buffer_load_dwordx4 v[120:123], v3, s[16:19], s40 offen offset:3072
    v_mfma_f32_4x4x4_16b_bf16 v[80:83], v[8:9], v[102:103], 0
    v_mfma_f32_4x4x4_16b_bf16 v[76:79], v[8:9], v[100:101], 0
    v_bitop3_b32 v15, v6, v15, v46 bitop3:0xca
    v_bitop3_b32 v14, v6, v14, v47 bitop3:0xca
    v_cmp_lt_u32 s[84:85], v5, v92
    s_nop 0
    v_pk_mul_f32 v[80:81], v[80:81], v[14:15] op_sel:[0,1] op_sel_hi:[1,1]
    v_pk_mul_f32 v[82:83], v[82:83], v[14:15] op_sel:[0,1] op_sel_hi:[1,1]
    v_pk_mul_f32 v[76:77], v[76:77], v[14:15] op_sel:[0,0] op_sel_hi:[1,0]
    v_pk_mul_f32 v[78:79], v[78:79], v[14:15] op_sel:[0,0] op_sel_hi:[1,0]
    v_mov_b32 v44, v43
    s_cmp_gt_u32 s37, 1024
    s_cbranch_scc1 L2_xs56
    s_cmp_lg_u32 s43, 0
    s_cbranch_scc1 L2_xa56
L2_xb56:
    v_lshlrev_b32 v89, 16, v96
    v_add_u32 v90, 60, v97
    v_bitop3_b32 v90, v89, v45, v90 bitop3:0x6a
    ds_write_b32 v98, v90 offset:12
    v_lshlrev_b32 v89, 20, v96
    v_add_u32 v90, 40, v97
    v_bitop3_b32 v90, v89, v45, v90 bitop3:0x6a
    ds_write_b32 v98, v90 offset:8
    v_lshlrev_b32 v89, 24, v96
    v_add_u32 v90, 20, v97
    v_bitop3_b32 v90, v89, v45, v90 bitop3:0x6a
    ds_write_b32 v98, v90 offset:4
    v_lshlrev_b32 v89, 28, v96
    v_bitop3_b32 v90, v89, v45, v97 bitop3:0x6a
    ds_write_b32 v98, v90 offset:0
    v_mov_b32_dpp v91, v64 quad_perm:[0,0,0,0] row_mask:0xf bank_mask:0xf
    v_and_b32 v89, 3, v91
    v_and_b32 v97, 0xfffc, v91
    v_sub_u16_dpp v88, v64, v91 quad_perm:[2,2,2,2] row_mask:0xf bank_mask:0xf
    v_mad_u32_u24 v97, v97, 5, v4
    v_add_u32 v99, v88, v89
    v_bfm_b32 v96, v88, v89
    v_cmp_lt_u32 s[58:59], 16, v99
    v_lshlrev_b32 v89, v1, v96
    v_and_b32 v89, v45, v89
    v_cmp_ne_u32 vcc, 0, v89
    v_xor_b32 v90, v97, v89
    s_add_u32 s3, s37, s38
    v_mbcnt_lo_u32_b32 v98, vcc_lo, 0
    v_mbcnt_hi_u32_b32 v98, vcc_hi, v98
    s_bcnt1_i32_b64 s41, vcc
    v_lshl_add_u32 v98, v98, 2, s3
    s_mov_b64 exec, vcc
    ds_write_b32 v98, v90
    s_mov_b64 exec, -1
    s_lshl2_add_u32 s37, s41, s37
    s_cmp_lg_u64 s[58:59], 0
    s_cbranch_scc1 L2_xe56
L2_xr56:
    v_add_u32 v98, s37, v0
    v_mov_b32 v90, -1
    ds_write_b32 v98, v90
    ds_read2st64_b32 v[40:41], v0 offset0:0 offset1:1
    ds_read2st64_b32 v[42:43], v0 offset0:2 offset1:3
    s_sub_u32 s3, s37, 768
    s_cmp_gt_u32 s3, 256
    s_cbranch_scc1 L2_xf56
L2_xg56:
    s_setprio 2
    s_waitcnt vmcnt(10)
    ds_write_b128 v3, v[108:111] offset:0
    s_waitcnt lgkmcnt(12)
    v_cmpx_ne_u64 vcc, v[74:75], v[70:71]
    s_and_b64 s[82:83], vcc, s[80:81]
    s_cbranch_scc1 L2_c57
L2_d57:
    v_mov_b64 v[84:85], v[70:71]
    v_mov_b32 v7, v95
    v_mov_b64 v[86:87], v[74:75]
    s_mov_b64 exec, -1
    s_or_b64 s[80:81], s[80:81], vcc
    v_cmpx_ne_u64 vcc, v[72:73], v[68:69]
    s_and_b64 s[82:83], vcc, s[80:81]
    s_cbranch_scc1 L2_c58
L2_d58:
    v_mov_b64 v[84:85], v[68:69]
    v_mov_b32 v7, v94
    v_mov_b64 v[86:87], v[72:73]
    s_mov_b64 exec, -1
    s_or_b64 s[80:81], s[80:81], vcc
    ds_read_b64 v[70:71], v93
    s_and_b64 exec, s[84:85], s[80:81]
    v_mfma_f32_4x4x4_16b_bf16 v[76:79], v[12:13], v[84:85], 0
    v_mov_b32 v92, v7
    s_andn2_b64 s[80:81], s[80:81], s[84:85]
    v_mfma_f32_4x4x4_16b_bf16 v[76:79], v[10:11], v[86:87], v[76:79]
    s_mov_b64 exec, -1
    ds_read_b64 v[68:69], v92
    s_setprio 1
    s_waitcnt vmcnt(7)
    ds_write_b128 v3, v[112:115] offset:1024
    s_waitcnt lgkmcnt(1)
    v_mfma_f32_4x4x4_16b_bf16 v[80:83], v[10:11], v[70:71], v[80:83]
    v_mfma_f32_4x4x4_16b_bf16 v[76:79], v[10:11], v[68:69], v[76:79]
    v_and_b32 v46, 0x40000000, v39
    v_bitop3_b32 v94, v36, v5, v46 bitop3:0xea
    v_and_b32 v46, 0x80000000, v39
    v_bitop3_b32 v95, v37, v5, v46 bitop3:0xea
    v_perm_b32 v15, v37, v38, s47
    v_bitop3_b32 v46, v37, 0.5, -0.5 bitop3:0xa8
    v_perm_b32 v14, v36, v38, s46
    v_bitop3_b32 v47, v36, 0.5, -0.5 bitop3:0xa8
    v_cvt_pk_bf16_f32 v80, v80, v81
    v_cvt_pk_bf16_f32 v81, v82, v83
    ds_wrxchg_rtn_b64 v[74:75], v93, v[80:81]
    v_cvt_pk_bf16_f32 v76, v76, v77
    v_cvt_pk_bf16_f32 v77, v78, v79
    ds_wrxchg_rtn_b64 v[72:73], v92, v[76:77]
    s_setprio 0
    v_mfma_f32_4x4x4_16b_bf16 v[80:83], v[8:9], v[106:107], 0
    v_mfma_f32_4x4x4_16b_bf16 v[76:79], v[8:9], v[104:105], 0
    v_bitop3_b32 v15, v6, v15, v46 bitop3:0xca
    v_bitop3_b32 v14, v6, v14, v47 bitop3:0xca
    s_nop 1
    v_pk_mul_f32 v[80:81], v[80:81], v[14:15] op_sel:[0,1] op_sel_hi:[1,1]
    v_pk_mul_f32 v[82:83], v[82:83], v[14:15] op_sel:[0,1] op_sel_hi:[1,1]
    v_pk_mul_f32 v[76:77], v[76:77], v[14:15] op_sel:[0,0] op_sel_hi:[1,0]
    v_pk_mul_f32 v[78:79], v[78:79], v[14:15] op_sel:[0,0] op_sel_hi:[1,0]
    s_add_u32 s42, s42, 1
    s_waitcnt lgkmcnt(2)
    s_barrier
    s_bitcmp1_b32 s36, s42
    s_cbranch_scc1 L2_slow
L2_ret3:
    s_setprio 3
    v_and_b32 v47, 0x0fffffff, v44
    v_mov_b32 v39, v44
    buffer_load_dwordx4 v[34:37], v47, s[8:11], 0 offen
    buffer_load_dwordx3 v[36:38], v47, s[8:11], 0 offen offset:8
    s_waitcnt lgkmcnt(0)
    v_cmpx_ne_u64 vcc, v[74:75], v[70:71]
    s_and_b64 s[82:83], vcc, s[80:81]
    s_cbranch_scc1 L2_c59
L2_d59:
    v_mov_b64 v[84:85], v[70:71]
    v_mov_b32 v7, v93
    v_mov_b64 v[86:87], v[74:75]
    s_mov_b64 exec, -1
    s_or_b64 s[80:81], s[80:81], vcc
    v_cmpx_ne_u64 vcc, v[72:73], v[68:69]
    s_and_b64 s[82:83], vcc, s[80:81]
    s_cbranch_scc1 L2_c60
L2_d60:
    v_mov_b64 v[84:85], v[68:69]
    v_mov_b32 v7, v92
    v_mov_b64 v[86:87], v[72:73]
    s_mov_b64 exec, -1
    s_or_b64 s[80:81], s[80:81], vcc
    ds_read_b64 v[70:71], v95
    ds_read_b64 v[68:69], v94
    v_and_b32 v46, 0x20000000, v21
    v_lshrrev_b32 v47, 14, v17
    v_bitop3_b32 v47, v47, v5, v46 bitop3:0xea
    ds_read_b64 v[102:103], v47 offset:63616
    v_bitop3_b32 v93, v17, v5, v46 bitop3:0xea
    v_and_b32 v46, 0x10000000, v21
    v_lshrrev_b32 v47, 14, v16
    v_bitop3_b32 v47, v47, v5, v46 bitop3:0xea
    ds_read_b64 v[100:101], v47 offset:63616
    v_bitop3_b32 v92, v16, v5, v46 bitop3:0xea
    s_waitcnt lgkmcnt(2)
    v_mfma_f32_4x4x4_16b_bf16 v[80:83], v[10:11], v[70:71], v[80:83]
    v_mfma_f32_4x4x4_16b_bf16 v[76:79], v[10:11], v[68:69], v[76:79]
    v_perm_b32 v15, v17, v20, s45
    v_bitop3_b32 v46, v17, 0.5, -0.5 bitop3:0xa8
    v_perm_b32 v14, v16, v20, s44
    v_bitop3_b32 v47, v16, 0.5, -0.5 bitop3:0xa8
    v_cvt_pk_bf16_f32 v80, v80, v81
    v_cvt_pk_bf16_f32 v81, v82, v83
    ds_wrxchg_rtn_b64 v[74:75], v95, v[80:81]
    v_cvt_pk_bf16_f32 v76, v76, v77
    v_cvt_pk_bf16_f32 v77, v78, v79
    ds_wrxchg_rtn_b64 v[72:73], v94, v[76:77]
    s_waitcnt lgkmcnt(2)
    v_mfma_f32_4x4x4_16b_bf16 v[80:83], v[8:9], v[102:103], 0
    v_mfma_f32_4x4x4_16b_bf16 v[76:79], v[8:9], v[100:101], 0
    v_bitop3_b32 v15, v6, v15, v46 bitop3:0xca
    v_bitop3_b32 v14, v6, v14, v47 bitop3:0xca
    v_cmp_lt_u32 s[84:85], v5, v92
    s_nop 0
    v_pk_mul_f32 v[80:81], v[80:81], v[14:15] op_sel:[0,1] op_sel_hi:[1,1]
    v_pk_mul_f32 v[82:83], v[82:83], v[14:15] op_sel:[0,1] op_sel_hi:[1,1]
    v_pk_mul_f32 v[76:77], v[76:77], v[14:15] op_sel:[0,0] op_sel_hi:[1,0]
    v_pk_mul_f32 v[78:79], v[78:79], v[14:15] op_sel:[0,0] op_sel_hi:[1,0]
    buffer_load_dwordx4 v[108:111], v3, s[16:19], s40 offen offset:0
    s_waitcnt lgkmcnt(0)
    v_cmpx_ne_u64 vcc, v[74:75], v[70:71]
    s_and_b64 s[82:83], vcc, s[80:81]
    s_cbranch_scc1 L2_c61
L2_d61:
    v_mov_b64 v[84:85], v[70:71]
    v_mov_b32 v7, v95
    v_mov_b64 v[86:87], v[74:75]
    s_mov_b64 exec, -1
    s_or_b64 s[80:81], s[80:81], vcc
    v_cmpx_ne_u64 vcc, v[72:73], v[68:69]
    s_and_b64 s[82:83], vcc, s[80:81]
    s_cbranch_scc1 L2_c62
L2_d62:
    v_mov_b64 v[84:85], v[68:69]
    v_mov_b32 v7, v94
    v_mov_b64 v[86:87], v[72:73]
    s_mov_b64 exec, -1
    s_or_b64 s[80:81], s[80:81], vcc
    ds_read_b64 v[70:71], v93
    s_and_b64 exec, s[84:85], s[80:81]
    v_mfma_f32_4x4x4_16b_bf16 v[76:79], v[12:13], v[84:85], 0
    v_mov_b32 v92, v7
    s_andn2_b64 s[80:81], s[80:81], s[84:85]
    v_mfma_f32_4x4x4_16b_bf16 v[76:79], v[10:11], v[86:87], v[76:79]
    s_mov_b64 exec, -1
    ds_read_b64 v[68:69], v92
    v_and_b32 v46, 0x80000000, v21
    v_lshrrev_b32 v47, 14, v19
    v_bitop3_b32 v47, v47, v5, v46 bitop3:0xea
    ds_read_b64 v[106:107], v47 offset:63616
    v_bitop3_b32 v95, v19, v5, v46 bitop3:0xea
    v_and_b32 v46, 0x40000000, v21
    v_lshrrev_b32 v47, 14, v18
    v_bitop3_b32 v47, v47, v5, v46 bitop3:0xea
    ds_read_b64 v[104:105], v47 offset:63616
    v_bitop3_b32 v94, v18, v5, v46 bitop3:0xea
    s_waitcnt lgkmcnt(2)
    v_mfma_f32_4x4x4_16b_bf16 v[80:83], v[10:11], v[70:71], v[80:83]
    v_mfma_f32_4x4x4_16b_bf16 v[76:79], v[10:11], v[68:69], v[76:79]
    v_perm_b32 v15, v19, v20, s47
    v_bitop3_b32 v46, v19, 0.5, -0.5 bitop3:0xa8
    v_perm_b32 v14, v18, v20, s46
    v_bitop3_b32 v47, v18, 0.5, -0.5 bitop3:0xa8
    v_cvt_pk_bf16_f32 v80, v80, v81
    v_cvt_pk_bf16_f32 v81, v82, v83
    ds_wrxchg_rtn_b64 v[74:75], v93, v[80:81]
    v_cvt_pk_bf16_f32 v76, v76, v77
    v_cvt_pk_bf16_f32 v77, v78, v79
    ds_wrxchg_rtn_b64 v[72:73], v92, v[76:77]
    s_setprio 2
    s_waitcnt lgkmcnt(2)
    v_mfma_f32_4x4x4_16b_bf16 v[80:83], v[8:9], v[106:107], 0
    v_mfma_f32_4x4x4_16b_bf16 v[76:79], v[8:9], v[104:105], 0
    v_bitop3_b32 v15, v6, v15, v46 bitop3:0xca
    v_bitop3_b32 v14, v6, v14, v47 bitop3:0xca
    s_nop 1
    v_pk_mul_f32 v[80:81], v[80:81], v[14:15] op_sel:[0,1] op_sel_hi:[1,1]
    v_pk_mul_f32 v[82:83], v[82:83], v[14:15] op_sel:[0,1] op_sel_hi:[1,1]
    v_pk_mul_f32 v[76:77], v[76:77], v[14:15] op_sel:[0,0] op_sel_hi:[1,0]
    v_pk_mul_f32 v[78:79], v[78:79], v[14:15] op_sel:[0,0] op_sel_hi:[1,0]
    v_and_b32 v47, 0x0fffffff, v40
    v_mov_b32 v21, v40
    buffer_load_dwordx4 v[16:19], v47, s[8:11], 0 offen
    buffer_load_dwordx3 v[18:20], v47, s[8:11], 0 offen offset:8
    s_waitcnt lgkmcnt(0)
    v_cmpx_ne_u64 vcc, v[74:75], v[70:71]
    s_and_b64 s[82:83], vcc, s[80:81]
    s_cbranch_scc1 L2_c63
L2_d63:
    v_mov_b64 v[84:85], v[70:71]
    v_mov_b32 v7, v93
    v_mov_b64 v[86:87], v[74:75]
    s_mov_b64 exec, -1
    s_or_b64 s[80:81], s[80:81], vcc
    v_cmpx_ne_u64 vcc, v[72:73], v[68:69]
    s_and_b64 s[82:83], vcc, s[80:81]
    s_cbranch_scc1 L2_c64
L2_d64:
    v_mov_b64 v[84:85], v[68:69]
    v_mov_b32 v7, v92
    v_mov_b64 v[86:87], v[72:73]
    s_mov_b64 exec, -1
    s_or_b64 s[80:81], s[80:81], vcc
    ds_read_b64 v[70:71], v95
    ds_read_b64 v[68:69], v94
    s_waitcnt vmcnt(10)
    v_and_b32 v46, 0x20000000, v27
    v_lshrrev_b32 v47, 14, v23
    v_bitop3_b32 v47, v47, v5, v46 bitop3:0xea
    ds_read_b64 v[102:103], v47 offset:63616
    v_bitop3_b32 v93, v23, v5, v46 bitop3:0xea
    v_and_b32 v46, 0x10000000, v27
    v_lshrrev_b32 v47, 14, v22
    v_bitop3_b32 v47, v47, v5, v46 bitop3:0xea
    ds_read_b64 v[100:101], v47 offset:63616
    v_bitop3_b32 v92, v22, v5, v46 bitop3:0xea
    s_waitcnt lgkmcnt(2)
    v_mfma_f32_4x4x4_16b_bf16 v[80:83], v[10:11], v[70:71], v[80:83]
    v_mfma_f32_4x4x4_16b_bf16 v[76:79], v[10:11], v[68:69], v[76:79]
    v_perm_b32 v15, v23, v26, s45
    v_bitop3_b32 v46, v23, 0.5, -0.5 bitop3:0xa8
    v_perm_b32 v14, v22, v26, s44
    v_bitop3_b32 v47, v22, 0.5, -0.5 bitop3:0xa8
    v_cvt_pk_bf16_f32 v80, v80, v81
    v_cvt_pk_bf16_f32 v81, v82, v83
    ds_wrxchg_rtn_b64 v[74:75], v95, v[80:81]
    v_cvt_pk_bf16_f32 v76, v76, v77
    v_cvt_pk_bf16_f32 v77, v78, v79
    ds_wrxchg_rtn_b64 v[72:73], v94, v[76:77]
    s_waitcnt lgkmcnt(2)
    v_mfma_f32_4x4x4_16b_bf16 v[80:83], v[8:9], v[102:103], 0
    v_mfma_f32_4x4x4_16b_bf16 v[76:79], v[8:9], v[100:101], 0
    v_bitop3_b32 v15, v6, v15, v46 bitop3:0xca
    v_bitop3_b32 v14, v6, v14, v47 bitop3:0xca
    v_cmp_lt_u32 s[84:85], v5, v92
    s_nop 0
    v_pk_mul_f32 v[80:81], v[80:81], v[14:15] op_sel:[0,1] op_sel_hi:[1,1]
    v_pk_mul_f32 v[82:83], v[82:83], v[14:15] op_sel:[0,1] op_sel_hi:[1,1]
    v_pk_mul_f32 v[76:77], v[76:77], v[14:15] op_sel:[0,0] op_sel_hi:[1,0]
    v_pk_mul_f32 v[78:79], v[78:79], v[14:15] op_sel:[0,0] op_sel_hi:[1,0]
    v_sub_u16 v88, v58, v50
    v_and_b32 v89, 3, v50
    v_add3_u32 v99, v88, v89, 3
    v_and_b32 v99, -4, v99
    v_max_u32 v99, 4, v99
    v_and_b32 v97, 0xfffc, v50
    v_bfm_b32 v96, v88, v89
    v_add_u32_dpp v91, v99, v99 row_shr:1 row_mask:0xf bank_mask:0xf bound_ctrl:1
    v_mad_u32_u24 v97, v97, 5, v2
    v_cmp_lt_u32 vcc, 16, v99
    v_add_u32_dpp v91, v91, v91 row_shr:2 row_mask:0xf bank_mask:0xf bound_ctrl:1
    v_sub_u32 v98, s38, v99
    v_lshrrev_b64 v[50:51], 16, v[50:51]
    v_add_u32_dpp v91, v91, v91 row_shr:4 row_mask:0xf bank_mask:0xf bound_ctrl:1
    v_lshrrev_b64 v[58:59], 16, v[58:59]
    s_mov_b32 s43, 0
    v_add_u32_dpp v91, v91, v91 row_shr:8 row_mask:0xf bank_mask:0xf bound_ctrl:1
    s_nop 1
    v_add_u32_dpp v91, v91, v91 row_bcast:15 row_mask:0xa bank_mask:0xf
    s_nop 1
    v_add_u32_dpp v91, v91, v91 row_bcast:31 row_mask:0xc bank_mask:0xf
    v_add_u32 v98, v98, v91
    v_readlane_b32 s37, v91, 63
    s_cbranch_vccnz L2_xo65
L2_xp65:
    buffer_load_dwordx4 v[112:115], v3, s[16:19], s40 offen offset:1024
    s_waitcnt lgkmcnt(0)
    v_cmpx_ne_u64 vcc, v[74:75], v[70:71]
    s_and_b64 s[82:83], vcc, s[80:81]
    s_cbranch_scc1 L2_c66
L2_d66:
    v_mov_b64 v[84:85], v[70:71]
    v_mov_b32 v7, v95
    v_mov_b64 v[86:87], v[74:75]
    s_mov_b64 exec, -1
    s_or_b64 s[80:81], s[80:81], vcc
    v_cmpx_ne_u64 vcc, v[72:73], v[68:69]
    s_and_b64 s[82:83], vcc, s[80:81]
    s_cbranch_scc1 L2_c67
L2_d67:
    v_mov_b64 v[84:85], v[68:69]
    v_mov_b32 v7, v94
    v_mov_b64 v[86:87], v[72:73]
    s_mov_b64 exec, -1
    s_or_b64 s[80:81], s[80:81], vcc
    ds_read_b64 v[70:71], v93
    s_and_b64 exec, s[84:85], s[80:81]
    v_mfma_f32_4x4x4_16b_bf16 v[76:79], v[12:13], v[84:85], 0
    v_mov_b32 v92, v7
    s_andn2_b64 s[80:81], s[80:81], s[84:85]
    v_mfma_f32_4x4x4_16b_bf16 v[76:79], v[10:11], v[86:87], v[76:79]
    s_mov_b64 exec, -1
    ds_read_b64 v[68:69], v92
    v_and_b32 v46, 0x80000000, v27
    v_lshrrev_b32 v47, 14, v25
    v_bitop3_b32 v47, v47, v5, v46 bitop3:0xea
    ds_read_b64 v[106:107], v47 offset:63616
    v_bitop3_b32 v95, v25, v5, v46 bitop3:0xea
    v_and_b32 v46, 0x40000000, v27
    v_lshrrev_b32 v47, 14, v24
    v_bitop3_b32 v47, v47, v5, v46 bitop3:0xea
    ds_read_b64 v[104:105], v47 offset:63616
    v_bitop3_b32 v94, v24, v5, v46 bitop3:0xea
    s_waitcnt lgkmcnt(2)
    v_mfma_f32_4x4x4_16b_bf16 v[80:83], v[10:11], v[70:71], v[80:83]
    v_mfma_f32_4x4x4_16b_bf16 v[76:79], v[10:11], v[68:69], v[76:79]
    v_perm_b32 v15, v25, v26, s47
    v_bitop3_b32 v46, v25, 0.5, -0.5 bitop3:0xa8
    v_perm_b32 v14, v24, v26, s46
    v_bitop3_b32 v47, v24, 0.5, -0.5 bitop3:0xa8
    v_cvt_pk_bf16_f32 v80, v80, v81
    v_cvt_pk_bf16_f32 v81, v82, v83
    ds_wrxchg_rtn_b64 v[74:75], v93, v[80:81]
    v_cvt_pk_bf16_f32 v76, v76, v77
    v_cvt_pk_bf16_f32 v77, v78, v79
    ds_wrxchg_rtn_b64 v[72:73], v92, v[76:77]
    s_setprio 1
    s_waitcnt lgkmcnt(2)
    v_mfma_f32_4x4x4_16b_bf16 v[80:83], v[8:9], v[106:107], 0
    v_mfma_f32_4x4x4_16b_bf16 v[76:79], v[8:9], v[104:105], 0
    v_bitop3_b32 v15, v6, v15, v46 bitop3:0xca
    v_bitop3_b32 v14, v6, v14, v47 bitop3:0xca
    s_nop 1
    v_pk_mul_f32 v[80:81], v[80:81], v[14:15] op_sel:[0,1] op_sel_hi:[1,1]
    v_pk_mul_f32 v[82:83], v[82:83], v[14:15] op_sel:[0,1] op_sel_hi:[1,1]
    v_pk_mul_f32 v[76:77], v[76:77], v[14:15] op_sel:[0,0] op_sel_hi:[1,0]
    v_pk_mul_f32 v[78:79], v[78:79], v[14:15] op_sel:[0,0] op_sel_hi:[1,0]
    v_and_b32 v47, 0x0fffffff, v41
    v_mov_b32 v27, v41
    buffer_load_dwordx4 v[22:25], v47, s[8:11], 0 offen
    buffer_load_dwordx3 v[24:26], v47, s[8:11], 0 offen offset:8
    s_waitcnt lgkmcnt(0)
    v_cmpx_ne_u64 vcc, v[74:75], v[70:71]
    s_and_b64 s[82:83], vcc, s[80:81]
    s_cbranch_scc1 L2_c68
L2_d68:
    v_mov_b64 v[84:85], v[70:71]
    v_mov_b32 v7, v93
    v_mov_b64 v[86:87], v[74:75]
    s_mov_b64 exec, -1
    s_or_b64 s[80:81], s[80:81], vcc
    v_cmpx_ne_u64 vcc, v[72:73], v[68:69]
    s_and_b64 s[82:83], vcc, s[80:81]
    s_cbranch_scc1 L2_c69
L2_d69:
    v_mov_b64 v[84:85], v[68:69]
    v_mov_b32 v7, v92
    v_mov_b64 v[86:87], v[72:73]
    s_mov_b64 exec, -1
    s_or_b64 s[80:81], s[80:81], vcc
    ds_read_b64 v[70:71], v95
    ds_read_b64 v[68:69], v94
    s_waitcnt vmcnt(11)
    v_and_b32 v46, 0x20000000, v33
    v_lshrrev_b32 v47, 14, v29
    v_bitop3_b32 v47, v47, v5, v46 bitop3:0xea
    ds_read_b64 v[102:103], v47 offset:63616
    v_bitop3_b32 v93, v29, v5, v46 bitop3:0xea
    v_and_b32 v46, 0x10000000, v33
    v_lshrrev_b32 v47, 14, v28
    v_bitop3_b32 v47, v47, v5, v46 bitop3:0xea
    ds_read_b64 v[100:101], v47 offset:63616
    v_bitop3_b32 v92, v28, v5, v46 bitop3:0xea
    s_waitcnt lgkmcnt(2)
    v_mfma_f32_4x4x4_16b_bf16 v[80:83], v[10:11], v[70:71], v[80:83]
    v_mfma_f32_4x4x4_16b_bf16 v[76:79], v[10:11], v[68:69], v[76:79]
    v_perm_b32 v15, v29, v32, s45
    v_bitop3_b32 v46, v29, 0.5, -0.5 bitop3:0xa8
    v_perm_b32 v14, v28, v32, s44
    v_bitop3_b32 v47, v28, 0.5, -0.5 bitop3:0xa8
    v_cvt_pk_bf16_f32 v80, v80, v81
    v_cvt_pk_bf16_f32 v81, v82, v83
    ds_wrxchg_rtn_b64 v[74:75], v95, v[80:81]
    v_cvt_pk_bf16_f32 v76, v76, v77
    v_cvt_pk_bf16_f32 v77, v78, v79
    ds_wrxchg_rtn_b64 v[72:73], v94, v[76:77]
    s_waitcnt lgkmcnt(2)
    v_mfma_f32_4x4x4_16b_bf16 v[80:83], v[8:9], v[102:103], 0
    v_mfma_f32_4x4x4_16b_bf16 v[76:79], v[8:9], v[100:101], 0
    v_bitop3_b32 v15, v6, v15, v46 bitop3:0xca
    v_bitop3_b32 v14, v6, v14, v47 bitop3:0xca
    v_cmp_lt_u32 s[84:85], v5, v92
    s_nop 0
    v_pk_mul_f32 v[80:81], v[80:81], v[14:15] op_sel:[0,1] op_sel_hi:[1,1]
    v_pk_mul_f32 v[82:83], v[82:83], v[14:15] op_sel:[0,1] op_sel_hi:[1,1]
    v_pk_mul_f32 v[76:77], v[76:77], v[14:15] op_sel:[0,0] op_sel_hi:[1,0]
    v_pk_mul_f32 v[78:79], v[78:79], v[14:15] op_sel:[0,0] op_sel_hi:[1,0]
    s_waitcnt lgkmcnt(0)
    v_cmpx_ne_u64 vcc, v[74:75], v[70:71]
    s_and_b64 s[82:83], vcc, s[80:81]
    s_cbranch_scc1 L2_c70
L2_d70:
    v_mov_b64 v[84:85], v[70:71]
    v_mov_b32 v7, v95
    v_mov_b64 v[86:87], v[74:75]
    s_mov_b64 exec, -1
    s_or_b64 s[80:81], s[80:81], vcc
    v_cmpx_ne_u64 vcc, v[72:73], v[68:69]
    s_and_b64 s[82:83], vcc, s[80:81]
    s_cbranch_scc1 L2_c71
L2_d71:
    v_mov_b64 v[84:85], v[68:69]
    v_mov_b32 v7, v94
    v_mov_b64 v[86:87], v[72:73]
    s_mov_b64 exec, -1
    s_or_b64 s[80:81], s[80:81], vcc
    ds_read_b64 v[70:71], v93
    s_and_b64 exec, s[84:85], s[80:81]
    v_mfma_f32_4x4x4_16b_bf16 v[76:79], v[12:13], v[84:85], 0
    v_mov_b32 v92, v7
    s_andn2_b64 s[80:81], s[80:81], s[84:85]
    v_mfma_f32_4x4x4_16b_bf16 v[76:79], v[10:11], v[86:87], v[76:79]
    s_mov_b64 exec, -1
    ds_read_b64 v[68:69], v92
    v_and_b32 v46, 0x80000000, v33
    v_lshrrev_b32 v47, 14, v31
    v_bitop3_b32 v47, v47, v5, v46 bitop3:0xea
    ds_read_b64 v[106:107], v47 offset:63616
    v_bitop3_b32 v95, v31, v5, v46 bitop3:0xea
    v_and_b32 v46, 0x40000000, v33
    v_lshrrev_b32 v47, 14, v30
    v_bitop3_b32 v47, v47, v5, v46 bitop3:0xea
    ds_read_b64 v[104:105], v47 offset:63616
    v_bitop3_b32 v94, v30, v5, v46 bitop3:0xea
    s_waitcnt lgkmcnt(2)
    v_mfma_f32_4x4x4_16b_bf16 v[80:83], v[10:11], v[70:71], v[80:83]
    v_mfma_f32_4x4x4_16b_bf16 v[76:79], v[10:11], v[68:69], v[76:79]
    v_perm_b32 v15, v31, v32, s47
    v_bitop3_b32 v46, v31, 0.5, -0.5 bitop3:0xa8
    v_perm_b32 v14, v30, v32, s46
    v_bitop3_b32 v47, v30, 0.5, -0.5 bitop3:0xa8
    v_cvt_pk_bf16_f32 v80, v80, v81
    v_cvt_pk_bf16_f32 v81, v82, v83
    ds_wrxchg_rtn_b64 v[74:75], v93, v[80:81]
    v_cvt_pk_bf16_f32 v76, v76, v77
    v_cvt_pk_bf16_f32 v77, v78, v79
    ds_wrxchg_rtn_b64 v[72:73], v92, v[76:77]
    s_setprio 0
    s_waitcnt lgkmcnt(2)
    v_mfma_f32_4x4x4_16b_bf16 v[80:83], v[8:9], v[106:107], 0
    v_mfma_f32_4x4x4_16b_bf16 v[76:79], v[8:9], v[104:105], 0
    v_bitop3_b32 v15, v6, v15, v46 bitop3:0xca
    v_bitop3_b32 v14, v6, v14, v47 bitop3:0xca
    s_nop 1
    v_pk_mul_f32 v[80:81], v[80:81], v[14:15] op_sel:[0,1] op_sel_hi:[1,1]
    v_pk_mul_f32 v[82:83], v[82:83], v[14:15] op_sel:[0,1] op_sel_hi:[1,1]
    v_pk_mul_f32 v[76:77], v[76:77], v[14:15] op_sel:[0,0] op_sel_hi:[1,0]
    v_pk_mul_f32 v[78:79], v[78:79], v[14:15] op_sel:[0,0] op_sel_hi:[1,0]
    s_add_u32 s40, s40, 0x4e200
    v_and_b32 v47, 0x0fffffff, v42
    v_mov_b32 v33, v42
    buffer_load_dwordx4 v[28:31], v47, s[8:11], 0 offen
    buffer_load_dwordx3 v[30:32], v47, s[8:11], 0 offen offset:8
    s_waitcnt lgkmcnt(0)
    v_cmpx_ne_u64 vcc, v[74:75], v[70:71]
    s_and_b64 s[82:83], vcc, s[80:81]
    s_cbranch_scc1 L2_c72
L2_d72:
    v_mov_b64 v[84:85], v[70:71]
    v_mov_b32 v7, v93
    v_mov_b64 v[86:87], v[74:75]
    s_mov_b64 exec, -1
    s_or_b64 s[80:81], s[80:81], vcc
    v_cmpx_ne_u64 vcc, v[72:73], v[68:69]
    s_and_b64 s[82:83], vcc, s[80:81]
    s_cbranch_scc1 L2_c73
L2_d73:
    v_mov_b64 v[84:85], v[68:69]
    v_mov_b32 v7, v92
    v_mov_b64 v[86:87], v[72:73]
    s_mov_b64 exec, -1
    s_or_b64 s[80:81], s[80:81], vcc
    ds_read_b64 v[70:71], v95
    ds_read_b64 v[68:69], v94
    s_waitcnt vmcnt(8)
    v_and_b32 v46, 0x20000000, v39
    v_lshrrev_b32 v47, 14, v35
    v_bitop3_b32 v47, v47, v5, v46 bitop3:0xea
    ds_read_b64 v[102:103], v47 offset:63616
    v_bitop3_b32 v93, v35, v5, v46 bitop3:0xea
    v_and_b32 v46, 0x10000000, v39
    v_lshrrev_b32 v47, 14, v34
    v_bitop3_b32 v47, v47, v5, v46 bitop3:0xea
    ds_read_b64 v[100:101], v47 offset:63616
    v_bitop3_b32 v92, v34, v5, v46 bitop3:0xea
    v_and_b32 v46, 0x80000000, v39
    v_lshrrev_b32 v47, 14, v37
    v_bitop3_b32 v47, v47, v5, v46 bitop3:0xea
    ds_read_b64 v[106:107], v47 offset:63616
    v_and_b32 v46, 0x40000000, v39
    v_lshrrev_b32 v47, 14, v36
    v_bitop3_b32 v47, v47, v5, v46 bitop3:0xea
    ds_read_b64 v[104:105], v47 offset:63616
    s_waitcnt lgkmcnt(4)
    v_mfma_f32_4x4x4_16b_bf16 v[80:83], v[10:11], v[70:71], v[80:83]
    v_mfma_f32_4x4x4_16b_bf16 v[76:79], v[10:11], v[68:69], v[76:79]
    v_perm_b32 v15, v35, v38, s45
    v_bitop3_b32 v46, v35, 0.5, -0.5 bitop3:0xa8
    v_perm_b32 v14, v34, v38, s44
    v_bitop3_b32 v47, v34, 0.5, -0.5 bitop3:0xa8
    v_cvt_pk_bf16_f32 v80, v80, v81
    v_cvt_pk_bf16_f32 v81, v82, v83
    ds_wrxchg_rtn_b64 v[74:75], v95, v[80:81]
    v_cvt_pk_bf16_f32 v76, v76, v77
    v_cvt_pk_bf16_f32 v77, v78, v79
    ds_wrxchg_rtn_b64 v[72:73], v94, v[76:77]
    s_waitcnt lgkmcnt(2)
    s_barrier
    s_setprio 3
    ds_write_b128 v3, v[124:127] offset:4096
    s_add_u32 s3, s40, 4096
    buffer_load_dwordx4 v[124:127], v3, s[16:19], s3 offen
    ds_write_b128 v3, v[116:119] offset:2048
    buffer_load_dwordx4 v[116:119], v3, s[16:19], s40 offen offset:2048
    ds_write_b128 v3, v[120:123] offset:3072
    buffer_load_dwordx4 v[120:123], v3, s[16:19], s40 offen offset:3072
    v_mfma_f32_4x4x4_16b_bf16 v[80:83], v[8:9], v[102:103], 0
    v_mfma_f32_4x4x4_16b_bf16 v[76:79], v[8:9], v[100:101], 0
    v_bitop3_b32 v15, v6, v15, v46 bitop3:0xca
    v_bitop3_b32 v14, v6, v14, v47 bitop3:0xca
    v_cmp_lt_u32 s[84:85], v5, v92
    s_nop 0
    v_pk_mul_f32 v[80:81], v[80:81], v[14:15] op_sel:[0,1] op_sel_hi:[1,1]
    v_pk_mul_f32 v[82:83], v[82:83], v[14:15] op_sel:[0,1] op_sel_hi:[1,1]
    v_pk_mul_f32 v[76:77], v[76:77], v[14:15] op_sel:[0,0] op_sel_hi:[1,0]
    v_pk_mul_f32 v[78:79], v[78:79], v[14:15] op_sel:[0,0] op_sel_hi:[1,0]
    v_mov_b32 v44, v43
    s_cmp_gt_u32 s37, 1024
    s_cbranch_scc1 L2_xs74
    s_cmp_lg_u32 s43, 0
    s_cbranch_scc1 L2_xa74
L2_xb74:
    v_lshlrev_b32 v89, 16, v96
    v_add_u32 v90, 60, v97
    v_bitop3_b32 v90, v89, v45, v90 bitop3:0x6a
    ds_write_b32 v98, v90 offset:12
    v_lshlrev_b32 v89, 20, v96
    v_add_u32 v90, 40, v97
    v_bitop3_b32 v90, v89, v45, v90 bitop3:0x6a
    ds_write_b32 v98, v90 offset:8
    v_lshlrev_b32 v89, 24, v96
    v_add_u32 v90, 20, v97
    v_bitop3_b32 v90, v89, v45, v90 bitop3:0x6a
    ds_write_b32 v98, v90 offset:4
    v_lshlrev_b32 v89, 28, v96
    v_bitop3_b32 v90, v89, v45, v97 bitop3:0x6a
    ds_write_b32 v98, v90 offset:0
    v_mov_b32_dpp v91, v66 quad_perm:[0,0,0,0] row_mask:0xf bank_mask:0xf
    v_and_b32 v89, 3, v91
    v_and_b32 v97, 0xfffc, v91
    v_sub_u16_dpp v88, v66, v91 quad_perm:[2,2,2,2] row_mask:0xf bank_mask:0xf
    v_mad_u32_u24 v97, v97, 5, v4
    v_add_u32 v99, v88, v89
    v_bfm_b32 v96, v88, v89
    v_cmp_lt_u32 s[58:59], 16, v99
    v_lshlrev_b32 v89, v1, v96
    v_and_b32 v89, v45, v89
    v_cmp_ne_u32 vcc, 0, v89
    v_xor_b32 v90, v97, v89
    s_add_u32 s3, s37, s38
    v_mbcnt_lo_u32_b32 v98, vcc_lo, 0
    v_mbcnt_hi_u32_b32 v98, vcc_hi, v98
    s_bcnt1_i32_b64 s41, vcc
    v_lshl_add_u32 v98, v98, 2, s3
    s_mov_b64 exec, vcc
    ds_write_b32 v98, v90
    s_mov_b64 exec, -1
    s_lshl2_add_u32 s37, s41, s37
    s_cmp_lg_u64 s[58:59], 0
    s_cbranch_scc1 L2_xe74
L2_xr74:
    v_add_u32 v98, s37, v0
    v_mov_b32 v90, -1
    ds_write_b32 v98, v90
    ds_read2st64_b32 v[40:41], v0 offset0:0 offset1:1
    ds_read2st64_b32 v[42:43], v0 offset0:2 offset1:3
    s_sub_u32 s3, s37, 768
    s_cmp_gt_u32 s3, 256
    s_cbranch_scc1 L2_xf74
L2_xg74:
    s_setprio 2
    s_waitcnt vmcnt(10)
    ds_write_b128 v3, v[108:111] offset:0
    s_waitcnt lgkmcnt(12)
    v_cmpx_ne_u64 vcc, v[74:75], v[70:71]
    s_and_b64 s[82:83], vcc, s[80:81]
    s_cbranch_scc1 L2_c75
L2_d75:
    v_mov_b64 v[84:85], v[70:71]
    v_mov_b32 v7, v95
    v_mov_b64 v[86:87], v[74:75]
    s_mov_b64 exec, -1
    s_or_b64 s[80:81], s[80:81], vcc
    v_cmpx_ne_u64 vcc, v[72:73], v[68:69]
    s_and_b64 s[82:83], vcc, s[80:81]
    s_cbranch_scc1 L2_c76
L2_d76:
    v_mov_b64 v[84:85], v[68:69]
    v_mov_b32 v7, v94
    v_mov_b64 v[86:87], v[72:73]
    s_mov_b64 exec, -1
    s_or_b64 s[80:81], s[80:81], vcc
    ds_read_b64 v[70:71], v93
    s_and_b64 exec, s[84:85], s[80:81]
    v_mfma_f32_4x4x4_16b_bf16 v[76:79], v[12:13], v[84:85], 0
    v_mov_b32 v92, v7
    s_andn2_b64 s[80:81], s[80:81], s[84:85]
    v_mfma_f32_4x4x4_16b_bf16 v[76:79], v[10:11], v[86:87], v[76:79]
    s_mov_b64 exec, -1
    ds_read_b64 v[68:69], v92
    s_setprio 1
    s_waitcnt vmcnt(7)
    ds_write_b128 v3, v[112:115] offset:1024
    s_waitcnt lgkmcnt(1)
    v_mfma_f32_4x4x4_16b_bf16 v[80:83], v[10:11], v[70:71], v[80:83]
    v_mfma_f32_4x4x4_16b_bf16 v[76:79], v[10:11], v[68:69], v[76:79]
    v_and_b32 v46, 0x40000000, v39
    v_bitop3_b32 v94, v36, v5, v46 bitop3:0xea
    v_and_b32 v46, 0x80000000, v39
    v_bitop3_b32 v95, v37, v5, v46 bitop3:0xea
    v_perm_b32 v15, v37, v38, s47
    v_bitop3_b32 v46, v37, 0.5, -0.5 bitop3:0xa8
    v_perm_b32 v14, v36, v38, s46
    v_bitop3_b32 v47, v36, 0.5, -0.5 bitop3:0xa8
    v_cvt_pk_bf16_f32 v80, v80, v81
    v_cvt_pk_bf16_f32 v81, v82, v83
    ds_wrxchg_rtn_b64 v[74:75], v93, v[80:81]
    v_cvt_pk_bf16_f32 v76, v76, v77
    v_cvt_pk_bf16_f32 v77, v78, v79
    ds_wrxchg_rtn_b64 v[72:73], v92, v[76:77]
    s_setprio 0
    v_mfma_f32_4x4x4_16b_bf16 v[80:83], v[8:9], v[106:107], 0
    v_mfma_f32_4x4x4_16b_bf16 v[76:79], v[8:9], v[104:105], 0
    v_bitop3_b32 v15, v6, v15, v46 bitop3:0xca
    v_bitop3_b32 v14, v6, v14, v47 bitop3:0xca
    s_nop 1
    v_pk_mul_f32 v[80:81], v[80:81], v[14:15] op_sel:[0,1] op_sel_hi:[1,1]
    v_pk_mul_f32 v[82:83], v[82:83], v[14:15] op_sel:[0,1] op_sel_hi:[1,1]
    v_pk_mul_f32 v[76:77], v[76:77], v[14:15] op_sel:[0,0] op_sel_hi:[1,0]
    v_pk_mul_f32 v[78:79], v[78:79], v[14:15] op_sel:[0,0] op_sel_hi:[1,0]
    s_cmp_eq_u32 s35, 3
    s_cbranch_scc1 L2_done
    s_add_u32 s35, s35, 1
    s_add_u32 s42, s42, 1
    s_waitcnt lgkmcnt(2)
    s_branch L2_loop
L2_done:
    s_waitcnt lgkmcnt(0)
    v_cmpx_ne_u64 vcc, v[74:75], v[70:71]
    s_and_b64 s[82:83], vcc, s[80:81]
    s_cbranch_scc1 L2_c77
L2_d77:
    v_mov_b64 v[84:85], v[70:71]
    v_mov_b32 v7, v93
    v_mov_b64 v[86:87], v[74:75]
    s_mov_b64 exec, -1
    s_or_b64 s[80:81], s[80:81], vcc
    v_cmpx_ne_u64 vcc, v[72:73], v[68:69]
    s_and_b64 s[82:83], vcc, s[80:81]
    s_cbranch_scc1 L2_c78
L2_d78:
    v_mov_b64 v[84:85], v[68:69]
    v_mov_b32 v7, v92
    v_mov_b64 v[86:87], v[72:73]
    s_mov_b64 exec, -1
    s_or_b64 s[80:81], s[80:81], vcc
    ds_read_b64 v[70:71], v95
    ds_read_b64 v[68:69], v94
    s_waitcnt lgkmcnt(0)
    v_mfma_f32_4x4x4_16b_bf16 v[80:83], v[10:11], v[70:71], v[80:83]
    v_mfma_f32_4x4x4_16b_bf16 v[76:79], v[10:11], v[68:69], v[76:79]
    s_nop 3
    v_cvt_pk_bf16_f32 v80, v80, v81
    v_cvt_pk_bf16_f32 v81, v82, v83
    ds_wrxchg_rtn_b64 v[74:75], v95, v[80:81]
    v_cvt_pk_bf16_f32 v76, v76, v77
    v_cvt_pk_bf16_f32 v77, v78, v79
    ds_wrxchg_rtn_b64 v[72:73], v94, v[76:77]
    s_waitcnt lgkmcnt(0)
    v_cmpx_ne_u64 vcc, v[74:75], v[70:71]
    s_and_b64 s[82:83], vcc, s[80:81]
    s_cbranch_scc1 L2_c79
L2_d79:
    v_mov_b64 v[84:85], v[70:71]
    v_mov_b32 v7, v95
    v_mov_b64 v[86:87], v[74:75]
    s_mov_b64 exec, -1
    s_or_b64 s[80:81], s[80:81], vcc
    v_cmpx_ne_u64 vcc, v[72:73], v[68:69]
    s_and_b64 s[82:83], vcc, s[80:81]
    s_cbranch_scc1 L2_c80
L2_d80:
    v_mov_b64 v[84:85], v[68:69]
    v_mov_b32 v7, v94
    v_mov_b64 v[86:87], v[72:73]
    s_mov_b64 exec, -1
    s_or_b64 s[80:81], s[80:81], vcc
    s_mov_b64 exec, s[80:81]
    s_nop 1
    v_mfma_f32_4x4x4_16b_bf16 v[88:91], v[12:13], v[84:85], 0
    s_nop 1
    v_mfma_f32_4x4x4_16b_bf16 v[88:91], v[10:11], v[86:87], v[88:91]
    s_nop 4
    v_cvt_pk_bf16_f32 v88, v88, v89
    v_cvt_pk_bf16_f32 v89, v90, v91
    ds_pk_add_bf16 v7, v88
    ds_pk_add_bf16 v7, v89 offset:4
    s_mov_b64 exec, -1
    s_lshl_b32 s3, s32, 12
    s_add_u32 s3, s3, 80000
    s_waitcnt vmcnt(0) lgkmcnt(0)
    s_barrier
    v_subrev_u32 v16, s3, v3
    v_add_u32 v17, 16384, v16
    v_add_u32 v18, 32768, v16
    v_add_u32 v19, 49152, v16
    v_add_u32 v20, 65536, v16
    ds_read_b128 v[48:51], v16
    ds_read_b128 v[52:55], v17
    ds_read_b128 v[56:59], v18
    ds_read_b128 v[60:63], v19
    ds_read_b128 v[64:67], v20
    s_waitcnt lgkmcnt(4)
    buffer_store_dwordx4 v[48:51], v16, s[20:23], 0 offen sc1
    s_waitcnt lgkmcnt(3)
    buffer_store_dwordx4 v[52:55], v17, s[20:23], 0 offen sc1
    s_waitcnt lgkmcnt(2)
    buffer_store_dwordx4 v[56:59], v18, s[20:23], 0 offen sc1
    s_waitcnt lgkmcnt(1)
    buffer_store_dwordx4 v[60:63], v19, s[20:23], 0 offen sc1
    s_waitcnt lgkmcnt(0)
    buffer_store_dwordx4 v[64:67], v20, s[20:23], 0 offen sc1
L2_end:
    s_endpgm
L2_slow:
    s_mul_i32 s50, s32, 80
    s_add_u32 s57, s50, 80
    s_and_b32 s3, s42, 3
    s_lshl_b32 s53, s3, 3
    s_add_u32 s53, s53, s39
    s_and_b32 s3, s35, 2
    s_lshl_b32 s3, s3, 1
    s_add_u32 s53, s53, s3
    s_and_b32 s54, s35, 1
    s_lshl_b32 s54, s54, 4
L2_sl_seg:
    s_mul_i32 s56, s50, 173056
    s_add_u32 s3, s56, s53
    s_add_u32 s55, s3, 32
    s_buffer_load_dword s51, s[12:15], s3
    s_buffer_load_dword s52, s[12:15], s55
    s_waitcnt lgkmcnt(0)
    s_lshr_b32 s51, s51, s54
    s_and_b32 s51, s51, 0xffff
    s_lshr_b32 s52, s52, s54
    s_and_b32 s52, s52, 0xffff
L2_sl_rec:
    s_cmp_ge_u32 s51, s52
    s_cbranch_scc1 L2_sl_next
    v_mbcnt_lo_u32_b32 v102, -1, 0
    v_mbcnt_hi_u32_b32 v102, -1, v102
    v_add_u32 v102, s51, v102
    v_and_b32 v103, -4, v102
    v_lshl_add_u32 v104, v102, 2, v103
    v_lshl_add_u32 v105, v103, 2, v102
    v_cmp_gt_u32 vcc, s52, v102
    s_mov_b64 exec, vcc
    buffer_load_dword v106, v104, s[8:11], s56 offen
    buffer_load_ubyte v107, v105, s[8:11], s56 offen offset:16
    s_waitcnt vmcnt(0)
    v_lshrrev_b32 v98, 14, v106
    v_and_b32 v98, v5, v98
    ds_read_b64 v[100:101], v98 offset:63616
    v_perm_b32 v97, v106, v107, s44
    v_and_b32 v96, v5, v106
    v_bitop3_b32 v103, v106, 0.5, -0.5 bitop3:0xa8
    v_bitop3_b32 v97, v6, v97, v103 bitop3:0xca
    s_waitcnt lgkmcnt(0)
    v_mfma_f32_4x4x4_16b_bf16 v[88:91], v[8:9], v[100:101], 0
    s_nop 4
    v_mul_f32 v88, v97, v88
    v_mul_f32 v89, v97, v89
    v_mul_f32 v90, v97, v90
    v_mul_f32 v91, v97, v91
    v_cvt_pk_bf16_f32 v88, v88, v89
    v_cvt_pk_bf16_f32 v89, v90, v91
    ds_pk_add_bf16 v96, v88
    ds_pk_add_bf16 v96, v89 offset:4
    s_mov_b64 exec, -1
    s_add_u32 s51, s51, 64
    s_branch L2_sl_rec
L2_sl_next:
    s_add_u32 s50, s50, 1
    s_cmp_lt_u32 s50, s57
    s_cbranch_scc1 L2_sl_seg
    s_waitcnt lgkmcnt(0)
    s_and_b32 s3, s42, 3
    s_cmp_eq_u32 s3, 0
    s_cbranch_scc1 L2_ret0
    s_cmp_eq_u32 s3, 1
    s_cbranch_scc1 L2_ret1
    s_cmp_eq_u32 s3, 2
    s_cbranch_scc1 L2_ret2
    s_branch L2_ret3
L2_xo1:
    v_cmp_lt_u32 vcc, 20, v99
    s_mov_b32 s43, 1
    s_cbranch_vccz L2_xp1
    v_cmp_lt_u32 vcc, 28, v99
    s_mov_b32 s43, 2
    s_cbranch_vccz L2_xp1
    s_mov_b32 s37, 0x10000
    s_branch L2_xp1
L2_xa2:
    s_cmp_eq_u32 s43, 1
    s_cbranch_scc1 L2_xc2
    v_lshlrev_b32 v89, 4, v96
    v_add_u32 v90, 120, v97
    v_bitop3_b32 v90, v89, v45, v90 bitop3:0x6a
    ds_write_b32 v98, v90 offset:24
    v_lshlrev_b32 v89, 8, v96
    v_add_u32 v90, 100, v97
    v_bitop3_b32 v90, v89, v45, v90 bitop3:0x6a
    ds_write_b32 v98, v90 offset:20
L2_xc2:
    v_lshlrev_b32 v89, 12, v96
    v_add_u32 v90, 80, v97
    v_bitop3_b32 v90, v89, v45, v90 bitop3:0x6a
    ds_write_b32 v98, v90 offset:16
    s_branch L2_xb2
L2_xe2:
    v_cmp_lt_u32 vcc, 31, v99
    v_lshrrev_b32 v89, 16, v96
    v_add_u32 v97, 80, v97
    s_cbranch_vccnz L2_xs2
    v_lshlrev_b32 v89, v1, v89
    v_and_b32 v89, v45, v89
    v_cmp_ne_u32 vcc, 0, v89
    v_xor_b32 v90, v97, v89
    s_add_u32 s3, s37, s38
    v_mbcnt_lo_u32_b32 v98, vcc_lo, 0
    v_mbcnt_hi_u32_b32 v98, vcc_hi, v98
    s_bcnt1_i32_b64 s41, vcc
    v_lshl_add_u32 v98, v98, 2, s3
    s_mov_b64 exec, vcc
    ds_write_b32 v98, v90
    s_mov_b64 exec, -1
    s_lshl2_add_u32 s37, s41, s37
    s_branch L2_xr2
L2_xf2:
    s_waitcnt lgkmcnt(0)
    s_cmp_gt_u32 s37, 1024
    s_cbranch_scc1 L2_xs2
    v_mov_b32 v43, -1
    s_cmp_ge_u32 s37, 512
    s_cbranch_scc1 L2_xg2
    v_mov_b32 v42, -1
    s_cmp_ge_u32 s37, 256
    s_cbranch_scc1 L2_xg2
    v_mov_b32 v41, -1
    s_branch L2_xg2
L2_xs2:
    s_waitcnt lgkmcnt(0)
    v_mov_b32 v40, -1
    v_mov_b32 v41, -1
    v_mov_b32 v42, -1
    v_mov_b32 v43, -1
    s_add_u32 s3, s42, 0
    s_bitset1_b32 s36, s3
    s_branch L2_xg2
L2_xo3:
    v_cmp_lt_u32 vcc, 20, v99
    s_mov_b32 s43, 1
    s_cbranch_vccz L2_xp3
    v_cmp_lt_u32 vcc, 28, v99
    s_mov_b32 s43, 2
    s_cbranch_vccz L2_xp3
    s_mov_b32 s37, 0x10000
    s_branch L2_xp3
L2_xa4:
    s_cmp_eq_u32 s43, 1
    s_cbranch_scc1 L2_xc4
    v_lshlrev_b32 v89, 4, v96
    v_add_u32 v90, 120, v97
    v_bitop3_b32 v90, v89, v45, v90 bitop3:0x6a
    ds_write_b32 v98, v90 offset:24
    v_lshlrev_b32 v89, 8, v96
    v_add_u32 v90, 100, v97
    v_bitop3_b32 v90, v89, v45, v90 bitop3:0x6a
    ds_write_b32 v98, v90 offset:20
L2_xc4:
    v_lshlrev_b32 v89, 12, v96
    v_add_u32 v90, 80, v97
    v_bitop3_b32 v90, v89, v45, v90 bitop3:0x6a
    ds_write_b32 v98, v90 offset:16
    s_branch L2_xb4
L2_xe4:
    v_cmp_lt_u32 vcc, 31, v99
    v_lshrrev_b32 v89, 16, v96
    v_add_u32 v97, 80, v97
    s_cbranch_vccnz L2_xs4
    v_lshlrev_b32 v89, v1, v89
    v_and_b32 v89, v45, v89
    v_cmp_ne_u32 vcc, 0, v89
    v_xor_b32 v90, v97, v89
    s_add_u32 s3, s37, s38
    v_mbcnt_lo_u32_b32 v98, vcc_lo, 0
    v_mbcnt_hi_u32_b32 v98, vcc_hi, v98
    s_bcnt1_i32_b64 s41, vcc
    v_lshl_add_u32 v98, v98, 2, s3
    s_mov_b64 exec, vcc
    ds_write_b32 v98, v90
    s_mov_b64 exec, -1
    s_lshl2_add_u32 s37, s41, s37
    s_branch L2_xr4
L2_xf4:
    s_waitcnt lgkmcnt(0)
    s_cmp_gt_u32 s37, 1024
    s_cbranch_scc1 L2_xs4
    v_mov_b32 v43, -1
    s_cmp_ge_u32 s37, 512
    s_cbranch_scc1 L2_xg4
    v_mov_b32 v42, -1
    s_cmp_ge_u32 s37, 256
    s_cbranch_scc1 L2_xg4
    v_mov_b32 v41, -1
    s_branch L2_xg4
L2_xs4:
    s_waitcnt lgkmcnt(0)
    v_mov_b32 v40, -1
    v_mov_b32 v41, -1
    v_mov_b32 v42, -1
    v_mov_b32 v43, -1
    s_add_u32 s3, s42, 1
    s_bitset1_b32 s36, s3
    s_branch L2_xg4
L2_c5:
    s_mov_b64 exec, s[82:83]
    s_nop 1
    v_mfma_f32_4x4x4_16b_bf16 v[88:91], v[12:13], v[84:85], 0
    s_nop 1
    v_mfma_f32_4x4x4_16b_bf16 v[88:91], v[10:11], v[86:87], v[88:91]
    s_nop 4
    v_cvt_pk_bf16_f32 v88, v88, v89
    v_cvt_pk_bf16_f32 v89, v90, v91
    ds_pk_add_bf16 v7, v88
    ds_pk_add_bf16 v7, v89 offset:4
    s_mov_b64 exec, vcc
    s_branch L2_d5
L2_c6:
    s_mov_b64 exec, s[82:83]
    s_nop 1
    v_mfma_f32_4x4x4_16b_bf16 v[88:91], v[12:13], v[84:85], 0
    s_nop 1
    v_mfma_f32_4x4x4_16b_bf16 v[88:91], v[10:11], v[86:87], v[88:91]
    s_nop 4
    v_cvt_pk_bf16_f32 v88, v88, v89
    v_cvt_pk_bf16_f32 v89, v90, v91
    ds_pk_add_bf16 v7, v88
    ds_pk_add_bf16 v7, v89 offset:4
    s_mov_b64 exec, vcc
    s_branch L2_d6
L2_c7:
    s_mov_b64 exec, s[82:83]
    s_nop 1
    v_mfma_f32_4x4x4_16b_bf16 v[88:91], v[12:13], v[84:85], 0
    s_nop 1
    v_mfma_f32_4x4x4_16b_bf16 v[88:91], v[10:11], v[86:87], v[88:91]
    s_nop 4
    v_cvt_pk_bf16_f32 v88, v88, v89
    v_cvt_pk_bf16_f32 v89, v90, v91
    ds_pk_add_bf16 v7, v88
    ds_pk_add_bf16 v7, v89 offset:4
    s_mov_b64 exec, vcc
    s_branch L2_d7
L2_c8:
    s_mov_b64 exec, s[82:83]
    s_nop 1
    v_mfma_f32_4x4x4_16b_bf16 v[88:91], v[12:13], v[84:85], 0
    s_nop 1
    v_mfma_f32_4x4x4_16b_bf16 v[88:91], v[10:11], v[86:87], v[88:91]
    s_nop 4
    v_cvt_pk_bf16_f32 v88, v88, v89
    v_cvt_pk_bf16_f32 v89, v90, v91
    ds_pk_add_bf16 v7, v88
    ds_pk_add_bf16 v7, v89 offset:4
    s_mov_b64 exec, vcc
    s_branch L2_d8
L2_c9:
    s_mov_b64 exec, s[82:83]
    s_nop 1
    v_mfma_f32_4x4x4_16b_bf16 v[88:91], v[12:13], v[84:85], 0
    s_nop 1
    v_mfma_f32_4x4x4_16b_bf16 v[88:91], v[10:11], v[86:87], v[88:91]
    s_nop 4
    v_cvt_pk_bf16_f32 v88, v88, v89
    v_cvt_pk_bf16_f32 v89, v90, v91
    ds_pk_add_bf16 v7, v88
    ds_pk_add_bf16 v7, v89 offset:4
    s_mov_b64 exec, vcc
    s_branch L2_d9
L2_c10:
    s_mov_b64 exec, s[82:83]
    s_nop 1
    v_mfma_f32_4x4x4_16b_bf16 v[88:91], v[12:13], v[84:85], 0
    s_nop 1
    v_mfma_f32_4x4x4_16b_bf16 v[88:91], v[10:11], v[86:87], v[88:91]
    s_nop 4
    v_cvt_pk_bf16_f32 v88, v88, v89
    v_cvt_pk_bf16_f32 v89, v90, v91
    ds_pk_add_bf16 v7, v88
    ds_pk_add_bf16 v7, v89 offset:4
    s_mov_b64 exec, vcc
    s_branch L2_d10
L2_xo11:
    v_cmp_lt_u32 vcc, 20, v99
    s_mov_b32 s43, 1
    s_cbranch_vccz L2_xp11
    v_cmp_lt_u32 vcc, 28, v99
    s_mov_b32 s43, 2
    s_cbranch_vccz L2_xp11
    s_mov_b32 s37, 0x10000
    s_branch L2_xp11
L2_c12:
    s_mov_b64 exec, s[82:83]
    s_nop 1
    v_mfma_f32_4x4x4_16b_bf16 v[88:91], v[12:13], v[84:85], 0
    s_nop 1
    v_mfma_f32_4x4x4_16b_bf16 v[88:91], v[10:11], v[86:87], v[88:91]
    s_nop 4
    v_cvt_pk_bf16_f32 v88, v88, v89
    v_cvt_pk_bf16_f32 v89, v90, v91
    ds_pk_add_bf16 v7, v88
    ds_pk_add_bf16 v7, v89 offset:4
    s_mov_b64 exec, vcc
    s_branch L2_d12
L2_c13:
    s_mov_b64 exec, s[82:83]
    s_nop 1
    v_mfma_f32_4x4x4_16b_bf16 v[88:91], v[12:13], v[84:85], 0
    s_nop 1
    v_mfma_f32_4x4x4_16b_bf16 v[88:91], v[10:11], v[86:87], v[88:91]
    s_nop 4
    v_cvt_pk_bf16_f32 v88, v88, v89
    v_cvt_pk_bf16_f32 v89, v90, v91
    ds_pk_add_bf16 v7, v88
    ds_pk_add_bf16 v7, v89 offset:4
    s_mov_b64 exec, vcc
    s_branch L2_d13
L2_c14:
    s_mov_b64 exec, s[82:83]
    s_nop 1
    v_mfma_f32_4x4x4_16b_bf16 v[88:91], v[12:13], v[84:85], 0
    s_nop 1
    v_mfma_f32_4x4x4_16b_bf16 v[88:91], v[10:11], v[86:87], v[88:91]
    s_nop 4
    v_cvt_pk_bf16_f32 v88, v88, v89
    v_cvt_pk_bf16_f32 v89, v90, v91
    ds_pk_add_bf16 v7, v88
    ds_pk_add_bf16 v7, v89 offset:4
    s_mov_b64 exec, vcc
    s_branch L2_d14
L2_c15:
    s_mov_b64 exec, s[82:83]
    s_nop 1
    v_mfma_f32_4x4x4_16b_bf16 v[88:91], v[12:13], v[84:85], 0
    s_nop 1
    v_mfma_f32_4x4x4_16b_bf16 v[88:91], v[10:11], v[86:87], v[88:91]
    s_nop 4
    v_cvt_pk_bf16_f32 v88, v88, v89
    v_cvt_pk_bf16_f32 v89, v90, v91
    ds_pk_add_bf16 v7, v88
    ds_pk_add_bf16 v7, v89 offset:4
    s_mov_b64 exec, vcc
    s_branch L2_d15
L2_c16:
    s_mov_b64 exec, s[82:83]
    s_nop 1
    v_mfma_f32_4x4x4_16b_bf16 v[88:91], v[12:13], v[84:85], 0
    s_nop 1
    v_mfma_f32_4x4x4_16b_bf16 v[88:91], v[10:11], v[86:87], v[88:91]
    s_nop 4
    v_cvt_pk_bf16_f32 v88, v88, v89
    v_cvt_pk_bf16_f32 v89, v90, v91
    ds_pk_add_bf16 v7, v88
    ds_pk_add_bf16 v7, v89 offset:4
    s_mov_b64 exec, vcc
    s_branch L2_d16
L2_c17:
    s_mov_b64 exec, s[82:83]
    s_nop 1
    v_mfma_f32_4x4x4_16b_bf16 v[88:91], v[12:13], v[84:85], 0
    s_nop 1
    v_mfma_f32_4x4x4_16b_bf16 v[88:91], v[10:11], v[86:87], v[88:91]
    s_nop 4
    v_cvt_pk_bf16_f32 v88, v88, v89
    v_cvt_pk_bf16_f32 v89, v90, v91
    ds_pk_add_bf16 v7, v88
    ds_pk_add_bf16 v7, v89 offset:4
    s_mov_b64 exec, vcc
    s_branch L2_d17
L2_c18:
    s_mov_b64 exec, s[82:83]
    s_nop 1
    v_mfma_f32_4x4x4_16b_bf16 v[88:91], v[12:13], v[84:85], 0
    s_nop 1
    v_mfma_f32_4x4x4_16b_bf16 v[88:91], v[10:11], v[86:87], v[88:91]
    s_nop 4
    v_cvt_pk_bf16_f32 v88, v88, v89
    v_cvt_pk_bf16_f32 v89, v90, v91
    ds_pk_add_bf16 v7, v88
    ds_pk_add_bf16 v7, v89 offset:4
    s_mov_b64 exec, vcc
    s_branch L2_d18
L2_c19:
    s_mov_b64 exec, s[82:83]
    s_nop 1
    v_mfma_f32_4x4x4_16b_bf16 v[88:91], v[12:13], v[84:85], 0
    s_nop 1
    v_mfma_f32_4x4x4_16b_bf16 v[88:91], v[10:11], v[86:87], v[88:91]
    s_nop 4
    v_cvt_pk_bf16_f32 v88, v88, v89
    v_cvt_pk_bf16_f32 v89, v90, v91
    ds_pk_add_bf16 v7, v88
    ds_pk_add_bf16 v7, v89 offset:4
    s_mov_b64 exec, vcc
    s_branch L2_d19
L2_xa20:
    s_cmp_eq_u32 s43, 1
    s_cbranch_scc1 L2_xc20
    v_lshlrev_b32 v89, 4, v96
    v_add_u32 v90, 120, v97
    v_bitop3_b32 v90, v89, v45, v90 bitop3:0x6a
    ds_write_b32 v98, v90 offset:24
    v_lshlrev_b32 v89, 8, v96
    v_add_u32 v90, 100, v97
    v_bitop3_b32 v90, v89, v45, v90 bitop3:0x6a
    ds_write_b32 v98, v90 offset:20
L2_xc20:
    v_lshlrev_b32 v89, 12, v96
    v_add_u32 v90, 80, v97
    v_bitop3_b32 v90, v89, v45, v90 bitop3:0x6a
    ds_write_b32 v98, v90 offset:16
    s_branch L2_xb20
L2_xe20:
    v_cmp_lt_u32 vcc, 31, v99
    v_lshrrev_b32 v89, 16, v96
    v_add_u32 v97, 80, v97
    s_cbranch_vccnz L2_xs20
    v_lshlrev_b32 v89, v1, v89
    v_and_b32 v89, v45, v89
    v_cmp_ne_u32 vcc, 0, v89
    v_xor_b32 v90, v97, v89
    s_add_u32 s3, s37, s38
    v_mbcnt_lo_u32_b32 v98, vcc_lo, 0
    v_mbcnt_hi_u32_b32 v98, vcc_hi, v98
    s_bcnt1_i32_b64 s41, vcc
    v_lshl_add_u32 v98, v98, 2, s3
    s_mov_b64 exec, vcc
    ds_write_b32 v98, v90
    s_mov_b64 exec, -1
    s_lshl2_add_u32 s37, s41, s37
    s_branch L2_xr20
L2_xf20:
    s_waitcnt lgkmcnt(0)
    s_cmp_gt_u32 s37, 1024
    s_cbranch_scc1 L2_xs20
    v_mov_b32 v43, -1
    s_cmp_ge_u32 s37, 512
    s_cbranch_scc1 L2_xg20
    v_mov_b32 v42, -1
    s_cmp_ge_u32 s37, 256
    s_cbranch_scc1 L2_xg20
    v_mov_b32 v41, -1
    s_branch L2_xg20
L2_xs20:
    s_waitcnt lgkmcnt(0)
    v_mov_b32 v40, -1
    v_mov_b32 v41, -1
    v_mov_b32 v42, -1
    v_mov_b32 v43, -1
    s_add_u32 s3, s42, 2
    s_bitset1_b32 s36, s3
    s_branch L2_xg20
L2_c21:
    s_mov_b64 exec, s[82:83]
    s_nop 1
    v_mfma_f32_4x4x4_16b_bf16 v[88:91], v[12:13], v[84:85], 0
    s_nop 1
    v_mfma_f32_4x4x4_16b_bf16 v[88:91], v[10:11], v[86:87], v[88:91]
    s_nop 4
    v_cvt_pk_bf16_f32 v88, v88, v89
    v_cvt_pk_bf16_f32 v89, v90, v91
    ds_pk_add_bf16 v7, v88
    ds_pk_add_bf16 v7, v89 offset:4
    s_mov_b64 exec, vcc
    s_branch L2_d21
L2_c22:
    s_mov_b64 exec, s[82:83]
    s_nop 1
    v_mfma_f32_4x4x4_16b_bf16 v[88:91], v[12:13], v[84:85], 0
    s_nop 1
    v_mfma_f32_4x4x4_16b_bf16 v[88:91], v[10:11], v[86:87], v[88:91]
    s_nop 4
    v_cvt_pk_bf16_f32 v88, v88, v89
    v_cvt_pk_bf16_f32 v89, v90, v91
    ds_pk_add_bf16 v7, v88
    ds_pk_add_bf16 v7, v89 offset:4
    s_mov_b64 exec, vcc
    s_branch L2_d22
L2_c23:
    s_mov_b64 exec, s[82:83]
    s_nop 1
    v_mfma_f32_4x4x4_16b_bf16 v[88:91], v[12:13], v[84:85], 0
    s_nop 1
    v_mfma_f32_4x4x4_16b_bf16 v[88:91], v[10:11], v[86:87], v[88:91]
    s_nop 4
    v_cvt_pk_bf16_f32 v88, v88, v89
    v_cvt_pk_bf16_f32 v89, v90, v91
    ds_pk_add_bf16 v7, v88
    ds_pk_add_bf16 v7, v89 offset:4
    s_mov_b64 exec, vcc
    s_branch L2_d23
L2_c24:
    s_mov_b64 exec, s[82:83]
    s_nop 1
    v_mfma_f32_4x4x4_16b_bf16 v[88:91], v[12:13], v[84:85], 0
    s_nop 1
    v_mfma_f32_4x4x4_16b_bf16 v[88:91], v[10:11], v[86:87], v[88:91]
    s_nop 4
    v_cvt_pk_bf16_f32 v88, v88, v89
    v_cvt_pk_bf16_f32 v89, v90, v91
    ds_pk_add_bf16 v7, v88
    ds_pk_add_bf16 v7, v89 offset:4
    s_mov_b64 exec, vcc
    s_branch L2_d24
L2_c25:
    s_mov_b64 exec, s[82:83]
    s_nop 1
    v_mfma_f32_4x4x4_16b_bf16 v[88:91], v[12:13], v[84:85], 0
    s_nop 1
    v_mfma_f32_4x4x4_16b_bf16 v[88:91], v[10:11], v[86:87], v[88:91]
    s_nop 4
    v_cvt_pk_bf16_f32 v88, v88, v89
    v_cvt_pk_bf16_f32 v89, v90, v91
    ds_pk_add_bf16 v7, v88
    ds_pk_add_bf16 v7, v89 offset:4
    s_mov_b64 exec, vcc
    s_branch L2_d25
L2_c26:
    s_mov_b64 exec, s[82:83]
    s_nop 1
    v_mfma_f32_4x4x4_16b_bf16 v[88:91], v[12:13], v[84:85], 0
    s_nop 1
    v_mfma_f32_4x4x4_16b_bf16 v[88:91], v[10:11], v[86:87], v[88:91]
    s_nop 4
    v_cvt_pk_bf16_f32 v88, v88, v89
    v_cvt_pk_bf16_f32 v89, v90, v91
    ds_pk_add_bf16 v7, v88
    ds_pk_add_bf16 v7, v89 offset:4
    s_mov_b64 exec, vcc
    s_branch L2_d26
L2_c27:
    s_mov_b64 exec, s[82:83]
    s_nop 1
    v_mfma_f32_4x4x4_16b_bf16 v[88:91], v[12:13], v[84:85], 0
    s_nop 1
    v_mfma_f32_4x4x4_16b_bf16 v[88:91], v[10:11], v[86:87], v[88:91]
    s_nop 4
    v_cvt_pk_bf16_f32 v88, v88, v89
    v_cvt_pk_bf16_f32 v89, v90, v91
    ds_pk_add_bf16 v7, v88
    ds_pk_add_bf16 v7, v89 offset:4
    s_mov_b64 exec, vcc
    s_branch L2_d27
L2_c28:
    s_mov_b64 exec, s[82:83]
    s_nop 1
    v_mfma_f32_4x4x4_16b_bf16 v[88:91], v[12:13], v[84:85], 0
    s_nop 1
    v_mfma_f32_4x4x4_16b_bf16 v[88:91], v[10:11], v[86:87], v[88:91]
    s_nop 4
    v_cvt_pk_bf16_f32 v88, v88, v89
    v_cvt_pk_bf16_f32 v89, v90, v91
    ds_pk_add_bf16 v7, v88
    ds_pk_add_bf16 v7, v89 offset:4
    s_mov_b64 exec, vcc
    s_branch L2_d28
L2_xo29:
    v_cmp_lt_u32 vcc, 20, v99
    s_mov_b32 s43, 1
    s_cbranch_vccz L2_xp29
    v_cmp_lt_u32 vcc, 28, v99
    s_mov_b32 s43, 2
    s_cbranch_vccz L2_xp29
    s_mov_b32 s37, 0x10000
    s_branch L2_xp29
L2_c30:
    s_mov_b64 exec, s[82:83]
    s_nop 1
    v_mfma_f32_4x4x4_16b_bf16 v[88:91], v[12:13], v[84:85], 0
    s_nop 1
    v_mfma_f32_4x4x4_16b_bf16 v[88:91], v[10:11], v[86:87], v[88:91]
    s_nop 4
    v_cvt_pk_bf16_f32 v88, v88, v89
    v_cvt_pk_bf16_f32 v89, v90, v91
    ds_pk_add_bf16 v7, v88
    ds_pk_add_bf16 v7, v89 offset:4
    s_mov_b64 exec, vcc
    s_branch L2_d30
L2_c31:
    s_mov_b64 exec, s[82:83]
    s_nop 1
    v_mfma_f32_4x4x4_16b_bf16 v[88:91], v[12:13], v[84:85], 0
    s_nop 1
    v_mfma_f32_4x4x4_16b_bf16 v[88:91], v[10:11], v[86:87], v[88:91]
    s_nop 4
    v_cvt_pk_bf16_f32 v88, v88, v89
    v_cvt_pk_bf16_f32 v89, v90, v91
    ds_pk_add_bf16 v7, v88
    ds_pk_add_bf16 v7, v89 offset:4
    s_mov_b64 exec, vcc
    s_branch L2_d31
L2_c32:
    s_mov_b64 exec, s[82:83]
    s_nop 1
    v_mfma_f32_4x4x4_16b_bf16 v[88:91], v[12:13], v[84:85], 0
    s_nop 1
    v_mfma_f32_4x4x4_16b_bf16 v[88:91], v[10:11], v[86:87], v[88:91]
    s_nop 4
    v_cvt_pk_bf16_f32 v88, v88, v89
    v_cvt_pk_bf16_f32 v89, v90, v91
    ds_pk_add_bf16 v7, v88
    ds_pk_add_bf16 v7, v89 offset:4
    s_mov_b64 exec, vcc
    s_branch L2_d32
L2_c33:
    s_mov_b64 exec, s[82:83]
    s_nop 1
    v_mfma_f32_4x4x4_16b_bf16 v[88:91], v[12:13], v[84:85], 0
    s_nop 1
    v_mfma_f32_4x4x4_16b_bf16 v[88:91], v[10:11], v[86:87], v[88:91]
    s_nop 4
    v_cvt_pk_bf16_f32 v88, v88, v89
    v_cvt_pk_bf16_f32 v89, v90, v91
    ds_pk_add_bf16 v7, v88
    ds_pk_add_bf16 v7, v89 offset:4
    s_mov_b64 exec, vcc
    s_branch L2_d33
L2_c34:
    s_mov_b64 exec, s[82:83]
    s_nop 1
    v_mfma_f32_4x4x4_16b_bf16 v[88:91], v[12:13], v[84:85], 0
    s_nop 1
    v_mfma_f32_4x4x4_16b_bf16 v[88:91], v[10:11], v[86:87], v[88:91]
    s_nop 4
    v_cvt_pk_bf16_f32 v88, v88, v89
    v_cvt_pk_bf16_f32 v89, v90, v91
    ds_pk_add_bf16 v7, v88
    ds_pk_add_bf16 v7, v89 offset:4
    s_mov_b64 exec, vcc
    s_branch L2_d34
L2_c35:
    s_mov_b64 exec, s[82:83]
    s_nop 1
    v_mfma_f32_4x4x4_16b_bf16 v[88:91], v[12:13], v[84:85], 0
    s_nop 1
    v_mfma_f32_4x4x4_16b_bf16 v[88:91], v[10:11], v[86:87], v[88:91]
    s_nop 4
    v_cvt_pk_bf16_f32 v88, v88, v89
    v_cvt_pk_bf16_f32 v89, v90, v91
    ds_pk_add_bf16 v7, v88
    ds_pk_add_bf16 v7, v89 offset:4
    s_mov_b64 exec, vcc
    s_branch L2_d35
L2_c36:
    s_mov_b64 exec, s[82:83]
    s_nop 1
    v_mfma_f32_4x4x4_16b_bf16 v[88:91], v[12:13], v[84:85], 0
    s_nop 1
    v_mfma_f32_4x4x4_16b_bf16 v[88:91], v[10:11], v[86:87], v[88:91]
    s_nop 4
    v_cvt_pk_bf16_f32 v88, v88, v89
    v_cvt_pk_bf16_f32 v89, v90, v91
    ds_pk_add_bf16 v7, v88
    ds_pk_add_bf16 v7, v89 offset:4
    s_mov_b64 exec, vcc
    s_branch L2_d36
L2_c37:
    s_mov_b64 exec, s[82:83]
    s_nop 1
    v_mfma_f32_4x4x4_16b_bf16 v[88:91], v[12:13], v[84:85], 0
    s_nop 1
    v_mfma_f32_4x4x4_16b_bf16 v[88:91], v[10:11], v[86:87], v[88:91]
    s_nop 4
    v_cvt_pk_bf16_f32 v88, v88, v89
    v_cvt_pk_bf16_f32 v89, v90, v91
    ds_pk_add_bf16 v7, v88
    ds_pk_add_bf16 v7, v89 offset:4
    s_mov_b64 exec, vcc
    s_branch L2_d37
L2_xa38:
    s_cmp_eq_u32 s43, 1
    s_cbranch_scc1 L2_xc38
    v_lshlrev_b32 v89, 4, v96
    v_add_u32 v90, 120, v97
    v_bitop3_b32 v90, v89, v45, v90 bitop3:0x6a
    ds_write_b32 v98, v90 offset:24
    v_lshlrev_b32 v89, 8, v96
    v_add_u32 v90, 100, v97
    v_bitop3_b32 v90, v89, v45, v90 bitop3:0x6a
    ds_write_b32 v98, v90 offset:20
L2_xc38:
    v_lshlrev_b32 v89, 12, v96
    v_add_u32 v90, 80, v97
    v_bitop3_b32 v90, v89, v45, v90 bitop3:0x6a
    ds_write_b32 v98, v90 offset:16
    s_branch L2_xb38
L2_xe38:
    v_cmp_lt_u32 vcc, 31, v99
    v_lshrrev_b32 v89, 16, v96
    v_add_u32 v97, 80, v97
    s_cbranch_vccnz L2_xs38
    v_lshlrev_b32 v89, v1, v89
    v_and_b32 v89, v45, v89
    v_cmp_ne_u32 vcc, 0, v89
    v_xor_b32 v90, v97, v89
    s_add_u32 s3, s37, s38
    v_mbcnt_lo_u32_b32 v98, vcc_lo, 0
    v_mbcnt_hi_u32_b32 v98, vcc_hi, v98
    s_bcnt1_i32_b64 s41, vcc
    v_lshl_add_u32 v98, v98, 2, s3
    s_mov_b64 exec, vcc
    ds_write_b32 v98, v90
    s_mov_b64 exec, -1
    s_lshl2_add_u32 s37, s41, s37
    s_branch L2_xr38
L2_xf38:
    s_waitcnt lgkmcnt(0)
    s_cmp_gt_u32 s37, 1024
    s_cbranch_scc1 L2_xs38
    v_mov_b32 v43, -1
    s_cmp_ge_u32 s37, 512
    s_cbranch_scc1 L2_xg38
    v_mov_b32 v42, -1
    s_cmp_ge_u32 s37, 256
    s_cbranch_scc1 L2_xg38
    v_mov_b32 v41, -1
    s_branch L2_xg38
L2_xs38:
    s_waitcnt lgkmcnt(0)
    v_mov_b32 v40, -1
    v_mov_b32 v41, -1
    v_mov_b32 v42, -1
    v_mov_b32 v43, -1
    s_add_u32 s3, s42, 2
    s_bitset1_b32 s36, s3
    s_branch L2_xg38
L2_c39:
    s_mov_b64 exec, s[82:83]
    s_nop 1
    v_mfma_f32_4x4x4_16b_bf16 v[88:91], v[12:13], v[84:85], 0
    s_nop 1
    v_mfma_f32_4x4x4_16b_bf16 v[88:91], v[10:11], v[86:87], v[88:91]
    s_nop 4
    v_cvt_pk_bf16_f32 v88, v88, v89
    v_cvt_pk_bf16_f32 v89, v90, v91
    ds_pk_add_bf16 v7, v88
    ds_pk_add_bf16 v7, v89 offset:4
    s_mov_b64 exec, vcc
    s_branch L2_d39
L2_c40:
    s_mov_b64 exec, s[82:83]
    s_nop 1
    v_mfma_f32_4x4x4_16b_bf16 v[88:91], v[12:13], v[84:85], 0
    s_nop 1
    v_mfma_f32_4x4x4_16b_bf16 v[88:91], v[10:11], v[86:87], v[88:91]
    s_nop 4
    v_cvt_pk_bf16_f32 v88, v88, v89
    v_cvt_pk_bf16_f32 v89, v90, v91
    ds_pk_add_bf16 v7, v88
    ds_pk_add_bf16 v7, v89 offset:4
    s_mov_b64 exec, vcc
    s_branch L2_d40
L2_c41:
    s_mov_b64 exec, s[82:83]
    s_nop 1
    v_mfma_f32_4x4x4_16b_bf16 v[88:91], v[12:13], v[84:85], 0
    s_nop 1
    v_mfma_f32_4x4x4_16b_bf16 v[88:91], v[10:11], v[86:87], v[88:91]
    s_nop 4
    v_cvt_pk_bf16_f32 v88, v88, v89
    v_cvt_pk_bf16_f32 v89, v90, v91
    ds_pk_add_bf16 v7, v88
    ds_pk_add_bf16 v7, v89 offset:4
    s_mov_b64 exec, vcc
    s_branch L2_d41
L2_c42:
    s_mov_b64 exec, s[82:83]
    s_nop 1
    v_mfma_f32_4x4x4_16b_bf16 v[88:91], v[12:13], v[84:85], 0
    s_nop 1
    v_mfma_f32_4x4x4_16b_bf16 v[88:91], v[10:11], v[86:87], v[88:91]
    s_nop 4
    v_cvt_pk_bf16_f32 v88, v88, v89
    v_cvt_pk_bf16_f32 v89, v90, v91
    ds_pk_add_bf16 v7, v88
    ds_pk_add_bf16 v7, v89 offset:4
    s_mov_b64 exec, vcc
    s_branch L2_d42
L2_c43:
    s_mov_b64 exec, s[82:83]
    s_nop 1
    v_mfma_f32_4x4x4_16b_bf16 v[88:91], v[12:13], v[84:85], 0
    s_nop 1
    v_mfma_f32_4x4x4_16b_bf16 v[88:91], v[10:11], v[86:87], v[88:91]
    s_nop 4
    v_cvt_pk_bf16_f32 v88, v88, v89
    v_cvt_pk_bf16_f32 v89, v90, v91
    ds_pk_add_bf16 v7, v88
    ds_pk_add_bf16 v7, v89 offset:4
    s_mov_b64 exec, vcc
    s_branch L2_d43
L2_c44:
    s_mov_b64 exec, s[82:83]
    s_nop 1
    v_mfma_f32_4x4x4_16b_bf16 v[88:91], v[12:13], v[84:85], 0
    s_nop 1
    v_mfma_f32_4x4x4_16b_bf16 v[88:91], v[10:11], v[86:87], v[88:91]
    s_nop 4
    v_cvt_pk_bf16_f32 v88, v88, v89
    v_cvt_pk_bf16_f32 v89, v90, v91
    ds_pk_add_bf16 v7, v88
    ds_pk_add_bf16 v7, v89 offset:4
    s_mov_b64 exec, vcc
    s_branch L2_d44
L2_c45:
    s_mov_b64 exec, s[82:83]
    s_nop 1
    v_mfma_f32_4x4x4_16b_bf16 v[88:91], v[12:13], v[84:85], 0
    s_nop 1
    v_mfma_f32_4x4x4_16b_bf16 v[88:91], v[10:11], v[86:87], v[88:91]
    s_nop 4
    v_cvt_pk_bf16_f32 v88, v88, v89
    v_cvt_pk_bf16_f32 v89, v90, v91
    ds_pk_add_bf16 v7, v88
    ds_pk_add_bf16 v7, v89 offset:4
    s_mov_b64 exec, vcc
    s_branch L2_d45
L2_c46:
    s_mov_b64 exec, s[82:83]
    s_nop 1
    v_mfma_f32_4x4x4_16b_bf16 v[88:91], v[12:13], v[84:85], 0
    s_nop 1
    v_mfma_f32_4x4x4_16b_bf16 v[88:91], v[10:11], v[86:87], v[88:91]
    s_nop 4
    v_cvt_pk_bf16_f32 v88, v88, v89
    v_cvt_pk_bf16_f32 v89, v90, v91
    ds_pk_add_bf16 v7, v88
    ds_pk_add_bf16 v7, v89 offset:4
    s_mov_b64 exec, vcc
    s_branch L2_d46
L2_xo47:
    v_cmp_lt_u32 vcc, 20, v99
    s_mov_b32 s43, 1
    s_cbranch_vccz L2_xp47
    v_cmp_lt_u32 vcc, 28, v99
    s_mov_b32 s43, 2
    s_cbranch_vccz L2_xp47
    s_mov_b32 s37, 0x10000
    s_branch L2_xp47
L2_c48:
    s_mov_b64 exec, s[82:83]
    s_nop 1
    v_mfma_f32_4x4x4_16b_bf16 v[88:91], v[12:13], v[84:85], 0
    s_nop 1
    v_mfma_f32_4x4x4_16b_bf16 v[88:91], v[10:11], v[86:87], v[88:91]
    s_nop 4
    v_cvt_pk_bf16_f32 v88, v88, v89
    v_cvt_pk_bf16_f32 v89, v90, v91
    ds_pk_add_bf16 v7, v88
    ds_pk_add_bf16 v7, v89 offset:4
    s_mov_b64 exec, vcc
    s_branch L2_d48
L2_c49:
    s_mov_b64 exec, s[82:83]
    s_nop 1
    v_mfma_f32_4x4x4_16b_bf16 v[88:91], v[12:13], v[84:85], 0
    s_nop 1
    v_mfma_f32_4x4x4_16b_bf16 v[88:91], v[10:11], v[86:87], v[88:91]
    s_nop 4
    v_cvt_pk_bf16_f32 v88, v88, v89
    v_cvt_pk_bf16_f32 v89, v90, v91
    ds_pk_add_bf16 v7, v88
    ds_pk_add_bf16 v7, v89 offset:4
    s_mov_b64 exec, vcc
    s_branch L2_d49
L2_c50:
    s_mov_b64 exec, s[82:83]
    s_nop 1
    v_mfma_f32_4x4x4_16b_bf16 v[88:91], v[12:13], v[84:85], 0
    s_nop 1
    v_mfma_f32_4x4x4_16b_bf16 v[88:91], v[10:11], v[86:87], v[88:91]
    s_nop 4
    v_cvt_pk_bf16_f32 v88, v88, v89
    v_cvt_pk_bf16_f32 v89, v90, v91
    ds_pk_add_bf16 v7, v88
    ds_pk_add_bf16 v7, v89 offset:4
    s_mov_b64 exec, vcc
    s_branch L2_d50
L2_c51:
    s_mov_b64 exec, s[82:83]
    s_nop 1
    v_mfma_f32_4x4x4_16b_bf16 v[88:91], v[12:13], v[84:85], 0
    s_nop 1
    v_mfma_f32_4x4x4_16b_bf16 v[88:91], v[10:11], v[86:87], v[88:91]
    s_nop 4
    v_cvt_pk_bf16_f32 v88, v88, v89
    v_cvt_pk_bf16_f32 v89, v90, v91
    ds_pk_add_bf16 v7, v88
    ds_pk_add_bf16 v7, v89 offset:4
    s_mov_b64 exec, vcc
    s_branch L2_d51
L2_c52:
    s_mov_b64 exec, s[82:83]
    s_nop 1
    v_mfma_f32_4x4x4_16b_bf16 v[88:91], v[12:13], v[84:85], 0
    s_nop 1
    v_mfma_f32_4x4x4_16b_bf16 v[88:91], v[10:11], v[86:87], v[88:91]
    s_nop 4
    v_cvt_pk_bf16_f32 v88, v88, v89
    v_cvt_pk_bf16_f32 v89, v90, v91
    ds_pk_add_bf16 v7, v88
    ds_pk_add_bf16 v7, v89 offset:4
    s_mov_b64 exec, vcc
    s_branch L2_d52
L2_c53:
    s_mov_b64 exec, s[82:83]
    s_nop 1
    v_mfma_f32_4x4x4_16b_bf16 v[88:91], v[12:13], v[84:85], 0
    s_nop 1
    v_mfma_f32_4x4x4_16b_bf16 v[88:91], v[10:11], v[86:87], v[88:91]
    s_nop 4
    v_cvt_pk_bf16_f32 v88, v88, v89
    v_cvt_pk_bf16_f32 v89, v90, v91
    ds_pk_add_bf16 v7, v88
    ds_pk_add_bf16 v7, v89 offset:4
    s_mov_b64 exec, vcc
    s_branch L2_d53
L2_c54:
    s_mov_b64 exec, s[82:83]
    s_nop 1
    v_mfma_f32_4x4x4_16b_bf16 v[88:91], v[12:13], v[84:85], 0
    s_nop 1
    v_mfma_f32_4x4x4_16b_bf16 v[88:91], v[10:11], v[86:87], v[88:91]
    s_nop 4
    v_cvt_pk_bf16_f32 v88, v88, v89
    v_cvt_pk_bf16_f32 v89, v90, v91
    ds_pk_add_bf16 v7, v88
    ds_pk_add_bf16 v7, v89 offset:4
    s_mov_b64 exec, vcc
    s_branch L2_d54
L2_c55:
    s_mov_b64 exec, s[82:83]
    s_nop 1
    v_mfma_f32_4x4x4_16b_bf16 v[88:91], v[12:13], v[84:85], 0
    s_nop 1
    v_mfma_f32_4x4x4_16b_bf16 v[88:91], v[10:11], v[86:87], v[88:91]
    s_nop 4
    v_cvt_pk_bf16_f32 v88, v88, v89
    v_cvt_pk_bf16_f32 v89, v90, v91
    ds_pk_add_bf16 v7, v88
    ds_pk_add_bf16 v7, v89 offset:4
    s_mov_b64 exec, vcc
    s_branch L2_d55
L2_xa56:
    s_cmp_eq_u32 s43, 1
    s_cbranch_scc1 L2_xc56
    v_lshlrev_b32 v89, 4, v96
    v_add_u32 v90, 120, v97
    v_bitop3_b32 v90, v89, v45, v90 bitop3:0x6a
    ds_write_b32 v98, v90 offset:24
    v_lshlrev_b32 v89, 8, v96
    v_add_u32 v90, 100, v97
    v_bitop3_b32 v90, v89, v45, v90 bitop3:0x6a
    ds_write_b32 v98, v90 offset:20
L2_xc56:
    v_lshlrev_b32 v89, 12, v96
    v_add_u32 v90, 80, v97
    v_bitop3_b32 v90, v89, v45, v90 bitop3:0x6a
    ds_write_b32 v98, v90 offset:16
    s_branch L2_xb56
L2_xe56:
    v_cmp_lt_u32 vcc, 31, v99
    v_lshrrev_b32 v89, 16, v96
    v_add_u32 v97, 80, v97
    s_cbranch_vccnz L2_xs56
    v_lshlrev_b32 v89, v1, v89
    v_and_b32 v89, v45, v89
    v_cmp_ne_u32 vcc, 0, v89
    v_xor_b32 v90, v97, v89
    s_add_u32 s3, s37, s38
    v_mbcnt_lo_u32_b32 v98, vcc_lo, 0
    v_mbcnt_hi_u32_b32 v98, vcc_hi, v98
    s_bcnt1_i32_b64 s41, vcc
    v_lshl_add_u32 v98, v98, 2, s3
    s_mov_b64 exec, vcc
    ds_write_b32 v98, v90
    s_mov_b64 exec, -1
    s_lshl2_add_u32 s37, s41, s37
    s_branch L2_xr56
L2_xf56:
    s_waitcnt lgkmcnt(0)
    s_cmp_gt_u32 s37, 1024
    s_cbranch_scc1 L2_xs56
    v_mov_b32 v43, -1
    s_cmp_ge_u32 s37, 512
    s_cbranch_scc1 L2_xg56
    v_mov_b32 v42, -1
    s_cmp_ge_u32 s37, 256
    s_cbranch_scc1 L2_xg56
    v_mov_b32 v41, -1
    s_branch L2_xg56
L2_xs56:
    s_waitcnt lgkmcnt(0)
    v_mov_b32 v40, -1
    v_mov_b32 v41, -1
    v_mov_b32 v42, -1
    v_mov_b32 v43, -1
    s_add_u32 s3, s42, 2
    s_bitset1_b32 s36, s3
    s_branch L2_xg56
L2_c57:
    s_mov_b64 exec, s[82:83]
    s_nop 1
    v_mfma_f32_4x4x4_16b_bf16 v[88:91], v[12:13], v[84:85], 0
    s_nop 1
    v_mfma_f32_4x4x4_16b_bf16 v[88:91], v[10:11], v[86:87], v[88:91]
    s_nop 4
    v_cvt_pk_bf16_f32 v88, v88, v89
    v_cvt_pk_bf16_f32 v89, v90, v91
    ds_pk_add_bf16 v7, v88
    ds_pk_add_bf16 v7, v89 offset:4
    s_mov_b64 exec, vcc
    s_branch L2_d57
L2_c58:
    s_mov_b64 exec, s[82:83]
    s_nop 1
    v_mfma_f32_4x4x4_16b_bf16 v[88:91], v[12:13], v[84:85], 0
    s_nop 1
    v_mfma_f32_4x4x4_16b_bf16 v[88:91], v[10:11], v[86:87], v[88:91]
    s_nop 4
    v_cvt_pk_bf16_f32 v88, v88, v89
    v_cvt_pk_bf16_f32 v89, v90, v91
    ds_pk_add_bf16 v7, v88
    ds_pk_add_bf16 v7, v89 offset:4
    s_mov_b64 exec, vcc
    s_branch L2_d58
L2_c59:
    s_mov_b64 exec, s[82:83]
    s_nop 1
    v_mfma_f32_4x4x4_16b_bf16 v[88:91], v[12:13], v[84:85], 0
    s_nop 1
    v_mfma_f32_4x4x4_16b_bf16 v[88:91], v[10:11], v[86:87], v[88:91]
    s_nop 4
    v_cvt_pk_bf16_f32 v88, v88, v89
    v_cvt_pk_bf16_f32 v89, v90, v91
    ds_pk_add_bf16 v7, v88
    ds_pk_add_bf16 v7, v89 offset:4
    s_mov_b64 exec, vcc
    s_branch L2_d59
L2_c60:
    s_mov_b64 exec, s[82:83]
    s_nop 1
    v_mfma_f32_4x4x4_16b_bf16 v[88:91], v[12:13], v[84:85], 0
    s_nop 1
    v_mfma_f32_4x4x4_16b_bf16 v[88:91], v[10:11], v[86:87], v[88:91]
    s_nop 4
    v_cvt_pk_bf16_f32 v88, v88, v89
    v_cvt_pk_bf16_f32 v89, v90, v91
    ds_pk_add_bf16 v7, v88
    ds_pk_add_bf16 v7, v89 offset:4
    s_mov_b64 exec, vcc
    s_branch L2_d60
L2_c61:
    s_mov_b64 exec, s[82:83]
    s_nop 1
    v_mfma_f32_4x4x4_16b_bf16 v[88:91], v[12:13], v[84:85], 0
    s_nop 1
    v_mfma_f32_4x4x4_16b_bf16 v[88:91], v[10:11], v[86:87], v[88:91]
    s_nop 4
    v_cvt_pk_bf16_f32 v88, v88, v89
    v_cvt_pk_bf16_f32 v89, v90, v91
    ds_pk_add_bf16 v7, v88
    ds_pk_add_bf16 v7, v89 offset:4
    s_mov_b64 exec, vcc
    s_branch L2_d61
L2_c62:
    s_mov_b64 exec, s[82:83]
    s_nop 1
    v_mfma_f32_4x4x4_16b_bf16 v[88:91], v[12:13], v[84:85], 0
    s_nop 1
    v_mfma_f32_4x4x4_16b_bf16 v[88:91], v[10:11], v[86:87], v[88:91]
    s_nop 4
    v_cvt_pk_bf16_f32 v88, v88, v89
    v_cvt_pk_bf16_f32 v89, v90, v91
    ds_pk_add_bf16 v7, v88
    ds_pk_add_bf16 v7, v89 offset:4
    s_mov_b64 exec, vcc
    s_branch L2_d62
L2_c63:
    s_mov_b64 exec, s[82:83]
    s_nop 1
    v_mfma_f32_4x4x4_16b_bf16 v[88:91], v[12:13], v[84:85], 0
    s_nop 1
    v_mfma_f32_4x4x4_16b_bf16 v[88:91], v[10:11], v[86:87], v[88:91]
    s_nop 4
    v_cvt_pk_bf16_f32 v88, v88, v89
    v_cvt_pk_bf16_f32 v89, v90, v91
    ds_pk_add_bf16 v7, v88
    ds_pk_add_bf16 v7, v89 offset:4
    s_mov_b64 exec, vcc
    s_branch L2_d63
L2_c64:
    s_mov_b64 exec, s[82:83]
    s_nop 1
    v_mfma_f32_4x4x4_16b_bf16 v[88:91], v[12:13], v[84:85], 0
    s_nop 1
    v_mfma_f32_4x4x4_16b_bf16 v[88:91], v[10:11], v[86:87], v[88:91]
    s_nop 4
    v_cvt_pk_bf16_f32 v88, v88, v89
    v_cvt_pk_bf16_f32 v89, v90, v91
    ds_pk_add_bf16 v7, v88
    ds_pk_add_bf16 v7, v89 offset:4
    s_mov_b64 exec, vcc
    s_branch L2_d64
L2_xo65:
    v_cmp_lt_u32 vcc, 20, v99
    s_mov_b32 s43, 1
    s_cbranch_vccz L2_xp65
    v_cmp_lt_u32 vcc, 28, v99
    s_mov_b32 s43, 2
    s_cbranch_vccz L2_xp65
    s_mov_b32 s37, 0x10000
    s_branch L2_xp65
L2_c66:
    s_mov_b64 exec, s[82:83]
    s_nop 1
    v_mfma_f32_4x4x4_16b_bf16 v[88:91], v[12:13], v[84:85], 0
    s_nop 1
    v_mfma_f32_4x4x4_16b_bf16 v[88:91], v[10:11], v[86:87], v[88:91]
    s_nop 4
    v_cvt_pk_bf16_f32 v88, v88, v89
    v_cvt_pk_bf16_f32 v89, v90, v91
    ds_pk_add_bf16 v7, v88
    ds_pk_add_bf16 v7, v89 offset:4
    s_mov_b64 exec, vcc
    s_branch L2_d66
L2_c67:
    s_mov_b64 exec, s[82:83]
    s_nop 1
    v_mfma_f32_4x4x4_16b_bf16 v[88:91], v[12:13], v[84:85], 0
    s_nop 1
    v_mfma_f32_4x4x4_16b_bf16 v[88:91], v[10:11], v[86:87], v[88:91]
    s_nop 4
    v_cvt_pk_bf16_f32 v88, v88, v89
    v_cvt_pk_bf16_f32 v89, v90, v91
    ds_pk_add_bf16 v7, v88
    ds_pk_add_bf16 v7, v89 offset:4
    s_mov_b64 exec, vcc
    s_branch L2_d67
L2_c68:
    s_mov_b64 exec, s[82:83]
    s_nop 1
    v_mfma_f32_4x4x4_16b_bf16 v[88:91], v[12:13], v[84:85], 0
    s_nop 1
    v_mfma_f32_4x4x4_16b_bf16 v[88:91], v[10:11], v[86:87], v[88:91]
    s_nop 4
    v_cvt_pk_bf16_f32 v88, v88, v89
    v_cvt_pk_bf16_f32 v89, v90, v91
    ds_pk_add_bf16 v7, v88
    ds_pk_add_bf16 v7, v89 offset:4
    s_mov_b64 exec, vcc
    s_branch L2_d68
L2_c69:
    s_mov_b64 exec, s[82:83]
    s_nop 1
    v_mfma_f32_4x4x4_16b_bf16 v[88:91], v[12:13], v[84:85], 0
    s_nop 1
    v_mfma_f32_4x4x4_16b_bf16 v[88:91], v[10:11], v[86:87], v[88:91]
    s_nop 4
    v_cvt_pk_bf16_f32 v88, v88, v89
    v_cvt_pk_bf16_f32 v89, v90, v91
    ds_pk_add_bf16 v7, v88
    ds_pk_add_bf16 v7, v89 offset:4
    s_mov_b64 exec, vcc
    s_branch L2_d69
L2_c70:
    s_mov_b64 exec, s[82:83]
    s_nop 1
    v_mfma_f32_4x4x4_16b_bf16 v[88:91], v[12:13], v[84:85], 0
    s_nop 1
    v_mfma_f32_4x4x4_16b_bf16 v[88:91], v[10:11], v[86:87], v[88:91]
    s_nop 4
    v_cvt_pk_bf16_f32 v88, v88, v89
    v_cvt_pk_bf16_f32 v89, v90, v91
    ds_pk_add_bf16 v7, v88
    ds_pk_add_bf16 v7, v89 offset:4
    s_mov_b64 exec, vcc
    s_branch L2_d70
L2_c71:
    s_mov_b64 exec, s[82:83]
    s_nop 1
    v_mfma_f32_4x4x4_16b_bf16 v[88:91], v[12:13], v[84:85], 0
    s_nop 1
    v_mfma_f32_4x4x4_16b_bf16 v[88:91], v[10:11], v[86:87], v[88:91]
    s_nop 4
    v_cvt_pk_bf16_f32 v88, v88, v89
    v_cvt_pk_bf16_f32 v89, v90, v91
    ds_pk_add_bf16 v7, v88
    ds_pk_add_bf16 v7, v89 offset:4
    s_mov_b64 exec, vcc
    s_branch L2_d71
L2_c72:
    s_mov_b64 exec, s[82:83]
    s_nop 1
    v_mfma_f32_4x4x4_16b_bf16 v[88:91], v[12:13], v[84:85], 0
    s_nop 1
    v_mfma_f32_4x4x4_16b_bf16 v[88:91], v[10:11], v[86:87], v[88:91]
    s_nop 4
    v_cvt_pk_bf16_f32 v88, v88, v89
    v_cvt_pk_bf16_f32 v89, v90, v91
    ds_pk_add_bf16 v7, v88
    ds_pk_add_bf16 v7, v89 offset:4
    s_mov_b64 exec, vcc
    s_branch L2_d72
L2_c73:
    s_mov_b64 exec, s[82:83]
    s_nop 1
    v_mfma_f32_4x4x4_16b_bf16 v[88:91], v[12:13], v[84:85], 0
    s_nop 1
    v_mfma_f32_4x4x4_16b_bf16 v[88:91], v[10:11], v[86:87], v[88:91]
    s_nop 4
    v_cvt_pk_bf16_f32 v88, v88, v89
    v_cvt_pk_bf16_f32 v89, v90, v91
    ds_pk_add_bf16 v7, v88
    ds_pk_add_bf16 v7, v89 offset:4
    s_mov_b64 exec, vcc
    s_branch L2_d73
L2_xa74:
    s_cmp_eq_u32 s43, 1
    s_cbranch_scc1 L2_xc74
    v_lshlrev_b32 v89, 4, v96
    v_add_u32 v90, 120, v97
    v_bitop3_b32 v90, v89, v45, v90 bitop3:0x6a
    ds_write_b32 v98, v90 offset:24
    v_lshlrev_b32 v89, 8, v96
    v_add_u32 v90, 100, v97
    v_bitop3_b32 v90, v89, v45, v90 bitop3:0x6a
    ds_write_b32 v98, v90 offset:20
L2_xc74:
    v_lshlrev_b32 v89, 12, v96
    v_add_u32 v90, 80, v97
    v_bitop3_b32 v90, v89, v45, v90 bitop3:0x6a
    ds_write_b32 v98, v90 offset:16
    s_branch L2_xb74
L2_xe74:
    v_cmp_lt_u32 vcc, 31, v99
    v_lshrrev_b32 v89, 16, v96
    v_add_u32 v97, 80, v97
    s_cbranch_vccnz L2_xs74
    v_lshlrev_b32 v89, v1, v89
    v_and_b32 v89, v45, v89
    v_cmp_ne_u32 vcc, 0, v89
    v_xor_b32 v90, v97, v89
    s_add_u32 s3, s37, s38
    v_mbcnt_lo_u32_b32 v98, vcc_lo, 0
    v_mbcnt_hi_u32_b32 v98, vcc_hi, v98
    s_bcnt1_i32_b64 s41, vcc
    v_lshl_add_u32 v98, v98, 2, s3
    s_mov_b64 exec, vcc
    ds_write_b32 v98, v90
    s_mov_b64 exec, -1
    s_lshl2_add_u32 s37, s41, s37
    s_branch L2_xr74
L2_xf74:
    s_waitcnt lgkmcnt(0)
    s_cmp_gt_u32 s37, 1024
    s_cbranch_scc1 L2_xs74
    v_mov_b32 v43, -1
    s_cmp_ge_u32 s37, 512
    s_cbranch_scc1 L2_xg74
    v_mov_b32 v42, -1
    s_cmp_ge_u32 s37, 256
    s_cbranch_scc1 L2_xg74
    v_mov_b32 v41, -1
    s_branch L2_xg74
L2_xs74:
    s_waitcnt lgkmcnt(0)
    v_mov_b32 v40, -1
    v_mov_b32 v41, -1
    v_mov_b32 v42, -1
    v_mov_b32 v43, -1
    s_add_u32 s3, s42, 2
    s_bitset1_b32 s36, s3
    s_branch L2_xg74
L2_c75:
    s_mov_b64 exec, s[82:83]
    s_nop 1
    v_mfma_f32_4x4x4_16b_bf16 v[88:91], v[12:13], v[84:85], 0
    s_nop 1
    v_mfma_f32_4x4x4_16b_bf16 v[88:91], v[10:11], v[86:87], v[88:91]
    s_nop 4
    v_cvt_pk_bf16_f32 v88, v88, v89
    v_cvt_pk_bf16_f32 v89, v90, v91
    ds_pk_add_bf16 v7, v88
    ds_pk_add_bf16 v7, v89 offset:4
    s_mov_b64 exec, vcc
    s_branch L2_d75
L2_c76:
    s_mov_b64 exec, s[82:83]
    s_nop 1
    v_mfma_f32_4x4x4_16b_bf16 v[88:91], v[12:13], v[84:85], 0
    s_nop 1
    v_mfma_f32_4x4x4_16b_bf16 v[88:91], v[10:11], v[86:87], v[88:91]
    s_nop 4
    v_cvt_pk_bf16_f32 v88, v88, v89
    v_cvt_pk_bf16_f32 v89, v90, v91
    ds_pk_add_bf16 v7, v88
    ds_pk_add_bf16 v7, v89 offset:4
    s_mov_b64 exec, vcc
    s_branch L2_d76
L2_c77:
    s_mov_b64 exec, s[82:83]
    s_nop 1
    v_mfma_f32_4x4x4_16b_bf16 v[88:91], v[12:13], v[84:85], 0
    s_nop 1
    v_mfma_f32_4x4x4_16b_bf16 v[88:91], v[10:11], v[86:87], v[88:91]
    s_nop 4
    v_cvt_pk_bf16_f32 v88, v88, v89
    v_cvt_pk_bf16_f32 v89, v90, v91
    ds_pk_add_bf16 v7, v88
    ds_pk_add_bf16 v7, v89 offset:4
    s_mov_b64 exec, vcc
    s_branch L2_d77
L2_c78:
    s_mov_b64 exec, s[82:83]
    s_nop 1
    v_mfma_f32_4x4x4_16b_bf16 v[88:91], v[12:13], v[84:85], 0
    s_nop 1
    v_mfma_f32_4x4x4_16b_bf16 v[88:91], v[10:11], v[86:87], v[88:91]
    s_nop 4
    v_cvt_pk_bf16_f32 v88, v88, v89
    v_cvt_pk_bf16_f32 v89, v90, v91
    ds_pk_add_bf16 v7, v88
    ds_pk_add_bf16 v7, v89 offset:4
    s_mov_b64 exec, vcc
    s_branch L2_d78
L2_c79:
    s_mov_b64 exec, s[82:83]
    s_nop 1
    v_mfma_f32_4x4x4_16b_bf16 v[88:91], v[12:13], v[84:85], 0
    s_nop 1
    v_mfma_f32_4x4x4_16b_bf16 v[88:91], v[10:11], v[86:87], v[88:91]
    s_nop 4
    v_cvt_pk_bf16_f32 v88, v88, v89
    v_cvt_pk_bf16_f32 v89, v90, v91
    ds_pk_add_bf16 v7, v88
    ds_pk_add_bf16 v7, v89 offset:4
    s_mov_b64 exec, vcc
    s_branch L2_d79
L2_c80:
    s_mov_b64 exec, s[82:83]
    s_nop 1
    v_mfma_f32_4x4x4_16b_bf16 v[88:91], v[12:13], v[84:85], 0
    s_nop 1
    v_mfma_f32_4x4x4_16b_bf16 v[88:91], v[10:11], v[86:87], v[88:91]
    s_nop 4
    v_cvt_pk_bf16_f32 v88, v88, v89
    v_cvt_pk_bf16_f32 v89, v90, v91
    ds_pk_add_bf16 v7, v88
    ds_pk_add_bf16 v7, v89 offset:4
    s_mov_b64 exec, vcc
    s_branch L2_d80
.text
.globl gs_final_kernel
.p2align 8
.type gs_final_kernel,@function
gs_final_kernel:
    s_cmp_ge_u32 s2, 1250
    s_cbranch_scc1 L3_end
    s_load_dwordx2 s[4:5], s[0:1], 0
    s_load_dwordx2 s[6:7], s[0:1], 24
    s_load_dwordx2 s[28:29], s[0:1], 40
    s_load_dwordx2 s[30:31], s[0:1], 88
    s_load_dwordx2 s[32:33], s[0:1], 104
    s_lshl_b32 s3, s2, 8
    v_add_u32 v1, s3, v0
    v_lshlrev_b32 v2, 4, v1
    v_lshlrev_b32 v3, 2, v1
    v_bfe_u32 v4, v1, 3, 6
    s_mov_b32 s3, 80000
    v_mul_lo_u32 v4, v4, s3
    v_lshrrev_b32 v5, 9, v1
    v_lshl_add_u32 v4, v5, 7, v4
    v_and_b32 v5, 7, v1
    v_lshl_add_u32 v4, v5, 4, v4
    v_and_b32 v5, 3, v0
    v_lshlrev_b32 v5, 6, v5
    s_waitcnt lgkmcnt(0)
    s_load_dwordx4 s[36:39], s[28:29], 0
    s_mov_b32 s8, s4
    s_mov_b32 s9, s5
    s_mov_b32 s10, 0x4e2000
    s_mov_b32 s11, 0x20000
    s_mov_b32 s12, s6
    s_mov_b32 s13, s7
    s_mov_b32 s14, 0x138800
    s_mov_b32 s15, 0x20000
    s_mov_b32 s16, s30
    s_mov_b32 s17, s31
    s_mov_b32 s18, 0x4e2000
    s_mov_b32 s19, 0x20000
    s_add_u32 s20, s32, 0xd823000
    s_addc_u32 s21, s33, 0
    s_mov_b32 s22, 0x1388000
    s_mov_b32 s23, 0x20000
    s_add_u32 s24, s32, 0xebab000
    s_addc_u32 s25, s33, 0
    s_mov_b32 s26, 0x100
    s_mov_b32 s27, 0x20000
    buffer_load_dword v6, v3, s[12:15], 0 offen
    buffer_load_dwordx4 v[8:11], v5, s[24:27], 0 offen
    buffer_load_dwordx4 v[12:15], v5, s[24:27], 0 offen offset:16
    buffer_load_dwordx2 v[16:17], v5, s[24:27], 0 offen offset:32
    s_mov_b32 s40, 0
    buffer_load_dwordx4 v[20:23], v4, s[20:23], s40 offen
    s_mov_b32 s41, 5120000
    buffer_load_dwordx4 v[24:27], v4, s[20:23], s41 offen
    s_mov_b32 s42, 10240000
    buffer_load_dwordx4 v[28:31], v4, s[20:23], s42 offen
    s_mov_b32 s43, 15360000
    buffer_load_dwordx4 v[32:35], v4, s[20:23], s43 offen
    buffer_load_dwordx4 v[36:39], v2, s[8:11], 0 offen
    v_and_b32 v7, 3, v0
    v_lshlrev_b32 v7, 4, v7
    v_mov_b32 v18, 0x3f80
    v_mov_b32 v19, 0
    v_lshlrev_b64 v[18:19], v7, v[18:19]
    s_waitcnt lgkmcnt(0)
    s_lshl_b32 s44, s36, 16
    s_and_b32 s45, s36, 0xffff0000
    s_lshl_b32 s46, s37, 16
    s_and_b32 s47, s37, 0xffff0000
    s_lshl_b32 s48, s38, 16
    s_and_b32 s49, s38, 0xffff0000
    s_lshl_b32 s50, s39, 16
    s_and_b32 s51, s39, 0xffff0000
    s_waitcnt vmcnt(8)
    v_lshlrev_b32 v7, 16, v6
    v_subrev_f32 v48, s44, v7
    v_subrev_f32 v49, s45, v7
    v_subrev_f32 v50, s46, v7
    v_subrev_f32 v51, s47, v7
    v_subrev_f32 v52, s48, v7
    v_subrev_f32 v53, s49, v7
    v_subrev_f32 v54, s50, v7
    v_subrev_f32 v55, s51, v7
    v_cvt_pk_bf16_f32 v56, v48, v49
    v_cvt_pk_bf16_f32 v57, v50, v51
    v_cvt_pk_bf16_f32 v58, v52, v53
    v_cvt_pk_bf16_f32 v59, v54, v55
    v_lshlrev_b32 v48, 16, v56
    v_and_b32 v49, 0xffff0000, v56
    v_lshlrev_b32 v50, 16, v57
    v_and_b32 v51, 0xffff0000, v57
    v_lshlrev_b32 v52, 16, v58
    v_and_b32 v53, 0xffff0000, v58
    v_lshlrev_b32 v54, 16, v59
    v_and_b32 v55, 0xffff0000, v59
    v_mul_f32 v48, v48, v48
    v_mul_f32 v49, v49, v49
    v_mul_f32 v50, v50, v50
    v_mul_f32 v51, v51, v51
    v_mul_f32 v52, v52, v52
    v_mul_f32 v53, v53, v53
    v_mul_f32 v54, v54, v54
    v_mul_f32 v55, v55, v55
    v_cvt_pk_bf16_f32 v56, v48, v49
    v_cvt_pk_bf16_f32 v57, v50, v51
    v_cvt_pk_bf16_f32 v58, v52, v53
    v_cvt_pk_bf16_f32 v59, v54, v55
    v_lshlrev_b32 v48, 16, v56
    v_and_b32 v49, 0xffff0000, v56
    v_lshlrev_b32 v50, 16, v57
    v_and_b32 v51, 0xffff0000, v57
    v_lshlrev_b32 v52, 16, v58
    v_and_b32 v53, 0xffff0000, v58
    v_lshlrev_b32 v54, 16, v59
    v_and_b32 v55, 0xffff0000, v59
    v_mul_f32 v48, 0xc1200000, v48
    v_mul_f32 v49, 0xc1200000, v49
    v_mul_f32 v50, 0xc1200000, v50
    v_mul_f32 v51, 0xc1200000, v51
    v_mul_f32 v52, 0xc1200000, v52
    v_mul_f32 v53, 0xc1200000, v53
    v_mul_f32 v54, 0xc1200000, v54
    v_mul_f32 v55, 0xc1200000, v55
    v_cvt_pk_bf16_f32 v56, v48, v49
    v_cvt_pk_bf16_f32 v57, v50, v51
    v_cvt_pk_bf16_f32 v58, v52, v53
    v_cvt_pk_bf16_f32 v59, v54, v55
    v_lshlrev_b32 v48, 16, v56
    v_and_b32 v49, 0xffff0000, v56
    v_lshlrev_b32 v50, 16, v57
    v_and_b32 v51, 0xffff0000, v57
    v_lshlrev_b32 v52, 16, v58
    v_and_b32 v53, 0xffff0000, v58
    v_lshlrev_b32 v54, 16, v59
    v_and_b32 v55, 0xffff0000, v59
    v_mul_f32 v48, 0x3fb8aa3b, v48
    v_mul_f32 v49, 0x3fb8aa3b, v49
    v_mul_f32 v50, 0x3fb8aa3b, v50
    v_mul_f32 v51, 0x3fb8aa3b, v51
    v_mul_f32 v52, 0x3fb8aa3b, v52
    v_mul_f32 v53, 0x3fb8aa3b, v53
    v_mul_f32 v54, 0x3fb8aa3b, v54
    v_mul_f32 v55, 0x3fb8aa3b, v55
    v_exp_f32 v48, v48
    v_exp_f32 v49, v49
    v_exp_f32 v50, v50
    v_exp_f32 v51, v51
    v_exp_f32 v52, v52
    v_exp_f32 v53, v53
    v_exp_f32 v54, v54
    v_exp_f32 v55, v55
    v_cvt_pk_bf16_f32 v40, v48, v49
    v_cvt_pk_bf16_f32 v41, v50, v51
    v_cvt_pk_bf16_f32 v42, v52, v53
    v_cvt_pk_bf16_f32 v43, v54, v55
    v_and_b32 v7, 0xffff0000, v6
    v_subrev_f32 v48, s44, v7
    v_subrev_f32 v49, s45, v7
    v_subrev_f32 v50, s46, v7
    v_subrev_f32 v51, s47, v7
    v_subrev_f32 v52, s48, v7
    v_subrev_f32 v53, s49, v7
    v_subrev_f32 v54, s50, v7
    v_subrev_f32 v55, s51, v7
    v_cvt_pk_bf16_f32 v56, v48, v49
    v_cvt_pk_bf16_f32 v57, v50, v51
    v_cvt_pk_bf16_f32 v58, v52, v53
    v_cvt_pk_bf16_f32 v59, v54, v55
    v_lshlrev_b32 v48, 16, v56
    v_and_b32 v49, 0xffff0000, v56
    v_lshlrev_b32 v50, 16, v57
    v_and_b32 v51, 0xffff0000, v57
    v_lshlrev_b32 v52, 16, v58
    v_and_b32 v53, 0xffff0000, v58
    v_lshlrev_b32 v54, 16, v59
    v_and_b32 v55, 0xffff0000, v59
    v_mul_f32 v48, v48, v48
    v_mul_f32 v49, v49, v49
    v_mul_f32 v50, v50, v50
    v_mul_f32 v51, v51, v51
    v_mul_f32 v52, v52, v52
    v_mul_f32 v53, v53, v53
    v_mul_f32 v54, v54, v54
    v_mul_f32 v55, v55, v55
    v_cvt_pk_bf16_f32 v56, v48, v49
    v_cvt_pk_bf16_f32 v57, v50, v51
    v_cvt_pk_bf16_f32 v58, v52, v53
    v_cvt_pk_bf16_f32 v59, v54, v55
    v_lshlrev_b32 v48, 16, v56
    v_and_b32 v49, 0xffff0000, v56
    v_lshlrev_b32 v50, 16, v57
    v_and_b32 v51, 0xffff0000, v57
    v_lshlrev_b32 v52, 16, v58
    v_and_b32 v53, 0xffff0000, v58
    v_lshlrev_b32 v54, 16, v59
    v_and_b32 v55, 0xffff0000, v59
    v_mul_f32 v48, 0xc1200000, v48
    v_mul_f32 v49, 0xc1200000, v49
    v_mul_f32 v50, 0xc1200000, v50
    v_mul_f32 v51, 0xc1200000, v51
    v_mul_f32 v52, 0xc1200000, v52
    v_mul_f32 v53, 0xc1200000, v53
    v_mul_f32 v54, 0xc1200000, v54
    v_mul_f32 v55, 0xc1200000, v55
    v_cvt_pk_bf16_f32 v56, v48, v49
    v_cvt_pk_bf16_f32 v57, v50, v51
    v_cvt_pk_bf16_f32 v58, v52, v53
    v_cvt_pk_bf16_f32 v59, v54, v55
    v_lshlrev_b32 v48, 16, v56
    v_and_b32 v49, 0xffff0000, v56
    v_lshlrev_b32 v50, 16, v57
    v_and_b32 v51, 0xffff0000, v57
    v_lshlrev_b32 v52, 16, v58
    v_and_b32 v53, 0xffff0000, v58
    v_lshlrev_b32 v54, 16, v59
    v_and_b32 v55, 0xffff0000, v59
    v_mul_f32 v48, 0x3fb8aa3b, v48
    v_mul_f32 v49, 0x3fb8aa3b, v49
    v_mul_f32 v50, 0x3fb8aa3b, v50
    v_mul_f32 v51, 0x3fb8aa3b, v51
    v_mul_f32 v52, 0x3fb8aa3b, v52
    v_mul_f32 v53, 0x3fb8aa3b, v53
    v_mul_f32 v54, 0x3fb8aa3b, v54
    v_mul_f32 v55, 0x3fb8aa3b, v55
    v_exp_f32 v48, v48
    v_exp_f32 v49, v49
    v_exp_f32 v50, v50
    v_exp_f32 v51, v51
    v_exp_f32 v52, v52
    v_exp_f32 v53, v53
    v_exp_f32 v54, v54
    v_exp_f32 v55, v55
    v_cvt_pk_bf16_f32 v44, v48, v49
    v_cvt_pk_bf16_f32 v45, v50, v51
    v_cvt_pk_bf16_f32 v46, v52, v53
    v_cvt_pk_bf16_f32 v47, v54, v55
    s_waitcnt vmcnt(5)
    v_mfma_f32_4x4x4_16b_bf16 v[48:51], v[8:9], v[40:41], 0
    v_mfma_f32_4x4x4_16b_bf16 v[56:59], v[12:13], v[40:41], 0
    v_mfma_f32_4x4x4_16b_bf16 v[52:55], v[8:9], v[44:45], 0
    v_mfma_f32_4x4x4_16b_bf16 v[60:63], v[12:13], v[44:45], 0
    v_mfma_f32_4x4x4_16b_bf16 v[48:51], v[10:11], v[42:43], v[48:51]
    v_mfma_f32_4x4x4_16b_bf16 v[56:59], v[14:15], v[42:43], v[56:59]
    v_mfma_f32_4x4x4_16b_bf16 v[52:55], v[10:11], v[46:47], v[52:55]
    v_mfma_f32_4x4x4_16b_bf16 v[60:63], v[14:15], v[46:47], v[60:63]
    s_waitcnt vmcnt(1)
    v_mfma_f32_4x4x4_16b_bf16 v[64:67], v[18:19], v[20:21], 0
    v_mfma_f32_4x4x4_16b_bf16 v[68:71], v[18:19], v[22:23], 0
    s_nop 0
    v_mfma_f32_4x4x4_16b_bf16 v[64:67], v[18:19], v[24:25], v[64:67]
    v_mfma_f32_4x4x4_16b_bf16 v[68:71], v[18:19], v[26:27], v[68:71]
    s_nop 0
    v_mfma_f32_4x4x4_16b_bf16 v[64:67], v[18:19], v[28:29], v[64:67]
    v_mfma_f32_4x4x4_16b_bf16 v[68:71], v[18:19], v[30:31], v[68:71]
    s_nop 0
    v_mfma_f32_4x4x4_16b_bf16 v[64:67], v[18:19], v[32:33], v[64:67]
    v_mfma_f32_4x4x4_16b_bf16 v[68:71], v[18:19], v[34:35], v[68:71]
    s_nop 3
    v_mul_f32 v64, v64, v48
    v_mul_f32 v65, v65, v49
    v_mul_f32 v66, v66, v50
    v_mul_f32 v67, v67, v51
    v_cvt_pk_bf16_f32 v20, v64, v65
    v_cvt_pk_bf16_f32 v21, v66, v67
    v_mul_f32 v68, v68, v52
    v_mul_f32 v69, v69, v53
    v_mul_f32 v70, v70, v54
    v_mul_f32 v71, v71, v55
    v_cvt_pk_bf16_f32 v22, v68, v69
    v_cvt_pk_bf16_f32 v23, v70, v71
    v_mfma_f32_4x4x4_16b_bf16 v[48:51], v[16:17], v[20:21], 0
    s_nop 0
    v_mfma_f32_4x4x4_16b_bf16 v[52:55], v[16:17], v[22:23], 0
    s_nop 2
    v_mul_f32 v48, v48, v56
    v_mul_f32 v49, v49, v57
    v_mul_f32 v50, v50, v58
    v_mul_f32 v51, v51, v59
    v_mul_f32 v52, v52, v60
    v_mul_f32 v53, v53, v61
    v_mul_f32 v54, v54, v62
    v_mul_f32 v55, v55, v63
    s_waitcnt vmcnt(0)
    v_mfma_f32_4x4x4_16b_bf16 v[64:67], v[18:19], v[36:37], v[48:51]
    v_mfma_f32_4x4x4_16b_bf16 v[68:71], v[18:19], v[38:39], v[52:55]
    s_nop 3
    v_cvt_pk_bf16_f32 v24, v64, v65
    v_cvt_pk_bf16_f32 v25, v66, v67
    v_cvt_pk_bf16_f32 v26, v68, v69
    v_cvt_pk_bf16_f32 v27, v70, v71
    buffer_store_dwordx4 v[24:27], v2, s[16:19], 0 offen
L3_end:
    s_endpgm
.section .rodata,"a"
.p2align 6
.amdhsa_kernel gs_sort_kernel
  .amdhsa_next_free_vgpr 128
  .amdhsa_next_free_sgpr 96
  .amdhsa_accum_offset 128
  .amdhsa_group_segment_fixed_size 0
  .amdhsa_kernarg_size 112
  .amdhsa_user_sgpr_count 2
  .amdhsa_user_sgpr_kernarg_segment_ptr 1
  .amdhsa_system_sgpr_workgroup_id_x 1
  .amdhsa_float_denorm_mode_32 3
.end_amdhsa_kernel
.p2align 6
.amdhsa_kernel gs_acc_kernel
  .amdhsa_next_free_vgpr 128
  .amdhsa_next_free_sgpr 96
  .amdhsa_accum_offset 128
  .amdhsa_group_segment_fixed_size 0
  .amdhsa_kernarg_size 112
  .amdhsa_user_sgpr_count 2
  .amdhsa_user_sgpr_kernarg_segment_ptr 1
  .amdhsa_system_sgpr_workgroup_id_x 1
  .amdhsa_float_denorm_mode_32 3
.end_amdhsa_kernel
.p2align 6
.amdhsa_kernel gs_final_kernel
  .amdhsa_next_free_vgpr 72
  .amdhsa_next_free_sgpr 64
  .amdhsa_accum_offset 72
  .amdhsa_group_segment_fixed_size 0
  .amdhsa_kernarg_size 112
  .amdhsa_user_sgpr_count 2
  .amdhsa_user_sgpr_kernarg_segment_ptr 1
  .amdhsa_system_sgpr_workgroup_id_x 1
  .amdhsa_float_denorm_mode_32 3
.end_amdhsa_kernel
```

```asm
; @launch kernel=gs_sort_kernel grid=(256,1,1) block=(1024,1,1) lds=163840
; @launch kernel=gs_acc_kernel grid=(256,1,1) block=(1024,1,1) lds=163840
; @launch kernel=gs_final_kernel grid=(1250,1,1) block=(256,1,1) lds=0
.amdgcn_target "amdgcn-amd-amdhsa--gfx950"
.text
.globl gs_sort_kernel
.p2align 8
.type gs_sort_kernel,@function
gs_sort_kernel:
    s_cmp_ge_u32 s2, 256
    s_cbranch_scc1 L1_end
    s_load_dwordx4 s[4:7], s[0:1], 8
    s_load_dwordx2 s[28:29], s[0:1], 32
    s_load_dwordx2 s[30:31], s[0:1], 104
    s_load_dwordx2 s[56:57], s[0:1], 96
    s_load_dwordx2 s[86:87], s[0:1], 0
    s_load_dwordx4 s[60:63], s[0:1], 56
    s_load_dwordx4 s[64:67], s[0:1], 72
    v_lshrrev_b32 v7, 6, v0
    v_lshlrev_b32 v1, 3, v0
    v_readfirstlane_b32 s32, v7
    v_lshlrev_b32 v0, 4, v0
    s_mul_i32 s33, s2, 131072
    s_mul_i32 s34, s2, 65536
    s_waitcnt lgkmcnt(0)
    s_mov_b32 s8, s4
    s_mov_b32 s9, s5
    s_mov_b32 s10, 0x9c40000
    s_mov_b32 s11, 0x20000
    s_mov_b32 s12, s6
    s_mov_b32 s13, s7
    s_mov_b32 s14, 0x9c40000
    s_mov_b32 s15, 0x20000
    s_mov_b32 s16, s28
    s_mov_b32 s17, s29
    s_mov_b32 s18, 0x4e20000
    s_mov_b32 s19, 0x20000
    s_add_u32 s44, s33, 0x0
    buffer_load_dwordx4 v[16:19], v0, s[8:11], s44 offen nt
    s_add_u32 s45, s33, 0x0
    buffer_load_dwordx4 v[20:23], v0, s[12:15], s45 offen nt
    s_add_u32 s46, s34, 0x0
    buffer_load_dwordx2 v[24:25], v1, s[16:19], s46 offen nt
    s_add_u32 s47, s34, 0x2000
    buffer_load_dwordx2 v[26:27], v1, s[16:19], s47 offen nt
    s_add_u32 s44, s33, 0x4000
    buffer_load_dwordx4 v[28:31], v0, s[8:11], s44 offen nt
    s_add_u32 s45, s33, 0x4000
    buffer_load_dwordx4 v[32:35], v0, s[12:15], s45 offen nt
    s_add_u32 s46, s33, 0x8000
    buffer_load_dwordx4 v[36:39], v0, s[8:11], s46 offen nt
    s_add_u32 s47, s33, 0x8000
    buffer_load_dwordx4 v[40:43], v0, s[12:15], s47 offen nt
    s_add_u32 s44, s34, 0x4000
    buffer_load_dwordx2 v[44:45], v1, s[16:19], s44 offen nt
    s_add_u32 s45, s34, 0x6000
    buffer_load_dwordx2 v[46:47], v1, s[16:19], s45 offen nt
    s_mov_b32 s68, s62
    s_mov_b32 s69, s63
    s_mov_b32 s70, 0x40
    s_mov_b32 s71, 0x20000
    s_mov_b32 s72, s60
    s_mov_b32 s73, s61
    s_mov_b32 s74, 0x40
    s_mov_b32 s75, 0x20000
    s_mov_b32 s20, s66
    s_mov_b32 s21, s67
    s_mov_b32 s22, 0x20
    s_mov_b32 s23, 0x20000
    s_mov_b32 s80, s64
    s_mov_b32 s81, s65
    s_mov_b32 s82, 0x20
    s_mov_b32 s83, 0x20000
    s_add_u32 s24, s30, 0xebab000
    s_addc_u32 s25, s31, 0
    s_mov_b32 s26, 0x100
    s_mov_b32 s27, 0x20000
    v_lshrrev_b32 v2, 3, v0
    v_and_b32 v2, 6, v2
    v_lshlrev_b32 v3, 2, v0
    s_lshl_b32 s3, s32, 8
    s_add_u32 s3, s3, s2
    s_cmp_lg_u32 s3, 254
    s_cbranch_scc1 L1_wt
    buffer_load_ushort v96, v2, s[68:71], 0 offen offset:0
    buffer_load_ushort v108, v2, s[68:71], 0 offen offset:8
    buffer_load_ushort v97, v2, s[68:71], 0 offen offset:16
    buffer_load_ushort v109, v2, s[68:71], 0 offen offset:24
    buffer_load_ushort v98, v2, s[68:71], 0 offen offset:32
    buffer_load_ushort v110, v2, s[68:71], 0 offen offset:40
    buffer_load_ushort v99, v2, s[68:71], 0 offen offset:48
    buffer_load_ushort v111, v2, s[68:71], 0 offen offset:56
    buffer_load_ushort v100, v2, s[72:75], 0 offen offset:0
    buffer_load_ushort v112, v2, s[72:75], 0 offen offset:8
    buffer_load_ushort v101, v2, s[72:75], 0 offen offset:16
    buffer_load_ushort v113, v2, s[72:75], 0 offen offset:24
    buffer_load_ushort v102, v2, s[72:75], 0 offen offset:32
    buffer_load_ushort v114, v2, s[72:75], 0 offen offset:40
    buffer_load_ushort v103, v2, s[72:75], 0 offen offset:48
    buffer_load_ushort v115, v2, s[72:75], 0 offen offset:56
    buffer_load_ushort v104, v2, s[20:23], 0 offen offset:0
    buffer_load_ushort v116, v2, s[20:23], 0 offen offset:8
    buffer_load_ushort v105, v2, s[20:23], 0 offen offset:16
    buffer_load_ushort v117, v2, s[20:23], 0 offen offset:24
    buffer_load_ushort v106, v2, s[80:83], 0 offen offset:0
    buffer_load_ushort v118, v2, s[80:83], 0 offen offset:8
    buffer_load_ushort v107, v2, s[80:83], 0 offen offset:16
    buffer_load_ushort v119, v2, s[80:83], 0 offen offset:24
    s_waitcnt vmcnt(0)
    v_lshl_or_b32 v96, v108, 16, v96
    v_lshl_or_b32 v97, v109, 16, v97
    v_lshl_or_b32 v98, v110, 16, v98
    v_lshl_or_b32 v99, v111, 16, v99
    v_lshl_or_b32 v100, v112, 16, v100
    v_lshl_or_b32 v101, v113, 16, v101
    v_lshl_or_b32 v102, v114, 16, v102
    v_lshl_or_b32 v103, v115, 16, v103
    v_lshl_or_b32 v104, v116, 16, v104
    v_lshl_or_b32 v105, v117, 16, v105
    v_lshl_or_b32 v106, v118, 16, v106
    v_lshl_or_b32 v107, v119, 16, v107
    buffer_store_dwordx4 v[96:99], v3, s[24:27], 0 offen offset:0
    buffer_store_dwordx4 v[100:103], v3, s[24:27], 0 offen offset:16
    buffer_store_dwordx4 v[104:107], v3, s[24:27], 0 offen offset:32
L1_wt:
    s_mov_b32 s20, s30
    s_mov_b32 s21, s31
    s_mov_b32 s22, 0xd340000
    s_mov_b32 s23, 0x20000
    s_add_u32 s24, s30, 0x28000
    s_addc_u32 s25, s31, 0
    s_mov_b32 s26, 0xd318000
    s_mov_b32 s27, 0x20000
    s_mov_b32 s80, s86
    s_mov_b32 s81, s87
    s_mov_b32 s82, 0x4e20
    s_mov_b32 s83, 0x20000
    s_mul_i32 s3, s2, 20000
    s_add_u32 s80, s80, s3
    s_addc_u32 s81, s81, 0
    s_mul_i32 s35, s2, 173056
    s_and_b32 s37, s32, 3
    s_lshl_b32 s37, s37, 3
    s_add_u32 s36, s35, s37
    s_lshr_b32 s37, s32, 2
    s_mul_i32 s37, s37, 2080
    s_add_u32 s36, s36, s37
    s_mul_i32 s4, s2, 5
    s_add_u32 s4, s4, 8192
    s_lshl_b32 s38, s4, 14
    s_lshl_b32 s39, s4, 13
    v_mov_b32 v2, 1
    v_mov_b32 v4, 0x80000007
    v_mov_b32 v5, 0xfc
    v_mov_b32 v6, 0x78
    s_mov_b32 s40, 2048
    s_mov_b32 s55, -10000
    s_mov_b32 s41, 0x010c0c01
    s_mov_b32 s42, 0x030c0c03
    v_mov_b32 v8, 0
    v_mov_b32 v9, 0
    v_mov_b32 v10, 0
    v_mov_b32 v11, 0
    ds_write_b128 v0, v[8:11]
    s_waitcnt lgkmcnt(0)
    s_barrier
    s_add_u32 s46, s33, 0xc000
    buffer_load_dwordx4 v[48:51], v0, s[8:11], s46 offen nt
    s_add_u32 s47, s33, 0xc000
    buffer_load_dwordx4 v[52:55], v0, s[12:15], s47 offen nt
    s_waitcnt vmcnt(8)
    v_lshlrev_b32 v7, 16, v24
    v_and_b32 v8, 0xffff0000, v24
    v_lshlrev_b32 v9, 16, v25
    v_and_b32 v10, 0xffff0000, v25
    v_mul_f32 v7, 0.15915494, v7
    v_mul_f32 v8, 0.15915494, v8
    v_mul_f32 v9, 0.15915494, v9
    v_mul_f32 v10, 0.15915494, v10
    v_mul_hi_u32_u24 v14, 429497, v16
    v_lshrrev_b32 v12, 3, v20
    v_cos_f32 v7, v7
    v_lshlrev_b16 v13, 3, v20
    v_mad_i32_i24 v11, v14, s55, v16
    v_bitop3_b32 v12, v6, v13, v12 bitop3:0xca
    v_add_lshl_u32 v11, v11, s40, 17
    v_lshlrev_b16 v14, 8, v14
    v_lshrrev_b32 v13, 2, v20
    v_or_b32 v16, v12, v11
    v_bitop3_b32 v20, v5, v13, v14 bitop3:0xea
    ds_add_u32 v20, v2
    v_mul_hi_u32_u24 v14, 429497, v17
    v_lshrrev_b32 v12, 3, v21
    v_cos_f32 v8, v8
    v_lshlrev_b16 v13, 3, v21
    v_mad_i32_i24 v11, v14, s55, v17
    v_bitop3_b32 v12, v6, v13, v12 bitop3:0xca
    v_add_lshl_u32 v11, v11, s40, 17
    v_lshlrev_b16 v14, 8, v14
    v_lshrrev_b32 v13, 2, v21
    v_or_b32 v17, v12, v11
    v_bitop3_b32 v21, v5, v13, v14 bitop3:0xea
    ds_add_u32 v21, v2
    v_cvt_pk_bf16_f32 v24, v7, v8
    v_perm_b32 v12, v24, v24, s41
    v_bitop3_b32 v16, v4, v12, v16 bitop3:0xca
    v_perm_b32 v13, v24, v24, s42
    v_bitop3_b32 v17, v4, v13, v17 bitop3:0xca
    v_mul_hi_u32_u24 v14, 429497, v18
    v_lshrrev_b32 v12, 3, v22
    v_cos_f32 v9, v9
    v_lshlrev_b16 v13, 3, v22
    v_mad_i32_i24 v11, v14, s55, v18
    v_bitop3_b32 v12, v6, v13, v12 bitop3:0xca
    v_add_lshl_u32 v11, v11, s40, 17
    v_lshlrev_b16 v14, 8, v14
    v_lshrrev_b32 v13, 2, v22
    v_or_b32 v18, v12, v11
    v_bitop3_b32 v22, v5, v13, v14 bitop3:0xea
    ds_add_u32 v22, v2
    v_mul_hi_u32_u24 v14, 429497, v19
    v_lshrrev_b32 v12, 3, v23
    v_cos_f32 v10, v10
    v_lshlrev_b16 v13, 3, v23
    v_mad_i32_i24 v11, v14, s55, v19
    v_bitop3_b32 v12, v6, v13, v12 bitop3:0xca
    v_add_lshl_u32 v11, v11, s40, 17
    v_lshlrev_b16 v14, 8, v14
    v_lshrrev_b32 v13, 2, v23
    v_or_b32 v19, v12, v11
    v_bitop3_b32 v23, v5, v13, v14 bitop3:0xea
    ds_add_u32 v23, v2
    v_cvt_pk_bf16_f32 v25, v9, v10
    v_perm_b32 v12, v25, v25, s41
    v_bitop3_b32 v18, v4, v12, v18 bitop3:0xca
    v_perm_b32 v13, v25, v25, s42
    v_bitop3_b32 v19, v4, v13, v19 bitop3:0xca
    s_add_u32 s44, s33, 0x10000
    buffer_load_dwordx4 v[56:59], v0, s[8:11], s44 offen nt
    s_add_u32 s45, s33, 0x10000
    buffer_load_dwordx4 v[60:63], v0, s[12:15], s45 offen nt
    s_add_u32 s46, s34, 0x8000
    buffer_load_dwordx2 v[64:65], v1, s[16:19], s46 offen nt
    s_add_u32 s47, s34, 0xa000
    buffer_load_dwordx2 v[66:67], v1, s[16:19], s47 offen nt
    s_waitcnt vmcnt(10)
    v_lshlrev_b32 v7, 16, v26
    v_and_b32 v8, 0xffff0000, v26
    v_lshlrev_b32 v9, 16, v27
    v_and_b32 v10, 0xffff0000, v27
    v_mul_f32 v7, 0.15915494, v7
    v_mul_f32 v8, 0.15915494, v8
    v_mul_f32 v9, 0.15915494, v9
    v_mul_f32 v10, 0.15915494, v10
    v_mul_hi_u32_u24 v14, 429497, v28
    v_lshrrev_b32 v12, 3, v32
    v_cos_f32 v7, v7
    v_lshlrev_b16 v13, 3, v32
    v_mad_i32_i24 v11, v14, s55, v28
    v_bitop3_b32 v12, v6, v13, v12 bitop3:0xca
    v_add_lshl_u32 v11, v11, s40, 17
    v_lshlrev_b16 v14, 8, v14
    v_lshrrev_b32 v13, 2, v32
    v_or_b32 v28, v12, v11
    v_bitop3_b32 v32, v5, v13, v14 bitop3:0xea
    ds_add_u32 v32, v2
    v_mul_hi_u32_u24 v14, 429497, v29
    v_lshrrev_b32 v12, 3, v33
    v_cos_f32 v8, v8
    v_lshlrev_b16 v13, 3, v33
    v_mad_i32_i24 v11, v14, s55, v29
    v_bitop3_b32 v12, v6, v13, v12 bitop3:0xca
    v_add_lshl_u32 v11, v11, s40, 17
    v_lshlrev_b16 v14, 8, v14
    v_lshrrev_b32 v13, 2, v33
    v_or_b32 v29, v12, v11
    v_bitop3_b32 v33, v5, v13, v14 bitop3:0xea
    ds_add_u32 v33, v2
    v_cvt_pk_bf16_f32 v26, v7, v8
    v_perm_b32 v12, v26, v26, s41
    v_bitop3_b32 v28, v4, v12, v28 bitop3:0xca
    v_perm_b32 v13, v26, v26, s42
    v_bitop3_b32 v29, v4, v13, v29 bitop3:0xca
    v_mul_hi_u32_u24 v14, 429497, v30
    v_lshrrev_b32 v12, 3, v34
    v_cos_f32 v9, v9
    v_lshlrev_b16 v13, 3, v34
    v_mad_i32_i24 v11, v14, s55, v30
    v_bitop3_b32 v12, v6, v13, v12 bitop3:0xca
    v_add_lshl_u32 v11, v11, s40, 17
    v_lshlrev_b16 v14, 8, v14
    v_lshrrev_b32 v13, 2, v34
    v_or_b32 v30, v12, v11
    v_bitop3_b32 v34, v5, v13, v14 bitop3:0xea
    ds_add_u32 v34, v2
    v_mul_hi_u32_u24 v14, 429497, v31
    v_lshrrev_b32 v12, 3, v35
    v_cos_f32 v10, v10
    v_lshlrev_b16 v13, 3, v35
    v_mad_i32_i24 v11, v14, s55, v31
    v_bitop3_b32 v12, v6, v13, v12 bitop3:0xca
    v_add_lshl_u32 v11, v11, s40, 17
    v_lshlrev_b16 v14, 8, v14
    v_lshrrev_b32 v13, 2, v35
    v_or_b32 v31, v12, v11
    v_bitop3_b32 v35, v5, v13, v14 bitop3:0xea
    ds_add_u32 v35, v2
    v_cvt_pk_bf16_f32 v27, v9, v10
    v_perm_b32 v12, v27, v27, s41
    v_bitop3_b32 v30, v4, v12, v30 bitop3:0xca
    v_perm_b32 v13, v27, v27, s42
    v_bitop3_b32 v31, v4, v13, v31 bitop3:0xca
    s_add_u32 s44, s33, 0x14000
    buffer_load_dwordx4 v[68:71], v0, s[8:11], s44 offen nt
    s_add_u32 s45, s33, 0x14000
    buffer_load_dwordx4 v[72:75], v0, s[12:15], s45 offen nt
    s_waitcnt vmcnt(8)
    v_lshlrev_b32 v7, 16, v44
    v_and_b32 v8, 0xffff0000, v44
    v_lshlrev_b32 v9, 16, v45
    v_and_b32 v10, 0xffff0000, v45
    v_mul_f32 v7, 0.15915494, v7
    v_mul_f32 v8, 0.15915494, v8
    v_mul_f32 v9, 0.15915494, v9
    v_mul_f32 v10, 0.15915494, v10
    v_mul_hi_u32_u24 v14, 429497, v36
    v_lshrrev_b32 v12, 3, v40
    v_cos_f32 v7, v7
    v_lshlrev_b16 v13, 3, v40
    v_mad_i32_i24 v11, v14, s55, v36
    v_bitop3_b32 v12, v6, v13, v12 bitop3:0xca
    v_add_lshl_u32 v11, v11, s40, 17
    v_lshlrev_b16 v14, 8, v14
    v_lshrrev_b32 v13, 2, v40
    v_or_b32 v36, v12, v11
    v_bitop3_b32 v40, v5, v13, v14 bitop3:0xea
    ds_add_u32 v40, v2
    v_mul_hi_u32_u24 v14, 429497, v37
    v_lshrrev_b32 v12, 3, v41
    v_cos_f32 v8, v8
    v_lshlrev_b16 v13, 3, v41
    v_mad_i32_i24 v11, v14, s55, v37
    v_bitop3_b32 v12, v6, v13, v12 bitop3:0xca
    v_add_lshl_u32 v11, v11, s40, 17
    v_lshlrev_b16 v14, 8, v14
    v_lshrrev_b32 v13, 2, v41
    v_or_b32 v37, v12, v11
    v_bitop3_b32 v41, v5, v13, v14 bitop3:0xea
    ds_add_u32 v41, v2
    v_cvt_pk_bf16_f32 v44, v7, v8
    v_perm_b32 v12, v44, v44, s41
    v_bitop3_b32 v36, v4, v12, v36 bitop3:0xca
    v_perm_b32 v13, v44, v44, s42
    v_bitop3_b32 v37, v4, v13, v37 bitop3:0xca
    v_mul_hi_u32_u24 v14, 429497, v38
    v_lshrrev_b32 v12, 3, v42
    v_cos_f32 v9, v9
    v_lshlrev_b16 v13, 3, v42
    v_mad_i32_i24 v11, v14, s55, v38
    v_bitop3_b32 v12, v6, v13, v12 bitop3:0xca
    v_add_lshl_u32 v11, v11, s40, 17
    v_lshlrev_b16 v14, 8, v14
    v_lshrrev_b32 v13, 2, v42
    v_or_b32 v38, v12, v11
    v_bitop3_b32 v42, v5, v13, v14 bitop3:0xea
    ds_add_u32 v42, v2
    v_mul_hi_u32_u24 v14, 429497, v39
    v_lshrrev_b32 v12, 3, v43
    v_cos_f32 v10, v10
    v_lshlrev_b16 v13, 3, v43
    v_mad_i32_i24 v11, v14, s55, v39
    v_bitop3_b32 v12, v6, v13, v12 bitop3:0xca
    v_add_lshl_u32 v11, v11, s40, 17
    v_lshlrev_b16 v14, 8, v14
    v_lshrrev_b32 v13, 2, v43
    v_or_b32 v39, v12, v11
    v_bitop3_b32 v43, v5, v13, v14 bitop3:0xea
    ds_add_u32 v43, v2
    v_cvt_pk_bf16_f32 v45, v9, v10
    v_perm_b32 v12, v45, v45, s41
    v_bitop3_b32 v38, v4, v12, v38 bitop3:0xca
    v_perm_b32 v13, v45, v45, s42
    v_bitop3_b32 v39, v4, v13, v39 bitop3:0xca
    s_add_u32 s46, s33, 0x18000
    buffer_load_dwordx4 v[76:79], v0, s[8:11], s46 offen nt
    s_add_u32 s47, s33, 0x18000
    buffer_load_dwordx4 v[80:83], v0, s[12:15], s47 offen nt
    s_add_u32 s44, s34, 0xc000
    buffer_load_dwordx2 v[84:85], v1, s[16:19], s44 offen nt
    s_add_u32 s45, s34, 0xe000
    buffer_load_dwordx2 v[86:87], v1, s[16:19], s45 offen nt
    s_waitcnt vmcnt(10)
    v_lshlrev_b32 v7, 16, v46
    v_and_b32 v8, 0xffff0000, v46
    v_lshlrev_b32 v9, 16, v47
    v_and_b32 v10, 0xffff0000, v47
    v_mul_f32 v7, 0.15915494, v7
    v_mul_f32 v8, 0.15915494, v8
    v_mul_f32 v9, 0.15915494, v9
    v_mul_f32 v10, 0.15915494, v10
    v_mul_hi_u32_u24 v14, 429497, v48
    v_lshrrev_b32 v12, 3, v52
    v_cos_f32 v7, v7
    v_lshlrev_b16 v13, 3, v52
    v_mad_i32_i24 v11, v14, s55, v48
    v_bitop3_b32 v12, v6, v13, v12 bitop3:0xca
    v_add_lshl_u32 v11, v11, s40, 17
    v_lshlrev_b16 v14, 8, v14
    v_lshrrev_b32 v13, 2, v52
    v_or_b32 v48, v12, v11
    v_bitop3_b32 v52, v5, v13, v14 bitop3:0xea
    ds_add_u32 v52, v2
    v_mul_hi_u32_u24 v14, 429497, v49
    v_lshrrev_b32 v12, 3, v53
    v_cos_f32 v8, v8
    v_lshlrev_b16 v13, 3, v53
    v_mad_i32_i24 v11, v14, s55, v49
    v_bitop3_b32 v12, v6, v13, v12 bitop3:0xca
    v_add_lshl_u32 v11, v11, s40, 17
    v_lshlrev_b16 v14, 8, v14
    v_lshrrev_b32 v13, 2, v53
    v_or_b32 v49, v12, v11
    v_bitop3_b32 v53, v5, v13, v14 bitop3:0xea
    ds_add_u32 v53, v2
    v_cvt_pk_bf16_f32 v46, v7, v8
    v_perm_b32 v12, v46, v46, s41
    v_bitop3_b32 v48, v4, v12, v48 bitop3:0xca
    v_perm_b32 v13, v46, v46, s42
    v_bitop3_b32 v49, v4, v13, v49 bitop3:0xca
    v_mul_hi_u32_u24 v14, 429497, v50
    v_lshrrev_b32 v12, 3, v54
    v_cos_f32 v9, v9
    v_lshlrev_b16 v13, 3, v54
    v_mad_i32_i24 v11, v14, s55, v50
    v_bitop3_b32 v12, v6, v13, v12 bitop3:0xca
    v_add_lshl_u32 v11, v11, s40, 17
    v_lshlrev_b16 v14, 8, v14
    v_lshrrev_b32 v13, 2, v54
    v_or_b32 v50, v12, v11
    v_bitop3_b32 v54, v5, v13, v14 bitop3:0xea
    ds_add_u32 v54, v2
    v_mul_hi_u32_u24 v14, 429497, v51
    v_lshrrev_b32 v12, 3, v55
    v_cos_f32 v10, v10
    v_lshlrev_b16 v13, 3, v55
    v_mad_i32_i24 v11, v14, s55, v51
    v_bitop3_b32 v12, v6, v13, v12 bitop3:0xca
    v_add_lshl_u32 v11, v11, s40, 17
    v_lshlrev_b16 v14, 8, v14
    v_lshrrev_b32 v13, 2, v55
    v_or_b32 v51, v12, v11
    v_bitop3_b32 v55, v5, v13, v14 bitop3:0xea
    ds_add_u32 v55, v2
    v_cvt_pk_bf16_f32 v47, v9, v10
    v_perm_b32 v12, v47, v47, s41
    v_bitop3_b32 v50, v4, v12, v50 bitop3:0xca
    v_perm_b32 v13, v47, v47, s42
    v_bitop3_b32 v51, v4, v13, v51 bitop3:0xca
    s_add_u32 s46, s33, 0x1c000
    buffer_load_dwordx4 v[88:91], v0, s[8:11], s46 offen nt
    s_add_u32 s47, s33, 0x1c000
    buffer_load_dwordx4 v[92:95], v0, s[12:15], s47 offen nt
    s_waitcnt vmcnt(8)
    v_lshlrev_b32 v7, 16, v64
    v_and_b32 v8, 0xffff0000, v64
    v_lshlrev_b32 v9, 16, v65
    v_and_b32 v10, 0xffff0000, v65
    v_mul_f32 v7, 0.15915494, v7
    v_mul_f32 v8, 0.15915494, v8
    v_mul_f32 v9, 0.15915494, v9
    v_mul_f32 v10, 0.15915494, v10
    v_mul_hi_u32_u24 v14, 429497, v56
    v_lshrrev_b32 v12, 3, v60
    v_cos_f32 v7, v7
    v_lshlrev_b16 v13, 3, v60
    v_mad_i32_i24 v11, v14, s55, v56
    v_bitop3_b32 v12, v6, v13, v12 bitop3:0xca
    v_add_lshl_u32 v11, v11, s40, 17
    v_lshlrev_b16 v14, 8, v14
    v_lshrrev_b32 v13, 2, v60
    v_or_b32 v56, v12, v11
    v_bitop3_b32 v60, v5, v13, v14 bitop3:0xea
    ds_add_u32 v60, v2
    v_mul_hi_u32_u24 v14, 429497, v57
    v_lshrrev_b32 v12, 3, v61
    v_cos_f32 v8, v8
    v_lshlrev_b16 v13, 3, v61
    v_mad_i32_i24 v11, v14, s55, v57
    v_bitop3_b32 v12, v6, v13, v12 bitop3:0xca
    v_add_lshl_u32 v11, v11, s40, 17
    v_lshlrev_b16 v14, 8, v14
    v_lshrrev_b32 v13, 2, v61
    v_or_b32 v57, v12, v11
    v_bitop3_b32 v61, v5, v13, v14 bitop3:0xea
    ds_add_u32 v61, v2
    v_cvt_pk_bf16_f32 v64, v7, v8
    v_perm_b32 v12, v64, v64, s41
    v_bitop3_b32 v56, v4, v12, v56 bitop3:0xca
    v_perm_b32 v13, v64, v64, s42
    v_bitop3_b32 v57, v4, v13, v57 bitop3:0xca
    v_mul_hi_u32_u24 v14, 429497, v58
    v_lshrrev_b32 v12, 3, v62
    v_cos_f32 v9, v9
    v_lshlrev_b16 v13, 3, v62
    v_mad_i32_i24 v11, v14, s55, v58
    v_bitop3_b32 v12, v6, v13, v12 bitop3:0xca
    v_add_lshl_u32 v11, v11, s40, 17
    v_lshlrev_b16 v14, 8, v14
    v_lshrrev_b32 v13, 2, v62
    v_or_b32 v58, v12, v11
    v_bitop3_b32 v62, v5, v13, v14 bitop3:0xea
    ds_add_u32 v62, v2
    v_mul_hi_u32_u24 v14, 429497, v59
    v_lshrrev_b32 v12, 3, v63
    v_cos_f32 v10, v10
    v_lshlrev_b16 v13, 3, v63
    v_mad_i32_i24 v11, v14, s55, v59
    v_bitop3_b32 v12, v6, v13, v12 bitop3:0xca
    v_add_lshl_u32 v11, v11, s40, 17
    v_lshlrev_b16 v14, 8, v14
    v_lshrrev_b32 v13, 2, v63
    v_or_b32 v59, v12, v11
    v_bitop3_b32 v63, v5, v13, v14 bitop3:0xea
    ds_add_u32 v63, v2
    v_cvt_pk_bf16_f32 v65, v9, v10
    v_perm_b32 v12, v65, v65, s41
    v_bitop3_b32 v58, v4, v12, v58 bitop3:0xca
    v_perm_b32 v13, v65, v65, s42
    v_bitop3_b32 v59, v4, v13, v59 bitop3:0xca
    s_add_u32 s44, s33, 0x2000000
    buffer_load_dwordx4 v[96:99], v0, s[8:11], s44 offen nt
    s_add_u32 s45, s33, 0x2000000
    buffer_load_dwordx4 v[100:103], v0, s[12:15], s45 offen nt
    s_add_u32 s46, s34, 0x1000000
    buffer_load_dwordx2 v[104:105], v1, s[16:19], s46 offen nt
    s_add_u32 s47, s34, 0x1002000
    buffer_load_dwordx2 v[106:107], v1, s[16:19], s47 offen nt
    s_waitcnt vmcnt(10)
    v_lshlrev_b32 v7, 16, v66
    v_and_b32 v8, 0xffff0000, v66
    v_lshlrev_b32 v9, 16, v67
    v_and_b32 v10, 0xffff0000, v67
    v_mul_f32 v7, 0.15915494, v7
    v_mul_f32 v8, 0.15915494, v8
    v_mul_f32 v9, 0.15915494, v9
    v_mul_f32 v10, 0.15915494, v10
    v_mul_hi_u32_u24 v14, 429497, v68
    v_lshrrev_b32 v12, 3, v72
    v_cos_f32 v7, v7
    v_lshlrev_b16 v13, 3, v72
    v_mad_i32_i24 v11, v14, s55, v68
    v_bitop3_b32 v12, v6, v13, v12 bitop3:0xca
    v_add_lshl_u32 v11, v11, s40, 17
    v_lshlrev_b16 v14, 8, v14
    v_lshrrev_b32 v13, 2, v72
    v_or_b32 v68, v12, v11
    v_bitop3_b32 v72, v5, v13, v14 bitop3:0xea
    ds_add_u32 v72, v2
    v_mul_hi_u32_u24 v14, 429497, v69
    v_lshrrev_b32 v12, 3, v73
    v_cos_f32 v8, v8
    v_lshlrev_b16 v13, 3, v73
    v_mad_i32_i24 v11, v14, s55, v69
    v_bitop3_b32 v12, v6, v13, v12 bitop3:0xca
    v_add_lshl_u32 v11, v11, s40, 17
    v_lshlrev_b16 v14, 8, v14
    v_lshrrev_b32 v13, 2, v73
    v_or_b32 v69, v12, v11
    v_bitop3_b32 v73, v5, v13, v14 bitop3:0xea
    ds_add_u32 v73, v2
    v_cvt_pk_bf16_f32 v66, v7, v8
    v_perm_b32 v12, v66, v66, s41
    v_bitop3_b32 v68, v4, v12, v68 bitop3:0xca
    v_perm_b32 v13, v66, v66, s42
    v_bitop3_b32 v69, v4, v13, v69 bitop3:0xca
    v_mul_hi_u32_u24 v14, 429497, v70
    v_lshrrev_b32 v12, 3, v74
    v_cos_f32 v9, v9
    v_lshlrev_b16 v13, 3, v74
    v_mad_i32_i24 v11, v14, s55, v70
    v_bitop3_b32 v12, v6, v13, v12 bitop3:0xca
    v_add_lshl_u32 v11, v11, s40, 17
    v_lshlrev_b16 v14, 8, v14
    v_lshrrev_b32 v13, 2, v74
    v_or_b32 v70, v12, v11
    v_bitop3_b32 v74, v5, v13, v14 bitop3:0xea
    ds_add_u32 v74, v2
    v_mul_hi_u32_u24 v14, 429497, v71
    v_lshrrev_b32 v12, 3, v75
    v_cos_f32 v10, v10
    v_lshlrev_b16 v13, 3, v75
    v_mad_i32_i24 v11, v14, s55, v71
    v_bitop3_b32 v12, v6, v13, v12 bitop3:0xca
    v_add_lshl_u32 v11, v11, s40, 17
    v_lshlrev_b16 v14, 8, v14
    v_lshrrev_b32 v13, 2, v75
    v_or_b32 v71, v12, v11
    v_bitop3_b32 v75, v5, v13, v14 bitop3:0xea
    ds_add_u32 v75, v2
    v_cvt_pk_bf16_f32 v67, v9, v10
    v_perm_b32 v12, v67, v67, s41
    v_bitop3_b32 v70, v4, v12, v70 bitop3:0xca
    v_perm_b32 v13, v67, v67, s42
    v_bitop3_b32 v71, v4, v13, v71 bitop3:0xca
    s_add_u32 s44, s33, 0x2004000
    buffer_load_dwordx4 v[108:111], v0, s[8:11], s44 offen nt
    s_waitcnt vmcnt(7)
    v_lshlrev_b32 v7, 16, v84
    v_and_b32 v8, 0xffff0000, v84
    v_lshlrev_b32 v9, 16, v85
    v_and_b32 v10, 0xffff0000, v85
    v_mul_f32 v7, 0.15915494, v7
    v_mul_f32 v8, 0.15915494, v8
    v_mul_f32 v9, 0.15915494, v9
    v_mul_f32 v10, 0.15915494, v10
    v_mul_hi_u32_u24 v14, 429497, v76
    v_lshrrev_b32 v12, 3, v80
    v_cos_f32 v7, v7
    v_lshlrev_b16 v13, 3, v80
    v_mad_i32_i24 v11, v14, s55, v76
    v_bitop3_b32 v12, v6, v13, v12 bitop3:0xca
    v_add_lshl_u32 v11, v11, s40, 17
    v_lshlrev_b16 v14, 8, v14
    v_lshrrev_b32 v13, 2, v80
    v_or_b32 v76, v12, v11
    v_bitop3_b32 v80, v5, v13, v14 bitop3:0xea
    ds_add_u32 v80, v2
    v_mul_hi_u32_u24 v14, 429497, v77
    v_lshrrev_b32 v12, 3, v81
    v_cos_f32 v8, v8
    v_lshlrev_b16 v13, 3, v81
    v_mad_i32_i24 v11, v14, s55, v77
    v_bitop3_b32 v12, v6, v13, v12 bitop3:0xca
    v_add_lshl_u32 v11, v11, s40, 17
    v_lshlrev_b16 v14, 8, v14
    v_lshrrev_b32 v13, 2, v81
    v_or_b32 v77, v12, v11
    v_bitop3_b32 v81, v5, v13, v14 bitop3:0xea
    ds_add_u32 v81, v2
    v_cvt_pk_bf16_f32 v84, v7, v8
    v_perm_b32 v12, v84, v84, s41
    v_bitop3_b32 v76, v4, v12, v76 bitop3:0xca
    v_perm_b32 v13, v84, v84, s42
    v_bitop3_b32 v77, v4, v13, v77 bitop3:0xca
    v_mul_hi_u32_u24 v14, 429497, v78
    v_lshrrev_b32 v12, 3, v82
    v_cos_f32 v9, v9
    v_lshlrev_b16 v13, 3, v82
    v_mad_i32_i24 v11, v14, s55, v78
    v_bitop3_b32 v12, v6, v13, v12 bitop3:0xca
    v_add_lshl_u32 v11, v11, s40, 17
    v_lshlrev_b16 v14, 8, v14
    v_lshrrev_b32 v13, 2, v82
    v_or_b32 v78, v12, v11
    v_bitop3_b32 v82, v5, v13, v14 bitop3:0xea
    ds_add_u32 v82, v2
    v_mul_hi_u32_u24 v14, 429497, v79
    v_lshrrev_b32 v12, 3, v83
    v_cos_f32 v10, v10
    v_lshlrev_b16 v13, 3, v83
    v_mad_i32_i24 v11, v14, s55, v79
    v_bitop3_b32 v12, v6, v13, v12 bitop3:0xca
    v_add_lshl_u32 v11, v11, s40, 17
    v_lshlrev_b16 v14, 8, v14
    v_lshrrev_b32 v13, 2, v83
    v_or_b32 v79, v12, v11
    v_bitop3_b32 v83, v5, v13, v14 bitop3:0xea
    ds_add_u32 v83, v2
    v_cvt_pk_bf16_f32 v85, v9, v10
    v_perm_b32 v12, v85, v85, s41
    v_bitop3_b32 v78, v4, v12, v78 bitop3:0xca
    v_perm_b32 v13, v85, v85, s42
    v_bitop3_b32 v79, v4, v13, v79 bitop3:0xca
    s_waitcnt vmcnt(5)
    v_lshlrev_b32 v7, 16, v86
    v_and_b32 v8, 0xffff0000, v86
    v_lshlrev_b32 v9, 16, v87
    v_and_b32 v10, 0xffff0000, v87
    v_mul_f32 v7, 0.15915494, v7
    v_mul_f32 v8, 0.15915494, v8
    v_mul_f32 v9, 0.15915494, v9
    v_mul_f32 v10, 0.15915494, v10
    v_mul_hi_u32_u24 v14, 429497, v88
    v_lshrrev_b32 v12, 3, v92
    v_cos_f32 v7, v7
    v_lshlrev_b16 v13, 3, v92
    v_mad_i32_i24 v11, v14, s55, v88
    v_bitop3_b32 v12, v6, v13, v12 bitop3:0xca
    v_add_lshl_u32 v11, v11, s40, 17
    v_lshlrev_b16 v14, 8, v14
    v_lshrrev_b32 v13, 2, v92
    v_or_b32 v88, v12, v11
    v_bitop3_b32 v92, v5, v13, v14 bitop3:0xea
    ds_add_u32 v92, v2
    v_mul_hi_u32_u24 v14, 429497, v89
    v_lshrrev_b32 v12, 3, v93
    v_cos_f32 v8, v8
    v_lshlrev_b16 v13, 3, v93
    v_mad_i32_i24 v11, v14, s55, v89
    v_bitop3_b32 v12, v6, v13, v12 bitop3:0xca
    v_add_lshl_u32 v11, v11, s40, 17
    v_lshlrev_b16 v14, 8, v14
    v_lshrrev_b32 v13, 2, v93
    v_or_b32 v89, v12, v11
    v_bitop3_b32 v93, v5, v13, v14 bitop3:0xea
    ds_add_u32 v93, v2
    v_cvt_pk_bf16_f32 v86, v7, v8
    v_perm_b32 v12, v86, v86, s41
    v_bitop3_b32 v88, v4, v12, v88 bitop3:0xca
    v_perm_b32 v13, v86, v86, s42
    v_bitop3_b32 v89, v4, v13, v89 bitop3:0xca
    v_mul_hi_u32_u24 v14, 429497, v90
    v_lshrrev_b32 v12, 3, v94
    v_cos_f32 v9, v9
    v_lshlrev_b16 v13, 3, v94
    v_mad_i32_i24 v11, v14, s55, v90
    v_bitop3_b32 v12, v6, v13, v12 bitop3:0xca
    v_add_lshl_u32 v11, v11, s40, 17
    v_lshlrev_b16 v14, 8, v14
    v_lshrrev_b32 v13, 2, v94
    v_or_b32 v90, v12, v11
    v_bitop3_b32 v94, v5, v13, v14 bitop3:0xea
    ds_add_u32 v94, v2
    v_mul_hi_u32_u24 v14, 429497, v91
    v_lshrrev_b32 v12, 3, v95
    v_cos_f32 v10, v10
    v_lshlrev_b16 v13, 3, v95
    v_mad_i32_i24 v11, v14, s55, v91
    v_bitop3_b32 v12, v6, v13, v12 bitop3:0xca
    v_add_lshl_u32 v11, v11, s40, 17
    v_lshlrev_b16 v14, 8, v14
    v_lshrrev_b32 v13, 2, v95
    v_or_b32 v91, v12, v11
    v_bitop3_b32 v95, v5, v13, v14 bitop3:0xea
    ds_add_u32 v95, v2
    v_cvt_pk_bf16_f32 v87, v9, v10
    v_perm_b32 v12, v87, v87, s41
    v_bitop3_b32 v90, v4, v12, v90 bitop3:0xca
    v_perm_b32 v13, v87, v87, s42
    v_bitop3_b32 v91, v4, v13, v91 bitop3:0xca
    v_lshrrev_b32 v8, 2, v0
    v_and_b32 v7, 0x3c00, v0
    v_bitop3_b32 v7, v5, v8, v7 bitop3:0xea
    s_waitcnt lgkmcnt(0)
    s_barrier
    ds_read2st64_b32 v[8:9], v7 offset0:0 offset1:1
    ds_read2st64_b32 v[10:11], v7 offset0:2 offset1:3
    s_add_u32 s45, s33, 0x2004000
    buffer_load_dwordx4 v[112:115], v0, s[12:15], s45 offen nt
    s_waitcnt lgkmcnt(0)
    v_lshl_or_b32 v12, v9, 16, v8
    v_lshl_or_b32 v13, v11, 16, v10
    v_mov_b32 v14, v12
    v_mov_b32 v15, v13
    s_nop 0
    v_add_u32_dpp v14, v14, v14 row_shr:1 row_mask:0xf bank_mask:0xf bound_ctrl:1
    v_add_u32_dpp v15, v15, v15 row_shr:1 row_mask:0xf bank_mask:0xf bound_ctrl:1
    s_nop 0
    v_add_u32_dpp v14, v14, v14 row_shr:2 row_mask:0xf bank_mask:0xf bound_ctrl:1
    v_add_u32_dpp v15, v15, v15 row_shr:2 row_mask:0xf bank_mask:0xf bound_ctrl:1
    s_nop 0
    v_add_u32_dpp v14, v14, v14 row_shr:4 row_mask:0xf bank_mask:0xf bound_ctrl:1
    v_add_u32_dpp v15, v15, v15 row_shr:4 row_mask:0xf bank_mask:0xf bound_ctrl:1
    s_nop 0
    v_add_u32_dpp v14, v14, v14 row_shr:8 row_mask:0xf bank_mask:0xf bound_ctrl:1
    v_add_u32_dpp v15, v15, v15 row_shr:8 row_mask:0xf bank_mask:0xf bound_ctrl:1
    s_nop 0
    v_add_u32_dpp v14, v14, v14 row_bcast:15 row_mask:0xa bank_mask:0xf
    v_add_u32_dpp v15, v15, v15 row_bcast:15 row_mask:0xa bank_mask:0xf
    s_nop 0
    v_add_u32_dpp v14, v14, v14 row_bcast:31 row_mask:0xc bank_mask:0xf
    v_add_u32_dpp v15, v15, v15 row_bcast:31 row_mask:0xc bank_mask:0xf
    v_readlane_b32 s48, v14, 63
    v_readlane_b32 s49, v15, 63
    s_lshl_b32 s54, s32, 2
    v_mov_b32 v8, s54
    s_and_b32 s50, s48, 0xffff
    s_lshr_b32 s51, s48, 16
    s_and_b32 s52, s49, 0xffff
    s_lshr_b32 s53, s49, 16
    s_add_u32 s51, s51, s50
    s_add_u32 s52, s52, s51
    s_add_u32 s53, s53, s52
    v_mov_b32 v9, s53
    s_mov_b64 exec, 1
    ds_write_b32 v8, v9 offset:16384
    s_mov_b64 exec, -1
    v_and_b32 v8, 60, v7
    s_waitcnt lgkmcnt(0)
    s_barrier
    ds_read_b32 v9, v8 offset:16384
    s_waitcnt lgkmcnt(0)
    v_add_u32_dpp v9, v9, v9 row_shr:1 row_mask:0xf bank_mask:0xf bound_ctrl:1
    s_nop 1
    v_add_u32_dpp v9, v9, v9 row_shr:2 row_mask:0xf bank_mask:0xf bound_ctrl:1
    s_nop 1
    v_add_u32_dpp v9, v9, v9 row_shr:4 row_mask:0xf bank_mask:0xf bound_ctrl:1
    s_nop 1
    v_add_u32_dpp v9, v9, v9 row_shr:8 row_mask:0xf bank_mask:0xf bound_ctrl:1
    s_nop 0
    v_readlane_b32 s54, v9, s32
    s_sub_u32 s54, s54, s53
    s_add_u32 s50, s50, s54
    s_add_u32 s51, s51, s54
    s_add_u32 s52, s52, s54
    s_pack_ll_b32_b16 s48, s54, s50
    s_pack_ll_b32_b16 s49, s51, s52
    v_add_u32 v14, s48, v14
    v_add_u32 v15, s49, v15
    v_sub_u32 v12, v14, v12
    v_sub_u32 v13, v15, v13
    v_and_b32 v8, 0xffff, v12
    v_lshrrev_b32 v9, 16, v12
    v_and_b32 v10, 0xffff, v13
    v_lshrrev_b32 v11, 16, v13
    ds_write2st64_b32 v7, v8, v9 offset0:0 offset1:1
    ds_write2st64_b32 v7, v10, v11 offset0:2 offset1:3
    s_waitcnt lgkmcnt(0)
    s_barrier
    ds_add_rtn_u32 v20, v20, v2
    ds_add_rtn_u32 v21, v21, v2
    ds_add_rtn_u32 v22, v22, v2
    ds_add_rtn_u32 v23, v23, v2
    s_add_u32 s46, s36, 0x0
    v_and_b32 v11, 0x3f0, v0
    v_add_u32 v11, v11, v11
    buffer_store_dwordx2 v[12:13], v11, s[24:27], s46 offen
    s_bitset0_b64 exec, 63
    s_not_b64 exec, exec
    buffer_store_dwordx2 v[14:15], v11, s[24:27], s46 offen offset:32
    s_mov_b64 exec, -1
    ds_add_rtn_u32 v32, v32, v2
    ds_add_rtn_u32 v33, v33, v2
    ds_add_rtn_u32 v34, v34, v2
    ds_add_rtn_u32 v35, v35, v2
    ds_add_rtn_u32 v40, v40, v2
    ds_add_rtn_u32 v41, v41, v2
    ds_add_rtn_u32 v42, v42, v2
    ds_add_rtn_u32 v43, v43, v2
    s_add_u32 s47, s33, 0x2008000
    buffer_load_dwordx4 v[116:119], v0, s[8:11], s47 offen nt
    ds_add_rtn_u32 v52, v52, v2
    ds_add_rtn_u32 v53, v53, v2
    ds_add_rtn_u32 v54, v54, v2
    ds_add_rtn_u32 v55, v55, v2
    ds_add_rtn_u32 v60, v60, v2
    ds_add_rtn_u32 v61, v61, v2
    ds_add_rtn_u32 v62, v62, v2
    ds_add_rtn_u32 v63, v63, v2
    s_add_u32 s44, s33, 0x2008000
    buffer_load_dwordx4 v[120:123], v0, s[12:15], s44 offen nt
    ds_add_rtn_u32 v72, v72, v2
    ds_add_rtn_u32 v73, v73, v2
    ds_add_rtn_u32 v74, v74, v2
    ds_add_rtn_u32 v75, v75, v2
    ds_add_rtn_u32 v80, v80, v2
    ds_add_rtn_u32 v81, v81, v2
    ds_add_rtn_u32 v82, v82, v2
    ds_add_rtn_u32 v83, v83, v2
    s_add_u32 s45, s34, 0x1004000
    buffer_load_dwordx2 v[124:125], v1, s[16:19], s45 offen nt
    s_add_u32 s46, s34, 0x1006000
    buffer_load_dwordx2 v[126:127], v1, s[16:19], s46 offen nt
    ds_add_rtn_u32 v92, v92, v2
    ds_add_rtn_u32 v93, v93, v2
    ds_add_rtn_u32 v94, v94, v2
    ds_add_rtn_u32 v95, v95, v2
    s_waitcnt lgkmcnt(0)
    s_barrier
    v_and_b32 v7, -4, v20
    v_lshl_add_u32 v8, v20, 2, v7
    ds_write_b32 v8, v16
    v_lshl_add_u32 v7, v7, 2, v20
    ds_write_b8 v7, v24 offset:16
    v_and_b32 v9, -4, v21
    v_lshl_add_u32 v10, v21, 2, v9
    ds_write_b32 v10, v17
    v_lshl_add_u32 v9, v9, 2, v21
    ds_write_b8_d16_hi v9, v24 offset:16
    v_and_b32 v7, -4, v22
    v_lshl_add_u32 v8, v22, 2, v7
    ds_write_b32 v8, v18
    v_lshl_add_u32 v7, v7, 2, v22
    ds_write_b8 v7, v25 offset:16
    v_and_b32 v9, -4, v23
    v_lshl_add_u32 v10, v23, 2, v9
    ds_write_b32 v10, v19
    v_lshl_add_u32 v9, v9, 2, v23
    ds_write_b8_d16_hi v9, v25 offset:16
    s_add_u32 s47, s33, 0x200c000
    buffer_load_dwordx4 v[16:19], v0, s[8:11], s47 offen nt
    s_add_u32 s44, s33, 0x200c000
    buffer_load_dwordx4 v[20:23], v0, s[12:15], s44 offen nt
    v_and_b32 v7, -4, v32
    v_lshl_add_u32 v8, v32, 2, v7
    ds_write_b32 v8, v28
    v_lshl_add_u32 v7, v7, 2, v32
    ds_write_b8 v7, v26 offset:16
    v_and_b32 v9, -4, v33
    v_lshl_add_u32 v10, v33, 2, v9
    ds_write_b32 v10, v29
    v_lshl_add_u32 v9, v9, 2, v33
    ds_write_b8_d16_hi v9, v26 offset:16
    v_and_b32 v7, -4, v34
    v_lshl_add_u32 v8, v34, 2, v7
    ds_write_b32 v8, v30
    v_lshl_add_u32 v7, v7, 2, v34
    ds_write_b8 v7, v27 offset:16
    v_and_b32 v9, -4, v35
    v_lshl_add_u32 v10, v35, 2, v9
    ds_write_b32 v10, v31
    v_lshl_add_u32 v9, v9, 2, v35
    ds_write_b8_d16_hi v9, v27 offset:16
    s_add_u32 s45, s33, 0x2010000
    buffer_load_dwordx4 v[28:31], v0, s[8:11], s45 offen nt
    v_and_b32 v7, -4, v40
    v_lshl_add_u32 v8, v40, 2, v7
    ds_write_b32 v8, v36
    v_lshl_add_u32 v7, v7, 2, v40
    ds_write_b8 v7, v44 offset:16
    v_and_b32 v9, -4, v41
    v_lshl_add_u32 v10, v41, 2, v9
    ds_write_b32 v10, v37
    v_lshl_add_u32 v9, v9, 2, v41
    ds_write_b8_d16_hi v9, v44 offset:16
    v_and_b32 v7, -4, v42
    v_lshl_add_u32 v8, v42, 2, v7
    ds_write_b32 v8, v38
    v_lshl_add_u32 v7, v7, 2, v42
    ds_write_b8 v7, v45 offset:16
    v_and_b32 v9, -4, v43
    v_lshl_add_u32 v10, v43, 2, v9
    ds_write_b32 v10, v39
    v_lshl_add_u32 v9, v9, 2, v43
    ds_write_b8_d16_hi v9, v45 offset:16
    s_add_u32 s46, s33, 0x2010000
    buffer_load_dwordx4 v[32:35], v0, s[12:15], s46 offen nt
    v_and_b32 v7, -4, v52
    v_lshl_add_u32 v8, v52, 2, v7
    ds_write_b32 v8, v48
    v_lshl_add_u32 v7, v7, 2, v52
    ds_write_b8 v7, v46 offset:16
    v_and_b32 v9, -4, v53
    v_lshl_add_u32 v10, v53, 2, v9
    ds_write_b32 v10, v49
    v_lshl_add_u32 v9, v9, 2, v53
    ds_write_b8_d16_hi v9, v46 offset:16
    v_and_b32 v7, -4, v54
    v_lshl_add_u32 v8, v54, 2, v7
    ds_write_b32 v8, v50
    v_lshl_add_u32 v7, v7, 2, v54
    ds_write_b8 v7, v47 offset:16
    v_and_b32 v9, -4, v55
    v_lshl_add_u32 v10, v55, 2, v9
    ds_write_b32 v10, v51
    v_lshl_add_u32 v9, v9, 2, v55
    ds_write_b8_d16_hi v9, v47 offset:16
    s_add_u32 s47, s34, 0x1008000
    buffer_load_dwordx2 v[24:25], v1, s[16:19], s47 offen nt
    s_add_u32 s44, s34, 0x100a000
    buffer_load_dwordx2 v[26:27], v1, s[16:19], s44 offen nt
    v_and_b32 v7, -4, v60
    v_lshl_add_u32 v8, v60, 2, v7
    ds_write_b32 v8, v56
    v_lshl_add_u32 v7, v7, 2, v60
    ds_write_b8 v7, v64 offset:16
    v_and_b32 v9, -4, v61
    v_lshl_add_u32 v10, v61, 2, v9
    ds_write_b32 v10, v57
    v_lshl_add_u32 v9, v9, 2, v61
    ds_write_b8_d16_hi v9, v64 offset:16
    v_and_b32 v7, -4, v62
    v_lshl_add_u32 v8, v62, 2, v7
    ds_write_b32 v8, v58
    v_lshl_add_u32 v7, v7, 2, v62
    ds_write_b8 v7, v65 offset:16
    v_and_b32 v9, -4, v63
    v_lshl_add_u32 v10, v63, 2, v9
    ds_write_b32 v10, v59
    v_lshl_add_u32 v9, v9, 2, v63
    ds_write_b8_d16_hi v9, v65 offset:16
    s_add_u32 s45, s33, 0x2014000
    buffer_load_dwordx4 v[36:39], v0, s[8:11], s45 offen nt
    s_add_u32 s46, s33, 0x2014000
    buffer_load_dwordx4 v[40:43], v0, s[12:15], s46 offen nt
    v_and_b32 v7, -4, v72
    v_lshl_add_u32 v8, v72, 2, v7
    ds_write_b32 v8, v68
    v_lshl_add_u32 v7, v7, 2, v72
    ds_write_b8 v7, v66 offset:16
    v_and_b32 v9, -4, v73
    v_lshl_add_u32 v10, v73, 2, v9
    ds_write_b32 v10, v69
    v_lshl_add_u32 v9, v9, 2, v73
    ds_write_b8_d16_hi v9, v66 offset:16
    v_and_b32 v7, -4, v74
    v_lshl_add_u32 v8, v74, 2, v7
    ds_write_b32 v8, v70
    v_lshl_add_u32 v7, v7, 2, v74
    ds_write_b8 v7, v67 offset:16
    v_and_b32 v9, -4, v75
    v_lshl_add_u32 v10, v75, 2, v9
    ds_write_b32 v10, v71
    v_lshl_add_u32 v9, v9, 2, v75
    ds_write_b8_d16_hi v9, v67 offset:16
    s_add_u32 s47, s33, 0x2018000
    buffer_load_dwordx4 v[48:51], v0, s[8:11], s47 offen nt
    v_and_b32 v7, -4, v80
    v_lshl_add_u32 v8, v80, 2, v7
    ds_write_b32 v8, v76
    v_lshl_add_u32 v7, v7, 2, v80
    ds_write_b8 v7, v84 offset:16
    v_and_b32 v9, -4, v81
    v_lshl_add_u32 v10, v81, 2, v9
    ds_write_b32 v10, v77
    v_lshl_add_u32 v9, v9, 2, v81
    ds_write_b8_d16_hi v9, v84 offset:16
    v_and_b32 v7, -4, v82
    v_lshl_add_u32 v8, v82, 2, v7
    ds_write_b32 v8, v78
    v_lshl_add_u32 v7, v7, 2, v82
    ds_write_b8 v7, v85 offset:16
    v_and_b32 v9, -4, v83
    v_lshl_add_u32 v10, v83, 2, v9
    ds_write_b32 v10, v79
    v_lshl_add_u32 v9, v9, 2, v83
    ds_write_b8_d16_hi v9, v85 offset:16
    s_add_u32 s44, s33, 0x2018000
    buffer_load_dwordx4 v[52:55], v0, s[12:15], s44 offen nt
    v_and_b32 v7, -4, v92
    v_lshl_add_u32 v8, v92, 2, v7
    ds_write_b32 v8, v88
    v_lshl_add_u32 v7, v7, 2, v92
    ds_write_b8 v7, v86 offset:16
    v_and_b32 v9, -4, v93
    v_lshl_add_u32 v10, v93, 2, v9
    ds_write_b32 v10, v89
    v_lshl_add_u32 v9, v9, 2, v93
    ds_write_b8_d16_hi v9, v86 offset:16
    v_and_b32 v7, -4, v94
    v_lshl_add_u32 v8, v94, 2, v7
    ds_write_b32 v8, v90
    v_lshl_add_u32 v7, v7, 2, v94
    ds_write_b8 v7, v87 offset:16
    v_and_b32 v9, -4, v95
    v_lshl_add_u32 v10, v95, 2, v9
    ds_write_b32 v10, v91
    v_lshl_add_u32 v9, v9, 2, v95
    ds_write_b8_d16_hi v9, v87 offset:16
    s_add_u32 s45, s34, 0x100c000
    buffer_load_dwordx2 v[44:45], v1, s[16:19], s45 offen nt
    s_add_u32 s46, s34, 0x100e000
    buffer_load_dwordx2 v[46:47], v1, s[16:19], s46 offen nt
    v_add_u32 v7, 0x10000, v0
    v_add_u32 v12, 0x20000, v0
    v_mov_b32 v8, 0
    v_mov_b32 v9, 0
    v_mov_b32 v10, 0
    v_mov_b32 v11, 0
    s_waitcnt lgkmcnt(0)
    s_barrier
    ds_read_b128 v[56:59], v0 offset:0
    ds_write_b128 v0, v[8:11]
    ds_read_b128 v[60:63], v0 offset:16384
    ds_read_b128 v[68:71], v0 offset:32768
    ds_read_b128 v[72:75], v0 offset:49152
    ds_read_b128 v[64:67], v7 offset:0
    ds_read_b128 v[76:79], v7 offset:16384
    ds_read_b128 v[80:83], v7 offset:32768
    ds_read_b128 v[88:91], v7 offset:49152
    ds_read_b128 v[92:95], v12 offset:0
    ds_read_b128 v[84:87], v12 offset:16384
    s_waitcnt lgkmcnt(0)
    s_barrier
    s_add_u32 s47, s35, 0x0
    buffer_store_dwordx4 v[56:59], v0, s[20:23], s47 offen sc1
    s_add_u32 s44, s33, 0x201c000
    s_nop 0
    buffer_load_dwordx4 v[56:59], v0, s[8:11], s44 offen nt
    s_add_u32 s45, s35, 0x4000
    buffer_store_dwordx4 v[60:63], v0, s[20:23], s45 offen sc1
    s_add_u32 s46, s33, 0x201c000
    s_nop 0
    buffer_load_dwordx4 v[60:63], v0, s[12:15], s46 offen nt
    s_waitcnt vmcnt(24)
    v_lshlrev_b32 v7, 16, v104
    v_and_b32 v8, 0xffff0000, v104
    v_lshlrev_b32 v9, 16, v105
    v_and_b32 v10, 0xffff0000, v105
    v_mul_f32 v7, 0.15915494, v7
    v_mul_f32 v8, 0.15915494, v8
    v_mul_f32 v9, 0.15915494, v9
    v_mul_f32 v10, 0.15915494, v10
    v_mul_hi_u32_u24 v14, 429497, v96
    v_lshrrev_b32 v12, 3, v100
    v_cos_f32 v7, v7
    v_lshlrev_b16 v13, 3, v100
    v_mad_i32_i24 v11, v14, s55, v96
    v_bitop3_b32 v12, v6, v13, v12 bitop3:0xca
    v_add_lshl_u32 v11, v11, s40, 17
    v_lshlrev_b16 v14, 8, v14
    v_lshrrev_b32 v13, 2, v100
    v_or_b32 v96, v12, v11
    v_bitop3_b32 v100, v5, v13, v14 bitop3:0xea
    ds_add_u32 v100, v2
    v_mul_hi_u32_u24 v14, 429497, v97
    v_lshrrev_b32 v12, 3, v101
    v_cos_f32 v8, v8
    v_lshlrev_b16 v13, 3, v101
    v_mad_i32_i24 v11, v14, s55, v97
    v_bitop3_b32 v12, v6, v13, v12 bitop3:0xca
    v_add_lshl_u32 v11, v11, s40, 17
    v_lshlrev_b16 v14, 8, v14
    v_lshrrev_b32 v13, 2, v101
    v_or_b32 v97, v12, v11
    v_bitop3_b32 v101, v5, v13, v14 bitop3:0xea
    ds_add_u32 v101, v2
    v_cvt_pk_bf16_f32 v104, v7, v8
    v_perm_b32 v12, v104, v104, s41
    v_bitop3_b32 v96, v4, v12, v96 bitop3:0xca
    v_perm_b32 v13, v104, v104, s42
    v_bitop3_b32 v97, v4, v13, v97 bitop3:0xca
    v_mul_hi_u32_u24 v14, 429497, v98
    v_lshrrev_b32 v12, 3, v102
    v_cos_f32 v9, v9
    v_lshlrev_b16 v13, 3, v102
    v_mad_i32_i24 v11, v14, s55, v98
    v_bitop3_b32 v12, v6, v13, v12 bitop3:0xca
    v_add_lshl_u32 v11, v11, s40, 17
    v_lshlrev_b16 v14, 8, v14
    v_lshrrev_b32 v13, 2, v102
    v_or_b32 v98, v12, v11
    v_bitop3_b32 v102, v5, v13, v14 bitop3:0xea
    ds_add_u32 v102, v2
    v_mul_hi_u32_u24 v14, 429497, v99
    v_lshrrev_b32 v12, 3, v103
    v_cos_f32 v10, v10
    v_lshlrev_b16 v13, 3, v103
    v_mad_i32_i24 v11, v14, s55, v99
    v_bitop3_b32 v12, v6, v13, v12 bitop3:0xca
    v_add_lshl_u32 v11, v11, s40, 17
    v_lshlrev_b16 v14, 8, v14
    v_lshrrev_b32 v13, 2, v103
    v_or_b32 v99, v12, v11
    v_bitop3_b32 v103, v5, v13, v14 bitop3:0xea
    ds_add_u32 v103, v2
    v_cvt_pk_bf16_f32 v105, v9, v10
    v_perm_b32 v12, v105, v105, s41
    v_bitop3_b32 v98, v4, v12, v98 bitop3:0xca
    v_perm_b32 v13, v105, v105, s42
    v_bitop3_b32 v99, v4, v13, v99 bitop3:0xca
    s_add_u32 s47, s35, 0x8000
    buffer_store_dwordx4 v[68:71], v0, s[20:23], s47 offen sc1
    s_add_u32 s44, s33, 0x4000000
    s_nop 0
    buffer_load_dwordx4 v[68:71], v0, s[8:11], s44 offen nt
    s_waitcnt vmcnt(24)
    v_lshlrev_b32 v7, 16, v106
    v_and_b32 v8, 0xffff0000, v106
    v_lshlrev_b32 v9, 16, v107
    v_and_b32 v10, 0xffff0000, v107
    v_mul_f32 v7, 0.15915494, v7
    v_mul_f32 v8, 0.15915494, v8
    v_mul_f32 v9, 0.15915494, v9
    v_mul_f32 v10, 0.15915494, v10
    v_mul_hi_u32_u24 v14, 429497, v108
    v_lshrrev_b32 v12, 3, v112
    v_cos_f32 v7, v7
    v_lshlrev_b16 v13, 3, v112
    v_mad_i32_i24 v11, v14, s55, v108
    v_bitop3_b32 v12, v6, v13, v12 bitop3:0xca
    v_add_lshl_u32 v11, v11, s40, 17
    v_lshlrev_b16 v14, 8, v14
    v_lshrrev_b32 v13, 2, v112
    v_or_b32 v108, v12, v11
    v_bitop3_b32 v112, v5, v13, v14 bitop3:0xea
    ds_add_u32 v112, v2
    v_mul_hi_u32_u24 v14, 429497, v109
    v_lshrrev_b32 v12, 3, v113
    v_cos_f32 v8, v8
    v_lshlrev_b16 v13, 3, v113
    v_mad_i32_i24 v11, v14, s55, v109
    v_bitop3_b32 v12, v6, v13, v12 bitop3:0xca
    v_add_lshl_u32 v11, v11, s40, 17
    v_lshlrev_b16 v14, 8, v14
    v_lshrrev_b32 v13, 2, v113
    v_or_b32 v109, v12, v11
    v_bitop3_b32 v113, v5, v13, v14 bitop3:0xea
    ds_add_u32 v113, v2
    v_cvt_pk_bf16_f32 v106, v7, v8
    v_perm_b32 v12, v106, v106, s41
    v_bitop3_b32 v108, v4, v12, v108 bitop3:0xca
    v_perm_b32 v13, v106, v106, s42
    v_bitop3_b32 v109, v4, v13, v109 bitop3:0xca
    v_mul_hi_u32_u24 v14, 429497, v110
    v_lshrrev_b32 v12, 3, v114
    v_cos_f32 v9, v9
    v_lshlrev_b16 v13, 3, v114
    v_mad_i32_i24 v11, v14, s55, v110
    v_bitop3_b32 v12, v6, v13, v12 bitop3:0xca
    v_add_lshl_u32 v11, v11, s40, 17
    v_lshlrev_b16 v14, 8, v14
    v_lshrrev_b32 v13, 2, v114
    v_or_b32 v110, v12, v11
    v_bitop3_b32 v114, v5, v13, v14 bitop3:0xea
    ds_add_u32 v114, v2
    v_mul_hi_u32_u24 v14, 429497, v111
    v_lshrrev_b32 v12, 3, v115
    v_cos_f32 v10, v10
    v_lshlrev_b16 v13, 3, v115
    v_mad_i32_i24 v11, v14, s55, v111
    v_bitop3_b32 v12, v6, v13, v12 bitop3:0xca
    v_add_lshl_u32 v11, v11, s40, 17
    v_lshlrev_b16 v14, 8, v14
    v_lshrrev_b32 v13, 2, v115
    v_or_b32 v111, v12, v11
    v_bitop3_b32 v115, v5, v13, v14 bitop3:0xea
    ds_add_u32 v115, v2
    v_cvt_pk_bf16_f32 v107, v9, v10
    v_perm_b32 v12, v107, v107, s41
    v_bitop3_b32 v110, v4, v12, v110 bitop3:0xca
    v_perm_b32 v13, v107, v107, s42
    v_bitop3_b32 v111, v4, v13, v111 bitop3:0xca
    s_waitcnt vmcnt(18)
    v_lshlrev_b32 v7, 16, v124
    v_and_b32 v8, 0xffff0000, v124
    v_lshlrev_b32 v9, 16, v125
    v_and_b32 v10, 0xffff0000, v125
    v_mul_f32 v7, 0.15915494, v7
    v_mul_f32 v8, 0.15915494, v8
    v_mul_f32 v9, 0.15915494, v9
    v_mul_f32 v10, 0.15915494, v10
    v_mul_hi_u32_u24 v14, 429497, v116
    v_lshrrev_b32 v12, 3, v120
    v_cos_f32 v7, v7
    v_lshlrev_b16 v13, 3, v120
    v_mad_i32_i24 v11, v14, s55, v116
    v_bitop3_b32 v12, v6, v13, v12 bitop3:0xca
    v_add_lshl_u32 v11, v11, s40, 17
    v_lshlrev_b16 v14, 8, v14
    v_lshrrev_b32 v13, 2, v120
    v_or_b32 v116, v12, v11
    v_bitop3_b32 v120, v5, v13, v14 bitop3:0xea
    ds_add_u32 v120, v2
    v_mul_hi_u32_u24 v14, 429497, v117
    v_lshrrev_b32 v12, 3, v121
    v_cos_f32 v8, v8
    v_lshlrev_b16 v13, 3, v121
    v_mad_i32_i24 v11, v14, s55, v117
    v_bitop3_b32 v12, v6, v13, v12 bitop3:0xca
    v_add_lshl_u32 v11, v11, s40, 17
    v_lshlrev_b16 v14, 8, v14
    v_lshrrev_b32 v13, 2, v121
    v_or_b32 v117, v12, v11
    v_bitop3_b32 v121, v5, v13, v14 bitop3:0xea
    ds_add_u32 v121, v2
    v_cvt_pk_bf16_f32 v124, v7, v8
    v_perm_b32 v12, v124, v124, s41
    v_bitop3_b32 v116, v4, v12, v116 bitop3:0xca
    v_perm_b32 v13, v124, v124, s42
    v_bitop3_b32 v117, v4, v13, v117 bitop3:0xca
    v_mul_hi_u32_u24 v14, 429497, v118
    v_lshrrev_b32 v12, 3, v122
    v_cos_f32 v9, v9
    v_lshlrev_b16 v13, 3, v122
    v_mad_i32_i24 v11, v14, s55, v118
    v_bitop3_b32 v12, v6, v13, v12 bitop3:0xca
    v_add_lshl_u32 v11, v11, s40, 17
    v_lshlrev_b16 v14, 8, v14
    v_lshrrev_b32 v13, 2, v122
    v_or_b32 v118, v12, v11
    v_bitop3_b32 v122, v5, v13, v14 bitop3:0xea
    ds_add_u32 v122, v2
    v_mul_hi_u32_u24 v14, 429497, v119
    v_lshrrev_b32 v12, 3, v123
    v_cos_f32 v10, v10
    v_lshlrev_b16 v13, 3, v123
    v_mad_i32_i24 v11, v14, s55, v119
    v_bitop3_b32 v12, v6, v13, v12 bitop3:0xca
    v_add_lshl_u32 v11, v11, s40, 17
    v_lshlrev_b16 v14, 8, v14
    v_lshrrev_b32 v13, 2, v123
    v_or_b32 v119, v12, v11
    v_bitop3_b32 v123, v5, v13, v14 bitop3:0xea
    ds_add_u32 v123, v2
    v_cvt_pk_bf16_f32 v125, v9, v10
    v_perm_b32 v12, v125, v125, s41
    v_bitop3_b32 v118, v4, v12, v118 bitop3:0xca
    v_perm_b32 v13, v125, v125, s42
    v_bitop3_b32 v119, v4, v13, v119 bitop3:0xca
    s_add_u32 s45, s35, 0xc000
    buffer_store_dwordx4 v[72:75], v0, s[20:23], s45 offen sc1
    s_add_u32 s46, s33, 0x4000000
    s_nop 0
    buffer_load_dwordx4 v[72:75], v0, s[12:15], s46 offen nt
    s_waitcnt vmcnt(18)
    v_lshlrev_b32 v7, 16, v126
    v_and_b32 v8, 0xffff0000, v126
    v_lshlrev_b32 v9, 16, v127
    v_and_b32 v10, 0xffff0000, v127
    v_mul_f32 v7, 0.15915494, v7
    v_mul_f32 v8, 0.15915494, v8
    v_mul_f32 v9, 0.15915494, v9
    v_mul_f32 v10, 0.15915494, v10
    v_mul_hi_u32_u24 v14, 429497, v16
    v_lshrrev_b32 v12, 3, v20
    v_cos_f32 v7, v7
    v_lshlrev_b16 v13, 3, v20
    v_mad_i32_i24 v11, v14, s55, v16
    v_bitop3_b32 v12, v6, v13, v12 bitop3:0xca
    v_add_lshl_u32 v11, v11, s40, 17
    v_lshlrev_b16 v14, 8, v14
    v_lshrrev_b32 v13, 2, v20
    v_or_b32 v16, v12, v11
    v_bitop3_b32 v20, v5, v13, v14 bitop3:0xea
    ds_add_u32 v20, v2
    v_mul_hi_u32_u24 v14, 429497, v17
    v_lshrrev_b32 v12, 3, v21
    v_cos_f32 v8, v8
    v_lshlrev_b16 v13, 3, v21
    v_mad_i32_i24 v11, v14, s55, v17
    v_bitop3_b32 v12, v6, v13, v12 bitop3:0xca
    v_add_lshl_u32 v11, v11, s40, 17
    v_lshlrev_b16 v14, 8, v14
    v_lshrrev_b32 v13, 2, v21
    v_or_b32 v17, v12, v11
    v_bitop3_b32 v21, v5, v13, v14 bitop3:0xea
    ds_add_u32 v21, v2
    v_cvt_pk_bf16_f32 v126, v7, v8
    v_perm_b32 v12, v126, v126, s41
    v_bitop3_b32 v16, v4, v12, v16 bitop3:0xca
    v_perm_b32 v13, v126, v126, s42
    v_bitop3_b32 v17, v4, v13, v17 bitop3:0xca
    v_mul_hi_u32_u24 v14, 429497, v18
    v_lshrrev_b32 v12, 3, v22
    v_cos_f32 v9, v9
    v_lshlrev_b16 v13, 3, v22
    v_mad_i32_i24 v11, v14, s55, v18
    v_bitop3_b32 v12, v6, v13, v12 bitop3:0xca
    v_add_lshl_u32 v11, v11, s40, 17
    v_lshlrev_b16 v14, 8, v14
    v_lshrrev_b32 v13, 2, v22
    v_or_b32 v18, v12, v11
    v_bitop3_b32 v22, v5, v13, v14 bitop3:0xea
    ds_add_u32 v22, v2
    v_mul_hi_u32_u24 v14, 429497, v19
    v_lshrrev_b32 v12, 3, v23
    v_cos_f32 v10, v10
    v_lshlrev_b16 v13, 3, v23
    v_mad_i32_i24 v11, v14, s55, v19
    v_bitop3_b32 v12, v6, v13, v12 bitop3:0xca
    v_add_lshl_u32 v11, v11, s40, 17
    v_lshlrev_b16 v14, 8, v14
    v_lshrrev_b32 v13, 2, v23
    v_or_b32 v19, v12, v11
    v_bitop3_b32 v23, v5, v13, v14 bitop3:0xea
    ds_add_u32 v23, v2
    v_cvt_pk_bf16_f32 v127, v9, v10
    v_perm_b32 v12, v127, v127, s41
    v_bitop3_b32 v18, v4, v12, v18 bitop3:0xca
    v_perm_b32 v13, v127, v127, s42
    v_bitop3_b32 v19, v4, v13, v19 bitop3:0xca
    s_waitcnt vmcnt(14)
    v_lshlrev_b32 v7, 16, v24
    v_and_b32 v8, 0xffff0000, v24
    v_lshlrev_b32 v9, 16, v25
    v_and_b32 v10, 0xffff0000, v25
    v_mul_f32 v7, 0.15915494, v7
    v_mul_f32 v8, 0.15915494, v8
    v_mul_f32 v9, 0.15915494, v9
    v_mul_f32 v10, 0.15915494, v10
    v_mul_hi_u32_u24 v14, 429497, v28
    v_lshrrev_b32 v12, 3, v32
    v_cos_f32 v7, v7
    v_lshlrev_b16 v13, 3, v32
    v_mad_i32_i24 v11, v14, s55, v28
    v_bitop3_b32 v12, v6, v13, v12 bitop3:0xca
    v_add_lshl_u32 v11, v11, s40, 17
    v_lshlrev_b16 v14, 8, v14
    v_lshrrev_b32 v13, 2, v32
    v_or_b32 v28, v12, v11
    v_bitop3_b32 v32, v5, v13, v14 bitop3:0xea
    ds_add_u32 v32, v2
    v_mul_hi_u32_u24 v14, 429497, v29
    v_lshrrev_b32 v12, 3, v33
    v_cos_f32 v8, v8
    v_lshlrev_b16 v13, 3, v33
    v_mad_i32_i24 v11, v14, s55, v29
    v_bitop3_b32 v12, v6, v13, v12 bitop3:0xca
    v_add_lshl_u32 v11, v11, s40, 17
    v_lshlrev_b16 v14, 8, v14
    v_lshrrev_b32 v13, 2, v33
    v_or_b32 v29, v12, v11
    v_bitop3_b32 v33, v5, v13, v14 bitop3:0xea
    ds_add_u32 v33, v2
    v_cvt_pk_bf16_f32 v24, v7, v8
    v_perm_b32 v12, v24, v24, s41
    v_bitop3_b32 v28, v4, v12, v28 bitop3:0xca
    v_perm_b32 v13, v24, v24, s42
    v_bitop3_b32 v29, v4, v13, v29 bitop3:0xca
    v_mul_hi_u32_u24 v14, 429497, v30
    v_lshrrev_b32 v12, 3, v34
    v_cos_f32 v9, v9
    v_lshlrev_b16 v13, 3, v34
    v_mad_i32_i24 v11, v14, s55, v30
    v_bitop3_b32 v12, v6, v13, v12 bitop3:0xca
    v_add_lshl_u32 v11, v11, s40, 17
    v_lshlrev_b16 v14, 8, v14
    v_lshrrev_b32 v13, 2, v34
    v_or_b32 v30, v12, v11
    v_bitop3_b32 v34, v5, v13, v14 bitop3:0xea
    ds_add_u32 v34, v2
    v_mul_hi_u32_u24 v14, 429497, v31
    v_lshrrev_b32 v12, 3, v35
    v_cos_f32 v10, v10
    v_lshlrev_b16 v13, 3, v35
    v_mad_i32_i24 v11, v14, s55, v31
    v_bitop3_b32 v12, v6, v13, v12 bitop3:0xca
    v_add_lshl_u32 v11, v11, s40, 17
    v_lshlrev_b16 v14, 8, v14
    v_lshrrev_b32 v13, 2, v35
    v_or_b32 v31, v12, v11
    v_bitop3_b32 v35, v5, v13, v14 bitop3:0xea
    ds_add_u32 v35, v2
    v_cvt_pk_bf16_f32 v25, v9, v10
    v_perm_b32 v12, v25, v25, s41
    v_bitop3_b32 v30, v4, v12, v30 bitop3:0xca
    v_perm_b32 v13, v25, v25, s42
    v_bitop3_b32 v31, v4, v13, v31 bitop3:0xca
    s_add_u32 s47, s35, 0x10000
    buffer_store_dwordx4 v[64:67], v0, s[20:23], s47 offen sc1
    s_add_u32 s44, s34, 0x2000000
    s_nop 0
    buffer_load_dwordx2 v[64:65], v1, s[16:19], s44 offen nt
    s_add_u32 s45, s34, 0x2002000
    buffer_load_dwordx2 v[66:67], v1, s[16:19], s45 offen nt
    s_waitcnt vmcnt(15)
    v_lshlrev_b32 v7, 16, v26
    v_and_b32 v8, 0xffff0000, v26
    v_lshlrev_b32 v9, 16, v27
    v_and_b32 v10, 0xffff0000, v27
    v_mul_f32 v7, 0.15915494, v7
    v_mul_f32 v8, 0.15915494, v8
    v_mul_f32 v9, 0.15915494, v9
    v_mul_f32 v10, 0.15915494, v10
    v_mul_hi_u32_u24 v14, 429497, v36
    v_lshrrev_b32 v12, 3, v40
    v_cos_f32 v7, v7
    v_lshlrev_b16 v13, 3, v40
    v_mad_i32_i24 v11, v14, s55, v36
    v_bitop3_b32 v12, v6, v13, v12 bitop3:0xca
    v_add_lshl_u32 v11, v11, s40, 17
    v_lshlrev_b16 v14, 8, v14
    v_lshrrev_b32 v13, 2, v40
    v_or_b32 v36, v12, v11
    v_bitop3_b32 v40, v5, v13, v14 bitop3:0xea
    ds_add_u32 v40, v2
    v_mul_hi_u32_u24 v14, 429497, v37
    v_lshrrev_b32 v12, 3, v41
    v_cos_f32 v8, v8
    v_lshlrev_b16 v13, 3, v41
    v_mad_i32_i24 v11, v14, s55, v37
    v_bitop3_b32 v12, v6, v13, v12 bitop3:0xca
    v_add_lshl_u32 v11, v11, s40, 17
    v_lshlrev_b16 v14, 8, v14
    v_lshrrev_b32 v13, 2, v41
    v_or_b32 v37, v12, v11
    v_bitop3_b32 v41, v5, v13, v14 bitop3:0xea
    ds_add_u32 v41, v2
    v_cvt_pk_bf16_f32 v26, v7, v8
    v_perm_b32 v12, v26, v26, s41
    v_bitop3_b32 v36, v4, v12, v36 bitop3:0xca
    v_perm_b32 v13, v26, v26, s42
    v_bitop3_b32 v37, v4, v13, v37 bitop3:0xca
    v_mul_hi_u32_u24 v14, 429497, v38
    v_lshrrev_b32 v12, 3, v42
    v_cos_f32 v9, v9
    v_lshlrev_b16 v13, 3, v42
    v_mad_i32_i24 v11, v14, s55, v38
    v_bitop3_b32 v12, v6, v13, v12 bitop3:0xca
    v_add_lshl_u32 v11, v11, s40, 17
    v_lshlrev_b16 v14, 8, v14
    v_lshrrev_b32 v13, 2, v42
    v_or_b32 v38, v12, v11
    v_bitop3_b32 v42, v5, v13, v14 bitop3:0xea
    ds_add_u32 v42, v2
    v_mul_hi_u32_u24 v14, 429497, v39
    v_lshrrev_b32 v12, 3, v43
    v_cos_f32 v10, v10
    v_lshlrev_b16 v13, 3, v43
    v_mad_i32_i24 v11, v14, s55, v39
    v_bitop3_b32 v12, v6, v13, v12 bitop3:0xca
    v_add_lshl_u32 v11, v11, s40, 17
    v_lshlrev_b16 v14, 8, v14
    v_lshrrev_b32 v13, 2, v43
    v_or_b32 v39, v12, v11
    v_bitop3_b32 v43, v5, v13, v14 bitop3:0xea
    ds_add_u32 v43, v2
    v_cvt_pk_bf16_f32 v27, v9, v10
    v_perm_b32 v12, v27, v27, s41
    v_bitop3_b32 v38, v4, v12, v38 bitop3:0xca
    v_perm_b32 v13, v27, v27, s42
    v_bitop3_b32 v39, v4, v13, v39 bitop3:0xca
    s_waitcnt vmcnt(11)
    v_lshlrev_b32 v7, 16, v44
    v_and_b32 v8, 0xffff0000, v44
    v_lshlrev_b32 v9, 16, v45
    v_and_b32 v10, 0xffff0000, v45
    v_mul_f32 v7, 0.15915494, v7
    v_mul_f32 v8, 0.15915494, v8
    v_mul_f32 v9, 0.15915494, v9
    v_mul_f32 v10, 0.15915494, v10
    v_mul_hi_u32_u24 v14, 429497, v48
    v_lshrrev_b32 v12, 3, v52
    v_cos_f32 v7, v7
    v_lshlrev_b16 v13, 3, v52
    v_mad_i32_i24 v11, v14, s55, v48
    v_bitop3_b32 v12, v6, v13, v12 bitop3:0xca
    v_add_lshl_u32 v11, v11, s40, 17
    v_lshlrev_b16 v14, 8, v14
    v_lshrrev_b32 v13, 2, v52
    v_or_b32 v48, v12, v11
    v_bitop3_b32 v52, v5, v13, v14 bitop3:0xea
    ds_add_u32 v52, v2
    v_mul_hi_u32_u24 v14, 429497, v49
    v_lshrrev_b32 v12, 3, v53
    v_cos_f32 v8, v8
    v_lshlrev_b16 v13, 3, v53
    v_mad_i32_i24 v11, v14, s55, v49
    v_bitop3_b32 v12, v6, v13, v12 bitop3:0xca
    v_add_lshl_u32 v11, v11, s40, 17
    v_lshlrev_b16 v14, 8, v14
    v_lshrrev_b32 v13, 2, v53
    v_or_b32 v49, v12, v11
    v_bitop3_b32 v53, v5, v13, v14 bitop3:0xea
    ds_add_u32 v53, v2
    v_cvt_pk_bf16_f32 v44, v7, v8
    v_perm_b32 v12, v44, v44, s41
    v_bitop3_b32 v48, v4, v12, v48 bitop3:0xca
    v_perm_b32 v13, v44, v44, s42
    v_bitop3_b32 v49, v4, v13, v49 bitop3:0xca
    v_mul_hi_u32_u24 v14, 429497, v50
    v_lshrrev_b32 v12, 3, v54
    v_cos_f32 v9, v9
    v_lshlrev_b16 v13, 3, v54
    v_mad_i32_i24 v11, v14, s55, v50
    v_bitop3_b32 v12, v6, v13, v12 bitop3:0xca
    v_add_lshl_u32 v11, v11, s40, 17
    v_lshlrev_b16 v14, 8, v14
    v_lshrrev_b32 v13, 2, v54
    v_or_b32 v50, v12, v11
    v_bitop3_b32 v54, v5, v13, v14 bitop3:0xea
    ds_add_u32 v54, v2
    v_mul_hi_u32_u24 v14, 429497, v51
    v_lshrrev_b32 v12, 3, v55
    v_cos_f32 v10, v10
    v_lshlrev_b16 v13, 3, v55
    v_mad_i32_i24 v11, v14, s55, v51
    v_bitop3_b32 v12, v6, v13, v12 bitop3:0xca
    v_add_lshl_u32 v11, v11, s40, 17
    v_lshlrev_b16 v14, 8, v14
    v_lshrrev_b32 v13, 2, v55
    v_or_b32 v51, v12, v11
    v_bitop3_b32 v55, v5, v13, v14 bitop3:0xea
    ds_add_u32 v55, v2
    v_cvt_pk_bf16_f32 v45, v9, v10
    v_perm_b32 v12, v45, v45, s41
    v_bitop3_b32 v50, v4, v12, v50 bitop3:0xca
    v_perm_b32 v13, v45, v45, s42
    v_bitop3_b32 v51, v4, v13, v51 bitop3:0xca
    s_add_u32 s46, s35, 0x14000
    buffer_store_dwordx4 v[76:79], v0, s[20:23], s46 offen sc1
    s_add_u32 s47, s33, 0x4004000
    s_nop 0
    buffer_load_dwordx4 v[76:79], v0, s[8:11], s47 offen nt
    s_waitcnt vmcnt(9)
    v_lshlrev_b32 v7, 16, v46
    v_and_b32 v8, 0xffff0000, v46
    v_lshlrev_b32 v9, 16, v47
    v_and_b32 v10, 0xffff0000, v47
    v_mul_f32 v7, 0.15915494, v7
    v_mul_f32 v8, 0.15915494, v8
    v_mul_f32 v9, 0.15915494, v9
    v_mul_f32 v10, 0.15915494, v10
    v_mul_hi_u32_u24 v14, 429497, v56
    v_lshrrev_b32 v12, 3, v60
    v_cos_f32 v7, v7
    v_lshlrev_b16 v13, 3, v60
    v_mad_i32_i24 v11, v14, s55, v56
    v_bitop3_b32 v12, v6, v13, v12 bitop3:0xca
    v_add_lshl_u32 v11, v11, s40, 17
    v_lshlrev_b16 v14, 8, v14
    v_lshrrev_b32 v13, 2, v60
    v_or_b32 v56, v12, v11
    v_bitop3_b32 v60, v5, v13, v14 bitop3:0xea
    ds_add_u32 v60, v2
    v_mul_hi_u32_u24 v14, 429497, v57
    v_lshrrev_b32 v12, 3, v61
    v_cos_f32 v8, v8
    v_lshlrev_b16 v13, 3, v61
    v_mad_i32_i24 v11, v14, s55, v57
    v_bitop3_b32 v12, v6, v13, v12 bitop3:0xca
    v_add_lshl_u32 v11, v11, s40, 17
    v_lshlrev_b16 v14, 8, v14
    v_lshrrev_b32 v13, 2, v61
    v_or_b32 v57, v12, v11
    v_bitop3_b32 v61, v5, v13, v14 bitop3:0xea
    ds_add_u32 v61, v2
    v_cvt_pk_bf16_f32 v46, v7, v8
    v_perm_b32 v12, v46, v46, s41
    v_bitop3_b32 v56, v4, v12, v56 bitop3:0xca
    v_perm_b32 v13, v46, v46, s42
    v_bitop3_b32 v57, v4, v13, v57 bitop3:0xca
    v_mul_hi_u32_u24 v14, 429497, v58
    v_lshrrev_b32 v12, 3, v62
    v_cos_f32 v9, v9
    v_lshlrev_b16 v13, 3, v62
    v_mad_i32_i24 v11, v14, s55, v58
    v_bitop3_b32 v12, v6, v13, v12 bitop3:0xca
    v_add_lshl_u32 v11, v11, s40, 17
    v_lshlrev_b16 v14, 8, v14
    v_lshrrev_b32 v13, 2, v62
    v_or_b32 v58, v12, v11
    v_bitop3_b32 v62, v5, v13, v14 bitop3:0xea
    ds_add_u32 v62, v2
    v_mul_hi_u32_u24 v14, 429497, v59
    v_lshrrev_b32 v12, 3, v63
    v_cos_f32 v10, v10
    v_lshlrev_b16 v13, 3, v63
    v_mad_i32_i24 v11, v14, s55, v59
    v_bitop3_b32 v12, v6, v13, v12 bitop3:0xca
    v_add_lshl_u32 v11, v11, s40, 17
    v_lshlrev_b16 v14, 8, v14
    v_lshrrev_b32 v13, 2, v63
    v_or_b32 v59, v12, v11
    v_bitop3_b32 v63, v5, v13, v14 bitop3:0xea
    ds_add_u32 v63, v2
    v_cvt_pk_bf16_f32 v47, v9, v10
    v_perm_b32 v12, v47, v47, s41
    v_bitop3_b32 v58, v4, v12, v58 bitop3:0xca
    v_perm_b32 v13, v47, v47, s42
    v_bitop3_b32 v59, v4, v13, v59 bitop3:0xca
    v_lshrrev_b32 v8, 2, v0
    v_and_b32 v7, 0x3c00, v0
    v_bitop3_b32 v7, v5, v8, v7 bitop3:0xea
    s_waitcnt lgkmcnt(0)
    s_barrier
    ds_read2st64_b32 v[8:9], v7 offset0:0 offset1:1
    ds_read2st64_b32 v[10:11], v7 offset0:2 offset1:3
    s_add_u32 s44, s35, 0x18000
    buffer_store_dwordx4 v[80:83], v0, s[20:23], s44 offen sc1
    s_add_u32 s45, s33, 0x4004000
    s_nop 0
    buffer_load_dwordx4 v[80:83], v0, s[12:15], s45 offen nt
    s_waitcnt lgkmcnt(0)
    v_lshl_or_b32 v12, v9, 16, v8
    v_lshl_or_b32 v13, v11, 16, v10
    v_mov_b32 v14, v12
    v_mov_b32 v15, v13
    s_nop 0
    v_add_u32_dpp v14, v14, v14 row_shr:1 row_mask:0xf bank_mask:0xf bound_ctrl:1
    v_add_u32_dpp v15, v15, v15 row_shr:1 row_mask:0xf bank_mask:0xf bound_ctrl:1
    s_nop 0
    v_add_u32_dpp v14, v14, v14 row_shr:2 row_mask:0xf bank_mask:0xf bound_ctrl:1
    v_add_u32_dpp v15, v15, v15 row_shr:2 row_mask:0xf bank_mask:0xf bound_ctrl:1
    s_nop 0
    v_add_u32_dpp v14, v14, v14 row_shr:4 row_mask:0xf bank_mask:0xf bound_ctrl:1
    v_add_u32_dpp v15, v15, v15 row_shr:4 row_mask:0xf bank_mask:0xf bound_ctrl:1
    s_nop 0
    v_add_u32_dpp v14, v14, v14 row_shr:8 row_mask:0xf bank_mask:0xf bound_ctrl:1
    v_add_u32_dpp v15, v15, v15 row_shr:8 row_mask:0xf bank_mask:0xf bound_ctrl:1
    s_nop 0
    v_add_u32_dpp v14, v14, v14 row_bcast:15 row_mask:0xa bank_mask:0xf
    v_add_u32_dpp v15, v15, v15 row_bcast:15 row_mask:0xa bank_mask:0xf
    s_nop 0
    v_add_u32_dpp v14, v14, v14 row_bcast:31 row_mask:0xc bank_mask:0xf
    v_add_u32_dpp v15, v15, v15 row_bcast:31 row_mask:0xc bank_mask:0xf
    v_readlane_b32 s48, v14, 63
    v_readlane_b32 s49, v15, 63
    s_lshl_b32 s54, s32, 2
    v_mov_b32 v8, s54
    s_and_b32 s50, s48, 0xffff
    s_lshr_b32 s51, s48, 16
    s_and_b32 s52, s49, 0xffff
    s_lshr_b32 s53, s49, 16
    s_add_u32 s51, s51, s50
    s_add_u32 s52, s52, s51
    s_add_u32 s53, s53, s52
    v_mov_b32 v9, s53
    s_mov_b64 exec, 1
    ds_write_b32 v8, v9 offset:16384
    s_mov_b64 exec, -1
    v_and_b32 v8, 60, v7
    s_waitcnt lgkmcnt(0)
    s_barrier
    ds_read_b32 v9, v8 offset:16384
    s_waitcnt lgkmcnt(0)
    v_add_u32_dpp v9, v9, v9 row_shr:1 row_mask:0xf bank_mask:0xf bound_ctrl:1
    s_nop 1
    v_add_u32_dpp v9, v9, v9 row_shr:2 row_mask:0xf bank_mask:0xf bound_ctrl:1
    s_nop 1
    v_add_u32_dpp v9, v9, v9 row_shr:4 row_mask:0xf bank_mask:0xf bound_ctrl:1
    s_nop 1
    v_add_u32_dpp v9, v9, v9 row_shr:8 row_mask:0xf bank_mask:0xf bound_ctrl:1
    s_nop 0
    v_readlane_b32 s54, v9, s32
    s_sub_u32 s54, s54, s53
    s_add_u32 s50, s50, s54
    s_add_u32 s51, s51, s54
    s_add_u32 s52, s52, s54
    s_pack_ll_b32_b16 s48, s54, s50
    s_pack_ll_b32_b16 s49, s51, s52
    v_add_u32 v14, s48, v14
    v_add_u32 v15, s49, v15
    v_sub_u32 v12, v14, v12
    v_sub_u32 v13, v15, v13
    v_and_b32 v8, 0xffff, v12
    v_lshrrev_b32 v9, 16, v12
    v_and_b32 v10, 0xffff, v13
    v_lshrrev_b32 v11, 16, v13
    ds_write2st64_b32 v7, v8, v9 offset0:0 offset1:1
    ds_write2st64_b32 v7, v10, v11 offset0:2 offset1:3
    s_waitcnt lgkmcnt(0)
    s_barrier
    ds_add_rtn_u32 v100, v100, v2
    ds_add_rtn_u32 v101, v101, v2
    ds_add_rtn_u32 v102, v102, v2
    ds_add_rtn_u32 v103, v103, v2
    s_add_u32 s46, s36, 0x2a40000
    v_and_b32 v11, 0x3f0, v0
    v_add_u32 v11, v11, v11
    buffer_store_dwordx2 v[12:13], v11, s[24:27], s46 offen
    s_bitset0_b64 exec, 63
    s_not_b64 exec, exec
    buffer_store_dwordx2 v[14:15], v11, s[24:27], s46 offen offset:32
    s_mov_b64 exec, -1
    ds_add_rtn_u32 v112, v112, v2
    ds_add_rtn_u32 v113, v113, v2
    ds_add_rtn_u32 v114, v114, v2
    ds_add_rtn_u32 v115, v115, v2
    ds_add_rtn_u32 v120, v120, v2
    ds_add_rtn_u32 v121, v121, v2
    ds_add_rtn_u32 v122, v122, v2
    ds_add_rtn_u32 v123, v123, v2
    s_add_u32 s47, s35, 0x1c000
    buffer_store_dwordx4 v[88:91], v0, s[20:23], s47 offen sc1
    s_add_u32 s44, s33, 0x4008000
    s_nop 0
    buffer_load_dwordx4 v[88:91], v0, s[8:11], s44 offen nt
    ds_add_rtn_u32 v20, v20, v2
    ds_add_rtn_u32 v21, v21, v2
    ds_add_rtn_u32 v22, v22, v2
    ds_add_rtn_u32 v23, v23, v2
    ds_add_rtn_u32 v32, v32, v2
    ds_add_rtn_u32 v33, v33, v2
    ds_add_rtn_u32 v34, v34, v2
    ds_add_rtn_u32 v35, v35, v2
    s_add_u32 s45, s35, 0x20000
    buffer_store_dwordx4 v[92:95], v0, s[20:23], s45 offen sc1
    s_add_u32 s46, s33, 0x4008000
    s_nop 0
    buffer_load_dwordx4 v[92:95], v0, s[12:15], s46 offen nt
    ds_add_rtn_u32 v40, v40, v2
    ds_add_rtn_u32 v41, v41, v2
    ds_add_rtn_u32 v42, v42, v2
    ds_add_rtn_u32 v43, v43, v2
    ds_add_rtn_u32 v52, v52, v2
    ds_add_rtn_u32 v53, v53, v2
    ds_add_rtn_u32 v54, v54, v2
    ds_add_rtn_u32 v55, v55, v2
    s_add_u32 s47, s35, 0x24000
    buffer_store_dwordx4 v[84:87], v0, s[20:23], s47 offen sc1
    s_add_u32 s44, s34, 0x2004000
    s_nop 0
    buffer_load_dwordx2 v[84:85], v1, s[16:19], s44 offen nt
    s_add_u32 s45, s34, 0x2006000
    buffer_load_dwordx2 v[86:87], v1, s[16:19], s45 offen nt
    ds_add_rtn_u32 v60, v60, v2
    ds_add_rtn_u32 v61, v61, v2
    ds_add_rtn_u32 v62, v62, v2
    ds_add_rtn_u32 v63, v63, v2
    s_waitcnt lgkmcnt(0)
    s_barrier
    v_and_b32 v7, -4, v100
    v_lshl_add_u32 v8, v100, 2, v7
    ds_write_b32 v8, v96
    v_lshl_add_u32 v7, v7, 2, v100
    ds_write_b8 v7, v104 offset:16
    v_and_b32 v9, -4, v101
    v_lshl_add_u32 v10, v101, 2, v9
    ds_write_b32 v10, v97
    v_lshl_add_u32 v9, v9, 2, v101
    ds_write_b8_d16_hi v9, v104 offset:16
    v_and_b32 v7, -4, v102
    v_lshl_add_u32 v8, v102, 2, v7
    ds_write_b32 v8, v98
    v_lshl_add_u32 v7, v7, 2, v102
    ds_write_b8 v7, v105 offset:16
    v_and_b32 v9, -4, v103
    v_lshl_add_u32 v10, v103, 2, v9
    ds_write_b32 v10, v99
    v_lshl_add_u32 v9, v9, 2, v103
    ds_write_b8_d16_hi v9, v105 offset:16
    s_add_u32 s46, s33, 0x400c000
    buffer_load_dwordx4 v[96:99], v0, s[8:11], s46 offen nt
    s_add_u32 s47, s33, 0x400c000
    buffer_load_dwordx4 v[100:103], v0, s[12:15], s47 offen nt
    v_and_b32 v7, -4, v112
    v_lshl_add_u32 v8, v112, 2, v7
    ds_write_b32 v8, v108
    v_lshl_add_u32 v7, v7, 2, v112
    ds_write_b8 v7, v106 offset:16
    v_and_b32 v9, -4, v113
    v_lshl_add_u32 v10, v113, 2, v9
    ds_write_b32 v10, v109
    v_lshl_add_u32 v9, v9, 2, v113
    ds_write_b8_d16_hi v9, v106 offset:16
    v_and_b32 v7, -4, v114
    v_lshl_add_u32 v8, v114, 2, v7
    ds_write_b32 v8, v110
    v_lshl_add_u32 v7, v7, 2, v114
    ds_write_b8 v7, v107 offset:16
    v_and_b32 v9, -4, v115
    v_lshl_add_u32 v10, v115, 2, v9
    ds_write_b32 v10, v111
    v_lshl_add_u32 v9, v9, 2, v115
    ds_write_b8_d16_hi v9, v107 offset:16
    s_add_u32 s44, s33, 0x4010000
    buffer_load_dwordx4 v[108:111], v0, s[8:11], s44 offen nt
    v_and_b32 v7, -4, v120
    v_lshl_add_u32 v8, v120, 2, v7
    ds_write_b32 v8, v116
    v_lshl_add_u32 v7, v7, 2, v120
    ds_write_b8 v7, v124 offset:16
    v_and_b32 v9, -4, v121
    v_lshl_add_u32 v10, v121, 2, v9
    ds_write_b32 v10, v117
    v_lshl_add_u32 v9, v9, 2, v121
    ds_write_b8_d16_hi v9, v124 offset:16
    v_and_b32 v7, -4, v122
    v_lshl_add_u32 v8, v122, 2, v7
    ds_write_b32 v8, v118
    v_lshl_add_u32 v7, v7, 2, v122
    ds_write_b8 v7, v125 offset:16
    v_and_b32 v9, -4, v123
    v_lshl_add_u32 v10, v123, 2, v9
    ds_write_b32 v10, v119
    v_lshl_add_u32 v9, v9, 2, v123
    ds_write_b8_d16_hi v9, v125 offset:16
    s_add_u32 s45, s33, 0x4010000
    buffer_load_dwordx4 v[112:115], v0, s[12:15], s45 offen nt
    v_and_b32 v7, -4, v20
    v_lshl_add_u32 v8, v20, 2, v7
    ds_write_b32 v8, v16
    v_lshl_add_u32 v7, v7, 2, v20
    ds_write_b8 v7, v126 offset:16
    v_and_b32 v9, -4, v21
    v_lshl_add_u32 v10, v21, 2, v9
    ds_write_b32 v10, v17
    v_lshl_add_u32 v9, v9, 2, v21
    ds_write_b8_d16_hi v9, v126 offset:16
    v_and_b32 v7, -4, v22
    v_lshl_add_u32 v8, v22, 2, v7
    ds_write_b32 v8, v18
    v_lshl_add_u32 v7, v7, 2, v22
    ds_write_b8 v7, v127 offset:16
    v_and_b32 v9, -4, v23
    v_lshl_add_u32 v10, v23, 2, v9
    ds_write_b32 v10, v19
    v_lshl_add_u32 v9, v9, 2, v23
    ds_write_b8_d16_hi v9, v127 offset:16
    s_add_u32 s46, s34, 0x2008000
    buffer_load_dwordx2 v[104:105], v1, s[16:19], s46 offen nt
    s_add_u32 s47, s34, 0x200a000
    buffer_load_dwordx2 v[106:107], v1, s[16:19], s47 offen nt
    v_and_b32 v7, -4, v32
    v_lshl_add_u32 v8, v32, 2, v7
    ds_write_b32 v8, v28
    v_lshl_add_u32 v7, v7, 2, v32
    ds_write_b8 v7, v24 offset:16
    v_and_b32 v9, -4, v33
    v_lshl_add_u32 v10, v33, 2, v9
    ds_write_b32 v10, v29
    v_lshl_add_u32 v9, v9, 2, v33
    ds_write_b8_d16_hi v9, v24 offset:16
    v_and_b32 v7, -4, v34
    v_lshl_add_u32 v8, v34, 2, v7
    ds_write_b32 v8, v30
    v_lshl_add_u32 v7, v7, 2, v34
    ds_write_b8 v7, v25 offset:16
    v_and_b32 v9, -4, v35
    v_lshl_add_u32 v10, v35, 2, v9
    ds_write_b32 v10, v31
    v_lshl_add_u32 v9, v9, 2, v35
    ds_write_b8_d16_hi v9, v25 offset:16
    s_add_u32 s44, s33, 0x4014000
    buffer_load_dwordx4 v[116:119], v0, s[8:11], s44 offen nt
    s_add_u32 s45, s33, 0x4014000
    buffer_load_dwordx4 v[120:123], v0, s[12:15], s45 offen nt
    v_and_b32 v7, -4, v40
    v_lshl_add_u32 v8, v40, 2, v7
    ds_write_b32 v8, v36
    v_lshl_add_u32 v7, v7, 2, v40
    ds_write_b8 v7, v26 offset:16
    v_and_b32 v9, -4, v41
    v_lshl_add_u32 v10, v41, 2, v9
    ds_write_b32 v10, v37
    v_lshl_add_u32 v9, v9, 2, v41
    ds_write_b8_d16_hi v9, v26 offset:16
    v_and_b32 v7, -4, v42
    v_lshl_add_u32 v8, v42, 2, v7
    ds_write_b32 v8, v38
    v_lshl_add_u32 v7, v7, 2, v42
    ds_write_b8 v7, v27 offset:16
    v_and_b32 v9, -4, v43
    v_lshl_add_u32 v10, v43, 2, v9
    ds_write_b32 v10, v39
    v_lshl_add_u32 v9, v9, 2, v43
    ds_write_b8_d16_hi v9, v27 offset:16
    s_add_u32 s46, s33, 0x4018000
    buffer_load_dwordx4 v[16:19], v0, s[8:11], s46 offen nt
    v_and_b32 v7, -4, v52
    v_lshl_add_u32 v8, v52, 2, v7
    ds_write_b32 v8, v48
    v_lshl_add_u32 v7, v7, 2, v52
    ds_write_b8 v7, v44 offset:16
    v_and_b32 v9, -4, v53
    v_lshl_add_u32 v10, v53, 2, v9
    ds_write_b32 v10, v49
    v_lshl_add_u32 v9, v9, 2, v53
    ds_write_b8_d16_hi v9, v44 offset:16
    v_and_b32 v7, -4, v54
    v_lshl_add_u32 v8, v54, 2, v7
    ds_write_b32 v8, v50
    v_lshl_add_u32 v7, v7, 2, v54
    ds_write_b8 v7, v45 offset:16
    v_and_b32 v9, -4, v55
    v_lshl_add_u32 v10, v55, 2, v9
    ds_write_b32 v10, v51
    v_lshl_add_u32 v9, v9, 2, v55
    ds_write_b8_d16_hi v9, v45 offset:16
    s_add_u32 s47, s33, 0x4018000
    buffer_load_dwordx4 v[20:23], v0, s[12:15], s47 offen nt
    v_and_b32 v7, -4, v60
    v_lshl_add_u32 v8, v60, 2, v7
    ds_write_b32 v8, v56
    v_lshl_add_u32 v7, v7, 2, v60
    ds_write_b8 v7, v46 offset:16
    v_and_b32 v9, -4, v61
    v_lshl_add_u32 v10, v61, 2, v9
    ds_write_b32 v10, v57
    v_lshl_add_u32 v9, v9, 2, v61
    ds_write_b8_d16_hi v9, v46 offset:16
    v_and_b32 v7, -4, v62
    v_lshl_add_u32 v8, v62, 2, v7
    ds_write_b32 v8, v58
    v_lshl_add_u32 v7, v7, 2, v62
    ds_write_b8 v7, v47 offset:16
    v_and_b32 v9, -4, v63
    v_lshl_add_u32 v10, v63, 2, v9
    ds_write_b32 v10, v59
    v_lshl_add_u32 v9, v9, 2, v63
    ds_write_b8_d16_hi v9, v47 offset:16
    s_add_u32 s44, s34, 0x200c000
    buffer_load_dwordx2 v[124:125], v1, s[16:19], s44 offen nt
    s_add_u32 s45, s34, 0x200e000
    buffer_load_dwordx2 v[126:127], v1, s[16:19], s45 offen nt
    v_add_u32 v7, 0x10000, v0
    v_add_u32 v12, 0x20000, v0
    v_mov_b32 v8, 0
    v_mov_b32 v9, 0
    v_mov_b32 v10, 0
    v_mov_b32 v11, 0
    s_waitcnt lgkmcnt(0)
    s_barrier
    ds_read_b128 v[28:31], v0 offset:0
    ds_write_b128 v0, v[8:11]
    ds_read_b128 v[32:35], v0 offset:16384
    ds_read_b128 v[36:39], v0 offset:32768
    ds_read_b128 v[40:43], v0 offset:49152
    ds_read_b128 v[24:27], v7 offset:0
    ds_read_b128 v[48:51], v7 offset:16384
    ds_read_b128 v[52:55], v7 offset:32768
    ds_read_b128 v[56:59], v7 offset:49152
    ds_read_b128 v[60:63], v12 offset:0
    ds_read_b128 v[44:47], v12 offset:16384
    s_waitcnt lgkmcnt(0)
    s_barrier
    s_add_u32 s46, s35, 0x2a40000
    buffer_store_dwordx4 v[28:31], v0, s[20:23], s46 offen sc1
    s_add_u32 s47, s33, 0x401c000
    s_nop 0
    buffer_load_dwordx4 v[28:31], v0, s[8:11], s47 offen nt
    s_add_u32 s44, s35, 0x2a44000
    buffer_store_dwordx4 v[32:35], v0, s[20:23], s44 offen sc1
    s_add_u32 s45, s33, 0x401c000
    s_nop 0
    buffer_load_dwordx4 v[32:35], v0, s[12:15], s45 offen nt
    s_waitcnt vmcnt(29)
    v_lshlrev_b32 v7, 16, v64
    v_and_b32 v8, 0xffff0000, v64
    v_lshlrev_b32 v9, 16, v65
    v_and_b32 v10, 0xffff0000, v65
    v_mul_f32 v7, 0.15915494, v7
    v_mul_f32 v8, 0.15915494, v8
    v_mul_f32 v9, 0.15915494, v9
    v_mul_f32 v10, 0.15915494, v10
    v_mul_hi_u32_u24 v14, 429497, v68
    v_lshrrev_b32 v12, 3, v72
    v_cos_f32 v7, v7
    v_lshlrev_b16 v13, 3, v72
    v_mad_i32_i24 v11, v14, s55, v68
    v_bitop3_b32 v12, v6, v13, v12 bitop3:0xca
    v_add_lshl_u32 v11, v11, s40, 17
    v_lshlrev_b16 v14, 8, v14
    v_lshrrev_b32 v13, 2, v72
    v_or_b32 v68, v12, v11
    v_bitop3_b32 v72, v5, v13, v14 bitop3:0xea
    ds_add_u32 v72, v2
    v_mul_hi_u32_u24 v14, 429497, v69
    v_lshrrev_b32 v12, 3, v73
    v_cos_f32 v8, v8
    v_lshlrev_b16 v13, 3, v73
    v_mad_i32_i24 v11, v14, s55, v69
    v_bitop3_b32 v12, v6, v13, v12 bitop3:0xca
    v_add_lshl_u32 v11, v11, s40, 17
    v_lshlrev_b16 v14, 8, v14
    v_lshrrev_b32 v13, 2, v73
    v_or_b32 v69, v12, v11
    v_bitop3_b32 v73, v5, v13, v14 bitop3:0xea
    ds_add_u32 v73, v2
    v_cvt_pk_bf16_f32 v64, v7, v8
    v_perm_b32 v12, v64, v64, s41
    v_bitop3_b32 v68, v4, v12, v68 bitop3:0xca
    v_perm_b32 v13, v64, v64, s42
    v_bitop3_b32 v69, v4, v13, v69 bitop3:0xca
    v_mul_hi_u32_u24 v14, 429497, v70
    v_lshrrev_b32 v12, 3, v74
    v_cos_f32 v9, v9
    v_lshlrev_b16 v13, 3, v74
    v_mad_i32_i24 v11, v14, s55, v70
    v_bitop3_b32 v12, v6, v13, v12 bitop3:0xca
    v_add_lshl_u32 v11, v11, s40, 17
    v_lshlrev_b16 v14, 8, v14
    v_lshrrev_b32 v13, 2, v74
    v_or_b32 v70, v12, v11
    v_bitop3_b32 v74, v5, v13, v14 bitop3:0xea
    ds_add_u32 v74, v2
    v_mul_hi_u32_u24 v14, 429497, v71
    v_lshrrev_b32 v12, 3, v75
    v_cos_f32 v10, v10
    v_lshlrev_b16 v13, 3, v75
    v_mad_i32_i24 v11, v14, s55, v71
    v_bitop3_b32 v12, v6, v13, v12 bitop3:0xca
    v_add_lshl_u32 v11, v11, s40, 17
    v_lshlrev_b16 v14, 8, v14
    v_lshrrev_b32 v13, 2, v75
    v_or_b32 v71, v12, v11
    v_bitop3_b32 v75, v5, v13, v14 bitop3:0xea
    ds_add_u32 v75, v2
    v_cvt_pk_bf16_f32 v65, v9, v10
    v_perm_b32 v12, v65, v65, s41
    v_bitop3_b32 v70, v4, v12, v70 bitop3:0xca
    v_perm_b32 v13, v65, v65, s42
    v_bitop3_b32 v71, v4, v13, v71 bitop3:0xca
    s_add_u32 s46, s35, 0x2a48000
    buffer_store_dwordx4 v[36:39], v0, s[20:23], s46 offen sc1
    s_add_u32 s47, s33, 0x6000000
    s_nop 0
    buffer_load_dwordx4 v[36:39], v0, s[8:11], s47 offen nt
    s_waitcnt vmcnt(27)
    v_lshlrev_b32 v7, 16, v66
    v_and_b32 v8, 0xffff0000, v66
    v_lshlrev_b32 v9, 16, v67
    v_and_b32 v10, 0xffff0000, v67
    v_mul_f32 v7, 0.15915494, v7
    v_mul_f32 v8, 0.15915494, v8
    v_mul_f32 v9, 0.15915494, v9
    v_mul_f32 v10, 0.15915494, v10
    v_mul_hi_u32_u24 v14, 429497, v76
    v_lshrrev_b32 v12, 3, v80
    v_cos_f32 v7, v7
    v_lshlrev_b16 v13, 3, v80
    v_mad_i32_i24 v11, v14, s55, v76
    v_bitop3_b32 v12, v6, v13, v12 bitop3:0xca
    v_add_lshl_u32 v11, v11, s40, 17
    v_lshlrev_b16 v14, 8, v14
    v_lshrrev_b32 v13, 2, v80
    v_or_b32 v76, v12, v11
    v_bitop3_b32 v80, v5, v13, v14 bitop3:0xea
    ds_add_u32 v80, v2
    v_mul_hi_u32_u24 v14, 429497, v77
    v_lshrrev_b32 v12, 3, v81
    v_cos_f32 v8, v8
    v_lshlrev_b16 v13, 3, v81
    v_mad_i32_i24 v11, v14, s55, v77
    v_bitop3_b32 v12, v6, v13, v12 bitop3:0xca
    v_add_lshl_u32 v11, v11, s40, 17
    v_lshlrev_b16 v14, 8, v14
    v_lshrrev_b32 v13, 2, v81
    v_or_b32 v77, v12, v11
    v_bitop3_b32 v81, v5, v13, v14 bitop3:0xea
    ds_add_u32 v81, v2
    v_cvt_pk_bf16_f32 v66, v7, v8
    v_perm_b32 v12, v66, v66, s41
    v_bitop3_b32 v76, v4, v12, v76 bitop3:0xca
    v_perm_b32 v13, v66, v66, s42
    v_bitop3_b32 v77, v4, v13, v77 bitop3:0xca
    v_mul_hi_u32_u24 v14, 429497, v78
    v_lshrrev_b32 v12, 3, v82
    v_cos_f32 v9, v9
    v_lshlrev_b16 v13, 3, v82
    v_mad_i32_i24 v11, v14, s55, v78
    v_bitop3_b32 v12, v6, v13, v12 bitop3:0xca
    v_add_lshl_u32 v11, v11, s40, 17
    v_lshlrev_b16 v14, 8, v14
    v_lshrrev_b32 v13, 2, v82
    v_or_b32 v78, v12, v11
    v_bitop3_b32 v82, v5, v13, v14 bitop3:0xea
    ds_add_u32 v82, v2
    v_mul_hi_u32_u24 v14, 429497, v79
    v_lshrrev_b32 v12, 3, v83
    v_cos_f32 v10, v10
    v_lshlrev_b16 v13, 3, v83
    v_mad_i32_i24 v11, v14, s55, v79
    v_bitop3_b32 v12, v6, v13, v12 bitop3:0xca
    v_add_lshl_u32 v11, v11, s40, 17
    v_lshlrev_b16 v14, 8, v14
    v_lshrrev_b32 v13, 2, v83
    v_or_b32 v79, v12, v11
    v_bitop3_b32 v83, v5, v13, v14 bitop3:0xea
    ds_add_u32 v83, v2
    v_cvt_pk_bf16_f32 v67, v9, v10
    v_perm_b32 v12, v67, v67, s41
    v_bitop3_b32 v78, v4, v12, v78 bitop3:0xca
    v_perm_b32 v13, v67, v67, s42
    v_bitop3_b32 v79, v4, v13, v79 bitop3:0xca
    s_waitcnt vmcnt(18)
    v_lshlrev_b32 v7, 16, v84
    v_and_b32 v8, 0xffff0000, v84
    v_lshlrev_b32 v9, 16, v85
    v_and_b32 v10, 0xffff0000, v85
    v_mul_f32 v7, 0.15915494, v7
    v_mul_f32 v8, 0.15915494, v8
    v_mul_f32 v9, 0.15915494, v9
    v_mul_f32 v10, 0.15915494, v10
    v_mul_hi_u32_u24 v14, 429497, v88
    v_lshrrev_b32 v12, 3, v92
    v_cos_f32 v7, v7
    v_lshlrev_b16 v13, 3, v92
    v_mad_i32_i24 v11, v14, s55, v88
    v_bitop3_b32 v12, v6, v13, v12 bitop3:0xca
    v_add_lshl_u32 v11, v11, s40, 17
    v_lshlrev_b16 v14, 8, v14
    v_lshrrev_b32 v13, 2, v92
    v_or_b32 v88, v12, v11
    v_bitop3_b32 v92, v5, v13, v14 bitop3:0xea
    ds_add_u32 v92, v2
    v_mul_hi_u32_u24 v14, 429497, v89
    v_lshrrev_b32 v12, 3, v93
    v_cos_f32 v8, v8
    v_lshlrev_b16 v13, 3, v93
    v_mad_i32_i24 v11, v14, s55, v89
    v_bitop3_b32 v12, v6, v13, v12 bitop3:0xca
    v_add_lshl_u32 v11, v11, s40, 17
    v_lshlrev_b16 v14, 8, v14
    v_lshrrev_b32 v13, 2, v93
    v_or_b32 v89, v12, v11
    v_bitop3_b32 v93, v5, v13, v14 bitop3:0xea
    ds_add_u32 v93, v2
    v_cvt_pk_bf16_f32 v84, v7, v8
    v_perm_b32 v12, v84, v84, s41
    v_bitop3_b32 v88, v4, v12, v88 bitop3:0xca
    v_perm_b32 v13, v84, v84, s42
    v_bitop3_b32 v89, v4, v13, v89 bitop3:0xca
    v_mul_hi_u32_u24 v14, 429497, v90
    v_lshrrev_b32 v12, 3, v94
    v_cos_f32 v9, v9
    v_lshlrev_b16 v13, 3, v94
    v_mad_i32_i24 v11, v14, s55, v90
    v_bitop3_b32 v12, v6, v13, v12 bitop3:0xca
    v_add_lshl_u32 v11, v11, s40, 17
    v_lshlrev_b16 v14, 8, v14
    v_lshrrev_b32 v13, 2, v94
    v_or_b32 v90, v12, v11
    v_bitop3_b32 v94, v5, v13, v14 bitop3:0xea
    ds_add_u32 v94, v2
    v_mul_hi_u32_u24 v14, 429497, v91
    v_lshrrev_b32 v12, 3, v95
    v_cos_f32 v10, v10
    v_lshlrev_b16 v13, 3, v95
    v_mad_i32_i24 v11, v14, s55, v91
    v_bitop3_b32 v12, v6, v13, v12 bitop3:0xca
    v_add_lshl_u32 v11, v11, s40, 17
    v_lshlrev_b16 v14, 8, v14
    v_lshrrev_b32 v13, 2, v95
    v_or_b32 v91, v12, v11
    v_bitop3_b32 v95, v5, v13, v14 bitop3:0xea
    ds_add_u32 v95, v2
    v_cvt_pk_bf16_f32 v85, v9, v10
    v_perm_b32 v12, v85, v85, s41
    v_bitop3_b32 v90, v4, v12, v90 bitop3:0xca
    v_perm_b32 v13, v85, v85, s42
    v_bitop3_b32 v91, v4, v13, v91 bitop3:0xca
    s_add_u32 s44, s35, 0x2a4c000
    buffer_store_dwordx4 v[40:43], v0, s[20:23], s44 offen sc1
    s_add_u32 s45, s33, 0x6000000
    s_nop 0
    buffer_load_dwordx4 v[40:43], v0, s[12:15], s45 offen nt
    s_waitcnt vmcnt(18)
    v_lshlrev_b32 v7, 16, v86
    v_and_b32 v8, 0xffff0000, v86
    v_lshlrev_b32 v9, 16, v87
    v_and_b32 v10, 0xffff0000, v87
    v_mul_f32 v7, 0.15915494, v7
    v_mul_f32 v8, 0.15915494, v8
    v_mul_f32 v9, 0.15915494, v9
    v_mul_f32 v10, 0.15915494, v10
    v_mul_hi_u32_u24 v14, 429497, v96
    v_lshrrev_b32 v12, 3, v100
    v_cos_f32 v7, v7
    v_lshlrev_b16 v13, 3, v100
    v_mad_i32_i24 v11, v14, s55, v96
    v_bitop3_b32 v12, v6, v13, v12 bitop3:0xca
    v_add_lshl_u32 v11, v11, s40, 17
    v_lshlrev_b16 v14, 8, v14
    v_lshrrev_b32 v13, 2, v100
    v_or_b32 v96, v12, v11
    v_bitop3_b32 v100, v5, v13, v14 bitop3:0xea
    ds_add_u32 v100, v2
    v_mul_hi_u32_u24 v14, 429497, v97
    v_lshrrev_b32 v12, 3, v101
    v_cos_f32 v8, v8
    v_lshlrev_b16 v13, 3, v101
    v_mad_i32_i24 v11, v14, s55, v97
    v_bitop3_b32 v12, v6, v13, v12 bitop3:0xca
    v_add_lshl_u32 v11, v11, s40, 17
    v_lshlrev_b16 v14, 8, v14
    v_lshrrev_b32 v13, 2, v101
    v_or_b32 v97, v12, v11
    v_bitop3_b32 v101, v5, v13, v14 bitop3:0xea
    ds_add_u32 v101, v2
    v_cvt_pk_bf16_f32 v86, v7, v8
    v_perm_b32 v12, v86, v86, s41
    v_bitop3_b32 v96, v4, v12, v96 bitop3:0xca
    v_perm_b32 v13, v86, v86, s42
    v_bitop3_b32 v97, v4, v13, v97 bitop3:0xca
    v_mul_hi_u32_u24 v14, 429497, v98
    v_lshrrev_b32 v12, 3, v102
    v_cos_f32 v9, v9
    v_lshlrev_b16 v13, 3, v102
    v_mad_i32_i24 v11, v14, s55, v98
    v_bitop3_b32 v12, v6, v13, v12 bitop3:0xca
    v_add_lshl_u32 v11, v11, s40, 17
    v_lshlrev_b16 v14, 8, v14
    v_lshrrev_b32 v13, 2, v102
    v_or_b32 v98, v12, v11
    v_bitop3_b32 v102, v5, v13, v14 bitop3:0xea
    ds_add_u32 v102, v2
    v_mul_hi_u32_u24 v14, 429497, v99
    v_lshrrev_b32 v12, 3, v103
    v_cos_f32 v10, v10
    v_lshlrev_b16 v13, 3, v103
    v_mad_i32_i24 v11, v14, s55, v99
    v_bitop3_b32 v12, v6, v13, v12 bitop3:0xca
    v_add_lshl_u32 v11, v11, s40, 17
    v_lshlrev_b16 v14, 8, v14
    v_lshrrev_b32 v13, 2, v103
    v_or_b32 v99, v12, v11
    v_bitop3_b32 v103, v5, v13, v14 bitop3:0xea
    ds_add_u32 v103, v2
    v_cvt_pk_bf16_f32 v87, v9, v10
    v_perm_b32 v12, v87, v87, s41
    v_bitop3_b32 v98, v4, v12, v98 bitop3:0xca
    v_perm_b32 v13, v87, v87, s42
    v_bitop3_b32 v99, v4, v13, v99 bitop3:0xca
    s_waitcnt vmcnt(14)
    v_lshlrev_b32 v7, 16, v104
    v_and_b32 v8, 0xffff0000, v104
    v_lshlrev_b32 v9, 16, v105
    v_and_b32 v10, 0xffff0000, v105
    v_mul_f32 v7, 0.15915494, v7
    v_mul_f32 v8, 0.15915494, v8
    v_mul_f32 v9, 0.15915494, v9
    v_mul_f32 v10, 0.15915494, v10
    v_mul_hi_u32_u24 v14, 429497, v108
    v_lshrrev_b32 v12, 3, v112
    v_cos_f32 v7, v7
    v_lshlrev_b16 v13, 3, v112
    v_mad_i32_i24 v11, v14, s55, v108
    v_bitop3_b32 v12, v6, v13, v12 bitop3:0xca
    v_add_lshl_u32 v11, v11, s40, 17
    v_lshlrev_b16 v14, 8, v14
    v_lshrrev_b32 v13, 2, v112
    v_or_b32 v108, v12, v11
    v_bitop3_b32 v112, v5, v13, v14 bitop3:0xea
    ds_add_u32 v112, v2
    v_mul_hi_u32_u24 v14, 429497, v109
    v_lshrrev_b32 v12, 3, v113
    v_cos_f32 v8, v8
    v_lshlrev_b16 v13, 3, v113
    v_mad_i32_i24 v11, v14, s55, v109
    v_bitop3_b32 v12, v6, v13, v12 bitop3:0xca
    v_add_lshl_u32 v11, v11, s40, 17
    v_lshlrev_b16 v14, 8, v14
    v_lshrrev_b32 v13, 2, v113
    v_or_b32 v109, v12, v11
    v_bitop3_b32 v113, v5, v13, v14 bitop3:0xea
    ds_add_u32 v113, v2
    v_cvt_pk_bf16_f32 v104, v7, v8
    v_perm_b32 v12, v104, v104, s41
    v_bitop3_b32 v108, v4, v12, v108 bitop3:0xca
    v_perm_b32 v13, v104, v104, s42
    v_bitop3_b32 v109, v4, v13, v109 bitop3:0xca
    v_mul_hi_u32_u24 v14, 429497, v110
    v_lshrrev_b32 v12, 3, v114
    v_cos_f32 v9, v9
    v_lshlrev_b16 v13, 3, v114
    v_mad_i32_i24 v11, v14, s55, v110
    v_bitop3_b32 v12, v6, v13, v12 bitop3:0xca
    v_add_lshl_u32 v11, v11, s40, 17
    v_lshlrev_b16 v14, 8, v14
    v_lshrrev_b32 v13, 2, v114
    v_or_b32 v110, v12, v11
    v_bitop3_b32 v114, v5, v13, v14 bitop3:0xea
    ds_add_u32 v114, v2
    v_mul_hi_u32_u24 v14, 429497, v111
    v_lshrrev_b32 v12, 3, v115
    v_cos_f32 v10, v10
    v_lshlrev_b16 v13, 3, v115
    v_mad_i32_i24 v11, v14, s55, v111
    v_bitop3_b32 v12, v6, v13, v12 bitop3:0xca
    v_add_lshl_u32 v11, v11, s40, 17
    v_lshlrev_b16 v14, 8, v14
    v_lshrrev_b32 v13, 2, v115
    v_or_b32 v111, v12, v11
    v_bitop3_b32 v115, v5, v13, v14 bitop3:0xea
    ds_add_u32 v115, v2
    v_cvt_pk_bf16_f32 v105, v9, v10
    v_perm_b32 v12, v105, v105, s41
    v_bitop3_b32 v110, v4, v12, v110 bitop3:0xca
    v_perm_b32 v13, v105, v105, s42
    v_bitop3_b32 v111, v4, v13, v111 bitop3:0xca
    s_add_u32 s46, s35, 0x2a50000
    buffer_store_dwordx4 v[24:27], v0, s[20:23], s46 offen sc1
    s_add_u32 s47, s34, 0x3000000
    s_nop 0
    buffer_load_dwordx2 v[24:25], v1, s[16:19], s47 offen nt
    s_add_u32 s44, s34, 0x3002000
    buffer_load_dwordx2 v[26:27], v1, s[16:19], s44 offen nt
    s_waitcnt vmcnt(15)
    v_lshlrev_b32 v7, 16, v106
    v_and_b32 v8, 0xffff0000, v106
    v_lshlrev_b32 v9, 16, v107
    v_and_b32 v10, 0xffff0000, v107
    v_mul_f32 v7, 0.15915494, v7
    v_mul_f32 v8, 0.15915494, v8
    v_mul_f32 v9, 0.15915494, v9
    v_mul_f32 v10, 0.15915494, v10
    v_mul_hi_u32_u24 v14, 429497, v116
    v_lshrrev_b32 v12, 3, v120
    v_cos_f32 v7, v7
    v_lshlrev_b16 v13, 3, v120
    v_mad_i32_i24 v11, v14, s55, v116
    v_bitop3_b32 v12, v6, v13, v12 bitop3:0xca
    v_add_lshl_u32 v11, v11, s40, 17
    v_lshlrev_b16 v14, 8, v14
    v_lshrrev_b32 v13, 2, v120
    v_or_b32 v116, v12, v11
    v_bitop3_b32 v120, v5, v13, v14 bitop3:0xea
    ds_add_u32 v120, v2
    v_mul_hi_u32_u24 v14, 429497, v117
    v_lshrrev_b32 v12, 3, v121
    v_cos_f32 v8, v8
    v_lshlrev_b16 v13, 3, v121
    v_mad_i32_i24 v11, v14, s55, v117
    v_bitop3_b32 v12, v6, v13, v12 bitop3:0xca
    v_add_lshl_u32 v11, v11, s40, 17
    v_lshlrev_b16 v14, 8, v14
    v_lshrrev_b32 v13, 2, v121
    v_or_b32 v117, v12, v11
    v_bitop3_b32 v121, v5, v13, v14 bitop3:0xea
    ds_add_u32 v121, v2
    v_cvt_pk_bf16_f32 v106, v7, v8
    v_perm_b32 v12, v106, v106, s41
    v_bitop3_b32 v116, v4, v12, v116 bitop3:0xca
    v_perm_b32 v13, v106, v106, s42
    v_bitop3_b32 v117, v4, v13, v117 bitop3:0xca
    v_mul_hi_u32_u24 v14, 429497, v118
    v_lshrrev_b32 v12, 3, v122
    v_cos_f32 v9, v9
    v_lshlrev_b16 v13, 3, v122
    v_mad_i32_i24 v11, v14, s55, v118
    v_bitop3_b32 v12, v6, v13, v12 bitop3:0xca
    v_add_lshl_u32 v11, v11, s40, 17
    v_lshlrev_b16 v14, 8, v14
    v_lshrrev_b32 v13, 2, v122
    v_or_b32 v118, v12, v11
    v_bitop3_b32 v122, v5, v13, v14 bitop3:0xea
    ds_add_u32 v122, v2
    v_mul_hi_u32_u24 v14, 429497, v119
    v_lshrrev_b32 v12, 3, v123
    v_cos_f32 v10, v10
    v_lshlrev_b16 v13, 3, v123
    v_mad_i32_i24 v11, v14, s55, v119
    v_bitop3_b32 v12, v6, v13, v12 bitop3:0xca
    v_add_lshl_u32 v11, v11, s40, 17
    v_lshlrev_b16 v14, 8, v14
    v_lshrrev_b32 v13, 2, v123
    v_or_b32 v119, v12, v11
    v_bitop3_b32 v123, v5, v13, v14 bitop3:0xea
    ds_add_u32 v123, v2
    v_cvt_pk_bf16_f32 v107, v9, v10
    v_perm_b32 v12, v107, v107, s41
    v_bitop3_b32 v118, v4, v12, v118 bitop3:0xca
    v_perm_b32 v13, v107, v107, s42
    v_bitop3_b32 v119, v4, v13, v119 bitop3:0xca
    s_waitcnt vmcnt(11)
    v_lshlrev_b32 v7, 16, v124
    v_and_b32 v8, 0xffff0000, v124
    v_lshlrev_b32 v9, 16, v125
    v_and_b32 v10, 0xffff0000, v125
    v_mul_f32 v7, 0.15915494, v7
    v_mul_f32 v8, 0.15915494, v8
    v_mul_f32 v9, 0.15915494, v9
    v_mul_f32 v10, 0.15915494, v10
    v_mul_hi_u32_u24 v14, 429497, v16
    v_lshrrev_b32 v12, 3, v20
    v_cos_f32 v7, v7
    v_lshlrev_b16 v13, 3, v20
    v_mad_i32_i24 v11, v14, s55, v16
    v_bitop3_b32 v12, v6, v13, v12 bitop3:0xca
    v_add_lshl_u32 v11, v11, s40, 17
    v_lshlrev_b16 v14, 8, v14
    v_lshrrev_b32 v13, 2, v20
    v_or_b32 v16, v12, v11
    v_bitop3_b32 v20, v5, v13, v14 bitop3:0xea
    ds_add_u32 v20, v2
    v_mul_hi_u32_u24 v14, 429497, v17
    v_lshrrev_b32 v12, 3, v21
    v_cos_f32 v8, v8
    v_lshlrev_b16 v13, 3, v21
    v_mad_i32_i24 v11, v14, s55, v17
    v_bitop3_b32 v12, v6, v13, v12 bitop3:0xca
    v_add_lshl_u32 v11, v11, s40, 17
    v_lshlrev_b16 v14, 8, v14
    v_lshrrev_b32 v13, 2, v21
    v_or_b32 v17, v12, v11
    v_bitop3_b32 v21, v5, v13, v14 bitop3:0xea
    ds_add_u32 v21, v2
    v_cvt_pk_bf16_f32 v124, v7, v8
    v_perm_b32 v12, v124, v124, s41
    v_bitop3_b32 v16, v4, v12, v16 bitop3:0xca
    v_perm_b32 v13, v124, v124, s42
    v_bitop3_b32 v17, v4, v13, v17 bitop3:0xca
    v_mul_hi_u32_u24 v14, 429497, v18
    v_lshrrev_b32 v12, 3, v22
    v_cos_f32 v9, v9
    v_lshlrev_b16 v13, 3, v22
    v_mad_i32_i24 v11, v14, s55, v18
    v_bitop3_b32 v12, v6, v13, v12 bitop3:0xca
    v_add_lshl_u32 v11, v11, s40, 17
    v_lshlrev_b16 v14, 8, v14
    v_lshrrev_b32 v13, 2, v22
    v_or_b32 v18, v12, v11
    v_bitop3_b32 v22, v5, v13, v14 bitop3:0xea
    ds_add_u32 v22, v2
    v_mul_hi_u32_u24 v14, 429497, v19
    v_lshrrev_b32 v12, 3, v23
    v_cos_f32 v10, v10
    v_lshlrev_b16 v13, 3, v23
    v_mad_i32_i24 v11, v14, s55, v19
    v_bitop3_b32 v12, v6, v13, v12 bitop3:0xca
    v_add_lshl_u32 v11, v11, s40, 17
    v_lshlrev_b16 v14, 8, v14
    v_lshrrev_b32 v13, 2, v23
    v_or_b32 v19, v12, v11
    v_bitop3_b32 v23, v5, v13, v14 bitop3:0xea
    ds_add_u32 v23, v2
    v_cvt_pk_bf16_f32 v125, v9, v10
    v_perm_b32 v12, v125, v125, s41
    v_bitop3_b32 v18, v4, v12, v18 bitop3:0xca
    v_perm_b32 v13, v125, v125, s42
    v_bitop3_b32 v19, v4, v13, v19 bitop3:0xca
    s_add_u32 s45, s35, 0x2a54000
    buffer_store_dwordx4 v[48:51], v0, s[20:23], s45 offen sc1
    s_add_u32 s46, s33, 0x6004000
    s_nop 0
    buffer_load_dwordx4 v[48:51], v0, s[8:11], s46 offen nt
    s_waitcnt vmcnt(9)
    v_lshlrev_b32 v7, 16, v126
    v_and_b32 v8, 0xffff0000, v126
    v_lshlrev_b32 v9, 16, v127
    v_and_b32 v10, 0xffff0000, v127
    v_mul_f32 v7, 0.15915494, v7
    v_mul_f32 v8, 0.15915494, v8
    v_mul_f32 v9, 0.15915494, v9
    v_mul_f32 v10, 0.15915494, v10
    v_mul_hi_u32_u24 v14, 429497, v28
    v_lshrrev_b32 v12, 3, v32
    v_cos_f32 v7, v7
    v_lshlrev_b16 v13, 3, v32
    v_mad_i32_i24 v11, v14, s55, v28
    v_bitop3_b32 v12, v6, v13, v12 bitop3:0xca
    v_add_lshl_u32 v11, v11, s40, 17
    v_lshlrev_b16 v14, 8, v14
    v_lshrrev_b32 v13, 2, v32
    v_or_b32 v28, v12, v11
    v_bitop3_b32 v32, v5, v13, v14 bitop3:0xea
    ds_add_u32 v32, v2
    v_mul_hi_u32_u24 v14, 429497, v29
    v_lshrrev_b32 v12, 3, v33
    v_cos_f32 v8, v8
    v_lshlrev_b16 v13, 3, v33
    v_mad_i32_i24 v11, v14, s55, v29
    v_bitop3_b32 v12, v6, v13, v12 bitop3:0xca
    v_add_lshl_u32 v11, v11, s40, 17
    v_lshlrev_b16 v14, 8, v14
    v_lshrrev_b32 v13, 2, v33
    v_or_b32 v29, v12, v11
    v_bitop3_b32 v33, v5, v13, v14 bitop3:0xea
    ds_add_u32 v33, v2
    v_cvt_pk_bf16_f32 v126, v7, v8
    v_perm_b32 v12, v126, v126, s41
    v_bitop3_b32 v28, v4, v12, v28 bitop3:0xca
    v_perm_b32 v13, v126, v126, s42
    v_bitop3_b32 v29, v4, v13, v29 bitop3:0xca
    v_mul_hi_u32_u24 v14, 429497, v30
    v_lshrrev_b32 v12, 3, v34
    v_cos_f32 v9, v9
    v_lshlrev_b16 v13, 3, v34
    v_mad_i32_i24 v11, v14, s55, v30
    v_bitop3_b32 v12, v6, v13, v12 bitop3:0xca
    v_add_lshl_u32 v11, v11, s40, 17
    v_lshlrev_b16 v14, 8, v14
    v_lshrrev_b32 v13, 2, v34
    v_or_b32 v30, v12, v11
    v_bitop3_b32 v34, v5, v13, v14 bitop3:0xea
    ds_add_u32 v34, v2
    v_mul_hi_u32_u24 v14, 429497, v31
    v_lshrrev_b32 v12, 3, v35
    v_cos_f32 v10, v10
    v_lshlrev_b16 v13, 3, v35
    v_mad_i32_i24 v11, v14, s55, v31
    v_bitop3_b32 v12, v6, v13, v12 bitop3:0xca
    v_add_lshl_u32 v11, v11, s40, 17
    v_lshlrev_b16 v14, 8, v14
    v_lshrrev_b32 v13, 2, v35
    v_or_b32 v31, v12, v11
    v_bitop3_b32 v35, v5, v13, v14 bitop3:0xea
    ds_add_u32 v35, v2
    v_cvt_pk_bf16_f32 v127, v9, v10
    v_perm_b32 v12, v127, v127, s41
    v_bitop3_b32 v30, v4, v12, v30 bitop3:0xca
    v_perm_b32 v13, v127, v127, s42
    v_bitop3_b32 v31, v4, v13, v31 bitop3:0xca
    v_lshrrev_b32 v8, 2, v0
    v_and_b32 v7, 0x3c00, v0
    v_bitop3_b32 v7, v5, v8, v7 bitop3:0xea
    s_waitcnt lgkmcnt(0)
    s_barrier
    ds_read2st64_b32 v[8:9], v7 offset0:0 offset1:1
    ds_read2st64_b32 v[10:11], v7 offset0:2 offset1:3
    s_add_u32 s47, s35, 0x2a58000
    buffer_store_dwordx4 v[52:55], v0, s[20:23], s47 offen sc1
    s_add_u32 s44, s33, 0x6004000
    s_nop 0
    buffer_load_dwordx4 v[52:55], v0, s[12:15], s44 offen nt
    s_waitcnt lgkmcnt(0)
    v_lshl_or_b32 v12, v9, 16, v8
    v_lshl_or_b32 v13, v11, 16, v10
    v_mov_b32 v14, v12
    v_mov_b32 v15, v13
    s_nop 0
    v_add_u32_dpp v14, v14, v14 row_shr:1 row_mask:0xf bank_mask:0xf bound_ctrl:1
    v_add_u32_dpp v15, v15, v15 row_shr:1 row_mask:0xf bank_mask:0xf bound_ctrl:1
    s_nop 0
    v_add_u32_dpp v14, v14, v14 row_shr:2 row_mask:0xf bank_mask:0xf bound_ctrl:1
    v_add_u32_dpp v15, v15, v15 row_shr:2 row_mask:0xf bank_mask:0xf bound_ctrl:1
    s_nop 0
    v_add_u32_dpp v14, v14, v14 row_shr:4 row_mask:0xf bank_mask:0xf bound_ctrl:1
    v_add_u32_dpp v15, v15, v15 row_shr:4 row_mask:0xf bank_mask:0xf bound_ctrl:1
    s_nop 0
    v_add_u32_dpp v14, v14, v14 row_shr:8 row_mask:0xf bank_mask:0xf bound_ctrl:1
    v_add_u32_dpp v15, v15, v15 row_shr:8 row_mask:0xf bank_mask:0xf bound_ctrl:1
    s_nop 0
    v_add_u32_dpp v14, v14, v14 row_bcast:15 row_mask:0xa bank_mask:0xf
    v_add_u32_dpp v15, v15, v15 row_bcast:15 row_mask:0xa bank_mask:0xf
    s_nop 0
    v_add_u32_dpp v14, v14, v14 row_bcast:31 row_mask:0xc bank_mask:0xf
    v_add_u32_dpp v15, v15, v15 row_bcast:31 row_mask:0xc bank_mask:0xf
    v_readlane_b32 s48, v14, 63
    v_readlane_b32 s49, v15, 63
    s_lshl_b32 s54, s32, 2
    v_mov_b32 v8, s54
    s_and_b32 s50, s48, 0xffff
    s_lshr_b32 s51, s48, 16
    s_and_b32 s52, s49, 0xffff
    s_lshr_b32 s53, s49, 16
    s_add_u32 s51, s51, s50
    s_add_u32 s52, s52, s51
    s_add_u32 s53, s53, s52
    v_mov_b32 v9, s53
    s_mov_b64 exec, 1
    ds_write_b32 v8, v9 offset:16384
    s_mov_b64 exec, -1
    v_and_b32 v8, 60, v7
    s_waitcnt lgkmcnt(0)
    s_barrier
    ds_read_b32 v9, v8 offset:16384
    s_waitcnt lgkmcnt(0)
    v_add_u32_dpp v9, v9, v9 row_shr:1 row_mask:0xf bank_mask:0xf bound_ctrl:1
    s_nop 1
    v_add_u32_dpp v9, v9, v9 row_shr:2 row_mask:0xf bank_mask:0xf bound_ctrl:1
    s_nop 1
    v_add_u32_dpp v9, v9, v9 row_shr:4 row_mask:0xf bank_mask:0xf bound_ctrl:1
    s_nop 1
    v_add_u32_dpp v9, v9, v9 row_shr:8 row_mask:0xf bank_mask:0xf bound_ctrl:1
    s_nop 0
    v_readlane_b32 s54, v9, s32
    s_sub_u32 s54, s54, s53
    s_add_u32 s50, s50, s54
    s_add_u32 s51, s51, s54
    s_add_u32 s52, s52, s54
    s_pack_ll_b32_b16 s48, s54, s50
    s_pack_ll_b32_b16 s49, s51, s52
    v_add_u32 v14, s48, v14
    v_add_u32 v15, s49, v15
    v_sub_u32 v12, v14, v12
    v_sub_u32 v13, v15, v13
    v_and_b32 v8, 0xffff, v12
    v_lshrrev_b32 v9, 16, v12
    v_and_b32 v10, 0xffff, v13
    v_lshrrev_b32 v11, 16, v13
    ds_write2st64_b32 v7, v8, v9 offset0:0 offset1:1
    ds_write2st64_b32 v7, v10, v11 offset0:2 offset1:3
    s_waitcnt lgkmcnt(0)
    s_barrier
    ds_add_rtn_u32 v72, v72, v2
    ds_add_rtn_u32 v73, v73, v2
    ds_add_rtn_u32 v74, v74, v2
    ds_add_rtn_u32 v75, v75, v2
    s_add_u32 s45, s36, 0x5480000
    v_and_b32 v11, 0x3f0, v0
    v_add_u32 v11, v11, v11
    buffer_store_dwordx2 v[12:13], v11, s[24:27], s45 offen
    s_bitset0_b64 exec, 63
    s_not_b64 exec, exec
    buffer_store_dwordx2 v[14:15], v11, s[24:27], s45 offen offset:32
    s_mov_b64 exec, -1
    ds_add_rtn_u32 v80, v80, v2
    ds_add_rtn_u32 v81, v81, v2
    ds_add_rtn_u32 v82, v82, v2
    ds_add_rtn_u32 v83, v83, v2
    ds_add_rtn_u32 v92, v92, v2
    ds_add_rtn_u32 v93, v93, v2
    ds_add_rtn_u32 v94, v94, v2
    ds_add_rtn_u32 v95, v95, v2
    s_add_u32 s46, s35, 0x2a5c000
    buffer_store_dwordx4 v[56:59], v0, s[20:23], s46 offen sc1
    s_add_u32 s47, s33, 0x6008000
    s_nop 0
    buffer_load_dwordx4 v[56:59], v0, s[8:11], s47 offen nt
    ds_add_rtn_u32 v100, v100, v2
    ds_add_rtn_u32 v101, v101, v2
    ds_add_rtn_u32 v102, v102, v2
    ds_add_rtn_u32 v103, v103, v2
    ds_add_rtn_u32 v112, v112, v2
    ds_add_rtn_u32 v113, v113, v2
    ds_add_rtn_u32 v114, v114, v2
    ds_add_rtn_u32 v115, v115, v2
    s_add_u32 s44, s35, 0x2a60000
    buffer_store_dwordx4 v[60:63], v0, s[20:23], s44 offen sc1
    s_add_u32 s45, s33, 0x6008000
    s_nop 0
    buffer_load_dwordx4 v[60:63], v0, s[12:15], s45 offen nt
    ds_add_rtn_u32 v120, v120, v2
    ds_add_rtn_u32 v121, v121, v2
    ds_add_rtn_u32 v122, v122, v2
    ds_add_rtn_u32 v123, v123, v2
    ds_add_rtn_u32 v20, v20, v2
    ds_add_rtn_u32 v21, v21, v2
    ds_add_rtn_u32 v22, v22, v2
    ds_add_rtn_u32 v23, v23, v2
    s_add_u32 s46, s35, 0x2a64000
    buffer_store_dwordx4 v[44:47], v0, s[20:23], s46 offen sc1
    s_add_u32 s47, s34, 0x3004000
    s_nop 0
    buffer_load_dwordx2 v[44:45], v1, s[16:19], s47 offen nt
    s_add_u32 s44, s34, 0x3006000
    buffer_load_dwordx2 v[46:47], v1, s[16:19], s44 offen nt
    ds_add_rtn_u32 v32, v32, v2
    ds_add_rtn_u32 v33, v33, v2
    ds_add_rtn_u32 v34, v34, v2
    ds_add_rtn_u32 v35, v35, v2
    s_waitcnt lgkmcnt(0)
    s_barrier
    v_and_b32 v7, -4, v72
    v_lshl_add_u32 v8, v72, 2, v7
    ds_write_b32 v8, v68
    v_lshl_add_u32 v7, v7, 2, v72
    ds_write_b8 v7, v64 offset:16
    v_and_b32 v9, -4, v73
    v_lshl_add_u32 v10, v73, 2, v9
    ds_write_b32 v10, v69
    v_lshl_add_u32 v9, v9, 2, v73
    ds_write_b8_d16_hi v9, v64 offset:16
    v_and_b32 v7, -4, v74
    v_lshl_add_u32 v8, v74, 2, v7
    ds_write_b32 v8, v70
    v_lshl_add_u32 v7, v7, 2, v74
    ds_write_b8 v7, v65 offset:16
    v_and_b32 v9, -4, v75
    v_lshl_add_u32 v10, v75, 2, v9
    ds_write_b32 v10, v71
    v_lshl_add_u32 v9, v9, 2, v75
    ds_write_b8_d16_hi v9, v65 offset:16
    s_add_u32 s45, s33, 0x600c000
    buffer_load_dwordx4 v[68:71], v0, s[8:11], s45 offen nt
    s_add_u32 s46, s33, 0x600c000
    buffer_load_dwordx4 v[72:75], v0, s[12:15], s46 offen nt
    v_and_b32 v7, -4, v80
    v_lshl_add_u32 v8, v80, 2, v7
    ds_write_b32 v8, v76
    v_lshl_add_u32 v7, v7, 2, v80
    ds_write_b8 v7, v66 offset:16
    v_and_b32 v9, -4, v81
    v_lshl_add_u32 v10, v81, 2, v9
    ds_write_b32 v10, v77
    v_lshl_add_u32 v9, v9, 2, v81
    ds_write_b8_d16_hi v9, v66 offset:16
    v_and_b32 v7, -4, v82
    v_lshl_add_u32 v8, v82, 2, v7
    ds_write_b32 v8, v78
    v_lshl_add_u32 v7, v7, 2, v82
    ds_write_b8 v7, v67 offset:16
    v_and_b32 v9, -4, v83
    v_lshl_add_u32 v10, v83, 2, v9
    ds_write_b32 v10, v79
    v_lshl_add_u32 v9, v9, 2, v83
    ds_write_b8_d16_hi v9, v67 offset:16
    s_add_u32 s47, s33, 0x6010000
    buffer_load_dwordx4 v[76:79], v0, s[8:11], s47 offen nt
    v_and_b32 v7, -4, v92
    v_lshl_add_u32 v8, v92, 2, v7
    ds_write_b32 v8, v88
    v_lshl_add_u32 v7, v7, 2, v92
    ds_write_b8 v7, v84 offset:16
    v_and_b32 v9, -4, v93
    v_lshl_add_u32 v10, v93, 2, v9
    ds_write_b32 v10, v89
    v_lshl_add_u32 v9, v9, 2, v93
    ds_write_b8_d16_hi v9, v84 offset:16
    v_and_b32 v7, -4, v94
    v_lshl_add_u32 v8, v94, 2, v7
    ds_write_b32 v8, v90
    v_lshl_add_u32 v7, v7, 2, v94
    ds_write_b8 v7, v85 offset:16
    v_and_b32 v9, -4, v95
    v_lshl_add_u32 v10, v95, 2, v9
    ds_write_b32 v10, v91
    v_lshl_add_u32 v9, v9, 2, v95
    ds_write_b8_d16_hi v9, v85 offset:16
    s_add_u32 s44, s33, 0x6010000
    buffer_load_dwordx4 v[80:83], v0, s[12:15], s44 offen nt
    v_and_b32 v7, -4, v100
    v_lshl_add_u32 v8, v100, 2, v7
    ds_write_b32 v8, v96
    v_lshl_add_u32 v7, v7, 2, v100
    ds_write_b8 v7, v86 offset:16
    v_and_b32 v9, -4, v101
    v_lshl_add_u32 v10, v101, 2, v9
    ds_write_b32 v10, v97
    v_lshl_add_u32 v9, v9, 2, v101
    ds_write_b8_d16_hi v9, v86 offset:16
    v_and_b32 v7, -4, v102
    v_lshl_add_u32 v8, v102, 2, v7
    ds_write_b32 v8, v98
    v_lshl_add_u32 v7, v7, 2, v102
    ds_write_b8 v7, v87 offset:16
    v_and_b32 v9, -4, v103
    v_lshl_add_u32 v10, v103, 2, v9
    ds_write_b32 v10, v99
    v_lshl_add_u32 v9, v9, 2, v103
    ds_write_b8_d16_hi v9, v87 offset:16
    s_add_u32 s45, s34, 0x3008000
    buffer_load_dwordx2 v[64:65], v1, s[16:19], s45 offen nt
    s_add_u32 s46, s34, 0x300a000
    buffer_load_dwordx2 v[66:67], v1, s[16:19], s46 offen nt
    v_and_b32 v7, -4, v112
    v_lshl_add_u32 v8, v112, 2, v7
    ds_write_b32 v8, v108
    v_lshl_add_u32 v7, v7, 2, v112
    ds_write_b8 v7, v104 offset:16
    v_and_b32 v9, -4, v113
    v_lshl_add_u32 v10, v113, 2, v9
    ds_write_b32 v10, v109
    v_lshl_add_u32 v9, v9, 2, v113
    ds_write_b8_d16_hi v9, v104 offset:16
    v_and_b32 v7, -4, v114
    v_lshl_add_u32 v8, v114, 2, v7
    ds_write_b32 v8, v110
    v_lshl_add_u32 v7, v7, 2, v114
    ds_write_b8 v7, v105 offset:16
    v_and_b32 v9, -4, v115
    v_lshl_add_u32 v10, v115, 2, v9
    ds_write_b32 v10, v111
    v_lshl_add_u32 v9, v9, 2, v115
    ds_write_b8_d16_hi v9, v105 offset:16
    s_add_u32 s47, s33, 0x6014000
    buffer_load_dwordx4 v[88:91], v0, s[8:11], s47 offen nt
    s_add_u32 s44, s33, 0x6014000
    buffer_load_dwordx4 v[92:95], v0, s[12:15], s44 offen nt
    v_and_b32 v7, -4, v120
    v_lshl_add_u32 v8, v120, 2, v7
    ds_write_b32 v8, v116
    v_lshl_add_u32 v7, v7, 2, v120
    ds_write_b8 v7, v106 offset:16
    v_and_b32 v9, -4, v121
    v_lshl_add_u32 v10, v121, 2, v9
    ds_write_b32 v10, v117
    v_lshl_add_u32 v9, v9, 2, v121
    ds_write_b8_d16_hi v9, v106 offset:16
    v_and_b32 v7, -4, v122
    v_lshl_add_u32 v8, v122, 2, v7
    ds_write_b32 v8, v118
    v_lshl_add_u32 v7, v7, 2, v122
    ds_write_b8 v7, v107 offset:16
    v_and_b32 v9, -4, v123
    v_lshl_add_u32 v10, v123, 2, v9
    ds_write_b32 v10, v119
    v_lshl_add_u32 v9, v9, 2, v123
    ds_write_b8_d16_hi v9, v107 offset:16
    s_add_u32 s45, s33, 0x6018000
    buffer_load_dwordx4 v[96:99], v0, s[8:11], s45 offen nt
    v_and_b32 v7, -4, v20
    v_lshl_add_u32 v8, v20, 2, v7
    ds_write_b32 v8, v16
    v_lshl_add_u32 v7, v7, 2, v20
    ds_write_b8 v7, v124 offset:16
    v_and_b32 v9, -4, v21
    v_lshl_add_u32 v10, v21, 2, v9
    ds_write_b32 v10, v17
    v_lshl_add_u32 v9, v9, 2, v21
    ds_write_b8_d16_hi v9, v124 offset:16
    v_and_b32 v7, -4, v22
    v_lshl_add_u32 v8, v22, 2, v7
    ds_write_b32 v8, v18
    v_lshl_add_u32 v7, v7, 2, v22
    ds_write_b8 v7, v125 offset:16
    v_and_b32 v9, -4, v23
    v_lshl_add_u32 v10, v23, 2, v9
    ds_write_b32 v10, v19
    v_lshl_add_u32 v9, v9, 2, v23
    ds_write_b8_d16_hi v9, v125 offset:16
    s_add_u32 s46, s33, 0x6018000
    buffer_load_dwordx4 v[100:103], v0, s[12:15], s46 offen nt
    v_and_b32 v7, -4, v32
    v_lshl_add_u32 v8, v32, 2, v7
    ds_write_b32 v8, v28
    v_lshl_add_u32 v7, v7, 2, v32
    ds_write_b8 v7, v126 offset:16
    v_and_b32 v9, -4, v33
    v_lshl_add_u32 v10, v33, 2, v9
    ds_write_b32 v10, v29
    v_lshl_add_u32 v9, v9, 2, v33
    ds_write_b8_d16_hi v9, v126 offset:16
    v_and_b32 v7, -4, v34
    v_lshl_add_u32 v8, v34, 2, v7
    ds_write_b32 v8, v30
    v_lshl_add_u32 v7, v7, 2, v34
    ds_write_b8 v7, v127 offset:16
    v_and_b32 v9, -4, v35
    v_lshl_add_u32 v10, v35, 2, v9
    ds_write_b32 v10, v31
    v_lshl_add_u32 v9, v9, 2, v35
    ds_write_b8_d16_hi v9, v127 offset:16
    s_add_u32 s47, s34, 0x300c000
    buffer_load_dwordx2 v[84:85], v1, s[16:19], s47 offen nt
    s_add_u32 s44, s34, 0x300e000
    buffer_load_dwordx2 v[86:87], v1, s[16:19], s44 offen nt
    v_add_u32 v7, 0x10000, v0
    v_add_u32 v12, 0x20000, v0
    v_mov_b32 v8, 0
    v_mov_b32 v9, 0
    v_mov_b32 v10, 0
    v_mov_b32 v11, 0
    s_waitcnt lgkmcnt(0)
    s_barrier
    ds_read_b128 v[108:111], v0 offset:0
    ds_write_b128 v0, v[8:11]
    ds_read_b128 v[112:115], v0 offset:16384
    ds_read_b128 v[116:119], v0 offset:32768
    ds_read_b128 v[120:123], v0 offset:49152
    ds_read_b128 v[104:107], v7 offset:0
    ds_read_b128 v[16:19], v7 offset:16384
    ds_read_b128 v[20:23], v7 offset:32768
    ds_read_b128 v[28:31], v7 offset:49152
    ds_read_b128 v[32:35], v12 offset:0
    ds_read_b128 v[124:127], v12 offset:16384
    s_waitcnt lgkmcnt(0)
    s_barrier
    s_add_u32 s45, s35, 0x5480000
    buffer_store_dwordx4 v[108:111], v0, s[20:23], s45 offen sc1
    s_add_u32 s46, s33, 0x601c000
    s_nop 0
    buffer_load_dwordx4 v[108:111], v0, s[8:11], s46 offen nt
    s_add_u32 s47, s35, 0x5484000
    buffer_store_dwordx4 v[112:115], v0, s[20:23], s47 offen sc1
    s_add_u32 s44, s33, 0x601c000
    s_nop 0
    buffer_load_dwordx4 v[112:115], v0, s[12:15], s44 offen nt
    s_waitcnt vmcnt(29)
    v_lshlrev_b32 v7, 16, v24
    v_and_b32 v8, 0xffff0000, v24
    v_lshlrev_b32 v9, 16, v25
    v_and_b32 v10, 0xffff0000, v25
    v_mul_f32 v7, 0.15915494, v7
    v_mul_f32 v8, 0.15915494, v8
    v_mul_f32 v9, 0.15915494, v9
    v_mul_f32 v10, 0.15915494, v10
    v_mul_hi_u32_u24 v14, 429497, v36
    v_lshrrev_b32 v12, 3, v40
    v_cos_f32 v7, v7
    v_lshlrev_b16 v13, 3, v40
    v_mad_i32_i24 v11, v14, s55, v36
    v_bitop3_b32 v12, v6, v13, v12 bitop3:0xca
    v_add_lshl_u32 v11, v11, s40, 17
    v_lshlrev_b16 v14, 8, v14
    v_lshrrev_b32 v13, 2, v40
    v_or_b32 v36, v12, v11
    v_bitop3_b32 v40, v5, v13, v14 bitop3:0xea
    ds_add_u32 v40, v2
    v_mul_hi_u32_u24 v14, 429497, v37
    v_lshrrev_b32 v12, 3, v41
    v_cos_f32 v8, v8
    v_lshlrev_b16 v13, 3, v41
    v_mad_i32_i24 v11, v14, s55, v37
    v_bitop3_b32 v12, v6, v13, v12 bitop3:0xca
    v_add_lshl_u32 v11, v11, s40, 17
    v_lshlrev_b16 v14, 8, v14
    v_lshrrev_b32 v13, 2, v41
    v_or_b32 v37, v12, v11
    v_bitop3_b32 v41, v5, v13, v14 bitop3:0xea
    ds_add_u32 v41, v2
    v_cvt_pk_bf16_f32 v24, v7, v8
    v_perm_b32 v12, v24, v24, s41
    v_bitop3_b32 v36, v4, v12, v36 bitop3:0xca
    v_perm_b32 v13, v24, v24, s42
    v_bitop3_b32 v37, v4, v13, v37 bitop3:0xca
    v_mul_hi_u32_u24 v14, 429497, v38
    v_lshrrev_b32 v12, 3, v42
    v_cos_f32 v9, v9
    v_lshlrev_b16 v13, 3, v42
    v_mad_i32_i24 v11, v14, s55, v38
    v_bitop3_b32 v12, v6, v13, v12 bitop3:0xca
    v_add_lshl_u32 v11, v11, s40, 17
    v_lshlrev_b16 v14, 8, v14
    v_lshrrev_b32 v13, 2, v42
    v_or_b32 v38, v12, v11
    v_bitop3_b32 v42, v5, v13, v14 bitop3:0xea
    ds_add_u32 v42, v2
    v_mul_hi_u32_u24 v14, 429497, v39
    v_lshrrev_b32 v12, 3, v43
    v_cos_f32 v10, v10
    v_lshlrev_b16 v13, 3, v43
    v_mad_i32_i24 v11, v14, s55, v39
    v_bitop3_b32 v12, v6, v13, v12 bitop3:0xca
    v_add_lshl_u32 v11, v11, s40, 17
    v_lshlrev_b16 v14, 8, v14
    v_lshrrev_b32 v13, 2, v43
    v_or_b32 v39, v12, v11
    v_bitop3_b32 v43, v5, v13, v14 bitop3:0xea
    ds_add_u32 v43, v2
    v_cvt_pk_bf16_f32 v25, v9, v10
    v_perm_b32 v12, v25, v25, s41
    v_bitop3_b32 v38, v4, v12, v38 bitop3:0xca
    v_perm_b32 v13, v25, v25, s42
    v_bitop3_b32 v39, v4, v13, v39 bitop3:0xca
    s_add_u32 s45, s35, 0x5488000
    buffer_store_dwordx4 v[116:119], v0, s[20:23], s45 offen sc1
    s_add_u32 s46, s38, 0x0
    s_nop 0
    buffer_load_dwordx4 v[116:119], v0, s[8:11], s46 offen nt
    s_waitcnt vmcnt(27)
    v_lshlrev_b32 v7, 16, v26
    v_and_b32 v8, 0xffff0000, v26
    v_lshlrev_b32 v9, 16, v27
    v_and_b32 v10, 0xffff0000, v27
    v_mul_f32 v7, 0.15915494, v7
    v_mul_f32 v8, 0.15915494, v8
    v_mul_f32 v9, 0.15915494, v9
    v_mul_f32 v10, 0.15915494, v10
    v_mul_hi_u32_u24 v14, 429497, v48
    v_lshrrev_b32 v12, 3, v52
    v_cos_f32 v7, v7
    v_lshlrev_b16 v13, 3, v52
    v_mad_i32_i24 v11, v14, s55, v48
    v_bitop3_b32 v12, v6, v13, v12 bitop3:0xca
    v_add_lshl_u32 v11, v11, s40, 17
    v_lshlrev_b16 v14, 8, v14
    v_lshrrev_b32 v13, 2, v52
    v_or_b32 v48, v12, v11
    v_bitop3_b32 v52, v5, v13, v14 bitop3:0xea
    ds_add_u32 v52, v2
    v_mul_hi_u32_u24 v14, 429497, v49
    v_lshrrev_b32 v12, 3, v53
    v_cos_f32 v8, v8
    v_lshlrev_b16 v13, 3, v53
    v_mad_i32_i24 v11, v14, s55, v49
    v_bitop3_b32 v12, v6, v13, v12 bitop3:0xca
    v_add_lshl_u32 v11, v11, s40, 17
    v_lshlrev_b16 v14, 8, v14
    v_lshrrev_b32 v13, 2, v53
    v_or_b32 v49, v12, v11
    v_bitop3_b32 v53, v5, v13, v14 bitop3:0xea
    ds_add_u32 v53, v2
    v_cvt_pk_bf16_f32 v26, v7, v8
    v_perm_b32 v12, v26, v26, s41
    v_bitop3_b32 v48, v4, v12, v48 bitop3:0xca
    v_perm_b32 v13, v26, v26, s42
    v_bitop3_b32 v49, v4, v13, v49 bitop3:0xca
    v_mul_hi_u32_u24 v14, 429497, v50
    v_lshrrev_b32 v12, 3, v54
    v_cos_f32 v9, v9
    v_lshlrev_b16 v13, 3, v54
    v_mad_i32_i24 v11, v14, s55, v50
    v_bitop3_b32 v12, v6, v13, v12 bitop3:0xca
    v_add_lshl_u32 v11, v11, s40, 17
    v_lshlrev_b16 v14, 8, v14
    v_lshrrev_b32 v13, 2, v54
    v_or_b32 v50, v12, v11
    v_bitop3_b32 v54, v5, v13, v14 bitop3:0xea
    ds_add_u32 v54, v2
    v_mul_hi_u32_u24 v14, 429497, v51
    v_lshrrev_b32 v12, 3, v55
    v_cos_f32 v10, v10
    v_lshlrev_b16 v13, 3, v55
    v_mad_i32_i24 v11, v14, s55, v51
    v_bitop3_b32 v12, v6, v13, v12 bitop3:0xca
    v_add_lshl_u32 v11, v11, s40, 17
    v_lshlrev_b16 v14, 8, v14
    v_lshrrev_b32 v13, 2, v55
    v_or_b32 v51, v12, v11
    v_bitop3_b32 v55, v5, v13, v14 bitop3:0xea
    ds_add_u32 v55, v2
    v_cvt_pk_bf16_f32 v27, v9, v10
    v_perm_b32 v12, v27, v27, s41
    v_bitop3_b32 v50, v4, v12, v50 bitop3:0xca
    v_perm_b32 v13, v27, v27, s42
    v_bitop3_b32 v51, v4, v13, v51 bitop3:0xca
    s_waitcnt vmcnt(18)
    v_lshlrev_b32 v7, 16, v44
    v_and_b32 v8, 0xffff0000, v44
    v_lshlrev_b32 v9, 16, v45
    v_and_b32 v10, 0xffff0000, v45
    v_mul_f32 v7, 0.15915494, v7
    v_mul_f32 v8, 0.15915494, v8
    v_mul_f32 v9, 0.15915494, v9
    v_mul_f32 v10, 0.15915494, v10
    v_mul_hi_u32_u24 v14, 429497, v56
    v_lshrrev_b32 v12, 3, v60
    v_cos_f32 v7, v7
    v_lshlrev_b16 v13, 3, v60
    v_mad_i32_i24 v11, v14, s55, v56
    v_bitop3_b32 v12, v6, v13, v12 bitop3:0xca
    v_add_lshl_u32 v11, v11, s40, 17
    v_lshlrev_b16 v14, 8, v14
    v_lshrrev_b32 v13, 2, v60
    v_or_b32 v56, v12, v11
    v_bitop3_b32 v60, v5, v13, v14 bitop3:0xea
    ds_add_u32 v60, v2
    v_mul_hi_u32_u24 v14, 429497, v57
    v_lshrrev_b32 v12, 3, v61
    v_cos_f32 v8, v8
    v_lshlrev_b16 v13, 3, v61
    v_mad_i32_i24 v11, v14, s55, v57
    v_bitop3_b32 v12, v6, v13, v12 bitop3:0xca
    v_add_lshl_u32 v11, v11, s40, 17
    v_lshlrev_b16 v14, 8, v14
    v_lshrrev_b32 v13, 2, v61
    v_or_b32 v57, v12, v11
    v_bitop3_b32 v61, v5, v13, v14 bitop3:0xea
    ds_add_u32 v61, v2
    v_cvt_pk_bf16_f32 v44, v7, v8
    v_perm_b32 v12, v44, v44, s41
    v_bitop3_b32 v56, v4, v12, v56 bitop3:0xca
    v_perm_b32 v13, v44, v44, s42
    v_bitop3_b32 v57, v4, v13, v57 bitop3:0xca
    v_mul_hi_u32_u24 v14, 429497, v58
    v_lshrrev_b32 v12, 3, v62
    v_cos_f32 v9, v9
    v_lshlrev_b16 v13, 3, v62
    v_mad_i32_i24 v11, v14, s55, v58
    v_bitop3_b32 v12, v6, v13, v12 bitop3:0xca
    v_add_lshl_u32 v11, v11, s40, 17
    v_lshlrev_b16 v14, 8, v14
    v_lshrrev_b32 v13, 2, v62
    v_or_b32 v58, v12, v11
    v_bitop3_b32 v62, v5, v13, v14 bitop3:0xea
    ds_add_u32 v62, v2
    v_mul_hi_u32_u24 v14, 429497, v59
    v_lshrrev_b32 v12, 3, v63
    v_cos_f32 v10, v10
    v_lshlrev_b16 v13, 3, v63
    v_mad_i32_i24 v11, v14, s55, v59
    v_bitop3_b32 v12, v6, v13, v12 bitop3:0xca
    v_add_lshl_u32 v11, v11, s40, 17
    v_lshlrev_b16 v14, 8, v14
    v_lshrrev_b32 v13, 2, v63
    v_or_b32 v59, v12, v11
    v_bitop3_b32 v63, v5, v13, v14 bitop3:0xea
    ds_add_u32 v63, v2
    v_cvt_pk_bf16_f32 v45, v9, v10
    v_perm_b32 v12, v45, v45, s41
    v_bitop3_b32 v58, v4, v12, v58 bitop3:0xca
    v_perm_b32 v13, v45, v45, s42
    v_bitop3_b32 v59, v4, v13, v59 bitop3:0xca
    s_add_u32 s47, s35, 0x548c000
    buffer_store_dwordx4 v[120:123], v0, s[20:23], s47 offen sc1
    s_add_u32 s44, s38, 0x0
    s_nop 0
    buffer_load_dwordx4 v[120:123], v0, s[12:15], s44 offen nt
    s_waitcnt vmcnt(18)
    v_lshlrev_b32 v7, 16, v46
    v_and_b32 v8, 0xffff0000, v46
    v_lshlrev_b32 v9, 16, v47
    v_and_b32 v10, 0xffff0000, v47
    v_mul_f32 v7, 0.15915494, v7
    v_mul_f32 v8, 0.15915494, v8
    v_mul_f32 v9, 0.15915494, v9
    v_mul_f32 v10, 0.15915494, v10
    v_mul_hi_u32_u24 v14, 429497, v68
    v_lshrrev_b32 v12, 3, v72
    v_cos_f32 v7, v7
    v_lshlrev_b16 v13, 3, v72
    v_mad_i32_i24 v11, v14, s55, v68
    v_bitop3_b32 v12, v6, v13, v12 bitop3:0xca
    v_add_lshl_u32 v11, v11, s40, 17
    v_lshlrev_b16 v14, 8, v14
    v_lshrrev_b32 v13, 2, v72
    v_or_b32 v68, v12, v11
    v_bitop3_b32 v72, v5, v13, v14 bitop3:0xea
    ds_add_u32 v72, v2
    v_mul_hi_u32_u24 v14, 429497, v69
    v_lshrrev_b32 v12, 3, v73
    v_cos_f32 v8, v8
    v_lshlrev_b16 v13, 3, v73
    v_mad_i32_i24 v11, v14, s55, v69
    v_bitop3_b32 v12, v6, v13, v12 bitop3:0xca
    v_add_lshl_u32 v11, v11, s40, 17
    v_lshlrev_b16 v14, 8, v14
    v_lshrrev_b32 v13, 2, v73
    v_or_b32 v69, v12, v11
    v_bitop3_b32 v73, v5, v13, v14 bitop3:0xea
    ds_add_u32 v73, v2
    v_cvt_pk_bf16_f32 v46, v7, v8
    v_perm_b32 v12, v46, v46, s41
    v_bitop3_b32 v68, v4, v12, v68 bitop3:0xca
    v_perm_b32 v13, v46, v46, s42
    v_bitop3_b32 v69, v4, v13, v69 bitop3:0xca
    v_mul_hi_u32_u24 v14, 429497, v70
    v_lshrrev_b32 v12, 3, v74
    v_cos_f32 v9, v9
    v_lshlrev_b16 v13, 3, v74
    v_mad_i32_i24 v11, v14, s55, v70
    v_bitop3_b32 v12, v6, v13, v12 bitop3:0xca
    v_add_lshl_u32 v11, v11, s40, 17
    v_lshlrev_b16 v14, 8, v14
    v_lshrrev_b32 v13, 2, v74
    v_or_b32 v70, v12, v11
    v_bitop3_b32 v74, v5, v13, v14 bitop3:0xea
    ds_add_u32 v74, v2
    v_mul_hi_u32_u24 v14, 429497, v71
    v_lshrrev_b32 v12, 3, v75
    v_cos_f32 v10, v10
    v_lshlrev_b16 v13, 3, v75
    v_mad_i32_i24 v11, v14, s55, v71
    v_bitop3_b32 v12, v6, v13, v12 bitop3:0xca
    v_add_lshl_u32 v11, v11, s40, 17
    v_lshlrev_b16 v14, 8, v14
    v_lshrrev_b32 v13, 2, v75
    v_or_b32 v71, v12, v11
    v_bitop3_b32 v75, v5, v13, v14 bitop3:0xea
    ds_add_u32 v75, v2
    v_cvt_pk_bf16_f32 v47, v9, v10
    v_perm_b32 v12, v47, v47, s41
    v_bitop3_b32 v70, v4, v12, v70 bitop3:0xca
    v_perm_b32 v13, v47, v47, s42
    v_bitop3_b32 v71, v4, v13, v71 bitop3:0xca
    s_mov_b32 s68, s56
    s_mov_b32 s69, s57
    s_mov_b32 s70, 0x100
    s_mov_b32 s71, 0x20000
    v_mov_b32 v3, 1
    s_cmp_lg_u32 s32, 15
    s_cbranch_scc1 L1_tk
    s_mov_b64 exec, 1
    buffer_atomic_add v3, off, s[68:71], 0 sc0
    s_mov_b64 exec, -1
L1_tk:
    s_waitcnt vmcnt(14)
    v_lshlrev_b32 v7, 16, v64
    v_and_b32 v8, 0xffff0000, v64
    v_lshlrev_b32 v9, 16, v65
    v_and_b32 v10, 0xffff0000, v65
    v_mul_f32 v7, 0.15915494, v7
    v_mul_f32 v8, 0.15915494, v8
    v_mul_f32 v9, 0.15915494, v9
    v_mul_f32 v10, 0.15915494, v10
    v_mul_hi_u32_u24 v14, 429497, v76
    v_lshrrev_b32 v12, 3, v80
    v_cos_f32 v7, v7
    v_lshlrev_b16 v13, 3, v80
    v_mad_i32_i24 v11, v14, s55, v76
    v_bitop3_b32 v12, v6, v13, v12 bitop3:0xca
    v_add_lshl_u32 v11, v11, s40, 17
    v_lshlrev_b16 v14, 8, v14
    v_lshrrev_b32 v13, 2, v80
    v_or_b32 v76, v12, v11
    v_bitop3_b32 v80, v5, v13, v14 bitop3:0xea
    ds_add_u32 v80, v2
    v_mul_hi_u32_u24 v14, 429497, v77
    v_lshrrev_b32 v12, 3, v81
    v_cos_f32 v8, v8
    v_lshlrev_b16 v13, 3, v81
    v_mad_i32_i24 v11, v14, s55, v77
    v_bitop3_b32 v12, v6, v13, v12 bitop3:0xca
    v_add_lshl_u32 v11, v11, s40, 17
    v_lshlrev_b16 v14, 8, v14
    v_lshrrev_b32 v13, 2, v81
    v_or_b32 v77, v12, v11
    v_bitop3_b32 v81, v5, v13, v14 bitop3:0xea
    ds_add_u32 v81, v2
    v_cvt_pk_bf16_f32 v64, v7, v8
    v_perm_b32 v12, v64, v64, s41
    v_bitop3_b32 v76, v4, v12, v76 bitop3:0xca
    v_perm_b32 v13, v64, v64, s42
    v_bitop3_b32 v77, v4, v13, v77 bitop3:0xca
    v_mul_hi_u32_u24 v14, 429497, v78
    v_lshrrev_b32 v12, 3, v82
    v_cos_f32 v9, v9
    v_lshlrev_b16 v13, 3, v82
    v_mad_i32_i24 v11, v14, s55, v78
    v_bitop3_b32 v12, v6, v13, v12 bitop3:0xca
    v_add_lshl_u32 v11, v11, s40, 17
    v_lshlrev_b16 v14, 8, v14
    v_lshrrev_b32 v13, 2, v82
    v_or_b32 v78, v12, v11
    v_bitop3_b32 v82, v5, v13, v14 bitop3:0xea
    ds_add_u32 v82, v2
    v_mul_hi_u32_u24 v14, 429497, v79
    v_lshrrev_b32 v12, 3, v83
    v_cos_f32 v10, v10
    v_lshlrev_b16 v13, 3, v83
    v_mad_i32_i24 v11, v14, s55, v79
    v_bitop3_b32 v12, v6, v13, v12 bitop3:0xca
    v_add_lshl_u32 v11, v11, s40, 17
    v_lshlrev_b16 v14, 8, v14
    v_lshrrev_b32 v13, 2, v83
    v_or_b32 v79, v12, v11
    v_bitop3_b32 v83, v5, v13, v14 bitop3:0xea
    ds_add_u32 v83, v2
    v_cvt_pk_bf16_f32 v65, v9, v10
    v_perm_b32 v12, v65, v65, s41
    v_bitop3_b32 v78, v4, v12, v78 bitop3:0xca
    v_perm_b32 v13, v65, v65, s42
    v_bitop3_b32 v79, v4, v13, v79 bitop3:0xca
    s_add_u32 s45, s35, 0x5490000
    buffer_store_dwordx4 v[104:107], v0, s[20:23], s45 offen sc1
    s_add_u32 s46, s39, 0x0
    s_nop 0
    buffer_load_dwordx2 v[104:105], v1, s[16:19], s46 offen nt
    s_add_u32 s47, s39, 0x2000
    buffer_load_dwordx2 v[106:107], v1, s[16:19], s47 offen nt
    s_waitcnt vmcnt(15)
    v_lshlrev_b32 v7, 16, v66
    v_and_b32 v8, 0xffff0000, v66
    v_lshlrev_b32 v9, 16, v67
    v_and_b32 v10, 0xffff0000, v67
    v_mul_f32 v7, 0.15915494, v7
    v_mul_f32 v8, 0.15915494, v8
    v_mul_f32 v9, 0.15915494, v9
    v_mul_f32 v10, 0.15915494, v10
    v_mul_hi_u32_u24 v14, 429497, v88
    v_lshrrev_b32 v12, 3, v92
    v_cos_f32 v7, v7
    v_lshlrev_b16 v13, 3, v92
    v_mad_i32_i24 v11, v14, s55, v88
    v_bitop3_b32 v12, v6, v13, v12 bitop3:0xca
    v_add_lshl_u32 v11, v11, s40, 17
    v_lshlrev_b16 v14, 8, v14
    v_lshrrev_b32 v13, 2, v92
    v_or_b32 v88, v12, v11
    v_bitop3_b32 v92, v5, v13, v14 bitop3:0xea
    ds_add_u32 v92, v2
    v_mul_hi_u32_u24 v14, 429497, v89
    v_lshrrev_b32 v12, 3, v93
    v_cos_f32 v8, v8
    v_lshlrev_b16 v13, 3, v93
    v_mad_i32_i24 v11, v14, s55, v89
    v_bitop3_b32 v12, v6, v13, v12 bitop3:0xca
    v_add_lshl_u32 v11, v11, s40, 17
    v_lshlrev_b16 v14, 8, v14
    v_lshrrev_b32 v13, 2, v93
    v_or_b32 v89, v12, v11
    v_bitop3_b32 v93, v5, v13, v14 bitop3:0xea
    ds_add_u32 v93, v2
    v_cvt_pk_bf16_f32 v66, v7, v8
    v_perm_b32 v12, v66, v66, s41
    v_bitop3_b32 v88, v4, v12, v88 bitop3:0xca
    v_perm_b32 v13, v66, v66, s42
    v_bitop3_b32 v89, v4, v13, v89 bitop3:0xca
    v_mul_hi_u32_u24 v14, 429497, v90
    v_lshrrev_b32 v12, 3, v94
    v_cos_f32 v9, v9
    v_lshlrev_b16 v13, 3, v94
    v_mad_i32_i24 v11, v14, s55, v90
    v_bitop3_b32 v12, v6, v13, v12 bitop3:0xca
    v_add_lshl_u32 v11, v11, s40, 17
    v_lshlrev_b16 v14, 8, v14
    v_lshrrev_b32 v13, 2, v94
    v_or_b32 v90, v12, v11
    v_bitop3_b32 v94, v5, v13, v14 bitop3:0xea
    ds_add_u32 v94, v2
    v_mul_hi_u32_u24 v14, 429497, v91
    v_lshrrev_b32 v12, 3, v95
    v_cos_f32 v10, v10
    v_lshlrev_b16 v13, 3, v95
    v_mad_i32_i24 v11, v14, s55, v91
    v_bitop3_b32 v12, v6, v13, v12 bitop3:0xca
    v_add_lshl_u32 v11, v11, s40, 17
    v_lshlrev_b16 v14, 8, v14
    v_lshrrev_b32 v13, 2, v95
    v_or_b32 v91, v12, v11
    v_bitop3_b32 v95, v5, v13, v14 bitop3:0xea
    ds_add_u32 v95, v2
    v_cvt_pk_bf16_f32 v67, v9, v10
    v_perm_b32 v12, v67, v67, s41
    v_bitop3_b32 v90, v4, v12, v90 bitop3:0xca
    v_perm_b32 v13, v67, v67, s42
    v_bitop3_b32 v91, v4, v13, v91 bitop3:0xca
    s_waitcnt vmcnt(11)
    v_lshlrev_b32 v7, 16, v84
    v_and_b32 v8, 0xffff0000, v84
    v_lshlrev_b32 v9, 16, v85
    v_and_b32 v10, 0xffff0000, v85
    v_mul_f32 v7, 0.15915494, v7
    v_mul_f32 v8, 0.15915494, v8
    v_mul_f32 v9, 0.15915494, v9
    v_mul_f32 v10, 0.15915494, v10
    v_mul_hi_u32_u24 v14, 429497, v96
    v_lshrrev_b32 v12, 3, v100
    v_cos_f32 v7, v7
    v_lshlrev_b16 v13, 3, v100
    v_mad_i32_i24 v11, v14, s55, v96
    v_bitop3_b32 v12, v6, v13, v12 bitop3:0xca
    v_add_lshl_u32 v11, v11, s40, 17
    v_lshlrev_b16 v14, 8, v14
    v_lshrrev_b32 v13, 2, v100
    v_or_b32 v96, v12, v11
    v_bitop3_b32 v100, v5, v13, v14 bitop3:0xea
    ds_add_u32 v100, v2
    v_mul_hi_u32_u24 v14, 429497, v97
    v_lshrrev_b32 v12, 3, v101
    v_cos_f32 v8, v8
    v_lshlrev_b16 v13, 3, v101
    v_mad_i32_i24 v11, v14, s55, v97
    v_bitop3_b32 v12, v6, v13, v12 bitop3:0xca
    v_add_lshl_u32 v11, v11, s40, 17
    v_lshlrev_b16 v14, 8, v14
    v_lshrrev_b32 v13, 2, v101
    v_or_b32 v97, v12, v11
    v_bitop3_b32 v101, v5, v13, v14 bitop3:0xea
    ds_add_u32 v101, v2
    v_cvt_pk_bf16_f32 v84, v7, v8
    v_perm_b32 v12, v84, v84, s41
    v_bitop3_b32 v96, v4, v12, v96 bitop3:0xca
    v_perm_b32 v13, v84, v84, s42
    v_bitop3_b32 v97, v4, v13, v97 bitop3:0xca
    v_mul_hi_u32_u24 v14, 429497, v98
    v_lshrrev_b32 v12, 3, v102
    v_cos_f32 v9, v9
    v_lshlrev_b16 v13, 3, v102
    v_mad_i32_i24 v11, v14, s55, v98
    v_bitop3_b32 v12, v6, v13, v12 bitop3:0xca
    v_add_lshl_u32 v11, v11, s40, 17
    v_lshlrev_b16 v14, 8, v14
    v_lshrrev_b32 v13, 2, v102
    v_or_b32 v98, v12, v11
    v_bitop3_b32 v102, v5, v13, v14 bitop3:0xea
    ds_add_u32 v102, v2
    v_mul_hi_u32_u24 v14, 429497, v99
    v_lshrrev_b32 v12, 3, v103
    v_cos_f32 v10, v10
    v_lshlrev_b16 v13, 3, v103
    v_mad_i32_i24 v11, v14, s55, v99
    v_bitop3_b32 v12, v6, v13, v12 bitop3:0xca
    v_add_lshl_u32 v11, v11, s40, 17
    v_lshlrev_b16 v14, 8, v14
    v_lshrrev_b32 v13, 2, v103
    v_or_b32 v99, v12, v11
    v_bitop3_b32 v103, v5, v13, v14 bitop3:0xea
    ds_add_u32 v103, v2
    v_cvt_pk_bf16_f32 v85, v9, v10
    v_perm_b32 v12, v85, v85, s41
    v_bitop3_b32 v98, v4, v12, v98 bitop3:0xca
    v_perm_b32 v13, v85, v85, s42
    v_bitop3_b32 v99, v4, v13, v99 bitop3:0xca
    s_add_u32 s44, s35, 0x5494000
    buffer_store_dwordx4 v[16:19], v0, s[20:23], s44 offen sc1
    s_add_u32 s45, s38, 0x4000
    s_nop 0
    buffer_load_dwordx4 v[16:19], v0, s[8:11], s45 offen nt
    s_waitcnt vmcnt(9)
    v_lshlrev_b32 v7, 16, v86
    v_and_b32 v8, 0xffff0000, v86
    v_lshlrev_b32 v9, 16, v87
    v_and_b32 v10, 0xffff0000, v87
    v_mul_f32 v7, 0.15915494, v7
    v_mul_f32 v8, 0.15915494, v8
    v_mul_f32 v9, 0.15915494, v9
    v_mul_f32 v10, 0.15915494, v10
    v_mul_hi_u32_u24 v14, 429497, v108
    v_lshrrev_b32 v12, 3, v112
    v_cos_f32 v7, v7
    v_lshlrev_b16 v13, 3, v112
    v_mad_i32_i24 v11, v14, s55, v108
    v_bitop3_b32 v12, v6, v13, v12 bitop3:0xca
    v_add_lshl_u32 v11, v11, s40, 17
    v_lshlrev_b16 v14, 8, v14
    v_lshrrev_b32 v13, 2, v112
    v_or_b32 v108, v12, v11
    v_bitop3_b32 v112, v5, v13, v14 bitop3:0xea
    ds_add_u32 v112, v2
    v_mul_hi_u32_u24 v14, 429497, v109
    v_lshrrev_b32 v12, 3, v113
    v_cos_f32 v8, v8
    v_lshlrev_b16 v13, 3, v113
    v_mad_i32_i24 v11, v14, s55, v109
    v_bitop3_b32 v12, v6, v13, v12 bitop3:0xca
    v_add_lshl_u32 v11, v11, s40, 17
    v_lshlrev_b16 v14, 8, v14
    v_lshrrev_b32 v13, 2, v113
    v_or_b32 v109, v12, v11
    v_bitop3_b32 v113, v5, v13, v14 bitop3:0xea
    ds_add_u32 v113, v2
    v_cvt_pk_bf16_f32 v86, v7, v8
    v_perm_b32 v12, v86, v86, s41
    v_bitop3_b32 v108, v4, v12, v108 bitop3:0xca
    v_perm_b32 v13, v86, v86, s42
    v_bitop3_b32 v109, v4, v13, v109 bitop3:0xca
    v_mul_hi_u32_u24 v14, 429497, v110
    v_lshrrev_b32 v12, 3, v114
    v_cos_f32 v9, v9
    v_lshlrev_b16 v13, 3, v114
    v_mad_i32_i24 v11, v14, s55, v110
    v_bitop3_b32 v12, v6, v13, v12 bitop3:0xca
    v_add_lshl_u32 v11, v11, s40, 17
    v_lshlrev_b16 v14, 8, v14
    v_lshrrev_b32 v13, 2, v114
    v_or_b32 v110, v12, v11
    v_bitop3_b32 v114, v5, v13, v14 bitop3:0xea
    ds_add_u32 v114, v2
    v_mul_hi_u32_u24 v14, 429497, v111
    v_lshrrev_b32 v12, 3, v115
    v_cos_f32 v10, v10
    v_lshlrev_b16 v13, 3, v115
    v_mad_i32_i24 v11, v14, s55, v111
    v_bitop3_b32 v12, v6, v13, v12 bitop3:0xca
    v_add_lshl_u32 v11, v11, s40, 17
    v_lshlrev_b16 v14, 8, v14
    v_lshrrev_b32 v13, 2, v115
    v_or_b32 v111, v12, v11
    v_bitop3_b32 v115, v5, v13, v14 bitop3:0xea
    ds_add_u32 v115, v2
    v_cvt_pk_bf16_f32 v87, v9, v10
    v_perm_b32 v12, v87, v87, s41
    v_bitop3_b32 v110, v4, v12, v110 bitop3:0xca
    v_perm_b32 v13, v87, v87, s42
    v_bitop3_b32 v111, v4, v13, v111 bitop3:0xca
    v_lshrrev_b32 v8, 2, v0
    v_and_b32 v7, 0x3c00, v0
    v_bitop3_b32 v7, v5, v8, v7 bitop3:0xea
    s_waitcnt lgkmcnt(0)
    s_barrier
    ds_read2st64_b32 v[8:9], v7 offset0:0 offset1:1
    ds_read2st64_b32 v[10:11], v7 offset0:2 offset1:3
    s_add_u32 s46, s35, 0x5498000
    buffer_store_dwordx4 v[20:23], v0, s[20:23], s46 offen sc1
    s_add_u32 s47, s38, 0x4000
    s_nop 0
    buffer_load_dwordx4 v[20:23], v0, s[12:15], s47 offen nt
    s_waitcnt lgkmcnt(0)
    v_lshl_or_b32 v12, v9, 16, v8
    v_lshl_or_b32 v13, v11, 16, v10
    v_mov_b32 v14, v12
    v_mov_b32 v15, v13
    s_nop 0
    v_add_u32_dpp v14, v14, v14 row_shr:1 row_mask:0xf bank_mask:0xf bound_ctrl:1
    v_add_u32_dpp v15, v15, v15 row_shr:1 row_mask:0xf bank_mask:0xf bound_ctrl:1
    s_nop 0
    v_add_u32_dpp v14, v14, v14 row_shr:2 row_mask:0xf bank_mask:0xf bound_ctrl:1
    v_add_u32_dpp v15, v15, v15 row_shr:2 row_mask:0xf bank_mask:0xf bound_ctrl:1
    s_nop 0
    v_add_u32_dpp v14, v14, v14 row_shr:4 row_mask:0xf bank_mask:0xf bound_ctrl:1
    v_add_u32_dpp v15, v15, v15 row_shr:4 row_mask:0xf bank_mask:0xf bound_ctrl:1
    s_nop 0
    v_add_u32_dpp v14, v14, v14 row_shr:8 row_mask:0xf bank_mask:0xf bound_ctrl:1
    v_add_u32_dpp v15, v15, v15 row_shr:8 row_mask:0xf bank_mask:0xf bound_ctrl:1
    s_nop 0
    v_add_u32_dpp v14, v14, v14 row_bcast:15 row_mask:0xa bank_mask:0xf
    v_add_u32_dpp v15, v15, v15 row_bcast:15 row_mask:0xa bank_mask:0xf
    s_nop 0
    v_add_u32_dpp v14, v14, v14 row_bcast:31 row_mask:0xc bank_mask:0xf
    v_add_u32_dpp v15, v15, v15 row_bcast:31 row_mask:0xc bank_mask:0xf
    v_readlane_b32 s48, v14, 63
    v_readlane_b32 s49, v15, 63
    s_lshl_b32 s54, s32, 2
    v_mov_b32 v8, s54
    s_and_b32 s50, s48, 0xffff
    s_lshr_b32 s51, s48, 16
    s_and_b32 s52, s49, 0xffff
    s_lshr_b32 s53, s49, 16
    s_add_u32 s51, s51, s50
    s_add_u32 s52, s52, s51
    s_add_u32 s53, s53, s52
    v_mov_b32 v9, s53
    s_mov_b64 exec, 1
    ds_write_b32 v8, v9 offset:16384
    s_waitcnt vmcnt(7)
    ds_write_b32 v8, v3 offset:16448
    s_mov_b64 exec, -1
    v_and_b32 v8, 60, v7
    s_waitcnt lgkmcnt(0)
    s_barrier
    ds_read_b32 v9, v8 offset:16384
    ds_read_b32 v10, v8 offset:16448
    s_waitcnt lgkmcnt(0)
    v_readlane_b32 s84, v10, 15
    s_min_u32 s4, s84, 136
    s_min_u32 s5, s84, 176
    s_min_u32 s6, s84, 216
    s_add_u32 s4, s4, s5
    s_add_u32 s4, s4, s6
    s_add_u32 s4, s4, 9467
    s_lshl_b32 s58, s4, 14
    s_lshl_b32 s59, s4, 13
    s_mov_b32 s43, 5
    s_cmp_lt_u32 s84, 136
    s_addc_u32 s43, s43, 0
    s_cmp_lt_u32 s84, 176
    s_addc_u32 s43, s43, 0
    s_cmp_lt_u32 s84, 216
    s_addc_u32 s43, s43, 0
    v_add_u32_dpp v9, v9, v9 row_shr:1 row_mask:0xf bank_mask:0xf bound_ctrl:1
    s_nop 1
    v_add_u32_dpp v9, v9, v9 row_shr:2 row_mask:0xf bank_mask:0xf bound_ctrl:1
    s_nop 1
    v_add_u32_dpp v9, v9, v9 row_shr:4 row_mask:0xf bank_mask:0xf bound_ctrl:1
    s_nop 1
    v_add_u32_dpp v9, v9, v9 row_shr:8 row_mask:0xf bank_mask:0xf bound_ctrl:1
    s_nop 0
    v_readlane_b32 s54, v9, s32
    s_sub_u32 s54, s54, s53
    s_add_u32 s50, s50, s54
    s_add_u32 s51, s51, s54
    s_add_u32 s52, s52, s54
    s_pack_ll_b32_b16 s48, s54, s50
    s_pack_ll_b32_b16 s49, s51, s52
    v_add_u32 v14, s48, v14
    v_add_u32 v15, s49, v15
    v_sub_u32 v12, v14, v12
    v_sub_u32 v13, v15, v13
    v_and_b32 v8, 0xffff, v12
    v_lshrrev_b32 v9, 16, v12
    v_and_b32 v10, 0xffff, v13
    v_lshrrev_b32 v11, 16, v13
    ds_write2st64_b32 v7, v8, v9 offset0:0 offset1:1
    ds_write2st64_b32 v7, v10, v11 offset0:2 offset1:3
    s_waitcnt lgkmcnt(0)
    s_barrier
    ds_add_rtn_u32 v40, v40, v2
    ds_add_rtn_u32 v41, v41, v2
    ds_add_rtn_u32 v42, v42, v2
    ds_add_rtn_u32 v43, v43, v2
    s_add_u32 s44, s36, 0x7ec0000
    v_and_b32 v11, 0x3f0, v0
    v_add_u32 v11, v11, v11
    buffer_store_dwordx2 v[12:13], v11, s[24:27], s44 offen
    s_bitset0_b64 exec, 63
    s_not_b64 exec, exec
    buffer_store_dwordx2 v[14:15], v11, s[24:27], s44 offen offset:32
    s_mov_b64 exec, -1
    ds_add_rtn_u32 v52, v52, v2
    ds_add_rtn_u32 v53, v53, v2
    ds_add_rtn_u32 v54, v54, v2
    ds_add_rtn_u32 v55, v55, v2
    ds_add_rtn_u32 v60, v60, v2
    ds_add_rtn_u32 v61, v61, v2
    ds_add_rtn_u32 v62, v62, v2
    ds_add_rtn_u32 v63, v63, v2
    s_add_u32 s45, s35, 0x549c000
    buffer_store_dwordx4 v[28:31], v0, s[20:23], s45 offen sc1
    s_add_u32 s46, s38, 0x8000
    s_nop 0
    buffer_load_dwordx4 v[28:31], v0, s[8:11], s46 offen nt
    ds_add_rtn_u32 v72, v72, v2
    ds_add_rtn_u32 v73, v73, v2
    ds_add_rtn_u32 v74, v74, v2
    ds_add_rtn_u32 v75, v75, v2
    ds_add_rtn_u32 v80, v80, v2
    ds_add_rtn_u32 v81, v81, v2
    ds_add_rtn_u32 v82, v82, v2
    ds_add_rtn_u32 v83, v83, v2
    s_add_u32 s47, s35, 0x54a0000
    buffer_store_dwordx4 v[32:35], v0, s[20:23], s47 offen sc1
    s_add_u32 s44, s38, 0x8000
    s_nop 0
    buffer_load_dwordx4 v[32:35], v0, s[12:15], s44 offen nt
    ds_add_rtn_u32 v92, v92, v2
    ds_add_rtn_u32 v93, v93, v2
    ds_add_rtn_u32 v94, v94, v2
    ds_add_rtn_u32 v95, v95, v2
    ds_add_rtn_u32 v100, v100, v2
    ds_add_rtn_u32 v101, v101, v2
    ds_add_rtn_u32 v102, v102, v2
    ds_add_rtn_u32 v103, v103, v2
    s_add_u32 s45, s35, 0x54a4000
    buffer_store_dwordx4 v[124:127], v0, s[20:23], s45 offen sc1
    s_add_u32 s46, s39, 0x4000
    s_nop 0
    buffer_load_dwordx2 v[124:125], v1, s[16:19], s46 offen nt
    s_add_u32 s47, s39, 0x6000
    buffer_load_dwordx2 v[126:127], v1, s[16:19], s47 offen nt
    ds_add_rtn_u32 v112, v112, v2
    ds_add_rtn_u32 v113, v113, v2
    ds_add_rtn_u32 v114, v114, v2
    ds_add_rtn_u32 v115, v115, v2
    s_waitcnt lgkmcnt(0)
    s_barrier
    v_and_b32 v7, -4, v40
    v_lshl_add_u32 v8, v40, 2, v7
    ds_write_b32 v8, v36
    v_lshl_add_u32 v7, v7, 2, v40
    ds_write_b8 v7, v24 offset:16
    v_and_b32 v9, -4, v41
    v_lshl_add_u32 v10, v41, 2, v9
    ds_write_b32 v10, v37
    v_lshl_add_u32 v9, v9, 2, v41
    ds_write_b8_d16_hi v9, v24 offset:16
    v_and_b32 v7, -4, v42
    v_lshl_add_u32 v8, v42, 2, v7
    ds_write_b32 v8, v38
    v_lshl_add_u32 v7, v7, 2, v42
    ds_write_b8 v7, v25 offset:16
    v_and_b32 v9, -4, v43
    v_lshl_add_u32 v10, v43, 2, v9
    ds_write_b32 v10, v39
    v_lshl_add_u32 v9, v9, 2, v43
    ds_write_b8_d16_hi v9, v25 offset:16
    s_add_u32 s44, s38, 0xc000
    buffer_load_dwordx4 v[36:39], v0, s[8:11], s44 offen nt
    s_add_u32 s45, s38, 0xc000
    buffer_load_dwordx4 v[40:43], v0, s[12:15], s45 offen nt
    v_and_b32 v7, -4, v52
    v_lshl_add_u32 v8, v52, 2, v7
    ds_write_b32 v8, v48
    v_lshl_add_u32 v7, v7, 2, v52
    ds_write_b8 v7, v26 offset:16
    v_and_b32 v9, -4, v53
    v_lshl_add_u32 v10, v53, 2, v9
    ds_write_b32 v10, v49
    v_lshl_add_u32 v9, v9, 2, v53
    ds_write_b8_d16_hi v9, v26 offset:16
    v_and_b32 v7, -4, v54
    v_lshl_add_u32 v8, v54, 2, v7
    ds_write_b32 v8, v50
    v_lshl_add_u32 v7, v7, 2, v54
    ds_write_b8 v7, v27 offset:16
    v_and_b32 v9, -4, v55
    v_lshl_add_u32 v10, v55, 2, v9
    ds_write_b32 v10, v51
    v_lshl_add_u32 v9, v9, 2, v55
    ds_write_b8_d16_hi v9, v27 offset:16
    s_add_u32 s46, s38, 0x10000
    buffer_load_dwordx4 v[48:51], v0, s[8:11], s46 offen nt
    v_and_b32 v7, -4, v60
    v_lshl_add_u32 v8, v60, 2, v7
    ds_write_b32 v8, v56
    v_lshl_add_u32 v7, v7, 2, v60
    ds_write_b8 v7, v44 offset:16
    v_and_b32 v9, -4, v61
    v_lshl_add_u32 v10, v61, 2, v9
    ds_write_b32 v10, v57
    v_lshl_add_u32 v9, v9, 2, v61
    ds_write_b8_d16_hi v9, v44 offset:16
    v_and_b32 v7, -4, v62
    v_lshl_add_u32 v8, v62, 2, v7
    ds_write_b32 v8, v58
    v_lshl_add_u32 v7, v7, 2, v62
    ds_write_b8 v7, v45 offset:16
    v_and_b32 v9, -4, v63
    v_lshl_add_u32 v10, v63, 2, v9
    ds_write_b32 v10, v59
    v_lshl_add_u32 v9, v9, 2, v63
    ds_write_b8_d16_hi v9, v45 offset:16
    s_add_u32 s47, s38, 0x10000
    buffer_load_dwordx4 v[52:55], v0, s[12:15], s47 offen nt
    v_and_b32 v7, -4, v72
    v_lshl_add_u32 v8, v72, 2, v7
    ds_write_b32 v8, v68
    v_lshl_add_u32 v7, v7, 2, v72
    ds_write_b8 v7, v46 offset:16
    v_and_b32 v9, -4, v73
    v_lshl_add_u32 v10, v73, 2, v9
    ds_write_b32 v10, v69
    v_lshl_add_u32 v9, v9, 2, v73
    ds_write_b8_d16_hi v9, v46 offset:16
    v_and_b32 v7, -4, v74
    v_lshl_add_u32 v8, v74, 2, v7
    ds_write_b32 v8, v70
    v_lshl_add_u32 v7, v7, 2, v74
    ds_write_b8 v7, v47 offset:16
    v_and_b32 v9, -4, v75
    v_lshl_add_u32 v10, v75, 2, v9
    ds_write_b32 v10, v71
    v_lshl_add_u32 v9, v9, 2, v75
    ds_write_b8_d16_hi v9, v47 offset:16
    s_add_u32 s44, s39, 0x8000
    buffer_load_dwordx2 v[24:25], v1, s[16:19], s44 offen nt
    s_cmp_le_u32 s43, 5
    s_cselect_b32 s18, 0, s18
    s_add_u32 s45, s59, 0xa000
    buffer_load_dwordx2 v[26:27], v1, s[16:19], s45 offen nt
    v_and_b32 v7, -4, v80
    v_lshl_add_u32 v8, v80, 2, v7
    ds_write_b32 v8, v76
    v_lshl_add_u32 v7, v7, 2, v80
    ds_write_b8 v7, v64 offset:16
    v_and_b32 v9, -4, v81
    v_lshl_add_u32 v10, v81, 2, v9
    ds_write_b32 v10, v77
    v_lshl_add_u32 v9, v9, 2, v81
    ds_write_b8_d16_hi v9, v64 offset:16
    v_and_b32 v7, -4, v82
    v_lshl_add_u32 v8, v82, 2, v7
    ds_write_b32 v8, v78
    v_lshl_add_u32 v7, v7, 2, v82
    ds_write_b8 v7, v65 offset:16
    v_and_b32 v9, -4, v83
    v_lshl_add_u32 v10, v83, 2, v9
    ds_write_b32 v10, v79
    v_lshl_add_u32 v9, v9, 2, v83
    ds_write_b8_d16_hi v9, v65 offset:16
    s_cmp_le_u32 s43, 5
    s_cselect_b32 s10, 0, s10
    s_add_u32 s46, s58, 0x14000
    buffer_load_dwordx4 v[56:59], v0, s[8:11], s46 offen nt
    s_cmp_le_u32 s43, 5
    s_cselect_b32 s14, 0, s14
    s_add_u32 s47, s58, 0x14000
    buffer_load_dwordx4 v[60:63], v0, s[12:15], s47 offen nt
    v_and_b32 v7, -4, v92
    v_lshl_add_u32 v8, v92, 2, v7
    ds_write_b32 v8, v88
    v_lshl_add_u32 v7, v7, 2, v92
    ds_write_b8 v7, v66 offset:16
    v_and_b32 v9, -4, v93
    v_lshl_add_u32 v10, v93, 2, v9
    ds_write_b32 v10, v89
    v_lshl_add_u32 v9, v9, 2, v93
    ds_write_b8_d16_hi v9, v66 offset:16
    v_and_b32 v7, -4, v94
    v_lshl_add_u32 v8, v94, 2, v7
    ds_write_b32 v8, v90
    v_lshl_add_u32 v7, v7, 2, v94
    ds_write_b8 v7, v67 offset:16
    v_and_b32 v9, -4, v95
    v_lshl_add_u32 v10, v95, 2, v9
    ds_write_b32 v10, v91
    v_lshl_add_u32 v9, v9, 2, v95
    ds_write_b8_d16_hi v9, v67 offset:16
    s_cmp_le_u32 s43, 6
    s_cselect_b32 s10, 0, s10
    s_add_u32 s44, s58, 0x18000
    buffer_load_dwordx4 v[68:71], v0, s[8:11], s44 offen nt
    v_and_b32 v7, -4, v100
    v_lshl_add_u32 v8, v100, 2, v7
    ds_write_b32 v8, v96
    v_lshl_add_u32 v7, v7, 2, v100
    ds_write_b8 v7, v84 offset:16
    v_and_b32 v9, -4, v101
    v_lshl_add_u32 v10, v101, 2, v9
    ds_write_b32 v10, v97
    v_lshl_add_u32 v9, v9, 2, v101
    ds_write_b8_d16_hi v9, v84 offset:16
    v_and_b32 v7, -4, v102
    v_lshl_add_u32 v8, v102, 2, v7
    ds_write_b32 v8, v98
    v_lshl_add_u32 v7, v7, 2, v102
    ds_write_b8 v7, v85 offset:16
    v_and_b32 v9, -4, v103
    v_lshl_add_u32 v10, v103, 2, v9
    ds_write_b32 v10, v99
    v_lshl_add_u32 v9, v9, 2, v103
    ds_write_b8_d16_hi v9, v85 offset:16
    s_cmp_le_u32 s43, 6
    s_cselect_b32 s14, 0, s14
    s_add_u32 s45, s58, 0x18000
    buffer_load_dwordx4 v[72:75], v0, s[12:15], s45 offen nt
    v_and_b32 v7, -4, v112
    v_lshl_add_u32 v8, v112, 2, v7
    ds_write_b32 v8, v108
    v_lshl_add_u32 v7, v7, 2, v112
    ds_write_b8 v7, v86 offset:16
    v_and_b32 v9, -4, v113
    v_lshl_add_u32 v10, v113, 2, v9
    ds_write_b32 v10, v109
    v_lshl_add_u32 v9, v9, 2, v113
    ds_write_b8_d16_hi v9, v86 offset:16
    v_and_b32 v7, -4, v114
    v_lshl_add_u32 v8, v114, 2, v7
    ds_write_b32 v8, v110
    v_lshl_add_u32 v7, v7, 2, v114
    ds_write_b8 v7, v87 offset:16
    v_and_b32 v9, -4, v115
    v_lshl_add_u32 v10, v115, 2, v9
    ds_write_b32 v10, v111
    v_lshl_add_u32 v9, v9, 2, v115
    ds_write_b8_d16_hi v9, v87 offset:16
    s_cmp_le_u32 s43, 6
    s_cselect_b32 s18, 0, s18
    s_add_u32 s46, s59, 0xc000
    buffer_load_dwordx2 v[44:45], v1, s[16:19], s46 offen nt
    s_cmp_le_u32 s43, 7
    s_cselect_b32 s18, 0, s18
    s_add_u32 s47, s59, 0xe000
    buffer_load_dwordx2 v[46:47], v1, s[16:19], s47 offen nt
    v_add_u32 v7, 0x10000, v0
    v_add_u32 v12, 0x20000, v0
    v_mov_b32 v8, 0
    v_mov_b32 v9, 0
    v_mov_b32 v10, 0
    v_mov_b32 v11, 0
    s_waitcnt lgkmcnt(0)
    s_barrier
    ds_read_b128 v[76:79], v0 offset:0
    ds_write_b128 v0, v[8:11]
    ds_read_b128 v[80:83], v0 offset:16384
    ds_read_b128 v[88:91], v0 offset:32768
    ds_read_b128 v[92:95], v0 offset:49152
    ds_read_b128 v[64:67], v7 offset:0
    ds_read_b128 v[96:99], v7 offset:16384
    ds_read_b128 v[100:103], v7 offset:32768
    ds_read_b128 v[108:111], v7 offset:49152
    ds_read_b128 v[112:115], v12 offset:0
    ds_read_b128 v[84:87], v12 offset:16384
    s_waitcnt lgkmcnt(0)
    s_barrier
    s_add_u32 s44, s35, 0x7ec0000
    buffer_store_dwordx4 v[76:79], v0, s[20:23], s44 offen sc1
    s_cmp_le_u32 s43, 7
    s_cselect_b32 s10, 0, s10
    s_add_u32 s45, s58, 0x1c000
    buffer_load_dwordx4 v[76:79], v0, s[8:11], s45 offen nt
    s_add_u32 s46, s35, 0x7ec4000
    buffer_store_dwordx4 v[80:83], v0, s[20:23], s46 offen sc1
    s_cmp_le_u32 s43, 7
    s_cselect_b32 s14, 0, s14
    s_add_u32 s47, s58, 0x1c000
    buffer_load_dwordx4 v[80:83], v0, s[12:15], s47 offen nt
    s_waitcnt vmcnt(29)
    v_lshlrev_b32 v7, 16, v104
    v_and_b32 v8, 0xffff0000, v104
    v_lshlrev_b32 v9, 16, v105
    v_and_b32 v10, 0xffff0000, v105
    v_mul_f32 v7, 0.15915494, v7
    v_mul_f32 v8, 0.15915494, v8
    v_mul_f32 v9, 0.15915494, v9
    v_mul_f32 v10, 0.15915494, v10
    v_mul_hi_u32_u24 v14, 429497, v116
    v_lshrrev_b32 v12, 3, v120
    v_cos_f32 v7, v7
    v_lshlrev_b16 v13, 3, v120
    v_mad_i32_i24 v11, v14, s55, v116
    v_bitop3_b32 v12, v6, v13, v12 bitop3:0xca
    v_add_lshl_u32 v11, v11, s40, 17
    v_lshlrev_b16 v14, 8, v14
    v_lshrrev_b32 v13, 2, v120
    v_or_b32 v116, v12, v11
    v_bitop3_b32 v120, v5, v13, v14 bitop3:0xea
    ds_add_u32 v120, v2
    v_mul_hi_u32_u24 v14, 429497, v117
    v_lshrrev_b32 v12, 3, v121
    v_cos_f32 v8, v8
    v_lshlrev_b16 v13, 3, v121
    v_mad_i32_i24 v11, v14, s55, v117
    v_bitop3_b32 v12, v6, v13, v12 bitop3:0xca
    v_add_lshl_u32 v11, v11, s40, 17
    v_lshlrev_b16 v14, 8, v14
    v_lshrrev_b32 v13, 2, v121
    v_or_b32 v117, v12, v11
    v_bitop3_b32 v121, v5, v13, v14 bitop3:0xea
    ds_add_u32 v121, v2
    v_cvt_pk_bf16_f32 v104, v7, v8
    v_perm_b32 v12, v104, v104, s41
    v_bitop3_b32 v116, v4, v12, v116 bitop3:0xca
    v_perm_b32 v13, v104, v104, s42
    v_bitop3_b32 v117, v4, v13, v117 bitop3:0xca
    v_mul_hi_u32_u24 v14, 429497, v118
    v_lshrrev_b32 v12, 3, v122
    v_cos_f32 v9, v9
    v_lshlrev_b16 v13, 3, v122
    v_mad_i32_i24 v11, v14, s55, v118
    v_bitop3_b32 v12, v6, v13, v12 bitop3:0xca
    v_add_lshl_u32 v11, v11, s40, 17
    v_lshlrev_b16 v14, 8, v14
    v_lshrrev_b32 v13, 2, v122
    v_or_b32 v118, v12, v11
    v_bitop3_b32 v122, v5, v13, v14 bitop3:0xea
    ds_add_u32 v122, v2
    v_mul_hi_u32_u24 v14, 429497, v119
    v_lshrrev_b32 v12, 3, v123
    v_cos_f32 v10, v10
    v_lshlrev_b16 v13, 3, v123
    v_mad_i32_i24 v11, v14, s55, v119
    v_bitop3_b32 v12, v6, v13, v12 bitop3:0xca
    v_add_lshl_u32 v11, v11, s40, 17
    v_lshlrev_b16 v14, 8, v14
    v_lshrrev_b32 v13, 2, v123
    v_or_b32 v119, v12, v11
    v_bitop3_b32 v123, v5, v13, v14 bitop3:0xea
    ds_add_u32 v123, v2
    v_cvt_pk_bf16_f32 v105, v9, v10
    v_perm_b32 v12, v105, v105, s41
    v_bitop3_b32 v118, v4, v12, v118 bitop3:0xca
    v_perm_b32 v13, v105, v105, s42
    v_bitop3_b32 v119, v4, v13, v119 bitop3:0xca
    s_add_u32 s44, s35, 0x7ec8000
    buffer_store_dwordx4 v[88:91], v0, s[20:23], s44 offen sc1
    s_waitcnt vmcnt(26)
    v_lshlrev_b32 v7, 16, v106
    v_and_b32 v8, 0xffff0000, v106
    v_lshlrev_b32 v9, 16, v107
    v_and_b32 v10, 0xffff0000, v107
    v_mul_f32 v7, 0.15915494, v7
    v_mul_f32 v8, 0.15915494, v8
    v_mul_f32 v9, 0.15915494, v9
    v_mul_f32 v10, 0.15915494, v10
    v_mul_hi_u32_u24 v14, 429497, v16
    v_lshrrev_b32 v12, 3, v20
    v_cos_f32 v7, v7
    v_lshlrev_b16 v13, 3, v20
    v_mad_i32_i24 v11, v14, s55, v16
    v_bitop3_b32 v12, v6, v13, v12 bitop3:0xca
    v_add_lshl_u32 v11, v11, s40, 17
    v_lshlrev_b16 v14, 8, v14
    v_lshrrev_b32 v13, 2, v20
    v_or_b32 v16, v12, v11
    v_bitop3_b32 v20, v5, v13, v14 bitop3:0xea
    ds_add_u32 v20, v2
    v_mul_hi_u32_u24 v14, 429497, v17
    v_lshrrev_b32 v12, 3, v21
    v_cos_f32 v8, v8
    v_lshlrev_b16 v13, 3, v21
    v_mad_i32_i24 v11, v14, s55, v17
    v_bitop3_b32 v12, v6, v13, v12 bitop3:0xca
    v_add_lshl_u32 v11, v11, s40, 17
    v_lshlrev_b16 v14, 8, v14
    v_lshrrev_b32 v13, 2, v21
    v_or_b32 v17, v12, v11
    v_bitop3_b32 v21, v5, v13, v14 bitop3:0xea
    ds_add_u32 v21, v2
    v_cvt_pk_bf16_f32 v106, v7, v8
    v_perm_b32 v12, v106, v106, s41
    v_bitop3_b32 v16, v4, v12, v16 bitop3:0xca
    v_perm_b32 v13, v106, v106, s42
    v_bitop3_b32 v17, v4, v13, v17 bitop3:0xca
    v_mul_hi_u32_u24 v14, 429497, v18
    v_lshrrev_b32 v12, 3, v22
    v_cos_f32 v9, v9
    v_lshlrev_b16 v13, 3, v22
    v_mad_i32_i24 v11, v14, s55, v18
    v_bitop3_b32 v12, v6, v13, v12 bitop3:0xca
    v_add_lshl_u32 v11, v11, s40, 17
    v_lshlrev_b16 v14, 8, v14
    v_lshrrev_b32 v13, 2, v22
    v_or_b32 v18, v12, v11
    v_bitop3_b32 v22, v5, v13, v14 bitop3:0xea
    ds_add_u32 v22, v2
    v_mul_hi_u32_u24 v14, 429497, v19
    v_lshrrev_b32 v12, 3, v23
    v_cos_f32 v10, v10
    v_lshlrev_b16 v13, 3, v23
    v_mad_i32_i24 v11, v14, s55, v19
    v_bitop3_b32 v12, v6, v13, v12 bitop3:0xca
    v_add_lshl_u32 v11, v11, s40, 17
    v_lshlrev_b16 v14, 8, v14
    v_lshrrev_b32 v13, 2, v23
    v_or_b32 v19, v12, v11
    v_bitop3_b32 v23, v5, v13, v14 bitop3:0xea
    ds_add_u32 v23, v2
    v_cvt_pk_bf16_f32 v107, v9, v10
    v_perm_b32 v12, v107, v107, s41
    v_bitop3_b32 v18, v4, v12, v18 bitop3:0xca
    v_perm_b32 v13, v107, v107, s42
    v_bitop3_b32 v19, v4, v13, v19 bitop3:0xca
    s_waitcnt vmcnt(17)
    v_lshlrev_b32 v7, 16, v124
    v_and_b32 v8, 0xffff0000, v124
    v_lshlrev_b32 v9, 16, v125
    v_and_b32 v10, 0xffff0000, v125
    v_mul_f32 v7, 0.15915494, v7
    v_mul_f32 v8, 0.15915494, v8
    v_mul_f32 v9, 0.15915494, v9
    v_mul_f32 v10, 0.15915494, v10
    v_mul_hi_u32_u24 v14, 429497, v28
    v_lshrrev_b32 v12, 3, v32
    v_cos_f32 v7, v7
    v_lshlrev_b16 v13, 3, v32
    v_mad_i32_i24 v11, v14, s55, v28
    v_bitop3_b32 v12, v6, v13, v12 bitop3:0xca
    v_add_lshl_u32 v11, v11, s40, 17
    v_lshlrev_b16 v14, 8, v14
    v_lshrrev_b32 v13, 2, v32
    v_or_b32 v28, v12, v11
    v_bitop3_b32 v32, v5, v13, v14 bitop3:0xea
    ds_add_u32 v32, v2
    v_mul_hi_u32_u24 v14, 429497, v29
    v_lshrrev_b32 v12, 3, v33
    v_cos_f32 v8, v8
    v_lshlrev_b16 v13, 3, v33
    v_mad_i32_i24 v11, v14, s55, v29
    v_bitop3_b32 v12, v6, v13, v12 bitop3:0xca
    v_add_lshl_u32 v11, v11, s40, 17
    v_lshlrev_b16 v14, 8, v14
    v_lshrrev_b32 v13, 2, v33
    v_or_b32 v29, v12, v11
    v_bitop3_b32 v33, v5, v13, v14 bitop3:0xea
    ds_add_u32 v33, v2
    v_cvt_pk_bf16_f32 v124, v7, v8
    v_perm_b32 v12, v124, v124, s41
    v_bitop3_b32 v28, v4, v12, v28 bitop3:0xca
    v_perm_b32 v13, v124, v124, s42
    v_bitop3_b32 v29, v4, v13, v29 bitop3:0xca
    v_mul_hi_u32_u24 v14, 429497, v30
    v_lshrrev_b32 v12, 3, v34
    v_cos_f32 v9, v9
    v_lshlrev_b16 v13, 3, v34
    v_mad_i32_i24 v11, v14, s55, v30
    v_bitop3_b32 v12, v6, v13, v12 bitop3:0xca
    v_add_lshl_u32 v11, v11, s40, 17
    v_lshlrev_b16 v14, 8, v14
    v_lshrrev_b32 v13, 2, v34
    v_or_b32 v30, v12, v11
    v_bitop3_b32 v34, v5, v13, v14 bitop3:0xea
    ds_add_u32 v34, v2
    v_mul_hi_u32_u24 v14, 429497, v31
    v_lshrrev_b32 v12, 3, v35
    v_cos_f32 v10, v10
    v_lshlrev_b16 v13, 3, v35
    v_mad_i32_i24 v11, v14, s55, v31
    v_bitop3_b32 v12, v6, v13, v12 bitop3:0xca
    v_add_lshl_u32 v11, v11, s40, 17
    v_lshlrev_b16 v14, 8, v14
    v_lshrrev_b32 v13, 2, v35
    v_or_b32 v31, v12, v11
    v_bitop3_b32 v35, v5, v13, v14 bitop3:0xea
    ds_add_u32 v35, v2
    v_cvt_pk_bf16_f32 v125, v9, v10
    v_perm_b32 v12, v125, v125, s41
    v_bitop3_b32 v30, v4, v12, v30 bitop3:0xca
    v_perm_b32 v13, v125, v125, s42
    v_bitop3_b32 v31, v4, v13, v31 bitop3:0xca
    s_waitcnt vmcnt(15)
    v_lshlrev_b32 v7, 16, v126
    v_and_b32 v8, 0xffff0000, v126
    v_lshlrev_b32 v9, 16, v127
    v_and_b32 v10, 0xffff0000, v127
    v_mul_f32 v7, 0.15915494, v7
    v_mul_f32 v8, 0.15915494, v8
    v_mul_f32 v9, 0.15915494, v9
    v_mul_f32 v10, 0.15915494, v10
    v_mul_hi_u32_u24 v14, 429497, v36
    v_lshrrev_b32 v12, 3, v40
    v_cos_f32 v7, v7
    v_lshlrev_b16 v13, 3, v40
    v_mad_i32_i24 v11, v14, s55, v36
    v_bitop3_b32 v12, v6, v13, v12 bitop3:0xca
    v_add_lshl_u32 v11, v11, s40, 17
    v_lshlrev_b16 v14, 8, v14
    v_lshrrev_b32 v13, 2, v40
    v_or_b32 v36, v12, v11
    v_bitop3_b32 v40, v5, v13, v14 bitop3:0xea
    ds_add_u32 v40, v2
    v_mul_hi_u32_u24 v14, 429497, v37
    v_lshrrev_b32 v12, 3, v41
    v_cos_f32 v8, v8
    v_lshlrev_b16 v13, 3, v41
    v_mad_i32_i24 v11, v14, s55, v37
    v_bitop3_b32 v12, v6, v13, v12 bitop3:0xca
    v_add_lshl_u32 v11, v11, s40, 17
    v_lshlrev_b16 v14, 8, v14
    v_lshrrev_b32 v13, 2, v41
    v_or_b32 v37, v12, v11
    v_bitop3_b32 v41, v5, v13, v14 bitop3:0xea
    ds_add_u32 v41, v2
    v_cvt_pk_bf16_f32 v126, v7, v8
    v_perm_b32 v12, v126, v126, s41
    v_bitop3_b32 v36, v4, v12, v36 bitop3:0xca
    v_perm_b32 v13, v126, v126, s42
    v_bitop3_b32 v37, v4, v13, v37 bitop3:0xca
    v_mul_hi_u32_u24 v14, 429497, v38
    v_lshrrev_b32 v12, 3, v42
    v_cos_f32 v9, v9
    v_lshlrev_b16 v13, 3, v42
    v_mad_i32_i24 v11, v14, s55, v38
    v_bitop3_b32 v12, v6, v13, v12 bitop3:0xca
    v_add_lshl_u32 v11, v11, s40, 17
    v_lshlrev_b16 v14, 8, v14
    v_lshrrev_b32 v13, 2, v42
    v_or_b32 v38, v12, v11
    v_bitop3_b32 v42, v5, v13, v14 bitop3:0xea
    ds_add_u32 v42, v2
    v_mul_hi_u32_u24 v14, 429497, v39
    v_lshrrev_b32 v12, 3, v43
    v_cos_f32 v10, v10
    v_lshlrev_b16 v13, 3, v43
    v_mad_i32_i24 v11, v14, s55, v39
    v_bitop3_b32 v12, v6, v13, v12 bitop3:0xca
    v_add_lshl_u32 v11, v11, s40, 17
    v_lshlrev_b16 v14, 8, v14
    v_lshrrev_b32 v13, 2, v43
    v_or_b32 v39, v12, v11
    v_bitop3_b32 v43, v5, v13, v14 bitop3:0xea
    ds_add_u32 v43, v2
    v_cvt_pk_bf16_f32 v127, v9, v10
    v_perm_b32 v12, v127, v127, s41
    v_bitop3_b32 v38, v4, v12, v38 bitop3:0xca
    v_perm_b32 v13, v127, v127, s42
    v_bitop3_b32 v39, v4, v13, v39 bitop3:0xca
    s_add_u32 s45, s35, 0x7ecc000
    buffer_store_dwordx4 v[92:95], v0, s[20:23], s45 offen sc1
    buffer_load_dwordx4 v[88:91], v0, s[80:83], 0 offen
    v_add_u32 v15, 0x4000, v0
    buffer_load_dwordx4 v[88:91], v15, s[80:83], 0 offen
    s_waitcnt vmcnt(14)
    v_lshlrev_b32 v7, 16, v24
    v_and_b32 v8, 0xffff0000, v24
    v_lshlrev_b32 v9, 16, v25
    v_and_b32 v10, 0xffff0000, v25
    v_mul_f32 v7, 0.15915494, v7
    v_mul_f32 v8, 0.15915494, v8
    v_mul_f32 v9, 0.15915494, v9
    v_mul_f32 v10, 0.15915494, v10
    v_mul_hi_u32_u24 v14, 429497, v48
    v_lshrrev_b32 v12, 3, v52
    v_cos_f32 v7, v7
    v_lshlrev_b16 v13, 3, v52
    v_mad_i32_i24 v11, v14, s55, v48
    v_bitop3_b32 v12, v6, v13, v12 bitop3:0xca
    v_add_lshl_u32 v11, v11, s40, 17
    v_lshlrev_b16 v14, 8, v14
    v_lshrrev_b32 v13, 2, v52
    v_or_b32 v48, v12, v11
    v_bitop3_b32 v52, v5, v13, v14 bitop3:0xea
    ds_add_u32 v52, v2
    v_mul_hi_u32_u24 v14, 429497, v49
    v_lshrrev_b32 v12, 3, v53
    v_cos_f32 v8, v8
    v_lshlrev_b16 v13, 3, v53
    v_mad_i32_i24 v11, v14, s55, v49
    v_bitop3_b32 v12, v6, v13, v12 bitop3:0xca
    v_add_lshl_u32 v11, v11, s40, 17
    v_lshlrev_b16 v14, 8, v14
    v_lshrrev_b32 v13, 2, v53
    v_or_b32 v49, v12, v11
    v_bitop3_b32 v53, v5, v13, v14 bitop3:0xea
    ds_add_u32 v53, v2
    v_cvt_pk_bf16_f32 v24, v7, v8
    v_perm_b32 v12, v24, v24, s41
    v_bitop3_b32 v48, v4, v12, v48 bitop3:0xca
    v_perm_b32 v13, v24, v24, s42
    v_bitop3_b32 v49, v4, v13, v49 bitop3:0xca
    v_mul_hi_u32_u24 v14, 429497, v50
    v_lshrrev_b32 v12, 3, v54
    v_cos_f32 v9, v9
    v_lshlrev_b16 v13, 3, v54
    v_mad_i32_i24 v11, v14, s55, v50
    v_bitop3_b32 v12, v6, v13, v12 bitop3:0xca
    v_add_lshl_u32 v11, v11, s40, 17
    v_lshlrev_b16 v14, 8, v14
    v_lshrrev_b32 v13, 2, v54
    v_or_b32 v50, v12, v11
    v_bitop3_b32 v54, v5, v13, v14 bitop3:0xea
    ds_add_u32 v54, v2
    v_mul_hi_u32_u24 v14, 429497, v51
    v_lshrrev_b32 v12, 3, v55
    v_cos_f32 v10, v10
    v_lshlrev_b16 v13, 3, v55
    v_mad_i32_i24 v11, v14, s55, v51
    v_bitop3_b32 v12, v6, v13, v12 bitop3:0xca
    v_add_lshl_u32 v11, v11, s40, 17
    v_lshlrev_b16 v14, 8, v14
    v_lshrrev_b32 v13, 2, v55
    v_or_b32 v51, v12, v11
    v_bitop3_b32 v55, v5, v13, v14 bitop3:0xea
    ds_add_u32 v55, v2
    v_cvt_pk_bf16_f32 v25, v9, v10
    v_perm_b32 v12, v25, v25, s41
    v_bitop3_b32 v50, v4, v12, v50 bitop3:0xca
    v_perm_b32 v13, v25, v25, s42
    v_bitop3_b32 v51, v4, v13, v51 bitop3:0xca
    s_waitcnt vmcnt(12)
    s_cmp_le_u32 s43, 5
    s_cbranch_scc1 L1_s1
    v_lshlrev_b32 v7, 16, v26
    v_and_b32 v8, 0xffff0000, v26
    v_lshlrev_b32 v9, 16, v27
    v_and_b32 v10, 0xffff0000, v27
    v_mul_f32 v7, 0.15915494, v7
    v_mul_f32 v8, 0.15915494, v8
    v_mul_f32 v9, 0.15915494, v9
    v_mul_f32 v10, 0.15915494, v10
    v_mul_hi_u32_u24 v14, 429497, v56
    v_lshrrev_b32 v12, 3, v60
    v_cos_f32 v7, v7
    v_lshlrev_b16 v13, 3, v60
    v_mad_i32_i24 v11, v14, s55, v56
    v_bitop3_b32 v12, v6, v13, v12 bitop3:0xca
    v_add_lshl_u32 v11, v11, s40, 17
    v_lshlrev_b16 v14, 8, v14
    v_lshrrev_b32 v13, 2, v60
    v_or_b32 v56, v12, v11
    v_bitop3_b32 v60, v5, v13, v14 bitop3:0xea
    ds_add_u32 v60, v2
    v_mul_hi_u32_u24 v14, 429497, v57
    v_lshrrev_b32 v12, 3, v61
    v_cos_f32 v8, v8
    v_lshlrev_b16 v13, 3, v61
    v_mad_i32_i24 v11, v14, s55, v57
    v_bitop3_b32 v12, v6, v13, v12 bitop3:0xca
    v_add_lshl_u32 v11, v11, s40, 17
    v_lshlrev_b16 v14, 8, v14
    v_lshrrev_b32 v13, 2, v61
    v_or_b32 v57, v12, v11
    v_bitop3_b32 v61, v5, v13, v14 bitop3:0xea
    ds_add_u32 v61, v2
    v_cvt_pk_bf16_f32 v26, v7, v8
    v_perm_b32 v12, v26, v26, s41
    v_bitop3_b32 v56, v4, v12, v56 bitop3:0xca
    v_perm_b32 v13, v26, v26, s42
    v_bitop3_b32 v57, v4, v13, v57 bitop3:0xca
    v_mul_hi_u32_u24 v14, 429497, v58
    v_lshrrev_b32 v12, 3, v62
    v_cos_f32 v9, v9
    v_lshlrev_b16 v13, 3, v62
    v_mad_i32_i24 v11, v14, s55, v58
    v_bitop3_b32 v12, v6, v13, v12 bitop3:0xca
    v_add_lshl_u32 v11, v11, s40, 17
    v_lshlrev_b16 v14, 8, v14
    v_lshrrev_b32 v13, 2, v62
    v_or_b32 v58, v12, v11
    v_bitop3_b32 v62, v5, v13, v14 bitop3:0xea
    ds_add_u32 v62, v2
    v_mul_hi_u32_u24 v14, 429497, v59
    v_lshrrev_b32 v12, 3, v63
    v_cos_f32 v10, v10
    v_lshlrev_b16 v13, 3, v63
    v_mad_i32_i24 v11, v14, s55, v59
    v_bitop3_b32 v12, v6, v13, v12 bitop3:0xca
    v_add_lshl_u32 v11, v11, s40, 17
    v_lshlrev_b16 v14, 8, v14
    v_lshrrev_b32 v13, 2, v63
    v_or_b32 v59, v12, v11
    v_bitop3_b32 v63, v5, v13, v14 bitop3:0xea
    ds_add_u32 v63, v2
    v_cvt_pk_bf16_f32 v27, v9, v10
    v_perm_b32 v12, v27, v27, s41
    v_bitop3_b32 v58, v4, v12, v58 bitop3:0xca
    v_perm_b32 v13, v27, v27, s42
    v_bitop3_b32 v59, v4, v13, v59 bitop3:0xca
L1_s1:
    s_waitcnt vmcnt(8)
    s_cmp_le_u32 s43, 6
    s_cbranch_scc1 L1_s2
    v_lshlrev_b32 v7, 16, v44
    v_and_b32 v8, 0xffff0000, v44
    v_lshlrev_b32 v9, 16, v45
    v_and_b32 v10, 0xffff0000, v45
    v_mul_f32 v7, 0.15915494, v7
    v_mul_f32 v8, 0.15915494, v8
    v_mul_f32 v9, 0.15915494, v9
    v_mul_f32 v10, 0.15915494, v10
    v_mul_hi_u32_u24 v14, 429497, v68
    v_lshrrev_b32 v12, 3, v72
    v_cos_f32 v7, v7
    v_lshlrev_b16 v13, 3, v72
    v_mad_i32_i24 v11, v14, s55, v68
    v_bitop3_b32 v12, v6, v13, v12 bitop3:0xca
    v_add_lshl_u32 v11, v11, s40, 17
    v_lshlrev_b16 v14, 8, v14
    v_lshrrev_b32 v13, 2, v72
    v_or_b32 v68, v12, v11
    v_bitop3_b32 v72, v5, v13, v14 bitop3:0xea
    ds_add_u32 v72, v2
    v_mul_hi_u32_u24 v14, 429497, v69
    v_lshrrev_b32 v12, 3, v73
    v_cos_f32 v8, v8
    v_lshlrev_b16 v13, 3, v73
    v_mad_i32_i24 v11, v14, s55, v69
    v_bitop3_b32 v12, v6, v13, v12 bitop3:0xca
    v_add_lshl_u32 v11, v11, s40, 17
    v_lshlrev_b16 v14, 8, v14
    v_lshrrev_b32 v13, 2, v73
    v_or_b32 v69, v12, v11
    v_bitop3_b32 v73, v5, v13, v14 bitop3:0xea
    ds_add_u32 v73, v2
    v_cvt_pk_bf16_f32 v44, v7, v8
    v_perm_b32 v12, v44, v44, s41
    v_bitop3_b32 v68, v4, v12, v68 bitop3:0xca
    v_perm_b32 v13, v44, v44, s42
    v_bitop3_b32 v69, v4, v13, v69 bitop3:0xca
    v_mul_hi_u32_u24 v14, 429497, v70
    v_lshrrev_b32 v12, 3, v74
    v_cos_f32 v9, v9
    v_lshlrev_b16 v13, 3, v74
    v_mad_i32_i24 v11, v14, s55, v70
    v_bitop3_b32 v12, v6, v13, v12 bitop3:0xca
    v_add_lshl_u32 v11, v11, s40, 17
    v_lshlrev_b16 v14, 8, v14
    v_lshrrev_b32 v13, 2, v74
    v_or_b32 v70, v12, v11
    v_bitop3_b32 v74, v5, v13, v14 bitop3:0xea
    ds_add_u32 v74, v2
    v_mul_hi_u32_u24 v14, 429497, v71
    v_lshrrev_b32 v12, 3, v75
    v_cos_f32 v10, v10
    v_lshlrev_b16 v13, 3, v75
    v_mad_i32_i24 v11, v14, s55, v71
    v_bitop3_b32 v12, v6, v13, v12 bitop3:0xca
    v_add_lshl_u32 v11, v11, s40, 17
    v_lshlrev_b16 v14, 8, v14
    v_lshrrev_b32 v13, 2, v75
    v_or_b32 v71, v12, v11
    v_bitop3_b32 v75, v5, v13, v14 bitop3:0xea
    ds_add_u32 v75, v2
    v_cvt_pk_bf16_f32 v45, v9, v10
    v_perm_b32 v12, v45, v45, s41
    v_bitop3_b32 v70, v4, v12, v70 bitop3:0xca
    v_perm_b32 v13, v45, v45, s42
    v_bitop3_b32 v71, v4, v13, v71 bitop3:0xca
L1_s2:
    s_waitcnt vmcnt(4)
    s_cmp_le_u32 s43, 7
    s_cbranch_scc1 L1_s3
    v_lshlrev_b32 v7, 16, v46
    v_and_b32 v8, 0xffff0000, v46
    v_lshlrev_b32 v9, 16, v47
    v_and_b32 v10, 0xffff0000, v47
    v_mul_f32 v7, 0.15915494, v7
    v_mul_f32 v8, 0.15915494, v8
    v_mul_f32 v9, 0.15915494, v9
    v_mul_f32 v10, 0.15915494, v10
    v_mul_hi_u32_u24 v14, 429497, v76
    v_lshrrev_b32 v12, 3, v80
    v_cos_f32 v7, v7
    v_lshlrev_b16 v13, 3, v80
    v_mad_i32_i24 v11, v14, s55, v76
    v_bitop3_b32 v12, v6, v13, v12 bitop3:0xca
    v_add_lshl_u32 v11, v11, s40, 17
    v_lshlrev_b16 v14, 8, v14
    v_lshrrev_b32 v13, 2, v80
    v_or_b32 v76, v12, v11
    v_bitop3_b32 v80, v5, v13, v14 bitop3:0xea
    ds_add_u32 v80, v2
    v_mul_hi_u32_u24 v14, 429497, v77
    v_lshrrev_b32 v12, 3, v81
    v_cos_f32 v8, v8
    v_lshlrev_b16 v13, 3, v81
    v_mad_i32_i24 v11, v14, s55, v77
    v_bitop3_b32 v12, v6, v13, v12 bitop3:0xca
    v_add_lshl_u32 v11, v11, s40, 17
    v_lshlrev_b16 v14, 8, v14
    v_lshrrev_b32 v13, 2, v81
    v_or_b32 v77, v12, v11
    v_bitop3_b32 v81, v5, v13, v14 bitop3:0xea
    ds_add_u32 v81, v2
    v_cvt_pk_bf16_f32 v46, v7, v8
    v_perm_b32 v12, v46, v46, s41
    v_bitop3_b32 v76, v4, v12, v76 bitop3:0xca
    v_perm_b32 v13, v46, v46, s42
    v_bitop3_b32 v77, v4, v13, v77 bitop3:0xca
    v_mul_hi_u32_u24 v14, 429497, v78
    v_lshrrev_b32 v12, 3, v82
    v_cos_f32 v9, v9
    v_lshlrev_b16 v13, 3, v82
    v_mad_i32_i24 v11, v14, s55, v78
    v_bitop3_b32 v12, v6, v13, v12 bitop3:0xca
    v_add_lshl_u32 v11, v11, s40, 17
    v_lshlrev_b16 v14, 8, v14
    v_lshrrev_b32 v13, 2, v82
    v_or_b32 v78, v12, v11
    v_bitop3_b32 v82, v5, v13, v14 bitop3:0xea
    ds_add_u32 v82, v2
    v_mul_hi_u32_u24 v14, 429497, v79
    v_lshrrev_b32 v12, 3, v83
    v_cos_f32 v10, v10
    v_lshlrev_b16 v13, 3, v83
    v_mad_i32_i24 v11, v14, s55, v79
    v_bitop3_b32 v12, v6, v13, v12 bitop3:0xca
    v_add_lshl_u32 v11, v11, s40, 17
    v_lshlrev_b16 v14, 8, v14
    v_lshrrev_b32 v13, 2, v83
    v_or_b32 v79, v12, v11
    v_bitop3_b32 v83, v5, v13, v14 bitop3:0xea
    ds_add_u32 v83, v2
    v_cvt_pk_bf16_f32 v47, v9, v10
    v_perm_b32 v12, v47, v47, s41
    v_bitop3_b32 v78, v4, v12, v78 bitop3:0xca
    v_perm_b32 v13, v47, v47, s42
    v_bitop3_b32 v79, v4, v13, v79 bitop3:0xca
L1_s3:
    v_lshrrev_b32 v8, 2, v0
    v_and_b32 v7, 0x3c00, v0
    v_bitop3_b32 v7, v5, v8, v7 bitop3:0xea
    s_waitcnt lgkmcnt(0)
    s_barrier
    ds_read2st64_b32 v[8:9], v7 offset0:0 offset1:1
    ds_read2st64_b32 v[10:11], v7 offset0:2 offset1:3
    s_add_u32 s46, s35, 0x7ed0000
    buffer_store_dwordx4 v[64:67], v0, s[20:23], s46 offen sc1
    s_waitcnt lgkmcnt(0)
    v_lshl_or_b32 v12, v9, 16, v8
    v_lshl_or_b32 v13, v11, 16, v10
    v_mov_b32 v14, v12
    v_mov_b32 v15, v13
    s_nop 0
    v_add_u32_dpp v14, v14, v14 row_shr:1 row_mask:0xf bank_mask:0xf bound_ctrl:1
    v_add_u32_dpp v15, v15, v15 row_shr:1 row_mask:0xf bank_mask:0xf bound_ctrl:1
    s_nop 0
    v_add_u32_dpp v14, v14, v14 row_shr:2 row_mask:0xf bank_mask:0xf bound_ctrl:1
    v_add_u32_dpp v15, v15, v15 row_shr:2 row_mask:0xf bank_mask:0xf bound_ctrl:1
    s_nop 0
    v_add_u32_dpp v14, v14, v14 row_shr:4 row_mask:0xf bank_mask:0xf bound_ctrl:1
    v_add_u32_dpp v15, v15, v15 row_shr:4 row_mask:0xf bank_mask:0xf bound_ctrl:1
    s_nop 0
    v_add_u32_dpp v14, v14, v14 row_shr:8 row_mask:0xf bank_mask:0xf bound_ctrl:1
    v_add_u32_dpp v15, v15, v15 row_shr:8 row_mask:0xf bank_mask:0xf bound_ctrl:1
    s_nop 0
    v_add_u32_dpp v14, v14, v14 row_bcast:15 row_mask:0xa bank_mask:0xf
    v_add_u32_dpp v15, v15, v15 row_bcast:15 row_mask:0xa bank_mask:0xf
    s_nop 0
    v_add_u32_dpp v14, v14, v14 row_bcast:31 row_mask:0xc bank_mask:0xf
    v_add_u32_dpp v15, v15, v15 row_bcast:31 row_mask:0xc bank_mask:0xf
    v_readlane_b32 s48, v14, 63
    v_readlane_b32 s49, v15, 63
    s_lshl_b32 s54, s32, 2
    v_mov_b32 v8, s54
    s_and_b32 s50, s48, 0xffff
    s_lshr_b32 s51, s48, 16
    s_and_b32 s52, s49, 0xffff
    s_lshr_b32 s53, s49, 16
    s_add_u32 s51, s51, s50
    s_add_u32 s52, s52, s51
    s_add_u32 s53, s53, s52
    v_mov_b32 v9, s53
    s_mov_b64 exec, 1
    ds_write_b32 v8, v9 offset:16384
    s_mov_b64 exec, -1
    v_and_b32 v8, 60, v7
    s_waitcnt lgkmcnt(0)
    s_barrier
    ds_read_b32 v9, v8 offset:16384
    s_waitcnt lgkmcnt(0)
    v_add_u32_dpp v9, v9, v9 row_shr:1 row_mask:0xf bank_mask:0xf bound_ctrl:1
    s_nop 1
    v_add_u32_dpp v9, v9, v9 row_shr:2 row_mask:0xf bank_mask:0xf bound_ctrl:1
    s_nop 1
    v_add_u32_dpp v9, v9, v9 row_shr:4 row_mask:0xf bank_mask:0xf bound_ctrl:1
    s_nop 1
    v_add_u32_dpp v9, v9, v9 row_shr:8 row_mask:0xf bank_mask:0xf bound_ctrl:1
    s_nop 0
    v_readlane_b32 s54, v9, s32
    s_sub_u32 s54, s54, s53
    s_add_u32 s50, s50, s54
    s_add_u32 s51, s51, s54
    s_add_u32 s52, s52, s54
    s_pack_ll_b32_b16 s48, s54, s50
    s_pack_ll_b32_b16 s49, s51, s52
    v_add_u32 v14, s48, v14
    v_add_u32 v15, s49, v15
    v_sub_u32 v12, v14, v12
    v_sub_u32 v13, v15, v13
    v_and_b32 v8, 0xffff, v12
    v_lshrrev_b32 v9, 16, v12
    v_and_b32 v10, 0xffff, v13
    v_lshrrev_b32 v11, 16, v13
    ds_write2st64_b32 v7, v8, v9 offset0:0 offset1:1
    ds_write2st64_b32 v7, v10, v11 offset0:2 offset1:3
    s_waitcnt lgkmcnt(0)
    s_barrier
    ds_add_rtn_u32 v120, v120, v2
    ds_add_rtn_u32 v121, v121, v2
    ds_add_rtn_u32 v122, v122, v2
    ds_add_rtn_u32 v123, v123, v2
    s_add_u32 s47, s36, 0xa900000
    v_and_b32 v11, 0x3f0, v0
    v_add_u32 v11, v11, v11
    buffer_store_dwordx2 v[12:13], v11, s[24:27], s47 offen
    s_bitset0_b64 exec, 63
    s_not_b64 exec, exec
    buffer_store_dwordx2 v[14:15], v11, s[24:27], s47 offen offset:32
    s_mov_b64 exec, -1
    ds_add_rtn_u32 v20, v20, v2
    ds_add_rtn_u32 v21, v21, v2
    ds_add_rtn_u32 v22, v22, v2
    ds_add_rtn_u32 v23, v23, v2
    ds_add_rtn_u32 v32, v32, v2
    ds_add_rtn_u32 v33, v33, v2
    ds_add_rtn_u32 v34, v34, v2
    ds_add_rtn_u32 v35, v35, v2
    s_add_u32 s44, s35, 0x7ed4000
    buffer_store_dwordx4 v[96:99], v0, s[20:23], s44 offen sc1
    ds_add_rtn_u32 v40, v40, v2
    ds_add_rtn_u32 v41, v41, v2
    ds_add_rtn_u32 v42, v42, v2
    ds_add_rtn_u32 v43, v43, v2
    ds_add_rtn_u32 v52, v52, v2
    ds_add_rtn_u32 v53, v53, v2
    ds_add_rtn_u32 v54, v54, v2
    ds_add_rtn_u32 v55, v55, v2
    s_cmp_le_u32 s43, 5
    s_cbranch_scc1 L1_s4
    ds_add_rtn_u32 v60, v60, v2
    ds_add_rtn_u32 v61, v61, v2
    ds_add_rtn_u32 v62, v62, v2
    ds_add_rtn_u32 v63, v63, v2
L1_s4:
    s_add_u32 s45, s35, 0x7ed8000
    buffer_store_dwordx4 v[100:103], v0, s[20:23], s45 offen sc1
    s_cmp_le_u32 s43, 6
    s_cbranch_scc1 L1_s5
    ds_add_rtn_u32 v72, v72, v2
    ds_add_rtn_u32 v73, v73, v2
    ds_add_rtn_u32 v74, v74, v2
    ds_add_rtn_u32 v75, v75, v2
L1_s5:
    s_cmp_le_u32 s43, 7
    s_cbranch_scc1 L1_s6
    ds_add_rtn_u32 v80, v80, v2
    ds_add_rtn_u32 v81, v81, v2
    ds_add_rtn_u32 v82, v82, v2
    ds_add_rtn_u32 v83, v83, v2
L1_s6:
    s_waitcnt lgkmcnt(0)
    s_barrier
    v_and_b32 v7, -4, v120
    v_lshl_add_u32 v8, v120, 2, v7
    ds_write_b32 v8, v116
    v_lshl_add_u32 v7, v7, 2, v120
    ds_write_b8 v7, v104 offset:16
    v_and_b32 v9, -4, v121
    v_lshl_add_u32 v10, v121, 2, v9
    ds_write_b32 v10, v117
    v_lshl_add_u32 v9, v9, 2, v121
    ds_write_b8_d16_hi v9, v104 offset:16
    v_and_b32 v7, -4, v122
    v_lshl_add_u32 v8, v122, 2, v7
    ds_write_b32 v8, v118
    v_lshl_add_u32 v7, v7, 2, v122
    ds_write_b8 v7, v105 offset:16
    v_and_b32 v9, -4, v123
    v_lshl_add_u32 v10, v123, 2, v9
    ds_write_b32 v10, v119
    v_lshl_add_u32 v9, v9, 2, v123
    ds_write_b8_d16_hi v9, v105 offset:16
    s_add_u32 s46, s35, 0x7edc000
    buffer_store_dwordx4 v[108:111], v0, s[20:23], s46 offen sc1
    v_and_b32 v7, -4, v20
    v_lshl_add_u32 v8, v20, 2, v7
    ds_write_b32 v8, v16
    v_lshl_add_u32 v7, v7, 2, v20
    ds_write_b8 v7, v106 offset:16
    v_and_b32 v9, -4, v21
    v_lshl_add_u32 v10, v21, 2, v9
    ds_write_b32 v10, v17
    v_lshl_add_u32 v9, v9, 2, v21
    ds_write_b8_d16_hi v9, v106 offset:16
    v_and_b32 v7, -4, v22
    v_lshl_add_u32 v8, v22, 2, v7
    ds_write_b32 v8, v18
    v_lshl_add_u32 v7, v7, 2, v22
    ds_write_b8 v7, v107 offset:16
    v_and_b32 v9, -4, v23
    v_lshl_add_u32 v10, v23, 2, v9
    ds_write_b32 v10, v19
    v_lshl_add_u32 v9, v9, 2, v23
    ds_write_b8_d16_hi v9, v107 offset:16
    v_and_b32 v7, -4, v32
    v_lshl_add_u32 v8, v32, 2, v7
    ds_write_b32 v8, v28
    v_lshl_add_u32 v7, v7, 2, v32
    ds_write_b8 v7, v124 offset:16
    v_and_b32 v9, -4, v33
    v_lshl_add_u32 v10, v33, 2, v9
    ds_write_b32 v10, v29
    v_lshl_add_u32 v9, v9, 2, v33
    ds_write_b8_d16_hi v9, v124 offset:16
    v_and_b32 v7, -4, v34
    v_lshl_add_u32 v8, v34, 2, v7
    ds_write_b32 v8, v30
    v_lshl_add_u32 v7, v7, 2, v34
    ds_write_b8 v7, v125 offset:16
    v_and_b32 v9, -4, v35
    v_lshl_add_u32 v10, v35, 2, v9
    ds_write_b32 v10, v31
    v_lshl_add_u32 v9, v9, 2, v35
    ds_write_b8_d16_hi v9, v125 offset:16
    s_add_u32 s47, s35, 0x7ee0000
    buffer_store_dwordx4 v[112:115], v0, s[20:23], s47 offen sc1
    v_and_b32 v7, -4, v40
    v_lshl_add_u32 v8, v40, 2, v7
    ds_write_b32 v8, v36
    v_lshl_add_u32 v7, v7, 2, v40
    ds_write_b8 v7, v126 offset:16
    v_and_b32 v9, -4, v41
    v_lshl_add_u32 v10, v41, 2, v9
    ds_write_b32 v10, v37
    v_lshl_add_u32 v9, v9, 2, v41
    ds_write_b8_d16_hi v9, v126 offset:16
    v_and_b32 v7, -4, v42
    v_lshl_add_u32 v8, v42, 2, v7
    ds_write_b32 v8, v38
    v_lshl_add_u32 v7, v7, 2, v42
    ds_write_b8 v7, v127 offset:16
    v_and_b32 v9, -4, v43
    v_lshl_add_u32 v10, v43, 2, v9
    ds_write_b32 v10, v39
    v_lshl_add_u32 v9, v9, 2, v43
    ds_write_b8_d16_hi v9, v127 offset:16
    v_and_b32 v7, -4, v52
    v_lshl_add_u32 v8, v52, 2, v7
    ds_write_b32 v8, v48
    v_lshl_add_u32 v7, v7, 2, v52
    ds_write_b8 v7, v24 offset:16
    v_and_b32 v9, -4, v53
    v_lshl_add_u32 v10, v53, 2, v9
    ds_write_b32 v10, v49
    v_lshl_add_u32 v9, v9, 2, v53
    ds_write_b8_d16_hi v9, v24 offset:16
    v_and_b32 v7, -4, v54
    v_lshl_add_u32 v8, v54, 2, v7
    ds_write_b32 v8, v50
    v_lshl_add_u32 v7, v7, 2, v54
    ds_write_b8 v7, v25 offset:16
    v_and_b32 v9, -4, v55
    v_lshl_add_u32 v10, v55, 2, v9
    ds_write_b32 v10, v51
    v_lshl_add_u32 v9, v9, 2, v55
    ds_write_b8_d16_hi v9, v25 offset:16
    s_add_u32 s44, s35, 0x7ee4000
    buffer_store_dwordx4 v[84:87], v0, s[20:23], s44 offen sc1
    s_cmp_le_u32 s43, 5
    s_cbranch_scc1 L1_s7
    v_and_b32 v7, -4, v60
    v_lshl_add_u32 v8, v60, 2, v7
    ds_write_b32 v8, v56
    v_lshl_add_u32 v7, v7, 2, v60
    ds_write_b8 v7, v26 offset:16
    v_and_b32 v9, -4, v61
    v_lshl_add_u32 v10, v61, 2, v9
    ds_write_b32 v10, v57
    v_lshl_add_u32 v9, v9, 2, v61
    ds_write_b8_d16_hi v9, v26 offset:16
    v_and_b32 v7, -4, v62
    v_lshl_add_u32 v8, v62, 2, v7
    ds_write_b32 v8, v58
    v_lshl_add_u32 v7, v7, 2, v62
    ds_write_b8 v7, v27 offset:16
    v_and_b32 v9, -4, v63
    v_lshl_add_u32 v10, v63, 2, v9
    ds_write_b32 v10, v59
    v_lshl_add_u32 v9, v9, 2, v63
    ds_write_b8_d16_hi v9, v27 offset:16
L1_s7:
    s_cmp_le_u32 s43, 6
    s_cbranch_scc1 L1_s8
    v_and_b32 v7, -4, v72
    v_lshl_add_u32 v8, v72, 2, v7
    ds_write_b32 v8, v68
    v_lshl_add_u32 v7, v7, 2, v72
    ds_write_b8 v7, v44 offset:16
    v_and_b32 v9, -4, v73
    v_lshl_add_u32 v10, v73, 2, v9
    ds_write_b32 v10, v69
    v_lshl_add_u32 v9, v9, 2, v73
    ds_write_b8_d16_hi v9, v44 offset:16
    v_and_b32 v7, -4, v74
    v_lshl_add_u32 v8, v74, 2, v7
    ds_write_b32 v8, v70
    v_lshl_add_u32 v7, v7, 2, v74
    ds_write_b8 v7, v45 offset:16
    v_and_b32 v9, -4, v75
    v_lshl_add_u32 v10, v75, 2, v9
    ds_write_b32 v10, v71
    v_lshl_add_u32 v9, v9, 2, v75
    ds_write_b8_d16_hi v9, v45 offset:16
L1_s8:
    s_cmp_le_u32 s43, 7
    s_cbranch_scc1 L1_s9
    v_and_b32 v7, -4, v80
    v_lshl_add_u32 v8, v80, 2, v7
    ds_write_b32 v8, v76
    v_lshl_add_u32 v7, v7, 2, v80
    ds_write_b8 v7, v46 offset:16
    v_and_b32 v9, -4, v81
    v_lshl_add_u32 v10, v81, 2, v9
    ds_write_b32 v10, v77
    v_lshl_add_u32 v9, v9, 2, v81
    ds_write_b8_d16_hi v9, v46 offset:16
    v_and_b32 v7, -4, v82
    v_lshl_add_u32 v8, v82, 2, v7
    ds_write_b32 v8, v78
    v_lshl_add_u32 v7, v7, 2, v82
    ds_write_b8 v7, v47 offset:16
    v_and_b32 v9, -4, v83
    v_lshl_add_u32 v10, v83, 2, v9
    ds_write_b32 v10, v79
    v_lshl_add_u32 v9, v9, 2, v83
    ds_write_b8_d16_hi v9, v47 offset:16
L1_s9:
    v_add_u32 v7, 0x10000, v0
    v_add_u32 v12, 0x20000, v0
    s_waitcnt lgkmcnt(0)
    s_barrier
    ds_read_b128 v[92:95], v0 offset:0
    ds_read_b128 v[64:67], v0 offset:16384
    ds_read_b128 v[96:99], v0 offset:32768
    ds_read_b128 v[100:103], v0 offset:49152
    ds_read_b128 v[116:119], v7 offset:0
    ds_read_b128 v[120:123], v7 offset:16384
    ds_read_b128 v[108:111], v7 offset:32768
    ds_read_b128 v[16:19], v7 offset:49152
    ds_read_b128 v[20:23], v12 offset:0
    ds_read_b128 v[104:107], v12 offset:16384
    s_waitcnt lgkmcnt(9)
    s_add_u32 s45, s35, 0xa900000
    buffer_store_dwordx4 v[92:95], v0, s[20:23], s45 offen sc1
    s_waitcnt lgkmcnt(8)
    s_add_u32 s46, s35, 0xa904000
    buffer_store_dwordx4 v[64:67], v0, s[20:23], s46 offen sc1
    s_waitcnt lgkmcnt(7)
    s_add_u32 s47, s35, 0xa908000
    buffer_store_dwordx4 v[96:99], v0, s[20:23], s47 offen sc1
    s_waitcnt lgkmcnt(6)
    s_add_u32 s44, s35, 0xa90c000
    buffer_store_dwordx4 v[100:103], v0, s[20:23], s44 offen sc1
    s_waitcnt lgkmcnt(5)
    s_add_u32 s45, s35, 0xa910000
    buffer_store_dwordx4 v[116:119], v0, s[20:23], s45 offen sc1
    s_waitcnt lgkmcnt(4)
    s_add_u32 s46, s35, 0xa914000
    buffer_store_dwordx4 v[120:123], v0, s[20:23], s46 offen sc1
    s_waitcnt lgkmcnt(3)
    s_add_u32 s47, s35, 0xa918000
    buffer_store_dwordx4 v[108:111], v0, s[20:23], s47 offen sc1
    s_cmp_le_u32 s43, 5
    s_cbranch_scc1 L1_fin
    s_waitcnt lgkmcnt(2)
    s_add_u32 s44, s35, 0xa91c000
    buffer_store_dwordx4 v[16:19], v0, s[20:23], s44 offen sc1
    s_cmp_le_u32 s43, 6
    s_cbranch_scc1 L1_fin
    s_waitcnt lgkmcnt(1)
    s_add_u32 s45, s35, 0xa920000
    buffer_store_dwordx4 v[20:23], v0, s[20:23], s45 offen sc1
    s_cmp_le_u32 s43, 7
    s_cbranch_scc1 L1_fin
    s_waitcnt lgkmcnt(0)
    s_add_u32 s46, s35, 0xa924000
    buffer_store_dwordx4 v[104:107], v0, s[20:23], s46 offen sc1
L1_fin:
L1_end:
    s_endpgm
.text
.globl gs_acc_kernel
.p2align 8
.type gs_acc_kernel,@function
gs_acc_kernel:
    s_cmp_ge_u32 s2, 256
    s_cbranch_scc1 L2_end
    s_load_dwordx2 s[30:31], s[0:1], 104
    s_load_dwordx2 s[28:29], s[0:1], 0
    v_lshrrev_b32 v16, 6, v0
    v_and_b32 v17, 63, v0
    v_readfirstlane_b32 s32, v16
    s_bfe_u32 s33, s2, 0x20001
    s_and_b32 s34, s2, 1
    s_lshl_b32 s34, s34, 5
    s_lshr_b32 s4, s2, 3
    s_add_u32 s34, s34, s4
    v_and_b32 v22, 3, v0
    v_mul_u32_u24 v19, 80, v16
    v_add_u32 v18, v17, v19
    v_mul_u32_u24 v2, 173056, v18
    v_lshrrev_b32 v18, 2, v17
    v_add3_u32 v18, v18, v19, 64
    v_mul_u32_u24 v4, 173056, v18
    v_lshl_add_u32 v20, v22, 4, v4
    s_mul_i32 s39, s33, 2080
    s_lshl_b32 s3, s34, 5
    s_add_u32 s39, s39, s3
    s_mul_i32 s40, s33, 1280000
    s_mul_i32 s38, s32, 5120
    s_add_u32 s38, s38, 80000
    v_lshl_add_u32 v3, v17, 4, s38
    s_waitcnt lgkmcnt(0)
    s_add_u32 s12, s30, 0x28000
    s_addc_u32 s13, s31, 0
    s_mov_b32 s14, 0xd318000
    s_mov_b32 s15, 0x20000
    buffer_load_dwordx4 v[48:51], v2, s[12:15], s39 offen offset:0
    buffer_load_dwordx4 v[56:59], v2, s[12:15], s39 offen offset:32
    buffer_load_dwordx4 v[52:55], v2, s[12:15], s39 offen offset:16
    buffer_load_dwordx4 v[60:63], v2, s[12:15], s39 offen offset:48
    buffer_load_dwordx4 v[64:67], v20, s[12:15], s39 offen
    s_mov_b32 s16, s28
    s_mov_b32 s17, s29
    s_mov_b32 s18, 0x4f5880
    s_mov_b32 s19, 0x20000
    s_sub_u32 s16, s16, 80000
    s_subb_u32 s17, s17, 0
    s_add_u32 s24, s30, 0xebab000
    s_addc_u32 s25, s31, 0
    s_mov_b32 s26, 0x100
    s_mov_b32 s27, 0x20000
    v_lshlrev_b32 v21, 6, v22
    buffer_load_dwordx2 v[8:9], v21, s[24:27], 0 offen offset:40
    s_add_u32 s3, s40, 4096
    buffer_load_dwordx4 v[124:127], v3, s[16:19], s3 offen
    buffer_load_dwordx4 v[116:119], v3, s[16:19], s40 offen offset:2048
    buffer_load_dwordx4 v[120:123], v3, s[16:19], s40 offen offset:3072
    buffer_load_dwordx4 v[108:111], v3, s[16:19], s40 offen offset:0
    buffer_load_dwordx4 v[112:115], v3, s[16:19], s40 offen offset:1024
    s_add_u32 s40, s40, 0x4e200
    v_mad_u32_u24 v4, v22, 20, v4
    v_or_b32 v4, 0xf0000000, v4
    v_or_b32 v2, 0xf0000000, v2
    v_lshlrev_b32 v23, 2, v22
    v_sub_u32 v1, 28, v23
    v_and_b32 v18, 3, v0
    v_lshlrev_b32 v18, 4, v18
    v_mov_b32 v10, 0x3f80
    v_mov_b32 v11, 0
    v_lshlrev_b64 v[10:11], v18, v[10:11]
    v_and_b32 v18, 3, v0
    v_lshlrev_b32 v18, 4, v18
    v_mov_b32 v12, 0xbf80
    v_mov_b32 v13, 0
    v_lshlrev_b64 v[12:13], v18, v[12:13]
    v_lshlrev_b32 v24, 4, v0
    v_lshl_add_u32 v0, v17, 2, s38
    v_mov_b32 v45, 0xf0000000
    v_mov_b32 v5, 0x1fff8
    v_mov_b32 v6, 0x07ff0000
    s_mov_b32 s44, 0x4000c0c
    s_mov_b32 s45, 0x4010c0c
    s_mov_b32 s46, 0x4020c0c
    s_mov_b32 s47, 0x4030c0c
    s_mov_b32 s36, 0
    s_mov_b32 s35, 0
    s_mov_b32 s42, 0
    s_mov_b64 s[80:81], 0
    s_mov_b64 s[84:85], 0
    s_mov_b64 s[48:49], 0
    s_mov_b32 s8, s30
    s_mov_b32 s9, s31
    s_mov_b32 s10, 0xd340000
    s_mov_b32 s11, 0x20000
    s_add_u32 s20, s30, 0xd823000
    s_addc_u32 s21, s31, 0
    s_mov_b32 s22, 0x13880
    s_mov_b32 s23, 0x20000
    s_lshl_b32 s3, s33, 6
    s_add_u32 s3, s3, s34
    s_mul_i32 s3, s3, 80000
    s_add_u32 s20, s20, s3
    s_addc_u32 s21, s21, 0
    v_mov_b32 v68, 0
    v_mov_b32 v76, 0
    v_mov_b32 v69, 0
    v_mov_b32 v77, 0
    v_mov_b32 v70, 0
    v_mov_b32 v78, 0
    v_mov_b32 v71, 0
    v_mov_b32 v79, 0
    v_mov_b32 v72, 0
    v_mov_b32 v80, 0
    v_mov_b32 v73, 0
    v_mov_b32 v81, 0
    v_mov_b32 v74, 0
    v_mov_b32 v82, 0
    v_mov_b32 v75, 0
    v_mov_b32 v83, 0
    v_mov_b32 v94, 2.0
    v_mov_b32 v95, 2.0
    ds_write_b128 v24, v[68:71] offset:0
    ds_write_b128 v24, v[68:71] offset:16384
    ds_write_b128 v24, v[68:71] offset:32768
    ds_write_b128 v24, v[68:71] offset:49152
    v_add_u32 v47, 0x10000, v24
    v_cmp_gt_u32 vcc, 80000, v47
    s_mov_b64 exec, vcc
    ds_write_b128 v47, v[68:71]
    s_mov_b64 exec, -1
    s_waitcnt vmcnt(5)
    v_sub_u16 v88, v56, v48
    v_and_b32 v89, 3, v48
    v_add3_u32 v99, v88, v89, 3
    v_and_b32 v99, -4, v99
    v_max_u32 v99, 4, v99
    v_and_b32 v97, 0xfffc, v48
    v_bfm_b32 v96, v88, v89
    v_add_u32_dpp v91, v99, v99 row_shr:1 row_mask:0xf bank_mask:0xf bound_ctrl:1
    v_mad_u32_u24 v97, v97, 5, v2
    v_cmp_lt_u32 vcc, 16, v99
    v_add_u32_dpp v91, v91, v91 row_shr:2 row_mask:0xf bank_mask:0xf bound_ctrl:1
    v_sub_u32 v98, s38, v99
    v_lshrrev_b64 v[48:49], 16, v[48:49]
    v_add_u32_dpp v91, v91, v91 row_shr:4 row_mask:0xf bank_mask:0xf bound_ctrl:1
    v_lshrrev_b64 v[56:57], 16, v[56:57]
    s_mov_b32 s43, 0
    v_add_u32_dpp v91, v91, v91 row_shr:8 row_mask:0xf bank_mask:0xf bound_ctrl:1
    s_nop 1
    v_add_u32_dpp v91, v91, v91 row_bcast:15 row_mask:0xa bank_mask:0xf
    s_nop 1
    v_add_u32_dpp v91, v91, v91 row_bcast:31 row_mask:0xc bank_mask:0xf
    v_add_u32 v98, v98, v91
    v_readlane_b32 s37, v91, 63
    s_cbranch_vccnz L2_xo1
L2_xp1:
    v_mov_b32 v44, v43
    s_cmp_gt_u32 s37, 1024
    s_cbranch_scc1 L2_xs2
    s_cmp_lg_u32 s43, 0
    s_cbranch_scc1 L2_xa2
L2_xb2:
    v_lshlrev_b32 v89, 16, v96
    v_add_u32 v90, 60, v97
    v_bitop3_b32 v90, v89, v45, v90 bitop3:0x6a
    ds_write_b32 v98, v90 offset:12
    v_lshlrev_b32 v89, 20, v96
    v_add_u32 v90, 40, v97
    v_bitop3_b32 v90, v89, v45, v90 bitop3:0x6a
    ds_write_b32 v98, v90 offset:8
    v_lshlrev_b32 v89, 24, v96
    v_add_u32 v90, 20, v97
    v_bitop3_b32 v90, v89, v45, v90 bitop3:0x6a
    ds_write_b32 v98, v90 offset:4
    v_lshlrev_b32 v89, 28, v96
    v_bitop3_b32 v90, v89, v45, v97 bitop3:0x6a
    ds_write_b32 v98, v90 offset:0
    v_mov_b32_dpp v91, v64 quad_perm:[0,0,0,0] row_mask:0xf bank_mask:0xf
    v_and_b32 v89, 3, v91
    v_and_b32 v97, 0xfffc, v91
    v_sub_u16_dpp v88, v64, v91 quad_perm:[2,2,2,2] row_mask:0xf bank_mask:0xf
    v_mad_u32_u24 v97, v97, 5, v4
    v_add_u32 v99, v88, v89
    v_bfm_b32 v96, v88, v89
    v_cmp_lt_u32 s[58:59], 16, v99
    v_lshlrev_b32 v89, v1, v96
    v_and_b32 v89, v45, v89
    v_cmp_ne_u32 vcc, 0, v89
    v_xor_b32 v90, v97, v89
    s_add_u32 s3, s37, s38
    v_mbcnt_lo_u32_b32 v98, vcc_lo, 0
    v_mbcnt_hi_u32_b32 v98, vcc_hi, v98
    s_bcnt1_i32_b64 s41, vcc
    v_lshl_add_u32 v98, v98, 2, s3
    s_mov_b64 exec, vcc
    ds_write_b32 v98, v90
    s_mov_b64 exec, -1
    s_lshl2_add_u32 s37, s41, s37
    s_cmp_lg_u64 s[58:59], 0
    s_cbranch_scc1 L2_xe2
L2_xr2:
    v_add_u32 v98, s37, v0
    v_mov_b32 v90, -1
    ds_write_b32 v98, v90
    ds_read2st64_b32 v[40:41], v0 offset0:0 offset1:1
    ds_read2st64_b32 v[42:43], v0 offset0:2 offset1:3
    s_sub_u32 s3, s37, 768
    s_cmp_gt_u32 s3, 256
    s_cbranch_scc1 L2_xf2
L2_xg2:
    v_sub_u16 v88, v58, v50
    v_and_b32 v89, 3, v50
    v_add3_u32 v99, v88, v89, 3
    v_and_b32 v99, -4, v99
    v_max_u32 v99, 4, v99
    v_and_b32 v97, 0xfffc, v50
    v_bfm_b32 v96, v88, v89
    v_add_u32_dpp v91, v99, v99 row_shr:1 row_mask:0xf bank_mask:0xf bound_ctrl:1
    v_mad_u32_u24 v97, v97, 5, v2
    v_cmp_lt_u32 vcc, 16, v99
    v_add_u32_dpp v91, v91, v91 row_shr:2 row_mask:0xf bank_mask:0xf bound_ctrl:1
    v_sub_u32 v98, s38, v99
    v_lshrrev_b64 v[50:51], 16, v[50:51]
    v_add_u32_dpp v91, v91, v91 row_shr:4 row_mask:0xf bank_mask:0xf bound_ctrl:1
    v_lshrrev_b64 v[58:59], 16, v[58:59]
    s_mov_b32 s43, 0
    v_add_u32_dpp v91, v91, v91 row_shr:8 row_mask:0xf bank_mask:0xf bound_ctrl:1
    s_nop 1
    v_add_u32_dpp v91, v91, v91 row_bcast:15 row_mask:0xa bank_mask:0xf
    s_nop 1
    v_add_u32_dpp v91, v91, v91 row_bcast:31 row_mask:0xc bank_mask:0xf
    v_add_u32 v98, v98, v91
    v_readlane_b32 s37, v91, 63
    s_cbranch_vccnz L2_xo3
L2_xp3:
    s_waitcnt lgkmcnt(0)
    v_and_b32 v47, 0x0fffffff, v40
    v_mov_b32 v21, v40
    buffer_load_dwordx4 v[16:19], v47, s[8:11], 0 offen
    buffer_load_dwordx3 v[18:20], v47, s[8:11], 0 offen offset:8
    s_waitcnt vmcnt(6)
    ds_write_b128 v3, v[124:127] offset:4096
    v_and_b32 v47, 0x0fffffff, v41
    v_mov_b32 v27, v41
    buffer_load_dwordx4 v[22:25], v47, s[8:11], 0 offen
    buffer_load_dwordx3 v[24:26], v47, s[8:11], 0 offen offset:8
    s_waitcnt vmcnt(7)
    ds_write_b128 v3, v[116:119] offset:2048
    v_and_b32 v47, 0x0fffffff, v42
    v_mov_b32 v33, v42
    buffer_load_dwordx4 v[28:31], v47, s[8:11], 0 offen
    buffer_load_dwordx3 v[30:32], v47, s[8:11], 0 offen offset:8
    s_waitcnt vmcnt(8)
    ds_write_b128 v3, v[120:123] offset:3072
    v_mov_b32 v44, v43
    s_cmp_gt_u32 s37, 1024
    s_cbranch_scc1 L2_xs4
    s_cmp_lg_u32 s43, 0
    s_cbranch_scc1 L2_xa4
L2_xb4:
    v_lshlrev_b32 v89, 16, v96
    v_add_u32 v90, 60, v97
    v_bitop3_b32 v90, v89, v45, v90 bitop3:0x6a
    ds_write_b32 v98, v90 offset:12
    v_lshlrev_b32 v89, 20, v96
    v_add_u32 v90, 40, v97
    v_bitop3_b32 v90, v89, v45, v90 bitop3:0x6a
    ds_write_b32 v98, v90 offset:8
    v_lshlrev_b32 v89, 24, v96
    v_add_u32 v90, 20, v97
    v_bitop3_b32 v90, v89, v45, v90 bitop3:0x6a
    ds_write_b32 v98, v90 offset:4
    v_lshlrev_b32 v89, 28, v96
    v_bitop3_b32 v90, v89, v45, v97 bitop3:0x6a
    ds_write_b32 v98, v90 offset:0
    v_mov_b32_dpp v91, v66 quad_perm:[0,0,0,0] row_mask:0xf bank_mask:0xf
    v_and_b32 v89, 3, v91
    v_and_b32 v97, 0xfffc, v91
    v_sub_u16_dpp v88, v66, v91 quad_perm:[2,2,2,2] row_mask:0xf bank_mask:0xf
    v_mad_u32_u24 v97, v97, 5, v4
    v_add_u32 v99, v88, v89
    v_bfm_b32 v96, v88, v89
    v_cmp_lt_u32 s[58:59], 16, v99
    v_lshlrev_b32 v89, v1, v96
    v_and_b32 v89, v45, v89
    v_cmp_ne_u32 vcc, 0, v89
    v_xor_b32 v90, v97, v89
    s_add_u32 s3, s37, s38
    v_mbcnt_lo_u32_b32 v98, vcc_lo, 0
    v_mbcnt_hi_u32_b32 v98, vcc_hi, v98
    s_bcnt1_i32_b64 s41, vcc
    v_lshl_add_u32 v98, v98, 2, s3
    s_mov_b64 exec, vcc
    ds_write_b32 v98, v90
    s_mov_b64 exec, -1
    s_lshl2_add_u32 s37, s41, s37
    s_cmp_lg_u64 s[58:59], 0
    s_cbranch_scc1 L2_xe4
L2_xr4:
    v_add_u32 v98, s37, v0
    v_mov_b32 v90, -1
    ds_write_b32 v98, v90
    ds_read2st64_b32 v[40:41], v0 offset0:0 offset1:1
    ds_read2st64_b32 v[42:43], v0 offset0:2 offset1:3
    s_sub_u32 s3, s37, 768
    s_cmp_gt_u32 s3, 256
    s_cbranch_scc1 L2_xf4
L2_xg4:
    s_waitcnt vmcnt(7)
    ds_write_b128 v3, v[108:111] offset:0
    s_waitcnt vmcnt(6)
    ds_write_b128 v3, v[112:115] offset:1024
    buffer_load_dwordx4 v[116:119], v3, s[16:19], s40 offen offset:2048
    buffer_load_dwordx4 v[120:123], v3, s[16:19], s40 offen offset:3072
    s_add_u32 s3, s40, 4096
    buffer_load_dwordx4 v[124:127], v3, s[16:19], s3 offen
    s_waitcnt lgkmcnt(0)
L2_loop:
    s_barrier
    s_bitcmp1_b32 s36, s42
    s_cbranch_scc1 L2_slow
L2_ret0:
    s_setprio 3
    v_and_b32 v47, 0x0fffffff, v44
    v_mov_b32 v39, v44
    buffer_load_dwordx4 v[34:37], v47, s[8:11], 0 offen
    buffer_load_dwordx3 v[36:38], v47, s[8:11], 0 offen offset:8
    s_waitcnt lgkmcnt(0)
    v_cmpx_ne_u64 vcc, v[74:75], v[70:71]
    s_and_b64 s[82:83], vcc, s[80:81]
    s_cbranch_scc1 L2_c5
L2_d5:
    v_mov_b64 v[84:85], v[70:71]
    v_mov_b32 v7, v93
    v_mov_b64 v[86:87], v[74:75]
    s_mov_b64 exec, -1
    s_or_b64 s[80:81], s[80:81], vcc
    v_cmpx_ne_u64 vcc, v[72:73], v[68:69]
    s_and_b64 s[82:83], vcc, s[80:81]
    s_cbranch_scc1 L2_c6
L2_d6:
    v_mov_b64 v[84:85], v[68:69]
    v_mov_b32 v7, v92
    v_mov_b64 v[86:87], v[72:73]
    s_mov_b64 exec, -1
    s_or_b64 s[80:81], s[80:81], vcc
    ds_read_b64 v[70:71], v95
    ds_read_b64 v[68:69], v94
    s_waitcnt vmcnt(9)
    v_and_b32 v46, 0x20000000, v21
    v_lshrrev_b32 v47, 14, v17
    v_bitop3_b32 v47, v47, v5, v46 bitop3:0xea
    ds_read_b64 v[102:103], v47 offset:63616
    v_bitop3_b32 v93, v17, v5, v46 bitop3:0xea
    v_and_b32 v46, 0x10000000, v21
    v_lshrrev_b32 v47, 14, v16
    v_bitop3_b32 v47, v47, v5, v46 bitop3:0xea
    ds_read_b64 v[100:101], v47 offset:63616
    v_bitop3_b32 v92, v16, v5, v46 bitop3:0xea
    s_waitcnt lgkmcnt(2)
    v_mfma_f32_4x4x4_16b_bf16 v[80:83], v[10:11], v[70:71], v[80:83]
    v_mfma_f32_4x4x4_16b_bf16 v[76:79], v[10:11], v[68:69], v[76:79]
    v_perm_b32 v15, v17, v20, s45
    v_bitop3_b32 v46, v17, 0.5, -0.5 bitop3:0xa8
    v_perm_b32 v14, v16, v20, s44
    v_bitop3_b32 v47, v16, 0.5, -0.5 bitop3:0xa8
    v_cvt_pk_bf16_f32 v80, v80, v81
    v_cvt_pk_bf16_f32 v81, v82, v83
    ds_wrxchg_rtn_b64 v[74:75], v95, v[80:81]
    v_cvt_pk_bf16_f32 v76, v76, v77
    v_cvt_pk_bf16_f32 v77, v78, v79
    ds_wrxchg_rtn_b64 v[72:73], v94, v[76:77]
    s_waitcnt lgkmcnt(2)
    v_mfma_f32_4x4x4_16b_bf16 v[80:83], v[8:9], v[102:103], 0
    v_mfma_f32_4x4x4_16b_bf16 v[76:79], v[8:9], v[100:101], 0
    v_bitop3_b32 v15, v6, v15, v46 bitop3:0xca
    v_bitop3_b32 v14, v6, v14, v47 bitop3:0xca
    v_cmp_lt_u32 s[84:85], v5, v92
    s_nop 0
    v_pk_mul_f32 v[80:81], v[80:81], v[14:15] op_sel:[0,1] op_sel_hi:[1,1]
    v_pk_mul_f32 v[82:83], v[82:83], v[14:15] op_sel:[0,1] op_sel_hi:[1,1]
    v_pk_mul_f32 v[76:77], v[76:77], v[14:15] op_sel:[0,0] op_sel_hi:[1,0]
    v_pk_mul_f32 v[78:79], v[78:79], v[14:15] op_sel:[0,0] op_sel_hi:[1,0]
    buffer_load_dwordx4 v[108:111], v3, s[16:19], s40 offen offset:0
    s_waitcnt lgkmcnt(0)
    v_cmpx_ne_u64 vcc, v[74:75], v[70:71]
    s_and_b64 s[82:83], vcc, s[80:81]
    s_cbranch_scc1 L2_c7
L2_d7:
    v_mov_b64 v[84:85], v[70:71]
    v_mov_b32 v7, v95
    v_mov_b64 v[86:87], v[74:75]
    s_mov_b64 exec, -1
    s_or_b64 s[80:81], s[80:81], vcc
    v_cmpx_ne_u64 vcc, v[72:73], v[68:69]
    s_and_b64 s[82:83], vcc, s[80:81]
    s_cbranch_scc1 L2_c8
L2_d8:
    v_mov_b64 v[84:85], v[68:69]
    v_mov_b32 v7, v94
    v_mov_b64 v[86:87], v[72:73]
    s_mov_b64 exec, -1
    s_or_b64 s[80:81], s[80:81], vcc
    ds_read_b64 v[70:71], v93
    s_and_b64 exec, s[84:85], s[80:81]
    v_mfma_f32_4x4x4_16b_bf16 v[76:79], v[12:13], v[84:85], 0
    v_mov_b32 v92, v7
    s_andn2_b64 s[80:81], s[80:81], s[84:85]
    v_mfma_f32_4x4x4_16b_bf16 v[76:79], v[10:11], v[86:87], v[76:79]
    s_mov_b64 exec, -1
    ds_read_b64 v[68:69], v92
    v_and_b32 v46, 0x80000000, v21
    v_lshrrev_b32 v47, 14, v19
    v_bitop3_b32 v47, v47, v5, v46 bitop3:0xea
    ds_read_b64 v[106:107], v47 offset:63616
    v_bitop3_b32 v95, v19, v5, v46 bitop3:0xea
    v_and_b32 v46, 0x40000000, v21
    v_lshrrev_b32 v47, 14, v18
    v_bitop3_b32 v47, v47, v5, v46 bitop3:0xea
    ds_read_b64 v[104:105], v47 offset:63616
    v_bitop3_b32 v94, v18, v5, v46 bitop3:0xea
    s_waitcnt lgkmcnt(2)
    v_mfma_f32_4x4x4_16b_bf16 v[80:83], v[10:11], v[70:71], v[80:83]
    v_mfma_f32_4x4x4_16b_bf16 v[76:79], v[10:11], v[68:69], v[76:79]
    v_perm_b32 v15, v19, v20, s47
    v_bitop3_b32 v46, v19, 0.5, -0.5 bitop3:0xa8
    v_perm_b32 v14, v18, v20, s46
    v_bitop3_b32 v47, v18, 0.5, -0.5 bitop3:0xa8
    v_cvt_pk_bf16_f32 v80, v80, v81
    v_cvt_pk_bf16_f32 v81, v82, v83
    ds_wrxchg_rtn_b64 v[74:75], v93, v[80:81]
    v_cvt_pk_bf16_f32 v76, v76, v77
    v_cvt_pk_bf16_f32 v77, v78, v79
    ds_wrxchg_rtn_b64 v[72:73], v92, v[76:77]
    s_setprio 2
    s_waitcnt lgkmcnt(2)
    v_mfma_f32_4x4x4_16b_bf16 v[80:83], v[8:9], v[106:107], 0
    v_mfma_f32_4x4x4_16b_bf16 v[76:79], v[8:9], v[104:105], 0
    v_bitop3_b32 v15, v6, v15, v46 bitop3:0xca
    v_bitop3_b32 v14, v6, v14, v47 bitop3:0xca
    s_nop 1
    v_pk_mul_f32 v[80:81], v[80:81], v[14:15] op_sel:[0,1] op_sel_hi:[1,1]
    v_pk_mul_f32 v[82:83], v[82:83], v[14:15] op_sel:[0,1] op_sel_hi:[1,1]
    v_pk_mul_f32 v[76:77], v[76:77], v[14:15] op_sel:[0,0] op_sel_hi:[1,0]
    v_pk_mul_f32 v[78:79], v[78:79], v[14:15] op_sel:[0,0] op_sel_hi:[1,0]
    v_and_b32 v47, 0x0fffffff, v40
    v_mov_b32 v21, v40
    buffer_load_dwordx4 v[16:19], v47, s[8:11], 0 offen
    buffer_load_dwordx3 v[18:20], v47, s[8:11], 0 offen offset:8
    s_waitcnt lgkmcnt(0)
    v_cmpx_ne_u64 vcc, v[74:75], v[70:71]
    s_and_b64 s[82:83], vcc, s[80:81]
    s_cbranch_scc1 L2_c9
L2_d9:
    v_mov_b64 v[84:85], v[70:71]
    v_mov_b32 v7, v93
    v_mov_b64 v[86:87], v[74:75]
    s_mov_b64 exec, -1
    s_or_b64 s[80:81], s[80:81], vcc
    v_cmpx_ne_u64 vcc, v[72:73], v[68:69]
    s_and_b64 s[82:83], vcc, s[80:81]
    s_cbranch_scc1 L2_c10
L2_d10:
    v_mov_b64 v[84:85], v[68:69]
    v_mov_b32 v7, v92
    v_mov_b64 v[86:87], v[72:73]
    s_mov_b64 exec, -1
    s_or_b64 s[80:81], s[80:81], vcc
    ds_read_b64 v[70:71], v95
    ds_read_b64 v[68:69], v94
    s_waitcnt vmcnt(10)
    v_and_b32 v46, 0x20000000, v27
    v_lshrrev_b32 v47, 14, v23
    v_bitop3_b32 v47, v47, v5, v46 bitop3:0xea
    ds_read_b64 v[102:103], v47 offset:63616
    v_bitop3_b32 v93, v23, v5, v46 bitop3:0xea
    v_and_b32 v46, 0x10000000, v27
    v_lshrrev_b32 v47, 14, v22
    v_bitop3_b32 v47, v47, v5, v46 bitop3:0xea
    ds_read_b64 v[100:101], v47 offset:63616
    v_bitop3_b32 v92, v22, v5, v46 bitop3:0xea
    s_waitcnt lgkmcnt(2)
    v_mfma_f32_4x4x4_16b_bf16 v[80:83], v[10:11], v[70:71], v[80:83]
    v_mfma_f32_4x4x4_16b_bf16 v[76:79], v[10:11], v[68:69], v[76:79]
    v_perm_b32 v15, v23, v26, s45
    v_bitop3_b32 v46, v23, 0.5, -0.5 bitop3:0xa8
    v_perm_b32 v14, v22, v26, s44
    v_bitop3_b32 v47, v22, 0.5, -0.5 bitop3:0xa8
    v_cvt_pk_bf16_f32 v80, v80, v81
    v_cvt_pk_bf16_f32 v81, v82, v83
    ds_wrxchg_rtn_b64 v[74:75], v95, v[80:81]
    v_cvt_pk_bf16_f32 v76, v76, v77
    v_cvt_pk_bf16_f32 v77, v78, v79
    ds_wrxchg_rtn_b64 v[72:73], v94, v[76:77]
    s_waitcnt lgkmcnt(2)
    v_mfma_f32_4x4x4_16b_bf16 v[80:83], v[8:9], v[102:103], 0
    v_mfma_f32_4x4x4_16b_bf16 v[76:79], v[8:9], v[100:101], 0
    v_bitop3_b32 v15, v6, v15, v46 bitop3:0xca
    v_bitop3_b32 v14, v6, v14, v47 bitop3:0xca
    v_cmp_lt_u32 s[84:85], v5, v92
    s_nop 0
    v_pk_mul_f32 v[80:81], v[80:81], v[14:15] op_sel:[0,1] op_sel_hi:[1,1]
    v_pk_mul_f32 v[82:83], v[82:83], v[14:15] op_sel:[0,1] op_sel_hi:[1,1]
    v_pk_mul_f32 v[76:77], v[76:77], v[14:15] op_sel:[0,0] op_sel_hi:[1,0]
    v_pk_mul_f32 v[78:79], v[78:79], v[14:15] op_sel:[0,0] op_sel_hi:[1,0]
    v_sub_u16 v88, v60, v52
    v_and_b32 v89, 3, v52
    v_add3_u32 v99, v88, v89, 3
    v_and_b32 v99, -4, v99
    v_max_u32 v99, 4, v99
    v_and_b32 v97, 0xfffc, v52
    v_bfm_b32 v96, v88, v89
    v_add_u32_dpp v91, v99, v99 row_shr:1 row_mask:0xf bank_mask:0xf bound_ctrl:1
    v_mad_u32_u24 v97, v97, 5, v2
    v_cmp_lt_u32 vcc, 16, v99
    v_add_u32_dpp v91, v91, v91 row_shr:2 row_mask:0xf bank_mask:0xf bound_ctrl:1
    v_sub_u32 v98, s38, v99
    v_lshrrev_b64 v[52:53], 16, v[52:53]
    v_add_u32_dpp v91, v91, v91 row_shr:4 row_mask:0xf bank_mask:0xf bound_ctrl:1
    v_lshrrev_b64 v[60:61], 16, v[60:61]
    s_mov_b32 s43, 0
    v_add_u32_dpp v91, v91, v91 row_shr:8 row_mask:0xf bank_mask:0xf bound_ctrl:1
    s_nop 1
    v_add_u32_dpp v91, v91, v91 row_bcast:15 row_mask:0xa bank_mask:0xf
    s_nop 1
    v_add_u32_dpp v91, v91, v91 row_bcast:31 row_mask:0xc bank_mask:0xf
    v_add_u32 v98, v98, v91
    v_readlane_b32 s37, v91, 63
    s_cbranch_vccnz L2_xo11
L2_xp11:
    buffer_load_dwordx4 v[112:115], v3, s[16:19], s40 offen offset:1024
    s_waitcnt lgkmcnt(0)
    v_cmpx_ne_u64 vcc, v[74:75], v[70:71]
    s_and_b64 s[82:83], vcc, s[80:81]
    s_cbranch_scc1 L2_c12
L2_d12:
    v_mov_b64 v[84:85], v[70:71]
    v_mov_b32 v7, v95
    v_mov_b64 v[86:87], v[74:75]
    s_mov_b64 exec, -1
    s_or_b64 s[80:81], s[80:81], vcc
    v_cmpx_ne_u64 vcc, v[72:73], v[68:69]
    s_and_b64 s[82:83], vcc, s[80:81]
    s_cbranch_scc1 L2_c13
L2_d13:
    v_mov_b64 v[84:85], v[68:69]
    v_mov_b32 v7, v94
    v_mov_b64 v[86:87], v[72:73]
    s_mov_b64 exec, -1
    s_or_b64 s[80:81], s[80:81], vcc
    ds_read_b64 v[70:71], v93
    s_and_b64 exec, s[84:85], s[80:81]
    v_mfma_f32_4x4x4_16b_bf16 v[76:79], v[12:13], v[84:85], 0
    v_mov_b32 v92, v7
    s_andn2_b64 s[80:81], s[80:81], s[84:85]
    v_mfma_f32_4x4x4_16b_bf16 v[76:79], v[10:11], v[86:87], v[76:79]
    s_mov_b64 exec, -1
    ds_read_b64 v[68:69], v92
    v_and_b32 v46, 0x80000000, v27
    v_lshrrev_b32 v47, 14, v25
    v_bitop3_b32 v47, v47, v5, v46 bitop3:0xea
    ds_read_b64 v[106:107], v47 offset:63616
    v_bitop3_b32 v95, v25, v5, v46 bitop3:0xea
    v_and_b32 v46, 0x40000000, v27
    v_lshrrev_b32 v47, 14, v24
    v_bitop3_b32 v47, v47, v5, v46 bitop3:0xea
    ds_read_b64 v[104:105], v47 offset:63616
    v_bitop3_b32 v94, v24, v5, v46 bitop3:0xea
    s_waitcnt lgkmcnt(2)
    v_mfma_f32_4x4x4_16b_bf16 v[80:83], v[10:11], v[70:71], v[80:83]
    v_mfma_f32_4x4x4_16b_bf16 v[76:79], v[10:11], v[68:69], v[76:79]
    v_perm_b32 v15, v25, v26, s47
    v_bitop3_b32 v46, v25, 0.5, -0.5 bitop3:0xa8
    v_perm_b32 v14, v24, v26, s46
    v_bitop3_b32 v47, v24, 0.5, -0.5 bitop3:0xa8
    v_cvt_pk_bf16_f32 v80, v80, v81
    v_cvt_pk_bf16_f32 v81, v82, v83
    ds_wrxchg_rtn_b64 v[74:75], v93, v[80:81]
    v_cvt_pk_bf16_f32 v76, v76, v77
    v_cvt_pk_bf16_f32 v77, v78, v79
    ds_wrxchg_rtn_b64 v[72:73], v92, v[76:77]
    s_setprio 1
    s_waitcnt lgkmcnt(2)
    v_mfma_f32_4x4x4_16b_bf16 v[80:83], v[8:9], v[106:107], 0
    v_mfma_f32_4x4x4_16b_bf16 v[76:79], v[8:9], v[104:105], 0
    v_bitop3_b32 v15, v6, v15, v46 bitop3:0xca
    v_bitop3_b32 v14, v6, v14, v47 bitop3:0xca
    s_nop 1
    v_pk_mul_f32 v[80:81], v[80:81], v[14:15] op_sel:[0,1] op_sel_hi:[1,1]
    v_pk_mul_f32 v[82:83], v[82:83], v[14:15] op_sel:[0,1] op_sel_hi:[1,1]
    v_pk_mul_f32 v[76:77], v[76:77], v[14:15] op_sel:[0,0] op_sel_hi:[1,0]
    v_pk_mul_f32 v[78:79], v[78:79], v[14:15] op_sel:[0,0] op_sel_hi:[1,0]
    v_and_b32 v47, 0x0fffffff, v41
    v_mov_b32 v27, v41
    buffer_load_dwordx4 v[22:25], v47, s[8:11], 0 offen
    buffer_load_dwordx3 v[24:26], v47, s[8:11], 0 offen offset:8
    s_waitcnt lgkmcnt(0)
    v_cmpx_ne_u64 vcc, v[74:75], v[70:71]
    s_and_b64 s[82:83], vcc, s[80:81]
    s_cbranch_scc1 L2_c14
L2_d14:
    v_mov_b64 v[84:85], v[70:71]
    v_mov_b32 v7, v93
    v_mov_b64 v[86:87], v[74:75]
    s_mov_b64 exec, -1
    s_or_b64 s[80:81], s[80:81], vcc
    v_cmpx_ne_u64 vcc, v[72:73], v[68:69]
    s_and_b64 s[82:83], vcc, s[80:81]
    s_cbranch_scc1 L2_c15
L2_d15:
    v_mov_b64 v[84:85], v[68:69]
    v_mov_b32 v7, v92
    v_mov_b64 v[86:87], v[72:73]
    s_mov_b64 exec, -1
    s_or_b64 s[80:81], s[80:81], vcc
    ds_read_b64 v[70:71], v95
    ds_read_b64 v[68:69], v94
    s_waitcnt vmcnt(11)
    v_and_b32 v46, 0x20000000, v33
    v_lshrrev_b32 v47, 14, v29
    v_bitop3_b32 v47, v47, v5, v46 bitop3:0xea
    ds_read_b64 v[102:103], v47 offset:63616
    v_bitop3_b32 v93, v29, v5, v46 bitop3:0xea
    v_and_b32 v46, 0x10000000, v33
    v_lshrrev_b32 v47, 14, v28
    v_bitop3_b32 v47, v47, v5, v46 bitop3:0xea
    ds_read_b64 v[100:101], v47 offset:63616
    v_bitop3_b32 v92, v28, v5, v46 bitop3:0xea
    s_waitcnt lgkmcnt(2)
    v_mfma_f32_4x4x4_16b_bf16 v[80:83], v[10:11], v[70:71], v[80:83]
    v_mfma_f32_4x4x4_16b_bf16 v[76:79], v[10:11], v[68:69], v[76:79]
    v_perm_b32 v15, v29, v32, s45
    v_bitop3_b32 v46, v29, 0.5, -0.5 bitop3:0xa8
    v_perm_b32 v14, v28, v32, s44
    v_bitop3_b32 v47, v28, 0.5, -0.5 bitop3:0xa8
    v_cvt_pk_bf16_f32 v80, v80, v81
    v_cvt_pk_bf16_f32 v81, v82, v83
    ds_wrxchg_rtn_b64 v[74:75], v95, v[80:81]
    v_cvt_pk_bf16_f32 v76, v76, v77
    v_cvt_pk_bf16_f32 v77, v78, v79
    ds_wrxchg_rtn_b64 v[72:73], v94, v[76:77]
    s_waitcnt lgkmcnt(2)
    v_mfma_f32_4x4x4_16b_bf16 v[80:83], v[8:9], v[102:103], 0
    v_mfma_f32_4x4x4_16b_bf16 v[76:79], v[8:9], v[100:101], 0
    v_bitop3_b32 v15, v6, v15, v46 bitop3:0xca
    v_bitop3_b32 v14, v6, v14, v47 bitop3:0xca
    v_cmp_lt_u32 s[84:85], v5, v92
    s_nop 0
    v_pk_mul_f32 v[80:81], v[80:81], v[14:15] op_sel:[0,1] op_sel_hi:[1,1]
    v_pk_mul_f32 v[82:83], v[82:83], v[14:15] op_sel:[0,1] op_sel_hi:[1,1]
    v_pk_mul_f32 v[76:77], v[76:77], v[14:15] op_sel:[0,0] op_sel_hi:[1,0]
    v_pk_mul_f32 v[78:79], v[78:79], v[14:15] op_sel:[0,0] op_sel_hi:[1,0]
    s_waitcnt lgkmcnt(0)
    v_cmpx_ne_u64 vcc, v[74:75], v[70:71]
    s_and_b64 s[82:83], vcc, s[80:81]
    s_cbranch_scc1 L2_c16
L2_d16:
    v_mov_b64 v[84:85], v[70:71]
    v_mov_b32 v7, v95
    v_mov_b64 v[86:87], v[74:75]
    s_mov_b64 exec, -1
    s_or_b64 s[80:81], s[80:81], vcc
    v_cmpx_ne_u64 vcc, v[72:73], v[68:69]
    s_and_b64 s[82:83], vcc, s[80:81]
    s_cbranch_scc1 L2_c17
L2_d17:
    v_mov_b64 v[84:85], v[68:69]
    v_mov_b32 v7, v94
    v_mov_b64 v[86:87], v[72:73]
    s_mov_b64 exec, -1
    s_or_b64 s[80:81], s[80:81], vcc
    ds_read_b64 v[70:71], v93
    s_and_b64 exec, s[84:85], s[80:81]
    v_mfma_f32_4x4x4_16b_bf16 v[76:79], v[12:13], v[84:85], 0
    v_mov_b32 v92, v7
    s_andn2_b64 s[80:81], s[80:81], s[84:85]
    v_mfma_f32_4x4x4_16b_bf16 v[76:79], v[10:11], v[86:87], v[76:79]
    s_mov_b64 exec, -1
    ds_read_b64 v[68:69], v92
    v_and_b32 v46, 0x80000000, v33
    v_lshrrev_b32 v47, 14, v31
    v_bitop3_b32 v47, v47, v5, v46 bitop3:0xea
    ds_read_b64 v[106:107], v47 offset:63616
    v_bitop3_b32 v95, v31, v5, v46 bitop3:0xea
    v_and_b32 v46, 0x40000000, v33
    v_lshrrev_b32 v47, 14, v30
    v_bitop3_b32 v47, v47, v5, v46 bitop3:0xea
    ds_read_b64 v[104:105], v47 offset:63616
    v_bitop3_b32 v94, v30, v5, v46 bitop3:0xea
    s_waitcnt lgkmcnt(2)
    v_mfma_f32_4x4x4_16b_bf16 v[80:83], v[10:11], v[70:71], v[80:83]
    v_mfma_f32_4x4x4_16b_bf16 v[76:79], v[10:11], v[68:69], v[76:79]
    v_perm_b32 v15, v31, v32, s47
    v_bitop3_b32 v46, v31, 0.5, -0.5 bitop3:0xa8
    v_perm_b32 v14, v30, v32, s46
    v_bitop3_b32 v47, v30, 0.5, -0.5 bitop3:0xa8
    v_cvt_pk_bf16_f32 v80, v80, v81
    v_cvt_pk_bf16_f32 v81, v82, v83
    ds_wrxchg_rtn_b64 v[74:75], v93, v[80:81]
    v_cvt_pk_bf16_f32 v76, v76, v77
    v_cvt_pk_bf16_f32 v77, v78, v79
    ds_wrxchg_rtn_b64 v[72:73], v92, v[76:77]
    s_setprio 0
    s_waitcnt lgkmcnt(2)
    v_mfma_f32_4x4x4_16b_bf16 v[80:83], v[8:9], v[106:107], 0
    v_mfma_f32_4x4x4_16b_bf16 v[76:79], v[8:9], v[104:105], 0
    v_bitop3_b32 v15, v6, v15, v46 bitop3:0xca
    v_bitop3_b32 v14, v6, v14, v47 bitop3:0xca
    s_nop 1
    v_pk_mul_f32 v[80:81], v[80:81], v[14:15] op_sel:[0,1] op_sel_hi:[1,1]
    v_pk_mul_f32 v[82:83], v[82:83], v[14:15] op_sel:[0,1] op_sel_hi:[1,1]
    v_pk_mul_f32 v[76:77], v[76:77], v[14:15] op_sel:[0,0] op_sel_hi:[1,0]
    v_pk_mul_f32 v[78:79], v[78:79], v[14:15] op_sel:[0,0] op_sel_hi:[1,0]
    s_add_u32 s40, s40, 0x4e200
    v_and_b32 v47, 0x0fffffff, v42
    v_mov_b32 v33, v42
    buffer_load_dwordx4 v[28:31], v47, s[8:11], 0 offen
    buffer_load_dwordx3 v[30:32], v47, s[8:11], 0 offen offset:8
    s_waitcnt lgkmcnt(0)
    v_cmpx_ne_u64 vcc, v[74:75], v[70:71]
    s_and_b64 s[82:83], vcc, s[80:81]
    s_cbranch_scc1 L2_c18
L2_d18:
    v_mov_b64 v[84:85], v[70:71]
    v_mov_b32 v7, v93
    v_mov_b64 v[86:87], v[74:75]
    s_mov_b64 exec, -1
    s_or_b64 s[80:81], s[80:81], vcc
    v_cmpx_ne_u64 vcc, v[72:73], v[68:69]
    s_and_b64 s[82:83], vcc, s[80:81]
    s_cbranch_scc1 L2_c19
L2_d19:
    v_mov_b64 v[84:85], v[68:69]
    v_mov_b32 v7, v92
    v_mov_b64 v[86:87], v[72:73]
    s_mov_b64 exec, -1
    s_or_b64 s[80:81], s[80:81], vcc
    ds_read_b64 v[70:71], v95
    ds_read_b64 v[68:69], v94
    s_waitcnt vmcnt(8)
    v_and_b32 v46, 0x20000000, v39
    v_lshrrev_b32 v47, 14, v35
    v_bitop3_b32 v47, v47, v5, v46 bitop3:0xea
    ds_read_b64 v[102:103], v47 offset:63616
    v_bitop3_b32 v93, v35, v5, v46 bitop3:0xea
    v_and_b32 v46, 0x10000000, v39
    v_lshrrev_b32 v47, 14, v34
    v_bitop3_b32 v47, v47, v5, v46 bitop3:0xea
    ds_read_b64 v[100:101], v47 offset:63616
    v_bitop3_b32 v92, v34, v5, v46 bitop3:0xea
    v_and_b32 v46, 0x80000000, v39
    v_lshrrev_b32 v47, 14, v37
    v_bitop3_b32 v47, v47, v5, v46 bitop3:0xea
    ds_read_b64 v[106:107], v47 offset:63616
    v_and_b32 v46, 0x40000000, v39
    v_lshrrev_b32 v47, 14, v36
    v_bitop3_b32 v47, v47, v5, v46 bitop3:0xea
    ds_read_b64 v[104:105], v47 offset:63616
    s_waitcnt lgkmcnt(4)
    v_mfma_f32_4x4x4_16b_bf16 v[80:83], v[10:11], v[70:71], v[80:83]
    v_mfma_f32_4x4x4_16b_bf16 v[76:79], v[10:11], v[68:69], v[76:79]
    v_perm_b32 v15, v35, v38, s45
    v_bitop3_b32 v46, v35, 0.5, -0.5 bitop3:0xa8
    v_perm_b32 v14, v34, v38, s44
    v_bitop3_b32 v47, v34, 0.5, -0.5 bitop3:0xa8
    v_cvt_pk_bf16_f32 v80, v80, v81
    v_cvt_pk_bf16_f32 v81, v82, v83
    ds_wrxchg_rtn_b64 v[74:75], v95, v[80:81]
    v_cvt_pk_bf16_f32 v76, v76, v77
    v_cvt_pk_bf16_f32 v77, v78, v79
    ds_wrxchg_rtn_b64 v[72:73], v94, v[76:77]
    s_waitcnt lgkmcnt(2)
    s_barrier
    s_setprio 3
    ds_write_b128 v3, v[124:127] offset:4096
    s_add_u32 s3, s40, 4096
    buffer_load_dwordx4 v[124:127], v3, s[16:19], s3 offen
    ds_write_b128 v3, v[116:119] offset:2048
    buffer_load_dwordx4 v[116:119], v3, s[16:19], s40 offen offset:2048
    ds_write_b128 v3, v[120:123] offset:3072
    buffer_load_dwordx4 v[120:123], v3, s[16:19], s40 offen offset:3072
    v_mfma_f32_4x4x4_16b_bf16 v[80:83], v[8:9], v[102:103], 0
    v_mfma_f32_4x4x4_16b_bf16 v[76:79], v[8:9], v[100:101], 0
    v_bitop3_b32 v15, v6, v15, v46 bitop3:0xca
    v_bitop3_b32 v14, v6, v14, v47 bitop3:0xca
    v_cmp_lt_u32 s[84:85], v5, v92
    s_nop 0
    v_pk_mul_f32 v[80:81], v[80:81], v[14:15] op_sel:[0,1] op_sel_hi:[1,1]
    v_pk_mul_f32 v[82:83], v[82:83], v[14:15] op_sel:[0,1] op_sel_hi:[1,1]
    v_pk_mul_f32 v[76:77], v[76:77], v[14:15] op_sel:[0,0] op_sel_hi:[1,0]
    v_pk_mul_f32 v[78:79], v[78:79], v[14:15] op_sel:[0,0] op_sel_hi:[1,0]
    v_mov_b32 v44, v43
    s_cmp_gt_u32 s37, 1024
    s_cbranch_scc1 L2_xs20
    s_cmp_lg_u32 s43, 0
    s_cbranch_scc1 L2_xa20
L2_xb20:
    v_lshlrev_b32 v89, 16, v96
    v_add_u32 v90, 60, v97
    v_bitop3_b32 v90, v89, v45, v90 bitop3:0x6a
    ds_write_b32 v98, v90 offset:12
    v_lshlrev_b32 v89, 20, v96
    v_add_u32 v90, 40, v97
    v_bitop3_b32 v90, v89, v45, v90 bitop3:0x6a
    ds_write_b32 v98, v90 offset:8
    v_lshlrev_b32 v89, 24, v96
    v_add_u32 v90, 20, v97
    v_bitop3_b32 v90, v89, v45, v90 bitop3:0x6a
    ds_write_b32 v98, v90 offset:4
    v_lshlrev_b32 v89, 28, v96
    v_bitop3_b32 v90, v89, v45, v97 bitop3:0x6a
    ds_write_b32 v98, v90 offset:0
    v_mov_b32_dpp v91, v64 quad_perm:[1,1,1,1] row_mask:0xf bank_mask:0xf
    v_and_b32 v89, 3, v91
    v_and_b32 v97, 0xfffc, v91
    v_sub_u16_dpp v88, v64, v91 quad_perm:[3,3,3,3] row_mask:0xf bank_mask:0xf
    v_mad_u32_u24 v97, v97, 5, v4
    v_add_u32 v99, v88, v89
    v_bfm_b32 v96, v88, v89
    v_cmp_lt_u32 s[58:59], 16, v99
    v_lshlrev_b32 v89, v1, v96
    v_and_b32 v89, v45, v89
    v_cmp_ne_u32 vcc, 0, v89
    v_xor_b32 v90, v97, v89
    s_add_u32 s3, s37, s38
    v_mbcnt_lo_u32_b32 v98, vcc_lo, 0
    v_mbcnt_hi_u32_b32 v98, vcc_hi, v98
    s_bcnt1_i32_b64 s41, vcc
    v_lshl_add_u32 v98, v98, 2, s3
    s_mov_b64 exec, vcc
    ds_write_b32 v98, v90
    s_mov_b64 exec, -1
    s_lshl2_add_u32 s37, s41, s37
    s_cmp_lg_u64 s[58:59], 0
    s_cbranch_scc1 L2_xe20
L2_xr20:
    v_add_u32 v98, s37, v0
    v_mov_b32 v90, -1
    ds_write_b32 v98, v90
    ds_read2st64_b32 v[40:41], v0 offset0:0 offset1:1
    ds_read2st64_b32 v[42:43], v0 offset0:2 offset1:3
    s_sub_u32 s3, s37, 768
    s_cmp_gt_u32 s3, 256
    s_cbranch_scc1 L2_xf20
L2_xg20:
    s_setprio 2
    s_waitcnt vmcnt(10)
    ds_write_b128 v3, v[108:111] offset:0
    s_waitcnt lgkmcnt(12)
    v_cmpx_ne_u64 vcc, v[74:75], v[70:71]
    s_and_b64 s[82:83], vcc, s[80:81]
    s_cbranch_scc1 L2_c21
L2_d21:
    v_mov_b64 v[84:85], v[70:71]
    v_mov_b32 v7, v95
    v_mov_b64 v[86:87], v[74:75]
    s_mov_b64 exec, -1
    s_or_b64 s[80:81], s[80:81], vcc
    v_cmpx_ne_u64 vcc, v[72:73], v[68:69]
    s_and_b64 s[82:83], vcc, s[80:81]
    s_cbranch_scc1 L2_c22
L2_d22:
    v_mov_b64 v[84:85], v[68:69]
    v_mov_b32 v7, v94
    v_mov_b64 v[86:87], v[72:73]
    s_mov_b64 exec, -1
    s_or_b64 s[80:81], s[80:81], vcc
    ds_read_b64 v[70:71], v93
    s_and_b64 exec, s[84:85], s[80:81]
    v_mfma_f32_4x4x4_16b_bf16 v[76:79], v[12:13], v[84:85], 0
    v_mov_b32 v92, v7
    s_andn2_b64 s[80:81], s[80:81], s[84:85]
    v_mfma_f32_4x4x4_16b_bf16 v[76:79], v[10:11], v[86:87], v[76:79]
    s_mov_b64 exec, -1
    ds_read_b64 v[68:69], v92
    s_setprio 1
    s_waitcnt vmcnt(7)
    ds_write_b128 v3, v[112:115] offset:1024
    s_waitcnt lgkmcnt(1)
    v_mfma_f32_4x4x4_16b_bf16 v[80:83], v[10:11], v[70:71], v[80:83]
    v_mfma_f32_4x4x4_16b_bf16 v[76:79], v[10:11], v[68:69], v[76:79]
    v_and_b32 v46, 0x40000000, v39
    v_bitop3_b32 v94, v36, v5, v46 bitop3:0xea
    v_and_b32 v46, 0x80000000, v39
    v_bitop3_b32 v95, v37, v5, v46 bitop3:0xea
    v_perm_b32 v15, v37, v38, s47
    v_bitop3_b32 v46, v37, 0.5, -0.5 bitop3:0xa8
    v_perm_b32 v14, v36, v38, s46
    v_bitop3_b32 v47, v36, 0.5, -0.5 bitop3:0xa8
    v_cvt_pk_bf16_f32 v80, v80, v81
    v_cvt_pk_bf16_f32 v81, v82, v83
    ds_wrxchg_rtn_b64 v[74:75], v93, v[80:81]
    v_cvt_pk_bf16_f32 v76, v76, v77
    v_cvt_pk_bf16_f32 v77, v78, v79
    ds_wrxchg_rtn_b64 v[72:73], v92, v[76:77]
    s_setprio 0
    v_mfma_f32_4x4x4_16b_bf16 v[80:83], v[8:9], v[106:107], 0
    v_mfma_f32_4x4x4_16b_bf16 v[76:79], v[8:9], v[104:105], 0
    v_bitop3_b32 v15, v6, v15, v46 bitop3:0xca
    v_bitop3_b32 v14, v6, v14, v47 bitop3:0xca
    s_nop 1
    v_pk_mul_f32 v[80:81], v[80:81], v[14:15] op_sel:[0,1] op_sel_hi:[1,1]
    v_pk_mul_f32 v[82:83], v[82:83], v[14:15] op_sel:[0,1] op_sel_hi:[1,1]
    v_pk_mul_f32 v[76:77], v[76:77], v[14:15] op_sel:[0,0] op_sel_hi:[1,0]
    v_pk_mul_f32 v[78:79], v[78:79], v[14:15] op_sel:[0,0] op_sel_hi:[1,0]
    s_add_u32 s42, s42, 1
    s_waitcnt lgkmcnt(2)
    s_barrier
    s_bitcmp1_b32 s36, s42
    s_cbranch_scc1 L2_slow
L2_ret1:
    s_setprio 3
    v_and_b32 v47, 0x0fffffff, v44
    v_mov_b32 v39, v44
    buffer_load_dwordx4 v[34:37], v47, s[8:11], 0 offen
    buffer_load_dwordx3 v[36:38], v47, s[8:11], 0 offen offset:8
    s_waitcnt lgkmcnt(0)
    v_cmpx_ne_u64 vcc, v[74:75], v[70:71]
    s_and_b64 s[82:83], vcc, s[80:81]
    s_cbranch_scc1 L2_c23
L2_d23:
    v_mov_b64 v[84:85], v[70:71]
    v_mov_b32 v7, v93
    v_mov_b64 v[86:87], v[74:75]
    s_mov_b64 exec, -1
    s_or_b64 s[80:81], s[80:81], vcc
    v_cmpx_ne_u64 vcc, v[72:73], v[68:69]
    s_and_b64 s[82:83], vcc, s[80:81]
    s_cbranch_scc1 L2_c24
L2_d24:
    v_mov_b64 v[84:85], v[68:69]
    v_mov_b32 v7, v92
    v_mov_b64 v[86:87], v[72:73]
    s_mov_b64 exec, -1
    s_or_b64 s[80:81], s[80:81], vcc
    ds_read_b64 v[70:71], v95
    ds_read_b64 v[68:69], v94
    v_and_b32 v46, 0x20000000, v21
    v_lshrrev_b32 v47, 14, v17
    v_bitop3_b32 v47, v47, v5, v46 bitop3:0xea
    ds_read_b64 v[102:103], v47 offset:63616
    v_bitop3_b32 v93, v17, v5, v46 bitop3:0xea
    v_and_b32 v46, 0x10000000, v21
    v_lshrrev_b32 v47, 14, v16
    v_bitop3_b32 v47, v47, v5, v46 bitop3:0xea
    ds_read_b64 v[100:101], v47 offset:63616
    v_bitop3_b32 v92, v16, v5, v46 bitop3:0xea
    s_waitcnt lgkmcnt(2)
    v_mfma_f32_4x4x4_16b_bf16 v[80:83], v[10:11], v[70:71], v[80:83]
    v_mfma_f32_4x4x4_16b_bf16 v[76:79], v[10:11], v[68:69], v[76:79]
    v_perm_b32 v15, v17, v20, s45
    v_bitop3_b32 v46, v17, 0.5, -0.5 bitop3:0xa8
    v_perm_b32 v14, v16, v20, s44
    v_bitop3_b32 v47, v16, 0.5, -0.5 bitop3:0xa8
    v_cvt_pk_bf16_f32 v80, v80, v81
    v_cvt_pk_bf16_f32 v81, v82, v83
    ds_wrxchg_rtn_b64 v[74:75], v95, v[80:81]
    v_cvt_pk_bf16_f32 v76, v76, v77
    v_cvt_pk_bf16_f32 v77, v78, v79
    ds_wrxchg_rtn_b64 v[72:73], v94, v[76:77]
    s_waitcnt lgkmcnt(2)
    v_mfma_f32_4x4x4_16b_bf16 v[80:83], v[8:9], v[102:103], 0
    v_mfma_f32_4x4x4_16b_bf16 v[76:79], v[8:9], v[100:101], 0
    v_bitop3_b32 v15, v6, v15, v46 bitop3:0xca
    v_bitop3_b32 v14, v6, v14, v47 bitop3:0xca
    v_cmp_lt_u32 s[84:85], v5, v92
    s_nop 0
    v_pk_mul_f32 v[80:81], v[80:81], v[14:15] op_sel:[0,1] op_sel_hi:[1,1]
    v_pk_mul_f32 v[82:83], v[82:83], v[14:15] op_sel:[0,1] op_sel_hi:[1,1]
    v_pk_mul_f32 v[76:77], v[76:77], v[14:15] op_sel:[0,0] op_sel_hi:[1,0]
    v_pk_mul_f32 v[78:79], v[78:79], v[14:15] op_sel:[0,0] op_sel_hi:[1,0]
    buffer_load_dwordx4 v[108:111], v3, s[16:19], s40 offen offset:0
    s_waitcnt lgkmcnt(0)
    v_cmpx_ne_u64 vcc, v[74:75], v[70:71]
    s_and_b64 s[82:83], vcc, s[80:81]
    s_cbranch_scc1 L2_c25
L2_d25:
    v_mov_b64 v[84:85], v[70:71]
    v_mov_b32 v7, v95
    v_mov_b64 v[86:87], v[74:75]
    s_mov_b64 exec, -1
    s_or_b64 s[80:81], s[80:81], vcc
    v_cmpx_ne_u64 vcc, v[72:73], v[68:69]
    s_and_b64 s[82:83], vcc, s[80:81]
    s_cbranch_scc1 L2_c26
L2_d26:
    v_mov_b64 v[84:85], v[68:69]
    v_mov_b32 v7, v94
    v_mov_b64 v[86:87], v[72:73]
    s_mov_b64 exec, -1
    s_or_b64 s[80:81], s[80:81], vcc
    ds_read_b64 v[70:71], v93
    s_and_b64 exec, s[84:85], s[80:81]
    v_mfma_f32_4x4x4_16b_bf16 v[76:79], v[12:13], v[84:85], 0
    v_mov_b32 v92, v7
    s_andn2_b64 s[80:81], s[80:81], s[84:85]
    v_mfma_f32_4x4x4_16b_bf16 v[76:79], v[10:11], v[86:87], v[76:79]
    s_mov_b64 exec, -1
    ds_read_b64 v[68:69], v92
    v_and_b32 v46, 0x80000000, v21
    v_lshrrev_b32 v47, 14, v19
    v_bitop3_b32 v47, v47, v5, v46 bitop3:0xea
    ds_read_b64 v[106:107], v47 offset:63616
    v_bitop3_b32 v95, v19, v5, v46 bitop3:0xea
    v_and_b32 v46, 0x40000000, v21
    v_lshrrev_b32 v47, 14, v18
    v_bitop3_b32 v47, v47, v5, v46 bitop3:0xea
    ds_read_b64 v[104:105], v47 offset:63616
    v_bitop3_b32 v94, v18, v5, v46 bitop3:0xea
    s_waitcnt lgkmcnt(2)
    v_mfma_f32_4x4x4_16b_bf16 v[80:83], v[10:11], v[70:71], v[80:83]
    v_mfma_f32_4x4x4_16b_bf16 v[76:79], v[10:11], v[68:69], v[76:79]
    v_perm_b32 v15, v19, v20, s47
    v_bitop3_b32 v46, v19, 0.5, -0.5 bitop3:0xa8
    v_perm_b32 v14, v18, v20, s46
    v_bitop3_b32 v47, v18, 0.5, -0.5 bitop3:0xa8
    v_cvt_pk_bf16_f32 v80, v80, v81
    v_cvt_pk_bf16_f32 v81, v82, v83
    ds_wrxchg_rtn_b64 v[74:75], v93, v[80:81]
    v_cvt_pk_bf16_f32 v76, v76, v77
    v_cvt_pk_bf16_f32 v77, v78, v79
    ds_wrxchg_rtn_b64 v[72:73], v92, v[76:77]
    s_setprio 2
    s_waitcnt lgkmcnt(2)
    v_mfma_f32_4x4x4_16b_bf16 v[80:83], v[8:9], v[106:107], 0
    v_mfma_f32_4x4x4_16b_bf16 v[76:79], v[8:9], v[104:105], 0
    v_bitop3_b32 v15, v6, v15, v46 bitop3:0xca
    v_bitop3_b32 v14, v6, v14, v47 bitop3:0xca
    s_nop 1
    v_pk_mul_f32 v[80:81], v[80:81], v[14:15] op_sel:[0,1] op_sel_hi:[1,1]
    v_pk_mul_f32 v[82:83], v[82:83], v[14:15] op_sel:[0,1] op_sel_hi:[1,1]
    v_pk_mul_f32 v[76:77], v[76:77], v[14:15] op_sel:[0,0] op_sel_hi:[1,0]
    v_pk_mul_f32 v[78:79], v[78:79], v[14:15] op_sel:[0,0] op_sel_hi:[1,0]
    v_and_b32 v47, 0x0fffffff, v40
    v_mov_b32 v21, v40
    buffer_load_dwordx4 v[16:19], v47, s[8:11], 0 offen
    buffer_load_dwordx3 v[18:20], v47, s[8:11], 0 offen offset:8
    s_waitcnt lgkmcnt(0)
    v_cmpx_ne_u64 vcc, v[74:75], v[70:71]
    s_and_b64 s[82:83], vcc, s[80:81]
    s_cbranch_scc1 L2_c27
L2_d27:
    v_mov_b64 v[84:85], v[70:71]
    v_mov_b32 v7, v93
    v_mov_b64 v[86:87], v[74:75]
    s_mov_b64 exec, -1
    s_or_b64 s[80:81], s[80:81], vcc
    v_cmpx_ne_u64 vcc, v[72:73], v[68:69]
    s_and_b64 s[82:83], vcc, s[80:81]
    s_cbranch_scc1 L2_c28
L2_d28:
    v_mov_b64 v[84:85], v[68:69]
    v_mov_b32 v7, v92
    v_mov_b64 v[86:87], v[72:73]
    s_mov_b64 exec, -1
    s_or_b64 s[80:81], s[80:81], vcc
    ds_read_b64 v[70:71], v95
    ds_read_b64 v[68:69], v94
    s_waitcnt vmcnt(10)
    v_and_b32 v46, 0x20000000, v27
    v_lshrrev_b32 v47, 14, v23
    v_bitop3_b32 v47, v47, v5, v46 bitop3:0xea
    ds_read_b64 v[102:103], v47 offset:63616
    v_bitop3_b32 v93, v23, v5, v46 bitop3:0xea
    v_and_b32 v46, 0x10000000, v27
    v_lshrrev_b32 v47, 14, v22
    v_bitop3_b32 v47, v47, v5, v46 bitop3:0xea
    ds_read_b64 v[100:101], v47 offset:63616
    v_bitop3_b32 v92, v22, v5, v46 bitop3:0xea
    s_waitcnt lgkmcnt(2)
    v_mfma_f32_4x4x4_16b_bf16 v[80:83], v[10:11], v[70:71], v[80:83]
    v_mfma_f32_4x4x4_16b_bf16 v[76:79], v[10:11], v[68:69], v[76:79]
    v_perm_b32 v15, v23, v26, s45
    v_bitop3_b32 v46, v23, 0.5, -0.5 bitop3:0xa8
    v_perm_b32 v14, v22, v26, s44
    v_bitop3_b32 v47, v22, 0.5, -0.5 bitop3:0xa8
    v_cvt_pk_bf16_f32 v80, v80, v81
    v_cvt_pk_bf16_f32 v81, v82, v83
    ds_wrxchg_rtn_b64 v[74:75], v95, v[80:81]
    v_cvt_pk_bf16_f32 v76, v76, v77
    v_cvt_pk_bf16_f32 v77, v78, v79
    ds_wrxchg_rtn_b64 v[72:73], v94, v[76:77]
    s_waitcnt lgkmcnt(2)
    v_mfma_f32_4x4x4_16b_bf16 v[80:83], v[8:9], v[102:103], 0
    v_mfma_f32_4x4x4_16b_bf16 v[76:79], v[8:9], v[100:101], 0
    v_bitop3_b32 v15, v6, v15, v46 bitop3:0xca
    v_bitop3_b32 v14, v6, v14, v47 bitop3:0xca
    v_cmp_lt_u32 s[84:85], v5, v92
    s_nop 0
    v_pk_mul_f32 v[80:81], v[80:81], v[14:15] op_sel:[0,1] op_sel_hi:[1,1]
    v_pk_mul_f32 v[82:83], v[82:83], v[14:15] op_sel:[0,1] op_sel_hi:[1,1]
    v_pk_mul_f32 v[76:77], v[76:77], v[14:15] op_sel:[0,0] op_sel_hi:[1,0]
    v_pk_mul_f32 v[78:79], v[78:79], v[14:15] op_sel:[0,0] op_sel_hi:[1,0]
    v_sub_u16 v88, v62, v54
    v_and_b32 v89, 3, v54
    v_add3_u32 v99, v88, v89, 3
    v_and_b32 v99, -4, v99
    v_max_u32 v99, 4, v99
    v_and_b32 v97, 0xfffc, v54
    v_bfm_b32 v96, v88, v89
    v_add_u32_dpp v91, v99, v99 row_shr:1 row_mask:0xf bank_mask:0xf bound_ctrl:1
    v_mad_u32_u24 v97, v97, 5, v2
    v_cmp_lt_u32 vcc, 16, v99
    v_add_u32_dpp v91, v91, v91 row_shr:2 row_mask:0xf bank_mask:0xf bound_ctrl:1
    v_sub_u32 v98, s38, v99
    v_lshrrev_b64 v[54:55], 16, v[54:55]
    v_add_u32_dpp v91, v91, v91 row_shr:4 row_mask:0xf bank_mask:0xf bound_ctrl:1
    v_lshrrev_b64 v[62:63], 16, v[62:63]
    s_mov_b32 s43, 0
    v_add_u32_dpp v91, v91, v91 row_shr:8 row_mask:0xf bank_mask:0xf bound_ctrl:1
    s_nop 1
    v_add_u32_dpp v91, v91, v91 row_bcast:15 row_mask:0xa bank_mask:0xf
    s_nop 1
    v_add_u32_dpp v91, v91, v91 row_bcast:31 row_mask:0xc bank_mask:0xf
    v_add_u32 v98, v98, v91
    v_readlane_b32 s37, v91, 63
    s_cbranch_vccnz L2_xo29
L2_xp29:
    buffer_load_dwordx4 v[112:115], v3, s[16:19], s40 offen offset:1024
    s_waitcnt lgkmcnt(0)
    v_cmpx_ne_u64 vcc, v[74:75], v[70:71]
    s_and_b64 s[82:83], vcc, s[80:81]
    s_cbranch_scc1 L2_c30
L2_d30:
    v_mov_b64 v[84:85], v[70:71]
    v_mov_b32 v7, v95
    v_mov_b64 v[86:87], v[74:75]
    s_mov_b64 exec, -1
    s_or_b64 s[80:81], s[80:81], vcc
    v_cmpx_ne_u64 vcc, v[72:73], v[68:69]
    s_and_b64 s[82:83], vcc, s[80:81]
    s_cbranch_scc1 L2_c31
L2_d31:
    v_mov_b64 v[84:85], v[68:69]
    v_mov_b32 v7, v94
    v_mov_b64 v[86:87], v[72:73]
    s_mov_b64 exec, -1
    s_or_b64 s[80:81], s[80:81], vcc
    ds_read_b64 v[70:71], v93
    s_and_b64 exec, s[84:85], s[80:81]
    v_mfma_f32_4x4x4_16b_bf16 v[76:79], v[12:13], v[84:85], 0
    v_mov_b32 v92, v7
    s_andn2_b64 s[80:81], s[80:81], s[84:85]
    v_mfma_f32_4x4x4_16b_bf16 v[76:79], v[10:11], v[86:87], v[76:79]
    s_mov_b64 exec, -1
    ds_read_b64 v[68:69], v92
    v_and_b32 v46, 0x80000000, v27
    v_lshrrev_b32 v47, 14, v25
    v_bitop3_b32 v47, v47, v5, v46 bitop3:0xea
    ds_read_b64 v[106:107], v47 offset:63616
    v_bitop3_b32 v95, v25, v5, v46 bitop3:0xea
    v_and_b32 v46, 0x40000000, v27
    v_lshrrev_b32 v47, 14, v24
    v_bitop3_b32 v47, v47, v5, v46 bitop3:0xea
    ds_read_b64 v[104:105], v47 offset:63616
    v_bitop3_b32 v94, v24, v5, v46 bitop3:0xea
    s_waitcnt lgkmcnt(2)
    v_mfma_f32_4x4x4_16b_bf16 v[80:83], v[10:11], v[70:71], v[80:83]
    v_mfma_f32_4x4x4_16b_bf16 v[76:79], v[10:11], v[68:69], v[76:79]
    v_perm_b32 v15, v25, v26, s47
    v_bitop3_b32 v46, v25, 0.5, -0.5 bitop3:0xa8
    v_perm_b32 v14, v24, v26, s46
    v_bitop3_b32 v47, v24, 0.5, -0.5 bitop3:0xa8
    v_cvt_pk_bf16_f32 v80, v80, v81
    v_cvt_pk_bf16_f32 v81, v82, v83
    ds_wrxchg_rtn_b64 v[74:75], v93, v[80:81]
    v_cvt_pk_bf16_f32 v76, v76, v77
    v_cvt_pk_bf16_f32 v77, v78, v79
    ds_wrxchg_rtn_b64 v[72:73], v92, v[76:77]
    s_setprio 1
    s_waitcnt lgkmcnt(2)
    v_mfma_f32_4x4x4_16b_bf16 v[80:83], v[8:9], v[106:107], 0
    v_mfma_f32_4x4x4_16b_bf16 v[76:79], v[8:9], v[104:105], 0
    v_bitop3_b32 v15, v6, v15, v46 bitop3:0xca
    v_bitop3_b32 v14, v6, v14, v47 bitop3:0xca
    s_nop 1
    v_pk_mul_f32 v[80:81], v[80:81], v[14:15] op_sel:[0,1] op_sel_hi:[1,1]
    v_pk_mul_f32 v[82:83], v[82:83], v[14:15] op_sel:[0,1] op_sel_hi:[1,1]
    v_pk_mul_f32 v[76:77], v[76:77], v[14:15] op_sel:[0,0] op_sel_hi:[1,0]
    v_pk_mul_f32 v[78:79], v[78:79], v[14:15] op_sel:[0,0] op_sel_hi:[1,0]
    v_and_b32 v47, 0x0fffffff, v41
    v_mov_b32 v27, v41
    buffer_load_dwordx4 v[22:25], v47, s[8:11], 0 offen
    buffer_load_dwordx3 v[24:26], v47, s[8:11], 0 offen offset:8
    s_waitcnt lgkmcnt(0)
    v_cmpx_ne_u64 vcc, v[74:75], v[70:71]
    s_and_b64 s[82:83], vcc, s[80:81]
    s_cbranch_scc1 L2_c32
L2_d32:
    v_mov_b64 v[84:85], v[70:71]
    v_mov_b32 v7, v93
    v_mov_b64 v[86:87], v[74:75]
    s_mov_b64 exec, -1
    s_or_b64 s[80:81], s[80:81], vcc
    v_cmpx_ne_u64 vcc, v[72:73], v[68:69]
    s_and_b64 s[82:83], vcc, s[80:81]
    s_cbranch_scc1 L2_c33
L2_d33:
    v_mov_b64 v[84:85], v[68:69]
    v_mov_b32 v7, v92
    v_mov_b64 v[86:87], v[72:73]
    s_mov_b64 exec, -1
    s_or_b64 s[80:81], s[80:81], vcc
    ds_read_b64 v[70:71], v95
    ds_read_b64 v[68:69], v94
    s_waitcnt vmcnt(11)
    v_and_b32 v46, 0x20000000, v33
    v_lshrrev_b32 v47, 14, v29
    v_bitop3_b32 v47, v47, v5, v46 bitop3:0xea
    ds_read_b64 v[102:103], v47 offset:63616
    v_bitop3_b32 v93, v29, v5, v46 bitop3:0xea
    v_and_b32 v46, 0x10000000, v33
    v_lshrrev_b32 v47, 14, v28
    v_bitop3_b32 v47, v47, v5, v46 bitop3:0xea
    ds_read_b64 v[100:101], v47 offset:63616
    v_bitop3_b32 v92, v28, v5, v46 bitop3:0xea
    s_waitcnt lgkmcnt(2)
    v_mfma_f32_4x4x4_16b_bf16 v[80:83], v[10:11], v[70:71], v[80:83]
    v_mfma_f32_4x4x4_16b_bf16 v[76:79], v[10:11], v[68:69], v[76:79]
    v_perm_b32 v15, v29, v32, s45
    v_bitop3_b32 v46, v29, 0.5, -0.5 bitop3:0xa8
    v_perm_b32 v14, v28, v32, s44
    v_bitop3_b32 v47, v28, 0.5, -0.5 bitop3:0xa8
    v_cvt_pk_bf16_f32 v80, v80, v81
    v_cvt_pk_bf16_f32 v81, v82, v83
    ds_wrxchg_rtn_b64 v[74:75], v95, v[80:81]
    v_cvt_pk_bf16_f32 v76, v76, v77
    v_cvt_pk_bf16_f32 v77, v78, v79
    ds_wrxchg_rtn_b64 v[72:73], v94, v[76:77]
    s_waitcnt lgkmcnt(2)
    v_mfma_f32_4x4x4_16b_bf16 v[80:83], v[8:9], v[102:103], 0
    v_mfma_f32_4x4x4_16b_bf16 v[76:79], v[8:9], v[100:101], 0
    v_bitop3_b32 v15, v6, v15, v46 bitop3:0xca
    v_bitop3_b32 v14, v6, v14, v47 bitop3:0xca
    v_cmp_lt_u32 s[84:85], v5, v92
    s_nop 0
    v_pk_mul_f32 v[80:81], v[80:81], v[14:15] op_sel:[0,1] op_sel_hi:[1,1]
    v_pk_mul_f32 v[82:83], v[82:83], v[14:15] op_sel:[0,1] op_sel_hi:[1,1]
    v_pk_mul_f32 v[76:77], v[76:77], v[14:15] op_sel:[0,0] op_sel_hi:[1,0]
    v_pk_mul_f32 v[78:79], v[78:79], v[14:15] op_sel:[0,0] op_sel_hi:[1,0]
    s_waitcnt lgkmcnt(0)
    v_cmpx_ne_u64 vcc, v[74:75], v[70:71]
    s_and_b64 s[82:83], vcc, s[80:81]
    s_cbranch_scc1 L2_c34
L2_d34:
    v_mov_b64 v[84:85], v[70:71]
    v_mov_b32 v7, v95
    v_mov_b64 v[86:87], v[74:75]
    s_mov_b64 exec, -1
    s_or_b64 s[80:81], s[80:81], vcc
    v_cmpx_ne_u64 vcc, v[72:73], v[68:69]
    s_and_b64 s[82:83], vcc, s[80:81]
    s_cbranch_scc1 L2_c35
L2_d35:
    v_mov_b64 v[84:85], v[68:69]
    v_mov_b32 v7, v94
    v_mov_b64 v[86:87], v[72:73]
    s_mov_b64 exec, -1
    s_or_b64 s[80:81], s[80:81], vcc
    ds_read_b64 v[70:71], v93
    s_and_b64 exec, s[84:85], s[80:81]
    v_mfma_f32_4x4x4_16b_bf16 v[76:79], v[12:13], v[84:85], 0
    v_mov_b32 v92, v7
    s_andn2_b64 s[80:81], s[80:81], s[84:85]
    v_mfma_f32_4x4x4_16b_bf16 v[76:79], v[10:11], v[86:87], v[76:79]
    s_mov_b64 exec, -1
    ds_read_b64 v[68:69], v92
    v_and_b32 v46, 0x80000000, v33
    v_lshrrev_b32 v47, 14, v31
    v_bitop3_b32 v47, v47, v5, v46 bitop3:0xea
    ds_read_b64 v[106:107], v47 offset:63616
    v_bitop3_b32 v95, v31, v5, v46 bitop3:0xea
    v_and_b32 v46, 0x40000000, v33
    v_lshrrev_b32 v47, 14, v30
    v_bitop3_b32 v47, v47, v5, v46 bitop3:0xea
    ds_read_b64 v[104:105], v47 offset:63616
    v_bitop3_b32 v94, v30, v5, v46 bitop3:0xea
    s_waitcnt lgkmcnt(2)
    v_mfma_f32_4x4x4_16b_bf16 v[80:83], v[10:11], v[70:71], v[80:83]
    v_mfma_f32_4x4x4_16b_bf16 v[76:79], v[10:11], v[68:69], v[76:79]
    v_perm_b32 v15, v31, v32, s47
    v_bitop3_b32 v46, v31, 0.5, -0.5 bitop3:0xa8
    v_perm_b32 v14, v30, v32, s46
    v_bitop3_b32 v47, v30, 0.5, -0.5 bitop3:0xa8
    v_cvt_pk_bf16_f32 v80, v80, v81
    v_cvt_pk_bf16_f32 v81, v82, v83
    ds_wrxchg_rtn_b64 v[74:75], v93, v[80:81]
    v_cvt_pk_bf16_f32 v76, v76, v77
    v_cvt_pk_bf16_f32 v77, v78, v79
    ds_wrxchg_rtn_b64 v[72:73], v92, v[76:77]
    s_setprio 0
    s_waitcnt lgkmcnt(2)
    v_mfma_f32_4x4x4_16b_bf16 v[80:83], v[8:9], v[106:107], 0
    v_mfma_f32_4x4x4_16b_bf16 v[76:79], v[8:9], v[104:105], 0
    v_bitop3_b32 v15, v6, v15, v46 bitop3:0xca
    v_bitop3_b32 v14, v6, v14, v47 bitop3:0xca
    s_nop 1
    v_pk_mul_f32 v[80:81], v[80:81], v[14:15] op_sel:[0,1] op_sel_hi:[1,1]
    v_pk_mul_f32 v[82:83], v[82:83], v[14:15] op_sel:[0,1] op_sel_hi:[1,1]
    v_pk_mul_f32 v[76:77], v[76:77], v[14:15] op_sel:[0,0] op_sel_hi:[1,0]
    v_pk_mul_f32 v[78:79], v[78:79], v[14:15] op_sel:[0,0] op_sel_hi:[1,0]
    s_add_u32 s40, s40, 0x4e200
    v_and_b32 v47, 0x0fffffff, v42
    v_mov_b32 v33, v42
    buffer_load_dwordx4 v[28:31], v47, s[8:11], 0 offen
    buffer_load_dwordx3 v[30:32], v47, s[8:11], 0 offen offset:8
    s_waitcnt lgkmcnt(0)
    v_cmpx_ne_u64 vcc, v[74:75], v[70:71]
    s_and_b64 s[82:83], vcc, s[80:81]
    s_cbranch_scc1 L2_c36
L2_d36:
    v_mov_b64 v[84:85], v[70:71]
    v_mov_b32 v7, v93
    v_mov_b64 v[86:87], v[74:75]
    s_mov_b64 exec, -1
    s_or_b64 s[80:81], s[80:81], vcc
    v_cmpx_ne_u64 vcc, v[72:73], v[68:69]
    s_and_b64 s[82:83], vcc, s[80:81]
    s_cbranch_scc1 L2_c37
L2_d37:
    v_mov_b64 v[84:85], v[68:69]
    v_mov_b32 v7, v92
    v_mov_b64 v[86:87], v[72:73]
    s_mov_b64 exec, -1
    s_or_b64 s[80:81], s[80:81], vcc
    ds_read_b64 v[70:71], v95
    ds_read_b64 v[68:69], v94
    s_waitcnt vmcnt(8)
    v_and_b32 v46, 0x20000000, v39
    v_lshrrev_b32 v47, 14, v35
    v_bitop3_b32 v47, v47, v5, v46 bitop3:0xea
    ds_read_b64 v[102:103], v47 offset:63616
    v_bitop3_b32 v93, v35, v5, v46 bitop3:0xea
    v_and_b32 v46, 0x10000000, v39
    v_lshrrev_b32 v47, 14, v34
    v_bitop3_b32 v47, v47, v5, v46 bitop3:0xea
    ds_read_b64 v[100:101], v47 offset:63616
    v_bitop3_b32 v92, v34, v5, v46 bitop3:0xea
    v_and_b32 v46, 0x80000000, v39
    v_lshrrev_b32 v47, 14, v37
    v_bitop3_b32 v47, v47, v5, v46 bitop3:0xea
    ds_read_b64 v[106:107], v47 offset:63616
    v_and_b32 v46, 0x40000000, v39
    v_lshrrev_b32 v47, 14, v36
    v_bitop3_b32 v47, v47, v5, v46 bitop3:0xea
    ds_read_b64 v[104:105], v47 offset:63616
    s_waitcnt lgkmcnt(4)
    v_mfma_f32_4x4x4_16b_bf16 v[80:83], v[10:11], v[70:71], v[80:83]
    v_mfma_f32_4x4x4_16b_bf16 v[76:79], v[10:11], v[68:69], v[76:79]
    v_perm_b32 v15, v35, v38, s45
    v_bitop3_b32 v46, v35, 0.5, -0.5 bitop3:0xa8
    v_perm_b32 v14, v34, v38, s44
    v_bitop3_b32 v47, v34, 0.5, -0.5 bitop3:0xa8
    v_cvt_pk_bf16_f32 v80, v80, v81
    v_cvt_pk_bf16_f32 v81, v82, v83
    ds_wrxchg_rtn_b64 v[74:75], v95, v[80:81]
    v_cvt_pk_bf16_f32 v76, v76, v77
    v_cvt_pk_bf16_f32 v77, v78, v79
    ds_wrxchg_rtn_b64 v[72:73], v94, v[76:77]
    s_waitcnt lgkmcnt(2)
    s_barrier
    s_setprio 3
    ds_write_b128 v3, v[124:127] offset:4096
    s_add_u32 s3, s40, 4096
    buffer_load_dwordx4 v[124:127], v3, s[16:19], s3 offen
    ds_write_b128 v3, v[116:119] offset:2048
    buffer_load_dwordx4 v[116:119], v3, s[16:19], s40 offen offset:2048
    ds_write_b128 v3, v[120:123] offset:3072
    buffer_load_dwordx4 v[120:123], v3, s[16:19], s40 offen offset:3072
    v_mfma_f32_4x4x4_16b_bf16 v[80:83], v[8:9], v[102:103], 0
    v_mfma_f32_4x4x4_16b_bf16 v[76:79], v[8:9], v[100:101], 0
    v_bitop3_b32 v15, v6, v15, v46 bitop3:0xca
    v_bitop3_b32 v14, v6, v14, v47 bitop3:0xca
    v_cmp_lt_u32 s[84:85], v5, v92
    s_nop 0
    v_pk_mul_f32 v[80:81], v[80:81], v[14:15] op_sel:[0,1] op_sel_hi:[1,1]
    v_pk_mul_f32 v[82:83], v[82:83], v[14:15] op_sel:[0,1] op_sel_hi:[1,1]
    v_pk_mul_f32 v[76:77], v[76:77], v[14:15] op_sel:[0,0] op_sel_hi:[1,0]
    v_pk_mul_f32 v[78:79], v[78:79], v[14:15] op_sel:[0,0] op_sel_hi:[1,0]
    v_mov_b32 v44, v43
    s_cmp_gt_u32 s37, 1024
    s_cbranch_scc1 L2_xs38
    s_cmp_lg_u32 s43, 0
    s_cbranch_scc1 L2_xa38
L2_xb38:
    v_lshlrev_b32 v89, 16, v96
    v_add_u32 v90, 60, v97
    v_bitop3_b32 v90, v89, v45, v90 bitop3:0x6a
    ds_write_b32 v98, v90 offset:12
    v_lshlrev_b32 v89, 20, v96
    v_add_u32 v90, 40, v97
    v_bitop3_b32 v90, v89, v45, v90 bitop3:0x6a
    ds_write_b32 v98, v90 offset:8
    v_lshlrev_b32 v89, 24, v96
    v_add_u32 v90, 20, v97
    v_bitop3_b32 v90, v89, v45, v90 bitop3:0x6a
    ds_write_b32 v98, v90 offset:4
    v_lshlrev_b32 v89, 28, v96
    v_bitop3_b32 v90, v89, v45, v97 bitop3:0x6a
    ds_write_b32 v98, v90 offset:0
    v_mov_b32_dpp v91, v66 quad_perm:[1,1,1,1] row_mask:0xf bank_mask:0xf
    v_and_b32 v89, 3, v91
    v_and_b32 v97, 0xfffc, v91
    v_sub_u16_dpp v88, v66, v91 quad_perm:[3,3,3,3] row_mask:0xf bank_mask:0xf
    v_mad_u32_u24 v97, v97, 5, v4
    v_add_u32 v99, v88, v89
    v_bfm_b32 v96, v88, v89
    v_cmp_lt_u32 s[58:59], 16, v99
    v_lshlrev_b32 v89, v1, v96
    v_and_b32 v89, v45, v89
    v_cmp_ne_u32 vcc, 0, v89
    v_xor_b32 v90, v97, v89
    s_add_u32 s3, s37, s38
    v_mbcnt_lo_u32_b32 v98, vcc_lo, 0
    v_mbcnt_hi_u32_b32 v98, vcc_hi, v98
    s_bcnt1_i32_b64 s41, vcc
    v_lshl_add_u32 v98, v98, 2, s3
    s_mov_b64 exec, vcc
    ds_write_b32 v98, v90
    s_mov_b64 exec, -1
    s_lshl2_add_u32 s37, s41, s37
    s_cmp_lg_u64 s[58:59], 0
    s_cbranch_scc1 L2_xe38
L2_xr38:
    v_add_u32 v98, s37, v0
    v_mov_b32 v90, -1
    ds_write_b32 v98, v90
    ds_read2st64_b32 v[40:41], v0 offset0:0 offset1:1
    ds_read2st64_b32 v[42:43], v0 offset0:2 offset1:3
    s_sub_u32 s3, s37, 768
    s_cmp_gt_u32 s3, 256
    s_cbranch_scc1 L2_xf38
L2_xg38:
    v_lshrrev_b64 v[64:65], 16, v[64:65]
    v_lshrrev_b64 v[66:67], 16, v[66:67]
    s_setprio 2
    s_waitcnt vmcnt(10)
    ds_write_b128 v3, v[108:111] offset:0
    s_waitcnt lgkmcnt(12)
    v_cmpx_ne_u64 vcc, v[74:75], v[70:71]
    s_and_b64 s[82:83], vcc, s[80:81]
    s_cbranch_scc1 L2_c39
L2_d39:
    v_mov_b64 v[84:85], v[70:71]
    v_mov_b32 v7, v95
    v_mov_b64 v[86:87], v[74:75]
    s_mov_b64 exec, -1
    s_or_b64 s[80:81], s[80:81], vcc
    v_cmpx_ne_u64 vcc, v[72:73], v[68:69]
    s_and_b64 s[82:83], vcc, s[80:81]
    s_cbranch_scc1 L2_c40
L2_d40:
    v_mov_b64 v[84:85], v[68:69]
    v_mov_b32 v7, v94
    v_mov_b64 v[86:87], v[72:73]
    s_mov_b64 exec, -1
    s_or_b64 s[80:81], s[80:81], vcc
    ds_read_b64 v[70:71], v93
    s_and_b64 exec, s[84:85], s[80:81]
    v_mfma_f32_4x4x4_16b_bf16 v[76:79], v[12:13], v[84:85], 0
    v_mov_b32 v92, v7
    s_andn2_b64 s[80:81], s[80:81], s[84:85]
    v_mfma_f32_4x4x4_16b_bf16 v[76:79], v[10:11], v[86:87], v[76:79]
    s_mov_b64 exec, -1
    ds_read_b64 v[68:69], v92
    s_setprio 1
    s_waitcnt vmcnt(7)
    ds_write_b128 v3, v[112:115] offset:1024
    s_waitcnt lgkmcnt(1)
    v_mfma_f32_4x4x4_16b_bf16 v[80:83], v[10:11], v[70:71], v[80:83]
    v_mfma_f32_4x4x4_16b_bf16 v[76:79], v[10:11], v[68:69], v[76:79]
    v_and_b32 v46, 0x40000000, v39
    v_bitop3_b32 v94, v36, v5, v46 bitop3:0xea
    v_and_b32 v46, 0x80000000, v39
    v_bitop3_b32 v95, v37, v5, v46 bitop3:0xea
    v_perm_b32 v15, v37, v38, s47
    v_bitop3_b32 v46, v37, 0.5, -0.5 bitop3:0xa8
    v_perm_b32 v14, v36, v38, s46
    v_bitop3_b32 v47, v36, 0.5, -0.5 bitop3:0xa8
    v_cvt_pk_bf16_f32 v80, v80, v81
    v_cvt_pk_bf16_f32 v81, v82, v83
    ds_wrxchg_rtn_b64 v[74:75], v93, v[80:81]
    v_cvt_pk_bf16_f32 v76, v76, v77
    v_cvt_pk_bf16_f32 v77, v78, v79
    ds_wrxchg_rtn_b64 v[72:73], v92, v[76:77]
    s_setprio 0
    v_mfma_f32_4x4x4_16b_bf16 v[80:83], v[8:9], v[106:107], 0
    v_mfma_f32_4x4x4_16b_bf16 v[76:79], v[8:9], v[104:105], 0
    v_bitop3_b32 v15, v6, v15, v46 bitop3:0xca
    v_bitop3_b32 v14, v6, v14, v47 bitop3:0xca
    s_nop 1
    v_pk_mul_f32 v[80:81], v[80:81], v[14:15] op_sel:[0,1] op_sel_hi:[1,1]
    v_pk_mul_f32 v[82:83], v[82:83], v[14:15] op_sel:[0,1] op_sel_hi:[1,1]
    v_pk_mul_f32 v[76:77], v[76:77], v[14:15] op_sel:[0,0] op_sel_hi:[1,0]
    v_pk_mul_f32 v[78:79], v[78:79], v[14:15] op_sel:[0,0] op_sel_hi:[1,0]
    s_add_u32 s42, s42, 1
    s_waitcnt lgkmcnt(2)
    s_barrier
    s_bitcmp1_b32 s36, s42
    s_cbranch_scc1 L2_slow
L2_ret2:
    s_setprio 3
    v_and_b32 v47, 0x0fffffff, v44
    v_mov_b32 v39, v44
    buffer_load_dwordx4 v[34:37], v47, s[8:11], 0 offen
    buffer_load_dwordx3 v[36:38], v47, s[8:11], 0 offen offset:8
    s_waitcnt lgkmcnt(0)
    v_cmpx_ne_u64 vcc, v[74:75], v[70:71]
    s_and_b64 s[82:83], vcc, s[80:81]
    s_cbranch_scc1 L2_c41
L2_d41:
    v_mov_b64 v[84:85], v[70:71]
    v_mov_b32 v7, v93
    v_mov_b64 v[86:87], v[74:75]
    s_mov_b64 exec, -1
    s_or_b64 s[80:81], s[80:81], vcc
    v_cmpx_ne_u64 vcc, v[72:73], v[68:69]
    s_and_b64 s[82:83], vcc, s[80:81]
    s_cbranch_scc1 L2_c42
L2_d42:
    v_mov_b64 v[84:85], v[68:69]
    v_mov_b32 v7, v92
    v_mov_b64 v[86:87], v[72:73]
    s_mov_b64 exec, -1
    s_or_b64 s[80:81], s[80:81], vcc
    ds_read_b64 v[70:71], v95
    ds_read_b64 v[68:69], v94
    v_and_b32 v46, 0x20000000, v21
    v_lshrrev_b32 v47, 14, v17
    v_bitop3_b32 v47, v47, v5, v46 bitop3:0xea
    ds_read_b64 v[102:103], v47 offset:63616
    v_bitop3_b32 v93, v17, v5, v46 bitop3:0xea
    v_and_b32 v46, 0x10000000, v21
    v_lshrrev_b32 v47, 14, v16
    v_bitop3_b32 v47, v47, v5, v46 bitop3:0xea
    ds_read_b64 v[100:101], v47 offset:63616
    v_bitop3_b32 v92, v16, v5, v46 bitop3:0xea
    s_waitcnt lgkmcnt(2)
    v_mfma_f32_4x4x4_16b_bf16 v[80:83], v[10:11], v[70:71], v[80:83]
    v_mfma_f32_4x4x4_16b_bf16 v[76:79], v[10:11], v[68:69], v[76:79]
    v_perm_b32 v15, v17, v20, s45
    v_bitop3_b32 v46, v17, 0.5, -0.5 bitop3:0xa8
    v_perm_b32 v14, v16, v20, s44
    v_bitop3_b32 v47, v16, 0.5, -0.5 bitop3:0xa8
    v_cvt_pk_bf16_f32 v80, v80, v81
    v_cvt_pk_bf16_f32 v81, v82, v83
    ds_wrxchg_rtn_b64 v[74:75], v95, v[80:81]
    v_cvt_pk_bf16_f32 v76, v76, v77
    v_cvt_pk_bf16_f32 v77, v78, v79
    ds_wrxchg_rtn_b64 v[72:73], v94, v[76:77]
    s_waitcnt lgkmcnt(2)
    v_mfma_f32_4x4x4_16b_bf16 v[80:83], v[8:9], v[102:103], 0
    v_mfma_f32_4x4x4_16b_bf16 v[76:79], v[8:9], v[100:101], 0
    v_bitop3_b32 v15, v6, v15, v46 bitop3:0xca
    v_bitop3_b32 v14, v6, v14, v47 bitop3:0xca
    v_cmp_lt_u32 s[84:85], v5, v92
    s_nop 0
    v_pk_mul_f32 v[80:81], v[80:81], v[14:15] op_sel:[0,1] op_sel_hi:[1,1]
    v_pk_mul_f32 v[82:83], v[82:83], v[14:15] op_sel:[0,1] op_sel_hi:[1,1]
    v_pk_mul_f32 v[76:77], v[76:77], v[14:15] op_sel:[0,0] op_sel_hi:[1,0]
    v_pk_mul_f32 v[78:79], v[78:79], v[14:15] op_sel:[0,0] op_sel_hi:[1,0]
    buffer_load_dwordx4 v[108:111], v3, s[16:19], s40 offen offset:0
    s_waitcnt lgkmcnt(0)
    v_cmpx_ne_u64 vcc, v[74:75], v[70:71]
    s_and_b64 s[82:83], vcc, s[80:81]
    s_cbranch_scc1 L2_c43
L2_d43:
    v_mov_b64 v[84:85], v[70:71]
    v_mov_b32 v7, v95
    v_mov_b64 v[86:87], v[74:75]
    s_mov_b64 exec, -1
    s_or_b64 s[80:81], s[80:81], vcc
    v_cmpx_ne_u64 vcc, v[72:73], v[68:69]
    s_and_b64 s[82:83], vcc, s[80:81]
    s_cbranch_scc1 L2_c44
L2_d44:
    v_mov_b64 v[84:85], v[68:69]
    v_mov_b32 v7, v94
    v_mov_b64 v[86:87], v[72:73]
    s_mov_b64 exec, -1
    s_or_b64 s[80:81], s[80:81], vcc
    ds_read_b64 v[70:71], v93
    s_and_b64 exec, s[84:85], s[80:81]
    v_mfma_f32_4x4x4_16b_bf16 v[76:79], v[12:13], v[84:85], 0
    v_mov_b32 v92, v7
    s_andn2_b64 s[80:81], s[80:81], s[84:85]
    v_mfma_f32_4x4x4_16b_bf16 v[76:79], v[10:11], v[86:87], v[76:79]
    s_mov_b64 exec, -1
    ds_read_b64 v[68:69], v92
    v_and_b32 v46, 0x80000000, v21
    v_lshrrev_b32 v47, 14, v19
    v_bitop3_b32 v47, v47, v5, v46 bitop3:0xea
    ds_read_b64 v[106:107], v47 offset:63616
    v_bitop3_b32 v95, v19, v5, v46 bitop3:0xea
    v_and_b32 v46, 0x40000000, v21
    v_lshrrev_b32 v47, 14, v18
    v_bitop3_b32 v47, v47, v5, v46 bitop3:0xea
    ds_read_b64 v[104:105], v47 offset:63616
    v_bitop3_b32 v94, v18, v5, v46 bitop3:0xea
    s_waitcnt lgkmcnt(2)
    v_mfma_f32_4x4x4_16b_bf16 v[80:83], v[10:11], v[70:71], v[80:83]
    v_mfma_f32_4x4x4_16b_bf16 v[76:79], v[10:11], v[68:69], v[76:79]
    v_perm_b32 v15, v19, v20, s47
    v_bitop3_b32 v46, v19, 0.5, -0.5 bitop3:0xa8
    v_perm_b32 v14, v18, v20, s46
    v_bitop3_b32 v47, v18, 0.5, -0.5 bitop3:0xa8
    v_cvt_pk_bf16_f32 v80, v80, v81
    v_cvt_pk_bf16_f32 v81, v82, v83
    ds_wrxchg_rtn_b64 v[74:75], v93, v[80:81]
    v_cvt_pk_bf16_f32 v76, v76, v77
    v_cvt_pk_bf16_f32 v77, v78, v79
    ds_wrxchg_rtn_b64 v[72:73], v92, v[76:77]
    s_setprio 2
    s_waitcnt lgkmcnt(2)
    v_mfma_f32_4x4x4_16b_bf16 v[80:83], v[8:9], v[106:107], 0
    v_mfma_f32_4x4x4_16b_bf16 v[76:79], v[8:9], v[104:105], 0
    v_bitop3_b32 v15, v6, v15, v46 bitop3:0xca
    v_bitop3_b32 v14, v6, v14, v47 bitop3:0xca
    s_nop 1
    v_pk_mul_f32 v[80:81], v[80:81], v[14:15] op_sel:[0,1] op_sel_hi:[1,1]
    v_pk_mul_f32 v[82:83], v[82:83], v[14:15] op_sel:[0,1] op_sel_hi:[1,1]
    v_pk_mul_f32 v[76:77], v[76:77], v[14:15] op_sel:[0,0] op_sel_hi:[1,0]
    v_pk_mul_f32 v[78:79], v[78:79], v[14:15] op_sel:[0,0] op_sel_hi:[1,0]
    v_and_b32 v47, 0x0fffffff, v40
    v_mov_b32 v21, v40
    buffer_load_dwordx4 v[16:19], v47, s[8:11], 0 offen
    buffer_load_dwordx3 v[18:20], v47, s[8:11], 0 offen offset:8
    s_waitcnt lgkmcnt(0)
    v_cmpx_ne_u64 vcc, v[74:75], v[70:71]
    s_and_b64 s[82:83], vcc, s[80:81]
    s_cbranch_scc1 L2_c45
L2_d45:
    v_mov_b64 v[84:85], v[70:71]
    v_mov_b32 v7, v93
    v_mov_b64 v[86:87], v[74:75]
    s_mov_b64 exec, -1
    s_or_b64 s[80:81], s[80:81], vcc
    v_cmpx_ne_u64 vcc, v[72:73], v[68:69]
    s_and_b64 s[82:83], vcc, s[80:81]
    s_cbranch_scc1 L2_c46
L2_d46:
    v_mov_b64 v[84:85], v[68:69]
    v_mov_b32 v7, v92
    v_mov_b64 v[86:87], v[72:73]
    s_mov_b64 exec, -1
    s_or_b64 s[80:81], s[80:81], vcc
    ds_read_b64 v[70:71], v95
    ds_read_b64 v[68:69], v94
    s_waitcnt vmcnt(10)
    v_and_b32 v46, 0x20000000, v27
    v_lshrrev_b32 v47, 14, v23
    v_bitop3_b32 v47, v47, v5, v46 bitop3:0xea
    ds_read_b64 v[102:103], v47 offset:63616
    v_bitop3_b32 v93, v23, v5, v46 bitop3:0xea
    v_and_b32 v46, 0x10000000, v27
    v_lshrrev_b32 v47, 14, v22
    v_bitop3_b32 v47, v47, v5, v46 bitop3:0xea
    ds_read_b64 v[100:101], v47 offset:63616
    v_bitop3_b32 v92, v22, v5, v46 bitop3:0xea
    s_waitcnt lgkmcnt(2)
    v_mfma_f32_4x4x4_16b_bf16 v[80:83], v[10:11], v[70:71], v[80:83]
    v_mfma_f32_4x4x4_16b_bf16 v[76:79], v[10:11], v[68:69], v[76:79]
    v_perm_b32 v15, v23, v26, s45
    v_bitop3_b32 v46, v23, 0.5, -0.5 bitop3:0xa8
    v_perm_b32 v14, v22, v26, s44
    v_bitop3_b32 v47, v22, 0.5, -0.5 bitop3:0xa8
    v_cvt_pk_bf16_f32 v80, v80, v81
    v_cvt_pk_bf16_f32 v81, v82, v83
    ds_wrxchg_rtn_b64 v[74:75], v95, v[80:81]
    v_cvt_pk_bf16_f32 v76, v76, v77
    v_cvt_pk_bf16_f32 v77, v78, v79
    ds_wrxchg_rtn_b64 v[72:73], v94, v[76:77]
    s_waitcnt lgkmcnt(2)
    v_mfma_f32_4x4x4_16b_bf16 v[80:83], v[8:9], v[102:103], 0
    v_mfma_f32_4x4x4_16b_bf16 v[76:79], v[8:9], v[100:101], 0
    v_bitop3_b32 v15, v6, v15, v46 bitop3:0xca
    v_bitop3_b32 v14, v6, v14, v47 bitop3:0xca
    v_cmp_lt_u32 s[84:85], v5, v92
    s_nop 0
    v_pk_mul_f32 v[80:81], v[80:81], v[14:15] op_sel:[0,1] op_sel_hi:[1,1]
    v_pk_mul_f32 v[82:83], v[82:83], v[14:15] op_sel:[0,1] op_sel_hi:[1,1]
    v_pk_mul_f32 v[76:77], v[76:77], v[14:15] op_sel:[0,0] op_sel_hi:[1,0]
    v_pk_mul_f32 v[78:79], v[78:79], v[14:15] op_sel:[0,0] op_sel_hi:[1,0]
    v_sub_u16 v88, v56, v48
    v_and_b32 v89, 3, v48
    v_add3_u32 v99, v88, v89, 3
    v_and_b32 v99, -4, v99
    v_max_u32 v99, 4, v99
    v_and_b32 v97, 0xfffc, v48
    v_bfm_b32 v96, v88, v89
    v_add_u32_dpp v91, v99, v99 row_shr:1 row_mask:0xf bank_mask:0xf bound_ctrl:1
    v_mad_u32_u24 v97, v97, 5, v2
    v_cmp_lt_u32 vcc, 16, v99
    v_add_u32_dpp v91, v91, v91 row_shr:2 row_mask:0xf bank_mask:0xf bound_ctrl:1
    v_sub_u32 v98, s38, v99
    v_lshrrev_b64 v[48:49], 16, v[48:49]
    v_add_u32_dpp v91, v91, v91 row_shr:4 row_mask:0xf bank_mask:0xf bound_ctrl:1
    v_lshrrev_b64 v[56:57], 16, v[56:57]
    s_mov_b32 s43, 0
    v_add_u32_dpp v91, v91, v91 row_shr:8 row_mask:0xf bank_mask:0xf bound_ctrl:1
    s_nop 1
    v_add_u32_dpp v91, v91, v91 row_bcast:15 row_mask:0xa bank_mask:0xf
    s_nop 1
    v_add_u32_dpp v91, v91, v91 row_bcast:31 row_mask:0xc bank_mask:0xf
    v_add_u32 v98, v98, v91
    v_readlane_b32 s37, v91, 63
    s_cbranch_vccnz L2_xo47
L2_xp47:
    buffer_load_dwordx4 v[112:115], v3, s[16:19], s40 offen offset:1024
    s_waitcnt lgkmcnt(0)
    v_cmpx_ne_u64 vcc, v[74:75], v[70:71]
    s_and_b64 s[82:83], vcc, s[80:81]
    s_cbranch_scc1 L2_c48
L2_d48:
    v_mov_b64 v[84:85], v[70:71]
    v_mov_b32 v7, v95
    v_mov_b64 v[86:87], v[74:75]
    s_mov_b64 exec, -1
    s_or_b64 s[80:81], s[80:81], vcc
    v_cmpx_ne_u64 vcc, v[72:73], v[68:69]
    s_and_b64 s[82:83], vcc, s[80:81]
    s_cbranch_scc1 L2_c49
L2_d49:
    v_mov_b64 v[84:85], v[68:69]
    v_mov_b32 v7, v94
    v_mov_b64 v[86:87], v[72:73]
    s_mov_b64 exec, -1
    s_or_b64 s[80:81], s[80:81], vcc
    ds_read_b64 v[70:71], v93
    s_and_b64 exec, s[84:85], s[80:81]
    v_mfma_f32_4x4x4_16b_bf16 v[76:79], v[12:13], v[84:85], 0
    v_mov_b32 v92, v7
    s_andn2_b64 s[80:81], s[80:81], s[84:85]
    v_mfma_f32_4x4x4_16b_bf16 v[76:79], v[10:11], v[86:87], v[76:79]
    s_mov_b64 exec, -1
    ds_read_b64 v[68:69], v92
    v_and_b32 v46, 0x80000000, v27
    v_lshrrev_b32 v47, 14, v25
    v_bitop3_b32 v47, v47, v5, v46 bitop3:0xea
    ds_read_b64 v[106:107], v47 offset:63616
    v_bitop3_b32 v95, v25, v5, v46 bitop3:0xea
    v_and_b32 v46, 0x40000000, v27
    v_lshrrev_b32 v47, 14, v24
    v_bitop3_b32 v47, v47, v5, v46 bitop3:0xea
    ds_read_b64 v[104:105], v47 offset:63616
    v_bitop3_b32 v94, v24, v5, v46 bitop3:0xea
    s_waitcnt lgkmcnt(2)
    v_mfma_f32_4x4x4_16b_bf16 v[80:83], v[10:11], v[70:71], v[80:83]
    v_mfma_f32_4x4x4_16b_bf16 v[76:79], v[10:11], v[68:69], v[76:79]
    v_perm_b32 v15, v25, v26, s47
    v_bitop3_b32 v46, v25, 0.5, -0.5 bitop3:0xa8
    v_perm_b32 v14, v24, v26, s46
    v_bitop3_b32 v47, v24, 0.5, -0.5 bitop3:0xa8
    v_cvt_pk_bf16_f32 v80, v80, v81
    v_cvt_pk_bf16_f32 v81, v82, v83
    ds_wrxchg_rtn_b64 v[74:75], v93, v[80:81]
    v_cvt_pk_bf16_f32 v76, v76, v77
    v_cvt_pk_bf16_f32 v77, v78, v79
    ds_wrxchg_rtn_b64 v[72:73], v92, v[76:77]
    s_setprio 1
    s_waitcnt lgkmcnt(2)
    v_mfma_f32_4x4x4_16b_bf16 v[80:83], v[8:9], v[106:107], 0
    v_mfma_f32_4x4x4_16b_bf16 v[76:79], v[8:9], v[104:105], 0
    v_bitop3_b32 v15, v6, v15, v46 bitop3:0xca
    v_bitop3_b32 v14, v6, v14, v47 bitop3:0xca
    s_nop 1
    v_pk_mul_f32 v[80:81], v[80:81], v[14:15] op_sel:[0,1] op_sel_hi:[1,1]
    v_pk_mul_f32 v[82:83], v[82:83], v[14:15] op_sel:[0,1] op_sel_hi:[1,1]
    v_pk_mul_f32 v[76:77], v[76:77], v[14:15] op_sel:[0,0] op_sel_hi:[1,0]
    v_pk_mul_f32 v[78:79], v[78:79], v[14:15] op_sel:[0,0] op_sel_hi:[1,0]
    v_and_b32 v47, 0x0fffffff, v41
    v_mov_b32 v27, v41
    buffer_load_dwordx4 v[22:25], v47, s[8:11], 0 offen
    buffer_load_dwordx3 v[24:26], v47, s[8:11], 0 offen offset:8
    s_waitcnt lgkmcnt(0)
    v_cmpx_ne_u64 vcc, v[74:75], v[70:71]
    s_and_b64 s[82:83], vcc, s[80:81]
    s_cbranch_scc1 L2_c50
L2_d50:
    v_mov_b64 v[84:85], v[70:71]
    v_mov_b32 v7, v93
    v_mov_b64 v[86:87], v[74:75]
    s_mov_b64 exec, -1
    s_or_b64 s[80:81], s[80:81], vcc
    v_cmpx_ne_u64 vcc, v[72:73], v[68:69]
    s_and_b64 s[82:83], vcc, s[80:81]
    s_cbranch_scc1 L2_c51
L2_d51:
    v_mov_b64 v[84:85], v[68:69]
    v_mov_b32 v7, v92
    v_mov_b64 v[86:87], v[72:73]
    s_mov_b64 exec, -1
    s_or_b64 s[80:81], s[80:81], vcc
    ds_read_b64 v[70:71], v95
    ds_read_b64 v[68:69], v94
    s_waitcnt vmcnt(11)
    v_and_b32 v46, 0x20000000, v33
    v_lshrrev_b32 v47, 14, v29
    v_bitop3_b32 v47, v47, v5, v46 bitop3:0xea
    ds_read_b64 v[102:103], v47 offset:63616
    v_bitop3_b32 v93, v29, v5, v46 bitop3:0xea
    v_and_b32 v46, 0x10000000, v33
    v_lshrrev_b32 v47, 14, v28
    v_bitop3_b32 v47, v47, v5, v46 bitop3:0xea
    ds_read_b64 v[100:101], v47 offset:63616
    v_bitop3_b32 v92, v28, v5, v46 bitop3:0xea
    s_waitcnt lgkmcnt(2)
    v_mfma_f32_4x4x4_16b_bf16 v[80:83], v[10:11], v[70:71], v[80:83]
    v_mfma_f32_4x4x4_16b_bf16 v[76:79], v[10:11], v[68:69], v[76:79]
    v_perm_b32 v15, v29, v32, s45
    v_bitop3_b32 v46, v29, 0.5, -0.5 bitop3:0xa8
    v_perm_b32 v14, v28, v32, s44
    v_bitop3_b32 v47, v28, 0.5, -0.5 bitop3:0xa8
    v_cvt_pk_bf16_f32 v80, v80, v81
    v_cvt_pk_bf16_f32 v81, v82, v83
    ds_wrxchg_rtn_b64 v[74:75], v95, v[80:81]
    v_cvt_pk_bf16_f32 v76, v76, v77
    v_cvt_pk_bf16_f32 v77, v78, v79
    ds_wrxchg_rtn_b64 v[72:73], v94, v[76:77]
    s_waitcnt lgkmcnt(2)
    v_mfma_f32_4x4x4_16b_bf16 v[80:83], v[8:9], v[102:103], 0
    v_mfma_f32_4x4x4_16b_bf16 v[76:79], v[8:9], v[100:101], 0
    v_bitop3_b32 v15, v6, v15, v46 bitop3:0xca
    v_bitop3_b32 v14, v6, v14, v47 bitop3:0xca
    v_cmp_lt_u32 s[84:85], v5, v92
    s_nop 0
    v_pk_mul_f32 v[80:81], v[80:81], v[14:15] op_sel:[0,1] op_sel_hi:[1,1]
    v_pk_mul_f32 v[82:83], v[82:83], v[14:15] op_sel:[0,1] op_sel_hi:[1,1]
    v_pk_mul_f32 v[76:77], v[76:77], v[14:15] op_sel:[0,0] op_sel_hi:[1,0]
    v_pk_mul_f32 v[78:79], v[78:79], v[14:15] op_sel:[0,0] op_sel_hi:[1,0]
    s_waitcnt lgkmcnt(0)
    v_cmpx_ne_u64 vcc, v[74:75], v[70:71]
    s_and_b64 s[82:83], vcc, s[80:81]
    s_cbranch_scc1 L2_c52
L2_d52:
    v_mov_b64 v[84:85], v[70:71]
    v_mov_b32 v7, v95
    v_mov_b64 v[86:87], v[74:75]
    s_mov_b64 exec, -1
    s_or_b64 s[80:81], s[80:81], vcc
    v_cmpx_ne_u64 vcc, v[72:73], v[68:69]
    s_and_b64 s[82:83], vcc, s[80:81]
    s_cbranch_scc1 L2_c53
L2_d53:
    v_mov_b64 v[84:85], v[68:69]
    v_mov_b32 v7, v94
    v_mov_b64 v[86:87], v[72:73]
    s_mov_b64 exec, -1
    s_or_b64 s[80:81], s[80:81], vcc
    ds_read_b64 v[70:71], v93
    s_and_b64 exec, s[84:85], s[80:81]
    v_mfma_f32_4x4x4_16b_bf16 v[76:79], v[12:13], v[84:85], 0
    v_mov_b32 v92, v7
    s_andn2_b64 s[80:81], s[80:81], s[84:85]
    v_mfma_f32_4x4x4_16b_bf16 v[76:79], v[10:11], v[86:87], v[76:79]
    s_mov_b64 exec, -1
    ds_read_b64 v[68:69], v92
    v_and_b32 v46, 0x80000000, v33
    v_lshrrev_b32 v47, 14, v31
    v_bitop3_b32 v47, v47, v5, v46 bitop3:0xea
    ds_read_b64 v[106:107], v47 offset:63616
    v_bitop3_b32 v95, v31, v5, v46 bitop3:0xea
    v_and_b32 v46, 0x40000000, v33
    v_lshrrev_b32 v47, 14, v30
    v_bitop3_b32 v47, v47, v5, v46 bitop3:0xea
    ds_read_b64 v[104:105], v47 offset:63616
    v_bitop3_b32 v94, v30, v5, v46 bitop3:0xea
    s_waitcnt lgkmcnt(2)
    v_mfma_f32_4x4x4_16b_bf16 v[80:83], v[10:11], v[70:71], v[80:83]
    v_mfma_f32_4x4x4_16b_bf16 v[76:79], v[10:11], v[68:69], v[76:79]
    v_perm_b32 v15, v31, v32, s47
    v_bitop3_b32 v46, v31, 0.5, -0.5 bitop3:0xa8
    v_perm_b32 v14, v30, v32, s46
    v_bitop3_b32 v47, v30, 0.5, -0.5 bitop3:0xa8
    v_cvt_pk_bf16_f32 v80, v80, v81
    v_cvt_pk_bf16_f32 v81, v82, v83
    ds_wrxchg_rtn_b64 v[74:75], v93, v[80:81]
    v_cvt_pk_bf16_f32 v76, v76, v77
    v_cvt_pk_bf16_f32 v77, v78, v79
    ds_wrxchg_rtn_b64 v[72:73], v92, v[76:77]
    s_setprio 0
    s_waitcnt lgkmcnt(2)
    v_mfma_f32_4x4x4_16b_bf16 v[80:83], v[8:9], v[106:107], 0
    v_mfma_f32_4x4x4_16b_bf16 v[76:79], v[8:9], v[104:105], 0
    v_bitop3_b32 v15, v6, v15, v46 bitop3:0xca
    v_bitop3_b32 v14, v6, v14, v47 bitop3:0xca
    s_nop 1
    v_pk_mul_f32 v[80:81], v[80:81], v[14:15] op_sel:[0,1] op_sel_hi:[1,1]
    v_pk_mul_f32 v[82:83], v[82:83], v[14:15] op_sel:[0,1] op_sel_hi:[1,1]
    v_pk_mul_f32 v[76:77], v[76:77], v[14:15] op_sel:[0,0] op_sel_hi:[1,0]
    v_pk_mul_f32 v[78:79], v[78:79], v[14:15] op_sel:[0,0] op_sel_hi:[1,0]
    s_add_u32 s40, s40, 0xfff29280
    v_and_b32 v47, 0x0fffffff, v42
    v_mov_b32 v33, v42
    buffer_load_dwordx4 v[28:31], v47, s[8:11], 0 offen
    buffer_load_dwordx3 v[30:32], v47, s[8:11], 0 offen offset:8
    s_waitcnt lgkmcnt(0)
    v_cmpx_ne_u64 vcc, v[74:75], v[70:71]
    s_and_b64 s[82:83], vcc, s[80:81]
    s_cbranch_scc1 L2_c54
L2_d54:
    v_mov_b64 v[84:85], v[70:71]
    v_mov_b32 v7, v93
    v_mov_b64 v[86:87], v[74:75]
    s_mov_b64 exec, -1
    s_or_b64 s[80:81], s[80:81], vcc
    v_cmpx_ne_u64 vcc, v[72:73], v[68:69]
    s_and_b64 s[82:83], vcc, s[80:81]
    s_cbranch_scc1 L2_c55
L2_d55:
    v_mov_b64 v[84:85], v[68:69]
    v_mov_b32 v7, v92
    v_mov_b64 v[86:87], v[72:73]
    s_mov_b64 exec, -1
    s_or_b64 s[80:81], s[80:81], vcc
    ds_read_b64 v[70:71], v95
    ds_read_b64 v[68:69], v94
    s_waitcnt vmcnt(8)
    v_and_b32 v46, 0x20000000, v39
    v_lshrrev_b32 v47, 14, v35
    v_bitop3_b32 v47, v47, v5, v46 bitop3:0xea
    ds_read_b64 v[102:103], v47 offset:63616
    v_bitop3_b32 v93, v35, v5, v46 bitop3:0xea
    v_and_b32 v46, 0x10000000, v39
    v_lshrrev_b32 v47, 14, v34
    v_bitop3_b32 v47, v47, v5, v46 bitop3:0xea
    ds_read_b64 v[100:101], v47 offset:63616
    v_bitop3_b32 v92, v34, v5, v46 bitop3:0xea
    v_and_b32 v46, 0x80000000, v39
    v_lshrrev_b32 v47, 14, v37
    v_bitop3_b32 v47, v47, v5, v46 bitop3:0xea
    ds_read_b64 v[106:107], v47 offset:63616
    v_and_b32 v46, 0x40000000, v39
    v_lshrrev_b32 v47, 14, v36
    v_bitop3_b32 v47, v47, v5, v46 bitop3:0xea
    ds_read_b64 v[104:105], v47 offset:63616
    s_waitcnt lgkmcnt(4)
    v_mfma_f32_4x4x4_16b_bf16 v[80:83], v[10:11], v[70:71], v[80:83]
    v_mfma_f32_4x4x4_16b_bf16 v[76:79], v[10:11], v[68:69], v[76:79]
    v_perm_b32 v15, v35, v38, s45
    v_bitop3_b32 v46, v35, 0.5, -0.5 bitop3:0xa8
    v_perm_b32 v14, v34, v38, s44
    v_bitop3_b32 v47, v34, 0.5, -0.5 bitop3:0xa8
    v_cvt_pk_bf16_f32 v80, v80, v81
    v_cvt_pk_bf16_f32 v81, v82, v83
    ds_wrxchg_rtn_b64 v[74:75], v95, v[80:81]
    v_cvt_pk_bf16_f32 v76, v76, v77
    v_cvt_pk_bf16_f32 v77, v78, v79
    ds_wrxchg_rtn_b64 v[72:73], v94, v[76:77]
    s_waitcnt lgkmcnt(2)
    s_barrier
    s_setprio 3
    ds_write_b128 v3, v[124:127] offset:4096
    s_add_u32 s3, s40, 4096
    buffer_load_dwordx4 v[124:127], v3, s[16:19], s3 offen
    ds_write_b128 v3, v[116:119] offset:2048
    buffer_load_dwordx4 v[116:119], v3, s[16:19], s40 offen offset:2048
    ds_write_b128 v3, v[120:123] offset:3072
    buffer_load_dwordx4 v[120:123], v3, s[16:19], s40 offen offset:3072
    v_mfma_f32_4x4x4_16b_bf16 v[80:83], v[8:9], v[102:103], 0
    v_mfma_f32_4x4x4_16b_bf16 v[76:79], v[8:9], v[100:101], 0
    v_bitop3_b32 v15, v6, v15, v46 bitop3:0xca
    v_bitop3_b32 v14, v6, v14, v47 bitop3:0xca
    v_cmp_lt_u32 s[84:85], v5, v92
    s_nop 0
    v_pk_mul_f32 v[80:81], v[80:81], v[14:15] op_sel:[0,1] op_sel_hi:[1,1]
    v_pk_mul_f32 v[82:83], v[82:83], v[14:15] op_sel:[0,1] op_sel_hi:[1,1]
    v_pk_mul_f32 v[76:77], v[76:77], v[14:15] op_sel:[0,0] op_sel_hi:[1,0]
    v_pk_mul_f32 v[78:79], v[78:79], v[14:15] op_sel:[0,0] op_sel_hi:[1,0]
    v_mov_b32 v44, v43
    s_cmp_gt_u32 s37, 1024
    s_cbranch_scc1 L2_xs56
    s_cmp_lg_u32 s43, 0
    s_cbranch_scc1 L2_xa56
L2_xb56:
    v_lshlrev_b32 v89, 16, v96
    v_add_u32 v90, 60, v97
    v_bitop3_b32 v90, v89, v45, v90 bitop3:0x6a
    ds_write_b32 v98, v90 offset:12
    v_lshlrev_b32 v89, 20, v96
    v_add_u32 v90, 40, v97
    v_bitop3_b32 v90, v89, v45, v90 bitop3:0x6a
    ds_write_b32 v98, v90 offset:8
    v_lshlrev_b32 v89, 24, v96
    v_add_u32 v90, 20, v97
    v_bitop3_b32 v90, v89, v45, v90 bitop3:0x6a
    ds_write_b32 v98, v90 offset:4
    v_lshlrev_b32 v89, 28, v96
    v_bitop3_b32 v90, v89, v45, v97 bitop3:0x6a
    ds_write_b32 v98, v90 offset:0
    v_mov_b32_dpp v91, v64 quad_perm:[0,0,0,0] row_mask:0xf bank_mask:0xf
    v_and_b32 v89, 3, v91
    v_and_b32 v97, 0xfffc, v91
    v_sub_u16_dpp v88, v64, v91 quad_perm:[2,2,2,2] row_mask:0xf bank_mask:0xf
    v_mad_u32_u24 v97, v97, 5, v4
    v_add_u32 v99, v88, v89
    v_bfm_b32 v96, v88, v89
    v_cmp_lt_u32 s[58:59], 16, v99
    v_lshlrev_b32 v89, v1, v96
    v_and_b32 v89, v45, v89
    v_cmp_ne_u32 vcc, 0, v89
    v_xor_b32 v90, v97, v89
    s_add_u32 s3, s37, s38
    v_mbcnt_lo_u32_b32 v98, vcc_lo, 0
    v_mbcnt_hi_u32_b32 v98, vcc_hi, v98
    s_bcnt1_i32_b64 s41, vcc
    v_lshl_add_u32 v98, v98, 2, s3
    s_mov_b64 exec, vcc
    ds_write_b32 v98, v90
    s_mov_b64 exec, -1
    s_lshl2_add_u32 s37, s41, s37
    s_cmp_lg_u64 s[58:59], 0
    s_cbranch_scc1 L2_xe56
L2_xr56:
    v_add_u32 v98, s37, v0
    v_mov_b32 v90, -1
    ds_write_b32 v98, v90
    ds_read2st64_b32 v[40:41], v0 offset0:0 offset1:1
    ds_read2st64_b32 v[42:43], v0 offset0:2 offset1:3
    s_sub_u32 s3, s37, 768
    s_cmp_gt_u32 s3, 256
    s_cbranch_scc1 L2_xf56
L2_xg56:
    s_setprio 2
    s_waitcnt vmcnt(10)
    ds_write_b128 v3, v[108:111] offset:0
    s_waitcnt lgkmcnt(12)
    v_cmpx_ne_u64 vcc, v[74:75], v[70:71]
    s_and_b64 s[82:83], vcc, s[80:81]
    s_cbranch_scc1 L2_c57
L2_d57:
    v_mov_b64 v[84:85], v[70:71]
    v_mov_b32 v7, v95
    v_mov_b64 v[86:87], v[74:75]
    s_mov_b64 exec, -1
    s_or_b64 s[80:81], s[80:81], vcc
    v_cmpx_ne_u64 vcc, v[72:73], v[68:69]
    s_and_b64 s[82:83], vcc, s[80:81]
    s_cbranch_scc1 L2_c58
L2_d58:
    v_mov_b64 v[84:85], v[68:69]
    v_mov_b32 v7, v94
    v_mov_b64 v[86:87], v[72:73]
    s_mov_b64 exec, -1
    s_or_b64 s[80:81], s[80:81], vcc
    ds_read_b64 v[70:71], v93
    s_and_b64 exec, s[84:85], s[80:81]
    v_mfma_f32_4x4x4_16b_bf16 v[76:79], v[12:13], v[84:85], 0
    v_mov_b32 v92, v7
    s_andn2_b64 s[80:81], s[80:81], s[84:85]
    v_mfma_f32_4x4x4_16b_bf16 v[76:79], v[10:11], v[86:87], v[76:79]
    s_mov_b64 exec, -1
    ds_read_b64 v[68:69], v92
    s_setprio 1
    s_waitcnt vmcnt(7)
    ds_write_b128 v3, v[112:115] offset:1024
    s_waitcnt lgkmcnt(1)
    v_mfma_f32_4x4x4_16b_bf16 v[80:83], v[10:11], v[70:71], v[80:83]
    v_mfma_f32_4x4x4_16b_bf16 v[76:79], v[10:11], v[68:69], v[76:79]
    v_and_b32 v46, 0x40000000, v39
    v_bitop3_b32 v94, v36, v5, v46 bitop3:0xea
    v_and_b32 v46, 0x80000000, v39
    v_bitop3_b32 v95, v37, v5, v46 bitop3:0xea
    v_perm_b32 v15, v37, v38, s47
    v_bitop3_b32 v46, v37, 0.5, -0.5 bitop3:0xa8
    v_perm_b32 v14, v36, v38, s46
    v_bitop3_b32 v47, v36, 0.5, -0.5 bitop3:0xa8
    v_cvt_pk_bf16_f32 v80, v80, v81
    v_cvt_pk_bf16_f32 v81, v82, v83
    ds_wrxchg_rtn_b64 v[74:75], v93, v[80:81]
    v_cvt_pk_bf16_f32 v76, v76, v77
    v_cvt_pk_bf16_f32 v77, v78, v79
    ds_wrxchg_rtn_b64 v[72:73], v92, v[76:77]
    s_setprio 0
    v_mfma_f32_4x4x4_16b_bf16 v[80:83], v[8:9], v[106:107], 0
    v_mfma_f32_4x4x4_16b_bf16 v[76:79], v[8:9], v[104:105], 0
    v_bitop3_b32 v15, v6, v15, v46 bitop3:0xca
    v_bitop3_b32 v14, v6, v14, v47 bitop3:0xca
    s_nop 1
    v_pk_mul_f32 v[80:81], v[80:81], v[14:15] op_sel:[0,1] op_sel_hi:[1,1]
    v_pk_mul_f32 v[82:83], v[82:83], v[14:15] op_sel:[0,1] op_sel_hi:[1,1]
    v_pk_mul_f32 v[76:77], v[76:77], v[14:15] op_sel:[0,0] op_sel_hi:[1,0]
    v_pk_mul_f32 v[78:79], v[78:79], v[14:15] op_sel:[0,0] op_sel_hi:[1,0]
    s_add_u32 s42, s42, 1
    s_waitcnt lgkmcnt(2)
    s_barrier
    s_bitcmp1_b32 s36, s42
    s_cbranch_scc1 L2_slow
L2_ret3:
    s_setprio 3
    v_and_b32 v47, 0x0fffffff, v44
    v_mov_b32 v39, v44
    buffer_load_dwordx4 v[34:37], v47, s[8:11], 0 offen
    buffer_load_dwordx3 v[36:38], v47, s[8:11], 0 offen offset:8
    s_waitcnt lgkmcnt(0)
    v_cmpx_ne_u64 vcc, v[74:75], v[70:71]
    s_and_b64 s[82:83], vcc, s[80:81]
    s_cbranch_scc1 L2_c59
L2_d59:
    v_mov_b64 v[84:85], v[70:71]
    v_mov_b32 v7, v93
    v_mov_b64 v[86:87], v[74:75]
    s_mov_b64 exec, -1
    s_or_b64 s[80:81], s[80:81], vcc
    v_cmpx_ne_u64 vcc, v[72:73], v[68:69]
    s_and_b64 s[82:83], vcc, s[80:81]
    s_cbranch_scc1 L2_c60
L2_d60:
    v_mov_b64 v[84:85], v[68:69]
    v_mov_b32 v7, v92
    v_mov_b64 v[86:87], v[72:73]
    s_mov_b64 exec, -1
    s_or_b64 s[80:81], s[80:81], vcc
    ds_read_b64 v[70:71], v95
    ds_read_b64 v[68:69], v94
    v_and_b32 v46, 0x20000000, v21
    v_lshrrev_b32 v47, 14, v17
    v_bitop3_b32 v47, v47, v5, v46 bitop3:0xea
    ds_read_b64 v[102:103], v47 offset:63616
    v_bitop3_b32 v93, v17, v5, v46 bitop3:0xea
    v_and_b32 v46, 0x10000000, v21
    v_lshrrev_b32 v47, 14, v16
    v_bitop3_b32 v47, v47, v5, v46 bitop3:0xea
    ds_read_b64 v[100:101], v47 offset:63616
    v_bitop3_b32 v92, v16, v5, v46 bitop3:0xea
    s_waitcnt lgkmcnt(2)
    v_mfma_f32_4x4x4_16b_bf16 v[80:83], v[10:11], v[70:71], v[80:83]
    v_mfma_f32_4x4x4_16b_bf16 v[76:79], v[10:11], v[68:69], v[76:79]
    v_perm_b32 v15, v17, v20, s45
    v_bitop3_b32 v46, v17, 0.5, -0.5 bitop3:0xa8
    v_perm_b32 v14, v16, v20, s44
    v_bitop3_b32 v47, v16, 0.5, -0.5 bitop3:0xa8
    v_cvt_pk_bf16_f32 v80, v80, v81
    v_cvt_pk_bf16_f32 v81, v82, v83
    ds_wrxchg_rtn_b64 v[74:75], v95, v[80:81]
    v_cvt_pk_bf16_f32 v76, v76, v77
    v_cvt_pk_bf16_f32 v77, v78, v79
    ds_wrxchg_rtn_b64 v[72:73], v94, v[76:77]
    s_waitcnt lgkmcnt(2)
    v_mfma_f32_4x4x4_16b_bf16 v[80:83], v[8:9], v[102:103], 0
    v_mfma_f32_4x4x4_16b_bf16 v[76:79], v[8:9], v[100:101], 0
    v_bitop3_b32 v15, v6, v15, v46 bitop3:0xca
    v_bitop3_b32 v14, v6, v14, v47 bitop3:0xca
    v_cmp_lt_u32 s[84:85], v5, v92
    s_nop 0
    v_pk_mul_f32 v[80:81], v[80:81], v[14:15] op_sel:[0,1] op_sel_hi:[1,1]
    v_pk_mul_f32 v[82:83], v[82:83], v[14:15] op_sel:[0,1] op_sel_hi:[1,1]
    v_pk_mul_f32 v[76:77], v[76:77], v[14:15] op_sel:[0,0] op_sel_hi:[1,0]
    v_pk_mul_f32 v[78:79], v[78:79], v[14:15] op_sel:[0,0] op_sel_hi:[1,0]
    buffer_load_dwordx4 v[108:111], v3, s[16:19], s40 offen offset:0
    s_waitcnt lgkmcnt(0)
    v_cmpx_ne_u64 vcc, v[74:75], v[70:71]
    s_and_b64 s[82:83], vcc, s[80:81]
    s_cbranch_scc1 L2_c61
L2_d61:
    v_mov_b64 v[84:85], v[70:71]
    v_mov_b32 v7, v95
    v_mov_b64 v[86:87], v[74:75]
    s_mov_b64 exec, -1
    s_or_b64 s[80:81], s[80:81], vcc
    v_cmpx_ne_u64 vcc, v[72:73], v[68:69]
    s_and_b64 s[82:83], vcc, s[80:81]
    s_cbranch_scc1 L2_c62
L2_d62:
    v_mov_b64 v[84:85], v[68:69]
    v_mov_b32 v7, v94
    v_mov_b64 v[86:87], v[72:73]
    s_mov_b64 exec, -1
    s_or_b64 s[80:81], s[80:81], vcc
    ds_read_b64 v[70:71], v93
    s_and_b64 exec, s[84:85], s[80:81]
    v_mfma_f32_4x4x4_16b_bf16 v[76:79], v[12:13], v[84:85], 0
    v_mov_b32 v92, v7
    s_andn2_b64 s[80:81], s[80:81], s[84:85]
    v_mfma_f32_4x4x4_16b_bf16 v[76:79], v[10:11], v[86:87], v[76:79]
    s_mov_b64 exec, -1
    ds_read_b64 v[68:69], v92
    v_and_b32 v46, 0x80000000, v21
    v_lshrrev_b32 v47, 14, v19
    v_bitop3_b32 v47, v47, v5, v46 bitop3:0xea
    ds_read_b64 v[106:107], v47 offset:63616
    v_bitop3_b32 v95, v19, v5, v46 bitop3:0xea
    v_and_b32 v46, 0x40000000, v21
    v_lshrrev_b32 v47, 14, v18
    v_bitop3_b32 v47, v47, v5, v46 bitop3:0xea
    ds_read_b64 v[104:105], v47 offset:63616
    v_bitop3_b32 v94, v18, v5, v46 bitop3:0xea
    s_waitcnt lgkmcnt(2)
    v_mfma_f32_4x4x4_16b_bf16 v[80:83], v[10:11], v[70:71], v[80:83]
    v_mfma_f32_4x4x4_16b_bf16 v[76:79], v[10:11], v[68:69], v[76:79]
    v_perm_b32 v15, v19, v20, s47
    v_bitop3_b32 v46, v19, 0.5, -0.5 bitop3:0xa8
    v_perm_b32 v14, v18, v20, s46
    v_bitop3_b32 v47, v18, 0.5, -0.5 bitop3:0xa8
    v_cvt_pk_bf16_f32 v80, v80, v81
    v_cvt_pk_bf16_f32 v81, v82, v83
    ds_wrxchg_rtn_b64 v[74:75], v93, v[80:81]
    v_cvt_pk_bf16_f32 v76, v76, v77
    v_cvt_pk_bf16_f32 v77, v78, v79
    ds_wrxchg_rtn_b64 v[72:73], v92, v[76:77]
    s_setprio 2
    s_waitcnt lgkmcnt(2)
    v_mfma_f32_4x4x4_16b_bf16 v[80:83], v[8:9], v[106:107], 0
    v_mfma_f32_4x4x4_16b_bf16 v[76:79], v[8:9], v[104:105], 0
    v_bitop3_b32 v15, v6, v15, v46 bitop3:0xca
    v_bitop3_b32 v14, v6, v14, v47 bitop3:0xca
    s_nop 1
    v_pk_mul_f32 v[80:81], v[80:81], v[14:15] op_sel:[0,1] op_sel_hi:[1,1]
    v_pk_mul_f32 v[82:83], v[82:83], v[14:15] op_sel:[0,1] op_sel_hi:[1,1]
    v_pk_mul_f32 v[76:77], v[76:77], v[14:15] op_sel:[0,0] op_sel_hi:[1,0]
    v_pk_mul_f32 v[78:79], v[78:79], v[14:15] op_sel:[0,0] op_sel_hi:[1,0]
    v_and_b32 v47, 0x0fffffff, v40
    v_mov_b32 v21, v40
    buffer_load_dwordx4 v[16:19], v47, s[8:11], 0 offen
    buffer_load_dwordx3 v[18:20], v47, s[8:11], 0 offen offset:8
    s_waitcnt lgkmcnt(0)
    v_cmpx_ne_u64 vcc, v[74:75], v[70:71]
    s_and_b64 s[82:83], vcc, s[80:81]
    s_cbranch_scc1 L2_c63
L2_d63:
    v_mov_b64 v[84:85], v[70:71]
    v_mov_b32 v7, v93
    v_mov_b64 v[86:87], v[74:75]
    s_mov_b64 exec, -1
    s_or_b64 s[80:81], s[80:81], vcc
    v_cmpx_ne_u64 vcc, v[72:73], v[68:69]
    s_and_b64 s[82:83], vcc, s[80:81]
    s_cbranch_scc1 L2_c64
L2_d64:
    v_mov_b64 v[84:85], v[68:69]
    v_mov_b32 v7, v92
    v_mov_b64 v[86:87], v[72:73]
    s_mov_b64 exec, -1
    s_or_b64 s[80:81], s[80:81], vcc
    ds_read_b64 v[70:71], v95
    ds_read_b64 v[68:69], v94
    s_waitcnt vmcnt(10)
    v_and_b32 v46, 0x20000000, v27
    v_lshrrev_b32 v47, 14, v23
    v_bitop3_b32 v47, v47, v5, v46 bitop3:0xea
    ds_read_b64 v[102:103], v47 offset:63616
    v_bitop3_b32 v93, v23, v5, v46 bitop3:0xea
    v_and_b32 v46, 0x10000000, v27
    v_lshrrev_b32 v47, 14, v22
    v_bitop3_b32 v47, v47, v5, v46 bitop3:0xea
    ds_read_b64 v[100:101], v47 offset:63616
    v_bitop3_b32 v92, v22, v5, v46 bitop3:0xea
    s_waitcnt lgkmcnt(2)
    v_mfma_f32_4x4x4_16b_bf16 v[80:83], v[10:11], v[70:71], v[80:83]
    v_mfma_f32_4x4x4_16b_bf16 v[76:79], v[10:11], v[68:69], v[76:79]
    v_perm_b32 v15, v23, v26, s45
    v_bitop3_b32 v46, v23, 0.5, -0.5 bitop3:0xa8
    v_perm_b32 v14, v22, v26, s44
    v_bitop3_b32 v47, v22, 0.5, -0.5 bitop3:0xa8
    v_cvt_pk_bf16_f32 v80, v80, v81
    v_cvt_pk_bf16_f32 v81, v82, v83
    ds_wrxchg_rtn_b64 v[74:75], v95, v[80:81]
    v_cvt_pk_bf16_f32 v76, v76, v77
    v_cvt_pk_bf16_f32 v77, v78, v79
    ds_wrxchg_rtn_b64 v[72:73], v94, v[76:77]
    s_waitcnt lgkmcnt(2)
    v_mfma_f32_4x4x4_16b_bf16 v[80:83], v[8:9], v[102:103], 0
    v_mfma_f32_4x4x4_16b_bf16 v[76:79], v[8:9], v[100:101], 0
    v_bitop3_b32 v15, v6, v15, v46 bitop3:0xca
    v_bitop3_b32 v14, v6, v14, v47 bitop3:0xca
    v_cmp_lt_u32 s[84:85], v5, v92
    s_nop 0
    v_pk_mul_f32 v[80:81], v[80:81], v[14:15] op_sel:[0,1] op_sel_hi:[1,1]
    v_pk_mul_f32 v[82:83], v[82:83], v[14:15] op_sel:[0,1] op_sel_hi:[1,1]
    v_pk_mul_f32 v[76:77], v[76:77], v[14:15] op_sel:[0,0] op_sel_hi:[1,0]
    v_pk_mul_f32 v[78:79], v[78:79], v[14:15] op_sel:[0,0] op_sel_hi:[1,0]
    v_sub_u16 v88, v58, v50
    v_and_b32 v89, 3, v50
    v_add3_u32 v99, v88, v89, 3
    v_and_b32 v99, -4, v99
    v_max_u32 v99, 4, v99
    v_and_b32 v97, 0xfffc, v50
    v_bfm_b32 v96, v88, v89
    v_add_u32_dpp v91, v99, v99 row_shr:1 row_mask:0xf bank_mask:0xf bound_ctrl:1
    v_mad_u32_u24 v97, v97, 5, v2
    v_cmp_lt_u32 vcc, 16, v99
    v_add_u32_dpp v91, v91, v91 row_shr:2 row_mask:0xf bank_mask:0xf bound_ctrl:1
    v_sub_u32 v98, s38, v99
    v_lshrrev_b64 v[50:51], 16, v[50:51]
    v_add_u32_dpp v91, v91, v91 row_shr:4 row_mask:0xf bank_mask:0xf bound_ctrl:1
    v_lshrrev_b64 v[58:59], 16, v[58:59]
    s_mov_b32 s43, 0
    v_add_u32_dpp v91, v91, v91 row_shr:8 row_mask:0xf bank_mask:0xf bound_ctrl:1
    s_nop 1
    v_add_u32_dpp v91, v91, v91 row_bcast:15 row_mask:0xa bank_mask:0xf
    s_nop 1
    v_add_u32_dpp v91, v91, v91 row_bcast:31 row_mask:0xc bank_mask:0xf
    v_add_u32 v98, v98, v91
    v_readlane_b32 s37, v91, 63
    s_cbranch_vccnz L2_xo65
L2_xp65:
    buffer_load_dwordx4 v[112:115], v3, s[16:19], s40 offen offset:1024
    s_waitcnt lgkmcnt(0)
    v_cmpx_ne_u64 vcc, v[74:75], v[70:71]
    s_and_b64 s[82:83], vcc, s[80:81]
    s_cbranch_scc1 L2_c66
L2_d66:
    v_mov_b64 v[84:85], v[70:71]
    v_mov_b32 v7, v95
    v_mov_b64 v[86:87], v[74:75]
    s_mov_b64 exec, -1
    s_or_b64 s[80:81], s[80:81], vcc
    v_cmpx_ne_u64 vcc, v[72:73], v[68:69]
    s_and_b64 s[82:83], vcc, s[80:81]
    s_cbranch_scc1 L2_c67
L2_d67:
    v_mov_b64 v[84:85], v[68:69]
    v_mov_b32 v7, v94
    v_mov_b64 v[86:87], v[72:73]
    s_mov_b64 exec, -1
    s_or_b64 s[80:81], s[80:81], vcc
    ds_read_b64 v[70:71], v93
    s_and_b64 exec, s[84:85], s[80:81]
    v_mfma_f32_4x4x4_16b_bf16 v[76:79], v[12:13], v[84:85], 0
    v_mov_b32 v92, v7
    s_andn2_b64 s[80:81], s[80:81], s[84:85]
    v_mfma_f32_4x4x4_16b_bf16 v[76:79], v[10:11], v[86:87], v[76:79]
    s_mov_b64 exec, -1
    ds_read_b64 v[68:69], v92
    v_and_b32 v46, 0x80000000, v27
    v_lshrrev_b32 v47, 14, v25
    v_bitop3_b32 v47, v47, v5, v46 bitop3:0xea
    ds_read_b64 v[106:107], v47 offset:63616
    v_bitop3_b32 v95, v25, v5, v46 bitop3:0xea
    v_and_b32 v46, 0x40000000, v27
    v_lshrrev_b32 v47, 14, v24
    v_bitop3_b32 v47, v47, v5, v46 bitop3:0xea
    ds_read_b64 v[104:105], v47 offset:63616
    v_bitop3_b32 v94, v24, v5, v46 bitop3:0xea
    s_waitcnt lgkmcnt(2)
    v_mfma_f32_4x4x4_16b_bf16 v[80:83], v[10:11], v[70:71], v[80:83]
    v_mfma_f32_4x4x4_16b_bf16 v[76:79], v[10:11], v[68:69], v[76:79]
    v_perm_b32 v15, v25, v26, s47
    v_bitop3_b32 v46, v25, 0.5, -0.5 bitop3:0xa8
    v_perm_b32 v14, v24, v26, s46
    v_bitop3_b32 v47, v24, 0.5, -0.5 bitop3:0xa8
    v_cvt_pk_bf16_f32 v80, v80, v81
    v_cvt_pk_bf16_f32 v81, v82, v83
    ds_wrxchg_rtn_b64 v[74:75], v93, v[80:81]
    v_cvt_pk_bf16_f32 v76, v76, v77
    v_cvt_pk_bf16_f32 v77, v78, v79
    ds_wrxchg_rtn_b64 v[72:73], v92, v[76:77]
    s_setprio 1
    s_waitcnt lgkmcnt(2)
    v_mfma_f32_4x4x4_16b_bf16 v[80:83], v[8:9], v[106:107], 0
    v_mfma_f32_4x4x4_16b_bf16 v[76:79], v[8:9], v[104:105], 0
    v_bitop3_b32 v15, v6, v15, v46 bitop3:0xca
    v_bitop3_b32 v14, v6, v14, v47 bitop3:0xca
    s_nop 1
    v_pk_mul_f32 v[80:81], v[80:81], v[14:15] op_sel:[0,1] op_sel_hi:[1,1]
    v_pk_mul_f32 v[82:83], v[82:83], v[14:15] op_sel:[0,1] op_sel_hi:[1,1]
    v_pk_mul_f32 v[76:77], v[76:77], v[14:15] op_sel:[0,0] op_sel_hi:[1,0]
    v_pk_mul_f32 v[78:79], v[78:79], v[14:15] op_sel:[0,0] op_sel_hi:[1,0]
    v_and_b32 v47, 0x0fffffff, v41
    v_mov_b32 v27, v41
    buffer_load_dwordx4 v[22:25], v47, s[8:11], 0 offen
    buffer_load_dwordx3 v[24:26], v47, s[8:11], 0 offen offset:8
    s_waitcnt lgkmcnt(0)
    v_cmpx_ne_u64 vcc, v[74:75], v[70:71]
    s_and_b64 s[82:83], vcc, s[80:81]
    s_cbranch_scc1 L2_c68
L2_d68:
    v_mov_b64 v[84:85], v[70:71]
    v_mov_b32 v7, v93
    v_mov_b64 v[86:87], v[74:75]
    s_mov_b64 exec, -1
    s_or_b64 s[80:81], s[80:81], vcc
    v_cmpx_ne_u64 vcc, v[72:73], v[68:69]
    s_and_b64 s[82:83], vcc, s[80:81]
    s_cbranch_scc1 L2_c69
L2_d69:
    v_mov_b64 v[84:85], v[68:69]
    v_mov_b32 v7, v92
    v_mov_b64 v[86:87], v[72:73]
    s_mov_b64 exec, -1
    s_or_b64 s[80:81], s[80:81], vcc
    ds_read_b64 v[70:71], v95
    ds_read_b64 v[68:69], v94
    s_waitcnt vmcnt(11)
    v_and_b32 v46, 0x20000000, v33
    v_lshrrev_b32 v47, 14, v29
    v_bitop3_b32 v47, v47, v5, v46 bitop3:0xea
    ds_read_b64 v[102:103], v47 offset:63616
    v_bitop3_b32 v93, v29, v5, v46 bitop3:0xea
    v_and_b32 v46, 0x10000000, v33
    v_lshrrev_b32 v47, 14, v28
    v_bitop3_b32 v47, v47, v5, v46 bitop3:0xea
    ds_read_b64 v[100:101], v47 offset:63616
    v_bitop3_b32 v92, v28, v5, v46 bitop3:0xea
    s_waitcnt lgkmcnt(2)
    v_mfma_f32_4x4x4_16b_bf16 v[80:83], v[10:11], v[70:71], v[80:83]
    v_mfma_f32_4x4x4_16b_bf16 v[76:79], v[10:11], v[68:69], v[76:79]
    v_perm_b32 v15, v29, v32, s45
    v_bitop3_b32 v46, v29, 0.5, -0.5 bitop3:0xa8
    v_perm_b32 v14, v28, v32, s44
    v_bitop3_b32 v47, v28, 0.5, -0.5 bitop3:0xa8
    v_cvt_pk_bf16_f32 v80, v80, v81
    v_cvt_pk_bf16_f32 v81, v82, v83
    ds_wrxchg_rtn_b64 v[74:75], v95, v[80:81]
    v_cvt_pk_bf16_f32 v76, v76, v77
    v_cvt_pk_bf16_f32 v77, v78, v79
    ds_wrxchg_rtn_b64 v[72:73], v94, v[76:77]
    s_waitcnt lgkmcnt(2)
    v_mfma_f32_4x4x4_16b_bf16 v[80:83], v[8:9], v[102:103], 0
    v_mfma_f32_4x4x4_16b_bf16 v[76:79], v[8:9], v[100:101], 0
    v_bitop3_b32 v15, v6, v15, v46 bitop3:0xca
    v_bitop3_b32 v14, v6, v14, v47 bitop3:0xca
    v_cmp_lt_u32 s[84:85], v5, v92
    s_nop 0
    v_pk_mul_f32 v[80:81], v[80:81], v[14:15] op_sel:[0,1] op_sel_hi:[1,1]
    v_pk_mul_f32 v[82:83], v[82:83], v[14:15] op_sel:[0,1] op_sel_hi:[1,1]
    v_pk_mul_f32 v[76:77], v[76:77], v[14:15] op_sel:[0,0] op_sel_hi:[1,0]
    v_pk_mul_f32 v[78:79], v[78:79], v[14:15] op_sel:[0,0] op_sel_hi:[1,0]
    s_waitcnt lgkmcnt(0)
    v_cmpx_ne_u64 vcc, v[74:75], v[70:71]
    s_and_b64 s[82:83], vcc, s[80:81]
    s_cbranch_scc1 L2_c70
L2_d70:
    v_mov_b64 v[84:85], v[70:71]
    v_mov_b32 v7, v95
    v_mov_b64 v[86:87], v[74:75]
    s_mov_b64 exec, -1
    s_or_b64 s[80:81], s[80:81], vcc
    v_cmpx_ne_u64 vcc, v[72:73], v[68:69]
    s_and_b64 s[82:83], vcc, s[80:81]
    s_cbranch_scc1 L2_c71
L2_d71:
    v_mov_b64 v[84:85], v[68:69]
    v_mov_b32 v7, v94
    v_mov_b64 v[86:87], v[72:73]
    s_mov_b64 exec, -1
    s_or_b64 s[80:81], s[80:81], vcc
    ds_read_b64 v[70:71], v93
    s_and_b64 exec, s[84:85], s[80:81]
    v_mfma_f32_4x4x4_16b_bf16 v[76:79], v[12:13], v[84:85], 0
    v_mov_b32 v92, v7
    s_andn2_b64 s[80:81], s[80:81], s[84:85]
    v_mfma_f32_4x4x4_16b_bf16 v[76:79], v[10:11], v[86:87], v[76:79]
    s_mov_b64 exec, -1
    ds_read_b64 v[68:69], v92
    v_and_b32 v46, 0x80000000, v33
    v_lshrrev_b32 v47, 14, v31
    v_bitop3_b32 v47, v47, v5, v46 bitop3:0xea
    ds_read_b64 v[106:107], v47 offset:63616
    v_bitop3_b32 v95, v31, v5, v46 bitop3:0xea
    v_and_b32 v46, 0x40000000, v33
    v_lshrrev_b32 v47, 14, v30
    v_bitop3_b32 v47, v47, v5, v46 bitop3:0xea
    ds_read_b64 v[104:105], v47 offset:63616
    v_bitop3_b32 v94, v30, v5, v46 bitop3:0xea
    s_waitcnt lgkmcnt(2)
    v_mfma_f32_4x4x4_16b_bf16 v[80:83], v[10:11], v[70:71], v[80:83]
    v_mfma_f32_4x4x4_16b_bf16 v[76:79], v[10:11], v[68:69], v[76:79]
    v_perm_b32 v15, v31, v32, s47
    v_bitop3_b32 v46, v31, 0.5, -0.5 bitop3:0xa8
    v_perm_b32 v14, v30, v32, s46
    v_bitop3_b32 v47, v30, 0.5, -0.5 bitop3:0xa8
    v_cvt_pk_bf16_f32 v80, v80, v81
    v_cvt_pk_bf16_f32 v81, v82, v83
    ds_wrxchg_rtn_b64 v[74:75], v93, v[80:81]
    v_cvt_pk_bf16_f32 v76, v76, v77
    v_cvt_pk_bf16_f32 v77, v78, v79
    ds_wrxchg_rtn_b64 v[72:73], v92, v[76:77]
    s_setprio 0
    s_waitcnt lgkmcnt(2)
    v_mfma_f32_4x4x4_16b_bf16 v[80:83], v[8:9], v[106:107], 0
    v_mfma_f32_4x4x4_16b_bf16 v[76:79], v[8:9], v[104:105], 0
    v_bitop3_b32 v15, v6, v15, v46 bitop3:0xca
    v_bitop3_b32 v14, v6, v14, v47 bitop3:0xca
    s_nop 1
    v_pk_mul_f32 v[80:81], v[80:81], v[14:15] op_sel:[0,1] op_sel_hi:[1,1]
    v_pk_mul_f32 v[82:83], v[82:83], v[14:15] op_sel:[0,1] op_sel_hi:[1,1]
    v_pk_mul_f32 v[76:77], v[76:77], v[14:15] op_sel:[0,0] op_sel_hi:[1,0]
    v_pk_mul_f32 v[78:79], v[78:79], v[14:15] op_sel:[0,0] op_sel_hi:[1,0]
    s_add_u32 s40, s40, 0x4e200
    v_and_b32 v47, 0x0fffffff, v42
    v_mov_b32 v33, v42
    buffer_load_dwordx4 v[28:31], v47, s[8:11], 0 offen
    buffer_load_dwordx3 v[30:32], v47, s[8:11], 0 offen offset:8
    s_waitcnt lgkmcnt(0)
    v_cmpx_ne_u64 vcc, v[74:75], v[70:71]
    s_and_b64 s[82:83], vcc, s[80:81]
    s_cbranch_scc1 L2_c72
L2_d72:
    v_mov_b64 v[84:85], v[70:71]
    v_mov_b32 v7, v93
    v_mov_b64 v[86:87], v[74:75]
    s_mov_b64 exec, -1
    s_or_b64 s[80:81], s[80:81], vcc
    v_cmpx_ne_u64 vcc, v[72:73], v[68:69]
    s_and_b64 s[82:83], vcc, s[80:81]
    s_cbranch_scc1 L2_c73
L2_d73:
    v_mov_b64 v[84:85], v[68:69]
    v_mov_b32 v7, v92
    v_mov_b64 v[86:87], v[72:73]
    s_mov_b64 exec, -1
    s_or_b64 s[80:81], s[80:81], vcc
    ds_read_b64 v[70:71], v95
    ds_read_b64 v[68:69], v94
    s_waitcnt vmcnt(8)
    v_and_b32 v46, 0x20000000, v39
    v_lshrrev_b32 v47, 14, v35
    v_bitop3_b32 v47, v47, v5, v46 bitop3:0xea
    ds_read_b64 v[102:103], v47 offset:63616
    v_bitop3_b32 v93, v35, v5, v46 bitop3:0xea
    v_and_b32 v46, 0x10000000, v39
    v_lshrrev_b32 v47, 14, v34
    v_bitop3_b32 v47, v47, v5, v46 bitop3:0xea
    ds_read_b64 v[100:101], v47 offset:63616
    v_bitop3_b32 v92, v34, v5, v46 bitop3:0xea
    v_and_b32 v46, 0x80000000, v39
    v_lshrrev_b32 v47, 14, v37
    v_bitop3_b32 v47, v47, v5, v46 bitop3:0xea
    ds_read_b64 v[106:107], v47 offset:63616
    v_and_b32 v46, 0x40000000, v39
    v_lshrrev_b32 v47, 14, v36
    v_bitop3_b32 v47, v47, v5, v46 bitop3:0xea
    ds_read_b64 v[104:105], v47 offset:63616
    s_waitcnt lgkmcnt(4)
    v_mfma_f32_4x4x4_16b_bf16 v[80:83], v[10:11], v[70:71], v[80:83]
    v_mfma_f32_4x4x4_16b_bf16 v[76:79], v[10:11], v[68:69], v[76:79]
    v_perm_b32 v15, v35, v38, s45
    v_bitop3_b32 v46, v35, 0.5, -0.5 bitop3:0xa8
    v_perm_b32 v14, v34, v38, s44
    v_bitop3_b32 v47, v34, 0.5, -0.5 bitop3:0xa8
    v_cvt_pk_bf16_f32 v80, v80, v81
    v_cvt_pk_bf16_f32 v81, v82, v83
    ds_wrxchg_rtn_b64 v[74:75], v95, v[80:81]
    v_cvt_pk_bf16_f32 v76, v76, v77
    v_cvt_pk_bf16_f32 v77, v78, v79
    ds_wrxchg_rtn_b64 v[72:73], v94, v[76:77]
    s_waitcnt lgkmcnt(2)
    s_barrier
    s_setprio 3
    ds_write_b128 v3, v[124:127] offset:4096
    s_add_u32 s3, s40, 4096
    buffer_load_dwordx4 v[124:127], v3, s[16:19], s3 offen
    ds_write_b128 v3, v[116:119] offset:2048
    buffer_load_dwordx4 v[116:119], v3, s[16:19], s40 offen offset:2048
    ds_write_b128 v3, v[120:123] offset:3072
    buffer_load_dwordx4 v[120:123], v3, s[16:19], s40 offen offset:3072
    v_mfma_f32_4x4x4_16b_bf16 v[80:83], v[8:9], v[102:103], 0
    v_mfma_f32_4x4x4_16b_bf16 v[76:79], v[8:9], v[100:101], 0
    v_bitop3_b32 v15, v6, v15, v46 bitop3:0xca
    v_bitop3_b32 v14, v6, v14, v47 bitop3:0xca
    v_cmp_lt_u32 s[84:85], v5, v92
    s_nop 0
    v_pk_mul_f32 v[80:81], v[80:81], v[14:15] op_sel:[0,1] op_sel_hi:[1,1]
    v_pk_mul_f32 v[82:83], v[82:83], v[14:15] op_sel:[0,1] op_sel_hi:[1,1]
    v_pk_mul_f32 v[76:77], v[76:77], v[14:15] op_sel:[0,0] op_sel_hi:[1,0]
    v_pk_mul_f32 v[78:79], v[78:79], v[14:15] op_sel:[0,0] op_sel_hi:[1,0]
    v_mov_b32 v44, v43
    s_cmp_gt_u32 s37, 1024
    s_cbranch_scc1 L2_xs74
    s_cmp_lg_u32 s43, 0
    s_cbranch_scc1 L2_xa74
L2_xb74:
    v_lshlrev_b32 v89, 16, v96
    v_add_u32 v90, 60, v97
    v_bitop3_b32 v90, v89, v45, v90 bitop3:0x6a
    ds_write_b32 v98, v90 offset:12
    v_lshlrev_b32 v89, 20, v96
    v_add_u32 v90, 40, v97
    v_bitop3_b32 v90, v89, v45, v90 bitop3:0x6a
    ds_write_b32 v98, v90 offset:8
    v_lshlrev_b32 v89, 24, v96
    v_add_u32 v90, 20, v97
    v_bitop3_b32 v90, v89, v45, v90 bitop3:0x6a
    ds_write_b32 v98, v90 offset:4
    v_lshlrev_b32 v89, 28, v96
    v_bitop3_b32 v90, v89, v45, v97 bitop3:0x6a
    ds_write_b32 v98, v90 offset:0
    v_mov_b32_dpp v91, v66 quad_perm:[0,0,0,0] row_mask:0xf bank_mask:0xf
    v_and_b32 v89, 3, v91
    v_and_b32 v97, 0xfffc, v91
    v_sub_u16_dpp v88, v66, v91 quad_perm:[2,2,2,2] row_mask:0xf bank_mask:0xf
    v_mad_u32_u24 v97, v97, 5, v4
    v_add_u32 v99, v88, v89
    v_bfm_b32 v96, v88, v89
    v_cmp_lt_u32 s[58:59], 16, v99
    v_lshlrev_b32 v89, v1, v96
    v_and_b32 v89, v45, v89
    v_cmp_ne_u32 vcc, 0, v89
    v_xor_b32 v90, v97, v89
    s_add_u32 s3, s37, s38
    v_mbcnt_lo_u32_b32 v98, vcc_lo, 0
    v_mbcnt_hi_u32_b32 v98, vcc_hi, v98
    s_bcnt1_i32_b64 s41, vcc
    v_lshl_add_u32 v98, v98, 2, s3
    s_mov_b64 exec, vcc
    ds_write_b32 v98, v90
    s_mov_b64 exec, -1
    s_lshl2_add_u32 s37, s41, s37
    s_cmp_lg_u64 s[58:59], 0
    s_cbranch_scc1 L2_xe74
L2_xr74:
    v_add_u32 v98, s37, v0
    v_mov_b32 v90, -1
    ds_write_b32 v98, v90
    ds_read2st64_b32 v[40:41], v0 offset0:0 offset1:1
    ds_read2st64_b32 v[42:43], v0 offset0:2 offset1:3
    s_sub_u32 s3, s37, 768
    s_cmp_gt_u32 s3, 256
    s_cbranch_scc1 L2_xf74
L2_xg74:
    s_setprio 2
    s_waitcnt vmcnt(10)
    ds_write_b128 v3, v[108:111] offset:0
    s_waitcnt lgkmcnt(12)
    v_cmpx_ne_u64 vcc, v[74:75], v[70:71]
    s_and_b64 s[82:83], vcc, s[80:81]
    s_cbranch_scc1 L2_c75
L2_d75:
    v_mov_b64 v[84:85], v[70:71]
    v_mov_b32 v7, v95
    v_mov_b64 v[86:87], v[74:75]
    s_mov_b64 exec, -1
    s_or_b64 s[80:81], s[80:81], vcc
    v_cmpx_ne_u64 vcc, v[72:73], v[68:69]
    s_and_b64 s[82:83], vcc, s[80:81]
    s_cbranch_scc1 L2_c76
L2_d76:
    v_mov_b64 v[84:85], v[68:69]
    v_mov_b32 v7, v94
    v_mov_b64 v[86:87], v[72:73]
    s_mov_b64 exec, -1
    s_or_b64 s[80:81], s[80:81], vcc
    ds_read_b64 v[70:71], v93
    s_and_b64 exec, s[84:85], s[80:81]
    v_mfma_f32_4x4x4_16b_bf16 v[76:79], v[12:13], v[84:85], 0
    v_mov_b32 v92, v7
    s_andn2_b64 s[80:81], s[80:81], s[84:85]
    v_mfma_f32_4x4x4_16b_bf16 v[76:79], v[10:11], v[86:87], v[76:79]
    s_mov_b64 exec, -1
    ds_read_b64 v[68:69], v92
    s_setprio 1
    s_waitcnt vmcnt(7)
    ds_write_b128 v3, v[112:115] offset:1024
    s_waitcnt lgkmcnt(1)
    v_mfma_f32_4x4x4_16b_bf16 v[80:83], v[10:11], v[70:71], v[80:83]
    v_mfma_f32_4x4x4_16b_bf16 v[76:79], v[10:11], v[68:69], v[76:79]
    v_and_b32 v46, 0x40000000, v39
    v_bitop3_b32 v94, v36, v5, v46 bitop3:0xea
    v_and_b32 v46, 0x80000000, v39
    v_bitop3_b32 v95, v37, v5, v46 bitop3:0xea
    v_perm_b32 v15, v37, v38, s47
    v_bitop3_b32 v46, v37, 0.5, -0.5 bitop3:0xa8
    v_perm_b32 v14, v36, v38, s46
    v_bitop3_b32 v47, v36, 0.5, -0.5 bitop3:0xa8
    v_cvt_pk_bf16_f32 v80, v80, v81
    v_cvt_pk_bf16_f32 v81, v82, v83
    ds_wrxchg_rtn_b64 v[74:75], v93, v[80:81]
    v_cvt_pk_bf16_f32 v76, v76, v77
    v_cvt_pk_bf16_f32 v77, v78, v79
    ds_wrxchg_rtn_b64 v[72:73], v92, v[76:77]
    s_setprio 0
    v_mfma_f32_4x4x4_16b_bf16 v[80:83], v[8:9], v[106:107], 0
    v_mfma_f32_4x4x4_16b_bf16 v[76:79], v[8:9], v[104:105], 0
    v_bitop3_b32 v15, v6, v15, v46 bitop3:0xca
    v_bitop3_b32 v14, v6, v14, v47 bitop3:0xca
    s_nop 1
    v_pk_mul_f32 v[80:81], v[80:81], v[14:15] op_sel:[0,1] op_sel_hi:[1,1]
    v_pk_mul_f32 v[82:83], v[82:83], v[14:15] op_sel:[0,1] op_sel_hi:[1,1]
    v_pk_mul_f32 v[76:77], v[76:77], v[14:15] op_sel:[0,0] op_sel_hi:[1,0]
    v_pk_mul_f32 v[78:79], v[78:79], v[14:15] op_sel:[0,0] op_sel_hi:[1,0]
    s_cmp_eq_u32 s35, 3
    s_cbranch_scc1 L2_done
    s_add_u32 s35, s35, 1
    s_add_u32 s42, s42, 1
    s_waitcnt lgkmcnt(2)
    s_branch L2_loop
L2_done:
    s_waitcnt lgkmcnt(0)
    v_cmpx_ne_u64 vcc, v[74:75], v[70:71]
    s_and_b64 s[82:83], vcc, s[80:81]
    s_cbranch_scc1 L2_c77
L2_d77:
    v_mov_b64 v[84:85], v[70:71]
    v_mov_b32 v7, v93
    v_mov_b64 v[86:87], v[74:75]
    s_mov_b64 exec, -1
    s_or_b64 s[80:81], s[80:81], vcc
    v_cmpx_ne_u64 vcc, v[72:73], v[68:69]
    s_and_b64 s[82:83], vcc, s[80:81]
    s_cbranch_scc1 L2_c78
L2_d78:
    v_mov_b64 v[84:85], v[68:69]
    v_mov_b32 v7, v92
    v_mov_b64 v[86:87], v[72:73]
    s_mov_b64 exec, -1
    s_or_b64 s[80:81], s[80:81], vcc
    ds_read_b64 v[70:71], v95
    ds_read_b64 v[68:69], v94
    s_waitcnt lgkmcnt(0)
    v_mfma_f32_4x4x4_16b_bf16 v[80:83], v[10:11], v[70:71], v[80:83]
    v_mfma_f32_4x4x4_16b_bf16 v[76:79], v[10:11], v[68:69], v[76:79]
    s_nop 3
    v_cvt_pk_bf16_f32 v80, v80, v81
    v_cvt_pk_bf16_f32 v81, v82, v83
    ds_wrxchg_rtn_b64 v[74:75], v95, v[80:81]
    v_cvt_pk_bf16_f32 v76, v76, v77
    v_cvt_pk_bf16_f32 v77, v78, v79
    ds_wrxchg_rtn_b64 v[72:73], v94, v[76:77]
    s_waitcnt lgkmcnt(0)
    v_cmpx_ne_u64 vcc, v[74:75], v[70:71]
    s_and_b64 s[82:83], vcc, s[80:81]
    s_cbranch_scc1 L2_c79
L2_d79:
    v_mov_b64 v[84:85], v[70:71]
    v_mov_b32 v7, v95
    v_mov_b64 v[86:87], v[74:75]
    s_mov_b64 exec, -1
    s_or_b64 s[80:81], s[80:81], vcc
    v_cmpx_ne_u64 vcc, v[72:73], v[68:69]
    s_and_b64 s[82:83], vcc, s[80:81]
    s_cbranch_scc1 L2_c80
L2_d80:
    v_mov_b64 v[84:85], v[68:69]
    v_mov_b32 v7, v94
    v_mov_b64 v[86:87], v[72:73]
    s_mov_b64 exec, -1
    s_or_b64 s[80:81], s[80:81], vcc
    s_mov_b64 exec, s[80:81]
    s_nop 1
    v_mfma_f32_4x4x4_16b_bf16 v[88:91], v[12:13], v[84:85], 0
    s_nop 1
    v_mfma_f32_4x4x4_16b_bf16 v[88:91], v[10:11], v[86:87], v[88:91]
    s_nop 4
    v_cvt_pk_bf16_f32 v88, v88, v89
    v_cvt_pk_bf16_f32 v89, v90, v91
    ds_pk_add_bf16 v7, v88
    ds_pk_add_bf16 v7, v89 offset:4
    s_mov_b64 exec, -1
    s_lshl_b32 s3, s32, 12
    s_add_u32 s3, s3, 80000
    s_waitcnt vmcnt(0) lgkmcnt(0)
    s_barrier
    v_subrev_u32 v16, s3, v3
    v_add_u32 v17, 16384, v16
    v_add_u32 v18, 32768, v16
    v_add_u32 v19, 49152, v16
    v_add_u32 v20, 65536, v16
    ds_read_b128 v[48:51], v16
    ds_read_b128 v[52:55], v17
    ds_read_b128 v[56:59], v18
    ds_read_b128 v[60:63], v19
    ds_read_b128 v[64:67], v20
    s_waitcnt lgkmcnt(4)
    buffer_store_dwordx4 v[48:51], v16, s[20:23], 0 offen sc1
    s_waitcnt lgkmcnt(3)
    buffer_store_dwordx4 v[52:55], v17, s[20:23], 0 offen sc1
    s_waitcnt lgkmcnt(2)
    buffer_store_dwordx4 v[56:59], v18, s[20:23], 0 offen sc1
    s_waitcnt lgkmcnt(1)
    buffer_store_dwordx4 v[60:63], v19, s[20:23], 0 offen sc1
    s_waitcnt lgkmcnt(0)
    buffer_store_dwordx4 v[64:67], v20, s[20:23], 0 offen sc1
L2_end:
    s_endpgm
L2_slow:
    s_mul_i32 s50, s32, 80
    s_add_u32 s57, s50, 80
    s_and_b32 s3, s42, 3
    s_lshl_b32 s53, s3, 3
    s_add_u32 s53, s53, s39
    s_and_b32 s3, s35, 2
    s_lshl_b32 s3, s3, 1
    s_add_u32 s53, s53, s3
    s_and_b32 s54, s35, 1
    s_lshl_b32 s54, s54, 4
L2_sl_seg:
    s_mul_i32 s56, s50, 173056
    s_add_u32 s3, s56, s53
    s_add_u32 s55, s3, 32
    s_buffer_load_dword s51, s[12:15], s3
    s_buffer_load_dword s52, s[12:15], s55
    s_waitcnt lgkmcnt(0)
    s_lshr_b32 s51, s51, s54
    s_and_b32 s51, s51, 0xffff
    s_lshr_b32 s52, s52, s54
    s_and_b32 s52, s52, 0xffff
L2_sl_rec:
    s_cmp_ge_u32 s51, s52
    s_cbranch_scc1 L2_sl_next
    v_mbcnt_lo_u32_b32 v102, -1, 0
    v_mbcnt_hi_u32_b32 v102, -1, v102
    v_add_u32 v102, s51, v102
    v_and_b32 v103, -4, v102
    v_lshl_add_u32 v104, v102, 2, v103
    v_lshl_add_u32 v105, v103, 2, v102
    v_cmp_gt_u32 vcc, s52, v102
    s_mov_b64 exec, vcc
    buffer_load_dword v106, v104, s[8:11], s56 offen
    buffer_load_ubyte v107, v105, s[8:11], s56 offen offset:16
    s_waitcnt vmcnt(0)
    v_lshrrev_b32 v98, 14, v106
    v_and_b32 v98, v5, v98
    ds_read_b64 v[100:101], v98 offset:63616
    v_perm_b32 v97, v106, v107, s44
    v_and_b32 v96, v5, v106
    v_bitop3_b32 v103, v106, 0.5, -0.5 bitop3:0xa8
    v_bitop3_b32 v97, v6, v97, v103 bitop3:0xca
    s_waitcnt lgkmcnt(0)
    v_mfma_f32_4x4x4_16b_bf16 v[88:91], v[8:9], v[100:101], 0
    s_nop 4
    v_mul_f32 v88, v97, v88
    v_mul_f32 v89, v97, v89
    v_mul_f32 v90, v97, v90
    v_mul_f32 v91, v97, v91
    v_cvt_pk_bf16_f32 v88, v88, v89
    v_cvt_pk_bf16_f32 v89, v90, v91
    ds_pk_add_bf16 v96, v88
    ds_pk_add_bf16 v96, v89 offset:4
    s_mov_b64 exec, -1
    s_add_u32 s51, s51, 64
    s_branch L2_sl_rec
L2_sl_next:
    s_add_u32 s50, s50, 1
    s_cmp_lt_u32 s50, s57
    s_cbranch_scc1 L2_sl_seg
    s_waitcnt lgkmcnt(0)
    s_and_b32 s3, s42, 3
    s_cmp_eq_u32 s3, 0
    s_cbranch_scc1 L2_ret0
    s_cmp_eq_u32 s3, 1
    s_cbranch_scc1 L2_ret1
    s_cmp_eq_u32 s3, 2
    s_cbranch_scc1 L2_ret2
    s_branch L2_ret3
L2_xo1:
    v_cmp_lt_u32 vcc, 20, v99
    s_mov_b32 s43, 1
    s_cbranch_vccz L2_xp1
    v_cmp_lt_u32 vcc, 32, v99
    v_cmp_lt_u32 s[58:59], 31, v88
    s_mov_b32 s43, 2
    s_or_b64 vcc, vcc, s[58:59]
    s_cbranch_scc0 L2_xp1
    s_mov_b32 s37, 0x10000
    s_branch L2_xp1
L2_xa2:
    s_cmp_eq_u32 s43, 1
    s_cbranch_scc1 L2_xc2
    v_lshlrev_b32 v89, 0, v96
    v_add_u32 v90, 140, v97
    v_bitop3_b32 v90, v89, v45, v90 bitop3:0x6a
    ds_write_b32 v98, v90 offset:28
    v_lshlrev_b32 v89, 4, v96
    v_add_u32 v90, 120, v97
    v_bitop3_b32 v90, v89, v45, v90 bitop3:0x6a
    ds_write_b32 v98, v90 offset:24
    v_lshlrev_b32 v89, 8, v96
    v_add_u32 v90, 100, v97
    v_bitop3_b32 v90, v89, v45, v90 bitop3:0x6a
    ds_write_b32 v98, v90 offset:20
L2_xc2:
    v_lshlrev_b32 v89, 12, v96
    v_add_u32 v90, 80, v97
    v_bitop3_b32 v90, v89, v45, v90 bitop3:0x6a
    ds_write_b32 v98, v90 offset:16
    s_branch L2_xb2
L2_xe2:
    v_cmp_lt_u32 vcc, 32, v99
    v_cmp_lt_u32 s[58:59], 31, v88
    v_lshrrev_b32 v89, 16, v96
    v_add_u32 v97, 80, v97
    s_or_b64 vcc, vcc, s[58:59]
    s_cbranch_scc1 L2_xs2
    v_lshlrev_b32 v89, v1, v89
    v_and_b32 v89, v45, v89
    v_cmp_ne_u32 vcc, 0, v89
    v_xor_b32 v90, v97, v89
    s_add_u32 s3, s37, s38
    v_mbcnt_lo_u32_b32 v98, vcc_lo, 0
    v_mbcnt_hi_u32_b32 v98, vcc_hi, v98
    s_bcnt1_i32_b64 s41, vcc
    v_lshl_add_u32 v98, v98, 2, s3
    s_mov_b64 exec, vcc
    ds_write_b32 v98, v90
    s_mov_b64 exec, -1
    s_lshl2_add_u32 s37, s41, s37
    s_branch L2_xr2
L2_xf2:
    s_waitcnt lgkmcnt(0)
    s_cmp_gt_u32 s37, 1024
    s_cbranch_scc1 L2_xs2
    v_mov_b32 v43, -1
    s_cmp_ge_u32 s37, 512
    s_cbranch_scc1 L2_xg2
    v_mov_b32 v42, -1
    s_cmp_ge_u32 s37, 256
    s_cbranch_scc1 L2_xg2
    v_mov_b32 v41, -1
    s_branch L2_xg2
L2_xs2:
    s_waitcnt lgkmcnt(0)
    v_mov_b32 v40, -1
    v_mov_b32 v41, -1
    v_mov_b32 v42, -1
    v_mov_b32 v43, -1
    s_add_u32 s3, s42, 0
    s_bitset1_b32 s36, s3
    s_branch L2_xg2
L2_xo3:
    v_cmp_lt_u32 vcc, 20, v99
    s_mov_b32 s43, 1
    s_cbranch_vccz L2_xp3
    v_cmp_lt_u32 vcc, 32, v99
    v_cmp_lt_u32 s[58:59], 31, v88
    s_mov_b32 s43, 2
    s_or_b64 vcc, vcc, s[58:59]
    s_cbranch_scc0 L2_xp3
    s_mov_b32 s37, 0x10000
    s_branch L2_xp3
L2_xa4:
    s_cmp_eq_u32 s43, 1
    s_cbranch_scc1 L2_xc4
    v_lshlrev_b32 v89, 0, v96
    v_add_u32 v90, 140, v97
    v_bitop3_b32 v90, v89, v45, v90 bitop3:0x6a
    ds_write_b32 v98, v90 offset:28
    v_lshlrev_b32 v89, 4, v96
    v_add_u32 v90, 120, v97
    v_bitop3_b32 v90, v89, v45, v90 bitop3:0x6a
    ds_write_b32 v98, v90 offset:24
    v_lshlrev_b32 v89, 8, v96
    v_add_u32 v90, 100, v97
    v_bitop3_b32 v90, v89, v45, v90 bitop3:0x6a
    ds_write_b32 v98, v90 offset:20
L2_xc4:
    v_lshlrev_b32 v89, 12, v96
    v_add_u32 v90, 80, v97
    v_bitop3_b32 v90, v89, v45, v90 bitop3:0x6a
    ds_write_b32 v98, v90 offset:16
    s_branch L2_xb4
L2_xe4:
    v_cmp_lt_u32 vcc, 32, v99
    v_cmp_lt_u32 s[58:59], 31, v88
    v_lshrrev_b32 v89, 16, v96
    v_add_u32 v97, 80, v97
    s_or_b64 vcc, vcc, s[58:59]
    s_cbranch_scc1 L2_xs4
    v_lshlrev_b32 v89, v1, v89
    v_and_b32 v89, v45, v89
    v_cmp_ne_u32 vcc, 0, v89
    v_xor_b32 v90, v97, v89
    s_add_u32 s3, s37, s38
    v_mbcnt_lo_u32_b32 v98, vcc_lo, 0
    v_mbcnt_hi_u32_b32 v98, vcc_hi, v98
    s_bcnt1_i32_b64 s41, vcc
    v_lshl_add_u32 v98, v98, 2, s3
    s_mov_b64 exec, vcc
    ds_write_b32 v98, v90
    s_mov_b64 exec, -1
    s_lshl2_add_u32 s37, s41, s37
    s_branch L2_xr4
L2_xf4:
    s_waitcnt lgkmcnt(0)
    s_cmp_gt_u32 s37, 1024
    s_cbranch_scc1 L2_xs4
    v_mov_b32 v43, -1
    s_cmp_ge_u32 s37, 512
    s_cbranch_scc1 L2_xg4
    v_mov_b32 v42, -1
    s_cmp_ge_u32 s37, 256
    s_cbranch_scc1 L2_xg4
    v_mov_b32 v41, -1
    s_branch L2_xg4
L2_xs4:
    s_waitcnt lgkmcnt(0)
    v_mov_b32 v40, -1
    v_mov_b32 v41, -1
    v_mov_b32 v42, -1
    v_mov_b32 v43, -1
    s_add_u32 s3, s42, 1
    s_bitset1_b32 s36, s3
    s_branch L2_xg4
L2_c5:
    s_mov_b64 exec, s[82:83]
    s_nop 1
    v_mfma_f32_4x4x4_16b_bf16 v[88:91], v[12:13], v[84:85], 0
    s_nop 1
    v_mfma_f32_4x4x4_16b_bf16 v[88:91], v[10:11], v[86:87], v[88:91]
    s_nop 4
    v_cvt_pk_bf16_f32 v88, v88, v89
    v_cvt_pk_bf16_f32 v89, v90, v91
    ds_pk_add_bf16 v7, v88
    ds_pk_add_bf16 v7, v89 offset:4
    s_mov_b64 exec, vcc
    s_branch L2_d5
L2_c6:
    s_mov_b64 exec, s[82:83]
    s_nop 1
    v_mfma_f32_4x4x4_16b_bf16 v[88:91], v[12:13], v[84:85], 0
    s_nop 1
    v_mfma_f32_4x4x4_16b_bf16 v[88:91], v[10:11], v[86:87], v[88:91]
    s_nop 4
    v_cvt_pk_bf16_f32 v88, v88, v89
    v_cvt_pk_bf16_f32 v89, v90, v91
    ds_pk_add_bf16 v7, v88
    ds_pk_add_bf16 v7, v89 offset:4
    s_mov_b64 exec, vcc
    s_branch L2_d6
L2_c7:
    s_mov_b64 exec, s[82:83]
    s_nop 1
    v_mfma_f32_4x4x4_16b_bf16 v[88:91], v[12:13], v[84:85], 0
    s_nop 1
    v_mfma_f32_4x4x4_16b_bf16 v[88:91], v[10:11], v[86:87], v[88:91]
    s_nop 4
    v_cvt_pk_bf16_f32 v88, v88, v89
    v_cvt_pk_bf16_f32 v89, v90, v91
    ds_pk_add_bf16 v7, v88
    ds_pk_add_bf16 v7, v89 offset:4
    s_mov_b64 exec, vcc
    s_branch L2_d7
L2_c8:
    s_mov_b64 exec, s[82:83]
    s_nop 1
    v_mfma_f32_4x4x4_16b_bf16 v[88:91], v[12:13], v[84:85], 0
    s_nop 1
    v_mfma_f32_4x4x4_16b_bf16 v[88:91], v[10:11], v[86:87], v[88:91]
    s_nop 4
    v_cvt_pk_bf16_f32 v88, v88, v89
    v_cvt_pk_bf16_f32 v89, v90, v91
    ds_pk_add_bf16 v7, v88
    ds_pk_add_bf16 v7, v89 offset:4
    s_mov_b64 exec, vcc
    s_branch L2_d8
L2_c9:
    s_mov_b64 exec, s[82:83]
    s_nop 1
    v_mfma_f32_4x4x4_16b_bf16 v[88:91], v[12:13], v[84:85], 0
    s_nop 1
    v_mfma_f32_4x4x4_16b_bf16 v[88:91], v[10:11], v[86:87], v[88:91]
    s_nop 4
    v_cvt_pk_bf16_f32 v88, v88, v89
    v_cvt_pk_bf16_f32 v89, v90, v91
    ds_pk_add_bf16 v7, v88
    ds_pk_add_bf16 v7, v89 offset:4
    s_mov_b64 exec, vcc
    s_branch L2_d9
L2_c10:
    s_mov_b64 exec, s[82:83]
    s_nop 1
    v_mfma_f32_4x4x4_16b_bf16 v[88:91], v[12:13], v[84:85], 0
    s_nop 1
    v_mfma_f32_4x4x4_16b_bf16 v[88:91], v[10:11], v[86:87], v[88:91]
    s_nop 4
    v_cvt_pk_bf16_f32 v88, v88, v89
    v_cvt_pk_bf16_f32 v89, v90, v91
    ds_pk_add_bf16 v7, v88
    ds_pk_add_bf16 v7, v89 offset:4
    s_mov_b64 exec, vcc
    s_branch L2_d10
L2_xo11:
    v_cmp_lt_u32 vcc, 20, v99
    s_mov_b32 s43, 1
    s_cbranch_vccz L2_xp11
    v_cmp_lt_u32 vcc, 32, v99
    v_cmp_lt_u32 s[58:59], 31, v88
    s_mov_b32 s43, 2
    s_or_b64 vcc, vcc, s[58:59]
    s_cbranch_scc0 L2_xp11
    s_mov_b32 s37, 0x10000
    s_branch L2_xp11
L2_c12:
    s_mov_b64 exec, s[82:83]
    s_nop 1
    v_mfma_f32_4x4x4_16b_bf16 v[88:91], v[12:13], v[84:85], 0
    s_nop 1
    v_mfma_f32_4x4x4_16b_bf16 v[88:91], v[10:11], v[86:87], v[88:91]
    s_nop 4
    v_cvt_pk_bf16_f32 v88, v88, v89
    v_cvt_pk_bf16_f32 v89, v90, v91
    ds_pk_add_bf16 v7, v88
    ds_pk_add_bf16 v7, v89 offset:4
    s_mov_b64 exec, vcc
    s_branch L2_d12
L2_c13:
    s_mov_b64 exec, s[82:83]
    s_nop 1
    v_mfma_f32_4x4x4_16b_bf16 v[88:91], v[12:13], v[84:85], 0
    s_nop 1
    v_mfma_f32_4x4x4_16b_bf16 v[88:91], v[10:11], v[86:87], v[88:91]
    s_nop 4
    v_cvt_pk_bf16_f32 v88, v88, v89
    v_cvt_pk_bf16_f32 v89, v90, v91
    ds_pk_add_bf16 v7, v88
    ds_pk_add_bf16 v7, v89 offset:4
    s_mov_b64 exec, vcc
    s_branch L2_d13
L2_c14:
    s_mov_b64 exec, s[82:83]
    s_nop 1
    v_mfma_f32_4x4x4_16b_bf16 v[88:91], v[12:13], v[84:85], 0
    s_nop 1
    v_mfma_f32_4x4x4_16b_bf16 v[88:91], v[10:11], v[86:87], v[88:91]
    s_nop 4
    v_cvt_pk_bf16_f32 v88, v88, v89
    v_cvt_pk_bf16_f32 v89, v90, v91
    ds_pk_add_bf16 v7, v88
    ds_pk_add_bf16 v7, v89 offset:4
    s_mov_b64 exec, vcc
    s_branch L2_d14
L2_c15:
    s_mov_b64 exec, s[82:83]
    s_nop 1
    v_mfma_f32_4x4x4_16b_bf16 v[88:91], v[12:13], v[84:85], 0
    s_nop 1
    v_mfma_f32_4x4x4_16b_bf16 v[88:91], v[10:11], v[86:87], v[88:91]
    s_nop 4
    v_cvt_pk_bf16_f32 v88, v88, v89
    v_cvt_pk_bf16_f32 v89, v90, v91
    ds_pk_add_bf16 v7, v88
    ds_pk_add_bf16 v7, v89 offset:4
    s_mov_b64 exec, vcc
    s_branch L2_d15
L2_c16:
    s_mov_b64 exec, s[82:83]
    s_nop 1
    v_mfma_f32_4x4x4_16b_bf16 v[88:91], v[12:13], v[84:85], 0
    s_nop 1
    v_mfma_f32_4x4x4_16b_bf16 v[88:91], v[10:11], v[86:87], v[88:91]
    s_nop 4
    v_cvt_pk_bf16_f32 v88, v88, v89
    v_cvt_pk_bf16_f32 v89, v90, v91
    ds_pk_add_bf16 v7, v88
    ds_pk_add_bf16 v7, v89 offset:4
    s_mov_b64 exec, vcc
    s_branch L2_d16
L2_c17:
    s_mov_b64 exec, s[82:83]
    s_nop 1
    v_mfma_f32_4x4x4_16b_bf16 v[88:91], v[12:13], v[84:85], 0
    s_nop 1
    v_mfma_f32_4x4x4_16b_bf16 v[88:91], v[10:11], v[86:87], v[88:91]
    s_nop 4
    v_cvt_pk_bf16_f32 v88, v88, v89
    v_cvt_pk_bf16_f32 v89, v90, v91
    ds_pk_add_bf16 v7, v88
    ds_pk_add_bf16 v7, v89 offset:4
    s_mov_b64 exec, vcc
    s_branch L2_d17
L2_c18:
    s_mov_b64 exec, s[82:83]
    s_nop 1
    v_mfma_f32_4x4x4_16b_bf16 v[88:91], v[12:13], v[84:85], 0
    s_nop 1
    v_mfma_f32_4x4x4_16b_bf16 v[88:91], v[10:11], v[86:87], v[88:91]
    s_nop 4
    v_cvt_pk_bf16_f32 v88, v88, v89
    v_cvt_pk_bf16_f32 v89, v90, v91
    ds_pk_add_bf16 v7, v88
    ds_pk_add_bf16 v7, v89 offset:4
    s_mov_b64 exec, vcc
    s_branch L2_d18
L2_c19:
    s_mov_b64 exec, s[82:83]
    s_nop 1
    v_mfma_f32_4x4x4_16b_bf16 v[88:91], v[12:13], v[84:85], 0
    s_nop 1
    v_mfma_f32_4x4x4_16b_bf16 v[88:91], v[10:11], v[86:87], v[88:91]
    s_nop 4
    v_cvt_pk_bf16_f32 v88, v88, v89
    v_cvt_pk_bf16_f32 v89, v90, v91
    ds_pk_add_bf16 v7, v88
    ds_pk_add_bf16 v7, v89 offset:4
    s_mov_b64 exec, vcc
    s_branch L2_d19
L2_xa20:
    s_cmp_eq_u32 s43, 1
    s_cbranch_scc1 L2_xc20
    v_lshlrev_b32 v89, 0, v96
    v_add_u32 v90, 140, v97
    v_bitop3_b32 v90, v89, v45, v90 bitop3:0x6a
    ds_write_b32 v98, v90 offset:28
    v_lshlrev_b32 v89, 4, v96
    v_add_u32 v90, 120, v97
    v_bitop3_b32 v90, v89, v45, v90 bitop3:0x6a
    ds_write_b32 v98, v90 offset:24
    v_lshlrev_b32 v89, 8, v96
    v_add_u32 v90, 100, v97
    v_bitop3_b32 v90, v89, v45, v90 bitop3:0x6a
    ds_write_b32 v98, v90 offset:20
L2_xc20:
    v_lshlrev_b32 v89, 12, v96
    v_add_u32 v90, 80, v97
    v_bitop3_b32 v90, v89, v45, v90 bitop3:0x6a
    ds_write_b32 v98, v90 offset:16
    s_branch L2_xb20
L2_xe20:
    v_cmp_lt_u32 vcc, 32, v99
    v_cmp_lt_u32 s[58:59], 31, v88
    v_lshrrev_b32 v89, 16, v96
    v_add_u32 v97, 80, v97
    s_or_b64 vcc, vcc, s[58:59]
    s_cbranch_scc1 L2_xs20
    v_lshlrev_b32 v89, v1, v89
    v_and_b32 v89, v45, v89
    v_cmp_ne_u32 vcc, 0, v89
    v_xor_b32 v90, v97, v89
    s_add_u32 s3, s37, s38
    v_mbcnt_lo_u32_b32 v98, vcc_lo, 0
    v_mbcnt_hi_u32_b32 v98, vcc_hi, v98
    s_bcnt1_i32_b64 s41, vcc
    v_lshl_add_u32 v98, v98, 2, s3
    s_mov_b64 exec, vcc
    ds_write_b32 v98, v90
    s_mov_b64 exec, -1
    s_lshl2_add_u32 s37, s41, s37
    s_branch L2_xr20
L2_xf20:
    s_waitcnt lgkmcnt(0)
    s_cmp_gt_u32 s37, 1024
    s_cbranch_scc1 L2_xs20
    v_mov_b32 v43, -1
    s_cmp_ge_u32 s37, 512
    s_cbranch_scc1 L2_xg20
    v_mov_b32 v42, -1
    s_cmp_ge_u32 s37, 256
    s_cbranch_scc1 L2_xg20
    v_mov_b32 v41, -1
    s_branch L2_xg20
L2_xs20:
    s_waitcnt lgkmcnt(0)
    v_mov_b32 v40, -1
    v_mov_b32 v41, -1
    v_mov_b32 v42, -1
    v_mov_b32 v43, -1
    s_add_u32 s3, s42, 2
    s_bitset1_b32 s36, s3
    s_branch L2_xg20
L2_c21:
    s_mov_b64 exec, s[82:83]
    s_nop 1
    v_mfma_f32_4x4x4_16b_bf16 v[88:91], v[12:13], v[84:85], 0
    s_nop 1
    v_mfma_f32_4x4x4_16b_bf16 v[88:91], v[10:11], v[86:87], v[88:91]
    s_nop 4
    v_cvt_pk_bf16_f32 v88, v88, v89
    v_cvt_pk_bf16_f32 v89, v90, v91
    ds_pk_add_bf16 v7, v88
    ds_pk_add_bf16 v7, v89 offset:4
    s_mov_b64 exec, vcc
    s_branch L2_d21
L2_c22:
    s_mov_b64 exec, s[82:83]
    s_nop 1
    v_mfma_f32_4x4x4_16b_bf16 v[88:91], v[12:13], v[84:85], 0
    s_nop 1
    v_mfma_f32_4x4x4_16b_bf16 v[88:91], v[10:11], v[86:87], v[88:91]
    s_nop 4
    v_cvt_pk_bf16_f32 v88, v88, v89
    v_cvt_pk_bf16_f32 v89, v90, v91
    ds_pk_add_bf16 v7, v88
    ds_pk_add_bf16 v7, v89 offset:4
    s_mov_b64 exec, vcc
    s_branch L2_d22
L2_c23:
    s_mov_b64 exec, s[82:83]
    s_nop 1
    v_mfma_f32_4x4x4_16b_bf16 v[88:91], v[12:13], v[84:85], 0
    s_nop 1
    v_mfma_f32_4x4x4_16b_bf16 v[88:91], v[10:11], v[86:87], v[88:91]
    s_nop 4
    v_cvt_pk_bf16_f32 v88, v88, v89
    v_cvt_pk_bf16_f32 v89, v90, v91
    ds_pk_add_bf16 v7, v88
    ds_pk_add_bf16 v7, v89 offset:4
    s_mov_b64 exec, vcc
    s_branch L2_d23
L2_c24:
    s_mov_b64 exec, s[82:83]
    s_nop 1
    v_mfma_f32_4x4x4_16b_bf16 v[88:91], v[12:13], v[84:85], 0
    s_nop 1
    v_mfma_f32_4x4x4_16b_bf16 v[88:91], v[10:11], v[86:87], v[88:91]
    s_nop 4
    v_cvt_pk_bf16_f32 v88, v88, v89
    v_cvt_pk_bf16_f32 v89, v90, v91
    ds_pk_add_bf16 v7, v88
    ds_pk_add_bf16 v7, v89 offset:4
    s_mov_b64 exec, vcc
    s_branch L2_d24
L2_c25:
    s_mov_b64 exec, s[82:83]
    s_nop 1
    v_mfma_f32_4x4x4_16b_bf16 v[88:91], v[12:13], v[84:85], 0
    s_nop 1
    v_mfma_f32_4x4x4_16b_bf16 v[88:91], v[10:11], v[86:87], v[88:91]
    s_nop 4
    v_cvt_pk_bf16_f32 v88, v88, v89
    v_cvt_pk_bf16_f32 v89, v90, v91
    ds_pk_add_bf16 v7, v88
    ds_pk_add_bf16 v7, v89 offset:4
    s_mov_b64 exec, vcc
    s_branch L2_d25
L2_c26:
    s_mov_b64 exec, s[82:83]
    s_nop 1
    v_mfma_f32_4x4x4_16b_bf16 v[88:91], v[12:13], v[84:85], 0
    s_nop 1
    v_mfma_f32_4x4x4_16b_bf16 v[88:91], v[10:11], v[86:87], v[88:91]
    s_nop 4
    v_cvt_pk_bf16_f32 v88, v88, v89
    v_cvt_pk_bf16_f32 v89, v90, v91
    ds_pk_add_bf16 v7, v88
    ds_pk_add_bf16 v7, v89 offset:4
    s_mov_b64 exec, vcc
    s_branch L2_d26
L2_c27:
    s_mov_b64 exec, s[82:83]
    s_nop 1
    v_mfma_f32_4x4x4_16b_bf16 v[88:91], v[12:13], v[84:85], 0
    s_nop 1
    v_mfma_f32_4x4x4_16b_bf16 v[88:91], v[10:11], v[86:87], v[88:91]
    s_nop 4
    v_cvt_pk_bf16_f32 v88, v88, v89
    v_cvt_pk_bf16_f32 v89, v90, v91
    ds_pk_add_bf16 v7, v88
    ds_pk_add_bf16 v7, v89 offset:4
    s_mov_b64 exec, vcc
    s_branch L2_d27
L2_c28:
    s_mov_b64 exec, s[82:83]
    s_nop 1
    v_mfma_f32_4x4x4_16b_bf16 v[88:91], v[12:13], v[84:85], 0
    s_nop 1
    v_mfma_f32_4x4x4_16b_bf16 v[88:91], v[10:11], v[86:87], v[88:91]
    s_nop 4
    v_cvt_pk_bf16_f32 v88, v88, v89
    v_cvt_pk_bf16_f32 v89, v90, v91
    ds_pk_add_bf16 v7, v88
    ds_pk_add_bf16 v7, v89 offset:4
    s_mov_b64 exec, vcc
    s_branch L2_d28
L2_xo29:
    v_cmp_lt_u32 vcc, 20, v99
    s_mov_b32 s43, 1
    s_cbranch_vccz L2_xp29
    v_cmp_lt_u32 vcc, 32, v99
    v_cmp_lt_u32 s[58:59], 31, v88
    s_mov_b32 s43, 2
    s_or_b64 vcc, vcc, s[58:59]
    s_cbranch_scc0 L2_xp29
    s_mov_b32 s37, 0x10000
    s_branch L2_xp29
L2_c30:
    s_mov_b64 exec, s[82:83]
    s_nop 1
    v_mfma_f32_4x4x4_16b_bf16 v[88:91], v[12:13], v[84:85], 0
    s_nop 1
    v_mfma_f32_4x4x4_16b_bf16 v[88:91], v[10:11], v[86:87], v[88:91]
    s_nop 4
    v_cvt_pk_bf16_f32 v88, v88, v89
    v_cvt_pk_bf16_f32 v89, v90, v91
    ds_pk_add_bf16 v7, v88
    ds_pk_add_bf16 v7, v89 offset:4
    s_mov_b64 exec, vcc
    s_branch L2_d30
L2_c31:
    s_mov_b64 exec, s[82:83]
    s_nop 1
    v_mfma_f32_4x4x4_16b_bf16 v[88:91], v[12:13], v[84:85], 0
    s_nop 1
    v_mfma_f32_4x4x4_16b_bf16 v[88:91], v[10:11], v[86:87], v[88:91]
    s_nop 4
    v_cvt_pk_bf16_f32 v88, v88, v89
    v_cvt_pk_bf16_f32 v89, v90, v91
    ds_pk_add_bf16 v7, v88
    ds_pk_add_bf16 v7, v89 offset:4
    s_mov_b64 exec, vcc
    s_branch L2_d31
L2_c32:
    s_mov_b64 exec, s[82:83]
    s_nop 1
    v_mfma_f32_4x4x4_16b_bf16 v[88:91], v[12:13], v[84:85], 0
    s_nop 1
    v_mfma_f32_4x4x4_16b_bf16 v[88:91], v[10:11], v[86:87], v[88:91]
    s_nop 4
    v_cvt_pk_bf16_f32 v88, v88, v89
    v_cvt_pk_bf16_f32 v89, v90, v91
    ds_pk_add_bf16 v7, v88
    ds_pk_add_bf16 v7, v89 offset:4
    s_mov_b64 exec, vcc
    s_branch L2_d32
L2_c33:
    s_mov_b64 exec, s[82:83]
    s_nop 1
    v_mfma_f32_4x4x4_16b_bf16 v[88:91], v[12:13], v[84:85], 0
    s_nop 1
    v_mfma_f32_4x4x4_16b_bf16 v[88:91], v[10:11], v[86:87], v[88:91]
    s_nop 4
    v_cvt_pk_bf16_f32 v88, v88, v89
    v_cvt_pk_bf16_f32 v89, v90, v91
    ds_pk_add_bf16 v7, v88
    ds_pk_add_bf16 v7, v89 offset:4
    s_mov_b64 exec, vcc
    s_branch L2_d33
L2_c34:
    s_mov_b64 exec, s[82:83]
    s_nop 1
    v_mfma_f32_4x4x4_16b_bf16 v[88:91], v[12:13], v[84:85], 0
    s_nop 1
    v_mfma_f32_4x4x4_16b_bf16 v[88:91], v[10:11], v[86:87], v[88:91]
    s_nop 4
    v_cvt_pk_bf16_f32 v88, v88, v89
    v_cvt_pk_bf16_f32 v89, v90, v91
    ds_pk_add_bf16 v7, v88
    ds_pk_add_bf16 v7, v89 offset:4
    s_mov_b64 exec, vcc
    s_branch L2_d34
L2_c35:
    s_mov_b64 exec, s[82:83]
    s_nop 1
    v_mfma_f32_4x4x4_16b_bf16 v[88:91], v[12:13], v[84:85], 0
    s_nop 1
    v_mfma_f32_4x4x4_16b_bf16 v[88:91], v[10:11], v[86:87], v[88:91]
    s_nop 4
    v_cvt_pk_bf16_f32 v88, v88, v89
    v_cvt_pk_bf16_f32 v89, v90, v91
    ds_pk_add_bf16 v7, v88
    ds_pk_add_bf16 v7, v89 offset:4
    s_mov_b64 exec, vcc
    s_branch L2_d35
L2_c36:
    s_mov_b64 exec, s[82:83]
    s_nop 1
    v_mfma_f32_4x4x4_16b_bf16 v[88:91], v[12:13], v[84:85], 0
    s_nop 1
    v_mfma_f32_4x4x4_16b_bf16 v[88:91], v[10:11], v[86:87], v[88:91]
    s_nop 4
    v_cvt_pk_bf16_f32 v88, v88, v89
    v_cvt_pk_bf16_f32 v89, v90, v91
    ds_pk_add_bf16 v7, v88
    ds_pk_add_bf16 v7, v89 offset:4
    s_mov_b64 exec, vcc
    s_branch L2_d36
L2_c37:
    s_mov_b64 exec, s[82:83]
    s_nop 1
    v_mfma_f32_4x4x4_16b_bf16 v[88:91], v[12:13], v[84:85], 0
    s_nop 1
    v_mfma_f32_4x4x4_16b_bf16 v[88:91], v[10:11], v[86:87], v[88:91]
    s_nop 4
    v_cvt_pk_bf16_f32 v88, v88, v89
    v_cvt_pk_bf16_f32 v89, v90, v91
    ds_pk_add_bf16 v7, v88
    ds_pk_add_bf16 v7, v89 offset:4
    s_mov_b64 exec, vcc
    s_branch L2_d37
L2_xa38:
    s_cmp_eq_u32 s43, 1
    s_cbranch_scc1 L2_xc38
    v_lshlrev_b32 v89, 0, v96
    v_add_u32 v90, 140, v97
    v_bitop3_b32 v90, v89, v45, v90 bitop3:0x6a
    ds_write_b32 v98, v90 offset:28
    v_lshlrev_b32 v89, 4, v96
    v_add_u32 v90, 120, v97
    v_bitop3_b32 v90, v89, v45, v90 bitop3:0x6a
    ds_write_b32 v98, v90 offset:24
    v_lshlrev_b32 v89, 8, v96
    v_add_u32 v90, 100, v97
    v_bitop3_b32 v90, v89, v45, v90 bitop3:0x6a
    ds_write_b32 v98, v90 offset:20
L2_xc38:
    v_lshlrev_b32 v89, 12, v96
    v_add_u32 v90, 80, v97
    v_bitop3_b32 v90, v89, v45, v90 bitop3:0x6a
    ds_write_b32 v98, v90 offset:16
    s_branch L2_xb38
L2_xe38:
    v_cmp_lt_u32 vcc, 32, v99
    v_cmp_lt_u32 s[58:59], 31, v88
    v_lshrrev_b32 v89, 16, v96
    v_add_u32 v97, 80, v97
    s_or_b64 vcc, vcc, s[58:59]
    s_cbranch_scc1 L2_xs38
    v_lshlrev_b32 v89, v1, v89
    v_and_b32 v89, v45, v89
    v_cmp_ne_u32 vcc, 0, v89
    v_xor_b32 v90, v97, v89
    s_add_u32 s3, s37, s38
    v_mbcnt_lo_u32_b32 v98, vcc_lo, 0
    v_mbcnt_hi_u32_b32 v98, vcc_hi, v98
    s_bcnt1_i32_b64 s41, vcc
    v_lshl_add_u32 v98, v98, 2, s3
    s_mov_b64 exec, vcc
    ds_write_b32 v98, v90
    s_mov_b64 exec, -1
    s_lshl2_add_u32 s37, s41, s37
    s_branch L2_xr38
L2_xf38:
    s_waitcnt lgkmcnt(0)
    s_cmp_gt_u32 s37, 1024
    s_cbranch_scc1 L2_xs38
    v_mov_b32 v43, -1
    s_cmp_ge_u32 s37, 512
    s_cbranch_scc1 L2_xg38
    v_mov_b32 v42, -1
    s_cmp_ge_u32 s37, 256
    s_cbranch_scc1 L2_xg38
    v_mov_b32 v41, -1
    s_branch L2_xg38
L2_xs38:
    s_waitcnt lgkmcnt(0)
    v_mov_b32 v40, -1
    v_mov_b32 v41, -1
    v_mov_b32 v42, -1
    v_mov_b32 v43, -1
    s_add_u32 s3, s42, 2
    s_bitset1_b32 s36, s3
    s_branch L2_xg38
L2_c39:
    s_mov_b64 exec, s[82:83]
    s_nop 1
    v_mfma_f32_4x4x4_16b_bf16 v[88:91], v[12:13], v[84:85], 0
    s_nop 1
    v_mfma_f32_4x4x4_16b_bf16 v[88:91], v[10:11], v[86:87], v[88:91]
    s_nop 4
    v_cvt_pk_bf16_f32 v88, v88, v89
    v_cvt_pk_bf16_f32 v89, v90, v91
    ds_pk_add_bf16 v7, v88
    ds_pk_add_bf16 v7, v89 offset:4
    s_mov_b64 exec, vcc
    s_branch L2_d39
L2_c40:
    s_mov_b64 exec, s[82:83]
    s_nop 1
    v_mfma_f32_4x4x4_16b_bf16 v[88:91], v[12:13], v[84:85], 0
    s_nop 1
    v_mfma_f32_4x4x4_16b_bf16 v[88:91], v[10:11], v[86:87], v[88:91]
    s_nop 4
    v_cvt_pk_bf16_f32 v88, v88, v89
    v_cvt_pk_bf16_f32 v89, v90, v91
    ds_pk_add_bf16 v7, v88
    ds_pk_add_bf16 v7, v89 offset:4
    s_mov_b64 exec, vcc
    s_branch L2_d40
L2_c41:
    s_mov_b64 exec, s[82:83]
    s_nop 1
    v_mfma_f32_4x4x4_16b_bf16 v[88:91], v[12:13], v[84:85], 0
    s_nop 1
    v_mfma_f32_4x4x4_16b_bf16 v[88:91], v[10:11], v[86:87], v[88:91]
    s_nop 4
    v_cvt_pk_bf16_f32 v88, v88, v89
    v_cvt_pk_bf16_f32 v89, v90, v91
    ds_pk_add_bf16 v7, v88
    ds_pk_add_bf16 v7, v89 offset:4
    s_mov_b64 exec, vcc
    s_branch L2_d41
L2_c42:
    s_mov_b64 exec, s[82:83]
    s_nop 1
    v_mfma_f32_4x4x4_16b_bf16 v[88:91], v[12:13], v[84:85], 0
    s_nop 1
    v_mfma_f32_4x4x4_16b_bf16 v[88:91], v[10:11], v[86:87], v[88:91]
    s_nop 4
    v_cvt_pk_bf16_f32 v88, v88, v89
    v_cvt_pk_bf16_f32 v89, v90, v91
    ds_pk_add_bf16 v7, v88
    ds_pk_add_bf16 v7, v89 offset:4
    s_mov_b64 exec, vcc
    s_branch L2_d42
L2_c43:
    s_mov_b64 exec, s[82:83]
    s_nop 1
    v_mfma_f32_4x4x4_16b_bf16 v[88:91], v[12:13], v[84:85], 0
    s_nop 1
    v_mfma_f32_4x4x4_16b_bf16 v[88:91], v[10:11], v[86:87], v[88:91]
    s_nop 4
    v_cvt_pk_bf16_f32 v88, v88, v89
    v_cvt_pk_bf16_f32 v89, v90, v91
    ds_pk_add_bf16 v7, v88
    ds_pk_add_bf16 v7, v89 offset:4
    s_mov_b64 exec, vcc
    s_branch L2_d43
L2_c44:
    s_mov_b64 exec, s[82:83]
    s_nop 1
    v_mfma_f32_4x4x4_16b_bf16 v[88:91], v[12:13], v[84:85], 0
    s_nop 1
    v_mfma_f32_4x4x4_16b_bf16 v[88:91], v[10:11], v[86:87], v[88:91]
    s_nop 4
    v_cvt_pk_bf16_f32 v88, v88, v89
    v_cvt_pk_bf16_f32 v89, v90, v91
    ds_pk_add_bf16 v7, v88
    ds_pk_add_bf16 v7, v89 offset:4
    s_mov_b64 exec, vcc
    s_branch L2_d44
L2_c45:
    s_mov_b64 exec, s[82:83]
    s_nop 1
    v_mfma_f32_4x4x4_16b_bf16 v[88:91], v[12:13], v[84:85], 0
    s_nop 1
    v_mfma_f32_4x4x4_16b_bf16 v[88:91], v[10:11], v[86:87], v[88:91]
    s_nop 4
    v_cvt_pk_bf16_f32 v88, v88, v89
    v_cvt_pk_bf16_f32 v89, v90, v91
    ds_pk_add_bf16 v7, v88
    ds_pk_add_bf16 v7, v89 offset:4
    s_mov_b64 exec, vcc
    s_branch L2_d45
L2_c46:
    s_mov_b64 exec, s[82:83]
    s_nop 1
    v_mfma_f32_4x4x4_16b_bf16 v[88:91], v[12:13], v[84:85], 0
    s_nop 1
    v_mfma_f32_4x4x4_16b_bf16 v[88:91], v[10:11], v[86:87], v[88:91]
    s_nop 4
    v_cvt_pk_bf16_f32 v88, v88, v89
    v_cvt_pk_bf16_f32 v89, v90, v91
    ds_pk_add_bf16 v7, v88
    ds_pk_add_bf16 v7, v89 offset:4
    s_mov_b64 exec, vcc
    s_branch L2_d46
L2_xo47:
    v_cmp_lt_u32 vcc, 20, v99
    s_mov_b32 s43, 1
    s_cbranch_vccz L2_xp47
    v_cmp_lt_u32 vcc, 32, v99
    v_cmp_lt_u32 s[58:59], 31, v88
    s_mov_b32 s43, 2
    s_or_b64 vcc, vcc, s[58:59]
    s_cbranch_scc0 L2_xp47
    s_mov_b32 s37, 0x10000
    s_branch L2_xp47
L2_c48:
    s_mov_b64 exec, s[82:83]
    s_nop 1
    v_mfma_f32_4x4x4_16b_bf16 v[88:91], v[12:13], v[84:85], 0
    s_nop 1
    v_mfma_f32_4x4x4_16b_bf16 v[88:91], v[10:11], v[86:87], v[88:91]
    s_nop 4
    v_cvt_pk_bf16_f32 v88, v88, v89
    v_cvt_pk_bf16_f32 v89, v90, v91
    ds_pk_add_bf16 v7, v88
    ds_pk_add_bf16 v7, v89 offset:4
    s_mov_b64 exec, vcc
    s_branch L2_d48
L2_c49:
    s_mov_b64 exec, s[82:83]
    s_nop 1
    v_mfma_f32_4x4x4_16b_bf16 v[88:91], v[12:13], v[84:85], 0
    s_nop 1
    v_mfma_f32_4x4x4_16b_bf16 v[88:91], v[10:11], v[86:87], v[88:91]
    s_nop 4
    v_cvt_pk_bf16_f32 v88, v88, v89
    v_cvt_pk_bf16_f32 v89, v90, v91
    ds_pk_add_bf16 v7, v88
    ds_pk_add_bf16 v7, v89 offset:4
    s_mov_b64 exec, vcc
    s_branch L2_d49
L2_c50:
    s_mov_b64 exec, s[82:83]
    s_nop 1
    v_mfma_f32_4x4x4_16b_bf16 v[88:91], v[12:13], v[84:85], 0
    s_nop 1
    v_mfma_f32_4x4x4_16b_bf16 v[88:91], v[10:11], v[86:87], v[88:91]
    s_nop 4
    v_cvt_pk_bf16_f32 v88, v88, v89
    v_cvt_pk_bf16_f32 v89, v90, v91
    ds_pk_add_bf16 v7, v88
    ds_pk_add_bf16 v7, v89 offset:4
    s_mov_b64 exec, vcc
    s_branch L2_d50
L2_c51:
    s_mov_b64 exec, s[82:83]
    s_nop 1
    v_mfma_f32_4x4x4_16b_bf16 v[88:91], v[12:13], v[84:85], 0
    s_nop 1
    v_mfma_f32_4x4x4_16b_bf16 v[88:91], v[10:11], v[86:87], v[88:91]
    s_nop 4
    v_cvt_pk_bf16_f32 v88, v88, v89
    v_cvt_pk_bf16_f32 v89, v90, v91
    ds_pk_add_bf16 v7, v88
    ds_pk_add_bf16 v7, v89 offset:4
    s_mov_b64 exec, vcc
    s_branch L2_d51
L2_c52:
    s_mov_b64 exec, s[82:83]
    s_nop 1
    v_mfma_f32_4x4x4_16b_bf16 v[88:91], v[12:13], v[84:85], 0
    s_nop 1
    v_mfma_f32_4x4x4_16b_bf16 v[88:91], v[10:11], v[86:87], v[88:91]
    s_nop 4
    v_cvt_pk_bf16_f32 v88, v88, v89
    v_cvt_pk_bf16_f32 v89, v90, v91
    ds_pk_add_bf16 v7, v88
    ds_pk_add_bf16 v7, v89 offset:4
    s_mov_b64 exec, vcc
    s_branch L2_d52
L2_c53:
    s_mov_b64 exec, s[82:83]
    s_nop 1
    v_mfma_f32_4x4x4_16b_bf16 v[88:91], v[12:13], v[84:85], 0
    s_nop 1
    v_mfma_f32_4x4x4_16b_bf16 v[88:91], v[10:11], v[86:87], v[88:91]
    s_nop 4
    v_cvt_pk_bf16_f32 v88, v88, v89
    v_cvt_pk_bf16_f32 v89, v90, v91
    ds_pk_add_bf16 v7, v88
    ds_pk_add_bf16 v7, v89 offset:4
    s_mov_b64 exec, vcc
    s_branch L2_d53
L2_c54:
    s_mov_b64 exec, s[82:83]
    s_nop 1
    v_mfma_f32_4x4x4_16b_bf16 v[88:91], v[12:13], v[84:85], 0
    s_nop 1
    v_mfma_f32_4x4x4_16b_bf16 v[88:91], v[10:11], v[86:87], v[88:91]
    s_nop 4
    v_cvt_pk_bf16_f32 v88, v88, v89
    v_cvt_pk_bf16_f32 v89, v90, v91
    ds_pk_add_bf16 v7, v88
    ds_pk_add_bf16 v7, v89 offset:4
    s_mov_b64 exec, vcc
    s_branch L2_d54
L2_c55:
    s_mov_b64 exec, s[82:83]
    s_nop 1
    v_mfma_f32_4x4x4_16b_bf16 v[88:91], v[12:13], v[84:85], 0
    s_nop 1
    v_mfma_f32_4x4x4_16b_bf16 v[88:91], v[10:11], v[86:87], v[88:91]
    s_nop 4
    v_cvt_pk_bf16_f32 v88, v88, v89
    v_cvt_pk_bf16_f32 v89, v90, v91
    ds_pk_add_bf16 v7, v88
    ds_pk_add_bf16 v7, v89 offset:4
    s_mov_b64 exec, vcc
    s_branch L2_d55
L2_xa56:
    s_cmp_eq_u32 s43, 1
    s_cbranch_scc1 L2_xc56
    v_lshlrev_b32 v89, 0, v96
    v_add_u32 v90, 140, v97
    v_bitop3_b32 v90, v89, v45, v90 bitop3:0x6a
    ds_write_b32 v98, v90 offset:28
    v_lshlrev_b32 v89, 4, v96
    v_add_u32 v90, 120, v97
    v_bitop3_b32 v90, v89, v45, v90 bitop3:0x6a
    ds_write_b32 v98, v90 offset:24
    v_lshlrev_b32 v89, 8, v96
    v_add_u32 v90, 100, v97
    v_bitop3_b32 v90, v89, v45, v90 bitop3:0x6a
    ds_write_b32 v98, v90 offset:20
L2_xc56:
    v_lshlrev_b32 v89, 12, v96
    v_add_u32 v90, 80, v97
    v_bitop3_b32 v90, v89, v45, v90 bitop3:0x6a
    ds_write_b32 v98, v90 offset:16
    s_branch L2_xb56
L2_xe56:
    v_cmp_lt_u32 vcc, 32, v99
    v_cmp_lt_u32 s[58:59], 31, v88
    v_lshrrev_b32 v89, 16, v96
    v_add_u32 v97, 80, v97
    s_or_b64 vcc, vcc, s[58:59]
    s_cbranch_scc1 L2_xs56
    v_lshlrev_b32 v89, v1, v89
    v_and_b32 v89, v45, v89
    v_cmp_ne_u32 vcc, 0, v89
    v_xor_b32 v90, v97, v89
    s_add_u32 s3, s37, s38
    v_mbcnt_lo_u32_b32 v98, vcc_lo, 0
    v_mbcnt_hi_u32_b32 v98, vcc_hi, v98
    s_bcnt1_i32_b64 s41, vcc
    v_lshl_add_u32 v98, v98, 2, s3
    s_mov_b64 exec, vcc
    ds_write_b32 v98, v90
    s_mov_b64 exec, -1
    s_lshl2_add_u32 s37, s41, s37
    s_branch L2_xr56
L2_xf56:
    s_waitcnt lgkmcnt(0)
    s_cmp_gt_u32 s37, 1024
    s_cbranch_scc1 L2_xs56
    v_mov_b32 v43, -1
    s_cmp_ge_u32 s37, 512
    s_cbranch_scc1 L2_xg56
    v_mov_b32 v42, -1
    s_cmp_ge_u32 s37, 256
    s_cbranch_scc1 L2_xg56
    v_mov_b32 v41, -1
    s_branch L2_xg56
L2_xs56:
    s_waitcnt lgkmcnt(0)
    v_mov_b32 v40, -1
    v_mov_b32 v41, -1
    v_mov_b32 v42, -1
    v_mov_b32 v43, -1
    s_add_u32 s3, s42, 2
    s_bitset1_b32 s36, s3
    s_branch L2_xg56
L2_c57:
    s_mov_b64 exec, s[82:83]
    s_nop 1
    v_mfma_f32_4x4x4_16b_bf16 v[88:91], v[12:13], v[84:85], 0
    s_nop 1
    v_mfma_f32_4x4x4_16b_bf16 v[88:91], v[10:11], v[86:87], v[88:91]
    s_nop 4
    v_cvt_pk_bf16_f32 v88, v88, v89
    v_cvt_pk_bf16_f32 v89, v90, v91
    ds_pk_add_bf16 v7, v88
    ds_pk_add_bf16 v7, v89 offset:4
    s_mov_b64 exec, vcc
    s_branch L2_d57
L2_c58:
    s_mov_b64 exec, s[82:83]
    s_nop 1
    v_mfma_f32_4x4x4_16b_bf16 v[88:91], v[12:13], v[84:85], 0
    s_nop 1
    v_mfma_f32_4x4x4_16b_bf16 v[88:91], v[10:11], v[86:87], v[88:91]
    s_nop 4
    v_cvt_pk_bf16_f32 v88, v88, v89
    v_cvt_pk_bf16_f32 v89, v90, v91
    ds_pk_add_bf16 v7, v88
    ds_pk_add_bf16 v7, v89 offset:4
    s_mov_b64 exec, vcc
    s_branch L2_d58
L2_c59:
    s_mov_b64 exec, s[82:83]
    s_nop 1
    v_mfma_f32_4x4x4_16b_bf16 v[88:91], v[12:13], v[84:85], 0
    s_nop 1
    v_mfma_f32_4x4x4_16b_bf16 v[88:91], v[10:11], v[86:87], v[88:91]
    s_nop 4
    v_cvt_pk_bf16_f32 v88, v88, v89
    v_cvt_pk_bf16_f32 v89, v90, v91
    ds_pk_add_bf16 v7, v88
    ds_pk_add_bf16 v7, v89 offset:4
    s_mov_b64 exec, vcc
    s_branch L2_d59
L2_c60:
    s_mov_b64 exec, s[82:83]
    s_nop 1
    v_mfma_f32_4x4x4_16b_bf16 v[88:91], v[12:13], v[84:85], 0
    s_nop 1
    v_mfma_f32_4x4x4_16b_bf16 v[88:91], v[10:11], v[86:87], v[88:91]
    s_nop 4
    v_cvt_pk_bf16_f32 v88, v88, v89
    v_cvt_pk_bf16_f32 v89, v90, v91
    ds_pk_add_bf16 v7, v88
    ds_pk_add_bf16 v7, v89 offset:4
    s_mov_b64 exec, vcc
    s_branch L2_d60
L2_c61:
    s_mov_b64 exec, s[82:83]
    s_nop 1
    v_mfma_f32_4x4x4_16b_bf16 v[88:91], v[12:13], v[84:85], 0
    s_nop 1
    v_mfma_f32_4x4x4_16b_bf16 v[88:91], v[10:11], v[86:87], v[88:91]
    s_nop 4
    v_cvt_pk_bf16_f32 v88, v88, v89
    v_cvt_pk_bf16_f32 v89, v90, v91
    ds_pk_add_bf16 v7, v88
    ds_pk_add_bf16 v7, v89 offset:4
    s_mov_b64 exec, vcc
    s_branch L2_d61
L2_c62:
    s_mov_b64 exec, s[82:83]
    s_nop 1
    v_mfma_f32_4x4x4_16b_bf16 v[88:91], v[12:13], v[84:85], 0
    s_nop 1
    v_mfma_f32_4x4x4_16b_bf16 v[88:91], v[10:11], v[86:87], v[88:91]
    s_nop 4
    v_cvt_pk_bf16_f32 v88, v88, v89
    v_cvt_pk_bf16_f32 v89, v90, v91
    ds_pk_add_bf16 v7, v88
    ds_pk_add_bf16 v7, v89 offset:4
    s_mov_b64 exec, vcc
    s_branch L2_d62
L2_c63:
    s_mov_b64 exec, s[82:83]
    s_nop 1
    v_mfma_f32_4x4x4_16b_bf16 v[88:91], v[12:13], v[84:85], 0
    s_nop 1
    v_mfma_f32_4x4x4_16b_bf16 v[88:91], v[10:11], v[86:87], v[88:91]
    s_nop 4
    v_cvt_pk_bf16_f32 v88, v88, v89
    v_cvt_pk_bf16_f32 v89, v90, v91
    ds_pk_add_bf16 v7, v88
    ds_pk_add_bf16 v7, v89 offset:4
    s_mov_b64 exec, vcc
    s_branch L2_d63
L2_c64:
    s_mov_b64 exec, s[82:83]
    s_nop 1
    v_mfma_f32_4x4x4_16b_bf16 v[88:91], v[12:13], v[84:85], 0
    s_nop 1
    v_mfma_f32_4x4x4_16b_bf16 v[88:91], v[10:11], v[86:87], v[88:91]
    s_nop 4
    v_cvt_pk_bf16_f32 v88, v88, v89
    v_cvt_pk_bf16_f32 v89, v90, v91
    ds_pk_add_bf16 v7, v88
    ds_pk_add_bf16 v7, v89 offset:4
    s_mov_b64 exec, vcc
    s_branch L2_d64
L2_xo65:
    v_cmp_lt_u32 vcc, 20, v99
    s_mov_b32 s43, 1
    s_cbranch_vccz L2_xp65
    v_cmp_lt_u32 vcc, 32, v99
    v_cmp_lt_u32 s[58:59], 31, v88
    s_mov_b32 s43, 2
    s_or_b64 vcc, vcc, s[58:59]
    s_cbranch_scc0 L2_xp65
    s_mov_b32 s37, 0x10000
    s_branch L2_xp65
L2_c66:
    s_mov_b64 exec, s[82:83]
    s_nop 1
    v_mfma_f32_4x4x4_16b_bf16 v[88:91], v[12:13], v[84:85], 0
    s_nop 1
    v_mfma_f32_4x4x4_16b_bf16 v[88:91], v[10:11], v[86:87], v[88:91]
    s_nop 4
    v_cvt_pk_bf16_f32 v88, v88, v89
    v_cvt_pk_bf16_f32 v89, v90, v91
    ds_pk_add_bf16 v7, v88
    ds_pk_add_bf16 v7, v89 offset:4
    s_mov_b64 exec, vcc
    s_branch L2_d66
L2_c67:
    s_mov_b64 exec, s[82:83]
    s_nop 1
    v_mfma_f32_4x4x4_16b_bf16 v[88:91], v[12:13], v[84:85], 0
    s_nop 1
    v_mfma_f32_4x4x4_16b_bf16 v[88:91], v[10:11], v[86:87], v[88:91]
    s_nop 4
    v_cvt_pk_bf16_f32 v88, v88, v89
    v_cvt_pk_bf16_f32 v89, v90, v91
    ds_pk_add_bf16 v7, v88
    ds_pk_add_bf16 v7, v89 offset:4
    s_mov_b64 exec, vcc
    s_branch L2_d67
L2_c68:
    s_mov_b64 exec, s[82:83]
    s_nop 1
    v_mfma_f32_4x4x4_16b_bf16 v[88:91], v[12:13], v[84:85], 0
    s_nop 1
    v_mfma_f32_4x4x4_16b_bf16 v[88:91], v[10:11], v[86:87], v[88:91]
    s_nop 4
    v_cvt_pk_bf16_f32 v88, v88, v89
    v_cvt_pk_bf16_f32 v89, v90, v91
    ds_pk_add_bf16 v7, v88
    ds_pk_add_bf16 v7, v89 offset:4
    s_mov_b64 exec, vcc
    s_branch L2_d68
L2_c69:
    s_mov_b64 exec, s[82:83]
    s_nop 1
    v_mfma_f32_4x4x4_16b_bf16 v[88:91], v[12:13], v[84:85], 0
    s_nop 1
    v_mfma_f32_4x4x4_16b_bf16 v[88:91], v[10:11], v[86:87], v[88:91]
    s_nop 4
    v_cvt_pk_bf16_f32 v88, v88, v89
    v_cvt_pk_bf16_f32 v89, v90, v91
    ds_pk_add_bf16 v7, v88
    ds_pk_add_bf16 v7, v89 offset:4
    s_mov_b64 exec, vcc
    s_branch L2_d69
L2_c70:
    s_mov_b64 exec, s[82:83]
    s_nop 1
    v_mfma_f32_4x4x4_16b_bf16 v[88:91], v[12:13], v[84:85], 0
    s_nop 1
    v_mfma_f32_4x4x4_16b_bf16 v[88:91], v[10:11], v[86:87], v[88:91]
    s_nop 4
    v_cvt_pk_bf16_f32 v88, v88, v89
    v_cvt_pk_bf16_f32 v89, v90, v91
    ds_pk_add_bf16 v7, v88
    ds_pk_add_bf16 v7, v89 offset:4
    s_mov_b64 exec, vcc
    s_branch L2_d70
L2_c71:
    s_mov_b64 exec, s[82:83]
    s_nop 1
    v_mfma_f32_4x4x4_16b_bf16 v[88:91], v[12:13], v[84:85], 0
    s_nop 1
    v_mfma_f32_4x4x4_16b_bf16 v[88:91], v[10:11], v[86:87], v[88:91]
    s_nop 4
    v_cvt_pk_bf16_f32 v88, v88, v89
    v_cvt_pk_bf16_f32 v89, v90, v91
    ds_pk_add_bf16 v7, v88
    ds_pk_add_bf16 v7, v89 offset:4
    s_mov_b64 exec, vcc
    s_branch L2_d71
L2_c72:
    s_mov_b64 exec, s[82:83]
    s_nop 1
    v_mfma_f32_4x4x4_16b_bf16 v[88:91], v[12:13], v[84:85], 0
    s_nop 1
    v_mfma_f32_4x4x4_16b_bf16 v[88:91], v[10:11], v[86:87], v[88:91]
    s_nop 4
    v_cvt_pk_bf16_f32 v88, v88, v89
    v_cvt_pk_bf16_f32 v89, v90, v91
    ds_pk_add_bf16 v7, v88
    ds_pk_add_bf16 v7, v89 offset:4
    s_mov_b64 exec, vcc
    s_branch L2_d72
L2_c73:
    s_mov_b64 exec, s[82:83]
    s_nop 1
    v_mfma_f32_4x4x4_16b_bf16 v[88:91], v[12:13], v[84:85], 0
    s_nop 1
    v_mfma_f32_4x4x4_16b_bf16 v[88:91], v[10:11], v[86:87], v[88:91]
    s_nop 4
    v_cvt_pk_bf16_f32 v88, v88, v89
    v_cvt_pk_bf16_f32 v89, v90, v91
    ds_pk_add_bf16 v7, v88
    ds_pk_add_bf16 v7, v89 offset:4
    s_mov_b64 exec, vcc
    s_branch L2_d73
L2_xa74:
    s_cmp_eq_u32 s43, 1
    s_cbranch_scc1 L2_xc74
    v_lshlrev_b32 v89, 0, v96
    v_add_u32 v90, 140, v97
    v_bitop3_b32 v90, v89, v45, v90 bitop3:0x6a
    ds_write_b32 v98, v90 offset:28
    v_lshlrev_b32 v89, 4, v96
    v_add_u32 v90, 120, v97
    v_bitop3_b32 v90, v89, v45, v90 bitop3:0x6a
    ds_write_b32 v98, v90 offset:24
    v_lshlrev_b32 v89, 8, v96
    v_add_u32 v90, 100, v97
    v_bitop3_b32 v90, v89, v45, v90 bitop3:0x6a
    ds_write_b32 v98, v90 offset:20
L2_xc74:
    v_lshlrev_b32 v89, 12, v96
    v_add_u32 v90, 80, v97
    v_bitop3_b32 v90, v89, v45, v90 bitop3:0x6a
    ds_write_b32 v98, v90 offset:16
    s_branch L2_xb74
L2_xe74:
    v_cmp_lt_u32 vcc, 32, v99
    v_cmp_lt_u32 s[58:59], 31, v88
    v_lshrrev_b32 v89, 16, v96
    v_add_u32 v97, 80, v97
    s_or_b64 vcc, vcc, s[58:59]
    s_cbranch_scc1 L2_xs74
    v_lshlrev_b32 v89, v1, v89
    v_and_b32 v89, v45, v89
    v_cmp_ne_u32 vcc, 0, v89
    v_xor_b32 v90, v97, v89
    s_add_u32 s3, s37, s38
    v_mbcnt_lo_u32_b32 v98, vcc_lo, 0
    v_mbcnt_hi_u32_b32 v98, vcc_hi, v98
    s_bcnt1_i32_b64 s41, vcc
    v_lshl_add_u32 v98, v98, 2, s3
    s_mov_b64 exec, vcc
    ds_write_b32 v98, v90
    s_mov_b64 exec, -1
    s_lshl2_add_u32 s37, s41, s37
    s_branch L2_xr74
L2_xf74:
    s_waitcnt lgkmcnt(0)
    s_cmp_gt_u32 s37, 1024
    s_cbranch_scc1 L2_xs74
    v_mov_b32 v43, -1
    s_cmp_ge_u32 s37, 512
    s_cbranch_scc1 L2_xg74
    v_mov_b32 v42, -1
    s_cmp_ge_u32 s37, 256
    s_cbranch_scc1 L2_xg74
    v_mov_b32 v41, -1
    s_branch L2_xg74
L2_xs74:
    s_waitcnt lgkmcnt(0)
    v_mov_b32 v40, -1
    v_mov_b32 v41, -1
    v_mov_b32 v42, -1
    v_mov_b32 v43, -1
    s_add_u32 s3, s42, 2
    s_bitset1_b32 s36, s3
    s_branch L2_xg74
L2_c75:
    s_mov_b64 exec, s[82:83]
    s_nop 1
    v_mfma_f32_4x4x4_16b_bf16 v[88:91], v[12:13], v[84:85], 0
    s_nop 1
    v_mfma_f32_4x4x4_16b_bf16 v[88:91], v[10:11], v[86:87], v[88:91]
    s_nop 4
    v_cvt_pk_bf16_f32 v88, v88, v89
    v_cvt_pk_bf16_f32 v89, v90, v91
    ds_pk_add_bf16 v7, v88
    ds_pk_add_bf16 v7, v89 offset:4
    s_mov_b64 exec, vcc
    s_branch L2_d75
L2_c76:
    s_mov_b64 exec, s[82:83]
    s_nop 1
    v_mfma_f32_4x4x4_16b_bf16 v[88:91], v[12:13], v[84:85], 0
    s_nop 1
    v_mfma_f32_4x4x4_16b_bf16 v[88:91], v[10:11], v[86:87], v[88:91]
    s_nop 4
    v_cvt_pk_bf16_f32 v88, v88, v89
    v_cvt_pk_bf16_f32 v89, v90, v91
    ds_pk_add_bf16 v7, v88
    ds_pk_add_bf16 v7, v89 offset:4
    s_mov_b64 exec, vcc
    s_branch L2_d76
L2_c77:
    s_mov_b64 exec, s[82:83]
    s_nop 1
    v_mfma_f32_4x4x4_16b_bf16 v[88:91], v[12:13], v[84:85], 0
    s_nop 1
    v_mfma_f32_4x4x4_16b_bf16 v[88:91], v[10:11], v[86:87], v[88:91]
    s_nop 4
    v_cvt_pk_bf16_f32 v88, v88, v89
    v_cvt_pk_bf16_f32 v89, v90, v91
    ds_pk_add_bf16 v7, v88
    ds_pk_add_bf16 v7, v89 offset:4
    s_mov_b64 exec, vcc
    s_branch L2_d77
L2_c78:
    s_mov_b64 exec, s[82:83]
    s_nop 1
    v_mfma_f32_4x4x4_16b_bf16 v[88:91], v[12:13], v[84:85], 0
    s_nop 1
    v_mfma_f32_4x4x4_16b_bf16 v[88:91], v[10:11], v[86:87], v[88:91]
    s_nop 4
    v_cvt_pk_bf16_f32 v88, v88, v89
    v_cvt_pk_bf16_f32 v89, v90, v91
    ds_pk_add_bf16 v7, v88
    ds_pk_add_bf16 v7, v89 offset:4
    s_mov_b64 exec, vcc
    s_branch L2_d78
L2_c79:
    s_mov_b64 exec, s[82:83]
    s_nop 1
    v_mfma_f32_4x4x4_16b_bf16 v[88:91], v[12:13], v[84:85], 0
    s_nop 1
    v_mfma_f32_4x4x4_16b_bf16 v[88:91], v[10:11], v[86:87], v[88:91]
    s_nop 4
    v_cvt_pk_bf16_f32 v88, v88, v89
    v_cvt_pk_bf16_f32 v89, v90, v91
    ds_pk_add_bf16 v7, v88
    ds_pk_add_bf16 v7, v89 offset:4
    s_mov_b64 exec, vcc
    s_branch L2_d79
L2_c80:
    s_mov_b64 exec, s[82:83]
    s_nop 1
    v_mfma_f32_4x4x4_16b_bf16 v[88:91], v[12:13], v[84:85], 0
    s_nop 1
    v_mfma_f32_4x4x4_16b_bf16 v[88:91], v[10:11], v[86:87], v[88:91]
    s_nop 4
    v_cvt_pk_bf16_f32 v88, v88, v89
    v_cvt_pk_bf16_f32 v89, v90, v91
    ds_pk_add_bf16 v7, v88
    ds_pk_add_bf16 v7, v89 offset:4
    s_mov_b64 exec, vcc
    s_branch L2_d80
.text
.globl gs_final_kernel
.p2align 8
.type gs_final_kernel,@function
gs_final_kernel:
    s_cmp_ge_u32 s2, 1250
    s_cbranch_scc1 L3_end
    s_load_dwordx2 s[4:5], s[0:1], 0
    s_load_dwordx2 s[6:7], s[0:1], 24
    s_load_dwordx2 s[28:29], s[0:1], 40
    s_load_dwordx2 s[30:31], s[0:1], 88
    s_load_dwordx2 s[32:33], s[0:1], 104
    s_lshl_b32 s3, s2, 8
    v_add_u32 v1, s3, v0
    v_lshlrev_b32 v2, 4, v1
    v_lshlrev_b32 v3, 2, v1
    v_bfe_u32 v4, v1, 3, 6
    s_mov_b32 s3, 80000
    v_mul_lo_u32 v4, v4, s3
    v_lshrrev_b32 v5, 9, v1
    v_lshl_add_u32 v4, v5, 7, v4
    v_and_b32 v5, 7, v1
    v_lshl_add_u32 v4, v5, 4, v4
    v_and_b32 v5, 3, v0
    v_lshlrev_b32 v5, 6, v5
    s_waitcnt lgkmcnt(0)
    s_load_dwordx4 s[36:39], s[28:29], 0
    s_mov_b32 s8, s4
    s_mov_b32 s9, s5
    s_mov_b32 s10, 0x4e2000
    s_mov_b32 s11, 0x20000
    s_mov_b32 s12, s6
    s_mov_b32 s13, s7
    s_mov_b32 s14, 0x138800
    s_mov_b32 s15, 0x20000
    s_mov_b32 s16, s30
    s_mov_b32 s17, s31
    s_mov_b32 s18, 0x4e2000
    s_mov_b32 s19, 0x20000
    s_add_u32 s20, s32, 0xd823000
    s_addc_u32 s21, s33, 0
    s_mov_b32 s22, 0x1388000
    s_mov_b32 s23, 0x20000
    s_add_u32 s24, s32, 0xebab000
    s_addc_u32 s25, s33, 0
    s_mov_b32 s26, 0x100
    s_mov_b32 s27, 0x20000
    buffer_load_dword v6, v3, s[12:15], 0 offen
    buffer_load_dwordx4 v[8:11], v5, s[24:27], 0 offen
    buffer_load_dwordx4 v[12:15], v5, s[24:27], 0 offen offset:16
    buffer_load_dwordx2 v[16:17], v5, s[24:27], 0 offen offset:32
    s_mov_b32 s40, 0
    buffer_load_dwordx4 v[20:23], v4, s[20:23], s40 offen
    s_mov_b32 s41, 5120000
    buffer_load_dwordx4 v[24:27], v4, s[20:23], s41 offen
    s_mov_b32 s42, 10240000
    buffer_load_dwordx4 v[28:31], v4, s[20:23], s42 offen
    s_mov_b32 s43, 15360000
    buffer_load_dwordx4 v[32:35], v4, s[20:23], s43 offen
    buffer_load_dwordx4 v[36:39], v2, s[8:11], 0 offen
    v_and_b32 v7, 3, v0
    v_lshlrev_b32 v7, 4, v7
    v_mov_b32 v18, 0x3f80
    v_mov_b32 v19, 0
    v_lshlrev_b64 v[18:19], v7, v[18:19]
    s_waitcnt lgkmcnt(0)
    s_lshl_b32 s44, s36, 16
    s_and_b32 s45, s36, 0xffff0000
    s_lshl_b32 s46, s37, 16
    s_and_b32 s47, s37, 0xffff0000
    s_lshl_b32 s48, s38, 16
    s_and_b32 s49, s38, 0xffff0000
    s_lshl_b32 s50, s39, 16
    s_and_b32 s51, s39, 0xffff0000
    s_waitcnt vmcnt(8)
    v_lshlrev_b32 v7, 16, v6
    v_subrev_f32 v48, s44, v7
    v_subrev_f32 v49, s45, v7
    v_subrev_f32 v50, s46, v7
    v_subrev_f32 v51, s47, v7
    v_subrev_f32 v52, s48, v7
    v_subrev_f32 v53, s49, v7
    v_subrev_f32 v54, s50, v7
    v_subrev_f32 v55, s51, v7
    v_cvt_pk_bf16_f32 v56, v48, v49
    v_cvt_pk_bf16_f32 v57, v50, v51
    v_cvt_pk_bf16_f32 v58, v52, v53
    v_cvt_pk_bf16_f32 v59, v54, v55
    v_lshlrev_b32 v48, 16, v56
    v_and_b32 v49, 0xffff0000, v56
    v_lshlrev_b32 v50, 16, v57
    v_and_b32 v51, 0xffff0000, v57
    v_lshlrev_b32 v52, 16, v58
    v_and_b32 v53, 0xffff0000, v58
    v_lshlrev_b32 v54, 16, v59
    v_and_b32 v55, 0xffff0000, v59
    v_mul_f32 v48, v48, v48
    v_mul_f32 v49, v49, v49
    v_mul_f32 v50, v50, v50
    v_mul_f32 v51, v51, v51
    v_mul_f32 v52, v52, v52
    v_mul_f32 v53, v53, v53
    v_mul_f32 v54, v54, v54
    v_mul_f32 v55, v55, v55
    v_cvt_pk_bf16_f32 v56, v48, v49
    v_cvt_pk_bf16_f32 v57, v50, v51
    v_cvt_pk_bf16_f32 v58, v52, v53
    v_cvt_pk_bf16_f32 v59, v54, v55
    v_lshlrev_b32 v48, 16, v56
    v_and_b32 v49, 0xffff0000, v56
    v_lshlrev_b32 v50, 16, v57
    v_and_b32 v51, 0xffff0000, v57
    v_lshlrev_b32 v52, 16, v58
    v_and_b32 v53, 0xffff0000, v58
    v_lshlrev_b32 v54, 16, v59
    v_and_b32 v55, 0xffff0000, v59
    v_mul_f32 v48, 0xc1200000, v48
    v_mul_f32 v49, 0xc1200000, v49
    v_mul_f32 v50, 0xc1200000, v50
    v_mul_f32 v51, 0xc1200000, v51
    v_mul_f32 v52, 0xc1200000, v52
    v_mul_f32 v53, 0xc1200000, v53
    v_mul_f32 v54, 0xc1200000, v54
    v_mul_f32 v55, 0xc1200000, v55
    v_cvt_pk_bf16_f32 v56, v48, v49
    v_cvt_pk_bf16_f32 v57, v50, v51
    v_cvt_pk_bf16_f32 v58, v52, v53
    v_cvt_pk_bf16_f32 v59, v54, v55
    v_lshlrev_b32 v48, 16, v56
    v_and_b32 v49, 0xffff0000, v56
    v_lshlrev_b32 v50, 16, v57
    v_and_b32 v51, 0xffff0000, v57
    v_lshlrev_b32 v52, 16, v58
    v_and_b32 v53, 0xffff0000, v58
    v_lshlrev_b32 v54, 16, v59
    v_and_b32 v55, 0xffff0000, v59
    v_mul_f32 v48, 0x3fb8aa3b, v48
    v_mul_f32 v49, 0x3fb8aa3b, v49
    v_mul_f32 v50, 0x3fb8aa3b, v50
    v_mul_f32 v51, 0x3fb8aa3b, v51
    v_mul_f32 v52, 0x3fb8aa3b, v52
    v_mul_f32 v53, 0x3fb8aa3b, v53
    v_mul_f32 v54, 0x3fb8aa3b, v54
    v_mul_f32 v55, 0x3fb8aa3b, v55
    v_exp_f32 v48, v48
    v_exp_f32 v49, v49
    v_exp_f32 v50, v50
    v_exp_f32 v51, v51
    v_exp_f32 v52, v52
    v_exp_f32 v53, v53
    v_exp_f32 v54, v54
    v_exp_f32 v55, v55
    v_cvt_pk_bf16_f32 v40, v48, v49
    v_cvt_pk_bf16_f32 v41, v50, v51
    v_cvt_pk_bf16_f32 v42, v52, v53
    v_cvt_pk_bf16_f32 v43, v54, v55
    v_and_b32 v7, 0xffff0000, v6
    v_subrev_f32 v48, s44, v7
    v_subrev_f32 v49, s45, v7
    v_subrev_f32 v50, s46, v7
    v_subrev_f32 v51, s47, v7
    v_subrev_f32 v52, s48, v7
    v_subrev_f32 v53, s49, v7
    v_subrev_f32 v54, s50, v7
    v_subrev_f32 v55, s51, v7
    v_cvt_pk_bf16_f32 v56, v48, v49
    v_cvt_pk_bf16_f32 v57, v50, v51
    v_cvt_pk_bf16_f32 v58, v52, v53
    v_cvt_pk_bf16_f32 v59, v54, v55
    v_lshlrev_b32 v48, 16, v56
    v_and_b32 v49, 0xffff0000, v56
    v_lshlrev_b32 v50, 16, v57
    v_and_b32 v51, 0xffff0000, v57
    v_lshlrev_b32 v52, 16, v58
    v_and_b32 v53, 0xffff0000, v58
    v_lshlrev_b32 v54, 16, v59
    v_and_b32 v55, 0xffff0000, v59
    v_mul_f32 v48, v48, v48
    v_mul_f32 v49, v49, v49
    v_mul_f32 v50, v50, v50
    v_mul_f32 v51, v51, v51
    v_mul_f32 v52, v52, v52
    v_mul_f32 v53, v53, v53
    v_mul_f32 v54, v54, v54
    v_mul_f32 v55, v55, v55
    v_cvt_pk_bf16_f32 v56, v48, v49
    v_cvt_pk_bf16_f32 v57, v50, v51
    v_cvt_pk_bf16_f32 v58, v52, v53
    v_cvt_pk_bf16_f32 v59, v54, v55
    v_lshlrev_b32 v48, 16, v56
    v_and_b32 v49, 0xffff0000, v56
    v_lshlrev_b32 v50, 16, v57
    v_and_b32 v51, 0xffff0000, v57
    v_lshlrev_b32 v52, 16, v58
    v_and_b32 v53, 0xffff0000, v58
    v_lshlrev_b32 v54, 16, v59
    v_and_b32 v55, 0xffff0000, v59
    v_mul_f32 v48, 0xc1200000, v48
    v_mul_f32 v49, 0xc1200000, v49
    v_mul_f32 v50, 0xc1200000, v50
    v_mul_f32 v51, 0xc1200000, v51
    v_mul_f32 v52, 0xc1200000, v52
    v_mul_f32 v53, 0xc1200000, v53
    v_mul_f32 v54, 0xc1200000, v54
    v_mul_f32 v55, 0xc1200000, v55
    v_cvt_pk_bf16_f32 v56, v48, v49
    v_cvt_pk_bf16_f32 v57, v50, v51
    v_cvt_pk_bf16_f32 v58, v52, v53
    v_cvt_pk_bf16_f32 v59, v54, v55
    v_lshlrev_b32 v48, 16, v56
    v_and_b32 v49, 0xffff0000, v56
    v_lshlrev_b32 v50, 16, v57
    v_and_b32 v51, 0xffff0000, v57
    v_lshlrev_b32 v52, 16, v58
    v_and_b32 v53, 0xffff0000, v58
    v_lshlrev_b32 v54, 16, v59
    v_and_b32 v55, 0xffff0000, v59
    v_mul_f32 v48, 0x3fb8aa3b, v48
    v_mul_f32 v49, 0x3fb8aa3b, v49
    v_mul_f32 v50, 0x3fb8aa3b, v50
    v_mul_f32 v51, 0x3fb8aa3b, v51
    v_mul_f32 v52, 0x3fb8aa3b, v52
    v_mul_f32 v53, 0x3fb8aa3b, v53
    v_mul_f32 v54, 0x3fb8aa3b, v54
    v_mul_f32 v55, 0x3fb8aa3b, v55
    v_exp_f32 v48, v48
    v_exp_f32 v49, v49
    v_exp_f32 v50, v50
    v_exp_f32 v51, v51
    v_exp_f32 v52, v52
    v_exp_f32 v53, v53
    v_exp_f32 v54, v54
    v_exp_f32 v55, v55
    v_cvt_pk_bf16_f32 v44, v48, v49
    v_cvt_pk_bf16_f32 v45, v50, v51
    v_cvt_pk_bf16_f32 v46, v52, v53
    v_cvt_pk_bf16_f32 v47, v54, v55
    s_waitcnt vmcnt(5)
    v_mfma_f32_4x4x4_16b_bf16 v[48:51], v[8:9], v[40:41], 0
    v_mfma_f32_4x4x4_16b_bf16 v[56:59], v[12:13], v[40:41], 0
    v_mfma_f32_4x4x4_16b_bf16 v[52:55], v[8:9], v[44:45], 0
    v_mfma_f32_4x4x4_16b_bf16 v[60:63], v[12:13], v[44:45], 0
    v_mfma_f32_4x4x4_16b_bf16 v[48:51], v[10:11], v[42:43], v[48:51]
    v_mfma_f32_4x4x4_16b_bf16 v[56:59], v[14:15], v[42:43], v[56:59]
    v_mfma_f32_4x4x4_16b_bf16 v[52:55], v[10:11], v[46:47], v[52:55]
    v_mfma_f32_4x4x4_16b_bf16 v[60:63], v[14:15], v[46:47], v[60:63]
    s_waitcnt vmcnt(1)
    v_mfma_f32_4x4x4_16b_bf16 v[64:67], v[18:19], v[20:21], 0
    v_mfma_f32_4x4x4_16b_bf16 v[68:71], v[18:19], v[22:23], 0
    s_nop 0
    v_mfma_f32_4x4x4_16b_bf16 v[64:67], v[18:19], v[24:25], v[64:67]
    v_mfma_f32_4x4x4_16b_bf16 v[68:71], v[18:19], v[26:27], v[68:71]
    s_nop 0
    v_mfma_f32_4x4x4_16b_bf16 v[64:67], v[18:19], v[28:29], v[64:67]
    v_mfma_f32_4x4x4_16b_bf16 v[68:71], v[18:19], v[30:31], v[68:71]
    s_nop 0
    v_mfma_f32_4x4x4_16b_bf16 v[64:67], v[18:19], v[32:33], v[64:67]
    v_mfma_f32_4x4x4_16b_bf16 v[68:71], v[18:19], v[34:35], v[68:71]
    s_nop 3
    v_mul_f32 v64, v64, v48
    v_mul_f32 v65, v65, v49
    v_mul_f32 v66, v66, v50
    v_mul_f32 v67, v67, v51
    v_cvt_pk_bf16_f32 v20, v64, v65
    v_cvt_pk_bf16_f32 v21, v66, v67
    v_mul_f32 v68, v68, v52
    v_mul_f32 v69, v69, v53
    v_mul_f32 v70, v70, v54
    v_mul_f32 v71, v71, v55
    v_cvt_pk_bf16_f32 v22, v68, v69
    v_cvt_pk_bf16_f32 v23, v70, v71
    v_mfma_f32_4x4x4_16b_bf16 v[48:51], v[16:17], v[20:21], 0
    s_nop 0
    v_mfma_f32_4x4x4_16b_bf16 v[52:55], v[16:17], v[22:23], 0
    s_nop 2
    v_mul_f32 v48, v48, v56
    v_mul_f32 v49, v49, v57
    v_mul_f32 v50, v50, v58
    v_mul_f32 v51, v51, v59
    v_mul_f32 v52, v52, v60
    v_mul_f32 v53, v53, v61
    v_mul_f32 v54, v54, v62
    v_mul_f32 v55, v55, v63
    s_waitcnt vmcnt(0)
    v_mfma_f32_4x4x4_16b_bf16 v[64:67], v[18:19], v[36:37], v[48:51]
    v_mfma_f32_4x4x4_16b_bf16 v[68:71], v[18:19], v[38:39], v[52:55]
    s_nop 3
    v_cvt_pk_bf16_f32 v24, v64, v65
    v_cvt_pk_bf16_f32 v25, v66, v67
    v_cvt_pk_bf16_f32 v26, v68, v69
    v_cvt_pk_bf16_f32 v27, v70, v71
    buffer_store_dwordx4 v[24:27], v2, s[16:19], 0 offen
L3_end:
    s_endpgm
.section .rodata,"a"
.p2align 6
.amdhsa_kernel gs_sort_kernel
  .amdhsa_next_free_vgpr 128
  .amdhsa_next_free_sgpr 96
  .amdhsa_accum_offset 128
  .amdhsa_group_segment_fixed_size 0
  .amdhsa_kernarg_size 112
  .amdhsa_user_sgpr_count 2
  .amdhsa_user_sgpr_kernarg_segment_ptr 1
  .amdhsa_system_sgpr_workgroup_id_x 1
  .amdhsa_float_denorm_mode_32 3
.end_amdhsa_kernel
.p2align 6
.amdhsa_kernel gs_acc_kernel
  .amdhsa_next_free_vgpr 128
  .amdhsa_next_free_sgpr 96
  .amdhsa_accum_offset 128
  .amdhsa_group_segment_fixed_size 0
  .amdhsa_kernarg_size 112
  .amdhsa_user_sgpr_count 2
  .amdhsa_user_sgpr_kernarg_segment_ptr 1
  .amdhsa_system_sgpr_workgroup_id_x 1
  .amdhsa_float_denorm_mode_32 3
.end_amdhsa_kernel
.p2align 6
.amdhsa_kernel gs_final_kernel
  .amdhsa_next_free_vgpr 72
  .amdhsa_next_free_sgpr 64
  .amdhsa_accum_offset 72
  .amdhsa_group_segment_fixed_size 0
  .amdhsa_kernarg_size 112
  .amdhsa_user_sgpr_count 2
  .amdhsa_user_sgpr_kernarg_segment_ptr 1
  .amdhsa_system_sgpr_workgroup_id_x 1
  .amdhsa_float_denorm_mode_32 3
.end_amdhsa_kernel
```

```asm
; @launch kernel=gs_sort_kernel grid=(256,1,1) block=(1024,1,1) lds=163840
; @launch kernel=gs_acc_kernel grid=(256,1,1) block=(1024,1,1) lds=163840
; @launch kernel=gs_final_kernel grid=(1250,1,1) block=(256,1,1) lds=0
.amdgcn_target "amdgcn-amd-amdhsa--gfx950"
.text
.globl gs_sort_kernel
.p2align 8
.type gs_sort_kernel,@function
gs_sort_kernel:
    s_cmp_ge_u32 s2, 256
    s_cbranch_scc1 L1_end
    s_load_dwordx4 s[4:7], s[0:1], 8
    s_load_dwordx2 s[28:29], s[0:1], 32
    s_load_dwordx2 s[30:31], s[0:1], 104
    s_load_dwordx2 s[56:57], s[0:1], 96
    s_load_dwordx2 s[86:87], s[0:1], 0
    s_load_dwordx4 s[60:63], s[0:1], 56
    s_load_dwordx4 s[64:67], s[0:1], 72
    v_lshrrev_b32 v7, 6, v0
    v_lshlrev_b32 v1, 3, v0
    v_readfirstlane_b32 s32, v7
    v_lshlrev_b32 v0, 4, v0
    s_mul_i32 s33, s2, 16384
    s_mul_i32 s34, s2, 8192
    s_waitcnt lgkmcnt(0)
    s_mov_b32 s8, s4
    s_mov_b32 s9, s5
    s_mov_b32 s10, 0x9c40000
    s_mov_b32 s11, 0x20000
    s_mov_b32 s12, s6
    s_mov_b32 s13, s7
    s_mov_b32 s14, 0x9c40000
    s_mov_b32 s15, 0x20000
    s_mov_b32 s16, s28
    s_mov_b32 s17, s29
    s_mov_b32 s18, 0x4e20000
    s_mov_b32 s19, 0x20000
    s_add_u32 s44, s33, 0x0
    buffer_load_dwordx4 v[16:19], v0, s[8:11], s44 offen nt
    s_add_u32 s45, s33, 0x0
    buffer_load_dwordx4 v[20:23], v0, s[12:15], s45 offen nt
    s_add_u32 s46, s34, 0x0
    buffer_load_dwordx2 v[24:25], v1, s[16:19], s46 offen nt
    s_add_u32 s47, s34, 0x200000
    buffer_load_dwordx2 v[26:27], v1, s[16:19], s47 offen nt
    s_add_u32 s44, s33, 0x400000
    buffer_load_dwordx4 v[28:31], v0, s[8:11], s44 offen nt
    s_add_u32 s45, s33, 0x400000
    buffer_load_dwordx4 v[32:35], v0, s[12:15], s45 offen nt
    s_add_u32 s46, s33, 0x800000
    buffer_load_dwordx4 v[36:39], v0, s[8:11], s46 offen nt
    s_add_u32 s47, s33, 0x800000
    buffer_load_dwordx4 v[40:43], v0, s[12:15], s47 offen nt
    s_add_u32 s44, s34, 0x400000
    buffer_load_dwordx2 v[44:45], v1, s[16:19], s44 offen nt
    s_add_u32 s45, s34, 0x600000
    buffer_load_dwordx2 v[46:47], v1, s[16:19], s45 offen nt
    s_mov_b32 s68, s62
    s_mov_b32 s69, s63
    s_mov_b32 s70, 0x40
    s_mov_b32 s71, 0x20000
    s_mov_b32 s72, s60
    s_mov_b32 s73, s61
    s_mov_b32 s74, 0x40
    s_mov_b32 s75, 0x20000
    s_mov_b32 s20, s66
    s_mov_b32 s21, s67
    s_mov_b32 s22, 0x20
    s_mov_b32 s23, 0x20000
    s_mov_b32 s80, s64
    s_mov_b32 s81, s65
    s_mov_b32 s82, 0x20
    s_mov_b32 s83, 0x20000
    s_add_u32 s24, s30, 0xebab000
    s_addc_u32 s25, s31, 0
    s_mov_b32 s26, 0x100
    s_mov_b32 s27, 0x20000
    v_lshrrev_b32 v2, 3, v0
    v_and_b32 v2, 6, v2
    v_lshlrev_b32 v3, 2, v0
    s_lshl_b32 s3, s32, 8
    s_add_u32 s3, s3, s2
    s_cmp_lg_u32 s3, 254
    s_cbranch_scc1 L1_wt
    buffer_load_ushort v96, v2, s[68:71], 0 offen offset:0
    buffer_load_ushort v108, v2, s[68:71], 0 offen offset:8
    buffer_load_ushort v97, v2, s[68:71], 0 offen offset:16
    buffer_load_ushort v109, v2, s[68:71], 0 offen offset:24
    buffer_load_ushort v98, v2, s[68:71], 0 offen offset:32
    buffer_load_ushort v110, v2, s[68:71], 0 offen offset:40
    buffer_load_ushort v99, v2, s[68:71], 0 offen offset:48
    buffer_load_ushort v111, v2, s[68:71], 0 offen offset:56
    buffer_load_ushort v100, v2, s[72:75], 0 offen offset:0
    buffer_load_ushort v112, v2, s[72:75], 0 offen offset:8
    buffer_load_ushort v101, v2, s[72:75], 0 offen offset:16
    buffer_load_ushort v113, v2, s[72:75], 0 offen offset:24
    buffer_load_ushort v102, v2, s[72:75], 0 offen offset:32
    buffer_load_ushort v114, v2, s[72:75], 0 offen offset:40
    buffer_load_ushort v103, v2, s[72:75], 0 offen offset:48
    buffer_load_ushort v115, v2, s[72:75], 0 offen offset:56
    buffer_load_ushort v104, v2, s[20:23], 0 offen offset:0
    buffer_load_ushort v116, v2, s[20:23], 0 offen offset:8
    buffer_load_ushort v105, v2, s[20:23], 0 offen offset:16
    buffer_load_ushort v117, v2, s[20:23], 0 offen offset:24
    buffer_load_ushort v106, v2, s[80:83], 0 offen offset:0
    buffer_load_ushort v118, v2, s[80:83], 0 offen offset:8
    buffer_load_ushort v107, v2, s[80:83], 0 offen offset:16
    buffer_load_ushort v119, v2, s[80:83], 0 offen offset:24
    s_waitcnt vmcnt(0)
    v_lshl_or_b32 v96, v108, 16, v96
    v_lshl_or_b32 v97, v109, 16, v97
    v_lshl_or_b32 v98, v110, 16, v98
    v_lshl_or_b32 v99, v111, 16, v99
    v_lshl_or_b32 v100, v112, 16, v100
    v_lshl_or_b32 v101, v113, 16, v101
    v_lshl_or_b32 v102, v114, 16, v102
    v_lshl_or_b32 v103, v115, 16, v103
    v_lshl_or_b32 v104, v116, 16, v104
    v_lshl_or_b32 v105, v117, 16, v105
    v_lshl_or_b32 v106, v118, 16, v106
    v_lshl_or_b32 v107, v119, 16, v107
    buffer_store_dwordx4 v[96:99], v3, s[24:27], 0 offen offset:0
    buffer_store_dwordx4 v[100:103], v3, s[24:27], 0 offen offset:16
    buffer_store_dwordx4 v[104:107], v3, s[24:27], 0 offen offset:32
L1_wt:
    s_mov_b32 s20, s30
    s_mov_b32 s21, s31
    s_mov_b32 s22, 0xd340000
    s_mov_b32 s23, 0x20000
    s_add_u32 s24, s30, 0x28000
    s_addc_u32 s25, s31, 0
    s_mov_b32 s26, 0xd318000
    s_mov_b32 s27, 0x20000
    s_mov_b32 s80, s86
    s_mov_b32 s81, s87
    s_mov_b32 s82, 0x4e20
    s_mov_b32 s83, 0x20000
    s_mul_i32 s3, s2, 20000
    s_add_u32 s80, s80, s3
    s_addc_u32 s81, s81, 0
    s_mul_i32 s35, s2, 173056
    s_and_b32 s37, s32, 3
    s_lshl_b32 s37, s37, 3
    s_add_u32 s36, s35, s37
    s_lshr_b32 s37, s32, 2
    s_mul_i32 s37, s37, 2080
    s_add_u32 s36, s36, s37
    s_mul_i32 s4, s2, 5
    s_add_u32 s4, s4, 8192
    s_lshl_b32 s38, s4, 14
    s_lshl_b32 s39, s4, 13
    v_mov_b32 v2, 1
    v_mov_b32 v4, 0x80000007
    v_mov_b32 v5, 0xfc
    v_mov_b32 v6, 0x78
    s_mov_b32 s40, 2048
    s_mov_b32 s55, -10000
    s_mov_b32 s41, 0x010c0c01
    s_mov_b32 s42, 0x030c0c03
    v_mov_b32 v8, 0
    v_mov_b32 v9, 0
    v_mov_b32 v10, 0
    v_mov_b32 v11, 0
    ds_write_b128 v0, v[8:11]
    s_waitcnt lgkmcnt(0)
    s_barrier
    s_add_u32 s46, s33, 0xc00000
    buffer_load_dwordx4 v[48:51], v0, s[8:11], s46 offen nt
    s_add_u32 s47, s33, 0xc00000
    buffer_load_dwordx4 v[52:55], v0, s[12:15], s47 offen nt
    s_waitcnt vmcnt(8)
    v_lshlrev_b32 v7, 16, v24
    v_and_b32 v8, 0xffff0000, v24
    v_lshlrev_b32 v9, 16, v25
    v_and_b32 v10, 0xffff0000, v25
    v_mul_f32 v7, 0.15915494, v7
    v_mul_f32 v8, 0.15915494, v8
    v_mul_f32 v9, 0.15915494, v9
    v_mul_f32 v10, 0.15915494, v10
    v_mul_hi_u32_u24 v14, 429497, v16
    v_lshrrev_b32 v12, 3, v20
    v_cos_f32 v7, v7
    v_lshlrev_b16 v13, 3, v20
    v_mad_i32_i24 v11, v14, s55, v16
    v_bitop3_b32 v12, v6, v13, v12 bitop3:0xca
    v_add_lshl_u32 v11, v11, s40, 17
    v_lshlrev_b16 v14, 8, v14
    v_lshrrev_b32 v13, 2, v20
    v_or_b32 v16, v12, v11
    v_bitop3_b32 v20, v5, v13, v14 bitop3:0xea
    ds_add_u32 v20, v2
    v_mul_hi_u32_u24 v14, 429497, v17
    v_lshrrev_b32 v12, 3, v21
    v_cos_f32 v8, v8
    v_lshlrev_b16 v13, 3, v21
    v_mad_i32_i24 v11, v14, s55, v17
    v_bitop3_b32 v12, v6, v13, v12 bitop3:0xca
    v_add_lshl_u32 v11, v11, s40, 17
    v_lshlrev_b16 v14, 8, v14
    v_lshrrev_b32 v13, 2, v21
    v_or_b32 v17, v12, v11
    v_bitop3_b32 v21, v5, v13, v14 bitop3:0xea
    ds_add_u32 v21, v2
    v_cvt_pk_bf16_f32 v24, v7, v8
    v_perm_b32 v12, v24, v24, s41
    v_bitop3_b32 v16, v4, v12, v16 bitop3:0xca
    v_perm_b32 v13, v24, v24, s42
    v_bitop3_b32 v17, v4, v13, v17 bitop3:0xca
    v_mul_hi_u32_u24 v14, 429497, v18
    v_lshrrev_b32 v12, 3, v22
    v_cos_f32 v9, v9
    v_lshlrev_b16 v13, 3, v22
    v_mad_i32_i24 v11, v14, s55, v18
    v_bitop3_b32 v12, v6, v13, v12 bitop3:0xca
    v_add_lshl_u32 v11, v11, s40, 17
    v_lshlrev_b16 v14, 8, v14
    v_lshrrev_b32 v13, 2, v22
    v_or_b32 v18, v12, v11
    v_bitop3_b32 v22, v5, v13, v14 bitop3:0xea
    ds_add_u32 v22, v2
    v_mul_hi_u32_u24 v14, 429497, v19
    v_lshrrev_b32 v12, 3, v23
    v_cos_f32 v10, v10
    v_lshlrev_b16 v13, 3, v23
    v_mad_i32_i24 v11, v14, s55, v19
    v_bitop3_b32 v12, v6, v13, v12 bitop3:0xca
    v_add_lshl_u32 v11, v11, s40, 17
    v_lshlrev_b16 v14, 8, v14
    v_lshrrev_b32 v13, 2, v23
    v_or_b32 v19, v12, v11
    v_bitop3_b32 v23, v5, v13, v14 bitop3:0xea
    ds_add_u32 v23, v2
    v_cvt_pk_bf16_f32 v25, v9, v10
    v_perm_b32 v12, v25, v25, s41
    v_bitop3_b32 v18, v4, v12, v18 bitop3:0xca
    v_perm_b32 v13, v25, v25, s42
    v_bitop3_b32 v19, v4, v13, v19 bitop3:0xca
    s_add_u32 s44, s33, 0x1000000
    buffer_load_dwordx4 v[56:59], v0, s[8:11], s44 offen nt
    s_add_u32 s45, s33, 0x1000000
    buffer_load_dwordx4 v[60:63], v0, s[12:15], s45 offen nt
    s_add_u32 s46, s34, 0x800000
    buffer_load_dwordx2 v[64:65], v1, s[16:19], s46 offen nt
    s_add_u32 s47, s34, 0xa00000
    buffer_load_dwordx2 v[66:67], v1, s[16:19], s47 offen nt
    s_waitcnt vmcnt(10)
    v_lshlrev_b32 v7, 16, v26
    v_and_b32 v8, 0xffff0000, v26
    v_lshlrev_b32 v9, 16, v27
    v_and_b32 v10, 0xffff0000, v27
    v_mul_f32 v7, 0.15915494, v7
    v_mul_f32 v8, 0.15915494, v8
    v_mul_f32 v9, 0.15915494, v9
    v_mul_f32 v10, 0.15915494, v10
    v_mul_hi_u32_u24 v14, 429497, v28
    v_lshrrev_b32 v12, 3, v32
    v_cos_f32 v7, v7
    v_lshlrev_b16 v13, 3, v32
    v_mad_i32_i24 v11, v14, s55, v28
    v_bitop3_b32 v12, v6, v13, v12 bitop3:0xca
    v_add_lshl_u32 v11, v11, s40, 17
    v_lshlrev_b16 v14, 8, v14
    v_lshrrev_b32 v13, 2, v32
    v_or_b32 v28, v12, v11
    v_bitop3_b32 v32, v5, v13, v14 bitop3:0xea
    ds_add_u32 v32, v2
    v_mul_hi_u32_u24 v14, 429497, v29
    v_lshrrev_b32 v12, 3, v33
    v_cos_f32 v8, v8
    v_lshlrev_b16 v13, 3, v33
    v_mad_i32_i24 v11, v14, s55, v29
    v_bitop3_b32 v12, v6, v13, v12 bitop3:0xca
    v_add_lshl_u32 v11, v11, s40, 17
    v_lshlrev_b16 v14, 8, v14
    v_lshrrev_b32 v13, 2, v33
    v_or_b32 v29, v12, v11
    v_bitop3_b32 v33, v5, v13, v14 bitop3:0xea
    ds_add_u32 v33, v2
    v_cvt_pk_bf16_f32 v26, v7, v8
    v_perm_b32 v12, v26, v26, s41
    v_bitop3_b32 v28, v4, v12, v28 bitop3:0xca
    v_perm_b32 v13, v26, v26, s42
    v_bitop3_b32 v29, v4, v13, v29 bitop3:0xca
    v_mul_hi_u32_u24 v14, 429497, v30
    v_lshrrev_b32 v12, 3, v34
    v_cos_f32 v9, v9
    v_lshlrev_b16 v13, 3, v34
    v_mad_i32_i24 v11, v14, s55, v30
    v_bitop3_b32 v12, v6, v13, v12 bitop3:0xca
    v_add_lshl_u32 v11, v11, s40, 17
    v_lshlrev_b16 v14, 8, v14
    v_lshrrev_b32 v13, 2, v34
    v_or_b32 v30, v12, v11
    v_bitop3_b32 v34, v5, v13, v14 bitop3:0xea
    ds_add_u32 v34, v2
    v_mul_hi_u32_u24 v14, 429497, v31
    v_lshrrev_b32 v12, 3, v35
    v_cos_f32 v10, v10
    v_lshlrev_b16 v13, 3, v35
    v_mad_i32_i24 v11, v14, s55, v31
    v_bitop3_b32 v12, v6, v13, v12 bitop3:0xca
    v_add_lshl_u32 v11, v11, s40, 17
    v_lshlrev_b16 v14, 8, v14
    v_lshrrev_b32 v13, 2, v35
    v_or_b32 v31, v12, v11
    v_bitop3_b32 v35, v5, v13, v14 bitop3:0xea
    ds_add_u32 v35, v2
    v_cvt_pk_bf16_f32 v27, v9, v10
    v_perm_b32 v12, v27, v27, s41
    v_bitop3_b32 v30, v4, v12, v30 bitop3:0xca
    v_perm_b32 v13, v27, v27, s42
    v_bitop3_b32 v31, v4, v13, v31 bitop3:0xca
    s_add_u32 s44, s33, 0x1400000
    buffer_load_dwordx4 v[68:71], v0, s[8:11], s44 offen nt
    s_add_u32 s45, s33, 0x1400000
    buffer_load_dwordx4 v[72:75], v0, s[12:15], s45 offen nt
    s_waitcnt vmcnt(8)
    v_lshlrev_b32 v7, 16, v44
    v_and_b32 v8, 0xffff0000, v44
    v_lshlrev_b32 v9, 16, v45
    v_and_b32 v10, 0xffff0000, v45
    v_mul_f32 v7, 0.15915494, v7
    v_mul_f32 v8, 0.15915494, v8
    v_mul_f32 v9, 0.15915494, v9
    v_mul_f32 v10, 0.15915494, v10
    v_mul_hi_u32_u24 v14, 429497, v36
    v_lshrrev_b32 v12, 3, v40
    v_cos_f32 v7, v7
    v_lshlrev_b16 v13, 3, v40
    v_mad_i32_i24 v11, v14, s55, v36
    v_bitop3_b32 v12, v6, v13, v12 bitop3:0xca
    v_add_lshl_u32 v11, v11, s40, 17
    v_lshlrev_b16 v14, 8, v14
    v_lshrrev_b32 v13, 2, v40
    v_or_b32 v36, v12, v11
    v_bitop3_b32 v40, v5, v13, v14 bitop3:0xea
    ds_add_u32 v40, v2
    v_mul_hi_u32_u24 v14, 429497, v37
    v_lshrrev_b32 v12, 3, v41
    v_cos_f32 v8, v8
    v_lshlrev_b16 v13, 3, v41
    v_mad_i32_i24 v11, v14, s55, v37
    v_bitop3_b32 v12, v6, v13, v12 bitop3:0xca
    v_add_lshl_u32 v11, v11, s40, 17
    v_lshlrev_b16 v14, 8, v14
    v_lshrrev_b32 v13, 2, v41
    v_or_b32 v37, v12, v11
    v_bitop3_b32 v41, v5, v13, v14 bitop3:0xea
    ds_add_u32 v41, v2
    v_cvt_pk_bf16_f32 v44, v7, v8
    v_perm_b32 v12, v44, v44, s41
    v_bitop3_b32 v36, v4, v12, v36 bitop3:0xca
    v_perm_b32 v13, v44, v44, s42
    v_bitop3_b32 v37, v4, v13, v37 bitop3:0xca
    v_mul_hi_u32_u24 v14, 429497, v38
    v_lshrrev_b32 v12, 3, v42
    v_cos_f32 v9, v9
    v_lshlrev_b16 v13, 3, v42
    v_mad_i32_i24 v11, v14, s55, v38
    v_bitop3_b32 v12, v6, v13, v12 bitop3:0xca
    v_add_lshl_u32 v11, v11, s40, 17
    v_lshlrev_b16 v14, 8, v14
    v_lshrrev_b32 v13, 2, v42
    v_or_b32 v38, v12, v11
    v_bitop3_b32 v42, v5, v13, v14 bitop3:0xea
    ds_add_u32 v42, v2
    v_mul_hi_u32_u24 v14, 429497, v39
    v_lshrrev_b32 v12, 3, v43
    v_cos_f32 v10, v10
    v_lshlrev_b16 v13, 3, v43
    v_mad_i32_i24 v11, v14, s55, v39
    v_bitop3_b32 v12, v6, v13, v12 bitop3:0xca
    v_add_lshl_u32 v11, v11, s40, 17
    v_lshlrev_b16 v14, 8, v14
    v_lshrrev_b32 v13, 2, v43
    v_or_b32 v39, v12, v11
    v_bitop3_b32 v43, v5, v13, v14 bitop3:0xea
    ds_add_u32 v43, v2
    v_cvt_pk_bf16_f32 v45, v9, v10
    v_perm_b32 v12, v45, v45, s41
    v_bitop3_b32 v38, v4, v12, v38 bitop3:0xca
    v_perm_b32 v13, v45, v45, s42
    v_bitop3_b32 v39, v4, v13, v39 bitop3:0xca
    s_add_u32 s46, s33, 0x1800000
    buffer_load_dwordx4 v[76:79], v0, s[8:11], s46 offen nt
    s_add_u32 s47, s33, 0x1800000
    buffer_load_dwordx4 v[80:83], v0, s[12:15], s47 offen nt
    s_add_u32 s44, s34, 0xc00000
    buffer_load_dwordx2 v[84:85], v1, s[16:19], s44 offen nt
    s_add_u32 s45, s34, 0xe00000
    buffer_load_dwordx2 v[86:87], v1, s[16:19], s45 offen nt
    s_waitcnt vmcnt(10)
    v_lshlrev_b32 v7, 16, v46
    v_and_b32 v8, 0xffff0000, v46
    v_lshlrev_b32 v9, 16, v47
    v_and_b32 v10, 0xffff0000, v47
    v_mul_f32 v7, 0.15915494, v7
    v_mul_f32 v8, 0.15915494, v8
    v_mul_f32 v9, 0.15915494, v9
    v_mul_f32 v10, 0.15915494, v10
    v_mul_hi_u32_u24 v14, 429497, v48
    v_lshrrev_b32 v12, 3, v52
    v_cos_f32 v7, v7
    v_lshlrev_b16 v13, 3, v52
    v_mad_i32_i24 v11, v14, s55, v48
    v_bitop3_b32 v12, v6, v13, v12 bitop3:0xca
    v_add_lshl_u32 v11, v11, s40, 17
    v_lshlrev_b16 v14, 8, v14
    v_lshrrev_b32 v13, 2, v52
    v_or_b32 v48, v12, v11
    v_bitop3_b32 v52, v5, v13, v14 bitop3:0xea
    ds_add_u32 v52, v2
    v_mul_hi_u32_u24 v14, 429497, v49
    v_lshrrev_b32 v12, 3, v53
    v_cos_f32 v8, v8
    v_lshlrev_b16 v13, 3, v53
    v_mad_i32_i24 v11, v14, s55, v49
    v_bitop3_b32 v12, v6, v13, v12 bitop3:0xca
    v_add_lshl_u32 v11, v11, s40, 17
    v_lshlrev_b16 v14, 8, v14
    v_lshrrev_b32 v13, 2, v53
    v_or_b32 v49, v12, v11
    v_bitop3_b32 v53, v5, v13, v14 bitop3:0xea
    ds_add_u32 v53, v2
    v_cvt_pk_bf16_f32 v46, v7, v8
    v_perm_b32 v12, v46, v46, s41
    v_bitop3_b32 v48, v4, v12, v48 bitop3:0xca
    v_perm_b32 v13, v46, v46, s42
    v_bitop3_b32 v49, v4, v13, v49 bitop3:0xca
    v_mul_hi_u32_u24 v14, 429497, v50
    v_lshrrev_b32 v12, 3, v54
    v_cos_f32 v9, v9
    v_lshlrev_b16 v13, 3, v54
    v_mad_i32_i24 v11, v14, s55, v50
    v_bitop3_b32 v12, v6, v13, v12 bitop3:0xca
    v_add_lshl_u32 v11, v11, s40, 17
    v_lshlrev_b16 v14, 8, v14
    v_lshrrev_b32 v13, 2, v54
    v_or_b32 v50, v12, v11
    v_bitop3_b32 v54, v5, v13, v14 bitop3:0xea
    ds_add_u32 v54, v2
    v_mul_hi_u32_u24 v14, 429497, v51
    v_lshrrev_b32 v12, 3, v55
    v_cos_f32 v10, v10
    v_lshlrev_b16 v13, 3, v55
    v_mad_i32_i24 v11, v14, s55, v51
    v_bitop3_b32 v12, v6, v13, v12 bitop3:0xca
    v_add_lshl_u32 v11, v11, s40, 17
    v_lshlrev_b16 v14, 8, v14
    v_lshrrev_b32 v13, 2, v55
    v_or_b32 v51, v12, v11
    v_bitop3_b32 v55, v5, v13, v14 bitop3:0xea
    ds_add_u32 v55, v2
    v_cvt_pk_bf16_f32 v47, v9, v10
    v_perm_b32 v12, v47, v47, s41
    v_bitop3_b32 v50, v4, v12, v50 bitop3:0xca
    v_perm_b32 v13, v47, v47, s42
    v_bitop3_b32 v51, v4, v13, v51 bitop3:0xca
    s_add_u32 s46, s33, 0x1c00000
    buffer_load_dwordx4 v[88:91], v0, s[8:11], s46 offen nt
    s_add_u32 s47, s33, 0x1c00000
    buffer_load_dwordx4 v[92:95], v0, s[12:15], s47 offen nt
    s_waitcnt vmcnt(8)
    v_lshlrev_b32 v7, 16, v64
    v_and_b32 v8, 0xffff0000, v64
    v_lshlrev_b32 v9, 16, v65
    v_and_b32 v10, 0xffff0000, v65
    v_mul_f32 v7, 0.15915494, v7
    v_mul_f32 v8, 0.15915494, v8
    v_mul_f32 v9, 0.15915494, v9
    v_mul_f32 v10, 0.15915494, v10
    v_mul_hi_u32_u24 v14, 429497, v56
    v_lshrrev_b32 v12, 3, v60
    v_cos_f32 v7, v7
    v_lshlrev_b16 v13, 3, v60
    v_mad_i32_i24 v11, v14, s55, v56
    v_bitop3_b32 v12, v6, v13, v12 bitop3:0xca
    v_add_lshl_u32 v11, v11, s40, 17
    v_lshlrev_b16 v14, 8, v14
    v_lshrrev_b32 v13, 2, v60
    v_or_b32 v56, v12, v11
    v_bitop3_b32 v60, v5, v13, v14 bitop3:0xea
    ds_add_u32 v60, v2
    v_mul_hi_u32_u24 v14, 429497, v57
    v_lshrrev_b32 v12, 3, v61
    v_cos_f32 v8, v8
    v_lshlrev_b16 v13, 3, v61
    v_mad_i32_i24 v11, v14, s55, v57
    v_bitop3_b32 v12, v6, v13, v12 bitop3:0xca
    v_add_lshl_u32 v11, v11, s40, 17
    v_lshlrev_b16 v14, 8, v14
    v_lshrrev_b32 v13, 2, v61
    v_or_b32 v57, v12, v11
    v_bitop3_b32 v61, v5, v13, v14 bitop3:0xea
    ds_add_u32 v61, v2
    v_cvt_pk_bf16_f32 v64, v7, v8
    v_perm_b32 v12, v64, v64, s41
    v_bitop3_b32 v56, v4, v12, v56 bitop3:0xca
    v_perm_b32 v13, v64, v64, s42
    v_bitop3_b32 v57, v4, v13, v57 bitop3:0xca
    v_mul_hi_u32_u24 v14, 429497, v58
    v_lshrrev_b32 v12, 3, v62
    v_cos_f32 v9, v9
    v_lshlrev_b16 v13, 3, v62
    v_mad_i32_i24 v11, v14, s55, v58
    v_bitop3_b32 v12, v6, v13, v12 bitop3:0xca
    v_add_lshl_u32 v11, v11, s40, 17
    v_lshlrev_b16 v14, 8, v14
    v_lshrrev_b32 v13, 2, v62
    v_or_b32 v58, v12, v11
    v_bitop3_b32 v62, v5, v13, v14 bitop3:0xea
    ds_add_u32 v62, v2
    v_mul_hi_u32_u24 v14, 429497, v59
    v_lshrrev_b32 v12, 3, v63
    v_cos_f32 v10, v10
    v_lshlrev_b16 v13, 3, v63
    v_mad_i32_i24 v11, v14, s55, v59
    v_bitop3_b32 v12, v6, v13, v12 bitop3:0xca
    v_add_lshl_u32 v11, v11, s40, 17
    v_lshlrev_b16 v14, 8, v14
    v_lshrrev_b32 v13, 2, v63
    v_or_b32 v59, v12, v11
    v_bitop3_b32 v63, v5, v13, v14 bitop3:0xea
    ds_add_u32 v63, v2
    v_cvt_pk_bf16_f32 v65, v9, v10
    v_perm_b32 v12, v65, v65, s41
    v_bitop3_b32 v58, v4, v12, v58 bitop3:0xca
    v_perm_b32 v13, v65, v65, s42
    v_bitop3_b32 v59, v4, v13, v59 bitop3:0xca
    s_add_u32 s44, s33, 0x2000000
    buffer_load_dwordx4 v[96:99], v0, s[8:11], s44 offen nt
    s_add_u32 s45, s33, 0x2000000
    buffer_load_dwordx4 v[100:103], v0, s[12:15], s45 offen nt
    s_add_u32 s46, s34, 0x1000000
    buffer_load_dwordx2 v[104:105], v1, s[16:19], s46 offen nt
    s_add_u32 s47, s34, 0x1200000
    buffer_load_dwordx2 v[106:107], v1, s[16:19], s47 offen nt
    s_waitcnt vmcnt(10)
    v_lshlrev_b32 v7, 16, v66
    v_and_b32 v8, 0xffff0000, v66
    v_lshlrev_b32 v9, 16, v67
    v_and_b32 v10, 0xffff0000, v67
    v_mul_f32 v7, 0.15915494, v7
    v_mul_f32 v8, 0.15915494, v8
    v_mul_f32 v9, 0.15915494, v9
    v_mul_f32 v10, 0.15915494, v10
    v_mul_hi_u32_u24 v14, 429497, v68
    v_lshrrev_b32 v12, 3, v72
    v_cos_f32 v7, v7
    v_lshlrev_b16 v13, 3, v72
    v_mad_i32_i24 v11, v14, s55, v68
    v_bitop3_b32 v12, v6, v13, v12 bitop3:0xca
    v_add_lshl_u32 v11, v11, s40, 17
    v_lshlrev_b16 v14, 8, v14
    v_lshrrev_b32 v13, 2, v72
    v_or_b32 v68, v12, v11
    v_bitop3_b32 v72, v5, v13, v14 bitop3:0xea
    ds_add_u32 v72, v2
    v_mul_hi_u32_u24 v14, 429497, v69
    v_lshrrev_b32 v12, 3, v73
    v_cos_f32 v8, v8
    v_lshlrev_b16 v13, 3, v73
    v_mad_i32_i24 v11, v14, s55, v69
    v_bitop3_b32 v12, v6, v13, v12 bitop3:0xca
    v_add_lshl_u32 v11, v11, s40, 17
    v_lshlrev_b16 v14, 8, v14
    v_lshrrev_b32 v13, 2, v73
    v_or_b32 v69, v12, v11
    v_bitop3_b32 v73, v5, v13, v14 bitop3:0xea
    ds_add_u32 v73, v2
    v_cvt_pk_bf16_f32 v66, v7, v8
    v_perm_b32 v12, v66, v66, s41
    v_bitop3_b32 v68, v4, v12, v68 bitop3:0xca
    v_perm_b32 v13, v66, v66, s42
    v_bitop3_b32 v69, v4, v13, v69 bitop3:0xca
    v_mul_hi_u32_u24 v14, 429497, v70
    v_lshrrev_b32 v12, 3, v74
    v_cos_f32 v9, v9
    v_lshlrev_b16 v13, 3, v74
    v_mad_i32_i24 v11, v14, s55, v70
    v_bitop3_b32 v12, v6, v13, v12 bitop3:0xca
    v_add_lshl_u32 v11, v11, s40, 17
    v_lshlrev_b16 v14, 8, v14
    v_lshrrev_b32 v13, 2, v74
    v_or_b32 v70, v12, v11
    v_bitop3_b32 v74, v5, v13, v14 bitop3:0xea
    ds_add_u32 v74, v2
    v_mul_hi_u32_u24 v14, 429497, v71
    v_lshrrev_b32 v12, 3, v75
    v_cos_f32 v10, v10
    v_lshlrev_b16 v13, 3, v75
    v_mad_i32_i24 v11, v14, s55, v71
    v_bitop3_b32 v12, v6, v13, v12 bitop3:0xca
    v_add_lshl_u32 v11, v11, s40, 17
    v_lshlrev_b16 v14, 8, v14
    v_lshrrev_b32 v13, 2, v75
    v_or_b32 v71, v12, v11
    v_bitop3_b32 v75, v5, v13, v14 bitop3:0xea
    ds_add_u32 v75, v2
    v_cvt_pk_bf16_f32 v67, v9, v10
    v_perm_b32 v12, v67, v67, s41
    v_bitop3_b32 v70, v4, v12, v70 bitop3:0xca
    v_perm_b32 v13, v67, v67, s42
    v_bitop3_b32 v71, v4, v13, v71 bitop3:0xca
    s_add_u32 s44, s33, 0x2400000
    buffer_load_dwordx4 v[108:111], v0, s[8:11], s44 offen nt
    s_waitcnt vmcnt(7)
    v_lshlrev_b32 v7, 16, v84
    v_and_b32 v8, 0xffff0000, v84
    v_lshlrev_b32 v9, 16, v85
    v_and_b32 v10, 0xffff0000, v85
    v_mul_f32 v7, 0.15915494, v7
    v_mul_f32 v8, 0.15915494, v8
    v_mul_f32 v9, 0.15915494, v9
    v_mul_f32 v10, 0.15915494, v10
    v_mul_hi_u32_u24 v14, 429497, v76
    v_lshrrev_b32 v12, 3, v80
    v_cos_f32 v7, v7
    v_lshlrev_b16 v13, 3, v80
    v_mad_i32_i24 v11, v14, s55, v76
    v_bitop3_b32 v12, v6, v13, v12 bitop3:0xca
    v_add_lshl_u32 v11, v11, s40, 17
    v_lshlrev_b16 v14, 8, v14
    v_lshrrev_b32 v13, 2, v80
    v_or_b32 v76, v12, v11
    v_bitop3_b32 v80, v5, v13, v14 bitop3:0xea
    ds_add_u32 v80, v2
    v_mul_hi_u32_u24 v14, 429497, v77
    v_lshrrev_b32 v12, 3, v81
    v_cos_f32 v8, v8
    v_lshlrev_b16 v13, 3, v81
    v_mad_i32_i24 v11, v14, s55, v77
    v_bitop3_b32 v12, v6, v13, v12 bitop3:0xca
    v_add_lshl_u32 v11, v11, s40, 17
    v_lshlrev_b16 v14, 8, v14
    v_lshrrev_b32 v13, 2, v81
    v_or_b32 v77, v12, v11
    v_bitop3_b32 v81, v5, v13, v14 bitop3:0xea
    ds_add_u32 v81, v2
    v_cvt_pk_bf16_f32 v84, v7, v8
    v_perm_b32 v12, v84, v84, s41
    v_bitop3_b32 v76, v4, v12, v76 bitop3:0xca
    v_perm_b32 v13, v84, v84, s42
    v_bitop3_b32 v77, v4, v13, v77 bitop3:0xca
    v_mul_hi_u32_u24 v14, 429497, v78
    v_lshrrev_b32 v12, 3, v82
    v_cos_f32 v9, v9
    v_lshlrev_b16 v13, 3, v82
    v_mad_i32_i24 v11, v14, s55, v78
    v_bitop3_b32 v12, v6, v13, v12 bitop3:0xca
    v_add_lshl_u32 v11, v11, s40, 17
    v_lshlrev_b16 v14, 8, v14
    v_lshrrev_b32 v13, 2, v82
    v_or_b32 v78, v12, v11
    v_bitop3_b32 v82, v5, v13, v14 bitop3:0xea
    ds_add_u32 v82, v2
    v_mul_hi_u32_u24 v14, 429497, v79
    v_lshrrev_b32 v12, 3, v83
    v_cos_f32 v10, v10
    v_lshlrev_b16 v13, 3, v83
    v_mad_i32_i24 v11, v14, s55, v79
    v_bitop3_b32 v12, v6, v13, v12 bitop3:0xca
    v_add_lshl_u32 v11, v11, s40, 17
    v_lshlrev_b16 v14, 8, v14
    v_lshrrev_b32 v13, 2, v83
    v_or_b32 v79, v12, v11
    v_bitop3_b32 v83, v5, v13, v14 bitop3:0xea
    ds_add_u32 v83, v2
    v_cvt_pk_bf16_f32 v85, v9, v10
    v_perm_b32 v12, v85, v85, s41
    v_bitop3_b32 v78, v4, v12, v78 bitop3:0xca
    v_perm_b32 v13, v85, v85, s42
    v_bitop3_b32 v79, v4, v13, v79 bitop3:0xca
    s_waitcnt vmcnt(5)
    v_lshlrev_b32 v7, 16, v86
    v_and_b32 v8, 0xffff0000, v86
    v_lshlrev_b32 v9, 16, v87
    v_and_b32 v10, 0xffff0000, v87
    v_mul_f32 v7, 0.15915494, v7
    v_mul_f32 v8, 0.15915494, v8
    v_mul_f32 v9, 0.15915494, v9
    v_mul_f32 v10, 0.15915494, v10
    v_mul_hi_u32_u24 v14, 429497, v88
    v_lshrrev_b32 v12, 3, v92
    v_cos_f32 v7, v7
    v_lshlrev_b16 v13, 3, v92
    v_mad_i32_i24 v11, v14, s55, v88
    v_bitop3_b32 v12, v6, v13, v12 bitop3:0xca
    v_add_lshl_u32 v11, v11, s40, 17
    v_lshlrev_b16 v14, 8, v14
    v_lshrrev_b32 v13, 2, v92
    v_or_b32 v88, v12, v11
    v_bitop3_b32 v92, v5, v13, v14 bitop3:0xea
    ds_add_u32 v92, v2
    v_mul_hi_u32_u24 v14, 429497, v89
    v_lshrrev_b32 v12, 3, v93
    v_cos_f32 v8, v8
    v_lshlrev_b16 v13, 3, v93
    v_mad_i32_i24 v11, v14, s55, v89
    v_bitop3_b32 v12, v6, v13, v12 bitop3:0xca
    v_add_lshl_u32 v11, v11, s40, 17
    v_lshlrev_b16 v14, 8, v14
    v_lshrrev_b32 v13, 2, v93
    v_or_b32 v89, v12, v11
    v_bitop3_b32 v93, v5, v13, v14 bitop3:0xea
    ds_add_u32 v93, v2
    v_cvt_pk_bf16_f32 v86, v7, v8
    v_perm_b32 v12, v86, v86, s41
    v_bitop3_b32 v88, v4, v12, v88 bitop3:0xca
    v_perm_b32 v13, v86, v86, s42
    v_bitop3_b32 v89, v4, v13, v89 bitop3:0xca
    v_mul_hi_u32_u24 v14, 429497, v90
    v_lshrrev_b32 v12, 3, v94
    v_cos_f32 v9, v9
    v_lshlrev_b16 v13, 3, v94
    v_mad_i32_i24 v11, v14, s55, v90
    v_bitop3_b32 v12, v6, v13, v12 bitop3:0xca
    v_add_lshl_u32 v11, v11, s40, 17
    v_lshlrev_b16 v14, 8, v14
    v_lshrrev_b32 v13, 2, v94
    v_or_b32 v90, v12, v11
    v_bitop3_b32 v94, v5, v13, v14 bitop3:0xea
    ds_add_u32 v94, v2
    v_mul_hi_u32_u24 v14, 429497, v91
    v_lshrrev_b32 v12, 3, v95
    v_cos_f32 v10, v10
    v_lshlrev_b16 v13, 3, v95
    v_mad_i32_i24 v11, v14, s55, v91
    v_bitop3_b32 v12, v6, v13, v12 bitop3:0xca
    v_add_lshl_u32 v11, v11, s40, 17
    v_lshlrev_b16 v14, 8, v14
    v_lshrrev_b32 v13, 2, v95
    v_or_b32 v91, v12, v11
    v_bitop3_b32 v95, v5, v13, v14 bitop3:0xea
    ds_add_u32 v95, v2
    v_cvt_pk_bf16_f32 v87, v9, v10
    v_perm_b32 v12, v87, v87, s41
    v_bitop3_b32 v90, v4, v12, v90 bitop3:0xca
    v_perm_b32 v13, v87, v87, s42
    v_bitop3_b32 v91, v4, v13, v91 bitop3:0xca
    v_lshrrev_b32 v8, 2, v0
    v_and_b32 v7, 0x3c00, v0
    v_bitop3_b32 v7, v5, v8, v7 bitop3:0xea
    s_waitcnt lgkmcnt(0)
    s_barrier
    ds_read2st64_b32 v[8:9], v7 offset0:0 offset1:1
    ds_read2st64_b32 v[10:11], v7 offset0:2 offset1:3
    s_add_u32 s45, s33, 0x2400000
    buffer_load_dwordx4 v[112:115], v0, s[12:15], s45 offen nt
    s_waitcnt lgkmcnt(0)
    v_lshl_or_b32 v12, v9, 16, v8
    v_lshl_or_b32 v13, v11, 16, v10
    v_mov_b32 v14, v12
    v_mov_b32 v15, v13
    s_nop 0
    v_add_u32_dpp v14, v14, v14 row_shr:1 row_mask:0xf bank_mask:0xf bound_ctrl:1
    v_add_u32_dpp v15, v15, v15 row_shr:1 row_mask:0xf bank_mask:0xf bound_ctrl:1
    s_nop 0
    v_add_u32_dpp v14, v14, v14 row_shr:2 row_mask:0xf bank_mask:0xf bound_ctrl:1
    v_add_u32_dpp v15, v15, v15 row_shr:2 row_mask:0xf bank_mask:0xf bound_ctrl:1
    s_nop 0
    v_add_u32_dpp v14, v14, v14 row_shr:4 row_mask:0xf bank_mask:0xf bound_ctrl:1
    v_add_u32_dpp v15, v15, v15 row_shr:4 row_mask:0xf bank_mask:0xf bound_ctrl:1
    s_nop 0
    v_add_u32_dpp v14, v14, v14 row_shr:8 row_mask:0xf bank_mask:0xf bound_ctrl:1
    v_add_u32_dpp v15, v15, v15 row_shr:8 row_mask:0xf bank_mask:0xf bound_ctrl:1
    s_nop 0
    v_add_u32_dpp v14, v14, v14 row_bcast:15 row_mask:0xa bank_mask:0xf
    v_add_u32_dpp v15, v15, v15 row_bcast:15 row_mask:0xa bank_mask:0xf
    s_nop 0
    v_add_u32_dpp v14, v14, v14 row_bcast:31 row_mask:0xc bank_mask:0xf
    v_add_u32_dpp v15, v15, v15 row_bcast:31 row_mask:0xc bank_mask:0xf
    v_readlane_b32 s48, v14, 63
    v_readlane_b32 s49, v15, 63
    s_lshl_b32 s54, s32, 2
    v_mov_b32 v8, s54
    s_and_b32 s50, s48, 0xffff
    s_lshr_b32 s51, s48, 16
    s_and_b32 s52, s49, 0xffff
    s_lshr_b32 s53, s49, 16
    s_add_u32 s51, s51, s50
    s_add_u32 s52, s52, s51
    s_add_u32 s53, s53, s52
    v_mov_b32 v9, s53
    s_mov_b64 exec, 1
    ds_write_b32 v8, v9 offset:16384
    s_mov_b64 exec, -1
    v_and_b32 v8, 60, v7
    s_waitcnt lgkmcnt(0)
    s_barrier
    ds_read_b32 v9, v8 offset:16384
    s_waitcnt lgkmcnt(0)
    v_add_u32_dpp v9, v9, v9 row_shr:1 row_mask:0xf bank_mask:0xf bound_ctrl:1
    s_nop 1
    v_add_u32_dpp v9, v9, v9 row_shr:2 row_mask:0xf bank_mask:0xf bound_ctrl:1
    s_nop 1
    v_add_u32_dpp v9, v9, v9 row_shr:4 row_mask:0xf bank_mask:0xf bound_ctrl:1
    s_nop 1
    v_add_u32_dpp v9, v9, v9 row_shr:8 row_mask:0xf bank_mask:0xf bound_ctrl:1
    s_nop 0
    v_readlane_b32 s54, v9, s32
    s_sub_u32 s54, s54, s53
    s_add_u32 s50, s50, s54
    s_add_u32 s51, s51, s54
    s_add_u32 s52, s52, s54
    s_pack_ll_b32_b16 s48, s54, s50
    s_pack_ll_b32_b16 s49, s51, s52
    v_add_u32 v14, s48, v14
    v_add_u32 v15, s49, v15
    v_sub_u32 v12, v14, v12
    v_sub_u32 v13, v15, v13
    v_and_b32 v8, 0xffff, v12
    v_lshrrev_b32 v9, 16, v12
    v_and_b32 v10, 0xffff, v13
    v_lshrrev_b32 v11, 16, v13
    ds_write2st64_b32 v7, v8, v9 offset0:0 offset1:1
    ds_write2st64_b32 v7, v10, v11 offset0:2 offset1:3
    s_waitcnt lgkmcnt(0)
    s_barrier
    ds_add_rtn_u32 v20, v20, v2
    ds_add_rtn_u32 v21, v21, v2
    ds_add_rtn_u32 v22, v22, v2
    ds_add_rtn_u32 v23, v23, v2
    s_add_u32 s46, s36, 0x0
    v_and_b32 v11, 0x3f0, v0
    v_add_u32 v11, v11, v11
    buffer_store_dwordx2 v[12:13], v11, s[24:27], s46 offen
    s_bitset0_b64 exec, 63
    s_not_b64 exec, exec
    buffer_store_dwordx2 v[14:15], v11, s[24:27], s46 offen offset:32
    s_mov_b64 exec, -1
    ds_add_rtn_u32 v32, v32, v2
    ds_add_rtn_u32 v33, v33, v2
    ds_add_rtn_u32 v34, v34, v2
    ds_add_rtn_u32 v35, v35, v2
    ds_add_rtn_u32 v40, v40, v2
    ds_add_rtn_u32 v41, v41, v2
    ds_add_rtn_u32 v42, v42, v2
    ds_add_rtn_u32 v43, v43, v2
    s_add_u32 s47, s33, 0x2800000
    buffer_load_dwordx4 v[116:119], v0, s[8:11], s47 offen nt
    ds_add_rtn_u32 v52, v52, v2
    ds_add_rtn_u32 v53, v53, v2
    ds_add_rtn_u32 v54, v54, v2
    ds_add_rtn_u32 v55, v55, v2
    ds_add_rtn_u32 v60, v60, v2
    ds_add_rtn_u32 v61, v61, v2
    ds_add_rtn_u32 v62, v62, v2
    ds_add_rtn_u32 v63, v63, v2
    ds_add_rtn_u32 v72, v72, v2
    ds_add_rtn_u32 v73, v73, v2
    ds_add_rtn_u32 v74, v74, v2
    ds_add_rtn_u32 v75, v75, v2
    s_add_u32 s44, s33, 0x2800000
    buffer_load_dwordx4 v[120:123], v0, s[12:15], s44 offen nt
    ds_add_rtn_u32 v80, v80, v2
    ds_add_rtn_u32 v81, v81, v2
    ds_add_rtn_u32 v82, v82, v2
    ds_add_rtn_u32 v83, v83, v2
    ds_add_rtn_u32 v92, v92, v2
    ds_add_rtn_u32 v93, v93, v2
    ds_add_rtn_u32 v94, v94, v2
    ds_add_rtn_u32 v95, v95, v2
    s_waitcnt lgkmcnt(0)
    s_barrier
    v_and_b32 v7, -4, v20
    v_lshl_add_u32 v8, v20, 2, v7
    ds_write_b32 v8, v16
    v_lshl_add_u32 v7, v7, 2, v20
    ds_write_b8 v7, v24 offset:16
    v_and_b32 v9, -4, v21
    v_lshl_add_u32 v10, v21, 2, v9
    ds_write_b32 v10, v17
    v_lshl_add_u32 v9, v9, 2, v21
    ds_write_b8_d16_hi v9, v24 offset:16
    v_and_b32 v7, -4, v22
    v_lshl_add_u32 v8, v22, 2, v7
    ds_write_b32 v8, v18
    v_lshl_add_u32 v7, v7, 2, v22
    ds_write_b8 v7, v25 offset:16
    v_and_b32 v9, -4, v23
    v_lshl_add_u32 v10, v23, 2, v9
    ds_write_b32 v10, v19
    v_lshl_add_u32 v9, v9, 2, v23
    ds_write_b8_d16_hi v9, v25 offset:16
    s_add_u32 s45, s34, 0x1400000
    buffer_load_dwordx2 v[124:125], v1, s[16:19], s45 offen nt
    s_add_u32 s46, s34, 0x1600000
    buffer_load_dwordx2 v[126:127], v1, s[16:19], s46 offen nt
    s_add_u32 s47, s33, 0x2c00000
    buffer_load_dwordx4 v[16:19], v0, s[8:11], s47 offen nt
    v_and_b32 v7, -4, v32
    v_lshl_add_u32 v8, v32, 2, v7
    ds_write_b32 v8, v28
    v_lshl_add_u32 v7, v7, 2, v32
    ds_write_b8 v7, v26 offset:16
    v_and_b32 v9, -4, v33
    v_lshl_add_u32 v10, v33, 2, v9
    ds_write_b32 v10, v29
    v_lshl_add_u32 v9, v9, 2, v33
    ds_write_b8_d16_hi v9, v26 offset:16
    v_and_b32 v7, -4, v34
    v_lshl_add_u32 v8, v34, 2, v7
    ds_write_b32 v8, v30
    v_lshl_add_u32 v7, v7, 2, v34
    ds_write_b8 v7, v27 offset:16
    v_and_b32 v9, -4, v35
    v_lshl_add_u32 v10, v35, 2, v9
    ds_write_b32 v10, v31
    v_lshl_add_u32 v9, v9, 2, v35
    ds_write_b8_d16_hi v9, v27 offset:16
    s_add_u32 s44, s33, 0x2c00000
    buffer_load_dwordx4 v[20:23], v0, s[12:15], s44 offen nt
    v_and_b32 v7, -4, v40
    v_lshl_add_u32 v8, v40, 2, v7
    ds_write_b32 v8, v36
    v_lshl_add_u32 v7, v7, 2, v40
    ds_write_b8 v7, v44 offset:16
    v_and_b32 v9, -4, v41
    v_lshl_add_u32 v10, v41, 2, v9
    ds_write_b32 v10, v37
    v_lshl_add_u32 v9, v9, 2, v41
    ds_write_b8_d16_hi v9, v44 offset:16
    v_and_b32 v7, -4, v42
    v_lshl_add_u32 v8, v42, 2, v7
    ds_write_b32 v8, v38
    v_lshl_add_u32 v7, v7, 2, v42
    ds_write_b8 v7, v45 offset:16
    v_and_b32 v9, -4, v43
    v_lshl_add_u32 v10, v43, 2, v9
    ds_write_b32 v10, v39
    v_lshl_add_u32 v9, v9, 2, v43
    ds_write_b8_d16_hi v9, v45 offset:16
    s_add_u32 s45, s33, 0x3000000
    buffer_load_dwordx4 v[28:31], v0, s[8:11], s45 offen nt
    s_add_u32 s46, s33, 0x3000000
    buffer_load_dwordx4 v[32:35], v0, s[12:15], s46 offen nt
    v_and_b32 v7, -4, v52
    v_lshl_add_u32 v8, v52, 2, v7
    ds_write_b32 v8, v48
    v_lshl_add_u32 v7, v7, 2, v52
    ds_write_b8 v7, v46 offset:16
    v_and_b32 v9, -4, v53
    v_lshl_add_u32 v10, v53, 2, v9
    ds_write_b32 v10, v49
    v_lshl_add_u32 v9, v9, 2, v53
    ds_write_b8_d16_hi v9, v46 offset:16
    v_and_b32 v7, -4, v54
    v_lshl_add_u32 v8, v54, 2, v7
    ds_write_b32 v8, v50
    v_lshl_add_u32 v7, v7, 2, v54
    ds_write_b8 v7, v47 offset:16
    v_and_b32 v9, -4, v55
    v_lshl_add_u32 v10, v55, 2, v9
    ds_write_b32 v10, v51
    v_lshl_add_u32 v9, v9, 2, v55
    ds_write_b8_d16_hi v9, v47 offset:16
    s_add_u32 s47, s34, 0x1800000
    buffer_load_dwordx2 v[24:25], v1, s[16:19], s47 offen nt
    s_add_u32 s44, s34, 0x1a00000
    buffer_load_dwordx2 v[26:27], v1, s[16:19], s44 offen nt
    v_and_b32 v7, -4, v60
    v_lshl_add_u32 v8, v60, 2, v7
    ds_write_b32 v8, v56
    v_lshl_add_u32 v7, v7, 2, v60
    ds_write_b8 v7, v64 offset:16
    v_and_b32 v9, -4, v61
    v_lshl_add_u32 v10, v61, 2, v9
    ds_write_b32 v10, v57
    v_lshl_add_u32 v9, v9, 2, v61
    ds_write_b8_d16_hi v9, v64 offset:16
    v_and_b32 v7, -4, v62
    v_lshl_add_u32 v8, v62, 2, v7
    ds_write_b32 v8, v58
    v_lshl_add_u32 v7, v7, 2, v62
    ds_write_b8 v7, v65 offset:16
    v_and_b32 v9, -4, v63
    v_lshl_add_u32 v10, v63, 2, v9
    ds_write_b32 v10, v59
    v_lshl_add_u32 v9, v9, 2, v63
    ds_write_b8_d16_hi v9, v65 offset:16
    s_add_u32 s45, s33, 0x3400000
    buffer_load_dwordx4 v[36:39], v0, s[8:11], s45 offen nt
    v_and_b32 v7, -4, v72
    v_lshl_add_u32 v8, v72, 2, v7
    ds_write_b32 v8, v68
    v_lshl_add_u32 v7, v7, 2, v72
    ds_write_b8 v7, v66 offset:16
    v_and_b32 v9, -4, v73
    v_lshl_add_u32 v10, v73, 2, v9
    ds_write_b32 v10, v69
    v_lshl_add_u32 v9, v9, 2, v73
    ds_write_b8_d16_hi v9, v66 offset:16
    v_and_b32 v7, -4, v74
    v_lshl_add_u32 v8, v74, 2, v7
    ds_write_b32 v8, v70
    v_lshl_add_u32 v7, v7, 2, v74
    ds_write_b8 v7, v67 offset:16
    v_and_b32 v9, -4, v75
    v_lshl_add_u32 v10, v75, 2, v9
    ds_write_b32 v10, v71
    v_lshl_add_u32 v9, v9, 2, v75
    ds_write_b8_d16_hi v9, v67 offset:16
    s_add_u32 s46, s33, 0x3400000
    buffer_load_dwordx4 v[40:43], v0, s[12:15], s46 offen nt
    s_add_u32 s47, s33, 0x3800000
    buffer_load_dwordx4 v[48:51], v0, s[8:11], s47 offen nt
    v_and_b32 v7, -4, v80
    v_lshl_add_u32 v8, v80, 2, v7
    ds_write_b32 v8, v76
    v_lshl_add_u32 v7, v7, 2, v80
    ds_write_b8 v7, v84 offset:16
    v_and_b32 v9, -4, v81
    v_lshl_add_u32 v10, v81, 2, v9
    ds_write_b32 v10, v77
    v_lshl_add_u32 v9, v9, 2, v81
    ds_write_b8_d16_hi v9, v84 offset:16
    v_and_b32 v7, -4, v82
    v_lshl_add_u32 v8, v82, 2, v7
    ds_write_b32 v8, v78
    v_lshl_add_u32 v7, v7, 2, v82
    ds_write_b8 v7, v85 offset:16
    v_and_b32 v9, -4, v83
    v_lshl_add_u32 v10, v83, 2, v9
    ds_write_b32 v10, v79
    v_lshl_add_u32 v9, v9, 2, v83
    ds_write_b8_d16_hi v9, v85 offset:16
    s_add_u32 s44, s33, 0x3800000
    buffer_load_dwordx4 v[52:55], v0, s[12:15], s44 offen nt
    v_and_b32 v7, -4, v92
    v_lshl_add_u32 v8, v92, 2, v7
    ds_write_b32 v8, v88
    v_lshl_add_u32 v7, v7, 2, v92
    ds_write_b8 v7, v86 offset:16
    v_and_b32 v9, -4, v93
    v_lshl_add_u32 v10, v93, 2, v9
    ds_write_b32 v10, v89
    v_lshl_add_u32 v9, v9, 2, v93
    ds_write_b8_d16_hi v9, v86 offset:16
    v_and_b32 v7, -4, v94
    v_lshl_add_u32 v8, v94, 2, v7
    ds_write_b32 v8, v90
    v_lshl_add_u32 v7, v7, 2, v94
    ds_write_b8 v7, v87 offset:16
    v_and_b32 v9, -4, v95
    v_lshl_add_u32 v10, v95, 2, v9
    ds_write_b32 v10, v91
    v_lshl_add_u32 v9, v9, 2, v95
    ds_write_b8_d16_hi v9, v87 offset:16
    s_add_u32 s45, s34, 0x1c00000
    buffer_load_dwordx2 v[44:45], v1, s[16:19], s45 offen nt
    s_add_u32 s46, s34, 0x1e00000
    buffer_load_dwordx2 v[46:47], v1, s[16:19], s46 offen nt
    v_add_u32 v7, 0x10000, v0
    v_add_u32 v12, 0x20000, v0
    v_mov_b32 v8, 0
    v_mov_b32 v9, 0
    v_mov_b32 v10, 0
    v_mov_b32 v11, 0
    s_waitcnt lgkmcnt(0)
    s_barrier
    ds_read_b128 v[56:59], v0 offset:0
    ds_write_b128 v0, v[8:11]
    ds_read_b128 v[60:63], v0 offset:16384
    ds_read_b128 v[68:71], v0 offset:32768
    ds_read_b128 v[72:75], v0 offset:49152
    ds_read_b128 v[64:67], v7 offset:0
    ds_read_b128 v[76:79], v7 offset:16384
    ds_read_b128 v[80:83], v7 offset:32768
    ds_read_b128 v[88:91], v7 offset:49152
    ds_read_b128 v[92:95], v12 offset:0
    ds_read_b128 v[84:87], v12 offset:16384
    s_waitcnt lgkmcnt(0)
    s_barrier
    s_add_u32 s47, s35, 0x0
    buffer_store_dwordx4 v[56:59], v0, s[20:23], s47 offen sc1
    s_add_u32 s44, s33, 0x3c00000
    s_nop 0
    buffer_load_dwordx4 v[56:59], v0, s[8:11], s44 offen nt
    s_add_u32 s45, s35, 0x4000
    buffer_store_dwordx4 v[60:63], v0, s[20:23], s45 offen sc1
    s_add_u32 s46, s33, 0x3c00000
    s_nop 0
    buffer_load_dwordx4 v[60:63], v0, s[12:15], s46 offen nt
    s_waitcnt vmcnt(24)
    v_lshlrev_b32 v7, 16, v104
    v_and_b32 v8, 0xffff0000, v104
    v_lshlrev_b32 v9, 16, v105
    v_and_b32 v10, 0xffff0000, v105
    v_mul_f32 v7, 0.15915494, v7
    v_mul_f32 v8, 0.15915494, v8
    v_mul_f32 v9, 0.15915494, v9
    v_mul_f32 v10, 0.15915494, v10
    v_mul_hi_u32_u24 v14, 429497, v96
    v_lshrrev_b32 v12, 3, v100
    v_cos_f32 v7, v7
    v_lshlrev_b16 v13, 3, v100
    v_mad_i32_i24 v11, v14, s55, v96
    v_bitop3_b32 v12, v6, v13, v12 bitop3:0xca
    v_add_lshl_u32 v11, v11, s40, 17
    v_lshlrev_b16 v14, 8, v14
    v_lshrrev_b32 v13, 2, v100
    v_or_b32 v96, v12, v11
    v_bitop3_b32 v100, v5, v13, v14 bitop3:0xea
    ds_add_u32 v100, v2
    v_mul_hi_u32_u24 v14, 429497, v97
    v_lshrrev_b32 v12, 3, v101
    v_cos_f32 v8, v8
    v_lshlrev_b16 v13, 3, v101
    v_mad_i32_i24 v11, v14, s55, v97
    v_bitop3_b32 v12, v6, v13, v12 bitop3:0xca
    v_add_lshl_u32 v11, v11, s40, 17
    v_lshlrev_b16 v14, 8, v14
    v_lshrrev_b32 v13, 2, v101
    v_or_b32 v97, v12, v11
    v_bitop3_b32 v101, v5, v13, v14 bitop3:0xea
    ds_add_u32 v101, v2
    v_cvt_pk_bf16_f32 v104, v7, v8
    v_perm_b32 v12, v104, v104, s41
    v_bitop3_b32 v96, v4, v12, v96 bitop3:0xca
    v_perm_b32 v13, v104, v104, s42
    v_bitop3_b32 v97, v4, v13, v97 bitop3:0xca
    v_mul_hi_u32_u24 v14, 429497, v98
    v_lshrrev_b32 v12, 3, v102
    v_cos_f32 v9, v9
    v_lshlrev_b16 v13, 3, v102
    v_mad_i32_i24 v11, v14, s55, v98
    v_bitop3_b32 v12, v6, v13, v12 bitop3:0xca
    v_add_lshl_u32 v11, v11, s40, 17
    v_lshlrev_b16 v14, 8, v14
    v_lshrrev_b32 v13, 2, v102
    v_or_b32 v98, v12, v11
    v_bitop3_b32 v102, v5, v13, v14 bitop3:0xea
    ds_add_u32 v102, v2
    v_mul_hi_u32_u24 v14, 429497, v99
    v_lshrrev_b32 v12, 3, v103
    v_cos_f32 v10, v10
    v_lshlrev_b16 v13, 3, v103
    v_mad_i32_i24 v11, v14, s55, v99
    v_bitop3_b32 v12, v6, v13, v12 bitop3:0xca
    v_add_lshl_u32 v11, v11, s40, 17
    v_lshlrev_b16 v14, 8, v14
    v_lshrrev_b32 v13, 2, v103
    v_or_b32 v99, v12, v11
    v_bitop3_b32 v103, v5, v13, v14 bitop3:0xea
    ds_add_u32 v103, v2
    v_cvt_pk_bf16_f32 v105, v9, v10
    v_perm_b32 v12, v105, v105, s41
    v_bitop3_b32 v98, v4, v12, v98 bitop3:0xca
    v_perm_b32 v13, v105, v105, s42
    v_bitop3_b32 v99, v4, v13, v99 bitop3:0xca
    s_waitcnt vmcnt(22)
    v_lshlrev_b32 v7, 16, v106
    v_and_b32 v8, 0xffff0000, v106
    v_lshlrev_b32 v9, 16, v107
    v_and_b32 v10, 0xffff0000, v107
    v_mul_f32 v7, 0.15915494, v7
    v_mul_f32 v8, 0.15915494, v8
    v_mul_f32 v9, 0.15915494, v9
    v_mul_f32 v10, 0.15915494, v10
    v_mul_hi_u32_u24 v14, 429497, v108
    v_lshrrev_b32 v12, 3, v112
    v_cos_f32 v7, v7
    v_lshlrev_b16 v13, 3, v112
    v_mad_i32_i24 v11, v14, s55, v108
    v_bitop3_b32 v12, v6, v13, v12 bitop3:0xca
    v_add_lshl_u32 v11, v11, s40, 17
    v_lshlrev_b16 v14, 8, v14
    v_lshrrev_b32 v13, 2, v112
    v_or_b32 v108, v12, v11
    v_bitop3_b32 v112, v5, v13, v14 bitop3:0xea
    ds_add_u32 v112, v2
    v_mul_hi_u32_u24 v14, 429497, v109
    v_lshrrev_b32 v12, 3, v113
    v_cos_f32 v8, v8
    v_lshlrev_b16 v13, 3, v113
    v_mad_i32_i24 v11, v14, s55, v109
    v_bitop3_b32 v12, v6, v13, v12 bitop3:0xca
    v_add_lshl_u32 v11, v11, s40, 17
    v_lshlrev_b16 v14, 8, v14
    v_lshrrev_b32 v13, 2, v113
    v_or_b32 v109, v12, v11
    v_bitop3_b32 v113, v5, v13, v14 bitop3:0xea
    ds_add_u32 v113, v2
    v_cvt_pk_bf16_f32 v106, v7, v8
    v_perm_b32 v12, v106, v106, s41
    v_bitop3_b32 v108, v4, v12, v108 bitop3:0xca
    v_perm_b32 v13, v106, v106, s42
    v_bitop3_b32 v109, v4, v13, v109 bitop3:0xca
    v_mul_hi_u32_u24 v14, 429497, v110
    v_lshrrev_b32 v12, 3, v114
    v_cos_f32 v9, v9
    v_lshlrev_b16 v13, 3, v114
    v_mad_i32_i24 v11, v14, s55, v110
    v_bitop3_b32 v12, v6, v13, v12 bitop3:0xca
    v_add_lshl_u32 v11, v11, s40, 17
    v_lshlrev_b16 v14, 8, v14
    v_lshrrev_b32 v13, 2, v114
    v_or_b32 v110, v12, v11
    v_bitop3_b32 v114, v5, v13, v14 bitop3:0xea
    ds_add_u32 v114, v2
    v_mul_hi_u32_u24 v14, 429497, v111
    v_lshrrev_b32 v12, 3, v115
    v_cos_f32 v10, v10
    v_lshlrev_b16 v13, 3, v115
    v_mad_i32_i24 v11, v14, s55, v111
    v_bitop3_b32 v12, v6, v13, v12 bitop3:0xca
    v_add_lshl_u32 v11, v11, s40, 17
    v_lshlrev_b16 v14, 8, v14
    v_lshrrev_b32 v13, 2, v115
    v_or_b32 v111, v12, v11
    v_bitop3_b32 v115, v5, v13, v14 bitop3:0xea
    ds_add_u32 v115, v2
    v_cvt_pk_bf16_f32 v107, v9, v10
    v_perm_b32 v12, v107, v107, s41
    v_bitop3_b32 v110, v4, v12, v110 bitop3:0xca
    v_perm_b32 v13, v107, v107, s42
    v_bitop3_b32 v111, v4, v13, v111 bitop3:0xca
    s_waitcnt vmcnt(16)
    v_lshlrev_b32 v7, 16, v124
    v_and_b32 v8, 0xffff0000, v124
    v_lshlrev_b32 v9, 16, v125
    v_and_b32 v10, 0xffff0000, v125
    v_mul_f32 v7, 0.15915494, v7
    v_mul_f32 v8, 0.15915494, v8
    v_mul_f32 v9, 0.15915494, v9
    v_mul_f32 v10, 0.15915494, v10
    v_mul_hi_u32_u24 v14, 429497, v116
    v_lshrrev_b32 v12, 3, v120
    v_cos_f32 v7, v7
    v_lshlrev_b16 v13, 3, v120
    v_mad_i32_i24 v11, v14, s55, v116
    v_bitop3_b32 v12, v6, v13, v12 bitop3:0xca
    v_add_lshl_u32 v11, v11, s40, 17
    v_lshlrev_b16 v14, 8, v14
    v_lshrrev_b32 v13, 2, v120
    v_or_b32 v116, v12, v11
    v_bitop3_b32 v120, v5, v13, v14 bitop3:0xea
    ds_add_u32 v120, v2
    v_mul_hi_u32_u24 v14, 429497, v117
    v_lshrrev_b32 v12, 3, v121
    v_cos_f32 v8, v8
    v_lshlrev_b16 v13, 3, v121
    v_mad_i32_i24 v11, v14, s55, v117
    v_bitop3_b32 v12, v6, v13, v12 bitop3:0xca
    v_add_lshl_u32 v11, v11, s40, 17
    v_lshlrev_b16 v14, 8, v14
    v_lshrrev_b32 v13, 2, v121
    v_or_b32 v117, v12, v11
    v_bitop3_b32 v121, v5, v13, v14 bitop3:0xea
    ds_add_u32 v121, v2
    v_cvt_pk_bf16_f32 v124, v7, v8
    v_perm_b32 v12, v124, v124, s41
    v_bitop3_b32 v116, v4, v12, v116 bitop3:0xca
    v_perm_b32 v13, v124, v124, s42
    v_bitop3_b32 v117, v4, v13, v117 bitop3:0xca
    v_mul_hi_u32_u24 v14, 429497, v118
    v_lshrrev_b32 v12, 3, v122
    v_cos_f32 v9, v9
    v_lshlrev_b16 v13, 3, v122
    v_mad_i32_i24 v11, v14, s55, v118
    v_bitop3_b32 v12, v6, v13, v12 bitop3:0xca
    v_add_lshl_u32 v11, v11, s40, 17
    v_lshlrev_b16 v14, 8, v14
    v_lshrrev_b32 v13, 2, v122
    v_or_b32 v118, v12, v11
    v_bitop3_b32 v122, v5, v13, v14 bitop3:0xea
    ds_add_u32 v122, v2
    v_mul_hi_u32_u24 v14, 429497, v119
    v_lshrrev_b32 v12, 3, v123
    v_cos_f32 v10, v10
    v_lshlrev_b16 v13, 3, v123
    v_mad_i32_i24 v11, v14, s55, v119
    v_bitop3_b32 v12, v6, v13, v12 bitop3:0xca
    v_add_lshl_u32 v11, v11, s40, 17
    v_lshlrev_b16 v14, 8, v14
    v_lshrrev_b32 v13, 2, v123
    v_or_b32 v119, v12, v11
    v_bitop3_b32 v123, v5, v13, v14 bitop3:0xea
    ds_add_u32 v123, v2
    v_cvt_pk_bf16_f32 v125, v9, v10
    v_perm_b32 v12, v125, v125, s41
    v_bitop3_b32 v118, v4, v12, v118 bitop3:0xca
    v_perm_b32 v13, v125, v125, s42
    v_bitop3_b32 v119, v4, v13, v119 bitop3:0xca
    s_add_u32 s47, s35, 0x8000
    buffer_store_dwordx4 v[68:71], v0, s[20:23], s47 offen sc1
    s_add_u32 s44, s33, 0x4000000
    s_nop 0
    buffer_load_dwordx4 v[68:71], v0, s[8:11], s44 offen nt
    s_waitcnt vmcnt(16)
    v_lshlrev_b32 v7, 16, v126
    v_and_b32 v8, 0xffff0000, v126
    v_lshlrev_b32 v9, 16, v127
    v_and_b32 v10, 0xffff0000, v127
    v_mul_f32 v7, 0.15915494, v7
    v_mul_f32 v8, 0.15915494, v8
    v_mul_f32 v9, 0.15915494, v9
    v_mul_f32 v10, 0.15915494, v10
    v_mul_hi_u32_u24 v14, 429497, v16
    v_lshrrev_b32 v12, 3, v20
    v_cos_f32 v7, v7
    v_lshlrev_b16 v13, 3, v20
    v_mad_i32_i24 v11, v14, s55, v16
    v_bitop3_b32 v12, v6, v13, v12 bitop3:0xca
    v_add_lshl_u32 v11, v11, s40, 17
    v_lshlrev_b16 v14, 8, v14
    v_lshrrev_b32 v13, 2, v20
    v_or_b32 v16, v12, v11
    v_bitop3_b32 v20, v5, v13, v14 bitop3:0xea
    ds_add_u32 v20, v2
    v_mul_hi_u32_u24 v14, 429497, v17
    v_lshrrev_b32 v12, 3, v21
    v_cos_f32 v8, v8
    v_lshlrev_b16 v13, 3, v21
    v_mad_i32_i24 v11, v14, s55, v17
    v_bitop3_b32 v12, v6, v13, v12 bitop3:0xca
    v_add_lshl_u32 v11, v11, s40, 17
    v_lshlrev_b16 v14, 8, v14
    v_lshrrev_b32 v13, 2, v21
    v_or_b32 v17, v12, v11
    v_bitop3_b32 v21, v5, v13, v14 bitop3:0xea
    ds_add_u32 v21, v2
    v_cvt_pk_bf16_f32 v126, v7, v8
    v_perm_b32 v12, v126, v126, s41
    v_bitop3_b32 v16, v4, v12, v16 bitop3:0xca
    v_perm_b32 v13, v126, v126, s42
    v_bitop3_b32 v17, v4, v13, v17 bitop3:0xca
    v_mul_hi_u32_u24 v14, 429497, v18
    v_lshrrev_b32 v12, 3, v22
    v_cos_f32 v9, v9
    v_lshlrev_b16 v13, 3, v22
    v_mad_i32_i24 v11, v14, s55, v18
    v_bitop3_b32 v12, v6, v13, v12 bitop3:0xca
    v_add_lshl_u32 v11, v11, s40, 17
    v_lshlrev_b16 v14, 8, v14
    v_lshrrev_b32 v13, 2, v22
    v_or_b32 v18, v12, v11
    v_bitop3_b32 v22, v5, v13, v14 bitop3:0xea
    ds_add_u32 v22, v2
    v_mul_hi_u32_u24 v14, 429497, v19
    v_lshrrev_b32 v12, 3, v23
    v_cos_f32 v10, v10
    v_lshlrev_b16 v13, 3, v23
    v_mad_i32_i24 v11, v14, s55, v19
    v_bitop3_b32 v12, v6, v13, v12 bitop3:0xca
    v_add_lshl_u32 v11, v11, s40, 17
    v_lshlrev_b16 v14, 8, v14
    v_lshrrev_b32 v13, 2, v23
    v_or_b32 v19, v12, v11
    v_bitop3_b32 v23, v5, v13, v14 bitop3:0xea
    ds_add_u32 v23, v2
    v_cvt_pk_bf16_f32 v127, v9, v10
    v_perm_b32 v12, v127, v127, s41
    v_bitop3_b32 v18, v4, v12, v18 bitop3:0xca
    v_perm_b32 v13, v127, v127, s42
    v_bitop3_b32 v19, v4, v13, v19 bitop3:0xca
    s_waitcnt vmcnt(12)
    v_lshlrev_b32 v7, 16, v24
    v_and_b32 v8, 0xffff0000, v24
    v_lshlrev_b32 v9, 16, v25
    v_and_b32 v10, 0xffff0000, v25
    v_mul_f32 v7, 0.15915494, v7
    v_mul_f32 v8, 0.15915494, v8
    v_mul_f32 v9, 0.15915494, v9
    v_mul_f32 v10, 0.15915494, v10
    v_mul_hi_u32_u24 v14, 429497, v28
    v_lshrrev_b32 v12, 3, v32
    v_cos_f32 v7, v7
    v_lshlrev_b16 v13, 3, v32
    v_mad_i32_i24 v11, v14, s55, v28
    v_bitop3_b32 v12, v6, v13, v12 bitop3:0xca
    v_add_lshl_u32 v11, v11, s40, 17
    v_lshlrev_b16 v14, 8, v14
    v_lshrrev_b32 v13, 2, v32
    v_or_b32 v28, v12, v11
    v_bitop3_b32 v32, v5, v13, v14 bitop3:0xea
    ds_add_u32 v32, v2
    v_mul_hi_u32_u24 v14, 429497, v29
    v_lshrrev_b32 v12, 3, v33
    v_cos_f32 v8, v8
    v_lshlrev_b16 v13, 3, v33
    v_mad_i32_i24 v11, v14, s55, v29
    v_bitop3_b32 v12, v6, v13, v12 bitop3:0xca
    v_add_lshl_u32 v11, v11, s40, 17
    v_lshlrev_b16 v14, 8, v14
    v_lshrrev_b32 v13, 2, v33
    v_or_b32 v29, v12, v11
    v_bitop3_b32 v33, v5, v13, v14 bitop3:0xea
    ds_add_u32 v33, v2
    v_cvt_pk_bf16_f32 v24, v7, v8
    v_perm_b32 v12, v24, v24, s41
    v_bitop3_b32 v28, v4, v12, v28 bitop3:0xca
    v_perm_b32 v13, v24, v24, s42
    v_bitop3_b32 v29, v4, v13, v29 bitop3:0xca
    v_mul_hi_u32_u24 v14, 429497, v30
    v_lshrrev_b32 v12, 3, v34
    v_cos_f32 v9, v9
    v_lshlrev_b16 v13, 3, v34
    v_mad_i32_i24 v11, v14, s55, v30
    v_bitop3_b32 v12, v6, v13, v12 bitop3:0xca
    v_add_lshl_u32 v11, v11, s40, 17
    v_lshlrev_b16 v14, 8, v14
    v_lshrrev_b32 v13, 2, v34
    v_or_b32 v30, v12, v11
    v_bitop3_b32 v34, v5, v13, v14 bitop3:0xea
    ds_add_u32 v34, v2
    v_mul_hi_u32_u24 v14, 429497, v31
    v_lshrrev_b32 v12, 3, v35
    v_cos_f32 v10, v10
    v_lshlrev_b16 v13, 3, v35
    v_mad_i32_i24 v11, v14, s55, v31
    v_bitop3_b32 v12, v6, v13, v12 bitop3:0xca
    v_add_lshl_u32 v11, v11, s40, 17
    v_lshlrev_b16 v14, 8, v14
    v_lshrrev_b32 v13, 2, v35
    v_or_b32 v31, v12, v11
    v_bitop3_b32 v35, v5, v13, v14 bitop3:0xea
    ds_add_u32 v35, v2
    v_cvt_pk_bf16_f32 v25, v9, v10
    v_perm_b32 v12, v25, v25, s41
    v_bitop3_b32 v30, v4, v12, v30 bitop3:0xca
    v_perm_b32 v13, v25, v25, s42
    v_bitop3_b32 v31, v4, v13, v31 bitop3:0xca
    s_waitcnt vmcnt(10)
    v_lshlrev_b32 v7, 16, v26
    v_and_b32 v8, 0xffff0000, v26
    v_lshlrev_b32 v9, 16, v27
    v_and_b32 v10, 0xffff0000, v27
    v_mul_f32 v7, 0.15915494, v7
    v_mul_f32 v8, 0.15915494, v8
    v_mul_f32 v9, 0.15915494, v9
    v_mul_f32 v10, 0.15915494, v10
    v_mul_hi_u32_u24 v14, 429497, v36
    v_lshrrev_b32 v12, 3, v40
    v_cos_f32 v7, v7
    v_lshlrev_b16 v13, 3, v40
    v_mad_i32_i24 v11, v14, s55, v36
    v_bitop3_b32 v12, v6, v13, v12 bitop3:0xca
    v_add_lshl_u32 v11, v11, s40, 17
    v_lshlrev_b16 v14, 8, v14
    v_lshrrev_b32 v13, 2, v40
    v_or_b32 v36, v12, v11
    v_bitop3_b32 v40, v5, v13, v14 bitop3:0xea
    ds_add_u32 v40, v2
    v_mul_hi_u32_u24 v14, 429497, v37
    v_lshrrev_b32 v12, 3, v41
    v_cos_f32 v8, v8
    v_lshlrev_b16 v13, 3, v41
    v_mad_i32_i24 v11, v14, s55, v37
    v_bitop3_b32 v12, v6, v13, v12 bitop3:0xca
    v_add_lshl_u32 v11, v11, s40, 17
    v_lshlrev_b16 v14, 8, v14
    v_lshrrev_b32 v13, 2, v41
    v_or_b32 v37, v12, v11
    v_bitop3_b32 v41, v5, v13, v14 bitop3:0xea
    ds_add_u32 v41, v2
    v_cvt_pk_bf16_f32 v26, v7, v8
    v_perm_b32 v12, v26, v26, s41
    v_bitop3_b32 v36, v4, v12, v36 bitop3:0xca
    v_perm_b32 v13, v26, v26, s42
    v_bitop3_b32 v37, v4, v13, v37 bitop3:0xca
    v_mul_hi_u32_u24 v14, 429497, v38
    v_lshrrev_b32 v12, 3, v42
    v_cos_f32 v9, v9
    v_lshlrev_b16 v13, 3, v42
    v_mad_i32_i24 v11, v14, s55, v38
    v_bitop3_b32 v12, v6, v13, v12 bitop3:0xca
    v_add_lshl_u32 v11, v11, s40, 17
    v_lshlrev_b16 v14, 8, v14
    v_lshrrev_b32 v13, 2, v42
    v_or_b32 v38, v12, v11
    v_bitop3_b32 v42, v5, v13, v14 bitop3:0xea
    ds_add_u32 v42, v2
    v_mul_hi_u32_u24 v14, 429497, v39
    v_lshrrev_b32 v12, 3, v43
    v_cos_f32 v10, v10
    v_lshlrev_b16 v13, 3, v43
    v_mad_i32_i24 v11, v14, s55, v39
    v_bitop3_b32 v12, v6, v13, v12 bitop3:0xca
    v_add_lshl_u32 v11, v11, s40, 17
    v_lshlrev_b16 v14, 8, v14
    v_lshrrev_b32 v13, 2, v43
    v_or_b32 v39, v12, v11
    v_bitop3_b32 v43, v5, v13, v14 bitop3:0xea
    ds_add_u32 v43, v2
    v_cvt_pk_bf16_f32 v27, v9, v10
    v_perm_b32 v12, v27, v27, s41
    v_bitop3_b32 v38, v4, v12, v38 bitop3:0xca
    v_perm_b32 v13, v27, v27, s42
    v_bitop3_b32 v39, v4, v13, v39 bitop3:0xca
    s_add_u32 s45, s35, 0xc000
    buffer_store_dwordx4 v[72:75], v0, s[20:23], s45 offen sc1
    s_add_u32 s46, s33, 0x4000000
    s_nop 0
    buffer_load_dwordx4 v[72:75], v0, s[12:15], s46 offen nt
    s_waitcnt vmcnt(8)
    v_lshlrev_b32 v7, 16, v44
    v_and_b32 v8, 0xffff0000, v44
    v_lshlrev_b32 v9, 16, v45
    v_and_b32 v10, 0xffff0000, v45
    v_mul_f32 v7, 0.15915494, v7
    v_mul_f32 v8, 0.15915494, v8
    v_mul_f32 v9, 0.15915494, v9
    v_mul_f32 v10, 0.15915494, v10
    v_mul_hi_u32_u24 v14, 429497, v48
    v_lshrrev_b32 v12, 3, v52
    v_cos_f32 v7, v7
    v_lshlrev_b16 v13, 3, v52
    v_mad_i32_i24 v11, v14, s55, v48
    v_bitop3_b32 v12, v6, v13, v12 bitop3:0xca
    v_add_lshl_u32 v11, v11, s40, 17
    v_lshlrev_b16 v14, 8, v14
    v_lshrrev_b32 v13, 2, v52
    v_or_b32 v48, v12, v11
    v_bitop3_b32 v52, v5, v13, v14 bitop3:0xea
    ds_add_u32 v52, v2
    v_mul_hi_u32_u24 v14, 429497, v49
    v_lshrrev_b32 v12, 3, v53
    v_cos_f32 v8, v8
    v_lshlrev_b16 v13, 3, v53
    v_mad_i32_i24 v11, v14, s55, v49
    v_bitop3_b32 v12, v6, v13, v12 bitop3:0xca
    v_add_lshl_u32 v11, v11, s40, 17
    v_lshlrev_b16 v14, 8, v14
    v_lshrrev_b32 v13, 2, v53
    v_or_b32 v49, v12, v11
    v_bitop3_b32 v53, v5, v13, v14 bitop3:0xea
    ds_add_u32 v53, v2
    v_cvt_pk_bf16_f32 v44, v7, v8
    v_perm_b32 v12, v44, v44, s41
    v_bitop3_b32 v48, v4, v12, v48 bitop3:0xca
    v_perm_b32 v13, v44, v44, s42
    v_bitop3_b32 v49, v4, v13, v49 bitop3:0xca
    v_mul_hi_u32_u24 v14, 429497, v50
    v_lshrrev_b32 v12, 3, v54
    v_cos_f32 v9, v9
    v_lshlrev_b16 v13, 3, v54
    v_mad_i32_i24 v11, v14, s55, v50
    v_bitop3_b32 v12, v6, v13, v12 bitop3:0xca
    v_add_lshl_u32 v11, v11, s40, 17
    v_lshlrev_b16 v14, 8, v14
    v_lshrrev_b32 v13, 2, v54
    v_or_b32 v50, v12, v11
    v_bitop3_b32 v54, v5, v13, v14 bitop3:0xea
    ds_add_u32 v54, v2
    v_mul_hi_u32_u24 v14, 429497, v51
    v_lshrrev_b32 v12, 3, v55
    v_cos_f32 v10, v10
    v_lshlrev_b16 v13, 3, v55
    v_mad_i32_i24 v11, v14, s55, v51
    v_bitop3_b32 v12, v6, v13, v12 bitop3:0xca
    v_add_lshl_u32 v11, v11, s40, 17
    v_lshlrev_b16 v14, 8, v14
    v_lshrrev_b32 v13, 2, v55
    v_or_b32 v51, v12, v11
    v_bitop3_b32 v55, v5, v13, v14 bitop3:0xea
    ds_add_u32 v55, v2
    v_cvt_pk_bf16_f32 v45, v9, v10
    v_perm_b32 v12, v45, v45, s41
    v_bitop3_b32 v50, v4, v12, v50 bitop3:0xca
    v_perm_b32 v13, v45, v45, s42
    v_bitop3_b32 v51, v4, v13, v51 bitop3:0xca
    s_waitcnt vmcnt(4)
    v_lshlrev_b32 v7, 16, v46
    v_and_b32 v8, 0xffff0000, v46
    v_lshlrev_b32 v9, 16, v47
    v_and_b32 v10, 0xffff0000, v47
    v_mul_f32 v7, 0.15915494, v7
    v_mul_f32 v8, 0.15915494, v8
    v_mul_f32 v9, 0.15915494, v9
    v_mul_f32 v10, 0.15915494, v10
    v_mul_hi_u32_u24 v14, 429497, v56
    v_lshrrev_b32 v12, 3, v60
    v_cos_f32 v7, v7
    v_lshlrev_b16 v13, 3, v60
    v_mad_i32_i24 v11, v14, s55, v56
    v_bitop3_b32 v12, v6, v13, v12 bitop3:0xca
    v_add_lshl_u32 v11, v11, s40, 17
    v_lshlrev_b16 v14, 8, v14
    v_lshrrev_b32 v13, 2, v60
    v_or_b32 v56, v12, v11
    v_bitop3_b32 v60, v5, v13, v14 bitop3:0xea
    ds_add_u32 v60, v2
    v_mul_hi_u32_u24 v14, 429497, v57
    v_lshrrev_b32 v12, 3, v61
    v_cos_f32 v8, v8
    v_lshlrev_b16 v13, 3, v61
    v_mad_i32_i24 v11, v14, s55, v57
    v_bitop3_b32 v12, v6, v13, v12 bitop3:0xca
    v_add_lshl_u32 v11, v11, s40, 17
    v_lshlrev_b16 v14, 8, v14
    v_lshrrev_b32 v13, 2, v61
    v_or_b32 v57, v12, v11
    v_bitop3_b32 v61, v5, v13, v14 bitop3:0xea
    ds_add_u32 v61, v2
    v_cvt_pk_bf16_f32 v46, v7, v8
    v_perm_b32 v12, v46, v46, s41
    v_bitop3_b32 v56, v4, v12, v56 bitop3:0xca
    v_perm_b32 v13, v46, v46, s42
    v_bitop3_b32 v57, v4, v13, v57 bitop3:0xca
    v_mul_hi_u32_u24 v14, 429497, v58
    v_lshrrev_b32 v12, 3, v62
    v_cos_f32 v9, v9
    v_lshlrev_b16 v13, 3, v62
    v_mad_i32_i24 v11, v14, s55, v58
    v_bitop3_b32 v12, v6, v13, v12 bitop3:0xca
    v_add_lshl_u32 v11, v11, s40, 17
    v_lshlrev_b16 v14, 8, v14
    v_lshrrev_b32 v13, 2, v62
    v_or_b32 v58, v12, v11
    v_bitop3_b32 v62, v5, v13, v14 bitop3:0xea
    ds_add_u32 v62, v2
    v_mul_hi_u32_u24 v14, 429497, v59
    v_lshrrev_b32 v12, 3, v63
    v_cos_f32 v10, v10
    v_lshlrev_b16 v13, 3, v63
    v_mad_i32_i24 v11, v14, s55, v59
    v_bitop3_b32 v12, v6, v13, v12 bitop3:0xca
    v_add_lshl_u32 v11, v11, s40, 17
    v_lshlrev_b16 v14, 8, v14
    v_lshrrev_b32 v13, 2, v63
    v_or_b32 v59, v12, v11
    v_bitop3_b32 v63, v5, v13, v14 bitop3:0xea
    ds_add_u32 v63, v2
    v_cvt_pk_bf16_f32 v47, v9, v10
    v_perm_b32 v12, v47, v47, s41
    v_bitop3_b32 v58, v4, v12, v58 bitop3:0xca
    v_perm_b32 v13, v47, v47, s42
    v_bitop3_b32 v59, v4, v13, v59 bitop3:0xca
    v_lshrrev_b32 v8, 2, v0
    v_and_b32 v7, 0x3c00, v0
    v_bitop3_b32 v7, v5, v8, v7 bitop3:0xea
    s_waitcnt lgkmcnt(0)
    s_barrier
    ds_read2st64_b32 v[8:9], v7 offset0:0 offset1:1
    ds_read2st64_b32 v[10:11], v7 offset0:2 offset1:3
    s_add_u32 s47, s35, 0x10000
    buffer_store_dwordx4 v[64:67], v0, s[20:23], s47 offen sc1
    s_add_u32 s44, s34, 0x2000000
    s_nop 0
    buffer_load_dwordx2 v[64:65], v1, s[16:19], s44 offen nt
    s_add_u32 s45, s34, 0x2200000
    buffer_load_dwordx2 v[66:67], v1, s[16:19], s45 offen nt
    s_waitcnt lgkmcnt(0)
    v_lshl_or_b32 v12, v9, 16, v8
    v_lshl_or_b32 v13, v11, 16, v10
    v_mov_b32 v14, v12
    v_mov_b32 v15, v13
    s_nop 0
    v_add_u32_dpp v14, v14, v14 row_shr:1 row_mask:0xf bank_mask:0xf bound_ctrl:1
    v_add_u32_dpp v15, v15, v15 row_shr:1 row_mask:0xf bank_mask:0xf bound_ctrl:1
    s_nop 0
    v_add_u32_dpp v14, v14, v14 row_shr:2 row_mask:0xf bank_mask:0xf bound_ctrl:1
    v_add_u32_dpp v15, v15, v15 row_shr:2 row_mask:0xf bank_mask:0xf bound_ctrl:1
    s_nop 0
    v_add_u32_dpp v14, v14, v14 row_shr:4 row_mask:0xf bank_mask:0xf bound_ctrl:1
    v_add_u32_dpp v15, v15, v15 row_shr:4 row_mask:0xf bank_mask:0xf bound_ctrl:1
    s_nop 0
    v_add_u32_dpp v14, v14, v14 row_shr:8 row_mask:0xf bank_mask:0xf bound_ctrl:1
    v_add_u32_dpp v15, v15, v15 row_shr:8 row_mask:0xf bank_mask:0xf bound_ctrl:1
    s_nop 0
    v_add_u32_dpp v14, v14, v14 row_bcast:15 row_mask:0xa bank_mask:0xf
    v_add_u32_dpp v15, v15, v15 row_bcast:15 row_mask:0xa bank_mask:0xf
    s_nop 0
    v_add_u32_dpp v14, v14, v14 row_bcast:31 row_mask:0xc bank_mask:0xf
    v_add_u32_dpp v15, v15, v15 row_bcast:31 row_mask:0xc bank_mask:0xf
    v_readlane_b32 s48, v14, 63
    v_readlane_b32 s49, v15, 63
    s_lshl_b32 s54, s32, 2
    v_mov_b32 v8, s54
    s_and_b32 s50, s48, 0xffff
    s_lshr_b32 s51, s48, 16
    s_and_b32 s52, s49, 0xffff
    s_lshr_b32 s53, s49, 16
    s_add_u32 s51, s51, s50
    s_add_u32 s52, s52, s51
    s_add_u32 s53, s53, s52
    v_mov_b32 v9, s53
    s_mov_b64 exec, 1
    ds_write_b32 v8, v9 offset:16384
    s_mov_b64 exec, -1
    v_and_b32 v8, 60, v7
    s_waitcnt lgkmcnt(0)
    s_barrier
    ds_read_b32 v9, v8 offset:16384
    s_waitcnt lgkmcnt(0)
    v_add_u32_dpp v9, v9, v9 row_shr:1 row_mask:0xf bank_mask:0xf bound_ctrl:1
    s_nop 1
    v_add_u32_dpp v9, v9, v9 row_shr:2 row_mask:0xf bank_mask:0xf bound_ctrl:1
    s_nop 1
    v_add_u32_dpp v9, v9, v9 row_shr:4 row_mask:0xf bank_mask:0xf bound_ctrl:1
    s_nop 1
    v_add_u32_dpp v9, v9, v9 row_shr:8 row_mask:0xf bank_mask:0xf bound_ctrl:1
    s_nop 0
    v_readlane_b32 s54, v9, s32
    s_sub_u32 s54, s54, s53
    s_add_u32 s50, s50, s54
    s_add_u32 s51, s51, s54
    s_add_u32 s52, s52, s54
    s_pack_ll_b32_b16 s48, s54, s50
    s_pack_ll_b32_b16 s49, s51, s52
    v_add_u32 v14, s48, v14
    v_add_u32 v15, s49, v15
    v_sub_u32 v12, v14, v12
    v_sub_u32 v13, v15, v13
    v_and_b32 v8, 0xffff, v12
    v_lshrrev_b32 v9, 16, v12
    v_and_b32 v10, 0xffff, v13
    v_lshrrev_b32 v11, 16, v13
    ds_write2st64_b32 v7, v8, v9 offset0:0 offset1:1
    ds_write2st64_b32 v7, v10, v11 offset0:2 offset1:3
    s_waitcnt lgkmcnt(0)
    s_barrier
    ds_add_rtn_u32 v100, v100, v2
    ds_add_rtn_u32 v101, v101, v2
    ds_add_rtn_u32 v102, v102, v2
    ds_add_rtn_u32 v103, v103, v2
    s_add_u32 s46, s36, 0x2a40000
    v_and_b32 v11, 0x3f0, v0
    v_add_u32 v11, v11, v11
    buffer_store_dwordx2 v[12:13], v11, s[24:27], s46 offen
    s_bitset0_b64 exec, 63
    s_not_b64 exec, exec
    buffer_store_dwordx2 v[14:15], v11, s[24:27], s46 offen offset:32
    s_mov_b64 exec, -1
    ds_add_rtn_u32 v112, v112, v2
    ds_add_rtn_u32 v113, v113, v2
    ds_add_rtn_u32 v114, v114, v2
    ds_add_rtn_u32 v115, v115, v2
    ds_add_rtn_u32 v120, v120, v2
    ds_add_rtn_u32 v121, v121, v2
    ds_add_rtn_u32 v122, v122, v2
    ds_add_rtn_u32 v123, v123, v2
    s_add_u32 s47, s35, 0x14000
    buffer_store_dwordx4 v[76:79], v0, s[20:23], s47 offen sc1
    s_add_u32 s44, s33, 0x4400000
    s_nop 0
    buffer_load_dwordx4 v[76:79], v0, s[8:11], s44 offen nt
    ds_add_rtn_u32 v20, v20, v2
    ds_add_rtn_u32 v21, v21, v2
    ds_add_rtn_u32 v22, v22, v2
    ds_add_rtn_u32 v23, v23, v2
    ds_add_rtn_u32 v32, v32, v2
    ds_add_rtn_u32 v33, v33, v2
    ds_add_rtn_u32 v34, v34, v2
    ds_add_rtn_u32 v35, v35, v2
    ds_add_rtn_u32 v40, v40, v2
    ds_add_rtn_u32 v41, v41, v2
    ds_add_rtn_u32 v42, v42, v2
    ds_add_rtn_u32 v43, v43, v2
    s_add_u32 s45, s35, 0x18000
    buffer_store_dwordx4 v[80:83], v0, s[20:23], s45 offen sc1
    s_add_u32 s46, s33, 0x4400000
    s_nop 0
    buffer_load_dwordx4 v[80:83], v0, s[12:15], s46 offen nt
    ds_add_rtn_u32 v52, v52, v2
    ds_add_rtn_u32 v53, v53, v2
    ds_add_rtn_u32 v54, v54, v2
    ds_add_rtn_u32 v55, v55, v2
    ds_add_rtn_u32 v60, v60, v2
    ds_add_rtn_u32 v61, v61, v2
    ds_add_rtn_u32 v62, v62, v2
    ds_add_rtn_u32 v63, v63, v2
    s_waitcnt lgkmcnt(0)
    s_barrier
    v_and_b32 v7, -4, v100
    v_lshl_add_u32 v8, v100, 2, v7
    ds_write_b32 v8, v96
    v_lshl_add_u32 v7, v7, 2, v100
    ds_write_b8 v7, v104 offset:16
    v_and_b32 v9, -4, v101
    v_lshl_add_u32 v10, v101, 2, v9
    ds_write_b32 v10, v97
    v_lshl_add_u32 v9, v9, 2, v101
    ds_write_b8_d16_hi v9, v104 offset:16
    v_and_b32 v7, -4, v102
    v_lshl_add_u32 v8, v102, 2, v7
    ds_write_b32 v8, v98
    v_lshl_add_u32 v7, v7, 2, v102
    ds_write_b8 v7, v105 offset:16
    v_and_b32 v9, -4, v103
    v_lshl_add_u32 v10, v103, 2, v9
    ds_write_b32 v10, v99
    v_lshl_add_u32 v9, v9, 2, v103
    ds_write_b8_d16_hi v9, v105 offset:16
    s_add_u32 s47, s35, 0x1c000
    buffer_store_dwordx4 v[88:91], v0, s[20:23], s47 offen sc1
    s_add_u32 s44, s33, 0x4800000
    buffer_load_dwordx4 v[96:99], v0, s[8:11], s44 offen nt
    s_add_u32 s45, s33, 0x4800000
    buffer_load_dwordx4 v[100:103], v0, s[12:15], s45 offen nt
    v_and_b32 v7, -4, v112
    v_lshl_add_u32 v8, v112, 2, v7
    ds_write_b32 v8, v108
    v_lshl_add_u32 v7, v7, 2, v112
    ds_write_b8 v7, v106 offset:16
    v_and_b32 v9, -4, v113
    v_lshl_add_u32 v10, v113, 2, v9
    ds_write_b32 v10, v109
    v_lshl_add_u32 v9, v9, 2, v113
    ds_write_b8_d16_hi v9, v106 offset:16
    v_and_b32 v7, -4, v114
    v_lshl_add_u32 v8, v114, 2, v7
    ds_write_b32 v8, v110
    v_lshl_add_u32 v7, v7, 2, v114
    ds_write_b8 v7, v107 offset:16
    v_and_b32 v9, -4, v115
    v_lshl_add_u32 v10, v115, 2, v9
    ds_write_b32 v10, v111
    v_lshl_add_u32 v9, v9, 2, v115
    ds_write_b8_d16_hi v9, v107 offset:16
    s_add_u32 s46, s34, 0x2400000
    buffer_load_dwordx2 v[88:89], v1, s[16:19], s46 offen nt
    s_add_u32 s47, s34, 0x2600000
    buffer_load_dwordx2 v[90:91], v1, s[16:19], s47 offen nt
    s_add_u32 s44, s33, 0x4c00000
    buffer_load_dwordx4 v[108:111], v0, s[8:11], s44 offen nt
    v_and_b32 v7, -4, v120
    v_lshl_add_u32 v8, v120, 2, v7
    ds_write_b32 v8, v116
    v_lshl_add_u32 v7, v7, 2, v120
    ds_write_b8 v7, v124 offset:16
    v_and_b32 v9, -4, v121
    v_lshl_add_u32 v10, v121, 2, v9
    ds_write_b32 v10, v117
    v_lshl_add_u32 v9, v9, 2, v121
    ds_write_b8_d16_hi v9, v124 offset:16
    v_and_b32 v7, -4, v122
    v_lshl_add_u32 v8, v122, 2, v7
    ds_write_b32 v8, v118
    v_lshl_add_u32 v7, v7, 2, v122
    ds_write_b8 v7, v125 offset:16
    v_and_b32 v9, -4, v123
    v_lshl_add_u32 v10, v123, 2, v9
    ds_write_b32 v10, v119
    v_lshl_add_u32 v9, v9, 2, v123
    ds_write_b8_d16_hi v9, v125 offset:16
    s_add_u32 s45, s35, 0x20000
    buffer_store_dwordx4 v[92:95], v0, s[20:23], s45 offen sc1
    s_add_u32 s46, s33, 0x4c00000
    buffer_load_dwordx4 v[112:115], v0, s[12:15], s46 offen nt
    v_and_b32 v7, -4, v20
    v_lshl_add_u32 v8, v20, 2, v7
    ds_write_b32 v8, v16
    v_lshl_add_u32 v7, v7, 2, v20
    ds_write_b8 v7, v126 offset:16
    v_and_b32 v9, -4, v21
    v_lshl_add_u32 v10, v21, 2, v9
    ds_write_b32 v10, v17
    v_lshl_add_u32 v9, v9, 2, v21
    ds_write_b8_d16_hi v9, v126 offset:16
    v_and_b32 v7, -4, v22
    v_lshl_add_u32 v8, v22, 2, v7
    ds_write_b32 v8, v18
    v_lshl_add_u32 v7, v7, 2, v22
    ds_write_b8 v7, v127 offset:16
    v_and_b32 v9, -4, v23
    v_lshl_add_u32 v10, v23, 2, v9
    ds_write_b32 v10, v19
    v_lshl_add_u32 v9, v9, 2, v23
    ds_write_b8_d16_hi v9, v127 offset:16
    s_add_u32 s47, s33, 0x5000000
    buffer_load_dwordx4 v[104:107], v0, s[8:11], s47 offen nt
    s_add_u32 s44, s33, 0x5000000
    buffer_load_dwordx4 v[116:119], v0, s[12:15], s44 offen nt
    v_and_b32 v7, -4, v32
    v_lshl_add_u32 v8, v32, 2, v7
    ds_write_b32 v8, v28
    v_lshl_add_u32 v7, v7, 2, v32
    ds_write_b8 v7, v24 offset:16
    v_and_b32 v9, -4, v33
    v_lshl_add_u32 v10, v33, 2, v9
    ds_write_b32 v10, v29
    v_lshl_add_u32 v9, v9, 2, v33
    ds_write_b8_d16_hi v9, v24 offset:16
    v_and_b32 v7, -4, v34
    v_lshl_add_u32 v8, v34, 2, v7
    ds_write_b32 v8, v30
    v_lshl_add_u32 v7, v7, 2, v34
    ds_write_b8 v7, v25 offset:16
    v_and_b32 v9, -4, v35
    v_lshl_add_u32 v10, v35, 2, v9
    ds_write_b32 v10, v31
    v_lshl_add_u32 v9, v9, 2, v35
    ds_write_b8_d16_hi v9, v25 offset:16
    s_add_u32 s45, s34, 0x2800000
    buffer_load_dwordx2 v[120:121], v1, s[16:19], s45 offen nt
    s_add_u32 s46, s34, 0x2a00000
    buffer_load_dwordx2 v[122:123], v1, s[16:19], s46 offen nt
    s_add_u32 s47, s33, 0x5400000
    buffer_load_dwordx4 v[92:95], v0, s[8:11], s47 offen nt
    v_and_b32 v7, -4, v40
    v_lshl_add_u32 v8, v40, 2, v7
    ds_write_b32 v8, v36
    v_lshl_add_u32 v7, v7, 2, v40
    ds_write_b8 v7, v26 offset:16
    v_and_b32 v9, -4, v41
    v_lshl_add_u32 v10, v41, 2, v9
    ds_write_b32 v10, v37
    v_lshl_add_u32 v9, v9, 2, v41
    ds_write_b8_d16_hi v9, v26 offset:16
    v_and_b32 v7, -4, v42
    v_lshl_add_u32 v8, v42, 2, v7
    ds_write_b32 v8, v38
    v_lshl_add_u32 v7, v7, 2, v42
    ds_write_b8 v7, v27 offset:16
    v_and_b32 v9, -4, v43
    v_lshl_add_u32 v10, v43, 2, v9
    ds_write_b32 v10, v39
    v_lshl_add_u32 v9, v9, 2, v43
    ds_write_b8_d16_hi v9, v27 offset:16
    s_add_u32 s44, s35, 0x24000
    buffer_store_dwordx4 v[84:87], v0, s[20:23], s44 offen sc1
    s_add_u32 s45, s33, 0x5400000
    buffer_load_dwordx4 v[16:19], v0, s[12:15], s45 offen nt
    v_and_b32 v7, -4, v52
    v_lshl_add_u32 v8, v52, 2, v7
    ds_write_b32 v8, v48
    v_lshl_add_u32 v7, v7, 2, v52
    ds_write_b8 v7, v44 offset:16
    v_and_b32 v9, -4, v53
    v_lshl_add_u32 v10, v53, 2, v9
    ds_write_b32 v10, v49
    v_lshl_add_u32 v9, v9, 2, v53
    ds_write_b8_d16_hi v9, v44 offset:16
    v_and_b32 v7, -4, v54
    v_lshl_add_u32 v8, v54, 2, v7
    ds_write_b32 v8, v50
    v_lshl_add_u32 v7, v7, 2, v54
    ds_write_b8 v7, v45 offset:16
    v_and_b32 v9, -4, v55
    v_lshl_add_u32 v10, v55, 2, v9
    ds_write_b32 v10, v51
    v_lshl_add_u32 v9, v9, 2, v55
    ds_write_b8_d16_hi v9, v45 offset:16
    s_add_u32 s46, s33, 0x5800000
    buffer_load_dwordx4 v[20:23], v0, s[8:11], s46 offen nt
    s_add_u32 s47, s33, 0x5800000
    buffer_load_dwordx4 v[124:127], v0, s[12:15], s47 offen nt
    v_and_b32 v7, -4, v60
    v_lshl_add_u32 v8, v60, 2, v7
    ds_write_b32 v8, v56
    v_lshl_add_u32 v7, v7, 2, v60
    ds_write_b8 v7, v46 offset:16
    v_and_b32 v9, -4, v61
    v_lshl_add_u32 v10, v61, 2, v9
    ds_write_b32 v10, v57
    v_lshl_add_u32 v9, v9, 2, v61
    ds_write_b8_d16_hi v9, v46 offset:16
    v_and_b32 v7, -4, v62
    v_lshl_add_u32 v8, v62, 2, v7
    ds_write_b32 v8, v58
    v_lshl_add_u32 v7, v7, 2, v62
    ds_write_b8 v7, v47 offset:16
    v_and_b32 v9, -4, v63
    v_lshl_add_u32 v10, v63, 2, v9
    ds_write_b32 v10, v59
    v_lshl_add_u32 v9, v9, 2, v63
    ds_write_b8_d16_hi v9, v47 offset:16
    s_add_u32 s44, s34, 0x2c00000
    buffer_load_dwordx2 v[28:29], v1, s[16:19], s44 offen nt
    s_add_u32 s45, s34, 0x2e00000
    buffer_load_dwordx2 v[30:31], v1, s[16:19], s45 offen nt
    v_add_u32 v7, 0x10000, v0
    v_add_u32 v12, 0x20000, v0
    v_mov_b32 v8, 0
    v_mov_b32 v9, 0
    v_mov_b32 v10, 0
    v_mov_b32 v11, 0
    s_waitcnt lgkmcnt(0)
    s_barrier
    ds_read_b128 v[32:35], v0 offset:0
    ds_write_b128 v0, v[8:11]
    ds_read_b128 v[36:39], v0 offset:16384
    ds_read_b128 v[40:43], v0 offset:32768
    ds_read_b128 v[24:27], v0 offset:49152
    ds_read_b128 v[84:87], v7 offset:0
    ds_read_b128 v[48:51], v7 offset:16384
    ds_read_b128 v[52:55], v7 offset:32768
    ds_read_b128 v[56:59], v7 offset:49152
    ds_read_b128 v[60:63], v12 offset:0
    ds_read_b128 v[44:47], v12 offset:16384
    s_waitcnt lgkmcnt(0)
    s_barrier
    s_add_u32 s46, s35, 0x2a40000
    buffer_store_dwordx4 v[32:35], v0, s[20:23], s46 offen sc1
    s_add_u32 s47, s33, 0x5c00000
    s_nop 0
    buffer_load_dwordx4 v[32:35], v0, s[8:11], s47 offen nt
    s_add_u32 s44, s35, 0x2a44000
    buffer_store_dwordx4 v[36:39], v0, s[20:23], s44 offen sc1
    s_add_u32 s45, s33, 0x5c00000
    s_nop 0
    buffer_load_dwordx4 v[36:39], v0, s[12:15], s45 offen nt
    s_waitcnt vmcnt(29)
    v_lshlrev_b32 v7, 16, v64
    v_and_b32 v8, 0xffff0000, v64
    v_lshlrev_b32 v9, 16, v65
    v_and_b32 v10, 0xffff0000, v65
    v_mul_f32 v7, 0.15915494, v7
    v_mul_f32 v8, 0.15915494, v8
    v_mul_f32 v9, 0.15915494, v9
    v_mul_f32 v10, 0.15915494, v10
    v_mul_hi_u32_u24 v14, 429497, v68
    v_lshrrev_b32 v12, 3, v72
    v_cos_f32 v7, v7
    v_lshlrev_b16 v13, 3, v72
    v_mad_i32_i24 v11, v14, s55, v68
    v_bitop3_b32 v12, v6, v13, v12 bitop3:0xca
    v_add_lshl_u32 v11, v11, s40, 17
    v_lshlrev_b16 v14, 8, v14
    v_lshrrev_b32 v13, 2, v72
    v_or_b32 v68, v12, v11
    v_bitop3_b32 v72, v5, v13, v14 bitop3:0xea
    ds_add_u32 v72, v2
    v_mul_hi_u32_u24 v14, 429497, v69
    v_lshrrev_b32 v12, 3, v73
    v_cos_f32 v8, v8
    v_lshlrev_b16 v13, 3, v73
    v_mad_i32_i24 v11, v14, s55, v69
    v_bitop3_b32 v12, v6, v13, v12 bitop3:0xca
    v_add_lshl_u32 v11, v11, s40, 17
    v_lshlrev_b16 v14, 8, v14
    v_lshrrev_b32 v13, 2, v73
    v_or_b32 v69, v12, v11
    v_bitop3_b32 v73, v5, v13, v14 bitop3:0xea
    ds_add_u32 v73, v2
    v_cvt_pk_bf16_f32 v64, v7, v8
    v_perm_b32 v12, v64, v64, s41
    v_bitop3_b32 v68, v4, v12, v68 bitop3:0xca
    v_perm_b32 v13, v64, v64, s42
    v_bitop3_b32 v69, v4, v13, v69 bitop3:0xca
    v_mul_hi_u32_u24 v14, 429497, v70
    v_lshrrev_b32 v12, 3, v74
    v_cos_f32 v9, v9
    v_lshlrev_b16 v13, 3, v74
    v_mad_i32_i24 v11, v14, s55, v70
    v_bitop3_b32 v12, v6, v13, v12 bitop3:0xca
    v_add_lshl_u32 v11, v11, s40, 17
    v_lshlrev_b16 v14, 8, v14
    v_lshrrev_b32 v13, 2, v74
    v_or_b32 v70, v12, v11
    v_bitop3_b32 v74, v5, v13, v14 bitop3:0xea
    ds_add_u32 v74, v2
    v_mul_hi_u32_u24 v14, 429497, v71
    v_lshrrev_b32 v12, 3, v75
    v_cos_f32 v10, v10
    v_lshlrev_b16 v13, 3, v75
    v_mad_i32_i24 v11, v14, s55, v71
    v_bitop3_b32 v12, v6, v13, v12 bitop3:0xca
    v_add_lshl_u32 v11, v11, s40, 17
    v_lshlrev_b16 v14, 8, v14
    v_lshrrev_b32 v13, 2, v75
    v_or_b32 v71, v12, v11
    v_bitop3_b32 v75, v5, v13, v14 bitop3:0xea
    ds_add_u32 v75, v2
    v_cvt_pk_bf16_f32 v65, v9, v10
    v_perm_b32 v12, v65, v65, s41
    v_bitop3_b32 v70, v4, v12, v70 bitop3:0xca
    v_perm_b32 v13, v65, v65, s42
    v_bitop3_b32 v71, v4, v13, v71 bitop3:0xca
    s_waitcnt vmcnt(23)
    v_lshlrev_b32 v7, 16, v66
    v_and_b32 v8, 0xffff0000, v66
    v_lshlrev_b32 v9, 16, v67
    v_and_b32 v10, 0xffff0000, v67
    v_mul_f32 v7, 0.15915494, v7
    v_mul_f32 v8, 0.15915494, v8
    v_mul_f32 v9, 0.15915494, v9
    v_mul_f32 v10, 0.15915494, v10
    v_mul_hi_u32_u24 v14, 429497, v76
    v_lshrrev_b32 v12, 3, v80
    v_cos_f32 v7, v7
    v_lshlrev_b16 v13, 3, v80
    v_mad_i32_i24 v11, v14, s55, v76
    v_bitop3_b32 v12, v6, v13, v12 bitop3:0xca
    v_add_lshl_u32 v11, v11, s40, 17
    v_lshlrev_b16 v14, 8, v14
    v_lshrrev_b32 v13, 2, v80
    v_or_b32 v76, v12, v11
    v_bitop3_b32 v80, v5, v13, v14 bitop3:0xea
    ds_add_u32 v80, v2
    v_mul_hi_u32_u24 v14, 429497, v77
    v_lshrrev_b32 v12, 3, v81
    v_cos_f32 v8, v8
    v_lshlrev_b16 v13, 3, v81
    v_mad_i32_i24 v11, v14, s55, v77
    v_bitop3_b32 v12, v6, v13, v12 bitop3:0xca
    v_add_lshl_u32 v11, v11, s40, 17
    v_lshlrev_b16 v14, 8, v14
    v_lshrrev_b32 v13, 2, v81
    v_or_b32 v77, v12, v11
    v_bitop3_b32 v81, v5, v13, v14 bitop3:0xea
    ds_add_u32 v81, v2
    v_cvt_pk_bf16_f32 v66, v7, v8
    v_perm_b32 v12, v66, v66, s41
    v_bitop3_b32 v76, v4, v12, v76 bitop3:0xca
    v_perm_b32 v13, v66, v66, s42
    v_bitop3_b32 v77, v4, v13, v77 bitop3:0xca
    v_mul_hi_u32_u24 v14, 429497, v78
    v_lshrrev_b32 v12, 3, v82
    v_cos_f32 v9, v9
    v_lshlrev_b16 v13, 3, v82
    v_mad_i32_i24 v11, v14, s55, v78
    v_bitop3_b32 v12, v6, v13, v12 bitop3:0xca
    v_add_lshl_u32 v11, v11, s40, 17
    v_lshlrev_b16 v14, 8, v14
    v_lshrrev_b32 v13, 2, v82
    v_or_b32 v78, v12, v11
    v_bitop3_b32 v82, v5, v13, v14 bitop3:0xea
    ds_add_u32 v82, v2
    v_mul_hi_u32_u24 v14, 429497, v79
    v_lshrrev_b32 v12, 3, v83
    v_cos_f32 v10, v10
    v_lshlrev_b16 v13, 3, v83
    v_mad_i32_i24 v11, v14, s55, v79
    v_bitop3_b32 v12, v6, v13, v12 bitop3:0xca
    v_add_lshl_u32 v11, v11, s40, 17
    v_lshlrev_b16 v14, 8, v14
    v_lshrrev_b32 v13, 2, v83
    v_or_b32 v79, v12, v11
    v_bitop3_b32 v83, v5, v13, v14 bitop3:0xea
    ds_add_u32 v83, v2
    v_cvt_pk_bf16_f32 v67, v9, v10
    v_perm_b32 v12, v67, v67, s41
    v_bitop3_b32 v78, v4, v12, v78 bitop3:0xca
    v_perm_b32 v13, v67, v67, s42
    v_bitop3_b32 v79, v4, v13, v79 bitop3:0xca
    s_waitcnt vmcnt(18)
    v_lshlrev_b32 v7, 16, v88
    v_and_b32 v8, 0xffff0000, v88
    v_lshlrev_b32 v9, 16, v89
    v_and_b32 v10, 0xffff0000, v89
    v_mul_f32 v7, 0.15915494, v7
    v_mul_f32 v8, 0.15915494, v8
    v_mul_f32 v9, 0.15915494, v9
    v_mul_f32 v10, 0.15915494, v10
    v_mul_hi_u32_u24 v14, 429497, v96
    v_lshrrev_b32 v12, 3, v100
    v_cos_f32 v7, v7
    v_lshlrev_b16 v13, 3, v100
    v_mad_i32_i24 v11, v14, s55, v96
    v_bitop3_b32 v12, v6, v13, v12 bitop3:0xca
    v_add_lshl_u32 v11, v11, s40, 17
    v_lshlrev_b16 v14, 8, v14
    v_lshrrev_b32 v13, 2, v100
    v_or_b32 v96, v12, v11
    v_bitop3_b32 v100, v5, v13, v14 bitop3:0xea
    ds_add_u32 v100, v2
    v_mul_hi_u32_u24 v14, 429497, v97
    v_lshrrev_b32 v12, 3, v101
    v_cos_f32 v8, v8
    v_lshlrev_b16 v13, 3, v101
    v_mad_i32_i24 v11, v14, s55, v97
    v_bitop3_b32 v12, v6, v13, v12 bitop3:0xca
    v_add_lshl_u32 v11, v11, s40, 17
    v_lshlrev_b16 v14, 8, v14
    v_lshrrev_b32 v13, 2, v101
    v_or_b32 v97, v12, v11
    v_bitop3_b32 v101, v5, v13, v14 bitop3:0xea
    ds_add_u32 v101, v2
    v_cvt_pk_bf16_f32 v88, v7, v8
    v_perm_b32 v12, v88, v88, s41
    v_bitop3_b32 v96, v4, v12, v96 bitop3:0xca
    v_perm_b32 v13, v88, v88, s42
    v_bitop3_b32 v97, v4, v13, v97 bitop3:0xca
    v_mul_hi_u32_u24 v14, 429497, v98
    v_lshrrev_b32 v12, 3, v102
    v_cos_f32 v9, v9
    v_lshlrev_b16 v13, 3, v102
    v_mad_i32_i24 v11, v14, s55, v98
    v_bitop3_b32 v12, v6, v13, v12 bitop3:0xca
    v_add_lshl_u32 v11, v11, s40, 17
    v_lshlrev_b16 v14, 8, v14
    v_lshrrev_b32 v13, 2, v102
    v_or_b32 v98, v12, v11
    v_bitop3_b32 v102, v5, v13, v14 bitop3:0xea
    ds_add_u32 v102, v2
    v_mul_hi_u32_u24 v14, 429497, v99
    v_lshrrev_b32 v12, 3, v103
    v_cos_f32 v10, v10
    v_lshlrev_b16 v13, 3, v103
    v_mad_i32_i24 v11, v14, s55, v99
    v_bitop3_b32 v12, v6, v13, v12 bitop3:0xca
    v_add_lshl_u32 v11, v11, s40, 17
    v_lshlrev_b16 v14, 8, v14
    v_lshrrev_b32 v13, 2, v103
    v_or_b32 v99, v12, v11
    v_bitop3_b32 v103, v5, v13, v14 bitop3:0xea
    ds_add_u32 v103, v2
    v_cvt_pk_bf16_f32 v89, v9, v10
    v_perm_b32 v12, v89, v89, s41
    v_bitop3_b32 v98, v4, v12, v98 bitop3:0xca
    v_perm_b32 v13, v89, v89, s42
    v_bitop3_b32 v99, v4, v13, v99 bitop3:0xca
    s_add_u32 s46, s35, 0x2a48000
    buffer_store_dwordx4 v[40:43], v0, s[20:23], s46 offen sc1
    s_add_u32 s47, s33, 0x6000000
    s_nop 0
    buffer_load_dwordx4 v[40:43], v0, s[8:11], s47 offen nt
    s_waitcnt vmcnt(17)
    v_lshlrev_b32 v7, 16, v90
    v_and_b32 v8, 0xffff0000, v90
    v_lshlrev_b32 v9, 16, v91
    v_and_b32 v10, 0xffff0000, v91
    v_mul_f32 v7, 0.15915494, v7
    v_mul_f32 v8, 0.15915494, v8
    v_mul_f32 v9, 0.15915494, v9
    v_mul_f32 v10, 0.15915494, v10
    v_mul_hi_u32_u24 v14, 429497, v108
    v_lshrrev_b32 v12, 3, v112
    v_cos_f32 v7, v7
    v_lshlrev_b16 v13, 3, v112
    v_mad_i32_i24 v11, v14, s55, v108
    v_bitop3_b32 v12, v6, v13, v12 bitop3:0xca
    v_add_lshl_u32 v11, v11, s40, 17
    v_lshlrev_b16 v14, 8, v14
    v_lshrrev_b32 v13, 2, v112
    v_or_b32 v108, v12, v11
    v_bitop3_b32 v112, v5, v13, v14 bitop3:0xea
    ds_add_u32 v112, v2
    v_mul_hi_u32_u24 v14, 429497, v109
    v_lshrrev_b32 v12, 3, v113
    v_cos_f32 v8, v8
    v_lshlrev_b16 v13, 3, v113
    v_mad_i32_i24 v11, v14, s55, v109
    v_bitop3_b32 v12, v6, v13, v12 bitop3:0xca
    v_add_lshl_u32 v11, v11, s40, 17
    v_lshlrev_b16 v14, 8, v14
    v_lshrrev_b32 v13, 2, v113
    v_or_b32 v109, v12, v11
    v_bitop3_b32 v113, v5, v13, v14 bitop3:0xea
    ds_add_u32 v113, v2
    v_cvt_pk_bf16_f32 v90, v7, v8
    v_perm_b32 v12, v90, v90, s41
    v_bitop3_b32 v108, v4, v12, v108 bitop3:0xca
    v_perm_b32 v13, v90, v90, s42
    v_bitop3_b32 v109, v4, v13, v109 bitop3:0xca
    v_mul_hi_u32_u24 v14, 429497, v110
    v_lshrrev_b32 v12, 3, v114
    v_cos_f32 v9, v9
    v_lshlrev_b16 v13, 3, v114
    v_mad_i32_i24 v11, v14, s55, v110
    v_bitop3_b32 v12, v6, v13, v12 bitop3:0xca
    v_add_lshl_u32 v11, v11, s40, 17
    v_lshlrev_b16 v14, 8, v14
    v_lshrrev_b32 v13, 2, v114
    v_or_b32 v110, v12, v11
    v_bitop3_b32 v114, v5, v13, v14 bitop3:0xea
    ds_add_u32 v114, v2
    v_mul_hi_u32_u24 v14, 429497, v111
    v_lshrrev_b32 v12, 3, v115
    v_cos_f32 v10, v10
    v_lshlrev_b16 v13, 3, v115
    v_mad_i32_i24 v11, v14, s55, v111
    v_bitop3_b32 v12, v6, v13, v12 bitop3:0xca
    v_add_lshl_u32 v11, v11, s40, 17
    v_lshlrev_b16 v14, 8, v14
    v_lshrrev_b32 v13, 2, v115
    v_or_b32 v111, v12, v11
    v_bitop3_b32 v115, v5, v13, v14 bitop3:0xea
    ds_add_u32 v115, v2
    v_cvt_pk_bf16_f32 v91, v9, v10
    v_perm_b32 v12, v91, v91, s41
    v_bitop3_b32 v110, v4, v12, v110 bitop3:0xca
    v_perm_b32 v13, v91, v91, s42
    v_bitop3_b32 v111, v4, v13, v111 bitop3:0xca
    s_waitcnt vmcnt(13)
    v_lshlrev_b32 v7, 16, v120
    v_and_b32 v8, 0xffff0000, v120
    v_lshlrev_b32 v9, 16, v121
    v_and_b32 v10, 0xffff0000, v121
    v_mul_f32 v7, 0.15915494, v7
    v_mul_f32 v8, 0.15915494, v8
    v_mul_f32 v9, 0.15915494, v9
    v_mul_f32 v10, 0.15915494, v10
    v_mul_hi_u32_u24 v14, 429497, v104
    v_lshrrev_b32 v12, 3, v116
    v_cos_f32 v7, v7
    v_lshlrev_b16 v13, 3, v116
    v_mad_i32_i24 v11, v14, s55, v104
    v_bitop3_b32 v12, v6, v13, v12 bitop3:0xca
    v_add_lshl_u32 v11, v11, s40, 17
    v_lshlrev_b16 v14, 8, v14
    v_lshrrev_b32 v13, 2, v116
    v_or_b32 v104, v12, v11
    v_bitop3_b32 v116, v5, v13, v14 bitop3:0xea
    ds_add_u32 v116, v2
    v_mul_hi_u32_u24 v14, 429497, v105
    v_lshrrev_b32 v12, 3, v117
    v_cos_f32 v8, v8
    v_lshlrev_b16 v13, 3, v117
    v_mad_i32_i24 v11, v14, s55, v105
    v_bitop3_b32 v12, v6, v13, v12 bitop3:0xca
    v_add_lshl_u32 v11, v11, s40, 17
    v_lshlrev_b16 v14, 8, v14
    v_lshrrev_b32 v13, 2, v117
    v_or_b32 v105, v12, v11
    v_bitop3_b32 v117, v5, v13, v14 bitop3:0xea
    ds_add_u32 v117, v2
    v_cvt_pk_bf16_f32 v120, v7, v8
    v_perm_b32 v12, v120, v120, s41
    v_bitop3_b32 v104, v4, v12, v104 bitop3:0xca
    v_perm_b32 v13, v120, v120, s42
    v_bitop3_b32 v105, v4, v13, v105 bitop3:0xca
    v_mul_hi_u32_u24 v14, 429497, v106
    v_lshrrev_b32 v12, 3, v118
    v_cos_f32 v9, v9
    v_lshlrev_b16 v13, 3, v118
    v_mad_i32_i24 v11, v14, s55, v106
    v_bitop3_b32 v12, v6, v13, v12 bitop3:0xca
    v_add_lshl_u32 v11, v11, s40, 17
    v_lshlrev_b16 v14, 8, v14
    v_lshrrev_b32 v13, 2, v118
    v_or_b32 v106, v12, v11
    v_bitop3_b32 v118, v5, v13, v14 bitop3:0xea
    ds_add_u32 v118, v2
    v_mul_hi_u32_u24 v14, 429497, v107
    v_lshrrev_b32 v12, 3, v119
    v_cos_f32 v10, v10
    v_lshlrev_b16 v13, 3, v119
    v_mad_i32_i24 v11, v14, s55, v107
    v_bitop3_b32 v12, v6, v13, v12 bitop3:0xca
    v_add_lshl_u32 v11, v11, s40, 17
    v_lshlrev_b16 v14, 8, v14
    v_lshrrev_b32 v13, 2, v119
    v_or_b32 v107, v12, v11
    v_bitop3_b32 v119, v5, v13, v14 bitop3:0xea
    ds_add_u32 v119, v2
    v_cvt_pk_bf16_f32 v121, v9, v10
    v_perm_b32 v12, v121, v121, s41
    v_bitop3_b32 v106, v4, v12, v106 bitop3:0xca
    v_perm_b32 v13, v121, v121, s42
    v_bitop3_b32 v107, v4, v13, v107 bitop3:0xca
    s_waitcnt vmcnt(10)
    v_lshlrev_b32 v7, 16, v122
    v_and_b32 v8, 0xffff0000, v122
    v_lshlrev_b32 v9, 16, v123
    v_and_b32 v10, 0xffff0000, v123
    v_mul_f32 v7, 0.15915494, v7
    v_mul_f32 v8, 0.15915494, v8
    v_mul_f32 v9, 0.15915494, v9
    v_mul_f32 v10, 0.15915494, v10
    v_mul_hi_u32_u24 v14, 429497, v92
    v_lshrrev_b32 v12, 3, v16
    v_cos_f32 v7, v7
    v_lshlrev_b16 v13, 3, v16
    v_mad_i32_i24 v11, v14, s55, v92
    v_bitop3_b32 v12, v6, v13, v12 bitop3:0xca
    v_add_lshl_u32 v11, v11, s40, 17
    v_lshlrev_b16 v14, 8, v14
    v_lshrrev_b32 v13, 2, v16
    v_or_b32 v92, v12, v11
    v_bitop3_b32 v16, v5, v13, v14 bitop3:0xea
    ds_add_u32 v16, v2
    v_mul_hi_u32_u24 v14, 429497, v93
    v_lshrrev_b32 v12, 3, v17
    v_cos_f32 v8, v8
    v_lshlrev_b16 v13, 3, v17
    v_mad_i32_i24 v11, v14, s55, v93
    v_bitop3_b32 v12, v6, v13, v12 bitop3:0xca
    v_add_lshl_u32 v11, v11, s40, 17
    v_lshlrev_b16 v14, 8, v14
    v_lshrrev_b32 v13, 2, v17
    v_or_b32 v93, v12, v11
    v_bitop3_b32 v17, v5, v13, v14 bitop3:0xea
    ds_add_u32 v17, v2
    v_cvt_pk_bf16_f32 v122, v7, v8
    v_perm_b32 v12, v122, v122, s41
    v_bitop3_b32 v92, v4, v12, v92 bitop3:0xca
    v_perm_b32 v13, v122, v122, s42
    v_bitop3_b32 v93, v4, v13, v93 bitop3:0xca
    v_mul_hi_u32_u24 v14, 429497, v94
    v_lshrrev_b32 v12, 3, v18
    v_cos_f32 v9, v9
    v_lshlrev_b16 v13, 3, v18
    v_mad_i32_i24 v11, v14, s55, v94
    v_bitop3_b32 v12, v6, v13, v12 bitop3:0xca
    v_add_lshl_u32 v11, v11, s40, 17
    v_lshlrev_b16 v14, 8, v14
    v_lshrrev_b32 v13, 2, v18
    v_or_b32 v94, v12, v11
    v_bitop3_b32 v18, v5, v13, v14 bitop3:0xea
    ds_add_u32 v18, v2
    v_mul_hi_u32_u24 v14, 429497, v95
    v_lshrrev_b32 v12, 3, v19
    v_cos_f32 v10, v10
    v_lshlrev_b16 v13, 3, v19
    v_mad_i32_i24 v11, v14, s55, v95
    v_bitop3_b32 v12, v6, v13, v12 bitop3:0xca
    v_add_lshl_u32 v11, v11, s40, 17
    v_lshlrev_b16 v14, 8, v14
    v_lshrrev_b32 v13, 2, v19
    v_or_b32 v95, v12, v11
    v_bitop3_b32 v19, v5, v13, v14 bitop3:0xea
    ds_add_u32 v19, v2
    v_cvt_pk_bf16_f32 v123, v9, v10
    v_perm_b32 v12, v123, v123, s41
    v_bitop3_b32 v94, v4, v12, v94 bitop3:0xca
    v_perm_b32 v13, v123, v123, s42
    v_bitop3_b32 v95, v4, v13, v95 bitop3:0xca
    s_add_u32 s44, s35, 0x2a4c000
    buffer_store_dwordx4 v[24:27], v0, s[20:23], s44 offen sc1
    s_add_u32 s45, s33, 0x6000000
    s_nop 0
    buffer_load_dwordx4 v[24:27], v0, s[12:15], s45 offen nt
    s_waitcnt vmcnt(8)
    v_lshlrev_b32 v7, 16, v28
    v_and_b32 v8, 0xffff0000, v28
    v_lshlrev_b32 v9, 16, v29
    v_and_b32 v10, 0xffff0000, v29
    v_mul_f32 v7, 0.15915494, v7
    v_mul_f32 v8, 0.15915494, v8
    v_mul_f32 v9, 0.15915494, v9
    v_mul_f32 v10, 0.15915494, v10
    v_mul_hi_u32_u24 v14, 429497, v20
    v_lshrrev_b32 v12, 3, v124
    v_cos_f32 v7, v7
    v_lshlrev_b16 v13, 3, v124
    v_mad_i32_i24 v11, v14, s55, v20
    v_bitop3_b32 v12, v6, v13, v12 bitop3:0xca
    v_add_lshl_u32 v11, v11, s40, 17
    v_lshlrev_b16 v14, 8, v14
    v_lshrrev_b32 v13, 2, v124
    v_or_b32 v20, v12, v11
    v_bitop3_b32 v124, v5, v13, v14 bitop3:0xea
    ds_add_u32 v124, v2
    v_mul_hi_u32_u24 v14, 429497, v21
    v_lshrrev_b32 v12, 3, v125
    v_cos_f32 v8, v8
    v_lshlrev_b16 v13, 3, v125
    v_mad_i32_i24 v11, v14, s55, v21
    v_bitop3_b32 v12, v6, v13, v12 bitop3:0xca
    v_add_lshl_u32 v11, v11, s40, 17
    v_lshlrev_b16 v14, 8, v14
    v_lshrrev_b32 v13, 2, v125
    v_or_b32 v21, v12, v11
    v_bitop3_b32 v125, v5, v13, v14 bitop3:0xea
    ds_add_u32 v125, v2
    v_cvt_pk_bf16_f32 v28, v7, v8
    v_perm_b32 v12, v28, v28, s41
    v_bitop3_b32 v20, v4, v12, v20 bitop3:0xca
    v_perm_b32 v13, v28, v28, s42
    v_bitop3_b32 v21, v4, v13, v21 bitop3:0xca
    v_mul_hi_u32_u24 v14, 429497, v22
    v_lshrrev_b32 v12, 3, v126
    v_cos_f32 v9, v9
    v_lshlrev_b16 v13, 3, v126
    v_mad_i32_i24 v11, v14, s55, v22
    v_bitop3_b32 v12, v6, v13, v12 bitop3:0xca
    v_add_lshl_u32 v11, v11, s40, 17
    v_lshlrev_b16 v14, 8, v14
    v_lshrrev_b32 v13, 2, v126
    v_or_b32 v22, v12, v11
    v_bitop3_b32 v126, v5, v13, v14 bitop3:0xea
    ds_add_u32 v126, v2
    v_mul_hi_u32_u24 v14, 429497, v23
    v_lshrrev_b32 v12, 3, v127
    v_cos_f32 v10, v10
    v_lshlrev_b16 v13, 3, v127
    v_mad_i32_i24 v11, v14, s55, v23
    v_bitop3_b32 v12, v6, v13, v12 bitop3:0xca
    v_add_lshl_u32 v11, v11, s40, 17
    v_lshlrev_b16 v14, 8, v14
    v_lshrrev_b32 v13, 2, v127
    v_or_b32 v23, v12, v11
    v_bitop3_b32 v127, v5, v13, v14 bitop3:0xea
    ds_add_u32 v127, v2
    v_cvt_pk_bf16_f32 v29, v9, v10
    v_perm_b32 v12, v29, v29, s41
    v_bitop3_b32 v22, v4, v12, v22 bitop3:0xca
    v_perm_b32 v13, v29, v29, s42
    v_bitop3_b32 v23, v4, v13, v23 bitop3:0xca
    s_waitcnt vmcnt(4)
    v_lshlrev_b32 v7, 16, v30
    v_and_b32 v8, 0xffff0000, v30
    v_lshlrev_b32 v9, 16, v31
    v_and_b32 v10, 0xffff0000, v31
    v_mul_f32 v7, 0.15915494, v7
    v_mul_f32 v8, 0.15915494, v8
    v_mul_f32 v9, 0.15915494, v9
    v_mul_f32 v10, 0.15915494, v10
    v_mul_hi_u32_u24 v14, 429497, v32
    v_lshrrev_b32 v12, 3, v36
    v_cos_f32 v7, v7
    v_lshlrev_b16 v13, 3, v36
    v_mad_i32_i24 v11, v14, s55, v32
    v_bitop3_b32 v12, v6, v13, v12 bitop3:0xca
    v_add_lshl_u32 v11, v11, s40, 17
    v_lshlrev_b16 v14, 8, v14
    v_lshrrev_b32 v13, 2, v36
    v_or_b32 v32, v12, v11
    v_bitop3_b32 v36, v5, v13, v14 bitop3:0xea
    ds_add_u32 v36, v2
    v_mul_hi_u32_u24 v14, 429497, v33
    v_lshrrev_b32 v12, 3, v37
    v_cos_f32 v8, v8
    v_lshlrev_b16 v13, 3, v37
    v_mad_i32_i24 v11, v14, s55, v33
    v_bitop3_b32 v12, v6, v13, v12 bitop3:0xca
    v_add_lshl_u32 v11, v11, s40, 17
    v_lshlrev_b16 v14, 8, v14
    v_lshrrev_b32 v13, 2, v37
    v_or_b32 v33, v12, v11
    v_bitop3_b32 v37, v5, v13, v14 bitop3:0xea
    ds_add_u32 v37, v2
    v_cvt_pk_bf16_f32 v30, v7, v8
    v_perm_b32 v12, v30, v30, s41
    v_bitop3_b32 v32, v4, v12, v32 bitop3:0xca
    v_perm_b32 v13, v30, v30, s42
    v_bitop3_b32 v33, v4, v13, v33 bitop3:0xca
    v_mul_hi_u32_u24 v14, 429497, v34
    v_lshrrev_b32 v12, 3, v38
    v_cos_f32 v9, v9
    v_lshlrev_b16 v13, 3, v38
    v_mad_i32_i24 v11, v14, s55, v34
    v_bitop3_b32 v12, v6, v13, v12 bitop3:0xca
    v_add_lshl_u32 v11, v11, s40, 17
    v_lshlrev_b16 v14, 8, v14
    v_lshrrev_b32 v13, 2, v38
    v_or_b32 v34, v12, v11
    v_bitop3_b32 v38, v5, v13, v14 bitop3:0xea
    ds_add_u32 v38, v2
    v_mul_hi_u32_u24 v14, 429497, v35
    v_lshrrev_b32 v12, 3, v39
    v_cos_f32 v10, v10
    v_lshlrev_b16 v13, 3, v39
    v_mad_i32_i24 v11, v14, s55, v35
    v_bitop3_b32 v12, v6, v13, v12 bitop3:0xca
    v_add_lshl_u32 v11, v11, s40, 17
    v_lshlrev_b16 v14, 8, v14
    v_lshrrev_b32 v13, 2, v39
    v_or_b32 v35, v12, v11
    v_bitop3_b32 v39, v5, v13, v14 bitop3:0xea
    ds_add_u32 v39, v2
    v_cvt_pk_bf16_f32 v31, v9, v10
    v_perm_b32 v12, v31, v31, s41
    v_bitop3_b32 v34, v4, v12, v34 bitop3:0xca
    v_perm_b32 v13, v31, v31, s42
    v_bitop3_b32 v35, v4, v13, v35 bitop3:0xca
    v_lshrrev_b32 v8, 2, v0
    v_and_b32 v7, 0x3c00, v0
    v_bitop3_b32 v7, v5, v8, v7 bitop3:0xea
    s_waitcnt lgkmcnt(0)
    s_barrier
    ds_read2st64_b32 v[8:9], v7 offset0:0 offset1:1
    ds_read2st64_b32 v[10:11], v7 offset0:2 offset1:3
    s_add_u32 s46, s35, 0x2a50000
    buffer_store_dwordx4 v[84:87], v0, s[20:23], s46 offen sc1
    s_add_u32 s47, s34, 0x3000000
    s_nop 0
    buffer_load_dwordx2 v[84:85], v1, s[16:19], s47 offen nt
    s_add_u32 s44, s34, 0x3200000
    buffer_load_dwordx2 v[86:87], v1, s[16:19], s44 offen nt
    s_waitcnt lgkmcnt(0)
    v_lshl_or_b32 v12, v9, 16, v8
    v_lshl_or_b32 v13, v11, 16, v10
    v_mov_b32 v14, v12
    v_mov_b32 v15, v13
    s_nop 0
    v_add_u32_dpp v14, v14, v14 row_shr:1 row_mask:0xf bank_mask:0xf bound_ctrl:1
    v_add_u32_dpp v15, v15, v15 row_shr:1 row_mask:0xf bank_mask:0xf bound_ctrl:1
    s_nop 0
    v_add_u32_dpp v14, v14, v14 row_shr:2 row_mask:0xf bank_mask:0xf bound_ctrl:1
    v_add_u32_dpp v15, v15, v15 row_shr:2 row_mask:0xf bank_mask:0xf bound_ctrl:1
    s_nop 0
    v_add_u32_dpp v14, v14, v14 row_shr:4 row_mask:0xf bank_mask:0xf bound_ctrl:1
    v_add_u32_dpp v15, v15, v15 row_shr:4 row_mask:0xf bank_mask:0xf bound_ctrl:1
    s_nop 0
    v_add_u32_dpp v14, v14, v14 row_shr:8 row_mask:0xf bank_mask:0xf bound_ctrl:1
    v_add_u32_dpp v15, v15, v15 row_shr:8 row_mask:0xf bank_mask:0xf bound_ctrl:1
    s_nop 0
    v_add_u32_dpp v14, v14, v14 row_bcast:15 row_mask:0xa bank_mask:0xf
    v_add_u32_dpp v15, v15, v15 row_bcast:15 row_mask:0xa bank_mask:0xf
    s_nop 0
    v_add_u32_dpp v14, v14, v14 row_bcast:31 row_mask:0xc bank_mask:0xf
    v_add_u32_dpp v15, v15, v15 row_bcast:31 row_mask:0xc bank_mask:0xf
    v_readlane_b32 s48, v14, 63
    v_readlane_b32 s49, v15, 63
    s_lshl_b32 s54, s32, 2
    v_mov_b32 v8, s54
    s_and_b32 s50, s48, 0xffff
    s_lshr_b32 s51, s48, 16
    s_and_b32 s52, s49, 0xffff
    s_lshr_b32 s53, s49, 16
    s_add_u32 s51, s51, s50
    s_add_u32 s52, s52, s51
    s_add_u32 s53, s53, s52
    v_mov_b32 v9, s53
    s_mov_b64 exec, 1
    ds_write_b32 v8, v9 offset:16384
    s_mov_b64 exec, -1
    v_and_b32 v8, 60, v7
    s_waitcnt lgkmcnt(0)
    s_barrier
    ds_read_b32 v9, v8 offset:16384
    s_waitcnt lgkmcnt(0)
    v_add_u32_dpp v9, v9, v9 row_shr:1 row_mask:0xf bank_mask:0xf bound_ctrl:1
    s_nop 1
    v_add_u32_dpp v9, v9, v9 row_shr:2 row_mask:0xf bank_mask:0xf bound_ctrl:1
    s_nop 1
    v_add_u32_dpp v9, v9, v9 row_shr:4 row_mask:0xf bank_mask:0xf bound_ctrl:1
    s_nop 1
    v_add_u32_dpp v9, v9, v9 row_shr:8 row_mask:0xf bank_mask:0xf bound_ctrl:1
    s_nop 0
    v_readlane_b32 s54, v9, s32
    s_sub_u32 s54, s54, s53
    s_add_u32 s50, s50, s54
    s_add_u32 s51, s51, s54
    s_add_u32 s52, s52, s54
    s_pack_ll_b32_b16 s48, s54, s50
    s_pack_ll_b32_b16 s49, s51, s52
    v_add_u32 v14, s48, v14
    v_add_u32 v15, s49, v15
    v_sub_u32 v12, v14, v12
    v_sub_u32 v13, v15, v13
    v_and_b32 v8, 0xffff, v12
    v_lshrrev_b32 v9, 16, v12
    v_and_b32 v10, 0xffff, v13
    v_lshrrev_b32 v11, 16, v13
    ds_write2st64_b32 v7, v8, v9 offset0:0 offset1:1
    ds_write2st64_b32 v7, v10, v11 offset0:2 offset1:3
    s_waitcnt lgkmcnt(0)
    s_barrier
    ds_add_rtn_u32 v72, v72, v2
    ds_add_rtn_u32 v73, v73, v2
    ds_add_rtn_u32 v74, v74, v2
    ds_add_rtn_u32 v75, v75, v2
    s_add_u32 s45, s36, 0x5480000
    v_and_b32 v11, 0x3f0, v0
    v_add_u32 v11, v11, v11
    buffer_store_dwordx2 v[12:13], v11, s[24:27], s45 offen
    s_bitset0_b64 exec, 63
    s_not_b64 exec, exec
    buffer_store_dwordx2 v[14:15], v11, s[24:27], s45 offen offset:32
    s_mov_b64 exec, -1
    ds_add_rtn_u32 v80, v80, v2
    ds_add_rtn_u32 v81, v81, v2
    ds_add_rtn_u32 v82, v82, v2
    ds_add_rtn_u32 v83, v83, v2
    ds_add_rtn_u32 v100, v100, v2
    ds_add_rtn_u32 v101, v101, v2
    ds_add_rtn_u32 v102, v102, v2
    ds_add_rtn_u32 v103, v103, v2
    s_add_u32 s46, s35, 0x2a54000
    buffer_store_dwordx4 v[48:51], v0, s[20:23], s46 offen sc1
    s_add_u32 s47, s33, 0x6400000
    s_nop 0
    buffer_load_dwordx4 v[48:51], v0, s[8:11], s47 offen nt
    ds_add_rtn_u32 v112, v112, v2
    ds_add_rtn_u32 v113, v113, v2
    ds_add_rtn_u32 v114, v114, v2
    ds_add_rtn_u32 v115, v115, v2
    ds_add_rtn_u32 v116, v116, v2
    ds_add_rtn_u32 v117, v117, v2
    ds_add_rtn_u32 v118, v118, v2
    ds_add_rtn_u32 v119, v119, v2
    ds_add_rtn_u32 v16, v16, v2
    ds_add_rtn_u32 v17, v17, v2
    ds_add_rtn_u32 v18, v18, v2
    ds_add_rtn_u32 v19, v19, v2
    s_add_u32 s44, s35, 0x2a58000
    buffer_store_dwordx4 v[52:55], v0, s[20:23], s44 offen sc1
    s_add_u32 s45, s33, 0x6400000
    s_nop 0
    buffer_load_dwordx4 v[52:55], v0, s[12:15], s45 offen nt
    ds_add_rtn_u32 v124, v124, v2
    ds_add_rtn_u32 v125, v125, v2
    ds_add_rtn_u32 v126, v126, v2
    ds_add_rtn_u32 v127, v127, v2
    ds_add_rtn_u32 v36, v36, v2
    ds_add_rtn_u32 v37, v37, v2
    ds_add_rtn_u32 v38, v38, v2
    ds_add_rtn_u32 v39, v39, v2
    s_waitcnt lgkmcnt(0)
    s_barrier
    v_and_b32 v7, -4, v72
    v_lshl_add_u32 v8, v72, 2, v7
    ds_write_b32 v8, v68
    v_lshl_add_u32 v7, v7, 2, v72
    ds_write_b8 v7, v64 offset:16
    v_and_b32 v9, -4, v73
    v_lshl_add_u32 v10, v73, 2, v9
    ds_write_b32 v10, v69
    v_lshl_add_u32 v9, v9, 2, v73
    ds_write_b8_d16_hi v9, v64 offset:16
    v_and_b32 v7, -4, v74
    v_lshl_add_u32 v8, v74, 2, v7
    ds_write_b32 v8, v70
    v_lshl_add_u32 v7, v7, 2, v74
    ds_write_b8 v7, v65 offset:16
    v_and_b32 v9, -4, v75
    v_lshl_add_u32 v10, v75, 2, v9
    ds_write_b32 v10, v71
    v_lshl_add_u32 v9, v9, 2, v75
    ds_write_b8_d16_hi v9, v65 offset:16
    s_add_u32 s46, s35, 0x2a5c000
    buffer_store_dwordx4 v[56:59], v0, s[20:23], s46 offen sc1
    s_add_u32 s47, s33, 0x6800000
    buffer_load_dwordx4 v[68:71], v0, s[8:11], s47 offen nt
    s_add_u32 s44, s33, 0x6800000
    buffer_load_dwordx4 v[72:75], v0, s[12:15], s44 offen nt
    v_and_b32 v7, -4, v80
    v_lshl_add_u32 v8, v80, 2, v7
    ds_write_b32 v8, v76
    v_lshl_add_u32 v7, v7, 2, v80
    ds_write_b8 v7, v66 offset:16
    v_and_b32 v9, -4, v81
    v_lshl_add_u32 v10, v81, 2, v9
    ds_write_b32 v10, v77
    v_lshl_add_u32 v9, v9, 2, v81
    ds_write_b8_d16_hi v9, v66 offset:16
    v_and_b32 v7, -4, v82
    v_lshl_add_u32 v8, v82, 2, v7
    ds_write_b32 v8, v78
    v_lshl_add_u32 v7, v7, 2, v82
    ds_write_b8 v7, v67 offset:16
    v_and_b32 v9, -4, v83
    v_lshl_add_u32 v10, v83, 2, v9
    ds_write_b32 v10, v79
    v_lshl_add_u32 v9, v9, 2, v83
    ds_write_b8_d16_hi v9, v67 offset:16
    s_add_u32 s45, s34, 0x3400000
    buffer_load_dwordx2 v[56:57], v1, s[16:19], s45 offen nt
    s_add_u32 s46, s34, 0x3600000
    buffer_load_dwordx2 v[58:59], v1, s[16:19], s46 offen nt
    s_add_u32 s47, s33, 0x6c00000
    buffer_load_dwordx4 v[76:79], v0, s[8:11], s47 offen nt
    v_and_b32 v7, -4, v100
    v_lshl_add_u32 v8, v100, 2, v7
    ds_write_b32 v8, v96
    v_lshl_add_u32 v7, v7, 2, v100
    ds_write_b8 v7, v88 offset:16
    v_and_b32 v9, -4, v101
    v_lshl_add_u32 v10, v101, 2, v9
    ds_write_b32 v10, v97
    v_lshl_add_u32 v9, v9, 2, v101
    ds_write_b8_d16_hi v9, v88 offset:16
    v_and_b32 v7, -4, v102
    v_lshl_add_u32 v8, v102, 2, v7
    ds_write_b32 v8, v98
    v_lshl_add_u32 v7, v7, 2, v102
    ds_write_b8 v7, v89 offset:16
    v_and_b32 v9, -4, v103
    v_lshl_add_u32 v10, v103, 2, v9
    ds_write_b32 v10, v99
    v_lshl_add_u32 v9, v9, 2, v103
    ds_write_b8_d16_hi v9, v89 offset:16
    s_add_u32 s44, s35, 0x2a60000
    buffer_store_dwordx4 v[60:63], v0, s[20:23], s44 offen sc1
    s_add_u32 s45, s33, 0x6c00000
    buffer_load_dwordx4 v[80:83], v0, s[12:15], s45 offen nt
    v_and_b32 v7, -4, v112
    v_lshl_add_u32 v8, v112, 2, v7
    ds_write_b32 v8, v108
    v_lshl_add_u32 v7, v7, 2, v112
    ds_write_b8 v7, v90 offset:16
    v_and_b32 v9, -4, v113
    v_lshl_add_u32 v10, v113, 2, v9
    ds_write_b32 v10, v109
    v_lshl_add_u32 v9, v9, 2, v113
    ds_write_b8_d16_hi v9, v90 offset:16
    v_and_b32 v7, -4, v114
    v_lshl_add_u32 v8, v114, 2, v7
    ds_write_b32 v8, v110
    v_lshl_add_u32 v7, v7, 2, v114
    ds_write_b8 v7, v91 offset:16
    v_and_b32 v9, -4, v115
    v_lshl_add_u32 v10, v115, 2, v9
    ds_write_b32 v10, v111
    v_lshl_add_u32 v9, v9, 2, v115
    ds_write_b8_d16_hi v9, v91 offset:16
    s_add_u32 s46, s33, 0x7000000
    buffer_load_dwordx4 v[64:67], v0, s[8:11], s46 offen nt
    s_add_u32 s47, s33, 0x7000000
    buffer_load_dwordx4 v[96:99], v0, s[12:15], s47 offen nt
    v_and_b32 v7, -4, v116
    v_lshl_add_u32 v8, v116, 2, v7
    ds_write_b32 v8, v104
    v_lshl_add_u32 v7, v7, 2, v116
    ds_write_b8 v7, v120 offset:16
    v_and_b32 v9, -4, v117
    v_lshl_add_u32 v10, v117, 2, v9
    ds_write_b32 v10, v105
    v_lshl_add_u32 v9, v9, 2, v117
    ds_write_b8_d16_hi v9, v120 offset:16
    v_and_b32 v7, -4, v118
    v_lshl_add_u32 v8, v118, 2, v7
    ds_write_b32 v8, v106
    v_lshl_add_u32 v7, v7, 2, v118
    ds_write_b8 v7, v121 offset:16
    v_and_b32 v9, -4, v119
    v_lshl_add_u32 v10, v119, 2, v9
    ds_write_b32 v10, v107
    v_lshl_add_u32 v9, v9, 2, v119
    ds_write_b8_d16_hi v9, v121 offset:16
    s_add_u32 s44, s34, 0x3800000
    buffer_load_dwordx2 v[100:101], v1, s[16:19], s44 offen nt
    s_add_u32 s45, s34, 0x3a00000
    buffer_load_dwordx2 v[102:103], v1, s[16:19], s45 offen nt
    s_add_u32 s46, s33, 0x7400000
    buffer_load_dwordx4 v[60:63], v0, s[8:11], s46 offen nt
    v_and_b32 v7, -4, v16
    v_lshl_add_u32 v8, v16, 2, v7
    ds_write_b32 v8, v92
    v_lshl_add_u32 v7, v7, 2, v16
    ds_write_b8 v7, v122 offset:16
    v_and_b32 v9, -4, v17
    v_lshl_add_u32 v10, v17, 2, v9
    ds_write_b32 v10, v93
    v_lshl_add_u32 v9, v9, 2, v17
    ds_write_b8_d16_hi v9, v122 offset:16
    v_and_b32 v7, -4, v18
    v_lshl_add_u32 v8, v18, 2, v7
    ds_write_b32 v8, v94
    v_lshl_add_u32 v7, v7, 2, v18
    ds_write_b8 v7, v123 offset:16
    v_and_b32 v9, -4, v19
    v_lshl_add_u32 v10, v19, 2, v9
    ds_write_b32 v10, v95
    v_lshl_add_u32 v9, v9, 2, v19
    ds_write_b8_d16_hi v9, v123 offset:16
    s_add_u32 s47, s35, 0x2a64000
    buffer_store_dwordx4 v[44:47], v0, s[20:23], s47 offen sc1
    s_add_u32 s44, s33, 0x7400000
    buffer_load_dwordx4 v[108:111], v0, s[12:15], s44 offen nt
    v_and_b32 v7, -4, v124
    v_lshl_add_u32 v8, v124, 2, v7
    ds_write_b32 v8, v20
    v_lshl_add_u32 v7, v7, 2, v124
    ds_write_b8 v7, v28 offset:16
    v_and_b32 v9, -4, v125
    v_lshl_add_u32 v10, v125, 2, v9
    ds_write_b32 v10, v21
    v_lshl_add_u32 v9, v9, 2, v125
    ds_write_b8_d16_hi v9, v28 offset:16
    v_and_b32 v7, -4, v126
    v_lshl_add_u32 v8, v126, 2, v7
    ds_write_b32 v8, v22
    v_lshl_add_u32 v7, v7, 2, v126
    ds_write_b8 v7, v29 offset:16
    v_and_b32 v9, -4, v127
    v_lshl_add_u32 v10, v127, 2, v9
    ds_write_b32 v10, v23
    v_lshl_add_u32 v9, v9, 2, v127
    ds_write_b8_d16_hi v9, v29 offset:16
    s_add_u32 s45, s33, 0x7800000
    buffer_load_dwordx4 v[112:115], v0, s[8:11], s45 offen nt
    s_add_u32 s46, s33, 0x7800000
    buffer_load_dwordx4 v[88:91], v0, s[12:15], s46 offen nt
    v_and_b32 v7, -4, v36
    v_lshl_add_u32 v8, v36, 2, v7
    ds_write_b32 v8, v32
    v_lshl_add_u32 v7, v7, 2, v36
    ds_write_b8 v7, v30 offset:16
    v_and_b32 v9, -4, v37
    v_lshl_add_u32 v10, v37, 2, v9
    ds_write_b32 v10, v33
    v_lshl_add_u32 v9, v9, 2, v37
    ds_write_b8_d16_hi v9, v30 offset:16
    v_and_b32 v7, -4, v38
    v_lshl_add_u32 v8, v38, 2, v7
    ds_write_b32 v8, v34
    v_lshl_add_u32 v7, v7, 2, v38
    ds_write_b8 v7, v31 offset:16
    v_and_b32 v9, -4, v39
    v_lshl_add_u32 v10, v39, 2, v9
    ds_write_b32 v10, v35
    v_lshl_add_u32 v9, v9, 2, v39
    ds_write_b8_d16_hi v9, v31 offset:16
    s_add_u32 s47, s34, 0x3c00000
    buffer_load_dwordx2 v[104:105], v1, s[16:19], s47 offen nt
    s_add_u32 s44, s34, 0x3e00000
    buffer_load_dwordx2 v[106:107], v1, s[16:19], s44 offen nt
    v_add_u32 v7, 0x10000, v0
    v_add_u32 v12, 0x20000, v0
    v_mov_b32 v8, 0
    v_mov_b32 v9, 0
    v_mov_b32 v10, 0
    v_mov_b32 v11, 0
    s_waitcnt lgkmcnt(0)
    s_barrier
    ds_read_b128 v[116:119], v0 offset:0
    ds_write_b128 v0, v[8:11]
    ds_read_b128 v[92:95], v0 offset:16384
    ds_read_b128 v[16:19], v0 offset:32768
    ds_read_b128 v[120:123], v0 offset:49152
    ds_read_b128 v[44:47], v7 offset:0
    ds_read_b128 v[20:23], v7 offset:16384
    ds_read_b128 v[124:127], v7 offset:32768
    ds_read_b128 v[32:35], v7 offset:49152
    ds_read_b128 v[36:39], v12 offset:0
    ds_read_b128 v[28:31], v12 offset:16384
    s_waitcnt lgkmcnt(0)
    s_barrier
    s_add_u32 s45, s35, 0x5480000
    buffer_store_dwordx4 v[116:119], v0, s[20:23], s45 offen sc1
    s_add_u32 s46, s33, 0x7c00000
    s_nop 0
    buffer_load_dwordx4 v[116:119], v0, s[8:11], s46 offen nt
    s_add_u32 s47, s35, 0x5484000
    buffer_store_dwordx4 v[92:95], v0, s[20:23], s47 offen sc1
    s_add_u32 s44, s33, 0x7c00000
    s_nop 0
    buffer_load_dwordx4 v[92:95], v0, s[12:15], s44 offen nt
    s_waitcnt vmcnt(29)
    v_lshlrev_b32 v7, 16, v84
    v_and_b32 v8, 0xffff0000, v84
    v_lshlrev_b32 v9, 16, v85
    v_and_b32 v10, 0xffff0000, v85
    v_mul_f32 v7, 0.15915494, v7
    v_mul_f32 v8, 0.15915494, v8
    v_mul_f32 v9, 0.15915494, v9
    v_mul_f32 v10, 0.15915494, v10
    v_mul_hi_u32_u24 v14, 429497, v40
    v_lshrrev_b32 v12, 3, v24
    v_cos_f32 v7, v7
    v_lshlrev_b16 v13, 3, v24
    v_mad_i32_i24 v11, v14, s55, v40
    v_bitop3_b32 v12, v6, v13, v12 bitop3:0xca
    v_add_lshl_u32 v11, v11, s40, 17
    v_lshlrev_b16 v14, 8, v14
    v_lshrrev_b32 v13, 2, v24
    v_or_b32 v40, v12, v11
    v_bitop3_b32 v24, v5, v13, v14 bitop3:0xea
    ds_add_u32 v24, v2
    v_mul_hi_u32_u24 v14, 429497, v41
    v_lshrrev_b32 v12, 3, v25
    v_cos_f32 v8, v8
    v_lshlrev_b16 v13, 3, v25
    v_mad_i32_i24 v11, v14, s55, v41
    v_bitop3_b32 v12, v6, v13, v12 bitop3:0xca
    v_add_lshl_u32 v11, v11, s40, 17
    v_lshlrev_b16 v14, 8, v14
    v_lshrrev_b32 v13, 2, v25
    v_or_b32 v41, v12, v11
    v_bitop3_b32 v25, v5, v13, v14 bitop3:0xea
    ds_add_u32 v25, v2
    v_cvt_pk_bf16_f32 v84, v7, v8
    v_perm_b32 v12, v84, v84, s41
    v_bitop3_b32 v40, v4, v12, v40 bitop3:0xca
    v_perm_b32 v13, v84, v84, s42
    v_bitop3_b32 v41, v4, v13, v41 bitop3:0xca
    v_mul_hi_u32_u24 v14, 429497, v42
    v_lshrrev_b32 v12, 3, v26
    v_cos_f32 v9, v9
    v_lshlrev_b16 v13, 3, v26
    v_mad_i32_i24 v11, v14, s55, v42
    v_bitop3_b32 v12, v6, v13, v12 bitop3:0xca
    v_add_lshl_u32 v11, v11, s40, 17
    v_lshlrev_b16 v14, 8, v14
    v_lshrrev_b32 v13, 2, v26
    v_or_b32 v42, v12, v11
    v_bitop3_b32 v26, v5, v13, v14 bitop3:0xea
    ds_add_u32 v26, v2
    v_mul_hi_u32_u24 v14, 429497, v43
    v_lshrrev_b32 v12, 3, v27
    v_cos_f32 v10, v10
    v_lshlrev_b16 v13, 3, v27
    v_mad_i32_i24 v11, v14, s55, v43
    v_bitop3_b32 v12, v6, v13, v12 bitop3:0xca
    v_add_lshl_u32 v11, v11, s40, 17
    v_lshlrev_b16 v14, 8, v14
    v_lshrrev_b32 v13, 2, v27
    v_or_b32 v43, v12, v11
    v_bitop3_b32 v27, v5, v13, v14 bitop3:0xea
    ds_add_u32 v27, v2
    v_cvt_pk_bf16_f32 v85, v9, v10
    v_perm_b32 v12, v85, v85, s41
    v_bitop3_b32 v42, v4, v12, v42 bitop3:0xca
    v_perm_b32 v13, v85, v85, s42
    v_bitop3_b32 v43, v4, v13, v43 bitop3:0xca
    s_waitcnt vmcnt(23)
    v_lshlrev_b32 v7, 16, v86
    v_and_b32 v8, 0xffff0000, v86
    v_lshlrev_b32 v9, 16, v87
    v_and_b32 v10, 0xffff0000, v87
    v_mul_f32 v7, 0.15915494, v7
    v_mul_f32 v8, 0.15915494, v8
    v_mul_f32 v9, 0.15915494, v9
    v_mul_f32 v10, 0.15915494, v10
    v_mul_hi_u32_u24 v14, 429497, v48
    v_lshrrev_b32 v12, 3, v52
    v_cos_f32 v7, v7
    v_lshlrev_b16 v13, 3, v52
    v_mad_i32_i24 v11, v14, s55, v48
    v_bitop3_b32 v12, v6, v13, v12 bitop3:0xca
    v_add_lshl_u32 v11, v11, s40, 17
    v_lshlrev_b16 v14, 8, v14
    v_lshrrev_b32 v13, 2, v52
    v_or_b32 v48, v12, v11
    v_bitop3_b32 v52, v5, v13, v14 bitop3:0xea
    ds_add_u32 v52, v2
    v_mul_hi_u32_u24 v14, 429497, v49
    v_lshrrev_b32 v12, 3, v53
    v_cos_f32 v8, v8
    v_lshlrev_b16 v13, 3, v53
    v_mad_i32_i24 v11, v14, s55, v49
    v_bitop3_b32 v12, v6, v13, v12 bitop3:0xca
    v_add_lshl_u32 v11, v11, s40, 17
    v_lshlrev_b16 v14, 8, v14
    v_lshrrev_b32 v13, 2, v53
    v_or_b32 v49, v12, v11
    v_bitop3_b32 v53, v5, v13, v14 bitop3:0xea
    ds_add_u32 v53, v2
    v_cvt_pk_bf16_f32 v86, v7, v8
    v_perm_b32 v12, v86, v86, s41
    v_bitop3_b32 v48, v4, v12, v48 bitop3:0xca
    v_perm_b32 v13, v86, v86, s42
    v_bitop3_b32 v49, v4, v13, v49 bitop3:0xca
    v_mul_hi_u32_u24 v14, 429497, v50
    v_lshrrev_b32 v12, 3, v54
    v_cos_f32 v9, v9
    v_lshlrev_b16 v13, 3, v54
    v_mad_i32_i24 v11, v14, s55, v50
    v_bitop3_b32 v12, v6, v13, v12 bitop3:0xca
    v_add_lshl_u32 v11, v11, s40, 17
    v_lshlrev_b16 v14, 8, v14
    v_lshrrev_b32 v13, 2, v54
    v_or_b32 v50, v12, v11
    v_bitop3_b32 v54, v5, v13, v14 bitop3:0xea
    ds_add_u32 v54, v2
    v_mul_hi_u32_u24 v14, 429497, v51
    v_lshrrev_b32 v12, 3, v55
    v_cos_f32 v10, v10
    v_lshlrev_b16 v13, 3, v55
    v_mad_i32_i24 v11, v14, s55, v51
    v_bitop3_b32 v12, v6, v13, v12 bitop3:0xca
    v_add_lshl_u32 v11, v11, s40, 17
    v_lshlrev_b16 v14, 8, v14
    v_lshrrev_b32 v13, 2, v55
    v_or_b32 v51, v12, v11
    v_bitop3_b32 v55, v5, v13, v14 bitop3:0xea
    ds_add_u32 v55, v2
    v_cvt_pk_bf16_f32 v87, v9, v10
    v_perm_b32 v12, v87, v87, s41
    v_bitop3_b32 v50, v4, v12, v50 bitop3:0xca
    v_perm_b32 v13, v87, v87, s42
    v_bitop3_b32 v51, v4, v13, v51 bitop3:0xca
    s_waitcnt vmcnt(18)
    v_lshlrev_b32 v7, 16, v56
    v_and_b32 v8, 0xffff0000, v56
    v_lshlrev_b32 v9, 16, v57
    v_and_b32 v10, 0xffff0000, v57
    v_mul_f32 v7, 0.15915494, v7
    v_mul_f32 v8, 0.15915494, v8
    v_mul_f32 v9, 0.15915494, v9
    v_mul_f32 v10, 0.15915494, v10
    v_mul_hi_u32_u24 v14, 429497, v68
    v_lshrrev_b32 v12, 3, v72
    v_cos_f32 v7, v7
    v_lshlrev_b16 v13, 3, v72
    v_mad_i32_i24 v11, v14, s55, v68
    v_bitop3_b32 v12, v6, v13, v12 bitop3:0xca
    v_add_lshl_u32 v11, v11, s40, 17
    v_lshlrev_b16 v14, 8, v14
    v_lshrrev_b32 v13, 2, v72
    v_or_b32 v68, v12, v11
    v_bitop3_b32 v72, v5, v13, v14 bitop3:0xea
    ds_add_u32 v72, v2
    v_mul_hi_u32_u24 v14, 429497, v69
    v_lshrrev_b32 v12, 3, v73
    v_cos_f32 v8, v8
    v_lshlrev_b16 v13, 3, v73
    v_mad_i32_i24 v11, v14, s55, v69
    v_bitop3_b32 v12, v6, v13, v12 bitop3:0xca
    v_add_lshl_u32 v11, v11, s40, 17
    v_lshlrev_b16 v14, 8, v14
    v_lshrrev_b32 v13, 2, v73
    v_or_b32 v69, v12, v11
    v_bitop3_b32 v73, v5, v13, v14 bitop3:0xea
    ds_add_u32 v73, v2
    v_cvt_pk_bf16_f32 v56, v7, v8
    v_perm_b32 v12, v56, v56, s41
    v_bitop3_b32 v68, v4, v12, v68 bitop3:0xca
    v_perm_b32 v13, v56, v56, s42
    v_bitop3_b32 v69, v4, v13, v69 bitop3:0xca
    v_mul_hi_u32_u24 v14, 429497, v70
    v_lshrrev_b32 v12, 3, v74
    v_cos_f32 v9, v9
    v_lshlrev_b16 v13, 3, v74
    v_mad_i32_i24 v11, v14, s55, v70
    v_bitop3_b32 v12, v6, v13, v12 bitop3:0xca
    v_add_lshl_u32 v11, v11, s40, 17
    v_lshlrev_b16 v14, 8, v14
    v_lshrrev_b32 v13, 2, v74
    v_or_b32 v70, v12, v11
    v_bitop3_b32 v74, v5, v13, v14 bitop3:0xea
    ds_add_u32 v74, v2
    v_mul_hi_u32_u24 v14, 429497, v71
    v_lshrrev_b32 v12, 3, v75
    v_cos_f32 v10, v10
    v_lshlrev_b16 v13, 3, v75
    v_mad_i32_i24 v11, v14, s55, v71
    v_bitop3_b32 v12, v6, v13, v12 bitop3:0xca
    v_add_lshl_u32 v11, v11, s40, 17
    v_lshlrev_b16 v14, 8, v14
    v_lshrrev_b32 v13, 2, v75
    v_or_b32 v71, v12, v11
    v_bitop3_b32 v75, v5, v13, v14 bitop3:0xea
    ds_add_u32 v75, v2
    v_cvt_pk_bf16_f32 v57, v9, v10
    v_perm_b32 v12, v57, v57, s41
    v_bitop3_b32 v70, v4, v12, v70 bitop3:0xca
    v_perm_b32 v13, v57, v57, s42
    v_bitop3_b32 v71, v4, v13, v71 bitop3:0xca
    s_add_u32 s45, s35, 0x5488000
    buffer_store_dwordx4 v[16:19], v0, s[20:23], s45 offen sc1
    s_add_u32 s46, s33, 0x8000000
    s_nop 0
    buffer_load_dwordx4 v[16:19], v0, s[8:11], s46 offen nt
    s_waitcnt vmcnt(17)
    v_lshlrev_b32 v7, 16, v58
    v_and_b32 v8, 0xffff0000, v58
    v_lshlrev_b32 v9, 16, v59
    v_and_b32 v10, 0xffff0000, v59
    v_mul_f32 v7, 0.15915494, v7
    v_mul_f32 v8, 0.15915494, v8
    v_mul_f32 v9, 0.15915494, v9
    v_mul_f32 v10, 0.15915494, v10
    v_mul_hi_u32_u24 v14, 429497, v76
    v_lshrrev_b32 v12, 3, v80
    v_cos_f32 v7, v7
    v_lshlrev_b16 v13, 3, v80
    v_mad_i32_i24 v11, v14, s55, v76
    v_bitop3_b32 v12, v6, v13, v12 bitop3:0xca
    v_add_lshl_u32 v11, v11, s40, 17
    v_lshlrev_b16 v14, 8, v14
    v_lshrrev_b32 v13, 2, v80
    v_or_b32 v76, v12, v11
    v_bitop3_b32 v80, v5, v13, v14 bitop3:0xea
    ds_add_u32 v80, v2
    v_mul_hi_u32_u24 v14, 429497, v77
    v_lshrrev_b32 v12, 3, v81
    v_cos_f32 v8, v8
    v_lshlrev_b16 v13, 3, v81
    v_mad_i32_i24 v11, v14, s55, v77
    v_bitop3_b32 v12, v6, v13, v12 bitop3:0xca
    v_add_lshl_u32 v11, v11, s40, 17
    v_lshlrev_b16 v14, 8, v14
    v_lshrrev_b32 v13, 2, v81
    v_or_b32 v77, v12, v11
    v_bitop3_b32 v81, v5, v13, v14 bitop3:0xea
    ds_add_u32 v81, v2
    v_cvt_pk_bf16_f32 v58, v7, v8
    v_perm_b32 v12, v58, v58, s41
    v_bitop3_b32 v76, v4, v12, v76 bitop3:0xca
    v_perm_b32 v13, v58, v58, s42
    v_bitop3_b32 v77, v4, v13, v77 bitop3:0xca
    v_mul_hi_u32_u24 v14, 429497, v78
    v_lshrrev_b32 v12, 3, v82
    v_cos_f32 v9, v9
    v_lshlrev_b16 v13, 3, v82
    v_mad_i32_i24 v11, v14, s55, v78
    v_bitop3_b32 v12, v6, v13, v12 bitop3:0xca
    v_add_lshl_u32 v11, v11, s40, 17
    v_lshlrev_b16 v14, 8, v14
    v_lshrrev_b32 v13, 2, v82
    v_or_b32 v78, v12, v11
    v_bitop3_b32 v82, v5, v13, v14 bitop3:0xea
    ds_add_u32 v82, v2
    v_mul_hi_u32_u24 v14, 429497, v79
    v_lshrrev_b32 v12, 3, v83
    v_cos_f32 v10, v10
    v_lshlrev_b16 v13, 3, v83
    v_mad_i32_i24 v11, v14, s55, v79
    v_bitop3_b32 v12, v6, v13, v12 bitop3:0xca
    v_add_lshl_u32 v11, v11, s40, 17
    v_lshlrev_b16 v14, 8, v14
    v_lshrrev_b32 v13, 2, v83
    v_or_b32 v79, v12, v11
    v_bitop3_b32 v83, v5, v13, v14 bitop3:0xea
    ds_add_u32 v83, v2
    v_cvt_pk_bf16_f32 v59, v9, v10
    v_perm_b32 v12, v59, v59, s41
    v_bitop3_b32 v78, v4, v12, v78 bitop3:0xca
    v_perm_b32 v13, v59, v59, s42
    v_bitop3_b32 v79, v4, v13, v79 bitop3:0xca
    s_mov_b32 s68, s56
    s_mov_b32 s69, s57
    s_mov_b32 s70, 0x100
    s_mov_b32 s71, 0x20000
    v_mov_b32 v3, 1
    s_cmp_lg_u32 s32, 15
    s_cbranch_scc1 L1_tk
    s_mov_b64 exec, 1
    buffer_atomic_add v3, off, s[68:71], 0 sc0
    s_mov_b64 exec, -1
L1_tk:
    s_waitcnt vmcnt(13)
    v_lshlrev_b32 v7, 16, v100
    v_and_b32 v8, 0xffff0000, v100
    v_lshlrev_b32 v9, 16, v101
    v_and_b32 v10, 0xffff0000, v101
    v_mul_f32 v7, 0.15915494, v7
    v_mul_f32 v8, 0.15915494, v8
    v_mul_f32 v9, 0.15915494, v9
    v_mul_f32 v10, 0.15915494, v10
    v_mul_hi_u32_u24 v14, 429497, v64
    v_lshrrev_b32 v12, 3, v96
    v_cos_f32 v7, v7
    v_lshlrev_b16 v13, 3, v96
    v_mad_i32_i24 v11, v14, s55, v64
    v_bitop3_b32 v12, v6, v13, v12 bitop3:0xca
    v_add_lshl_u32 v11, v11, s40, 17
    v_lshlrev_b16 v14, 8, v14
    v_lshrrev_b32 v13, 2, v96
    v_or_b32 v64, v12, v11
    v_bitop3_b32 v96, v5, v13, v14 bitop3:0xea
    ds_add_u32 v96, v2
    v_mul_hi_u32_u24 v14, 429497, v65
    v_lshrrev_b32 v12, 3, v97
    v_cos_f32 v8, v8
    v_lshlrev_b16 v13, 3, v97
    v_mad_i32_i24 v11, v14, s55, v65
    v_bitop3_b32 v12, v6, v13, v12 bitop3:0xca
    v_add_lshl_u32 v11, v11, s40, 17
    v_lshlrev_b16 v14, 8, v14
    v_lshrrev_b32 v13, 2, v97
    v_or_b32 v65, v12, v11
    v_bitop3_b32 v97, v5, v13, v14 bitop3:0xea
    ds_add_u32 v97, v2
    v_cvt_pk_bf16_f32 v100, v7, v8
    v_perm_b32 v12, v100, v100, s41
    v_bitop3_b32 v64, v4, v12, v64 bitop3:0xca
    v_perm_b32 v13, v100, v100, s42
    v_bitop3_b32 v65, v4, v13, v65 bitop3:0xca
    v_mul_hi_u32_u24 v14, 429497, v66
    v_lshrrev_b32 v12, 3, v98
    v_cos_f32 v9, v9
    v_lshlrev_b16 v13, 3, v98
    v_mad_i32_i24 v11, v14, s55, v66
    v_bitop3_b32 v12, v6, v13, v12 bitop3:0xca
    v_add_lshl_u32 v11, v11, s40, 17
    v_lshlrev_b16 v14, 8, v14
    v_lshrrev_b32 v13, 2, v98
    v_or_b32 v66, v12, v11
    v_bitop3_b32 v98, v5, v13, v14 bitop3:0xea
    ds_add_u32 v98, v2
    v_mul_hi_u32_u24 v14, 429497, v67
    v_lshrrev_b32 v12, 3, v99
    v_cos_f32 v10, v10
    v_lshlrev_b16 v13, 3, v99
    v_mad_i32_i24 v11, v14, s55, v67
    v_bitop3_b32 v12, v6, v13, v12 bitop3:0xca
    v_add_lshl_u32 v11, v11, s40, 17
    v_lshlrev_b16 v14, 8, v14
    v_lshrrev_b32 v13, 2, v99
    v_or_b32 v67, v12, v11
    v_bitop3_b32 v99, v5, v13, v14 bitop3:0xea
    ds_add_u32 v99, v2
    v_cvt_pk_bf16_f32 v101, v9, v10
    v_perm_b32 v12, v101, v101, s41
    v_bitop3_b32 v66, v4, v12, v66 bitop3:0xca
    v_perm_b32 v13, v101, v101, s42
    v_bitop3_b32 v67, v4, v13, v67 bitop3:0xca
    s_waitcnt vmcnt(10)
    v_lshlrev_b32 v7, 16, v102
    v_and_b32 v8, 0xffff0000, v102
    v_lshlrev_b32 v9, 16, v103
    v_and_b32 v10, 0xffff0000, v103
    v_mul_f32 v7, 0.15915494, v7
    v_mul_f32 v8, 0.15915494, v8
    v_mul_f32 v9, 0.15915494, v9
    v_mul_f32 v10, 0.15915494, v10
    v_mul_hi_u32_u24 v14, 429497, v60
    v_lshrrev_b32 v12, 3, v108
    v_cos_f32 v7, v7
    v_lshlrev_b16 v13, 3, v108
    v_mad_i32_i24 v11, v14, s55, v60
    v_bitop3_b32 v12, v6, v13, v12 bitop3:0xca
    v_add_lshl_u32 v11, v11, s40, 17
    v_lshlrev_b16 v14, 8, v14
    v_lshrrev_b32 v13, 2, v108
    v_or_b32 v60, v12, v11
    v_bitop3_b32 v108, v5, v13, v14 bitop3:0xea
    ds_add_u32 v108, v2
    v_mul_hi_u32_u24 v14, 429497, v61
    v_lshrrev_b32 v12, 3, v109
    v_cos_f32 v8, v8
    v_lshlrev_b16 v13, 3, v109
    v_mad_i32_i24 v11, v14, s55, v61
    v_bitop3_b32 v12, v6, v13, v12 bitop3:0xca
    v_add_lshl_u32 v11, v11, s40, 17
    v_lshlrev_b16 v14, 8, v14
    v_lshrrev_b32 v13, 2, v109
    v_or_b32 v61, v12, v11
    v_bitop3_b32 v109, v5, v13, v14 bitop3:0xea
    ds_add_u32 v109, v2
    v_cvt_pk_bf16_f32 v102, v7, v8
    v_perm_b32 v12, v102, v102, s41
    v_bitop3_b32 v60, v4, v12, v60 bitop3:0xca
    v_perm_b32 v13, v102, v102, s42
    v_bitop3_b32 v61, v4, v13, v61 bitop3:0xca
    v_mul_hi_u32_u24 v14, 429497, v62
    v_lshrrev_b32 v12, 3, v110
    v_cos_f32 v9, v9
    v_lshlrev_b16 v13, 3, v110
    v_mad_i32_i24 v11, v14, s55, v62
    v_bitop3_b32 v12, v6, v13, v12 bitop3:0xca
    v_add_lshl_u32 v11, v11, s40, 17
    v_lshlrev_b16 v14, 8, v14
    v_lshrrev_b32 v13, 2, v110
    v_or_b32 v62, v12, v11
    v_bitop3_b32 v110, v5, v13, v14 bitop3:0xea
    ds_add_u32 v110, v2
    v_mul_hi_u32_u24 v14, 429497, v63
    v_lshrrev_b32 v12, 3, v111
    v_cos_f32 v10, v10
    v_lshlrev_b16 v13, 3, v111
    v_mad_i32_i24 v11, v14, s55, v63
    v_bitop3_b32 v12, v6, v13, v12 bitop3:0xca
    v_add_lshl_u32 v11, v11, s40, 17
    v_lshlrev_b16 v14, 8, v14
    v_lshrrev_b32 v13, 2, v111
    v_or_b32 v63, v12, v11
    v_bitop3_b32 v111, v5, v13, v14 bitop3:0xea
    ds_add_u32 v111, v2
    v_cvt_pk_bf16_f32 v103, v9, v10
    v_perm_b32 v12, v103, v103, s41
    v_bitop3_b32 v62, v4, v12, v62 bitop3:0xca
    v_perm_b32 v13, v103, v103, s42
    v_bitop3_b32 v63, v4, v13, v63 bitop3:0xca
    s_add_u32 s47, s35, 0x548c000
    buffer_store_dwordx4 v[120:123], v0, s[20:23], s47 offen sc1
    s_add_u32 s44, s33, 0x8000000
    s_nop 0
    buffer_load_dwordx4 v[120:123], v0, s[12:15], s44 offen nt
    s_waitcnt vmcnt(8)
    v_lshlrev_b32 v7, 16, v104
    v_and_b32 v8, 0xffff0000, v104
    v_lshlrev_b32 v9, 16, v105
    v_and_b32 v10, 0xffff0000, v105
    v_mul_f32 v7, 0.15915494, v7
    v_mul_f32 v8, 0.15915494, v8
    v_mul_f32 v9, 0.15915494, v9
    v_mul_f32 v10, 0.15915494, v10
    v_mul_hi_u32_u24 v14, 429497, v112
    v_lshrrev_b32 v12, 3, v88
    v_cos_f32 v7, v7
    v_lshlrev_b16 v13, 3, v88
    v_mad_i32_i24 v11, v14, s55, v112
    v_bitop3_b32 v12, v6, v13, v12 bitop3:0xca
    v_add_lshl_u32 v11, v11, s40, 17
    v_lshlrev_b16 v14, 8, v14
    v_lshrrev_b32 v13, 2, v88
    v_or_b32 v112, v12, v11
    v_bitop3_b32 v88, v5, v13, v14 bitop3:0xea
    ds_add_u32 v88, v2
    v_mul_hi_u32_u24 v14, 429497, v113
    v_lshrrev_b32 v12, 3, v89
    v_cos_f32 v8, v8
    v_lshlrev_b16 v13, 3, v89
    v_mad_i32_i24 v11, v14, s55, v113
    v_bitop3_b32 v12, v6, v13, v12 bitop3:0xca
    v_add_lshl_u32 v11, v11, s40, 17
    v_lshlrev_b16 v14, 8, v14
    v_lshrrev_b32 v13, 2, v89
    v_or_b32 v113, v12, v11
    v_bitop3_b32 v89, v5, v13, v14 bitop3:0xea
    ds_add_u32 v89, v2
    v_cvt_pk_bf16_f32 v104, v7, v8
    v_perm_b32 v12, v104, v104, s41
    v_bitop3_b32 v112, v4, v12, v112 bitop3:0xca
    v_perm_b32 v13, v104, v104, s42
    v_bitop3_b32 v113, v4, v13, v113 bitop3:0xca
    v_mul_hi_u32_u24 v14, 429497, v114
    v_lshrrev_b32 v12, 3, v90
    v_cos_f32 v9, v9
    v_lshlrev_b16 v13, 3, v90
    v_mad_i32_i24 v11, v14, s55, v114
    v_bitop3_b32 v12, v6, v13, v12 bitop3:0xca
    v_add_lshl_u32 v11, v11, s40, 17
    v_lshlrev_b16 v14, 8, v14
    v_lshrrev_b32 v13, 2, v90
    v_or_b32 v114, v12, v11
    v_bitop3_b32 v90, v5, v13, v14 bitop3:0xea
    ds_add_u32 v90, v2
    v_mul_hi_u32_u24 v14, 429497, v115
    v_lshrrev_b32 v12, 3, v91
    v_cos_f32 v10, v10
    v_lshlrev_b16 v13, 3, v91
    v_mad_i32_i24 v11, v14, s55, v115
    v_bitop3_b32 v12, v6, v13, v12 bitop3:0xca
    v_add_lshl_u32 v11, v11, s40, 17
    v_lshlrev_b16 v14, 8, v14
    v_lshrrev_b32 v13, 2, v91
    v_or_b32 v115, v12, v11
    v_bitop3_b32 v91, v5, v13, v14 bitop3:0xea
    ds_add_u32 v91, v2
    v_cvt_pk_bf16_f32 v105, v9, v10
    v_perm_b32 v12, v105, v105, s41
    v_bitop3_b32 v114, v4, v12, v114 bitop3:0xca
    v_perm_b32 v13, v105, v105, s42
    v_bitop3_b32 v115, v4, v13, v115 bitop3:0xca
    s_waitcnt vmcnt(4)
    v_lshlrev_b32 v7, 16, v106
    v_and_b32 v8, 0xffff0000, v106
    v_lshlrev_b32 v9, 16, v107
    v_and_b32 v10, 0xffff0000, v107
    v_mul_f32 v7, 0.15915494, v7
    v_mul_f32 v8, 0.15915494, v8
    v_mul_f32 v9, 0.15915494, v9
    v_mul_f32 v10, 0.15915494, v10
    v_mul_hi_u32_u24 v14, 429497, v116
    v_lshrrev_b32 v12, 3, v92
    v_cos_f32 v7, v7
    v_lshlrev_b16 v13, 3, v92
    v_mad_i32_i24 v11, v14, s55, v116
    v_bitop3_b32 v12, v6, v13, v12 bitop3:0xca
    v_add_lshl_u32 v11, v11, s40, 17
    v_lshlrev_b16 v14, 8, v14
    v_lshrrev_b32 v13, 2, v92
    v_or_b32 v116, v12, v11
    v_bitop3_b32 v92, v5, v13, v14 bitop3:0xea
    ds_add_u32 v92, v2
    v_mul_hi_u32_u24 v14, 429497, v117
    v_lshrrev_b32 v12, 3, v93
    v_cos_f32 v8, v8
    v_lshlrev_b16 v13, 3, v93
    v_mad_i32_i24 v11, v14, s55, v117
    v_bitop3_b32 v12, v6, v13, v12 bitop3:0xca
    v_add_lshl_u32 v11, v11, s40, 17
    v_lshlrev_b16 v14, 8, v14
    v_lshrrev_b32 v13, 2, v93
    v_or_b32 v117, v12, v11
    v_bitop3_b32 v93, v5, v13, v14 bitop3:0xea
    ds_add_u32 v93, v2
    v_cvt_pk_bf16_f32 v106, v7, v8
    v_perm_b32 v12, v106, v106, s41
    v_bitop3_b32 v116, v4, v12, v116 bitop3:0xca
    v_perm_b32 v13, v106, v106, s42
    v_bitop3_b32 v117, v4, v13, v117 bitop3:0xca
    v_mul_hi_u32_u24 v14, 429497, v118
    v_lshrrev_b32 v12, 3, v94
    v_cos_f32 v9, v9
    v_lshlrev_b16 v13, 3, v94
    v_mad_i32_i24 v11, v14, s55, v118
    v_bitop3_b32 v12, v6, v13, v12 bitop3:0xca
    v_add_lshl_u32 v11, v11, s40, 17
    v_lshlrev_b16 v14, 8, v14
    v_lshrrev_b32 v13, 2, v94
    v_or_b32 v118, v12, v11
    v_bitop3_b32 v94, v5, v13, v14 bitop3:0xea
    ds_add_u32 v94, v2
    v_mul_hi_u32_u24 v14, 429497, v119
    v_lshrrev_b32 v12, 3, v95
    v_cos_f32 v10, v10
    v_lshlrev_b16 v13, 3, v95
    v_mad_i32_i24 v11, v14, s55, v119
    v_bitop3_b32 v12, v6, v13, v12 bitop3:0xca
    v_add_lshl_u32 v11, v11, s40, 17
    v_lshlrev_b16 v14, 8, v14
    v_lshrrev_b32 v13, 2, v95
    v_or_b32 v119, v12, v11
    v_bitop3_b32 v95, v5, v13, v14 bitop3:0xea
    ds_add_u32 v95, v2
    v_cvt_pk_bf16_f32 v107, v9, v10
    v_perm_b32 v12, v107, v107, s41
    v_bitop3_b32 v118, v4, v12, v118 bitop3:0xca
    v_perm_b32 v13, v107, v107, s42
    v_bitop3_b32 v119, v4, v13, v119 bitop3:0xca
    v_lshrrev_b32 v8, 2, v0
    v_and_b32 v7, 0x3c00, v0
    v_bitop3_b32 v7, v5, v8, v7 bitop3:0xea
    s_waitcnt lgkmcnt(0)
    s_barrier
    ds_read2st64_b32 v[8:9], v7 offset0:0 offset1:1
    ds_read2st64_b32 v[10:11], v7 offset0:2 offset1:3
    s_add_u32 s45, s35, 0x5490000
    buffer_store_dwordx4 v[44:47], v0, s[20:23], s45 offen sc1
    s_add_u32 s46, s34, 0x4000000
    s_nop 0
    buffer_load_dwordx2 v[44:45], v1, s[16:19], s46 offen nt
    s_add_u32 s47, s34, 0x4200000
    buffer_load_dwordx2 v[46:47], v1, s[16:19], s47 offen nt
    s_waitcnt lgkmcnt(0)
    v_lshl_or_b32 v12, v9, 16, v8
    v_lshl_or_b32 v13, v11, 16, v10
    v_mov_b32 v14, v12
    v_mov_b32 v15, v13
    s_nop 0
    v_add_u32_dpp v14, v14, v14 row_shr:1 row_mask:0xf bank_mask:0xf bound_ctrl:1
    v_add_u32_dpp v15, v15, v15 row_shr:1 row_mask:0xf bank_mask:0xf bound_ctrl:1
    s_nop 0
    v_add_u32_dpp v14, v14, v14 row_shr:2 row_mask:0xf bank_mask:0xf bound_ctrl:1
    v_add_u32_dpp v15, v15, v15 row_shr:2 row_mask:0xf bank_mask:0xf bound_ctrl:1
    s_nop 0
    v_add_u32_dpp v14, v14, v14 row_shr:4 row_mask:0xf bank_mask:0xf bound_ctrl:1
    v_add_u32_dpp v15, v15, v15 row_shr:4 row_mask:0xf bank_mask:0xf bound_ctrl:1
    s_nop 0
    v_add_u32_dpp v14, v14, v14 row_shr:8 row_mask:0xf bank_mask:0xf bound_ctrl:1
    v_add_u32_dpp v15, v15, v15 row_shr:8 row_mask:0xf bank_mask:0xf bound_ctrl:1
    s_nop 0
    v_add_u32_dpp v14, v14, v14 row_bcast:15 row_mask:0xa bank_mask:0xf
    v_add_u32_dpp v15, v15, v15 row_bcast:15 row_mask:0xa bank_mask:0xf
    s_nop 0
    v_add_u32_dpp v14, v14, v14 row_bcast:31 row_mask:0xc bank_mask:0xf
    v_add_u32_dpp v15, v15, v15 row_bcast:31 row_mask:0xc bank_mask:0xf
    v_readlane_b32 s48, v14, 63
    v_readlane_b32 s49, v15, 63
    s_lshl_b32 s54, s32, 2
    v_mov_b32 v8, s54
    s_and_b32 s50, s48, 0xffff
    s_lshr_b32 s51, s48, 16
    s_and_b32 s52, s49, 0xffff
    s_lshr_b32 s53, s49, 16
    s_add_u32 s51, s51, s50
    s_add_u32 s52, s52, s51
    s_add_u32 s53, s53, s52
    v_mov_b32 v9, s53
    s_mov_b64 exec, 1
    ds_write_b32 v8, v9 offset:16384
    s_waitcnt vmcnt(5)
    ds_write_b32 v8, v3 offset:16448
    s_mov_b64 exec, -1
    v_and_b32 v8, 60, v7
    s_waitcnt lgkmcnt(0)
    s_barrier
    ds_read_b32 v9, v8 offset:16384
    ds_read_b32 v10, v8 offset:16448
    s_waitcnt lgkmcnt(0)
    v_readlane_b32 s84, v10, 15
    s_min_u32 s4, s84, 136
    s_min_u32 s5, s84, 176
    s_min_u32 s6, s84, 216
    s_add_u32 s4, s4, s5
    s_add_u32 s4, s4, s6
    s_add_u32 s4, s4, 9467
    s_mov_b32 s4, s84
    s_lshl_b32 s58, s4, 14
    s_lshl_b32 s59, s4, 13
    s_mov_b32 s43, 5
    s_cmp_lt_u32 s84, 136
    s_addc_u32 s43, s43, 0
    s_cmp_lt_u32 s84, 176
    s_addc_u32 s43, s43, 0
    s_cmp_lt_u32 s84, 216
    s_addc_u32 s43, s43, 0
    v_add_u32_dpp v9, v9, v9 row_shr:1 row_mask:0xf bank_mask:0xf bound_ctrl:1
    s_nop 1
    v_add_u32_dpp v9, v9, v9 row_shr:2 row_mask:0xf bank_mask:0xf bound_ctrl:1
    s_nop 1
    v_add_u32_dpp v9, v9, v9 row_shr:4 row_mask:0xf bank_mask:0xf bound_ctrl:1
    s_nop 1
    v_add_u32_dpp v9, v9, v9 row_shr:8 row_mask:0xf bank_mask:0xf bound_ctrl:1
    s_nop 0
    v_readlane_b32 s54, v9, s32
    s_sub_u32 s54, s54, s53
    s_add_u32 s50, s50, s54
    s_add_u32 s51, s51, s54
    s_add_u32 s52, s52, s54
    s_pack_ll_b32_b16 s48, s54, s50
    s_pack_ll_b32_b16 s49, s51, s52
    v_add_u32 v14, s48, v14
    v_add_u32 v15, s49, v15
    v_sub_u32 v12, v14, v12
    v_sub_u32 v13, v15, v13
    v_and_b32 v8, 0xffff, v12
    v_lshrrev_b32 v9, 16, v12
    v_and_b32 v10, 0xffff, v13
    v_lshrrev_b32 v11, 16, v13
    ds_write2st64_b32 v7, v8, v9 offset0:0 offset1:1
    ds_write2st64_b32 v7, v10, v11 offset0:2 offset1:3
    s_waitcnt lgkmcnt(0)
    s_barrier
    ds_add_rtn_u32 v24, v24, v2
    ds_add_rtn_u32 v25, v25, v2
    ds_add_rtn_u32 v26, v26, v2
    ds_add_rtn_u32 v27, v27, v2
    s_add_u32 s44, s36, 0x7ec0000
    v_and_b32 v11, 0x3f0, v0
    v_add_u32 v11, v11, v11
    buffer_store_dwordx2 v[12:13], v11, s[24:27], s44 offen
    s_bitset0_b64 exec, 63
    s_not_b64 exec, exec
    buffer_store_dwordx2 v[14:15], v11, s[24:27], s44 offen offset:32
    s_mov_b64 exec, -1
    ds_add_rtn_u32 v52, v52, v2
    ds_add_rtn_u32 v53, v53, v2
    ds_add_rtn_u32 v54, v54, v2
    ds_add_rtn_u32 v55, v55, v2
    ds_add_rtn_u32 v72, v72, v2
    ds_add_rtn_u32 v73, v73, v2
    ds_add_rtn_u32 v74, v74, v2
    ds_add_rtn_u32 v75, v75, v2
    s_add_u32 s45, s35, 0x5494000
    buffer_store_dwordx4 v[20:23], v0, s[20:23], s45 offen sc1
    s_add_u32 s46, s33, 0x8400000
    s_nop 0
    buffer_load_dwordx4 v[20:23], v0, s[8:11], s46 offen nt
    ds_add_rtn_u32 v80, v80, v2
    ds_add_rtn_u32 v81, v81, v2
    ds_add_rtn_u32 v82, v82, v2
    ds_add_rtn_u32 v83, v83, v2
    ds_add_rtn_u32 v96, v96, v2
    ds_add_rtn_u32 v97, v97, v2
    ds_add_rtn_u32 v98, v98, v2
    ds_add_rtn_u32 v99, v99, v2
    ds_add_rtn_u32 v108, v108, v2
    ds_add_rtn_u32 v109, v109, v2
    ds_add_rtn_u32 v110, v110, v2
    ds_add_rtn_u32 v111, v111, v2
    s_add_u32 s47, s35, 0x5498000
    buffer_store_dwordx4 v[124:127], v0, s[20:23], s47 offen sc1
    s_add_u32 s44, s33, 0x8400000
    s_nop 0
    buffer_load_dwordx4 v[124:127], v0, s[12:15], s44 offen nt
    ds_add_rtn_u32 v88, v88, v2
    ds_add_rtn_u32 v89, v89, v2
    ds_add_rtn_u32 v90, v90, v2
    ds_add_rtn_u32 v91, v91, v2
    ds_add_rtn_u32 v92, v92, v2
    ds_add_rtn_u32 v93, v93, v2
    ds_add_rtn_u32 v94, v94, v2
    ds_add_rtn_u32 v95, v95, v2
    s_waitcnt lgkmcnt(0)
    s_barrier
    v_and_b32 v7, -4, v24
    v_lshl_add_u32 v8, v24, 2, v7
    ds_write_b32 v8, v40
    v_lshl_add_u32 v7, v7, 2, v24
    ds_write_b8 v7, v84 offset:16
    v_and_b32 v9, -4, v25
    v_lshl_add_u32 v10, v25, 2, v9
    ds_write_b32 v10, v41
    v_lshl_add_u32 v9, v9, 2, v25
    ds_write_b8_d16_hi v9, v84 offset:16
    v_and_b32 v7, -4, v26
    v_lshl_add_u32 v8, v26, 2, v7
    ds_write_b32 v8, v42
    v_lshl_add_u32 v7, v7, 2, v26
    ds_write_b8 v7, v85 offset:16
    v_and_b32 v9, -4, v27
    v_lshl_add_u32 v10, v27, 2, v9
    ds_write_b32 v10, v43
    v_lshl_add_u32 v9, v9, 2, v27
    ds_write_b8_d16_hi v9, v85 offset:16
    s_add_u32 s45, s35, 0x549c000
    buffer_store_dwordx4 v[32:35], v0, s[20:23], s45 offen sc1
    s_add_u32 s46, s33, 0x8800000
    buffer_load_dwordx4 v[40:43], v0, s[8:11], s46 offen nt
    s_add_u32 s47, s33, 0x8800000
    buffer_load_dwordx4 v[24:27], v0, s[12:15], s47 offen nt
    v_and_b32 v7, -4, v52
    v_lshl_add_u32 v8, v52, 2, v7
    ds_write_b32 v8, v48
    v_lshl_add_u32 v7, v7, 2, v52
    ds_write_b8 v7, v86 offset:16
    v_and_b32 v9, -4, v53
    v_lshl_add_u32 v10, v53, 2, v9
    ds_write_b32 v10, v49
    v_lshl_add_u32 v9, v9, 2, v53
    ds_write_b8_d16_hi v9, v86 offset:16
    v_and_b32 v7, -4, v54
    v_lshl_add_u32 v8, v54, 2, v7
    ds_write_b32 v8, v50
    v_lshl_add_u32 v7, v7, 2, v54
    ds_write_b8 v7, v87 offset:16
    v_and_b32 v9, -4, v55
    v_lshl_add_u32 v10, v55, 2, v9
    ds_write_b32 v10, v51
    v_lshl_add_u32 v9, v9, 2, v55
    ds_write_b8_d16_hi v9, v87 offset:16
    s_add_u32 s44, s34, 0x4400000
    buffer_load_dwordx2 v[32:33], v1, s[16:19], s44 offen nt
    s_add_u32 s45, s34, 0x4600000
    buffer_load_dwordx2 v[34:35], v1, s[16:19], s45 offen nt
    s_add_u32 s46, s33, 0x8c00000
    buffer_load_dwordx4 v[48:51], v0, s[8:11], s46 offen nt
    v_and_b32 v7, -4, v72
    v_lshl_add_u32 v8, v72, 2, v7
    ds_write_b32 v8, v68
    v_lshl_add_u32 v7, v7, 2, v72
    ds_write_b8 v7, v56 offset:16
    v_and_b32 v9, -4, v73
    v_lshl_add_u32 v10, v73, 2, v9
    ds_write_b32 v10, v69
    v_lshl_add_u32 v9, v9, 2, v73
    ds_write_b8_d16_hi v9, v56 offset:16
    v_and_b32 v7, -4, v74
    v_lshl_add_u32 v8, v74, 2, v7
    ds_write_b32 v8, v70
    v_lshl_add_u32 v7, v7, 2, v74
    ds_write_b8 v7, v57 offset:16
    v_and_b32 v9, -4, v75
    v_lshl_add_u32 v10, v75, 2, v9
    ds_write_b32 v10, v71
    v_lshl_add_u32 v9, v9, 2, v75
    ds_write_b8_d16_hi v9, v57 offset:16
    s_add_u32 s47, s35, 0x54a0000
    buffer_store_dwordx4 v[36:39], v0, s[20:23], s47 offen sc1
    s_add_u32 s44, s33, 0x8c00000
    buffer_load_dwordx4 v[52:55], v0, s[12:15], s44 offen nt
    v_and_b32 v7, -4, v80
    v_lshl_add_u32 v8, v80, 2, v7
    ds_write_b32 v8, v76
    v_lshl_add_u32 v7, v7, 2, v80
    ds_write_b8 v7, v58 offset:16
    v_and_b32 v9, -4, v81
    v_lshl_add_u32 v10, v81, 2, v9
    ds_write_b32 v10, v77
    v_lshl_add_u32 v9, v9, 2, v81
    ds_write_b8_d16_hi v9, v58 offset:16
    v_and_b32 v7, -4, v82
    v_lshl_add_u32 v8, v82, 2, v7
    ds_write_b32 v8, v78
    v_lshl_add_u32 v7, v7, 2, v82
    ds_write_b8 v7, v59 offset:16
    v_and_b32 v9, -4, v83
    v_lshl_add_u32 v10, v83, 2, v9
    ds_write_b32 v10, v79
    v_lshl_add_u32 v9, v9, 2, v83
    ds_write_b8_d16_hi v9, v59 offset:16
    s_add_u32 s45, s33, 0x9000000
    buffer_load_dwordx4 v[84:87], v0, s[8:11], s45 offen nt
    s_add_u32 s46, s33, 0x9000000
    buffer_load_dwordx4 v[68:71], v0, s[12:15], s46 offen nt
    v_and_b32 v7, -4, v96
    v_lshl_add_u32 v8, v96, 2, v7
    ds_write_b32 v8, v64
    v_lshl_add_u32 v7, v7, 2, v96
    ds_write_b8 v7, v100 offset:16
    v_and_b32 v9, -4, v97
    v_lshl_add_u32 v10, v97, 2, v9
    ds_write_b32 v10, v65
    v_lshl_add_u32 v9, v9, 2, v97
    ds_write_b8_d16_hi v9, v100 offset:16
    v_and_b32 v7, -4, v98
    v_lshl_add_u32 v8, v98, 2, v7
    ds_write_b32 v8, v66
    v_lshl_add_u32 v7, v7, 2, v98
    ds_write_b8 v7, v101 offset:16
    v_and_b32 v9, -4, v99
    v_lshl_add_u32 v10, v99, 2, v9
    ds_write_b32 v10, v67
    v_lshl_add_u32 v9, v9, 2, v99
    ds_write_b8_d16_hi v9, v101 offset:16
    s_add_u32 s47, s34, 0x4800000
    buffer_load_dwordx2 v[72:73], v1, s[16:19], s47 offen nt
    s_cmp_le_u32 s43, 5
    s_cselect_b32 s18, 0, s18
    s_add_u32 s44, s59, 0x4a00000
    buffer_load_dwordx2 v[74:75], v1, s[16:19], s44 offen nt
    s_cmp_le_u32 s43, 5
    s_cselect_b32 s10, 0, s10
    s_add_u32 s45, s58, 0x9400000
    buffer_load_dwordx4 v[36:39], v0, s[8:11], s45 offen nt
    v_and_b32 v7, -4, v108
    v_lshl_add_u32 v8, v108, 2, v7
    ds_write_b32 v8, v60
    v_lshl_add_u32 v7, v7, 2, v108
    ds_write_b8 v7, v102 offset:16
    v_and_b32 v9, -4, v109
    v_lshl_add_u32 v10, v109, 2, v9
    ds_write_b32 v10, v61
    v_lshl_add_u32 v9, v9, 2, v109
    ds_write_b8_d16_hi v9, v102 offset:16
    v_and_b32 v7, -4, v110
    v_lshl_add_u32 v8, v110, 2, v7
    ds_write_b32 v8, v62
    v_lshl_add_u32 v7, v7, 2, v110
    ds_write_b8 v7, v103 offset:16
    v_and_b32 v9, -4, v111
    v_lshl_add_u32 v10, v111, 2, v9
    ds_write_b32 v10, v63
    v_lshl_add_u32 v9, v9, 2, v111
    ds_write_b8_d16_hi v9, v103 offset:16
    s_add_u32 s46, s35, 0x54a4000
    buffer_store_dwordx4 v[28:31], v0, s[20:23], s46 offen sc1
    s_cmp_le_u32 s43, 5
    s_cselect_b32 s14, 0, s14
    s_add_u32 s47, s58, 0x9400000
    buffer_load_dwordx4 v[76:79], v0, s[12:15], s47 offen nt
    v_and_b32 v7, -4, v88
    v_lshl_add_u32 v8, v88, 2, v7
    ds_write_b32 v8, v112
    v_lshl_add_u32 v7, v7, 2, v88
    ds_write_b8 v7, v104 offset:16
    v_and_b32 v9, -4, v89
    v_lshl_add_u32 v10, v89, 2, v9
    ds_write_b32 v10, v113
    v_lshl_add_u32 v9, v9, 2, v89
    ds_write_b8_d16_hi v9, v104 offset:16
    v_and_b32 v7, -4, v90
    v_lshl_add_u32 v8, v90, 2, v7
    ds_write_b32 v8, v114
    v_lshl_add_u32 v7, v7, 2, v90
    ds_write_b8 v7, v105 offset:16
    v_and_b32 v9, -4, v91
    v_lshl_add_u32 v10, v91, 2, v9
    ds_write_b32 v10, v115
    v_lshl_add_u32 v9, v9, 2, v91
    ds_write_b8_d16_hi v9, v105 offset:16
    s_cmp_le_u32 s43, 6
    s_cselect_b32 s10, 0, s10
    s_add_u32 s44, s58, 0x9760000
    buffer_load_dwordx4 v[80:83], v0, s[8:11], s44 offen nt
    s_cmp_le_u32 s43, 6
    s_cselect_b32 s14, 0, s14
    s_add_u32 s45, s58, 0x9760000
    buffer_load_dwordx4 v[56:59], v0, s[12:15], s45 offen nt
    v_and_b32 v7, -4, v92
    v_lshl_add_u32 v8, v92, 2, v7
    ds_write_b32 v8, v116
    v_lshl_add_u32 v7, v7, 2, v92
    ds_write_b8 v7, v106 offset:16
    v_and_b32 v9, -4, v93
    v_lshl_add_u32 v10, v93, 2, v9
    ds_write_b32 v10, v117
    v_lshl_add_u32 v9, v9, 2, v93
    ds_write_b8_d16_hi v9, v106 offset:16
    v_and_b32 v7, -4, v94
    v_lshl_add_u32 v8, v94, 2, v7
    ds_write_b32 v8, v118
    v_lshl_add_u32 v7, v7, 2, v94
    ds_write_b8 v7, v107 offset:16
    v_and_b32 v9, -4, v95
    v_lshl_add_u32 v10, v95, 2, v9
    ds_write_b32 v10, v119
    v_lshl_add_u32 v9, v9, 2, v95
    ds_write_b8_d16_hi v9, v107 offset:16
    s_cmp_le_u32 s43, 6
    s_cselect_b32 s18, 0, s18
    s_add_u32 s46, s59, 0x4bb0000
    buffer_load_dwordx2 v[64:65], v1, s[16:19], s46 offen nt
    s_cmp_le_u32 s43, 7
    s_cselect_b32 s18, 0, s18
    s_add_u32 s47, s59, 0x4d10000
    buffer_load_dwordx2 v[66:67], v1, s[16:19], s47 offen nt
    v_add_u32 v7, 0x10000, v0
    v_add_u32 v12, 0x20000, v0
    v_mov_b32 v8, 0
    v_mov_b32 v9, 0
    v_mov_b32 v10, 0
    v_mov_b32 v11, 0
    s_waitcnt lgkmcnt(0)
    s_barrier
    ds_read_b128 v[96:99], v0 offset:0
    ds_write_b128 v0, v[8:11]
    ds_read_b128 v[60:63], v0 offset:16384
    ds_read_b128 v[108:111], v0 offset:32768
    ds_read_b128 v[100:103], v0 offset:49152
    ds_read_b128 v[28:31], v7 offset:0
    ds_read_b128 v[112:115], v7 offset:16384
    ds_read_b128 v[88:91], v7 offset:32768
    ds_read_b128 v[116:119], v7 offset:49152
    ds_read_b128 v[92:95], v12 offset:0
    ds_read_b128 v[104:107], v12 offset:16384
    s_waitcnt lgkmcnt(0)
    s_barrier
    s_add_u32 s44, s35, 0x7ec0000
    buffer_store_dwordx4 v[96:99], v0, s[20:23], s44 offen sc1
    s_cmp_le_u32 s43, 7
    s_cselect_b32 s10, 0, s10
    s_add_u32 s45, s58, 0x9a20000
    buffer_load_dwordx4 v[96:99], v0, s[8:11], s45 offen nt
    s_add_u32 s46, s35, 0x7ec4000
    buffer_store_dwordx4 v[60:63], v0, s[20:23], s46 offen sc1
    s_cmp_le_u32 s43, 7
    s_cselect_b32 s14, 0, s14
    s_add_u32 s47, s58, 0x9a20000
    buffer_load_dwordx4 v[60:63], v0, s[12:15], s47 offen nt
    s_waitcnt vmcnt(29)
    v_lshlrev_b32 v7, 16, v44
    v_and_b32 v8, 0xffff0000, v44
    v_lshlrev_b32 v9, 16, v45
    v_and_b32 v10, 0xffff0000, v45
    v_mul_f32 v7, 0.15915494, v7
    v_mul_f32 v8, 0.15915494, v8
    v_mul_f32 v9, 0.15915494, v9
    v_mul_f32 v10, 0.15915494, v10
    v_mul_hi_u32_u24 v14, 429497, v16
    v_lshrrev_b32 v12, 3, v120
    v_cos_f32 v7, v7
    v_lshlrev_b16 v13, 3, v120
    v_mad_i32_i24 v11, v14, s55, v16
    v_bitop3_b32 v12, v6, v13, v12 bitop3:0xca
    v_add_lshl_u32 v11, v11, s40, 17
    v_lshlrev_b16 v14, 8, v14
    v_lshrrev_b32 v13, 2, v120
    v_or_b32 v16, v12, v11
    v_bitop3_b32 v120, v5, v13, v14 bitop3:0xea
    ds_add_u32 v120, v2
    v_mul_hi_u32_u24 v14, 429497, v17
    v_lshrrev_b32 v12, 3, v121
    v_cos_f32 v8, v8
    v_lshlrev_b16 v13, 3, v121
    v_mad_i32_i24 v11, v14, s55, v17
    v_bitop3_b32 v12, v6, v13, v12 bitop3:0xca
    v_add_lshl_u32 v11, v11, s40, 17
    v_lshlrev_b16 v14, 8, v14
    v_lshrrev_b32 v13, 2, v121
    v_or_b32 v17, v12, v11
    v_bitop3_b32 v121, v5, v13, v14 bitop3:0xea
    ds_add_u32 v121, v2
    v_cvt_pk_bf16_f32 v44, v7, v8
    v_perm_b32 v12, v44, v44, s41
    v_bitop3_b32 v16, v4, v12, v16 bitop3:0xca
    v_perm_b32 v13, v44, v44, s42
    v_bitop3_b32 v17, v4, v13, v17 bitop3:0xca
    v_mul_hi_u32_u24 v14, 429497, v18
    v_lshrrev_b32 v12, 3, v122
    v_cos_f32 v9, v9
    v_lshlrev_b16 v13, 3, v122
    v_mad_i32_i24 v11, v14, s55, v18
    v_bitop3_b32 v12, v6, v13, v12 bitop3:0xca
    v_add_lshl_u32 v11, v11, s40, 17
    v_lshlrev_b16 v14, 8, v14
    v_lshrrev_b32 v13, 2, v122
    v_or_b32 v18, v12, v11
    v_bitop3_b32 v122, v5, v13, v14 bitop3:0xea
    ds_add_u32 v122, v2
    v_mul_hi_u32_u24 v14, 429497, v19
    v_lshrrev_b32 v12, 3, v123
    v_cos_f32 v10, v10
    v_lshlrev_b16 v13, 3, v123
    v_mad_i32_i24 v11, v14, s55, v19
    v_bitop3_b32 v12, v6, v13, v12 bitop3:0xca
    v_add_lshl_u32 v11, v11, s40, 17
    v_lshlrev_b16 v14, 8, v14
    v_lshrrev_b32 v13, 2, v123
    v_or_b32 v19, v12, v11
    v_bitop3_b32 v123, v5, v13, v14 bitop3:0xea
    ds_add_u32 v123, v2
    v_cvt_pk_bf16_f32 v45, v9, v10
    v_perm_b32 v12, v45, v45, s41
    v_bitop3_b32 v18, v4, v12, v18 bitop3:0xca
    v_perm_b32 v13, v45, v45, s42
    v_bitop3_b32 v19, v4, v13, v19 bitop3:0xca
    s_add_u32 s44, s35, 0x7ec8000
    buffer_store_dwordx4 v[108:111], v0, s[20:23], s44 offen sc1
    s_waitcnt vmcnt(24)
    v_lshlrev_b32 v7, 16, v46
    v_and_b32 v8, 0xffff0000, v46
    v_lshlrev_b32 v9, 16, v47
    v_and_b32 v10, 0xffff0000, v47
    v_mul_f32 v7, 0.15915494, v7
    v_mul_f32 v8, 0.15915494, v8
    v_mul_f32 v9, 0.15915494, v9
    v_mul_f32 v10, 0.15915494, v10
    v_mul_hi_u32_u24 v14, 429497, v20
    v_lshrrev_b32 v12, 3, v124
    v_cos_f32 v7, v7
    v_lshlrev_b16 v13, 3, v124
    v_mad_i32_i24 v11, v14, s55, v20
    v_bitop3_b32 v12, v6, v13, v12 bitop3:0xca
    v_add_lshl_u32 v11, v11, s40, 17
    v_lshlrev_b16 v14, 8, v14
    v_lshrrev_b32 v13, 2, v124
    v_or_b32 v20, v12, v11
    v_bitop3_b32 v124, v5, v13, v14 bitop3:0xea
    ds_add_u32 v124, v2
    v_mul_hi_u32_u24 v14, 429497, v21
    v_lshrrev_b32 v12, 3, v125
    v_cos_f32 v8, v8
    v_lshlrev_b16 v13, 3, v125
    v_mad_i32_i24 v11, v14, s55, v21
    v_bitop3_b32 v12, v6, v13, v12 bitop3:0xca
    v_add_lshl_u32 v11, v11, s40, 17
    v_lshlrev_b16 v14, 8, v14
    v_lshrrev_b32 v13, 2, v125
    v_or_b32 v21, v12, v11
    v_bitop3_b32 v125, v5, v13, v14 bitop3:0xea
    ds_add_u32 v125, v2
    v_cvt_pk_bf16_f32 v46, v7, v8
    v_perm_b32 v12, v46, v46, s41
    v_bitop3_b32 v20, v4, v12, v20 bitop3:0xca
    v_perm_b32 v13, v46, v46, s42
    v_bitop3_b32 v21, v4, v13, v21 bitop3:0xca
    v_mul_hi_u32_u24 v14, 429497, v22
    v_lshrrev_b32 v12, 3, v126
    v_cos_f32 v9, v9
    v_lshlrev_b16 v13, 3, v126
    v_mad_i32_i24 v11, v14, s55, v22
    v_bitop3_b32 v12, v6, v13, v12 bitop3:0xca
    v_add_lshl_u32 v11, v11, s40, 17
    v_lshlrev_b16 v14, 8, v14
    v_lshrrev_b32 v13, 2, v126
    v_or_b32 v22, v12, v11
    v_bitop3_b32 v126, v5, v13, v14 bitop3:0xea
    ds_add_u32 v126, v2
    v_mul_hi_u32_u24 v14, 429497, v23
    v_lshrrev_b32 v12, 3, v127
    v_cos_f32 v10, v10
    v_lshlrev_b16 v13, 3, v127
    v_mad_i32_i24 v11, v14, s55, v23
    v_bitop3_b32 v12, v6, v13, v12 bitop3:0xca
    v_add_lshl_u32 v11, v11, s40, 17
    v_lshlrev_b16 v14, 8, v14
    v_lshrrev_b32 v13, 2, v127
    v_or_b32 v23, v12, v11
    v_bitop3_b32 v127, v5, v13, v14 bitop3:0xea
    ds_add_u32 v127, v2
    v_cvt_pk_bf16_f32 v47, v9, v10
    v_perm_b32 v12, v47, v47, s41
    v_bitop3_b32 v22, v4, v12, v22 bitop3:0xca
    v_perm_b32 v13, v47, v47, s42
    v_bitop3_b32 v23, v4, v13, v23 bitop3:0xca
    s_waitcnt vmcnt(19)
    v_lshlrev_b32 v7, 16, v32
    v_and_b32 v8, 0xffff0000, v32
    v_lshlrev_b32 v9, 16, v33
    v_and_b32 v10, 0xffff0000, v33
    v_mul_f32 v7, 0.15915494, v7
    v_mul_f32 v8, 0.15915494, v8
    v_mul_f32 v9, 0.15915494, v9
    v_mul_f32 v10, 0.15915494, v10
    v_mul_hi_u32_u24 v14, 429497, v40
    v_lshrrev_b32 v12, 3, v24
    v_cos_f32 v7, v7
    v_lshlrev_b16 v13, 3, v24
    v_mad_i32_i24 v11, v14, s55, v40
    v_bitop3_b32 v12, v6, v13, v12 bitop3:0xca
    v_add_lshl_u32 v11, v11, s40, 17
    v_lshlrev_b16 v14, 8, v14
    v_lshrrev_b32 v13, 2, v24
    v_or_b32 v40, v12, v11
    v_bitop3_b32 v24, v5, v13, v14 bitop3:0xea
    ds_add_u32 v24, v2
    v_mul_hi_u32_u24 v14, 429497, v41
    v_lshrrev_b32 v12, 3, v25
    v_cos_f32 v8, v8
    v_lshlrev_b16 v13, 3, v25
    v_mad_i32_i24 v11, v14, s55, v41
    v_bitop3_b32 v12, v6, v13, v12 bitop3:0xca
    v_add_lshl_u32 v11, v11, s40, 17
    v_lshlrev_b16 v14, 8, v14
    v_lshrrev_b32 v13, 2, v25
    v_or_b32 v41, v12, v11
    v_bitop3_b32 v25, v5, v13, v14 bitop3:0xea
    ds_add_u32 v25, v2
    v_cvt_pk_bf16_f32 v32, v7, v8
    v_perm_b32 v12, v32, v32, s41
    v_bitop3_b32 v40, v4, v12, v40 bitop3:0xca
    v_perm_b32 v13, v32, v32, s42
    v_bitop3_b32 v41, v4, v13, v41 bitop3:0xca
    v_mul_hi_u32_u24 v14, 429497, v42
    v_lshrrev_b32 v12, 3, v26
    v_cos_f32 v9, v9
    v_lshlrev_b16 v13, 3, v26
    v_mad_i32_i24 v11, v14, s55, v42
    v_bitop3_b32 v12, v6, v13, v12 bitop3:0xca
    v_add_lshl_u32 v11, v11, s40, 17
    v_lshlrev_b16 v14, 8, v14
    v_lshrrev_b32 v13, 2, v26
    v_or_b32 v42, v12, v11
    v_bitop3_b32 v26, v5, v13, v14 bitop3:0xea
    ds_add_u32 v26, v2
    v_mul_hi_u32_u24 v14, 429497, v43
    v_lshrrev_b32 v12, 3, v27
    v_cos_f32 v10, v10
    v_lshlrev_b16 v13, 3, v27
    v_mad_i32_i24 v11, v14, s55, v43
    v_bitop3_b32 v12, v6, v13, v12 bitop3:0xca
    v_add_lshl_u32 v11, v11, s40, 17
    v_lshlrev_b16 v14, 8, v14
    v_lshrrev_b32 v13, 2, v27
    v_or_b32 v43, v12, v11
    v_bitop3_b32 v27, v5, v13, v14 bitop3:0xea
    ds_add_u32 v27, v2
    v_cvt_pk_bf16_f32 v33, v9, v10
    v_perm_b32 v12, v33, v33, s41
    v_bitop3_b32 v42, v4, v12, v42 bitop3:0xca
    v_perm_b32 v13, v33, v33, s42
    v_bitop3_b32 v43, v4, v13, v43 bitop3:0xca
    s_waitcnt vmcnt(16)
    v_lshlrev_b32 v7, 16, v34
    v_and_b32 v8, 0xffff0000, v34
    v_lshlrev_b32 v9, 16, v35
    v_and_b32 v10, 0xffff0000, v35
    v_mul_f32 v7, 0.15915494, v7
    v_mul_f32 v8, 0.15915494, v8
    v_mul_f32 v9, 0.15915494, v9
    v_mul_f32 v10, 0.15915494, v10
    v_mul_hi_u32_u24 v14, 429497, v48
    v_lshrrev_b32 v12, 3, v52
    v_cos_f32 v7, v7
    v_lshlrev_b16 v13, 3, v52
    v_mad_i32_i24 v11, v14, s55, v48
    v_bitop3_b32 v12, v6, v13, v12 bitop3:0xca
    v_add_lshl_u32 v11, v11, s40, 17
    v_lshlrev_b16 v14, 8, v14
    v_lshrrev_b32 v13, 2, v52
    v_or_b32 v48, v12, v11
    v_bitop3_b32 v52, v5, v13, v14 bitop3:0xea
    ds_add_u32 v52, v2
    v_mul_hi_u32_u24 v14, 429497, v49
    v_lshrrev_b32 v12, 3, v53
    v_cos_f32 v8, v8
    v_lshlrev_b16 v13, 3, v53
    v_mad_i32_i24 v11, v14, s55, v49
    v_bitop3_b32 v12, v6, v13, v12 bitop3:0xca
    v_add_lshl_u32 v11, v11, s40, 17
    v_lshlrev_b16 v14, 8, v14
    v_lshrrev_b32 v13, 2, v53
    v_or_b32 v49, v12, v11
    v_bitop3_b32 v53, v5, v13, v14 bitop3:0xea
    ds_add_u32 v53, v2
    v_cvt_pk_bf16_f32 v34, v7, v8
    v_perm_b32 v12, v34, v34, s41
    v_bitop3_b32 v48, v4, v12, v48 bitop3:0xca
    v_perm_b32 v13, v34, v34, s42
    v_bitop3_b32 v49, v4, v13, v49 bitop3:0xca
    v_mul_hi_u32_u24 v14, 429497, v50
    v_lshrrev_b32 v12, 3, v54
    v_cos_f32 v9, v9
    v_lshlrev_b16 v13, 3, v54
    v_mad_i32_i24 v11, v14, s55, v50
    v_bitop3_b32 v12, v6, v13, v12 bitop3:0xca
    v_add_lshl_u32 v11, v11, s40, 17
    v_lshlrev_b16 v14, 8, v14
    v_lshrrev_b32 v13, 2, v54
    v_or_b32 v50, v12, v11
    v_bitop3_b32 v54, v5, v13, v14 bitop3:0xea
    ds_add_u32 v54, v2
    v_mul_hi_u32_u24 v14, 429497, v51
    v_lshrrev_b32 v12, 3, v55
    v_cos_f32 v10, v10
    v_lshlrev_b16 v13, 3, v55
    v_mad_i32_i24 v11, v14, s55, v51
    v_bitop3_b32 v12, v6, v13, v12 bitop3:0xca
    v_add_lshl_u32 v11, v11, s40, 17
    v_lshlrev_b16 v14, 8, v14
    v_lshrrev_b32 v13, 2, v55
    v_or_b32 v51, v12, v11
    v_bitop3_b32 v55, v5, v13, v14 bitop3:0xea
    ds_add_u32 v55, v2
    v_cvt_pk_bf16_f32 v35, v9, v10
    v_perm_b32 v12, v35, v35, s41
    v_bitop3_b32 v50, v4, v12, v50 bitop3:0xca
    v_perm_b32 v13, v35, v35, s42
    v_bitop3_b32 v51, v4, v13, v51 bitop3:0xca
    s_add_u32 s45, s35, 0x7ecc000
    buffer_store_dwordx4 v[100:103], v0, s[20:23], s45 offen sc1
    buffer_load_dwordx4 v[108:111], v0, s[80:83], 0 offen
    v_add_u32 v15, 0x4000, v0
    buffer_load_dwordx4 v[108:111], v15, s[80:83], 0 offen
    s_waitcnt vmcnt(15)
    v_lshlrev_b32 v7, 16, v72
    v_and_b32 v8, 0xffff0000, v72
    v_lshlrev_b32 v9, 16, v73
    v_and_b32 v10, 0xffff0000, v73
    v_mul_f32 v7, 0.15915494, v7
    v_mul_f32 v8, 0.15915494, v8
    v_mul_f32 v9, 0.15915494, v9
    v_mul_f32 v10, 0.15915494, v10
    v_mul_hi_u32_u24 v14, 429497, v84
    v_lshrrev_b32 v12, 3, v68
    v_cos_f32 v7, v7
    v_lshlrev_b16 v13, 3, v68
    v_mad_i32_i24 v11, v14, s55, v84
    v_bitop3_b32 v12, v6, v13, v12 bitop3:0xca
    v_add_lshl_u32 v11, v11, s40, 17
    v_lshlrev_b16 v14, 8, v14
    v_lshrrev_b32 v13, 2, v68
    v_or_b32 v84, v12, v11
    v_bitop3_b32 v68, v5, v13, v14 bitop3:0xea
    ds_add_u32 v68, v2
    v_mul_hi_u32_u24 v14, 429497, v85
    v_lshrrev_b32 v12, 3, v69
    v_cos_f32 v8, v8
    v_lshlrev_b16 v13, 3, v69
    v_mad_i32_i24 v11, v14, s55, v85
    v_bitop3_b32 v12, v6, v13, v12 bitop3:0xca
    v_add_lshl_u32 v11, v11, s40, 17
    v_lshlrev_b16 v14, 8, v14
    v_lshrrev_b32 v13, 2, v69
    v_or_b32 v85, v12, v11
    v_bitop3_b32 v69, v5, v13, v14 bitop3:0xea
    ds_add_u32 v69, v2
    v_cvt_pk_bf16_f32 v72, v7, v8
    v_perm_b32 v12, v72, v72, s41
    v_bitop3_b32 v84, v4, v12, v84 bitop3:0xca
    v_perm_b32 v13, v72, v72, s42
    v_bitop3_b32 v85, v4, v13, v85 bitop3:0xca
    v_mul_hi_u32_u24 v14, 429497, v86
    v_lshrrev_b32 v12, 3, v70
    v_cos_f32 v9, v9
    v_lshlrev_b16 v13, 3, v70
    v_mad_i32_i24 v11, v14, s55, v86
    v_bitop3_b32 v12, v6, v13, v12 bitop3:0xca
    v_add_lshl_u32 v11, v11, s40, 17
    v_lshlrev_b16 v14, 8, v14
    v_lshrrev_b32 v13, 2, v70
    v_or_b32 v86, v12, v11
    v_bitop3_b32 v70, v5, v13, v14 bitop3:0xea
    ds_add_u32 v70, v2
    v_mul_hi_u32_u24 v14, 429497, v87
    v_lshrrev_b32 v12, 3, v71
    v_cos_f32 v10, v10
    v_lshlrev_b16 v13, 3, v71
    v_mad_i32_i24 v11, v14, s55, v87
    v_bitop3_b32 v12, v6, v13, v12 bitop3:0xca
    v_add_lshl_u32 v11, v11, s40, 17
    v_lshlrev_b16 v14, 8, v14
    v_lshrrev_b32 v13, 2, v71
    v_or_b32 v87, v12, v11
    v_bitop3_b32 v71, v5, v13, v14 bitop3:0xea
    ds_add_u32 v71, v2
    v_cvt_pk_bf16_f32 v73, v9, v10
    v_perm_b32 v12, v73, v73, s41
    v_bitop3_b32 v86, v4, v12, v86 bitop3:0xca
    v_perm_b32 v13, v73, v73, s42
    v_bitop3_b32 v87, v4, v13, v87 bitop3:0xca
    s_waitcnt vmcnt(12)
    s_cmp_le_u32 s43, 5
    s_cbranch_scc1 L1_s1
    v_lshlrev_b32 v7, 16, v74
    v_and_b32 v8, 0xffff0000, v74
    v_lshlrev_b32 v9, 16, v75
    v_and_b32 v10, 0xffff0000, v75
    v_mul_f32 v7, 0.15915494, v7
    v_mul_f32 v8, 0.15915494, v8
    v_mul_f32 v9, 0.15915494, v9
    v_mul_f32 v10, 0.15915494, v10
    v_mul_hi_u32_u24 v14, 429497, v36
    v_lshrrev_b32 v12, 3, v76
    v_cos_f32 v7, v7
    v_lshlrev_b16 v13, 3, v76
    v_mad_i32_i24 v11, v14, s55, v36
    v_bitop3_b32 v12, v6, v13, v12 bitop3:0xca
    v_add_lshl_u32 v11, v11, s40, 17
    v_lshlrev_b16 v14, 8, v14
    v_lshrrev_b32 v13, 2, v76
    v_or_b32 v36, v12, v11
    v_bitop3_b32 v76, v5, v13, v14 bitop3:0xea
    ds_add_u32 v76, v2
    v_mul_hi_u32_u24 v14, 429497, v37
    v_lshrrev_b32 v12, 3, v77
    v_cos_f32 v8, v8
    v_lshlrev_b16 v13, 3, v77
    v_mad_i32_i24 v11, v14, s55, v37
    v_bitop3_b32 v12, v6, v13, v12 bitop3:0xca
    v_add_lshl_u32 v11, v11, s40, 17
    v_lshlrev_b16 v14, 8, v14
    v_lshrrev_b32 v13, 2, v77
    v_or_b32 v37, v12, v11
    v_bitop3_b32 v77, v5, v13, v14 bitop3:0xea
    ds_add_u32 v77, v2
    v_cvt_pk_bf16_f32 v74, v7, v8
    v_perm_b32 v12, v74, v74, s41
    v_bitop3_b32 v36, v4, v12, v36 bitop3:0xca
    v_perm_b32 v13, v74, v74, s42
    v_bitop3_b32 v37, v4, v13, v37 bitop3:0xca
    v_mul_hi_u32_u24 v14, 429497, v38
    v_lshrrev_b32 v12, 3, v78
    v_cos_f32 v9, v9
    v_lshlrev_b16 v13, 3, v78
    v_mad_i32_i24 v11, v14, s55, v38
    v_bitop3_b32 v12, v6, v13, v12 bitop3:0xca
    v_add_lshl_u32 v11, v11, s40, 17
    v_lshlrev_b16 v14, 8, v14
    v_lshrrev_b32 v13, 2, v78
    v_or_b32 v38, v12, v11
    v_bitop3_b32 v78, v5, v13, v14 bitop3:0xea
    ds_add_u32 v78, v2
    v_mul_hi_u32_u24 v14, 429497, v39
    v_lshrrev_b32 v12, 3, v79
    v_cos_f32 v10, v10
    v_lshlrev_b16 v13, 3, v79
    v_mad_i32_i24 v11, v14, s55, v39
    v_bitop3_b32 v12, v6, v13, v12 bitop3:0xca
    v_add_lshl_u32 v11, v11, s40, 17
    v_lshlrev_b16 v14, 8, v14
    v_lshrrev_b32 v13, 2, v79
    v_or_b32 v39, v12, v11
    v_bitop3_b32 v79, v5, v13, v14 bitop3:0xea
    ds_add_u32 v79, v2
    v_cvt_pk_bf16_f32 v75, v9, v10
    v_perm_b32 v12, v75, v75, s41
    v_bitop3_b32 v38, v4, v12, v38 bitop3:0xca
    v_perm_b32 v13, v75, v75, s42
    v_bitop3_b32 v39, v4, v13, v39 bitop3:0xca
L1_s1:
    s_waitcnt vmcnt(8)
    s_cmp_le_u32 s43, 6
    s_cbranch_scc1 L1_s2
    v_lshlrev_b32 v7, 16, v64
    v_and_b32 v8, 0xffff0000, v64
    v_lshlrev_b32 v9, 16, v65
    v_and_b32 v10, 0xffff0000, v65
    v_mul_f32 v7, 0.15915494, v7
    v_mul_f32 v8, 0.15915494, v8
    v_mul_f32 v9, 0.15915494, v9
    v_mul_f32 v10, 0.15915494, v10
    v_mul_hi_u32_u24 v14, 429497, v80
    v_lshrrev_b32 v12, 3, v56
    v_cos_f32 v7, v7
    v_lshlrev_b16 v13, 3, v56
    v_mad_i32_i24 v11, v14, s55, v80
    v_bitop3_b32 v12, v6, v13, v12 bitop3:0xca
    v_add_lshl_u32 v11, v11, s40, 17
    v_lshlrev_b16 v14, 8, v14
    v_lshrrev_b32 v13, 2, v56
    v_or_b32 v80, v12, v11
    v_bitop3_b32 v56, v5, v13, v14 bitop3:0xea
    ds_add_u32 v56, v2
    v_mul_hi_u32_u24 v14, 429497, v81
    v_lshrrev_b32 v12, 3, v57
    v_cos_f32 v8, v8
    v_lshlrev_b16 v13, 3, v57
    v_mad_i32_i24 v11, v14, s55, v81
    v_bitop3_b32 v12, v6, v13, v12 bitop3:0xca
    v_add_lshl_u32 v11, v11, s40, 17
    v_lshlrev_b16 v14, 8, v14
    v_lshrrev_b32 v13, 2, v57
    v_or_b32 v81, v12, v11
    v_bitop3_b32 v57, v5, v13, v14 bitop3:0xea
    ds_add_u32 v57, v2
    v_cvt_pk_bf16_f32 v64, v7, v8
    v_perm_b32 v12, v64, v64, s41
    v_bitop3_b32 v80, v4, v12, v80 bitop3:0xca
    v_perm_b32 v13, v64, v64, s42
    v_bitop3_b32 v81, v4, v13, v81 bitop3:0xca
    v_mul_hi_u32_u24 v14, 429497, v82
    v_lshrrev_b32 v12, 3, v58
    v_cos_f32 v9, v9
    v_lshlrev_b16 v13, 3, v58
    v_mad_i32_i24 v11, v14, s55, v82
    v_bitop3_b32 v12, v6, v13, v12 bitop3:0xca
    v_add_lshl_u32 v11, v11, s40, 17
    v_lshlrev_b16 v14, 8, v14
    v_lshrrev_b32 v13, 2, v58
    v_or_b32 v82, v12, v11
    v_bitop3_b32 v58, v5, v13, v14 bitop3:0xea
    ds_add_u32 v58, v2
    v_mul_hi_u32_u24 v14, 429497, v83
    v_lshrrev_b32 v12, 3, v59
    v_cos_f32 v10, v10
    v_lshlrev_b16 v13, 3, v59
    v_mad_i32_i24 v11, v14, s55, v83
    v_bitop3_b32 v12, v6, v13, v12 bitop3:0xca
    v_add_lshl_u32 v11, v11, s40, 17
    v_lshlrev_b16 v14, 8, v14
    v_lshrrev_b32 v13, 2, v59
    v_or_b32 v83, v12, v11
    v_bitop3_b32 v59, v5, v13, v14 bitop3:0xea
    ds_add_u32 v59, v2
    v_cvt_pk_bf16_f32 v65, v9, v10
    v_perm_b32 v12, v65, v65, s41
    v_bitop3_b32 v82, v4, v12, v82 bitop3:0xca
    v_perm_b32 v13, v65, v65, s42
    v_bitop3_b32 v83, v4, v13, v83 bitop3:0xca
L1_s2:
    s_waitcnt vmcnt(4)
    s_cmp_le_u32 s43, 7
    s_cbranch_scc1 L1_s3
    v_lshlrev_b32 v7, 16, v66
    v_and_b32 v8, 0xffff0000, v66
    v_lshlrev_b32 v9, 16, v67
    v_and_b32 v10, 0xffff0000, v67
    v_mul_f32 v7, 0.15915494, v7
    v_mul_f32 v8, 0.15915494, v8
    v_mul_f32 v9, 0.15915494, v9
    v_mul_f32 v10, 0.15915494, v10
    v_mul_hi_u32_u24 v14, 429497, v96
    v_lshrrev_b32 v12, 3, v60
    v_cos_f32 v7, v7
    v_lshlrev_b16 v13, 3, v60
    v_mad_i32_i24 v11, v14, s55, v96
    v_bitop3_b32 v12, v6, v13, v12 bitop3:0xca
    v_add_lshl_u32 v11, v11, s40, 17
    v_lshlrev_b16 v14, 8, v14
    v_lshrrev_b32 v13, 2, v60
    v_or_b32 v96, v12, v11
    v_bitop3_b32 v60, v5, v13, v14 bitop3:0xea
    ds_add_u32 v60, v2
    v_mul_hi_u32_u24 v14, 429497, v97
    v_lshrrev_b32 v12, 3, v61
    v_cos_f32 v8, v8
    v_lshlrev_b16 v13, 3, v61
    v_mad_i32_i24 v11, v14, s55, v97
    v_bitop3_b32 v12, v6, v13, v12 bitop3:0xca
    v_add_lshl_u32 v11, v11, s40, 17
    v_lshlrev_b16 v14, 8, v14
    v_lshrrev_b32 v13, 2, v61
    v_or_b32 v97, v12, v11
    v_bitop3_b32 v61, v5, v13, v14 bitop3:0xea
    ds_add_u32 v61, v2
    v_cvt_pk_bf16_f32 v66, v7, v8
    v_perm_b32 v12, v66, v66, s41
    v_bitop3_b32 v96, v4, v12, v96 bitop3:0xca
    v_perm_b32 v13, v66, v66, s42
    v_bitop3_b32 v97, v4, v13, v97 bitop3:0xca
    v_mul_hi_u32_u24 v14, 429497, v98
    v_lshrrev_b32 v12, 3, v62
    v_cos_f32 v9, v9
    v_lshlrev_b16 v13, 3, v62
    v_mad_i32_i24 v11, v14, s55, v98
    v_bitop3_b32 v12, v6, v13, v12 bitop3:0xca
    v_add_lshl_u32 v11, v11, s40, 17
    v_lshlrev_b16 v14, 8, v14
    v_lshrrev_b32 v13, 2, v62
    v_or_b32 v98, v12, v11
    v_bitop3_b32 v62, v5, v13, v14 bitop3:0xea
    ds_add_u32 v62, v2
    v_mul_hi_u32_u24 v14, 429497, v99
    v_lshrrev_b32 v12, 3, v63
    v_cos_f32 v10, v10
    v_lshlrev_b16 v13, 3, v63
    v_mad_i32_i24 v11, v14, s55, v99
    v_bitop3_b32 v12, v6, v13, v12 bitop3:0xca
    v_add_lshl_u32 v11, v11, s40, 17
    v_lshlrev_b16 v14, 8, v14
    v_lshrrev_b32 v13, 2, v63
    v_or_b32 v99, v12, v11
    v_bitop3_b32 v63, v5, v13, v14 bitop3:0xea
    ds_add_u32 v63, v2
    v_cvt_pk_bf16_f32 v67, v9, v10
    v_perm_b32 v12, v67, v67, s41
    v_bitop3_b32 v98, v4, v12, v98 bitop3:0xca
    v_perm_b32 v13, v67, v67, s42
    v_bitop3_b32 v99, v4, v13, v99 bitop3:0xca
L1_s3:
    v_lshrrev_b32 v8, 2, v0
    v_and_b32 v7, 0x3c00, v0
    v_bitop3_b32 v7, v5, v8, v7 bitop3:0xea
    s_waitcnt lgkmcnt(0)
    s_barrier
    ds_read2st64_b32 v[8:9], v7 offset0:0 offset1:1
    ds_read2st64_b32 v[10:11], v7 offset0:2 offset1:3
    s_add_u32 s46, s35, 0x7ed0000
    buffer_store_dwordx4 v[28:31], v0, s[20:23], s46 offen sc1
    s_waitcnt lgkmcnt(0)
    v_lshl_or_b32 v12, v9, 16, v8
    v_lshl_or_b32 v13, v11, 16, v10
    v_mov_b32 v14, v12
    v_mov_b32 v15, v13
    s_nop 0
    v_add_u32_dpp v14, v14, v14 row_shr:1 row_mask:0xf bank_mask:0xf bound_ctrl:1
    v_add_u32_dpp v15, v15, v15 row_shr:1 row_mask:0xf bank_mask:0xf bound_ctrl:1
    s_nop 0
    v_add_u32_dpp v14, v14, v14 row_shr:2 row_mask:0xf bank_mask:0xf bound_ctrl:1
    v_add_u32_dpp v15, v15, v15 row_shr:2 row_mask:0xf bank_mask:0xf bound_ctrl:1
    s_nop 0
    v_add_u32_dpp v14, v14, v14 row_shr:4 row_mask:0xf bank_mask:0xf bound_ctrl:1
    v_add_u32_dpp v15, v15, v15 row_shr:4 row_mask:0xf bank_mask:0xf bound_ctrl:1
    s_nop 0
    v_add_u32_dpp v14, v14, v14 row_shr:8 row_mask:0xf bank_mask:0xf bound_ctrl:1
    v_add_u32_dpp v15, v15, v15 row_shr:8 row_mask:0xf bank_mask:0xf bound_ctrl:1
    s_nop 0
    v_add_u32_dpp v14, v14, v14 row_bcast:15 row_mask:0xa bank_mask:0xf
    v_add_u32_dpp v15, v15, v15 row_bcast:15 row_mask:0xa bank_mask:0xf
    s_nop 0
    v_add_u32_dpp v14, v14, v14 row_bcast:31 row_mask:0xc bank_mask:0xf
    v_add_u32_dpp v15, v15, v15 row_bcast:31 row_mask:0xc bank_mask:0xf
    v_readlane_b32 s48, v14, 63
    v_readlane_b32 s49, v15, 63
    s_lshl_b32 s54, s32, 2
    v_mov_b32 v8, s54
    s_and_b32 s50, s48, 0xffff
    s_lshr_b32 s51, s48, 16
    s_and_b32 s52, s49, 0xffff
    s_lshr_b32 s53, s49, 16
    s_add_u32 s51, s51, s50
    s_add_u32 s52, s52, s51
    s_add_u32 s53, s53, s52
    v_mov_b32 v9, s53
    s_mov_b64 exec, 1
    ds_write_b32 v8, v9 offset:16384
    s_mov_b64 exec, -1
    v_and_b32 v8, 60, v7
    s_waitcnt lgkmcnt(0)
    s_barrier
    ds_read_b32 v9, v8 offset:16384
    s_waitcnt lgkmcnt(0)
    v_add_u32_dpp v9, v9, v9 row_shr:1 row_mask:0xf bank_mask:0xf bound_ctrl:1
    s_nop 1
    v_add_u32_dpp v9, v9, v9 row_shr:2 row_mask:0xf bank_mask:0xf bound_ctrl:1
    s_nop 1
    v_add_u32_dpp v9, v9, v9 row_shr:4 row_mask:0xf bank_mask:0xf bound_ctrl:1
    s_nop 1
    v_add_u32_dpp v9, v9, v9 row_shr:8 row_mask:0xf bank_mask:0xf bound_ctrl:1
    s_nop 0
    v_readlane_b32 s54, v9, s32
    s_sub_u32 s54, s54, s53
    s_add_u32 s50, s50, s54
    s_add_u32 s51, s51, s54
    s_add_u32 s52, s52, s54
    s_pack_ll_b32_b16 s48, s54, s50
    s_pack_ll_b32_b16 s49, s51, s52
    v_add_u32 v14, s48, v14
    v_add_u32 v15, s49, v15
    v_sub_u32 v12, v14, v12
    v_sub_u32 v13, v15, v13
    v_and_b32 v8, 0xffff, v12
    v_lshrrev_b32 v9, 16, v12
    v_and_b32 v10, 0xffff, v13
    v_lshrrev_b32 v11, 16, v13
    ds_write2st64_b32 v7, v8, v9 offset0:0 offset1:1
    ds_write2st64_b32 v7, v10, v11 offset0:2 offset1:3
    s_waitcnt lgkmcnt(0)
    s_barrier
    ds_add_rtn_u32 v120, v120, v2
    ds_add_rtn_u32 v121, v121, v2
    ds_add_rtn_u32 v122, v122, v2
    ds_add_rtn_u32 v123, v123, v2
    s_add_u32 s47, s36, 0xa900000
    v_and_b32 v11, 0x3f0, v0
    v_add_u32 v11, v11, v11
    buffer_store_dwordx2 v[12:13], v11, s[24:27], s47 offen
    s_bitset0_b64 exec, 63
    s_not_b64 exec, exec
    buffer_store_dwordx2 v[14:15], v11, s[24:27], s47 offen offset:32
    s_mov_b64 exec, -1
    ds_add_rtn_u32 v124, v124, v2
    ds_add_rtn_u32 v125, v125, v2
    ds_add_rtn_u32 v126, v126, v2
    ds_add_rtn_u32 v127, v127, v2
    ds_add_rtn_u32 v24, v24, v2
    ds_add_rtn_u32 v25, v25, v2
    ds_add_rtn_u32 v26, v26, v2
    ds_add_rtn_u32 v27, v27, v2
    s_add_u32 s44, s35, 0x7ed4000
    buffer_store_dwordx4 v[112:115], v0, s[20:23], s44 offen sc1
    ds_add_rtn_u32 v52, v52, v2
    ds_add_rtn_u32 v53, v53, v2
    ds_add_rtn_u32 v54, v54, v2
    ds_add_rtn_u32 v55, v55, v2
    ds_add_rtn_u32 v68, v68, v2
    ds_add_rtn_u32 v69, v69, v2
    ds_add_rtn_u32 v70, v70, v2
    ds_add_rtn_u32 v71, v71, v2
    s_cmp_le_u32 s43, 5
    s_cbranch_scc1 L1_s4
    ds_add_rtn_u32 v76, v76, v2
    ds_add_rtn_u32 v77, v77, v2
    ds_add_rtn_u32 v78, v78, v2
    ds_add_rtn_u32 v79, v79, v2
L1_s4:
    s_add_u32 s45, s35, 0x7ed8000
    buffer_store_dwordx4 v[88:91], v0, s[20:23], s45 offen sc1
    s_cmp_le_u32 s43, 6
    s_cbranch_scc1 L1_s5
    ds_add_rtn_u32 v56, v56, v2
    ds_add_rtn_u32 v57, v57, v2
    ds_add_rtn_u32 v58, v58, v2
    ds_add_rtn_u32 v59, v59, v2
L1_s5:
    s_cmp_le_u32 s43, 7
    s_cbranch_scc1 L1_s6
    ds_add_rtn_u32 v60, v60, v2
    ds_add_rtn_u32 v61, v61, v2
    ds_add_rtn_u32 v62, v62, v2
    ds_add_rtn_u32 v63, v63, v2
L1_s6:
    s_waitcnt lgkmcnt(0)
    s_barrier
    v_and_b32 v7, -4, v120
    v_lshl_add_u32 v8, v120, 2, v7
    ds_write_b32 v8, v16
    v_lshl_add_u32 v7, v7, 2, v120
    ds_write_b8 v7, v44 offset:16
    v_and_b32 v9, -4, v121
    v_lshl_add_u32 v10, v121, 2, v9
    ds_write_b32 v10, v17
    v_lshl_add_u32 v9, v9, 2, v121
    ds_write_b8_d16_hi v9, v44 offset:16
    v_and_b32 v7, -4, v122
    v_lshl_add_u32 v8, v122, 2, v7
    ds_write_b32 v8, v18
    v_lshl_add_u32 v7, v7, 2, v122
    ds_write_b8 v7, v45 offset:16
    v_and_b32 v9, -4, v123
    v_lshl_add_u32 v10, v123, 2, v9
    ds_write_b32 v10, v19
    v_lshl_add_u32 v9, v9, 2, v123
    ds_write_b8_d16_hi v9, v45 offset:16
    s_add_u32 s46, s35, 0x7edc000
    buffer_store_dwordx4 v[116:119], v0, s[20:23], s46 offen sc1
    v_and_b32 v7, -4, v124
    v_lshl_add_u32 v8, v124, 2, v7
    ds_write_b32 v8, v20
    v_lshl_add_u32 v7, v7, 2, v124
    ds_write_b8 v7, v46 offset:16
    v_and_b32 v9, -4, v125
    v_lshl_add_u32 v10, v125, 2, v9
    ds_write_b32 v10, v21
    v_lshl_add_u32 v9, v9, 2, v125
    ds_write_b8_d16_hi v9, v46 offset:16
    v_and_b32 v7, -4, v126
    v_lshl_add_u32 v8, v126, 2, v7
    ds_write_b32 v8, v22
    v_lshl_add_u32 v7, v7, 2, v126
    ds_write_b8 v7, v47 offset:16
    v_and_b32 v9, -4, v127
    v_lshl_add_u32 v10, v127, 2, v9
    ds_write_b32 v10, v23
    v_lshl_add_u32 v9, v9, 2, v127
    ds_write_b8_d16_hi v9, v47 offset:16
    v_and_b32 v7, -4, v24
    v_lshl_add_u32 v8, v24, 2, v7
    ds_write_b32 v8, v40
    v_lshl_add_u32 v7, v7, 2, v24
    ds_write_b8 v7, v32 offset:16
    v_and_b32 v9, -4, v25
    v_lshl_add_u32 v10, v25, 2, v9
    ds_write_b32 v10, v41
    v_lshl_add_u32 v9, v9, 2, v25
    ds_write_b8_d16_hi v9, v32 offset:16
    v_and_b32 v7, -4, v26
    v_lshl_add_u32 v8, v26, 2, v7
    ds_write_b32 v8, v42
    v_lshl_add_u32 v7, v7, 2, v26
    ds_write_b8 v7, v33 offset:16
    v_and_b32 v9, -4, v27
    v_lshl_add_u32 v10, v27, 2, v9
    ds_write_b32 v10, v43
    v_lshl_add_u32 v9, v9, 2, v27
    ds_write_b8_d16_hi v9, v33 offset:16
    s_add_u32 s47, s35, 0x7ee0000
    buffer_store_dwordx4 v[92:95], v0, s[20:23], s47 offen sc1
    v_and_b32 v7, -4, v52
    v_lshl_add_u32 v8, v52, 2, v7
    ds_write_b32 v8, v48
    v_lshl_add_u32 v7, v7, 2, v52
    ds_write_b8 v7, v34 offset:16
    v_and_b32 v9, -4, v53
    v_lshl_add_u32 v10, v53, 2, v9
    ds_write_b32 v10, v49
    v_lshl_add_u32 v9, v9, 2, v53
    ds_write_b8_d16_hi v9, v34 offset:16
    v_and_b32 v7, -4, v54
    v_lshl_add_u32 v8, v54, 2, v7
    ds_write_b32 v8, v50
    v_lshl_add_u32 v7, v7, 2, v54
    ds_write_b8 v7, v35 offset:16
    v_and_b32 v9, -4, v55
    v_lshl_add_u32 v10, v55, 2, v9
    ds_write_b32 v10, v51
    v_lshl_add_u32 v9, v9, 2, v55
    ds_write_b8_d16_hi v9, v35 offset:16
    v_and_b32 v7, -4, v68
    v_lshl_add_u32 v8, v68, 2, v7
    ds_write_b32 v8, v84
    v_lshl_add_u32 v7, v7, 2, v68
    ds_write_b8 v7, v72 offset:16
    v_and_b32 v9, -4, v69
    v_lshl_add_u32 v10, v69, 2, v9
    ds_write_b32 v10, v85
    v_lshl_add_u32 v9, v9, 2, v69
    ds_write_b8_d16_hi v9, v72 offset:16
    v_and_b32 v7, -4, v70
    v_lshl_add_u32 v8, v70, 2, v7
    ds_write_b32 v8, v86
    v_lshl_add_u32 v7, v7, 2, v70
    ds_write_b8 v7, v73 offset:16
    v_and_b32 v9, -4, v71
    v_lshl_add_u32 v10, v71, 2, v9
    ds_write_b32 v10, v87
    v_lshl_add_u32 v9, v9, 2, v71
    ds_write_b8_d16_hi v9, v73 offset:16
    s_cmp_le_u32 s43, 5
    s_cbranch_scc1 L1_s7
    v_and_b32 v7, -4, v76
    v_lshl_add_u32 v8, v76, 2, v7
    ds_write_b32 v8, v36
    v_lshl_add_u32 v7, v7, 2, v76
    ds_write_b8 v7, v74 offset:16
    v_and_b32 v9, -4, v77
    v_lshl_add_u32 v10, v77, 2, v9
    ds_write_b32 v10, v37
    v_lshl_add_u32 v9, v9, 2, v77
    ds_write_b8_d16_hi v9, v74 offset:16
    v_and_b32 v7, -4, v78
    v_lshl_add_u32 v8, v78, 2, v7
    ds_write_b32 v8, v38
    v_lshl_add_u32 v7, v7, 2, v78
    ds_write_b8 v7, v75 offset:16
    v_and_b32 v9, -4, v79
    v_lshl_add_u32 v10, v79, 2, v9
    ds_write_b32 v10, v39
    v_lshl_add_u32 v9, v9, 2, v79
    ds_write_b8_d16_hi v9, v75 offset:16
L1_s7:
    s_add_u32 s44, s35, 0x7ee4000
    buffer_store_dwordx4 v[104:107], v0, s[20:23], s44 offen sc1
    s_cmp_le_u32 s43, 6
    s_cbranch_scc1 L1_s8
    v_and_b32 v7, -4, v56
    v_lshl_add_u32 v8, v56, 2, v7
    ds_write_b32 v8, v80
    v_lshl_add_u32 v7, v7, 2, v56
    ds_write_b8 v7, v64 offset:16
    v_and_b32 v9, -4, v57
    v_lshl_add_u32 v10, v57, 2, v9
    ds_write_b32 v10, v81
    v_lshl_add_u32 v9, v9, 2, v57
    ds_write_b8_d16_hi v9, v64 offset:16
    v_and_b32 v7, -4, v58
    v_lshl_add_u32 v8, v58, 2, v7
    ds_write_b32 v8, v82
    v_lshl_add_u32 v7, v7, 2, v58
    ds_write_b8 v7, v65 offset:16
    v_and_b32 v9, -4, v59
    v_lshl_add_u32 v10, v59, 2, v9
    ds_write_b32 v10, v83
    v_lshl_add_u32 v9, v9, 2, v59
    ds_write_b8_d16_hi v9, v65 offset:16
L1_s8:
    s_cmp_le_u32 s43, 7
    s_cbranch_scc1 L1_s9
    v_and_b32 v7, -4, v60
    v_lshl_add_u32 v8, v60, 2, v7
    ds_write_b32 v8, v96
    v_lshl_add_u32 v7, v7, 2, v60
    ds_write_b8 v7, v66 offset:16
    v_and_b32 v9, -4, v61
    v_lshl_add_u32 v10, v61, 2, v9
    ds_write_b32 v10, v97
    v_lshl_add_u32 v9, v9, 2, v61
    ds_write_b8_d16_hi v9, v66 offset:16
    v_and_b32 v7, -4, v62
    v_lshl_add_u32 v8, v62, 2, v7
    ds_write_b32 v8, v98
    v_lshl_add_u32 v7, v7, 2, v62
    ds_write_b8 v7, v67 offset:16
    v_and_b32 v9, -4, v63
    v_lshl_add_u32 v10, v63, 2, v9
    ds_write_b32 v10, v99
    v_lshl_add_u32 v9, v9, 2, v63
    ds_write_b8_d16_hi v9, v67 offset:16
L1_s9:
    v_add_u32 v7, 0x10000, v0
    v_add_u32 v12, 0x20000, v0
    s_waitcnt lgkmcnt(0)
    s_barrier
    ds_read_b128 v[100:103], v0 offset:0
    ds_read_b128 v[28:31], v0 offset:16384
    ds_read_b128 v[112:115], v0 offset:32768
    ds_read_b128 v[88:91], v0 offset:49152
    ds_read_b128 v[16:19], v7 offset:0
    ds_read_b128 v[120:123], v7 offset:16384
    ds_read_b128 v[116:119], v7 offset:32768
    ds_read_b128 v[20:23], v7 offset:49152
    ds_read_b128 v[124:127], v12 offset:0
    ds_read_b128 v[44:47], v12 offset:16384
    s_waitcnt lgkmcnt(9)
    s_add_u32 s45, s35, 0xa900000
    buffer_store_dwordx4 v[100:103], v0, s[20:23], s45 offen sc1
    s_waitcnt lgkmcnt(8)
    s_add_u32 s46, s35, 0xa904000
    buffer_store_dwordx4 v[28:31], v0, s[20:23], s46 offen sc1
    s_waitcnt lgkmcnt(7)
    s_add_u32 s47, s35, 0xa908000
    buffer_store_dwordx4 v[112:115], v0, s[20:23], s47 offen sc1
    s_waitcnt lgkmcnt(6)
    s_add_u32 s44, s35, 0xa90c000
    buffer_store_dwordx4 v[88:91], v0, s[20:23], s44 offen sc1
    s_waitcnt lgkmcnt(5)
    s_add_u32 s45, s35, 0xa910000
    buffer_store_dwordx4 v[16:19], v0, s[20:23], s45 offen sc1
    s_waitcnt lgkmcnt(4)
    s_add_u32 s46, s35, 0xa914000
    buffer_store_dwordx4 v[120:123], v0, s[20:23], s46 offen sc1
    s_waitcnt lgkmcnt(3)
    s_add_u32 s47, s35, 0xa918000
    buffer_store_dwordx4 v[116:119], v0, s[20:23], s47 offen sc1
    s_cmp_le_u32 s43, 5
    s_cbranch_scc1 L1_fin
    s_waitcnt lgkmcnt(2)
    s_add_u32 s44, s35, 0xa91c000
    buffer_store_dwordx4 v[20:23], v0, s[20:23], s44 offen sc1
    s_cmp_le_u32 s43, 6
    s_cbranch_scc1 L1_fin
    s_waitcnt lgkmcnt(1)
    s_add_u32 s45, s35, 0xa920000
    buffer_store_dwordx4 v[124:127], v0, s[20:23], s45 offen sc1
    s_cmp_le_u32 s43, 7
    s_cbranch_scc1 L1_fin
    s_waitcnt lgkmcnt(0)
    s_add_u32 s46, s35, 0xa924000
    buffer_store_dwordx4 v[44:47], v0, s[20:23], s46 offen sc1
L1_fin:
L1_end:
    s_endpgm
.text
.globl gs_acc_kernel
.p2align 8
.type gs_acc_kernel,@function
gs_acc_kernel:
    s_cmp_ge_u32 s2, 256
    s_cbranch_scc1 L2_end
    s_load_dwordx2 s[30:31], s[0:1], 104
    s_load_dwordx2 s[28:29], s[0:1], 0
    v_lshrrev_b32 v16, 6, v0
    v_and_b32 v17, 63, v0
    v_readfirstlane_b32 s32, v16
    s_bfe_u32 s33, s2, 0x20001
    s_and_b32 s34, s2, 1
    s_lshl_b32 s34, s34, 5
    s_lshr_b32 s4, s2, 3
    s_add_u32 s34, s34, s4
    v_and_b32 v22, 3, v0
    v_mul_u32_u24 v19, 80, v16
    v_add_u32 v18, v17, v19
    v_mul_u32_u24 v2, 173056, v18
    v_lshrrev_b32 v18, 2, v17
    v_add3_u32 v18, v18, v19, 64
    v_mul_u32_u24 v4, 173056, v18
    v_lshl_add_u32 v20, v22, 4, v4
    s_mul_i32 s39, s33, 2080
    s_lshl_b32 s3, s34, 5
    s_add_u32 s39, s39, s3
    s_mul_i32 s40, s33, 1280000
    s_mul_i32 s38, s32, 5120
    s_add_u32 s38, s38, 80000
    v_lshl_add_u32 v3, v17, 4, s38
    s_waitcnt lgkmcnt(0)
    s_add_u32 s12, s30, 0x28000
    s_addc_u32 s13, s31, 0
    s_mov_b32 s14, 0xd318000
    s_mov_b32 s15, 0x20000
    buffer_load_dwordx4 v[48:51], v2, s[12:15], s39 offen offset:0
    buffer_load_dwordx4 v[56:59], v2, s[12:15], s39 offen offset:32
    buffer_load_dwordx4 v[52:55], v2, s[12:15], s39 offen offset:16
    buffer_load_dwordx4 v[60:63], v2, s[12:15], s39 offen offset:48
    buffer_load_dwordx4 v[64:67], v20, s[12:15], s39 offen
    s_mov_b32 s16, s28
    s_mov_b32 s17, s29
    s_mov_b32 s18, 0x4f5880
    s_mov_b32 s19, 0x20000
    s_sub_u32 s16, s16, 80000
    s_subb_u32 s17, s17, 0
    s_add_u32 s24, s30, 0xebab000
    s_addc_u32 s25, s31, 0
    s_mov_b32 s26, 0x100
    s_mov_b32 s27, 0x20000
    v_lshlrev_b32 v21, 6, v22
    buffer_load_dwordx2 v[8:9], v21, s[24:27], 0 offen offset:40
    s_add_u32 s3, s40, 4096
    buffer_load_dwordx4 v[124:127], v3, s[16:19], s3 offen
    buffer_load_dwordx4 v[116:119], v3, s[16:19], s40 offen offset:2048
    buffer_load_dwordx4 v[120:123], v3, s[16:19], s40 offen offset:3072
    buffer_load_dwordx4 v[108:111], v3, s[16:19], s40 offen offset:0
    buffer_load_dwordx4 v[112:115], v3, s[16:19], s40 offen offset:1024
    s_add_u32 s40, s40, 0x4e200
    v_mad_u32_u24 v4, v22, 20, v4
    v_or_b32 v4, 0xf0000000, v4
    v_or_b32 v2, 0xf0000000, v2
    v_lshlrev_b32 v23, 2, v22
    v_sub_u32 v1, 28, v23
    v_and_b32 v18, 3, v0
    v_lshlrev_b32 v18, 4, v18
    v_mov_b32 v10, 0x3f80
    v_mov_b32 v11, 0
    v_lshlrev_b64 v[10:11], v18, v[10:11]
    v_and_b32 v18, 3, v0
    v_lshlrev_b32 v18, 4, v18
    v_mov_b32 v12, 0xbf80
    v_mov_b32 v13, 0
    v_lshlrev_b64 v[12:13], v18, v[12:13]
    v_lshlrev_b32 v24, 4, v0
    v_lshl_add_u32 v0, v17, 2, s38
    v_mov_b32 v45, 0xf0000000
    v_mov_b32 v5, 0x1fff8
    v_mov_b32 v6, 0x07ff0000
    s_mov_b32 s44, 0x4000c0c
    s_mov_b32 s45, 0x4010c0c
    s_mov_b32 s46, 0x4020c0c
    s_mov_b32 s47, 0x4030c0c
    s_mov_b32 s36, 0
    s_mov_b32 s35, 0
    s_mov_b32 s42, 0
    s_mov_b64 s[80:81], 0
    s_mov_b64 s[84:85], 0
    s_mov_b64 s[48:49], 0
    s_mov_b32 s8, s30
    s_mov_b32 s9, s31
    s_mov_b32 s10, 0xd340000
    s_mov_b32 s11, 0x20000
    s_add_u32 s20, s30, 0xd823000
    s_addc_u32 s21, s31, 0
    s_mov_b32 s22, 0x13880
    s_mov_b32 s23, 0x20000
    s_lshl_b32 s3, s33, 6
    s_add_u32 s3, s3, s34
    s_mul_i32 s3, s3, 80000
    s_add_u32 s20, s20, s3
    s_addc_u32 s21, s21, 0
    v_mov_b32 v68, 0
    v_mov_b32 v76, 0
    v_mov_b32 v69, 0
    v_mov_b32 v77, 0
    v_mov_b32 v70, 0
    v_mov_b32 v78, 0
    v_mov_b32 v71, 0
    v_mov_b32 v79, 0
    v_mov_b32 v72, 0
    v_mov_b32 v80, 0
    v_mov_b32 v73, 0
    v_mov_b32 v81, 0
    v_mov_b32 v74, 0
    v_mov_b32 v82, 0
    v_mov_b32 v75, 0
    v_mov_b32 v83, 0
    v_mov_b32 v94, 2.0
    v_mov_b32 v95, 2.0
    ds_write_b128 v24, v[68:71] offset:0
    ds_write_b128 v24, v[68:71] offset:16384
    ds_write_b128 v24, v[68:71] offset:32768
    ds_write_b128 v24, v[68:71] offset:49152
    v_add_u32 v47, 0x10000, v24
    v_cmp_gt_u32 vcc, 80000, v47
    s_mov_b64 exec, vcc
    ds_write_b128 v47, v[68:71]
    s_mov_b64 exec, -1
    s_waitcnt vmcnt(5)
    v_sub_u16 v88, v56, v48
    v_and_b32 v89, 3, v48
    v_add3_u32 v99, v88, v89, 3
    v_and_b32 v99, -4, v99
    v_max_u32 v99, 4, v99
    v_and_b32 v97, 0xfffc, v48
    v_bfm_b32 v96, v88, v89
    v_add_u32_dpp v91, v99, v99 row_shr:1 row_mask:0xf bank_mask:0xf bound_ctrl:1
    v_mad_u32_u24 v97, v97, 5, v2
    v_cmp_lt_u32 vcc, 16, v99
    v_add_u32_dpp v91, v91, v91 row_shr:2 row_mask:0xf bank_mask:0xf bound_ctrl:1
    v_sub_u32 v98, s38, v99
    v_lshrrev_b64 v[48:49], 16, v[48:49]
    v_add_u32_dpp v91, v91, v91 row_shr:4 row_mask:0xf bank_mask:0xf bound_ctrl:1
    v_lshrrev_b64 v[56:57], 16, v[56:57]
    s_mov_b32 s43, 0
    v_add_u32_dpp v91, v91, v91 row_shr:8 row_mask:0xf bank_mask:0xf bound_ctrl:1
    s_nop 1
    v_add_u32_dpp v91, v91, v91 row_bcast:15 row_mask:0xa bank_mask:0xf
    s_nop 1
    v_add_u32_dpp v91, v91, v91 row_bcast:31 row_mask:0xc bank_mask:0xf
    v_add_u32 v98, v98, v91
    v_readlane_b32 s37, v91, 63
    s_cbranch_vccnz L2_xo1
L2_xp1:
    v_mov_b32 v44, v43
    s_cmp_gt_u32 s37, 1024
    s_cbranch_scc1 L2_xs2
    s_cmp_lg_u32 s43, 0
    s_cbranch_scc1 L2_xa2
L2_xb2:
    v_lshlrev_b32 v89, 16, v96
    v_add_u32 v90, 60, v97
    v_bitop3_b32 v90, v89, v45, v90 bitop3:0x6a
    ds_write_b32 v98, v90 offset:12
    v_lshlrev_b32 v89, 20, v96
    v_add_u32 v90, 40, v97
    v_bitop3_b32 v90, v89, v45, v90 bitop3:0x6a
    ds_write_b32 v98, v90 offset:8
    v_lshlrev_b32 v89, 24, v96
    v_add_u32 v90, 20, v97
    v_bitop3_b32 v90, v89, v45, v90 bitop3:0x6a
    ds_write_b32 v98, v90 offset:4
    v_lshlrev_b32 v89, 28, v96
    v_bitop3_b32 v90, v89, v45, v97 bitop3:0x6a
    ds_write_b32 v98, v90 offset:0
    v_mov_b32_dpp v91, v64 quad_perm:[0,0,0,0] row_mask:0xf bank_mask:0xf
    v_and_b32 v89, 3, v91
    v_and_b32 v97, 0xfffc, v91
    v_sub_u16_dpp v88, v64, v91 quad_perm:[2,2,2,2] row_mask:0xf bank_mask:0xf
    v_mad_u32_u24 v97, v97, 5, v4
    v_add_u32 v99, v88, v89
    v_bfm_b32 v96, v88, v89
    v_cmp_lt_u32 s[58:59], 16, v99
    v_lshlrev_b32 v89, v1, v96
    v_and_b32 v89, v45, v89
    v_cmp_ne_u32 vcc, 0, v89
    v_xor_b32 v90, v97, v89
    s_add_u32 s3, s37, s38
    v_mbcnt_lo_u32_b32 v98, vcc_lo, 0
    v_mbcnt_hi_u32_b32 v98, vcc_hi, v98
    s_bcnt1_i32_b64 s41, vcc
    v_lshl_add_u32 v98, v98, 2, s3
    s_mov_b64 exec, vcc
    ds_write_b32 v98, v90
    s_mov_b64 exec, -1
    s_lshl2_add_u32 s37, s41, s37
    s_cmp_lg_u64 s[58:59], 0
    s_cbranch_scc1 L2_xe2
L2_xr2:
    v_add_u32 v98, s37, v0
    v_mov_b32 v90, -1
    ds_write_b32 v98, v90
    ds_read2st64_b32 v[40:41], v0 offset0:0 offset1:1
    ds_read2st64_b32 v[42:43], v0 offset0:2 offset1:3
    s_sub_u32 s3, s37, 768
    s_cmp_gt_u32 s3, 256
    s_cbranch_scc1 L2_xf2
L2_xg2:
    v_sub_u16 v88, v58, v50
    v_and_b32 v89, 3, v50
    v_add3_u32 v99, v88, v89, 3
    v_and_b32 v99, -4, v99
    v_max_u32 v99, 4, v99
    v_and_b32 v97, 0xfffc, v50
    v_bfm_b32 v96, v88, v89
    v_add_u32_dpp v91, v99, v99 row_shr:1 row_mask:0xf bank_mask:0xf bound_ctrl:1
    v_mad_u32_u24 v97, v97, 5, v2
    v_cmp_lt_u32 vcc, 16, v99
    v_add_u32_dpp v91, v91, v91 row_shr:2 row_mask:0xf bank_mask:0xf bound_ctrl:1
    v_sub_u32 v98, s38, v99
    v_lshrrev_b64 v[50:51], 16, v[50:51]
    v_add_u32_dpp v91, v91, v91 row_shr:4 row_mask:0xf bank_mask:0xf bound_ctrl:1
    v_lshrrev_b64 v[58:59], 16, v[58:59]
    s_mov_b32 s43, 0
    v_add_u32_dpp v91, v91, v91 row_shr:8 row_mask:0xf bank_mask:0xf bound_ctrl:1
    s_nop 1
    v_add_u32_dpp v91, v91, v91 row_bcast:15 row_mask:0xa bank_mask:0xf
    s_nop 1
    v_add_u32_dpp v91, v91, v91 row_bcast:31 row_mask:0xc bank_mask:0xf
    v_add_u32 v98, v98, v91
    v_readlane_b32 s37, v91, 63
    s_cbranch_vccnz L2_xo3
L2_xp3:
    s_waitcnt lgkmcnt(0)
    v_and_b32 v47, 0x0fffffff, v40
    v_mov_b32 v21, v40
    buffer_load_dwordx4 v[16:19], v47, s[8:11], 0 offen
    buffer_load_dwordx3 v[18:20], v47, s[8:11], 0 offen offset:8
    s_waitcnt vmcnt(6)
    ds_write_b128 v3, v[124:127] offset:4096
    v_and_b32 v47, 0x0fffffff, v41
    v_mov_b32 v27, v41
    buffer_load_dwordx4 v[22:25], v47, s[8:11], 0 offen
    buffer_load_dwordx3 v[24:26], v47, s[8:11], 0 offen offset:8
    s_waitcnt vmcnt(7)
    ds_write_b128 v3, v[116:119] offset:2048
    v_and_b32 v47, 0x0fffffff, v42
    v_mov_b32 v33, v42
    buffer_load_dwordx4 v[28:31], v47, s[8:11], 0 offen
    buffer_load_dwordx3 v[30:32], v47, s[8:11], 0 offen offset:8
    s_waitcnt vmcnt(8)
    ds_write_b128 v3, v[120:123] offset:3072
    v_mov_b32 v44, v43
    s_cmp_gt_u32 s37, 1024
    s_cbranch_scc1 L2_xs4
    s_cmp_lg_u32 s43, 0
    s_cbranch_scc1 L2_xa4
L2_xb4:
    v_lshlrev_b32 v89, 16, v96
    v_add_u32 v90, 60, v97
    v_bitop3_b32 v90, v89, v45, v90 bitop3:0x6a
    ds_write_b32 v98, v90 offset:12
    v_lshlrev_b32 v89, 20, v96
    v_add_u32 v90, 40, v97
    v_bitop3_b32 v90, v89, v45, v90 bitop3:0x6a
    ds_write_b32 v98, v90 offset:8
    v_lshlrev_b32 v89, 24, v96
    v_add_u32 v90, 20, v97
    v_bitop3_b32 v90, v89, v45, v90 bitop3:0x6a
    ds_write_b32 v98, v90 offset:4
    v_lshlrev_b32 v89, 28, v96
    v_bitop3_b32 v90, v89, v45, v97 bitop3:0x6a
    ds_write_b32 v98, v90 offset:0
    v_mov_b32_dpp v91, v66 quad_perm:[0,0,0,0] row_mask:0xf bank_mask:0xf
    v_and_b32 v89, 3, v91
    v_and_b32 v97, 0xfffc, v91
    v_sub_u16_dpp v88, v66, v91 quad_perm:[2,2,2,2] row_mask:0xf bank_mask:0xf
    v_mad_u32_u24 v97, v97, 5, v4
    v_add_u32 v99, v88, v89
    v_bfm_b32 v96, v88, v89
    v_cmp_lt_u32 s[58:59], 16, v99
    v_lshlrev_b32 v89, v1, v96
    v_and_b32 v89, v45, v89
    v_cmp_ne_u32 vcc, 0, v89
    v_xor_b32 v90, v97, v89
    s_add_u32 s3, s37, s38
    v_mbcnt_lo_u32_b32 v98, vcc_lo, 0
    v_mbcnt_hi_u32_b32 v98, vcc_hi, v98
    s_bcnt1_i32_b64 s41, vcc
    v_lshl_add_u32 v98, v98, 2, s3
    s_mov_b64 exec, vcc
    ds_write_b32 v98, v90
    s_mov_b64 exec, -1
    s_lshl2_add_u32 s37, s41, s37
    s_cmp_lg_u64 s[58:59], 0
    s_cbranch_scc1 L2_xe4
L2_xr4:
    v_add_u32 v98, s37, v0
    v_mov_b32 v90, -1
    ds_write_b32 v98, v90
    ds_read2st64_b32 v[40:41], v0 offset0:0 offset1:1
    ds_read2st64_b32 v[42:43], v0 offset0:2 offset1:3
    s_sub_u32 s3, s37, 768
    s_cmp_gt_u32 s3, 256
    s_cbranch_scc1 L2_xf4
L2_xg4:
    s_waitcnt vmcnt(7)
    ds_write_b128 v3, v[108:111] offset:0
    s_waitcnt vmcnt(6)
    ds_write_b128 v3, v[112:115] offset:1024
    buffer_load_dwordx4 v[116:119], v3, s[16:19], s40 offen offset:2048
    buffer_load_dwordx4 v[120:123], v3, s[16:19], s40 offen offset:3072
    s_add_u32 s3, s40, 4096
    buffer_load_dwordx4 v[124:127], v3, s[16:19], s3 offen
    s_waitcnt lgkmcnt(0)
L2_loop:
    s_barrier
    s_bitcmp1_b32 s36, s42
    s_cbranch_scc1 L2_slow
L2_ret0:
    s_setprio 3
    v_and_b32 v47, 0x0fffffff, v44
    v_mov_b32 v39, v44
    buffer_load_dwordx4 v[34:37], v47, s[8:11], 0 offen
    buffer_load_dwordx3 v[36:38], v47, s[8:11], 0 offen offset:8
    s_waitcnt lgkmcnt(0)
    v_cmpx_ne_u64 vcc, v[74:75], v[70:71]
    s_and_b64 s[82:83], vcc, s[80:81]
    s_cbranch_scc1 L2_c5
L2_d5:
    v_mov_b64 v[84:85], v[70:71]
    v_mov_b32 v7, v93
    v_mov_b64 v[86:87], v[74:75]
    s_mov_b64 exec, -1
    s_or_b64 s[80:81], s[80:81], vcc
    v_cmpx_ne_u64 vcc, v[72:73], v[68:69]
    s_and_b64 s[82:83], vcc, s[80:81]
    s_cbranch_scc1 L2_c6
L2_d6:
    v_mov_b64 v[84:85], v[68:69]
    v_mov_b32 v7, v92
    v_mov_b64 v[86:87], v[72:73]
    s_mov_b64 exec, -1
    s_or_b64 s[80:81], s[80:81], vcc
    ds_read_b64 v[70:71], v95
    ds_read_b64 v[68:69], v94
    s_waitcnt vmcnt(9)
    v_and_b32 v46, 0x20000000, v21
    v_lshrrev_b32 v47, 14, v17
    v_bitop3_b32 v47, v47, v5, v46 bitop3:0xea
    ds_read_b64 v[102:103], v47 offset:63616
    v_bitop3_b32 v93, v17, v5, v46 bitop3:0xea
    v_and_b32 v46, 0x10000000, v21
    v_lshrrev_b32 v47, 14, v16
    v_bitop3_b32 v47, v47, v5, v46 bitop3:0xea
    ds_read_b64 v[100:101], v47 offset:63616
    v_bitop3_b32 v92, v16, v5, v46 bitop3:0xea
    s_waitcnt lgkmcnt(2)
    v_mfma_f32_4x4x4_16b_bf16 v[80:83], v[10:11], v[70:71], v[80:83]
    v_mfma_f32_4x4x4_16b_bf16 v[76:79], v[10:11], v[68:69], v[76:79]
    v_perm_b32 v15, v17, v20, s45
    v_bitop3_b32 v46, v17, 0.5, -0.5 bitop3:0xa8
    v_perm_b32 v14, v16, v20, s44
    v_bitop3_b32 v47, v16, 0.5, -0.5 bitop3:0xa8
    v_cvt_pk_bf16_f32 v80, v80, v81
    v_cvt_pk_bf16_f32 v81, v82, v83
    ds_wrxchg_rtn_b64 v[74:75], v95, v[80:81]
    v_cvt_pk_bf16_f32 v76, v76, v77
    v_cvt_pk_bf16_f32 v77, v78, v79
    ds_wrxchg_rtn_b64 v[72:73], v94, v[76:77]
    s_waitcnt lgkmcnt(2)
    v_mfma_f32_4x4x4_16b_bf16 v[80:83], v[8:9], v[102:103], 0
    v_mfma_f32_4x4x4_16b_bf16 v[76:79], v[8:9], v[100:101], 0
    v_bitop3_b32 v15, v6, v15, v46 bitop3:0xca
    v_bitop3_b32 v14, v6, v14, v47 bitop3:0xca
    v_cmp_lt_u32 s[84:85], v5, v92
    s_nop 0
    v_pk_mul_f32 v[80:81], v[80:81], v[14:15] op_sel:[0,1] op_sel_hi:[1,1]
    v_pk_mul_f32 v[82:83], v[82:83], v[14:15] op_sel:[0,1] op_sel_hi:[1,1]
    v_pk_mul_f32 v[76:77], v[76:77], v[14:15] op_sel:[0,0] op_sel_hi:[1,0]
    v_pk_mul_f32 v[78:79], v[78:79], v[14:15] op_sel:[0,0] op_sel_hi:[1,0]
    buffer_load_dwordx4 v[108:111], v3, s[16:19], s40 offen offset:0
    s_waitcnt lgkmcnt(0)
    v_cmpx_ne_u64 vcc, v[74:75], v[70:71]
    s_and_b64 s[82:83], vcc, s[80:81]
    s_cbranch_scc1 L2_c7
L2_d7:
    v_mov_b64 v[84:85], v[70:71]
    v_mov_b32 v7, v95
    v_mov_b64 v[86:87], v[74:75]
    s_mov_b64 exec, -1
    s_or_b64 s[80:81], s[80:81], vcc
    v_cmpx_ne_u64 vcc, v[72:73], v[68:69]
    s_and_b64 s[82:83], vcc, s[80:81]
    s_cbranch_scc1 L2_c8
L2_d8:
    v_mov_b64 v[84:85], v[68:69]
    v_mov_b32 v7, v94
    v_mov_b64 v[86:87], v[72:73]
    s_mov_b64 exec, -1
    s_or_b64 s[80:81], s[80:81], vcc
    ds_read_b64 v[70:71], v93
    s_and_b64 exec, s[84:85], s[80:81]
    v_mfma_f32_4x4x4_16b_bf16 v[76:79], v[12:13], v[84:85], 0
    v_mov_b32 v92, v7
    s_andn2_b64 s[80:81], s[80:81], s[84:85]
    v_mfma_f32_4x4x4_16b_bf16 v[76:79], v[10:11], v[86:87], v[76:79]
    s_mov_b64 exec, -1
    ds_read_b64 v[68:69], v92
    v_and_b32 v46, 0x80000000, v21
    v_lshrrev_b32 v47, 14, v19
    v_bitop3_b32 v47, v47, v5, v46 bitop3:0xea
    ds_read_b64 v[106:107], v47 offset:63616
    v_bitop3_b32 v95, v19, v5, v46 bitop3:0xea
    v_and_b32 v46, 0x40000000, v21
    v_lshrrev_b32 v47, 14, v18
    v_bitop3_b32 v47, v47, v5, v46 bitop3:0xea
    ds_read_b64 v[104:105], v47 offset:63616
    v_bitop3_b32 v94, v18, v5, v46 bitop3:0xea
    s_waitcnt lgkmcnt(2)
    v_mfma_f32_4x4x4_16b_bf16 v[80:83], v[10:11], v[70:71], v[80:83]
    v_mfma_f32_4x4x4_16b_bf16 v[76:79], v[10:11], v[68:69], v[76:79]
    v_perm_b32 v15, v19, v20, s47
    v_bitop3_b32 v46, v19, 0.5, -0.5 bitop3:0xa8
    v_perm_b32 v14, v18, v20, s46
    v_bitop3_b32 v47, v18, 0.5, -0.5 bitop3:0xa8
    v_cvt_pk_bf16_f32 v80, v80, v81
    v_cvt_pk_bf16_f32 v81, v82, v83
    ds_wrxchg_rtn_b64 v[74:75], v93, v[80:81]
    v_cvt_pk_bf16_f32 v76, v76, v77
    v_cvt_pk_bf16_f32 v77, v78, v79
    ds_wrxchg_rtn_b64 v[72:73], v92, v[76:77]
    s_setprio 2
    s_waitcnt lgkmcnt(2)
    v_mfma_f32_4x4x4_16b_bf16 v[80:83], v[8:9], v[106:107], 0
    v_mfma_f32_4x4x4_16b_bf16 v[76:79], v[8:9], v[104:105], 0
    v_bitop3_b32 v15, v6, v15, v46 bitop3:0xca
    v_bitop3_b32 v14, v6, v14, v47 bitop3:0xca
    s_nop 1
    v_pk_mul_f32 v[80:81], v[80:81], v[14:15] op_sel:[0,1] op_sel_hi:[1,1]
    v_pk_mul_f32 v[82:83], v[82:83], v[14:15] op_sel:[0,1] op_sel_hi:[1,1]
    v_pk_mul_f32 v[76:77], v[76:77], v[14:15] op_sel:[0,0] op_sel_hi:[1,0]
    v_pk_mul_f32 v[78:79], v[78:79], v[14:15] op_sel:[0,0] op_sel_hi:[1,0]
    v_and_b32 v47, 0x0fffffff, v40
    v_mov_b32 v21, v40
    buffer_load_dwordx4 v[16:19], v47, s[8:11], 0 offen
    buffer_load_dwordx3 v[18:20], v47, s[8:11], 0 offen offset:8
    s_waitcnt lgkmcnt(0)
    v_cmpx_ne_u64 vcc, v[74:75], v[70:71]
    s_and_b64 s[82:83], vcc, s[80:81]
    s_cbranch_scc1 L2_c9
L2_d9:
    v_mov_b64 v[84:85], v[70:71]
    v_mov_b32 v7, v93
    v_mov_b64 v[86:87], v[74:75]
    s_mov_b64 exec, -1
    s_or_b64 s[80:81], s[80:81], vcc
    v_cmpx_ne_u64 vcc, v[72:73], v[68:69]
    s_and_b64 s[82:83], vcc, s[80:81]
    s_cbranch_scc1 L2_c10
L2_d10:
    v_mov_b64 v[84:85], v[68:69]
    v_mov_b32 v7, v92
    v_mov_b64 v[86:87], v[72:73]
    s_mov_b64 exec, -1
    s_or_b64 s[80:81], s[80:81], vcc
    ds_read_b64 v[70:71], v95
    ds_read_b64 v[68:69], v94
    s_waitcnt vmcnt(10)
    v_and_b32 v46, 0x20000000, v27
    v_lshrrev_b32 v47, 14, v23
    v_bitop3_b32 v47, v47, v5, v46 bitop3:0xea
    ds_read_b64 v[102:103], v47 offset:63616
    v_bitop3_b32 v93, v23, v5, v46 bitop3:0xea
    v_and_b32 v46, 0x10000000, v27
    v_lshrrev_b32 v47, 14, v22
    v_bitop3_b32 v47, v47, v5, v46 bitop3:0xea
    ds_read_b64 v[100:101], v47 offset:63616
    v_bitop3_b32 v92, v22, v5, v46 bitop3:0xea
    s_waitcnt lgkmcnt(2)
    v_mfma_f32_4x4x4_16b_bf16 v[80:83], v[10:11], v[70:71], v[80:83]
    v_mfma_f32_4x4x4_16b_bf16 v[76:79], v[10:11], v[68:69], v[76:79]
    v_perm_b32 v15, v23, v26, s45
    v_bitop3_b32 v46, v23, 0.5, -0.5 bitop3:0xa8
    v_perm_b32 v14, v22, v26, s44
    v_bitop3_b32 v47, v22, 0.5, -0.5 bitop3:0xa8
    v_cvt_pk_bf16_f32 v80, v80, v81
    v_cvt_pk_bf16_f32 v81, v82, v83
    ds_wrxchg_rtn_b64 v[74:75], v95, v[80:81]
    v_cvt_pk_bf16_f32 v76, v76, v77
    v_cvt_pk_bf16_f32 v77, v78, v79
    ds_wrxchg_rtn_b64 v[72:73], v94, v[76:77]
    s_waitcnt lgkmcnt(2)
    v_mfma_f32_4x4x4_16b_bf16 v[80:83], v[8:9], v[102:103], 0
    v_mfma_f32_4x4x4_16b_bf16 v[76:79], v[8:9], v[100:101], 0
    v_bitop3_b32 v15, v6, v15, v46 bitop3:0xca
    v_bitop3_b32 v14, v6, v14, v47 bitop3:0xca
    v_cmp_lt_u32 s[84:85], v5, v92
    s_nop 0
    v_pk_mul_f32 v[80:81], v[80:81], v[14:15] op_sel:[0,1] op_sel_hi:[1,1]
    v_pk_mul_f32 v[82:83], v[82:83], v[14:15] op_sel:[0,1] op_sel_hi:[1,1]
    v_pk_mul_f32 v[76:77], v[76:77], v[14:15] op_sel:[0,0] op_sel_hi:[1,0]
    v_pk_mul_f32 v[78:79], v[78:79], v[14:15] op_sel:[0,0] op_sel_hi:[1,0]
    v_sub_u16 v88, v60, v52
    v_and_b32 v89, 3, v52
    v_add3_u32 v99, v88, v89, 3
    v_and_b32 v99, -4, v99
    v_max_u32 v99, 4, v99
    v_and_b32 v97, 0xfffc, v52
    v_bfm_b32 v96, v88, v89
    v_add_u32_dpp v91, v99, v99 row_shr:1 row_mask:0xf bank_mask:0xf bound_ctrl:1
    v_mad_u32_u24 v97, v97, 5, v2
    v_cmp_lt_u32 vcc, 16, v99
    v_add_u32_dpp v91, v91, v91 row_shr:2 row_mask:0xf bank_mask:0xf bound_ctrl:1
    v_sub_u32 v98, s38, v99
    v_lshrrev_b64 v[52:53], 16, v[52:53]
    v_add_u32_dpp v91, v91, v91 row_shr:4 row_mask:0xf bank_mask:0xf bound_ctrl:1
    v_lshrrev_b64 v[60:61], 16, v[60:61]
    s_mov_b32 s43, 0
    v_add_u32_dpp v91, v91, v91 row_shr:8 row_mask:0xf bank_mask:0xf bound_ctrl:1
    s_nop 1
    v_add_u32_dpp v91, v91, v91 row_bcast:15 row_mask:0xa bank_mask:0xf
    s_nop 1
    v_add_u32_dpp v91, v91, v91 row_bcast:31 row_mask:0xc bank_mask:0xf
    v_add_u32 v98, v98, v91
    v_readlane_b32 s37, v91, 63
    s_cbranch_vccnz L2_xo11
L2_xp11:
    buffer_load_dwordx4 v[112:115], v3, s[16:19], s40 offen offset:1024
    s_waitcnt lgkmcnt(0)
    v_cmpx_ne_u64 vcc, v[74:75], v[70:71]
    s_and_b64 s[82:83], vcc, s[80:81]
    s_cbranch_scc1 L2_c12
L2_d12:
    v_mov_b64 v[84:85], v[70:71]
    v_mov_b32 v7, v95
    v_mov_b64 v[86:87], v[74:75]
    s_mov_b64 exec, -1
    s_or_b64 s[80:81], s[80:81], vcc
    v_cmpx_ne_u64 vcc, v[72:73], v[68:69]
    s_and_b64 s[82:83], vcc, s[80:81]
    s_cbranch_scc1 L2_c13
L2_d13:
    v_mov_b64 v[84:85], v[68:69]
    v_mov_b32 v7, v94
    v_mov_b64 v[86:87], v[72:73]
    s_mov_b64 exec, -1
    s_or_b64 s[80:81], s[80:81], vcc
    ds_read_b64 v[70:71], v93
    s_and_b64 exec, s[84:85], s[80:81]
    v_mfma_f32_4x4x4_16b_bf16 v[76:79], v[12:13], v[84:85], 0
    v_mov_b32 v92, v7
    s_andn2_b64 s[80:81], s[80:81], s[84:85]
    v_mfma_f32_4x4x4_16b_bf16 v[76:79], v[10:11], v[86:87], v[76:79]
    s_mov_b64 exec, -1
    ds_read_b64 v[68:69], v92
    v_and_b32 v46, 0x80000000, v27
    v_lshrrev_b32 v47, 14, v25
    v_bitop3_b32 v47, v47, v5, v46 bitop3:0xea
    ds_read_b64 v[106:107], v47 offset:63616
    v_bitop3_b32 v95, v25, v5, v46 bitop3:0xea
    v_and_b32 v46, 0x40000000, v27
    v_lshrrev_b32 v47, 14, v24
    v_bitop3_b32 v47, v47, v5, v46 bitop3:0xea
    ds_read_b64 v[104:105], v47 offset:63616
    v_bitop3_b32 v94, v24, v5, v46 bitop3:0xea
    s_waitcnt lgkmcnt(2)
    v_mfma_f32_4x4x4_16b_bf16 v[80:83], v[10:11], v[70:71], v[80:83]
    v_mfma_f32_4x4x4_16b_bf16 v[76:79], v[10:11], v[68:69], v[76:79]
    v_perm_b32 v15, v25, v26, s47
    v_bitop3_b32 v46, v25, 0.5, -0.5 bitop3:0xa8
    v_perm_b32 v14, v24, v26, s46
    v_bitop3_b32 v47, v24, 0.5, -0.5 bitop3:0xa8
    v_cvt_pk_bf16_f32 v80, v80, v81
    v_cvt_pk_bf16_f32 v81, v82, v83
    ds_wrxchg_rtn_b64 v[74:75], v93, v[80:81]
    v_cvt_pk_bf16_f32 v76, v76, v77
    v_cvt_pk_bf16_f32 v77, v78, v79
    ds_wrxchg_rtn_b64 v[72:73], v92, v[76:77]
    s_setprio 1
    s_waitcnt lgkmcnt(2)
    v_mfma_f32_4x4x4_16b_bf16 v[80:83], v[8:9], v[106:107], 0
    v_mfma_f32_4x4x4_16b_bf16 v[76:79], v[8:9], v[104:105], 0
    v_bitop3_b32 v15, v6, v15, v46 bitop3:0xca
    v_bitop3_b32 v14, v6, v14, v47 bitop3:0xca
    s_nop 1
    v_pk_mul_f32 v[80:81], v[80:81], v[14:15] op_sel:[0,1] op_sel_hi:[1,1]
    v_pk_mul_f32 v[82:83], v[82:83], v[14:15] op_sel:[0,1] op_sel_hi:[1,1]
    v_pk_mul_f32 v[76:77], v[76:77], v[14:15] op_sel:[0,0] op_sel_hi:[1,0]
    v_pk_mul_f32 v[78:79], v[78:79], v[14:15] op_sel:[0,0] op_sel_hi:[1,0]
    v_and_b32 v47, 0x0fffffff, v41
    v_mov_b32 v27, v41
    buffer_load_dwordx4 v[22:25], v47, s[8:11], 0 offen
    buffer_load_dwordx3 v[24:26], v47, s[8:11], 0 offen offset:8
    s_waitcnt lgkmcnt(0)
    v_cmpx_ne_u64 vcc, v[74:75], v[70:71]
    s_and_b64 s[82:83], vcc, s[80:81]
    s_cbranch_scc1 L2_c14
L2_d14:
    v_mov_b64 v[84:85], v[70:71]
    v_mov_b32 v7, v93
    v_mov_b64 v[86:87], v[74:75]
    s_mov_b64 exec, -1
    s_or_b64 s[80:81], s[80:81], vcc
    v_cmpx_ne_u64 vcc, v[72:73], v[68:69]
    s_and_b64 s[82:83], vcc, s[80:81]
    s_cbranch_scc1 L2_c15
L2_d15:
    v_mov_b64 v[84:85], v[68:69]
    v_mov_b32 v7, v92
    v_mov_b64 v[86:87], v[72:73]
    s_mov_b64 exec, -1
    s_or_b64 s[80:81], s[80:81], vcc
    ds_read_b64 v[70:71], v95
    ds_read_b64 v[68:69], v94
    s_waitcnt vmcnt(11)
    v_and_b32 v46, 0x20000000, v33
    v_lshrrev_b32 v47, 14, v29
    v_bitop3_b32 v47, v47, v5, v46 bitop3:0xea
    ds_read_b64 v[102:103], v47 offset:63616
    v_bitop3_b32 v93, v29, v5, v46 bitop3:0xea
    v_and_b32 v46, 0x10000000, v33
    v_lshrrev_b32 v47, 14, v28
    v_bitop3_b32 v47, v47, v5, v46 bitop3:0xea
    ds_read_b64 v[100:101], v47 offset:63616
    v_bitop3_b32 v92, v28, v5, v46 bitop3:0xea
    s_waitcnt lgkmcnt(2)
    v_mfma_f32_4x4x4_16b_bf16 v[80:83], v[10:11], v[70:71], v[80:83]
    v_mfma_f32_4x4x4_16b_bf16 v[76:79], v[10:11], v[68:69], v[76:79]
    v_perm_b32 v15, v29, v32, s45
    v_bitop3_b32 v46, v29, 0.5, -0.5 bitop3:0xa8
    v_perm_b32 v14, v28, v32, s44
    v_bitop3_b32 v47, v28, 0.5, -0.5 bitop3:0xa8
    v_cvt_pk_bf16_f32 v80, v80, v81
    v_cvt_pk_bf16_f32 v81, v82, v83
    ds_wrxchg_rtn_b64 v[74:75], v95, v[80:81]
    v_cvt_pk_bf16_f32 v76, v76, v77
    v_cvt_pk_bf16_f32 v77, v78, v79
    ds_wrxchg_rtn_b64 v[72:73], v94, v[76:77]
    s_waitcnt lgkmcnt(2)
    v_mfma_f32_4x4x4_16b_bf16 v[80:83], v[8:9], v[102:103], 0
    v_mfma_f32_4x4x4_16b_bf16 v[76:79], v[8:9], v[100:101], 0
    v_bitop3_b32 v15, v6, v15, v46 bitop3:0xca
    v_bitop3_b32 v14, v6, v14, v47 bitop3:0xca
    v_cmp_lt_u32 s[84:85], v5, v92
    s_nop 0
    v_pk_mul_f32 v[80:81], v[80:81], v[14:15] op_sel:[0,1] op_sel_hi:[1,1]
    v_pk_mul_f32 v[82:83], v[82:83], v[14:15] op_sel:[0,1] op_sel_hi:[1,1]
    v_pk_mul_f32 v[76:77], v[76:77], v[14:15] op_sel:[0,0] op_sel_hi:[1,0]
    v_pk_mul_f32 v[78:79], v[78:79], v[14:15] op_sel:[0,0] op_sel_hi:[1,0]
    s_waitcnt lgkmcnt(0)
    v_cmpx_ne_u64 vcc, v[74:75], v[70:71]
    s_and_b64 s[82:83], vcc, s[80:81]
    s_cbranch_scc1 L2_c16
L2_d16:
    v_mov_b64 v[84:85], v[70:71]
    v_mov_b32 v7, v95
    v_mov_b64 v[86:87], v[74:75]
    s_mov_b64 exec, -1
    s_or_b64 s[80:81], s[80:81], vcc
    v_cmpx_ne_u64 vcc, v[72:73], v[68:69]
    s_and_b64 s[82:83], vcc, s[80:81]
    s_cbranch_scc1 L2_c17
L2_d17:
    v_mov_b64 v[84:85], v[68:69]
    v_mov_b32 v7, v94
    v_mov_b64 v[86:87], v[72:73]
    s_mov_b64 exec, -1
    s_or_b64 s[80:81], s[80:81], vcc
    ds_read_b64 v[70:71], v93
    s_and_b64 exec, s[84:85], s[80:81]
    v_mfma_f32_4x4x4_16b_bf16 v[76:79], v[12:13], v[84:85], 0
    v_mov_b32 v92, v7
    s_andn2_b64 s[80:81], s[80:81], s[84:85]
    v_mfma_f32_4x4x4_16b_bf16 v[76:79], v[10:11], v[86:87], v[76:79]
    s_mov_b64 exec, -1
    ds_read_b64 v[68:69], v92
    v_and_b32 v46, 0x80000000, v33
    v_lshrrev_b32 v47, 14, v31
    v_bitop3_b32 v47, v47, v5, v46 bitop3:0xea
    ds_read_b64 v[106:107], v47 offset:63616
    v_bitop3_b32 v95, v31, v5, v46 bitop3:0xea
    v_and_b32 v46, 0x40000000, v33
    v_lshrrev_b32 v47, 14, v30
    v_bitop3_b32 v47, v47, v5, v46 bitop3:0xea
    ds_read_b64 v[104:105], v47 offset:63616
    v_bitop3_b32 v94, v30, v5, v46 bitop3:0xea
    s_waitcnt lgkmcnt(2)
    v_mfma_f32_4x4x4_16b_bf16 v[80:83], v[10:11], v[70:71], v[80:83]
    v_mfma_f32_4x4x4_16b_bf16 v[76:79], v[10:11], v[68:69], v[76:79]
    v_perm_b32 v15, v31, v32, s47
    v_bitop3_b32 v46, v31, 0.5, -0.5 bitop3:0xa8
    v_perm_b32 v14, v30, v32, s46
    v_bitop3_b32 v47, v30, 0.5, -0.5 bitop3:0xa8
    v_cvt_pk_bf16_f32 v80, v80, v81
    v_cvt_pk_bf16_f32 v81, v82, v83
    ds_wrxchg_rtn_b64 v[74:75], v93, v[80:81]
    v_cvt_pk_bf16_f32 v76, v76, v77
    v_cvt_pk_bf16_f32 v77, v78, v79
    ds_wrxchg_rtn_b64 v[72:73], v92, v[76:77]
    s_setprio 0
    s_waitcnt lgkmcnt(2)
    v_mfma_f32_4x4x4_16b_bf16 v[80:83], v[8:9], v[106:107], 0
    v_mfma_f32_4x4x4_16b_bf16 v[76:79], v[8:9], v[104:105], 0
    v_bitop3_b32 v15, v6, v15, v46 bitop3:0xca
    v_bitop3_b32 v14, v6, v14, v47 bitop3:0xca
    s_nop 1
    v_pk_mul_f32 v[80:81], v[80:81], v[14:15] op_sel:[0,1] op_sel_hi:[1,1]
    v_pk_mul_f32 v[82:83], v[82:83], v[14:15] op_sel:[0,1] op_sel_hi:[1,1]
    v_pk_mul_f32 v[76:77], v[76:77], v[14:15] op_sel:[0,0] op_sel_hi:[1,0]
    v_pk_mul_f32 v[78:79], v[78:79], v[14:15] op_sel:[0,0] op_sel_hi:[1,0]
    s_add_u32 s40, s40, 0x4e200
    v_and_b32 v47, 0x0fffffff, v42
    v_mov_b32 v33, v42
    buffer_load_dwordx4 v[28:31], v47, s[8:11], 0 offen
    buffer_load_dwordx3 v[30:32], v47, s[8:11], 0 offen offset:8
    s_waitcnt lgkmcnt(0)
    v_cmpx_ne_u64 vcc, v[74:75], v[70:71]
    s_and_b64 s[82:83], vcc, s[80:81]
    s_cbranch_scc1 L2_c18
L2_d18:
    v_mov_b64 v[84:85], v[70:71]
    v_mov_b32 v7, v93
    v_mov_b64 v[86:87], v[74:75]
    s_mov_b64 exec, -1
    s_or_b64 s[80:81], s[80:81], vcc
    v_cmpx_ne_u64 vcc, v[72:73], v[68:69]
    s_and_b64 s[82:83], vcc, s[80:81]
    s_cbranch_scc1 L2_c19
L2_d19:
    v_mov_b64 v[84:85], v[68:69]
    v_mov_b32 v7, v92
    v_mov_b64 v[86:87], v[72:73]
    s_mov_b64 exec, -1
    s_or_b64 s[80:81], s[80:81], vcc
    ds_read_b64 v[70:71], v95
    ds_read_b64 v[68:69], v94
    s_waitcnt vmcnt(8)
    v_and_b32 v46, 0x20000000, v39
    v_lshrrev_b32 v47, 14, v35
    v_bitop3_b32 v47, v47, v5, v46 bitop3:0xea
    ds_read_b64 v[102:103], v47 offset:63616
    v_bitop3_b32 v93, v35, v5, v46 bitop3:0xea
    v_and_b32 v46, 0x10000000, v39
    v_lshrrev_b32 v47, 14, v34
    v_bitop3_b32 v47, v47, v5, v46 bitop3:0xea
    ds_read_b64 v[100:101], v47 offset:63616
    v_bitop3_b32 v92, v34, v5, v46 bitop3:0xea
    v_and_b32 v46, 0x80000000, v39
    v_lshrrev_b32 v47, 14, v37
    v_bitop3_b32 v47, v47, v5, v46 bitop3:0xea
    ds_read_b64 v[106:107], v47 offset:63616
    v_and_b32 v46, 0x40000000, v39
    v_lshrrev_b32 v47, 14, v36
    v_bitop3_b32 v47, v47, v5, v46 bitop3:0xea
    ds_read_b64 v[104:105], v47 offset:63616
    s_waitcnt lgkmcnt(4)
    v_mfma_f32_4x4x4_16b_bf16 v[80:83], v[10:11], v[70:71], v[80:83]
    v_mfma_f32_4x4x4_16b_bf16 v[76:79], v[10:11], v[68:69], v[76:79]
    v_perm_b32 v15, v35, v38, s45
    v_bitop3_b32 v46, v35, 0.5, -0.5 bitop3:0xa8
    v_perm_b32 v14, v34, v38, s44
    v_bitop3_b32 v47, v34, 0.5, -0.5 bitop3:0xa8
    v_cvt_pk_bf16_f32 v80, v80, v81
    v_cvt_pk_bf16_f32 v81, v82, v83
    ds_wrxchg_rtn_b64 v[74:75], v95, v[80:81]
    v_cvt_pk_bf16_f32 v76, v76, v77
    v_cvt_pk_bf16_f32 v77, v78, v79
    ds_wrxchg_rtn_b64 v[72:73], v94, v[76:77]
    s_waitcnt lgkmcnt(2)
    s_barrier
    s_setprio 3
    ds_write_b128 v3, v[124:127] offset:4096
    s_add_u32 s3, s40, 4096
    buffer_load_dwordx4 v[124:127], v3, s[16:19], s3 offen
    ds_write_b128 v3, v[116:119] offset:2048
    buffer_load_dwordx4 v[116:119], v3, s[16:19], s40 offen offset:2048
    ds_write_b128 v3, v[120:123] offset:3072
    buffer_load_dwordx4 v[120:123], v3, s[16:19], s40 offen offset:3072
    v_mfma_f32_4x4x4_16b_bf16 v[80:83], v[8:9], v[102:103], 0
    v_mfma_f32_4x4x4_16b_bf16 v[76:79], v[8:9], v[100:101], 0
    v_bitop3_b32 v15, v6, v15, v46 bitop3:0xca
    v_bitop3_b32 v14, v6, v14, v47 bitop3:0xca
    v_cmp_lt_u32 s[84:85], v5, v92
    s_nop 0
    v_pk_mul_f32 v[80:81], v[80:81], v[14:15] op_sel:[0,1] op_sel_hi:[1,1]
    v_pk_mul_f32 v[82:83], v[82:83], v[14:15] op_sel:[0,1] op_sel_hi:[1,1]
    v_pk_mul_f32 v[76:77], v[76:77], v[14:15] op_sel:[0,0] op_sel_hi:[1,0]
    v_pk_mul_f32 v[78:79], v[78:79], v[14:15] op_sel:[0,0] op_sel_hi:[1,0]
    v_mov_b32 v44, v43
    s_cmp_gt_u32 s37, 1024
    s_cbranch_scc1 L2_xs20
    s_cmp_lg_u32 s43, 0
    s_cbranch_scc1 L2_xa20
L2_xb20:
    v_lshlrev_b32 v89, 16, v96
    v_add_u32 v90, 60, v97
    v_bitop3_b32 v90, v89, v45, v90 bitop3:0x6a
    ds_write_b32 v98, v90 offset:12
    v_lshlrev_b32 v89, 20, v96
    v_add_u32 v90, 40, v97
    v_bitop3_b32 v90, v89, v45, v90 bitop3:0x6a
    ds_write_b32 v98, v90 offset:8
    v_lshlrev_b32 v89, 24, v96
    v_add_u32 v90, 20, v97
    v_bitop3_b32 v90, v89, v45, v90 bitop3:0x6a
    ds_write_b32 v98, v90 offset:4
    v_lshlrev_b32 v89, 28, v96
    v_bitop3_b32 v90, v89, v45, v97 bitop3:0x6a
    ds_write_b32 v98, v90 offset:0
    v_mov_b32_dpp v91, v64 quad_perm:[1,1,1,1] row_mask:0xf bank_mask:0xf
    v_and_b32 v89, 3, v91
    v_and_b32 v97, 0xfffc, v91
    v_sub_u16_dpp v88, v64, v91 quad_perm:[3,3,3,3] row_mask:0xf bank_mask:0xf
    v_mad_u32_u24 v97, v97, 5, v4
    v_add_u32 v99, v88, v89
    v_bfm_b32 v96, v88, v89
    v_cmp_lt_u32 s[58:59], 16, v99
    v_lshlrev_b32 v89, v1, v96
    v_and_b32 v89, v45, v89
    v_cmp_ne_u32 vcc, 0, v89
    v_xor_b32 v90, v97, v89
    s_add_u32 s3, s37, s38
    v_mbcnt_lo_u32_b32 v98, vcc_lo, 0
    v_mbcnt_hi_u32_b32 v98, vcc_hi, v98
    s_bcnt1_i32_b64 s41, vcc
    v_lshl_add_u32 v98, v98, 2, s3
    s_mov_b64 exec, vcc
    ds_write_b32 v98, v90
    s_mov_b64 exec, -1
    s_lshl2_add_u32 s37, s41, s37
    s_cmp_lg_u64 s[58:59], 0
    s_cbranch_scc1 L2_xe20
L2_xr20:
    v_add_u32 v98, s37, v0
    v_mov_b32 v90, -1
    ds_write_b32 v98, v90
    ds_read2st64_b32 v[40:41], v0 offset0:0 offset1:1
    ds_read2st64_b32 v[42:43], v0 offset0:2 offset1:3
    s_sub_u32 s3, s37, 768
    s_cmp_gt_u32 s3, 256
    s_cbranch_scc1 L2_xf20
L2_xg20:
    s_setprio 2
    s_waitcnt vmcnt(10)
    ds_write_b128 v3, v[108:111] offset:0
    s_waitcnt lgkmcnt(12)
    v_cmpx_ne_u64 vcc, v[74:75], v[70:71]
    s_and_b64 s[82:83], vcc, s[80:81]
    s_cbranch_scc1 L2_c21
L2_d21:
    v_mov_b64 v[84:85], v[70:71]
    v_mov_b32 v7, v95
    v_mov_b64 v[86:87], v[74:75]
    s_mov_b64 exec, -1
    s_or_b64 s[80:81], s[80:81], vcc
    v_cmpx_ne_u64 vcc, v[72:73], v[68:69]
    s_and_b64 s[82:83], vcc, s[80:81]
    s_cbranch_scc1 L2_c22
L2_d22:
    v_mov_b64 v[84:85], v[68:69]
    v_mov_b32 v7, v94
    v_mov_b64 v[86:87], v[72:73]
    s_mov_b64 exec, -1
    s_or_b64 s[80:81], s[80:81], vcc
    ds_read_b64 v[70:71], v93
    s_and_b64 exec, s[84:85], s[80:81]
    v_mfma_f32_4x4x4_16b_bf16 v[76:79], v[12:13], v[84:85], 0
    v_mov_b32 v92, v7
    s_andn2_b64 s[80:81], s[80:81], s[84:85]
    v_mfma_f32_4x4x4_16b_bf16 v[76:79], v[10:11], v[86:87], v[76:79]
    s_mov_b64 exec, -1
    ds_read_b64 v[68:69], v92
    s_setprio 1
    s_waitcnt vmcnt(7)
    ds_write_b128 v3, v[112:115] offset:1024
    s_waitcnt lgkmcnt(1)
    v_mfma_f32_4x4x4_16b_bf16 v[80:83], v[10:11], v[70:71], v[80:83]
    v_mfma_f32_4x4x4_16b_bf16 v[76:79], v[10:11], v[68:69], v[76:79]
    v_and_b32 v46, 0x40000000, v39
    v_bitop3_b32 v94, v36, v5, v46 bitop3:0xea
    v_and_b32 v46, 0x80000000, v39
    v_bitop3_b32 v95, v37, v5, v46 bitop3:0xea
    v_perm_b32 v15, v37, v38, s47
    v_bitop3_b32 v46, v37, 0.5, -0.5 bitop3:0xa8
    v_perm_b32 v14, v36, v38, s46
    v_bitop3_b32 v47, v36, 0.5, -0.5 bitop3:0xa8
    v_cvt_pk_bf16_f32 v80, v80, v81
    v_cvt_pk_bf16_f32 v81, v82, v83
    ds_wrxchg_rtn_b64 v[74:75], v93, v[80:81]
    v_cvt_pk_bf16_f32 v76, v76, v77
    v_cvt_pk_bf16_f32 v77, v78, v79
    ds_wrxchg_rtn_b64 v[72:73], v92, v[76:77]
    s_setprio 0
    v_mfma_f32_4x4x4_16b_bf16 v[80:83], v[8:9], v[106:107], 0
    v_mfma_f32_4x4x4_16b_bf16 v[76:79], v[8:9], v[104:105], 0
    v_bitop3_b32 v15, v6, v15, v46 bitop3:0xca
    v_bitop3_b32 v14, v6, v14, v47 bitop3:0xca
    s_nop 1
    v_pk_mul_f32 v[80:81], v[80:81], v[14:15] op_sel:[0,1] op_sel_hi:[1,1]
    v_pk_mul_f32 v[82:83], v[82:83], v[14:15] op_sel:[0,1] op_sel_hi:[1,1]
    v_pk_mul_f32 v[76:77], v[76:77], v[14:15] op_sel:[0,0] op_sel_hi:[1,0]
    v_pk_mul_f32 v[78:79], v[78:79], v[14:15] op_sel:[0,0] op_sel_hi:[1,0]
    s_add_u32 s42, s42, 1
    s_waitcnt lgkmcnt(2)
    s_barrier
    s_bitcmp1_b32 s36, s42
    s_cbranch_scc1 L2_slow
L2_ret1:
    s_setprio 3
    v_and_b32 v47, 0x0fffffff, v44
    v_mov_b32 v39, v44
    buffer_load_dwordx4 v[34:37], v47, s[8:11], 0 offen
    buffer_load_dwordx3 v[36:38], v47, s[8:11], 0 offen offset:8
    s_waitcnt lgkmcnt(0)
    v_cmpx_ne_u64 vcc, v[74:75], v[70:71]
    s_and_b64 s[82:83], vcc, s[80:81]
    s_cbranch_scc1 L2_c23
L2_d23:
    v_mov_b64 v[84:85], v[70:71]
    v_mov_b32 v7, v93
    v_mov_b64 v[86:87], v[74:75]
    s_mov_b64 exec, -1
    s_or_b64 s[80:81], s[80:81], vcc
    v_cmpx_ne_u64 vcc, v[72:73], v[68:69]
    s_and_b64 s[82:83], vcc, s[80:81]
    s_cbranch_scc1 L2_c24
L2_d24:
    v_mov_b64 v[84:85], v[68:69]
    v_mov_b32 v7, v92
    v_mov_b64 v[86:87], v[72:73]
    s_mov_b64 exec, -1
    s_or_b64 s[80:81], s[80:81], vcc
    ds_read_b64 v[70:71], v95
    ds_read_b64 v[68:69], v94
    v_and_b32 v46, 0x20000000, v21
    v_lshrrev_b32 v47, 14, v17
    v_bitop3_b32 v47, v47, v5, v46 bitop3:0xea
    ds_read_b64 v[102:103], v47 offset:63616
    v_bitop3_b32 v93, v17, v5, v46 bitop3:0xea
    v_and_b32 v46, 0x10000000, v21
    v_lshrrev_b32 v47, 14, v16
    v_bitop3_b32 v47, v47, v5, v46 bitop3:0xea
    ds_read_b64 v[100:101], v47 offset:63616
    v_bitop3_b32 v92, v16, v5, v46 bitop3:0xea
    s_waitcnt lgkmcnt(2)
    v_mfma_f32_4x4x4_16b_bf16 v[80:83], v[10:11], v[70:71], v[80:83]
    v_mfma_f32_4x4x4_16b_bf16 v[76:79], v[10:11], v[68:69], v[76:79]
    v_perm_b32 v15, v17, v20, s45
    v_bitop3_b32 v46, v17, 0.5, -0.5 bitop3:0xa8
    v_perm_b32 v14, v16, v20, s44
    v_bitop3_b32 v47, v16, 0.5, -0.5 bitop3:0xa8
    v_cvt_pk_bf16_f32 v80, v80, v81
    v_cvt_pk_bf16_f32 v81, v82, v83
    ds_wrxchg_rtn_b64 v[74:75], v95, v[80:81]
    v_cvt_pk_bf16_f32 v76, v76, v77
    v_cvt_pk_bf16_f32 v77, v78, v79
    ds_wrxchg_rtn_b64 v[72:73], v94, v[76:77]
    s_waitcnt lgkmcnt(2)
    v_mfma_f32_4x4x4_16b_bf16 v[80:83], v[8:9], v[102:103], 0
    v_mfma_f32_4x4x4_16b_bf16 v[76:79], v[8:9], v[100:101], 0
    v_bitop3_b32 v15, v6, v15, v46 bitop3:0xca
    v_bitop3_b32 v14, v6, v14, v47 bitop3:0xca
    v_cmp_lt_u32 s[84:85], v5, v92
    s_nop 0
    v_pk_mul_f32 v[80:81], v[80:81], v[14:15] op_sel:[0,1] op_sel_hi:[1,1]
    v_pk_mul_f32 v[82:83], v[82:83], v[14:15] op_sel:[0,1] op_sel_hi:[1,1]
    v_pk_mul_f32 v[76:77], v[76:77], v[14:15] op_sel:[0,0] op_sel_hi:[1,0]
    v_pk_mul_f32 v[78:79], v[78:79], v[14:15] op_sel:[0,0] op_sel_hi:[1,0]
    buffer_load_dwordx4 v[108:111], v3, s[16:19], s40 offen offset:0
    s_waitcnt lgkmcnt(0)
    v_cmpx_ne_u64 vcc, v[74:75], v[70:71]
    s_and_b64 s[82:83], vcc, s[80:81]
    s_cbranch_scc1 L2_c25
L2_d25:
    v_mov_b64 v[84:85], v[70:71]
    v_mov_b32 v7, v95
    v_mov_b64 v[86:87], v[74:75]
    s_mov_b64 exec, -1
    s_or_b64 s[80:81], s[80:81], vcc
    v_cmpx_ne_u64 vcc, v[72:73], v[68:69]
    s_and_b64 s[82:83], vcc, s[80:81]
    s_cbranch_scc1 L2_c26
L2_d26:
    v_mov_b64 v[84:85], v[68:69]
    v_mov_b32 v7, v94
    v_mov_b64 v[86:87], v[72:73]
    s_mov_b64 exec, -1
    s_or_b64 s[80:81], s[80:81], vcc
    ds_read_b64 v[70:71], v93
    s_and_b64 exec, s[84:85], s[80:81]
    v_mfma_f32_4x4x4_16b_bf16 v[76:79], v[12:13], v[84:85], 0
    v_mov_b32 v92, v7
    s_andn2_b64 s[80:81], s[80:81], s[84:85]
    v_mfma_f32_4x4x4_16b_bf16 v[76:79], v[10:11], v[86:87], v[76:79]
    s_mov_b64 exec, -1
    ds_read_b64 v[68:69], v92
    v_and_b32 v46, 0x80000000, v21
    v_lshrrev_b32 v47, 14, v19
    v_bitop3_b32 v47, v47, v5, v46 bitop3:0xea
    ds_read_b64 v[106:107], v47 offset:63616
    v_bitop3_b32 v95, v19, v5, v46 bitop3:0xea
    v_and_b32 v46, 0x40000000, v21
    v_lshrrev_b32 v47, 14, v18
    v_bitop3_b32 v47, v47, v5, v46 bitop3:0xea
    ds_read_b64 v[104:105], v47 offset:63616
    v_bitop3_b32 v94, v18, v5, v46 bitop3:0xea
    s_waitcnt lgkmcnt(2)
    v_mfma_f32_4x4x4_16b_bf16 v[80:83], v[10:11], v[70:71], v[80:83]
    v_mfma_f32_4x4x4_16b_bf16 v[76:79], v[10:11], v[68:69], v[76:79]
    v_perm_b32 v15, v19, v20, s47
    v_bitop3_b32 v46, v19, 0.5, -0.5 bitop3:0xa8
    v_perm_b32 v14, v18, v20, s46
    v_bitop3_b32 v47, v18, 0.5, -0.5 bitop3:0xa8
    v_cvt_pk_bf16_f32 v80, v80, v81
    v_cvt_pk_bf16_f32 v81, v82, v83
    ds_wrxchg_rtn_b64 v[74:75], v93, v[80:81]
    v_cvt_pk_bf16_f32 v76, v76, v77
    v_cvt_pk_bf16_f32 v77, v78, v79
    ds_wrxchg_rtn_b64 v[72:73], v92, v[76:77]
    s_setprio 2
    s_waitcnt lgkmcnt(2)
    v_mfma_f32_4x4x4_16b_bf16 v[80:83], v[8:9], v[106:107], 0
    v_mfma_f32_4x4x4_16b_bf16 v[76:79], v[8:9], v[104:105], 0
    v_bitop3_b32 v15, v6, v15, v46 bitop3:0xca
    v_bitop3_b32 v14, v6, v14, v47 bitop3:0xca
    s_nop 1
    v_pk_mul_f32 v[80:81], v[80:81], v[14:15] op_sel:[0,1] op_sel_hi:[1,1]
    v_pk_mul_f32 v[82:83], v[82:83], v[14:15] op_sel:[0,1] op_sel_hi:[1,1]
    v_pk_mul_f32 v[76:77], v[76:77], v[14:15] op_sel:[0,0] op_sel_hi:[1,0]
    v_pk_mul_f32 v[78:79], v[78:79], v[14:15] op_sel:[0,0] op_sel_hi:[1,0]
    v_and_b32 v47, 0x0fffffff, v40
    v_mov_b32 v21, v40
    buffer_load_dwordx4 v[16:19], v47, s[8:11], 0 offen
    buffer_load_dwordx3 v[18:20], v47, s[8:11], 0 offen offset:8
    s_waitcnt lgkmcnt(0)
    v_cmpx_ne_u64 vcc, v[74:75], v[70:71]
    s_and_b64 s[82:83], vcc, s[80:81]
    s_cbranch_scc1 L2_c27
L2_d27:
    v_mov_b64 v[84:85], v[70:71]
    v_mov_b32 v7, v93
    v_mov_b64 v[86:87], v[74:75]
    s_mov_b64 exec, -1
    s_or_b64 s[80:81], s[80:81], vcc
    v_cmpx_ne_u64 vcc, v[72:73], v[68:69]
    s_and_b64 s[82:83], vcc, s[80:81]
    s_cbranch_scc1 L2_c28
L2_d28:
    v_mov_b64 v[84:85], v[68:69]
    v_mov_b32 v7, v92
    v_mov_b64 v[86:87], v[72:73]
    s_mov_b64 exec, -1
    s_or_b64 s[80:81], s[80:81], vcc
    ds_read_b64 v[70:71], v95
    ds_read_b64 v[68:69], v94
    s_waitcnt vmcnt(10)
    v_and_b32 v46, 0x20000000, v27
    v_lshrrev_b32 v47, 14, v23
    v_bitop3_b32 v47, v47, v5, v46 bitop3:0xea
    ds_read_b64 v[102:103], v47 offset:63616
    v_bitop3_b32 v93, v23, v5, v46 bitop3:0xea
    v_and_b32 v46, 0x10000000, v27
    v_lshrrev_b32 v47, 14, v22
    v_bitop3_b32 v47, v47, v5, v46 bitop3:0xea
    ds_read_b64 v[100:101], v47 offset:63616
    v_bitop3_b32 v92, v22, v5, v46 bitop3:0xea
    s_waitcnt lgkmcnt(2)
    v_mfma_f32_4x4x4_16b_bf16 v[80:83], v[10:11], v[70:71], v[80:83]
    v_mfma_f32_4x4x4_16b_bf16 v[76:79], v[10:11], v[68:69], v[76:79]
    v_perm_b32 v15, v23, v26, s45
    v_bitop3_b32 v46, v23, 0.5, -0.5 bitop3:0xa8
    v_perm_b32 v14, v22, v26, s44
    v_bitop3_b32 v47, v22, 0.5, -0.5 bitop3:0xa8
    v_cvt_pk_bf16_f32 v80, v80, v81
    v_cvt_pk_bf16_f32 v81, v82, v83
    ds_wrxchg_rtn_b64 v[74:75], v95, v[80:81]
    v_cvt_pk_bf16_f32 v76, v76, v77
    v_cvt_pk_bf16_f32 v77, v78, v79
    ds_wrxchg_rtn_b64 v[72:73], v94, v[76:77]
    s_waitcnt lgkmcnt(2)
    v_mfma_f32_4x4x4_16b_bf16 v[80:83], v[8:9], v[102:103], 0
    v_mfma_f32_4x4x4_16b_bf16 v[76:79], v[8:9], v[100:101], 0
    v_bitop3_b32 v15, v6, v15, v46 bitop3:0xca
    v_bitop3_b32 v14, v6, v14, v47 bitop3:0xca
    v_cmp_lt_u32 s[84:85], v5, v92
    s_nop 0
    v_pk_mul_f32 v[80:81], v[80:81], v[14:15] op_sel:[0,1] op_sel_hi:[1,1]
    v_pk_mul_f32 v[82:83], v[82:83], v[14:15] op_sel:[0,1] op_sel_hi:[1,1]
    v_pk_mul_f32 v[76:77], v[76:77], v[14:15] op_sel:[0,0] op_sel_hi:[1,0]
    v_pk_mul_f32 v[78:79], v[78:79], v[14:15] op_sel:[0,0] op_sel_hi:[1,0]
    v_sub_u16 v88, v62, v54
    v_and_b32 v89, 3, v54
    v_add3_u32 v99, v88, v89, 3
    v_and_b32 v99, -4, v99
    v_max_u32 v99, 4, v99
    v_and_b32 v97, 0xfffc, v54
    v_bfm_b32 v96, v88, v89
    v_add_u32_dpp v91, v99, v99 row_shr:1 row_mask:0xf bank_mask:0xf bound_ctrl:1
    v_mad_u32_u24 v97, v97, 5, v2
    v_cmp_lt_u32 vcc, 16, v99
    v_add_u32_dpp v91, v91, v91 row_shr:2 row_mask:0xf bank_mask:0xf bound_ctrl:1
    v_sub_u32 v98, s38, v99
    v_lshrrev_b64 v[54:55], 16, v[54:55]
    v_add_u32_dpp v91, v91, v91 row_shr:4 row_mask:0xf bank_mask:0xf bound_ctrl:1
    v_lshrrev_b64 v[62:63], 16, v[62:63]
    s_mov_b32 s43, 0
    v_add_u32_dpp v91, v91, v91 row_shr:8 row_mask:0xf bank_mask:0xf bound_ctrl:1
    s_nop 1
    v_add_u32_dpp v91, v91, v91 row_bcast:15 row_mask:0xa bank_mask:0xf
    s_nop 1
    v_add_u32_dpp v91, v91, v91 row_bcast:31 row_mask:0xc bank_mask:0xf
    v_add_u32 v98, v98, v91
    v_readlane_b32 s37, v91, 63
    s_cbranch_vccnz L2_xo29
L2_xp29:
    buffer_load_dwordx4 v[112:115], v3, s[16:19], s40 offen offset:1024
    s_waitcnt lgkmcnt(0)
    v_cmpx_ne_u64 vcc, v[74:75], v[70:71]
    s_and_b64 s[82:83], vcc, s[80:81]
    s_cbranch_scc1 L2_c30
L2_d30:
    v_mov_b64 v[84:85], v[70:71]
    v_mov_b32 v7, v95
    v_mov_b64 v[86:87], v[74:75]
    s_mov_b64 exec, -1
    s_or_b64 s[80:81], s[80:81], vcc
    v_cmpx_ne_u64 vcc, v[72:73], v[68:69]
    s_and_b64 s[82:83], vcc, s[80:81]
    s_cbranch_scc1 L2_c31
L2_d31:
    v_mov_b64 v[84:85], v[68:69]
    v_mov_b32 v7, v94
    v_mov_b64 v[86:87], v[72:73]
    s_mov_b64 exec, -1
    s_or_b64 s[80:81], s[80:81], vcc
    ds_read_b64 v[70:71], v93
    s_and_b64 exec, s[84:85], s[80:81]
    v_mfma_f32_4x4x4_16b_bf16 v[76:79], v[12:13], v[84:85], 0
    v_mov_b32 v92, v7
    s_andn2_b64 s[80:81], s[80:81], s[84:85]
    v_mfma_f32_4x4x4_16b_bf16 v[76:79], v[10:11], v[86:87], v[76:79]
    s_mov_b64 exec, -1
    ds_read_b64 v[68:69], v92
    v_and_b32 v46, 0x80000000, v27
    v_lshrrev_b32 v47, 14, v25
    v_bitop3_b32 v47, v47, v5, v46 bitop3:0xea
    ds_read_b64 v[106:107], v47 offset:63616
    v_bitop3_b32 v95, v25, v5, v46 bitop3:0xea
    v_and_b32 v46, 0x40000000, v27
    v_lshrrev_b32 v47, 14, v24
    v_bitop3_b32 v47, v47, v5, v46 bitop3:0xea
    ds_read_b64 v[104:105], v47 offset:63616
    v_bitop3_b32 v94, v24, v5, v46 bitop3:0xea
    s_waitcnt lgkmcnt(2)
    v_mfma_f32_4x4x4_16b_bf16 v[80:83], v[10:11], v[70:71], v[80:83]
    v_mfma_f32_4x4x4_16b_bf16 v[76:79], v[10:11], v[68:69], v[76:79]
    v_perm_b32 v15, v25, v26, s47
    v_bitop3_b32 v46, v25, 0.5, -0.5 bitop3:0xa8
    v_perm_b32 v14, v24, v26, s46
    v_bitop3_b32 v47, v24, 0.5, -0.5 bitop3:0xa8
    v_cvt_pk_bf16_f32 v80, v80, v81
    v_cvt_pk_bf16_f32 v81, v82, v83
    ds_wrxchg_rtn_b64 v[74:75], v93, v[80:81]
    v_cvt_pk_bf16_f32 v76, v76, v77
    v_cvt_pk_bf16_f32 v77, v78, v79
    ds_wrxchg_rtn_b64 v[72:73], v92, v[76:77]
    s_setprio 1
    s_waitcnt lgkmcnt(2)
    v_mfma_f32_4x4x4_16b_bf16 v[80:83], v[8:9], v[106:107], 0
    v_mfma_f32_4x4x4_16b_bf16 v[76:79], v[8:9], v[104:105], 0
    v_bitop3_b32 v15, v6, v15, v46 bitop3:0xca
    v_bitop3_b32 v14, v6, v14, v47 bitop3:0xca
    s_nop 1
    v_pk_mul_f32 v[80:81], v[80:81], v[14:15] op_sel:[0,1] op_sel_hi:[1,1]
    v_pk_mul_f32 v[82:83], v[82:83], v[14:15] op_sel:[0,1] op_sel_hi:[1,1]
    v_pk_mul_f32 v[76:77], v[76:77], v[14:15] op_sel:[0,0] op_sel_hi:[1,0]
    v_pk_mul_f32 v[78:79], v[78:79], v[14:15] op_sel:[0,0] op_sel_hi:[1,0]
    v_and_b32 v47, 0x0fffffff, v41
    v_mov_b32 v27, v41
    buffer_load_dwordx4 v[22:25], v47, s[8:11], 0 offen
    buffer_load_dwordx3 v[24:26], v47, s[8:11], 0 offen offset:8
    s_waitcnt lgkmcnt(0)
    v_cmpx_ne_u64 vcc, v[74:75], v[70:71]
    s_and_b64 s[82:83], vcc, s[80:81]
    s_cbranch_scc1 L2_c32
L2_d32:
    v_mov_b64 v[84:85], v[70:71]
    v_mov_b32 v7, v93
    v_mov_b64 v[86:87], v[74:75]
    s_mov_b64 exec, -1
    s_or_b64 s[80:81], s[80:81], vcc
    v_cmpx_ne_u64 vcc, v[72:73], v[68:69]
    s_and_b64 s[82:83], vcc, s[80:81]
    s_cbranch_scc1 L2_c33
L2_d33:
    v_mov_b64 v[84:85], v[68:69]
    v_mov_b32 v7, v92
    v_mov_b64 v[86:87], v[72:73]
    s_mov_b64 exec, -1
    s_or_b64 s[80:81], s[80:81], vcc
    ds_read_b64 v[70:71], v95
    ds_read_b64 v[68:69], v94
    s_waitcnt vmcnt(11)
    v_and_b32 v46, 0x20000000, v33
    v_lshrrev_b32 v47, 14, v29
    v_bitop3_b32 v47, v47, v5, v46 bitop3:0xea
    ds_read_b64 v[102:103], v47 offset:63616
    v_bitop3_b32 v93, v29, v5, v46 bitop3:0xea
    v_and_b32 v46, 0x10000000, v33
    v_lshrrev_b32 v47, 14, v28
    v_bitop3_b32 v47, v47, v5, v46 bitop3:0xea
    ds_read_b64 v[100:101], v47 offset:63616
    v_bitop3_b32 v92, v28, v5, v46 bitop3:0xea
    s_waitcnt lgkmcnt(2)
    v_mfma_f32_4x4x4_16b_bf16 v[80:83], v[10:11], v[70:71], v[80:83]
    v_mfma_f32_4x4x4_16b_bf16 v[76:79], v[10:11], v[68:69], v[76:79]
    v_perm_b32 v15, v29, v32, s45
    v_bitop3_b32 v46, v29, 0.5, -0.5 bitop3:0xa8
    v_perm_b32 v14, v28, v32, s44
    v_bitop3_b32 v47, v28, 0.5, -0.5 bitop3:0xa8
    v_cvt_pk_bf16_f32 v80, v80, v81
    v_cvt_pk_bf16_f32 v81, v82, v83
    ds_wrxchg_rtn_b64 v[74:75], v95, v[80:81]
    v_cvt_pk_bf16_f32 v76, v76, v77
    v_cvt_pk_bf16_f32 v77, v78, v79
    ds_wrxchg_rtn_b64 v[72:73], v94, v[76:77]
    s_waitcnt lgkmcnt(2)
    v_mfma_f32_4x4x4_16b_bf16 v[80:83], v[8:9], v[102:103], 0
    v_mfma_f32_4x4x4_16b_bf16 v[76:79], v[8:9], v[100:101], 0
    v_bitop3_b32 v15, v6, v15, v46 bitop3:0xca
    v_bitop3_b32 v14, v6, v14, v47 bitop3:0xca
    v_cmp_lt_u32 s[84:85], v5, v92
    s_nop 0
    v_pk_mul_f32 v[80:81], v[80:81], v[14:15] op_sel:[0,1] op_sel_hi:[1,1]
    v_pk_mul_f32 v[82:83], v[82:83], v[14:15] op_sel:[0,1] op_sel_hi:[1,1]
    v_pk_mul_f32 v[76:77], v[76:77], v[14:15] op_sel:[0,0] op_sel_hi:[1,0]
    v_pk_mul_f32 v[78:79], v[78:79], v[14:15] op_sel:[0,0] op_sel_hi:[1,0]
    s_waitcnt lgkmcnt(0)
    v_cmpx_ne_u64 vcc, v[74:75], v[70:71]
    s_and_b64 s[82:83], vcc, s[80:81]
    s_cbranch_scc1 L2_c34
L2_d34:
    v_mov_b64 v[84:85], v[70:71]
    v_mov_b32 v7, v95
    v_mov_b64 v[86:87], v[74:75]
    s_mov_b64 exec, -1
    s_or_b64 s[80:81], s[80:81], vcc
    v_cmpx_ne_u64 vcc, v[72:73], v[68:69]
    s_and_b64 s[82:83], vcc, s[80:81]
    s_cbranch_scc1 L2_c35
L2_d35:
    v_mov_b64 v[84:85], v[68:69]
    v_mov_b32 v7, v94
    v_mov_b64 v[86:87], v[72:73]
    s_mov_b64 exec, -1
    s_or_b64 s[80:81], s[80:81], vcc
    ds_read_b64 v[70:71], v93
    s_and_b64 exec, s[84:85], s[80:81]
    v_mfma_f32_4x4x4_16b_bf16 v[76:79], v[12:13], v[84:85], 0
    v_mov_b32 v92, v7
    s_andn2_b64 s[80:81], s[80:81], s[84:85]
    v_mfma_f32_4x4x4_16b_bf16 v[76:79], v[10:11], v[86:87], v[76:79]
    s_mov_b64 exec, -1
    ds_read_b64 v[68:69], v92
    v_and_b32 v46, 0x80000000, v33
    v_lshrrev_b32 v47, 14, v31
    v_bitop3_b32 v47, v47, v5, v46 bitop3:0xea
    ds_read_b64 v[106:107], v47 offset:63616
    v_bitop3_b32 v95, v31, v5, v46 bitop3:0xea
    v_and_b32 v46, 0x40000000, v33
    v_lshrrev_b32 v47, 14, v30
    v_bitop3_b32 v47, v47, v5, v46 bitop3:0xea
    ds_read_b64 v[104:105], v47 offset:63616
    v_bitop3_b32 v94, v30, v5, v46 bitop3:0xea
    s_waitcnt lgkmcnt(2)
    v_mfma_f32_4x4x4_16b_bf16 v[80:83], v[10:11], v[70:71], v[80:83]
    v_mfma_f32_4x4x4_16b_bf16 v[76:79], v[10:11], v[68:69], v[76:79]
    v_perm_b32 v15, v31, v32, s47
    v_bitop3_b32 v46, v31, 0.5, -0.5 bitop3:0xa8
    v_perm_b32 v14, v30, v32, s46
    v_bitop3_b32 v47, v30, 0.5, -0.5 bitop3:0xa8
    v_cvt_pk_bf16_f32 v80, v80, v81
    v_cvt_pk_bf16_f32 v81, v82, v83
    ds_wrxchg_rtn_b64 v[74:75], v93, v[80:81]
    v_cvt_pk_bf16_f32 v76, v76, v77
    v_cvt_pk_bf16_f32 v77, v78, v79
    ds_wrxchg_rtn_b64 v[72:73], v92, v[76:77]
    s_setprio 0
    s_waitcnt lgkmcnt(2)
    v_mfma_f32_4x4x4_16b_bf16 v[80:83], v[8:9], v[106:107], 0
    v_mfma_f32_4x4x4_16b_bf16 v[76:79], v[8:9], v[104:105], 0
    v_bitop3_b32 v15, v6, v15, v46 bitop3:0xca
    v_bitop3_b32 v14, v6, v14, v47 bitop3:0xca
    s_nop 1
    v_pk_mul_f32 v[80:81], v[80:81], v[14:15] op_sel:[0,1] op_sel_hi:[1,1]
    v_pk_mul_f32 v[82:83], v[82:83], v[14:15] op_sel:[0,1] op_sel_hi:[1,1]
    v_pk_mul_f32 v[76:77], v[76:77], v[14:15] op_sel:[0,0] op_sel_hi:[1,0]
    v_pk_mul_f32 v[78:79], v[78:79], v[14:15] op_sel:[0,0] op_sel_hi:[1,0]
    s_add_u32 s40, s40, 0x4e200
    v_and_b32 v47, 0x0fffffff, v42
    v_mov_b32 v33, v42
    buffer_load_dwordx4 v[28:31], v47, s[8:11], 0 offen
    buffer_load_dwordx3 v[30:32], v47, s[8:11], 0 offen offset:8
    s_waitcnt lgkmcnt(0)
    v_cmpx_ne_u64 vcc, v[74:75], v[70:71]
    s_and_b64 s[82:83], vcc, s[80:81]
    s_cbranch_scc1 L2_c36
L2_d36:
    v_mov_b64 v[84:85], v[70:71]
    v_mov_b32 v7, v93
    v_mov_b64 v[86:87], v[74:75]
    s_mov_b64 exec, -1
    s_or_b64 s[80:81], s[80:81], vcc
    v_cmpx_ne_u64 vcc, v[72:73], v[68:69]
    s_and_b64 s[82:83], vcc, s[80:81]
    s_cbranch_scc1 L2_c37
L2_d37:
    v_mov_b64 v[84:85], v[68:69]
    v_mov_b32 v7, v92
    v_mov_b64 v[86:87], v[72:73]
    s_mov_b64 exec, -1
    s_or_b64 s[80:81], s[80:81], vcc
    ds_read_b64 v[70:71], v95
    ds_read_b64 v[68:69], v94
    s_waitcnt vmcnt(8)
    v_and_b32 v46, 0x20000000, v39
    v_lshrrev_b32 v47, 14, v35
    v_bitop3_b32 v47, v47, v5, v46 bitop3:0xea
    ds_read_b64 v[102:103], v47 offset:63616
    v_bitop3_b32 v93, v35, v5, v46 bitop3:0xea
    v_and_b32 v46, 0x10000000, v39
    v_lshrrev_b32 v47, 14, v34
    v_bitop3_b32 v47, v47, v5, v46 bitop3:0xea
    ds_read_b64 v[100:101], v47 offset:63616
    v_bitop3_b32 v92, v34, v5, v46 bitop3:0xea
    v_and_b32 v46, 0x80000000, v39
    v_lshrrev_b32 v47, 14, v37
    v_bitop3_b32 v47, v47, v5, v46 bitop3:0xea
    ds_read_b64 v[106:107], v47 offset:63616
    v_and_b32 v46, 0x40000000, v39
    v_lshrrev_b32 v47, 14, v36
    v_bitop3_b32 v47, v47, v5, v46 bitop3:0xea
    ds_read_b64 v[104:105], v47 offset:63616
    s_waitcnt lgkmcnt(4)
    v_mfma_f32_4x4x4_16b_bf16 v[80:83], v[10:11], v[70:71], v[80:83]
    v_mfma_f32_4x4x4_16b_bf16 v[76:79], v[10:11], v[68:69], v[76:79]
    v_perm_b32 v15, v35, v38, s45
    v_bitop3_b32 v46, v35, 0.5, -0.5 bitop3:0xa8
    v_perm_b32 v14, v34, v38, s44
    v_bitop3_b32 v47, v34, 0.5, -0.5 bitop3:0xa8
    v_cvt_pk_bf16_f32 v80, v80, v81
    v_cvt_pk_bf16_f32 v81, v82, v83
    ds_wrxchg_rtn_b64 v[74:75], v95, v[80:81]
    v_cvt_pk_bf16_f32 v76, v76, v77
    v_cvt_pk_bf16_f32 v77, v78, v79
    ds_wrxchg_rtn_b64 v[72:73], v94, v[76:77]
    s_waitcnt lgkmcnt(2)
    s_barrier
    s_setprio 3
    ds_write_b128 v3, v[124:127] offset:4096
    s_add_u32 s3, s40, 4096
    buffer_load_dwordx4 v[124:127], v3, s[16:19], s3 offen
    ds_write_b128 v3, v[116:119] offset:2048
    buffer_load_dwordx4 v[116:119], v3, s[16:19], s40 offen offset:2048
    ds_write_b128 v3, v[120:123] offset:3072
    buffer_load_dwordx4 v[120:123], v3, s[16:19], s40 offen offset:3072
    v_mfma_f32_4x4x4_16b_bf16 v[80:83], v[8:9], v[102:103], 0
    v_mfma_f32_4x4x4_16b_bf16 v[76:79], v[8:9], v[100:101], 0
    v_bitop3_b32 v15, v6, v15, v46 bitop3:0xca
    v_bitop3_b32 v14, v6, v14, v47 bitop3:0xca
    v_cmp_lt_u32 s[84:85], v5, v92
    s_nop 0
    v_pk_mul_f32 v[80:81], v[80:81], v[14:15] op_sel:[0,1] op_sel_hi:[1,1]
    v_pk_mul_f32 v[82:83], v[82:83], v[14:15] op_sel:[0,1] op_sel_hi:[1,1]
    v_pk_mul_f32 v[76:77], v[76:77], v[14:15] op_sel:[0,0] op_sel_hi:[1,0]
    v_pk_mul_f32 v[78:79], v[78:79], v[14:15] op_sel:[0,0] op_sel_hi:[1,0]
    v_mov_b32 v44, v43
    s_cmp_gt_u32 s37, 1024
    s_cbranch_scc1 L2_xs38
    s_cmp_lg_u32 s43, 0
    s_cbranch_scc1 L2_xa38
L2_xb38:
    v_lshlrev_b32 v89, 16, v96
    v_add_u32 v90, 60, v97
    v_bitop3_b32 v90, v89, v45, v90 bitop3:0x6a
    ds_write_b32 v98, v90 offset:12
    v_lshlrev_b32 v89, 20, v96
    v_add_u32 v90, 40, v97
    v_bitop3_b32 v90, v89, v45, v90 bitop3:0x6a
    ds_write_b32 v98, v90 offset:8
    v_lshlrev_b32 v89, 24, v96
    v_add_u32 v90, 20, v97
    v_bitop3_b32 v90, v89, v45, v90 bitop3:0x6a
    ds_write_b32 v98, v90 offset:4
    v_lshlrev_b32 v89, 28, v96
    v_bitop3_b32 v90, v89, v45, v97 bitop3:0x6a
    ds_write_b32 v98, v90 offset:0
    v_mov_b32_dpp v91, v66 quad_perm:[1,1,1,1] row_mask:0xf bank_mask:0xf
    v_and_b32 v89, 3, v91
    v_and_b32 v97, 0xfffc, v91
    v_sub_u16_dpp v88, v66, v91 quad_perm:[3,3,3,3] row_mask:0xf bank_mask:0xf
    v_mad_u32_u24 v97, v97, 5, v4
    v_add_u32 v99, v88, v89
    v_bfm_b32 v96, v88, v89
    v_cmp_lt_u32 s[58:59], 16, v99
    v_lshlrev_b32 v89, v1, v96
    v_and_b32 v89, v45, v89
    v_cmp_ne_u32 vcc, 0, v89
    v_xor_b32 v90, v97, v89
    s_add_u32 s3, s37, s38
    v_mbcnt_lo_u32_b32 v98, vcc_lo, 0
    v_mbcnt_hi_u32_b32 v98, vcc_hi, v98
    s_bcnt1_i32_b64 s41, vcc
    v_lshl_add_u32 v98, v98, 2, s3
    s_mov_b64 exec, vcc
    ds_write_b32 v98, v90
    s_mov_b64 exec, -1
    s_lshl2_add_u32 s37, s41, s37
    s_cmp_lg_u64 s[58:59], 0
    s_cbranch_scc1 L2_xe38
L2_xr38:
    v_add_u32 v98, s37, v0
    v_mov_b32 v90, -1
    ds_write_b32 v98, v90
    ds_read2st64_b32 v[40:41], v0 offset0:0 offset1:1
    ds_read2st64_b32 v[42:43], v0 offset0:2 offset1:3
    s_sub_u32 s3, s37, 768
    s_cmp_gt_u32 s3, 256
    s_cbranch_scc1 L2_xf38
L2_xg38:
    v_lshrrev_b64 v[64:65], 16, v[64:65]
    v_lshrrev_b64 v[66:67], 16, v[66:67]
    s_setprio 2
    s_waitcnt vmcnt(10)
    ds_write_b128 v3, v[108:111] offset:0
    s_waitcnt lgkmcnt(12)
    v_cmpx_ne_u64 vcc, v[74:75], v[70:71]
    s_and_b64 s[82:83], vcc, s[80:81]
    s_cbranch_scc1 L2_c39
L2_d39:
    v_mov_b64 v[84:85], v[70:71]
    v_mov_b32 v7, v95
    v_mov_b64 v[86:87], v[74:75]
    s_mov_b64 exec, -1
    s_or_b64 s[80:81], s[80:81], vcc
    v_cmpx_ne_u64 vcc, v[72:73], v[68:69]
    s_and_b64 s[82:83], vcc, s[80:81]
    s_cbranch_scc1 L2_c40
L2_d40:
    v_mov_b64 v[84:85], v[68:69]
    v_mov_b32 v7, v94
    v_mov_b64 v[86:87], v[72:73]
    s_mov_b64 exec, -1
    s_or_b64 s[80:81], s[80:81], vcc
    ds_read_b64 v[70:71], v93
    s_and_b64 exec, s[84:85], s[80:81]
    v_mfma_f32_4x4x4_16b_bf16 v[76:79], v[12:13], v[84:85], 0
    v_mov_b32 v92, v7
    s_andn2_b64 s[80:81], s[80:81], s[84:85]
    v_mfma_f32_4x4x4_16b_bf16 v[76:79], v[10:11], v[86:87], v[76:79]
    s_mov_b64 exec, -1
    ds_read_b64 v[68:69], v92
    s_setprio 1
    s_waitcnt vmcnt(7)
    ds_write_b128 v3, v[112:115] offset:1024
    s_waitcnt lgkmcnt(1)
    v_mfma_f32_4x4x4_16b_bf16 v[80:83], v[10:11], v[70:71], v[80:83]
    v_mfma_f32_4x4x4_16b_bf16 v[76:79], v[10:11], v[68:69], v[76:79]
    v_and_b32 v46, 0x40000000, v39
    v_bitop3_b32 v94, v36, v5, v46 bitop3:0xea
    v_and_b32 v46, 0x80000000, v39
    v_bitop3_b32 v95, v37, v5, v46 bitop3:0xea
    v_perm_b32 v15, v37, v38, s47
    v_bitop3_b32 v46, v37, 0.5, -0.5 bitop3:0xa8
    v_perm_b32 v14, v36, v38, s46
    v_bitop3_b32 v47, v36, 0.5, -0.5 bitop3:0xa8
    v_cvt_pk_bf16_f32 v80, v80, v81
    v_cvt_pk_bf16_f32 v81, v82, v83
    ds_wrxchg_rtn_b64 v[74:75], v93, v[80:81]
    v_cvt_pk_bf16_f32 v76, v76, v77
    v_cvt_pk_bf16_f32 v77, v78, v79
    ds_wrxchg_rtn_b64 v[72:73], v92, v[76:77]
    s_setprio 0
    v_mfma_f32_4x4x4_16b_bf16 v[80:83], v[8:9], v[106:107], 0
    v_mfma_f32_4x4x4_16b_bf16 v[76:79], v[8:9], v[104:105], 0
    v_bitop3_b32 v15, v6, v15, v46 bitop3:0xca
    v_bitop3_b32 v14, v6, v14, v47 bitop3:0xca
    s_nop 1
    v_pk_mul_f32 v[80:81], v[80:81], v[14:15] op_sel:[0,1] op_sel_hi:[1,1]
    v_pk_mul_f32 v[82:83], v[82:83], v[14:15] op_sel:[0,1] op_sel_hi:[1,1]
    v_pk_mul_f32 v[76:77], v[76:77], v[14:15] op_sel:[0,0] op_sel_hi:[1,0]
    v_pk_mul_f32 v[78:79], v[78:79], v[14:15] op_sel:[0,0] op_sel_hi:[1,0]
    s_add_u32 s42, s42, 1
    s_waitcnt lgkmcnt(2)
    s_barrier
    s_bitcmp1_b32 s36, s42
    s_cbranch_scc1 L2_slow
L2_ret2:
    s_setprio 3
    v_and_b32 v47, 0x0fffffff, v44
    v_mov_b32 v39, v44
    buffer_load_dwordx4 v[34:37], v47, s[8:11], 0 offen
    buffer_load_dwordx3 v[36:38], v47, s[8:11], 0 offen offset:8
    s_waitcnt lgkmcnt(0)
    v_cmpx_ne_u64 vcc, v[74:75], v[70:71]
    s_and_b64 s[82:83], vcc, s[80:81]
    s_cbranch_scc1 L2_c41
L2_d41:
    v_mov_b64 v[84:85], v[70:71]
    v_mov_b32 v7, v93
    v_mov_b64 v[86:87], v[74:75]
    s_mov_b64 exec, -1
    s_or_b64 s[80:81], s[80:81], vcc
    v_cmpx_ne_u64 vcc, v[72:73], v[68:69]
    s_and_b64 s[82:83], vcc, s[80:81]
    s_cbranch_scc1 L2_c42
L2_d42:
    v_mov_b64 v[84:85], v[68:69]
    v_mov_b32 v7, v92
    v_mov_b64 v[86:87], v[72:73]
    s_mov_b64 exec, -1
    s_or_b64 s[80:81], s[80:81], vcc
    ds_read_b64 v[70:71], v95
    ds_read_b64 v[68:69], v94
    v_and_b32 v46, 0x20000000, v21
    v_lshrrev_b32 v47, 14, v17
    v_bitop3_b32 v47, v47, v5, v46 bitop3:0xea
    ds_read_b64 v[102:103], v47 offset:63616
    v_bitop3_b32 v93, v17, v5, v46 bitop3:0xea
    v_and_b32 v46, 0x10000000, v21
    v_lshrrev_b32 v47, 14, v16
    v_bitop3_b32 v47, v47, v5, v46 bitop3:0xea
    ds_read_b64 v[100:101], v47 offset:63616
    v_bitop3_b32 v92, v16, v5, v46 bitop3:0xea
    s_waitcnt lgkmcnt(2)
    v_mfma_f32_4x4x4_16b_bf16 v[80:83], v[10:11], v[70:71], v[80:83]
    v_mfma_f32_4x4x4_16b_bf16 v[76:79], v[10:11], v[68:69], v[76:79]
    v_perm_b32 v15, v17, v20, s45
    v_bitop3_b32 v46, v17, 0.5, -0.5 bitop3:0xa8
    v_perm_b32 v14, v16, v20, s44
    v_bitop3_b32 v47, v16, 0.5, -0.5 bitop3:0xa8
    v_cvt_pk_bf16_f32 v80, v80, v81
    v_cvt_pk_bf16_f32 v81, v82, v83
    ds_wrxchg_rtn_b64 v[74:75], v95, v[80:81]
    v_cvt_pk_bf16_f32 v76, v76, v77
    v_cvt_pk_bf16_f32 v77, v78, v79
    ds_wrxchg_rtn_b64 v[72:73], v94, v[76:77]
    s_waitcnt lgkmcnt(2)
    v_mfma_f32_4x4x4_16b_bf16 v[80:83], v[8:9], v[102:103], 0
    v_mfma_f32_4x4x4_16b_bf16 v[76:79], v[8:9], v[100:101], 0
    v_bitop3_b32 v15, v6, v15, v46 bitop3:0xca
    v_bitop3_b32 v14, v6, v14, v47 bitop3:0xca
    v_cmp_lt_u32 s[84:85], v5, v92
    s_nop 0
    v_pk_mul_f32 v[80:81], v[80:81], v[14:15] op_sel:[0,1] op_sel_hi:[1,1]
    v_pk_mul_f32 v[82:83], v[82:83], v[14:15] op_sel:[0,1] op_sel_hi:[1,1]
    v_pk_mul_f32 v[76:77], v[76:77], v[14:15] op_sel:[0,0] op_sel_hi:[1,0]
    v_pk_mul_f32 v[78:79], v[78:79], v[14:15] op_sel:[0,0] op_sel_hi:[1,0]
    buffer_load_dwordx4 v[108:111], v3, s[16:19], s40 offen offset:0
    s_waitcnt lgkmcnt(0)
    v_cmpx_ne_u64 vcc, v[74:75], v[70:71]
    s_and_b64 s[82:83], vcc, s[80:81]
    s_cbranch_scc1 L2_c43
L2_d43:
    v_mov_b64 v[84:85], v[70:71]
    v_mov_b32 v7, v95
    v_mov_b64 v[86:87], v[74:75]
    s_mov_b64 exec, -1
    s_or_b64 s[80:81], s[80:81], vcc
    v_cmpx_ne_u64 vcc, v[72:73], v[68:69]
    s_and_b64 s[82:83], vcc, s[80:81]
    s_cbranch_scc1 L2_c44
L2_d44:
    v_mov_b64 v[84:85], v[68:69]
    v_mov_b32 v7, v94
    v_mov_b64 v[86:87], v[72:73]
    s_mov_b64 exec, -1
    s_or_b64 s[80:81], s[80:81], vcc
    ds_read_b64 v[70:71], v93
    s_and_b64 exec, s[84:85], s[80:81]
    v_mfma_f32_4x4x4_16b_bf16 v[76:79], v[12:13], v[84:85], 0
    v_mov_b32 v92, v7
    s_andn2_b64 s[80:81], s[80:81], s[84:85]
    v_mfma_f32_4x4x4_16b_bf16 v[76:79], v[10:11], v[86:87], v[76:79]
    s_mov_b64 exec, -1
    ds_read_b64 v[68:69], v92
    v_and_b32 v46, 0x80000000, v21
    v_lshrrev_b32 v47, 14, v19
    v_bitop3_b32 v47, v47, v5, v46 bitop3:0xea
    ds_read_b64 v[106:107], v47 offset:63616
    v_bitop3_b32 v95, v19, v5, v46 bitop3:0xea
    v_and_b32 v46, 0x40000000, v21
    v_lshrrev_b32 v47, 14, v18
    v_bitop3_b32 v47, v47, v5, v46 bitop3:0xea
    ds_read_b64 v[104:105], v47 offset:63616
    v_bitop3_b32 v94, v18, v5, v46 bitop3:0xea
    s_waitcnt lgkmcnt(2)
    v_mfma_f32_4x4x4_16b_bf16 v[80:83], v[10:11], v[70:71], v[80:83]
    v_mfma_f32_4x4x4_16b_bf16 v[76:79], v[10:11], v[68:69], v[76:79]
    v_perm_b32 v15, v19, v20, s47
    v_bitop3_b32 v46, v19, 0.5, -0.5 bitop3:0xa8
    v_perm_b32 v14, v18, v20, s46
    v_bitop3_b32 v47, v18, 0.5, -0.5 bitop3:0xa8
    v_cvt_pk_bf16_f32 v80, v80, v81
    v_cvt_pk_bf16_f32 v81, v82, v83
    ds_wrxchg_rtn_b64 v[74:75], v93, v[80:81]
    v_cvt_pk_bf16_f32 v76, v76, v77
    v_cvt_pk_bf16_f32 v77, v78, v79
    ds_wrxchg_rtn_b64 v[72:73], v92, v[76:77]
    s_setprio 2
    s_waitcnt lgkmcnt(2)
    v_mfma_f32_4x4x4_16b_bf16 v[80:83], v[8:9], v[106:107], 0
    v_mfma_f32_4x4x4_16b_bf16 v[76:79], v[8:9], v[104:105], 0
    v_bitop3_b32 v15, v6, v15, v46 bitop3:0xca
    v_bitop3_b32 v14, v6, v14, v47 bitop3:0xca
    s_nop 1
    v_pk_mul_f32 v[80:81], v[80:81], v[14:15] op_sel:[0,1] op_sel_hi:[1,1]
    v_pk_mul_f32 v[82:83], v[82:83], v[14:15] op_sel:[0,1] op_sel_hi:[1,1]
    v_pk_mul_f32 v[76:77], v[76:77], v[14:15] op_sel:[0,0] op_sel_hi:[1,0]
    v_pk_mul_f32 v[78:79], v[78:79], v[14:15] op_sel:[0,0] op_sel_hi:[1,0]
    v_and_b32 v47, 0x0fffffff, v40
    v_mov_b32 v21, v40
    buffer_load_dwordx4 v[16:19], v47, s[8:11], 0 offen
    buffer_load_dwordx3 v[18:20], v47, s[8:11], 0 offen offset:8
    s_waitcnt lgkmcnt(0)
    v_cmpx_ne_u64 vcc, v[74:75], v[70:71]
    s_and_b64 s[82:83], vcc, s[80:81]
    s_cbranch_scc1 L2_c45
L2_d45:
    v_mov_b64 v[84:85], v[70:71]
    v_mov_b32 v7, v93
    v_mov_b64 v[86:87], v[74:75]
    s_mov_b64 exec, -1
    s_or_b64 s[80:81], s[80:81], vcc
    v_cmpx_ne_u64 vcc, v[72:73], v[68:69]
    s_and_b64 s[82:83], vcc, s[80:81]
    s_cbranch_scc1 L2_c46
L2_d46:
    v_mov_b64 v[84:85], v[68:69]
    v_mov_b32 v7, v92
    v_mov_b64 v[86:87], v[72:73]
    s_mov_b64 exec, -1
    s_or_b64 s[80:81], s[80:81], vcc
    ds_read_b64 v[70:71], v95
    ds_read_b64 v[68:69], v94
    s_waitcnt vmcnt(10)
    v_and_b32 v46, 0x20000000, v27
    v_lshrrev_b32 v47, 14, v23
    v_bitop3_b32 v47, v47, v5, v46 bitop3:0xea
    ds_read_b64 v[102:103], v47 offset:63616
    v_bitop3_b32 v93, v23, v5, v46 bitop3:0xea
    v_and_b32 v46, 0x10000000, v27
    v_lshrrev_b32 v47, 14, v22
    v_bitop3_b32 v47, v47, v5, v46 bitop3:0xea
    ds_read_b64 v[100:101], v47 offset:63616
    v_bitop3_b32 v92, v22, v5, v46 bitop3:0xea
    s_waitcnt lgkmcnt(2)
    v_mfma_f32_4x4x4_16b_bf16 v[80:83], v[10:11], v[70:71], v[80:83]
    v_mfma_f32_4x4x4_16b_bf16 v[76:79], v[10:11], v[68:69], v[76:79]
    v_perm_b32 v15, v23, v26, s45
    v_bitop3_b32 v46, v23, 0.5, -0.5 bitop3:0xa8
    v_perm_b32 v14, v22, v26, s44
    v_bitop3_b32 v47, v22, 0.5, -0.5 bitop3:0xa8
    v_cvt_pk_bf16_f32 v80, v80, v81
    v_cvt_pk_bf16_f32 v81, v82, v83
    ds_wrxchg_rtn_b64 v[74:75], v95, v[80:81]
    v_cvt_pk_bf16_f32 v76, v76, v77
    v_cvt_pk_bf16_f32 v77, v78, v79
    ds_wrxchg_rtn_b64 v[72:73], v94, v[76:77]
    s_waitcnt lgkmcnt(2)
    v_mfma_f32_4x4x4_16b_bf16 v[80:83], v[8:9], v[102:103], 0
    v_mfma_f32_4x4x4_16b_bf16 v[76:79], v[8:9], v[100:101], 0
    v_bitop3_b32 v15, v6, v15, v46 bitop3:0xca
    v_bitop3_b32 v14, v6, v14, v47 bitop3:0xca
    v_cmp_lt_u32 s[84:85], v5, v92
    s_nop 0
    v_pk_mul_f32 v[80:81], v[80:81], v[14:15] op_sel:[0,1] op_sel_hi:[1,1]
    v_pk_mul_f32 v[82:83], v[82:83], v[14:15] op_sel:[0,1] op_sel_hi:[1,1]
    v_pk_mul_f32 v[76:77], v[76:77], v[14:15] op_sel:[0,0] op_sel_hi:[1,0]
    v_pk_mul_f32 v[78:79], v[78:79], v[14:15] op_sel:[0,0] op_sel_hi:[1,0]
    v_sub_u16 v88, v56, v48
    v_and_b32 v89, 3, v48
    v_add3_u32 v99, v88, v89, 3
    v_and_b32 v99, -4, v99
    v_max_u32 v99, 4, v99
    v_and_b32 v97, 0xfffc, v48
    v_bfm_b32 v96, v88, v89
    v_add_u32_dpp v91, v99, v99 row_shr:1 row_mask:0xf bank_mask:0xf bound_ctrl:1
    v_mad_u32_u24 v97, v97, 5, v2
    v_cmp_lt_u32 vcc, 16, v99
    v_add_u32_dpp v91, v91, v91 row_shr:2 row_mask:0xf bank_mask:0xf bound_ctrl:1
    v_sub_u32 v98, s38, v99
    v_lshrrev_b64 v[48:49], 16, v[48:49]
    v_add_u32_dpp v91, v91, v91 row_shr:4 row_mask:0xf bank_mask:0xf bound_ctrl:1
    v_lshrrev_b64 v[56:57], 16, v[56:57]
    s_mov_b32 s43, 0
    v_add_u32_dpp v91, v91, v91 row_shr:8 row_mask:0xf bank_mask:0xf bound_ctrl:1
    s_nop 1
    v_add_u32_dpp v91, v91, v91 row_bcast:15 row_mask:0xa bank_mask:0xf
    s_nop 1
    v_add_u32_dpp v91, v91, v91 row_bcast:31 row_mask:0xc bank_mask:0xf
    v_add_u32 v98, v98, v91
    v_readlane_b32 s37, v91, 63
    s_cbranch_vccnz L2_xo47
L2_xp47:
    buffer_load_dwordx4 v[112:115], v3, s[16:19], s40 offen offset:1024
    s_waitcnt lgkmcnt(0)
    v_cmpx_ne_u64 vcc, v[74:75], v[70:71]
    s_and_b64 s[82:83], vcc, s[80:81]
    s_cbranch_scc1 L2_c48
L2_d48:
    v_mov_b64 v[84:85], v[70:71]
    v_mov_b32 v7, v95
    v_mov_b64 v[86:87], v[74:75]
    s_mov_b64 exec, -1
    s_or_b64 s[80:81], s[80:81], vcc
    v_cmpx_ne_u64 vcc, v[72:73], v[68:69]
    s_and_b64 s[82:83], vcc, s[80:81]
    s_cbranch_scc1 L2_c49
L2_d49:
    v_mov_b64 v[84:85], v[68:69]
    v_mov_b32 v7, v94
    v_mov_b64 v[86:87], v[72:73]
    s_mov_b64 exec, -1
    s_or_b64 s[80:81], s[80:81], vcc
    ds_read_b64 v[70:71], v93
    s_and_b64 exec, s[84:85], s[80:81]
    v_mfma_f32_4x4x4_16b_bf16 v[76:79], v[12:13], v[84:85], 0
    v_mov_b32 v92, v7
    s_andn2_b64 s[80:81], s[80:81], s[84:85]
    v_mfma_f32_4x4x4_16b_bf16 v[76:79], v[10:11], v[86:87], v[76:79]
    s_mov_b64 exec, -1
    ds_read_b64 v[68:69], v92
    v_and_b32 v46, 0x80000000, v27
    v_lshrrev_b32 v47, 14, v25
    v_bitop3_b32 v47, v47, v5, v46 bitop3:0xea
    ds_read_b64 v[106:107], v47 offset:63616
    v_bitop3_b32 v95, v25, v5, v46 bitop3:0xea
    v_and_b32 v46, 0x40000000, v27
    v_lshrrev_b32 v47, 14, v24
    v_bitop3_b32 v47, v47, v5, v46 bitop3:0xea
    ds_read_b64 v[104:105], v47 offset:63616
    v_bitop3_b32 v94, v24, v5, v46 bitop3:0xea
    s_waitcnt lgkmcnt(2)
    v_mfma_f32_4x4x4_16b_bf16 v[80:83], v[10:11], v[70:71], v[80:83]
    v_mfma_f32_4x4x4_16b_bf16 v[76:79], v[10:11], v[68:69], v[76:79]
    v_perm_b32 v15, v25, v26, s47
    v_bitop3_b32 v46, v25, 0.5, -0.5 bitop3:0xa8
    v_perm_b32 v14, v24, v26, s46
    v_bitop3_b32 v47, v24, 0.5, -0.5 bitop3:0xa8
    v_cvt_pk_bf16_f32 v80, v80, v81
    v_cvt_pk_bf16_f32 v81, v82, v83
    ds_wrxchg_rtn_b64 v[74:75], v93, v[80:81]
    v_cvt_pk_bf16_f32 v76, v76, v77
    v_cvt_pk_bf16_f32 v77, v78, v79
    ds_wrxchg_rtn_b64 v[72:73], v92, v[76:77]
    s_setprio 1
    s_waitcnt lgkmcnt(2)
    v_mfma_f32_4x4x4_16b_bf16 v[80:83], v[8:9], v[106:107], 0
    v_mfma_f32_4x4x4_16b_bf16 v[76:79], v[8:9], v[104:105], 0
    v_bitop3_b32 v15, v6, v15, v46 bitop3:0xca
    v_bitop3_b32 v14, v6, v14, v47 bitop3:0xca
    s_nop 1
    v_pk_mul_f32 v[80:81], v[80:81], v[14:15] op_sel:[0,1] op_sel_hi:[1,1]
    v_pk_mul_f32 v[82:83], v[82:83], v[14:15] op_sel:[0,1] op_sel_hi:[1,1]
    v_pk_mul_f32 v[76:77], v[76:77], v[14:15] op_sel:[0,0] op_sel_hi:[1,0]
    v_pk_mul_f32 v[78:79], v[78:79], v[14:15] op_sel:[0,0] op_sel_hi:[1,0]
    v_and_b32 v47, 0x0fffffff, v41
    v_mov_b32 v27, v41
    buffer_load_dwordx4 v[22:25], v47, s[8:11], 0 offen
    buffer_load_dwordx3 v[24:26], v47, s[8:11], 0 offen offset:8
    s_waitcnt lgkmcnt(0)
    v_cmpx_ne_u64 vcc, v[74:75], v[70:71]
    s_and_b64 s[82:83], vcc, s[80:81]
    s_cbranch_scc1 L2_c50
L2_d50:
    v_mov_b64 v[84:85], v[70:71]
    v_mov_b32 v7, v93
    v_mov_b64 v[86:87], v[74:75]
    s_mov_b64 exec, -1
    s_or_b64 s[80:81], s[80:81], vcc
    v_cmpx_ne_u64 vcc, v[72:73], v[68:69]
    s_and_b64 s[82:83], vcc, s[80:81]
    s_cbranch_scc1 L2_c51
L2_d51:
    v_mov_b64 v[84:85], v[68:69]
    v_mov_b32 v7, v92
    v_mov_b64 v[86:87], v[72:73]
    s_mov_b64 exec, -1
    s_or_b64 s[80:81], s[80:81], vcc
    ds_read_b64 v[70:71], v95
    ds_read_b64 v[68:69], v94
    s_waitcnt vmcnt(11)
    v_and_b32 v46, 0x20000000, v33
    v_lshrrev_b32 v47, 14, v29
    v_bitop3_b32 v47, v47, v5, v46 bitop3:0xea
    ds_read_b64 v[102:103], v47 offset:63616
    v_bitop3_b32 v93, v29, v5, v46 bitop3:0xea
    v_and_b32 v46, 0x10000000, v33
    v_lshrrev_b32 v47, 14, v28
    v_bitop3_b32 v47, v47, v5, v46 bitop3:0xea
    ds_read_b64 v[100:101], v47 offset:63616
    v_bitop3_b32 v92, v28, v5, v46 bitop3:0xea
    s_waitcnt lgkmcnt(2)
    v_mfma_f32_4x4x4_16b_bf16 v[80:83], v[10:11], v[70:71], v[80:83]
    v_mfma_f32_4x4x4_16b_bf16 v[76:79], v[10:11], v[68:69], v[76:79]
    v_perm_b32 v15, v29, v32, s45
    v_bitop3_b32 v46, v29, 0.5, -0.5 bitop3:0xa8
    v_perm_b32 v14, v28, v32, s44
    v_bitop3_b32 v47, v28, 0.5, -0.5 bitop3:0xa8
    v_cvt_pk_bf16_f32 v80, v80, v81
    v_cvt_pk_bf16_f32 v81, v82, v83
    ds_wrxchg_rtn_b64 v[74:75], v95, v[80:81]
    v_cvt_pk_bf16_f32 v76, v76, v77
    v_cvt_pk_bf16_f32 v77, v78, v79
    ds_wrxchg_rtn_b64 v[72:73], v94, v[76:77]
    s_waitcnt lgkmcnt(2)
    v_mfma_f32_4x4x4_16b_bf16 v[80:83], v[8:9], v[102:103], 0
    v_mfma_f32_4x4x4_16b_bf16 v[76:79], v[8:9], v[100:101], 0
    v_bitop3_b32 v15, v6, v15, v46 bitop3:0xca
    v_bitop3_b32 v14, v6, v14, v47 bitop3:0xca
    v_cmp_lt_u32 s[84:85], v5, v92
    s_nop 0
    v_pk_mul_f32 v[80:81], v[80:81], v[14:15] op_sel:[0,1] op_sel_hi:[1,1]
    v_pk_mul_f32 v[82:83], v[82:83], v[14:15] op_sel:[0,1] op_sel_hi:[1,1]
    v_pk_mul_f32 v[76:77], v[76:77], v[14:15] op_sel:[0,0] op_sel_hi:[1,0]
    v_pk_mul_f32 v[78:79], v[78:79], v[14:15] op_sel:[0,0] op_sel_hi:[1,0]
    s_waitcnt lgkmcnt(0)
    v_cmpx_ne_u64 vcc, v[74:75], v[70:71]
    s_and_b64 s[82:83], vcc, s[80:81]
    s_cbranch_scc1 L2_c52
L2_d52:
    v_mov_b64 v[84:85], v[70:71]
    v_mov_b32 v7, v95
    v_mov_b64 v[86:87], v[74:75]
    s_mov_b64 exec, -1
    s_or_b64 s[80:81], s[80:81], vcc
    v_cmpx_ne_u64 vcc, v[72:73], v[68:69]
    s_and_b64 s[82:83], vcc, s[80:81]
    s_cbranch_scc1 L2_c53
L2_d53:
    v_mov_b64 v[84:85], v[68:69]
    v_mov_b32 v7, v94
    v_mov_b64 v[86:87], v[72:73]
    s_mov_b64 exec, -1
    s_or_b64 s[80:81], s[80:81], vcc
    ds_read_b64 v[70:71], v93
    s_and_b64 exec, s[84:85], s[80:81]
    v_mfma_f32_4x4x4_16b_bf16 v[76:79], v[12:13], v[84:85], 0
    v_mov_b32 v92, v7
    s_andn2_b64 s[80:81], s[80:81], s[84:85]
    v_mfma_f32_4x4x4_16b_bf16 v[76:79], v[10:11], v[86:87], v[76:79]
    s_mov_b64 exec, -1
    ds_read_b64 v[68:69], v92
    v_and_b32 v46, 0x80000000, v33
    v_lshrrev_b32 v47, 14, v31
    v_bitop3_b32 v47, v47, v5, v46 bitop3:0xea
    ds_read_b64 v[106:107], v47 offset:63616
    v_bitop3_b32 v95, v31, v5, v46 bitop3:0xea
    v_and_b32 v46, 0x40000000, v33
    v_lshrrev_b32 v47, 14, v30
    v_bitop3_b32 v47, v47, v5, v46 bitop3:0xea
    ds_read_b64 v[104:105], v47 offset:63616
    v_bitop3_b32 v94, v30, v5, v46 bitop3:0xea
    s_waitcnt lgkmcnt(2)
    v_mfma_f32_4x4x4_16b_bf16 v[80:83], v[10:11], v[70:71], v[80:83]
    v_mfma_f32_4x4x4_16b_bf16 v[76:79], v[10:11], v[68:69], v[76:79]
    v_perm_b32 v15, v31, v32, s47
    v_bitop3_b32 v46, v31, 0.5, -0.5 bitop3:0xa8
    v_perm_b32 v14, v30, v32, s46
    v_bitop3_b32 v47, v30, 0.5, -0.5 bitop3:0xa8
    v_cvt_pk_bf16_f32 v80, v80, v81
    v_cvt_pk_bf16_f32 v81, v82, v83
    ds_wrxchg_rtn_b64 v[74:75], v93, v[80:81]
    v_cvt_pk_bf16_f32 v76, v76, v77
    v_cvt_pk_bf16_f32 v77, v78, v79
    ds_wrxchg_rtn_b64 v[72:73], v92, v[76:77]
    s_setprio 0
    s_waitcnt lgkmcnt(2)
    v_mfma_f32_4x4x4_16b_bf16 v[80:83], v[8:9], v[106:107], 0
    v_mfma_f32_4x4x4_16b_bf16 v[76:79], v[8:9], v[104:105], 0
    v_bitop3_b32 v15, v6, v15, v46 bitop3:0xca
    v_bitop3_b32 v14, v6, v14, v47 bitop3:0xca
    s_nop 1
    v_pk_mul_f32 v[80:81], v[80:81], v[14:15] op_sel:[0,1] op_sel_hi:[1,1]
    v_pk_mul_f32 v[82:83], v[82:83], v[14:15] op_sel:[0,1] op_sel_hi:[1,1]
    v_pk_mul_f32 v[76:77], v[76:77], v[14:15] op_sel:[0,0] op_sel_hi:[1,0]
    v_pk_mul_f32 v[78:79], v[78:79], v[14:15] op_sel:[0,0] op_sel_hi:[1,0]
    s_add_u32 s40, s40, 0xfff29280
    v_and_b32 v47, 0x0fffffff, v42
    v_mov_b32 v33, v42
    buffer_load_dwordx4 v[28:31], v47, s[8:11], 0 offen
    buffer_load_dwordx3 v[30:32], v47, s[8:11], 0 offen offset:8
    s_waitcnt lgkmcnt(0)
    v_cmpx_ne_u64 vcc, v[74:75], v[70:71]
    s_and_b64 s[82:83], vcc, s[80:81]
    s_cbranch_scc1 L2_c54
L2_d54:
    v_mov_b64 v[84:85], v[70:71]
    v_mov_b32 v7, v93
    v_mov_b64 v[86:87], v[74:75]
    s_mov_b64 exec, -1
    s_or_b64 s[80:81], s[80:81], vcc
    v_cmpx_ne_u64 vcc, v[72:73], v[68:69]
    s_and_b64 s[82:83], vcc, s[80:81]
    s_cbranch_scc1 L2_c55
L2_d55:
    v_mov_b64 v[84:85], v[68:69]
    v_mov_b32 v7, v92
    v_mov_b64 v[86:87], v[72:73]
    s_mov_b64 exec, -1
    s_or_b64 s[80:81], s[80:81], vcc
    ds_read_b64 v[70:71], v95
    ds_read_b64 v[68:69], v94
    s_waitcnt vmcnt(8)
    v_and_b32 v46, 0x20000000, v39
    v_lshrrev_b32 v47, 14, v35
    v_bitop3_b32 v47, v47, v5, v46 bitop3:0xea
    ds_read_b64 v[102:103], v47 offset:63616
    v_bitop3_b32 v93, v35, v5, v46 bitop3:0xea
    v_and_b32 v46, 0x10000000, v39
    v_lshrrev_b32 v47, 14, v34
    v_bitop3_b32 v47, v47, v5, v46 bitop3:0xea
    ds_read_b64 v[100:101], v47 offset:63616
    v_bitop3_b32 v92, v34, v5, v46 bitop3:0xea
    v_and_b32 v46, 0x80000000, v39
    v_lshrrev_b32 v47, 14, v37
    v_bitop3_b32 v47, v47, v5, v46 bitop3:0xea
    ds_read_b64 v[106:107], v47 offset:63616
    v_and_b32 v46, 0x40000000, v39
    v_lshrrev_b32 v47, 14, v36
    v_bitop3_b32 v47, v47, v5, v46 bitop3:0xea
    ds_read_b64 v[104:105], v47 offset:63616
    s_waitcnt lgkmcnt(4)
    v_mfma_f32_4x4x4_16b_bf16 v[80:83], v[10:11], v[70:71], v[80:83]
    v_mfma_f32_4x4x4_16b_bf16 v[76:79], v[10:11], v[68:69], v[76:79]
    v_perm_b32 v15, v35, v38, s45
    v_bitop3_b32 v46, v35, 0.5, -0.5 bitop3:0xa8
    v_perm_b32 v14, v34, v38, s44
    v_bitop3_b32 v47, v34, 0.5, -0.5 bitop3:0xa8
    v_cvt_pk_bf16_f32 v80, v80, v81
    v_cvt_pk_bf16_f32 v81, v82, v83
    ds_wrxchg_rtn_b64 v[74:75], v95, v[80:81]
    v_cvt_pk_bf16_f32 v76, v76, v77
    v_cvt_pk_bf16_f32 v77, v78, v79
    ds_wrxchg_rtn_b64 v[72:73], v94, v[76:77]
    s_waitcnt lgkmcnt(2)
    s_barrier
    s_setprio 3
    ds_write_b128 v3, v[124:127] offset:4096
    s_add_u32 s3, s40, 4096
    buffer_load_dwordx4 v[124:127], v3, s[16:19], s3 offen
    ds_write_b128 v3, v[116:119] offset:2048
    buffer_load_dwordx4 v[116:119], v3, s[16:19], s40 offen offset:2048
    ds_write_b128 v3, v[120:123] offset:3072
    buffer_load_dwordx4 v[120:123], v3, s[16:19], s40 offen offset:3072
    v_mfma_f32_4x4x4_16b_bf16 v[80:83], v[8:9], v[102:103], 0
    v_mfma_f32_4x4x4_16b_bf16 v[76:79], v[8:9], v[100:101], 0
    v_bitop3_b32 v15, v6, v15, v46 bitop3:0xca
    v_bitop3_b32 v14, v6, v14, v47 bitop3:0xca
    v_cmp_lt_u32 s[84:85], v5, v92
    s_nop 0
    v_pk_mul_f32 v[80:81], v[80:81], v[14:15] op_sel:[0,1] op_sel_hi:[1,1]
    v_pk_mul_f32 v[82:83], v[82:83], v[14:15] op_sel:[0,1] op_sel_hi:[1,1]
    v_pk_mul_f32 v[76:77], v[76:77], v[14:15] op_sel:[0,0] op_sel_hi:[1,0]
    v_pk_mul_f32 v[78:79], v[78:79], v[14:15] op_sel:[0,0] op_sel_hi:[1,0]
    v_mov_b32 v44, v43
    s_cmp_gt_u32 s37, 1024
    s_cbranch_scc1 L2_xs56
    s_cmp_lg_u32 s43, 0
    s_cbranch_scc1 L2_xa56
L2_xb56:
    v_lshlrev_b32 v89, 16, v96
    v_add_u32 v90, 60, v97
    v_bitop3_b32 v90, v89, v45, v90 bitop3:0x6a
    ds_write_b32 v98, v90 offset:12
    v_lshlrev_b32 v89, 20, v96
    v_add_u32 v90, 40, v97
    v_bitop3_b32 v90, v89, v45, v90 bitop3:0x6a
    ds_write_b32 v98, v90 offset:8
    v_lshlrev_b32 v89, 24, v96
    v_add_u32 v90, 20, v97
    v_bitop3_b32 v90, v89, v45, v90 bitop3:0x6a
    ds_write_b32 v98, v90 offset:4
    v_lshlrev_b32 v89, 28, v96
    v_bitop3_b32 v90, v89, v45, v97 bitop3:0x6a
    ds_write_b32 v98, v90 offset:0
    v_mov_b32_dpp v91, v64 quad_perm:[0,0,0,0] row_mask:0xf bank_mask:0xf
    v_and_b32 v89, 3, v91
    v_and_b32 v97, 0xfffc, v91
    v_sub_u16_dpp v88, v64, v91 quad_perm:[2,2,2,2] row_mask:0xf bank_mask:0xf
    v_mad_u32_u24 v97, v97, 5, v4
    v_add_u32 v99, v88, v89
    v_bfm_b32 v96, v88, v89
    v_cmp_lt_u32 s[58:59], 16, v99
    v_lshlrev_b32 v89, v1, v96
    v_and_b32 v89, v45, v89
    v_cmp_ne_u32 vcc, 0, v89
    v_xor_b32 v90, v97, v89
    s_add_u32 s3, s37, s38
    v_mbcnt_lo_u32_b32 v98, vcc_lo, 0
    v_mbcnt_hi_u32_b32 v98, vcc_hi, v98
    s_bcnt1_i32_b64 s41, vcc
    v_lshl_add_u32 v98, v98, 2, s3
    s_mov_b64 exec, vcc
    ds_write_b32 v98, v90
    s_mov_b64 exec, -1
    s_lshl2_add_u32 s37, s41, s37
    s_cmp_lg_u64 s[58:59], 0
    s_cbranch_scc1 L2_xe56
L2_xr56:
    v_add_u32 v98, s37, v0
    v_mov_b32 v90, -1
    ds_write_b32 v98, v90
    ds_read2st64_b32 v[40:41], v0 offset0:0 offset1:1
    ds_read2st64_b32 v[42:43], v0 offset0:2 offset1:3
    s_sub_u32 s3, s37, 768
    s_cmp_gt_u32 s3, 256
    s_cbranch_scc1 L2_xf56
L2_xg56:
    s_setprio 2
    s_waitcnt vmcnt(10)
    ds_write_b128 v3, v[108:111] offset:0
    s_waitcnt lgkmcnt(12)
    v_cmpx_ne_u64 vcc, v[74:75], v[70:71]
    s_and_b64 s[82:83], vcc, s[80:81]
    s_cbranch_scc1 L2_c57
L2_d57:
    v_mov_b64 v[84:85], v[70:71]
    v_mov_b32 v7, v95
    v_mov_b64 v[86:87], v[74:75]
    s_mov_b64 exec, -1
    s_or_b64 s[80:81], s[80:81], vcc
    v_cmpx_ne_u64 vcc, v[72:73], v[68:69]
    s_and_b64 s[82:83], vcc, s[80:81]
    s_cbranch_scc1 L2_c58
L2_d58:
    v_mov_b64 v[84:85], v[68:69]
    v_mov_b32 v7, v94
    v_mov_b64 v[86:87], v[72:73]
    s_mov_b64 exec, -1
    s_or_b64 s[80:81], s[80:81], vcc
    ds_read_b64 v[70:71], v93
    s_and_b64 exec, s[84:85], s[80:81]
    v_mfma_f32_4x4x4_16b_bf16 v[76:79], v[12:13], v[84:85], 0
    v_mov_b32 v92, v7
    s_andn2_b64 s[80:81], s[80:81], s[84:85]
    v_mfma_f32_4x4x4_16b_bf16 v[76:79], v[10:11], v[86:87], v[76:79]
    s_mov_b64 exec, -1
    ds_read_b64 v[68:69], v92
    s_setprio 1
    s_waitcnt vmcnt(7)
    ds_write_b128 v3, v[112:115] offset:1024
    s_waitcnt lgkmcnt(1)
    v_mfma_f32_4x4x4_16b_bf16 v[80:83], v[10:11], v[70:71], v[80:83]
    v_mfma_f32_4x4x4_16b_bf16 v[76:79], v[10:11], v[68:69], v[76:79]
    v_and_b32 v46, 0x40000000, v39
    v_bitop3_b32 v94, v36, v5, v46 bitop3:0xea
    v_and_b32 v46, 0x80000000, v39
    v_bitop3_b32 v95, v37, v5, v46 bitop3:0xea
    v_perm_b32 v15, v37, v38, s47
    v_bitop3_b32 v46, v37, 0.5, -0.5 bitop3:0xa8
    v_perm_b32 v14, v36, v38, s46
    v_bitop3_b32 v47, v36, 0.5, -0.5 bitop3:0xa8
    v_cvt_pk_bf16_f32 v80, v80, v81
    v_cvt_pk_bf16_f32 v81, v82, v83
    ds_wrxchg_rtn_b64 v[74:75], v93, v[80:81]
    v_cvt_pk_bf16_f32 v76, v76, v77
    v_cvt_pk_bf16_f32 v77, v78, v79
    ds_wrxchg_rtn_b64 v[72:73], v92, v[76:77]
    s_setprio 0
    v_mfma_f32_4x4x4_16b_bf16 v[80:83], v[8:9], v[106:107], 0
    v_mfma_f32_4x4x4_16b_bf16 v[76:79], v[8:9], v[104:105], 0
    v_bitop3_b32 v15, v6, v15, v46 bitop3:0xca
    v_bitop3_b32 v14, v6, v14, v47 bitop3:0xca
    s_nop 1
    v_pk_mul_f32 v[80:81], v[80:81], v[14:15] op_sel:[0,1] op_sel_hi:[1,1]
    v_pk_mul_f32 v[82:83], v[82:83], v[14:15] op_sel:[0,1] op_sel_hi:[1,1]
    v_pk_mul_f32 v[76:77], v[76:77], v[14:15] op_sel:[0,0] op_sel_hi:[1,0]
    v_pk_mul_f32 v[78:79], v[78:79], v[14:15] op_sel:[0,0] op_sel_hi:[1,0]
    s_add_u32 s42, s42, 1
    s_waitcnt lgkmcnt(2)
    s_barrier
    s_bitcmp1_b32 s36, s42
    s_cbranch_scc1 L2_slow
L2_ret3:
    s_setprio 3
    v_and_b32 v47, 0x0fffffff, v44
    v_mov_b32 v39, v44
    buffer_load_dwordx4 v[34:37], v47, s[8:11], 0 offen
    buffer_load_dwordx3 v[36:38], v47, s[8:11], 0 offen offset:8
    s_waitcnt lgkmcnt(0)
    v_cmpx_ne_u64 vcc, v[74:75], v[70:71]
    s_and_b64 s[82:83], vcc, s[80:81]
    s_cbranch_scc1 L2_c59
L2_d59:
    v_mov_b64 v[84:85], v[70:71]
    v_mov_b32 v7, v93
    v_mov_b64 v[86:87], v[74:75]
    s_mov_b64 exec, -1
    s_or_b64 s[80:81], s[80:81], vcc
    v_cmpx_ne_u64 vcc, v[72:73], v[68:69]
    s_and_b64 s[82:83], vcc, s[80:81]
    s_cbranch_scc1 L2_c60
L2_d60:
    v_mov_b64 v[84:85], v[68:69]
    v_mov_b32 v7, v92
    v_mov_b64 v[86:87], v[72:73]
    s_mov_b64 exec, -1
    s_or_b64 s[80:81], s[80:81], vcc
    ds_read_b64 v[70:71], v95
    ds_read_b64 v[68:69], v94
    v_and_b32 v46, 0x20000000, v21
    v_lshrrev_b32 v47, 14, v17
    v_bitop3_b32 v47, v47, v5, v46 bitop3:0xea
    ds_read_b64 v[102:103], v47 offset:63616
    v_bitop3_b32 v93, v17, v5, v46 bitop3:0xea
    v_and_b32 v46, 0x10000000, v21
    v_lshrrev_b32 v47, 14, v16
    v_bitop3_b32 v47, v47, v5, v46 bitop3:0xea
    ds_read_b64 v[100:101], v47 offset:63616
    v_bitop3_b32 v92, v16, v5, v46 bitop3:0xea
    s_waitcnt lgkmcnt(2)
    v_mfma_f32_4x4x4_16b_bf16 v[80:83], v[10:11], v[70:71], v[80:83]
    v_mfma_f32_4x4x4_16b_bf16 v[76:79], v[10:11], v[68:69], v[76:79]
    v_perm_b32 v15, v17, v20, s45
    v_bitop3_b32 v46, v17, 0.5, -0.5 bitop3:0xa8
    v_perm_b32 v14, v16, v20, s44
    v_bitop3_b32 v47, v16, 0.5, -0.5 bitop3:0xa8
    v_cvt_pk_bf16_f32 v80, v80, v81
    v_cvt_pk_bf16_f32 v81, v82, v83
    ds_wrxchg_rtn_b64 v[74:75], v95, v[80:81]
    v_cvt_pk_bf16_f32 v76, v76, v77
    v_cvt_pk_bf16_f32 v77, v78, v79
    ds_wrxchg_rtn_b64 v[72:73], v94, v[76:77]
    s_waitcnt lgkmcnt(2)
    v_mfma_f32_4x4x4_16b_bf16 v[80:83], v[8:9], v[102:103], 0
    v_mfma_f32_4x4x4_16b_bf16 v[76:79], v[8:9], v[100:101], 0
    v_bitop3_b32 v15, v6, v15, v46 bitop3:0xca
    v_bitop3_b32 v14, v6, v14, v47 bitop3:0xca
    v_cmp_lt_u32 s[84:85], v5, v92
    s_nop 0
    v_pk_mul_f32 v[80:81], v[80:81], v[14:15] op_sel:[0,1] op_sel_hi:[1,1]
    v_pk_mul_f32 v[82:83], v[82:83], v[14:15] op_sel:[0,1] op_sel_hi:[1,1]
    v_pk_mul_f32 v[76:77], v[76:77], v[14:15] op_sel:[0,0] op_sel_hi:[1,0]
    v_pk_mul_f32 v[78:79], v[78:79], v[14:15] op_sel:[0,0] op_sel_hi:[1,0]
    buffer_load_dwordx4 v[108:111], v3, s[16:19], s40 offen offset:0
    s_waitcnt lgkmcnt(0)
    v_cmpx_ne_u64 vcc, v[74:75], v[70:71]
    s_and_b64 s[82:83], vcc, s[80:81]
    s_cbranch_scc1 L2_c61
L2_d61:
    v_mov_b64 v[84:85], v[70:71]
    v_mov_b32 v7, v95
    v_mov_b64 v[86:87], v[74:75]
    s_mov_b64 exec, -1
    s_or_b64 s[80:81], s[80:81], vcc
    v_cmpx_ne_u64 vcc, v[72:73], v[68:69]
    s_and_b64 s[82:83], vcc, s[80:81]
    s_cbranch_scc1 L2_c62
L2_d62:
    v_mov_b64 v[84:85], v[68:69]
    v_mov_b32 v7, v94
    v_mov_b64 v[86:87], v[72:73]
    s_mov_b64 exec, -1
    s_or_b64 s[80:81], s[80:81], vcc
    ds_read_b64 v[70:71], v93
    s_and_b64 exec, s[84:85], s[80:81]
    v_mfma_f32_4x4x4_16b_bf16 v[76:79], v[12:13], v[84:85], 0
    v_mov_b32 v92, v7
    s_andn2_b64 s[80:81], s[80:81], s[84:85]
    v_mfma_f32_4x4x4_16b_bf16 v[76:79], v[10:11], v[86:87], v[76:79]
    s_mov_b64 exec, -1
    ds_read_b64 v[68:69], v92
    v_and_b32 v46, 0x80000000, v21
    v_lshrrev_b32 v47, 14, v19
    v_bitop3_b32 v47, v47, v5, v46 bitop3:0xea
    ds_read_b64 v[106:107], v47 offset:63616
    v_bitop3_b32 v95, v19, v5, v46 bitop3:0xea
    v_and_b32 v46, 0x40000000, v21
    v_lshrrev_b32 v47, 14, v18
    v_bitop3_b32 v47, v47, v5, v46 bitop3:0xea
    ds_read_b64 v[104:105], v47 offset:63616
    v_bitop3_b32 v94, v18, v5, v46 bitop3:0xea
    s_waitcnt lgkmcnt(2)
    v_mfma_f32_4x4x4_16b_bf16 v[80:83], v[10:11], v[70:71], v[80:83]
    v_mfma_f32_4x4x4_16b_bf16 v[76:79], v[10:11], v[68:69], v[76:79]
    v_perm_b32 v15, v19, v20, s47
    v_bitop3_b32 v46, v19, 0.5, -0.5 bitop3:0xa8
    v_perm_b32 v14, v18, v20, s46
    v_bitop3_b32 v47, v18, 0.5, -0.5 bitop3:0xa8
    v_cvt_pk_bf16_f32 v80, v80, v81
    v_cvt_pk_bf16_f32 v81, v82, v83
    ds_wrxchg_rtn_b64 v[74:75], v93, v[80:81]
    v_cvt_pk_bf16_f32 v76, v76, v77
    v_cvt_pk_bf16_f32 v77, v78, v79
    ds_wrxchg_rtn_b64 v[72:73], v92, v[76:77]
    s_setprio 2
    s_waitcnt lgkmcnt(2)
    v_mfma_f32_4x4x4_16b_bf16 v[80:83], v[8:9], v[106:107], 0
    v_mfma_f32_4x4x4_16b_bf16 v[76:79], v[8:9], v[104:105], 0
    v_bitop3_b32 v15, v6, v15, v46 bitop3:0xca
    v_bitop3_b32 v14, v6, v14, v47 bitop3:0xca
    s_nop 1
    v_pk_mul_f32 v[80:81], v[80:81], v[14:15] op_sel:[0,1] op_sel_hi:[1,1]
    v_pk_mul_f32 v[82:83], v[82:83], v[14:15] op_sel:[0,1] op_sel_hi:[1,1]
    v_pk_mul_f32 v[76:77], v[76:77], v[14:15] op_sel:[0,0] op_sel_hi:[1,0]
    v_pk_mul_f32 v[78:79], v[78:79], v[14:15] op_sel:[0,0] op_sel_hi:[1,0]
    v_and_b32 v47, 0x0fffffff, v40
    v_mov_b32 v21, v40
    buffer_load_dwordx4 v[16:19], v47, s[8:11], 0 offen
    buffer_load_dwordx3 v[18:20], v47, s[8:11], 0 offen offset:8
    s_waitcnt lgkmcnt(0)
    v_cmpx_ne_u64 vcc, v[74:75], v[70:71]
    s_and_b64 s[82:83], vcc, s[80:81]
    s_cbranch_scc1 L2_c63
L2_d63:
    v_mov_b64 v[84:85], v[70:71]
    v_mov_b32 v7, v93
    v_mov_b64 v[86:87], v[74:75]
    s_mov_b64 exec, -1
    s_or_b64 s[80:81], s[80:81], vcc
    v_cmpx_ne_u64 vcc, v[72:73], v[68:69]
    s_and_b64 s[82:83], vcc, s[80:81]
    s_cbranch_scc1 L2_c64
L2_d64:
    v_mov_b64 v[84:85], v[68:69]
    v_mov_b32 v7, v92
    v_mov_b64 v[86:87], v[72:73]
    s_mov_b64 exec, -1
    s_or_b64 s[80:81], s[80:81], vcc
    ds_read_b64 v[70:71], v95
    ds_read_b64 v[68:69], v94
    s_waitcnt vmcnt(10)
    v_and_b32 v46, 0x20000000, v27
    v_lshrrev_b32 v47, 14, v23
    v_bitop3_b32 v47, v47, v5, v46 bitop3:0xea
    ds_read_b64 v[102:103], v47 offset:63616
    v_bitop3_b32 v93, v23, v5, v46 bitop3:0xea
    v_and_b32 v46, 0x10000000, v27
    v_lshrrev_b32 v47, 14, v22
    v_bitop3_b32 v47, v47, v5, v46 bitop3:0xea
    ds_read_b64 v[100:101], v47 offset:63616
    v_bitop3_b32 v92, v22, v5, v46 bitop3:0xea
    s_waitcnt lgkmcnt(2)
    v_mfma_f32_4x4x4_16b_bf16 v[80:83], v[10:11], v[70:71], v[80:83]
    v_mfma_f32_4x4x4_16b_bf16 v[76:79], v[10:11], v[68:69], v[76:79]
    v_perm_b32 v15, v23, v26, s45
    v_bitop3_b32 v46, v23, 0.5, -0.5 bitop3:0xa8
    v_perm_b32 v14, v22, v26, s44
    v_bitop3_b32 v47, v22, 0.5, -0.5 bitop3:0xa8
    v_cvt_pk_bf16_f32 v80, v80, v81
    v_cvt_pk_bf16_f32 v81, v82, v83
    ds_wrxchg_rtn_b64 v[74:75], v95, v[80:81]
    v_cvt_pk_bf16_f32 v76, v76, v77
    v_cvt_pk_bf16_f32 v77, v78, v79
    ds_wrxchg_rtn_b64 v[72:73], v94, v[76:77]
    s_waitcnt lgkmcnt(2)
    v_mfma_f32_4x4x4_16b_bf16 v[80:83], v[8:9], v[102:103], 0
    v_mfma_f32_4x4x4_16b_bf16 v[76:79], v[8:9], v[100:101], 0
    v_bitop3_b32 v15, v6, v15, v46 bitop3:0xca
    v_bitop3_b32 v14, v6, v14, v47 bitop3:0xca
    v_cmp_lt_u32 s[84:85], v5, v92
    s_nop 0
    v_pk_mul_f32 v[80:81], v[80:81], v[14:15] op_sel:[0,1] op_sel_hi:[1,1]
    v_pk_mul_f32 v[82:83], v[82:83], v[14:15] op_sel:[0,1] op_sel_hi:[1,1]
    v_pk_mul_f32 v[76:77], v[76:77], v[14:15] op_sel:[0,0] op_sel_hi:[1,0]
    v_pk_mul_f32 v[78:79], v[78:79], v[14:15] op_sel:[0,0] op_sel_hi:[1,0]
    v_sub_u16 v88, v58, v50
    v_and_b32 v89, 3, v50
    v_add3_u32 v99, v88, v89, 3
    v_and_b32 v99, -4, v99
    v_max_u32 v99, 4, v99
    v_and_b32 v97, 0xfffc, v50
    v_bfm_b32 v96, v88, v89
    v_add_u32_dpp v91, v99, v99 row_shr:1 row_mask:0xf bank_mask:0xf bound_ctrl:1
    v_mad_u32_u24 v97, v97, 5, v2
    v_cmp_lt_u32 vcc, 16, v99
    v_add_u32_dpp v91, v91, v91 row_shr:2 row_mask:0xf bank_mask:0xf bound_ctrl:1
    v_sub_u32 v98, s38, v99
    v_lshrrev_b64 v[50:51], 16, v[50:51]
    v_add_u32_dpp v91, v91, v91 row_shr:4 row_mask:0xf bank_mask:0xf bound_ctrl:1
    v_lshrrev_b64 v[58:59], 16, v[58:59]
    s_mov_b32 s43, 0
    v_add_u32_dpp v91, v91, v91 row_shr:8 row_mask:0xf bank_mask:0xf bound_ctrl:1
    s_nop 1
    v_add_u32_dpp v91, v91, v91 row_bcast:15 row_mask:0xa bank_mask:0xf
    s_nop 1
    v_add_u32_dpp v91, v91, v91 row_bcast:31 row_mask:0xc bank_mask:0xf
    v_add_u32 v98, v98, v91
    v_readlane_b32 s37, v91, 63
    s_cbranch_vccnz L2_xo65
L2_xp65:
    buffer_load_dwordx4 v[112:115], v3, s[16:19], s40 offen offset:1024
    s_waitcnt lgkmcnt(0)
    v_cmpx_ne_u64 vcc, v[74:75], v[70:71]
    s_and_b64 s[82:83], vcc, s[80:81]
    s_cbranch_scc1 L2_c66
L2_d66:
    v_mov_b64 v[84:85], v[70:71]
    v_mov_b32 v7, v95
    v_mov_b64 v[86:87], v[74:75]
    s_mov_b64 exec, -1
    s_or_b64 s[80:81], s[80:81], vcc
    v_cmpx_ne_u64 vcc, v[72:73], v[68:69]
    s_and_b64 s[82:83], vcc, s[80:81]
    s_cbranch_scc1 L2_c67
L2_d67:
    v_mov_b64 v[84:85], v[68:69]
    v_mov_b32 v7, v94
    v_mov_b64 v[86:87], v[72:73]
    s_mov_b64 exec, -1
    s_or_b64 s[80:81], s[80:81], vcc
    ds_read_b64 v[70:71], v93
    s_and_b64 exec, s[84:85], s[80:81]
    v_mfma_f32_4x4x4_16b_bf16 v[76:79], v[12:13], v[84:85], 0
    v_mov_b32 v92, v7
    s_andn2_b64 s[80:81], s[80:81], s[84:85]
    v_mfma_f32_4x4x4_16b_bf16 v[76:79], v[10:11], v[86:87], v[76:79]
    s_mov_b64 exec, -1
    ds_read_b64 v[68:69], v92
    v_and_b32 v46, 0x80000000, v27
    v_lshrrev_b32 v47, 14, v25
    v_bitop3_b32 v47, v47, v5, v46 bitop3:0xea
    ds_read_b64 v[106:107], v47 offset:63616
    v_bitop3_b32 v95, v25, v5, v46 bitop3:0xea
    v_and_b32 v46, 0x40000000, v27
    v_lshrrev_b32 v47, 14, v24
    v_bitop3_b32 v47, v47, v5, v46 bitop3:0xea
    ds_read_b64 v[104:105], v47 offset:63616
    v_bitop3_b32 v94, v24, v5, v46 bitop3:0xea
    s_waitcnt lgkmcnt(2)
    v_mfma_f32_4x4x4_16b_bf16 v[80:83], v[10:11], v[70:71], v[80:83]
    v_mfma_f32_4x4x4_16b_bf16 v[76:79], v[10:11], v[68:69], v[76:79]
    v_perm_b32 v15, v25, v26, s47
    v_bitop3_b32 v46, v25, 0.5, -0.5 bitop3:0xa8
    v_perm_b32 v14, v24, v26, s46
    v_bitop3_b32 v47, v24, 0.5, -0.5 bitop3:0xa8
    v_cvt_pk_bf16_f32 v80, v80, v81
    v_cvt_pk_bf16_f32 v81, v82, v83
    ds_wrxchg_rtn_b64 v[74:75], v93, v[80:81]
    v_cvt_pk_bf16_f32 v76, v76, v77
    v_cvt_pk_bf16_f32 v77, v78, v79
    ds_wrxchg_rtn_b64 v[72:73], v92, v[76:77]
    s_setprio 1
    s_waitcnt lgkmcnt(2)
    v_mfma_f32_4x4x4_16b_bf16 v[80:83], v[8:9], v[106:107], 0
    v_mfma_f32_4x4x4_16b_bf16 v[76:79], v[8:9], v[104:105], 0
    v_bitop3_b32 v15, v6, v15, v46 bitop3:0xca
    v_bitop3_b32 v14, v6, v14, v47 bitop3:0xca
    s_nop 1
    v_pk_mul_f32 v[80:81], v[80:81], v[14:15] op_sel:[0,1] op_sel_hi:[1,1]
    v_pk_mul_f32 v[82:83], v[82:83], v[14:15] op_sel:[0,1] op_sel_hi:[1,1]
    v_pk_mul_f32 v[76:77], v[76:77], v[14:15] op_sel:[0,0] op_sel_hi:[1,0]
    v_pk_mul_f32 v[78:79], v[78:79], v[14:15] op_sel:[0,0] op_sel_hi:[1,0]
    v_and_b32 v47, 0x0fffffff, v41
    v_mov_b32 v27, v41
    buffer_load_dwordx4 v[22:25], v47, s[8:11], 0 offen
    buffer_load_dwordx3 v[24:26], v47, s[8:11], 0 offen offset:8
    s_waitcnt lgkmcnt(0)
    v_cmpx_ne_u64 vcc, v[74:75], v[70:71]
    s_and_b64 s[82:83], vcc, s[80:81]
    s_cbranch_scc1 L2_c68
L2_d68:
    v_mov_b64 v[84:85], v[70:71]
    v_mov_b32 v7, v93
    v_mov_b64 v[86:87], v[74:75]
    s_mov_b64 exec, -1
    s_or_b64 s[80:81], s[80:81], vcc
    v_cmpx_ne_u64 vcc, v[72:73], v[68:69]
    s_and_b64 s[82:83], vcc, s[80:81]
    s_cbranch_scc1 L2_c69
L2_d69:
    v_mov_b64 v[84:85], v[68:69]
    v_mov_b32 v7, v92
    v_mov_b64 v[86:87], v[72:73]
    s_mov_b64 exec, -1
    s_or_b64 s[80:81], s[80:81], vcc
    ds_read_b64 v[70:71], v95
    ds_read_b64 v[68:69], v94
    s_waitcnt vmcnt(11)
    v_and_b32 v46, 0x20000000, v33
    v_lshrrev_b32 v47, 14, v29
    v_bitop3_b32 v47, v47, v5, v46 bitop3:0xea
    ds_read_b64 v[102:103], v47 offset:63616
    v_bitop3_b32 v93, v29, v5, v46 bitop3:0xea
    v_and_b32 v46, 0x10000000, v33
    v_lshrrev_b32 v47, 14, v28
    v_bitop3_b32 v47, v47, v5, v46 bitop3:0xea
    ds_read_b64 v[100:101], v47 offset:63616
    v_bitop3_b32 v92, v28, v5, v46 bitop3:0xea
    s_waitcnt lgkmcnt(2)
    v_mfma_f32_4x4x4_16b_bf16 v[80:83], v[10:11], v[70:71], v[80:83]
    v_mfma_f32_4x4x4_16b_bf16 v[76:79], v[10:11], v[68:69], v[76:79]
    v_perm_b32 v15, v29, v32, s45
    v_bitop3_b32 v46, v29, 0.5, -0.5 bitop3:0xa8
    v_perm_b32 v14, v28, v32, s44
    v_bitop3_b32 v47, v28, 0.5, -0.5 bitop3:0xa8
    v_cvt_pk_bf16_f32 v80, v80, v81
    v_cvt_pk_bf16_f32 v81, v82, v83
    ds_wrxchg_rtn_b64 v[74:75], v95, v[80:81]
    v_cvt_pk_bf16_f32 v76, v76, v77
    v_cvt_pk_bf16_f32 v77, v78, v79
    ds_wrxchg_rtn_b64 v[72:73], v94, v[76:77]
    s_waitcnt lgkmcnt(2)
    v_mfma_f32_4x4x4_16b_bf16 v[80:83], v[8:9], v[102:103], 0
    v_mfma_f32_4x4x4_16b_bf16 v[76:79], v[8:9], v[100:101], 0
    v_bitop3_b32 v15, v6, v15, v46 bitop3:0xca
    v_bitop3_b32 v14, v6, v14, v47 bitop3:0xca
    v_cmp_lt_u32 s[84:85], v5, v92
    s_nop 0
    v_pk_mul_f32 v[80:81], v[80:81], v[14:15] op_sel:[0,1] op_sel_hi:[1,1]
    v_pk_mul_f32 v[82:83], v[82:83], v[14:15] op_sel:[0,1] op_sel_hi:[1,1]
    v_pk_mul_f32 v[76:77], v[76:77], v[14:15] op_sel:[0,0] op_sel_hi:[1,0]
    v_pk_mul_f32 v[78:79], v[78:79], v[14:15] op_sel:[0,0] op_sel_hi:[1,0]
    s_waitcnt lgkmcnt(0)
    v_cmpx_ne_u64 vcc, v[74:75], v[70:71]
    s_and_b64 s[82:83], vcc, s[80:81]
    s_cbranch_scc1 L2_c70
L2_d70:
    v_mov_b64 v[84:85], v[70:71]
    v_mov_b32 v7, v95
    v_mov_b64 v[86:87], v[74:75]
    s_mov_b64 exec, -1
    s_or_b64 s[80:81], s[80:81], vcc
    v_cmpx_ne_u64 vcc, v[72:73], v[68:69]
    s_and_b64 s[82:83], vcc, s[80:81]
    s_cbranch_scc1 L2_c71
L2_d71:
    v_mov_b64 v[84:85], v[68:69]
    v_mov_b32 v7, v94
    v_mov_b64 v[86:87], v[72:73]
    s_mov_b64 exec, -1
    s_or_b64 s[80:81], s[80:81], vcc
    ds_read_b64 v[70:71], v93
    s_and_b64 exec, s[84:85], s[80:81]
    v_mfma_f32_4x4x4_16b_bf16 v[76:79], v[12:13], v[84:85], 0
    v_mov_b32 v92, v7
    s_andn2_b64 s[80:81], s[80:81], s[84:85]
    v_mfma_f32_4x4x4_16b_bf16 v[76:79], v[10:11], v[86:87], v[76:79]
    s_mov_b64 exec, -1
    ds_read_b64 v[68:69], v92
    v_and_b32 v46, 0x80000000, v33
    v_lshrrev_b32 v47, 14, v31
    v_bitop3_b32 v47, v47, v5, v46 bitop3:0xea
    ds_read_b64 v[106:107], v47 offset:63616
    v_bitop3_b32 v95, v31, v5, v46 bitop3:0xea
    v_and_b32 v46, 0x40000000, v33
    v_lshrrev_b32 v47, 14, v30
    v_bitop3_b32 v47, v47, v5, v46 bitop3:0xea
    ds_read_b64 v[104:105], v47 offset:63616
    v_bitop3_b32 v94, v30, v5, v46 bitop3:0xea
    s_waitcnt lgkmcnt(2)
    v_mfma_f32_4x4x4_16b_bf16 v[80:83], v[10:11], v[70:71], v[80:83]
    v_mfma_f32_4x4x4_16b_bf16 v[76:79], v[10:11], v[68:69], v[76:79]
    v_perm_b32 v15, v31, v32, s47
    v_bitop3_b32 v46, v31, 0.5, -0.5 bitop3:0xa8
    v_perm_b32 v14, v30, v32, s46
    v_bitop3_b32 v47, v30, 0.5, -0.5 bitop3:0xa8
    v_cvt_pk_bf16_f32 v80, v80, v81
    v_cvt_pk_bf16_f32 v81, v82, v83
    ds_wrxchg_rtn_b64 v[74:75], v93, v[80:81]
    v_cvt_pk_bf16_f32 v76, v76, v77
    v_cvt_pk_bf16_f32 v77, v78, v79
    ds_wrxchg_rtn_b64 v[72:73], v92, v[76:77]
    s_setprio 0
    s_waitcnt lgkmcnt(2)
    v_mfma_f32_4x4x4_16b_bf16 v[80:83], v[8:9], v[106:107], 0
    v_mfma_f32_4x4x4_16b_bf16 v[76:79], v[8:9], v[104:105], 0
    v_bitop3_b32 v15, v6, v15, v46 bitop3:0xca
    v_bitop3_b32 v14, v6, v14, v47 bitop3:0xca
    s_nop 1
    v_pk_mul_f32 v[80:81], v[80:81], v[14:15] op_sel:[0,1] op_sel_hi:[1,1]
    v_pk_mul_f32 v[82:83], v[82:83], v[14:15] op_sel:[0,1] op_sel_hi:[1,1]
    v_pk_mul_f32 v[76:77], v[76:77], v[14:15] op_sel:[0,0] op_sel_hi:[1,0]
    v_pk_mul_f32 v[78:79], v[78:79], v[14:15] op_sel:[0,0] op_sel_hi:[1,0]
    s_add_u32 s40, s40, 0x4e200
    v_and_b32 v47, 0x0fffffff, v42
    v_mov_b32 v33, v42
    buffer_load_dwordx4 v[28:31], v47, s[8:11], 0 offen
    buffer_load_dwordx3 v[30:32], v47, s[8:11], 0 offen offset:8
    s_waitcnt lgkmcnt(0)
    v_cmpx_ne_u64 vcc, v[74:75], v[70:71]
    s_and_b64 s[82:83], vcc, s[80:81]
    s_cbranch_scc1 L2_c72
L2_d72:
    v_mov_b64 v[84:85], v[70:71]
    v_mov_b32 v7, v93
    v_mov_b64 v[86:87], v[74:75]
    s_mov_b64 exec, -1
    s_or_b64 s[80:81], s[80:81], vcc
    v_cmpx_ne_u64 vcc, v[72:73], v[68:69]
    s_and_b64 s[82:83], vcc, s[80:81]
    s_cbranch_scc1 L2_c73
L2_d73:
    v_mov_b64 v[84:85], v[68:69]
    v_mov_b32 v7, v92
    v_mov_b64 v[86:87], v[72:73]
    s_mov_b64 exec, -1
    s_or_b64 s[80:81], s[80:81], vcc
    ds_read_b64 v[70:71], v95
    ds_read_b64 v[68:69], v94
    s_waitcnt vmcnt(8)
    v_and_b32 v46, 0x20000000, v39
    v_lshrrev_b32 v47, 14, v35
    v_bitop3_b32 v47, v47, v5, v46 bitop3:0xea
    ds_read_b64 v[102:103], v47 offset:63616
    v_bitop3_b32 v93, v35, v5, v46 bitop3:0xea
    v_and_b32 v46, 0x10000000, v39
    v_lshrrev_b32 v47, 14, v34
    v_bitop3_b32 v47, v47, v5, v46 bitop3:0xea
    ds_read_b64 v[100:101], v47 offset:63616
    v_bitop3_b32 v92, v34, v5, v46 bitop3:0xea
    v_and_b32 v46, 0x80000000, v39
    v_lshrrev_b32 v47, 14, v37
    v_bitop3_b32 v47, v47, v5, v46 bitop3:0xea
    ds_read_b64 v[106:107], v47 offset:63616
    v_and_b32 v46, 0x40000000, v39
    v_lshrrev_b32 v47, 14, v36
    v_bitop3_b32 v47, v47, v5, v46 bitop3:0xea
    ds_read_b64 v[104:105], v47 offset:63616
    s_waitcnt lgkmcnt(4)
    v_mfma_f32_4x4x4_16b_bf16 v[80:83], v[10:11], v[70:71], v[80:83]
    v_mfma_f32_4x4x4_16b_bf16 v[76:79], v[10:11], v[68:69], v[76:79]
    v_perm_b32 v15, v35, v38, s45
    v_bitop3_b32 v46, v35, 0.5, -0.5 bitop3:0xa8
    v_perm_b32 v14, v34, v38, s44
    v_bitop3_b32 v47, v34, 0.5, -0.5 bitop3:0xa8
    v_cvt_pk_bf16_f32 v80, v80, v81
    v_cvt_pk_bf16_f32 v81, v82, v83
    ds_wrxchg_rtn_b64 v[74:75], v95, v[80:81]
    v_cvt_pk_bf16_f32 v76, v76, v77
    v_cvt_pk_bf16_f32 v77, v78, v79
    ds_wrxchg_rtn_b64 v[72:73], v94, v[76:77]
    s_waitcnt lgkmcnt(2)
    s_barrier
    s_setprio 3
    ds_write_b128 v3, v[124:127] offset:4096
    s_add_u32 s3, s40, 4096
    buffer_load_dwordx4 v[124:127], v3, s[16:19], s3 offen
    ds_write_b128 v3, v[116:119] offset:2048
    buffer_load_dwordx4 v[116:119], v3, s[16:19], s40 offen offset:2048
    ds_write_b128 v3, v[120:123] offset:3072
    buffer_load_dwordx4 v[120:123], v3, s[16:19], s40 offen offset:3072
    v_mfma_f32_4x4x4_16b_bf16 v[80:83], v[8:9], v[102:103], 0
    v_mfma_f32_4x4x4_16b_bf16 v[76:79], v[8:9], v[100:101], 0
    v_bitop3_b32 v15, v6, v15, v46 bitop3:0xca
    v_bitop3_b32 v14, v6, v14, v47 bitop3:0xca
    v_cmp_lt_u32 s[84:85], v5, v92
    s_nop 0
    v_pk_mul_f32 v[80:81], v[80:81], v[14:15] op_sel:[0,1] op_sel_hi:[1,1]
    v_pk_mul_f32 v[82:83], v[82:83], v[14:15] op_sel:[0,1] op_sel_hi:[1,1]
    v_pk_mul_f32 v[76:77], v[76:77], v[14:15] op_sel:[0,0] op_sel_hi:[1,0]
    v_pk_mul_f32 v[78:79], v[78:79], v[14:15] op_sel:[0,0] op_sel_hi:[1,0]
    v_mov_b32 v44, v43
    s_cmp_gt_u32 s37, 1024
    s_cbranch_scc1 L2_xs74
    s_cmp_lg_u32 s43, 0
    s_cbranch_scc1 L2_xa74
L2_xb74:
    v_lshlrev_b32 v89, 16, v96
    v_add_u32 v90, 60, v97
    v_bitop3_b32 v90, v89, v45, v90 bitop3:0x6a
    ds_write_b32 v98, v90 offset:12
    v_lshlrev_b32 v89, 20, v96
    v_add_u32 v90, 40, v97
    v_bitop3_b32 v90, v89, v45, v90 bitop3:0x6a
    ds_write_b32 v98, v90 offset:8
    v_lshlrev_b32 v89, 24, v96
    v_add_u32 v90, 20, v97
    v_bitop3_b32 v90, v89, v45, v90 bitop3:0x6a
    ds_write_b32 v98, v90 offset:4
    v_lshlrev_b32 v89, 28, v96
    v_bitop3_b32 v90, v89, v45, v97 bitop3:0x6a
    ds_write_b32 v98, v90 offset:0
    v_mov_b32_dpp v91, v66 quad_perm:[0,0,0,0] row_mask:0xf bank_mask:0xf
    v_and_b32 v89, 3, v91
    v_and_b32 v97, 0xfffc, v91
    v_sub_u16_dpp v88, v66, v91 quad_perm:[2,2,2,2] row_mask:0xf bank_mask:0xf
    v_mad_u32_u24 v97, v97, 5, v4
    v_add_u32 v99, v88, v89
    v_bfm_b32 v96, v88, v89
    v_cmp_lt_u32 s[58:59], 16, v99
    v_lshlrev_b32 v89, v1, v96
    v_and_b32 v89, v45, v89
    v_cmp_ne_u32 vcc, 0, v89
    v_xor_b32 v90, v97, v89
    s_add_u32 s3, s37, s38
    v_mbcnt_lo_u32_b32 v98, vcc_lo, 0
    v_mbcnt_hi_u32_b32 v98, vcc_hi, v98
    s_bcnt1_i32_b64 s41, vcc
    v_lshl_add_u32 v98, v98, 2, s3
    s_mov_b64 exec, vcc
    ds_write_b32 v98, v90
    s_mov_b64 exec, -1
    s_lshl2_add_u32 s37, s41, s37
    s_cmp_lg_u64 s[58:59], 0
    s_cbranch_scc1 L2_xe74
L2_xr74:
    v_add_u32 v98, s37, v0
    v_mov_b32 v90, -1
    ds_write_b32 v98, v90
    ds_read2st64_b32 v[40:41], v0 offset0:0 offset1:1
    ds_read2st64_b32 v[42:43], v0 offset0:2 offset1:3
    s_sub_u32 s3, s37, 768
    s_cmp_gt_u32 s3, 256
    s_cbranch_scc1 L2_xf74
L2_xg74:
    s_setprio 2
    s_waitcnt vmcnt(10)
    ds_write_b128 v3, v[108:111] offset:0
    s_waitcnt lgkmcnt(12)
    v_cmpx_ne_u64 vcc, v[74:75], v[70:71]
    s_and_b64 s[82:83], vcc, s[80:81]
    s_cbranch_scc1 L2_c75
L2_d75:
    v_mov_b64 v[84:85], v[70:71]
    v_mov_b32 v7, v95
    v_mov_b64 v[86:87], v[74:75]
    s_mov_b64 exec, -1
    s_or_b64 s[80:81], s[80:81], vcc
    v_cmpx_ne_u64 vcc, v[72:73], v[68:69]
    s_and_b64 s[82:83], vcc, s[80:81]
    s_cbranch_scc1 L2_c76
L2_d76:
    v_mov_b64 v[84:85], v[68:69]
    v_mov_b32 v7, v94
    v_mov_b64 v[86:87], v[72:73]
    s_mov_b64 exec, -1
    s_or_b64 s[80:81], s[80:81], vcc
    ds_read_b64 v[70:71], v93
    s_and_b64 exec, s[84:85], s[80:81]
    v_mfma_f32_4x4x4_16b_bf16 v[76:79], v[12:13], v[84:85], 0
    v_mov_b32 v92, v7
    s_andn2_b64 s[80:81], s[80:81], s[84:85]
    v_mfma_f32_4x4x4_16b_bf16 v[76:79], v[10:11], v[86:87], v[76:79]
    s_mov_b64 exec, -1
    ds_read_b64 v[68:69], v92
    s_setprio 1
    s_waitcnt vmcnt(7)
    ds_write_b128 v3, v[112:115] offset:1024
    s_waitcnt lgkmcnt(1)
    v_mfma_f32_4x4x4_16b_bf16 v[80:83], v[10:11], v[70:71], v[80:83]
    v_mfma_f32_4x4x4_16b_bf16 v[76:79], v[10:11], v[68:69], v[76:79]
    v_and_b32 v46, 0x40000000, v39
    v_bitop3_b32 v94, v36, v5, v46 bitop3:0xea
    v_and_b32 v46, 0x80000000, v39
    v_bitop3_b32 v95, v37, v5, v46 bitop3:0xea
    v_perm_b32 v15, v37, v38, s47
    v_bitop3_b32 v46, v37, 0.5, -0.5 bitop3:0xa8
    v_perm_b32 v14, v36, v38, s46
    v_bitop3_b32 v47, v36, 0.5, -0.5 bitop3:0xa8
    v_cvt_pk_bf16_f32 v80, v80, v81
    v_cvt_pk_bf16_f32 v81, v82, v83
    ds_wrxchg_rtn_b64 v[74:75], v93, v[80:81]
    v_cvt_pk_bf16_f32 v76, v76, v77
    v_cvt_pk_bf16_f32 v77, v78, v79
    ds_wrxchg_rtn_b64 v[72:73], v92, v[76:77]
    s_setprio 0
    v_mfma_f32_4x4x4_16b_bf16 v[80:83], v[8:9], v[106:107], 0
    v_mfma_f32_4x4x4_16b_bf16 v[76:79], v[8:9], v[104:105], 0
    v_bitop3_b32 v15, v6, v15, v46 bitop3:0xca
    v_bitop3_b32 v14, v6, v14, v47 bitop3:0xca
    s_nop 1
    v_pk_mul_f32 v[80:81], v[80:81], v[14:15] op_sel:[0,1] op_sel_hi:[1,1]
    v_pk_mul_f32 v[82:83], v[82:83], v[14:15] op_sel:[0,1] op_sel_hi:[1,1]
    v_pk_mul_f32 v[76:77], v[76:77], v[14:15] op_sel:[0,0] op_sel_hi:[1,0]
    v_pk_mul_f32 v[78:79], v[78:79], v[14:15] op_sel:[0,0] op_sel_hi:[1,0]
    s_cmp_eq_u32 s35, 3
    s_cbranch_scc1 L2_done
    s_add_u32 s35, s35, 1
    s_add_u32 s42, s42, 1
    s_waitcnt lgkmcnt(2)
    s_branch L2_loop
L2_done:
    s_waitcnt lgkmcnt(0)
    v_cmpx_ne_u64 vcc, v[74:75], v[70:71]
    s_and_b64 s[82:83], vcc, s[80:81]
    s_cbranch_scc1 L2_c77
L2_d77:
    v_mov_b64 v[84:85], v[70:71]
    v_mov_b32 v7, v93
    v_mov_b64 v[86:87], v[74:75]
    s_mov_b64 exec, -1
    s_or_b64 s[80:81], s[80:81], vcc
    v_cmpx_ne_u64 vcc, v[72:73], v[68:69]
    s_and_b64 s[82:83], vcc, s[80:81]
    s_cbranch_scc1 L2_c78
L2_d78:
    v_mov_b64 v[84:85], v[68:69]
    v_mov_b32 v7, v92
    v_mov_b64 v[86:87], v[72:73]
    s_mov_b64 exec, -1
    s_or_b64 s[80:81], s[80:81], vcc
    ds_read_b64 v[70:71], v95
    ds_read_b64 v[68:69], v94
    s_waitcnt lgkmcnt(0)
    v_mfma_f32_4x4x4_16b_bf16 v[80:83], v[10:11], v[70:71], v[80:83]
    v_mfma_f32_4x4x4_16b_bf16 v[76:79], v[10:11], v[68:69], v[76:79]
    s_nop 3
    v_cvt_pk_bf16_f32 v80, v80, v81
    v_cvt_pk_bf16_f32 v81, v82, v83
    ds_wrxchg_rtn_b64 v[74:75], v95, v[80:81]
    v_cvt_pk_bf16_f32 v76, v76, v77
    v_cvt_pk_bf16_f32 v77, v78, v79
    ds_wrxchg_rtn_b64 v[72:73], v94, v[76:77]
    s_waitcnt lgkmcnt(0)
    v_cmpx_ne_u64 vcc, v[74:75], v[70:71]
    s_and_b64 s[82:83], vcc, s[80:81]
    s_cbranch_scc1 L2_c79
L2_d79:
    v_mov_b64 v[84:85], v[70:71]
    v_mov_b32 v7, v95
    v_mov_b64 v[86:87], v[74:75]
    s_mov_b64 exec, -1
    s_or_b64 s[80:81], s[80:81], vcc
    v_cmpx_ne_u64 vcc, v[72:73], v[68:69]
    s_and_b64 s[82:83], vcc, s[80:81]
    s_cbranch_scc1 L2_c80
L2_d80:
    v_mov_b64 v[84:85], v[68:69]
    v_mov_b32 v7, v94
    v_mov_b64 v[86:87], v[72:73]
    s_mov_b64 exec, -1
    s_or_b64 s[80:81], s[80:81], vcc
    s_mov_b64 exec, s[80:81]
    s_nop 1
    v_mfma_f32_4x4x4_16b_bf16 v[88:91], v[12:13], v[84:85], 0
    s_nop 1
    v_mfma_f32_4x4x4_16b_bf16 v[88:91], v[10:11], v[86:87], v[88:91]
    s_nop 4
    v_cvt_pk_bf16_f32 v88, v88, v89
    v_cvt_pk_bf16_f32 v89, v90, v91
    ds_pk_add_bf16 v7, v88
    ds_pk_add_bf16 v7, v89 offset:4
    s_mov_b64 exec, -1
    s_lshl_b32 s3, s32, 12
    s_add_u32 s3, s3, 80000
    s_waitcnt vmcnt(0) lgkmcnt(0)
    s_barrier
    v_subrev_u32 v16, s3, v3
    v_add_u32 v17, 16384, v16
    v_add_u32 v18, 32768, v16
    v_add_u32 v19, 49152, v16
    v_add_u32 v20, 65536, v16
    ds_read_b128 v[48:51], v16
    ds_read_b128 v[52:55], v17
    ds_read_b128 v[56:59], v18
    ds_read_b128 v[60:63], v19
    ds_read_b128 v[64:67], v20
    s_waitcnt lgkmcnt(4)
    buffer_store_dwordx4 v[48:51], v16, s[20:23], 0 offen sc1
    s_waitcnt lgkmcnt(3)
    buffer_store_dwordx4 v[52:55], v17, s[20:23], 0 offen sc1
    s_waitcnt lgkmcnt(2)
    buffer_store_dwordx4 v[56:59], v18, s[20:23], 0 offen sc1
    s_waitcnt lgkmcnt(1)
    buffer_store_dwordx4 v[60:63], v19, s[20:23], 0 offen sc1
    s_waitcnt lgkmcnt(0)
    buffer_store_dwordx4 v[64:67], v20, s[20:23], 0 offen sc1
L2_end:
    s_endpgm
L2_slow:
    s_mul_i32 s50, s32, 80
    s_add_u32 s57, s50, 80
    s_and_b32 s3, s42, 3
    s_lshl_b32 s53, s3, 3
    s_add_u32 s53, s53, s39
    s_and_b32 s3, s35, 2
    s_lshl_b32 s3, s3, 1
    s_add_u32 s53, s53, s3
    s_and_b32 s54, s35, 1
    s_lshl_b32 s54, s54, 4
L2_sl_seg:
    s_mul_i32 s56, s50, 173056
    s_add_u32 s3, s56, s53
    s_add_u32 s55, s3, 32
    s_buffer_load_dword s51, s[12:15], s3
    s_buffer_load_dword s52, s[12:15], s55
    s_waitcnt lgkmcnt(0)
    s_lshr_b32 s51, s51, s54
    s_and_b32 s51, s51, 0xffff
    s_lshr_b32 s52, s52, s54
    s_and_b32 s52, s52, 0xffff
L2_sl_rec:
    s_cmp_ge_u32 s51, s52
    s_cbranch_scc1 L2_sl_next
    v_mbcnt_lo_u32_b32 v102, -1, 0
    v_mbcnt_hi_u32_b32 v102, -1, v102
    v_add_u32 v102, s51, v102
    v_and_b32 v103, -4, v102
    v_lshl_add_u32 v104, v102, 2, v103
    v_lshl_add_u32 v105, v103, 2, v102
    v_cmp_gt_u32 vcc, s52, v102
    s_mov_b64 exec, vcc
    buffer_load_dword v106, v104, s[8:11], s56 offen
    buffer_load_ubyte v107, v105, s[8:11], s56 offen offset:16
    s_waitcnt vmcnt(0)
    v_lshrrev_b32 v98, 14, v106
    v_and_b32 v98, v5, v98
    ds_read_b64 v[100:101], v98 offset:63616
    v_perm_b32 v97, v106, v107, s44
    v_and_b32 v96, v5, v106
    v_bitop3_b32 v103, v106, 0.5, -0.5 bitop3:0xa8
    v_bitop3_b32 v97, v6, v97, v103 bitop3:0xca
    s_waitcnt lgkmcnt(0)
    v_mfma_f32_4x4x4_16b_bf16 v[88:91], v[8:9], v[100:101], 0
    s_nop 4
    v_mul_f32 v88, v97, v88
    v_mul_f32 v89, v97, v89
    v_mul_f32 v90, v97, v90
    v_mul_f32 v91, v97, v91
    v_cvt_pk_bf16_f32 v88, v88, v89
    v_cvt_pk_bf16_f32 v89, v90, v91
    ds_pk_add_bf16 v96, v88
    ds_pk_add_bf16 v96, v89 offset:4
    s_mov_b64 exec, -1
    s_add_u32 s51, s51, 64
    s_branch L2_sl_rec
L2_sl_next:
    s_add_u32 s50, s50, 1
    s_cmp_lt_u32 s50, s57
    s_cbranch_scc1 L2_sl_seg
    s_waitcnt lgkmcnt(0)
    s_and_b32 s3, s42, 3
    s_cmp_eq_u32 s3, 0
    s_cbranch_scc1 L2_ret0
    s_cmp_eq_u32 s3, 1
    s_cbranch_scc1 L2_ret1
    s_cmp_eq_u32 s3, 2
    s_cbranch_scc1 L2_ret2
    s_branch L2_ret3
L2_xo1:
    v_cmp_lt_u32 vcc, 20, v99
    s_mov_b32 s43, 1
    s_cbranch_vccz L2_xp1
    v_cmp_lt_u32 vcc, 32, v99
    v_cmp_lt_u32 s[58:59], 31, v88
    s_mov_b32 s43, 2
    s_or_b64 vcc, vcc, s[58:59]
    s_cbranch_scc0 L2_xp1
    s_mov_b32 s37, 0x10000
    s_branch L2_xp1
L2_xa2:
    s_cmp_eq_u32 s43, 1
    s_cbranch_scc1 L2_xc2
    v_lshlrev_b32 v89, 0, v96
    v_add_u32 v90, 140, v97
    v_bitop3_b32 v90, v89, v45, v90 bitop3:0x6a
    ds_write_b32 v98, v90 offset:28
    v_lshlrev_b32 v89, 4, v96
    v_add_u32 v90, 120, v97
    v_bitop3_b32 v90, v89, v45, v90 bitop3:0x6a
    ds_write_b32 v98, v90 offset:24
    v_lshlrev_b32 v89, 8, v96
    v_add_u32 v90, 100, v97
    v_bitop3_b32 v90, v89, v45, v90 bitop3:0x6a
    ds_write_b32 v98, v90 offset:20
L2_xc2:
    v_lshlrev_b32 v89, 12, v96
    v_add_u32 v90, 80, v97
    v_bitop3_b32 v90, v89, v45, v90 bitop3:0x6a
    ds_write_b32 v98, v90 offset:16
    s_branch L2_xb2
L2_xe2:
    v_cmp_lt_u32 vcc, 32, v99
    v_cmp_lt_u32 s[58:59], 31, v88
    v_lshrrev_b32 v89, 16, v96
    v_add_u32 v97, 80, v97
    s_or_b64 vcc, vcc, s[58:59]
    s_cbranch_scc1 L2_xs2
    v_lshlrev_b32 v89, v1, v89
    v_and_b32 v89, v45, v89
    v_cmp_ne_u32 vcc, 0, v89
    v_xor_b32 v90, v97, v89
    s_add_u32 s3, s37, s38
    v_mbcnt_lo_u32_b32 v98, vcc_lo, 0
    v_mbcnt_hi_u32_b32 v98, vcc_hi, v98
    s_bcnt1_i32_b64 s41, vcc
    v_lshl_add_u32 v98, v98, 2, s3
    s_mov_b64 exec, vcc
    ds_write_b32 v98, v90
    s_mov_b64 exec, -1
    s_lshl2_add_u32 s37, s41, s37
    s_branch L2_xr2
L2_xf2:
    s_waitcnt lgkmcnt(0)
    s_cmp_gt_u32 s37, 1024
    s_cbranch_scc1 L2_xs2
    v_mov_b32 v43, -1
    s_cmp_ge_u32 s37, 512
    s_cbranch_scc1 L2_xg2
    v_mov_b32 v42, -1
    s_cmp_ge_u32 s37, 256
    s_cbranch_scc1 L2_xg2
    v_mov_b32 v41, -1
    s_branch L2_xg2
L2_xs2:
    s_waitcnt lgkmcnt(0)
    v_mov_b32 v40, -1
    v_mov_b32 v41, -1
    v_mov_b32 v42, -1
    v_mov_b32 v43, -1
    s_add_u32 s3, s42, 0
    s_bitset1_b32 s36, s3
    s_branch L2_xg2
L2_xo3:
    v_cmp_lt_u32 vcc, 20, v99
    s_mov_b32 s43, 1
    s_cbranch_vccz L2_xp3
    v_cmp_lt_u32 vcc, 32, v99
    v_cmp_lt_u32 s[58:59], 31, v88
    s_mov_b32 s43, 2
    s_or_b64 vcc, vcc, s[58:59]
    s_cbranch_scc0 L2_xp3
    s_mov_b32 s37, 0x10000
    s_branch L2_xp3
L2_xa4:
    s_cmp_eq_u32 s43, 1
    s_cbranch_scc1 L2_xc4
    v_lshlrev_b32 v89, 0, v96
    v_add_u32 v90, 140, v97
    v_bitop3_b32 v90, v89, v45, v90 bitop3:0x6a
    ds_write_b32 v98, v90 offset:28
    v_lshlrev_b32 v89, 4, v96
    v_add_u32 v90, 120, v97
    v_bitop3_b32 v90, v89, v45, v90 bitop3:0x6a
    ds_write_b32 v98, v90 offset:24
    v_lshlrev_b32 v89, 8, v96
    v_add_u32 v90, 100, v97
    v_bitop3_b32 v90, v89, v45, v90 bitop3:0x6a
    ds_write_b32 v98, v90 offset:20
L2_xc4:
    v_lshlrev_b32 v89, 12, v96
    v_add_u32 v90, 80, v97
    v_bitop3_b32 v90, v89, v45, v90 bitop3:0x6a
    ds_write_b32 v98, v90 offset:16
    s_branch L2_xb4
L2_xe4:
    v_cmp_lt_u32 vcc, 32, v99
    v_cmp_lt_u32 s[58:59], 31, v88
    v_lshrrev_b32 v89, 16, v96
    v_add_u32 v97, 80, v97
    s_or_b64 vcc, vcc, s[58:59]
    s_cbranch_scc1 L2_xs4
    v_lshlrev_b32 v89, v1, v89
    v_and_b32 v89, v45, v89
    v_cmp_ne_u32 vcc, 0, v89
    v_xor_b32 v90, v97, v89
    s_add_u32 s3, s37, s38
    v_mbcnt_lo_u32_b32 v98, vcc_lo, 0
    v_mbcnt_hi_u32_b32 v98, vcc_hi, v98
    s_bcnt1_i32_b64 s41, vcc
    v_lshl_add_u32 v98, v98, 2, s3
    s_mov_b64 exec, vcc
    ds_write_b32 v98, v90
    s_mov_b64 exec, -1
    s_lshl2_add_u32 s37, s41, s37
    s_branch L2_xr4
L2_xf4:
    s_waitcnt lgkmcnt(0)
    s_cmp_gt_u32 s37, 1024
    s_cbranch_scc1 L2_xs4
    v_mov_b32 v43, -1
    s_cmp_ge_u32 s37, 512
    s_cbranch_scc1 L2_xg4
    v_mov_b32 v42, -1
    s_cmp_ge_u32 s37, 256
    s_cbranch_scc1 L2_xg4
    v_mov_b32 v41, -1
    s_branch L2_xg4
L2_xs4:
    s_waitcnt lgkmcnt(0)
    v_mov_b32 v40, -1
    v_mov_b32 v41, -1
    v_mov_b32 v42, -1
    v_mov_b32 v43, -1
    s_add_u32 s3, s42, 1
    s_bitset1_b32 s36, s3
    s_branch L2_xg4
L2_c5:
    s_mov_b64 exec, s[82:83]
    s_nop 1
    v_mfma_f32_4x4x4_16b_bf16 v[88:91], v[12:13], v[84:85], 0
    s_nop 1
    v_mfma_f32_4x4x4_16b_bf16 v[88:91], v[10:11], v[86:87], v[88:91]
    s_nop 4
    v_cvt_pk_bf16_f32 v88, v88, v89
    v_cvt_pk_bf16_f32 v89, v90, v91
    ds_pk_add_bf16 v7, v88
    ds_pk_add_bf16 v7, v89 offset:4
    s_mov_b64 exec, vcc
    s_branch L2_d5
L2_c6:
    s_mov_b64 exec, s[82:83]
    s_nop 1
    v_mfma_f32_4x4x4_16b_bf16 v[88:91], v[12:13], v[84:85], 0
    s_nop 1
    v_mfma_f32_4x4x4_16b_bf16 v[88:91], v[10:11], v[86:87], v[88:91]
    s_nop 4
    v_cvt_pk_bf16_f32 v88, v88, v89
    v_cvt_pk_bf16_f32 v89, v90, v91
    ds_pk_add_bf16 v7, v88
    ds_pk_add_bf16 v7, v89 offset:4
    s_mov_b64 exec, vcc
    s_branch L2_d6
L2_c7:
    s_mov_b64 exec, s[82:83]
    s_nop 1
    v_mfma_f32_4x4x4_16b_bf16 v[88:91], v[12:13], v[84:85], 0
    s_nop 1
    v_mfma_f32_4x4x4_16b_bf16 v[88:91], v[10:11], v[86:87], v[88:91]
    s_nop 4
    v_cvt_pk_bf16_f32 v88, v88, v89
    v_cvt_pk_bf16_f32 v89, v90, v91
    ds_pk_add_bf16 v7, v88
    ds_pk_add_bf16 v7, v89 offset:4
    s_mov_b64 exec, vcc
    s_branch L2_d7
L2_c8:
    s_mov_b64 exec, s[82:83]
    s_nop 1
    v_mfma_f32_4x4x4_16b_bf16 v[88:91], v[12:13], v[84:85], 0
    s_nop 1
    v_mfma_f32_4x4x4_16b_bf16 v[88:91], v[10:11], v[86:87], v[88:91]
    s_nop 4
    v_cvt_pk_bf16_f32 v88, v88, v89
    v_cvt_pk_bf16_f32 v89, v90, v91
    ds_pk_add_bf16 v7, v88
    ds_pk_add_bf16 v7, v89 offset:4
    s_mov_b64 exec, vcc
    s_branch L2_d8
L2_c9:
    s_mov_b64 exec, s[82:83]
    s_nop 1
    v_mfma_f32_4x4x4_16b_bf16 v[88:91], v[12:13], v[84:85], 0
    s_nop 1
    v_mfma_f32_4x4x4_16b_bf16 v[88:91], v[10:11], v[86:87], v[88:91]
    s_nop 4
    v_cvt_pk_bf16_f32 v88, v88, v89
    v_cvt_pk_bf16_f32 v89, v90, v91
    ds_pk_add_bf16 v7, v88
    ds_pk_add_bf16 v7, v89 offset:4
    s_mov_b64 exec, vcc
    s_branch L2_d9
L2_c10:
    s_mov_b64 exec, s[82:83]
    s_nop 1
    v_mfma_f32_4x4x4_16b_bf16 v[88:91], v[12:13], v[84:85], 0
    s_nop 1
    v_mfma_f32_4x4x4_16b_bf16 v[88:91], v[10:11], v[86:87], v[88:91]
    s_nop 4
    v_cvt_pk_bf16_f32 v88, v88, v89
    v_cvt_pk_bf16_f32 v89, v90, v91
    ds_pk_add_bf16 v7, v88
    ds_pk_add_bf16 v7, v89 offset:4
    s_mov_b64 exec, vcc
    s_branch L2_d10
L2_xo11:
    v_cmp_lt_u32 vcc, 20, v99
    s_mov_b32 s43, 1
    s_cbranch_vccz L2_xp11
    v_cmp_lt_u32 vcc, 32, v99
    v_cmp_lt_u32 s[58:59], 31, v88
    s_mov_b32 s43, 2
    s_or_b64 vcc, vcc, s[58:59]
    s_cbranch_scc0 L2_xp11
    s_mov_b32 s37, 0x10000
    s_branch L2_xp11
L2_c12:
    s_mov_b64 exec, s[82:83]
    s_nop 1
    v_mfma_f32_4x4x4_16b_bf16 v[88:91], v[12:13], v[84:85], 0
    s_nop 1
    v_mfma_f32_4x4x4_16b_bf16 v[88:91], v[10:11], v[86:87], v[88:91]
    s_nop 4
    v_cvt_pk_bf16_f32 v88, v88, v89
    v_cvt_pk_bf16_f32 v89, v90, v91
    ds_pk_add_bf16 v7, v88
    ds_pk_add_bf16 v7, v89 offset:4
    s_mov_b64 exec, vcc
    s_branch L2_d12
L2_c13:
    s_mov_b64 exec, s[82:83]
    s_nop 1
    v_mfma_f32_4x4x4_16b_bf16 v[88:91], v[12:13], v[84:85], 0
    s_nop 1
    v_mfma_f32_4x4x4_16b_bf16 v[88:91], v[10:11], v[86:87], v[88:91]
    s_nop 4
    v_cvt_pk_bf16_f32 v88, v88, v89
    v_cvt_pk_bf16_f32 v89, v90, v91
    ds_pk_add_bf16 v7, v88
    ds_pk_add_bf16 v7, v89 offset:4
    s_mov_b64 exec, vcc
    s_branch L2_d13
L2_c14:
    s_mov_b64 exec, s[82:83]
    s_nop 1
    v_mfma_f32_4x4x4_16b_bf16 v[88:91], v[12:13], v[84:85], 0
    s_nop 1
    v_mfma_f32_4x4x4_16b_bf16 v[88:91], v[10:11], v[86:87], v[88:91]
    s_nop 4
    v_cvt_pk_bf16_f32 v88, v88, v89
    v_cvt_pk_bf16_f32 v89, v90, v91
    ds_pk_add_bf16 v7, v88
    ds_pk_add_bf16 v7, v89 offset:4
    s_mov_b64 exec, vcc
    s_branch L2_d14
L2_c15:
    s_mov_b64 exec, s[82:83]
    s_nop 1
    v_mfma_f32_4x4x4_16b_bf16 v[88:91], v[12:13], v[84:85], 0
    s_nop 1
    v_mfma_f32_4x4x4_16b_bf16 v[88:91], v[10:11], v[86:87], v[88:91]
    s_nop 4
    v_cvt_pk_bf16_f32 v88, v88, v89
    v_cvt_pk_bf16_f32 v89, v90, v91
    ds_pk_add_bf16 v7, v88
    ds_pk_add_bf16 v7, v89 offset:4
    s_mov_b64 exec, vcc
    s_branch L2_d15
L2_c16:
    s_mov_b64 exec, s[82:83]
    s_nop 1
    v_mfma_f32_4x4x4_16b_bf16 v[88:91], v[12:13], v[84:85], 0
    s_nop 1
    v_mfma_f32_4x4x4_16b_bf16 v[88:91], v[10:11], v[86:87], v[88:91]
    s_nop 4
    v_cvt_pk_bf16_f32 v88, v88, v89
    v_cvt_pk_bf16_f32 v89, v90, v91
    ds_pk_add_bf16 v7, v88
    ds_pk_add_bf16 v7, v89 offset:4
    s_mov_b64 exec, vcc
    s_branch L2_d16
L2_c17:
    s_mov_b64 exec, s[82:83]
    s_nop 1
    v_mfma_f32_4x4x4_16b_bf16 v[88:91], v[12:13], v[84:85], 0
    s_nop 1
    v_mfma_f32_4x4x4_16b_bf16 v[88:91], v[10:11], v[86:87], v[88:91]
    s_nop 4
    v_cvt_pk_bf16_f32 v88, v88, v89
    v_cvt_pk_bf16_f32 v89, v90, v91
    ds_pk_add_bf16 v7, v88
    ds_pk_add_bf16 v7, v89 offset:4
    s_mov_b64 exec, vcc
    s_branch L2_d17
L2_c18:
    s_mov_b64 exec, s[82:83]
    s_nop 1
    v_mfma_f32_4x4x4_16b_bf16 v[88:91], v[12:13], v[84:85], 0
    s_nop 1
    v_mfma_f32_4x4x4_16b_bf16 v[88:91], v[10:11], v[86:87], v[88:91]
    s_nop 4
    v_cvt_pk_bf16_f32 v88, v88, v89
    v_cvt_pk_bf16_f32 v89, v90, v91
    ds_pk_add_bf16 v7, v88
    ds_pk_add_bf16 v7, v89 offset:4
    s_mov_b64 exec, vcc
    s_branch L2_d18
L2_c19:
    s_mov_b64 exec, s[82:83]
    s_nop 1
    v_mfma_f32_4x4x4_16b_bf16 v[88:91], v[12:13], v[84:85], 0
    s_nop 1
    v_mfma_f32_4x4x4_16b_bf16 v[88:91], v[10:11], v[86:87], v[88:91]
    s_nop 4
    v_cvt_pk_bf16_f32 v88, v88, v89
    v_cvt_pk_bf16_f32 v89, v90, v91
    ds_pk_add_bf16 v7, v88
    ds_pk_add_bf16 v7, v89 offset:4
    s_mov_b64 exec, vcc
    s_branch L2_d19
L2_xa20:
    s_cmp_eq_u32 s43, 1
    s_cbranch_scc1 L2_xc20
    v_lshlrev_b32 v89, 0, v96
    v_add_u32 v90, 140, v97
    v_bitop3_b32 v90, v89, v45, v90 bitop3:0x6a
    ds_write_b32 v98, v90 offset:28
    v_lshlrev_b32 v89, 4, v96
    v_add_u32 v90, 120, v97
    v_bitop3_b32 v90, v89, v45, v90 bitop3:0x6a
    ds_write_b32 v98, v90 offset:24
    v_lshlrev_b32 v89, 8, v96
    v_add_u32 v90, 100, v97
    v_bitop3_b32 v90, v89, v45, v90 bitop3:0x6a
    ds_write_b32 v98, v90 offset:20
L2_xc20:
    v_lshlrev_b32 v89, 12, v96
    v_add_u32 v90, 80, v97
    v_bitop3_b32 v90, v89, v45, v90 bitop3:0x6a
    ds_write_b32 v98, v90 offset:16
    s_branch L2_xb20
L2_xe20:
    v_cmp_lt_u32 vcc, 32, v99
    v_cmp_lt_u32 s[58:59], 31, v88
    v_lshrrev_b32 v89, 16, v96
    v_add_u32 v97, 80, v97
    s_or_b64 vcc, vcc, s[58:59]
    s_cbranch_scc1 L2_xs20
    v_lshlrev_b32 v89, v1, v89
    v_and_b32 v89, v45, v89
    v_cmp_ne_u32 vcc, 0, v89
    v_xor_b32 v90, v97, v89
    s_add_u32 s3, s37, s38
    v_mbcnt_lo_u32_b32 v98, vcc_lo, 0
    v_mbcnt_hi_u32_b32 v98, vcc_hi, v98
    s_bcnt1_i32_b64 s41, vcc
    v_lshl_add_u32 v98, v98, 2, s3
    s_mov_b64 exec, vcc
    ds_write_b32 v98, v90
    s_mov_b64 exec, -1
    s_lshl2_add_u32 s37, s41, s37
    s_branch L2_xr20
L2_xf20:
    s_waitcnt lgkmcnt(0)
    s_cmp_gt_u32 s37, 1024
    s_cbranch_scc1 L2_xs20
    v_mov_b32 v43, -1
    s_cmp_ge_u32 s37, 512
    s_cbranch_scc1 L2_xg20
    v_mov_b32 v42, -1
    s_cmp_ge_u32 s37, 256
    s_cbranch_scc1 L2_xg20
    v_mov_b32 v41, -1
    s_branch L2_xg20
L2_xs20:
    s_waitcnt lgkmcnt(0)
    v_mov_b32 v40, -1
    v_mov_b32 v41, -1
    v_mov_b32 v42, -1
    v_mov_b32 v43, -1
    s_add_u32 s3, s42, 2
    s_bitset1_b32 s36, s3
    s_branch L2_xg20
L2_c21:
    s_mov_b64 exec, s[82:83]
    s_nop 1
    v_mfma_f32_4x4x4_16b_bf16 v[88:91], v[12:13], v[84:85], 0
    s_nop 1
    v_mfma_f32_4x4x4_16b_bf16 v[88:91], v[10:11], v[86:87], v[88:91]
    s_nop 4
    v_cvt_pk_bf16_f32 v88, v88, v89
    v_cvt_pk_bf16_f32 v89, v90, v91
    ds_pk_add_bf16 v7, v88
    ds_pk_add_bf16 v7, v89 offset:4
    s_mov_b64 exec, vcc
    s_branch L2_d21
L2_c22:
    s_mov_b64 exec, s[82:83]
    s_nop 1
    v_mfma_f32_4x4x4_16b_bf16 v[88:91], v[12:13], v[84:85], 0
    s_nop 1
    v_mfma_f32_4x4x4_16b_bf16 v[88:91], v[10:11], v[86:87], v[88:91]
    s_nop 4
    v_cvt_pk_bf16_f32 v88, v88, v89
    v_cvt_pk_bf16_f32 v89, v90, v91
    ds_pk_add_bf16 v7, v88
    ds_pk_add_bf16 v7, v89 offset:4
    s_mov_b64 exec, vcc
    s_branch L2_d22
L2_c23:
    s_mov_b64 exec, s[82:83]
    s_nop 1
    v_mfma_f32_4x4x4_16b_bf16 v[88:91], v[12:13], v[84:85], 0
    s_nop 1
    v_mfma_f32_4x4x4_16b_bf16 v[88:91], v[10:11], v[86:87], v[88:91]
    s_nop 4
    v_cvt_pk_bf16_f32 v88, v88, v89
    v_cvt_pk_bf16_f32 v89, v90, v91
    ds_pk_add_bf16 v7, v88
    ds_pk_add_bf16 v7, v89 offset:4
    s_mov_b64 exec, vcc
    s_branch L2_d23
L2_c24:
    s_mov_b64 exec, s[82:83]
    s_nop 1
    v_mfma_f32_4x4x4_16b_bf16 v[88:91], v[12:13], v[84:85], 0
    s_nop 1
    v_mfma_f32_4x4x4_16b_bf16 v[88:91], v[10:11], v[86:87], v[88:91]
    s_nop 4
    v_cvt_pk_bf16_f32 v88, v88, v89
    v_cvt_pk_bf16_f32 v89, v90, v91
    ds_pk_add_bf16 v7, v88
    ds_pk_add_bf16 v7, v89 offset:4
    s_mov_b64 exec, vcc
    s_branch L2_d24
L2_c25:
    s_mov_b64 exec, s[82:83]
    s_nop 1
    v_mfma_f32_4x4x4_16b_bf16 v[88:91], v[12:13], v[84:85], 0
    s_nop 1
    v_mfma_f32_4x4x4_16b_bf16 v[88:91], v[10:11], v[86:87], v[88:91]
    s_nop 4
    v_cvt_pk_bf16_f32 v88, v88, v89
    v_cvt_pk_bf16_f32 v89, v90, v91
    ds_pk_add_bf16 v7, v88
    ds_pk_add_bf16 v7, v89 offset:4
    s_mov_b64 exec, vcc
    s_branch L2_d25
L2_c26:
    s_mov_b64 exec, s[82:83]
    s_nop 1
    v_mfma_f32_4x4x4_16b_bf16 v[88:91], v[12:13], v[84:85], 0
    s_nop 1
    v_mfma_f32_4x4x4_16b_bf16 v[88:91], v[10:11], v[86:87], v[88:91]
    s_nop 4
    v_cvt_pk_bf16_f32 v88, v88, v89
    v_cvt_pk_bf16_f32 v89, v90, v91
    ds_pk_add_bf16 v7, v88
    ds_pk_add_bf16 v7, v89 offset:4
    s_mov_b64 exec, vcc
    s_branch L2_d26
L2_c27:
    s_mov_b64 exec, s[82:83]
    s_nop 1
    v_mfma_f32_4x4x4_16b_bf16 v[88:91], v[12:13], v[84:85], 0
    s_nop 1
    v_mfma_f32_4x4x4_16b_bf16 v[88:91], v[10:11], v[86:87], v[88:91]
    s_nop 4
    v_cvt_pk_bf16_f32 v88, v88, v89
    v_cvt_pk_bf16_f32 v89, v90, v91
    ds_pk_add_bf16 v7, v88
    ds_pk_add_bf16 v7, v89 offset:4
    s_mov_b64 exec, vcc
    s_branch L2_d27
L2_c28:
    s_mov_b64 exec, s[82:83]
    s_nop 1
    v_mfma_f32_4x4x4_16b_bf16 v[88:91], v[12:13], v[84:85], 0
    s_nop 1
    v_mfma_f32_4x4x4_16b_bf16 v[88:91], v[10:11], v[86:87], v[88:91]
    s_nop 4
    v_cvt_pk_bf16_f32 v88, v88, v89
    v_cvt_pk_bf16_f32 v89, v90, v91
    ds_pk_add_bf16 v7, v88
    ds_pk_add_bf16 v7, v89 offset:4
    s_mov_b64 exec, vcc
    s_branch L2_d28
L2_xo29:
    v_cmp_lt_u32 vcc, 20, v99
    s_mov_b32 s43, 1
    s_cbranch_vccz L2_xp29
    v_cmp_lt_u32 vcc, 32, v99
    v_cmp_lt_u32 s[58:59], 31, v88
    s_mov_b32 s43, 2
    s_or_b64 vcc, vcc, s[58:59]
    s_cbranch_scc0 L2_xp29
    s_mov_b32 s37, 0x10000
    s_branch L2_xp29
L2_c30:
    s_mov_b64 exec, s[82:83]
    s_nop 1
    v_mfma_f32_4x4x4_16b_bf16 v[88:91], v[12:13], v[84:85], 0
    s_nop 1
    v_mfma_f32_4x4x4_16b_bf16 v[88:91], v[10:11], v[86:87], v[88:91]
    s_nop 4
    v_cvt_pk_bf16_f32 v88, v88, v89
    v_cvt_pk_bf16_f32 v89, v90, v91
    ds_pk_add_bf16 v7, v88
    ds_pk_add_bf16 v7, v89 offset:4
    s_mov_b64 exec, vcc
    s_branch L2_d30
L2_c31:
    s_mov_b64 exec, s[82:83]
    s_nop 1
    v_mfma_f32_4x4x4_16b_bf16 v[88:91], v[12:13], v[84:85], 0
    s_nop 1
    v_mfma_f32_4x4x4_16b_bf16 v[88:91], v[10:11], v[86:87], v[88:91]
    s_nop 4
    v_cvt_pk_bf16_f32 v88, v88, v89
    v_cvt_pk_bf16_f32 v89, v90, v91
    ds_pk_add_bf16 v7, v88
    ds_pk_add_bf16 v7, v89 offset:4
    s_mov_b64 exec, vcc
    s_branch L2_d31
L2_c32:
    s_mov_b64 exec, s[82:83]
    s_nop 1
    v_mfma_f32_4x4x4_16b_bf16 v[88:91], v[12:13], v[84:85], 0
    s_nop 1
    v_mfma_f32_4x4x4_16b_bf16 v[88:91], v[10:11], v[86:87], v[88:91]
    s_nop 4
    v_cvt_pk_bf16_f32 v88, v88, v89
    v_cvt_pk_bf16_f32 v89, v90, v91
    ds_pk_add_bf16 v7, v88
    ds_pk_add_bf16 v7, v89 offset:4
    s_mov_b64 exec, vcc
    s_branch L2_d32
L2_c33:
    s_mov_b64 exec, s[82:83]
    s_nop 1
    v_mfma_f32_4x4x4_16b_bf16 v[88:91], v[12:13], v[84:85], 0
    s_nop 1
    v_mfma_f32_4x4x4_16b_bf16 v[88:91], v[10:11], v[86:87], v[88:91]
    s_nop 4
    v_cvt_pk_bf16_f32 v88, v88, v89
    v_cvt_pk_bf16_f32 v89, v90, v91
    ds_pk_add_bf16 v7, v88
    ds_pk_add_bf16 v7, v89 offset:4
    s_mov_b64 exec, vcc
    s_branch L2_d33
L2_c34:
    s_mov_b64 exec, s[82:83]
    s_nop 1
    v_mfma_f32_4x4x4_16b_bf16 v[88:91], v[12:13], v[84:85], 0
    s_nop 1
    v_mfma_f32_4x4x4_16b_bf16 v[88:91], v[10:11], v[86:87], v[88:91]
    s_nop 4
    v_cvt_pk_bf16_f32 v88, v88, v89
    v_cvt_pk_bf16_f32 v89, v90, v91
    ds_pk_add_bf16 v7, v88
    ds_pk_add_bf16 v7, v89 offset:4
    s_mov_b64 exec, vcc
    s_branch L2_d34
L2_c35:
    s_mov_b64 exec, s[82:83]
    s_nop 1
    v_mfma_f32_4x4x4_16b_bf16 v[88:91], v[12:13], v[84:85], 0
    s_nop 1
    v_mfma_f32_4x4x4_16b_bf16 v[88:91], v[10:11], v[86:87], v[88:91]
    s_nop 4
    v_cvt_pk_bf16_f32 v88, v88, v89
    v_cvt_pk_bf16_f32 v89, v90, v91
    ds_pk_add_bf16 v7, v88
    ds_pk_add_bf16 v7, v89 offset:4
    s_mov_b64 exec, vcc
    s_branch L2_d35
L2_c36:
    s_mov_b64 exec, s[82:83]
    s_nop 1
    v_mfma_f32_4x4x4_16b_bf16 v[88:91], v[12:13], v[84:85], 0
    s_nop 1
    v_mfma_f32_4x4x4_16b_bf16 v[88:91], v[10:11], v[86:87], v[88:91]
    s_nop 4
    v_cvt_pk_bf16_f32 v88, v88, v89
    v_cvt_pk_bf16_f32 v89, v90, v91
    ds_pk_add_bf16 v7, v88
    ds_pk_add_bf16 v7, v89 offset:4
    s_mov_b64 exec, vcc
    s_branch L2_d36
L2_c37:
    s_mov_b64 exec, s[82:83]
    s_nop 1
    v_mfma_f32_4x4x4_16b_bf16 v[88:91], v[12:13], v[84:85], 0
    s_nop 1
    v_mfma_f32_4x4x4_16b_bf16 v[88:91], v[10:11], v[86:87], v[88:91]
    s_nop 4
    v_cvt_pk_bf16_f32 v88, v88, v89
    v_cvt_pk_bf16_f32 v89, v90, v91
    ds_pk_add_bf16 v7, v88
    ds_pk_add_bf16 v7, v89 offset:4
    s_mov_b64 exec, vcc
    s_branch L2_d37
L2_xa38:
    s_cmp_eq_u32 s43, 1
    s_cbranch_scc1 L2_xc38
    v_lshlrev_b32 v89, 0, v96
    v_add_u32 v90, 140, v97
    v_bitop3_b32 v90, v89, v45, v90 bitop3:0x6a
    ds_write_b32 v98, v90 offset:28
    v_lshlrev_b32 v89, 4, v96
    v_add_u32 v90, 120, v97
    v_bitop3_b32 v90, v89, v45, v90 bitop3:0x6a
    ds_write_b32 v98, v90 offset:24
    v_lshlrev_b32 v89, 8, v96
    v_add_u32 v90, 100, v97
    v_bitop3_b32 v90, v89, v45, v90 bitop3:0x6a
    ds_write_b32 v98, v90 offset:20
L2_xc38:
    v_lshlrev_b32 v89, 12, v96
    v_add_u32 v90, 80, v97
    v_bitop3_b32 v90, v89, v45, v90 bitop3:0x6a
    ds_write_b32 v98, v90 offset:16
    s_branch L2_xb38
L2_xe38:
    v_cmp_lt_u32 vcc, 32, v99
    v_cmp_lt_u32 s[58:59], 31, v88
    v_lshrrev_b32 v89, 16, v96
    v_add_u32 v97, 80, v97
    s_or_b64 vcc, vcc, s[58:59]
    s_cbranch_scc1 L2_xs38
    v_lshlrev_b32 v89, v1, v89
    v_and_b32 v89, v45, v89
    v_cmp_ne_u32 vcc, 0, v89
    v_xor_b32 v90, v97, v89
    s_add_u32 s3, s37, s38
    v_mbcnt_lo_u32_b32 v98, vcc_lo, 0
    v_mbcnt_hi_u32_b32 v98, vcc_hi, v98
    s_bcnt1_i32_b64 s41, vcc
    v_lshl_add_u32 v98, v98, 2, s3
    s_mov_b64 exec, vcc
    ds_write_b32 v98, v90
    s_mov_b64 exec, -1
    s_lshl2_add_u32 s37, s41, s37
    s_branch L2_xr38
L2_xf38:
    s_waitcnt lgkmcnt(0)
    s_cmp_gt_u32 s37, 1024
    s_cbranch_scc1 L2_xs38
    v_mov_b32 v43, -1
    s_cmp_ge_u32 s37, 512
    s_cbranch_scc1 L2_xg38
    v_mov_b32 v42, -1
    s_cmp_ge_u32 s37, 256
    s_cbranch_scc1 L2_xg38
    v_mov_b32 v41, -1
    s_branch L2_xg38
L2_xs38:
    s_waitcnt lgkmcnt(0)
    v_mov_b32 v40, -1
    v_mov_b32 v41, -1
    v_mov_b32 v42, -1
    v_mov_b32 v43, -1
    s_add_u32 s3, s42, 2
    s_bitset1_b32 s36, s3
    s_branch L2_xg38
L2_c39:
    s_mov_b64 exec, s[82:83]
    s_nop 1
    v_mfma_f32_4x4x4_16b_bf16 v[88:91], v[12:13], v[84:85], 0
    s_nop 1
    v_mfma_f32_4x4x4_16b_bf16 v[88:91], v[10:11], v[86:87], v[88:91]
    s_nop 4
    v_cvt_pk_bf16_f32 v88, v88, v89
    v_cvt_pk_bf16_f32 v89, v90, v91
    ds_pk_add_bf16 v7, v88
    ds_pk_add_bf16 v7, v89 offset:4
    s_mov_b64 exec, vcc
    s_branch L2_d39
L2_c40:
    s_mov_b64 exec, s[82:83]
    s_nop 1
    v_mfma_f32_4x4x4_16b_bf16 v[88:91], v[12:13], v[84:85], 0
    s_nop 1
    v_mfma_f32_4x4x4_16b_bf16 v[88:91], v[10:11], v[86:87], v[88:91]
    s_nop 4
    v_cvt_pk_bf16_f32 v88, v88, v89
    v_cvt_pk_bf16_f32 v89, v90, v91
    ds_pk_add_bf16 v7, v88
    ds_pk_add_bf16 v7, v89 offset:4
    s_mov_b64 exec, vcc
    s_branch L2_d40
L2_c41:
    s_mov_b64 exec, s[82:83]
    s_nop 1
    v_mfma_f32_4x4x4_16b_bf16 v[88:91], v[12:13], v[84:85], 0
    s_nop 1
    v_mfma_f32_4x4x4_16b_bf16 v[88:91], v[10:11], v[86:87], v[88:91]
    s_nop 4
    v_cvt_pk_bf16_f32 v88, v88, v89
    v_cvt_pk_bf16_f32 v89, v90, v91
    ds_pk_add_bf16 v7, v88
    ds_pk_add_bf16 v7, v89 offset:4
    s_mov_b64 exec, vcc
    s_branch L2_d41
L2_c42:
    s_mov_b64 exec, s[82:83]
    s_nop 1
    v_mfma_f32_4x4x4_16b_bf16 v[88:91], v[12:13], v[84:85], 0
    s_nop 1
    v_mfma_f32_4x4x4_16b_bf16 v[88:91], v[10:11], v[86:87], v[88:91]
    s_nop 4
    v_cvt_pk_bf16_f32 v88, v88, v89
    v_cvt_pk_bf16_f32 v89, v90, v91
    ds_pk_add_bf16 v7, v88
    ds_pk_add_bf16 v7, v89 offset:4
    s_mov_b64 exec, vcc
    s_branch L2_d42
L2_c43:
    s_mov_b64 exec, s[82:83]
    s_nop 1
    v_mfma_f32_4x4x4_16b_bf16 v[88:91], v[12:13], v[84:85], 0
    s_nop 1
    v_mfma_f32_4x4x4_16b_bf16 v[88:91], v[10:11], v[86:87], v[88:91]
    s_nop 4
    v_cvt_pk_bf16_f32 v88, v88, v89
    v_cvt_pk_bf16_f32 v89, v90, v91
    ds_pk_add_bf16 v7, v88
    ds_pk_add_bf16 v7, v89 offset:4
    s_mov_b64 exec, vcc
    s_branch L2_d43
L2_c44:
    s_mov_b64 exec, s[82:83]
    s_nop 1
    v_mfma_f32_4x4x4_16b_bf16 v[88:91], v[12:13], v[84:85], 0
    s_nop 1
    v_mfma_f32_4x4x4_16b_bf16 v[88:91], v[10:11], v[86:87], v[88:91]
    s_nop 4
    v_cvt_pk_bf16_f32 v88, v88, v89
    v_cvt_pk_bf16_f32 v89, v90, v91
    ds_pk_add_bf16 v7, v88
    ds_pk_add_bf16 v7, v89 offset:4
    s_mov_b64 exec, vcc
    s_branch L2_d44
L2_c45:
    s_mov_b64 exec, s[82:83]
    s_nop 1
    v_mfma_f32_4x4x4_16b_bf16 v[88:91], v[12:13], v[84:85], 0
    s_nop 1
    v_mfma_f32_4x4x4_16b_bf16 v[88:91], v[10:11], v[86:87], v[88:91]
    s_nop 4
    v_cvt_pk_bf16_f32 v88, v88, v89
    v_cvt_pk_bf16_f32 v89, v90, v91
    ds_pk_add_bf16 v7, v88
    ds_pk_add_bf16 v7, v89 offset:4
    s_mov_b64 exec, vcc
    s_branch L2_d45
L2_c46:
    s_mov_b64 exec, s[82:83]
    s_nop 1
    v_mfma_f32_4x4x4_16b_bf16 v[88:91], v[12:13], v[84:85], 0
    s_nop 1
    v_mfma_f32_4x4x4_16b_bf16 v[88:91], v[10:11], v[86:87], v[88:91]
    s_nop 4
    v_cvt_pk_bf16_f32 v88, v88, v89
    v_cvt_pk_bf16_f32 v89, v90, v91
    ds_pk_add_bf16 v7, v88
    ds_pk_add_bf16 v7, v89 offset:4
    s_mov_b64 exec, vcc
    s_branch L2_d46
L2_xo47:
    v_cmp_lt_u32 vcc, 20, v99
    s_mov_b32 s43, 1
    s_cbranch_vccz L2_xp47
    v_cmp_lt_u32 vcc, 32, v99
    v_cmp_lt_u32 s[58:59], 31, v88
    s_mov_b32 s43, 2
    s_or_b64 vcc, vcc, s[58:59]
    s_cbranch_scc0 L2_xp47
    s_mov_b32 s37, 0x10000
    s_branch L2_xp47
L2_c48:
    s_mov_b64 exec, s[82:83]
    s_nop 1
    v_mfma_f32_4x4x4_16b_bf16 v[88:91], v[12:13], v[84:85], 0
    s_nop 1
    v_mfma_f32_4x4x4_16b_bf16 v[88:91], v[10:11], v[86:87], v[88:91]
    s_nop 4
    v_cvt_pk_bf16_f32 v88, v88, v89
    v_cvt_pk_bf16_f32 v89, v90, v91
    ds_pk_add_bf16 v7, v88
    ds_pk_add_bf16 v7, v89 offset:4
    s_mov_b64 exec, vcc
    s_branch L2_d48
L2_c49:
    s_mov_b64 exec, s[82:83]
    s_nop 1
    v_mfma_f32_4x4x4_16b_bf16 v[88:91], v[12:13], v[84:85], 0
    s_nop 1
    v_mfma_f32_4x4x4_16b_bf16 v[88:91], v[10:11], v[86:87], v[88:91]
    s_nop 4
    v_cvt_pk_bf16_f32 v88, v88, v89
    v_cvt_pk_bf16_f32 v89, v90, v91
    ds_pk_add_bf16 v7, v88
    ds_pk_add_bf16 v7, v89 offset:4
    s_mov_b64 exec, vcc
    s_branch L2_d49
L2_c50:
    s_mov_b64 exec, s[82:83]
    s_nop 1
    v_mfma_f32_4x4x4_16b_bf16 v[88:91], v[12:13], v[84:85], 0
    s_nop 1
    v_mfma_f32_4x4x4_16b_bf16 v[88:91], v[10:11], v[86:87], v[88:91]
    s_nop 4
    v_cvt_pk_bf16_f32 v88, v88, v89
    v_cvt_pk_bf16_f32 v89, v90, v91
    ds_pk_add_bf16 v7, v88
    ds_pk_add_bf16 v7, v89 offset:4
    s_mov_b64 exec, vcc
    s_branch L2_d50
L2_c51:
    s_mov_b64 exec, s[82:83]
    s_nop 1
    v_mfma_f32_4x4x4_16b_bf16 v[88:91], v[12:13], v[84:85], 0
    s_nop 1
    v_mfma_f32_4x4x4_16b_bf16 v[88:91], v[10:11], v[86:87], v[88:91]
    s_nop 4
    v_cvt_pk_bf16_f32 v88, v88, v89
    v_cvt_pk_bf16_f32 v89, v90, v91
    ds_pk_add_bf16 v7, v88
    ds_pk_add_bf16 v7, v89 offset:4
    s_mov_b64 exec, vcc
    s_branch L2_d51
L2_c52:
    s_mov_b64 exec, s[82:83]
    s_nop 1
    v_mfma_f32_4x4x4_16b_bf16 v[88:91], v[12:13], v[84:85], 0
    s_nop 1
    v_mfma_f32_4x4x4_16b_bf16 v[88:91], v[10:11], v[86:87], v[88:91]
    s_nop 4
    v_cvt_pk_bf16_f32 v88, v88, v89
    v_cvt_pk_bf16_f32 v89, v90, v91
    ds_pk_add_bf16 v7, v88
    ds_pk_add_bf16 v7, v89 offset:4
    s_mov_b64 exec, vcc
    s_branch L2_d52
L2_c53:
    s_mov_b64 exec, s[82:83]
    s_nop 1
    v_mfma_f32_4x4x4_16b_bf16 v[88:91], v[12:13], v[84:85], 0
    s_nop 1
    v_mfma_f32_4x4x4_16b_bf16 v[88:91], v[10:11], v[86:87], v[88:91]
    s_nop 4
    v_cvt_pk_bf16_f32 v88, v88, v89
    v_cvt_pk_bf16_f32 v89, v90, v91
    ds_pk_add_bf16 v7, v88
    ds_pk_add_bf16 v7, v89 offset:4
    s_mov_b64 exec, vcc
    s_branch L2_d53
L2_c54:
    s_mov_b64 exec, s[82:83]
    s_nop 1
    v_mfma_f32_4x4x4_16b_bf16 v[88:91], v[12:13], v[84:85], 0
    s_nop 1
    v_mfma_f32_4x4x4_16b_bf16 v[88:91], v[10:11], v[86:87], v[88:91]
    s_nop 4
    v_cvt_pk_bf16_f32 v88, v88, v89
    v_cvt_pk_bf16_f32 v89, v90, v91
    ds_pk_add_bf16 v7, v88
    ds_pk_add_bf16 v7, v89 offset:4
    s_mov_b64 exec, vcc
    s_branch L2_d54
L2_c55:
    s_mov_b64 exec, s[82:83]
    s_nop 1
    v_mfma_f32_4x4x4_16b_bf16 v[88:91], v[12:13], v[84:85], 0
    s_nop 1
    v_mfma_f32_4x4x4_16b_bf16 v[88:91], v[10:11], v[86:87], v[88:91]
    s_nop 4
    v_cvt_pk_bf16_f32 v88, v88, v89
    v_cvt_pk_bf16_f32 v89, v90, v91
    ds_pk_add_bf16 v7, v88
    ds_pk_add_bf16 v7, v89 offset:4
    s_mov_b64 exec, vcc
    s_branch L2_d55
L2_xa56:
    s_cmp_eq_u32 s43, 1
    s_cbranch_scc1 L2_xc56
    v_lshlrev_b32 v89, 0, v96
    v_add_u32 v90, 140, v97
    v_bitop3_b32 v90, v89, v45, v90 bitop3:0x6a
    ds_write_b32 v98, v90 offset:28
    v_lshlrev_b32 v89, 4, v96
    v_add_u32 v90, 120, v97
    v_bitop3_b32 v90, v89, v45, v90 bitop3:0x6a
    ds_write_b32 v98, v90 offset:24
    v_lshlrev_b32 v89, 8, v96
    v_add_u32 v90, 100, v97
    v_bitop3_b32 v90, v89, v45, v90 bitop3:0x6a
    ds_write_b32 v98, v90 offset:20
L2_xc56:
    v_lshlrev_b32 v89, 12, v96
    v_add_u32 v90, 80, v97
    v_bitop3_b32 v90, v89, v45, v90 bitop3:0x6a
    ds_write_b32 v98, v90 offset:16
    s_branch L2_xb56
L2_xe56:
    v_cmp_lt_u32 vcc, 32, v99
    v_cmp_lt_u32 s[58:59], 31, v88
    v_lshrrev_b32 v89, 16, v96
    v_add_u32 v97, 80, v97
    s_or_b64 vcc, vcc, s[58:59]
    s_cbranch_scc1 L2_xs56
    v_lshlrev_b32 v89, v1, v89
    v_and_b32 v89, v45, v89
    v_cmp_ne_u32 vcc, 0, v89
    v_xor_b32 v90, v97, v89
    s_add_u32 s3, s37, s38
    v_mbcnt_lo_u32_b32 v98, vcc_lo, 0
    v_mbcnt_hi_u32_b32 v98, vcc_hi, v98
    s_bcnt1_i32_b64 s41, vcc
    v_lshl_add_u32 v98, v98, 2, s3
    s_mov_b64 exec, vcc
    ds_write_b32 v98, v90
    s_mov_b64 exec, -1
    s_lshl2_add_u32 s37, s41, s37
    s_branch L2_xr56
L2_xf56:
    s_waitcnt lgkmcnt(0)
    s_cmp_gt_u32 s37, 1024
    s_cbranch_scc1 L2_xs56
    v_mov_b32 v43, -1
    s_cmp_ge_u32 s37, 512
    s_cbranch_scc1 L2_xg56
    v_mov_b32 v42, -1
    s_cmp_ge_u32 s37, 256
    s_cbranch_scc1 L2_xg56
    v_mov_b32 v41, -1
    s_branch L2_xg56
L2_xs56:
    s_waitcnt lgkmcnt(0)
    v_mov_b32 v40, -1
    v_mov_b32 v41, -1
    v_mov_b32 v42, -1
    v_mov_b32 v43, -1
    s_add_u32 s3, s42, 2
    s_bitset1_b32 s36, s3
    s_branch L2_xg56
L2_c57:
    s_mov_b64 exec, s[82:83]
    s_nop 1
    v_mfma_f32_4x4x4_16b_bf16 v[88:91], v[12:13], v[84:85], 0
    s_nop 1
    v_mfma_f32_4x4x4_16b_bf16 v[88:91], v[10:11], v[86:87], v[88:91]
    s_nop 4
    v_cvt_pk_bf16_f32 v88, v88, v89
    v_cvt_pk_bf16_f32 v89, v90, v91
    ds_pk_add_bf16 v7, v88
    ds_pk_add_bf16 v7, v89 offset:4
    s_mov_b64 exec, vcc
    s_branch L2_d57
L2_c58:
    s_mov_b64 exec, s[82:83]
    s_nop 1
    v_mfma_f32_4x4x4_16b_bf16 v[88:91], v[12:13], v[84:85], 0
    s_nop 1
    v_mfma_f32_4x4x4_16b_bf16 v[88:91], v[10:11], v[86:87], v[88:91]
    s_nop 4
    v_cvt_pk_bf16_f32 v88, v88, v89
    v_cvt_pk_bf16_f32 v89, v90, v91
    ds_pk_add_bf16 v7, v88
    ds_pk_add_bf16 v7, v89 offset:4
    s_mov_b64 exec, vcc
    s_branch L2_d58
L2_c59:
    s_mov_b64 exec, s[82:83]
    s_nop 1
    v_mfma_f32_4x4x4_16b_bf16 v[88:91], v[12:13], v[84:85], 0
    s_nop 1
    v_mfma_f32_4x4x4_16b_bf16 v[88:91], v[10:11], v[86:87], v[88:91]
    s_nop 4
    v_cvt_pk_bf16_f32 v88, v88, v89
    v_cvt_pk_bf16_f32 v89, v90, v91
    ds_pk_add_bf16 v7, v88
    ds_pk_add_bf16 v7, v89 offset:4
    s_mov_b64 exec, vcc
    s_branch L2_d59
L2_c60:
    s_mov_b64 exec, s[82:83]
    s_nop 1
    v_mfma_f32_4x4x4_16b_bf16 v[88:91], v[12:13], v[84:85], 0
    s_nop 1
    v_mfma_f32_4x4x4_16b_bf16 v[88:91], v[10:11], v[86:87], v[88:91]
    s_nop 4
    v_cvt_pk_bf16_f32 v88, v88, v89
    v_cvt_pk_bf16_f32 v89, v90, v91
    ds_pk_add_bf16 v7, v88
    ds_pk_add_bf16 v7, v89 offset:4
    s_mov_b64 exec, vcc
    s_branch L2_d60
L2_c61:
    s_mov_b64 exec, s[82:83]
    s_nop 1
    v_mfma_f32_4x4x4_16b_bf16 v[88:91], v[12:13], v[84:85], 0
    s_nop 1
    v_mfma_f32_4x4x4_16b_bf16 v[88:91], v[10:11], v[86:87], v[88:91]
    s_nop 4
    v_cvt_pk_bf16_f32 v88, v88, v89
    v_cvt_pk_bf16_f32 v89, v90, v91
    ds_pk_add_bf16 v7, v88
    ds_pk_add_bf16 v7, v89 offset:4
    s_mov_b64 exec, vcc
    s_branch L2_d61
L2_c62:
    s_mov_b64 exec, s[82:83]
    s_nop 1
    v_mfma_f32_4x4x4_16b_bf16 v[88:91], v[12:13], v[84:85], 0
    s_nop 1
    v_mfma_f32_4x4x4_16b_bf16 v[88:91], v[10:11], v[86:87], v[88:91]
    s_nop 4
    v_cvt_pk_bf16_f32 v88, v88, v89
    v_cvt_pk_bf16_f32 v89, v90, v91
    ds_pk_add_bf16 v7, v88
    ds_pk_add_bf16 v7, v89 offset:4
    s_mov_b64 exec, vcc
    s_branch L2_d62
L2_c63:
    s_mov_b64 exec, s[82:83]
    s_nop 1
    v_mfma_f32_4x4x4_16b_bf16 v[88:91], v[12:13], v[84:85], 0
    s_nop 1
    v_mfma_f32_4x4x4_16b_bf16 v[88:91], v[10:11], v[86:87], v[88:91]
    s_nop 4
    v_cvt_pk_bf16_f32 v88, v88, v89
    v_cvt_pk_bf16_f32 v89, v90, v91
    ds_pk_add_bf16 v7, v88
    ds_pk_add_bf16 v7, v89 offset:4
    s_mov_b64 exec, vcc
    s_branch L2_d63
L2_c64:
    s_mov_b64 exec, s[82:83]
    s_nop 1
    v_mfma_f32_4x4x4_16b_bf16 v[88:91], v[12:13], v[84:85], 0
    s_nop 1
    v_mfma_f32_4x4x4_16b_bf16 v[88:91], v[10:11], v[86:87], v[88:91]
    s_nop 4
    v_cvt_pk_bf16_f32 v88, v88, v89
    v_cvt_pk_bf16_f32 v89, v90, v91
    ds_pk_add_bf16 v7, v88
    ds_pk_add_bf16 v7, v89 offset:4
    s_mov_b64 exec, vcc
    s_branch L2_d64
L2_xo65:
    v_cmp_lt_u32 vcc, 20, v99
    s_mov_b32 s43, 1
    s_cbranch_vccz L2_xp65
    v_cmp_lt_u32 vcc, 32, v99
    v_cmp_lt_u32 s[58:59], 31, v88
    s_mov_b32 s43, 2
    s_or_b64 vcc, vcc, s[58:59]
    s_cbranch_scc0 L2_xp65
    s_mov_b32 s37, 0x10000
    s_branch L2_xp65
L2_c66:
    s_mov_b64 exec, s[82:83]
    s_nop 1
    v_mfma_f32_4x4x4_16b_bf16 v[88:91], v[12:13], v[84:85], 0
    s_nop 1
    v_mfma_f32_4x4x4_16b_bf16 v[88:91], v[10:11], v[86:87], v[88:91]
    s_nop 4
    v_cvt_pk_bf16_f32 v88, v88, v89
    v_cvt_pk_bf16_f32 v89, v90, v91
    ds_pk_add_bf16 v7, v88
    ds_pk_add_bf16 v7, v89 offset:4
    s_mov_b64 exec, vcc
    s_branch L2_d66
L2_c67:
    s_mov_b64 exec, s[82:83]
    s_nop 1
    v_mfma_f32_4x4x4_16b_bf16 v[88:91], v[12:13], v[84:85], 0
    s_nop 1
    v_mfma_f32_4x4x4_16b_bf16 v[88:91], v[10:11], v[86:87], v[88:91]
    s_nop 4
    v_cvt_pk_bf16_f32 v88, v88, v89
    v_cvt_pk_bf16_f32 v89, v90, v91
    ds_pk_add_bf16 v7, v88
    ds_pk_add_bf16 v7, v89 offset:4
    s_mov_b64 exec, vcc
    s_branch L2_d67
L2_c68:
    s_mov_b64 exec, s[82:83]
    s_nop 1
    v_mfma_f32_4x4x4_16b_bf16 v[88:91], v[12:13], v[84:85], 0
    s_nop 1
    v_mfma_f32_4x4x4_16b_bf16 v[88:91], v[10:11], v[86:87], v[88:91]
    s_nop 4
    v_cvt_pk_bf16_f32 v88, v88, v89
    v_cvt_pk_bf16_f32 v89, v90, v91
    ds_pk_add_bf16 v7, v88
    ds_pk_add_bf16 v7, v89 offset:4
    s_mov_b64 exec, vcc
    s_branch L2_d68
L2_c69:
    s_mov_b64 exec, s[82:83]
    s_nop 1
    v_mfma_f32_4x4x4_16b_bf16 v[88:91], v[12:13], v[84:85], 0
    s_nop 1
    v_mfma_f32_4x4x4_16b_bf16 v[88:91], v[10:11], v[86:87], v[88:91]
    s_nop 4
    v_cvt_pk_bf16_f32 v88, v88, v89
    v_cvt_pk_bf16_f32 v89, v90, v91
    ds_pk_add_bf16 v7, v88
    ds_pk_add_bf16 v7, v89 offset:4
    s_mov_b64 exec, vcc
    s_branch L2_d69
L2_c70:
    s_mov_b64 exec, s[82:83]
    s_nop 1
    v_mfma_f32_4x4x4_16b_bf16 v[88:91], v[12:13], v[84:85], 0
    s_nop 1
    v_mfma_f32_4x4x4_16b_bf16 v[88:91], v[10:11], v[86:87], v[88:91]
    s_nop 4
    v_cvt_pk_bf16_f32 v88, v88, v89
    v_cvt_pk_bf16_f32 v89, v90, v91
    ds_pk_add_bf16 v7, v88
    ds_pk_add_bf16 v7, v89 offset:4
    s_mov_b64 exec, vcc
    s_branch L2_d70
L2_c71:
    s_mov_b64 exec, s[82:83]
    s_nop 1
    v_mfma_f32_4x4x4_16b_bf16 v[88:91], v[12:13], v[84:85], 0
    s_nop 1
    v_mfma_f32_4x4x4_16b_bf16 v[88:91], v[10:11], v[86:87], v[88:91]
    s_nop 4
    v_cvt_pk_bf16_f32 v88, v88, v89
    v_cvt_pk_bf16_f32 v89, v90, v91
    ds_pk_add_bf16 v7, v88
    ds_pk_add_bf16 v7, v89 offset:4
    s_mov_b64 exec, vcc
    s_branch L2_d71
L2_c72:
    s_mov_b64 exec, s[82:83]
    s_nop 1
    v_mfma_f32_4x4x4_16b_bf16 v[88:91], v[12:13], v[84:85], 0
    s_nop 1
    v_mfma_f32_4x4x4_16b_bf16 v[88:91], v[10:11], v[86:87], v[88:91]
    s_nop 4
    v_cvt_pk_bf16_f32 v88, v88, v89
    v_cvt_pk_bf16_f32 v89, v90, v91
    ds_pk_add_bf16 v7, v88
    ds_pk_add_bf16 v7, v89 offset:4
    s_mov_b64 exec, vcc
    s_branch L2_d72
L2_c73:
    s_mov_b64 exec, s[82:83]
    s_nop 1
    v_mfma_f32_4x4x4_16b_bf16 v[88:91], v[12:13], v[84:85], 0
    s_nop 1
    v_mfma_f32_4x4x4_16b_bf16 v[88:91], v[10:11], v[86:87], v[88:91]
    s_nop 4
    v_cvt_pk_bf16_f32 v88, v88, v89
    v_cvt_pk_bf16_f32 v89, v90, v91
    ds_pk_add_bf16 v7, v88
    ds_pk_add_bf16 v7, v89 offset:4
    s_mov_b64 exec, vcc
    s_branch L2_d73
L2_xa74:
    s_cmp_eq_u32 s43, 1
    s_cbranch_scc1 L2_xc74
    v_lshlrev_b32 v89, 0, v96
    v_add_u32 v90, 140, v97
    v_bitop3_b32 v90, v89, v45, v90 bitop3:0x6a
    ds_write_b32 v98, v90 offset:28
    v_lshlrev_b32 v89, 4, v96
    v_add_u32 v90, 120, v97
    v_bitop3_b32 v90, v89, v45, v90 bitop3:0x6a
    ds_write_b32 v98, v90 offset:24
    v_lshlrev_b32 v89, 8, v96
    v_add_u32 v90, 100, v97
    v_bitop3_b32 v90, v89, v45, v90 bitop3:0x6a
    ds_write_b32 v98, v90 offset:20
L2_xc74:
    v_lshlrev_b32 v89, 12, v96
    v_add_u32 v90, 80, v97
    v_bitop3_b32 v90, v89, v45, v90 bitop3:0x6a
    ds_write_b32 v98, v90 offset:16
    s_branch L2_xb74
L2_xe74:
    v_cmp_lt_u32 vcc, 32, v99
    v_cmp_lt_u32 s[58:59], 31, v88
    v_lshrrev_b32 v89, 16, v96
    v_add_u32 v97, 80, v97
    s_or_b64 vcc, vcc, s[58:59]
    s_cbranch_scc1 L2_xs74
    v_lshlrev_b32 v89, v1, v89
    v_and_b32 v89, v45, v89
    v_cmp_ne_u32 vcc, 0, v89
    v_xor_b32 v90, v97, v89
    s_add_u32 s3, s37, s38
    v_mbcnt_lo_u32_b32 v98, vcc_lo, 0
    v_mbcnt_hi_u32_b32 v98, vcc_hi, v98
    s_bcnt1_i32_b64 s41, vcc
    v_lshl_add_u32 v98, v98, 2, s3
    s_mov_b64 exec, vcc
    ds_write_b32 v98, v90
    s_mov_b64 exec, -1
    s_lshl2_add_u32 s37, s41, s37
    s_branch L2_xr74
L2_xf74:
    s_waitcnt lgkmcnt(0)
    s_cmp_gt_u32 s37, 1024
    s_cbranch_scc1 L2_xs74
    v_mov_b32 v43, -1
    s_cmp_ge_u32 s37, 512
    s_cbranch_scc1 L2_xg74
    v_mov_b32 v42, -1
    s_cmp_ge_u32 s37, 256
    s_cbranch_scc1 L2_xg74
    v_mov_b32 v41, -1
    s_branch L2_xg74
L2_xs74:
    s_waitcnt lgkmcnt(0)
    v_mov_b32 v40, -1
    v_mov_b32 v41, -1
    v_mov_b32 v42, -1
    v_mov_b32 v43, -1
    s_add_u32 s3, s42, 2
    s_bitset1_b32 s36, s3
    s_branch L2_xg74
L2_c75:
    s_mov_b64 exec, s[82:83]
    s_nop 1
    v_mfma_f32_4x4x4_16b_bf16 v[88:91], v[12:13], v[84:85], 0
    s_nop 1
    v_mfma_f32_4x4x4_16b_bf16 v[88:91], v[10:11], v[86:87], v[88:91]
    s_nop 4
    v_cvt_pk_bf16_f32 v88, v88, v89
    v_cvt_pk_bf16_f32 v89, v90, v91
    ds_pk_add_bf16 v7, v88
    ds_pk_add_bf16 v7, v89 offset:4
    s_mov_b64 exec, vcc
    s_branch L2_d75
L2_c76:
    s_mov_b64 exec, s[82:83]
    s_nop 1
    v_mfma_f32_4x4x4_16b_bf16 v[88:91], v[12:13], v[84:85], 0
    s_nop 1
    v_mfma_f32_4x4x4_16b_bf16 v[88:91], v[10:11], v[86:87], v[88:91]
    s_nop 4
    v_cvt_pk_bf16_f32 v88, v88, v89
    v_cvt_pk_bf16_f32 v89, v90, v91
    ds_pk_add_bf16 v7, v88
    ds_pk_add_bf16 v7, v89 offset:4
    s_mov_b64 exec, vcc
    s_branch L2_d76
L2_c77:
    s_mov_b64 exec, s[82:83]
    s_nop 1
    v_mfma_f32_4x4x4_16b_bf16 v[88:91], v[12:13], v[84:85], 0
    s_nop 1
    v_mfma_f32_4x4x4_16b_bf16 v[88:91], v[10:11], v[86:87], v[88:91]
    s_nop 4
    v_cvt_pk_bf16_f32 v88, v88, v89
    v_cvt_pk_bf16_f32 v89, v90, v91
    ds_pk_add_bf16 v7, v88
    ds_pk_add_bf16 v7, v89 offset:4
    s_mov_b64 exec, vcc
    s_branch L2_d77
L2_c78:
    s_mov_b64 exec, s[82:83]
    s_nop 1
    v_mfma_f32_4x4x4_16b_bf16 v[88:91], v[12:13], v[84:85], 0
    s_nop 1
    v_mfma_f32_4x4x4_16b_bf16 v[88:91], v[10:11], v[86:87], v[88:91]
    s_nop 4
    v_cvt_pk_bf16_f32 v88, v88, v89
    v_cvt_pk_bf16_f32 v89, v90, v91
    ds_pk_add_bf16 v7, v88
    ds_pk_add_bf16 v7, v89 offset:4
    s_mov_b64 exec, vcc
    s_branch L2_d78
L2_c79:
    s_mov_b64 exec, s[82:83]
    s_nop 1
    v_mfma_f32_4x4x4_16b_bf16 v[88:91], v[12:13], v[84:85], 0
    s_nop 1
    v_mfma_f32_4x4x4_16b_bf16 v[88:91], v[10:11], v[86:87], v[88:91]
    s_nop 4
    v_cvt_pk_bf16_f32 v88, v88, v89
    v_cvt_pk_bf16_f32 v89, v90, v91
    ds_pk_add_bf16 v7, v88
    ds_pk_add_bf16 v7, v89 offset:4
    s_mov_b64 exec, vcc
    s_branch L2_d79
L2_c80:
    s_mov_b64 exec, s[82:83]
    s_nop 1
    v_mfma_f32_4x4x4_16b_bf16 v[88:91], v[12:13], v[84:85], 0
    s_nop 1
    v_mfma_f32_4x4x4_16b_bf16 v[88:91], v[10:11], v[86:87], v[88:91]
    s_nop 4
    v_cvt_pk_bf16_f32 v88, v88, v89
    v_cvt_pk_bf16_f32 v89, v90, v91
    ds_pk_add_bf16 v7, v88
    ds_pk_add_bf16 v7, v89 offset:4
    s_mov_b64 exec, vcc
    s_branch L2_d80
.text
.globl gs_final_kernel
.p2align 8
.type gs_final_kernel,@function
gs_final_kernel:
    s_cmp_ge_u32 s2, 1250
    s_cbranch_scc1 L3_end
    s_load_dwordx2 s[4:5], s[0:1], 0
    s_load_dwordx2 s[6:7], s[0:1], 24
    s_load_dwordx2 s[28:29], s[0:1], 40
    s_load_dwordx2 s[30:31], s[0:1], 88
    s_load_dwordx2 s[32:33], s[0:1], 104
    s_lshl_b32 s3, s2, 8
    v_add_u32 v1, s3, v0
    v_lshlrev_b32 v2, 4, v1
    v_lshlrev_b32 v3, 2, v1
    v_bfe_u32 v4, v1, 3, 6
    s_mov_b32 s3, 80000
    v_mul_lo_u32 v4, v4, s3
    v_lshrrev_b32 v5, 9, v1
    v_lshl_add_u32 v4, v5, 7, v4
    v_and_b32 v5, 7, v1
    v_lshl_add_u32 v4, v5, 4, v4
    v_and_b32 v5, 3, v0
    v_lshlrev_b32 v5, 6, v5
    s_waitcnt lgkmcnt(0)
    s_load_dwordx4 s[36:39], s[28:29], 0
    s_mov_b32 s8, s4
    s_mov_b32 s9, s5
    s_mov_b32 s10, 0x4e2000
    s_mov_b32 s11, 0x20000
    s_mov_b32 s12, s6
    s_mov_b32 s13, s7
    s_mov_b32 s14, 0x138800
    s_mov_b32 s15, 0x20000
    s_mov_b32 s16, s30
    s_mov_b32 s17, s31
    s_mov_b32 s18, 0x4e2000
    s_mov_b32 s19, 0x20000
    s_add_u32 s20, s32, 0xd823000
    s_addc_u32 s21, s33, 0
    s_mov_b32 s22, 0x1388000
    s_mov_b32 s23, 0x20000
    s_add_u32 s24, s32, 0xebab000
    s_addc_u32 s25, s33, 0
    s_mov_b32 s26, 0x100
    s_mov_b32 s27, 0x20000
    buffer_load_dword v6, v3, s[12:15], 0 offen
    buffer_load_dwordx4 v[8:11], v5, s[24:27], 0 offen
    buffer_load_dwordx4 v[12:15], v5, s[24:27], 0 offen offset:16
    buffer_load_dwordx2 v[16:17], v5, s[24:27], 0 offen offset:32
    s_mov_b32 s40, 0
    buffer_load_dwordx4 v[20:23], v4, s[20:23], s40 offen
    s_mov_b32 s41, 5120000
    buffer_load_dwordx4 v[24:27], v4, s[20:23], s41 offen
    s_mov_b32 s42, 10240000
    buffer_load_dwordx4 v[28:31], v4, s[20:23], s42 offen
    s_mov_b32 s43, 15360000
    buffer_load_dwordx4 v[32:35], v4, s[20:23], s43 offen
    buffer_load_dwordx4 v[36:39], v2, s[8:11], 0 offen
    v_and_b32 v7, 3, v0
    v_lshlrev_b32 v7, 4, v7
    v_mov_b32 v18, 0x3f80
    v_mov_b32 v19, 0
    v_lshlrev_b64 v[18:19], v7, v[18:19]
    s_waitcnt lgkmcnt(0)
    s_lshl_b32 s44, s36, 16
    s_and_b32 s45, s36, 0xffff0000
    s_lshl_b32 s46, s37, 16
    s_and_b32 s47, s37, 0xffff0000
    s_lshl_b32 s48, s38, 16
    s_and_b32 s49, s38, 0xffff0000
    s_lshl_b32 s50, s39, 16
    s_and_b32 s51, s39, 0xffff0000
    s_waitcnt vmcnt(8)
    v_lshlrev_b32 v7, 16, v6
    v_subrev_f32 v48, s44, v7
    v_subrev_f32 v49, s45, v7
    v_subrev_f32 v50, s46, v7
    v_subrev_f32 v51, s47, v7
    v_subrev_f32 v52, s48, v7
    v_subrev_f32 v53, s49, v7
    v_subrev_f32 v54, s50, v7
    v_subrev_f32 v55, s51, v7
    v_cvt_pk_bf16_f32 v56, v48, v49
    v_cvt_pk_bf16_f32 v57, v50, v51
    v_cvt_pk_bf16_f32 v58, v52, v53
    v_cvt_pk_bf16_f32 v59, v54, v55
    v_lshlrev_b32 v48, 16, v56
    v_and_b32 v49, 0xffff0000, v56
    v_lshlrev_b32 v50, 16, v57
    v_and_b32 v51, 0xffff0000, v57
    v_lshlrev_b32 v52, 16, v58
    v_and_b32 v53, 0xffff0000, v58
    v_lshlrev_b32 v54, 16, v59
    v_and_b32 v55, 0xffff0000, v59
    v_mul_f32 v48, v48, v48
    v_mul_f32 v49, v49, v49
    v_mul_f32 v50, v50, v50
    v_mul_f32 v51, v51, v51
    v_mul_f32 v52, v52, v52
    v_mul_f32 v53, v53, v53
    v_mul_f32 v54, v54, v54
    v_mul_f32 v55, v55, v55
    v_cvt_pk_bf16_f32 v56, v48, v49
    v_cvt_pk_bf16_f32 v57, v50, v51
    v_cvt_pk_bf16_f32 v58, v52, v53
    v_cvt_pk_bf16_f32 v59, v54, v55
    v_lshlrev_b32 v48, 16, v56
    v_and_b32 v49, 0xffff0000, v56
    v_lshlrev_b32 v50, 16, v57
    v_and_b32 v51, 0xffff0000, v57
    v_lshlrev_b32 v52, 16, v58
    v_and_b32 v53, 0xffff0000, v58
    v_lshlrev_b32 v54, 16, v59
    v_and_b32 v55, 0xffff0000, v59
    v_mul_f32 v48, 0xc1200000, v48
    v_mul_f32 v49, 0xc1200000, v49
    v_mul_f32 v50, 0xc1200000, v50
    v_mul_f32 v51, 0xc1200000, v51
    v_mul_f32 v52, 0xc1200000, v52
    v_mul_f32 v53, 0xc1200000, v53
    v_mul_f32 v54, 0xc1200000, v54
    v_mul_f32 v55, 0xc1200000, v55
    v_cvt_pk_bf16_f32 v56, v48, v49
    v_cvt_pk_bf16_f32 v57, v50, v51
    v_cvt_pk_bf16_f32 v58, v52, v53
    v_cvt_pk_bf16_f32 v59, v54, v55
    v_lshlrev_b32 v48, 16, v56
    v_and_b32 v49, 0xffff0000, v56
    v_lshlrev_b32 v50, 16, v57
    v_and_b32 v51, 0xffff0000, v57
    v_lshlrev_b32 v52, 16, v58
    v_and_b32 v53, 0xffff0000, v58
    v_lshlrev_b32 v54, 16, v59
    v_and_b32 v55, 0xffff0000, v59
    v_mul_f32 v48, 0x3fb8aa3b, v48
    v_mul_f32 v49, 0x3fb8aa3b, v49
    v_mul_f32 v50, 0x3fb8aa3b, v50
    v_mul_f32 v51, 0x3fb8aa3b, v51
    v_mul_f32 v52, 0x3fb8aa3b, v52
    v_mul_f32 v53, 0x3fb8aa3b, v53
    v_mul_f32 v54, 0x3fb8aa3b, v54
    v_mul_f32 v55, 0x3fb8aa3b, v55
    v_exp_f32 v48, v48
    v_exp_f32 v49, v49
    v_exp_f32 v50, v50
    v_exp_f32 v51, v51
    v_exp_f32 v52, v52
    v_exp_f32 v53, v53
    v_exp_f32 v54, v54
    v_exp_f32 v55, v55
    v_cvt_pk_bf16_f32 v40, v48, v49
    v_cvt_pk_bf16_f32 v41, v50, v51
    v_cvt_pk_bf16_f32 v42, v52, v53
    v_cvt_pk_bf16_f32 v43, v54, v55
    v_and_b32 v7, 0xffff0000, v6
    v_subrev_f32 v48, s44, v7
    v_subrev_f32 v49, s45, v7
    v_subrev_f32 v50, s46, v7
    v_subrev_f32 v51, s47, v7
    v_subrev_f32 v52, s48, v7
    v_subrev_f32 v53, s49, v7
    v_subrev_f32 v54, s50, v7
    v_subrev_f32 v55, s51, v7
    v_cvt_pk_bf16_f32 v56, v48, v49
    v_cvt_pk_bf16_f32 v57, v50, v51
    v_cvt_pk_bf16_f32 v58, v52, v53
    v_cvt_pk_bf16_f32 v59, v54, v55
    v_lshlrev_b32 v48, 16, v56
    v_and_b32 v49, 0xffff0000, v56
    v_lshlrev_b32 v50, 16, v57
    v_and_b32 v51, 0xffff0000, v57
    v_lshlrev_b32 v52, 16, v58
    v_and_b32 v53, 0xffff0000, v58
    v_lshlrev_b32 v54, 16, v59
    v_and_b32 v55, 0xffff0000, v59
    v_mul_f32 v48, v48, v48
    v_mul_f32 v49, v49, v49
    v_mul_f32 v50, v50, v50
    v_mul_f32 v51, v51, v51
    v_mul_f32 v52, v52, v52
    v_mul_f32 v53, v53, v53
    v_mul_f32 v54, v54, v54
    v_mul_f32 v55, v55, v55
    v_cvt_pk_bf16_f32 v56, v48, v49
    v_cvt_pk_bf16_f32 v57, v50, v51
    v_cvt_pk_bf16_f32 v58, v52, v53
    v_cvt_pk_bf16_f32 v59, v54, v55
    v_lshlrev_b32 v48, 16, v56
    v_and_b32 v49, 0xffff0000, v56
    v_lshlrev_b32 v50, 16, v57
    v_and_b32 v51, 0xffff0000, v57
    v_lshlrev_b32 v52, 16, v58
    v_and_b32 v53, 0xffff0000, v58
    v_lshlrev_b32 v54, 16, v59
    v_and_b32 v55, 0xffff0000, v59
    v_mul_f32 v48, 0xc1200000, v48
    v_mul_f32 v49, 0xc1200000, v49
    v_mul_f32 v50, 0xc1200000, v50
    v_mul_f32 v51, 0xc1200000, v51
    v_mul_f32 v52, 0xc1200000, v52
    v_mul_f32 v53, 0xc1200000, v53
    v_mul_f32 v54, 0xc1200000, v54
    v_mul_f32 v55, 0xc1200000, v55
    v_cvt_pk_bf16_f32 v56, v48, v49
    v_cvt_pk_bf16_f32 v57, v50, v51
    v_cvt_pk_bf16_f32 v58, v52, v53
    v_cvt_pk_bf16_f32 v59, v54, v55
    v_lshlrev_b32 v48, 16, v56
    v_and_b32 v49, 0xffff0000, v56
    v_lshlrev_b32 v50, 16, v57
    v_and_b32 v51, 0xffff0000, v57
    v_lshlrev_b32 v52, 16, v58
    v_and_b32 v53, 0xffff0000, v58
    v_lshlrev_b32 v54, 16, v59
    v_and_b32 v55, 0xffff0000, v59
    v_mul_f32 v48, 0x3fb8aa3b, v48
    v_mul_f32 v49, 0x3fb8aa3b, v49
    v_mul_f32 v50, 0x3fb8aa3b, v50
    v_mul_f32 v51, 0x3fb8aa3b, v51
    v_mul_f32 v52, 0x3fb8aa3b, v52
    v_mul_f32 v53, 0x3fb8aa3b, v53
    v_mul_f32 v54, 0x3fb8aa3b, v54
    v_mul_f32 v55, 0x3fb8aa3b, v55
    v_exp_f32 v48, v48
    v_exp_f32 v49, v49
    v_exp_f32 v50, v50
    v_exp_f32 v51, v51
    v_exp_f32 v52, v52
    v_exp_f32 v53, v53
    v_exp_f32 v54, v54
    v_exp_f32 v55, v55
    v_cvt_pk_bf16_f32 v44, v48, v49
    v_cvt_pk_bf16_f32 v45, v50, v51
    v_cvt_pk_bf16_f32 v46, v52, v53
    v_cvt_pk_bf16_f32 v47, v54, v55
    s_waitcnt vmcnt(5)
    v_mfma_f32_4x4x4_16b_bf16 v[48:51], v[8:9], v[40:41], 0
    v_mfma_f32_4x4x4_16b_bf16 v[56:59], v[12:13], v[40:41], 0
    v_mfma_f32_4x4x4_16b_bf16 v[52:55], v[8:9], v[44:45], 0
    v_mfma_f32_4x4x4_16b_bf16 v[60:63], v[12:13], v[44:45], 0
    v_mfma_f32_4x4x4_16b_bf16 v[48:51], v[10:11], v[42:43], v[48:51]
    v_mfma_f32_4x4x4_16b_bf16 v[56:59], v[14:15], v[42:43], v[56:59]
    v_mfma_f32_4x4x4_16b_bf16 v[52:55], v[10:11], v[46:47], v[52:55]
    v_mfma_f32_4x4x4_16b_bf16 v[60:63], v[14:15], v[46:47], v[60:63]
    s_waitcnt vmcnt(1)
    v_mfma_f32_4x4x4_16b_bf16 v[64:67], v[18:19], v[20:21], 0
    v_mfma_f32_4x4x4_16b_bf16 v[68:71], v[18:19], v[22:23], 0
    s_nop 0
    v_mfma_f32_4x4x4_16b_bf16 v[64:67], v[18:19], v[24:25], v[64:67]
    v_mfma_f32_4x4x4_16b_bf16 v[68:71], v[18:19], v[26:27], v[68:71]
    s_nop 0
    v_mfma_f32_4x4x4_16b_bf16 v[64:67], v[18:19], v[28:29], v[64:67]
    v_mfma_f32_4x4x4_16b_bf16 v[68:71], v[18:19], v[30:31], v[68:71]
    s_nop 0
    v_mfma_f32_4x4x4_16b_bf16 v[64:67], v[18:19], v[32:33], v[64:67]
    v_mfma_f32_4x4x4_16b_bf16 v[68:71], v[18:19], v[34:35], v[68:71]
    s_nop 3
    v_mul_f32 v64, v64, v48
    v_mul_f32 v65, v65, v49
    v_mul_f32 v66, v66, v50
    v_mul_f32 v67, v67, v51
    v_cvt_pk_bf16_f32 v20, v64, v65
    v_cvt_pk_bf16_f32 v21, v66, v67
    v_mul_f32 v68, v68, v52
    v_mul_f32 v69, v69, v53
    v_mul_f32 v70, v70, v54
    v_mul_f32 v71, v71, v55
    v_cvt_pk_bf16_f32 v22, v68, v69
    v_cvt_pk_bf16_f32 v23, v70, v71
    v_mfma_f32_4x4x4_16b_bf16 v[48:51], v[16:17], v[20:21], 0
    s_nop 0
    v_mfma_f32_4x4x4_16b_bf16 v[52:55], v[16:17], v[22:23], 0
    s_nop 2
    v_mul_f32 v48, v48, v56
    v_mul_f32 v49, v49, v57
    v_mul_f32 v50, v50, v58
    v_mul_f32 v51, v51, v59
    v_mul_f32 v52, v52, v60
    v_mul_f32 v53, v53, v61
    v_mul_f32 v54, v54, v62
    v_mul_f32 v55, v55, v63
    s_waitcnt vmcnt(0)
    v_mfma_f32_4x4x4_16b_bf16 v[64:67], v[18:19], v[36:37], v[48:51]
    v_mfma_f32_4x4x4_16b_bf16 v[68:71], v[18:19], v[38:39], v[52:55]
    s_nop 3
    v_cvt_pk_bf16_f32 v24, v64, v65
    v_cvt_pk_bf16_f32 v25, v66, v67
    v_cvt_pk_bf16_f32 v26, v68, v69
    v_cvt_pk_bf16_f32 v27, v70, v71
    buffer_store_dwordx4 v[24:27], v2, s[16:19], 0 offen
L3_end:
    s_endpgm
.section .rodata,"a"
.p2align 6
.amdhsa_kernel gs_sort_kernel
  .amdhsa_next_free_vgpr 128
  .amdhsa_next_free_sgpr 96
  .amdhsa_accum_offset 128
  .amdhsa_group_segment_fixed_size 0
  .amdhsa_kernarg_size 112
  .amdhsa_user_sgpr_count 2
  .amdhsa_user_sgpr_kernarg_segment_ptr 1
  .amdhsa_system_sgpr_workgroup_id_x 1
  .amdhsa_float_denorm_mode_32 3
.end_amdhsa_kernel
.p2align 6
.amdhsa_kernel gs_acc_kernel
  .amdhsa_next_free_vgpr 128
  .amdhsa_next_free_sgpr 96
  .amdhsa_accum_offset 128
  .amdhsa_group_segment_fixed_size 0
  .amdhsa_kernarg_size 112
  .amdhsa_user_sgpr_count 2
  .amdhsa_user_sgpr_kernarg_segment_ptr 1
  .amdhsa_system_sgpr_workgroup_id_x 1
  .amdhsa_float_denorm_mode_32 3
.end_amdhsa_kernel
.p2align 6
.amdhsa_kernel gs_final_kernel
  .amdhsa_next_free_vgpr 72
  .amdhsa_next_free_sgpr 64
  .amdhsa_accum_offset 72
  .amdhsa_group_segment_fixed_size 0
  .amdhsa_kernarg_size 112
  .amdhsa_user_sgpr_count 2
  .amdhsa_user_sgpr_kernarg_segment_ptr 1
  .amdhsa_system_sgpr_workgroup_id_x 1
  .amdhsa_float_denorm_mode_32 3
.end_amdhsa_kernel
```

```asm
; @launch kernel=gs_sort_kernel grid=(256,1,1) block=(1024,1,1) lds=163840
; @launch kernel=gs_acc_kernel grid=(256,1,1) block=(1024,1,1) lds=163840
; @launch kernel=gs_final_kernel grid=(1250,1,1) block=(256,1,1) lds=0
.amdgcn_target "amdgcn-amd-amdhsa--gfx950"
.text
.globl gs_sort_kernel
.p2align 8
.type gs_sort_kernel,@function
gs_sort_kernel:
    s_cmp_ge_u32 s2, 256
    s_cbranch_scc1 L1_end
    s_load_dwordx4 s[4:7], s[0:1], 8
    s_load_dwordx2 s[28:29], s[0:1], 32
    s_load_dwordx2 s[30:31], s[0:1], 104
    s_load_dwordx2 s[56:57], s[0:1], 96
    s_load_dwordx2 s[86:87], s[0:1], 0
    s_load_dwordx4 s[60:63], s[0:1], 56
    s_load_dwordx4 s[64:67], s[0:1], 72
    v_lshrrev_b32 v7, 6, v0
    v_lshlrev_b32 v1, 3, v0
    v_readfirstlane_b32 s32, v7
    v_lshlrev_b32 v0, 4, v0
    s_mul_i32 s33, s2, 16384
    s_mul_i32 s34, s2, 8192
    s_waitcnt lgkmcnt(0)
    s_mov_b32 s8, s4
    s_mov_b32 s9, s5
    s_mov_b32 s10, 0x9c40000
    s_mov_b32 s11, 0x20000
    s_mov_b32 s12, s6
    s_mov_b32 s13, s7
    s_mov_b32 s14, 0x9c40000
    s_mov_b32 s15, 0x20000
    s_mov_b32 s16, s28
    s_mov_b32 s17, s29
    s_mov_b32 s18, 0x4e20000
    s_mov_b32 s19, 0x20000
    s_add_u32 s44, s33, 0x0
    buffer_load_dwordx4 v[16:19], v0, s[8:11], s44 offen nt
    s_add_u32 s45, s33, 0x0
    buffer_load_dwordx4 v[20:23], v0, s[12:15], s45 offen nt
    s_add_u32 s46, s34, 0x0
    buffer_load_dwordx2 v[24:25], v1, s[16:19], s46 offen nt
    s_add_u32 s47, s34, 0x200000
    buffer_load_dwordx2 v[26:27], v1, s[16:19], s47 offen nt
    s_add_u32 s44, s33, 0x400000
    buffer_load_dwordx4 v[28:31], v0, s[8:11], s44 offen nt
    s_add_u32 s45, s33, 0x400000
    buffer_load_dwordx4 v[32:35], v0, s[12:15], s45 offen nt
    s_add_u32 s46, s33, 0x800000
    buffer_load_dwordx4 v[36:39], v0, s[8:11], s46 offen nt
    s_add_u32 s47, s33, 0x800000
    buffer_load_dwordx4 v[40:43], v0, s[12:15], s47 offen nt
    s_add_u32 s44, s34, 0x400000
    buffer_load_dwordx2 v[44:45], v1, s[16:19], s44 offen nt
    s_add_u32 s45, s34, 0x600000
    buffer_load_dwordx2 v[46:47], v1, s[16:19], s45 offen nt
    s_mov_b32 s68, s62
    s_mov_b32 s69, s63
    s_mov_b32 s70, 0x40
    s_mov_b32 s71, 0x20000
    s_mov_b32 s72, s60
    s_mov_b32 s73, s61
    s_mov_b32 s74, 0x40
    s_mov_b32 s75, 0x20000
    s_mov_b32 s20, s66
    s_mov_b32 s21, s67
    s_mov_b32 s22, 0x20
    s_mov_b32 s23, 0x20000
    s_mov_b32 s80, s64
    s_mov_b32 s81, s65
    s_mov_b32 s82, 0x20
    s_mov_b32 s83, 0x20000
    s_add_u32 s24, s30, 0xebab000
    s_addc_u32 s25, s31, 0
    s_mov_b32 s26, 0x100
    s_mov_b32 s27, 0x20000
    v_lshrrev_b32 v2, 3, v0
    v_and_b32 v2, 6, v2
    v_lshlrev_b32 v3, 2, v0
    s_lshl_b32 s3, s32, 8
    s_add_u32 s3, s3, s2
    s_cmp_lg_u32 s3, 254
    s_cbranch_scc1 L1_wt
    buffer_load_ushort v96, v2, s[68:71], 0 offen offset:0
    buffer_load_ushort v108, v2, s[68:71], 0 offen offset:8
    buffer_load_ushort v97, v2, s[68:71], 0 offen offset:16
    buffer_load_ushort v109, v2, s[68:71], 0 offen offset:24
    buffer_load_ushort v98, v2, s[68:71], 0 offen offset:32
    buffer_load_ushort v110, v2, s[68:71], 0 offen offset:40
    buffer_load_ushort v99, v2, s[68:71], 0 offen offset:48
    buffer_load_ushort v111, v2, s[68:71], 0 offen offset:56
    buffer_load_ushort v100, v2, s[72:75], 0 offen offset:0
    buffer_load_ushort v112, v2, s[72:75], 0 offen offset:8
    buffer_load_ushort v101, v2, s[72:75], 0 offen offset:16
    buffer_load_ushort v113, v2, s[72:75], 0 offen offset:24
    buffer_load_ushort v102, v2, s[72:75], 0 offen offset:32
    buffer_load_ushort v114, v2, s[72:75], 0 offen offset:40
    buffer_load_ushort v103, v2, s[72:75], 0 offen offset:48
    buffer_load_ushort v115, v2, s[72:75], 0 offen offset:56
    buffer_load_ushort v104, v2, s[20:23], 0 offen offset:0
    buffer_load_ushort v116, v2, s[20:23], 0 offen offset:8
    buffer_load_ushort v105, v2, s[20:23], 0 offen offset:16
    buffer_load_ushort v117, v2, s[20:23], 0 offen offset:24
    buffer_load_ushort v106, v2, s[80:83], 0 offen offset:0
    buffer_load_ushort v118, v2, s[80:83], 0 offen offset:8
    buffer_load_ushort v107, v2, s[80:83], 0 offen offset:16
    buffer_load_ushort v119, v2, s[80:83], 0 offen offset:24
    s_waitcnt vmcnt(0)
    v_lshl_or_b32 v96, v108, 16, v96
    v_lshl_or_b32 v97, v109, 16, v97
    v_lshl_or_b32 v98, v110, 16, v98
    v_lshl_or_b32 v99, v111, 16, v99
    v_lshl_or_b32 v100, v112, 16, v100
    v_lshl_or_b32 v101, v113, 16, v101
    v_lshl_or_b32 v102, v114, 16, v102
    v_lshl_or_b32 v103, v115, 16, v103
    v_lshl_or_b32 v104, v116, 16, v104
    v_lshl_or_b32 v105, v117, 16, v105
    v_lshl_or_b32 v106, v118, 16, v106
    v_lshl_or_b32 v107, v119, 16, v107
    buffer_store_dwordx4 v[96:99], v3, s[24:27], 0 offen offset:0
    buffer_store_dwordx4 v[100:103], v3, s[24:27], 0 offen offset:16
    buffer_store_dwordx4 v[104:107], v3, s[24:27], 0 offen offset:32
L1_wt:
    s_mov_b32 s20, s30
    s_mov_b32 s21, s31
    s_mov_b32 s22, 0xd340000
    s_mov_b32 s23, 0x20000
    s_add_u32 s24, s30, 0x28000
    s_addc_u32 s25, s31, 0
    s_mov_b32 s26, 0xd318000
    s_mov_b32 s27, 0x20000
    s_mov_b32 s80, s86
    s_mov_b32 s81, s87
    s_mov_b32 s82, 0x4e20
    s_mov_b32 s83, 0x20000
    s_mul_i32 s3, s2, 20000
    s_add_u32 s80, s80, s3
    s_addc_u32 s81, s81, 0
    s_mul_i32 s35, s2, 173056
    s_and_b32 s37, s32, 3
    s_lshl_b32 s37, s37, 3
    s_add_u32 s36, s35, s37
    s_lshr_b32 s37, s32, 2
    s_mul_i32 s37, s37, 2080
    s_add_u32 s36, s36, s37
    s_mul_i32 s4, s2, 5
    s_add_u32 s4, s4, 8192
    s_lshl_b32 s38, s4, 14
    s_lshl_b32 s39, s4, 13
    v_mov_b32 v2, 1
    v_mov_b32 v4, 0x80000007
    v_mov_b32 v5, 0xfc
    v_mov_b32 v6, 0x78
    s_mov_b32 s40, 2048
    s_mov_b32 s55, -10000
    s_mov_b32 s41, 0x010c0c01
    s_mov_b32 s42, 0x030c0c03
    v_mov_b32 v8, 0
    v_mov_b32 v9, 0
    v_mov_b32 v10, 0
    v_mov_b32 v11, 0
    ds_write_b128 v0, v[8:11]
    s_waitcnt lgkmcnt(0)
    s_barrier
    s_add_u32 s46, s33, 0xc00000
    buffer_load_dwordx4 v[48:51], v0, s[8:11], s46 offen nt
    s_add_u32 s47, s33, 0xc00000
    buffer_load_dwordx4 v[52:55], v0, s[12:15], s47 offen nt
    s_waitcnt vmcnt(8)
    v_lshlrev_b32 v7, 16, v24
    v_and_b32 v8, 0xffff0000, v24
    v_lshlrev_b32 v9, 16, v25
    v_and_b32 v10, 0xffff0000, v25
    v_mul_f32 v7, 0.15915494, v7
    v_mul_f32 v8, 0.15915494, v8
    v_mul_f32 v9, 0.15915494, v9
    v_mul_f32 v10, 0.15915494, v10
    v_mul_hi_u32_u24 v14, 429497, v16
    v_lshrrev_b32 v12, 3, v20
    v_cos_f32 v7, v7
    v_lshlrev_b16 v13, 3, v20
    v_mad_i32_i24 v11, v14, s55, v16
    v_bitop3_b32 v12, v6, v13, v12 bitop3:0xca
    v_add_lshl_u32 v11, v11, s40, 17
    v_lshlrev_b16 v14, 8, v14
    v_lshrrev_b32 v13, 2, v20
    v_or_b32 v16, v12, v11
    v_bitop3_b32 v20, v5, v13, v14 bitop3:0xea
    ds_add_u32 v20, v2
    v_mul_hi_u32_u24 v14, 429497, v17
    v_lshrrev_b32 v12, 3, v21
    v_cos_f32 v8, v8
    v_lshlrev_b16 v13, 3, v21
    v_mad_i32_i24 v11, v14, s55, v17
    v_bitop3_b32 v12, v6, v13, v12 bitop3:0xca
    v_add_lshl_u32 v11, v11, s40, 17
    v_lshlrev_b16 v14, 8, v14
    v_lshrrev_b32 v13, 2, v21
    v_or_b32 v17, v12, v11
    v_bitop3_b32 v21, v5, v13, v14 bitop3:0xea
    ds_add_u32 v21, v2
    v_cvt_pk_bf16_f32 v24, v7, v8
    v_perm_b32 v12, v24, v24, s41
    v_bitop3_b32 v16, v4, v12, v16 bitop3:0xca
    v_perm_b32 v13, v24, v24, s42
    v_bitop3_b32 v17, v4, v13, v17 bitop3:0xca
    v_mul_hi_u32_u24 v14, 429497, v18
    v_lshrrev_b32 v12, 3, v22
    v_cos_f32 v9, v9
    v_lshlrev_b16 v13, 3, v22
    v_mad_i32_i24 v11, v14, s55, v18
    v_bitop3_b32 v12, v6, v13, v12 bitop3:0xca
    v_add_lshl_u32 v11, v11, s40, 17
    v_lshlrev_b16 v14, 8, v14
    v_lshrrev_b32 v13, 2, v22
    v_or_b32 v18, v12, v11
    v_bitop3_b32 v22, v5, v13, v14 bitop3:0xea
    ds_add_u32 v22, v2
    v_mul_hi_u32_u24 v14, 429497, v19
    v_lshrrev_b32 v12, 3, v23
    v_cos_f32 v10, v10
    v_lshlrev_b16 v13, 3, v23
    v_mad_i32_i24 v11, v14, s55, v19
    v_bitop3_b32 v12, v6, v13, v12 bitop3:0xca
    v_add_lshl_u32 v11, v11, s40, 17
    v_lshlrev_b16 v14, 8, v14
    v_lshrrev_b32 v13, 2, v23
    v_or_b32 v19, v12, v11
    v_bitop3_b32 v23, v5, v13, v14 bitop3:0xea
    ds_add_u32 v23, v2
    v_cvt_pk_bf16_f32 v25, v9, v10
    v_perm_b32 v12, v25, v25, s41
    v_bitop3_b32 v18, v4, v12, v18 bitop3:0xca
    v_perm_b32 v13, v25, v25, s42
    v_bitop3_b32 v19, v4, v13, v19 bitop3:0xca
    s_add_u32 s44, s33, 0x1000000
    buffer_load_dwordx4 v[56:59], v0, s[8:11], s44 offen nt
    s_add_u32 s45, s33, 0x1000000
    buffer_load_dwordx4 v[60:63], v0, s[12:15], s45 offen nt
    s_add_u32 s46, s34, 0x800000
    buffer_load_dwordx2 v[64:65], v1, s[16:19], s46 offen nt
    s_add_u32 s47, s34, 0xa00000
    buffer_load_dwordx2 v[66:67], v1, s[16:19], s47 offen nt
    s_waitcnt vmcnt(10)
    v_lshlrev_b32 v7, 16, v26
    v_and_b32 v8, 0xffff0000, v26
    v_lshlrev_b32 v9, 16, v27
    v_and_b32 v10, 0xffff0000, v27
    v_mul_f32 v7, 0.15915494, v7
    v_mul_f32 v8, 0.15915494, v8
    v_mul_f32 v9, 0.15915494, v9
    v_mul_f32 v10, 0.15915494, v10
    v_mul_hi_u32_u24 v14, 429497, v28
    v_lshrrev_b32 v12, 3, v32
    v_cos_f32 v7, v7
    v_lshlrev_b16 v13, 3, v32
    v_mad_i32_i24 v11, v14, s55, v28
    v_bitop3_b32 v12, v6, v13, v12 bitop3:0xca
    v_add_lshl_u32 v11, v11, s40, 17
    v_lshlrev_b16 v14, 8, v14
    v_lshrrev_b32 v13, 2, v32
    v_or_b32 v28, v12, v11
    v_bitop3_b32 v32, v5, v13, v14 bitop3:0xea
    ds_add_u32 v32, v2
    v_mul_hi_u32_u24 v14, 429497, v29
    v_lshrrev_b32 v12, 3, v33
    v_cos_f32 v8, v8
    v_lshlrev_b16 v13, 3, v33
    v_mad_i32_i24 v11, v14, s55, v29
    v_bitop3_b32 v12, v6, v13, v12 bitop3:0xca
    v_add_lshl_u32 v11, v11, s40, 17
    v_lshlrev_b16 v14, 8, v14
    v_lshrrev_b32 v13, 2, v33
    v_or_b32 v29, v12, v11
    v_bitop3_b32 v33, v5, v13, v14 bitop3:0xea
    ds_add_u32 v33, v2
    v_cvt_pk_bf16_f32 v26, v7, v8
    v_perm_b32 v12, v26, v26, s41
    v_bitop3_b32 v28, v4, v12, v28 bitop3:0xca
    v_perm_b32 v13, v26, v26, s42
    v_bitop3_b32 v29, v4, v13, v29 bitop3:0xca
    v_mul_hi_u32_u24 v14, 429497, v30
    v_lshrrev_b32 v12, 3, v34
    v_cos_f32 v9, v9
    v_lshlrev_b16 v13, 3, v34
    v_mad_i32_i24 v11, v14, s55, v30
    v_bitop3_b32 v12, v6, v13, v12 bitop3:0xca
    v_add_lshl_u32 v11, v11, s40, 17
    v_lshlrev_b16 v14, 8, v14
    v_lshrrev_b32 v13, 2, v34
    v_or_b32 v30, v12, v11
    v_bitop3_b32 v34, v5, v13, v14 bitop3:0xea
    ds_add_u32 v34, v2
    v_mul_hi_u32_u24 v14, 429497, v31
    v_lshrrev_b32 v12, 3, v35
    v_cos_f32 v10, v10
    v_lshlrev_b16 v13, 3, v35
    v_mad_i32_i24 v11, v14, s55, v31
    v_bitop3_b32 v12, v6, v13, v12 bitop3:0xca
    v_add_lshl_u32 v11, v11, s40, 17
    v_lshlrev_b16 v14, 8, v14
    v_lshrrev_b32 v13, 2, v35
    v_or_b32 v31, v12, v11
    v_bitop3_b32 v35, v5, v13, v14 bitop3:0xea
    ds_add_u32 v35, v2
    v_cvt_pk_bf16_f32 v27, v9, v10
    v_perm_b32 v12, v27, v27, s41
    v_bitop3_b32 v30, v4, v12, v30 bitop3:0xca
    v_perm_b32 v13, v27, v27, s42
    v_bitop3_b32 v31, v4, v13, v31 bitop3:0xca
    s_add_u32 s44, s33, 0x1400000
    buffer_load_dwordx4 v[68:71], v0, s[8:11], s44 offen nt
    s_add_u32 s45, s33, 0x1400000
    buffer_load_dwordx4 v[72:75], v0, s[12:15], s45 offen nt
    s_waitcnt vmcnt(8)
    v_lshlrev_b32 v7, 16, v44
    v_and_b32 v8, 0xffff0000, v44
    v_lshlrev_b32 v9, 16, v45
    v_and_b32 v10, 0xffff0000, v45
    v_mul_f32 v7, 0.15915494, v7
    v_mul_f32 v8, 0.15915494, v8
    v_mul_f32 v9, 0.15915494, v9
    v_mul_f32 v10, 0.15915494, v10
    v_mul_hi_u32_u24 v14, 429497, v36
    v_lshrrev_b32 v12, 3, v40
    v_cos_f32 v7, v7
    v_lshlrev_b16 v13, 3, v40
    v_mad_i32_i24 v11, v14, s55, v36
    v_bitop3_b32 v12, v6, v13, v12 bitop3:0xca
    v_add_lshl_u32 v11, v11, s40, 17
    v_lshlrev_b16 v14, 8, v14
    v_lshrrev_b32 v13, 2, v40
    v_or_b32 v36, v12, v11
    v_bitop3_b32 v40, v5, v13, v14 bitop3:0xea
    ds_add_u32 v40, v2
    v_mul_hi_u32_u24 v14, 429497, v37
    v_lshrrev_b32 v12, 3, v41
    v_cos_f32 v8, v8
    v_lshlrev_b16 v13, 3, v41
    v_mad_i32_i24 v11, v14, s55, v37
    v_bitop3_b32 v12, v6, v13, v12 bitop3:0xca
    v_add_lshl_u32 v11, v11, s40, 17
    v_lshlrev_b16 v14, 8, v14
    v_lshrrev_b32 v13, 2, v41
    v_or_b32 v37, v12, v11
    v_bitop3_b32 v41, v5, v13, v14 bitop3:0xea
    ds_add_u32 v41, v2
    v_cvt_pk_bf16_f32 v44, v7, v8
    v_perm_b32 v12, v44, v44, s41
    v_bitop3_b32 v36, v4, v12, v36 bitop3:0xca
    v_perm_b32 v13, v44, v44, s42
    v_bitop3_b32 v37, v4, v13, v37 bitop3:0xca
    v_mul_hi_u32_u24 v14, 429497, v38
    v_lshrrev_b32 v12, 3, v42
    v_cos_f32 v9, v9
    v_lshlrev_b16 v13, 3, v42
    v_mad_i32_i24 v11, v14, s55, v38
    v_bitop3_b32 v12, v6, v13, v12 bitop3:0xca
    v_add_lshl_u32 v11, v11, s40, 17
    v_lshlrev_b16 v14, 8, v14
    v_lshrrev_b32 v13, 2, v42
    v_or_b32 v38, v12, v11
    v_bitop3_b32 v42, v5, v13, v14 bitop3:0xea
    ds_add_u32 v42, v2
    v_mul_hi_u32_u24 v14, 429497, v39
    v_lshrrev_b32 v12, 3, v43
    v_cos_f32 v10, v10
    v_lshlrev_b16 v13, 3, v43
    v_mad_i32_i24 v11, v14, s55, v39
    v_bitop3_b32 v12, v6, v13, v12 bitop3:0xca
    v_add_lshl_u32 v11, v11, s40, 17
    v_lshlrev_b16 v14, 8, v14
    v_lshrrev_b32 v13, 2, v43
    v_or_b32 v39, v12, v11
    v_bitop3_b32 v43, v5, v13, v14 bitop3:0xea
    ds_add_u32 v43, v2
    v_cvt_pk_bf16_f32 v45, v9, v10
    v_perm_b32 v12, v45, v45, s41
    v_bitop3_b32 v38, v4, v12, v38 bitop3:0xca
    v_perm_b32 v13, v45, v45, s42
    v_bitop3_b32 v39, v4, v13, v39 bitop3:0xca
    s_add_u32 s46, s33, 0x1800000
    buffer_load_dwordx4 v[76:79], v0, s[8:11], s46 offen nt
    s_add_u32 s47, s33, 0x1800000
    buffer_load_dwordx4 v[80:83], v0, s[12:15], s47 offen nt
    s_add_u32 s44, s34, 0xc00000
    buffer_load_dwordx2 v[84:85], v1, s[16:19], s44 offen nt
    s_add_u32 s45, s34, 0xe00000
    buffer_load_dwordx2 v[86:87], v1, s[16:19], s45 offen nt
    s_waitcnt vmcnt(10)
    v_lshlrev_b32 v7, 16, v46
    v_and_b32 v8, 0xffff0000, v46
    v_lshlrev_b32 v9, 16, v47
    v_and_b32 v10, 0xffff0000, v47
    v_mul_f32 v7, 0.15915494, v7
    v_mul_f32 v8, 0.15915494, v8
    v_mul_f32 v9, 0.15915494, v9
    v_mul_f32 v10, 0.15915494, v10
    v_mul_hi_u32_u24 v14, 429497, v48
    v_lshrrev_b32 v12, 3, v52
    v_cos_f32 v7, v7
    v_lshlrev_b16 v13, 3, v52
    v_mad_i32_i24 v11, v14, s55, v48
    v_bitop3_b32 v12, v6, v13, v12 bitop3:0xca
    v_add_lshl_u32 v11, v11, s40, 17
    v_lshlrev_b16 v14, 8, v14
    v_lshrrev_b32 v13, 2, v52
    v_or_b32 v48, v12, v11
    v_bitop3_b32 v52, v5, v13, v14 bitop3:0xea
    ds_add_u32 v52, v2
    v_mul_hi_u32_u24 v14, 429497, v49
    v_lshrrev_b32 v12, 3, v53
    v_cos_f32 v8, v8
    v_lshlrev_b16 v13, 3, v53
    v_mad_i32_i24 v11, v14, s55, v49
    v_bitop3_b32 v12, v6, v13, v12 bitop3:0xca
    v_add_lshl_u32 v11, v11, s40, 17
    v_lshlrev_b16 v14, 8, v14
    v_lshrrev_b32 v13, 2, v53
    v_or_b32 v49, v12, v11
    v_bitop3_b32 v53, v5, v13, v14 bitop3:0xea
    ds_add_u32 v53, v2
    v_cvt_pk_bf16_f32 v46, v7, v8
    v_perm_b32 v12, v46, v46, s41
    v_bitop3_b32 v48, v4, v12, v48 bitop3:0xca
    v_perm_b32 v13, v46, v46, s42
    v_bitop3_b32 v49, v4, v13, v49 bitop3:0xca
    v_mul_hi_u32_u24 v14, 429497, v50
    v_lshrrev_b32 v12, 3, v54
    v_cos_f32 v9, v9
    v_lshlrev_b16 v13, 3, v54
    v_mad_i32_i24 v11, v14, s55, v50
    v_bitop3_b32 v12, v6, v13, v12 bitop3:0xca
    v_add_lshl_u32 v11, v11, s40, 17
    v_lshlrev_b16 v14, 8, v14
    v_lshrrev_b32 v13, 2, v54
    v_or_b32 v50, v12, v11
    v_bitop3_b32 v54, v5, v13, v14 bitop3:0xea
    ds_add_u32 v54, v2
    v_mul_hi_u32_u24 v14, 429497, v51
    v_lshrrev_b32 v12, 3, v55
    v_cos_f32 v10, v10
    v_lshlrev_b16 v13, 3, v55
    v_mad_i32_i24 v11, v14, s55, v51
    v_bitop3_b32 v12, v6, v13, v12 bitop3:0xca
    v_add_lshl_u32 v11, v11, s40, 17
    v_lshlrev_b16 v14, 8, v14
    v_lshrrev_b32 v13, 2, v55
    v_or_b32 v51, v12, v11
    v_bitop3_b32 v55, v5, v13, v14 bitop3:0xea
    ds_add_u32 v55, v2
    v_cvt_pk_bf16_f32 v47, v9, v10
    v_perm_b32 v12, v47, v47, s41
    v_bitop3_b32 v50, v4, v12, v50 bitop3:0xca
    v_perm_b32 v13, v47, v47, s42
    v_bitop3_b32 v51, v4, v13, v51 bitop3:0xca
    s_add_u32 s46, s33, 0x1c00000
    buffer_load_dwordx4 v[88:91], v0, s[8:11], s46 offen nt
    s_add_u32 s47, s33, 0x1c00000
    buffer_load_dwordx4 v[92:95], v0, s[12:15], s47 offen nt
    s_waitcnt vmcnt(8)
    v_lshlrev_b32 v7, 16, v64
    v_and_b32 v8, 0xffff0000, v64
    v_lshlrev_b32 v9, 16, v65
    v_and_b32 v10, 0xffff0000, v65
    v_mul_f32 v7, 0.15915494, v7
    v_mul_f32 v8, 0.15915494, v8
    v_mul_f32 v9, 0.15915494, v9
    v_mul_f32 v10, 0.15915494, v10
    v_mul_hi_u32_u24 v14, 429497, v56
    v_lshrrev_b32 v12, 3, v60
    v_cos_f32 v7, v7
    v_lshlrev_b16 v13, 3, v60
    v_mad_i32_i24 v11, v14, s55, v56
    v_bitop3_b32 v12, v6, v13, v12 bitop3:0xca
    v_add_lshl_u32 v11, v11, s40, 17
    v_lshlrev_b16 v14, 8, v14
    v_lshrrev_b32 v13, 2, v60
    v_or_b32 v56, v12, v11
    v_bitop3_b32 v60, v5, v13, v14 bitop3:0xea
    ds_add_u32 v60, v2
    v_mul_hi_u32_u24 v14, 429497, v57
    v_lshrrev_b32 v12, 3, v61
    v_cos_f32 v8, v8
    v_lshlrev_b16 v13, 3, v61
    v_mad_i32_i24 v11, v14, s55, v57
    v_bitop3_b32 v12, v6, v13, v12 bitop3:0xca
    v_add_lshl_u32 v11, v11, s40, 17
    v_lshlrev_b16 v14, 8, v14
    v_lshrrev_b32 v13, 2, v61
    v_or_b32 v57, v12, v11
    v_bitop3_b32 v61, v5, v13, v14 bitop3:0xea
    ds_add_u32 v61, v2
    v_cvt_pk_bf16_f32 v64, v7, v8
    v_perm_b32 v12, v64, v64, s41
    v_bitop3_b32 v56, v4, v12, v56 bitop3:0xca
    v_perm_b32 v13, v64, v64, s42
    v_bitop3_b32 v57, v4, v13, v57 bitop3:0xca
    v_mul_hi_u32_u24 v14, 429497, v58
    v_lshrrev_b32 v12, 3, v62
    v_cos_f32 v9, v9
    v_lshlrev_b16 v13, 3, v62
    v_mad_i32_i24 v11, v14, s55, v58
    v_bitop3_b32 v12, v6, v13, v12 bitop3:0xca
    v_add_lshl_u32 v11, v11, s40, 17
    v_lshlrev_b16 v14, 8, v14
    v_lshrrev_b32 v13, 2, v62
    v_or_b32 v58, v12, v11
    v_bitop3_b32 v62, v5, v13, v14 bitop3:0xea
    ds_add_u32 v62, v2
    v_mul_hi_u32_u24 v14, 429497, v59
    v_lshrrev_b32 v12, 3, v63
    v_cos_f32 v10, v10
    v_lshlrev_b16 v13, 3, v63
    v_mad_i32_i24 v11, v14, s55, v59
    v_bitop3_b32 v12, v6, v13, v12 bitop3:0xca
    v_add_lshl_u32 v11, v11, s40, 17
    v_lshlrev_b16 v14, 8, v14
    v_lshrrev_b32 v13, 2, v63
    v_or_b32 v59, v12, v11
    v_bitop3_b32 v63, v5, v13, v14 bitop3:0xea
    ds_add_u32 v63, v2
    v_cvt_pk_bf16_f32 v65, v9, v10
    v_perm_b32 v12, v65, v65, s41
    v_bitop3_b32 v58, v4, v12, v58 bitop3:0xca
    v_perm_b32 v13, v65, v65, s42
    v_bitop3_b32 v59, v4, v13, v59 bitop3:0xca
    s_add_u32 s44, s33, 0x2000000
    buffer_load_dwordx4 v[96:99], v0, s[8:11], s44 offen nt
    s_add_u32 s45, s33, 0x2000000
    buffer_load_dwordx4 v[100:103], v0, s[12:15], s45 offen nt
    s_add_u32 s46, s34, 0x1000000
    buffer_load_dwordx2 v[104:105], v1, s[16:19], s46 offen nt
    s_add_u32 s47, s34, 0x1200000
    buffer_load_dwordx2 v[106:107], v1, s[16:19], s47 offen nt
    s_waitcnt vmcnt(10)
    v_lshlrev_b32 v7, 16, v66
    v_and_b32 v8, 0xffff0000, v66
    v_lshlrev_b32 v9, 16, v67
    v_and_b32 v10, 0xffff0000, v67
    v_mul_f32 v7, 0.15915494, v7
    v_mul_f32 v8, 0.15915494, v8
    v_mul_f32 v9, 0.15915494, v9
    v_mul_f32 v10, 0.15915494, v10
    v_mul_hi_u32_u24 v14, 429497, v68
    v_lshrrev_b32 v12, 3, v72
    v_cos_f32 v7, v7
    v_lshlrev_b16 v13, 3, v72
    v_mad_i32_i24 v11, v14, s55, v68
    v_bitop3_b32 v12, v6, v13, v12 bitop3:0xca
    v_add_lshl_u32 v11, v11, s40, 17
    v_lshlrev_b16 v14, 8, v14
    v_lshrrev_b32 v13, 2, v72
    v_or_b32 v68, v12, v11
    v_bitop3_b32 v72, v5, v13, v14 bitop3:0xea
    ds_add_u32 v72, v2
    v_mul_hi_u32_u24 v14, 429497, v69
    v_lshrrev_b32 v12, 3, v73
    v_cos_f32 v8, v8
    v_lshlrev_b16 v13, 3, v73
    v_mad_i32_i24 v11, v14, s55, v69
    v_bitop3_b32 v12, v6, v13, v12 bitop3:0xca
    v_add_lshl_u32 v11, v11, s40, 17
    v_lshlrev_b16 v14, 8, v14
    v_lshrrev_b32 v13, 2, v73
    v_or_b32 v69, v12, v11
    v_bitop3_b32 v73, v5, v13, v14 bitop3:0xea
    ds_add_u32 v73, v2
    v_cvt_pk_bf16_f32 v66, v7, v8
    v_perm_b32 v12, v66, v66, s41
    v_bitop3_b32 v68, v4, v12, v68 bitop3:0xca
    v_perm_b32 v13, v66, v66, s42
    v_bitop3_b32 v69, v4, v13, v69 bitop3:0xca
    v_mul_hi_u32_u24 v14, 429497, v70
    v_lshrrev_b32 v12, 3, v74
    v_cos_f32 v9, v9
    v_lshlrev_b16 v13, 3, v74
    v_mad_i32_i24 v11, v14, s55, v70
    v_bitop3_b32 v12, v6, v13, v12 bitop3:0xca
    v_add_lshl_u32 v11, v11, s40, 17
    v_lshlrev_b16 v14, 8, v14
    v_lshrrev_b32 v13, 2, v74
    v_or_b32 v70, v12, v11
    v_bitop3_b32 v74, v5, v13, v14 bitop3:0xea
    ds_add_u32 v74, v2
    v_mul_hi_u32_u24 v14, 429497, v71
    v_lshrrev_b32 v12, 3, v75
    v_cos_f32 v10, v10
    v_lshlrev_b16 v13, 3, v75
    v_mad_i32_i24 v11, v14, s55, v71
    v_bitop3_b32 v12, v6, v13, v12 bitop3:0xca
    v_add_lshl_u32 v11, v11, s40, 17
    v_lshlrev_b16 v14, 8, v14
    v_lshrrev_b32 v13, 2, v75
    v_or_b32 v71, v12, v11
    v_bitop3_b32 v75, v5, v13, v14 bitop3:0xea
    ds_add_u32 v75, v2
    v_cvt_pk_bf16_f32 v67, v9, v10
    v_perm_b32 v12, v67, v67, s41
    v_bitop3_b32 v70, v4, v12, v70 bitop3:0xca
    v_perm_b32 v13, v67, v67, s42
    v_bitop3_b32 v71, v4, v13, v71 bitop3:0xca
    s_add_u32 s44, s33, 0x2400000
    buffer_load_dwordx4 v[108:111], v0, s[8:11], s44 offen nt
    s_waitcnt vmcnt(7)
    v_lshlrev_b32 v7, 16, v84
    v_and_b32 v8, 0xffff0000, v84
    v_lshlrev_b32 v9, 16, v85
    v_and_b32 v10, 0xffff0000, v85
    v_mul_f32 v7, 0.15915494, v7
    v_mul_f32 v8, 0.15915494, v8
    v_mul_f32 v9, 0.15915494, v9
    v_mul_f32 v10, 0.15915494, v10
    v_mul_hi_u32_u24 v14, 429497, v76
    v_lshrrev_b32 v12, 3, v80
    v_cos_f32 v7, v7
    v_lshlrev_b16 v13, 3, v80
    v_mad_i32_i24 v11, v14, s55, v76
    v_bitop3_b32 v12, v6, v13, v12 bitop3:0xca
    v_add_lshl_u32 v11, v11, s40, 17
    v_lshlrev_b16 v14, 8, v14
    v_lshrrev_b32 v13, 2, v80
    v_or_b32 v76, v12, v11
    v_bitop3_b32 v80, v5, v13, v14 bitop3:0xea
    ds_add_u32 v80, v2
    v_mul_hi_u32_u24 v14, 429497, v77
    v_lshrrev_b32 v12, 3, v81
    v_cos_f32 v8, v8
    v_lshlrev_b16 v13, 3, v81
    v_mad_i32_i24 v11, v14, s55, v77
    v_bitop3_b32 v12, v6, v13, v12 bitop3:0xca
    v_add_lshl_u32 v11, v11, s40, 17
    v_lshlrev_b16 v14, 8, v14
    v_lshrrev_b32 v13, 2, v81
    v_or_b32 v77, v12, v11
    v_bitop3_b32 v81, v5, v13, v14 bitop3:0xea
    ds_add_u32 v81, v2
    v_cvt_pk_bf16_f32 v84, v7, v8
    v_perm_b32 v12, v84, v84, s41
    v_bitop3_b32 v76, v4, v12, v76 bitop3:0xca
    v_perm_b32 v13, v84, v84, s42
    v_bitop3_b32 v77, v4, v13, v77 bitop3:0xca
    v_mul_hi_u32_u24 v14, 429497, v78
    v_lshrrev_b32 v12, 3, v82
    v_cos_f32 v9, v9
    v_lshlrev_b16 v13, 3, v82
    v_mad_i32_i24 v11, v14, s55, v78
    v_bitop3_b32 v12, v6, v13, v12 bitop3:0xca
    v_add_lshl_u32 v11, v11, s40, 17
    v_lshlrev_b16 v14, 8, v14
    v_lshrrev_b32 v13, 2, v82
    v_or_b32 v78, v12, v11
    v_bitop3_b32 v82, v5, v13, v14 bitop3:0xea
    ds_add_u32 v82, v2
    v_mul_hi_u32_u24 v14, 429497, v79
    v_lshrrev_b32 v12, 3, v83
    v_cos_f32 v10, v10
    v_lshlrev_b16 v13, 3, v83
    v_mad_i32_i24 v11, v14, s55, v79
    v_bitop3_b32 v12, v6, v13, v12 bitop3:0xca
    v_add_lshl_u32 v11, v11, s40, 17
    v_lshlrev_b16 v14, 8, v14
    v_lshrrev_b32 v13, 2, v83
    v_or_b32 v79, v12, v11
    v_bitop3_b32 v83, v5, v13, v14 bitop3:0xea
    ds_add_u32 v83, v2
    v_cvt_pk_bf16_f32 v85, v9, v10
    v_perm_b32 v12, v85, v85, s41
    v_bitop3_b32 v78, v4, v12, v78 bitop3:0xca
    v_perm_b32 v13, v85, v85, s42
    v_bitop3_b32 v79, v4, v13, v79 bitop3:0xca
    s_waitcnt vmcnt(5)
    v_lshlrev_b32 v7, 16, v86
    v_and_b32 v8, 0xffff0000, v86
    v_lshlrev_b32 v9, 16, v87
    v_and_b32 v10, 0xffff0000, v87
    v_mul_f32 v7, 0.15915494, v7
    v_mul_f32 v8, 0.15915494, v8
    v_mul_f32 v9, 0.15915494, v9
    v_mul_f32 v10, 0.15915494, v10
    v_mul_hi_u32_u24 v14, 429497, v88
    v_lshrrev_b32 v12, 3, v92
    v_cos_f32 v7, v7
    v_lshlrev_b16 v13, 3, v92
    v_mad_i32_i24 v11, v14, s55, v88
    v_bitop3_b32 v12, v6, v13, v12 bitop3:0xca
    v_add_lshl_u32 v11, v11, s40, 17
    v_lshlrev_b16 v14, 8, v14
    v_lshrrev_b32 v13, 2, v92
    v_or_b32 v88, v12, v11
    v_bitop3_b32 v92, v5, v13, v14 bitop3:0xea
    ds_add_u32 v92, v2
    v_mul_hi_u32_u24 v14, 429497, v89
    v_lshrrev_b32 v12, 3, v93
    v_cos_f32 v8, v8
    v_lshlrev_b16 v13, 3, v93
    v_mad_i32_i24 v11, v14, s55, v89
    v_bitop3_b32 v12, v6, v13, v12 bitop3:0xca
    v_add_lshl_u32 v11, v11, s40, 17
    v_lshlrev_b16 v14, 8, v14
    v_lshrrev_b32 v13, 2, v93
    v_or_b32 v89, v12, v11
    v_bitop3_b32 v93, v5, v13, v14 bitop3:0xea
    ds_add_u32 v93, v2
    v_cvt_pk_bf16_f32 v86, v7, v8
    v_perm_b32 v12, v86, v86, s41
    v_bitop3_b32 v88, v4, v12, v88 bitop3:0xca
    v_perm_b32 v13, v86, v86, s42
    v_bitop3_b32 v89, v4, v13, v89 bitop3:0xca
    v_mul_hi_u32_u24 v14, 429497, v90
    v_lshrrev_b32 v12, 3, v94
    v_cos_f32 v9, v9
    v_lshlrev_b16 v13, 3, v94
    v_mad_i32_i24 v11, v14, s55, v90
    v_bitop3_b32 v12, v6, v13, v12 bitop3:0xca
    v_add_lshl_u32 v11, v11, s40, 17
    v_lshlrev_b16 v14, 8, v14
    v_lshrrev_b32 v13, 2, v94
    v_or_b32 v90, v12, v11
    v_bitop3_b32 v94, v5, v13, v14 bitop3:0xea
    ds_add_u32 v94, v2
    v_mul_hi_u32_u24 v14, 429497, v91
    v_lshrrev_b32 v12, 3, v95
    v_cos_f32 v10, v10
    v_lshlrev_b16 v13, 3, v95
    v_mad_i32_i24 v11, v14, s55, v91
    v_bitop3_b32 v12, v6, v13, v12 bitop3:0xca
    v_add_lshl_u32 v11, v11, s40, 17
    v_lshlrev_b16 v14, 8, v14
    v_lshrrev_b32 v13, 2, v95
    v_or_b32 v91, v12, v11
    v_bitop3_b32 v95, v5, v13, v14 bitop3:0xea
    ds_add_u32 v95, v2
    v_cvt_pk_bf16_f32 v87, v9, v10
    v_perm_b32 v12, v87, v87, s41
    v_bitop3_b32 v90, v4, v12, v90 bitop3:0xca
    v_perm_b32 v13, v87, v87, s42
    v_bitop3_b32 v91, v4, v13, v91 bitop3:0xca
    v_lshrrev_b32 v8, 2, v0
    v_and_b32 v7, 0x3c00, v0
    v_bitop3_b32 v7, v5, v8, v7 bitop3:0xea
    s_waitcnt lgkmcnt(0)
    s_barrier
    ds_read2st64_b32 v[8:9], v7 offset0:0 offset1:1
    ds_read2st64_b32 v[10:11], v7 offset0:2 offset1:3
    s_add_u32 s45, s33, 0x2400000
    buffer_load_dwordx4 v[112:115], v0, s[12:15], s45 offen nt
    s_waitcnt lgkmcnt(0)
    v_lshl_or_b32 v12, v9, 16, v8
    v_lshl_or_b32 v13, v11, 16, v10
    v_mov_b32 v14, v12
    v_mov_b32 v15, v13
    s_nop 0
    v_add_u32_dpp v14, v14, v14 row_shr:1 row_mask:0xf bank_mask:0xf bound_ctrl:1
    v_add_u32_dpp v15, v15, v15 row_shr:1 row_mask:0xf bank_mask:0xf bound_ctrl:1
    s_nop 0
    v_add_u32_dpp v14, v14, v14 row_shr:2 row_mask:0xf bank_mask:0xf bound_ctrl:1
    v_add_u32_dpp v15, v15, v15 row_shr:2 row_mask:0xf bank_mask:0xf bound_ctrl:1
    s_nop 0
    v_add_u32_dpp v14, v14, v14 row_shr:4 row_mask:0xf bank_mask:0xf bound_ctrl:1
    v_add_u32_dpp v15, v15, v15 row_shr:4 row_mask:0xf bank_mask:0xf bound_ctrl:1
    s_nop 0
    v_add_u32_dpp v14, v14, v14 row_shr:8 row_mask:0xf bank_mask:0xf bound_ctrl:1
    v_add_u32_dpp v15, v15, v15 row_shr:8 row_mask:0xf bank_mask:0xf bound_ctrl:1
    s_nop 0
    v_add_u32_dpp v14, v14, v14 row_bcast:15 row_mask:0xa bank_mask:0xf
    v_add_u32_dpp v15, v15, v15 row_bcast:15 row_mask:0xa bank_mask:0xf
    s_nop 0
    v_add_u32_dpp v14, v14, v14 row_bcast:31 row_mask:0xc bank_mask:0xf
    v_add_u32_dpp v15, v15, v15 row_bcast:31 row_mask:0xc bank_mask:0xf
    v_readlane_b32 s48, v14, 63
    v_readlane_b32 s49, v15, 63
    s_lshl_b32 s54, s32, 2
    v_mov_b32 v8, s54
    s_and_b32 s50, s48, 0xffff
    s_lshr_b32 s51, s48, 16
    s_and_b32 s52, s49, 0xffff
    s_lshr_b32 s53, s49, 16
    s_add_u32 s51, s51, s50
    s_add_u32 s52, s52, s51
    s_add_u32 s53, s53, s52
    v_mov_b32 v9, s53
    s_mov_b64 exec, 1
    ds_write_b32 v8, v9 offset:16384
    s_mov_b64 exec, -1
    v_and_b32 v8, 60, v7
    s_waitcnt lgkmcnt(0)
    s_barrier
    ds_read_b32 v9, v8 offset:16384
    s_waitcnt lgkmcnt(0)
    v_add_u32_dpp v9, v9, v9 row_shr:1 row_mask:0xf bank_mask:0xf bound_ctrl:1
    s_nop 1
    v_add_u32_dpp v9, v9, v9 row_shr:2 row_mask:0xf bank_mask:0xf bound_ctrl:1
    s_nop 1
    v_add_u32_dpp v9, v9, v9 row_shr:4 row_mask:0xf bank_mask:0xf bound_ctrl:1
    s_nop 1
    v_add_u32_dpp v9, v9, v9 row_shr:8 row_mask:0xf bank_mask:0xf bound_ctrl:1
    s_nop 0
    v_readlane_b32 s54, v9, s32
    s_sub_u32 s54, s54, s53
    s_add_u32 s50, s50, s54
    s_add_u32 s51, s51, s54
    s_add_u32 s52, s52, s54
    s_pack_ll_b32_b16 s48, s54, s50
    s_pack_ll_b32_b16 s49, s51, s52
    v_add_u32 v14, s48, v14
    v_add_u32 v15, s49, v15
    v_sub_u32 v12, v14, v12
    v_sub_u32 v13, v15, v13
    v_and_b32 v8, 0xffff, v12
    v_lshrrev_b32 v9, 16, v12
    v_and_b32 v10, 0xffff, v13
    v_lshrrev_b32 v11, 16, v13
    ds_write2st64_b32 v7, v8, v9 offset0:0 offset1:1
    ds_write2st64_b32 v7, v10, v11 offset0:2 offset1:3
    s_waitcnt lgkmcnt(0)
    s_barrier
    ds_add_rtn_u32 v20, v20, v2
    ds_add_rtn_u32 v21, v21, v2
    ds_add_rtn_u32 v22, v22, v2
    ds_add_rtn_u32 v23, v23, v2
    s_add_u32 s46, s36, 0x0
    v_and_b32 v11, 0x3f0, v0
    v_add_u32 v11, v11, v11
    buffer_store_dwordx2 v[12:13], v11, s[24:27], s46 offen
    s_bitset0_b64 exec, 63
    s_not_b64 exec, exec
    buffer_store_dwordx2 v[14:15], v11, s[24:27], s46 offen offset:32
    s_mov_b64 exec, -1
    ds_add_rtn_u32 v32, v32, v2
    ds_add_rtn_u32 v33, v33, v2
    ds_add_rtn_u32 v34, v34, v2
    ds_add_rtn_u32 v35, v35, v2
    ds_add_rtn_u32 v40, v40, v2
    ds_add_rtn_u32 v41, v41, v2
    ds_add_rtn_u32 v42, v42, v2
    ds_add_rtn_u32 v43, v43, v2
    s_add_u32 s47, s33, 0x2800000
    buffer_load_dwordx4 v[116:119], v0, s[8:11], s47 offen nt
    ds_add_rtn_u32 v52, v52, v2
    ds_add_rtn_u32 v53, v53, v2
    ds_add_rtn_u32 v54, v54, v2
    ds_add_rtn_u32 v55, v55, v2
    ds_add_rtn_u32 v60, v60, v2
    ds_add_rtn_u32 v61, v61, v2
    ds_add_rtn_u32 v62, v62, v2
    ds_add_rtn_u32 v63, v63, v2
    ds_add_rtn_u32 v72, v72, v2
    ds_add_rtn_u32 v73, v73, v2
    ds_add_rtn_u32 v74, v74, v2
    ds_add_rtn_u32 v75, v75, v2
    s_add_u32 s44, s33, 0x2800000
    buffer_load_dwordx4 v[120:123], v0, s[12:15], s44 offen nt
    ds_add_rtn_u32 v80, v80, v2
    ds_add_rtn_u32 v81, v81, v2
    ds_add_rtn_u32 v82, v82, v2
    ds_add_rtn_u32 v83, v83, v2
    ds_add_rtn_u32 v92, v92, v2
    ds_add_rtn_u32 v93, v93, v2
    ds_add_rtn_u32 v94, v94, v2
    ds_add_rtn_u32 v95, v95, v2
    s_waitcnt lgkmcnt(0)
    s_barrier
    v_and_b32 v7, -4, v20
    v_lshl_add_u32 v8, v20, 2, v7
    ds_write_b32 v8, v16
    v_lshl_add_u32 v7, v7, 2, v20
    ds_write_b8 v7, v24 offset:16
    v_and_b32 v9, -4, v21
    v_lshl_add_u32 v10, v21, 2, v9
    ds_write_b32 v10, v17
    v_lshl_add_u32 v9, v9, 2, v21
    ds_write_b8_d16_hi v9, v24 offset:16
    v_and_b32 v7, -4, v22
    v_lshl_add_u32 v8, v22, 2, v7
    ds_write_b32 v8, v18
    v_lshl_add_u32 v7, v7, 2, v22
    ds_write_b8 v7, v25 offset:16
    v_and_b32 v9, -4, v23
    v_lshl_add_u32 v10, v23, 2, v9
    ds_write_b32 v10, v19
    v_lshl_add_u32 v9, v9, 2, v23
    ds_write_b8_d16_hi v9, v25 offset:16
    s_add_u32 s45, s34, 0x1400000
    buffer_load_dwordx2 v[124:125], v1, s[16:19], s45 offen nt
    s_add_u32 s46, s34, 0x1600000
    buffer_load_dwordx2 v[126:127], v1, s[16:19], s46 offen nt
    s_add_u32 s47, s33, 0x2c00000
    buffer_load_dwordx4 v[16:19], v0, s[8:11], s47 offen nt
    v_and_b32 v7, -4, v32
    v_lshl_add_u32 v8, v32, 2, v7
    ds_write_b32 v8, v28
    v_lshl_add_u32 v7, v7, 2, v32
    ds_write_b8 v7, v26 offset:16
    v_and_b32 v9, -4, v33
    v_lshl_add_u32 v10, v33, 2, v9
    ds_write_b32 v10, v29
    v_lshl_add_u32 v9, v9, 2, v33
    ds_write_b8_d16_hi v9, v26 offset:16
    v_and_b32 v7, -4, v34
    v_lshl_add_u32 v8, v34, 2, v7
    ds_write_b32 v8, v30
    v_lshl_add_u32 v7, v7, 2, v34
    ds_write_b8 v7, v27 offset:16
    v_and_b32 v9, -4, v35
    v_lshl_add_u32 v10, v35, 2, v9
    ds_write_b32 v10, v31
    v_lshl_add_u32 v9, v9, 2, v35
    ds_write_b8_d16_hi v9, v27 offset:16
    s_add_u32 s44, s33, 0x2c00000
    buffer_load_dwordx4 v[20:23], v0, s[12:15], s44 offen nt
    v_and_b32 v7, -4, v40
    v_lshl_add_u32 v8, v40, 2, v7
    ds_write_b32 v8, v36
    v_lshl_add_u32 v7, v7, 2, v40
    ds_write_b8 v7, v44 offset:16
    v_and_b32 v9, -4, v41
    v_lshl_add_u32 v10, v41, 2, v9
    ds_write_b32 v10, v37
    v_lshl_add_u32 v9, v9, 2, v41
    ds_write_b8_d16_hi v9, v44 offset:16
    v_and_b32 v7, -4, v42
    v_lshl_add_u32 v8, v42, 2, v7
    ds_write_b32 v8, v38
    v_lshl_add_u32 v7, v7, 2, v42
    ds_write_b8 v7, v45 offset:16
    v_and_b32 v9, -4, v43
    v_lshl_add_u32 v10, v43, 2, v9
    ds_write_b32 v10, v39
    v_lshl_add_u32 v9, v9, 2, v43
    ds_write_b8_d16_hi v9, v45 offset:16
    s_add_u32 s45, s33, 0x3000000
    buffer_load_dwordx4 v[28:31], v0, s[8:11], s45 offen nt
    s_add_u32 s46, s33, 0x3000000
    buffer_load_dwordx4 v[32:35], v0, s[12:15], s46 offen nt
    v_and_b32 v7, -4, v52
    v_lshl_add_u32 v8, v52, 2, v7
    ds_write_b32 v8, v48
    v_lshl_add_u32 v7, v7, 2, v52
    ds_write_b8 v7, v46 offset:16
    v_and_b32 v9, -4, v53
    v_lshl_add_u32 v10, v53, 2, v9
    ds_write_b32 v10, v49
    v_lshl_add_u32 v9, v9, 2, v53
    ds_write_b8_d16_hi v9, v46 offset:16
    v_and_b32 v7, -4, v54
    v_lshl_add_u32 v8, v54, 2, v7
    ds_write_b32 v8, v50
    v_lshl_add_u32 v7, v7, 2, v54
    ds_write_b8 v7, v47 offset:16
    v_and_b32 v9, -4, v55
    v_lshl_add_u32 v10, v55, 2, v9
    ds_write_b32 v10, v51
    v_lshl_add_u32 v9, v9, 2, v55
    ds_write_b8_d16_hi v9, v47 offset:16
    s_add_u32 s47, s34, 0x1800000
    buffer_load_dwordx2 v[24:25], v1, s[16:19], s47 offen nt
    s_add_u32 s44, s34, 0x1a00000
    buffer_load_dwordx2 v[26:27], v1, s[16:19], s44 offen nt
    v_and_b32 v7, -4, v60
    v_lshl_add_u32 v8, v60, 2, v7
    ds_write_b32 v8, v56
    v_lshl_add_u32 v7, v7, 2, v60
    ds_write_b8 v7, v64 offset:16
    v_and_b32 v9, -4, v61
    v_lshl_add_u32 v10, v61, 2, v9
    ds_write_b32 v10, v57
    v_lshl_add_u32 v9, v9, 2, v61
    ds_write_b8_d16_hi v9, v64 offset:16
    v_and_b32 v7, -4, v62
    v_lshl_add_u32 v8, v62, 2, v7
    ds_write_b32 v8, v58
    v_lshl_add_u32 v7, v7, 2, v62
    ds_write_b8 v7, v65 offset:16
    v_and_b32 v9, -4, v63
    v_lshl_add_u32 v10, v63, 2, v9
    ds_write_b32 v10, v59
    v_lshl_add_u32 v9, v9, 2, v63
    ds_write_b8_d16_hi v9, v65 offset:16
    s_add_u32 s45, s33, 0x3400000
    buffer_load_dwordx4 v[36:39], v0, s[8:11], s45 offen nt
    v_and_b32 v7, -4, v72
    v_lshl_add_u32 v8, v72, 2, v7
    ds_write_b32 v8, v68
    v_lshl_add_u32 v7, v7, 2, v72
    ds_write_b8 v7, v66 offset:16
    v_and_b32 v9, -4, v73
    v_lshl_add_u32 v10, v73, 2, v9
    ds_write_b32 v10, v69
    v_lshl_add_u32 v9, v9, 2, v73
    ds_write_b8_d16_hi v9, v66 offset:16
    v_and_b32 v7, -4, v74
    v_lshl_add_u32 v8, v74, 2, v7
    ds_write_b32 v8, v70
    v_lshl_add_u32 v7, v7, 2, v74
    ds_write_b8 v7, v67 offset:16
    v_and_b32 v9, -4, v75
    v_lshl_add_u32 v10, v75, 2, v9
    ds_write_b32 v10, v71
    v_lshl_add_u32 v9, v9, 2, v75
    ds_write_b8_d16_hi v9, v67 offset:16
    s_add_u32 s46, s33, 0x3400000
    buffer_load_dwordx4 v[40:43], v0, s[12:15], s46 offen nt
    s_add_u32 s47, s33, 0x3800000
    buffer_load_dwordx4 v[48:51], v0, s[8:11], s47 offen nt
    v_and_b32 v7, -4, v80
    v_lshl_add_u32 v8, v80, 2, v7
    ds_write_b32 v8, v76
    v_lshl_add_u32 v7, v7, 2, v80
    ds_write_b8 v7, v84 offset:16
    v_and_b32 v9, -4, v81
    v_lshl_add_u32 v10, v81, 2, v9
    ds_write_b32 v10, v77
    v_lshl_add_u32 v9, v9, 2, v81
    ds_write_b8_d16_hi v9, v84 offset:16
    v_and_b32 v7, -4, v82
    v_lshl_add_u32 v8, v82, 2, v7
    ds_write_b32 v8, v78
    v_lshl_add_u32 v7, v7, 2, v82
    ds_write_b8 v7, v85 offset:16
    v_and_b32 v9, -4, v83
    v_lshl_add_u32 v10, v83, 2, v9
    ds_write_b32 v10, v79
    v_lshl_add_u32 v9, v9, 2, v83
    ds_write_b8_d16_hi v9, v85 offset:16
    s_add_u32 s44, s33, 0x3800000
    buffer_load_dwordx4 v[52:55], v0, s[12:15], s44 offen nt
    v_and_b32 v7, -4, v92
    v_lshl_add_u32 v8, v92, 2, v7
    ds_write_b32 v8, v88
    v_lshl_add_u32 v7, v7, 2, v92
    ds_write_b8 v7, v86 offset:16
    v_and_b32 v9, -4, v93
    v_lshl_add_u32 v10, v93, 2, v9
    ds_write_b32 v10, v89
    v_lshl_add_u32 v9, v9, 2, v93
    ds_write_b8_d16_hi v9, v86 offset:16
    v_and_b32 v7, -4, v94
    v_lshl_add_u32 v8, v94, 2, v7
    ds_write_b32 v8, v90
    v_lshl_add_u32 v7, v7, 2, v94
    ds_write_b8 v7, v87 offset:16
    v_and_b32 v9, -4, v95
    v_lshl_add_u32 v10, v95, 2, v9
    ds_write_b32 v10, v91
    v_lshl_add_u32 v9, v9, 2, v95
    ds_write_b8_d16_hi v9, v87 offset:16
    s_add_u32 s45, s34, 0x1c00000
    buffer_load_dwordx2 v[44:45], v1, s[16:19], s45 offen nt
    s_add_u32 s46, s34, 0x1e00000
    buffer_load_dwordx2 v[46:47], v1, s[16:19], s46 offen nt
    v_add_u32 v7, 0x10000, v0
    v_add_u32 v12, 0x20000, v0
    v_mov_b32 v8, 0
    v_mov_b32 v9, 0
    v_mov_b32 v10, 0
    v_mov_b32 v11, 0
    s_waitcnt lgkmcnt(0)
    s_barrier
    ds_read_b128 v[56:59], v0 offset:0
    ds_write_b128 v0, v[8:11]
    ds_read_b128 v[60:63], v0 offset:16384
    ds_read_b128 v[68:71], v0 offset:32768
    ds_read_b128 v[72:75], v0 offset:49152
    ds_read_b128 v[64:67], v7 offset:0
    ds_read_b128 v[76:79], v7 offset:16384
    ds_read_b128 v[80:83], v7 offset:32768
    ds_read_b128 v[88:91], v7 offset:49152
    ds_read_b128 v[92:95], v12 offset:0
    ds_read_b128 v[84:87], v12 offset:16384
    s_waitcnt lgkmcnt(0)
    s_barrier
    s_add_u32 s47, s35, 0x0
    buffer_store_dwordx4 v[56:59], v0, s[20:23], s47 offen sc1
    s_add_u32 s44, s33, 0x3c00000
    s_nop 0
    buffer_load_dwordx4 v[56:59], v0, s[8:11], s44 offen nt
    s_add_u32 s45, s35, 0x4000
    buffer_store_dwordx4 v[60:63], v0, s[20:23], s45 offen sc1
    s_add_u32 s46, s33, 0x3c00000
    s_nop 0
    buffer_load_dwordx4 v[60:63], v0, s[12:15], s46 offen nt
    s_waitcnt vmcnt(24)
    v_lshlrev_b32 v7, 16, v104
    v_and_b32 v8, 0xffff0000, v104
    v_lshlrev_b32 v9, 16, v105
    v_and_b32 v10, 0xffff0000, v105
    v_mul_f32 v7, 0.15915494, v7
    v_mul_f32 v8, 0.15915494, v8
    v_mul_f32 v9, 0.15915494, v9
    v_mul_f32 v10, 0.15915494, v10
    v_mul_hi_u32_u24 v14, 429497, v96
    v_lshrrev_b32 v12, 3, v100
    v_cos_f32 v7, v7
    v_lshlrev_b16 v13, 3, v100
    v_mad_i32_i24 v11, v14, s55, v96
    v_bitop3_b32 v12, v6, v13, v12 bitop3:0xca
    v_add_lshl_u32 v11, v11, s40, 17
    v_lshlrev_b16 v14, 8, v14
    v_lshrrev_b32 v13, 2, v100
    v_or_b32 v96, v12, v11
    v_bitop3_b32 v100, v5, v13, v14 bitop3:0xea
    ds_add_u32 v100, v2
    v_mul_hi_u32_u24 v14, 429497, v97
    v_lshrrev_b32 v12, 3, v101
    v_cos_f32 v8, v8
    v_lshlrev_b16 v13, 3, v101
    v_mad_i32_i24 v11, v14, s55, v97
    v_bitop3_b32 v12, v6, v13, v12 bitop3:0xca
    v_add_lshl_u32 v11, v11, s40, 17
    v_lshlrev_b16 v14, 8, v14
    v_lshrrev_b32 v13, 2, v101
    v_or_b32 v97, v12, v11
    v_bitop3_b32 v101, v5, v13, v14 bitop3:0xea
    ds_add_u32 v101, v2
    v_cvt_pk_bf16_f32 v104, v7, v8
    v_perm_b32 v12, v104, v104, s41
    v_bitop3_b32 v96, v4, v12, v96 bitop3:0xca
    v_perm_b32 v13, v104, v104, s42
    v_bitop3_b32 v97, v4, v13, v97 bitop3:0xca
    v_mul_hi_u32_u24 v14, 429497, v98
    v_lshrrev_b32 v12, 3, v102
    v_cos_f32 v9, v9
    v_lshlrev_b16 v13, 3, v102
    v_mad_i32_i24 v11, v14, s55, v98
    v_bitop3_b32 v12, v6, v13, v12 bitop3:0xca
    v_add_lshl_u32 v11, v11, s40, 17
    v_lshlrev_b16 v14, 8, v14
    v_lshrrev_b32 v13, 2, v102
    v_or_b32 v98, v12, v11
    v_bitop3_b32 v102, v5, v13, v14 bitop3:0xea
    ds_add_u32 v102, v2
    v_mul_hi_u32_u24 v14, 429497, v99
    v_lshrrev_b32 v12, 3, v103
    v_cos_f32 v10, v10
    v_lshlrev_b16 v13, 3, v103
    v_mad_i32_i24 v11, v14, s55, v99
    v_bitop3_b32 v12, v6, v13, v12 bitop3:0xca
    v_add_lshl_u32 v11, v11, s40, 17
    v_lshlrev_b16 v14, 8, v14
    v_lshrrev_b32 v13, 2, v103
    v_or_b32 v99, v12, v11
    v_bitop3_b32 v103, v5, v13, v14 bitop3:0xea
    ds_add_u32 v103, v2
    v_cvt_pk_bf16_f32 v105, v9, v10
    v_perm_b32 v12, v105, v105, s41
    v_bitop3_b32 v98, v4, v12, v98 bitop3:0xca
    v_perm_b32 v13, v105, v105, s42
    v_bitop3_b32 v99, v4, v13, v99 bitop3:0xca
    s_waitcnt vmcnt(22)
    v_lshlrev_b32 v7, 16, v106
    v_and_b32 v8, 0xffff0000, v106
    v_lshlrev_b32 v9, 16, v107
    v_and_b32 v10, 0xffff0000, v107
    v_mul_f32 v7, 0.15915494, v7
    v_mul_f32 v8, 0.15915494, v8
    v_mul_f32 v9, 0.15915494, v9
    v_mul_f32 v10, 0.15915494, v10
    v_mul_hi_u32_u24 v14, 429497, v108
    v_lshrrev_b32 v12, 3, v112
    v_cos_f32 v7, v7
    v_lshlrev_b16 v13, 3, v112
    v_mad_i32_i24 v11, v14, s55, v108
    v_bitop3_b32 v12, v6, v13, v12 bitop3:0xca
    v_add_lshl_u32 v11, v11, s40, 17
    v_lshlrev_b16 v14, 8, v14
    v_lshrrev_b32 v13, 2, v112
    v_or_b32 v108, v12, v11
    v_bitop3_b32 v112, v5, v13, v14 bitop3:0xea
    ds_add_u32 v112, v2
    v_mul_hi_u32_u24 v14, 429497, v109
    v_lshrrev_b32 v12, 3, v113
    v_cos_f32 v8, v8
    v_lshlrev_b16 v13, 3, v113
    v_mad_i32_i24 v11, v14, s55, v109
    v_bitop3_b32 v12, v6, v13, v12 bitop3:0xca
    v_add_lshl_u32 v11, v11, s40, 17
    v_lshlrev_b16 v14, 8, v14
    v_lshrrev_b32 v13, 2, v113
    v_or_b32 v109, v12, v11
    v_bitop3_b32 v113, v5, v13, v14 bitop3:0xea
    ds_add_u32 v113, v2
    v_cvt_pk_bf16_f32 v106, v7, v8
    v_perm_b32 v12, v106, v106, s41
    v_bitop3_b32 v108, v4, v12, v108 bitop3:0xca
    v_perm_b32 v13, v106, v106, s42
    v_bitop3_b32 v109, v4, v13, v109 bitop3:0xca
    v_mul_hi_u32_u24 v14, 429497, v110
    v_lshrrev_b32 v12, 3, v114
    v_cos_f32 v9, v9
    v_lshlrev_b16 v13, 3, v114
    v_mad_i32_i24 v11, v14, s55, v110
    v_bitop3_b32 v12, v6, v13, v12 bitop3:0xca
    v_add_lshl_u32 v11, v11, s40, 17
    v_lshlrev_b16 v14, 8, v14
    v_lshrrev_b32 v13, 2, v114
    v_or_b32 v110, v12, v11
    v_bitop3_b32 v114, v5, v13, v14 bitop3:0xea
    ds_add_u32 v114, v2
    v_mul_hi_u32_u24 v14, 429497, v111
    v_lshrrev_b32 v12, 3, v115
    v_cos_f32 v10, v10
    v_lshlrev_b16 v13, 3, v115
    v_mad_i32_i24 v11, v14, s55, v111
    v_bitop3_b32 v12, v6, v13, v12 bitop3:0xca
    v_add_lshl_u32 v11, v11, s40, 17
    v_lshlrev_b16 v14, 8, v14
    v_lshrrev_b32 v13, 2, v115
    v_or_b32 v111, v12, v11
    v_bitop3_b32 v115, v5, v13, v14 bitop3:0xea
    ds_add_u32 v115, v2
    v_cvt_pk_bf16_f32 v107, v9, v10
    v_perm_b32 v12, v107, v107, s41
    v_bitop3_b32 v110, v4, v12, v110 bitop3:0xca
    v_perm_b32 v13, v107, v107, s42
    v_bitop3_b32 v111, v4, v13, v111 bitop3:0xca
    s_waitcnt vmcnt(16)
    v_lshlrev_b32 v7, 16, v124
    v_and_b32 v8, 0xffff0000, v124
    v_lshlrev_b32 v9, 16, v125
    v_and_b32 v10, 0xffff0000, v125
    v_mul_f32 v7, 0.15915494, v7
    v_mul_f32 v8, 0.15915494, v8
    v_mul_f32 v9, 0.15915494, v9
    v_mul_f32 v10, 0.15915494, v10
    v_mul_hi_u32_u24 v14, 429497, v116
    v_lshrrev_b32 v12, 3, v120
    v_cos_f32 v7, v7
    v_lshlrev_b16 v13, 3, v120
    v_mad_i32_i24 v11, v14, s55, v116
    v_bitop3_b32 v12, v6, v13, v12 bitop3:0xca
    v_add_lshl_u32 v11, v11, s40, 17
    v_lshlrev_b16 v14, 8, v14
    v_lshrrev_b32 v13, 2, v120
    v_or_b32 v116, v12, v11
    v_bitop3_b32 v120, v5, v13, v14 bitop3:0xea
    ds_add_u32 v120, v2
    v_mul_hi_u32_u24 v14, 429497, v117
    v_lshrrev_b32 v12, 3, v121
    v_cos_f32 v8, v8
    v_lshlrev_b16 v13, 3, v121
    v_mad_i32_i24 v11, v14, s55, v117
    v_bitop3_b32 v12, v6, v13, v12 bitop3:0xca
    v_add_lshl_u32 v11, v11, s40, 17
    v_lshlrev_b16 v14, 8, v14
    v_lshrrev_b32 v13, 2, v121
    v_or_b32 v117, v12, v11
    v_bitop3_b32 v121, v5, v13, v14 bitop3:0xea
    ds_add_u32 v121, v2
    v_cvt_pk_bf16_f32 v124, v7, v8
    v_perm_b32 v12, v124, v124, s41
    v_bitop3_b32 v116, v4, v12, v116 bitop3:0xca
    v_perm_b32 v13, v124, v124, s42
    v_bitop3_b32 v117, v4, v13, v117 bitop3:0xca
    v_mul_hi_u32_u24 v14, 429497, v118
    v_lshrrev_b32 v12, 3, v122
    v_cos_f32 v9, v9
    v_lshlrev_b16 v13, 3, v122
    v_mad_i32_i24 v11, v14, s55, v118
    v_bitop3_b32 v12, v6, v13, v12 bitop3:0xca
    v_add_lshl_u32 v11, v11, s40, 17
    v_lshlrev_b16 v14, 8, v14
    v_lshrrev_b32 v13, 2, v122
    v_or_b32 v118, v12, v11
    v_bitop3_b32 v122, v5, v13, v14 bitop3:0xea
    ds_add_u32 v122, v2
    v_mul_hi_u32_u24 v14, 429497, v119
    v_lshrrev_b32 v12, 3, v123
    v_cos_f32 v10, v10
    v_lshlrev_b16 v13, 3, v123
    v_mad_i32_i24 v11, v14, s55, v119
    v_bitop3_b32 v12, v6, v13, v12 bitop3:0xca
    v_add_lshl_u32 v11, v11, s40, 17
    v_lshlrev_b16 v14, 8, v14
    v_lshrrev_b32 v13, 2, v123
    v_or_b32 v119, v12, v11
    v_bitop3_b32 v123, v5, v13, v14 bitop3:0xea
    ds_add_u32 v123, v2
    v_cvt_pk_bf16_f32 v125, v9, v10
    v_perm_b32 v12, v125, v125, s41
    v_bitop3_b32 v118, v4, v12, v118 bitop3:0xca
    v_perm_b32 v13, v125, v125, s42
    v_bitop3_b32 v119, v4, v13, v119 bitop3:0xca
    s_add_u32 s47, s35, 0x8000
    buffer_store_dwordx4 v[68:71], v0, s[20:23], s47 offen sc1
    s_add_u32 s44, s33, 0x4000000
    s_nop 0
    buffer_load_dwordx4 v[68:71], v0, s[8:11], s44 offen nt
    s_waitcnt vmcnt(16)
    v_lshlrev_b32 v7, 16, v126
    v_and_b32 v8, 0xffff0000, v126
    v_lshlrev_b32 v9, 16, v127
    v_and_b32 v10, 0xffff0000, v127
    v_mul_f32 v7, 0.15915494, v7
    v_mul_f32 v8, 0.15915494, v8
    v_mul_f32 v9, 0.15915494, v9
    v_mul_f32 v10, 0.15915494, v10
    v_mul_hi_u32_u24 v14, 429497, v16
    v_lshrrev_b32 v12, 3, v20
    v_cos_f32 v7, v7
    v_lshlrev_b16 v13, 3, v20
    v_mad_i32_i24 v11, v14, s55, v16
    v_bitop3_b32 v12, v6, v13, v12 bitop3:0xca
    v_add_lshl_u32 v11, v11, s40, 17
    v_lshlrev_b16 v14, 8, v14
    v_lshrrev_b32 v13, 2, v20
    v_or_b32 v16, v12, v11
    v_bitop3_b32 v20, v5, v13, v14 bitop3:0xea
    ds_add_u32 v20, v2
    v_mul_hi_u32_u24 v14, 429497, v17
    v_lshrrev_b32 v12, 3, v21
    v_cos_f32 v8, v8
    v_lshlrev_b16 v13, 3, v21
    v_mad_i32_i24 v11, v14, s55, v17
    v_bitop3_b32 v12, v6, v13, v12 bitop3:0xca
    v_add_lshl_u32 v11, v11, s40, 17
    v_lshlrev_b16 v14, 8, v14
    v_lshrrev_b32 v13, 2, v21
    v_or_b32 v17, v12, v11
    v_bitop3_b32 v21, v5, v13, v14 bitop3:0xea
    ds_add_u32 v21, v2
    v_cvt_pk_bf16_f32 v126, v7, v8
    v_perm_b32 v12, v126, v126, s41
    v_bitop3_b32 v16, v4, v12, v16 bitop3:0xca
    v_perm_b32 v13, v126, v126, s42
    v_bitop3_b32 v17, v4, v13, v17 bitop3:0xca
    v_mul_hi_u32_u24 v14, 429497, v18
    v_lshrrev_b32 v12, 3, v22
    v_cos_f32 v9, v9
    v_lshlrev_b16 v13, 3, v22
    v_mad_i32_i24 v11, v14, s55, v18
    v_bitop3_b32 v12, v6, v13, v12 bitop3:0xca
    v_add_lshl_u32 v11, v11, s40, 17
    v_lshlrev_b16 v14, 8, v14
    v_lshrrev_b32 v13, 2, v22
    v_or_b32 v18, v12, v11
    v_bitop3_b32 v22, v5, v13, v14 bitop3:0xea
    ds_add_u32 v22, v2
    v_mul_hi_u32_u24 v14, 429497, v19
    v_lshrrev_b32 v12, 3, v23
    v_cos_f32 v10, v10
    v_lshlrev_b16 v13, 3, v23
    v_mad_i32_i24 v11, v14, s55, v19
    v_bitop3_b32 v12, v6, v13, v12 bitop3:0xca
    v_add_lshl_u32 v11, v11, s40, 17
    v_lshlrev_b16 v14, 8, v14
    v_lshrrev_b32 v13, 2, v23
    v_or_b32 v19, v12, v11
    v_bitop3_b32 v23, v5, v13, v14 bitop3:0xea
    ds_add_u32 v23, v2
    v_cvt_pk_bf16_f32 v127, v9, v10
    v_perm_b32 v12, v127, v127, s41
    v_bitop3_b32 v18, v4, v12, v18 bitop3:0xca
    v_perm_b32 v13, v127, v127, s42
    v_bitop3_b32 v19, v4, v13, v19 bitop3:0xca
    s_waitcnt vmcnt(12)
    v_lshlrev_b32 v7, 16, v24
    v_and_b32 v8, 0xffff0000, v24
    v_lshlrev_b32 v9, 16, v25
    v_and_b32 v10, 0xffff0000, v25
    v_mul_f32 v7, 0.15915494, v7
    v_mul_f32 v8, 0.15915494, v8
    v_mul_f32 v9, 0.15915494, v9
    v_mul_f32 v10, 0.15915494, v10
    v_mul_hi_u32_u24 v14, 429497, v28
    v_lshrrev_b32 v12, 3, v32
    v_cos_f32 v7, v7
    v_lshlrev_b16 v13, 3, v32
    v_mad_i32_i24 v11, v14, s55, v28
    v_bitop3_b32 v12, v6, v13, v12 bitop3:0xca
    v_add_lshl_u32 v11, v11, s40, 17
    v_lshlrev_b16 v14, 8, v14
    v_lshrrev_b32 v13, 2, v32
    v_or_b32 v28, v12, v11
    v_bitop3_b32 v32, v5, v13, v14 bitop3:0xea
    ds_add_u32 v32, v2
    v_mul_hi_u32_u24 v14, 429497, v29
    v_lshrrev_b32 v12, 3, v33
    v_cos_f32 v8, v8
    v_lshlrev_b16 v13, 3, v33
    v_mad_i32_i24 v11, v14, s55, v29
    v_bitop3_b32 v12, v6, v13, v12 bitop3:0xca
    v_add_lshl_u32 v11, v11, s40, 17
    v_lshlrev_b16 v14, 8, v14
    v_lshrrev_b32 v13, 2, v33
    v_or_b32 v29, v12, v11
    v_bitop3_b32 v33, v5, v13, v14 bitop3:0xea
    ds_add_u32 v33, v2
    v_cvt_pk_bf16_f32 v24, v7, v8
    v_perm_b32 v12, v24, v24, s41
    v_bitop3_b32 v28, v4, v12, v28 bitop3:0xca
    v_perm_b32 v13, v24, v24, s42
    v_bitop3_b32 v29, v4, v13, v29 bitop3:0xca
    v_mul_hi_u32_u24 v14, 429497, v30
    v_lshrrev_b32 v12, 3, v34
    v_cos_f32 v9, v9
    v_lshlrev_b16 v13, 3, v34
    v_mad_i32_i24 v11, v14, s55, v30
    v_bitop3_b32 v12, v6, v13, v12 bitop3:0xca
    v_add_lshl_u32 v11, v11, s40, 17
    v_lshlrev_b16 v14, 8, v14
    v_lshrrev_b32 v13, 2, v34
    v_or_b32 v30, v12, v11
    v_bitop3_b32 v34, v5, v13, v14 bitop3:0xea
    ds_add_u32 v34, v2
    v_mul_hi_u32_u24 v14, 429497, v31
    v_lshrrev_b32 v12, 3, v35
    v_cos_f32 v10, v10
    v_lshlrev_b16 v13, 3, v35
    v_mad_i32_i24 v11, v14, s55, v31
    v_bitop3_b32 v12, v6, v13, v12 bitop3:0xca
    v_add_lshl_u32 v11, v11, s40, 17
    v_lshlrev_b16 v14, 8, v14
    v_lshrrev_b32 v13, 2, v35
    v_or_b32 v31, v12, v11
    v_bitop3_b32 v35, v5, v13, v14 bitop3:0xea
    ds_add_u32 v35, v2
    v_cvt_pk_bf16_f32 v25, v9, v10
    v_perm_b32 v12, v25, v25, s41
    v_bitop3_b32 v30, v4, v12, v30 bitop3:0xca
    v_perm_b32 v13, v25, v25, s42
    v_bitop3_b32 v31, v4, v13, v31 bitop3:0xca
    s_waitcnt vmcnt(10)
    v_lshlrev_b32 v7, 16, v26
    v_and_b32 v8, 0xffff0000, v26
    v_lshlrev_b32 v9, 16, v27
    v_and_b32 v10, 0xffff0000, v27
    v_mul_f32 v7, 0.15915494, v7
    v_mul_f32 v8, 0.15915494, v8
    v_mul_f32 v9, 0.15915494, v9
    v_mul_f32 v10, 0.15915494, v10
    v_mul_hi_u32_u24 v14, 429497, v36
    v_lshrrev_b32 v12, 3, v40
    v_cos_f32 v7, v7
    v_lshlrev_b16 v13, 3, v40
    v_mad_i32_i24 v11, v14, s55, v36
    v_bitop3_b32 v12, v6, v13, v12 bitop3:0xca
    v_add_lshl_u32 v11, v11, s40, 17
    v_lshlrev_b16 v14, 8, v14
    v_lshrrev_b32 v13, 2, v40
    v_or_b32 v36, v12, v11
    v_bitop3_b32 v40, v5, v13, v14 bitop3:0xea
    ds_add_u32 v40, v2
    v_mul_hi_u32_u24 v14, 429497, v37
    v_lshrrev_b32 v12, 3, v41
    v_cos_f32 v8, v8
    v_lshlrev_b16 v13, 3, v41
    v_mad_i32_i24 v11, v14, s55, v37
    v_bitop3_b32 v12, v6, v13, v12 bitop3:0xca
    v_add_lshl_u32 v11, v11, s40, 17
    v_lshlrev_b16 v14, 8, v14
    v_lshrrev_b32 v13, 2, v41
    v_or_b32 v37, v12, v11
    v_bitop3_b32 v41, v5, v13, v14 bitop3:0xea
    ds_add_u32 v41, v2
    v_cvt_pk_bf16_f32 v26, v7, v8
    v_perm_b32 v12, v26, v26, s41
    v_bitop3_b32 v36, v4, v12, v36 bitop3:0xca
    v_perm_b32 v13, v26, v26, s42
    v_bitop3_b32 v37, v4, v13, v37 bitop3:0xca
    v_mul_hi_u32_u24 v14, 429497, v38
    v_lshrrev_b32 v12, 3, v42
    v_cos_f32 v9, v9
    v_lshlrev_b16 v13, 3, v42
    v_mad_i32_i24 v11, v14, s55, v38
    v_bitop3_b32 v12, v6, v13, v12 bitop3:0xca
    v_add_lshl_u32 v11, v11, s40, 17
    v_lshlrev_b16 v14, 8, v14
    v_lshrrev_b32 v13, 2, v42
    v_or_b32 v38, v12, v11
    v_bitop3_b32 v42, v5, v13, v14 bitop3:0xea
    ds_add_u32 v42, v2
    v_mul_hi_u32_u24 v14, 429497, v39
    v_lshrrev_b32 v12, 3, v43
    v_cos_f32 v10, v10
    v_lshlrev_b16 v13, 3, v43
    v_mad_i32_i24 v11, v14, s55, v39
    v_bitop3_b32 v12, v6, v13, v12 bitop3:0xca
    v_add_lshl_u32 v11, v11, s40, 17
    v_lshlrev_b16 v14, 8, v14
    v_lshrrev_b32 v13, 2, v43
    v_or_b32 v39, v12, v11
    v_bitop3_b32 v43, v5, v13, v14 bitop3:0xea
    ds_add_u32 v43, v2
    v_cvt_pk_bf16_f32 v27, v9, v10
    v_perm_b32 v12, v27, v27, s41
    v_bitop3_b32 v38, v4, v12, v38 bitop3:0xca
    v_perm_b32 v13, v27, v27, s42
    v_bitop3_b32 v39, v4, v13, v39 bitop3:0xca
    s_add_u32 s45, s35, 0xc000
    buffer_store_dwordx4 v[72:75], v0, s[20:23], s45 offen sc1
    s_add_u32 s46, s33, 0x4000000
    s_nop 0
    buffer_load_dwordx4 v[72:75], v0, s[12:15], s46 offen nt
    s_waitcnt vmcnt(8)
    v_lshlrev_b32 v7, 16, v44
    v_and_b32 v8, 0xffff0000, v44
    v_lshlrev_b32 v9, 16, v45
    v_and_b32 v10, 0xffff0000, v45
    v_mul_f32 v7, 0.15915494, v7
    v_mul_f32 v8, 0.15915494, v8
    v_mul_f32 v9, 0.15915494, v9
    v_mul_f32 v10, 0.15915494, v10
    v_mul_hi_u32_u24 v14, 429497, v48
    v_lshrrev_b32 v12, 3, v52
    v_cos_f32 v7, v7
    v_lshlrev_b16 v13, 3, v52
    v_mad_i32_i24 v11, v14, s55, v48
    v_bitop3_b32 v12, v6, v13, v12 bitop3:0xca
    v_add_lshl_u32 v11, v11, s40, 17
    v_lshlrev_b16 v14, 8, v14
    v_lshrrev_b32 v13, 2, v52
    v_or_b32 v48, v12, v11
    v_bitop3_b32 v52, v5, v13, v14 bitop3:0xea
    ds_add_u32 v52, v2
    v_mul_hi_u32_u24 v14, 429497, v49
    v_lshrrev_b32 v12, 3, v53
    v_cos_f32 v8, v8
    v_lshlrev_b16 v13, 3, v53
    v_mad_i32_i24 v11, v14, s55, v49
    v_bitop3_b32 v12, v6, v13, v12 bitop3:0xca
    v_add_lshl_u32 v11, v11, s40, 17
    v_lshlrev_b16 v14, 8, v14
    v_lshrrev_b32 v13, 2, v53
    v_or_b32 v49, v12, v11
    v_bitop3_b32 v53, v5, v13, v14 bitop3:0xea
    ds_add_u32 v53, v2
    v_cvt_pk_bf16_f32 v44, v7, v8
    v_perm_b32 v12, v44, v44, s41
    v_bitop3_b32 v48, v4, v12, v48 bitop3:0xca
    v_perm_b32 v13, v44, v44, s42
    v_bitop3_b32 v49, v4, v13, v49 bitop3:0xca
    v_mul_hi_u32_u24 v14, 429497, v50
    v_lshrrev_b32 v12, 3, v54
    v_cos_f32 v9, v9
    v_lshlrev_b16 v13, 3, v54
    v_mad_i32_i24 v11, v14, s55, v50
    v_bitop3_b32 v12, v6, v13, v12 bitop3:0xca
    v_add_lshl_u32 v11, v11, s40, 17
    v_lshlrev_b16 v14, 8, v14
    v_lshrrev_b32 v13, 2, v54
    v_or_b32 v50, v12, v11
    v_bitop3_b32 v54, v5, v13, v14 bitop3:0xea
    ds_add_u32 v54, v2
    v_mul_hi_u32_u24 v14, 429497, v51
    v_lshrrev_b32 v12, 3, v55
    v_cos_f32 v10, v10
    v_lshlrev_b16 v13, 3, v55
    v_mad_i32_i24 v11, v14, s55, v51
    v_bitop3_b32 v12, v6, v13, v12 bitop3:0xca
    v_add_lshl_u32 v11, v11, s40, 17
    v_lshlrev_b16 v14, 8, v14
    v_lshrrev_b32 v13, 2, v55
    v_or_b32 v51, v12, v11
    v_bitop3_b32 v55, v5, v13, v14 bitop3:0xea
    ds_add_u32 v55, v2
    v_cvt_pk_bf16_f32 v45, v9, v10
    v_perm_b32 v12, v45, v45, s41
    v_bitop3_b32 v50, v4, v12, v50 bitop3:0xca
    v_perm_b32 v13, v45, v45, s42
    v_bitop3_b32 v51, v4, v13, v51 bitop3:0xca
    s_waitcnt vmcnt(4)
    v_lshlrev_b32 v7, 16, v46
    v_and_b32 v8, 0xffff0000, v46
    v_lshlrev_b32 v9, 16, v47
    v_and_b32 v10, 0xffff0000, v47
    v_mul_f32 v7, 0.15915494, v7
    v_mul_f32 v8, 0.15915494, v8
    v_mul_f32 v9, 0.15915494, v9
    v_mul_f32 v10, 0.15915494, v10
    v_mul_hi_u32_u24 v14, 429497, v56
    v_lshrrev_b32 v12, 3, v60
    v_cos_f32 v7, v7
    v_lshlrev_b16 v13, 3, v60
    v_mad_i32_i24 v11, v14, s55, v56
    v_bitop3_b32 v12, v6, v13, v12 bitop3:0xca
    v_add_lshl_u32 v11, v11, s40, 17
    v_lshlrev_b16 v14, 8, v14
    v_lshrrev_b32 v13, 2, v60
    v_or_b32 v56, v12, v11
    v_bitop3_b32 v60, v5, v13, v14 bitop3:0xea
    ds_add_u32 v60, v2
    v_mul_hi_u32_u24 v14, 429497, v57
    v_lshrrev_b32 v12, 3, v61
    v_cos_f32 v8, v8
    v_lshlrev_b16 v13, 3, v61
    v_mad_i32_i24 v11, v14, s55, v57
    v_bitop3_b32 v12, v6, v13, v12 bitop3:0xca
    v_add_lshl_u32 v11, v11, s40, 17
    v_lshlrev_b16 v14, 8, v14
    v_lshrrev_b32 v13, 2, v61
    v_or_b32 v57, v12, v11
    v_bitop3_b32 v61, v5, v13, v14 bitop3:0xea
    ds_add_u32 v61, v2
    v_cvt_pk_bf16_f32 v46, v7, v8
    v_perm_b32 v12, v46, v46, s41
    v_bitop3_b32 v56, v4, v12, v56 bitop3:0xca
    v_perm_b32 v13, v46, v46, s42
    v_bitop3_b32 v57, v4, v13, v57 bitop3:0xca
    v_mul_hi_u32_u24 v14, 429497, v58
    v_lshrrev_b32 v12, 3, v62
    v_cos_f32 v9, v9
    v_lshlrev_b16 v13, 3, v62
    v_mad_i32_i24 v11, v14, s55, v58
    v_bitop3_b32 v12, v6, v13, v12 bitop3:0xca
    v_add_lshl_u32 v11, v11, s40, 17
    v_lshlrev_b16 v14, 8, v14
    v_lshrrev_b32 v13, 2, v62
    v_or_b32 v58, v12, v11
    v_bitop3_b32 v62, v5, v13, v14 bitop3:0xea
    ds_add_u32 v62, v2
    v_mul_hi_u32_u24 v14, 429497, v59
    v_lshrrev_b32 v12, 3, v63
    v_cos_f32 v10, v10
    v_lshlrev_b16 v13, 3, v63
    v_mad_i32_i24 v11, v14, s55, v59
    v_bitop3_b32 v12, v6, v13, v12 bitop3:0xca
    v_add_lshl_u32 v11, v11, s40, 17
    v_lshlrev_b16 v14, 8, v14
    v_lshrrev_b32 v13, 2, v63
    v_or_b32 v59, v12, v11
    v_bitop3_b32 v63, v5, v13, v14 bitop3:0xea
    ds_add_u32 v63, v2
    v_cvt_pk_bf16_f32 v47, v9, v10
    v_perm_b32 v12, v47, v47, s41
    v_bitop3_b32 v58, v4, v12, v58 bitop3:0xca
    v_perm_b32 v13, v47, v47, s42
    v_bitop3_b32 v59, v4, v13, v59 bitop3:0xca
    v_lshrrev_b32 v8, 2, v0
    v_and_b32 v7, 0x3c00, v0
    v_bitop3_b32 v7, v5, v8, v7 bitop3:0xea
    s_waitcnt lgkmcnt(0)
    s_barrier
    ds_read2st64_b32 v[8:9], v7 offset0:0 offset1:1
    ds_read2st64_b32 v[10:11], v7 offset0:2 offset1:3
    s_add_u32 s47, s35, 0x10000
    buffer_store_dwordx4 v[64:67], v0, s[20:23], s47 offen sc1
    s_add_u32 s44, s34, 0x2000000
    s_nop 0
    buffer_load_dwordx2 v[64:65], v1, s[16:19], s44 offen nt
    s_add_u32 s45, s34, 0x2200000
    buffer_load_dwordx2 v[66:67], v1, s[16:19], s45 offen nt
    s_waitcnt lgkmcnt(0)
    v_lshl_or_b32 v12, v9, 16, v8
    v_lshl_or_b32 v13, v11, 16, v10
    v_mov_b32 v14, v12
    v_mov_b32 v15, v13
    s_nop 0
    v_add_u32_dpp v14, v14, v14 row_shr:1 row_mask:0xf bank_mask:0xf bound_ctrl:1
    v_add_u32_dpp v15, v15, v15 row_shr:1 row_mask:0xf bank_mask:0xf bound_ctrl:1
    s_nop 0
    v_add_u32_dpp v14, v14, v14 row_shr:2 row_mask:0xf bank_mask:0xf bound_ctrl:1
    v_add_u32_dpp v15, v15, v15 row_shr:2 row_mask:0xf bank_mask:0xf bound_ctrl:1
    s_nop 0
    v_add_u32_dpp v14, v14, v14 row_shr:4 row_mask:0xf bank_mask:0xf bound_ctrl:1
    v_add_u32_dpp v15, v15, v15 row_shr:4 row_mask:0xf bank_mask:0xf bound_ctrl:1
    s_nop 0
    v_add_u32_dpp v14, v14, v14 row_shr:8 row_mask:0xf bank_mask:0xf bound_ctrl:1
    v_add_u32_dpp v15, v15, v15 row_shr:8 row_mask:0xf bank_mask:0xf bound_ctrl:1
    s_nop 0
    v_add_u32_dpp v14, v14, v14 row_bcast:15 row_mask:0xa bank_mask:0xf
    v_add_u32_dpp v15, v15, v15 row_bcast:15 row_mask:0xa bank_mask:0xf
    s_nop 0
    v_add_u32_dpp v14, v14, v14 row_bcast:31 row_mask:0xc bank_mask:0xf
    v_add_u32_dpp v15, v15, v15 row_bcast:31 row_mask:0xc bank_mask:0xf
    v_readlane_b32 s48, v14, 63
    v_readlane_b32 s49, v15, 63
    s_lshl_b32 s54, s32, 2
    v_mov_b32 v8, s54
    s_and_b32 s50, s48, 0xffff
    s_lshr_b32 s51, s48, 16
    s_and_b32 s52, s49, 0xffff
    s_lshr_b32 s53, s49, 16
    s_add_u32 s51, s51, s50
    s_add_u32 s52, s52, s51
    s_add_u32 s53, s53, s52
    v_mov_b32 v9, s53
    s_mov_b64 exec, 1
    ds_write_b32 v8, v9 offset:16384
    s_mov_b64 exec, -1
    v_and_b32 v8, 60, v7
    s_waitcnt lgkmcnt(0)
    s_barrier
    ds_read_b32 v9, v8 offset:16384
    s_waitcnt lgkmcnt(0)
    v_add_u32_dpp v9, v9, v9 row_shr:1 row_mask:0xf bank_mask:0xf bound_ctrl:1
    s_nop 1
    v_add_u32_dpp v9, v9, v9 row_shr:2 row_mask:0xf bank_mask:0xf bound_ctrl:1
    s_nop 1
    v_add_u32_dpp v9, v9, v9 row_shr:4 row_mask:0xf bank_mask:0xf bound_ctrl:1
    s_nop 1
    v_add_u32_dpp v9, v9, v9 row_shr:8 row_mask:0xf bank_mask:0xf bound_ctrl:1
    s_nop 0
    v_readlane_b32 s54, v9, s32
    s_sub_u32 s54, s54, s53
    s_add_u32 s50, s50, s54
    s_add_u32 s51, s51, s54
    s_add_u32 s52, s52, s54
    s_pack_ll_b32_b16 s48, s54, s50
    s_pack_ll_b32_b16 s49, s51, s52
    v_add_u32 v14, s48, v14
    v_add_u32 v15, s49, v15
    v_sub_u32 v12, v14, v12
    v_sub_u32 v13, v15, v13
    v_and_b32 v8, 0xffff, v12
    v_lshrrev_b32 v9, 16, v12
    v_and_b32 v10, 0xffff, v13
    v_lshrrev_b32 v11, 16, v13
    ds_write2st64_b32 v7, v8, v9 offset0:0 offset1:1
    ds_write2st64_b32 v7, v10, v11 offset0:2 offset1:3
    s_waitcnt lgkmcnt(0)
    s_barrier
    ds_add_rtn_u32 v100, v100, v2
    ds_add_rtn_u32 v101, v101, v2
    ds_add_rtn_u32 v102, v102, v2
    ds_add_rtn_u32 v103, v103, v2
    s_add_u32 s46, s36, 0x2a40000
    v_and_b32 v11, 0x3f0, v0
    v_add_u32 v11, v11, v11
    buffer_store_dwordx2 v[12:13], v11, s[24:27], s46 offen
    s_bitset0_b64 exec, 63
    s_not_b64 exec, exec
    buffer_store_dwordx2 v[14:15], v11, s[24:27], s46 offen offset:32
    s_mov_b64 exec, -1
    ds_add_rtn_u32 v112, v112, v2
    ds_add_rtn_u32 v113, v113, v2
    ds_add_rtn_u32 v114, v114, v2
    ds_add_rtn_u32 v115, v115, v2
    ds_add_rtn_u32 v120, v120, v2
    ds_add_rtn_u32 v121, v121, v2
    ds_add_rtn_u32 v122, v122, v2
    ds_add_rtn_u32 v123, v123, v2
    s_add_u32 s47, s35, 0x14000
    buffer_store_dwordx4 v[76:79], v0, s[20:23], s47 offen sc1
    s_add_u32 s44, s33, 0x4400000
    s_nop 0
    buffer_load_dwordx4 v[76:79], v0, s[8:11], s44 offen nt
    ds_add_rtn_u32 v20, v20, v2
    ds_add_rtn_u32 v21, v21, v2
    ds_add_rtn_u32 v22, v22, v2
    ds_add_rtn_u32 v23, v23, v2
    ds_add_rtn_u32 v32, v32, v2
    ds_add_rtn_u32 v33, v33, v2
    ds_add_rtn_u32 v34, v34, v2
    ds_add_rtn_u32 v35, v35, v2
    ds_add_rtn_u32 v40, v40, v2
    ds_add_rtn_u32 v41, v41, v2
    ds_add_rtn_u32 v42, v42, v2
    ds_add_rtn_u32 v43, v43, v2
    s_add_u32 s45, s35, 0x18000
    buffer_store_dwordx4 v[80:83], v0, s[20:23], s45 offen sc1
    s_add_u32 s46, s33, 0x4400000
    s_nop 0
    buffer_load_dwordx4 v[80:83], v0, s[12:15], s46 offen nt
    ds_add_rtn_u32 v52, v52, v2
    ds_add_rtn_u32 v53, v53, v2
    ds_add_rtn_u32 v54, v54, v2
    ds_add_rtn_u32 v55, v55, v2
    ds_add_rtn_u32 v60, v60, v2
    ds_add_rtn_u32 v61, v61, v2
    ds_add_rtn_u32 v62, v62, v2
    ds_add_rtn_u32 v63, v63, v2
    s_waitcnt lgkmcnt(0)
    s_barrier
    v_and_b32 v7, -4, v100
    v_lshl_add_u32 v8, v100, 2, v7
    ds_write_b32 v8, v96
    v_lshl_add_u32 v7, v7, 2, v100
    ds_write_b8 v7, v104 offset:16
    v_and_b32 v9, -4, v101
    v_lshl_add_u32 v10, v101, 2, v9
    ds_write_b32 v10, v97
    v_lshl_add_u32 v9, v9, 2, v101
    ds_write_b8_d16_hi v9, v104 offset:16
    v_and_b32 v7, -4, v102
    v_lshl_add_u32 v8, v102, 2, v7
    ds_write_b32 v8, v98
    v_lshl_add_u32 v7, v7, 2, v102
    ds_write_b8 v7, v105 offset:16
    v_and_b32 v9, -4, v103
    v_lshl_add_u32 v10, v103, 2, v9
    ds_write_b32 v10, v99
    v_lshl_add_u32 v9, v9, 2, v103
    ds_write_b8_d16_hi v9, v105 offset:16
    s_add_u32 s47, s35, 0x1c000
    buffer_store_dwordx4 v[88:91], v0, s[20:23], s47 offen sc1
    s_add_u32 s44, s33, 0x4800000
    buffer_load_dwordx4 v[96:99], v0, s[8:11], s44 offen nt
    s_add_u32 s45, s33, 0x4800000
    buffer_load_dwordx4 v[100:103], v0, s[12:15], s45 offen nt
    v_and_b32 v7, -4, v112
    v_lshl_add_u32 v8, v112, 2, v7
    ds_write_b32 v8, v108
    v_lshl_add_u32 v7, v7, 2, v112
    ds_write_b8 v7, v106 offset:16
    v_and_b32 v9, -4, v113
    v_lshl_add_u32 v10, v113, 2, v9
    ds_write_b32 v10, v109
    v_lshl_add_u32 v9, v9, 2, v113
    ds_write_b8_d16_hi v9, v106 offset:16
    v_and_b32 v7, -4, v114
    v_lshl_add_u32 v8, v114, 2, v7
    ds_write_b32 v8, v110
    v_lshl_add_u32 v7, v7, 2, v114
    ds_write_b8 v7, v107 offset:16
    v_and_b32 v9, -4, v115
    v_lshl_add_u32 v10, v115, 2, v9
    ds_write_b32 v10, v111
    v_lshl_add_u32 v9, v9, 2, v115
    ds_write_b8_d16_hi v9, v107 offset:16
    s_add_u32 s46, s34, 0x2400000
    buffer_load_dwordx2 v[88:89], v1, s[16:19], s46 offen nt
    s_add_u32 s47, s34, 0x2600000
    buffer_load_dwordx2 v[90:91], v1, s[16:19], s47 offen nt
    s_add_u32 s44, s33, 0x4c00000
    buffer_load_dwordx4 v[108:111], v0, s[8:11], s44 offen nt
    v_and_b32 v7, -4, v120
    v_lshl_add_u32 v8, v120, 2, v7
    ds_write_b32 v8, v116
    v_lshl_add_u32 v7, v7, 2, v120
    ds_write_b8 v7, v124 offset:16
    v_and_b32 v9, -4, v121
    v_lshl_add_u32 v10, v121, 2, v9
    ds_write_b32 v10, v117
    v_lshl_add_u32 v9, v9, 2, v121
    ds_write_b8_d16_hi v9, v124 offset:16
    v_and_b32 v7, -4, v122
    v_lshl_add_u32 v8, v122, 2, v7
    ds_write_b32 v8, v118
    v_lshl_add_u32 v7, v7, 2, v122
    ds_write_b8 v7, v125 offset:16
    v_and_b32 v9, -4, v123
    v_lshl_add_u32 v10, v123, 2, v9
    ds_write_b32 v10, v119
    v_lshl_add_u32 v9, v9, 2, v123
    ds_write_b8_d16_hi v9, v125 offset:16
    s_add_u32 s45, s35, 0x20000
    buffer_store_dwordx4 v[92:95], v0, s[20:23], s45 offen sc1
    s_add_u32 s46, s33, 0x4c00000
    buffer_load_dwordx4 v[112:115], v0, s[12:15], s46 offen nt
    v_and_b32 v7, -4, v20
    v_lshl_add_u32 v8, v20, 2, v7
    ds_write_b32 v8, v16
    v_lshl_add_u32 v7, v7, 2, v20
    ds_write_b8 v7, v126 offset:16
    v_and_b32 v9, -4, v21
    v_lshl_add_u32 v10, v21, 2, v9
    ds_write_b32 v10, v17
    v_lshl_add_u32 v9, v9, 2, v21
    ds_write_b8_d16_hi v9, v126 offset:16
    v_and_b32 v7, -4, v22
    v_lshl_add_u32 v8, v22, 2, v7
    ds_write_b32 v8, v18
    v_lshl_add_u32 v7, v7, 2, v22
    ds_write_b8 v7, v127 offset:16
    v_and_b32 v9, -4, v23
    v_lshl_add_u32 v10, v23, 2, v9
    ds_write_b32 v10, v19
    v_lshl_add_u32 v9, v9, 2, v23
    ds_write_b8_d16_hi v9, v127 offset:16
    s_add_u32 s47, s33, 0x5000000
    buffer_load_dwordx4 v[104:107], v0, s[8:11], s47 offen nt
    s_add_u32 s44, s33, 0x5000000
    buffer_load_dwordx4 v[116:119], v0, s[12:15], s44 offen nt
    v_and_b32 v7, -4, v32
    v_lshl_add_u32 v8, v32, 2, v7
    ds_write_b32 v8, v28
    v_lshl_add_u32 v7, v7, 2, v32
    ds_write_b8 v7, v24 offset:16
    v_and_b32 v9, -4, v33
    v_lshl_add_u32 v10, v33, 2, v9
    ds_write_b32 v10, v29
    v_lshl_add_u32 v9, v9, 2, v33
    ds_write_b8_d16_hi v9, v24 offset:16
    v_and_b32 v7, -4, v34
    v_lshl_add_u32 v8, v34, 2, v7
    ds_write_b32 v8, v30
    v_lshl_add_u32 v7, v7, 2, v34
    ds_write_b8 v7, v25 offset:16
    v_and_b32 v9, -4, v35
    v_lshl_add_u32 v10, v35, 2, v9
    ds_write_b32 v10, v31
    v_lshl_add_u32 v9, v9, 2, v35
    ds_write_b8_d16_hi v9, v25 offset:16
    s_add_u32 s45, s34, 0x2800000
    buffer_load_dwordx2 v[120:121], v1, s[16:19], s45 offen nt
    s_add_u32 s46, s34, 0x2a00000
    buffer_load_dwordx2 v[122:123], v1, s[16:19], s46 offen nt
    s_add_u32 s47, s33, 0x5400000
    buffer_load_dwordx4 v[92:95], v0, s[8:11], s47 offen nt
    v_and_b32 v7, -4, v40
    v_lshl_add_u32 v8, v40, 2, v7
    ds_write_b32 v8, v36
    v_lshl_add_u32 v7, v7, 2, v40
    ds_write_b8 v7, v26 offset:16
    v_and_b32 v9, -4, v41
    v_lshl_add_u32 v10, v41, 2, v9
    ds_write_b32 v10, v37
    v_lshl_add_u32 v9, v9, 2, v41
    ds_write_b8_d16_hi v9, v26 offset:16
    v_and_b32 v7, -4, v42
    v_lshl_add_u32 v8, v42, 2, v7
    ds_write_b32 v8, v38
    v_lshl_add_u32 v7, v7, 2, v42
    ds_write_b8 v7, v27 offset:16
    v_and_b32 v9, -4, v43
    v_lshl_add_u32 v10, v43, 2, v9
    ds_write_b32 v10, v39
    v_lshl_add_u32 v9, v9, 2, v43
    ds_write_b8_d16_hi v9, v27 offset:16
    s_add_u32 s44, s35, 0x24000
    buffer_store_dwordx4 v[84:87], v0, s[20:23], s44 offen sc1
    s_add_u32 s45, s33, 0x5400000
    buffer_load_dwordx4 v[16:19], v0, s[12:15], s45 offen nt
    v_and_b32 v7, -4, v52
    v_lshl_add_u32 v8, v52, 2, v7
    ds_write_b32 v8, v48
    v_lshl_add_u32 v7, v7, 2, v52
    ds_write_b8 v7, v44 offset:16
    v_and_b32 v9, -4, v53
    v_lshl_add_u32 v10, v53, 2, v9
    ds_write_b32 v10, v49
    v_lshl_add_u32 v9, v9, 2, v53
    ds_write_b8_d16_hi v9, v44 offset:16
    v_and_b32 v7, -4, v54
    v_lshl_add_u32 v8, v54, 2, v7
    ds_write_b32 v8, v50
    v_lshl_add_u32 v7, v7, 2, v54
    ds_write_b8 v7, v45 offset:16
    v_and_b32 v9, -4, v55
    v_lshl_add_u32 v10, v55, 2, v9
    ds_write_b32 v10, v51
    v_lshl_add_u32 v9, v9, 2, v55
    ds_write_b8_d16_hi v9, v45 offset:16
    s_add_u32 s46, s33, 0x5800000
    buffer_load_dwordx4 v[20:23], v0, s[8:11], s46 offen nt
    s_add_u32 s47, s33, 0x5800000
    buffer_load_dwordx4 v[124:127], v0, s[12:15], s47 offen nt
    v_and_b32 v7, -4, v60
    v_lshl_add_u32 v8, v60, 2, v7
    ds_write_b32 v8, v56
    v_lshl_add_u32 v7, v7, 2, v60
    ds_write_b8 v7, v46 offset:16
    v_and_b32 v9, -4, v61
    v_lshl_add_u32 v10, v61, 2, v9
    ds_write_b32 v10, v57
    v_lshl_add_u32 v9, v9, 2, v61
    ds_write_b8_d16_hi v9, v46 offset:16
    v_and_b32 v7, -4, v62
    v_lshl_add_u32 v8, v62, 2, v7
    ds_write_b32 v8, v58
    v_lshl_add_u32 v7, v7, 2, v62
    ds_write_b8 v7, v47 offset:16
    v_and_b32 v9, -4, v63
    v_lshl_add_u32 v10, v63, 2, v9
    ds_write_b32 v10, v59
    v_lshl_add_u32 v9, v9, 2, v63
    ds_write_b8_d16_hi v9, v47 offset:16
    s_add_u32 s44, s34, 0x2c00000
    buffer_load_dwordx2 v[28:29], v1, s[16:19], s44 offen nt
    s_add_u32 s45, s34, 0x2e00000
    buffer_load_dwordx2 v[30:31], v1, s[16:19], s45 offen nt
    v_add_u32 v7, 0x10000, v0
    v_add_u32 v12, 0x20000, v0
    v_mov_b32 v8, 0
    v_mov_b32 v9, 0
    v_mov_b32 v10, 0
    v_mov_b32 v11, 0
    s_waitcnt lgkmcnt(0)
    s_barrier
    ds_read_b128 v[32:35], v0 offset:0
    ds_write_b128 v0, v[8:11]
    ds_read_b128 v[36:39], v0 offset:16384
    ds_read_b128 v[40:43], v0 offset:32768
    ds_read_b128 v[24:27], v0 offset:49152
    ds_read_b128 v[84:87], v7 offset:0
    ds_read_b128 v[48:51], v7 offset:16384
    ds_read_b128 v[52:55], v7 offset:32768
    ds_read_b128 v[56:59], v7 offset:49152
    ds_read_b128 v[60:63], v12 offset:0
    ds_read_b128 v[44:47], v12 offset:16384
    s_waitcnt lgkmcnt(0)
    s_barrier
    s_add_u32 s46, s35, 0x2a40000
    buffer_store_dwordx4 v[32:35], v0, s[20:23], s46 offen sc1
    s_add_u32 s47, s33, 0x5c00000
    s_nop 0
    buffer_load_dwordx4 v[32:35], v0, s[8:11], s47 offen nt
    s_add_u32 s44, s35, 0x2a44000
    buffer_store_dwordx4 v[36:39], v0, s[20:23], s44 offen sc1
    s_add_u32 s45, s33, 0x5c00000
    s_nop 0
    buffer_load_dwordx4 v[36:39], v0, s[12:15], s45 offen nt
    s_waitcnt vmcnt(29)
    v_lshlrev_b32 v7, 16, v64
    v_and_b32 v8, 0xffff0000, v64
    v_lshlrev_b32 v9, 16, v65
    v_and_b32 v10, 0xffff0000, v65
    v_mul_f32 v7, 0.15915494, v7
    v_mul_f32 v8, 0.15915494, v8
    v_mul_f32 v9, 0.15915494, v9
    v_mul_f32 v10, 0.15915494, v10
    v_mul_hi_u32_u24 v14, 429497, v68
    v_lshrrev_b32 v12, 3, v72
    v_cos_f32 v7, v7
    v_lshlrev_b16 v13, 3, v72
    v_mad_i32_i24 v11, v14, s55, v68
    v_bitop3_b32 v12, v6, v13, v12 bitop3:0xca
    v_add_lshl_u32 v11, v11, s40, 17
    v_lshlrev_b16 v14, 8, v14
    v_lshrrev_b32 v13, 2, v72
    v_or_b32 v68, v12, v11
    v_bitop3_b32 v72, v5, v13, v14 bitop3:0xea
    ds_add_u32 v72, v2
    v_mul_hi_u32_u24 v14, 429497, v69
    v_lshrrev_b32 v12, 3, v73
    v_cos_f32 v8, v8
    v_lshlrev_b16 v13, 3, v73
    v_mad_i32_i24 v11, v14, s55, v69
    v_bitop3_b32 v12, v6, v13, v12 bitop3:0xca
    v_add_lshl_u32 v11, v11, s40, 17
    v_lshlrev_b16 v14, 8, v14
    v_lshrrev_b32 v13, 2, v73
    v_or_b32 v69, v12, v11
    v_bitop3_b32 v73, v5, v13, v14 bitop3:0xea
    ds_add_u32 v73, v2
    v_cvt_pk_bf16_f32 v64, v7, v8
    v_perm_b32 v12, v64, v64, s41
    v_bitop3_b32 v68, v4, v12, v68 bitop3:0xca
    v_perm_b32 v13, v64, v64, s42
    v_bitop3_b32 v69, v4, v13, v69 bitop3:0xca
    v_mul_hi_u32_u24 v14, 429497, v70
    v_lshrrev_b32 v12, 3, v74
    v_cos_f32 v9, v9
    v_lshlrev_b16 v13, 3, v74
    v_mad_i32_i24 v11, v14, s55, v70
    v_bitop3_b32 v12, v6, v13, v12 bitop3:0xca
    v_add_lshl_u32 v11, v11, s40, 17
    v_lshlrev_b16 v14, 8, v14
    v_lshrrev_b32 v13, 2, v74
    v_or_b32 v70, v12, v11
    v_bitop3_b32 v74, v5, v13, v14 bitop3:0xea
    ds_add_u32 v74, v2
    v_mul_hi_u32_u24 v14, 429497, v71
    v_lshrrev_b32 v12, 3, v75
    v_cos_f32 v10, v10
    v_lshlrev_b16 v13, 3, v75
    v_mad_i32_i24 v11, v14, s55, v71
    v_bitop3_b32 v12, v6, v13, v12 bitop3:0xca
    v_add_lshl_u32 v11, v11, s40, 17
    v_lshlrev_b16 v14, 8, v14
    v_lshrrev_b32 v13, 2, v75
    v_or_b32 v71, v12, v11
    v_bitop3_b32 v75, v5, v13, v14 bitop3:0xea
    ds_add_u32 v75, v2
    v_cvt_pk_bf16_f32 v65, v9, v10
    v_perm_b32 v12, v65, v65, s41
    v_bitop3_b32 v70, v4, v12, v70 bitop3:0xca
    v_perm_b32 v13, v65, v65, s42
    v_bitop3_b32 v71, v4, v13, v71 bitop3:0xca
    s_waitcnt vmcnt(23)
    v_lshlrev_b32 v7, 16, v66
    v_and_b32 v8, 0xffff0000, v66
    v_lshlrev_b32 v9, 16, v67
    v_and_b32 v10, 0xffff0000, v67
    v_mul_f32 v7, 0.15915494, v7
    v_mul_f32 v8, 0.15915494, v8
    v_mul_f32 v9, 0.15915494, v9
    v_mul_f32 v10, 0.15915494, v10
    v_mul_hi_u32_u24 v14, 429497, v76
    v_lshrrev_b32 v12, 3, v80
    v_cos_f32 v7, v7
    v_lshlrev_b16 v13, 3, v80
    v_mad_i32_i24 v11, v14, s55, v76
    v_bitop3_b32 v12, v6, v13, v12 bitop3:0xca
    v_add_lshl_u32 v11, v11, s40, 17
    v_lshlrev_b16 v14, 8, v14
    v_lshrrev_b32 v13, 2, v80
    v_or_b32 v76, v12, v11
    v_bitop3_b32 v80, v5, v13, v14 bitop3:0xea
    ds_add_u32 v80, v2
    v_mul_hi_u32_u24 v14, 429497, v77
    v_lshrrev_b32 v12, 3, v81
    v_cos_f32 v8, v8
    v_lshlrev_b16 v13, 3, v81
    v_mad_i32_i24 v11, v14, s55, v77
    v_bitop3_b32 v12, v6, v13, v12 bitop3:0xca
    v_add_lshl_u32 v11, v11, s40, 17
    v_lshlrev_b16 v14, 8, v14
    v_lshrrev_b32 v13, 2, v81
    v_or_b32 v77, v12, v11
    v_bitop3_b32 v81, v5, v13, v14 bitop3:0xea
    ds_add_u32 v81, v2
    v_cvt_pk_bf16_f32 v66, v7, v8
    v_perm_b32 v12, v66, v66, s41
    v_bitop3_b32 v76, v4, v12, v76 bitop3:0xca
    v_perm_b32 v13, v66, v66, s42
    v_bitop3_b32 v77, v4, v13, v77 bitop3:0xca
    v_mul_hi_u32_u24 v14, 429497, v78
    v_lshrrev_b32 v12, 3, v82
    v_cos_f32 v9, v9
    v_lshlrev_b16 v13, 3, v82
    v_mad_i32_i24 v11, v14, s55, v78
    v_bitop3_b32 v12, v6, v13, v12 bitop3:0xca
    v_add_lshl_u32 v11, v11, s40, 17
    v_lshlrev_b16 v14, 8, v14
    v_lshrrev_b32 v13, 2, v82
    v_or_b32 v78, v12, v11
    v_bitop3_b32 v82, v5, v13, v14 bitop3:0xea
    ds_add_u32 v82, v2
    v_mul_hi_u32_u24 v14, 429497, v79
    v_lshrrev_b32 v12, 3, v83
    v_cos_f32 v10, v10
    v_lshlrev_b16 v13, 3, v83
    v_mad_i32_i24 v11, v14, s55, v79
    v_bitop3_b32 v12, v6, v13, v12 bitop3:0xca
    v_add_lshl_u32 v11, v11, s40, 17
    v_lshlrev_b16 v14, 8, v14
    v_lshrrev_b32 v13, 2, v83
    v_or_b32 v79, v12, v11
    v_bitop3_b32 v83, v5, v13, v14 bitop3:0xea
    ds_add_u32 v83, v2
    v_cvt_pk_bf16_f32 v67, v9, v10
    v_perm_b32 v12, v67, v67, s41
    v_bitop3_b32 v78, v4, v12, v78 bitop3:0xca
    v_perm_b32 v13, v67, v67, s42
    v_bitop3_b32 v79, v4, v13, v79 bitop3:0xca
    s_waitcnt vmcnt(18)
    v_lshlrev_b32 v7, 16, v88
    v_and_b32 v8, 0xffff0000, v88
    v_lshlrev_b32 v9, 16, v89
    v_and_b32 v10, 0xffff0000, v89
    v_mul_f32 v7, 0.15915494, v7
    v_mul_f32 v8, 0.15915494, v8
    v_mul_f32 v9, 0.15915494, v9
    v_mul_f32 v10, 0.15915494, v10
    v_mul_hi_u32_u24 v14, 429497, v96
    v_lshrrev_b32 v12, 3, v100
    v_cos_f32 v7, v7
    v_lshlrev_b16 v13, 3, v100
    v_mad_i32_i24 v11, v14, s55, v96
    v_bitop3_b32 v12, v6, v13, v12 bitop3:0xca
    v_add_lshl_u32 v11, v11, s40, 17
    v_lshlrev_b16 v14, 8, v14
    v_lshrrev_b32 v13, 2, v100
    v_or_b32 v96, v12, v11
    v_bitop3_b32 v100, v5, v13, v14 bitop3:0xea
    ds_add_u32 v100, v2
    v_mul_hi_u32_u24 v14, 429497, v97
    v_lshrrev_b32 v12, 3, v101
    v_cos_f32 v8, v8
    v_lshlrev_b16 v13, 3, v101
    v_mad_i32_i24 v11, v14, s55, v97
    v_bitop3_b32 v12, v6, v13, v12 bitop3:0xca
    v_add_lshl_u32 v11, v11, s40, 17
    v_lshlrev_b16 v14, 8, v14
    v_lshrrev_b32 v13, 2, v101
    v_or_b32 v97, v12, v11
    v_bitop3_b32 v101, v5, v13, v14 bitop3:0xea
    ds_add_u32 v101, v2
    v_cvt_pk_bf16_f32 v88, v7, v8
    v_perm_b32 v12, v88, v88, s41
    v_bitop3_b32 v96, v4, v12, v96 bitop3:0xca
    v_perm_b32 v13, v88, v88, s42
    v_bitop3_b32 v97, v4, v13, v97 bitop3:0xca
    v_mul_hi_u32_u24 v14, 429497, v98
    v_lshrrev_b32 v12, 3, v102
    v_cos_f32 v9, v9
    v_lshlrev_b16 v13, 3, v102
    v_mad_i32_i24 v11, v14, s55, v98
    v_bitop3_b32 v12, v6, v13, v12 bitop3:0xca
    v_add_lshl_u32 v11, v11, s40, 17
    v_lshlrev_b16 v14, 8, v14
    v_lshrrev_b32 v13, 2, v102
    v_or_b32 v98, v12, v11
    v_bitop3_b32 v102, v5, v13, v14 bitop3:0xea
    ds_add_u32 v102, v2
    v_mul_hi_u32_u24 v14, 429497, v99
    v_lshrrev_b32 v12, 3, v103
    v_cos_f32 v10, v10
    v_lshlrev_b16 v13, 3, v103
    v_mad_i32_i24 v11, v14, s55, v99
    v_bitop3_b32 v12, v6, v13, v12 bitop3:0xca
    v_add_lshl_u32 v11, v11, s40, 17
    v_lshlrev_b16 v14, 8, v14
    v_lshrrev_b32 v13, 2, v103
    v_or_b32 v99, v12, v11
    v_bitop3_b32 v103, v5, v13, v14 bitop3:0xea
    ds_add_u32 v103, v2
    v_cvt_pk_bf16_f32 v89, v9, v10
    v_perm_b32 v12, v89, v89, s41
    v_bitop3_b32 v98, v4, v12, v98 bitop3:0xca
    v_perm_b32 v13, v89, v89, s42
    v_bitop3_b32 v99, v4, v13, v99 bitop3:0xca
    s_add_u32 s46, s35, 0x2a48000
    buffer_store_dwordx4 v[40:43], v0, s[20:23], s46 offen sc1
    s_add_u32 s47, s33, 0x6000000
    s_nop 0
    buffer_load_dwordx4 v[40:43], v0, s[8:11], s47 offen nt
    s_waitcnt vmcnt(17)
    v_lshlrev_b32 v7, 16, v90
    v_and_b32 v8, 0xffff0000, v90
    v_lshlrev_b32 v9, 16, v91
    v_and_b32 v10, 0xffff0000, v91
    v_mul_f32 v7, 0.15915494, v7
    v_mul_f32 v8, 0.15915494, v8
    v_mul_f32 v9, 0.15915494, v9
    v_mul_f32 v10, 0.15915494, v10
    v_mul_hi_u32_u24 v14, 429497, v108
    v_lshrrev_b32 v12, 3, v112
    v_cos_f32 v7, v7
    v_lshlrev_b16 v13, 3, v112
    v_mad_i32_i24 v11, v14, s55, v108
    v_bitop3_b32 v12, v6, v13, v12 bitop3:0xca
    v_add_lshl_u32 v11, v11, s40, 17
    v_lshlrev_b16 v14, 8, v14
    v_lshrrev_b32 v13, 2, v112
    v_or_b32 v108, v12, v11
    v_bitop3_b32 v112, v5, v13, v14 bitop3:0xea
    ds_add_u32 v112, v2
    v_mul_hi_u32_u24 v14, 429497, v109
    v_lshrrev_b32 v12, 3, v113
    v_cos_f32 v8, v8
    v_lshlrev_b16 v13, 3, v113
    v_mad_i32_i24 v11, v14, s55, v109
    v_bitop3_b32 v12, v6, v13, v12 bitop3:0xca
    v_add_lshl_u32 v11, v11, s40, 17
    v_lshlrev_b16 v14, 8, v14
    v_lshrrev_b32 v13, 2, v113
    v_or_b32 v109, v12, v11
    v_bitop3_b32 v113, v5, v13, v14 bitop3:0xea
    ds_add_u32 v113, v2
    v_cvt_pk_bf16_f32 v90, v7, v8
    v_perm_b32 v12, v90, v90, s41
    v_bitop3_b32 v108, v4, v12, v108 bitop3:0xca
    v_perm_b32 v13, v90, v90, s42
    v_bitop3_b32 v109, v4, v13, v109 bitop3:0xca
    v_mul_hi_u32_u24 v14, 429497, v110
    v_lshrrev_b32 v12, 3, v114
    v_cos_f32 v9, v9
    v_lshlrev_b16 v13, 3, v114
    v_mad_i32_i24 v11, v14, s55, v110
    v_bitop3_b32 v12, v6, v13, v12 bitop3:0xca
    v_add_lshl_u32 v11, v11, s40, 17
    v_lshlrev_b16 v14, 8, v14
    v_lshrrev_b32 v13, 2, v114
    v_or_b32 v110, v12, v11
    v_bitop3_b32 v114, v5, v13, v14 bitop3:0xea
    ds_add_u32 v114, v2
    v_mul_hi_u32_u24 v14, 429497, v111
    v_lshrrev_b32 v12, 3, v115
    v_cos_f32 v10, v10
    v_lshlrev_b16 v13, 3, v115
    v_mad_i32_i24 v11, v14, s55, v111
    v_bitop3_b32 v12, v6, v13, v12 bitop3:0xca
    v_add_lshl_u32 v11, v11, s40, 17
    v_lshlrev_b16 v14, 8, v14
    v_lshrrev_b32 v13, 2, v115
    v_or_b32 v111, v12, v11
    v_bitop3_b32 v115, v5, v13, v14 bitop3:0xea
    ds_add_u32 v115, v2
    v_cvt_pk_bf16_f32 v91, v9, v10
    v_perm_b32 v12, v91, v91, s41
    v_bitop3_b32 v110, v4, v12, v110 bitop3:0xca
    v_perm_b32 v13, v91, v91, s42
    v_bitop3_b32 v111, v4, v13, v111 bitop3:0xca
    s_waitcnt vmcnt(13)
    v_lshlrev_b32 v7, 16, v120
    v_and_b32 v8, 0xffff0000, v120
    v_lshlrev_b32 v9, 16, v121
    v_and_b32 v10, 0xffff0000, v121
    v_mul_f32 v7, 0.15915494, v7
    v_mul_f32 v8, 0.15915494, v8
    v_mul_f32 v9, 0.15915494, v9
    v_mul_f32 v10, 0.15915494, v10
    v_mul_hi_u32_u24 v14, 429497, v104
    v_lshrrev_b32 v12, 3, v116
    v_cos_f32 v7, v7
    v_lshlrev_b16 v13, 3, v116
    v_mad_i32_i24 v11, v14, s55, v104
    v_bitop3_b32 v12, v6, v13, v12 bitop3:0xca
    v_add_lshl_u32 v11, v11, s40, 17
    v_lshlrev_b16 v14, 8, v14
    v_lshrrev_b32 v13, 2, v116
    v_or_b32 v104, v12, v11
    v_bitop3_b32 v116, v5, v13, v14 bitop3:0xea
    ds_add_u32 v116, v2
    v_mul_hi_u32_u24 v14, 429497, v105
    v_lshrrev_b32 v12, 3, v117
    v_cos_f32 v8, v8
    v_lshlrev_b16 v13, 3, v117
    v_mad_i32_i24 v11, v14, s55, v105
    v_bitop3_b32 v12, v6, v13, v12 bitop3:0xca
    v_add_lshl_u32 v11, v11, s40, 17
    v_lshlrev_b16 v14, 8, v14
    v_lshrrev_b32 v13, 2, v117
    v_or_b32 v105, v12, v11
    v_bitop3_b32 v117, v5, v13, v14 bitop3:0xea
    ds_add_u32 v117, v2
    v_cvt_pk_bf16_f32 v120, v7, v8
    v_perm_b32 v12, v120, v120, s41
    v_bitop3_b32 v104, v4, v12, v104 bitop3:0xca
    v_perm_b32 v13, v120, v120, s42
    v_bitop3_b32 v105, v4, v13, v105 bitop3:0xca
    v_mul_hi_u32_u24 v14, 429497, v106
    v_lshrrev_b32 v12, 3, v118
    v_cos_f32 v9, v9
    v_lshlrev_b16 v13, 3, v118
    v_mad_i32_i24 v11, v14, s55, v106
    v_bitop3_b32 v12, v6, v13, v12 bitop3:0xca
    v_add_lshl_u32 v11, v11, s40, 17
    v_lshlrev_b16 v14, 8, v14
    v_lshrrev_b32 v13, 2, v118
    v_or_b32 v106, v12, v11
    v_bitop3_b32 v118, v5, v13, v14 bitop3:0xea
    ds_add_u32 v118, v2
    v_mul_hi_u32_u24 v14, 429497, v107
    v_lshrrev_b32 v12, 3, v119
    v_cos_f32 v10, v10
    v_lshlrev_b16 v13, 3, v119
    v_mad_i32_i24 v11, v14, s55, v107
    v_bitop3_b32 v12, v6, v13, v12 bitop3:0xca
    v_add_lshl_u32 v11, v11, s40, 17
    v_lshlrev_b16 v14, 8, v14
    v_lshrrev_b32 v13, 2, v119
    v_or_b32 v107, v12, v11
    v_bitop3_b32 v119, v5, v13, v14 bitop3:0xea
    ds_add_u32 v119, v2
    v_cvt_pk_bf16_f32 v121, v9, v10
    v_perm_b32 v12, v121, v121, s41
    v_bitop3_b32 v106, v4, v12, v106 bitop3:0xca
    v_perm_b32 v13, v121, v121, s42
    v_bitop3_b32 v107, v4, v13, v107 bitop3:0xca
    s_waitcnt vmcnt(10)
    v_lshlrev_b32 v7, 16, v122
    v_and_b32 v8, 0xffff0000, v122
    v_lshlrev_b32 v9, 16, v123
    v_and_b32 v10, 0xffff0000, v123
    v_mul_f32 v7, 0.15915494, v7
    v_mul_f32 v8, 0.15915494, v8
    v_mul_f32 v9, 0.15915494, v9
    v_mul_f32 v10, 0.15915494, v10
    v_mul_hi_u32_u24 v14, 429497, v92
    v_lshrrev_b32 v12, 3, v16
    v_cos_f32 v7, v7
    v_lshlrev_b16 v13, 3, v16
    v_mad_i32_i24 v11, v14, s55, v92
    v_bitop3_b32 v12, v6, v13, v12 bitop3:0xca
    v_add_lshl_u32 v11, v11, s40, 17
    v_lshlrev_b16 v14, 8, v14
    v_lshrrev_b32 v13, 2, v16
    v_or_b32 v92, v12, v11
    v_bitop3_b32 v16, v5, v13, v14 bitop3:0xea
    ds_add_u32 v16, v2
    v_mul_hi_u32_u24 v14, 429497, v93
    v_lshrrev_b32 v12, 3, v17
    v_cos_f32 v8, v8
    v_lshlrev_b16 v13, 3, v17
    v_mad_i32_i24 v11, v14, s55, v93
    v_bitop3_b32 v12, v6, v13, v12 bitop3:0xca
    v_add_lshl_u32 v11, v11, s40, 17
    v_lshlrev_b16 v14, 8, v14
    v_lshrrev_b32 v13, 2, v17
    v_or_b32 v93, v12, v11
    v_bitop3_b32 v17, v5, v13, v14 bitop3:0xea
    ds_add_u32 v17, v2
    v_cvt_pk_bf16_f32 v122, v7, v8
    v_perm_b32 v12, v122, v122, s41
    v_bitop3_b32 v92, v4, v12, v92 bitop3:0xca
    v_perm_b32 v13, v122, v122, s42
    v_bitop3_b32 v93, v4, v13, v93 bitop3:0xca
    v_mul_hi_u32_u24 v14, 429497, v94
    v_lshrrev_b32 v12, 3, v18
    v_cos_f32 v9, v9
    v_lshlrev_b16 v13, 3, v18
    v_mad_i32_i24 v11, v14, s55, v94
    v_bitop3_b32 v12, v6, v13, v12 bitop3:0xca
    v_add_lshl_u32 v11, v11, s40, 17
    v_lshlrev_b16 v14, 8, v14
    v_lshrrev_b32 v13, 2, v18
    v_or_b32 v94, v12, v11
    v_bitop3_b32 v18, v5, v13, v14 bitop3:0xea
    ds_add_u32 v18, v2
    v_mul_hi_u32_u24 v14, 429497, v95
    v_lshrrev_b32 v12, 3, v19
    v_cos_f32 v10, v10
    v_lshlrev_b16 v13, 3, v19
    v_mad_i32_i24 v11, v14, s55, v95
    v_bitop3_b32 v12, v6, v13, v12 bitop3:0xca
    v_add_lshl_u32 v11, v11, s40, 17
    v_lshlrev_b16 v14, 8, v14
    v_lshrrev_b32 v13, 2, v19
    v_or_b32 v95, v12, v11
    v_bitop3_b32 v19, v5, v13, v14 bitop3:0xea
    ds_add_u32 v19, v2
    v_cvt_pk_bf16_f32 v123, v9, v10
    v_perm_b32 v12, v123, v123, s41
    v_bitop3_b32 v94, v4, v12, v94 bitop3:0xca
    v_perm_b32 v13, v123, v123, s42
    v_bitop3_b32 v95, v4, v13, v95 bitop3:0xca
    s_add_u32 s44, s35, 0x2a4c000
    buffer_store_dwordx4 v[24:27], v0, s[20:23], s44 offen sc1
    s_add_u32 s45, s33, 0x6000000
    s_nop 0
    buffer_load_dwordx4 v[24:27], v0, s[12:15], s45 offen nt
    s_waitcnt vmcnt(8)
    v_lshlrev_b32 v7, 16, v28
    v_and_b32 v8, 0xffff0000, v28
    v_lshlrev_b32 v9, 16, v29
    v_and_b32 v10, 0xffff0000, v29
    v_mul_f32 v7, 0.15915494, v7
    v_mul_f32 v8, 0.15915494, v8
    v_mul_f32 v9, 0.15915494, v9
    v_mul_f32 v10, 0.15915494, v10
    v_mul_hi_u32_u24 v14, 429497, v20
    v_lshrrev_b32 v12, 3, v124
    v_cos_f32 v7, v7
    v_lshlrev_b16 v13, 3, v124
    v_mad_i32_i24 v11, v14, s55, v20
    v_bitop3_b32 v12, v6, v13, v12 bitop3:0xca
    v_add_lshl_u32 v11, v11, s40, 17
    v_lshlrev_b16 v14, 8, v14
    v_lshrrev_b32 v13, 2, v124
    v_or_b32 v20, v12, v11
    v_bitop3_b32 v124, v5, v13, v14 bitop3:0xea
    ds_add_u32 v124, v2
    v_mul_hi_u32_u24 v14, 429497, v21
    v_lshrrev_b32 v12, 3, v125
    v_cos_f32 v8, v8
    v_lshlrev_b16 v13, 3, v125
    v_mad_i32_i24 v11, v14, s55, v21
    v_bitop3_b32 v12, v6, v13, v12 bitop3:0xca
    v_add_lshl_u32 v11, v11, s40, 17
    v_lshlrev_b16 v14, 8, v14
    v_lshrrev_b32 v13, 2, v125
    v_or_b32 v21, v12, v11
    v_bitop3_b32 v125, v5, v13, v14 bitop3:0xea
    ds_add_u32 v125, v2
    v_cvt_pk_bf16_f32 v28, v7, v8
    v_perm_b32 v12, v28, v28, s41
    v_bitop3_b32 v20, v4, v12, v20 bitop3:0xca
    v_perm_b32 v13, v28, v28, s42
    v_bitop3_b32 v21, v4, v13, v21 bitop3:0xca
    v_mul_hi_u32_u24 v14, 429497, v22
    v_lshrrev_b32 v12, 3, v126
    v_cos_f32 v9, v9
    v_lshlrev_b16 v13, 3, v126
    v_mad_i32_i24 v11, v14, s55, v22
    v_bitop3_b32 v12, v6, v13, v12 bitop3:0xca
    v_add_lshl_u32 v11, v11, s40, 17
    v_lshlrev_b16 v14, 8, v14
    v_lshrrev_b32 v13, 2, v126
    v_or_b32 v22, v12, v11
    v_bitop3_b32 v126, v5, v13, v14 bitop3:0xea
    ds_add_u32 v126, v2
    v_mul_hi_u32_u24 v14, 429497, v23
    v_lshrrev_b32 v12, 3, v127
    v_cos_f32 v10, v10
    v_lshlrev_b16 v13, 3, v127
    v_mad_i32_i24 v11, v14, s55, v23
    v_bitop3_b32 v12, v6, v13, v12 bitop3:0xca
    v_add_lshl_u32 v11, v11, s40, 17
    v_lshlrev_b16 v14, 8, v14
    v_lshrrev_b32 v13, 2, v127
    v_or_b32 v23, v12, v11
    v_bitop3_b32 v127, v5, v13, v14 bitop3:0xea
    ds_add_u32 v127, v2
    v_cvt_pk_bf16_f32 v29, v9, v10
    v_perm_b32 v12, v29, v29, s41
    v_bitop3_b32 v22, v4, v12, v22 bitop3:0xca
    v_perm_b32 v13, v29, v29, s42
    v_bitop3_b32 v23, v4, v13, v23 bitop3:0xca
    s_waitcnt vmcnt(4)
    v_lshlrev_b32 v7, 16, v30
    v_and_b32 v8, 0xffff0000, v30
    v_lshlrev_b32 v9, 16, v31
    v_and_b32 v10, 0xffff0000, v31
    v_mul_f32 v7, 0.15915494, v7
    v_mul_f32 v8, 0.15915494, v8
    v_mul_f32 v9, 0.15915494, v9
    v_mul_f32 v10, 0.15915494, v10
    v_mul_hi_u32_u24 v14, 429497, v32
    v_lshrrev_b32 v12, 3, v36
    v_cos_f32 v7, v7
    v_lshlrev_b16 v13, 3, v36
    v_mad_i32_i24 v11, v14, s55, v32
    v_bitop3_b32 v12, v6, v13, v12 bitop3:0xca
    v_add_lshl_u32 v11, v11, s40, 17
    v_lshlrev_b16 v14, 8, v14
    v_lshrrev_b32 v13, 2, v36
    v_or_b32 v32, v12, v11
    v_bitop3_b32 v36, v5, v13, v14 bitop3:0xea
    ds_add_u32 v36, v2
    v_mul_hi_u32_u24 v14, 429497, v33
    v_lshrrev_b32 v12, 3, v37
    v_cos_f32 v8, v8
    v_lshlrev_b16 v13, 3, v37
    v_mad_i32_i24 v11, v14, s55, v33
    v_bitop3_b32 v12, v6, v13, v12 bitop3:0xca
    v_add_lshl_u32 v11, v11, s40, 17
    v_lshlrev_b16 v14, 8, v14
    v_lshrrev_b32 v13, 2, v37
    v_or_b32 v33, v12, v11
    v_bitop3_b32 v37, v5, v13, v14 bitop3:0xea
    ds_add_u32 v37, v2
    v_cvt_pk_bf16_f32 v30, v7, v8
    v_perm_b32 v12, v30, v30, s41
    v_bitop3_b32 v32, v4, v12, v32 bitop3:0xca
    v_perm_b32 v13, v30, v30, s42
    v_bitop3_b32 v33, v4, v13, v33 bitop3:0xca
    v_mul_hi_u32_u24 v14, 429497, v34
    v_lshrrev_b32 v12, 3, v38
    v_cos_f32 v9, v9
    v_lshlrev_b16 v13, 3, v38
    v_mad_i32_i24 v11, v14, s55, v34
    v_bitop3_b32 v12, v6, v13, v12 bitop3:0xca
    v_add_lshl_u32 v11, v11, s40, 17
    v_lshlrev_b16 v14, 8, v14
    v_lshrrev_b32 v13, 2, v38
    v_or_b32 v34, v12, v11
    v_bitop3_b32 v38, v5, v13, v14 bitop3:0xea
    ds_add_u32 v38, v2
    v_mul_hi_u32_u24 v14, 429497, v35
    v_lshrrev_b32 v12, 3, v39
    v_cos_f32 v10, v10
    v_lshlrev_b16 v13, 3, v39
    v_mad_i32_i24 v11, v14, s55, v35
    v_bitop3_b32 v12, v6, v13, v12 bitop3:0xca
    v_add_lshl_u32 v11, v11, s40, 17
    v_lshlrev_b16 v14, 8, v14
    v_lshrrev_b32 v13, 2, v39
    v_or_b32 v35, v12, v11
    v_bitop3_b32 v39, v5, v13, v14 bitop3:0xea
    ds_add_u32 v39, v2
    v_cvt_pk_bf16_f32 v31, v9, v10
    v_perm_b32 v12, v31, v31, s41
    v_bitop3_b32 v34, v4, v12, v34 bitop3:0xca
    v_perm_b32 v13, v31, v31, s42
    v_bitop3_b32 v35, v4, v13, v35 bitop3:0xca
    v_lshrrev_b32 v8, 2, v0
    v_and_b32 v7, 0x3c00, v0
    v_bitop3_b32 v7, v5, v8, v7 bitop3:0xea
    s_waitcnt lgkmcnt(0)
    s_barrier
    ds_read2st64_b32 v[8:9], v7 offset0:0 offset1:1
    ds_read2st64_b32 v[10:11], v7 offset0:2 offset1:3
    s_add_u32 s46, s35, 0x2a50000
    buffer_store_dwordx4 v[84:87], v0, s[20:23], s46 offen sc1
    s_add_u32 s47, s34, 0x3000000
    s_nop 0
    buffer_load_dwordx2 v[84:85], v1, s[16:19], s47 offen nt
    s_add_u32 s44, s34, 0x3200000
    buffer_load_dwordx2 v[86:87], v1, s[16:19], s44 offen nt
    s_waitcnt lgkmcnt(0)
    v_lshl_or_b32 v12, v9, 16, v8
    v_lshl_or_b32 v13, v11, 16, v10
    v_mov_b32 v14, v12
    v_mov_b32 v15, v13
    s_nop 0
    v_add_u32_dpp v14, v14, v14 row_shr:1 row_mask:0xf bank_mask:0xf bound_ctrl:1
    v_add_u32_dpp v15, v15, v15 row_shr:1 row_mask:0xf bank_mask:0xf bound_ctrl:1
    s_nop 0
    v_add_u32_dpp v14, v14, v14 row_shr:2 row_mask:0xf bank_mask:0xf bound_ctrl:1
    v_add_u32_dpp v15, v15, v15 row_shr:2 row_mask:0xf bank_mask:0xf bound_ctrl:1
    s_nop 0
    v_add_u32_dpp v14, v14, v14 row_shr:4 row_mask:0xf bank_mask:0xf bound_ctrl:1
    v_add_u32_dpp v15, v15, v15 row_shr:4 row_mask:0xf bank_mask:0xf bound_ctrl:1
    s_nop 0
    v_add_u32_dpp v14, v14, v14 row_shr:8 row_mask:0xf bank_mask:0xf bound_ctrl:1
    v_add_u32_dpp v15, v15, v15 row_shr:8 row_mask:0xf bank_mask:0xf bound_ctrl:1
    s_nop 0
    v_add_u32_dpp v14, v14, v14 row_bcast:15 row_mask:0xa bank_mask:0xf
    v_add_u32_dpp v15, v15, v15 row_bcast:15 row_mask:0xa bank_mask:0xf
    s_nop 0
    v_add_u32_dpp v14, v14, v14 row_bcast:31 row_mask:0xc bank_mask:0xf
    v_add_u32_dpp v15, v15, v15 row_bcast:31 row_mask:0xc bank_mask:0xf
    v_readlane_b32 s48, v14, 63
    v_readlane_b32 s49, v15, 63
    s_lshl_b32 s54, s32, 2
    v_mov_b32 v8, s54
    s_and_b32 s50, s48, 0xffff
    s_lshr_b32 s51, s48, 16
    s_and_b32 s52, s49, 0xffff
    s_lshr_b32 s53, s49, 16
    s_add_u32 s51, s51, s50
    s_add_u32 s52, s52, s51
    s_add_u32 s53, s53, s52
    v_mov_b32 v9, s53
    s_mov_b64 exec, 1
    ds_write_b32 v8, v9 offset:16384
    s_mov_b64 exec, -1
    v_and_b32 v8, 60, v7
    s_waitcnt lgkmcnt(0)
    s_barrier
    ds_read_b32 v9, v8 offset:16384
    s_waitcnt lgkmcnt(0)
    v_add_u32_dpp v9, v9, v9 row_shr:1 row_mask:0xf bank_mask:0xf bound_ctrl:1
    s_nop 1
    v_add_u32_dpp v9, v9, v9 row_shr:2 row_mask:0xf bank_mask:0xf bound_ctrl:1
    s_nop 1
    v_add_u32_dpp v9, v9, v9 row_shr:4 row_mask:0xf bank_mask:0xf bound_ctrl:1
    s_nop 1
    v_add_u32_dpp v9, v9, v9 row_shr:8 row_mask:0xf bank_mask:0xf bound_ctrl:1
    s_nop 0
    v_readlane_b32 s54, v9, s32
    s_sub_u32 s54, s54, s53
    s_add_u32 s50, s50, s54
    s_add_u32 s51, s51, s54
    s_add_u32 s52, s52, s54
    s_pack_ll_b32_b16 s48, s54, s50
    s_pack_ll_b32_b16 s49, s51, s52
    v_add_u32 v14, s48, v14
    v_add_u32 v15, s49, v15
    v_sub_u32 v12, v14, v12
    v_sub_u32 v13, v15, v13
    v_and_b32 v8, 0xffff, v12
    v_lshrrev_b32 v9, 16, v12
    v_and_b32 v10, 0xffff, v13
    v_lshrrev_b32 v11, 16, v13
    ds_write2st64_b32 v7, v8, v9 offset0:0 offset1:1
    ds_write2st64_b32 v7, v10, v11 offset0:2 offset1:3
    s_waitcnt lgkmcnt(0)
    s_barrier
    ds_add_rtn_u32 v72, v72, v2
    ds_add_rtn_u32 v73, v73, v2
    ds_add_rtn_u32 v74, v74, v2
    ds_add_rtn_u32 v75, v75, v2
    s_add_u32 s45, s36, 0x5480000
    v_and_b32 v11, 0x3f0, v0
    v_add_u32 v11, v11, v11
    buffer_store_dwordx2 v[12:13], v11, s[24:27], s45 offen
    s_bitset0_b64 exec, 63
    s_not_b64 exec, exec
    buffer_store_dwordx2 v[14:15], v11, s[24:27], s45 offen offset:32
    s_mov_b64 exec, -1
    ds_add_rtn_u32 v80, v80, v2
    ds_add_rtn_u32 v81, v81, v2
    ds_add_rtn_u32 v82, v82, v2
    ds_add_rtn_u32 v83, v83, v2
    ds_add_rtn_u32 v100, v100, v2
    ds_add_rtn_u32 v101, v101, v2
    ds_add_rtn_u32 v102, v102, v2
    ds_add_rtn_u32 v103, v103, v2
    s_add_u32 s46, s35, 0x2a54000
    buffer_store_dwordx4 v[48:51], v0, s[20:23], s46 offen sc1
    s_add_u32 s47, s33, 0x6400000
    s_nop 0
    buffer_load_dwordx4 v[48:51], v0, s[8:11], s47 offen nt
    ds_add_rtn_u32 v112, v112, v2
    ds_add_rtn_u32 v113, v113, v2
    ds_add_rtn_u32 v114, v114, v2
    ds_add_rtn_u32 v115, v115, v2
    ds_add_rtn_u32 v116, v116, v2
    ds_add_rtn_u32 v117, v117, v2
    ds_add_rtn_u32 v118, v118, v2
    ds_add_rtn_u32 v119, v119, v2
    ds_add_rtn_u32 v16, v16, v2
    ds_add_rtn_u32 v17, v17, v2
    ds_add_rtn_u32 v18, v18, v2
    ds_add_rtn_u32 v19, v19, v2
    s_add_u32 s44, s35, 0x2a58000
    buffer_store_dwordx4 v[52:55], v0, s[20:23], s44 offen sc1
    s_add_u32 s45, s33, 0x6400000
    s_nop 0
    buffer_load_dwordx4 v[52:55], v0, s[12:15], s45 offen nt
    ds_add_rtn_u32 v124, v124, v2
    ds_add_rtn_u32 v125, v125, v2
    ds_add_rtn_u32 v126, v126, v2
    ds_add_rtn_u32 v127, v127, v2
    ds_add_rtn_u32 v36, v36, v2
    ds_add_rtn_u32 v37, v37, v2
    ds_add_rtn_u32 v38, v38, v2
    ds_add_rtn_u32 v39, v39, v2
    s_waitcnt lgkmcnt(0)
    s_barrier
    v_and_b32 v7, -4, v72
    v_lshl_add_u32 v8, v72, 2, v7
    ds_write_b32 v8, v68
    v_lshl_add_u32 v7, v7, 2, v72
    ds_write_b8 v7, v64 offset:16
    v_and_b32 v9, -4, v73
    v_lshl_add_u32 v10, v73, 2, v9
    ds_write_b32 v10, v69
    v_lshl_add_u32 v9, v9, 2, v73
    ds_write_b8_d16_hi v9, v64 offset:16
    v_and_b32 v7, -4, v74
    v_lshl_add_u32 v8, v74, 2, v7
    ds_write_b32 v8, v70
    v_lshl_add_u32 v7, v7, 2, v74
    ds_write_b8 v7, v65 offset:16
    v_and_b32 v9, -4, v75
    v_lshl_add_u32 v10, v75, 2, v9
    ds_write_b32 v10, v71
    v_lshl_add_u32 v9, v9, 2, v75
    ds_write_b8_d16_hi v9, v65 offset:16
    s_add_u32 s46, s35, 0x2a5c000
    buffer_store_dwordx4 v[56:59], v0, s[20:23], s46 offen sc1
    s_add_u32 s47, s33, 0x6800000
    buffer_load_dwordx4 v[68:71], v0, s[8:11], s47 offen nt
    s_add_u32 s44, s33, 0x6800000
    buffer_load_dwordx4 v[72:75], v0, s[12:15], s44 offen nt
    v_and_b32 v7, -4, v80
    v_lshl_add_u32 v8, v80, 2, v7
    ds_write_b32 v8, v76
    v_lshl_add_u32 v7, v7, 2, v80
    ds_write_b8 v7, v66 offset:16
    v_and_b32 v9, -4, v81
    v_lshl_add_u32 v10, v81, 2, v9
    ds_write_b32 v10, v77
    v_lshl_add_u32 v9, v9, 2, v81
    ds_write_b8_d16_hi v9, v66 offset:16
    v_and_b32 v7, -4, v82
    v_lshl_add_u32 v8, v82, 2, v7
    ds_write_b32 v8, v78
    v_lshl_add_u32 v7, v7, 2, v82
    ds_write_b8 v7, v67 offset:16
    v_and_b32 v9, -4, v83
    v_lshl_add_u32 v10, v83, 2, v9
    ds_write_b32 v10, v79
    v_lshl_add_u32 v9, v9, 2, v83
    ds_write_b8_d16_hi v9, v67 offset:16
    s_add_u32 s45, s34, 0x3400000
    buffer_load_dwordx2 v[56:57], v1, s[16:19], s45 offen nt
    s_add_u32 s46, s34, 0x3600000
    buffer_load_dwordx2 v[58:59], v1, s[16:19], s46 offen nt
    s_add_u32 s47, s33, 0x6c00000
    buffer_load_dwordx4 v[76:79], v0, s[8:11], s47 offen nt
    v_and_b32 v7, -4, v100
    v_lshl_add_u32 v8, v100, 2, v7
    ds_write_b32 v8, v96
    v_lshl_add_u32 v7, v7, 2, v100
    ds_write_b8 v7, v88 offset:16
    v_and_b32 v9, -4, v101
    v_lshl_add_u32 v10, v101, 2, v9
    ds_write_b32 v10, v97
    v_lshl_add_u32 v9, v9, 2, v101
    ds_write_b8_d16_hi v9, v88 offset:16
    v_and_b32 v7, -4, v102
    v_lshl_add_u32 v8, v102, 2, v7
    ds_write_b32 v8, v98
    v_lshl_add_u32 v7, v7, 2, v102
    ds_write_b8 v7, v89 offset:16
    v_and_b32 v9, -4, v103
    v_lshl_add_u32 v10, v103, 2, v9
    ds_write_b32 v10, v99
    v_lshl_add_u32 v9, v9, 2, v103
    ds_write_b8_d16_hi v9, v89 offset:16
    s_add_u32 s44, s35, 0x2a60000
    buffer_store_dwordx4 v[60:63], v0, s[20:23], s44 offen sc1
    s_add_u32 s45, s33, 0x6c00000
    buffer_load_dwordx4 v[80:83], v0, s[12:15], s45 offen nt
    v_and_b32 v7, -4, v112
    v_lshl_add_u32 v8, v112, 2, v7
    ds_write_b32 v8, v108
    v_lshl_add_u32 v7, v7, 2, v112
    ds_write_b8 v7, v90 offset:16
    v_and_b32 v9, -4, v113
    v_lshl_add_u32 v10, v113, 2, v9
    ds_write_b32 v10, v109
    v_lshl_add_u32 v9, v9, 2, v113
    ds_write_b8_d16_hi v9, v90 offset:16
    v_and_b32 v7, -4, v114
    v_lshl_add_u32 v8, v114, 2, v7
    ds_write_b32 v8, v110
    v_lshl_add_u32 v7, v7, 2, v114
    ds_write_b8 v7, v91 offset:16
    v_and_b32 v9, -4, v115
    v_lshl_add_u32 v10, v115, 2, v9
    ds_write_b32 v10, v111
    v_lshl_add_u32 v9, v9, 2, v115
    ds_write_b8_d16_hi v9, v91 offset:16
    s_add_u32 s46, s33, 0x7000000
    buffer_load_dwordx4 v[64:67], v0, s[8:11], s46 offen nt
    s_add_u32 s47, s33, 0x7000000
    buffer_load_dwordx4 v[96:99], v0, s[12:15], s47 offen nt
    v_and_b32 v7, -4, v116
    v_lshl_add_u32 v8, v116, 2, v7
    ds_write_b32 v8, v104
    v_lshl_add_u32 v7, v7, 2, v116
    ds_write_b8 v7, v120 offset:16
    v_and_b32 v9, -4, v117
    v_lshl_add_u32 v10, v117, 2, v9
    ds_write_b32 v10, v105
    v_lshl_add_u32 v9, v9, 2, v117
    ds_write_b8_d16_hi v9, v120 offset:16
    v_and_b32 v7, -4, v118
    v_lshl_add_u32 v8, v118, 2, v7
    ds_write_b32 v8, v106
    v_lshl_add_u32 v7, v7, 2, v118
    ds_write_b8 v7, v121 offset:16
    v_and_b32 v9, -4, v119
    v_lshl_add_u32 v10, v119, 2, v9
    ds_write_b32 v10, v107
    v_lshl_add_u32 v9, v9, 2, v119
    ds_write_b8_d16_hi v9, v121 offset:16
    s_add_u32 s44, s34, 0x3800000
    buffer_load_dwordx2 v[100:101], v1, s[16:19], s44 offen nt
    s_add_u32 s45, s34, 0x3a00000
    buffer_load_dwordx2 v[102:103], v1, s[16:19], s45 offen nt
    s_add_u32 s46, s33, 0x7400000
    buffer_load_dwordx4 v[60:63], v0, s[8:11], s46 offen nt
    v_and_b32 v7, -4, v16
    v_lshl_add_u32 v8, v16, 2, v7
    ds_write_b32 v8, v92
    v_lshl_add_u32 v7, v7, 2, v16
    ds_write_b8 v7, v122 offset:16
    v_and_b32 v9, -4, v17
    v_lshl_add_u32 v10, v17, 2, v9
    ds_write_b32 v10, v93
    v_lshl_add_u32 v9, v9, 2, v17
    ds_write_b8_d16_hi v9, v122 offset:16
    v_and_b32 v7, -4, v18
    v_lshl_add_u32 v8, v18, 2, v7
    ds_write_b32 v8, v94
    v_lshl_add_u32 v7, v7, 2, v18
    ds_write_b8 v7, v123 offset:16
    v_and_b32 v9, -4, v19
    v_lshl_add_u32 v10, v19, 2, v9
    ds_write_b32 v10, v95
    v_lshl_add_u32 v9, v9, 2, v19
    ds_write_b8_d16_hi v9, v123 offset:16
    s_add_u32 s47, s35, 0x2a64000
    buffer_store_dwordx4 v[44:47], v0, s[20:23], s47 offen sc1
    s_add_u32 s44, s33, 0x7400000
    buffer_load_dwordx4 v[108:111], v0, s[12:15], s44 offen nt
    v_and_b32 v7, -4, v124
    v_lshl_add_u32 v8, v124, 2, v7
    ds_write_b32 v8, v20
    v_lshl_add_u32 v7, v7, 2, v124
    ds_write_b8 v7, v28 offset:16
    v_and_b32 v9, -4, v125
    v_lshl_add_u32 v10, v125, 2, v9
    ds_write_b32 v10, v21
    v_lshl_add_u32 v9, v9, 2, v125
    ds_write_b8_d16_hi v9, v28 offset:16
    v_and_b32 v7, -4, v126
    v_lshl_add_u32 v8, v126, 2, v7
    ds_write_b32 v8, v22
    v_lshl_add_u32 v7, v7, 2, v126
    ds_write_b8 v7, v29 offset:16
    v_and_b32 v9, -4, v127
    v_lshl_add_u32 v10, v127, 2, v9
    ds_write_b32 v10, v23
    v_lshl_add_u32 v9, v9, 2, v127
    ds_write_b8_d16_hi v9, v29 offset:16
    s_add_u32 s45, s33, 0x7800000
    buffer_load_dwordx4 v[112:115], v0, s[8:11], s45 offen nt
    s_add_u32 s46, s33, 0x7800000
    buffer_load_dwordx4 v[88:91], v0, s[12:15], s46 offen nt
    v_and_b32 v7, -4, v36
    v_lshl_add_u32 v8, v36, 2, v7
    ds_write_b32 v8, v32
    v_lshl_add_u32 v7, v7, 2, v36
    ds_write_b8 v7, v30 offset:16
    v_and_b32 v9, -4, v37
    v_lshl_add_u32 v10, v37, 2, v9
    ds_write_b32 v10, v33
    v_lshl_add_u32 v9, v9, 2, v37
    ds_write_b8_d16_hi v9, v30 offset:16
    v_and_b32 v7, -4, v38
    v_lshl_add_u32 v8, v38, 2, v7
    ds_write_b32 v8, v34
    v_lshl_add_u32 v7, v7, 2, v38
    ds_write_b8 v7, v31 offset:16
    v_and_b32 v9, -4, v39
    v_lshl_add_u32 v10, v39, 2, v9
    ds_write_b32 v10, v35
    v_lshl_add_u32 v9, v9, 2, v39
    ds_write_b8_d16_hi v9, v31 offset:16
    s_add_u32 s47, s34, 0x3c00000
    buffer_load_dwordx2 v[104:105], v1, s[16:19], s47 offen nt
    s_add_u32 s44, s34, 0x3e00000
    buffer_load_dwordx2 v[106:107], v1, s[16:19], s44 offen nt
    v_add_u32 v7, 0x10000, v0
    v_add_u32 v12, 0x20000, v0
    v_mov_b32 v8, 0
    v_mov_b32 v9, 0
    v_mov_b32 v10, 0
    v_mov_b32 v11, 0
    s_waitcnt lgkmcnt(0)
    s_barrier
    ds_read_b128 v[116:119], v0 offset:0
    ds_write_b128 v0, v[8:11]
    ds_read_b128 v[92:95], v0 offset:16384
    ds_read_b128 v[16:19], v0 offset:32768
    ds_read_b128 v[120:123], v0 offset:49152
    ds_read_b128 v[44:47], v7 offset:0
    ds_read_b128 v[20:23], v7 offset:16384
    ds_read_b128 v[124:127], v7 offset:32768
    ds_read_b128 v[32:35], v7 offset:49152
    ds_read_b128 v[36:39], v12 offset:0
    ds_read_b128 v[28:31], v12 offset:16384
    s_waitcnt lgkmcnt(0)
    s_barrier
    s_add_u32 s45, s35, 0x5480000
    buffer_store_dwordx4 v[116:119], v0, s[20:23], s45 offen sc1
    s_add_u32 s46, s33, 0x7c00000
    s_nop 0
    buffer_load_dwordx4 v[116:119], v0, s[8:11], s46 offen nt
    s_add_u32 s47, s35, 0x5484000
    buffer_store_dwordx4 v[92:95], v0, s[20:23], s47 offen sc1
    s_add_u32 s44, s33, 0x7c00000
    s_nop 0
    buffer_load_dwordx4 v[92:95], v0, s[12:15], s44 offen nt
    s_waitcnt vmcnt(29)
    v_lshlrev_b32 v7, 16, v84
    v_and_b32 v8, 0xffff0000, v84
    v_lshlrev_b32 v9, 16, v85
    v_and_b32 v10, 0xffff0000, v85
    v_mul_f32 v7, 0.15915494, v7
    v_mul_f32 v8, 0.15915494, v8
    v_mul_f32 v9, 0.15915494, v9
    v_mul_f32 v10, 0.15915494, v10
    v_mul_hi_u32_u24 v14, 429497, v40
    v_lshrrev_b32 v12, 3, v24
    v_cos_f32 v7, v7
    v_lshlrev_b16 v13, 3, v24
    v_mad_i32_i24 v11, v14, s55, v40
    v_bitop3_b32 v12, v6, v13, v12 bitop3:0xca
    v_add_lshl_u32 v11, v11, s40, 17
    v_lshlrev_b16 v14, 8, v14
    v_lshrrev_b32 v13, 2, v24
    v_or_b32 v40, v12, v11
    v_bitop3_b32 v24, v5, v13, v14 bitop3:0xea
    ds_add_u32 v24, v2
    v_mul_hi_u32_u24 v14, 429497, v41
    v_lshrrev_b32 v12, 3, v25
    v_cos_f32 v8, v8
    v_lshlrev_b16 v13, 3, v25
    v_mad_i32_i24 v11, v14, s55, v41
    v_bitop3_b32 v12, v6, v13, v12 bitop3:0xca
    v_add_lshl_u32 v11, v11, s40, 17
    v_lshlrev_b16 v14, 8, v14
    v_lshrrev_b32 v13, 2, v25
    v_or_b32 v41, v12, v11
    v_bitop3_b32 v25, v5, v13, v14 bitop3:0xea
    ds_add_u32 v25, v2
    v_cvt_pk_bf16_f32 v84, v7, v8
    v_perm_b32 v12, v84, v84, s41
    v_bitop3_b32 v40, v4, v12, v40 bitop3:0xca
    v_perm_b32 v13, v84, v84, s42
    v_bitop3_b32 v41, v4, v13, v41 bitop3:0xca
    v_mul_hi_u32_u24 v14, 429497, v42
    v_lshrrev_b32 v12, 3, v26
    v_cos_f32 v9, v9
    v_lshlrev_b16 v13, 3, v26
    v_mad_i32_i24 v11, v14, s55, v42
    v_bitop3_b32 v12, v6, v13, v12 bitop3:0xca
    v_add_lshl_u32 v11, v11, s40, 17
    v_lshlrev_b16 v14, 8, v14
    v_lshrrev_b32 v13, 2, v26
    v_or_b32 v42, v12, v11
    v_bitop3_b32 v26, v5, v13, v14 bitop3:0xea
    ds_add_u32 v26, v2
    v_mul_hi_u32_u24 v14, 429497, v43
    v_lshrrev_b32 v12, 3, v27
    v_cos_f32 v10, v10
    v_lshlrev_b16 v13, 3, v27
    v_mad_i32_i24 v11, v14, s55, v43
    v_bitop3_b32 v12, v6, v13, v12 bitop3:0xca
    v_add_lshl_u32 v11, v11, s40, 17
    v_lshlrev_b16 v14, 8, v14
    v_lshrrev_b32 v13, 2, v27
    v_or_b32 v43, v12, v11
    v_bitop3_b32 v27, v5, v13, v14 bitop3:0xea
    ds_add_u32 v27, v2
    v_cvt_pk_bf16_f32 v85, v9, v10
    v_perm_b32 v12, v85, v85, s41
    v_bitop3_b32 v42, v4, v12, v42 bitop3:0xca
    v_perm_b32 v13, v85, v85, s42
    v_bitop3_b32 v43, v4, v13, v43 bitop3:0xca
    s_waitcnt vmcnt(23)
    v_lshlrev_b32 v7, 16, v86
    v_and_b32 v8, 0xffff0000, v86
    v_lshlrev_b32 v9, 16, v87
    v_and_b32 v10, 0xffff0000, v87
    v_mul_f32 v7, 0.15915494, v7
    v_mul_f32 v8, 0.15915494, v8
    v_mul_f32 v9, 0.15915494, v9
    v_mul_f32 v10, 0.15915494, v10
    v_mul_hi_u32_u24 v14, 429497, v48
    v_lshrrev_b32 v12, 3, v52
    v_cos_f32 v7, v7
    v_lshlrev_b16 v13, 3, v52
    v_mad_i32_i24 v11, v14, s55, v48
    v_bitop3_b32 v12, v6, v13, v12 bitop3:0xca
    v_add_lshl_u32 v11, v11, s40, 17
    v_lshlrev_b16 v14, 8, v14
    v_lshrrev_b32 v13, 2, v52
    v_or_b32 v48, v12, v11
    v_bitop3_b32 v52, v5, v13, v14 bitop3:0xea
    ds_add_u32 v52, v2
    v_mul_hi_u32_u24 v14, 429497, v49
    v_lshrrev_b32 v12, 3, v53
    v_cos_f32 v8, v8
    v_lshlrev_b16 v13, 3, v53
    v_mad_i32_i24 v11, v14, s55, v49
    v_bitop3_b32 v12, v6, v13, v12 bitop3:0xca
    v_add_lshl_u32 v11, v11, s40, 17
    v_lshlrev_b16 v14, 8, v14
    v_lshrrev_b32 v13, 2, v53
    v_or_b32 v49, v12, v11
    v_bitop3_b32 v53, v5, v13, v14 bitop3:0xea
    ds_add_u32 v53, v2
    v_cvt_pk_bf16_f32 v86, v7, v8
    v_perm_b32 v12, v86, v86, s41
    v_bitop3_b32 v48, v4, v12, v48 bitop3:0xca
    v_perm_b32 v13, v86, v86, s42
    v_bitop3_b32 v49, v4, v13, v49 bitop3:0xca
    v_mul_hi_u32_u24 v14, 429497, v50
    v_lshrrev_b32 v12, 3, v54
    v_cos_f32 v9, v9
    v_lshlrev_b16 v13, 3, v54
    v_mad_i32_i24 v11, v14, s55, v50
    v_bitop3_b32 v12, v6, v13, v12 bitop3:0xca
    v_add_lshl_u32 v11, v11, s40, 17
    v_lshlrev_b16 v14, 8, v14
    v_lshrrev_b32 v13, 2, v54
    v_or_b32 v50, v12, v11
    v_bitop3_b32 v54, v5, v13, v14 bitop3:0xea
    ds_add_u32 v54, v2
    v_mul_hi_u32_u24 v14, 429497, v51
    v_lshrrev_b32 v12, 3, v55
    v_cos_f32 v10, v10
    v_lshlrev_b16 v13, 3, v55
    v_mad_i32_i24 v11, v14, s55, v51
    v_bitop3_b32 v12, v6, v13, v12 bitop3:0xca
    v_add_lshl_u32 v11, v11, s40, 17
    v_lshlrev_b16 v14, 8, v14
    v_lshrrev_b32 v13, 2, v55
    v_or_b32 v51, v12, v11
    v_bitop3_b32 v55, v5, v13, v14 bitop3:0xea
    ds_add_u32 v55, v2
    v_cvt_pk_bf16_f32 v87, v9, v10
    v_perm_b32 v12, v87, v87, s41
    v_bitop3_b32 v50, v4, v12, v50 bitop3:0xca
    v_perm_b32 v13, v87, v87, s42
    v_bitop3_b32 v51, v4, v13, v51 bitop3:0xca
    s_waitcnt vmcnt(18)
    v_lshlrev_b32 v7, 16, v56
    v_and_b32 v8, 0xffff0000, v56
    v_lshlrev_b32 v9, 16, v57
    v_and_b32 v10, 0xffff0000, v57
    v_mul_f32 v7, 0.15915494, v7
    v_mul_f32 v8, 0.15915494, v8
    v_mul_f32 v9, 0.15915494, v9
    v_mul_f32 v10, 0.15915494, v10
    v_mul_hi_u32_u24 v14, 429497, v68
    v_lshrrev_b32 v12, 3, v72
    v_cos_f32 v7, v7
    v_lshlrev_b16 v13, 3, v72
    v_mad_i32_i24 v11, v14, s55, v68
    v_bitop3_b32 v12, v6, v13, v12 bitop3:0xca
    v_add_lshl_u32 v11, v11, s40, 17
    v_lshlrev_b16 v14, 8, v14
    v_lshrrev_b32 v13, 2, v72
    v_or_b32 v68, v12, v11
    v_bitop3_b32 v72, v5, v13, v14 bitop3:0xea
    ds_add_u32 v72, v2
    v_mul_hi_u32_u24 v14, 429497, v69
    v_lshrrev_b32 v12, 3, v73
    v_cos_f32 v8, v8
    v_lshlrev_b16 v13, 3, v73
    v_mad_i32_i24 v11, v14, s55, v69
    v_bitop3_b32 v12, v6, v13, v12 bitop3:0xca
    v_add_lshl_u32 v11, v11, s40, 17
    v_lshlrev_b16 v14, 8, v14
    v_lshrrev_b32 v13, 2, v73
    v_or_b32 v69, v12, v11
    v_bitop3_b32 v73, v5, v13, v14 bitop3:0xea
    ds_add_u32 v73, v2
    v_cvt_pk_bf16_f32 v56, v7, v8
    v_perm_b32 v12, v56, v56, s41
    v_bitop3_b32 v68, v4, v12, v68 bitop3:0xca
    v_perm_b32 v13, v56, v56, s42
    v_bitop3_b32 v69, v4, v13, v69 bitop3:0xca
    v_mul_hi_u32_u24 v14, 429497, v70
    v_lshrrev_b32 v12, 3, v74
    v_cos_f32 v9, v9
    v_lshlrev_b16 v13, 3, v74
    v_mad_i32_i24 v11, v14, s55, v70
    v_bitop3_b32 v12, v6, v13, v12 bitop3:0xca
    v_add_lshl_u32 v11, v11, s40, 17
    v_lshlrev_b16 v14, 8, v14
    v_lshrrev_b32 v13, 2, v74
    v_or_b32 v70, v12, v11
    v_bitop3_b32 v74, v5, v13, v14 bitop3:0xea
    ds_add_u32 v74, v2
    v_mul_hi_u32_u24 v14, 429497, v71
    v_lshrrev_b32 v12, 3, v75
    v_cos_f32 v10, v10
    v_lshlrev_b16 v13, 3, v75
    v_mad_i32_i24 v11, v14, s55, v71
    v_bitop3_b32 v12, v6, v13, v12 bitop3:0xca
    v_add_lshl_u32 v11, v11, s40, 17
    v_lshlrev_b16 v14, 8, v14
    v_lshrrev_b32 v13, 2, v75
    v_or_b32 v71, v12, v11
    v_bitop3_b32 v75, v5, v13, v14 bitop3:0xea
    ds_add_u32 v75, v2
    v_cvt_pk_bf16_f32 v57, v9, v10
    v_perm_b32 v12, v57, v57, s41
    v_bitop3_b32 v70, v4, v12, v70 bitop3:0xca
    v_perm_b32 v13, v57, v57, s42
    v_bitop3_b32 v71, v4, v13, v71 bitop3:0xca
    s_add_u32 s45, s35, 0x5488000
    buffer_store_dwordx4 v[16:19], v0, s[20:23], s45 offen sc1
    s_add_u32 s46, s33, 0x8000000
    s_nop 0
    buffer_load_dwordx4 v[16:19], v0, s[8:11], s46 offen nt
    s_waitcnt vmcnt(17)
    v_lshlrev_b32 v7, 16, v58
    v_and_b32 v8, 0xffff0000, v58
    v_lshlrev_b32 v9, 16, v59
    v_and_b32 v10, 0xffff0000, v59
    v_mul_f32 v7, 0.15915494, v7
    v_mul_f32 v8, 0.15915494, v8
    v_mul_f32 v9, 0.15915494, v9
    v_mul_f32 v10, 0.15915494, v10
    v_mul_hi_u32_u24 v14, 429497, v76
    v_lshrrev_b32 v12, 3, v80
    v_cos_f32 v7, v7
    v_lshlrev_b16 v13, 3, v80
    v_mad_i32_i24 v11, v14, s55, v76
    v_bitop3_b32 v12, v6, v13, v12 bitop3:0xca
    v_add_lshl_u32 v11, v11, s40, 17
    v_lshlrev_b16 v14, 8, v14
    v_lshrrev_b32 v13, 2, v80
    v_or_b32 v76, v12, v11
    v_bitop3_b32 v80, v5, v13, v14 bitop3:0xea
    ds_add_u32 v80, v2
    v_mul_hi_u32_u24 v14, 429497, v77
    v_lshrrev_b32 v12, 3, v81
    v_cos_f32 v8, v8
    v_lshlrev_b16 v13, 3, v81
    v_mad_i32_i24 v11, v14, s55, v77
    v_bitop3_b32 v12, v6, v13, v12 bitop3:0xca
    v_add_lshl_u32 v11, v11, s40, 17
    v_lshlrev_b16 v14, 8, v14
    v_lshrrev_b32 v13, 2, v81
    v_or_b32 v77, v12, v11
    v_bitop3_b32 v81, v5, v13, v14 bitop3:0xea
    ds_add_u32 v81, v2
    v_cvt_pk_bf16_f32 v58, v7, v8
    v_perm_b32 v12, v58, v58, s41
    v_bitop3_b32 v76, v4, v12, v76 bitop3:0xca
    v_perm_b32 v13, v58, v58, s42
    v_bitop3_b32 v77, v4, v13, v77 bitop3:0xca
    v_mul_hi_u32_u24 v14, 429497, v78
    v_lshrrev_b32 v12, 3, v82
    v_cos_f32 v9, v9
    v_lshlrev_b16 v13, 3, v82
    v_mad_i32_i24 v11, v14, s55, v78
    v_bitop3_b32 v12, v6, v13, v12 bitop3:0xca
    v_add_lshl_u32 v11, v11, s40, 17
    v_lshlrev_b16 v14, 8, v14
    v_lshrrev_b32 v13, 2, v82
    v_or_b32 v78, v12, v11
    v_bitop3_b32 v82, v5, v13, v14 bitop3:0xea
    ds_add_u32 v82, v2
    v_mul_hi_u32_u24 v14, 429497, v79
    v_lshrrev_b32 v12, 3, v83
    v_cos_f32 v10, v10
    v_lshlrev_b16 v13, 3, v83
    v_mad_i32_i24 v11, v14, s55, v79
    v_bitop3_b32 v12, v6, v13, v12 bitop3:0xca
    v_add_lshl_u32 v11, v11, s40, 17
    v_lshlrev_b16 v14, 8, v14
    v_lshrrev_b32 v13, 2, v83
    v_or_b32 v79, v12, v11
    v_bitop3_b32 v83, v5, v13, v14 bitop3:0xea
    ds_add_u32 v83, v2
    v_cvt_pk_bf16_f32 v59, v9, v10
    v_perm_b32 v12, v59, v59, s41
    v_bitop3_b32 v78, v4, v12, v78 bitop3:0xca
    v_perm_b32 v13, v59, v59, s42
    v_bitop3_b32 v79, v4, v13, v79 bitop3:0xca
    s_mov_b32 s68, s56
    s_mov_b32 s69, s57
    s_mov_b32 s70, 0x100
    s_mov_b32 s71, 0x20000
    v_mov_b32 v3, 1
    s_cmp_lg_u32 s32, 15
    s_cbranch_scc1 L1_tk
    s_mov_b64 exec, 1
    buffer_atomic_add v3, off, s[68:71], 0 sc0
    s_mov_b64 exec, -1
L1_tk:
    s_waitcnt vmcnt(13)
    v_lshlrev_b32 v7, 16, v100
    v_and_b32 v8, 0xffff0000, v100
    v_lshlrev_b32 v9, 16, v101
    v_and_b32 v10, 0xffff0000, v101
    v_mul_f32 v7, 0.15915494, v7
    v_mul_f32 v8, 0.15915494, v8
    v_mul_f32 v9, 0.15915494, v9
    v_mul_f32 v10, 0.15915494, v10
    v_mul_hi_u32_u24 v14, 429497, v64
    v_lshrrev_b32 v12, 3, v96
    v_cos_f32 v7, v7
    v_lshlrev_b16 v13, 3, v96
    v_mad_i32_i24 v11, v14, s55, v64
    v_bitop3_b32 v12, v6, v13, v12 bitop3:0xca
    v_add_lshl_u32 v11, v11, s40, 17
    v_lshlrev_b16 v14, 8, v14
    v_lshrrev_b32 v13, 2, v96
    v_or_b32 v64, v12, v11
    v_bitop3_b32 v96, v5, v13, v14 bitop3:0xea
    ds_add_u32 v96, v2
    v_mul_hi_u32_u24 v14, 429497, v65
    v_lshrrev_b32 v12, 3, v97
    v_cos_f32 v8, v8
    v_lshlrev_b16 v13, 3, v97
    v_mad_i32_i24 v11, v14, s55, v65
    v_bitop3_b32 v12, v6, v13, v12 bitop3:0xca
    v_add_lshl_u32 v11, v11, s40, 17
    v_lshlrev_b16 v14, 8, v14
    v_lshrrev_b32 v13, 2, v97
    v_or_b32 v65, v12, v11
    v_bitop3_b32 v97, v5, v13, v14 bitop3:0xea
    ds_add_u32 v97, v2
    v_cvt_pk_bf16_f32 v100, v7, v8
    v_perm_b32 v12, v100, v100, s41
    v_bitop3_b32 v64, v4, v12, v64 bitop3:0xca
    v_perm_b32 v13, v100, v100, s42
    v_bitop3_b32 v65, v4, v13, v65 bitop3:0xca
    v_mul_hi_u32_u24 v14, 429497, v66
    v_lshrrev_b32 v12, 3, v98
    v_cos_f32 v9, v9
    v_lshlrev_b16 v13, 3, v98
    v_mad_i32_i24 v11, v14, s55, v66
    v_bitop3_b32 v12, v6, v13, v12 bitop3:0xca
    v_add_lshl_u32 v11, v11, s40, 17
    v_lshlrev_b16 v14, 8, v14
    v_lshrrev_b32 v13, 2, v98
    v_or_b32 v66, v12, v11
    v_bitop3_b32 v98, v5, v13, v14 bitop3:0xea
    ds_add_u32 v98, v2
    v_mul_hi_u32_u24 v14, 429497, v67
    v_lshrrev_b32 v12, 3, v99
    v_cos_f32 v10, v10
    v_lshlrev_b16 v13, 3, v99
    v_mad_i32_i24 v11, v14, s55, v67
    v_bitop3_b32 v12, v6, v13, v12 bitop3:0xca
    v_add_lshl_u32 v11, v11, s40, 17
    v_lshlrev_b16 v14, 8, v14
    v_lshrrev_b32 v13, 2, v99
    v_or_b32 v67, v12, v11
    v_bitop3_b32 v99, v5, v13, v14 bitop3:0xea
    ds_add_u32 v99, v2
    v_cvt_pk_bf16_f32 v101, v9, v10
    v_perm_b32 v12, v101, v101, s41
    v_bitop3_b32 v66, v4, v12, v66 bitop3:0xca
    v_perm_b32 v13, v101, v101, s42
    v_bitop3_b32 v67, v4, v13, v67 bitop3:0xca
    s_waitcnt vmcnt(10)
    v_lshlrev_b32 v7, 16, v102
    v_and_b32 v8, 0xffff0000, v102
    v_lshlrev_b32 v9, 16, v103
    v_and_b32 v10, 0xffff0000, v103
    v_mul_f32 v7, 0.15915494, v7
    v_mul_f32 v8, 0.15915494, v8
    v_mul_f32 v9, 0.15915494, v9
    v_mul_f32 v10, 0.15915494, v10
    v_mul_hi_u32_u24 v14, 429497, v60
    v_lshrrev_b32 v12, 3, v108
    v_cos_f32 v7, v7
    v_lshlrev_b16 v13, 3, v108
    v_mad_i32_i24 v11, v14, s55, v60
    v_bitop3_b32 v12, v6, v13, v12 bitop3:0xca
    v_add_lshl_u32 v11, v11, s40, 17
    v_lshlrev_b16 v14, 8, v14
    v_lshrrev_b32 v13, 2, v108
    v_or_b32 v60, v12, v11
    v_bitop3_b32 v108, v5, v13, v14 bitop3:0xea
    ds_add_u32 v108, v2
    v_mul_hi_u32_u24 v14, 429497, v61
    v_lshrrev_b32 v12, 3, v109
    v_cos_f32 v8, v8
    v_lshlrev_b16 v13, 3, v109
    v_mad_i32_i24 v11, v14, s55, v61
    v_bitop3_b32 v12, v6, v13, v12 bitop3:0xca
    v_add_lshl_u32 v11, v11, s40, 17
    v_lshlrev_b16 v14, 8, v14
    v_lshrrev_b32 v13, 2, v109
    v_or_b32 v61, v12, v11
    v_bitop3_b32 v109, v5, v13, v14 bitop3:0xea
    ds_add_u32 v109, v2
    v_cvt_pk_bf16_f32 v102, v7, v8
    v_perm_b32 v12, v102, v102, s41
    v_bitop3_b32 v60, v4, v12, v60 bitop3:0xca
    v_perm_b32 v13, v102, v102, s42
    v_bitop3_b32 v61, v4, v13, v61 bitop3:0xca
    v_mul_hi_u32_u24 v14, 429497, v62
    v_lshrrev_b32 v12, 3, v110
    v_cos_f32 v9, v9
    v_lshlrev_b16 v13, 3, v110
    v_mad_i32_i24 v11, v14, s55, v62
    v_bitop3_b32 v12, v6, v13, v12 bitop3:0xca
    v_add_lshl_u32 v11, v11, s40, 17
    v_lshlrev_b16 v14, 8, v14
    v_lshrrev_b32 v13, 2, v110
    v_or_b32 v62, v12, v11
    v_bitop3_b32 v110, v5, v13, v14 bitop3:0xea
    ds_add_u32 v110, v2
    v_mul_hi_u32_u24 v14, 429497, v63
    v_lshrrev_b32 v12, 3, v111
    v_cos_f32 v10, v10
    v_lshlrev_b16 v13, 3, v111
    v_mad_i32_i24 v11, v14, s55, v63
    v_bitop3_b32 v12, v6, v13, v12 bitop3:0xca
    v_add_lshl_u32 v11, v11, s40, 17
    v_lshlrev_b16 v14, 8, v14
    v_lshrrev_b32 v13, 2, v111
    v_or_b32 v63, v12, v11
    v_bitop3_b32 v111, v5, v13, v14 bitop3:0xea
    ds_add_u32 v111, v2
    v_cvt_pk_bf16_f32 v103, v9, v10
    v_perm_b32 v12, v103, v103, s41
    v_bitop3_b32 v62, v4, v12, v62 bitop3:0xca
    v_perm_b32 v13, v103, v103, s42
    v_bitop3_b32 v63, v4, v13, v63 bitop3:0xca
    s_add_u32 s47, s35, 0x548c000
    buffer_store_dwordx4 v[120:123], v0, s[20:23], s47 offen sc1
    s_add_u32 s44, s33, 0x8000000
    s_nop 0
    buffer_load_dwordx4 v[120:123], v0, s[12:15], s44 offen nt
    s_waitcnt vmcnt(8)
    v_lshlrev_b32 v7, 16, v104
    v_and_b32 v8, 0xffff0000, v104
    v_lshlrev_b32 v9, 16, v105
    v_and_b32 v10, 0xffff0000, v105
    v_mul_f32 v7, 0.15915494, v7
    v_mul_f32 v8, 0.15915494, v8
    v_mul_f32 v9, 0.15915494, v9
    v_mul_f32 v10, 0.15915494, v10
    v_mul_hi_u32_u24 v14, 429497, v112
    v_lshrrev_b32 v12, 3, v88
    v_cos_f32 v7, v7
    v_lshlrev_b16 v13, 3, v88
    v_mad_i32_i24 v11, v14, s55, v112
    v_bitop3_b32 v12, v6, v13, v12 bitop3:0xca
    v_add_lshl_u32 v11, v11, s40, 17
    v_lshlrev_b16 v14, 8, v14
    v_lshrrev_b32 v13, 2, v88
    v_or_b32 v112, v12, v11
    v_bitop3_b32 v88, v5, v13, v14 bitop3:0xea
    ds_add_u32 v88, v2
    v_mul_hi_u32_u24 v14, 429497, v113
    v_lshrrev_b32 v12, 3, v89
    v_cos_f32 v8, v8
    v_lshlrev_b16 v13, 3, v89
    v_mad_i32_i24 v11, v14, s55, v113
    v_bitop3_b32 v12, v6, v13, v12 bitop3:0xca
    v_add_lshl_u32 v11, v11, s40, 17
    v_lshlrev_b16 v14, 8, v14
    v_lshrrev_b32 v13, 2, v89
    v_or_b32 v113, v12, v11
    v_bitop3_b32 v89, v5, v13, v14 bitop3:0xea
    ds_add_u32 v89, v2
    v_cvt_pk_bf16_f32 v104, v7, v8
    v_perm_b32 v12, v104, v104, s41
    v_bitop3_b32 v112, v4, v12, v112 bitop3:0xca
    v_perm_b32 v13, v104, v104, s42
    v_bitop3_b32 v113, v4, v13, v113 bitop3:0xca
    v_mul_hi_u32_u24 v14, 429497, v114
    v_lshrrev_b32 v12, 3, v90
    v_cos_f32 v9, v9
    v_lshlrev_b16 v13, 3, v90
    v_mad_i32_i24 v11, v14, s55, v114
    v_bitop3_b32 v12, v6, v13, v12 bitop3:0xca
    v_add_lshl_u32 v11, v11, s40, 17
    v_lshlrev_b16 v14, 8, v14
    v_lshrrev_b32 v13, 2, v90
    v_or_b32 v114, v12, v11
    v_bitop3_b32 v90, v5, v13, v14 bitop3:0xea
    ds_add_u32 v90, v2
    v_mul_hi_u32_u24 v14, 429497, v115
    v_lshrrev_b32 v12, 3, v91
    v_cos_f32 v10, v10
    v_lshlrev_b16 v13, 3, v91
    v_mad_i32_i24 v11, v14, s55, v115
    v_bitop3_b32 v12, v6, v13, v12 bitop3:0xca
    v_add_lshl_u32 v11, v11, s40, 17
    v_lshlrev_b16 v14, 8, v14
    v_lshrrev_b32 v13, 2, v91
    v_or_b32 v115, v12, v11
    v_bitop3_b32 v91, v5, v13, v14 bitop3:0xea
    ds_add_u32 v91, v2
    v_cvt_pk_bf16_f32 v105, v9, v10
    v_perm_b32 v12, v105, v105, s41
    v_bitop3_b32 v114, v4, v12, v114 bitop3:0xca
    v_perm_b32 v13, v105, v105, s42
    v_bitop3_b32 v115, v4, v13, v115 bitop3:0xca
    s_waitcnt vmcnt(4)
    v_lshlrev_b32 v7, 16, v106
    v_and_b32 v8, 0xffff0000, v106
    v_lshlrev_b32 v9, 16, v107
    v_and_b32 v10, 0xffff0000, v107
    v_mul_f32 v7, 0.15915494, v7
    v_mul_f32 v8, 0.15915494, v8
    v_mul_f32 v9, 0.15915494, v9
    v_mul_f32 v10, 0.15915494, v10
    v_mul_hi_u32_u24 v14, 429497, v116
    v_lshrrev_b32 v12, 3, v92
    v_cos_f32 v7, v7
    v_lshlrev_b16 v13, 3, v92
    v_mad_i32_i24 v11, v14, s55, v116
    v_bitop3_b32 v12, v6, v13, v12 bitop3:0xca
    v_add_lshl_u32 v11, v11, s40, 17
    v_lshlrev_b16 v14, 8, v14
    v_lshrrev_b32 v13, 2, v92
    v_or_b32 v116, v12, v11
    v_bitop3_b32 v92, v5, v13, v14 bitop3:0xea
    ds_add_u32 v92, v2
    v_mul_hi_u32_u24 v14, 429497, v117
    v_lshrrev_b32 v12, 3, v93
    v_cos_f32 v8, v8
    v_lshlrev_b16 v13, 3, v93
    v_mad_i32_i24 v11, v14, s55, v117
    v_bitop3_b32 v12, v6, v13, v12 bitop3:0xca
    v_add_lshl_u32 v11, v11, s40, 17
    v_lshlrev_b16 v14, 8, v14
    v_lshrrev_b32 v13, 2, v93
    v_or_b32 v117, v12, v11
    v_bitop3_b32 v93, v5, v13, v14 bitop3:0xea
    ds_add_u32 v93, v2
    v_cvt_pk_bf16_f32 v106, v7, v8
    v_perm_b32 v12, v106, v106, s41
    v_bitop3_b32 v116, v4, v12, v116 bitop3:0xca
    v_perm_b32 v13, v106, v106, s42
    v_bitop3_b32 v117, v4, v13, v117 bitop3:0xca
    v_mul_hi_u32_u24 v14, 429497, v118
    v_lshrrev_b32 v12, 3, v94
    v_cos_f32 v9, v9
    v_lshlrev_b16 v13, 3, v94
    v_mad_i32_i24 v11, v14, s55, v118
    v_bitop3_b32 v12, v6, v13, v12 bitop3:0xca
    v_add_lshl_u32 v11, v11, s40, 17
    v_lshlrev_b16 v14, 8, v14
    v_lshrrev_b32 v13, 2, v94
    v_or_b32 v118, v12, v11
    v_bitop3_b32 v94, v5, v13, v14 bitop3:0xea
    ds_add_u32 v94, v2
    v_mul_hi_u32_u24 v14, 429497, v119
    v_lshrrev_b32 v12, 3, v95
    v_cos_f32 v10, v10
    v_lshlrev_b16 v13, 3, v95
    v_mad_i32_i24 v11, v14, s55, v119
    v_bitop3_b32 v12, v6, v13, v12 bitop3:0xca
    v_add_lshl_u32 v11, v11, s40, 17
    v_lshlrev_b16 v14, 8, v14
    v_lshrrev_b32 v13, 2, v95
    v_or_b32 v119, v12, v11
    v_bitop3_b32 v95, v5, v13, v14 bitop3:0xea
    ds_add_u32 v95, v2
    v_cvt_pk_bf16_f32 v107, v9, v10
    v_perm_b32 v12, v107, v107, s41
    v_bitop3_b32 v118, v4, v12, v118 bitop3:0xca
    v_perm_b32 v13, v107, v107, s42
    v_bitop3_b32 v119, v4, v13, v119 bitop3:0xca
    v_lshrrev_b32 v8, 2, v0
    v_and_b32 v7, 0x3c00, v0
    v_bitop3_b32 v7, v5, v8, v7 bitop3:0xea
    s_waitcnt lgkmcnt(0)
    s_barrier
    ds_read2st64_b32 v[8:9], v7 offset0:0 offset1:1
    ds_read2st64_b32 v[10:11], v7 offset0:2 offset1:3
    s_add_u32 s45, s35, 0x5490000
    buffer_store_dwordx4 v[44:47], v0, s[20:23], s45 offen sc1
    s_add_u32 s46, s34, 0x4000000
    s_nop 0
    buffer_load_dwordx2 v[44:45], v1, s[16:19], s46 offen nt
    s_add_u32 s47, s34, 0x4200000
    buffer_load_dwordx2 v[46:47], v1, s[16:19], s47 offen nt
    s_waitcnt lgkmcnt(0)
    v_lshl_or_b32 v12, v9, 16, v8
    v_lshl_or_b32 v13, v11, 16, v10
    v_mov_b32 v14, v12
    v_mov_b32 v15, v13
    s_nop 0
    v_add_u32_dpp v14, v14, v14 row_shr:1 row_mask:0xf bank_mask:0xf bound_ctrl:1
    v_add_u32_dpp v15, v15, v15 row_shr:1 row_mask:0xf bank_mask:0xf bound_ctrl:1
    s_nop 0
    v_add_u32_dpp v14, v14, v14 row_shr:2 row_mask:0xf bank_mask:0xf bound_ctrl:1
    v_add_u32_dpp v15, v15, v15 row_shr:2 row_mask:0xf bank_mask:0xf bound_ctrl:1
    s_nop 0
    v_add_u32_dpp v14, v14, v14 row_shr:4 row_mask:0xf bank_mask:0xf bound_ctrl:1
    v_add_u32_dpp v15, v15, v15 row_shr:4 row_mask:0xf bank_mask:0xf bound_ctrl:1
    s_nop 0
    v_add_u32_dpp v14, v14, v14 row_shr:8 row_mask:0xf bank_mask:0xf bound_ctrl:1
    v_add_u32_dpp v15, v15, v15 row_shr:8 row_mask:0xf bank_mask:0xf bound_ctrl:1
    s_nop 0
    v_add_u32_dpp v14, v14, v14 row_bcast:15 row_mask:0xa bank_mask:0xf
    v_add_u32_dpp v15, v15, v15 row_bcast:15 row_mask:0xa bank_mask:0xf
    s_nop 0
    v_add_u32_dpp v14, v14, v14 row_bcast:31 row_mask:0xc bank_mask:0xf
    v_add_u32_dpp v15, v15, v15 row_bcast:31 row_mask:0xc bank_mask:0xf
    v_readlane_b32 s48, v14, 63
    v_readlane_b32 s49, v15, 63
    s_lshl_b32 s54, s32, 2
    v_mov_b32 v8, s54
    s_and_b32 s50, s48, 0xffff
    s_lshr_b32 s51, s48, 16
    s_and_b32 s52, s49, 0xffff
    s_lshr_b32 s53, s49, 16
    s_add_u32 s51, s51, s50
    s_add_u32 s52, s52, s51
    s_add_u32 s53, s53, s52
    v_mov_b32 v9, s53
    s_mov_b64 exec, 1
    ds_write_b32 v8, v9 offset:16384
    s_waitcnt vmcnt(5)
    ds_write_b32 v8, v3 offset:16448
    s_mov_b64 exec, -1
    v_and_b32 v8, 60, v7
    s_waitcnt lgkmcnt(0)
    s_barrier
    ds_read_b32 v9, v8 offset:16384
    ds_read_b32 v10, v8 offset:16448
    s_waitcnt lgkmcnt(0)
    v_readlane_b32 s84, v10, 15
    s_min_u32 s4, s84, 136
    s_min_u32 s5, s84, 176
    s_min_u32 s6, s84, 216
    s_add_u32 s4, s4, s5
    s_add_u32 s4, s4, s6
    s_add_u32 s4, s4, 9467
    s_mov_b32 s4, s84
    s_lshl_b32 s58, s4, 14
    s_lshl_b32 s59, s4, 13
    s_mov_b32 s43, 5
    s_cmp_lt_u32 s84, 136
    s_addc_u32 s43, s43, 0
    s_cmp_lt_u32 s84, 176
    s_addc_u32 s43, s43, 0
    s_cmp_lt_u32 s84, 216
    s_addc_u32 s43, s43, 0
    v_add_u32_dpp v9, v9, v9 row_shr:1 row_mask:0xf bank_mask:0xf bound_ctrl:1
    s_nop 1
    v_add_u32_dpp v9, v9, v9 row_shr:2 row_mask:0xf bank_mask:0xf bound_ctrl:1
    s_nop 1
    v_add_u32_dpp v9, v9, v9 row_shr:4 row_mask:0xf bank_mask:0xf bound_ctrl:1
    s_nop 1
    v_add_u32_dpp v9, v9, v9 row_shr:8 row_mask:0xf bank_mask:0xf bound_ctrl:1
    s_nop 0
    v_readlane_b32 s54, v9, s32
    s_sub_u32 s54, s54, s53
    s_add_u32 s50, s50, s54
    s_add_u32 s51, s51, s54
    s_add_u32 s52, s52, s54
    s_pack_ll_b32_b16 s48, s54, s50
    s_pack_ll_b32_b16 s49, s51, s52
    v_add_u32 v14, s48, v14
    v_add_u32 v15, s49, v15
    v_sub_u32 v12, v14, v12
    v_sub_u32 v13, v15, v13
    v_and_b32 v8, 0xffff, v12
    v_lshrrev_b32 v9, 16, v12
    v_and_b32 v10, 0xffff, v13
    v_lshrrev_b32 v11, 16, v13
    ds_write2st64_b32 v7, v8, v9 offset0:0 offset1:1
    ds_write2st64_b32 v7, v10, v11 offset0:2 offset1:3
    s_waitcnt lgkmcnt(0)
    s_barrier
    ds_add_rtn_u32 v24, v24, v2
    ds_add_rtn_u32 v25, v25, v2
    ds_add_rtn_u32 v26, v26, v2
    ds_add_rtn_u32 v27, v27, v2
    s_add_u32 s44, s36, 0x7ec0000
    v_and_b32 v11, 0x3f0, v0
    v_add_u32 v11, v11, v11
    buffer_store_dwordx2 v[12:13], v11, s[24:27], s44 offen
    s_bitset0_b64 exec, 63
    s_not_b64 exec, exec
    buffer_store_dwordx2 v[14:15], v11, s[24:27], s44 offen offset:32
    s_mov_b64 exec, -1
    ds_add_rtn_u32 v52, v52, v2
    ds_add_rtn_u32 v53, v53, v2
    ds_add_rtn_u32 v54, v54, v2
    ds_add_rtn_u32 v55, v55, v2
    ds_add_rtn_u32 v72, v72, v2
    ds_add_rtn_u32 v73, v73, v2
    ds_add_rtn_u32 v74, v74, v2
    ds_add_rtn_u32 v75, v75, v2
    s_add_u32 s45, s35, 0x5494000
    buffer_store_dwordx4 v[20:23], v0, s[20:23], s45 offen sc1
    s_add_u32 s46, s33, 0x8400000
    s_nop 0
    buffer_load_dwordx4 v[20:23], v0, s[8:11], s46 offen nt
    ds_add_rtn_u32 v80, v80, v2
    ds_add_rtn_u32 v81, v81, v2
    ds_add_rtn_u32 v82, v82, v2
    ds_add_rtn_u32 v83, v83, v2
    ds_add_rtn_u32 v96, v96, v2
    ds_add_rtn_u32 v97, v97, v2
    ds_add_rtn_u32 v98, v98, v2
    ds_add_rtn_u32 v99, v99, v2
    ds_add_rtn_u32 v108, v108, v2
    ds_add_rtn_u32 v109, v109, v2
    ds_add_rtn_u32 v110, v110, v2
    ds_add_rtn_u32 v111, v111, v2
    s_add_u32 s47, s35, 0x5498000
    buffer_store_dwordx4 v[124:127], v0, s[20:23], s47 offen sc1
    s_add_u32 s44, s33, 0x8400000
    s_nop 0
    buffer_load_dwordx4 v[124:127], v0, s[12:15], s44 offen nt
    ds_add_rtn_u32 v88, v88, v2
    ds_add_rtn_u32 v89, v89, v2
    ds_add_rtn_u32 v90, v90, v2
    ds_add_rtn_u32 v91, v91, v2
    ds_add_rtn_u32 v92, v92, v2
    ds_add_rtn_u32 v93, v93, v2
    ds_add_rtn_u32 v94, v94, v2
    ds_add_rtn_u32 v95, v95, v2
    s_waitcnt lgkmcnt(0)
    s_barrier
    v_and_b32 v7, -4, v24
    v_lshl_add_u32 v8, v24, 2, v7
    ds_write_b32 v8, v40
    v_lshl_add_u32 v7, v7, 2, v24
    ds_write_b8 v7, v84 offset:16
    v_and_b32 v9, -4, v25
    v_lshl_add_u32 v10, v25, 2, v9
    ds_write_b32 v10, v41
    v_lshl_add_u32 v9, v9, 2, v25
    ds_write_b8_d16_hi v9, v84 offset:16
    v_and_b32 v7, -4, v26
    v_lshl_add_u32 v8, v26, 2, v7
    ds_write_b32 v8, v42
    v_lshl_add_u32 v7, v7, 2, v26
    ds_write_b8 v7, v85 offset:16
    v_and_b32 v9, -4, v27
    v_lshl_add_u32 v10, v27, 2, v9
    ds_write_b32 v10, v43
    v_lshl_add_u32 v9, v9, 2, v27
    ds_write_b8_d16_hi v9, v85 offset:16
    s_add_u32 s45, s35, 0x549c000
    buffer_store_dwordx4 v[32:35], v0, s[20:23], s45 offen sc1
    s_add_u32 s46, s33, 0x8800000
    buffer_load_dwordx4 v[40:43], v0, s[8:11], s46 offen nt
    s_add_u32 s47, s33, 0x8800000
    buffer_load_dwordx4 v[24:27], v0, s[12:15], s47 offen nt
    v_and_b32 v7, -4, v52
    v_lshl_add_u32 v8, v52, 2, v7
    ds_write_b32 v8, v48
    v_lshl_add_u32 v7, v7, 2, v52
    ds_write_b8 v7, v86 offset:16
    v_and_b32 v9, -4, v53
    v_lshl_add_u32 v10, v53, 2, v9
    ds_write_b32 v10, v49
    v_lshl_add_u32 v9, v9, 2, v53
    ds_write_b8_d16_hi v9, v86 offset:16
    v_and_b32 v7, -4, v54
    v_lshl_add_u32 v8, v54, 2, v7
    ds_write_b32 v8, v50
    v_lshl_add_u32 v7, v7, 2, v54
    ds_write_b8 v7, v87 offset:16
    v_and_b32 v9, -4, v55
    v_lshl_add_u32 v10, v55, 2, v9
    ds_write_b32 v10, v51
    v_lshl_add_u32 v9, v9, 2, v55
    ds_write_b8_d16_hi v9, v87 offset:16
    s_add_u32 s44, s34, 0x4400000
    buffer_load_dwordx2 v[32:33], v1, s[16:19], s44 offen nt
    s_add_u32 s45, s34, 0x4600000
    buffer_load_dwordx2 v[34:35], v1, s[16:19], s45 offen nt
    s_add_u32 s46, s33, 0x8c00000
    buffer_load_dwordx4 v[48:51], v0, s[8:11], s46 offen nt
    v_and_b32 v7, -4, v72
    v_lshl_add_u32 v8, v72, 2, v7
    ds_write_b32 v8, v68
    v_lshl_add_u32 v7, v7, 2, v72
    ds_write_b8 v7, v56 offset:16
    v_and_b32 v9, -4, v73
    v_lshl_add_u32 v10, v73, 2, v9
    ds_write_b32 v10, v69
    v_lshl_add_u32 v9, v9, 2, v73
    ds_write_b8_d16_hi v9, v56 offset:16
    v_and_b32 v7, -4, v74
    v_lshl_add_u32 v8, v74, 2, v7
    ds_write_b32 v8, v70
    v_lshl_add_u32 v7, v7, 2, v74
    ds_write_b8 v7, v57 offset:16
    v_and_b32 v9, -4, v75
    v_lshl_add_u32 v10, v75, 2, v9
    ds_write_b32 v10, v71
    v_lshl_add_u32 v9, v9, 2, v75
    ds_write_b8_d16_hi v9, v57 offset:16
    s_add_u32 s47, s35, 0x54a0000
    buffer_store_dwordx4 v[36:39], v0, s[20:23], s47 offen sc1
    s_add_u32 s44, s33, 0x8c00000
    buffer_load_dwordx4 v[52:55], v0, s[12:15], s44 offen nt
    v_and_b32 v7, -4, v80
    v_lshl_add_u32 v8, v80, 2, v7
    ds_write_b32 v8, v76
    v_lshl_add_u32 v7, v7, 2, v80
    ds_write_b8 v7, v58 offset:16
    v_and_b32 v9, -4, v81
    v_lshl_add_u32 v10, v81, 2, v9
    ds_write_b32 v10, v77
    v_lshl_add_u32 v9, v9, 2, v81
    ds_write_b8_d16_hi v9, v58 offset:16
    v_and_b32 v7, -4, v82
    v_lshl_add_u32 v8, v82, 2, v7
    ds_write_b32 v8, v78
    v_lshl_add_u32 v7, v7, 2, v82
    ds_write_b8 v7, v59 offset:16
    v_and_b32 v9, -4, v83
    v_lshl_add_u32 v10, v83, 2, v9
    ds_write_b32 v10, v79
    v_lshl_add_u32 v9, v9, 2, v83
    ds_write_b8_d16_hi v9, v59 offset:16
    s_add_u32 s45, s33, 0x9000000
    buffer_load_dwordx4 v[84:87], v0, s[8:11], s45 offen nt
    s_add_u32 s46, s33, 0x9000000
    buffer_load_dwordx4 v[68:71], v0, s[12:15], s46 offen nt
    v_and_b32 v7, -4, v96
    v_lshl_add_u32 v8, v96, 2, v7
    ds_write_b32 v8, v64
    v_lshl_add_u32 v7, v7, 2, v96
    ds_write_b8 v7, v100 offset:16
    v_and_b32 v9, -4, v97
    v_lshl_add_u32 v10, v97, 2, v9
    ds_write_b32 v10, v65
    v_lshl_add_u32 v9, v9, 2, v97
    ds_write_b8_d16_hi v9, v100 offset:16
    v_and_b32 v7, -4, v98
    v_lshl_add_u32 v8, v98, 2, v7
    ds_write_b32 v8, v66
    v_lshl_add_u32 v7, v7, 2, v98
    ds_write_b8 v7, v101 offset:16
    v_and_b32 v9, -4, v99
    v_lshl_add_u32 v10, v99, 2, v9
    ds_write_b32 v10, v67
    v_lshl_add_u32 v9, v9, 2, v99
    ds_write_b8_d16_hi v9, v101 offset:16
    s_add_u32 s47, s34, 0x4800000
    buffer_load_dwordx2 v[72:73], v1, s[16:19], s47 offen nt
    s_cmp_le_u32 s43, 5
    s_cselect_b32 s18, 0, s18
    s_add_u32 s44, s59, 0x4a00000
    buffer_load_dwordx2 v[74:75], v1, s[16:19], s44 offen nt
    s_cmp_le_u32 s43, 5
    s_cselect_b32 s10, 0, s10
    s_add_u32 s45, s58, 0x9400000
    buffer_load_dwordx4 v[36:39], v0, s[8:11], s45 offen nt
    v_and_b32 v7, -4, v108
    v_lshl_add_u32 v8, v108, 2, v7
    ds_write_b32 v8, v60
    v_lshl_add_u32 v7, v7, 2, v108
    ds_write_b8 v7, v102 offset:16
    v_and_b32 v9, -4, v109
    v_lshl_add_u32 v10, v109, 2, v9
    ds_write_b32 v10, v61
    v_lshl_add_u32 v9, v9, 2, v109
    ds_write_b8_d16_hi v9, v102 offset:16
    v_and_b32 v7, -4, v110
    v_lshl_add_u32 v8, v110, 2, v7
    ds_write_b32 v8, v62
    v_lshl_add_u32 v7, v7, 2, v110
    ds_write_b8 v7, v103 offset:16
    v_and_b32 v9, -4, v111
    v_lshl_add_u32 v10, v111, 2, v9
    ds_write_b32 v10, v63
    v_lshl_add_u32 v9, v9, 2, v111
    ds_write_b8_d16_hi v9, v103 offset:16
    s_add_u32 s46, s35, 0x54a4000
    buffer_store_dwordx4 v[28:31], v0, s[20:23], s46 offen sc1
    s_cmp_le_u32 s43, 5
    s_cselect_b32 s14, 0, s14
    s_add_u32 s47, s58, 0x9400000
    buffer_load_dwordx4 v[76:79], v0, s[12:15], s47 offen nt
    v_and_b32 v7, -4, v88
    v_lshl_add_u32 v8, v88, 2, v7
    ds_write_b32 v8, v112
    v_lshl_add_u32 v7, v7, 2, v88
    ds_write_b8 v7, v104 offset:16
    v_and_b32 v9, -4, v89
    v_lshl_add_u32 v10, v89, 2, v9
    ds_write_b32 v10, v113
    v_lshl_add_u32 v9, v9, 2, v89
    ds_write_b8_d16_hi v9, v104 offset:16
    v_and_b32 v7, -4, v90
    v_lshl_add_u32 v8, v90, 2, v7
    ds_write_b32 v8, v114
    v_lshl_add_u32 v7, v7, 2, v90
    ds_write_b8 v7, v105 offset:16
    v_and_b32 v9, -4, v91
    v_lshl_add_u32 v10, v91, 2, v9
    ds_write_b32 v10, v115
    v_lshl_add_u32 v9, v9, 2, v91
    ds_write_b8_d16_hi v9, v105 offset:16
    s_cmp_le_u32 s43, 6
    s_cselect_b32 s10, 0, s10
    s_add_u32 s44, s58, 0x9760000
    buffer_load_dwordx4 v[80:83], v0, s[8:11], s44 offen nt
    s_cmp_le_u32 s43, 6
    s_cselect_b32 s14, 0, s14
    s_add_u32 s45, s58, 0x9760000
    buffer_load_dwordx4 v[56:59], v0, s[12:15], s45 offen nt
    v_and_b32 v7, -4, v92
    v_lshl_add_u32 v8, v92, 2, v7
    ds_write_b32 v8, v116
    v_lshl_add_u32 v7, v7, 2, v92
    ds_write_b8 v7, v106 offset:16
    v_and_b32 v9, -4, v93
    v_lshl_add_u32 v10, v93, 2, v9
    ds_write_b32 v10, v117
    v_lshl_add_u32 v9, v9, 2, v93
    ds_write_b8_d16_hi v9, v106 offset:16
    v_and_b32 v7, -4, v94
    v_lshl_add_u32 v8, v94, 2, v7
    ds_write_b32 v8, v118
    v_lshl_add_u32 v7, v7, 2, v94
    ds_write_b8 v7, v107 offset:16
    v_and_b32 v9, -4, v95
    v_lshl_add_u32 v10, v95, 2, v9
    ds_write_b32 v10, v119
    v_lshl_add_u32 v9, v9, 2, v95
    ds_write_b8_d16_hi v9, v107 offset:16
    s_cmp_le_u32 s43, 6
    s_cselect_b32 s18, 0, s18
    s_add_u32 s46, s59, 0x4bb0000
    buffer_load_dwordx2 v[64:65], v1, s[16:19], s46 offen nt
    s_cmp_le_u32 s43, 7
    s_cselect_b32 s18, 0, s18
    s_add_u32 s47, s59, 0x4d10000
    buffer_load_dwordx2 v[66:67], v1, s[16:19], s47 offen nt
    v_add_u32 v7, 0x10000, v0
    v_add_u32 v12, 0x20000, v0
    v_mov_b32 v8, 0
    v_mov_b32 v9, 0
    v_mov_b32 v10, 0
    v_mov_b32 v11, 0
    s_waitcnt lgkmcnt(0)
    s_barrier
    ds_read_b128 v[96:99], v0 offset:0
    ds_write_b128 v0, v[8:11]
    ds_read_b128 v[60:63], v0 offset:16384
    ds_read_b128 v[108:111], v0 offset:32768
    ds_read_b128 v[100:103], v0 offset:49152
    ds_read_b128 v[28:31], v7 offset:0
    ds_read_b128 v[112:115], v7 offset:16384
    ds_read_b128 v[88:91], v7 offset:32768
    ds_read_b128 v[116:119], v7 offset:49152
    ds_read_b128 v[92:95], v12 offset:0
    ds_read_b128 v[104:107], v12 offset:16384
    s_waitcnt lgkmcnt(0)
    s_barrier
    s_add_u32 s44, s35, 0x7ec0000
    buffer_store_dwordx4 v[96:99], v0, s[20:23], s44 offen sc1
    s_cmp_le_u32 s43, 7
    s_cselect_b32 s10, 0, s10
    s_add_u32 s45, s58, 0x9a20000
    buffer_load_dwordx4 v[96:99], v0, s[8:11], s45 offen nt
    s_add_u32 s46, s35, 0x7ec4000
    buffer_store_dwordx4 v[60:63], v0, s[20:23], s46 offen sc1
    s_cmp_le_u32 s43, 7
    s_cselect_b32 s14, 0, s14
    s_add_u32 s47, s58, 0x9a20000
    buffer_load_dwordx4 v[60:63], v0, s[12:15], s47 offen nt
    s_waitcnt vmcnt(29)
    v_lshlrev_b32 v7, 16, v44
    v_and_b32 v8, 0xffff0000, v44
    v_lshlrev_b32 v9, 16, v45
    v_and_b32 v10, 0xffff0000, v45
    v_mul_f32 v7, 0.15915494, v7
    v_mul_f32 v8, 0.15915494, v8
    v_mul_f32 v9, 0.15915494, v9
    v_mul_f32 v10, 0.15915494, v10
    v_mul_hi_u32_u24 v14, 429497, v16
    v_lshrrev_b32 v12, 3, v120
    v_cos_f32 v7, v7
    v_lshlrev_b16 v13, 3, v120
    v_mad_i32_i24 v11, v14, s55, v16
    v_bitop3_b32 v12, v6, v13, v12 bitop3:0xca
    v_add_lshl_u32 v11, v11, s40, 17
    v_lshlrev_b16 v14, 8, v14
    v_lshrrev_b32 v13, 2, v120
    v_or_b32 v16, v12, v11
    v_bitop3_b32 v120, v5, v13, v14 bitop3:0xea
    ds_add_u32 v120, v2
    v_mul_hi_u32_u24 v14, 429497, v17
    v_lshrrev_b32 v12, 3, v121
    v_cos_f32 v8, v8
    v_lshlrev_b16 v13, 3, v121
    v_mad_i32_i24 v11, v14, s55, v17
    v_bitop3_b32 v12, v6, v13, v12 bitop3:0xca
    v_add_lshl_u32 v11, v11, s40, 17
    v_lshlrev_b16 v14, 8, v14
    v_lshrrev_b32 v13, 2, v121
    v_or_b32 v17, v12, v11
    v_bitop3_b32 v121, v5, v13, v14 bitop3:0xea
    ds_add_u32 v121, v2
    v_cvt_pk_bf16_f32 v44, v7, v8
    v_perm_b32 v12, v44, v44, s41
    v_bitop3_b32 v16, v4, v12, v16 bitop3:0xca
    v_perm_b32 v13, v44, v44, s42
    v_bitop3_b32 v17, v4, v13, v17 bitop3:0xca
    v_mul_hi_u32_u24 v14, 429497, v18
    v_lshrrev_b32 v12, 3, v122
    v_cos_f32 v9, v9
    v_lshlrev_b16 v13, 3, v122
    v_mad_i32_i24 v11, v14, s55, v18
    v_bitop3_b32 v12, v6, v13, v12 bitop3:0xca
    v_add_lshl_u32 v11, v11, s40, 17
    v_lshlrev_b16 v14, 8, v14
    v_lshrrev_b32 v13, 2, v122
    v_or_b32 v18, v12, v11
    v_bitop3_b32 v122, v5, v13, v14 bitop3:0xea
    ds_add_u32 v122, v2
    v_mul_hi_u32_u24 v14, 429497, v19
    v_lshrrev_b32 v12, 3, v123
    v_cos_f32 v10, v10
    v_lshlrev_b16 v13, 3, v123
    v_mad_i32_i24 v11, v14, s55, v19
    v_bitop3_b32 v12, v6, v13, v12 bitop3:0xca
    v_add_lshl_u32 v11, v11, s40, 17
    v_lshlrev_b16 v14, 8, v14
    v_lshrrev_b32 v13, 2, v123
    v_or_b32 v19, v12, v11
    v_bitop3_b32 v123, v5, v13, v14 bitop3:0xea
    ds_add_u32 v123, v2
    v_cvt_pk_bf16_f32 v45, v9, v10
    v_perm_b32 v12, v45, v45, s41
    v_bitop3_b32 v18, v4, v12, v18 bitop3:0xca
    v_perm_b32 v13, v45, v45, s42
    v_bitop3_b32 v19, v4, v13, v19 bitop3:0xca
    s_add_u32 s44, s35, 0x7ec8000
    buffer_store_dwordx4 v[108:111], v0, s[20:23], s44 offen sc1
    s_waitcnt vmcnt(24)
    v_lshlrev_b32 v7, 16, v46
    v_and_b32 v8, 0xffff0000, v46
    v_lshlrev_b32 v9, 16, v47
    v_and_b32 v10, 0xffff0000, v47
    v_mul_f32 v7, 0.15915494, v7
    v_mul_f32 v8, 0.15915494, v8
    v_mul_f32 v9, 0.15915494, v9
    v_mul_f32 v10, 0.15915494, v10
    v_mul_hi_u32_u24 v14, 429497, v20
    v_lshrrev_b32 v12, 3, v124
    v_cos_f32 v7, v7
    v_lshlrev_b16 v13, 3, v124
    v_mad_i32_i24 v11, v14, s55, v20
    v_bitop3_b32 v12, v6, v13, v12 bitop3:0xca
    v_add_lshl_u32 v11, v11, s40, 17
    v_lshlrev_b16 v14, 8, v14
    v_lshrrev_b32 v13, 2, v124
    v_or_b32 v20, v12, v11
    v_bitop3_b32 v124, v5, v13, v14 bitop3:0xea
    ds_add_u32 v124, v2
    v_mul_hi_u32_u24 v14, 429497, v21
    v_lshrrev_b32 v12, 3, v125
    v_cos_f32 v8, v8
    v_lshlrev_b16 v13, 3, v125
    v_mad_i32_i24 v11, v14, s55, v21
    v_bitop3_b32 v12, v6, v13, v12 bitop3:0xca
    v_add_lshl_u32 v11, v11, s40, 17
    v_lshlrev_b16 v14, 8, v14
    v_lshrrev_b32 v13, 2, v125
    v_or_b32 v21, v12, v11
    v_bitop3_b32 v125, v5, v13, v14 bitop3:0xea
    ds_add_u32 v125, v2
    v_cvt_pk_bf16_f32 v46, v7, v8
    v_perm_b32 v12, v46, v46, s41
    v_bitop3_b32 v20, v4, v12, v20 bitop3:0xca
    v_perm_b32 v13, v46, v46, s42
    v_bitop3_b32 v21, v4, v13, v21 bitop3:0xca
    v_mul_hi_u32_u24 v14, 429497, v22
    v_lshrrev_b32 v12, 3, v126
    v_cos_f32 v9, v9
    v_lshlrev_b16 v13, 3, v126
    v_mad_i32_i24 v11, v14, s55, v22
    v_bitop3_b32 v12, v6, v13, v12 bitop3:0xca
    v_add_lshl_u32 v11, v11, s40, 17
    v_lshlrev_b16 v14, 8, v14
    v_lshrrev_b32 v13, 2, v126
    v_or_b32 v22, v12, v11
    v_bitop3_b32 v126, v5, v13, v14 bitop3:0xea
    ds_add_u32 v126, v2
    v_mul_hi_u32_u24 v14, 429497, v23
    v_lshrrev_b32 v12, 3, v127
    v_cos_f32 v10, v10
    v_lshlrev_b16 v13, 3, v127
    v_mad_i32_i24 v11, v14, s55, v23
    v_bitop3_b32 v12, v6, v13, v12 bitop3:0xca
    v_add_lshl_u32 v11, v11, s40, 17
    v_lshlrev_b16 v14, 8, v14
    v_lshrrev_b32 v13, 2, v127
    v_or_b32 v23, v12, v11
    v_bitop3_b32 v127, v5, v13, v14 bitop3:0xea
    ds_add_u32 v127, v2
    v_cvt_pk_bf16_f32 v47, v9, v10
    v_perm_b32 v12, v47, v47, s41
    v_bitop3_b32 v22, v4, v12, v22 bitop3:0xca
    v_perm_b32 v13, v47, v47, s42
    v_bitop3_b32 v23, v4, v13, v23 bitop3:0xca
    s_waitcnt vmcnt(19)
    v_lshlrev_b32 v7, 16, v32
    v_and_b32 v8, 0xffff0000, v32
    v_lshlrev_b32 v9, 16, v33
    v_and_b32 v10, 0xffff0000, v33
    v_mul_f32 v7, 0.15915494, v7
    v_mul_f32 v8, 0.15915494, v8
    v_mul_f32 v9, 0.15915494, v9
    v_mul_f32 v10, 0.15915494, v10
    v_mul_hi_u32_u24 v14, 429497, v40
    v_lshrrev_b32 v12, 3, v24
    v_cos_f32 v7, v7
    v_lshlrev_b16 v13, 3, v24
    v_mad_i32_i24 v11, v14, s55, v40
    v_bitop3_b32 v12, v6, v13, v12 bitop3:0xca
    v_add_lshl_u32 v11, v11, s40, 17
    v_lshlrev_b16 v14, 8, v14
    v_lshrrev_b32 v13, 2, v24
    v_or_b32 v40, v12, v11
    v_bitop3_b32 v24, v5, v13, v14 bitop3:0xea
    ds_add_u32 v24, v2
    v_mul_hi_u32_u24 v14, 429497, v41
    v_lshrrev_b32 v12, 3, v25
    v_cos_f32 v8, v8
    v_lshlrev_b16 v13, 3, v25
    v_mad_i32_i24 v11, v14, s55, v41
    v_bitop3_b32 v12, v6, v13, v12 bitop3:0xca
    v_add_lshl_u32 v11, v11, s40, 17
    v_lshlrev_b16 v14, 8, v14
    v_lshrrev_b32 v13, 2, v25
    v_or_b32 v41, v12, v11
    v_bitop3_b32 v25, v5, v13, v14 bitop3:0xea
    ds_add_u32 v25, v2
    v_cvt_pk_bf16_f32 v32, v7, v8
    v_perm_b32 v12, v32, v32, s41
    v_bitop3_b32 v40, v4, v12, v40 bitop3:0xca
    v_perm_b32 v13, v32, v32, s42
    v_bitop3_b32 v41, v4, v13, v41 bitop3:0xca
    v_mul_hi_u32_u24 v14, 429497, v42
    v_lshrrev_b32 v12, 3, v26
    v_cos_f32 v9, v9
    v_lshlrev_b16 v13, 3, v26
    v_mad_i32_i24 v11, v14, s55, v42
    v_bitop3_b32 v12, v6, v13, v12 bitop3:0xca
    v_add_lshl_u32 v11, v11, s40, 17
    v_lshlrev_b16 v14, 8, v14
    v_lshrrev_b32 v13, 2, v26
    v_or_b32 v42, v12, v11
    v_bitop3_b32 v26, v5, v13, v14 bitop3:0xea
    ds_add_u32 v26, v2
    v_mul_hi_u32_u24 v14, 429497, v43
    v_lshrrev_b32 v12, 3, v27
    v_cos_f32 v10, v10
    v_lshlrev_b16 v13, 3, v27
    v_mad_i32_i24 v11, v14, s55, v43
    v_bitop3_b32 v12, v6, v13, v12 bitop3:0xca
    v_add_lshl_u32 v11, v11, s40, 17
    v_lshlrev_b16 v14, 8, v14
    v_lshrrev_b32 v13, 2, v27
    v_or_b32 v43, v12, v11
    v_bitop3_b32 v27, v5, v13, v14 bitop3:0xea
    ds_add_u32 v27, v2
    v_cvt_pk_bf16_f32 v33, v9, v10
    v_perm_b32 v12, v33, v33, s41
    v_bitop3_b32 v42, v4, v12, v42 bitop3:0xca
    v_perm_b32 v13, v33, v33, s42
    v_bitop3_b32 v43, v4, v13, v43 bitop3:0xca
    s_waitcnt vmcnt(16)
    v_lshlrev_b32 v7, 16, v34
    v_and_b32 v8, 0xffff0000, v34
    v_lshlrev_b32 v9, 16, v35
    v_and_b32 v10, 0xffff0000, v35
    v_mul_f32 v7, 0.15915494, v7
    v_mul_f32 v8, 0.15915494, v8
    v_mul_f32 v9, 0.15915494, v9
    v_mul_f32 v10, 0.15915494, v10
    v_mul_hi_u32_u24 v14, 429497, v48
    v_lshrrev_b32 v12, 3, v52
    v_cos_f32 v7, v7
    v_lshlrev_b16 v13, 3, v52
    v_mad_i32_i24 v11, v14, s55, v48
    v_bitop3_b32 v12, v6, v13, v12 bitop3:0xca
    v_add_lshl_u32 v11, v11, s40, 17
    v_lshlrev_b16 v14, 8, v14
    v_lshrrev_b32 v13, 2, v52
    v_or_b32 v48, v12, v11
    v_bitop3_b32 v52, v5, v13, v14 bitop3:0xea
    ds_add_u32 v52, v2
    v_mul_hi_u32_u24 v14, 429497, v49
    v_lshrrev_b32 v12, 3, v53
    v_cos_f32 v8, v8
    v_lshlrev_b16 v13, 3, v53
    v_mad_i32_i24 v11, v14, s55, v49
    v_bitop3_b32 v12, v6, v13, v12 bitop3:0xca
    v_add_lshl_u32 v11, v11, s40, 17
    v_lshlrev_b16 v14, 8, v14
    v_lshrrev_b32 v13, 2, v53
    v_or_b32 v49, v12, v11
    v_bitop3_b32 v53, v5, v13, v14 bitop3:0xea
    ds_add_u32 v53, v2
    v_cvt_pk_bf16_f32 v34, v7, v8
    v_perm_b32 v12, v34, v34, s41
    v_bitop3_b32 v48, v4, v12, v48 bitop3:0xca
    v_perm_b32 v13, v34, v34, s42
    v_bitop3_b32 v49, v4, v13, v49 bitop3:0xca
    v_mul_hi_u32_u24 v14, 429497, v50
    v_lshrrev_b32 v12, 3, v54
    v_cos_f32 v9, v9
    v_lshlrev_b16 v13, 3, v54
    v_mad_i32_i24 v11, v14, s55, v50
    v_bitop3_b32 v12, v6, v13, v12 bitop3:0xca
    v_add_lshl_u32 v11, v11, s40, 17
    v_lshlrev_b16 v14, 8, v14
    v_lshrrev_b32 v13, 2, v54
    v_or_b32 v50, v12, v11
    v_bitop3_b32 v54, v5, v13, v14 bitop3:0xea
    ds_add_u32 v54, v2
    v_mul_hi_u32_u24 v14, 429497, v51
    v_lshrrev_b32 v12, 3, v55
    v_cos_f32 v10, v10
    v_lshlrev_b16 v13, 3, v55
    v_mad_i32_i24 v11, v14, s55, v51
    v_bitop3_b32 v12, v6, v13, v12 bitop3:0xca
    v_add_lshl_u32 v11, v11, s40, 17
    v_lshlrev_b16 v14, 8, v14
    v_lshrrev_b32 v13, 2, v55
    v_or_b32 v51, v12, v11
    v_bitop3_b32 v55, v5, v13, v14 bitop3:0xea
    ds_add_u32 v55, v2
    v_cvt_pk_bf16_f32 v35, v9, v10
    v_perm_b32 v12, v35, v35, s41
    v_bitop3_b32 v50, v4, v12, v50 bitop3:0xca
    v_perm_b32 v13, v35, v35, s42
    v_bitop3_b32 v51, v4, v13, v51 bitop3:0xca
    s_add_u32 s45, s35, 0x7ecc000
    buffer_store_dwordx4 v[100:103], v0, s[20:23], s45 offen sc1
    buffer_load_dwordx4 v[108:111], v0, s[80:83], 0 offen
    v_add_u32 v15, 0x4000, v0
    buffer_load_dwordx4 v[108:111], v15, s[80:83], 0 offen
    s_waitcnt vmcnt(15)
    v_lshlrev_b32 v7, 16, v72
    v_and_b32 v8, 0xffff0000, v72
    v_lshlrev_b32 v9, 16, v73
    v_and_b32 v10, 0xffff0000, v73
    v_mul_f32 v7, 0.15915494, v7
    v_mul_f32 v8, 0.15915494, v8
    v_mul_f32 v9, 0.15915494, v9
    v_mul_f32 v10, 0.15915494, v10
    v_mul_hi_u32_u24 v14, 429497, v84
    v_lshrrev_b32 v12, 3, v68
    v_cos_f32 v7, v7
    v_lshlrev_b16 v13, 3, v68
    v_mad_i32_i24 v11, v14, s55, v84
    v_bitop3_b32 v12, v6, v13, v12 bitop3:0xca
    v_add_lshl_u32 v11, v11, s40, 17
    v_lshlrev_b16 v14, 8, v14
    v_lshrrev_b32 v13, 2, v68
    v_or_b32 v84, v12, v11
    v_bitop3_b32 v68, v5, v13, v14 bitop3:0xea
    ds_add_u32 v68, v2
    v_mul_hi_u32_u24 v14, 429497, v85
    v_lshrrev_b32 v12, 3, v69
    v_cos_f32 v8, v8
    v_lshlrev_b16 v13, 3, v69
    v_mad_i32_i24 v11, v14, s55, v85
    v_bitop3_b32 v12, v6, v13, v12 bitop3:0xca
    v_add_lshl_u32 v11, v11, s40, 17
    v_lshlrev_b16 v14, 8, v14
    v_lshrrev_b32 v13, 2, v69
    v_or_b32 v85, v12, v11
    v_bitop3_b32 v69, v5, v13, v14 bitop3:0xea
    ds_add_u32 v69, v2
    v_cvt_pk_bf16_f32 v72, v7, v8
    v_perm_b32 v12, v72, v72, s41
    v_bitop3_b32 v84, v4, v12, v84 bitop3:0xca
    v_perm_b32 v13, v72, v72, s42
    v_bitop3_b32 v85, v4, v13, v85 bitop3:0xca
    v_mul_hi_u32_u24 v14, 429497, v86
    v_lshrrev_b32 v12, 3, v70
    v_cos_f32 v9, v9
    v_lshlrev_b16 v13, 3, v70
    v_mad_i32_i24 v11, v14, s55, v86
    v_bitop3_b32 v12, v6, v13, v12 bitop3:0xca
    v_add_lshl_u32 v11, v11, s40, 17
    v_lshlrev_b16 v14, 8, v14
    v_lshrrev_b32 v13, 2, v70
    v_or_b32 v86, v12, v11
    v_bitop3_b32 v70, v5, v13, v14 bitop3:0xea
    ds_add_u32 v70, v2
    v_mul_hi_u32_u24 v14, 429497, v87
    v_lshrrev_b32 v12, 3, v71
    v_cos_f32 v10, v10
    v_lshlrev_b16 v13, 3, v71
    v_mad_i32_i24 v11, v14, s55, v87
    v_bitop3_b32 v12, v6, v13, v12 bitop3:0xca
    v_add_lshl_u32 v11, v11, s40, 17
    v_lshlrev_b16 v14, 8, v14
    v_lshrrev_b32 v13, 2, v71
    v_or_b32 v87, v12, v11
    v_bitop3_b32 v71, v5, v13, v14 bitop3:0xea
    ds_add_u32 v71, v2
    v_cvt_pk_bf16_f32 v73, v9, v10
    v_perm_b32 v12, v73, v73, s41
    v_bitop3_b32 v86, v4, v12, v86 bitop3:0xca
    v_perm_b32 v13, v73, v73, s42
    v_bitop3_b32 v87, v4, v13, v87 bitop3:0xca
    s_waitcnt vmcnt(12)
    s_cmp_le_u32 s43, 5
    s_cbranch_scc1 L1_s1
    v_lshlrev_b32 v7, 16, v74
    v_and_b32 v8, 0xffff0000, v74
    v_lshlrev_b32 v9, 16, v75
    v_and_b32 v10, 0xffff0000, v75
    v_mul_f32 v7, 0.15915494, v7
    v_mul_f32 v8, 0.15915494, v8
    v_mul_f32 v9, 0.15915494, v9
    v_mul_f32 v10, 0.15915494, v10
    v_mul_hi_u32_u24 v14, 429497, v36
    v_lshrrev_b32 v12, 3, v76
    v_cos_f32 v7, v7
    v_lshlrev_b16 v13, 3, v76
    v_mad_i32_i24 v11, v14, s55, v36
    v_bitop3_b32 v12, v6, v13, v12 bitop3:0xca
    v_add_lshl_u32 v11, v11, s40, 17
    v_lshlrev_b16 v14, 8, v14
    v_lshrrev_b32 v13, 2, v76
    v_or_b32 v36, v12, v11
    v_bitop3_b32 v76, v5, v13, v14 bitop3:0xea
    ds_add_u32 v76, v2
    v_mul_hi_u32_u24 v14, 429497, v37
    v_lshrrev_b32 v12, 3, v77
    v_cos_f32 v8, v8
    v_lshlrev_b16 v13, 3, v77
    v_mad_i32_i24 v11, v14, s55, v37
    v_bitop3_b32 v12, v6, v13, v12 bitop3:0xca
    v_add_lshl_u32 v11, v11, s40, 17
    v_lshlrev_b16 v14, 8, v14
    v_lshrrev_b32 v13, 2, v77
    v_or_b32 v37, v12, v11
    v_bitop3_b32 v77, v5, v13, v14 bitop3:0xea
    ds_add_u32 v77, v2
    v_cvt_pk_bf16_f32 v74, v7, v8
    v_perm_b32 v12, v74, v74, s41
    v_bitop3_b32 v36, v4, v12, v36 bitop3:0xca
    v_perm_b32 v13, v74, v74, s42
    v_bitop3_b32 v37, v4, v13, v37 bitop3:0xca
    v_mul_hi_u32_u24 v14, 429497, v38
    v_lshrrev_b32 v12, 3, v78
    v_cos_f32 v9, v9
    v_lshlrev_b16 v13, 3, v78
    v_mad_i32_i24 v11, v14, s55, v38
    v_bitop3_b32 v12, v6, v13, v12 bitop3:0xca
    v_add_lshl_u32 v11, v11, s40, 17
    v_lshlrev_b16 v14, 8, v14
    v_lshrrev_b32 v13, 2, v78
    v_or_b32 v38, v12, v11
    v_bitop3_b32 v78, v5, v13, v14 bitop3:0xea
    ds_add_u32 v78, v2
    v_mul_hi_u32_u24 v14, 429497, v39
    v_lshrrev_b32 v12, 3, v79
    v_cos_f32 v10, v10
    v_lshlrev_b16 v13, 3, v79
    v_mad_i32_i24 v11, v14, s55, v39
    v_bitop3_b32 v12, v6, v13, v12 bitop3:0xca
    v_add_lshl_u32 v11, v11, s40, 17
    v_lshlrev_b16 v14, 8, v14
    v_lshrrev_b32 v13, 2, v79
    v_or_b32 v39, v12, v11
    v_bitop3_b32 v79, v5, v13, v14 bitop3:0xea
    ds_add_u32 v79, v2
    v_cvt_pk_bf16_f32 v75, v9, v10
    v_perm_b32 v12, v75, v75, s41
    v_bitop3_b32 v38, v4, v12, v38 bitop3:0xca
    v_perm_b32 v13, v75, v75, s42
    v_bitop3_b32 v39, v4, v13, v39 bitop3:0xca
L1_s1:
    s_waitcnt vmcnt(8)
    s_cmp_le_u32 s43, 6
    s_cbranch_scc1 L1_s2
    v_lshlrev_b32 v7, 16, v64
    v_and_b32 v8, 0xffff0000, v64
    v_lshlrev_b32 v9, 16, v65
    v_and_b32 v10, 0xffff0000, v65
    v_mul_f32 v7, 0.15915494, v7
    v_mul_f32 v8, 0.15915494, v8
    v_mul_f32 v9, 0.15915494, v9
    v_mul_f32 v10, 0.15915494, v10
    v_mul_hi_u32_u24 v14, 429497, v80
    v_lshrrev_b32 v12, 3, v56
    v_cos_f32 v7, v7
    v_lshlrev_b16 v13, 3, v56
    v_mad_i32_i24 v11, v14, s55, v80
    v_bitop3_b32 v12, v6, v13, v12 bitop3:0xca
    v_add_lshl_u32 v11, v11, s40, 17
    v_lshlrev_b16 v14, 8, v14
    v_lshrrev_b32 v13, 2, v56
    v_or_b32 v80, v12, v11
    v_bitop3_b32 v56, v5, v13, v14 bitop3:0xea
    ds_add_u32 v56, v2
    v_mul_hi_u32_u24 v14, 429497, v81
    v_lshrrev_b32 v12, 3, v57
    v_cos_f32 v8, v8
    v_lshlrev_b16 v13, 3, v57
    v_mad_i32_i24 v11, v14, s55, v81
    v_bitop3_b32 v12, v6, v13, v12 bitop3:0xca
    v_add_lshl_u32 v11, v11, s40, 17
    v_lshlrev_b16 v14, 8, v14
    v_lshrrev_b32 v13, 2, v57
    v_or_b32 v81, v12, v11
    v_bitop3_b32 v57, v5, v13, v14 bitop3:0xea
    ds_add_u32 v57, v2
    v_cvt_pk_bf16_f32 v64, v7, v8
    v_perm_b32 v12, v64, v64, s41
    v_bitop3_b32 v80, v4, v12, v80 bitop3:0xca
    v_perm_b32 v13, v64, v64, s42
    v_bitop3_b32 v81, v4, v13, v81 bitop3:0xca
    v_mul_hi_u32_u24 v14, 429497, v82
    v_lshrrev_b32 v12, 3, v58
    v_cos_f32 v9, v9
    v_lshlrev_b16 v13, 3, v58
    v_mad_i32_i24 v11, v14, s55, v82
    v_bitop3_b32 v12, v6, v13, v12 bitop3:0xca
    v_add_lshl_u32 v11, v11, s40, 17
    v_lshlrev_b16 v14, 8, v14
    v_lshrrev_b32 v13, 2, v58
    v_or_b32 v82, v12, v11
    v_bitop3_b32 v58, v5, v13, v14 bitop3:0xea
    ds_add_u32 v58, v2
    v_mul_hi_u32_u24 v14, 429497, v83
    v_lshrrev_b32 v12, 3, v59
    v_cos_f32 v10, v10
    v_lshlrev_b16 v13, 3, v59
    v_mad_i32_i24 v11, v14, s55, v83
    v_bitop3_b32 v12, v6, v13, v12 bitop3:0xca
    v_add_lshl_u32 v11, v11, s40, 17
    v_lshlrev_b16 v14, 8, v14
    v_lshrrev_b32 v13, 2, v59
    v_or_b32 v83, v12, v11
    v_bitop3_b32 v59, v5, v13, v14 bitop3:0xea
    ds_add_u32 v59, v2
    v_cvt_pk_bf16_f32 v65, v9, v10
    v_perm_b32 v12, v65, v65, s41
    v_bitop3_b32 v82, v4, v12, v82 bitop3:0xca
    v_perm_b32 v13, v65, v65, s42
    v_bitop3_b32 v83, v4, v13, v83 bitop3:0xca
L1_s2:
    s_waitcnt vmcnt(4)
    s_cmp_le_u32 s43, 7
    s_cbranch_scc1 L1_s3
    v_lshlrev_b32 v7, 16, v66
    v_and_b32 v8, 0xffff0000, v66
    v_lshlrev_b32 v9, 16, v67
    v_and_b32 v10, 0xffff0000, v67
    v_mul_f32 v7, 0.15915494, v7
    v_mul_f32 v8, 0.15915494, v8
    v_mul_f32 v9, 0.15915494, v9
    v_mul_f32 v10, 0.15915494, v10
    v_mul_hi_u32_u24 v14, 429497, v96
    v_lshrrev_b32 v12, 3, v60
    v_cos_f32 v7, v7
    v_lshlrev_b16 v13, 3, v60
    v_mad_i32_i24 v11, v14, s55, v96
    v_bitop3_b32 v12, v6, v13, v12 bitop3:0xca
    v_add_lshl_u32 v11, v11, s40, 17
    v_lshlrev_b16 v14, 8, v14
    v_lshrrev_b32 v13, 2, v60
    v_or_b32 v96, v12, v11
    v_bitop3_b32 v60, v5, v13, v14 bitop3:0xea
    ds_add_u32 v60, v2
    v_mul_hi_u32_u24 v14, 429497, v97
    v_lshrrev_b32 v12, 3, v61
    v_cos_f32 v8, v8
    v_lshlrev_b16 v13, 3, v61
    v_mad_i32_i24 v11, v14, s55, v97
    v_bitop3_b32 v12, v6, v13, v12 bitop3:0xca
    v_add_lshl_u32 v11, v11, s40, 17
    v_lshlrev_b16 v14, 8, v14
    v_lshrrev_b32 v13, 2, v61
    v_or_b32 v97, v12, v11
    v_bitop3_b32 v61, v5, v13, v14 bitop3:0xea
    ds_add_u32 v61, v2
    v_cvt_pk_bf16_f32 v66, v7, v8
    v_perm_b32 v12, v66, v66, s41
    v_bitop3_b32 v96, v4, v12, v96 bitop3:0xca
    v_perm_b32 v13, v66, v66, s42
    v_bitop3_b32 v97, v4, v13, v97 bitop3:0xca
    v_mul_hi_u32_u24 v14, 429497, v98
    v_lshrrev_b32 v12, 3, v62
    v_cos_f32 v9, v9
    v_lshlrev_b16 v13, 3, v62
    v_mad_i32_i24 v11, v14, s55, v98
    v_bitop3_b32 v12, v6, v13, v12 bitop3:0xca
    v_add_lshl_u32 v11, v11, s40, 17
    v_lshlrev_b16 v14, 8, v14
    v_lshrrev_b32 v13, 2, v62
    v_or_b32 v98, v12, v11
    v_bitop3_b32 v62, v5, v13, v14 bitop3:0xea
    ds_add_u32 v62, v2
    v_mul_hi_u32_u24 v14, 429497, v99
    v_lshrrev_b32 v12, 3, v63
    v_cos_f32 v10, v10
    v_lshlrev_b16 v13, 3, v63
    v_mad_i32_i24 v11, v14, s55, v99
    v_bitop3_b32 v12, v6, v13, v12 bitop3:0xca
    v_add_lshl_u32 v11, v11, s40, 17
    v_lshlrev_b16 v14, 8, v14
    v_lshrrev_b32 v13, 2, v63
    v_or_b32 v99, v12, v11
    v_bitop3_b32 v63, v5, v13, v14 bitop3:0xea
    ds_add_u32 v63, v2
    v_cvt_pk_bf16_f32 v67, v9, v10
    v_perm_b32 v12, v67, v67, s41
    v_bitop3_b32 v98, v4, v12, v98 bitop3:0xca
    v_perm_b32 v13, v67, v67, s42
    v_bitop3_b32 v99, v4, v13, v99 bitop3:0xca
L1_s3:
    v_lshrrev_b32 v8, 2, v0
    v_and_b32 v7, 0x3c00, v0
    v_bitop3_b32 v7, v5, v8, v7 bitop3:0xea
    s_waitcnt lgkmcnt(0)
    s_barrier
    ds_read2st64_b32 v[8:9], v7 offset0:0 offset1:1
    ds_read2st64_b32 v[10:11], v7 offset0:2 offset1:3
    s_add_u32 s46, s35, 0x7ed0000
    buffer_store_dwordx4 v[28:31], v0, s[20:23], s46 offen sc1
    s_waitcnt lgkmcnt(0)
    v_lshl_or_b32 v12, v9, 16, v8
    v_lshl_or_b32 v13, v11, 16, v10
    v_mov_b32 v14, v12
    v_mov_b32 v15, v13
    s_nop 0
    v_add_u32_dpp v14, v14, v14 row_shr:1 row_mask:0xf bank_mask:0xf bound_ctrl:1
    v_add_u32_dpp v15, v15, v15 row_shr:1 row_mask:0xf bank_mask:0xf bound_ctrl:1
    s_nop 0
    v_add_u32_dpp v14, v14, v14 row_shr:2 row_mask:0xf bank_mask:0xf bound_ctrl:1
    v_add_u32_dpp v15, v15, v15 row_shr:2 row_mask:0xf bank_mask:0xf bound_ctrl:1
    s_nop 0
    v_add_u32_dpp v14, v14, v14 row_shr:4 row_mask:0xf bank_mask:0xf bound_ctrl:1
    v_add_u32_dpp v15, v15, v15 row_shr:4 row_mask:0xf bank_mask:0xf bound_ctrl:1
    s_nop 0
    v_add_u32_dpp v14, v14, v14 row_shr:8 row_mask:0xf bank_mask:0xf bound_ctrl:1
    v_add_u32_dpp v15, v15, v15 row_shr:8 row_mask:0xf bank_mask:0xf bound_ctrl:1
    s_nop 0
    v_add_u32_dpp v14, v14, v14 row_bcast:15 row_mask:0xa bank_mask:0xf
    v_add_u32_dpp v15, v15, v15 row_bcast:15 row_mask:0xa bank_mask:0xf
    s_nop 0
    v_add_u32_dpp v14, v14, v14 row_bcast:31 row_mask:0xc bank_mask:0xf
    v_add_u32_dpp v15, v15, v15 row_bcast:31 row_mask:0xc bank_mask:0xf
    v_readlane_b32 s48, v14, 63
    v_readlane_b32 s49, v15, 63
    s_lshl_b32 s54, s32, 2
    v_mov_b32 v8, s54
    s_and_b32 s50, s48, 0xffff
    s_lshr_b32 s51, s48, 16
    s_and_b32 s52, s49, 0xffff
    s_lshr_b32 s53, s49, 16
    s_add_u32 s51, s51, s50
    s_add_u32 s52, s52, s51
    s_add_u32 s53, s53, s52
    v_mov_b32 v9, s53
    s_mov_b64 exec, 1
    ds_write_b32 v8, v9 offset:16384
    s_mov_b64 exec, -1
    v_and_b32 v8, 60, v7
    s_waitcnt lgkmcnt(0)
    s_barrier
    ds_read_b32 v9, v8 offset:16384
    s_waitcnt lgkmcnt(0)
    v_add_u32_dpp v9, v9, v9 row_shr:1 row_mask:0xf bank_mask:0xf bound_ctrl:1
    s_nop 1
    v_add_u32_dpp v9, v9, v9 row_shr:2 row_mask:0xf bank_mask:0xf bound_ctrl:1
    s_nop 1
    v_add_u32_dpp v9, v9, v9 row_shr:4 row_mask:0xf bank_mask:0xf bound_ctrl:1
    s_nop 1
    v_add_u32_dpp v9, v9, v9 row_shr:8 row_mask:0xf bank_mask:0xf bound_ctrl:1
    s_nop 0
    v_readlane_b32 s54, v9, s32
    s_sub_u32 s54, s54, s53
    s_add_u32 s50, s50, s54
    s_add_u32 s51, s51, s54
    s_add_u32 s52, s52, s54
    s_pack_ll_b32_b16 s48, s54, s50
    s_pack_ll_b32_b16 s49, s51, s52
    v_add_u32 v14, s48, v14
    v_add_u32 v15, s49, v15
    v_sub_u32 v12, v14, v12
    v_sub_u32 v13, v15, v13
    v_and_b32 v8, 0xffff, v12
    v_lshrrev_b32 v9, 16, v12
    v_and_b32 v10, 0xffff, v13
    v_lshrrev_b32 v11, 16, v13
    ds_write2st64_b32 v7, v8, v9 offset0:0 offset1:1
    ds_write2st64_b32 v7, v10, v11 offset0:2 offset1:3
    s_waitcnt lgkmcnt(0)
    s_barrier
    ds_add_rtn_u32 v120, v120, v2
    ds_add_rtn_u32 v121, v121, v2
    ds_add_rtn_u32 v122, v122, v2
    ds_add_rtn_u32 v123, v123, v2
    s_add_u32 s47, s36, 0xa900000
    v_and_b32 v11, 0x3f0, v0
    v_add_u32 v11, v11, v11
    buffer_store_dwordx2 v[12:13], v11, s[24:27], s47 offen
    s_bitset0_b64 exec, 63
    s_not_b64 exec, exec
    buffer_store_dwordx2 v[14:15], v11, s[24:27], s47 offen offset:32
    s_mov_b64 exec, -1
    ds_add_rtn_u32 v124, v124, v2
    ds_add_rtn_u32 v125, v125, v2
    ds_add_rtn_u32 v126, v126, v2
    ds_add_rtn_u32 v127, v127, v2
    ds_add_rtn_u32 v24, v24, v2
    ds_add_rtn_u32 v25, v25, v2
    ds_add_rtn_u32 v26, v26, v2
    ds_add_rtn_u32 v27, v27, v2
    s_add_u32 s44, s35, 0x7ed4000
    buffer_store_dwordx4 v[112:115], v0, s[20:23], s44 offen sc1
    ds_add_rtn_u32 v52, v52, v2
    ds_add_rtn_u32 v53, v53, v2
    ds_add_rtn_u32 v54, v54, v2
    ds_add_rtn_u32 v55, v55, v2
    ds_add_rtn_u32 v68, v68, v2
    ds_add_rtn_u32 v69, v69, v2
    ds_add_rtn_u32 v70, v70, v2
    ds_add_rtn_u32 v71, v71, v2
    s_cmp_le_u32 s43, 5
    s_cbranch_scc1 L1_s4
    ds_add_rtn_u32 v76, v76, v2
    ds_add_rtn_u32 v77, v77, v2
    ds_add_rtn_u32 v78, v78, v2
    ds_add_rtn_u32 v79, v79, v2
L1_s4:
    s_add_u32 s45, s35, 0x7ed8000
    buffer_store_dwordx4 v[88:91], v0, s[20:23], s45 offen sc1
    s_cmp_le_u32 s43, 6
    s_cbranch_scc1 L1_s5
    ds_add_rtn_u32 v56, v56, v2
    ds_add_rtn_u32 v57, v57, v2
    ds_add_rtn_u32 v58, v58, v2
    ds_add_rtn_u32 v59, v59, v2
L1_s5:
    s_cmp_le_u32 s43, 7
    s_cbranch_scc1 L1_s6
    ds_add_rtn_u32 v60, v60, v2
    ds_add_rtn_u32 v61, v61, v2
    ds_add_rtn_u32 v62, v62, v2
    ds_add_rtn_u32 v63, v63, v2
L1_s6:
    s_waitcnt lgkmcnt(0)
    s_barrier
    v_and_b32 v7, -4, v120
    v_lshl_add_u32 v8, v120, 2, v7
    ds_write_b32 v8, v16
    v_lshl_add_u32 v7, v7, 2, v120
    ds_write_b8 v7, v44 offset:16
    v_and_b32 v9, -4, v121
    v_lshl_add_u32 v10, v121, 2, v9
    ds_write_b32 v10, v17
    v_lshl_add_u32 v9, v9, 2, v121
    ds_write_b8_d16_hi v9, v44 offset:16
    v_and_b32 v7, -4, v122
    v_lshl_add_u32 v8, v122, 2, v7
    ds_write_b32 v8, v18
    v_lshl_add_u32 v7, v7, 2, v122
    ds_write_b8 v7, v45 offset:16
    v_and_b32 v9, -4, v123
    v_lshl_add_u32 v10, v123, 2, v9
    ds_write_b32 v10, v19
    v_lshl_add_u32 v9, v9, 2, v123
    ds_write_b8_d16_hi v9, v45 offset:16
    s_add_u32 s46, s35, 0x7edc000
    buffer_store_dwordx4 v[116:119], v0, s[20:23], s46 offen sc1
    v_and_b32 v7, -4, v124
    v_lshl_add_u32 v8, v124, 2, v7
    ds_write_b32 v8, v20
    v_lshl_add_u32 v7, v7, 2, v124
    ds_write_b8 v7, v46 offset:16
    v_and_b32 v9, -4, v125
    v_lshl_add_u32 v10, v125, 2, v9
    ds_write_b32 v10, v21
    v_lshl_add_u32 v9, v9, 2, v125
    ds_write_b8_d16_hi v9, v46 offset:16
    v_and_b32 v7, -4, v126
    v_lshl_add_u32 v8, v126, 2, v7
    ds_write_b32 v8, v22
    v_lshl_add_u32 v7, v7, 2, v126
    ds_write_b8 v7, v47 offset:16
    v_and_b32 v9, -4, v127
    v_lshl_add_u32 v10, v127, 2, v9
    ds_write_b32 v10, v23
    v_lshl_add_u32 v9, v9, 2, v127
    ds_write_b8_d16_hi v9, v47 offset:16
    v_and_b32 v7, -4, v24
    v_lshl_add_u32 v8, v24, 2, v7
    ds_write_b32 v8, v40
    v_lshl_add_u32 v7, v7, 2, v24
    ds_write_b8 v7, v32 offset:16
    v_and_b32 v9, -4, v25
    v_lshl_add_u32 v10, v25, 2, v9
    ds_write_b32 v10, v41
    v_lshl_add_u32 v9, v9, 2, v25
    ds_write_b8_d16_hi v9, v32 offset:16
    v_and_b32 v7, -4, v26
    v_lshl_add_u32 v8, v26, 2, v7
    ds_write_b32 v8, v42
    v_lshl_add_u32 v7, v7, 2, v26
    ds_write_b8 v7, v33 offset:16
    v_and_b32 v9, -4, v27
    v_lshl_add_u32 v10, v27, 2, v9
    ds_write_b32 v10, v43
    v_lshl_add_u32 v9, v9, 2, v27
    ds_write_b8_d16_hi v9, v33 offset:16
    s_add_u32 s47, s35, 0x7ee0000
    buffer_store_dwordx4 v[92:95], v0, s[20:23], s47 offen sc1
    v_and_b32 v7, -4, v52
    v_lshl_add_u32 v8, v52, 2, v7
    ds_write_b32 v8, v48
    v_lshl_add_u32 v7, v7, 2, v52
    ds_write_b8 v7, v34 offset:16
    v_and_b32 v9, -4, v53
    v_lshl_add_u32 v10, v53, 2, v9
    ds_write_b32 v10, v49
    v_lshl_add_u32 v9, v9, 2, v53
    ds_write_b8_d16_hi v9, v34 offset:16
    v_and_b32 v7, -4, v54
    v_lshl_add_u32 v8, v54, 2, v7
    ds_write_b32 v8, v50
    v_lshl_add_u32 v7, v7, 2, v54
    ds_write_b8 v7, v35 offset:16
    v_and_b32 v9, -4, v55
    v_lshl_add_u32 v10, v55, 2, v9
    ds_write_b32 v10, v51
    v_lshl_add_u32 v9, v9, 2, v55
    ds_write_b8_d16_hi v9, v35 offset:16
    v_and_b32 v7, -4, v68
    v_lshl_add_u32 v8, v68, 2, v7
    ds_write_b32 v8, v84
    v_lshl_add_u32 v7, v7, 2, v68
    ds_write_b8 v7, v72 offset:16
    v_and_b32 v9, -4, v69
    v_lshl_add_u32 v10, v69, 2, v9
    ds_write_b32 v10, v85
    v_lshl_add_u32 v9, v9, 2, v69
    ds_write_b8_d16_hi v9, v72 offset:16
    v_and_b32 v7, -4, v70
    v_lshl_add_u32 v8, v70, 2, v7
    ds_write_b32 v8, v86
    v_lshl_add_u32 v7, v7, 2, v70
    ds_write_b8 v7, v73 offset:16
    v_and_b32 v9, -4, v71
    v_lshl_add_u32 v10, v71, 2, v9
    ds_write_b32 v10, v87
    v_lshl_add_u32 v9, v9, 2, v71
    ds_write_b8_d16_hi v9, v73 offset:16
    s_cmp_le_u32 s43, 5
    s_cbranch_scc1 L1_s7
    v_and_b32 v7, -4, v76
    v_lshl_add_u32 v8, v76, 2, v7
    ds_write_b32 v8, v36
    v_lshl_add_u32 v7, v7, 2, v76
    ds_write_b8 v7, v74 offset:16
    v_and_b32 v9, -4, v77
    v_lshl_add_u32 v10, v77, 2, v9
    ds_write_b32 v10, v37
    v_lshl_add_u32 v9, v9, 2, v77
    ds_write_b8_d16_hi v9, v74 offset:16
    v_and_b32 v7, -4, v78
    v_lshl_add_u32 v8, v78, 2, v7
    ds_write_b32 v8, v38
    v_lshl_add_u32 v7, v7, 2, v78
    ds_write_b8 v7, v75 offset:16
    v_and_b32 v9, -4, v79
    v_lshl_add_u32 v10, v79, 2, v9
    ds_write_b32 v10, v39
    v_lshl_add_u32 v9, v9, 2, v79
    ds_write_b8_d16_hi v9, v75 offset:16
L1_s7:
    s_add_u32 s44, s35, 0x7ee4000
    buffer_store_dwordx4 v[104:107], v0, s[20:23], s44 offen sc1
    s_cmp_le_u32 s43, 6
    s_cbranch_scc1 L1_s8
    v_and_b32 v7, -4, v56
    v_lshl_add_u32 v8, v56, 2, v7
    ds_write_b32 v8, v80
    v_lshl_add_u32 v7, v7, 2, v56
    ds_write_b8 v7, v64 offset:16
    v_and_b32 v9, -4, v57
    v_lshl_add_u32 v10, v57, 2, v9
    ds_write_b32 v10, v81
    v_lshl_add_u32 v9, v9, 2, v57
    ds_write_b8_d16_hi v9, v64 offset:16
    v_and_b32 v7, -4, v58
    v_lshl_add_u32 v8, v58, 2, v7
    ds_write_b32 v8, v82
    v_lshl_add_u32 v7, v7, 2, v58
    ds_write_b8 v7, v65 offset:16
    v_and_b32 v9, -4, v59
    v_lshl_add_u32 v10, v59, 2, v9
    ds_write_b32 v10, v83
    v_lshl_add_u32 v9, v9, 2, v59
    ds_write_b8_d16_hi v9, v65 offset:16
L1_s8:
    s_cmp_le_u32 s43, 7
    s_cbranch_scc1 L1_s9
    v_and_b32 v7, -4, v60
    v_lshl_add_u32 v8, v60, 2, v7
    ds_write_b32 v8, v96
    v_lshl_add_u32 v7, v7, 2, v60
    ds_write_b8 v7, v66 offset:16
    v_and_b32 v9, -4, v61
    v_lshl_add_u32 v10, v61, 2, v9
    ds_write_b32 v10, v97
    v_lshl_add_u32 v9, v9, 2, v61
    ds_write_b8_d16_hi v9, v66 offset:16
    v_and_b32 v7, -4, v62
    v_lshl_add_u32 v8, v62, 2, v7
    ds_write_b32 v8, v98
    v_lshl_add_u32 v7, v7, 2, v62
    ds_write_b8 v7, v67 offset:16
    v_and_b32 v9, -4, v63
    v_lshl_add_u32 v10, v63, 2, v9
    ds_write_b32 v10, v99
    v_lshl_add_u32 v9, v9, 2, v63
    ds_write_b8_d16_hi v9, v67 offset:16
L1_s9:
    v_add_u32 v7, 0x10000, v0
    v_add_u32 v12, 0x20000, v0
    s_waitcnt lgkmcnt(0)
    s_barrier
    ds_read_b128 v[100:103], v0 offset:0
    ds_read_b128 v[28:31], v0 offset:16384
    ds_read_b128 v[112:115], v0 offset:32768
    ds_read_b128 v[88:91], v0 offset:49152
    ds_read_b128 v[16:19], v7 offset:0
    ds_read_b128 v[120:123], v7 offset:16384
    ds_read_b128 v[116:119], v7 offset:32768
    ds_read_b128 v[20:23], v7 offset:49152
    ds_read_b128 v[124:127], v12 offset:0
    ds_read_b128 v[44:47], v12 offset:16384
    s_waitcnt lgkmcnt(9)
    s_add_u32 s45, s35, 0xa900000
    buffer_store_dwordx4 v[100:103], v0, s[20:23], s45 offen sc1
    s_waitcnt lgkmcnt(8)
    s_add_u32 s46, s35, 0xa904000
    buffer_store_dwordx4 v[28:31], v0, s[20:23], s46 offen sc1
    s_waitcnt lgkmcnt(7)
    s_add_u32 s47, s35, 0xa908000
    buffer_store_dwordx4 v[112:115], v0, s[20:23], s47 offen sc1
    s_waitcnt lgkmcnt(6)
    s_add_u32 s44, s35, 0xa90c000
    buffer_store_dwordx4 v[88:91], v0, s[20:23], s44 offen sc1
    s_waitcnt lgkmcnt(5)
    s_add_u32 s45, s35, 0xa910000
    buffer_store_dwordx4 v[16:19], v0, s[20:23], s45 offen sc1
    s_waitcnt lgkmcnt(4)
    s_add_u32 s46, s35, 0xa914000
    buffer_store_dwordx4 v[120:123], v0, s[20:23], s46 offen sc1
    s_waitcnt lgkmcnt(3)
    s_add_u32 s47, s35, 0xa918000
    buffer_store_dwordx4 v[116:119], v0, s[20:23], s47 offen sc1
    s_cmp_le_u32 s43, 5
    s_cbranch_scc1 L1_fin
    s_waitcnt lgkmcnt(2)
    s_add_u32 s44, s35, 0xa91c000
    buffer_store_dwordx4 v[20:23], v0, s[20:23], s44 offen sc1
    s_cmp_le_u32 s43, 6
    s_cbranch_scc1 L1_fin
    s_waitcnt lgkmcnt(1)
    s_add_u32 s45, s35, 0xa920000
    buffer_store_dwordx4 v[124:127], v0, s[20:23], s45 offen sc1
    s_cmp_le_u32 s43, 7
    s_cbranch_scc1 L1_fin
    s_waitcnt lgkmcnt(0)
    s_add_u32 s46, s35, 0xa924000
    buffer_store_dwordx4 v[44:47], v0, s[20:23], s46 offen sc1
L1_fin:
L1_end:
    s_endpgm
.text
.globl gs_acc_kernel
.p2align 8
.type gs_acc_kernel,@function
gs_acc_kernel:
    s_cmp_ge_u32 s2, 256
    s_cbranch_scc1 L2_end
    s_load_dwordx2 s[30:31], s[0:1], 104
    s_load_dwordx2 s[28:29], s[0:1], 0
    v_lshrrev_b32 v16, 6, v0
    v_and_b32 v17, 63, v0
    v_readfirstlane_b32 s32, v16
    s_bfe_u32 s33, s2, 0x20001
    s_and_b32 s34, s2, 1
    s_lshl_b32 s34, s34, 5
    s_lshr_b32 s4, s2, 3
    s_add_u32 s34, s34, s4
    v_and_b32 v22, 3, v0
    v_mul_u32_u24 v19, 80, v16
    v_add_u32 v18, v17, v19
    v_mul_u32_u24 v2, 173056, v18
    v_lshrrev_b32 v18, 2, v17
    v_add3_u32 v18, v18, v19, 64
    v_mul_u32_u24 v4, 173056, v18
    v_lshl_add_u32 v20, v22, 4, v4
    s_mul_i32 s39, s33, 2080
    s_lshl_b32 s3, s34, 5
    s_add_u32 s39, s39, s3
    s_mul_i32 s40, s33, 1280000
    s_mul_i32 s38, s32, 5120
    s_add_u32 s38, s38, 80000
    v_lshl_add_u32 v3, v17, 4, s38
    s_waitcnt lgkmcnt(0)
    s_add_u32 s12, s30, 0x28000
    s_addc_u32 s13, s31, 0
    s_mov_b32 s14, 0xd318000
    s_mov_b32 s15, 0x20000
    buffer_load_dwordx4 v[48:51], v2, s[12:15], s39 offen offset:0
    buffer_load_dwordx4 v[56:59], v2, s[12:15], s39 offen offset:32
    buffer_load_dwordx4 v[52:55], v2, s[12:15], s39 offen offset:16
    buffer_load_dwordx4 v[60:63], v2, s[12:15], s39 offen offset:48
    buffer_load_dwordx4 v[64:67], v20, s[12:15], s39 offen
    s_mov_b32 s16, s28
    s_mov_b32 s17, s29
    s_mov_b32 s18, 0x4f5880
    s_mov_b32 s19, 0x20000
    s_sub_u32 s16, s16, 80000
    s_subb_u32 s17, s17, 0
    s_add_u32 s24, s30, 0xebab000
    s_addc_u32 s25, s31, 0
    s_mov_b32 s26, 0x100
    s_mov_b32 s27, 0x20000
    v_lshlrev_b32 v21, 6, v22
    buffer_load_dwordx2 v[8:9], v21, s[24:27], 0 offen offset:40
    s_add_u32 s3, s40, 4096
    buffer_load_dwordx4 v[124:127], v3, s[16:19], s3 offen
    buffer_load_dwordx4 v[116:119], v3, s[16:19], s40 offen offset:2048
    buffer_load_dwordx4 v[120:123], v3, s[16:19], s40 offen offset:3072
    buffer_load_dwordx4 v[108:111], v3, s[16:19], s40 offen offset:0
    buffer_load_dwordx4 v[112:115], v3, s[16:19], s40 offen offset:1024
    s_add_u32 s40, s40, 0x4e200
    v_mad_u32_u24 v4, v22, 20, v4
    v_or_b32 v4, 0xf0000000, v4
    v_or_b32 v2, 0xf0000000, v2
    v_lshlrev_b32 v23, 2, v22
    v_sub_u32 v1, 28, v23
    v_and_b32 v18, 3, v0
    v_lshlrev_b32 v18, 4, v18
    v_mov_b32 v10, 0x3f80
    v_mov_b32 v11, 0
    v_lshlrev_b64 v[10:11], v18, v[10:11]
    v_and_b32 v18, 3, v0
    v_lshlrev_b32 v18, 4, v18
    v_mov_b32 v12, 0xbf80
    v_mov_b32 v13, 0
    v_lshlrev_b64 v[12:13], v18, v[12:13]
    v_lshlrev_b32 v24, 4, v0
    v_lshl_add_u32 v0, v17, 2, s38
    v_mov_b32 v45, 0xf0000000
    v_mov_b32 v5, 0x1fff8
    v_mov_b32 v6, 0x07ff0000
    s_mov_b32 s44, 0x4000c0c
    s_mov_b32 s45, 0x4010c0c
    s_mov_b32 s46, 0x4020c0c
    s_mov_b32 s47, 0x4030c0c
    s_mov_b32 s36, 0
    s_mov_b32 s42, 0
    s_mov_b64 s[80:81], 0
    s_mov_b64 s[84:85], 0
    s_mov_b64 s[48:49], 0
    s_mov_b32 s8, s30
    s_mov_b32 s9, s31
    s_mov_b32 s10, 0xd340000
    s_mov_b32 s11, 0x20000
    s_add_u32 s20, s30, 0xd823000
    s_addc_u32 s21, s31, 0
    s_mov_b32 s22, 0x13880
    s_mov_b32 s23, 0x20000
    s_lshl_b32 s3, s33, 6
    s_add_u32 s3, s3, s34
    s_mul_i32 s3, s3, 80000
    s_add_u32 s20, s20, s3
    s_addc_u32 s21, s21, 0
    v_mov_b32 v68, 0
    v_mov_b32 v69, 0
    v_mov_b32 v70, 0
    v_mov_b32 v71, 0
    v_mov_b32 v72, 0
    v_mov_b32 v73, 0
    v_mov_b32 v74, 0
    v_mov_b32 v75, 0
    ds_write_b128 v24, v[68:71] offset:0
    ds_write_b128 v24, v[68:71] offset:16384
    ds_write_b128 v24, v[68:71] offset:32768
    ds_write_b128 v24, v[68:71] offset:49152
    v_add_u32 v47, 0x10000, v24
    v_cmp_gt_u32 vcc, 80000, v47
    s_mov_b64 exec, vcc
    ds_write_b128 v47, v[68:71]
    s_mov_b64 exec, -1
    s_waitcnt vmcnt(5)
    v_sub_u16 v88, v56, v48
    v_and_b32 v89, 3, v48
    v_add3_u32 v99, v88, v89, 3
    v_and_b32 v99, -4, v99
    v_max_u32 v99, 4, v99
    v_and_b32 v97, 0xfffc, v48
    v_bfm_b32 v96, v88, v89
    v_add_u32_dpp v91, v99, v99 row_shr:1 row_mask:0xf bank_mask:0xf bound_ctrl:1
    v_mad_u32_u24 v97, v97, 5, v2
    v_cmp_lt_u32 vcc, 16, v99
    v_add_u32_dpp v91, v91, v91 row_shr:2 row_mask:0xf bank_mask:0xf bound_ctrl:1
    v_sub_u32 v98, s38, v99
    v_lshrrev_b64 v[48:49], 16, v[48:49]
    v_add_u32_dpp v91, v91, v91 row_shr:4 row_mask:0xf bank_mask:0xf bound_ctrl:1
    v_lshrrev_b64 v[56:57], 16, v[56:57]
    s_mov_b32 s43, 0
    v_add_u32_dpp v91, v91, v91 row_shr:8 row_mask:0xf bank_mask:0xf bound_ctrl:1
    s_nop 1
    v_add_u32_dpp v91, v91, v91 row_bcast:15 row_mask:0xa bank_mask:0xf
    s_nop 1
    v_add_u32_dpp v91, v91, v91 row_bcast:31 row_mask:0xc bank_mask:0xf
    v_add_u32 v98, v98, v91
    v_readlane_b32 s37, v91, 63
    s_cbranch_vccnz L2_xo1
L2_xp1:
    v_mov_b32 v44, v43
    s_cmp_gt_u32 s37, 1024
    s_cbranch_scc1 L2_xs2
    s_cmp_lg_u32 s43, 0
    s_cbranch_scc1 L2_xa2
L2_xb2:
    v_lshlrev_b32 v89, 16, v96
    v_add_u32 v90, 60, v97
    v_bitop3_b32 v90, v89, v45, v90 bitop3:0x6a
    ds_write_b32 v98, v90 offset:12
    v_lshlrev_b32 v89, 20, v96
    v_add_u32 v90, 40, v97
    v_bitop3_b32 v90, v89, v45, v90 bitop3:0x6a
    ds_write_b32 v98, v90 offset:8
    v_lshlrev_b32 v89, 24, v96
    v_add_u32 v90, 20, v97
    v_bitop3_b32 v90, v89, v45, v90 bitop3:0x6a
    ds_write_b32 v98, v90 offset:4
    v_lshlrev_b32 v89, 28, v96
    v_bitop3_b32 v90, v89, v45, v97 bitop3:0x6a
    ds_write_b32 v98, v90 offset:0
    v_mov_b32_dpp v91, v64 quad_perm:[0,0,0,0] row_mask:0xf bank_mask:0xf
    v_and_b32 v89, 3, v91
    v_and_b32 v97, 0xfffc, v91
    v_sub_u16_dpp v88, v64, v91 quad_perm:[2,2,2,2] row_mask:0xf bank_mask:0xf
    v_mad_u32_u24 v97, v97, 5, v4
    v_add_u32 v99, v88, v89
    v_bfm_b32 v96, v88, v89
    v_cmp_lt_u32 s[58:59], 16, v99
    v_lshlrev_b32 v89, v1, v96
    v_and_b32 v89, v45, v89
    v_cmp_ne_u32 vcc, 0, v89
    v_xor_b32 v90, v97, v89
    s_add_u32 s3, s37, s38
    v_mbcnt_lo_u32_b32 v98, vcc_lo, 0
    v_mbcnt_hi_u32_b32 v98, vcc_hi, v98
    s_bcnt1_i32_b64 s41, vcc
    v_lshl_add_u32 v98, v98, 2, s3
    s_mov_b64 exec, vcc
    ds_write_b32 v98, v90
    s_mov_b64 exec, -1
    s_lshl2_add_u32 s37, s41, s37
    s_cmp_lg_u64 s[58:59], 0
    s_cbranch_scc1 L2_xe2
L2_xr2:
    v_add_u32 v98, s37, v0
    v_mov_b32 v90, -1
    ds_write_b32 v98, v90
    ds_read2st64_b32 v[40:41], v0 offset0:0 offset1:1
    ds_read2st64_b32 v[42:43], v0 offset0:2 offset1:3
    s_sub_u32 s3, s37, 768
    s_cmp_gt_u32 s3, 256
    s_cbranch_scc1 L2_xf2
L2_xg2:
    v_sub_u16 v88, v58, v50
    v_and_b32 v89, 3, v50
    v_add3_u32 v99, v88, v89, 3
    v_and_b32 v99, -4, v99
    v_max_u32 v99, 4, v99
    v_and_b32 v97, 0xfffc, v50
    v_bfm_b32 v96, v88, v89
    v_add_u32_dpp v91, v99, v99 row_shr:1 row_mask:0xf bank_mask:0xf bound_ctrl:1
    v_mad_u32_u24 v97, v97, 5, v2
    v_cmp_lt_u32 vcc, 16, v99
    v_add_u32_dpp v91, v91, v91 row_shr:2 row_mask:0xf bank_mask:0xf bound_ctrl:1
    v_sub_u32 v98, s38, v99
    v_lshrrev_b64 v[50:51], 16, v[50:51]
    v_add_u32_dpp v91, v91, v91 row_shr:4 row_mask:0xf bank_mask:0xf bound_ctrl:1
    v_lshrrev_b64 v[58:59], 16, v[58:59]
    s_mov_b32 s43, 0
    v_add_u32_dpp v91, v91, v91 row_shr:8 row_mask:0xf bank_mask:0xf bound_ctrl:1
    s_nop 1
    v_add_u32_dpp v91, v91, v91 row_bcast:15 row_mask:0xa bank_mask:0xf
    s_nop 1
    v_add_u32_dpp v91, v91, v91 row_bcast:31 row_mask:0xc bank_mask:0xf
    v_add_u32 v98, v98, v91
    v_readlane_b32 s37, v91, 63
    s_cbranch_vccnz L2_xo3
L2_xp3:
    s_waitcnt lgkmcnt(0)
    v_mov_b32 v21, v40
    v_mov_b32 v27, v41
    v_mov_b32 v33, v42
    v_mov_b32 v39, v43
    v_and_b32 v47, 0x0fffffff, v21
    buffer_load_dwordx4 v[16:19], v47, s[8:11], 0 offen
    buffer_load_dwordx3 v[18:20], v47, s[8:11], 0 offen offset:8
    s_waitcnt vmcnt(6)
    ds_write_b128 v3, v[124:127] offset:4096
    s_waitcnt vmcnt(5)
    ds_write_b128 v3, v[116:119] offset:2048
    s_waitcnt vmcnt(4)
    ds_write_b128 v3, v[120:123] offset:3072
    v_mov_b32 v44, v43
    s_cmp_gt_u32 s37, 1024
    s_cbranch_scc1 L2_xs4
    s_cmp_lg_u32 s43, 0
    s_cbranch_scc1 L2_xa4
L2_xb4:
    v_lshlrev_b32 v89, 16, v96
    v_add_u32 v90, 60, v97
    v_bitop3_b32 v90, v89, v45, v90 bitop3:0x6a
    ds_write_b32 v98, v90 offset:12
    v_lshlrev_b32 v89, 20, v96
    v_add_u32 v90, 40, v97
    v_bitop3_b32 v90, v89, v45, v90 bitop3:0x6a
    ds_write_b32 v98, v90 offset:8
    v_lshlrev_b32 v89, 24, v96
    v_add_u32 v90, 20, v97
    v_bitop3_b32 v90, v89, v45, v90 bitop3:0x6a
    ds_write_b32 v98, v90 offset:4
    v_lshlrev_b32 v89, 28, v96
    v_bitop3_b32 v90, v89, v45, v97 bitop3:0x6a
    ds_write_b32 v98, v90 offset:0
    v_mov_b32_dpp v91, v66 quad_perm:[0,0,0,0] row_mask:0xf bank_mask:0xf
    v_and_b32 v89, 3, v91
    v_and_b32 v97, 0xfffc, v91
    v_sub_u16_dpp v88, v66, v91 quad_perm:[2,2,2,2] row_mask:0xf bank_mask:0xf
    v_mad_u32_u24 v97, v97, 5, v4
    v_add_u32 v99, v88, v89
    v_bfm_b32 v96, v88, v89
    v_cmp_lt_u32 s[58:59], 16, v99
    v_lshlrev_b32 v89, v1, v96
    v_and_b32 v89, v45, v89
    v_cmp_ne_u32 vcc, 0, v89
    v_xor_b32 v90, v97, v89
    s_add_u32 s3, s37, s38
    v_mbcnt_lo_u32_b32 v98, vcc_lo, 0
    v_mbcnt_hi_u32_b32 v98, vcc_hi, v98
    s_bcnt1_i32_b64 s41, vcc
    v_lshl_add_u32 v98, v98, 2, s3
    s_mov_b64 exec, vcc
    ds_write_b32 v98, v90
    s_mov_b64 exec, -1
    s_lshl2_add_u32 s37, s41, s37
    s_cmp_lg_u64 s[58:59], 0
    s_cbranch_scc1 L2_xe4
L2_xr4:
    v_add_u32 v98, s37, v0
    v_mov_b32 v90, -1
    ds_write_b32 v98, v90
    ds_read2st64_b32 v[40:41], v0 offset0:0 offset1:1
    ds_read2st64_b32 v[42:43], v0 offset0:2 offset1:3
    s_sub_u32 s3, s37, 768
    s_cmp_gt_u32 s3, 256
    s_cbranch_scc1 L2_xf4
L2_xg4:
    s_waitcnt vmcnt(3)
    ds_write_b128 v3, v[108:111] offset:0
    s_waitcnt vmcnt(2)
    ds_write_b128 v3, v[112:115] offset:1024
    s_waitcnt lgkmcnt(0)
    s_barrier
    s_bitcmp1_b32 s36, s42
    s_cbranch_scc1 L2_slow
L2_ret0:
    s_setprio 3
    v_and_b32 v47, 0x0fffffff, v27
    buffer_load_dwordx4 v[22:25], v47, s[8:11], 0 offen
    buffer_load_dwordx3 v[24:26], v47, s[8:11], 0 offen offset:8
    s_waitcnt vmcnt(2)
    v_and_b32 v46, 0x20000000, v21
    v_lshrrev_b32 v47, 14, v17
    v_bitop3_b32 v47, v47, v5, v46 bitop3:0xea
    ds_read_b64 v[102:103], v47 offset:63616
    v_bitop3_b32 v93, v17, v5, v46 bitop3:0xea
    v_and_b32 v46, 0x10000000, v21
    v_lshrrev_b32 v47, 14, v16
    v_bitop3_b32 v47, v47, v5, v46 bitop3:0xea
    ds_read_b64 v[100:101], v47 offset:63616
    v_bitop3_b32 v92, v16, v5, v46 bitop3:0xea
    v_perm_b32 v15, v17, v20, s45
    v_bitop3_b32 v46, v17, 0.5, -0.5 bitop3:0xa8
    v_perm_b32 v14, v16, v20, s44
    v_bitop3_b32 v47, v16, 0.5, -0.5 bitop3:0xa8
    s_waitcnt lgkmcnt(0)
    v_mfma_f32_4x4x4_16b_bf16 v[80:83], v[8:9], v[102:103], 0
    v_mfma_f32_4x4x4_16b_bf16 v[76:79], v[8:9], v[100:101], 0
    v_bitop3_b32 v15, v6, v15, v46 bitop3:0xca
    v_bitop3_b32 v14, v6, v14, v47 bitop3:0xca
    v_cmp_lt_u32 s[84:85], v5, v92
    s_nop 0
    v_pk_mul_f32 v[80:81], v[80:81], v[14:15] op_sel:[0,1] op_sel_hi:[1,1]
    v_pk_mul_f32 v[82:83], v[82:83], v[14:15] op_sel:[0,1] op_sel_hi:[1,1]
    v_pk_mul_f32 v[76:77], v[76:77], v[14:15] op_sel:[0,0] op_sel_hi:[1,0]
    v_pk_mul_f32 v[78:79], v[78:79], v[14:15] op_sel:[0,0] op_sel_hi:[1,0]
    v_and_b32 v47, 0x0fffffff, v33
    buffer_load_dwordx4 v[28:31], v47, s[8:11], 0 offen
    buffer_load_dwordx3 v[30:32], v47, s[8:11], 0 offen offset:8
    v_cmpx_ne_u64 vcc, v[74:75], v[70:71]
    s_and_b64 s[82:83], vcc, s[80:81]
    s_cbranch_scc1 L2_c5
L2_d5:
    v_mov_b64 v[84:85], v[70:71]
    v_mov_b32 v7, v95
    v_mov_b64 v[86:87], v[74:75]
    s_mov_b64 exec, -1
    s_or_b64 s[80:81], s[80:81], vcc
    v_cmpx_ne_u64 vcc, v[72:73], v[68:69]
    s_and_b64 s[82:83], vcc, s[80:81]
    s_cbranch_scc1 L2_c6
L2_d6:
    v_mov_b64 v[84:85], v[68:69]
    v_mov_b32 v7, v94
    v_mov_b64 v[86:87], v[72:73]
    s_mov_b64 exec, -1
    s_or_b64 s[80:81], s[80:81], vcc
    ds_read_b64 v[70:71], v93
    s_and_b64 exec, s[84:85], s[80:81]
    v_mfma_f32_4x4x4_16b_bf16 v[76:79], v[12:13], v[84:85], 0
    v_mov_b32 v92, v7
    s_andn2_b64 s[80:81], s[80:81], s[84:85]
    v_mfma_f32_4x4x4_16b_bf16 v[76:79], v[10:11], v[86:87], v[76:79]
    s_mov_b64 exec, -1
    ds_read_b64 v[68:69], v92
    v_and_b32 v46, 0x80000000, v21
    v_lshrrev_b32 v47, 14, v19
    v_bitop3_b32 v47, v47, v5, v46 bitop3:0xea
    ds_read_b64 v[106:107], v47 offset:63616
    v_bitop3_b32 v95, v19, v5, v46 bitop3:0xea
    v_and_b32 v46, 0x40000000, v21
    v_lshrrev_b32 v47, 14, v18
    v_bitop3_b32 v47, v47, v5, v46 bitop3:0xea
    ds_read_b64 v[104:105], v47 offset:63616
    v_bitop3_b32 v94, v18, v5, v46 bitop3:0xea
    s_waitcnt lgkmcnt(2)
    v_mfma_f32_4x4x4_16b_bf16 v[80:83], v[10:11], v[70:71], v[80:83]
    v_mfma_f32_4x4x4_16b_bf16 v[76:79], v[10:11], v[68:69], v[76:79]
    v_perm_b32 v15, v19, v20, s47
    v_bitop3_b32 v46, v19, 0.5, -0.5 bitop3:0xa8
    v_perm_b32 v14, v18, v20, s46
    v_bitop3_b32 v47, v18, 0.5, -0.5 bitop3:0xa8
    v_cvt_pk_bf16_f32 v80, v80, v81
    v_cvt_pk_bf16_f32 v81, v82, v83
    ds_wrxchg_rtn_b64 v[74:75], v93, v[80:81]
    v_cvt_pk_bf16_f32 v76, v76, v77
    v_cvt_pk_bf16_f32 v77, v78, v79
    ds_wrxchg_rtn_b64 v[72:73], v92, v[76:77]
    s_setprio 2
    s_waitcnt lgkmcnt(2)
    v_mfma_f32_4x4x4_16b_bf16 v[80:83], v[8:9], v[106:107], 0
    v_mfma_f32_4x4x4_16b_bf16 v[76:79], v[8:9], v[104:105], 0
    v_bitop3_b32 v15, v6, v15, v46 bitop3:0xca
    v_bitop3_b32 v14, v6, v14, v47 bitop3:0xca
    s_nop 1
    v_pk_mul_f32 v[80:81], v[80:81], v[14:15] op_sel:[0,1] op_sel_hi:[1,1]
    v_pk_mul_f32 v[82:83], v[82:83], v[14:15] op_sel:[0,1] op_sel_hi:[1,1]
    v_pk_mul_f32 v[76:77], v[76:77], v[14:15] op_sel:[0,0] op_sel_hi:[1,0]
    v_pk_mul_f32 v[78:79], v[78:79], v[14:15] op_sel:[0,0] op_sel_hi:[1,0]
    s_add_u32 s3, s40, 4096
    buffer_load_dwordx4 v[124:127], v3, s[16:19], s3 offen
    buffer_load_dwordx4 v[116:119], v3, s[16:19], s40 offen offset:2048
    s_waitcnt lgkmcnt(0)
    v_cmpx_ne_u64 vcc, v[74:75], v[70:71]
    s_and_b64 s[82:83], vcc, s[80:81]
    s_cbranch_scc1 L2_c7
L2_d7:
    v_mov_b64 v[84:85], v[70:71]
    v_mov_b32 v7, v93
    v_mov_b64 v[86:87], v[74:75]
    s_mov_b64 exec, -1
    s_or_b64 s[80:81], s[80:81], vcc
    v_cmpx_ne_u64 vcc, v[72:73], v[68:69]
    s_and_b64 s[82:83], vcc, s[80:81]
    s_cbranch_scc1 L2_c8
L2_d8:
    v_mov_b64 v[84:85], v[68:69]
    v_mov_b32 v7, v92
    v_mov_b64 v[86:87], v[72:73]
    s_mov_b64 exec, -1
    s_or_b64 s[80:81], s[80:81], vcc
    ds_read_b64 v[70:71], v95
    ds_read_b64 v[68:69], v94
    s_waitcnt vmcnt(4)
    v_and_b32 v46, 0x20000000, v27
    v_lshrrev_b32 v47, 14, v23
    v_bitop3_b32 v47, v47, v5, v46 bitop3:0xea
    ds_read_b64 v[102:103], v47 offset:63616
    v_bitop3_b32 v93, v23, v5, v46 bitop3:0xea
    v_and_b32 v46, 0x10000000, v27
    v_lshrrev_b32 v47, 14, v22
    v_bitop3_b32 v47, v47, v5, v46 bitop3:0xea
    ds_read_b64 v[100:101], v47 offset:63616
    v_bitop3_b32 v92, v22, v5, v46 bitop3:0xea
    s_waitcnt lgkmcnt(2)
    v_mfma_f32_4x4x4_16b_bf16 v[80:83], v[10:11], v[70:71], v[80:83]
    v_mfma_f32_4x4x4_16b_bf16 v[76:79], v[10:11], v[68:69], v[76:79]
    v_perm_b32 v15, v23, v26, s45
    v_bitop3_b32 v46, v23, 0.5, -0.5 bitop3:0xa8
    v_perm_b32 v14, v22, v26, s44
    v_bitop3_b32 v47, v22, 0.5, -0.5 bitop3:0xa8
    v_cvt_pk_bf16_f32 v80, v80, v81
    v_cvt_pk_bf16_f32 v81, v82, v83
    ds_wrxchg_rtn_b64 v[74:75], v95, v[80:81]
    v_cvt_pk_bf16_f32 v76, v76, v77
    v_cvt_pk_bf16_f32 v77, v78, v79
    ds_wrxchg_rtn_b64 v[72:73], v94, v[76:77]
    s_waitcnt lgkmcnt(2)
    v_mfma_f32_4x4x4_16b_bf16 v[80:83], v[8:9], v[102:103], 0
    v_mfma_f32_4x4x4_16b_bf16 v[76:79], v[8:9], v[100:101], 0
    v_bitop3_b32 v15, v6, v15, v46 bitop3:0xca
    v_bitop3_b32 v14, v6, v14, v47 bitop3:0xca
    v_cmp_lt_u32 s[84:85], v5, v92
    s_nop 0
    v_pk_mul_f32 v[80:81], v[80:81], v[14:15] op_sel:[0,1] op_sel_hi:[1,1]
    v_pk_mul_f32 v[82:83], v[82:83], v[14:15] op_sel:[0,1] op_sel_hi:[1,1]
    v_pk_mul_f32 v[76:77], v[76:77], v[14:15] op_sel:[0,0] op_sel_hi:[1,0]
    v_pk_mul_f32 v[78:79], v[78:79], v[14:15] op_sel:[0,0] op_sel_hi:[1,0]
    v_sub_u16 v88, v60, v52
    v_and_b32 v89, 3, v52
    v_add3_u32 v99, v88, v89, 3
    v_and_b32 v99, -4, v99
    v_max_u32 v99, 4, v99
    v_and_b32 v97, 0xfffc, v52
    v_bfm_b32 v96, v88, v89
    v_add_u32_dpp v91, v99, v99 row_shr:1 row_mask:0xf bank_mask:0xf bound_ctrl:1
    v_mad_u32_u24 v97, v97, 5, v2
    v_cmp_lt_u32 vcc, 16, v99
    v_add_u32_dpp v91, v91, v91 row_shr:2 row_mask:0xf bank_mask:0xf bound_ctrl:1
    v_sub_u32 v98, s38, v99
    v_lshrrev_b64 v[52:53], 16, v[52:53]
    v_add_u32_dpp v91, v91, v91 row_shr:4 row_mask:0xf bank_mask:0xf bound_ctrl:1
    v_lshrrev_b64 v[60:61], 16, v[60:61]
    s_mov_b32 s43, 0
    v_add_u32_dpp v91, v91, v91 row_shr:8 row_mask:0xf bank_mask:0xf bound_ctrl:1
    s_nop 1
    v_add_u32_dpp v91, v91, v91 row_bcast:15 row_mask:0xa bank_mask:0xf
    s_nop 1
    v_add_u32_dpp v91, v91, v91 row_bcast:31 row_mask:0xc bank_mask:0xf
    v_add_u32 v98, v98, v91
    v_readlane_b32 s37, v91, 63
    s_cbranch_vccnz L2_xo9
L2_xp9:
    v_and_b32 v47, 0x0fffffff, v39
    buffer_load_dwordx4 v[34:37], v47, s[8:11], 0 offen
    buffer_load_dwordx3 v[36:38], v47, s[8:11], 0 offen offset:8
    buffer_load_dwordx4 v[120:123], v3, s[16:19], s40 offen offset:3072
    s_waitcnt lgkmcnt(0)
    v_cmpx_ne_u64 vcc, v[74:75], v[70:71]
    s_and_b64 s[82:83], vcc, s[80:81]
    s_cbranch_scc1 L2_c10
L2_d10:
    v_mov_b64 v[84:85], v[70:71]
    v_mov_b32 v7, v95
    v_mov_b64 v[86:87], v[74:75]
    s_mov_b64 exec, -1
    s_or_b64 s[80:81], s[80:81], vcc
    v_cmpx_ne_u64 vcc, v[72:73], v[68:69]
    s_and_b64 s[82:83], vcc, s[80:81]
    s_cbranch_scc1 L2_c11
L2_d11:
    v_mov_b64 v[84:85], v[68:69]
    v_mov_b32 v7, v94
    v_mov_b64 v[86:87], v[72:73]
    s_mov_b64 exec, -1
    s_or_b64 s[80:81], s[80:81], vcc
    ds_read_b64 v[70:71], v93
    s_and_b64 exec, s[84:85], s[80:81]
    v_mfma_f32_4x4x4_16b_bf16 v[76:79], v[12:13], v[84:85], 0
    v_mov_b32 v92, v7
    s_andn2_b64 s[80:81], s[80:81], s[84:85]
    v_mfma_f32_4x4x4_16b_bf16 v[76:79], v[10:11], v[86:87], v[76:79]
    s_mov_b64 exec, -1
    ds_read_b64 v[68:69], v92
    v_and_b32 v46, 0x80000000, v27
    v_lshrrev_b32 v47, 14, v25
    v_bitop3_b32 v47, v47, v5, v46 bitop3:0xea
    ds_read_b64 v[106:107], v47 offset:63616
    v_bitop3_b32 v95, v25, v5, v46 bitop3:0xea
    v_and_b32 v46, 0x40000000, v27
    v_lshrrev_b32 v47, 14, v24
    v_bitop3_b32 v47, v47, v5, v46 bitop3:0xea
    ds_read_b64 v[104:105], v47 offset:63616
    v_bitop3_b32 v94, v24, v5, v46 bitop3:0xea
    s_waitcnt lgkmcnt(2)
    v_mfma_f32_4x4x4_16b_bf16 v[80:83], v[10:11], v[70:71], v[80:83]
    v_mfma_f32_4x4x4_16b_bf16 v[76:79], v[10:11], v[68:69], v[76:79]
    v_perm_b32 v15, v25, v26, s47
    v_bitop3_b32 v46, v25, 0.5, -0.5 bitop3:0xa8
    v_perm_b32 v14, v24, v26, s46
    v_bitop3_b32 v47, v24, 0.5, -0.5 bitop3:0xa8
    v_cvt_pk_bf16_f32 v80, v80, v81
    v_cvt_pk_bf16_f32 v81, v82, v83
    ds_wrxchg_rtn_b64 v[74:75], v93, v[80:81]
    v_cvt_pk_bf16_f32 v76, v76, v77
    v_cvt_pk_bf16_f32 v77, v78, v79
    ds_wrxchg_rtn_b64 v[72:73], v92, v[76:77]
    s_setprio 1
    s_waitcnt lgkmcnt(2)
    v_mfma_f32_4x4x4_16b_bf16 v[80:83], v[8:9], v[106:107], 0
    v_mfma_f32_4x4x4_16b_bf16 v[76:79], v[8:9], v[104:105], 0
    v_bitop3_b32 v15, v6, v15, v46 bitop3:0xca
    v_bitop3_b32 v14, v6, v14, v47 bitop3:0xca
    s_nop 1
    v_pk_mul_f32 v[80:81], v[80:81], v[14:15] op_sel:[0,1] op_sel_hi:[1,1]
    v_pk_mul_f32 v[82:83], v[82:83], v[14:15] op_sel:[0,1] op_sel_hi:[1,1]
    v_pk_mul_f32 v[76:77], v[76:77], v[14:15] op_sel:[0,0] op_sel_hi:[1,0]
    v_pk_mul_f32 v[78:79], v[78:79], v[14:15] op_sel:[0,0] op_sel_hi:[1,0]
    buffer_load_dwordx4 v[108:111], v3, s[16:19], s40 offen offset:0
    buffer_load_dwordx4 v[112:115], v3, s[16:19], s40 offen offset:1024
    s_waitcnt lgkmcnt(0)
    v_cmpx_ne_u64 vcc, v[74:75], v[70:71]
    s_and_b64 s[82:83], vcc, s[80:81]
    s_cbranch_scc1 L2_c12
L2_d12:
    v_mov_b64 v[84:85], v[70:71]
    v_mov_b32 v7, v93
    v_mov_b64 v[86:87], v[74:75]
    s_mov_b64 exec, -1
    s_or_b64 s[80:81], s[80:81], vcc
    v_cmpx_ne_u64 vcc, v[72:73], v[68:69]
    s_and_b64 s[82:83], vcc, s[80:81]
    s_cbranch_scc1 L2_c13
L2_d13:
    v_mov_b64 v[84:85], v[68:69]
    v_mov_b32 v7, v92
    v_mov_b64 v[86:87], v[72:73]
    s_mov_b64 exec, -1
    s_or_b64 s[80:81], s[80:81], vcc
    ds_read_b64 v[70:71], v95
    ds_read_b64 v[68:69], v94
    s_waitcnt vmcnt(7)
    v_and_b32 v46, 0x20000000, v33
    v_lshrrev_b32 v47, 14, v29
    v_bitop3_b32 v47, v47, v5, v46 bitop3:0xea
    ds_read_b64 v[102:103], v47 offset:63616
    v_bitop3_b32 v93, v29, v5, v46 bitop3:0xea
    v_and_b32 v46, 0x10000000, v33
    v_lshrrev_b32 v47, 14, v28
    v_bitop3_b32 v47, v47, v5, v46 bitop3:0xea
    ds_read_b64 v[100:101], v47 offset:63616
    v_bitop3_b32 v92, v28, v5, v46 bitop3:0xea
    s_waitcnt lgkmcnt(2)
    v_mfma_f32_4x4x4_16b_bf16 v[80:83], v[10:11], v[70:71], v[80:83]
    v_mfma_f32_4x4x4_16b_bf16 v[76:79], v[10:11], v[68:69], v[76:79]
    v_perm_b32 v15, v29, v32, s45
    v_bitop3_b32 v46, v29, 0.5, -0.5 bitop3:0xa8
    v_perm_b32 v14, v28, v32, s44
    v_bitop3_b32 v47, v28, 0.5, -0.5 bitop3:0xa8
    v_cvt_pk_bf16_f32 v80, v80, v81
    v_cvt_pk_bf16_f32 v81, v82, v83
    ds_wrxchg_rtn_b64 v[74:75], v95, v[80:81]
    v_cvt_pk_bf16_f32 v76, v76, v77
    v_cvt_pk_bf16_f32 v77, v78, v79
    ds_wrxchg_rtn_b64 v[72:73], v94, v[76:77]
    s_waitcnt lgkmcnt(2)
    v_mfma_f32_4x4x4_16b_bf16 v[80:83], v[8:9], v[102:103], 0
    v_mfma_f32_4x4x4_16b_bf16 v[76:79], v[8:9], v[100:101], 0
    v_bitop3_b32 v15, v6, v15, v46 bitop3:0xca
    v_bitop3_b32 v14, v6, v14, v47 bitop3:0xca
    v_cmp_lt_u32 s[84:85], v5, v92
    s_nop 0
    v_pk_mul_f32 v[80:81], v[80:81], v[14:15] op_sel:[0,1] op_sel_hi:[1,1]
    v_pk_mul_f32 v[82:83], v[82:83], v[14:15] op_sel:[0,1] op_sel_hi:[1,1]
    v_pk_mul_f32 v[76:77], v[76:77], v[14:15] op_sel:[0,0] op_sel_hi:[1,0]
    v_pk_mul_f32 v[78:79], v[78:79], v[14:15] op_sel:[0,0] op_sel_hi:[1,0]
    v_and_b32 v47, 0x0fffffff, v40
    v_mov_b32 v21, v40
    buffer_load_dwordx4 v[16:19], v47, s[8:11], 0 offen
    buffer_load_dwordx3 v[18:20], v47, s[8:11], 0 offen offset:8
    s_waitcnt lgkmcnt(0)
    v_cmpx_ne_u64 vcc, v[74:75], v[70:71]
    s_and_b64 s[82:83], vcc, s[80:81]
    s_cbranch_scc1 L2_c14
L2_d14:
    v_mov_b64 v[84:85], v[70:71]
    v_mov_b32 v7, v95
    v_mov_b64 v[86:87], v[74:75]
    s_mov_b64 exec, -1
    s_or_b64 s[80:81], s[80:81], vcc
    v_cmpx_ne_u64 vcc, v[72:73], v[68:69]
    s_and_b64 s[82:83], vcc, s[80:81]
    s_cbranch_scc1 L2_c15
L2_d15:
    v_mov_b64 v[84:85], v[68:69]
    v_mov_b32 v7, v94
    v_mov_b64 v[86:87], v[72:73]
    s_mov_b64 exec, -1
    s_or_b64 s[80:81], s[80:81], vcc
    ds_read_b64 v[70:71], v93
    s_and_b64 exec, s[84:85], s[80:81]
    v_mfma_f32_4x4x4_16b_bf16 v[76:79], v[12:13], v[84:85], 0
    v_mov_b32 v92, v7
    s_andn2_b64 s[80:81], s[80:81], s[84:85]
    v_mfma_f32_4x4x4_16b_bf16 v[76:79], v[10:11], v[86:87], v[76:79]
    s_mov_b64 exec, -1
    ds_read_b64 v[68:69], v92
    v_and_b32 v46, 0x80000000, v33
    v_lshrrev_b32 v47, 14, v31
    v_bitop3_b32 v47, v47, v5, v46 bitop3:0xea
    ds_read_b64 v[106:107], v47 offset:63616
    v_bitop3_b32 v95, v31, v5, v46 bitop3:0xea
    v_and_b32 v46, 0x40000000, v33
    v_lshrrev_b32 v47, 14, v30
    v_bitop3_b32 v47, v47, v5, v46 bitop3:0xea
    ds_read_b64 v[104:105], v47 offset:63616
    v_bitop3_b32 v94, v30, v5, v46 bitop3:0xea
    s_waitcnt lgkmcnt(2)
    v_mfma_f32_4x4x4_16b_bf16 v[80:83], v[10:11], v[70:71], v[80:83]
    v_mfma_f32_4x4x4_16b_bf16 v[76:79], v[10:11], v[68:69], v[76:79]
    v_perm_b32 v15, v31, v32, s47
    v_bitop3_b32 v46, v31, 0.5, -0.5 bitop3:0xa8
    v_perm_b32 v14, v30, v32, s46
    v_bitop3_b32 v47, v30, 0.5, -0.5 bitop3:0xa8
    v_cvt_pk_bf16_f32 v80, v80, v81
    v_cvt_pk_bf16_f32 v81, v82, v83
    ds_wrxchg_rtn_b64 v[74:75], v93, v[80:81]
    v_cvt_pk_bf16_f32 v76, v76, v77
    v_cvt_pk_bf16_f32 v77, v78, v79
    ds_wrxchg_rtn_b64 v[72:73], v92, v[76:77]
    s_setprio 0
    s_waitcnt lgkmcnt(2)
    v_mfma_f32_4x4x4_16b_bf16 v[80:83], v[8:9], v[106:107], 0
    v_mfma_f32_4x4x4_16b_bf16 v[76:79], v[8:9], v[104:105], 0
    v_bitop3_b32 v15, v6, v15, v46 bitop3:0xca
    v_bitop3_b32 v14, v6, v14, v47 bitop3:0xca
    s_nop 1
    v_pk_mul_f32 v[80:81], v[80:81], v[14:15] op_sel:[0,1] op_sel_hi:[1,1]
    v_pk_mul_f32 v[82:83], v[82:83], v[14:15] op_sel:[0,1] op_sel_hi:[1,1]
    v_pk_mul_f32 v[76:77], v[76:77], v[14:15] op_sel:[0,0] op_sel_hi:[1,0]
    v_pk_mul_f32 v[78:79], v[78:79], v[14:15] op_sel:[0,0] op_sel_hi:[1,0]
    s_add_u32 s40, s40, 0x4e200
    v_and_b32 v47, 0x0fffffff, v41
    v_mov_b32 v27, v41
    buffer_load_dwordx4 v[22:25], v47, s[8:11], 0 offen
    buffer_load_dwordx3 v[24:26], v47, s[8:11], 0 offen offset:8
    s_waitcnt lgkmcnt(0)
    v_cmpx_ne_u64 vcc, v[74:75], v[70:71]
    s_and_b64 s[82:83], vcc, s[80:81]
    s_cbranch_scc1 L2_c16
L2_d16:
    v_mov_b64 v[84:85], v[70:71]
    v_mov_b32 v7, v93
    v_mov_b64 v[86:87], v[74:75]
    s_mov_b64 exec, -1
    s_or_b64 s[80:81], s[80:81], vcc
    v_cmpx_ne_u64 vcc, v[72:73], v[68:69]
    s_and_b64 s[82:83], vcc, s[80:81]
    s_cbranch_scc1 L2_c17
L2_d17:
    v_mov_b64 v[84:85], v[68:69]
    v_mov_b32 v7, v92
    v_mov_b64 v[86:87], v[72:73]
    s_mov_b64 exec, -1
    s_or_b64 s[80:81], s[80:81], vcc
    ds_read_b64 v[70:71], v95
    ds_read_b64 v[68:69], v94
    s_waitcnt vmcnt(7)
    v_and_b32 v46, 0x20000000, v39
    v_lshrrev_b32 v47, 14, v35
    v_bitop3_b32 v47, v47, v5, v46 bitop3:0xea
    ds_read_b64 v[102:103], v47 offset:63616
    v_bitop3_b32 v93, v35, v5, v46 bitop3:0xea
    v_and_b32 v46, 0x10000000, v39
    v_lshrrev_b32 v47, 14, v34
    v_bitop3_b32 v47, v47, v5, v46 bitop3:0xea
    ds_read_b64 v[100:101], v47 offset:63616
    v_bitop3_b32 v92, v34, v5, v46 bitop3:0xea
    v_and_b32 v46, 0x80000000, v39
    v_lshrrev_b32 v47, 14, v37
    v_bitop3_b32 v47, v47, v5, v46 bitop3:0xea
    ds_read_b64 v[106:107], v47 offset:63616
    v_and_b32 v46, 0x40000000, v39
    v_lshrrev_b32 v47, 14, v36
    v_bitop3_b32 v47, v47, v5, v46 bitop3:0xea
    ds_read_b64 v[104:105], v47 offset:63616
    s_waitcnt lgkmcnt(4)
    v_mfma_f32_4x4x4_16b_bf16 v[80:83], v[10:11], v[70:71], v[80:83]
    v_mfma_f32_4x4x4_16b_bf16 v[76:79], v[10:11], v[68:69], v[76:79]
    v_perm_b32 v15, v35, v38, s45
    v_bitop3_b32 v46, v35, 0.5, -0.5 bitop3:0xa8
    v_perm_b32 v14, v34, v38, s44
    v_bitop3_b32 v47, v34, 0.5, -0.5 bitop3:0xa8
    v_cvt_pk_bf16_f32 v80, v80, v81
    v_cvt_pk_bf16_f32 v81, v82, v83
    ds_wrxchg_rtn_b64 v[74:75], v95, v[80:81]
    v_cvt_pk_bf16_f32 v76, v76, v77
    v_cvt_pk_bf16_f32 v77, v78, v79
    ds_wrxchg_rtn_b64 v[72:73], v94, v[76:77]
    s_waitcnt lgkmcnt(2)
    s_barrier
    s_setprio 3
    ds_write_b128 v3, v[124:127] offset:4096
    s_add_u32 s3, s40, 4096
    buffer_load_dwordx4 v[124:127], v3, s[16:19], s3 offen
    ds_write_b128 v3, v[116:119] offset:2048
    buffer_load_dwordx4 v[116:119], v3, s[16:19], s40 offen offset:2048
    s_waitcnt vmcnt(8)
    ds_write_b128 v3, v[120:123] offset:3072
    buffer_load_dwordx4 v[120:123], v3, s[16:19], s40 offen offset:3072
    v_mfma_f32_4x4x4_16b_bf16 v[80:83], v[8:9], v[102:103], 0
    v_mfma_f32_4x4x4_16b_bf16 v[76:79], v[8:9], v[100:101], 0
    v_bitop3_b32 v15, v6, v15, v46 bitop3:0xca
    v_bitop3_b32 v14, v6, v14, v47 bitop3:0xca
    v_cmp_lt_u32 s[84:85], v5, v92
    s_nop 0
    v_pk_mul_f32 v[80:81], v[80:81], v[14:15] op_sel:[0,1] op_sel_hi:[1,1]
    v_pk_mul_f32 v[82:83], v[82:83], v[14:15] op_sel:[0,1] op_sel_hi:[1,1]
    v_pk_mul_f32 v[76:77], v[76:77], v[14:15] op_sel:[0,0] op_sel_hi:[1,0]
    v_pk_mul_f32 v[78:79], v[78:79], v[14:15] op_sel:[0,0] op_sel_hi:[1,0]
    v_and_b32 v47, 0x0fffffff, v42
    v_mov_b32 v33, v42
    buffer_load_dwordx4 v[28:31], v47, s[8:11], 0 offen
    buffer_load_dwordx3 v[30:32], v47, s[8:11], 0 offen offset:8
    v_mov_b32 v44, v43
    s_cmp_gt_u32 s37, 1024
    s_cbranch_scc1 L2_xs18
    s_cmp_lg_u32 s43, 0
    s_cbranch_scc1 L2_xa18
L2_xb18:
    v_lshlrev_b32 v89, 16, v96
    v_add_u32 v90, 60, v97
    v_bitop3_b32 v90, v89, v45, v90 bitop3:0x6a
    ds_write_b32 v98, v90 offset:12
    v_lshlrev_b32 v89, 20, v96
    v_add_u32 v90, 40, v97
    v_bitop3_b32 v90, v89, v45, v90 bitop3:0x6a
    ds_write_b32 v98, v90 offset:8
    v_lshlrev_b32 v89, 24, v96
    v_add_u32 v90, 20, v97
    v_bitop3_b32 v90, v89, v45, v90 bitop3:0x6a
    ds_write_b32 v98, v90 offset:4
    v_lshlrev_b32 v89, 28, v96
    v_bitop3_b32 v90, v89, v45, v97 bitop3:0x6a
    ds_write_b32 v98, v90 offset:0
    v_mov_b32_dpp v91, v64 quad_perm:[1,1,1,1] row_mask:0xf bank_mask:0xf
    v_and_b32 v89, 3, v91
    v_and_b32 v97, 0xfffc, v91
    v_sub_u16_dpp v88, v64, v91 quad_perm:[3,3,3,3] row_mask:0xf bank_mask:0xf
    v_mad_u32_u24 v97, v97, 5, v4
    v_add_u32 v99, v88, v89
    v_bfm_b32 v96, v88, v89
    v_cmp_lt_u32 s[58:59], 16, v99
    v_lshlrev_b32 v89, v1, v96
    v_and_b32 v89, v45, v89
    v_cmp_ne_u32 vcc, 0, v89
    v_xor_b32 v90, v97, v89
    s_add_u32 s3, s37, s38
    v_mbcnt_lo_u32_b32 v98, vcc_lo, 0
    v_mbcnt_hi_u32_b32 v98, vcc_hi, v98
    s_bcnt1_i32_b64 s41, vcc
    v_lshl_add_u32 v98, v98, 2, s3
    s_mov_b64 exec, vcc
    ds_write_b32 v98, v90
    s_mov_b64 exec, -1
    s_lshl2_add_u32 s37, s41, s37
    s_cmp_lg_u64 s[58:59], 0
    s_cbranch_scc1 L2_xe18
L2_xr18:
    v_add_u32 v98, s37, v0
    v_mov_b32 v90, -1
    ds_write_b32 v98, v90
    ds_read2st64_b32 v[40:41], v0 offset0:0 offset1:1
    ds_read2st64_b32 v[42:43], v0 offset0:2 offset1:3
    s_sub_u32 s3, s37, 768
    s_cmp_gt_u32 s3, 256
    s_cbranch_scc1 L2_xf18
L2_xg18:
    s_setprio 2
    s_waitcnt vmcnt(10)
    ds_write_b128 v3, v[108:111] offset:0
    s_waitcnt lgkmcnt(12)
    v_cmpx_ne_u64 vcc, v[74:75], v[70:71]
    s_and_b64 s[82:83], vcc, s[80:81]
    s_cbranch_scc1 L2_c19
L2_d19:
    v_mov_b64 v[84:85], v[70:71]
    v_mov_b32 v7, v95
    v_mov_b64 v[86:87], v[74:75]
    s_mov_b64 exec, -1
    s_or_b64 s[80:81], s[80:81], vcc
    v_cmpx_ne_u64 vcc, v[72:73], v[68:69]
    s_and_b64 s[82:83], vcc, s[80:81]
    s_cbranch_scc1 L2_c20
L2_d20:
    v_mov_b64 v[84:85], v[68:69]
    v_mov_b32 v7, v94
    v_mov_b64 v[86:87], v[72:73]
    s_mov_b64 exec, -1
    s_or_b64 s[80:81], s[80:81], vcc
    ds_read_b64 v[70:71], v93
    s_and_b64 exec, s[84:85], s[80:81]
    v_mfma_f32_4x4x4_16b_bf16 v[76:79], v[12:13], v[84:85], 0
    v_mov_b32 v92, v7
    s_andn2_b64 s[80:81], s[80:81], s[84:85]
    v_mfma_f32_4x4x4_16b_bf16 v[76:79], v[10:11], v[86:87], v[76:79]
    s_mov_b64 exec, -1
    ds_read_b64 v[68:69], v92
    s_setprio 1
    s_waitcnt vmcnt(9)
    ds_write_b128 v3, v[112:115] offset:1024
    s_waitcnt lgkmcnt(1)
    v_mfma_f32_4x4x4_16b_bf16 v[80:83], v[10:11], v[70:71], v[80:83]
    v_mfma_f32_4x4x4_16b_bf16 v[76:79], v[10:11], v[68:69], v[76:79]
    v_and_b32 v46, 0x40000000, v39
    v_bitop3_b32 v94, v36, v5, v46 bitop3:0xea
    v_and_b32 v46, 0x80000000, v39
    v_bitop3_b32 v95, v37, v5, v46 bitop3:0xea
    v_perm_b32 v15, v37, v38, s47
    v_bitop3_b32 v46, v37, 0.5, -0.5 bitop3:0xa8
    v_perm_b32 v14, v36, v38, s46
    v_bitop3_b32 v47, v36, 0.5, -0.5 bitop3:0xa8
    v_cvt_pk_bf16_f32 v80, v80, v81
    v_cvt_pk_bf16_f32 v81, v82, v83
    ds_wrxchg_rtn_b64 v[74:75], v93, v[80:81]
    v_cvt_pk_bf16_f32 v76, v76, v77
    v_cvt_pk_bf16_f32 v77, v78, v79
    ds_wrxchg_rtn_b64 v[72:73], v92, v[76:77]
    s_setprio 0
    v_mfma_f32_4x4x4_16b_bf16 v[80:83], v[8:9], v[106:107], 0
    v_mfma_f32_4x4x4_16b_bf16 v[76:79], v[8:9], v[104:105], 0
    v_bitop3_b32 v15, v6, v15, v46 bitop3:0xca
    v_bitop3_b32 v14, v6, v14, v47 bitop3:0xca
    s_nop 1
    v_pk_mul_f32 v[80:81], v[80:81], v[14:15] op_sel:[0,1] op_sel_hi:[1,1]
    v_pk_mul_f32 v[82:83], v[82:83], v[14:15] op_sel:[0,1] op_sel_hi:[1,1]
    v_pk_mul_f32 v[76:77], v[76:77], v[14:15] op_sel:[0,0] op_sel_hi:[1,0]
    v_pk_mul_f32 v[78:79], v[78:79], v[14:15] op_sel:[0,0] op_sel_hi:[1,0]
    s_add_u32 s42, s42, 1
    s_waitcnt lgkmcnt(2)
    s_barrier
    s_bitcmp1_b32 s36, s42
    s_cbranch_scc1 L2_slow
L2_ret1:
    s_setprio 3
    v_and_b32 v47, 0x0fffffff, v44
    v_mov_b32 v39, v44
    buffer_load_dwordx4 v[34:37], v47, s[8:11], 0 offen
    buffer_load_dwordx3 v[36:38], v47, s[8:11], 0 offen offset:8
    s_waitcnt lgkmcnt(0)
    v_cmpx_ne_u64 vcc, v[74:75], v[70:71]
    s_and_b64 s[82:83], vcc, s[80:81]
    s_cbranch_scc1 L2_c21
L2_d21:
    v_mov_b64 v[84:85], v[70:71]
    v_mov_b32 v7, v93
    v_mov_b64 v[86:87], v[74:75]
    s_mov_b64 exec, -1
    s_or_b64 s[80:81], s[80:81], vcc
    v_cmpx_ne_u64 vcc, v[72:73], v[68:69]
    s_and_b64 s[82:83], vcc, s[80:81]
    s_cbranch_scc1 L2_c22
L2_d22:
    v_mov_b64 v[84:85], v[68:69]
    v_mov_b32 v7, v92
    v_mov_b64 v[86:87], v[72:73]
    s_mov_b64 exec, -1
    s_or_b64 s[80:81], s[80:81], vcc
    ds_read_b64 v[70:71], v95
    ds_read_b64 v[68:69], v94
    s_waitcnt vmcnt(9)
    v_and_b32 v46, 0x20000000, v21
    v_lshrrev_b32 v47, 14, v17
    v_bitop3_b32 v47, v47, v5, v46 bitop3:0xea
    ds_read_b64 v[102:103], v47 offset:63616
    v_bitop3_b32 v93, v17, v5, v46 bitop3:0xea
    v_and_b32 v46, 0x10000000, v21
    v_lshrrev_b32 v47, 14, v16
    v_bitop3_b32 v47, v47, v5, v46 bitop3:0xea
    ds_read_b64 v[100:101], v47 offset:63616
    v_bitop3_b32 v92, v16, v5, v46 bitop3:0xea
    s_waitcnt lgkmcnt(2)
    v_mfma_f32_4x4x4_16b_bf16 v[80:83], v[10:11], v[70:71], v[80:83]
    v_mfma_f32_4x4x4_16b_bf16 v[76:79], v[10:11], v[68:69], v[76:79]
    v_perm_b32 v15, v17, v20, s45
    v_bitop3_b32 v46, v17, 0.5, -0.5 bitop3:0xa8
    v_perm_b32 v14, v16, v20, s44
    v_bitop3_b32 v47, v16, 0.5, -0.5 bitop3:0xa8
    v_cvt_pk_bf16_f32 v80, v80, v81
    v_cvt_pk_bf16_f32 v81, v82, v83
    ds_wrxchg_rtn_b64 v[74:75], v95, v[80:81]
    v_cvt_pk_bf16_f32 v76, v76, v77
    v_cvt_pk_bf16_f32 v77, v78, v79
    ds_wrxchg_rtn_b64 v[72:73], v94, v[76:77]
    s_waitcnt lgkmcnt(2)
    v_mfma_f32_4x4x4_16b_bf16 v[80:83], v[8:9], v[102:103], 0
    v_mfma_f32_4x4x4_16b_bf16 v[76:79], v[8:9], v[100:101], 0
    v_bitop3_b32 v15, v6, v15, v46 bitop3:0xca
    v_bitop3_b32 v14, v6, v14, v47 bitop3:0xca
    v_cmp_lt_u32 s[84:85], v5, v92
    s_nop 0
    v_pk_mul_f32 v[80:81], v[80:81], v[14:15] op_sel:[0,1] op_sel_hi:[1,1]
    v_pk_mul_f32 v[82:83], v[82:83], v[14:15] op_sel:[0,1] op_sel_hi:[1,1]
    v_pk_mul_f32 v[76:77], v[76:77], v[14:15] op_sel:[0,0] op_sel_hi:[1,0]
    v_pk_mul_f32 v[78:79], v[78:79], v[14:15] op_sel:[0,0] op_sel_hi:[1,0]
    buffer_load_dwordx4 v[108:111], v3, s[16:19], s40 offen offset:0
    s_waitcnt lgkmcnt(0)
    v_cmpx_ne_u64 vcc, v[74:75], v[70:71]
    s_and_b64 s[82:83], vcc, s[80:81]
    s_cbranch_scc1 L2_c23
L2_d23:
    v_mov_b64 v[84:85], v[70:71]
    v_mov_b32 v7, v95
    v_mov_b64 v[86:87], v[74:75]
    s_mov_b64 exec, -1
    s_or_b64 s[80:81], s[80:81], vcc
    v_cmpx_ne_u64 vcc, v[72:73], v[68:69]
    s_and_b64 s[82:83], vcc, s[80:81]
    s_cbranch_scc1 L2_c24
L2_d24:
    v_mov_b64 v[84:85], v[68:69]
    v_mov_b32 v7, v94
    v_mov_b64 v[86:87], v[72:73]
    s_mov_b64 exec, -1
    s_or_b64 s[80:81], s[80:81], vcc
    ds_read_b64 v[70:71], v93
    s_and_b64 exec, s[84:85], s[80:81]
    v_mfma_f32_4x4x4_16b_bf16 v[76:79], v[12:13], v[84:85], 0
    v_mov_b32 v92, v7
    s_andn2_b64 s[80:81], s[80:81], s[84:85]
    v_mfma_f32_4x4x4_16b_bf16 v[76:79], v[10:11], v[86:87], v[76:79]
    s_mov_b64 exec, -1
    ds_read_b64 v[68:69], v92
    v_and_b32 v46, 0x80000000, v21
    v_lshrrev_b32 v47, 14, v19
    v_bitop3_b32 v47, v47, v5, v46 bitop3:0xea
    ds_read_b64 v[106:107], v47 offset:63616
    v_bitop3_b32 v95, v19, v5, v46 bitop3:0xea
    v_and_b32 v46, 0x40000000, v21
    v_lshrrev_b32 v47, 14, v18
    v_bitop3_b32 v47, v47, v5, v46 bitop3:0xea
    ds_read_b64 v[104:105], v47 offset:63616
    v_bitop3_b32 v94, v18, v5, v46 bitop3:0xea
    s_waitcnt lgkmcnt(2)
    v_mfma_f32_4x4x4_16b_bf16 v[80:83], v[10:11], v[70:71], v[80:83]
    v_mfma_f32_4x4x4_16b_bf16 v[76:79], v[10:11], v[68:69], v[76:79]
    v_perm_b32 v15, v19, v20, s47
    v_bitop3_b32 v46, v19, 0.5, -0.5 bitop3:0xa8
    v_perm_b32 v14, v18, v20, s46
    v_bitop3_b32 v47, v18, 0.5, -0.5 bitop3:0xa8
    v_cvt_pk_bf16_f32 v80, v80, v81
    v_cvt_pk_bf16_f32 v81, v82, v83
    ds_wrxchg_rtn_b64 v[74:75], v93, v[80:81]
    v_cvt_pk_bf16_f32 v76, v76, v77
    v_cvt_pk_bf16_f32 v77, v78, v79
    ds_wrxchg_rtn_b64 v[72:73], v92, v[76:77]
    s_setprio 2
    s_waitcnt lgkmcnt(2)
    v_mfma_f32_4x4x4_16b_bf16 v[80:83], v[8:9], v[106:107], 0
    v_mfma_f32_4x4x4_16b_bf16 v[76:79], v[8:9], v[104:105], 0
    v_bitop3_b32 v15, v6, v15, v46 bitop3:0xca
    v_bitop3_b32 v14, v6, v14, v47 bitop3:0xca
    s_nop 1
    v_pk_mul_f32 v[80:81], v[80:81], v[14:15] op_sel:[0,1] op_sel_hi:[1,1]
    v_pk_mul_f32 v[82:83], v[82:83], v[14:15] op_sel:[0,1] op_sel_hi:[1,1]
    v_pk_mul_f32 v[76:77], v[76:77], v[14:15] op_sel:[0,0] op_sel_hi:[1,0]
    v_pk_mul_f32 v[78:79], v[78:79], v[14:15] op_sel:[0,0] op_sel_hi:[1,0]
    v_and_b32 v47, 0x0fffffff, v40
    v_mov_b32 v21, v40
    buffer_load_dwordx4 v[16:19], v47, s[8:11], 0 offen
    buffer_load_dwordx3 v[18:20], v47, s[8:11], 0 offen offset:8
    s_waitcnt lgkmcnt(0)
    v_cmpx_ne_u64 vcc, v[74:75], v[70:71]
    s_and_b64 s[82:83], vcc, s[80:81]
    s_cbranch_scc1 L2_c25
L2_d25:
    v_mov_b64 v[84:85], v[70:71]
    v_mov_b32 v7, v93
    v_mov_b64 v[86:87], v[74:75]
    s_mov_b64 exec, -1
    s_or_b64 s[80:81], s[80:81], vcc
    v_cmpx_ne_u64 vcc, v[72:73], v[68:69]
    s_and_b64 s[82:83], vcc, s[80:81]
    s_cbranch_scc1 L2_c26
L2_d26:
    v_mov_b64 v[84:85], v[68:69]
    v_mov_b32 v7, v92
    v_mov_b64 v[86:87], v[72:73]
    s_mov_b64 exec, -1
    s_or_b64 s[80:81], s[80:81], vcc
    ds_read_b64 v[70:71], v95
    ds_read_b64 v[68:69], v94
    s_waitcnt vmcnt(10)
    v_and_b32 v46, 0x20000000, v27
    v_lshrrev_b32 v47, 14, v23
    v_bitop3_b32 v47, v47, v5, v46 bitop3:0xea
    ds_read_b64 v[102:103], v47 offset:63616
    v_bitop3_b32 v93, v23, v5, v46 bitop3:0xea
    v_and_b32 v46, 0x10000000, v27
    v_lshrrev_b32 v47, 14, v22
    v_bitop3_b32 v47, v47, v5, v46 bitop3:0xea
    ds_read_b64 v[100:101], v47 offset:63616
    v_bitop3_b32 v92, v22, v5, v46 bitop3:0xea
    s_waitcnt lgkmcnt(2)
    v_mfma_f32_4x4x4_16b_bf16 v[80:83], v[10:11], v[70:71], v[80:83]
    v_mfma_f32_4x4x4_16b_bf16 v[76:79], v[10:11], v[68:69], v[76:79]
    v_perm_b32 v15, v23, v26, s45
    v_bitop3_b32 v46, v23, 0.5, -0.5 bitop3:0xa8
    v_perm_b32 v14, v22, v26, s44
    v_bitop3_b32 v47, v22, 0.5, -0.5 bitop3:0xa8
    v_cvt_pk_bf16_f32 v80, v80, v81
    v_cvt_pk_bf16_f32 v81, v82, v83
    ds_wrxchg_rtn_b64 v[74:75], v95, v[80:81]
    v_cvt_pk_bf16_f32 v76, v76, v77
    v_cvt_pk_bf16_f32 v77, v78, v79
    ds_wrxchg_rtn_b64 v[72:73], v94, v[76:77]
    s_waitcnt lgkmcnt(2)
    v_mfma_f32_4x4x4_16b_bf16 v[80:83], v[8:9], v[102:103], 0
    v_mfma_f32_4x4x4_16b_bf16 v[76:79], v[8:9], v[100:101], 0
    v_bitop3_b32 v15, v6, v15, v46 bitop3:0xca
    v_bitop3_b32 v14, v6, v14, v47 bitop3:0xca
    v_cmp_lt_u32 s[84:85], v5, v92
    s_nop 0
    v_pk_mul_f32 v[80:81], v[80:81], v[14:15] op_sel:[0,1] op_sel_hi:[1,1]
    v_pk_mul_f32 v[82:83], v[82:83], v[14:15] op_sel:[0,1] op_sel_hi:[1,1]
    v_pk_mul_f32 v[76:77], v[76:77], v[14:15] op_sel:[0,0] op_sel_hi:[1,0]
    v_pk_mul_f32 v[78:79], v[78:79], v[14:15] op_sel:[0,0] op_sel_hi:[1,0]
    v_sub_u16 v88, v62, v54
    v_and_b32 v89, 3, v54
    v_add3_u32 v99, v88, v89, 3
    v_and_b32 v99, -4, v99
    v_max_u32 v99, 4, v99
    v_and_b32 v97, 0xfffc, v54
    v_bfm_b32 v96, v88, v89
    v_add_u32_dpp v91, v99, v99 row_shr:1 row_mask:0xf bank_mask:0xf bound_ctrl:1
    v_mad_u32_u24 v97, v97, 5, v2
    v_cmp_lt_u32 vcc, 16, v99
    v_add_u32_dpp v91, v91, v91 row_shr:2 row_mask:0xf bank_mask:0xf bound_ctrl:1
    v_sub_u32 v98, s38, v99
    v_lshrrev_b64 v[54:55], 16, v[54:55]
    v_add_u32_dpp v91, v91, v91 row_shr:4 row_mask:0xf bank_mask:0xf bound_ctrl:1
    v_lshrrev_b64 v[62:63], 16, v[62:63]
    s_mov_b32 s43, 0
    v_add_u32_dpp v91, v91, v91 row_shr:8 row_mask:0xf bank_mask:0xf bound_ctrl:1
    s_nop 1
    v_add_u32_dpp v91, v91, v91 row_bcast:15 row_mask:0xa bank_mask:0xf
    s_nop 1
    v_add_u32_dpp v91, v91, v91 row_bcast:31 row_mask:0xc bank_mask:0xf
    v_add_u32 v98, v98, v91
    v_readlane_b32 s37, v91, 63
    s_cbranch_vccnz L2_xo27
L2_xp27:
    buffer_load_dwordx4 v[112:115], v3, s[16:19], s40 offen offset:1024
    s_waitcnt lgkmcnt(0)
    v_cmpx_ne_u64 vcc, v[74:75], v[70:71]
    s_and_b64 s[82:83], vcc, s[80:81]
    s_cbranch_scc1 L2_c28
L2_d28:
    v_mov_b64 v[84:85], v[70:71]
    v_mov_b32 v7, v95
    v_mov_b64 v[86:87], v[74:75]
    s_mov_b64 exec, -1
    s_or_b64 s[80:81], s[80:81], vcc
    v_cmpx_ne_u64 vcc, v[72:73], v[68:69]
    s_and_b64 s[82:83], vcc, s[80:81]
    s_cbranch_scc1 L2_c29
L2_d29:
    v_mov_b64 v[84:85], v[68:69]
    v_mov_b32 v7, v94
    v_mov_b64 v[86:87], v[72:73]
    s_mov_b64 exec, -1
    s_or_b64 s[80:81], s[80:81], vcc
    ds_read_b64 v[70:71], v93
    s_and_b64 exec, s[84:85], s[80:81]
    v_mfma_f32_4x4x4_16b_bf16 v[76:79], v[12:13], v[84:85], 0
    v_mov_b32 v92, v7
    s_andn2_b64 s[80:81], s[80:81], s[84:85]
    v_mfma_f32_4x4x4_16b_bf16 v[76:79], v[10:11], v[86:87], v[76:79]
    s_mov_b64 exec, -1
    ds_read_b64 v[68:69], v92
    v_and_b32 v46, 0x80000000, v27
    v_lshrrev_b32 v47, 14, v25
    v_bitop3_b32 v47, v47, v5, v46 bitop3:0xea
    ds_read_b64 v[106:107], v47 offset:63616
    v_bitop3_b32 v95, v25, v5, v46 bitop3:0xea
    v_and_b32 v46, 0x40000000, v27
    v_lshrrev_b32 v47, 14, v24
    v_bitop3_b32 v47, v47, v5, v46 bitop3:0xea
    ds_read_b64 v[104:105], v47 offset:63616
    v_bitop3_b32 v94, v24, v5, v46 bitop3:0xea
    s_waitcnt lgkmcnt(2)
    v_mfma_f32_4x4x4_16b_bf16 v[80:83], v[10:11], v[70:71], v[80:83]
    v_mfma_f32_4x4x4_16b_bf16 v[76:79], v[10:11], v[68:69], v[76:79]
    v_perm_b32 v15, v25, v26, s47
    v_bitop3_b32 v46, v25, 0.5, -0.5 bitop3:0xa8
    v_perm_b32 v14, v24, v26, s46
    v_bitop3_b32 v47, v24, 0.5, -0.5 bitop3:0xa8
    v_cvt_pk_bf16_f32 v80, v80, v81
    v_cvt_pk_bf16_f32 v81, v82, v83
    ds_wrxchg_rtn_b64 v[74:75], v93, v[80:81]
    v_cvt_pk_bf16_f32 v76, v76, v77
    v_cvt_pk_bf16_f32 v77, v78, v79
    ds_wrxchg_rtn_b64 v[72:73], v92, v[76:77]
    s_setprio 1
    s_waitcnt lgkmcnt(2)
    v_mfma_f32_4x4x4_16b_bf16 v[80:83], v[8:9], v[106:107], 0
    v_mfma_f32_4x4x4_16b_bf16 v[76:79], v[8:9], v[104:105], 0
    v_bitop3_b32 v15, v6, v15, v46 bitop3:0xca
    v_bitop3_b32 v14, v6, v14, v47 bitop3:0xca
    s_nop 1
    v_pk_mul_f32 v[80:81], v[80:81], v[14:15] op_sel:[0,1] op_sel_hi:[1,1]
    v_pk_mul_f32 v[82:83], v[82:83], v[14:15] op_sel:[0,1] op_sel_hi:[1,1]
    v_pk_mul_f32 v[76:77], v[76:77], v[14:15] op_sel:[0,0] op_sel_hi:[1,0]
    v_pk_mul_f32 v[78:79], v[78:79], v[14:15] op_sel:[0,0] op_sel_hi:[1,0]
    v_and_b32 v47, 0x0fffffff, v41
    v_mov_b32 v27, v41
    buffer_load_dwordx4 v[22:25], v47, s[8:11], 0 offen
    buffer_load_dwordx3 v[24:26], v47, s[8:11], 0 offen offset:8
    s_waitcnt lgkmcnt(0)
    v_cmpx_ne_u64 vcc, v[74:75], v[70:71]
    s_and_b64 s[82:83], vcc, s[80:81]
    s_cbranch_scc1 L2_c30
L2_d30:
    v_mov_b64 v[84:85], v[70:71]
    v_mov_b32 v7, v93
    v_mov_b64 v[86:87], v[74:75]
    s_mov_b64 exec, -1
    s_or_b64 s[80:81], s[80:81], vcc
    v_cmpx_ne_u64 vcc, v[72:73], v[68:69]
    s_and_b64 s[82:83], vcc, s[80:81]
    s_cbranch_scc1 L2_c31
L2_d31:
    v_mov_b64 v[84:85], v[68:69]
    v_mov_b32 v7, v92
    v_mov_b64 v[86:87], v[72:73]
    s_mov_b64 exec, -1
    s_or_b64 s[80:81], s[80:81], vcc
    ds_read_b64 v[70:71], v95
    ds_read_b64 v[68:69], v94
    s_waitcnt vmcnt(8)
    v_and_b32 v46, 0x20000000, v33
    v_lshrrev_b32 v47, 14, v29
    v_bitop3_b32 v47, v47, v5, v46 bitop3:0xea
    ds_read_b64 v[102:103], v47 offset:63616
    v_bitop3_b32 v93, v29, v5, v46 bitop3:0xea
    v_and_b32 v46, 0x10000000, v33
    v_lshrrev_b32 v47, 14, v28
    v_bitop3_b32 v47, v47, v5, v46 bitop3:0xea
    ds_read_b64 v[100:101], v47 offset:63616
    v_bitop3_b32 v92, v28, v5, v46 bitop3:0xea
    s_waitcnt lgkmcnt(2)
    v_mfma_f32_4x4x4_16b_bf16 v[80:83], v[10:11], v[70:71], v[80:83]
    v_mfma_f32_4x4x4_16b_bf16 v[76:79], v[10:11], v[68:69], v[76:79]
    v_perm_b32 v15, v29, v32, s45
    v_bitop3_b32 v46, v29, 0.5, -0.5 bitop3:0xa8
    v_perm_b32 v14, v28, v32, s44
    v_bitop3_b32 v47, v28, 0.5, -0.5 bitop3:0xa8
    v_cvt_pk_bf16_f32 v80, v80, v81
    v_cvt_pk_bf16_f32 v81, v82, v83
    ds_wrxchg_rtn_b64 v[74:75], v95, v[80:81]
    v_cvt_pk_bf16_f32 v76, v76, v77
    v_cvt_pk_bf16_f32 v77, v78, v79
    ds_wrxchg_rtn_b64 v[72:73], v94, v[76:77]
    s_waitcnt lgkmcnt(2)
    v_mfma_f32_4x4x4_16b_bf16 v[80:83], v[8:9], v[102:103], 0
    v_mfma_f32_4x4x4_16b_bf16 v[76:79], v[8:9], v[100:101], 0
    v_bitop3_b32 v15, v6, v15, v46 bitop3:0xca
    v_bitop3_b32 v14, v6, v14, v47 bitop3:0xca
    v_cmp_lt_u32 s[84:85], v5, v92
    s_nop 0
    v_pk_mul_f32 v[80:81], v[80:81], v[14:15] op_sel:[0,1] op_sel_hi:[1,1]
    v_pk_mul_f32 v[82:83], v[82:83], v[14:15] op_sel:[0,1] op_sel_hi:[1,1]
    v_pk_mul_f32 v[76:77], v[76:77], v[14:15] op_sel:[0,0] op_sel_hi:[1,0]
    v_pk_mul_f32 v[78:79], v[78:79], v[14:15] op_sel:[0,0] op_sel_hi:[1,0]
    s_waitcnt lgkmcnt(0)
    v_cmpx_ne_u64 vcc, v[74:75], v[70:71]
    s_and_b64 s[82:83], vcc, s[80:81]
    s_cbranch_scc1 L2_c32
L2_d32:
    v_mov_b64 v[84:85], v[70:71]
    v_mov_b32 v7, v95
    v_mov_b64 v[86:87], v[74:75]
    s_mov_b64 exec, -1
    s_or_b64 s[80:81], s[80:81], vcc
    v_cmpx_ne_u64 vcc, v[72:73], v[68:69]
    s_and_b64 s[82:83], vcc, s[80:81]
    s_cbranch_scc1 L2_c33
L2_d33:
    v_mov_b64 v[84:85], v[68:69]
    v_mov_b32 v7, v94
    v_mov_b64 v[86:87], v[72:73]
    s_mov_b64 exec, -1
    s_or_b64 s[80:81], s[80:81], vcc
    ds_read_b64 v[70:71], v93
    s_and_b64 exec, s[84:85], s[80:81]
    v_mfma_f32_4x4x4_16b_bf16 v[76:79], v[12:13], v[84:85], 0
    v_mov_b32 v92, v7
    s_andn2_b64 s[80:81], s[80:81], s[84:85]
    v_mfma_f32_4x4x4_16b_bf16 v[76:79], v[10:11], v[86:87], v[76:79]
    s_mov_b64 exec, -1
    ds_read_b64 v[68:69], v92
    v_and_b32 v46, 0x80000000, v33
    v_lshrrev_b32 v47, 14, v31
    v_bitop3_b32 v47, v47, v5, v46 bitop3:0xea
    ds_read_b64 v[106:107], v47 offset:63616
    v_bitop3_b32 v95, v31, v5, v46 bitop3:0xea
    v_and_b32 v46, 0x40000000, v33
    v_lshrrev_b32 v47, 14, v30
    v_bitop3_b32 v47, v47, v5, v46 bitop3:0xea
    ds_read_b64 v[104:105], v47 offset:63616
    v_bitop3_b32 v94, v30, v5, v46 bitop3:0xea
    s_waitcnt lgkmcnt(2)
    v_mfma_f32_4x4x4_16b_bf16 v[80:83], v[10:11], v[70:71], v[80:83]
    v_mfma_f32_4x4x4_16b_bf16 v[76:79], v[10:11], v[68:69], v[76:79]
    v_perm_b32 v15, v31, v32, s47
    v_bitop3_b32 v46, v31, 0.5, -0.5 bitop3:0xa8
    v_perm_b32 v14, v30, v32, s46
    v_bitop3_b32 v47, v30, 0.5, -0.5 bitop3:0xa8
    v_cvt_pk_bf16_f32 v80, v80, v81
    v_cvt_pk_bf16_f32 v81, v82, v83
    ds_wrxchg_rtn_b64 v[74:75], v93, v[80:81]
    v_cvt_pk_bf16_f32 v76, v76, v77
    v_cvt_pk_bf16_f32 v77, v78, v79
    ds_wrxchg_rtn_b64 v[72:73], v92, v[76:77]
    s_setprio 0
    s_waitcnt lgkmcnt(2)
    v_mfma_f32_4x4x4_16b_bf16 v[80:83], v[8:9], v[106:107], 0
    v_mfma_f32_4x4x4_16b_bf16 v[76:79], v[8:9], v[104:105], 0
    v_bitop3_b32 v15, v6, v15, v46 bitop3:0xca
    v_bitop3_b32 v14, v6, v14, v47 bitop3:0xca
    s_nop 1
    v_pk_mul_f32 v[80:81], v[80:81], v[14:15] op_sel:[0,1] op_sel_hi:[1,1]
    v_pk_mul_f32 v[82:83], v[82:83], v[14:15] op_sel:[0,1] op_sel_hi:[1,1]
    v_pk_mul_f32 v[76:77], v[76:77], v[14:15] op_sel:[0,0] op_sel_hi:[1,0]
    v_pk_mul_f32 v[78:79], v[78:79], v[14:15] op_sel:[0,0] op_sel_hi:[1,0]
    s_add_u32 s40, s40, 0x4e200
    v_and_b32 v47, 0x0fffffff, v42
    v_mov_b32 v33, v42
    buffer_load_dwordx4 v[28:31], v47, s[8:11], 0 offen
    buffer_load_dwordx3 v[30:32], v47, s[8:11], 0 offen offset:8
    s_waitcnt lgkmcnt(0)
    v_cmpx_ne_u64 vcc, v[74:75], v[70:71]
    s_and_b64 s[82:83], vcc, s[80:81]
    s_cbranch_scc1 L2_c34
L2_d34:
    v_mov_b64 v[84:85], v[70:71]
    v_mov_b32 v7, v93
    v_mov_b64 v[86:87], v[74:75]
    s_mov_b64 exec, -1
    s_or_b64 s[80:81], s[80:81], vcc
    v_cmpx_ne_u64 vcc, v[72:73], v[68:69]
    s_and_b64 s[82:83], vcc, s[80:81]
    s_cbranch_scc1 L2_c35
L2_d35:
    v_mov_b64 v[84:85], v[68:69]
    v_mov_b32 v7, v92
    v_mov_b64 v[86:87], v[72:73]
    s_mov_b64 exec, -1
    s_or_b64 s[80:81], s[80:81], vcc
    ds_read_b64 v[70:71], v95
    ds_read_b64 v[68:69], v94
    s_waitcnt vmcnt(8)
    v_and_b32 v46, 0x20000000, v39
    v_lshrrev_b32 v47, 14, v35
    v_bitop3_b32 v47, v47, v5, v46 bitop3:0xea
    ds_read_b64 v[102:103], v47 offset:63616
    v_bitop3_b32 v93, v35, v5, v46 bitop3:0xea
    v_and_b32 v46, 0x10000000, v39
    v_lshrrev_b32 v47, 14, v34
    v_bitop3_b32 v47, v47, v5, v46 bitop3:0xea
    ds_read_b64 v[100:101], v47 offset:63616
    v_bitop3_b32 v92, v34, v5, v46 bitop3:0xea
    v_and_b32 v46, 0x80000000, v39
    v_lshrrev_b32 v47, 14, v37
    v_bitop3_b32 v47, v47, v5, v46 bitop3:0xea
    ds_read_b64 v[106:107], v47 offset:63616
    v_and_b32 v46, 0x40000000, v39
    v_lshrrev_b32 v47, 14, v36
    v_bitop3_b32 v47, v47, v5, v46 bitop3:0xea
    ds_read_b64 v[104:105], v47 offset:63616
    s_waitcnt lgkmcnt(4)
    v_mfma_f32_4x4x4_16b_bf16 v[80:83], v[10:11], v[70:71], v[80:83]
    v_mfma_f32_4x4x4_16b_bf16 v[76:79], v[10:11], v[68:69], v[76:79]
    v_perm_b32 v15, v35, v38, s45
    v_bitop3_b32 v46, v35, 0.5, -0.5 bitop3:0xa8
    v_perm_b32 v14, v34, v38, s44
    v_bitop3_b32 v47, v34, 0.5, -0.5 bitop3:0xa8
    v_cvt_pk_bf16_f32 v80, v80, v81
    v_cvt_pk_bf16_f32 v81, v82, v83
    ds_wrxchg_rtn_b64 v[74:75], v95, v[80:81]
    v_cvt_pk_bf16_f32 v76, v76, v77
    v_cvt_pk_bf16_f32 v77, v78, v79
    ds_wrxchg_rtn_b64 v[72:73], v94, v[76:77]
    s_waitcnt lgkmcnt(2)
    s_barrier
    s_setprio 3
    ds_write_b128 v3, v[124:127] offset:4096
    s_add_u32 s3, s40, 4096
    buffer_load_dwordx4 v[124:127], v3, s[16:19], s3 offen
    ds_write_b128 v3, v[116:119] offset:2048
    buffer_load_dwordx4 v[116:119], v3, s[16:19], s40 offen offset:2048
    ds_write_b128 v3, v[120:123] offset:3072
    buffer_load_dwordx4 v[120:123], v3, s[16:19], s40 offen offset:3072
    v_mfma_f32_4x4x4_16b_bf16 v[80:83], v[8:9], v[102:103], 0
    v_mfma_f32_4x4x4_16b_bf16 v[76:79], v[8:9], v[100:101], 0
    v_bitop3_b32 v15, v6, v15, v46 bitop3:0xca
    v_bitop3_b32 v14, v6, v14, v47 bitop3:0xca
    v_cmp_lt_u32 s[84:85], v5, v92
    s_nop 0
    v_pk_mul_f32 v[80:81], v[80:81], v[14:15] op_sel:[0,1] op_sel_hi:[1,1]
    v_pk_mul_f32 v[82:83], v[82:83], v[14:15] op_sel:[0,1] op_sel_hi:[1,1]
    v_pk_mul_f32 v[76:77], v[76:77], v[14:15] op_sel:[0,0] op_sel_hi:[1,0]
    v_pk_mul_f32 v[78:79], v[78:79], v[14:15] op_sel:[0,0] op_sel_hi:[1,0]
    v_mov_b32 v44, v43
    s_cmp_gt_u32 s37, 1024
    s_cbranch_scc1 L2_xs36
    s_cmp_lg_u32 s43, 0
    s_cbranch_scc1 L2_xa36
L2_xb36:
    v_lshlrev_b32 v89, 16, v96
    v_add_u32 v90, 60, v97
    v_bitop3_b32 v90, v89, v45, v90 bitop3:0x6a
    ds_write_b32 v98, v90 offset:12
    v_lshlrev_b32 v89, 20, v96
    v_add_u32 v90, 40, v97
    v_bitop3_b32 v90, v89, v45, v90 bitop3:0x6a
    ds_write_b32 v98, v90 offset:8
    v_lshlrev_b32 v89, 24, v96
    v_add_u32 v90, 20, v97
    v_bitop3_b32 v90, v89, v45, v90 bitop3:0x6a
    ds_write_b32 v98, v90 offset:4
    v_lshlrev_b32 v89, 28, v96
    v_bitop3_b32 v90, v89, v45, v97 bitop3:0x6a
    ds_write_b32 v98, v90 offset:0
    v_mov_b32_dpp v91, v66 quad_perm:[1,1,1,1] row_mask:0xf bank_mask:0xf
    v_and_b32 v89, 3, v91
    v_and_b32 v97, 0xfffc, v91
    v_sub_u16_dpp v88, v66, v91 quad_perm:[3,3,3,3] row_mask:0xf bank_mask:0xf
    v_mad_u32_u24 v97, v97, 5, v4
    v_add_u32 v99, v88, v89
    v_bfm_b32 v96, v88, v89
    v_cmp_lt_u32 s[58:59], 16, v99
    v_lshlrev_b32 v89, v1, v96
    v_and_b32 v89, v45, v89
    v_cmp_ne_u32 vcc, 0, v89
    v_xor_b32 v90, v97, v89
    s_add_u32 s3, s37, s38
    v_mbcnt_lo_u32_b32 v98, vcc_lo, 0
    v_mbcnt_hi_u32_b32 v98, vcc_hi, v98
    s_bcnt1_i32_b64 s41, vcc
    v_lshl_add_u32 v98, v98, 2, s3
    s_mov_b64 exec, vcc
    ds_write_b32 v98, v90
    s_mov_b64 exec, -1
    s_lshl2_add_u32 s37, s41, s37
    s_cmp_lg_u64 s[58:59], 0
    s_cbranch_scc1 L2_xe36
L2_xr36:
    v_add_u32 v98, s37, v0
    v_mov_b32 v90, -1
    ds_write_b32 v98, v90
    ds_read2st64_b32 v[40:41], v0 offset0:0 offset1:1
    ds_read2st64_b32 v[42:43], v0 offset0:2 offset1:3
    s_sub_u32 s3, s37, 768
    s_cmp_gt_u32 s3, 256
    s_cbranch_scc1 L2_xf36
L2_xg36:
    v_lshrrev_b64 v[64:65], 16, v[64:65]
    v_lshrrev_b64 v[66:67], 16, v[66:67]
    s_setprio 2
    s_waitcnt vmcnt(10)
    ds_write_b128 v3, v[108:111] offset:0
    s_waitcnt lgkmcnt(12)
    v_cmpx_ne_u64 vcc, v[74:75], v[70:71]
    s_and_b64 s[82:83], vcc, s[80:81]
    s_cbranch_scc1 L2_c37
L2_d37:
    v_mov_b64 v[84:85], v[70:71]
    v_mov_b32 v7, v95
    v_mov_b64 v[86:87], v[74:75]
    s_mov_b64 exec, -1
    s_or_b64 s[80:81], s[80:81], vcc
    v_cmpx_ne_u64 vcc, v[72:73], v[68:69]
    s_and_b64 s[82:83], vcc, s[80:81]
    s_cbranch_scc1 L2_c38
L2_d38:
    v_mov_b64 v[84:85], v[68:69]
    v_mov_b32 v7, v94
    v_mov_b64 v[86:87], v[72:73]
    s_mov_b64 exec, -1
    s_or_b64 s[80:81], s[80:81], vcc
    ds_read_b64 v[70:71], v93
    s_and_b64 exec, s[84:85], s[80:81]
    v_mfma_f32_4x4x4_16b_bf16 v[76:79], v[12:13], v[84:85], 0
    v_mov_b32 v92, v7
    s_andn2_b64 s[80:81], s[80:81], s[84:85]
    v_mfma_f32_4x4x4_16b_bf16 v[76:79], v[10:11], v[86:87], v[76:79]
    s_mov_b64 exec, -1
    ds_read_b64 v[68:69], v92
    s_setprio 1
    s_waitcnt vmcnt(7)
    ds_write_b128 v3, v[112:115] offset:1024
    s_waitcnt lgkmcnt(1)
    v_mfma_f32_4x4x4_16b_bf16 v[80:83], v[10:11], v[70:71], v[80:83]
    v_mfma_f32_4x4x4_16b_bf16 v[76:79], v[10:11], v[68:69], v[76:79]
    v_and_b32 v46, 0x40000000, v39
    v_bitop3_b32 v94, v36, v5, v46 bitop3:0xea
    v_and_b32 v46, 0x80000000, v39
    v_bitop3_b32 v95, v37, v5, v46 bitop3:0xea
    v_perm_b32 v15, v37, v38, s47
    v_bitop3_b32 v46, v37, 0.5, -0.5 bitop3:0xa8
    v_perm_b32 v14, v36, v38, s46
    v_bitop3_b32 v47, v36, 0.5, -0.5 bitop3:0xa8
    v_cvt_pk_bf16_f32 v80, v80, v81
    v_cvt_pk_bf16_f32 v81, v82, v83
    ds_wrxchg_rtn_b64 v[74:75], v93, v[80:81]
    v_cvt_pk_bf16_f32 v76, v76, v77
    v_cvt_pk_bf16_f32 v77, v78, v79
    ds_wrxchg_rtn_b64 v[72:73], v92, v[76:77]
    s_setprio 0
    v_mfma_f32_4x4x4_16b_bf16 v[80:83], v[8:9], v[106:107], 0
    v_mfma_f32_4x4x4_16b_bf16 v[76:79], v[8:9], v[104:105], 0
    v_bitop3_b32 v15, v6, v15, v46 bitop3:0xca
    v_bitop3_b32 v14, v6, v14, v47 bitop3:0xca
    s_nop 1
    v_pk_mul_f32 v[80:81], v[80:81], v[14:15] op_sel:[0,1] op_sel_hi:[1,1]
    v_pk_mul_f32 v[82:83], v[82:83], v[14:15] op_sel:[0,1] op_sel_hi:[1,1]
    v_pk_mul_f32 v[76:77], v[76:77], v[14:15] op_sel:[0,0] op_sel_hi:[1,0]
    v_pk_mul_f32 v[78:79], v[78:79], v[14:15] op_sel:[0,0] op_sel_hi:[1,0]
    s_add_u32 s42, s42, 1
    s_waitcnt lgkmcnt(2)
L2_loop:
    s_barrier
    s_bitcmp1_b32 s36, s42
    s_cbranch_scc1 L2_slow
L2_ret2:
    s_setprio 3
    v_and_b32 v47, 0x0fffffff, v44
    v_mov_b32 v39, v44
    buffer_load_dwordx4 v[34:37], v47, s[8:11], 0 offen
    buffer_load_dwordx3 v[36:38], v47, s[8:11], 0 offen offset:8
    s_waitcnt lgkmcnt(0)
    v_cmpx_ne_u64 vcc, v[74:75], v[70:71]
    s_and_b64 s[82:83], vcc, s[80:81]
    s_cbranch_scc1 L2_c39
L2_d39:
    v_mov_b64 v[84:85], v[70:71]
    v_mov_b32 v7, v93
    v_mov_b64 v[86:87], v[74:75]
    s_mov_b64 exec, -1
    s_or_b64 s[80:81], s[80:81], vcc
    v_cmpx_ne_u64 vcc, v[72:73], v[68:69]
    s_and_b64 s[82:83], vcc, s[80:81]
    s_cbranch_scc1 L2_c40
L2_d40:
    v_mov_b64 v[84:85], v[68:69]
    v_mov_b32 v7, v92
    v_mov_b64 v[86:87], v[72:73]
    s_mov_b64 exec, -1
    s_or_b64 s[80:81], s[80:81], vcc
    ds_read_b64 v[70:71], v95
    ds_read_b64 v[68:69], v94
    v_and_b32 v46, 0x20000000, v21
    v_lshrrev_b32 v47, 14, v17
    v_bitop3_b32 v47, v47, v5, v46 bitop3:0xea
    ds_read_b64 v[102:103], v47 offset:63616
    v_bitop3_b32 v93, v17, v5, v46 bitop3:0xea
    v_and_b32 v46, 0x10000000, v21
    v_lshrrev_b32 v47, 14, v16
    v_bitop3_b32 v47, v47, v5, v46 bitop3:0xea
    ds_read_b64 v[100:101], v47 offset:63616
    v_bitop3_b32 v92, v16, v5, v46 bitop3:0xea
    s_waitcnt lgkmcnt(2)
    v_mfma_f32_4x4x4_16b_bf16 v[80:83], v[10:11], v[70:71], v[80:83]
    v_mfma_f32_4x4x4_16b_bf16 v[76:79], v[10:11], v[68:69], v[76:79]
    v_perm_b32 v15, v17, v20, s45
    v_bitop3_b32 v46, v17, 0.5, -0.5 bitop3:0xa8
    v_perm_b32 v14, v16, v20, s44
    v_bitop3_b32 v47, v16, 0.5, -0.5 bitop3:0xa8
    v_cvt_pk_bf16_f32 v80, v80, v81
    v_cvt_pk_bf16_f32 v81, v82, v83
    ds_wrxchg_rtn_b64 v[74:75], v95, v[80:81]
    v_cvt_pk_bf16_f32 v76, v76, v77
    v_cvt_pk_bf16_f32 v77, v78, v79
    ds_wrxchg_rtn_b64 v[72:73], v94, v[76:77]
    s_waitcnt lgkmcnt(2)
    v_mfma_f32_4x4x4_16b_bf16 v[80:83], v[8:9], v[102:103], 0
    v_mfma_f32_4x4x4_16b_bf16 v[76:79], v[8:9], v[100:101], 0
    v_bitop3_b32 v15, v6, v15, v46 bitop3:0xca
    v_bitop3_b32 v14, v6, v14, v47 bitop3:0xca
    v_cmp_lt_u32 s[84:85], v5, v92
    s_nop 0
    v_pk_mul_f32 v[80:81], v[80:81], v[14:15] op_sel:[0,1] op_sel_hi:[1,1]
    v_pk_mul_f32 v[82:83], v[82:83], v[14:15] op_sel:[0,1] op_sel_hi:[1,1]
    v_pk_mul_f32 v[76:77], v[76:77], v[14:15] op_sel:[0,0] op_sel_hi:[1,0]
    v_pk_mul_f32 v[78:79], v[78:79], v[14:15] op_sel:[0,0] op_sel_hi:[1,0]
    buffer_load_dwordx4 v[108:111], v3, s[16:19], s40 offen offset:0
    s_waitcnt lgkmcnt(0)
    v_cmpx_ne_u64 vcc, v[74:75], v[70:71]
    s_and_b64 s[82:83], vcc, s[80:81]
    s_cbranch_scc1 L2_c41
L2_d41:
    v_mov_b64 v[84:85], v[70:71]
    v_mov_b32 v7, v95
    v_mov_b64 v[86:87], v[74:75]
    s_mov_b64 exec, -1
    s_or_b64 s[80:81], s[80:81], vcc
    v_cmpx_ne_u64 vcc, v[72:73], v[68:69]
    s_and_b64 s[82:83], vcc, s[80:81]
    s_cbranch_scc1 L2_c42
L2_d42:
    v_mov_b64 v[84:85], v[68:69]
    v_mov_b32 v7, v94
    v_mov_b64 v[86:87], v[72:73]
    s_mov_b64 exec, -1
    s_or_b64 s[80:81], s[80:81], vcc
    ds_read_b64 v[70:71], v93
    s_and_b64 exec, s[84:85], s[80:81]
    v_mfma_f32_4x4x4_16b_bf16 v[76:79], v[12:13], v[84:85], 0
    v_mov_b32 v92, v7
    s_andn2_b64 s[80:81], s[80:81], s[84:85]
    v_mfma_f32_4x4x4_16b_bf16 v[76:79], v[10:11], v[86:87], v[76:79]
    s_mov_b64 exec, -1
    ds_read_b64 v[68:69], v92
    v_and_b32 v46, 0x80000000, v21
    v_lshrrev_b32 v47, 14, v19
    v_bitop3_b32 v47, v47, v5, v46 bitop3:0xea
    ds_read_b64 v[106:107], v47 offset:63616
    v_bitop3_b32 v95, v19, v5, v46 bitop3:0xea
    v_and_b32 v46, 0x40000000, v21
    v_lshrrev_b32 v47, 14, v18
    v_bitop3_b32 v47, v47, v5, v46 bitop3:0xea
    ds_read_b64 v[104:105], v47 offset:63616
    v_bitop3_b32 v94, v18, v5, v46 bitop3:0xea
    s_waitcnt lgkmcnt(2)
    v_mfma_f32_4x4x4_16b_bf16 v[80:83], v[10:11], v[70:71], v[80:83]
    v_mfma_f32_4x4x4_16b_bf16 v[76:79], v[10:11], v[68:69], v[76:79]
    v_perm_b32 v15, v19, v20, s47
    v_bitop3_b32 v46, v19, 0.5, -0.5 bitop3:0xa8
    v_perm_b32 v14, v18, v20, s46
    v_bitop3_b32 v47, v18, 0.5, -0.5 bitop3:0xa8
    v_cvt_pk_bf16_f32 v80, v80, v81
    v_cvt_pk_bf16_f32 v81, v82, v83
    ds_wrxchg_rtn_b64 v[74:75], v93, v[80:81]
    v_cvt_pk_bf16_f32 v76, v76, v77
    v_cvt_pk_bf16_f32 v77, v78, v79
    ds_wrxchg_rtn_b64 v[72:73], v92, v[76:77]
    s_setprio 2
    s_waitcnt lgkmcnt(2)
    v_mfma_f32_4x4x4_16b_bf16 v[80:83], v[8:9], v[106:107], 0
    v_mfma_f32_4x4x4_16b_bf16 v[76:79], v[8:9], v[104:105], 0
    v_bitop3_b32 v15, v6, v15, v46 bitop3:0xca
    v_bitop3_b32 v14, v6, v14, v47 bitop3:0xca
    s_nop 1
    v_pk_mul_f32 v[80:81], v[80:81], v[14:15] op_sel:[0,1] op_sel_hi:[1,1]
    v_pk_mul_f32 v[82:83], v[82:83], v[14:15] op_sel:[0,1] op_sel_hi:[1,1]
    v_pk_mul_f32 v[76:77], v[76:77], v[14:15] op_sel:[0,0] op_sel_hi:[1,0]
    v_pk_mul_f32 v[78:79], v[78:79], v[14:15] op_sel:[0,0] op_sel_hi:[1,0]
    v_and_b32 v47, 0x0fffffff, v40
    v_mov_b32 v21, v40
    buffer_load_dwordx4 v[16:19], v47, s[8:11], 0 offen
    buffer_load_dwordx3 v[18:20], v47, s[8:11], 0 offen offset:8
    s_waitcnt lgkmcnt(0)
    v_cmpx_ne_u64 vcc, v[74:75], v[70:71]
    s_and_b64 s[82:83], vcc, s[80:81]
    s_cbranch_scc1 L2_c43
L2_d43:
    v_mov_b64 v[84:85], v[70:71]
    v_mov_b32 v7, v93
    v_mov_b64 v[86:87], v[74:75]
    s_mov_b64 exec, -1
    s_or_b64 s[80:81], s[80:81], vcc
    v_cmpx_ne_u64 vcc, v[72:73], v[68:69]
    s_and_b64 s[82:83], vcc, s[80:81]
    s_cbranch_scc1 L2_c44
L2_d44:
    v_mov_b64 v[84:85], v[68:69]
    v_mov_b32 v7, v92
    v_mov_b64 v[86:87], v[72:73]
    s_mov_b64 exec, -1
    s_or_b64 s[80:81], s[80:81], vcc
    ds_read_b64 v[70:71], v95
    ds_read_b64 v[68:69], v94
    s_waitcnt vmcnt(10)
    v_and_b32 v46, 0x20000000, v27
    v_lshrrev_b32 v47, 14, v23
    v_bitop3_b32 v47, v47, v5, v46 bitop3:0xea
    ds_read_b64 v[102:103], v47 offset:63616
    v_bitop3_b32 v93, v23, v5, v46 bitop3:0xea
    v_and_b32 v46, 0x10000000, v27
    v_lshrrev_b32 v47, 14, v22
    v_bitop3_b32 v47, v47, v5, v46 bitop3:0xea
    ds_read_b64 v[100:101], v47 offset:63616
    v_bitop3_b32 v92, v22, v5, v46 bitop3:0xea
    s_waitcnt lgkmcnt(2)
    v_mfma_f32_4x4x4_16b_bf16 v[80:83], v[10:11], v[70:71], v[80:83]
    v_mfma_f32_4x4x4_16b_bf16 v[76:79], v[10:11], v[68:69], v[76:79]
    v_perm_b32 v15, v23, v26, s45
    v_bitop3_b32 v46, v23, 0.5, -0.5 bitop3:0xa8
    v_perm_b32 v14, v22, v26, s44
    v_bitop3_b32 v47, v22, 0.5, -0.5 bitop3:0xa8
    v_cvt_pk_bf16_f32 v80, v80, v81
    v_cvt_pk_bf16_f32 v81, v82, v83
    ds_wrxchg_rtn_b64 v[74:75], v95, v[80:81]
    v_cvt_pk_bf16_f32 v76, v76, v77
    v_cvt_pk_bf16_f32 v77, v78, v79
    ds_wrxchg_rtn_b64 v[72:73], v94, v[76:77]
    s_waitcnt lgkmcnt(2)
    v_mfma_f32_4x4x4_16b_bf16 v[80:83], v[8:9], v[102:103], 0
    v_mfma_f32_4x4x4_16b_bf16 v[76:79], v[8:9], v[100:101], 0
    v_bitop3_b32 v15, v6, v15, v46 bitop3:0xca
    v_bitop3_b32 v14, v6, v14, v47 bitop3:0xca
    v_cmp_lt_u32 s[84:85], v5, v92
    s_nop 0
    v_pk_mul_f32 v[80:81], v[80:81], v[14:15] op_sel:[0,1] op_sel_hi:[1,1]
    v_pk_mul_f32 v[82:83], v[82:83], v[14:15] op_sel:[0,1] op_sel_hi:[1,1]
    v_pk_mul_f32 v[76:77], v[76:77], v[14:15] op_sel:[0,0] op_sel_hi:[1,0]
    v_pk_mul_f32 v[78:79], v[78:79], v[14:15] op_sel:[0,0] op_sel_hi:[1,0]
    v_sub_u16 v88, v56, v48
    v_and_b32 v89, 3, v48
    v_add3_u32 v99, v88, v89, 3
    v_and_b32 v99, -4, v99
    v_max_u32 v99, 4, v99
    v_and_b32 v97, 0xfffc, v48
    v_bfm_b32 v96, v88, v89
    v_add_u32_dpp v91, v99, v99 row_shr:1 row_mask:0xf bank_mask:0xf bound_ctrl:1
    v_mad_u32_u24 v97, v97, 5, v2
    v_cmp_lt_u32 vcc, 16, v99
    v_add_u32_dpp v91, v91, v91 row_shr:2 row_mask:0xf bank_mask:0xf bound_ctrl:1
    v_sub_u32 v98, s38, v99
    v_lshrrev_b64 v[48:49], 16, v[48:49]
    v_add_u32_dpp v91, v91, v91 row_shr:4 row_mask:0xf bank_mask:0xf bound_ctrl:1
    v_lshrrev_b64 v[56:57], 16, v[56:57]
    s_mov_b32 s43, 0
    v_add_u32_dpp v91, v91, v91 row_shr:8 row_mask:0xf bank_mask:0xf bound_ctrl:1
    s_nop 1
    v_add_u32_dpp v91, v91, v91 row_bcast:15 row_mask:0xa bank_mask:0xf
    s_nop 1
    v_add_u32_dpp v91, v91, v91 row_bcast:31 row_mask:0xc bank_mask:0xf
    v_add_u32 v98, v98, v91
    v_readlane_b32 s37, v91, 63
    s_cbranch_vccnz L2_xo45
L2_xp45:
    buffer_load_dwordx4 v[112:115], v3, s[16:19], s40 offen offset:1024
    s_waitcnt lgkmcnt(0)
    v_cmpx_ne_u64 vcc, v[74:75], v[70:71]
    s_and_b64 s[82:83], vcc, s[80:81]
    s_cbranch_scc1 L2_c46
L2_d46:
    v_mov_b64 v[84:85], v[70:71]
    v_mov_b32 v7, v95
    v_mov_b64 v[86:87], v[74:75]
    s_mov_b64 exec, -1
    s_or_b64 s[80:81], s[80:81], vcc
    v_cmpx_ne_u64 vcc, v[72:73], v[68:69]
    s_and_b64 s[82:83], vcc, s[80:81]
    s_cbranch_scc1 L2_c47
L2_d47:
    v_mov_b64 v[84:85], v[68:69]
    v_mov_b32 v7, v94
    v_mov_b64 v[86:87], v[72:73]
    s_mov_b64 exec, -1
    s_or_b64 s[80:81], s[80:81], vcc
    ds_read_b64 v[70:71], v93
    s_and_b64 exec, s[84:85], s[80:81]
    v_mfma_f32_4x4x4_16b_bf16 v[76:79], v[12:13], v[84:85], 0
    v_mov_b32 v92, v7
    s_andn2_b64 s[80:81], s[80:81], s[84:85]
    v_mfma_f32_4x4x4_16b_bf16 v[76:79], v[10:11], v[86:87], v[76:79]
    s_mov_b64 exec, -1
    ds_read_b64 v[68:69], v92
    v_and_b32 v46, 0x80000000, v27
    v_lshrrev_b32 v47, 14, v25
    v_bitop3_b32 v47, v47, v5, v46 bitop3:0xea
    ds_read_b64 v[106:107], v47 offset:63616
    v_bitop3_b32 v95, v25, v5, v46 bitop3:0xea
    v_and_b32 v46, 0x40000000, v27
    v_lshrrev_b32 v47, 14, v24
    v_bitop3_b32 v47, v47, v5, v46 bitop3:0xea
    ds_read_b64 v[104:105], v47 offset:63616
    v_bitop3_b32 v94, v24, v5, v46 bitop3:0xea
    s_waitcnt lgkmcnt(2)
    v_mfma_f32_4x4x4_16b_bf16 v[80:83], v[10:11], v[70:71], v[80:83]
    v_mfma_f32_4x4x4_16b_bf16 v[76:79], v[10:11], v[68:69], v[76:79]
    v_perm_b32 v15, v25, v26, s47
    v_bitop3_b32 v46, v25, 0.5, -0.5 bitop3:0xa8
    v_perm_b32 v14, v24, v26, s46
    v_bitop3_b32 v47, v24, 0.5, -0.5 bitop3:0xa8
    v_cvt_pk_bf16_f32 v80, v80, v81
    v_cvt_pk_bf16_f32 v81, v82, v83
    ds_wrxchg_rtn_b64 v[74:75], v93, v[80:81]
    v_cvt_pk_bf16_f32 v76, v76, v77
    v_cvt_pk_bf16_f32 v77, v78, v79
    ds_wrxchg_rtn_b64 v[72:73], v92, v[76:77]
    s_setprio 1
    s_waitcnt lgkmcnt(2)
    v_mfma_f32_4x4x4_16b_bf16 v[80:83], v[8:9], v[106:107], 0
    v_mfma_f32_4x4x4_16b_bf16 v[76:79], v[8:9], v[104:105], 0
    v_bitop3_b32 v15, v6, v15, v46 bitop3:0xca
    v_bitop3_b32 v14, v6, v14, v47 bitop3:0xca
    s_nop 1
    v_pk_mul_f32 v[80:81], v[80:81], v[14:15] op_sel:[0,1] op_sel_hi:[1,1]
    v_pk_mul_f32 v[82:83], v[82:83], v[14:15] op_sel:[0,1] op_sel_hi:[1,1]
    v_pk_mul_f32 v[76:77], v[76:77], v[14:15] op_sel:[0,0] op_sel_hi:[1,0]
    v_pk_mul_f32 v[78:79], v[78:79], v[14:15] op_sel:[0,0] op_sel_hi:[1,0]
    v_and_b32 v47, 0x0fffffff, v41
    v_mov_b32 v27, v41
    buffer_load_dwordx4 v[22:25], v47, s[8:11], 0 offen
    buffer_load_dwordx3 v[24:26], v47, s[8:11], 0 offen offset:8
    s_waitcnt lgkmcnt(0)
    v_cmpx_ne_u64 vcc, v[74:75], v[70:71]
    s_and_b64 s[82:83], vcc, s[80:81]
    s_cbranch_scc1 L2_c48
L2_d48:
    v_mov_b64 v[84:85], v[70:71]
    v_mov_b32 v7, v93
    v_mov_b64 v[86:87], v[74:75]
    s_mov_b64 exec, -1
    s_or_b64 s[80:81], s[80:81], vcc
    v_cmpx_ne_u64 vcc, v[72:73], v[68:69]
    s_and_b64 s[82:83], vcc, s[80:81]
    s_cbranch_scc1 L2_c49
L2_d49:
    v_mov_b64 v[84:85], v[68:69]
    v_mov_b32 v7, v92
    v_mov_b64 v[86:87], v[72:73]
    s_mov_b64 exec, -1
    s_or_b64 s[80:81], s[80:81], vcc
    ds_read_b64 v[70:71], v95
    ds_read_b64 v[68:69], v94
    s_waitcnt vmcnt(11)
    v_and_b32 v46, 0x20000000, v33
    v_lshrrev_b32 v47, 14, v29
    v_bitop3_b32 v47, v47, v5, v46 bitop3:0xea
    ds_read_b64 v[102:103], v47 offset:63616
    v_bitop3_b32 v93, v29, v5, v46 bitop3:0xea
    v_and_b32 v46, 0x10000000, v33
    v_lshrrev_b32 v47, 14, v28
    v_bitop3_b32 v47, v47, v5, v46 bitop3:0xea
    ds_read_b64 v[100:101], v47 offset:63616
    v_bitop3_b32 v92, v28, v5, v46 bitop3:0xea
    s_waitcnt lgkmcnt(2)
    v_mfma_f32_4x4x4_16b_bf16 v[80:83], v[10:11], v[70:71], v[80:83]
    v_mfma_f32_4x4x4_16b_bf16 v[76:79], v[10:11], v[68:69], v[76:79]
    v_perm_b32 v15, v29, v32, s45
    v_bitop3_b32 v46, v29, 0.5, -0.5 bitop3:0xa8
    v_perm_b32 v14, v28, v32, s44
    v_bitop3_b32 v47, v28, 0.5, -0.5 bitop3:0xa8
    v_cvt_pk_bf16_f32 v80, v80, v81
    v_cvt_pk_bf16_f32 v81, v82, v83
    ds_wrxchg_rtn_b64 v[74:75], v95, v[80:81]
    v_cvt_pk_bf16_f32 v76, v76, v77
    v_cvt_pk_bf16_f32 v77, v78, v79
    ds_wrxchg_rtn_b64 v[72:73], v94, v[76:77]
    s_waitcnt lgkmcnt(2)
    v_mfma_f32_4x4x4_16b_bf16 v[80:83], v[8:9], v[102:103], 0
    v_mfma_f32_4x4x4_16b_bf16 v[76:79], v[8:9], v[100:101], 0
    v_bitop3_b32 v15, v6, v15, v46 bitop3:0xca
    v_bitop3_b32 v14, v6, v14, v47 bitop3:0xca
    v_cmp_lt_u32 s[84:85], v5, v92
    s_nop 0
    v_pk_mul_f32 v[80:81], v[80:81], v[14:15] op_sel:[0,1] op_sel_hi:[1,1]
    v_pk_mul_f32 v[82:83], v[82:83], v[14:15] op_sel:[0,1] op_sel_hi:[1,1]
    v_pk_mul_f32 v[76:77], v[76:77], v[14:15] op_sel:[0,0] op_sel_hi:[1,0]
    v_pk_mul_f32 v[78:79], v[78:79], v[14:15] op_sel:[0,0] op_sel_hi:[1,0]
    s_waitcnt lgkmcnt(0)
    v_cmpx_ne_u64 vcc, v[74:75], v[70:71]
    s_and_b64 s[82:83], vcc, s[80:81]
    s_cbranch_scc1 L2_c50
L2_d50:
    v_mov_b64 v[84:85], v[70:71]
    v_mov_b32 v7, v95
    v_mov_b64 v[86:87], v[74:75]
    s_mov_b64 exec, -1
    s_or_b64 s[80:81], s[80:81], vcc
    v_cmpx_ne_u64 vcc, v[72:73], v[68:69]
    s_and_b64 s[82:83], vcc, s[80:81]
    s_cbranch_scc1 L2_c51
L2_d51:
    v_mov_b64 v[84:85], v[68:69]
    v_mov_b32 v7, v94
    v_mov_b64 v[86:87], v[72:73]
    s_mov_b64 exec, -1
    s_or_b64 s[80:81], s[80:81], vcc
    ds_read_b64 v[70:71], v93
    s_and_b64 exec, s[84:85], s[80:81]
    v_mfma_f32_4x4x4_16b_bf16 v[76:79], v[12:13], v[84:85], 0
    v_mov_b32 v92, v7
    s_andn2_b64 s[80:81], s[80:81], s[84:85]
    v_mfma_f32_4x4x4_16b_bf16 v[76:79], v[10:11], v[86:87], v[76:79]
    s_mov_b64 exec, -1
    ds_read_b64 v[68:69], v92
    v_and_b32 v46, 0x80000000, v33
    v_lshrrev_b32 v47, 14, v31
    v_bitop3_b32 v47, v47, v5, v46 bitop3:0xea
    ds_read_b64 v[106:107], v47 offset:63616
    v_bitop3_b32 v95, v31, v5, v46 bitop3:0xea
    v_and_b32 v46, 0x40000000, v33
    v_lshrrev_b32 v47, 14, v30
    v_bitop3_b32 v47, v47, v5, v46 bitop3:0xea
    ds_read_b64 v[104:105], v47 offset:63616
    v_bitop3_b32 v94, v30, v5, v46 bitop3:0xea
    s_waitcnt lgkmcnt(2)
    v_mfma_f32_4x4x4_16b_bf16 v[80:83], v[10:11], v[70:71], v[80:83]
    v_mfma_f32_4x4x4_16b_bf16 v[76:79], v[10:11], v[68:69], v[76:79]
    v_perm_b32 v15, v31, v32, s47
    v_bitop3_b32 v46, v31, 0.5, -0.5 bitop3:0xa8
    v_perm_b32 v14, v30, v32, s46
    v_bitop3_b32 v47, v30, 0.5, -0.5 bitop3:0xa8
    v_cvt_pk_bf16_f32 v80, v80, v81
    v_cvt_pk_bf16_f32 v81, v82, v83
    ds_wrxchg_rtn_b64 v[74:75], v93, v[80:81]
    v_cvt_pk_bf16_f32 v76, v76, v77
    v_cvt_pk_bf16_f32 v77, v78, v79
    ds_wrxchg_rtn_b64 v[72:73], v92, v[76:77]
    s_setprio 0
    s_waitcnt lgkmcnt(2)
    v_mfma_f32_4x4x4_16b_bf16 v[80:83], v[8:9], v[106:107], 0
    v_mfma_f32_4x4x4_16b_bf16 v[76:79], v[8:9], v[104:105], 0
    v_bitop3_b32 v15, v6, v15, v46 bitop3:0xca
    v_bitop3_b32 v14, v6, v14, v47 bitop3:0xca
    s_nop 1
    v_pk_mul_f32 v[80:81], v[80:81], v[14:15] op_sel:[0,1] op_sel_hi:[1,1]
    v_pk_mul_f32 v[82:83], v[82:83], v[14:15] op_sel:[0,1] op_sel_hi:[1,1]
    v_pk_mul_f32 v[76:77], v[76:77], v[14:15] op_sel:[0,0] op_sel_hi:[1,0]
    v_pk_mul_f32 v[78:79], v[78:79], v[14:15] op_sel:[0,0] op_sel_hi:[1,0]
    s_add_u32 s40, s40, 0xfff29280
    v_and_b32 v47, 0x0fffffff, v42
    v_mov_b32 v33, v42
    buffer_load_dwordx4 v[28:31], v47, s[8:11], 0 offen
    buffer_load_dwordx3 v[30:32], v47, s[8:11], 0 offen offset:8
    s_waitcnt lgkmcnt(0)
    v_cmpx_ne_u64 vcc, v[74:75], v[70:71]
    s_and_b64 s[82:83], vcc, s[80:81]
    s_cbranch_scc1 L2_c52
L2_d52:
    v_mov_b64 v[84:85], v[70:71]
    v_mov_b32 v7, v93
    v_mov_b64 v[86:87], v[74:75]
    s_mov_b64 exec, -1
    s_or_b64 s[80:81], s[80:81], vcc
    v_cmpx_ne_u64 vcc, v[72:73], v[68:69]
    s_and_b64 s[82:83], vcc, s[80:81]
    s_cbranch_scc1 L2_c53
L2_d53:
    v_mov_b64 v[84:85], v[68:69]
    v_mov_b32 v7, v92
    v_mov_b64 v[86:87], v[72:73]
    s_mov_b64 exec, -1
    s_or_b64 s[80:81], s[80:81], vcc
    ds_read_b64 v[70:71], v95
    ds_read_b64 v[68:69], v94
    s_waitcnt vmcnt(8)
    v_and_b32 v46, 0x20000000, v39
    v_lshrrev_b32 v47, 14, v35
    v_bitop3_b32 v47, v47, v5, v46 bitop3:0xea
    ds_read_b64 v[102:103], v47 offset:63616
    v_bitop3_b32 v93, v35, v5, v46 bitop3:0xea
    v_and_b32 v46, 0x10000000, v39
    v_lshrrev_b32 v47, 14, v34
    v_bitop3_b32 v47, v47, v5, v46 bitop3:0xea
    ds_read_b64 v[100:101], v47 offset:63616
    v_bitop3_b32 v92, v34, v5, v46 bitop3:0xea
    v_and_b32 v46, 0x80000000, v39
    v_lshrrev_b32 v47, 14, v37
    v_bitop3_b32 v47, v47, v5, v46 bitop3:0xea
    ds_read_b64 v[106:107], v47 offset:63616
    v_and_b32 v46, 0x40000000, v39
    v_lshrrev_b32 v47, 14, v36
    v_bitop3_b32 v47, v47, v5, v46 bitop3:0xea
    ds_read_b64 v[104:105], v47 offset:63616
    s_waitcnt lgkmcnt(4)
    v_mfma_f32_4x4x4_16b_bf16 v[80:83], v[10:11], v[70:71], v[80:83]
    v_mfma_f32_4x4x4_16b_bf16 v[76:79], v[10:11], v[68:69], v[76:79]
    v_perm_b32 v15, v35, v38, s45
    v_bitop3_b32 v46, v35, 0.5, -0.5 bitop3:0xa8
    v_perm_b32 v14, v34, v38, s44
    v_bitop3_b32 v47, v34, 0.5, -0.5 bitop3:0xa8
    v_cvt_pk_bf16_f32 v80, v80, v81
    v_cvt_pk_bf16_f32 v81, v82, v83
    ds_wrxchg_rtn_b64 v[74:75], v95, v[80:81]
    v_cvt_pk_bf16_f32 v76, v76, v77
    v_cvt_pk_bf16_f32 v77, v78, v79
    ds_wrxchg_rtn_b64 v[72:73], v94, v[76:77]
    s_waitcnt lgkmcnt(2)
    s_barrier
    s_setprio 3
    ds_write_b128 v3, v[124:127] offset:4096
    s_add_u32 s3, s40, 4096
    buffer_load_dwordx4 v[124:127], v3, s[16:19], s3 offen
    ds_write_b128 v3, v[116:119] offset:2048
    buffer_load_dwordx4 v[116:119], v3, s[16:19], s40 offen offset:2048
    ds_write_b128 v3, v[120:123] offset:3072
    buffer_load_dwordx4 v[120:123], v3, s[16:19], s40 offen offset:3072
    v_mfma_f32_4x4x4_16b_bf16 v[80:83], v[8:9], v[102:103], 0
    v_mfma_f32_4x4x4_16b_bf16 v[76:79], v[8:9], v[100:101], 0
    v_bitop3_b32 v15, v6, v15, v46 bitop3:0xca
    v_bitop3_b32 v14, v6, v14, v47 bitop3:0xca
    v_cmp_lt_u32 s[84:85], v5, v92
    s_nop 0
    v_pk_mul_f32 v[80:81], v[80:81], v[14:15] op_sel:[0,1] op_sel_hi:[1,1]
    v_pk_mul_f32 v[82:83], v[82:83], v[14:15] op_sel:[0,1] op_sel_hi:[1,1]
    v_pk_mul_f32 v[76:77], v[76:77], v[14:15] op_sel:[0,0] op_sel_hi:[1,0]
    v_pk_mul_f32 v[78:79], v[78:79], v[14:15] op_sel:[0,0] op_sel_hi:[1,0]
    v_mov_b32 v44, v43
    s_cmp_gt_u32 s37, 1024
    s_cbranch_scc1 L2_xs54
    s_cmp_lg_u32 s43, 0
    s_cbranch_scc1 L2_xa54
L2_xb54:
    v_lshlrev_b32 v89, 16, v96
    v_add_u32 v90, 60, v97
    v_bitop3_b32 v90, v89, v45, v90 bitop3:0x6a
    ds_write_b32 v98, v90 offset:12
    v_lshlrev_b32 v89, 20, v96
    v_add_u32 v90, 40, v97
    v_bitop3_b32 v90, v89, v45, v90 bitop3:0x6a
    ds_write_b32 v98, v90 offset:8
    v_lshlrev_b32 v89, 24, v96
    v_add_u32 v90, 20, v97
    v_bitop3_b32 v90, v89, v45, v90 bitop3:0x6a
    ds_write_b32 v98, v90 offset:4
    v_lshlrev_b32 v89, 28, v96
    v_bitop3_b32 v90, v89, v45, v97 bitop3:0x6a
    ds_write_b32 v98, v90 offset:0
    v_mov_b32_dpp v91, v64 quad_perm:[0,0,0,0] row_mask:0xf bank_mask:0xf
    v_and_b32 v89, 3, v91
    v_and_b32 v97, 0xfffc, v91
    v_sub_u16_dpp v88, v64, v91 quad_perm:[2,2,2,2] row_mask:0xf bank_mask:0xf
    v_mad_u32_u24 v97, v97, 5, v4
    v_add_u32 v99, v88, v89
    v_bfm_b32 v96, v88, v89
    v_cmp_lt_u32 s[58:59], 16, v99
    v_lshlrev_b32 v89, v1, v96
    v_and_b32 v89, v45, v89
    v_cmp_ne_u32 vcc, 0, v89
    v_xor_b32 v90, v97, v89
    s_add_u32 s3, s37, s38
    v_mbcnt_lo_u32_b32 v98, vcc_lo, 0
    v_mbcnt_hi_u32_b32 v98, vcc_hi, v98
    s_bcnt1_i32_b64 s41, vcc
    v_lshl_add_u32 v98, v98, 2, s3
    s_mov_b64 exec, vcc
    ds_write_b32 v98, v90
    s_mov_b64 exec, -1
    s_lshl2_add_u32 s37, s41, s37
    s_cmp_lg_u64 s[58:59], 0
    s_cbranch_scc1 L2_xe54
L2_xr54:
    v_add_u32 v98, s37, v0
    v_mov_b32 v90, -1
    ds_write_b32 v98, v90
    ds_read2st64_b32 v[40:41], v0 offset0:0 offset1:1
    ds_read2st64_b32 v[42:43], v0 offset0:2 offset1:3
    s_sub_u32 s3, s37, 768
    s_cmp_gt_u32 s3, 256
    s_cbranch_scc1 L2_xf54
L2_xg54:
    s_setprio 2
    s_waitcnt vmcnt(10)
    ds_write_b128 v3, v[108:111] offset:0
    s_waitcnt lgkmcnt(12)
    v_cmpx_ne_u64 vcc, v[74:75], v[70:71]
    s_and_b64 s[82:83], vcc, s[80:81]
    s_cbranch_scc1 L2_c55
L2_d55:
    v_mov_b64 v[84:85], v[70:71]
    v_mov_b32 v7, v95
    v_mov_b64 v[86:87], v[74:75]
    s_mov_b64 exec, -1
    s_or_b64 s[80:81], s[80:81], vcc
    v_cmpx_ne_u64 vcc, v[72:73], v[68:69]
    s_and_b64 s[82:83], vcc, s[80:81]
    s_cbranch_scc1 L2_c56
L2_d56:
    v_mov_b64 v[84:85], v[68:69]
    v_mov_b32 v7, v94
    v_mov_b64 v[86:87], v[72:73]
    s_mov_b64 exec, -1
    s_or_b64 s[80:81], s[80:81], vcc
    ds_read_b64 v[70:71], v93
    s_and_b64 exec, s[84:85], s[80:81]
    v_mfma_f32_4x4x4_16b_bf16 v[76:79], v[12:13], v[84:85], 0
    v_mov_b32 v92, v7
    s_andn2_b64 s[80:81], s[80:81], s[84:85]
    v_mfma_f32_4x4x4_16b_bf16 v[76:79], v[10:11], v[86:87], v[76:79]
    s_mov_b64 exec, -1
    ds_read_b64 v[68:69], v92
    s_setprio 1
    s_waitcnt vmcnt(7)
    ds_write_b128 v3, v[112:115] offset:1024
    s_waitcnt lgkmcnt(1)
    v_mfma_f32_4x4x4_16b_bf16 v[80:83], v[10:11], v[70:71], v[80:83]
    v_mfma_f32_4x4x4_16b_bf16 v[76:79], v[10:11], v[68:69], v[76:79]
    v_and_b32 v46, 0x40000000, v39
    v_bitop3_b32 v94, v36, v5, v46 bitop3:0xea
    v_and_b32 v46, 0x80000000, v39
    v_bitop3_b32 v95, v37, v5, v46 bitop3:0xea
    v_perm_b32 v15, v37, v38, s47
    v_bitop3_b32 v46, v37, 0.5, -0.5 bitop3:0xa8
    v_perm_b32 v14, v36, v38, s46
    v_bitop3_b32 v47, v36, 0.5, -0.5 bitop3:0xa8
    v_cvt_pk_bf16_f32 v80, v80, v81
    v_cvt_pk_bf16_f32 v81, v82, v83
    ds_wrxchg_rtn_b64 v[74:75], v93, v[80:81]
    v_cvt_pk_bf16_f32 v76, v76, v77
    v_cvt_pk_bf16_f32 v77, v78, v79
    ds_wrxchg_rtn_b64 v[72:73], v92, v[76:77]
    s_setprio 0
    v_mfma_f32_4x4x4_16b_bf16 v[80:83], v[8:9], v[106:107], 0
    v_mfma_f32_4x4x4_16b_bf16 v[76:79], v[8:9], v[104:105], 0
    v_bitop3_b32 v15, v6, v15, v46 bitop3:0xca
    v_bitop3_b32 v14, v6, v14, v47 bitop3:0xca
    s_nop 1
    v_pk_mul_f32 v[80:81], v[80:81], v[14:15] op_sel:[0,1] op_sel_hi:[1,1]
    v_pk_mul_f32 v[82:83], v[82:83], v[14:15] op_sel:[0,1] op_sel_hi:[1,1]
    v_pk_mul_f32 v[76:77], v[76:77], v[14:15] op_sel:[0,0] op_sel_hi:[1,0]
    v_pk_mul_f32 v[78:79], v[78:79], v[14:15] op_sel:[0,0] op_sel_hi:[1,0]
    s_add_u32 s42, s42, 1
    s_waitcnt lgkmcnt(2)
    s_barrier
    s_bitcmp1_b32 s36, s42
    s_cbranch_scc1 L2_slow
L2_ret3:
    s_setprio 3
    v_and_b32 v47, 0x0fffffff, v44
    v_mov_b32 v39, v44
    buffer_load_dwordx4 v[34:37], v47, s[8:11], 0 offen
    buffer_load_dwordx3 v[36:38], v47, s[8:11], 0 offen offset:8
    s_waitcnt lgkmcnt(0)
    v_cmpx_ne_u64 vcc, v[74:75], v[70:71]
    s_and_b64 s[82:83], vcc, s[80:81]
    s_cbranch_scc1 L2_c57
L2_d57:
    v_mov_b64 v[84:85], v[70:71]
    v_mov_b32 v7, v93
    v_mov_b64 v[86:87], v[74:75]
    s_mov_b64 exec, -1
    s_or_b64 s[80:81], s[80:81], vcc
    v_cmpx_ne_u64 vcc, v[72:73], v[68:69]
    s_and_b64 s[82:83], vcc, s[80:81]
    s_cbranch_scc1 L2_c58
L2_d58:
    v_mov_b64 v[84:85], v[68:69]
    v_mov_b32 v7, v92
    v_mov_b64 v[86:87], v[72:73]
    s_mov_b64 exec, -1
    s_or_b64 s[80:81], s[80:81], vcc
    ds_read_b64 v[70:71], v95
    ds_read_b64 v[68:69], v94
    v_and_b32 v46, 0x20000000, v21
    v_lshrrev_b32 v47, 14, v17
    v_bitop3_b32 v47, v47, v5, v46 bitop3:0xea
    ds_read_b64 v[102:103], v47 offset:63616
    v_bitop3_b32 v93, v17, v5, v46 bitop3:0xea
    v_and_b32 v46, 0x10000000, v21
    v_lshrrev_b32 v47, 14, v16
    v_bitop3_b32 v47, v47, v5, v46 bitop3:0xea
    ds_read_b64 v[100:101], v47 offset:63616
    v_bitop3_b32 v92, v16, v5, v46 bitop3:0xea
    s_waitcnt lgkmcnt(2)
    v_mfma_f32_4x4x4_16b_bf16 v[80:83], v[10:11], v[70:71], v[80:83]
    v_mfma_f32_4x4x4_16b_bf16 v[76:79], v[10:11], v[68:69], v[76:79]
    v_perm_b32 v15, v17, v20, s45
    v_bitop3_b32 v46, v17, 0.5, -0.5 bitop3:0xa8
    v_perm_b32 v14, v16, v20, s44
    v_bitop3_b32 v47, v16, 0.5, -0.5 bitop3:0xa8
    v_cvt_pk_bf16_f32 v80, v80, v81
    v_cvt_pk_bf16_f32 v81, v82, v83
    ds_wrxchg_rtn_b64 v[74:75], v95, v[80:81]
    v_cvt_pk_bf16_f32 v76, v76, v77
    v_cvt_pk_bf16_f32 v77, v78, v79
    ds_wrxchg_rtn_b64 v[72:73], v94, v[76:77]
    s_waitcnt lgkmcnt(2)
    v_mfma_f32_4x4x4_16b_bf16 v[80:83], v[8:9], v[102:103], 0
    v_mfma_f32_4x4x4_16b_bf16 v[76:79], v[8:9], v[100:101], 0
    v_bitop3_b32 v15, v6, v15, v46 bitop3:0xca
    v_bitop3_b32 v14, v6, v14, v47 bitop3:0xca
    v_cmp_lt_u32 s[84:85], v5, v92
    s_nop 0
    v_pk_mul_f32 v[80:81], v[80:81], v[14:15] op_sel:[0,1] op_sel_hi:[1,1]
    v_pk_mul_f32 v[82:83], v[82:83], v[14:15] op_sel:[0,1] op_sel_hi:[1,1]
    v_pk_mul_f32 v[76:77], v[76:77], v[14:15] op_sel:[0,0] op_sel_hi:[1,0]
    v_pk_mul_f32 v[78:79], v[78:79], v[14:15] op_sel:[0,0] op_sel_hi:[1,0]
    buffer_load_dwordx4 v[108:111], v3, s[16:19], s40 offen offset:0
    s_waitcnt lgkmcnt(0)
    v_cmpx_ne_u64 vcc, v[74:75], v[70:71]
    s_and_b64 s[82:83], vcc, s[80:81]
    s_cbranch_scc1 L2_c59
L2_d59:
    v_mov_b64 v[84:85], v[70:71]
    v_mov_b32 v7, v95
    v_mov_b64 v[86:87], v[74:75]
    s_mov_b64 exec, -1
    s_or_b64 s[80:81], s[80:81], vcc
    v_cmpx_ne_u64 vcc, v[72:73], v[68:69]
    s_and_b64 s[82:83], vcc, s[80:81]
    s_cbranch_scc1 L2_c60
L2_d60:
    v_mov_b64 v[84:85], v[68:69]
    v_mov_b32 v7, v94
    v_mov_b64 v[86:87], v[72:73]
    s_mov_b64 exec, -1
    s_or_b64 s[80:81], s[80:81], vcc
    ds_read_b64 v[70:71], v93
    s_and_b64 exec, s[84:85], s[80:81]
    v_mfma_f32_4x4x4_16b_bf16 v[76:79], v[12:13], v[84:85], 0
    v_mov_b32 v92, v7
    s_andn2_b64 s[80:81], s[80:81], s[84:85]
    v_mfma_f32_4x4x4_16b_bf16 v[76:79], v[10:11], v[86:87], v[76:79]
    s_mov_b64 exec, -1
    ds_read_b64 v[68:69], v92
    v_and_b32 v46, 0x80000000, v21
    v_lshrrev_b32 v47, 14, v19
    v_bitop3_b32 v47, v47, v5, v46 bitop3:0xea
    ds_read_b64 v[106:107], v47 offset:63616
    v_bitop3_b32 v95, v19, v5, v46 bitop3:0xea
    v_and_b32 v46, 0x40000000, v21
    v_lshrrev_b32 v47, 14, v18
    v_bitop3_b32 v47, v47, v5, v46 bitop3:0xea
    ds_read_b64 v[104:105], v47 offset:63616
    v_bitop3_b32 v94, v18, v5, v46 bitop3:0xea
    s_waitcnt lgkmcnt(2)
    v_mfma_f32_4x4x4_16b_bf16 v[80:83], v[10:11], v[70:71], v[80:83]
    v_mfma_f32_4x4x4_16b_bf16 v[76:79], v[10:11], v[68:69], v[76:79]
    v_perm_b32 v15, v19, v20, s47
    v_bitop3_b32 v46, v19, 0.5, -0.5 bitop3:0xa8
    v_perm_b32 v14, v18, v20, s46
    v_bitop3_b32 v47, v18, 0.5, -0.5 bitop3:0xa8
    v_cvt_pk_bf16_f32 v80, v80, v81
    v_cvt_pk_bf16_f32 v81, v82, v83
    ds_wrxchg_rtn_b64 v[74:75], v93, v[80:81]
    v_cvt_pk_bf16_f32 v76, v76, v77
    v_cvt_pk_bf16_f32 v77, v78, v79
    ds_wrxchg_rtn_b64 v[72:73], v92, v[76:77]
    s_setprio 2
    s_waitcnt lgkmcnt(2)
    v_mfma_f32_4x4x4_16b_bf16 v[80:83], v[8:9], v[106:107], 0
    v_mfma_f32_4x4x4_16b_bf16 v[76:79], v[8:9], v[104:105], 0
    v_bitop3_b32 v15, v6, v15, v46 bitop3:0xca
    v_bitop3_b32 v14, v6, v14, v47 bitop3:0xca
    s_nop 1
    v_pk_mul_f32 v[80:81], v[80:81], v[14:15] op_sel:[0,1] op_sel_hi:[1,1]
    v_pk_mul_f32 v[82:83], v[82:83], v[14:15] op_sel:[0,1] op_sel_hi:[1,1]
    v_pk_mul_f32 v[76:77], v[76:77], v[14:15] op_sel:[0,0] op_sel_hi:[1,0]
    v_pk_mul_f32 v[78:79], v[78:79], v[14:15] op_sel:[0,0] op_sel_hi:[1,0]
    v_and_b32 v47, 0x0fffffff, v40
    v_mov_b32 v21, v40
    buffer_load_dwordx4 v[16:19], v47, s[8:11], 0 offen
    buffer_load_dwordx3 v[18:20], v47, s[8:11], 0 offen offset:8
    s_waitcnt lgkmcnt(0)
    v_cmpx_ne_u64 vcc, v[74:75], v[70:71]
    s_and_b64 s[82:83], vcc, s[80:81]
    s_cbranch_scc1 L2_c61
L2_d61:
    v_mov_b64 v[84:85], v[70:71]
    v_mov_b32 v7, v93
    v_mov_b64 v[86:87], v[74:75]
    s_mov_b64 exec, -1
    s_or_b64 s[80:81], s[80:81], vcc
    v_cmpx_ne_u64 vcc, v[72:73], v[68:69]
    s_and_b64 s[82:83], vcc, s[80:81]
    s_cbranch_scc1 L2_c62
L2_d62:
    v_mov_b64 v[84:85], v[68:69]
    v_mov_b32 v7, v92
    v_mov_b64 v[86:87], v[72:73]
    s_mov_b64 exec, -1
    s_or_b64 s[80:81], s[80:81], vcc
    ds_read_b64 v[70:71], v95
    ds_read_b64 v[68:69], v94
    s_waitcnt vmcnt(10)
    v_and_b32 v46, 0x20000000, v27
    v_lshrrev_b32 v47, 14, v23
    v_bitop3_b32 v47, v47, v5, v46 bitop3:0xea
    ds_read_b64 v[102:103], v47 offset:63616
    v_bitop3_b32 v93, v23, v5, v46 bitop3:0xea
    v_and_b32 v46, 0x10000000, v27
    v_lshrrev_b32 v47, 14, v22
    v_bitop3_b32 v47, v47, v5, v46 bitop3:0xea
    ds_read_b64 v[100:101], v47 offset:63616
    v_bitop3_b32 v92, v22, v5, v46 bitop3:0xea
    s_waitcnt lgkmcnt(2)
    v_mfma_f32_4x4x4_16b_bf16 v[80:83], v[10:11], v[70:71], v[80:83]
    v_mfma_f32_4x4x4_16b_bf16 v[76:79], v[10:11], v[68:69], v[76:79]
    v_perm_b32 v15, v23, v26, s45
    v_bitop3_b32 v46, v23, 0.5, -0.5 bitop3:0xa8
    v_perm_b32 v14, v22, v26, s44
    v_bitop3_b32 v47, v22, 0.5, -0.5 bitop3:0xa8
    v_cvt_pk_bf16_f32 v80, v80, v81
    v_cvt_pk_bf16_f32 v81, v82, v83
    ds_wrxchg_rtn_b64 v[74:75], v95, v[80:81]
    v_cvt_pk_bf16_f32 v76, v76, v77
    v_cvt_pk_bf16_f32 v77, v78, v79
    ds_wrxchg_rtn_b64 v[72:73], v94, v[76:77]
    s_waitcnt lgkmcnt(2)
    v_mfma_f32_4x4x4_16b_bf16 v[80:83], v[8:9], v[102:103], 0
    v_mfma_f32_4x4x4_16b_bf16 v[76:79], v[8:9], v[100:101], 0
    v_bitop3_b32 v15, v6, v15, v46 bitop3:0xca
    v_bitop3_b32 v14, v6, v14, v47 bitop3:0xca
    v_cmp_lt_u32 s[84:85], v5, v92
    s_nop 0
    v_pk_mul_f32 v[80:81], v[80:81], v[14:15] op_sel:[0,1] op_sel_hi:[1,1]
    v_pk_mul_f32 v[82:83], v[82:83], v[14:15] op_sel:[0,1] op_sel_hi:[1,1]
    v_pk_mul_f32 v[76:77], v[76:77], v[14:15] op_sel:[0,0] op_sel_hi:[1,0]
    v_pk_mul_f32 v[78:79], v[78:79], v[14:15] op_sel:[0,0] op_sel_hi:[1,0]
    v_sub_u16 v88, v58, v50
    v_and_b32 v89, 3, v50
    v_add3_u32 v99, v88, v89, 3
    v_and_b32 v99, -4, v99
    v_max_u32 v99, 4, v99
    v_and_b32 v97, 0xfffc, v50
    v_bfm_b32 v96, v88, v89
    v_add_u32_dpp v91, v99, v99 row_shr:1 row_mask:0xf bank_mask:0xf bound_ctrl:1
    v_mad_u32_u24 v97, v97, 5, v2
    v_cmp_lt_u32 vcc, 16, v99
    v_add_u32_dpp v91, v91, v91 row_shr:2 row_mask:0xf bank_mask:0xf bound_ctrl:1
    v_sub_u32 v98, s38, v99
    v_lshrrev_b64 v[50:51], 16, v[50:51]
    v_add_u32_dpp v91, v91, v91 row_shr:4 row_mask:0xf bank_mask:0xf bound_ctrl:1
    v_lshrrev_b64 v[58:59], 16, v[58:59]
    s_mov_b32 s43, 0
    v_add_u32_dpp v91, v91, v91 row_shr:8 row_mask:0xf bank_mask:0xf bound_ctrl:1
    s_nop 1
    v_add_u32_dpp v91, v91, v91 row_bcast:15 row_mask:0xa bank_mask:0xf
    s_nop 1
    v_add_u32_dpp v91, v91, v91 row_bcast:31 row_mask:0xc bank_mask:0xf
    v_add_u32 v98, v98, v91
    v_readlane_b32 s37, v91, 63
    s_cbranch_vccnz L2_xo63
L2_xp63:
    buffer_load_dwordx4 v[112:115], v3, s[16:19], s40 offen offset:1024
    s_waitcnt lgkmcnt(0)
    v_cmpx_ne_u64 vcc, v[74:75], v[70:71]
    s_and_b64 s[82:83], vcc, s[80:81]
    s_cbranch_scc1 L2_c64
L2_d64:
    v_mov_b64 v[84:85], v[70:71]
    v_mov_b32 v7, v95
    v_mov_b64 v[86:87], v[74:75]
    s_mov_b64 exec, -1
    s_or_b64 s[80:81], s[80:81], vcc
    v_cmpx_ne_u64 vcc, v[72:73], v[68:69]
    s_and_b64 s[82:83], vcc, s[80:81]
    s_cbranch_scc1 L2_c65
L2_d65:
    v_mov_b64 v[84:85], v[68:69]
    v_mov_b32 v7, v94
    v_mov_b64 v[86:87], v[72:73]
    s_mov_b64 exec, -1
    s_or_b64 s[80:81], s[80:81], vcc
    ds_read_b64 v[70:71], v93
    s_and_b64 exec, s[84:85], s[80:81]
    v_mfma_f32_4x4x4_16b_bf16 v[76:79], v[12:13], v[84:85], 0
    v_mov_b32 v92, v7
    s_andn2_b64 s[80:81], s[80:81], s[84:85]
    v_mfma_f32_4x4x4_16b_bf16 v[76:79], v[10:11], v[86:87], v[76:79]
    s_mov_b64 exec, -1
    ds_read_b64 v[68:69], v92
    v_and_b32 v46, 0x80000000, v27
    v_lshrrev_b32 v47, 14, v25
    v_bitop3_b32 v47, v47, v5, v46 bitop3:0xea
    ds_read_b64 v[106:107], v47 offset:63616
    v_bitop3_b32 v95, v25, v5, v46 bitop3:0xea
    v_and_b32 v46, 0x40000000, v27
    v_lshrrev_b32 v47, 14, v24
    v_bitop3_b32 v47, v47, v5, v46 bitop3:0xea
    ds_read_b64 v[104:105], v47 offset:63616
    v_bitop3_b32 v94, v24, v5, v46 bitop3:0xea
    s_waitcnt lgkmcnt(2)
    v_mfma_f32_4x4x4_16b_bf16 v[80:83], v[10:11], v[70:71], v[80:83]
    v_mfma_f32_4x4x4_16b_bf16 v[76:79], v[10:11], v[68:69], v[76:79]
    v_perm_b32 v15, v25, v26, s47
    v_bitop3_b32 v46, v25, 0.5, -0.5 bitop3:0xa8
    v_perm_b32 v14, v24, v26, s46
    v_bitop3_b32 v47, v24, 0.5, -0.5 bitop3:0xa8
    v_cvt_pk_bf16_f32 v80, v80, v81
    v_cvt_pk_bf16_f32 v81, v82, v83
    ds_wrxchg_rtn_b64 v[74:75], v93, v[80:81]
    v_cvt_pk_bf16_f32 v76, v76, v77
    v_cvt_pk_bf16_f32 v77, v78, v79
    ds_wrxchg_rtn_b64 v[72:73], v92, v[76:77]
    s_setprio 1
    s_waitcnt lgkmcnt(2)
    v_mfma_f32_4x4x4_16b_bf16 v[80:83], v[8:9], v[106:107], 0
    v_mfma_f32_4x4x4_16b_bf16 v[76:79], v[8:9], v[104:105], 0
    v_bitop3_b32 v15, v6, v15, v46 bitop3:0xca
    v_bitop3_b32 v14, v6, v14, v47 bitop3:0xca
    s_nop 1
    v_pk_mul_f32 v[80:81], v[80:81], v[14:15] op_sel:[0,1] op_sel_hi:[1,1]
    v_pk_mul_f32 v[82:83], v[82:83], v[14:15] op_sel:[0,1] op_sel_hi:[1,1]
    v_pk_mul_f32 v[76:77], v[76:77], v[14:15] op_sel:[0,0] op_sel_hi:[1,0]
    v_pk_mul_f32 v[78:79], v[78:79], v[14:15] op_sel:[0,0] op_sel_hi:[1,0]
    v_and_b32 v47, 0x0fffffff, v41
    v_mov_b32 v27, v41
    buffer_load_dwordx4 v[22:25], v47, s[8:11], 0 offen
    buffer_load_dwordx3 v[24:26], v47, s[8:11], 0 offen offset:8
    s_waitcnt lgkmcnt(0)
    v_cmpx_ne_u64 vcc, v[74:75], v[70:71]
    s_and_b64 s[82:83], vcc, s[80:81]
    s_cbranch_scc1 L2_c66
L2_d66:
    v_mov_b64 v[84:85], v[70:71]
    v_mov_b32 v7, v93
    v_mov_b64 v[86:87], v[74:75]
    s_mov_b64 exec, -1
    s_or_b64 s[80:81], s[80:81], vcc
    v_cmpx_ne_u64 vcc, v[72:73], v[68:69]
    s_and_b64 s[82:83], vcc, s[80:81]
    s_cbranch_scc1 L2_c67
L2_d67:
    v_mov_b64 v[84:85], v[68:69]
    v_mov_b32 v7, v92
    v_mov_b64 v[86:87], v[72:73]
    s_mov_b64 exec, -1
    s_or_b64 s[80:81], s[80:81], vcc
    ds_read_b64 v[70:71], v95
    ds_read_b64 v[68:69], v94
    s_waitcnt vmcnt(11)
    v_and_b32 v46, 0x20000000, v33
    v_lshrrev_b32 v47, 14, v29
    v_bitop3_b32 v47, v47, v5, v46 bitop3:0xea
    ds_read_b64 v[102:103], v47 offset:63616
    v_bitop3_b32 v93, v29, v5, v46 bitop3:0xea
    v_and_b32 v46, 0x10000000, v33
    v_lshrrev_b32 v47, 14, v28
    v_bitop3_b32 v47, v47, v5, v46 bitop3:0xea
    ds_read_b64 v[100:101], v47 offset:63616
    v_bitop3_b32 v92, v28, v5, v46 bitop3:0xea
    s_waitcnt lgkmcnt(2)
    v_mfma_f32_4x4x4_16b_bf16 v[80:83], v[10:11], v[70:71], v[80:83]
    v_mfma_f32_4x4x4_16b_bf16 v[76:79], v[10:11], v[68:69], v[76:79]
    v_perm_b32 v15, v29, v32, s45
    v_bitop3_b32 v46, v29, 0.5, -0.5 bitop3:0xa8
    v_perm_b32 v14, v28, v32, s44
    v_bitop3_b32 v47, v28, 0.5, -0.5 bitop3:0xa8
    v_cvt_pk_bf16_f32 v80, v80, v81
    v_cvt_pk_bf16_f32 v81, v82, v83
    ds_wrxchg_rtn_b64 v[74:75], v95, v[80:81]
    v_cvt_pk_bf16_f32 v76, v76, v77
    v_cvt_pk_bf16_f32 v77, v78, v79
    ds_wrxchg_rtn_b64 v[72:73], v94, v[76:77]
    s_waitcnt lgkmcnt(2)
    v_mfma_f32_4x4x4_16b_bf16 v[80:83], v[8:9], v[102:103], 0
    v_mfma_f32_4x4x4_16b_bf16 v[76:79], v[8:9], v[100:101], 0
    v_bitop3_b32 v15, v6, v15, v46 bitop3:0xca
    v_bitop3_b32 v14, v6, v14, v47 bitop3:0xca
    v_cmp_lt_u32 s[84:85], v5, v92
    s_nop 0
    v_pk_mul_f32 v[80:81], v[80:81], v[14:15] op_sel:[0,1] op_sel_hi:[1,1]
    v_pk_mul_f32 v[82:83], v[82:83], v[14:15] op_sel:[0,1] op_sel_hi:[1,1]
    v_pk_mul_f32 v[76:77], v[76:77], v[14:15] op_sel:[0,0] op_sel_hi:[1,0]
    v_pk_mul_f32 v[78:79], v[78:79], v[14:15] op_sel:[0,0] op_sel_hi:[1,0]
    s_waitcnt lgkmcnt(0)
    v_cmpx_ne_u64 vcc, v[74:75], v[70:71]
    s_and_b64 s[82:83], vcc, s[80:81]
    s_cbranch_scc1 L2_c68
L2_d68:
    v_mov_b64 v[84:85], v[70:71]
    v_mov_b32 v7, v95
    v_mov_b64 v[86:87], v[74:75]
    s_mov_b64 exec, -1
    s_or_b64 s[80:81], s[80:81], vcc
    v_cmpx_ne_u64 vcc, v[72:73], v[68:69]
    s_and_b64 s[82:83], vcc, s[80:81]
    s_cbranch_scc1 L2_c69
L2_d69:
    v_mov_b64 v[84:85], v[68:69]
    v_mov_b32 v7, v94
    v_mov_b64 v[86:87], v[72:73]
    s_mov_b64 exec, -1
    s_or_b64 s[80:81], s[80:81], vcc
    ds_read_b64 v[70:71], v93
    s_and_b64 exec, s[84:85], s[80:81]
    v_mfma_f32_4x4x4_16b_bf16 v[76:79], v[12:13], v[84:85], 0
    v_mov_b32 v92, v7
    s_andn2_b64 s[80:81], s[80:81], s[84:85]
    v_mfma_f32_4x4x4_16b_bf16 v[76:79], v[10:11], v[86:87], v[76:79]
    s_mov_b64 exec, -1
    ds_read_b64 v[68:69], v92
    v_and_b32 v46, 0x80000000, v33
    v_lshrrev_b32 v47, 14, v31
    v_bitop3_b32 v47, v47, v5, v46 bitop3:0xea
    ds_read_b64 v[106:107], v47 offset:63616
    v_bitop3_b32 v95, v31, v5, v46 bitop3:0xea
    v_and_b32 v46, 0x40000000, v33
    v_lshrrev_b32 v47, 14, v30
    v_bitop3_b32 v47, v47, v5, v46 bitop3:0xea
    ds_read_b64 v[104:105], v47 offset:63616
    v_bitop3_b32 v94, v30, v5, v46 bitop3:0xea
    s_waitcnt lgkmcnt(2)
    v_mfma_f32_4x4x4_16b_bf16 v[80:83], v[10:11], v[70:71], v[80:83]
    v_mfma_f32_4x4x4_16b_bf16 v[76:79], v[10:11], v[68:69], v[76:79]
    v_perm_b32 v15, v31, v32, s47
    v_bitop3_b32 v46, v31, 0.5, -0.5 bitop3:0xa8
    v_perm_b32 v14, v30, v32, s46
    v_bitop3_b32 v47, v30, 0.5, -0.5 bitop3:0xa8
    v_cvt_pk_bf16_f32 v80, v80, v81
    v_cvt_pk_bf16_f32 v81, v82, v83
    ds_wrxchg_rtn_b64 v[74:75], v93, v[80:81]
    v_cvt_pk_bf16_f32 v76, v76, v77
    v_cvt_pk_bf16_f32 v77, v78, v79
    ds_wrxchg_rtn_b64 v[72:73], v92, v[76:77]
    s_setprio 0
    s_waitcnt lgkmcnt(2)
    v_mfma_f32_4x4x4_16b_bf16 v[80:83], v[8:9], v[106:107], 0
    v_mfma_f32_4x4x4_16b_bf16 v[76:79], v[8:9], v[104:105], 0
    v_bitop3_b32 v15, v6, v15, v46 bitop3:0xca
    v_bitop3_b32 v14, v6, v14, v47 bitop3:0xca
    s_nop 1
    v_pk_mul_f32 v[80:81], v[80:81], v[14:15] op_sel:[0,1] op_sel_hi:[1,1]
    v_pk_mul_f32 v[82:83], v[82:83], v[14:15] op_sel:[0,1] op_sel_hi:[1,1]
    v_pk_mul_f32 v[76:77], v[76:77], v[14:15] op_sel:[0,0] op_sel_hi:[1,0]
    v_pk_mul_f32 v[78:79], v[78:79], v[14:15] op_sel:[0,0] op_sel_hi:[1,0]
    s_add_u32 s40, s40, 0x4e200
    v_and_b32 v47, 0x0fffffff, v42
    v_mov_b32 v33, v42
    buffer_load_dwordx4 v[28:31], v47, s[8:11], 0 offen
    buffer_load_dwordx3 v[30:32], v47, s[8:11], 0 offen offset:8
    s_waitcnt lgkmcnt(0)
    v_cmpx_ne_u64 vcc, v[74:75], v[70:71]
    s_and_b64 s[82:83], vcc, s[80:81]
    s_cbranch_scc1 L2_c70
L2_d70:
    v_mov_b64 v[84:85], v[70:71]
    v_mov_b32 v7, v93
    v_mov_b64 v[86:87], v[74:75]
    s_mov_b64 exec, -1
    s_or_b64 s[80:81], s[80:81], vcc
    v_cmpx_ne_u64 vcc, v[72:73], v[68:69]
    s_and_b64 s[82:83], vcc, s[80:81]
    s_cbranch_scc1 L2_c71
L2_d71:
    v_mov_b64 v[84:85], v[68:69]
    v_mov_b32 v7, v92
    v_mov_b64 v[86:87], v[72:73]
    s_mov_b64 exec, -1
    s_or_b64 s[80:81], s[80:81], vcc
    ds_read_b64 v[70:71], v95
    ds_read_b64 v[68:69], v94
    s_waitcnt vmcnt(8)
    v_and_b32 v46, 0x20000000, v39
    v_lshrrev_b32 v47, 14, v35
    v_bitop3_b32 v47, v47, v5, v46 bitop3:0xea
    ds_read_b64 v[102:103], v47 offset:63616
    v_bitop3_b32 v93, v35, v5, v46 bitop3:0xea
    v_and_b32 v46, 0x10000000, v39
    v_lshrrev_b32 v47, 14, v34
    v_bitop3_b32 v47, v47, v5, v46 bitop3:0xea
    ds_read_b64 v[100:101], v47 offset:63616
    v_bitop3_b32 v92, v34, v5, v46 bitop3:0xea
    v_and_b32 v46, 0x80000000, v39
    v_lshrrev_b32 v47, 14, v37
    v_bitop3_b32 v47, v47, v5, v46 bitop3:0xea
    ds_read_b64 v[106:107], v47 offset:63616
    v_and_b32 v46, 0x40000000, v39
    v_lshrrev_b32 v47, 14, v36
    v_bitop3_b32 v47, v47, v5, v46 bitop3:0xea
    ds_read_b64 v[104:105], v47 offset:63616
    s_waitcnt lgkmcnt(4)
    v_mfma_f32_4x4x4_16b_bf16 v[80:83], v[10:11], v[70:71], v[80:83]
    v_mfma_f32_4x4x4_16b_bf16 v[76:79], v[10:11], v[68:69], v[76:79]
    v_perm_b32 v15, v35, v38, s45
    v_bitop3_b32 v46, v35, 0.5, -0.5 bitop3:0xa8
    v_perm_b32 v14, v34, v38, s44
    v_bitop3_b32 v47, v34, 0.5, -0.5 bitop3:0xa8
    v_cvt_pk_bf16_f32 v80, v80, v81
    v_cvt_pk_bf16_f32 v81, v82, v83
    ds_wrxchg_rtn_b64 v[74:75], v95, v[80:81]
    v_cvt_pk_bf16_f32 v76, v76, v77
    v_cvt_pk_bf16_f32 v77, v78, v79
    ds_wrxchg_rtn_b64 v[72:73], v94, v[76:77]
    s_waitcnt lgkmcnt(2)
    s_barrier
    s_setprio 3
    ds_write_b128 v3, v[124:127] offset:4096
    s_add_u32 s3, s40, 4096
    buffer_load_dwordx4 v[124:127], v3, s[16:19], s3 offen
    ds_write_b128 v3, v[116:119] offset:2048
    buffer_load_dwordx4 v[116:119], v3, s[16:19], s40 offen offset:2048
    ds_write_b128 v3, v[120:123] offset:3072
    buffer_load_dwordx4 v[120:123], v3, s[16:19], s40 offen offset:3072
    v_mfma_f32_4x4x4_16b_bf16 v[80:83], v[8:9], v[102:103], 0
    v_mfma_f32_4x4x4_16b_bf16 v[76:79], v[8:9], v[100:101], 0
    v_bitop3_b32 v15, v6, v15, v46 bitop3:0xca
    v_bitop3_b32 v14, v6, v14, v47 bitop3:0xca
    v_cmp_lt_u32 s[84:85], v5, v92
    s_nop 0
    v_pk_mul_f32 v[80:81], v[80:81], v[14:15] op_sel:[0,1] op_sel_hi:[1,1]
    v_pk_mul_f32 v[82:83], v[82:83], v[14:15] op_sel:[0,1] op_sel_hi:[1,1]
    v_pk_mul_f32 v[76:77], v[76:77], v[14:15] op_sel:[0,0] op_sel_hi:[1,0]
    v_pk_mul_f32 v[78:79], v[78:79], v[14:15] op_sel:[0,0] op_sel_hi:[1,0]
    v_mov_b32 v44, v43
    s_cmp_gt_u32 s37, 1024
    s_cbranch_scc1 L2_xs72
    s_cmp_lg_u32 s43, 0
    s_cbranch_scc1 L2_xa72
L2_xb72:
    v_lshlrev_b32 v89, 16, v96
    v_add_u32 v90, 60, v97
    v_bitop3_b32 v90, v89, v45, v90 bitop3:0x6a
    ds_write_b32 v98, v90 offset:12
    v_lshlrev_b32 v89, 20, v96
    v_add_u32 v90, 40, v97
    v_bitop3_b32 v90, v89, v45, v90 bitop3:0x6a
    ds_write_b32 v98, v90 offset:8
    v_lshlrev_b32 v89, 24, v96
    v_add_u32 v90, 20, v97
    v_bitop3_b32 v90, v89, v45, v90 bitop3:0x6a
    ds_write_b32 v98, v90 offset:4
    v_lshlrev_b32 v89, 28, v96
    v_bitop3_b32 v90, v89, v45, v97 bitop3:0x6a
    ds_write_b32 v98, v90 offset:0
    v_mov_b32_dpp v91, v66 quad_perm:[0,0,0,0] row_mask:0xf bank_mask:0xf
    v_and_b32 v89, 3, v91
    v_and_b32 v97, 0xfffc, v91
    v_sub_u16_dpp v88, v66, v91 quad_perm:[2,2,2,2] row_mask:0xf bank_mask:0xf
    v_mad_u32_u24 v97, v97, 5, v4
    v_add_u32 v99, v88, v89
    v_bfm_b32 v96, v88, v89
    v_cmp_lt_u32 s[58:59], 16, v99
    v_lshlrev_b32 v89, v1, v96
    v_and_b32 v89, v45, v89
    v_cmp_ne_u32 vcc, 0, v89
    v_xor_b32 v90, v97, v89
    s_add_u32 s3, s37, s38
    v_mbcnt_lo_u32_b32 v98, vcc_lo, 0
    v_mbcnt_hi_u32_b32 v98, vcc_hi, v98
    s_bcnt1_i32_b64 s41, vcc
    v_lshl_add_u32 v98, v98, 2, s3
    s_mov_b64 exec, vcc
    ds_write_b32 v98, v90
    s_mov_b64 exec, -1
    s_lshl2_add_u32 s37, s41, s37
    s_cmp_lg_u64 s[58:59], 0
    s_cbranch_scc1 L2_xe72
L2_xr72:
    v_add_u32 v98, s37, v0
    v_mov_b32 v90, -1
    ds_write_b32 v98, v90
    ds_read2st64_b32 v[40:41], v0 offset0:0 offset1:1
    ds_read2st64_b32 v[42:43], v0 offset0:2 offset1:3
    s_sub_u32 s3, s37, 768
    s_cmp_gt_u32 s3, 256
    s_cbranch_scc1 L2_xf72
L2_xg72:
    s_setprio 2
    s_waitcnt vmcnt(10)
    ds_write_b128 v3, v[108:111] offset:0
    s_waitcnt lgkmcnt(12)
    v_cmpx_ne_u64 vcc, v[74:75], v[70:71]
    s_and_b64 s[82:83], vcc, s[80:81]
    s_cbranch_scc1 L2_c73
L2_d73:
    v_mov_b64 v[84:85], v[70:71]
    v_mov_b32 v7, v95
    v_mov_b64 v[86:87], v[74:75]
    s_mov_b64 exec, -1
    s_or_b64 s[80:81], s[80:81], vcc
    v_cmpx_ne_u64 vcc, v[72:73], v[68:69]
    s_and_b64 s[82:83], vcc, s[80:81]
    s_cbranch_scc1 L2_c74
L2_d74:
    v_mov_b64 v[84:85], v[68:69]
    v_mov_b32 v7, v94
    v_mov_b64 v[86:87], v[72:73]
    s_mov_b64 exec, -1
    s_or_b64 s[80:81], s[80:81], vcc
    ds_read_b64 v[70:71], v93
    s_and_b64 exec, s[84:85], s[80:81]
    v_mfma_f32_4x4x4_16b_bf16 v[76:79], v[12:13], v[84:85], 0
    v_mov_b32 v92, v7
    s_andn2_b64 s[80:81], s[80:81], s[84:85]
    v_mfma_f32_4x4x4_16b_bf16 v[76:79], v[10:11], v[86:87], v[76:79]
    s_mov_b64 exec, -1
    ds_read_b64 v[68:69], v92
    s_setprio 1
    s_waitcnt vmcnt(7)
    ds_write_b128 v3, v[112:115] offset:1024
    s_waitcnt lgkmcnt(1)
    v_mfma_f32_4x4x4_16b_bf16 v[80:83], v[10:11], v[70:71], v[80:83]
    v_mfma_f32_4x4x4_16b_bf16 v[76:79], v[10:11], v[68:69], v[76:79]
    v_and_b32 v46, 0x40000000, v39
    v_bitop3_b32 v94, v36, v5, v46 bitop3:0xea
    v_and_b32 v46, 0x80000000, v39
    v_bitop3_b32 v95, v37, v5, v46 bitop3:0xea
    v_perm_b32 v15, v37, v38, s47
    v_bitop3_b32 v46, v37, 0.5, -0.5 bitop3:0xa8
    v_perm_b32 v14, v36, v38, s46
    v_bitop3_b32 v47, v36, 0.5, -0.5 bitop3:0xa8
    v_cvt_pk_bf16_f32 v80, v80, v81
    v_cvt_pk_bf16_f32 v81, v82, v83
    ds_wrxchg_rtn_b64 v[74:75], v93, v[80:81]
    v_cvt_pk_bf16_f32 v76, v76, v77
    v_cvt_pk_bf16_f32 v77, v78, v79
    ds_wrxchg_rtn_b64 v[72:73], v92, v[76:77]
    s_setprio 0
    v_mfma_f32_4x4x4_16b_bf16 v[80:83], v[8:9], v[106:107], 0
    v_mfma_f32_4x4x4_16b_bf16 v[76:79], v[8:9], v[104:105], 0
    v_bitop3_b32 v15, v6, v15, v46 bitop3:0xca
    v_bitop3_b32 v14, v6, v14, v47 bitop3:0xca
    s_nop 1
    v_pk_mul_f32 v[80:81], v[80:81], v[14:15] op_sel:[0,1] op_sel_hi:[1,1]
    v_pk_mul_f32 v[82:83], v[82:83], v[14:15] op_sel:[0,1] op_sel_hi:[1,1]
    v_pk_mul_f32 v[76:77], v[76:77], v[14:15] op_sel:[0,0] op_sel_hi:[1,0]
    v_pk_mul_f32 v[78:79], v[78:79], v[14:15] op_sel:[0,0] op_sel_hi:[1,0]
    s_add_u32 s42, s42, 1
    s_waitcnt lgkmcnt(2)
    s_barrier
    s_bitcmp1_b32 s36, s42
    s_cbranch_scc1 L2_slow
L2_ret4:
    s_setprio 3
    v_and_b32 v47, 0x0fffffff, v44
    v_mov_b32 v39, v44
    buffer_load_dwordx4 v[34:37], v47, s[8:11], 0 offen
    buffer_load_dwordx3 v[36:38], v47, s[8:11], 0 offen offset:8
    s_waitcnt lgkmcnt(0)
    v_cmpx_ne_u64 vcc, v[74:75], v[70:71]
    s_and_b64 s[82:83], vcc, s[80:81]
    s_cbranch_scc1 L2_c75
L2_d75:
    v_mov_b64 v[84:85], v[70:71]
    v_mov_b32 v7, v93
    v_mov_b64 v[86:87], v[74:75]
    s_mov_b64 exec, -1
    s_or_b64 s[80:81], s[80:81], vcc
    v_cmpx_ne_u64 vcc, v[72:73], v[68:69]
    s_and_b64 s[82:83], vcc, s[80:81]
    s_cbranch_scc1 L2_c76
L2_d76:
    v_mov_b64 v[84:85], v[68:69]
    v_mov_b32 v7, v92
    v_mov_b64 v[86:87], v[72:73]
    s_mov_b64 exec, -1
    s_or_b64 s[80:81], s[80:81], vcc
    ds_read_b64 v[70:71], v95
    ds_read_b64 v[68:69], v94
    v_and_b32 v46, 0x20000000, v21
    v_lshrrev_b32 v47, 14, v17
    v_bitop3_b32 v47, v47, v5, v46 bitop3:0xea
    ds_read_b64 v[102:103], v47 offset:63616
    v_bitop3_b32 v93, v17, v5, v46 bitop3:0xea
    v_and_b32 v46, 0x10000000, v21
    v_lshrrev_b32 v47, 14, v16
    v_bitop3_b32 v47, v47, v5, v46 bitop3:0xea
    ds_read_b64 v[100:101], v47 offset:63616
    v_bitop3_b32 v92, v16, v5, v46 bitop3:0xea
    s_waitcnt lgkmcnt(2)
    v_mfma_f32_4x4x4_16b_bf16 v[80:83], v[10:11], v[70:71], v[80:83]
    v_mfma_f32_4x4x4_16b_bf16 v[76:79], v[10:11], v[68:69], v[76:79]
    v_perm_b32 v15, v17, v20, s45
    v_bitop3_b32 v46, v17, 0.5, -0.5 bitop3:0xa8
    v_perm_b32 v14, v16, v20, s44
    v_bitop3_b32 v47, v16, 0.5, -0.5 bitop3:0xa8
    v_cvt_pk_bf16_f32 v80, v80, v81
    v_cvt_pk_bf16_f32 v81, v82, v83
    ds_wrxchg_rtn_b64 v[74:75], v95, v[80:81]
    v_cvt_pk_bf16_f32 v76, v76, v77
    v_cvt_pk_bf16_f32 v77, v78, v79
    ds_wrxchg_rtn_b64 v[72:73], v94, v[76:77]
    s_waitcnt lgkmcnt(2)
    v_mfma_f32_4x4x4_16b_bf16 v[80:83], v[8:9], v[102:103], 0
    v_mfma_f32_4x4x4_16b_bf16 v[76:79], v[8:9], v[100:101], 0
    v_bitop3_b32 v15, v6, v15, v46 bitop3:0xca
    v_bitop3_b32 v14, v6, v14, v47 bitop3:0xca
    v_cmp_lt_u32 s[84:85], v5, v92
    s_nop 0
    v_pk_mul_f32 v[80:81], v[80:81], v[14:15] op_sel:[0,1] op_sel_hi:[1,1]
    v_pk_mul_f32 v[82:83], v[82:83], v[14:15] op_sel:[0,1] op_sel_hi:[1,1]
    v_pk_mul_f32 v[76:77], v[76:77], v[14:15] op_sel:[0,0] op_sel_hi:[1,0]
    v_pk_mul_f32 v[78:79], v[78:79], v[14:15] op_sel:[0,0] op_sel_hi:[1,0]
    buffer_load_dwordx4 v[108:111], v3, s[16:19], s40 offen offset:0
    s_waitcnt lgkmcnt(0)
    v_cmpx_ne_u64 vcc, v[74:75], v[70:71]
    s_and_b64 s[82:83], vcc, s[80:81]
    s_cbranch_scc1 L2_c77
L2_d77:
    v_mov_b64 v[84:85], v[70:71]
    v_mov_b32 v7, v95
    v_mov_b64 v[86:87], v[74:75]
    s_mov_b64 exec, -1
    s_or_b64 s[80:81], s[80:81], vcc
    v_cmpx_ne_u64 vcc, v[72:73], v[68:69]
    s_and_b64 s[82:83], vcc, s[80:81]
    s_cbranch_scc1 L2_c78
L2_d78:
    v_mov_b64 v[84:85], v[68:69]
    v_mov_b32 v7, v94
    v_mov_b64 v[86:87], v[72:73]
    s_mov_b64 exec, -1
    s_or_b64 s[80:81], s[80:81], vcc
    ds_read_b64 v[70:71], v93
    s_and_b64 exec, s[84:85], s[80:81]
    v_mfma_f32_4x4x4_16b_bf16 v[76:79], v[12:13], v[84:85], 0
    v_mov_b32 v92, v7
    s_andn2_b64 s[80:81], s[80:81], s[84:85]
    v_mfma_f32_4x4x4_16b_bf16 v[76:79], v[10:11], v[86:87], v[76:79]
    s_mov_b64 exec, -1
    ds_read_b64 v[68:69], v92
    v_and_b32 v46, 0x80000000, v21
    v_lshrrev_b32 v47, 14, v19
    v_bitop3_b32 v47, v47, v5, v46 bitop3:0xea
    ds_read_b64 v[106:107], v47 offset:63616
    v_bitop3_b32 v95, v19, v5, v46 bitop3:0xea
    v_and_b32 v46, 0x40000000, v21
    v_lshrrev_b32 v47, 14, v18
    v_bitop3_b32 v47, v47, v5, v46 bitop3:0xea
    ds_read_b64 v[104:105], v47 offset:63616
    v_bitop3_b32 v94, v18, v5, v46 bitop3:0xea
    s_waitcnt lgkmcnt(2)
    v_mfma_f32_4x4x4_16b_bf16 v[80:83], v[10:11], v[70:71], v[80:83]
    v_mfma_f32_4x4x4_16b_bf16 v[76:79], v[10:11], v[68:69], v[76:79]
    v_perm_b32 v15, v19, v20, s47
    v_bitop3_b32 v46, v19, 0.5, -0.5 bitop3:0xa8
    v_perm_b32 v14, v18, v20, s46
    v_bitop3_b32 v47, v18, 0.5, -0.5 bitop3:0xa8
    v_cvt_pk_bf16_f32 v80, v80, v81
    v_cvt_pk_bf16_f32 v81, v82, v83
    ds_wrxchg_rtn_b64 v[74:75], v93, v[80:81]
    v_cvt_pk_bf16_f32 v76, v76, v77
    v_cvt_pk_bf16_f32 v77, v78, v79
    ds_wrxchg_rtn_b64 v[72:73], v92, v[76:77]
    s_setprio 2
    s_waitcnt lgkmcnt(2)
    v_mfma_f32_4x4x4_16b_bf16 v[80:83], v[8:9], v[106:107], 0
    v_mfma_f32_4x4x4_16b_bf16 v[76:79], v[8:9], v[104:105], 0
    v_bitop3_b32 v15, v6, v15, v46 bitop3:0xca
    v_bitop3_b32 v14, v6, v14, v47 bitop3:0xca
    s_nop 1
    v_pk_mul_f32 v[80:81], v[80:81], v[14:15] op_sel:[0,1] op_sel_hi:[1,1]
    v_pk_mul_f32 v[82:83], v[82:83], v[14:15] op_sel:[0,1] op_sel_hi:[1,1]
    v_pk_mul_f32 v[76:77], v[76:77], v[14:15] op_sel:[0,0] op_sel_hi:[1,0]
    v_pk_mul_f32 v[78:79], v[78:79], v[14:15] op_sel:[0,0] op_sel_hi:[1,0]
    v_and_b32 v47, 0x0fffffff, v40
    v_mov_b32 v21, v40
    buffer_load_dwordx4 v[16:19], v47, s[8:11], 0 offen
    buffer_load_dwordx3 v[18:20], v47, s[8:11], 0 offen offset:8
    s_waitcnt lgkmcnt(0)
    v_cmpx_ne_u64 vcc, v[74:75], v[70:71]
    s_and_b64 s[82:83], vcc, s[80:81]
    s_cbranch_scc1 L2_c79
L2_d79:
    v_mov_b64 v[84:85], v[70:71]
    v_mov_b32 v7, v93
    v_mov_b64 v[86:87], v[74:75]
    s_mov_b64 exec, -1
    s_or_b64 s[80:81], s[80:81], vcc
    v_cmpx_ne_u64 vcc, v[72:73], v[68:69]
    s_and_b64 s[82:83], vcc, s[80:81]
    s_cbranch_scc1 L2_c80
L2_d80:
    v_mov_b64 v[84:85], v[68:69]
    v_mov_b32 v7, v92
    v_mov_b64 v[86:87], v[72:73]
    s_mov_b64 exec, -1
    s_or_b64 s[80:81], s[80:81], vcc
    ds_read_b64 v[70:71], v95
    ds_read_b64 v[68:69], v94
    s_waitcnt vmcnt(10)
    v_and_b32 v46, 0x20000000, v27
    v_lshrrev_b32 v47, 14, v23
    v_bitop3_b32 v47, v47, v5, v46 bitop3:0xea
    ds_read_b64 v[102:103], v47 offset:63616
    v_bitop3_b32 v93, v23, v5, v46 bitop3:0xea
    v_and_b32 v46, 0x10000000, v27
    v_lshrrev_b32 v47, 14, v22
    v_bitop3_b32 v47, v47, v5, v46 bitop3:0xea
    ds_read_b64 v[100:101], v47 offset:63616
    v_bitop3_b32 v92, v22, v5, v46 bitop3:0xea
    s_waitcnt lgkmcnt(2)
    v_mfma_f32_4x4x4_16b_bf16 v[80:83], v[10:11], v[70:71], v[80:83]
    v_mfma_f32_4x4x4_16b_bf16 v[76:79], v[10:11], v[68:69], v[76:79]
    v_perm_b32 v15, v23, v26, s45
    v_bitop3_b32 v46, v23, 0.5, -0.5 bitop3:0xa8
    v_perm_b32 v14, v22, v26, s44
    v_bitop3_b32 v47, v22, 0.5, -0.5 bitop3:0xa8
    v_cvt_pk_bf16_f32 v80, v80, v81
    v_cvt_pk_bf16_f32 v81, v82, v83
    ds_wrxchg_rtn_b64 v[74:75], v95, v[80:81]
    v_cvt_pk_bf16_f32 v76, v76, v77
    v_cvt_pk_bf16_f32 v77, v78, v79
    ds_wrxchg_rtn_b64 v[72:73], v94, v[76:77]
    s_waitcnt lgkmcnt(2)
    v_mfma_f32_4x4x4_16b_bf16 v[80:83], v[8:9], v[102:103], 0
    v_mfma_f32_4x4x4_16b_bf16 v[76:79], v[8:9], v[100:101], 0
    v_bitop3_b32 v15, v6, v15, v46 bitop3:0xca
    v_bitop3_b32 v14, v6, v14, v47 bitop3:0xca
    v_cmp_lt_u32 s[84:85], v5, v92
    s_nop 0
    v_pk_mul_f32 v[80:81], v[80:81], v[14:15] op_sel:[0,1] op_sel_hi:[1,1]
    v_pk_mul_f32 v[82:83], v[82:83], v[14:15] op_sel:[0,1] op_sel_hi:[1,1]
    v_pk_mul_f32 v[76:77], v[76:77], v[14:15] op_sel:[0,0] op_sel_hi:[1,0]
    v_pk_mul_f32 v[78:79], v[78:79], v[14:15] op_sel:[0,0] op_sel_hi:[1,0]
    v_sub_u16 v88, v60, v52
    v_and_b32 v89, 3, v52
    v_add3_u32 v99, v88, v89, 3
    v_and_b32 v99, -4, v99
    v_max_u32 v99, 4, v99
    v_and_b32 v97, 0xfffc, v52
    v_bfm_b32 v96, v88, v89
    v_add_u32_dpp v91, v99, v99 row_shr:1 row_mask:0xf bank_mask:0xf bound_ctrl:1
    v_mad_u32_u24 v97, v97, 5, v2
    v_cmp_lt_u32 vcc, 16, v99
    v_add_u32_dpp v91, v91, v91 row_shr:2 row_mask:0xf bank_mask:0xf bound_ctrl:1
    v_sub_u32 v98, s38, v99
    v_lshrrev_b64 v[52:53], 16, v[52:53]
    v_add_u32_dpp v91, v91, v91 row_shr:4 row_mask:0xf bank_mask:0xf bound_ctrl:1
    v_lshrrev_b64 v[60:61], 16, v[60:61]
    s_mov_b32 s43, 0
    v_add_u32_dpp v91, v91, v91 row_shr:8 row_mask:0xf bank_mask:0xf bound_ctrl:1
    s_nop 1
    v_add_u32_dpp v91, v91, v91 row_bcast:15 row_mask:0xa bank_mask:0xf
    s_nop 1
    v_add_u32_dpp v91, v91, v91 row_bcast:31 row_mask:0xc bank_mask:0xf
    v_add_u32 v98, v98, v91
    v_readlane_b32 s37, v91, 63
    s_cbranch_vccnz L2_xo81
L2_xp81:
    buffer_load_dwordx4 v[112:115], v3, s[16:19], s40 offen offset:1024
    s_waitcnt lgkmcnt(0)
    v_cmpx_ne_u64 vcc, v[74:75], v[70:71]
    s_and_b64 s[82:83], vcc, s[80:81]
    s_cbranch_scc1 L2_c82
L2_d82:
    v_mov_b64 v[84:85], v[70:71]
    v_mov_b32 v7, v95
    v_mov_b64 v[86:87], v[74:75]
    s_mov_b64 exec, -1
    s_or_b64 s[80:81], s[80:81], vcc
    v_cmpx_ne_u64 vcc, v[72:73], v[68:69]
    s_and_b64 s[82:83], vcc, s[80:81]
    s_cbranch_scc1 L2_c83
L2_d83:
    v_mov_b64 v[84:85], v[68:69]
    v_mov_b32 v7, v94
    v_mov_b64 v[86:87], v[72:73]
    s_mov_b64 exec, -1
    s_or_b64 s[80:81], s[80:81], vcc
    ds_read_b64 v[70:71], v93
    s_and_b64 exec, s[84:85], s[80:81]
    v_mfma_f32_4x4x4_16b_bf16 v[76:79], v[12:13], v[84:85], 0
    v_mov_b32 v92, v7
    s_andn2_b64 s[80:81], s[80:81], s[84:85]
    v_mfma_f32_4x4x4_16b_bf16 v[76:79], v[10:11], v[86:87], v[76:79]
    s_mov_b64 exec, -1
    ds_read_b64 v[68:69], v92
    v_and_b32 v46, 0x80000000, v27
    v_lshrrev_b32 v47, 14, v25
    v_bitop3_b32 v47, v47, v5, v46 bitop3:0xea
    ds_read_b64 v[106:107], v47 offset:63616
    v_bitop3_b32 v95, v25, v5, v46 bitop3:0xea
    v_and_b32 v46, 0x40000000, v27
    v_lshrrev_b32 v47, 14, v24
    v_bitop3_b32 v47, v47, v5, v46 bitop3:0xea
    ds_read_b64 v[104:105], v47 offset:63616
    v_bitop3_b32 v94, v24, v5, v46 bitop3:0xea
    s_waitcnt lgkmcnt(2)
    v_mfma_f32_4x4x4_16b_bf16 v[80:83], v[10:11], v[70:71], v[80:83]
    v_mfma_f32_4x4x4_16b_bf16 v[76:79], v[10:11], v[68:69], v[76:79]
    v_perm_b32 v15, v25, v26, s47
    v_bitop3_b32 v46, v25, 0.5, -0.5 bitop3:0xa8
    v_perm_b32 v14, v24, v26, s46
    v_bitop3_b32 v47, v24, 0.5, -0.5 bitop3:0xa8
    v_cvt_pk_bf16_f32 v80, v80, v81
    v_cvt_pk_bf16_f32 v81, v82, v83
    ds_wrxchg_rtn_b64 v[74:75], v93, v[80:81]
    v_cvt_pk_bf16_f32 v76, v76, v77
    v_cvt_pk_bf16_f32 v77, v78, v79
    ds_wrxchg_rtn_b64 v[72:73], v92, v[76:77]
    s_setprio 1
    s_waitcnt lgkmcnt(2)
    v_mfma_f32_4x4x4_16b_bf16 v[80:83], v[8:9], v[106:107], 0
    v_mfma_f32_4x4x4_16b_bf16 v[76:79], v[8:9], v[104:105], 0
    v_bitop3_b32 v15, v6, v15, v46 bitop3:0xca
    v_bitop3_b32 v14, v6, v14, v47 bitop3:0xca
    s_nop 1
    v_pk_mul_f32 v[80:81], v[80:81], v[14:15] op_sel:[0,1] op_sel_hi:[1,1]
    v_pk_mul_f32 v[82:83], v[82:83], v[14:15] op_sel:[0,1] op_sel_hi:[1,1]
    v_pk_mul_f32 v[76:77], v[76:77], v[14:15] op_sel:[0,0] op_sel_hi:[1,0]
    v_pk_mul_f32 v[78:79], v[78:79], v[14:15] op_sel:[0,0] op_sel_hi:[1,0]
    v_and_b32 v47, 0x0fffffff, v41
    v_mov_b32 v27, v41
    buffer_load_dwordx4 v[22:25], v47, s[8:11], 0 offen
    buffer_load_dwordx3 v[24:26], v47, s[8:11], 0 offen offset:8
    s_waitcnt lgkmcnt(0)
    v_cmpx_ne_u64 vcc, v[74:75], v[70:71]
    s_and_b64 s[82:83], vcc, s[80:81]
    s_cbranch_scc1 L2_c84
L2_d84:
    v_mov_b64 v[84:85], v[70:71]
    v_mov_b32 v7, v93
    v_mov_b64 v[86:87], v[74:75]
    s_mov_b64 exec, -1
    s_or_b64 s[80:81], s[80:81], vcc
    v_cmpx_ne_u64 vcc, v[72:73], v[68:69]
    s_and_b64 s[82:83], vcc, s[80:81]
    s_cbranch_scc1 L2_c85
L2_d85:
    v_mov_b64 v[84:85], v[68:69]
    v_mov_b32 v7, v92
    v_mov_b64 v[86:87], v[72:73]
    s_mov_b64 exec, -1
    s_or_b64 s[80:81], s[80:81], vcc
    ds_read_b64 v[70:71], v95
    ds_read_b64 v[68:69], v94
    s_waitcnt vmcnt(11)
    v_and_b32 v46, 0x20000000, v33
    v_lshrrev_b32 v47, 14, v29
    v_bitop3_b32 v47, v47, v5, v46 bitop3:0xea
    ds_read_b64 v[102:103], v47 offset:63616
    v_bitop3_b32 v93, v29, v5, v46 bitop3:0xea
    v_and_b32 v46, 0x10000000, v33
    v_lshrrev_b32 v47, 14, v28
    v_bitop3_b32 v47, v47, v5, v46 bitop3:0xea
    ds_read_b64 v[100:101], v47 offset:63616
    v_bitop3_b32 v92, v28, v5, v46 bitop3:0xea
    s_waitcnt lgkmcnt(2)
    v_mfma_f32_4x4x4_16b_bf16 v[80:83], v[10:11], v[70:71], v[80:83]
    v_mfma_f32_4x4x4_16b_bf16 v[76:79], v[10:11], v[68:69], v[76:79]
    v_perm_b32 v15, v29, v32, s45
    v_bitop3_b32 v46, v29, 0.5, -0.5 bitop3:0xa8
    v_perm_b32 v14, v28, v32, s44
    v_bitop3_b32 v47, v28, 0.5, -0.5 bitop3:0xa8
    v_cvt_pk_bf16_f32 v80, v80, v81
    v_cvt_pk_bf16_f32 v81, v82, v83
    ds_wrxchg_rtn_b64 v[74:75], v95, v[80:81]
    v_cvt_pk_bf16_f32 v76, v76, v77
    v_cvt_pk_bf16_f32 v77, v78, v79
    ds_wrxchg_rtn_b64 v[72:73], v94, v[76:77]
    s_waitcnt lgkmcnt(2)
    v_mfma_f32_4x4x4_16b_bf16 v[80:83], v[8:9], v[102:103], 0
    v_mfma_f32_4x4x4_16b_bf16 v[76:79], v[8:9], v[100:101], 0
    v_bitop3_b32 v15, v6, v15, v46 bitop3:0xca
    v_bitop3_b32 v14, v6, v14, v47 bitop3:0xca
    v_cmp_lt_u32 s[84:85], v5, v92
    s_nop 0
    v_pk_mul_f32 v[80:81], v[80:81], v[14:15] op_sel:[0,1] op_sel_hi:[1,1]
    v_pk_mul_f32 v[82:83], v[82:83], v[14:15] op_sel:[0,1] op_sel_hi:[1,1]
    v_pk_mul_f32 v[76:77], v[76:77], v[14:15] op_sel:[0,0] op_sel_hi:[1,0]
    v_pk_mul_f32 v[78:79], v[78:79], v[14:15] op_sel:[0,0] op_sel_hi:[1,0]
    s_waitcnt lgkmcnt(0)
    v_cmpx_ne_u64 vcc, v[74:75], v[70:71]
    s_and_b64 s[82:83], vcc, s[80:81]
    s_cbranch_scc1 L2_c86
L2_d86:
    v_mov_b64 v[84:85], v[70:71]
    v_mov_b32 v7, v95
    v_mov_b64 v[86:87], v[74:75]
    s_mov_b64 exec, -1
    s_or_b64 s[80:81], s[80:81], vcc
    v_cmpx_ne_u64 vcc, v[72:73], v[68:69]
    s_and_b64 s[82:83], vcc, s[80:81]
    s_cbranch_scc1 L2_c87
L2_d87:
    v_mov_b64 v[84:85], v[68:69]
    v_mov_b32 v7, v94
    v_mov_b64 v[86:87], v[72:73]
    s_mov_b64 exec, -1
    s_or_b64 s[80:81], s[80:81], vcc
    ds_read_b64 v[70:71], v93
    s_and_b64 exec, s[84:85], s[80:81]
    v_mfma_f32_4x4x4_16b_bf16 v[76:79], v[12:13], v[84:85], 0
    v_mov_b32 v92, v7
    s_andn2_b64 s[80:81], s[80:81], s[84:85]
    v_mfma_f32_4x4x4_16b_bf16 v[76:79], v[10:11], v[86:87], v[76:79]
    s_mov_b64 exec, -1
    ds_read_b64 v[68:69], v92
    v_and_b32 v46, 0x80000000, v33
    v_lshrrev_b32 v47, 14, v31
    v_bitop3_b32 v47, v47, v5, v46 bitop3:0xea
    ds_read_b64 v[106:107], v47 offset:63616
    v_bitop3_b32 v95, v31, v5, v46 bitop3:0xea
    v_and_b32 v46, 0x40000000, v33
    v_lshrrev_b32 v47, 14, v30
    v_bitop3_b32 v47, v47, v5, v46 bitop3:0xea
    ds_read_b64 v[104:105], v47 offset:63616
    v_bitop3_b32 v94, v30, v5, v46 bitop3:0xea
    s_waitcnt lgkmcnt(2)
    v_mfma_f32_4x4x4_16b_bf16 v[80:83], v[10:11], v[70:71], v[80:83]
    v_mfma_f32_4x4x4_16b_bf16 v[76:79], v[10:11], v[68:69], v[76:79]
    v_perm_b32 v15, v31, v32, s47
    v_bitop3_b32 v46, v31, 0.5, -0.5 bitop3:0xa8
    v_perm_b32 v14, v30, v32, s46
    v_bitop3_b32 v47, v30, 0.5, -0.5 bitop3:0xa8
    v_cvt_pk_bf16_f32 v80, v80, v81
    v_cvt_pk_bf16_f32 v81, v82, v83
    ds_wrxchg_rtn_b64 v[74:75], v93, v[80:81]
    v_cvt_pk_bf16_f32 v76, v76, v77
    v_cvt_pk_bf16_f32 v77, v78, v79
    ds_wrxchg_rtn_b64 v[72:73], v92, v[76:77]
    s_setprio 0
    s_waitcnt lgkmcnt(2)
    v_mfma_f32_4x4x4_16b_bf16 v[80:83], v[8:9], v[106:107], 0
    v_mfma_f32_4x4x4_16b_bf16 v[76:79], v[8:9], v[104:105], 0
    v_bitop3_b32 v15, v6, v15, v46 bitop3:0xca
    v_bitop3_b32 v14, v6, v14, v47 bitop3:0xca
    s_nop 1
    v_pk_mul_f32 v[80:81], v[80:81], v[14:15] op_sel:[0,1] op_sel_hi:[1,1]
    v_pk_mul_f32 v[82:83], v[82:83], v[14:15] op_sel:[0,1] op_sel_hi:[1,1]
    v_pk_mul_f32 v[76:77], v[76:77], v[14:15] op_sel:[0,0] op_sel_hi:[1,0]
    v_pk_mul_f32 v[78:79], v[78:79], v[14:15] op_sel:[0,0] op_sel_hi:[1,0]
    s_add_u32 s40, s40, 0x4e200
    v_and_b32 v47, 0x0fffffff, v42
    v_mov_b32 v33, v42
    buffer_load_dwordx4 v[28:31], v47, s[8:11], 0 offen
    buffer_load_dwordx3 v[30:32], v47, s[8:11], 0 offen offset:8
    s_waitcnt lgkmcnt(0)
    v_cmpx_ne_u64 vcc, v[74:75], v[70:71]
    s_and_b64 s[82:83], vcc, s[80:81]
    s_cbranch_scc1 L2_c88
L2_d88:
    v_mov_b64 v[84:85], v[70:71]
    v_mov_b32 v7, v93
    v_mov_b64 v[86:87], v[74:75]
    s_mov_b64 exec, -1
    s_or_b64 s[80:81], s[80:81], vcc
    v_cmpx_ne_u64 vcc, v[72:73], v[68:69]
    s_and_b64 s[82:83], vcc, s[80:81]
    s_cbranch_scc1 L2_c89
L2_d89:
    v_mov_b64 v[84:85], v[68:69]
    v_mov_b32 v7, v92
    v_mov_b64 v[86:87], v[72:73]
    s_mov_b64 exec, -1
    s_or_b64 s[80:81], s[80:81], vcc
    ds_read_b64 v[70:71], v95
    ds_read_b64 v[68:69], v94
    s_waitcnt vmcnt(8)
    v_and_b32 v46, 0x20000000, v39
    v_lshrrev_b32 v47, 14, v35
    v_bitop3_b32 v47, v47, v5, v46 bitop3:0xea
    ds_read_b64 v[102:103], v47 offset:63616
    v_bitop3_b32 v93, v35, v5, v46 bitop3:0xea
    v_and_b32 v46, 0x10000000, v39
    v_lshrrev_b32 v47, 14, v34
    v_bitop3_b32 v47, v47, v5, v46 bitop3:0xea
    ds_read_b64 v[100:101], v47 offset:63616
    v_bitop3_b32 v92, v34, v5, v46 bitop3:0xea
    v_and_b32 v46, 0x80000000, v39
    v_lshrrev_b32 v47, 14, v37
    v_bitop3_b32 v47, v47, v5, v46 bitop3:0xea
    ds_read_b64 v[106:107], v47 offset:63616
    v_and_b32 v46, 0x40000000, v39
    v_lshrrev_b32 v47, 14, v36
    v_bitop3_b32 v47, v47, v5, v46 bitop3:0xea
    ds_read_b64 v[104:105], v47 offset:63616
    s_waitcnt lgkmcnt(4)
    v_mfma_f32_4x4x4_16b_bf16 v[80:83], v[10:11], v[70:71], v[80:83]
    v_mfma_f32_4x4x4_16b_bf16 v[76:79], v[10:11], v[68:69], v[76:79]
    v_perm_b32 v15, v35, v38, s45
    v_bitop3_b32 v46, v35, 0.5, -0.5 bitop3:0xa8
    v_perm_b32 v14, v34, v38, s44
    v_bitop3_b32 v47, v34, 0.5, -0.5 bitop3:0xa8
    v_cvt_pk_bf16_f32 v80, v80, v81
    v_cvt_pk_bf16_f32 v81, v82, v83
    ds_wrxchg_rtn_b64 v[74:75], v95, v[80:81]
    v_cvt_pk_bf16_f32 v76, v76, v77
    v_cvt_pk_bf16_f32 v77, v78, v79
    ds_wrxchg_rtn_b64 v[72:73], v94, v[76:77]
    s_waitcnt lgkmcnt(2)
    s_barrier
    s_setprio 3
    ds_write_b128 v3, v[124:127] offset:4096
    s_add_u32 s3, s40, 4096
    buffer_load_dwordx4 v[124:127], v3, s[16:19], s3 offen
    ds_write_b128 v3, v[116:119] offset:2048
    buffer_load_dwordx4 v[116:119], v3, s[16:19], s40 offen offset:2048
    ds_write_b128 v3, v[120:123] offset:3072
    buffer_load_dwordx4 v[120:123], v3, s[16:19], s40 offen offset:3072
    v_mfma_f32_4x4x4_16b_bf16 v[80:83], v[8:9], v[102:103], 0
    v_mfma_f32_4x4x4_16b_bf16 v[76:79], v[8:9], v[100:101], 0
    v_bitop3_b32 v15, v6, v15, v46 bitop3:0xca
    v_bitop3_b32 v14, v6, v14, v47 bitop3:0xca
    v_cmp_lt_u32 s[84:85], v5, v92
    s_nop 0
    v_pk_mul_f32 v[80:81], v[80:81], v[14:15] op_sel:[0,1] op_sel_hi:[1,1]
    v_pk_mul_f32 v[82:83], v[82:83], v[14:15] op_sel:[0,1] op_sel_hi:[1,1]
    v_pk_mul_f32 v[76:77], v[76:77], v[14:15] op_sel:[0,0] op_sel_hi:[1,0]
    v_pk_mul_f32 v[78:79], v[78:79], v[14:15] op_sel:[0,0] op_sel_hi:[1,0]
    v_mov_b32 v44, v43
    s_cmp_gt_u32 s37, 1024
    s_cbranch_scc1 L2_xs90
    s_cmp_lg_u32 s43, 0
    s_cbranch_scc1 L2_xa90
L2_xb90:
    v_lshlrev_b32 v89, 16, v96
    v_add_u32 v90, 60, v97
    v_bitop3_b32 v90, v89, v45, v90 bitop3:0x6a
    ds_write_b32 v98, v90 offset:12
    v_lshlrev_b32 v89, 20, v96
    v_add_u32 v90, 40, v97
    v_bitop3_b32 v90, v89, v45, v90 bitop3:0x6a
    ds_write_b32 v98, v90 offset:8
    v_lshlrev_b32 v89, 24, v96
    v_add_u32 v90, 20, v97
    v_bitop3_b32 v90, v89, v45, v90 bitop3:0x6a
    ds_write_b32 v98, v90 offset:4
    v_lshlrev_b32 v89, 28, v96
    v_bitop3_b32 v90, v89, v45, v97 bitop3:0x6a
    ds_write_b32 v98, v90 offset:0
    v_mov_b32_dpp v91, v64 quad_perm:[1,1,1,1] row_mask:0xf bank_mask:0xf
    v_and_b32 v89, 3, v91
    v_and_b32 v97, 0xfffc, v91
    v_sub_u16_dpp v88, v64, v91 quad_perm:[3,3,3,3] row_mask:0xf bank_mask:0xf
    v_mad_u32_u24 v97, v97, 5, v4
    v_add_u32 v99, v88, v89
    v_bfm_b32 v96, v88, v89
    v_cmp_lt_u32 s[58:59], 16, v99
    v_lshlrev_b32 v89, v1, v96
    v_and_b32 v89, v45, v89
    v_cmp_ne_u32 vcc, 0, v89
    v_xor_b32 v90, v97, v89
    s_add_u32 s3, s37, s38
    v_mbcnt_lo_u32_b32 v98, vcc_lo, 0
    v_mbcnt_hi_u32_b32 v98, vcc_hi, v98
    s_bcnt1_i32_b64 s41, vcc
    v_lshl_add_u32 v98, v98, 2, s3
    s_mov_b64 exec, vcc
    ds_write_b32 v98, v90
    s_mov_b64 exec, -1
    s_lshl2_add_u32 s37, s41, s37
    s_cmp_lg_u64 s[58:59], 0
    s_cbranch_scc1 L2_xe90
L2_xr90:
    v_add_u32 v98, s37, v0
    v_mov_b32 v90, -1
    ds_write_b32 v98, v90
    ds_read2st64_b32 v[40:41], v0 offset0:0 offset1:1
    ds_read2st64_b32 v[42:43], v0 offset0:2 offset1:3
    s_sub_u32 s3, s37, 768
    s_cmp_gt_u32 s3, 256
    s_cbranch_scc1 L2_xf90
L2_xg90:
    s_setprio 2
    s_waitcnt vmcnt(10)
    ds_write_b128 v3, v[108:111] offset:0
    s_waitcnt lgkmcnt(12)
    v_cmpx_ne_u64 vcc, v[74:75], v[70:71]
    s_and_b64 s[82:83], vcc, s[80:81]
    s_cbranch_scc1 L2_c91
L2_d91:
    v_mov_b64 v[84:85], v[70:71]
    v_mov_b32 v7, v95
    v_mov_b64 v[86:87], v[74:75]
    s_mov_b64 exec, -1
    s_or_b64 s[80:81], s[80:81], vcc
    v_cmpx_ne_u64 vcc, v[72:73], v[68:69]
    s_and_b64 s[82:83], vcc, s[80:81]
    s_cbranch_scc1 L2_c92
L2_d92:
    v_mov_b64 v[84:85], v[68:69]
    v_mov_b32 v7, v94
    v_mov_b64 v[86:87], v[72:73]
    s_mov_b64 exec, -1
    s_or_b64 s[80:81], s[80:81], vcc
    ds_read_b64 v[70:71], v93
    s_and_b64 exec, s[84:85], s[80:81]
    v_mfma_f32_4x4x4_16b_bf16 v[76:79], v[12:13], v[84:85], 0
    v_mov_b32 v92, v7
    s_andn2_b64 s[80:81], s[80:81], s[84:85]
    v_mfma_f32_4x4x4_16b_bf16 v[76:79], v[10:11], v[86:87], v[76:79]
    s_mov_b64 exec, -1
    ds_read_b64 v[68:69], v92
    s_setprio 1
    s_waitcnt vmcnt(7)
    ds_write_b128 v3, v[112:115] offset:1024
    s_waitcnt lgkmcnt(1)
    v_mfma_f32_4x4x4_16b_bf16 v[80:83], v[10:11], v[70:71], v[80:83]
    v_mfma_f32_4x4x4_16b_bf16 v[76:79], v[10:11], v[68:69], v[76:79]
    v_and_b32 v46, 0x40000000, v39
    v_bitop3_b32 v94, v36, v5, v46 bitop3:0xea
    v_and_b32 v46, 0x80000000, v39
    v_bitop3_b32 v95, v37, v5, v46 bitop3:0xea
    v_perm_b32 v15, v37, v38, s47
    v_bitop3_b32 v46, v37, 0.5, -0.5 bitop3:0xa8
    v_perm_b32 v14, v36, v38, s46
    v_bitop3_b32 v47, v36, 0.5, -0.5 bitop3:0xa8
    v_cvt_pk_bf16_f32 v80, v80, v81
    v_cvt_pk_bf16_f32 v81, v82, v83
    ds_wrxchg_rtn_b64 v[74:75], v93, v[80:81]
    v_cvt_pk_bf16_f32 v76, v76, v77
    v_cvt_pk_bf16_f32 v77, v78, v79
    ds_wrxchg_rtn_b64 v[72:73], v92, v[76:77]
    s_setprio 0
    v_mfma_f32_4x4x4_16b_bf16 v[80:83], v[8:9], v[106:107], 0
    v_mfma_f32_4x4x4_16b_bf16 v[76:79], v[8:9], v[104:105], 0
    v_bitop3_b32 v15, v6, v15, v46 bitop3:0xca
    v_bitop3_b32 v14, v6, v14, v47 bitop3:0xca
    s_nop 1
    v_pk_mul_f32 v[80:81], v[80:81], v[14:15] op_sel:[0,1] op_sel_hi:[1,1]
    v_pk_mul_f32 v[82:83], v[82:83], v[14:15] op_sel:[0,1] op_sel_hi:[1,1]
    v_pk_mul_f32 v[76:77], v[76:77], v[14:15] op_sel:[0,0] op_sel_hi:[1,0]
    v_pk_mul_f32 v[78:79], v[78:79], v[14:15] op_sel:[0,0] op_sel_hi:[1,0]
    s_add_u32 s42, s42, 1
    s_waitcnt lgkmcnt(2)
    s_barrier
    s_bitcmp1_b32 s36, s42
    s_cbranch_scc1 L2_slow
L2_ret5:
    s_setprio 3
    v_and_b32 v47, 0x0fffffff, v44
    v_mov_b32 v39, v44
    buffer_load_dwordx4 v[34:37], v47, s[8:11], 0 offen
    buffer_load_dwordx3 v[36:38], v47, s[8:11], 0 offen offset:8
    s_waitcnt lgkmcnt(0)
    v_cmpx_ne_u64 vcc, v[74:75], v[70:71]
    s_and_b64 s[82:83], vcc, s[80:81]
    s_cbranch_scc1 L2_c93
L2_d93:
    v_mov_b64 v[84:85], v[70:71]
    v_mov_b32 v7, v93
    v_mov_b64 v[86:87], v[74:75]
    s_mov_b64 exec, -1
    s_or_b64 s[80:81], s[80:81], vcc
    v_cmpx_ne_u64 vcc, v[72:73], v[68:69]
    s_and_b64 s[82:83], vcc, s[80:81]
    s_cbranch_scc1 L2_c94
L2_d94:
    v_mov_b64 v[84:85], v[68:69]
    v_mov_b32 v7, v92
    v_mov_b64 v[86:87], v[72:73]
    s_mov_b64 exec, -1
    s_or_b64 s[80:81], s[80:81], vcc
    ds_read_b64 v[70:71], v95
    ds_read_b64 v[68:69], v94
    v_and_b32 v46, 0x20000000, v21
    v_lshrrev_b32 v47, 14, v17
    v_bitop3_b32 v47, v47, v5, v46 bitop3:0xea
    ds_read_b64 v[102:103], v47 offset:63616
    v_bitop3_b32 v93, v17, v5, v46 bitop3:0xea
    v_and_b32 v46, 0x10000000, v21
    v_lshrrev_b32 v47, 14, v16
    v_bitop3_b32 v47, v47, v5, v46 bitop3:0xea
    ds_read_b64 v[100:101], v47 offset:63616
    v_bitop3_b32 v92, v16, v5, v46 bitop3:0xea
    s_waitcnt lgkmcnt(2)
    v_mfma_f32_4x4x4_16b_bf16 v[80:83], v[10:11], v[70:71], v[80:83]
    v_mfma_f32_4x4x4_16b_bf16 v[76:79], v[10:11], v[68:69], v[76:79]
    v_perm_b32 v15, v17, v20, s45
    v_bitop3_b32 v46, v17, 0.5, -0.5 bitop3:0xa8
    v_perm_b32 v14, v16, v20, s44
    v_bitop3_b32 v47, v16, 0.5, -0.5 bitop3:0xa8
    v_cvt_pk_bf16_f32 v80, v80, v81
    v_cvt_pk_bf16_f32 v81, v82, v83
    ds_wrxchg_rtn_b64 v[74:75], v95, v[80:81]
    v_cvt_pk_bf16_f32 v76, v76, v77
    v_cvt_pk_bf16_f32 v77, v78, v79
    ds_wrxchg_rtn_b64 v[72:73], v94, v[76:77]
    s_waitcnt lgkmcnt(2)
    v_mfma_f32_4x4x4_16b_bf16 v[80:83], v[8:9], v[102:103], 0
    v_mfma_f32_4x4x4_16b_bf16 v[76:79], v[8:9], v[100:101], 0
    v_bitop3_b32 v15, v6, v15, v46 bitop3:0xca
    v_bitop3_b32 v14, v6, v14, v47 bitop3:0xca
    v_cmp_lt_u32 s[84:85], v5, v92
    s_nop 0
    v_pk_mul_f32 v[80:81], v[80:81], v[14:15] op_sel:[0,1] op_sel_hi:[1,1]
    v_pk_mul_f32 v[82:83], v[82:83], v[14:15] op_sel:[0,1] op_sel_hi:[1,1]
    v_pk_mul_f32 v[76:77], v[76:77], v[14:15] op_sel:[0,0] op_sel_hi:[1,0]
    v_pk_mul_f32 v[78:79], v[78:79], v[14:15] op_sel:[0,0] op_sel_hi:[1,0]
    buffer_load_dwordx4 v[108:111], v3, s[16:19], s40 offen offset:0
    s_waitcnt lgkmcnt(0)
    v_cmpx_ne_u64 vcc, v[74:75], v[70:71]
    s_and_b64 s[82:83], vcc, s[80:81]
    s_cbranch_scc1 L2_c95
L2_d95:
    v_mov_b64 v[84:85], v[70:71]
    v_mov_b32 v7, v95
    v_mov_b64 v[86:87], v[74:75]
    s_mov_b64 exec, -1
    s_or_b64 s[80:81], s[80:81], vcc
    v_cmpx_ne_u64 vcc, v[72:73], v[68:69]
    s_and_b64 s[82:83], vcc, s[80:81]
    s_cbranch_scc1 L2_c96
L2_d96:
    v_mov_b64 v[84:85], v[68:69]
    v_mov_b32 v7, v94
    v_mov_b64 v[86:87], v[72:73]
    s_mov_b64 exec, -1
    s_or_b64 s[80:81], s[80:81], vcc
    ds_read_b64 v[70:71], v93
    s_and_b64 exec, s[84:85], s[80:81]
    v_mfma_f32_4x4x4_16b_bf16 v[76:79], v[12:13], v[84:85], 0
    v_mov_b32 v92, v7
    s_andn2_b64 s[80:81], s[80:81], s[84:85]
    v_mfma_f32_4x4x4_16b_bf16 v[76:79], v[10:11], v[86:87], v[76:79]
    s_mov_b64 exec, -1
    ds_read_b64 v[68:69], v92
    v_and_b32 v46, 0x80000000, v21
    v_lshrrev_b32 v47, 14, v19
    v_bitop3_b32 v47, v47, v5, v46 bitop3:0xea
    ds_read_b64 v[106:107], v47 offset:63616
    v_bitop3_b32 v95, v19, v5, v46 bitop3:0xea
    v_and_b32 v46, 0x40000000, v21
    v_lshrrev_b32 v47, 14, v18
    v_bitop3_b32 v47, v47, v5, v46 bitop3:0xea
    ds_read_b64 v[104:105], v47 offset:63616
    v_bitop3_b32 v94, v18, v5, v46 bitop3:0xea
    s_waitcnt lgkmcnt(2)
    v_mfma_f32_4x4x4_16b_bf16 v[80:83], v[10:11], v[70:71], v[80:83]
    v_mfma_f32_4x4x4_16b_bf16 v[76:79], v[10:11], v[68:69], v[76:79]
    v_perm_b32 v15, v19, v20, s47
    v_bitop3_b32 v46, v19, 0.5, -0.5 bitop3:0xa8
    v_perm_b32 v14, v18, v20, s46
    v_bitop3_b32 v47, v18, 0.5, -0.5 bitop3:0xa8
    v_cvt_pk_bf16_f32 v80, v80, v81
    v_cvt_pk_bf16_f32 v81, v82, v83
    ds_wrxchg_rtn_b64 v[74:75], v93, v[80:81]
    v_cvt_pk_bf16_f32 v76, v76, v77
    v_cvt_pk_bf16_f32 v77, v78, v79
    ds_wrxchg_rtn_b64 v[72:73], v92, v[76:77]
    s_setprio 2
    s_waitcnt lgkmcnt(2)
    v_mfma_f32_4x4x4_16b_bf16 v[80:83], v[8:9], v[106:107], 0
    v_mfma_f32_4x4x4_16b_bf16 v[76:79], v[8:9], v[104:105], 0
    v_bitop3_b32 v15, v6, v15, v46 bitop3:0xca
    v_bitop3_b32 v14, v6, v14, v47 bitop3:0xca
    s_nop 1
    v_pk_mul_f32 v[80:81], v[80:81], v[14:15] op_sel:[0,1] op_sel_hi:[1,1]
    v_pk_mul_f32 v[82:83], v[82:83], v[14:15] op_sel:[0,1] op_sel_hi:[1,1]
    v_pk_mul_f32 v[76:77], v[76:77], v[14:15] op_sel:[0,0] op_sel_hi:[1,0]
    v_pk_mul_f32 v[78:79], v[78:79], v[14:15] op_sel:[0,0] op_sel_hi:[1,0]
    v_and_b32 v47, 0x0fffffff, v40
    v_mov_b32 v21, v40
    buffer_load_dwordx4 v[16:19], v47, s[8:11], 0 offen
    buffer_load_dwordx3 v[18:20], v47, s[8:11], 0 offen offset:8
    s_waitcnt lgkmcnt(0)
    v_cmpx_ne_u64 vcc, v[74:75], v[70:71]
    s_and_b64 s[82:83], vcc, s[80:81]
    s_cbranch_scc1 L2_c97
L2_d97:
    v_mov_b64 v[84:85], v[70:71]
    v_mov_b32 v7, v93
    v_mov_b64 v[86:87], v[74:75]
    s_mov_b64 exec, -1
    s_or_b64 s[80:81], s[80:81], vcc
    v_cmpx_ne_u64 vcc, v[72:73], v[68:69]
    s_and_b64 s[82:83], vcc, s[80:81]
    s_cbranch_scc1 L2_c98
L2_d98:
    v_mov_b64 v[84:85], v[68:69]
    v_mov_b32 v7, v92
    v_mov_b64 v[86:87], v[72:73]
    s_mov_b64 exec, -1
    s_or_b64 s[80:81], s[80:81], vcc
    ds_read_b64 v[70:71], v95
    ds_read_b64 v[68:69], v94
    s_waitcnt vmcnt(10)
    v_and_b32 v46, 0x20000000, v27
    v_lshrrev_b32 v47, 14, v23
    v_bitop3_b32 v47, v47, v5, v46 bitop3:0xea
    ds_read_b64 v[102:103], v47 offset:63616
    v_bitop3_b32 v93, v23, v5, v46 bitop3:0xea
    v_and_b32 v46, 0x10000000, v27
    v_lshrrev_b32 v47, 14, v22
    v_bitop3_b32 v47, v47, v5, v46 bitop3:0xea
    ds_read_b64 v[100:101], v47 offset:63616
    v_bitop3_b32 v92, v22, v5, v46 bitop3:0xea
    s_waitcnt lgkmcnt(2)
    v_mfma_f32_4x4x4_16b_bf16 v[80:83], v[10:11], v[70:71], v[80:83]
    v_mfma_f32_4x4x4_16b_bf16 v[76:79], v[10:11], v[68:69], v[76:79]
    v_perm_b32 v15, v23, v26, s45
    v_bitop3_b32 v46, v23, 0.5, -0.5 bitop3:0xa8
    v_perm_b32 v14, v22, v26, s44
    v_bitop3_b32 v47, v22, 0.5, -0.5 bitop3:0xa8
    v_cvt_pk_bf16_f32 v80, v80, v81
    v_cvt_pk_bf16_f32 v81, v82, v83
    ds_wrxchg_rtn_b64 v[74:75], v95, v[80:81]
    v_cvt_pk_bf16_f32 v76, v76, v77
    v_cvt_pk_bf16_f32 v77, v78, v79
    ds_wrxchg_rtn_b64 v[72:73], v94, v[76:77]
    s_waitcnt lgkmcnt(2)
    v_mfma_f32_4x4x4_16b_bf16 v[80:83], v[8:9], v[102:103], 0
    v_mfma_f32_4x4x4_16b_bf16 v[76:79], v[8:9], v[100:101], 0
    v_bitop3_b32 v15, v6, v15, v46 bitop3:0xca
    v_bitop3_b32 v14, v6, v14, v47 bitop3:0xca
    v_cmp_lt_u32 s[84:85], v5, v92
    s_nop 0
    v_pk_mul_f32 v[80:81], v[80:81], v[14:15] op_sel:[0,1] op_sel_hi:[1,1]
    v_pk_mul_f32 v[82:83], v[82:83], v[14:15] op_sel:[0,1] op_sel_hi:[1,1]
    v_pk_mul_f32 v[76:77], v[76:77], v[14:15] op_sel:[0,0] op_sel_hi:[1,0]
    v_pk_mul_f32 v[78:79], v[78:79], v[14:15] op_sel:[0,0] op_sel_hi:[1,0]
    v_sub_u16 v88, v62, v54
    v_and_b32 v89, 3, v54
    v_add3_u32 v99, v88, v89, 3
    v_and_b32 v99, -4, v99
    v_max_u32 v99, 4, v99
    v_and_b32 v97, 0xfffc, v54
    v_bfm_b32 v96, v88, v89
    v_add_u32_dpp v91, v99, v99 row_shr:1 row_mask:0xf bank_mask:0xf bound_ctrl:1
    v_mad_u32_u24 v97, v97, 5, v2
    v_cmp_lt_u32 vcc, 16, v99
    v_add_u32_dpp v91, v91, v91 row_shr:2 row_mask:0xf bank_mask:0xf bound_ctrl:1
    v_sub_u32 v98, s38, v99
    v_lshrrev_b64 v[54:55], 16, v[54:55]
    v_add_u32_dpp v91, v91, v91 row_shr:4 row_mask:0xf bank_mask:0xf bound_ctrl:1
    v_lshrrev_b64 v[62:63], 16, v[62:63]
    s_mov_b32 s43, 0
    v_add_u32_dpp v91, v91, v91 row_shr:8 row_mask:0xf bank_mask:0xf bound_ctrl:1
    s_nop 1
    v_add_u32_dpp v91, v91, v91 row_bcast:15 row_mask:0xa bank_mask:0xf
    s_nop 1
    v_add_u32_dpp v91, v91, v91 row_bcast:31 row_mask:0xc bank_mask:0xf
    v_add_u32 v98, v98, v91
    v_readlane_b32 s37, v91, 63
    s_cbranch_vccnz L2_xo99
L2_xp99:
    buffer_load_dwordx4 v[112:115], v3, s[16:19], s40 offen offset:1024
    s_waitcnt lgkmcnt(0)
    v_cmpx_ne_u64 vcc, v[74:75], v[70:71]
    s_and_b64 s[82:83], vcc, s[80:81]
    s_cbranch_scc1 L2_c100
L2_d100:
    v_mov_b64 v[84:85], v[70:71]
    v_mov_b32 v7, v95
    v_mov_b64 v[86:87], v[74:75]
    s_mov_b64 exec, -1
    s_or_b64 s[80:81], s[80:81], vcc
    v_cmpx_ne_u64 vcc, v[72:73], v[68:69]
    s_and_b64 s[82:83], vcc, s[80:81]
    s_cbranch_scc1 L2_c101
L2_d101:
    v_mov_b64 v[84:85], v[68:69]
    v_mov_b32 v7, v94
    v_mov_b64 v[86:87], v[72:73]
    s_mov_b64 exec, -1
    s_or_b64 s[80:81], s[80:81], vcc
    ds_read_b64 v[70:71], v93
    s_and_b64 exec, s[84:85], s[80:81]
    v_mfma_f32_4x4x4_16b_bf16 v[76:79], v[12:13], v[84:85], 0
    v_mov_b32 v92, v7
    s_andn2_b64 s[80:81], s[80:81], s[84:85]
    v_mfma_f32_4x4x4_16b_bf16 v[76:79], v[10:11], v[86:87], v[76:79]
    s_mov_b64 exec, -1
    ds_read_b64 v[68:69], v92
    v_and_b32 v46, 0x80000000, v27
    v_lshrrev_b32 v47, 14, v25
    v_bitop3_b32 v47, v47, v5, v46 bitop3:0xea
    ds_read_b64 v[106:107], v47 offset:63616
    v_bitop3_b32 v95, v25, v5, v46 bitop3:0xea
    v_and_b32 v46, 0x40000000, v27
    v_lshrrev_b32 v47, 14, v24
    v_bitop3_b32 v47, v47, v5, v46 bitop3:0xea
    ds_read_b64 v[104:105], v47 offset:63616
    v_bitop3_b32 v94, v24, v5, v46 bitop3:0xea
    s_waitcnt lgkmcnt(2)
    v_mfma_f32_4x4x4_16b_bf16 v[80:83], v[10:11], v[70:71], v[80:83]
    v_mfma_f32_4x4x4_16b_bf16 v[76:79], v[10:11], v[68:69], v[76:79]
    v_perm_b32 v15, v25, v26, s47
    v_bitop3_b32 v46, v25, 0.5, -0.5 bitop3:0xa8
    v_perm_b32 v14, v24, v26, s46
    v_bitop3_b32 v47, v24, 0.5, -0.5 bitop3:0xa8
    v_cvt_pk_bf16_f32 v80, v80, v81
    v_cvt_pk_bf16_f32 v81, v82, v83
    ds_wrxchg_rtn_b64 v[74:75], v93, v[80:81]
    v_cvt_pk_bf16_f32 v76, v76, v77
    v_cvt_pk_bf16_f32 v77, v78, v79
    ds_wrxchg_rtn_b64 v[72:73], v92, v[76:77]
    s_setprio 1
    s_waitcnt lgkmcnt(2)
    v_mfma_f32_4x4x4_16b_bf16 v[80:83], v[8:9], v[106:107], 0
    v_mfma_f32_4x4x4_16b_bf16 v[76:79], v[8:9], v[104:105], 0
    v_bitop3_b32 v15, v6, v15, v46 bitop3:0xca
    v_bitop3_b32 v14, v6, v14, v47 bitop3:0xca
    s_nop 1
    v_pk_mul_f32 v[80:81], v[80:81], v[14:15] op_sel:[0,1] op_sel_hi:[1,1]
    v_pk_mul_f32 v[82:83], v[82:83], v[14:15] op_sel:[0,1] op_sel_hi:[1,1]
    v_pk_mul_f32 v[76:77], v[76:77], v[14:15] op_sel:[0,0] op_sel_hi:[1,0]
    v_pk_mul_f32 v[78:79], v[78:79], v[14:15] op_sel:[0,0] op_sel_hi:[1,0]
    v_and_b32 v47, 0x0fffffff, v41
    v_mov_b32 v27, v41
    buffer_load_dwordx4 v[22:25], v47, s[8:11], 0 offen
    buffer_load_dwordx3 v[24:26], v47, s[8:11], 0 offen offset:8
    s_waitcnt lgkmcnt(0)
    v_cmpx_ne_u64 vcc, v[74:75], v[70:71]
    s_and_b64 s[82:83], vcc, s[80:81]
    s_cbranch_scc1 L2_c102
L2_d102:
    v_mov_b64 v[84:85], v[70:71]
    v_mov_b32 v7, v93
    v_mov_b64 v[86:87], v[74:75]
    s_mov_b64 exec, -1
    s_or_b64 s[80:81], s[80:81], vcc
    v_cmpx_ne_u64 vcc, v[72:73], v[68:69]
    s_and_b64 s[82:83], vcc, s[80:81]
    s_cbranch_scc1 L2_c103
L2_d103:
    v_mov_b64 v[84:85], v[68:69]
    v_mov_b32 v7, v92
    v_mov_b64 v[86:87], v[72:73]
    s_mov_b64 exec, -1
    s_or_b64 s[80:81], s[80:81], vcc
    ds_read_b64 v[70:71], v95
    ds_read_b64 v[68:69], v94
    s_waitcnt vmcnt(11)
    v_and_b32 v46, 0x20000000, v33
    v_lshrrev_b32 v47, 14, v29
    v_bitop3_b32 v47, v47, v5, v46 bitop3:0xea
    ds_read_b64 v[102:103], v47 offset:63616
    v_bitop3_b32 v93, v29, v5, v46 bitop3:0xea
    v_and_b32 v46, 0x10000000, v33
    v_lshrrev_b32 v47, 14, v28
    v_bitop3_b32 v47, v47, v5, v46 bitop3:0xea
    ds_read_b64 v[100:101], v47 offset:63616
    v_bitop3_b32 v92, v28, v5, v46 bitop3:0xea
    s_waitcnt lgkmcnt(2)
    v_mfma_f32_4x4x4_16b_bf16 v[80:83], v[10:11], v[70:71], v[80:83]
    v_mfma_f32_4x4x4_16b_bf16 v[76:79], v[10:11], v[68:69], v[76:79]
    v_perm_b32 v15, v29, v32, s45
    v_bitop3_b32 v46, v29, 0.5, -0.5 bitop3:0xa8
    v_perm_b32 v14, v28, v32, s44
    v_bitop3_b32 v47, v28, 0.5, -0.5 bitop3:0xa8
    v_cvt_pk_bf16_f32 v80, v80, v81
    v_cvt_pk_bf16_f32 v81, v82, v83
    ds_wrxchg_rtn_b64 v[74:75], v95, v[80:81]
    v_cvt_pk_bf16_f32 v76, v76, v77
    v_cvt_pk_bf16_f32 v77, v78, v79
    ds_wrxchg_rtn_b64 v[72:73], v94, v[76:77]
    s_waitcnt lgkmcnt(2)
    v_mfma_f32_4x4x4_16b_bf16 v[80:83], v[8:9], v[102:103], 0
    v_mfma_f32_4x4x4_16b_bf16 v[76:79], v[8:9], v[100:101], 0
    v_bitop3_b32 v15, v6, v15, v46 bitop3:0xca
    v_bitop3_b32 v14, v6, v14, v47 bitop3:0xca
    v_cmp_lt_u32 s[84:85], v5, v92
    s_nop 0
    v_pk_mul_f32 v[80:81], v[80:81], v[14:15] op_sel:[0,1] op_sel_hi:[1,1]
    v_pk_mul_f32 v[82:83], v[82:83], v[14:15] op_sel:[0,1] op_sel_hi:[1,1]
    v_pk_mul_f32 v[76:77], v[76:77], v[14:15] op_sel:[0,0] op_sel_hi:[1,0]
    v_pk_mul_f32 v[78:79], v[78:79], v[14:15] op_sel:[0,0] op_sel_hi:[1,0]
    s_waitcnt lgkmcnt(0)
    v_cmpx_ne_u64 vcc, v[74:75], v[70:71]
    s_and_b64 s[82:83], vcc, s[80:81]
    s_cbranch_scc1 L2_c104
L2_d104:
    v_mov_b64 v[84:85], v[70:71]
    v_mov_b32 v7, v95
    v_mov_b64 v[86:87], v[74:75]
    s_mov_b64 exec, -1
    s_or_b64 s[80:81], s[80:81], vcc
    v_cmpx_ne_u64 vcc, v[72:73], v[68:69]
    s_and_b64 s[82:83], vcc, s[80:81]
    s_cbranch_scc1 L2_c105
L2_d105:
    v_mov_b64 v[84:85], v[68:69]
    v_mov_b32 v7, v94
    v_mov_b64 v[86:87], v[72:73]
    s_mov_b64 exec, -1
    s_or_b64 s[80:81], s[80:81], vcc
    ds_read_b64 v[70:71], v93
    s_and_b64 exec, s[84:85], s[80:81]
    v_mfma_f32_4x4x4_16b_bf16 v[76:79], v[12:13], v[84:85], 0
    v_mov_b32 v92, v7
    s_andn2_b64 s[80:81], s[80:81], s[84:85]
    v_mfma_f32_4x4x4_16b_bf16 v[76:79], v[10:11], v[86:87], v[76:79]
    s_mov_b64 exec, -1
    ds_read_b64 v[68:69], v92
    v_and_b32 v46, 0x80000000, v33
    v_lshrrev_b32 v47, 14, v31
    v_bitop3_b32 v47, v47, v5, v46 bitop3:0xea
    ds_read_b64 v[106:107], v47 offset:63616
    v_bitop3_b32 v95, v31, v5, v46 bitop3:0xea
    v_and_b32 v46, 0x40000000, v33
    v_lshrrev_b32 v47, 14, v30
    v_bitop3_b32 v47, v47, v5, v46 bitop3:0xea
    ds_read_b64 v[104:105], v47 offset:63616
    v_bitop3_b32 v94, v30, v5, v46 bitop3:0xea
    s_waitcnt lgkmcnt(2)
    v_mfma_f32_4x4x4_16b_bf16 v[80:83], v[10:11], v[70:71], v[80:83]
    v_mfma_f32_4x4x4_16b_bf16 v[76:79], v[10:11], v[68:69], v[76:79]
    v_perm_b32 v15, v31, v32, s47
    v_bitop3_b32 v46, v31, 0.5, -0.5 bitop3:0xa8
    v_perm_b32 v14, v30, v32, s46
    v_bitop3_b32 v47, v30, 0.5, -0.5 bitop3:0xa8
    v_cvt_pk_bf16_f32 v80, v80, v81
    v_cvt_pk_bf16_f32 v81, v82, v83
    ds_wrxchg_rtn_b64 v[74:75], v93, v[80:81]
    v_cvt_pk_bf16_f32 v76, v76, v77
    v_cvt_pk_bf16_f32 v77, v78, v79
    ds_wrxchg_rtn_b64 v[72:73], v92, v[76:77]
    s_setprio 0
    s_waitcnt lgkmcnt(2)
    v_mfma_f32_4x4x4_16b_bf16 v[80:83], v[8:9], v[106:107], 0
    v_mfma_f32_4x4x4_16b_bf16 v[76:79], v[8:9], v[104:105], 0
    v_bitop3_b32 v15, v6, v15, v46 bitop3:0xca
    v_bitop3_b32 v14, v6, v14, v47 bitop3:0xca
    s_nop 1
    v_pk_mul_f32 v[80:81], v[80:81], v[14:15] op_sel:[0,1] op_sel_hi:[1,1]
    v_pk_mul_f32 v[82:83], v[82:83], v[14:15] op_sel:[0,1] op_sel_hi:[1,1]
    v_pk_mul_f32 v[76:77], v[76:77], v[14:15] op_sel:[0,0] op_sel_hi:[1,0]
    v_pk_mul_f32 v[78:79], v[78:79], v[14:15] op_sel:[0,0] op_sel_hi:[1,0]
    s_add_u32 s40, s40, 0x4e200
    v_and_b32 v47, 0x0fffffff, v42
    v_mov_b32 v33, v42
    buffer_load_dwordx4 v[28:31], v47, s[8:11], 0 offen
    buffer_load_dwordx3 v[30:32], v47, s[8:11], 0 offen offset:8
    s_waitcnt lgkmcnt(0)
    v_cmpx_ne_u64 vcc, v[74:75], v[70:71]
    s_and_b64 s[82:83], vcc, s[80:81]
    s_cbranch_scc1 L2_c106
L2_d106:
    v_mov_b64 v[84:85], v[70:71]
    v_mov_b32 v7, v93
    v_mov_b64 v[86:87], v[74:75]
    s_mov_b64 exec, -1
    s_or_b64 s[80:81], s[80:81], vcc
    v_cmpx_ne_u64 vcc, v[72:73], v[68:69]
    s_and_b64 s[82:83], vcc, s[80:81]
    s_cbranch_scc1 L2_c107
L2_d107:
    v_mov_b64 v[84:85], v[68:69]
    v_mov_b32 v7, v92
    v_mov_b64 v[86:87], v[72:73]
    s_mov_b64 exec, -1
    s_or_b64 s[80:81], s[80:81], vcc
    ds_read_b64 v[70:71], v95
    ds_read_b64 v[68:69], v94
    s_waitcnt vmcnt(8)
    v_and_b32 v46, 0x20000000, v39
    v_lshrrev_b32 v47, 14, v35
    v_bitop3_b32 v47, v47, v5, v46 bitop3:0xea
    ds_read_b64 v[102:103], v47 offset:63616
    v_bitop3_b32 v93, v35, v5, v46 bitop3:0xea
    v_and_b32 v46, 0x10000000, v39
    v_lshrrev_b32 v47, 14, v34
    v_bitop3_b32 v47, v47, v5, v46 bitop3:0xea
    ds_read_b64 v[100:101], v47 offset:63616
    v_bitop3_b32 v92, v34, v5, v46 bitop3:0xea
    v_and_b32 v46, 0x80000000, v39
    v_lshrrev_b32 v47, 14, v37
    v_bitop3_b32 v47, v47, v5, v46 bitop3:0xea
    ds_read_b64 v[106:107], v47 offset:63616
    v_and_b32 v46, 0x40000000, v39
    v_lshrrev_b32 v47, 14, v36
    v_bitop3_b32 v47, v47, v5, v46 bitop3:0xea
    ds_read_b64 v[104:105], v47 offset:63616
    s_waitcnt lgkmcnt(4)
    v_mfma_f32_4x4x4_16b_bf16 v[80:83], v[10:11], v[70:71], v[80:83]
    v_mfma_f32_4x4x4_16b_bf16 v[76:79], v[10:11], v[68:69], v[76:79]
    v_perm_b32 v15, v35, v38, s45
    v_bitop3_b32 v46, v35, 0.5, -0.5 bitop3:0xa8
    v_perm_b32 v14, v34, v38, s44
    v_bitop3_b32 v47, v34, 0.5, -0.5 bitop3:0xa8
    v_cvt_pk_bf16_f32 v80, v80, v81
    v_cvt_pk_bf16_f32 v81, v82, v83
    ds_wrxchg_rtn_b64 v[74:75], v95, v[80:81]
    v_cvt_pk_bf16_f32 v76, v76, v77
    v_cvt_pk_bf16_f32 v77, v78, v79
    ds_wrxchg_rtn_b64 v[72:73], v94, v[76:77]
    s_waitcnt lgkmcnt(2)
    s_barrier
    s_setprio 3
    ds_write_b128 v3, v[124:127] offset:4096
    s_add_u32 s3, s40, 4096
    buffer_load_dwordx4 v[124:127], v3, s[16:19], s3 offen
    ds_write_b128 v3, v[116:119] offset:2048
    buffer_load_dwordx4 v[116:119], v3, s[16:19], s40 offen offset:2048
    ds_write_b128 v3, v[120:123] offset:3072
    buffer_load_dwordx4 v[120:123], v3, s[16:19], s40 offen offset:3072
    v_mfma_f32_4x4x4_16b_bf16 v[80:83], v[8:9], v[102:103], 0
    v_mfma_f32_4x4x4_16b_bf16 v[76:79], v[8:9], v[100:101], 0
    v_bitop3_b32 v15, v6, v15, v46 bitop3:0xca
    v_bitop3_b32 v14, v6, v14, v47 bitop3:0xca
    v_cmp_lt_u32 s[84:85], v5, v92
    s_nop 0
    v_pk_mul_f32 v[80:81], v[80:81], v[14:15] op_sel:[0,1] op_sel_hi:[1,1]
    v_pk_mul_f32 v[82:83], v[82:83], v[14:15] op_sel:[0,1] op_sel_hi:[1,1]
    v_pk_mul_f32 v[76:77], v[76:77], v[14:15] op_sel:[0,0] op_sel_hi:[1,0]
    v_pk_mul_f32 v[78:79], v[78:79], v[14:15] op_sel:[0,0] op_sel_hi:[1,0]
    v_mov_b32 v44, v43
    s_cmp_gt_u32 s37, 1024
    s_cbranch_scc1 L2_xs108
    s_cmp_lg_u32 s43, 0
    s_cbranch_scc1 L2_xa108
L2_xb108:
    v_lshlrev_b32 v89, 16, v96
    v_add_u32 v90, 60, v97
    v_bitop3_b32 v90, v89, v45, v90 bitop3:0x6a
    ds_write_b32 v98, v90 offset:12
    v_lshlrev_b32 v89, 20, v96
    v_add_u32 v90, 40, v97
    v_bitop3_b32 v90, v89, v45, v90 bitop3:0x6a
    ds_write_b32 v98, v90 offset:8
    v_lshlrev_b32 v89, 24, v96
    v_add_u32 v90, 20, v97
    v_bitop3_b32 v90, v89, v45, v90 bitop3:0x6a
    ds_write_b32 v98, v90 offset:4
    v_lshlrev_b32 v89, 28, v96
    v_bitop3_b32 v90, v89, v45, v97 bitop3:0x6a
    ds_write_b32 v98, v90 offset:0
    v_mov_b32_dpp v91, v66 quad_perm:[1,1,1,1] row_mask:0xf bank_mask:0xf
    v_and_b32 v89, 3, v91
    v_and_b32 v97, 0xfffc, v91
    v_sub_u16_dpp v88, v66, v91 quad_perm:[3,3,3,3] row_mask:0xf bank_mask:0xf
    v_mad_u32_u24 v97, v97, 5, v4
    v_add_u32 v99, v88, v89
    v_bfm_b32 v96, v88, v89
    v_cmp_lt_u32 s[58:59], 16, v99
    v_lshlrev_b32 v89, v1, v96
    v_and_b32 v89, v45, v89
    v_cmp_ne_u32 vcc, 0, v89
    v_xor_b32 v90, v97, v89
    s_add_u32 s3, s37, s38
    v_mbcnt_lo_u32_b32 v98, vcc_lo, 0
    v_mbcnt_hi_u32_b32 v98, vcc_hi, v98
    s_bcnt1_i32_b64 s41, vcc
    v_lshl_add_u32 v98, v98, 2, s3
    s_mov_b64 exec, vcc
    ds_write_b32 v98, v90
    s_mov_b64 exec, -1
    s_lshl2_add_u32 s37, s41, s37
    s_cmp_lg_u64 s[58:59], 0
    s_cbranch_scc1 L2_xe108
L2_xr108:
    v_add_u32 v98, s37, v0
    v_mov_b32 v90, -1
    ds_write_b32 v98, v90
    ds_read2st64_b32 v[40:41], v0 offset0:0 offset1:1
    ds_read2st64_b32 v[42:43], v0 offset0:2 offset1:3
    s_sub_u32 s3, s37, 768
    s_cmp_gt_u32 s3, 256
    s_cbranch_scc1 L2_xf108
L2_xg108:
    v_lshrrev_b64 v[64:65], 16, v[64:65]
    v_lshrrev_b64 v[66:67], 16, v[66:67]
    s_setprio 2
    s_waitcnt vmcnt(10)
    ds_write_b128 v3, v[108:111] offset:0
    s_waitcnt lgkmcnt(12)
    v_cmpx_ne_u64 vcc, v[74:75], v[70:71]
    s_and_b64 s[82:83], vcc, s[80:81]
    s_cbranch_scc1 L2_c109
L2_d109:
    v_mov_b64 v[84:85], v[70:71]
    v_mov_b32 v7, v95
    v_mov_b64 v[86:87], v[74:75]
    s_mov_b64 exec, -1
    s_or_b64 s[80:81], s[80:81], vcc
    v_cmpx_ne_u64 vcc, v[72:73], v[68:69]
    s_and_b64 s[82:83], vcc, s[80:81]
    s_cbranch_scc1 L2_c110
L2_d110:
    v_mov_b64 v[84:85], v[68:69]
    v_mov_b32 v7, v94
    v_mov_b64 v[86:87], v[72:73]
    s_mov_b64 exec, -1
    s_or_b64 s[80:81], s[80:81], vcc
    ds_read_b64 v[70:71], v93
    s_and_b64 exec, s[84:85], s[80:81]
    v_mfma_f32_4x4x4_16b_bf16 v[76:79], v[12:13], v[84:85], 0
    v_mov_b32 v92, v7
    s_andn2_b64 s[80:81], s[80:81], s[84:85]
    v_mfma_f32_4x4x4_16b_bf16 v[76:79], v[10:11], v[86:87], v[76:79]
    s_mov_b64 exec, -1
    ds_read_b64 v[68:69], v92
    s_setprio 1
    s_waitcnt vmcnt(7)
    ds_write_b128 v3, v[112:115] offset:1024
    s_waitcnt lgkmcnt(1)
    v_mfma_f32_4x4x4_16b_bf16 v[80:83], v[10:11], v[70:71], v[80:83]
    v_mfma_f32_4x4x4_16b_bf16 v[76:79], v[10:11], v[68:69], v[76:79]
    v_and_b32 v46, 0x40000000, v39
    v_bitop3_b32 v94, v36, v5, v46 bitop3:0xea
    v_and_b32 v46, 0x80000000, v39
    v_bitop3_b32 v95, v37, v5, v46 bitop3:0xea
    v_perm_b32 v15, v37, v38, s47
    v_bitop3_b32 v46, v37, 0.5, -0.5 bitop3:0xa8
    v_perm_b32 v14, v36, v38, s46
    v_bitop3_b32 v47, v36, 0.5, -0.5 bitop3:0xa8
    v_cvt_pk_bf16_f32 v80, v80, v81
    v_cvt_pk_bf16_f32 v81, v82, v83
    ds_wrxchg_rtn_b64 v[74:75], v93, v[80:81]
    v_cvt_pk_bf16_f32 v76, v76, v77
    v_cvt_pk_bf16_f32 v77, v78, v79
    ds_wrxchg_rtn_b64 v[72:73], v92, v[76:77]
    s_setprio 0
    v_mfma_f32_4x4x4_16b_bf16 v[80:83], v[8:9], v[106:107], 0
    v_mfma_f32_4x4x4_16b_bf16 v[76:79], v[8:9], v[104:105], 0
    v_bitop3_b32 v15, v6, v15, v46 bitop3:0xca
    v_bitop3_b32 v14, v6, v14, v47 bitop3:0xca
    s_nop 1
    v_pk_mul_f32 v[80:81], v[80:81], v[14:15] op_sel:[0,1] op_sel_hi:[1,1]
    v_pk_mul_f32 v[82:83], v[82:83], v[14:15] op_sel:[0,1] op_sel_hi:[1,1]
    v_pk_mul_f32 v[76:77], v[76:77], v[14:15] op_sel:[0,0] op_sel_hi:[1,0]
    v_pk_mul_f32 v[78:79], v[78:79], v[14:15] op_sel:[0,0] op_sel_hi:[1,0]
    s_add_u32 s42, s42, 1
    s_waitcnt lgkmcnt(2)
    s_cmp_lg_u32 s42, 14
    s_cbranch_scc1 L2_loop
    s_barrier
    s_bitcmp1_b32 s36, s42
    s_cbranch_scc1 L2_slow
L2_ret6:
    s_setprio 3
    v_and_b32 v47, 0x0fffffff, v44
    v_mov_b32 v39, v44
    buffer_load_dwordx4 v[34:37], v47, s[8:11], 0 offen
    buffer_load_dwordx3 v[36:38], v47, s[8:11], 0 offen offset:8
    s_waitcnt lgkmcnt(0)
    v_cmpx_ne_u64 vcc, v[74:75], v[70:71]
    s_and_b64 s[82:83], vcc, s[80:81]
    s_cbranch_scc1 L2_c111
L2_d111:
    v_mov_b64 v[84:85], v[70:71]
    v_mov_b32 v7, v93
    v_mov_b64 v[86:87], v[74:75]
    s_mov_b64 exec, -1
    s_or_b64 s[80:81], s[80:81], vcc
    v_cmpx_ne_u64 vcc, v[72:73], v[68:69]
    s_and_b64 s[82:83], vcc, s[80:81]
    s_cbranch_scc1 L2_c112
L2_d112:
    v_mov_b64 v[84:85], v[68:69]
    v_mov_b32 v7, v92
    v_mov_b64 v[86:87], v[72:73]
    s_mov_b64 exec, -1
    s_or_b64 s[80:81], s[80:81], vcc
    ds_read_b64 v[70:71], v95
    ds_read_b64 v[68:69], v94
    v_and_b32 v46, 0x20000000, v21
    v_lshrrev_b32 v47, 14, v17
    v_bitop3_b32 v47, v47, v5, v46 bitop3:0xea
    ds_read_b64 v[102:103], v47 offset:63616
    v_bitop3_b32 v93, v17, v5, v46 bitop3:0xea
    v_and_b32 v46, 0x10000000, v21
    v_lshrrev_b32 v47, 14, v16
    v_bitop3_b32 v47, v47, v5, v46 bitop3:0xea
    ds_read_b64 v[100:101], v47 offset:63616
    v_bitop3_b32 v92, v16, v5, v46 bitop3:0xea
    s_waitcnt lgkmcnt(2)
    v_mfma_f32_4x4x4_16b_bf16 v[80:83], v[10:11], v[70:71], v[80:83]
    v_mfma_f32_4x4x4_16b_bf16 v[76:79], v[10:11], v[68:69], v[76:79]
    v_perm_b32 v15, v17, v20, s45
    v_bitop3_b32 v46, v17, 0.5, -0.5 bitop3:0xa8
    v_perm_b32 v14, v16, v20, s44
    v_bitop3_b32 v47, v16, 0.5, -0.5 bitop3:0xa8
    v_cvt_pk_bf16_f32 v80, v80, v81
    v_cvt_pk_bf16_f32 v81, v82, v83
    ds_wrxchg_rtn_b64 v[74:75], v95, v[80:81]
    v_cvt_pk_bf16_f32 v76, v76, v77
    v_cvt_pk_bf16_f32 v77, v78, v79
    ds_wrxchg_rtn_b64 v[72:73], v94, v[76:77]
    s_waitcnt lgkmcnt(2)
    v_mfma_f32_4x4x4_16b_bf16 v[80:83], v[8:9], v[102:103], 0
    v_mfma_f32_4x4x4_16b_bf16 v[76:79], v[8:9], v[100:101], 0
    v_bitop3_b32 v15, v6, v15, v46 bitop3:0xca
    v_bitop3_b32 v14, v6, v14, v47 bitop3:0xca
    v_cmp_lt_u32 s[84:85], v5, v92
    s_nop 0
    v_pk_mul_f32 v[80:81], v[80:81], v[14:15] op_sel:[0,1] op_sel_hi:[1,1]
    v_pk_mul_f32 v[82:83], v[82:83], v[14:15] op_sel:[0,1] op_sel_hi:[1,1]
    v_pk_mul_f32 v[76:77], v[76:77], v[14:15] op_sel:[0,0] op_sel_hi:[1,0]
    v_pk_mul_f32 v[78:79], v[78:79], v[14:15] op_sel:[0,0] op_sel_hi:[1,0]
    buffer_load_dwordx4 v[108:111], v3, s[16:19], s40 offen offset:0
    s_waitcnt lgkmcnt(0)
    v_cmpx_ne_u64 vcc, v[74:75], v[70:71]
    s_and_b64 s[82:83], vcc, s[80:81]
    s_cbranch_scc1 L2_c113
L2_d113:
    v_mov_b64 v[84:85], v[70:71]
    v_mov_b32 v7, v95
    v_mov_b64 v[86:87], v[74:75]
    s_mov_b64 exec, -1
    s_or_b64 s[80:81], s[80:81], vcc
    v_cmpx_ne_u64 vcc, v[72:73], v[68:69]
    s_and_b64 s[82:83], vcc, s[80:81]
    s_cbranch_scc1 L2_c114
L2_d114:
    v_mov_b64 v[84:85], v[68:69]
    v_mov_b32 v7, v94
    v_mov_b64 v[86:87], v[72:73]
    s_mov_b64 exec, -1
    s_or_b64 s[80:81], s[80:81], vcc
    ds_read_b64 v[70:71], v93
    s_and_b64 exec, s[84:85], s[80:81]
    v_mfma_f32_4x4x4_16b_bf16 v[76:79], v[12:13], v[84:85], 0
    v_mov_b32 v92, v7
    s_andn2_b64 s[80:81], s[80:81], s[84:85]
    v_mfma_f32_4x4x4_16b_bf16 v[76:79], v[10:11], v[86:87], v[76:79]
    s_mov_b64 exec, -1
    ds_read_b64 v[68:69], v92
    v_and_b32 v46, 0x80000000, v21
    v_lshrrev_b32 v47, 14, v19
    v_bitop3_b32 v47, v47, v5, v46 bitop3:0xea
    ds_read_b64 v[106:107], v47 offset:63616
    v_bitop3_b32 v95, v19, v5, v46 bitop3:0xea
    v_and_b32 v46, 0x40000000, v21
    v_lshrrev_b32 v47, 14, v18
    v_bitop3_b32 v47, v47, v5, v46 bitop3:0xea
    ds_read_b64 v[104:105], v47 offset:63616
    v_bitop3_b32 v94, v18, v5, v46 bitop3:0xea
    s_waitcnt lgkmcnt(2)
    v_mfma_f32_4x4x4_16b_bf16 v[80:83], v[10:11], v[70:71], v[80:83]
    v_mfma_f32_4x4x4_16b_bf16 v[76:79], v[10:11], v[68:69], v[76:79]
    v_perm_b32 v15, v19, v20, s47
    v_bitop3_b32 v46, v19, 0.5, -0.5 bitop3:0xa8
    v_perm_b32 v14, v18, v20, s46
    v_bitop3_b32 v47, v18, 0.5, -0.5 bitop3:0xa8
    v_cvt_pk_bf16_f32 v80, v80, v81
    v_cvt_pk_bf16_f32 v81, v82, v83
    ds_wrxchg_rtn_b64 v[74:75], v93, v[80:81]
    v_cvt_pk_bf16_f32 v76, v76, v77
    v_cvt_pk_bf16_f32 v77, v78, v79
    ds_wrxchg_rtn_b64 v[72:73], v92, v[76:77]
    s_setprio 2
    s_waitcnt lgkmcnt(2)
    v_mfma_f32_4x4x4_16b_bf16 v[80:83], v[8:9], v[106:107], 0
    v_mfma_f32_4x4x4_16b_bf16 v[76:79], v[8:9], v[104:105], 0
    v_bitop3_b32 v15, v6, v15, v46 bitop3:0xca
    v_bitop3_b32 v14, v6, v14, v47 bitop3:0xca
    s_nop 1
    v_pk_mul_f32 v[80:81], v[80:81], v[14:15] op_sel:[0,1] op_sel_hi:[1,1]
    v_pk_mul_f32 v[82:83], v[82:83], v[14:15] op_sel:[0,1] op_sel_hi:[1,1]
    v_pk_mul_f32 v[76:77], v[76:77], v[14:15] op_sel:[0,0] op_sel_hi:[1,0]
    v_pk_mul_f32 v[78:79], v[78:79], v[14:15] op_sel:[0,0] op_sel_hi:[1,0]
    v_and_b32 v47, 0x0fffffff, v40
    v_mov_b32 v21, v40
    buffer_load_dwordx4 v[16:19], v47, s[8:11], 0 offen
    buffer_load_dwordx3 v[18:20], v47, s[8:11], 0 offen offset:8
    s_waitcnt lgkmcnt(0)
    v_cmpx_ne_u64 vcc, v[74:75], v[70:71]
    s_and_b64 s[82:83], vcc, s[80:81]
    s_cbranch_scc1 L2_c115
L2_d115:
    v_mov_b64 v[84:85], v[70:71]
    v_mov_b32 v7, v93
    v_mov_b64 v[86:87], v[74:75]
    s_mov_b64 exec, -1
    s_or_b64 s[80:81], s[80:81], vcc
    v_cmpx_ne_u64 vcc, v[72:73], v[68:69]
    s_and_b64 s[82:83], vcc, s[80:81]
    s_cbranch_scc1 L2_c116
L2_d116:
    v_mov_b64 v[84:85], v[68:69]
    v_mov_b32 v7, v92
    v_mov_b64 v[86:87], v[72:73]
    s_mov_b64 exec, -1
    s_or_b64 s[80:81], s[80:81], vcc
    ds_read_b64 v[70:71], v95
    ds_read_b64 v[68:69], v94
    s_waitcnt vmcnt(10)
    v_and_b32 v46, 0x20000000, v27
    v_lshrrev_b32 v47, 14, v23
    v_bitop3_b32 v47, v47, v5, v46 bitop3:0xea
    ds_read_b64 v[102:103], v47 offset:63616
    v_bitop3_b32 v93, v23, v5, v46 bitop3:0xea
    v_and_b32 v46, 0x10000000, v27
    v_lshrrev_b32 v47, 14, v22
    v_bitop3_b32 v47, v47, v5, v46 bitop3:0xea
    ds_read_b64 v[100:101], v47 offset:63616
    v_bitop3_b32 v92, v22, v5, v46 bitop3:0xea
    s_waitcnt lgkmcnt(2)
    v_mfma_f32_4x4x4_16b_bf16 v[80:83], v[10:11], v[70:71], v[80:83]
    v_mfma_f32_4x4x4_16b_bf16 v[76:79], v[10:11], v[68:69], v[76:79]
    v_perm_b32 v15, v23, v26, s45
    v_bitop3_b32 v46, v23, 0.5, -0.5 bitop3:0xa8
    v_perm_b32 v14, v22, v26, s44
    v_bitop3_b32 v47, v22, 0.5, -0.5 bitop3:0xa8
    v_cvt_pk_bf16_f32 v80, v80, v81
    v_cvt_pk_bf16_f32 v81, v82, v83
    ds_wrxchg_rtn_b64 v[74:75], v95, v[80:81]
    v_cvt_pk_bf16_f32 v76, v76, v77
    v_cvt_pk_bf16_f32 v77, v78, v79
    ds_wrxchg_rtn_b64 v[72:73], v94, v[76:77]
    s_waitcnt lgkmcnt(2)
    v_mfma_f32_4x4x4_16b_bf16 v[80:83], v[8:9], v[102:103], 0
    v_mfma_f32_4x4x4_16b_bf16 v[76:79], v[8:9], v[100:101], 0
    v_bitop3_b32 v15, v6, v15, v46 bitop3:0xca
    v_bitop3_b32 v14, v6, v14, v47 bitop3:0xca
    v_cmp_lt_u32 s[84:85], v5, v92
    s_nop 0
    v_pk_mul_f32 v[80:81], v[80:81], v[14:15] op_sel:[0,1] op_sel_hi:[1,1]
    v_pk_mul_f32 v[82:83], v[82:83], v[14:15] op_sel:[0,1] op_sel_hi:[1,1]
    v_pk_mul_f32 v[76:77], v[76:77], v[14:15] op_sel:[0,0] op_sel_hi:[1,0]
    v_pk_mul_f32 v[78:79], v[78:79], v[14:15] op_sel:[0,0] op_sel_hi:[1,0]
    buffer_load_dwordx4 v[112:115], v3, s[16:19], s40 offen offset:1024
    s_waitcnt lgkmcnt(0)
    v_cmpx_ne_u64 vcc, v[74:75], v[70:71]
    s_and_b64 s[82:83], vcc, s[80:81]
    s_cbranch_scc1 L2_c117
L2_d117:
    v_mov_b64 v[84:85], v[70:71]
    v_mov_b32 v7, v95
    v_mov_b64 v[86:87], v[74:75]
    s_mov_b64 exec, -1
    s_or_b64 s[80:81], s[80:81], vcc
    v_cmpx_ne_u64 vcc, v[72:73], v[68:69]
    s_and_b64 s[82:83], vcc, s[80:81]
    s_cbranch_scc1 L2_c118
L2_d118:
    v_mov_b64 v[84:85], v[68:69]
    v_mov_b32 v7, v94
    v_mov_b64 v[86:87], v[72:73]
    s_mov_b64 exec, -1
    s_or_b64 s[80:81], s[80:81], vcc
    ds_read_b64 v[70:71], v93
    s_and_b64 exec, s[84:85], s[80:81]
    v_mfma_f32_4x4x4_16b_bf16 v[76:79], v[12:13], v[84:85], 0
    v_mov_b32 v92, v7
    s_andn2_b64 s[80:81], s[80:81], s[84:85]
    v_mfma_f32_4x4x4_16b_bf16 v[76:79], v[10:11], v[86:87], v[76:79]
    s_mov_b64 exec, -1
    ds_read_b64 v[68:69], v92
    v_and_b32 v46, 0x80000000, v27
    v_lshrrev_b32 v47, 14, v25
    v_bitop3_b32 v47, v47, v5, v46 bitop3:0xea
    ds_read_b64 v[106:107], v47 offset:63616
    v_bitop3_b32 v95, v25, v5, v46 bitop3:0xea
    v_and_b32 v46, 0x40000000, v27
    v_lshrrev_b32 v47, 14, v24
    v_bitop3_b32 v47, v47, v5, v46 bitop3:0xea
    ds_read_b64 v[104:105], v47 offset:63616
    v_bitop3_b32 v94, v24, v5, v46 bitop3:0xea
    s_waitcnt lgkmcnt(2)
    v_mfma_f32_4x4x4_16b_bf16 v[80:83], v[10:11], v[70:71], v[80:83]
    v_mfma_f32_4x4x4_16b_bf16 v[76:79], v[10:11], v[68:69], v[76:79]
    v_perm_b32 v15, v25, v26, s47
    v_bitop3_b32 v46, v25, 0.5, -0.5 bitop3:0xa8
    v_perm_b32 v14, v24, v26, s46
    v_bitop3_b32 v47, v24, 0.5, -0.5 bitop3:0xa8
    v_cvt_pk_bf16_f32 v80, v80, v81
    v_cvt_pk_bf16_f32 v81, v82, v83
    ds_wrxchg_rtn_b64 v[74:75], v93, v[80:81]
    v_cvt_pk_bf16_f32 v76, v76, v77
    v_cvt_pk_bf16_f32 v77, v78, v79
    ds_wrxchg_rtn_b64 v[72:73], v92, v[76:77]
    s_setprio 1
    s_waitcnt lgkmcnt(2)
    v_mfma_f32_4x4x4_16b_bf16 v[80:83], v[8:9], v[106:107], 0
    v_mfma_f32_4x4x4_16b_bf16 v[76:79], v[8:9], v[104:105], 0
    v_bitop3_b32 v15, v6, v15, v46 bitop3:0xca
    v_bitop3_b32 v14, v6, v14, v47 bitop3:0xca
    s_nop 1
    v_pk_mul_f32 v[80:81], v[80:81], v[14:15] op_sel:[0,1] op_sel_hi:[1,1]
    v_pk_mul_f32 v[82:83], v[82:83], v[14:15] op_sel:[0,1] op_sel_hi:[1,1]
    v_pk_mul_f32 v[76:77], v[76:77], v[14:15] op_sel:[0,0] op_sel_hi:[1,0]
    v_pk_mul_f32 v[78:79], v[78:79], v[14:15] op_sel:[0,0] op_sel_hi:[1,0]
    v_and_b32 v47, 0x0fffffff, v41
    v_mov_b32 v27, v41
    buffer_load_dwordx4 v[22:25], v47, s[8:11], 0 offen
    buffer_load_dwordx3 v[24:26], v47, s[8:11], 0 offen offset:8
    s_waitcnt lgkmcnt(0)
    v_cmpx_ne_u64 vcc, v[74:75], v[70:71]
    s_and_b64 s[82:83], vcc, s[80:81]
    s_cbranch_scc1 L2_c119
L2_d119:
    v_mov_b64 v[84:85], v[70:71]
    v_mov_b32 v7, v93
    v_mov_b64 v[86:87], v[74:75]
    s_mov_b64 exec, -1
    s_or_b64 s[80:81], s[80:81], vcc
    v_cmpx_ne_u64 vcc, v[72:73], v[68:69]
    s_and_b64 s[82:83], vcc, s[80:81]
    s_cbranch_scc1 L2_c120
L2_d120:
    v_mov_b64 v[84:85], v[68:69]
    v_mov_b32 v7, v92
    v_mov_b64 v[86:87], v[72:73]
    s_mov_b64 exec, -1
    s_or_b64 s[80:81], s[80:81], vcc
    ds_read_b64 v[70:71], v95
    ds_read_b64 v[68:69], v94
    s_waitcnt vmcnt(11)
    v_and_b32 v46, 0x20000000, v33
    v_lshrrev_b32 v47, 14, v29
    v_bitop3_b32 v47, v47, v5, v46 bitop3:0xea
    ds_read_b64 v[102:103], v47 offset:63616
    v_bitop3_b32 v93, v29, v5, v46 bitop3:0xea
    v_and_b32 v46, 0x10000000, v33
    v_lshrrev_b32 v47, 14, v28
    v_bitop3_b32 v47, v47, v5, v46 bitop3:0xea
    ds_read_b64 v[100:101], v47 offset:63616
    v_bitop3_b32 v92, v28, v5, v46 bitop3:0xea
    s_waitcnt lgkmcnt(2)
    v_mfma_f32_4x4x4_16b_bf16 v[80:83], v[10:11], v[70:71], v[80:83]
    v_mfma_f32_4x4x4_16b_bf16 v[76:79], v[10:11], v[68:69], v[76:79]
    v_perm_b32 v15, v29, v32, s45
    v_bitop3_b32 v46, v29, 0.5, -0.5 bitop3:0xa8
    v_perm_b32 v14, v28, v32, s44
    v_bitop3_b32 v47, v28, 0.5, -0.5 bitop3:0xa8
    v_cvt_pk_bf16_f32 v80, v80, v81
    v_cvt_pk_bf16_f32 v81, v82, v83
    ds_wrxchg_rtn_b64 v[74:75], v95, v[80:81]
    v_cvt_pk_bf16_f32 v76, v76, v77
    v_cvt_pk_bf16_f32 v77, v78, v79
    ds_wrxchg_rtn_b64 v[72:73], v94, v[76:77]
    s_waitcnt lgkmcnt(2)
    v_mfma_f32_4x4x4_16b_bf16 v[80:83], v[8:9], v[102:103], 0
    v_mfma_f32_4x4x4_16b_bf16 v[76:79], v[8:9], v[100:101], 0
    v_bitop3_b32 v15, v6, v15, v46 bitop3:0xca
    v_bitop3_b32 v14, v6, v14, v47 bitop3:0xca
    v_cmp_lt_u32 s[84:85], v5, v92
    s_nop 0
    v_pk_mul_f32 v[80:81], v[80:81], v[14:15] op_sel:[0,1] op_sel_hi:[1,1]
    v_pk_mul_f32 v[82:83], v[82:83], v[14:15] op_sel:[0,1] op_sel_hi:[1,1]
    v_pk_mul_f32 v[76:77], v[76:77], v[14:15] op_sel:[0,0] op_sel_hi:[1,0]
    v_pk_mul_f32 v[78:79], v[78:79], v[14:15] op_sel:[0,0] op_sel_hi:[1,0]
    s_waitcnt lgkmcnt(0)
    v_cmpx_ne_u64 vcc, v[74:75], v[70:71]
    s_and_b64 s[82:83], vcc, s[80:81]
    s_cbranch_scc1 L2_c121
L2_d121:
    v_mov_b64 v[84:85], v[70:71]
    v_mov_b32 v7, v95
    v_mov_b64 v[86:87], v[74:75]
    s_mov_b64 exec, -1
    s_or_b64 s[80:81], s[80:81], vcc
    v_cmpx_ne_u64 vcc, v[72:73], v[68:69]
    s_and_b64 s[82:83], vcc, s[80:81]
    s_cbranch_scc1 L2_c122
L2_d122:
    v_mov_b64 v[84:85], v[68:69]
    v_mov_b32 v7, v94
    v_mov_b64 v[86:87], v[72:73]
    s_mov_b64 exec, -1
    s_or_b64 s[80:81], s[80:81], vcc
    ds_read_b64 v[70:71], v93
    s_and_b64 exec, s[84:85], s[80:81]
    v_mfma_f32_4x4x4_16b_bf16 v[76:79], v[12:13], v[84:85], 0
    v_mov_b32 v92, v7
    s_andn2_b64 s[80:81], s[80:81], s[84:85]
    v_mfma_f32_4x4x4_16b_bf16 v[76:79], v[10:11], v[86:87], v[76:79]
    s_mov_b64 exec, -1
    ds_read_b64 v[68:69], v92
    v_and_b32 v46, 0x80000000, v33
    v_lshrrev_b32 v47, 14, v31
    v_bitop3_b32 v47, v47, v5, v46 bitop3:0xea
    ds_read_b64 v[106:107], v47 offset:63616
    v_bitop3_b32 v95, v31, v5, v46 bitop3:0xea
    v_and_b32 v46, 0x40000000, v33
    v_lshrrev_b32 v47, 14, v30
    v_bitop3_b32 v47, v47, v5, v46 bitop3:0xea
    ds_read_b64 v[104:105], v47 offset:63616
    v_bitop3_b32 v94, v30, v5, v46 bitop3:0xea
    s_waitcnt lgkmcnt(2)
    v_mfma_f32_4x4x4_16b_bf16 v[80:83], v[10:11], v[70:71], v[80:83]
    v_mfma_f32_4x4x4_16b_bf16 v[76:79], v[10:11], v[68:69], v[76:79]
    v_perm_b32 v15, v31, v32, s47
    v_bitop3_b32 v46, v31, 0.5, -0.5 bitop3:0xa8
    v_perm_b32 v14, v30, v32, s46
    v_bitop3_b32 v47, v30, 0.5, -0.5 bitop3:0xa8
    v_cvt_pk_bf16_f32 v80, v80, v81
    v_cvt_pk_bf16_f32 v81, v82, v83
    ds_wrxchg_rtn_b64 v[74:75], v93, v[80:81]
    v_cvt_pk_bf16_f32 v76, v76, v77
    v_cvt_pk_bf16_f32 v77, v78, v79
    ds_wrxchg_rtn_b64 v[72:73], v92, v[76:77]
    s_setprio 0
    s_waitcnt lgkmcnt(2)
    v_mfma_f32_4x4x4_16b_bf16 v[80:83], v[8:9], v[106:107], 0
    v_mfma_f32_4x4x4_16b_bf16 v[76:79], v[8:9], v[104:105], 0
    v_bitop3_b32 v15, v6, v15, v46 bitop3:0xca
    v_bitop3_b32 v14, v6, v14, v47 bitop3:0xca
    s_nop 1
    v_pk_mul_f32 v[80:81], v[80:81], v[14:15] op_sel:[0,1] op_sel_hi:[1,1]
    v_pk_mul_f32 v[82:83], v[82:83], v[14:15] op_sel:[0,1] op_sel_hi:[1,1]
    v_pk_mul_f32 v[76:77], v[76:77], v[14:15] op_sel:[0,0] op_sel_hi:[1,0]
    v_pk_mul_f32 v[78:79], v[78:79], v[14:15] op_sel:[0,0] op_sel_hi:[1,0]
    s_add_u32 s40, s40, 0xfff29280
    v_and_b32 v47, 0x0fffffff, v42
    v_mov_b32 v33, v42
    buffer_load_dwordx4 v[28:31], v47, s[8:11], 0 offen
    buffer_load_dwordx3 v[30:32], v47, s[8:11], 0 offen offset:8
    s_waitcnt lgkmcnt(0)
    v_cmpx_ne_u64 vcc, v[74:75], v[70:71]
    s_and_b64 s[82:83], vcc, s[80:81]
    s_cbranch_scc1 L2_c123
L2_d123:
    v_mov_b64 v[84:85], v[70:71]
    v_mov_b32 v7, v93
    v_mov_b64 v[86:87], v[74:75]
    s_mov_b64 exec, -1
    s_or_b64 s[80:81], s[80:81], vcc
    v_cmpx_ne_u64 vcc, v[72:73], v[68:69]
    s_and_b64 s[82:83], vcc, s[80:81]
    s_cbranch_scc1 L2_c124
L2_d124:
    v_mov_b64 v[84:85], v[68:69]
    v_mov_b32 v7, v92
    v_mov_b64 v[86:87], v[72:73]
    s_mov_b64 exec, -1
    s_or_b64 s[80:81], s[80:81], vcc
    ds_read_b64 v[70:71], v95
    ds_read_b64 v[68:69], v94
    s_waitcnt vmcnt(8)
    v_and_b32 v46, 0x20000000, v39
    v_lshrrev_b32 v47, 14, v35
    v_bitop3_b32 v47, v47, v5, v46 bitop3:0xea
    ds_read_b64 v[102:103], v47 offset:63616
    v_bitop3_b32 v93, v35, v5, v46 bitop3:0xea
    v_and_b32 v46, 0x10000000, v39
    v_lshrrev_b32 v47, 14, v34
    v_bitop3_b32 v47, v47, v5, v46 bitop3:0xea
    ds_read_b64 v[100:101], v47 offset:63616
    v_bitop3_b32 v92, v34, v5, v46 bitop3:0xea
    v_and_b32 v46, 0x80000000, v39
    v_lshrrev_b32 v47, 14, v37
    v_bitop3_b32 v47, v47, v5, v46 bitop3:0xea
    ds_read_b64 v[106:107], v47 offset:63616
    v_and_b32 v46, 0x40000000, v39
    v_lshrrev_b32 v47, 14, v36
    v_bitop3_b32 v47, v47, v5, v46 bitop3:0xea
    ds_read_b64 v[104:105], v47 offset:63616
    s_waitcnt lgkmcnt(4)
    v_mfma_f32_4x4x4_16b_bf16 v[80:83], v[10:11], v[70:71], v[80:83]
    v_mfma_f32_4x4x4_16b_bf16 v[76:79], v[10:11], v[68:69], v[76:79]
    v_perm_b32 v15, v35, v38, s45
    v_bitop3_b32 v46, v35, 0.5, -0.5 bitop3:0xa8
    v_perm_b32 v14, v34, v38, s44
    v_bitop3_b32 v47, v34, 0.5, -0.5 bitop3:0xa8
    v_cvt_pk_bf16_f32 v80, v80, v81
    v_cvt_pk_bf16_f32 v81, v82, v83
    ds_wrxchg_rtn_b64 v[74:75], v95, v[80:81]
    v_cvt_pk_bf16_f32 v76, v76, v77
    v_cvt_pk_bf16_f32 v77, v78, v79
    ds_wrxchg_rtn_b64 v[72:73], v94, v[76:77]
    s_waitcnt lgkmcnt(2)
    s_barrier
    s_setprio 3
    ds_write_b128 v3, v[124:127] offset:4096
    ds_write_b128 v3, v[116:119] offset:2048
    ds_write_b128 v3, v[120:123] offset:3072
    v_mfma_f32_4x4x4_16b_bf16 v[80:83], v[8:9], v[102:103], 0
    v_mfma_f32_4x4x4_16b_bf16 v[76:79], v[8:9], v[100:101], 0
    v_bitop3_b32 v15, v6, v15, v46 bitop3:0xca
    v_bitop3_b32 v14, v6, v14, v47 bitop3:0xca
    v_cmp_lt_u32 s[84:85], v5, v92
    s_nop 0
    v_pk_mul_f32 v[80:81], v[80:81], v[14:15] op_sel:[0,1] op_sel_hi:[1,1]
    v_pk_mul_f32 v[82:83], v[82:83], v[14:15] op_sel:[0,1] op_sel_hi:[1,1]
    v_pk_mul_f32 v[76:77], v[76:77], v[14:15] op_sel:[0,0] op_sel_hi:[1,0]
    v_pk_mul_f32 v[78:79], v[78:79], v[14:15] op_sel:[0,0] op_sel_hi:[1,0]
    v_mov_b32 v44, v43
    s_setprio 2
    s_waitcnt vmcnt(7)
    ds_write_b128 v3, v[108:111] offset:0
    s_waitcnt lgkmcnt(4)
    v_cmpx_ne_u64 vcc, v[74:75], v[70:71]
    s_and_b64 s[82:83], vcc, s[80:81]
    s_cbranch_scc1 L2_c125
L2_d125:
    v_mov_b64 v[84:85], v[70:71]
    v_mov_b32 v7, v95
    v_mov_b64 v[86:87], v[74:75]
    s_mov_b64 exec, -1
    s_or_b64 s[80:81], s[80:81], vcc
    v_cmpx_ne_u64 vcc, v[72:73], v[68:69]
    s_and_b64 s[82:83], vcc, s[80:81]
    s_cbranch_scc1 L2_c126
L2_d126:
    v_mov_b64 v[84:85], v[68:69]
    v_mov_b32 v7, v94
    v_mov_b64 v[86:87], v[72:73]
    s_mov_b64 exec, -1
    s_or_b64 s[80:81], s[80:81], vcc
    ds_read_b64 v[70:71], v93
    s_and_b64 exec, s[84:85], s[80:81]
    v_mfma_f32_4x4x4_16b_bf16 v[76:79], v[12:13], v[84:85], 0
    v_mov_b32 v92, v7
    s_andn2_b64 s[80:81], s[80:81], s[84:85]
    v_mfma_f32_4x4x4_16b_bf16 v[76:79], v[10:11], v[86:87], v[76:79]
    s_mov_b64 exec, -1
    ds_read_b64 v[68:69], v92
    s_setprio 1
    s_waitcnt vmcnt(4)
    ds_write_b128 v3, v[112:115] offset:1024
    s_waitcnt lgkmcnt(1)
    v_mfma_f32_4x4x4_16b_bf16 v[80:83], v[10:11], v[70:71], v[80:83]
    v_mfma_f32_4x4x4_16b_bf16 v[76:79], v[10:11], v[68:69], v[76:79]
    v_and_b32 v46, 0x40000000, v39
    v_bitop3_b32 v94, v36, v5, v46 bitop3:0xea
    v_and_b32 v46, 0x80000000, v39
    v_bitop3_b32 v95, v37, v5, v46 bitop3:0xea
    v_perm_b32 v15, v37, v38, s47
    v_bitop3_b32 v46, v37, 0.5, -0.5 bitop3:0xa8
    v_perm_b32 v14, v36, v38, s46
    v_bitop3_b32 v47, v36, 0.5, -0.5 bitop3:0xa8
    v_cvt_pk_bf16_f32 v80, v80, v81
    v_cvt_pk_bf16_f32 v81, v82, v83
    ds_wrxchg_rtn_b64 v[74:75], v93, v[80:81]
    v_cvt_pk_bf16_f32 v76, v76, v77
    v_cvt_pk_bf16_f32 v77, v78, v79
    ds_wrxchg_rtn_b64 v[72:73], v92, v[76:77]
    s_setprio 0
    v_mfma_f32_4x4x4_16b_bf16 v[80:83], v[8:9], v[106:107], 0
    v_mfma_f32_4x4x4_16b_bf16 v[76:79], v[8:9], v[104:105], 0
    v_bitop3_b32 v15, v6, v15, v46 bitop3:0xca
    v_bitop3_b32 v14, v6, v14, v47 bitop3:0xca
    s_nop 1
    v_pk_mul_f32 v[80:81], v[80:81], v[14:15] op_sel:[0,1] op_sel_hi:[1,1]
    v_pk_mul_f32 v[82:83], v[82:83], v[14:15] op_sel:[0,1] op_sel_hi:[1,1]
    v_pk_mul_f32 v[76:77], v[76:77], v[14:15] op_sel:[0,0] op_sel_hi:[1,0]
    v_pk_mul_f32 v[78:79], v[78:79], v[14:15] op_sel:[0,0] op_sel_hi:[1,0]
    s_add_u32 s42, s42, 1
    s_waitcnt lgkmcnt(2)
    s_barrier
    s_bitcmp1_b32 s36, s42
    s_cbranch_scc1 L2_slow
L2_ret7:
    s_setprio 3
    v_and_b32 v47, 0x0fffffff, v44
    v_mov_b32 v39, v44
    buffer_load_dwordx4 v[34:37], v47, s[8:11], 0 offen
    buffer_load_dwordx3 v[36:38], v47, s[8:11], 0 offen offset:8
    s_waitcnt lgkmcnt(0)
    v_cmpx_ne_u64 vcc, v[74:75], v[70:71]
    s_and_b64 s[82:83], vcc, s[80:81]
    s_cbranch_scc1 L2_c127
L2_d127:
    v_mov_b64 v[84:85], v[70:71]
    v_mov_b32 v7, v93
    v_mov_b64 v[86:87], v[74:75]
    s_mov_b64 exec, -1
    s_or_b64 s[80:81], s[80:81], vcc
    v_cmpx_ne_u64 vcc, v[72:73], v[68:69]
    s_and_b64 s[82:83], vcc, s[80:81]
    s_cbranch_scc1 L2_c128
L2_d128:
    v_mov_b64 v[84:85], v[68:69]
    v_mov_b32 v7, v92
    v_mov_b64 v[86:87], v[72:73]
    s_mov_b64 exec, -1
    s_or_b64 s[80:81], s[80:81], vcc
    ds_read_b64 v[70:71], v95
    ds_read_b64 v[68:69], v94
    v_and_b32 v46, 0x20000000, v21
    v_lshrrev_b32 v47, 14, v17
    v_bitop3_b32 v47, v47, v5, v46 bitop3:0xea
    ds_read_b64 v[102:103], v47 offset:63616
    v_bitop3_b32 v93, v17, v5, v46 bitop3:0xea
    v_and_b32 v46, 0x10000000, v21
    v_lshrrev_b32 v47, 14, v16
    v_bitop3_b32 v47, v47, v5, v46 bitop3:0xea
    ds_read_b64 v[100:101], v47 offset:63616
    v_bitop3_b32 v92, v16, v5, v46 bitop3:0xea
    s_waitcnt lgkmcnt(2)
    v_mfma_f32_4x4x4_16b_bf16 v[80:83], v[10:11], v[70:71], v[80:83]
    v_mfma_f32_4x4x4_16b_bf16 v[76:79], v[10:11], v[68:69], v[76:79]
    v_perm_b32 v15, v17, v20, s45
    v_bitop3_b32 v46, v17, 0.5, -0.5 bitop3:0xa8
    v_perm_b32 v14, v16, v20, s44
    v_bitop3_b32 v47, v16, 0.5, -0.5 bitop3:0xa8
    v_cvt_pk_bf16_f32 v80, v80, v81
    v_cvt_pk_bf16_f32 v81, v82, v83
    ds_wrxchg_rtn_b64 v[74:75], v95, v[80:81]
    v_cvt_pk_bf16_f32 v76, v76, v77
    v_cvt_pk_bf16_f32 v77, v78, v79
    ds_wrxchg_rtn_b64 v[72:73], v94, v[76:77]
    s_waitcnt lgkmcnt(2)
    v_mfma_f32_4x4x4_16b_bf16 v[80:83], v[8:9], v[102:103], 0
    v_mfma_f32_4x4x4_16b_bf16 v[76:79], v[8:9], v[100:101], 0
    v_bitop3_b32 v15, v6, v15, v46 bitop3:0xca
    v_bitop3_b32 v14, v6, v14, v47 bitop3:0xca
    v_cmp_lt_u32 s[84:85], v5, v92
    s_nop 0
    v_pk_mul_f32 v[80:81], v[80:81], v[14:15] op_sel:[0,1] op_sel_hi:[1,1]
    v_pk_mul_f32 v[82:83], v[82:83], v[14:15] op_sel:[0,1] op_sel_hi:[1,1]
    v_pk_mul_f32 v[76:77], v[76:77], v[14:15] op_sel:[0,0] op_sel_hi:[1,0]
    v_pk_mul_f32 v[78:79], v[78:79], v[14:15] op_sel:[0,0] op_sel_hi:[1,0]
    s_waitcnt lgkmcnt(0)
    v_cmpx_ne_u64 vcc, v[74:75], v[70:71]
    s_and_b64 s[82:83], vcc, s[80:81]
    s_cbranch_scc1 L2_c129
L2_d129:
    v_mov_b64 v[84:85], v[70:71]
    v_mov_b32 v7, v95
    v_mov_b64 v[86:87], v[74:75]
    s_mov_b64 exec, -1
    s_or_b64 s[80:81], s[80:81], vcc
    v_cmpx_ne_u64 vcc, v[72:73], v[68:69]
    s_and_b64 s[82:83], vcc, s[80:81]
    s_cbranch_scc1 L2_c130
L2_d130:
    v_mov_b64 v[84:85], v[68:69]
    v_mov_b32 v7, v94
    v_mov_b64 v[86:87], v[72:73]
    s_mov_b64 exec, -1
    s_or_b64 s[80:81], s[80:81], vcc
    ds_read_b64 v[70:71], v93
    s_and_b64 exec, s[84:85], s[80:81]
    v_mfma_f32_4x4x4_16b_bf16 v[76:79], v[12:13], v[84:85], 0
    v_mov_b32 v92, v7
    s_andn2_b64 s[80:81], s[80:81], s[84:85]
    v_mfma_f32_4x4x4_16b_bf16 v[76:79], v[10:11], v[86:87], v[76:79]
    s_mov_b64 exec, -1
    ds_read_b64 v[68:69], v92
    v_and_b32 v46, 0x80000000, v21
    v_lshrrev_b32 v47, 14, v19
    v_bitop3_b32 v47, v47, v5, v46 bitop3:0xea
    ds_read_b64 v[106:107], v47 offset:63616
    v_bitop3_b32 v95, v19, v5, v46 bitop3:0xea
    v_and_b32 v46, 0x40000000, v21
    v_lshrrev_b32 v47, 14, v18
    v_bitop3_b32 v47, v47, v5, v46 bitop3:0xea
    ds_read_b64 v[104:105], v47 offset:63616
    v_bitop3_b32 v94, v18, v5, v46 bitop3:0xea
    s_waitcnt lgkmcnt(2)
    v_mfma_f32_4x4x4_16b_bf16 v[80:83], v[10:11], v[70:71], v[80:83]
    v_mfma_f32_4x4x4_16b_bf16 v[76:79], v[10:11], v[68:69], v[76:79]
    v_perm_b32 v15, v19, v20, s47
    v_bitop3_b32 v46, v19, 0.5, -0.5 bitop3:0xa8
    v_perm_b32 v14, v18, v20, s46
    v_bitop3_b32 v47, v18, 0.5, -0.5 bitop3:0xa8
    v_cvt_pk_bf16_f32 v80, v80, v81
    v_cvt_pk_bf16_f32 v81, v82, v83
    ds_wrxchg_rtn_b64 v[74:75], v93, v[80:81]
    v_cvt_pk_bf16_f32 v76, v76, v77
    v_cvt_pk_bf16_f32 v77, v78, v79
    ds_wrxchg_rtn_b64 v[72:73], v92, v[76:77]
    s_setprio 2
    s_waitcnt lgkmcnt(2)
    v_mfma_f32_4x4x4_16b_bf16 v[80:83], v[8:9], v[106:107], 0
    v_mfma_f32_4x4x4_16b_bf16 v[76:79], v[8:9], v[104:105], 0
    v_bitop3_b32 v15, v6, v15, v46 bitop3:0xca
    v_bitop3_b32 v14, v6, v14, v47 bitop3:0xca
    s_nop 1
    v_pk_mul_f32 v[80:81], v[80:81], v[14:15] op_sel:[0,1] op_sel_hi:[1,1]
    v_pk_mul_f32 v[82:83], v[82:83], v[14:15] op_sel:[0,1] op_sel_hi:[1,1]
    v_pk_mul_f32 v[76:77], v[76:77], v[14:15] op_sel:[0,0] op_sel_hi:[1,0]
    v_pk_mul_f32 v[78:79], v[78:79], v[14:15] op_sel:[0,0] op_sel_hi:[1,0]
    s_waitcnt lgkmcnt(0)
    v_cmpx_ne_u64 vcc, v[74:75], v[70:71]
    s_and_b64 s[82:83], vcc, s[80:81]
    s_cbranch_scc1 L2_c131
L2_d131:
    v_mov_b64 v[84:85], v[70:71]
    v_mov_b32 v7, v93
    v_mov_b64 v[86:87], v[74:75]
    s_mov_b64 exec, -1
    s_or_b64 s[80:81], s[80:81], vcc
    v_cmpx_ne_u64 vcc, v[72:73], v[68:69]
    s_and_b64 s[82:83], vcc, s[80:81]
    s_cbranch_scc1 L2_c132
L2_d132:
    v_mov_b64 v[84:85], v[68:69]
    v_mov_b32 v7, v92
    v_mov_b64 v[86:87], v[72:73]
    s_mov_b64 exec, -1
    s_or_b64 s[80:81], s[80:81], vcc
    ds_read_b64 v[70:71], v95
    ds_read_b64 v[68:69], v94
    s_waitcnt vmcnt(4)
    v_and_b32 v46, 0x20000000, v27
    v_lshrrev_b32 v47, 14, v23
    v_bitop3_b32 v47, v47, v5, v46 bitop3:0xea
    ds_read_b64 v[102:103], v47 offset:63616
    v_bitop3_b32 v93, v23, v5, v46 bitop3:0xea
    v_and_b32 v46, 0x10000000, v27
    v_lshrrev_b32 v47, 14, v22
    v_bitop3_b32 v47, v47, v5, v46 bitop3:0xea
    ds_read_b64 v[100:101], v47 offset:63616
    v_bitop3_b32 v92, v22, v5, v46 bitop3:0xea
    s_waitcnt lgkmcnt(2)
    v_mfma_f32_4x4x4_16b_bf16 v[80:83], v[10:11], v[70:71], v[80:83]
    v_mfma_f32_4x4x4_16b_bf16 v[76:79], v[10:11], v[68:69], v[76:79]
    v_perm_b32 v15, v23, v26, s45
    v_bitop3_b32 v46, v23, 0.5, -0.5 bitop3:0xa8
    v_perm_b32 v14, v22, v26, s44
    v_bitop3_b32 v47, v22, 0.5, -0.5 bitop3:0xa8
    v_cvt_pk_bf16_f32 v80, v80, v81
    v_cvt_pk_bf16_f32 v81, v82, v83
    ds_wrxchg_rtn_b64 v[74:75], v95, v[80:81]
    v_cvt_pk_bf16_f32 v76, v76, v77
    v_cvt_pk_bf16_f32 v77, v78, v79
    ds_wrxchg_rtn_b64 v[72:73], v94, v[76:77]
    s_waitcnt lgkmcnt(2)
    v_mfma_f32_4x4x4_16b_bf16 v[80:83], v[8:9], v[102:103], 0
    v_mfma_f32_4x4x4_16b_bf16 v[76:79], v[8:9], v[100:101], 0
    v_bitop3_b32 v15, v6, v15, v46 bitop3:0xca
    v_bitop3_b32 v14, v6, v14, v47 bitop3:0xca
    v_cmp_lt_u32 s[84:85], v5, v92
    s_nop 0
    v_pk_mul_f32 v[80:81], v[80:81], v[14:15] op_sel:[0,1] op_sel_hi:[1,1]
    v_pk_mul_f32 v[82:83], v[82:83], v[14:15] op_sel:[0,1] op_sel_hi:[1,1]
    v_pk_mul_f32 v[76:77], v[76:77], v[14:15] op_sel:[0,0] op_sel_hi:[1,0]
    v_pk_mul_f32 v[78:79], v[78:79], v[14:15] op_sel:[0,0] op_sel_hi:[1,0]
    s_waitcnt lgkmcnt(0)
    v_cmpx_ne_u64 vcc, v[74:75], v[70:71]
    s_and_b64 s[82:83], vcc, s[80:81]
    s_cbranch_scc1 L2_c133
L2_d133:
    v_mov_b64 v[84:85], v[70:71]
    v_mov_b32 v7, v95
    v_mov_b64 v[86:87], v[74:75]
    s_mov_b64 exec, -1
    s_or_b64 s[80:81], s[80:81], vcc
    v_cmpx_ne_u64 vcc, v[72:73], v[68:69]
    s_and_b64 s[82:83], vcc, s[80:81]
    s_cbranch_scc1 L2_c134
L2_d134:
    v_mov_b64 v[84:85], v[68:69]
    v_mov_b32 v7, v94
    v_mov_b64 v[86:87], v[72:73]
    s_mov_b64 exec, -1
    s_or_b64 s[80:81], s[80:81], vcc
    ds_read_b64 v[70:71], v93
    s_and_b64 exec, s[84:85], s[80:81]
    v_mfma_f32_4x4x4_16b_bf16 v[76:79], v[12:13], v[84:85], 0
    v_mov_b32 v92, v7
    s_andn2_b64 s[80:81], s[80:81], s[84:85]
    v_mfma_f32_4x4x4_16b_bf16 v[76:79], v[10:11], v[86:87], v[76:79]
    s_mov_b64 exec, -1
    ds_read_b64 v[68:69], v92
    v_and_b32 v46, 0x80000000, v27
    v_lshrrev_b32 v47, 14, v25
    v_bitop3_b32 v47, v47, v5, v46 bitop3:0xea
    ds_read_b64 v[106:107], v47 offset:63616
    v_bitop3_b32 v95, v25, v5, v46 bitop3:0xea
    v_and_b32 v46, 0x40000000, v27
    v_lshrrev_b32 v47, 14, v24
    v_bitop3_b32 v47, v47, v5, v46 bitop3:0xea
    ds_read_b64 v[104:105], v47 offset:63616
    v_bitop3_b32 v94, v24, v5, v46 bitop3:0xea
    s_waitcnt lgkmcnt(2)
    v_mfma_f32_4x4x4_16b_bf16 v[80:83], v[10:11], v[70:71], v[80:83]
    v_mfma_f32_4x4x4_16b_bf16 v[76:79], v[10:11], v[68:69], v[76:79]
    v_perm_b32 v15, v25, v26, s47
    v_bitop3_b32 v46, v25, 0.5, -0.5 bitop3:0xa8
    v_perm_b32 v14, v24, v26, s46
    v_bitop3_b32 v47, v24, 0.5, -0.5 bitop3:0xa8
    v_cvt_pk_bf16_f32 v80, v80, v81
    v_cvt_pk_bf16_f32 v81, v82, v83
    ds_wrxchg_rtn_b64 v[74:75], v93, v[80:81]
    v_cvt_pk_bf16_f32 v76, v76, v77
    v_cvt_pk_bf16_f32 v77, v78, v79
    ds_wrxchg_rtn_b64 v[72:73], v92, v[76:77]
    s_setprio 1
    s_waitcnt lgkmcnt(2)
    v_mfma_f32_4x4x4_16b_bf16 v[80:83], v[8:9], v[106:107], 0
    v_mfma_f32_4x4x4_16b_bf16 v[76:79], v[8:9], v[104:105], 0
    v_bitop3_b32 v15, v6, v15, v46 bitop3:0xca
    v_bitop3_b32 v14, v6, v14, v47 bitop3:0xca
    s_nop 1
    v_pk_mul_f32 v[80:81], v[80:81], v[14:15] op_sel:[0,1] op_sel_hi:[1,1]
    v_pk_mul_f32 v[82:83], v[82:83], v[14:15] op_sel:[0,1] op_sel_hi:[1,1]
    v_pk_mul_f32 v[76:77], v[76:77], v[14:15] op_sel:[0,0] op_sel_hi:[1,0]
    v_pk_mul_f32 v[78:79], v[78:79], v[14:15] op_sel:[0,0] op_sel_hi:[1,0]
    s_waitcnt lgkmcnt(0)
    v_cmpx_ne_u64 vcc, v[74:75], v[70:71]
    s_and_b64 s[82:83], vcc, s[80:81]
    s_cbranch_scc1 L2_c135
L2_d135:
    v_mov_b64 v[84:85], v[70:71]
    v_mov_b32 v7, v93
    v_mov_b64 v[86:87], v[74:75]
    s_mov_b64 exec, -1
    s_or_b64 s[80:81], s[80:81], vcc
    v_cmpx_ne_u64 vcc, v[72:73], v[68:69]
    s_and_b64 s[82:83], vcc, s[80:81]
    s_cbranch_scc1 L2_c136
L2_d136:
    v_mov_b64 v[84:85], v[68:69]
    v_mov_b32 v7, v92
    v_mov_b64 v[86:87], v[72:73]
    s_mov_b64 exec, -1
    s_or_b64 s[80:81], s[80:81], vcc
    ds_read_b64 v[70:71], v95
    ds_read_b64 v[68:69], v94
    s_waitcnt vmcnt(2)
    v_and_b32 v46, 0x20000000, v33
    v_lshrrev_b32 v47, 14, v29
    v_bitop3_b32 v47, v47, v5, v46 bitop3:0xea
    ds_read_b64 v[102:103], v47 offset:63616
    v_bitop3_b32 v93, v29, v5, v46 bitop3:0xea
    v_and_b32 v46, 0x10000000, v33
    v_lshrrev_b32 v47, 14, v28
    v_bitop3_b32 v47, v47, v5, v46 bitop3:0xea
    ds_read_b64 v[100:101], v47 offset:63616
    v_bitop3_b32 v92, v28, v5, v46 bitop3:0xea
    s_waitcnt lgkmcnt(2)
    v_mfma_f32_4x4x4_16b_bf16 v[80:83], v[10:11], v[70:71], v[80:83]
    v_mfma_f32_4x4x4_16b_bf16 v[76:79], v[10:11], v[68:69], v[76:79]
    v_perm_b32 v15, v29, v32, s45
    v_bitop3_b32 v46, v29, 0.5, -0.5 bitop3:0xa8
    v_perm_b32 v14, v28, v32, s44
    v_bitop3_b32 v47, v28, 0.5, -0.5 bitop3:0xa8
    v_cvt_pk_bf16_f32 v80, v80, v81
    v_cvt_pk_bf16_f32 v81, v82, v83
    ds_wrxchg_rtn_b64 v[74:75], v95, v[80:81]
    v_cvt_pk_bf16_f32 v76, v76, v77
    v_cvt_pk_bf16_f32 v77, v78, v79
    ds_wrxchg_rtn_b64 v[72:73], v94, v[76:77]
    s_waitcnt lgkmcnt(2)
    v_mfma_f32_4x4x4_16b_bf16 v[80:83], v[8:9], v[102:103], 0
    v_mfma_f32_4x4x4_16b_bf16 v[76:79], v[8:9], v[100:101], 0
    v_bitop3_b32 v15, v6, v15, v46 bitop3:0xca
    v_bitop3_b32 v14, v6, v14, v47 bitop3:0xca
    v_cmp_lt_u32 s[84:85], v5, v92
    s_nop 0
    v_pk_mul_f32 v[80:81], v[80:81], v[14:15] op_sel:[0,1] op_sel_hi:[1,1]
    v_pk_mul_f32 v[82:83], v[82:83], v[14:15] op_sel:[0,1] op_sel_hi:[1,1]
    v_pk_mul_f32 v[76:77], v[76:77], v[14:15] op_sel:[0,0] op_sel_hi:[1,0]
    v_pk_mul_f32 v[78:79], v[78:79], v[14:15] op_sel:[0,0] op_sel_hi:[1,0]
    s_waitcnt lgkmcnt(0)
    v_cmpx_ne_u64 vcc, v[74:75], v[70:71]
    s_and_b64 s[82:83], vcc, s[80:81]
    s_cbranch_scc1 L2_c137
L2_d137:
    v_mov_b64 v[84:85], v[70:71]
    v_mov_b32 v7, v95
    v_mov_b64 v[86:87], v[74:75]
    s_mov_b64 exec, -1
    s_or_b64 s[80:81], s[80:81], vcc
    v_cmpx_ne_u64 vcc, v[72:73], v[68:69]
    s_and_b64 s[82:83], vcc, s[80:81]
    s_cbranch_scc1 L2_c138
L2_d138:
    v_mov_b64 v[84:85], v[68:69]
    v_mov_b32 v7, v94
    v_mov_b64 v[86:87], v[72:73]
    s_mov_b64 exec, -1
    s_or_b64 s[80:81], s[80:81], vcc
    ds_read_b64 v[70:71], v93
    s_and_b64 exec, s[84:85], s[80:81]
    v_mfma_f32_4x4x4_16b_bf16 v[76:79], v[12:13], v[84:85], 0
    v_mov_b32 v92, v7
    s_andn2_b64 s[80:81], s[80:81], s[84:85]
    v_mfma_f32_4x4x4_16b_bf16 v[76:79], v[10:11], v[86:87], v[76:79]
    s_mov_b64 exec, -1
    ds_read_b64 v[68:69], v92
    v_and_b32 v46, 0x80000000, v33
    v_lshrrev_b32 v47, 14, v31
    v_bitop3_b32 v47, v47, v5, v46 bitop3:0xea
    ds_read_b64 v[106:107], v47 offset:63616
    v_bitop3_b32 v95, v31, v5, v46 bitop3:0xea
    v_and_b32 v46, 0x40000000, v33
    v_lshrrev_b32 v47, 14, v30
    v_bitop3_b32 v47, v47, v5, v46 bitop3:0xea
    ds_read_b64 v[104:105], v47 offset:63616
    v_bitop3_b32 v94, v30, v5, v46 bitop3:0xea
    s_waitcnt lgkmcnt(2)
    v_mfma_f32_4x4x4_16b_bf16 v[80:83], v[10:11], v[70:71], v[80:83]
    v_mfma_f32_4x4x4_16b_bf16 v[76:79], v[10:11], v[68:69], v[76:79]
    v_perm_b32 v15, v31, v32, s47
    v_bitop3_b32 v46, v31, 0.5, -0.5 bitop3:0xa8
    v_perm_b32 v14, v30, v32, s46
    v_bitop3_b32 v47, v30, 0.5, -0.5 bitop3:0xa8
    v_cvt_pk_bf16_f32 v80, v80, v81
    v_cvt_pk_bf16_f32 v81, v82, v83
    ds_wrxchg_rtn_b64 v[74:75], v93, v[80:81]
    v_cvt_pk_bf16_f32 v76, v76, v77
    v_cvt_pk_bf16_f32 v77, v78, v79
    ds_wrxchg_rtn_b64 v[72:73], v92, v[76:77]
    s_setprio 0
    s_waitcnt lgkmcnt(2)
    v_mfma_f32_4x4x4_16b_bf16 v[80:83], v[8:9], v[106:107], 0
    v_mfma_f32_4x4x4_16b_bf16 v[76:79], v[8:9], v[104:105], 0
    v_bitop3_b32 v15, v6, v15, v46 bitop3:0xca
    v_bitop3_b32 v14, v6, v14, v47 bitop3:0xca
    s_nop 1
    v_pk_mul_f32 v[80:81], v[80:81], v[14:15] op_sel:[0,1] op_sel_hi:[1,1]
    v_pk_mul_f32 v[82:83], v[82:83], v[14:15] op_sel:[0,1] op_sel_hi:[1,1]
    v_pk_mul_f32 v[76:77], v[76:77], v[14:15] op_sel:[0,0] op_sel_hi:[1,0]
    v_pk_mul_f32 v[78:79], v[78:79], v[14:15] op_sel:[0,0] op_sel_hi:[1,0]
    s_waitcnt lgkmcnt(0)
    v_cmpx_ne_u64 vcc, v[74:75], v[70:71]
    s_and_b64 s[82:83], vcc, s[80:81]
    s_cbranch_scc1 L2_c139
L2_d139:
    v_mov_b64 v[84:85], v[70:71]
    v_mov_b32 v7, v93
    v_mov_b64 v[86:87], v[74:75]
    s_mov_b64 exec, -1
    s_or_b64 s[80:81], s[80:81], vcc
    v_cmpx_ne_u64 vcc, v[72:73], v[68:69]
    s_and_b64 s[82:83], vcc, s[80:81]
    s_cbranch_scc1 L2_c140
L2_d140:
    v_mov_b64 v[84:85], v[68:69]
    v_mov_b32 v7, v92
    v_mov_b64 v[86:87], v[72:73]
    s_mov_b64 exec, -1
    s_or_b64 s[80:81], s[80:81], vcc
    ds_read_b64 v[70:71], v95
    ds_read_b64 v[68:69], v94
    s_waitcnt vmcnt(0)
    v_and_b32 v46, 0x20000000, v39
    v_lshrrev_b32 v47, 14, v35
    v_bitop3_b32 v47, v47, v5, v46 bitop3:0xea
    ds_read_b64 v[102:103], v47 offset:63616
    v_bitop3_b32 v93, v35, v5, v46 bitop3:0xea
    v_and_b32 v46, 0x10000000, v39
    v_lshrrev_b32 v47, 14, v34
    v_bitop3_b32 v47, v47, v5, v46 bitop3:0xea
    ds_read_b64 v[100:101], v47 offset:63616
    v_bitop3_b32 v92, v34, v5, v46 bitop3:0xea
    v_and_b32 v46, 0x80000000, v39
    v_lshrrev_b32 v47, 14, v37
    v_bitop3_b32 v47, v47, v5, v46 bitop3:0xea
    ds_read_b64 v[106:107], v47 offset:63616
    v_and_b32 v46, 0x40000000, v39
    v_lshrrev_b32 v47, 14, v36
    v_bitop3_b32 v47, v47, v5, v46 bitop3:0xea
    ds_read_b64 v[104:105], v47 offset:63616
    s_waitcnt lgkmcnt(4)
    v_mfma_f32_4x4x4_16b_bf16 v[80:83], v[10:11], v[70:71], v[80:83]
    v_mfma_f32_4x4x4_16b_bf16 v[76:79], v[10:11], v[68:69], v[76:79]
    v_perm_b32 v15, v35, v38, s45
    v_bitop3_b32 v46, v35, 0.5, -0.5 bitop3:0xa8
    v_perm_b32 v14, v34, v38, s44
    v_bitop3_b32 v47, v34, 0.5, -0.5 bitop3:0xa8
    v_cvt_pk_bf16_f32 v80, v80, v81
    v_cvt_pk_bf16_f32 v81, v82, v83
    ds_wrxchg_rtn_b64 v[74:75], v95, v[80:81]
    v_cvt_pk_bf16_f32 v76, v76, v77
    v_cvt_pk_bf16_f32 v77, v78, v79
    ds_wrxchg_rtn_b64 v[72:73], v94, v[76:77]
    s_waitcnt lgkmcnt(4)
    v_mfma_f32_4x4x4_16b_bf16 v[80:83], v[8:9], v[102:103], 0
    v_mfma_f32_4x4x4_16b_bf16 v[76:79], v[8:9], v[100:101], 0
    v_bitop3_b32 v15, v6, v15, v46 bitop3:0xca
    v_bitop3_b32 v14, v6, v14, v47 bitop3:0xca
    v_cmp_lt_u32 s[84:85], v5, v92
    s_nop 0
    v_pk_mul_f32 v[80:81], v[80:81], v[14:15] op_sel:[0,1] op_sel_hi:[1,1]
    v_pk_mul_f32 v[82:83], v[82:83], v[14:15] op_sel:[0,1] op_sel_hi:[1,1]
    v_pk_mul_f32 v[76:77], v[76:77], v[14:15] op_sel:[0,0] op_sel_hi:[1,0]
    v_pk_mul_f32 v[78:79], v[78:79], v[14:15] op_sel:[0,0] op_sel_hi:[1,0]
    s_waitcnt lgkmcnt(0)
    v_cmpx_ne_u64 vcc, v[74:75], v[70:71]
    s_and_b64 s[82:83], vcc, s[80:81]
    s_cbranch_scc1 L2_c141
L2_d141:
    v_mov_b64 v[84:85], v[70:71]
    v_mov_b32 v7, v95
    v_mov_b64 v[86:87], v[74:75]
    s_mov_b64 exec, -1
    s_or_b64 s[80:81], s[80:81], vcc
    v_cmpx_ne_u64 vcc, v[72:73], v[68:69]
    s_and_b64 s[82:83], vcc, s[80:81]
    s_cbranch_scc1 L2_c142
L2_d142:
    v_mov_b64 v[84:85], v[68:69]
    v_mov_b32 v7, v94
    v_mov_b64 v[86:87], v[72:73]
    s_mov_b64 exec, -1
    s_or_b64 s[80:81], s[80:81], vcc
    ds_read_b64 v[70:71], v93
    s_and_b64 exec, s[84:85], s[80:81]
    v_mfma_f32_4x4x4_16b_bf16 v[76:79], v[12:13], v[84:85], 0
    v_mov_b32 v92, v7
    s_andn2_b64 s[80:81], s[80:81], s[84:85]
    v_mfma_f32_4x4x4_16b_bf16 v[76:79], v[10:11], v[86:87], v[76:79]
    s_mov_b64 exec, -1
    ds_read_b64 v[68:69], v92
    s_waitcnt lgkmcnt(0)
    v_mfma_f32_4x4x4_16b_bf16 v[80:83], v[10:11], v[70:71], v[80:83]
    v_mfma_f32_4x4x4_16b_bf16 v[76:79], v[10:11], v[68:69], v[76:79]
    v_and_b32 v46, 0x40000000, v39
    v_bitop3_b32 v94, v36, v5, v46 bitop3:0xea
    v_and_b32 v46, 0x80000000, v39
    v_bitop3_b32 v95, v37, v5, v46 bitop3:0xea
    v_perm_b32 v15, v37, v38, s47
    v_bitop3_b32 v46, v37, 0.5, -0.5 bitop3:0xa8
    v_perm_b32 v14, v36, v38, s46
    v_bitop3_b32 v47, v36, 0.5, -0.5 bitop3:0xa8
    v_cvt_pk_bf16_f32 v80, v80, v81
    v_cvt_pk_bf16_f32 v81, v82, v83
    ds_wrxchg_rtn_b64 v[74:75], v93, v[80:81]
    v_cvt_pk_bf16_f32 v76, v76, v77
    v_cvt_pk_bf16_f32 v77, v78, v79
    ds_wrxchg_rtn_b64 v[72:73], v92, v[76:77]
    v_mfma_f32_4x4x4_16b_bf16 v[80:83], v[8:9], v[106:107], 0
    v_mfma_f32_4x4x4_16b_bf16 v[76:79], v[8:9], v[104:105], 0
    v_bitop3_b32 v15, v6, v15, v46 bitop3:0xca
    v_bitop3_b32 v14, v6, v14, v47 bitop3:0xca
    s_nop 1
    v_pk_mul_f32 v[80:81], v[80:81], v[14:15] op_sel:[0,1] op_sel_hi:[1,1]
    v_pk_mul_f32 v[82:83], v[82:83], v[14:15] op_sel:[0,1] op_sel_hi:[1,1]
    v_pk_mul_f32 v[76:77], v[76:77], v[14:15] op_sel:[0,0] op_sel_hi:[1,0]
    v_pk_mul_f32 v[78:79], v[78:79], v[14:15] op_sel:[0,0] op_sel_hi:[1,0]
    s_waitcnt lgkmcnt(0)
    v_cmpx_ne_u64 vcc, v[74:75], v[70:71]
    s_and_b64 s[82:83], vcc, s[80:81]
    s_cbranch_scc1 L2_c143
L2_d143:
    v_mov_b64 v[84:85], v[70:71]
    v_mov_b32 v7, v93
    v_mov_b64 v[86:87], v[74:75]
    s_mov_b64 exec, -1
    s_or_b64 s[80:81], s[80:81], vcc
    v_cmpx_ne_u64 vcc, v[72:73], v[68:69]
    s_and_b64 s[82:83], vcc, s[80:81]
    s_cbranch_scc1 L2_c144
L2_d144:
    v_mov_b64 v[84:85], v[68:69]
    v_mov_b32 v7, v92
    v_mov_b64 v[86:87], v[72:73]
    s_mov_b64 exec, -1
    s_or_b64 s[80:81], s[80:81], vcc
    ds_read_b64 v[70:71], v95
    ds_read_b64 v[68:69], v94
    s_waitcnt lgkmcnt(0)
    v_mfma_f32_4x4x4_16b_bf16 v[80:83], v[10:11], v[70:71], v[80:83]
    v_mfma_f32_4x4x4_16b_bf16 v[76:79], v[10:11], v[68:69], v[76:79]
    s_nop 3
    v_cvt_pk_bf16_f32 v80, v80, v81
    v_cvt_pk_bf16_f32 v81, v82, v83
    ds_wrxchg_rtn_b64 v[74:75], v95, v[80:81]
    v_cvt_pk_bf16_f32 v76, v76, v77
    v_cvt_pk_bf16_f32 v77, v78, v79
    ds_wrxchg_rtn_b64 v[72:73], v94, v[76:77]
    s_waitcnt lgkmcnt(0)
    v_cmpx_ne_u64 vcc, v[74:75], v[70:71]
    s_and_b64 s[82:83], vcc, s[80:81]
    s_cbranch_scc1 L2_c145
L2_d145:
    v_mov_b64 v[84:85], v[70:71]
    v_mov_b32 v7, v95
    v_mov_b64 v[86:87], v[74:75]
    s_mov_b64 exec, -1
    s_or_b64 s[80:81], s[80:81], vcc
    v_cmpx_ne_u64 vcc, v[72:73], v[68:69]
    s_and_b64 s[82:83], vcc, s[80:81]
    s_cbranch_scc1 L2_c146
L2_d146:
    v_mov_b64 v[84:85], v[68:69]
    v_mov_b32 v7, v94
    v_mov_b64 v[86:87], v[72:73]
    s_mov_b64 exec, -1
    s_or_b64 s[80:81], s[80:81], vcc
    s_mov_b64 exec, s[80:81]
    s_nop 1
    v_mfma_f32_4x4x4_16b_bf16 v[88:91], v[12:13], v[84:85], 0
    s_nop 1
    v_mfma_f32_4x4x4_16b_bf16 v[88:91], v[10:11], v[86:87], v[88:91]
    s_nop 4
    v_cvt_pk_bf16_f32 v88, v88, v89
    v_cvt_pk_bf16_f32 v89, v90, v91
    ds_pk_add_bf16 v7, v88
    ds_pk_add_bf16 v7, v89 offset:4
    s_mov_b64 exec, -1
    s_lshl_b32 s3, s32, 12
    s_add_u32 s3, s3, 80000
    s_waitcnt vmcnt(0) lgkmcnt(0)
    s_barrier
    v_subrev_u32 v16, s3, v3
    v_add_u32 v17, 16384, v16
    v_add_u32 v18, 32768, v16
    v_add_u32 v19, 49152, v16
    v_add_u32 v20, 65536, v16
    ds_read_b128 v[48:51], v16
    ds_read_b128 v[52:55], v17
    ds_read_b128 v[56:59], v18
    ds_read_b128 v[60:63], v19
    ds_read_b128 v[64:67], v20
    s_waitcnt lgkmcnt(4)
    buffer_store_dwordx4 v[48:51], v16, s[20:23], 0 offen sc1
    s_waitcnt lgkmcnt(3)
    buffer_store_dwordx4 v[52:55], v17, s[20:23], 0 offen sc1
    s_waitcnt lgkmcnt(2)
    buffer_store_dwordx4 v[56:59], v18, s[20:23], 0 offen sc1
    s_waitcnt lgkmcnt(1)
    buffer_store_dwordx4 v[60:63], v19, s[20:23], 0 offen sc1
    s_waitcnt lgkmcnt(0)
    buffer_store_dwordx4 v[64:67], v20, s[20:23], 0 offen sc1
L2_end:
    s_endpgm
L2_slow:
    s_lshr_b32 s35, s42, 2
    s_mul_i32 s50, s32, 80
    s_add_u32 s57, s50, 80
    s_and_b32 s3, s42, 3
    s_lshl_b32 s53, s3, 3
    s_add_u32 s53, s53, s39
    s_and_b32 s3, s35, 2
    s_lshl_b32 s3, s3, 1
    s_add_u32 s53, s53, s3
    s_and_b32 s54, s35, 1
    s_lshl_b32 s54, s54, 4
L2_sl_seg:
    s_mul_i32 s56, s50, 173056
    s_add_u32 s3, s56, s53
    s_add_u32 s55, s3, 32
    s_buffer_load_dword s51, s[12:15], s3
    s_buffer_load_dword s52, s[12:15], s55
    s_waitcnt lgkmcnt(0)
    s_lshr_b32 s51, s51, s54
    s_and_b32 s51, s51, 0xffff
    s_lshr_b32 s52, s52, s54
    s_and_b32 s52, s52, 0xffff
L2_sl_rec:
    s_cmp_ge_u32 s51, s52
    s_cbranch_scc1 L2_sl_next
    v_mbcnt_lo_u32_b32 v102, -1, 0
    v_mbcnt_hi_u32_b32 v102, -1, v102
    v_add_u32 v102, s51, v102
    v_and_b32 v103, -4, v102
    v_lshl_add_u32 v104, v102, 2, v103
    v_lshl_add_u32 v105, v103, 2, v102
    v_cmp_gt_u32 vcc, s52, v102
    s_mov_b64 exec, vcc
    buffer_load_dword v106, v104, s[8:11], s56 offen
    buffer_load_ubyte v107, v105, s[8:11], s56 offen offset:16
    s_waitcnt vmcnt(0)
    v_lshrrev_b32 v98, 14, v106
    v_and_b32 v98, v5, v98
    ds_read_b64 v[100:101], v98 offset:63616
    v_perm_b32 v97, v106, v107, s44
    v_and_b32 v96, v5, v106
    v_bitop3_b32 v103, v106, 0.5, -0.5 bitop3:0xa8
    v_bitop3_b32 v97, v6, v97, v103 bitop3:0xca
    s_waitcnt lgkmcnt(0)
    v_mfma_f32_4x4x4_16b_bf16 v[88:91], v[8:9], v[100:101], 0
    s_nop 4
    v_mul_f32 v88, v97, v88
    v_mul_f32 v89, v97, v89
    v_mul_f32 v90, v97, v90
    v_mul_f32 v91, v97, v91
    v_cvt_pk_bf16_f32 v88, v88, v89
    v_cvt_pk_bf16_f32 v89, v90, v91
    ds_pk_add_bf16 v96, v88
    ds_pk_add_bf16 v96, v89 offset:4
    s_mov_b64 exec, -1
    s_add_u32 s51, s51, 64
    s_branch L2_sl_rec
L2_sl_next:
    s_add_u32 s50, s50, 1
    s_cmp_lt_u32 s50, s57
    s_cbranch_scc1 L2_sl_seg
    s_waitcnt lgkmcnt(0)
    s_cmp_eq_u32 s42, 0
    s_cbranch_scc1 L2_ret0
    s_cmp_eq_u32 s42, 1
    s_cbranch_scc1 L2_ret1
    s_cmp_eq_u32 s42, 14
    s_cbranch_scc1 L2_ret6
    s_cmp_eq_u32 s42, 15
    s_cbranch_scc1 L2_ret7
    s_and_b32 s3, s42, 3
    s_cmp_eq_u32 s3, 2
    s_cbranch_scc1 L2_ret2
    s_cmp_eq_u32 s3, 3
    s_cbranch_scc1 L2_ret3
    s_cmp_eq_u32 s3, 0
    s_cbranch_scc1 L2_ret4
    s_branch L2_ret5
L2_xo1:
    v_cmp_lt_u32 vcc, 20, v99
    s_mov_b32 s43, 1
    s_cbranch_vccz L2_xp1
    v_cmp_lt_u32 vcc, 32, v99
    v_cmp_lt_u32 s[58:59], 31, v88
    s_mov_b32 s43, 2
    s_or_b64 vcc, vcc, s[58:59]
    s_cbranch_scc0 L2_xp1
    s_mov_b32 s37, 0x10000
    s_branch L2_xp1
L2_xa2:
    s_cmp_eq_u32 s43, 1
    s_cbranch_scc1 L2_xc2
    v_lshlrev_b32 v89, 0, v96
    v_add_u32 v90, 140, v97
    v_bitop3_b32 v90, v89, v45, v90 bitop3:0x6a
    ds_write_b32 v98, v90 offset:28
    v_lshlrev_b32 v89, 4, v96
    v_add_u32 v90, 120, v97
    v_bitop3_b32 v90, v89, v45, v90 bitop3:0x6a
    ds_write_b32 v98, v90 offset:24
    v_lshlrev_b32 v89, 8, v96
    v_add_u32 v90, 100, v97
    v_bitop3_b32 v90, v89, v45, v90 bitop3:0x6a
    ds_write_b32 v98, v90 offset:20
L2_xc2:
    v_lshlrev_b32 v89, 12, v96
    v_add_u32 v90, 80, v97
    v_bitop3_b32 v90, v89, v45, v90 bitop3:0x6a
    ds_write_b32 v98, v90 offset:16
    s_branch L2_xb2
L2_xe2:
    v_cmp_lt_u32 vcc, 32, v99
    v_cmp_lt_u32 s[58:59], 31, v88
    v_lshrrev_b32 v89, 16, v96
    v_add_u32 v97, 80, v97
    s_or_b64 vcc, vcc, s[58:59]
    s_cbranch_scc1 L2_xs2
    v_lshlrev_b32 v89, v1, v89
    v_and_b32 v89, v45, v89
    v_cmp_ne_u32 vcc, 0, v89
    v_xor_b32 v90, v97, v89
    s_add_u32 s3, s37, s38
    v_mbcnt_lo_u32_b32 v98, vcc_lo, 0
    v_mbcnt_hi_u32_b32 v98, vcc_hi, v98
    s_bcnt1_i32_b64 s41, vcc
    v_lshl_add_u32 v98, v98, 2, s3
    s_mov_b64 exec, vcc
    ds_write_b32 v98, v90
    s_mov_b64 exec, -1
    s_lshl2_add_u32 s37, s41, s37
    s_branch L2_xr2
L2_xf2:
    s_waitcnt lgkmcnt(0)
    s_cmp_gt_u32 s37, 1024
    s_cbranch_scc1 L2_xs2
    v_mov_b32 v43, -1
    s_cmp_ge_u32 s37, 512
    s_cbranch_scc1 L2_xg2
    v_mov_b32 v42, -1
    s_cmp_ge_u32 s37, 256
    s_cbranch_scc1 L2_xg2
    v_mov_b32 v41, -1
    s_branch L2_xg2
L2_xs2:
    s_waitcnt lgkmcnt(0)
    v_mov_b32 v40, -1
    v_mov_b32 v41, -1
    v_mov_b32 v42, -1
    v_mov_b32 v43, -1
    s_add_u32 s3, s42, 0
    s_bitset1_b32 s36, s3
    s_branch L2_xg2
L2_xo3:
    v_cmp_lt_u32 vcc, 20, v99
    s_mov_b32 s43, 1
    s_cbranch_vccz L2_xp3
    v_cmp_lt_u32 vcc, 32, v99
    v_cmp_lt_u32 s[58:59], 31, v88
    s_mov_b32 s43, 2
    s_or_b64 vcc, vcc, s[58:59]
    s_cbranch_scc0 L2_xp3
    s_mov_b32 s37, 0x10000
    s_branch L2_xp3
L2_xa4:
    s_cmp_eq_u32 s43, 1
    s_cbranch_scc1 L2_xc4
    v_lshlrev_b32 v89, 0, v96
    v_add_u32 v90, 140, v97
    v_bitop3_b32 v90, v89, v45, v90 bitop3:0x6a
    ds_write_b32 v98, v90 offset:28
    v_lshlrev_b32 v89, 4, v96
    v_add_u32 v90, 120, v97
    v_bitop3_b32 v90, v89, v45, v90 bitop3:0x6a
    ds_write_b32 v98, v90 offset:24
    v_lshlrev_b32 v89, 8, v96
    v_add_u32 v90, 100, v97
    v_bitop3_b32 v90, v89, v45, v90 bitop3:0x6a
    ds_write_b32 v98, v90 offset:20
L2_xc4:
    v_lshlrev_b32 v89, 12, v96
    v_add_u32 v90, 80, v97
    v_bitop3_b32 v90, v89, v45, v90 bitop3:0x6a
    ds_write_b32 v98, v90 offset:16
    s_branch L2_xb4
L2_xe4:
    v_cmp_lt_u32 vcc, 32, v99
    v_cmp_lt_u32 s[58:59], 31, v88
    v_lshrrev_b32 v89, 16, v96
    v_add_u32 v97, 80, v97
    s_or_b64 vcc, vcc, s[58:59]
    s_cbranch_scc1 L2_xs4
    v_lshlrev_b32 v89, v1, v89
    v_and_b32 v89, v45, v89
    v_cmp_ne_u32 vcc, 0, v89
    v_xor_b32 v90, v97, v89
    s_add_u32 s3, s37, s38
    v_mbcnt_lo_u32_b32 v98, vcc_lo, 0
    v_mbcnt_hi_u32_b32 v98, vcc_hi, v98
    s_bcnt1_i32_b64 s41, vcc
    v_lshl_add_u32 v98, v98, 2, s3
    s_mov_b64 exec, vcc
    ds_write_b32 v98, v90
    s_mov_b64 exec, -1
    s_lshl2_add_u32 s37, s41, s37
    s_branch L2_xr4
L2_xf4:
    s_waitcnt lgkmcnt(0)
    s_cmp_gt_u32 s37, 1024
    s_cbranch_scc1 L2_xs4
    v_mov_b32 v43, -1
    s_cmp_ge_u32 s37, 512
    s_cbranch_scc1 L2_xg4
    v_mov_b32 v42, -1
    s_cmp_ge_u32 s37, 256
    s_cbranch_scc1 L2_xg4
    v_mov_b32 v41, -1
    s_branch L2_xg4
L2_xs4:
    s_waitcnt lgkmcnt(0)
    v_mov_b32 v40, -1
    v_mov_b32 v41, -1
    v_mov_b32 v42, -1
    v_mov_b32 v43, -1
    s_add_u32 s3, s42, 1
    s_bitset1_b32 s36, s3
    s_branch L2_xg4
L2_c5:
    s_mov_b64 exec, s[82:83]
    s_nop 1
    v_mfma_f32_4x4x4_16b_bf16 v[88:91], v[12:13], v[84:85], 0
    s_nop 1
    v_mfma_f32_4x4x4_16b_bf16 v[88:91], v[10:11], v[86:87], v[88:91]
    s_nop 4
    v_cvt_pk_bf16_f32 v88, v88, v89
    v_cvt_pk_bf16_f32 v89, v90, v91
    ds_pk_add_bf16 v7, v88
    ds_pk_add_bf16 v7, v89 offset:4
    s_mov_b64 exec, vcc
    s_branch L2_d5
L2_c6:
    s_mov_b64 exec, s[82:83]
    s_nop 1
    v_mfma_f32_4x4x4_16b_bf16 v[88:91], v[12:13], v[84:85], 0
    s_nop 1
    v_mfma_f32_4x4x4_16b_bf16 v[88:91], v[10:11], v[86:87], v[88:91]
    s_nop 4
    v_cvt_pk_bf16_f32 v88, v88, v89
    v_cvt_pk_bf16_f32 v89, v90, v91
    ds_pk_add_bf16 v7, v88
    ds_pk_add_bf16 v7, v89 offset:4
    s_mov_b64 exec, vcc
    s_branch L2_d6
L2_c7:
    s_mov_b64 exec, s[82:83]
    s_nop 1
    v_mfma_f32_4x4x4_16b_bf16 v[88:91], v[12:13], v[84:85], 0
    s_nop 1
    v_mfma_f32_4x4x4_16b_bf16 v[88:91], v[10:11], v[86:87], v[88:91]
    s_nop 4
    v_cvt_pk_bf16_f32 v88, v88, v89
    v_cvt_pk_bf16_f32 v89, v90, v91
    ds_pk_add_bf16 v7, v88
    ds_pk_add_bf16 v7, v89 offset:4
    s_mov_b64 exec, vcc
    s_branch L2_d7
L2_c8:
    s_mov_b64 exec, s[82:83]
    s_nop 1
    v_mfma_f32_4x4x4_16b_bf16 v[88:91], v[12:13], v[84:85], 0
    s_nop 1
    v_mfma_f32_4x4x4_16b_bf16 v[88:91], v[10:11], v[86:87], v[88:91]
    s_nop 4
    v_cvt_pk_bf16_f32 v88, v88, v89
    v_cvt_pk_bf16_f32 v89, v90, v91
    ds_pk_add_bf16 v7, v88
    ds_pk_add_bf16 v7, v89 offset:4
    s_mov_b64 exec, vcc
    s_branch L2_d8
L2_xo9:
    v_cmp_lt_u32 vcc, 20, v99
    s_mov_b32 s43, 1
    s_cbranch_vccz L2_xp9
    v_cmp_lt_u32 vcc, 32, v99
    v_cmp_lt_u32 s[58:59], 31, v88
    s_mov_b32 s43, 2
    s_or_b64 vcc, vcc, s[58:59]
    s_cbranch_scc0 L2_xp9
    s_mov_b32 s37, 0x10000
    s_branch L2_xp9
L2_c10:
    s_mov_b64 exec, s[82:83]
    s_nop 1
    v_mfma_f32_4x4x4_16b_bf16 v[88:91], v[12:13], v[84:85], 0
    s_nop 1
    v_mfma_f32_4x4x4_16b_bf16 v[88:91], v[10:11], v[86:87], v[88:91]
    s_nop 4
    v_cvt_pk_bf16_f32 v88, v88, v89
    v_cvt_pk_bf16_f32 v89, v90, v91
    ds_pk_add_bf16 v7, v88
    ds_pk_add_bf16 v7, v89 offset:4
    s_mov_b64 exec, vcc
    s_branch L2_d10
L2_c11:
    s_mov_b64 exec, s[82:83]
    s_nop 1
    v_mfma_f32_4x4x4_16b_bf16 v[88:91], v[12:13], v[84:85], 0
    s_nop 1
    v_mfma_f32_4x4x4_16b_bf16 v[88:91], v[10:11], v[86:87], v[88:91]
    s_nop 4
    v_cvt_pk_bf16_f32 v88, v88, v89
    v_cvt_pk_bf16_f32 v89, v90, v91
    ds_pk_add_bf16 v7, v88
    ds_pk_add_bf16 v7, v89 offset:4
    s_mov_b64 exec, vcc
    s_branch L2_d11
L2_c12:
    s_mov_b64 exec, s[82:83]
    s_nop 1
    v_mfma_f32_4x4x4_16b_bf16 v[88:91], v[12:13], v[84:85], 0
    s_nop 1
    v_mfma_f32_4x4x4_16b_bf16 v[88:91], v[10:11], v[86:87], v[88:91]
    s_nop 4
    v_cvt_pk_bf16_f32 v88, v88, v89
    v_cvt_pk_bf16_f32 v89, v90, v91
    ds_pk_add_bf16 v7, v88
    ds_pk_add_bf16 v7, v89 offset:4
    s_mov_b64 exec, vcc
    s_branch L2_d12
L2_c13:
    s_mov_b64 exec, s[82:83]
    s_nop 1
    v_mfma_f32_4x4x4_16b_bf16 v[88:91], v[12:13], v[84:85], 0
    s_nop 1
    v_mfma_f32_4x4x4_16b_bf16 v[88:91], v[10:11], v[86:87], v[88:91]
    s_nop 4
    v_cvt_pk_bf16_f32 v88, v88, v89
    v_cvt_pk_bf16_f32 v89, v90, v91
    ds_pk_add_bf16 v7, v88
    ds_pk_add_bf16 v7, v89 offset:4
    s_mov_b64 exec, vcc
    s_branch L2_d13
L2_c14:
    s_mov_b64 exec, s[82:83]
    s_nop 1
    v_mfma_f32_4x4x4_16b_bf16 v[88:91], v[12:13], v[84:85], 0
    s_nop 1
    v_mfma_f32_4x4x4_16b_bf16 v[88:91], v[10:11], v[86:87], v[88:91]
    s_nop 4
    v_cvt_pk_bf16_f32 v88, v88, v89
    v_cvt_pk_bf16_f32 v89, v90, v91
    ds_pk_add_bf16 v7, v88
    ds_pk_add_bf16 v7, v89 offset:4
    s_mov_b64 exec, vcc
    s_branch L2_d14
L2_c15:
    s_mov_b64 exec, s[82:83]
    s_nop 1
    v_mfma_f32_4x4x4_16b_bf16 v[88:91], v[12:13], v[84:85], 0
    s_nop 1
    v_mfma_f32_4x4x4_16b_bf16 v[88:91], v[10:11], v[86:87], v[88:91]
    s_nop 4
    v_cvt_pk_bf16_f32 v88, v88, v89
    v_cvt_pk_bf16_f32 v89, v90, v91
    ds_pk_add_bf16 v7, v88
    ds_pk_add_bf16 v7, v89 offset:4
    s_mov_b64 exec, vcc
    s_branch L2_d15
L2_c16:
    s_mov_b64 exec, s[82:83]
    s_nop 1
    v_mfma_f32_4x4x4_16b_bf16 v[88:91], v[12:13], v[84:85], 0
    s_nop 1
    v_mfma_f32_4x4x4_16b_bf16 v[88:91], v[10:11], v[86:87], v[88:91]
    s_nop 4
    v_cvt_pk_bf16_f32 v88, v88, v89
    v_cvt_pk_bf16_f32 v89, v90, v91
    ds_pk_add_bf16 v7, v88
    ds_pk_add_bf16 v7, v89 offset:4
    s_mov_b64 exec, vcc
    s_branch L2_d16
L2_c17:
    s_mov_b64 exec, s[82:83]
    s_nop 1
    v_mfma_f32_4x4x4_16b_bf16 v[88:91], v[12:13], v[84:85], 0
    s_nop 1
    v_mfma_f32_4x4x4_16b_bf16 v[88:91], v[10:11], v[86:87], v[88:91]
    s_nop 4
    v_cvt_pk_bf16_f32 v88, v88, v89
    v_cvt_pk_bf16_f32 v89, v90, v91
    ds_pk_add_bf16 v7, v88
    ds_pk_add_bf16 v7, v89 offset:4
    s_mov_b64 exec, vcc
    s_branch L2_d17
L2_xa18:
    s_cmp_eq_u32 s43, 1
    s_cbranch_scc1 L2_xc18
    v_lshlrev_b32 v89, 0, v96
    v_add_u32 v90, 140, v97
    v_bitop3_b32 v90, v89, v45, v90 bitop3:0x6a
    ds_write_b32 v98, v90 offset:28
    v_lshlrev_b32 v89, 4, v96
    v_add_u32 v90, 120, v97
    v_bitop3_b32 v90, v89, v45, v90 bitop3:0x6a
    ds_write_b32 v98, v90 offset:24
    v_lshlrev_b32 v89, 8, v96
    v_add_u32 v90, 100, v97
    v_bitop3_b32 v90, v89, v45, v90 bitop3:0x6a
    ds_write_b32 v98, v90 offset:20
L2_xc18:
    v_lshlrev_b32 v89, 12, v96
    v_add_u32 v90, 80, v97
    v_bitop3_b32 v90, v89, v45, v90 bitop3:0x6a
    ds_write_b32 v98, v90 offset:16
    s_branch L2_xb18
L2_xe18:
    v_cmp_lt_u32 vcc, 32, v99
    v_cmp_lt_u32 s[58:59], 31, v88
    v_lshrrev_b32 v89, 16, v96
    v_add_u32 v97, 80, v97
    s_or_b64 vcc, vcc, s[58:59]
    s_cbranch_scc1 L2_xs18
    v_lshlrev_b32 v89, v1, v89
    v_and_b32 v89, v45, v89
    v_cmp_ne_u32 vcc, 0, v89
    v_xor_b32 v90, v97, v89
    s_add_u32 s3, s37, s38
    v_mbcnt_lo_u32_b32 v98, vcc_lo, 0
    v_mbcnt_hi_u32_b32 v98, vcc_hi, v98
    s_bcnt1_i32_b64 s41, vcc
    v_lshl_add_u32 v98, v98, 2, s3
    s_mov_b64 exec, vcc
    ds_write_b32 v98, v90
    s_mov_b64 exec, -1
    s_lshl2_add_u32 s37, s41, s37
    s_branch L2_xr18
L2_xf18:
    s_waitcnt lgkmcnt(0)
    s_cmp_gt_u32 s37, 1024
    s_cbranch_scc1 L2_xs18
    v_mov_b32 v43, -1
    s_cmp_ge_u32 s37, 512
    s_cbranch_scc1 L2_xg18
    v_mov_b32 v42, -1
    s_cmp_ge_u32 s37, 256
    s_cbranch_scc1 L2_xg18
    v_mov_b32 v41, -1
    s_branch L2_xg18
L2_xs18:
    s_waitcnt lgkmcnt(0)
    v_mov_b32 v40, -1
    v_mov_b32 v41, -1
    v_mov_b32 v42, -1
    v_mov_b32 v43, -1
    s_add_u32 s3, s42, 2
    s_bitset1_b32 s36, s3
    s_branch L2_xg18
L2_c19:
    s_mov_b64 exec, s[82:83]
    s_nop 1
    v_mfma_f32_4x4x4_16b_bf16 v[88:91], v[12:13], v[84:85], 0
    s_nop 1
    v_mfma_f32_4x4x4_16b_bf16 v[88:91], v[10:11], v[86:87], v[88:91]
    s_nop 4
    v_cvt_pk_bf16_f32 v88, v88, v89
    v_cvt_pk_bf16_f32 v89, v90, v91
    ds_pk_add_bf16 v7, v88
    ds_pk_add_bf16 v7, v89 offset:4
    s_mov_b64 exec, vcc
    s_branch L2_d19
L2_c20:
    s_mov_b64 exec, s[82:83]
    s_nop 1
    v_mfma_f32_4x4x4_16b_bf16 v[88:91], v[12:13], v[84:85], 0
    s_nop 1
    v_mfma_f32_4x4x4_16b_bf16 v[88:91], v[10:11], v[86:87], v[88:91]
    s_nop 4
    v_cvt_pk_bf16_f32 v88, v88, v89
    v_cvt_pk_bf16_f32 v89, v90, v91
    ds_pk_add_bf16 v7, v88
    ds_pk_add_bf16 v7, v89 offset:4
    s_mov_b64 exec, vcc
    s_branch L2_d20
L2_c21:
    s_mov_b64 exec, s[82:83]
    s_nop 1
    v_mfma_f32_4x4x4_16b_bf16 v[88:91], v[12:13], v[84:85], 0
    s_nop 1
    v_mfma_f32_4x4x4_16b_bf16 v[88:91], v[10:11], v[86:87], v[88:91]
    s_nop 4
    v_cvt_pk_bf16_f32 v88, v88, v89
    v_cvt_pk_bf16_f32 v89, v90, v91
    ds_pk_add_bf16 v7, v88
    ds_pk_add_bf16 v7, v89 offset:4
    s_mov_b64 exec, vcc
    s_branch L2_d21
L2_c22:
    s_mov_b64 exec, s[82:83]
    s_nop 1
    v_mfma_f32_4x4x4_16b_bf16 v[88:91], v[12:13], v[84:85], 0
    s_nop 1
    v_mfma_f32_4x4x4_16b_bf16 v[88:91], v[10:11], v[86:87], v[88:91]
    s_nop 4
    v_cvt_pk_bf16_f32 v88, v88, v89
    v_cvt_pk_bf16_f32 v89, v90, v91
    ds_pk_add_bf16 v7, v88
    ds_pk_add_bf16 v7, v89 offset:4
    s_mov_b64 exec, vcc
    s_branch L2_d22
L2_c23:
    s_mov_b64 exec, s[82:83]
    s_nop 1
    v_mfma_f32_4x4x4_16b_bf16 v[88:91], v[12:13], v[84:85], 0
    s_nop 1
    v_mfma_f32_4x4x4_16b_bf16 v[88:91], v[10:11], v[86:87], v[88:91]
    s_nop 4
    v_cvt_pk_bf16_f32 v88, v88, v89
    v_cvt_pk_bf16_f32 v89, v90, v91
    ds_pk_add_bf16 v7, v88
    ds_pk_add_bf16 v7, v89 offset:4
    s_mov_b64 exec, vcc
    s_branch L2_d23
L2_c24:
    s_mov_b64 exec, s[82:83]
    s_nop 1
    v_mfma_f32_4x4x4_16b_bf16 v[88:91], v[12:13], v[84:85], 0
    s_nop 1
    v_mfma_f32_4x4x4_16b_bf16 v[88:91], v[10:11], v[86:87], v[88:91]
    s_nop 4
    v_cvt_pk_bf16_f32 v88, v88, v89
    v_cvt_pk_bf16_f32 v89, v90, v91
    ds_pk_add_bf16 v7, v88
    ds_pk_add_bf16 v7, v89 offset:4
    s_mov_b64 exec, vcc
    s_branch L2_d24
L2_c25:
    s_mov_b64 exec, s[82:83]
    s_nop 1
    v_mfma_f32_4x4x4_16b_bf16 v[88:91], v[12:13], v[84:85], 0
    s_nop 1
    v_mfma_f32_4x4x4_16b_bf16 v[88:91], v[10:11], v[86:87], v[88:91]
    s_nop 4
    v_cvt_pk_bf16_f32 v88, v88, v89
    v_cvt_pk_bf16_f32 v89, v90, v91
    ds_pk_add_bf16 v7, v88
    ds_pk_add_bf16 v7, v89 offset:4
    s_mov_b64 exec, vcc
    s_branch L2_d25
L2_c26:
    s_mov_b64 exec, s[82:83]
    s_nop 1
    v_mfma_f32_4x4x4_16b_bf16 v[88:91], v[12:13], v[84:85], 0
    s_nop 1
    v_mfma_f32_4x4x4_16b_bf16 v[88:91], v[10:11], v[86:87], v[88:91]
    s_nop 4
    v_cvt_pk_bf16_f32 v88, v88, v89
    v_cvt_pk_bf16_f32 v89, v90, v91
    ds_pk_add_bf16 v7, v88
    ds_pk_add_bf16 v7, v89 offset:4
    s_mov_b64 exec, vcc
    s_branch L2_d26
L2_xo27:
    v_cmp_lt_u32 vcc, 20, v99
    s_mov_b32 s43, 1
    s_cbranch_vccz L2_xp27
    v_cmp_lt_u32 vcc, 32, v99
    v_cmp_lt_u32 s[58:59], 31, v88
    s_mov_b32 s43, 2
    s_or_b64 vcc, vcc, s[58:59]
    s_cbranch_scc0 L2_xp27
    s_mov_b32 s37, 0x10000
    s_branch L2_xp27
L2_c28:
    s_mov_b64 exec, s[82:83]
    s_nop 1
    v_mfma_f32_4x4x4_16b_bf16 v[88:91], v[12:13], v[84:85], 0
    s_nop 1
    v_mfma_f32_4x4x4_16b_bf16 v[88:91], v[10:11], v[86:87], v[88:91]
    s_nop 4
    v_cvt_pk_bf16_f32 v88, v88, v89
    v_cvt_pk_bf16_f32 v89, v90, v91
    ds_pk_add_bf16 v7, v88
    ds_pk_add_bf16 v7, v89 offset:4
    s_mov_b64 exec, vcc
    s_branch L2_d28
L2_c29:
    s_mov_b64 exec, s[82:83]
    s_nop 1
    v_mfma_f32_4x4x4_16b_bf16 v[88:91], v[12:13], v[84:85], 0
    s_nop 1
    v_mfma_f32_4x4x4_16b_bf16 v[88:91], v[10:11], v[86:87], v[88:91]
    s_nop 4
    v_cvt_pk_bf16_f32 v88, v88, v89
    v_cvt_pk_bf16_f32 v89, v90, v91
    ds_pk_add_bf16 v7, v88
    ds_pk_add_bf16 v7, v89 offset:4
    s_mov_b64 exec, vcc
    s_branch L2_d29
L2_c30:
    s_mov_b64 exec, s[82:83]
    s_nop 1
    v_mfma_f32_4x4x4_16b_bf16 v[88:91], v[12:13], v[84:85], 0
    s_nop 1
    v_mfma_f32_4x4x4_16b_bf16 v[88:91], v[10:11], v[86:87], v[88:91]
    s_nop 4
    v_cvt_pk_bf16_f32 v88, v88, v89
    v_cvt_pk_bf16_f32 v89, v90, v91
    ds_pk_add_bf16 v7, v88
    ds_pk_add_bf16 v7, v89 offset:4
    s_mov_b64 exec, vcc
    s_branch L2_d30
L2_c31:
    s_mov_b64 exec, s[82:83]
    s_nop 1
    v_mfma_f32_4x4x4_16b_bf16 v[88:91], v[12:13], v[84:85], 0
    s_nop 1
    v_mfma_f32_4x4x4_16b_bf16 v[88:91], v[10:11], v[86:87], v[88:91]
    s_nop 4
    v_cvt_pk_bf16_f32 v88, v88, v89
    v_cvt_pk_bf16_f32 v89, v90, v91
    ds_pk_add_bf16 v7, v88
    ds_pk_add_bf16 v7, v89 offset:4
    s_mov_b64 exec, vcc
    s_branch L2_d31
L2_c32:
    s_mov_b64 exec, s[82:83]
    s_nop 1
    v_mfma_f32_4x4x4_16b_bf16 v[88:91], v[12:13], v[84:85], 0
    s_nop 1
    v_mfma_f32_4x4x4_16b_bf16 v[88:91], v[10:11], v[86:87], v[88:91]
    s_nop 4
    v_cvt_pk_bf16_f32 v88, v88, v89
    v_cvt_pk_bf16_f32 v89, v90, v91
    ds_pk_add_bf16 v7, v88
    ds_pk_add_bf16 v7, v89 offset:4
    s_mov_b64 exec, vcc
    s_branch L2_d32
L2_c33:
    s_mov_b64 exec, s[82:83]
    s_nop 1
    v_mfma_f32_4x4x4_16b_bf16 v[88:91], v[12:13], v[84:85], 0
    s_nop 1
    v_mfma_f32_4x4x4_16b_bf16 v[88:91], v[10:11], v[86:87], v[88:91]
    s_nop 4
    v_cvt_pk_bf16_f32 v88, v88, v89
    v_cvt_pk_bf16_f32 v89, v90, v91
    ds_pk_add_bf16 v7, v88
    ds_pk_add_bf16 v7, v89 offset:4
    s_mov_b64 exec, vcc
    s_branch L2_d33
L2_c34:
    s_mov_b64 exec, s[82:83]
    s_nop 1
    v_mfma_f32_4x4x4_16b_bf16 v[88:91], v[12:13], v[84:85], 0
    s_nop 1
    v_mfma_f32_4x4x4_16b_bf16 v[88:91], v[10:11], v[86:87], v[88:91]
    s_nop 4
    v_cvt_pk_bf16_f32 v88, v88, v89
    v_cvt_pk_bf16_f32 v89, v90, v91
    ds_pk_add_bf16 v7, v88
    ds_pk_add_bf16 v7, v89 offset:4
    s_mov_b64 exec, vcc
    s_branch L2_d34
L2_c35:
    s_mov_b64 exec, s[82:83]
    s_nop 1
    v_mfma_f32_4x4x4_16b_bf16 v[88:91], v[12:13], v[84:85], 0
    s_nop 1
    v_mfma_f32_4x4x4_16b_bf16 v[88:91], v[10:11], v[86:87], v[88:91]
    s_nop 4
    v_cvt_pk_bf16_f32 v88, v88, v89
    v_cvt_pk_bf16_f32 v89, v90, v91
    ds_pk_add_bf16 v7, v88
    ds_pk_add_bf16 v7, v89 offset:4
    s_mov_b64 exec, vcc
    s_branch L2_d35
L2_xa36:
    s_cmp_eq_u32 s43, 1
    s_cbranch_scc1 L2_xc36
    v_lshlrev_b32 v89, 0, v96
    v_add_u32 v90, 140, v97
    v_bitop3_b32 v90, v89, v45, v90 bitop3:0x6a
    ds_write_b32 v98, v90 offset:28
    v_lshlrev_b32 v89, 4, v96
    v_add_u32 v90, 120, v97
    v_bitop3_b32 v90, v89, v45, v90 bitop3:0x6a
    ds_write_b32 v98, v90 offset:24
    v_lshlrev_b32 v89, 8, v96
    v_add_u32 v90, 100, v97
    v_bitop3_b32 v90, v89, v45, v90 bitop3:0x6a
    ds_write_b32 v98, v90 offset:20
L2_xc36:
    v_lshlrev_b32 v89, 12, v96
    v_add_u32 v90, 80, v97
    v_bitop3_b32 v90, v89, v45, v90 bitop3:0x6a
    ds_write_b32 v98, v90 offset:16
    s_branch L2_xb36
L2_xe36:
    v_cmp_lt_u32 vcc, 32, v99
    v_cmp_lt_u32 s[58:59], 31, v88
    v_lshrrev_b32 v89, 16, v96
    v_add_u32 v97, 80, v97
    s_or_b64 vcc, vcc, s[58:59]
    s_cbranch_scc1 L2_xs36
    v_lshlrev_b32 v89, v1, v89
    v_and_b32 v89, v45, v89
    v_cmp_ne_u32 vcc, 0, v89
    v_xor_b32 v90, v97, v89
    s_add_u32 s3, s37, s38
    v_mbcnt_lo_u32_b32 v98, vcc_lo, 0
    v_mbcnt_hi_u32_b32 v98, vcc_hi, v98
    s_bcnt1_i32_b64 s41, vcc
    v_lshl_add_u32 v98, v98, 2, s3
    s_mov_b64 exec, vcc
    ds_write_b32 v98, v90
    s_mov_b64 exec, -1
    s_lshl2_add_u32 s37, s41, s37
    s_branch L2_xr36
L2_xf36:
    s_waitcnt lgkmcnt(0)
    s_cmp_gt_u32 s37, 1024
    s_cbranch_scc1 L2_xs36
    v_mov_b32 v43, -1
    s_cmp_ge_u32 s37, 512
    s_cbranch_scc1 L2_xg36
    v_mov_b32 v42, -1
    s_cmp_ge_u32 s37, 256
    s_cbranch_scc1 L2_xg36
    v_mov_b32 v41, -1
    s_branch L2_xg36
L2_xs36:
    s_waitcnt lgkmcnt(0)
    v_mov_b32 v40, -1
    v_mov_b32 v41, -1
    v_mov_b32 v42, -1
    v_mov_b32 v43, -1
    s_add_u32 s3, s42, 2
    s_bitset1_b32 s36, s3
    s_branch L2_xg36
L2_c37:
    s_mov_b64 exec, s[82:83]
    s_nop 1
    v_mfma_f32_4x4x4_16b_bf16 v[88:91], v[12:13], v[84:85], 0
    s_nop 1
    v_mfma_f32_4x4x4_16b_bf16 v[88:91], v[10:11], v[86:87], v[88:91]
    s_nop 4
    v_cvt_pk_bf16_f32 v88, v88, v89
    v_cvt_pk_bf16_f32 v89, v90, v91
    ds_pk_add_bf16 v7, v88
    ds_pk_add_bf16 v7, v89 offset:4
    s_mov_b64 exec, vcc
    s_branch L2_d37
L2_c38:
    s_mov_b64 exec, s[82:83]
    s_nop 1
    v_mfma_f32_4x4x4_16b_bf16 v[88:91], v[12:13], v[84:85], 0
    s_nop 1
    v_mfma_f32_4x4x4_16b_bf16 v[88:91], v[10:11], v[86:87], v[88:91]
    s_nop 4
    v_cvt_pk_bf16_f32 v88, v88, v89
    v_cvt_pk_bf16_f32 v89, v90, v91
    ds_pk_add_bf16 v7, v88
    ds_pk_add_bf16 v7, v89 offset:4
    s_mov_b64 exec, vcc
    s_branch L2_d38
L2_c39:
    s_mov_b64 exec, s[82:83]
    s_nop 1
    v_mfma_f32_4x4x4_16b_bf16 v[88:91], v[12:13], v[84:85], 0
    s_nop 1
    v_mfma_f32_4x4x4_16b_bf16 v[88:91], v[10:11], v[86:87], v[88:91]
    s_nop 4
    v_cvt_pk_bf16_f32 v88, v88, v89
    v_cvt_pk_bf16_f32 v89, v90, v91
    ds_pk_add_bf16 v7, v88
    ds_pk_add_bf16 v7, v89 offset:4
    s_mov_b64 exec, vcc
    s_branch L2_d39
L2_c40:
    s_mov_b64 exec, s[82:83]
    s_nop 1
    v_mfma_f32_4x4x4_16b_bf16 v[88:91], v[12:13], v[84:85], 0
    s_nop 1
    v_mfma_f32_4x4x4_16b_bf16 v[88:91], v[10:11], v[86:87], v[88:91]
    s_nop 4
    v_cvt_pk_bf16_f32 v88, v88, v89
    v_cvt_pk_bf16_f32 v89, v90, v91
    ds_pk_add_bf16 v7, v88
    ds_pk_add_bf16 v7, v89 offset:4
    s_mov_b64 exec, vcc
    s_branch L2_d40
L2_c41:
    s_mov_b64 exec, s[82:83]
    s_nop 1
    v_mfma_f32_4x4x4_16b_bf16 v[88:91], v[12:13], v[84:85], 0
    s_nop 1
    v_mfma_f32_4x4x4_16b_bf16 v[88:91], v[10:11], v[86:87], v[88:91]
    s_nop 4
    v_cvt_pk_bf16_f32 v88, v88, v89
    v_cvt_pk_bf16_f32 v89, v90, v91
    ds_pk_add_bf16 v7, v88
    ds_pk_add_bf16 v7, v89 offset:4
    s_mov_b64 exec, vcc
    s_branch L2_d41
L2_c42:
    s_mov_b64 exec, s[82:83]
    s_nop 1
    v_mfma_f32_4x4x4_16b_bf16 v[88:91], v[12:13], v[84:85], 0
    s_nop 1
    v_mfma_f32_4x4x4_16b_bf16 v[88:91], v[10:11], v[86:87], v[88:91]
    s_nop 4
    v_cvt_pk_bf16_f32 v88, v88, v89
    v_cvt_pk_bf16_f32 v89, v90, v91
    ds_pk_add_bf16 v7, v88
    ds_pk_add_bf16 v7, v89 offset:4
    s_mov_b64 exec, vcc
    s_branch L2_d42
L2_c43:
    s_mov_b64 exec, s[82:83]
    s_nop 1
    v_mfma_f32_4x4x4_16b_bf16 v[88:91], v[12:13], v[84:85], 0
    s_nop 1
    v_mfma_f32_4x4x4_16b_bf16 v[88:91], v[10:11], v[86:87], v[88:91]
    s_nop 4
    v_cvt_pk_bf16_f32 v88, v88, v89
    v_cvt_pk_bf16_f32 v89, v90, v91
    ds_pk_add_bf16 v7, v88
    ds_pk_add_bf16 v7, v89 offset:4
    s_mov_b64 exec, vcc
    s_branch L2_d43
L2_c44:
    s_mov_b64 exec, s[82:83]
    s_nop 1
    v_mfma_f32_4x4x4_16b_bf16 v[88:91], v[12:13], v[84:85], 0
    s_nop 1
    v_mfma_f32_4x4x4_16b_bf16 v[88:91], v[10:11], v[86:87], v[88:91]
    s_nop 4
    v_cvt_pk_bf16_f32 v88, v88, v89
    v_cvt_pk_bf16_f32 v89, v90, v91
    ds_pk_add_bf16 v7, v88
    ds_pk_add_bf16 v7, v89 offset:4
    s_mov_b64 exec, vcc
    s_branch L2_d44
L2_xo45:
    v_cmp_lt_u32 vcc, 20, v99
    s_mov_b32 s43, 1
    s_cbranch_vccz L2_xp45
    v_cmp_lt_u32 vcc, 32, v99
    v_cmp_lt_u32 s[58:59], 31, v88
    s_mov_b32 s43, 2
    s_or_b64 vcc, vcc, s[58:59]
    s_cbranch_scc0 L2_xp45
    s_mov_b32 s37, 0x10000
    s_branch L2_xp45
L2_c46:
    s_mov_b64 exec, s[82:83]
    s_nop 1
    v_mfma_f32_4x4x4_16b_bf16 v[88:91], v[12:13], v[84:85], 0
    s_nop 1
    v_mfma_f32_4x4x4_16b_bf16 v[88:91], v[10:11], v[86:87], v[88:91]
    s_nop 4
    v_cvt_pk_bf16_f32 v88, v88, v89
    v_cvt_pk_bf16_f32 v89, v90, v91
    ds_pk_add_bf16 v7, v88
    ds_pk_add_bf16 v7, v89 offset:4
    s_mov_b64 exec, vcc
    s_branch L2_d46
L2_c47:
    s_mov_b64 exec, s[82:83]
    s_nop 1
    v_mfma_f32_4x4x4_16b_bf16 v[88:91], v[12:13], v[84:85], 0
    s_nop 1
    v_mfma_f32_4x4x4_16b_bf16 v[88:91], v[10:11], v[86:87], v[88:91]
    s_nop 4
    v_cvt_pk_bf16_f32 v88, v88, v89
    v_cvt_pk_bf16_f32 v89, v90, v91
    ds_pk_add_bf16 v7, v88
    ds_pk_add_bf16 v7, v89 offset:4
    s_mov_b64 exec, vcc
    s_branch L2_d47
L2_c48:
    s_mov_b64 exec, s[82:83]
    s_nop 1
    v_mfma_f32_4x4x4_16b_bf16 v[88:91], v[12:13], v[84:85], 0
    s_nop 1
    v_mfma_f32_4x4x4_16b_bf16 v[88:91], v[10:11], v[86:87], v[88:91]
    s_nop 4
    v_cvt_pk_bf16_f32 v88, v88, v89
    v_cvt_pk_bf16_f32 v89, v90, v91
    ds_pk_add_bf16 v7, v88
    ds_pk_add_bf16 v7, v89 offset:4
    s_mov_b64 exec, vcc
    s_branch L2_d48
L2_c49:
    s_mov_b64 exec, s[82:83]
    s_nop 1
    v_mfma_f32_4x4x4_16b_bf16 v[88:91], v[12:13], v[84:85], 0
    s_nop 1
    v_mfma_f32_4x4x4_16b_bf16 v[88:91], v[10:11], v[86:87], v[88:91]
    s_nop 4
    v_cvt_pk_bf16_f32 v88, v88, v89
    v_cvt_pk_bf16_f32 v89, v90, v91
    ds_pk_add_bf16 v7, v88
    ds_pk_add_bf16 v7, v89 offset:4
    s_mov_b64 exec, vcc
    s_branch L2_d49
L2_c50:
    s_mov_b64 exec, s[82:83]
    s_nop 1
    v_mfma_f32_4x4x4_16b_bf16 v[88:91], v[12:13], v[84:85], 0
    s_nop 1
    v_mfma_f32_4x4x4_16b_bf16 v[88:91], v[10:11], v[86:87], v[88:91]
    s_nop 4
    v_cvt_pk_bf16_f32 v88, v88, v89
    v_cvt_pk_bf16_f32 v89, v90, v91
    ds_pk_add_bf16 v7, v88
    ds_pk_add_bf16 v7, v89 offset:4
    s_mov_b64 exec, vcc
    s_branch L2_d50
L2_c51:
    s_mov_b64 exec, s[82:83]
    s_nop 1
    v_mfma_f32_4x4x4_16b_bf16 v[88:91], v[12:13], v[84:85], 0
    s_nop 1
    v_mfma_f32_4x4x4_16b_bf16 v[88:91], v[10:11], v[86:87], v[88:91]
    s_nop 4
    v_cvt_pk_bf16_f32 v88, v88, v89
    v_cvt_pk_bf16_f32 v89, v90, v91
    ds_pk_add_bf16 v7, v88
    ds_pk_add_bf16 v7, v89 offset:4
    s_mov_b64 exec, vcc
    s_branch L2_d51
L2_c52:
    s_mov_b64 exec, s[82:83]
    s_nop 1
    v_mfma_f32_4x4x4_16b_bf16 v[88:91], v[12:13], v[84:85], 0
    s_nop 1
    v_mfma_f32_4x4x4_16b_bf16 v[88:91], v[10:11], v[86:87], v[88:91]
    s_nop 4
    v_cvt_pk_bf16_f32 v88, v88, v89
    v_cvt_pk_bf16_f32 v89, v90, v91
    ds_pk_add_bf16 v7, v88
    ds_pk_add_bf16 v7, v89 offset:4
    s_mov_b64 exec, vcc
    s_branch L2_d52
L2_c53:
    s_mov_b64 exec, s[82:83]
    s_nop 1
    v_mfma_f32_4x4x4_16b_bf16 v[88:91], v[12:13], v[84:85], 0
    s_nop 1
    v_mfma_f32_4x4x4_16b_bf16 v[88:91], v[10:11], v[86:87], v[88:91]
    s_nop 4
    v_cvt_pk_bf16_f32 v88, v88, v89
    v_cvt_pk_bf16_f32 v89, v90, v91
    ds_pk_add_bf16 v7, v88
    ds_pk_add_bf16 v7, v89 offset:4
    s_mov_b64 exec, vcc
    s_branch L2_d53
L2_xa54:
    s_cmp_eq_u32 s43, 1
    s_cbranch_scc1 L2_xc54
    v_lshlrev_b32 v89, 0, v96
    v_add_u32 v90, 140, v97
    v_bitop3_b32 v90, v89, v45, v90 bitop3:0x6a
    ds_write_b32 v98, v90 offset:28
    v_lshlrev_b32 v89, 4, v96
    v_add_u32 v90, 120, v97
    v_bitop3_b32 v90, v89, v45, v90 bitop3:0x6a
    ds_write_b32 v98, v90 offset:24
    v_lshlrev_b32 v89, 8, v96
    v_add_u32 v90, 100, v97
    v_bitop3_b32 v90, v89, v45, v90 bitop3:0x6a
    ds_write_b32 v98, v90 offset:20
L2_xc54:
    v_lshlrev_b32 v89, 12, v96
    v_add_u32 v90, 80, v97
    v_bitop3_b32 v90, v89, v45, v90 bitop3:0x6a
    ds_write_b32 v98, v90 offset:16
    s_branch L2_xb54
L2_xe54:
    v_cmp_lt_u32 vcc, 32, v99
    v_cmp_lt_u32 s[58:59], 31, v88
    v_lshrrev_b32 v89, 16, v96
    v_add_u32 v97, 80, v97
    s_or_b64 vcc, vcc, s[58:59]
    s_cbranch_scc1 L2_xs54
    v_lshlrev_b32 v89, v1, v89
    v_and_b32 v89, v45, v89
    v_cmp_ne_u32 vcc, 0, v89
    v_xor_b32 v90, v97, v89
    s_add_u32 s3, s37, s38
    v_mbcnt_lo_u32_b32 v98, vcc_lo, 0
    v_mbcnt_hi_u32_b32 v98, vcc_hi, v98
    s_bcnt1_i32_b64 s41, vcc
    v_lshl_add_u32 v98, v98, 2, s3
    s_mov_b64 exec, vcc
    ds_write_b32 v98, v90
    s_mov_b64 exec, -1
    s_lshl2_add_u32 s37, s41, s37
    s_branch L2_xr54
L2_xf54:
    s_waitcnt lgkmcnt(0)
    s_cmp_gt_u32 s37, 1024
    s_cbranch_scc1 L2_xs54
    v_mov_b32 v43, -1
    s_cmp_ge_u32 s37, 512
    s_cbranch_scc1 L2_xg54
    v_mov_b32 v42, -1
    s_cmp_ge_u32 s37, 256
    s_cbranch_scc1 L2_xg54
    v_mov_b32 v41, -1
    s_branch L2_xg54
L2_xs54:
    s_waitcnt lgkmcnt(0)
    v_mov_b32 v40, -1
    v_mov_b32 v41, -1
    v_mov_b32 v42, -1
    v_mov_b32 v43, -1
    s_add_u32 s3, s42, 2
    s_bitset1_b32 s36, s3
    s_branch L2_xg54
L2_c55:
    s_mov_b64 exec, s[82:83]
    s_nop 1
    v_mfma_f32_4x4x4_16b_bf16 v[88:91], v[12:13], v[84:85], 0
    s_nop 1
    v_mfma_f32_4x4x4_16b_bf16 v[88:91], v[10:11], v[86:87], v[88:91]
    s_nop 4
    v_cvt_pk_bf16_f32 v88, v88, v89
    v_cvt_pk_bf16_f32 v89, v90, v91
    ds_pk_add_bf16 v7, v88
    ds_pk_add_bf16 v7, v89 offset:4
    s_mov_b64 exec, vcc
    s_branch L2_d55
L2_c56:
    s_mov_b64 exec, s[82:83]
    s_nop 1
    v_mfma_f32_4x4x4_16b_bf16 v[88:91], v[12:13], v[84:85], 0
    s_nop 1
    v_mfma_f32_4x4x4_16b_bf16 v[88:91], v[10:11], v[86:87], v[88:91]
    s_nop 4
    v_cvt_pk_bf16_f32 v88, v88, v89
    v_cvt_pk_bf16_f32 v89, v90, v91
    ds_pk_add_bf16 v7, v88
    ds_pk_add_bf16 v7, v89 offset:4
    s_mov_b64 exec, vcc
    s_branch L2_d56
L2_c57:
    s_mov_b64 exec, s[82:83]
    s_nop 1
    v_mfma_f32_4x4x4_16b_bf16 v[88:91], v[12:13], v[84:85], 0
    s_nop 1
    v_mfma_f32_4x4x4_16b_bf16 v[88:91], v[10:11], v[86:87], v[88:91]
    s_nop 4
    v_cvt_pk_bf16_f32 v88, v88, v89
    v_cvt_pk_bf16_f32 v89, v90, v91
    ds_pk_add_bf16 v7, v88
    ds_pk_add_bf16 v7, v89 offset:4
    s_mov_b64 exec, vcc
    s_branch L2_d57
L2_c58:
    s_mov_b64 exec, s[82:83]
    s_nop 1
    v_mfma_f32_4x4x4_16b_bf16 v[88:91], v[12:13], v[84:85], 0
    s_nop 1
    v_mfma_f32_4x4x4_16b_bf16 v[88:91], v[10:11], v[86:87], v[88:91]
    s_nop 4
    v_cvt_pk_bf16_f32 v88, v88, v89
    v_cvt_pk_bf16_f32 v89, v90, v91
    ds_pk_add_bf16 v7, v88
    ds_pk_add_bf16 v7, v89 offset:4
    s_mov_b64 exec, vcc
    s_branch L2_d58
L2_c59:
    s_mov_b64 exec, s[82:83]
    s_nop 1
    v_mfma_f32_4x4x4_16b_bf16 v[88:91], v[12:13], v[84:85], 0
    s_nop 1
    v_mfma_f32_4x4x4_16b_bf16 v[88:91], v[10:11], v[86:87], v[88:91]
    s_nop 4
    v_cvt_pk_bf16_f32 v88, v88, v89
    v_cvt_pk_bf16_f32 v89, v90, v91
    ds_pk_add_bf16 v7, v88
    ds_pk_add_bf16 v7, v89 offset:4
    s_mov_b64 exec, vcc
    s_branch L2_d59
L2_c60:
    s_mov_b64 exec, s[82:83]
    s_nop 1
    v_mfma_f32_4x4x4_16b_bf16 v[88:91], v[12:13], v[84:85], 0
    s_nop 1
    v_mfma_f32_4x4x4_16b_bf16 v[88:91], v[10:11], v[86:87], v[88:91]
    s_nop 4
    v_cvt_pk_bf16_f32 v88, v88, v89
    v_cvt_pk_bf16_f32 v89, v90, v91
    ds_pk_add_bf16 v7, v88
    ds_pk_add_bf16 v7, v89 offset:4
    s_mov_b64 exec, vcc
    s_branch L2_d60
L2_c61:
    s_mov_b64 exec, s[82:83]
    s_nop 1
    v_mfma_f32_4x4x4_16b_bf16 v[88:91], v[12:13], v[84:85], 0
    s_nop 1
    v_mfma_f32_4x4x4_16b_bf16 v[88:91], v[10:11], v[86:87], v[88:91]
    s_nop 4
    v_cvt_pk_bf16_f32 v88, v88, v89
    v_cvt_pk_bf16_f32 v89, v90, v91
    ds_pk_add_bf16 v7, v88
    ds_pk_add_bf16 v7, v89 offset:4
    s_mov_b64 exec, vcc
    s_branch L2_d61
L2_c62:
    s_mov_b64 exec, s[82:83]
    s_nop 1
    v_mfma_f32_4x4x4_16b_bf16 v[88:91], v[12:13], v[84:85], 0
    s_nop 1
    v_mfma_f32_4x4x4_16b_bf16 v[88:91], v[10:11], v[86:87], v[88:91]
    s_nop 4
    v_cvt_pk_bf16_f32 v88, v88, v89
    v_cvt_pk_bf16_f32 v89, v90, v91
    ds_pk_add_bf16 v7, v88
    ds_pk_add_bf16 v7, v89 offset:4
    s_mov_b64 exec, vcc
    s_branch L2_d62
L2_xo63:
    v_cmp_lt_u32 vcc, 20, v99
    s_mov_b32 s43, 1
    s_cbranch_vccz L2_xp63
    v_cmp_lt_u32 vcc, 32, v99
    v_cmp_lt_u32 s[58:59], 31, v88
    s_mov_b32 s43, 2
    s_or_b64 vcc, vcc, s[58:59]
    s_cbranch_scc0 L2_xp63
    s_mov_b32 s37, 0x10000
    s_branch L2_xp63
L2_c64:
    s_mov_b64 exec, s[82:83]
    s_nop 1
    v_mfma_f32_4x4x4_16b_bf16 v[88:91], v[12:13], v[84:85], 0
    s_nop 1
    v_mfma_f32_4x4x4_16b_bf16 v[88:91], v[10:11], v[86:87], v[88:91]
    s_nop 4
    v_cvt_pk_bf16_f32 v88, v88, v89
    v_cvt_pk_bf16_f32 v89, v90, v91
    ds_pk_add_bf16 v7, v88
    ds_pk_add_bf16 v7, v89 offset:4
    s_mov_b64 exec, vcc
    s_branch L2_d64
L2_c65:
    s_mov_b64 exec, s[82:83]
    s_nop 1
    v_mfma_f32_4x4x4_16b_bf16 v[88:91], v[12:13], v[84:85], 0
    s_nop 1
    v_mfma_f32_4x4x4_16b_bf16 v[88:91], v[10:11], v[86:87], v[88:91]
    s_nop 4
    v_cvt_pk_bf16_f32 v88, v88, v89
    v_cvt_pk_bf16_f32 v89, v90, v91
    ds_pk_add_bf16 v7, v88
    ds_pk_add_bf16 v7, v89 offset:4
    s_mov_b64 exec, vcc
    s_branch L2_d65
L2_c66:
    s_mov_b64 exec, s[82:83]
    s_nop 1
    v_mfma_f32_4x4x4_16b_bf16 v[88:91], v[12:13], v[84:85], 0
    s_nop 1
    v_mfma_f32_4x4x4_16b_bf16 v[88:91], v[10:11], v[86:87], v[88:91]
    s_nop 4
    v_cvt_pk_bf16_f32 v88, v88, v89
    v_cvt_pk_bf16_f32 v89, v90, v91
    ds_pk_add_bf16 v7, v88
    ds_pk_add_bf16 v7, v89 offset:4
    s_mov_b64 exec, vcc
    s_branch L2_d66
L2_c67:
    s_mov_b64 exec, s[82:83]
    s_nop 1
    v_mfma_f32_4x4x4_16b_bf16 v[88:91], v[12:13], v[84:85], 0
    s_nop 1
    v_mfma_f32_4x4x4_16b_bf16 v[88:91], v[10:11], v[86:87], v[88:91]
    s_nop 4
    v_cvt_pk_bf16_f32 v88, v88, v89
    v_cvt_pk_bf16_f32 v89, v90, v91
    ds_pk_add_bf16 v7, v88
    ds_pk_add_bf16 v7, v89 offset:4
    s_mov_b64 exec, vcc
    s_branch L2_d67
L2_c68:
    s_mov_b64 exec, s[82:83]
    s_nop 1
    v_mfma_f32_4x4x4_16b_bf16 v[88:91], v[12:13], v[84:85], 0
    s_nop 1
    v_mfma_f32_4x4x4_16b_bf16 v[88:91], v[10:11], v[86:87], v[88:91]
    s_nop 4
    v_cvt_pk_bf16_f32 v88, v88, v89
    v_cvt_pk_bf16_f32 v89, v90, v91
    ds_pk_add_bf16 v7, v88
    ds_pk_add_bf16 v7, v89 offset:4
    s_mov_b64 exec, vcc
    s_branch L2_d68
L2_c69:
    s_mov_b64 exec, s[82:83]
    s_nop 1
    v_mfma_f32_4x4x4_16b_bf16 v[88:91], v[12:13], v[84:85], 0
    s_nop 1
    v_mfma_f32_4x4x4_16b_bf16 v[88:91], v[10:11], v[86:87], v[88:91]
    s_nop 4
    v_cvt_pk_bf16_f32 v88, v88, v89
    v_cvt_pk_bf16_f32 v89, v90, v91
    ds_pk_add_bf16 v7, v88
    ds_pk_add_bf16 v7, v89 offset:4
    s_mov_b64 exec, vcc
    s_branch L2_d69
L2_c70:
    s_mov_b64 exec, s[82:83]
    s_nop 1
    v_mfma_f32_4x4x4_16b_bf16 v[88:91], v[12:13], v[84:85], 0
    s_nop 1
    v_mfma_f32_4x4x4_16b_bf16 v[88:91], v[10:11], v[86:87], v[88:91]
    s_nop 4
    v_cvt_pk_bf16_f32 v88, v88, v89
    v_cvt_pk_bf16_f32 v89, v90, v91
    ds_pk_add_bf16 v7, v88
    ds_pk_add_bf16 v7, v89 offset:4
    s_mov_b64 exec, vcc
    s_branch L2_d70
L2_c71:
    s_mov_b64 exec, s[82:83]
    s_nop 1
    v_mfma_f32_4x4x4_16b_bf16 v[88:91], v[12:13], v[84:85], 0
    s_nop 1
    v_mfma_f32_4x4x4_16b_bf16 v[88:91], v[10:11], v[86:87], v[88:91]
    s_nop 4
    v_cvt_pk_bf16_f32 v88, v88, v89
    v_cvt_pk_bf16_f32 v89, v90, v91
    ds_pk_add_bf16 v7, v88
    ds_pk_add_bf16 v7, v89 offset:4
    s_mov_b64 exec, vcc
    s_branch L2_d71
L2_xa72:
    s_cmp_eq_u32 s43, 1
    s_cbranch_scc1 L2_xc72
    v_lshlrev_b32 v89, 0, v96
    v_add_u32 v90, 140, v97
    v_bitop3_b32 v90, v89, v45, v90 bitop3:0x6a
    ds_write_b32 v98, v90 offset:28
    v_lshlrev_b32 v89, 4, v96
    v_add_u32 v90, 120, v97
    v_bitop3_b32 v90, v89, v45, v90 bitop3:0x6a
    ds_write_b32 v98, v90 offset:24
    v_lshlrev_b32 v89, 8, v96
    v_add_u32 v90, 100, v97
    v_bitop3_b32 v90, v89, v45, v90 bitop3:0x6a
    ds_write_b32 v98, v90 offset:20
L2_xc72:
    v_lshlrev_b32 v89, 12, v96
    v_add_u32 v90, 80, v97
    v_bitop3_b32 v90, v89, v45, v90 bitop3:0x6a
    ds_write_b32 v98, v90 offset:16
    s_branch L2_xb72
L2_xe72:
    v_cmp_lt_u32 vcc, 32, v99
    v_cmp_lt_u32 s[58:59], 31, v88
    v_lshrrev_b32 v89, 16, v96
    v_add_u32 v97, 80, v97
    s_or_b64 vcc, vcc, s[58:59]
    s_cbranch_scc1 L2_xs72
    v_lshlrev_b32 v89, v1, v89
    v_and_b32 v89, v45, v89
    v_cmp_ne_u32 vcc, 0, v89
    v_xor_b32 v90, v97, v89
    s_add_u32 s3, s37, s38
    v_mbcnt_lo_u32_b32 v98, vcc_lo, 0
    v_mbcnt_hi_u32_b32 v98, vcc_hi, v98
    s_bcnt1_i32_b64 s41, vcc
    v_lshl_add_u32 v98, v98, 2, s3
    s_mov_b64 exec, vcc
    ds_write_b32 v98, v90
    s_mov_b64 exec, -1
    s_lshl2_add_u32 s37, s41, s37
    s_branch L2_xr72
L2_xf72:
    s_waitcnt lgkmcnt(0)
    s_cmp_gt_u32 s37, 1024
    s_cbranch_scc1 L2_xs72
    v_mov_b32 v43, -1
    s_cmp_ge_u32 s37, 512
    s_cbranch_scc1 L2_xg72
    v_mov_b32 v42, -1
    s_cmp_ge_u32 s37, 256
    s_cbranch_scc1 L2_xg72
    v_mov_b32 v41, -1
    s_branch L2_xg72
L2_xs72:
    s_waitcnt lgkmcnt(0)
    v_mov_b32 v40, -1
    v_mov_b32 v41, -1
    v_mov_b32 v42, -1
    v_mov_b32 v43, -1
    s_add_u32 s3, s42, 2
    s_bitset1_b32 s36, s3
    s_branch L2_xg72
L2_c73:
    s_mov_b64 exec, s[82:83]
    s_nop 1
    v_mfma_f32_4x4x4_16b_bf16 v[88:91], v[12:13], v[84:85], 0
    s_nop 1
    v_mfma_f32_4x4x4_16b_bf16 v[88:91], v[10:11], v[86:87], v[88:91]
    s_nop 4
    v_cvt_pk_bf16_f32 v88, v88, v89
    v_cvt_pk_bf16_f32 v89, v90, v91
    ds_pk_add_bf16 v7, v88
    ds_pk_add_bf16 v7, v89 offset:4
    s_mov_b64 exec, vcc
    s_branch L2_d73
L2_c74:
    s_mov_b64 exec, s[82:83]
    s_nop 1
    v_mfma_f32_4x4x4_16b_bf16 v[88:91], v[12:13], v[84:85], 0
    s_nop 1
    v_mfma_f32_4x4x4_16b_bf16 v[88:91], v[10:11], v[86:87], v[88:91]
    s_nop 4
    v_cvt_pk_bf16_f32 v88, v88, v89
    v_cvt_pk_bf16_f32 v89, v90, v91
    ds_pk_add_bf16 v7, v88
    ds_pk_add_bf16 v7, v89 offset:4
    s_mov_b64 exec, vcc
    s_branch L2_d74
L2_c75:
    s_mov_b64 exec, s[82:83]
    s_nop 1
    v_mfma_f32_4x4x4_16b_bf16 v[88:91], v[12:13], v[84:85], 0
    s_nop 1
    v_mfma_f32_4x4x4_16b_bf16 v[88:91], v[10:11], v[86:87], v[88:91]
    s_nop 4
    v_cvt_pk_bf16_f32 v88, v88, v89
    v_cvt_pk_bf16_f32 v89, v90, v91
    ds_pk_add_bf16 v7, v88
    ds_pk_add_bf16 v7, v89 offset:4
    s_mov_b64 exec, vcc
    s_branch L2_d75
L2_c76:
    s_mov_b64 exec, s[82:83]
    s_nop 1
    v_mfma_f32_4x4x4_16b_bf16 v[88:91], v[12:13], v[84:85], 0
    s_nop 1
    v_mfma_f32_4x4x4_16b_bf16 v[88:91], v[10:11], v[86:87], v[88:91]
    s_nop 4
    v_cvt_pk_bf16_f32 v88, v88, v89
    v_cvt_pk_bf16_f32 v89, v90, v91
    ds_pk_add_bf16 v7, v88
    ds_pk_add_bf16 v7, v89 offset:4
    s_mov_b64 exec, vcc
    s_branch L2_d76
L2_c77:
    s_mov_b64 exec, s[82:83]
    s_nop 1
    v_mfma_f32_4x4x4_16b_bf16 v[88:91], v[12:13], v[84:85], 0
    s_nop 1
    v_mfma_f32_4x4x4_16b_bf16 v[88:91], v[10:11], v[86:87], v[88:91]
    s_nop 4
    v_cvt_pk_bf16_f32 v88, v88, v89
    v_cvt_pk_bf16_f32 v89, v90, v91
    ds_pk_add_bf16 v7, v88
    ds_pk_add_bf16 v7, v89 offset:4
    s_mov_b64 exec, vcc
    s_branch L2_d77
L2_c78:
    s_mov_b64 exec, s[82:83]
    s_nop 1
    v_mfma_f32_4x4x4_16b_bf16 v[88:91], v[12:13], v[84:85], 0
    s_nop 1
    v_mfma_f32_4x4x4_16b_bf16 v[88:91], v[10:11], v[86:87], v[88:91]
    s_nop 4
    v_cvt_pk_bf16_f32 v88, v88, v89
    v_cvt_pk_bf16_f32 v89, v90, v91
    ds_pk_add_bf16 v7, v88
    ds_pk_add_bf16 v7, v89 offset:4
    s_mov_b64 exec, vcc
    s_branch L2_d78
L2_c79:
    s_mov_b64 exec, s[82:83]
    s_nop 1
    v_mfma_f32_4x4x4_16b_bf16 v[88:91], v[12:13], v[84:85], 0
    s_nop 1
    v_mfma_f32_4x4x4_16b_bf16 v[88:91], v[10:11], v[86:87], v[88:91]
    s_nop 4
    v_cvt_pk_bf16_f32 v88, v88, v89
    v_cvt_pk_bf16_f32 v89, v90, v91
    ds_pk_add_bf16 v7, v88
    ds_pk_add_bf16 v7, v89 offset:4
    s_mov_b64 exec, vcc
    s_branch L2_d79
L2_c80:
    s_mov_b64 exec, s[82:83]
    s_nop 1
    v_mfma_f32_4x4x4_16b_bf16 v[88:91], v[12:13], v[84:85], 0
    s_nop 1
    v_mfma_f32_4x4x4_16b_bf16 v[88:91], v[10:11], v[86:87], v[88:91]
    s_nop 4
    v_cvt_pk_bf16_f32 v88, v88, v89
    v_cvt_pk_bf16_f32 v89, v90, v91
    ds_pk_add_bf16 v7, v88
    ds_pk_add_bf16 v7, v89 offset:4
    s_mov_b64 exec, vcc
    s_branch L2_d80
L2_xo81:
    v_cmp_lt_u32 vcc, 20, v99
    s_mov_b32 s43, 1
    s_cbranch_vccz L2_xp81
    v_cmp_lt_u32 vcc, 32, v99
    v_cmp_lt_u32 s[58:59], 31, v88
    s_mov_b32 s43, 2
    s_or_b64 vcc, vcc, s[58:59]
    s_cbranch_scc0 L2_xp81
    s_mov_b32 s37, 0x10000
    s_branch L2_xp81
L2_c82:
    s_mov_b64 exec, s[82:83]
    s_nop 1
    v_mfma_f32_4x4x4_16b_bf16 v[88:91], v[12:13], v[84:85], 0
    s_nop 1
    v_mfma_f32_4x4x4_16b_bf16 v[88:91], v[10:11], v[86:87], v[88:91]
    s_nop 4
    v_cvt_pk_bf16_f32 v88, v88, v89
    v_cvt_pk_bf16_f32 v89, v90, v91
    ds_pk_add_bf16 v7, v88
    ds_pk_add_bf16 v7, v89 offset:4
    s_mov_b64 exec, vcc
    s_branch L2_d82
L2_c83:
    s_mov_b64 exec, s[82:83]
    s_nop 1
    v_mfma_f32_4x4x4_16b_bf16 v[88:91], v[12:13], v[84:85], 0
    s_nop 1
    v_mfma_f32_4x4x4_16b_bf16 v[88:91], v[10:11], v[86:87], v[88:91]
    s_nop 4
    v_cvt_pk_bf16_f32 v88, v88, v89
    v_cvt_pk_bf16_f32 v89, v90, v91
    ds_pk_add_bf16 v7, v88
    ds_pk_add_bf16 v7, v89 offset:4
    s_mov_b64 exec, vcc
    s_branch L2_d83
L2_c84:
    s_mov_b64 exec, s[82:83]
    s_nop 1
    v_mfma_f32_4x4x4_16b_bf16 v[88:91], v[12:13], v[84:85], 0
    s_nop 1
    v_mfma_f32_4x4x4_16b_bf16 v[88:91], v[10:11], v[86:87], v[88:91]
    s_nop 4
    v_cvt_pk_bf16_f32 v88, v88, v89
    v_cvt_pk_bf16_f32 v89, v90, v91
    ds_pk_add_bf16 v7, v88
    ds_pk_add_bf16 v7, v89 offset:4
    s_mov_b64 exec, vcc
    s_branch L2_d84
L2_c85:
    s_mov_b64 exec, s[82:83]
    s_nop 1
    v_mfma_f32_4x4x4_16b_bf16 v[88:91], v[12:13], v[84:85], 0
    s_nop 1
    v_mfma_f32_4x4x4_16b_bf16 v[88:91], v[10:11], v[86:87], v[88:91]
    s_nop 4
    v_cvt_pk_bf16_f32 v88, v88, v89
    v_cvt_pk_bf16_f32 v89, v90, v91
    ds_pk_add_bf16 v7, v88
    ds_pk_add_bf16 v7, v89 offset:4
    s_mov_b64 exec, vcc
    s_branch L2_d85
L2_c86:
    s_mov_b64 exec, s[82:83]
    s_nop 1
    v_mfma_f32_4x4x4_16b_bf16 v[88:91], v[12:13], v[84:85], 0
    s_nop 1
    v_mfma_f32_4x4x4_16b_bf16 v[88:91], v[10:11], v[86:87], v[88:91]
    s_nop 4
    v_cvt_pk_bf16_f32 v88, v88, v89
    v_cvt_pk_bf16_f32 v89, v90, v91
    ds_pk_add_bf16 v7, v88
    ds_pk_add_bf16 v7, v89 offset:4
    s_mov_b64 exec, vcc
    s_branch L2_d86
L2_c87:
    s_mov_b64 exec, s[82:83]
    s_nop 1
    v_mfma_f32_4x4x4_16b_bf16 v[88:91], v[12:13], v[84:85], 0
    s_nop 1
    v_mfma_f32_4x4x4_16b_bf16 v[88:91], v[10:11], v[86:87], v[88:91]
    s_nop 4
    v_cvt_pk_bf16_f32 v88, v88, v89
    v_cvt_pk_bf16_f32 v89, v90, v91
    ds_pk_add_bf16 v7, v88
    ds_pk_add_bf16 v7, v89 offset:4
    s_mov_b64 exec, vcc
    s_branch L2_d87
L2_c88:
    s_mov_b64 exec, s[82:83]
    s_nop 1
    v_mfma_f32_4x4x4_16b_bf16 v[88:91], v[12:13], v[84:85], 0
    s_nop 1
    v_mfma_f32_4x4x4_16b_bf16 v[88:91], v[10:11], v[86:87], v[88:91]
    s_nop 4
    v_cvt_pk_bf16_f32 v88, v88, v89
    v_cvt_pk_bf16_f32 v89, v90, v91
    ds_pk_add_bf16 v7, v88
    ds_pk_add_bf16 v7, v89 offset:4
    s_mov_b64 exec, vcc
    s_branch L2_d88
L2_c89:
    s_mov_b64 exec, s[82:83]
    s_nop 1
    v_mfma_f32_4x4x4_16b_bf16 v[88:91], v[12:13], v[84:85], 0
    s_nop 1
    v_mfma_f32_4x4x4_16b_bf16 v[88:91], v[10:11], v[86:87], v[88:91]
    s_nop 4
    v_cvt_pk_bf16_f32 v88, v88, v89
    v_cvt_pk_bf16_f32 v89, v90, v91
    ds_pk_add_bf16 v7, v88
    ds_pk_add_bf16 v7, v89 offset:4
    s_mov_b64 exec, vcc
    s_branch L2_d89
L2_xa90:
    s_cmp_eq_u32 s43, 1
    s_cbranch_scc1 L2_xc90
    v_lshlrev_b32 v89, 0, v96
    v_add_u32 v90, 140, v97
    v_bitop3_b32 v90, v89, v45, v90 bitop3:0x6a
    ds_write_b32 v98, v90 offset:28
    v_lshlrev_b32 v89, 4, v96
    v_add_u32 v90, 120, v97
    v_bitop3_b32 v90, v89, v45, v90 bitop3:0x6a
    ds_write_b32 v98, v90 offset:24
    v_lshlrev_b32 v89, 8, v96
    v_add_u32 v90, 100, v97
    v_bitop3_b32 v90, v89, v45, v90 bitop3:0x6a
    ds_write_b32 v98, v90 offset:20
L2_xc90:
    v_lshlrev_b32 v89, 12, v96
    v_add_u32 v90, 80, v97
    v_bitop3_b32 v90, v89, v45, v90 bitop3:0x6a
    ds_write_b32 v98, v90 offset:16
    s_branch L2_xb90
L2_xe90:
    v_cmp_lt_u32 vcc, 32, v99
    v_cmp_lt_u32 s[58:59], 31, v88
    v_lshrrev_b32 v89, 16, v96
    v_add_u32 v97, 80, v97
    s_or_b64 vcc, vcc, s[58:59]
    s_cbranch_scc1 L2_xs90
    v_lshlrev_b32 v89, v1, v89
    v_and_b32 v89, v45, v89
    v_cmp_ne_u32 vcc, 0, v89
    v_xor_b32 v90, v97, v89
    s_add_u32 s3, s37, s38
    v_mbcnt_lo_u32_b32 v98, vcc_lo, 0
    v_mbcnt_hi_u32_b32 v98, vcc_hi, v98
    s_bcnt1_i32_b64 s41, vcc
    v_lshl_add_u32 v98, v98, 2, s3
    s_mov_b64 exec, vcc
    ds_write_b32 v98, v90
    s_mov_b64 exec, -1
    s_lshl2_add_u32 s37, s41, s37
    s_branch L2_xr90
L2_xf90:
    s_waitcnt lgkmcnt(0)
    s_cmp_gt_u32 s37, 1024
    s_cbranch_scc1 L2_xs90
    v_mov_b32 v43, -1
    s_cmp_ge_u32 s37, 512
    s_cbranch_scc1 L2_xg90
    v_mov_b32 v42, -1
    s_cmp_ge_u32 s37, 256
    s_cbranch_scc1 L2_xg90
    v_mov_b32 v41, -1
    s_branch L2_xg90
L2_xs90:
    s_waitcnt lgkmcnt(0)
    v_mov_b32 v40, -1
    v_mov_b32 v41, -1
    v_mov_b32 v42, -1
    v_mov_b32 v43, -1
    s_add_u32 s3, s42, 2
    s_bitset1_b32 s36, s3
    s_branch L2_xg90
L2_c91:
    s_mov_b64 exec, s[82:83]
    s_nop 1
    v_mfma_f32_4x4x4_16b_bf16 v[88:91], v[12:13], v[84:85], 0
    s_nop 1
    v_mfma_f32_4x4x4_16b_bf16 v[88:91], v[10:11], v[86:87], v[88:91]
    s_nop 4
    v_cvt_pk_bf16_f32 v88, v88, v89
    v_cvt_pk_bf16_f32 v89, v90, v91
    ds_pk_add_bf16 v7, v88
    ds_pk_add_bf16 v7, v89 offset:4
    s_mov_b64 exec, vcc
    s_branch L2_d91
L2_c92:
    s_mov_b64 exec, s[82:83]
    s_nop 1
    v_mfma_f32_4x4x4_16b_bf16 v[88:91], v[12:13], v[84:85], 0
    s_nop 1
    v_mfma_f32_4x4x4_16b_bf16 v[88:91], v[10:11], v[86:87], v[88:91]
    s_nop 4
    v_cvt_pk_bf16_f32 v88, v88, v89
    v_cvt_pk_bf16_f32 v89, v90, v91
    ds_pk_add_bf16 v7, v88
    ds_pk_add_bf16 v7, v89 offset:4
    s_mov_b64 exec, vcc
    s_branch L2_d92
L2_c93:
    s_mov_b64 exec, s[82:83]
    s_nop 1
    v_mfma_f32_4x4x4_16b_bf16 v[88:91], v[12:13], v[84:85], 0
    s_nop 1
    v_mfma_f32_4x4x4_16b_bf16 v[88:91], v[10:11], v[86:87], v[88:91]
    s_nop 4
    v_cvt_pk_bf16_f32 v88, v88, v89
    v_cvt_pk_bf16_f32 v89, v90, v91
    ds_pk_add_bf16 v7, v88
    ds_pk_add_bf16 v7, v89 offset:4
    s_mov_b64 exec, vcc
    s_branch L2_d93
L2_c94:
    s_mov_b64 exec, s[82:83]
    s_nop 1
    v_mfma_f32_4x4x4_16b_bf16 v[88:91], v[12:13], v[84:85], 0
    s_nop 1
    v_mfma_f32_4x4x4_16b_bf16 v[88:91], v[10:11], v[86:87], v[88:91]
    s_nop 4
    v_cvt_pk_bf16_f32 v88, v88, v89
    v_cvt_pk_bf16_f32 v89, v90, v91
    ds_pk_add_bf16 v7, v88
    ds_pk_add_bf16 v7, v89 offset:4
    s_mov_b64 exec, vcc
    s_branch L2_d94
L2_c95:
    s_mov_b64 exec, s[82:83]
    s_nop 1
    v_mfma_f32_4x4x4_16b_bf16 v[88:91], v[12:13], v[84:85], 0
    s_nop 1
    v_mfma_f32_4x4x4_16b_bf16 v[88:91], v[10:11], v[86:87], v[88:91]
    s_nop 4
    v_cvt_pk_bf16_f32 v88, v88, v89
    v_cvt_pk_bf16_f32 v89, v90, v91
    ds_pk_add_bf16 v7, v88
    ds_pk_add_bf16 v7, v89 offset:4
    s_mov_b64 exec, vcc
    s_branch L2_d95
L2_c96:
    s_mov_b64 exec, s[82:83]
    s_nop 1
    v_mfma_f32_4x4x4_16b_bf16 v[88:91], v[12:13], v[84:85], 0
    s_nop 1
    v_mfma_f32_4x4x4_16b_bf16 v[88:91], v[10:11], v[86:87], v[88:91]
    s_nop 4
    v_cvt_pk_bf16_f32 v88, v88, v89
    v_cvt_pk_bf16_f32 v89, v90, v91
    ds_pk_add_bf16 v7, v88
    ds_pk_add_bf16 v7, v89 offset:4
    s_mov_b64 exec, vcc
    s_branch L2_d96
L2_c97:
    s_mov_b64 exec, s[82:83]
    s_nop 1
    v_mfma_f32_4x4x4_16b_bf16 v[88:91], v[12:13], v[84:85], 0
    s_nop 1
    v_mfma_f32_4x4x4_16b_bf16 v[88:91], v[10:11], v[86:87], v[88:91]
    s_nop 4
    v_cvt_pk_bf16_f32 v88, v88, v89
    v_cvt_pk_bf16_f32 v89, v90, v91
    ds_pk_add_bf16 v7, v88
    ds_pk_add_bf16 v7, v89 offset:4
    s_mov_b64 exec, vcc
    s_branch L2_d97
L2_c98:
    s_mov_b64 exec, s[82:83]
    s_nop 1
    v_mfma_f32_4x4x4_16b_bf16 v[88:91], v[12:13], v[84:85], 0
    s_nop 1
    v_mfma_f32_4x4x4_16b_bf16 v[88:91], v[10:11], v[86:87], v[88:91]
    s_nop 4
    v_cvt_pk_bf16_f32 v88, v88, v89
    v_cvt_pk_bf16_f32 v89, v90, v91
    ds_pk_add_bf16 v7, v88
    ds_pk_add_bf16 v7, v89 offset:4
    s_mov_b64 exec, vcc
    s_branch L2_d98
L2_xo99:
    v_cmp_lt_u32 vcc, 20, v99
    s_mov_b32 s43, 1
    s_cbranch_vccz L2_xp99
    v_cmp_lt_u32 vcc, 32, v99
    v_cmp_lt_u32 s[58:59], 31, v88
    s_mov_b32 s43, 2
    s_or_b64 vcc, vcc, s[58:59]
    s_cbranch_scc0 L2_xp99
    s_mov_b32 s37, 0x10000
    s_branch L2_xp99
L2_c100:
    s_mov_b64 exec, s[82:83]
    s_nop 1
    v_mfma_f32_4x4x4_16b_bf16 v[88:91], v[12:13], v[84:85], 0
    s_nop 1
    v_mfma_f32_4x4x4_16b_bf16 v[88:91], v[10:11], v[86:87], v[88:91]
    s_nop 4
    v_cvt_pk_bf16_f32 v88, v88, v89
    v_cvt_pk_bf16_f32 v89, v90, v91
    ds_pk_add_bf16 v7, v88
    ds_pk_add_bf16 v7, v89 offset:4
    s_mov_b64 exec, vcc
    s_branch L2_d100
L2_c101:
    s_mov_b64 exec, s[82:83]
    s_nop 1
    v_mfma_f32_4x4x4_16b_bf16 v[88:91], v[12:13], v[84:85], 0
    s_nop 1
    v_mfma_f32_4x4x4_16b_bf16 v[88:91], v[10:11], v[86:87], v[88:91]
    s_nop 4
    v_cvt_pk_bf16_f32 v88, v88, v89
    v_cvt_pk_bf16_f32 v89, v90, v91
    ds_pk_add_bf16 v7, v88
    ds_pk_add_bf16 v7, v89 offset:4
    s_mov_b64 exec, vcc
    s_branch L2_d101
L2_c102:
    s_mov_b64 exec, s[82:83]
    s_nop 1
    v_mfma_f32_4x4x4_16b_bf16 v[88:91], v[12:13], v[84:85], 0
    s_nop 1
    v_mfma_f32_4x4x4_16b_bf16 v[88:91], v[10:11], v[86:87], v[88:91]
    s_nop 4
    v_cvt_pk_bf16_f32 v88, v88, v89
    v_cvt_pk_bf16_f32 v89, v90, v91
    ds_pk_add_bf16 v7, v88
    ds_pk_add_bf16 v7, v89 offset:4
    s_mov_b64 exec, vcc
    s_branch L2_d102
L2_c103:
    s_mov_b64 exec, s[82:83]
    s_nop 1
    v_mfma_f32_4x4x4_16b_bf16 v[88:91], v[12:13], v[84:85], 0
    s_nop 1
    v_mfma_f32_4x4x4_16b_bf16 v[88:91], v[10:11], v[86:87], v[88:91]
    s_nop 4
    v_cvt_pk_bf16_f32 v88, v88, v89
    v_cvt_pk_bf16_f32 v89, v90, v91
    ds_pk_add_bf16 v7, v88
    ds_pk_add_bf16 v7, v89 offset:4
    s_mov_b64 exec, vcc
    s_branch L2_d103
L2_c104:
    s_mov_b64 exec, s[82:83]
    s_nop 1
    v_mfma_f32_4x4x4_16b_bf16 v[88:91], v[12:13], v[84:85], 0
    s_nop 1
    v_mfma_f32_4x4x4_16b_bf16 v[88:91], v[10:11], v[86:87], v[88:91]
    s_nop 4
    v_cvt_pk_bf16_f32 v88, v88, v89
    v_cvt_pk_bf16_f32 v89, v90, v91
    ds_pk_add_bf16 v7, v88
    ds_pk_add_bf16 v7, v89 offset:4
    s_mov_b64 exec, vcc
    s_branch L2_d104
L2_c105:
    s_mov_b64 exec, s[82:83]
    s_nop 1
    v_mfma_f32_4x4x4_16b_bf16 v[88:91], v[12:13], v[84:85], 0
    s_nop 1
    v_mfma_f32_4x4x4_16b_bf16 v[88:91], v[10:11], v[86:87], v[88:91]
    s_nop 4
    v_cvt_pk_bf16_f32 v88, v88, v89
    v_cvt_pk_bf16_f32 v89, v90, v91
    ds_pk_add_bf16 v7, v88
    ds_pk_add_bf16 v7, v89 offset:4
    s_mov_b64 exec, vcc
    s_branch L2_d105
L2_c106:
    s_mov_b64 exec, s[82:83]
    s_nop 1
    v_mfma_f32_4x4x4_16b_bf16 v[88:91], v[12:13], v[84:85], 0
    s_nop 1
    v_mfma_f32_4x4x4_16b_bf16 v[88:91], v[10:11], v[86:87], v[88:91]
    s_nop 4
    v_cvt_pk_bf16_f32 v88, v88, v89
    v_cvt_pk_bf16_f32 v89, v90, v91
    ds_pk_add_bf16 v7, v88
    ds_pk_add_bf16 v7, v89 offset:4
    s_mov_b64 exec, vcc
    s_branch L2_d106
L2_c107:
    s_mov_b64 exec, s[82:83]
    s_nop 1
    v_mfma_f32_4x4x4_16b_bf16 v[88:91], v[12:13], v[84:85], 0
    s_nop 1
    v_mfma_f32_4x4x4_16b_bf16 v[88:91], v[10:11], v[86:87], v[88:91]
    s_nop 4
    v_cvt_pk_bf16_f32 v88, v88, v89
    v_cvt_pk_bf16_f32 v89, v90, v91
    ds_pk_add_bf16 v7, v88
    ds_pk_add_bf16 v7, v89 offset:4
    s_mov_b64 exec, vcc
    s_branch L2_d107
L2_xa108:
    s_cmp_eq_u32 s43, 1
    s_cbranch_scc1 L2_xc108
    v_lshlrev_b32 v89, 0, v96
    v_add_u32 v90, 140, v97
    v_bitop3_b32 v90, v89, v45, v90 bitop3:0x6a
    ds_write_b32 v98, v90 offset:28
    v_lshlrev_b32 v89, 4, v96
    v_add_u32 v90, 120, v97
    v_bitop3_b32 v90, v89, v45, v90 bitop3:0x6a
    ds_write_b32 v98, v90 offset:24
    v_lshlrev_b32 v89, 8, v96
    v_add_u32 v90, 100, v97
    v_bitop3_b32 v90, v89, v45, v90 bitop3:0x6a
    ds_write_b32 v98, v90 offset:20
L2_xc108:
    v_lshlrev_b32 v89, 12, v96
    v_add_u32 v90, 80, v97
    v_bitop3_b32 v90, v89, v45, v90 bitop3:0x6a
    ds_write_b32 v98, v90 offset:16
    s_branch L2_xb108
L2_xe108:
    v_cmp_lt_u32 vcc, 32, v99
    v_cmp_lt_u32 s[58:59], 31, v88
    v_lshrrev_b32 v89, 16, v96
    v_add_u32 v97, 80, v97
    s_or_b64 vcc, vcc, s[58:59]
    s_cbranch_scc1 L2_xs108
    v_lshlrev_b32 v89, v1, v89
    v_and_b32 v89, v45, v89
    v_cmp_ne_u32 vcc, 0, v89
    v_xor_b32 v90, v97, v89
    s_add_u32 s3, s37, s38
    v_mbcnt_lo_u32_b32 v98, vcc_lo, 0
    v_mbcnt_hi_u32_b32 v98, vcc_hi, v98
    s_bcnt1_i32_b64 s41, vcc
    v_lshl_add_u32 v98, v98, 2, s3
    s_mov_b64 exec, vcc
    ds_write_b32 v98, v90
    s_mov_b64 exec, -1
    s_lshl2_add_u32 s37, s41, s37
    s_branch L2_xr108
L2_xf108:
    s_waitcnt lgkmcnt(0)
    s_cmp_gt_u32 s37, 1024
    s_cbranch_scc1 L2_xs108
    v_mov_b32 v43, -1
    s_cmp_ge_u32 s37, 512
    s_cbranch_scc1 L2_xg108
    v_mov_b32 v42, -1
    s_cmp_ge_u32 s37, 256
    s_cbranch_scc1 L2_xg108
    v_mov_b32 v41, -1
    s_branch L2_xg108
L2_xs108:
    s_waitcnt lgkmcnt(0)
    v_mov_b32 v40, -1
    v_mov_b32 v41, -1
    v_mov_b32 v42, -1
    v_mov_b32 v43, -1
    s_add_u32 s3, s42, 2
    s_bitset1_b32 s36, s3
    s_branch L2_xg108
L2_c109:
    s_mov_b64 exec, s[82:83]
    s_nop 1
    v_mfma_f32_4x4x4_16b_bf16 v[88:91], v[12:13], v[84:85], 0
    s_nop 1
    v_mfma_f32_4x4x4_16b_bf16 v[88:91], v[10:11], v[86:87], v[88:91]
    s_nop 4
    v_cvt_pk_bf16_f32 v88, v88, v89
    v_cvt_pk_bf16_f32 v89, v90, v91
    ds_pk_add_bf16 v7, v88
    ds_pk_add_bf16 v7, v89 offset:4
    s_mov_b64 exec, vcc
    s_branch L2_d109
L2_c110:
    s_mov_b64 exec, s[82:83]
    s_nop 1
    v_mfma_f32_4x4x4_16b_bf16 v[88:91], v[12:13], v[84:85], 0
    s_nop 1
    v_mfma_f32_4x4x4_16b_bf16 v[88:91], v[10:11], v[86:87], v[88:91]
    s_nop 4
    v_cvt_pk_bf16_f32 v88, v88, v89
    v_cvt_pk_bf16_f32 v89, v90, v91
    ds_pk_add_bf16 v7, v88
    ds_pk_add_bf16 v7, v89 offset:4
    s_mov_b64 exec, vcc
    s_branch L2_d110
L2_c111:
    s_mov_b64 exec, s[82:83]
    s_nop 1
    v_mfma_f32_4x4x4_16b_bf16 v[88:91], v[12:13], v[84:85], 0
    s_nop 1
    v_mfma_f32_4x4x4_16b_bf16 v[88:91], v[10:11], v[86:87], v[88:91]
    s_nop 4
    v_cvt_pk_bf16_f32 v88, v88, v89
    v_cvt_pk_bf16_f32 v89, v90, v91
    ds_pk_add_bf16 v7, v88
    ds_pk_add_bf16 v7, v89 offset:4
    s_mov_b64 exec, vcc
    s_branch L2_d111
L2_c112:
    s_mov_b64 exec, s[82:83]
    s_nop 1
    v_mfma_f32_4x4x4_16b_bf16 v[88:91], v[12:13], v[84:85], 0
    s_nop 1
    v_mfma_f32_4x4x4_16b_bf16 v[88:91], v[10:11], v[86:87], v[88:91]
    s_nop 4
    v_cvt_pk_bf16_f32 v88, v88, v89
    v_cvt_pk_bf16_f32 v89, v90, v91
    ds_pk_add_bf16 v7, v88
    ds_pk_add_bf16 v7, v89 offset:4
    s_mov_b64 exec, vcc
    s_branch L2_d112
L2_c113:
    s_mov_b64 exec, s[82:83]
    s_nop 1
    v_mfma_f32_4x4x4_16b_bf16 v[88:91], v[12:13], v[84:85], 0
    s_nop 1
    v_mfma_f32_4x4x4_16b_bf16 v[88:91], v[10:11], v[86:87], v[88:91]
    s_nop 4
    v_cvt_pk_bf16_f32 v88, v88, v89
    v_cvt_pk_bf16_f32 v89, v90, v91
    ds_pk_add_bf16 v7, v88
    ds_pk_add_bf16 v7, v89 offset:4
    s_mov_b64 exec, vcc
    s_branch L2_d113
L2_c114:
    s_mov_b64 exec, s[82:83]
    s_nop 1
    v_mfma_f32_4x4x4_16b_bf16 v[88:91], v[12:13], v[84:85], 0
    s_nop 1
    v_mfma_f32_4x4x4_16b_bf16 v[88:91], v[10:11], v[86:87], v[88:91]
    s_nop 4
    v_cvt_pk_bf16_f32 v88, v88, v89
    v_cvt_pk_bf16_f32 v89, v90, v91
    ds_pk_add_bf16 v7, v88
    ds_pk_add_bf16 v7, v89 offset:4
    s_mov_b64 exec, vcc
    s_branch L2_d114
L2_c115:
    s_mov_b64 exec, s[82:83]
    s_nop 1
    v_mfma_f32_4x4x4_16b_bf16 v[88:91], v[12:13], v[84:85], 0
    s_nop 1
    v_mfma_f32_4x4x4_16b_bf16 v[88:91], v[10:11], v[86:87], v[88:91]
    s_nop 4
    v_cvt_pk_bf16_f32 v88, v88, v89
    v_cvt_pk_bf16_f32 v89, v90, v91
    ds_pk_add_bf16 v7, v88
    ds_pk_add_bf16 v7, v89 offset:4
    s_mov_b64 exec, vcc
    s_branch L2_d115
L2_c116:
    s_mov_b64 exec, s[82:83]
    s_nop 1
    v_mfma_f32_4x4x4_16b_bf16 v[88:91], v[12:13], v[84:85], 0
    s_nop 1
    v_mfma_f32_4x4x4_16b_bf16 v[88:91], v[10:11], v[86:87], v[88:91]
    s_nop 4
    v_cvt_pk_bf16_f32 v88, v88, v89
    v_cvt_pk_bf16_f32 v89, v90, v91
    ds_pk_add_bf16 v7, v88
    ds_pk_add_bf16 v7, v89 offset:4
    s_mov_b64 exec, vcc
    s_branch L2_d116
L2_c117:
    s_mov_b64 exec, s[82:83]
    s_nop 1
    v_mfma_f32_4x4x4_16b_bf16 v[88:91], v[12:13], v[84:85], 0
    s_nop 1
    v_mfma_f32_4x4x4_16b_bf16 v[88:91], v[10:11], v[86:87], v[88:91]
    s_nop 4
    v_cvt_pk_bf16_f32 v88, v88, v89
    v_cvt_pk_bf16_f32 v89, v90, v91
    ds_pk_add_bf16 v7, v88
    ds_pk_add_bf16 v7, v89 offset:4
    s_mov_b64 exec, vcc
    s_branch L2_d117
L2_c118:
    s_mov_b64 exec, s[82:83]
    s_nop 1
    v_mfma_f32_4x4x4_16b_bf16 v[88:91], v[12:13], v[84:85], 0
    s_nop 1
    v_mfma_f32_4x4x4_16b_bf16 v[88:91], v[10:11], v[86:87], v[88:91]
    s_nop 4
    v_cvt_pk_bf16_f32 v88, v88, v89
    v_cvt_pk_bf16_f32 v89, v90, v91
    ds_pk_add_bf16 v7, v88
    ds_pk_add_bf16 v7, v89 offset:4
    s_mov_b64 exec, vcc
    s_branch L2_d118
L2_c119:
    s_mov_b64 exec, s[82:83]
    s_nop 1
    v_mfma_f32_4x4x4_16b_bf16 v[88:91], v[12:13], v[84:85], 0
    s_nop 1
    v_mfma_f32_4x4x4_16b_bf16 v[88:91], v[10:11], v[86:87], v[88:91]
    s_nop 4
    v_cvt_pk_bf16_f32 v88, v88, v89
    v_cvt_pk_bf16_f32 v89, v90, v91
    ds_pk_add_bf16 v7, v88
    ds_pk_add_bf16 v7, v89 offset:4
    s_mov_b64 exec, vcc
    s_branch L2_d119
L2_c120:
    s_mov_b64 exec, s[82:83]
    s_nop 1
    v_mfma_f32_4x4x4_16b_bf16 v[88:91], v[12:13], v[84:85], 0
    s_nop 1
    v_mfma_f32_4x4x4_16b_bf16 v[88:91], v[10:11], v[86:87], v[88:91]
    s_nop 4
    v_cvt_pk_bf16_f32 v88, v88, v89
    v_cvt_pk_bf16_f32 v89, v90, v91
    ds_pk_add_bf16 v7, v88
    ds_pk_add_bf16 v7, v89 offset:4
    s_mov_b64 exec, vcc
    s_branch L2_d120
L2_c121:
    s_mov_b64 exec, s[82:83]
    s_nop 1
    v_mfma_f32_4x4x4_16b_bf16 v[88:91], v[12:13], v[84:85], 0
    s_nop 1
    v_mfma_f32_4x4x4_16b_bf16 v[88:91], v[10:11], v[86:87], v[88:91]
    s_nop 4
    v_cvt_pk_bf16_f32 v88, v88, v89
    v_cvt_pk_bf16_f32 v89, v90, v91
    ds_pk_add_bf16 v7, v88
    ds_pk_add_bf16 v7, v89 offset:4
    s_mov_b64 exec, vcc
    s_branch L2_d121
L2_c122:
    s_mov_b64 exec, s[82:83]
    s_nop 1
    v_mfma_f32_4x4x4_16b_bf16 v[88:91], v[12:13], v[84:85], 0
    s_nop 1
    v_mfma_f32_4x4x4_16b_bf16 v[88:91], v[10:11], v[86:87], v[88:91]
    s_nop 4
    v_cvt_pk_bf16_f32 v88, v88, v89
    v_cvt_pk_bf16_f32 v89, v90, v91
    ds_pk_add_bf16 v7, v88
    ds_pk_add_bf16 v7, v89 offset:4
    s_mov_b64 exec, vcc
    s_branch L2_d122
L2_c123:
    s_mov_b64 exec, s[82:83]
    s_nop 1
    v_mfma_f32_4x4x4_16b_bf16 v[88:91], v[12:13], v[84:85], 0
    s_nop 1
    v_mfma_f32_4x4x4_16b_bf16 v[88:91], v[10:11], v[86:87], v[88:91]
    s_nop 4
    v_cvt_pk_bf16_f32 v88, v88, v89
    v_cvt_pk_bf16_f32 v89, v90, v91
    ds_pk_add_bf16 v7, v88
    ds_pk_add_bf16 v7, v89 offset:4
    s_mov_b64 exec, vcc
    s_branch L2_d123
L2_c124:
    s_mov_b64 exec, s[82:83]
    s_nop 1
    v_mfma_f32_4x4x4_16b_bf16 v[88:91], v[12:13], v[84:85], 0
    s_nop 1
    v_mfma_f32_4x4x4_16b_bf16 v[88:91], v[10:11], v[86:87], v[88:91]
    s_nop 4
    v_cvt_pk_bf16_f32 v88, v88, v89
    v_cvt_pk_bf16_f32 v89, v90, v91
    ds_pk_add_bf16 v7, v88
    ds_pk_add_bf16 v7, v89 offset:4
    s_mov_b64 exec, vcc
    s_branch L2_d124
L2_c125:
    s_mov_b64 exec, s[82:83]
    s_nop 1
    v_mfma_f32_4x4x4_16b_bf16 v[88:91], v[12:13], v[84:85], 0
    s_nop 1
    v_mfma_f32_4x4x4_16b_bf16 v[88:91], v[10:11], v[86:87], v[88:91]
    s_nop 4
    v_cvt_pk_bf16_f32 v88, v88, v89
    v_cvt_pk_bf16_f32 v89, v90, v91
    ds_pk_add_bf16 v7, v88
    ds_pk_add_bf16 v7, v89 offset:4
    s_mov_b64 exec, vcc
    s_branch L2_d125
L2_c126:
    s_mov_b64 exec, s[82:83]
    s_nop 1
    v_mfma_f32_4x4x4_16b_bf16 v[88:91], v[12:13], v[84:85], 0
    s_nop 1
    v_mfma_f32_4x4x4_16b_bf16 v[88:91], v[10:11], v[86:87], v[88:91]
    s_nop 4
    v_cvt_pk_bf16_f32 v88, v88, v89
    v_cvt_pk_bf16_f32 v89, v90, v91
    ds_pk_add_bf16 v7, v88
    ds_pk_add_bf16 v7, v89 offset:4
    s_mov_b64 exec, vcc
    s_branch L2_d126
L2_c127:
    s_mov_b64 exec, s[82:83]
    s_nop 1
    v_mfma_f32_4x4x4_16b_bf16 v[88:91], v[12:13], v[84:85], 0
    s_nop 1
    v_mfma_f32_4x4x4_16b_bf16 v[88:91], v[10:11], v[86:87], v[88:91]
    s_nop 4
    v_cvt_pk_bf16_f32 v88, v88, v89
    v_cvt_pk_bf16_f32 v89, v90, v91
    ds_pk_add_bf16 v7, v88
    ds_pk_add_bf16 v7, v89 offset:4
    s_mov_b64 exec, vcc
    s_branch L2_d127
L2_c128:
    s_mov_b64 exec, s[82:83]
    s_nop 1
    v_mfma_f32_4x4x4_16b_bf16 v[88:91], v[12:13], v[84:85], 0
    s_nop 1
    v_mfma_f32_4x4x4_16b_bf16 v[88:91], v[10:11], v[86:87], v[88:91]
    s_nop 4
    v_cvt_pk_bf16_f32 v88, v88, v89
    v_cvt_pk_bf16_f32 v89, v90, v91
    ds_pk_add_bf16 v7, v88
    ds_pk_add_bf16 v7, v89 offset:4
    s_mov_b64 exec, vcc
    s_branch L2_d128
L2_c129:
    s_mov_b64 exec, s[82:83]
    s_nop 1
    v_mfma_f32_4x4x4_16b_bf16 v[88:91], v[12:13], v[84:85], 0
    s_nop 1
    v_mfma_f32_4x4x4_16b_bf16 v[88:91], v[10:11], v[86:87], v[88:91]
    s_nop 4
    v_cvt_pk_bf16_f32 v88, v88, v89
    v_cvt_pk_bf16_f32 v89, v90, v91
    ds_pk_add_bf16 v7, v88
    ds_pk_add_bf16 v7, v89 offset:4
    s_mov_b64 exec, vcc
    s_branch L2_d129
L2_c130:
    s_mov_b64 exec, s[82:83]
    s_nop 1
    v_mfma_f32_4x4x4_16b_bf16 v[88:91], v[12:13], v[84:85], 0
    s_nop 1
    v_mfma_f32_4x4x4_16b_bf16 v[88:91], v[10:11], v[86:87], v[88:91]
    s_nop 4
    v_cvt_pk_bf16_f32 v88, v88, v89
    v_cvt_pk_bf16_f32 v89, v90, v91
    ds_pk_add_bf16 v7, v88
    ds_pk_add_bf16 v7, v89 offset:4
    s_mov_b64 exec, vcc
    s_branch L2_d130
L2_c131:
    s_mov_b64 exec, s[82:83]
    s_nop 1
    v_mfma_f32_4x4x4_16b_bf16 v[88:91], v[12:13], v[84:85], 0
    s_nop 1
    v_mfma_f32_4x4x4_16b_bf16 v[88:91], v[10:11], v[86:87], v[88:91]
    s_nop 4
    v_cvt_pk_bf16_f32 v88, v88, v89
    v_cvt_pk_bf16_f32 v89, v90, v91
    ds_pk_add_bf16 v7, v88
    ds_pk_add_bf16 v7, v89 offset:4
    s_mov_b64 exec, vcc
    s_branch L2_d131
L2_c132:
    s_mov_b64 exec, s[82:83]
    s_nop 1
    v_mfma_f32_4x4x4_16b_bf16 v[88:91], v[12:13], v[84:85], 0
    s_nop 1
    v_mfma_f32_4x4x4_16b_bf16 v[88:91], v[10:11], v[86:87], v[88:91]
    s_nop 4
    v_cvt_pk_bf16_f32 v88, v88, v89
    v_cvt_pk_bf16_f32 v89, v90, v91
    ds_pk_add_bf16 v7, v88
    ds_pk_add_bf16 v7, v89 offset:4
    s_mov_b64 exec, vcc
    s_branch L2_d132
L2_c133:
    s_mov_b64 exec, s[82:83]
    s_nop 1
    v_mfma_f32_4x4x4_16b_bf16 v[88:91], v[12:13], v[84:85], 0
    s_nop 1
    v_mfma_f32_4x4x4_16b_bf16 v[88:91], v[10:11], v[86:87], v[88:91]
    s_nop 4
    v_cvt_pk_bf16_f32 v88, v88, v89
    v_cvt_pk_bf16_f32 v89, v90, v91
    ds_pk_add_bf16 v7, v88
    ds_pk_add_bf16 v7, v89 offset:4
    s_mov_b64 exec, vcc
    s_branch L2_d133
L2_c134:
    s_mov_b64 exec, s[82:83]
    s_nop 1
    v_mfma_f32_4x4x4_16b_bf16 v[88:91], v[12:13], v[84:85], 0
    s_nop 1
    v_mfma_f32_4x4x4_16b_bf16 v[88:91], v[10:11], v[86:87], v[88:91]
    s_nop 4
    v_cvt_pk_bf16_f32 v88, v88, v89
    v_cvt_pk_bf16_f32 v89, v90, v91
    ds_pk_add_bf16 v7, v88
    ds_pk_add_bf16 v7, v89 offset:4
    s_mov_b64 exec, vcc
    s_branch L2_d134
L2_c135:
    s_mov_b64 exec, s[82:83]
    s_nop 1
    v_mfma_f32_4x4x4_16b_bf16 v[88:91], v[12:13], v[84:85], 0
    s_nop 1
    v_mfma_f32_4x4x4_16b_bf16 v[88:91], v[10:11], v[86:87], v[88:91]
    s_nop 4
    v_cvt_pk_bf16_f32 v88, v88, v89
    v_cvt_pk_bf16_f32 v89, v90, v91
    ds_pk_add_bf16 v7, v88
    ds_pk_add_bf16 v7, v89 offset:4
    s_mov_b64 exec, vcc
    s_branch L2_d135
L2_c136:
    s_mov_b64 exec, s[82:83]
    s_nop 1
    v_mfma_f32_4x4x4_16b_bf16 v[88:91], v[12:13], v[84:85], 0
    s_nop 1
    v_mfma_f32_4x4x4_16b_bf16 v[88:91], v[10:11], v[86:87], v[88:91]
    s_nop 4
    v_cvt_pk_bf16_f32 v88, v88, v89
    v_cvt_pk_bf16_f32 v89, v90, v91
    ds_pk_add_bf16 v7, v88
    ds_pk_add_bf16 v7, v89 offset:4
    s_mov_b64 exec, vcc
    s_branch L2_d136
L2_c137:
    s_mov_b64 exec, s[82:83]
    s_nop 1
    v_mfma_f32_4x4x4_16b_bf16 v[88:91], v[12:13], v[84:85], 0
    s_nop 1
    v_mfma_f32_4x4x4_16b_bf16 v[88:91], v[10:11], v[86:87], v[88:91]
    s_nop 4
    v_cvt_pk_bf16_f32 v88, v88, v89
    v_cvt_pk_bf16_f32 v89, v90, v91
    ds_pk_add_bf16 v7, v88
    ds_pk_add_bf16 v7, v89 offset:4
    s_mov_b64 exec, vcc
    s_branch L2_d137
L2_c138:
    s_mov_b64 exec, s[82:83]
    s_nop 1
    v_mfma_f32_4x4x4_16b_bf16 v[88:91], v[12:13], v[84:85], 0
    s_nop 1
    v_mfma_f32_4x4x4_16b_bf16 v[88:91], v[10:11], v[86:87], v[88:91]
    s_nop 4
    v_cvt_pk_bf16_f32 v88, v88, v89
    v_cvt_pk_bf16_f32 v89, v90, v91
    ds_pk_add_bf16 v7, v88
    ds_pk_add_bf16 v7, v89 offset:4
    s_mov_b64 exec, vcc
    s_branch L2_d138
L2_c139:
    s_mov_b64 exec, s[82:83]
    s_nop 1
    v_mfma_f32_4x4x4_16b_bf16 v[88:91], v[12:13], v[84:85], 0
    s_nop 1
    v_mfma_f32_4x4x4_16b_bf16 v[88:91], v[10:11], v[86:87], v[88:91]
    s_nop 4
    v_cvt_pk_bf16_f32 v88, v88, v89
    v_cvt_pk_bf16_f32 v89, v90, v91
    ds_pk_add_bf16 v7, v88
    ds_pk_add_bf16 v7, v89 offset:4
    s_mov_b64 exec, vcc
    s_branch L2_d139
L2_c140:
    s_mov_b64 exec, s[82:83]
    s_nop 1
    v_mfma_f32_4x4x4_16b_bf16 v[88:91], v[12:13], v[84:85], 0
    s_nop 1
    v_mfma_f32_4x4x4_16b_bf16 v[88:91], v[10:11], v[86:87], v[88:91]
    s_nop 4
    v_cvt_pk_bf16_f32 v88, v88, v89
    v_cvt_pk_bf16_f32 v89, v90, v91
    ds_pk_add_bf16 v7, v88
    ds_pk_add_bf16 v7, v89 offset:4
    s_mov_b64 exec, vcc
    s_branch L2_d140
L2_c141:
    s_mov_b64 exec, s[82:83]
    s_nop 1
    v_mfma_f32_4x4x4_16b_bf16 v[88:91], v[12:13], v[84:85], 0
    s_nop 1
    v_mfma_f32_4x4x4_16b_bf16 v[88:91], v[10:11], v[86:87], v[88:91]
    s_nop 4
    v_cvt_pk_bf16_f32 v88, v88, v89
    v_cvt_pk_bf16_f32 v89, v90, v91
    ds_pk_add_bf16 v7, v88
    ds_pk_add_bf16 v7, v89 offset:4
    s_mov_b64 exec, vcc
    s_branch L2_d141
L2_c142:
    s_mov_b64 exec, s[82:83]
    s_nop 1
    v_mfma_f32_4x4x4_16b_bf16 v[88:91], v[12:13], v[84:85], 0
    s_nop 1
    v_mfma_f32_4x4x4_16b_bf16 v[88:91], v[10:11], v[86:87], v[88:91]
    s_nop 4
    v_cvt_pk_bf16_f32 v88, v88, v89
    v_cvt_pk_bf16_f32 v89, v90, v91
    ds_pk_add_bf16 v7, v88
    ds_pk_add_bf16 v7, v89 offset:4
    s_mov_b64 exec, vcc
    s_branch L2_d142
L2_c143:
    s_mov_b64 exec, s[82:83]
    s_nop 1
    v_mfma_f32_4x4x4_16b_bf16 v[88:91], v[12:13], v[84:85], 0
    s_nop 1
    v_mfma_f32_4x4x4_16b_bf16 v[88:91], v[10:11], v[86:87], v[88:91]
    s_nop 4
    v_cvt_pk_bf16_f32 v88, v88, v89
    v_cvt_pk_bf16_f32 v89, v90, v91
    ds_pk_add_bf16 v7, v88
    ds_pk_add_bf16 v7, v89 offset:4
    s_mov_b64 exec, vcc
    s_branch L2_d143
L2_c144:
    s_mov_b64 exec, s[82:83]
    s_nop 1
    v_mfma_f32_4x4x4_16b_bf16 v[88:91], v[12:13], v[84:85], 0
    s_nop 1
    v_mfma_f32_4x4x4_16b_bf16 v[88:91], v[10:11], v[86:87], v[88:91]
    s_nop 4
    v_cvt_pk_bf16_f32 v88, v88, v89
    v_cvt_pk_bf16_f32 v89, v90, v91
    ds_pk_add_bf16 v7, v88
    ds_pk_add_bf16 v7, v89 offset:4
    s_mov_b64 exec, vcc
    s_branch L2_d144
L2_c145:
    s_mov_b64 exec, s[82:83]
    s_nop 1
    v_mfma_f32_4x4x4_16b_bf16 v[88:91], v[12:13], v[84:85], 0
    s_nop 1
    v_mfma_f32_4x4x4_16b_bf16 v[88:91], v[10:11], v[86:87], v[88:91]
    s_nop 4
    v_cvt_pk_bf16_f32 v88, v88, v89
    v_cvt_pk_bf16_f32 v89, v90, v91
    ds_pk_add_bf16 v7, v88
    ds_pk_add_bf16 v7, v89 offset:4
    s_mov_b64 exec, vcc
    s_branch L2_d145
L2_c146:
    s_mov_b64 exec, s[82:83]
    s_nop 1
    v_mfma_f32_4x4x4_16b_bf16 v[88:91], v[12:13], v[84:85], 0
    s_nop 1
    v_mfma_f32_4x4x4_16b_bf16 v[88:91], v[10:11], v[86:87], v[88:91]
    s_nop 4
    v_cvt_pk_bf16_f32 v88, v88, v89
    v_cvt_pk_bf16_f32 v89, v90, v91
    ds_pk_add_bf16 v7, v88
    ds_pk_add_bf16 v7, v89 offset:4
    s_mov_b64 exec, vcc
    s_branch L2_d146
.text
.globl gs_final_kernel
.p2align 8
.type gs_final_kernel,@function
gs_final_kernel:
    s_cmp_ge_u32 s2, 1250
    s_cbranch_scc1 L3_end
    s_load_dwordx2 s[4:5], s[0:1], 0
    s_load_dwordx2 s[6:7], s[0:1], 24
    s_load_dwordx2 s[28:29], s[0:1], 40
    s_load_dwordx2 s[30:31], s[0:1], 88
    s_load_dwordx2 s[32:33], s[0:1], 104
    s_lshl_b32 s3, s2, 8
    v_add_u32 v1, s3, v0
    v_lshlrev_b32 v2, 4, v1
    v_lshlrev_b32 v3, 2, v1
    v_bfe_u32 v4, v1, 3, 6
    s_mov_b32 s3, 80000
    v_mul_lo_u32 v4, v4, s3
    v_lshrrev_b32 v5, 9, v1
    v_lshl_add_u32 v4, v5, 7, v4
    v_and_b32 v5, 7, v1
    v_lshl_add_u32 v4, v5, 4, v4
    v_and_b32 v5, 3, v0
    v_lshlrev_b32 v5, 6, v5
    s_waitcnt lgkmcnt(0)
    s_load_dwordx4 s[36:39], s[28:29], 0
    s_mov_b32 s8, s4
    s_mov_b32 s9, s5
    s_mov_b32 s10, 0x4e2000
    s_mov_b32 s11, 0x20000
    s_mov_b32 s12, s6
    s_mov_b32 s13, s7
    s_mov_b32 s14, 0x138800
    s_mov_b32 s15, 0x20000
    s_mov_b32 s16, s30
    s_mov_b32 s17, s31
    s_mov_b32 s18, 0x4e2000
    s_mov_b32 s19, 0x20000
    s_add_u32 s20, s32, 0xd823000
    s_addc_u32 s21, s33, 0
    s_mov_b32 s22, 0x1388000
    s_mov_b32 s23, 0x20000
    s_add_u32 s24, s32, 0xebab000
    s_addc_u32 s25, s33, 0
    s_mov_b32 s26, 0x100
    s_mov_b32 s27, 0x20000
    buffer_load_dword v6, v3, s[12:15], 0 offen
    buffer_load_dwordx4 v[8:11], v5, s[24:27], 0 offen
    buffer_load_dwordx4 v[12:15], v5, s[24:27], 0 offen offset:16
    buffer_load_dwordx2 v[16:17], v5, s[24:27], 0 offen offset:32
    s_mov_b32 s40, 0
    buffer_load_dwordx4 v[20:23], v4, s[20:23], s40 offen
    s_mov_b32 s41, 5120000
    buffer_load_dwordx4 v[24:27], v4, s[20:23], s41 offen
    s_mov_b32 s42, 10240000
    buffer_load_dwordx4 v[28:31], v4, s[20:23], s42 offen
    s_mov_b32 s43, 15360000
    buffer_load_dwordx4 v[32:35], v4, s[20:23], s43 offen
    buffer_load_dwordx4 v[36:39], v2, s[8:11], 0 offen
    v_and_b32 v7, 3, v0
    v_lshlrev_b32 v7, 4, v7
    v_mov_b32 v18, 0x3f80
    v_mov_b32 v19, 0
    v_lshlrev_b64 v[18:19], v7, v[18:19]
    s_waitcnt lgkmcnt(0)
    s_lshl_b32 s44, s36, 16
    s_and_b32 s45, s36, 0xffff0000
    s_lshl_b32 s46, s37, 16
    s_and_b32 s47, s37, 0xffff0000
    s_lshl_b32 s48, s38, 16
    s_and_b32 s49, s38, 0xffff0000
    s_lshl_b32 s50, s39, 16
    s_and_b32 s51, s39, 0xffff0000
    s_waitcnt vmcnt(8)
    v_lshlrev_b32 v7, 16, v6
    v_subrev_f32 v48, s44, v7
    v_subrev_f32 v49, s45, v7
    v_subrev_f32 v50, s46, v7
    v_subrev_f32 v51, s47, v7
    v_subrev_f32 v52, s48, v7
    v_subrev_f32 v53, s49, v7
    v_subrev_f32 v54, s50, v7
    v_subrev_f32 v55, s51, v7
    v_cvt_pk_bf16_f32 v56, v48, v49
    v_cvt_pk_bf16_f32 v57, v50, v51
    v_cvt_pk_bf16_f32 v58, v52, v53
    v_cvt_pk_bf16_f32 v59, v54, v55
    v_lshlrev_b32 v48, 16, v56
    v_and_b32 v49, 0xffff0000, v56
    v_lshlrev_b32 v50, 16, v57
    v_and_b32 v51, 0xffff0000, v57
    v_lshlrev_b32 v52, 16, v58
    v_and_b32 v53, 0xffff0000, v58
    v_lshlrev_b32 v54, 16, v59
    v_and_b32 v55, 0xffff0000, v59
    v_mul_f32 v48, v48, v48
    v_mul_f32 v49, v49, v49
    v_mul_f32 v50, v50, v50
    v_mul_f32 v51, v51, v51
    v_mul_f32 v52, v52, v52
    v_mul_f32 v53, v53, v53
    v_mul_f32 v54, v54, v54
    v_mul_f32 v55, v55, v55
    v_cvt_pk_bf16_f32 v56, v48, v49
    v_cvt_pk_bf16_f32 v57, v50, v51
    v_cvt_pk_bf16_f32 v58, v52, v53
    v_cvt_pk_bf16_f32 v59, v54, v55
    v_lshlrev_b32 v48, 16, v56
    v_and_b32 v49, 0xffff0000, v56
    v_lshlrev_b32 v50, 16, v57
    v_and_b32 v51, 0xffff0000, v57
    v_lshlrev_b32 v52, 16, v58
    v_and_b32 v53, 0xffff0000, v58
    v_lshlrev_b32 v54, 16, v59
    v_and_b32 v55, 0xffff0000, v59
    v_mul_f32 v48, 0xc1200000, v48
    v_mul_f32 v49, 0xc1200000, v49
    v_mul_f32 v50, 0xc1200000, v50
    v_mul_f32 v51, 0xc1200000, v51
    v_mul_f32 v52, 0xc1200000, v52
    v_mul_f32 v53, 0xc1200000, v53
    v_mul_f32 v54, 0xc1200000, v54
    v_mul_f32 v55, 0xc1200000, v55
    v_cvt_pk_bf16_f32 v56, v48, v49
    v_cvt_pk_bf16_f32 v57, v50, v51
    v_cvt_pk_bf16_f32 v58, v52, v53
    v_cvt_pk_bf16_f32 v59, v54, v55
    v_lshlrev_b32 v48, 16, v56
    v_and_b32 v49, 0xffff0000, v56
    v_lshlrev_b32 v50, 16, v57
    v_and_b32 v51, 0xffff0000, v57
    v_lshlrev_b32 v52, 16, v58
    v_and_b32 v53, 0xffff0000, v58
    v_lshlrev_b32 v54, 16, v59
    v_and_b32 v55, 0xffff0000, v59
    v_mul_f32 v48, 0x3fb8aa3b, v48
    v_mul_f32 v49, 0x3fb8aa3b, v49
    v_mul_f32 v50, 0x3fb8aa3b, v50
    v_mul_f32 v51, 0x3fb8aa3b, v51
    v_mul_f32 v52, 0x3fb8aa3b, v52
    v_mul_f32 v53, 0x3fb8aa3b, v53
    v_mul_f32 v54, 0x3fb8aa3b, v54
    v_mul_f32 v55, 0x3fb8aa3b, v55
    v_exp_f32 v48, v48
    v_exp_f32 v49, v49
    v_exp_f32 v50, v50
    v_exp_f32 v51, v51
    v_exp_f32 v52, v52
    v_exp_f32 v53, v53
    v_exp_f32 v54, v54
    v_exp_f32 v55, v55
    v_cvt_pk_bf16_f32 v40, v48, v49
    v_cvt_pk_bf16_f32 v41, v50, v51
    v_cvt_pk_bf16_f32 v42, v52, v53
    v_cvt_pk_bf16_f32 v43, v54, v55
    v_and_b32 v7, 0xffff0000, v6
    v_subrev_f32 v48, s44, v7
    v_subrev_f32 v49, s45, v7
    v_subrev_f32 v50, s46, v7
    v_subrev_f32 v51, s47, v7
    v_subrev_f32 v52, s48, v7
    v_subrev_f32 v53, s49, v7
    v_subrev_f32 v54, s50, v7
    v_subrev_f32 v55, s51, v7
    v_cvt_pk_bf16_f32 v56, v48, v49
    v_cvt_pk_bf16_f32 v57, v50, v51
    v_cvt_pk_bf16_f32 v58, v52, v53
    v_cvt_pk_bf16_f32 v59, v54, v55
    v_lshlrev_b32 v48, 16, v56
    v_and_b32 v49, 0xffff0000, v56
    v_lshlrev_b32 v50, 16, v57
    v_and_b32 v51, 0xffff0000, v57
    v_lshlrev_b32 v52, 16, v58
    v_and_b32 v53, 0xffff0000, v58
    v_lshlrev_b32 v54, 16, v59
    v_and_b32 v55, 0xffff0000, v59
    v_mul_f32 v48, v48, v48
    v_mul_f32 v49, v49, v49
    v_mul_f32 v50, v50, v50
    v_mul_f32 v51, v51, v51
    v_mul_f32 v52, v52, v52
    v_mul_f32 v53, v53, v53
    v_mul_f32 v54, v54, v54
    v_mul_f32 v55, v55, v55
    v_cvt_pk_bf16_f32 v56, v48, v49
    v_cvt_pk_bf16_f32 v57, v50, v51
    v_cvt_pk_bf16_f32 v58, v52, v53
    v_cvt_pk_bf16_f32 v59, v54, v55
    v_lshlrev_b32 v48, 16, v56
    v_and_b32 v49, 0xffff0000, v56
    v_lshlrev_b32 v50, 16, v57
    v_and_b32 v51, 0xffff0000, v57
    v_lshlrev_b32 v52, 16, v58
    v_and_b32 v53, 0xffff0000, v58
    v_lshlrev_b32 v54, 16, v59
    v_and_b32 v55, 0xffff0000, v59
    v_mul_f32 v48, 0xc1200000, v48
    v_mul_f32 v49, 0xc1200000, v49
    v_mul_f32 v50, 0xc1200000, v50
    v_mul_f32 v51, 0xc1200000, v51
    v_mul_f32 v52, 0xc1200000, v52
    v_mul_f32 v53, 0xc1200000, v53
    v_mul_f32 v54, 0xc1200000, v54
    v_mul_f32 v55, 0xc1200000, v55
    v_cvt_pk_bf16_f32 v56, v48, v49
    v_cvt_pk_bf16_f32 v57, v50, v51
    v_cvt_pk_bf16_f32 v58, v52, v53
    v_cvt_pk_bf16_f32 v59, v54, v55
    v_lshlrev_b32 v48, 16, v56
    v_and_b32 v49, 0xffff0000, v56
    v_lshlrev_b32 v50, 16, v57
    v_and_b32 v51, 0xffff0000, v57
    v_lshlrev_b32 v52, 16, v58
    v_and_b32 v53, 0xffff0000, v58
    v_lshlrev_b32 v54, 16, v59
    v_and_b32 v55, 0xffff0000, v59
    v_mul_f32 v48, 0x3fb8aa3b, v48
    v_mul_f32 v49, 0x3fb8aa3b, v49
    v_mul_f32 v50, 0x3fb8aa3b, v50
    v_mul_f32 v51, 0x3fb8aa3b, v51
    v_mul_f32 v52, 0x3fb8aa3b, v52
    v_mul_f32 v53, 0x3fb8aa3b, v53
    v_mul_f32 v54, 0x3fb8aa3b, v54
    v_mul_f32 v55, 0x3fb8aa3b, v55
    v_exp_f32 v48, v48
    v_exp_f32 v49, v49
    v_exp_f32 v50, v50
    v_exp_f32 v51, v51
    v_exp_f32 v52, v52
    v_exp_f32 v53, v53
    v_exp_f32 v54, v54
    v_exp_f32 v55, v55
    v_cvt_pk_bf16_f32 v44, v48, v49
    v_cvt_pk_bf16_f32 v45, v50, v51
    v_cvt_pk_bf16_f32 v46, v52, v53
    v_cvt_pk_bf16_f32 v47, v54, v55
    s_waitcnt vmcnt(5)
    v_mfma_f32_4x4x4_16b_bf16 v[48:51], v[8:9], v[40:41], 0
    v_mfma_f32_4x4x4_16b_bf16 v[56:59], v[12:13], v[40:41], 0
    v_mfma_f32_4x4x4_16b_bf16 v[52:55], v[8:9], v[44:45], 0
    v_mfma_f32_4x4x4_16b_bf16 v[60:63], v[12:13], v[44:45], 0
    v_mfma_f32_4x4x4_16b_bf16 v[48:51], v[10:11], v[42:43], v[48:51]
    v_mfma_f32_4x4x4_16b_bf16 v[56:59], v[14:15], v[42:43], v[56:59]
    v_mfma_f32_4x4x4_16b_bf16 v[52:55], v[10:11], v[46:47], v[52:55]
    v_mfma_f32_4x4x4_16b_bf16 v[60:63], v[14:15], v[46:47], v[60:63]
    s_waitcnt vmcnt(1)
    v_mfma_f32_4x4x4_16b_bf16 v[64:67], v[18:19], v[20:21], 0
    v_mfma_f32_4x4x4_16b_bf16 v[68:71], v[18:19], v[22:23], 0
    s_nop 0
    v_mfma_f32_4x4x4_16b_bf16 v[64:67], v[18:19], v[24:25], v[64:67]
    v_mfma_f32_4x4x4_16b_bf16 v[68:71], v[18:19], v[26:27], v[68:71]
    s_nop 0
    v_mfma_f32_4x4x4_16b_bf16 v[64:67], v[18:19], v[28:29], v[64:67]
    v_mfma_f32_4x4x4_16b_bf16 v[68:71], v[18:19], v[30:31], v[68:71]
    s_nop 0
    v_mfma_f32_4x4x4_16b_bf16 v[64:67], v[18:19], v[32:33], v[64:67]
    v_mfma_f32_4x4x4_16b_bf16 v[68:71], v[18:19], v[34:35], v[68:71]
    s_nop 3
    v_mul_f32 v64, v64, v48
    v_mul_f32 v65, v65, v49
    v_mul_f32 v66, v66, v50
    v_mul_f32 v67, v67, v51
    v_cvt_pk_bf16_f32 v20, v64, v65
    v_cvt_pk_bf16_f32 v21, v66, v67
    v_mul_f32 v68, v68, v52
    v_mul_f32 v69, v69, v53
    v_mul_f32 v70, v70, v54
    v_mul_f32 v71, v71, v55
    v_cvt_pk_bf16_f32 v22, v68, v69
    v_cvt_pk_bf16_f32 v23, v70, v71
    v_mfma_f32_4x4x4_16b_bf16 v[48:51], v[16:17], v[20:21], 0
    s_nop 0
    v_mfma_f32_4x4x4_16b_bf16 v[52:55], v[16:17], v[22:23], 0
    s_nop 2
    v_mul_f32 v48, v48, v56
    v_mul_f32 v49, v49, v57
    v_mul_f32 v50, v50, v58
    v_mul_f32 v51, v51, v59
    v_mul_f32 v52, v52, v60
    v_mul_f32 v53, v53, v61
    v_mul_f32 v54, v54, v62
    v_mul_f32 v55, v55, v63
    s_waitcnt vmcnt(0)
    v_mfma_f32_4x4x4_16b_bf16 v[64:67], v[18:19], v[36:37], v[48:51]
    v_mfma_f32_4x4x4_16b_bf16 v[68:71], v[18:19], v[38:39], v[52:55]
    s_nop 3
    v_cvt_pk_bf16_f32 v24, v64, v65
    v_cvt_pk_bf16_f32 v25, v66, v67
    v_cvt_pk_bf16_f32 v26, v68, v69
    v_cvt_pk_bf16_f32 v27, v70, v71
    buffer_store_dwordx4 v[24:27], v2, s[16:19], 0 offen
L3_end:
    s_endpgm
.section .rodata,"a"
.p2align 6
.amdhsa_kernel gs_sort_kernel
  .amdhsa_next_free_vgpr 128
  .amdhsa_next_free_sgpr 96
  .amdhsa_accum_offset 128
  .amdhsa_group_segment_fixed_size 0
  .amdhsa_kernarg_size 112
  .amdhsa_user_sgpr_count 2
  .amdhsa_user_sgpr_kernarg_segment_ptr 1
  .amdhsa_system_sgpr_workgroup_id_x 1
  .amdhsa_float_denorm_mode_32 3
.end_amdhsa_kernel
.p2align 6
.amdhsa_kernel gs_acc_kernel
  .amdhsa_next_free_vgpr 128
  .amdhsa_next_free_sgpr 96
  .amdhsa_accum_offset 128
  .amdhsa_group_segment_fixed_size 0
  .amdhsa_kernarg_size 112
  .amdhsa_user_sgpr_count 2
  .amdhsa_user_sgpr_kernarg_segment_ptr 1
  .amdhsa_system_sgpr_workgroup_id_x 1
  .amdhsa_float_denorm_mode_32 3
.end_amdhsa_kernel
.p2align 6
.amdhsa_kernel gs_final_kernel
  .amdhsa_next_free_vgpr 72
  .amdhsa_next_free_sgpr 64
  .amdhsa_accum_offset 72
  .amdhsa_group_segment_fixed_size 0
  .amdhsa_kernarg_size 112
  .amdhsa_user_sgpr_count 2
  .amdhsa_user_sgpr_kernarg_segment_ptr 1
  .amdhsa_system_sgpr_workgroup_id_x 1
  .amdhsa_float_denorm_mode_32 3
.end_amdhsa_kernel
```

```asm
; @launch kernel=gs_sort_kernel grid=(256,1,1) block=(1024,1,1) lds=163840
; @launch kernel=gs_acc_kernel grid=(256,1,1) block=(1024,1,1) lds=163840
.amdgcn_target "amdgcn-amd-amdhsa--gfx950"
.text
.globl gs_sort_kernel
.p2align 8
.type gs_sort_kernel,@function
gs_sort_kernel:
    s_cmp_ge_u32 s2, 256
    s_cbranch_scc1 L1_end
    s_load_dwordx4 s[4:7], s[0:1], 8
    s_load_dwordx2 s[28:29], s[0:1], 32
    s_load_dwordx2 s[30:31], s[0:1], 104
    s_load_dwordx2 s[56:57], s[0:1], 96
    s_load_dwordx2 s[86:87], s[0:1], 0
    s_load_dwordx4 s[60:63], s[0:1], 56
    s_load_dwordx4 s[64:67], s[0:1], 72
    v_lshrrev_b32 v7, 6, v0
    v_lshlrev_b32 v1, 3, v0
    v_readfirstlane_b32 s32, v7
    v_lshlrev_b32 v0, 4, v0
    s_mul_i32 s33, s2, 16384
    s_mul_i32 s34, s2, 8192
    s_waitcnt lgkmcnt(0)
    s_mov_b32 s8, s4
    s_mov_b32 s9, s5
    s_mov_b32 s10, 0x9c40000
    s_mov_b32 s11, 0x20000
    s_mov_b32 s12, s6
    s_mov_b32 s13, s7
    s_mov_b32 s14, 0x9c40000
    s_mov_b32 s15, 0x20000
    s_mov_b32 s16, s28
    s_mov_b32 s17, s29
    s_mov_b32 s18, 0x4e20000
    s_mov_b32 s19, 0x20000
    s_add_u32 s44, s33, 0x0
    buffer_load_dwordx4 v[16:19], v0, s[8:11], s44 offen nt
    s_add_u32 s45, s33, 0x0
    buffer_load_dwordx4 v[20:23], v0, s[12:15], s45 offen nt
    s_add_u32 s46, s34, 0x0
    buffer_load_dwordx2 v[24:25], v1, s[16:19], s46 offen nt
    s_add_u32 s47, s34, 0x200000
    buffer_load_dwordx2 v[26:27], v1, s[16:19], s47 offen nt
    s_add_u32 s44, s33, 0x400000
    buffer_load_dwordx4 v[28:31], v0, s[8:11], s44 offen nt
    s_add_u32 s45, s33, 0x400000
    buffer_load_dwordx4 v[32:35], v0, s[12:15], s45 offen nt
    s_add_u32 s46, s33, 0x800000
    buffer_load_dwordx4 v[36:39], v0, s[8:11], s46 offen nt
    s_add_u32 s47, s33, 0x800000
    buffer_load_dwordx4 v[40:43], v0, s[12:15], s47 offen nt
    s_add_u32 s44, s34, 0x400000
    buffer_load_dwordx2 v[44:45], v1, s[16:19], s44 offen nt
    s_add_u32 s45, s34, 0x600000
    buffer_load_dwordx2 v[46:47], v1, s[16:19], s45 offen nt
    s_mov_b32 s68, s62
    s_mov_b32 s69, s63
    s_mov_b32 s70, 0x40
    s_mov_b32 s71, 0x20000
    s_mov_b32 s72, s60
    s_mov_b32 s73, s61
    s_mov_b32 s74, 0x40
    s_mov_b32 s75, 0x20000
    s_mov_b32 s20, s66
    s_mov_b32 s21, s67
    s_mov_b32 s22, 0x20
    s_mov_b32 s23, 0x20000
    s_mov_b32 s80, s64
    s_mov_b32 s81, s65
    s_mov_b32 s82, 0x20
    s_mov_b32 s83, 0x20000
    s_add_u32 s24, s30, 0xebab000
    s_addc_u32 s25, s31, 0
    s_mov_b32 s26, 0x100
    s_mov_b32 s27, 0x20000
    v_lshrrev_b32 v2, 3, v0
    v_and_b32 v2, 6, v2
    v_lshlrev_b32 v3, 2, v0
    s_lshl_b32 s3, s32, 8
    s_add_u32 s3, s3, s2
    s_cmp_lg_u32 s3, 254
    s_cbranch_scc1 L1_wt
    buffer_load_ushort v96, v2, s[68:71], 0 offen offset:0
    buffer_load_ushort v108, v2, s[68:71], 0 offen offset:8
    buffer_load_ushort v97, v2, s[68:71], 0 offen offset:16
    buffer_load_ushort v109, v2, s[68:71], 0 offen offset:24
    buffer_load_ushort v98, v2, s[68:71], 0 offen offset:32
    buffer_load_ushort v110, v2, s[68:71], 0 offen offset:40
    buffer_load_ushort v99, v2, s[68:71], 0 offen offset:48
    buffer_load_ushort v111, v2, s[68:71], 0 offen offset:56
    buffer_load_ushort v100, v2, s[72:75], 0 offen offset:0
    buffer_load_ushort v112, v2, s[72:75], 0 offen offset:8
    buffer_load_ushort v101, v2, s[72:75], 0 offen offset:16
    buffer_load_ushort v113, v2, s[72:75], 0 offen offset:24
    buffer_load_ushort v102, v2, s[72:75], 0 offen offset:32
    buffer_load_ushort v114, v2, s[72:75], 0 offen offset:40
    buffer_load_ushort v103, v2, s[72:75], 0 offen offset:48
    buffer_load_ushort v115, v2, s[72:75], 0 offen offset:56
    buffer_load_ushort v104, v2, s[20:23], 0 offen offset:0
    buffer_load_ushort v116, v2, s[20:23], 0 offen offset:8
    buffer_load_ushort v105, v2, s[20:23], 0 offen offset:16
    buffer_load_ushort v117, v2, s[20:23], 0 offen offset:24
    buffer_load_ushort v106, v2, s[80:83], 0 offen offset:0
    buffer_load_ushort v118, v2, s[80:83], 0 offen offset:8
    buffer_load_ushort v107, v2, s[80:83], 0 offen offset:16
    buffer_load_ushort v119, v2, s[80:83], 0 offen offset:24
    s_waitcnt vmcnt(0)
    v_lshl_or_b32 v96, v108, 16, v96
    v_lshl_or_b32 v97, v109, 16, v97
    v_lshl_or_b32 v98, v110, 16, v98
    v_lshl_or_b32 v99, v111, 16, v99
    v_lshl_or_b32 v100, v112, 16, v100
    v_lshl_or_b32 v101, v113, 16, v101
    v_lshl_or_b32 v102, v114, 16, v102
    v_lshl_or_b32 v103, v115, 16, v103
    v_lshl_or_b32 v104, v116, 16, v104
    v_lshl_or_b32 v105, v117, 16, v105
    v_lshl_or_b32 v106, v118, 16, v106
    v_lshl_or_b32 v107, v119, 16, v107
    buffer_store_dwordx4 v[96:99], v3, s[24:27], 0 offen offset:0
    buffer_store_dwordx4 v[100:103], v3, s[24:27], 0 offen offset:16
    buffer_store_dwordx4 v[104:107], v3, s[24:27], 0 offen offset:32
L1_wt:
    s_mov_b32 s20, s30
    s_mov_b32 s21, s31
    s_mov_b32 s22, 0xd340000
    s_mov_b32 s23, 0x20000
    s_add_u32 s24, s30, 0x28000
    s_addc_u32 s25, s31, 0
    s_mov_b32 s26, 0xd318000
    s_mov_b32 s27, 0x20000
    s_mov_b32 s80, s86
    s_mov_b32 s81, s87
    s_mov_b32 s82, 0x4e20
    s_mov_b32 s83, 0x20000
    s_mul_i32 s3, s2, 20000
    s_add_u32 s80, s80, s3
    s_addc_u32 s81, s81, 0
    s_mul_i32 s35, s2, 173056
    s_and_b32 s37, s32, 3
    s_lshl_b32 s37, s37, 3
    s_add_u32 s36, s35, s37
    s_lshr_b32 s37, s32, 2
    s_mul_i32 s37, s37, 2080
    s_add_u32 s36, s36, s37
    s_mul_i32 s4, s2, 5
    s_add_u32 s4, s4, 8192
    s_lshl_b32 s38, s4, 14
    s_lshl_b32 s39, s4, 13
    v_mov_b32 v2, 1
    v_mov_b32 v4, 0x80000007
    v_mov_b32 v5, 0xfc
    v_mov_b32 v6, 0x78
    s_mov_b32 s40, 2048
    s_mov_b32 s55, -10000
    s_mov_b32 s41, 0x010c0c01
    s_mov_b32 s42, 0x030c0c03
    v_mov_b32 v8, 0
    v_mov_b32 v9, 0
    v_mov_b32 v10, 0
    v_mov_b32 v11, 0
    ds_write_b128 v0, v[8:11]
    s_add_u32 s68, s30, 0xebac000
    s_addc_u32 s69, s31, 0
    s_mov_b32 s70, 0x80
    s_mov_b32 s71, 0x20000
    s_lshl_b32 s3, s2, 7
    s_add_u32 s68, s68, s3
    s_addc_u32 s69, s69, 0
    s_cmp_lg_u32 s32, 0
    s_cbranch_scc1 L1_fl
    buffer_store_dwordx4 v[8:11], v0, s[68:71], 0 offen sc1
L1_fl:
    s_waitcnt lgkmcnt(0)
    s_barrier
    s_add_u32 s46, s33, 0xc00000
    buffer_load_dwordx4 v[48:51], v0, s[8:11], s46 offen nt
    s_add_u32 s47, s33, 0xc00000
    buffer_load_dwordx4 v[52:55], v0, s[12:15], s47 offen nt
    s_waitcnt vmcnt(8)
    v_lshlrev_b32 v7, 16, v24
    v_and_b32 v8, 0xffff0000, v24
    v_lshlrev_b32 v9, 16, v25
    v_and_b32 v10, 0xffff0000, v25
    v_mul_f32 v7, 0.15915494, v7
    v_mul_f32 v8, 0.15915494, v8
    v_mul_f32 v9, 0.15915494, v9
    v_mul_f32 v10, 0.15915494, v10
    v_mul_hi_u32_u24 v14, 429497, v16
    v_lshrrev_b32 v12, 3, v20
    v_cos_f32 v7, v7
    v_lshlrev_b16 v13, 3, v20
    v_mad_i32_i24 v11, v14, s55, v16
    v_bitop3_b32 v12, v6, v13, v12 bitop3:0xca
    v_add_lshl_u32 v11, v11, s40, 17
    v_lshlrev_b16 v14, 8, v14
    v_lshrrev_b32 v13, 2, v20
    v_or_b32 v16, v12, v11
    v_bitop3_b32 v20, v5, v13, v14 bitop3:0xea
    ds_add_u32 v20, v2
    v_mul_hi_u32_u24 v14, 429497, v17
    v_lshrrev_b32 v12, 3, v21
    v_cos_f32 v8, v8
    v_lshlrev_b16 v13, 3, v21
    v_mad_i32_i24 v11, v14, s55, v17
    v_bitop3_b32 v12, v6, v13, v12 bitop3:0xca
    v_add_lshl_u32 v11, v11, s40, 17
    v_lshlrev_b16 v14, 8, v14
    v_lshrrev_b32 v13, 2, v21
    v_or_b32 v17, v12, v11
    v_bitop3_b32 v21, v5, v13, v14 bitop3:0xea
    ds_add_u32 v21, v2
    v_cvt_pk_bf16_f32 v24, v7, v8
    v_perm_b32 v12, v24, v24, s41
    v_bitop3_b32 v16, v4, v12, v16 bitop3:0xca
    v_perm_b32 v13, v24, v24, s42
    v_bitop3_b32 v17, v4, v13, v17 bitop3:0xca
    v_mul_hi_u32_u24 v14, 429497, v18
    v_lshrrev_b32 v12, 3, v22
    v_cos_f32 v9, v9
    v_lshlrev_b16 v13, 3, v22
    v_mad_i32_i24 v11, v14, s55, v18
    v_bitop3_b32 v12, v6, v13, v12 bitop3:0xca
    v_add_lshl_u32 v11, v11, s40, 17
    v_lshlrev_b16 v14, 8, v14
    v_lshrrev_b32 v13, 2, v22
    v_or_b32 v18, v12, v11
    v_bitop3_b32 v22, v5, v13, v14 bitop3:0xea
    ds_add_u32 v22, v2
    v_mul_hi_u32_u24 v14, 429497, v19
    v_lshrrev_b32 v12, 3, v23
    v_cos_f32 v10, v10
    v_lshlrev_b16 v13, 3, v23
    v_mad_i32_i24 v11, v14, s55, v19
    v_bitop3_b32 v12, v6, v13, v12 bitop3:0xca
    v_add_lshl_u32 v11, v11, s40, 17
    v_lshlrev_b16 v14, 8, v14
    v_lshrrev_b32 v13, 2, v23
    v_or_b32 v19, v12, v11
    v_bitop3_b32 v23, v5, v13, v14 bitop3:0xea
    ds_add_u32 v23, v2
    v_cvt_pk_bf16_f32 v25, v9, v10
    v_perm_b32 v12, v25, v25, s41
    v_bitop3_b32 v18, v4, v12, v18 bitop3:0xca
    v_perm_b32 v13, v25, v25, s42
    v_bitop3_b32 v19, v4, v13, v19 bitop3:0xca
    s_add_u32 s44, s33, 0x1000000
    buffer_load_dwordx4 v[56:59], v0, s[8:11], s44 offen nt
    s_add_u32 s45, s33, 0x1000000
    buffer_load_dwordx4 v[60:63], v0, s[12:15], s45 offen nt
    s_add_u32 s46, s34, 0x800000
    buffer_load_dwordx2 v[64:65], v1, s[16:19], s46 offen nt
    s_add_u32 s47, s34, 0xa00000
    buffer_load_dwordx2 v[66:67], v1, s[16:19], s47 offen nt
    s_waitcnt vmcnt(10)
    v_lshlrev_b32 v7, 16, v26
    v_and_b32 v8, 0xffff0000, v26
    v_lshlrev_b32 v9, 16, v27
    v_and_b32 v10, 0xffff0000, v27
    v_mul_f32 v7, 0.15915494, v7
    v_mul_f32 v8, 0.15915494, v8
    v_mul_f32 v9, 0.15915494, v9
    v_mul_f32 v10, 0.15915494, v10
    v_mul_hi_u32_u24 v14, 429497, v28
    v_lshrrev_b32 v12, 3, v32
    v_cos_f32 v7, v7
    v_lshlrev_b16 v13, 3, v32
    v_mad_i32_i24 v11, v14, s55, v28
    v_bitop3_b32 v12, v6, v13, v12 bitop3:0xca
    v_add_lshl_u32 v11, v11, s40, 17
    v_lshlrev_b16 v14, 8, v14
    v_lshrrev_b32 v13, 2, v32
    v_or_b32 v28, v12, v11
    v_bitop3_b32 v32, v5, v13, v14 bitop3:0xea
    ds_add_u32 v32, v2
    v_mul_hi_u32_u24 v14, 429497, v29
    v_lshrrev_b32 v12, 3, v33
    v_cos_f32 v8, v8
    v_lshlrev_b16 v13, 3, v33
    v_mad_i32_i24 v11, v14, s55, v29
    v_bitop3_b32 v12, v6, v13, v12 bitop3:0xca
    v_add_lshl_u32 v11, v11, s40, 17
    v_lshlrev_b16 v14, 8, v14
    v_lshrrev_b32 v13, 2, v33
    v_or_b32 v29, v12, v11
    v_bitop3_b32 v33, v5, v13, v14 bitop3:0xea
    ds_add_u32 v33, v2
    v_cvt_pk_bf16_f32 v26, v7, v8
    v_perm_b32 v12, v26, v26, s41
    v_bitop3_b32 v28, v4, v12, v28 bitop3:0xca
    v_perm_b32 v13, v26, v26, s42
    v_bitop3_b32 v29, v4, v13, v29 bitop3:0xca
    v_mul_hi_u32_u24 v14, 429497, v30
    v_lshrrev_b32 v12, 3, v34
    v_cos_f32 v9, v9
    v_lshlrev_b16 v13, 3, v34
    v_mad_i32_i24 v11, v14, s55, v30
    v_bitop3_b32 v12, v6, v13, v12 bitop3:0xca
    v_add_lshl_u32 v11, v11, s40, 17
    v_lshlrev_b16 v14, 8, v14
    v_lshrrev_b32 v13, 2, v34
    v_or_b32 v30, v12, v11
    v_bitop3_b32 v34, v5, v13, v14 bitop3:0xea
    ds_add_u32 v34, v2
    v_mul_hi_u32_u24 v14, 429497, v31
    v_lshrrev_b32 v12, 3, v35
    v_cos_f32 v10, v10
    v_lshlrev_b16 v13, 3, v35
    v_mad_i32_i24 v11, v14, s55, v31
    v_bitop3_b32 v12, v6, v13, v12 bitop3:0xca
    v_add_lshl_u32 v11, v11, s40, 17
    v_lshlrev_b16 v14, 8, v14
    v_lshrrev_b32 v13, 2, v35
    v_or_b32 v31, v12, v11
    v_bitop3_b32 v35, v5, v13, v14 bitop3:0xea
    ds_add_u32 v35, v2
    v_cvt_pk_bf16_f32 v27, v9, v10
    v_perm_b32 v12, v27, v27, s41
    v_bitop3_b32 v30, v4, v12, v30 bitop3:0xca
    v_perm_b32 v13, v27, v27, s42
    v_bitop3_b32 v31, v4, v13, v31 bitop3:0xca
    s_add_u32 s44, s33, 0x1400000
    buffer_load_dwordx4 v[68:71], v0, s[8:11], s44 offen nt
    s_add_u32 s45, s33, 0x1400000
    buffer_load_dwordx4 v[72:75], v0, s[12:15], s45 offen nt
    s_waitcnt vmcnt(8)
    v_lshlrev_b32 v7, 16, v44
    v_and_b32 v8, 0xffff0000, v44
    v_lshlrev_b32 v9, 16, v45
    v_and_b32 v10, 0xffff0000, v45
    v_mul_f32 v7, 0.15915494, v7
    v_mul_f32 v8, 0.15915494, v8
    v_mul_f32 v9, 0.15915494, v9
    v_mul_f32 v10, 0.15915494, v10
    v_mul_hi_u32_u24 v14, 429497, v36
    v_lshrrev_b32 v12, 3, v40
    v_cos_f32 v7, v7
    v_lshlrev_b16 v13, 3, v40
    v_mad_i32_i24 v11, v14, s55, v36
    v_bitop3_b32 v12, v6, v13, v12 bitop3:0xca
    v_add_lshl_u32 v11, v11, s40, 17
    v_lshlrev_b16 v14, 8, v14
    v_lshrrev_b32 v13, 2, v40
    v_or_b32 v36, v12, v11
    v_bitop3_b32 v40, v5, v13, v14 bitop3:0xea
    ds_add_u32 v40, v2
    v_mul_hi_u32_u24 v14, 429497, v37
    v_lshrrev_b32 v12, 3, v41
    v_cos_f32 v8, v8
    v_lshlrev_b16 v13, 3, v41
    v_mad_i32_i24 v11, v14, s55, v37
    v_bitop3_b32 v12, v6, v13, v12 bitop3:0xca
    v_add_lshl_u32 v11, v11, s40, 17
    v_lshlrev_b16 v14, 8, v14
    v_lshrrev_b32 v13, 2, v41
    v_or_b32 v37, v12, v11
    v_bitop3_b32 v41, v5, v13, v14 bitop3:0xea
    ds_add_u32 v41, v2
    v_cvt_pk_bf16_f32 v44, v7, v8
    v_perm_b32 v12, v44, v44, s41
    v_bitop3_b32 v36, v4, v12, v36 bitop3:0xca
    v_perm_b32 v13, v44, v44, s42
    v_bitop3_b32 v37, v4, v13, v37 bitop3:0xca
    v_mul_hi_u32_u24 v14, 429497, v38
    v_lshrrev_b32 v12, 3, v42
    v_cos_f32 v9, v9
    v_lshlrev_b16 v13, 3, v42
    v_mad_i32_i24 v11, v14, s55, v38
    v_bitop3_b32 v12, v6, v13, v12 bitop3:0xca
    v_add_lshl_u32 v11, v11, s40, 17
    v_lshlrev_b16 v14, 8, v14
    v_lshrrev_b32 v13, 2, v42
    v_or_b32 v38, v12, v11
    v_bitop3_b32 v42, v5, v13, v14 bitop3:0xea
    ds_add_u32 v42, v2
    v_mul_hi_u32_u24 v14, 429497, v39
    v_lshrrev_b32 v12, 3, v43
    v_cos_f32 v10, v10
    v_lshlrev_b16 v13, 3, v43
    v_mad_i32_i24 v11, v14, s55, v39
    v_bitop3_b32 v12, v6, v13, v12 bitop3:0xca
    v_add_lshl_u32 v11, v11, s40, 17
    v_lshlrev_b16 v14, 8, v14
    v_lshrrev_b32 v13, 2, v43
    v_or_b32 v39, v12, v11
    v_bitop3_b32 v43, v5, v13, v14 bitop3:0xea
    ds_add_u32 v43, v2
    v_cvt_pk_bf16_f32 v45, v9, v10
    v_perm_b32 v12, v45, v45, s41
    v_bitop3_b32 v38, v4, v12, v38 bitop3:0xca
    v_perm_b32 v13, v45, v45, s42
    v_bitop3_b32 v39, v4, v13, v39 bitop3:0xca
    s_add_u32 s46, s33, 0x1800000
    buffer_load_dwordx4 v[76:79], v0, s[8:11], s46 offen nt
    s_add_u32 s47, s33, 0x1800000
    buffer_load_dwordx4 v[80:83], v0, s[12:15], s47 offen nt
    s_add_u32 s44, s34, 0xc00000
    buffer_load_dwordx2 v[84:85], v1, s[16:19], s44 offen nt
    s_add_u32 s45, s34, 0xe00000
    buffer_load_dwordx2 v[86:87], v1, s[16:19], s45 offen nt
    s_waitcnt vmcnt(10)
    v_lshlrev_b32 v7, 16, v46
    v_and_b32 v8, 0xffff0000, v46
    v_lshlrev_b32 v9, 16, v47
    v_and_b32 v10, 0xffff0000, v47
    v_mul_f32 v7, 0.15915494, v7
    v_mul_f32 v8, 0.15915494, v8
    v_mul_f32 v9, 0.15915494, v9
    v_mul_f32 v10, 0.15915494, v10
    v_mul_hi_u32_u24 v14, 429497, v48
    v_lshrrev_b32 v12, 3, v52
    v_cos_f32 v7, v7
    v_lshlrev_b16 v13, 3, v52
    v_mad_i32_i24 v11, v14, s55, v48
    v_bitop3_b32 v12, v6, v13, v12 bitop3:0xca
    v_add_lshl_u32 v11, v11, s40, 17
    v_lshlrev_b16 v14, 8, v14
    v_lshrrev_b32 v13, 2, v52
    v_or_b32 v48, v12, v11
    v_bitop3_b32 v52, v5, v13, v14 bitop3:0xea
    ds_add_u32 v52, v2
    v_mul_hi_u32_u24 v14, 429497, v49
    v_lshrrev_b32 v12, 3, v53
    v_cos_f32 v8, v8
    v_lshlrev_b16 v13, 3, v53
    v_mad_i32_i24 v11, v14, s55, v49
    v_bitop3_b32 v12, v6, v13, v12 bitop3:0xca
    v_add_lshl_u32 v11, v11, s40, 17
    v_lshlrev_b16 v14, 8, v14
    v_lshrrev_b32 v13, 2, v53
    v_or_b32 v49, v12, v11
    v_bitop3_b32 v53, v5, v13, v14 bitop3:0xea
    ds_add_u32 v53, v2
    v_cvt_pk_bf16_f32 v46, v7, v8
    v_perm_b32 v12, v46, v46, s41
    v_bitop3_b32 v48, v4, v12, v48 bitop3:0xca
    v_perm_b32 v13, v46, v46, s42
    v_bitop3_b32 v49, v4, v13, v49 bitop3:0xca
    v_mul_hi_u32_u24 v14, 429497, v50
    v_lshrrev_b32 v12, 3, v54
    v_cos_f32 v9, v9
    v_lshlrev_b16 v13, 3, v54
    v_mad_i32_i24 v11, v14, s55, v50
    v_bitop3_b32 v12, v6, v13, v12 bitop3:0xca
    v_add_lshl_u32 v11, v11, s40, 17
    v_lshlrev_b16 v14, 8, v14
    v_lshrrev_b32 v13, 2, v54
    v_or_b32 v50, v12, v11
    v_bitop3_b32 v54, v5, v13, v14 bitop3:0xea
    ds_add_u32 v54, v2
    v_mul_hi_u32_u24 v14, 429497, v51
    v_lshrrev_b32 v12, 3, v55
    v_cos_f32 v10, v10
    v_lshlrev_b16 v13, 3, v55
    v_mad_i32_i24 v11, v14, s55, v51
    v_bitop3_b32 v12, v6, v13, v12 bitop3:0xca
    v_add_lshl_u32 v11, v11, s40, 17
    v_lshlrev_b16 v14, 8, v14
    v_lshrrev_b32 v13, 2, v55
    v_or_b32 v51, v12, v11
    v_bitop3_b32 v55, v5, v13, v14 bitop3:0xea
    ds_add_u32 v55, v2
    v_cvt_pk_bf16_f32 v47, v9, v10
    v_perm_b32 v12, v47, v47, s41
    v_bitop3_b32 v50, v4, v12, v50 bitop3:0xca
    v_perm_b32 v13, v47, v47, s42
    v_bitop3_b32 v51, v4, v13, v51 bitop3:0xca
    s_add_u32 s46, s33, 0x1c00000
    buffer_load_dwordx4 v[88:91], v0, s[8:11], s46 offen nt
    s_add_u32 s47, s33, 0x1c00000
    buffer_load_dwordx4 v[92:95], v0, s[12:15], s47 offen nt
    s_waitcnt vmcnt(8)
    v_lshlrev_b32 v7, 16, v64
    v_and_b32 v8, 0xffff0000, v64
    v_lshlrev_b32 v9, 16, v65
    v_and_b32 v10, 0xffff0000, v65
    v_mul_f32 v7, 0.15915494, v7
    v_mul_f32 v8, 0.15915494, v8
    v_mul_f32 v9, 0.15915494, v9
    v_mul_f32 v10, 0.15915494, v10
    v_mul_hi_u32_u24 v14, 429497, v56
    v_lshrrev_b32 v12, 3, v60
    v_cos_f32 v7, v7
    v_lshlrev_b16 v13, 3, v60
    v_mad_i32_i24 v11, v14, s55, v56
    v_bitop3_b32 v12, v6, v13, v12 bitop3:0xca
    v_add_lshl_u32 v11, v11, s40, 17
    v_lshlrev_b16 v14, 8, v14
    v_lshrrev_b32 v13, 2, v60
    v_or_b32 v56, v12, v11
    v_bitop3_b32 v60, v5, v13, v14 bitop3:0xea
    ds_add_u32 v60, v2
    v_mul_hi_u32_u24 v14, 429497, v57
    v_lshrrev_b32 v12, 3, v61
    v_cos_f32 v8, v8
    v_lshlrev_b16 v13, 3, v61
    v_mad_i32_i24 v11, v14, s55, v57
    v_bitop3_b32 v12, v6, v13, v12 bitop3:0xca
    v_add_lshl_u32 v11, v11, s40, 17
    v_lshlrev_b16 v14, 8, v14
    v_lshrrev_b32 v13, 2, v61
    v_or_b32 v57, v12, v11
    v_bitop3_b32 v61, v5, v13, v14 bitop3:0xea
    ds_add_u32 v61, v2
    v_cvt_pk_bf16_f32 v64, v7, v8
    v_perm_b32 v12, v64, v64, s41
    v_bitop3_b32 v56, v4, v12, v56 bitop3:0xca
    v_perm_b32 v13, v64, v64, s42
    v_bitop3_b32 v57, v4, v13, v57 bitop3:0xca
    v_mul_hi_u32_u24 v14, 429497, v58
    v_lshrrev_b32 v12, 3, v62
    v_cos_f32 v9, v9
    v_lshlrev_b16 v13, 3, v62
    v_mad_i32_i24 v11, v14, s55, v58
    v_bitop3_b32 v12, v6, v13, v12 bitop3:0xca
    v_add_lshl_u32 v11, v11, s40, 17
    v_lshlrev_b16 v14, 8, v14
    v_lshrrev_b32 v13, 2, v62
    v_or_b32 v58, v12, v11
    v_bitop3_b32 v62, v5, v13, v14 bitop3:0xea
    ds_add_u32 v62, v2
    v_mul_hi_u32_u24 v14, 429497, v59
    v_lshrrev_b32 v12, 3, v63
    v_cos_f32 v10, v10
    v_lshlrev_b16 v13, 3, v63
    v_mad_i32_i24 v11, v14, s55, v59
    v_bitop3_b32 v12, v6, v13, v12 bitop3:0xca
    v_add_lshl_u32 v11, v11, s40, 17
    v_lshlrev_b16 v14, 8, v14
    v_lshrrev_b32 v13, 2, v63
    v_or_b32 v59, v12, v11
    v_bitop3_b32 v63, v5, v13, v14 bitop3:0xea
    ds_add_u32 v63, v2
    v_cvt_pk_bf16_f32 v65, v9, v10
    v_perm_b32 v12, v65, v65, s41
    v_bitop3_b32 v58, v4, v12, v58 bitop3:0xca
    v_perm_b32 v13, v65, v65, s42
    v_bitop3_b32 v59, v4, v13, v59 bitop3:0xca
    s_add_u32 s44, s33, 0x2000000
    buffer_load_dwordx4 v[96:99], v0, s[8:11], s44 offen nt
    s_add_u32 s45, s33, 0x2000000
    buffer_load_dwordx4 v[100:103], v0, s[12:15], s45 offen nt
    s_add_u32 s46, s34, 0x1000000
    buffer_load_dwordx2 v[104:105], v1, s[16:19], s46 offen nt
    s_add_u32 s47, s34, 0x1200000
    buffer_load_dwordx2 v[106:107], v1, s[16:19], s47 offen nt
    s_waitcnt vmcnt(10)
    v_lshlrev_b32 v7, 16, v66
    v_and_b32 v8, 0xffff0000, v66
    v_lshlrev_b32 v9, 16, v67
    v_and_b32 v10, 0xffff0000, v67
    v_mul_f32 v7, 0.15915494, v7
    v_mul_f32 v8, 0.15915494, v8
    v_mul_f32 v9, 0.15915494, v9
    v_mul_f32 v10, 0.15915494, v10
    v_mul_hi_u32_u24 v14, 429497, v68
    v_lshrrev_b32 v12, 3, v72
    v_cos_f32 v7, v7
    v_lshlrev_b16 v13, 3, v72
    v_mad_i32_i24 v11, v14, s55, v68
    v_bitop3_b32 v12, v6, v13, v12 bitop3:0xca
    v_add_lshl_u32 v11, v11, s40, 17
    v_lshlrev_b16 v14, 8, v14
    v_lshrrev_b32 v13, 2, v72
    v_or_b32 v68, v12, v11
    v_bitop3_b32 v72, v5, v13, v14 bitop3:0xea
    ds_add_u32 v72, v2
    v_mul_hi_u32_u24 v14, 429497, v69
    v_lshrrev_b32 v12, 3, v73
    v_cos_f32 v8, v8
    v_lshlrev_b16 v13, 3, v73
    v_mad_i32_i24 v11, v14, s55, v69
    v_bitop3_b32 v12, v6, v13, v12 bitop3:0xca
    v_add_lshl_u32 v11, v11, s40, 17
    v_lshlrev_b16 v14, 8, v14
    v_lshrrev_b32 v13, 2, v73
    v_or_b32 v69, v12, v11
    v_bitop3_b32 v73, v5, v13, v14 bitop3:0xea
    ds_add_u32 v73, v2
    v_cvt_pk_bf16_f32 v66, v7, v8
    v_perm_b32 v12, v66, v66, s41
    v_bitop3_b32 v68, v4, v12, v68 bitop3:0xca
    v_perm_b32 v13, v66, v66, s42
    v_bitop3_b32 v69, v4, v13, v69 bitop3:0xca
    v_mul_hi_u32_u24 v14, 429497, v70
    v_lshrrev_b32 v12, 3, v74
    v_cos_f32 v9, v9
    v_lshlrev_b16 v13, 3, v74
    v_mad_i32_i24 v11, v14, s55, v70
    v_bitop3_b32 v12, v6, v13, v12 bitop3:0xca
    v_add_lshl_u32 v11, v11, s40, 17
    v_lshlrev_b16 v14, 8, v14
    v_lshrrev_b32 v13, 2, v74
    v_or_b32 v70, v12, v11
    v_bitop3_b32 v74, v5, v13, v14 bitop3:0xea
    ds_add_u32 v74, v2
    v_mul_hi_u32_u24 v14, 429497, v71
    v_lshrrev_b32 v12, 3, v75
    v_cos_f32 v10, v10
    v_lshlrev_b16 v13, 3, v75
    v_mad_i32_i24 v11, v14, s55, v71
    v_bitop3_b32 v12, v6, v13, v12 bitop3:0xca
    v_add_lshl_u32 v11, v11, s40, 17
    v_lshlrev_b16 v14, 8, v14
    v_lshrrev_b32 v13, 2, v75
    v_or_b32 v71, v12, v11
    v_bitop3_b32 v75, v5, v13, v14 bitop3:0xea
    ds_add_u32 v75, v2
    v_cvt_pk_bf16_f32 v67, v9, v10
    v_perm_b32 v12, v67, v67, s41
    v_bitop3_b32 v70, v4, v12, v70 bitop3:0xca
    v_perm_b32 v13, v67, v67, s42
    v_bitop3_b32 v71, v4, v13, v71 bitop3:0xca
    s_add_u32 s44, s33, 0x2400000
    buffer_load_dwordx4 v[108:111], v0, s[8:11], s44 offen nt
    s_waitcnt vmcnt(7)
    v_lshlrev_b32 v7, 16, v84
    v_and_b32 v8, 0xffff0000, v84
    v_lshlrev_b32 v9, 16, v85
    v_and_b32 v10, 0xffff0000, v85
    v_mul_f32 v7, 0.15915494, v7
    v_mul_f32 v8, 0.15915494, v8
    v_mul_f32 v9, 0.15915494, v9
    v_mul_f32 v10, 0.15915494, v10
    v_mul_hi_u32_u24 v14, 429497, v76
    v_lshrrev_b32 v12, 3, v80
    v_cos_f32 v7, v7
    v_lshlrev_b16 v13, 3, v80
    v_mad_i32_i24 v11, v14, s55, v76
    v_bitop3_b32 v12, v6, v13, v12 bitop3:0xca
    v_add_lshl_u32 v11, v11, s40, 17
    v_lshlrev_b16 v14, 8, v14
    v_lshrrev_b32 v13, 2, v80
    v_or_b32 v76, v12, v11
    v_bitop3_b32 v80, v5, v13, v14 bitop3:0xea
    ds_add_u32 v80, v2
    v_mul_hi_u32_u24 v14, 429497, v77
    v_lshrrev_b32 v12, 3, v81
    v_cos_f32 v8, v8
    v_lshlrev_b16 v13, 3, v81
    v_mad_i32_i24 v11, v14, s55, v77
    v_bitop3_b32 v12, v6, v13, v12 bitop3:0xca
    v_add_lshl_u32 v11, v11, s40, 17
    v_lshlrev_b16 v14, 8, v14
    v_lshrrev_b32 v13, 2, v81
    v_or_b32 v77, v12, v11
    v_bitop3_b32 v81, v5, v13, v14 bitop3:0xea
    ds_add_u32 v81, v2
    v_cvt_pk_bf16_f32 v84, v7, v8
    v_perm_b32 v12, v84, v84, s41
    v_bitop3_b32 v76, v4, v12, v76 bitop3:0xca
    v_perm_b32 v13, v84, v84, s42
    v_bitop3_b32 v77, v4, v13, v77 bitop3:0xca
    v_mul_hi_u32_u24 v14, 429497, v78
    v_lshrrev_b32 v12, 3, v82
    v_cos_f32 v9, v9
    v_lshlrev_b16 v13, 3, v82
    v_mad_i32_i24 v11, v14, s55, v78
    v_bitop3_b32 v12, v6, v13, v12 bitop3:0xca
    v_add_lshl_u32 v11, v11, s40, 17
    v_lshlrev_b16 v14, 8, v14
    v_lshrrev_b32 v13, 2, v82
    v_or_b32 v78, v12, v11
    v_bitop3_b32 v82, v5, v13, v14 bitop3:0xea
    ds_add_u32 v82, v2
    v_mul_hi_u32_u24 v14, 429497, v79
    v_lshrrev_b32 v12, 3, v83
    v_cos_f32 v10, v10
    v_lshlrev_b16 v13, 3, v83
    v_mad_i32_i24 v11, v14, s55, v79
    v_bitop3_b32 v12, v6, v13, v12 bitop3:0xca
    v_add_lshl_u32 v11, v11, s40, 17
    v_lshlrev_b16 v14, 8, v14
    v_lshrrev_b32 v13, 2, v83
    v_or_b32 v79, v12, v11
    v_bitop3_b32 v83, v5, v13, v14 bitop3:0xea
    ds_add_u32 v83, v2
    v_cvt_pk_bf16_f32 v85, v9, v10
    v_perm_b32 v12, v85, v85, s41
    v_bitop3_b32 v78, v4, v12, v78 bitop3:0xca
    v_perm_b32 v13, v85, v85, s42
    v_bitop3_b32 v79, v4, v13, v79 bitop3:0xca
    s_waitcnt vmcnt(5)
    v_lshlrev_b32 v7, 16, v86
    v_and_b32 v8, 0xffff0000, v86
    v_lshlrev_b32 v9, 16, v87
    v_and_b32 v10, 0xffff0000, v87
    v_mul_f32 v7, 0.15915494, v7
    v_mul_f32 v8, 0.15915494, v8
    v_mul_f32 v9, 0.15915494, v9
    v_mul_f32 v10, 0.15915494, v10
    v_mul_hi_u32_u24 v14, 429497, v88
    v_lshrrev_b32 v12, 3, v92
    v_cos_f32 v7, v7
    v_lshlrev_b16 v13, 3, v92
    v_mad_i32_i24 v11, v14, s55, v88
    v_bitop3_b32 v12, v6, v13, v12 bitop3:0xca
    v_add_lshl_u32 v11, v11, s40, 17
    v_lshlrev_b16 v14, 8, v14
    v_lshrrev_b32 v13, 2, v92
    v_or_b32 v88, v12, v11
    v_bitop3_b32 v92, v5, v13, v14 bitop3:0xea
    ds_add_u32 v92, v2
    v_mul_hi_u32_u24 v14, 429497, v89
    v_lshrrev_b32 v12, 3, v93
    v_cos_f32 v8, v8
    v_lshlrev_b16 v13, 3, v93
    v_mad_i32_i24 v11, v14, s55, v89
    v_bitop3_b32 v12, v6, v13, v12 bitop3:0xca
    v_add_lshl_u32 v11, v11, s40, 17
    v_lshlrev_b16 v14, 8, v14
    v_lshrrev_b32 v13, 2, v93
    v_or_b32 v89, v12, v11
    v_bitop3_b32 v93, v5, v13, v14 bitop3:0xea
    ds_add_u32 v93, v2
    v_cvt_pk_bf16_f32 v86, v7, v8
    v_perm_b32 v12, v86, v86, s41
    v_bitop3_b32 v88, v4, v12, v88 bitop3:0xca
    v_perm_b32 v13, v86, v86, s42
    v_bitop3_b32 v89, v4, v13, v89 bitop3:0xca
    v_mul_hi_u32_u24 v14, 429497, v90
    v_lshrrev_b32 v12, 3, v94
    v_cos_f32 v9, v9
    v_lshlrev_b16 v13, 3, v94
    v_mad_i32_i24 v11, v14, s55, v90
    v_bitop3_b32 v12, v6, v13, v12 bitop3:0xca
    v_add_lshl_u32 v11, v11, s40, 17
    v_lshlrev_b16 v14, 8, v14
    v_lshrrev_b32 v13, 2, v94
    v_or_b32 v90, v12, v11
    v_bitop3_b32 v94, v5, v13, v14 bitop3:0xea
    ds_add_u32 v94, v2
    v_mul_hi_u32_u24 v14, 429497, v91
    v_lshrrev_b32 v12, 3, v95
    v_cos_f32 v10, v10
    v_lshlrev_b16 v13, 3, v95
    v_mad_i32_i24 v11, v14, s55, v91
    v_bitop3_b32 v12, v6, v13, v12 bitop3:0xca
    v_add_lshl_u32 v11, v11, s40, 17
    v_lshlrev_b16 v14, 8, v14
    v_lshrrev_b32 v13, 2, v95
    v_or_b32 v91, v12, v11
    v_bitop3_b32 v95, v5, v13, v14 bitop3:0xea
    ds_add_u32 v95, v2
    v_cvt_pk_bf16_f32 v87, v9, v10
    v_perm_b32 v12, v87, v87, s41
    v_bitop3_b32 v90, v4, v12, v90 bitop3:0xca
    v_perm_b32 v13, v87, v87, s42
    v_bitop3_b32 v91, v4, v13, v91 bitop3:0xca
    v_lshrrev_b32 v8, 2, v0
    v_and_b32 v7, 0x3c00, v0
    v_bitop3_b32 v7, v5, v8, v7 bitop3:0xea
    s_waitcnt lgkmcnt(0)
    s_barrier
    ds_read2st64_b32 v[8:9], v7 offset0:0 offset1:1
    ds_read2st64_b32 v[10:11], v7 offset0:2 offset1:3
    s_add_u32 s45, s33, 0x2400000
    buffer_load_dwordx4 v[112:115], v0, s[12:15], s45 offen nt
    s_waitcnt lgkmcnt(0)
    v_lshl_or_b32 v12, v9, 16, v8
    v_lshl_or_b32 v13, v11, 16, v10
    v_mov_b32 v14, v12
    v_mov_b32 v15, v13
    s_nop 0
    v_add_u32_dpp v14, v14, v14 row_shr:1 row_mask:0xf bank_mask:0xf bound_ctrl:1
    v_add_u32_dpp v15, v15, v15 row_shr:1 row_mask:0xf bank_mask:0xf bound_ctrl:1
    s_nop 0
    v_add_u32_dpp v14, v14, v14 row_shr:2 row_mask:0xf bank_mask:0xf bound_ctrl:1
    v_add_u32_dpp v15, v15, v15 row_shr:2 row_mask:0xf bank_mask:0xf bound_ctrl:1
    s_nop 0
    v_add_u32_dpp v14, v14, v14 row_shr:4 row_mask:0xf bank_mask:0xf bound_ctrl:1
    v_add_u32_dpp v15, v15, v15 row_shr:4 row_mask:0xf bank_mask:0xf bound_ctrl:1
    s_nop 0
    v_add_u32_dpp v14, v14, v14 row_shr:8 row_mask:0xf bank_mask:0xf bound_ctrl:1
    v_add_u32_dpp v15, v15, v15 row_shr:8 row_mask:0xf bank_mask:0xf bound_ctrl:1
    s_nop 0
    v_add_u32_dpp v14, v14, v14 row_bcast:15 row_mask:0xa bank_mask:0xf
    v_add_u32_dpp v15, v15, v15 row_bcast:15 row_mask:0xa bank_mask:0xf
    s_nop 0
    v_add_u32_dpp v14, v14, v14 row_bcast:31 row_mask:0xc bank_mask:0xf
    v_add_u32_dpp v15, v15, v15 row_bcast:31 row_mask:0xc bank_mask:0xf
    v_readlane_b32 s48, v14, 63
    v_readlane_b32 s49, v15, 63
    s_lshl_b32 s54, s32, 2
    v_mov_b32 v8, s54
    s_and_b32 s50, s48, 0xffff
    s_lshr_b32 s51, s48, 16
    s_and_b32 s52, s49, 0xffff
    s_lshr_b32 s53, s49, 16
    s_add_u32 s51, s51, s50
    s_add_u32 s52, s52, s51
    s_add_u32 s53, s53, s52
    v_mov_b32 v9, s53
    s_mov_b64 exec, 1
    ds_write_b32 v8, v9 offset:16384
    s_mov_b64 exec, -1
    v_and_b32 v8, 60, v7
    s_waitcnt lgkmcnt(0)
    s_barrier
    ds_read_b32 v9, v8 offset:16384
    s_waitcnt lgkmcnt(0)
    v_add_u32_dpp v9, v9, v9 row_shr:1 row_mask:0xf bank_mask:0xf bound_ctrl:1
    s_nop 1
    v_add_u32_dpp v9, v9, v9 row_shr:2 row_mask:0xf bank_mask:0xf bound_ctrl:1
    s_nop 1
    v_add_u32_dpp v9, v9, v9 row_shr:4 row_mask:0xf bank_mask:0xf bound_ctrl:1
    s_nop 1
    v_add_u32_dpp v9, v9, v9 row_shr:8 row_mask:0xf bank_mask:0xf bound_ctrl:1
    s_nop 0
    v_readlane_b32 s54, v9, s32
    s_sub_u32 s54, s54, s53
    s_add_u32 s50, s50, s54
    s_add_u32 s51, s51, s54
    s_add_u32 s52, s52, s54
    s_pack_ll_b32_b16 s48, s54, s50
    s_pack_ll_b32_b16 s49, s51, s52
    v_add_u32 v14, s48, v14
    v_add_u32 v15, s49, v15
    v_sub_u32 v12, v14, v12
    v_sub_u32 v13, v15, v13
    v_and_b32 v8, 0xffff, v12
    v_lshrrev_b32 v9, 16, v12
    v_and_b32 v10, 0xffff, v13
    v_lshrrev_b32 v11, 16, v13
    ds_write2st64_b32 v7, v8, v9 offset0:0 offset1:1
    ds_write2st64_b32 v7, v10, v11 offset0:2 offset1:3
    s_waitcnt lgkmcnt(0)
    s_barrier
    ds_add_rtn_u32 v20, v20, v2
    ds_add_rtn_u32 v21, v21, v2
    ds_add_rtn_u32 v22, v22, v2
    ds_add_rtn_u32 v23, v23, v2
    s_add_u32 s46, s36, 0x0
    v_and_b32 v11, 0x3f0, v0
    v_add_u32 v11, v11, v11
    buffer_store_dwordx2 v[12:13], v11, s[24:27], s46 offen
    s_bitset0_b64 exec, 63
    s_not_b64 exec, exec
    buffer_store_dwordx2 v[14:15], v11, s[24:27], s46 offen offset:32
    s_mov_b64 exec, -1
    ds_add_rtn_u32 v32, v32, v2
    ds_add_rtn_u32 v33, v33, v2
    ds_add_rtn_u32 v34, v34, v2
    ds_add_rtn_u32 v35, v35, v2
    ds_add_rtn_u32 v40, v40, v2
    ds_add_rtn_u32 v41, v41, v2
    ds_add_rtn_u32 v42, v42, v2
    ds_add_rtn_u32 v43, v43, v2
    s_add_u32 s47, s33, 0x2800000
    buffer_load_dwordx4 v[116:119], v0, s[8:11], s47 offen nt
    ds_add_rtn_u32 v52, v52, v2
    ds_add_rtn_u32 v53, v53, v2
    ds_add_rtn_u32 v54, v54, v2
    ds_add_rtn_u32 v55, v55, v2
    ds_add_rtn_u32 v60, v60, v2
    ds_add_rtn_u32 v61, v61, v2
    ds_add_rtn_u32 v62, v62, v2
    ds_add_rtn_u32 v63, v63, v2
    ds_add_rtn_u32 v72, v72, v2
    ds_add_rtn_u32 v73, v73, v2
    ds_add_rtn_u32 v74, v74, v2
    ds_add_rtn_u32 v75, v75, v2
    s_add_u32 s44, s33, 0x2800000
    buffer_load_dwordx4 v[120:123], v0, s[12:15], s44 offen nt
    ds_add_rtn_u32 v80, v80, v2
    ds_add_rtn_u32 v81, v81, v2
    ds_add_rtn_u32 v82, v82, v2
    ds_add_rtn_u32 v83, v83, v2
    ds_add_rtn_u32 v92, v92, v2
    ds_add_rtn_u32 v93, v93, v2
    ds_add_rtn_u32 v94, v94, v2
    ds_add_rtn_u32 v95, v95, v2
    s_waitcnt lgkmcnt(0)
    s_barrier
    v_and_b32 v7, -4, v20
    v_lshl_add_u32 v8, v20, 2, v7
    ds_write_b32 v8, v16
    v_lshl_add_u32 v7, v7, 2, v20
    ds_write_b8 v7, v24 offset:16
    v_and_b32 v9, -4, v21
    v_lshl_add_u32 v10, v21, 2, v9
    ds_write_b32 v10, v17
    v_lshl_add_u32 v9, v9, 2, v21
    ds_write_b8_d16_hi v9, v24 offset:16
    v_and_b32 v7, -4, v22
    v_lshl_add_u32 v8, v22, 2, v7
    ds_write_b32 v8, v18
    v_lshl_add_u32 v7, v7, 2, v22
    ds_write_b8 v7, v25 offset:16
    v_and_b32 v9, -4, v23
    v_lshl_add_u32 v10, v23, 2, v9
    ds_write_b32 v10, v19
    v_lshl_add_u32 v9, v9, 2, v23
    ds_write_b8_d16_hi v9, v25 offset:16
    s_add_u32 s45, s34, 0x1400000
    buffer_load_dwordx2 v[124:125], v1, s[16:19], s45 offen nt
    s_add_u32 s46, s34, 0x1600000
    buffer_load_dwordx2 v[126:127], v1, s[16:19], s46 offen nt
    s_add_u32 s47, s33, 0x2c00000
    buffer_load_dwordx4 v[16:19], v0, s[8:11], s47 offen nt
    v_and_b32 v7, -4, v32
    v_lshl_add_u32 v8, v32, 2, v7
    ds_write_b32 v8, v28
    v_lshl_add_u32 v7, v7, 2, v32
    ds_write_b8 v7, v26 offset:16
    v_and_b32 v9, -4, v33
    v_lshl_add_u32 v10, v33, 2, v9
    ds_write_b32 v10, v29
    v_lshl_add_u32 v9, v9, 2, v33
    ds_write_b8_d16_hi v9, v26 offset:16
    v_and_b32 v7, -4, v34
    v_lshl_add_u32 v8, v34, 2, v7
    ds_write_b32 v8, v30
    v_lshl_add_u32 v7, v7, 2, v34
    ds_write_b8 v7, v27 offset:16
    v_and_b32 v9, -4, v35
    v_lshl_add_u32 v10, v35, 2, v9
    ds_write_b32 v10, v31
    v_lshl_add_u32 v9, v9, 2, v35
    ds_write_b8_d16_hi v9, v27 offset:16
    s_add_u32 s44, s33, 0x2c00000
    buffer_load_dwordx4 v[20:23], v0, s[12:15], s44 offen nt
    v_and_b32 v7, -4, v40
    v_lshl_add_u32 v8, v40, 2, v7
    ds_write_b32 v8, v36
    v_lshl_add_u32 v7, v7, 2, v40
    ds_write_b8 v7, v44 offset:16
    v_and_b32 v9, -4, v41
    v_lshl_add_u32 v10, v41, 2, v9
    ds_write_b32 v10, v37
    v_lshl_add_u32 v9, v9, 2, v41
    ds_write_b8_d16_hi v9, v44 offset:16
    v_and_b32 v7, -4, v42
    v_lshl_add_u32 v8, v42, 2, v7
    ds_write_b32 v8, v38
    v_lshl_add_u32 v7, v7, 2, v42
    ds_write_b8 v7, v45 offset:16
    v_and_b32 v9, -4, v43
    v_lshl_add_u32 v10, v43, 2, v9
    ds_write_b32 v10, v39
    v_lshl_add_u32 v9, v9, 2, v43
    ds_write_b8_d16_hi v9, v45 offset:16
    s_add_u32 s45, s33, 0x3000000
    buffer_load_dwordx4 v[28:31], v0, s[8:11], s45 offen nt
    s_add_u32 s46, s33, 0x3000000
    buffer_load_dwordx4 v[32:35], v0, s[12:15], s46 offen nt
    v_and_b32 v7, -4, v52
    v_lshl_add_u32 v8, v52, 2, v7
    ds_write_b32 v8, v48
    v_lshl_add_u32 v7, v7, 2, v52
    ds_write_b8 v7, v46 offset:16
    v_and_b32 v9, -4, v53
    v_lshl_add_u32 v10, v53, 2, v9
    ds_write_b32 v10, v49
    v_lshl_add_u32 v9, v9, 2, v53
    ds_write_b8_d16_hi v9, v46 offset:16
    v_and_b32 v7, -4, v54
    v_lshl_add_u32 v8, v54, 2, v7
    ds_write_b32 v8, v50
    v_lshl_add_u32 v7, v7, 2, v54
    ds_write_b8 v7, v47 offset:16
    v_and_b32 v9, -4, v55
    v_lshl_add_u32 v10, v55, 2, v9
    ds_write_b32 v10, v51
    v_lshl_add_u32 v9, v9, 2, v55
    ds_write_b8_d16_hi v9, v47 offset:16
    s_add_u32 s47, s34, 0x1800000
    buffer_load_dwordx2 v[24:25], v1, s[16:19], s47 offen nt
    s_add_u32 s44, s34, 0x1a00000
    buffer_load_dwordx2 v[26:27], v1, s[16:19], s44 offen nt
    v_and_b32 v7, -4, v60
    v_lshl_add_u32 v8, v60, 2, v7
    ds_write_b32 v8, v56
    v_lshl_add_u32 v7, v7, 2, v60
    ds_write_b8 v7, v64 offset:16
    v_and_b32 v9, -4, v61
    v_lshl_add_u32 v10, v61, 2, v9
    ds_write_b32 v10, v57
    v_lshl_add_u32 v9, v9, 2, v61
    ds_write_b8_d16_hi v9, v64 offset:16
    v_and_b32 v7, -4, v62
    v_lshl_add_u32 v8, v62, 2, v7
    ds_write_b32 v8, v58
    v_lshl_add_u32 v7, v7, 2, v62
    ds_write_b8 v7, v65 offset:16
    v_and_b32 v9, -4, v63
    v_lshl_add_u32 v10, v63, 2, v9
    ds_write_b32 v10, v59
    v_lshl_add_u32 v9, v9, 2, v63
    ds_write_b8_d16_hi v9, v65 offset:16
    s_add_u32 s45, s33, 0x3400000
    buffer_load_dwordx4 v[36:39], v0, s[8:11], s45 offen nt
    v_and_b32 v7, -4, v72
    v_lshl_add_u32 v8, v72, 2, v7
    ds_write_b32 v8, v68
    v_lshl_add_u32 v7, v7, 2, v72
    ds_write_b8 v7, v66 offset:16
    v_and_b32 v9, -4, v73
    v_lshl_add_u32 v10, v73, 2, v9
    ds_write_b32 v10, v69
    v_lshl_add_u32 v9, v9, 2, v73
    ds_write_b8_d16_hi v9, v66 offset:16
    v_and_b32 v7, -4, v74
    v_lshl_add_u32 v8, v74, 2, v7
    ds_write_b32 v8, v70
    v_lshl_add_u32 v7, v7, 2, v74
    ds_write_b8 v7, v67 offset:16
    v_and_b32 v9, -4, v75
    v_lshl_add_u32 v10, v75, 2, v9
    ds_write_b32 v10, v71
    v_lshl_add_u32 v9, v9, 2, v75
    ds_write_b8_d16_hi v9, v67 offset:16
    s_add_u32 s46, s33, 0x3400000
    buffer_load_dwordx4 v[40:43], v0, s[12:15], s46 offen nt
    s_add_u32 s47, s33, 0x3800000
    buffer_load_dwordx4 v[48:51], v0, s[8:11], s47 offen nt
    v_and_b32 v7, -4, v80
    v_lshl_add_u32 v8, v80, 2, v7
    ds_write_b32 v8, v76
    v_lshl_add_u32 v7, v7, 2, v80
    ds_write_b8 v7, v84 offset:16
    v_and_b32 v9, -4, v81
    v_lshl_add_u32 v10, v81, 2, v9
    ds_write_b32 v10, v77
    v_lshl_add_u32 v9, v9, 2, v81
    ds_write_b8_d16_hi v9, v84 offset:16
    v_and_b32 v7, -4, v82
    v_lshl_add_u32 v8, v82, 2, v7
    ds_write_b32 v8, v78
    v_lshl_add_u32 v7, v7, 2, v82
    ds_write_b8 v7, v85 offset:16
    v_and_b32 v9, -4, v83
    v_lshl_add_u32 v10, v83, 2, v9
    ds_write_b32 v10, v79
    v_lshl_add_u32 v9, v9, 2, v83
    ds_write_b8_d16_hi v9, v85 offset:16
    s_add_u32 s44, s33, 0x3800000
    buffer_load_dwordx4 v[52:55], v0, s[12:15], s44 offen nt
    v_and_b32 v7, -4, v92
    v_lshl_add_u32 v8, v92, 2, v7
    ds_write_b32 v8, v88
    v_lshl_add_u32 v7, v7, 2, v92
    ds_write_b8 v7, v86 offset:16
    v_and_b32 v9, -4, v93
    v_lshl_add_u32 v10, v93, 2, v9
    ds_write_b32 v10, v89
    v_lshl_add_u32 v9, v9, 2, v93
    ds_write_b8_d16_hi v9, v86 offset:16
    v_and_b32 v7, -4, v94
    v_lshl_add_u32 v8, v94, 2, v7
    ds_write_b32 v8, v90
    v_lshl_add_u32 v7, v7, 2, v94
    ds_write_b8 v7, v87 offset:16
    v_and_b32 v9, -4, v95
    v_lshl_add_u32 v10, v95, 2, v9
    ds_write_b32 v10, v91
    v_lshl_add_u32 v9, v9, 2, v95
    ds_write_b8_d16_hi v9, v87 offset:16
    s_add_u32 s45, s34, 0x1c00000
    buffer_load_dwordx2 v[44:45], v1, s[16:19], s45 offen nt
    s_add_u32 s46, s34, 0x1e00000
    buffer_load_dwordx2 v[46:47], v1, s[16:19], s46 offen nt
    v_add_u32 v7, 0x10000, v0
    v_add_u32 v12, 0x20000, v0
    v_mov_b32 v8, 0
    v_mov_b32 v9, 0
    v_mov_b32 v10, 0
    v_mov_b32 v11, 0
    s_waitcnt lgkmcnt(0)
    s_barrier
    ds_read_b128 v[56:59], v0 offset:0
    ds_write_b128 v0, v[8:11]
    ds_read_b128 v[60:63], v0 offset:16384
    ds_read_b128 v[68:71], v0 offset:32768
    ds_read_b128 v[72:75], v0 offset:49152
    ds_read_b128 v[64:67], v7 offset:0
    ds_read_b128 v[76:79], v7 offset:16384
    ds_read_b128 v[80:83], v7 offset:32768
    ds_read_b128 v[88:91], v7 offset:49152
    ds_read_b128 v[92:95], v12 offset:0
    ds_read_b128 v[84:87], v12 offset:16384
    s_waitcnt lgkmcnt(0)
    s_barrier
    s_add_u32 s47, s35, 0x0
    buffer_store_dwordx4 v[56:59], v0, s[20:23], s47 offen sc1
    s_add_u32 s44, s33, 0x3c00000
    s_nop 0
    buffer_load_dwordx4 v[56:59], v0, s[8:11], s44 offen nt
    s_add_u32 s45, s35, 0x4000
    buffer_store_dwordx4 v[60:63], v0, s[20:23], s45 offen sc1
    s_add_u32 s46, s33, 0x3c00000
    s_nop 0
    buffer_load_dwordx4 v[60:63], v0, s[12:15], s46 offen nt
    s_waitcnt vmcnt(24)
    v_lshlrev_b32 v7, 16, v104
    v_and_b32 v8, 0xffff0000, v104
    v_lshlrev_b32 v9, 16, v105
    v_and_b32 v10, 0xffff0000, v105
    v_mul_f32 v7, 0.15915494, v7
    v_mul_f32 v8, 0.15915494, v8
    v_mul_f32 v9, 0.15915494, v9
    v_mul_f32 v10, 0.15915494, v10
    v_mul_hi_u32_u24 v14, 429497, v96
    v_lshrrev_b32 v12, 3, v100
    v_cos_f32 v7, v7
    v_lshlrev_b16 v13, 3, v100
    v_mad_i32_i24 v11, v14, s55, v96
    v_bitop3_b32 v12, v6, v13, v12 bitop3:0xca
    v_add_lshl_u32 v11, v11, s40, 17
    v_lshlrev_b16 v14, 8, v14
    v_lshrrev_b32 v13, 2, v100
    v_or_b32 v96, v12, v11
    v_bitop3_b32 v100, v5, v13, v14 bitop3:0xea
    ds_add_u32 v100, v2
    v_mul_hi_u32_u24 v14, 429497, v97
    v_lshrrev_b32 v12, 3, v101
    v_cos_f32 v8, v8
    v_lshlrev_b16 v13, 3, v101
    v_mad_i32_i24 v11, v14, s55, v97
    v_bitop3_b32 v12, v6, v13, v12 bitop3:0xca
    v_add_lshl_u32 v11, v11, s40, 17
    v_lshlrev_b16 v14, 8, v14
    v_lshrrev_b32 v13, 2, v101
    v_or_b32 v97, v12, v11
    v_bitop3_b32 v101, v5, v13, v14 bitop3:0xea
    ds_add_u32 v101, v2
    v_cvt_pk_bf16_f32 v104, v7, v8
    v_perm_b32 v12, v104, v104, s41
    v_bitop3_b32 v96, v4, v12, v96 bitop3:0xca
    v_perm_b32 v13, v104, v104, s42
    v_bitop3_b32 v97, v4, v13, v97 bitop3:0xca
    v_mul_hi_u32_u24 v14, 429497, v98
    v_lshrrev_b32 v12, 3, v102
    v_cos_f32 v9, v9
    v_lshlrev_b16 v13, 3, v102
    v_mad_i32_i24 v11, v14, s55, v98
    v_bitop3_b32 v12, v6, v13, v12 bitop3:0xca
    v_add_lshl_u32 v11, v11, s40, 17
    v_lshlrev_b16 v14, 8, v14
    v_lshrrev_b32 v13, 2, v102
    v_or_b32 v98, v12, v11
    v_bitop3_b32 v102, v5, v13, v14 bitop3:0xea
    ds_add_u32 v102, v2
    v_mul_hi_u32_u24 v14, 429497, v99
    v_lshrrev_b32 v12, 3, v103
    v_cos_f32 v10, v10
    v_lshlrev_b16 v13, 3, v103
    v_mad_i32_i24 v11, v14, s55, v99
    v_bitop3_b32 v12, v6, v13, v12 bitop3:0xca
    v_add_lshl_u32 v11, v11, s40, 17
    v_lshlrev_b16 v14, 8, v14
    v_lshrrev_b32 v13, 2, v103
    v_or_b32 v99, v12, v11
    v_bitop3_b32 v103, v5, v13, v14 bitop3:0xea
    ds_add_u32 v103, v2
    v_cvt_pk_bf16_f32 v105, v9, v10
    v_perm_b32 v12, v105, v105, s41
    v_bitop3_b32 v98, v4, v12, v98 bitop3:0xca
    v_perm_b32 v13, v105, v105, s42
    v_bitop3_b32 v99, v4, v13, v99 bitop3:0xca
    s_waitcnt vmcnt(22)
    v_lshlrev_b32 v7, 16, v106
    v_and_b32 v8, 0xffff0000, v106
    v_lshlrev_b32 v9, 16, v107
    v_and_b32 v10, 0xffff0000, v107
    v_mul_f32 v7, 0.15915494, v7
    v_mul_f32 v8, 0.15915494, v8
    v_mul_f32 v9, 0.15915494, v9
    v_mul_f32 v10, 0.15915494, v10
    v_mul_hi_u32_u24 v14, 429497, v108
    v_lshrrev_b32 v12, 3, v112
    v_cos_f32 v7, v7
    v_lshlrev_b16 v13, 3, v112
    v_mad_i32_i24 v11, v14, s55, v108
    v_bitop3_b32 v12, v6, v13, v12 bitop3:0xca
    v_add_lshl_u32 v11, v11, s40, 17
    v_lshlrev_b16 v14, 8, v14
    v_lshrrev_b32 v13, 2, v112
    v_or_b32 v108, v12, v11
    v_bitop3_b32 v112, v5, v13, v14 bitop3:0xea
    ds_add_u32 v112, v2
    v_mul_hi_u32_u24 v14, 429497, v109
    v_lshrrev_b32 v12, 3, v113
    v_cos_f32 v8, v8
    v_lshlrev_b16 v13, 3, v113
    v_mad_i32_i24 v11, v14, s55, v109
    v_bitop3_b32 v12, v6, v13, v12 bitop3:0xca
    v_add_lshl_u32 v11, v11, s40, 17
    v_lshlrev_b16 v14, 8, v14
    v_lshrrev_b32 v13, 2, v113
    v_or_b32 v109, v12, v11
    v_bitop3_b32 v113, v5, v13, v14 bitop3:0xea
    ds_add_u32 v113, v2
    v_cvt_pk_bf16_f32 v106, v7, v8
    v_perm_b32 v12, v106, v106, s41
    v_bitop3_b32 v108, v4, v12, v108 bitop3:0xca
    v_perm_b32 v13, v106, v106, s42
    v_bitop3_b32 v109, v4, v13, v109 bitop3:0xca
    v_mul_hi_u32_u24 v14, 429497, v110
    v_lshrrev_b32 v12, 3, v114
    v_cos_f32 v9, v9
    v_lshlrev_b16 v13, 3, v114
    v_mad_i32_i24 v11, v14, s55, v110
    v_bitop3_b32 v12, v6, v13, v12 bitop3:0xca
    v_add_lshl_u32 v11, v11, s40, 17
    v_lshlrev_b16 v14, 8, v14
    v_lshrrev_b32 v13, 2, v114
    v_or_b32 v110, v12, v11
    v_bitop3_b32 v114, v5, v13, v14 bitop3:0xea
    ds_add_u32 v114, v2
    v_mul_hi_u32_u24 v14, 429497, v111
    v_lshrrev_b32 v12, 3, v115
    v_cos_f32 v10, v10
    v_lshlrev_b16 v13, 3, v115
    v_mad_i32_i24 v11, v14, s55, v111
    v_bitop3_b32 v12, v6, v13, v12 bitop3:0xca
    v_add_lshl_u32 v11, v11, s40, 17
    v_lshlrev_b16 v14, 8, v14
    v_lshrrev_b32 v13, 2, v115
    v_or_b32 v111, v12, v11
    v_bitop3_b32 v115, v5, v13, v14 bitop3:0xea
    ds_add_u32 v115, v2
    v_cvt_pk_bf16_f32 v107, v9, v10
    v_perm_b32 v12, v107, v107, s41
    v_bitop3_b32 v110, v4, v12, v110 bitop3:0xca
    v_perm_b32 v13, v107, v107, s42
    v_bitop3_b32 v111, v4, v13, v111 bitop3:0xca
    s_waitcnt vmcnt(16)
    v_lshlrev_b32 v7, 16, v124
    v_and_b32 v8, 0xffff0000, v124
    v_lshlrev_b32 v9, 16, v125
    v_and_b32 v10, 0xffff0000, v125
    v_mul_f32 v7, 0.15915494, v7
    v_mul_f32 v8, 0.15915494, v8
    v_mul_f32 v9, 0.15915494, v9
    v_mul_f32 v10, 0.15915494, v10
    v_mul_hi_u32_u24 v14, 429497, v116
    v_lshrrev_b32 v12, 3, v120
    v_cos_f32 v7, v7
    v_lshlrev_b16 v13, 3, v120
    v_mad_i32_i24 v11, v14, s55, v116
    v_bitop3_b32 v12, v6, v13, v12 bitop3:0xca
    v_add_lshl_u32 v11, v11, s40, 17
    v_lshlrev_b16 v14, 8, v14
    v_lshrrev_b32 v13, 2, v120
    v_or_b32 v116, v12, v11
    v_bitop3_b32 v120, v5, v13, v14 bitop3:0xea
    ds_add_u32 v120, v2
    v_mul_hi_u32_u24 v14, 429497, v117
    v_lshrrev_b32 v12, 3, v121
    v_cos_f32 v8, v8
    v_lshlrev_b16 v13, 3, v121
    v_mad_i32_i24 v11, v14, s55, v117
    v_bitop3_b32 v12, v6, v13, v12 bitop3:0xca
    v_add_lshl_u32 v11, v11, s40, 17
    v_lshlrev_b16 v14, 8, v14
    v_lshrrev_b32 v13, 2, v121
    v_or_b32 v117, v12, v11
    v_bitop3_b32 v121, v5, v13, v14 bitop3:0xea
    ds_add_u32 v121, v2
    v_cvt_pk_bf16_f32 v124, v7, v8
    v_perm_b32 v12, v124, v124, s41
    v_bitop3_b32 v116, v4, v12, v116 bitop3:0xca
    v_perm_b32 v13, v124, v124, s42
    v_bitop3_b32 v117, v4, v13, v117 bitop3:0xca
    v_mul_hi_u32_u24 v14, 429497, v118
    v_lshrrev_b32 v12, 3, v122
    v_cos_f32 v9, v9
    v_lshlrev_b16 v13, 3, v122
    v_mad_i32_i24 v11, v14, s55, v118
    v_bitop3_b32 v12, v6, v13, v12 bitop3:0xca
    v_add_lshl_u32 v11, v11, s40, 17
    v_lshlrev_b16 v14, 8, v14
    v_lshrrev_b32 v13, 2, v122
    v_or_b32 v118, v12, v11
    v_bitop3_b32 v122, v5, v13, v14 bitop3:0xea
    ds_add_u32 v122, v2
    v_mul_hi_u32_u24 v14, 429497, v119
    v_lshrrev_b32 v12, 3, v123
    v_cos_f32 v10, v10
    v_lshlrev_b16 v13, 3, v123
    v_mad_i32_i24 v11, v14, s55, v119
    v_bitop3_b32 v12, v6, v13, v12 bitop3:0xca
    v_add_lshl_u32 v11, v11, s40, 17
    v_lshlrev_b16 v14, 8, v14
    v_lshrrev_b32 v13, 2, v123
    v_or_b32 v119, v12, v11
    v_bitop3_b32 v123, v5, v13, v14 bitop3:0xea
    ds_add_u32 v123, v2
    v_cvt_pk_bf16_f32 v125, v9, v10
    v_perm_b32 v12, v125, v125, s41
    v_bitop3_b32 v118, v4, v12, v118 bitop3:0xca
    v_perm_b32 v13, v125, v125, s42
    v_bitop3_b32 v119, v4, v13, v119 bitop3:0xca
    s_add_u32 s47, s35, 0x8000
    buffer_store_dwordx4 v[68:71], v0, s[20:23], s47 offen sc1
    s_add_u32 s44, s33, 0x4000000
    s_nop 0
    buffer_load_dwordx4 v[68:71], v0, s[8:11], s44 offen nt
    s_waitcnt vmcnt(16)
    v_lshlrev_b32 v7, 16, v126
    v_and_b32 v8, 0xffff0000, v126
    v_lshlrev_b32 v9, 16, v127
    v_and_b32 v10, 0xffff0000, v127
    v_mul_f32 v7, 0.15915494, v7
    v_mul_f32 v8, 0.15915494, v8
    v_mul_f32 v9, 0.15915494, v9
    v_mul_f32 v10, 0.15915494, v10
    v_mul_hi_u32_u24 v14, 429497, v16
    v_lshrrev_b32 v12, 3, v20
    v_cos_f32 v7, v7
    v_lshlrev_b16 v13, 3, v20
    v_mad_i32_i24 v11, v14, s55, v16
    v_bitop3_b32 v12, v6, v13, v12 bitop3:0xca
    v_add_lshl_u32 v11, v11, s40, 17
    v_lshlrev_b16 v14, 8, v14
    v_lshrrev_b32 v13, 2, v20
    v_or_b32 v16, v12, v11
    v_bitop3_b32 v20, v5, v13, v14 bitop3:0xea
    ds_add_u32 v20, v2
    v_mul_hi_u32_u24 v14, 429497, v17
    v_lshrrev_b32 v12, 3, v21
    v_cos_f32 v8, v8
    v_lshlrev_b16 v13, 3, v21
    v_mad_i32_i24 v11, v14, s55, v17
    v_bitop3_b32 v12, v6, v13, v12 bitop3:0xca
    v_add_lshl_u32 v11, v11, s40, 17
    v_lshlrev_b16 v14, 8, v14
    v_lshrrev_b32 v13, 2, v21
    v_or_b32 v17, v12, v11
    v_bitop3_b32 v21, v5, v13, v14 bitop3:0xea
    ds_add_u32 v21, v2
    v_cvt_pk_bf16_f32 v126, v7, v8
    v_perm_b32 v12, v126, v126, s41
    v_bitop3_b32 v16, v4, v12, v16 bitop3:0xca
    v_perm_b32 v13, v126, v126, s42
    v_bitop3_b32 v17, v4, v13, v17 bitop3:0xca
    v_mul_hi_u32_u24 v14, 429497, v18
    v_lshrrev_b32 v12, 3, v22
    v_cos_f32 v9, v9
    v_lshlrev_b16 v13, 3, v22
    v_mad_i32_i24 v11, v14, s55, v18
    v_bitop3_b32 v12, v6, v13, v12 bitop3:0xca
    v_add_lshl_u32 v11, v11, s40, 17
    v_lshlrev_b16 v14, 8, v14
    v_lshrrev_b32 v13, 2, v22
    v_or_b32 v18, v12, v11
    v_bitop3_b32 v22, v5, v13, v14 bitop3:0xea
    ds_add_u32 v22, v2
    v_mul_hi_u32_u24 v14, 429497, v19
    v_lshrrev_b32 v12, 3, v23
    v_cos_f32 v10, v10
    v_lshlrev_b16 v13, 3, v23
    v_mad_i32_i24 v11, v14, s55, v19
    v_bitop3_b32 v12, v6, v13, v12 bitop3:0xca
    v_add_lshl_u32 v11, v11, s40, 17
    v_lshlrev_b16 v14, 8, v14
    v_lshrrev_b32 v13, 2, v23
    v_or_b32 v19, v12, v11
    v_bitop3_b32 v23, v5, v13, v14 bitop3:0xea
    ds_add_u32 v23, v2
    v_cvt_pk_bf16_f32 v127, v9, v10
    v_perm_b32 v12, v127, v127, s41
    v_bitop3_b32 v18, v4, v12, v18 bitop3:0xca
    v_perm_b32 v13, v127, v127, s42
    v_bitop3_b32 v19, v4, v13, v19 bitop3:0xca
    s_waitcnt vmcnt(12)
    v_lshlrev_b32 v7, 16, v24
    v_and_b32 v8, 0xffff0000, v24
    v_lshlrev_b32 v9, 16, v25
    v_and_b32 v10, 0xffff0000, v25
    v_mul_f32 v7, 0.15915494, v7
    v_mul_f32 v8, 0.15915494, v8
    v_mul_f32 v9, 0.15915494, v9
    v_mul_f32 v10, 0.15915494, v10
    v_mul_hi_u32_u24 v14, 429497, v28
    v_lshrrev_b32 v12, 3, v32
    v_cos_f32 v7, v7
    v_lshlrev_b16 v13, 3, v32
    v_mad_i32_i24 v11, v14, s55, v28
    v_bitop3_b32 v12, v6, v13, v12 bitop3:0xca
    v_add_lshl_u32 v11, v11, s40, 17
    v_lshlrev_b16 v14, 8, v14
    v_lshrrev_b32 v13, 2, v32
    v_or_b32 v28, v12, v11
    v_bitop3_b32 v32, v5, v13, v14 bitop3:0xea
    ds_add_u32 v32, v2
    v_mul_hi_u32_u24 v14, 429497, v29
    v_lshrrev_b32 v12, 3, v33
    v_cos_f32 v8, v8
    v_lshlrev_b16 v13, 3, v33
    v_mad_i32_i24 v11, v14, s55, v29
    v_bitop3_b32 v12, v6, v13, v12 bitop3:0xca
    v_add_lshl_u32 v11, v11, s40, 17
    v_lshlrev_b16 v14, 8, v14
    v_lshrrev_b32 v13, 2, v33
    v_or_b32 v29, v12, v11
    v_bitop3_b32 v33, v5, v13, v14 bitop3:0xea
    ds_add_u32 v33, v2
    v_cvt_pk_bf16_f32 v24, v7, v8
    v_perm_b32 v12, v24, v24, s41
    v_bitop3_b32 v28, v4, v12, v28 bitop3:0xca
    v_perm_b32 v13, v24, v24, s42
    v_bitop3_b32 v29, v4, v13, v29 bitop3:0xca
    v_mul_hi_u32_u24 v14, 429497, v30
    v_lshrrev_b32 v12, 3, v34
    v_cos_f32 v9, v9
    v_lshlrev_b16 v13, 3, v34
    v_mad_i32_i24 v11, v14, s55, v30
    v_bitop3_b32 v12, v6, v13, v12 bitop3:0xca
    v_add_lshl_u32 v11, v11, s40, 17
    v_lshlrev_b16 v14, 8, v14
    v_lshrrev_b32 v13, 2, v34
    v_or_b32 v30, v12, v11
    v_bitop3_b32 v34, v5, v13, v14 bitop3:0xea
    ds_add_u32 v34, v2
    v_mul_hi_u32_u24 v14, 429497, v31
    v_lshrrev_b32 v12, 3, v35
    v_cos_f32 v10, v10
    v_lshlrev_b16 v13, 3, v35
    v_mad_i32_i24 v11, v14, s55, v31
    v_bitop3_b32 v12, v6, v13, v12 bitop3:0xca
    v_add_lshl_u32 v11, v11, s40, 17
    v_lshlrev_b16 v14, 8, v14
    v_lshrrev_b32 v13, 2, v35
    v_or_b32 v31, v12, v11
    v_bitop3_b32 v35, v5, v13, v14 bitop3:0xea
    ds_add_u32 v35, v2
    v_cvt_pk_bf16_f32 v25, v9, v10
    v_perm_b32 v12, v25, v25, s41
    v_bitop3_b32 v30, v4, v12, v30 bitop3:0xca
    v_perm_b32 v13, v25, v25, s42
    v_bitop3_b32 v31, v4, v13, v31 bitop3:0xca
    s_waitcnt vmcnt(10)
    v_lshlrev_b32 v7, 16, v26
    v_and_b32 v8, 0xffff0000, v26
    v_lshlrev_b32 v9, 16, v27
    v_and_b32 v10, 0xffff0000, v27
    v_mul_f32 v7, 0.15915494, v7
    v_mul_f32 v8, 0.15915494, v8
    v_mul_f32 v9, 0.15915494, v9
    v_mul_f32 v10, 0.15915494, v10
    v_mul_hi_u32_u24 v14, 429497, v36
    v_lshrrev_b32 v12, 3, v40
    v_cos_f32 v7, v7
    v_lshlrev_b16 v13, 3, v40
    v_mad_i32_i24 v11, v14, s55, v36
    v_bitop3_b32 v12, v6, v13, v12 bitop3:0xca
    v_add_lshl_u32 v11, v11, s40, 17
    v_lshlrev_b16 v14, 8, v14
    v_lshrrev_b32 v13, 2, v40
    v_or_b32 v36, v12, v11
    v_bitop3_b32 v40, v5, v13, v14 bitop3:0xea
    ds_add_u32 v40, v2
    v_mul_hi_u32_u24 v14, 429497, v37
    v_lshrrev_b32 v12, 3, v41
    v_cos_f32 v8, v8
    v_lshlrev_b16 v13, 3, v41
    v_mad_i32_i24 v11, v14, s55, v37
    v_bitop3_b32 v12, v6, v13, v12 bitop3:0xca
    v_add_lshl_u32 v11, v11, s40, 17
    v_lshlrev_b16 v14, 8, v14
    v_lshrrev_b32 v13, 2, v41
    v_or_b32 v37, v12, v11
    v_bitop3_b32 v41, v5, v13, v14 bitop3:0xea
    ds_add_u32 v41, v2
    v_cvt_pk_bf16_f32 v26, v7, v8
    v_perm_b32 v12, v26, v26, s41
    v_bitop3_b32 v36, v4, v12, v36 bitop3:0xca
    v_perm_b32 v13, v26, v26, s42
    v_bitop3_b32 v37, v4, v13, v37 bitop3:0xca
    v_mul_hi_u32_u24 v14, 429497, v38
    v_lshrrev_b32 v12, 3, v42
    v_cos_f32 v9, v9
    v_lshlrev_b16 v13, 3, v42
    v_mad_i32_i24 v11, v14, s55, v38
    v_bitop3_b32 v12, v6, v13, v12 bitop3:0xca
    v_add_lshl_u32 v11, v11, s40, 17
    v_lshlrev_b16 v14, 8, v14
    v_lshrrev_b32 v13, 2, v42
    v_or_b32 v38, v12, v11
    v_bitop3_b32 v42, v5, v13, v14 bitop3:0xea
    ds_add_u32 v42, v2
    v_mul_hi_u32_u24 v14, 429497, v39
    v_lshrrev_b32 v12, 3, v43
    v_cos_f32 v10, v10
    v_lshlrev_b16 v13, 3, v43
    v_mad_i32_i24 v11, v14, s55, v39
    v_bitop3_b32 v12, v6, v13, v12 bitop3:0xca
    v_add_lshl_u32 v11, v11, s40, 17
    v_lshlrev_b16 v14, 8, v14
    v_lshrrev_b32 v13, 2, v43
    v_or_b32 v39, v12, v11
    v_bitop3_b32 v43, v5, v13, v14 bitop3:0xea
    ds_add_u32 v43, v2
    v_cvt_pk_bf16_f32 v27, v9, v10
    v_perm_b32 v12, v27, v27, s41
    v_bitop3_b32 v38, v4, v12, v38 bitop3:0xca
    v_perm_b32 v13, v27, v27, s42
    v_bitop3_b32 v39, v4, v13, v39 bitop3:0xca
    s_add_u32 s45, s35, 0xc000
    buffer_store_dwordx4 v[72:75], v0, s[20:23], s45 offen sc1
    s_add_u32 s46, s33, 0x4000000
    s_nop 0
    buffer_load_dwordx4 v[72:75], v0, s[12:15], s46 offen nt
    s_waitcnt vmcnt(8)
    v_lshlrev_b32 v7, 16, v44
    v_and_b32 v8, 0xffff0000, v44
    v_lshlrev_b32 v9, 16, v45
    v_and_b32 v10, 0xffff0000, v45
    v_mul_f32 v7, 0.15915494, v7
    v_mul_f32 v8, 0.15915494, v8
    v_mul_f32 v9, 0.15915494, v9
    v_mul_f32 v10, 0.15915494, v10
    v_mul_hi_u32_u24 v14, 429497, v48
    v_lshrrev_b32 v12, 3, v52
    v_cos_f32 v7, v7
    v_lshlrev_b16 v13, 3, v52
    v_mad_i32_i24 v11, v14, s55, v48
    v_bitop3_b32 v12, v6, v13, v12 bitop3:0xca
    v_add_lshl_u32 v11, v11, s40, 17
    v_lshlrev_b16 v14, 8, v14
    v_lshrrev_b32 v13, 2, v52
    v_or_b32 v48, v12, v11
    v_bitop3_b32 v52, v5, v13, v14 bitop3:0xea
    ds_add_u32 v52, v2
    v_mul_hi_u32_u24 v14, 429497, v49
    v_lshrrev_b32 v12, 3, v53
    v_cos_f32 v8, v8
    v_lshlrev_b16 v13, 3, v53
    v_mad_i32_i24 v11, v14, s55, v49
    v_bitop3_b32 v12, v6, v13, v12 bitop3:0xca
    v_add_lshl_u32 v11, v11, s40, 17
    v_lshlrev_b16 v14, 8, v14
    v_lshrrev_b32 v13, 2, v53
    v_or_b32 v49, v12, v11
    v_bitop3_b32 v53, v5, v13, v14 bitop3:0xea
    ds_add_u32 v53, v2
    v_cvt_pk_bf16_f32 v44, v7, v8
    v_perm_b32 v12, v44, v44, s41
    v_bitop3_b32 v48, v4, v12, v48 bitop3:0xca
    v_perm_b32 v13, v44, v44, s42
    v_bitop3_b32 v49, v4, v13, v49 bitop3:0xca
    v_mul_hi_u32_u24 v14, 429497, v50
    v_lshrrev_b32 v12, 3, v54
    v_cos_f32 v9, v9
    v_lshlrev_b16 v13, 3, v54
    v_mad_i32_i24 v11, v14, s55, v50
    v_bitop3_b32 v12, v6, v13, v12 bitop3:0xca
    v_add_lshl_u32 v11, v11, s40, 17
    v_lshlrev_b16 v14, 8, v14
    v_lshrrev_b32 v13, 2, v54
    v_or_b32 v50, v12, v11
    v_bitop3_b32 v54, v5, v13, v14 bitop3:0xea
    ds_add_u32 v54, v2
    v_mul_hi_u32_u24 v14, 429497, v51
    v_lshrrev_b32 v12, 3, v55
    v_cos_f32 v10, v10
    v_lshlrev_b16 v13, 3, v55
    v_mad_i32_i24 v11, v14, s55, v51
    v_bitop3_b32 v12, v6, v13, v12 bitop3:0xca
    v_add_lshl_u32 v11, v11, s40, 17
    v_lshlrev_b16 v14, 8, v14
    v_lshrrev_b32 v13, 2, v55
    v_or_b32 v51, v12, v11
    v_bitop3_b32 v55, v5, v13, v14 bitop3:0xea
    ds_add_u32 v55, v2
    v_cvt_pk_bf16_f32 v45, v9, v10
    v_perm_b32 v12, v45, v45, s41
    v_bitop3_b32 v50, v4, v12, v50 bitop3:0xca
    v_perm_b32 v13, v45, v45, s42
    v_bitop3_b32 v51, v4, v13, v51 bitop3:0xca
    s_waitcnt vmcnt(4)
    v_lshlrev_b32 v7, 16, v46
    v_and_b32 v8, 0xffff0000, v46
    v_lshlrev_b32 v9, 16, v47
    v_and_b32 v10, 0xffff0000, v47
    v_mul_f32 v7, 0.15915494, v7
    v_mul_f32 v8, 0.15915494, v8
    v_mul_f32 v9, 0.15915494, v9
    v_mul_f32 v10, 0.15915494, v10
    v_mul_hi_u32_u24 v14, 429497, v56
    v_lshrrev_b32 v12, 3, v60
    v_cos_f32 v7, v7
    v_lshlrev_b16 v13, 3, v60
    v_mad_i32_i24 v11, v14, s55, v56
    v_bitop3_b32 v12, v6, v13, v12 bitop3:0xca
    v_add_lshl_u32 v11, v11, s40, 17
    v_lshlrev_b16 v14, 8, v14
    v_lshrrev_b32 v13, 2, v60
    v_or_b32 v56, v12, v11
    v_bitop3_b32 v60, v5, v13, v14 bitop3:0xea
    ds_add_u32 v60, v2
    v_mul_hi_u32_u24 v14, 429497, v57
    v_lshrrev_b32 v12, 3, v61
    v_cos_f32 v8, v8
    v_lshlrev_b16 v13, 3, v61
    v_mad_i32_i24 v11, v14, s55, v57
    v_bitop3_b32 v12, v6, v13, v12 bitop3:0xca
    v_add_lshl_u32 v11, v11, s40, 17
    v_lshlrev_b16 v14, 8, v14
    v_lshrrev_b32 v13, 2, v61
    v_or_b32 v57, v12, v11
    v_bitop3_b32 v61, v5, v13, v14 bitop3:0xea
    ds_add_u32 v61, v2
    v_cvt_pk_bf16_f32 v46, v7, v8
    v_perm_b32 v12, v46, v46, s41
    v_bitop3_b32 v56, v4, v12, v56 bitop3:0xca
    v_perm_b32 v13, v46, v46, s42
    v_bitop3_b32 v57, v4, v13, v57 bitop3:0xca
    v_mul_hi_u32_u24 v14, 429497, v58
    v_lshrrev_b32 v12, 3, v62
    v_cos_f32 v9, v9
    v_lshlrev_b16 v13, 3, v62
    v_mad_i32_i24 v11, v14, s55, v58
    v_bitop3_b32 v12, v6, v13, v12 bitop3:0xca
    v_add_lshl_u32 v11, v11, s40, 17
    v_lshlrev_b16 v14, 8, v14
    v_lshrrev_b32 v13, 2, v62
    v_or_b32 v58, v12, v11
    v_bitop3_b32 v62, v5, v13, v14 bitop3:0xea
    ds_add_u32 v62, v2
    v_mul_hi_u32_u24 v14, 429497, v59
    v_lshrrev_b32 v12, 3, v63
    v_cos_f32 v10, v10
    v_lshlrev_b16 v13, 3, v63
    v_mad_i32_i24 v11, v14, s55, v59
    v_bitop3_b32 v12, v6, v13, v12 bitop3:0xca
    v_add_lshl_u32 v11, v11, s40, 17
    v_lshlrev_b16 v14, 8, v14
    v_lshrrev_b32 v13, 2, v63
    v_or_b32 v59, v12, v11
    v_bitop3_b32 v63, v5, v13, v14 bitop3:0xea
    ds_add_u32 v63, v2
    v_cvt_pk_bf16_f32 v47, v9, v10
    v_perm_b32 v12, v47, v47, s41
    v_bitop3_b32 v58, v4, v12, v58 bitop3:0xca
    v_perm_b32 v13, v47, v47, s42
    v_bitop3_b32 v59, v4, v13, v59 bitop3:0xca
    v_lshrrev_b32 v8, 2, v0
    v_and_b32 v7, 0x3c00, v0
    v_bitop3_b32 v7, v5, v8, v7 bitop3:0xea
    s_waitcnt lgkmcnt(0)
    s_barrier
    ds_read2st64_b32 v[8:9], v7 offset0:0 offset1:1
    ds_read2st64_b32 v[10:11], v7 offset0:2 offset1:3
    s_add_u32 s47, s35, 0x10000
    buffer_store_dwordx4 v[64:67], v0, s[20:23], s47 offen sc1
    s_add_u32 s44, s34, 0x2000000
    s_nop 0
    buffer_load_dwordx2 v[64:65], v1, s[16:19], s44 offen nt
    s_add_u32 s45, s34, 0x2200000
    buffer_load_dwordx2 v[66:67], v1, s[16:19], s45 offen nt
    s_waitcnt lgkmcnt(0)
    v_lshl_or_b32 v12, v9, 16, v8
    v_lshl_or_b32 v13, v11, 16, v10
    v_mov_b32 v14, v12
    v_mov_b32 v15, v13
    s_nop 0
    v_add_u32_dpp v14, v14, v14 row_shr:1 row_mask:0xf bank_mask:0xf bound_ctrl:1
    v_add_u32_dpp v15, v15, v15 row_shr:1 row_mask:0xf bank_mask:0xf bound_ctrl:1
    s_nop 0
    v_add_u32_dpp v14, v14, v14 row_shr:2 row_mask:0xf bank_mask:0xf bound_ctrl:1
    v_add_u32_dpp v15, v15, v15 row_shr:2 row_mask:0xf bank_mask:0xf bound_ctrl:1
    s_nop 0
    v_add_u32_dpp v14, v14, v14 row_shr:4 row_mask:0xf bank_mask:0xf bound_ctrl:1
    v_add_u32_dpp v15, v15, v15 row_shr:4 row_mask:0xf bank_mask:0xf bound_ctrl:1
    s_nop 0
    v_add_u32_dpp v14, v14, v14 row_shr:8 row_mask:0xf bank_mask:0xf bound_ctrl:1
    v_add_u32_dpp v15, v15, v15 row_shr:8 row_mask:0xf bank_mask:0xf bound_ctrl:1
    s_nop 0
    v_add_u32_dpp v14, v14, v14 row_bcast:15 row_mask:0xa bank_mask:0xf
    v_add_u32_dpp v15, v15, v15 row_bcast:15 row_mask:0xa bank_mask:0xf
    s_nop 0
    v_add_u32_dpp v14, v14, v14 row_bcast:31 row_mask:0xc bank_mask:0xf
    v_add_u32_dpp v15, v15, v15 row_bcast:31 row_mask:0xc bank_mask:0xf
    v_readlane_b32 s48, v14, 63
    v_readlane_b32 s49, v15, 63
    s_lshl_b32 s54, s32, 2
    v_mov_b32 v8, s54
    s_and_b32 s50, s48, 0xffff
    s_lshr_b32 s51, s48, 16
    s_and_b32 s52, s49, 0xffff
    s_lshr_b32 s53, s49, 16
    s_add_u32 s51, s51, s50
    s_add_u32 s52, s52, s51
    s_add_u32 s53, s53, s52
    v_mov_b32 v9, s53
    s_mov_b64 exec, 1
    ds_write_b32 v8, v9 offset:16384
    s_mov_b64 exec, -1
    v_and_b32 v8, 60, v7
    s_waitcnt lgkmcnt(0)
    s_barrier
    ds_read_b32 v9, v8 offset:16384
    s_waitcnt lgkmcnt(0)
    v_add_u32_dpp v9, v9, v9 row_shr:1 row_mask:0xf bank_mask:0xf bound_ctrl:1
    s_nop 1
    v_add_u32_dpp v9, v9, v9 row_shr:2 row_mask:0xf bank_mask:0xf bound_ctrl:1
    s_nop 1
    v_add_u32_dpp v9, v9, v9 row_shr:4 row_mask:0xf bank_mask:0xf bound_ctrl:1
    s_nop 1
    v_add_u32_dpp v9, v9, v9 row_shr:8 row_mask:0xf bank_mask:0xf bound_ctrl:1
    s_nop 0
    v_readlane_b32 s54, v9, s32
    s_sub_u32 s54, s54, s53
    s_add_u32 s50, s50, s54
    s_add_u32 s51, s51, s54
    s_add_u32 s52, s52, s54
    s_pack_ll_b32_b16 s48, s54, s50
    s_pack_ll_b32_b16 s49, s51, s52
    v_add_u32 v14, s48, v14
    v_add_u32 v15, s49, v15
    v_sub_u32 v12, v14, v12
    v_sub_u32 v13, v15, v13
    v_and_b32 v8, 0xffff, v12
    v_lshrrev_b32 v9, 16, v12
    v_and_b32 v10, 0xffff, v13
    v_lshrrev_b32 v11, 16, v13
    ds_write2st64_b32 v7, v8, v9 offset0:0 offset1:1
    ds_write2st64_b32 v7, v10, v11 offset0:2 offset1:3
    s_waitcnt lgkmcnt(0)
    s_barrier
    ds_add_rtn_u32 v100, v100, v2
    ds_add_rtn_u32 v101, v101, v2
    ds_add_rtn_u32 v102, v102, v2
    ds_add_rtn_u32 v103, v103, v2
    s_add_u32 s46, s36, 0x2a40000
    v_and_b32 v11, 0x3f0, v0
    v_add_u32 v11, v11, v11
    buffer_store_dwordx2 v[12:13], v11, s[24:27], s46 offen
    s_bitset0_b64 exec, 63
    s_not_b64 exec, exec
    buffer_store_dwordx2 v[14:15], v11, s[24:27], s46 offen offset:32
    s_mov_b64 exec, -1
    ds_add_rtn_u32 v112, v112, v2
    ds_add_rtn_u32 v113, v113, v2
    ds_add_rtn_u32 v114, v114, v2
    ds_add_rtn_u32 v115, v115, v2
    ds_add_rtn_u32 v120, v120, v2
    ds_add_rtn_u32 v121, v121, v2
    ds_add_rtn_u32 v122, v122, v2
    ds_add_rtn_u32 v123, v123, v2
    s_add_u32 s47, s35, 0x14000
    buffer_store_dwordx4 v[76:79], v0, s[20:23], s47 offen sc1
    s_add_u32 s44, s33, 0x4400000
    s_nop 0
    buffer_load_dwordx4 v[76:79], v0, s[8:11], s44 offen nt
    ds_add_rtn_u32 v20, v20, v2
    ds_add_rtn_u32 v21, v21, v2
    ds_add_rtn_u32 v22, v22, v2
    ds_add_rtn_u32 v23, v23, v2
    ds_add_rtn_u32 v32, v32, v2
    ds_add_rtn_u32 v33, v33, v2
    ds_add_rtn_u32 v34, v34, v2
    ds_add_rtn_u32 v35, v35, v2
    ds_add_rtn_u32 v40, v40, v2
    ds_add_rtn_u32 v41, v41, v2
    ds_add_rtn_u32 v42, v42, v2
    ds_add_rtn_u32 v43, v43, v2
    s_add_u32 s45, s35, 0x18000
    buffer_store_dwordx4 v[80:83], v0, s[20:23], s45 offen sc1
    s_add_u32 s46, s33, 0x4400000
    s_nop 0
    buffer_load_dwordx4 v[80:83], v0, s[12:15], s46 offen nt
    ds_add_rtn_u32 v52, v52, v2
    ds_add_rtn_u32 v53, v53, v2
    ds_add_rtn_u32 v54, v54, v2
    ds_add_rtn_u32 v55, v55, v2
    ds_add_rtn_u32 v60, v60, v2
    ds_add_rtn_u32 v61, v61, v2
    ds_add_rtn_u32 v62, v62, v2
    ds_add_rtn_u32 v63, v63, v2
    s_waitcnt lgkmcnt(0)
    s_barrier
    v_and_b32 v7, -4, v100
    v_lshl_add_u32 v8, v100, 2, v7
    ds_write_b32 v8, v96
    v_lshl_add_u32 v7, v7, 2, v100
    ds_write_b8 v7, v104 offset:16
    v_and_b32 v9, -4, v101
    v_lshl_add_u32 v10, v101, 2, v9
    ds_write_b32 v10, v97
    v_lshl_add_u32 v9, v9, 2, v101
    ds_write_b8_d16_hi v9, v104 offset:16
    v_and_b32 v7, -4, v102
    v_lshl_add_u32 v8, v102, 2, v7
    ds_write_b32 v8, v98
    v_lshl_add_u32 v7, v7, 2, v102
    ds_write_b8 v7, v105 offset:16
    v_and_b32 v9, -4, v103
    v_lshl_add_u32 v10, v103, 2, v9
    ds_write_b32 v10, v99
    v_lshl_add_u32 v9, v9, 2, v103
    ds_write_b8_d16_hi v9, v105 offset:16
    s_add_u32 s47, s35, 0x1c000
    buffer_store_dwordx4 v[88:91], v0, s[20:23], s47 offen sc1
    s_add_u32 s44, s33, 0x4800000
    buffer_load_dwordx4 v[96:99], v0, s[8:11], s44 offen nt
    s_add_u32 s45, s33, 0x4800000
    buffer_load_dwordx4 v[100:103], v0, s[12:15], s45 offen nt
    v_and_b32 v7, -4, v112
    v_lshl_add_u32 v8, v112, 2, v7
    ds_write_b32 v8, v108
    v_lshl_add_u32 v7, v7, 2, v112
    ds_write_b8 v7, v106 offset:16
    v_and_b32 v9, -4, v113
    v_lshl_add_u32 v10, v113, 2, v9
    ds_write_b32 v10, v109
    v_lshl_add_u32 v9, v9, 2, v113
    ds_write_b8_d16_hi v9, v106 offset:16
    v_and_b32 v7, -4, v114
    v_lshl_add_u32 v8, v114, 2, v7
    ds_write_b32 v8, v110
    v_lshl_add_u32 v7, v7, 2, v114
    ds_write_b8 v7, v107 offset:16
    v_and_b32 v9, -4, v115
    v_lshl_add_u32 v10, v115, 2, v9
    ds_write_b32 v10, v111
    v_lshl_add_u32 v9, v9, 2, v115
    ds_write_b8_d16_hi v9, v107 offset:16
    s_add_u32 s46, s34, 0x2400000
    buffer_load_dwordx2 v[88:89], v1, s[16:19], s46 offen nt
    s_add_u32 s47, s34, 0x2600000
    buffer_load_dwordx2 v[90:91], v1, s[16:19], s47 offen nt
    s_add_u32 s44, s33, 0x4c00000
    buffer_load_dwordx4 v[108:111], v0, s[8:11], s44 offen nt
    v_and_b32 v7, -4, v120
    v_lshl_add_u32 v8, v120, 2, v7
    ds_write_b32 v8, v116
    v_lshl_add_u32 v7, v7, 2, v120
    ds_write_b8 v7, v124 offset:16
    v_and_b32 v9, -4, v121
    v_lshl_add_u32 v10, v121, 2, v9
    ds_write_b32 v10, v117
    v_lshl_add_u32 v9, v9, 2, v121
    ds_write_b8_d16_hi v9, v124 offset:16
    v_and_b32 v7, -4, v122
    v_lshl_add_u32 v8, v122, 2, v7
    ds_write_b32 v8, v118
    v_lshl_add_u32 v7, v7, 2, v122
    ds_write_b8 v7, v125 offset:16
    v_and_b32 v9, -4, v123
    v_lshl_add_u32 v10, v123, 2, v9
    ds_write_b32 v10, v119
    v_lshl_add_u32 v9, v9, 2, v123
    ds_write_b8_d16_hi v9, v125 offset:16
    s_add_u32 s45, s35, 0x20000
    buffer_store_dwordx4 v[92:95], v0, s[20:23], s45 offen sc1
    s_add_u32 s46, s33, 0x4c00000
    buffer_load_dwordx4 v[112:115], v0, s[12:15], s46 offen nt
    v_and_b32 v7, -4, v20
    v_lshl_add_u32 v8, v20, 2, v7
    ds_write_b32 v8, v16
    v_lshl_add_u32 v7, v7, 2, v20
    ds_write_b8 v7, v126 offset:16
    v_and_b32 v9, -4, v21
    v_lshl_add_u32 v10, v21, 2, v9
    ds_write_b32 v10, v17
    v_lshl_add_u32 v9, v9, 2, v21
    ds_write_b8_d16_hi v9, v126 offset:16
    v_and_b32 v7, -4, v22
    v_lshl_add_u32 v8, v22, 2, v7
    ds_write_b32 v8, v18
    v_lshl_add_u32 v7, v7, 2, v22
    ds_write_b8 v7, v127 offset:16
    v_and_b32 v9, -4, v23
    v_lshl_add_u32 v10, v23, 2, v9
    ds_write_b32 v10, v19
    v_lshl_add_u32 v9, v9, 2, v23
    ds_write_b8_d16_hi v9, v127 offset:16
    s_add_u32 s47, s33, 0x5000000
    buffer_load_dwordx4 v[104:107], v0, s[8:11], s47 offen nt
    s_add_u32 s44, s33, 0x5000000
    buffer_load_dwordx4 v[116:119], v0, s[12:15], s44 offen nt
    v_and_b32 v7, -4, v32
    v_lshl_add_u32 v8, v32, 2, v7
    ds_write_b32 v8, v28
    v_lshl_add_u32 v7, v7, 2, v32
    ds_write_b8 v7, v24 offset:16
    v_and_b32 v9, -4, v33
    v_lshl_add_u32 v10, v33, 2, v9
    ds_write_b32 v10, v29
    v_lshl_add_u32 v9, v9, 2, v33
    ds_write_b8_d16_hi v9, v24 offset:16
    v_and_b32 v7, -4, v34
    v_lshl_add_u32 v8, v34, 2, v7
    ds_write_b32 v8, v30
    v_lshl_add_u32 v7, v7, 2, v34
    ds_write_b8 v7, v25 offset:16
    v_and_b32 v9, -4, v35
    v_lshl_add_u32 v10, v35, 2, v9
    ds_write_b32 v10, v31
    v_lshl_add_u32 v9, v9, 2, v35
    ds_write_b8_d16_hi v9, v25 offset:16
    s_add_u32 s45, s34, 0x2800000
    buffer_load_dwordx2 v[120:121], v1, s[16:19], s45 offen nt
    s_add_u32 s46, s34, 0x2a00000
    buffer_load_dwordx2 v[122:123], v1, s[16:19], s46 offen nt
    s_add_u32 s47, s33, 0x5400000
    buffer_load_dwordx4 v[92:95], v0, s[8:11], s47 offen nt
    v_and_b32 v7, -4, v40
    v_lshl_add_u32 v8, v40, 2, v7
    ds_write_b32 v8, v36
    v_lshl_add_u32 v7, v7, 2, v40
    ds_write_b8 v7, v26 offset:16
    v_and_b32 v9, -4, v41
    v_lshl_add_u32 v10, v41, 2, v9
    ds_write_b32 v10, v37
    v_lshl_add_u32 v9, v9, 2, v41
    ds_write_b8_d16_hi v9, v26 offset:16
    v_and_b32 v7, -4, v42
    v_lshl_add_u32 v8, v42, 2, v7
    ds_write_b32 v8, v38
    v_lshl_add_u32 v7, v7, 2, v42
    ds_write_b8 v7, v27 offset:16
    v_and_b32 v9, -4, v43
    v_lshl_add_u32 v10, v43, 2, v9
    ds_write_b32 v10, v39
    v_lshl_add_u32 v9, v9, 2, v43
    ds_write_b8_d16_hi v9, v27 offset:16
    s_add_u32 s44, s35, 0x24000
    buffer_store_dwordx4 v[84:87], v0, s[20:23], s44 offen sc1
    s_add_u32 s45, s33, 0x5400000
    buffer_load_dwordx4 v[16:19], v0, s[12:15], s45 offen nt
    v_and_b32 v7, -4, v52
    v_lshl_add_u32 v8, v52, 2, v7
    ds_write_b32 v8, v48
    v_lshl_add_u32 v7, v7, 2, v52
    ds_write_b8 v7, v44 offset:16
    v_and_b32 v9, -4, v53
    v_lshl_add_u32 v10, v53, 2, v9
    ds_write_b32 v10, v49
    v_lshl_add_u32 v9, v9, 2, v53
    ds_write_b8_d16_hi v9, v44 offset:16
    v_and_b32 v7, -4, v54
    v_lshl_add_u32 v8, v54, 2, v7
    ds_write_b32 v8, v50
    v_lshl_add_u32 v7, v7, 2, v54
    ds_write_b8 v7, v45 offset:16
    v_and_b32 v9, -4, v55
    v_lshl_add_u32 v10, v55, 2, v9
    ds_write_b32 v10, v51
    v_lshl_add_u32 v9, v9, 2, v55
    ds_write_b8_d16_hi v9, v45 offset:16
    s_add_u32 s46, s33, 0x5800000
    buffer_load_dwordx4 v[20:23], v0, s[8:11], s46 offen nt
    s_add_u32 s47, s33, 0x5800000
    buffer_load_dwordx4 v[124:127], v0, s[12:15], s47 offen nt
    v_and_b32 v7, -4, v60
    v_lshl_add_u32 v8, v60, 2, v7
    ds_write_b32 v8, v56
    v_lshl_add_u32 v7, v7, 2, v60
    ds_write_b8 v7, v46 offset:16
    v_and_b32 v9, -4, v61
    v_lshl_add_u32 v10, v61, 2, v9
    ds_write_b32 v10, v57
    v_lshl_add_u32 v9, v9, 2, v61
    ds_write_b8_d16_hi v9, v46 offset:16
    v_and_b32 v7, -4, v62
    v_lshl_add_u32 v8, v62, 2, v7
    ds_write_b32 v8, v58
    v_lshl_add_u32 v7, v7, 2, v62
    ds_write_b8 v7, v47 offset:16
    v_and_b32 v9, -4, v63
    v_lshl_add_u32 v10, v63, 2, v9
    ds_write_b32 v10, v59
    v_lshl_add_u32 v9, v9, 2, v63
    ds_write_b8_d16_hi v9, v47 offset:16
    s_add_u32 s44, s34, 0x2c00000
    buffer_load_dwordx2 v[28:29], v1, s[16:19], s44 offen nt
    s_add_u32 s45, s34, 0x2e00000
    buffer_load_dwordx2 v[30:31], v1, s[16:19], s45 offen nt
    v_add_u32 v7, 0x10000, v0
    v_add_u32 v12, 0x20000, v0
    v_mov_b32 v8, 0
    v_mov_b32 v9, 0
    v_mov_b32 v10, 0
    v_mov_b32 v11, 0
    s_waitcnt lgkmcnt(0)
    s_barrier
    ds_read_b128 v[32:35], v0 offset:0
    ds_write_b128 v0, v[8:11]
    ds_read_b128 v[36:39], v0 offset:16384
    ds_read_b128 v[40:43], v0 offset:32768
    ds_read_b128 v[24:27], v0 offset:49152
    ds_read_b128 v[84:87], v7 offset:0
    ds_read_b128 v[48:51], v7 offset:16384
    ds_read_b128 v[52:55], v7 offset:32768
    ds_read_b128 v[56:59], v7 offset:49152
    ds_read_b128 v[60:63], v12 offset:0
    ds_read_b128 v[44:47], v12 offset:16384
    s_waitcnt lgkmcnt(0)
    s_barrier
    s_add_u32 s46, s35, 0x2a40000
    buffer_store_dwordx4 v[32:35], v0, s[20:23], s46 offen sc1
    s_add_u32 s47, s33, 0x5c00000
    s_nop 0
    buffer_load_dwordx4 v[32:35], v0, s[8:11], s47 offen nt
    s_add_u32 s44, s35, 0x2a44000
    buffer_store_dwordx4 v[36:39], v0, s[20:23], s44 offen sc1
    s_add_u32 s45, s33, 0x5c00000
    s_nop 0
    buffer_load_dwordx4 v[36:39], v0, s[12:15], s45 offen nt
    s_waitcnt vmcnt(29)
    v_lshlrev_b32 v7, 16, v64
    v_and_b32 v8, 0xffff0000, v64
    v_lshlrev_b32 v9, 16, v65
    v_and_b32 v10, 0xffff0000, v65
    v_mul_f32 v7, 0.15915494, v7
    v_mul_f32 v8, 0.15915494, v8
    v_mul_f32 v9, 0.15915494, v9
    v_mul_f32 v10, 0.15915494, v10
    v_mul_hi_u32_u24 v14, 429497, v68
    v_lshrrev_b32 v12, 3, v72
    v_cos_f32 v7, v7
    v_lshlrev_b16 v13, 3, v72
    v_mad_i32_i24 v11, v14, s55, v68
    v_bitop3_b32 v12, v6, v13, v12 bitop3:0xca
    v_add_lshl_u32 v11, v11, s40, 17
    v_lshlrev_b16 v14, 8, v14
    v_lshrrev_b32 v13, 2, v72
    v_or_b32 v68, v12, v11
    v_bitop3_b32 v72, v5, v13, v14 bitop3:0xea
    ds_add_u32 v72, v2
    v_mul_hi_u32_u24 v14, 429497, v69
    v_lshrrev_b32 v12, 3, v73
    v_cos_f32 v8, v8
    v_lshlrev_b16 v13, 3, v73
    v_mad_i32_i24 v11, v14, s55, v69
    v_bitop3_b32 v12, v6, v13, v12 bitop3:0xca
    v_add_lshl_u32 v11, v11, s40, 17
    v_lshlrev_b16 v14, 8, v14
    v_lshrrev_b32 v13, 2, v73
    v_or_b32 v69, v12, v11
    v_bitop3_b32 v73, v5, v13, v14 bitop3:0xea
    ds_add_u32 v73, v2
    v_cvt_pk_bf16_f32 v64, v7, v8
    v_perm_b32 v12, v64, v64, s41
    v_bitop3_b32 v68, v4, v12, v68 bitop3:0xca
    v_perm_b32 v13, v64, v64, s42
    v_bitop3_b32 v69, v4, v13, v69 bitop3:0xca
    v_mul_hi_u32_u24 v14, 429497, v70
    v_lshrrev_b32 v12, 3, v74
    v_cos_f32 v9, v9
    v_lshlrev_b16 v13, 3, v74
    v_mad_i32_i24 v11, v14, s55, v70
    v_bitop3_b32 v12, v6, v13, v12 bitop3:0xca
    v_add_lshl_u32 v11, v11, s40, 17
    v_lshlrev_b16 v14, 8, v14
    v_lshrrev_b32 v13, 2, v74
    v_or_b32 v70, v12, v11
    v_bitop3_b32 v74, v5, v13, v14 bitop3:0xea
    ds_add_u32 v74, v2
    v_mul_hi_u32_u24 v14, 429497, v71
    v_lshrrev_b32 v12, 3, v75
    v_cos_f32 v10, v10
    v_lshlrev_b16 v13, 3, v75
    v_mad_i32_i24 v11, v14, s55, v71
    v_bitop3_b32 v12, v6, v13, v12 bitop3:0xca
    v_add_lshl_u32 v11, v11, s40, 17
    v_lshlrev_b16 v14, 8, v14
    v_lshrrev_b32 v13, 2, v75
    v_or_b32 v71, v12, v11
    v_bitop3_b32 v75, v5, v13, v14 bitop3:0xea
    ds_add_u32 v75, v2
    v_cvt_pk_bf16_f32 v65, v9, v10
    v_perm_b32 v12, v65, v65, s41
    v_bitop3_b32 v70, v4, v12, v70 bitop3:0xca
    v_perm_b32 v13, v65, v65, s42
    v_bitop3_b32 v71, v4, v13, v71 bitop3:0xca
    s_waitcnt vmcnt(23)
    v_lshlrev_b32 v7, 16, v66
    v_and_b32 v8, 0xffff0000, v66
    v_lshlrev_b32 v9, 16, v67
    v_and_b32 v10, 0xffff0000, v67
    v_mul_f32 v7, 0.15915494, v7
    v_mul_f32 v8, 0.15915494, v8
    v_mul_f32 v9, 0.15915494, v9
    v_mul_f32 v10, 0.15915494, v10
    v_mul_hi_u32_u24 v14, 429497, v76
    v_lshrrev_b32 v12, 3, v80
    v_cos_f32 v7, v7
    v_lshlrev_b16 v13, 3, v80
    v_mad_i32_i24 v11, v14, s55, v76
    v_bitop3_b32 v12, v6, v13, v12 bitop3:0xca
    v_add_lshl_u32 v11, v11, s40, 17
    v_lshlrev_b16 v14, 8, v14
    v_lshrrev_b32 v13, 2, v80
    v_or_b32 v76, v12, v11
    v_bitop3_b32 v80, v5, v13, v14 bitop3:0xea
    ds_add_u32 v80, v2
    v_mul_hi_u32_u24 v14, 429497, v77
    v_lshrrev_b32 v12, 3, v81
    v_cos_f32 v8, v8
    v_lshlrev_b16 v13, 3, v81
    v_mad_i32_i24 v11, v14, s55, v77
    v_bitop3_b32 v12, v6, v13, v12 bitop3:0xca
    v_add_lshl_u32 v11, v11, s40, 17
    v_lshlrev_b16 v14, 8, v14
    v_lshrrev_b32 v13, 2, v81
    v_or_b32 v77, v12, v11
    v_bitop3_b32 v81, v5, v13, v14 bitop3:0xea
    ds_add_u32 v81, v2
    v_cvt_pk_bf16_f32 v66, v7, v8
    v_perm_b32 v12, v66, v66, s41
    v_bitop3_b32 v76, v4, v12, v76 bitop3:0xca
    v_perm_b32 v13, v66, v66, s42
    v_bitop3_b32 v77, v4, v13, v77 bitop3:0xca
    v_mul_hi_u32_u24 v14, 429497, v78
    v_lshrrev_b32 v12, 3, v82
    v_cos_f32 v9, v9
    v_lshlrev_b16 v13, 3, v82
    v_mad_i32_i24 v11, v14, s55, v78
    v_bitop3_b32 v12, v6, v13, v12 bitop3:0xca
    v_add_lshl_u32 v11, v11, s40, 17
    v_lshlrev_b16 v14, 8, v14
    v_lshrrev_b32 v13, 2, v82
    v_or_b32 v78, v12, v11
    v_bitop3_b32 v82, v5, v13, v14 bitop3:0xea
    ds_add_u32 v82, v2
    v_mul_hi_u32_u24 v14, 429497, v79
    v_lshrrev_b32 v12, 3, v83
    v_cos_f32 v10, v10
    v_lshlrev_b16 v13, 3, v83
    v_mad_i32_i24 v11, v14, s55, v79
    v_bitop3_b32 v12, v6, v13, v12 bitop3:0xca
    v_add_lshl_u32 v11, v11, s40, 17
    v_lshlrev_b16 v14, 8, v14
    v_lshrrev_b32 v13, 2, v83
    v_or_b32 v79, v12, v11
    v_bitop3_b32 v83, v5, v13, v14 bitop3:0xea
    ds_add_u32 v83, v2
    v_cvt_pk_bf16_f32 v67, v9, v10
    v_perm_b32 v12, v67, v67, s41
    v_bitop3_b32 v78, v4, v12, v78 bitop3:0xca
    v_perm_b32 v13, v67, v67, s42
    v_bitop3_b32 v79, v4, v13, v79 bitop3:0xca
    s_waitcnt vmcnt(18)
    v_lshlrev_b32 v7, 16, v88
    v_and_b32 v8, 0xffff0000, v88
    v_lshlrev_b32 v9, 16, v89
    v_and_b32 v10, 0xffff0000, v89
    v_mul_f32 v7, 0.15915494, v7
    v_mul_f32 v8, 0.15915494, v8
    v_mul_f32 v9, 0.15915494, v9
    v_mul_f32 v10, 0.15915494, v10
    v_mul_hi_u32_u24 v14, 429497, v96
    v_lshrrev_b32 v12, 3, v100
    v_cos_f32 v7, v7
    v_lshlrev_b16 v13, 3, v100
    v_mad_i32_i24 v11, v14, s55, v96
    v_bitop3_b32 v12, v6, v13, v12 bitop3:0xca
    v_add_lshl_u32 v11, v11, s40, 17
    v_lshlrev_b16 v14, 8, v14
    v_lshrrev_b32 v13, 2, v100
    v_or_b32 v96, v12, v11
    v_bitop3_b32 v100, v5, v13, v14 bitop3:0xea
    ds_add_u32 v100, v2
    v_mul_hi_u32_u24 v14, 429497, v97
    v_lshrrev_b32 v12, 3, v101
    v_cos_f32 v8, v8
    v_lshlrev_b16 v13, 3, v101
    v_mad_i32_i24 v11, v14, s55, v97
    v_bitop3_b32 v12, v6, v13, v12 bitop3:0xca
    v_add_lshl_u32 v11, v11, s40, 17
    v_lshlrev_b16 v14, 8, v14
    v_lshrrev_b32 v13, 2, v101
    v_or_b32 v97, v12, v11
    v_bitop3_b32 v101, v5, v13, v14 bitop3:0xea
    ds_add_u32 v101, v2
    v_cvt_pk_bf16_f32 v88, v7, v8
    v_perm_b32 v12, v88, v88, s41
    v_bitop3_b32 v96, v4, v12, v96 bitop3:0xca
    v_perm_b32 v13, v88, v88, s42
    v_bitop3_b32 v97, v4, v13, v97 bitop3:0xca
    v_mul_hi_u32_u24 v14, 429497, v98
    v_lshrrev_b32 v12, 3, v102
    v_cos_f32 v9, v9
    v_lshlrev_b16 v13, 3, v102
    v_mad_i32_i24 v11, v14, s55, v98
    v_bitop3_b32 v12, v6, v13, v12 bitop3:0xca
    v_add_lshl_u32 v11, v11, s40, 17
    v_lshlrev_b16 v14, 8, v14
    v_lshrrev_b32 v13, 2, v102
    v_or_b32 v98, v12, v11
    v_bitop3_b32 v102, v5, v13, v14 bitop3:0xea
    ds_add_u32 v102, v2
    v_mul_hi_u32_u24 v14, 429497, v99
    v_lshrrev_b32 v12, 3, v103
    v_cos_f32 v10, v10
    v_lshlrev_b16 v13, 3, v103
    v_mad_i32_i24 v11, v14, s55, v99
    v_bitop3_b32 v12, v6, v13, v12 bitop3:0xca
    v_add_lshl_u32 v11, v11, s40, 17
    v_lshlrev_b16 v14, 8, v14
    v_lshrrev_b32 v13, 2, v103
    v_or_b32 v99, v12, v11
    v_bitop3_b32 v103, v5, v13, v14 bitop3:0xea
    ds_add_u32 v103, v2
    v_cvt_pk_bf16_f32 v89, v9, v10
    v_perm_b32 v12, v89, v89, s41
    v_bitop3_b32 v98, v4, v12, v98 bitop3:0xca
    v_perm_b32 v13, v89, v89, s42
    v_bitop3_b32 v99, v4, v13, v99 bitop3:0xca
    s_add_u32 s46, s35, 0x2a48000
    buffer_store_dwordx4 v[40:43], v0, s[20:23], s46 offen sc1
    s_add_u32 s47, s33, 0x6000000
    s_nop 0
    buffer_load_dwordx4 v[40:43], v0, s[8:11], s47 offen nt
    s_waitcnt vmcnt(17)
    v_lshlrev_b32 v7, 16, v90
    v_and_b32 v8, 0xffff0000, v90
    v_lshlrev_b32 v9, 16, v91
    v_and_b32 v10, 0xffff0000, v91
    v_mul_f32 v7, 0.15915494, v7
    v_mul_f32 v8, 0.15915494, v8
    v_mul_f32 v9, 0.15915494, v9
    v_mul_f32 v10, 0.15915494, v10
    v_mul_hi_u32_u24 v14, 429497, v108
    v_lshrrev_b32 v12, 3, v112
    v_cos_f32 v7, v7
    v_lshlrev_b16 v13, 3, v112
    v_mad_i32_i24 v11, v14, s55, v108
    v_bitop3_b32 v12, v6, v13, v12 bitop3:0xca
    v_add_lshl_u32 v11, v11, s40, 17
    v_lshlrev_b16 v14, 8, v14
    v_lshrrev_b32 v13, 2, v112
    v_or_b32 v108, v12, v11
    v_bitop3_b32 v112, v5, v13, v14 bitop3:0xea
    ds_add_u32 v112, v2
    v_mul_hi_u32_u24 v14, 429497, v109
    v_lshrrev_b32 v12, 3, v113
    v_cos_f32 v8, v8
    v_lshlrev_b16 v13, 3, v113
    v_mad_i32_i24 v11, v14, s55, v109
    v_bitop3_b32 v12, v6, v13, v12 bitop3:0xca
    v_add_lshl_u32 v11, v11, s40, 17
    v_lshlrev_b16 v14, 8, v14
    v_lshrrev_b32 v13, 2, v113
    v_or_b32 v109, v12, v11
    v_bitop3_b32 v113, v5, v13, v14 bitop3:0xea
    ds_add_u32 v113, v2
    v_cvt_pk_bf16_f32 v90, v7, v8
    v_perm_b32 v12, v90, v90, s41
    v_bitop3_b32 v108, v4, v12, v108 bitop3:0xca
    v_perm_b32 v13, v90, v90, s42
    v_bitop3_b32 v109, v4, v13, v109 bitop3:0xca
    v_mul_hi_u32_u24 v14, 429497, v110
    v_lshrrev_b32 v12, 3, v114
    v_cos_f32 v9, v9
    v_lshlrev_b16 v13, 3, v114
    v_mad_i32_i24 v11, v14, s55, v110
    v_bitop3_b32 v12, v6, v13, v12 bitop3:0xca
    v_add_lshl_u32 v11, v11, s40, 17
    v_lshlrev_b16 v14, 8, v14
    v_lshrrev_b32 v13, 2, v114
    v_or_b32 v110, v12, v11
    v_bitop3_b32 v114, v5, v13, v14 bitop3:0xea
    ds_add_u32 v114, v2
    v_mul_hi_u32_u24 v14, 429497, v111
    v_lshrrev_b32 v12, 3, v115
    v_cos_f32 v10, v10
    v_lshlrev_b16 v13, 3, v115
    v_mad_i32_i24 v11, v14, s55, v111
    v_bitop3_b32 v12, v6, v13, v12 bitop3:0xca
    v_add_lshl_u32 v11, v11, s40, 17
    v_lshlrev_b16 v14, 8, v14
    v_lshrrev_b32 v13, 2, v115
    v_or_b32 v111, v12, v11
    v_bitop3_b32 v115, v5, v13, v14 bitop3:0xea
    ds_add_u32 v115, v2
    v_cvt_pk_bf16_f32 v91, v9, v10
    v_perm_b32 v12, v91, v91, s41
    v_bitop3_b32 v110, v4, v12, v110 bitop3:0xca
    v_perm_b32 v13, v91, v91, s42
    v_bitop3_b32 v111, v4, v13, v111 bitop3:0xca
    s_waitcnt vmcnt(13)
    v_lshlrev_b32 v7, 16, v120
    v_and_b32 v8, 0xffff0000, v120
    v_lshlrev_b32 v9, 16, v121
    v_and_b32 v10, 0xffff0000, v121
    v_mul_f32 v7, 0.15915494, v7
    v_mul_f32 v8, 0.15915494, v8
    v_mul_f32 v9, 0.15915494, v9
    v_mul_f32 v10, 0.15915494, v10
    v_mul_hi_u32_u24 v14, 429497, v104
    v_lshrrev_b32 v12, 3, v116
    v_cos_f32 v7, v7
    v_lshlrev_b16 v13, 3, v116
    v_mad_i32_i24 v11, v14, s55, v104
    v_bitop3_b32 v12, v6, v13, v12 bitop3:0xca
    v_add_lshl_u32 v11, v11, s40, 17
    v_lshlrev_b16 v14, 8, v14
    v_lshrrev_b32 v13, 2, v116
    v_or_b32 v104, v12, v11
    v_bitop3_b32 v116, v5, v13, v14 bitop3:0xea
    ds_add_u32 v116, v2
    v_mul_hi_u32_u24 v14, 429497, v105
    v_lshrrev_b32 v12, 3, v117
    v_cos_f32 v8, v8
    v_lshlrev_b16 v13, 3, v117
    v_mad_i32_i24 v11, v14, s55, v105
    v_bitop3_b32 v12, v6, v13, v12 bitop3:0xca
    v_add_lshl_u32 v11, v11, s40, 17
    v_lshlrev_b16 v14, 8, v14
    v_lshrrev_b32 v13, 2, v117
    v_or_b32 v105, v12, v11
    v_bitop3_b32 v117, v5, v13, v14 bitop3:0xea
    ds_add_u32 v117, v2
    v_cvt_pk_bf16_f32 v120, v7, v8
    v_perm_b32 v12, v120, v120, s41
    v_bitop3_b32 v104, v4, v12, v104 bitop3:0xca
    v_perm_b32 v13, v120, v120, s42
    v_bitop3_b32 v105, v4, v13, v105 bitop3:0xca
    v_mul_hi_u32_u24 v14, 429497, v106
    v_lshrrev_b32 v12, 3, v118
    v_cos_f32 v9, v9
    v_lshlrev_b16 v13, 3, v118
    v_mad_i32_i24 v11, v14, s55, v106
    v_bitop3_b32 v12, v6, v13, v12 bitop3:0xca
    v_add_lshl_u32 v11, v11, s40, 17
    v_lshlrev_b16 v14, 8, v14
    v_lshrrev_b32 v13, 2, v118
    v_or_b32 v106, v12, v11
    v_bitop3_b32 v118, v5, v13, v14 bitop3:0xea
    ds_add_u32 v118, v2
    v_mul_hi_u32_u24 v14, 429497, v107
    v_lshrrev_b32 v12, 3, v119
    v_cos_f32 v10, v10
    v_lshlrev_b16 v13, 3, v119
    v_mad_i32_i24 v11, v14, s55, v107
    v_bitop3_b32 v12, v6, v13, v12 bitop3:0xca
    v_add_lshl_u32 v11, v11, s40, 17
    v_lshlrev_b16 v14, 8, v14
    v_lshrrev_b32 v13, 2, v119
    v_or_b32 v107, v12, v11
    v_bitop3_b32 v119, v5, v13, v14 bitop3:0xea
    ds_add_u32 v119, v2
    v_cvt_pk_bf16_f32 v121, v9, v10
    v_perm_b32 v12, v121, v121, s41
    v_bitop3_b32 v106, v4, v12, v106 bitop3:0xca
    v_perm_b32 v13, v121, v121, s42
    v_bitop3_b32 v107, v4, v13, v107 bitop3:0xca
    s_waitcnt vmcnt(10)
    v_lshlrev_b32 v7, 16, v122
    v_and_b32 v8, 0xffff0000, v122
    v_lshlrev_b32 v9, 16, v123
    v_and_b32 v10, 0xffff0000, v123
    v_mul_f32 v7, 0.15915494, v7
    v_mul_f32 v8, 0.15915494, v8
    v_mul_f32 v9, 0.15915494, v9
    v_mul_f32 v10, 0.15915494, v10
    v_mul_hi_u32_u24 v14, 429497, v92
    v_lshrrev_b32 v12, 3, v16
    v_cos_f32 v7, v7
    v_lshlrev_b16 v13, 3, v16
    v_mad_i32_i24 v11, v14, s55, v92
    v_bitop3_b32 v12, v6, v13, v12 bitop3:0xca
    v_add_lshl_u32 v11, v11, s40, 17
    v_lshlrev_b16 v14, 8, v14
    v_lshrrev_b32 v13, 2, v16
    v_or_b32 v92, v12, v11
    v_bitop3_b32 v16, v5, v13, v14 bitop3:0xea
    ds_add_u32 v16, v2
    v_mul_hi_u32_u24 v14, 429497, v93
    v_lshrrev_b32 v12, 3, v17
    v_cos_f32 v8, v8
    v_lshlrev_b16 v13, 3, v17
    v_mad_i32_i24 v11, v14, s55, v93
    v_bitop3_b32 v12, v6, v13, v12 bitop3:0xca
    v_add_lshl_u32 v11, v11, s40, 17
    v_lshlrev_b16 v14, 8, v14
    v_lshrrev_b32 v13, 2, v17
    v_or_b32 v93, v12, v11
    v_bitop3_b32 v17, v5, v13, v14 bitop3:0xea
    ds_add_u32 v17, v2
    v_cvt_pk_bf16_f32 v122, v7, v8
    v_perm_b32 v12, v122, v122, s41
    v_bitop3_b32 v92, v4, v12, v92 bitop3:0xca
    v_perm_b32 v13, v122, v122, s42
    v_bitop3_b32 v93, v4, v13, v93 bitop3:0xca
    v_mul_hi_u32_u24 v14, 429497, v94
    v_lshrrev_b32 v12, 3, v18
    v_cos_f32 v9, v9
    v_lshlrev_b16 v13, 3, v18
    v_mad_i32_i24 v11, v14, s55, v94
    v_bitop3_b32 v12, v6, v13, v12 bitop3:0xca
    v_add_lshl_u32 v11, v11, s40, 17
    v_lshlrev_b16 v14, 8, v14
    v_lshrrev_b32 v13, 2, v18
    v_or_b32 v94, v12, v11
    v_bitop3_b32 v18, v5, v13, v14 bitop3:0xea
    ds_add_u32 v18, v2
    v_mul_hi_u32_u24 v14, 429497, v95
    v_lshrrev_b32 v12, 3, v19
    v_cos_f32 v10, v10
    v_lshlrev_b16 v13, 3, v19
    v_mad_i32_i24 v11, v14, s55, v95
    v_bitop3_b32 v12, v6, v13, v12 bitop3:0xca
    v_add_lshl_u32 v11, v11, s40, 17
    v_lshlrev_b16 v14, 8, v14
    v_lshrrev_b32 v13, 2, v19
    v_or_b32 v95, v12, v11
    v_bitop3_b32 v19, v5, v13, v14 bitop3:0xea
    ds_add_u32 v19, v2
    v_cvt_pk_bf16_f32 v123, v9, v10
    v_perm_b32 v12, v123, v123, s41
    v_bitop3_b32 v94, v4, v12, v94 bitop3:0xca
    v_perm_b32 v13, v123, v123, s42
    v_bitop3_b32 v95, v4, v13, v95 bitop3:0xca
    s_add_u32 s44, s35, 0x2a4c000
    buffer_store_dwordx4 v[24:27], v0, s[20:23], s44 offen sc1
    s_add_u32 s45, s33, 0x6000000
    s_nop 0
    buffer_load_dwordx4 v[24:27], v0, s[12:15], s45 offen nt
    s_waitcnt vmcnt(8)
    v_lshlrev_b32 v7, 16, v28
    v_and_b32 v8, 0xffff0000, v28
    v_lshlrev_b32 v9, 16, v29
    v_and_b32 v10, 0xffff0000, v29
    v_mul_f32 v7, 0.15915494, v7
    v_mul_f32 v8, 0.15915494, v8
    v_mul_f32 v9, 0.15915494, v9
    v_mul_f32 v10, 0.15915494, v10
    v_mul_hi_u32_u24 v14, 429497, v20
    v_lshrrev_b32 v12, 3, v124
    v_cos_f32 v7, v7
    v_lshlrev_b16 v13, 3, v124
    v_mad_i32_i24 v11, v14, s55, v20
    v_bitop3_b32 v12, v6, v13, v12 bitop3:0xca
    v_add_lshl_u32 v11, v11, s40, 17
    v_lshlrev_b16 v14, 8, v14
    v_lshrrev_b32 v13, 2, v124
    v_or_b32 v20, v12, v11
    v_bitop3_b32 v124, v5, v13, v14 bitop3:0xea
    ds_add_u32 v124, v2
    v_mul_hi_u32_u24 v14, 429497, v21
    v_lshrrev_b32 v12, 3, v125
    v_cos_f32 v8, v8
    v_lshlrev_b16 v13, 3, v125
    v_mad_i32_i24 v11, v14, s55, v21
    v_bitop3_b32 v12, v6, v13, v12 bitop3:0xca
    v_add_lshl_u32 v11, v11, s40, 17
    v_lshlrev_b16 v14, 8, v14
    v_lshrrev_b32 v13, 2, v125
    v_or_b32 v21, v12, v11
    v_bitop3_b32 v125, v5, v13, v14 bitop3:0xea
    ds_add_u32 v125, v2
    v_cvt_pk_bf16_f32 v28, v7, v8
    v_perm_b32 v12, v28, v28, s41
    v_bitop3_b32 v20, v4, v12, v20 bitop3:0xca
    v_perm_b32 v13, v28, v28, s42
    v_bitop3_b32 v21, v4, v13, v21 bitop3:0xca
    v_mul_hi_u32_u24 v14, 429497, v22
    v_lshrrev_b32 v12, 3, v126
    v_cos_f32 v9, v9
    v_lshlrev_b16 v13, 3, v126
    v_mad_i32_i24 v11, v14, s55, v22
    v_bitop3_b32 v12, v6, v13, v12 bitop3:0xca
    v_add_lshl_u32 v11, v11, s40, 17
    v_lshlrev_b16 v14, 8, v14
    v_lshrrev_b32 v13, 2, v126
    v_or_b32 v22, v12, v11
    v_bitop3_b32 v126, v5, v13, v14 bitop3:0xea
    ds_add_u32 v126, v2
    v_mul_hi_u32_u24 v14, 429497, v23
    v_lshrrev_b32 v12, 3, v127
    v_cos_f32 v10, v10
    v_lshlrev_b16 v13, 3, v127
    v_mad_i32_i24 v11, v14, s55, v23
    v_bitop3_b32 v12, v6, v13, v12 bitop3:0xca
    v_add_lshl_u32 v11, v11, s40, 17
    v_lshlrev_b16 v14, 8, v14
    v_lshrrev_b32 v13, 2, v127
    v_or_b32 v23, v12, v11
    v_bitop3_b32 v127, v5, v13, v14 bitop3:0xea
    ds_add_u32 v127, v2
    v_cvt_pk_bf16_f32 v29, v9, v10
    v_perm_b32 v12, v29, v29, s41
    v_bitop3_b32 v22, v4, v12, v22 bitop3:0xca
    v_perm_b32 v13, v29, v29, s42
    v_bitop3_b32 v23, v4, v13, v23 bitop3:0xca
    s_waitcnt vmcnt(4)
    v_lshlrev_b32 v7, 16, v30
    v_and_b32 v8, 0xffff0000, v30
    v_lshlrev_b32 v9, 16, v31
    v_and_b32 v10, 0xffff0000, v31
    v_mul_f32 v7, 0.15915494, v7
    v_mul_f32 v8, 0.15915494, v8
    v_mul_f32 v9, 0.15915494, v9
    v_mul_f32 v10, 0.15915494, v10
    v_mul_hi_u32_u24 v14, 429497, v32
    v_lshrrev_b32 v12, 3, v36
    v_cos_f32 v7, v7
    v_lshlrev_b16 v13, 3, v36
    v_mad_i32_i24 v11, v14, s55, v32
    v_bitop3_b32 v12, v6, v13, v12 bitop3:0xca
    v_add_lshl_u32 v11, v11, s40, 17
    v_lshlrev_b16 v14, 8, v14
    v_lshrrev_b32 v13, 2, v36
    v_or_b32 v32, v12, v11
    v_bitop3_b32 v36, v5, v13, v14 bitop3:0xea
    ds_add_u32 v36, v2
    v_mul_hi_u32_u24 v14, 429497, v33
    v_lshrrev_b32 v12, 3, v37
    v_cos_f32 v8, v8
    v_lshlrev_b16 v13, 3, v37
    v_mad_i32_i24 v11, v14, s55, v33
    v_bitop3_b32 v12, v6, v13, v12 bitop3:0xca
    v_add_lshl_u32 v11, v11, s40, 17
    v_lshlrev_b16 v14, 8, v14
    v_lshrrev_b32 v13, 2, v37
    v_or_b32 v33, v12, v11
    v_bitop3_b32 v37, v5, v13, v14 bitop3:0xea
    ds_add_u32 v37, v2
    v_cvt_pk_bf16_f32 v30, v7, v8
    v_perm_b32 v12, v30, v30, s41
    v_bitop3_b32 v32, v4, v12, v32 bitop3:0xca
    v_perm_b32 v13, v30, v30, s42
    v_bitop3_b32 v33, v4, v13, v33 bitop3:0xca
    v_mul_hi_u32_u24 v14, 429497, v34
    v_lshrrev_b32 v12, 3, v38
    v_cos_f32 v9, v9
    v_lshlrev_b16 v13, 3, v38
    v_mad_i32_i24 v11, v14, s55, v34
    v_bitop3_b32 v12, v6, v13, v12 bitop3:0xca
    v_add_lshl_u32 v11, v11, s40, 17
    v_lshlrev_b16 v14, 8, v14
    v_lshrrev_b32 v13, 2, v38
    v_or_b32 v34, v12, v11
    v_bitop3_b32 v38, v5, v13, v14 bitop3:0xea
    ds_add_u32 v38, v2
    v_mul_hi_u32_u24 v14, 429497, v35
    v_lshrrev_b32 v12, 3, v39
    v_cos_f32 v10, v10
    v_lshlrev_b16 v13, 3, v39
    v_mad_i32_i24 v11, v14, s55, v35
    v_bitop3_b32 v12, v6, v13, v12 bitop3:0xca
    v_add_lshl_u32 v11, v11, s40, 17
    v_lshlrev_b16 v14, 8, v14
    v_lshrrev_b32 v13, 2, v39
    v_or_b32 v35, v12, v11
    v_bitop3_b32 v39, v5, v13, v14 bitop3:0xea
    ds_add_u32 v39, v2
    v_cvt_pk_bf16_f32 v31, v9, v10
    v_perm_b32 v12, v31, v31, s41
    v_bitop3_b32 v34, v4, v12, v34 bitop3:0xca
    v_perm_b32 v13, v31, v31, s42
    v_bitop3_b32 v35, v4, v13, v35 bitop3:0xca
    v_lshrrev_b32 v8, 2, v0
    v_and_b32 v7, 0x3c00, v0
    v_bitop3_b32 v7, v5, v8, v7 bitop3:0xea
    s_waitcnt lgkmcnt(0)
    s_barrier
    ds_read2st64_b32 v[8:9], v7 offset0:0 offset1:1
    ds_read2st64_b32 v[10:11], v7 offset0:2 offset1:3
    s_add_u32 s46, s35, 0x2a50000
    buffer_store_dwordx4 v[84:87], v0, s[20:23], s46 offen sc1
    s_add_u32 s47, s34, 0x3000000
    s_nop 0
    buffer_load_dwordx2 v[84:85], v1, s[16:19], s47 offen nt
    s_add_u32 s44, s34, 0x3200000
    buffer_load_dwordx2 v[86:87], v1, s[16:19], s44 offen nt
    s_waitcnt lgkmcnt(0)
    v_lshl_or_b32 v12, v9, 16, v8
    v_lshl_or_b32 v13, v11, 16, v10
    v_mov_b32 v14, v12
    v_mov_b32 v15, v13
    s_nop 0
    v_add_u32_dpp v14, v14, v14 row_shr:1 row_mask:0xf bank_mask:0xf bound_ctrl:1
    v_add_u32_dpp v15, v15, v15 row_shr:1 row_mask:0xf bank_mask:0xf bound_ctrl:1
    s_nop 0
    v_add_u32_dpp v14, v14, v14 row_shr:2 row_mask:0xf bank_mask:0xf bound_ctrl:1
    v_add_u32_dpp v15, v15, v15 row_shr:2 row_mask:0xf bank_mask:0xf bound_ctrl:1
    s_nop 0
    v_add_u32_dpp v14, v14, v14 row_shr:4 row_mask:0xf bank_mask:0xf bound_ctrl:1
    v_add_u32_dpp v15, v15, v15 row_shr:4 row_mask:0xf bank_mask:0xf bound_ctrl:1
    s_nop 0
    v_add_u32_dpp v14, v14, v14 row_shr:8 row_mask:0xf bank_mask:0xf bound_ctrl:1
    v_add_u32_dpp v15, v15, v15 row_shr:8 row_mask:0xf bank_mask:0xf bound_ctrl:1
    s_nop 0
    v_add_u32_dpp v14, v14, v14 row_bcast:15 row_mask:0xa bank_mask:0xf
    v_add_u32_dpp v15, v15, v15 row_bcast:15 row_mask:0xa bank_mask:0xf
    s_nop 0
    v_add_u32_dpp v14, v14, v14 row_bcast:31 row_mask:0xc bank_mask:0xf
    v_add_u32_dpp v15, v15, v15 row_bcast:31 row_mask:0xc bank_mask:0xf
    v_readlane_b32 s48, v14, 63
    v_readlane_b32 s49, v15, 63
    s_lshl_b32 s54, s32, 2
    v_mov_b32 v8, s54
    s_and_b32 s50, s48, 0xffff
    s_lshr_b32 s51, s48, 16
    s_and_b32 s52, s49, 0xffff
    s_lshr_b32 s53, s49, 16
    s_add_u32 s51, s51, s50
    s_add_u32 s52, s52, s51
    s_add_u32 s53, s53, s52
    v_mov_b32 v9, s53
    s_mov_b64 exec, 1
    ds_write_b32 v8, v9 offset:16384
    s_mov_b64 exec, -1
    v_and_b32 v8, 60, v7
    s_waitcnt lgkmcnt(0)
    s_barrier
    ds_read_b32 v9, v8 offset:16384
    s_waitcnt lgkmcnt(0)
    v_add_u32_dpp v9, v9, v9 row_shr:1 row_mask:0xf bank_mask:0xf bound_ctrl:1
    s_nop 1
    v_add_u32_dpp v9, v9, v9 row_shr:2 row_mask:0xf bank_mask:0xf bound_ctrl:1
    s_nop 1
    v_add_u32_dpp v9, v9, v9 row_shr:4 row_mask:0xf bank_mask:0xf bound_ctrl:1
    s_nop 1
    v_add_u32_dpp v9, v9, v9 row_shr:8 row_mask:0xf bank_mask:0xf bound_ctrl:1
    s_nop 0
    v_readlane_b32 s54, v9, s32
    s_sub_u32 s54, s54, s53
    s_add_u32 s50, s50, s54
    s_add_u32 s51, s51, s54
    s_add_u32 s52, s52, s54
    s_pack_ll_b32_b16 s48, s54, s50
    s_pack_ll_b32_b16 s49, s51, s52
    v_add_u32 v14, s48, v14
    v_add_u32 v15, s49, v15
    v_sub_u32 v12, v14, v12
    v_sub_u32 v13, v15, v13
    v_and_b32 v8, 0xffff, v12
    v_lshrrev_b32 v9, 16, v12
    v_and_b32 v10, 0xffff, v13
    v_lshrrev_b32 v11, 16, v13
    ds_write2st64_b32 v7, v8, v9 offset0:0 offset1:1
    ds_write2st64_b32 v7, v10, v11 offset0:2 offset1:3
    s_waitcnt lgkmcnt(0)
    s_barrier
    ds_add_rtn_u32 v72, v72, v2
    ds_add_rtn_u32 v73, v73, v2
    ds_add_rtn_u32 v74, v74, v2
    ds_add_rtn_u32 v75, v75, v2
    s_add_u32 s45, s36, 0x5480000
    v_and_b32 v11, 0x3f0, v0
    v_add_u32 v11, v11, v11
    buffer_store_dwordx2 v[12:13], v11, s[24:27], s45 offen
    s_bitset0_b64 exec, 63
    s_not_b64 exec, exec
    buffer_store_dwordx2 v[14:15], v11, s[24:27], s45 offen offset:32
    s_mov_b64 exec, -1
    ds_add_rtn_u32 v80, v80, v2
    ds_add_rtn_u32 v81, v81, v2
    ds_add_rtn_u32 v82, v82, v2
    ds_add_rtn_u32 v83, v83, v2
    ds_add_rtn_u32 v100, v100, v2
    ds_add_rtn_u32 v101, v101, v2
    ds_add_rtn_u32 v102, v102, v2
    ds_add_rtn_u32 v103, v103, v2
    s_add_u32 s46, s35, 0x2a54000
    buffer_store_dwordx4 v[48:51], v0, s[20:23], s46 offen sc1
    s_add_u32 s47, s33, 0x6400000
    s_nop 0
    buffer_load_dwordx4 v[48:51], v0, s[8:11], s47 offen nt
    ds_add_rtn_u32 v112, v112, v2
    ds_add_rtn_u32 v113, v113, v2
    ds_add_rtn_u32 v114, v114, v2
    ds_add_rtn_u32 v115, v115, v2
    ds_add_rtn_u32 v116, v116, v2
    ds_add_rtn_u32 v117, v117, v2
    ds_add_rtn_u32 v118, v118, v2
    ds_add_rtn_u32 v119, v119, v2
    ds_add_rtn_u32 v16, v16, v2
    ds_add_rtn_u32 v17, v17, v2
    ds_add_rtn_u32 v18, v18, v2
    ds_add_rtn_u32 v19, v19, v2
    s_add_u32 s44, s35, 0x2a58000
    buffer_store_dwordx4 v[52:55], v0, s[20:23], s44 offen sc1
    s_add_u32 s45, s33, 0x6400000
    s_nop 0
    buffer_load_dwordx4 v[52:55], v0, s[12:15], s45 offen nt
    ds_add_rtn_u32 v124, v124, v2
    ds_add_rtn_u32 v125, v125, v2
    ds_add_rtn_u32 v126, v126, v2
    ds_add_rtn_u32 v127, v127, v2
    ds_add_rtn_u32 v36, v36, v2
    ds_add_rtn_u32 v37, v37, v2
    ds_add_rtn_u32 v38, v38, v2
    ds_add_rtn_u32 v39, v39, v2
    s_waitcnt lgkmcnt(0)
    s_barrier
    v_and_b32 v7, -4, v72
    v_lshl_add_u32 v8, v72, 2, v7
    ds_write_b32 v8, v68
    v_lshl_add_u32 v7, v7, 2, v72
    ds_write_b8 v7, v64 offset:16
    v_and_b32 v9, -4, v73
    v_lshl_add_u32 v10, v73, 2, v9
    ds_write_b32 v10, v69
    v_lshl_add_u32 v9, v9, 2, v73
    ds_write_b8_d16_hi v9, v64 offset:16
    v_and_b32 v7, -4, v74
    v_lshl_add_u32 v8, v74, 2, v7
    ds_write_b32 v8, v70
    v_lshl_add_u32 v7, v7, 2, v74
    ds_write_b8 v7, v65 offset:16
    v_and_b32 v9, -4, v75
    v_lshl_add_u32 v10, v75, 2, v9
    ds_write_b32 v10, v71
    v_lshl_add_u32 v9, v9, 2, v75
    ds_write_b8_d16_hi v9, v65 offset:16
    s_add_u32 s46, s35, 0x2a5c000
    buffer_store_dwordx4 v[56:59], v0, s[20:23], s46 offen sc1
    s_add_u32 s47, s33, 0x6800000
    buffer_load_dwordx4 v[68:71], v0, s[8:11], s47 offen nt
    s_add_u32 s44, s33, 0x6800000
    buffer_load_dwordx4 v[72:75], v0, s[12:15], s44 offen nt
    v_and_b32 v7, -4, v80
    v_lshl_add_u32 v8, v80, 2, v7
    ds_write_b32 v8, v76
    v_lshl_add_u32 v7, v7, 2, v80
    ds_write_b8 v7, v66 offset:16
    v_and_b32 v9, -4, v81
    v_lshl_add_u32 v10, v81, 2, v9
    ds_write_b32 v10, v77
    v_lshl_add_u32 v9, v9, 2, v81
    ds_write_b8_d16_hi v9, v66 offset:16
    v_and_b32 v7, -4, v82
    v_lshl_add_u32 v8, v82, 2, v7
    ds_write_b32 v8, v78
    v_lshl_add_u32 v7, v7, 2, v82
    ds_write_b8 v7, v67 offset:16
    v_and_b32 v9, -4, v83
    v_lshl_add_u32 v10, v83, 2, v9
    ds_write_b32 v10, v79
    v_lshl_add_u32 v9, v9, 2, v83
    ds_write_b8_d16_hi v9, v67 offset:16
    s_add_u32 s45, s34, 0x3400000
    buffer_load_dwordx2 v[56:57], v1, s[16:19], s45 offen nt
    s_add_u32 s46, s34, 0x3600000
    buffer_load_dwordx2 v[58:59], v1, s[16:19], s46 offen nt
    s_add_u32 s47, s33, 0x6c00000
    buffer_load_dwordx4 v[76:79], v0, s[8:11], s47 offen nt
    v_and_b32 v7, -4, v100
    v_lshl_add_u32 v8, v100, 2, v7
    ds_write_b32 v8, v96
    v_lshl_add_u32 v7, v7, 2, v100
    ds_write_b8 v7, v88 offset:16
    v_and_b32 v9, -4, v101
    v_lshl_add_u32 v10, v101, 2, v9
    ds_write_b32 v10, v97
    v_lshl_add_u32 v9, v9, 2, v101
    ds_write_b8_d16_hi v9, v88 offset:16
    v_and_b32 v7, -4, v102
    v_lshl_add_u32 v8, v102, 2, v7
    ds_write_b32 v8, v98
    v_lshl_add_u32 v7, v7, 2, v102
    ds_write_b8 v7, v89 offset:16
    v_and_b32 v9, -4, v103
    v_lshl_add_u32 v10, v103, 2, v9
    ds_write_b32 v10, v99
    v_lshl_add_u32 v9, v9, 2, v103
    ds_write_b8_d16_hi v9, v89 offset:16
    s_add_u32 s44, s35, 0x2a60000
    buffer_store_dwordx4 v[60:63], v0, s[20:23], s44 offen sc1
    s_add_u32 s45, s33, 0x6c00000
    buffer_load_dwordx4 v[80:83], v0, s[12:15], s45 offen nt
    v_and_b32 v7, -4, v112
    v_lshl_add_u32 v8, v112, 2, v7
    ds_write_b32 v8, v108
    v_lshl_add_u32 v7, v7, 2, v112
    ds_write_b8 v7, v90 offset:16
    v_and_b32 v9, -4, v113
    v_lshl_add_u32 v10, v113, 2, v9
    ds_write_b32 v10, v109
    v_lshl_add_u32 v9, v9, 2, v113
    ds_write_b8_d16_hi v9, v90 offset:16
    v_and_b32 v7, -4, v114
    v_lshl_add_u32 v8, v114, 2, v7
    ds_write_b32 v8, v110
    v_lshl_add_u32 v7, v7, 2, v114
    ds_write_b8 v7, v91 offset:16
    v_and_b32 v9, -4, v115
    v_lshl_add_u32 v10, v115, 2, v9
    ds_write_b32 v10, v111
    v_lshl_add_u32 v9, v9, 2, v115
    ds_write_b8_d16_hi v9, v91 offset:16
    s_add_u32 s46, s33, 0x7000000
    buffer_load_dwordx4 v[64:67], v0, s[8:11], s46 offen nt
    s_add_u32 s47, s33, 0x7000000
    buffer_load_dwordx4 v[96:99], v0, s[12:15], s47 offen nt
    v_and_b32 v7, -4, v116
    v_lshl_add_u32 v8, v116, 2, v7
    ds_write_b32 v8, v104
    v_lshl_add_u32 v7, v7, 2, v116
    ds_write_b8 v7, v120 offset:16
    v_and_b32 v9, -4, v117
    v_lshl_add_u32 v10, v117, 2, v9
    ds_write_b32 v10, v105
    v_lshl_add_u32 v9, v9, 2, v117
    ds_write_b8_d16_hi v9, v120 offset:16
    v_and_b32 v7, -4, v118
    v_lshl_add_u32 v8, v118, 2, v7
    ds_write_b32 v8, v106
    v_lshl_add_u32 v7, v7, 2, v118
    ds_write_b8 v7, v121 offset:16
    v_and_b32 v9, -4, v119
    v_lshl_add_u32 v10, v119, 2, v9
    ds_write_b32 v10, v107
    v_lshl_add_u32 v9, v9, 2, v119
    ds_write_b8_d16_hi v9, v121 offset:16
    s_add_u32 s44, s34, 0x3800000
    buffer_load_dwordx2 v[100:101], v1, s[16:19], s44 offen nt
    s_add_u32 s45, s34, 0x3a00000
    buffer_load_dwordx2 v[102:103], v1, s[16:19], s45 offen nt
    s_add_u32 s46, s33, 0x7400000
    buffer_load_dwordx4 v[60:63], v0, s[8:11], s46 offen nt
    v_and_b32 v7, -4, v16
    v_lshl_add_u32 v8, v16, 2, v7
    ds_write_b32 v8, v92
    v_lshl_add_u32 v7, v7, 2, v16
    ds_write_b8 v7, v122 offset:16
    v_and_b32 v9, -4, v17
    v_lshl_add_u32 v10, v17, 2, v9
    ds_write_b32 v10, v93
    v_lshl_add_u32 v9, v9, 2, v17
    ds_write_b8_d16_hi v9, v122 offset:16
    v_and_b32 v7, -4, v18
    v_lshl_add_u32 v8, v18, 2, v7
    ds_write_b32 v8, v94
    v_lshl_add_u32 v7, v7, 2, v18
    ds_write_b8 v7, v123 offset:16
    v_and_b32 v9, -4, v19
    v_lshl_add_u32 v10, v19, 2, v9
    ds_write_b32 v10, v95
    v_lshl_add_u32 v9, v9, 2, v19
    ds_write_b8_d16_hi v9, v123 offset:16
    s_add_u32 s47, s35, 0x2a64000
    buffer_store_dwordx4 v[44:47], v0, s[20:23], s47 offen sc1
    s_add_u32 s44, s33, 0x7400000
    buffer_load_dwordx4 v[108:111], v0, s[12:15], s44 offen nt
    v_and_b32 v7, -4, v124
    v_lshl_add_u32 v8, v124, 2, v7
    ds_write_b32 v8, v20
    v_lshl_add_u32 v7, v7, 2, v124
    ds_write_b8 v7, v28 offset:16
    v_and_b32 v9, -4, v125
    v_lshl_add_u32 v10, v125, 2, v9
    ds_write_b32 v10, v21
    v_lshl_add_u32 v9, v9, 2, v125
    ds_write_b8_d16_hi v9, v28 offset:16
    v_and_b32 v7, -4, v126
    v_lshl_add_u32 v8, v126, 2, v7
    ds_write_b32 v8, v22
    v_lshl_add_u32 v7, v7, 2, v126
    ds_write_b8 v7, v29 offset:16
    v_and_b32 v9, -4, v127
    v_lshl_add_u32 v10, v127, 2, v9
    ds_write_b32 v10, v23
    v_lshl_add_u32 v9, v9, 2, v127
    ds_write_b8_d16_hi v9, v29 offset:16
    s_add_u32 s45, s33, 0x7800000
    buffer_load_dwordx4 v[112:115], v0, s[8:11], s45 offen nt
    s_add_u32 s46, s33, 0x7800000
    buffer_load_dwordx4 v[88:91], v0, s[12:15], s46 offen nt
    v_and_b32 v7, -4, v36
    v_lshl_add_u32 v8, v36, 2, v7
    ds_write_b32 v8, v32
    v_lshl_add_u32 v7, v7, 2, v36
    ds_write_b8 v7, v30 offset:16
    v_and_b32 v9, -4, v37
    v_lshl_add_u32 v10, v37, 2, v9
    ds_write_b32 v10, v33
    v_lshl_add_u32 v9, v9, 2, v37
    ds_write_b8_d16_hi v9, v30 offset:16
    v_and_b32 v7, -4, v38
    v_lshl_add_u32 v8, v38, 2, v7
    ds_write_b32 v8, v34
    v_lshl_add_u32 v7, v7, 2, v38
    ds_write_b8 v7, v31 offset:16
    v_and_b32 v9, -4, v39
    v_lshl_add_u32 v10, v39, 2, v9
    ds_write_b32 v10, v35
    v_lshl_add_u32 v9, v9, 2, v39
    ds_write_b8_d16_hi v9, v31 offset:16
    s_add_u32 s47, s34, 0x3c00000
    buffer_load_dwordx2 v[104:105], v1, s[16:19], s47 offen nt
    s_add_u32 s44, s34, 0x3e00000
    buffer_load_dwordx2 v[106:107], v1, s[16:19], s44 offen nt
    v_add_u32 v7, 0x10000, v0
    v_add_u32 v12, 0x20000, v0
    v_mov_b32 v8, 0
    v_mov_b32 v9, 0
    v_mov_b32 v10, 0
    v_mov_b32 v11, 0
    s_waitcnt lgkmcnt(0)
    s_barrier
    ds_read_b128 v[116:119], v0 offset:0
    ds_write_b128 v0, v[8:11]
    ds_read_b128 v[92:95], v0 offset:16384
    ds_read_b128 v[16:19], v0 offset:32768
    ds_read_b128 v[120:123], v0 offset:49152
    ds_read_b128 v[44:47], v7 offset:0
    ds_read_b128 v[20:23], v7 offset:16384
    ds_read_b128 v[124:127], v7 offset:32768
    ds_read_b128 v[32:35], v7 offset:49152
    ds_read_b128 v[36:39], v12 offset:0
    ds_read_b128 v[28:31], v12 offset:16384
    s_waitcnt lgkmcnt(0)
    s_barrier
    s_add_u32 s45, s35, 0x5480000
    buffer_store_dwordx4 v[116:119], v0, s[20:23], s45 offen sc1
    s_add_u32 s46, s33, 0x7c00000
    s_nop 0
    buffer_load_dwordx4 v[116:119], v0, s[8:11], s46 offen nt
    s_add_u32 s47, s35, 0x5484000
    buffer_store_dwordx4 v[92:95], v0, s[20:23], s47 offen sc1
    s_add_u32 s44, s33, 0x7c00000
    s_nop 0
    buffer_load_dwordx4 v[92:95], v0, s[12:15], s44 offen nt
    s_waitcnt vmcnt(29)
    v_lshlrev_b32 v7, 16, v84
    v_and_b32 v8, 0xffff0000, v84
    v_lshlrev_b32 v9, 16, v85
    v_and_b32 v10, 0xffff0000, v85
    v_mul_f32 v7, 0.15915494, v7
    v_mul_f32 v8, 0.15915494, v8
    v_mul_f32 v9, 0.15915494, v9
    v_mul_f32 v10, 0.15915494, v10
    v_mul_hi_u32_u24 v14, 429497, v40
    v_lshrrev_b32 v12, 3, v24
    v_cos_f32 v7, v7
    v_lshlrev_b16 v13, 3, v24
    v_mad_i32_i24 v11, v14, s55, v40
    v_bitop3_b32 v12, v6, v13, v12 bitop3:0xca
    v_add_lshl_u32 v11, v11, s40, 17
    v_lshlrev_b16 v14, 8, v14
    v_lshrrev_b32 v13, 2, v24
    v_or_b32 v40, v12, v11
    v_bitop3_b32 v24, v5, v13, v14 bitop3:0xea
    ds_add_u32 v24, v2
    v_mul_hi_u32_u24 v14, 429497, v41
    v_lshrrev_b32 v12, 3, v25
    v_cos_f32 v8, v8
    v_lshlrev_b16 v13, 3, v25
    v_mad_i32_i24 v11, v14, s55, v41
    v_bitop3_b32 v12, v6, v13, v12 bitop3:0xca
    v_add_lshl_u32 v11, v11, s40, 17
    v_lshlrev_b16 v14, 8, v14
    v_lshrrev_b32 v13, 2, v25
    v_or_b32 v41, v12, v11
    v_bitop3_b32 v25, v5, v13, v14 bitop3:0xea
    ds_add_u32 v25, v2
    v_cvt_pk_bf16_f32 v84, v7, v8
    v_perm_b32 v12, v84, v84, s41
    v_bitop3_b32 v40, v4, v12, v40 bitop3:0xca
    v_perm_b32 v13, v84, v84, s42
    v_bitop3_b32 v41, v4, v13, v41 bitop3:0xca
    v_mul_hi_u32_u24 v14, 429497, v42
    v_lshrrev_b32 v12, 3, v26
    v_cos_f32 v9, v9
    v_lshlrev_b16 v13, 3, v26
    v_mad_i32_i24 v11, v14, s55, v42
    v_bitop3_b32 v12, v6, v13, v12 bitop3:0xca
    v_add_lshl_u32 v11, v11, s40, 17
    v_lshlrev_b16 v14, 8, v14
    v_lshrrev_b32 v13, 2, v26
    v_or_b32 v42, v12, v11
    v_bitop3_b32 v26, v5, v13, v14 bitop3:0xea
    ds_add_u32 v26, v2
    v_mul_hi_u32_u24 v14, 429497, v43
    v_lshrrev_b32 v12, 3, v27
    v_cos_f32 v10, v10
    v_lshlrev_b16 v13, 3, v27
    v_mad_i32_i24 v11, v14, s55, v43
    v_bitop3_b32 v12, v6, v13, v12 bitop3:0xca
    v_add_lshl_u32 v11, v11, s40, 17
    v_lshlrev_b16 v14, 8, v14
    v_lshrrev_b32 v13, 2, v27
    v_or_b32 v43, v12, v11
    v_bitop3_b32 v27, v5, v13, v14 bitop3:0xea
    ds_add_u32 v27, v2
    v_cvt_pk_bf16_f32 v85, v9, v10
    v_perm_b32 v12, v85, v85, s41
    v_bitop3_b32 v42, v4, v12, v42 bitop3:0xca
    v_perm_b32 v13, v85, v85, s42
    v_bitop3_b32 v43, v4, v13, v43 bitop3:0xca
    s_waitcnt vmcnt(23)
    v_lshlrev_b32 v7, 16, v86
    v_and_b32 v8, 0xffff0000, v86
    v_lshlrev_b32 v9, 16, v87
    v_and_b32 v10, 0xffff0000, v87
    v_mul_f32 v7, 0.15915494, v7
    v_mul_f32 v8, 0.15915494, v8
    v_mul_f32 v9, 0.15915494, v9
    v_mul_f32 v10, 0.15915494, v10
    v_mul_hi_u32_u24 v14, 429497, v48
    v_lshrrev_b32 v12, 3, v52
    v_cos_f32 v7, v7
    v_lshlrev_b16 v13, 3, v52
    v_mad_i32_i24 v11, v14, s55, v48
    v_bitop3_b32 v12, v6, v13, v12 bitop3:0xca
    v_add_lshl_u32 v11, v11, s40, 17
    v_lshlrev_b16 v14, 8, v14
    v_lshrrev_b32 v13, 2, v52
    v_or_b32 v48, v12, v11
    v_bitop3_b32 v52, v5, v13, v14 bitop3:0xea
    ds_add_u32 v52, v2
    v_mul_hi_u32_u24 v14, 429497, v49
    v_lshrrev_b32 v12, 3, v53
    v_cos_f32 v8, v8
    v_lshlrev_b16 v13, 3, v53
    v_mad_i32_i24 v11, v14, s55, v49
    v_bitop3_b32 v12, v6, v13, v12 bitop3:0xca
    v_add_lshl_u32 v11, v11, s40, 17
    v_lshlrev_b16 v14, 8, v14
    v_lshrrev_b32 v13, 2, v53
    v_or_b32 v49, v12, v11
    v_bitop3_b32 v53, v5, v13, v14 bitop3:0xea
    ds_add_u32 v53, v2
    v_cvt_pk_bf16_f32 v86, v7, v8
    v_perm_b32 v12, v86, v86, s41
    v_bitop3_b32 v48, v4, v12, v48 bitop3:0xca
    v_perm_b32 v13, v86, v86, s42
    v_bitop3_b32 v49, v4, v13, v49 bitop3:0xca
    v_mul_hi_u32_u24 v14, 429497, v50
    v_lshrrev_b32 v12, 3, v54
    v_cos_f32 v9, v9
    v_lshlrev_b16 v13, 3, v54
    v_mad_i32_i24 v11, v14, s55, v50
    v_bitop3_b32 v12, v6, v13, v12 bitop3:0xca
    v_add_lshl_u32 v11, v11, s40, 17
    v_lshlrev_b16 v14, 8, v14
    v_lshrrev_b32 v13, 2, v54
    v_or_b32 v50, v12, v11
    v_bitop3_b32 v54, v5, v13, v14 bitop3:0xea
    ds_add_u32 v54, v2
    v_mul_hi_u32_u24 v14, 429497, v51
    v_lshrrev_b32 v12, 3, v55
    v_cos_f32 v10, v10
    v_lshlrev_b16 v13, 3, v55
    v_mad_i32_i24 v11, v14, s55, v51
    v_bitop3_b32 v12, v6, v13, v12 bitop3:0xca
    v_add_lshl_u32 v11, v11, s40, 17
    v_lshlrev_b16 v14, 8, v14
    v_lshrrev_b32 v13, 2, v55
    v_or_b32 v51, v12, v11
    v_bitop3_b32 v55, v5, v13, v14 bitop3:0xea
    ds_add_u32 v55, v2
    v_cvt_pk_bf16_f32 v87, v9, v10
    v_perm_b32 v12, v87, v87, s41
    v_bitop3_b32 v50, v4, v12, v50 bitop3:0xca
    v_perm_b32 v13, v87, v87, s42
    v_bitop3_b32 v51, v4, v13, v51 bitop3:0xca
    s_waitcnt vmcnt(18)
    v_lshlrev_b32 v7, 16, v56
    v_and_b32 v8, 0xffff0000, v56
    v_lshlrev_b32 v9, 16, v57
    v_and_b32 v10, 0xffff0000, v57
    v_mul_f32 v7, 0.15915494, v7
    v_mul_f32 v8, 0.15915494, v8
    v_mul_f32 v9, 0.15915494, v9
    v_mul_f32 v10, 0.15915494, v10
    v_mul_hi_u32_u24 v14, 429497, v68
    v_lshrrev_b32 v12, 3, v72
    v_cos_f32 v7, v7
    v_lshlrev_b16 v13, 3, v72
    v_mad_i32_i24 v11, v14, s55, v68
    v_bitop3_b32 v12, v6, v13, v12 bitop3:0xca
    v_add_lshl_u32 v11, v11, s40, 17
    v_lshlrev_b16 v14, 8, v14
    v_lshrrev_b32 v13, 2, v72
    v_or_b32 v68, v12, v11
    v_bitop3_b32 v72, v5, v13, v14 bitop3:0xea
    ds_add_u32 v72, v2
    v_mul_hi_u32_u24 v14, 429497, v69
    v_lshrrev_b32 v12, 3, v73
    v_cos_f32 v8, v8
    v_lshlrev_b16 v13, 3, v73
    v_mad_i32_i24 v11, v14, s55, v69
    v_bitop3_b32 v12, v6, v13, v12 bitop3:0xca
    v_add_lshl_u32 v11, v11, s40, 17
    v_lshlrev_b16 v14, 8, v14
    v_lshrrev_b32 v13, 2, v73
    v_or_b32 v69, v12, v11
    v_bitop3_b32 v73, v5, v13, v14 bitop3:0xea
    ds_add_u32 v73, v2
    v_cvt_pk_bf16_f32 v56, v7, v8
    v_perm_b32 v12, v56, v56, s41
    v_bitop3_b32 v68, v4, v12, v68 bitop3:0xca
    v_perm_b32 v13, v56, v56, s42
    v_bitop3_b32 v69, v4, v13, v69 bitop3:0xca
    v_mul_hi_u32_u24 v14, 429497, v70
    v_lshrrev_b32 v12, 3, v74
    v_cos_f32 v9, v9
    v_lshlrev_b16 v13, 3, v74
    v_mad_i32_i24 v11, v14, s55, v70
    v_bitop3_b32 v12, v6, v13, v12 bitop3:0xca
    v_add_lshl_u32 v11, v11, s40, 17
    v_lshlrev_b16 v14, 8, v14
    v_lshrrev_b32 v13, 2, v74
    v_or_b32 v70, v12, v11
    v_bitop3_b32 v74, v5, v13, v14 bitop3:0xea
    ds_add_u32 v74, v2
    v_mul_hi_u32_u24 v14, 429497, v71
    v_lshrrev_b32 v12, 3, v75
    v_cos_f32 v10, v10
    v_lshlrev_b16 v13, 3, v75
    v_mad_i32_i24 v11, v14, s55, v71
    v_bitop3_b32 v12, v6, v13, v12 bitop3:0xca
    v_add_lshl_u32 v11, v11, s40, 17
    v_lshlrev_b16 v14, 8, v14
    v_lshrrev_b32 v13, 2, v75
    v_or_b32 v71, v12, v11
    v_bitop3_b32 v75, v5, v13, v14 bitop3:0xea
    ds_add_u32 v75, v2
    v_cvt_pk_bf16_f32 v57, v9, v10
    v_perm_b32 v12, v57, v57, s41
    v_bitop3_b32 v70, v4, v12, v70 bitop3:0xca
    v_perm_b32 v13, v57, v57, s42
    v_bitop3_b32 v71, v4, v13, v71 bitop3:0xca
    s_add_u32 s45, s35, 0x5488000
    buffer_store_dwordx4 v[16:19], v0, s[20:23], s45 offen sc1
    s_add_u32 s46, s33, 0x8000000
    s_nop 0
    buffer_load_dwordx4 v[16:19], v0, s[8:11], s46 offen nt
    s_waitcnt vmcnt(17)
    v_lshlrev_b32 v7, 16, v58
    v_and_b32 v8, 0xffff0000, v58
    v_lshlrev_b32 v9, 16, v59
    v_and_b32 v10, 0xffff0000, v59
    v_mul_f32 v7, 0.15915494, v7
    v_mul_f32 v8, 0.15915494, v8
    v_mul_f32 v9, 0.15915494, v9
    v_mul_f32 v10, 0.15915494, v10
    v_mul_hi_u32_u24 v14, 429497, v76
    v_lshrrev_b32 v12, 3, v80
    v_cos_f32 v7, v7
    v_lshlrev_b16 v13, 3, v80
    v_mad_i32_i24 v11, v14, s55, v76
    v_bitop3_b32 v12, v6, v13, v12 bitop3:0xca
    v_add_lshl_u32 v11, v11, s40, 17
    v_lshlrev_b16 v14, 8, v14
    v_lshrrev_b32 v13, 2, v80
    v_or_b32 v76, v12, v11
    v_bitop3_b32 v80, v5, v13, v14 bitop3:0xea
    ds_add_u32 v80, v2
    v_mul_hi_u32_u24 v14, 429497, v77
    v_lshrrev_b32 v12, 3, v81
    v_cos_f32 v8, v8
    v_lshlrev_b16 v13, 3, v81
    v_mad_i32_i24 v11, v14, s55, v77
    v_bitop3_b32 v12, v6, v13, v12 bitop3:0xca
    v_add_lshl_u32 v11, v11, s40, 17
    v_lshlrev_b16 v14, 8, v14
    v_lshrrev_b32 v13, 2, v81
    v_or_b32 v77, v12, v11
    v_bitop3_b32 v81, v5, v13, v14 bitop3:0xea
    ds_add_u32 v81, v2
    v_cvt_pk_bf16_f32 v58, v7, v8
    v_perm_b32 v12, v58, v58, s41
    v_bitop3_b32 v76, v4, v12, v76 bitop3:0xca
    v_perm_b32 v13, v58, v58, s42
    v_bitop3_b32 v77, v4, v13, v77 bitop3:0xca
    v_mul_hi_u32_u24 v14, 429497, v78
    v_lshrrev_b32 v12, 3, v82
    v_cos_f32 v9, v9
    v_lshlrev_b16 v13, 3, v82
    v_mad_i32_i24 v11, v14, s55, v78
    v_bitop3_b32 v12, v6, v13, v12 bitop3:0xca
    v_add_lshl_u32 v11, v11, s40, 17
    v_lshlrev_b16 v14, 8, v14
    v_lshrrev_b32 v13, 2, v82
    v_or_b32 v78, v12, v11
    v_bitop3_b32 v82, v5, v13, v14 bitop3:0xea
    ds_add_u32 v82, v2
    v_mul_hi_u32_u24 v14, 429497, v79
    v_lshrrev_b32 v12, 3, v83
    v_cos_f32 v10, v10
    v_lshlrev_b16 v13, 3, v83
    v_mad_i32_i24 v11, v14, s55, v79
    v_bitop3_b32 v12, v6, v13, v12 bitop3:0xca
    v_add_lshl_u32 v11, v11, s40, 17
    v_lshlrev_b16 v14, 8, v14
    v_lshrrev_b32 v13, 2, v83
    v_or_b32 v79, v12, v11
    v_bitop3_b32 v83, v5, v13, v14 bitop3:0xea
    ds_add_u32 v83, v2
    v_cvt_pk_bf16_f32 v59, v9, v10
    v_perm_b32 v12, v59, v59, s41
    v_bitop3_b32 v78, v4, v12, v78 bitop3:0xca
    v_perm_b32 v13, v59, v59, s42
    v_bitop3_b32 v79, v4, v13, v79 bitop3:0xca
    s_mov_b32 s68, s56
    s_mov_b32 s69, s57
    s_mov_b32 s70, 0x100
    s_mov_b32 s71, 0x20000
    v_mov_b32 v3, 1
    s_cmp_lg_u32 s32, 15
    s_cbranch_scc1 L1_tk
    s_mov_b64 exec, 1
    buffer_atomic_add v3, off, s[68:71], 0 sc0
    s_mov_b64 exec, -1
L1_tk:
    s_waitcnt vmcnt(13)
    v_lshlrev_b32 v7, 16, v100
    v_and_b32 v8, 0xffff0000, v100
    v_lshlrev_b32 v9, 16, v101
    v_and_b32 v10, 0xffff0000, v101
    v_mul_f32 v7, 0.15915494, v7
    v_mul_f32 v8, 0.15915494, v8
    v_mul_f32 v9, 0.15915494, v9
    v_mul_f32 v10, 0.15915494, v10
    v_mul_hi_u32_u24 v14, 429497, v64
    v_lshrrev_b32 v12, 3, v96
    v_cos_f32 v7, v7
    v_lshlrev_b16 v13, 3, v96
    v_mad_i32_i24 v11, v14, s55, v64
    v_bitop3_b32 v12, v6, v13, v12 bitop3:0xca
    v_add_lshl_u32 v11, v11, s40, 17
    v_lshlrev_b16 v14, 8, v14
    v_lshrrev_b32 v13, 2, v96
    v_or_b32 v64, v12, v11
    v_bitop3_b32 v96, v5, v13, v14 bitop3:0xea
    ds_add_u32 v96, v2
    v_mul_hi_u32_u24 v14, 429497, v65
    v_lshrrev_b32 v12, 3, v97
    v_cos_f32 v8, v8
    v_lshlrev_b16 v13, 3, v97
    v_mad_i32_i24 v11, v14, s55, v65
    v_bitop3_b32 v12, v6, v13, v12 bitop3:0xca
    v_add_lshl_u32 v11, v11, s40, 17
    v_lshlrev_b16 v14, 8, v14
    v_lshrrev_b32 v13, 2, v97
    v_or_b32 v65, v12, v11
    v_bitop3_b32 v97, v5, v13, v14 bitop3:0xea
    ds_add_u32 v97, v2
    v_cvt_pk_bf16_f32 v100, v7, v8
    v_perm_b32 v12, v100, v100, s41
    v_bitop3_b32 v64, v4, v12, v64 bitop3:0xca
    v_perm_b32 v13, v100, v100, s42
    v_bitop3_b32 v65, v4, v13, v65 bitop3:0xca
    v_mul_hi_u32_u24 v14, 429497, v66
    v_lshrrev_b32 v12, 3, v98
    v_cos_f32 v9, v9
    v_lshlrev_b16 v13, 3, v98
    v_mad_i32_i24 v11, v14, s55, v66
    v_bitop3_b32 v12, v6, v13, v12 bitop3:0xca
    v_add_lshl_u32 v11, v11, s40, 17
    v_lshlrev_b16 v14, 8, v14
    v_lshrrev_b32 v13, 2, v98
    v_or_b32 v66, v12, v11
    v_bitop3_b32 v98, v5, v13, v14 bitop3:0xea
    ds_add_u32 v98, v2
    v_mul_hi_u32_u24 v14, 429497, v67
    v_lshrrev_b32 v12, 3, v99
    v_cos_f32 v10, v10
    v_lshlrev_b16 v13, 3, v99
    v_mad_i32_i24 v11, v14, s55, v67
    v_bitop3_b32 v12, v6, v13, v12 bitop3:0xca
    v_add_lshl_u32 v11, v11, s40, 17
    v_lshlrev_b16 v14, 8, v14
    v_lshrrev_b32 v13, 2, v99
    v_or_b32 v67, v12, v11
    v_bitop3_b32 v99, v5, v13, v14 bitop3:0xea
    ds_add_u32 v99, v2
    v_cvt_pk_bf16_f32 v101, v9, v10
    v_perm_b32 v12, v101, v101, s41
    v_bitop3_b32 v66, v4, v12, v66 bitop3:0xca
    v_perm_b32 v13, v101, v101, s42
    v_bitop3_b32 v67, v4, v13, v67 bitop3:0xca
    s_waitcnt vmcnt(10)
    v_lshlrev_b32 v7, 16, v102
    v_and_b32 v8, 0xffff0000, v102
    v_lshlrev_b32 v9, 16, v103
    v_and_b32 v10, 0xffff0000, v103
    v_mul_f32 v7, 0.15915494, v7
    v_mul_f32 v8, 0.15915494, v8
    v_mul_f32 v9, 0.15915494, v9
    v_mul_f32 v10, 0.15915494, v10
    v_mul_hi_u32_u24 v14, 429497, v60
    v_lshrrev_b32 v12, 3, v108
    v_cos_f32 v7, v7
    v_lshlrev_b16 v13, 3, v108
    v_mad_i32_i24 v11, v14, s55, v60
    v_bitop3_b32 v12, v6, v13, v12 bitop3:0xca
    v_add_lshl_u32 v11, v11, s40, 17
    v_lshlrev_b16 v14, 8, v14
    v_lshrrev_b32 v13, 2, v108
    v_or_b32 v60, v12, v11
    v_bitop3_b32 v108, v5, v13, v14 bitop3:0xea
    ds_add_u32 v108, v2
    v_mul_hi_u32_u24 v14, 429497, v61
    v_lshrrev_b32 v12, 3, v109
    v_cos_f32 v8, v8
    v_lshlrev_b16 v13, 3, v109
    v_mad_i32_i24 v11, v14, s55, v61
    v_bitop3_b32 v12, v6, v13, v12 bitop3:0xca
    v_add_lshl_u32 v11, v11, s40, 17
    v_lshlrev_b16 v14, 8, v14
    v_lshrrev_b32 v13, 2, v109
    v_or_b32 v61, v12, v11
    v_bitop3_b32 v109, v5, v13, v14 bitop3:0xea
    ds_add_u32 v109, v2
    v_cvt_pk_bf16_f32 v102, v7, v8
    v_perm_b32 v12, v102, v102, s41
    v_bitop3_b32 v60, v4, v12, v60 bitop3:0xca
    v_perm_b32 v13, v102, v102, s42
    v_bitop3_b32 v61, v4, v13, v61 bitop3:0xca
    v_mul_hi_u32_u24 v14, 429497, v62
    v_lshrrev_b32 v12, 3, v110
    v_cos_f32 v9, v9
    v_lshlrev_b16 v13, 3, v110
    v_mad_i32_i24 v11, v14, s55, v62
    v_bitop3_b32 v12, v6, v13, v12 bitop3:0xca
    v_add_lshl_u32 v11, v11, s40, 17
    v_lshlrev_b16 v14, 8, v14
    v_lshrrev_b32 v13, 2, v110
    v_or_b32 v62, v12, v11
    v_bitop3_b32 v110, v5, v13, v14 bitop3:0xea
    ds_add_u32 v110, v2
    v_mul_hi_u32_u24 v14, 429497, v63
    v_lshrrev_b32 v12, 3, v111
    v_cos_f32 v10, v10
    v_lshlrev_b16 v13, 3, v111
    v_mad_i32_i24 v11, v14, s55, v63
    v_bitop3_b32 v12, v6, v13, v12 bitop3:0xca
    v_add_lshl_u32 v11, v11, s40, 17
    v_lshlrev_b16 v14, 8, v14
    v_lshrrev_b32 v13, 2, v111
    v_or_b32 v63, v12, v11
    v_bitop3_b32 v111, v5, v13, v14 bitop3:0xea
    ds_add_u32 v111, v2
    v_cvt_pk_bf16_f32 v103, v9, v10
    v_perm_b32 v12, v103, v103, s41
    v_bitop3_b32 v62, v4, v12, v62 bitop3:0xca
    v_perm_b32 v13, v103, v103, s42
    v_bitop3_b32 v63, v4, v13, v63 bitop3:0xca
    s_add_u32 s47, s35, 0x548c000
    buffer_store_dwordx4 v[120:123], v0, s[20:23], s47 offen sc1
    s_add_u32 s44, s33, 0x8000000
    s_nop 0
    buffer_load_dwordx4 v[120:123], v0, s[12:15], s44 offen nt
    s_waitcnt vmcnt(8)
    v_lshlrev_b32 v7, 16, v104
    v_and_b32 v8, 0xffff0000, v104
    v_lshlrev_b32 v9, 16, v105
    v_and_b32 v10, 0xffff0000, v105
    v_mul_f32 v7, 0.15915494, v7
    v_mul_f32 v8, 0.15915494, v8
    v_mul_f32 v9, 0.15915494, v9
    v_mul_f32 v10, 0.15915494, v10
    v_mul_hi_u32_u24 v14, 429497, v112
    v_lshrrev_b32 v12, 3, v88
    v_cos_f32 v7, v7
    v_lshlrev_b16 v13, 3, v88
    v_mad_i32_i24 v11, v14, s55, v112
    v_bitop3_b32 v12, v6, v13, v12 bitop3:0xca
    v_add_lshl_u32 v11, v11, s40, 17
    v_lshlrev_b16 v14, 8, v14
    v_lshrrev_b32 v13, 2, v88
    v_or_b32 v112, v12, v11
    v_bitop3_b32 v88, v5, v13, v14 bitop3:0xea
    ds_add_u32 v88, v2
    v_mul_hi_u32_u24 v14, 429497, v113
    v_lshrrev_b32 v12, 3, v89
    v_cos_f32 v8, v8
    v_lshlrev_b16 v13, 3, v89
    v_mad_i32_i24 v11, v14, s55, v113
    v_bitop3_b32 v12, v6, v13, v12 bitop3:0xca
    v_add_lshl_u32 v11, v11, s40, 17
    v_lshlrev_b16 v14, 8, v14
    v_lshrrev_b32 v13, 2, v89
    v_or_b32 v113, v12, v11
    v_bitop3_b32 v89, v5, v13, v14 bitop3:0xea
    ds_add_u32 v89, v2
    v_cvt_pk_bf16_f32 v104, v7, v8
    v_perm_b32 v12, v104, v104, s41
    v_bitop3_b32 v112, v4, v12, v112 bitop3:0xca
    v_perm_b32 v13, v104, v104, s42
    v_bitop3_b32 v113, v4, v13, v113 bitop3:0xca
    v_mul_hi_u32_u24 v14, 429497, v114
    v_lshrrev_b32 v12, 3, v90
    v_cos_f32 v9, v9
    v_lshlrev_b16 v13, 3, v90
    v_mad_i32_i24 v11, v14, s55, v114
    v_bitop3_b32 v12, v6, v13, v12 bitop3:0xca
    v_add_lshl_u32 v11, v11, s40, 17
    v_lshlrev_b16 v14, 8, v14
    v_lshrrev_b32 v13, 2, v90
    v_or_b32 v114, v12, v11
    v_bitop3_b32 v90, v5, v13, v14 bitop3:0xea
    ds_add_u32 v90, v2
    v_mul_hi_u32_u24 v14, 429497, v115
    v_lshrrev_b32 v12, 3, v91
    v_cos_f32 v10, v10
    v_lshlrev_b16 v13, 3, v91
    v_mad_i32_i24 v11, v14, s55, v115
    v_bitop3_b32 v12, v6, v13, v12 bitop3:0xca
    v_add_lshl_u32 v11, v11, s40, 17
    v_lshlrev_b16 v14, 8, v14
    v_lshrrev_b32 v13, 2, v91
    v_or_b32 v115, v12, v11
    v_bitop3_b32 v91, v5, v13, v14 bitop3:0xea
    ds_add_u32 v91, v2
    v_cvt_pk_bf16_f32 v105, v9, v10
    v_perm_b32 v12, v105, v105, s41
    v_bitop3_b32 v114, v4, v12, v114 bitop3:0xca
    v_perm_b32 v13, v105, v105, s42
    v_bitop3_b32 v115, v4, v13, v115 bitop3:0xca
    s_waitcnt vmcnt(4)
    v_lshlrev_b32 v7, 16, v106
    v_and_b32 v8, 0xffff0000, v106
    v_lshlrev_b32 v9, 16, v107
    v_and_b32 v10, 0xffff0000, v107
    v_mul_f32 v7, 0.15915494, v7
    v_mul_f32 v8, 0.15915494, v8
    v_mul_f32 v9, 0.15915494, v9
    v_mul_f32 v10, 0.15915494, v10
    v_mul_hi_u32_u24 v14, 429497, v116
    v_lshrrev_b32 v12, 3, v92
    v_cos_f32 v7, v7
    v_lshlrev_b16 v13, 3, v92
    v_mad_i32_i24 v11, v14, s55, v116
    v_bitop3_b32 v12, v6, v13, v12 bitop3:0xca
    v_add_lshl_u32 v11, v11, s40, 17
    v_lshlrev_b16 v14, 8, v14
    v_lshrrev_b32 v13, 2, v92
    v_or_b32 v116, v12, v11
    v_bitop3_b32 v92, v5, v13, v14 bitop3:0xea
    ds_add_u32 v92, v2
    v_mul_hi_u32_u24 v14, 429497, v117
    v_lshrrev_b32 v12, 3, v93
    v_cos_f32 v8, v8
    v_lshlrev_b16 v13, 3, v93
    v_mad_i32_i24 v11, v14, s55, v117
    v_bitop3_b32 v12, v6, v13, v12 bitop3:0xca
    v_add_lshl_u32 v11, v11, s40, 17
    v_lshlrev_b16 v14, 8, v14
    v_lshrrev_b32 v13, 2, v93
    v_or_b32 v117, v12, v11
    v_bitop3_b32 v93, v5, v13, v14 bitop3:0xea
    ds_add_u32 v93, v2
    v_cvt_pk_bf16_f32 v106, v7, v8
    v_perm_b32 v12, v106, v106, s41
    v_bitop3_b32 v116, v4, v12, v116 bitop3:0xca
    v_perm_b32 v13, v106, v106, s42
    v_bitop3_b32 v117, v4, v13, v117 bitop3:0xca
    v_mul_hi_u32_u24 v14, 429497, v118
    v_lshrrev_b32 v12, 3, v94
    v_cos_f32 v9, v9
    v_lshlrev_b16 v13, 3, v94
    v_mad_i32_i24 v11, v14, s55, v118
    v_bitop3_b32 v12, v6, v13, v12 bitop3:0xca
    v_add_lshl_u32 v11, v11, s40, 17
    v_lshlrev_b16 v14, 8, v14
    v_lshrrev_b32 v13, 2, v94
    v_or_b32 v118, v12, v11
    v_bitop3_b32 v94, v5, v13, v14 bitop3:0xea
    ds_add_u32 v94, v2
    v_mul_hi_u32_u24 v14, 429497, v119
    v_lshrrev_b32 v12, 3, v95
    v_cos_f32 v10, v10
    v_lshlrev_b16 v13, 3, v95
    v_mad_i32_i24 v11, v14, s55, v119
    v_bitop3_b32 v12, v6, v13, v12 bitop3:0xca
    v_add_lshl_u32 v11, v11, s40, 17
    v_lshlrev_b16 v14, 8, v14
    v_lshrrev_b32 v13, 2, v95
    v_or_b32 v119, v12, v11
    v_bitop3_b32 v95, v5, v13, v14 bitop3:0xea
    ds_add_u32 v95, v2
    v_cvt_pk_bf16_f32 v107, v9, v10
    v_perm_b32 v12, v107, v107, s41
    v_bitop3_b32 v118, v4, v12, v118 bitop3:0xca
    v_perm_b32 v13, v107, v107, s42
    v_bitop3_b32 v119, v4, v13, v119 bitop3:0xca
    v_lshrrev_b32 v8, 2, v0
    v_and_b32 v7, 0x3c00, v0
    v_bitop3_b32 v7, v5, v8, v7 bitop3:0xea
    s_waitcnt lgkmcnt(0)
    s_barrier
    ds_read2st64_b32 v[8:9], v7 offset0:0 offset1:1
    ds_read2st64_b32 v[10:11], v7 offset0:2 offset1:3
    s_add_u32 s45, s35, 0x5490000
    buffer_store_dwordx4 v[44:47], v0, s[20:23], s45 offen sc1
    s_add_u32 s46, s34, 0x4000000
    s_nop 0
    buffer_load_dwordx2 v[44:45], v1, s[16:19], s46 offen nt
    s_add_u32 s47, s34, 0x4200000
    buffer_load_dwordx2 v[46:47], v1, s[16:19], s47 offen nt
    s_waitcnt lgkmcnt(0)
    v_lshl_or_b32 v12, v9, 16, v8
    v_lshl_or_b32 v13, v11, 16, v10
    v_mov_b32 v14, v12
    v_mov_b32 v15, v13
    s_nop 0
    v_add_u32_dpp v14, v14, v14 row_shr:1 row_mask:0xf bank_mask:0xf bound_ctrl:1
    v_add_u32_dpp v15, v15, v15 row_shr:1 row_mask:0xf bank_mask:0xf bound_ctrl:1
    s_nop 0
    v_add_u32_dpp v14, v14, v14 row_shr:2 row_mask:0xf bank_mask:0xf bound_ctrl:1
    v_add_u32_dpp v15, v15, v15 row_shr:2 row_mask:0xf bank_mask:0xf bound_ctrl:1
    s_nop 0
    v_add_u32_dpp v14, v14, v14 row_shr:4 row_mask:0xf bank_mask:0xf bound_ctrl:1
    v_add_u32_dpp v15, v15, v15 row_shr:4 row_mask:0xf bank_mask:0xf bound_ctrl:1
    s_nop 0
    v_add_u32_dpp v14, v14, v14 row_shr:8 row_mask:0xf bank_mask:0xf bound_ctrl:1
    v_add_u32_dpp v15, v15, v15 row_shr:8 row_mask:0xf bank_mask:0xf bound_ctrl:1
    s_nop 0
    v_add_u32_dpp v14, v14, v14 row_bcast:15 row_mask:0xa bank_mask:0xf
    v_add_u32_dpp v15, v15, v15 row_bcast:15 row_mask:0xa bank_mask:0xf
    s_nop 0
    v_add_u32_dpp v14, v14, v14 row_bcast:31 row_mask:0xc bank_mask:0xf
    v_add_u32_dpp v15, v15, v15 row_bcast:31 row_mask:0xc bank_mask:0xf
    v_readlane_b32 s48, v14, 63
    v_readlane_b32 s49, v15, 63
    s_lshl_b32 s54, s32, 2
    v_mov_b32 v8, s54
    s_and_b32 s50, s48, 0xffff
    s_lshr_b32 s51, s48, 16
    s_and_b32 s52, s49, 0xffff
    s_lshr_b32 s53, s49, 16
    s_add_u32 s51, s51, s50
    s_add_u32 s52, s52, s51
    s_add_u32 s53, s53, s52
    v_mov_b32 v9, s53
    s_mov_b64 exec, 1
    ds_write_b32 v8, v9 offset:16384
    s_waitcnt vmcnt(5)
    ds_write_b32 v8, v3 offset:16448
    s_mov_b64 exec, -1
    v_and_b32 v8, 60, v7
    s_waitcnt lgkmcnt(0)
    s_barrier
    ds_read_b32 v9, v8 offset:16384
    ds_read_b32 v10, v8 offset:16448
    s_waitcnt lgkmcnt(0)
    v_readlane_b32 s84, v10, 15
    s_min_u32 s4, s84, 136
    s_min_u32 s5, s84, 176
    s_min_u32 s6, s84, 216
    s_add_u32 s4, s4, s5
    s_add_u32 s4, s4, s6
    s_add_u32 s4, s4, 9467
    s_mov_b32 s4, s84
    s_lshl_b32 s58, s4, 14
    s_lshl_b32 s59, s4, 13
    s_mov_b32 s43, 5
    s_cmp_lt_u32 s84, 136
    s_addc_u32 s43, s43, 0
    s_cmp_lt_u32 s84, 176
    s_addc_u32 s43, s43, 0
    s_cmp_lt_u32 s84, 216
    s_addc_u32 s43, s43, 0
    v_add_u32_dpp v9, v9, v9 row_shr:1 row_mask:0xf bank_mask:0xf bound_ctrl:1
    s_nop 1
    v_add_u32_dpp v9, v9, v9 row_shr:2 row_mask:0xf bank_mask:0xf bound_ctrl:1
    s_nop 1
    v_add_u32_dpp v9, v9, v9 row_shr:4 row_mask:0xf bank_mask:0xf bound_ctrl:1
    s_nop 1
    v_add_u32_dpp v9, v9, v9 row_shr:8 row_mask:0xf bank_mask:0xf bound_ctrl:1
    s_nop 0
    v_readlane_b32 s54, v9, s32
    s_sub_u32 s54, s54, s53
    s_add_u32 s50, s50, s54
    s_add_u32 s51, s51, s54
    s_add_u32 s52, s52, s54
    s_pack_ll_b32_b16 s48, s54, s50
    s_pack_ll_b32_b16 s49, s51, s52
    v_add_u32 v14, s48, v14
    v_add_u32 v15, s49, v15
    v_sub_u32 v12, v14, v12
    v_sub_u32 v13, v15, v13
    v_and_b32 v8, 0xffff, v12
    v_lshrrev_b32 v9, 16, v12
    v_and_b32 v10, 0xffff, v13
    v_lshrrev_b32 v11, 16, v13
    ds_write2st64_b32 v7, v8, v9 offset0:0 offset1:1
    ds_write2st64_b32 v7, v10, v11 offset0:2 offset1:3
    s_waitcnt lgkmcnt(0)
    s_barrier
    ds_add_rtn_u32 v24, v24, v2
    ds_add_rtn_u32 v25, v25, v2
    ds_add_rtn_u32 v26, v26, v2
    ds_add_rtn_u32 v27, v27, v2
    s_add_u32 s44, s36, 0x7ec0000
    v_and_b32 v11, 0x3f0, v0
    v_add_u32 v11, v11, v11
    buffer_store_dwordx2 v[12:13], v11, s[24:27], s44 offen
    s_bitset0_b64 exec, 63
    s_not_b64 exec, exec
    buffer_store_dwordx2 v[14:15], v11, s[24:27], s44 offen offset:32
    s_mov_b64 exec, -1
    ds_add_rtn_u32 v52, v52, v2
    ds_add_rtn_u32 v53, v53, v2
    ds_add_rtn_u32 v54, v54, v2
    ds_add_rtn_u32 v55, v55, v2
    ds_add_rtn_u32 v72, v72, v2
    ds_add_rtn_u32 v73, v73, v2
    ds_add_rtn_u32 v74, v74, v2
    ds_add_rtn_u32 v75, v75, v2
    s_add_u32 s45, s35, 0x5494000
    buffer_store_dwordx4 v[20:23], v0, s[20:23], s45 offen sc1
    s_add_u32 s46, s33, 0x8400000
    s_nop 0
    buffer_load_dwordx4 v[20:23], v0, s[8:11], s46 offen nt
    ds_add_rtn_u32 v80, v80, v2
    ds_add_rtn_u32 v81, v81, v2
    ds_add_rtn_u32 v82, v82, v2
    ds_add_rtn_u32 v83, v83, v2
    ds_add_rtn_u32 v96, v96, v2
    ds_add_rtn_u32 v97, v97, v2
    ds_add_rtn_u32 v98, v98, v2
    ds_add_rtn_u32 v99, v99, v2
    ds_add_rtn_u32 v108, v108, v2
    ds_add_rtn_u32 v109, v109, v2
    ds_add_rtn_u32 v110, v110, v2
    ds_add_rtn_u32 v111, v111, v2
    s_add_u32 s47, s35, 0x5498000
    buffer_store_dwordx4 v[124:127], v0, s[20:23], s47 offen sc1
    s_add_u32 s44, s33, 0x8400000
    s_nop 0
    buffer_load_dwordx4 v[124:127], v0, s[12:15], s44 offen nt
    ds_add_rtn_u32 v88, v88, v2
    ds_add_rtn_u32 v89, v89, v2
    ds_add_rtn_u32 v90, v90, v2
    ds_add_rtn_u32 v91, v91, v2
    ds_add_rtn_u32 v92, v92, v2
    ds_add_rtn_u32 v93, v93, v2
    ds_add_rtn_u32 v94, v94, v2
    ds_add_rtn_u32 v95, v95, v2
    s_waitcnt lgkmcnt(0)
    s_barrier
    v_and_b32 v7, -4, v24
    v_lshl_add_u32 v8, v24, 2, v7
    ds_write_b32 v8, v40
    v_lshl_add_u32 v7, v7, 2, v24
    ds_write_b8 v7, v84 offset:16
    v_and_b32 v9, -4, v25
    v_lshl_add_u32 v10, v25, 2, v9
    ds_write_b32 v10, v41
    v_lshl_add_u32 v9, v9, 2, v25
    ds_write_b8_d16_hi v9, v84 offset:16
    v_and_b32 v7, -4, v26
    v_lshl_add_u32 v8, v26, 2, v7
    ds_write_b32 v8, v42
    v_lshl_add_u32 v7, v7, 2, v26
    ds_write_b8 v7, v85 offset:16
    v_and_b32 v9, -4, v27
    v_lshl_add_u32 v10, v27, 2, v9
    ds_write_b32 v10, v43
    v_lshl_add_u32 v9, v9, 2, v27
    ds_write_b8_d16_hi v9, v85 offset:16
    s_add_u32 s45, s35, 0x549c000
    buffer_store_dwordx4 v[32:35], v0, s[20:23], s45 offen sc1
    s_add_u32 s46, s33, 0x8800000
    buffer_load_dwordx4 v[40:43], v0, s[8:11], s46 offen nt
    s_add_u32 s47, s33, 0x8800000
    buffer_load_dwordx4 v[24:27], v0, s[12:15], s47 offen nt
    v_and_b32 v7, -4, v52
    v_lshl_add_u32 v8, v52, 2, v7
    ds_write_b32 v8, v48
    v_lshl_add_u32 v7, v7, 2, v52
    ds_write_b8 v7, v86 offset:16
    v_and_b32 v9, -4, v53
    v_lshl_add_u32 v10, v53, 2, v9
    ds_write_b32 v10, v49
    v_lshl_add_u32 v9, v9, 2, v53
    ds_write_b8_d16_hi v9, v86 offset:16
    v_and_b32 v7, -4, v54
    v_lshl_add_u32 v8, v54, 2, v7
    ds_write_b32 v8, v50
    v_lshl_add_u32 v7, v7, 2, v54
    ds_write_b8 v7, v87 offset:16
    v_and_b32 v9, -4, v55
    v_lshl_add_u32 v10, v55, 2, v9
    ds_write_b32 v10, v51
    v_lshl_add_u32 v9, v9, 2, v55
    ds_write_b8_d16_hi v9, v87 offset:16
    s_add_u32 s44, s34, 0x4400000
    buffer_load_dwordx2 v[32:33], v1, s[16:19], s44 offen nt
    s_add_u32 s45, s34, 0x4600000
    buffer_load_dwordx2 v[34:35], v1, s[16:19], s45 offen nt
    s_add_u32 s46, s33, 0x8c00000
    buffer_load_dwordx4 v[48:51], v0, s[8:11], s46 offen nt
    v_and_b32 v7, -4, v72
    v_lshl_add_u32 v8, v72, 2, v7
    ds_write_b32 v8, v68
    v_lshl_add_u32 v7, v7, 2, v72
    ds_write_b8 v7, v56 offset:16
    v_and_b32 v9, -4, v73
    v_lshl_add_u32 v10, v73, 2, v9
    ds_write_b32 v10, v69
    v_lshl_add_u32 v9, v9, 2, v73
    ds_write_b8_d16_hi v9, v56 offset:16
    v_and_b32 v7, -4, v74
    v_lshl_add_u32 v8, v74, 2, v7
    ds_write_b32 v8, v70
    v_lshl_add_u32 v7, v7, 2, v74
    ds_write_b8 v7, v57 offset:16
    v_and_b32 v9, -4, v75
    v_lshl_add_u32 v10, v75, 2, v9
    ds_write_b32 v10, v71
    v_lshl_add_u32 v9, v9, 2, v75
    ds_write_b8_d16_hi v9, v57 offset:16
    s_add_u32 s47, s35, 0x54a0000
    buffer_store_dwordx4 v[36:39], v0, s[20:23], s47 offen sc1
    s_add_u32 s44, s33, 0x8c00000
    buffer_load_dwordx4 v[52:55], v0, s[12:15], s44 offen nt
    v_and_b32 v7, -4, v80
    v_lshl_add_u32 v8, v80, 2, v7
    ds_write_b32 v8, v76
    v_lshl_add_u32 v7, v7, 2, v80
    ds_write_b8 v7, v58 offset:16
    v_and_b32 v9, -4, v81
    v_lshl_add_u32 v10, v81, 2, v9
    ds_write_b32 v10, v77
    v_lshl_add_u32 v9, v9, 2, v81
    ds_write_b8_d16_hi v9, v58 offset:16
    v_and_b32 v7, -4, v82
    v_lshl_add_u32 v8, v82, 2, v7
    ds_write_b32 v8, v78
    v_lshl_add_u32 v7, v7, 2, v82
    ds_write_b8 v7, v59 offset:16
    v_and_b32 v9, -4, v83
    v_lshl_add_u32 v10, v83, 2, v9
    ds_write_b32 v10, v79
    v_lshl_add_u32 v9, v9, 2, v83
    ds_write_b8_d16_hi v9, v59 offset:16
    s_add_u32 s45, s33, 0x9000000
    buffer_load_dwordx4 v[84:87], v0, s[8:11], s45 offen nt
    s_add_u32 s46, s33, 0x9000000
    buffer_load_dwordx4 v[68:71], v0, s[12:15], s46 offen nt
    v_and_b32 v7, -4, v96
    v_lshl_add_u32 v8, v96, 2, v7
    ds_write_b32 v8, v64
    v_lshl_add_u32 v7, v7, 2, v96
    ds_write_b8 v7, v100 offset:16
    v_and_b32 v9, -4, v97
    v_lshl_add_u32 v10, v97, 2, v9
    ds_write_b32 v10, v65
    v_lshl_add_u32 v9, v9, 2, v97
    ds_write_b8_d16_hi v9, v100 offset:16
    v_and_b32 v7, -4, v98
    v_lshl_add_u32 v8, v98, 2, v7
    ds_write_b32 v8, v66
    v_lshl_add_u32 v7, v7, 2, v98
    ds_write_b8 v7, v101 offset:16
    v_and_b32 v9, -4, v99
    v_lshl_add_u32 v10, v99, 2, v9
    ds_write_b32 v10, v67
    v_lshl_add_u32 v9, v9, 2, v99
    ds_write_b8_d16_hi v9, v101 offset:16
    s_add_u32 s47, s34, 0x4800000
    buffer_load_dwordx2 v[72:73], v1, s[16:19], s47 offen nt
    s_cmp_le_u32 s43, 5
    s_cselect_b32 s18, 0, s18
    s_add_u32 s44, s59, 0x4a00000
    buffer_load_dwordx2 v[74:75], v1, s[16:19], s44 offen nt
    s_cmp_le_u32 s43, 5
    s_cselect_b32 s10, 0, s10
    s_add_u32 s45, s58, 0x9400000
    buffer_load_dwordx4 v[36:39], v0, s[8:11], s45 offen nt
    v_and_b32 v7, -4, v108
    v_lshl_add_u32 v8, v108, 2, v7
    ds_write_b32 v8, v60
    v_lshl_add_u32 v7, v7, 2, v108
    ds_write_b8 v7, v102 offset:16
    v_and_b32 v9, -4, v109
    v_lshl_add_u32 v10, v109, 2, v9
    ds_write_b32 v10, v61
    v_lshl_add_u32 v9, v9, 2, v109
    ds_write_b8_d16_hi v9, v102 offset:16
    v_and_b32 v7, -4, v110
    v_lshl_add_u32 v8, v110, 2, v7
    ds_write_b32 v8, v62
    v_lshl_add_u32 v7, v7, 2, v110
    ds_write_b8 v7, v103 offset:16
    v_and_b32 v9, -4, v111
    v_lshl_add_u32 v10, v111, 2, v9
    ds_write_b32 v10, v63
    v_lshl_add_u32 v9, v9, 2, v111
    ds_write_b8_d16_hi v9, v103 offset:16
    s_add_u32 s46, s35, 0x54a4000
    buffer_store_dwordx4 v[28:31], v0, s[20:23], s46 offen sc1
    s_cmp_le_u32 s43, 5
    s_cselect_b32 s14, 0, s14
    s_add_u32 s47, s58, 0x9400000
    buffer_load_dwordx4 v[76:79], v0, s[12:15], s47 offen nt
    v_and_b32 v7, -4, v88
    v_lshl_add_u32 v8, v88, 2, v7
    ds_write_b32 v8, v112
    v_lshl_add_u32 v7, v7, 2, v88
    ds_write_b8 v7, v104 offset:16
    v_and_b32 v9, -4, v89
    v_lshl_add_u32 v10, v89, 2, v9
    ds_write_b32 v10, v113
    v_lshl_add_u32 v9, v9, 2, v89
    ds_write_b8_d16_hi v9, v104 offset:16
    v_and_b32 v7, -4, v90
    v_lshl_add_u32 v8, v90, 2, v7
    ds_write_b32 v8, v114
    v_lshl_add_u32 v7, v7, 2, v90
    ds_write_b8 v7, v105 offset:16
    v_and_b32 v9, -4, v91
    v_lshl_add_u32 v10, v91, 2, v9
    ds_write_b32 v10, v115
    v_lshl_add_u32 v9, v9, 2, v91
    ds_write_b8_d16_hi v9, v105 offset:16
    s_cmp_le_u32 s43, 6
    s_cselect_b32 s10, 0, s10
    s_add_u32 s44, s58, 0x9760000
    buffer_load_dwordx4 v[80:83], v0, s[8:11], s44 offen nt
    s_cmp_le_u32 s43, 6
    s_cselect_b32 s14, 0, s14
    s_add_u32 s45, s58, 0x9760000
    buffer_load_dwordx4 v[56:59], v0, s[12:15], s45 offen nt
    v_and_b32 v7, -4, v92
    v_lshl_add_u32 v8, v92, 2, v7
    ds_write_b32 v8, v116
    v_lshl_add_u32 v7, v7, 2, v92
    ds_write_b8 v7, v106 offset:16
    v_and_b32 v9, -4, v93
    v_lshl_add_u32 v10, v93, 2, v9
    ds_write_b32 v10, v117
    v_lshl_add_u32 v9, v9, 2, v93
    ds_write_b8_d16_hi v9, v106 offset:16
    v_and_b32 v7, -4, v94
    v_lshl_add_u32 v8, v94, 2, v7
    ds_write_b32 v8, v118
    v_lshl_add_u32 v7, v7, 2, v94
    ds_write_b8 v7, v107 offset:16
    v_and_b32 v9, -4, v95
    v_lshl_add_u32 v10, v95, 2, v9
    ds_write_b32 v10, v119
    v_lshl_add_u32 v9, v9, 2, v95
    ds_write_b8_d16_hi v9, v107 offset:16
    s_cmp_le_u32 s43, 6
    s_cselect_b32 s18, 0, s18
    s_add_u32 s46, s59, 0x4bb0000
    buffer_load_dwordx2 v[64:65], v1, s[16:19], s46 offen nt
    s_cmp_le_u32 s43, 7
    s_cselect_b32 s18, 0, s18
    s_add_u32 s47, s59, 0x4d10000
    buffer_load_dwordx2 v[66:67], v1, s[16:19], s47 offen nt
    v_add_u32 v7, 0x10000, v0
    v_add_u32 v12, 0x20000, v0
    v_mov_b32 v8, 0
    v_mov_b32 v9, 0
    v_mov_b32 v10, 0
    v_mov_b32 v11, 0
    s_waitcnt lgkmcnt(0)
    s_barrier
    ds_read_b128 v[96:99], v0 offset:0
    ds_write_b128 v0, v[8:11]
    ds_read_b128 v[60:63], v0 offset:16384
    ds_read_b128 v[108:111], v0 offset:32768
    ds_read_b128 v[100:103], v0 offset:49152
    ds_read_b128 v[28:31], v7 offset:0
    ds_read_b128 v[112:115], v7 offset:16384
    ds_read_b128 v[88:91], v7 offset:32768
    ds_read_b128 v[116:119], v7 offset:49152
    ds_read_b128 v[92:95], v12 offset:0
    ds_read_b128 v[104:107], v12 offset:16384
    s_waitcnt lgkmcnt(0)
    s_barrier
    s_add_u32 s44, s35, 0x7ec0000
    buffer_store_dwordx4 v[96:99], v0, s[20:23], s44 offen sc1
    s_cmp_le_u32 s43, 7
    s_cselect_b32 s10, 0, s10
    s_add_u32 s45, s58, 0x9a20000
    buffer_load_dwordx4 v[96:99], v0, s[8:11], s45 offen nt
    s_add_u32 s46, s35, 0x7ec4000
    buffer_store_dwordx4 v[60:63], v0, s[20:23], s46 offen sc1
    s_cmp_le_u32 s43, 7
    s_cselect_b32 s14, 0, s14
    s_add_u32 s47, s58, 0x9a20000
    buffer_load_dwordx4 v[60:63], v0, s[12:15], s47 offen nt
    s_waitcnt vmcnt(29)
    v_lshlrev_b32 v7, 16, v44
    v_and_b32 v8, 0xffff0000, v44
    v_lshlrev_b32 v9, 16, v45
    v_and_b32 v10, 0xffff0000, v45
    v_mul_f32 v7, 0.15915494, v7
    v_mul_f32 v8, 0.15915494, v8
    v_mul_f32 v9, 0.15915494, v9
    v_mul_f32 v10, 0.15915494, v10
    v_mul_hi_u32_u24 v14, 429497, v16
    v_lshrrev_b32 v12, 3, v120
    v_cos_f32 v7, v7
    v_lshlrev_b16 v13, 3, v120
    v_mad_i32_i24 v11, v14, s55, v16
    v_bitop3_b32 v12, v6, v13, v12 bitop3:0xca
    v_add_lshl_u32 v11, v11, s40, 17
    v_lshlrev_b16 v14, 8, v14
    v_lshrrev_b32 v13, 2, v120
    v_or_b32 v16, v12, v11
    v_bitop3_b32 v120, v5, v13, v14 bitop3:0xea
    ds_add_u32 v120, v2
    v_mul_hi_u32_u24 v14, 429497, v17
    v_lshrrev_b32 v12, 3, v121
    v_cos_f32 v8, v8
    v_lshlrev_b16 v13, 3, v121
    v_mad_i32_i24 v11, v14, s55, v17
    v_bitop3_b32 v12, v6, v13, v12 bitop3:0xca
    v_add_lshl_u32 v11, v11, s40, 17
    v_lshlrev_b16 v14, 8, v14
    v_lshrrev_b32 v13, 2, v121
    v_or_b32 v17, v12, v11
    v_bitop3_b32 v121, v5, v13, v14 bitop3:0xea
    ds_add_u32 v121, v2
    v_cvt_pk_bf16_f32 v44, v7, v8
    v_perm_b32 v12, v44, v44, s41
    v_bitop3_b32 v16, v4, v12, v16 bitop3:0xca
    v_perm_b32 v13, v44, v44, s42
    v_bitop3_b32 v17, v4, v13, v17 bitop3:0xca
    v_mul_hi_u32_u24 v14, 429497, v18
    v_lshrrev_b32 v12, 3, v122
    v_cos_f32 v9, v9
    v_lshlrev_b16 v13, 3, v122
    v_mad_i32_i24 v11, v14, s55, v18
    v_bitop3_b32 v12, v6, v13, v12 bitop3:0xca
    v_add_lshl_u32 v11, v11, s40, 17
    v_lshlrev_b16 v14, 8, v14
    v_lshrrev_b32 v13, 2, v122
    v_or_b32 v18, v12, v11
    v_bitop3_b32 v122, v5, v13, v14 bitop3:0xea
    ds_add_u32 v122, v2
    v_mul_hi_u32_u24 v14, 429497, v19
    v_lshrrev_b32 v12, 3, v123
    v_cos_f32 v10, v10
    v_lshlrev_b16 v13, 3, v123
    v_mad_i32_i24 v11, v14, s55, v19
    v_bitop3_b32 v12, v6, v13, v12 bitop3:0xca
    v_add_lshl_u32 v11, v11, s40, 17
    v_lshlrev_b16 v14, 8, v14
    v_lshrrev_b32 v13, 2, v123
    v_or_b32 v19, v12, v11
    v_bitop3_b32 v123, v5, v13, v14 bitop3:0xea
    ds_add_u32 v123, v2
    v_cvt_pk_bf16_f32 v45, v9, v10
    v_perm_b32 v12, v45, v45, s41
    v_bitop3_b32 v18, v4, v12, v18 bitop3:0xca
    v_perm_b32 v13, v45, v45, s42
    v_bitop3_b32 v19, v4, v13, v19 bitop3:0xca
    s_add_u32 s44, s35, 0x7ec8000
    buffer_store_dwordx4 v[108:111], v0, s[20:23], s44 offen sc1
    s_waitcnt vmcnt(24)
    v_lshlrev_b32 v7, 16, v46
    v_and_b32 v8, 0xffff0000, v46
    v_lshlrev_b32 v9, 16, v47
    v_and_b32 v10, 0xffff0000, v47
    v_mul_f32 v7, 0.15915494, v7
    v_mul_f32 v8, 0.15915494, v8
    v_mul_f32 v9, 0.15915494, v9
    v_mul_f32 v10, 0.15915494, v10
    v_mul_hi_u32_u24 v14, 429497, v20
    v_lshrrev_b32 v12, 3, v124
    v_cos_f32 v7, v7
    v_lshlrev_b16 v13, 3, v124
    v_mad_i32_i24 v11, v14, s55, v20
    v_bitop3_b32 v12, v6, v13, v12 bitop3:0xca
    v_add_lshl_u32 v11, v11, s40, 17
    v_lshlrev_b16 v14, 8, v14
    v_lshrrev_b32 v13, 2, v124
    v_or_b32 v20, v12, v11
    v_bitop3_b32 v124, v5, v13, v14 bitop3:0xea
    ds_add_u32 v124, v2
    v_mul_hi_u32_u24 v14, 429497, v21
    v_lshrrev_b32 v12, 3, v125
    v_cos_f32 v8, v8
    v_lshlrev_b16 v13, 3, v125
    v_mad_i32_i24 v11, v14, s55, v21
    v_bitop3_b32 v12, v6, v13, v12 bitop3:0xca
    v_add_lshl_u32 v11, v11, s40, 17
    v_lshlrev_b16 v14, 8, v14
    v_lshrrev_b32 v13, 2, v125
    v_or_b32 v21, v12, v11
    v_bitop3_b32 v125, v5, v13, v14 bitop3:0xea
    ds_add_u32 v125, v2
    v_cvt_pk_bf16_f32 v46, v7, v8
    v_perm_b32 v12, v46, v46, s41
    v_bitop3_b32 v20, v4, v12, v20 bitop3:0xca
    v_perm_b32 v13, v46, v46, s42
    v_bitop3_b32 v21, v4, v13, v21 bitop3:0xca
    v_mul_hi_u32_u24 v14, 429497, v22
    v_lshrrev_b32 v12, 3, v126
    v_cos_f32 v9, v9
    v_lshlrev_b16 v13, 3, v126
    v_mad_i32_i24 v11, v14, s55, v22
    v_bitop3_b32 v12, v6, v13, v12 bitop3:0xca
    v_add_lshl_u32 v11, v11, s40, 17
    v_lshlrev_b16 v14, 8, v14
    v_lshrrev_b32 v13, 2, v126
    v_or_b32 v22, v12, v11
    v_bitop3_b32 v126, v5, v13, v14 bitop3:0xea
    ds_add_u32 v126, v2
    v_mul_hi_u32_u24 v14, 429497, v23
    v_lshrrev_b32 v12, 3, v127
    v_cos_f32 v10, v10
    v_lshlrev_b16 v13, 3, v127
    v_mad_i32_i24 v11, v14, s55, v23
    v_bitop3_b32 v12, v6, v13, v12 bitop3:0xca
    v_add_lshl_u32 v11, v11, s40, 17
    v_lshlrev_b16 v14, 8, v14
    v_lshrrev_b32 v13, 2, v127
    v_or_b32 v23, v12, v11
    v_bitop3_b32 v127, v5, v13, v14 bitop3:0xea
    ds_add_u32 v127, v2
    v_cvt_pk_bf16_f32 v47, v9, v10
    v_perm_b32 v12, v47, v47, s41
    v_bitop3_b32 v22, v4, v12, v22 bitop3:0xca
    v_perm_b32 v13, v47, v47, s42
    v_bitop3_b32 v23, v4, v13, v23 bitop3:0xca
    s_waitcnt vmcnt(19)
    v_lshlrev_b32 v7, 16, v32
    v_and_b32 v8, 0xffff0000, v32
    v_lshlrev_b32 v9, 16, v33
    v_and_b32 v10, 0xffff0000, v33
    v_mul_f32 v7, 0.15915494, v7
    v_mul_f32 v8, 0.15915494, v8
    v_mul_f32 v9, 0.15915494, v9
    v_mul_f32 v10, 0.15915494, v10
    v_mul_hi_u32_u24 v14, 429497, v40
    v_lshrrev_b32 v12, 3, v24
    v_cos_f32 v7, v7
    v_lshlrev_b16 v13, 3, v24
    v_mad_i32_i24 v11, v14, s55, v40
    v_bitop3_b32 v12, v6, v13, v12 bitop3:0xca
    v_add_lshl_u32 v11, v11, s40, 17
    v_lshlrev_b16 v14, 8, v14
    v_lshrrev_b32 v13, 2, v24
    v_or_b32 v40, v12, v11
    v_bitop3_b32 v24, v5, v13, v14 bitop3:0xea
    ds_add_u32 v24, v2
    v_mul_hi_u32_u24 v14, 429497, v41
    v_lshrrev_b32 v12, 3, v25
    v_cos_f32 v8, v8
    v_lshlrev_b16 v13, 3, v25
    v_mad_i32_i24 v11, v14, s55, v41
    v_bitop3_b32 v12, v6, v13, v12 bitop3:0xca
    v_add_lshl_u32 v11, v11, s40, 17
    v_lshlrev_b16 v14, 8, v14
    v_lshrrev_b32 v13, 2, v25
    v_or_b32 v41, v12, v11
    v_bitop3_b32 v25, v5, v13, v14 bitop3:0xea
    ds_add_u32 v25, v2
    v_cvt_pk_bf16_f32 v32, v7, v8
    v_perm_b32 v12, v32, v32, s41
    v_bitop3_b32 v40, v4, v12, v40 bitop3:0xca
    v_perm_b32 v13, v32, v32, s42
    v_bitop3_b32 v41, v4, v13, v41 bitop3:0xca
    v_mul_hi_u32_u24 v14, 429497, v42
    v_lshrrev_b32 v12, 3, v26
    v_cos_f32 v9, v9
    v_lshlrev_b16 v13, 3, v26
    v_mad_i32_i24 v11, v14, s55, v42
    v_bitop3_b32 v12, v6, v13, v12 bitop3:0xca
    v_add_lshl_u32 v11, v11, s40, 17
    v_lshlrev_b16 v14, 8, v14
    v_lshrrev_b32 v13, 2, v26
    v_or_b32 v42, v12, v11
    v_bitop3_b32 v26, v5, v13, v14 bitop3:0xea
    ds_add_u32 v26, v2
    v_mul_hi_u32_u24 v14, 429497, v43
    v_lshrrev_b32 v12, 3, v27
    v_cos_f32 v10, v10
    v_lshlrev_b16 v13, 3, v27
    v_mad_i32_i24 v11, v14, s55, v43
    v_bitop3_b32 v12, v6, v13, v12 bitop3:0xca
    v_add_lshl_u32 v11, v11, s40, 17
    v_lshlrev_b16 v14, 8, v14
    v_lshrrev_b32 v13, 2, v27
    v_or_b32 v43, v12, v11
    v_bitop3_b32 v27, v5, v13, v14 bitop3:0xea
    ds_add_u32 v27, v2
    v_cvt_pk_bf16_f32 v33, v9, v10
    v_perm_b32 v12, v33, v33, s41
    v_bitop3_b32 v42, v4, v12, v42 bitop3:0xca
    v_perm_b32 v13, v33, v33, s42
    v_bitop3_b32 v43, v4, v13, v43 bitop3:0xca
    s_waitcnt vmcnt(16)
    v_lshlrev_b32 v7, 16, v34
    v_and_b32 v8, 0xffff0000, v34
    v_lshlrev_b32 v9, 16, v35
    v_and_b32 v10, 0xffff0000, v35
    v_mul_f32 v7, 0.15915494, v7
    v_mul_f32 v8, 0.15915494, v8
    v_mul_f32 v9, 0.15915494, v9
    v_mul_f32 v10, 0.15915494, v10
    v_mul_hi_u32_u24 v14, 429497, v48
    v_lshrrev_b32 v12, 3, v52
    v_cos_f32 v7, v7
    v_lshlrev_b16 v13, 3, v52
    v_mad_i32_i24 v11, v14, s55, v48
    v_bitop3_b32 v12, v6, v13, v12 bitop3:0xca
    v_add_lshl_u32 v11, v11, s40, 17
    v_lshlrev_b16 v14, 8, v14
    v_lshrrev_b32 v13, 2, v52
    v_or_b32 v48, v12, v11
    v_bitop3_b32 v52, v5, v13, v14 bitop3:0xea
    ds_add_u32 v52, v2
    v_mul_hi_u32_u24 v14, 429497, v49
    v_lshrrev_b32 v12, 3, v53
    v_cos_f32 v8, v8
    v_lshlrev_b16 v13, 3, v53
    v_mad_i32_i24 v11, v14, s55, v49
    v_bitop3_b32 v12, v6, v13, v12 bitop3:0xca
    v_add_lshl_u32 v11, v11, s40, 17
    v_lshlrev_b16 v14, 8, v14
    v_lshrrev_b32 v13, 2, v53
    v_or_b32 v49, v12, v11
    v_bitop3_b32 v53, v5, v13, v14 bitop3:0xea
    ds_add_u32 v53, v2
    v_cvt_pk_bf16_f32 v34, v7, v8
    v_perm_b32 v12, v34, v34, s41
    v_bitop3_b32 v48, v4, v12, v48 bitop3:0xca
    v_perm_b32 v13, v34, v34, s42
    v_bitop3_b32 v49, v4, v13, v49 bitop3:0xca
    v_mul_hi_u32_u24 v14, 429497, v50
    v_lshrrev_b32 v12, 3, v54
    v_cos_f32 v9, v9
    v_lshlrev_b16 v13, 3, v54
    v_mad_i32_i24 v11, v14, s55, v50
    v_bitop3_b32 v12, v6, v13, v12 bitop3:0xca
    v_add_lshl_u32 v11, v11, s40, 17
    v_lshlrev_b16 v14, 8, v14
    v_lshrrev_b32 v13, 2, v54
    v_or_b32 v50, v12, v11
    v_bitop3_b32 v54, v5, v13, v14 bitop3:0xea
    ds_add_u32 v54, v2
    v_mul_hi_u32_u24 v14, 429497, v51
    v_lshrrev_b32 v12, 3, v55
    v_cos_f32 v10, v10
    v_lshlrev_b16 v13, 3, v55
    v_mad_i32_i24 v11, v14, s55, v51
    v_bitop3_b32 v12, v6, v13, v12 bitop3:0xca
    v_add_lshl_u32 v11, v11, s40, 17
    v_lshlrev_b16 v14, 8, v14
    v_lshrrev_b32 v13, 2, v55
    v_or_b32 v51, v12, v11
    v_bitop3_b32 v55, v5, v13, v14 bitop3:0xea
    ds_add_u32 v55, v2
    v_cvt_pk_bf16_f32 v35, v9, v10
    v_perm_b32 v12, v35, v35, s41
    v_bitop3_b32 v50, v4, v12, v50 bitop3:0xca
    v_perm_b32 v13, v35, v35, s42
    v_bitop3_b32 v51, v4, v13, v51 bitop3:0xca
    s_add_u32 s45, s35, 0x7ecc000
    buffer_store_dwordx4 v[100:103], v0, s[20:23], s45 offen sc1
    buffer_load_dwordx4 v[108:111], v0, s[80:83], 0 offen
    v_add_u32 v15, 0x4000, v0
    buffer_load_dwordx4 v[108:111], v15, s[80:83], 0 offen
    s_waitcnt vmcnt(15)
    v_lshlrev_b32 v7, 16, v72
    v_and_b32 v8, 0xffff0000, v72
    v_lshlrev_b32 v9, 16, v73
    v_and_b32 v10, 0xffff0000, v73
    v_mul_f32 v7, 0.15915494, v7
    v_mul_f32 v8, 0.15915494, v8
    v_mul_f32 v9, 0.15915494, v9
    v_mul_f32 v10, 0.15915494, v10
    v_mul_hi_u32_u24 v14, 429497, v84
    v_lshrrev_b32 v12, 3, v68
    v_cos_f32 v7, v7
    v_lshlrev_b16 v13, 3, v68
    v_mad_i32_i24 v11, v14, s55, v84
    v_bitop3_b32 v12, v6, v13, v12 bitop3:0xca
    v_add_lshl_u32 v11, v11, s40, 17
    v_lshlrev_b16 v14, 8, v14
    v_lshrrev_b32 v13, 2, v68
    v_or_b32 v84, v12, v11
    v_bitop3_b32 v68, v5, v13, v14 bitop3:0xea
    ds_add_u32 v68, v2
    v_mul_hi_u32_u24 v14, 429497, v85
    v_lshrrev_b32 v12, 3, v69
    v_cos_f32 v8, v8
    v_lshlrev_b16 v13, 3, v69
    v_mad_i32_i24 v11, v14, s55, v85
    v_bitop3_b32 v12, v6, v13, v12 bitop3:0xca
    v_add_lshl_u32 v11, v11, s40, 17
    v_lshlrev_b16 v14, 8, v14
    v_lshrrev_b32 v13, 2, v69
    v_or_b32 v85, v12, v11
    v_bitop3_b32 v69, v5, v13, v14 bitop3:0xea
    ds_add_u32 v69, v2
    v_cvt_pk_bf16_f32 v72, v7, v8
    v_perm_b32 v12, v72, v72, s41
    v_bitop3_b32 v84, v4, v12, v84 bitop3:0xca
    v_perm_b32 v13, v72, v72, s42
    v_bitop3_b32 v85, v4, v13, v85 bitop3:0xca
    v_mul_hi_u32_u24 v14, 429497, v86
    v_lshrrev_b32 v12, 3, v70
    v_cos_f32 v9, v9
    v_lshlrev_b16 v13, 3, v70
    v_mad_i32_i24 v11, v14, s55, v86
    v_bitop3_b32 v12, v6, v13, v12 bitop3:0xca
    v_add_lshl_u32 v11, v11, s40, 17
    v_lshlrev_b16 v14, 8, v14
    v_lshrrev_b32 v13, 2, v70
    v_or_b32 v86, v12, v11
    v_bitop3_b32 v70, v5, v13, v14 bitop3:0xea
    ds_add_u32 v70, v2
    v_mul_hi_u32_u24 v14, 429497, v87
    v_lshrrev_b32 v12, 3, v71
    v_cos_f32 v10, v10
    v_lshlrev_b16 v13, 3, v71
    v_mad_i32_i24 v11, v14, s55, v87
    v_bitop3_b32 v12, v6, v13, v12 bitop3:0xca
    v_add_lshl_u32 v11, v11, s40, 17
    v_lshlrev_b16 v14, 8, v14
    v_lshrrev_b32 v13, 2, v71
    v_or_b32 v87, v12, v11
    v_bitop3_b32 v71, v5, v13, v14 bitop3:0xea
    ds_add_u32 v71, v2
    v_cvt_pk_bf16_f32 v73, v9, v10
    v_perm_b32 v12, v73, v73, s41
    v_bitop3_b32 v86, v4, v12, v86 bitop3:0xca
    v_perm_b32 v13, v73, v73, s42
    v_bitop3_b32 v87, v4, v13, v87 bitop3:0xca
    s_waitcnt vmcnt(12)
    s_cmp_le_u32 s43, 5
    s_cbranch_scc1 L1_s1
    v_lshlrev_b32 v7, 16, v74
    v_and_b32 v8, 0xffff0000, v74
    v_lshlrev_b32 v9, 16, v75
    v_and_b32 v10, 0xffff0000, v75
    v_mul_f32 v7, 0.15915494, v7
    v_mul_f32 v8, 0.15915494, v8
    v_mul_f32 v9, 0.15915494, v9
    v_mul_f32 v10, 0.15915494, v10
    v_mul_hi_u32_u24 v14, 429497, v36
    v_lshrrev_b32 v12, 3, v76
    v_cos_f32 v7, v7
    v_lshlrev_b16 v13, 3, v76
    v_mad_i32_i24 v11, v14, s55, v36
    v_bitop3_b32 v12, v6, v13, v12 bitop3:0xca
    v_add_lshl_u32 v11, v11, s40, 17
    v_lshlrev_b16 v14, 8, v14
    v_lshrrev_b32 v13, 2, v76
    v_or_b32 v36, v12, v11
    v_bitop3_b32 v76, v5, v13, v14 bitop3:0xea
    ds_add_u32 v76, v2
    v_mul_hi_u32_u24 v14, 429497, v37
    v_lshrrev_b32 v12, 3, v77
    v_cos_f32 v8, v8
    v_lshlrev_b16 v13, 3, v77
    v_mad_i32_i24 v11, v14, s55, v37
    v_bitop3_b32 v12, v6, v13, v12 bitop3:0xca
    v_add_lshl_u32 v11, v11, s40, 17
    v_lshlrev_b16 v14, 8, v14
    v_lshrrev_b32 v13, 2, v77
    v_or_b32 v37, v12, v11
    v_bitop3_b32 v77, v5, v13, v14 bitop3:0xea
    ds_add_u32 v77, v2
    v_cvt_pk_bf16_f32 v74, v7, v8
    v_perm_b32 v12, v74, v74, s41
    v_bitop3_b32 v36, v4, v12, v36 bitop3:0xca
    v_perm_b32 v13, v74, v74, s42
    v_bitop3_b32 v37, v4, v13, v37 bitop3:0xca
    v_mul_hi_u32_u24 v14, 429497, v38
    v_lshrrev_b32 v12, 3, v78
    v_cos_f32 v9, v9
    v_lshlrev_b16 v13, 3, v78
    v_mad_i32_i24 v11, v14, s55, v38
    v_bitop3_b32 v12, v6, v13, v12 bitop3:0xca
    v_add_lshl_u32 v11, v11, s40, 17
    v_lshlrev_b16 v14, 8, v14
    v_lshrrev_b32 v13, 2, v78
    v_or_b32 v38, v12, v11
    v_bitop3_b32 v78, v5, v13, v14 bitop3:0xea
    ds_add_u32 v78, v2
    v_mul_hi_u32_u24 v14, 429497, v39
    v_lshrrev_b32 v12, 3, v79
    v_cos_f32 v10, v10
    v_lshlrev_b16 v13, 3, v79
    v_mad_i32_i24 v11, v14, s55, v39
    v_bitop3_b32 v12, v6, v13, v12 bitop3:0xca
    v_add_lshl_u32 v11, v11, s40, 17
    v_lshlrev_b16 v14, 8, v14
    v_lshrrev_b32 v13, 2, v79
    v_or_b32 v39, v12, v11
    v_bitop3_b32 v79, v5, v13, v14 bitop3:0xea
    ds_add_u32 v79, v2
    v_cvt_pk_bf16_f32 v75, v9, v10
    v_perm_b32 v12, v75, v75, s41
    v_bitop3_b32 v38, v4, v12, v38 bitop3:0xca
    v_perm_b32 v13, v75, v75, s42
    v_bitop3_b32 v39, v4, v13, v39 bitop3:0xca
L1_s1:
    s_waitcnt vmcnt(8)
    s_cmp_le_u32 s43, 6
    s_cbranch_scc1 L1_s2
    v_lshlrev_b32 v7, 16, v64
    v_and_b32 v8, 0xffff0000, v64
    v_lshlrev_b32 v9, 16, v65
    v_and_b32 v10, 0xffff0000, v65
    v_mul_f32 v7, 0.15915494, v7
    v_mul_f32 v8, 0.15915494, v8
    v_mul_f32 v9, 0.15915494, v9
    v_mul_f32 v10, 0.15915494, v10
    v_mul_hi_u32_u24 v14, 429497, v80
    v_lshrrev_b32 v12, 3, v56
    v_cos_f32 v7, v7
    v_lshlrev_b16 v13, 3, v56
    v_mad_i32_i24 v11, v14, s55, v80
    v_bitop3_b32 v12, v6, v13, v12 bitop3:0xca
    v_add_lshl_u32 v11, v11, s40, 17
    v_lshlrev_b16 v14, 8, v14
    v_lshrrev_b32 v13, 2, v56
    v_or_b32 v80, v12, v11
    v_bitop3_b32 v56, v5, v13, v14 bitop3:0xea
    ds_add_u32 v56, v2
    v_mul_hi_u32_u24 v14, 429497, v81
    v_lshrrev_b32 v12, 3, v57
    v_cos_f32 v8, v8
    v_lshlrev_b16 v13, 3, v57
    v_mad_i32_i24 v11, v14, s55, v81
    v_bitop3_b32 v12, v6, v13, v12 bitop3:0xca
    v_add_lshl_u32 v11, v11, s40, 17
    v_lshlrev_b16 v14, 8, v14
    v_lshrrev_b32 v13, 2, v57
    v_or_b32 v81, v12, v11
    v_bitop3_b32 v57, v5, v13, v14 bitop3:0xea
    ds_add_u32 v57, v2
    v_cvt_pk_bf16_f32 v64, v7, v8
    v_perm_b32 v12, v64, v64, s41
    v_bitop3_b32 v80, v4, v12, v80 bitop3:0xca
    v_perm_b32 v13, v64, v64, s42
    v_bitop3_b32 v81, v4, v13, v81 bitop3:0xca
    v_mul_hi_u32_u24 v14, 429497, v82
    v_lshrrev_b32 v12, 3, v58
    v_cos_f32 v9, v9
    v_lshlrev_b16 v13, 3, v58
    v_mad_i32_i24 v11, v14, s55, v82
    v_bitop3_b32 v12, v6, v13, v12 bitop3:0xca
    v_add_lshl_u32 v11, v11, s40, 17
    v_lshlrev_b16 v14, 8, v14
    v_lshrrev_b32 v13, 2, v58
    v_or_b32 v82, v12, v11
    v_bitop3_b32 v58, v5, v13, v14 bitop3:0xea
    ds_add_u32 v58, v2
    v_mul_hi_u32_u24 v14, 429497, v83
    v_lshrrev_b32 v12, 3, v59
    v_cos_f32 v10, v10
    v_lshlrev_b16 v13, 3, v59
    v_mad_i32_i24 v11, v14, s55, v83
    v_bitop3_b32 v12, v6, v13, v12 bitop3:0xca
    v_add_lshl_u32 v11, v11, s40, 17
    v_lshlrev_b16 v14, 8, v14
    v_lshrrev_b32 v13, 2, v59
    v_or_b32 v83, v12, v11
    v_bitop3_b32 v59, v5, v13, v14 bitop3:0xea
    ds_add_u32 v59, v2
    v_cvt_pk_bf16_f32 v65, v9, v10
    v_perm_b32 v12, v65, v65, s41
    v_bitop3_b32 v82, v4, v12, v82 bitop3:0xca
    v_perm_b32 v13, v65, v65, s42
    v_bitop3_b32 v83, v4, v13, v83 bitop3:0xca
L1_s2:
    s_waitcnt vmcnt(4)
    s_cmp_le_u32 s43, 7
    s_cbranch_scc1 L1_s3
    v_lshlrev_b32 v7, 16, v66
    v_and_b32 v8, 0xffff0000, v66
    v_lshlrev_b32 v9, 16, v67
    v_and_b32 v10, 0xffff0000, v67
    v_mul_f32 v7, 0.15915494, v7
    v_mul_f32 v8, 0.15915494, v8
    v_mul_f32 v9, 0.15915494, v9
    v_mul_f32 v10, 0.15915494, v10
    v_mul_hi_u32_u24 v14, 429497, v96
    v_lshrrev_b32 v12, 3, v60
    v_cos_f32 v7, v7
    v_lshlrev_b16 v13, 3, v60
    v_mad_i32_i24 v11, v14, s55, v96
    v_bitop3_b32 v12, v6, v13, v12 bitop3:0xca
    v_add_lshl_u32 v11, v11, s40, 17
    v_lshlrev_b16 v14, 8, v14
    v_lshrrev_b32 v13, 2, v60
    v_or_b32 v96, v12, v11
    v_bitop3_b32 v60, v5, v13, v14 bitop3:0xea
    ds_add_u32 v60, v2
    v_mul_hi_u32_u24 v14, 429497, v97
    v_lshrrev_b32 v12, 3, v61
    v_cos_f32 v8, v8
    v_lshlrev_b16 v13, 3, v61
    v_mad_i32_i24 v11, v14, s55, v97
    v_bitop3_b32 v12, v6, v13, v12 bitop3:0xca
    v_add_lshl_u32 v11, v11, s40, 17
    v_lshlrev_b16 v14, 8, v14
    v_lshrrev_b32 v13, 2, v61
    v_or_b32 v97, v12, v11
    v_bitop3_b32 v61, v5, v13, v14 bitop3:0xea
    ds_add_u32 v61, v2
    v_cvt_pk_bf16_f32 v66, v7, v8
    v_perm_b32 v12, v66, v66, s41
    v_bitop3_b32 v96, v4, v12, v96 bitop3:0xca
    v_perm_b32 v13, v66, v66, s42
    v_bitop3_b32 v97, v4, v13, v97 bitop3:0xca
    v_mul_hi_u32_u24 v14, 429497, v98
    v_lshrrev_b32 v12, 3, v62
    v_cos_f32 v9, v9
    v_lshlrev_b16 v13, 3, v62
    v_mad_i32_i24 v11, v14, s55, v98
    v_bitop3_b32 v12, v6, v13, v12 bitop3:0xca
    v_add_lshl_u32 v11, v11, s40, 17
    v_lshlrev_b16 v14, 8, v14
    v_lshrrev_b32 v13, 2, v62
    v_or_b32 v98, v12, v11
    v_bitop3_b32 v62, v5, v13, v14 bitop3:0xea
    ds_add_u32 v62, v2
    v_mul_hi_u32_u24 v14, 429497, v99
    v_lshrrev_b32 v12, 3, v63
    v_cos_f32 v10, v10
    v_lshlrev_b16 v13, 3, v63
    v_mad_i32_i24 v11, v14, s55, v99
    v_bitop3_b32 v12, v6, v13, v12 bitop3:0xca
    v_add_lshl_u32 v11, v11, s40, 17
    v_lshlrev_b16 v14, 8, v14
    v_lshrrev_b32 v13, 2, v63
    v_or_b32 v99, v12, v11
    v_bitop3_b32 v63, v5, v13, v14 bitop3:0xea
    ds_add_u32 v63, v2
    v_cvt_pk_bf16_f32 v67, v9, v10
    v_perm_b32 v12, v67, v67, s41
    v_bitop3_b32 v98, v4, v12, v98 bitop3:0xca
    v_perm_b32 v13, v67, v67, s42
    v_bitop3_b32 v99, v4, v13, v99 bitop3:0xca
L1_s3:
    v_lshrrev_b32 v8, 2, v0
    v_and_b32 v7, 0x3c00, v0
    v_bitop3_b32 v7, v5, v8, v7 bitop3:0xea
    s_waitcnt lgkmcnt(0)
    s_barrier
    ds_read2st64_b32 v[8:9], v7 offset0:0 offset1:1
    ds_read2st64_b32 v[10:11], v7 offset0:2 offset1:3
    s_add_u32 s46, s35, 0x7ed0000
    buffer_store_dwordx4 v[28:31], v0, s[20:23], s46 offen sc1
    s_waitcnt lgkmcnt(0)
    v_lshl_or_b32 v12, v9, 16, v8
    v_lshl_or_b32 v13, v11, 16, v10
    v_mov_b32 v14, v12
    v_mov_b32 v15, v13
    s_nop 0
    v_add_u32_dpp v14, v14, v14 row_shr:1 row_mask:0xf bank_mask:0xf bound_ctrl:1
    v_add_u32_dpp v15, v15, v15 row_shr:1 row_mask:0xf bank_mask:0xf bound_ctrl:1
    s_nop 0
    v_add_u32_dpp v14, v14, v14 row_shr:2 row_mask:0xf bank_mask:0xf bound_ctrl:1
    v_add_u32_dpp v15, v15, v15 row_shr:2 row_mask:0xf bank_mask:0xf bound_ctrl:1
    s_nop 0
    v_add_u32_dpp v14, v14, v14 row_shr:4 row_mask:0xf bank_mask:0xf bound_ctrl:1
    v_add_u32_dpp v15, v15, v15 row_shr:4 row_mask:0xf bank_mask:0xf bound_ctrl:1
    s_nop 0
    v_add_u32_dpp v14, v14, v14 row_shr:8 row_mask:0xf bank_mask:0xf bound_ctrl:1
    v_add_u32_dpp v15, v15, v15 row_shr:8 row_mask:0xf bank_mask:0xf bound_ctrl:1
    s_nop 0
    v_add_u32_dpp v14, v14, v14 row_bcast:15 row_mask:0xa bank_mask:0xf
    v_add_u32_dpp v15, v15, v15 row_bcast:15 row_mask:0xa bank_mask:0xf
    s_nop 0
    v_add_u32_dpp v14, v14, v14 row_bcast:31 row_mask:0xc bank_mask:0xf
    v_add_u32_dpp v15, v15, v15 row_bcast:31 row_mask:0xc bank_mask:0xf
    v_readlane_b32 s48, v14, 63
    v_readlane_b32 s49, v15, 63
    s_lshl_b32 s54, s32, 2
    v_mov_b32 v8, s54
    s_and_b32 s50, s48, 0xffff
    s_lshr_b32 s51, s48, 16
    s_and_b32 s52, s49, 0xffff
    s_lshr_b32 s53, s49, 16
    s_add_u32 s51, s51, s50
    s_add_u32 s52, s52, s51
    s_add_u32 s53, s53, s52
    v_mov_b32 v9, s53
    s_mov_b64 exec, 1
    ds_write_b32 v8, v9 offset:16384
    s_mov_b64 exec, -1
    v_and_b32 v8, 60, v7
    s_waitcnt lgkmcnt(0)
    s_barrier
    ds_read_b32 v9, v8 offset:16384
    s_waitcnt lgkmcnt(0)
    v_add_u32_dpp v9, v9, v9 row_shr:1 row_mask:0xf bank_mask:0xf bound_ctrl:1
    s_nop 1
    v_add_u32_dpp v9, v9, v9 row_shr:2 row_mask:0xf bank_mask:0xf bound_ctrl:1
    s_nop 1
    v_add_u32_dpp v9, v9, v9 row_shr:4 row_mask:0xf bank_mask:0xf bound_ctrl:1
    s_nop 1
    v_add_u32_dpp v9, v9, v9 row_shr:8 row_mask:0xf bank_mask:0xf bound_ctrl:1
    s_nop 0
    v_readlane_b32 s54, v9, s32
    s_sub_u32 s54, s54, s53
    s_add_u32 s50, s50, s54
    s_add_u32 s51, s51, s54
    s_add_u32 s52, s52, s54
    s_pack_ll_b32_b16 s48, s54, s50
    s_pack_ll_b32_b16 s49, s51, s52
    v_add_u32 v14, s48, v14
    v_add_u32 v15, s49, v15
    v_sub_u32 v12, v14, v12
    v_sub_u32 v13, v15, v13
    v_and_b32 v8, 0xffff, v12
    v_lshrrev_b32 v9, 16, v12
    v_and_b32 v10, 0xffff, v13
    v_lshrrev_b32 v11, 16, v13
    ds_write2st64_b32 v7, v8, v9 offset0:0 offset1:1
    ds_write2st64_b32 v7, v10, v11 offset0:2 offset1:3
    s_waitcnt lgkmcnt(0)
    s_barrier
    ds_add_rtn_u32 v120, v120, v2
    ds_add_rtn_u32 v121, v121, v2
    ds_add_rtn_u32 v122, v122, v2
    ds_add_rtn_u32 v123, v123, v2
    s_add_u32 s47, s36, 0xa900000
    v_and_b32 v11, 0x3f0, v0
    v_add_u32 v11, v11, v11
    buffer_store_dwordx2 v[12:13], v11, s[24:27], s47 offen
    s_bitset0_b64 exec, 63
    s_not_b64 exec, exec
    buffer_store_dwordx2 v[14:15], v11, s[24:27], s47 offen offset:32
    s_mov_b64 exec, -1
    ds_add_rtn_u32 v124, v124, v2
    ds_add_rtn_u32 v125, v125, v2
    ds_add_rtn_u32 v126, v126, v2
    ds_add_rtn_u32 v127, v127, v2
    ds_add_rtn_u32 v24, v24, v2
    ds_add_rtn_u32 v25, v25, v2
    ds_add_rtn_u32 v26, v26, v2
    ds_add_rtn_u32 v27, v27, v2
    s_add_u32 s44, s35, 0x7ed4000
    buffer_store_dwordx4 v[112:115], v0, s[20:23], s44 offen sc1
    ds_add_rtn_u32 v52, v52, v2
    ds_add_rtn_u32 v53, v53, v2
    ds_add_rtn_u32 v54, v54, v2
    ds_add_rtn_u32 v55, v55, v2
    ds_add_rtn_u32 v68, v68, v2
    ds_add_rtn_u32 v69, v69, v2
    ds_add_rtn_u32 v70, v70, v2
    ds_add_rtn_u32 v71, v71, v2
    s_cmp_le_u32 s43, 5
    s_cbranch_scc1 L1_s4
    ds_add_rtn_u32 v76, v76, v2
    ds_add_rtn_u32 v77, v77, v2
    ds_add_rtn_u32 v78, v78, v2
    ds_add_rtn_u32 v79, v79, v2
L1_s4:
    s_add_u32 s45, s35, 0x7ed8000
    buffer_store_dwordx4 v[88:91], v0, s[20:23], s45 offen sc1
    s_cmp_le_u32 s43, 6
    s_cbranch_scc1 L1_s5
    ds_add_rtn_u32 v56, v56, v2
    ds_add_rtn_u32 v57, v57, v2
    ds_add_rtn_u32 v58, v58, v2
    ds_add_rtn_u32 v59, v59, v2
L1_s5:
    s_cmp_le_u32 s43, 7
    s_cbranch_scc1 L1_s6
    ds_add_rtn_u32 v60, v60, v2
    ds_add_rtn_u32 v61, v61, v2
    ds_add_rtn_u32 v62, v62, v2
    ds_add_rtn_u32 v63, v63, v2
L1_s6:
    s_waitcnt lgkmcnt(0)
    s_barrier
    v_and_b32 v7, -4, v120
    v_lshl_add_u32 v8, v120, 2, v7
    ds_write_b32 v8, v16
    v_lshl_add_u32 v7, v7, 2, v120
    ds_write_b8 v7, v44 offset:16
    v_and_b32 v9, -4, v121
    v_lshl_add_u32 v10, v121, 2, v9
    ds_write_b32 v10, v17
    v_lshl_add_u32 v9, v9, 2, v121
    ds_write_b8_d16_hi v9, v44 offset:16
    v_and_b32 v7, -4, v122
    v_lshl_add_u32 v8, v122, 2, v7
    ds_write_b32 v8, v18
    v_lshl_add_u32 v7, v7, 2, v122
    ds_write_b8 v7, v45 offset:16
    v_and_b32 v9, -4, v123
    v_lshl_add_u32 v10, v123, 2, v9
    ds_write_b32 v10, v19
    v_lshl_add_u32 v9, v9, 2, v123
    ds_write_b8_d16_hi v9, v45 offset:16
    s_add_u32 s46, s35, 0x7edc000
    buffer_store_dwordx4 v[116:119], v0, s[20:23], s46 offen sc1
    v_and_b32 v7, -4, v124
    v_lshl_add_u32 v8, v124, 2, v7
    ds_write_b32 v8, v20
    v_lshl_add_u32 v7, v7, 2, v124
    ds_write_b8 v7, v46 offset:16
    v_and_b32 v9, -4, v125
    v_lshl_add_u32 v10, v125, 2, v9
    ds_write_b32 v10, v21
    v_lshl_add_u32 v9, v9, 2, v125
    ds_write_b8_d16_hi v9, v46 offset:16
    v_and_b32 v7, -4, v126
    v_lshl_add_u32 v8, v126, 2, v7
    ds_write_b32 v8, v22
    v_lshl_add_u32 v7, v7, 2, v126
    ds_write_b8 v7, v47 offset:16
    v_and_b32 v9, -4, v127
    v_lshl_add_u32 v10, v127, 2, v9
    ds_write_b32 v10, v23
    v_lshl_add_u32 v9, v9, 2, v127
    ds_write_b8_d16_hi v9, v47 offset:16
    v_and_b32 v7, -4, v24
    v_lshl_add_u32 v8, v24, 2, v7
    ds_write_b32 v8, v40
    v_lshl_add_u32 v7, v7, 2, v24
    ds_write_b8 v7, v32 offset:16
    v_and_b32 v9, -4, v25
    v_lshl_add_u32 v10, v25, 2, v9
    ds_write_b32 v10, v41
    v_lshl_add_u32 v9, v9, 2, v25
    ds_write_b8_d16_hi v9, v32 offset:16
    v_and_b32 v7, -4, v26
    v_lshl_add_u32 v8, v26, 2, v7
    ds_write_b32 v8, v42
    v_lshl_add_u32 v7, v7, 2, v26
    ds_write_b8 v7, v33 offset:16
    v_and_b32 v9, -4, v27
    v_lshl_add_u32 v10, v27, 2, v9
    ds_write_b32 v10, v43
    v_lshl_add_u32 v9, v9, 2, v27
    ds_write_b8_d16_hi v9, v33 offset:16
    s_add_u32 s47, s35, 0x7ee0000
    buffer_store_dwordx4 v[92:95], v0, s[20:23], s47 offen sc1
    v_and_b32 v7, -4, v52
    v_lshl_add_u32 v8, v52, 2, v7
    ds_write_b32 v8, v48
    v_lshl_add_u32 v7, v7, 2, v52
    ds_write_b8 v7, v34 offset:16
    v_and_b32 v9, -4, v53
    v_lshl_add_u32 v10, v53, 2, v9
    ds_write_b32 v10, v49
    v_lshl_add_u32 v9, v9, 2, v53
    ds_write_b8_d16_hi v9, v34 offset:16
    v_and_b32 v7, -4, v54
    v_lshl_add_u32 v8, v54, 2, v7
    ds_write_b32 v8, v50
    v_lshl_add_u32 v7, v7, 2, v54
    ds_write_b8 v7, v35 offset:16
    v_and_b32 v9, -4, v55
    v_lshl_add_u32 v10, v55, 2, v9
    ds_write_b32 v10, v51
    v_lshl_add_u32 v9, v9, 2, v55
    ds_write_b8_d16_hi v9, v35 offset:16
    v_and_b32 v7, -4, v68
    v_lshl_add_u32 v8, v68, 2, v7
    ds_write_b32 v8, v84
    v_lshl_add_u32 v7, v7, 2, v68
    ds_write_b8 v7, v72 offset:16
    v_and_b32 v9, -4, v69
    v_lshl_add_u32 v10, v69, 2, v9
    ds_write_b32 v10, v85
    v_lshl_add_u32 v9, v9, 2, v69
    ds_write_b8_d16_hi v9, v72 offset:16
    v_and_b32 v7, -4, v70
    v_lshl_add_u32 v8, v70, 2, v7
    ds_write_b32 v8, v86
    v_lshl_add_u32 v7, v7, 2, v70
    ds_write_b8 v7, v73 offset:16
    v_and_b32 v9, -4, v71
    v_lshl_add_u32 v10, v71, 2, v9
    ds_write_b32 v10, v87
    v_lshl_add_u32 v9, v9, 2, v71
    ds_write_b8_d16_hi v9, v73 offset:16
    s_cmp_le_u32 s43, 5
    s_cbranch_scc1 L1_s7
    v_and_b32 v7, -4, v76
    v_lshl_add_u32 v8, v76, 2, v7
    ds_write_b32 v8, v36
    v_lshl_add_u32 v7, v7, 2, v76
    ds_write_b8 v7, v74 offset:16
    v_and_b32 v9, -4, v77
    v_lshl_add_u32 v10, v77, 2, v9
    ds_write_b32 v10, v37
    v_lshl_add_u32 v9, v9, 2, v77
    ds_write_b8_d16_hi v9, v74 offset:16
    v_and_b32 v7, -4, v78
    v_lshl_add_u32 v8, v78, 2, v7
    ds_write_b32 v8, v38
    v_lshl_add_u32 v7, v7, 2, v78
    ds_write_b8 v7, v75 offset:16
    v_and_b32 v9, -4, v79
    v_lshl_add_u32 v10, v79, 2, v9
    ds_write_b32 v10, v39
    v_lshl_add_u32 v9, v9, 2, v79
    ds_write_b8_d16_hi v9, v75 offset:16
L1_s7:
    s_add_u32 s44, s35, 0x7ee4000
    buffer_store_dwordx4 v[104:107], v0, s[20:23], s44 offen sc1
    s_cmp_le_u32 s43, 6
    s_cbranch_scc1 L1_s8
    v_and_b32 v7, -4, v56
    v_lshl_add_u32 v8, v56, 2, v7
    ds_write_b32 v8, v80
    v_lshl_add_u32 v7, v7, 2, v56
    ds_write_b8 v7, v64 offset:16
    v_and_b32 v9, -4, v57
    v_lshl_add_u32 v10, v57, 2, v9
    ds_write_b32 v10, v81
    v_lshl_add_u32 v9, v9, 2, v57
    ds_write_b8_d16_hi v9, v64 offset:16
    v_and_b32 v7, -4, v58
    v_lshl_add_u32 v8, v58, 2, v7
    ds_write_b32 v8, v82
    v_lshl_add_u32 v7, v7, 2, v58
    ds_write_b8 v7, v65 offset:16
    v_and_b32 v9, -4, v59
    v_lshl_add_u32 v10, v59, 2, v9
    ds_write_b32 v10, v83
    v_lshl_add_u32 v9, v9, 2, v59
    ds_write_b8_d16_hi v9, v65 offset:16
L1_s8:
    s_cmp_le_u32 s43, 7
    s_cbranch_scc1 L1_s9
    v_and_b32 v7, -4, v60
    v_lshl_add_u32 v8, v60, 2, v7
    ds_write_b32 v8, v96
    v_lshl_add_u32 v7, v7, 2, v60
    ds_write_b8 v7, v66 offset:16
    v_and_b32 v9, -4, v61
    v_lshl_add_u32 v10, v61, 2, v9
    ds_write_b32 v10, v97
    v_lshl_add_u32 v9, v9, 2, v61
    ds_write_b8_d16_hi v9, v66 offset:16
    v_and_b32 v7, -4, v62
    v_lshl_add_u32 v8, v62, 2, v7
    ds_write_b32 v8, v98
    v_lshl_add_u32 v7, v7, 2, v62
    ds_write_b8 v7, v67 offset:16
    v_and_b32 v9, -4, v63
    v_lshl_add_u32 v10, v63, 2, v9
    ds_write_b32 v10, v99
    v_lshl_add_u32 v9, v9, 2, v63
    ds_write_b8_d16_hi v9, v67 offset:16
L1_s9:
    v_add_u32 v7, 0x10000, v0
    v_add_u32 v12, 0x20000, v0
    s_waitcnt lgkmcnt(0)
    s_barrier
    ds_read_b128 v[100:103], v0 offset:0
    ds_read_b128 v[28:31], v0 offset:16384
    ds_read_b128 v[112:115], v0 offset:32768
    ds_read_b128 v[88:91], v0 offset:49152
    ds_read_b128 v[16:19], v7 offset:0
    ds_read_b128 v[120:123], v7 offset:16384
    ds_read_b128 v[116:119], v7 offset:32768
    ds_read_b128 v[20:23], v7 offset:49152
    ds_read_b128 v[124:127], v12 offset:0
    ds_read_b128 v[44:47], v12 offset:16384
    s_waitcnt lgkmcnt(9)
    s_add_u32 s45, s35, 0xa900000
    buffer_store_dwordx4 v[100:103], v0, s[20:23], s45 offen sc1
    s_waitcnt lgkmcnt(8)
    s_add_u32 s46, s35, 0xa904000
    buffer_store_dwordx4 v[28:31], v0, s[20:23], s46 offen sc1
    s_waitcnt lgkmcnt(7)
    s_add_u32 s47, s35, 0xa908000
    buffer_store_dwordx4 v[112:115], v0, s[20:23], s47 offen sc1
    s_waitcnt lgkmcnt(6)
    s_add_u32 s44, s35, 0xa90c000
    buffer_store_dwordx4 v[88:91], v0, s[20:23], s44 offen sc1
    s_waitcnt lgkmcnt(5)
    s_add_u32 s45, s35, 0xa910000
    buffer_store_dwordx4 v[16:19], v0, s[20:23], s45 offen sc1
    s_waitcnt lgkmcnt(4)
    s_add_u32 s46, s35, 0xa914000
    buffer_store_dwordx4 v[120:123], v0, s[20:23], s46 offen sc1
    s_waitcnt lgkmcnt(3)
    s_add_u32 s47, s35, 0xa918000
    buffer_store_dwordx4 v[116:119], v0, s[20:23], s47 offen sc1
    s_cmp_le_u32 s43, 5
    s_cbranch_scc1 L1_fin
    s_waitcnt lgkmcnt(2)
    s_add_u32 s44, s35, 0xa91c000
    buffer_store_dwordx4 v[20:23], v0, s[20:23], s44 offen sc1
    s_cmp_le_u32 s43, 6
    s_cbranch_scc1 L1_fin
    s_waitcnt lgkmcnt(1)
    s_add_u32 s45, s35, 0xa920000
    buffer_store_dwordx4 v[124:127], v0, s[20:23], s45 offen sc1
    s_cmp_le_u32 s43, 7
    s_cbranch_scc1 L1_fin
    s_waitcnt lgkmcnt(0)
    s_add_u32 s46, s35, 0xa924000
    buffer_store_dwordx4 v[44:47], v0, s[20:23], s46 offen sc1
L1_fin:
L1_end:
    s_endpgm
.text
.globl gs_acc_kernel
.p2align 8
.type gs_acc_kernel,@function
gs_acc_kernel:
    s_cmp_ge_u32 s2, 256
    s_cbranch_scc1 L2_end
    s_load_dwordx2 s[30:31], s[0:1], 104
    s_load_dwordx2 s[28:29], s[0:1], 0
    s_load_dwordx2 s[6:7], s[0:1], 40
    v_lshrrev_b32 v16, 6, v0
    v_and_b32 v17, 63, v0
    v_readfirstlane_b32 s32, v16
    s_bfe_u32 s33, s2, 0x20001
    s_and_b32 s34, s2, 1
    s_lshl_b32 s34, s34, 5
    s_lshr_b32 s4, s2, 3
    s_add_u32 s34, s34, s4
    v_and_b32 v22, 3, v0
    v_mul_u32_u24 v19, 80, v16
    v_add_u32 v18, v17, v19
    v_mul_u32_u24 v2, 173056, v18
    v_lshrrev_b32 v18, 2, v17
    v_add3_u32 v18, v18, v19, 64
    v_mul_u32_u24 v4, 173056, v18
    v_lshl_add_u32 v20, v22, 4, v4
    s_mul_i32 s39, s33, 2080
    s_lshl_b32 s3, s34, 5
    s_add_u32 s39, s39, s3
    s_mul_i32 s40, s33, 1280000
    s_mul_i32 s38, s32, 5120
    s_add_u32 s38, s38, 80000
    v_lshl_add_u32 v3, v17, 4, s38
    s_waitcnt lgkmcnt(0)
    s_add_u32 s12, s30, 0x28000
    s_addc_u32 s13, s31, 0
    s_mov_b32 s14, 0xd318000
    s_mov_b32 s15, 0x20000
    buffer_load_dwordx4 v[48:51], v2, s[12:15], s39 offen offset:0
    buffer_load_dwordx4 v[56:59], v2, s[12:15], s39 offen offset:32
    buffer_load_dwordx4 v[52:55], v2, s[12:15], s39 offen offset:16
    buffer_load_dwordx4 v[60:63], v2, s[12:15], s39 offen offset:48
    buffer_load_dwordx4 v[64:67], v20, s[12:15], s39 offen
    s_mov_b32 s16, s28
    s_mov_b32 s17, s29
    s_mov_b32 s18, 0x4f5880
    s_mov_b32 s19, 0x20000
    s_sub_u32 s16, s16, 80000
    s_subb_u32 s17, s17, 0
    s_add_u32 s24, s30, 0xebab000
    s_addc_u32 s25, s31, 0
    s_mov_b32 s26, 0x100
    s_mov_b32 s27, 0x20000
    v_lshlrev_b32 v21, 6, v22
    buffer_load_dwordx2 v[8:9], v21, s[24:27], 0 offen offset:40
    s_add_u32 s3, s40, 4096
    buffer_load_dwordx4 v[124:127], v3, s[16:19], s3 offen
    buffer_load_dwordx4 v[116:119], v3, s[16:19], s40 offen offset:2048
    buffer_load_dwordx4 v[120:123], v3, s[16:19], s40 offen offset:3072
    buffer_load_dwordx4 v[108:111], v3, s[16:19], s40 offen offset:0
    buffer_load_dwordx4 v[112:115], v3, s[16:19], s40 offen offset:1024
    s_add_u32 s40, s40, 0x4e200
    v_mad_u32_u24 v4, v22, 20, v4
    v_or_b32 v4, 0xf0000000, v4
    v_or_b32 v2, 0xf0000000, v2
    v_lshlrev_b32 v23, 2, v22
    v_sub_u32 v1, 28, v23
    v_and_b32 v18, 3, v0
    v_lshlrev_b32 v18, 4, v18
    v_mov_b32 v10, 0x3f80
    v_mov_b32 v11, 0
    v_lshlrev_b64 v[10:11], v18, v[10:11]
    v_and_b32 v18, 3, v0
    v_lshlrev_b32 v18, 4, v18
    v_mov_b32 v12, 0xbf80
    v_mov_b32 v13, 0
    v_lshlrev_b64 v[12:13], v18, v[12:13]
    v_lshlrev_b32 v24, 4, v0
    v_lshl_add_u32 v0, v17, 2, s38
    v_mov_b32 v45, 0xf0000000
    v_mov_b32 v5, 0x1fff8
    v_mov_b32 v6, 0x07ff0000
    s_mov_b32 s44, 0x4000c0c
    s_mov_b32 s45, 0x4010c0c
    s_mov_b32 s46, 0x4020c0c
    s_mov_b32 s47, 0x4030c0c
    s_mov_b32 s36, 0
    s_mov_b32 s42, 0
    s_mov_b64 s[80:81], 0
    s_mov_b64 s[84:85], 0
    s_mov_b64 s[48:49], 0
    s_load_dwordx4 s[96:99], s[6:7], 0
    s_load_dwordx2 s[4:5], s[0:1], 24
    s_waitcnt lgkmcnt(0)
    s_mov_b32 s8, s30
    s_mov_b32 s9, s31
    s_mov_b32 s10, 0xd340000
    s_mov_b32 s11, 0x20000
    s_add_u32 s20, s30, 0xd823000
    s_addc_u32 s21, s31, 0
    s_mov_b32 s22, 0x13880
    s_mov_b32 s23, 0x20000
    s_lshl_b32 s3, s33, 6
    s_add_u32 s3, s3, s34
    s_mul_i32 s3, s3, 80000
    s_add_u32 s20, s20, s3
    s_addc_u32 s21, s21, 0
    v_mov_b32 v68, 0
    v_mov_b32 v69, 0
    v_mov_b32 v70, 0
    v_mov_b32 v71, 0
    v_mov_b32 v72, 0
    v_mov_b32 v73, 0
    v_mov_b32 v74, 0
    v_mov_b32 v75, 0
    ds_write_b128 v24, v[68:71] offset:0
    ds_write_b128 v24, v[68:71] offset:16384
    ds_write_b128 v24, v[68:71] offset:32768
    ds_write_b128 v24, v[68:71] offset:49152
    v_add_u32 v47, 0x10000, v24
    v_cmp_gt_u32 vcc, 80000, v47
    s_mov_b64 exec, vcc
    ds_write_b128 v47, v[68:71]
    s_mov_b64 exec, -1
    s_waitcnt vmcnt(5)
    v_sub_u16 v88, v56, v48
    v_and_b32 v89, 3, v48
    v_add3_u32 v99, v88, v89, 3
    v_and_b32 v99, -4, v99
    v_max_u32 v99, 4, v99
    v_and_b32 v97, 0xfffc, v48
    v_bfm_b32 v96, v88, v89
    v_add_u32_dpp v91, v99, v99 row_shr:1 row_mask:0xf bank_mask:0xf bound_ctrl:1
    v_mad_u32_u24 v97, v97, 5, v2
    v_cmp_lt_u32 vcc, 16, v99
    v_add_u32_dpp v91, v91, v91 row_shr:2 row_mask:0xf bank_mask:0xf bound_ctrl:1
    v_sub_u32 v98, s38, v99
    v_lshrrev_b64 v[48:49], 16, v[48:49]
    v_add_u32_dpp v91, v91, v91 row_shr:4 row_mask:0xf bank_mask:0xf bound_ctrl:1
    v_lshrrev_b64 v[56:57], 16, v[56:57]
    s_mov_b32 s43, 0
    v_add_u32_dpp v91, v91, v91 row_shr:8 row_mask:0xf bank_mask:0xf bound_ctrl:1
    s_nop 1
    v_add_u32_dpp v91, v91, v91 row_bcast:15 row_mask:0xa bank_mask:0xf
    s_nop 1
    v_add_u32_dpp v91, v91, v91 row_bcast:31 row_mask:0xc bank_mask:0xf
    v_add_u32 v98, v98, v91
    v_readlane_b32 s37, v91, 63
    s_cbranch_vccnz L2_xo1
L2_xp1:
    v_mov_b32 v44, v43
    s_cmp_gt_u32 s37, 1024
    s_cbranch_scc1 L2_xs2
    s_cmp_lg_u32 s43, 0
    s_cbranch_scc1 L2_xa2
L2_xb2:
    v_lshlrev_b32 v89, 16, v96
    v_add_u32 v90, 60, v97
    v_bitop3_b32 v90, v89, v45, v90 bitop3:0x6a
    ds_write_b32 v98, v90 offset:12
    v_lshlrev_b32 v89, 20, v96
    v_add_u32 v90, 40, v97
    v_bitop3_b32 v90, v89, v45, v90 bitop3:0x6a
    ds_write_b32 v98, v90 offset:8
    v_lshlrev_b32 v89, 24, v96
    v_add_u32 v90, 20, v97
    v_bitop3_b32 v90, v89, v45, v90 bitop3:0x6a
    ds_write_b32 v98, v90 offset:4
    v_lshlrev_b32 v89, 28, v96
    v_bitop3_b32 v90, v89, v45, v97 bitop3:0x6a
    ds_write_b32 v98, v90 offset:0
    v_mov_b32_dpp v91, v64 quad_perm:[0,0,0,0] row_mask:0xf bank_mask:0xf
    v_and_b32 v89, 3, v91
    v_and_b32 v97, 0xfffc, v91
    v_sub_u16_dpp v88, v64, v91 quad_perm:[2,2,2,2] row_mask:0xf bank_mask:0xf
    v_mad_u32_u24 v97, v97, 5, v4
    v_add_u32 v99, v88, v89
    v_bfm_b32 v96, v88, v89
    v_cmp_lt_u32 s[58:59], 16, v99
    v_lshlrev_b32 v89, v1, v96
    v_and_b32 v89, v45, v89
    v_cmp_ne_u32 vcc, 0, v89
    v_xor_b32 v90, v97, v89
    s_add_u32 s3, s37, s38
    v_mbcnt_lo_u32_b32 v98, vcc_lo, 0
    v_mbcnt_hi_u32_b32 v98, vcc_hi, v98
    s_bcnt1_i32_b64 s41, vcc
    v_lshl_add_u32 v98, v98, 2, s3
    s_mov_b64 exec, vcc
    ds_write_b32 v98, v90
    s_mov_b64 exec, -1
    s_lshl2_add_u32 s37, s41, s37
    s_cmp_lg_u64 s[58:59], 0
    s_cbranch_scc1 L2_xe2
L2_xr2:
    v_add_u32 v98, s37, v0
    v_mov_b32 v90, -1
    ds_write_b32 v98, v90
    ds_read2st64_b32 v[40:41], v0 offset0:0 offset1:1
    ds_read2st64_b32 v[42:43], v0 offset0:2 offset1:3
    s_sub_u32 s3, s37, 768
    s_cmp_gt_u32 s3, 256
    s_cbranch_scc1 L2_xf2
L2_xg2:
    v_sub_u16 v88, v58, v50
    v_and_b32 v89, 3, v50
    v_add3_u32 v99, v88, v89, 3
    v_and_b32 v99, -4, v99
    v_max_u32 v99, 4, v99
    v_and_b32 v97, 0xfffc, v50
    v_bfm_b32 v96, v88, v89
    v_add_u32_dpp v91, v99, v99 row_shr:1 row_mask:0xf bank_mask:0xf bound_ctrl:1
    v_mad_u32_u24 v97, v97, 5, v2
    v_cmp_lt_u32 vcc, 16, v99
    v_add_u32_dpp v91, v91, v91 row_shr:2 row_mask:0xf bank_mask:0xf bound_ctrl:1
    v_sub_u32 v98, s38, v99
    v_lshrrev_b64 v[50:51], 16, v[50:51]
    v_add_u32_dpp v91, v91, v91 row_shr:4 row_mask:0xf bank_mask:0xf bound_ctrl:1
    v_lshrrev_b64 v[58:59], 16, v[58:59]
    s_mov_b32 s43, 0
    v_add_u32_dpp v91, v91, v91 row_shr:8 row_mask:0xf bank_mask:0xf bound_ctrl:1
    s_nop 1
    v_add_u32_dpp v91, v91, v91 row_bcast:15 row_mask:0xa bank_mask:0xf
    s_nop 1
    v_add_u32_dpp v91, v91, v91 row_bcast:31 row_mask:0xc bank_mask:0xf
    v_add_u32 v98, v98, v91
    v_readlane_b32 s37, v91, 63
    s_cbranch_vccnz L2_xo3
L2_xp3:
    s_waitcnt lgkmcnt(0)
    v_mov_b32 v21, v40
    v_mov_b32 v27, v41
    v_mov_b32 v33, v42
    v_mov_b32 v39, v43
    v_and_b32 v47, 0x0fffffff, v21
    buffer_load_dwordx4 v[16:19], v47, s[8:11], 0 offen
    buffer_load_dwordx3 v[18:20], v47, s[8:11], 0 offen offset:8
    s_waitcnt vmcnt(6)
    ds_write_b128 v3, v[124:127] offset:4096
    s_waitcnt vmcnt(5)
    ds_write_b128 v3, v[116:119] offset:2048
    s_waitcnt vmcnt(4)
    ds_write_b128 v3, v[120:123] offset:3072
    v_mov_b32 v44, v43
    s_cmp_gt_u32 s37, 1024
    s_cbranch_scc1 L2_xs4
    s_cmp_lg_u32 s43, 0
    s_cbranch_scc1 L2_xa4
L2_xb4:
    v_lshlrev_b32 v89, 16, v96
    v_add_u32 v90, 60, v97
    v_bitop3_b32 v90, v89, v45, v90 bitop3:0x6a
    ds_write_b32 v98, v90 offset:12
    v_lshlrev_b32 v89, 20, v96
    v_add_u32 v90, 40, v97
    v_bitop3_b32 v90, v89, v45, v90 bitop3:0x6a
    ds_write_b32 v98, v90 offset:8
    v_lshlrev_b32 v89, 24, v96
    v_add_u32 v90, 20, v97
    v_bitop3_b32 v90, v89, v45, v90 bitop3:0x6a
    ds_write_b32 v98, v90 offset:4
    v_lshlrev_b32 v89, 28, v96
    v_bitop3_b32 v90, v89, v45, v97 bitop3:0x6a
    ds_write_b32 v98, v90 offset:0
    v_mov_b32_dpp v91, v66 quad_perm:[0,0,0,0] row_mask:0xf bank_mask:0xf
    v_and_b32 v89, 3, v91
    v_and_b32 v97, 0xfffc, v91
    v_sub_u16_dpp v88, v66, v91 quad_perm:[2,2,2,2] row_mask:0xf bank_mask:0xf
    v_mad_u32_u24 v97, v97, 5, v4
    v_add_u32 v99, v88, v89
    v_bfm_b32 v96, v88, v89
    v_cmp_lt_u32 s[58:59], 16, v99
    v_lshlrev_b32 v89, v1, v96
    v_and_b32 v89, v45, v89
    v_cmp_ne_u32 vcc, 0, v89
    v_xor_b32 v90, v97, v89
    s_add_u32 s3, s37, s38
    v_mbcnt_lo_u32_b32 v98, vcc_lo, 0
    v_mbcnt_hi_u32_b32 v98, vcc_hi, v98
    s_bcnt1_i32_b64 s41, vcc
    v_lshl_add_u32 v98, v98, 2, s3
    s_mov_b64 exec, vcc
    ds_write_b32 v98, v90
    s_mov_b64 exec, -1
    s_lshl2_add_u32 s37, s41, s37
    s_cmp_lg_u64 s[58:59], 0
    s_cbranch_scc1 L2_xe4
L2_xr4:
    v_add_u32 v98, s37, v0
    v_mov_b32 v90, -1
    ds_write_b32 v98, v90
    ds_read2st64_b32 v[40:41], v0 offset0:0 offset1:1
    ds_read2st64_b32 v[42:43], v0 offset0:2 offset1:3
    s_sub_u32 s3, s37, 768
    s_cmp_gt_u32 s3, 256
    s_cbranch_scc1 L2_xf4
L2_xg4:
    s_waitcnt vmcnt(3)
    ds_write_b128 v3, v[108:111] offset:0
    s_waitcnt vmcnt(2)
    ds_write_b128 v3, v[112:115] offset:1024
    s_waitcnt lgkmcnt(0)
    s_barrier
    s_bitcmp1_b32 s36, s42
    s_cbranch_scc1 L2_slow
L2_ret0:
    s_setprio 3
    v_and_b32 v47, 0x0fffffff, v27
    buffer_load_dwordx4 v[22:25], v47, s[8:11], 0 offen
    buffer_load_dwordx3 v[24:26], v47, s[8:11], 0 offen offset:8
    s_waitcnt vmcnt(2)
    v_and_b32 v46, 0x20000000, v21
    v_lshrrev_b32 v47, 14, v17
    v_bitop3_b32 v47, v47, v5, v46 bitop3:0xea
    ds_read_b64 v[102:103], v47 offset:63616
    v_bitop3_b32 v93, v17, v5, v46 bitop3:0xea
    v_and_b32 v46, 0x10000000, v21
    v_lshrrev_b32 v47, 14, v16
    v_bitop3_b32 v47, v47, v5, v46 bitop3:0xea
    ds_read_b64 v[100:101], v47 offset:63616
    v_bitop3_b32 v92, v16, v5, v46 bitop3:0xea
    v_perm_b32 v15, v17, v20, s45
    v_bitop3_b32 v46, v17, 0.5, -0.5 bitop3:0xa8
    v_perm_b32 v14, v16, v20, s44
    v_bitop3_b32 v47, v16, 0.5, -0.5 bitop3:0xa8
    s_waitcnt lgkmcnt(0)
    v_mfma_f32_4x4x4_16b_bf16 v[80:83], v[8:9], v[102:103], 0
    v_mfma_f32_4x4x4_16b_bf16 v[76:79], v[8:9], v[100:101], 0
    v_bitop3_b32 v15, v6, v15, v46 bitop3:0xca
    v_bitop3_b32 v14, v6, v14, v47 bitop3:0xca
    v_cmp_lt_u32 s[84:85], v5, v92
    s_nop 0
    v_pk_mul_f32 v[80:81], v[80:81], v[14:15] op_sel:[0,1] op_sel_hi:[1,1]
    v_pk_mul_f32 v[82:83], v[82:83], v[14:15] op_sel:[0,1] op_sel_hi:[1,1]
    v_pk_mul_f32 v[76:77], v[76:77], v[14:15] op_sel:[0,0] op_sel_hi:[1,0]
    v_pk_mul_f32 v[78:79], v[78:79], v[14:15] op_sel:[0,0] op_sel_hi:[1,0]
    v_and_b32 v47, 0x0fffffff, v33
    buffer_load_dwordx4 v[28:31], v47, s[8:11], 0 offen
    buffer_load_dwordx3 v[30:32], v47, s[8:11], 0 offen offset:8
    v_cmpx_ne_u64 vcc, v[74:75], v[70:71]
    s_and_b64 s[82:83], vcc, s[80:81]
    s_cbranch_scc1 L2_c5
L2_d5:
    v_mov_b64 v[84:85], v[70:71]
    v_mov_b32 v7, v95
    v_mov_b64 v[86:87], v[74:75]
    s_mov_b64 exec, -1
    s_or_b64 s[80:81], s[80:81], vcc
    v_cmpx_ne_u64 vcc, v[72:73], v[68:69]
    s_and_b64 s[82:83], vcc, s[80:81]
    s_cbranch_scc1 L2_c6
L2_d6:
    v_mov_b64 v[84:85], v[68:69]
    v_mov_b32 v7, v94
    v_mov_b64 v[86:87], v[72:73]
    s_mov_b64 exec, -1
    s_or_b64 s[80:81], s[80:81], vcc
    ds_read_b64 v[70:71], v93
    s_and_b64 exec, s[84:85], s[80:81]
    v_mfma_f32_4x4x4_16b_bf16 v[76:79], v[12:13], v[84:85], 0
    v_mov_b32 v92, v7
    s_andn2_b64 s[80:81], s[80:81], s[84:85]
    v_mfma_f32_4x4x4_16b_bf16 v[76:79], v[10:11], v[86:87], v[76:79]
    s_mov_b64 exec, -1
    ds_read_b64 v[68:69], v92
    v_and_b32 v46, 0x80000000, v21
    v_lshrrev_b32 v47, 14, v19
    v_bitop3_b32 v47, v47, v5, v46 bitop3:0xea
    ds_read_b64 v[106:107], v47 offset:63616
    v_bitop3_b32 v95, v19, v5, v46 bitop3:0xea
    v_and_b32 v46, 0x40000000, v21
    v_lshrrev_b32 v47, 14, v18
    v_bitop3_b32 v47, v47, v5, v46 bitop3:0xea
    ds_read_b64 v[104:105], v47 offset:63616
    v_bitop3_b32 v94, v18, v5, v46 bitop3:0xea
    s_waitcnt lgkmcnt(2)
    v_mfma_f32_4x4x4_16b_bf16 v[80:83], v[10:11], v[70:71], v[80:83]
    v_mfma_f32_4x4x4_16b_bf16 v[76:79], v[10:11], v[68:69], v[76:79]
    v_perm_b32 v15, v19, v20, s47
    v_bitop3_b32 v46, v19, 0.5, -0.5 bitop3:0xa8
    v_perm_b32 v14, v18, v20, s46
    v_bitop3_b32 v47, v18, 0.5, -0.5 bitop3:0xa8
    v_cvt_pk_bf16_f32 v80, v80, v81
    v_cvt_pk_bf16_f32 v81, v82, v83
    ds_wrxchg_rtn_b64 v[74:75], v93, v[80:81]
    v_cvt_pk_bf16_f32 v76, v76, v77
    v_cvt_pk_bf16_f32 v77, v78, v79
    ds_wrxchg_rtn_b64 v[72:73], v92, v[76:77]
    s_setprio 2
    s_waitcnt lgkmcnt(2)
    v_mfma_f32_4x4x4_16b_bf16 v[80:83], v[8:9], v[106:107], 0
    v_mfma_f32_4x4x4_16b_bf16 v[76:79], v[8:9], v[104:105], 0
    v_bitop3_b32 v15, v6, v15, v46 bitop3:0xca
    v_bitop3_b32 v14, v6, v14, v47 bitop3:0xca
    s_nop 1
    v_pk_mul_f32 v[80:81], v[80:81], v[14:15] op_sel:[0,1] op_sel_hi:[1,1]
    v_pk_mul_f32 v[82:83], v[82:83], v[14:15] op_sel:[0,1] op_sel_hi:[1,1]
    v_pk_mul_f32 v[76:77], v[76:77], v[14:15] op_sel:[0,0] op_sel_hi:[1,0]
    v_pk_mul_f32 v[78:79], v[78:79], v[14:15] op_sel:[0,0] op_sel_hi:[1,0]
    s_add_u32 s3, s40, 4096
    buffer_load_dwordx4 v[124:127], v3, s[16:19], s3 offen
    buffer_load_dwordx4 v[116:119], v3, s[16:19], s40 offen offset:2048
    s_waitcnt lgkmcnt(0)
    v_cmpx_ne_u64 vcc, v[74:75], v[70:71]
    s_and_b64 s[82:83], vcc, s[80:81]
    s_cbranch_scc1 L2_c7
L2_d7:
    v_mov_b64 v[84:85], v[70:71]
    v_mov_b32 v7, v93
    v_mov_b64 v[86:87], v[74:75]
    s_mov_b64 exec, -1
    s_or_b64 s[80:81], s[80:81], vcc
    v_cmpx_ne_u64 vcc, v[72:73], v[68:69]
    s_and_b64 s[82:83], vcc, s[80:81]
    s_cbranch_scc1 L2_c8
L2_d8:
    v_mov_b64 v[84:85], v[68:69]
    v_mov_b32 v7, v92
    v_mov_b64 v[86:87], v[72:73]
    s_mov_b64 exec, -1
    s_or_b64 s[80:81], s[80:81], vcc
    ds_read_b64 v[70:71], v95
    ds_read_b64 v[68:69], v94
    s_waitcnt vmcnt(4)
    v_and_b32 v46, 0x20000000, v27
    v_lshrrev_b32 v47, 14, v23
    v_bitop3_b32 v47, v47, v5, v46 bitop3:0xea
    ds_read_b64 v[102:103], v47 offset:63616
    v_bitop3_b32 v93, v23, v5, v46 bitop3:0xea
    v_and_b32 v46, 0x10000000, v27
    v_lshrrev_b32 v47, 14, v22
    v_bitop3_b32 v47, v47, v5, v46 bitop3:0xea
    ds_read_b64 v[100:101], v47 offset:63616
    v_bitop3_b32 v92, v22, v5, v46 bitop3:0xea
    s_waitcnt lgkmcnt(2)
    v_mfma_f32_4x4x4_16b_bf16 v[80:83], v[10:11], v[70:71], v[80:83]
    v_mfma_f32_4x4x4_16b_bf16 v[76:79], v[10:11], v[68:69], v[76:79]
    v_perm_b32 v15, v23, v26, s45
    v_bitop3_b32 v46, v23, 0.5, -0.5 bitop3:0xa8
    v_perm_b32 v14, v22, v26, s44
    v_bitop3_b32 v47, v22, 0.5, -0.5 bitop3:0xa8
    v_cvt_pk_bf16_f32 v80, v80, v81
    v_cvt_pk_bf16_f32 v81, v82, v83
    ds_wrxchg_rtn_b64 v[74:75], v95, v[80:81]
    v_cvt_pk_bf16_f32 v76, v76, v77
    v_cvt_pk_bf16_f32 v77, v78, v79
    ds_wrxchg_rtn_b64 v[72:73], v94, v[76:77]
    s_waitcnt lgkmcnt(2)
    v_mfma_f32_4x4x4_16b_bf16 v[80:83], v[8:9], v[102:103], 0
    v_mfma_f32_4x4x4_16b_bf16 v[76:79], v[8:9], v[100:101], 0
    v_bitop3_b32 v15, v6, v15, v46 bitop3:0xca
    v_bitop3_b32 v14, v6, v14, v47 bitop3:0xca
    v_cmp_lt_u32 s[84:85], v5, v92
    s_nop 0
    v_pk_mul_f32 v[80:81], v[80:81], v[14:15] op_sel:[0,1] op_sel_hi:[1,1]
    v_pk_mul_f32 v[82:83], v[82:83], v[14:15] op_sel:[0,1] op_sel_hi:[1,1]
    v_pk_mul_f32 v[76:77], v[76:77], v[14:15] op_sel:[0,0] op_sel_hi:[1,0]
    v_pk_mul_f32 v[78:79], v[78:79], v[14:15] op_sel:[0,0] op_sel_hi:[1,0]
    v_sub_u16 v88, v60, v52
    v_and_b32 v89, 3, v52
    v_add3_u32 v99, v88, v89, 3
    v_and_b32 v99, -4, v99
    v_max_u32 v99, 4, v99
    v_and_b32 v97, 0xfffc, v52
    v_bfm_b32 v96, v88, v89
    v_add_u32_dpp v91, v99, v99 row_shr:1 row_mask:0xf bank_mask:0xf bound_ctrl:1
    v_mad_u32_u24 v97, v97, 5, v2
    v_cmp_lt_u32 vcc, 16, v99
    v_add_u32_dpp v91, v91, v91 row_shr:2 row_mask:0xf bank_mask:0xf bound_ctrl:1
    v_sub_u32 v98, s38, v99
    v_lshrrev_b64 v[52:53], 16, v[52:53]
    v_add_u32_dpp v91, v91, v91 row_shr:4 row_mask:0xf bank_mask:0xf bound_ctrl:1
    v_lshrrev_b64 v[60:61], 16, v[60:61]
    s_mov_b32 s43, 0
    v_add_u32_dpp v91, v91, v91 row_shr:8 row_mask:0xf bank_mask:0xf bound_ctrl:1
    s_nop 1
    v_add_u32_dpp v91, v91, v91 row_bcast:15 row_mask:0xa bank_mask:0xf
    s_nop 1
    v_add_u32_dpp v91, v91, v91 row_bcast:31 row_mask:0xc bank_mask:0xf
    v_add_u32 v98, v98, v91
    v_readlane_b32 s37, v91, 63
    s_cbranch_vccnz L2_xo9
L2_xp9:
    v_and_b32 v47, 0x0fffffff, v39
    buffer_load_dwordx4 v[34:37], v47, s[8:11], 0 offen
    buffer_load_dwordx3 v[36:38], v47, s[8:11], 0 offen offset:8
    buffer_load_dwordx4 v[120:123], v3, s[16:19], s40 offen offset:3072
    s_waitcnt lgkmcnt(0)
    v_cmpx_ne_u64 vcc, v[74:75], v[70:71]
    s_and_b64 s[82:83], vcc, s[80:81]
    s_cbranch_scc1 L2_c10
L2_d10:
    v_mov_b64 v[84:85], v[70:71]
    v_mov_b32 v7, v95
    v_mov_b64 v[86:87], v[74:75]
    s_mov_b64 exec, -1
    s_or_b64 s[80:81], s[80:81], vcc
    v_cmpx_ne_u64 vcc, v[72:73], v[68:69]
    s_and_b64 s[82:83], vcc, s[80:81]
    s_cbranch_scc1 L2_c11
L2_d11:
    v_mov_b64 v[84:85], v[68:69]
    v_mov_b32 v7, v94
    v_mov_b64 v[86:87], v[72:73]
    s_mov_b64 exec, -1
    s_or_b64 s[80:81], s[80:81], vcc
    ds_read_b64 v[70:71], v93
    s_and_b64 exec, s[84:85], s[80:81]
    v_mfma_f32_4x4x4_16b_bf16 v[76:79], v[12:13], v[84:85], 0
    v_mov_b32 v92, v7
    s_andn2_b64 s[80:81], s[80:81], s[84:85]
    v_mfma_f32_4x4x4_16b_bf16 v[76:79], v[10:11], v[86:87], v[76:79]
    s_mov_b64 exec, -1
    ds_read_b64 v[68:69], v92
    v_and_b32 v46, 0x80000000, v27
    v_lshrrev_b32 v47, 14, v25
    v_bitop3_b32 v47, v47, v5, v46 bitop3:0xea
    ds_read_b64 v[106:107], v47 offset:63616
    v_bitop3_b32 v95, v25, v5, v46 bitop3:0xea
    v_and_b32 v46, 0x40000000, v27
    v_lshrrev_b32 v47, 14, v24
    v_bitop3_b32 v47, v47, v5, v46 bitop3:0xea
    ds_read_b64 v[104:105], v47 offset:63616
    v_bitop3_b32 v94, v24, v5, v46 bitop3:0xea
    s_waitcnt lgkmcnt(2)
    v_mfma_f32_4x4x4_16b_bf16 v[80:83], v[10:11], v[70:71], v[80:83]
    v_mfma_f32_4x4x4_16b_bf16 v[76:79], v[10:11], v[68:69], v[76:79]
    v_perm_b32 v15, v25, v26, s47
    v_bitop3_b32 v46, v25, 0.5, -0.5 bitop3:0xa8
    v_perm_b32 v14, v24, v26, s46
    v_bitop3_b32 v47, v24, 0.5, -0.5 bitop3:0xa8
    v_cvt_pk_bf16_f32 v80, v80, v81
    v_cvt_pk_bf16_f32 v81, v82, v83
    ds_wrxchg_rtn_b64 v[74:75], v93, v[80:81]
    v_cvt_pk_bf16_f32 v76, v76, v77
    v_cvt_pk_bf16_f32 v77, v78, v79
    ds_wrxchg_rtn_b64 v[72:73], v92, v[76:77]
    s_setprio 1
    s_waitcnt lgkmcnt(2)
    v_mfma_f32_4x4x4_16b_bf16 v[80:83], v[8:9], v[106:107], 0
    v_mfma_f32_4x4x4_16b_bf16 v[76:79], v[8:9], v[104:105], 0
    v_bitop3_b32 v15, v6, v15, v46 bitop3:0xca
    v_bitop3_b32 v14, v6, v14, v47 bitop3:0xca
    s_nop 1
    v_pk_mul_f32 v[80:81], v[80:81], v[14:15] op_sel:[0,1] op_sel_hi:[1,1]
    v_pk_mul_f32 v[82:83], v[82:83], v[14:15] op_sel:[0,1] op_sel_hi:[1,1]
    v_pk_mul_f32 v[76:77], v[76:77], v[14:15] op_sel:[0,0] op_sel_hi:[1,0]
    v_pk_mul_f32 v[78:79], v[78:79], v[14:15] op_sel:[0,0] op_sel_hi:[1,0]
    buffer_load_dwordx4 v[108:111], v3, s[16:19], s40 offen offset:0
    buffer_load_dwordx4 v[112:115], v3, s[16:19], s40 offen offset:1024
    s_waitcnt lgkmcnt(0)
    v_cmpx_ne_u64 vcc, v[74:75], v[70:71]
    s_and_b64 s[82:83], vcc, s[80:81]
    s_cbranch_scc1 L2_c12
L2_d12:
    v_mov_b64 v[84:85], v[70:71]
    v_mov_b32 v7, v93
    v_mov_b64 v[86:87], v[74:75]
    s_mov_b64 exec, -1
    s_or_b64 s[80:81], s[80:81], vcc
    v_cmpx_ne_u64 vcc, v[72:73], v[68:69]
    s_and_b64 s[82:83], vcc, s[80:81]
    s_cbranch_scc1 L2_c13
L2_d13:
    v_mov_b64 v[84:85], v[68:69]
    v_mov_b32 v7, v92
    v_mov_b64 v[86:87], v[72:73]
    s_mov_b64 exec, -1
    s_or_b64 s[80:81], s[80:81], vcc
    ds_read_b64 v[70:71], v95
    ds_read_b64 v[68:69], v94
    s_waitcnt vmcnt(7)
    v_and_b32 v46, 0x20000000, v33
    v_lshrrev_b32 v47, 14, v29
    v_bitop3_b32 v47, v47, v5, v46 bitop3:0xea
    ds_read_b64 v[102:103], v47 offset:63616
    v_bitop3_b32 v93, v29, v5, v46 bitop3:0xea
    v_and_b32 v46, 0x10000000, v33
    v_lshrrev_b32 v47, 14, v28
    v_bitop3_b32 v47, v47, v5, v46 bitop3:0xea
    ds_read_b64 v[100:101], v47 offset:63616
    v_bitop3_b32 v92, v28, v5, v46 bitop3:0xea
    s_waitcnt lgkmcnt(2)
    v_mfma_f32_4x4x4_16b_bf16 v[80:83], v[10:11], v[70:71], v[80:83]
    v_mfma_f32_4x4x4_16b_bf16 v[76:79], v[10:11], v[68:69], v[76:79]
    v_perm_b32 v15, v29, v32, s45
    v_bitop3_b32 v46, v29, 0.5, -0.5 bitop3:0xa8
    v_perm_b32 v14, v28, v32, s44
    v_bitop3_b32 v47, v28, 0.5, -0.5 bitop3:0xa8
    v_cvt_pk_bf16_f32 v80, v80, v81
    v_cvt_pk_bf16_f32 v81, v82, v83
    ds_wrxchg_rtn_b64 v[74:75], v95, v[80:81]
    v_cvt_pk_bf16_f32 v76, v76, v77
    v_cvt_pk_bf16_f32 v77, v78, v79
    ds_wrxchg_rtn_b64 v[72:73], v94, v[76:77]
    s_waitcnt lgkmcnt(2)
    v_mfma_f32_4x4x4_16b_bf16 v[80:83], v[8:9], v[102:103], 0
    v_mfma_f32_4x4x4_16b_bf16 v[76:79], v[8:9], v[100:101], 0
    v_bitop3_b32 v15, v6, v15, v46 bitop3:0xca
    v_bitop3_b32 v14, v6, v14, v47 bitop3:0xca
    v_cmp_lt_u32 s[84:85], v5, v92
    s_nop 0
    v_pk_mul_f32 v[80:81], v[80:81], v[14:15] op_sel:[0,1] op_sel_hi:[1,1]
    v_pk_mul_f32 v[82:83], v[82:83], v[14:15] op_sel:[0,1] op_sel_hi:[1,1]
    v_pk_mul_f32 v[76:77], v[76:77], v[14:15] op_sel:[0,0] op_sel_hi:[1,0]
    v_pk_mul_f32 v[78:79], v[78:79], v[14:15] op_sel:[0,0] op_sel_hi:[1,0]
    v_and_b32 v47, 0x0fffffff, v40
    v_mov_b32 v21, v40
    buffer_load_dwordx4 v[16:19], v47, s[8:11], 0 offen
    buffer_load_dwordx3 v[18:20], v47, s[8:11], 0 offen offset:8
    s_waitcnt lgkmcnt(0)
    v_cmpx_ne_u64 vcc, v[74:75], v[70:71]
    s_and_b64 s[82:83], vcc, s[80:81]
    s_cbranch_scc1 L2_c14
L2_d14:
    v_mov_b64 v[84:85], v[70:71]
    v_mov_b32 v7, v95
    v_mov_b64 v[86:87], v[74:75]
    s_mov_b64 exec, -1
    s_or_b64 s[80:81], s[80:81], vcc
    v_cmpx_ne_u64 vcc, v[72:73], v[68:69]
    s_and_b64 s[82:83], vcc, s[80:81]
    s_cbranch_scc1 L2_c15
L2_d15:
    v_mov_b64 v[84:85], v[68:69]
    v_mov_b32 v7, v94
    v_mov_b64 v[86:87], v[72:73]
    s_mov_b64 exec, -1
    s_or_b64 s[80:81], s[80:81], vcc
    ds_read_b64 v[70:71], v93
    s_and_b64 exec, s[84:85], s[80:81]
    v_mfma_f32_4x4x4_16b_bf16 v[76:79], v[12:13], v[84:85], 0
    v_mov_b32 v92, v7
    s_andn2_b64 s[80:81], s[80:81], s[84:85]
    v_mfma_f32_4x4x4_16b_bf16 v[76:79], v[10:11], v[86:87], v[76:79]
    s_mov_b64 exec, -1
    ds_read_b64 v[68:69], v92
    v_and_b32 v46, 0x80000000, v33
    v_lshrrev_b32 v47, 14, v31
    v_bitop3_b32 v47, v47, v5, v46 bitop3:0xea
    ds_read_b64 v[106:107], v47 offset:63616
    v_bitop3_b32 v95, v31, v5, v46 bitop3:0xea
    v_and_b32 v46, 0x40000000, v33
    v_lshrrev_b32 v47, 14, v30
    v_bitop3_b32 v47, v47, v5, v46 bitop3:0xea
    ds_read_b64 v[104:105], v47 offset:63616
    v_bitop3_b32 v94, v30, v5, v46 bitop3:0xea
    s_waitcnt lgkmcnt(2)
    v_mfma_f32_4x4x4_16b_bf16 v[80:83], v[10:11], v[70:71], v[80:83]
    v_mfma_f32_4x4x4_16b_bf16 v[76:79], v[10:11], v[68:69], v[76:79]
    v_perm_b32 v15, v31, v32, s47
    v_bitop3_b32 v46, v31, 0.5, -0.5 bitop3:0xa8
    v_perm_b32 v14, v30, v32, s46
    v_bitop3_b32 v47, v30, 0.5, -0.5 bitop3:0xa8
    v_cvt_pk_bf16_f32 v80, v80, v81
    v_cvt_pk_bf16_f32 v81, v82, v83
    ds_wrxchg_rtn_b64 v[74:75], v93, v[80:81]
    v_cvt_pk_bf16_f32 v76, v76, v77
    v_cvt_pk_bf16_f32 v77, v78, v79
    ds_wrxchg_rtn_b64 v[72:73], v92, v[76:77]
    s_setprio 0
    s_waitcnt lgkmcnt(2)
    v_mfma_f32_4x4x4_16b_bf16 v[80:83], v[8:9], v[106:107], 0
    v_mfma_f32_4x4x4_16b_bf16 v[76:79], v[8:9], v[104:105], 0
    v_bitop3_b32 v15, v6, v15, v46 bitop3:0xca
    v_bitop3_b32 v14, v6, v14, v47 bitop3:0xca
    s_nop 1
    v_pk_mul_f32 v[80:81], v[80:81], v[14:15] op_sel:[0,1] op_sel_hi:[1,1]
    v_pk_mul_f32 v[82:83], v[82:83], v[14:15] op_sel:[0,1] op_sel_hi:[1,1]
    v_pk_mul_f32 v[76:77], v[76:77], v[14:15] op_sel:[0,0] op_sel_hi:[1,0]
    v_pk_mul_f32 v[78:79], v[78:79], v[14:15] op_sel:[0,0] op_sel_hi:[1,0]
    s_add_u32 s40, s40, 0x4e200
    v_and_b32 v47, 0x0fffffff, v41
    v_mov_b32 v27, v41
    buffer_load_dwordx4 v[22:25], v47, s[8:11], 0 offen
    buffer_load_dwordx3 v[24:26], v47, s[8:11], 0 offen offset:8
    s_waitcnt lgkmcnt(0)
    v_cmpx_ne_u64 vcc, v[74:75], v[70:71]
    s_and_b64 s[82:83], vcc, s[80:81]
    s_cbranch_scc1 L2_c16
L2_d16:
    v_mov_b64 v[84:85], v[70:71]
    v_mov_b32 v7, v93
    v_mov_b64 v[86:87], v[74:75]
    s_mov_b64 exec, -1
    s_or_b64 s[80:81], s[80:81], vcc
    v_cmpx_ne_u64 vcc, v[72:73], v[68:69]
    s_and_b64 s[82:83], vcc, s[80:81]
    s_cbranch_scc1 L2_c17
L2_d17:
    v_mov_b64 v[84:85], v[68:69]
    v_mov_b32 v7, v92
    v_mov_b64 v[86:87], v[72:73]
    s_mov_b64 exec, -1
    s_or_b64 s[80:81], s[80:81], vcc
    ds_read_b64 v[70:71], v95
    ds_read_b64 v[68:69], v94
    s_waitcnt vmcnt(7)
    v_and_b32 v46, 0x20000000, v39
    v_lshrrev_b32 v47, 14, v35
    v_bitop3_b32 v47, v47, v5, v46 bitop3:0xea
    ds_read_b64 v[102:103], v47 offset:63616
    v_bitop3_b32 v93, v35, v5, v46 bitop3:0xea
    v_and_b32 v46, 0x10000000, v39
    v_lshrrev_b32 v47, 14, v34
    v_bitop3_b32 v47, v47, v5, v46 bitop3:0xea
    ds_read_b64 v[100:101], v47 offset:63616
    v_bitop3_b32 v92, v34, v5, v46 bitop3:0xea
    v_and_b32 v46, 0x80000000, v39
    v_lshrrev_b32 v47, 14, v37
    v_bitop3_b32 v47, v47, v5, v46 bitop3:0xea
    ds_read_b64 v[106:107], v47 offset:63616
    v_and_b32 v46, 0x40000000, v39
    v_lshrrev_b32 v47, 14, v36
    v_bitop3_b32 v47, v47, v5, v46 bitop3:0xea
    ds_read_b64 v[104:105], v47 offset:63616
    s_waitcnt lgkmcnt(4)
    v_mfma_f32_4x4x4_16b_bf16 v[80:83], v[10:11], v[70:71], v[80:83]
    v_mfma_f32_4x4x4_16b_bf16 v[76:79], v[10:11], v[68:69], v[76:79]
    v_perm_b32 v15, v35, v38, s45
    v_bitop3_b32 v46, v35, 0.5, -0.5 bitop3:0xa8
    v_perm_b32 v14, v34, v38, s44
    v_bitop3_b32 v47, v34, 0.5, -0.5 bitop3:0xa8
    v_cvt_pk_bf16_f32 v80, v80, v81
    v_cvt_pk_bf16_f32 v81, v82, v83
    ds_wrxchg_rtn_b64 v[74:75], v95, v[80:81]
    v_cvt_pk_bf16_f32 v76, v76, v77
    v_cvt_pk_bf16_f32 v77, v78, v79
    ds_wrxchg_rtn_b64 v[72:73], v94, v[76:77]
    s_waitcnt lgkmcnt(2)
    s_barrier
    s_setprio 3
    ds_write_b128 v3, v[124:127] offset:4096
    s_add_u32 s3, s40, 4096
    buffer_load_dwordx4 v[124:127], v3, s[16:19], s3 offen
    ds_write_b128 v3, v[116:119] offset:2048
    buffer_load_dwordx4 v[116:119], v3, s[16:19], s40 offen offset:2048
    s_waitcnt vmcnt(8)
    ds_write_b128 v3, v[120:123] offset:3072
    buffer_load_dwordx4 v[120:123], v3, s[16:19], s40 offen offset:3072
    v_mfma_f32_4x4x4_16b_bf16 v[80:83], v[8:9], v[102:103], 0
    v_mfma_f32_4x4x4_16b_bf16 v[76:79], v[8:9], v[100:101], 0
    v_bitop3_b32 v15, v6, v15, v46 bitop3:0xca
    v_bitop3_b32 v14, v6, v14, v47 bitop3:0xca
    v_cmp_lt_u32 s[84:85], v5, v92
    s_nop 0
    v_pk_mul_f32 v[80:81], v[80:81], v[14:15] op_sel:[0,1] op_sel_hi:[1,1]
    v_pk_mul_f32 v[82:83], v[82:83], v[14:15] op_sel:[0,1] op_sel_hi:[1,1]
    v_pk_mul_f32 v[76:77], v[76:77], v[14:15] op_sel:[0,0] op_sel_hi:[1,0]
    v_pk_mul_f32 v[78:79], v[78:79], v[14:15] op_sel:[0,0] op_sel_hi:[1,0]
    v_and_b32 v47, 0x0fffffff, v42
    v_mov_b32 v33, v42
    buffer_load_dwordx4 v[28:31], v47, s[8:11], 0 offen
    buffer_load_dwordx3 v[30:32], v47, s[8:11], 0 offen offset:8
    v_mov_b32 v44, v43
    s_cmp_gt_u32 s37, 1024
    s_cbranch_scc1 L2_xs18
    s_cmp_lg_u32 s43, 0
    s_cbranch_scc1 L2_xa18
L2_xb18:
    v_lshlrev_b32 v89, 16, v96
    v_add_u32 v90, 60, v97
    v_bitop3_b32 v90, v89, v45, v90 bitop3:0x6a
    ds_write_b32 v98, v90 offset:12
    v_lshlrev_b32 v89, 20, v96
    v_add_u32 v90, 40, v97
    v_bitop3_b32 v90, v89, v45, v90 bitop3:0x6a
    ds_write_b32 v98, v90 offset:8
    v_lshlrev_b32 v89, 24, v96
    v_add_u32 v90, 20, v97
    v_bitop3_b32 v90, v89, v45, v90 bitop3:0x6a
    ds_write_b32 v98, v90 offset:4
    v_lshlrev_b32 v89, 28, v96
    v_bitop3_b32 v90, v89, v45, v97 bitop3:0x6a
    ds_write_b32 v98, v90 offset:0
    v_mov_b32_dpp v91, v64 quad_perm:[1,1,1,1] row_mask:0xf bank_mask:0xf
    v_and_b32 v89, 3, v91
    v_and_b32 v97, 0xfffc, v91
    v_sub_u16_dpp v88, v64, v91 quad_perm:[3,3,3,3] row_mask:0xf bank_mask:0xf
    v_mad_u32_u24 v97, v97, 5, v4
    v_add_u32 v99, v88, v89
    v_bfm_b32 v96, v88, v89
    v_cmp_lt_u32 s[58:59], 16, v99
    v_lshlrev_b32 v89, v1, v96
    v_and_b32 v89, v45, v89
    v_cmp_ne_u32 vcc, 0, v89
    v_xor_b32 v90, v97, v89
    s_add_u32 s3, s37, s38
    v_mbcnt_lo_u32_b32 v98, vcc_lo, 0
    v_mbcnt_hi_u32_b32 v98, vcc_hi, v98
    s_bcnt1_i32_b64 s41, vcc
    v_lshl_add_u32 v98, v98, 2, s3
    s_mov_b64 exec, vcc
    ds_write_b32 v98, v90
    s_mov_b64 exec, -1
    s_lshl2_add_u32 s37, s41, s37
    s_cmp_lg_u64 s[58:59], 0
    s_cbranch_scc1 L2_xe18
L2_xr18:
    v_add_u32 v98, s37, v0
    v_mov_b32 v90, -1
    ds_write_b32 v98, v90
    ds_read2st64_b32 v[40:41], v0 offset0:0 offset1:1
    ds_read2st64_b32 v[42:43], v0 offset0:2 offset1:3
    s_sub_u32 s3, s37, 768
    s_cmp_gt_u32 s3, 256
    s_cbranch_scc1 L2_xf18
L2_xg18:
    s_setprio 2
    s_waitcnt vmcnt(10)
    ds_write_b128 v3, v[108:111] offset:0
    s_waitcnt lgkmcnt(12)
    v_cmpx_ne_u64 vcc, v[74:75], v[70:71]
    s_and_b64 s[82:83], vcc, s[80:81]
    s_cbranch_scc1 L2_c19
L2_d19:
    v_mov_b64 v[84:85], v[70:71]
    v_mov_b32 v7, v95
    v_mov_b64 v[86:87], v[74:75]
    s_mov_b64 exec, -1
    s_or_b64 s[80:81], s[80:81], vcc
    v_cmpx_ne_u64 vcc, v[72:73], v[68:69]
    s_and_b64 s[82:83], vcc, s[80:81]
    s_cbranch_scc1 L2_c20
L2_d20:
    v_mov_b64 v[84:85], v[68:69]
    v_mov_b32 v7, v94
    v_mov_b64 v[86:87], v[72:73]
    s_mov_b64 exec, -1
    s_or_b64 s[80:81], s[80:81], vcc
    ds_read_b64 v[70:71], v93
    s_and_b64 exec, s[84:85], s[80:81]
    v_mfma_f32_4x4x4_16b_bf16 v[76:79], v[12:13], v[84:85], 0
    v_mov_b32 v92, v7
    s_andn2_b64 s[80:81], s[80:81], s[84:85]
    v_mfma_f32_4x4x4_16b_bf16 v[76:79], v[10:11], v[86:87], v[76:79]
    s_mov_b64 exec, -1
    ds_read_b64 v[68:69], v92
    s_setprio 1
    s_waitcnt vmcnt(9)
    ds_write_b128 v3, v[112:115] offset:1024
    s_waitcnt lgkmcnt(1)
    v_mfma_f32_4x4x4_16b_bf16 v[80:83], v[10:11], v[70:71], v[80:83]
    v_mfma_f32_4x4x4_16b_bf16 v[76:79], v[10:11], v[68:69], v[76:79]
    v_and_b32 v46, 0x40000000, v39
    v_bitop3_b32 v94, v36, v5, v46 bitop3:0xea
    v_and_b32 v46, 0x80000000, v39
    v_bitop3_b32 v95, v37, v5, v46 bitop3:0xea
    v_perm_b32 v15, v37, v38, s47
    v_bitop3_b32 v46, v37, 0.5, -0.5 bitop3:0xa8
    v_perm_b32 v14, v36, v38, s46
    v_bitop3_b32 v47, v36, 0.5, -0.5 bitop3:0xa8
    v_cvt_pk_bf16_f32 v80, v80, v81
    v_cvt_pk_bf16_f32 v81, v82, v83
    ds_wrxchg_rtn_b64 v[74:75], v93, v[80:81]
    v_cvt_pk_bf16_f32 v76, v76, v77
    v_cvt_pk_bf16_f32 v77, v78, v79
    ds_wrxchg_rtn_b64 v[72:73], v92, v[76:77]
    s_setprio 0
    v_mfma_f32_4x4x4_16b_bf16 v[80:83], v[8:9], v[106:107], 0
    v_mfma_f32_4x4x4_16b_bf16 v[76:79], v[8:9], v[104:105], 0
    v_bitop3_b32 v15, v6, v15, v46 bitop3:0xca
    v_bitop3_b32 v14, v6, v14, v47 bitop3:0xca
    s_nop 1
    v_pk_mul_f32 v[80:81], v[80:81], v[14:15] op_sel:[0,1] op_sel_hi:[1,1]
    v_pk_mul_f32 v[82:83], v[82:83], v[14:15] op_sel:[0,1] op_sel_hi:[1,1]
    v_pk_mul_f32 v[76:77], v[76:77], v[14:15] op_sel:[0,0] op_sel_hi:[1,0]
    v_pk_mul_f32 v[78:79], v[78:79], v[14:15] op_sel:[0,0] op_sel_hi:[1,0]
    s_add_u32 s42, s42, 1
    s_waitcnt lgkmcnt(2)
    s_barrier
    s_bitcmp1_b32 s36, s42
    s_cbranch_scc1 L2_slow
L2_ret1:
    s_setprio 3
    v_and_b32 v47, 0x0fffffff, v44
    v_mov_b32 v39, v44
    buffer_load_dwordx4 v[34:37], v47, s[8:11], 0 offen
    buffer_load_dwordx3 v[36:38], v47, s[8:11], 0 offen offset:8
    s_waitcnt lgkmcnt(0)
    v_cmpx_ne_u64 vcc, v[74:75], v[70:71]
    s_and_b64 s[82:83], vcc, s[80:81]
    s_cbranch_scc1 L2_c21
L2_d21:
    v_mov_b64 v[84:85], v[70:71]
    v_mov_b32 v7, v93
    v_mov_b64 v[86:87], v[74:75]
    s_mov_b64 exec, -1
    s_or_b64 s[80:81], s[80:81], vcc
    v_cmpx_ne_u64 vcc, v[72:73], v[68:69]
    s_and_b64 s[82:83], vcc, s[80:81]
    s_cbranch_scc1 L2_c22
L2_d22:
    v_mov_b64 v[84:85], v[68:69]
    v_mov_b32 v7, v92
    v_mov_b64 v[86:87], v[72:73]
    s_mov_b64 exec, -1
    s_or_b64 s[80:81], s[80:81], vcc
    ds_read_b64 v[70:71], v95
    ds_read_b64 v[68:69], v94
    s_waitcnt vmcnt(9)
    v_and_b32 v46, 0x20000000, v21
    v_lshrrev_b32 v47, 14, v17
    v_bitop3_b32 v47, v47, v5, v46 bitop3:0xea
    ds_read_b64 v[102:103], v47 offset:63616
    v_bitop3_b32 v93, v17, v5, v46 bitop3:0xea
    v_and_b32 v46, 0x10000000, v21
    v_lshrrev_b32 v47, 14, v16
    v_bitop3_b32 v47, v47, v5, v46 bitop3:0xea
    ds_read_b64 v[100:101], v47 offset:63616
    v_bitop3_b32 v92, v16, v5, v46 bitop3:0xea
    s_waitcnt lgkmcnt(2)
    v_mfma_f32_4x4x4_16b_bf16 v[80:83], v[10:11], v[70:71], v[80:83]
    v_mfma_f32_4x4x4_16b_bf16 v[76:79], v[10:11], v[68:69], v[76:79]
    v_perm_b32 v15, v17, v20, s45
    v_bitop3_b32 v46, v17, 0.5, -0.5 bitop3:0xa8
    v_perm_b32 v14, v16, v20, s44
    v_bitop3_b32 v47, v16, 0.5, -0.5 bitop3:0xa8
    v_cvt_pk_bf16_f32 v80, v80, v81
    v_cvt_pk_bf16_f32 v81, v82, v83
    ds_wrxchg_rtn_b64 v[74:75], v95, v[80:81]
    v_cvt_pk_bf16_f32 v76, v76, v77
    v_cvt_pk_bf16_f32 v77, v78, v79
    ds_wrxchg_rtn_b64 v[72:73], v94, v[76:77]
    s_waitcnt lgkmcnt(2)
    v_mfma_f32_4x4x4_16b_bf16 v[80:83], v[8:9], v[102:103], 0
    v_mfma_f32_4x4x4_16b_bf16 v[76:79], v[8:9], v[100:101], 0
    v_bitop3_b32 v15, v6, v15, v46 bitop3:0xca
    v_bitop3_b32 v14, v6, v14, v47 bitop3:0xca
    v_cmp_lt_u32 s[84:85], v5, v92
    s_nop 0
    v_pk_mul_f32 v[80:81], v[80:81], v[14:15] op_sel:[0,1] op_sel_hi:[1,1]
    v_pk_mul_f32 v[82:83], v[82:83], v[14:15] op_sel:[0,1] op_sel_hi:[1,1]
    v_pk_mul_f32 v[76:77], v[76:77], v[14:15] op_sel:[0,0] op_sel_hi:[1,0]
    v_pk_mul_f32 v[78:79], v[78:79], v[14:15] op_sel:[0,0] op_sel_hi:[1,0]
    buffer_load_dwordx4 v[108:111], v3, s[16:19], s40 offen offset:0
    s_waitcnt lgkmcnt(0)
    v_cmpx_ne_u64 vcc, v[74:75], v[70:71]
    s_and_b64 s[82:83], vcc, s[80:81]
    s_cbranch_scc1 L2_c23
L2_d23:
    v_mov_b64 v[84:85], v[70:71]
    v_mov_b32 v7, v95
    v_mov_b64 v[86:87], v[74:75]
    s_mov_b64 exec, -1
    s_or_b64 s[80:81], s[80:81], vcc
    v_cmpx_ne_u64 vcc, v[72:73], v[68:69]
    s_and_b64 s[82:83], vcc, s[80:81]
    s_cbranch_scc1 L2_c24
L2_d24:
    v_mov_b64 v[84:85], v[68:69]
    v_mov_b32 v7, v94
    v_mov_b64 v[86:87], v[72:73]
    s_mov_b64 exec, -1
    s_or_b64 s[80:81], s[80:81], vcc
    ds_read_b64 v[70:71], v93
    s_and_b64 exec, s[84:85], s[80:81]
    v_mfma_f32_4x4x4_16b_bf16 v[76:79], v[12:13], v[84:85], 0
    v_mov_b32 v92, v7
    s_andn2_b64 s[80:81], s[80:81], s[84:85]
    v_mfma_f32_4x4x4_16b_bf16 v[76:79], v[10:11], v[86:87], v[76:79]
    s_mov_b64 exec, -1
    ds_read_b64 v[68:69], v92
    v_and_b32 v46, 0x80000000, v21
    v_lshrrev_b32 v47, 14, v19
    v_bitop3_b32 v47, v47, v5, v46 bitop3:0xea
    ds_read_b64 v[106:107], v47 offset:63616
    v_bitop3_b32 v95, v19, v5, v46 bitop3:0xea
    v_and_b32 v46, 0x40000000, v21
    v_lshrrev_b32 v47, 14, v18
    v_bitop3_b32 v47, v47, v5, v46 bitop3:0xea
    ds_read_b64 v[104:105], v47 offset:63616
    v_bitop3_b32 v94, v18, v5, v46 bitop3:0xea
    s_waitcnt lgkmcnt(2)
    v_mfma_f32_4x4x4_16b_bf16 v[80:83], v[10:11], v[70:71], v[80:83]
    v_mfma_f32_4x4x4_16b_bf16 v[76:79], v[10:11], v[68:69], v[76:79]
    v_perm_b32 v15, v19, v20, s47
    v_bitop3_b32 v46, v19, 0.5, -0.5 bitop3:0xa8
    v_perm_b32 v14, v18, v20, s46
    v_bitop3_b32 v47, v18, 0.5, -0.5 bitop3:0xa8
    v_cvt_pk_bf16_f32 v80, v80, v81
    v_cvt_pk_bf16_f32 v81, v82, v83
    ds_wrxchg_rtn_b64 v[74:75], v93, v[80:81]
    v_cvt_pk_bf16_f32 v76, v76, v77
    v_cvt_pk_bf16_f32 v77, v78, v79
    ds_wrxchg_rtn_b64 v[72:73], v92, v[76:77]
    s_setprio 2
    s_waitcnt lgkmcnt(2)
    v_mfma_f32_4x4x4_16b_bf16 v[80:83], v[8:9], v[106:107], 0
    v_mfma_f32_4x4x4_16b_bf16 v[76:79], v[8:9], v[104:105], 0
    v_bitop3_b32 v15, v6, v15, v46 bitop3:0xca
    v_bitop3_b32 v14, v6, v14, v47 bitop3:0xca
    s_nop 1
    v_pk_mul_f32 v[80:81], v[80:81], v[14:15] op_sel:[0,1] op_sel_hi:[1,1]
    v_pk_mul_f32 v[82:83], v[82:83], v[14:15] op_sel:[0,1] op_sel_hi:[1,1]
    v_pk_mul_f32 v[76:77], v[76:77], v[14:15] op_sel:[0,0] op_sel_hi:[1,0]
    v_pk_mul_f32 v[78:79], v[78:79], v[14:15] op_sel:[0,0] op_sel_hi:[1,0]
    v_and_b32 v47, 0x0fffffff, v40
    v_mov_b32 v21, v40
    buffer_load_dwordx4 v[16:19], v47, s[8:11], 0 offen
    buffer_load_dwordx3 v[18:20], v47, s[8:11], 0 offen offset:8
    s_waitcnt lgkmcnt(0)
    v_cmpx_ne_u64 vcc, v[74:75], v[70:71]
    s_and_b64 s[82:83], vcc, s[80:81]
    s_cbranch_scc1 L2_c25
L2_d25:
    v_mov_b64 v[84:85], v[70:71]
    v_mov_b32 v7, v93
    v_mov_b64 v[86:87], v[74:75]
    s_mov_b64 exec, -1
    s_or_b64 s[80:81], s[80:81], vcc
    v_cmpx_ne_u64 vcc, v[72:73], v[68:69]
    s_and_b64 s[82:83], vcc, s[80:81]
    s_cbranch_scc1 L2_c26
L2_d26:
    v_mov_b64 v[84:85], v[68:69]
    v_mov_b32 v7, v92
    v_mov_b64 v[86:87], v[72:73]
    s_mov_b64 exec, -1
    s_or_b64 s[80:81], s[80:81], vcc
    ds_read_b64 v[70:71], v95
    ds_read_b64 v[68:69], v94
    s_waitcnt vmcnt(10)
    v_and_b32 v46, 0x20000000, v27
    v_lshrrev_b32 v47, 14, v23
    v_bitop3_b32 v47, v47, v5, v46 bitop3:0xea
    ds_read_b64 v[102:103], v47 offset:63616
    v_bitop3_b32 v93, v23, v5, v46 bitop3:0xea
    v_and_b32 v46, 0x10000000, v27
    v_lshrrev_b32 v47, 14, v22
    v_bitop3_b32 v47, v47, v5, v46 bitop3:0xea
    ds_read_b64 v[100:101], v47 offset:63616
    v_bitop3_b32 v92, v22, v5, v46 bitop3:0xea
    s_waitcnt lgkmcnt(2)
    v_mfma_f32_4x4x4_16b_bf16 v[80:83], v[10:11], v[70:71], v[80:83]
    v_mfma_f32_4x4x4_16b_bf16 v[76:79], v[10:11], v[68:69], v[76:79]
    v_perm_b32 v15, v23, v26, s45
    v_bitop3_b32 v46, v23, 0.5, -0.5 bitop3:0xa8
    v_perm_b32 v14, v22, v26, s44
    v_bitop3_b32 v47, v22, 0.5, -0.5 bitop3:0xa8
    v_cvt_pk_bf16_f32 v80, v80, v81
    v_cvt_pk_bf16_f32 v81, v82, v83
    ds_wrxchg_rtn_b64 v[74:75], v95, v[80:81]
    v_cvt_pk_bf16_f32 v76, v76, v77
    v_cvt_pk_bf16_f32 v77, v78, v79
    ds_wrxchg_rtn_b64 v[72:73], v94, v[76:77]
    s_waitcnt lgkmcnt(2)
    v_mfma_f32_4x4x4_16b_bf16 v[80:83], v[8:9], v[102:103], 0
    v_mfma_f32_4x4x4_16b_bf16 v[76:79], v[8:9], v[100:101], 0
    v_bitop3_b32 v15, v6, v15, v46 bitop3:0xca
    v_bitop3_b32 v14, v6, v14, v47 bitop3:0xca
    v_cmp_lt_u32 s[84:85], v5, v92
    s_nop 0
    v_pk_mul_f32 v[80:81], v[80:81], v[14:15] op_sel:[0,1] op_sel_hi:[1,1]
    v_pk_mul_f32 v[82:83], v[82:83], v[14:15] op_sel:[0,1] op_sel_hi:[1,1]
    v_pk_mul_f32 v[76:77], v[76:77], v[14:15] op_sel:[0,0] op_sel_hi:[1,0]
    v_pk_mul_f32 v[78:79], v[78:79], v[14:15] op_sel:[0,0] op_sel_hi:[1,0]
    v_sub_u16 v88, v62, v54
    v_and_b32 v89, 3, v54
    v_add3_u32 v99, v88, v89, 3
    v_and_b32 v99, -4, v99
    v_max_u32 v99, 4, v99
    v_and_b32 v97, 0xfffc, v54
    v_bfm_b32 v96, v88, v89
    v_add_u32_dpp v91, v99, v99 row_shr:1 row_mask:0xf bank_mask:0xf bound_ctrl:1
    v_mad_u32_u24 v97, v97, 5, v2
    v_cmp_lt_u32 vcc, 16, v99
    v_add_u32_dpp v91, v91, v91 row_shr:2 row_mask:0xf bank_mask:0xf bound_ctrl:1
    v_sub_u32 v98, s38, v99
    v_lshrrev_b64 v[54:55], 16, v[54:55]
    v_add_u32_dpp v91, v91, v91 row_shr:4 row_mask:0xf bank_mask:0xf bound_ctrl:1
    v_lshrrev_b64 v[62:63], 16, v[62:63]
    s_mov_b32 s43, 0
    v_add_u32_dpp v91, v91, v91 row_shr:8 row_mask:0xf bank_mask:0xf bound_ctrl:1
    s_nop 1
    v_add_u32_dpp v91, v91, v91 row_bcast:15 row_mask:0xa bank_mask:0xf
    s_nop 1
    v_add_u32_dpp v91, v91, v91 row_bcast:31 row_mask:0xc bank_mask:0xf
    v_add_u32 v98, v98, v91
    v_readlane_b32 s37, v91, 63
    s_cbranch_vccnz L2_xo27
L2_xp27:
    buffer_load_dwordx4 v[112:115], v3, s[16:19], s40 offen offset:1024
    s_waitcnt lgkmcnt(0)
    v_cmpx_ne_u64 vcc, v[74:75], v[70:71]
    s_and_b64 s[82:83], vcc, s[80:81]
    s_cbranch_scc1 L2_c28
L2_d28:
    v_mov_b64 v[84:85], v[70:71]
    v_mov_b32 v7, v95
    v_mov_b64 v[86:87], v[74:75]
    s_mov_b64 exec, -1
    s_or_b64 s[80:81], s[80:81], vcc
    v_cmpx_ne_u64 vcc, v[72:73], v[68:69]
    s_and_b64 s[82:83], vcc, s[80:81]
    s_cbranch_scc1 L2_c29
L2_d29:
    v_mov_b64 v[84:85], v[68:69]
    v_mov_b32 v7, v94
    v_mov_b64 v[86:87], v[72:73]
    s_mov_b64 exec, -1
    s_or_b64 s[80:81], s[80:81], vcc
    ds_read_b64 v[70:71], v93
    s_and_b64 exec, s[84:85], s[80:81]
    v_mfma_f32_4x4x4_16b_bf16 v[76:79], v[12:13], v[84:85], 0
    v_mov_b32 v92, v7
    s_andn2_b64 s[80:81], s[80:81], s[84:85]
    v_mfma_f32_4x4x4_16b_bf16 v[76:79], v[10:11], v[86:87], v[76:79]
    s_mov_b64 exec, -1
    ds_read_b64 v[68:69], v92
    v_and_b32 v46, 0x80000000, v27
    v_lshrrev_b32 v47, 14, v25
    v_bitop3_b32 v47, v47, v5, v46 bitop3:0xea
    ds_read_b64 v[106:107], v47 offset:63616
    v_bitop3_b32 v95, v25, v5, v46 bitop3:0xea
    v_and_b32 v46, 0x40000000, v27
    v_lshrrev_b32 v47, 14, v24
    v_bitop3_b32 v47, v47, v5, v46 bitop3:0xea
    ds_read_b64 v[104:105], v47 offset:63616
    v_bitop3_b32 v94, v24, v5, v46 bitop3:0xea
    s_waitcnt lgkmcnt(2)
    v_mfma_f32_4x4x4_16b_bf16 v[80:83], v[10:11], v[70:71], v[80:83]
    v_mfma_f32_4x4x4_16b_bf16 v[76:79], v[10:11], v[68:69], v[76:79]
    v_perm_b32 v15, v25, v26, s47
    v_bitop3_b32 v46, v25, 0.5, -0.5 bitop3:0xa8
    v_perm_b32 v14, v24, v26, s46
    v_bitop3_b32 v47, v24, 0.5, -0.5 bitop3:0xa8
    v_cvt_pk_bf16_f32 v80, v80, v81
    v_cvt_pk_bf16_f32 v81, v82, v83
    ds_wrxchg_rtn_b64 v[74:75], v93, v[80:81]
    v_cvt_pk_bf16_f32 v76, v76, v77
    v_cvt_pk_bf16_f32 v77, v78, v79
    ds_wrxchg_rtn_b64 v[72:73], v92, v[76:77]
    s_setprio 1
    s_waitcnt lgkmcnt(2)
    v_mfma_f32_4x4x4_16b_bf16 v[80:83], v[8:9], v[106:107], 0
    v_mfma_f32_4x4x4_16b_bf16 v[76:79], v[8:9], v[104:105], 0
    v_bitop3_b32 v15, v6, v15, v46 bitop3:0xca
    v_bitop3_b32 v14, v6, v14, v47 bitop3:0xca
    s_nop 1
    v_pk_mul_f32 v[80:81], v[80:81], v[14:15] op_sel:[0,1] op_sel_hi:[1,1]
    v_pk_mul_f32 v[82:83], v[82:83], v[14:15] op_sel:[0,1] op_sel_hi:[1,1]
    v_pk_mul_f32 v[76:77], v[76:77], v[14:15] op_sel:[0,0] op_sel_hi:[1,0]
    v_pk_mul_f32 v[78:79], v[78:79], v[14:15] op_sel:[0,0] op_sel_hi:[1,0]
    v_and_b32 v47, 0x0fffffff, v41
    v_mov_b32 v27, v41
    buffer_load_dwordx4 v[22:25], v47, s[8:11], 0 offen
    buffer_load_dwordx3 v[24:26], v47, s[8:11], 0 offen offset:8
    s_waitcnt lgkmcnt(0)
    v_cmpx_ne_u64 vcc, v[74:75], v[70:71]
    s_and_b64 s[82:83], vcc, s[80:81]
    s_cbranch_scc1 L2_c30
L2_d30:
    v_mov_b64 v[84:85], v[70:71]
    v_mov_b32 v7, v93
    v_mov_b64 v[86:87], v[74:75]
    s_mov_b64 exec, -1
    s_or_b64 s[80:81], s[80:81], vcc
    v_cmpx_ne_u64 vcc, v[72:73], v[68:69]
    s_and_b64 s[82:83], vcc, s[80:81]
    s_cbranch_scc1 L2_c31
L2_d31:
    v_mov_b64 v[84:85], v[68:69]
    v_mov_b32 v7, v92
    v_mov_b64 v[86:87], v[72:73]
    s_mov_b64 exec, -1
    s_or_b64 s[80:81], s[80:81], vcc
    ds_read_b64 v[70:71], v95
    ds_read_b64 v[68:69], v94
    s_waitcnt vmcnt(8)
    v_and_b32 v46, 0x20000000, v33
    v_lshrrev_b32 v47, 14, v29
    v_bitop3_b32 v47, v47, v5, v46 bitop3:0xea
    ds_read_b64 v[102:103], v47 offset:63616
    v_bitop3_b32 v93, v29, v5, v46 bitop3:0xea
    v_and_b32 v46, 0x10000000, v33
    v_lshrrev_b32 v47, 14, v28
    v_bitop3_b32 v47, v47, v5, v46 bitop3:0xea
    ds_read_b64 v[100:101], v47 offset:63616
    v_bitop3_b32 v92, v28, v5, v46 bitop3:0xea
    s_waitcnt lgkmcnt(2)
    v_mfma_f32_4x4x4_16b_bf16 v[80:83], v[10:11], v[70:71], v[80:83]
    v_mfma_f32_4x4x4_16b_bf16 v[76:79], v[10:11], v[68:69], v[76:79]
    v_perm_b32 v15, v29, v32, s45
    v_bitop3_b32 v46, v29, 0.5, -0.5 bitop3:0xa8
    v_perm_b32 v14, v28, v32, s44
    v_bitop3_b32 v47, v28, 0.5, -0.5 bitop3:0xa8
    v_cvt_pk_bf16_f32 v80, v80, v81
    v_cvt_pk_bf16_f32 v81, v82, v83
    ds_wrxchg_rtn_b64 v[74:75], v95, v[80:81]
    v_cvt_pk_bf16_f32 v76, v76, v77
    v_cvt_pk_bf16_f32 v77, v78, v79
    ds_wrxchg_rtn_b64 v[72:73], v94, v[76:77]
    s_waitcnt lgkmcnt(2)
    v_mfma_f32_4x4x4_16b_bf16 v[80:83], v[8:9], v[102:103], 0
    v_mfma_f32_4x4x4_16b_bf16 v[76:79], v[8:9], v[100:101], 0
    v_bitop3_b32 v15, v6, v15, v46 bitop3:0xca
    v_bitop3_b32 v14, v6, v14, v47 bitop3:0xca
    v_cmp_lt_u32 s[84:85], v5, v92
    s_nop 0
    v_pk_mul_f32 v[80:81], v[80:81], v[14:15] op_sel:[0,1] op_sel_hi:[1,1]
    v_pk_mul_f32 v[82:83], v[82:83], v[14:15] op_sel:[0,1] op_sel_hi:[1,1]
    v_pk_mul_f32 v[76:77], v[76:77], v[14:15] op_sel:[0,0] op_sel_hi:[1,0]
    v_pk_mul_f32 v[78:79], v[78:79], v[14:15] op_sel:[0,0] op_sel_hi:[1,0]
    s_waitcnt lgkmcnt(0)
    v_cmpx_ne_u64 vcc, v[74:75], v[70:71]
    s_and_b64 s[82:83], vcc, s[80:81]
    s_cbranch_scc1 L2_c32
L2_d32:
    v_mov_b64 v[84:85], v[70:71]
    v_mov_b32 v7, v95
    v_mov_b64 v[86:87], v[74:75]
    s_mov_b64 exec, -1
    s_or_b64 s[80:81], s[80:81], vcc
    v_cmpx_ne_u64 vcc, v[72:73], v[68:69]
    s_and_b64 s[82:83], vcc, s[80:81]
    s_cbranch_scc1 L2_c33
L2_d33:
    v_mov_b64 v[84:85], v[68:69]
    v_mov_b32 v7, v94
    v_mov_b64 v[86:87], v[72:73]
    s_mov_b64 exec, -1
    s_or_b64 s[80:81], s[80:81], vcc
    ds_read_b64 v[70:71], v93
    s_and_b64 exec, s[84:85], s[80:81]
    v_mfma_f32_4x4x4_16b_bf16 v[76:79], v[12:13], v[84:85], 0
    v_mov_b32 v92, v7
    s_andn2_b64 s[80:81], s[80:81], s[84:85]
    v_mfma_f32_4x4x4_16b_bf16 v[76:79], v[10:11], v[86:87], v[76:79]
    s_mov_b64 exec, -1
    ds_read_b64 v[68:69], v92
    v_and_b32 v46, 0x80000000, v33
    v_lshrrev_b32 v47, 14, v31
    v_bitop3_b32 v47, v47, v5, v46 bitop3:0xea
    ds_read_b64 v[106:107], v47 offset:63616
    v_bitop3_b32 v95, v31, v5, v46 bitop3:0xea
    v_and_b32 v46, 0x40000000, v33
    v_lshrrev_b32 v47, 14, v30
    v_bitop3_b32 v47, v47, v5, v46 bitop3:0xea
    ds_read_b64 v[104:105], v47 offset:63616
    v_bitop3_b32 v94, v30, v5, v46 bitop3:0xea
    s_waitcnt lgkmcnt(2)
    v_mfma_f32_4x4x4_16b_bf16 v[80:83], v[10:11], v[70:71], v[80:83]
    v_mfma_f32_4x4x4_16b_bf16 v[76:79], v[10:11], v[68:69], v[76:79]
    v_perm_b32 v15, v31, v32, s47
    v_bitop3_b32 v46, v31, 0.5, -0.5 bitop3:0xa8
    v_perm_b32 v14, v30, v32, s46
    v_bitop3_b32 v47, v30, 0.5, -0.5 bitop3:0xa8
    v_cvt_pk_bf16_f32 v80, v80, v81
    v_cvt_pk_bf16_f32 v81, v82, v83
    ds_wrxchg_rtn_b64 v[74:75], v93, v[80:81]
    v_cvt_pk_bf16_f32 v76, v76, v77
    v_cvt_pk_bf16_f32 v77, v78, v79
    ds_wrxchg_rtn_b64 v[72:73], v92, v[76:77]
    s_setprio 0
    s_waitcnt lgkmcnt(2)
    v_mfma_f32_4x4x4_16b_bf16 v[80:83], v[8:9], v[106:107], 0
    v_mfma_f32_4x4x4_16b_bf16 v[76:79], v[8:9], v[104:105], 0
    v_bitop3_b32 v15, v6, v15, v46 bitop3:0xca
    v_bitop3_b32 v14, v6, v14, v47 bitop3:0xca
    s_nop 1
    v_pk_mul_f32 v[80:81], v[80:81], v[14:15] op_sel:[0,1] op_sel_hi:[1,1]
    v_pk_mul_f32 v[82:83], v[82:83], v[14:15] op_sel:[0,1] op_sel_hi:[1,1]
    v_pk_mul_f32 v[76:77], v[76:77], v[14:15] op_sel:[0,0] op_sel_hi:[1,0]
    v_pk_mul_f32 v[78:79], v[78:79], v[14:15] op_sel:[0,0] op_sel_hi:[1,0]
    s_add_u32 s40, s40, 0x4e200
    v_and_b32 v47, 0x0fffffff, v42
    v_mov_b32 v33, v42
    buffer_load_dwordx4 v[28:31], v47, s[8:11], 0 offen
    buffer_load_dwordx3 v[30:32], v47, s[8:11], 0 offen offset:8
    s_waitcnt lgkmcnt(0)
    v_cmpx_ne_u64 vcc, v[74:75], v[70:71]
    s_and_b64 s[82:83], vcc, s[80:81]
    s_cbranch_scc1 L2_c34
L2_d34:
    v_mov_b64 v[84:85], v[70:71]
    v_mov_b32 v7, v93
    v_mov_b64 v[86:87], v[74:75]
    s_mov_b64 exec, -1
    s_or_b64 s[80:81], s[80:81], vcc
    v_cmpx_ne_u64 vcc, v[72:73], v[68:69]
    s_and_b64 s[82:83], vcc, s[80:81]
    s_cbranch_scc1 L2_c35
L2_d35:
    v_mov_b64 v[84:85], v[68:69]
    v_mov_b32 v7, v92
    v_mov_b64 v[86:87], v[72:73]
    s_mov_b64 exec, -1
    s_or_b64 s[80:81], s[80:81], vcc
    ds_read_b64 v[70:71], v95
    ds_read_b64 v[68:69], v94
    s_waitcnt vmcnt(8)
    v_and_b32 v46, 0x20000000, v39
    v_lshrrev_b32 v47, 14, v35
    v_bitop3_b32 v47, v47, v5, v46 bitop3:0xea
    ds_read_b64 v[102:103], v47 offset:63616
    v_bitop3_b32 v93, v35, v5, v46 bitop3:0xea
    v_and_b32 v46, 0x10000000, v39
    v_lshrrev_b32 v47, 14, v34
    v_bitop3_b32 v47, v47, v5, v46 bitop3:0xea
    ds_read_b64 v[100:101], v47 offset:63616
    v_bitop3_b32 v92, v34, v5, v46 bitop3:0xea
    v_and_b32 v46, 0x80000000, v39
    v_lshrrev_b32 v47, 14, v37
    v_bitop3_b32 v47, v47, v5, v46 bitop3:0xea
    ds_read_b64 v[106:107], v47 offset:63616
    v_and_b32 v46, 0x40000000, v39
    v_lshrrev_b32 v47, 14, v36
    v_bitop3_b32 v47, v47, v5, v46 bitop3:0xea
    ds_read_b64 v[104:105], v47 offset:63616
    s_waitcnt lgkmcnt(4)
    v_mfma_f32_4x4x4_16b_bf16 v[80:83], v[10:11], v[70:71], v[80:83]
    v_mfma_f32_4x4x4_16b_bf16 v[76:79], v[10:11], v[68:69], v[76:79]
    v_perm_b32 v15, v35, v38, s45
    v_bitop3_b32 v46, v35, 0.5, -0.5 bitop3:0xa8
    v_perm_b32 v14, v34, v38, s44
    v_bitop3_b32 v47, v34, 0.5, -0.5 bitop3:0xa8
    v_cvt_pk_bf16_f32 v80, v80, v81
    v_cvt_pk_bf16_f32 v81, v82, v83
    ds_wrxchg_rtn_b64 v[74:75], v95, v[80:81]
    v_cvt_pk_bf16_f32 v76, v76, v77
    v_cvt_pk_bf16_f32 v77, v78, v79
    ds_wrxchg_rtn_b64 v[72:73], v94, v[76:77]
    s_waitcnt lgkmcnt(2)
    s_barrier
    s_setprio 3
    ds_write_b128 v3, v[124:127] offset:4096
    s_add_u32 s3, s40, 4096
    buffer_load_dwordx4 v[124:127], v3, s[16:19], s3 offen
    ds_write_b128 v3, v[116:119] offset:2048
    buffer_load_dwordx4 v[116:119], v3, s[16:19], s40 offen offset:2048
    ds_write_b128 v3, v[120:123] offset:3072
    buffer_load_dwordx4 v[120:123], v3, s[16:19], s40 offen offset:3072
    v_mfma_f32_4x4x4_16b_bf16 v[80:83], v[8:9], v[102:103], 0
    v_mfma_f32_4x4x4_16b_bf16 v[76:79], v[8:9], v[100:101], 0
    v_bitop3_b32 v15, v6, v15, v46 bitop3:0xca
    v_bitop3_b32 v14, v6, v14, v47 bitop3:0xca
    v_cmp_lt_u32 s[84:85], v5, v92
    s_nop 0
    v_pk_mul_f32 v[80:81], v[80:81], v[14:15] op_sel:[0,1] op_sel_hi:[1,1]
    v_pk_mul_f32 v[82:83], v[82:83], v[14:15] op_sel:[0,1] op_sel_hi:[1,1]
    v_pk_mul_f32 v[76:77], v[76:77], v[14:15] op_sel:[0,0] op_sel_hi:[1,0]
    v_pk_mul_f32 v[78:79], v[78:79], v[14:15] op_sel:[0,0] op_sel_hi:[1,0]
    v_mov_b32 v44, v43
    s_cmp_gt_u32 s37, 1024
    s_cbranch_scc1 L2_xs36
    s_cmp_lg_u32 s43, 0
    s_cbranch_scc1 L2_xa36
L2_xb36:
    v_lshlrev_b32 v89, 16, v96
    v_add_u32 v90, 60, v97
    v_bitop3_b32 v90, v89, v45, v90 bitop3:0x6a
    ds_write_b32 v98, v90 offset:12
    v_lshlrev_b32 v89, 20, v96
    v_add_u32 v90, 40, v97
    v_bitop3_b32 v90, v89, v45, v90 bitop3:0x6a
    ds_write_b32 v98, v90 offset:8
    v_lshlrev_b32 v89, 24, v96
    v_add_u32 v90, 20, v97
    v_bitop3_b32 v90, v89, v45, v90 bitop3:0x6a
    ds_write_b32 v98, v90 offset:4
    v_lshlrev_b32 v89, 28, v96
    v_bitop3_b32 v90, v89, v45, v97 bitop3:0x6a
    ds_write_b32 v98, v90 offset:0
    v_mov_b32_dpp v91, v66 quad_perm:[1,1,1,1] row_mask:0xf bank_mask:0xf
    v_and_b32 v89, 3, v91
    v_and_b32 v97, 0xfffc, v91
    v_sub_u16_dpp v88, v66, v91 quad_perm:[3,3,3,3] row_mask:0xf bank_mask:0xf
    v_mad_u32_u24 v97, v97, 5, v4
    v_add_u32 v99, v88, v89
    v_bfm_b32 v96, v88, v89
    v_cmp_lt_u32 s[58:59], 16, v99
    v_lshlrev_b32 v89, v1, v96
    v_and_b32 v89, v45, v89
    v_cmp_ne_u32 vcc, 0, v89
    v_xor_b32 v90, v97, v89
    s_add_u32 s3, s37, s38
    v_mbcnt_lo_u32_b32 v98, vcc_lo, 0
    v_mbcnt_hi_u32_b32 v98, vcc_hi, v98
    s_bcnt1_i32_b64 s41, vcc
    v_lshl_add_u32 v98, v98, 2, s3
    s_mov_b64 exec, vcc
    ds_write_b32 v98, v90
    s_mov_b64 exec, -1
    s_lshl2_add_u32 s37, s41, s37
    s_cmp_lg_u64 s[58:59], 0
    s_cbranch_scc1 L2_xe36
L2_xr36:
    v_add_u32 v98, s37, v0
    v_mov_b32 v90, -1
    ds_write_b32 v98, v90
    ds_read2st64_b32 v[40:41], v0 offset0:0 offset1:1
    ds_read2st64_b32 v[42:43], v0 offset0:2 offset1:3
    s_sub_u32 s3, s37, 768
    s_cmp_gt_u32 s3, 256
    s_cbranch_scc1 L2_xf36
L2_xg36:
    v_lshrrev_b64 v[64:65], 16, v[64:65]
    v_lshrrev_b64 v[66:67], 16, v[66:67]
    s_setprio 2
    s_waitcnt vmcnt(10)
    ds_write_b128 v3, v[108:111] offset:0
    s_waitcnt lgkmcnt(12)
    v_cmpx_ne_u64 vcc, v[74:75], v[70:71]
    s_and_b64 s[82:83], vcc, s[80:81]
    s_cbranch_scc1 L2_c37
L2_d37:
    v_mov_b64 v[84:85], v[70:71]
    v_mov_b32 v7, v95
    v_mov_b64 v[86:87], v[74:75]
    s_mov_b64 exec, -1
    s_or_b64 s[80:81], s[80:81], vcc
    v_cmpx_ne_u64 vcc, v[72:73], v[68:69]
    s_and_b64 s[82:83], vcc, s[80:81]
    s_cbranch_scc1 L2_c38
L2_d38:
    v_mov_b64 v[84:85], v[68:69]
    v_mov_b32 v7, v94
    v_mov_b64 v[86:87], v[72:73]
    s_mov_b64 exec, -1
    s_or_b64 s[80:81], s[80:81], vcc
    ds_read_b64 v[70:71], v93
    s_and_b64 exec, s[84:85], s[80:81]
    v_mfma_f32_4x4x4_16b_bf16 v[76:79], v[12:13], v[84:85], 0
    v_mov_b32 v92, v7
    s_andn2_b64 s[80:81], s[80:81], s[84:85]
    v_mfma_f32_4x4x4_16b_bf16 v[76:79], v[10:11], v[86:87], v[76:79]
    s_mov_b64 exec, -1
    ds_read_b64 v[68:69], v92
    s_setprio 1
    s_waitcnt vmcnt(7)
    ds_write_b128 v3, v[112:115] offset:1024
    s_waitcnt lgkmcnt(1)
    v_mfma_f32_4x4x4_16b_bf16 v[80:83], v[10:11], v[70:71], v[80:83]
    v_mfma_f32_4x4x4_16b_bf16 v[76:79], v[10:11], v[68:69], v[76:79]
    v_and_b32 v46, 0x40000000, v39
    v_bitop3_b32 v94, v36, v5, v46 bitop3:0xea
    v_and_b32 v46, 0x80000000, v39
    v_bitop3_b32 v95, v37, v5, v46 bitop3:0xea
    v_perm_b32 v15, v37, v38, s47
    v_bitop3_b32 v46, v37, 0.5, -0.5 bitop3:0xa8
    v_perm_b32 v14, v36, v38, s46
    v_bitop3_b32 v47, v36, 0.5, -0.5 bitop3:0xa8
    v_cvt_pk_bf16_f32 v80, v80, v81
    v_cvt_pk_bf16_f32 v81, v82, v83
    ds_wrxchg_rtn_b64 v[74:75], v93, v[80:81]
    v_cvt_pk_bf16_f32 v76, v76, v77
    v_cvt_pk_bf16_f32 v77, v78, v79
    ds_wrxchg_rtn_b64 v[72:73], v92, v[76:77]
    s_setprio 0
    v_mfma_f32_4x4x4_16b_bf16 v[80:83], v[8:9], v[106:107], 0
    v_mfma_f32_4x4x4_16b_bf16 v[76:79], v[8:9], v[104:105], 0
    v_bitop3_b32 v15, v6, v15, v46 bitop3:0xca
    v_bitop3_b32 v14, v6, v14, v47 bitop3:0xca
    s_nop 1
    v_pk_mul_f32 v[80:81], v[80:81], v[14:15] op_sel:[0,1] op_sel_hi:[1,1]
    v_pk_mul_f32 v[82:83], v[82:83], v[14:15] op_sel:[0,1] op_sel_hi:[1,1]
    v_pk_mul_f32 v[76:77], v[76:77], v[14:15] op_sel:[0,0] op_sel_hi:[1,0]
    v_pk_mul_f32 v[78:79], v[78:79], v[14:15] op_sel:[0,0] op_sel_hi:[1,0]
    s_add_u32 s42, s42, 1
    s_waitcnt lgkmcnt(2)
L2_loop:
    s_barrier
    s_bitcmp1_b32 s36, s42
    s_cbranch_scc1 L2_slow
L2_ret2:
    s_setprio 3
    v_and_b32 v47, 0x0fffffff, v44
    v_mov_b32 v39, v44
    buffer_load_dwordx4 v[34:37], v47, s[8:11], 0 offen
    buffer_load_dwordx3 v[36:38], v47, s[8:11], 0 offen offset:8
    s_waitcnt lgkmcnt(0)
    v_cmpx_ne_u64 vcc, v[74:75], v[70:71]
    s_and_b64 s[82:83], vcc, s[80:81]
    s_cbranch_scc1 L2_c39
L2_d39:
    v_mov_b64 v[84:85], v[70:71]
    v_mov_b32 v7, v93
    v_mov_b64 v[86:87], v[74:75]
    s_mov_b64 exec, -1
    s_or_b64 s[80:81], s[80:81], vcc
    v_cmpx_ne_u64 vcc, v[72:73], v[68:69]
    s_and_b64 s[82:83], vcc, s[80:81]
    s_cbranch_scc1 L2_c40
L2_d40:
    v_mov_b64 v[84:85], v[68:69]
    v_mov_b32 v7, v92
    v_mov_b64 v[86:87], v[72:73]
    s_mov_b64 exec, -1
    s_or_b64 s[80:81], s[80:81], vcc
    ds_read_b64 v[70:71], v95
    ds_read_b64 v[68:69], v94
    v_and_b32 v46, 0x20000000, v21
    v_lshrrev_b32 v47, 14, v17
    v_bitop3_b32 v47, v47, v5, v46 bitop3:0xea
    ds_read_b64 v[102:103], v47 offset:63616
    v_bitop3_b32 v93, v17, v5, v46 bitop3:0xea
    v_and_b32 v46, 0x10000000, v21
    v_lshrrev_b32 v47, 14, v16
    v_bitop3_b32 v47, v47, v5, v46 bitop3:0xea
    ds_read_b64 v[100:101], v47 offset:63616
    v_bitop3_b32 v92, v16, v5, v46 bitop3:0xea
    s_waitcnt lgkmcnt(2)
    v_mfma_f32_4x4x4_16b_bf16 v[80:83], v[10:11], v[70:71], v[80:83]
    v_mfma_f32_4x4x4_16b_bf16 v[76:79], v[10:11], v[68:69], v[76:79]
    v_perm_b32 v15, v17, v20, s45
    v_bitop3_b32 v46, v17, 0.5, -0.5 bitop3:0xa8
    v_perm_b32 v14, v16, v20, s44
    v_bitop3_b32 v47, v16, 0.5, -0.5 bitop3:0xa8
    v_cvt_pk_bf16_f32 v80, v80, v81
    v_cvt_pk_bf16_f32 v81, v82, v83
    ds_wrxchg_rtn_b64 v[74:75], v95, v[80:81]
    v_cvt_pk_bf16_f32 v76, v76, v77
    v_cvt_pk_bf16_f32 v77, v78, v79
    ds_wrxchg_rtn_b64 v[72:73], v94, v[76:77]
    s_waitcnt lgkmcnt(2)
    v_mfma_f32_4x4x4_16b_bf16 v[80:83], v[8:9], v[102:103], 0
    v_mfma_f32_4x4x4_16b_bf16 v[76:79], v[8:9], v[100:101], 0
    v_bitop3_b32 v15, v6, v15, v46 bitop3:0xca
    v_bitop3_b32 v14, v6, v14, v47 bitop3:0xca
    v_cmp_lt_u32 s[84:85], v5, v92
    s_nop 0
    v_pk_mul_f32 v[80:81], v[80:81], v[14:15] op_sel:[0,1] op_sel_hi:[1,1]
    v_pk_mul_f32 v[82:83], v[82:83], v[14:15] op_sel:[0,1] op_sel_hi:[1,1]
    v_pk_mul_f32 v[76:77], v[76:77], v[14:15] op_sel:[0,0] op_sel_hi:[1,0]
    v_pk_mul_f32 v[78:79], v[78:79], v[14:15] op_sel:[0,0] op_sel_hi:[1,0]
    buffer_load_dwordx4 v[108:111], v3, s[16:19], s40 offen offset:0
    s_waitcnt lgkmcnt(0)
    v_cmpx_ne_u64 vcc, v[74:75], v[70:71]
    s_and_b64 s[82:83], vcc, s[80:81]
    s_cbranch_scc1 L2_c41
L2_d41:
    v_mov_b64 v[84:85], v[70:71]
    v_mov_b32 v7, v95
    v_mov_b64 v[86:87], v[74:75]
    s_mov_b64 exec, -1
    s_or_b64 s[80:81], s[80:81], vcc
    v_cmpx_ne_u64 vcc, v[72:73], v[68:69]
    s_and_b64 s[82:83], vcc, s[80:81]
    s_cbranch_scc1 L2_c42
L2_d42:
    v_mov_b64 v[84:85], v[68:69]
    v_mov_b32 v7, v94
    v_mov_b64 v[86:87], v[72:73]
    s_mov_b64 exec, -1
    s_or_b64 s[80:81], s[80:81], vcc
    ds_read_b64 v[70:71], v93
    s_and_b64 exec, s[84:85], s[80:81]
    v_mfma_f32_4x4x4_16b_bf16 v[76:79], v[12:13], v[84:85], 0
    v_mov_b32 v92, v7
    s_andn2_b64 s[80:81], s[80:81], s[84:85]
    v_mfma_f32_4x4x4_16b_bf16 v[76:79], v[10:11], v[86:87], v[76:79]
    s_mov_b64 exec, -1
    ds_read_b64 v[68:69], v92
    v_and_b32 v46, 0x80000000, v21
    v_lshrrev_b32 v47, 14, v19
    v_bitop3_b32 v47, v47, v5, v46 bitop3:0xea
    ds_read_b64 v[106:107], v47 offset:63616
    v_bitop3_b32 v95, v19, v5, v46 bitop3:0xea
    v_and_b32 v46, 0x40000000, v21
    v_lshrrev_b32 v47, 14, v18
    v_bitop3_b32 v47, v47, v5, v46 bitop3:0xea
    ds_read_b64 v[104:105], v47 offset:63616
    v_bitop3_b32 v94, v18, v5, v46 bitop3:0xea
    s_waitcnt lgkmcnt(2)
    v_mfma_f32_4x4x4_16b_bf16 v[80:83], v[10:11], v[70:71], v[80:83]
    v_mfma_f32_4x4x4_16b_bf16 v[76:79], v[10:11], v[68:69], v[76:79]
    v_perm_b32 v15, v19, v20, s47
    v_bitop3_b32 v46, v19, 0.5, -0.5 bitop3:0xa8
    v_perm_b32 v14, v18, v20, s46
    v_bitop3_b32 v47, v18, 0.5, -0.5 bitop3:0xa8
    v_cvt_pk_bf16_f32 v80, v80, v81
    v_cvt_pk_bf16_f32 v81, v82, v83
    ds_wrxchg_rtn_b64 v[74:75], v93, v[80:81]
    v_cvt_pk_bf16_f32 v76, v76, v77
    v_cvt_pk_bf16_f32 v77, v78, v79
    ds_wrxchg_rtn_b64 v[72:73], v92, v[76:77]
    s_setprio 2
    s_waitcnt lgkmcnt(2)
    v_mfma_f32_4x4x4_16b_bf16 v[80:83], v[8:9], v[106:107], 0
    v_mfma_f32_4x4x4_16b_bf16 v[76:79], v[8:9], v[104:105], 0
    v_bitop3_b32 v15, v6, v15, v46 bitop3:0xca
    v_bitop3_b32 v14, v6, v14, v47 bitop3:0xca
    s_nop 1
    v_pk_mul_f32 v[80:81], v[80:81], v[14:15] op_sel:[0,1] op_sel_hi:[1,1]
    v_pk_mul_f32 v[82:83], v[82:83], v[14:15] op_sel:[0,1] op_sel_hi:[1,1]
    v_pk_mul_f32 v[76:77], v[76:77], v[14:15] op_sel:[0,0] op_sel_hi:[1,0]
    v_pk_mul_f32 v[78:79], v[78:79], v[14:15] op_sel:[0,0] op_sel_hi:[1,0]
    v_and_b32 v47, 0x0fffffff, v40
    v_mov_b32 v21, v40
    buffer_load_dwordx4 v[16:19], v47, s[8:11], 0 offen
    buffer_load_dwordx3 v[18:20], v47, s[8:11], 0 offen offset:8
    s_waitcnt lgkmcnt(0)
    v_cmpx_ne_u64 vcc, v[74:75], v[70:71]
    s_and_b64 s[82:83], vcc, s[80:81]
    s_cbranch_scc1 L2_c43
L2_d43:
    v_mov_b64 v[84:85], v[70:71]
    v_mov_b32 v7, v93
    v_mov_b64 v[86:87], v[74:75]
    s_mov_b64 exec, -1
    s_or_b64 s[80:81], s[80:81], vcc
    v_cmpx_ne_u64 vcc, v[72:73], v[68:69]
    s_and_b64 s[82:83], vcc, s[80:81]
    s_cbranch_scc1 L2_c44
L2_d44:
    v_mov_b64 v[84:85], v[68:69]
    v_mov_b32 v7, v92
    v_mov_b64 v[86:87], v[72:73]
    s_mov_b64 exec, -1
    s_or_b64 s[80:81], s[80:81], vcc
    ds_read_b64 v[70:71], v95
    ds_read_b64 v[68:69], v94
    s_waitcnt vmcnt(10)
    v_and_b32 v46, 0x20000000, v27
    v_lshrrev_b32 v47, 14, v23
    v_bitop3_b32 v47, v47, v5, v46 bitop3:0xea
    ds_read_b64 v[102:103], v47 offset:63616
    v_bitop3_b32 v93, v23, v5, v46 bitop3:0xea
    v_and_b32 v46, 0x10000000, v27
    v_lshrrev_b32 v47, 14, v22
    v_bitop3_b32 v47, v47, v5, v46 bitop3:0xea
    ds_read_b64 v[100:101], v47 offset:63616
    v_bitop3_b32 v92, v22, v5, v46 bitop3:0xea
    s_waitcnt lgkmcnt(2)
    v_mfma_f32_4x4x4_16b_bf16 v[80:83], v[10:11], v[70:71], v[80:83]
    v_mfma_f32_4x4x4_16b_bf16 v[76:79], v[10:11], v[68:69], v[76:79]
    v_perm_b32 v15, v23, v26, s45
    v_bitop3_b32 v46, v23, 0.5, -0.5 bitop3:0xa8
    v_perm_b32 v14, v22, v26, s44
    v_bitop3_b32 v47, v22, 0.5, -0.5 bitop3:0xa8
    v_cvt_pk_bf16_f32 v80, v80, v81
    v_cvt_pk_bf16_f32 v81, v82, v83
    ds_wrxchg_rtn_b64 v[74:75], v95, v[80:81]
    v_cvt_pk_bf16_f32 v76, v76, v77
    v_cvt_pk_bf16_f32 v77, v78, v79
    ds_wrxchg_rtn_b64 v[72:73], v94, v[76:77]
    s_waitcnt lgkmcnt(2)
    v_mfma_f32_4x4x4_16b_bf16 v[80:83], v[8:9], v[102:103], 0
    v_mfma_f32_4x4x4_16b_bf16 v[76:79], v[8:9], v[100:101], 0
    v_bitop3_b32 v15, v6, v15, v46 bitop3:0xca
    v_bitop3_b32 v14, v6, v14, v47 bitop3:0xca
    v_cmp_lt_u32 s[84:85], v5, v92
    s_nop 0
    v_pk_mul_f32 v[80:81], v[80:81], v[14:15] op_sel:[0,1] op_sel_hi:[1,1]
    v_pk_mul_f32 v[82:83], v[82:83], v[14:15] op_sel:[0,1] op_sel_hi:[1,1]
    v_pk_mul_f32 v[76:77], v[76:77], v[14:15] op_sel:[0,0] op_sel_hi:[1,0]
    v_pk_mul_f32 v[78:79], v[78:79], v[14:15] op_sel:[0,0] op_sel_hi:[1,0]
    v_sub_u16 v88, v56, v48
    v_and_b32 v89, 3, v48
    v_add3_u32 v99, v88, v89, 3
    v_and_b32 v99, -4, v99
    v_max_u32 v99, 4, v99
    v_and_b32 v97, 0xfffc, v48
    v_bfm_b32 v96, v88, v89
    v_add_u32_dpp v91, v99, v99 row_shr:1 row_mask:0xf bank_mask:0xf bound_ctrl:1
    v_mad_u32_u24 v97, v97, 5, v2
    v_cmp_lt_u32 vcc, 16, v99
    v_add_u32_dpp v91, v91, v91 row_shr:2 row_mask:0xf bank_mask:0xf bound_ctrl:1
    v_sub_u32 v98, s38, v99
    v_lshrrev_b64 v[48:49], 16, v[48:49]
    v_add_u32_dpp v91, v91, v91 row_shr:4 row_mask:0xf bank_mask:0xf bound_ctrl:1
    v_lshrrev_b64 v[56:57], 16, v[56:57]
    s_mov_b32 s43, 0
    v_add_u32_dpp v91, v91, v91 row_shr:8 row_mask:0xf bank_mask:0xf bound_ctrl:1
    s_nop 1
    v_add_u32_dpp v91, v91, v91 row_bcast:15 row_mask:0xa bank_mask:0xf
    s_nop 1
    v_add_u32_dpp v91, v91, v91 row_bcast:31 row_mask:0xc bank_mask:0xf
    v_add_u32 v98, v98, v91
    v_readlane_b32 s37, v91, 63
    s_cbranch_vccnz L2_xo45
L2_xp45:
    buffer_load_dwordx4 v[112:115], v3, s[16:19], s40 offen offset:1024
    s_waitcnt lgkmcnt(0)
    v_cmpx_ne_u64 vcc, v[74:75], v[70:71]
    s_and_b64 s[82:83], vcc, s[80:81]
    s_cbranch_scc1 L2_c46
L2_d46:
    v_mov_b64 v[84:85], v[70:71]
    v_mov_b32 v7, v95
    v_mov_b64 v[86:87], v[74:75]
    s_mov_b64 exec, -1
    s_or_b64 s[80:81], s[80:81], vcc
    v_cmpx_ne_u64 vcc, v[72:73], v[68:69]
    s_and_b64 s[82:83], vcc, s[80:81]
    s_cbranch_scc1 L2_c47
L2_d47:
    v_mov_b64 v[84:85], v[68:69]
    v_mov_b32 v7, v94
    v_mov_b64 v[86:87], v[72:73]
    s_mov_b64 exec, -1
    s_or_b64 s[80:81], s[80:81], vcc
    ds_read_b64 v[70:71], v93
    s_and_b64 exec, s[84:85], s[80:81]
    v_mfma_f32_4x4x4_16b_bf16 v[76:79], v[12:13], v[84:85], 0
    v_mov_b32 v92, v7
    s_andn2_b64 s[80:81], s[80:81], s[84:85]
    v_mfma_f32_4x4x4_16b_bf16 v[76:79], v[10:11], v[86:87], v[76:79]
    s_mov_b64 exec, -1
    ds_read_b64 v[68:69], v92
    v_and_b32 v46, 0x80000000, v27
    v_lshrrev_b32 v47, 14, v25
    v_bitop3_b32 v47, v47, v5, v46 bitop3:0xea
    ds_read_b64 v[106:107], v47 offset:63616
    v_bitop3_b32 v95, v25, v5, v46 bitop3:0xea
    v_and_b32 v46, 0x40000000, v27
    v_lshrrev_b32 v47, 14, v24
    v_bitop3_b32 v47, v47, v5, v46 bitop3:0xea
    ds_read_b64 v[104:105], v47 offset:63616
    v_bitop3_b32 v94, v24, v5, v46 bitop3:0xea
    s_waitcnt lgkmcnt(2)
    v_mfma_f32_4x4x4_16b_bf16 v[80:83], v[10:11], v[70:71], v[80:83]
    v_mfma_f32_4x4x4_16b_bf16 v[76:79], v[10:11], v[68:69], v[76:79]
    v_perm_b32 v15, v25, v26, s47
    v_bitop3_b32 v46, v25, 0.5, -0.5 bitop3:0xa8
    v_perm_b32 v14, v24, v26, s46
    v_bitop3_b32 v47, v24, 0.5, -0.5 bitop3:0xa8
    v_cvt_pk_bf16_f32 v80, v80, v81
    v_cvt_pk_bf16_f32 v81, v82, v83
    ds_wrxchg_rtn_b64 v[74:75], v93, v[80:81]
    v_cvt_pk_bf16_f32 v76, v76, v77
    v_cvt_pk_bf16_f32 v77, v78, v79
    ds_wrxchg_rtn_b64 v[72:73], v92, v[76:77]
    s_setprio 1
    s_waitcnt lgkmcnt(2)
    v_mfma_f32_4x4x4_16b_bf16 v[80:83], v[8:9], v[106:107], 0
    v_mfma_f32_4x4x4_16b_bf16 v[76:79], v[8:9], v[104:105], 0
    v_bitop3_b32 v15, v6, v15, v46 bitop3:0xca
    v_bitop3_b32 v14, v6, v14, v47 bitop3:0xca
    s_nop 1
    v_pk_mul_f32 v[80:81], v[80:81], v[14:15] op_sel:[0,1] op_sel_hi:[1,1]
    v_pk_mul_f32 v[82:83], v[82:83], v[14:15] op_sel:[0,1] op_sel_hi:[1,1]
    v_pk_mul_f32 v[76:77], v[76:77], v[14:15] op_sel:[0,0] op_sel_hi:[1,0]
    v_pk_mul_f32 v[78:79], v[78:79], v[14:15] op_sel:[0,0] op_sel_hi:[1,0]
    v_and_b32 v47, 0x0fffffff, v41
    v_mov_b32 v27, v41
    buffer_load_dwordx4 v[22:25], v47, s[8:11], 0 offen
    buffer_load_dwordx3 v[24:26], v47, s[8:11], 0 offen offset:8
    s_waitcnt lgkmcnt(0)
    v_cmpx_ne_u64 vcc, v[74:75], v[70:71]
    s_and_b64 s[82:83], vcc, s[80:81]
    s_cbranch_scc1 L2_c48
L2_d48:
    v_mov_b64 v[84:85], v[70:71]
    v_mov_b32 v7, v93
    v_mov_b64 v[86:87], v[74:75]
    s_mov_b64 exec, -1
    s_or_b64 s[80:81], s[80:81], vcc
    v_cmpx_ne_u64 vcc, v[72:73], v[68:69]
    s_and_b64 s[82:83], vcc, s[80:81]
    s_cbranch_scc1 L2_c49
L2_d49:
    v_mov_b64 v[84:85], v[68:69]
    v_mov_b32 v7, v92
    v_mov_b64 v[86:87], v[72:73]
    s_mov_b64 exec, -1
    s_or_b64 s[80:81], s[80:81], vcc
    ds_read_b64 v[70:71], v95
    ds_read_b64 v[68:69], v94
    s_waitcnt vmcnt(11)
    v_and_b32 v46, 0x20000000, v33
    v_lshrrev_b32 v47, 14, v29
    v_bitop3_b32 v47, v47, v5, v46 bitop3:0xea
    ds_read_b64 v[102:103], v47 offset:63616
    v_bitop3_b32 v93, v29, v5, v46 bitop3:0xea
    v_and_b32 v46, 0x10000000, v33
    v_lshrrev_b32 v47, 14, v28
    v_bitop3_b32 v47, v47, v5, v46 bitop3:0xea
    ds_read_b64 v[100:101], v47 offset:63616
    v_bitop3_b32 v92, v28, v5, v46 bitop3:0xea
    s_waitcnt lgkmcnt(2)
    v_mfma_f32_4x4x4_16b_bf16 v[80:83], v[10:11], v[70:71], v[80:83]
    v_mfma_f32_4x4x4_16b_bf16 v[76:79], v[10:11], v[68:69], v[76:79]
    v_perm_b32 v15, v29, v32, s45
    v_bitop3_b32 v46, v29, 0.5, -0.5 bitop3:0xa8
    v_perm_b32 v14, v28, v32, s44
    v_bitop3_b32 v47, v28, 0.5, -0.5 bitop3:0xa8
    v_cvt_pk_bf16_f32 v80, v80, v81
    v_cvt_pk_bf16_f32 v81, v82, v83
    ds_wrxchg_rtn_b64 v[74:75], v95, v[80:81]
    v_cvt_pk_bf16_f32 v76, v76, v77
    v_cvt_pk_bf16_f32 v77, v78, v79
    ds_wrxchg_rtn_b64 v[72:73], v94, v[76:77]
    s_waitcnt lgkmcnt(2)
    v_mfma_f32_4x4x4_16b_bf16 v[80:83], v[8:9], v[102:103], 0
    v_mfma_f32_4x4x4_16b_bf16 v[76:79], v[8:9], v[100:101], 0
    v_bitop3_b32 v15, v6, v15, v46 bitop3:0xca
    v_bitop3_b32 v14, v6, v14, v47 bitop3:0xca
    v_cmp_lt_u32 s[84:85], v5, v92
    s_nop 0
    v_pk_mul_f32 v[80:81], v[80:81], v[14:15] op_sel:[0,1] op_sel_hi:[1,1]
    v_pk_mul_f32 v[82:83], v[82:83], v[14:15] op_sel:[0,1] op_sel_hi:[1,1]
    v_pk_mul_f32 v[76:77], v[76:77], v[14:15] op_sel:[0,0] op_sel_hi:[1,0]
    v_pk_mul_f32 v[78:79], v[78:79], v[14:15] op_sel:[0,0] op_sel_hi:[1,0]
    s_waitcnt lgkmcnt(0)
    v_cmpx_ne_u64 vcc, v[74:75], v[70:71]
    s_and_b64 s[82:83], vcc, s[80:81]
    s_cbranch_scc1 L2_c50
L2_d50:
    v_mov_b64 v[84:85], v[70:71]
    v_mov_b32 v7, v95
    v_mov_b64 v[86:87], v[74:75]
    s_mov_b64 exec, -1
    s_or_b64 s[80:81], s[80:81], vcc
    v_cmpx_ne_u64 vcc, v[72:73], v[68:69]
    s_and_b64 s[82:83], vcc, s[80:81]
    s_cbranch_scc1 L2_c51
L2_d51:
    v_mov_b64 v[84:85], v[68:69]
    v_mov_b32 v7, v94
    v_mov_b64 v[86:87], v[72:73]
    s_mov_b64 exec, -1
    s_or_b64 s[80:81], s[80:81], vcc
    ds_read_b64 v[70:71], v93
    s_and_b64 exec, s[84:85], s[80:81]
    v_mfma_f32_4x4x4_16b_bf16 v[76:79], v[12:13], v[84:85], 0
    v_mov_b32 v92, v7
    s_andn2_b64 s[80:81], s[80:81], s[84:85]
    v_mfma_f32_4x4x4_16b_bf16 v[76:79], v[10:11], v[86:87], v[76:79]
    s_mov_b64 exec, -1
    ds_read_b64 v[68:69], v92
    v_and_b32 v46, 0x80000000, v33
    v_lshrrev_b32 v47, 14, v31
    v_bitop3_b32 v47, v47, v5, v46 bitop3:0xea
    ds_read_b64 v[106:107], v47 offset:63616
    v_bitop3_b32 v95, v31, v5, v46 bitop3:0xea
    v_and_b32 v46, 0x40000000, v33
    v_lshrrev_b32 v47, 14, v30
    v_bitop3_b32 v47, v47, v5, v46 bitop3:0xea
    ds_read_b64 v[104:105], v47 offset:63616
    v_bitop3_b32 v94, v30, v5, v46 bitop3:0xea
    s_waitcnt lgkmcnt(2)
    v_mfma_f32_4x4x4_16b_bf16 v[80:83], v[10:11], v[70:71], v[80:83]
    v_mfma_f32_4x4x4_16b_bf16 v[76:79], v[10:11], v[68:69], v[76:79]
    v_perm_b32 v15, v31, v32, s47
    v_bitop3_b32 v46, v31, 0.5, -0.5 bitop3:0xa8
    v_perm_b32 v14, v30, v32, s46
    v_bitop3_b32 v47, v30, 0.5, -0.5 bitop3:0xa8
    v_cvt_pk_bf16_f32 v80, v80, v81
    v_cvt_pk_bf16_f32 v81, v82, v83
    ds_wrxchg_rtn_b64 v[74:75], v93, v[80:81]
    v_cvt_pk_bf16_f32 v76, v76, v77
    v_cvt_pk_bf16_f32 v77, v78, v79
    ds_wrxchg_rtn_b64 v[72:73], v92, v[76:77]
    s_setprio 0
    s_waitcnt lgkmcnt(2)
    v_mfma_f32_4x4x4_16b_bf16 v[80:83], v[8:9], v[106:107], 0
    v_mfma_f32_4x4x4_16b_bf16 v[76:79], v[8:9], v[104:105], 0
    v_bitop3_b32 v15, v6, v15, v46 bitop3:0xca
    v_bitop3_b32 v14, v6, v14, v47 bitop3:0xca
    s_nop 1
    v_pk_mul_f32 v[80:81], v[80:81], v[14:15] op_sel:[0,1] op_sel_hi:[1,1]
    v_pk_mul_f32 v[82:83], v[82:83], v[14:15] op_sel:[0,1] op_sel_hi:[1,1]
    v_pk_mul_f32 v[76:77], v[76:77], v[14:15] op_sel:[0,0] op_sel_hi:[1,0]
    v_pk_mul_f32 v[78:79], v[78:79], v[14:15] op_sel:[0,0] op_sel_hi:[1,0]
    s_add_u32 s40, s40, 0xfff29280
    v_and_b32 v47, 0x0fffffff, v42
    v_mov_b32 v33, v42
    buffer_load_dwordx4 v[28:31], v47, s[8:11], 0 offen
    buffer_load_dwordx3 v[30:32], v47, s[8:11], 0 offen offset:8
    s_waitcnt lgkmcnt(0)
    v_cmpx_ne_u64 vcc, v[74:75], v[70:71]
    s_and_b64 s[82:83], vcc, s[80:81]
    s_cbranch_scc1 L2_c52
L2_d52:
    v_mov_b64 v[84:85], v[70:71]
    v_mov_b32 v7, v93
    v_mov_b64 v[86:87], v[74:75]
    s_mov_b64 exec, -1
    s_or_b64 s[80:81], s[80:81], vcc
    v_cmpx_ne_u64 vcc, v[72:73], v[68:69]
    s_and_b64 s[82:83], vcc, s[80:81]
    s_cbranch_scc1 L2_c53
L2_d53:
    v_mov_b64 v[84:85], v[68:69]
    v_mov_b32 v7, v92
    v_mov_b64 v[86:87], v[72:73]
    s_mov_b64 exec, -1
    s_or_b64 s[80:81], s[80:81], vcc
    ds_read_b64 v[70:71], v95
    ds_read_b64 v[68:69], v94
    s_waitcnt vmcnt(8)
    v_and_b32 v46, 0x20000000, v39
    v_lshrrev_b32 v47, 14, v35
    v_bitop3_b32 v47, v47, v5, v46 bitop3:0xea
    ds_read_b64 v[102:103], v47 offset:63616
    v_bitop3_b32 v93, v35, v5, v46 bitop3:0xea
    v_and_b32 v46, 0x10000000, v39
    v_lshrrev_b32 v47, 14, v34
    v_bitop3_b32 v47, v47, v5, v46 bitop3:0xea
    ds_read_b64 v[100:101], v47 offset:63616
    v_bitop3_b32 v92, v34, v5, v46 bitop3:0xea
    v_and_b32 v46, 0x80000000, v39
    v_lshrrev_b32 v47, 14, v37
    v_bitop3_b32 v47, v47, v5, v46 bitop3:0xea
    ds_read_b64 v[106:107], v47 offset:63616
    v_and_b32 v46, 0x40000000, v39
    v_lshrrev_b32 v47, 14, v36
    v_bitop3_b32 v47, v47, v5, v46 bitop3:0xea
    ds_read_b64 v[104:105], v47 offset:63616
    s_waitcnt lgkmcnt(4)
    v_mfma_f32_4x4x4_16b_bf16 v[80:83], v[10:11], v[70:71], v[80:83]
    v_mfma_f32_4x4x4_16b_bf16 v[76:79], v[10:11], v[68:69], v[76:79]
    v_perm_b32 v15, v35, v38, s45
    v_bitop3_b32 v46, v35, 0.5, -0.5 bitop3:0xa8
    v_perm_b32 v14, v34, v38, s44
    v_bitop3_b32 v47, v34, 0.5, -0.5 bitop3:0xa8
    v_cvt_pk_bf16_f32 v80, v80, v81
    v_cvt_pk_bf16_f32 v81, v82, v83
    ds_wrxchg_rtn_b64 v[74:75], v95, v[80:81]
    v_cvt_pk_bf16_f32 v76, v76, v77
    v_cvt_pk_bf16_f32 v77, v78, v79
    ds_wrxchg_rtn_b64 v[72:73], v94, v[76:77]
    s_waitcnt lgkmcnt(2)
    s_barrier
    s_setprio 3
    ds_write_b128 v3, v[124:127] offset:4096
    s_add_u32 s3, s40, 4096
    buffer_load_dwordx4 v[124:127], v3, s[16:19], s3 offen
    ds_write_b128 v3, v[116:119] offset:2048
    buffer_load_dwordx4 v[116:119], v3, s[16:19], s40 offen offset:2048
    ds_write_b128 v3, v[120:123] offset:3072
    buffer_load_dwordx4 v[120:123], v3, s[16:19], s40 offen offset:3072
    v_mfma_f32_4x4x4_16b_bf16 v[80:83], v[8:9], v[102:103], 0
    v_mfma_f32_4x4x4_16b_bf16 v[76:79], v[8:9], v[100:101], 0
    v_bitop3_b32 v15, v6, v15, v46 bitop3:0xca
    v_bitop3_b32 v14, v6, v14, v47 bitop3:0xca
    v_cmp_lt_u32 s[84:85], v5, v92
    s_nop 0
    v_pk_mul_f32 v[80:81], v[80:81], v[14:15] op_sel:[0,1] op_sel_hi:[1,1]
    v_pk_mul_f32 v[82:83], v[82:83], v[14:15] op_sel:[0,1] op_sel_hi:[1,1]
    v_pk_mul_f32 v[76:77], v[76:77], v[14:15] op_sel:[0,0] op_sel_hi:[1,0]
    v_pk_mul_f32 v[78:79], v[78:79], v[14:15] op_sel:[0,0] op_sel_hi:[1,0]
    v_mov_b32 v44, v43
    s_cmp_gt_u32 s37, 1024
    s_cbranch_scc1 L2_xs54
    s_cmp_lg_u32 s43, 0
    s_cbranch_scc1 L2_xa54
L2_xb54:
    v_lshlrev_b32 v89, 16, v96
    v_add_u32 v90, 60, v97
    v_bitop3_b32 v90, v89, v45, v90 bitop3:0x6a
    ds_write_b32 v98, v90 offset:12
    v_lshlrev_b32 v89, 20, v96
    v_add_u32 v90, 40, v97
    v_bitop3_b32 v90, v89, v45, v90 bitop3:0x6a
    ds_write_b32 v98, v90 offset:8
    v_lshlrev_b32 v89, 24, v96
    v_add_u32 v90, 20, v97
    v_bitop3_b32 v90, v89, v45, v90 bitop3:0x6a
    ds_write_b32 v98, v90 offset:4
    v_lshlrev_b32 v89, 28, v96
    v_bitop3_b32 v90, v89, v45, v97 bitop3:0x6a
    ds_write_b32 v98, v90 offset:0
    v_mov_b32_dpp v91, v64 quad_perm:[0,0,0,0] row_mask:0xf bank_mask:0xf
    v_and_b32 v89, 3, v91
    v_and_b32 v97, 0xfffc, v91
    v_sub_u16_dpp v88, v64, v91 quad_perm:[2,2,2,2] row_mask:0xf bank_mask:0xf
    v_mad_u32_u24 v97, v97, 5, v4
    v_add_u32 v99, v88, v89
    v_bfm_b32 v96, v88, v89
    v_cmp_lt_u32 s[58:59], 16, v99
    v_lshlrev_b32 v89, v1, v96
    v_and_b32 v89, v45, v89
    v_cmp_ne_u32 vcc, 0, v89
    v_xor_b32 v90, v97, v89
    s_add_u32 s3, s37, s38
    v_mbcnt_lo_u32_b32 v98, vcc_lo, 0
    v_mbcnt_hi_u32_b32 v98, vcc_hi, v98
    s_bcnt1_i32_b64 s41, vcc
    v_lshl_add_u32 v98, v98, 2, s3
    s_mov_b64 exec, vcc
    ds_write_b32 v98, v90
    s_mov_b64 exec, -1
    s_lshl2_add_u32 s37, s41, s37
    s_cmp_lg_u64 s[58:59], 0
    s_cbranch_scc1 L2_xe54
L2_xr54:
    v_add_u32 v98, s37, v0
    v_mov_b32 v90, -1
    ds_write_b32 v98, v90
    ds_read2st64_b32 v[40:41], v0 offset0:0 offset1:1
    ds_read2st64_b32 v[42:43], v0 offset0:2 offset1:3
    s_sub_u32 s3, s37, 768
    s_cmp_gt_u32 s3, 256
    s_cbranch_scc1 L2_xf54
L2_xg54:
    s_setprio 2
    s_waitcnt vmcnt(10)
    ds_write_b128 v3, v[108:111] offset:0
    s_waitcnt lgkmcnt(12)
    v_cmpx_ne_u64 vcc, v[74:75], v[70:71]
    s_and_b64 s[82:83], vcc, s[80:81]
    s_cbranch_scc1 L2_c55
L2_d55:
    v_mov_b64 v[84:85], v[70:71]
    v_mov_b32 v7, v95
    v_mov_b64 v[86:87], v[74:75]
    s_mov_b64 exec, -1
    s_or_b64 s[80:81], s[80:81], vcc
    v_cmpx_ne_u64 vcc, v[72:73], v[68:69]
    s_and_b64 s[82:83], vcc, s[80:81]
    s_cbranch_scc1 L2_c56
L2_d56:
    v_mov_b64 v[84:85], v[68:69]
    v_mov_b32 v7, v94
    v_mov_b64 v[86:87], v[72:73]
    s_mov_b64 exec, -1
    s_or_b64 s[80:81], s[80:81], vcc
    ds_read_b64 v[70:71], v93
    s_and_b64 exec, s[84:85], s[80:81]
    v_mfma_f32_4x4x4_16b_bf16 v[76:79], v[12:13], v[84:85], 0
    v_mov_b32 v92, v7
    s_andn2_b64 s[80:81], s[80:81], s[84:85]
    v_mfma_f32_4x4x4_16b_bf16 v[76:79], v[10:11], v[86:87], v[76:79]
    s_mov_b64 exec, -1
    ds_read_b64 v[68:69], v92
    s_setprio 1
    s_waitcnt vmcnt(7)
    ds_write_b128 v3, v[112:115] offset:1024
    s_waitcnt lgkmcnt(1)
    v_mfma_f32_4x4x4_16b_bf16 v[80:83], v[10:11], v[70:71], v[80:83]
    v_mfma_f32_4x4x4_16b_bf16 v[76:79], v[10:11], v[68:69], v[76:79]
    v_and_b32 v46, 0x40000000, v39
    v_bitop3_b32 v94, v36, v5, v46 bitop3:0xea
    v_and_b32 v46, 0x80000000, v39
    v_bitop3_b32 v95, v37, v5, v46 bitop3:0xea
    v_perm_b32 v15, v37, v38, s47
    v_bitop3_b32 v46, v37, 0.5, -0.5 bitop3:0xa8
    v_perm_b32 v14, v36, v38, s46
    v_bitop3_b32 v47, v36, 0.5, -0.5 bitop3:0xa8
    v_cvt_pk_bf16_f32 v80, v80, v81
    v_cvt_pk_bf16_f32 v81, v82, v83
    ds_wrxchg_rtn_b64 v[74:75], v93, v[80:81]
    v_cvt_pk_bf16_f32 v76, v76, v77
    v_cvt_pk_bf16_f32 v77, v78, v79
    ds_wrxchg_rtn_b64 v[72:73], v92, v[76:77]
    s_setprio 0
    v_mfma_f32_4x4x4_16b_bf16 v[80:83], v[8:9], v[106:107], 0
    v_mfma_f32_4x4x4_16b_bf16 v[76:79], v[8:9], v[104:105], 0
    v_bitop3_b32 v15, v6, v15, v46 bitop3:0xca
    v_bitop3_b32 v14, v6, v14, v47 bitop3:0xca
    s_nop 1
    v_pk_mul_f32 v[80:81], v[80:81], v[14:15] op_sel:[0,1] op_sel_hi:[1,1]
    v_pk_mul_f32 v[82:83], v[82:83], v[14:15] op_sel:[0,1] op_sel_hi:[1,1]
    v_pk_mul_f32 v[76:77], v[76:77], v[14:15] op_sel:[0,0] op_sel_hi:[1,0]
    v_pk_mul_f32 v[78:79], v[78:79], v[14:15] op_sel:[0,0] op_sel_hi:[1,0]
    s_add_u32 s42, s42, 1
    s_waitcnt lgkmcnt(2)
    s_barrier
    s_bitcmp1_b32 s36, s42
    s_cbranch_scc1 L2_slow
L2_ret3:
    s_setprio 3
    v_and_b32 v47, 0x0fffffff, v44
    v_mov_b32 v39, v44
    buffer_load_dwordx4 v[34:37], v47, s[8:11], 0 offen
    buffer_load_dwordx3 v[36:38], v47, s[8:11], 0 offen offset:8
    s_waitcnt lgkmcnt(0)
    v_cmpx_ne_u64 vcc, v[74:75], v[70:71]
    s_and_b64 s[82:83], vcc, s[80:81]
    s_cbranch_scc1 L2_c57
L2_d57:
    v_mov_b64 v[84:85], v[70:71]
    v_mov_b32 v7, v93
    v_mov_b64 v[86:87], v[74:75]
    s_mov_b64 exec, -1
    s_or_b64 s[80:81], s[80:81], vcc
    v_cmpx_ne_u64 vcc, v[72:73], v[68:69]
    s_and_b64 s[82:83], vcc, s[80:81]
    s_cbranch_scc1 L2_c58
L2_d58:
    v_mov_b64 v[84:85], v[68:69]
    v_mov_b32 v7, v92
    v_mov_b64 v[86:87], v[72:73]
    s_mov_b64 exec, -1
    s_or_b64 s[80:81], s[80:81], vcc
    ds_read_b64 v[70:71], v95
    ds_read_b64 v[68:69], v94
    v_and_b32 v46, 0x20000000, v21
    v_lshrrev_b32 v47, 14, v17
    v_bitop3_b32 v47, v47, v5, v46 bitop3:0xea
    ds_read_b64 v[102:103], v47 offset:63616
    v_bitop3_b32 v93, v17, v5, v46 bitop3:0xea
    v_and_b32 v46, 0x10000000, v21
    v_lshrrev_b32 v47, 14, v16
    v_bitop3_b32 v47, v47, v5, v46 bitop3:0xea
    ds_read_b64 v[100:101], v47 offset:63616
    v_bitop3_b32 v92, v16, v5, v46 bitop3:0xea
    s_waitcnt lgkmcnt(2)
    v_mfma_f32_4x4x4_16b_bf16 v[80:83], v[10:11], v[70:71], v[80:83]
    v_mfma_f32_4x4x4_16b_bf16 v[76:79], v[10:11], v[68:69], v[76:79]
    v_perm_b32 v15, v17, v20, s45
    v_bitop3_b32 v46, v17, 0.5, -0.5 bitop3:0xa8
    v_perm_b32 v14, v16, v20, s44
    v_bitop3_b32 v47, v16, 0.5, -0.5 bitop3:0xa8
    v_cvt_pk_bf16_f32 v80, v80, v81
    v_cvt_pk_bf16_f32 v81, v82, v83
    ds_wrxchg_rtn_b64 v[74:75], v95, v[80:81]
    v_cvt_pk_bf16_f32 v76, v76, v77
    v_cvt_pk_bf16_f32 v77, v78, v79
    ds_wrxchg_rtn_b64 v[72:73], v94, v[76:77]
    s_waitcnt lgkmcnt(2)
    v_mfma_f32_4x4x4_16b_bf16 v[80:83], v[8:9], v[102:103], 0
    v_mfma_f32_4x4x4_16b_bf16 v[76:79], v[8:9], v[100:101], 0
    v_bitop3_b32 v15, v6, v15, v46 bitop3:0xca
    v_bitop3_b32 v14, v6, v14, v47 bitop3:0xca
    v_cmp_lt_u32 s[84:85], v5, v92
    s_nop 0
    v_pk_mul_f32 v[80:81], v[80:81], v[14:15] op_sel:[0,1] op_sel_hi:[1,1]
    v_pk_mul_f32 v[82:83], v[82:83], v[14:15] op_sel:[0,1] op_sel_hi:[1,1]
    v_pk_mul_f32 v[76:77], v[76:77], v[14:15] op_sel:[0,0] op_sel_hi:[1,0]
    v_pk_mul_f32 v[78:79], v[78:79], v[14:15] op_sel:[0,0] op_sel_hi:[1,0]
    buffer_load_dwordx4 v[108:111], v3, s[16:19], s40 offen offset:0
    s_waitcnt lgkmcnt(0)
    v_cmpx_ne_u64 vcc, v[74:75], v[70:71]
    s_and_b64 s[82:83], vcc, s[80:81]
    s_cbranch_scc1 L2_c59
L2_d59:
    v_mov_b64 v[84:85], v[70:71]
    v_mov_b32 v7, v95
    v_mov_b64 v[86:87], v[74:75]
    s_mov_b64 exec, -1
    s_or_b64 s[80:81], s[80:81], vcc
    v_cmpx_ne_u64 vcc, v[72:73], v[68:69]
    s_and_b64 s[82:83], vcc, s[80:81]
    s_cbranch_scc1 L2_c60
L2_d60:
    v_mov_b64 v[84:85], v[68:69]
    v_mov_b32 v7, v94
    v_mov_b64 v[86:87], v[72:73]
    s_mov_b64 exec, -1
    s_or_b64 s[80:81], s[80:81], vcc
    ds_read_b64 v[70:71], v93
    s_and_b64 exec, s[84:85], s[80:81]
    v_mfma_f32_4x4x4_16b_bf16 v[76:79], v[12:13], v[84:85], 0
    v_mov_b32 v92, v7
    s_andn2_b64 s[80:81], s[80:81], s[84:85]
    v_mfma_f32_4x4x4_16b_bf16 v[76:79], v[10:11], v[86:87], v[76:79]
    s_mov_b64 exec, -1
    ds_read_b64 v[68:69], v92
    v_and_b32 v46, 0x80000000, v21
    v_lshrrev_b32 v47, 14, v19
    v_bitop3_b32 v47, v47, v5, v46 bitop3:0xea
    ds_read_b64 v[106:107], v47 offset:63616
    v_bitop3_b32 v95, v19, v5, v46 bitop3:0xea
    v_and_b32 v46, 0x40000000, v21
    v_lshrrev_b32 v47, 14, v18
    v_bitop3_b32 v47, v47, v5, v46 bitop3:0xea
    ds_read_b64 v[104:105], v47 offset:63616
    v_bitop3_b32 v94, v18, v5, v46 bitop3:0xea
    s_waitcnt lgkmcnt(2)
    v_mfma_f32_4x4x4_16b_bf16 v[80:83], v[10:11], v[70:71], v[80:83]
    v_mfma_f32_4x4x4_16b_bf16 v[76:79], v[10:11], v[68:69], v[76:79]
    v_perm_b32 v15, v19, v20, s47
    v_bitop3_b32 v46, v19, 0.5, -0.5 bitop3:0xa8
    v_perm_b32 v14, v18, v20, s46
    v_bitop3_b32 v47, v18, 0.5, -0.5 bitop3:0xa8
    v_cvt_pk_bf16_f32 v80, v80, v81
    v_cvt_pk_bf16_f32 v81, v82, v83
    ds_wrxchg_rtn_b64 v[74:75], v93, v[80:81]
    v_cvt_pk_bf16_f32 v76, v76, v77
    v_cvt_pk_bf16_f32 v77, v78, v79
    ds_wrxchg_rtn_b64 v[72:73], v92, v[76:77]
    s_setprio 2
    s_waitcnt lgkmcnt(2)
    v_mfma_f32_4x4x4_16b_bf16 v[80:83], v[8:9], v[106:107], 0
    v_mfma_f32_4x4x4_16b_bf16 v[76:79], v[8:9], v[104:105], 0
    v_bitop3_b32 v15, v6, v15, v46 bitop3:0xca
    v_bitop3_b32 v14, v6, v14, v47 bitop3:0xca
    s_nop 1
    v_pk_mul_f32 v[80:81], v[80:81], v[14:15] op_sel:[0,1] op_sel_hi:[1,1]
    v_pk_mul_f32 v[82:83], v[82:83], v[14:15] op_sel:[0,1] op_sel_hi:[1,1]
    v_pk_mul_f32 v[76:77], v[76:77], v[14:15] op_sel:[0,0] op_sel_hi:[1,0]
    v_pk_mul_f32 v[78:79], v[78:79], v[14:15] op_sel:[0,0] op_sel_hi:[1,0]
    v_and_b32 v47, 0x0fffffff, v40
    v_mov_b32 v21, v40
    buffer_load_dwordx4 v[16:19], v47, s[8:11], 0 offen
    buffer_load_dwordx3 v[18:20], v47, s[8:11], 0 offen offset:8
    s_waitcnt lgkmcnt(0)
    v_cmpx_ne_u64 vcc, v[74:75], v[70:71]
    s_and_b64 s[82:83], vcc, s[80:81]
    s_cbranch_scc1 L2_c61
L2_d61:
    v_mov_b64 v[84:85], v[70:71]
    v_mov_b32 v7, v93
    v_mov_b64 v[86:87], v[74:75]
    s_mov_b64 exec, -1
    s_or_b64 s[80:81], s[80:81], vcc
    v_cmpx_ne_u64 vcc, v[72:73], v[68:69]
    s_and_b64 s[82:83], vcc, s[80:81]
    s_cbranch_scc1 L2_c62
L2_d62:
    v_mov_b64 v[84:85], v[68:69]
    v_mov_b32 v7, v92
    v_mov_b64 v[86:87], v[72:73]
    s_mov_b64 exec, -1
    s_or_b64 s[80:81], s[80:81], vcc
    ds_read_b64 v[70:71], v95
    ds_read_b64 v[68:69], v94
    s_waitcnt vmcnt(10)
    v_and_b32 v46, 0x20000000, v27
    v_lshrrev_b32 v47, 14, v23
    v_bitop3_b32 v47, v47, v5, v46 bitop3:0xea
    ds_read_b64 v[102:103], v47 offset:63616
    v_bitop3_b32 v93, v23, v5, v46 bitop3:0xea
    v_and_b32 v46, 0x10000000, v27
    v_lshrrev_b32 v47, 14, v22
    v_bitop3_b32 v47, v47, v5, v46 bitop3:0xea
    ds_read_b64 v[100:101], v47 offset:63616
    v_bitop3_b32 v92, v22, v5, v46 bitop3:0xea
    s_waitcnt lgkmcnt(2)
    v_mfma_f32_4x4x4_16b_bf16 v[80:83], v[10:11], v[70:71], v[80:83]
    v_mfma_f32_4x4x4_16b_bf16 v[76:79], v[10:11], v[68:69], v[76:79]
    v_perm_b32 v15, v23, v26, s45
    v_bitop3_b32 v46, v23, 0.5, -0.5 bitop3:0xa8
    v_perm_b32 v14, v22, v26, s44
    v_bitop3_b32 v47, v22, 0.5, -0.5 bitop3:0xa8
    v_cvt_pk_bf16_f32 v80, v80, v81
    v_cvt_pk_bf16_f32 v81, v82, v83
    ds_wrxchg_rtn_b64 v[74:75], v95, v[80:81]
    v_cvt_pk_bf16_f32 v76, v76, v77
    v_cvt_pk_bf16_f32 v77, v78, v79
    ds_wrxchg_rtn_b64 v[72:73], v94, v[76:77]
    s_waitcnt lgkmcnt(2)
    v_mfma_f32_4x4x4_16b_bf16 v[80:83], v[8:9], v[102:103], 0
    v_mfma_f32_4x4x4_16b_bf16 v[76:79], v[8:9], v[100:101], 0
    v_bitop3_b32 v15, v6, v15, v46 bitop3:0xca
    v_bitop3_b32 v14, v6, v14, v47 bitop3:0xca
    v_cmp_lt_u32 s[84:85], v5, v92
    s_nop 0
    v_pk_mul_f32 v[80:81], v[80:81], v[14:15] op_sel:[0,1] op_sel_hi:[1,1]
    v_pk_mul_f32 v[82:83], v[82:83], v[14:15] op_sel:[0,1] op_sel_hi:[1,1]
    v_pk_mul_f32 v[76:77], v[76:77], v[14:15] op_sel:[0,0] op_sel_hi:[1,0]
    v_pk_mul_f32 v[78:79], v[78:79], v[14:15] op_sel:[0,0] op_sel_hi:[1,0]
    v_sub_u16 v88, v58, v50
    v_and_b32 v89, 3, v50
    v_add3_u32 v99, v88, v89, 3
    v_and_b32 v99, -4, v99
    v_max_u32 v99, 4, v99
    v_and_b32 v97, 0xfffc, v50
    v_bfm_b32 v96, v88, v89
    v_add_u32_dpp v91, v99, v99 row_shr:1 row_mask:0xf bank_mask:0xf bound_ctrl:1
    v_mad_u32_u24 v97, v97, 5, v2
    v_cmp_lt_u32 vcc, 16, v99
    v_add_u32_dpp v91, v91, v91 row_shr:2 row_mask:0xf bank_mask:0xf bound_ctrl:1
    v_sub_u32 v98, s38, v99
    v_lshrrev_b64 v[50:51], 16, v[50:51]
    v_add_u32_dpp v91, v91, v91 row_shr:4 row_mask:0xf bank_mask:0xf bound_ctrl:1
    v_lshrrev_b64 v[58:59], 16, v[58:59]
    s_mov_b32 s43, 0
    v_add_u32_dpp v91, v91, v91 row_shr:8 row_mask:0xf bank_mask:0xf bound_ctrl:1
    s_nop 1
    v_add_u32_dpp v91, v91, v91 row_bcast:15 row_mask:0xa bank_mask:0xf
    s_nop 1
    v_add_u32_dpp v91, v91, v91 row_bcast:31 row_mask:0xc bank_mask:0xf
    v_add_u32 v98, v98, v91
    v_readlane_b32 s37, v91, 63
    s_cbranch_vccnz L2_xo63
L2_xp63:
    buffer_load_dwordx4 v[112:115], v3, s[16:19], s40 offen offset:1024
    s_waitcnt lgkmcnt(0)
    v_cmpx_ne_u64 vcc, v[74:75], v[70:71]
    s_and_b64 s[82:83], vcc, s[80:81]
    s_cbranch_scc1 L2_c64
L2_d64:
    v_mov_b64 v[84:85], v[70:71]
    v_mov_b32 v7, v95
    v_mov_b64 v[86:87], v[74:75]
    s_mov_b64 exec, -1
    s_or_b64 s[80:81], s[80:81], vcc
    v_cmpx_ne_u64 vcc, v[72:73], v[68:69]
    s_and_b64 s[82:83], vcc, s[80:81]
    s_cbranch_scc1 L2_c65
L2_d65:
    v_mov_b64 v[84:85], v[68:69]
    v_mov_b32 v7, v94
    v_mov_b64 v[86:87], v[72:73]
    s_mov_b64 exec, -1
    s_or_b64 s[80:81], s[80:81], vcc
    ds_read_b64 v[70:71], v93
    s_and_b64 exec, s[84:85], s[80:81]
    v_mfma_f32_4x4x4_16b_bf16 v[76:79], v[12:13], v[84:85], 0
    v_mov_b32 v92, v7
    s_andn2_b64 s[80:81], s[80:81], s[84:85]
    v_mfma_f32_4x4x4_16b_bf16 v[76:79], v[10:11], v[86:87], v[76:79]
    s_mov_b64 exec, -1
    ds_read_b64 v[68:69], v92
    v_and_b32 v46, 0x80000000, v27
    v_lshrrev_b32 v47, 14, v25
    v_bitop3_b32 v47, v47, v5, v46 bitop3:0xea
    ds_read_b64 v[106:107], v47 offset:63616
    v_bitop3_b32 v95, v25, v5, v46 bitop3:0xea
    v_and_b32 v46, 0x40000000, v27
    v_lshrrev_b32 v47, 14, v24
    v_bitop3_b32 v47, v47, v5, v46 bitop3:0xea
    ds_read_b64 v[104:105], v47 offset:63616
    v_bitop3_b32 v94, v24, v5, v46 bitop3:0xea
    s_waitcnt lgkmcnt(2)
    v_mfma_f32_4x4x4_16b_bf16 v[80:83], v[10:11], v[70:71], v[80:83]
    v_mfma_f32_4x4x4_16b_bf16 v[76:79], v[10:11], v[68:69], v[76:79]
    v_perm_b32 v15, v25, v26, s47
    v_bitop3_b32 v46, v25, 0.5, -0.5 bitop3:0xa8
    v_perm_b32 v14, v24, v26, s46
    v_bitop3_b32 v47, v24, 0.5, -0.5 bitop3:0xa8
    v_cvt_pk_bf16_f32 v80, v80, v81
    v_cvt_pk_bf16_f32 v81, v82, v83
    ds_wrxchg_rtn_b64 v[74:75], v93, v[80:81]
    v_cvt_pk_bf16_f32 v76, v76, v77
    v_cvt_pk_bf16_f32 v77, v78, v79
    ds_wrxchg_rtn_b64 v[72:73], v92, v[76:77]
    s_setprio 1
    s_waitcnt lgkmcnt(2)
    v_mfma_f32_4x4x4_16b_bf16 v[80:83], v[8:9], v[106:107], 0
    v_mfma_f32_4x4x4_16b_bf16 v[76:79], v[8:9], v[104:105], 0
    v_bitop3_b32 v15, v6, v15, v46 bitop3:0xca
    v_bitop3_b32 v14, v6, v14, v47 bitop3:0xca
    s_nop 1
    v_pk_mul_f32 v[80:81], v[80:81], v[14:15] op_sel:[0,1] op_sel_hi:[1,1]
    v_pk_mul_f32 v[82:83], v[82:83], v[14:15] op_sel:[0,1] op_sel_hi:[1,1]
    v_pk_mul_f32 v[76:77], v[76:77], v[14:15] op_sel:[0,0] op_sel_hi:[1,0]
    v_pk_mul_f32 v[78:79], v[78:79], v[14:15] op_sel:[0,0] op_sel_hi:[1,0]
    v_and_b32 v47, 0x0fffffff, v41
    v_mov_b32 v27, v41
    buffer_load_dwordx4 v[22:25], v47, s[8:11], 0 offen
    buffer_load_dwordx3 v[24:26], v47, s[8:11], 0 offen offset:8
    s_waitcnt lgkmcnt(0)
    v_cmpx_ne_u64 vcc, v[74:75], v[70:71]
    s_and_b64 s[82:83], vcc, s[80:81]
    s_cbranch_scc1 L2_c66
L2_d66:
    v_mov_b64 v[84:85], v[70:71]
    v_mov_b32 v7, v93
    v_mov_b64 v[86:87], v[74:75]
    s_mov_b64 exec, -1
    s_or_b64 s[80:81], s[80:81], vcc
    v_cmpx_ne_u64 vcc, v[72:73], v[68:69]
    s_and_b64 s[82:83], vcc, s[80:81]
    s_cbranch_scc1 L2_c67
L2_d67:
    v_mov_b64 v[84:85], v[68:69]
    v_mov_b32 v7, v92
    v_mov_b64 v[86:87], v[72:73]
    s_mov_b64 exec, -1
    s_or_b64 s[80:81], s[80:81], vcc
    ds_read_b64 v[70:71], v95
    ds_read_b64 v[68:69], v94
    s_waitcnt vmcnt(11)
    v_and_b32 v46, 0x20000000, v33
    v_lshrrev_b32 v47, 14, v29
    v_bitop3_b32 v47, v47, v5, v46 bitop3:0xea
    ds_read_b64 v[102:103], v47 offset:63616
    v_bitop3_b32 v93, v29, v5, v46 bitop3:0xea
    v_and_b32 v46, 0x10000000, v33
    v_lshrrev_b32 v47, 14, v28
    v_bitop3_b32 v47, v47, v5, v46 bitop3:0xea
    ds_read_b64 v[100:101], v47 offset:63616
    v_bitop3_b32 v92, v28, v5, v46 bitop3:0xea
    s_waitcnt lgkmcnt(2)
    v_mfma_f32_4x4x4_16b_bf16 v[80:83], v[10:11], v[70:71], v[80:83]
    v_mfma_f32_4x4x4_16b_bf16 v[76:79], v[10:11], v[68:69], v[76:79]
    v_perm_b32 v15, v29, v32, s45
    v_bitop3_b32 v46, v29, 0.5, -0.5 bitop3:0xa8
    v_perm_b32 v14, v28, v32, s44
    v_bitop3_b32 v47, v28, 0.5, -0.5 bitop3:0xa8
    v_cvt_pk_bf16_f32 v80, v80, v81
    v_cvt_pk_bf16_f32 v81, v82, v83
    ds_wrxchg_rtn_b64 v[74:75], v95, v[80:81]
    v_cvt_pk_bf16_f32 v76, v76, v77
    v_cvt_pk_bf16_f32 v77, v78, v79
    ds_wrxchg_rtn_b64 v[72:73], v94, v[76:77]
    s_waitcnt lgkmcnt(2)
    v_mfma_f32_4x4x4_16b_bf16 v[80:83], v[8:9], v[102:103], 0
    v_mfma_f32_4x4x4_16b_bf16 v[76:79], v[8:9], v[100:101], 0
    v_bitop3_b32 v15, v6, v15, v46 bitop3:0xca
    v_bitop3_b32 v14, v6, v14, v47 bitop3:0xca
    v_cmp_lt_u32 s[84:85], v5, v92
    s_nop 0
    v_pk_mul_f32 v[80:81], v[80:81], v[14:15] op_sel:[0,1] op_sel_hi:[1,1]
    v_pk_mul_f32 v[82:83], v[82:83], v[14:15] op_sel:[0,1] op_sel_hi:[1,1]
    v_pk_mul_f32 v[76:77], v[76:77], v[14:15] op_sel:[0,0] op_sel_hi:[1,0]
    v_pk_mul_f32 v[78:79], v[78:79], v[14:15] op_sel:[0,0] op_sel_hi:[1,0]
    s_waitcnt lgkmcnt(0)
    v_cmpx_ne_u64 vcc, v[74:75], v[70:71]
    s_and_b64 s[82:83], vcc, s[80:81]
    s_cbranch_scc1 L2_c68
L2_d68:
    v_mov_b64 v[84:85], v[70:71]
    v_mov_b32 v7, v95
    v_mov_b64 v[86:87], v[74:75]
    s_mov_b64 exec, -1
    s_or_b64 s[80:81], s[80:81], vcc
    v_cmpx_ne_u64 vcc, v[72:73], v[68:69]
    s_and_b64 s[82:83], vcc, s[80:81]
    s_cbranch_scc1 L2_c69
L2_d69:
    v_mov_b64 v[84:85], v[68:69]
    v_mov_b32 v7, v94
    v_mov_b64 v[86:87], v[72:73]
    s_mov_b64 exec, -1
    s_or_b64 s[80:81], s[80:81], vcc
    ds_read_b64 v[70:71], v93
    s_and_b64 exec, s[84:85], s[80:81]
    v_mfma_f32_4x4x4_16b_bf16 v[76:79], v[12:13], v[84:85], 0
    v_mov_b32 v92, v7
    s_andn2_b64 s[80:81], s[80:81], s[84:85]
    v_mfma_f32_4x4x4_16b_bf16 v[76:79], v[10:11], v[86:87], v[76:79]
    s_mov_b64 exec, -1
    ds_read_b64 v[68:69], v92
    v_and_b32 v46, 0x80000000, v33
    v_lshrrev_b32 v47, 14, v31
    v_bitop3_b32 v47, v47, v5, v46 bitop3:0xea
    ds_read_b64 v[106:107], v47 offset:63616
    v_bitop3_b32 v95, v31, v5, v46 bitop3:0xea
    v_and_b32 v46, 0x40000000, v33
    v_lshrrev_b32 v47, 14, v30
    v_bitop3_b32 v47, v47, v5, v46 bitop3:0xea
    ds_read_b64 v[104:105], v47 offset:63616
    v_bitop3_b32 v94, v30, v5, v46 bitop3:0xea
    s_waitcnt lgkmcnt(2)
    v_mfma_f32_4x4x4_16b_bf16 v[80:83], v[10:11], v[70:71], v[80:83]
    v_mfma_f32_4x4x4_16b_bf16 v[76:79], v[10:11], v[68:69], v[76:79]
    v_perm_b32 v15, v31, v32, s47
    v_bitop3_b32 v46, v31, 0.5, -0.5 bitop3:0xa8
    v_perm_b32 v14, v30, v32, s46
    v_bitop3_b32 v47, v30, 0.5, -0.5 bitop3:0xa8
    v_cvt_pk_bf16_f32 v80, v80, v81
    v_cvt_pk_bf16_f32 v81, v82, v83
    ds_wrxchg_rtn_b64 v[74:75], v93, v[80:81]
    v_cvt_pk_bf16_f32 v76, v76, v77
    v_cvt_pk_bf16_f32 v77, v78, v79
    ds_wrxchg_rtn_b64 v[72:73], v92, v[76:77]
    s_setprio 0
    s_waitcnt lgkmcnt(2)
    v_mfma_f32_4x4x4_16b_bf16 v[80:83], v[8:9], v[106:107], 0
    v_mfma_f32_4x4x4_16b_bf16 v[76:79], v[8:9], v[104:105], 0
    v_bitop3_b32 v15, v6, v15, v46 bitop3:0xca
    v_bitop3_b32 v14, v6, v14, v47 bitop3:0xca
    s_nop 1
    v_pk_mul_f32 v[80:81], v[80:81], v[14:15] op_sel:[0,1] op_sel_hi:[1,1]
    v_pk_mul_f32 v[82:83], v[82:83], v[14:15] op_sel:[0,1] op_sel_hi:[1,1]
    v_pk_mul_f32 v[76:77], v[76:77], v[14:15] op_sel:[0,0] op_sel_hi:[1,0]
    v_pk_mul_f32 v[78:79], v[78:79], v[14:15] op_sel:[0,0] op_sel_hi:[1,0]
    s_add_u32 s40, s40, 0x4e200
    v_and_b32 v47, 0x0fffffff, v42
    v_mov_b32 v33, v42
    buffer_load_dwordx4 v[28:31], v47, s[8:11], 0 offen
    buffer_load_dwordx3 v[30:32], v47, s[8:11], 0 offen offset:8
    s_waitcnt lgkmcnt(0)
    v_cmpx_ne_u64 vcc, v[74:75], v[70:71]
    s_and_b64 s[82:83], vcc, s[80:81]
    s_cbranch_scc1 L2_c70
L2_d70:
    v_mov_b64 v[84:85], v[70:71]
    v_mov_b32 v7, v93
    v_mov_b64 v[86:87], v[74:75]
    s_mov_b64 exec, -1
    s_or_b64 s[80:81], s[80:81], vcc
    v_cmpx_ne_u64 vcc, v[72:73], v[68:69]
    s_and_b64 s[82:83], vcc, s[80:81]
    s_cbranch_scc1 L2_c71
L2_d71:
    v_mov_b64 v[84:85], v[68:69]
    v_mov_b32 v7, v92
    v_mov_b64 v[86:87], v[72:73]
    s_mov_b64 exec, -1
    s_or_b64 s[80:81], s[80:81], vcc
    ds_read_b64 v[70:71], v95
    ds_read_b64 v[68:69], v94
    s_waitcnt vmcnt(8)
    v_and_b32 v46, 0x20000000, v39
    v_lshrrev_b32 v47, 14, v35
    v_bitop3_b32 v47, v47, v5, v46 bitop3:0xea
    ds_read_b64 v[102:103], v47 offset:63616
    v_bitop3_b32 v93, v35, v5, v46 bitop3:0xea
    v_and_b32 v46, 0x10000000, v39
    v_lshrrev_b32 v47, 14, v34
    v_bitop3_b32 v47, v47, v5, v46 bitop3:0xea
    ds_read_b64 v[100:101], v47 offset:63616
    v_bitop3_b32 v92, v34, v5, v46 bitop3:0xea
    v_and_b32 v46, 0x80000000, v39
    v_lshrrev_b32 v47, 14, v37
    v_bitop3_b32 v47, v47, v5, v46 bitop3:0xea
    ds_read_b64 v[106:107], v47 offset:63616
    v_and_b32 v46, 0x40000000, v39
    v_lshrrev_b32 v47, 14, v36
    v_bitop3_b32 v47, v47, v5, v46 bitop3:0xea
    ds_read_b64 v[104:105], v47 offset:63616
    s_waitcnt lgkmcnt(4)
    v_mfma_f32_4x4x4_16b_bf16 v[80:83], v[10:11], v[70:71], v[80:83]
    v_mfma_f32_4x4x4_16b_bf16 v[76:79], v[10:11], v[68:69], v[76:79]
    v_perm_b32 v15, v35, v38, s45
    v_bitop3_b32 v46, v35, 0.5, -0.5 bitop3:0xa8
    v_perm_b32 v14, v34, v38, s44
    v_bitop3_b32 v47, v34, 0.5, -0.5 bitop3:0xa8
    v_cvt_pk_bf16_f32 v80, v80, v81
    v_cvt_pk_bf16_f32 v81, v82, v83
    ds_wrxchg_rtn_b64 v[74:75], v95, v[80:81]
    v_cvt_pk_bf16_f32 v76, v76, v77
    v_cvt_pk_bf16_f32 v77, v78, v79
    ds_wrxchg_rtn_b64 v[72:73], v94, v[76:77]
    s_waitcnt lgkmcnt(2)
    s_barrier
    s_setprio 3
    ds_write_b128 v3, v[124:127] offset:4096
    s_add_u32 s3, s40, 4096
    buffer_load_dwordx4 v[124:127], v3, s[16:19], s3 offen
    ds_write_b128 v3, v[116:119] offset:2048
    buffer_load_dwordx4 v[116:119], v3, s[16:19], s40 offen offset:2048
    ds_write_b128 v3, v[120:123] offset:3072
    buffer_load_dwordx4 v[120:123], v3, s[16:19], s40 offen offset:3072
    v_mfma_f32_4x4x4_16b_bf16 v[80:83], v[8:9], v[102:103], 0
    v_mfma_f32_4x4x4_16b_bf16 v[76:79], v[8:9], v[100:101], 0
    v_bitop3_b32 v15, v6, v15, v46 bitop3:0xca
    v_bitop3_b32 v14, v6, v14, v47 bitop3:0xca
    v_cmp_lt_u32 s[84:85], v5, v92
    s_nop 0
    v_pk_mul_f32 v[80:81], v[80:81], v[14:15] op_sel:[0,1] op_sel_hi:[1,1]
    v_pk_mul_f32 v[82:83], v[82:83], v[14:15] op_sel:[0,1] op_sel_hi:[1,1]
    v_pk_mul_f32 v[76:77], v[76:77], v[14:15] op_sel:[0,0] op_sel_hi:[1,0]
    v_pk_mul_f32 v[78:79], v[78:79], v[14:15] op_sel:[0,0] op_sel_hi:[1,0]
    v_mov_b32 v44, v43
    s_cmp_gt_u32 s37, 1024
    s_cbranch_scc1 L2_xs72
    s_cmp_lg_u32 s43, 0
    s_cbranch_scc1 L2_xa72
L2_xb72:
    v_lshlrev_b32 v89, 16, v96
    v_add_u32 v90, 60, v97
    v_bitop3_b32 v90, v89, v45, v90 bitop3:0x6a
    ds_write_b32 v98, v90 offset:12
    v_lshlrev_b32 v89, 20, v96
    v_add_u32 v90, 40, v97
    v_bitop3_b32 v90, v89, v45, v90 bitop3:0x6a
    ds_write_b32 v98, v90 offset:8
    v_lshlrev_b32 v89, 24, v96
    v_add_u32 v90, 20, v97
    v_bitop3_b32 v90, v89, v45, v90 bitop3:0x6a
    ds_write_b32 v98, v90 offset:4
    v_lshlrev_b32 v89, 28, v96
    v_bitop3_b32 v90, v89, v45, v97 bitop3:0x6a
    ds_write_b32 v98, v90 offset:0
    v_mov_b32_dpp v91, v66 quad_perm:[0,0,0,0] row_mask:0xf bank_mask:0xf
    v_and_b32 v89, 3, v91
    v_and_b32 v97, 0xfffc, v91
    v_sub_u16_dpp v88, v66, v91 quad_perm:[2,2,2,2] row_mask:0xf bank_mask:0xf
    v_mad_u32_u24 v97, v97, 5, v4
    v_add_u32 v99, v88, v89
    v_bfm_b32 v96, v88, v89
    v_cmp_lt_u32 s[58:59], 16, v99
    v_lshlrev_b32 v89, v1, v96
    v_and_b32 v89, v45, v89
    v_cmp_ne_u32 vcc, 0, v89
    v_xor_b32 v90, v97, v89
    s_add_u32 s3, s37, s38
    v_mbcnt_lo_u32_b32 v98, vcc_lo, 0
    v_mbcnt_hi_u32_b32 v98, vcc_hi, v98
    s_bcnt1_i32_b64 s41, vcc
    v_lshl_add_u32 v98, v98, 2, s3
    s_mov_b64 exec, vcc
    ds_write_b32 v98, v90
    s_mov_b64 exec, -1
    s_lshl2_add_u32 s37, s41, s37
    s_cmp_lg_u64 s[58:59], 0
    s_cbranch_scc1 L2_xe72
L2_xr72:
    v_add_u32 v98, s37, v0
    v_mov_b32 v90, -1
    ds_write_b32 v98, v90
    ds_read2st64_b32 v[40:41], v0 offset0:0 offset1:1
    ds_read2st64_b32 v[42:43], v0 offset0:2 offset1:3
    s_sub_u32 s3, s37, 768
    s_cmp_gt_u32 s3, 256
    s_cbranch_scc1 L2_xf72
L2_xg72:
    s_setprio 2
    s_waitcnt vmcnt(10)
    ds_write_b128 v3, v[108:111] offset:0
    s_waitcnt lgkmcnt(12)
    v_cmpx_ne_u64 vcc, v[74:75], v[70:71]
    s_and_b64 s[82:83], vcc, s[80:81]
    s_cbranch_scc1 L2_c73
L2_d73:
    v_mov_b64 v[84:85], v[70:71]
    v_mov_b32 v7, v95
    v_mov_b64 v[86:87], v[74:75]
    s_mov_b64 exec, -1
    s_or_b64 s[80:81], s[80:81], vcc
    v_cmpx_ne_u64 vcc, v[72:73], v[68:69]
    s_and_b64 s[82:83], vcc, s[80:81]
    s_cbranch_scc1 L2_c74
L2_d74:
    v_mov_b64 v[84:85], v[68:69]
    v_mov_b32 v7, v94
    v_mov_b64 v[86:87], v[72:73]
    s_mov_b64 exec, -1
    s_or_b64 s[80:81], s[80:81], vcc
    ds_read_b64 v[70:71], v93
    s_and_b64 exec, s[84:85], s[80:81]
    v_mfma_f32_4x4x4_16b_bf16 v[76:79], v[12:13], v[84:85], 0
    v_mov_b32 v92, v7
    s_andn2_b64 s[80:81], s[80:81], s[84:85]
    v_mfma_f32_4x4x4_16b_bf16 v[76:79], v[10:11], v[86:87], v[76:79]
    s_mov_b64 exec, -1
    ds_read_b64 v[68:69], v92
    s_setprio 1
    s_waitcnt vmcnt(7)
    ds_write_b128 v3, v[112:115] offset:1024
    s_waitcnt lgkmcnt(1)
    v_mfma_f32_4x4x4_16b_bf16 v[80:83], v[10:11], v[70:71], v[80:83]
    v_mfma_f32_4x4x4_16b_bf16 v[76:79], v[10:11], v[68:69], v[76:79]
    v_and_b32 v46, 0x40000000, v39
    v_bitop3_b32 v94, v36, v5, v46 bitop3:0xea
    v_and_b32 v46, 0x80000000, v39
    v_bitop3_b32 v95, v37, v5, v46 bitop3:0xea
    v_perm_b32 v15, v37, v38, s47
    v_bitop3_b32 v46, v37, 0.5, -0.5 bitop3:0xa8
    v_perm_b32 v14, v36, v38, s46
    v_bitop3_b32 v47, v36, 0.5, -0.5 bitop3:0xa8
    v_cvt_pk_bf16_f32 v80, v80, v81
    v_cvt_pk_bf16_f32 v81, v82, v83
    ds_wrxchg_rtn_b64 v[74:75], v93, v[80:81]
    v_cvt_pk_bf16_f32 v76, v76, v77
    v_cvt_pk_bf16_f32 v77, v78, v79
    ds_wrxchg_rtn_b64 v[72:73], v92, v[76:77]
    s_setprio 0
    v_mfma_f32_4x4x4_16b_bf16 v[80:83], v[8:9], v[106:107], 0
    v_mfma_f32_4x4x4_16b_bf16 v[76:79], v[8:9], v[104:105], 0
    v_bitop3_b32 v15, v6, v15, v46 bitop3:0xca
    v_bitop3_b32 v14, v6, v14, v47 bitop3:0xca
    s_nop 1
    v_pk_mul_f32 v[80:81], v[80:81], v[14:15] op_sel:[0,1] op_sel_hi:[1,1]
    v_pk_mul_f32 v[82:83], v[82:83], v[14:15] op_sel:[0,1] op_sel_hi:[1,1]
    v_pk_mul_f32 v[76:77], v[76:77], v[14:15] op_sel:[0,0] op_sel_hi:[1,0]
    v_pk_mul_f32 v[78:79], v[78:79], v[14:15] op_sel:[0,0] op_sel_hi:[1,0]
    s_add_u32 s42, s42, 1
    s_waitcnt lgkmcnt(2)
    s_barrier
    s_bitcmp1_b32 s36, s42
    s_cbranch_scc1 L2_slow
L2_ret4:
    s_setprio 3
    v_and_b32 v47, 0x0fffffff, v44
    v_mov_b32 v39, v44
    buffer_load_dwordx4 v[34:37], v47, s[8:11], 0 offen
    buffer_load_dwordx3 v[36:38], v47, s[8:11], 0 offen offset:8
    s_waitcnt lgkmcnt(0)
    v_cmpx_ne_u64 vcc, v[74:75], v[70:71]
    s_and_b64 s[82:83], vcc, s[80:81]
    s_cbranch_scc1 L2_c75
L2_d75:
    v_mov_b64 v[84:85], v[70:71]
    v_mov_b32 v7, v93
    v_mov_b64 v[86:87], v[74:75]
    s_mov_b64 exec, -1
    s_or_b64 s[80:81], s[80:81], vcc
    v_cmpx_ne_u64 vcc, v[72:73], v[68:69]
    s_and_b64 s[82:83], vcc, s[80:81]
    s_cbranch_scc1 L2_c76
L2_d76:
    v_mov_b64 v[84:85], v[68:69]
    v_mov_b32 v7, v92
    v_mov_b64 v[86:87], v[72:73]
    s_mov_b64 exec, -1
    s_or_b64 s[80:81], s[80:81], vcc
    ds_read_b64 v[70:71], v95
    ds_read_b64 v[68:69], v94
    v_and_b32 v46, 0x20000000, v21
    v_lshrrev_b32 v47, 14, v17
    v_bitop3_b32 v47, v47, v5, v46 bitop3:0xea
    ds_read_b64 v[102:103], v47 offset:63616
    v_bitop3_b32 v93, v17, v5, v46 bitop3:0xea
    v_and_b32 v46, 0x10000000, v21
    v_lshrrev_b32 v47, 14, v16
    v_bitop3_b32 v47, v47, v5, v46 bitop3:0xea
    ds_read_b64 v[100:101], v47 offset:63616
    v_bitop3_b32 v92, v16, v5, v46 bitop3:0xea
    s_waitcnt lgkmcnt(2)
    v_mfma_f32_4x4x4_16b_bf16 v[80:83], v[10:11], v[70:71], v[80:83]
    v_mfma_f32_4x4x4_16b_bf16 v[76:79], v[10:11], v[68:69], v[76:79]
    v_perm_b32 v15, v17, v20, s45
    v_bitop3_b32 v46, v17, 0.5, -0.5 bitop3:0xa8
    v_perm_b32 v14, v16, v20, s44
    v_bitop3_b32 v47, v16, 0.5, -0.5 bitop3:0xa8
    v_cvt_pk_bf16_f32 v80, v80, v81
    v_cvt_pk_bf16_f32 v81, v82, v83
    ds_wrxchg_rtn_b64 v[74:75], v95, v[80:81]
    v_cvt_pk_bf16_f32 v76, v76, v77
    v_cvt_pk_bf16_f32 v77, v78, v79
    ds_wrxchg_rtn_b64 v[72:73], v94, v[76:77]
    s_waitcnt lgkmcnt(2)
    v_mfma_f32_4x4x4_16b_bf16 v[80:83], v[8:9], v[102:103], 0
    v_mfma_f32_4x4x4_16b_bf16 v[76:79], v[8:9], v[100:101], 0
    v_bitop3_b32 v15, v6, v15, v46 bitop3:0xca
    v_bitop3_b32 v14, v6, v14, v47 bitop3:0xca
    v_cmp_lt_u32 s[84:85], v5, v92
    s_nop 0
    v_pk_mul_f32 v[80:81], v[80:81], v[14:15] op_sel:[0,1] op_sel_hi:[1,1]
    v_pk_mul_f32 v[82:83], v[82:83], v[14:15] op_sel:[0,1] op_sel_hi:[1,1]
    v_pk_mul_f32 v[76:77], v[76:77], v[14:15] op_sel:[0,0] op_sel_hi:[1,0]
    v_pk_mul_f32 v[78:79], v[78:79], v[14:15] op_sel:[0,0] op_sel_hi:[1,0]
    buffer_load_dwordx4 v[108:111], v3, s[16:19], s40 offen offset:0
    s_waitcnt lgkmcnt(0)
    v_cmpx_ne_u64 vcc, v[74:75], v[70:71]
    s_and_b64 s[82:83], vcc, s[80:81]
    s_cbranch_scc1 L2_c77
L2_d77:
    v_mov_b64 v[84:85], v[70:71]
    v_mov_b32 v7, v95
    v_mov_b64 v[86:87], v[74:75]
    s_mov_b64 exec, -1
    s_or_b64 s[80:81], s[80:81], vcc
    v_cmpx_ne_u64 vcc, v[72:73], v[68:69]
    s_and_b64 s[82:83], vcc, s[80:81]
    s_cbranch_scc1 L2_c78
L2_d78:
    v_mov_b64 v[84:85], v[68:69]
    v_mov_b32 v7, v94
    v_mov_b64 v[86:87], v[72:73]
    s_mov_b64 exec, -1
    s_or_b64 s[80:81], s[80:81], vcc
    ds_read_b64 v[70:71], v93
    s_and_b64 exec, s[84:85], s[80:81]
    v_mfma_f32_4x4x4_16b_bf16 v[76:79], v[12:13], v[84:85], 0
    v_mov_b32 v92, v7
    s_andn2_b64 s[80:81], s[80:81], s[84:85]
    v_mfma_f32_4x4x4_16b_bf16 v[76:79], v[10:11], v[86:87], v[76:79]
    s_mov_b64 exec, -1
    ds_read_b64 v[68:69], v92
    v_and_b32 v46, 0x80000000, v21
    v_lshrrev_b32 v47, 14, v19
    v_bitop3_b32 v47, v47, v5, v46 bitop3:0xea
    ds_read_b64 v[106:107], v47 offset:63616
    v_bitop3_b32 v95, v19, v5, v46 bitop3:0xea
    v_and_b32 v46, 0x40000000, v21
    v_lshrrev_b32 v47, 14, v18
    v_bitop3_b32 v47, v47, v5, v46 bitop3:0xea
    ds_read_b64 v[104:105], v47 offset:63616
    v_bitop3_b32 v94, v18, v5, v46 bitop3:0xea
    s_waitcnt lgkmcnt(2)
    v_mfma_f32_4x4x4_16b_bf16 v[80:83], v[10:11], v[70:71], v[80:83]
    v_mfma_f32_4x4x4_16b_bf16 v[76:79], v[10:11], v[68:69], v[76:79]
    v_perm_b32 v15, v19, v20, s47
    v_bitop3_b32 v46, v19, 0.5, -0.5 bitop3:0xa8
    v_perm_b32 v14, v18, v20, s46
    v_bitop3_b32 v47, v18, 0.5, -0.5 bitop3:0xa8
    v_cvt_pk_bf16_f32 v80, v80, v81
    v_cvt_pk_bf16_f32 v81, v82, v83
    ds_wrxchg_rtn_b64 v[74:75], v93, v[80:81]
    v_cvt_pk_bf16_f32 v76, v76, v77
    v_cvt_pk_bf16_f32 v77, v78, v79
    ds_wrxchg_rtn_b64 v[72:73], v92, v[76:77]
    s_setprio 2
    s_waitcnt lgkmcnt(2)
    v_mfma_f32_4x4x4_16b_bf16 v[80:83], v[8:9], v[106:107], 0
    v_mfma_f32_4x4x4_16b_bf16 v[76:79], v[8:9], v[104:105], 0
    v_bitop3_b32 v15, v6, v15, v46 bitop3:0xca
    v_bitop3_b32 v14, v6, v14, v47 bitop3:0xca
    s_nop 1
    v_pk_mul_f32 v[80:81], v[80:81], v[14:15] op_sel:[0,1] op_sel_hi:[1,1]
    v_pk_mul_f32 v[82:83], v[82:83], v[14:15] op_sel:[0,1] op_sel_hi:[1,1]
    v_pk_mul_f32 v[76:77], v[76:77], v[14:15] op_sel:[0,0] op_sel_hi:[1,0]
    v_pk_mul_f32 v[78:79], v[78:79], v[14:15] op_sel:[0,0] op_sel_hi:[1,0]
    v_and_b32 v47, 0x0fffffff, v40
    v_mov_b32 v21, v40
    buffer_load_dwordx4 v[16:19], v47, s[8:11], 0 offen
    buffer_load_dwordx3 v[18:20], v47, s[8:11], 0 offen offset:8
    s_waitcnt lgkmcnt(0)
    v_cmpx_ne_u64 vcc, v[74:75], v[70:71]
    s_and_b64 s[82:83], vcc, s[80:81]
    s_cbranch_scc1 L2_c79
L2_d79:
    v_mov_b64 v[84:85], v[70:71]
    v_mov_b32 v7, v93
    v_mov_b64 v[86:87], v[74:75]
    s_mov_b64 exec, -1
    s_or_b64 s[80:81], s[80:81], vcc
    v_cmpx_ne_u64 vcc, v[72:73], v[68:69]
    s_and_b64 s[82:83], vcc, s[80:81]
    s_cbranch_scc1 L2_c80
L2_d80:
    v_mov_b64 v[84:85], v[68:69]
    v_mov_b32 v7, v92
    v_mov_b64 v[86:87], v[72:73]
    s_mov_b64 exec, -1
    s_or_b64 s[80:81], s[80:81], vcc
    ds_read_b64 v[70:71], v95
    ds_read_b64 v[68:69], v94
    s_waitcnt vmcnt(10)
    v_and_b32 v46, 0x20000000, v27
    v_lshrrev_b32 v47, 14, v23
    v_bitop3_b32 v47, v47, v5, v46 bitop3:0xea
    ds_read_b64 v[102:103], v47 offset:63616
    v_bitop3_b32 v93, v23, v5, v46 bitop3:0xea
    v_and_b32 v46, 0x10000000, v27
    v_lshrrev_b32 v47, 14, v22
    v_bitop3_b32 v47, v47, v5, v46 bitop3:0xea
    ds_read_b64 v[100:101], v47 offset:63616
    v_bitop3_b32 v92, v22, v5, v46 bitop3:0xea
    s_waitcnt lgkmcnt(2)
    v_mfma_f32_4x4x4_16b_bf16 v[80:83], v[10:11], v[70:71], v[80:83]
    v_mfma_f32_4x4x4_16b_bf16 v[76:79], v[10:11], v[68:69], v[76:79]
    v_perm_b32 v15, v23, v26, s45
    v_bitop3_b32 v46, v23, 0.5, -0.5 bitop3:0xa8
    v_perm_b32 v14, v22, v26, s44
    v_bitop3_b32 v47, v22, 0.5, -0.5 bitop3:0xa8
    v_cvt_pk_bf16_f32 v80, v80, v81
    v_cvt_pk_bf16_f32 v81, v82, v83
    ds_wrxchg_rtn_b64 v[74:75], v95, v[80:81]
    v_cvt_pk_bf16_f32 v76, v76, v77
    v_cvt_pk_bf16_f32 v77, v78, v79
    ds_wrxchg_rtn_b64 v[72:73], v94, v[76:77]
    s_waitcnt lgkmcnt(2)
    v_mfma_f32_4x4x4_16b_bf16 v[80:83], v[8:9], v[102:103], 0
    v_mfma_f32_4x4x4_16b_bf16 v[76:79], v[8:9], v[100:101], 0
    v_bitop3_b32 v15, v6, v15, v46 bitop3:0xca
    v_bitop3_b32 v14, v6, v14, v47 bitop3:0xca
    v_cmp_lt_u32 s[84:85], v5, v92
    s_nop 0
    v_pk_mul_f32 v[80:81], v[80:81], v[14:15] op_sel:[0,1] op_sel_hi:[1,1]
    v_pk_mul_f32 v[82:83], v[82:83], v[14:15] op_sel:[0,1] op_sel_hi:[1,1]
    v_pk_mul_f32 v[76:77], v[76:77], v[14:15] op_sel:[0,0] op_sel_hi:[1,0]
    v_pk_mul_f32 v[78:79], v[78:79], v[14:15] op_sel:[0,0] op_sel_hi:[1,0]
    v_sub_u16 v88, v60, v52
    v_and_b32 v89, 3, v52
    v_add3_u32 v99, v88, v89, 3
    v_and_b32 v99, -4, v99
    v_max_u32 v99, 4, v99
    v_and_b32 v97, 0xfffc, v52
    v_bfm_b32 v96, v88, v89
    v_add_u32_dpp v91, v99, v99 row_shr:1 row_mask:0xf bank_mask:0xf bound_ctrl:1
    v_mad_u32_u24 v97, v97, 5, v2
    v_cmp_lt_u32 vcc, 16, v99
    v_add_u32_dpp v91, v91, v91 row_shr:2 row_mask:0xf bank_mask:0xf bound_ctrl:1
    v_sub_u32 v98, s38, v99
    v_lshrrev_b64 v[52:53], 16, v[52:53]
    v_add_u32_dpp v91, v91, v91 row_shr:4 row_mask:0xf bank_mask:0xf bound_ctrl:1
    v_lshrrev_b64 v[60:61], 16, v[60:61]
    s_mov_b32 s43, 0
    v_add_u32_dpp v91, v91, v91 row_shr:8 row_mask:0xf bank_mask:0xf bound_ctrl:1
    s_nop 1
    v_add_u32_dpp v91, v91, v91 row_bcast:15 row_mask:0xa bank_mask:0xf
    s_nop 1
    v_add_u32_dpp v91, v91, v91 row_bcast:31 row_mask:0xc bank_mask:0xf
    v_add_u32 v98, v98, v91
    v_readlane_b32 s37, v91, 63
    s_cbranch_vccnz L2_xo81
L2_xp81:
    buffer_load_dwordx4 v[112:115], v3, s[16:19], s40 offen offset:1024
    s_waitcnt lgkmcnt(0)
    v_cmpx_ne_u64 vcc, v[74:75], v[70:71]
    s_and_b64 s[82:83], vcc, s[80:81]
    s_cbranch_scc1 L2_c82
L2_d82:
    v_mov_b64 v[84:85], v[70:71]
    v_mov_b32 v7, v95
    v_mov_b64 v[86:87], v[74:75]
    s_mov_b64 exec, -1
    s_or_b64 s[80:81], s[80:81], vcc
    v_cmpx_ne_u64 vcc, v[72:73], v[68:69]
    s_and_b64 s[82:83], vcc, s[80:81]
    s_cbranch_scc1 L2_c83
L2_d83:
    v_mov_b64 v[84:85], v[68:69]
    v_mov_b32 v7, v94
    v_mov_b64 v[86:87], v[72:73]
    s_mov_b64 exec, -1
    s_or_b64 s[80:81], s[80:81], vcc
    ds_read_b64 v[70:71], v93
    s_and_b64 exec, s[84:85], s[80:81]
    v_mfma_f32_4x4x4_16b_bf16 v[76:79], v[12:13], v[84:85], 0
    v_mov_b32 v92, v7
    s_andn2_b64 s[80:81], s[80:81], s[84:85]
    v_mfma_f32_4x4x4_16b_bf16 v[76:79], v[10:11], v[86:87], v[76:79]
    s_mov_b64 exec, -1
    ds_read_b64 v[68:69], v92
    v_and_b32 v46, 0x80000000, v27
    v_lshrrev_b32 v47, 14, v25
    v_bitop3_b32 v47, v47, v5, v46 bitop3:0xea
    ds_read_b64 v[106:107], v47 offset:63616
    v_bitop3_b32 v95, v25, v5, v46 bitop3:0xea
    v_and_b32 v46, 0x40000000, v27
    v_lshrrev_b32 v47, 14, v24
    v_bitop3_b32 v47, v47, v5, v46 bitop3:0xea
    ds_read_b64 v[104:105], v47 offset:63616
    v_bitop3_b32 v94, v24, v5, v46 bitop3:0xea
    s_waitcnt lgkmcnt(2)
    v_mfma_f32_4x4x4_16b_bf16 v[80:83], v[10:11], v[70:71], v[80:83]
    v_mfma_f32_4x4x4_16b_bf16 v[76:79], v[10:11], v[68:69], v[76:79]
    v_perm_b32 v15, v25, v26, s47
    v_bitop3_b32 v46, v25, 0.5, -0.5 bitop3:0xa8
    v_perm_b32 v14, v24, v26, s46
    v_bitop3_b32 v47, v24, 0.5, -0.5 bitop3:0xa8
    v_cvt_pk_bf16_f32 v80, v80, v81
    v_cvt_pk_bf16_f32 v81, v82, v83
    ds_wrxchg_rtn_b64 v[74:75], v93, v[80:81]
    v_cvt_pk_bf16_f32 v76, v76, v77
    v_cvt_pk_bf16_f32 v77, v78, v79
    ds_wrxchg_rtn_b64 v[72:73], v92, v[76:77]
    s_setprio 1
    s_waitcnt lgkmcnt(2)
    v_mfma_f32_4x4x4_16b_bf16 v[80:83], v[8:9], v[106:107], 0
    v_mfma_f32_4x4x4_16b_bf16 v[76:79], v[8:9], v[104:105], 0
    v_bitop3_b32 v15, v6, v15, v46 bitop3:0xca
    v_bitop3_b32 v14, v6, v14, v47 bitop3:0xca
    s_nop 1
    v_pk_mul_f32 v[80:81], v[80:81], v[14:15] op_sel:[0,1] op_sel_hi:[1,1]
    v_pk_mul_f32 v[82:83], v[82:83], v[14:15] op_sel:[0,1] op_sel_hi:[1,1]
    v_pk_mul_f32 v[76:77], v[76:77], v[14:15] op_sel:[0,0] op_sel_hi:[1,0]
    v_pk_mul_f32 v[78:79], v[78:79], v[14:15] op_sel:[0,0] op_sel_hi:[1,0]
    v_and_b32 v47, 0x0fffffff, v41
    v_mov_b32 v27, v41
    buffer_load_dwordx4 v[22:25], v47, s[8:11], 0 offen
    buffer_load_dwordx3 v[24:26], v47, s[8:11], 0 offen offset:8
    s_waitcnt lgkmcnt(0)
    v_cmpx_ne_u64 vcc, v[74:75], v[70:71]
    s_and_b64 s[82:83], vcc, s[80:81]
    s_cbranch_scc1 L2_c84
L2_d84:
    v_mov_b64 v[84:85], v[70:71]
    v_mov_b32 v7, v93
    v_mov_b64 v[86:87], v[74:75]
    s_mov_b64 exec, -1
    s_or_b64 s[80:81], s[80:81], vcc
    v_cmpx_ne_u64 vcc, v[72:73], v[68:69]
    s_and_b64 s[82:83], vcc, s[80:81]
    s_cbranch_scc1 L2_c85
L2_d85:
    v_mov_b64 v[84:85], v[68:69]
    v_mov_b32 v7, v92
    v_mov_b64 v[86:87], v[72:73]
    s_mov_b64 exec, -1
    s_or_b64 s[80:81], s[80:81], vcc
    ds_read_b64 v[70:71], v95
    ds_read_b64 v[68:69], v94
    s_waitcnt vmcnt(11)
    v_and_b32 v46, 0x20000000, v33
    v_lshrrev_b32 v47, 14, v29
    v_bitop3_b32 v47, v47, v5, v46 bitop3:0xea
    ds_read_b64 v[102:103], v47 offset:63616
    v_bitop3_b32 v93, v29, v5, v46 bitop3:0xea
    v_and_b32 v46, 0x10000000, v33
    v_lshrrev_b32 v47, 14, v28
    v_bitop3_b32 v47, v47, v5, v46 bitop3:0xea
    ds_read_b64 v[100:101], v47 offset:63616
    v_bitop3_b32 v92, v28, v5, v46 bitop3:0xea
    s_waitcnt lgkmcnt(2)
    v_mfma_f32_4x4x4_16b_bf16 v[80:83], v[10:11], v[70:71], v[80:83]
    v_mfma_f32_4x4x4_16b_bf16 v[76:79], v[10:11], v[68:69], v[76:79]
    v_perm_b32 v15, v29, v32, s45
    v_bitop3_b32 v46, v29, 0.5, -0.5 bitop3:0xa8
    v_perm_b32 v14, v28, v32, s44
    v_bitop3_b32 v47, v28, 0.5, -0.5 bitop3:0xa8
    v_cvt_pk_bf16_f32 v80, v80, v81
    v_cvt_pk_bf16_f32 v81, v82, v83
    ds_wrxchg_rtn_b64 v[74:75], v95, v[80:81]
    v_cvt_pk_bf16_f32 v76, v76, v77
    v_cvt_pk_bf16_f32 v77, v78, v79
    ds_wrxchg_rtn_b64 v[72:73], v94, v[76:77]
    s_waitcnt lgkmcnt(2)
    v_mfma_f32_4x4x4_16b_bf16 v[80:83], v[8:9], v[102:103], 0
    v_mfma_f32_4x4x4_16b_bf16 v[76:79], v[8:9], v[100:101], 0
    v_bitop3_b32 v15, v6, v15, v46 bitop3:0xca
    v_bitop3_b32 v14, v6, v14, v47 bitop3:0xca
    v_cmp_lt_u32 s[84:85], v5, v92
    s_nop 0
    v_pk_mul_f32 v[80:81], v[80:81], v[14:15] op_sel:[0,1] op_sel_hi:[1,1]
    v_pk_mul_f32 v[82:83], v[82:83], v[14:15] op_sel:[0,1] op_sel_hi:[1,1]
    v_pk_mul_f32 v[76:77], v[76:77], v[14:15] op_sel:[0,0] op_sel_hi:[1,0]
    v_pk_mul_f32 v[78:79], v[78:79], v[14:15] op_sel:[0,0] op_sel_hi:[1,0]
    s_waitcnt lgkmcnt(0)
    v_cmpx_ne_u64 vcc, v[74:75], v[70:71]
    s_and_b64 s[82:83], vcc, s[80:81]
    s_cbranch_scc1 L2_c86
L2_d86:
    v_mov_b64 v[84:85], v[70:71]
    v_mov_b32 v7, v95
    v_mov_b64 v[86:87], v[74:75]
    s_mov_b64 exec, -1
    s_or_b64 s[80:81], s[80:81], vcc
    v_cmpx_ne_u64 vcc, v[72:73], v[68:69]
    s_and_b64 s[82:83], vcc, s[80:81]
    s_cbranch_scc1 L2_c87
L2_d87:
    v_mov_b64 v[84:85], v[68:69]
    v_mov_b32 v7, v94
    v_mov_b64 v[86:87], v[72:73]
    s_mov_b64 exec, -1
    s_or_b64 s[80:81], s[80:81], vcc
    ds_read_b64 v[70:71], v93
    s_and_b64 exec, s[84:85], s[80:81]
    v_mfma_f32_4x4x4_16b_bf16 v[76:79], v[12:13], v[84:85], 0
    v_mov_b32 v92, v7
    s_andn2_b64 s[80:81], s[80:81], s[84:85]
    v_mfma_f32_4x4x4_16b_bf16 v[76:79], v[10:11], v[86:87], v[76:79]
    s_mov_b64 exec, -1
    ds_read_b64 v[68:69], v92
    v_and_b32 v46, 0x80000000, v33
    v_lshrrev_b32 v47, 14, v31
    v_bitop3_b32 v47, v47, v5, v46 bitop3:0xea
    ds_read_b64 v[106:107], v47 offset:63616
    v_bitop3_b32 v95, v31, v5, v46 bitop3:0xea
    v_and_b32 v46, 0x40000000, v33
    v_lshrrev_b32 v47, 14, v30
    v_bitop3_b32 v47, v47, v5, v46 bitop3:0xea
    ds_read_b64 v[104:105], v47 offset:63616
    v_bitop3_b32 v94, v30, v5, v46 bitop3:0xea
    s_waitcnt lgkmcnt(2)
    v_mfma_f32_4x4x4_16b_bf16 v[80:83], v[10:11], v[70:71], v[80:83]
    v_mfma_f32_4x4x4_16b_bf16 v[76:79], v[10:11], v[68:69], v[76:79]
    v_perm_b32 v15, v31, v32, s47
    v_bitop3_b32 v46, v31, 0.5, -0.5 bitop3:0xa8
    v_perm_b32 v14, v30, v32, s46
    v_bitop3_b32 v47, v30, 0.5, -0.5 bitop3:0xa8
    v_cvt_pk_bf16_f32 v80, v80, v81
    v_cvt_pk_bf16_f32 v81, v82, v83
    ds_wrxchg_rtn_b64 v[74:75], v93, v[80:81]
    v_cvt_pk_bf16_f32 v76, v76, v77
    v_cvt_pk_bf16_f32 v77, v78, v79
    ds_wrxchg_rtn_b64 v[72:73], v92, v[76:77]
    s_setprio 0
    s_waitcnt lgkmcnt(2)
    v_mfma_f32_4x4x4_16b_bf16 v[80:83], v[8:9], v[106:107], 0
    v_mfma_f32_4x4x4_16b_bf16 v[76:79], v[8:9], v[104:105], 0
    v_bitop3_b32 v15, v6, v15, v46 bitop3:0xca
    v_bitop3_b32 v14, v6, v14, v47 bitop3:0xca
    s_nop 1
    v_pk_mul_f32 v[80:81], v[80:81], v[14:15] op_sel:[0,1] op_sel_hi:[1,1]
    v_pk_mul_f32 v[82:83], v[82:83], v[14:15] op_sel:[0,1] op_sel_hi:[1,1]
    v_pk_mul_f32 v[76:77], v[76:77], v[14:15] op_sel:[0,0] op_sel_hi:[1,0]
    v_pk_mul_f32 v[78:79], v[78:79], v[14:15] op_sel:[0,0] op_sel_hi:[1,0]
    s_add_u32 s40, s40, 0x4e200
    v_and_b32 v47, 0x0fffffff, v42
    v_mov_b32 v33, v42
    buffer_load_dwordx4 v[28:31], v47, s[8:11], 0 offen
    buffer_load_dwordx3 v[30:32], v47, s[8:11], 0 offen offset:8
    s_waitcnt lgkmcnt(0)
    v_cmpx_ne_u64 vcc, v[74:75], v[70:71]
    s_and_b64 s[82:83], vcc, s[80:81]
    s_cbranch_scc1 L2_c88
L2_d88:
    v_mov_b64 v[84:85], v[70:71]
    v_mov_b32 v7, v93
    v_mov_b64 v[86:87], v[74:75]
    s_mov_b64 exec, -1
    s_or_b64 s[80:81], s[80:81], vcc
    v_cmpx_ne_u64 vcc, v[72:73], v[68:69]
    s_and_b64 s[82:83], vcc, s[80:81]
    s_cbranch_scc1 L2_c89
L2_d89:
    v_mov_b64 v[84:85], v[68:69]
    v_mov_b32 v7, v92
    v_mov_b64 v[86:87], v[72:73]
    s_mov_b64 exec, -1
    s_or_b64 s[80:81], s[80:81], vcc
    ds_read_b64 v[70:71], v95
    ds_read_b64 v[68:69], v94
    s_waitcnt vmcnt(8)
    v_and_b32 v46, 0x20000000, v39
    v_lshrrev_b32 v47, 14, v35
    v_bitop3_b32 v47, v47, v5, v46 bitop3:0xea
    ds_read_b64 v[102:103], v47 offset:63616
    v_bitop3_b32 v93, v35, v5, v46 bitop3:0xea
    v_and_b32 v46, 0x10000000, v39
    v_lshrrev_b32 v47, 14, v34
    v_bitop3_b32 v47, v47, v5, v46 bitop3:0xea
    ds_read_b64 v[100:101], v47 offset:63616
    v_bitop3_b32 v92, v34, v5, v46 bitop3:0xea
    v_and_b32 v46, 0x80000000, v39
    v_lshrrev_b32 v47, 14, v37
    v_bitop3_b32 v47, v47, v5, v46 bitop3:0xea
    ds_read_b64 v[106:107], v47 offset:63616
    v_and_b32 v46, 0x40000000, v39
    v_lshrrev_b32 v47, 14, v36
    v_bitop3_b32 v47, v47, v5, v46 bitop3:0xea
    ds_read_b64 v[104:105], v47 offset:63616
    s_waitcnt lgkmcnt(4)
    v_mfma_f32_4x4x4_16b_bf16 v[80:83], v[10:11], v[70:71], v[80:83]
    v_mfma_f32_4x4x4_16b_bf16 v[76:79], v[10:11], v[68:69], v[76:79]
    v_perm_b32 v15, v35, v38, s45
    v_bitop3_b32 v46, v35, 0.5, -0.5 bitop3:0xa8
    v_perm_b32 v14, v34, v38, s44
    v_bitop3_b32 v47, v34, 0.5, -0.5 bitop3:0xa8
    v_cvt_pk_bf16_f32 v80, v80, v81
    v_cvt_pk_bf16_f32 v81, v82, v83
    ds_wrxchg_rtn_b64 v[74:75], v95, v[80:81]
    v_cvt_pk_bf16_f32 v76, v76, v77
    v_cvt_pk_bf16_f32 v77, v78, v79
    ds_wrxchg_rtn_b64 v[72:73], v94, v[76:77]
    s_waitcnt lgkmcnt(2)
    s_barrier
    s_setprio 3
    ds_write_b128 v3, v[124:127] offset:4096
    s_add_u32 s3, s40, 4096
    buffer_load_dwordx4 v[124:127], v3, s[16:19], s3 offen
    ds_write_b128 v3, v[116:119] offset:2048
    buffer_load_dwordx4 v[116:119], v3, s[16:19], s40 offen offset:2048
    ds_write_b128 v3, v[120:123] offset:3072
    buffer_load_dwordx4 v[120:123], v3, s[16:19], s40 offen offset:3072
    v_mfma_f32_4x4x4_16b_bf16 v[80:83], v[8:9], v[102:103], 0
    v_mfma_f32_4x4x4_16b_bf16 v[76:79], v[8:9], v[100:101], 0
    v_bitop3_b32 v15, v6, v15, v46 bitop3:0xca
    v_bitop3_b32 v14, v6, v14, v47 bitop3:0xca
    v_cmp_lt_u32 s[84:85], v5, v92
    s_nop 0
    v_pk_mul_f32 v[80:81], v[80:81], v[14:15] op_sel:[0,1] op_sel_hi:[1,1]
    v_pk_mul_f32 v[82:83], v[82:83], v[14:15] op_sel:[0,1] op_sel_hi:[1,1]
    v_pk_mul_f32 v[76:77], v[76:77], v[14:15] op_sel:[0,0] op_sel_hi:[1,0]
    v_pk_mul_f32 v[78:79], v[78:79], v[14:15] op_sel:[0,0] op_sel_hi:[1,0]
    v_mov_b32 v44, v43
    s_cmp_gt_u32 s37, 1024
    s_cbranch_scc1 L2_xs90
    s_cmp_lg_u32 s43, 0
    s_cbranch_scc1 L2_xa90
L2_xb90:
    v_lshlrev_b32 v89, 16, v96
    v_add_u32 v90, 60, v97
    v_bitop3_b32 v90, v89, v45, v90 bitop3:0x6a
    ds_write_b32 v98, v90 offset:12
    v_lshlrev_b32 v89, 20, v96
    v_add_u32 v90, 40, v97
    v_bitop3_b32 v90, v89, v45, v90 bitop3:0x6a
    ds_write_b32 v98, v90 offset:8
    v_lshlrev_b32 v89, 24, v96
    v_add_u32 v90, 20, v97
    v_bitop3_b32 v90, v89, v45, v90 bitop3:0x6a
    ds_write_b32 v98, v90 offset:4
    v_lshlrev_b32 v89, 28, v96
    v_bitop3_b32 v90, v89, v45, v97 bitop3:0x6a
    ds_write_b32 v98, v90 offset:0
    v_mov_b32_dpp v91, v64 quad_perm:[1,1,1,1] row_mask:0xf bank_mask:0xf
    v_and_b32 v89, 3, v91
    v_and_b32 v97, 0xfffc, v91
    v_sub_u16_dpp v88, v64, v91 quad_perm:[3,3,3,3] row_mask:0xf bank_mask:0xf
    v_mad_u32_u24 v97, v97, 5, v4
    v_add_u32 v99, v88, v89
    v_bfm_b32 v96, v88, v89
    v_cmp_lt_u32 s[58:59], 16, v99
    v_lshlrev_b32 v89, v1, v96
    v_and_b32 v89, v45, v89
    v_cmp_ne_u32 vcc, 0, v89
    v_xor_b32 v90, v97, v89
    s_add_u32 s3, s37, s38
    v_mbcnt_lo_u32_b32 v98, vcc_lo, 0
    v_mbcnt_hi_u32_b32 v98, vcc_hi, v98
    s_bcnt1_i32_b64 s41, vcc
    v_lshl_add_u32 v98, v98, 2, s3
    s_mov_b64 exec, vcc
    ds_write_b32 v98, v90
    s_mov_b64 exec, -1
    s_lshl2_add_u32 s37, s41, s37
    s_cmp_lg_u64 s[58:59], 0
    s_cbranch_scc1 L2_xe90
L2_xr90:
    v_add_u32 v98, s37, v0
    v_mov_b32 v90, -1
    ds_write_b32 v98, v90
    ds_read2st64_b32 v[40:41], v0 offset0:0 offset1:1
    ds_read2st64_b32 v[42:43], v0 offset0:2 offset1:3
    s_sub_u32 s3, s37, 768
    s_cmp_gt_u32 s3, 256
    s_cbranch_scc1 L2_xf90
L2_xg90:
    s_setprio 2
    s_waitcnt vmcnt(10)
    ds_write_b128 v3, v[108:111] offset:0
    s_waitcnt lgkmcnt(12)
    v_cmpx_ne_u64 vcc, v[74:75], v[70:71]
    s_and_b64 s[82:83], vcc, s[80:81]
    s_cbranch_scc1 L2_c91
L2_d91:
    v_mov_b64 v[84:85], v[70:71]
    v_mov_b32 v7, v95
    v_mov_b64 v[86:87], v[74:75]
    s_mov_b64 exec, -1
    s_or_b64 s[80:81], s[80:81], vcc
    v_cmpx_ne_u64 vcc, v[72:73], v[68:69]
    s_and_b64 s[82:83], vcc, s[80:81]
    s_cbranch_scc1 L2_c92
L2_d92:
    v_mov_b64 v[84:85], v[68:69]
    v_mov_b32 v7, v94
    v_mov_b64 v[86:87], v[72:73]
    s_mov_b64 exec, -1
    s_or_b64 s[80:81], s[80:81], vcc
    ds_read_b64 v[70:71], v93
    s_and_b64 exec, s[84:85], s[80:81]
    v_mfma_f32_4x4x4_16b_bf16 v[76:79], v[12:13], v[84:85], 0
    v_mov_b32 v92, v7
    s_andn2_b64 s[80:81], s[80:81], s[84:85]
    v_mfma_f32_4x4x4_16b_bf16 v[76:79], v[10:11], v[86:87], v[76:79]
    s_mov_b64 exec, -1
    ds_read_b64 v[68:69], v92
    s_setprio 1
    s_waitcnt vmcnt(7)
    ds_write_b128 v3, v[112:115] offset:1024
    s_waitcnt lgkmcnt(1)
    v_mfma_f32_4x4x4_16b_bf16 v[80:83], v[10:11], v[70:71], v[80:83]
    v_mfma_f32_4x4x4_16b_bf16 v[76:79], v[10:11], v[68:69], v[76:79]
    v_and_b32 v46, 0x40000000, v39
    v_bitop3_b32 v94, v36, v5, v46 bitop3:0xea
    v_and_b32 v46, 0x80000000, v39
    v_bitop3_b32 v95, v37, v5, v46 bitop3:0xea
    v_perm_b32 v15, v37, v38, s47
    v_bitop3_b32 v46, v37, 0.5, -0.5 bitop3:0xa8
    v_perm_b32 v14, v36, v38, s46
    v_bitop3_b32 v47, v36, 0.5, -0.5 bitop3:0xa8
    v_cvt_pk_bf16_f32 v80, v80, v81
    v_cvt_pk_bf16_f32 v81, v82, v83
    ds_wrxchg_rtn_b64 v[74:75], v93, v[80:81]
    v_cvt_pk_bf16_f32 v76, v76, v77
    v_cvt_pk_bf16_f32 v77, v78, v79
    ds_wrxchg_rtn_b64 v[72:73], v92, v[76:77]
    s_setprio 0
    v_mfma_f32_4x4x4_16b_bf16 v[80:83], v[8:9], v[106:107], 0
    v_mfma_f32_4x4x4_16b_bf16 v[76:79], v[8:9], v[104:105], 0
    v_bitop3_b32 v15, v6, v15, v46 bitop3:0xca
    v_bitop3_b32 v14, v6, v14, v47 bitop3:0xca
    s_nop 1
    v_pk_mul_f32 v[80:81], v[80:81], v[14:15] op_sel:[0,1] op_sel_hi:[1,1]
    v_pk_mul_f32 v[82:83], v[82:83], v[14:15] op_sel:[0,1] op_sel_hi:[1,1]
    v_pk_mul_f32 v[76:77], v[76:77], v[14:15] op_sel:[0,0] op_sel_hi:[1,0]
    v_pk_mul_f32 v[78:79], v[78:79], v[14:15] op_sel:[0,0] op_sel_hi:[1,0]
    s_add_u32 s42, s42, 1
    s_waitcnt lgkmcnt(2)
    s_barrier
    s_bitcmp1_b32 s36, s42
    s_cbranch_scc1 L2_slow
L2_ret5:
    s_setprio 3
    v_and_b32 v47, 0x0fffffff, v44
    v_mov_b32 v39, v44
    buffer_load_dwordx4 v[34:37], v47, s[8:11], 0 offen
    buffer_load_dwordx3 v[36:38], v47, s[8:11], 0 offen offset:8
    s_waitcnt lgkmcnt(0)
    v_cmpx_ne_u64 vcc, v[74:75], v[70:71]
    s_and_b64 s[82:83], vcc, s[80:81]
    s_cbranch_scc1 L2_c93
L2_d93:
    v_mov_b64 v[84:85], v[70:71]
    v_mov_b32 v7, v93
    v_mov_b64 v[86:87], v[74:75]
    s_mov_b64 exec, -1
    s_or_b64 s[80:81], s[80:81], vcc
    v_cmpx_ne_u64 vcc, v[72:73], v[68:69]
    s_and_b64 s[82:83], vcc, s[80:81]
    s_cbranch_scc1 L2_c94
L2_d94:
    v_mov_b64 v[84:85], v[68:69]
    v_mov_b32 v7, v92
    v_mov_b64 v[86:87], v[72:73]
    s_mov_b64 exec, -1
    s_or_b64 s[80:81], s[80:81], vcc
    ds_read_b64 v[70:71], v95
    ds_read_b64 v[68:69], v94
    v_and_b32 v46, 0x20000000, v21
    v_lshrrev_b32 v47, 14, v17
    v_bitop3_b32 v47, v47, v5, v46 bitop3:0xea
    ds_read_b64 v[102:103], v47 offset:63616
    v_bitop3_b32 v93, v17, v5, v46 bitop3:0xea
    v_and_b32 v46, 0x10000000, v21
    v_lshrrev_b32 v47, 14, v16
    v_bitop3_b32 v47, v47, v5, v46 bitop3:0xea
    ds_read_b64 v[100:101], v47 offset:63616
    v_bitop3_b32 v92, v16, v5, v46 bitop3:0xea
    s_waitcnt lgkmcnt(2)
    v_mfma_f32_4x4x4_16b_bf16 v[80:83], v[10:11], v[70:71], v[80:83]
    v_mfma_f32_4x4x4_16b_bf16 v[76:79], v[10:11], v[68:69], v[76:79]
    v_perm_b32 v15, v17, v20, s45
    v_bitop3_b32 v46, v17, 0.5, -0.5 bitop3:0xa8
    v_perm_b32 v14, v16, v20, s44
    v_bitop3_b32 v47, v16, 0.5, -0.5 bitop3:0xa8
    v_cvt_pk_bf16_f32 v80, v80, v81
    v_cvt_pk_bf16_f32 v81, v82, v83
    ds_wrxchg_rtn_b64 v[74:75], v95, v[80:81]
    v_cvt_pk_bf16_f32 v76, v76, v77
    v_cvt_pk_bf16_f32 v77, v78, v79
    ds_wrxchg_rtn_b64 v[72:73], v94, v[76:77]
    s_waitcnt lgkmcnt(2)
    v_mfma_f32_4x4x4_16b_bf16 v[80:83], v[8:9], v[102:103], 0
    v_mfma_f32_4x4x4_16b_bf16 v[76:79], v[8:9], v[100:101], 0
    v_bitop3_b32 v15, v6, v15, v46 bitop3:0xca
    v_bitop3_b32 v14, v6, v14, v47 bitop3:0xca
    v_cmp_lt_u32 s[84:85], v5, v92
    s_nop 0
    v_pk_mul_f32 v[80:81], v[80:81], v[14:15] op_sel:[0,1] op_sel_hi:[1,1]
    v_pk_mul_f32 v[82:83], v[82:83], v[14:15] op_sel:[0,1] op_sel_hi:[1,1]
    v_pk_mul_f32 v[76:77], v[76:77], v[14:15] op_sel:[0,0] op_sel_hi:[1,0]
    v_pk_mul_f32 v[78:79], v[78:79], v[14:15] op_sel:[0,0] op_sel_hi:[1,0]
    buffer_load_dwordx4 v[108:111], v3, s[16:19], s40 offen offset:0
    s_waitcnt lgkmcnt(0)
    v_cmpx_ne_u64 vcc, v[74:75], v[70:71]
    s_and_b64 s[82:83], vcc, s[80:81]
    s_cbranch_scc1 L2_c95
L2_d95:
    v_mov_b64 v[84:85], v[70:71]
    v_mov_b32 v7, v95
    v_mov_b64 v[86:87], v[74:75]
    s_mov_b64 exec, -1
    s_or_b64 s[80:81], s[80:81], vcc
    v_cmpx_ne_u64 vcc, v[72:73], v[68:69]
    s_and_b64 s[82:83], vcc, s[80:81]
    s_cbranch_scc1 L2_c96
L2_d96:
    v_mov_b64 v[84:85], v[68:69]
    v_mov_b32 v7, v94
    v_mov_b64 v[86:87], v[72:73]
    s_mov_b64 exec, -1
    s_or_b64 s[80:81], s[80:81], vcc
    ds_read_b64 v[70:71], v93
    s_and_b64 exec, s[84:85], s[80:81]
    v_mfma_f32_4x4x4_16b_bf16 v[76:79], v[12:13], v[84:85], 0
    v_mov_b32 v92, v7
    s_andn2_b64 s[80:81], s[80:81], s[84:85]
    v_mfma_f32_4x4x4_16b_bf16 v[76:79], v[10:11], v[86:87], v[76:79]
    s_mov_b64 exec, -1
    ds_read_b64 v[68:69], v92
    v_and_b32 v46, 0x80000000, v21
    v_lshrrev_b32 v47, 14, v19
    v_bitop3_b32 v47, v47, v5, v46 bitop3:0xea
    ds_read_b64 v[106:107], v47 offset:63616
    v_bitop3_b32 v95, v19, v5, v46 bitop3:0xea
    v_and_b32 v46, 0x40000000, v21
    v_lshrrev_b32 v47, 14, v18
    v_bitop3_b32 v47, v47, v5, v46 bitop3:0xea
    ds_read_b64 v[104:105], v47 offset:63616
    v_bitop3_b32 v94, v18, v5, v46 bitop3:0xea
    s_waitcnt lgkmcnt(2)
    v_mfma_f32_4x4x4_16b_bf16 v[80:83], v[10:11], v[70:71], v[80:83]
    v_mfma_f32_4x4x4_16b_bf16 v[76:79], v[10:11], v[68:69], v[76:79]
    v_perm_b32 v15, v19, v20, s47
    v_bitop3_b32 v46, v19, 0.5, -0.5 bitop3:0xa8
    v_perm_b32 v14, v18, v20, s46
    v_bitop3_b32 v47, v18, 0.5, -0.5 bitop3:0xa8
    v_cvt_pk_bf16_f32 v80, v80, v81
    v_cvt_pk_bf16_f32 v81, v82, v83
    ds_wrxchg_rtn_b64 v[74:75], v93, v[80:81]
    v_cvt_pk_bf16_f32 v76, v76, v77
    v_cvt_pk_bf16_f32 v77, v78, v79
    ds_wrxchg_rtn_b64 v[72:73], v92, v[76:77]
    s_setprio 2
    s_waitcnt lgkmcnt(2)
    v_mfma_f32_4x4x4_16b_bf16 v[80:83], v[8:9], v[106:107], 0
    v_mfma_f32_4x4x4_16b_bf16 v[76:79], v[8:9], v[104:105], 0
    v_bitop3_b32 v15, v6, v15, v46 bitop3:0xca
    v_bitop3_b32 v14, v6, v14, v47 bitop3:0xca
    s_nop 1
    v_pk_mul_f32 v[80:81], v[80:81], v[14:15] op_sel:[0,1] op_sel_hi:[1,1]
    v_pk_mul_f32 v[82:83], v[82:83], v[14:15] op_sel:[0,1] op_sel_hi:[1,1]
    v_pk_mul_f32 v[76:77], v[76:77], v[14:15] op_sel:[0,0] op_sel_hi:[1,0]
    v_pk_mul_f32 v[78:79], v[78:79], v[14:15] op_sel:[0,0] op_sel_hi:[1,0]
    v_and_b32 v47, 0x0fffffff, v40
    v_mov_b32 v21, v40
    buffer_load_dwordx4 v[16:19], v47, s[8:11], 0 offen
    buffer_load_dwordx3 v[18:20], v47, s[8:11], 0 offen offset:8
    s_waitcnt lgkmcnt(0)
    v_cmpx_ne_u64 vcc, v[74:75], v[70:71]
    s_and_b64 s[82:83], vcc, s[80:81]
    s_cbranch_scc1 L2_c97
L2_d97:
    v_mov_b64 v[84:85], v[70:71]
    v_mov_b32 v7, v93
    v_mov_b64 v[86:87], v[74:75]
    s_mov_b64 exec, -1
    s_or_b64 s[80:81], s[80:81], vcc
    v_cmpx_ne_u64 vcc, v[72:73], v[68:69]
    s_and_b64 s[82:83], vcc, s[80:81]
    s_cbranch_scc1 L2_c98
L2_d98:
    v_mov_b64 v[84:85], v[68:69]
    v_mov_b32 v7, v92
    v_mov_b64 v[86:87], v[72:73]
    s_mov_b64 exec, -1
    s_or_b64 s[80:81], s[80:81], vcc
    ds_read_b64 v[70:71], v95
    ds_read_b64 v[68:69], v94
    s_waitcnt vmcnt(10)
    v_and_b32 v46, 0x20000000, v27
    v_lshrrev_b32 v47, 14, v23
    v_bitop3_b32 v47, v47, v5, v46 bitop3:0xea
    ds_read_b64 v[102:103], v47 offset:63616
    v_bitop3_b32 v93, v23, v5, v46 bitop3:0xea
    v_and_b32 v46, 0x10000000, v27
    v_lshrrev_b32 v47, 14, v22
    v_bitop3_b32 v47, v47, v5, v46 bitop3:0xea
    ds_read_b64 v[100:101], v47 offset:63616
    v_bitop3_b32 v92, v22, v5, v46 bitop3:0xea
    s_waitcnt lgkmcnt(2)
    v_mfma_f32_4x4x4_16b_bf16 v[80:83], v[10:11], v[70:71], v[80:83]
    v_mfma_f32_4x4x4_16b_bf16 v[76:79], v[10:11], v[68:69], v[76:79]
    v_perm_b32 v15, v23, v26, s45
    v_bitop3_b32 v46, v23, 0.5, -0.5 bitop3:0xa8
    v_perm_b32 v14, v22, v26, s44
    v_bitop3_b32 v47, v22, 0.5, -0.5 bitop3:0xa8
    v_cvt_pk_bf16_f32 v80, v80, v81
    v_cvt_pk_bf16_f32 v81, v82, v83
    ds_wrxchg_rtn_b64 v[74:75], v95, v[80:81]
    v_cvt_pk_bf16_f32 v76, v76, v77
    v_cvt_pk_bf16_f32 v77, v78, v79
    ds_wrxchg_rtn_b64 v[72:73], v94, v[76:77]
    s_waitcnt lgkmcnt(2)
    v_mfma_f32_4x4x4_16b_bf16 v[80:83], v[8:9], v[102:103], 0
    v_mfma_f32_4x4x4_16b_bf16 v[76:79], v[8:9], v[100:101], 0
    v_bitop3_b32 v15, v6, v15, v46 bitop3:0xca
    v_bitop3_b32 v14, v6, v14, v47 bitop3:0xca
    v_cmp_lt_u32 s[84:85], v5, v92
    s_nop 0
    v_pk_mul_f32 v[80:81], v[80:81], v[14:15] op_sel:[0,1] op_sel_hi:[1,1]
    v_pk_mul_f32 v[82:83], v[82:83], v[14:15] op_sel:[0,1] op_sel_hi:[1,1]
    v_pk_mul_f32 v[76:77], v[76:77], v[14:15] op_sel:[0,0] op_sel_hi:[1,0]
    v_pk_mul_f32 v[78:79], v[78:79], v[14:15] op_sel:[0,0] op_sel_hi:[1,0]
    v_sub_u16 v88, v62, v54
    v_and_b32 v89, 3, v54
    v_add3_u32 v99, v88, v89, 3
    v_and_b32 v99, -4, v99
    v_max_u32 v99, 4, v99
    v_and_b32 v97, 0xfffc, v54
    v_bfm_b32 v96, v88, v89
    v_add_u32_dpp v91, v99, v99 row_shr:1 row_mask:0xf bank_mask:0xf bound_ctrl:1
    v_mad_u32_u24 v97, v97, 5, v2
    v_cmp_lt_u32 vcc, 16, v99
    v_add_u32_dpp v91, v91, v91 row_shr:2 row_mask:0xf bank_mask:0xf bound_ctrl:1
    v_sub_u32 v98, s38, v99
    v_lshrrev_b64 v[54:55], 16, v[54:55]
    v_add_u32_dpp v91, v91, v91 row_shr:4 row_mask:0xf bank_mask:0xf bound_ctrl:1
    v_lshrrev_b64 v[62:63], 16, v[62:63]
    s_mov_b32 s43, 0
    v_add_u32_dpp v91, v91, v91 row_shr:8 row_mask:0xf bank_mask:0xf bound_ctrl:1
    s_nop 1
    v_add_u32_dpp v91, v91, v91 row_bcast:15 row_mask:0xa bank_mask:0xf
    s_nop 1
    v_add_u32_dpp v91, v91, v91 row_bcast:31 row_mask:0xc bank_mask:0xf
    v_add_u32 v98, v98, v91
    v_readlane_b32 s37, v91, 63
    s_cbranch_vccnz L2_xo99
L2_xp99:
    buffer_load_dwordx4 v[112:115], v3, s[16:19], s40 offen offset:1024
    s_waitcnt lgkmcnt(0)
    v_cmpx_ne_u64 vcc, v[74:75], v[70:71]
    s_and_b64 s[82:83], vcc, s[80:81]
    s_cbranch_scc1 L2_c100
L2_d100:
    v_mov_b64 v[84:85], v[70:71]
    v_mov_b32 v7, v95
    v_mov_b64 v[86:87], v[74:75]
    s_mov_b64 exec, -1
    s_or_b64 s[80:81], s[80:81], vcc
    v_cmpx_ne_u64 vcc, v[72:73], v[68:69]
    s_and_b64 s[82:83], vcc, s[80:81]
    s_cbranch_scc1 L2_c101
L2_d101:
    v_mov_b64 v[84:85], v[68:69]
    v_mov_b32 v7, v94
    v_mov_b64 v[86:87], v[72:73]
    s_mov_b64 exec, -1
    s_or_b64 s[80:81], s[80:81], vcc
    ds_read_b64 v[70:71], v93
    s_and_b64 exec, s[84:85], s[80:81]
    v_mfma_f32_4x4x4_16b_bf16 v[76:79], v[12:13], v[84:85], 0
    v_mov_b32 v92, v7
    s_andn2_b64 s[80:81], s[80:81], s[84:85]
    v_mfma_f32_4x4x4_16b_bf16 v[76:79], v[10:11], v[86:87], v[76:79]
    s_mov_b64 exec, -1
    ds_read_b64 v[68:69], v92
    v_and_b32 v46, 0x80000000, v27
    v_lshrrev_b32 v47, 14, v25
    v_bitop3_b32 v47, v47, v5, v46 bitop3:0xea
    ds_read_b64 v[106:107], v47 offset:63616
    v_bitop3_b32 v95, v25, v5, v46 bitop3:0xea
    v_and_b32 v46, 0x40000000, v27
    v_lshrrev_b32 v47, 14, v24
    v_bitop3_b32 v47, v47, v5, v46 bitop3:0xea
    ds_read_b64 v[104:105], v47 offset:63616
    v_bitop3_b32 v94, v24, v5, v46 bitop3:0xea
    s_waitcnt lgkmcnt(2)
    v_mfma_f32_4x4x4_16b_bf16 v[80:83], v[10:11], v[70:71], v[80:83]
    v_mfma_f32_4x4x4_16b_bf16 v[76:79], v[10:11], v[68:69], v[76:79]
    v_perm_b32 v15, v25, v26, s47
    v_bitop3_b32 v46, v25, 0.5, -0.5 bitop3:0xa8
    v_perm_b32 v14, v24, v26, s46
    v_bitop3_b32 v47, v24, 0.5, -0.5 bitop3:0xa8
    v_cvt_pk_bf16_f32 v80, v80, v81
    v_cvt_pk_bf16_f32 v81, v82, v83
    ds_wrxchg_rtn_b64 v[74:75], v93, v[80:81]
    v_cvt_pk_bf16_f32 v76, v76, v77
    v_cvt_pk_bf16_f32 v77, v78, v79
    ds_wrxchg_rtn_b64 v[72:73], v92, v[76:77]
    s_setprio 1
    s_waitcnt lgkmcnt(2)
    v_mfma_f32_4x4x4_16b_bf16 v[80:83], v[8:9], v[106:107], 0
    v_mfma_f32_4x4x4_16b_bf16 v[76:79], v[8:9], v[104:105], 0
    v_bitop3_b32 v15, v6, v15, v46 bitop3:0xca
    v_bitop3_b32 v14, v6, v14, v47 bitop3:0xca
    s_nop 1
    v_pk_mul_f32 v[80:81], v[80:81], v[14:15] op_sel:[0,1] op_sel_hi:[1,1]
    v_pk_mul_f32 v[82:83], v[82:83], v[14:15] op_sel:[0,1] op_sel_hi:[1,1]
    v_pk_mul_f32 v[76:77], v[76:77], v[14:15] op_sel:[0,0] op_sel_hi:[1,0]
    v_pk_mul_f32 v[78:79], v[78:79], v[14:15] op_sel:[0,0] op_sel_hi:[1,0]
    v_and_b32 v47, 0x0fffffff, v41
    v_mov_b32 v27, v41
    buffer_load_dwordx4 v[22:25], v47, s[8:11], 0 offen
    buffer_load_dwordx3 v[24:26], v47, s[8:11], 0 offen offset:8
    s_waitcnt lgkmcnt(0)
    v_cmpx_ne_u64 vcc, v[74:75], v[70:71]
    s_and_b64 s[82:83], vcc, s[80:81]
    s_cbranch_scc1 L2_c102
L2_d102:
    v_mov_b64 v[84:85], v[70:71]
    v_mov_b32 v7, v93
    v_mov_b64 v[86:87], v[74:75]
    s_mov_b64 exec, -1
    s_or_b64 s[80:81], s[80:81], vcc
    v_cmpx_ne_u64 vcc, v[72:73], v[68:69]
    s_and_b64 s[82:83], vcc, s[80:81]
    s_cbranch_scc1 L2_c103
L2_d103:
    v_mov_b64 v[84:85], v[68:69]
    v_mov_b32 v7, v92
    v_mov_b64 v[86:87], v[72:73]
    s_mov_b64 exec, -1
    s_or_b64 s[80:81], s[80:81], vcc
    ds_read_b64 v[70:71], v95
    ds_read_b64 v[68:69], v94
    s_waitcnt vmcnt(11)
    v_and_b32 v46, 0x20000000, v33
    v_lshrrev_b32 v47, 14, v29
    v_bitop3_b32 v47, v47, v5, v46 bitop3:0xea
    ds_read_b64 v[102:103], v47 offset:63616
    v_bitop3_b32 v93, v29, v5, v46 bitop3:0xea
    v_and_b32 v46, 0x10000000, v33
    v_lshrrev_b32 v47, 14, v28
    v_bitop3_b32 v47, v47, v5, v46 bitop3:0xea
    ds_read_b64 v[100:101], v47 offset:63616
    v_bitop3_b32 v92, v28, v5, v46 bitop3:0xea
    s_waitcnt lgkmcnt(2)
    v_mfma_f32_4x4x4_16b_bf16 v[80:83], v[10:11], v[70:71], v[80:83]
    v_mfma_f32_4x4x4_16b_bf16 v[76:79], v[10:11], v[68:69], v[76:79]
    v_perm_b32 v15, v29, v32, s45
    v_bitop3_b32 v46, v29, 0.5, -0.5 bitop3:0xa8
    v_perm_b32 v14, v28, v32, s44
    v_bitop3_b32 v47, v28, 0.5, -0.5 bitop3:0xa8
    v_cvt_pk_bf16_f32 v80, v80, v81
    v_cvt_pk_bf16_f32 v81, v82, v83
    ds_wrxchg_rtn_b64 v[74:75], v95, v[80:81]
    v_cvt_pk_bf16_f32 v76, v76, v77
    v_cvt_pk_bf16_f32 v77, v78, v79
    ds_wrxchg_rtn_b64 v[72:73], v94, v[76:77]
    s_waitcnt lgkmcnt(2)
    v_mfma_f32_4x4x4_16b_bf16 v[80:83], v[8:9], v[102:103], 0
    v_mfma_f32_4x4x4_16b_bf16 v[76:79], v[8:9], v[100:101], 0
    v_bitop3_b32 v15, v6, v15, v46 bitop3:0xca
    v_bitop3_b32 v14, v6, v14, v47 bitop3:0xca
    v_cmp_lt_u32 s[84:85], v5, v92
    s_nop 0
    v_pk_mul_f32 v[80:81], v[80:81], v[14:15] op_sel:[0,1] op_sel_hi:[1,1]
    v_pk_mul_f32 v[82:83], v[82:83], v[14:15] op_sel:[0,1] op_sel_hi:[1,1]
    v_pk_mul_f32 v[76:77], v[76:77], v[14:15] op_sel:[0,0] op_sel_hi:[1,0]
    v_pk_mul_f32 v[78:79], v[78:79], v[14:15] op_sel:[0,0] op_sel_hi:[1,0]
    s_waitcnt lgkmcnt(0)
    v_cmpx_ne_u64 vcc, v[74:75], v[70:71]
    s_and_b64 s[82:83], vcc, s[80:81]
    s_cbranch_scc1 L2_c104
L2_d104:
    v_mov_b64 v[84:85], v[70:71]
    v_mov_b32 v7, v95
    v_mov_b64 v[86:87], v[74:75]
    s_mov_b64 exec, -1
    s_or_b64 s[80:81], s[80:81], vcc
    v_cmpx_ne_u64 vcc, v[72:73], v[68:69]
    s_and_b64 s[82:83], vcc, s[80:81]
    s_cbranch_scc1 L2_c105
L2_d105:
    v_mov_b64 v[84:85], v[68:69]
    v_mov_b32 v7, v94
    v_mov_b64 v[86:87], v[72:73]
    s_mov_b64 exec, -1
    s_or_b64 s[80:81], s[80:81], vcc
    ds_read_b64 v[70:71], v93
    s_and_b64 exec, s[84:85], s[80:81]
    v_mfma_f32_4x4x4_16b_bf16 v[76:79], v[12:13], v[84:85], 0
    v_mov_b32 v92, v7
    s_andn2_b64 s[80:81], s[80:81], s[84:85]
    v_mfma_f32_4x4x4_16b_bf16 v[76:79], v[10:11], v[86:87], v[76:79]
    s_mov_b64 exec, -1
    ds_read_b64 v[68:69], v92
    v_and_b32 v46, 0x80000000, v33
    v_lshrrev_b32 v47, 14, v31
    v_bitop3_b32 v47, v47, v5, v46 bitop3:0xea
    ds_read_b64 v[106:107], v47 offset:63616
    v_bitop3_b32 v95, v31, v5, v46 bitop3:0xea
    v_and_b32 v46, 0x40000000, v33
    v_lshrrev_b32 v47, 14, v30
    v_bitop3_b32 v47, v47, v5, v46 bitop3:0xea
    ds_read_b64 v[104:105], v47 offset:63616
    v_bitop3_b32 v94, v30, v5, v46 bitop3:0xea
    s_waitcnt lgkmcnt(2)
    v_mfma_f32_4x4x4_16b_bf16 v[80:83], v[10:11], v[70:71], v[80:83]
    v_mfma_f32_4x4x4_16b_bf16 v[76:79], v[10:11], v[68:69], v[76:79]
    v_perm_b32 v15, v31, v32, s47
    v_bitop3_b32 v46, v31, 0.5, -0.5 bitop3:0xa8
    v_perm_b32 v14, v30, v32, s46
    v_bitop3_b32 v47, v30, 0.5, -0.5 bitop3:0xa8
    v_cvt_pk_bf16_f32 v80, v80, v81
    v_cvt_pk_bf16_f32 v81, v82, v83
    ds_wrxchg_rtn_b64 v[74:75], v93, v[80:81]
    v_cvt_pk_bf16_f32 v76, v76, v77
    v_cvt_pk_bf16_f32 v77, v78, v79
    ds_wrxchg_rtn_b64 v[72:73], v92, v[76:77]
    s_setprio 0
    s_waitcnt lgkmcnt(2)
    v_mfma_f32_4x4x4_16b_bf16 v[80:83], v[8:9], v[106:107], 0
    v_mfma_f32_4x4x4_16b_bf16 v[76:79], v[8:9], v[104:105], 0
    v_bitop3_b32 v15, v6, v15, v46 bitop3:0xca
    v_bitop3_b32 v14, v6, v14, v47 bitop3:0xca
    s_nop 1
    v_pk_mul_f32 v[80:81], v[80:81], v[14:15] op_sel:[0,1] op_sel_hi:[1,1]
    v_pk_mul_f32 v[82:83], v[82:83], v[14:15] op_sel:[0,1] op_sel_hi:[1,1]
    v_pk_mul_f32 v[76:77], v[76:77], v[14:15] op_sel:[0,0] op_sel_hi:[1,0]
    v_pk_mul_f32 v[78:79], v[78:79], v[14:15] op_sel:[0,0] op_sel_hi:[1,0]
    s_add_u32 s40, s40, 0x4e200
    v_and_b32 v47, 0x0fffffff, v42
    v_mov_b32 v33, v42
    buffer_load_dwordx4 v[28:31], v47, s[8:11], 0 offen
    buffer_load_dwordx3 v[30:32], v47, s[8:11], 0 offen offset:8
    s_waitcnt lgkmcnt(0)
    v_cmpx_ne_u64 vcc, v[74:75], v[70:71]
    s_and_b64 s[82:83], vcc, s[80:81]
    s_cbranch_scc1 L2_c106
L2_d106:
    v_mov_b64 v[84:85], v[70:71]
    v_mov_b32 v7, v93
    v_mov_b64 v[86:87], v[74:75]
    s_mov_b64 exec, -1
    s_or_b64 s[80:81], s[80:81], vcc
    v_cmpx_ne_u64 vcc, v[72:73], v[68:69]
    s_and_b64 s[82:83], vcc, s[80:81]
    s_cbranch_scc1 L2_c107
L2_d107:
    v_mov_b64 v[84:85], v[68:69]
    v_mov_b32 v7, v92
    v_mov_b64 v[86:87], v[72:73]
    s_mov_b64 exec, -1
    s_or_b64 s[80:81], s[80:81], vcc
    ds_read_b64 v[70:71], v95
    ds_read_b64 v[68:69], v94
    s_waitcnt vmcnt(8)
    v_and_b32 v46, 0x20000000, v39
    v_lshrrev_b32 v47, 14, v35
    v_bitop3_b32 v47, v47, v5, v46 bitop3:0xea
    ds_read_b64 v[102:103], v47 offset:63616
    v_bitop3_b32 v93, v35, v5, v46 bitop3:0xea
    v_and_b32 v46, 0x10000000, v39
    v_lshrrev_b32 v47, 14, v34
    v_bitop3_b32 v47, v47, v5, v46 bitop3:0xea
    ds_read_b64 v[100:101], v47 offset:63616
    v_bitop3_b32 v92, v34, v5, v46 bitop3:0xea
    v_and_b32 v46, 0x80000000, v39
    v_lshrrev_b32 v47, 14, v37
    v_bitop3_b32 v47, v47, v5, v46 bitop3:0xea
    ds_read_b64 v[106:107], v47 offset:63616
    v_and_b32 v46, 0x40000000, v39
    v_lshrrev_b32 v47, 14, v36
    v_bitop3_b32 v47, v47, v5, v46 bitop3:0xea
    ds_read_b64 v[104:105], v47 offset:63616
    s_waitcnt lgkmcnt(4)
    v_mfma_f32_4x4x4_16b_bf16 v[80:83], v[10:11], v[70:71], v[80:83]
    v_mfma_f32_4x4x4_16b_bf16 v[76:79], v[10:11], v[68:69], v[76:79]
    v_perm_b32 v15, v35, v38, s45
    v_bitop3_b32 v46, v35, 0.5, -0.5 bitop3:0xa8
    v_perm_b32 v14, v34, v38, s44
    v_bitop3_b32 v47, v34, 0.5, -0.5 bitop3:0xa8
    v_cvt_pk_bf16_f32 v80, v80, v81
    v_cvt_pk_bf16_f32 v81, v82, v83
    ds_wrxchg_rtn_b64 v[74:75], v95, v[80:81]
    v_cvt_pk_bf16_f32 v76, v76, v77
    v_cvt_pk_bf16_f32 v77, v78, v79
    ds_wrxchg_rtn_b64 v[72:73], v94, v[76:77]
    s_waitcnt lgkmcnt(2)
    s_barrier
    s_setprio 3
    ds_write_b128 v3, v[124:127] offset:4096
    s_add_u32 s3, s40, 4096
    buffer_load_dwordx4 v[124:127], v3, s[16:19], s3 offen
    ds_write_b128 v3, v[116:119] offset:2048
    buffer_load_dwordx4 v[116:119], v3, s[16:19], s40 offen offset:2048
    ds_write_b128 v3, v[120:123] offset:3072
    buffer_load_dwordx4 v[120:123], v3, s[16:19], s40 offen offset:3072
    v_mfma_f32_4x4x4_16b_bf16 v[80:83], v[8:9], v[102:103], 0
    v_mfma_f32_4x4x4_16b_bf16 v[76:79], v[8:9], v[100:101], 0
    v_bitop3_b32 v15, v6, v15, v46 bitop3:0xca
    v_bitop3_b32 v14, v6, v14, v47 bitop3:0xca
    v_cmp_lt_u32 s[84:85], v5, v92
    s_nop 0
    v_pk_mul_f32 v[80:81], v[80:81], v[14:15] op_sel:[0,1] op_sel_hi:[1,1]
    v_pk_mul_f32 v[82:83], v[82:83], v[14:15] op_sel:[0,1] op_sel_hi:[1,1]
    v_pk_mul_f32 v[76:77], v[76:77], v[14:15] op_sel:[0,0] op_sel_hi:[1,0]
    v_pk_mul_f32 v[78:79], v[78:79], v[14:15] op_sel:[0,0] op_sel_hi:[1,0]
    v_mov_b32 v44, v43
    s_cmp_gt_u32 s37, 1024
    s_cbranch_scc1 L2_xs108
    s_cmp_lg_u32 s43, 0
    s_cbranch_scc1 L2_xa108
L2_xb108:
    v_lshlrev_b32 v89, 16, v96
    v_add_u32 v90, 60, v97
    v_bitop3_b32 v90, v89, v45, v90 bitop3:0x6a
    ds_write_b32 v98, v90 offset:12
    v_lshlrev_b32 v89, 20, v96
    v_add_u32 v90, 40, v97
    v_bitop3_b32 v90, v89, v45, v90 bitop3:0x6a
    ds_write_b32 v98, v90 offset:8
    v_lshlrev_b32 v89, 24, v96
    v_add_u32 v90, 20, v97
    v_bitop3_b32 v90, v89, v45, v90 bitop3:0x6a
    ds_write_b32 v98, v90 offset:4
    v_lshlrev_b32 v89, 28, v96
    v_bitop3_b32 v90, v89, v45, v97 bitop3:0x6a
    ds_write_b32 v98, v90 offset:0
    v_mov_b32_dpp v91, v66 quad_perm:[1,1,1,1] row_mask:0xf bank_mask:0xf
    v_and_b32 v89, 3, v91
    v_and_b32 v97, 0xfffc, v91
    v_sub_u16_dpp v88, v66, v91 quad_perm:[3,3,3,3] row_mask:0xf bank_mask:0xf
    v_mad_u32_u24 v97, v97, 5, v4
    v_add_u32 v99, v88, v89
    v_bfm_b32 v96, v88, v89
    v_cmp_lt_u32 s[58:59], 16, v99
    v_lshlrev_b32 v89, v1, v96
    v_and_b32 v89, v45, v89
    v_cmp_ne_u32 vcc, 0, v89
    v_xor_b32 v90, v97, v89
    s_add_u32 s3, s37, s38
    v_mbcnt_lo_u32_b32 v98, vcc_lo, 0
    v_mbcnt_hi_u32_b32 v98, vcc_hi, v98
    s_bcnt1_i32_b64 s41, vcc
    v_lshl_add_u32 v98, v98, 2, s3
    s_mov_b64 exec, vcc
    ds_write_b32 v98, v90
    s_mov_b64 exec, -1
    s_lshl2_add_u32 s37, s41, s37
    s_cmp_lg_u64 s[58:59], 0
    s_cbranch_scc1 L2_xe108
L2_xr108:
    v_add_u32 v98, s37, v0
    v_mov_b32 v90, -1
    ds_write_b32 v98, v90
    ds_read2st64_b32 v[40:41], v0 offset0:0 offset1:1
    ds_read2st64_b32 v[42:43], v0 offset0:2 offset1:3
    s_sub_u32 s3, s37, 768
    s_cmp_gt_u32 s3, 256
    s_cbranch_scc1 L2_xf108
L2_xg108:
    v_lshrrev_b64 v[64:65], 16, v[64:65]
    v_lshrrev_b64 v[66:67], 16, v[66:67]
    s_setprio 2
    s_waitcnt vmcnt(10)
    ds_write_b128 v3, v[108:111] offset:0
    s_waitcnt lgkmcnt(12)
    v_cmpx_ne_u64 vcc, v[74:75], v[70:71]
    s_and_b64 s[82:83], vcc, s[80:81]
    s_cbranch_scc1 L2_c109
L2_d109:
    v_mov_b64 v[84:85], v[70:71]
    v_mov_b32 v7, v95
    v_mov_b64 v[86:87], v[74:75]
    s_mov_b64 exec, -1
    s_or_b64 s[80:81], s[80:81], vcc
    v_cmpx_ne_u64 vcc, v[72:73], v[68:69]
    s_and_b64 s[82:83], vcc, s[80:81]
    s_cbranch_scc1 L2_c110
L2_d110:
    v_mov_b64 v[84:85], v[68:69]
    v_mov_b32 v7, v94
    v_mov_b64 v[86:87], v[72:73]
    s_mov_b64 exec, -1
    s_or_b64 s[80:81], s[80:81], vcc
    ds_read_b64 v[70:71], v93
    s_and_b64 exec, s[84:85], s[80:81]
    v_mfma_f32_4x4x4_16b_bf16 v[76:79], v[12:13], v[84:85], 0
    v_mov_b32 v92, v7
    s_andn2_b64 s[80:81], s[80:81], s[84:85]
    v_mfma_f32_4x4x4_16b_bf16 v[76:79], v[10:11], v[86:87], v[76:79]
    s_mov_b64 exec, -1
    ds_read_b64 v[68:69], v92
    s_setprio 1
    s_waitcnt vmcnt(7)
    ds_write_b128 v3, v[112:115] offset:1024
    s_waitcnt lgkmcnt(1)
    v_mfma_f32_4x4x4_16b_bf16 v[80:83], v[10:11], v[70:71], v[80:83]
    v_mfma_f32_4x4x4_16b_bf16 v[76:79], v[10:11], v[68:69], v[76:79]
    v_and_b32 v46, 0x40000000, v39
    v_bitop3_b32 v94, v36, v5, v46 bitop3:0xea
    v_and_b32 v46, 0x80000000, v39
    v_bitop3_b32 v95, v37, v5, v46 bitop3:0xea
    v_perm_b32 v15, v37, v38, s47
    v_bitop3_b32 v46, v37, 0.5, -0.5 bitop3:0xa8
    v_perm_b32 v14, v36, v38, s46
    v_bitop3_b32 v47, v36, 0.5, -0.5 bitop3:0xa8
    v_cvt_pk_bf16_f32 v80, v80, v81
    v_cvt_pk_bf16_f32 v81, v82, v83
    ds_wrxchg_rtn_b64 v[74:75], v93, v[80:81]
    v_cvt_pk_bf16_f32 v76, v76, v77
    v_cvt_pk_bf16_f32 v77, v78, v79
    ds_wrxchg_rtn_b64 v[72:73], v92, v[76:77]
    s_setprio 0
    v_mfma_f32_4x4x4_16b_bf16 v[80:83], v[8:9], v[106:107], 0
    v_mfma_f32_4x4x4_16b_bf16 v[76:79], v[8:9], v[104:105], 0
    v_bitop3_b32 v15, v6, v15, v46 bitop3:0xca
    v_bitop3_b32 v14, v6, v14, v47 bitop3:0xca
    s_nop 1
    v_pk_mul_f32 v[80:81], v[80:81], v[14:15] op_sel:[0,1] op_sel_hi:[1,1]
    v_pk_mul_f32 v[82:83], v[82:83], v[14:15] op_sel:[0,1] op_sel_hi:[1,1]
    v_pk_mul_f32 v[76:77], v[76:77], v[14:15] op_sel:[0,0] op_sel_hi:[1,0]
    v_pk_mul_f32 v[78:79], v[78:79], v[14:15] op_sel:[0,0] op_sel_hi:[1,0]
    s_add_u32 s42, s42, 1
    s_waitcnt lgkmcnt(2)
    s_cmp_lg_u32 s42, 14
    s_cbranch_scc1 L2_loop
    s_barrier
    s_bitcmp1_b32 s36, s42
    s_cbranch_scc1 L2_slow
L2_ret6:
    s_setprio 3
    v_and_b32 v47, 0x0fffffff, v44
    v_mov_b32 v39, v44
    buffer_load_dwordx4 v[34:37], v47, s[8:11], 0 offen
    buffer_load_dwordx3 v[36:38], v47, s[8:11], 0 offen offset:8
    s_waitcnt lgkmcnt(0)
    v_cmpx_ne_u64 vcc, v[74:75], v[70:71]
    s_and_b64 s[82:83], vcc, s[80:81]
    s_cbranch_scc1 L2_c111
L2_d111:
    v_mov_b64 v[84:85], v[70:71]
    v_mov_b32 v7, v93
    v_mov_b64 v[86:87], v[74:75]
    s_mov_b64 exec, -1
    s_or_b64 s[80:81], s[80:81], vcc
    v_cmpx_ne_u64 vcc, v[72:73], v[68:69]
    s_and_b64 s[82:83], vcc, s[80:81]
    s_cbranch_scc1 L2_c112
L2_d112:
    v_mov_b64 v[84:85], v[68:69]
    v_mov_b32 v7, v92
    v_mov_b64 v[86:87], v[72:73]
    s_mov_b64 exec, -1
    s_or_b64 s[80:81], s[80:81], vcc
    ds_read_b64 v[70:71], v95
    ds_read_b64 v[68:69], v94
    v_and_b32 v46, 0x20000000, v21
    v_lshrrev_b32 v47, 14, v17
    v_bitop3_b32 v47, v47, v5, v46 bitop3:0xea
    ds_read_b64 v[102:103], v47 offset:63616
    v_bitop3_b32 v93, v17, v5, v46 bitop3:0xea
    v_and_b32 v46, 0x10000000, v21
    v_lshrrev_b32 v47, 14, v16
    v_bitop3_b32 v47, v47, v5, v46 bitop3:0xea
    ds_read_b64 v[100:101], v47 offset:63616
    v_bitop3_b32 v92, v16, v5, v46 bitop3:0xea
    s_waitcnt lgkmcnt(2)
    v_mfma_f32_4x4x4_16b_bf16 v[80:83], v[10:11], v[70:71], v[80:83]
    v_mfma_f32_4x4x4_16b_bf16 v[76:79], v[10:11], v[68:69], v[76:79]
    v_perm_b32 v15, v17, v20, s45
    v_bitop3_b32 v46, v17, 0.5, -0.5 bitop3:0xa8
    v_perm_b32 v14, v16, v20, s44
    v_bitop3_b32 v47, v16, 0.5, -0.5 bitop3:0xa8
    v_cvt_pk_bf16_f32 v80, v80, v81
    v_cvt_pk_bf16_f32 v81, v82, v83
    ds_wrxchg_rtn_b64 v[74:75], v95, v[80:81]
    v_cvt_pk_bf16_f32 v76, v76, v77
    v_cvt_pk_bf16_f32 v77, v78, v79
    ds_wrxchg_rtn_b64 v[72:73], v94, v[76:77]
    s_waitcnt lgkmcnt(2)
    v_mfma_f32_4x4x4_16b_bf16 v[80:83], v[8:9], v[102:103], 0
    v_mfma_f32_4x4x4_16b_bf16 v[76:79], v[8:9], v[100:101], 0
    v_bitop3_b32 v15, v6, v15, v46 bitop3:0xca
    v_bitop3_b32 v14, v6, v14, v47 bitop3:0xca
    v_cmp_lt_u32 s[84:85], v5, v92
    s_nop 0
    v_pk_mul_f32 v[80:81], v[80:81], v[14:15] op_sel:[0,1] op_sel_hi:[1,1]
    v_pk_mul_f32 v[82:83], v[82:83], v[14:15] op_sel:[0,1] op_sel_hi:[1,1]
    v_pk_mul_f32 v[76:77], v[76:77], v[14:15] op_sel:[0,0] op_sel_hi:[1,0]
    v_pk_mul_f32 v[78:79], v[78:79], v[14:15] op_sel:[0,0] op_sel_hi:[1,0]
    buffer_load_dwordx4 v[108:111], v3, s[16:19], s40 offen offset:0
    s_waitcnt lgkmcnt(0)
    v_cmpx_ne_u64 vcc, v[74:75], v[70:71]
    s_and_b64 s[82:83], vcc, s[80:81]
    s_cbranch_scc1 L2_c113
L2_d113:
    v_mov_b64 v[84:85], v[70:71]
    v_mov_b32 v7, v95
    v_mov_b64 v[86:87], v[74:75]
    s_mov_b64 exec, -1
    s_or_b64 s[80:81], s[80:81], vcc
    v_cmpx_ne_u64 vcc, v[72:73], v[68:69]
    s_and_b64 s[82:83], vcc, s[80:81]
    s_cbranch_scc1 L2_c114
L2_d114:
    v_mov_b64 v[84:85], v[68:69]
    v_mov_b32 v7, v94
    v_mov_b64 v[86:87], v[72:73]
    s_mov_b64 exec, -1
    s_or_b64 s[80:81], s[80:81], vcc
    ds_read_b64 v[70:71], v93
    s_and_b64 exec, s[84:85], s[80:81]
    v_mfma_f32_4x4x4_16b_bf16 v[76:79], v[12:13], v[84:85], 0
    v_mov_b32 v92, v7
    s_andn2_b64 s[80:81], s[80:81], s[84:85]
    v_mfma_f32_4x4x4_16b_bf16 v[76:79], v[10:11], v[86:87], v[76:79]
    s_mov_b64 exec, -1
    ds_read_b64 v[68:69], v92
    v_and_b32 v46, 0x80000000, v21
    v_lshrrev_b32 v47, 14, v19
    v_bitop3_b32 v47, v47, v5, v46 bitop3:0xea
    ds_read_b64 v[106:107], v47 offset:63616
    v_bitop3_b32 v95, v19, v5, v46 bitop3:0xea
    v_and_b32 v46, 0x40000000, v21
    v_lshrrev_b32 v47, 14, v18
    v_bitop3_b32 v47, v47, v5, v46 bitop3:0xea
    ds_read_b64 v[104:105], v47 offset:63616
    v_bitop3_b32 v94, v18, v5, v46 bitop3:0xea
    s_waitcnt lgkmcnt(2)
    v_mfma_f32_4x4x4_16b_bf16 v[80:83], v[10:11], v[70:71], v[80:83]
    v_mfma_f32_4x4x4_16b_bf16 v[76:79], v[10:11], v[68:69], v[76:79]
    v_perm_b32 v15, v19, v20, s47
    v_bitop3_b32 v46, v19, 0.5, -0.5 bitop3:0xa8
    v_perm_b32 v14, v18, v20, s46
    v_bitop3_b32 v47, v18, 0.5, -0.5 bitop3:0xa8
    v_cvt_pk_bf16_f32 v80, v80, v81
    v_cvt_pk_bf16_f32 v81, v82, v83
    ds_wrxchg_rtn_b64 v[74:75], v93, v[80:81]
    v_cvt_pk_bf16_f32 v76, v76, v77
    v_cvt_pk_bf16_f32 v77, v78, v79
    ds_wrxchg_rtn_b64 v[72:73], v92, v[76:77]
    s_setprio 2
    s_waitcnt lgkmcnt(2)
    v_mfma_f32_4x4x4_16b_bf16 v[80:83], v[8:9], v[106:107], 0
    v_mfma_f32_4x4x4_16b_bf16 v[76:79], v[8:9], v[104:105], 0
    v_bitop3_b32 v15, v6, v15, v46 bitop3:0xca
    v_bitop3_b32 v14, v6, v14, v47 bitop3:0xca
    s_nop 1
    v_pk_mul_f32 v[80:81], v[80:81], v[14:15] op_sel:[0,1] op_sel_hi:[1,1]
    v_pk_mul_f32 v[82:83], v[82:83], v[14:15] op_sel:[0,1] op_sel_hi:[1,1]
    v_pk_mul_f32 v[76:77], v[76:77], v[14:15] op_sel:[0,0] op_sel_hi:[1,0]
    v_pk_mul_f32 v[78:79], v[78:79], v[14:15] op_sel:[0,0] op_sel_hi:[1,0]
    v_and_b32 v47, 0x0fffffff, v40
    v_mov_b32 v21, v40
    buffer_load_dwordx4 v[16:19], v47, s[8:11], 0 offen
    buffer_load_dwordx3 v[18:20], v47, s[8:11], 0 offen offset:8
    s_waitcnt lgkmcnt(0)
    v_cmpx_ne_u64 vcc, v[74:75], v[70:71]
    s_and_b64 s[82:83], vcc, s[80:81]
    s_cbranch_scc1 L2_c115
L2_d115:
    v_mov_b64 v[84:85], v[70:71]
    v_mov_b32 v7, v93
    v_mov_b64 v[86:87], v[74:75]
    s_mov_b64 exec, -1
    s_or_b64 s[80:81], s[80:81], vcc
    v_cmpx_ne_u64 vcc, v[72:73], v[68:69]
    s_and_b64 s[82:83], vcc, s[80:81]
    s_cbranch_scc1 L2_c116
L2_d116:
    v_mov_b64 v[84:85], v[68:69]
    v_mov_b32 v7, v92
    v_mov_b64 v[86:87], v[72:73]
    s_mov_b64 exec, -1
    s_or_b64 s[80:81], s[80:81], vcc
    ds_read_b64 v[70:71], v95
    ds_read_b64 v[68:69], v94
    s_waitcnt vmcnt(10)
    v_and_b32 v46, 0x20000000, v27
    v_lshrrev_b32 v47, 14, v23
    v_bitop3_b32 v47, v47, v5, v46 bitop3:0xea
    ds_read_b64 v[102:103], v47 offset:63616
    v_bitop3_b32 v93, v23, v5, v46 bitop3:0xea
    v_and_b32 v46, 0x10000000, v27
    v_lshrrev_b32 v47, 14, v22
    v_bitop3_b32 v47, v47, v5, v46 bitop3:0xea
    ds_read_b64 v[100:101], v47 offset:63616
    v_bitop3_b32 v92, v22, v5, v46 bitop3:0xea
    s_waitcnt lgkmcnt(2)
    v_mfma_f32_4x4x4_16b_bf16 v[80:83], v[10:11], v[70:71], v[80:83]
    v_mfma_f32_4x4x4_16b_bf16 v[76:79], v[10:11], v[68:69], v[76:79]
    v_perm_b32 v15, v23, v26, s45
    v_bitop3_b32 v46, v23, 0.5, -0.5 bitop3:0xa8
    v_perm_b32 v14, v22, v26, s44
    v_bitop3_b32 v47, v22, 0.5, -0.5 bitop3:0xa8
    v_cvt_pk_bf16_f32 v80, v80, v81
    v_cvt_pk_bf16_f32 v81, v82, v83
    ds_wrxchg_rtn_b64 v[74:75], v95, v[80:81]
    v_cvt_pk_bf16_f32 v76, v76, v77
    v_cvt_pk_bf16_f32 v77, v78, v79
    ds_wrxchg_rtn_b64 v[72:73], v94, v[76:77]
    s_waitcnt lgkmcnt(2)
    v_mfma_f32_4x4x4_16b_bf16 v[80:83], v[8:9], v[102:103], 0
    v_mfma_f32_4x4x4_16b_bf16 v[76:79], v[8:9], v[100:101], 0
    v_bitop3_b32 v15, v6, v15, v46 bitop3:0xca
    v_bitop3_b32 v14, v6, v14, v47 bitop3:0xca
    v_cmp_lt_u32 s[84:85], v5, v92
    s_nop 0
    v_pk_mul_f32 v[80:81], v[80:81], v[14:15] op_sel:[0,1] op_sel_hi:[1,1]
    v_pk_mul_f32 v[82:83], v[82:83], v[14:15] op_sel:[0,1] op_sel_hi:[1,1]
    v_pk_mul_f32 v[76:77], v[76:77], v[14:15] op_sel:[0,0] op_sel_hi:[1,0]
    v_pk_mul_f32 v[78:79], v[78:79], v[14:15] op_sel:[0,0] op_sel_hi:[1,0]
    buffer_load_dwordx4 v[112:115], v3, s[16:19], s40 offen offset:1024
    s_waitcnt lgkmcnt(0)
    v_cmpx_ne_u64 vcc, v[74:75], v[70:71]
    s_and_b64 s[82:83], vcc, s[80:81]
    s_cbranch_scc1 L2_c117
L2_d117:
    v_mov_b64 v[84:85], v[70:71]
    v_mov_b32 v7, v95
    v_mov_b64 v[86:87], v[74:75]
    s_mov_b64 exec, -1
    s_or_b64 s[80:81], s[80:81], vcc
    v_cmpx_ne_u64 vcc, v[72:73], v[68:69]
    s_and_b64 s[82:83], vcc, s[80:81]
    s_cbranch_scc1 L2_c118
L2_d118:
    v_mov_b64 v[84:85], v[68:69]
    v_mov_b32 v7, v94
    v_mov_b64 v[86:87], v[72:73]
    s_mov_b64 exec, -1
    s_or_b64 s[80:81], s[80:81], vcc
    ds_read_b64 v[70:71], v93
    s_and_b64 exec, s[84:85], s[80:81]
    v_mfma_f32_4x4x4_16b_bf16 v[76:79], v[12:13], v[84:85], 0
    v_mov_b32 v92, v7
    s_andn2_b64 s[80:81], s[80:81], s[84:85]
    v_mfma_f32_4x4x4_16b_bf16 v[76:79], v[10:11], v[86:87], v[76:79]
    s_mov_b64 exec, -1
    ds_read_b64 v[68:69], v92
    v_and_b32 v46, 0x80000000, v27
    v_lshrrev_b32 v47, 14, v25
    v_bitop3_b32 v47, v47, v5, v46 bitop3:0xea
    ds_read_b64 v[106:107], v47 offset:63616
    v_bitop3_b32 v95, v25, v5, v46 bitop3:0xea
    v_and_b32 v46, 0x40000000, v27
    v_lshrrev_b32 v47, 14, v24
    v_bitop3_b32 v47, v47, v5, v46 bitop3:0xea
    ds_read_b64 v[104:105], v47 offset:63616
    v_bitop3_b32 v94, v24, v5, v46 bitop3:0xea
    s_waitcnt lgkmcnt(2)
    v_mfma_f32_4x4x4_16b_bf16 v[80:83], v[10:11], v[70:71], v[80:83]
    v_mfma_f32_4x4x4_16b_bf16 v[76:79], v[10:11], v[68:69], v[76:79]
    v_perm_b32 v15, v25, v26, s47
    v_bitop3_b32 v46, v25, 0.5, -0.5 bitop3:0xa8
    v_perm_b32 v14, v24, v26, s46
    v_bitop3_b32 v47, v24, 0.5, -0.5 bitop3:0xa8
    v_cvt_pk_bf16_f32 v80, v80, v81
    v_cvt_pk_bf16_f32 v81, v82, v83
    ds_wrxchg_rtn_b64 v[74:75], v93, v[80:81]
    v_cvt_pk_bf16_f32 v76, v76, v77
    v_cvt_pk_bf16_f32 v77, v78, v79
    ds_wrxchg_rtn_b64 v[72:73], v92, v[76:77]
    s_setprio 1
    s_waitcnt lgkmcnt(2)
    v_mfma_f32_4x4x4_16b_bf16 v[80:83], v[8:9], v[106:107], 0
    v_mfma_f32_4x4x4_16b_bf16 v[76:79], v[8:9], v[104:105], 0
    v_bitop3_b32 v15, v6, v15, v46 bitop3:0xca
    v_bitop3_b32 v14, v6, v14, v47 bitop3:0xca
    s_nop 1
    v_pk_mul_f32 v[80:81], v[80:81], v[14:15] op_sel:[0,1] op_sel_hi:[1,1]
    v_pk_mul_f32 v[82:83], v[82:83], v[14:15] op_sel:[0,1] op_sel_hi:[1,1]
    v_pk_mul_f32 v[76:77], v[76:77], v[14:15] op_sel:[0,0] op_sel_hi:[1,0]
    v_pk_mul_f32 v[78:79], v[78:79], v[14:15] op_sel:[0,0] op_sel_hi:[1,0]
    v_and_b32 v47, 0x0fffffff, v41
    v_mov_b32 v27, v41
    buffer_load_dwordx4 v[22:25], v47, s[8:11], 0 offen
    buffer_load_dwordx3 v[24:26], v47, s[8:11], 0 offen offset:8
    s_waitcnt lgkmcnt(0)
    v_cmpx_ne_u64 vcc, v[74:75], v[70:71]
    s_and_b64 s[82:83], vcc, s[80:81]
    s_cbranch_scc1 L2_c119
L2_d119:
    v_mov_b64 v[84:85], v[70:71]
    v_mov_b32 v7, v93
    v_mov_b64 v[86:87], v[74:75]
    s_mov_b64 exec, -1
    s_or_b64 s[80:81], s[80:81], vcc
    v_cmpx_ne_u64 vcc, v[72:73], v[68:69]
    s_and_b64 s[82:83], vcc, s[80:81]
    s_cbranch_scc1 L2_c120
L2_d120:
    v_mov_b64 v[84:85], v[68:69]
    v_mov_b32 v7, v92
    v_mov_b64 v[86:87], v[72:73]
    s_mov_b64 exec, -1
    s_or_b64 s[80:81], s[80:81], vcc
    ds_read_b64 v[70:71], v95
    ds_read_b64 v[68:69], v94
    s_waitcnt vmcnt(11)
    v_and_b32 v46, 0x20000000, v33
    v_lshrrev_b32 v47, 14, v29
    v_bitop3_b32 v47, v47, v5, v46 bitop3:0xea
    ds_read_b64 v[102:103], v47 offset:63616
    v_bitop3_b32 v93, v29, v5, v46 bitop3:0xea
    v_and_b32 v46, 0x10000000, v33
    v_lshrrev_b32 v47, 14, v28
    v_bitop3_b32 v47, v47, v5, v46 bitop3:0xea
    ds_read_b64 v[100:101], v47 offset:63616
    v_bitop3_b32 v92, v28, v5, v46 bitop3:0xea
    s_waitcnt lgkmcnt(2)
    v_mfma_f32_4x4x4_16b_bf16 v[80:83], v[10:11], v[70:71], v[80:83]
    v_mfma_f32_4x4x4_16b_bf16 v[76:79], v[10:11], v[68:69], v[76:79]
    v_perm_b32 v15, v29, v32, s45
    v_bitop3_b32 v46, v29, 0.5, -0.5 bitop3:0xa8
    v_perm_b32 v14, v28, v32, s44
    v_bitop3_b32 v47, v28, 0.5, -0.5 bitop3:0xa8
    v_cvt_pk_bf16_f32 v80, v80, v81
    v_cvt_pk_bf16_f32 v81, v82, v83
    ds_wrxchg_rtn_b64 v[74:75], v95, v[80:81]
    v_cvt_pk_bf16_f32 v76, v76, v77
    v_cvt_pk_bf16_f32 v77, v78, v79
    ds_wrxchg_rtn_b64 v[72:73], v94, v[76:77]
    s_waitcnt lgkmcnt(2)
    v_mfma_f32_4x4x4_16b_bf16 v[80:83], v[8:9], v[102:103], 0
    v_mfma_f32_4x4x4_16b_bf16 v[76:79], v[8:9], v[100:101], 0
    v_bitop3_b32 v15, v6, v15, v46 bitop3:0xca
    v_bitop3_b32 v14, v6, v14, v47 bitop3:0xca
    v_cmp_lt_u32 s[84:85], v5, v92
    s_nop 0
    v_pk_mul_f32 v[80:81], v[80:81], v[14:15] op_sel:[0,1] op_sel_hi:[1,1]
    v_pk_mul_f32 v[82:83], v[82:83], v[14:15] op_sel:[0,1] op_sel_hi:[1,1]
    v_pk_mul_f32 v[76:77], v[76:77], v[14:15] op_sel:[0,0] op_sel_hi:[1,0]
    v_pk_mul_f32 v[78:79], v[78:79], v[14:15] op_sel:[0,0] op_sel_hi:[1,0]
    s_waitcnt lgkmcnt(0)
    v_cmpx_ne_u64 vcc, v[74:75], v[70:71]
    s_and_b64 s[82:83], vcc, s[80:81]
    s_cbranch_scc1 L2_c121
L2_d121:
    v_mov_b64 v[84:85], v[70:71]
    v_mov_b32 v7, v95
    v_mov_b64 v[86:87], v[74:75]
    s_mov_b64 exec, -1
    s_or_b64 s[80:81], s[80:81], vcc
    v_cmpx_ne_u64 vcc, v[72:73], v[68:69]
    s_and_b64 s[82:83], vcc, s[80:81]
    s_cbranch_scc1 L2_c122
L2_d122:
    v_mov_b64 v[84:85], v[68:69]
    v_mov_b32 v7, v94
    v_mov_b64 v[86:87], v[72:73]
    s_mov_b64 exec, -1
    s_or_b64 s[80:81], s[80:81], vcc
    ds_read_b64 v[70:71], v93
    s_and_b64 exec, s[84:85], s[80:81]
    v_mfma_f32_4x4x4_16b_bf16 v[76:79], v[12:13], v[84:85], 0
    v_mov_b32 v92, v7
    s_andn2_b64 s[80:81], s[80:81], s[84:85]
    v_mfma_f32_4x4x4_16b_bf16 v[76:79], v[10:11], v[86:87], v[76:79]
    s_mov_b64 exec, -1
    ds_read_b64 v[68:69], v92
    v_and_b32 v46, 0x80000000, v33
    v_lshrrev_b32 v47, 14, v31
    v_bitop3_b32 v47, v47, v5, v46 bitop3:0xea
    ds_read_b64 v[106:107], v47 offset:63616
    v_bitop3_b32 v95, v31, v5, v46 bitop3:0xea
    v_and_b32 v46, 0x40000000, v33
    v_lshrrev_b32 v47, 14, v30
    v_bitop3_b32 v47, v47, v5, v46 bitop3:0xea
    ds_read_b64 v[104:105], v47 offset:63616
    v_bitop3_b32 v94, v30, v5, v46 bitop3:0xea
    s_waitcnt lgkmcnt(2)
    v_mfma_f32_4x4x4_16b_bf16 v[80:83], v[10:11], v[70:71], v[80:83]
    v_mfma_f32_4x4x4_16b_bf16 v[76:79], v[10:11], v[68:69], v[76:79]
    v_perm_b32 v15, v31, v32, s47
    v_bitop3_b32 v46, v31, 0.5, -0.5 bitop3:0xa8
    v_perm_b32 v14, v30, v32, s46
    v_bitop3_b32 v47, v30, 0.5, -0.5 bitop3:0xa8
    v_cvt_pk_bf16_f32 v80, v80, v81
    v_cvt_pk_bf16_f32 v81, v82, v83
    ds_wrxchg_rtn_b64 v[74:75], v93, v[80:81]
    v_cvt_pk_bf16_f32 v76, v76, v77
    v_cvt_pk_bf16_f32 v77, v78, v79
    ds_wrxchg_rtn_b64 v[72:73], v92, v[76:77]
    s_setprio 0
    s_waitcnt lgkmcnt(2)
    v_mfma_f32_4x4x4_16b_bf16 v[80:83], v[8:9], v[106:107], 0
    v_mfma_f32_4x4x4_16b_bf16 v[76:79], v[8:9], v[104:105], 0
    v_bitop3_b32 v15, v6, v15, v46 bitop3:0xca
    v_bitop3_b32 v14, v6, v14, v47 bitop3:0xca
    s_nop 1
    v_pk_mul_f32 v[80:81], v[80:81], v[14:15] op_sel:[0,1] op_sel_hi:[1,1]
    v_pk_mul_f32 v[82:83], v[82:83], v[14:15] op_sel:[0,1] op_sel_hi:[1,1]
    v_pk_mul_f32 v[76:77], v[76:77], v[14:15] op_sel:[0,0] op_sel_hi:[1,0]
    v_pk_mul_f32 v[78:79], v[78:79], v[14:15] op_sel:[0,0] op_sel_hi:[1,0]
    s_add_u32 s40, s40, 0xfff29280
    v_and_b32 v47, 0x0fffffff, v42
    v_mov_b32 v33, v42
    buffer_load_dwordx4 v[28:31], v47, s[8:11], 0 offen
    buffer_load_dwordx3 v[30:32], v47, s[8:11], 0 offen offset:8
    s_waitcnt lgkmcnt(0)
    v_cmpx_ne_u64 vcc, v[74:75], v[70:71]
    s_and_b64 s[82:83], vcc, s[80:81]
    s_cbranch_scc1 L2_c123
L2_d123:
    v_mov_b64 v[84:85], v[70:71]
    v_mov_b32 v7, v93
    v_mov_b64 v[86:87], v[74:75]
    s_mov_b64 exec, -1
    s_or_b64 s[80:81], s[80:81], vcc
    v_cmpx_ne_u64 vcc, v[72:73], v[68:69]
    s_and_b64 s[82:83], vcc, s[80:81]
    s_cbranch_scc1 L2_c124
L2_d124:
    v_mov_b64 v[84:85], v[68:69]
    v_mov_b32 v7, v92
    v_mov_b64 v[86:87], v[72:73]
    s_mov_b64 exec, -1
    s_or_b64 s[80:81], s[80:81], vcc
    ds_read_b64 v[70:71], v95
    ds_read_b64 v[68:69], v94
    s_waitcnt vmcnt(8)
    v_and_b32 v46, 0x20000000, v39
    v_lshrrev_b32 v47, 14, v35
    v_bitop3_b32 v47, v47, v5, v46 bitop3:0xea
    ds_read_b64 v[102:103], v47 offset:63616
    v_bitop3_b32 v93, v35, v5, v46 bitop3:0xea
    v_and_b32 v46, 0x10000000, v39
    v_lshrrev_b32 v47, 14, v34
    v_bitop3_b32 v47, v47, v5, v46 bitop3:0xea
    ds_read_b64 v[100:101], v47 offset:63616
    v_bitop3_b32 v92, v34, v5, v46 bitop3:0xea
    v_and_b32 v46, 0x80000000, v39
    v_lshrrev_b32 v47, 14, v37
    v_bitop3_b32 v47, v47, v5, v46 bitop3:0xea
    ds_read_b64 v[106:107], v47 offset:63616
    v_and_b32 v46, 0x40000000, v39
    v_lshrrev_b32 v47, 14, v36
    v_bitop3_b32 v47, v47, v5, v46 bitop3:0xea
    ds_read_b64 v[104:105], v47 offset:63616
    s_waitcnt lgkmcnt(4)
    v_mfma_f32_4x4x4_16b_bf16 v[80:83], v[10:11], v[70:71], v[80:83]
    v_mfma_f32_4x4x4_16b_bf16 v[76:79], v[10:11], v[68:69], v[76:79]
    v_perm_b32 v15, v35, v38, s45
    v_bitop3_b32 v46, v35, 0.5, -0.5 bitop3:0xa8
    v_perm_b32 v14, v34, v38, s44
    v_bitop3_b32 v47, v34, 0.5, -0.5 bitop3:0xa8
    v_cvt_pk_bf16_f32 v80, v80, v81
    v_cvt_pk_bf16_f32 v81, v82, v83
    ds_wrxchg_rtn_b64 v[74:75], v95, v[80:81]
    v_cvt_pk_bf16_f32 v76, v76, v77
    v_cvt_pk_bf16_f32 v77, v78, v79
    ds_wrxchg_rtn_b64 v[72:73], v94, v[76:77]
    s_waitcnt lgkmcnt(2)
    s_barrier
    s_setprio 3
    ds_write_b128 v3, v[124:127] offset:4096
    ds_write_b128 v3, v[116:119] offset:2048
    ds_write_b128 v3, v[120:123] offset:3072
    v_mfma_f32_4x4x4_16b_bf16 v[80:83], v[8:9], v[102:103], 0
    v_mfma_f32_4x4x4_16b_bf16 v[76:79], v[8:9], v[100:101], 0
    v_bitop3_b32 v15, v6, v15, v46 bitop3:0xca
    v_bitop3_b32 v14, v6, v14, v47 bitop3:0xca
    v_cmp_lt_u32 s[84:85], v5, v92
    s_nop 0
    v_pk_mul_f32 v[80:81], v[80:81], v[14:15] op_sel:[0,1] op_sel_hi:[1,1]
    v_pk_mul_f32 v[82:83], v[82:83], v[14:15] op_sel:[0,1] op_sel_hi:[1,1]
    v_pk_mul_f32 v[76:77], v[76:77], v[14:15] op_sel:[0,0] op_sel_hi:[1,0]
    v_pk_mul_f32 v[78:79], v[78:79], v[14:15] op_sel:[0,0] op_sel_hi:[1,0]
    v_mov_b32 v44, v43
    s_setprio 2
    s_waitcnt vmcnt(7)
    ds_write_b128 v3, v[108:111] offset:0
    s_waitcnt lgkmcnt(4)
    v_cmpx_ne_u64 vcc, v[74:75], v[70:71]
    s_and_b64 s[82:83], vcc, s[80:81]
    s_cbranch_scc1 L2_c125
L2_d125:
    v_mov_b64 v[84:85], v[70:71]
    v_mov_b32 v7, v95
    v_mov_b64 v[86:87], v[74:75]
    s_mov_b64 exec, -1
    s_or_b64 s[80:81], s[80:81], vcc
    v_cmpx_ne_u64 vcc, v[72:73], v[68:69]
    s_and_b64 s[82:83], vcc, s[80:81]
    s_cbranch_scc1 L2_c126
L2_d126:
    v_mov_b64 v[84:85], v[68:69]
    v_mov_b32 v7, v94
    v_mov_b64 v[86:87], v[72:73]
    s_mov_b64 exec, -1
    s_or_b64 s[80:81], s[80:81], vcc
    ds_read_b64 v[70:71], v93
    s_and_b64 exec, s[84:85], s[80:81]
    v_mfma_f32_4x4x4_16b_bf16 v[76:79], v[12:13], v[84:85], 0
    v_mov_b32 v92, v7
    s_andn2_b64 s[80:81], s[80:81], s[84:85]
    v_mfma_f32_4x4x4_16b_bf16 v[76:79], v[10:11], v[86:87], v[76:79]
    s_mov_b64 exec, -1
    ds_read_b64 v[68:69], v92
    s_setprio 1
    s_waitcnt vmcnt(4)
    ds_write_b128 v3, v[112:115] offset:1024
    s_waitcnt lgkmcnt(1)
    v_mfma_f32_4x4x4_16b_bf16 v[80:83], v[10:11], v[70:71], v[80:83]
    v_mfma_f32_4x4x4_16b_bf16 v[76:79], v[10:11], v[68:69], v[76:79]
    v_and_b32 v46, 0x40000000, v39
    v_bitop3_b32 v94, v36, v5, v46 bitop3:0xea
    v_and_b32 v46, 0x80000000, v39
    v_bitop3_b32 v95, v37, v5, v46 bitop3:0xea
    v_perm_b32 v15, v37, v38, s47
    v_bitop3_b32 v46, v37, 0.5, -0.5 bitop3:0xa8
    v_perm_b32 v14, v36, v38, s46
    v_bitop3_b32 v47, v36, 0.5, -0.5 bitop3:0xa8
    v_cvt_pk_bf16_f32 v80, v80, v81
    v_cvt_pk_bf16_f32 v81, v82, v83
    ds_wrxchg_rtn_b64 v[74:75], v93, v[80:81]
    v_cvt_pk_bf16_f32 v76, v76, v77
    v_cvt_pk_bf16_f32 v77, v78, v79
    ds_wrxchg_rtn_b64 v[72:73], v92, v[76:77]
    s_setprio 0
    v_mfma_f32_4x4x4_16b_bf16 v[80:83], v[8:9], v[106:107], 0
    v_mfma_f32_4x4x4_16b_bf16 v[76:79], v[8:9], v[104:105], 0
    v_bitop3_b32 v15, v6, v15, v46 bitop3:0xca
    v_bitop3_b32 v14, v6, v14, v47 bitop3:0xca
    s_nop 1
    v_pk_mul_f32 v[80:81], v[80:81], v[14:15] op_sel:[0,1] op_sel_hi:[1,1]
    v_pk_mul_f32 v[82:83], v[82:83], v[14:15] op_sel:[0,1] op_sel_hi:[1,1]
    v_pk_mul_f32 v[76:77], v[76:77], v[14:15] op_sel:[0,0] op_sel_hi:[1,0]
    v_pk_mul_f32 v[78:79], v[78:79], v[14:15] op_sel:[0,0] op_sel_hi:[1,0]
    s_add_u32 s42, s42, 1
    s_waitcnt lgkmcnt(2)
    s_barrier
    s_bitcmp1_b32 s36, s42
    s_cbranch_scc1 L2_slow
L2_ret7:
    s_setprio 3
    v_and_b32 v47, 0x0fffffff, v44
    v_mov_b32 v39, v44
    buffer_load_dwordx4 v[34:37], v47, s[8:11], 0 offen
    buffer_load_dwordx3 v[36:38], v47, s[8:11], 0 offen offset:8
    s_waitcnt lgkmcnt(0)
    v_cmpx_ne_u64 vcc, v[74:75], v[70:71]
    s_and_b64 s[82:83], vcc, s[80:81]
    s_cbranch_scc1 L2_c127
L2_d127:
    v_mov_b64 v[84:85], v[70:71]
    v_mov_b32 v7, v93
    v_mov_b64 v[86:87], v[74:75]
    s_mov_b64 exec, -1
    s_or_b64 s[80:81], s[80:81], vcc
    v_cmpx_ne_u64 vcc, v[72:73], v[68:69]
    s_and_b64 s[82:83], vcc, s[80:81]
    s_cbranch_scc1 L2_c128
L2_d128:
    v_mov_b64 v[84:85], v[68:69]
    v_mov_b32 v7, v92
    v_mov_b64 v[86:87], v[72:73]
    s_mov_b64 exec, -1
    s_or_b64 s[80:81], s[80:81], vcc
    ds_read_b64 v[70:71], v95
    ds_read_b64 v[68:69], v94
    v_and_b32 v46, 0x20000000, v21
    v_lshrrev_b32 v47, 14, v17
    v_bitop3_b32 v47, v47, v5, v46 bitop3:0xea
    ds_read_b64 v[102:103], v47 offset:63616
    v_bitop3_b32 v93, v17, v5, v46 bitop3:0xea
    v_and_b32 v46, 0x10000000, v21
    v_lshrrev_b32 v47, 14, v16
    v_bitop3_b32 v47, v47, v5, v46 bitop3:0xea
    ds_read_b64 v[100:101], v47 offset:63616
    v_bitop3_b32 v92, v16, v5, v46 bitop3:0xea
    s_waitcnt lgkmcnt(2)
    v_mfma_f32_4x4x4_16b_bf16 v[80:83], v[10:11], v[70:71], v[80:83]
    v_mfma_f32_4x4x4_16b_bf16 v[76:79], v[10:11], v[68:69], v[76:79]
    v_perm_b32 v15, v17, v20, s45
    v_bitop3_b32 v46, v17, 0.5, -0.5 bitop3:0xa8
    v_perm_b32 v14, v16, v20, s44
    v_bitop3_b32 v47, v16, 0.5, -0.5 bitop3:0xa8
    v_cvt_pk_bf16_f32 v80, v80, v81
    v_cvt_pk_bf16_f32 v81, v82, v83
    ds_wrxchg_rtn_b64 v[74:75], v95, v[80:81]
    v_cvt_pk_bf16_f32 v76, v76, v77
    v_cvt_pk_bf16_f32 v77, v78, v79
    ds_wrxchg_rtn_b64 v[72:73], v94, v[76:77]
    s_waitcnt lgkmcnt(2)
    v_mfma_f32_4x4x4_16b_bf16 v[80:83], v[8:9], v[102:103], 0
    v_mfma_f32_4x4x4_16b_bf16 v[76:79], v[8:9], v[100:101], 0
    v_bitop3_b32 v15, v6, v15, v46 bitop3:0xca
    v_bitop3_b32 v14, v6, v14, v47 bitop3:0xca
    v_cmp_lt_u32 s[84:85], v5, v92
    s_nop 0
    v_pk_mul_f32 v[80:81], v[80:81], v[14:15] op_sel:[0,1] op_sel_hi:[1,1]
    v_pk_mul_f32 v[82:83], v[82:83], v[14:15] op_sel:[0,1] op_sel_hi:[1,1]
    v_pk_mul_f32 v[76:77], v[76:77], v[14:15] op_sel:[0,0] op_sel_hi:[1,0]
    v_pk_mul_f32 v[78:79], v[78:79], v[14:15] op_sel:[0,0] op_sel_hi:[1,0]
    s_waitcnt lgkmcnt(0)
    v_cmpx_ne_u64 vcc, v[74:75], v[70:71]
    s_and_b64 s[82:83], vcc, s[80:81]
    s_cbranch_scc1 L2_c129
L2_d129:
    v_mov_b64 v[84:85], v[70:71]
    v_mov_b32 v7, v95
    v_mov_b64 v[86:87], v[74:75]
    s_mov_b64 exec, -1
    s_or_b64 s[80:81], s[80:81], vcc
    v_cmpx_ne_u64 vcc, v[72:73], v[68:69]
    s_and_b64 s[82:83], vcc, s[80:81]
    s_cbranch_scc1 L2_c130
L2_d130:
    v_mov_b64 v[84:85], v[68:69]
    v_mov_b32 v7, v94
    v_mov_b64 v[86:87], v[72:73]
    s_mov_b64 exec, -1
    s_or_b64 s[80:81], s[80:81], vcc
    ds_read_b64 v[70:71], v93
    s_and_b64 exec, s[84:85], s[80:81]
    v_mfma_f32_4x4x4_16b_bf16 v[76:79], v[12:13], v[84:85], 0
    v_mov_b32 v92, v7
    s_andn2_b64 s[80:81], s[80:81], s[84:85]
    v_mfma_f32_4x4x4_16b_bf16 v[76:79], v[10:11], v[86:87], v[76:79]
    s_mov_b64 exec, -1
    ds_read_b64 v[68:69], v92
    v_and_b32 v46, 0x80000000, v21
    v_lshrrev_b32 v47, 14, v19
    v_bitop3_b32 v47, v47, v5, v46 bitop3:0xea
    ds_read_b64 v[106:107], v47 offset:63616
    v_bitop3_b32 v95, v19, v5, v46 bitop3:0xea
    v_and_b32 v46, 0x40000000, v21
    v_lshrrev_b32 v47, 14, v18
    v_bitop3_b32 v47, v47, v5, v46 bitop3:0xea
    ds_read_b64 v[104:105], v47 offset:63616
    v_bitop3_b32 v94, v18, v5, v46 bitop3:0xea
    s_waitcnt lgkmcnt(2)
    v_mfma_f32_4x4x4_16b_bf16 v[80:83], v[10:11], v[70:71], v[80:83]
    v_mfma_f32_4x4x4_16b_bf16 v[76:79], v[10:11], v[68:69], v[76:79]
    v_perm_b32 v15, v19, v20, s47
    v_bitop3_b32 v46, v19, 0.5, -0.5 bitop3:0xa8
    v_perm_b32 v14, v18, v20, s46
    v_bitop3_b32 v47, v18, 0.5, -0.5 bitop3:0xa8
    v_cvt_pk_bf16_f32 v80, v80, v81
    v_cvt_pk_bf16_f32 v81, v82, v83
    ds_wrxchg_rtn_b64 v[74:75], v93, v[80:81]
    v_cvt_pk_bf16_f32 v76, v76, v77
    v_cvt_pk_bf16_f32 v77, v78, v79
    ds_wrxchg_rtn_b64 v[72:73], v92, v[76:77]
    s_setprio 2
    s_waitcnt lgkmcnt(2)
    v_mfma_f32_4x4x4_16b_bf16 v[80:83], v[8:9], v[106:107], 0
    v_mfma_f32_4x4x4_16b_bf16 v[76:79], v[8:9], v[104:105], 0
    v_bitop3_b32 v15, v6, v15, v46 bitop3:0xca
    v_bitop3_b32 v14, v6, v14, v47 bitop3:0xca
    s_nop 1
    v_pk_mul_f32 v[80:81], v[80:81], v[14:15] op_sel:[0,1] op_sel_hi:[1,1]
    v_pk_mul_f32 v[82:83], v[82:83], v[14:15] op_sel:[0,1] op_sel_hi:[1,1]
    v_pk_mul_f32 v[76:77], v[76:77], v[14:15] op_sel:[0,0] op_sel_hi:[1,0]
    v_pk_mul_f32 v[78:79], v[78:79], v[14:15] op_sel:[0,0] op_sel_hi:[1,0]
    s_lshl_b32 s3, s32, 12
    s_add_u32 s3, s3, 80000
    v_subrev_u32 v122, s3, v3
    s_mul_i32 s3, s33, 20000
    v_add_u32 v118, s3, v122
    v_add_u32 v119, 0x4000, v118
    s_lshl_b32 s3, s34, 7
    v_lshrrev_b32 v123, 7, v118
    v_and_b32 v120, 0x70, v118
    v_lshl_add_u32 v120, v123, 13, v120
    v_add_u32 v120, s3, v120
    v_lshrrev_b32 v123, 7, v119
    v_and_b32 v121, 0x70, v119
    v_lshl_add_u32 v121, v123, 13, v121
    v_add_u32 v121, s3, v121
    v_cmp_le_u32 vcc, 3616, v122
    s_mov_b64 exec, vcc
    v_mov_b32 v119, 2.0
    v_mov_b32 v121, 2.0
    s_mov_b64 exec, -1
    v_and_b32 v123, 0x30, v122
    v_lshlrev_b32 v123, 2, v123
    buffer_load_dwordx4 v[48:51], v123, s[24:27], 0 offen
    buffer_load_dwordx4 v[52:55], v123, s[24:27], 0 offen offset:16
    buffer_load_dwordx2 v[56:57], v123, s[24:27], 0 offen offset:32
    s_mov_b32 s12, s4
    s_mov_b32 s13, s5
    s_mov_b32 s14, 0x138800
    s_mov_b32 s15, 0x20000
    s_mov_b32 s3, 80000
    v_lshrrev_b32 v123, 2, v120
    buffer_load_dword v116, v123, s[12:15], 0 offen
    buffer_load_dwordx4 v[108:111], v120, s[16:19], s3 offen
    v_lshrrev_b32 v123, 2, v121
    buffer_load_dword v117, v123, s[12:15], 0 offen
    buffer_load_dwordx4 v[112:115], v121, s[16:19], s3 offen
    s_waitcnt lgkmcnt(0)
    v_cmpx_ne_u64 vcc, v[74:75], v[70:71]
    s_and_b64 s[82:83], vcc, s[80:81]
    s_cbranch_scc1 L2_c131
L2_d131:
    v_mov_b64 v[84:85], v[70:71]
    v_mov_b32 v7, v93
    v_mov_b64 v[86:87], v[74:75]
    s_mov_b64 exec, -1
    s_or_b64 s[80:81], s[80:81], vcc
    v_cmpx_ne_u64 vcc, v[72:73], v[68:69]
    s_and_b64 s[82:83], vcc, s[80:81]
    s_cbranch_scc1 L2_c132
L2_d132:
    v_mov_b64 v[84:85], v[68:69]
    v_mov_b32 v7, v92
    v_mov_b64 v[86:87], v[72:73]
    s_mov_b64 exec, -1
    s_or_b64 s[80:81], s[80:81], vcc
    ds_read_b64 v[70:71], v95
    ds_read_b64 v[68:69], v94
    s_waitcnt vmcnt(11)
    v_and_b32 v46, 0x20000000, v27
    v_lshrrev_b32 v47, 14, v23
    v_bitop3_b32 v47, v47, v5, v46 bitop3:0xea
    ds_read_b64 v[102:103], v47 offset:63616
    v_bitop3_b32 v93, v23, v5, v46 bitop3:0xea
    v_and_b32 v46, 0x10000000, v27
    v_lshrrev_b32 v47, 14, v22
    v_bitop3_b32 v47, v47, v5, v46 bitop3:0xea
    ds_read_b64 v[100:101], v47 offset:63616
    v_bitop3_b32 v92, v22, v5, v46 bitop3:0xea
    s_waitcnt lgkmcnt(2)
    v_mfma_f32_4x4x4_16b_bf16 v[80:83], v[10:11], v[70:71], v[80:83]
    v_mfma_f32_4x4x4_16b_bf16 v[76:79], v[10:11], v[68:69], v[76:79]
    v_perm_b32 v15, v23, v26, s45
    v_bitop3_b32 v46, v23, 0.5, -0.5 bitop3:0xa8
    v_perm_b32 v14, v22, v26, s44
    v_bitop3_b32 v47, v22, 0.5, -0.5 bitop3:0xa8
    v_cvt_pk_bf16_f32 v80, v80, v81
    v_cvt_pk_bf16_f32 v81, v82, v83
    ds_wrxchg_rtn_b64 v[74:75], v95, v[80:81]
    v_cvt_pk_bf16_f32 v76, v76, v77
    v_cvt_pk_bf16_f32 v77, v78, v79
    ds_wrxchg_rtn_b64 v[72:73], v94, v[76:77]
    s_waitcnt lgkmcnt(2)
    v_mfma_f32_4x4x4_16b_bf16 v[80:83], v[8:9], v[102:103], 0
    v_mfma_f32_4x4x4_16b_bf16 v[76:79], v[8:9], v[100:101], 0
    v_bitop3_b32 v15, v6, v15, v46 bitop3:0xca
    v_bitop3_b32 v14, v6, v14, v47 bitop3:0xca
    v_cmp_lt_u32 s[84:85], v5, v92
    s_nop 0
    v_pk_mul_f32 v[80:81], v[80:81], v[14:15] op_sel:[0,1] op_sel_hi:[1,1]
    v_pk_mul_f32 v[82:83], v[82:83], v[14:15] op_sel:[0,1] op_sel_hi:[1,1]
    v_pk_mul_f32 v[76:77], v[76:77], v[14:15] op_sel:[0,0] op_sel_hi:[1,0]
    v_pk_mul_f32 v[78:79], v[78:79], v[14:15] op_sel:[0,0] op_sel_hi:[1,0]
    s_waitcnt lgkmcnt(0)
    v_cmpx_ne_u64 vcc, v[74:75], v[70:71]
    s_and_b64 s[82:83], vcc, s[80:81]
    s_cbranch_scc1 L2_c133
L2_d133:
    v_mov_b64 v[84:85], v[70:71]
    v_mov_b32 v7, v95
    v_mov_b64 v[86:87], v[74:75]
    s_mov_b64 exec, -1
    s_or_b64 s[80:81], s[80:81], vcc
    v_cmpx_ne_u64 vcc, v[72:73], v[68:69]
    s_and_b64 s[82:83], vcc, s[80:81]
    s_cbranch_scc1 L2_c134
L2_d134:
    v_mov_b64 v[84:85], v[68:69]
    v_mov_b32 v7, v94
    v_mov_b64 v[86:87], v[72:73]
    s_mov_b64 exec, -1
    s_or_b64 s[80:81], s[80:81], vcc
    ds_read_b64 v[70:71], v93
    s_and_b64 exec, s[84:85], s[80:81]
    v_mfma_f32_4x4x4_16b_bf16 v[76:79], v[12:13], v[84:85], 0
    v_mov_b32 v92, v7
    s_andn2_b64 s[80:81], s[80:81], s[84:85]
    v_mfma_f32_4x4x4_16b_bf16 v[76:79], v[10:11], v[86:87], v[76:79]
    s_mov_b64 exec, -1
    ds_read_b64 v[68:69], v92
    v_and_b32 v46, 0x80000000, v27
    v_lshrrev_b32 v47, 14, v25
    v_bitop3_b32 v47, v47, v5, v46 bitop3:0xea
    ds_read_b64 v[106:107], v47 offset:63616
    v_bitop3_b32 v95, v25, v5, v46 bitop3:0xea
    v_and_b32 v46, 0x40000000, v27
    v_lshrrev_b32 v47, 14, v24
    v_bitop3_b32 v47, v47, v5, v46 bitop3:0xea
    ds_read_b64 v[104:105], v47 offset:63616
    v_bitop3_b32 v94, v24, v5, v46 bitop3:0xea
    s_waitcnt lgkmcnt(2)
    v_mfma_f32_4x4x4_16b_bf16 v[80:83], v[10:11], v[70:71], v[80:83]
    v_mfma_f32_4x4x4_16b_bf16 v[76:79], v[10:11], v[68:69], v[76:79]
    v_perm_b32 v15, v25, v26, s47
    v_bitop3_b32 v46, v25, 0.5, -0.5 bitop3:0xa8
    v_perm_b32 v14, v24, v26, s46
    v_bitop3_b32 v47, v24, 0.5, -0.5 bitop3:0xa8
    v_cvt_pk_bf16_f32 v80, v80, v81
    v_cvt_pk_bf16_f32 v81, v82, v83
    ds_wrxchg_rtn_b64 v[74:75], v93, v[80:81]
    v_cvt_pk_bf16_f32 v76, v76, v77
    v_cvt_pk_bf16_f32 v77, v78, v79
    ds_wrxchg_rtn_b64 v[72:73], v92, v[76:77]
    s_setprio 1
    s_waitcnt lgkmcnt(2)
    v_mfma_f32_4x4x4_16b_bf16 v[80:83], v[8:9], v[106:107], 0
    v_mfma_f32_4x4x4_16b_bf16 v[76:79], v[8:9], v[104:105], 0
    v_bitop3_b32 v15, v6, v15, v46 bitop3:0xca
    v_bitop3_b32 v14, v6, v14, v47 bitop3:0xca
    s_nop 1
    v_pk_mul_f32 v[80:81], v[80:81], v[14:15] op_sel:[0,1] op_sel_hi:[1,1]
    v_pk_mul_f32 v[82:83], v[82:83], v[14:15] op_sel:[0,1] op_sel_hi:[1,1]
    v_pk_mul_f32 v[76:77], v[76:77], v[14:15] op_sel:[0,0] op_sel_hi:[1,0]
    v_pk_mul_f32 v[78:79], v[78:79], v[14:15] op_sel:[0,0] op_sel_hi:[1,0]
    s_waitcnt lgkmcnt(0)
    v_cmpx_ne_u64 vcc, v[74:75], v[70:71]
    s_and_b64 s[82:83], vcc, s[80:81]
    s_cbranch_scc1 L2_c135
L2_d135:
    v_mov_b64 v[84:85], v[70:71]
    v_mov_b32 v7, v93
    v_mov_b64 v[86:87], v[74:75]
    s_mov_b64 exec, -1
    s_or_b64 s[80:81], s[80:81], vcc
    v_cmpx_ne_u64 vcc, v[72:73], v[68:69]
    s_and_b64 s[82:83], vcc, s[80:81]
    s_cbranch_scc1 L2_c136
L2_d136:
    v_mov_b64 v[84:85], v[68:69]
    v_mov_b32 v7, v92
    v_mov_b64 v[86:87], v[72:73]
    s_mov_b64 exec, -1
    s_or_b64 s[80:81], s[80:81], vcc
    ds_read_b64 v[70:71], v95
    ds_read_b64 v[68:69], v94
    s_waitcnt vmcnt(9)
    v_and_b32 v46, 0x20000000, v33
    v_lshrrev_b32 v47, 14, v29
    v_bitop3_b32 v47, v47, v5, v46 bitop3:0xea
    ds_read_b64 v[102:103], v47 offset:63616
    v_bitop3_b32 v93, v29, v5, v46 bitop3:0xea
    v_and_b32 v46, 0x10000000, v33
    v_lshrrev_b32 v47, 14, v28
    v_bitop3_b32 v47, v47, v5, v46 bitop3:0xea
    ds_read_b64 v[100:101], v47 offset:63616
    v_bitop3_b32 v92, v28, v5, v46 bitop3:0xea
    s_waitcnt lgkmcnt(2)
    v_mfma_f32_4x4x4_16b_bf16 v[80:83], v[10:11], v[70:71], v[80:83]
    v_mfma_f32_4x4x4_16b_bf16 v[76:79], v[10:11], v[68:69], v[76:79]
    v_perm_b32 v15, v29, v32, s45
    v_bitop3_b32 v46, v29, 0.5, -0.5 bitop3:0xa8
    v_perm_b32 v14, v28, v32, s44
    v_bitop3_b32 v47, v28, 0.5, -0.5 bitop3:0xa8
    v_cvt_pk_bf16_f32 v80, v80, v81
    v_cvt_pk_bf16_f32 v81, v82, v83
    ds_wrxchg_rtn_b64 v[74:75], v95, v[80:81]
    v_cvt_pk_bf16_f32 v76, v76, v77
    v_cvt_pk_bf16_f32 v77, v78, v79
    ds_wrxchg_rtn_b64 v[72:73], v94, v[76:77]
    s_waitcnt lgkmcnt(2)
    v_mfma_f32_4x4x4_16b_bf16 v[80:83], v[8:9], v[102:103], 0
    v_mfma_f32_4x4x4_16b_bf16 v[76:79], v[8:9], v[100:101], 0
    v_bitop3_b32 v15, v6, v15, v46 bitop3:0xca
    v_bitop3_b32 v14, v6, v14, v47 bitop3:0xca
    v_cmp_lt_u32 s[84:85], v5, v92
    s_nop 0
    v_pk_mul_f32 v[80:81], v[80:81], v[14:15] op_sel:[0,1] op_sel_hi:[1,1]
    v_pk_mul_f32 v[82:83], v[82:83], v[14:15] op_sel:[0,1] op_sel_hi:[1,1]
    v_pk_mul_f32 v[76:77], v[76:77], v[14:15] op_sel:[0,0] op_sel_hi:[1,0]
    v_pk_mul_f32 v[78:79], v[78:79], v[14:15] op_sel:[0,0] op_sel_hi:[1,0]
    s_waitcnt lgkmcnt(0)
    v_cmpx_ne_u64 vcc, v[74:75], v[70:71]
    s_and_b64 s[82:83], vcc, s[80:81]
    s_cbranch_scc1 L2_c137
L2_d137:
    v_mov_b64 v[84:85], v[70:71]
    v_mov_b32 v7, v95
    v_mov_b64 v[86:87], v[74:75]
    s_mov_b64 exec, -1
    s_or_b64 s[80:81], s[80:81], vcc
    v_cmpx_ne_u64 vcc, v[72:73], v[68:69]
    s_and_b64 s[82:83], vcc, s[80:81]
    s_cbranch_scc1 L2_c138
L2_d138:
    v_mov_b64 v[84:85], v[68:69]
    v_mov_b32 v7, v94
    v_mov_b64 v[86:87], v[72:73]
    s_mov_b64 exec, -1
    s_or_b64 s[80:81], s[80:81], vcc
    ds_read_b64 v[70:71], v93
    s_and_b64 exec, s[84:85], s[80:81]
    v_mfma_f32_4x4x4_16b_bf16 v[76:79], v[12:13], v[84:85], 0
    v_mov_b32 v92, v7
    s_andn2_b64 s[80:81], s[80:81], s[84:85]
    v_mfma_f32_4x4x4_16b_bf16 v[76:79], v[10:11], v[86:87], v[76:79]
    s_mov_b64 exec, -1
    ds_read_b64 v[68:69], v92
    v_and_b32 v46, 0x80000000, v33
    v_lshrrev_b32 v47, 14, v31
    v_bitop3_b32 v47, v47, v5, v46 bitop3:0xea
    ds_read_b64 v[106:107], v47 offset:63616
    v_bitop3_b32 v95, v31, v5, v46 bitop3:0xea
    v_and_b32 v46, 0x40000000, v33
    v_lshrrev_b32 v47, 14, v30
    v_bitop3_b32 v47, v47, v5, v46 bitop3:0xea
    ds_read_b64 v[104:105], v47 offset:63616
    v_bitop3_b32 v94, v30, v5, v46 bitop3:0xea
    s_waitcnt lgkmcnt(2)
    v_mfma_f32_4x4x4_16b_bf16 v[80:83], v[10:11], v[70:71], v[80:83]
    v_mfma_f32_4x4x4_16b_bf16 v[76:79], v[10:11], v[68:69], v[76:79]
    v_perm_b32 v15, v31, v32, s47
    v_bitop3_b32 v46, v31, 0.5, -0.5 bitop3:0xa8
    v_perm_b32 v14, v30, v32, s46
    v_bitop3_b32 v47, v30, 0.5, -0.5 bitop3:0xa8
    v_cvt_pk_bf16_f32 v80, v80, v81
    v_cvt_pk_bf16_f32 v81, v82, v83
    ds_wrxchg_rtn_b64 v[74:75], v93, v[80:81]
    v_cvt_pk_bf16_f32 v76, v76, v77
    v_cvt_pk_bf16_f32 v77, v78, v79
    ds_wrxchg_rtn_b64 v[72:73], v92, v[76:77]
    s_setprio 0
    s_waitcnt lgkmcnt(2)
    v_mfma_f32_4x4x4_16b_bf16 v[80:83], v[8:9], v[106:107], 0
    v_mfma_f32_4x4x4_16b_bf16 v[76:79], v[8:9], v[104:105], 0
    v_bitop3_b32 v15, v6, v15, v46 bitop3:0xca
    v_bitop3_b32 v14, v6, v14, v47 bitop3:0xca
    s_nop 1
    v_pk_mul_f32 v[80:81], v[80:81], v[14:15] op_sel:[0,1] op_sel_hi:[1,1]
    v_pk_mul_f32 v[82:83], v[82:83], v[14:15] op_sel:[0,1] op_sel_hi:[1,1]
    v_pk_mul_f32 v[76:77], v[76:77], v[14:15] op_sel:[0,0] op_sel_hi:[1,0]
    v_pk_mul_f32 v[78:79], v[78:79], v[14:15] op_sel:[0,0] op_sel_hi:[1,0]
    s_waitcnt lgkmcnt(0)
    v_cmpx_ne_u64 vcc, v[74:75], v[70:71]
    s_and_b64 s[82:83], vcc, s[80:81]
    s_cbranch_scc1 L2_c139
L2_d139:
    v_mov_b64 v[84:85], v[70:71]
    v_mov_b32 v7, v93
    v_mov_b64 v[86:87], v[74:75]
    s_mov_b64 exec, -1
    s_or_b64 s[80:81], s[80:81], vcc
    v_cmpx_ne_u64 vcc, v[72:73], v[68:69]
    s_and_b64 s[82:83], vcc, s[80:81]
    s_cbranch_scc1 L2_c140
L2_d140:
    v_mov_b64 v[84:85], v[68:69]
    v_mov_b32 v7, v92
    v_mov_b64 v[86:87], v[72:73]
    s_mov_b64 exec, -1
    s_or_b64 s[80:81], s[80:81], vcc
    ds_read_b64 v[70:71], v95
    ds_read_b64 v[68:69], v94
    s_waitcnt vmcnt(7)
    v_and_b32 v46, 0x20000000, v39
    v_lshrrev_b32 v47, 14, v35
    v_bitop3_b32 v47, v47, v5, v46 bitop3:0xea
    ds_read_b64 v[102:103], v47 offset:63616
    v_bitop3_b32 v93, v35, v5, v46 bitop3:0xea
    v_and_b32 v46, 0x10000000, v39
    v_lshrrev_b32 v47, 14, v34
    v_bitop3_b32 v47, v47, v5, v46 bitop3:0xea
    ds_read_b64 v[100:101], v47 offset:63616
    v_bitop3_b32 v92, v34, v5, v46 bitop3:0xea
    v_and_b32 v46, 0x80000000, v39
    v_lshrrev_b32 v47, 14, v37
    v_bitop3_b32 v47, v47, v5, v46 bitop3:0xea
    ds_read_b64 v[106:107], v47 offset:63616
    v_and_b32 v46, 0x40000000, v39
    v_lshrrev_b32 v47, 14, v36
    v_bitop3_b32 v47, v47, v5, v46 bitop3:0xea
    ds_read_b64 v[104:105], v47 offset:63616
    s_waitcnt lgkmcnt(4)
    v_mfma_f32_4x4x4_16b_bf16 v[80:83], v[10:11], v[70:71], v[80:83]
    v_mfma_f32_4x4x4_16b_bf16 v[76:79], v[10:11], v[68:69], v[76:79]
    v_perm_b32 v15, v35, v38, s45
    v_bitop3_b32 v46, v35, 0.5, -0.5 bitop3:0xa8
    v_perm_b32 v14, v34, v38, s44
    v_bitop3_b32 v47, v34, 0.5, -0.5 bitop3:0xa8
    v_cvt_pk_bf16_f32 v80, v80, v81
    v_cvt_pk_bf16_f32 v81, v82, v83
    ds_wrxchg_rtn_b64 v[74:75], v95, v[80:81]
    v_cvt_pk_bf16_f32 v76, v76, v77
    v_cvt_pk_bf16_f32 v77, v78, v79
    ds_wrxchg_rtn_b64 v[72:73], v94, v[76:77]
    s_waitcnt lgkmcnt(4)
    v_mfma_f32_4x4x4_16b_bf16 v[80:83], v[8:9], v[102:103], 0
    v_mfma_f32_4x4x4_16b_bf16 v[76:79], v[8:9], v[100:101], 0
    v_bitop3_b32 v15, v6, v15, v46 bitop3:0xca
    v_bitop3_b32 v14, v6, v14, v47 bitop3:0xca
    v_cmp_lt_u32 s[84:85], v5, v92
    s_nop 0
    v_pk_mul_f32 v[80:81], v[80:81], v[14:15] op_sel:[0,1] op_sel_hi:[1,1]
    v_pk_mul_f32 v[82:83], v[82:83], v[14:15] op_sel:[0,1] op_sel_hi:[1,1]
    v_pk_mul_f32 v[76:77], v[76:77], v[14:15] op_sel:[0,0] op_sel_hi:[1,0]
    v_pk_mul_f32 v[78:79], v[78:79], v[14:15] op_sel:[0,0] op_sel_hi:[1,0]
    s_waitcnt lgkmcnt(0)
    v_cmpx_ne_u64 vcc, v[74:75], v[70:71]
    s_and_b64 s[82:83], vcc, s[80:81]
    s_cbranch_scc1 L2_c141
L2_d141:
    v_mov_b64 v[84:85], v[70:71]
    v_mov_b32 v7, v95
    v_mov_b64 v[86:87], v[74:75]
    s_mov_b64 exec, -1
    s_or_b64 s[80:81], s[80:81], vcc
    v_cmpx_ne_u64 vcc, v[72:73], v[68:69]
    s_and_b64 s[82:83], vcc, s[80:81]
    s_cbranch_scc1 L2_c142
L2_d142:
    v_mov_b64 v[84:85], v[68:69]
    v_mov_b32 v7, v94
    v_mov_b64 v[86:87], v[72:73]
    s_mov_b64 exec, -1
    s_or_b64 s[80:81], s[80:81], vcc
    ds_read_b64 v[70:71], v93
    s_and_b64 exec, s[84:85], s[80:81]
    v_mfma_f32_4x4x4_16b_bf16 v[76:79], v[12:13], v[84:85], 0
    v_mov_b32 v92, v7
    s_andn2_b64 s[80:81], s[80:81], s[84:85]
    v_mfma_f32_4x4x4_16b_bf16 v[76:79], v[10:11], v[86:87], v[76:79]
    s_mov_b64 exec, -1
    ds_read_b64 v[68:69], v92
    s_waitcnt lgkmcnt(0)
    v_mfma_f32_4x4x4_16b_bf16 v[80:83], v[10:11], v[70:71], v[80:83]
    v_mfma_f32_4x4x4_16b_bf16 v[76:79], v[10:11], v[68:69], v[76:79]
    v_and_b32 v46, 0x40000000, v39
    v_bitop3_b32 v94, v36, v5, v46 bitop3:0xea
    v_and_b32 v46, 0x80000000, v39
    v_bitop3_b32 v95, v37, v5, v46 bitop3:0xea
    v_perm_b32 v15, v37, v38, s47
    v_bitop3_b32 v46, v37, 0.5, -0.5 bitop3:0xa8
    v_perm_b32 v14, v36, v38, s46
    v_bitop3_b32 v47, v36, 0.5, -0.5 bitop3:0xa8
    v_cvt_pk_bf16_f32 v80, v80, v81
    v_cvt_pk_bf16_f32 v81, v82, v83
    ds_wrxchg_rtn_b64 v[74:75], v93, v[80:81]
    v_cvt_pk_bf16_f32 v76, v76, v77
    v_cvt_pk_bf16_f32 v77, v78, v79
    ds_wrxchg_rtn_b64 v[72:73], v92, v[76:77]
    v_mfma_f32_4x4x4_16b_bf16 v[80:83], v[8:9], v[106:107], 0
    v_mfma_f32_4x4x4_16b_bf16 v[76:79], v[8:9], v[104:105], 0
    v_bitop3_b32 v15, v6, v15, v46 bitop3:0xca
    v_bitop3_b32 v14, v6, v14, v47 bitop3:0xca
    s_nop 1
    v_pk_mul_f32 v[80:81], v[80:81], v[14:15] op_sel:[0,1] op_sel_hi:[1,1]
    v_pk_mul_f32 v[82:83], v[82:83], v[14:15] op_sel:[0,1] op_sel_hi:[1,1]
    v_pk_mul_f32 v[76:77], v[76:77], v[14:15] op_sel:[0,0] op_sel_hi:[1,0]
    v_pk_mul_f32 v[78:79], v[78:79], v[14:15] op_sel:[0,0] op_sel_hi:[1,0]
    s_waitcnt lgkmcnt(0)
    v_cmpx_ne_u64 vcc, v[74:75], v[70:71]
    s_and_b64 s[82:83], vcc, s[80:81]
    s_cbranch_scc1 L2_c143
L2_d143:
    v_mov_b64 v[84:85], v[70:71]
    v_mov_b32 v7, v93
    v_mov_b64 v[86:87], v[74:75]
    s_mov_b64 exec, -1
    s_or_b64 s[80:81], s[80:81], vcc
    v_cmpx_ne_u64 vcc, v[72:73], v[68:69]
    s_and_b64 s[82:83], vcc, s[80:81]
    s_cbranch_scc1 L2_c144
L2_d144:
    v_mov_b64 v[84:85], v[68:69]
    v_mov_b32 v7, v92
    v_mov_b64 v[86:87], v[72:73]
    s_mov_b64 exec, -1
    s_or_b64 s[80:81], s[80:81], vcc
    ds_read_b64 v[70:71], v95
    ds_read_b64 v[68:69], v94
    s_waitcnt lgkmcnt(0)
    v_mfma_f32_4x4x4_16b_bf16 v[80:83], v[10:11], v[70:71], v[80:83]
    v_mfma_f32_4x4x4_16b_bf16 v[76:79], v[10:11], v[68:69], v[76:79]
    s_nop 3
    v_cvt_pk_bf16_f32 v80, v80, v81
    v_cvt_pk_bf16_f32 v81, v82, v83
    ds_wrxchg_rtn_b64 v[74:75], v95, v[80:81]
    v_cvt_pk_bf16_f32 v76, v76, v77
    v_cvt_pk_bf16_f32 v77, v78, v79
    ds_wrxchg_rtn_b64 v[72:73], v94, v[76:77]
    s_waitcnt lgkmcnt(0)
    v_cmpx_ne_u64 vcc, v[74:75], v[70:71]
    s_and_b64 s[82:83], vcc, s[80:81]
    s_cbranch_scc1 L2_c145
L2_d145:
    v_mov_b64 v[84:85], v[70:71]
    v_mov_b32 v7, v95
    v_mov_b64 v[86:87], v[74:75]
    s_mov_b64 exec, -1
    s_or_b64 s[80:81], s[80:81], vcc
    v_cmpx_ne_u64 vcc, v[72:73], v[68:69]
    s_and_b64 s[82:83], vcc, s[80:81]
    s_cbranch_scc1 L2_c146
L2_d146:
    v_mov_b64 v[84:85], v[68:69]
    v_mov_b32 v7, v94
    v_mov_b64 v[86:87], v[72:73]
    s_mov_b64 exec, -1
    s_or_b64 s[80:81], s[80:81], vcc
    s_mov_b64 exec, s[80:81]
    s_nop 1
    v_mfma_f32_4x4x4_16b_bf16 v[88:91], v[12:13], v[84:85], 0
    s_nop 1
    v_mfma_f32_4x4x4_16b_bf16 v[88:91], v[10:11], v[86:87], v[88:91]
    s_nop 4
    v_cvt_pk_bf16_f32 v88, v88, v89
    v_cvt_pk_bf16_f32 v89, v90, v91
    ds_pk_add_bf16 v7, v88
    ds_pk_add_bf16 v7, v89 offset:4
    s_mov_b64 exec, -1
    s_load_dwordx2 s[4:5], s[0:1], 88
    v_add_u32 v123, 16384, v122
    v_add_u32 v124, 32768, v122
    v_add_u32 v125, 49152, v122
    v_add_u32 v126, 65536, v122
    s_lshl_b32 s50, s96, 16
    s_and_b32 s51, s96, 0xffff0000
    s_lshl_b32 s52, s97, 16
    s_and_b32 s53, s97, 0xffff0000
    s_lshl_b32 s54, s98, 16
    s_and_b32 s55, s98, 0xffff0000
    s_lshl_b32 s56, s99, 16
    s_and_b32 s57, s99, 0xffff0000
    s_waitcnt vmcnt(0) lgkmcnt(0)
    s_barrier
    ds_read_b128 v[16:19], v122
    ds_read_b128 v[20:23], v123
    ds_read_b128 v[24:27], v124
    ds_read_b128 v[28:31], v125
    ds_read_b128 v[32:35], v126
    s_add_u32 s8, s30, 0xebac000
    s_addc_u32 s9, s31, 0
    s_mov_b32 s10, 0x8000
    s_mov_b32 s11, 0x20000
    s_mov_b32 s12, s4
    s_mov_b32 s13, s5
    s_mov_b32 s14, 0x4e2000
    s_mov_b32 s15, 0x20000
    s_mul_i32 s3, s33, 20000
    v_subrev_u32 v36, s3, v122
    v_cmp_le_u32 vcc, 20000, v36
    s_waitcnt lgkmcnt(4)
    s_mov_b64 exec, vcc
    buffer_store_dwordx4 v[16:19], v122, s[20:23], 0 offen sc1
    s_mov_b64 exec, -1
    v_subrev_u32 v36, s3, v123
    v_cmp_le_u32 vcc, 20000, v36
    s_waitcnt lgkmcnt(3)
    s_mov_b64 exec, vcc
    buffer_store_dwordx4 v[20:23], v123, s[20:23], 0 offen sc1
    s_mov_b64 exec, -1
    v_subrev_u32 v36, s3, v124
    v_cmp_le_u32 vcc, 20000, v36
    s_waitcnt lgkmcnt(2)
    s_mov_b64 exec, vcc
    buffer_store_dwordx4 v[24:27], v124, s[20:23], 0 offen sc1
    s_mov_b64 exec, -1
    v_subrev_u32 v36, s3, v125
    v_cmp_le_u32 vcc, 20000, v36
    s_waitcnt lgkmcnt(1)
    s_mov_b64 exec, vcc
    buffer_store_dwordx4 v[28:31], v125, s[20:23], 0 offen sc1
    s_mov_b64 exec, -1
    v_subrev_u32 v36, s3, v126
    v_cmp_le_u32 vcc, 20000, v36
    s_waitcnt lgkmcnt(0)
    s_mov_b64 exec, vcc
    buffer_store_dwordx4 v[32:35], v126, s[20:23], 0 offen sc1
    s_mov_b64 exec, -1
    v_lshlrev_b32 v80, 16, v116
    v_subrev_f32 v60, s50, v80
    v_subrev_f32 v61, s51, v80
    v_subrev_f32 v62, s52, v80
    v_subrev_f32 v63, s53, v80
    v_subrev_f32 v64, s54, v80
    v_subrev_f32 v65, s55, v80
    v_subrev_f32 v66, s56, v80
    v_subrev_f32 v67, s57, v80
    v_cvt_pk_bf16_f32 v68, v60, v61
    v_cvt_pk_bf16_f32 v69, v62, v63
    v_cvt_pk_bf16_f32 v70, v64, v65
    v_cvt_pk_bf16_f32 v71, v66, v67
    v_lshlrev_b32 v60, 16, v68
    v_and_b32 v61, 0xffff0000, v68
    v_lshlrev_b32 v62, 16, v69
    v_and_b32 v63, 0xffff0000, v69
    v_lshlrev_b32 v64, 16, v70
    v_and_b32 v65, 0xffff0000, v70
    v_lshlrev_b32 v66, 16, v71
    v_and_b32 v67, 0xffff0000, v71
    v_mul_f32 v60, v60, v60
    v_mul_f32 v61, v61, v61
    v_mul_f32 v62, v62, v62
    v_mul_f32 v63, v63, v63
    v_mul_f32 v64, v64, v64
    v_mul_f32 v65, v65, v65
    v_mul_f32 v66, v66, v66
    v_mul_f32 v67, v67, v67
    v_cvt_pk_bf16_f32 v68, v60, v61
    v_cvt_pk_bf16_f32 v69, v62, v63
    v_cvt_pk_bf16_f32 v70, v64, v65
    v_cvt_pk_bf16_f32 v71, v66, v67
    v_lshlrev_b32 v60, 16, v68
    v_and_b32 v61, 0xffff0000, v68
    v_lshlrev_b32 v62, 16, v69
    v_and_b32 v63, 0xffff0000, v69
    v_lshlrev_b32 v64, 16, v70
    v_and_b32 v65, 0xffff0000, v70
    v_lshlrev_b32 v66, 16, v71
    v_and_b32 v67, 0xffff0000, v71
    v_mul_f32 v60, 0xc1200000, v60
    v_mul_f32 v61, 0xc1200000, v61
    v_mul_f32 v62, 0xc1200000, v62
    v_mul_f32 v63, 0xc1200000, v63
    v_mul_f32 v64, 0xc1200000, v64
    v_mul_f32 v65, 0xc1200000, v65
    v_mul_f32 v66, 0xc1200000, v66
    v_mul_f32 v67, 0xc1200000, v67
    v_cvt_pk_bf16_f32 v68, v60, v61
    v_cvt_pk_bf16_f32 v69, v62, v63
    v_cvt_pk_bf16_f32 v70, v64, v65
    v_cvt_pk_bf16_f32 v71, v66, v67
    v_lshlrev_b32 v60, 16, v68
    v_and_b32 v61, 0xffff0000, v68
    v_lshlrev_b32 v62, 16, v69
    v_and_b32 v63, 0xffff0000, v69
    v_lshlrev_b32 v64, 16, v70
    v_and_b32 v65, 0xffff0000, v70
    v_lshlrev_b32 v66, 16, v71
    v_and_b32 v67, 0xffff0000, v71
    v_mul_f32 v60, 0x3fb8aa3b, v60
    v_mul_f32 v61, 0x3fb8aa3b, v61
    v_mul_f32 v62, 0x3fb8aa3b, v62
    v_mul_f32 v63, 0x3fb8aa3b, v63
    v_mul_f32 v64, 0x3fb8aa3b, v64
    v_mul_f32 v65, 0x3fb8aa3b, v65
    v_mul_f32 v66, 0x3fb8aa3b, v66
    v_mul_f32 v67, 0x3fb8aa3b, v67
    v_exp_f32 v60, v60
    v_exp_f32 v61, v61
    v_exp_f32 v62, v62
    v_exp_f32 v63, v63
    v_exp_f32 v64, v64
    v_exp_f32 v65, v65
    v_exp_f32 v66, v66
    v_exp_f32 v67, v67
    v_cvt_pk_bf16_f32 v72, v60, v61
    v_cvt_pk_bf16_f32 v73, v62, v63
    v_cvt_pk_bf16_f32 v74, v64, v65
    v_cvt_pk_bf16_f32 v75, v66, v67
    v_and_b32 v80, 0xffff0000, v116
    v_subrev_f32 v60, s50, v80
    v_subrev_f32 v61, s51, v80
    v_subrev_f32 v62, s52, v80
    v_subrev_f32 v63, s53, v80
    v_subrev_f32 v64, s54, v80
    v_subrev_f32 v65, s55, v80
    v_subrev_f32 v66, s56, v80
    v_subrev_f32 v67, s57, v80
    v_cvt_pk_bf16_f32 v68, v60, v61
    v_cvt_pk_bf16_f32 v69, v62, v63
    v_cvt_pk_bf16_f32 v70, v64, v65
    v_cvt_pk_bf16_f32 v71, v66, v67
    v_lshlrev_b32 v60, 16, v68
    v_and_b32 v61, 0xffff0000, v68
    v_lshlrev_b32 v62, 16, v69
    v_and_b32 v63, 0xffff0000, v69
    v_lshlrev_b32 v64, 16, v70
    v_and_b32 v65, 0xffff0000, v70
    v_lshlrev_b32 v66, 16, v71
    v_and_b32 v67, 0xffff0000, v71
    v_mul_f32 v60, v60, v60
    v_mul_f32 v61, v61, v61
    v_mul_f32 v62, v62, v62
    v_mul_f32 v63, v63, v63
    v_mul_f32 v64, v64, v64
    v_mul_f32 v65, v65, v65
    v_mul_f32 v66, v66, v66
    v_mul_f32 v67, v67, v67
    v_cvt_pk_bf16_f32 v68, v60, v61
    v_cvt_pk_bf16_f32 v69, v62, v63
    v_cvt_pk_bf16_f32 v70, v64, v65
    v_cvt_pk_bf16_f32 v71, v66, v67
    v_lshlrev_b32 v60, 16, v68
    v_and_b32 v61, 0xffff0000, v68
    v_lshlrev_b32 v62, 16, v69
    v_and_b32 v63, 0xffff0000, v69
    v_lshlrev_b32 v64, 16, v70
    v_and_b32 v65, 0xffff0000, v70
    v_lshlrev_b32 v66, 16, v71
    v_and_b32 v67, 0xffff0000, v71
    v_mul_f32 v60, 0xc1200000, v60
    v_mul_f32 v61, 0xc1200000, v61
    v_mul_f32 v62, 0xc1200000, v62
    v_mul_f32 v63, 0xc1200000, v63
    v_mul_f32 v64, 0xc1200000, v64
    v_mul_f32 v65, 0xc1200000, v65
    v_mul_f32 v66, 0xc1200000, v66
    v_mul_f32 v67, 0xc1200000, v67
    v_cvt_pk_bf16_f32 v68, v60, v61
    v_cvt_pk_bf16_f32 v69, v62, v63
    v_cvt_pk_bf16_f32 v70, v64, v65
    v_cvt_pk_bf16_f32 v71, v66, v67
    v_lshlrev_b32 v60, 16, v68
    v_and_b32 v61, 0xffff0000, v68
    v_lshlrev_b32 v62, 16, v69
    v_and_b32 v63, 0xffff0000, v69
    v_lshlrev_b32 v64, 16, v70
    v_and_b32 v65, 0xffff0000, v70
    v_lshlrev_b32 v66, 16, v71
    v_and_b32 v67, 0xffff0000, v71
    v_mul_f32 v60, 0x3fb8aa3b, v60
    v_mul_f32 v61, 0x3fb8aa3b, v61
    v_mul_f32 v62, 0x3fb8aa3b, v62
    v_mul_f32 v63, 0x3fb8aa3b, v63
    v_mul_f32 v64, 0x3fb8aa3b, v64
    v_mul_f32 v65, 0x3fb8aa3b, v65
    v_mul_f32 v66, 0x3fb8aa3b, v66
    v_mul_f32 v67, 0x3fb8aa3b, v67
    v_exp_f32 v60, v60
    v_exp_f32 v61, v61
    v_exp_f32 v62, v62
    v_exp_f32 v63, v63
    v_exp_f32 v64, v64
    v_exp_f32 v65, v65
    v_exp_f32 v66, v66
    v_exp_f32 v67, v67
    v_cvt_pk_bf16_f32 v76, v60, v61
    v_cvt_pk_bf16_f32 v77, v62, v63
    v_cvt_pk_bf16_f32 v78, v64, v65
    v_cvt_pk_bf16_f32 v79, v66, v67
    v_mfma_f32_4x4x4_16b_bf16 v[80:83], v[48:49], v[72:73], 0
    v_mfma_f32_4x4x4_16b_bf16 v[88:91], v[52:53], v[72:73], 0
    v_mfma_f32_4x4x4_16b_bf16 v[84:87], v[48:49], v[76:77], 0
    v_mfma_f32_4x4x4_16b_bf16 v[92:95], v[52:53], v[76:77], 0
    v_mfma_f32_4x4x4_16b_bf16 v[80:83], v[50:51], v[74:75], v[80:83]
    v_mfma_f32_4x4x4_16b_bf16 v[88:91], v[54:55], v[74:75], v[88:91]
    v_mfma_f32_4x4x4_16b_bf16 v[84:87], v[50:51], v[78:79], v[84:87]
    v_mfma_f32_4x4x4_16b_bf16 v[92:95], v[54:55], v[78:79], v[92:95]
    s_cmp_ge_u32 s32, 4
    s_cbranch_scc1 L2_f1
    v_lshlrev_b32 v16, 16, v117
    v_subrev_f32 v60, s50, v16
    v_subrev_f32 v61, s51, v16
    v_subrev_f32 v62, s52, v16
    v_subrev_f32 v63, s53, v16
    v_subrev_f32 v64, s54, v16
    v_subrev_f32 v65, s55, v16
    v_subrev_f32 v66, s56, v16
    v_subrev_f32 v67, s57, v16
    v_cvt_pk_bf16_f32 v68, v60, v61
    v_cvt_pk_bf16_f32 v69, v62, v63
    v_cvt_pk_bf16_f32 v70, v64, v65
    v_cvt_pk_bf16_f32 v71, v66, v67
    v_lshlrev_b32 v60, 16, v68
    v_and_b32 v61, 0xffff0000, v68
    v_lshlrev_b32 v62, 16, v69
    v_and_b32 v63, 0xffff0000, v69
    v_lshlrev_b32 v64, 16, v70
    v_and_b32 v65, 0xffff0000, v70
    v_lshlrev_b32 v66, 16, v71
    v_and_b32 v67, 0xffff0000, v71
    v_mul_f32 v60, v60, v60
    v_mul_f32 v61, v61, v61
    v_mul_f32 v62, v62, v62
    v_mul_f32 v63, v63, v63
    v_mul_f32 v64, v64, v64
    v_mul_f32 v65, v65, v65
    v_mul_f32 v66, v66, v66
    v_mul_f32 v67, v67, v67
    v_cvt_pk_bf16_f32 v68, v60, v61
    v_cvt_pk_bf16_f32 v69, v62, v63
    v_cvt_pk_bf16_f32 v70, v64, v65
    v_cvt_pk_bf16_f32 v71, v66, v67
    v_lshlrev_b32 v60, 16, v68
    v_and_b32 v61, 0xffff0000, v68
    v_lshlrev_b32 v62, 16, v69
    v_and_b32 v63, 0xffff0000, v69
    v_lshlrev_b32 v64, 16, v70
    v_and_b32 v65, 0xffff0000, v70
    v_lshlrev_b32 v66, 16, v71
    v_and_b32 v67, 0xffff0000, v71
    v_mul_f32 v60, 0xc1200000, v60
    v_mul_f32 v61, 0xc1200000, v61
    v_mul_f32 v62, 0xc1200000, v62
    v_mul_f32 v63, 0xc1200000, v63
    v_mul_f32 v64, 0xc1200000, v64
    v_mul_f32 v65, 0xc1200000, v65
    v_mul_f32 v66, 0xc1200000, v66
    v_mul_f32 v67, 0xc1200000, v67
    v_cvt_pk_bf16_f32 v68, v60, v61
    v_cvt_pk_bf16_f32 v69, v62, v63
    v_cvt_pk_bf16_f32 v70, v64, v65
    v_cvt_pk_bf16_f32 v71, v66, v67
    v_lshlrev_b32 v60, 16, v68
    v_and_b32 v61, 0xffff0000, v68
    v_lshlrev_b32 v62, 16, v69
    v_and_b32 v63, 0xffff0000, v69
    v_lshlrev_b32 v64, 16, v70
    v_and_b32 v65, 0xffff0000, v70
    v_lshlrev_b32 v66, 16, v71
    v_and_b32 v67, 0xffff0000, v71
    v_mul_f32 v60, 0x3fb8aa3b, v60
    v_mul_f32 v61, 0x3fb8aa3b, v61
    v_mul_f32 v62, 0x3fb8aa3b, v62
    v_mul_f32 v63, 0x3fb8aa3b, v63
    v_mul_f32 v64, 0x3fb8aa3b, v64
    v_mul_f32 v65, 0x3fb8aa3b, v65
    v_mul_f32 v66, 0x3fb8aa3b, v66
    v_mul_f32 v67, 0x3fb8aa3b, v67
    v_exp_f32 v60, v60
    v_exp_f32 v61, v61
    v_exp_f32 v62, v62
    v_exp_f32 v63, v63
    v_exp_f32 v64, v64
    v_exp_f32 v65, v65
    v_exp_f32 v66, v66
    v_exp_f32 v67, v67
    v_cvt_pk_bf16_f32 v72, v60, v61
    v_cvt_pk_bf16_f32 v73, v62, v63
    v_cvt_pk_bf16_f32 v74, v64, v65
    v_cvt_pk_bf16_f32 v75, v66, v67
    v_and_b32 v16, 0xffff0000, v117
    v_subrev_f32 v60, s50, v16
    v_subrev_f32 v61, s51, v16
    v_subrev_f32 v62, s52, v16
    v_subrev_f32 v63, s53, v16
    v_subrev_f32 v64, s54, v16
    v_subrev_f32 v65, s55, v16
    v_subrev_f32 v66, s56, v16
    v_subrev_f32 v67, s57, v16
    v_cvt_pk_bf16_f32 v68, v60, v61
    v_cvt_pk_bf16_f32 v69, v62, v63
    v_cvt_pk_bf16_f32 v70, v64, v65
    v_cvt_pk_bf16_f32 v71, v66, v67
    v_lshlrev_b32 v60, 16, v68
    v_and_b32 v61, 0xffff0000, v68
    v_lshlrev_b32 v62, 16, v69
    v_and_b32 v63, 0xffff0000, v69
    v_lshlrev_b32 v64, 16, v70
    v_and_b32 v65, 0xffff0000, v70
    v_lshlrev_b32 v66, 16, v71
    v_and_b32 v67, 0xffff0000, v71
    v_mul_f32 v60, v60, v60
    v_mul_f32 v61, v61, v61
    v_mul_f32 v62, v62, v62
    v_mul_f32 v63, v63, v63
    v_mul_f32 v64, v64, v64
    v_mul_f32 v65, v65, v65
    v_mul_f32 v66, v66, v66
    v_mul_f32 v67, v67, v67
    v_cvt_pk_bf16_f32 v68, v60, v61
    v_cvt_pk_bf16_f32 v69, v62, v63
    v_cvt_pk_bf16_f32 v70, v64, v65
    v_cvt_pk_bf16_f32 v71, v66, v67
    v_lshlrev_b32 v60, 16, v68
    v_and_b32 v61, 0xffff0000, v68
    v_lshlrev_b32 v62, 16, v69
    v_and_b32 v63, 0xffff0000, v69
    v_lshlrev_b32 v64, 16, v70
    v_and_b32 v65, 0xffff0000, v70
    v_lshlrev_b32 v66, 16, v71
    v_and_b32 v67, 0xffff0000, v71
    v_mul_f32 v60, 0xc1200000, v60
    v_mul_f32 v61, 0xc1200000, v61
    v_mul_f32 v62, 0xc1200000, v62
    v_mul_f32 v63, 0xc1200000, v63
    v_mul_f32 v64, 0xc1200000, v64
    v_mul_f32 v65, 0xc1200000, v65
    v_mul_f32 v66, 0xc1200000, v66
    v_mul_f32 v67, 0xc1200000, v67
    v_cvt_pk_bf16_f32 v68, v60, v61
    v_cvt_pk_bf16_f32 v69, v62, v63
    v_cvt_pk_bf16_f32 v70, v64, v65
    v_cvt_pk_bf16_f32 v71, v66, v67
    v_lshlrev_b32 v60, 16, v68
    v_and_b32 v61, 0xffff0000, v68
    v_lshlrev_b32 v62, 16, v69
    v_and_b32 v63, 0xffff0000, v69
    v_lshlrev_b32 v64, 16, v70
    v_and_b32 v65, 0xffff0000, v70
    v_lshlrev_b32 v66, 16, v71
    v_and_b32 v67, 0xffff0000, v71
    v_mul_f32 v60, 0x3fb8aa3b, v60
    v_mul_f32 v61, 0x3fb8aa3b, v61
    v_mul_f32 v62, 0x3fb8aa3b, v62
    v_mul_f32 v63, 0x3fb8aa3b, v63
    v_mul_f32 v64, 0x3fb8aa3b, v64
    v_mul_f32 v65, 0x3fb8aa3b, v65
    v_mul_f32 v66, 0x3fb8aa3b, v66
    v_mul_f32 v67, 0x3fb8aa3b, v67
    v_exp_f32 v60, v60
    v_exp_f32 v61, v61
    v_exp_f32 v62, v62
    v_exp_f32 v63, v63
    v_exp_f32 v64, v64
    v_exp_f32 v65, v65
    v_exp_f32 v66, v66
    v_exp_f32 v67, v67
    v_cvt_pk_bf16_f32 v76, v60, v61
    v_cvt_pk_bf16_f32 v77, v62, v63
    v_cvt_pk_bf16_f32 v78, v64, v65
    v_cvt_pk_bf16_f32 v79, v66, v67
    v_mfma_f32_4x4x4_16b_bf16 v[16:19], v[48:49], v[72:73], 0
    v_mfma_f32_4x4x4_16b_bf16 v[24:27], v[52:53], v[72:73], 0
    v_mfma_f32_4x4x4_16b_bf16 v[20:23], v[48:49], v[76:77], 0
    v_mfma_f32_4x4x4_16b_bf16 v[28:31], v[52:53], v[76:77], 0
    v_mfma_f32_4x4x4_16b_bf16 v[16:19], v[50:51], v[74:75], v[16:19]
    v_mfma_f32_4x4x4_16b_bf16 v[24:27], v[54:55], v[74:75], v[24:27]
    v_mfma_f32_4x4x4_16b_bf16 v[20:23], v[50:51], v[78:79], v[20:23]
    v_mfma_f32_4x4x4_16b_bf16 v[28:31], v[54:55], v[78:79], v[28:31]
L2_f1:
    ds_read_b128 v[32:35], v118
    ds_read_b128 v[60:63], v119
    s_add_u32 s20, s30, 0xd823000
    s_addc_u32 s21, s31, 0
    s_mov_b32 s22, 0x1388000
    s_mov_b32 s23, 0x20000
    s_add_u32 s3, s33, 1
    s_and_b32 s3, s3, 3
    s_lshl_b32 s3, s3, 6
    s_add_u32 s3, s3, s34
    s_mul_i32 s44, s3, 80000
    s_add_u32 s3, s33, 2
    s_and_b32 s3, s3, 3
    s_lshl_b32 s3, s3, 6
    s_add_u32 s3, s3, s34
    s_mul_i32 s45, s3, 80000
    s_add_u32 s3, s33, 3
    s_and_b32 s3, s3, 3
    s_lshl_b32 s3, s3, 6
    s_add_u32 s3, s3, s34
    s_mul_i32 s46, s3, 80000
    s_lshl_b32 s3, s34, 9
    s_lshl_b32 s4, s33, 7
    s_add_u32 s4, s4, s3
    v_mov_b32 v104, 1
    v_lshlrev_b32 v105, 3, v122
    s_waitcnt vmcnt(0)
    s_barrier
    s_cmp_lg_u32 s32, 0
    s_cbranch_scc1 L2_f2
    s_mov_b64 exec, 1
    buffer_store_dword v104, off, s[8:11], s4 sc1
    s_mov_b64 exec, 15
    s_bitset0_b64 exec, s33
L2_f3:
    buffer_load_dword v104, v105, s[8:11], s3 offen sc1
    s_waitcnt vmcnt(0)
    v_cmp_ne_u32 vcc, 1, v104
    s_cbranch_vccnz L2_f3
L2_f4:
    s_mov_b64 exec, -1
L2_f2:
    s_barrier
    buffer_load_dwordx4 v[36:39], v118, s[20:23], s44 offen sc1
    buffer_load_dwordx4 v[40:43], v118, s[20:23], s45 offen sc1
    buffer_load_dwordx4 v[44:47], v118, s[20:23], s46 offen sc1
    s_cmp_ge_u32 s32, 4
    s_cbranch_scc1 L2_f5
    buffer_load_dwordx4 v[64:67], v119, s[20:23], s44 offen sc1
    buffer_load_dwordx4 v[68:71], v119, s[20:23], s45 offen sc1
    buffer_load_dwordx4 v[72:75], v119, s[20:23], s46 offen sc1
L2_f5:
    s_waitcnt vmcnt(0) lgkmcnt(0)
    v_mfma_f32_4x4x4_16b_bf16 v[96:99], v[10:11], v[32:33], 0
    v_mfma_f32_4x4x4_16b_bf16 v[100:103], v[10:11], v[34:35], 0
    s_nop 0
    v_mfma_f32_4x4x4_16b_bf16 v[96:99], v[10:11], v[36:37], v[96:99]
    v_mfma_f32_4x4x4_16b_bf16 v[100:103], v[10:11], v[38:39], v[100:103]
    s_nop 0
    v_mfma_f32_4x4x4_16b_bf16 v[96:99], v[10:11], v[40:41], v[96:99]
    v_mfma_f32_4x4x4_16b_bf16 v[100:103], v[10:11], v[42:43], v[100:103]
    s_nop 0
    v_mfma_f32_4x4x4_16b_bf16 v[96:99], v[10:11], v[44:45], v[96:99]
    v_mfma_f32_4x4x4_16b_bf16 v[100:103], v[10:11], v[46:47], v[100:103]
    s_nop 3
    v_mul_f32 v96, v96, v80
    v_mul_f32 v97, v97, v81
    v_mul_f32 v98, v98, v82
    v_mul_f32 v99, v99, v83
    v_cvt_pk_bf16_f32 v32, v96, v97
    v_cvt_pk_bf16_f32 v33, v98, v99
    v_mul_f32 v100, v100, v84
    v_mul_f32 v101, v101, v85
    v_mul_f32 v102, v102, v86
    v_mul_f32 v103, v103, v87
    v_cvt_pk_bf16_f32 v34, v100, v101
    v_cvt_pk_bf16_f32 v35, v102, v103
    v_mfma_f32_4x4x4_16b_bf16 v[80:83], v[56:57], v[32:33], 0
    s_nop 0
    v_mfma_f32_4x4x4_16b_bf16 v[84:87], v[56:57], v[34:35], 0
    s_nop 2
    v_mul_f32 v80, v80, v88
    v_mul_f32 v81, v81, v89
    v_mul_f32 v82, v82, v90
    v_mul_f32 v83, v83, v91
    v_mul_f32 v84, v84, v92
    v_mul_f32 v85, v85, v93
    v_mul_f32 v86, v86, v94
    v_mul_f32 v87, v87, v95
    v_mfma_f32_4x4x4_16b_bf16 v[96:99], v[10:11], v[108:109], v[80:83]
    s_nop 0
    v_mfma_f32_4x4x4_16b_bf16 v[100:103], v[10:11], v[110:111], v[84:87]
    s_nop 2
    v_cvt_pk_bf16_f32 v36, v96, v97
    v_cvt_pk_bf16_f32 v37, v98, v99
    v_cvt_pk_bf16_f32 v38, v100, v101
    v_cvt_pk_bf16_f32 v39, v102, v103
    buffer_store_dwordx4 v[36:39], v120, s[12:15], 0 offen
    s_cmp_ge_u32 s32, 4
    s_cbranch_scc1 L2_f6
    v_mfma_f32_4x4x4_16b_bf16 v[96:99], v[10:11], v[60:61], 0
    v_mfma_f32_4x4x4_16b_bf16 v[100:103], v[10:11], v[62:63], 0
    s_nop 0
    v_mfma_f32_4x4x4_16b_bf16 v[96:99], v[10:11], v[64:65], v[96:99]
    v_mfma_f32_4x4x4_16b_bf16 v[100:103], v[10:11], v[66:67], v[100:103]
    s_nop 0
    v_mfma_f32_4x4x4_16b_bf16 v[96:99], v[10:11], v[68:69], v[96:99]
    v_mfma_f32_4x4x4_16b_bf16 v[100:103], v[10:11], v[70:71], v[100:103]
    s_nop 0
    v_mfma_f32_4x4x4_16b_bf16 v[96:99], v[10:11], v[72:73], v[96:99]
    v_mfma_f32_4x4x4_16b_bf16 v[100:103], v[10:11], v[74:75], v[100:103]
    s_nop 3
    v_mul_f32 v96, v96, v16
    v_mul_f32 v97, v97, v17
    v_mul_f32 v98, v98, v18
    v_mul_f32 v99, v99, v19
    v_cvt_pk_bf16_f32 v60, v96, v97
    v_cvt_pk_bf16_f32 v61, v98, v99
    v_mul_f32 v100, v100, v20
    v_mul_f32 v101, v101, v21
    v_mul_f32 v102, v102, v22
    v_mul_f32 v103, v103, v23
    v_cvt_pk_bf16_f32 v62, v100, v101
    v_cvt_pk_bf16_f32 v63, v102, v103
    v_mfma_f32_4x4x4_16b_bf16 v[16:19], v[56:57], v[60:61], 0
    s_nop 0
    v_mfma_f32_4x4x4_16b_bf16 v[20:23], v[56:57], v[62:63], 0
    s_nop 2
    v_mul_f32 v16, v16, v24
    v_mul_f32 v17, v17, v25
    v_mul_f32 v18, v18, v26
    v_mul_f32 v19, v19, v27
    v_mul_f32 v20, v20, v28
    v_mul_f32 v21, v21, v29
    v_mul_f32 v22, v22, v30
    v_mul_f32 v23, v23, v31
    v_mfma_f32_4x4x4_16b_bf16 v[96:99], v[10:11], v[112:113], v[16:19]
    s_nop 0
    v_mfma_f32_4x4x4_16b_bf16 v[100:103], v[10:11], v[114:115], v[20:23]
    s_nop 2
    v_cvt_pk_bf16_f32 v64, v96, v97
    v_cvt_pk_bf16_f32 v65, v98, v99
    v_cvt_pk_bf16_f32 v66, v100, v101
    v_cvt_pk_bf16_f32 v67, v102, v103
    buffer_store_dwordx4 v[64:67], v121, s[12:15], 0 offen
L2_f6:
L2_end:
    s_endpgm
L2_slow:
    s_lshr_b32 s35, s42, 2
    s_mul_i32 s50, s32, 80
    s_add_u32 s57, s50, 80
    s_and_b32 s3, s42, 3
    s_lshl_b32 s53, s3, 3
    s_add_u32 s53, s53, s39
    s_and_b32 s3, s35, 2
    s_lshl_b32 s3, s3, 1
    s_add_u32 s53, s53, s3
    s_and_b32 s54, s35, 1
    s_lshl_b32 s54, s54, 4
L2_sl_seg:
    s_mul_i32 s56, s50, 173056
    s_add_u32 s3, s56, s53
    s_add_u32 s55, s3, 32
    s_buffer_load_dword s51, s[12:15], s3
    s_buffer_load_dword s52, s[12:15], s55
    s_waitcnt lgkmcnt(0)
    s_lshr_b32 s51, s51, s54
    s_and_b32 s51, s51, 0xffff
    s_lshr_b32 s52, s52, s54
    s_and_b32 s52, s52, 0xffff
L2_sl_rec:
    s_cmp_ge_u32 s51, s52
    s_cbranch_scc1 L2_sl_next
    v_mbcnt_lo_u32_b32 v102, -1, 0
    v_mbcnt_hi_u32_b32 v102, -1, v102
    v_add_u32 v102, s51, v102
    v_and_b32 v103, -4, v102
    v_lshl_add_u32 v104, v102, 2, v103
    v_lshl_add_u32 v105, v103, 2, v102
    v_cmp_gt_u32 vcc, s52, v102
    s_mov_b64 exec, vcc
    buffer_load_dword v106, v104, s[8:11], s56 offen
    buffer_load_ubyte v107, v105, s[8:11], s56 offen offset:16
    s_waitcnt vmcnt(0)
    v_lshrrev_b32 v98, 14, v106
    v_and_b32 v98, v5, v98
    ds_read_b64 v[100:101], v98 offset:63616
    v_perm_b32 v97, v106, v107, s44
    v_and_b32 v96, v5, v106
    v_bitop3_b32 v103, v106, 0.5, -0.5 bitop3:0xa8
    v_bitop3_b32 v97, v6, v97, v103 bitop3:0xca
    s_waitcnt lgkmcnt(0)
    v_mfma_f32_4x4x4_16b_bf16 v[88:91], v[8:9], v[100:101], 0
    s_nop 4
    v_mul_f32 v88, v97, v88
    v_mul_f32 v89, v97, v89
    v_mul_f32 v90, v97, v90
    v_mul_f32 v91, v97, v91
    v_cvt_pk_bf16_f32 v88, v88, v89
    v_cvt_pk_bf16_f32 v89, v90, v91
    ds_pk_add_bf16 v96, v88
    ds_pk_add_bf16 v96, v89 offset:4
    s_mov_b64 exec, -1
    s_add_u32 s51, s51, 64
    s_branch L2_sl_rec
L2_sl_next:
    s_add_u32 s50, s50, 1
    s_cmp_lt_u32 s50, s57
    s_cbranch_scc1 L2_sl_seg
    s_waitcnt lgkmcnt(0)
    s_cmp_eq_u32 s42, 0
    s_cbranch_scc1 L2_ret0
    s_cmp_eq_u32 s42, 1
    s_cbranch_scc1 L2_ret1
    s_cmp_eq_u32 s42, 14
    s_cbranch_scc1 L2_ret6
    s_cmp_eq_u32 s42, 15
    s_cbranch_scc1 L2_ret7
    s_and_b32 s3, s42, 3
    s_cmp_eq_u32 s3, 2
    s_cbranch_scc1 L2_ret2
    s_cmp_eq_u32 s3, 3
    s_cbranch_scc1 L2_ret3
    s_cmp_eq_u32 s3, 0
    s_cbranch_scc1 L2_ret4
    s_branch L2_ret5
L2_xo1:
    v_cmp_lt_u32 vcc, 20, v99
    s_mov_b32 s43, 1
    s_cbranch_vccz L2_xp1
    v_cmp_lt_u32 vcc, 32, v99
    v_cmp_lt_u32 s[58:59], 31, v88
    s_mov_b32 s43, 2
    s_or_b64 vcc, vcc, s[58:59]
    s_cbranch_scc0 L2_xp1
    s_mov_b32 s37, 0x10000
    s_branch L2_xp1
L2_xa2:
    s_cmp_eq_u32 s43, 1
    s_cbranch_scc1 L2_xc2
    v_lshlrev_b32 v89, 0, v96
    v_add_u32 v90, 140, v97
    v_bitop3_b32 v90, v89, v45, v90 bitop3:0x6a
    ds_write_b32 v98, v90 offset:28
    v_lshlrev_b32 v89, 4, v96
    v_add_u32 v90, 120, v97
    v_bitop3_b32 v90, v89, v45, v90 bitop3:0x6a
    ds_write_b32 v98, v90 offset:24
    v_lshlrev_b32 v89, 8, v96
    v_add_u32 v90, 100, v97
    v_bitop3_b32 v90, v89, v45, v90 bitop3:0x6a
    ds_write_b32 v98, v90 offset:20
L2_xc2:
    v_lshlrev_b32 v89, 12, v96
    v_add_u32 v90, 80, v97
    v_bitop3_b32 v90, v89, v45, v90 bitop3:0x6a
    ds_write_b32 v98, v90 offset:16
    s_branch L2_xb2
L2_xe2:
    v_cmp_lt_u32 vcc, 32, v99
    v_cmp_lt_u32 s[58:59], 31, v88
    v_lshrrev_b32 v89, 16, v96
    v_add_u32 v97, 80, v97
    s_or_b64 vcc, vcc, s[58:59]
    s_cbranch_scc1 L2_xs2
    v_lshlrev_b32 v89, v1, v89
    v_and_b32 v89, v45, v89
    v_cmp_ne_u32 vcc, 0, v89
    v_xor_b32 v90, v97, v89
    s_add_u32 s3, s37, s38
    v_mbcnt_lo_u32_b32 v98, vcc_lo, 0
    v_mbcnt_hi_u32_b32 v98, vcc_hi, v98
    s_bcnt1_i32_b64 s41, vcc
    v_lshl_add_u32 v98, v98, 2, s3
    s_mov_b64 exec, vcc
    ds_write_b32 v98, v90
    s_mov_b64 exec, -1
    s_lshl2_add_u32 s37, s41, s37
    s_branch L2_xr2
L2_xf2:
    s_waitcnt lgkmcnt(0)
    s_cmp_gt_u32 s37, 1024
    s_cbranch_scc1 L2_xs2
    v_mov_b32 v43, -1
    s_cmp_ge_u32 s37, 512
    s_cbranch_scc1 L2_xg2
    v_mov_b32 v42, -1
    s_cmp_ge_u32 s37, 256
    s_cbranch_scc1 L2_xg2
    v_mov_b32 v41, -1
    s_branch L2_xg2
L2_xs2:
    s_waitcnt lgkmcnt(0)
    v_mov_b32 v40, -1
    v_mov_b32 v41, -1
    v_mov_b32 v42, -1
    v_mov_b32 v43, -1
    s_add_u32 s3, s42, 0
    s_bitset1_b32 s36, s3
    s_branch L2_xg2
L2_xo3:
    v_cmp_lt_u32 vcc, 20, v99
    s_mov_b32 s43, 1
    s_cbranch_vccz L2_xp3
    v_cmp_lt_u32 vcc, 32, v99
    v_cmp_lt_u32 s[58:59], 31, v88
    s_mov_b32 s43, 2
    s_or_b64 vcc, vcc, s[58:59]
    s_cbranch_scc0 L2_xp3
    s_mov_b32 s37, 0x10000
    s_branch L2_xp3
L2_xa4:
    s_cmp_eq_u32 s43, 1
    s_cbranch_scc1 L2_xc4
    v_lshlrev_b32 v89, 0, v96
    v_add_u32 v90, 140, v97
    v_bitop3_b32 v90, v89, v45, v90 bitop3:0x6a
    ds_write_b32 v98, v90 offset:28
    v_lshlrev_b32 v89, 4, v96
    v_add_u32 v90, 120, v97
    v_bitop3_b32 v90, v89, v45, v90 bitop3:0x6a
    ds_write_b32 v98, v90 offset:24
    v_lshlrev_b32 v89, 8, v96
    v_add_u32 v90, 100, v97
    v_bitop3_b32 v90, v89, v45, v90 bitop3:0x6a
    ds_write_b32 v98, v90 offset:20
L2_xc4:
    v_lshlrev_b32 v89, 12, v96
    v_add_u32 v90, 80, v97
    v_bitop3_b32 v90, v89, v45, v90 bitop3:0x6a
    ds_write_b32 v98, v90 offset:16
    s_branch L2_xb4
L2_xe4:
    v_cmp_lt_u32 vcc, 32, v99
    v_cmp_lt_u32 s[58:59], 31, v88
    v_lshrrev_b32 v89, 16, v96
    v_add_u32 v97, 80, v97
    s_or_b64 vcc, vcc, s[58:59]
    s_cbranch_scc1 L2_xs4
    v_lshlrev_b32 v89, v1, v89
    v_and_b32 v89, v45, v89
    v_cmp_ne_u32 vcc, 0, v89
    v_xor_b32 v90, v97, v89
    s_add_u32 s3, s37, s38
    v_mbcnt_lo_u32_b32 v98, vcc_lo, 0
    v_mbcnt_hi_u32_b32 v98, vcc_hi, v98
    s_bcnt1_i32_b64 s41, vcc
    v_lshl_add_u32 v98, v98, 2, s3
    s_mov_b64 exec, vcc
    ds_write_b32 v98, v90
    s_mov_b64 exec, -1
    s_lshl2_add_u32 s37, s41, s37
    s_branch L2_xr4
L2_xf4:
    s_waitcnt lgkmcnt(0)
    s_cmp_gt_u32 s37, 1024
    s_cbranch_scc1 L2_xs4
    v_mov_b32 v43, -1
    s_cmp_ge_u32 s37, 512
    s_cbranch_scc1 L2_xg4
    v_mov_b32 v42, -1
    s_cmp_ge_u32 s37, 256
    s_cbranch_scc1 L2_xg4
    v_mov_b32 v41, -1
    s_branch L2_xg4
L2_xs4:
    s_waitcnt lgkmcnt(0)
    v_mov_b32 v40, -1
    v_mov_b32 v41, -1
    v_mov_b32 v42, -1
    v_mov_b32 v43, -1
    s_add_u32 s3, s42, 1
    s_bitset1_b32 s36, s3
    s_branch L2_xg4
L2_c5:
    s_mov_b64 exec, s[82:83]
    s_nop 1
    v_mfma_f32_4x4x4_16b_bf16 v[88:91], v[12:13], v[84:85], 0
    s_nop 1
    v_mfma_f32_4x4x4_16b_bf16 v[88:91], v[10:11], v[86:87], v[88:91]
    s_nop 4
    v_cvt_pk_bf16_f32 v88, v88, v89
    v_cvt_pk_bf16_f32 v89, v90, v91
    ds_pk_add_bf16 v7, v88
    ds_pk_add_bf16 v7, v89 offset:4
    s_mov_b64 exec, vcc
    s_branch L2_d5
L2_c6:
    s_mov_b64 exec, s[82:83]
    s_nop 1
    v_mfma_f32_4x4x4_16b_bf16 v[88:91], v[12:13], v[84:85], 0
    s_nop 1
    v_mfma_f32_4x4x4_16b_bf16 v[88:91], v[10:11], v[86:87], v[88:91]
    s_nop 4
    v_cvt_pk_bf16_f32 v88, v88, v89
    v_cvt_pk_bf16_f32 v89, v90, v91
    ds_pk_add_bf16 v7, v88
    ds_pk_add_bf16 v7, v89 offset:4
    s_mov_b64 exec, vcc
    s_branch L2_d6
L2_c7:
    s_mov_b64 exec, s[82:83]
    s_nop 1
    v_mfma_f32_4x4x4_16b_bf16 v[88:91], v[12:13], v[84:85], 0
    s_nop 1
    v_mfma_f32_4x4x4_16b_bf16 v[88:91], v[10:11], v[86:87], v[88:91]
    s_nop 4
    v_cvt_pk_bf16_f32 v88, v88, v89
    v_cvt_pk_bf16_f32 v89, v90, v91
    ds_pk_add_bf16 v7, v88
    ds_pk_add_bf16 v7, v89 offset:4
    s_mov_b64 exec, vcc
    s_branch L2_d7
L2_c8:
    s_mov_b64 exec, s[82:83]
    s_nop 1
    v_mfma_f32_4x4x4_16b_bf16 v[88:91], v[12:13], v[84:85], 0
    s_nop 1
    v_mfma_f32_4x4x4_16b_bf16 v[88:91], v[10:11], v[86:87], v[88:91]
    s_nop 4
    v_cvt_pk_bf16_f32 v88, v88, v89
    v_cvt_pk_bf16_f32 v89, v90, v91
    ds_pk_add_bf16 v7, v88
    ds_pk_add_bf16 v7, v89 offset:4
    s_mov_b64 exec, vcc
    s_branch L2_d8
L2_xo9:
    v_cmp_lt_u32 vcc, 20, v99
    s_mov_b32 s43, 1
    s_cbranch_vccz L2_xp9
    v_cmp_lt_u32 vcc, 32, v99
    v_cmp_lt_u32 s[58:59], 31, v88
    s_mov_b32 s43, 2
    s_or_b64 vcc, vcc, s[58:59]
    s_cbranch_scc0 L2_xp9
    s_mov_b32 s37, 0x10000
    s_branch L2_xp9
L2_c10:
    s_mov_b64 exec, s[82:83]
    s_nop 1
    v_mfma_f32_4x4x4_16b_bf16 v[88:91], v[12:13], v[84:85], 0
    s_nop 1
    v_mfma_f32_4x4x4_16b_bf16 v[88:91], v[10:11], v[86:87], v[88:91]
    s_nop 4
    v_cvt_pk_bf16_f32 v88, v88, v89
    v_cvt_pk_bf16_f32 v89, v90, v91
    ds_pk_add_bf16 v7, v88
    ds_pk_add_bf16 v7, v89 offset:4
    s_mov_b64 exec, vcc
    s_branch L2_d10
L2_c11:
    s_mov_b64 exec, s[82:83]
    s_nop 1
    v_mfma_f32_4x4x4_16b_bf16 v[88:91], v[12:13], v[84:85], 0
    s_nop 1
    v_mfma_f32_4x4x4_16b_bf16 v[88:91], v[10:11], v[86:87], v[88:91]
    s_nop 4
    v_cvt_pk_bf16_f32 v88, v88, v89
    v_cvt_pk_bf16_f32 v89, v90, v91
    ds_pk_add_bf16 v7, v88
    ds_pk_add_bf16 v7, v89 offset:4
    s_mov_b64 exec, vcc
    s_branch L2_d11
L2_c12:
    s_mov_b64 exec, s[82:83]
    s_nop 1
    v_mfma_f32_4x4x4_16b_bf16 v[88:91], v[12:13], v[84:85], 0
    s_nop 1
    v_mfma_f32_4x4x4_16b_bf16 v[88:91], v[10:11], v[86:87], v[88:91]
    s_nop 4
    v_cvt_pk_bf16_f32 v88, v88, v89
    v_cvt_pk_bf16_f32 v89, v90, v91
    ds_pk_add_bf16 v7, v88
    ds_pk_add_bf16 v7, v89 offset:4
    s_mov_b64 exec, vcc
    s_branch L2_d12
L2_c13:
    s_mov_b64 exec, s[82:83]
    s_nop 1
    v_mfma_f32_4x4x4_16b_bf16 v[88:91], v[12:13], v[84:85], 0
    s_nop 1
    v_mfma_f32_4x4x4_16b_bf16 v[88:91], v[10:11], v[86:87], v[88:91]
    s_nop 4
    v_cvt_pk_bf16_f32 v88, v88, v89
    v_cvt_pk_bf16_f32 v89, v90, v91
    ds_pk_add_bf16 v7, v88
    ds_pk_add_bf16 v7, v89 offset:4
    s_mov_b64 exec, vcc
    s_branch L2_d13
L2_c14:
    s_mov_b64 exec, s[82:83]
    s_nop 1
    v_mfma_f32_4x4x4_16b_bf16 v[88:91], v[12:13], v[84:85], 0
    s_nop 1
    v_mfma_f32_4x4x4_16b_bf16 v[88:91], v[10:11], v[86:87], v[88:91]
    s_nop 4
    v_cvt_pk_bf16_f32 v88, v88, v89
    v_cvt_pk_bf16_f32 v89, v90, v91
    ds_pk_add_bf16 v7, v88
    ds_pk_add_bf16 v7, v89 offset:4
    s_mov_b64 exec, vcc
    s_branch L2_d14
L2_c15:
    s_mov_b64 exec, s[82:83]
    s_nop 1
    v_mfma_f32_4x4x4_16b_bf16 v[88:91], v[12:13], v[84:85], 0
    s_nop 1
    v_mfma_f32_4x4x4_16b_bf16 v[88:91], v[10:11], v[86:87], v[88:91]
    s_nop 4
    v_cvt_pk_bf16_f32 v88, v88, v89
    v_cvt_pk_bf16_f32 v89, v90, v91
    ds_pk_add_bf16 v7, v88
    ds_pk_add_bf16 v7, v89 offset:4
    s_mov_b64 exec, vcc
    s_branch L2_d15
L2_c16:
    s_mov_b64 exec, s[82:83]
    s_nop 1
    v_mfma_f32_4x4x4_16b_bf16 v[88:91], v[12:13], v[84:85], 0
    s_nop 1
    v_mfma_f32_4x4x4_16b_bf16 v[88:91], v[10:11], v[86:87], v[88:91]
    s_nop 4
    v_cvt_pk_bf16_f32 v88, v88, v89
    v_cvt_pk_bf16_f32 v89, v90, v91
    ds_pk_add_bf16 v7, v88
    ds_pk_add_bf16 v7, v89 offset:4
    s_mov_b64 exec, vcc
    s_branch L2_d16
L2_c17:
    s_mov_b64 exec, s[82:83]
    s_nop 1
    v_mfma_f32_4x4x4_16b_bf16 v[88:91], v[12:13], v[84:85], 0
    s_nop 1
    v_mfma_f32_4x4x4_16b_bf16 v[88:91], v[10:11], v[86:87], v[88:91]
    s_nop 4
    v_cvt_pk_bf16_f32 v88, v88, v89
    v_cvt_pk_bf16_f32 v89, v90, v91
    ds_pk_add_bf16 v7, v88
    ds_pk_add_bf16 v7, v89 offset:4
    s_mov_b64 exec, vcc
    s_branch L2_d17
L2_xa18:
    s_cmp_eq_u32 s43, 1
    s_cbranch_scc1 L2_xc18
    v_lshlrev_b32 v89, 0, v96
    v_add_u32 v90, 140, v97
    v_bitop3_b32 v90, v89, v45, v90 bitop3:0x6a
    ds_write_b32 v98, v90 offset:28
    v_lshlrev_b32 v89, 4, v96
    v_add_u32 v90, 120, v97
    v_bitop3_b32 v90, v89, v45, v90 bitop3:0x6a
    ds_write_b32 v98, v90 offset:24
    v_lshlrev_b32 v89, 8, v96
    v_add_u32 v90, 100, v97
    v_bitop3_b32 v90, v89, v45, v90 bitop3:0x6a
    ds_write_b32 v98, v90 offset:20
L2_xc18:
    v_lshlrev_b32 v89, 12, v96
    v_add_u32 v90, 80, v97
    v_bitop3_b32 v90, v89, v45, v90 bitop3:0x6a
    ds_write_b32 v98, v90 offset:16
    s_branch L2_xb18
L2_xe18:
    v_cmp_lt_u32 vcc, 32, v99
    v_cmp_lt_u32 s[58:59], 31, v88
    v_lshrrev_b32 v89, 16, v96
    v_add_u32 v97, 80, v97
    s_or_b64 vcc, vcc, s[58:59]
    s_cbranch_scc1 L2_xs18
    v_lshlrev_b32 v89, v1, v89
    v_and_b32 v89, v45, v89
    v_cmp_ne_u32 vcc, 0, v89
    v_xor_b32 v90, v97, v89
    s_add_u32 s3, s37, s38
    v_mbcnt_lo_u32_b32 v98, vcc_lo, 0
    v_mbcnt_hi_u32_b32 v98, vcc_hi, v98
    s_bcnt1_i32_b64 s41, vcc
    v_lshl_add_u32 v98, v98, 2, s3
    s_mov_b64 exec, vcc
    ds_write_b32 v98, v90
    s_mov_b64 exec, -1
    s_lshl2_add_u32 s37, s41, s37
    s_branch L2_xr18
L2_xf18:
    s_waitcnt lgkmcnt(0)
    s_cmp_gt_u32 s37, 1024
    s_cbranch_scc1 L2_xs18
    v_mov_b32 v43, -1
    s_cmp_ge_u32 s37, 512
    s_cbranch_scc1 L2_xg18
    v_mov_b32 v42, -1
    s_cmp_ge_u32 s37, 256
    s_cbranch_scc1 L2_xg18
    v_mov_b32 v41, -1
    s_branch L2_xg18
L2_xs18:
    s_waitcnt lgkmcnt(0)
    v_mov_b32 v40, -1
    v_mov_b32 v41, -1
    v_mov_b32 v42, -1
    v_mov_b32 v43, -1
    s_add_u32 s3, s42, 2
    s_bitset1_b32 s36, s3
    s_branch L2_xg18
L2_c19:
    s_mov_b64 exec, s[82:83]
    s_nop 1
    v_mfma_f32_4x4x4_16b_bf16 v[88:91], v[12:13], v[84:85], 0
    s_nop 1
    v_mfma_f32_4x4x4_16b_bf16 v[88:91], v[10:11], v[86:87], v[88:91]
    s_nop 4
    v_cvt_pk_bf16_f32 v88, v88, v89
    v_cvt_pk_bf16_f32 v89, v90, v91
    ds_pk_add_bf16 v7, v88
    ds_pk_add_bf16 v7, v89 offset:4
    s_mov_b64 exec, vcc
    s_branch L2_d19
L2_c20:
    s_mov_b64 exec, s[82:83]
    s_nop 1
    v_mfma_f32_4x4x4_16b_bf16 v[88:91], v[12:13], v[84:85], 0
    s_nop 1
    v_mfma_f32_4x4x4_16b_bf16 v[88:91], v[10:11], v[86:87], v[88:91]
    s_nop 4
    v_cvt_pk_bf16_f32 v88, v88, v89
    v_cvt_pk_bf16_f32 v89, v90, v91
    ds_pk_add_bf16 v7, v88
    ds_pk_add_bf16 v7, v89 offset:4
    s_mov_b64 exec, vcc
    s_branch L2_d20
L2_c21:
    s_mov_b64 exec, s[82:83]
    s_nop 1
    v_mfma_f32_4x4x4_16b_bf16 v[88:91], v[12:13], v[84:85], 0
    s_nop 1
    v_mfma_f32_4x4x4_16b_bf16 v[88:91], v[10:11], v[86:87], v[88:91]
    s_nop 4
    v_cvt_pk_bf16_f32 v88, v88, v89
    v_cvt_pk_bf16_f32 v89, v90, v91
    ds_pk_add_bf16 v7, v88
    ds_pk_add_bf16 v7, v89 offset:4
    s_mov_b64 exec, vcc
    s_branch L2_d21
L2_c22:
    s_mov_b64 exec, s[82:83]
    s_nop 1
    v_mfma_f32_4x4x4_16b_bf16 v[88:91], v[12:13], v[84:85], 0
    s_nop 1
    v_mfma_f32_4x4x4_16b_bf16 v[88:91], v[10:11], v[86:87], v[88:91]
    s_nop 4
    v_cvt_pk_bf16_f32 v88, v88, v89
    v_cvt_pk_bf16_f32 v89, v90, v91
    ds_pk_add_bf16 v7, v88
    ds_pk_add_bf16 v7, v89 offset:4
    s_mov_b64 exec, vcc
    s_branch L2_d22
L2_c23:
    s_mov_b64 exec, s[82:83]
    s_nop 1
    v_mfma_f32_4x4x4_16b_bf16 v[88:91], v[12:13], v[84:85], 0
    s_nop 1
    v_mfma_f32_4x4x4_16b_bf16 v[88:91], v[10:11], v[86:87], v[88:91]
    s_nop 4
    v_cvt_pk_bf16_f32 v88, v88, v89
    v_cvt_pk_bf16_f32 v89, v90, v91
    ds_pk_add_bf16 v7, v88
    ds_pk_add_bf16 v7, v89 offset:4
    s_mov_b64 exec, vcc
    s_branch L2_d23
L2_c24:
    s_mov_b64 exec, s[82:83]
    s_nop 1
    v_mfma_f32_4x4x4_16b_bf16 v[88:91], v[12:13], v[84:85], 0
    s_nop 1
    v_mfma_f32_4x4x4_16b_bf16 v[88:91], v[10:11], v[86:87], v[88:91]
    s_nop 4
    v_cvt_pk_bf16_f32 v88, v88, v89
    v_cvt_pk_bf16_f32 v89, v90, v91
    ds_pk_add_bf16 v7, v88
    ds_pk_add_bf16 v7, v89 offset:4
    s_mov_b64 exec, vcc
    s_branch L2_d24
L2_c25:
    s_mov_b64 exec, s[82:83]
    s_nop 1
    v_mfma_f32_4x4x4_16b_bf16 v[88:91], v[12:13], v[84:85], 0
    s_nop 1
    v_mfma_f32_4x4x4_16b_bf16 v[88:91], v[10:11], v[86:87], v[88:91]
    s_nop 4
    v_cvt_pk_bf16_f32 v88, v88, v89
    v_cvt_pk_bf16_f32 v89, v90, v91
    ds_pk_add_bf16 v7, v88
    ds_pk_add_bf16 v7, v89 offset:4
    s_mov_b64 exec, vcc
    s_branch L2_d25
L2_c26:
    s_mov_b64 exec, s[82:83]
    s_nop 1
    v_mfma_f32_4x4x4_16b_bf16 v[88:91], v[12:13], v[84:85], 0
    s_nop 1
    v_mfma_f32_4x4x4_16b_bf16 v[88:91], v[10:11], v[86:87], v[88:91]
    s_nop 4
    v_cvt_pk_bf16_f32 v88, v88, v89
    v_cvt_pk_bf16_f32 v89, v90, v91
    ds_pk_add_bf16 v7, v88
    ds_pk_add_bf16 v7, v89 offset:4
    s_mov_b64 exec, vcc
    s_branch L2_d26
L2_xo27:
    v_cmp_lt_u32 vcc, 20, v99
    s_mov_b32 s43, 1
    s_cbranch_vccz L2_xp27
    v_cmp_lt_u32 vcc, 32, v99
    v_cmp_lt_u32 s[58:59], 31, v88
    s_mov_b32 s43, 2
    s_or_b64 vcc, vcc, s[58:59]
    s_cbranch_scc0 L2_xp27
    s_mov_b32 s37, 0x10000
    s_branch L2_xp27
L2_c28:
    s_mov_b64 exec, s[82:83]
    s_nop 1
    v_mfma_f32_4x4x4_16b_bf16 v[88:91], v[12:13], v[84:85], 0
    s_nop 1
    v_mfma_f32_4x4x4_16b_bf16 v[88:91], v[10:11], v[86:87], v[88:91]
    s_nop 4
    v_cvt_pk_bf16_f32 v88, v88, v89
    v_cvt_pk_bf16_f32 v89, v90, v91
    ds_pk_add_bf16 v7, v88
    ds_pk_add_bf16 v7, v89 offset:4
    s_mov_b64 exec, vcc
    s_branch L2_d28
L2_c29:
    s_mov_b64 exec, s[82:83]
    s_nop 1
    v_mfma_f32_4x4x4_16b_bf16 v[88:91], v[12:13], v[84:85], 0
    s_nop 1
    v_mfma_f32_4x4x4_16b_bf16 v[88:91], v[10:11], v[86:87], v[88:91]
    s_nop 4
    v_cvt_pk_bf16_f32 v88, v88, v89
    v_cvt_pk_bf16_f32 v89, v90, v91
    ds_pk_add_bf16 v7, v88
    ds_pk_add_bf16 v7, v89 offset:4
    s_mov_b64 exec, vcc
    s_branch L2_d29
L2_c30:
    s_mov_b64 exec, s[82:83]
    s_nop 1
    v_mfma_f32_4x4x4_16b_bf16 v[88:91], v[12:13], v[84:85], 0
    s_nop 1
    v_mfma_f32_4x4x4_16b_bf16 v[88:91], v[10:11], v[86:87], v[88:91]
    s_nop 4
    v_cvt_pk_bf16_f32 v88, v88, v89
    v_cvt_pk_bf16_f32 v89, v90, v91
    ds_pk_add_bf16 v7, v88
    ds_pk_add_bf16 v7, v89 offset:4
    s_mov_b64 exec, vcc
    s_branch L2_d30
L2_c31:
    s_mov_b64 exec, s[82:83]
    s_nop 1
    v_mfma_f32_4x4x4_16b_bf16 v[88:91], v[12:13], v[84:85], 0
    s_nop 1
    v_mfma_f32_4x4x4_16b_bf16 v[88:91], v[10:11], v[86:87], v[88:91]
    s_nop 4
    v_cvt_pk_bf16_f32 v88, v88, v89
    v_cvt_pk_bf16_f32 v89, v90, v91
    ds_pk_add_bf16 v7, v88
    ds_pk_add_bf16 v7, v89 offset:4
    s_mov_b64 exec, vcc
    s_branch L2_d31
L2_c32:
    s_mov_b64 exec, s[82:83]
    s_nop 1
    v_mfma_f32_4x4x4_16b_bf16 v[88:91], v[12:13], v[84:85], 0
    s_nop 1
    v_mfma_f32_4x4x4_16b_bf16 v[88:91], v[10:11], v[86:87], v[88:91]
    s_nop 4
    v_cvt_pk_bf16_f32 v88, v88, v89
    v_cvt_pk_bf16_f32 v89, v90, v91
    ds_pk_add_bf16 v7, v88
    ds_pk_add_bf16 v7, v89 offset:4
    s_mov_b64 exec, vcc
    s_branch L2_d32
L2_c33:
    s_mov_b64 exec, s[82:83]
    s_nop 1
    v_mfma_f32_4x4x4_16b_bf16 v[88:91], v[12:13], v[84:85], 0
    s_nop 1
    v_mfma_f32_4x4x4_16b_bf16 v[88:91], v[10:11], v[86:87], v[88:91]
    s_nop 4
    v_cvt_pk_bf16_f32 v88, v88, v89
    v_cvt_pk_bf16_f32 v89, v90, v91
    ds_pk_add_bf16 v7, v88
    ds_pk_add_bf16 v7, v89 offset:4
    s_mov_b64 exec, vcc
    s_branch L2_d33
L2_c34:
    s_mov_b64 exec, s[82:83]
    s_nop 1
    v_mfma_f32_4x4x4_16b_bf16 v[88:91], v[12:13], v[84:85], 0
    s_nop 1
    v_mfma_f32_4x4x4_16b_bf16 v[88:91], v[10:11], v[86:87], v[88:91]
    s_nop 4
    v_cvt_pk_bf16_f32 v88, v88, v89
    v_cvt_pk_bf16_f32 v89, v90, v91
    ds_pk_add_bf16 v7, v88
    ds_pk_add_bf16 v7, v89 offset:4
    s_mov_b64 exec, vcc
    s_branch L2_d34
L2_c35:
    s_mov_b64 exec, s[82:83]
    s_nop 1
    v_mfma_f32_4x4x4_16b_bf16 v[88:91], v[12:13], v[84:85], 0
    s_nop 1
    v_mfma_f32_4x4x4_16b_bf16 v[88:91], v[10:11], v[86:87], v[88:91]
    s_nop 4
    v_cvt_pk_bf16_f32 v88, v88, v89
    v_cvt_pk_bf16_f32 v89, v90, v91
    ds_pk_add_bf16 v7, v88
    ds_pk_add_bf16 v7, v89 offset:4
    s_mov_b64 exec, vcc
    s_branch L2_d35
L2_xa36:
    s_cmp_eq_u32 s43, 1
    s_cbranch_scc1 L2_xc36
    v_lshlrev_b32 v89, 0, v96
    v_add_u32 v90, 140, v97
    v_bitop3_b32 v90, v89, v45, v90 bitop3:0x6a
    ds_write_b32 v98, v90 offset:28
    v_lshlrev_b32 v89, 4, v96
    v_add_u32 v90, 120, v97
    v_bitop3_b32 v90, v89, v45, v90 bitop3:0x6a
    ds_write_b32 v98, v90 offset:24
    v_lshlrev_b32 v89, 8, v96
    v_add_u32 v90, 100, v97
    v_bitop3_b32 v90, v89, v45, v90 bitop3:0x6a
    ds_write_b32 v98, v90 offset:20
L2_xc36:
    v_lshlrev_b32 v89, 12, v96
    v_add_u32 v90, 80, v97
    v_bitop3_b32 v90, v89, v45, v90 bitop3:0x6a
    ds_write_b32 v98, v90 offset:16
    s_branch L2_xb36
L2_xe36:
    v_cmp_lt_u32 vcc, 32, v99
    v_cmp_lt_u32 s[58:59], 31, v88
    v_lshrrev_b32 v89, 16, v96
    v_add_u32 v97, 80, v97
    s_or_b64 vcc, vcc, s[58:59]
    s_cbranch_scc1 L2_xs36
    v_lshlrev_b32 v89, v1, v89
    v_and_b32 v89, v45, v89
    v_cmp_ne_u32 vcc, 0, v89
    v_xor_b32 v90, v97, v89
    s_add_u32 s3, s37, s38
    v_mbcnt_lo_u32_b32 v98, vcc_lo, 0
    v_mbcnt_hi_u32_b32 v98, vcc_hi, v98
    s_bcnt1_i32_b64 s41, vcc
    v_lshl_add_u32 v98, v98, 2, s3
    s_mov_b64 exec, vcc
    ds_write_b32 v98, v90
    s_mov_b64 exec, -1
    s_lshl2_add_u32 s37, s41, s37
    s_branch L2_xr36
L2_xf36:
    s_waitcnt lgkmcnt(0)
    s_cmp_gt_u32 s37, 1024
    s_cbranch_scc1 L2_xs36
    v_mov_b32 v43, -1
    s_cmp_ge_u32 s37, 512
    s_cbranch_scc1 L2_xg36
    v_mov_b32 v42, -1
    s_cmp_ge_u32 s37, 256
    s_cbranch_scc1 L2_xg36
    v_mov_b32 v41, -1
    s_branch L2_xg36
L2_xs36:
    s_waitcnt lgkmcnt(0)
    v_mov_b32 v40, -1
    v_mov_b32 v41, -1
    v_mov_b32 v42, -1
    v_mov_b32 v43, -1
    s_add_u32 s3, s42, 2
    s_bitset1_b32 s36, s3
    s_branch L2_xg36
L2_c37:
    s_mov_b64 exec, s[82:83]
    s_nop 1
    v_mfma_f32_4x4x4_16b_bf16 v[88:91], v[12:13], v[84:85], 0
    s_nop 1
    v_mfma_f32_4x4x4_16b_bf16 v[88:91], v[10:11], v[86:87], v[88:91]
    s_nop 4
    v_cvt_pk_bf16_f32 v88, v88, v89
    v_cvt_pk_bf16_f32 v89, v90, v91
    ds_pk_add_bf16 v7, v88
    ds_pk_add_bf16 v7, v89 offset:4
    s_mov_b64 exec, vcc
    s_branch L2_d37
L2_c38:
    s_mov_b64 exec, s[82:83]
    s_nop 1
    v_mfma_f32_4x4x4_16b_bf16 v[88:91], v[12:13], v[84:85], 0
    s_nop 1
    v_mfma_f32_4x4x4_16b_bf16 v[88:91], v[10:11], v[86:87], v[88:91]
    s_nop 4
    v_cvt_pk_bf16_f32 v88, v88, v89
    v_cvt_pk_bf16_f32 v89, v90, v91
    ds_pk_add_bf16 v7, v88
    ds_pk_add_bf16 v7, v89 offset:4
    s_mov_b64 exec, vcc
    s_branch L2_d38
L2_c39:
    s_mov_b64 exec, s[82:83]
    s_nop 1
    v_mfma_f32_4x4x4_16b_bf16 v[88:91], v[12:13], v[84:85], 0
    s_nop 1
    v_mfma_f32_4x4x4_16b_bf16 v[88:91], v[10:11], v[86:87], v[88:91]
    s_nop 4
    v_cvt_pk_bf16_f32 v88, v88, v89
    v_cvt_pk_bf16_f32 v89, v90, v91
    ds_pk_add_bf16 v7, v88
    ds_pk_add_bf16 v7, v89 offset:4
    s_mov_b64 exec, vcc
    s_branch L2_d39
L2_c40:
    s_mov_b64 exec, s[82:83]
    s_nop 1
    v_mfma_f32_4x4x4_16b_bf16 v[88:91], v[12:13], v[84:85], 0
    s_nop 1
    v_mfma_f32_4x4x4_16b_bf16 v[88:91], v[10:11], v[86:87], v[88:91]
    s_nop 4
    v_cvt_pk_bf16_f32 v88, v88, v89
    v_cvt_pk_bf16_f32 v89, v90, v91
    ds_pk_add_bf16 v7, v88
    ds_pk_add_bf16 v7, v89 offset:4
    s_mov_b64 exec, vcc
    s_branch L2_d40
L2_c41:
    s_mov_b64 exec, s[82:83]
    s_nop 1
    v_mfma_f32_4x4x4_16b_bf16 v[88:91], v[12:13], v[84:85], 0
    s_nop 1
    v_mfma_f32_4x4x4_16b_bf16 v[88:91], v[10:11], v[86:87], v[88:91]
    s_nop 4
    v_cvt_pk_bf16_f32 v88, v88, v89
    v_cvt_pk_bf16_f32 v89, v90, v91
    ds_pk_add_bf16 v7, v88
    ds_pk_add_bf16 v7, v89 offset:4
    s_mov_b64 exec, vcc
    s_branch L2_d41
L2_c42:
    s_mov_b64 exec, s[82:83]
    s_nop 1
    v_mfma_f32_4x4x4_16b_bf16 v[88:91], v[12:13], v[84:85], 0
    s_nop 1
    v_mfma_f32_4x4x4_16b_bf16 v[88:91], v[10:11], v[86:87], v[88:91]
    s_nop 4
    v_cvt_pk_bf16_f32 v88, v88, v89
    v_cvt_pk_bf16_f32 v89, v90, v91
    ds_pk_add_bf16 v7, v88
    ds_pk_add_bf16 v7, v89 offset:4
    s_mov_b64 exec, vcc
    s_branch L2_d42
L2_c43:
    s_mov_b64 exec, s[82:83]
    s_nop 1
    v_mfma_f32_4x4x4_16b_bf16 v[88:91], v[12:13], v[84:85], 0
    s_nop 1
    v_mfma_f32_4x4x4_16b_bf16 v[88:91], v[10:11], v[86:87], v[88:91]
    s_nop 4
    v_cvt_pk_bf16_f32 v88, v88, v89
    v_cvt_pk_bf16_f32 v89, v90, v91
    ds_pk_add_bf16 v7, v88
    ds_pk_add_bf16 v7, v89 offset:4
    s_mov_b64 exec, vcc
    s_branch L2_d43
L2_c44:
    s_mov_b64 exec, s[82:83]
    s_nop 1
    v_mfma_f32_4x4x4_16b_bf16 v[88:91], v[12:13], v[84:85], 0
    s_nop 1
    v_mfma_f32_4x4x4_16b_bf16 v[88:91], v[10:11], v[86:87], v[88:91]
    s_nop 4
    v_cvt_pk_bf16_f32 v88, v88, v89
    v_cvt_pk_bf16_f32 v89, v90, v91
    ds_pk_add_bf16 v7, v88
    ds_pk_add_bf16 v7, v89 offset:4
    s_mov_b64 exec, vcc
    s_branch L2_d44
L2_xo45:
    v_cmp_lt_u32 vcc, 20, v99
    s_mov_b32 s43, 1
    s_cbranch_vccz L2_xp45
    v_cmp_lt_u32 vcc, 32, v99
    v_cmp_lt_u32 s[58:59], 31, v88
    s_mov_b32 s43, 2
    s_or_b64 vcc, vcc, s[58:59]
    s_cbranch_scc0 L2_xp45
    s_mov_b32 s37, 0x10000
    s_branch L2_xp45
L2_c46:
    s_mov_b64 exec, s[82:83]
    s_nop 1
    v_mfma_f32_4x4x4_16b_bf16 v[88:91], v[12:13], v[84:85], 0
    s_nop 1
    v_mfma_f32_4x4x4_16b_bf16 v[88:91], v[10:11], v[86:87], v[88:91]
    s_nop 4
    v_cvt_pk_bf16_f32 v88, v88, v89
    v_cvt_pk_bf16_f32 v89, v90, v91
    ds_pk_add_bf16 v7, v88
    ds_pk_add_bf16 v7, v89 offset:4
    s_mov_b64 exec, vcc
    s_branch L2_d46
L2_c47:
    s_mov_b64 exec, s[82:83]
    s_nop 1
    v_mfma_f32_4x4x4_16b_bf16 v[88:91], v[12:13], v[84:85], 0
    s_nop 1
    v_mfma_f32_4x4x4_16b_bf16 v[88:91], v[10:11], v[86:87], v[88:91]
    s_nop 4
    v_cvt_pk_bf16_f32 v88, v88, v89
    v_cvt_pk_bf16_f32 v89, v90, v91
    ds_pk_add_bf16 v7, v88
    ds_pk_add_bf16 v7, v89 offset:4
    s_mov_b64 exec, vcc
    s_branch L2_d47
L2_c48:
    s_mov_b64 exec, s[82:83]
    s_nop 1
    v_mfma_f32_4x4x4_16b_bf16 v[88:91], v[12:13], v[84:85], 0
    s_nop 1
    v_mfma_f32_4x4x4_16b_bf16 v[88:91], v[10:11], v[86:87], v[88:91]
    s_nop 4
    v_cvt_pk_bf16_f32 v88, v88, v89
    v_cvt_pk_bf16_f32 v89, v90, v91
    ds_pk_add_bf16 v7, v88
    ds_pk_add_bf16 v7, v89 offset:4
    s_mov_b64 exec, vcc
    s_branch L2_d48
L2_c49:
    s_mov_b64 exec, s[82:83]
    s_nop 1
    v_mfma_f32_4x4x4_16b_bf16 v[88:91], v[12:13], v[84:85], 0
    s_nop 1
    v_mfma_f32_4x4x4_16b_bf16 v[88:91], v[10:11], v[86:87], v[88:91]
    s_nop 4
    v_cvt_pk_bf16_f32 v88, v88, v89
    v_cvt_pk_bf16_f32 v89, v90, v91
    ds_pk_add_bf16 v7, v88
    ds_pk_add_bf16 v7, v89 offset:4
    s_mov_b64 exec, vcc
    s_branch L2_d49
L2_c50:
    s_mov_b64 exec, s[82:83]
    s_nop 1
    v_mfma_f32_4x4x4_16b_bf16 v[88:91], v[12:13], v[84:85], 0
    s_nop 1
    v_mfma_f32_4x4x4_16b_bf16 v[88:91], v[10:11], v[86:87], v[88:91]
    s_nop 4
    v_cvt_pk_bf16_f32 v88, v88, v89
    v_cvt_pk_bf16_f32 v89, v90, v91
    ds_pk_add_bf16 v7, v88
    ds_pk_add_bf16 v7, v89 offset:4
    s_mov_b64 exec, vcc
    s_branch L2_d50
L2_c51:
    s_mov_b64 exec, s[82:83]
    s_nop 1
    v_mfma_f32_4x4x4_16b_bf16 v[88:91], v[12:13], v[84:85], 0
    s_nop 1
    v_mfma_f32_4x4x4_16b_bf16 v[88:91], v[10:11], v[86:87], v[88:91]
    s_nop 4
    v_cvt_pk_bf16_f32 v88, v88, v89
    v_cvt_pk_bf16_f32 v89, v90, v91
    ds_pk_add_bf16 v7, v88
    ds_pk_add_bf16 v7, v89 offset:4
    s_mov_b64 exec, vcc
    s_branch L2_d51
L2_c52:
    s_mov_b64 exec, s[82:83]
    s_nop 1
    v_mfma_f32_4x4x4_16b_bf16 v[88:91], v[12:13], v[84:85], 0
    s_nop 1
    v_mfma_f32_4x4x4_16b_bf16 v[88:91], v[10:11], v[86:87], v[88:91]
    s_nop 4
    v_cvt_pk_bf16_f32 v88, v88, v89
    v_cvt_pk_bf16_f32 v89, v90, v91
    ds_pk_add_bf16 v7, v88
    ds_pk_add_bf16 v7, v89 offset:4
    s_mov_b64 exec, vcc
    s_branch L2_d52
L2_c53:
    s_mov_b64 exec, s[82:83]
    s_nop 1
    v_mfma_f32_4x4x4_16b_bf16 v[88:91], v[12:13], v[84:85], 0
    s_nop 1
    v_mfma_f32_4x4x4_16b_bf16 v[88:91], v[10:11], v[86:87], v[88:91]
    s_nop 4
    v_cvt_pk_bf16_f32 v88, v88, v89
    v_cvt_pk_bf16_f32 v89, v90, v91
    ds_pk_add_bf16 v7, v88
    ds_pk_add_bf16 v7, v89 offset:4
    s_mov_b64 exec, vcc
    s_branch L2_d53
L2_xa54:
    s_cmp_eq_u32 s43, 1
    s_cbranch_scc1 L2_xc54
    v_lshlrev_b32 v89, 0, v96
    v_add_u32 v90, 140, v97
    v_bitop3_b32 v90, v89, v45, v90 bitop3:0x6a
    ds_write_b32 v98, v90 offset:28
    v_lshlrev_b32 v89, 4, v96
    v_add_u32 v90, 120, v97
    v_bitop3_b32 v90, v89, v45, v90 bitop3:0x6a
    ds_write_b32 v98, v90 offset:24
    v_lshlrev_b32 v89, 8, v96
    v_add_u32 v90, 100, v97
    v_bitop3_b32 v90, v89, v45, v90 bitop3:0x6a
    ds_write_b32 v98, v90 offset:20
L2_xc54:
    v_lshlrev_b32 v89, 12, v96
    v_add_u32 v90, 80, v97
    v_bitop3_b32 v90, v89, v45, v90 bitop3:0x6a
    ds_write_b32 v98, v90 offset:16
    s_branch L2_xb54
L2_xe54:
    v_cmp_lt_u32 vcc, 32, v99
    v_cmp_lt_u32 s[58:59], 31, v88
    v_lshrrev_b32 v89, 16, v96
    v_add_u32 v97, 80, v97
    s_or_b64 vcc, vcc, s[58:59]
    s_cbranch_scc1 L2_xs54
    v_lshlrev_b32 v89, v1, v89
    v_and_b32 v89, v45, v89
    v_cmp_ne_u32 vcc, 0, v89
    v_xor_b32 v90, v97, v89
    s_add_u32 s3, s37, s38
    v_mbcnt_lo_u32_b32 v98, vcc_lo, 0
    v_mbcnt_hi_u32_b32 v98, vcc_hi, v98
    s_bcnt1_i32_b64 s41, vcc
    v_lshl_add_u32 v98, v98, 2, s3
    s_mov_b64 exec, vcc
    ds_write_b32 v98, v90
    s_mov_b64 exec, -1
    s_lshl2_add_u32 s37, s41, s37
    s_branch L2_xr54
L2_xf54:
    s_waitcnt lgkmcnt(0)
    s_cmp_gt_u32 s37, 1024
    s_cbranch_scc1 L2_xs54
    v_mov_b32 v43, -1
    s_cmp_ge_u32 s37, 512
    s_cbranch_scc1 L2_xg54
    v_mov_b32 v42, -1
    s_cmp_ge_u32 s37, 256
    s_cbranch_scc1 L2_xg54
    v_mov_b32 v41, -1
    s_branch L2_xg54
L2_xs54:
    s_waitcnt lgkmcnt(0)
    v_mov_b32 v40, -1
    v_mov_b32 v41, -1
    v_mov_b32 v42, -1
    v_mov_b32 v43, -1
    s_add_u32 s3, s42, 2
    s_bitset1_b32 s36, s3
    s_branch L2_xg54
L2_c55:
    s_mov_b64 exec, s[82:83]
    s_nop 1
    v_mfma_f32_4x4x4_16b_bf16 v[88:91], v[12:13], v[84:85], 0
    s_nop 1
    v_mfma_f32_4x4x4_16b_bf16 v[88:91], v[10:11], v[86:87], v[88:91]
    s_nop 4
    v_cvt_pk_bf16_f32 v88, v88, v89
    v_cvt_pk_bf16_f32 v89, v90, v91
    ds_pk_add_bf16 v7, v88
    ds_pk_add_bf16 v7, v89 offset:4
    s_mov_b64 exec, vcc
    s_branch L2_d55
L2_c56:
    s_mov_b64 exec, s[82:83]
    s_nop 1
    v_mfma_f32_4x4x4_16b_bf16 v[88:91], v[12:13], v[84:85], 0
    s_nop 1
    v_mfma_f32_4x4x4_16b_bf16 v[88:91], v[10:11], v[86:87], v[88:91]
    s_nop 4
    v_cvt_pk_bf16_f32 v88, v88, v89
    v_cvt_pk_bf16_f32 v89, v90, v91
    ds_pk_add_bf16 v7, v88
    ds_pk_add_bf16 v7, v89 offset:4
    s_mov_b64 exec, vcc
    s_branch L2_d56
L2_c57:
    s_mov_b64 exec, s[82:83]
    s_nop 1
    v_mfma_f32_4x4x4_16b_bf16 v[88:91], v[12:13], v[84:85], 0
    s_nop 1
    v_mfma_f32_4x4x4_16b_bf16 v[88:91], v[10:11], v[86:87], v[88:91]
    s_nop 4
    v_cvt_pk_bf16_f32 v88, v88, v89
    v_cvt_pk_bf16_f32 v89, v90, v91
    ds_pk_add_bf16 v7, v88
    ds_pk_add_bf16 v7, v89 offset:4
    s_mov_b64 exec, vcc
    s_branch L2_d57
L2_c58:
    s_mov_b64 exec, s[82:83]
    s_nop 1
    v_mfma_f32_4x4x4_16b_bf16 v[88:91], v[12:13], v[84:85], 0
    s_nop 1
    v_mfma_f32_4x4x4_16b_bf16 v[88:91], v[10:11], v[86:87], v[88:91]
    s_nop 4
    v_cvt_pk_bf16_f32 v88, v88, v89
    v_cvt_pk_bf16_f32 v89, v90, v91
    ds_pk_add_bf16 v7, v88
    ds_pk_add_bf16 v7, v89 offset:4
    s_mov_b64 exec, vcc
    s_branch L2_d58
L2_c59:
    s_mov_b64 exec, s[82:83]
    s_nop 1
    v_mfma_f32_4x4x4_16b_bf16 v[88:91], v[12:13], v[84:85], 0
    s_nop 1
    v_mfma_f32_4x4x4_16b_bf16 v[88:91], v[10:11], v[86:87], v[88:91]
    s_nop 4
    v_cvt_pk_bf16_f32 v88, v88, v89
    v_cvt_pk_bf16_f32 v89, v90, v91
    ds_pk_add_bf16 v7, v88
    ds_pk_add_bf16 v7, v89 offset:4
    s_mov_b64 exec, vcc
    s_branch L2_d59
L2_c60:
    s_mov_b64 exec, s[82:83]
    s_nop 1
    v_mfma_f32_4x4x4_16b_bf16 v[88:91], v[12:13], v[84:85], 0
    s_nop 1
    v_mfma_f32_4x4x4_16b_bf16 v[88:91], v[10:11], v[86:87], v[88:91]
    s_nop 4
    v_cvt_pk_bf16_f32 v88, v88, v89
    v_cvt_pk_bf16_f32 v89, v90, v91
    ds_pk_add_bf16 v7, v88
    ds_pk_add_bf16 v7, v89 offset:4
    s_mov_b64 exec, vcc
    s_branch L2_d60
L2_c61:
    s_mov_b64 exec, s[82:83]
    s_nop 1
    v_mfma_f32_4x4x4_16b_bf16 v[88:91], v[12:13], v[84:85], 0
    s_nop 1
    v_mfma_f32_4x4x4_16b_bf16 v[88:91], v[10:11], v[86:87], v[88:91]
    s_nop 4
    v_cvt_pk_bf16_f32 v88, v88, v89
    v_cvt_pk_bf16_f32 v89, v90, v91
    ds_pk_add_bf16 v7, v88
    ds_pk_add_bf16 v7, v89 offset:4
    s_mov_b64 exec, vcc
    s_branch L2_d61
L2_c62:
    s_mov_b64 exec, s[82:83]
    s_nop 1
    v_mfma_f32_4x4x4_16b_bf16 v[88:91], v[12:13], v[84:85], 0
    s_nop 1
    v_mfma_f32_4x4x4_16b_bf16 v[88:91], v[10:11], v[86:87], v[88:91]
    s_nop 4
    v_cvt_pk_bf16_f32 v88, v88, v89
    v_cvt_pk_bf16_f32 v89, v90, v91
    ds_pk_add_bf16 v7, v88
    ds_pk_add_bf16 v7, v89 offset:4
    s_mov_b64 exec, vcc
    s_branch L2_d62
L2_xo63:
    v_cmp_lt_u32 vcc, 20, v99
    s_mov_b32 s43, 1
    s_cbranch_vccz L2_xp63
    v_cmp_lt_u32 vcc, 32, v99
    v_cmp_lt_u32 s[58:59], 31, v88
    s_mov_b32 s43, 2
    s_or_b64 vcc, vcc, s[58:59]
    s_cbranch_scc0 L2_xp63
    s_mov_b32 s37, 0x10000
    s_branch L2_xp63
L2_c64:
    s_mov_b64 exec, s[82:83]
    s_nop 1
    v_mfma_f32_4x4x4_16b_bf16 v[88:91], v[12:13], v[84:85], 0
    s_nop 1
    v_mfma_f32_4x4x4_16b_bf16 v[88:91], v[10:11], v[86:87], v[88:91]
    s_nop 4
    v_cvt_pk_bf16_f32 v88, v88, v89
    v_cvt_pk_bf16_f32 v89, v90, v91
    ds_pk_add_bf16 v7, v88
    ds_pk_add_bf16 v7, v89 offset:4
    s_mov_b64 exec, vcc
    s_branch L2_d64
L2_c65:
    s_mov_b64 exec, s[82:83]
    s_nop 1
    v_mfma_f32_4x4x4_16b_bf16 v[88:91], v[12:13], v[84:85], 0
    s_nop 1
    v_mfma_f32_4x4x4_16b_bf16 v[88:91], v[10:11], v[86:87], v[88:91]
    s_nop 4
    v_cvt_pk_bf16_f32 v88, v88, v89
    v_cvt_pk_bf16_f32 v89, v90, v91
    ds_pk_add_bf16 v7, v88
    ds_pk_add_bf16 v7, v89 offset:4
    s_mov_b64 exec, vcc
    s_branch L2_d65
L2_c66:
    s_mov_b64 exec, s[82:83]
    s_nop 1
    v_mfma_f32_4x4x4_16b_bf16 v[88:91], v[12:13], v[84:85], 0
    s_nop 1
    v_mfma_f32_4x4x4_16b_bf16 v[88:91], v[10:11], v[86:87], v[88:91]
    s_nop 4
    v_cvt_pk_bf16_f32 v88, v88, v89
    v_cvt_pk_bf16_f32 v89, v90, v91
    ds_pk_add_bf16 v7, v88
    ds_pk_add_bf16 v7, v89 offset:4
    s_mov_b64 exec, vcc
    s_branch L2_d66
L2_c67:
    s_mov_b64 exec, s[82:83]
    s_nop 1
    v_mfma_f32_4x4x4_16b_bf16 v[88:91], v[12:13], v[84:85], 0
    s_nop 1
    v_mfma_f32_4x4x4_16b_bf16 v[88:91], v[10:11], v[86:87], v[88:91]
    s_nop 4
    v_cvt_pk_bf16_f32 v88, v88, v89
    v_cvt_pk_bf16_f32 v89, v90, v91
    ds_pk_add_bf16 v7, v88
    ds_pk_add_bf16 v7, v89 offset:4
    s_mov_b64 exec, vcc
    s_branch L2_d67
L2_c68:
    s_mov_b64 exec, s[82:83]
    s_nop 1
    v_mfma_f32_4x4x4_16b_bf16 v[88:91], v[12:13], v[84:85], 0
    s_nop 1
    v_mfma_f32_4x4x4_16b_bf16 v[88:91], v[10:11], v[86:87], v[88:91]
    s_nop 4
    v_cvt_pk_bf16_f32 v88, v88, v89
    v_cvt_pk_bf16_f32 v89, v90, v91
    ds_pk_add_bf16 v7, v88
    ds_pk_add_bf16 v7, v89 offset:4
    s_mov_b64 exec, vcc
    s_branch L2_d68
L2_c69:
    s_mov_b64 exec, s[82:83]
    s_nop 1
    v_mfma_f32_4x4x4_16b_bf16 v[88:91], v[12:13], v[84:85], 0
    s_nop 1
    v_mfma_f32_4x4x4_16b_bf16 v[88:91], v[10:11], v[86:87], v[88:91]
    s_nop 4
    v_cvt_pk_bf16_f32 v88, v88, v89
    v_cvt_pk_bf16_f32 v89, v90, v91
    ds_pk_add_bf16 v7, v88
    ds_pk_add_bf16 v7, v89 offset:4
    s_mov_b64 exec, vcc
    s_branch L2_d69
L2_c70:
    s_mov_b64 exec, s[82:83]
    s_nop 1
    v_mfma_f32_4x4x4_16b_bf16 v[88:91], v[12:13], v[84:85], 0
    s_nop 1
    v_mfma_f32_4x4x4_16b_bf16 v[88:91], v[10:11], v[86:87], v[88:91]
    s_nop 4
    v_cvt_pk_bf16_f32 v88, v88, v89
    v_cvt_pk_bf16_f32 v89, v90, v91
    ds_pk_add_bf16 v7, v88
    ds_pk_add_bf16 v7, v89 offset:4
    s_mov_b64 exec, vcc
    s_branch L2_d70
L2_c71:
    s_mov_b64 exec, s[82:83]
    s_nop 1
    v_mfma_f32_4x4x4_16b_bf16 v[88:91], v[12:13], v[84:85], 0
    s_nop 1
    v_mfma_f32_4x4x4_16b_bf16 v[88:91], v[10:11], v[86:87], v[88:91]
    s_nop 4
    v_cvt_pk_bf16_f32 v88, v88, v89
    v_cvt_pk_bf16_f32 v89, v90, v91
    ds_pk_add_bf16 v7, v88
    ds_pk_add_bf16 v7, v89 offset:4
    s_mov_b64 exec, vcc
    s_branch L2_d71
L2_xa72:
    s_cmp_eq_u32 s43, 1
    s_cbranch_scc1 L2_xc72
    v_lshlrev_b32 v89, 0, v96
    v_add_u32 v90, 140, v97
    v_bitop3_b32 v90, v89, v45, v90 bitop3:0x6a
    ds_write_b32 v98, v90 offset:28
    v_lshlrev_b32 v89, 4, v96
    v_add_u32 v90, 120, v97
    v_bitop3_b32 v90, v89, v45, v90 bitop3:0x6a
    ds_write_b32 v98, v90 offset:24
    v_lshlrev_b32 v89, 8, v96
    v_add_u32 v90, 100, v97
    v_bitop3_b32 v90, v89, v45, v90 bitop3:0x6a
    ds_write_b32 v98, v90 offset:20
L2_xc72:
    v_lshlrev_b32 v89, 12, v96
    v_add_u32 v90, 80, v97
    v_bitop3_b32 v90, v89, v45, v90 bitop3:0x6a
    ds_write_b32 v98, v90 offset:16
    s_branch L2_xb72
L2_xe72:
    v_cmp_lt_u32 vcc, 32, v99
    v_cmp_lt_u32 s[58:59], 31, v88
    v_lshrrev_b32 v89, 16, v96
    v_add_u32 v97, 80, v97
    s_or_b64 vcc, vcc, s[58:59]
    s_cbranch_scc1 L2_xs72
    v_lshlrev_b32 v89, v1, v89
    v_and_b32 v89, v45, v89
    v_cmp_ne_u32 vcc, 0, v89
    v_xor_b32 v90, v97, v89
    s_add_u32 s3, s37, s38
    v_mbcnt_lo_u32_b32 v98, vcc_lo, 0
    v_mbcnt_hi_u32_b32 v98, vcc_hi, v98
    s_bcnt1_i32_b64 s41, vcc
    v_lshl_add_u32 v98, v98, 2, s3
    s_mov_b64 exec, vcc
    ds_write_b32 v98, v90
    s_mov_b64 exec, -1
    s_lshl2_add_u32 s37, s41, s37
    s_branch L2_xr72
L2_xf72:
    s_waitcnt lgkmcnt(0)
    s_cmp_gt_u32 s37, 1024
    s_cbranch_scc1 L2_xs72
    v_mov_b32 v43, -1
    s_cmp_ge_u32 s37, 512
    s_cbranch_scc1 L2_xg72
    v_mov_b32 v42, -1
    s_cmp_ge_u32 s37, 256
    s_cbranch_scc1 L2_xg72
    v_mov_b32 v41, -1
    s_branch L2_xg72
L2_xs72:
    s_waitcnt lgkmcnt(0)
    v_mov_b32 v40, -1
    v_mov_b32 v41, -1
    v_mov_b32 v42, -1
    v_mov_b32 v43, -1
    s_add_u32 s3, s42, 2
    s_bitset1_b32 s36, s3
    s_branch L2_xg72
L2_c73:
    s_mov_b64 exec, s[82:83]
    s_nop 1
    v_mfma_f32_4x4x4_16b_bf16 v[88:91], v[12:13], v[84:85], 0
    s_nop 1
    v_mfma_f32_4x4x4_16b_bf16 v[88:91], v[10:11], v[86:87], v[88:91]
    s_nop 4
    v_cvt_pk_bf16_f32 v88, v88, v89
    v_cvt_pk_bf16_f32 v89, v90, v91
    ds_pk_add_bf16 v7, v88
    ds_pk_add_bf16 v7, v89 offset:4
    s_mov_b64 exec, vcc
    s_branch L2_d73
L2_c74:
    s_mov_b64 exec, s[82:83]
    s_nop 1
    v_mfma_f32_4x4x4_16b_bf16 v[88:91], v[12:13], v[84:85], 0
    s_nop 1
    v_mfma_f32_4x4x4_16b_bf16 v[88:91], v[10:11], v[86:87], v[88:91]
    s_nop 4
    v_cvt_pk_bf16_f32 v88, v88, v89
    v_cvt_pk_bf16_f32 v89, v90, v91
    ds_pk_add_bf16 v7, v88
    ds_pk_add_bf16 v7, v89 offset:4
    s_mov_b64 exec, vcc
    s_branch L2_d74
L2_c75:
    s_mov_b64 exec, s[82:83]
    s_nop 1
    v_mfma_f32_4x4x4_16b_bf16 v[88:91], v[12:13], v[84:85], 0
    s_nop 1
    v_mfma_f32_4x4x4_16b_bf16 v[88:91], v[10:11], v[86:87], v[88:91]
    s_nop 4
    v_cvt_pk_bf16_f32 v88, v88, v89
    v_cvt_pk_bf16_f32 v89, v90, v91
    ds_pk_add_bf16 v7, v88
    ds_pk_add_bf16 v7, v89 offset:4
    s_mov_b64 exec, vcc
    s_branch L2_d75
L2_c76:
    s_mov_b64 exec, s[82:83]
    s_nop 1
    v_mfma_f32_4x4x4_16b_bf16 v[88:91], v[12:13], v[84:85], 0
    s_nop 1
    v_mfma_f32_4x4x4_16b_bf16 v[88:91], v[10:11], v[86:87], v[88:91]
    s_nop 4
    v_cvt_pk_bf16_f32 v88, v88, v89
    v_cvt_pk_bf16_f32 v89, v90, v91
    ds_pk_add_bf16 v7, v88
    ds_pk_add_bf16 v7, v89 offset:4
    s_mov_b64 exec, vcc
    s_branch L2_d76
L2_c77:
    s_mov_b64 exec, s[82:83]
    s_nop 1
    v_mfma_f32_4x4x4_16b_bf16 v[88:91], v[12:13], v[84:85], 0
    s_nop 1
    v_mfma_f32_4x4x4_16b_bf16 v[88:91], v[10:11], v[86:87], v[88:91]
    s_nop 4
    v_cvt_pk_bf16_f32 v88, v88, v89
    v_cvt_pk_bf16_f32 v89, v90, v91
    ds_pk_add_bf16 v7, v88
    ds_pk_add_bf16 v7, v89 offset:4
    s_mov_b64 exec, vcc
    s_branch L2_d77
L2_c78:
    s_mov_b64 exec, s[82:83]
    s_nop 1
    v_mfma_f32_4x4x4_16b_bf16 v[88:91], v[12:13], v[84:85], 0
    s_nop 1
    v_mfma_f32_4x4x4_16b_bf16 v[88:91], v[10:11], v[86:87], v[88:91]
    s_nop 4
    v_cvt_pk_bf16_f32 v88, v88, v89
    v_cvt_pk_bf16_f32 v89, v90, v91
    ds_pk_add_bf16 v7, v88
    ds_pk_add_bf16 v7, v89 offset:4
    s_mov_b64 exec, vcc
    s_branch L2_d78
L2_c79:
    s_mov_b64 exec, s[82:83]
    s_nop 1
    v_mfma_f32_4x4x4_16b_bf16 v[88:91], v[12:13], v[84:85], 0
    s_nop 1
    v_mfma_f32_4x4x4_16b_bf16 v[88:91], v[10:11], v[86:87], v[88:91]
    s_nop 4
    v_cvt_pk_bf16_f32 v88, v88, v89
    v_cvt_pk_bf16_f32 v89, v90, v91
    ds_pk_add_bf16 v7, v88
    ds_pk_add_bf16 v7, v89 offset:4
    s_mov_b64 exec, vcc
    s_branch L2_d79
L2_c80:
    s_mov_b64 exec, s[82:83]
    s_nop 1
    v_mfma_f32_4x4x4_16b_bf16 v[88:91], v[12:13], v[84:85], 0
    s_nop 1
    v_mfma_f32_4x4x4_16b_bf16 v[88:91], v[10:11], v[86:87], v[88:91]
    s_nop 4
    v_cvt_pk_bf16_f32 v88, v88, v89
    v_cvt_pk_bf16_f32 v89, v90, v91
    ds_pk_add_bf16 v7, v88
    ds_pk_add_bf16 v7, v89 offset:4
    s_mov_b64 exec, vcc
    s_branch L2_d80
L2_xo81:
    v_cmp_lt_u32 vcc, 20, v99
    s_mov_b32 s43, 1
    s_cbranch_vccz L2_xp81
    v_cmp_lt_u32 vcc, 32, v99
    v_cmp_lt_u32 s[58:59], 31, v88
    s_mov_b32 s43, 2
    s_or_b64 vcc, vcc, s[58:59]
    s_cbranch_scc0 L2_xp81
    s_mov_b32 s37, 0x10000
    s_branch L2_xp81
L2_c82:
    s_mov_b64 exec, s[82:83]
    s_nop 1
    v_mfma_f32_4x4x4_16b_bf16 v[88:91], v[12:13], v[84:85], 0
    s_nop 1
    v_mfma_f32_4x4x4_16b_bf16 v[88:91], v[10:11], v[86:87], v[88:91]
    s_nop 4
    v_cvt_pk_bf16_f32 v88, v88, v89
    v_cvt_pk_bf16_f32 v89, v90, v91
    ds_pk_add_bf16 v7, v88
    ds_pk_add_bf16 v7, v89 offset:4
    s_mov_b64 exec, vcc
    s_branch L2_d82
L2_c83:
    s_mov_b64 exec, s[82:83]
    s_nop 1
    v_mfma_f32_4x4x4_16b_bf16 v[88:91], v[12:13], v[84:85], 0
    s_nop 1
    v_mfma_f32_4x4x4_16b_bf16 v[88:91], v[10:11], v[86:87], v[88:91]
    s_nop 4
    v_cvt_pk_bf16_f32 v88, v88, v89
    v_cvt_pk_bf16_f32 v89, v90, v91
    ds_pk_add_bf16 v7, v88
    ds_pk_add_bf16 v7, v89 offset:4
    s_mov_b64 exec, vcc
    s_branch L2_d83
L2_c84:
    s_mov_b64 exec, s[82:83]
    s_nop 1
    v_mfma_f32_4x4x4_16b_bf16 v[88:91], v[12:13], v[84:85], 0
    s_nop 1
    v_mfma_f32_4x4x4_16b_bf16 v[88:91], v[10:11], v[86:87], v[88:91]
    s_nop 4
    v_cvt_pk_bf16_f32 v88, v88, v89
    v_cvt_pk_bf16_f32 v89, v90, v91
    ds_pk_add_bf16 v7, v88
    ds_pk_add_bf16 v7, v89 offset:4
    s_mov_b64 exec, vcc
    s_branch L2_d84
L2_c85:
    s_mov_b64 exec, s[82:83]
    s_nop 1
    v_mfma_f32_4x4x4_16b_bf16 v[88:91], v[12:13], v[84:85], 0
    s_nop 1
    v_mfma_f32_4x4x4_16b_bf16 v[88:91], v[10:11], v[86:87], v[88:91]
    s_nop 4
    v_cvt_pk_bf16_f32 v88, v88, v89
    v_cvt_pk_bf16_f32 v89, v90, v91
    ds_pk_add_bf16 v7, v88
    ds_pk_add_bf16 v7, v89 offset:4
    s_mov_b64 exec, vcc
    s_branch L2_d85
L2_c86:
    s_mov_b64 exec, s[82:83]
    s_nop 1
    v_mfma_f32_4x4x4_16b_bf16 v[88:91], v[12:13], v[84:85], 0
    s_nop 1
    v_mfma_f32_4x4x4_16b_bf16 v[88:91], v[10:11], v[86:87], v[88:91]
    s_nop 4
    v_cvt_pk_bf16_f32 v88, v88, v89
    v_cvt_pk_bf16_f32 v89, v90, v91
    ds_pk_add_bf16 v7, v88
    ds_pk_add_bf16 v7, v89 offset:4
    s_mov_b64 exec, vcc
    s_branch L2_d86
L2_c87:
    s_mov_b64 exec, s[82:83]
    s_nop 1
    v_mfma_f32_4x4x4_16b_bf16 v[88:91], v[12:13], v[84:85], 0
    s_nop 1
    v_mfma_f32_4x4x4_16b_bf16 v[88:91], v[10:11], v[86:87], v[88:91]
    s_nop 4
    v_cvt_pk_bf16_f32 v88, v88, v89
    v_cvt_pk_bf16_f32 v89, v90, v91
    ds_pk_add_bf16 v7, v88
    ds_pk_add_bf16 v7, v89 offset:4
    s_mov_b64 exec, vcc
    s_branch L2_d87
L2_c88:
    s_mov_b64 exec, s[82:83]
    s_nop 1
    v_mfma_f32_4x4x4_16b_bf16 v[88:91], v[12:13], v[84:85], 0
    s_nop 1
    v_mfma_f32_4x4x4_16b_bf16 v[88:91], v[10:11], v[86:87], v[88:91]
    s_nop 4
    v_cvt_pk_bf16_f32 v88, v88, v89
    v_cvt_pk_bf16_f32 v89, v90, v91
    ds_pk_add_bf16 v7, v88
    ds_pk_add_bf16 v7, v89 offset:4
    s_mov_b64 exec, vcc
    s_branch L2_d88
L2_c89:
    s_mov_b64 exec, s[82:83]
    s_nop 1
    v_mfma_f32_4x4x4_16b_bf16 v[88:91], v[12:13], v[84:85], 0
    s_nop 1
    v_mfma_f32_4x4x4_16b_bf16 v[88:91], v[10:11], v[86:87], v[88:91]
    s_nop 4
    v_cvt_pk_bf16_f32 v88, v88, v89
    v_cvt_pk_bf16_f32 v89, v90, v91
    ds_pk_add_bf16 v7, v88
    ds_pk_add_bf16 v7, v89 offset:4
    s_mov_b64 exec, vcc
    s_branch L2_d89
L2_xa90:
    s_cmp_eq_u32 s43, 1
    s_cbranch_scc1 L2_xc90
    v_lshlrev_b32 v89, 0, v96
    v_add_u32 v90, 140, v97
    v_bitop3_b32 v90, v89, v45, v90 bitop3:0x6a
    ds_write_b32 v98, v90 offset:28
    v_lshlrev_b32 v89, 4, v96
    v_add_u32 v90, 120, v97
    v_bitop3_b32 v90, v89, v45, v90 bitop3:0x6a
    ds_write_b32 v98, v90 offset:24
    v_lshlrev_b32 v89, 8, v96
    v_add_u32 v90, 100, v97
    v_bitop3_b32 v90, v89, v45, v90 bitop3:0x6a
    ds_write_b32 v98, v90 offset:20
L2_xc90:
    v_lshlrev_b32 v89, 12, v96
    v_add_u32 v90, 80, v97
    v_bitop3_b32 v90, v89, v45, v90 bitop3:0x6a
    ds_write_b32 v98, v90 offset:16
    s_branch L2_xb90
L2_xe90:
    v_cmp_lt_u32 vcc, 32, v99
    v_cmp_lt_u32 s[58:59], 31, v88
    v_lshrrev_b32 v89, 16, v96
    v_add_u32 v97, 80, v97
    s_or_b64 vcc, vcc, s[58:59]
    s_cbranch_scc1 L2_xs90
    v_lshlrev_b32 v89, v1, v89
    v_and_b32 v89, v45, v89
    v_cmp_ne_u32 vcc, 0, v89
    v_xor_b32 v90, v97, v89
    s_add_u32 s3, s37, s38
    v_mbcnt_lo_u32_b32 v98, vcc_lo, 0
    v_mbcnt_hi_u32_b32 v98, vcc_hi, v98
    s_bcnt1_i32_b64 s41, vcc
    v_lshl_add_u32 v98, v98, 2, s3
    s_mov_b64 exec, vcc
    ds_write_b32 v98, v90
    s_mov_b64 exec, -1
    s_lshl2_add_u32 s37, s41, s37
    s_branch L2_xr90
L2_xf90:
    s_waitcnt lgkmcnt(0)
    s_cmp_gt_u32 s37, 1024
    s_cbranch_scc1 L2_xs90
    v_mov_b32 v43, -1
    s_cmp_ge_u32 s37, 512
    s_cbranch_scc1 L2_xg90
    v_mov_b32 v42, -1
    s_cmp_ge_u32 s37, 256
    s_cbranch_scc1 L2_xg90
    v_mov_b32 v41, -1
    s_branch L2_xg90
L2_xs90:
    s_waitcnt lgkmcnt(0)
    v_mov_b32 v40, -1
    v_mov_b32 v41, -1
    v_mov_b32 v42, -1
    v_mov_b32 v43, -1
    s_add_u32 s3, s42, 2
    s_bitset1_b32 s36, s3
    s_branch L2_xg90
L2_c91:
    s_mov_b64 exec, s[82:83]
    s_nop 1
    v_mfma_f32_4x4x4_16b_bf16 v[88:91], v[12:13], v[84:85], 0
    s_nop 1
    v_mfma_f32_4x4x4_16b_bf16 v[88:91], v[10:11], v[86:87], v[88:91]
    s_nop 4
    v_cvt_pk_bf16_f32 v88, v88, v89
    v_cvt_pk_bf16_f32 v89, v90, v91
    ds_pk_add_bf16 v7, v88
    ds_pk_add_bf16 v7, v89 offset:4
    s_mov_b64 exec, vcc
    s_branch L2_d91
L2_c92:
    s_mov_b64 exec, s[82:83]
    s_nop 1
    v_mfma_f32_4x4x4_16b_bf16 v[88:91], v[12:13], v[84:85], 0
    s_nop 1
    v_mfma_f32_4x4x4_16b_bf16 v[88:91], v[10:11], v[86:87], v[88:91]
    s_nop 4
    v_cvt_pk_bf16_f32 v88, v88, v89
    v_cvt_pk_bf16_f32 v89, v90, v91
    ds_pk_add_bf16 v7, v88
    ds_pk_add_bf16 v7, v89 offset:4
    s_mov_b64 exec, vcc
    s_branch L2_d92
L2_c93:
    s_mov_b64 exec, s[82:83]
    s_nop 1
    v_mfma_f32_4x4x4_16b_bf16 v[88:91], v[12:13], v[84:85], 0
    s_nop 1
    v_mfma_f32_4x4x4_16b_bf16 v[88:91], v[10:11], v[86:87], v[88:91]
    s_nop 4
    v_cvt_pk_bf16_f32 v88, v88, v89
    v_cvt_pk_bf16_f32 v89, v90, v91
    ds_pk_add_bf16 v7, v88
    ds_pk_add_bf16 v7, v89 offset:4
    s_mov_b64 exec, vcc
    s_branch L2_d93
L2_c94:
    s_mov_b64 exec, s[82:83]
    s_nop 1
    v_mfma_f32_4x4x4_16b_bf16 v[88:91], v[12:13], v[84:85], 0
    s_nop 1
    v_mfma_f32_4x4x4_16b_bf16 v[88:91], v[10:11], v[86:87], v[88:91]
    s_nop 4
    v_cvt_pk_bf16_f32 v88, v88, v89
    v_cvt_pk_bf16_f32 v89, v90, v91
    ds_pk_add_bf16 v7, v88
    ds_pk_add_bf16 v7, v89 offset:4
    s_mov_b64 exec, vcc
    s_branch L2_d94
L2_c95:
    s_mov_b64 exec, s[82:83]
    s_nop 1
    v_mfma_f32_4x4x4_16b_bf16 v[88:91], v[12:13], v[84:85], 0
    s_nop 1
    v_mfma_f32_4x4x4_16b_bf16 v[88:91], v[10:11], v[86:87], v[88:91]
    s_nop 4
    v_cvt_pk_bf16_f32 v88, v88, v89
    v_cvt_pk_bf16_f32 v89, v90, v91
    ds_pk_add_bf16 v7, v88
    ds_pk_add_bf16 v7, v89 offset:4
    s_mov_b64 exec, vcc
    s_branch L2_d95
L2_c96:
    s_mov_b64 exec, s[82:83]
    s_nop 1
    v_mfma_f32_4x4x4_16b_bf16 v[88:91], v[12:13], v[84:85], 0
    s_nop 1
    v_mfma_f32_4x4x4_16b_bf16 v[88:91], v[10:11], v[86:87], v[88:91]
    s_nop 4
    v_cvt_pk_bf16_f32 v88, v88, v89
    v_cvt_pk_bf16_f32 v89, v90, v91
    ds_pk_add_bf16 v7, v88
    ds_pk_add_bf16 v7, v89 offset:4
    s_mov_b64 exec, vcc
    s_branch L2_d96
L2_c97:
    s_mov_b64 exec, s[82:83]
    s_nop 1
    v_mfma_f32_4x4x4_16b_bf16 v[88:91], v[12:13], v[84:85], 0
    s_nop 1
    v_mfma_f32_4x4x4_16b_bf16 v[88:91], v[10:11], v[86:87], v[88:91]
    s_nop 4
    v_cvt_pk_bf16_f32 v88, v88, v89
    v_cvt_pk_bf16_f32 v89, v90, v91
    ds_pk_add_bf16 v7, v88
    ds_pk_add_bf16 v7, v89 offset:4
    s_mov_b64 exec, vcc
    s_branch L2_d97
L2_c98:
    s_mov_b64 exec, s[82:83]
    s_nop 1
    v_mfma_f32_4x4x4_16b_bf16 v[88:91], v[12:13], v[84:85], 0
    s_nop 1
    v_mfma_f32_4x4x4_16b_bf16 v[88:91], v[10:11], v[86:87], v[88:91]
    s_nop 4
    v_cvt_pk_bf16_f32 v88, v88, v89
    v_cvt_pk_bf16_f32 v89, v90, v91
    ds_pk_add_bf16 v7, v88
    ds_pk_add_bf16 v7, v89 offset:4
    s_mov_b64 exec, vcc
    s_branch L2_d98
L2_xo99:
    v_cmp_lt_u32 vcc, 20, v99
    s_mov_b32 s43, 1
    s_cbranch_vccz L2_xp99
    v_cmp_lt_u32 vcc, 32, v99
    v_cmp_lt_u32 s[58:59], 31, v88
    s_mov_b32 s43, 2
    s_or_b64 vcc, vcc, s[58:59]
    s_cbranch_scc0 L2_xp99
    s_mov_b32 s37, 0x10000
    s_branch L2_xp99
L2_c100:
    s_mov_b64 exec, s[82:83]
    s_nop 1
    v_mfma_f32_4x4x4_16b_bf16 v[88:91], v[12:13], v[84:85], 0
    s_nop 1
    v_mfma_f32_4x4x4_16b_bf16 v[88:91], v[10:11], v[86:87], v[88:91]
    s_nop 4
    v_cvt_pk_bf16_f32 v88, v88, v89
    v_cvt_pk_bf16_f32 v89, v90, v91
    ds_pk_add_bf16 v7, v88
    ds_pk_add_bf16 v7, v89 offset:4
    s_mov_b64 exec, vcc
    s_branch L2_d100
L2_c101:
    s_mov_b64 exec, s[82:83]
    s_nop 1
    v_mfma_f32_4x4x4_16b_bf16 v[88:91], v[12:13], v[84:85], 0
    s_nop 1
    v_mfma_f32_4x4x4_16b_bf16 v[88:91], v[10:11], v[86:87], v[88:91]
    s_nop 4
    v_cvt_pk_bf16_f32 v88, v88, v89
    v_cvt_pk_bf16_f32 v89, v90, v91
    ds_pk_add_bf16 v7, v88
    ds_pk_add_bf16 v7, v89 offset:4
    s_mov_b64 exec, vcc
    s_branch L2_d101
L2_c102:
    s_mov_b64 exec, s[82:83]
    s_nop 1
    v_mfma_f32_4x4x4_16b_bf16 v[88:91], v[12:13], v[84:85], 0
    s_nop 1
    v_mfma_f32_4x4x4_16b_bf16 v[88:91], v[10:11], v[86:87], v[88:91]
    s_nop 4
    v_cvt_pk_bf16_f32 v88, v88, v89
    v_cvt_pk_bf16_f32 v89, v90, v91
    ds_pk_add_bf16 v7, v88
    ds_pk_add_bf16 v7, v89 offset:4
    s_mov_b64 exec, vcc
    s_branch L2_d102
L2_c103:
    s_mov_b64 exec, s[82:83]
    s_nop 1
    v_mfma_f32_4x4x4_16b_bf16 v[88:91], v[12:13], v[84:85], 0
    s_nop 1
    v_mfma_f32_4x4x4_16b_bf16 v[88:91], v[10:11], v[86:87], v[88:91]
    s_nop 4
    v_cvt_pk_bf16_f32 v88, v88, v89
    v_cvt_pk_bf16_f32 v89, v90, v91
    ds_pk_add_bf16 v7, v88
    ds_pk_add_bf16 v7, v89 offset:4
    s_mov_b64 exec, vcc
    s_branch L2_d103
L2_c104:
    s_mov_b64 exec, s[82:83]
    s_nop 1
    v_mfma_f32_4x4x4_16b_bf16 v[88:91], v[12:13], v[84:85], 0
    s_nop 1
    v_mfma_f32_4x4x4_16b_bf16 v[88:91], v[10:11], v[86:87], v[88:91]
    s_nop 4
    v_cvt_pk_bf16_f32 v88, v88, v89
    v_cvt_pk_bf16_f32 v89, v90, v91
    ds_pk_add_bf16 v7, v88
    ds_pk_add_bf16 v7, v89 offset:4
    s_mov_b64 exec, vcc
    s_branch L2_d104
L2_c105:
    s_mov_b64 exec, s[82:83]
    s_nop 1
    v_mfma_f32_4x4x4_16b_bf16 v[88:91], v[12:13], v[84:85], 0
    s_nop 1
    v_mfma_f32_4x4x4_16b_bf16 v[88:91], v[10:11], v[86:87], v[88:91]
    s_nop 4
    v_cvt_pk_bf16_f32 v88, v88, v89
    v_cvt_pk_bf16_f32 v89, v90, v91
    ds_pk_add_bf16 v7, v88
    ds_pk_add_bf16 v7, v89 offset:4
    s_mov_b64 exec, vcc
    s_branch L2_d105
L2_c106:
    s_mov_b64 exec, s[82:83]
    s_nop 1
    v_mfma_f32_4x4x4_16b_bf16 v[88:91], v[12:13], v[84:85], 0
    s_nop 1
    v_mfma_f32_4x4x4_16b_bf16 v[88:91], v[10:11], v[86:87], v[88:91]
    s_nop 4
    v_cvt_pk_bf16_f32 v88, v88, v89
    v_cvt_pk_bf16_f32 v89, v90, v91
    ds_pk_add_bf16 v7, v88
    ds_pk_add_bf16 v7, v89 offset:4
    s_mov_b64 exec, vcc
    s_branch L2_d106
L2_c107:
    s_mov_b64 exec, s[82:83]
    s_nop 1
    v_mfma_f32_4x4x4_16b_bf16 v[88:91], v[12:13], v[84:85], 0
    s_nop 1
    v_mfma_f32_4x4x4_16b_bf16 v[88:91], v[10:11], v[86:87], v[88:91]
    s_nop 4
    v_cvt_pk_bf16_f32 v88, v88, v89
    v_cvt_pk_bf16_f32 v89, v90, v91
    ds_pk_add_bf16 v7, v88
    ds_pk_add_bf16 v7, v89 offset:4
    s_mov_b64 exec, vcc
    s_branch L2_d107
L2_xa108:
    s_cmp_eq_u32 s43, 1
    s_cbranch_scc1 L2_xc108
    v_lshlrev_b32 v89, 0, v96
    v_add_u32 v90, 140, v97
    v_bitop3_b32 v90, v89, v45, v90 bitop3:0x6a
    ds_write_b32 v98, v90 offset:28
    v_lshlrev_b32 v89, 4, v96
    v_add_u32 v90, 120, v97
    v_bitop3_b32 v90, v89, v45, v90 bitop3:0x6a
    ds_write_b32 v98, v90 offset:24
    v_lshlrev_b32 v89, 8, v96
    v_add_u32 v90, 100, v97
    v_bitop3_b32 v90, v89, v45, v90 bitop3:0x6a
    ds_write_b32 v98, v90 offset:20
L2_xc108:
    v_lshlrev_b32 v89, 12, v96
    v_add_u32 v90, 80, v97
    v_bitop3_b32 v90, v89, v45, v90 bitop3:0x6a
    ds_write_b32 v98, v90 offset:16
    s_branch L2_xb108
L2_xe108:
    v_cmp_lt_u32 vcc, 32, v99
    v_cmp_lt_u32 s[58:59], 31, v88
    v_lshrrev_b32 v89, 16, v96
    v_add_u32 v97, 80, v97
    s_or_b64 vcc, vcc, s[58:59]
    s_cbranch_scc1 L2_xs108
    v_lshlrev_b32 v89, v1, v89
    v_and_b32 v89, v45, v89
    v_cmp_ne_u32 vcc, 0, v89
    v_xor_b32 v90, v97, v89
    s_add_u32 s3, s37, s38
    v_mbcnt_lo_u32_b32 v98, vcc_lo, 0
    v_mbcnt_hi_u32_b32 v98, vcc_hi, v98
    s_bcnt1_i32_b64 s41, vcc
    v_lshl_add_u32 v98, v98, 2, s3
    s_mov_b64 exec, vcc
    ds_write_b32 v98, v90
    s_mov_b64 exec, -1
    s_lshl2_add_u32 s37, s41, s37
    s_branch L2_xr108
L2_xf108:
    s_waitcnt lgkmcnt(0)
    s_cmp_gt_u32 s37, 1024
    s_cbranch_scc1 L2_xs108
    v_mov_b32 v43, -1
    s_cmp_ge_u32 s37, 512
    s_cbranch_scc1 L2_xg108
    v_mov_b32 v42, -1
    s_cmp_ge_u32 s37, 256
    s_cbranch_scc1 L2_xg108
    v_mov_b32 v41, -1
    s_branch L2_xg108
L2_xs108:
    s_waitcnt lgkmcnt(0)
    v_mov_b32 v40, -1
    v_mov_b32 v41, -1
    v_mov_b32 v42, -1
    v_mov_b32 v43, -1
    s_add_u32 s3, s42, 2
    s_bitset1_b32 s36, s3
    s_branch L2_xg108
L2_c109:
    s_mov_b64 exec, s[82:83]
    s_nop 1
    v_mfma_f32_4x4x4_16b_bf16 v[88:91], v[12:13], v[84:85], 0
    s_nop 1
    v_mfma_f32_4x4x4_16b_bf16 v[88:91], v[10:11], v[86:87], v[88:91]
    s_nop 4
    v_cvt_pk_bf16_f32 v88, v88, v89
    v_cvt_pk_bf16_f32 v89, v90, v91
    ds_pk_add_bf16 v7, v88
    ds_pk_add_bf16 v7, v89 offset:4
    s_mov_b64 exec, vcc
    s_branch L2_d109
L2_c110:
    s_mov_b64 exec, s[82:83]
    s_nop 1
    v_mfma_f32_4x4x4_16b_bf16 v[88:91], v[12:13], v[84:85], 0
    s_nop 1
    v_mfma_f32_4x4x4_16b_bf16 v[88:91], v[10:11], v[86:87], v[88:91]
    s_nop 4
    v_cvt_pk_bf16_f32 v88, v88, v89
    v_cvt_pk_bf16_f32 v89, v90, v91
    ds_pk_add_bf16 v7, v88
    ds_pk_add_bf16 v7, v89 offset:4
    s_mov_b64 exec, vcc
    s_branch L2_d110
L2_c111:
    s_mov_b64 exec, s[82:83]
    s_nop 1
    v_mfma_f32_4x4x4_16b_bf16 v[88:91], v[12:13], v[84:85], 0
    s_nop 1
    v_mfma_f32_4x4x4_16b_bf16 v[88:91], v[10:11], v[86:87], v[88:91]
    s_nop 4
    v_cvt_pk_bf16_f32 v88, v88, v89
    v_cvt_pk_bf16_f32 v89, v90, v91
    ds_pk_add_bf16 v7, v88
    ds_pk_add_bf16 v7, v89 offset:4
    s_mov_b64 exec, vcc
    s_branch L2_d111
L2_c112:
    s_mov_b64 exec, s[82:83]
    s_nop 1
    v_mfma_f32_4x4x4_16b_bf16 v[88:91], v[12:13], v[84:85], 0
    s_nop 1
    v_mfma_f32_4x4x4_16b_bf16 v[88:91], v[10:11], v[86:87], v[88:91]
    s_nop 4
    v_cvt_pk_bf16_f32 v88, v88, v89
    v_cvt_pk_bf16_f32 v89, v90, v91
    ds_pk_add_bf16 v7, v88
    ds_pk_add_bf16 v7, v89 offset:4
    s_mov_b64 exec, vcc
    s_branch L2_d112
L2_c113:
    s_mov_b64 exec, s[82:83]
    s_nop 1
    v_mfma_f32_4x4x4_16b_bf16 v[88:91], v[12:13], v[84:85], 0
    s_nop 1
    v_mfma_f32_4x4x4_16b_bf16 v[88:91], v[10:11], v[86:87], v[88:91]
    s_nop 4
    v_cvt_pk_bf16_f32 v88, v88, v89
    v_cvt_pk_bf16_f32 v89, v90, v91
    ds_pk_add_bf16 v7, v88
    ds_pk_add_bf16 v7, v89 offset:4
    s_mov_b64 exec, vcc
    s_branch L2_d113
L2_c114:
    s_mov_b64 exec, s[82:83]
    s_nop 1
    v_mfma_f32_4x4x4_16b_bf16 v[88:91], v[12:13], v[84:85], 0
    s_nop 1
    v_mfma_f32_4x4x4_16b_bf16 v[88:91], v[10:11], v[86:87], v[88:91]
    s_nop 4
    v_cvt_pk_bf16_f32 v88, v88, v89
    v_cvt_pk_bf16_f32 v89, v90, v91
    ds_pk_add_bf16 v7, v88
    ds_pk_add_bf16 v7, v89 offset:4
    s_mov_b64 exec, vcc
    s_branch L2_d114
L2_c115:
    s_mov_b64 exec, s[82:83]
    s_nop 1
    v_mfma_f32_4x4x4_16b_bf16 v[88:91], v[12:13], v[84:85], 0
    s_nop 1
    v_mfma_f32_4x4x4_16b_bf16 v[88:91], v[10:11], v[86:87], v[88:91]
    s_nop 4
    v_cvt_pk_bf16_f32 v88, v88, v89
    v_cvt_pk_bf16_f32 v89, v90, v91
    ds_pk_add_bf16 v7, v88
    ds_pk_add_bf16 v7, v89 offset:4
    s_mov_b64 exec, vcc
    s_branch L2_d115
L2_c116:
    s_mov_b64 exec, s[82:83]
    s_nop 1
    v_mfma_f32_4x4x4_16b_bf16 v[88:91], v[12:13], v[84:85], 0
    s_nop 1
    v_mfma_f32_4x4x4_16b_bf16 v[88:91], v[10:11], v[86:87], v[88:91]
    s_nop 4
    v_cvt_pk_bf16_f32 v88, v88, v89
    v_cvt_pk_bf16_f32 v89, v90, v91
    ds_pk_add_bf16 v7, v88
    ds_pk_add_bf16 v7, v89 offset:4
    s_mov_b64 exec, vcc
    s_branch L2_d116
L2_c117:
    s_mov_b64 exec, s[82:83]
    s_nop 1
    v_mfma_f32_4x4x4_16b_bf16 v[88:91], v[12:13], v[84:85], 0
    s_nop 1
    v_mfma_f32_4x4x4_16b_bf16 v[88:91], v[10:11], v[86:87], v[88:91]
    s_nop 4
    v_cvt_pk_bf16_f32 v88, v88, v89
    v_cvt_pk_bf16_f32 v89, v90, v91
    ds_pk_add_bf16 v7, v88
    ds_pk_add_bf16 v7, v89 offset:4
    s_mov_b64 exec, vcc
    s_branch L2_d117
L2_c118:
    s_mov_b64 exec, s[82:83]
    s_nop 1
    v_mfma_f32_4x4x4_16b_bf16 v[88:91], v[12:13], v[84:85], 0
    s_nop 1
    v_mfma_f32_4x4x4_16b_bf16 v[88:91], v[10:11], v[86:87], v[88:91]
    s_nop 4
    v_cvt_pk_bf16_f32 v88, v88, v89
    v_cvt_pk_bf16_f32 v89, v90, v91
    ds_pk_add_bf16 v7, v88
    ds_pk_add_bf16 v7, v89 offset:4
    s_mov_b64 exec, vcc
    s_branch L2_d118
L2_c119:
    s_mov_b64 exec, s[82:83]
    s_nop 1
    v_mfma_f32_4x4x4_16b_bf16 v[88:91], v[12:13], v[84:85], 0
    s_nop 1
    v_mfma_f32_4x4x4_16b_bf16 v[88:91], v[10:11], v[86:87], v[88:91]
    s_nop 4
    v_cvt_pk_bf16_f32 v88, v88, v89
    v_cvt_pk_bf16_f32 v89, v90, v91
    ds_pk_add_bf16 v7, v88
    ds_pk_add_bf16 v7, v89 offset:4
    s_mov_b64 exec, vcc
    s_branch L2_d119
L2_c120:
    s_mov_b64 exec, s[82:83]
    s_nop 1
    v_mfma_f32_4x4x4_16b_bf16 v[88:91], v[12:13], v[84:85], 0
    s_nop 1
    v_mfma_f32_4x4x4_16b_bf16 v[88:91], v[10:11], v[86:87], v[88:91]
    s_nop 4
    v_cvt_pk_bf16_f32 v88, v88, v89
    v_cvt_pk_bf16_f32 v89, v90, v91
    ds_pk_add_bf16 v7, v88
    ds_pk_add_bf16 v7, v89 offset:4
    s_mov_b64 exec, vcc
    s_branch L2_d120
L2_c121:
    s_mov_b64 exec, s[82:83]
    s_nop 1
    v_mfma_f32_4x4x4_16b_bf16 v[88:91], v[12:13], v[84:85], 0
    s_nop 1
    v_mfma_f32_4x4x4_16b_bf16 v[88:91], v[10:11], v[86:87], v[88:91]
    s_nop 4
    v_cvt_pk_bf16_f32 v88, v88, v89
    v_cvt_pk_bf16_f32 v89, v90, v91
    ds_pk_add_bf16 v7, v88
    ds_pk_add_bf16 v7, v89 offset:4
    s_mov_b64 exec, vcc
    s_branch L2_d121
L2_c122:
    s_mov_b64 exec, s[82:83]
    s_nop 1
    v_mfma_f32_4x4x4_16b_bf16 v[88:91], v[12:13], v[84:85], 0
    s_nop 1
    v_mfma_f32_4x4x4_16b_bf16 v[88:91], v[10:11], v[86:87], v[88:91]
    s_nop 4
    v_cvt_pk_bf16_f32 v88, v88, v89
    v_cvt_pk_bf16_f32 v89, v90, v91
    ds_pk_add_bf16 v7, v88
    ds_pk_add_bf16 v7, v89 offset:4
    s_mov_b64 exec, vcc
    s_branch L2_d122
L2_c123:
    s_mov_b64 exec, s[82:83]
    s_nop 1
    v_mfma_f32_4x4x4_16b_bf16 v[88:91], v[12:13], v[84:85], 0
    s_nop 1
    v_mfma_f32_4x4x4_16b_bf16 v[88:91], v[10:11], v[86:87], v[88:91]
    s_nop 4
    v_cvt_pk_bf16_f32 v88, v88, v89
    v_cvt_pk_bf16_f32 v89, v90, v91
    ds_pk_add_bf16 v7, v88
    ds_pk_add_bf16 v7, v89 offset:4
    s_mov_b64 exec, vcc
    s_branch L2_d123
L2_c124:
    s_mov_b64 exec, s[82:83]
    s_nop 1
    v_mfma_f32_4x4x4_16b_bf16 v[88:91], v[12:13], v[84:85], 0
    s_nop 1
    v_mfma_f32_4x4x4_16b_bf16 v[88:91], v[10:11], v[86:87], v[88:91]
    s_nop 4
    v_cvt_pk_bf16_f32 v88, v88, v89
    v_cvt_pk_bf16_f32 v89, v90, v91
    ds_pk_add_bf16 v7, v88
    ds_pk_add_bf16 v7, v89 offset:4
    s_mov_b64 exec, vcc
    s_branch L2_d124
L2_c125:
    s_mov_b64 exec, s[82:83]
    s_nop 1
    v_mfma_f32_4x4x4_16b_bf16 v[88:91], v[12:13], v[84:85], 0
    s_nop 1
    v_mfma_f32_4x4x4_16b_bf16 v[88:91], v[10:11], v[86:87], v[88:91]
    s_nop 4
    v_cvt_pk_bf16_f32 v88, v88, v89
    v_cvt_pk_bf16_f32 v89, v90, v91
    ds_pk_add_bf16 v7, v88
    ds_pk_add_bf16 v7, v89 offset:4
    s_mov_b64 exec, vcc
    s_branch L2_d125
L2_c126:
    s_mov_b64 exec, s[82:83]
    s_nop 1
    v_mfma_f32_4x4x4_16b_bf16 v[88:91], v[12:13], v[84:85], 0
    s_nop 1
    v_mfma_f32_4x4x4_16b_bf16 v[88:91], v[10:11], v[86:87], v[88:91]
    s_nop 4
    v_cvt_pk_bf16_f32 v88, v88, v89
    v_cvt_pk_bf16_f32 v89, v90, v91
    ds_pk_add_bf16 v7, v88
    ds_pk_add_bf16 v7, v89 offset:4
    s_mov_b64 exec, vcc
    s_branch L2_d126
L2_c127:
    s_mov_b64 exec, s[82:83]
    s_nop 1
    v_mfma_f32_4x4x4_16b_bf16 v[88:91], v[12:13], v[84:85], 0
    s_nop 1
    v_mfma_f32_4x4x4_16b_bf16 v[88:91], v[10:11], v[86:87], v[88:91]
    s_nop 4
    v_cvt_pk_bf16_f32 v88, v88, v89
    v_cvt_pk_bf16_f32 v89, v90, v91
    ds_pk_add_bf16 v7, v88
    ds_pk_add_bf16 v7, v89 offset:4
    s_mov_b64 exec, vcc
    s_branch L2_d127
L2_c128:
    s_mov_b64 exec, s[82:83]
    s_nop 1
    v_mfma_f32_4x4x4_16b_bf16 v[88:91], v[12:13], v[84:85], 0
    s_nop 1
    v_mfma_f32_4x4x4_16b_bf16 v[88:91], v[10:11], v[86:87], v[88:91]
    s_nop 4
    v_cvt_pk_bf16_f32 v88, v88, v89
    v_cvt_pk_bf16_f32 v89, v90, v91
    ds_pk_add_bf16 v7, v88
    ds_pk_add_bf16 v7, v89 offset:4
    s_mov_b64 exec, vcc
    s_branch L2_d128
L2_c129:
    s_mov_b64 exec, s[82:83]
    s_nop 1
    v_mfma_f32_4x4x4_16b_bf16 v[88:91], v[12:13], v[84:85], 0
    s_nop 1
    v_mfma_f32_4x4x4_16b_bf16 v[88:91], v[10:11], v[86:87], v[88:91]
    s_nop 4
    v_cvt_pk_bf16_f32 v88, v88, v89
    v_cvt_pk_bf16_f32 v89, v90, v91
    ds_pk_add_bf16 v7, v88
    ds_pk_add_bf16 v7, v89 offset:4
    s_mov_b64 exec, vcc
    s_branch L2_d129
L2_c130:
    s_mov_b64 exec, s[82:83]
    s_nop 1
    v_mfma_f32_4x4x4_16b_bf16 v[88:91], v[12:13], v[84:85], 0
    s_nop 1
    v_mfma_f32_4x4x4_16b_bf16 v[88:91], v[10:11], v[86:87], v[88:91]
    s_nop 4
    v_cvt_pk_bf16_f32 v88, v88, v89
    v_cvt_pk_bf16_f32 v89, v90, v91
    ds_pk_add_bf16 v7, v88
    ds_pk_add_bf16 v7, v89 offset:4
    s_mov_b64 exec, vcc
    s_branch L2_d130
L2_c131:
    s_mov_b64 exec, s[82:83]
    s_nop 1
    v_mfma_f32_4x4x4_16b_bf16 v[88:91], v[12:13], v[84:85], 0
    s_nop 1
    v_mfma_f32_4x4x4_16b_bf16 v[88:91], v[10:11], v[86:87], v[88:91]
    s_nop 4
    v_cvt_pk_bf16_f32 v88, v88, v89
    v_cvt_pk_bf16_f32 v89, v90, v91
    ds_pk_add_bf16 v7, v88
    ds_pk_add_bf16 v7, v89 offset:4
    s_mov_b64 exec, vcc
    s_branch L2_d131
L2_c132:
    s_mov_b64 exec, s[82:83]
    s_nop 1
    v_mfma_f32_4x4x4_16b_bf16 v[88:91], v[12:13], v[84:85], 0
    s_nop 1
    v_mfma_f32_4x4x4_16b_bf16 v[88:91], v[10:11], v[86:87], v[88:91]
    s_nop 4
    v_cvt_pk_bf16_f32 v88, v88, v89
    v_cvt_pk_bf16_f32 v89, v90, v91
    ds_pk_add_bf16 v7, v88
    ds_pk_add_bf16 v7, v89 offset:4
    s_mov_b64 exec, vcc
    s_branch L2_d132
L2_c133:
    s_mov_b64 exec, s[82:83]
    s_nop 1
    v_mfma_f32_4x4x4_16b_bf16 v[88:91], v[12:13], v[84:85], 0
    s_nop 1
    v_mfma_f32_4x4x4_16b_bf16 v[88:91], v[10:11], v[86:87], v[88:91]
    s_nop 4
    v_cvt_pk_bf16_f32 v88, v88, v89
    v_cvt_pk_bf16_f32 v89, v90, v91
    ds_pk_add_bf16 v7, v88
    ds_pk_add_bf16 v7, v89 offset:4
    s_mov_b64 exec, vcc
    s_branch L2_d133
L2_c134:
    s_mov_b64 exec, s[82:83]
    s_nop 1
    v_mfma_f32_4x4x4_16b_bf16 v[88:91], v[12:13], v[84:85], 0
    s_nop 1
    v_mfma_f32_4x4x4_16b_bf16 v[88:91], v[10:11], v[86:87], v[88:91]
    s_nop 4
    v_cvt_pk_bf16_f32 v88, v88, v89
    v_cvt_pk_bf16_f32 v89, v90, v91
    ds_pk_add_bf16 v7, v88
    ds_pk_add_bf16 v7, v89 offset:4
    s_mov_b64 exec, vcc
    s_branch L2_d134
L2_c135:
    s_mov_b64 exec, s[82:83]
    s_nop 1
    v_mfma_f32_4x4x4_16b_bf16 v[88:91], v[12:13], v[84:85], 0
    s_nop 1
    v_mfma_f32_4x4x4_16b_bf16 v[88:91], v[10:11], v[86:87], v[88:91]
    s_nop 4
    v_cvt_pk_bf16_f32 v88, v88, v89
    v_cvt_pk_bf16_f32 v89, v90, v91
    ds_pk_add_bf16 v7, v88
    ds_pk_add_bf16 v7, v89 offset:4
    s_mov_b64 exec, vcc
    s_branch L2_d135
L2_c136:
    s_mov_b64 exec, s[82:83]
    s_nop 1
    v_mfma_f32_4x4x4_16b_bf16 v[88:91], v[12:13], v[84:85], 0
    s_nop 1
    v_mfma_f32_4x4x4_16b_bf16 v[88:91], v[10:11], v[86:87], v[88:91]
    s_nop 4
    v_cvt_pk_bf16_f32 v88, v88, v89
    v_cvt_pk_bf16_f32 v89, v90, v91
    ds_pk_add_bf16 v7, v88
    ds_pk_add_bf16 v7, v89 offset:4
    s_mov_b64 exec, vcc
    s_branch L2_d136
L2_c137:
    s_mov_b64 exec, s[82:83]
    s_nop 1
    v_mfma_f32_4x4x4_16b_bf16 v[88:91], v[12:13], v[84:85], 0
    s_nop 1
    v_mfma_f32_4x4x4_16b_bf16 v[88:91], v[10:11], v[86:87], v[88:91]
    s_nop 4
    v_cvt_pk_bf16_f32 v88, v88, v89
    v_cvt_pk_bf16_f32 v89, v90, v91
    ds_pk_add_bf16 v7, v88
    ds_pk_add_bf16 v7, v89 offset:4
    s_mov_b64 exec, vcc
    s_branch L2_d137
L2_c138:
    s_mov_b64 exec, s[82:83]
    s_nop 1
    v_mfma_f32_4x4x4_16b_bf16 v[88:91], v[12:13], v[84:85], 0
    s_nop 1
    v_mfma_f32_4x4x4_16b_bf16 v[88:91], v[10:11], v[86:87], v[88:91]
    s_nop 4
    v_cvt_pk_bf16_f32 v88, v88, v89
    v_cvt_pk_bf16_f32 v89, v90, v91
    ds_pk_add_bf16 v7, v88
    ds_pk_add_bf16 v7, v89 offset:4
    s_mov_b64 exec, vcc
    s_branch L2_d138
L2_c139:
    s_mov_b64 exec, s[82:83]
    s_nop 1
    v_mfma_f32_4x4x4_16b_bf16 v[88:91], v[12:13], v[84:85], 0
    s_nop 1
    v_mfma_f32_4x4x4_16b_bf16 v[88:91], v[10:11], v[86:87], v[88:91]
    s_nop 4
    v_cvt_pk_bf16_f32 v88, v88, v89
    v_cvt_pk_bf16_f32 v89, v90, v91
    ds_pk_add_bf16 v7, v88
    ds_pk_add_bf16 v7, v89 offset:4
    s_mov_b64 exec, vcc
    s_branch L2_d139
L2_c140:
    s_mov_b64 exec, s[82:83]
    s_nop 1
    v_mfma_f32_4x4x4_16b_bf16 v[88:91], v[12:13], v[84:85], 0
    s_nop 1
    v_mfma_f32_4x4x4_16b_bf16 v[88:91], v[10:11], v[86:87], v[88:91]
    s_nop 4
    v_cvt_pk_bf16_f32 v88, v88, v89
    v_cvt_pk_bf16_f32 v89, v90, v91
    ds_pk_add_bf16 v7, v88
    ds_pk_add_bf16 v7, v89 offset:4
    s_mov_b64 exec, vcc
    s_branch L2_d140
L2_c141:
    s_mov_b64 exec, s[82:83]
    s_nop 1
    v_mfma_f32_4x4x4_16b_bf16 v[88:91], v[12:13], v[84:85], 0
    s_nop 1
    v_mfma_f32_4x4x4_16b_bf16 v[88:91], v[10:11], v[86:87], v[88:91]
    s_nop 4
    v_cvt_pk_bf16_f32 v88, v88, v89
    v_cvt_pk_bf16_f32 v89, v90, v91
    ds_pk_add_bf16 v7, v88
    ds_pk_add_bf16 v7, v89 offset:4
    s_mov_b64 exec, vcc
    s_branch L2_d141
L2_c142:
    s_mov_b64 exec, s[82:83]
    s_nop 1
    v_mfma_f32_4x4x4_16b_bf16 v[88:91], v[12:13], v[84:85], 0
    s_nop 1
    v_mfma_f32_4x4x4_16b_bf16 v[88:91], v[10:11], v[86:87], v[88:91]
    s_nop 4
    v_cvt_pk_bf16_f32 v88, v88, v89
    v_cvt_pk_bf16_f32 v89, v90, v91
    ds_pk_add_bf16 v7, v88
    ds_pk_add_bf16 v7, v89 offset:4
    s_mov_b64 exec, vcc
    s_branch L2_d142
L2_c143:
    s_mov_b64 exec, s[82:83]
    s_nop 1
    v_mfma_f32_4x4x4_16b_bf16 v[88:91], v[12:13], v[84:85], 0
    s_nop 1
    v_mfma_f32_4x4x4_16b_bf16 v[88:91], v[10:11], v[86:87], v[88:91]
    s_nop 4
    v_cvt_pk_bf16_f32 v88, v88, v89
    v_cvt_pk_bf16_f32 v89, v90, v91
    ds_pk_add_bf16 v7, v88
    ds_pk_add_bf16 v7, v89 offset:4
    s_mov_b64 exec, vcc
    s_branch L2_d143
L2_c144:
    s_mov_b64 exec, s[82:83]
    s_nop 1
    v_mfma_f32_4x4x4_16b_bf16 v[88:91], v[12:13], v[84:85], 0
    s_nop 1
    v_mfma_f32_4x4x4_16b_bf16 v[88:91], v[10:11], v[86:87], v[88:91]
    s_nop 4
    v_cvt_pk_bf16_f32 v88, v88, v89
    v_cvt_pk_bf16_f32 v89, v90, v91
    ds_pk_add_bf16 v7, v88
    ds_pk_add_bf16 v7, v89 offset:4
    s_mov_b64 exec, vcc
    s_branch L2_d144
L2_c145:
    s_mov_b64 exec, s[82:83]
    s_nop 1
    v_mfma_f32_4x4x4_16b_bf16 v[88:91], v[12:13], v[84:85], 0
    s_nop 1
    v_mfma_f32_4x4x4_16b_bf16 v[88:91], v[10:11], v[86:87], v[88:91]
    s_nop 4
    v_cvt_pk_bf16_f32 v88, v88, v89
    v_cvt_pk_bf16_f32 v89, v90, v91
    ds_pk_add_bf16 v7, v88
    ds_pk_add_bf16 v7, v89 offset:4
    s_mov_b64 exec, vcc
    s_branch L2_d145
L2_c146:
    s_mov_b64 exec, s[82:83]
    s_nop 1
    v_mfma_f32_4x4x4_16b_bf16 v[88:91], v[12:13], v[84:85], 0
    s_nop 1
    v_mfma_f32_4x4x4_16b_bf16 v[88:91], v[10:11], v[86:87], v[88:91]
    s_nop 4
    v_cvt_pk_bf16_f32 v88, v88, v89
    v_cvt_pk_bf16_f32 v89, v90, v91
    ds_pk_add_bf16 v7, v88
    ds_pk_add_bf16 v7, v89 offset:4
    s_mov_b64 exec, vcc
    s_branch L2_d146
.section .rodata,"a"
.p2align 6
.amdhsa_kernel gs_sort_kernel
  .amdhsa_next_free_vgpr 128
  .amdhsa_next_free_sgpr 96
  .amdhsa_accum_offset 128
  .amdhsa_group_segment_fixed_size 0
  .amdhsa_kernarg_size 112
  .amdhsa_user_sgpr_count 2
  .amdhsa_user_sgpr_kernarg_segment_ptr 1
  .amdhsa_system_sgpr_workgroup_id_x 1
  .amdhsa_float_denorm_mode_32 3
.end_amdhsa_kernel
.p2align 6
.amdhsa_kernel gs_acc_kernel
  .amdhsa_next_free_vgpr 128
  .amdhsa_next_free_sgpr 100
  .amdhsa_accum_offset 128
  .amdhsa_group_segment_fixed_size 0
  .amdhsa_kernarg_size 112
  .amdhsa_user_sgpr_count 2
  .amdhsa_user_sgpr_kernarg_segment_ptr 1
  .amdhsa_system_sgpr_workgroup_id_x 1
  .amdhsa_float_denorm_mode_32 3
.end_amdhsa_kernel
```

```asm
; @launch kernel=gs_sort_kernel grid=(256,1,1) block=(1024,1,1) lds=163840
; @launch kernel=gs_acc_kernel grid=(256,1,1) block=(1024,1,1) lds=163840
.amdgcn_target "amdgcn-amd-amdhsa--gfx950"
.text
.globl gs_sort_kernel
.p2align 8
.type gs_sort_kernel,@function
gs_sort_kernel:
    s_cmp_ge_u32 s2, 256
    s_cbranch_scc1 L1_end
    s_load_dwordx4 s[4:7], s[0:1], 8
    s_load_dwordx2 s[28:29], s[0:1], 32
    s_load_dwordx2 s[30:31], s[0:1], 104
    s_load_dwordx2 s[56:57], s[0:1], 96
    s_load_dwordx2 s[86:87], s[0:1], 0
    s_load_dwordx4 s[60:63], s[0:1], 56
    s_load_dwordx4 s[64:67], s[0:1], 72
    v_lshrrev_b32 v7, 6, v0
    v_lshlrev_b32 v1, 3, v0
    v_readfirstlane_b32 s32, v7
    v_lshlrev_b32 v0, 4, v0
    s_mul_i32 s33, s2, 16384
    s_mul_i32 s34, s2, 8192
    s_waitcnt lgkmcnt(0)
    s_mov_b32 s8, s4
    s_mov_b32 s9, s5
    s_mov_b32 s10, 0x9c40000
    s_mov_b32 s11, 0x20000
    s_mov_b32 s12, s6
    s_mov_b32 s13, s7
    s_mov_b32 s14, 0x9c40000
    s_mov_b32 s15, 0x20000
    s_mov_b32 s16, s28
    s_mov_b32 s17, s29
    s_mov_b32 s18, 0x4e20000
    s_mov_b32 s19, 0x20000
    s_add_u32 s44, s33, 0x0
    buffer_load_dwordx4 v[16:19], v0, s[8:11], s44 offen nt
    s_add_u32 s45, s33, 0x0
    buffer_load_dwordx4 v[20:23], v0, s[12:15], s45 offen nt
    s_add_u32 s46, s34, 0x0
    buffer_load_dwordx2 v[24:25], v1, s[16:19], s46 offen nt
    s_add_u32 s47, s34, 0x200000
    buffer_load_dwordx2 v[26:27], v1, s[16:19], s47 offen nt
    s_add_u32 s44, s33, 0x400000
    buffer_load_dwordx4 v[28:31], v0, s[8:11], s44 offen nt
    s_add_u32 s45, s33, 0x400000
    buffer_load_dwordx4 v[32:35], v0, s[12:15], s45 offen nt
    s_add_u32 s46, s33, 0x800000
    buffer_load_dwordx4 v[36:39], v0, s[8:11], s46 offen nt
    s_add_u32 s47, s33, 0x800000
    buffer_load_dwordx4 v[40:43], v0, s[12:15], s47 offen nt
    s_add_u32 s44, s34, 0x400000
    buffer_load_dwordx2 v[44:45], v1, s[16:19], s44 offen nt
    s_add_u32 s45, s34, 0x600000
    buffer_load_dwordx2 v[46:47], v1, s[16:19], s45 offen nt
    s_mov_b32 s68, s62
    s_mov_b32 s69, s63
    s_mov_b32 s70, 0x40
    s_mov_b32 s71, 0x20000
    s_mov_b32 s72, s60
    s_mov_b32 s73, s61
    s_mov_b32 s74, 0x40
    s_mov_b32 s75, 0x20000
    s_mov_b32 s20, s66
    s_mov_b32 s21, s67
    s_mov_b32 s22, 0x20
    s_mov_b32 s23, 0x20000
    s_mov_b32 s80, s64
    s_mov_b32 s81, s65
    s_mov_b32 s82, 0x20
    s_mov_b32 s83, 0x20000
    s_add_u32 s24, s30, 0xebab000
    s_addc_u32 s25, s31, 0
    s_mov_b32 s26, 0x100
    s_mov_b32 s27, 0x20000
    v_lshrrev_b32 v2, 3, v0
    v_and_b32 v2, 6, v2
    v_lshlrev_b32 v3, 2, v0
    s_lshl_b32 s3, s32, 8
    s_add_u32 s3, s3, s2
    s_cmp_lg_u32 s3, 254
    s_cbranch_scc1 L1_wt
    buffer_load_ushort v96, v2, s[68:71], 0 offen offset:0
    buffer_load_ushort v108, v2, s[68:71], 0 offen offset:8
    buffer_load_ushort v97, v2, s[68:71], 0 offen offset:16
    buffer_load_ushort v109, v2, s[68:71], 0 offen offset:24
    buffer_load_ushort v98, v2, s[68:71], 0 offen offset:32
    buffer_load_ushort v110, v2, s[68:71], 0 offen offset:40
    buffer_load_ushort v99, v2, s[68:71], 0 offen offset:48
    buffer_load_ushort v111, v2, s[68:71], 0 offen offset:56
    buffer_load_ushort v100, v2, s[72:75], 0 offen offset:0
    buffer_load_ushort v112, v2, s[72:75], 0 offen offset:8
    buffer_load_ushort v101, v2, s[72:75], 0 offen offset:16
    buffer_load_ushort v113, v2, s[72:75], 0 offen offset:24
    buffer_load_ushort v102, v2, s[72:75], 0 offen offset:32
    buffer_load_ushort v114, v2, s[72:75], 0 offen offset:40
    buffer_load_ushort v103, v2, s[72:75], 0 offen offset:48
    buffer_load_ushort v115, v2, s[72:75], 0 offen offset:56
    buffer_load_ushort v104, v2, s[20:23], 0 offen offset:0
    buffer_load_ushort v116, v2, s[20:23], 0 offen offset:8
    buffer_load_ushort v105, v2, s[20:23], 0 offen offset:16
    buffer_load_ushort v117, v2, s[20:23], 0 offen offset:24
    buffer_load_ushort v106, v2, s[80:83], 0 offen offset:0
    buffer_load_ushort v118, v2, s[80:83], 0 offen offset:8
    buffer_load_ushort v107, v2, s[80:83], 0 offen offset:16
    buffer_load_ushort v119, v2, s[80:83], 0 offen offset:24
    s_waitcnt vmcnt(0)
    v_lshl_or_b32 v96, v108, 16, v96
    v_lshl_or_b32 v97, v109, 16, v97
    v_lshl_or_b32 v98, v110, 16, v98
    v_lshl_or_b32 v99, v111, 16, v99
    v_lshl_or_b32 v100, v112, 16, v100
    v_lshl_or_b32 v101, v113, 16, v101
    v_lshl_or_b32 v102, v114, 16, v102
    v_lshl_or_b32 v103, v115, 16, v103
    v_lshl_or_b32 v104, v116, 16, v104
    v_lshl_or_b32 v105, v117, 16, v105
    v_lshl_or_b32 v106, v118, 16, v106
    v_lshl_or_b32 v107, v119, 16, v107
    buffer_store_dwordx4 v[96:99], v3, s[24:27], 0 offen offset:0
    buffer_store_dwordx4 v[100:103], v3, s[24:27], 0 offen offset:16
    buffer_store_dwordx4 v[104:107], v3, s[24:27], 0 offen offset:32
L1_wt:
    s_mov_b32 s20, s30
    s_mov_b32 s21, s31
    s_mov_b32 s22, 0xd340000
    s_mov_b32 s23, 0x20000
    s_add_u32 s24, s30, 0x28000
    s_addc_u32 s25, s31, 0
    s_mov_b32 s26, 0xd318000
    s_mov_b32 s27, 0x20000
    s_mov_b32 s80, s86
    s_mov_b32 s81, s87
    s_mov_b32 s82, 0x4e20
    s_mov_b32 s83, 0x20000
    s_mul_i32 s3, s2, 20000
    s_add_u32 s80, s80, s3
    s_addc_u32 s81, s81, 0
    s_mul_i32 s35, s2, 173056
    s_and_b32 s37, s32, 3
    s_lshl_b32 s37, s37, 3
    s_add_u32 s36, s35, s37
    s_lshr_b32 s37, s32, 2
    s_mul_i32 s37, s37, 2080
    s_add_u32 s36, s36, s37
    s_and_b32 s37, s2, 3
    s_lshl_b32 s37, s37, 5
    s_add_u32 s36, s36, s37
    s_mul_i32 s4, s2, 5
    s_add_u32 s4, s4, 8192
    s_lshl_b32 s38, s4, 14
    s_lshl_b32 s39, s4, 13
    v_mov_b32 v2, 1
    v_mov_b32 v4, 0x80000007
    v_mov_b32 v5, 0xfc
    v_mov_b32 v6, 0x78
    s_mov_b32 s40, 2048
    s_mov_b32 s55, -10000
    s_mov_b32 s41, 0x010c0c01
    s_mov_b32 s42, 0x030c0c03
    v_mov_b32 v8, 0
    v_mov_b32 v9, 0
    v_mov_b32 v10, 0
    v_mov_b32 v11, 0
    ds_write_b128 v0, v[8:11]
    s_add_u32 s68, s30, 0xebac000
    s_addc_u32 s69, s31, 0
    s_mov_b32 s70, 0x80
    s_mov_b32 s71, 0x20000
    s_lshl_b32 s3, s2, 7
    s_add_u32 s68, s68, s3
    s_addc_u32 s69, s69, 0
    s_cmp_lg_u32 s32, 0
    s_cbranch_scc1 L1_fl
    buffer_store_dwordx4 v[8:11], v0, s[68:71], 0 offen sc1
L1_fl:
    s_waitcnt lgkmcnt(0)
    s_barrier
    s_add_u32 s46, s33, 0xc00000
    buffer_load_dwordx4 v[48:51], v0, s[8:11], s46 offen nt
    s_add_u32 s47, s33, 0xc00000
    buffer_load_dwordx4 v[52:55], v0, s[12:15], s47 offen nt
    s_waitcnt vmcnt(8)
    v_lshlrev_b32 v7, 16, v24
    v_and_b32 v8, 0xffff0000, v24
    v_lshlrev_b32 v9, 16, v25
    v_and_b32 v10, 0xffff0000, v25
    v_mul_f32 v7, 0.15915494, v7
    v_mul_f32 v8, 0.15915494, v8
    v_mul_f32 v9, 0.15915494, v9
    v_mul_f32 v10, 0.15915494, v10
    v_mul_hi_u32_u24 v14, 429497, v16
    v_lshrrev_b32 v12, 3, v20
    v_cos_f32 v7, v7
    v_lshlrev_b16 v13, 3, v20
    v_mad_i32_i24 v11, v14, s55, v16
    v_bitop3_b32 v12, v6, v13, v12 bitop3:0xca
    v_add_lshl_u32 v11, v11, s40, 17
    v_lshlrev_b16 v14, 8, v14
    v_lshrrev_b32 v13, 2, v20
    v_or_b32 v16, v12, v11
    v_bitop3_b32 v20, v5, v13, v14 bitop3:0xea
    ds_add_u32 v20, v2
    v_mul_hi_u32_u24 v14, 429497, v17
    v_lshrrev_b32 v12, 3, v21
    v_cos_f32 v8, v8
    v_lshlrev_b16 v13, 3, v21
    v_mad_i32_i24 v11, v14, s55, v17
    v_bitop3_b32 v12, v6, v13, v12 bitop3:0xca
    v_add_lshl_u32 v11, v11, s40, 17
    v_lshlrev_b16 v14, 8, v14
    v_lshrrev_b32 v13, 2, v21
    v_or_b32 v17, v12, v11
    v_bitop3_b32 v21, v5, v13, v14 bitop3:0xea
    ds_add_u32 v21, v2
    v_cvt_pk_bf16_f32 v24, v7, v8
    v_perm_b32 v12, v24, v24, s41
    v_bitop3_b32 v16, v4, v12, v16 bitop3:0xca
    v_perm_b32 v13, v24, v24, s42
    v_bitop3_b32 v17, v4, v13, v17 bitop3:0xca
    v_mul_hi_u32_u24 v14, 429497, v18
    v_lshrrev_b32 v12, 3, v22
    v_cos_f32 v9, v9
    v_lshlrev_b16 v13, 3, v22
    v_mad_i32_i24 v11, v14, s55, v18
    v_bitop3_b32 v12, v6, v13, v12 bitop3:0xca
    v_add_lshl_u32 v11, v11, s40, 17
    v_lshlrev_b16 v14, 8, v14
    v_lshrrev_b32 v13, 2, v22
    v_or_b32 v18, v12, v11
    v_bitop3_b32 v22, v5, v13, v14 bitop3:0xea
    ds_add_u32 v22, v2
    v_mul_hi_u32_u24 v14, 429497, v19
    v_lshrrev_b32 v12, 3, v23
    v_cos_f32 v10, v10
    v_lshlrev_b16 v13, 3, v23
    v_mad_i32_i24 v11, v14, s55, v19
    v_bitop3_b32 v12, v6, v13, v12 bitop3:0xca
    v_add_lshl_u32 v11, v11, s40, 17
    v_lshlrev_b16 v14, 8, v14
    v_lshrrev_b32 v13, 2, v23
    v_or_b32 v19, v12, v11
    v_bitop3_b32 v23, v5, v13, v14 bitop3:0xea
    ds_add_u32 v23, v2
    v_cvt_pk_bf16_f32 v25, v9, v10
    v_perm_b32 v12, v25, v25, s41
    v_bitop3_b32 v18, v4, v12, v18 bitop3:0xca
    v_perm_b32 v13, v25, v25, s42
    v_bitop3_b32 v19, v4, v13, v19 bitop3:0xca
    s_add_u32 s44, s33, 0x1000000
    buffer_load_dwordx4 v[56:59], v0, s[8:11], s44 offen nt
    s_add_u32 s45, s33, 0x1000000
    buffer_load_dwordx4 v[60:63], v0, s[12:15], s45 offen nt
    s_add_u32 s46, s34, 0x800000
    buffer_load_dwordx2 v[64:65], v1, s[16:19], s46 offen nt
    s_add_u32 s47, s34, 0xa00000
    buffer_load_dwordx2 v[66:67], v1, s[16:19], s47 offen nt
    s_waitcnt vmcnt(10)
    v_lshlrev_b32 v7, 16, v26
    v_and_b32 v8, 0xffff0000, v26
    v_lshlrev_b32 v9, 16, v27
    v_and_b32 v10, 0xffff0000, v27
    v_mul_f32 v7, 0.15915494, v7
    v_mul_f32 v8, 0.15915494, v8
    v_mul_f32 v9, 0.15915494, v9
    v_mul_f32 v10, 0.15915494, v10
    v_mul_hi_u32_u24 v14, 429497, v28
    v_lshrrev_b32 v12, 3, v32
    v_cos_f32 v7, v7
    v_lshlrev_b16 v13, 3, v32
    v_mad_i32_i24 v11, v14, s55, v28
    v_bitop3_b32 v12, v6, v13, v12 bitop3:0xca
    v_add_lshl_u32 v11, v11, s40, 17
    v_lshlrev_b16 v14, 8, v14
    v_lshrrev_b32 v13, 2, v32
    v_or_b32 v28, v12, v11
    v_bitop3_b32 v32, v5, v13, v14 bitop3:0xea
    ds_add_u32 v32, v2
    v_mul_hi_u32_u24 v14, 429497, v29
    v_lshrrev_b32 v12, 3, v33
    v_cos_f32 v8, v8
    v_lshlrev_b16 v13, 3, v33
    v_mad_i32_i24 v11, v14, s55, v29
    v_bitop3_b32 v12, v6, v13, v12 bitop3:0xca
    v_add_lshl_u32 v11, v11, s40, 17
    v_lshlrev_b16 v14, 8, v14
    v_lshrrev_b32 v13, 2, v33
    v_or_b32 v29, v12, v11
    v_bitop3_b32 v33, v5, v13, v14 bitop3:0xea
    ds_add_u32 v33, v2
    v_cvt_pk_bf16_f32 v26, v7, v8
    v_perm_b32 v12, v26, v26, s41
    v_bitop3_b32 v28, v4, v12, v28 bitop3:0xca
    v_perm_b32 v13, v26, v26, s42
    v_bitop3_b32 v29, v4, v13, v29 bitop3:0xca
    v_mul_hi_u32_u24 v14, 429497, v30
    v_lshrrev_b32 v12, 3, v34
    v_cos_f32 v9, v9
    v_lshlrev_b16 v13, 3, v34
    v_mad_i32_i24 v11, v14, s55, v30
    v_bitop3_b32 v12, v6, v13, v12 bitop3:0xca
    v_add_lshl_u32 v11, v11, s40, 17
    v_lshlrev_b16 v14, 8, v14
    v_lshrrev_b32 v13, 2, v34
    v_or_b32 v30, v12, v11
    v_bitop3_b32 v34, v5, v13, v14 bitop3:0xea
    ds_add_u32 v34, v2
    v_mul_hi_u32_u24 v14, 429497, v31
    v_lshrrev_b32 v12, 3, v35
    v_cos_f32 v10, v10
    v_lshlrev_b16 v13, 3, v35
    v_mad_i32_i24 v11, v14, s55, v31
    v_bitop3_b32 v12, v6, v13, v12 bitop3:0xca
    v_add_lshl_u32 v11, v11, s40, 17
    v_lshlrev_b16 v14, 8, v14
    v_lshrrev_b32 v13, 2, v35
    v_or_b32 v31, v12, v11
    v_bitop3_b32 v35, v5, v13, v14 bitop3:0xea
    ds_add_u32 v35, v2
    v_cvt_pk_bf16_f32 v27, v9, v10
    v_perm_b32 v12, v27, v27, s41
    v_bitop3_b32 v30, v4, v12, v30 bitop3:0xca
    v_perm_b32 v13, v27, v27, s42
    v_bitop3_b32 v31, v4, v13, v31 bitop3:0xca
    s_add_u32 s44, s33, 0x1400000
    buffer_load_dwordx4 v[68:71], v0, s[8:11], s44 offen nt
    s_add_u32 s45, s33, 0x1400000
    buffer_load_dwordx4 v[72:75], v0, s[12:15], s45 offen nt
    s_waitcnt vmcnt(8)
    v_lshlrev_b32 v7, 16, v44
    v_and_b32 v8, 0xffff0000, v44
    v_lshlrev_b32 v9, 16, v45
    v_and_b32 v10, 0xffff0000, v45
    v_mul_f32 v7, 0.15915494, v7
    v_mul_f32 v8, 0.15915494, v8
    v_mul_f32 v9, 0.15915494, v9
    v_mul_f32 v10, 0.15915494, v10
    v_mul_hi_u32_u24 v14, 429497, v36
    v_lshrrev_b32 v12, 3, v40
    v_cos_f32 v7, v7
    v_lshlrev_b16 v13, 3, v40
    v_mad_i32_i24 v11, v14, s55, v36
    v_bitop3_b32 v12, v6, v13, v12 bitop3:0xca
    v_add_lshl_u32 v11, v11, s40, 17
    v_lshlrev_b16 v14, 8, v14
    v_lshrrev_b32 v13, 2, v40
    v_or_b32 v36, v12, v11
    v_bitop3_b32 v40, v5, v13, v14 bitop3:0xea
    ds_add_u32 v40, v2
    v_mul_hi_u32_u24 v14, 429497, v37
    v_lshrrev_b32 v12, 3, v41
    v_cos_f32 v8, v8
    v_lshlrev_b16 v13, 3, v41
    v_mad_i32_i24 v11, v14, s55, v37
    v_bitop3_b32 v12, v6, v13, v12 bitop3:0xca
    v_add_lshl_u32 v11, v11, s40, 17
    v_lshlrev_b16 v14, 8, v14
    v_lshrrev_b32 v13, 2, v41
    v_or_b32 v37, v12, v11
    v_bitop3_b32 v41, v5, v13, v14 bitop3:0xea
    ds_add_u32 v41, v2
    v_cvt_pk_bf16_f32 v44, v7, v8
    v_perm_b32 v12, v44, v44, s41
    v_bitop3_b32 v36, v4, v12, v36 bitop3:0xca
    v_perm_b32 v13, v44, v44, s42
    v_bitop3_b32 v37, v4, v13, v37 bitop3:0xca
    v_mul_hi_u32_u24 v14, 429497, v38
    v_lshrrev_b32 v12, 3, v42
    v_cos_f32 v9, v9
    v_lshlrev_b16 v13, 3, v42
    v_mad_i32_i24 v11, v14, s55, v38
    v_bitop3_b32 v12, v6, v13, v12 bitop3:0xca
    v_add_lshl_u32 v11, v11, s40, 17
    v_lshlrev_b16 v14, 8, v14
    v_lshrrev_b32 v13, 2, v42
    v_or_b32 v38, v12, v11
    v_bitop3_b32 v42, v5, v13, v14 bitop3:0xea
    ds_add_u32 v42, v2
    v_mul_hi_u32_u24 v14, 429497, v39
    v_lshrrev_b32 v12, 3, v43
    v_cos_f32 v10, v10
    v_lshlrev_b16 v13, 3, v43
    v_mad_i32_i24 v11, v14, s55, v39
    v_bitop3_b32 v12, v6, v13, v12 bitop3:0xca
    v_add_lshl_u32 v11, v11, s40, 17
    v_lshlrev_b16 v14, 8, v14
    v_lshrrev_b32 v13, 2, v43
    v_or_b32 v39, v12, v11
    v_bitop3_b32 v43, v5, v13, v14 bitop3:0xea
    ds_add_u32 v43, v2
    v_cvt_pk_bf16_f32 v45, v9, v10
    v_perm_b32 v12, v45, v45, s41
    v_bitop3_b32 v38, v4, v12, v38 bitop3:0xca
    v_perm_b32 v13, v45, v45, s42
    v_bitop3_b32 v39, v4, v13, v39 bitop3:0xca
    s_add_u32 s46, s33, 0x1800000
    buffer_load_dwordx4 v[76:79], v0, s[8:11], s46 offen nt
    s_add_u32 s47, s33, 0x1800000
    buffer_load_dwordx4 v[80:83], v0, s[12:15], s47 offen nt
    s_add_u32 s44, s34, 0xc00000
    buffer_load_dwordx2 v[84:85], v1, s[16:19], s44 offen nt
    s_add_u32 s45, s34, 0xe00000
    buffer_load_dwordx2 v[86:87], v1, s[16:19], s45 offen nt
    s_waitcnt vmcnt(10)
    v_lshlrev_b32 v7, 16, v46
    v_and_b32 v8, 0xffff0000, v46
    v_lshlrev_b32 v9, 16, v47
    v_and_b32 v10, 0xffff0000, v47
    v_mul_f32 v7, 0.15915494, v7
    v_mul_f32 v8, 0.15915494, v8
    v_mul_f32 v9, 0.15915494, v9
    v_mul_f32 v10, 0.15915494, v10
    v_mul_hi_u32_u24 v14, 429497, v48
    v_lshrrev_b32 v12, 3, v52
    v_cos_f32 v7, v7
    v_lshlrev_b16 v13, 3, v52
    v_mad_i32_i24 v11, v14, s55, v48
    v_bitop3_b32 v12, v6, v13, v12 bitop3:0xca
    v_add_lshl_u32 v11, v11, s40, 17
    v_lshlrev_b16 v14, 8, v14
    v_lshrrev_b32 v13, 2, v52
    v_or_b32 v48, v12, v11
    v_bitop3_b32 v52, v5, v13, v14 bitop3:0xea
    ds_add_u32 v52, v2
    v_mul_hi_u32_u24 v14, 429497, v49
    v_lshrrev_b32 v12, 3, v53
    v_cos_f32 v8, v8
    v_lshlrev_b16 v13, 3, v53
    v_mad_i32_i24 v11, v14, s55, v49
    v_bitop3_b32 v12, v6, v13, v12 bitop3:0xca
    v_add_lshl_u32 v11, v11, s40, 17
    v_lshlrev_b16 v14, 8, v14
    v_lshrrev_b32 v13, 2, v53
    v_or_b32 v49, v12, v11
    v_bitop3_b32 v53, v5, v13, v14 bitop3:0xea
    ds_add_u32 v53, v2
    v_cvt_pk_bf16_f32 v46, v7, v8
    v_perm_b32 v12, v46, v46, s41
    v_bitop3_b32 v48, v4, v12, v48 bitop3:0xca
    v_perm_b32 v13, v46, v46, s42
    v_bitop3_b32 v49, v4, v13, v49 bitop3:0xca
    v_mul_hi_u32_u24 v14, 429497, v50
    v_lshrrev_b32 v12, 3, v54
    v_cos_f32 v9, v9
    v_lshlrev_b16 v13, 3, v54
    v_mad_i32_i24 v11, v14, s55, v50
    v_bitop3_b32 v12, v6, v13, v12 bitop3:0xca
    v_add_lshl_u32 v11, v11, s40, 17
    v_lshlrev_b16 v14, 8, v14
    v_lshrrev_b32 v13, 2, v54
    v_or_b32 v50, v12, v11
    v_bitop3_b32 v54, v5, v13, v14 bitop3:0xea
    ds_add_u32 v54, v2
    v_mul_hi_u32_u24 v14, 429497, v51
    v_lshrrev_b32 v12, 3, v55
    v_cos_f32 v10, v10
    v_lshlrev_b16 v13, 3, v55
    v_mad_i32_i24 v11, v14, s55, v51
    v_bitop3_b32 v12, v6, v13, v12 bitop3:0xca
    v_add_lshl_u32 v11, v11, s40, 17
    v_lshlrev_b16 v14, 8, v14
    v_lshrrev_b32 v13, 2, v55
    v_or_b32 v51, v12, v11
    v_bitop3_b32 v55, v5, v13, v14 bitop3:0xea
    ds_add_u32 v55, v2
    v_cvt_pk_bf16_f32 v47, v9, v10
    v_perm_b32 v12, v47, v47, s41
    v_bitop3_b32 v50, v4, v12, v50 bitop3:0xca
    v_perm_b32 v13, v47, v47, s42
    v_bitop3_b32 v51, v4, v13, v51 bitop3:0xca
    s_add_u32 s46, s33, 0x1c00000
    buffer_load_dwordx4 v[88:91], v0, s[8:11], s46 offen nt
    s_add_u32 s47, s33, 0x1c00000
    buffer_load_dwordx4 v[92:95], v0, s[12:15], s47 offen nt
    s_waitcnt vmcnt(8)
    v_lshlrev_b32 v7, 16, v64
    v_and_b32 v8, 0xffff0000, v64
    v_lshlrev_b32 v9, 16, v65
    v_and_b32 v10, 0xffff0000, v65
    v_mul_f32 v7, 0.15915494, v7
    v_mul_f32 v8, 0.15915494, v8
    v_mul_f32 v9, 0.15915494, v9
    v_mul_f32 v10, 0.15915494, v10
    v_mul_hi_u32_u24 v14, 429497, v56
    v_lshrrev_b32 v12, 3, v60
    v_cos_f32 v7, v7
    v_lshlrev_b16 v13, 3, v60
    v_mad_i32_i24 v11, v14, s55, v56
    v_bitop3_b32 v12, v6, v13, v12 bitop3:0xca
    v_add_lshl_u32 v11, v11, s40, 17
    v_lshlrev_b16 v14, 8, v14
    v_lshrrev_b32 v13, 2, v60
    v_or_b32 v56, v12, v11
    v_bitop3_b32 v60, v5, v13, v14 bitop3:0xea
    ds_add_u32 v60, v2
    v_mul_hi_u32_u24 v14, 429497, v57
    v_lshrrev_b32 v12, 3, v61
    v_cos_f32 v8, v8
    v_lshlrev_b16 v13, 3, v61
    v_mad_i32_i24 v11, v14, s55, v57
    v_bitop3_b32 v12, v6, v13, v12 bitop3:0xca
    v_add_lshl_u32 v11, v11, s40, 17
    v_lshlrev_b16 v14, 8, v14
    v_lshrrev_b32 v13, 2, v61
    v_or_b32 v57, v12, v11
    v_bitop3_b32 v61, v5, v13, v14 bitop3:0xea
    ds_add_u32 v61, v2
    v_cvt_pk_bf16_f32 v64, v7, v8
    v_perm_b32 v12, v64, v64, s41
    v_bitop3_b32 v56, v4, v12, v56 bitop3:0xca
    v_perm_b32 v13, v64, v64, s42
    v_bitop3_b32 v57, v4, v13, v57 bitop3:0xca
    v_mul_hi_u32_u24 v14, 429497, v58
    v_lshrrev_b32 v12, 3, v62
    v_cos_f32 v9, v9
    v_lshlrev_b16 v13, 3, v62
    v_mad_i32_i24 v11, v14, s55, v58
    v_bitop3_b32 v12, v6, v13, v12 bitop3:0xca
    v_add_lshl_u32 v11, v11, s40, 17
    v_lshlrev_b16 v14, 8, v14
    v_lshrrev_b32 v13, 2, v62
    v_or_b32 v58, v12, v11
    v_bitop3_b32 v62, v5, v13, v14 bitop3:0xea
    ds_add_u32 v62, v2
    v_mul_hi_u32_u24 v14, 429497, v59
    v_lshrrev_b32 v12, 3, v63
    v_cos_f32 v10, v10
    v_lshlrev_b16 v13, 3, v63
    v_mad_i32_i24 v11, v14, s55, v59
    v_bitop3_b32 v12, v6, v13, v12 bitop3:0xca
    v_add_lshl_u32 v11, v11, s40, 17
    v_lshlrev_b16 v14, 8, v14
    v_lshrrev_b32 v13, 2, v63
    v_or_b32 v59, v12, v11
    v_bitop3_b32 v63, v5, v13, v14 bitop3:0xea
    ds_add_u32 v63, v2
    v_cvt_pk_bf16_f32 v65, v9, v10
    v_perm_b32 v12, v65, v65, s41
    v_bitop3_b32 v58, v4, v12, v58 bitop3:0xca
    v_perm_b32 v13, v65, v65, s42
    v_bitop3_b32 v59, v4, v13, v59 bitop3:0xca
    s_add_u32 s44, s33, 0x2000000
    buffer_load_dwordx4 v[96:99], v0, s[8:11], s44 offen nt
    s_add_u32 s45, s33, 0x2000000
    buffer_load_dwordx4 v[100:103], v0, s[12:15], s45 offen nt
    s_add_u32 s46, s34, 0x1000000
    buffer_load_dwordx2 v[104:105], v1, s[16:19], s46 offen nt
    s_add_u32 s47, s34, 0x1200000
    buffer_load_dwordx2 v[106:107], v1, s[16:19], s47 offen nt
    s_waitcnt vmcnt(10)
    v_lshlrev_b32 v7, 16, v66
    v_and_b32 v8, 0xffff0000, v66
    v_lshlrev_b32 v9, 16, v67
    v_and_b32 v10, 0xffff0000, v67
    v_mul_f32 v7, 0.15915494, v7
    v_mul_f32 v8, 0.15915494, v8
    v_mul_f32 v9, 0.15915494, v9
    v_mul_f32 v10, 0.15915494, v10
    v_mul_hi_u32_u24 v14, 429497, v68
    v_lshrrev_b32 v12, 3, v72
    v_cos_f32 v7, v7
    v_lshlrev_b16 v13, 3, v72
    v_mad_i32_i24 v11, v14, s55, v68
    v_bitop3_b32 v12, v6, v13, v12 bitop3:0xca
    v_add_lshl_u32 v11, v11, s40, 17
    v_lshlrev_b16 v14, 8, v14
    v_lshrrev_b32 v13, 2, v72
    v_or_b32 v68, v12, v11
    v_bitop3_b32 v72, v5, v13, v14 bitop3:0xea
    ds_add_u32 v72, v2
    v_mul_hi_u32_u24 v14, 429497, v69
    v_lshrrev_b32 v12, 3, v73
    v_cos_f32 v8, v8
    v_lshlrev_b16 v13, 3, v73
    v_mad_i32_i24 v11, v14, s55, v69
    v_bitop3_b32 v12, v6, v13, v12 bitop3:0xca
    v_add_lshl_u32 v11, v11, s40, 17
    v_lshlrev_b16 v14, 8, v14
    v_lshrrev_b32 v13, 2, v73
    v_or_b32 v69, v12, v11
    v_bitop3_b32 v73, v5, v13, v14 bitop3:0xea
    ds_add_u32 v73, v2
    v_cvt_pk_bf16_f32 v66, v7, v8
    v_perm_b32 v12, v66, v66, s41
    v_bitop3_b32 v68, v4, v12, v68 bitop3:0xca
    v_perm_b32 v13, v66, v66, s42
    v_bitop3_b32 v69, v4, v13, v69 bitop3:0xca
    v_mul_hi_u32_u24 v14, 429497, v70
    v_lshrrev_b32 v12, 3, v74
    v_cos_f32 v9, v9
    v_lshlrev_b16 v13, 3, v74
    v_mad_i32_i24 v11, v14, s55, v70
    v_bitop3_b32 v12, v6, v13, v12 bitop3:0xca
    v_add_lshl_u32 v11, v11, s40, 17
    v_lshlrev_b16 v14, 8, v14
    v_lshrrev_b32 v13, 2, v74
    v_or_b32 v70, v12, v11
    v_bitop3_b32 v74, v5, v13, v14 bitop3:0xea
    ds_add_u32 v74, v2
    v_mul_hi_u32_u24 v14, 429497, v71
    v_lshrrev_b32 v12, 3, v75
    v_cos_f32 v10, v10
    v_lshlrev_b16 v13, 3, v75
    v_mad_i32_i24 v11, v14, s55, v71
    v_bitop3_b32 v12, v6, v13, v12 bitop3:0xca
    v_add_lshl_u32 v11, v11, s40, 17
    v_lshlrev_b16 v14, 8, v14
    v_lshrrev_b32 v13, 2, v75
    v_or_b32 v71, v12, v11
    v_bitop3_b32 v75, v5, v13, v14 bitop3:0xea
    ds_add_u32 v75, v2
    v_cvt_pk_bf16_f32 v67, v9, v10
    v_perm_b32 v12, v67, v67, s41
    v_bitop3_b32 v70, v4, v12, v70 bitop3:0xca
    v_perm_b32 v13, v67, v67, s42
    v_bitop3_b32 v71, v4, v13, v71 bitop3:0xca
    s_add_u32 s44, s33, 0x2400000
    buffer_load_dwordx4 v[108:111], v0, s[8:11], s44 offen nt
    s_waitcnt vmcnt(7)
    v_lshlrev_b32 v7, 16, v84
    v_and_b32 v8, 0xffff0000, v84
    v_lshlrev_b32 v9, 16, v85
    v_and_b32 v10, 0xffff0000, v85
    v_mul_f32 v7, 0.15915494, v7
    v_mul_f32 v8, 0.15915494, v8
    v_mul_f32 v9, 0.15915494, v9
    v_mul_f32 v10, 0.15915494, v10
    v_mul_hi_u32_u24 v14, 429497, v76
    v_lshrrev_b32 v12, 3, v80
    v_cos_f32 v7, v7
    v_lshlrev_b16 v13, 3, v80
    v_mad_i32_i24 v11, v14, s55, v76
    v_bitop3_b32 v12, v6, v13, v12 bitop3:0xca
    v_add_lshl_u32 v11, v11, s40, 17
    v_lshlrev_b16 v14, 8, v14
    v_lshrrev_b32 v13, 2, v80
    v_or_b32 v76, v12, v11
    v_bitop3_b32 v80, v5, v13, v14 bitop3:0xea
    ds_add_u32 v80, v2
    v_mul_hi_u32_u24 v14, 429497, v77
    v_lshrrev_b32 v12, 3, v81
    v_cos_f32 v8, v8
    v_lshlrev_b16 v13, 3, v81
    v_mad_i32_i24 v11, v14, s55, v77
    v_bitop3_b32 v12, v6, v13, v12 bitop3:0xca
    v_add_lshl_u32 v11, v11, s40, 17
    v_lshlrev_b16 v14, 8, v14
    v_lshrrev_b32 v13, 2, v81
    v_or_b32 v77, v12, v11
    v_bitop3_b32 v81, v5, v13, v14 bitop3:0xea
    ds_add_u32 v81, v2
    v_cvt_pk_bf16_f32 v84, v7, v8
    v_perm_b32 v12, v84, v84, s41
    v_bitop3_b32 v76, v4, v12, v76 bitop3:0xca
    v_perm_b32 v13, v84, v84, s42
    v_bitop3_b32 v77, v4, v13, v77 bitop3:0xca
    v_mul_hi_u32_u24 v14, 429497, v78
    v_lshrrev_b32 v12, 3, v82
    v_cos_f32 v9, v9
    v_lshlrev_b16 v13, 3, v82
    v_mad_i32_i24 v11, v14, s55, v78
    v_bitop3_b32 v12, v6, v13, v12 bitop3:0xca
    v_add_lshl_u32 v11, v11, s40, 17
    v_lshlrev_b16 v14, 8, v14
    v_lshrrev_b32 v13, 2, v82
    v_or_b32 v78, v12, v11
    v_bitop3_b32 v82, v5, v13, v14 bitop3:0xea
    ds_add_u32 v82, v2
    v_mul_hi_u32_u24 v14, 429497, v79
    v_lshrrev_b32 v12, 3, v83
    v_cos_f32 v10, v10
    v_lshlrev_b16 v13, 3, v83
    v_mad_i32_i24 v11, v14, s55, v79
    v_bitop3_b32 v12, v6, v13, v12 bitop3:0xca
    v_add_lshl_u32 v11, v11, s40, 17
    v_lshlrev_b16 v14, 8, v14
    v_lshrrev_b32 v13, 2, v83
    v_or_b32 v79, v12, v11
    v_bitop3_b32 v83, v5, v13, v14 bitop3:0xea
    ds_add_u32 v83, v2
    v_cvt_pk_bf16_f32 v85, v9, v10
    v_perm_b32 v12, v85, v85, s41
    v_bitop3_b32 v78, v4, v12, v78 bitop3:0xca
    v_perm_b32 v13, v85, v85, s42
    v_bitop3_b32 v79, v4, v13, v79 bitop3:0xca
    s_waitcnt vmcnt(5)
    v_lshlrev_b32 v7, 16, v86
    v_and_b32 v8, 0xffff0000, v86
    v_lshlrev_b32 v9, 16, v87
    v_and_b32 v10, 0xffff0000, v87
    v_mul_f32 v7, 0.15915494, v7
    v_mul_f32 v8, 0.15915494, v8
    v_mul_f32 v9, 0.15915494, v9
    v_mul_f32 v10, 0.15915494, v10
    v_mul_hi_u32_u24 v14, 429497, v88
    v_lshrrev_b32 v12, 3, v92
    v_cos_f32 v7, v7
    v_lshlrev_b16 v13, 3, v92
    v_mad_i32_i24 v11, v14, s55, v88
    v_bitop3_b32 v12, v6, v13, v12 bitop3:0xca
    v_add_lshl_u32 v11, v11, s40, 17
    v_lshlrev_b16 v14, 8, v14
    v_lshrrev_b32 v13, 2, v92
    v_or_b32 v88, v12, v11
    v_bitop3_b32 v92, v5, v13, v14 bitop3:0xea
    ds_add_u32 v92, v2
    v_mul_hi_u32_u24 v14, 429497, v89
    v_lshrrev_b32 v12, 3, v93
    v_cos_f32 v8, v8
    v_lshlrev_b16 v13, 3, v93
    v_mad_i32_i24 v11, v14, s55, v89
    v_bitop3_b32 v12, v6, v13, v12 bitop3:0xca
    v_add_lshl_u32 v11, v11, s40, 17
    v_lshlrev_b16 v14, 8, v14
    v_lshrrev_b32 v13, 2, v93
    v_or_b32 v89, v12, v11
    v_bitop3_b32 v93, v5, v13, v14 bitop3:0xea
    ds_add_u32 v93, v2
    v_cvt_pk_bf16_f32 v86, v7, v8
    v_perm_b32 v12, v86, v86, s41
    v_bitop3_b32 v88, v4, v12, v88 bitop3:0xca
    v_perm_b32 v13, v86, v86, s42
    v_bitop3_b32 v89, v4, v13, v89 bitop3:0xca
    v_mul_hi_u32_u24 v14, 429497, v90
    v_lshrrev_b32 v12, 3, v94
    v_cos_f32 v9, v9
    v_lshlrev_b16 v13, 3, v94
    v_mad_i32_i24 v11, v14, s55, v90
    v_bitop3_b32 v12, v6, v13, v12 bitop3:0xca
    v_add_lshl_u32 v11, v11, s40, 17
    v_lshlrev_b16 v14, 8, v14
    v_lshrrev_b32 v13, 2, v94
    v_or_b32 v90, v12, v11
    v_bitop3_b32 v94, v5, v13, v14 bitop3:0xea
    ds_add_u32 v94, v2
    v_mul_hi_u32_u24 v14, 429497, v91
    v_lshrrev_b32 v12, 3, v95
    v_cos_f32 v10, v10
    v_lshlrev_b16 v13, 3, v95
    v_mad_i32_i24 v11, v14, s55, v91
    v_bitop3_b32 v12, v6, v13, v12 bitop3:0xca
    v_add_lshl_u32 v11, v11, s40, 17
    v_lshlrev_b16 v14, 8, v14
    v_lshrrev_b32 v13, 2, v95
    v_or_b32 v91, v12, v11
    v_bitop3_b32 v95, v5, v13, v14 bitop3:0xea
    ds_add_u32 v95, v2
    v_cvt_pk_bf16_f32 v87, v9, v10
    v_perm_b32 v12, v87, v87, s41
    v_bitop3_b32 v90, v4, v12, v90 bitop3:0xca
    v_perm_b32 v13, v87, v87, s42
    v_bitop3_b32 v91, v4, v13, v91 bitop3:0xca
    v_lshrrev_b32 v8, 2, v0
    v_and_b32 v7, 0x3c00, v0
    v_bitop3_b32 v7, v5, v8, v7 bitop3:0xea
    s_waitcnt lgkmcnt(0)
    s_barrier
    ds_read2st64_b32 v[8:9], v7 offset0:0 offset1:1
    ds_read2st64_b32 v[10:11], v7 offset0:2 offset1:3
    s_add_u32 s45, s33, 0x2400000
    buffer_load_dwordx4 v[112:115], v0, s[12:15], s45 offen nt
    s_waitcnt lgkmcnt(0)
    v_lshl_or_b32 v12, v9, 16, v8
    v_lshl_or_b32 v13, v11, 16, v10
    v_mov_b32 v14, v12
    v_mov_b32 v15, v13
    s_nop 0
    v_add_u32_dpp v14, v14, v14 row_shr:1 row_mask:0xf bank_mask:0xf bound_ctrl:1
    v_add_u32_dpp v15, v15, v15 row_shr:1 row_mask:0xf bank_mask:0xf bound_ctrl:1
    s_nop 0
    v_add_u32_dpp v14, v14, v14 row_shr:2 row_mask:0xf bank_mask:0xf bound_ctrl:1
    v_add_u32_dpp v15, v15, v15 row_shr:2 row_mask:0xf bank_mask:0xf bound_ctrl:1
    s_nop 0
    v_add_u32_dpp v14, v14, v14 row_shr:4 row_mask:0xf bank_mask:0xf bound_ctrl:1
    v_add_u32_dpp v15, v15, v15 row_shr:4 row_mask:0xf bank_mask:0xf bound_ctrl:1
    s_nop 0
    v_add_u32_dpp v14, v14, v14 row_shr:8 row_mask:0xf bank_mask:0xf bound_ctrl:1
    v_add_u32_dpp v15, v15, v15 row_shr:8 row_mask:0xf bank_mask:0xf bound_ctrl:1
    s_nop 0
    v_add_u32_dpp v14, v14, v14 row_bcast:15 row_mask:0xa bank_mask:0xf
    v_add_u32_dpp v15, v15, v15 row_bcast:15 row_mask:0xa bank_mask:0xf
    s_nop 0
    v_add_u32_dpp v14, v14, v14 row_bcast:31 row_mask:0xc bank_mask:0xf
    v_add_u32_dpp v15, v15, v15 row_bcast:31 row_mask:0xc bank_mask:0xf
    v_readlane_b32 s48, v14, 63
    v_readlane_b32 s49, v15, 63
    s_lshl_b32 s54, s32, 2
    v_mov_b32 v8, s54
    s_and_b32 s50, s48, 0xffff
    s_lshr_b32 s51, s48, 16
    s_and_b32 s52, s49, 0xffff
    s_lshr_b32 s53, s49, 16
    s_add_u32 s51, s51, s50
    s_add_u32 s52, s52, s51
    s_add_u32 s53, s53, s52
    v_mov_b32 v9, s53
    s_mov_b64 exec, 1
    ds_write_b32 v8, v9 offset:16384
    s_mov_b64 exec, -1
    v_and_b32 v8, 60, v7
    s_waitcnt lgkmcnt(0)
    s_barrier
    ds_read_b32 v9, v8 offset:16384
    s_waitcnt lgkmcnt(0)
    v_add_u32_dpp v9, v9, v9 row_shr:1 row_mask:0xf bank_mask:0xf bound_ctrl:1
    s_nop 1
    v_add_u32_dpp v9, v9, v9 row_shr:2 row_mask:0xf bank_mask:0xf bound_ctrl:1
    s_nop 1
    v_add_u32_dpp v9, v9, v9 row_shr:4 row_mask:0xf bank_mask:0xf bound_ctrl:1
    s_nop 1
    v_add_u32_dpp v9, v9, v9 row_shr:8 row_mask:0xf bank_mask:0xf bound_ctrl:1
    s_nop 0
    v_readlane_b32 s54, v9, s32
    s_sub_u32 s54, s54, s53
    s_add_u32 s50, s50, s54
    s_add_u32 s51, s51, s54
    s_add_u32 s52, s52, s54
    s_pack_ll_b32_b16 s48, s54, s50
    s_pack_ll_b32_b16 s49, s51, s52
    v_add_u32 v14, s48, v14
    v_add_u32 v15, s49, v15
    v_sub_u32 v12, v14, v12
    v_sub_u32 v13, v15, v13
    v_and_b32 v8, 0xffff, v12
    v_lshrrev_b32 v9, 16, v12
    v_and_b32 v10, 0xffff, v13
    v_lshrrev_b32 v11, 16, v13
    ds_write2st64_b32 v7, v8, v9 offset0:0 offset1:1
    ds_write2st64_b32 v7, v10, v11 offset0:2 offset1:3
    s_waitcnt lgkmcnt(0)
    s_barrier
    ds_add_rtn_u32 v20, v20, v2
    ds_add_rtn_u32 v21, v21, v2
    ds_add_rtn_u32 v22, v22, v2
    ds_add_rtn_u32 v23, v23, v2
    s_add_u32 s46, s36, 0x0
    v_and_b32 v11, 0x3f0, v0
    v_add_u32 v11, v11, v11
    buffer_store_dwordx2 v[12:13], v11, s[24:27], s46 offen
    s_bitset0_b64 exec, 63
    s_not_b64 exec, exec
    buffer_store_dwordx2 v[14:15], v11, s[24:27], s46 offen offset:32
    s_mov_b64 exec, -1
    v_cmp_le_u32 vcc, s37, v0
    v_add_u32 v10, 8320, v0
    s_cmp_lg_u32 s32, 0
    v_cndmask_b32 v10, v0, v10, vcc
    s_cbranch_scc1 L1_p1
    s_add_u32 s47, s35, 0x0
    s_mov_b64 exec, 0xff
    buffer_store_dwordx4 v[12:15], v10, s[24:27], s47 offen
    s_mov_b64 exec, -1
L1_p1:
    ds_add_rtn_u32 v32, v32, v2
    ds_add_rtn_u32 v33, v33, v2
    ds_add_rtn_u32 v34, v34, v2
    ds_add_rtn_u32 v35, v35, v2
    ds_add_rtn_u32 v40, v40, v2
    ds_add_rtn_u32 v41, v41, v2
    ds_add_rtn_u32 v42, v42, v2
    ds_add_rtn_u32 v43, v43, v2
    s_add_u32 s44, s33, 0x2800000
    buffer_load_dwordx4 v[116:119], v0, s[8:11], s44 offen nt
    ds_add_rtn_u32 v52, v52, v2
    ds_add_rtn_u32 v53, v53, v2
    ds_add_rtn_u32 v54, v54, v2
    ds_add_rtn_u32 v55, v55, v2
    ds_add_rtn_u32 v60, v60, v2
    ds_add_rtn_u32 v61, v61, v2
    ds_add_rtn_u32 v62, v62, v2
    ds_add_rtn_u32 v63, v63, v2
    ds_add_rtn_u32 v72, v72, v2
    ds_add_rtn_u32 v73, v73, v2
    ds_add_rtn_u32 v74, v74, v2
    ds_add_rtn_u32 v75, v75, v2
    s_add_u32 s45, s33, 0x2800000
    buffer_load_dwordx4 v[120:123], v0, s[12:15], s45 offen nt
    ds_add_rtn_u32 v80, v80, v2
    ds_add_rtn_u32 v81, v81, v2
    ds_add_rtn_u32 v82, v82, v2
    ds_add_rtn_u32 v83, v83, v2
    ds_add_rtn_u32 v92, v92, v2
    ds_add_rtn_u32 v93, v93, v2
    ds_add_rtn_u32 v94, v94, v2
    ds_add_rtn_u32 v95, v95, v2
    s_waitcnt lgkmcnt(0)
    s_barrier
    v_and_b32 v7, -4, v20
    v_lshl_add_u32 v8, v20, 2, v7
    ds_write_b32 v8, v16
    v_lshl_add_u32 v7, v7, 2, v20
    ds_write_b8 v7, v24 offset:16
    v_and_b32 v9, -4, v21
    v_lshl_add_u32 v10, v21, 2, v9
    ds_write_b32 v10, v17
    v_lshl_add_u32 v9, v9, 2, v21
    ds_write_b8_d16_hi v9, v24 offset:16
    v_and_b32 v7, -4, v22
    v_lshl_add_u32 v8, v22, 2, v7
    ds_write_b32 v8, v18
    v_lshl_add_u32 v7, v7, 2, v22
    ds_write_b8 v7, v25 offset:16
    v_and_b32 v9, -4, v23
    v_lshl_add_u32 v10, v23, 2, v9
    ds_write_b32 v10, v19
    v_lshl_add_u32 v9, v9, 2, v23
    ds_write_b8_d16_hi v9, v25 offset:16
    s_add_u32 s46, s34, 0x1400000
    buffer_load_dwordx2 v[124:125], v1, s[16:19], s46 offen nt
    s_add_u32 s47, s34, 0x1600000
    buffer_load_dwordx2 v[126:127], v1, s[16:19], s47 offen nt
    s_add_u32 s44, s33, 0x2c00000
    buffer_load_dwordx4 v[16:19], v0, s[8:11], s44 offen nt
    v_and_b32 v7, -4, v32
    v_lshl_add_u32 v8, v32, 2, v7
    ds_write_b32 v8, v28
    v_lshl_add_u32 v7, v7, 2, v32
    ds_write_b8 v7, v26 offset:16
    v_and_b32 v9, -4, v33
    v_lshl_add_u32 v10, v33, 2, v9
    ds_write_b32 v10, v29
    v_lshl_add_u32 v9, v9, 2, v33
    ds_write_b8_d16_hi v9, v26 offset:16
    v_and_b32 v7, -4, v34
    v_lshl_add_u32 v8, v34, 2, v7
    ds_write_b32 v8, v30
    v_lshl_add_u32 v7, v7, 2, v34
    ds_write_b8 v7, v27 offset:16
    v_and_b32 v9, -4, v35
    v_lshl_add_u32 v10, v35, 2, v9
    ds_write_b32 v10, v31
    v_lshl_add_u32 v9, v9, 2, v35
    ds_write_b8_d16_hi v9, v27 offset:16
    s_add_u32 s45, s33, 0x2c00000
    buffer_load_dwordx4 v[20:23], v0, s[12:15], s45 offen nt
    v_and_b32 v7, -4, v40
    v_lshl_add_u32 v8, v40, 2, v7
    ds_write_b32 v8, v36
    v_lshl_add_u32 v7, v7, 2, v40
    ds_write_b8 v7, v44 offset:16
    v_and_b32 v9, -4, v41
    v_lshl_add_u32 v10, v41, 2, v9
    ds_write_b32 v10, v37
    v_lshl_add_u32 v9, v9, 2, v41
    ds_write_b8_d16_hi v9, v44 offset:16
    v_and_b32 v7, -4, v42
    v_lshl_add_u32 v8, v42, 2, v7
    ds_write_b32 v8, v38
    v_lshl_add_u32 v7, v7, 2, v42
    ds_write_b8 v7, v45 offset:16
    v_and_b32 v9, -4, v43
    v_lshl_add_u32 v10, v43, 2, v9
    ds_write_b32 v10, v39
    v_lshl_add_u32 v9, v9, 2, v43
    ds_write_b8_d16_hi v9, v45 offset:16
    s_add_u32 s46, s33, 0x3000000
    buffer_load_dwordx4 v[28:31], v0, s[8:11], s46 offen nt
    s_add_u32 s47, s33, 0x3000000
    buffer_load_dwordx4 v[32:35], v0, s[12:15], s47 offen nt
    v_and_b32 v7, -4, v52
    v_lshl_add_u32 v8, v52, 2, v7
    ds_write_b32 v8, v48
    v_lshl_add_u32 v7, v7, 2, v52
    ds_write_b8 v7, v46 offset:16
    v_and_b32 v9, -4, v53
    v_lshl_add_u32 v10, v53, 2, v9
    ds_write_b32 v10, v49
    v_lshl_add_u32 v9, v9, 2, v53
    ds_write_b8_d16_hi v9, v46 offset:16
    v_and_b32 v7, -4, v54
    v_lshl_add_u32 v8, v54, 2, v7
    ds_write_b32 v8, v50
    v_lshl_add_u32 v7, v7, 2, v54
    ds_write_b8 v7, v47 offset:16
    v_and_b32 v9, -4, v55
    v_lshl_add_u32 v10, v55, 2, v9
    ds_write_b32 v10, v51
    v_lshl_add_u32 v9, v9, 2, v55
    ds_write_b8_d16_hi v9, v47 offset:16
    s_add_u32 s44, s34, 0x1800000
    buffer_load_dwordx2 v[24:25], v1, s[16:19], s44 offen nt
    s_add_u32 s45, s34, 0x1a00000
    buffer_load_dwordx2 v[26:27], v1, s[16:19], s45 offen nt
    v_and_b32 v7, -4, v60
    v_lshl_add_u32 v8, v60, 2, v7
    ds_write_b32 v8, v56
    v_lshl_add_u32 v7, v7, 2, v60
    ds_write_b8 v7, v64 offset:16
    v_and_b32 v9, -4, v61
    v_lshl_add_u32 v10, v61, 2, v9
    ds_write_b32 v10, v57
    v_lshl_add_u32 v9, v9, 2, v61
    ds_write_b8_d16_hi v9, v64 offset:16
    v_and_b32 v7, -4, v62
    v_lshl_add_u32 v8, v62, 2, v7
    ds_write_b32 v8, v58
    v_lshl_add_u32 v7, v7, 2, v62
    ds_write_b8 v7, v65 offset:16
    v_and_b32 v9, -4, v63
    v_lshl_add_u32 v10, v63, 2, v9
    ds_write_b32 v10, v59
    v_lshl_add_u32 v9, v9, 2, v63
    ds_write_b8_d16_hi v9, v65 offset:16
    s_add_u32 s46, s33, 0x3400000
    buffer_load_dwordx4 v[36:39], v0, s[8:11], s46 offen nt
    v_and_b32 v7, -4, v72
    v_lshl_add_u32 v8, v72, 2, v7
    ds_write_b32 v8, v68
    v_lshl_add_u32 v7, v7, 2, v72
    ds_write_b8 v7, v66 offset:16
    v_and_b32 v9, -4, v73
    v_lshl_add_u32 v10, v73, 2, v9
    ds_write_b32 v10, v69
    v_lshl_add_u32 v9, v9, 2, v73
    ds_write_b8_d16_hi v9, v66 offset:16
    v_and_b32 v7, -4, v74
    v_lshl_add_u32 v8, v74, 2, v7
    ds_write_b32 v8, v70
    v_lshl_add_u32 v7, v7, 2, v74
    ds_write_b8 v7, v67 offset:16
    v_and_b32 v9, -4, v75
    v_lshl_add_u32 v10, v75, 2, v9
    ds_write_b32 v10, v71
    v_lshl_add_u32 v9, v9, 2, v75
    ds_write_b8_d16_hi v9, v67 offset:16
    s_add_u32 s47, s33, 0x3400000
    buffer_load_dwordx4 v[40:43], v0, s[12:15], s47 offen nt
    s_add_u32 s44, s33, 0x3800000
    buffer_load_dwordx4 v[48:51], v0, s[8:11], s44 offen nt
    v_and_b32 v7, -4, v80
    v_lshl_add_u32 v8, v80, 2, v7
    ds_write_b32 v8, v76
    v_lshl_add_u32 v7, v7, 2, v80
    ds_write_b8 v7, v84 offset:16
    v_and_b32 v9, -4, v81
    v_lshl_add_u32 v10, v81, 2, v9
    ds_write_b32 v10, v77
    v_lshl_add_u32 v9, v9, 2, v81
    ds_write_b8_d16_hi v9, v84 offset:16
    v_and_b32 v7, -4, v82
    v_lshl_add_u32 v8, v82, 2, v7
    ds_write_b32 v8, v78
    v_lshl_add_u32 v7, v7, 2, v82
    ds_write_b8 v7, v85 offset:16
    v_and_b32 v9, -4, v83
    v_lshl_add_u32 v10, v83, 2, v9
    ds_write_b32 v10, v79
    v_lshl_add_u32 v9, v9, 2, v83
    ds_write_b8_d16_hi v9, v85 offset:16
    s_add_u32 s45, s33, 0x3800000
    buffer_load_dwordx4 v[52:55], v0, s[12:15], s45 offen nt
    v_and_b32 v7, -4, v92
    v_lshl_add_u32 v8, v92, 2, v7
    ds_write_b32 v8, v88
    v_lshl_add_u32 v7, v7, 2, v92
    ds_write_b8 v7, v86 offset:16
    v_and_b32 v9, -4, v93
    v_lshl_add_u32 v10, v93, 2, v9
    ds_write_b32 v10, v89
    v_lshl_add_u32 v9, v9, 2, v93
    ds_write_b8_d16_hi v9, v86 offset:16
    v_and_b32 v7, -4, v94
    v_lshl_add_u32 v8, v94, 2, v7
    ds_write_b32 v8, v90
    v_lshl_add_u32 v7, v7, 2, v94
    ds_write_b8 v7, v87 offset:16
    v_and_b32 v9, -4, v95
    v_lshl_add_u32 v10, v95, 2, v9
    ds_write_b32 v10, v91
    v_lshl_add_u32 v9, v9, 2, v95
    ds_write_b8_d16_hi v9, v87 offset:16
    s_add_u32 s46, s34, 0x1c00000
    buffer_load_dwordx2 v[44:45], v1, s[16:19], s46 offen nt
    s_add_u32 s47, s34, 0x1e00000
    buffer_load_dwordx2 v[46:47], v1, s[16:19], s47 offen nt
    v_add_u32 v7, 0x10000, v0
    v_add_u32 v12, 0x20000, v0
    v_mov_b32 v8, 0
    v_mov_b32 v9, 0
    v_mov_b32 v10, 0
    v_mov_b32 v11, 0
    s_waitcnt lgkmcnt(0)
    s_barrier
    ds_read_b128 v[56:59], v0 offset:0
    ds_write_b128 v0, v[8:11]
    ds_read_b128 v[60:63], v0 offset:16384
    ds_read_b128 v[68:71], v0 offset:32768
    ds_read_b128 v[72:75], v0 offset:49152
    ds_read_b128 v[64:67], v7 offset:0
    ds_read_b128 v[76:79], v7 offset:16384
    ds_read_b128 v[80:83], v7 offset:32768
    ds_read_b128 v[88:91], v7 offset:49152
    ds_read_b128 v[92:95], v12 offset:0
    ds_read_b128 v[84:87], v12 offset:16384
    s_waitcnt lgkmcnt(0)
    s_barrier
    s_add_u32 s44, s35, 0x0
    buffer_store_dwordx4 v[56:59], v0, s[20:23], s44 offen sc1
    s_add_u32 s45, s33, 0x3c00000
    s_nop 0
    buffer_load_dwordx4 v[56:59], v0, s[8:11], s45 offen nt
    s_add_u32 s46, s35, 0x4000
    buffer_store_dwordx4 v[60:63], v0, s[20:23], s46 offen sc1
    s_add_u32 s47, s33, 0x3c00000
    s_nop 0
    buffer_load_dwordx4 v[60:63], v0, s[12:15], s47 offen nt
    s_waitcnt vmcnt(24)
    v_lshlrev_b32 v7, 16, v104
    v_and_b32 v8, 0xffff0000, v104
    v_lshlrev_b32 v9, 16, v105
    v_and_b32 v10, 0xffff0000, v105
    v_mul_f32 v7, 0.15915494, v7
    v_mul_f32 v8, 0.15915494, v8
    v_mul_f32 v9, 0.15915494, v9
    v_mul_f32 v10, 0.15915494, v10
    v_mul_hi_u32_u24 v14, 429497, v96
    v_lshrrev_b32 v12, 3, v100
    v_cos_f32 v7, v7
    v_lshlrev_b16 v13, 3, v100
    v_mad_i32_i24 v11, v14, s55, v96
    v_bitop3_b32 v12, v6, v13, v12 bitop3:0xca
    v_add_lshl_u32 v11, v11, s40, 17
    v_lshlrev_b16 v14, 8, v14
    v_lshrrev_b32 v13, 2, v100
    v_or_b32 v96, v12, v11
    v_bitop3_b32 v100, v5, v13, v14 bitop3:0xea
    ds_add_u32 v100, v2
    v_mul_hi_u32_u24 v14, 429497, v97
    v_lshrrev_b32 v12, 3, v101
    v_cos_f32 v8, v8
    v_lshlrev_b16 v13, 3, v101
    v_mad_i32_i24 v11, v14, s55, v97
    v_bitop3_b32 v12, v6, v13, v12 bitop3:0xca
    v_add_lshl_u32 v11, v11, s40, 17
    v_lshlrev_b16 v14, 8, v14
    v_lshrrev_b32 v13, 2, v101
    v_or_b32 v97, v12, v11
    v_bitop3_b32 v101, v5, v13, v14 bitop3:0xea
    ds_add_u32 v101, v2
    v_cvt_pk_bf16_f32 v104, v7, v8
    v_perm_b32 v12, v104, v104, s41
    v_bitop3_b32 v96, v4, v12, v96 bitop3:0xca
    v_perm_b32 v13, v104, v104, s42
    v_bitop3_b32 v97, v4, v13, v97 bitop3:0xca
    v_mul_hi_u32_u24 v14, 429497, v98
    v_lshrrev_b32 v12, 3, v102
    v_cos_f32 v9, v9
    v_lshlrev_b16 v13, 3, v102
    v_mad_i32_i24 v11, v14, s55, v98
    v_bitop3_b32 v12, v6, v13, v12 bitop3:0xca
    v_add_lshl_u32 v11, v11, s40, 17
    v_lshlrev_b16 v14, 8, v14
    v_lshrrev_b32 v13, 2, v102
    v_or_b32 v98, v12, v11
    v_bitop3_b32 v102, v5, v13, v14 bitop3:0xea
    ds_add_u32 v102, v2
    v_mul_hi_u32_u24 v14, 429497, v99
    v_lshrrev_b32 v12, 3, v103
    v_cos_f32 v10, v10
    v_lshlrev_b16 v13, 3, v103
    v_mad_i32_i24 v11, v14, s55, v99
    v_bitop3_b32 v12, v6, v13, v12 bitop3:0xca
    v_add_lshl_u32 v11, v11, s40, 17
    v_lshlrev_b16 v14, 8, v14
    v_lshrrev_b32 v13, 2, v103
    v_or_b32 v99, v12, v11
    v_bitop3_b32 v103, v5, v13, v14 bitop3:0xea
    ds_add_u32 v103, v2
    v_cvt_pk_bf16_f32 v105, v9, v10
    v_perm_b32 v12, v105, v105, s41
    v_bitop3_b32 v98, v4, v12, v98 bitop3:0xca
    v_perm_b32 v13, v105, v105, s42
    v_bitop3_b32 v99, v4, v13, v99 bitop3:0xca
    s_waitcnt vmcnt(22)
    v_lshlrev_b32 v7, 16, v106
    v_and_b32 v8, 0xffff0000, v106
    v_lshlrev_b32 v9, 16, v107
    v_and_b32 v10, 0xffff0000, v107
    v_mul_f32 v7, 0.15915494, v7
    v_mul_f32 v8, 0.15915494, v8
    v_mul_f32 v9, 0.15915494, v9
    v_mul_f32 v10, 0.15915494, v10
    v_mul_hi_u32_u24 v14, 429497, v108
    v_lshrrev_b32 v12, 3, v112
    v_cos_f32 v7, v7
    v_lshlrev_b16 v13, 3, v112
    v_mad_i32_i24 v11, v14, s55, v108
    v_bitop3_b32 v12, v6, v13, v12 bitop3:0xca
    v_add_lshl_u32 v11, v11, s40, 17
    v_lshlrev_b16 v14, 8, v14
    v_lshrrev_b32 v13, 2, v112
    v_or_b32 v108, v12, v11
    v_bitop3_b32 v112, v5, v13, v14 bitop3:0xea
    ds_add_u32 v112, v2
    v_mul_hi_u32_u24 v14, 429497, v109
    v_lshrrev_b32 v12, 3, v113
    v_cos_f32 v8, v8
    v_lshlrev_b16 v13, 3, v113
    v_mad_i32_i24 v11, v14, s55, v109
    v_bitop3_b32 v12, v6, v13, v12 bitop3:0xca
    v_add_lshl_u32 v11, v11, s40, 17
    v_lshlrev_b16 v14, 8, v14
    v_lshrrev_b32 v13, 2, v113
    v_or_b32 v109, v12, v11
    v_bitop3_b32 v113, v5, v13, v14 bitop3:0xea
    ds_add_u32 v113, v2
    v_cvt_pk_bf16_f32 v106, v7, v8
    v_perm_b32 v12, v106, v106, s41
    v_bitop3_b32 v108, v4, v12, v108 bitop3:0xca
    v_perm_b32 v13, v106, v106, s42
    v_bitop3_b32 v109, v4, v13, v109 bitop3:0xca
    v_mul_hi_u32_u24 v14, 429497, v110
    v_lshrrev_b32 v12, 3, v114
    v_cos_f32 v9, v9
    v_lshlrev_b16 v13, 3, v114
    v_mad_i32_i24 v11, v14, s55, v110
    v_bitop3_b32 v12, v6, v13, v12 bitop3:0xca
    v_add_lshl_u32 v11, v11, s40, 17
    v_lshlrev_b16 v14, 8, v14
    v_lshrrev_b32 v13, 2, v114
    v_or_b32 v110, v12, v11
    v_bitop3_b32 v114, v5, v13, v14 bitop3:0xea
    ds_add_u32 v114, v2
    v_mul_hi_u32_u24 v14, 429497, v111
    v_lshrrev_b32 v12, 3, v115
    v_cos_f32 v10, v10
    v_lshlrev_b16 v13, 3, v115
    v_mad_i32_i24 v11, v14, s55, v111
    v_bitop3_b32 v12, v6, v13, v12 bitop3:0xca
    v_add_lshl_u32 v11, v11, s40, 17
    v_lshlrev_b16 v14, 8, v14
    v_lshrrev_b32 v13, 2, v115
    v_or_b32 v111, v12, v11
    v_bitop3_b32 v115, v5, v13, v14 bitop3:0xea
    ds_add_u32 v115, v2
    v_cvt_pk_bf16_f32 v107, v9, v10
    v_perm_b32 v12, v107, v107, s41
    v_bitop3_b32 v110, v4, v12, v110 bitop3:0xca
    v_perm_b32 v13, v107, v107, s42
    v_bitop3_b32 v111, v4, v13, v111 bitop3:0xca
    s_waitcnt vmcnt(16)
    v_lshlrev_b32 v7, 16, v124
    v_and_b32 v8, 0xffff0000, v124
    v_lshlrev_b32 v9, 16, v125
    v_and_b32 v10, 0xffff0000, v125
    v_mul_f32 v7, 0.15915494, v7
    v_mul_f32 v8, 0.15915494, v8
    v_mul_f32 v9, 0.15915494, v9
    v_mul_f32 v10, 0.15915494, v10
    v_mul_hi_u32_u24 v14, 429497, v116
    v_lshrrev_b32 v12, 3, v120
    v_cos_f32 v7, v7
    v_lshlrev_b16 v13, 3, v120
    v_mad_i32_i24 v11, v14, s55, v116
    v_bitop3_b32 v12, v6, v13, v12 bitop3:0xca
    v_add_lshl_u32 v11, v11, s40, 17
    v_lshlrev_b16 v14, 8, v14
    v_lshrrev_b32 v13, 2, v120
    v_or_b32 v116, v12, v11
    v_bitop3_b32 v120, v5, v13, v14 bitop3:0xea
    ds_add_u32 v120, v2
    v_mul_hi_u32_u24 v14, 429497, v117
    v_lshrrev_b32 v12, 3, v121
    v_cos_f32 v8, v8
    v_lshlrev_b16 v13, 3, v121
    v_mad_i32_i24 v11, v14, s55, v117
    v_bitop3_b32 v12, v6, v13, v12 bitop3:0xca
    v_add_lshl_u32 v11, v11, s40, 17
    v_lshlrev_b16 v14, 8, v14
    v_lshrrev_b32 v13, 2, v121
    v_or_b32 v117, v12, v11
    v_bitop3_b32 v121, v5, v13, v14 bitop3:0xea
    ds_add_u32 v121, v2
    v_cvt_pk_bf16_f32 v124, v7, v8
    v_perm_b32 v12, v124, v124, s41
    v_bitop3_b32 v116, v4, v12, v116 bitop3:0xca
    v_perm_b32 v13, v124, v124, s42
    v_bitop3_b32 v117, v4, v13, v117 bitop3:0xca
    v_mul_hi_u32_u24 v14, 429497, v118
    v_lshrrev_b32 v12, 3, v122
    v_cos_f32 v9, v9
    v_lshlrev_b16 v13, 3, v122
    v_mad_i32_i24 v11, v14, s55, v118
    v_bitop3_b32 v12, v6, v13, v12 bitop3:0xca
    v_add_lshl_u32 v11, v11, s40, 17
    v_lshlrev_b16 v14, 8, v14
    v_lshrrev_b32 v13, 2, v122
    v_or_b32 v118, v12, v11
    v_bitop3_b32 v122, v5, v13, v14 bitop3:0xea
    ds_add_u32 v122, v2
    v_mul_hi_u32_u24 v14, 429497, v119
    v_lshrrev_b32 v12, 3, v123
    v_cos_f32 v10, v10
    v_lshlrev_b16 v13, 3, v123
    v_mad_i32_i24 v11, v14, s55, v119
    v_bitop3_b32 v12, v6, v13, v12 bitop3:0xca
    v_add_lshl_u32 v11, v11, s40, 17
    v_lshlrev_b16 v14, 8, v14
    v_lshrrev_b32 v13, 2, v123
    v_or_b32 v119, v12, v11
    v_bitop3_b32 v123, v5, v13, v14 bitop3:0xea
    ds_add_u32 v123, v2
    v_cvt_pk_bf16_f32 v125, v9, v10
    v_perm_b32 v12, v125, v125, s41
    v_bitop3_b32 v118, v4, v12, v118 bitop3:0xca
    v_perm_b32 v13, v125, v125, s42
    v_bitop3_b32 v119, v4, v13, v119 bitop3:0xca
    s_add_u32 s44, s35, 0x8000
    buffer_store_dwordx4 v[68:71], v0, s[20:23], s44 offen sc1
    s_add_u32 s45, s33, 0x4000000
    s_nop 0
    buffer_load_dwordx4 v[68:71], v0, s[8:11], s45 offen nt
    s_waitcnt vmcnt(16)
    v_lshlrev_b32 v7, 16, v126
    v_and_b32 v8, 0xffff0000, v126
    v_lshlrev_b32 v9, 16, v127
    v_and_b32 v10, 0xffff0000, v127
    v_mul_f32 v7, 0.15915494, v7
    v_mul_f32 v8, 0.15915494, v8
    v_mul_f32 v9, 0.15915494, v9
    v_mul_f32 v10, 0.15915494, v10
    v_mul_hi_u32_u24 v14, 429497, v16
    v_lshrrev_b32 v12, 3, v20
    v_cos_f32 v7, v7
    v_lshlrev_b16 v13, 3, v20
    v_mad_i32_i24 v11, v14, s55, v16
    v_bitop3_b32 v12, v6, v13, v12 bitop3:0xca
    v_add_lshl_u32 v11, v11, s40, 17
    v_lshlrev_b16 v14, 8, v14
    v_lshrrev_b32 v13, 2, v20
    v_or_b32 v16, v12, v11
    v_bitop3_b32 v20, v5, v13, v14 bitop3:0xea
    ds_add_u32 v20, v2
    v_mul_hi_u32_u24 v14, 429497, v17
    v_lshrrev_b32 v12, 3, v21
    v_cos_f32 v8, v8
    v_lshlrev_b16 v13, 3, v21
    v_mad_i32_i24 v11, v14, s55, v17
    v_bitop3_b32 v12, v6, v13, v12 bitop3:0xca
    v_add_lshl_u32 v11, v11, s40, 17
    v_lshlrev_b16 v14, 8, v14
    v_lshrrev_b32 v13, 2, v21
    v_or_b32 v17, v12, v11
    v_bitop3_b32 v21, v5, v13, v14 bitop3:0xea
    ds_add_u32 v21, v2
    v_cvt_pk_bf16_f32 v126, v7, v8
    v_perm_b32 v12, v126, v126, s41
    v_bitop3_b32 v16, v4, v12, v16 bitop3:0xca
    v_perm_b32 v13, v126, v126, s42
    v_bitop3_b32 v17, v4, v13, v17 bitop3:0xca
    v_mul_hi_u32_u24 v14, 429497, v18
    v_lshrrev_b32 v12, 3, v22
    v_cos_f32 v9, v9
    v_lshlrev_b16 v13, 3, v22
    v_mad_i32_i24 v11, v14, s55, v18
    v_bitop3_b32 v12, v6, v13, v12 bitop3:0xca
    v_add_lshl_u32 v11, v11, s40, 17
    v_lshlrev_b16 v14, 8, v14
    v_lshrrev_b32 v13, 2, v22
    v_or_b32 v18, v12, v11
    v_bitop3_b32 v22, v5, v13, v14 bitop3:0xea
    ds_add_u32 v22, v2
    v_mul_hi_u32_u24 v14, 429497, v19
    v_lshrrev_b32 v12, 3, v23
    v_cos_f32 v10, v10
    v_lshlrev_b16 v13, 3, v23
    v_mad_i32_i24 v11, v14, s55, v19
    v_bitop3_b32 v12, v6, v13, v12 bitop3:0xca
    v_add_lshl_u32 v11, v11, s40, 17
    v_lshlrev_b16 v14, 8, v14
    v_lshrrev_b32 v13, 2, v23
    v_or_b32 v19, v12, v11
    v_bitop3_b32 v23, v5, v13, v14 bitop3:0xea
    ds_add_u32 v23, v2
    v_cvt_pk_bf16_f32 v127, v9, v10
    v_perm_b32 v12, v127, v127, s41
    v_bitop3_b32 v18, v4, v12, v18 bitop3:0xca
    v_perm_b32 v13, v127, v127, s42
    v_bitop3_b32 v19, v4, v13, v19 bitop3:0xca
    s_waitcnt vmcnt(12)
    v_lshlrev_b32 v7, 16, v24
    v_and_b32 v8, 0xffff0000, v24
    v_lshlrev_b32 v9, 16, v25
    v_and_b32 v10, 0xffff0000, v25
    v_mul_f32 v7, 0.15915494, v7
    v_mul_f32 v8, 0.15915494, v8
    v_mul_f32 v9, 0.15915494, v9
    v_mul_f32 v10, 0.15915494, v10
    v_mul_hi_u32_u24 v14, 429497, v28
    v_lshrrev_b32 v12, 3, v32
    v_cos_f32 v7, v7
    v_lshlrev_b16 v13, 3, v32
    v_mad_i32_i24 v11, v14, s55, v28
    v_bitop3_b32 v12, v6, v13, v12 bitop3:0xca
    v_add_lshl_u32 v11, v11, s40, 17
    v_lshlrev_b16 v14, 8, v14
    v_lshrrev_b32 v13, 2, v32
    v_or_b32 v28, v12, v11
    v_bitop3_b32 v32, v5, v13, v14 bitop3:0xea
    ds_add_u32 v32, v2
    v_mul_hi_u32_u24 v14, 429497, v29
    v_lshrrev_b32 v12, 3, v33
    v_cos_f32 v8, v8
    v_lshlrev_b16 v13, 3, v33
    v_mad_i32_i24 v11, v14, s55, v29
    v_bitop3_b32 v12, v6, v13, v12 bitop3:0xca
    v_add_lshl_u32 v11, v11, s40, 17
    v_lshlrev_b16 v14, 8, v14
    v_lshrrev_b32 v13, 2, v33
    v_or_b32 v29, v12, v11
    v_bitop3_b32 v33, v5, v13, v14 bitop3:0xea
    ds_add_u32 v33, v2
    v_cvt_pk_bf16_f32 v24, v7, v8
    v_perm_b32 v12, v24, v24, s41
    v_bitop3_b32 v28, v4, v12, v28 bitop3:0xca
    v_perm_b32 v13, v24, v24, s42
    v_bitop3_b32 v29, v4, v13, v29 bitop3:0xca
    v_mul_hi_u32_u24 v14, 429497, v30
    v_lshrrev_b32 v12, 3, v34
    v_cos_f32 v9, v9
    v_lshlrev_b16 v13, 3, v34
    v_mad_i32_i24 v11, v14, s55, v30
    v_bitop3_b32 v12, v6, v13, v12 bitop3:0xca
    v_add_lshl_u32 v11, v11, s40, 17
    v_lshlrev_b16 v14, 8, v14
    v_lshrrev_b32 v13, 2, v34
    v_or_b32 v30, v12, v11
    v_bitop3_b32 v34, v5, v13, v14 bitop3:0xea
    ds_add_u32 v34, v2
    v_mul_hi_u32_u24 v14, 429497, v31
    v_lshrrev_b32 v12, 3, v35
    v_cos_f32 v10, v10
    v_lshlrev_b16 v13, 3, v35
    v_mad_i32_i24 v11, v14, s55, v31
    v_bitop3_b32 v12, v6, v13, v12 bitop3:0xca
    v_add_lshl_u32 v11, v11, s40, 17
    v_lshlrev_b16 v14, 8, v14
    v_lshrrev_b32 v13, 2, v35
    v_or_b32 v31, v12, v11
    v_bitop3_b32 v35, v5, v13, v14 bitop3:0xea
    ds_add_u32 v35, v2
    v_cvt_pk_bf16_f32 v25, v9, v10
    v_perm_b32 v12, v25, v25, s41
    v_bitop3_b32 v30, v4, v12, v30 bitop3:0xca
    v_perm_b32 v13, v25, v25, s42
    v_bitop3_b32 v31, v4, v13, v31 bitop3:0xca
    s_waitcnt vmcnt(10)
    v_lshlrev_b32 v7, 16, v26
    v_and_b32 v8, 0xffff0000, v26
    v_lshlrev_b32 v9, 16, v27
    v_and_b32 v10, 0xffff0000, v27
    v_mul_f32 v7, 0.15915494, v7
    v_mul_f32 v8, 0.15915494, v8
    v_mul_f32 v9, 0.15915494, v9
    v_mul_f32 v10, 0.15915494, v10
    v_mul_hi_u32_u24 v14, 429497, v36
    v_lshrrev_b32 v12, 3, v40
    v_cos_f32 v7, v7
    v_lshlrev_b16 v13, 3, v40
    v_mad_i32_i24 v11, v14, s55, v36
    v_bitop3_b32 v12, v6, v13, v12 bitop3:0xca
    v_add_lshl_u32 v11, v11, s40, 17
    v_lshlrev_b16 v14, 8, v14
    v_lshrrev_b32 v13, 2, v40
    v_or_b32 v36, v12, v11
    v_bitop3_b32 v40, v5, v13, v14 bitop3:0xea
    ds_add_u32 v40, v2
    v_mul_hi_u32_u24 v14, 429497, v37
    v_lshrrev_b32 v12, 3, v41
    v_cos_f32 v8, v8
    v_lshlrev_b16 v13, 3, v41
    v_mad_i32_i24 v11, v14, s55, v37
    v_bitop3_b32 v12, v6, v13, v12 bitop3:0xca
    v_add_lshl_u32 v11, v11, s40, 17
    v_lshlrev_b16 v14, 8, v14
    v_lshrrev_b32 v13, 2, v41
    v_or_b32 v37, v12, v11
    v_bitop3_b32 v41, v5, v13, v14 bitop3:0xea
    ds_add_u32 v41, v2
    v_cvt_pk_bf16_f32 v26, v7, v8
    v_perm_b32 v12, v26, v26, s41
    v_bitop3_b32 v36, v4, v12, v36 bitop3:0xca
    v_perm_b32 v13, v26, v26, s42
    v_bitop3_b32 v37, v4, v13, v37 bitop3:0xca
    v_mul_hi_u32_u24 v14, 429497, v38
    v_lshrrev_b32 v12, 3, v42
    v_cos_f32 v9, v9
    v_lshlrev_b16 v13, 3, v42
    v_mad_i32_i24 v11, v14, s55, v38
    v_bitop3_b32 v12, v6, v13, v12 bitop3:0xca
    v_add_lshl_u32 v11, v11, s40, 17
    v_lshlrev_b16 v14, 8, v14
    v_lshrrev_b32 v13, 2, v42
    v_or_b32 v38, v12, v11
    v_bitop3_b32 v42, v5, v13, v14 bitop3:0xea
    ds_add_u32 v42, v2
    v_mul_hi_u32_u24 v14, 429497, v39
    v_lshrrev_b32 v12, 3, v43
    v_cos_f32 v10, v10
    v_lshlrev_b16 v13, 3, v43
    v_mad_i32_i24 v11, v14, s55, v39
    v_bitop3_b32 v12, v6, v13, v12 bitop3:0xca
    v_add_lshl_u32 v11, v11, s40, 17
    v_lshlrev_b16 v14, 8, v14
    v_lshrrev_b32 v13, 2, v43
    v_or_b32 v39, v12, v11
    v_bitop3_b32 v43, v5, v13, v14 bitop3:0xea
    ds_add_u32 v43, v2
    v_cvt_pk_bf16_f32 v27, v9, v10
    v_perm_b32 v12, v27, v27, s41
    v_bitop3_b32 v38, v4, v12, v38 bitop3:0xca
    v_perm_b32 v13, v27, v27, s42
    v_bitop3_b32 v39, v4, v13, v39 bitop3:0xca
    s_add_u32 s46, s35, 0xc000
    buffer_store_dwordx4 v[72:75], v0, s[20:23], s46 offen sc1
    s_add_u32 s47, s33, 0x4000000
    s_nop 0
    buffer_load_dwordx4 v[72:75], v0, s[12:15], s47 offen nt
    s_waitcnt vmcnt(8)
    v_lshlrev_b32 v7, 16, v44
    v_and_b32 v8, 0xffff0000, v44
    v_lshlrev_b32 v9, 16, v45
    v_and_b32 v10, 0xffff0000, v45
    v_mul_f32 v7, 0.15915494, v7
    v_mul_f32 v8, 0.15915494, v8
    v_mul_f32 v9, 0.15915494, v9
    v_mul_f32 v10, 0.15915494, v10
    v_mul_hi_u32_u24 v14, 429497, v48
    v_lshrrev_b32 v12, 3, v52
    v_cos_f32 v7, v7
    v_lshlrev_b16 v13, 3, v52
    v_mad_i32_i24 v11, v14, s55, v48
    v_bitop3_b32 v12, v6, v13, v12 bitop3:0xca
    v_add_lshl_u32 v11, v11, s40, 17
    v_lshlrev_b16 v14, 8, v14
    v_lshrrev_b32 v13, 2, v52
    v_or_b32 v48, v12, v11
    v_bitop3_b32 v52, v5, v13, v14 bitop3:0xea
    ds_add_u32 v52, v2
    v_mul_hi_u32_u24 v14, 429497, v49
    v_lshrrev_b32 v12, 3, v53
    v_cos_f32 v8, v8
    v_lshlrev_b16 v13, 3, v53
    v_mad_i32_i24 v11, v14, s55, v49
    v_bitop3_b32 v12, v6, v13, v12 bitop3:0xca
    v_add_lshl_u32 v11, v11, s40, 17
    v_lshlrev_b16 v14, 8, v14
    v_lshrrev_b32 v13, 2, v53
    v_or_b32 v49, v12, v11
    v_bitop3_b32 v53, v5, v13, v14 bitop3:0xea
    ds_add_u32 v53, v2
    v_cvt_pk_bf16_f32 v44, v7, v8
    v_perm_b32 v12, v44, v44, s41
    v_bitop3_b32 v48, v4, v12, v48 bitop3:0xca
    v_perm_b32 v13, v44, v44, s42
    v_bitop3_b32 v49, v4, v13, v49 bitop3:0xca
    v_mul_hi_u32_u24 v14, 429497, v50
    v_lshrrev_b32 v12, 3, v54
    v_cos_f32 v9, v9
    v_lshlrev_b16 v13, 3, v54
    v_mad_i32_i24 v11, v14, s55, v50
    v_bitop3_b32 v12, v6, v13, v12 bitop3:0xca
    v_add_lshl_u32 v11, v11, s40, 17
    v_lshlrev_b16 v14, 8, v14
    v_lshrrev_b32 v13, 2, v54
    v_or_b32 v50, v12, v11
    v_bitop3_b32 v54, v5, v13, v14 bitop3:0xea
    ds_add_u32 v54, v2
    v_mul_hi_u32_u24 v14, 429497, v51
    v_lshrrev_b32 v12, 3, v55
    v_cos_f32 v10, v10
    v_lshlrev_b16 v13, 3, v55
    v_mad_i32_i24 v11, v14, s55, v51
    v_bitop3_b32 v12, v6, v13, v12 bitop3:0xca
    v_add_lshl_u32 v11, v11, s40, 17
    v_lshlrev_b16 v14, 8, v14
    v_lshrrev_b32 v13, 2, v55
    v_or_b32 v51, v12, v11
    v_bitop3_b32 v55, v5, v13, v14 bitop3:0xea
    ds_add_u32 v55, v2
    v_cvt_pk_bf16_f32 v45, v9, v10
    v_perm_b32 v12, v45, v45, s41
    v_bitop3_b32 v50, v4, v12, v50 bitop3:0xca
    v_perm_b32 v13, v45, v45, s42
    v_bitop3_b32 v51, v4, v13, v51 bitop3:0xca
    s_waitcnt vmcnt(4)
    v_lshlrev_b32 v7, 16, v46
    v_and_b32 v8, 0xffff0000, v46
    v_lshlrev_b32 v9, 16, v47
    v_and_b32 v10, 0xffff0000, v47
    v_mul_f32 v7, 0.15915494, v7
    v_mul_f32 v8, 0.15915494, v8
    v_mul_f32 v9, 0.15915494, v9
    v_mul_f32 v10, 0.15915494, v10
    v_mul_hi_u32_u24 v14, 429497, v56
    v_lshrrev_b32 v12, 3, v60
    v_cos_f32 v7, v7
    v_lshlrev_b16 v13, 3, v60
    v_mad_i32_i24 v11, v14, s55, v56
    v_bitop3_b32 v12, v6, v13, v12 bitop3:0xca
    v_add_lshl_u32 v11, v11, s40, 17
    v_lshlrev_b16 v14, 8, v14
    v_lshrrev_b32 v13, 2, v60
    v_or_b32 v56, v12, v11
    v_bitop3_b32 v60, v5, v13, v14 bitop3:0xea
    ds_add_u32 v60, v2
    v_mul_hi_u32_u24 v14, 429497, v57
    v_lshrrev_b32 v12, 3, v61
    v_cos_f32 v8, v8
    v_lshlrev_b16 v13, 3, v61
    v_mad_i32_i24 v11, v14, s55, v57
    v_bitop3_b32 v12, v6, v13, v12 bitop3:0xca
    v_add_lshl_u32 v11, v11, s40, 17
    v_lshlrev_b16 v14, 8, v14
    v_lshrrev_b32 v13, 2, v61
    v_or_b32 v57, v12, v11
    v_bitop3_b32 v61, v5, v13, v14 bitop3:0xea
    ds_add_u32 v61, v2
    v_cvt_pk_bf16_f32 v46, v7, v8
    v_perm_b32 v12, v46, v46, s41
    v_bitop3_b32 v56, v4, v12, v56 bitop3:0xca
    v_perm_b32 v13, v46, v46, s42
    v_bitop3_b32 v57, v4, v13, v57 bitop3:0xca
    v_mul_hi_u32_u24 v14, 429497, v58
    v_lshrrev_b32 v12, 3, v62
    v_cos_f32 v9, v9
    v_lshlrev_b16 v13, 3, v62
    v_mad_i32_i24 v11, v14, s55, v58
    v_bitop3_b32 v12, v6, v13, v12 bitop3:0xca
    v_add_lshl_u32 v11, v11, s40, 17
    v_lshlrev_b16 v14, 8, v14
    v_lshrrev_b32 v13, 2, v62
    v_or_b32 v58, v12, v11
    v_bitop3_b32 v62, v5, v13, v14 bitop3:0xea
    ds_add_u32 v62, v2
    v_mul_hi_u32_u24 v14, 429497, v59
    v_lshrrev_b32 v12, 3, v63
    v_cos_f32 v10, v10
    v_lshlrev_b16 v13, 3, v63
    v_mad_i32_i24 v11, v14, s55, v59
    v_bitop3_b32 v12, v6, v13, v12 bitop3:0xca
    v_add_lshl_u32 v11, v11, s40, 17
    v_lshlrev_b16 v14, 8, v14
    v_lshrrev_b32 v13, 2, v63
    v_or_b32 v59, v12, v11
    v_bitop3_b32 v63, v5, v13, v14 bitop3:0xea
    ds_add_u32 v63, v2
    v_cvt_pk_bf16_f32 v47, v9, v10
    v_perm_b32 v12, v47, v47, s41
    v_bitop3_b32 v58, v4, v12, v58 bitop3:0xca
    v_perm_b32 v13, v47, v47, s42
    v_bitop3_b32 v59, v4, v13, v59 bitop3:0xca
    v_lshrrev_b32 v8, 2, v0
    v_and_b32 v7, 0x3c00, v0
    v_bitop3_b32 v7, v5, v8, v7 bitop3:0xea
    s_waitcnt lgkmcnt(0)
    s_barrier
    ds_read2st64_b32 v[8:9], v7 offset0:0 offset1:1
    ds_read2st64_b32 v[10:11], v7 offset0:2 offset1:3
    s_add_u32 s44, s35, 0x10000
    buffer_store_dwordx4 v[64:67], v0, s[20:23], s44 offen sc1
    s_add_u32 s45, s34, 0x2000000
    s_nop 0
    buffer_load_dwordx2 v[64:65], v1, s[16:19], s45 offen nt
    s_add_u32 s46, s34, 0x2200000
    buffer_load_dwordx2 v[66:67], v1, s[16:19], s46 offen nt
    s_waitcnt lgkmcnt(0)
    v_lshl_or_b32 v12, v9, 16, v8
    v_lshl_or_b32 v13, v11, 16, v10
    v_mov_b32 v14, v12
    v_mov_b32 v15, v13
    s_nop 0
    v_add_u32_dpp v14, v14, v14 row_shr:1 row_mask:0xf bank_mask:0xf bound_ctrl:1
    v_add_u32_dpp v15, v15, v15 row_shr:1 row_mask:0xf bank_mask:0xf bound_ctrl:1
    s_nop 0
    v_add_u32_dpp v14, v14, v14 row_shr:2 row_mask:0xf bank_mask:0xf bound_ctrl:1
    v_add_u32_dpp v15, v15, v15 row_shr:2 row_mask:0xf bank_mask:0xf bound_ctrl:1
    s_nop 0
    v_add_u32_dpp v14, v14, v14 row_shr:4 row_mask:0xf bank_mask:0xf bound_ctrl:1
    v_add_u32_dpp v15, v15, v15 row_shr:4 row_mask:0xf bank_mask:0xf bound_ctrl:1
    s_nop 0
    v_add_u32_dpp v14, v14, v14 row_shr:8 row_mask:0xf bank_mask:0xf bound_ctrl:1
    v_add_u32_dpp v15, v15, v15 row_shr:8 row_mask:0xf bank_mask:0xf bound_ctrl:1
    s_nop 0
    v_add_u32_dpp v14, v14, v14 row_bcast:15 row_mask:0xa bank_mask:0xf
    v_add_u32_dpp v15, v15, v15 row_bcast:15 row_mask:0xa bank_mask:0xf
    s_nop 0
    v_add_u32_dpp v14, v14, v14 row_bcast:31 row_mask:0xc bank_mask:0xf
    v_add_u32_dpp v15, v15, v15 row_bcast:31 row_mask:0xc bank_mask:0xf
    v_readlane_b32 s48, v14, 63
    v_readlane_b32 s49, v15, 63
    s_lshl_b32 s54, s32, 2
    v_mov_b32 v8, s54
    s_and_b32 s50, s48, 0xffff
    s_lshr_b32 s51, s48, 16
    s_and_b32 s52, s49, 0xffff
    s_lshr_b32 s53, s49, 16
    s_add_u32 s51, s51, s50
    s_add_u32 s52, s52, s51
    s_add_u32 s53, s53, s52
    v_mov_b32 v9, s53
    s_mov_b64 exec, 1
    ds_write_b32 v8, v9 offset:16384
    s_mov_b64 exec, -1
    v_and_b32 v8, 60, v7
    s_waitcnt lgkmcnt(0)
    s_barrier
    ds_read_b32 v9, v8 offset:16384
    s_waitcnt lgkmcnt(0)
    v_add_u32_dpp v9, v9, v9 row_shr:1 row_mask:0xf bank_mask:0xf bound_ctrl:1
    s_nop 1
    v_add_u32_dpp v9, v9, v9 row_shr:2 row_mask:0xf bank_mask:0xf bound_ctrl:1
    s_nop 1
    v_add_u32_dpp v9, v9, v9 row_shr:4 row_mask:0xf bank_mask:0xf bound_ctrl:1
    s_nop 1
    v_add_u32_dpp v9, v9, v9 row_shr:8 row_mask:0xf bank_mask:0xf bound_ctrl:1
    s_nop 0
    v_readlane_b32 s54, v9, s32
    s_sub_u32 s54, s54, s53
    s_add_u32 s50, s50, s54
    s_add_u32 s51, s51, s54
    s_add_u32 s52, s52, s54
    s_pack_ll_b32_b16 s48, s54, s50
    s_pack_ll_b32_b16 s49, s51, s52
    v_add_u32 v14, s48, v14
    v_add_u32 v15, s49, v15
    v_sub_u32 v12, v14, v12
    v_sub_u32 v13, v15, v13
    v_and_b32 v8, 0xffff, v12
    v_lshrrev_b32 v9, 16, v12
    v_and_b32 v10, 0xffff, v13
    v_lshrrev_b32 v11, 16, v13
    ds_write2st64_b32 v7, v8, v9 offset0:0 offset1:1
    ds_write2st64_b32 v7, v10, v11 offset0:2 offset1:3
    s_waitcnt lgkmcnt(0)
    s_barrier
    ds_add_rtn_u32 v100, v100, v2
    ds_add_rtn_u32 v101, v101, v2
    ds_add_rtn_u32 v102, v102, v2
    ds_add_rtn_u32 v103, v103, v2
    s_add_u32 s47, s36, 0x2a40000
    v_and_b32 v11, 0x3f0, v0
    v_add_u32 v11, v11, v11
    buffer_store_dwordx2 v[12:13], v11, s[24:27], s47 offen
    s_bitset0_b64 exec, 63
    s_not_b64 exec, exec
    buffer_store_dwordx2 v[14:15], v11, s[24:27], s47 offen offset:32
    s_mov_b64 exec, -1
    v_cmp_le_u32 vcc, s37, v0
    v_add_u32 v10, 8320, v0
    s_cmp_lg_u32 s32, 0
    v_cndmask_b32 v10, v0, v10, vcc
    s_cbranch_scc1 L1_p2
    s_add_u32 s44, s35, 0x2a40000
    s_mov_b64 exec, 0xff
    buffer_store_dwordx4 v[12:15], v10, s[24:27], s44 offen
    s_mov_b64 exec, -1
L1_p2:
    ds_add_rtn_u32 v112, v112, v2
    ds_add_rtn_u32 v113, v113, v2
    ds_add_rtn_u32 v114, v114, v2
    ds_add_rtn_u32 v115, v115, v2
    ds_add_rtn_u32 v120, v120, v2
    ds_add_rtn_u32 v121, v121, v2
    ds_add_rtn_u32 v122, v122, v2
    ds_add_rtn_u32 v123, v123, v2
    s_add_u32 s45, s35, 0x14000
    buffer_store_dwordx4 v[76:79], v0, s[20:23], s45 offen sc1
    s_add_u32 s46, s33, 0x4400000
    s_nop 0
    buffer_load_dwordx4 v[76:79], v0, s[8:11], s46 offen nt
    ds_add_rtn_u32 v20, v20, v2
    ds_add_rtn_u32 v21, v21, v2
    ds_add_rtn_u32 v22, v22, v2
    ds_add_rtn_u32 v23, v23, v2
    ds_add_rtn_u32 v32, v32, v2
    ds_add_rtn_u32 v33, v33, v2
    ds_add_rtn_u32 v34, v34, v2
    ds_add_rtn_u32 v35, v35, v2
    ds_add_rtn_u32 v40, v40, v2
    ds_add_rtn_u32 v41, v41, v2
    ds_add_rtn_u32 v42, v42, v2
    ds_add_rtn_u32 v43, v43, v2
    s_add_u32 s47, s35, 0x18000
    buffer_store_dwordx4 v[80:83], v0, s[20:23], s47 offen sc1
    s_add_u32 s44, s33, 0x4400000
    s_nop 0
    buffer_load_dwordx4 v[80:83], v0, s[12:15], s44 offen nt
    ds_add_rtn_u32 v52, v52, v2
    ds_add_rtn_u32 v53, v53, v2
    ds_add_rtn_u32 v54, v54, v2
    ds_add_rtn_u32 v55, v55, v2
    ds_add_rtn_u32 v60, v60, v2
    ds_add_rtn_u32 v61, v61, v2
    ds_add_rtn_u32 v62, v62, v2
    ds_add_rtn_u32 v63, v63, v2
    s_waitcnt lgkmcnt(0)
    s_barrier
    v_and_b32 v7, -4, v100
    v_lshl_add_u32 v8, v100, 2, v7
    ds_write_b32 v8, v96
    v_lshl_add_u32 v7, v7, 2, v100
    ds_write_b8 v7, v104 offset:16
    v_and_b32 v9, -4, v101
    v_lshl_add_u32 v10, v101, 2, v9
    ds_write_b32 v10, v97
    v_lshl_add_u32 v9, v9, 2, v101
    ds_write_b8_d16_hi v9, v104 offset:16
    v_and_b32 v7, -4, v102
    v_lshl_add_u32 v8, v102, 2, v7
    ds_write_b32 v8, v98
    v_lshl_add_u32 v7, v7, 2, v102
    ds_write_b8 v7, v105 offset:16
    v_and_b32 v9, -4, v103
    v_lshl_add_u32 v10, v103, 2, v9
    ds_write_b32 v10, v99
    v_lshl_add_u32 v9, v9, 2, v103
    ds_write_b8_d16_hi v9, v105 offset:16
    s_add_u32 s45, s35, 0x1c000
    buffer_store_dwordx4 v[88:91], v0, s[20:23], s45 offen sc1
    s_add_u32 s46, s33, 0x4800000
    buffer_load_dwordx4 v[96:99], v0, s[8:11], s46 offen nt
    s_add_u32 s47, s33, 0x4800000
    buffer_load_dwordx4 v[100:103], v0, s[12:15], s47 offen nt
    v_and_b32 v7, -4, v112
    v_lshl_add_u32 v8, v112, 2, v7
    ds_write_b32 v8, v108
    v_lshl_add_u32 v7, v7, 2, v112
    ds_write_b8 v7, v106 offset:16
    v_and_b32 v9, -4, v113
    v_lshl_add_u32 v10, v113, 2, v9
    ds_write_b32 v10, v109
    v_lshl_add_u32 v9, v9, 2, v113
    ds_write_b8_d16_hi v9, v106 offset:16
    v_and_b32 v7, -4, v114
    v_lshl_add_u32 v8, v114, 2, v7
    ds_write_b32 v8, v110
    v_lshl_add_u32 v7, v7, 2, v114
    ds_write_b8 v7, v107 offset:16
    v_and_b32 v9, -4, v115
    v_lshl_add_u32 v10, v115, 2, v9
    ds_write_b32 v10, v111
    v_lshl_add_u32 v9, v9, 2, v115
    ds_write_b8_d16_hi v9, v107 offset:16
    s_add_u32 s44, s34, 0x2400000
    buffer_load_dwordx2 v[88:89], v1, s[16:19], s44 offen nt
    s_add_u32 s45, s34, 0x2600000
    buffer_load_dwordx2 v[90:91], v1, s[16:19], s45 offen nt
    s_add_u32 s46, s33, 0x4c00000
    buffer_load_dwordx4 v[108:111], v0, s[8:11], s46 offen nt
    v_and_b32 v7, -4, v120
    v_lshl_add_u32 v8, v120, 2, v7
    ds_write_b32 v8, v116
    v_lshl_add_u32 v7, v7, 2, v120
    ds_write_b8 v7, v124 offset:16
    v_and_b32 v9, -4, v121
    v_lshl_add_u32 v10, v121, 2, v9
    ds_write_b32 v10, v117
    v_lshl_add_u32 v9, v9, 2, v121
    ds_write_b8_d16_hi v9, v124 offset:16
    v_and_b32 v7, -4, v122
    v_lshl_add_u32 v8, v122, 2, v7
    ds_write_b32 v8, v118
    v_lshl_add_u32 v7, v7, 2, v122
    ds_write_b8 v7, v125 offset:16
    v_and_b32 v9, -4, v123
    v_lshl_add_u32 v10, v123, 2, v9
    ds_write_b32 v10, v119
    v_lshl_add_u32 v9, v9, 2, v123
    ds_write_b8_d16_hi v9, v125 offset:16
    s_add_u32 s47, s35, 0x20000
    buffer_store_dwordx4 v[92:95], v0, s[20:23], s47 offen sc1
    s_add_u32 s44, s33, 0x4c00000
    buffer_load_dwordx4 v[112:115], v0, s[12:15], s44 offen nt
    v_and_b32 v7, -4, v20
    v_lshl_add_u32 v8, v20, 2, v7
    ds_write_b32 v8, v16
    v_lshl_add_u32 v7, v7, 2, v20
    ds_write_b8 v7, v126 offset:16
    v_and_b32 v9, -4, v21
    v_lshl_add_u32 v10, v21, 2, v9
    ds_write_b32 v10, v17
    v_lshl_add_u32 v9, v9, 2, v21
    ds_write_b8_d16_hi v9, v126 offset:16
    v_and_b32 v7, -4, v22
    v_lshl_add_u32 v8, v22, 2, v7
    ds_write_b32 v8, v18
    v_lshl_add_u32 v7, v7, 2, v22
    ds_write_b8 v7, v127 offset:16
    v_and_b32 v9, -4, v23
    v_lshl_add_u32 v10, v23, 2, v9
    ds_write_b32 v10, v19
    v_lshl_add_u32 v9, v9, 2, v23
    ds_write_b8_d16_hi v9, v127 offset:16
    s_add_u32 s45, s33, 0x5000000
    buffer_load_dwordx4 v[104:107], v0, s[8:11], s45 offen nt
    s_add_u32 s46, s33, 0x5000000
    buffer_load_dwordx4 v[116:119], v0, s[12:15], s46 offen nt
    v_and_b32 v7, -4, v32
    v_lshl_add_u32 v8, v32, 2, v7
    ds_write_b32 v8, v28
    v_lshl_add_u32 v7, v7, 2, v32
    ds_write_b8 v7, v24 offset:16
    v_and_b32 v9, -4, v33
    v_lshl_add_u32 v10, v33, 2, v9
    ds_write_b32 v10, v29
    v_lshl_add_u32 v9, v9, 2, v33
    ds_write_b8_d16_hi v9, v24 offset:16
    v_and_b32 v7, -4, v34
    v_lshl_add_u32 v8, v34, 2, v7
    ds_write_b32 v8, v30
    v_lshl_add_u32 v7, v7, 2, v34
    ds_write_b8 v7, v25 offset:16
    v_and_b32 v9, -4, v35
    v_lshl_add_u32 v10, v35, 2, v9
    ds_write_b32 v10, v31
    v_lshl_add_u32 v9, v9, 2, v35
    ds_write_b8_d16_hi v9, v25 offset:16
    s_add_u32 s47, s34, 0x2800000
    buffer_load_dwordx2 v[120:121], v1, s[16:19], s47 offen nt
    s_add_u32 s44, s34, 0x2a00000
    buffer_load_dwordx2 v[122:123], v1, s[16:19], s44 offen nt
    s_add_u32 s45, s33, 0x5400000
    buffer_load_dwordx4 v[92:95], v0, s[8:11], s45 offen nt
    v_and_b32 v7, -4, v40
    v_lshl_add_u32 v8, v40, 2, v7
    ds_write_b32 v8, v36
    v_lshl_add_u32 v7, v7, 2, v40
    ds_write_b8 v7, v26 offset:16
    v_and_b32 v9, -4, v41
    v_lshl_add_u32 v10, v41, 2, v9
    ds_write_b32 v10, v37
    v_lshl_add_u32 v9, v9, 2, v41
    ds_write_b8_d16_hi v9, v26 offset:16
    v_and_b32 v7, -4, v42
    v_lshl_add_u32 v8, v42, 2, v7
    ds_write_b32 v8, v38
    v_lshl_add_u32 v7, v7, 2, v42
    ds_write_b8 v7, v27 offset:16
    v_and_b32 v9, -4, v43
    v_lshl_add_u32 v10, v43, 2, v9
    ds_write_b32 v10, v39
    v_lshl_add_u32 v9, v9, 2, v43
    ds_write_b8_d16_hi v9, v27 offset:16
    s_add_u32 s46, s35, 0x24000
    buffer_store_dwordx4 v[84:87], v0, s[20:23], s46 offen sc1
    s_add_u32 s47, s33, 0x5400000
    buffer_load_dwordx4 v[16:19], v0, s[12:15], s47 offen nt
    v_and_b32 v7, -4, v52
    v_lshl_add_u32 v8, v52, 2, v7
    ds_write_b32 v8, v48
    v_lshl_add_u32 v7, v7, 2, v52
    ds_write_b8 v7, v44 offset:16
    v_and_b32 v9, -4, v53
    v_lshl_add_u32 v10, v53, 2, v9
    ds_write_b32 v10, v49
    v_lshl_add_u32 v9, v9, 2, v53
    ds_write_b8_d16_hi v9, v44 offset:16
    v_and_b32 v7, -4, v54
    v_lshl_add_u32 v8, v54, 2, v7
    ds_write_b32 v8, v50
    v_lshl_add_u32 v7, v7, 2, v54
    ds_write_b8 v7, v45 offset:16
    v_and_b32 v9, -4, v55
    v_lshl_add_u32 v10, v55, 2, v9
    ds_write_b32 v10, v51
    v_lshl_add_u32 v9, v9, 2, v55
    ds_write_b8_d16_hi v9, v45 offset:16
    s_add_u32 s44, s33, 0x5800000
    buffer_load_dwordx4 v[20:23], v0, s[8:11], s44 offen nt
    s_add_u32 s45, s33, 0x5800000
    buffer_load_dwordx4 v[124:127], v0, s[12:15], s45 offen nt
    v_and_b32 v7, -4, v60
    v_lshl_add_u32 v8, v60, 2, v7
    ds_write_b32 v8, v56
    v_lshl_add_u32 v7, v7, 2, v60
    ds_write_b8 v7, v46 offset:16
    v_and_b32 v9, -4, v61
    v_lshl_add_u32 v10, v61, 2, v9
    ds_write_b32 v10, v57
    v_lshl_add_u32 v9, v9, 2, v61
    ds_write_b8_d16_hi v9, v46 offset:16
    v_and_b32 v7, -4, v62
    v_lshl_add_u32 v8, v62, 2, v7
    ds_write_b32 v8, v58
    v_lshl_add_u32 v7, v7, 2, v62
    ds_write_b8 v7, v47 offset:16
    v_and_b32 v9, -4, v63
    v_lshl_add_u32 v10, v63, 2, v9
    ds_write_b32 v10, v59
    v_lshl_add_u32 v9, v9, 2, v63
    ds_write_b8_d16_hi v9, v47 offset:16
    s_add_u32 s46, s34, 0x2c00000
    buffer_load_dwordx2 v[28:29], v1, s[16:19], s46 offen nt
    s_add_u32 s47, s34, 0x2e00000
    buffer_load_dwordx2 v[30:31], v1, s[16:19], s47 offen nt
    v_add_u32 v7, 0x10000, v0
    v_add_u32 v12, 0x20000, v0
    v_mov_b32 v8, 0
    v_mov_b32 v9, 0
    v_mov_b32 v10, 0
    v_mov_b32 v11, 0
    s_waitcnt lgkmcnt(0)
    s_barrier
    ds_read_b128 v[32:35], v0 offset:0
    ds_write_b128 v0, v[8:11]
    ds_read_b128 v[36:39], v0 offset:16384
    ds_read_b128 v[40:43], v0 offset:32768
    ds_read_b128 v[24:27], v0 offset:49152
    ds_read_b128 v[84:87], v7 offset:0
    ds_read_b128 v[48:51], v7 offset:16384
    ds_read_b128 v[52:55], v7 offset:32768
    ds_read_b128 v[56:59], v7 offset:49152
    ds_read_b128 v[60:63], v12 offset:0
    ds_read_b128 v[44:47], v12 offset:16384
    s_waitcnt lgkmcnt(0)
    s_barrier
    s_add_u32 s44, s35, 0x2a40000
    buffer_store_dwordx4 v[32:35], v0, s[20:23], s44 offen sc1
    s_add_u32 s45, s33, 0x5c00000
    s_nop 0
    buffer_load_dwordx4 v[32:35], v0, s[8:11], s45 offen nt
    s_add_u32 s46, s35, 0x2a44000
    buffer_store_dwordx4 v[36:39], v0, s[20:23], s46 offen sc1
    s_add_u32 s47, s33, 0x5c00000
    s_nop 0
    buffer_load_dwordx4 v[36:39], v0, s[12:15], s47 offen nt
    s_waitcnt vmcnt(29)
    v_lshlrev_b32 v7, 16, v64
    v_and_b32 v8, 0xffff0000, v64
    v_lshlrev_b32 v9, 16, v65
    v_and_b32 v10, 0xffff0000, v65
    v_mul_f32 v7, 0.15915494, v7
    v_mul_f32 v8, 0.15915494, v8
    v_mul_f32 v9, 0.15915494, v9
    v_mul_f32 v10, 0.15915494, v10
    v_mul_hi_u32_u24 v14, 429497, v68
    v_lshrrev_b32 v12, 3, v72
    v_cos_f32 v7, v7
    v_lshlrev_b16 v13, 3, v72
    v_mad_i32_i24 v11, v14, s55, v68
    v_bitop3_b32 v12, v6, v13, v12 bitop3:0xca
    v_add_lshl_u32 v11, v11, s40, 17
    v_lshlrev_b16 v14, 8, v14
    v_lshrrev_b32 v13, 2, v72
    v_or_b32 v68, v12, v11
    v_bitop3_b32 v72, v5, v13, v14 bitop3:0xea
    ds_add_u32 v72, v2
    v_mul_hi_u32_u24 v14, 429497, v69
    v_lshrrev_b32 v12, 3, v73
    v_cos_f32 v8, v8
    v_lshlrev_b16 v13, 3, v73
    v_mad_i32_i24 v11, v14, s55, v69
    v_bitop3_b32 v12, v6, v13, v12 bitop3:0xca
    v_add_lshl_u32 v11, v11, s40, 17
    v_lshlrev_b16 v14, 8, v14
    v_lshrrev_b32 v13, 2, v73
    v_or_b32 v69, v12, v11
    v_bitop3_b32 v73, v5, v13, v14 bitop3:0xea
    ds_add_u32 v73, v2
    v_cvt_pk_bf16_f32 v64, v7, v8
    v_perm_b32 v12, v64, v64, s41
    v_bitop3_b32 v68, v4, v12, v68 bitop3:0xca
    v_perm_b32 v13, v64, v64, s42
    v_bitop3_b32 v69, v4, v13, v69 bitop3:0xca
    v_mul_hi_u32_u24 v14, 429497, v70
    v_lshrrev_b32 v12, 3, v74
    v_cos_f32 v9, v9
    v_lshlrev_b16 v13, 3, v74
    v_mad_i32_i24 v11, v14, s55, v70
    v_bitop3_b32 v12, v6, v13, v12 bitop3:0xca
    v_add_lshl_u32 v11, v11, s40, 17
    v_lshlrev_b16 v14, 8, v14
    v_lshrrev_b32 v13, 2, v74
    v_or_b32 v70, v12, v11
    v_bitop3_b32 v74, v5, v13, v14 bitop3:0xea
    ds_add_u32 v74, v2
    v_mul_hi_u32_u24 v14, 429497, v71
    v_lshrrev_b32 v12, 3, v75
    v_cos_f32 v10, v10
    v_lshlrev_b16 v13, 3, v75
    v_mad_i32_i24 v11, v14, s55, v71
    v_bitop3_b32 v12, v6, v13, v12 bitop3:0xca
    v_add_lshl_u32 v11, v11, s40, 17
    v_lshlrev_b16 v14, 8, v14
    v_lshrrev_b32 v13, 2, v75
    v_or_b32 v71, v12, v11
    v_bitop3_b32 v75, v5, v13, v14 bitop3:0xea
    ds_add_u32 v75, v2
    v_cvt_pk_bf16_f32 v65, v9, v10
    v_perm_b32 v12, v65, v65, s41
    v_bitop3_b32 v70, v4, v12, v70 bitop3:0xca
    v_perm_b32 v13, v65, v65, s42
    v_bitop3_b32 v71, v4, v13, v71 bitop3:0xca
    s_waitcnt vmcnt(23)
    v_lshlrev_b32 v7, 16, v66
    v_and_b32 v8, 0xffff0000, v66
    v_lshlrev_b32 v9, 16, v67
    v_and_b32 v10, 0xffff0000, v67
    v_mul_f32 v7, 0.15915494, v7
    v_mul_f32 v8, 0.15915494, v8
    v_mul_f32 v9, 0.15915494, v9
    v_mul_f32 v10, 0.15915494, v10
    v_mul_hi_u32_u24 v14, 429497, v76
    v_lshrrev_b32 v12, 3, v80
    v_cos_f32 v7, v7
    v_lshlrev_b16 v13, 3, v80
    v_mad_i32_i24 v11, v14, s55, v76
    v_bitop3_b32 v12, v6, v13, v12 bitop3:0xca
    v_add_lshl_u32 v11, v11, s40, 17
    v_lshlrev_b16 v14, 8, v14
    v_lshrrev_b32 v13, 2, v80
    v_or_b32 v76, v12, v11
    v_bitop3_b32 v80, v5, v13, v14 bitop3:0xea
    ds_add_u32 v80, v2
    v_mul_hi_u32_u24 v14, 429497, v77
    v_lshrrev_b32 v12, 3, v81
    v_cos_f32 v8, v8
    v_lshlrev_b16 v13, 3, v81
    v_mad_i32_i24 v11, v14, s55, v77
    v_bitop3_b32 v12, v6, v13, v12 bitop3:0xca
    v_add_lshl_u32 v11, v11, s40, 17
    v_lshlrev_b16 v14, 8, v14
    v_lshrrev_b32 v13, 2, v81
    v_or_b32 v77, v12, v11
    v_bitop3_b32 v81, v5, v13, v14 bitop3:0xea
    ds_add_u32 v81, v2
    v_cvt_pk_bf16_f32 v66, v7, v8
    v_perm_b32 v12, v66, v66, s41
    v_bitop3_b32 v76, v4, v12, v76 bitop3:0xca
    v_perm_b32 v13, v66, v66, s42
    v_bitop3_b32 v77, v4, v13, v77 bitop3:0xca
    v_mul_hi_u32_u24 v14, 429497, v78
    v_lshrrev_b32 v12, 3, v82
    v_cos_f32 v9, v9
    v_lshlrev_b16 v13, 3, v82
    v_mad_i32_i24 v11, v14, s55, v78
    v_bitop3_b32 v12, v6, v13, v12 bitop3:0xca
    v_add_lshl_u32 v11, v11, s40, 17
    v_lshlrev_b16 v14, 8, v14
    v_lshrrev_b32 v13, 2, v82
    v_or_b32 v78, v12, v11
    v_bitop3_b32 v82, v5, v13, v14 bitop3:0xea
    ds_add_u32 v82, v2
    v_mul_hi_u32_u24 v14, 429497, v79
    v_lshrrev_b32 v12, 3, v83
    v_cos_f32 v10, v10
    v_lshlrev_b16 v13, 3, v83
    v_mad_i32_i24 v11, v14, s55, v79
    v_bitop3_b32 v12, v6, v13, v12 bitop3:0xca
    v_add_lshl_u32 v11, v11, s40, 17
    v_lshlrev_b16 v14, 8, v14
    v_lshrrev_b32 v13, 2, v83
    v_or_b32 v79, v12, v11
    v_bitop3_b32 v83, v5, v13, v14 bitop3:0xea
    ds_add_u32 v83, v2
    v_cvt_pk_bf16_f32 v67, v9, v10
    v_perm_b32 v12, v67, v67, s41
    v_bitop3_b32 v78, v4, v12, v78 bitop3:0xca
    v_perm_b32 v13, v67, v67, s42
    v_bitop3_b32 v79, v4, v13, v79 bitop3:0xca
    s_waitcnt vmcnt(18)
    v_lshlrev_b32 v7, 16, v88
    v_and_b32 v8, 0xffff0000, v88
    v_lshlrev_b32 v9, 16, v89
    v_and_b32 v10, 0xffff0000, v89
    v_mul_f32 v7, 0.15915494, v7
    v_mul_f32 v8, 0.15915494, v8
    v_mul_f32 v9, 0.15915494, v9
    v_mul_f32 v10, 0.15915494, v10
    v_mul_hi_u32_u24 v14, 429497, v96
    v_lshrrev_b32 v12, 3, v100
    v_cos_f32 v7, v7
    v_lshlrev_b16 v13, 3, v100
    v_mad_i32_i24 v11, v14, s55, v96
    v_bitop3_b32 v12, v6, v13, v12 bitop3:0xca
    v_add_lshl_u32 v11, v11, s40, 17
    v_lshlrev_b16 v14, 8, v14
    v_lshrrev_b32 v13, 2, v100
    v_or_b32 v96, v12, v11
    v_bitop3_b32 v100, v5, v13, v14 bitop3:0xea
    ds_add_u32 v100, v2
    v_mul_hi_u32_u24 v14, 429497, v97
    v_lshrrev_b32 v12, 3, v101
    v_cos_f32 v8, v8
    v_lshlrev_b16 v13, 3, v101
    v_mad_i32_i24 v11, v14, s55, v97
    v_bitop3_b32 v12, v6, v13, v12 bitop3:0xca
    v_add_lshl_u32 v11, v11, s40, 17
    v_lshlrev_b16 v14, 8, v14
    v_lshrrev_b32 v13, 2, v101
    v_or_b32 v97, v12, v11
    v_bitop3_b32 v101, v5, v13, v14 bitop3:0xea
    ds_add_u32 v101, v2
    v_cvt_pk_bf16_f32 v88, v7, v8
    v_perm_b32 v12, v88, v88, s41
    v_bitop3_b32 v96, v4, v12, v96 bitop3:0xca
    v_perm_b32 v13, v88, v88, s42
    v_bitop3_b32 v97, v4, v13, v97 bitop3:0xca
    v_mul_hi_u32_u24 v14, 429497, v98
    v_lshrrev_b32 v12, 3, v102
    v_cos_f32 v9, v9
    v_lshlrev_b16 v13, 3, v102
    v_mad_i32_i24 v11, v14, s55, v98
    v_bitop3_b32 v12, v6, v13, v12 bitop3:0xca
    v_add_lshl_u32 v11, v11, s40, 17
    v_lshlrev_b16 v14, 8, v14
    v_lshrrev_b32 v13, 2, v102
    v_or_b32 v98, v12, v11
    v_bitop3_b32 v102, v5, v13, v14 bitop3:0xea
    ds_add_u32 v102, v2
    v_mul_hi_u32_u24 v14, 429497, v99
    v_lshrrev_b32 v12, 3, v103
    v_cos_f32 v10, v10
    v_lshlrev_b16 v13, 3, v103
    v_mad_i32_i24 v11, v14, s55, v99
    v_bitop3_b32 v12, v6, v13, v12 bitop3:0xca
    v_add_lshl_u32 v11, v11, s40, 17
    v_lshlrev_b16 v14, 8, v14
    v_lshrrev_b32 v13, 2, v103
    v_or_b32 v99, v12, v11
    v_bitop3_b32 v103, v5, v13, v14 bitop3:0xea
    ds_add_u32 v103, v2
    v_cvt_pk_bf16_f32 v89, v9, v10
    v_perm_b32 v12, v89, v89, s41
    v_bitop3_b32 v98, v4, v12, v98 bitop3:0xca
    v_perm_b32 v13, v89, v89, s42
    v_bitop3_b32 v99, v4, v13, v99 bitop3:0xca
    s_add_u32 s44, s35, 0x2a48000
    buffer_store_dwordx4 v[40:43], v0, s[20:23], s44 offen sc1
    s_add_u32 s45, s33, 0x6000000
    s_nop 0
    buffer_load_dwordx4 v[40:43], v0, s[8:11], s45 offen nt
    s_waitcnt vmcnt(17)
    v_lshlrev_b32 v7, 16, v90
    v_and_b32 v8, 0xffff0000, v90
    v_lshlrev_b32 v9, 16, v91
    v_and_b32 v10, 0xffff0000, v91
    v_mul_f32 v7, 0.15915494, v7
    v_mul_f32 v8, 0.15915494, v8
    v_mul_f32 v9, 0.15915494, v9
    v_mul_f32 v10, 0.15915494, v10
    v_mul_hi_u32_u24 v14, 429497, v108
    v_lshrrev_b32 v12, 3, v112
    v_cos_f32 v7, v7
    v_lshlrev_b16 v13, 3, v112
    v_mad_i32_i24 v11, v14, s55, v108
    v_bitop3_b32 v12, v6, v13, v12 bitop3:0xca
    v_add_lshl_u32 v11, v11, s40, 17
    v_lshlrev_b16 v14, 8, v14
    v_lshrrev_b32 v13, 2, v112
    v_or_b32 v108, v12, v11
    v_bitop3_b32 v112, v5, v13, v14 bitop3:0xea
    ds_add_u32 v112, v2
    v_mul_hi_u32_u24 v14, 429497, v109
    v_lshrrev_b32 v12, 3, v113
    v_cos_f32 v8, v8
    v_lshlrev_b16 v13, 3, v113
    v_mad_i32_i24 v11, v14, s55, v109
    v_bitop3_b32 v12, v6, v13, v12 bitop3:0xca
    v_add_lshl_u32 v11, v11, s40, 17
    v_lshlrev_b16 v14, 8, v14
    v_lshrrev_b32 v13, 2, v113
    v_or_b32 v109, v12, v11
    v_bitop3_b32 v113, v5, v13, v14 bitop3:0xea
    ds_add_u32 v113, v2
    v_cvt_pk_bf16_f32 v90, v7, v8
    v_perm_b32 v12, v90, v90, s41
    v_bitop3_b32 v108, v4, v12, v108 bitop3:0xca
    v_perm_b32 v13, v90, v90, s42
    v_bitop3_b32 v109, v4, v13, v109 bitop3:0xca
    v_mul_hi_u32_u24 v14, 429497, v110
    v_lshrrev_b32 v12, 3, v114
    v_cos_f32 v9, v9
    v_lshlrev_b16 v13, 3, v114
    v_mad_i32_i24 v11, v14, s55, v110
    v_bitop3_b32 v12, v6, v13, v12 bitop3:0xca
    v_add_lshl_u32 v11, v11, s40, 17
    v_lshlrev_b16 v14, 8, v14
    v_lshrrev_b32 v13, 2, v114
    v_or_b32 v110, v12, v11
    v_bitop3_b32 v114, v5, v13, v14 bitop3:0xea
    ds_add_u32 v114, v2
    v_mul_hi_u32_u24 v14, 429497, v111
    v_lshrrev_b32 v12, 3, v115
    v_cos_f32 v10, v10
    v_lshlrev_b16 v13, 3, v115
    v_mad_i32_i24 v11, v14, s55, v111
    v_bitop3_b32 v12, v6, v13, v12 bitop3:0xca
    v_add_lshl_u32 v11, v11, s40, 17
    v_lshlrev_b16 v14, 8, v14
    v_lshrrev_b32 v13, 2, v115
    v_or_b32 v111, v12, v11
    v_bitop3_b32 v115, v5, v13, v14 bitop3:0xea
    ds_add_u32 v115, v2
    v_cvt_pk_bf16_f32 v91, v9, v10
    v_perm_b32 v12, v91, v91, s41
    v_bitop3_b32 v110, v4, v12, v110 bitop3:0xca
    v_perm_b32 v13, v91, v91, s42
    v_bitop3_b32 v111, v4, v13, v111 bitop3:0xca
    s_waitcnt vmcnt(13)
    v_lshlrev_b32 v7, 16, v120
    v_and_b32 v8, 0xffff0000, v120
    v_lshlrev_b32 v9, 16, v121
    v_and_b32 v10, 0xffff0000, v121
    v_mul_f32 v7, 0.15915494, v7
    v_mul_f32 v8, 0.15915494, v8
    v_mul_f32 v9, 0.15915494, v9
    v_mul_f32 v10, 0.15915494, v10
    v_mul_hi_u32_u24 v14, 429497, v104
    v_lshrrev_b32 v12, 3, v116
    v_cos_f32 v7, v7
    v_lshlrev_b16 v13, 3, v116
    v_mad_i32_i24 v11, v14, s55, v104
    v_bitop3_b32 v12, v6, v13, v12 bitop3:0xca
    v_add_lshl_u32 v11, v11, s40, 17
    v_lshlrev_b16 v14, 8, v14
    v_lshrrev_b32 v13, 2, v116
    v_or_b32 v104, v12, v11
    v_bitop3_b32 v116, v5, v13, v14 bitop3:0xea
    ds_add_u32 v116, v2
    v_mul_hi_u32_u24 v14, 429497, v105
    v_lshrrev_b32 v12, 3, v117
    v_cos_f32 v8, v8
    v_lshlrev_b16 v13, 3, v117
    v_mad_i32_i24 v11, v14, s55, v105
    v_bitop3_b32 v12, v6, v13, v12 bitop3:0xca
    v_add_lshl_u32 v11, v11, s40, 17
    v_lshlrev_b16 v14, 8, v14
    v_lshrrev_b32 v13, 2, v117
    v_or_b32 v105, v12, v11
    v_bitop3_b32 v117, v5, v13, v14 bitop3:0xea
    ds_add_u32 v117, v2
    v_cvt_pk_bf16_f32 v120, v7, v8
    v_perm_b32 v12, v120, v120, s41
    v_bitop3_b32 v104, v4, v12, v104 bitop3:0xca
    v_perm_b32 v13, v120, v120, s42
    v_bitop3_b32 v105, v4, v13, v105 bitop3:0xca
    v_mul_hi_u32_u24 v14, 429497, v106
    v_lshrrev_b32 v12, 3, v118
    v_cos_f32 v9, v9
    v_lshlrev_b16 v13, 3, v118
    v_mad_i32_i24 v11, v14, s55, v106
    v_bitop3_b32 v12, v6, v13, v12 bitop3:0xca
    v_add_lshl_u32 v11, v11, s40, 17
    v_lshlrev_b16 v14, 8, v14
    v_lshrrev_b32 v13, 2, v118
    v_or_b32 v106, v12, v11
    v_bitop3_b32 v118, v5, v13, v14 bitop3:0xea
    ds_add_u32 v118, v2
    v_mul_hi_u32_u24 v14, 429497, v107
    v_lshrrev_b32 v12, 3, v119
    v_cos_f32 v10, v10
    v_lshlrev_b16 v13, 3, v119
    v_mad_i32_i24 v11, v14, s55, v107
    v_bitop3_b32 v12, v6, v13, v12 bitop3:0xca
    v_add_lshl_u32 v11, v11, s40, 17
    v_lshlrev_b16 v14, 8, v14
    v_lshrrev_b32 v13, 2, v119
    v_or_b32 v107, v12, v11
    v_bitop3_b32 v119, v5, v13, v14 bitop3:0xea
    ds_add_u32 v119, v2
    v_cvt_pk_bf16_f32 v121, v9, v10
    v_perm_b32 v12, v121, v121, s41
    v_bitop3_b32 v106, v4, v12, v106 bitop3:0xca
    v_perm_b32 v13, v121, v121, s42
    v_bitop3_b32 v107, v4, v13, v107 bitop3:0xca
    s_waitcnt vmcnt(10)
    v_lshlrev_b32 v7, 16, v122
    v_and_b32 v8, 0xffff0000, v122
    v_lshlrev_b32 v9, 16, v123
    v_and_b32 v10, 0xffff0000, v123
    v_mul_f32 v7, 0.15915494, v7
    v_mul_f32 v8, 0.15915494, v8
    v_mul_f32 v9, 0.15915494, v9
    v_mul_f32 v10, 0.15915494, v10
    v_mul_hi_u32_u24 v14, 429497, v92
    v_lshrrev_b32 v12, 3, v16
    v_cos_f32 v7, v7
    v_lshlrev_b16 v13, 3, v16
    v_mad_i32_i24 v11, v14, s55, v92
    v_bitop3_b32 v12, v6, v13, v12 bitop3:0xca
    v_add_lshl_u32 v11, v11, s40, 17
    v_lshlrev_b16 v14, 8, v14
    v_lshrrev_b32 v13, 2, v16
    v_or_b32 v92, v12, v11
    v_bitop3_b32 v16, v5, v13, v14 bitop3:0xea
    ds_add_u32 v16, v2
    v_mul_hi_u32_u24 v14, 429497, v93
    v_lshrrev_b32 v12, 3, v17
    v_cos_f32 v8, v8
    v_lshlrev_b16 v13, 3, v17
    v_mad_i32_i24 v11, v14, s55, v93
    v_bitop3_b32 v12, v6, v13, v12 bitop3:0xca
    v_add_lshl_u32 v11, v11, s40, 17
    v_lshlrev_b16 v14, 8, v14
    v_lshrrev_b32 v13, 2, v17
    v_or_b32 v93, v12, v11
    v_bitop3_b32 v17, v5, v13, v14 bitop3:0xea
    ds_add_u32 v17, v2
    v_cvt_pk_bf16_f32 v122, v7, v8
    v_perm_b32 v12, v122, v122, s41
    v_bitop3_b32 v92, v4, v12, v92 bitop3:0xca
    v_perm_b32 v13, v122, v122, s42
    v_bitop3_b32 v93, v4, v13, v93 bitop3:0xca
    v_mul_hi_u32_u24 v14, 429497, v94
    v_lshrrev_b32 v12, 3, v18
    v_cos_f32 v9, v9
    v_lshlrev_b16 v13, 3, v18
    v_mad_i32_i24 v11, v14, s55, v94
    v_bitop3_b32 v12, v6, v13, v12 bitop3:0xca
    v_add_lshl_u32 v11, v11, s40, 17
    v_lshlrev_b16 v14, 8, v14
    v_lshrrev_b32 v13, 2, v18
    v_or_b32 v94, v12, v11
    v_bitop3_b32 v18, v5, v13, v14 bitop3:0xea
    ds_add_u32 v18, v2
    v_mul_hi_u32_u24 v14, 429497, v95
    v_lshrrev_b32 v12, 3, v19
    v_cos_f32 v10, v10
    v_lshlrev_b16 v13, 3, v19
    v_mad_i32_i24 v11, v14, s55, v95
    v_bitop3_b32 v12, v6, v13, v12 bitop3:0xca
    v_add_lshl_u32 v11, v11, s40, 17
    v_lshlrev_b16 v14, 8, v14
    v_lshrrev_b32 v13, 2, v19
    v_or_b32 v95, v12, v11
    v_bitop3_b32 v19, v5, v13, v14 bitop3:0xea
    ds_add_u32 v19, v2
    v_cvt_pk_bf16_f32 v123, v9, v10
    v_perm_b32 v12, v123, v123, s41
    v_bitop3_b32 v94, v4, v12, v94 bitop3:0xca
    v_perm_b32 v13, v123, v123, s42
    v_bitop3_b32 v95, v4, v13, v95 bitop3:0xca
    s_add_u32 s46, s35, 0x2a4c000
    buffer_store_dwordx4 v[24:27], v0, s[20:23], s46 offen sc1
    s_add_u32 s47, s33, 0x6000000
    s_nop 0
    buffer_load_dwordx4 v[24:27], v0, s[12:15], s47 offen nt
    s_waitcnt vmcnt(8)
    v_lshlrev_b32 v7, 16, v28
    v_and_b32 v8, 0xffff0000, v28
    v_lshlrev_b32 v9, 16, v29
    v_and_b32 v10, 0xffff0000, v29
    v_mul_f32 v7, 0.15915494, v7
    v_mul_f32 v8, 0.15915494, v8
    v_mul_f32 v9, 0.15915494, v9
    v_mul_f32 v10, 0.15915494, v10
    v_mul_hi_u32_u24 v14, 429497, v20
    v_lshrrev_b32 v12, 3, v124
    v_cos_f32 v7, v7
    v_lshlrev_b16 v13, 3, v124
    v_mad_i32_i24 v11, v14, s55, v20
    v_bitop3_b32 v12, v6, v13, v12 bitop3:0xca
    v_add_lshl_u32 v11, v11, s40, 17
    v_lshlrev_b16 v14, 8, v14
    v_lshrrev_b32 v13, 2, v124
    v_or_b32 v20, v12, v11
    v_bitop3_b32 v124, v5, v13, v14 bitop3:0xea
    ds_add_u32 v124, v2
    v_mul_hi_u32_u24 v14, 429497, v21
    v_lshrrev_b32 v12, 3, v125
    v_cos_f32 v8, v8
    v_lshlrev_b16 v13, 3, v125
    v_mad_i32_i24 v11, v14, s55, v21
    v_bitop3_b32 v12, v6, v13, v12 bitop3:0xca
    v_add_lshl_u32 v11, v11, s40, 17
    v_lshlrev_b16 v14, 8, v14
    v_lshrrev_b32 v13, 2, v125
    v_or_b32 v21, v12, v11
    v_bitop3_b32 v125, v5, v13, v14 bitop3:0xea
    ds_add_u32 v125, v2
    v_cvt_pk_bf16_f32 v28, v7, v8
    v_perm_b32 v12, v28, v28, s41
    v_bitop3_b32 v20, v4, v12, v20 bitop3:0xca
    v_perm_b32 v13, v28, v28, s42
    v_bitop3_b32 v21, v4, v13, v21 bitop3:0xca
    v_mul_hi_u32_u24 v14, 429497, v22
    v_lshrrev_b32 v12, 3, v126
    v_cos_f32 v9, v9
    v_lshlrev_b16 v13, 3, v126
    v_mad_i32_i24 v11, v14, s55, v22
    v_bitop3_b32 v12, v6, v13, v12 bitop3:0xca
    v_add_lshl_u32 v11, v11, s40, 17
    v_lshlrev_b16 v14, 8, v14
    v_lshrrev_b32 v13, 2, v126
    v_or_b32 v22, v12, v11
    v_bitop3_b32 v126, v5, v13, v14 bitop3:0xea
    ds_add_u32 v126, v2
    v_mul_hi_u32_u24 v14, 429497, v23
    v_lshrrev_b32 v12, 3, v127
    v_cos_f32 v10, v10
    v_lshlrev_b16 v13, 3, v127
    v_mad_i32_i24 v11, v14, s55, v23
    v_bitop3_b32 v12, v6, v13, v12 bitop3:0xca
    v_add_lshl_u32 v11, v11, s40, 17
    v_lshlrev_b16 v14, 8, v14
    v_lshrrev_b32 v13, 2, v127
    v_or_b32 v23, v12, v11
    v_bitop3_b32 v127, v5, v13, v14 bitop3:0xea
    ds_add_u32 v127, v2
    v_cvt_pk_bf16_f32 v29, v9, v10
    v_perm_b32 v12, v29, v29, s41
    v_bitop3_b32 v22, v4, v12, v22 bitop3:0xca
    v_perm_b32 v13, v29, v29, s42
    v_bitop3_b32 v23, v4, v13, v23 bitop3:0xca
    s_waitcnt vmcnt(4)
    v_lshlrev_b32 v7, 16, v30
    v_and_b32 v8, 0xffff0000, v30
    v_lshlrev_b32 v9, 16, v31
    v_and_b32 v10, 0xffff0000, v31
    v_mul_f32 v7, 0.15915494, v7
    v_mul_f32 v8, 0.15915494, v8
    v_mul_f32 v9, 0.15915494, v9
    v_mul_f32 v10, 0.15915494, v10
    v_mul_hi_u32_u24 v14, 429497, v32
    v_lshrrev_b32 v12, 3, v36
    v_cos_f32 v7, v7
    v_lshlrev_b16 v13, 3, v36
    v_mad_i32_i24 v11, v14, s55, v32
    v_bitop3_b32 v12, v6, v13, v12 bitop3:0xca
    v_add_lshl_u32 v11, v11, s40, 17
    v_lshlrev_b16 v14, 8, v14
    v_lshrrev_b32 v13, 2, v36
    v_or_b32 v32, v12, v11
    v_bitop3_b32 v36, v5, v13, v14 bitop3:0xea
    ds_add_u32 v36, v2
    v_mul_hi_u32_u24 v14, 429497, v33
    v_lshrrev_b32 v12, 3, v37
    v_cos_f32 v8, v8
    v_lshlrev_b16 v13, 3, v37
    v_mad_i32_i24 v11, v14, s55, v33
    v_bitop3_b32 v12, v6, v13, v12 bitop3:0xca
    v_add_lshl_u32 v11, v11, s40, 17
    v_lshlrev_b16 v14, 8, v14
    v_lshrrev_b32 v13, 2, v37
    v_or_b32 v33, v12, v11
    v_bitop3_b32 v37, v5, v13, v14 bitop3:0xea
    ds_add_u32 v37, v2
    v_cvt_pk_bf16_f32 v30, v7, v8
    v_perm_b32 v12, v30, v30, s41
    v_bitop3_b32 v32, v4, v12, v32 bitop3:0xca
    v_perm_b32 v13, v30, v30, s42
    v_bitop3_b32 v33, v4, v13, v33 bitop3:0xca
    v_mul_hi_u32_u24 v14, 429497, v34
    v_lshrrev_b32 v12, 3, v38
    v_cos_f32 v9, v9
    v_lshlrev_b16 v13, 3, v38
    v_mad_i32_i24 v11, v14, s55, v34
    v_bitop3_b32 v12, v6, v13, v12 bitop3:0xca
    v_add_lshl_u32 v11, v11, s40, 17
    v_lshlrev_b16 v14, 8, v14
    v_lshrrev_b32 v13, 2, v38
    v_or_b32 v34, v12, v11
    v_bitop3_b32 v38, v5, v13, v14 bitop3:0xea
    ds_add_u32 v38, v2
    v_mul_hi_u32_u24 v14, 429497, v35
    v_lshrrev_b32 v12, 3, v39
    v_cos_f32 v10, v10
    v_lshlrev_b16 v13, 3, v39
    v_mad_i32_i24 v11, v14, s55, v35
    v_bitop3_b32 v12, v6, v13, v12 bitop3:0xca
    v_add_lshl_u32 v11, v11, s40, 17
    v_lshlrev_b16 v14, 8, v14
    v_lshrrev_b32 v13, 2, v39
    v_or_b32 v35, v12, v11
    v_bitop3_b32 v39, v5, v13, v14 bitop3:0xea
    ds_add_u32 v39, v2
    v_cvt_pk_bf16_f32 v31, v9, v10
    v_perm_b32 v12, v31, v31, s41
    v_bitop3_b32 v34, v4, v12, v34 bitop3:0xca
    v_perm_b32 v13, v31, v31, s42
    v_bitop3_b32 v35, v4, v13, v35 bitop3:0xca
    v_lshrrev_b32 v8, 2, v0
    v_and_b32 v7, 0x3c00, v0
    v_bitop3_b32 v7, v5, v8, v7 bitop3:0xea
    s_waitcnt lgkmcnt(0)
    s_barrier
    ds_read2st64_b32 v[8:9], v7 offset0:0 offset1:1
    ds_read2st64_b32 v[10:11], v7 offset0:2 offset1:3
    s_add_u32 s44, s35, 0x2a50000
    buffer_store_dwordx4 v[84:87], v0, s[20:23], s44 offen sc1
    s_add_u32 s45, s34, 0x3000000
    s_nop 0
    buffer_load_dwordx2 v[84:85], v1, s[16:19], s45 offen nt
    s_add_u32 s46, s34, 0x3200000
    buffer_load_dwordx2 v[86:87], v1, s[16:19], s46 offen nt
    s_waitcnt lgkmcnt(0)
    v_lshl_or_b32 v12, v9, 16, v8
    v_lshl_or_b32 v13, v11, 16, v10
    v_mov_b32 v14, v12
    v_mov_b32 v15, v13
    s_nop 0
    v_add_u32_dpp v14, v14, v14 row_shr:1 row_mask:0xf bank_mask:0xf bound_ctrl:1
    v_add_u32_dpp v15, v15, v15 row_shr:1 row_mask:0xf bank_mask:0xf bound_ctrl:1
    s_nop 0
    v_add_u32_dpp v14, v14, v14 row_shr:2 row_mask:0xf bank_mask:0xf bound_ctrl:1
    v_add_u32_dpp v15, v15, v15 row_shr:2 row_mask:0xf bank_mask:0xf bound_ctrl:1
    s_nop 0
    v_add_u32_dpp v14, v14, v14 row_shr:4 row_mask:0xf bank_mask:0xf bound_ctrl:1
    v_add_u32_dpp v15, v15, v15 row_shr:4 row_mask:0xf bank_mask:0xf bound_ctrl:1
    s_nop 0
    v_add_u32_dpp v14, v14, v14 row_shr:8 row_mask:0xf bank_mask:0xf bound_ctrl:1
    v_add_u32_dpp v15, v15, v15 row_shr:8 row_mask:0xf bank_mask:0xf bound_ctrl:1
    s_nop 0
    v_add_u32_dpp v14, v14, v14 row_bcast:15 row_mask:0xa bank_mask:0xf
    v_add_u32_dpp v15, v15, v15 row_bcast:15 row_mask:0xa bank_mask:0xf
    s_nop 0
    v_add_u32_dpp v14, v14, v14 row_bcast:31 row_mask:0xc bank_mask:0xf
    v_add_u32_dpp v15, v15, v15 row_bcast:31 row_mask:0xc bank_mask:0xf
    v_readlane_b32 s48, v14, 63
    v_readlane_b32 s49, v15, 63
    s_lshl_b32 s54, s32, 2
    v_mov_b32 v8, s54
    s_and_b32 s50, s48, 0xffff
    s_lshr_b32 s51, s48, 16
    s_and_b32 s52, s49, 0xffff
    s_lshr_b32 s53, s49, 16
    s_add_u32 s51, s51, s50
    s_add_u32 s52, s52, s51
    s_add_u32 s53, s53, s52
    v_mov_b32 v9, s53
    s_mov_b64 exec, 1
    ds_write_b32 v8, v9 offset:16384
    s_mov_b64 exec, -1
    v_and_b32 v8, 60, v7
    s_waitcnt lgkmcnt(0)
    s_barrier
    ds_read_b32 v9, v8 offset:16384
    s_waitcnt lgkmcnt(0)
    v_add_u32_dpp v9, v9, v9 row_shr:1 row_mask:0xf bank_mask:0xf bound_ctrl:1
    s_nop 1
    v_add_u32_dpp v9, v9, v9 row_shr:2 row_mask:0xf bank_mask:0xf bound_ctrl:1
    s_nop 1
    v_add_u32_dpp v9, v9, v9 row_shr:4 row_mask:0xf bank_mask:0xf bound_ctrl:1
    s_nop 1
    v_add_u32_dpp v9, v9, v9 row_shr:8 row_mask:0xf bank_mask:0xf bound_ctrl:1
    s_nop 0
    v_readlane_b32 s54, v9, s32
    s_sub_u32 s54, s54, s53
    s_add_u32 s50, s50, s54
    s_add_u32 s51, s51, s54
    s_add_u32 s52, s52, s54
    s_pack_ll_b32_b16 s48, s54, s50
    s_pack_ll_b32_b16 s49, s51, s52
    v_add_u32 v14, s48, v14
    v_add_u32 v15, s49, v15
    v_sub_u32 v12, v14, v12
    v_sub_u32 v13, v15, v13
    v_and_b32 v8, 0xffff, v12
    v_lshrrev_b32 v9, 16, v12
    v_and_b32 v10, 0xffff, v13
    v_lshrrev_b32 v11, 16, v13
    ds_write2st64_b32 v7, v8, v9 offset0:0 offset1:1
    ds_write2st64_b32 v7, v10, v11 offset0:2 offset1:3
    s_waitcnt lgkmcnt(0)
    s_barrier
    ds_add_rtn_u32 v72, v72, v2
    ds_add_rtn_u32 v73, v73, v2
    ds_add_rtn_u32 v74, v74, v2
    ds_add_rtn_u32 v75, v75, v2
    s_add_u32 s47, s36, 0x5480000
    v_and_b32 v11, 0x3f0, v0
    v_add_u32 v11, v11, v11
    buffer_store_dwordx2 v[12:13], v11, s[24:27], s47 offen
    s_bitset0_b64 exec, 63
    s_not_b64 exec, exec
    buffer_store_dwordx2 v[14:15], v11, s[24:27], s47 offen offset:32
    s_mov_b64 exec, -1
    v_cmp_le_u32 vcc, s37, v0
    v_add_u32 v10, 8320, v0
    s_cmp_lg_u32 s32, 0
    v_cndmask_b32 v10, v0, v10, vcc
    s_cbranch_scc1 L1_p3
    s_add_u32 s44, s35, 0x5480000
    s_mov_b64 exec, 0xff
    buffer_store_dwordx4 v[12:15], v10, s[24:27], s44 offen
    s_mov_b64 exec, -1
L1_p3:
    ds_add_rtn_u32 v80, v80, v2
    ds_add_rtn_u32 v81, v81, v2
    ds_add_rtn_u32 v82, v82, v2
    ds_add_rtn_u32 v83, v83, v2
    ds_add_rtn_u32 v100, v100, v2
    ds_add_rtn_u32 v101, v101, v2
    ds_add_rtn_u32 v102, v102, v2
    ds_add_rtn_u32 v103, v103, v2
    s_add_u32 s45, s35, 0x2a54000
    buffer_store_dwordx4 v[48:51], v0, s[20:23], s45 offen sc1
    s_add_u32 s46, s33, 0x6400000
    s_nop 0
    buffer_load_dwordx4 v[48:51], v0, s[8:11], s46 offen nt
    ds_add_rtn_u32 v112, v112, v2
    ds_add_rtn_u32 v113, v113, v2
    ds_add_rtn_u32 v114, v114, v2
    ds_add_rtn_u32 v115, v115, v2
    ds_add_rtn_u32 v116, v116, v2
    ds_add_rtn_u32 v117, v117, v2
    ds_add_rtn_u32 v118, v118, v2
    ds_add_rtn_u32 v119, v119, v2
    ds_add_rtn_u32 v16, v16, v2
    ds_add_rtn_u32 v17, v17, v2
    ds_add_rtn_u32 v18, v18, v2
    ds_add_rtn_u32 v19, v19, v2
    s_add_u32 s47, s35, 0x2a58000
    buffer_store_dwordx4 v[52:55], v0, s[20:23], s47 offen sc1
    s_add_u32 s44, s33, 0x6400000
    s_nop 0
    buffer_load_dwordx4 v[52:55], v0, s[12:15], s44 offen nt
    ds_add_rtn_u32 v124, v124, v2
    ds_add_rtn_u32 v125, v125, v2
    ds_add_rtn_u32 v126, v126, v2
    ds_add_rtn_u32 v127, v127, v2
    ds_add_rtn_u32 v36, v36, v2
    ds_add_rtn_u32 v37, v37, v2
    ds_add_rtn_u32 v38, v38, v2
    ds_add_rtn_u32 v39, v39, v2
    s_waitcnt lgkmcnt(0)
    s_barrier
    v_and_b32 v7, -4, v72
    v_lshl_add_u32 v8, v72, 2, v7
    ds_write_b32 v8, v68
    v_lshl_add_u32 v7, v7, 2, v72
    ds_write_b8 v7, v64 offset:16
    v_and_b32 v9, -4, v73
    v_lshl_add_u32 v10, v73, 2, v9
    ds_write_b32 v10, v69
    v_lshl_add_u32 v9, v9, 2, v73
    ds_write_b8_d16_hi v9, v64 offset:16
    v_and_b32 v7, -4, v74
    v_lshl_add_u32 v8, v74, 2, v7
    ds_write_b32 v8, v70
    v_lshl_add_u32 v7, v7, 2, v74
    ds_write_b8 v7, v65 offset:16
    v_and_b32 v9, -4, v75
    v_lshl_add_u32 v10, v75, 2, v9
    ds_write_b32 v10, v71
    v_lshl_add_u32 v9, v9, 2, v75
    ds_write_b8_d16_hi v9, v65 offset:16
    s_add_u32 s45, s35, 0x2a5c000
    buffer_store_dwordx4 v[56:59], v0, s[20:23], s45 offen sc1
    s_add_u32 s46, s33, 0x6800000
    buffer_load_dwordx4 v[68:71], v0, s[8:11], s46 offen nt
    s_add_u32 s47, s33, 0x6800000
    buffer_load_dwordx4 v[72:75], v0, s[12:15], s47 offen nt
    v_and_b32 v7, -4, v80
    v_lshl_add_u32 v8, v80, 2, v7
    ds_write_b32 v8, v76
    v_lshl_add_u32 v7, v7, 2, v80
    ds_write_b8 v7, v66 offset:16
    v_and_b32 v9, -4, v81
    v_lshl_add_u32 v10, v81, 2, v9
    ds_write_b32 v10, v77
    v_lshl_add_u32 v9, v9, 2, v81
    ds_write_b8_d16_hi v9, v66 offset:16
    v_and_b32 v7, -4, v82
    v_lshl_add_u32 v8, v82, 2, v7
    ds_write_b32 v8, v78
    v_lshl_add_u32 v7, v7, 2, v82
    ds_write_b8 v7, v67 offset:16
    v_and_b32 v9, -4, v83
    v_lshl_add_u32 v10, v83, 2, v9
    ds_write_b32 v10, v79
    v_lshl_add_u32 v9, v9, 2, v83
    ds_write_b8_d16_hi v9, v67 offset:16
    s_add_u32 s44, s34, 0x3400000
    buffer_load_dwordx2 v[56:57], v1, s[16:19], s44 offen nt
    s_add_u32 s45, s34, 0x3600000
    buffer_load_dwordx2 v[58:59], v1, s[16:19], s45 offen nt
    s_add_u32 s46, s33, 0x6c00000
    buffer_load_dwordx4 v[76:79], v0, s[8:11], s46 offen nt
    v_and_b32 v7, -4, v100
    v_lshl_add_u32 v8, v100, 2, v7
    ds_write_b32 v8, v96
    v_lshl_add_u32 v7, v7, 2, v100
    ds_write_b8 v7, v88 offset:16
    v_and_b32 v9, -4, v101
    v_lshl_add_u32 v10, v101, 2, v9
    ds_write_b32 v10, v97
    v_lshl_add_u32 v9, v9, 2, v101
    ds_write_b8_d16_hi v9, v88 offset:16
    v_and_b32 v7, -4, v102
    v_lshl_add_u32 v8, v102, 2, v7
    ds_write_b32 v8, v98
    v_lshl_add_u32 v7, v7, 2, v102
    ds_write_b8 v7, v89 offset:16
    v_and_b32 v9, -4, v103
    v_lshl_add_u32 v10, v103, 2, v9
    ds_write_b32 v10, v99
    v_lshl_add_u32 v9, v9, 2, v103
    ds_write_b8_d16_hi v9, v89 offset:16
    s_add_u32 s47, s35, 0x2a60000
    buffer_store_dwordx4 v[60:63], v0, s[20:23], s47 offen sc1
    s_add_u32 s44, s33, 0x6c00000
    buffer_load_dwordx4 v[80:83], v0, s[12:15], s44 offen nt
    v_and_b32 v7, -4, v112
    v_lshl_add_u32 v8, v112, 2, v7
    ds_write_b32 v8, v108
    v_lshl_add_u32 v7, v7, 2, v112
    ds_write_b8 v7, v90 offset:16
    v_and_b32 v9, -4, v113
    v_lshl_add_u32 v10, v113, 2, v9
    ds_write_b32 v10, v109
    v_lshl_add_u32 v9, v9, 2, v113
    ds_write_b8_d16_hi v9, v90 offset:16
    v_and_b32 v7, -4, v114
    v_lshl_add_u32 v8, v114, 2, v7
    ds_write_b32 v8, v110
    v_lshl_add_u32 v7, v7, 2, v114
    ds_write_b8 v7, v91 offset:16
    v_and_b32 v9, -4, v115
    v_lshl_add_u32 v10, v115, 2, v9
    ds_write_b32 v10, v111
    v_lshl_add_u32 v9, v9, 2, v115
    ds_write_b8_d16_hi v9, v91 offset:16
    s_add_u32 s45, s33, 0x7000000
    buffer_load_dwordx4 v[64:67], v0, s[8:11], s45 offen nt
    s_add_u32 s46, s33, 0x7000000
    buffer_load_dwordx4 v[96:99], v0, s[12:15], s46 offen nt
    v_and_b32 v7, -4, v116
    v_lshl_add_u32 v8, v116, 2, v7
    ds_write_b32 v8, v104
    v_lshl_add_u32 v7, v7, 2, v116
    ds_write_b8 v7, v120 offset:16
    v_and_b32 v9, -4, v117
    v_lshl_add_u32 v10, v117, 2, v9
    ds_write_b32 v10, v105
    v_lshl_add_u32 v9, v9, 2, v117
    ds_write_b8_d16_hi v9, v120 offset:16
    v_and_b32 v7, -4, v118
    v_lshl_add_u32 v8, v118, 2, v7
    ds_write_b32 v8, v106
    v_lshl_add_u32 v7, v7, 2, v118
    ds_write_b8 v7, v121 offset:16
    v_and_b32 v9, -4, v119
    v_lshl_add_u32 v10, v119, 2, v9
    ds_write_b32 v10, v107
    v_lshl_add_u32 v9, v9, 2, v119
    ds_write_b8_d16_hi v9, v121 offset:16
    s_add_u32 s47, s34, 0x3800000
    buffer_load_dwordx2 v[100:101], v1, s[16:19], s47 offen nt
    s_add_u32 s44, s34, 0x3a00000
    buffer_load_dwordx2 v[102:103], v1, s[16:19], s44 offen nt
    s_add_u32 s45, s33, 0x7400000
    buffer_load_dwordx4 v[60:63], v0, s[8:11], s45 offen nt
    v_and_b32 v7, -4, v16
    v_lshl_add_u32 v8, v16, 2, v7
    ds_write_b32 v8, v92
    v_lshl_add_u32 v7, v7, 2, v16
    ds_write_b8 v7, v122 offset:16
    v_and_b32 v9, -4, v17
    v_lshl_add_u32 v10, v17, 2, v9
    ds_write_b32 v10, v93
    v_lshl_add_u32 v9, v9, 2, v17
    ds_write_b8_d16_hi v9, v122 offset:16
    v_and_b32 v7, -4, v18
    v_lshl_add_u32 v8, v18, 2, v7
    ds_write_b32 v8, v94
    v_lshl_add_u32 v7, v7, 2, v18
    ds_write_b8 v7, v123 offset:16
    v_and_b32 v9, -4, v19
    v_lshl_add_u32 v10, v19, 2, v9
    ds_write_b32 v10, v95
    v_lshl_add_u32 v9, v9, 2, v19
    ds_write_b8_d16_hi v9, v123 offset:16
    s_add_u32 s46, s35, 0x2a64000
    buffer_store_dwordx4 v[44:47], v0, s[20:23], s46 offen sc1
    s_add_u32 s47, s33, 0x7400000
    buffer_load_dwordx4 v[108:111], v0, s[12:15], s47 offen nt
    v_and_b32 v7, -4, v124
    v_lshl_add_u32 v8, v124, 2, v7
    ds_write_b32 v8, v20
    v_lshl_add_u32 v7, v7, 2, v124
    ds_write_b8 v7, v28 offset:16
    v_and_b32 v9, -4, v125
    v_lshl_add_u32 v10, v125, 2, v9
    ds_write_b32 v10, v21
    v_lshl_add_u32 v9, v9, 2, v125
    ds_write_b8_d16_hi v9, v28 offset:16
    v_and_b32 v7, -4, v126
    v_lshl_add_u32 v8, v126, 2, v7
    ds_write_b32 v8, v22
    v_lshl_add_u32 v7, v7, 2, v126
    ds_write_b8 v7, v29 offset:16
    v_and_b32 v9, -4, v127
    v_lshl_add_u32 v10, v127, 2, v9
    ds_write_b32 v10, v23
    v_lshl_add_u32 v9, v9, 2, v127
    ds_write_b8_d16_hi v9, v29 offset:16
    s_add_u32 s44, s33, 0x7800000
    buffer_load_dwordx4 v[112:115], v0, s[8:11], s44 offen nt
    s_add_u32 s45, s33, 0x7800000
    buffer_load_dwordx4 v[88:91], v0, s[12:15], s45 offen nt
    v_and_b32 v7, -4, v36
    v_lshl_add_u32 v8, v36, 2, v7
    ds_write_b32 v8, v32
    v_lshl_add_u32 v7, v7, 2, v36
    ds_write_b8 v7, v30 offset:16
    v_and_b32 v9, -4, v37
    v_lshl_add_u32 v10, v37, 2, v9
    ds_write_b32 v10, v33
    v_lshl_add_u32 v9, v9, 2, v37
    ds_write_b8_d16_hi v9, v30 offset:16
    v_and_b32 v7, -4, v38
    v_lshl_add_u32 v8, v38, 2, v7
    ds_write_b32 v8, v34
    v_lshl_add_u32 v7, v7, 2, v38
    ds_write_b8 v7, v31 offset:16
    v_and_b32 v9, -4, v39
    v_lshl_add_u32 v10, v39, 2, v9
    ds_write_b32 v10, v35
    v_lshl_add_u32 v9, v9, 2, v39
    ds_write_b8_d16_hi v9, v31 offset:16
    s_add_u32 s46, s34, 0x3c00000
    buffer_load_dwordx2 v[104:105], v1, s[16:19], s46 offen nt
    s_add_u32 s47, s34, 0x3e00000
    buffer_load_dwordx2 v[106:107], v1, s[16:19], s47 offen nt
    v_add_u32 v7, 0x10000, v0
    v_add_u32 v12, 0x20000, v0
    v_mov_b32 v8, 0
    v_mov_b32 v9, 0
    v_mov_b32 v10, 0
    v_mov_b32 v11, 0
    s_waitcnt lgkmcnt(0)
    s_barrier
    ds_read_b128 v[116:119], v0 offset:0
    ds_write_b128 v0, v[8:11]
    ds_read_b128 v[92:95], v0 offset:16384
    ds_read_b128 v[16:19], v0 offset:32768
    ds_read_b128 v[120:123], v0 offset:49152
    ds_read_b128 v[44:47], v7 offset:0
    ds_read_b128 v[20:23], v7 offset:16384
    ds_read_b128 v[124:127], v7 offset:32768
    ds_read_b128 v[32:35], v7 offset:49152
    ds_read_b128 v[36:39], v12 offset:0
    ds_read_b128 v[28:31], v12 offset:16384
    s_waitcnt lgkmcnt(0)
    s_barrier
    s_add_u32 s44, s35, 0x5480000
    buffer_store_dwordx4 v[116:119], v0, s[20:23], s44 offen sc1
    s_add_u32 s45, s33, 0x7c00000
    s_nop 0
    buffer_load_dwordx4 v[116:119], v0, s[8:11], s45 offen nt
    s_add_u32 s46, s35, 0x5484000
    buffer_store_dwordx4 v[92:95], v0, s[20:23], s46 offen sc1
    s_add_u32 s47, s33, 0x7c00000
    s_nop 0
    buffer_load_dwordx4 v[92:95], v0, s[12:15], s47 offen nt
    s_waitcnt vmcnt(29)
    v_lshlrev_b32 v7, 16, v84
    v_and_b32 v8, 0xffff0000, v84
    v_lshlrev_b32 v9, 16, v85
    v_and_b32 v10, 0xffff0000, v85
    v_mul_f32 v7, 0.15915494, v7
    v_mul_f32 v8, 0.15915494, v8
    v_mul_f32 v9, 0.15915494, v9
    v_mul_f32 v10, 0.15915494, v10
    v_mul_hi_u32_u24 v14, 429497, v40
    v_lshrrev_b32 v12, 3, v24
    v_cos_f32 v7, v7
    v_lshlrev_b16 v13, 3, v24
    v_mad_i32_i24 v11, v14, s55, v40
    v_bitop3_b32 v12, v6, v13, v12 bitop3:0xca
    v_add_lshl_u32 v11, v11, s40, 17
    v_lshlrev_b16 v14, 8, v14
    v_lshrrev_b32 v13, 2, v24
    v_or_b32 v40, v12, v11
    v_bitop3_b32 v24, v5, v13, v14 bitop3:0xea
    ds_add_u32 v24, v2
    v_mul_hi_u32_u24 v14, 429497, v41
    v_lshrrev_b32 v12, 3, v25
    v_cos_f32 v8, v8
    v_lshlrev_b16 v13, 3, v25
    v_mad_i32_i24 v11, v14, s55, v41
    v_bitop3_b32 v12, v6, v13, v12 bitop3:0xca
    v_add_lshl_u32 v11, v11, s40, 17
    v_lshlrev_b16 v14, 8, v14
    v_lshrrev_b32 v13, 2, v25
    v_or_b32 v41, v12, v11
    v_bitop3_b32 v25, v5, v13, v14 bitop3:0xea
    ds_add_u32 v25, v2
    v_cvt_pk_bf16_f32 v84, v7, v8
    v_perm_b32 v12, v84, v84, s41
    v_bitop3_b32 v40, v4, v12, v40 bitop3:0xca
    v_perm_b32 v13, v84, v84, s42
    v_bitop3_b32 v41, v4, v13, v41 bitop3:0xca
    v_mul_hi_u32_u24 v14, 429497, v42
    v_lshrrev_b32 v12, 3, v26
    v_cos_f32 v9, v9
    v_lshlrev_b16 v13, 3, v26
    v_mad_i32_i24 v11, v14, s55, v42
    v_bitop3_b32 v12, v6, v13, v12 bitop3:0xca
    v_add_lshl_u32 v11, v11, s40, 17
    v_lshlrev_b16 v14, 8, v14
    v_lshrrev_b32 v13, 2, v26
    v_or_b32 v42, v12, v11
    v_bitop3_b32 v26, v5, v13, v14 bitop3:0xea
    ds_add_u32 v26, v2
    v_mul_hi_u32_u24 v14, 429497, v43
    v_lshrrev_b32 v12, 3, v27
    v_cos_f32 v10, v10
    v_lshlrev_b16 v13, 3, v27
    v_mad_i32_i24 v11, v14, s55, v43
    v_bitop3_b32 v12, v6, v13, v12 bitop3:0xca
    v_add_lshl_u32 v11, v11, s40, 17
    v_lshlrev_b16 v14, 8, v14
    v_lshrrev_b32 v13, 2, v27
    v_or_b32 v43, v12, v11
    v_bitop3_b32 v27, v5, v13, v14 bitop3:0xea
    ds_add_u32 v27, v2
    v_cvt_pk_bf16_f32 v85, v9, v10
    v_perm_b32 v12, v85, v85, s41
    v_bitop3_b32 v42, v4, v12, v42 bitop3:0xca
    v_perm_b32 v13, v85, v85, s42
    v_bitop3_b32 v43, v4, v13, v43 bitop3:0xca
    s_waitcnt vmcnt(23)
    v_lshlrev_b32 v7, 16, v86
    v_and_b32 v8, 0xffff0000, v86
    v_lshlrev_b32 v9, 16, v87
    v_and_b32 v10, 0xffff0000, v87
    v_mul_f32 v7, 0.15915494, v7
    v_mul_f32 v8, 0.15915494, v8
    v_mul_f32 v9, 0.15915494, v9
    v_mul_f32 v10, 0.15915494, v10
    v_mul_hi_u32_u24 v14, 429497, v48
    v_lshrrev_b32 v12, 3, v52
    v_cos_f32 v7, v7
    v_lshlrev_b16 v13, 3, v52
    v_mad_i32_i24 v11, v14, s55, v48
    v_bitop3_b32 v12, v6, v13, v12 bitop3:0xca
    v_add_lshl_u32 v11, v11, s40, 17
    v_lshlrev_b16 v14, 8, v14
    v_lshrrev_b32 v13, 2, v52
    v_or_b32 v48, v12, v11
    v_bitop3_b32 v52, v5, v13, v14 bitop3:0xea
    ds_add_u32 v52, v2
    v_mul_hi_u32_u24 v14, 429497, v49
    v_lshrrev_b32 v12, 3, v53
    v_cos_f32 v8, v8
    v_lshlrev_b16 v13, 3, v53
    v_mad_i32_i24 v11, v14, s55, v49
    v_bitop3_b32 v12, v6, v13, v12 bitop3:0xca
    v_add_lshl_u32 v11, v11, s40, 17
    v_lshlrev_b16 v14, 8, v14
    v_lshrrev_b32 v13, 2, v53
    v_or_b32 v49, v12, v11
    v_bitop3_b32 v53, v5, v13, v14 bitop3:0xea
    ds_add_u32 v53, v2
    v_cvt_pk_bf16_f32 v86, v7, v8
    v_perm_b32 v12, v86, v86, s41
    v_bitop3_b32 v48, v4, v12, v48 bitop3:0xca
    v_perm_b32 v13, v86, v86, s42
    v_bitop3_b32 v49, v4, v13, v49 bitop3:0xca
    v_mul_hi_u32_u24 v14, 429497, v50
    v_lshrrev_b32 v12, 3, v54
    v_cos_f32 v9, v9
    v_lshlrev_b16 v13, 3, v54
    v_mad_i32_i24 v11, v14, s55, v50
    v_bitop3_b32 v12, v6, v13, v12 bitop3:0xca
    v_add_lshl_u32 v11, v11, s40, 17
    v_lshlrev_b16 v14, 8, v14
    v_lshrrev_b32 v13, 2, v54
    v_or_b32 v50, v12, v11
    v_bitop3_b32 v54, v5, v13, v14 bitop3:0xea
    ds_add_u32 v54, v2
    v_mul_hi_u32_u24 v14, 429497, v51
    v_lshrrev_b32 v12, 3, v55
    v_cos_f32 v10, v10
    v_lshlrev_b16 v13, 3, v55
    v_mad_i32_i24 v11, v14, s55, v51
    v_bitop3_b32 v12, v6, v13, v12 bitop3:0xca
    v_add_lshl_u32 v11, v11, s40, 17
    v_lshlrev_b16 v14, 8, v14
    v_lshrrev_b32 v13, 2, v55
    v_or_b32 v51, v12, v11
    v_bitop3_b32 v55, v5, v13, v14 bitop3:0xea
    ds_add_u32 v55, v2
    v_cvt_pk_bf16_f32 v87, v9, v10
    v_perm_b32 v12, v87, v87, s41
    v_bitop3_b32 v50, v4, v12, v50 bitop3:0xca
    v_perm_b32 v13, v87, v87, s42
    v_bitop3_b32 v51, v4, v13, v51 bitop3:0xca
    s_waitcnt vmcnt(18)
    v_lshlrev_b32 v7, 16, v56
    v_and_b32 v8, 0xffff0000, v56
    v_lshlrev_b32 v9, 16, v57
    v_and_b32 v10, 0xffff0000, v57
    v_mul_f32 v7, 0.15915494, v7
    v_mul_f32 v8, 0.15915494, v8
    v_mul_f32 v9, 0.15915494, v9
    v_mul_f32 v10, 0.15915494, v10
    v_mul_hi_u32_u24 v14, 429497, v68
    v_lshrrev_b32 v12, 3, v72
    v_cos_f32 v7, v7
    v_lshlrev_b16 v13, 3, v72
    v_mad_i32_i24 v11, v14, s55, v68
    v_bitop3_b32 v12, v6, v13, v12 bitop3:0xca
    v_add_lshl_u32 v11, v11, s40, 17
    v_lshlrev_b16 v14, 8, v14
    v_lshrrev_b32 v13, 2, v72
    v_or_b32 v68, v12, v11
    v_bitop3_b32 v72, v5, v13, v14 bitop3:0xea
    ds_add_u32 v72, v2
    v_mul_hi_u32_u24 v14, 429497, v69
    v_lshrrev_b32 v12, 3, v73
    v_cos_f32 v8, v8
    v_lshlrev_b16 v13, 3, v73
    v_mad_i32_i24 v11, v14, s55, v69
    v_bitop3_b32 v12, v6, v13, v12 bitop3:0xca
    v_add_lshl_u32 v11, v11, s40, 17
    v_lshlrev_b16 v14, 8, v14
    v_lshrrev_b32 v13, 2, v73
    v_or_b32 v69, v12, v11
    v_bitop3_b32 v73, v5, v13, v14 bitop3:0xea
    ds_add_u32 v73, v2
    v_cvt_pk_bf16_f32 v56, v7, v8
    v_perm_b32 v12, v56, v56, s41
    v_bitop3_b32 v68, v4, v12, v68 bitop3:0xca
    v_perm_b32 v13, v56, v56, s42
    v_bitop3_b32 v69, v4, v13, v69 bitop3:0xca
    v_mul_hi_u32_u24 v14, 429497, v70
    v_lshrrev_b32 v12, 3, v74
    v_cos_f32 v9, v9
    v_lshlrev_b16 v13, 3, v74
    v_mad_i32_i24 v11, v14, s55, v70
    v_bitop3_b32 v12, v6, v13, v12 bitop3:0xca
    v_add_lshl_u32 v11, v11, s40, 17
    v_lshlrev_b16 v14, 8, v14
    v_lshrrev_b32 v13, 2, v74
    v_or_b32 v70, v12, v11
    v_bitop3_b32 v74, v5, v13, v14 bitop3:0xea
    ds_add_u32 v74, v2
    v_mul_hi_u32_u24 v14, 429497, v71
    v_lshrrev_b32 v12, 3, v75
    v_cos_f32 v10, v10
    v_lshlrev_b16 v13, 3, v75
    v_mad_i32_i24 v11, v14, s55, v71
    v_bitop3_b32 v12, v6, v13, v12 bitop3:0xca
    v_add_lshl_u32 v11, v11, s40, 17
    v_lshlrev_b16 v14, 8, v14
    v_lshrrev_b32 v13, 2, v75
    v_or_b32 v71, v12, v11
    v_bitop3_b32 v75, v5, v13, v14 bitop3:0xea
    ds_add_u32 v75, v2
    v_cvt_pk_bf16_f32 v57, v9, v10
    v_perm_b32 v12, v57, v57, s41
    v_bitop3_b32 v70, v4, v12, v70 bitop3:0xca
    v_perm_b32 v13, v57, v57, s42
    v_bitop3_b32 v71, v4, v13, v71 bitop3:0xca
    s_add_u32 s44, s35, 0x5488000
    buffer_store_dwordx4 v[16:19], v0, s[20:23], s44 offen sc1
    s_add_u32 s45, s33, 0x8000000
    s_nop 0
    buffer_load_dwordx4 v[16:19], v0, s[8:11], s45 offen nt
    s_waitcnt vmcnt(17)
    v_lshlrev_b32 v7, 16, v58
    v_and_b32 v8, 0xffff0000, v58
    v_lshlrev_b32 v9, 16, v59
    v_and_b32 v10, 0xffff0000, v59
    v_mul_f32 v7, 0.15915494, v7
    v_mul_f32 v8, 0.15915494, v8
    v_mul_f32 v9, 0.15915494, v9
    v_mul_f32 v10, 0.15915494, v10
    v_mul_hi_u32_u24 v14, 429497, v76
    v_lshrrev_b32 v12, 3, v80
    v_cos_f32 v7, v7
    v_lshlrev_b16 v13, 3, v80
    v_mad_i32_i24 v11, v14, s55, v76
    v_bitop3_b32 v12, v6, v13, v12 bitop3:0xca
    v_add_lshl_u32 v11, v11, s40, 17
    v_lshlrev_b16 v14, 8, v14
    v_lshrrev_b32 v13, 2, v80
    v_or_b32 v76, v12, v11
    v_bitop3_b32 v80, v5, v13, v14 bitop3:0xea
    ds_add_u32 v80, v2
    v_mul_hi_u32_u24 v14, 429497, v77
    v_lshrrev_b32 v12, 3, v81
    v_cos_f32 v8, v8
    v_lshlrev_b16 v13, 3, v81
    v_mad_i32_i24 v11, v14, s55, v77
    v_bitop3_b32 v12, v6, v13, v12 bitop3:0xca
    v_add_lshl_u32 v11, v11, s40, 17
    v_lshlrev_b16 v14, 8, v14
    v_lshrrev_b32 v13, 2, v81
    v_or_b32 v77, v12, v11
    v_bitop3_b32 v81, v5, v13, v14 bitop3:0xea
    ds_add_u32 v81, v2
    v_cvt_pk_bf16_f32 v58, v7, v8
    v_perm_b32 v12, v58, v58, s41
    v_bitop3_b32 v76, v4, v12, v76 bitop3:0xca
    v_perm_b32 v13, v58, v58, s42
    v_bitop3_b32 v77, v4, v13, v77 bitop3:0xca
    v_mul_hi_u32_u24 v14, 429497, v78
    v_lshrrev_b32 v12, 3, v82
    v_cos_f32 v9, v9
    v_lshlrev_b16 v13, 3, v82
    v_mad_i32_i24 v11, v14, s55, v78
    v_bitop3_b32 v12, v6, v13, v12 bitop3:0xca
    v_add_lshl_u32 v11, v11, s40, 17
    v_lshlrev_b16 v14, 8, v14
    v_lshrrev_b32 v13, 2, v82
    v_or_b32 v78, v12, v11
    v_bitop3_b32 v82, v5, v13, v14 bitop3:0xea
    ds_add_u32 v82, v2
    v_mul_hi_u32_u24 v14, 429497, v79
    v_lshrrev_b32 v12, 3, v83
    v_cos_f32 v10, v10
    v_lshlrev_b16 v13, 3, v83
    v_mad_i32_i24 v11, v14, s55, v79
    v_bitop3_b32 v12, v6, v13, v12 bitop3:0xca
    v_add_lshl_u32 v11, v11, s40, 17
    v_lshlrev_b16 v14, 8, v14
    v_lshrrev_b32 v13, 2, v83
    v_or_b32 v79, v12, v11
    v_bitop3_b32 v83, v5, v13, v14 bitop3:0xea
    ds_add_u32 v83, v2
    v_cvt_pk_bf16_f32 v59, v9, v10
    v_perm_b32 v12, v59, v59, s41
    v_bitop3_b32 v78, v4, v12, v78 bitop3:0xca
    v_perm_b32 v13, v59, v59, s42
    v_bitop3_b32 v79, v4, v13, v79 bitop3:0xca
    s_mov_b32 s68, s56
    s_mov_b32 s69, s57
    s_mov_b32 s70, 0x100
    s_mov_b32 s71, 0x20000
    v_mov_b32 v3, 1
    s_cmp_lg_u32 s32, 15
    s_cbranch_scc1 L1_tk
    s_mov_b64 exec, 1
    buffer_atomic_add v3, off, s[68:71], 0 sc0
    s_mov_b64 exec, -1
L1_tk:
    s_waitcnt vmcnt(13)
    v_lshlrev_b32 v7, 16, v100
    v_and_b32 v8, 0xffff0000, v100
    v_lshlrev_b32 v9, 16, v101
    v_and_b32 v10, 0xffff0000, v101
    v_mul_f32 v7, 0.15915494, v7
    v_mul_f32 v8, 0.15915494, v8
    v_mul_f32 v9, 0.15915494, v9
    v_mul_f32 v10, 0.15915494, v10
    v_mul_hi_u32_u24 v14, 429497, v64
    v_lshrrev_b32 v12, 3, v96
    v_cos_f32 v7, v7
    v_lshlrev_b16 v13, 3, v96
    v_mad_i32_i24 v11, v14, s55, v64
    v_bitop3_b32 v12, v6, v13, v12 bitop3:0xca
    v_add_lshl_u32 v11, v11, s40, 17
    v_lshlrev_b16 v14, 8, v14
    v_lshrrev_b32 v13, 2, v96
    v_or_b32 v64, v12, v11
    v_bitop3_b32 v96, v5, v13, v14 bitop3:0xea
    ds_add_u32 v96, v2
    v_mul_hi_u32_u24 v14, 429497, v65
    v_lshrrev_b32 v12, 3, v97
    v_cos_f32 v8, v8
    v_lshlrev_b16 v13, 3, v97
    v_mad_i32_i24 v11, v14, s55, v65
    v_bitop3_b32 v12, v6, v13, v12 bitop3:0xca
    v_add_lshl_u32 v11, v11, s40, 17
    v_lshlrev_b16 v14, 8, v14
    v_lshrrev_b32 v13, 2, v97
    v_or_b32 v65, v12, v11
    v_bitop3_b32 v97, v5, v13, v14 bitop3:0xea
    ds_add_u32 v97, v2
    v_cvt_pk_bf16_f32 v100, v7, v8
    v_perm_b32 v12, v100, v100, s41
    v_bitop3_b32 v64, v4, v12, v64 bitop3:0xca
    v_perm_b32 v13, v100, v100, s42
    v_bitop3_b32 v65, v4, v13, v65 bitop3:0xca
    v_mul_hi_u32_u24 v14, 429497, v66
    v_lshrrev_b32 v12, 3, v98
    v_cos_f32 v9, v9
    v_lshlrev_b16 v13, 3, v98
    v_mad_i32_i24 v11, v14, s55, v66
    v_bitop3_b32 v12, v6, v13, v12 bitop3:0xca
    v_add_lshl_u32 v11, v11, s40, 17
    v_lshlrev_b16 v14, 8, v14
    v_lshrrev_b32 v13, 2, v98
    v_or_b32 v66, v12, v11
    v_bitop3_b32 v98, v5, v13, v14 bitop3:0xea
    ds_add_u32 v98, v2
    v_mul_hi_u32_u24 v14, 429497, v67
    v_lshrrev_b32 v12, 3, v99
    v_cos_f32 v10, v10
    v_lshlrev_b16 v13, 3, v99
    v_mad_i32_i24 v11, v14, s55, v67
    v_bitop3_b32 v12, v6, v13, v12 bitop3:0xca
    v_add_lshl_u32 v11, v11, s40, 17
    v_lshlrev_b16 v14, 8, v14
    v_lshrrev_b32 v13, 2, v99
    v_or_b32 v67, v12, v11
    v_bitop3_b32 v99, v5, v13, v14 bitop3:0xea
    ds_add_u32 v99, v2
    v_cvt_pk_bf16_f32 v101, v9, v10
    v_perm_b32 v12, v101, v101, s41
    v_bitop3_b32 v66, v4, v12, v66 bitop3:0xca
    v_perm_b32 v13, v101, v101, s42
    v_bitop3_b32 v67, v4, v13, v67 bitop3:0xca
    s_waitcnt vmcnt(10)
    v_lshlrev_b32 v7, 16, v102
    v_and_b32 v8, 0xffff0000, v102
    v_lshlrev_b32 v9, 16, v103
    v_and_b32 v10, 0xffff0000, v103
    v_mul_f32 v7, 0.15915494, v7
    v_mul_f32 v8, 0.15915494, v8
    v_mul_f32 v9, 0.15915494, v9
    v_mul_f32 v10, 0.15915494, v10
    v_mul_hi_u32_u24 v14, 429497, v60
    v_lshrrev_b32 v12, 3, v108
    v_cos_f32 v7, v7
    v_lshlrev_b16 v13, 3, v108
    v_mad_i32_i24 v11, v14, s55, v60
    v_bitop3_b32 v12, v6, v13, v12 bitop3:0xca
    v_add_lshl_u32 v11, v11, s40, 17
    v_lshlrev_b16 v14, 8, v14
    v_lshrrev_b32 v13, 2, v108
    v_or_b32 v60, v12, v11
    v_bitop3_b32 v108, v5, v13, v14 bitop3:0xea
    ds_add_u32 v108, v2
    v_mul_hi_u32_u24 v14, 429497, v61
    v_lshrrev_b32 v12, 3, v109
    v_cos_f32 v8, v8
    v_lshlrev_b16 v13, 3, v109
    v_mad_i32_i24 v11, v14, s55, v61
    v_bitop3_b32 v12, v6, v13, v12 bitop3:0xca
    v_add_lshl_u32 v11, v11, s40, 17
    v_lshlrev_b16 v14, 8, v14
    v_lshrrev_b32 v13, 2, v109
    v_or_b32 v61, v12, v11
    v_bitop3_b32 v109, v5, v13, v14 bitop3:0xea
    ds_add_u32 v109, v2
    v_cvt_pk_bf16_f32 v102, v7, v8
    v_perm_b32 v12, v102, v102, s41
    v_bitop3_b32 v60, v4, v12, v60 bitop3:0xca
    v_perm_b32 v13, v102, v102, s42
    v_bitop3_b32 v61, v4, v13, v61 bitop3:0xca
    v_mul_hi_u32_u24 v14, 429497, v62
    v_lshrrev_b32 v12, 3, v110
    v_cos_f32 v9, v9
    v_lshlrev_b16 v13, 3, v110
    v_mad_i32_i24 v11, v14, s55, v62
    v_bitop3_b32 v12, v6, v13, v12 bitop3:0xca
    v_add_lshl_u32 v11, v11, s40, 17
    v_lshlrev_b16 v14, 8, v14
    v_lshrrev_b32 v13, 2, v110
    v_or_b32 v62, v12, v11
    v_bitop3_b32 v110, v5, v13, v14 bitop3:0xea
    ds_add_u32 v110, v2
    v_mul_hi_u32_u24 v14, 429497, v63
    v_lshrrev_b32 v12, 3, v111
    v_cos_f32 v10, v10
    v_lshlrev_b16 v13, 3, v111
    v_mad_i32_i24 v11, v14, s55, v63
    v_bitop3_b32 v12, v6, v13, v12 bitop3:0xca
    v_add_lshl_u32 v11, v11, s40, 17
    v_lshlrev_b16 v14, 8, v14
    v_lshrrev_b32 v13, 2, v111
    v_or_b32 v63, v12, v11
    v_bitop3_b32 v111, v5, v13, v14 bitop3:0xea
    ds_add_u32 v111, v2
    v_cvt_pk_bf16_f32 v103, v9, v10
    v_perm_b32 v12, v103, v103, s41
    v_bitop3_b32 v62, v4, v12, v62 bitop3:0xca
    v_perm_b32 v13, v103, v103, s42
    v_bitop3_b32 v63, v4, v13, v63 bitop3:0xca
    s_add_u32 s46, s35, 0x548c000
    buffer_store_dwordx4 v[120:123], v0, s[20:23], s46 offen sc1
    s_add_u32 s47, s33, 0x8000000
    s_nop 0
    buffer_load_dwordx4 v[120:123], v0, s[12:15], s47 offen nt
    s_waitcnt vmcnt(8)
    v_lshlrev_b32 v7, 16, v104
    v_and_b32 v8, 0xffff0000, v104
    v_lshlrev_b32 v9, 16, v105
    v_and_b32 v10, 0xffff0000, v105
    v_mul_f32 v7, 0.15915494, v7
    v_mul_f32 v8, 0.15915494, v8
    v_mul_f32 v9, 0.15915494, v9
    v_mul_f32 v10, 0.15915494, v10
    v_mul_hi_u32_u24 v14, 429497, v112
    v_lshrrev_b32 v12, 3, v88
    v_cos_f32 v7, v7
    v_lshlrev_b16 v13, 3, v88
    v_mad_i32_i24 v11, v14, s55, v112
    v_bitop3_b32 v12, v6, v13, v12 bitop3:0xca
    v_add_lshl_u32 v11, v11, s40, 17
    v_lshlrev_b16 v14, 8, v14
    v_lshrrev_b32 v13, 2, v88
    v_or_b32 v112, v12, v11
    v_bitop3_b32 v88, v5, v13, v14 bitop3:0xea
    ds_add_u32 v88, v2
    v_mul_hi_u32_u24 v14, 429497, v113
    v_lshrrev_b32 v12, 3, v89
    v_cos_f32 v8, v8
    v_lshlrev_b16 v13, 3, v89
    v_mad_i32_i24 v11, v14, s55, v113
    v_bitop3_b32 v12, v6, v13, v12 bitop3:0xca
    v_add_lshl_u32 v11, v11, s40, 17
    v_lshlrev_b16 v14, 8, v14
    v_lshrrev_b32 v13, 2, v89
    v_or_b32 v113, v12, v11
    v_bitop3_b32 v89, v5, v13, v14 bitop3:0xea
    ds_add_u32 v89, v2
    v_cvt_pk_bf16_f32 v104, v7, v8
    v_perm_b32 v12, v104, v104, s41
    v_bitop3_b32 v112, v4, v12, v112 bitop3:0xca
    v_perm_b32 v13, v104, v104, s42
    v_bitop3_b32 v113, v4, v13, v113 bitop3:0xca
    v_mul_hi_u32_u24 v14, 429497, v114
    v_lshrrev_b32 v12, 3, v90
    v_cos_f32 v9, v9
    v_lshlrev_b16 v13, 3, v90
    v_mad_i32_i24 v11, v14, s55, v114
    v_bitop3_b32 v12, v6, v13, v12 bitop3:0xca
    v_add_lshl_u32 v11, v11, s40, 17
    v_lshlrev_b16 v14, 8, v14
    v_lshrrev_b32 v13, 2, v90
    v_or_b32 v114, v12, v11
    v_bitop3_b32 v90, v5, v13, v14 bitop3:0xea
    ds_add_u32 v90, v2
    v_mul_hi_u32_u24 v14, 429497, v115
    v_lshrrev_b32 v12, 3, v91
    v_cos_f32 v10, v10
    v_lshlrev_b16 v13, 3, v91
    v_mad_i32_i24 v11, v14, s55, v115
    v_bitop3_b32 v12, v6, v13, v12 bitop3:0xca
    v_add_lshl_u32 v11, v11, s40, 17
    v_lshlrev_b16 v14, 8, v14
    v_lshrrev_b32 v13, 2, v91
    v_or_b32 v115, v12, v11
    v_bitop3_b32 v91, v5, v13, v14 bitop3:0xea
    ds_add_u32 v91, v2
    v_cvt_pk_bf16_f32 v105, v9, v10
    v_perm_b32 v12, v105, v105, s41
    v_bitop3_b32 v114, v4, v12, v114 bitop3:0xca
    v_perm_b32 v13, v105, v105, s42
    v_bitop3_b32 v115, v4, v13, v115 bitop3:0xca
    s_waitcnt vmcnt(4)
    v_lshlrev_b32 v7, 16, v106
    v_and_b32 v8, 0xffff0000, v106
    v_lshlrev_b32 v9, 16, v107
    v_and_b32 v10, 0xffff0000, v107
    v_mul_f32 v7, 0.15915494, v7
    v_mul_f32 v8, 0.15915494, v8
    v_mul_f32 v9, 0.15915494, v9
    v_mul_f32 v10, 0.15915494, v10
    v_mul_hi_u32_u24 v14, 429497, v116
    v_lshrrev_b32 v12, 3, v92
    v_cos_f32 v7, v7
    v_lshlrev_b16 v13, 3, v92
    v_mad_i32_i24 v11, v14, s55, v116
    v_bitop3_b32 v12, v6, v13, v12 bitop3:0xca
    v_add_lshl_u32 v11, v11, s40, 17
    v_lshlrev_b16 v14, 8, v14
    v_lshrrev_b32 v13, 2, v92
    v_or_b32 v116, v12, v11
    v_bitop3_b32 v92, v5, v13, v14 bitop3:0xea
    ds_add_u32 v92, v2
    v_mul_hi_u32_u24 v14, 429497, v117
    v_lshrrev_b32 v12, 3, v93
    v_cos_f32 v8, v8
    v_lshlrev_b16 v13, 3, v93
    v_mad_i32_i24 v11, v14, s55, v117
    v_bitop3_b32 v12, v6, v13, v12 bitop3:0xca
    v_add_lshl_u32 v11, v11, s40, 17
    v_lshlrev_b16 v14, 8, v14
    v_lshrrev_b32 v13, 2, v93
    v_or_b32 v117, v12, v11
    v_bitop3_b32 v93, v5, v13, v14 bitop3:0xea
    ds_add_u32 v93, v2
    v_cvt_pk_bf16_f32 v106, v7, v8
    v_perm_b32 v12, v106, v106, s41
    v_bitop3_b32 v116, v4, v12, v116 bitop3:0xca
    v_perm_b32 v13, v106, v106, s42
    v_bitop3_b32 v117, v4, v13, v117 bitop3:0xca
    v_mul_hi_u32_u24 v14, 429497, v118
    v_lshrrev_b32 v12, 3, v94
    v_cos_f32 v9, v9
    v_lshlrev_b16 v13, 3, v94
    v_mad_i32_i24 v11, v14, s55, v118
    v_bitop3_b32 v12, v6, v13, v12 bitop3:0xca
    v_add_lshl_u32 v11, v11, s40, 17
    v_lshlrev_b16 v14, 8, v14
    v_lshrrev_b32 v13, 2, v94
    v_or_b32 v118, v12, v11
    v_bitop3_b32 v94, v5, v13, v14 bitop3:0xea
    ds_add_u32 v94, v2
    v_mul_hi_u32_u24 v14, 429497, v119
    v_lshrrev_b32 v12, 3, v95
    v_cos_f32 v10, v10
    v_lshlrev_b16 v13, 3, v95
    v_mad_i32_i24 v11, v14, s55, v119
    v_bitop3_b32 v12, v6, v13, v12 bitop3:0xca
    v_add_lshl_u32 v11, v11, s40, 17
    v_lshlrev_b16 v14, 8, v14
    v_lshrrev_b32 v13, 2, v95
    v_or_b32 v119, v12, v11
    v_bitop3_b32 v95, v5, v13, v14 bitop3:0xea
    ds_add_u32 v95, v2
    v_cvt_pk_bf16_f32 v107, v9, v10
    v_perm_b32 v12, v107, v107, s41
    v_bitop3_b32 v118, v4, v12, v118 bitop3:0xca
    v_perm_b32 v13, v107, v107, s42
    v_bitop3_b32 v119, v4, v13, v119 bitop3:0xca
    v_lshrrev_b32 v8, 2, v0
    v_and_b32 v7, 0x3c00, v0
    v_bitop3_b32 v7, v5, v8, v7 bitop3:0xea
    s_waitcnt lgkmcnt(0)
    s_barrier
    ds_read2st64_b32 v[8:9], v7 offset0:0 offset1:1
    ds_read2st64_b32 v[10:11], v7 offset0:2 offset1:3
    s_add_u32 s44, s35, 0x5490000
    buffer_store_dwordx4 v[44:47], v0, s[20:23], s44 offen sc1
    s_add_u32 s45, s34, 0x4000000
    s_nop 0
    buffer_load_dwordx2 v[44:45], v1, s[16:19], s45 offen nt
    s_add_u32 s46, s34, 0x4200000
    buffer_load_dwordx2 v[46:47], v1, s[16:19], s46 offen nt
    s_waitcnt lgkmcnt(0)
    v_lshl_or_b32 v12, v9, 16, v8
    v_lshl_or_b32 v13, v11, 16, v10
    v_mov_b32 v14, v12
    v_mov_b32 v15, v13
    s_nop 0
    v_add_u32_dpp v14, v14, v14 row_shr:1 row_mask:0xf bank_mask:0xf bound_ctrl:1
    v_add_u32_dpp v15, v15, v15 row_shr:1 row_mask:0xf bank_mask:0xf bound_ctrl:1
    s_nop 0
    v_add_u32_dpp v14, v14, v14 row_shr:2 row_mask:0xf bank_mask:0xf bound_ctrl:1
    v_add_u32_dpp v15, v15, v15 row_shr:2 row_mask:0xf bank_mask:0xf bound_ctrl:1
    s_nop 0
    v_add_u32_dpp v14, v14, v14 row_shr:4 row_mask:0xf bank_mask:0xf bound_ctrl:1
    v_add_u32_dpp v15, v15, v15 row_shr:4 row_mask:0xf bank_mask:0xf bound_ctrl:1
    s_nop 0
    v_add_u32_dpp v14, v14, v14 row_shr:8 row_mask:0xf bank_mask:0xf bound_ctrl:1
    v_add_u32_dpp v15, v15, v15 row_shr:8 row_mask:0xf bank_mask:0xf bound_ctrl:1
    s_nop 0
    v_add_u32_dpp v14, v14, v14 row_bcast:15 row_mask:0xa bank_mask:0xf
    v_add_u32_dpp v15, v15, v15 row_bcast:15 row_mask:0xa bank_mask:0xf
    s_nop 0
    v_add_u32_dpp v14, v14, v14 row_bcast:31 row_mask:0xc bank_mask:0xf
    v_add_u32_dpp v15, v15, v15 row_bcast:31 row_mask:0xc bank_mask:0xf
    v_readlane_b32 s48, v14, 63
    v_readlane_b32 s49, v15, 63
    s_lshl_b32 s54, s32, 2
    v_mov_b32 v8, s54
    s_and_b32 s50, s48, 0xffff
    s_lshr_b32 s51, s48, 16
    s_and_b32 s52, s49, 0xffff
    s_lshr_b32 s53, s49, 16
    s_add_u32 s51, s51, s50
    s_add_u32 s52, s52, s51
    s_add_u32 s53, s53, s52
    v_mov_b32 v9, s53
    s_mov_b64 exec, 1
    ds_write_b32 v8, v9 offset:16384
    s_waitcnt vmcnt(5)
    ds_write_b32 v8, v3 offset:16448
    s_mov_b64 exec, -1
    v_and_b32 v8, 60, v7
    s_waitcnt lgkmcnt(0)
    s_barrier
    ds_read_b32 v9, v8 offset:16384
    ds_read_b32 v10, v8 offset:16448
    s_waitcnt lgkmcnt(0)
    v_readlane_b32 s84, v10, 15
    s_min_u32 s4, s84, 136
    s_min_u32 s5, s84, 176
    s_min_u32 s6, s84, 216
    s_add_u32 s4, s4, s5
    s_add_u32 s4, s4, s6
    s_add_u32 s4, s4, 9467
    s_mov_b32 s4, s84
    s_lshl_b32 s58, s4, 14
    s_lshl_b32 s59, s4, 13
    s_mov_b32 s43, 5
    s_cmp_lt_u32 s84, 136
    s_addc_u32 s43, s43, 0
    s_cmp_lt_u32 s84, 176
    s_addc_u32 s43, s43, 0
    s_cmp_lt_u32 s84, 216
    s_addc_u32 s43, s43, 0
    v_add_u32_dpp v9, v9, v9 row_shr:1 row_mask:0xf bank_mask:0xf bound_ctrl:1
    s_nop 1
    v_add_u32_dpp v9, v9, v9 row_shr:2 row_mask:0xf bank_mask:0xf bound_ctrl:1
    s_nop 1
    v_add_u32_dpp v9, v9, v9 row_shr:4 row_mask:0xf bank_mask:0xf bound_ctrl:1
    s_nop 1
    v_add_u32_dpp v9, v9, v9 row_shr:8 row_mask:0xf bank_mask:0xf bound_ctrl:1
    s_nop 0
    v_readlane_b32 s54, v9, s32
    s_sub_u32 s54, s54, s53
    s_add_u32 s50, s50, s54
    s_add_u32 s51, s51, s54
    s_add_u32 s52, s52, s54
    s_pack_ll_b32_b16 s48, s54, s50
    s_pack_ll_b32_b16 s49, s51, s52
    v_add_u32 v14, s48, v14
    v_add_u32 v15, s49, v15
    v_sub_u32 v12, v14, v12
    v_sub_u32 v13, v15, v13
    v_and_b32 v8, 0xffff, v12
    v_lshrrev_b32 v9, 16, v12
    v_and_b32 v10, 0xffff, v13
    v_lshrrev_b32 v11, 16, v13
    ds_write2st64_b32 v7, v8, v9 offset0:0 offset1:1
    ds_write2st64_b32 v7, v10, v11 offset0:2 offset1:3
    s_waitcnt lgkmcnt(0)
    s_barrier
    ds_add_rtn_u32 v24, v24, v2
    ds_add_rtn_u32 v25, v25, v2
    ds_add_rtn_u32 v26, v26, v2
    ds_add_rtn_u32 v27, v27, v2
    s_add_u32 s47, s36, 0x7ec0000
    v_and_b32 v11, 0x3f0, v0
    v_add_u32 v11, v11, v11
    buffer_store_dwordx2 v[12:13], v11, s[24:27], s47 offen
    s_bitset0_b64 exec, 63
    s_not_b64 exec, exec
    buffer_store_dwordx2 v[14:15], v11, s[24:27], s47 offen offset:32
    s_mov_b64 exec, -1
    v_cmp_le_u32 vcc, s37, v0
    v_add_u32 v10, 8320, v0
    s_cmp_lg_u32 s32, 0
    v_cndmask_b32 v10, v0, v10, vcc
    s_cbranch_scc1 L1_p4
    s_add_u32 s44, s35, 0x7ec0000
    s_mov_b64 exec, 0xff
    buffer_store_dwordx4 v[12:15], v10, s[24:27], s44 offen
    s_mov_b64 exec, -1
L1_p4:
    ds_add_rtn_u32 v52, v52, v2
    ds_add_rtn_u32 v53, v53, v2
    ds_add_rtn_u32 v54, v54, v2
    ds_add_rtn_u32 v55, v55, v2
    ds_add_rtn_u32 v72, v72, v2
    ds_add_rtn_u32 v73, v73, v2
    ds_add_rtn_u32 v74, v74, v2
    ds_add_rtn_u32 v75, v75, v2
    s_add_u32 s45, s35, 0x5494000
    buffer_store_dwordx4 v[20:23], v0, s[20:23], s45 offen sc1
    s_add_u32 s46, s33, 0x8400000
    s_nop 0
    buffer_load_dwordx4 v[20:23], v0, s[8:11], s46 offen nt
    ds_add_rtn_u32 v80, v80, v2
    ds_add_rtn_u32 v81, v81, v2
    ds_add_rtn_u32 v82, v82, v2
    ds_add_rtn_u32 v83, v83, v2
    ds_add_rtn_u32 v96, v96, v2
    ds_add_rtn_u32 v97, v97, v2
    ds_add_rtn_u32 v98, v98, v2
    ds_add_rtn_u32 v99, v99, v2
    ds_add_rtn_u32 v108, v108, v2
    ds_add_rtn_u32 v109, v109, v2
    ds_add_rtn_u32 v110, v110, v2
    ds_add_rtn_u32 v111, v111, v2
    s_add_u32 s47, s35, 0x5498000
    buffer_store_dwordx4 v[124:127], v0, s[20:23], s47 offen sc1
    s_add_u32 s44, s33, 0x8400000
    s_nop 0
    buffer_load_dwordx4 v[124:127], v0, s[12:15], s44 offen nt
    ds_add_rtn_u32 v88, v88, v2
    ds_add_rtn_u32 v89, v89, v2
    ds_add_rtn_u32 v90, v90, v2
    ds_add_rtn_u32 v91, v91, v2
    ds_add_rtn_u32 v92, v92, v2
    ds_add_rtn_u32 v93, v93, v2
    ds_add_rtn_u32 v94, v94, v2
    ds_add_rtn_u32 v95, v95, v2
    s_waitcnt lgkmcnt(0)
    s_barrier
    v_and_b32 v7, -4, v24
    v_lshl_add_u32 v8, v24, 2, v7
    ds_write_b32 v8, v40
    v_lshl_add_u32 v7, v7, 2, v24
    ds_write_b8 v7, v84 offset:16
    v_and_b32 v9, -4, v25
    v_lshl_add_u32 v10, v25, 2, v9
    ds_write_b32 v10, v41
    v_lshl_add_u32 v9, v9, 2, v25
    ds_write_b8_d16_hi v9, v84 offset:16
    v_and_b32 v7, -4, v26
    v_lshl_add_u32 v8, v26, 2, v7
    ds_write_b32 v8, v42
    v_lshl_add_u32 v7, v7, 2, v26
    ds_write_b8 v7, v85 offset:16
    v_and_b32 v9, -4, v27
    v_lshl_add_u32 v10, v27, 2, v9
    ds_write_b32 v10, v43
    v_lshl_add_u32 v9, v9, 2, v27
    ds_write_b8_d16_hi v9, v85 offset:16
    s_add_u32 s45, s35, 0x549c000
    buffer_store_dwordx4 v[32:35], v0, s[20:23], s45 offen sc1
    s_add_u32 s46, s33, 0x8800000
    buffer_load_dwordx4 v[40:43], v0, s[8:11], s46 offen nt
    s_add_u32 s47, s33, 0x8800000
    buffer_load_dwordx4 v[24:27], v0, s[12:15], s47 offen nt
    v_and_b32 v7, -4, v52
    v_lshl_add_u32 v8, v52, 2, v7
    ds_write_b32 v8, v48
    v_lshl_add_u32 v7, v7, 2, v52
    ds_write_b8 v7, v86 offset:16
    v_and_b32 v9, -4, v53
    v_lshl_add_u32 v10, v53, 2, v9
    ds_write_b32 v10, v49
    v_lshl_add_u32 v9, v9, 2, v53
    ds_write_b8_d16_hi v9, v86 offset:16
    v_and_b32 v7, -4, v54
    v_lshl_add_u32 v8, v54, 2, v7
    ds_write_b32 v8, v50
    v_lshl_add_u32 v7, v7, 2, v54
    ds_write_b8 v7, v87 offset:16
    v_and_b32 v9, -4, v55
    v_lshl_add_u32 v10, v55, 2, v9
    ds_write_b32 v10, v51
    v_lshl_add_u32 v9, v9, 2, v55
    ds_write_b8_d16_hi v9, v87 offset:16
    s_add_u32 s44, s34, 0x4400000
    buffer_load_dwordx2 v[32:33], v1, s[16:19], s44 offen nt
    s_add_u32 s45, s34, 0x4600000
    buffer_load_dwordx2 v[34:35], v1, s[16:19], s45 offen nt
    s_add_u32 s46, s33, 0x8c00000
    buffer_load_dwordx4 v[48:51], v0, s[8:11], s46 offen nt
    v_and_b32 v7, -4, v72
    v_lshl_add_u32 v8, v72, 2, v7
    ds_write_b32 v8, v68
    v_lshl_add_u32 v7, v7, 2, v72
    ds_write_b8 v7, v56 offset:16
    v_and_b32 v9, -4, v73
    v_lshl_add_u32 v10, v73, 2, v9
    ds_write_b32 v10, v69
    v_lshl_add_u32 v9, v9, 2, v73
    ds_write_b8_d16_hi v9, v56 offset:16
    v_and_b32 v7, -4, v74
    v_lshl_add_u32 v8, v74, 2, v7
    ds_write_b32 v8, v70
    v_lshl_add_u32 v7, v7, 2, v74
    ds_write_b8 v7, v57 offset:16
    v_and_b32 v9, -4, v75
    v_lshl_add_u32 v10, v75, 2, v9
    ds_write_b32 v10, v71
    v_lshl_add_u32 v9, v9, 2, v75
    ds_write_b8_d16_hi v9, v57 offset:16
    s_add_u32 s47, s35, 0x54a0000
    buffer_store_dwordx4 v[36:39], v0, s[20:23], s47 offen sc1
    s_add_u32 s44, s33, 0x8c00000
    buffer_load_dwordx4 v[52:55], v0, s[12:15], s44 offen nt
    v_and_b32 v7, -4, v80
    v_lshl_add_u32 v8, v80, 2, v7
    ds_write_b32 v8, v76
    v_lshl_add_u32 v7, v7, 2, v80
    ds_write_b8 v7, v58 offset:16
    v_and_b32 v9, -4, v81
    v_lshl_add_u32 v10, v81, 2, v9
    ds_write_b32 v10, v77
    v_lshl_add_u32 v9, v9, 2, v81
    ds_write_b8_d16_hi v9, v58 offset:16
    v_and_b32 v7, -4, v82
    v_lshl_add_u32 v8, v82, 2, v7
    ds_write_b32 v8, v78
    v_lshl_add_u32 v7, v7, 2, v82
    ds_write_b8 v7, v59 offset:16
    v_and_b32 v9, -4, v83
    v_lshl_add_u32 v10, v83, 2, v9
    ds_write_b32 v10, v79
    v_lshl_add_u32 v9, v9, 2, v83
    ds_write_b8_d16_hi v9, v59 offset:16
    s_add_u32 s45, s33, 0x9000000
    buffer_load_dwordx4 v[84:87], v0, s[8:11], s45 offen nt
    s_add_u32 s46, s33, 0x9000000
    buffer_load_dwordx4 v[68:71], v0, s[12:15], s46 offen nt
    v_and_b32 v7, -4, v96
    v_lshl_add_u32 v8, v96, 2, v7
    ds_write_b32 v8, v64
    v_lshl_add_u32 v7, v7, 2, v96
    ds_write_b8 v7, v100 offset:16
    v_and_b32 v9, -4, v97
    v_lshl_add_u32 v10, v97, 2, v9
    ds_write_b32 v10, v65
    v_lshl_add_u32 v9, v9, 2, v97
    ds_write_b8_d16_hi v9, v100 offset:16
    v_and_b32 v7, -4, v98
    v_lshl_add_u32 v8, v98, 2, v7
    ds_write_b32 v8, v66
    v_lshl_add_u32 v7, v7, 2, v98
    ds_write_b8 v7, v101 offset:16
    v_and_b32 v9, -4, v99
    v_lshl_add_u32 v10, v99, 2, v9
    ds_write_b32 v10, v67
    v_lshl_add_u32 v9, v9, 2, v99
    ds_write_b8_d16_hi v9, v101 offset:16
    s_add_u32 s47, s34, 0x4800000
    buffer_load_dwordx2 v[72:73], v1, s[16:19], s47 offen nt
    s_cmp_le_u32 s43, 5
    s_cselect_b32 s18, 0, s18
    s_add_u32 s44, s59, 0x4a00000
    buffer_load_dwordx2 v[74:75], v1, s[16:19], s44 offen nt
    s_cmp_le_u32 s43, 5
    s_cselect_b32 s10, 0, s10
    s_add_u32 s45, s58, 0x9400000
    buffer_load_dwordx4 v[36:39], v0, s[8:11], s45 offen nt
    v_and_b32 v7, -4, v108
    v_lshl_add_u32 v8, v108, 2, v7
    ds_write_b32 v8, v60
    v_lshl_add_u32 v7, v7, 2, v108
    ds_write_b8 v7, v102 offset:16
    v_and_b32 v9, -4, v109
    v_lshl_add_u32 v10, v109, 2, v9
    ds_write_b32 v10, v61
    v_lshl_add_u32 v9, v9, 2, v109
    ds_write_b8_d16_hi v9, v102 offset:16
    v_and_b32 v7, -4, v110
    v_lshl_add_u32 v8, v110, 2, v7
    ds_write_b32 v8, v62
    v_lshl_add_u32 v7, v7, 2, v110
    ds_write_b8 v7, v103 offset:16
    v_and_b32 v9, -4, v111
    v_lshl_add_u32 v10, v111, 2, v9
    ds_write_b32 v10, v63
    v_lshl_add_u32 v9, v9, 2, v111
    ds_write_b8_d16_hi v9, v103 offset:16
    s_add_u32 s46, s35, 0x54a4000
    buffer_store_dwordx4 v[28:31], v0, s[20:23], s46 offen sc1
    s_cmp_le_u32 s43, 5
    s_cselect_b32 s14, 0, s14
    s_add_u32 s47, s58, 0x9400000
    buffer_load_dwordx4 v[76:79], v0, s[12:15], s47 offen nt
    v_and_b32 v7, -4, v88
    v_lshl_add_u32 v8, v88, 2, v7
    ds_write_b32 v8, v112
    v_lshl_add_u32 v7, v7, 2, v88
    ds_write_b8 v7, v104 offset:16
    v_and_b32 v9, -4, v89
    v_lshl_add_u32 v10, v89, 2, v9
    ds_write_b32 v10, v113
    v_lshl_add_u32 v9, v9, 2, v89
    ds_write_b8_d16_hi v9, v104 offset:16
    v_and_b32 v7, -4, v90
    v_lshl_add_u32 v8, v90, 2, v7
    ds_write_b32 v8, v114
    v_lshl_add_u32 v7, v7, 2, v90
    ds_write_b8 v7, v105 offset:16
    v_and_b32 v9, -4, v91
    v_lshl_add_u32 v10, v91, 2, v9
    ds_write_b32 v10, v115
    v_lshl_add_u32 v9, v9, 2, v91
    ds_write_b8_d16_hi v9, v105 offset:16
    s_cmp_le_u32 s43, 6
    s_cselect_b32 s10, 0, s10
    s_add_u32 s44, s58, 0x9760000
    buffer_load_dwordx4 v[80:83], v0, s[8:11], s44 offen nt
    s_cmp_le_u32 s43, 6
    s_cselect_b32 s14, 0, s14
    s_add_u32 s45, s58, 0x9760000
    buffer_load_dwordx4 v[56:59], v0, s[12:15], s45 offen nt
    v_and_b32 v7, -4, v92
    v_lshl_add_u32 v8, v92, 2, v7
    ds_write_b32 v8, v116
    v_lshl_add_u32 v7, v7, 2, v92
    ds_write_b8 v7, v106 offset:16
    v_and_b32 v9, -4, v93
    v_lshl_add_u32 v10, v93, 2, v9
    ds_write_b32 v10, v117
    v_lshl_add_u32 v9, v9, 2, v93
    ds_write_b8_d16_hi v9, v106 offset:16
    v_and_b32 v7, -4, v94
    v_lshl_add_u32 v8, v94, 2, v7
    ds_write_b32 v8, v118
    v_lshl_add_u32 v7, v7, 2, v94
    ds_write_b8 v7, v107 offset:16
    v_and_b32 v9, -4, v95
    v_lshl_add_u32 v10, v95, 2, v9
    ds_write_b32 v10, v119
    v_lshl_add_u32 v9, v9, 2, v95
    ds_write_b8_d16_hi v9, v107 offset:16
    s_cmp_le_u32 s43, 6
    s_cselect_b32 s18, 0, s18
    s_add_u32 s46, s59, 0x4bb0000
    buffer_load_dwordx2 v[64:65], v1, s[16:19], s46 offen nt
    s_cmp_le_u32 s43, 7
    s_cselect_b32 s18, 0, s18
    s_add_u32 s47, s59, 0x4d10000
    buffer_load_dwordx2 v[66:67], v1, s[16:19], s47 offen nt
    v_add_u32 v7, 0x10000, v0
    v_add_u32 v12, 0x20000, v0
    v_mov_b32 v8, 0
    v_mov_b32 v9, 0
    v_mov_b32 v10, 0
    v_mov_b32 v11, 0
    s_waitcnt lgkmcnt(0)
    s_barrier
    ds_read_b128 v[96:99], v0 offset:0
    ds_write_b128 v0, v[8:11]
    ds_read_b128 v[60:63], v0 offset:16384
    ds_read_b128 v[108:111], v0 offset:32768
    ds_read_b128 v[100:103], v0 offset:49152
    ds_read_b128 v[28:31], v7 offset:0
    ds_read_b128 v[112:115], v7 offset:16384
    ds_read_b128 v[88:91], v7 offset:32768
    ds_read_b128 v[116:119], v7 offset:49152
    ds_read_b128 v[92:95], v12 offset:0
    ds_read_b128 v[104:107], v12 offset:16384
    s_waitcnt lgkmcnt(0)
    s_barrier
    s_add_u32 s44, s35, 0x7ec0000
    buffer_store_dwordx4 v[96:99], v0, s[20:23], s44 offen sc1
    s_cmp_le_u32 s43, 7
    s_cselect_b32 s10, 0, s10
    s_add_u32 s45, s58, 0x9a20000
    buffer_load_dwordx4 v[96:99], v0, s[8:11], s45 offen nt
    s_add_u32 s46, s35, 0x7ec4000
    buffer_store_dwordx4 v[60:63], v0, s[20:23], s46 offen sc1
    s_cmp_le_u32 s43, 7
    s_cselect_b32 s14, 0, s14
    s_add_u32 s47, s58, 0x9a20000
    buffer_load_dwordx4 v[60:63], v0, s[12:15], s47 offen nt
    s_waitcnt vmcnt(29)
    v_lshlrev_b32 v7, 16, v44
    v_and_b32 v8, 0xffff0000, v44
    v_lshlrev_b32 v9, 16, v45
    v_and_b32 v10, 0xffff0000, v45
    v_mul_f32 v7, 0.15915494, v7
    v_mul_f32 v8, 0.15915494, v8
    v_mul_f32 v9, 0.15915494, v9
    v_mul_f32 v10, 0.15915494, v10
    v_mul_hi_u32_u24 v14, 429497, v16
    v_lshrrev_b32 v12, 3, v120
    v_cos_f32 v7, v7
    v_lshlrev_b16 v13, 3, v120
    v_mad_i32_i24 v11, v14, s55, v16
    v_bitop3_b32 v12, v6, v13, v12 bitop3:0xca
    v_add_lshl_u32 v11, v11, s40, 17
    v_lshlrev_b16 v14, 8, v14
    v_lshrrev_b32 v13, 2, v120
    v_or_b32 v16, v12, v11
    v_bitop3_b32 v120, v5, v13, v14 bitop3:0xea
    ds_add_u32 v120, v2
    v_mul_hi_u32_u24 v14, 429497, v17
    v_lshrrev_b32 v12, 3, v121
    v_cos_f32 v8, v8
    v_lshlrev_b16 v13, 3, v121
    v_mad_i32_i24 v11, v14, s55, v17
    v_bitop3_b32 v12, v6, v13, v12 bitop3:0xca
    v_add_lshl_u32 v11, v11, s40, 17
    v_lshlrev_b16 v14, 8, v14
    v_lshrrev_b32 v13, 2, v121
    v_or_b32 v17, v12, v11
    v_bitop3_b32 v121, v5, v13, v14 bitop3:0xea
    ds_add_u32 v121, v2
    v_cvt_pk_bf16_f32 v44, v7, v8
    v_perm_b32 v12, v44, v44, s41
    v_bitop3_b32 v16, v4, v12, v16 bitop3:0xca
    v_perm_b32 v13, v44, v44, s42
    v_bitop3_b32 v17, v4, v13, v17 bitop3:0xca
    v_mul_hi_u32_u24 v14, 429497, v18
    v_lshrrev_b32 v12, 3, v122
    v_cos_f32 v9, v9
    v_lshlrev_b16 v13, 3, v122
    v_mad_i32_i24 v11, v14, s55, v18
    v_bitop3_b32 v12, v6, v13, v12 bitop3:0xca
    v_add_lshl_u32 v11, v11, s40, 17
    v_lshlrev_b16 v14, 8, v14
    v_lshrrev_b32 v13, 2, v122
    v_or_b32 v18, v12, v11
    v_bitop3_b32 v122, v5, v13, v14 bitop3:0xea
    ds_add_u32 v122, v2
    v_mul_hi_u32_u24 v14, 429497, v19
    v_lshrrev_b32 v12, 3, v123
    v_cos_f32 v10, v10
    v_lshlrev_b16 v13, 3, v123
    v_mad_i32_i24 v11, v14, s55, v19
    v_bitop3_b32 v12, v6, v13, v12 bitop3:0xca
    v_add_lshl_u32 v11, v11, s40, 17
    v_lshlrev_b16 v14, 8, v14
    v_lshrrev_b32 v13, 2, v123
    v_or_b32 v19, v12, v11
    v_bitop3_b32 v123, v5, v13, v14 bitop3:0xea
    ds_add_u32 v123, v2
    v_cvt_pk_bf16_f32 v45, v9, v10
    v_perm_b32 v12, v45, v45, s41
    v_bitop3_b32 v18, v4, v12, v18 bitop3:0xca
    v_perm_b32 v13, v45, v45, s42
    v_bitop3_b32 v19, v4, v13, v19 bitop3:0xca
    s_add_u32 s44, s35, 0x7ec8000
    buffer_store_dwordx4 v[108:111], v0, s[20:23], s44 offen sc1
    s_waitcnt vmcnt(24)
    v_lshlrev_b32 v7, 16, v46
    v_and_b32 v8, 0xffff0000, v46
    v_lshlrev_b32 v9, 16, v47
    v_and_b32 v10, 0xffff0000, v47
    v_mul_f32 v7, 0.15915494, v7
    v_mul_f32 v8, 0.15915494, v8
    v_mul_f32 v9, 0.15915494, v9
    v_mul_f32 v10, 0.15915494, v10
    v_mul_hi_u32_u24 v14, 429497, v20
    v_lshrrev_b32 v12, 3, v124
    v_cos_f32 v7, v7
    v_lshlrev_b16 v13, 3, v124
    v_mad_i32_i24 v11, v14, s55, v20
    v_bitop3_b32 v12, v6, v13, v12 bitop3:0xca
    v_add_lshl_u32 v11, v11, s40, 17
    v_lshlrev_b16 v14, 8, v14
    v_lshrrev_b32 v13, 2, v124
    v_or_b32 v20, v12, v11
    v_bitop3_b32 v124, v5, v13, v14 bitop3:0xea
    ds_add_u32 v124, v2
    v_mul_hi_u32_u24 v14, 429497, v21
    v_lshrrev_b32 v12, 3, v125
    v_cos_f32 v8, v8
    v_lshlrev_b16 v13, 3, v125
    v_mad_i32_i24 v11, v14, s55, v21
    v_bitop3_b32 v12, v6, v13, v12 bitop3:0xca
    v_add_lshl_u32 v11, v11, s40, 17
    v_lshlrev_b16 v14, 8, v14
    v_lshrrev_b32 v13, 2, v125
    v_or_b32 v21, v12, v11
    v_bitop3_b32 v125, v5, v13, v14 bitop3:0xea
    ds_add_u32 v125, v2
    v_cvt_pk_bf16_f32 v46, v7, v8
    v_perm_b32 v12, v46, v46, s41
    v_bitop3_b32 v20, v4, v12, v20 bitop3:0xca
    v_perm_b32 v13, v46, v46, s42
    v_bitop3_b32 v21, v4, v13, v21 bitop3:0xca
    v_mul_hi_u32_u24 v14, 429497, v22
    v_lshrrev_b32 v12, 3, v126
    v_cos_f32 v9, v9
    v_lshlrev_b16 v13, 3, v126
    v_mad_i32_i24 v11, v14, s55, v22
    v_bitop3_b32 v12, v6, v13, v12 bitop3:0xca
    v_add_lshl_u32 v11, v11, s40, 17
    v_lshlrev_b16 v14, 8, v14
    v_lshrrev_b32 v13, 2, v126
    v_or_b32 v22, v12, v11
    v_bitop3_b32 v126, v5, v13, v14 bitop3:0xea
    ds_add_u32 v126, v2
    v_mul_hi_u32_u24 v14, 429497, v23
    v_lshrrev_b32 v12, 3, v127
    v_cos_f32 v10, v10
    v_lshlrev_b16 v13, 3, v127
    v_mad_i32_i24 v11, v14, s55, v23
    v_bitop3_b32 v12, v6, v13, v12 bitop3:0xca
    v_add_lshl_u32 v11, v11, s40, 17
    v_lshlrev_b16 v14, 8, v14
    v_lshrrev_b32 v13, 2, v127
    v_or_b32 v23, v12, v11
    v_bitop3_b32 v127, v5, v13, v14 bitop3:0xea
    ds_add_u32 v127, v2
    v_cvt_pk_bf16_f32 v47, v9, v10
    v_perm_b32 v12, v47, v47, s41
    v_bitop3_b32 v22, v4, v12, v22 bitop3:0xca
    v_perm_b32 v13, v47, v47, s42
    v_bitop3_b32 v23, v4, v13, v23 bitop3:0xca
    s_waitcnt vmcnt(19)
    v_lshlrev_b32 v7, 16, v32
    v_and_b32 v8, 0xffff0000, v32
    v_lshlrev_b32 v9, 16, v33
    v_and_b32 v10, 0xffff0000, v33
    v_mul_f32 v7, 0.15915494, v7
    v_mul_f32 v8, 0.15915494, v8
    v_mul_f32 v9, 0.15915494, v9
    v_mul_f32 v10, 0.15915494, v10
    v_mul_hi_u32_u24 v14, 429497, v40
    v_lshrrev_b32 v12, 3, v24
    v_cos_f32 v7, v7
    v_lshlrev_b16 v13, 3, v24
    v_mad_i32_i24 v11, v14, s55, v40
    v_bitop3_b32 v12, v6, v13, v12 bitop3:0xca
    v_add_lshl_u32 v11, v11, s40, 17
    v_lshlrev_b16 v14, 8, v14
    v_lshrrev_b32 v13, 2, v24
    v_or_b32 v40, v12, v11
    v_bitop3_b32 v24, v5, v13, v14 bitop3:0xea
    ds_add_u32 v24, v2
    v_mul_hi_u32_u24 v14, 429497, v41
    v_lshrrev_b32 v12, 3, v25
    v_cos_f32 v8, v8
    v_lshlrev_b16 v13, 3, v25
    v_mad_i32_i24 v11, v14, s55, v41
    v_bitop3_b32 v12, v6, v13, v12 bitop3:0xca
    v_add_lshl_u32 v11, v11, s40, 17
    v_lshlrev_b16 v14, 8, v14
    v_lshrrev_b32 v13, 2, v25
    v_or_b32 v41, v12, v11
    v_bitop3_b32 v25, v5, v13, v14 bitop3:0xea
    ds_add_u32 v25, v2
    v_cvt_pk_bf16_f32 v32, v7, v8
    v_perm_b32 v12, v32, v32, s41
    v_bitop3_b32 v40, v4, v12, v40 bitop3:0xca
    v_perm_b32 v13, v32, v32, s42
    v_bitop3_b32 v41, v4, v13, v41 bitop3:0xca
    v_mul_hi_u32_u24 v14, 429497, v42
    v_lshrrev_b32 v12, 3, v26
    v_cos_f32 v9, v9
    v_lshlrev_b16 v13, 3, v26
    v_mad_i32_i24 v11, v14, s55, v42
    v_bitop3_b32 v12, v6, v13, v12 bitop3:0xca
    v_add_lshl_u32 v11, v11, s40, 17
    v_lshlrev_b16 v14, 8, v14
    v_lshrrev_b32 v13, 2, v26
    v_or_b32 v42, v12, v11
    v_bitop3_b32 v26, v5, v13, v14 bitop3:0xea
    ds_add_u32 v26, v2
    v_mul_hi_u32_u24 v14, 429497, v43
    v_lshrrev_b32 v12, 3, v27
    v_cos_f32 v10, v10
    v_lshlrev_b16 v13, 3, v27
    v_mad_i32_i24 v11, v14, s55, v43
    v_bitop3_b32 v12, v6, v13, v12 bitop3:0xca
    v_add_lshl_u32 v11, v11, s40, 17
    v_lshlrev_b16 v14, 8, v14
    v_lshrrev_b32 v13, 2, v27
    v_or_b32 v43, v12, v11
    v_bitop3_b32 v27, v5, v13, v14 bitop3:0xea
    ds_add_u32 v27, v2
    v_cvt_pk_bf16_f32 v33, v9, v10
    v_perm_b32 v12, v33, v33, s41
    v_bitop3_b32 v42, v4, v12, v42 bitop3:0xca
    v_perm_b32 v13, v33, v33, s42
    v_bitop3_b32 v43, v4, v13, v43 bitop3:0xca
    s_waitcnt vmcnt(16)
    v_lshlrev_b32 v7, 16, v34
    v_and_b32 v8, 0xffff0000, v34
    v_lshlrev_b32 v9, 16, v35
    v_and_b32 v10, 0xffff0000, v35
    v_mul_f32 v7, 0.15915494, v7
    v_mul_f32 v8, 0.15915494, v8
    v_mul_f32 v9, 0.15915494, v9
    v_mul_f32 v10, 0.15915494, v10
    v_mul_hi_u32_u24 v14, 429497, v48
    v_lshrrev_b32 v12, 3, v52
    v_cos_f32 v7, v7
    v_lshlrev_b16 v13, 3, v52
    v_mad_i32_i24 v11, v14, s55, v48
    v_bitop3_b32 v12, v6, v13, v12 bitop3:0xca
    v_add_lshl_u32 v11, v11, s40, 17
    v_lshlrev_b16 v14, 8, v14
    v_lshrrev_b32 v13, 2, v52
    v_or_b32 v48, v12, v11
    v_bitop3_b32 v52, v5, v13, v14 bitop3:0xea
    ds_add_u32 v52, v2
    v_mul_hi_u32_u24 v14, 429497, v49
    v_lshrrev_b32 v12, 3, v53
    v_cos_f32 v8, v8
    v_lshlrev_b16 v13, 3, v53
    v_mad_i32_i24 v11, v14, s55, v49
    v_bitop3_b32 v12, v6, v13, v12 bitop3:0xca
    v_add_lshl_u32 v11, v11, s40, 17
    v_lshlrev_b16 v14, 8, v14
    v_lshrrev_b32 v13, 2, v53
    v_or_b32 v49, v12, v11
    v_bitop3_b32 v53, v5, v13, v14 bitop3:0xea
    ds_add_u32 v53, v2
    v_cvt_pk_bf16_f32 v34, v7, v8
    v_perm_b32 v12, v34, v34, s41
    v_bitop3_b32 v48, v4, v12, v48 bitop3:0xca
    v_perm_b32 v13, v34, v34, s42
    v_bitop3_b32 v49, v4, v13, v49 bitop3:0xca
    v_mul_hi_u32_u24 v14, 429497, v50
    v_lshrrev_b32 v12, 3, v54
    v_cos_f32 v9, v9
    v_lshlrev_b16 v13, 3, v54
    v_mad_i32_i24 v11, v14, s55, v50
    v_bitop3_b32 v12, v6, v13, v12 bitop3:0xca
    v_add_lshl_u32 v11, v11, s40, 17
    v_lshlrev_b16 v14, 8, v14
    v_lshrrev_b32 v13, 2, v54
    v_or_b32 v50, v12, v11
    v_bitop3_b32 v54, v5, v13, v14 bitop3:0xea
    ds_add_u32 v54, v2
    v_mul_hi_u32_u24 v14, 429497, v51
    v_lshrrev_b32 v12, 3, v55
    v_cos_f32 v10, v10
    v_lshlrev_b16 v13, 3, v55
    v_mad_i32_i24 v11, v14, s55, v51
    v_bitop3_b32 v12, v6, v13, v12 bitop3:0xca
    v_add_lshl_u32 v11, v11, s40, 17
    v_lshlrev_b16 v14, 8, v14
    v_lshrrev_b32 v13, 2, v55
    v_or_b32 v51, v12, v11
    v_bitop3_b32 v55, v5, v13, v14 bitop3:0xea
    ds_add_u32 v55, v2
    v_cvt_pk_bf16_f32 v35, v9, v10
    v_perm_b32 v12, v35, v35, s41
    v_bitop3_b32 v50, v4, v12, v50 bitop3:0xca
    v_perm_b32 v13, v35, v35, s42
    v_bitop3_b32 v51, v4, v13, v51 bitop3:0xca
    s_add_u32 s45, s35, 0x7ecc000
    buffer_store_dwordx4 v[100:103], v0, s[20:23], s45 offen sc1
    buffer_load_dwordx4 v[108:111], v0, s[80:83], 0 offen
    v_add_u32 v15, 0x4000, v0
    buffer_load_dwordx4 v[108:111], v15, s[80:83], 0 offen
    s_waitcnt vmcnt(15)
    v_lshlrev_b32 v7, 16, v72
    v_and_b32 v8, 0xffff0000, v72
    v_lshlrev_b32 v9, 16, v73
    v_and_b32 v10, 0xffff0000, v73
    v_mul_f32 v7, 0.15915494, v7
    v_mul_f32 v8, 0.15915494, v8
    v_mul_f32 v9, 0.15915494, v9
    v_mul_f32 v10, 0.15915494, v10
    v_mul_hi_u32_u24 v14, 429497, v84
    v_lshrrev_b32 v12, 3, v68
    v_cos_f32 v7, v7
    v_lshlrev_b16 v13, 3, v68
    v_mad_i32_i24 v11, v14, s55, v84
    v_bitop3_b32 v12, v6, v13, v12 bitop3:0xca
    v_add_lshl_u32 v11, v11, s40, 17
    v_lshlrev_b16 v14, 8, v14
    v_lshrrev_b32 v13, 2, v68
    v_or_b32 v84, v12, v11
    v_bitop3_b32 v68, v5, v13, v14 bitop3:0xea
    ds_add_u32 v68, v2
    v_mul_hi_u32_u24 v14, 429497, v85
    v_lshrrev_b32 v12, 3, v69
    v_cos_f32 v8, v8
    v_lshlrev_b16 v13, 3, v69
    v_mad_i32_i24 v11, v14, s55, v85
    v_bitop3_b32 v12, v6, v13, v12 bitop3:0xca
    v_add_lshl_u32 v11, v11, s40, 17
    v_lshlrev_b16 v14, 8, v14
    v_lshrrev_b32 v13, 2, v69
    v_or_b32 v85, v12, v11
    v_bitop3_b32 v69, v5, v13, v14 bitop3:0xea
    ds_add_u32 v69, v2
    v_cvt_pk_bf16_f32 v72, v7, v8
    v_perm_b32 v12, v72, v72, s41
    v_bitop3_b32 v84, v4, v12, v84 bitop3:0xca
    v_perm_b32 v13, v72, v72, s42
    v_bitop3_b32 v85, v4, v13, v85 bitop3:0xca
    v_mul_hi_u32_u24 v14, 429497, v86
    v_lshrrev_b32 v12, 3, v70
    v_cos_f32 v9, v9
    v_lshlrev_b16 v13, 3, v70
    v_mad_i32_i24 v11, v14, s55, v86
    v_bitop3_b32 v12, v6, v13, v12 bitop3:0xca
    v_add_lshl_u32 v11, v11, s40, 17
    v_lshlrev_b16 v14, 8, v14
    v_lshrrev_b32 v13, 2, v70
    v_or_b32 v86, v12, v11
    v_bitop3_b32 v70, v5, v13, v14 bitop3:0xea
    ds_add_u32 v70, v2
    v_mul_hi_u32_u24 v14, 429497, v87
    v_lshrrev_b32 v12, 3, v71
    v_cos_f32 v10, v10
    v_lshlrev_b16 v13, 3, v71
    v_mad_i32_i24 v11, v14, s55, v87
    v_bitop3_b32 v12, v6, v13, v12 bitop3:0xca
    v_add_lshl_u32 v11, v11, s40, 17
    v_lshlrev_b16 v14, 8, v14
    v_lshrrev_b32 v13, 2, v71
    v_or_b32 v87, v12, v11
    v_bitop3_b32 v71, v5, v13, v14 bitop3:0xea
    ds_add_u32 v71, v2
    v_cvt_pk_bf16_f32 v73, v9, v10
    v_perm_b32 v12, v73, v73, s41
    v_bitop3_b32 v86, v4, v12, v86 bitop3:0xca
    v_perm_b32 v13, v73, v73, s42
    v_bitop3_b32 v87, v4, v13, v87 bitop3:0xca
    s_waitcnt vmcnt(12)
    s_cmp_le_u32 s43, 5
    s_cbranch_scc1 L1_s5
    v_lshlrev_b32 v7, 16, v74
    v_and_b32 v8, 0xffff0000, v74
    v_lshlrev_b32 v9, 16, v75
    v_and_b32 v10, 0xffff0000, v75
    v_mul_f32 v7, 0.15915494, v7
    v_mul_f32 v8, 0.15915494, v8
    v_mul_f32 v9, 0.15915494, v9
    v_mul_f32 v10, 0.15915494, v10
    v_mul_hi_u32_u24 v14, 429497, v36
    v_lshrrev_b32 v12, 3, v76
    v_cos_f32 v7, v7
    v_lshlrev_b16 v13, 3, v76
    v_mad_i32_i24 v11, v14, s55, v36
    v_bitop3_b32 v12, v6, v13, v12 bitop3:0xca
    v_add_lshl_u32 v11, v11, s40, 17
    v_lshlrev_b16 v14, 8, v14
    v_lshrrev_b32 v13, 2, v76
    v_or_b32 v36, v12, v11
    v_bitop3_b32 v76, v5, v13, v14 bitop3:0xea
    ds_add_u32 v76, v2
    v_mul_hi_u32_u24 v14, 429497, v37
    v_lshrrev_b32 v12, 3, v77
    v_cos_f32 v8, v8
    v_lshlrev_b16 v13, 3, v77
    v_mad_i32_i24 v11, v14, s55, v37
    v_bitop3_b32 v12, v6, v13, v12 bitop3:0xca
    v_add_lshl_u32 v11, v11, s40, 17
    v_lshlrev_b16 v14, 8, v14
    v_lshrrev_b32 v13, 2, v77
    v_or_b32 v37, v12, v11
    v_bitop3_b32 v77, v5, v13, v14 bitop3:0xea
    ds_add_u32 v77, v2
    v_cvt_pk_bf16_f32 v74, v7, v8
    v_perm_b32 v12, v74, v74, s41
    v_bitop3_b32 v36, v4, v12, v36 bitop3:0xca
    v_perm_b32 v13, v74, v74, s42
    v_bitop3_b32 v37, v4, v13, v37 bitop3:0xca
    v_mul_hi_u32_u24 v14, 429497, v38
    v_lshrrev_b32 v12, 3, v78
    v_cos_f32 v9, v9
    v_lshlrev_b16 v13, 3, v78
    v_mad_i32_i24 v11, v14, s55, v38
    v_bitop3_b32 v12, v6, v13, v12 bitop3:0xca
    v_add_lshl_u32 v11, v11, s40, 17
    v_lshlrev_b16 v14, 8, v14
    v_lshrrev_b32 v13, 2, v78
    v_or_b32 v38, v12, v11
    v_bitop3_b32 v78, v5, v13, v14 bitop3:0xea
    ds_add_u32 v78, v2
    v_mul_hi_u32_u24 v14, 429497, v39
    v_lshrrev_b32 v12, 3, v79
    v_cos_f32 v10, v10
    v_lshlrev_b16 v13, 3, v79
    v_mad_i32_i24 v11, v14, s55, v39
    v_bitop3_b32 v12, v6, v13, v12 bitop3:0xca
    v_add_lshl_u32 v11, v11, s40, 17
    v_lshlrev_b16 v14, 8, v14
    v_lshrrev_b32 v13, 2, v79
    v_or_b32 v39, v12, v11
    v_bitop3_b32 v79, v5, v13, v14 bitop3:0xea
    ds_add_u32 v79, v2
    v_cvt_pk_bf16_f32 v75, v9, v10
    v_perm_b32 v12, v75, v75, s41
    v_bitop3_b32 v38, v4, v12, v38 bitop3:0xca
    v_perm_b32 v13, v75, v75, s42
    v_bitop3_b32 v39, v4, v13, v39 bitop3:0xca
L1_s5:
    s_waitcnt vmcnt(8)
    s_cmp_le_u32 s43, 6
    s_cbranch_scc1 L1_s6
    v_lshlrev_b32 v7, 16, v64
    v_and_b32 v8, 0xffff0000, v64
    v_lshlrev_b32 v9, 16, v65
    v_and_b32 v10, 0xffff0000, v65
    v_mul_f32 v7, 0.15915494, v7
    v_mul_f32 v8, 0.15915494, v8
    v_mul_f32 v9, 0.15915494, v9
    v_mul_f32 v10, 0.15915494, v10
    v_mul_hi_u32_u24 v14, 429497, v80
    v_lshrrev_b32 v12, 3, v56
    v_cos_f32 v7, v7
    v_lshlrev_b16 v13, 3, v56
    v_mad_i32_i24 v11, v14, s55, v80
    v_bitop3_b32 v12, v6, v13, v12 bitop3:0xca
    v_add_lshl_u32 v11, v11, s40, 17
    v_lshlrev_b16 v14, 8, v14
    v_lshrrev_b32 v13, 2, v56
    v_or_b32 v80, v12, v11
    v_bitop3_b32 v56, v5, v13, v14 bitop3:0xea
    ds_add_u32 v56, v2
    v_mul_hi_u32_u24 v14, 429497, v81
    v_lshrrev_b32 v12, 3, v57
    v_cos_f32 v8, v8
    v_lshlrev_b16 v13, 3, v57
    v_mad_i32_i24 v11, v14, s55, v81
    v_bitop3_b32 v12, v6, v13, v12 bitop3:0xca
    v_add_lshl_u32 v11, v11, s40, 17
    v_lshlrev_b16 v14, 8, v14
    v_lshrrev_b32 v13, 2, v57
    v_or_b32 v81, v12, v11
    v_bitop3_b32 v57, v5, v13, v14 bitop3:0xea
    ds_add_u32 v57, v2
    v_cvt_pk_bf16_f32 v64, v7, v8
    v_perm_b32 v12, v64, v64, s41
    v_bitop3_b32 v80, v4, v12, v80 bitop3:0xca
    v_perm_b32 v13, v64, v64, s42
    v_bitop3_b32 v81, v4, v13, v81 bitop3:0xca
    v_mul_hi_u32_u24 v14, 429497, v82
    v_lshrrev_b32 v12, 3, v58
    v_cos_f32 v9, v9
    v_lshlrev_b16 v13, 3, v58
    v_mad_i32_i24 v11, v14, s55, v82
    v_bitop3_b32 v12, v6, v13, v12 bitop3:0xca
    v_add_lshl_u32 v11, v11, s40, 17
    v_lshlrev_b16 v14, 8, v14
    v_lshrrev_b32 v13, 2, v58
    v_or_b32 v82, v12, v11
    v_bitop3_b32 v58, v5, v13, v14 bitop3:0xea
    ds_add_u32 v58, v2
    v_mul_hi_u32_u24 v14, 429497, v83
    v_lshrrev_b32 v12, 3, v59
    v_cos_f32 v10, v10
    v_lshlrev_b16 v13, 3, v59
    v_mad_i32_i24 v11, v14, s55, v83
    v_bitop3_b32 v12, v6, v13, v12 bitop3:0xca
    v_add_lshl_u32 v11, v11, s40, 17
    v_lshlrev_b16 v14, 8, v14
    v_lshrrev_b32 v13, 2, v59
    v_or_b32 v83, v12, v11
    v_bitop3_b32 v59, v5, v13, v14 bitop3:0xea
    ds_add_u32 v59, v2
    v_cvt_pk_bf16_f32 v65, v9, v10
    v_perm_b32 v12, v65, v65, s41
    v_bitop3_b32 v82, v4, v12, v82 bitop3:0xca
    v_perm_b32 v13, v65, v65, s42
    v_bitop3_b32 v83, v4, v13, v83 bitop3:0xca
L1_s6:
    s_waitcnt vmcnt(4)
    s_cmp_le_u32 s43, 7
    s_cbranch_scc1 L1_s7
    v_lshlrev_b32 v7, 16, v66
    v_and_b32 v8, 0xffff0000, v66
    v_lshlrev_b32 v9, 16, v67
    v_and_b32 v10, 0xffff0000, v67
    v_mul_f32 v7, 0.15915494, v7
    v_mul_f32 v8, 0.15915494, v8
    v_mul_f32 v9, 0.15915494, v9
    v_mul_f32 v10, 0.15915494, v10
    v_mul_hi_u32_u24 v14, 429497, v96
    v_lshrrev_b32 v12, 3, v60
    v_cos_f32 v7, v7
    v_lshlrev_b16 v13, 3, v60
    v_mad_i32_i24 v11, v14, s55, v96
    v_bitop3_b32 v12, v6, v13, v12 bitop3:0xca
    v_add_lshl_u32 v11, v11, s40, 17
    v_lshlrev_b16 v14, 8, v14
    v_lshrrev_b32 v13, 2, v60
    v_or_b32 v96, v12, v11
    v_bitop3_b32 v60, v5, v13, v14 bitop3:0xea
    ds_add_u32 v60, v2
    v_mul_hi_u32_u24 v14, 429497, v97
    v_lshrrev_b32 v12, 3, v61
    v_cos_f32 v8, v8
    v_lshlrev_b16 v13, 3, v61
    v_mad_i32_i24 v11, v14, s55, v97
    v_bitop3_b32 v12, v6, v13, v12 bitop3:0xca
    v_add_lshl_u32 v11, v11, s40, 17
    v_lshlrev_b16 v14, 8, v14
    v_lshrrev_b32 v13, 2, v61
    v_or_b32 v97, v12, v11
    v_bitop3_b32 v61, v5, v13, v14 bitop3:0xea
    ds_add_u32 v61, v2
    v_cvt_pk_bf16_f32 v66, v7, v8
    v_perm_b32 v12, v66, v66, s41
    v_bitop3_b32 v96, v4, v12, v96 bitop3:0xca
    v_perm_b32 v13, v66, v66, s42
    v_bitop3_b32 v97, v4, v13, v97 bitop3:0xca
    v_mul_hi_u32_u24 v14, 429497, v98
    v_lshrrev_b32 v12, 3, v62
    v_cos_f32 v9, v9
    v_lshlrev_b16 v13, 3, v62
    v_mad_i32_i24 v11, v14, s55, v98
    v_bitop3_b32 v12, v6, v13, v12 bitop3:0xca
    v_add_lshl_u32 v11, v11, s40, 17
    v_lshlrev_b16 v14, 8, v14
    v_lshrrev_b32 v13, 2, v62
    v_or_b32 v98, v12, v11
    v_bitop3_b32 v62, v5, v13, v14 bitop3:0xea
    ds_add_u32 v62, v2
    v_mul_hi_u32_u24 v14, 429497, v99
    v_lshrrev_b32 v12, 3, v63
    v_cos_f32 v10, v10
    v_lshlrev_b16 v13, 3, v63
    v_mad_i32_i24 v11, v14, s55, v99
    v_bitop3_b32 v12, v6, v13, v12 bitop3:0xca
    v_add_lshl_u32 v11, v11, s40, 17
    v_lshlrev_b16 v14, 8, v14
    v_lshrrev_b32 v13, 2, v63
    v_or_b32 v99, v12, v11
    v_bitop3_b32 v63, v5, v13, v14 bitop3:0xea
    ds_add_u32 v63, v2
    v_cvt_pk_bf16_f32 v67, v9, v10
    v_perm_b32 v12, v67, v67, s41
    v_bitop3_b32 v98, v4, v12, v98 bitop3:0xca
    v_perm_b32 v13, v67, v67, s42
    v_bitop3_b32 v99, v4, v13, v99 bitop3:0xca
L1_s7:
    v_lshrrev_b32 v8, 2, v0
    v_and_b32 v7, 0x3c00, v0
    v_bitop3_b32 v7, v5, v8, v7 bitop3:0xea
    s_waitcnt lgkmcnt(0)
    s_barrier
    ds_read2st64_b32 v[8:9], v7 offset0:0 offset1:1
    ds_read2st64_b32 v[10:11], v7 offset0:2 offset1:3
    s_add_u32 s46, s35, 0x7ed0000
    buffer_store_dwordx4 v[28:31], v0, s[20:23], s46 offen sc1
    s_waitcnt lgkmcnt(0)
    v_lshl_or_b32 v12, v9, 16, v8
    v_lshl_or_b32 v13, v11, 16, v10
    v_mov_b32 v14, v12
    v_mov_b32 v15, v13
    s_nop 0
    v_add_u32_dpp v14, v14, v14 row_shr:1 row_mask:0xf bank_mask:0xf bound_ctrl:1
    v_add_u32_dpp v15, v15, v15 row_shr:1 row_mask:0xf bank_mask:0xf bound_ctrl:1
    s_nop 0
    v_add_u32_dpp v14, v14, v14 row_shr:2 row_mask:0xf bank_mask:0xf bound_ctrl:1
    v_add_u32_dpp v15, v15, v15 row_shr:2 row_mask:0xf bank_mask:0xf bound_ctrl:1
    s_nop 0
    v_add_u32_dpp v14, v14, v14 row_shr:4 row_mask:0xf bank_mask:0xf bound_ctrl:1
    v_add_u32_dpp v15, v15, v15 row_shr:4 row_mask:0xf bank_mask:0xf bound_ctrl:1
    s_nop 0
    v_add_u32_dpp v14, v14, v14 row_shr:8 row_mask:0xf bank_mask:0xf bound_ctrl:1
    v_add_u32_dpp v15, v15, v15 row_shr:8 row_mask:0xf bank_mask:0xf bound_ctrl:1
    s_nop 0
    v_add_u32_dpp v14, v14, v14 row_bcast:15 row_mask:0xa bank_mask:0xf
    v_add_u32_dpp v15, v15, v15 row_bcast:15 row_mask:0xa bank_mask:0xf
    s_nop 0
    v_add_u32_dpp v14, v14, v14 row_bcast:31 row_mask:0xc bank_mask:0xf
    v_add_u32_dpp v15, v15, v15 row_bcast:31 row_mask:0xc bank_mask:0xf
    v_readlane_b32 s48, v14, 63
    v_readlane_b32 s49, v15, 63
    s_lshl_b32 s54, s32, 2
    v_mov_b32 v8, s54
    s_and_b32 s50, s48, 0xffff
    s_lshr_b32 s51, s48, 16
    s_and_b32 s52, s49, 0xffff
    s_lshr_b32 s53, s49, 16
    s_add_u32 s51, s51, s50
    s_add_u32 s52, s52, s51
    s_add_u32 s53, s53, s52
    v_mov_b32 v9, s53
    s_mov_b64 exec, 1
    ds_write_b32 v8, v9 offset:16384
    s_mov_b64 exec, -1
    v_and_b32 v8, 60, v7
    s_waitcnt lgkmcnt(0)
    s_barrier
    ds_read_b32 v9, v8 offset:16384
    s_waitcnt lgkmcnt(0)
    v_add_u32_dpp v9, v9, v9 row_shr:1 row_mask:0xf bank_mask:0xf bound_ctrl:1
    s_nop 1
    v_add_u32_dpp v9, v9, v9 row_shr:2 row_mask:0xf bank_mask:0xf bound_ctrl:1
    s_nop 1
    v_add_u32_dpp v9, v9, v9 row_shr:4 row_mask:0xf bank_mask:0xf bound_ctrl:1
    s_nop 1
    v_add_u32_dpp v9, v9, v9 row_shr:8 row_mask:0xf bank_mask:0xf bound_ctrl:1
    s_nop 0
    v_readlane_b32 s54, v9, s32
    s_sub_u32 s54, s54, s53
    s_add_u32 s50, s50, s54
    s_add_u32 s51, s51, s54
    s_add_u32 s52, s52, s54
    s_pack_ll_b32_b16 s48, s54, s50
    s_pack_ll_b32_b16 s49, s51, s52
    v_add_u32 v14, s48, v14
    v_add_u32 v15, s49, v15
    v_sub_u32 v12, v14, v12
    v_sub_u32 v13, v15, v13
    v_and_b32 v8, 0xffff, v12
    v_lshrrev_b32 v9, 16, v12
    v_and_b32 v10, 0xffff, v13
    v_lshrrev_b32 v11, 16, v13
    ds_write2st64_b32 v7, v8, v9 offset0:0 offset1:1
    ds_write2st64_b32 v7, v10, v11 offset0:2 offset1:3
    s_waitcnt lgkmcnt(0)
    s_barrier
    ds_add_rtn_u32 v120, v120, v2
    ds_add_rtn_u32 v121, v121, v2
    ds_add_rtn_u32 v122, v122, v2
    ds_add_rtn_u32 v123, v123, v2
    s_add_u32 s47, s36, 0xa900000
    v_and_b32 v11, 0x3f0, v0
    v_add_u32 v11, v11, v11
    buffer_store_dwordx2 v[12:13], v11, s[24:27], s47 offen
    s_bitset0_b64 exec, 63
    s_not_b64 exec, exec
    buffer_store_dwordx2 v[14:15], v11, s[24:27], s47 offen offset:32
    s_mov_b64 exec, -1
    v_cmp_le_u32 vcc, s37, v0
    v_add_u32 v10, 8320, v0
    s_cmp_lg_u32 s32, 0
    v_cndmask_b32 v10, v0, v10, vcc
    s_cbranch_scc1 L1_p8
    s_add_u32 s44, s35, 0xa900000
    s_mov_b64 exec, 0xff
    buffer_store_dwordx4 v[12:15], v10, s[24:27], s44 offen
    s_mov_b64 exec, -1
L1_p8:
    ds_add_rtn_u32 v124, v124, v2
    ds_add_rtn_u32 v125, v125, v2
    ds_add_rtn_u32 v126, v126, v2
    ds_add_rtn_u32 v127, v127, v2
    ds_add_rtn_u32 v24, v24, v2
    ds_add_rtn_u32 v25, v25, v2
    ds_add_rtn_u32 v26, v26, v2
    ds_add_rtn_u32 v27, v27, v2
    s_add_u32 s45, s35, 0x7ed4000
    buffer_store_dwordx4 v[112:115], v0, s[20:23], s45 offen sc1
    ds_add_rtn_u32 v52, v52, v2
    ds_add_rtn_u32 v53, v53, v2
    ds_add_rtn_u32 v54, v54, v2
    ds_add_rtn_u32 v55, v55, v2
    ds_add_rtn_u32 v68, v68, v2
    ds_add_rtn_u32 v69, v69, v2
    ds_add_rtn_u32 v70, v70, v2
    ds_add_rtn_u32 v71, v71, v2
    s_cmp_le_u32 s43, 5
    s_cbranch_scc1 L1_s9
    ds_add_rtn_u32 v76, v76, v2
    ds_add_rtn_u32 v77, v77, v2
    ds_add_rtn_u32 v78, v78, v2
    ds_add_rtn_u32 v79, v79, v2
L1_s9:
    s_add_u32 s46, s35, 0x7ed8000
    buffer_store_dwordx4 v[88:91], v0, s[20:23], s46 offen sc1
    s_cmp_le_u32 s43, 6
    s_cbranch_scc1 L1_s10
    ds_add_rtn_u32 v56, v56, v2
    ds_add_rtn_u32 v57, v57, v2
    ds_add_rtn_u32 v58, v58, v2
    ds_add_rtn_u32 v59, v59, v2
L1_s10:
    s_cmp_le_u32 s43, 7
    s_cbranch_scc1 L1_s11
    ds_add_rtn_u32 v60, v60, v2
    ds_add_rtn_u32 v61, v61, v2
    ds_add_rtn_u32 v62, v62, v2
    ds_add_rtn_u32 v63, v63, v2
L1_s11:
    s_waitcnt lgkmcnt(0)
    s_barrier
    v_and_b32 v7, -4, v120
    v_lshl_add_u32 v8, v120, 2, v7
    ds_write_b32 v8, v16
    v_lshl_add_u32 v7, v7, 2, v120
    ds_write_b8 v7, v44 offset:16
    v_and_b32 v9, -4, v121
    v_lshl_add_u32 v10, v121, 2, v9
    ds_write_b32 v10, v17
    v_lshl_add_u32 v9, v9, 2, v121
    ds_write_b8_d16_hi v9, v44 offset:16
    v_and_b32 v7, -4, v122
    v_lshl_add_u32 v8, v122, 2, v7
    ds_write_b32 v8, v18
    v_lshl_add_u32 v7, v7, 2, v122
    ds_write_b8 v7, v45 offset:16
    v_and_b32 v9, -4, v123
    v_lshl_add_u32 v10, v123, 2, v9
    ds_write_b32 v10, v19
    v_lshl_add_u32 v9, v9, 2, v123
    ds_write_b8_d16_hi v9, v45 offset:16
    s_add_u32 s47, s35, 0x7edc000
    buffer_store_dwordx4 v[116:119], v0, s[20:23], s47 offen sc1
    v_and_b32 v7, -4, v124
    v_lshl_add_u32 v8, v124, 2, v7
    ds_write_b32 v8, v20
    v_lshl_add_u32 v7, v7, 2, v124
    ds_write_b8 v7, v46 offset:16
    v_and_b32 v9, -4, v125
    v_lshl_add_u32 v10, v125, 2, v9
    ds_write_b32 v10, v21
    v_lshl_add_u32 v9, v9, 2, v125
    ds_write_b8_d16_hi v9, v46 offset:16
    v_and_b32 v7, -4, v126
    v_lshl_add_u32 v8, v126, 2, v7
    ds_write_b32 v8, v22
    v_lshl_add_u32 v7, v7, 2, v126
    ds_write_b8 v7, v47 offset:16
    v_and_b32 v9, -4, v127
    v_lshl_add_u32 v10, v127, 2, v9
    ds_write_b32 v10, v23
    v_lshl_add_u32 v9, v9, 2, v127
    ds_write_b8_d16_hi v9, v47 offset:16
    v_and_b32 v7, -4, v24
    v_lshl_add_u32 v8, v24, 2, v7
    ds_write_b32 v8, v40
    v_lshl_add_u32 v7, v7, 2, v24
    ds_write_b8 v7, v32 offset:16
    v_and_b32 v9, -4, v25
    v_lshl_add_u32 v10, v25, 2, v9
    ds_write_b32 v10, v41
    v_lshl_add_u32 v9, v9, 2, v25
    ds_write_b8_d16_hi v9, v32 offset:16
    v_and_b32 v7, -4, v26
    v_lshl_add_u32 v8, v26, 2, v7
    ds_write_b32 v8, v42
    v_lshl_add_u32 v7, v7, 2, v26
    ds_write_b8 v7, v33 offset:16
    v_and_b32 v9, -4, v27
    v_lshl_add_u32 v10, v27, 2, v9
    ds_write_b32 v10, v43
    v_lshl_add_u32 v9, v9, 2, v27
    ds_write_b8_d16_hi v9, v33 offset:16
    s_add_u32 s44, s35, 0x7ee0000
    buffer_store_dwordx4 v[92:95], v0, s[20:23], s44 offen sc1
    v_and_b32 v7, -4, v52
    v_lshl_add_u32 v8, v52, 2, v7
    ds_write_b32 v8, v48
    v_lshl_add_u32 v7, v7, 2, v52
    ds_write_b8 v7, v34 offset:16
    v_and_b32 v9, -4, v53
    v_lshl_add_u32 v10, v53, 2, v9
    ds_write_b32 v10, v49
    v_lshl_add_u32 v9, v9, 2, v53
    ds_write_b8_d16_hi v9, v34 offset:16
    v_and_b32 v7, -4, v54
    v_lshl_add_u32 v8, v54, 2, v7
    ds_write_b32 v8, v50
    v_lshl_add_u32 v7, v7, 2, v54
    ds_write_b8 v7, v35 offset:16
    v_and_b32 v9, -4, v55
    v_lshl_add_u32 v10, v55, 2, v9
    ds_write_b32 v10, v51
    v_lshl_add_u32 v9, v9, 2, v55
    ds_write_b8_d16_hi v9, v35 offset:16
    v_and_b32 v7, -4, v68
    v_lshl_add_u32 v8, v68, 2, v7
    ds_write_b32 v8, v84
    v_lshl_add_u32 v7, v7, 2, v68
    ds_write_b8 v7, v72 offset:16
    v_and_b32 v9, -4, v69
    v_lshl_add_u32 v10, v69, 2, v9
    ds_write_b32 v10, v85
    v_lshl_add_u32 v9, v9, 2, v69
    ds_write_b8_d16_hi v9, v72 offset:16
    v_and_b32 v7, -4, v70
    v_lshl_add_u32 v8, v70, 2, v7
    ds_write_b32 v8, v86
    v_lshl_add_u32 v7, v7, 2, v70
    ds_write_b8 v7, v73 offset:16
    v_and_b32 v9, -4, v71
    v_lshl_add_u32 v10, v71, 2, v9
    ds_write_b32 v10, v87
    v_lshl_add_u32 v9, v9, 2, v71
    ds_write_b8_d16_hi v9, v73 offset:16
    s_cmp_le_u32 s43, 5
    s_cbranch_scc1 L1_s12
    v_and_b32 v7, -4, v76
    v_lshl_add_u32 v8, v76, 2, v7
    ds_write_b32 v8, v36
    v_lshl_add_u32 v7, v7, 2, v76
    ds_write_b8 v7, v74 offset:16
    v_and_b32 v9, -4, v77
    v_lshl_add_u32 v10, v77, 2, v9
    ds_write_b32 v10, v37
    v_lshl_add_u32 v9, v9, 2, v77
    ds_write_b8_d16_hi v9, v74 offset:16
    v_and_b32 v7, -4, v78
    v_lshl_add_u32 v8, v78, 2, v7
    ds_write_b32 v8, v38
    v_lshl_add_u32 v7, v7, 2, v78
    ds_write_b8 v7, v75 offset:16
    v_and_b32 v9, -4, v79
    v_lshl_add_u32 v10, v79, 2, v9
    ds_write_b32 v10, v39
    v_lshl_add_u32 v9, v9, 2, v79
    ds_write_b8_d16_hi v9, v75 offset:16
L1_s12:
    s_add_u32 s45, s35, 0x7ee4000
    buffer_store_dwordx4 v[104:107], v0, s[20:23], s45 offen sc1
    s_cmp_le_u32 s43, 6
    s_cbranch_scc1 L1_s13
    v_and_b32 v7, -4, v56
    v_lshl_add_u32 v8, v56, 2, v7
    ds_write_b32 v8, v80
    v_lshl_add_u32 v7, v7, 2, v56
    ds_write_b8 v7, v64 offset:16
    v_and_b32 v9, -4, v57
    v_lshl_add_u32 v10, v57, 2, v9
    ds_write_b32 v10, v81
    v_lshl_add_u32 v9, v9, 2, v57
    ds_write_b8_d16_hi v9, v64 offset:16
    v_and_b32 v7, -4, v58
    v_lshl_add_u32 v8, v58, 2, v7
    ds_write_b32 v8, v82
    v_lshl_add_u32 v7, v7, 2, v58
    ds_write_b8 v7, v65 offset:16
    v_and_b32 v9, -4, v59
    v_lshl_add_u32 v10, v59, 2, v9
    ds_write_b32 v10, v83
    v_lshl_add_u32 v9, v9, 2, v59
    ds_write_b8_d16_hi v9, v65 offset:16
L1_s13:
    s_cmp_le_u32 s43, 7
    s_cbranch_scc1 L1_s14
    v_and_b32 v7, -4, v60
    v_lshl_add_u32 v8, v60, 2, v7
    ds_write_b32 v8, v96
    v_lshl_add_u32 v7, v7, 2, v60
    ds_write_b8 v7, v66 offset:16
    v_and_b32 v9, -4, v61
    v_lshl_add_u32 v10, v61, 2, v9
    ds_write_b32 v10, v97
    v_lshl_add_u32 v9, v9, 2, v61
    ds_write_b8_d16_hi v9, v66 offset:16
    v_and_b32 v7, -4, v62
    v_lshl_add_u32 v8, v62, 2, v7
    ds_write_b32 v8, v98
    v_lshl_add_u32 v7, v7, 2, v62
    ds_write_b8 v7, v67 offset:16
    v_and_b32 v9, -4, v63
    v_lshl_add_u32 v10, v63, 2, v9
    ds_write_b32 v10, v99
    v_lshl_add_u32 v9, v9, 2, v63
    ds_write_b8_d16_hi v9, v67 offset:16
L1_s14:
    v_add_u32 v7, 0x10000, v0
    v_add_u32 v12, 0x20000, v0
    s_waitcnt lgkmcnt(0)
    s_barrier
    ds_read_b128 v[100:103], v0 offset:0
    ds_read_b128 v[28:31], v0 offset:16384
    ds_read_b128 v[112:115], v0 offset:32768
    ds_read_b128 v[88:91], v0 offset:49152
    ds_read_b128 v[16:19], v7 offset:0
    ds_read_b128 v[120:123], v7 offset:16384
    ds_read_b128 v[116:119], v7 offset:32768
    ds_read_b128 v[20:23], v7 offset:49152
    ds_read_b128 v[124:127], v12 offset:0
    ds_read_b128 v[44:47], v12 offset:16384
    s_waitcnt lgkmcnt(9)
    s_add_u32 s46, s35, 0xa900000
    buffer_store_dwordx4 v[100:103], v0, s[20:23], s46 offen sc1
    s_waitcnt lgkmcnt(8)
    s_add_u32 s47, s35, 0xa904000
    buffer_store_dwordx4 v[28:31], v0, s[20:23], s47 offen sc1
    s_waitcnt lgkmcnt(7)
    s_add_u32 s44, s35, 0xa908000
    buffer_store_dwordx4 v[112:115], v0, s[20:23], s44 offen sc1
    s_waitcnt lgkmcnt(6)
    s_add_u32 s45, s35, 0xa90c000
    buffer_store_dwordx4 v[88:91], v0, s[20:23], s45 offen sc1
    s_waitcnt lgkmcnt(5)
    s_add_u32 s46, s35, 0xa910000
    buffer_store_dwordx4 v[16:19], v0, s[20:23], s46 offen sc1
    s_waitcnt lgkmcnt(4)
    s_add_u32 s47, s35, 0xa914000
    buffer_store_dwordx4 v[120:123], v0, s[20:23], s47 offen sc1
    s_waitcnt lgkmcnt(3)
    s_add_u32 s44, s35, 0xa918000
    buffer_store_dwordx4 v[116:119], v0, s[20:23], s44 offen sc1
    s_cmp_le_u32 s43, 5
    s_cbranch_scc1 L1_fin
    s_waitcnt lgkmcnt(2)
    s_add_u32 s45, s35, 0xa91c000
    buffer_store_dwordx4 v[20:23], v0, s[20:23], s45 offen sc1
    s_cmp_le_u32 s43, 6
    s_cbranch_scc1 L1_fin
    s_waitcnt lgkmcnt(1)
    s_add_u32 s46, s35, 0xa920000
    buffer_store_dwordx4 v[124:127], v0, s[20:23], s46 offen sc1
    s_cmp_le_u32 s43, 7
    s_cbranch_scc1 L1_fin
    s_waitcnt lgkmcnt(0)
    s_add_u32 s47, s35, 0xa924000
    buffer_store_dwordx4 v[44:47], v0, s[20:23], s47 offen sc1
L1_fin:
L1_end:
    s_endpgm
.text
.globl gs_acc_kernel
.p2align 8
.type gs_acc_kernel,@function
gs_acc_kernel:
    s_cmp_ge_u32 s2, 256
    s_cbranch_scc1 L2_end
    s_load_dwordx2 s[30:31], s[0:1], 104
    s_load_dwordx2 s[28:29], s[0:1], 0
    s_load_dwordx2 s[6:7], s[0:1], 40
    v_lshrrev_b32 v16, 6, v0
    v_and_b32 v17, 63, v0
    v_readfirstlane_b32 s32, v16
    s_bfe_u32 s33, s2, 0x20001
    s_and_b32 s34, s2, 1
    s_lshl_b32 s34, s34, 5
    s_lshr_b32 s4, s2, 3
    s_add_u32 s34, s34, s4
    v_and_b32 v22, 3, v0
    v_mul_u32_u24 v19, 80, v16
    v_add_u32 v18, v17, v19
    v_mul_u32_u24 v2, 173056, v18
    v_lshrrev_b32 v18, 2, v17
    v_add3_u32 v18, v18, v19, 64
    v_mul_u32_u24 v4, 173056, v18
    v_lshl_add_u32 v20, v22, 4, v4
    v_and_b32 v18, 3, v18
    v_lshl_add_u32 v20, v18, 5, v20
    v_lshl_add_u32 v25, v22, 5, v2
    s_mul_i32 s39, s33, 2080
    s_lshl_b32 s3, s34, 5
    s_add_u32 s39, s39, s3
    s_mul_i32 s40, s33, 1280000
    s_mul_i32 s38, s32, 5120
    s_add_u32 s38, s38, 80000
    v_lshl_add_u32 v3, v17, 4, s38
    s_waitcnt lgkmcnt(0)
    s_add_u32 s12, s30, 0x28000
    s_addc_u32 s13, s31, 0
    s_mov_b32 s14, 0xd318000
    s_mov_b32 s15, 0x20000
    buffer_load_dwordx4 v[48:51], v25, s[12:15], s39 offen offset:0
    buffer_load_dwordx4 v[56:59], v25, s[12:15], s39 offen offset:32
    buffer_load_dwordx4 v[52:55], v25, s[12:15], s39 offen offset:16
    buffer_load_dwordx4 v[60:63], v25, s[12:15], s39 offen offset:48
    buffer_load_dwordx4 v[64:67], v20, s[12:15], s39 offen
    s_mov_b32 s16, s28
    s_mov_b32 s17, s29
    s_mov_b32 s18, 0x4f5880
    s_mov_b32 s19, 0x20000
    s_sub_u32 s16, s16, 80000
    s_subb_u32 s17, s17, 0
    s_add_u32 s24, s30, 0xebab000
    s_addc_u32 s25, s31, 0
    s_mov_b32 s26, 0x100
    s_mov_b32 s27, 0x20000
    v_lshlrev_b32 v21, 6, v22
    buffer_load_dwordx2 v[8:9], v21, s[24:27], 0 offen offset:40
    s_add_u32 s3, s40, 4096
    buffer_load_dwordx4 v[124:127], v3, s[16:19], s3 offen
    buffer_load_dwordx4 v[116:119], v3, s[16:19], s40 offen offset:2048
    buffer_load_dwordx4 v[120:123], v3, s[16:19], s40 offen offset:3072
    buffer_load_dwordx4 v[108:111], v3, s[16:19], s40 offen offset:0
    buffer_load_dwordx4 v[112:115], v3, s[16:19], s40 offen offset:1024
    s_add_u32 s40, s40, 0x4e200
    v_mad_u32_u24 v4, v22, 20, v4
    v_or_b32 v4, 0xf0000000, v4
    v_or_b32 v2, 0xf0000000, v2
    v_lshlrev_b32 v23, 2, v22
    v_sub_u32 v1, 28, v23
    v_and_b32 v18, 3, v0
    v_lshlrev_b32 v18, 4, v18
    v_mov_b32 v10, 0x3f80
    v_mov_b32 v11, 0
    v_lshlrev_b64 v[10:11], v18, v[10:11]
    v_and_b32 v18, 3, v0
    v_lshlrev_b32 v18, 4, v18
    v_mov_b32 v12, 0xbf80
    v_mov_b32 v13, 0
    v_lshlrev_b64 v[12:13], v18, v[12:13]
    v_lshlrev_b32 v24, 4, v0
    v_lshl_add_u32 v0, v17, 2, s38
    v_mov_b32 v45, 0xf0000000
    v_mov_b32 v5, 0x1fff8
    v_mov_b32 v6, 0x07ff0000
    s_mov_b32 s44, 0x4000c0c
    s_mov_b32 s45, 0x4010c0c
    s_mov_b32 s46, 0x4020c0c
    s_mov_b32 s47, 0x4030c0c
    s_mov_b32 s36, 0
    s_mov_b32 s42, 0
    s_mov_b64 s[80:81], 0
    s_mov_b64 s[84:85], 0
    s_mov_b64 s[48:49], 0
    s_load_dwordx4 s[96:99], s[6:7], 0
    s_load_dwordx2 s[4:5], s[0:1], 24
    s_waitcnt lgkmcnt(0)
    s_mov_b32 s8, s30
    s_mov_b32 s9, s31
    s_mov_b32 s10, 0xd340000
    s_mov_b32 s11, 0x20000
    s_add_u32 s20, s30, 0xd823000
    s_addc_u32 s21, s31, 0
    s_mov_b32 s22, 0x13880
    s_mov_b32 s23, 0x20000
    s_lshl_b32 s3, s33, 6
    s_add_u32 s3, s3, s34
    s_mul_i32 s3, s3, 80000
    s_add_u32 s20, s20, s3
    s_addc_u32 s21, s21, 0
    v_mov_b32 v68, 0
    v_mov_b32 v69, 0
    v_mov_b32 v70, 0
    v_mov_b32 v71, 0
    v_mov_b32 v72, 0
    v_mov_b32 v73, 0
    v_mov_b32 v74, 0
    v_mov_b32 v75, 0
    ds_write_b128 v24, v[68:71] offset:0
    ds_write_b128 v24, v[68:71] offset:16384
    ds_write_b128 v24, v[68:71] offset:32768
    ds_write_b128 v24, v[68:71] offset:49152
    v_add_u32 v47, 0x10000, v24
    v_cmp_gt_u32 vcc, 80000, v47
    s_mov_b64 exec, vcc
    ds_write_b128 v47, v[68:71]
    s_mov_b64 exec, -1
    s_waitcnt vmcnt(5)
    v_sub_u16 v88, v56, v48
    v_and_b32 v89, 3, v48
    v_add3_u32 v99, v88, v89, 3
    v_and_b32 v99, -4, v99
    v_max_u32 v99, 4, v99
    v_and_b32 v97, 0xfffc, v48
    v_bfm_b32 v96, v88, v89
    v_add_u32_dpp v91, v99, v99 row_shr:1 row_mask:0xf bank_mask:0xf bound_ctrl:1
    v_mad_u32_u24 v97, v97, 5, v2
    v_cmp_lt_u32 vcc, 16, v99
    v_add_u32_dpp v91, v91, v91 row_shr:2 row_mask:0xf bank_mask:0xf bound_ctrl:1
    v_sub_u32 v98, s38, v99
    v_lshrrev_b64 v[48:49], 16, v[48:49]
    v_add_u32_dpp v91, v91, v91 row_shr:4 row_mask:0xf bank_mask:0xf bound_ctrl:1
    v_lshrrev_b64 v[56:57], 16, v[56:57]
    s_mov_b32 s43, 0
    v_add_u32_dpp v91, v91, v91 row_shr:8 row_mask:0xf bank_mask:0xf bound_ctrl:1
    s_nop 1
    v_add_u32_dpp v91, v91, v91 row_bcast:15 row_mask:0xa bank_mask:0xf
    s_nop 1
    v_add_u32_dpp v91, v91, v91 row_bcast:31 row_mask:0xc bank_mask:0xf
    v_add_u32 v98, v98, v91
    v_readlane_b32 s37, v91, 63
    s_cbranch_vccnz L2_xo1
L2_xp1:
    v_mov_b32 v44, v43
    s_cmp_gt_u32 s37, 1024
    s_cbranch_scc1 L2_xs2
    s_cmp_lg_u32 s43, 0
    s_cbranch_scc1 L2_xa2
L2_xb2:
    v_lshlrev_b32 v89, 16, v96
    v_add_u32 v90, 60, v97
    v_bitop3_b32 v90, v89, v45, v90 bitop3:0x6a
    ds_write_b32 v98, v90 offset:12
    v_lshlrev_b32 v89, 20, v96
    v_add_u32 v90, 40, v97
    v_bitop3_b32 v90, v89, v45, v90 bitop3:0x6a
    ds_write_b32 v98, v90 offset:8
    v_lshlrev_b32 v89, 24, v96
    v_add_u32 v90, 20, v97
    v_bitop3_b32 v90, v89, v45, v90 bitop3:0x6a
    ds_write_b32 v98, v90 offset:4
    v_lshlrev_b32 v89, 28, v96
    v_bitop3_b32 v90, v89, v45, v97 bitop3:0x6a
    ds_write_b32 v98, v90 offset:0
    v_mov_b32_dpp v91, v64 quad_perm:[0,0,0,0] row_mask:0xf bank_mask:0xf
    v_and_b32 v89, 3, v91
    v_and_b32 v97, 0xfffc, v91
    v_sub_u16_dpp v88, v64, v91 quad_perm:[2,2,2,2] row_mask:0xf bank_mask:0xf
    v_mad_u32_u24 v97, v97, 5, v4
    v_add_u32 v99, v88, v89
    v_bfm_b32 v96, v88, v89
    v_cmp_lt_u32 s[58:59], 16, v99
    v_lshlrev_b32 v89, v1, v96
    v_and_b32 v89, v45, v89
    v_cmp_ne_u32 vcc, 0, v89
    v_xor_b32 v90, v97, v89
    s_add_u32 s3, s37, s38
    v_mbcnt_lo_u32_b32 v98, vcc_lo, 0
    v_mbcnt_hi_u32_b32 v98, vcc_hi, v98
    s_bcnt1_i32_b64 s41, vcc
    v_lshl_add_u32 v98, v98, 2, s3
    s_mov_b64 exec, vcc
    ds_write_b32 v98, v90
    s_mov_b64 exec, -1
    s_lshl2_add_u32 s37, s41, s37
    s_cmp_lg_u64 s[58:59], 0
    s_cbranch_scc1 L2_xe2
L2_xr2:
    v_add_u32 v98, s37, v0
    v_mov_b32 v90, -1
    ds_write_b32 v98, v90
    ds_read2st64_b32 v[40:41], v0 offset0:0 offset1:1
    ds_read2st64_b32 v[42:43], v0 offset0:2 offset1:3
    s_sub_u32 s3, s37, 768
    s_cmp_gt_u32 s3, 256
    s_cbranch_scc1 L2_xf2
L2_xg2:
    v_sub_u16 v88, v58, v50
    v_and_b32 v89, 3, v50
    v_add3_u32 v99, v88, v89, 3
    v_and_b32 v99, -4, v99
    v_max_u32 v99, 4, v99
    v_and_b32 v97, 0xfffc, v50
    v_bfm_b32 v96, v88, v89
    v_add_u32_dpp v91, v99, v99 row_shr:1 row_mask:0xf bank_mask:0xf bound_ctrl:1
    v_mad_u32_u24 v97, v97, 5, v2
    v_cmp_lt_u32 vcc, 16, v99
    v_add_u32_dpp v91, v91, v91 row_shr:2 row_mask:0xf bank_mask:0xf bound_ctrl:1
    v_sub_u32 v98, s38, v99
    v_lshrrev_b64 v[50:51], 16, v[50:51]
    v_add_u32_dpp v91, v91, v91 row_shr:4 row_mask:0xf bank_mask:0xf bound_ctrl:1
    v_lshrrev_b64 v[58:59], 16, v[58:59]
    s_mov_b32 s43, 0
    v_add_u32_dpp v91, v91, v91 row_shr:8 row_mask:0xf bank_mask:0xf bound_ctrl:1
    s_nop 1
    v_add_u32_dpp v91, v91, v91 row_bcast:15 row_mask:0xa bank_mask:0xf
    s_nop 1
    v_add_u32_dpp v91, v91, v91 row_bcast:31 row_mask:0xc bank_mask:0xf
    v_add_u32 v98, v98, v91
    v_readlane_b32 s37, v91, 63
    s_cbranch_vccnz L2_xo3
L2_xp3:
    s_waitcnt lgkmcnt(0)
    v_mov_b32 v21, v40
    v_mov_b32 v27, v41
    v_mov_b32 v33, v42
    v_mov_b32 v39, v43
    v_and_b32 v47, 0x0fffffff, v21
    buffer_load_dwordx4 v[16:19], v47, s[8:11], 0 offen
    buffer_load_dwordx3 v[18:20], v47, s[8:11], 0 offen offset:8
    s_waitcnt vmcnt(6)
    ds_write_b128 v3, v[124:127] offset:4096
    s_waitcnt vmcnt(5)
    ds_write_b128 v3, v[116:119] offset:2048
    s_waitcnt vmcnt(4)
    ds_write_b128 v3, v[120:123] offset:3072
    v_mov_b32 v44, v43
    s_cmp_gt_u32 s37, 1024
    s_cbranch_scc1 L2_xs4
    s_cmp_lg_u32 s43, 0
    s_cbranch_scc1 L2_xa4
L2_xb4:
    v_lshlrev_b32 v89, 16, v96
    v_add_u32 v90, 60, v97
    v_bitop3_b32 v90, v89, v45, v90 bitop3:0x6a
    ds_write_b32 v98, v90 offset:12
    v_lshlrev_b32 v89, 20, v96
    v_add_u32 v90, 40, v97
    v_bitop3_b32 v90, v89, v45, v90 bitop3:0x6a
    ds_write_b32 v98, v90 offset:8
    v_lshlrev_b32 v89, 24, v96
    v_add_u32 v90, 20, v97
    v_bitop3_b32 v90, v89, v45, v90 bitop3:0x6a
    ds_write_b32 v98, v90 offset:4
    v_lshlrev_b32 v89, 28, v96
    v_bitop3_b32 v90, v89, v45, v97 bitop3:0x6a
    ds_write_b32 v98, v90 offset:0
    v_mov_b32_dpp v91, v66 quad_perm:[0,0,0,0] row_mask:0xf bank_mask:0xf
    v_and_b32 v89, 3, v91
    v_and_b32 v97, 0xfffc, v91
    v_sub_u16_dpp v88, v66, v91 quad_perm:[2,2,2,2] row_mask:0xf bank_mask:0xf
    v_mad_u32_u24 v97, v97, 5, v4
    v_add_u32 v99, v88, v89
    v_bfm_b32 v96, v88, v89
    v_cmp_lt_u32 s[58:59], 16, v99
    v_lshlrev_b32 v89, v1, v96
    v_and_b32 v89, v45, v89
    v_cmp_ne_u32 vcc, 0, v89
    v_xor_b32 v90, v97, v89
    s_add_u32 s3, s37, s38
    v_mbcnt_lo_u32_b32 v98, vcc_lo, 0
    v_mbcnt_hi_u32_b32 v98, vcc_hi, v98
    s_bcnt1_i32_b64 s41, vcc
    v_lshl_add_u32 v98, v98, 2, s3
    s_mov_b64 exec, vcc
    ds_write_b32 v98, v90
    s_mov_b64 exec, -1
    s_lshl2_add_u32 s37, s41, s37
    s_cmp_lg_u64 s[58:59], 0
    s_cbranch_scc1 L2_xe4
L2_xr4:
    v_add_u32 v98, s37, v0
    v_mov_b32 v90, -1
    ds_write_b32 v98, v90
    ds_read2st64_b32 v[40:41], v0 offset0:0 offset1:1
    ds_read2st64_b32 v[42:43], v0 offset0:2 offset1:3
    s_sub_u32 s3, s37, 768
    s_cmp_gt_u32 s3, 256
    s_cbranch_scc1 L2_xf4
L2_xg4:
    s_waitcnt vmcnt(3)
    ds_write_b128 v3, v[108:111] offset:0
    s_waitcnt vmcnt(2)
    ds_write_b128 v3, v[112:115] offset:1024
    s_waitcnt lgkmcnt(0)
    s_barrier
    s_bitcmp1_b32 s36, s42
    s_cbranch_scc1 L2_slow
L2_ret0:
    s_setprio 3
    v_and_b32 v47, 0x0fffffff, v27
    buffer_load_dwordx4 v[22:25], v47, s[8:11], 0 offen
    buffer_load_dwordx3 v[24:26], v47, s[8:11], 0 offen offset:8
    s_waitcnt vmcnt(2)
    v_and_b32 v46, 0x20000000, v21
    v_lshrrev_b32 v47, 14, v17
    v_bitop3_b32 v47, v47, v5, v46 bitop3:0xea
    ds_read_b64 v[102:103], v47 offset:63616
    v_bitop3_b32 v93, v17, v5, v46 bitop3:0xea
    v_and_b32 v46, 0x10000000, v21
    v_lshrrev_b32 v47, 14, v16
    v_bitop3_b32 v47, v47, v5, v46 bitop3:0xea
    ds_read_b64 v[100:101], v47 offset:63616
    v_bitop3_b32 v92, v16, v5, v46 bitop3:0xea
    v_perm_b32 v15, v17, v20, s45
    v_bitop3_b32 v46, v17, 0.5, -0.5 bitop3:0xa8
    v_perm_b32 v14, v16, v20, s44
    v_bitop3_b32 v47, v16, 0.5, -0.5 bitop3:0xa8
    s_waitcnt lgkmcnt(0)
    v_mfma_f32_4x4x4_16b_bf16 v[80:83], v[8:9], v[102:103], 0
    v_mfma_f32_4x4x4_16b_bf16 v[76:79], v[8:9], v[100:101], 0
    v_bitop3_b32 v15, v6, v15, v46 bitop3:0xca
    v_bitop3_b32 v14, v6, v14, v47 bitop3:0xca
    v_cmp_lt_u32 s[84:85], v5, v92
    s_nop 0
    v_pk_mul_f32 v[80:81], v[80:81], v[14:15] op_sel:[0,1] op_sel_hi:[1,1]
    v_pk_mul_f32 v[82:83], v[82:83], v[14:15] op_sel:[0,1] op_sel_hi:[1,1]
    v_pk_mul_f32 v[76:77], v[76:77], v[14:15] op_sel:[0,0] op_sel_hi:[1,0]
    v_pk_mul_f32 v[78:79], v[78:79], v[14:15] op_sel:[0,0] op_sel_hi:[1,0]
    v_and_b32 v47, 0x0fffffff, v33
    buffer_load_dwordx4 v[28:31], v47, s[8:11], 0 offen
    buffer_load_dwordx3 v[30:32], v47, s[8:11], 0 offen offset:8
    v_cmpx_ne_u64 vcc, v[74:75], v[70:71]
    s_and_b64 s[82:83], vcc, s[80:81]
    s_cbranch_scc1 L2_c5
L2_d5:
    v_mov_b64 v[84:85], v[70:71]
    v_mov_b32 v7, v95
    v_mov_b64 v[86:87], v[74:75]
    s_mov_b64 exec, -1
    s_or_b64 s[80:81], s[80:81], vcc
    v_cmpx_ne_u64 vcc, v[72:73], v[68:69]
    s_and_b64 s[82:83], vcc, s[80:81]
    s_cbranch_scc1 L2_c6
L2_d6:
    v_mov_b64 v[84:85], v[68:69]
    v_mov_b32 v7, v94
    v_mov_b64 v[86:87], v[72:73]
    s_mov_b64 exec, -1
    s_or_b64 s[80:81], s[80:81], vcc
    ds_read_b64 v[70:71], v93
    s_and_b64 exec, s[84:85], s[80:81]
    v_mfma_f32_4x4x4_16b_bf16 v[76:79], v[12:13], v[84:85], 0
    v_mov_b32 v92, v7
    s_andn2_b64 s[80:81], s[80:81], s[84:85]
    v_mfma_f32_4x4x4_16b_bf16 v[76:79], v[10:11], v[86:87], v[76:79]
    s_mov_b64 exec, -1
    ds_read_b64 v[68:69], v92
    v_and_b32 v46, 0x80000000, v21
    v_lshrrev_b32 v47, 14, v19
    v_bitop3_b32 v47, v47, v5, v46 bitop3:0xea
    ds_read_b64 v[106:107], v47 offset:63616
    v_bitop3_b32 v95, v19, v5, v46 bitop3:0xea
    v_and_b32 v46, 0x40000000, v21
    v_lshrrev_b32 v47, 14, v18
    v_bitop3_b32 v47, v47, v5, v46 bitop3:0xea
    ds_read_b64 v[104:105], v47 offset:63616
    v_bitop3_b32 v94, v18, v5, v46 bitop3:0xea
    s_waitcnt lgkmcnt(2)
    v_mfma_f32_4x4x4_16b_bf16 v[80:83], v[10:11], v[70:71], v[80:83]
    v_mfma_f32_4x4x4_16b_bf16 v[76:79], v[10:11], v[68:69], v[76:79]
    v_perm_b32 v15, v19, v20, s47
    v_bitop3_b32 v46, v19, 0.5, -0.5 bitop3:0xa8
    v_perm_b32 v14, v18, v20, s46
    v_bitop3_b32 v47, v18, 0.5, -0.5 bitop3:0xa8
    v_cvt_pk_bf16_f32 v80, v80, v81
    v_cvt_pk_bf16_f32 v81, v82, v83
    ds_wrxchg_rtn_b64 v[74:75], v93, v[80:81]
    v_cvt_pk_bf16_f32 v76, v76, v77
    v_cvt_pk_bf16_f32 v77, v78, v79
    ds_wrxchg_rtn_b64 v[72:73], v92, v[76:77]
    s_setprio 2
    s_waitcnt lgkmcnt(2)
    v_mfma_f32_4x4x4_16b_bf16 v[80:83], v[8:9], v[106:107], 0
    v_mfma_f32_4x4x4_16b_bf16 v[76:79], v[8:9], v[104:105], 0
    v_bitop3_b32 v15, v6, v15, v46 bitop3:0xca
    v_bitop3_b32 v14, v6, v14, v47 bitop3:0xca
    s_nop 1
    v_pk_mul_f32 v[80:81], v[80:81], v[14:15] op_sel:[0,1] op_sel_hi:[1,1]
    v_pk_mul_f32 v[82:83], v[82:83], v[14:15] op_sel:[0,1] op_sel_hi:[1,1]
    v_pk_mul_f32 v[76:77], v[76:77], v[14:15] op_sel:[0,0] op_sel_hi:[1,0]
    v_pk_mul_f32 v[78:79], v[78:79], v[14:15] op_sel:[0,0] op_sel_hi:[1,0]
    s_add_u32 s3, s40, 4096
    buffer_load_dwordx4 v[124:127], v3, s[16:19], s3 offen
    buffer_load_dwordx4 v[116:119], v3, s[16:19], s40 offen offset:2048
    s_waitcnt lgkmcnt(0)
    v_cmpx_ne_u64 vcc, v[74:75], v[70:71]
    s_and_b64 s[82:83], vcc, s[80:81]
    s_cbranch_scc1 L2_c7
L2_d7:
    v_mov_b64 v[84:85], v[70:71]
    v_mov_b32 v7, v93
    v_mov_b64 v[86:87], v[74:75]
    s_mov_b64 exec, -1
    s_or_b64 s[80:81], s[80:81], vcc
    v_cmpx_ne_u64 vcc, v[72:73], v[68:69]
    s_and_b64 s[82:83], vcc, s[80:81]
    s_cbranch_scc1 L2_c8
L2_d8:
    v_mov_b64 v[84:85], v[68:69]
    v_mov_b32 v7, v92
    v_mov_b64 v[86:87], v[72:73]
    s_mov_b64 exec, -1
    s_or_b64 s[80:81], s[80:81], vcc
    ds_read_b64 v[70:71], v95
    ds_read_b64 v[68:69], v94
    s_waitcnt vmcnt(4)
    v_and_b32 v46, 0x20000000, v27
    v_lshrrev_b32 v47, 14, v23
    v_bitop3_b32 v47, v47, v5, v46 bitop3:0xea
    ds_read_b64 v[102:103], v47 offset:63616
    v_bitop3_b32 v93, v23, v5, v46 bitop3:0xea
    v_and_b32 v46, 0x10000000, v27
    v_lshrrev_b32 v47, 14, v22
    v_bitop3_b32 v47, v47, v5, v46 bitop3:0xea
    ds_read_b64 v[100:101], v47 offset:63616
    v_bitop3_b32 v92, v22, v5, v46 bitop3:0xea
    s_waitcnt lgkmcnt(2)
    v_mfma_f32_4x4x4_16b_bf16 v[80:83], v[10:11], v[70:71], v[80:83]
    v_mfma_f32_4x4x4_16b_bf16 v[76:79], v[10:11], v[68:69], v[76:79]
    v_perm_b32 v15, v23, v26, s45
    v_bitop3_b32 v46, v23, 0.5, -0.5 bitop3:0xa8
    v_perm_b32 v14, v22, v26, s44
    v_bitop3_b32 v47, v22, 0.5, -0.5 bitop3:0xa8
    v_cvt_pk_bf16_f32 v80, v80, v81
    v_cvt_pk_bf16_f32 v81, v82, v83
    ds_wrxchg_rtn_b64 v[74:75], v95, v[80:81]
    v_cvt_pk_bf16_f32 v76, v76, v77
    v_cvt_pk_bf16_f32 v77, v78, v79
    ds_wrxchg_rtn_b64 v[72:73], v94, v[76:77]
    s_waitcnt lgkmcnt(2)
    v_mfma_f32_4x4x4_16b_bf16 v[80:83], v[8:9], v[102:103], 0
    v_mfma_f32_4x4x4_16b_bf16 v[76:79], v[8:9], v[100:101], 0
    v_bitop3_b32 v15, v6, v15, v46 bitop3:0xca
    v_bitop3_b32 v14, v6, v14, v47 bitop3:0xca
    v_cmp_lt_u32 s[84:85], v5, v92
    s_nop 0
    v_pk_mul_f32 v[80:81], v[80:81], v[14:15] op_sel:[0,1] op_sel_hi:[1,1]
    v_pk_mul_f32 v[82:83], v[82:83], v[14:15] op_sel:[0,1] op_sel_hi:[1,1]
    v_pk_mul_f32 v[76:77], v[76:77], v[14:15] op_sel:[0,0] op_sel_hi:[1,0]
    v_pk_mul_f32 v[78:79], v[78:79], v[14:15] op_sel:[0,0] op_sel_hi:[1,0]
    v_sub_u16 v88, v60, v52
    v_and_b32 v89, 3, v52
    v_add3_u32 v99, v88, v89, 3
    v_and_b32 v99, -4, v99
    v_max_u32 v99, 4, v99
    v_and_b32 v97, 0xfffc, v52
    v_bfm_b32 v96, v88, v89
    v_add_u32_dpp v91, v99, v99 row_shr:1 row_mask:0xf bank_mask:0xf bound_ctrl:1
    v_mad_u32_u24 v97, v97, 5, v2
    v_cmp_lt_u32 vcc, 16, v99
    v_add_u32_dpp v91, v91, v91 row_shr:2 row_mask:0xf bank_mask:0xf bound_ctrl:1
    v_sub_u32 v98, s38, v99
    v_lshrrev_b64 v[52:53], 16, v[52:53]
    v_add_u32_dpp v91, v91, v91 row_shr:4 row_mask:0xf bank_mask:0xf bound_ctrl:1
    v_lshrrev_b64 v[60:61], 16, v[60:61]
    s_mov_b32 s43, 0
    v_add_u32_dpp v91, v91, v91 row_shr:8 row_mask:0xf bank_mask:0xf bound_ctrl:1
    s_nop 1
    v_add_u32_dpp v91, v91, v91 row_bcast:15 row_mask:0xa bank_mask:0xf
    s_nop 1
    v_add_u32_dpp v91, v91, v91 row_bcast:31 row_mask:0xc bank_mask:0xf
    v_add_u32 v98, v98, v91
    v_readlane_b32 s37, v91, 63
    s_cbranch_vccnz L2_xo9
L2_xp9:
    v_and_b32 v47, 0x0fffffff, v39
    buffer_load_dwordx4 v[34:37], v47, s[8:11], 0 offen
    buffer_load_dwordx3 v[36:38], v47, s[8:11], 0 offen offset:8
    buffer_load_dwordx4 v[120:123], v3, s[16:19], s40 offen offset:3072
    s_waitcnt lgkmcnt(0)
    v_cmpx_ne_u64 vcc, v[74:75], v[70:71]
    s_and_b64 s[82:83], vcc, s[80:81]
    s_cbranch_scc1 L2_c10
L2_d10:
    v_mov_b64 v[84:85], v[70:71]
    v_mov_b32 v7, v95
    v_mov_b64 v[86:87], v[74:75]
    s_mov_b64 exec, -1
    s_or_b64 s[80:81], s[80:81], vcc
    v_cmpx_ne_u64 vcc, v[72:73], v[68:69]
    s_and_b64 s[82:83], vcc, s[80:81]
    s_cbranch_scc1 L2_c11
L2_d11:
    v_mov_b64 v[84:85], v[68:69]
    v_mov_b32 v7, v94
    v_mov_b64 v[86:87], v[72:73]
    s_mov_b64 exec, -1
    s_or_b64 s[80:81], s[80:81], vcc
    ds_read_b64 v[70:71], v93
    s_and_b64 exec, s[84:85], s[80:81]
    v_mfma_f32_4x4x4_16b_bf16 v[76:79], v[12:13], v[84:85], 0
    v_mov_b32 v92, v7
    s_andn2_b64 s[80:81], s[80:81], s[84:85]
    v_mfma_f32_4x4x4_16b_bf16 v[76:79], v[10:11], v[86:87], v[76:79]
    s_mov_b64 exec, -1
    ds_read_b64 v[68:69], v92
    v_and_b32 v46, 0x80000000, v27
    v_lshrrev_b32 v47, 14, v25
    v_bitop3_b32 v47, v47, v5, v46 bitop3:0xea
    ds_read_b64 v[106:107], v47 offset:63616
    v_bitop3_b32 v95, v25, v5, v46 bitop3:0xea
    v_and_b32 v46, 0x40000000, v27
    v_lshrrev_b32 v47, 14, v24
    v_bitop3_b32 v47, v47, v5, v46 bitop3:0xea
    ds_read_b64 v[104:105], v47 offset:63616
    v_bitop3_b32 v94, v24, v5, v46 bitop3:0xea
    s_waitcnt lgkmcnt(2)
    v_mfma_f32_4x4x4_16b_bf16 v[80:83], v[10:11], v[70:71], v[80:83]
    v_mfma_f32_4x4x4_16b_bf16 v[76:79], v[10:11], v[68:69], v[76:79]
    v_perm_b32 v15, v25, v26, s47
    v_bitop3_b32 v46, v25, 0.5, -0.5 bitop3:0xa8
    v_perm_b32 v14, v24, v26, s46
    v_bitop3_b32 v47, v24, 0.5, -0.5 bitop3:0xa8
    v_cvt_pk_bf16_f32 v80, v80, v81
    v_cvt_pk_bf16_f32 v81, v82, v83
    ds_wrxchg_rtn_b64 v[74:75], v93, v[80:81]
    v_cvt_pk_bf16_f32 v76, v76, v77
    v_cvt_pk_bf16_f32 v77, v78, v79
    ds_wrxchg_rtn_b64 v[72:73], v92, v[76:77]
    s_setprio 1
    s_waitcnt lgkmcnt(2)
    v_mfma_f32_4x4x4_16b_bf16 v[80:83], v[8:9], v[106:107], 0
    v_mfma_f32_4x4x4_16b_bf16 v[76:79], v[8:9], v[104:105], 0
    v_bitop3_b32 v15, v6, v15, v46 bitop3:0xca
    v_bitop3_b32 v14, v6, v14, v47 bitop3:0xca
    s_nop 1
    v_pk_mul_f32 v[80:81], v[80:81], v[14:15] op_sel:[0,1] op_sel_hi:[1,1]
    v_pk_mul_f32 v[82:83], v[82:83], v[14:15] op_sel:[0,1] op_sel_hi:[1,1]
    v_pk_mul_f32 v[76:77], v[76:77], v[14:15] op_sel:[0,0] op_sel_hi:[1,0]
    v_pk_mul_f32 v[78:79], v[78:79], v[14:15] op_sel:[0,0] op_sel_hi:[1,0]
    buffer_load_dwordx4 v[108:111], v3, s[16:19], s40 offen offset:0
    buffer_load_dwordx4 v[112:115], v3, s[16:19], s40 offen offset:1024
    s_waitcnt lgkmcnt(0)
    v_cmpx_ne_u64 vcc, v[74:75], v[70:71]
    s_and_b64 s[82:83], vcc, s[80:81]
    s_cbranch_scc1 L2_c12
L2_d12:
    v_mov_b64 v[84:85], v[70:71]
    v_mov_b32 v7, v93
    v_mov_b64 v[86:87], v[74:75]
    s_mov_b64 exec, -1
    s_or_b64 s[80:81], s[80:81], vcc
    v_cmpx_ne_u64 vcc, v[72:73], v[68:69]
    s_and_b64 s[82:83], vcc, s[80:81]
    s_cbranch_scc1 L2_c13
L2_d13:
    v_mov_b64 v[84:85], v[68:69]
    v_mov_b32 v7, v92
    v_mov_b64 v[86:87], v[72:73]
    s_mov_b64 exec, -1
    s_or_b64 s[80:81], s[80:81], vcc
    ds_read_b64 v[70:71], v95
    ds_read_b64 v[68:69], v94
    s_waitcnt vmcnt(7)
    v_and_b32 v46, 0x20000000, v33
    v_lshrrev_b32 v47, 14, v29
    v_bitop3_b32 v47, v47, v5, v46 bitop3:0xea
    ds_read_b64 v[102:103], v47 offset:63616
    v_bitop3_b32 v93, v29, v5, v46 bitop3:0xea
    v_and_b32 v46, 0x10000000, v33
    v_lshrrev_b32 v47, 14, v28
    v_bitop3_b32 v47, v47, v5, v46 bitop3:0xea
    ds_read_b64 v[100:101], v47 offset:63616
    v_bitop3_b32 v92, v28, v5, v46 bitop3:0xea
    s_waitcnt lgkmcnt(2)
    v_mfma_f32_4x4x4_16b_bf16 v[80:83], v[10:11], v[70:71], v[80:83]
    v_mfma_f32_4x4x4_16b_bf16 v[76:79], v[10:11], v[68:69], v[76:79]
    v_perm_b32 v15, v29, v32, s45
    v_bitop3_b32 v46, v29, 0.5, -0.5 bitop3:0xa8
    v_perm_b32 v14, v28, v32, s44
    v_bitop3_b32 v47, v28, 0.5, -0.5 bitop3:0xa8
    v_cvt_pk_bf16_f32 v80, v80, v81
    v_cvt_pk_bf16_f32 v81, v82, v83
    ds_wrxchg_rtn_b64 v[74:75], v95, v[80:81]
    v_cvt_pk_bf16_f32 v76, v76, v77
    v_cvt_pk_bf16_f32 v77, v78, v79
    ds_wrxchg_rtn_b64 v[72:73], v94, v[76:77]
    s_waitcnt lgkmcnt(2)
    v_mfma_f32_4x4x4_16b_bf16 v[80:83], v[8:9], v[102:103], 0
    v_mfma_f32_4x4x4_16b_bf16 v[76:79], v[8:9], v[100:101], 0
    v_bitop3_b32 v15, v6, v15, v46 bitop3:0xca
    v_bitop3_b32 v14, v6, v14, v47 bitop3:0xca
    v_cmp_lt_u32 s[84:85], v5, v92
    s_nop 0
    v_pk_mul_f32 v[80:81], v[80:81], v[14:15] op_sel:[0,1] op_sel_hi:[1,1]
    v_pk_mul_f32 v[82:83], v[82:83], v[14:15] op_sel:[0,1] op_sel_hi:[1,1]
    v_pk_mul_f32 v[76:77], v[76:77], v[14:15] op_sel:[0,0] op_sel_hi:[1,0]
    v_pk_mul_f32 v[78:79], v[78:79], v[14:15] op_sel:[0,0] op_sel_hi:[1,0]
    v_and_b32 v47, 0x0fffffff, v40
    v_mov_b32 v21, v40
    buffer_load_dwordx4 v[16:19], v47, s[8:11], 0 offen
    buffer_load_dwordx3 v[18:20], v47, s[8:11], 0 offen offset:8
    s_waitcnt lgkmcnt(0)
    v_cmpx_ne_u64 vcc, v[74:75], v[70:71]
    s_and_b64 s[82:83], vcc, s[80:81]
    s_cbranch_scc1 L2_c14
L2_d14:
    v_mov_b64 v[84:85], v[70:71]
    v_mov_b32 v7, v95
    v_mov_b64 v[86:87], v[74:75]
    s_mov_b64 exec, -1
    s_or_b64 s[80:81], s[80:81], vcc
    v_cmpx_ne_u64 vcc, v[72:73], v[68:69]
    s_and_b64 s[82:83], vcc, s[80:81]
    s_cbranch_scc1 L2_c15
L2_d15:
    v_mov_b64 v[84:85], v[68:69]
    v_mov_b32 v7, v94
    v_mov_b64 v[86:87], v[72:73]
    s_mov_b64 exec, -1
    s_or_b64 s[80:81], s[80:81], vcc
    ds_read_b64 v[70:71], v93
    s_and_b64 exec, s[84:85], s[80:81]
    v_mfma_f32_4x4x4_16b_bf16 v[76:79], v[12:13], v[84:85], 0
    v_mov_b32 v92, v7
    s_andn2_b64 s[80:81], s[80:81], s[84:85]
    v_mfma_f32_4x4x4_16b_bf16 v[76:79], v[10:11], v[86:87], v[76:79]
    s_mov_b64 exec, -1
    ds_read_b64 v[68:69], v92
    v_and_b32 v46, 0x80000000, v33
    v_lshrrev_b32 v47, 14, v31
    v_bitop3_b32 v47, v47, v5, v46 bitop3:0xea
    ds_read_b64 v[106:107], v47 offset:63616
    v_bitop3_b32 v95, v31, v5, v46 bitop3:0xea
    v_and_b32 v46, 0x40000000, v33
    v_lshrrev_b32 v47, 14, v30
    v_bitop3_b32 v47, v47, v5, v46 bitop3:0xea
    ds_read_b64 v[104:105], v47 offset:63616
    v_bitop3_b32 v94, v30, v5, v46 bitop3:0xea
    s_waitcnt lgkmcnt(2)
    v_mfma_f32_4x4x4_16b_bf16 v[80:83], v[10:11], v[70:71], v[80:83]
    v_mfma_f32_4x4x4_16b_bf16 v[76:79], v[10:11], v[68:69], v[76:79]
    v_perm_b32 v15, v31, v32, s47
    v_bitop3_b32 v46, v31, 0.5, -0.5 bitop3:0xa8
    v_perm_b32 v14, v30, v32, s46
    v_bitop3_b32 v47, v30, 0.5, -0.5 bitop3:0xa8
    v_cvt_pk_bf16_f32 v80, v80, v81
    v_cvt_pk_bf16_f32 v81, v82, v83
    ds_wrxchg_rtn_b64 v[74:75], v93, v[80:81]
    v_cvt_pk_bf16_f32 v76, v76, v77
    v_cvt_pk_bf16_f32 v77, v78, v79
    ds_wrxchg_rtn_b64 v[72:73], v92, v[76:77]
    s_setprio 0
    s_waitcnt lgkmcnt(2)
    v_mfma_f32_4x4x4_16b_bf16 v[80:83], v[8:9], v[106:107], 0
    v_mfma_f32_4x4x4_16b_bf16 v[76:79], v[8:9], v[104:105], 0
    v_bitop3_b32 v15, v6, v15, v46 bitop3:0xca
    v_bitop3_b32 v14, v6, v14, v47 bitop3:0xca
    s_nop 1
    v_pk_mul_f32 v[80:81], v[80:81], v[14:15] op_sel:[0,1] op_sel_hi:[1,1]
    v_pk_mul_f32 v[82:83], v[82:83], v[14:15] op_sel:[0,1] op_sel_hi:[1,1]
    v_pk_mul_f32 v[76:77], v[76:77], v[14:15] op_sel:[0,0] op_sel_hi:[1,0]
    v_pk_mul_f32 v[78:79], v[78:79], v[14:15] op_sel:[0,0] op_sel_hi:[1,0]
    s_add_u32 s40, s40, 0x4e200
    s_waitcnt lgkmcnt(0)
    v_cmpx_ne_u64 vcc, v[74:75], v[70:71]
    s_and_b64 s[82:83], vcc, s[80:81]
    s_cbranch_scc1 L2_c16
L2_d16:
    v_mov_b64 v[84:85], v[70:71]
    v_mov_b32 v7, v93
    v_mov_b64 v[86:87], v[74:75]
    s_mov_b64 exec, -1
    s_or_b64 s[80:81], s[80:81], vcc
    v_cmpx_ne_u64 vcc, v[72:73], v[68:69]
    s_and_b64 s[82:83], vcc, s[80:81]
    s_cbranch_scc1 L2_c17
L2_d17:
    v_mov_b64 v[84:85], v[68:69]
    v_mov_b32 v7, v92
    v_mov_b64 v[86:87], v[72:73]
    s_mov_b64 exec, -1
    s_or_b64 s[80:81], s[80:81], vcc
    ds_read_b64 v[70:71], v95
    ds_read_b64 v[68:69], v94
    s_waitcnt vmcnt(5)
    v_and_b32 v46, 0x20000000, v39
    v_lshrrev_b32 v47, 14, v35
    v_bitop3_b32 v47, v47, v5, v46 bitop3:0xea
    ds_read_b64 v[102:103], v47 offset:63616
    v_bitop3_b32 v93, v35, v5, v46 bitop3:0xea
    v_and_b32 v46, 0x10000000, v39
    v_lshrrev_b32 v47, 14, v34
    v_bitop3_b32 v47, v47, v5, v46 bitop3:0xea
    ds_read_b64 v[100:101], v47 offset:63616
    v_bitop3_b32 v92, v34, v5, v46 bitop3:0xea
    v_and_b32 v46, 0x80000000, v39
    v_lshrrev_b32 v47, 14, v37
    v_bitop3_b32 v47, v47, v5, v46 bitop3:0xea
    ds_read_b64 v[106:107], v47 offset:63616
    v_and_b32 v46, 0x40000000, v39
    v_lshrrev_b32 v47, 14, v36
    v_bitop3_b32 v47, v47, v5, v46 bitop3:0xea
    ds_read_b64 v[104:105], v47 offset:63616
    s_waitcnt lgkmcnt(4)
    v_mfma_f32_4x4x4_16b_bf16 v[80:83], v[10:11], v[70:71], v[80:83]
    v_mfma_f32_4x4x4_16b_bf16 v[76:79], v[10:11], v[68:69], v[76:79]
    v_perm_b32 v15, v35, v38, s45
    v_bitop3_b32 v46, v35, 0.5, -0.5 bitop3:0xa8
    v_perm_b32 v14, v34, v38, s44
    v_bitop3_b32 v47, v34, 0.5, -0.5 bitop3:0xa8
    v_cvt_pk_bf16_f32 v80, v80, v81
    v_cvt_pk_bf16_f32 v81, v82, v83
    ds_wrxchg_rtn_b64 v[74:75], v95, v[80:81]
    v_cvt_pk_bf16_f32 v76, v76, v77
    v_cvt_pk_bf16_f32 v77, v78, v79
    ds_wrxchg_rtn_b64 v[72:73], v94, v[76:77]
    s_waitcnt lgkmcnt(2)
    s_barrier
    s_setprio 3
    ds_write_b128 v3, v[124:127] offset:4096
    s_add_u32 s3, s40, 4096
    buffer_load_dwordx4 v[124:127], v3, s[16:19], s3 offen
    ds_write_b128 v3, v[116:119] offset:2048
    buffer_load_dwordx4 v[116:119], v3, s[16:19], s40 offen offset:2048
    s_waitcnt vmcnt(6)
    ds_write_b128 v3, v[120:123] offset:3072
    buffer_load_dwordx4 v[120:123], v3, s[16:19], s40 offen offset:3072
    v_mfma_f32_4x4x4_16b_bf16 v[80:83], v[8:9], v[102:103], 0
    v_mfma_f32_4x4x4_16b_bf16 v[76:79], v[8:9], v[100:101], 0
    v_bitop3_b32 v15, v6, v15, v46 bitop3:0xca
    v_bitop3_b32 v14, v6, v14, v47 bitop3:0xca
    v_cmp_lt_u32 s[84:85], v5, v92
    s_nop 0
    v_pk_mul_f32 v[80:81], v[80:81], v[14:15] op_sel:[0,1] op_sel_hi:[1,1]
    v_pk_mul_f32 v[82:83], v[82:83], v[14:15] op_sel:[0,1] op_sel_hi:[1,1]
    v_pk_mul_f32 v[76:77], v[76:77], v[14:15] op_sel:[0,0] op_sel_hi:[1,0]
    v_pk_mul_f32 v[78:79], v[78:79], v[14:15] op_sel:[0,0] op_sel_hi:[1,0]
    v_and_b32 v47, 0x0fffffff, v41
    v_mov_b32 v27, v41
    buffer_load_dwordx4 v[22:25], v47, s[8:11], 0 offen
    buffer_load_dwordx3 v[24:26], v47, s[8:11], 0 offen offset:8
    v_mov_b32 v33, v42
    v_mov_b32 v44, v43
    s_cmp_gt_u32 s37, 1024
    s_cbranch_scc1 L2_xs18
    s_cmp_lg_u32 s43, 0
    s_cbranch_scc1 L2_xa18
L2_xb18:
    v_lshlrev_b32 v89, 16, v96
    v_add_u32 v90, 60, v97
    v_bitop3_b32 v90, v89, v45, v90 bitop3:0x6a
    ds_write_b32 v98, v90 offset:12
    v_lshlrev_b32 v89, 20, v96
    v_add_u32 v90, 40, v97
    v_bitop3_b32 v90, v89, v45, v90 bitop3:0x6a
    ds_write_b32 v98, v90 offset:8
    v_lshlrev_b32 v89, 24, v96
    v_add_u32 v90, 20, v97
    v_bitop3_b32 v90, v89, v45, v90 bitop3:0x6a
    ds_write_b32 v98, v90 offset:4
    v_lshlrev_b32 v89, 28, v96
    v_bitop3_b32 v90, v89, v45, v97 bitop3:0x6a
    ds_write_b32 v98, v90 offset:0
    v_mov_b32_dpp v91, v64 quad_perm:[1,1,1,1] row_mask:0xf bank_mask:0xf
    v_and_b32 v89, 3, v91
    v_and_b32 v97, 0xfffc, v91
    v_sub_u16_dpp v88, v64, v91 quad_perm:[3,3,3,3] row_mask:0xf bank_mask:0xf
    v_mad_u32_u24 v97, v97, 5, v4
    v_add_u32 v99, v88, v89
    v_bfm_b32 v96, v88, v89
    v_cmp_lt_u32 s[58:59], 16, v99
    v_lshlrev_b32 v89, v1, v96
    v_and_b32 v89, v45, v89
    v_cmp_ne_u32 vcc, 0, v89
    v_xor_b32 v90, v97, v89
    s_add_u32 s3, s37, s38
    v_mbcnt_lo_u32_b32 v98, vcc_lo, 0
    v_mbcnt_hi_u32_b32 v98, vcc_hi, v98
    s_bcnt1_i32_b64 s41, vcc
    v_lshl_add_u32 v98, v98, 2, s3
    s_mov_b64 exec, vcc
    ds_write_b32 v98, v90
    s_mov_b64 exec, -1
    s_lshl2_add_u32 s37, s41, s37
    s_cmp_lg_u64 s[58:59], 0
    s_cbranch_scc1 L2_xe18
L2_xr18:
    v_add_u32 v98, s37, v0
    v_mov_b32 v90, -1
    ds_write_b32 v98, v90
    ds_read2st64_b32 v[40:41], v0 offset0:0 offset1:1
    ds_read2st64_b32 v[42:43], v0 offset0:2 offset1:3
    s_sub_u32 s3, s37, 768
    s_cmp_gt_u32 s3, 256
    s_cbranch_scc1 L2_xf18
L2_xg18:
    s_setprio 2
    s_waitcnt vmcnt(8)
    ds_write_b128 v3, v[108:111] offset:0
    s_waitcnt lgkmcnt(12)
    v_cmpx_ne_u64 vcc, v[74:75], v[70:71]
    s_and_b64 s[82:83], vcc, s[80:81]
    s_cbranch_scc1 L2_c19
L2_d19:
    v_mov_b64 v[84:85], v[70:71]
    v_mov_b32 v7, v95
    v_mov_b64 v[86:87], v[74:75]
    s_mov_b64 exec, -1
    s_or_b64 s[80:81], s[80:81], vcc
    v_cmpx_ne_u64 vcc, v[72:73], v[68:69]
    s_and_b64 s[82:83], vcc, s[80:81]
    s_cbranch_scc1 L2_c20
L2_d20:
    v_mov_b64 v[84:85], v[68:69]
    v_mov_b32 v7, v94
    v_mov_b64 v[86:87], v[72:73]
    s_mov_b64 exec, -1
    s_or_b64 s[80:81], s[80:81], vcc
    ds_read_b64 v[70:71], v93
    s_and_b64 exec, s[84:85], s[80:81]
    v_mfma_f32_4x4x4_16b_bf16 v[76:79], v[12:13], v[84:85], 0
    v_mov_b32 v92, v7
    s_andn2_b64 s[80:81], s[80:81], s[84:85]
    v_mfma_f32_4x4x4_16b_bf16 v[76:79], v[10:11], v[86:87], v[76:79]
    s_mov_b64 exec, -1
    ds_read_b64 v[68:69], v92
    s_setprio 1
    s_waitcnt vmcnt(7)
    ds_write_b128 v3, v[112:115] offset:1024
    s_waitcnt lgkmcnt(1)
    v_mfma_f32_4x4x4_16b_bf16 v[80:83], v[10:11], v[70:71], v[80:83]
    v_mfma_f32_4x4x4_16b_bf16 v[76:79], v[10:11], v[68:69], v[76:79]
    v_and_b32 v46, 0x40000000, v39
    v_bitop3_b32 v94, v36, v5, v46 bitop3:0xea
    v_and_b32 v46, 0x80000000, v39
    v_bitop3_b32 v95, v37, v5, v46 bitop3:0xea
    v_perm_b32 v15, v37, v38, s47
    v_bitop3_b32 v46, v37, 0.5, -0.5 bitop3:0xa8
    v_perm_b32 v14, v36, v38, s46
    v_bitop3_b32 v47, v36, 0.5, -0.5 bitop3:0xa8
    v_cvt_pk_bf16_f32 v80, v80, v81
    v_cvt_pk_bf16_f32 v81, v82, v83
    ds_wrxchg_rtn_b64 v[74:75], v93, v[80:81]
    v_cvt_pk_bf16_f32 v76, v76, v77
    v_cvt_pk_bf16_f32 v77, v78, v79
    ds_wrxchg_rtn_b64 v[72:73], v92, v[76:77]
    s_setprio 0
    v_mfma_f32_4x4x4_16b_bf16 v[80:83], v[8:9], v[106:107], 0
    v_mfma_f32_4x4x4_16b_bf16 v[76:79], v[8:9], v[104:105], 0
    v_bitop3_b32 v15, v6, v15, v46 bitop3:0xca
    v_bitop3_b32 v14, v6, v14, v47 bitop3:0xca
    s_nop 1
    v_pk_mul_f32 v[80:81], v[80:81], v[14:15] op_sel:[0,1] op_sel_hi:[1,1]
    v_pk_mul_f32 v[82:83], v[82:83], v[14:15] op_sel:[0,1] op_sel_hi:[1,1]
    v_pk_mul_f32 v[76:77], v[76:77], v[14:15] op_sel:[0,0] op_sel_hi:[1,0]
    v_pk_mul_f32 v[78:79], v[78:79], v[14:15] op_sel:[0,0] op_sel_hi:[1,0]
    s_add_u32 s42, s42, 1
    s_waitcnt lgkmcnt(2)
    s_barrier
    s_bitcmp1_b32 s36, s42
    s_cbranch_scc1 L2_slow
L2_ret1:
    s_setprio 3
    v_and_b32 v47, 0x0fffffff, v33
    buffer_load_dwordx4 v[28:31], v47, s[8:11], 0 offen
    buffer_load_dwordx3 v[30:32], v47, s[8:11], 0 offen offset:8
    s_waitcnt lgkmcnt(0)
    v_cmpx_ne_u64 vcc, v[74:75], v[70:71]
    s_and_b64 s[82:83], vcc, s[80:81]
    s_cbranch_scc1 L2_c21
L2_d21:
    v_mov_b64 v[84:85], v[70:71]
    v_mov_b32 v7, v93
    v_mov_b64 v[86:87], v[74:75]
    s_mov_b64 exec, -1
    s_or_b64 s[80:81], s[80:81], vcc
    v_cmpx_ne_u64 vcc, v[72:73], v[68:69]
    s_and_b64 s[82:83], vcc, s[80:81]
    s_cbranch_scc1 L2_c22
L2_d22:
    v_mov_b64 v[84:85], v[68:69]
    v_mov_b32 v7, v92
    v_mov_b64 v[86:87], v[72:73]
    s_mov_b64 exec, -1
    s_or_b64 s[80:81], s[80:81], vcc
    ds_read_b64 v[70:71], v95
    ds_read_b64 v[68:69], v94
    s_waitcnt vmcnt(7)
    v_and_b32 v46, 0x20000000, v21
    v_lshrrev_b32 v47, 14, v17
    v_bitop3_b32 v47, v47, v5, v46 bitop3:0xea
    ds_read_b64 v[102:103], v47 offset:63616
    v_bitop3_b32 v93, v17, v5, v46 bitop3:0xea
    v_and_b32 v46, 0x10000000, v21
    v_lshrrev_b32 v47, 14, v16
    v_bitop3_b32 v47, v47, v5, v46 bitop3:0xea
    ds_read_b64 v[100:101], v47 offset:63616
    v_bitop3_b32 v92, v16, v5, v46 bitop3:0xea
    s_waitcnt lgkmcnt(2)
    v_mfma_f32_4x4x4_16b_bf16 v[80:83], v[10:11], v[70:71], v[80:83]
    v_mfma_f32_4x4x4_16b_bf16 v[76:79], v[10:11], v[68:69], v[76:79]
    v_perm_b32 v15, v17, v20, s45
    v_bitop3_b32 v46, v17, 0.5, -0.5 bitop3:0xa8
    v_perm_b32 v14, v16, v20, s44
    v_bitop3_b32 v47, v16, 0.5, -0.5 bitop3:0xa8
    v_cvt_pk_bf16_f32 v80, v80, v81
    v_cvt_pk_bf16_f32 v81, v82, v83
    ds_wrxchg_rtn_b64 v[74:75], v95, v[80:81]
    v_cvt_pk_bf16_f32 v76, v76, v77
    v_cvt_pk_bf16_f32 v77, v78, v79
    ds_wrxchg_rtn_b64 v[72:73], v94, v[76:77]
    s_waitcnt lgkmcnt(2)
    v_mfma_f32_4x4x4_16b_bf16 v[80:83], v[8:9], v[102:103], 0
    v_mfma_f32_4x4x4_16b_bf16 v[76:79], v[8:9], v[100:101], 0
    v_bitop3_b32 v15, v6, v15, v46 bitop3:0xca
    v_bitop3_b32 v14, v6, v14, v47 bitop3:0xca
    v_cmp_lt_u32 s[84:85], v5, v92
    s_nop 0
    v_pk_mul_f32 v[80:81], v[80:81], v[14:15] op_sel:[0,1] op_sel_hi:[1,1]
    v_pk_mul_f32 v[82:83], v[82:83], v[14:15] op_sel:[0,1] op_sel_hi:[1,1]
    v_pk_mul_f32 v[76:77], v[76:77], v[14:15] op_sel:[0,0] op_sel_hi:[1,0]
    v_pk_mul_f32 v[78:79], v[78:79], v[14:15] op_sel:[0,0] op_sel_hi:[1,0]
    buffer_load_dwordx4 v[108:111], v3, s[16:19], s40 offen offset:0
    s_waitcnt lgkmcnt(0)
    v_cmpx_ne_u64 vcc, v[74:75], v[70:71]
    s_and_b64 s[82:83], vcc, s[80:81]
    s_cbranch_scc1 L2_c23
L2_d23:
    v_mov_b64 v[84:85], v[70:71]
    v_mov_b32 v7, v95
    v_mov_b64 v[86:87], v[74:75]
    s_mov_b64 exec, -1
    s_or_b64 s[80:81], s[80:81], vcc
    v_cmpx_ne_u64 vcc, v[72:73], v[68:69]
    s_and_b64 s[82:83], vcc, s[80:81]
    s_cbranch_scc1 L2_c24
L2_d24:
    v_mov_b64 v[84:85], v[68:69]
    v_mov_b32 v7, v94
    v_mov_b64 v[86:87], v[72:73]
    s_mov_b64 exec, -1
    s_or_b64 s[80:81], s[80:81], vcc
    ds_read_b64 v[70:71], v93
    s_and_b64 exec, s[84:85], s[80:81]
    v_mfma_f32_4x4x4_16b_bf16 v[76:79], v[12:13], v[84:85], 0
    v_mov_b32 v92, v7
    s_andn2_b64 s[80:81], s[80:81], s[84:85]
    v_mfma_f32_4x4x4_16b_bf16 v[76:79], v[10:11], v[86:87], v[76:79]
    s_mov_b64 exec, -1
    ds_read_b64 v[68:69], v92
    v_and_b32 v46, 0x80000000, v21
    v_lshrrev_b32 v47, 14, v19
    v_bitop3_b32 v47, v47, v5, v46 bitop3:0xea
    ds_read_b64 v[106:107], v47 offset:63616
    v_bitop3_b32 v95, v19, v5, v46 bitop3:0xea
    v_and_b32 v46, 0x40000000, v21
    v_lshrrev_b32 v47, 14, v18
    v_bitop3_b32 v47, v47, v5, v46 bitop3:0xea
    ds_read_b64 v[104:105], v47 offset:63616
    v_bitop3_b32 v94, v18, v5, v46 bitop3:0xea
    s_waitcnt lgkmcnt(2)
    v_mfma_f32_4x4x4_16b_bf16 v[80:83], v[10:11], v[70:71], v[80:83]
    v_mfma_f32_4x4x4_16b_bf16 v[76:79], v[10:11], v[68:69], v[76:79]
    v_perm_b32 v15, v19, v20, s47
    v_bitop3_b32 v46, v19, 0.5, -0.5 bitop3:0xa8
    v_perm_b32 v14, v18, v20, s46
    v_bitop3_b32 v47, v18, 0.5, -0.5 bitop3:0xa8
    v_cvt_pk_bf16_f32 v80, v80, v81
    v_cvt_pk_bf16_f32 v81, v82, v83
    ds_wrxchg_rtn_b64 v[74:75], v93, v[80:81]
    v_cvt_pk_bf16_f32 v76, v76, v77
    v_cvt_pk_bf16_f32 v77, v78, v79
    ds_wrxchg_rtn_b64 v[72:73], v92, v[76:77]
    s_setprio 2
    s_waitcnt lgkmcnt(2)
    v_mfma_f32_4x4x4_16b_bf16 v[80:83], v[8:9], v[106:107], 0
    v_mfma_f32_4x4x4_16b_bf16 v[76:79], v[8:9], v[104:105], 0
    v_bitop3_b32 v15, v6, v15, v46 bitop3:0xca
    v_bitop3_b32 v14, v6, v14, v47 bitop3:0xca
    s_nop 1
    v_pk_mul_f32 v[80:81], v[80:81], v[14:15] op_sel:[0,1] op_sel_hi:[1,1]
    v_pk_mul_f32 v[82:83], v[82:83], v[14:15] op_sel:[0,1] op_sel_hi:[1,1]
    v_pk_mul_f32 v[76:77], v[76:77], v[14:15] op_sel:[0,0] op_sel_hi:[1,0]
    v_pk_mul_f32 v[78:79], v[78:79], v[14:15] op_sel:[0,0] op_sel_hi:[1,0]
    v_and_b32 v47, 0x0fffffff, v44
    v_mov_b32 v39, v44
    buffer_load_dwordx4 v[34:37], v47, s[8:11], 0 offen
    buffer_load_dwordx3 v[36:38], v47, s[8:11], 0 offen offset:8
    s_waitcnt lgkmcnt(0)
    v_cmpx_ne_u64 vcc, v[74:75], v[70:71]
    s_and_b64 s[82:83], vcc, s[80:81]
    s_cbranch_scc1 L2_c25
L2_d25:
    v_mov_b64 v[84:85], v[70:71]
    v_mov_b32 v7, v93
    v_mov_b64 v[86:87], v[74:75]
    s_mov_b64 exec, -1
    s_or_b64 s[80:81], s[80:81], vcc
    v_cmpx_ne_u64 vcc, v[72:73], v[68:69]
    s_and_b64 s[82:83], vcc, s[80:81]
    s_cbranch_scc1 L2_c26
L2_d26:
    v_mov_b64 v[84:85], v[68:69]
    v_mov_b32 v7, v92
    v_mov_b64 v[86:87], v[72:73]
    s_mov_b64 exec, -1
    s_or_b64 s[80:81], s[80:81], vcc
    ds_read_b64 v[70:71], v95
    ds_read_b64 v[68:69], v94
    s_waitcnt vmcnt(5)
    v_and_b32 v46, 0x20000000, v27
    v_lshrrev_b32 v47, 14, v23
    v_bitop3_b32 v47, v47, v5, v46 bitop3:0xea
    ds_read_b64 v[102:103], v47 offset:63616
    v_bitop3_b32 v93, v23, v5, v46 bitop3:0xea
    v_and_b32 v46, 0x10000000, v27
    v_lshrrev_b32 v47, 14, v22
    v_bitop3_b32 v47, v47, v5, v46 bitop3:0xea
    ds_read_b64 v[100:101], v47 offset:63616
    v_bitop3_b32 v92, v22, v5, v46 bitop3:0xea
    s_waitcnt lgkmcnt(2)
    v_mfma_f32_4x4x4_16b_bf16 v[80:83], v[10:11], v[70:71], v[80:83]
    v_mfma_f32_4x4x4_16b_bf16 v[76:79], v[10:11], v[68:69], v[76:79]
    v_perm_b32 v15, v23, v26, s45
    v_bitop3_b32 v46, v23, 0.5, -0.5 bitop3:0xa8
    v_perm_b32 v14, v22, v26, s44
    v_bitop3_b32 v47, v22, 0.5, -0.5 bitop3:0xa8
    v_cvt_pk_bf16_f32 v80, v80, v81
    v_cvt_pk_bf16_f32 v81, v82, v83
    ds_wrxchg_rtn_b64 v[74:75], v95, v[80:81]
    v_cvt_pk_bf16_f32 v76, v76, v77
    v_cvt_pk_bf16_f32 v77, v78, v79
    ds_wrxchg_rtn_b64 v[72:73], v94, v[76:77]
    s_waitcnt lgkmcnt(2)
    v_mfma_f32_4x4x4_16b_bf16 v[80:83], v[8:9], v[102:103], 0
    v_mfma_f32_4x4x4_16b_bf16 v[76:79], v[8:9], v[100:101], 0
    v_bitop3_b32 v15, v6, v15, v46 bitop3:0xca
    v_bitop3_b32 v14, v6, v14, v47 bitop3:0xca
    v_cmp_lt_u32 s[84:85], v5, v92
    s_nop 0
    v_pk_mul_f32 v[80:81], v[80:81], v[14:15] op_sel:[0,1] op_sel_hi:[1,1]
    v_pk_mul_f32 v[82:83], v[82:83], v[14:15] op_sel:[0,1] op_sel_hi:[1,1]
    v_pk_mul_f32 v[76:77], v[76:77], v[14:15] op_sel:[0,0] op_sel_hi:[1,0]
    v_pk_mul_f32 v[78:79], v[78:79], v[14:15] op_sel:[0,0] op_sel_hi:[1,0]
    v_sub_u16 v88, v62, v54
    v_and_b32 v89, 3, v54
    v_add3_u32 v99, v88, v89, 3
    v_and_b32 v99, -4, v99
    v_max_u32 v99, 4, v99
    v_and_b32 v97, 0xfffc, v54
    v_bfm_b32 v96, v88, v89
    v_add_u32_dpp v91, v99, v99 row_shr:1 row_mask:0xf bank_mask:0xf bound_ctrl:1
    v_mad_u32_u24 v97, v97, 5, v2
    v_cmp_lt_u32 vcc, 16, v99
    v_add_u32_dpp v91, v91, v91 row_shr:2 row_mask:0xf bank_mask:0xf bound_ctrl:1
    v_sub_u32 v98, s38, v99
    v_lshrrev_b64 v[54:55], 16, v[54:55]
    v_add_u32_dpp v91, v91, v91 row_shr:4 row_mask:0xf bank_mask:0xf bound_ctrl:1
    v_lshrrev_b64 v[62:63], 16, v[62:63]
    s_mov_b32 s43, 0
    v_add_u32_dpp v91, v91, v91 row_shr:8 row_mask:0xf bank_mask:0xf bound_ctrl:1
    s_nop 1
    v_add_u32_dpp v91, v91, v91 row_bcast:15 row_mask:0xa bank_mask:0xf
    s_nop 1
    v_add_u32_dpp v91, v91, v91 row_bcast:31 row_mask:0xc bank_mask:0xf
    v_add_u32 v98, v98, v91
    v_readlane_b32 s37, v91, 63
    s_cbranch_vccnz L2_xo27
L2_xp27:
    buffer_load_dwordx4 v[112:115], v3, s[16:19], s40 offen offset:1024
    v_and_b32 v47, 0x0fffffff, v40
    v_mov_b32 v21, v40
    buffer_load_dwordx4 v[16:19], v47, s[8:11], 0 offen
    buffer_load_dwordx3 v[18:20], v47, s[8:11], 0 offen offset:8
    s_waitcnt lgkmcnt(0)
    v_cmpx_ne_u64 vcc, v[74:75], v[70:71]
    s_and_b64 s[82:83], vcc, s[80:81]
    s_cbranch_scc1 L2_c28
L2_d28:
    v_mov_b64 v[84:85], v[70:71]
    v_mov_b32 v7, v95
    v_mov_b64 v[86:87], v[74:75]
    s_mov_b64 exec, -1
    s_or_b64 s[80:81], s[80:81], vcc
    v_cmpx_ne_u64 vcc, v[72:73], v[68:69]
    s_and_b64 s[82:83], vcc, s[80:81]
    s_cbranch_scc1 L2_c29
L2_d29:
    v_mov_b64 v[84:85], v[68:69]
    v_mov_b32 v7, v94
    v_mov_b64 v[86:87], v[72:73]
    s_mov_b64 exec, -1
    s_or_b64 s[80:81], s[80:81], vcc
    ds_read_b64 v[70:71], v93
    s_and_b64 exec, s[84:85], s[80:81]
    v_mfma_f32_4x4x4_16b_bf16 v[76:79], v[12:13], v[84:85], 0
    v_mov_b32 v92, v7
    s_andn2_b64 s[80:81], s[80:81], s[84:85]
    v_mfma_f32_4x4x4_16b_bf16 v[76:79], v[10:11], v[86:87], v[76:79]
    s_mov_b64 exec, -1
    ds_read_b64 v[68:69], v92
    v_and_b32 v46, 0x80000000, v27
    v_lshrrev_b32 v47, 14, v25
    v_bitop3_b32 v47, v47, v5, v46 bitop3:0xea
    ds_read_b64 v[106:107], v47 offset:63616
    v_bitop3_b32 v95, v25, v5, v46 bitop3:0xea
    v_and_b32 v46, 0x40000000, v27
    v_lshrrev_b32 v47, 14, v24
    v_bitop3_b32 v47, v47, v5, v46 bitop3:0xea
    ds_read_b64 v[104:105], v47 offset:63616
    v_bitop3_b32 v94, v24, v5, v46 bitop3:0xea
    s_waitcnt lgkmcnt(2)
    v_mfma_f32_4x4x4_16b_bf16 v[80:83], v[10:11], v[70:71], v[80:83]
    v_mfma_f32_4x4x4_16b_bf16 v[76:79], v[10:11], v[68:69], v[76:79]
    v_perm_b32 v15, v25, v26, s47
    v_bitop3_b32 v46, v25, 0.5, -0.5 bitop3:0xa8
    v_perm_b32 v14, v24, v26, s46
    v_bitop3_b32 v47, v24, 0.5, -0.5 bitop3:0xa8
    v_cvt_pk_bf16_f32 v80, v80, v81
    v_cvt_pk_bf16_f32 v81, v82, v83
    ds_wrxchg_rtn_b64 v[74:75], v93, v[80:81]
    v_cvt_pk_bf16_f32 v76, v76, v77
    v_cvt_pk_bf16_f32 v77, v78, v79
    ds_wrxchg_rtn_b64 v[72:73], v92, v[76:77]
    s_setprio 1
    s_waitcnt lgkmcnt(2)
    v_mfma_f32_4x4x4_16b_bf16 v[80:83], v[8:9], v[106:107], 0
    v_mfma_f32_4x4x4_16b_bf16 v[76:79], v[8:9], v[104:105], 0
    v_bitop3_b32 v15, v6, v15, v46 bitop3:0xca
    v_bitop3_b32 v14, v6, v14, v47 bitop3:0xca
    s_nop 1
    v_pk_mul_f32 v[80:81], v[80:81], v[14:15] op_sel:[0,1] op_sel_hi:[1,1]
    v_pk_mul_f32 v[82:83], v[82:83], v[14:15] op_sel:[0,1] op_sel_hi:[1,1]
    v_pk_mul_f32 v[76:77], v[76:77], v[14:15] op_sel:[0,0] op_sel_hi:[1,0]
    v_pk_mul_f32 v[78:79], v[78:79], v[14:15] op_sel:[0,0] op_sel_hi:[1,0]
    s_waitcnt lgkmcnt(0)
    v_cmpx_ne_u64 vcc, v[74:75], v[70:71]
    s_and_b64 s[82:83], vcc, s[80:81]
    s_cbranch_scc1 L2_c30
L2_d30:
    v_mov_b64 v[84:85], v[70:71]
    v_mov_b32 v7, v93
    v_mov_b64 v[86:87], v[74:75]
    s_mov_b64 exec, -1
    s_or_b64 s[80:81], s[80:81], vcc
    v_cmpx_ne_u64 vcc, v[72:73], v[68:69]
    s_and_b64 s[82:83], vcc, s[80:81]
    s_cbranch_scc1 L2_c31
L2_d31:
    v_mov_b64 v[84:85], v[68:69]
    v_mov_b32 v7, v92
    v_mov_b64 v[86:87], v[72:73]
    s_mov_b64 exec, -1
    s_or_b64 s[80:81], s[80:81], vcc
    ds_read_b64 v[70:71], v95
    ds_read_b64 v[68:69], v94
    s_waitcnt vmcnt(6)
    v_and_b32 v46, 0x20000000, v33
    v_lshrrev_b32 v47, 14, v29
    v_bitop3_b32 v47, v47, v5, v46 bitop3:0xea
    ds_read_b64 v[102:103], v47 offset:63616
    v_bitop3_b32 v93, v29, v5, v46 bitop3:0xea
    v_and_b32 v46, 0x10000000, v33
    v_lshrrev_b32 v47, 14, v28
    v_bitop3_b32 v47, v47, v5, v46 bitop3:0xea
    ds_read_b64 v[100:101], v47 offset:63616
    v_bitop3_b32 v92, v28, v5, v46 bitop3:0xea
    s_waitcnt lgkmcnt(2)
    v_mfma_f32_4x4x4_16b_bf16 v[80:83], v[10:11], v[70:71], v[80:83]
    v_mfma_f32_4x4x4_16b_bf16 v[76:79], v[10:11], v[68:69], v[76:79]
    v_perm_b32 v15, v29, v32, s45
    v_bitop3_b32 v46, v29, 0.5, -0.5 bitop3:0xa8
    v_perm_b32 v14, v28, v32, s44
    v_bitop3_b32 v47, v28, 0.5, -0.5 bitop3:0xa8
    v_cvt_pk_bf16_f32 v80, v80, v81
    v_cvt_pk_bf16_f32 v81, v82, v83
    ds_wrxchg_rtn_b64 v[74:75], v95, v[80:81]
    v_cvt_pk_bf16_f32 v76, v76, v77
    v_cvt_pk_bf16_f32 v77, v78, v79
    ds_wrxchg_rtn_b64 v[72:73], v94, v[76:77]
    s_waitcnt lgkmcnt(2)
    v_mfma_f32_4x4x4_16b_bf16 v[80:83], v[8:9], v[102:103], 0
    v_mfma_f32_4x4x4_16b_bf16 v[76:79], v[8:9], v[100:101], 0
    v_bitop3_b32 v15, v6, v15, v46 bitop3:0xca
    v_bitop3_b32 v14, v6, v14, v47 bitop3:0xca
    v_cmp_lt_u32 s[84:85], v5, v92
    s_nop 0
    v_pk_mul_f32 v[80:81], v[80:81], v[14:15] op_sel:[0,1] op_sel_hi:[1,1]
    v_pk_mul_f32 v[82:83], v[82:83], v[14:15] op_sel:[0,1] op_sel_hi:[1,1]
    v_pk_mul_f32 v[76:77], v[76:77], v[14:15] op_sel:[0,0] op_sel_hi:[1,0]
    v_pk_mul_f32 v[78:79], v[78:79], v[14:15] op_sel:[0,0] op_sel_hi:[1,0]
    v_and_b32 v47, 0x0fffffff, v41
    v_mov_b32 v27, v41
    buffer_load_dwordx4 v[22:25], v47, s[8:11], 0 offen
    buffer_load_dwordx3 v[24:26], v47, s[8:11], 0 offen offset:8
    s_waitcnt lgkmcnt(0)
    v_cmpx_ne_u64 vcc, v[74:75], v[70:71]
    s_and_b64 s[82:83], vcc, s[80:81]
    s_cbranch_scc1 L2_c32
L2_d32:
    v_mov_b64 v[84:85], v[70:71]
    v_mov_b32 v7, v95
    v_mov_b64 v[86:87], v[74:75]
    s_mov_b64 exec, -1
    s_or_b64 s[80:81], s[80:81], vcc
    v_cmpx_ne_u64 vcc, v[72:73], v[68:69]
    s_and_b64 s[82:83], vcc, s[80:81]
    s_cbranch_scc1 L2_c33
L2_d33:
    v_mov_b64 v[84:85], v[68:69]
    v_mov_b32 v7, v94
    v_mov_b64 v[86:87], v[72:73]
    s_mov_b64 exec, -1
    s_or_b64 s[80:81], s[80:81], vcc
    ds_read_b64 v[70:71], v93
    s_and_b64 exec, s[84:85], s[80:81]
    v_mfma_f32_4x4x4_16b_bf16 v[76:79], v[12:13], v[84:85], 0
    v_mov_b32 v92, v7
    s_andn2_b64 s[80:81], s[80:81], s[84:85]
    v_mfma_f32_4x4x4_16b_bf16 v[76:79], v[10:11], v[86:87], v[76:79]
    s_mov_b64 exec, -1
    ds_read_b64 v[68:69], v92
    v_and_b32 v46, 0x80000000, v33
    v_lshrrev_b32 v47, 14, v31
    v_bitop3_b32 v47, v47, v5, v46 bitop3:0xea
    ds_read_b64 v[106:107], v47 offset:63616
    v_bitop3_b32 v95, v31, v5, v46 bitop3:0xea
    v_and_b32 v46, 0x40000000, v33
    v_lshrrev_b32 v47, 14, v30
    v_bitop3_b32 v47, v47, v5, v46 bitop3:0xea
    ds_read_b64 v[104:105], v47 offset:63616
    v_bitop3_b32 v94, v30, v5, v46 bitop3:0xea
    s_waitcnt lgkmcnt(2)
    v_mfma_f32_4x4x4_16b_bf16 v[80:83], v[10:11], v[70:71], v[80:83]
    v_mfma_f32_4x4x4_16b_bf16 v[76:79], v[10:11], v[68:69], v[76:79]
    v_perm_b32 v15, v31, v32, s47
    v_bitop3_b32 v46, v31, 0.5, -0.5 bitop3:0xa8
    v_perm_b32 v14, v30, v32, s46
    v_bitop3_b32 v47, v30, 0.5, -0.5 bitop3:0xa8
    v_cvt_pk_bf16_f32 v80, v80, v81
    v_cvt_pk_bf16_f32 v81, v82, v83
    ds_wrxchg_rtn_b64 v[74:75], v93, v[80:81]
    v_cvt_pk_bf16_f32 v76, v76, v77
    v_cvt_pk_bf16_f32 v77, v78, v79
    ds_wrxchg_rtn_b64 v[72:73], v92, v[76:77]
    s_setprio 0
    s_waitcnt lgkmcnt(2)
    v_mfma_f32_4x4x4_16b_bf16 v[80:83], v[8:9], v[106:107], 0
    v_mfma_f32_4x4x4_16b_bf16 v[76:79], v[8:9], v[104:105], 0
    v_bitop3_b32 v15, v6, v15, v46 bitop3:0xca
    v_bitop3_b32 v14, v6, v14, v47 bitop3:0xca
    s_nop 1
    v_pk_mul_f32 v[80:81], v[80:81], v[14:15] op_sel:[0,1] op_sel_hi:[1,1]
    v_pk_mul_f32 v[82:83], v[82:83], v[14:15] op_sel:[0,1] op_sel_hi:[1,1]
    v_pk_mul_f32 v[76:77], v[76:77], v[14:15] op_sel:[0,0] op_sel_hi:[1,0]
    v_pk_mul_f32 v[78:79], v[78:79], v[14:15] op_sel:[0,0] op_sel_hi:[1,0]
    s_add_u32 s40, s40, 0x4e200
    s_waitcnt lgkmcnt(0)
    v_cmpx_ne_u64 vcc, v[74:75], v[70:71]
    s_and_b64 s[82:83], vcc, s[80:81]
    s_cbranch_scc1 L2_c34
L2_d34:
    v_mov_b64 v[84:85], v[70:71]
    v_mov_b32 v7, v93
    v_mov_b64 v[86:87], v[74:75]
    s_mov_b64 exec, -1
    s_or_b64 s[80:81], s[80:81], vcc
    v_cmpx_ne_u64 vcc, v[72:73], v[68:69]
    s_and_b64 s[82:83], vcc, s[80:81]
    s_cbranch_scc1 L2_c35
L2_d35:
    v_mov_b64 v[84:85], v[68:69]
    v_mov_b32 v7, v92
    v_mov_b64 v[86:87], v[72:73]
    s_mov_b64 exec, -1
    s_or_b64 s[80:81], s[80:81], vcc
    ds_read_b64 v[70:71], v95
    ds_read_b64 v[68:69], v94
    s_waitcnt vmcnt(5)
    v_and_b32 v46, 0x20000000, v39
    v_lshrrev_b32 v47, 14, v35
    v_bitop3_b32 v47, v47, v5, v46 bitop3:0xea
    ds_read_b64 v[102:103], v47 offset:63616
    v_bitop3_b32 v93, v35, v5, v46 bitop3:0xea
    v_and_b32 v46, 0x10000000, v39
    v_lshrrev_b32 v47, 14, v34
    v_bitop3_b32 v47, v47, v5, v46 bitop3:0xea
    ds_read_b64 v[100:101], v47 offset:63616
    v_bitop3_b32 v92, v34, v5, v46 bitop3:0xea
    v_and_b32 v46, 0x80000000, v39
    v_lshrrev_b32 v47, 14, v37
    v_bitop3_b32 v47, v47, v5, v46 bitop3:0xea
    ds_read_b64 v[106:107], v47 offset:63616
    v_and_b32 v46, 0x40000000, v39
    v_lshrrev_b32 v47, 14, v36
    v_bitop3_b32 v47, v47, v5, v46 bitop3:0xea
    ds_read_b64 v[104:105], v47 offset:63616
    s_waitcnt lgkmcnt(4)
    v_mfma_f32_4x4x4_16b_bf16 v[80:83], v[10:11], v[70:71], v[80:83]
    v_mfma_f32_4x4x4_16b_bf16 v[76:79], v[10:11], v[68:69], v[76:79]
    v_perm_b32 v15, v35, v38, s45
    v_bitop3_b32 v46, v35, 0.5, -0.5 bitop3:0xa8
    v_perm_b32 v14, v34, v38, s44
    v_bitop3_b32 v47, v34, 0.5, -0.5 bitop3:0xa8
    v_cvt_pk_bf16_f32 v80, v80, v81
    v_cvt_pk_bf16_f32 v81, v82, v83
    ds_wrxchg_rtn_b64 v[74:75], v95, v[80:81]
    v_cvt_pk_bf16_f32 v76, v76, v77
    v_cvt_pk_bf16_f32 v77, v78, v79
    ds_wrxchg_rtn_b64 v[72:73], v94, v[76:77]
    s_waitcnt lgkmcnt(2)
    s_barrier
    s_setprio 3
    ds_write_b128 v3, v[124:127] offset:4096
    s_add_u32 s3, s40, 4096
    buffer_load_dwordx4 v[124:127], v3, s[16:19], s3 offen
    ds_write_b128 v3, v[116:119] offset:2048
    buffer_load_dwordx4 v[116:119], v3, s[16:19], s40 offen offset:2048
    ds_write_b128 v3, v[120:123] offset:3072
    buffer_load_dwordx4 v[120:123], v3, s[16:19], s40 offen offset:3072
    v_mfma_f32_4x4x4_16b_bf16 v[80:83], v[8:9], v[102:103], 0
    v_mfma_f32_4x4x4_16b_bf16 v[76:79], v[8:9], v[100:101], 0
    v_bitop3_b32 v15, v6, v15, v46 bitop3:0xca
    v_bitop3_b32 v14, v6, v14, v47 bitop3:0xca
    v_cmp_lt_u32 s[84:85], v5, v92
    s_nop 0
    v_pk_mul_f32 v[80:81], v[80:81], v[14:15] op_sel:[0,1] op_sel_hi:[1,1]
    v_pk_mul_f32 v[82:83], v[82:83], v[14:15] op_sel:[0,1] op_sel_hi:[1,1]
    v_pk_mul_f32 v[76:77], v[76:77], v[14:15] op_sel:[0,0] op_sel_hi:[1,0]
    v_pk_mul_f32 v[78:79], v[78:79], v[14:15] op_sel:[0,0] op_sel_hi:[1,0]
    v_and_b32 v47, 0x0fffffff, v42
    v_mov_b32 v33, v42
    buffer_load_dwordx4 v[28:31], v47, s[8:11], 0 offen
    buffer_load_dwordx3 v[30:32], v47, s[8:11], 0 offen offset:8
    v_mov_b32 v44, v43
    s_cmp_gt_u32 s37, 1024
    s_cbranch_scc1 L2_xs36
    s_cmp_lg_u32 s43, 0
    s_cbranch_scc1 L2_xa36
L2_xb36:
    v_lshlrev_b32 v89, 16, v96
    v_add_u32 v90, 60, v97
    v_bitop3_b32 v90, v89, v45, v90 bitop3:0x6a
    ds_write_b32 v98, v90 offset:12
    v_lshlrev_b32 v89, 20, v96
    v_add_u32 v90, 40, v97
    v_bitop3_b32 v90, v89, v45, v90 bitop3:0x6a
    ds_write_b32 v98, v90 offset:8
    v_lshlrev_b32 v89, 24, v96
    v_add_u32 v90, 20, v97
    v_bitop3_b32 v90, v89, v45, v90 bitop3:0x6a
    ds_write_b32 v98, v90 offset:4
    v_lshlrev_b32 v89, 28, v96
    v_bitop3_b32 v90, v89, v45, v97 bitop3:0x6a
    ds_write_b32 v98, v90 offset:0
    v_mov_b32_dpp v91, v66 quad_perm:[1,1,1,1] row_mask:0xf bank_mask:0xf
    v_and_b32 v89, 3, v91
    v_and_b32 v97, 0xfffc, v91
    v_sub_u16_dpp v88, v66, v91 quad_perm:[3,3,3,3] row_mask:0xf bank_mask:0xf
    v_mad_u32_u24 v97, v97, 5, v4
    v_add_u32 v99, v88, v89
    v_bfm_b32 v96, v88, v89
    v_cmp_lt_u32 s[58:59], 16, v99
    v_lshlrev_b32 v89, v1, v96
    v_and_b32 v89, v45, v89
    v_cmp_ne_u32 vcc, 0, v89
    v_xor_b32 v90, v97, v89
    s_add_u32 s3, s37, s38
    v_mbcnt_lo_u32_b32 v98, vcc_lo, 0
    v_mbcnt_hi_u32_b32 v98, vcc_hi, v98
    s_bcnt1_i32_b64 s41, vcc
    v_lshl_add_u32 v98, v98, 2, s3
    s_mov_b64 exec, vcc
    ds_write_b32 v98, v90
    s_mov_b64 exec, -1
    s_lshl2_add_u32 s37, s41, s37
    s_cmp_lg_u64 s[58:59], 0
    s_cbranch_scc1 L2_xe36
L2_xr36:
    v_add_u32 v98, s37, v0
    v_mov_b32 v90, -1
    ds_write_b32 v98, v90
    ds_read2st64_b32 v[40:41], v0 offset0:0 offset1:1
    ds_read2st64_b32 v[42:43], v0 offset0:2 offset1:3
    s_sub_u32 s3, s37, 768
    s_cmp_gt_u32 s3, 256
    s_cbranch_scc1 L2_xf36
L2_xg36:
    v_lshrrev_b64 v[64:65], 16, v[64:65]
    v_lshrrev_b64 v[66:67], 16, v[66:67]
    s_setprio 2
    ds_write_b128 v3, v[108:111] offset:0
    s_waitcnt lgkmcnt(12)
    v_cmpx_ne_u64 vcc, v[74:75], v[70:71]
    s_and_b64 s[82:83], vcc, s[80:81]
    s_cbranch_scc1 L2_c37
L2_d37:
    v_mov_b64 v[84:85], v[70:71]
    v_mov_b32 v7, v95
    v_mov_b64 v[86:87], v[74:75]
    s_mov_b64 exec, -1
    s_or_b64 s[80:81], s[80:81], vcc
    v_cmpx_ne_u64 vcc, v[72:73], v[68:69]
    s_and_b64 s[82:83], vcc, s[80:81]
    s_cbranch_scc1 L2_c38
L2_d38:
    v_mov_b64 v[84:85], v[68:69]
    v_mov_b32 v7, v94
    v_mov_b64 v[86:87], v[72:73]
    s_mov_b64 exec, -1
    s_or_b64 s[80:81], s[80:81], vcc
    ds_read_b64 v[70:71], v93
    s_and_b64 exec, s[84:85], s[80:81]
    v_mfma_f32_4x4x4_16b_bf16 v[76:79], v[12:13], v[84:85], 0
    v_mov_b32 v92, v7
    s_andn2_b64 s[80:81], s[80:81], s[84:85]
    v_mfma_f32_4x4x4_16b_bf16 v[76:79], v[10:11], v[86:87], v[76:79]
    s_mov_b64 exec, -1
    ds_read_b64 v[68:69], v92
    s_setprio 1
    s_waitcnt vmcnt(9)
    ds_write_b128 v3, v[112:115] offset:1024
    s_waitcnt lgkmcnt(1)
    v_mfma_f32_4x4x4_16b_bf16 v[80:83], v[10:11], v[70:71], v[80:83]
    v_mfma_f32_4x4x4_16b_bf16 v[76:79], v[10:11], v[68:69], v[76:79]
    v_and_b32 v46, 0x40000000, v39
    v_bitop3_b32 v94, v36, v5, v46 bitop3:0xea
    v_and_b32 v46, 0x80000000, v39
    v_bitop3_b32 v95, v37, v5, v46 bitop3:0xea
    v_perm_b32 v15, v37, v38, s47
    v_bitop3_b32 v46, v37, 0.5, -0.5 bitop3:0xa8
    v_perm_b32 v14, v36, v38, s46
    v_bitop3_b32 v47, v36, 0.5, -0.5 bitop3:0xa8
    v_cvt_pk_bf16_f32 v80, v80, v81
    v_cvt_pk_bf16_f32 v81, v82, v83
    ds_wrxchg_rtn_b64 v[74:75], v93, v[80:81]
    v_cvt_pk_bf16_f32 v76, v76, v77
    v_cvt_pk_bf16_f32 v77, v78, v79
    ds_wrxchg_rtn_b64 v[72:73], v92, v[76:77]
    s_setprio 0
    v_mfma_f32_4x4x4_16b_bf16 v[80:83], v[8:9], v[106:107], 0
    v_mfma_f32_4x4x4_16b_bf16 v[76:79], v[8:9], v[104:105], 0
    v_bitop3_b32 v15, v6, v15, v46 bitop3:0xca
    v_bitop3_b32 v14, v6, v14, v47 bitop3:0xca
    s_nop 1
    v_pk_mul_f32 v[80:81], v[80:81], v[14:15] op_sel:[0,1] op_sel_hi:[1,1]
    v_pk_mul_f32 v[82:83], v[82:83], v[14:15] op_sel:[0,1] op_sel_hi:[1,1]
    v_pk_mul_f32 v[76:77], v[76:77], v[14:15] op_sel:[0,0] op_sel_hi:[1,0]
    v_pk_mul_f32 v[78:79], v[78:79], v[14:15] op_sel:[0,0] op_sel_hi:[1,0]
    s_add_u32 s42, s42, 1
    s_waitcnt lgkmcnt(2)
L2_loop:
    s_barrier
    s_bitcmp1_b32 s36, s42
    s_cbranch_scc1 L2_slow
L2_ret2:
    s_setprio 3
    v_and_b32 v47, 0x0fffffff, v44
    v_mov_b32 v39, v44
    buffer_load_dwordx4 v[34:37], v47, s[8:11], 0 offen
    buffer_load_dwordx3 v[36:38], v47, s[8:11], 0 offen offset:8
    s_waitcnt lgkmcnt(0)
    v_cmpx_ne_u64 vcc, v[74:75], v[70:71]
    s_and_b64 s[82:83], vcc, s[80:81]
    s_cbranch_scc1 L2_c39
L2_d39:
    v_mov_b64 v[84:85], v[70:71]
    v_mov_b32 v7, v93
    v_mov_b64 v[86:87], v[74:75]
    s_mov_b64 exec, -1
    s_or_b64 s[80:81], s[80:81], vcc
    v_cmpx_ne_u64 vcc, v[72:73], v[68:69]
    s_and_b64 s[82:83], vcc, s[80:81]
    s_cbranch_scc1 L2_c40
L2_d40:
    v_mov_b64 v[84:85], v[68:69]
    v_mov_b32 v7, v92
    v_mov_b64 v[86:87], v[72:73]
    s_mov_b64 exec, -1
    s_or_b64 s[80:81], s[80:81], vcc
    ds_read_b64 v[70:71], v95
    ds_read_b64 v[68:69], v94
    s_waitcnt vmcnt(9)
    v_and_b32 v46, 0x20000000, v21
    v_lshrrev_b32 v47, 14, v17
    v_bitop3_b32 v47, v47, v5, v46 bitop3:0xea
    ds_read_b64 v[102:103], v47 offset:63616
    v_bitop3_b32 v93, v17, v5, v46 bitop3:0xea
    v_and_b32 v46, 0x10000000, v21
    v_lshrrev_b32 v47, 14, v16
    v_bitop3_b32 v47, v47, v5, v46 bitop3:0xea
    ds_read_b64 v[100:101], v47 offset:63616
    v_bitop3_b32 v92, v16, v5, v46 bitop3:0xea
    s_waitcnt lgkmcnt(2)
    v_mfma_f32_4x4x4_16b_bf16 v[80:83], v[10:11], v[70:71], v[80:83]
    v_mfma_f32_4x4x4_16b_bf16 v[76:79], v[10:11], v[68:69], v[76:79]
    v_perm_b32 v15, v17, v20, s45
    v_bitop3_b32 v46, v17, 0.5, -0.5 bitop3:0xa8
    v_perm_b32 v14, v16, v20, s44
    v_bitop3_b32 v47, v16, 0.5, -0.5 bitop3:0xa8
    v_cvt_pk_bf16_f32 v80, v80, v81
    v_cvt_pk_bf16_f32 v81, v82, v83
    ds_wrxchg_rtn_b64 v[74:75], v95, v[80:81]
    v_cvt_pk_bf16_f32 v76, v76, v77
    v_cvt_pk_bf16_f32 v77, v78, v79
    ds_wrxchg_rtn_b64 v[72:73], v94, v[76:77]
    s_waitcnt lgkmcnt(2)
    v_mfma_f32_4x4x4_16b_bf16 v[80:83], v[8:9], v[102:103], 0
    v_mfma_f32_4x4x4_16b_bf16 v[76:79], v[8:9], v[100:101], 0
    v_bitop3_b32 v15, v6, v15, v46 bitop3:0xca
    v_bitop3_b32 v14, v6, v14, v47 bitop3:0xca
    v_cmp_lt_u32 s[84:85], v5, v92
    s_nop 0
    v_pk_mul_f32 v[80:81], v[80:81], v[14:15] op_sel:[0,1] op_sel_hi:[1,1]
    v_pk_mul_f32 v[82:83], v[82:83], v[14:15] op_sel:[0,1] op_sel_hi:[1,1]
    v_pk_mul_f32 v[76:77], v[76:77], v[14:15] op_sel:[0,0] op_sel_hi:[1,0]
    v_pk_mul_f32 v[78:79], v[78:79], v[14:15] op_sel:[0,0] op_sel_hi:[1,0]
    buffer_load_dwordx4 v[108:111], v3, s[16:19], s40 offen offset:0
    s_waitcnt lgkmcnt(0)
    v_cmpx_ne_u64 vcc, v[74:75], v[70:71]
    s_and_b64 s[82:83], vcc, s[80:81]
    s_cbranch_scc1 L2_c41
L2_d41:
    v_mov_b64 v[84:85], v[70:71]
    v_mov_b32 v7, v95
    v_mov_b64 v[86:87], v[74:75]
    s_mov_b64 exec, -1
    s_or_b64 s[80:81], s[80:81], vcc
    v_cmpx_ne_u64 vcc, v[72:73], v[68:69]
    s_and_b64 s[82:83], vcc, s[80:81]
    s_cbranch_scc1 L2_c42
L2_d42:
    v_mov_b64 v[84:85], v[68:69]
    v_mov_b32 v7, v94
    v_mov_b64 v[86:87], v[72:73]
    s_mov_b64 exec, -1
    s_or_b64 s[80:81], s[80:81], vcc
    ds_read_b64 v[70:71], v93
    s_and_b64 exec, s[84:85], s[80:81]
    v_mfma_f32_4x4x4_16b_bf16 v[76:79], v[12:13], v[84:85], 0
    v_mov_b32 v92, v7
    s_andn2_b64 s[80:81], s[80:81], s[84:85]
    v_mfma_f32_4x4x4_16b_bf16 v[76:79], v[10:11], v[86:87], v[76:79]
    s_mov_b64 exec, -1
    ds_read_b64 v[68:69], v92
    v_and_b32 v46, 0x80000000, v21
    v_lshrrev_b32 v47, 14, v19
    v_bitop3_b32 v47, v47, v5, v46 bitop3:0xea
    ds_read_b64 v[106:107], v47 offset:63616
    v_bitop3_b32 v95, v19, v5, v46 bitop3:0xea
    v_and_b32 v46, 0x40000000, v21
    v_lshrrev_b32 v47, 14, v18
    v_bitop3_b32 v47, v47, v5, v46 bitop3:0xea
    ds_read_b64 v[104:105], v47 offset:63616
    v_bitop3_b32 v94, v18, v5, v46 bitop3:0xea
    s_waitcnt lgkmcnt(2)
    v_mfma_f32_4x4x4_16b_bf16 v[80:83], v[10:11], v[70:71], v[80:83]
    v_mfma_f32_4x4x4_16b_bf16 v[76:79], v[10:11], v[68:69], v[76:79]
    v_perm_b32 v15, v19, v20, s47
    v_bitop3_b32 v46, v19, 0.5, -0.5 bitop3:0xa8
    v_perm_b32 v14, v18, v20, s46
    v_bitop3_b32 v47, v18, 0.5, -0.5 bitop3:0xa8
    v_cvt_pk_bf16_f32 v80, v80, v81
    v_cvt_pk_bf16_f32 v81, v82, v83
    ds_wrxchg_rtn_b64 v[74:75], v93, v[80:81]
    v_cvt_pk_bf16_f32 v76, v76, v77
    v_cvt_pk_bf16_f32 v77, v78, v79
    ds_wrxchg_rtn_b64 v[72:73], v92, v[76:77]
    s_setprio 2
    s_waitcnt lgkmcnt(2)
    v_mfma_f32_4x4x4_16b_bf16 v[80:83], v[8:9], v[106:107], 0
    v_mfma_f32_4x4x4_16b_bf16 v[76:79], v[8:9], v[104:105], 0
    v_bitop3_b32 v15, v6, v15, v46 bitop3:0xca
    v_bitop3_b32 v14, v6, v14, v47 bitop3:0xca
    s_nop 1
    v_pk_mul_f32 v[80:81], v[80:81], v[14:15] op_sel:[0,1] op_sel_hi:[1,1]
    v_pk_mul_f32 v[82:83], v[82:83], v[14:15] op_sel:[0,1] op_sel_hi:[1,1]
    v_pk_mul_f32 v[76:77], v[76:77], v[14:15] op_sel:[0,0] op_sel_hi:[1,0]
    v_pk_mul_f32 v[78:79], v[78:79], v[14:15] op_sel:[0,0] op_sel_hi:[1,0]
    v_and_b32 v47, 0x0fffffff, v40
    v_mov_b32 v21, v40
    buffer_load_dwordx4 v[16:19], v47, s[8:11], 0 offen
    buffer_load_dwordx3 v[18:20], v47, s[8:11], 0 offen offset:8
    s_waitcnt lgkmcnt(0)
    v_cmpx_ne_u64 vcc, v[74:75], v[70:71]
    s_and_b64 s[82:83], vcc, s[80:81]
    s_cbranch_scc1 L2_c43
L2_d43:
    v_mov_b64 v[84:85], v[70:71]
    v_mov_b32 v7, v93
    v_mov_b64 v[86:87], v[74:75]
    s_mov_b64 exec, -1
    s_or_b64 s[80:81], s[80:81], vcc
    v_cmpx_ne_u64 vcc, v[72:73], v[68:69]
    s_and_b64 s[82:83], vcc, s[80:81]
    s_cbranch_scc1 L2_c44
L2_d44:
    v_mov_b64 v[84:85], v[68:69]
    v_mov_b32 v7, v92
    v_mov_b64 v[86:87], v[72:73]
    s_mov_b64 exec, -1
    s_or_b64 s[80:81], s[80:81], vcc
    ds_read_b64 v[70:71], v95
    ds_read_b64 v[68:69], v94
    s_waitcnt vmcnt(10)
    v_and_b32 v46, 0x20000000, v27
    v_lshrrev_b32 v47, 14, v23
    v_bitop3_b32 v47, v47, v5, v46 bitop3:0xea
    ds_read_b64 v[102:103], v47 offset:63616
    v_bitop3_b32 v93, v23, v5, v46 bitop3:0xea
    v_and_b32 v46, 0x10000000, v27
    v_lshrrev_b32 v47, 14, v22
    v_bitop3_b32 v47, v47, v5, v46 bitop3:0xea
    ds_read_b64 v[100:101], v47 offset:63616
    v_bitop3_b32 v92, v22, v5, v46 bitop3:0xea
    s_waitcnt lgkmcnt(2)
    v_mfma_f32_4x4x4_16b_bf16 v[80:83], v[10:11], v[70:71], v[80:83]
    v_mfma_f32_4x4x4_16b_bf16 v[76:79], v[10:11], v[68:69], v[76:79]
    v_perm_b32 v15, v23, v26, s45
    v_bitop3_b32 v46, v23, 0.5, -0.5 bitop3:0xa8
    v_perm_b32 v14, v22, v26, s44
    v_bitop3_b32 v47, v22, 0.5, -0.5 bitop3:0xa8
    v_cvt_pk_bf16_f32 v80, v80, v81
    v_cvt_pk_bf16_f32 v81, v82, v83
    ds_wrxchg_rtn_b64 v[74:75], v95, v[80:81]
    v_cvt_pk_bf16_f32 v76, v76, v77
    v_cvt_pk_bf16_f32 v77, v78, v79
    ds_wrxchg_rtn_b64 v[72:73], v94, v[76:77]
    s_waitcnt lgkmcnt(2)
    v_mfma_f32_4x4x4_16b_bf16 v[80:83], v[8:9], v[102:103], 0
    v_mfma_f32_4x4x4_16b_bf16 v[76:79], v[8:9], v[100:101], 0
    v_bitop3_b32 v15, v6, v15, v46 bitop3:0xca
    v_bitop3_b32 v14, v6, v14, v47 bitop3:0xca
    v_cmp_lt_u32 s[84:85], v5, v92
    s_nop 0
    v_pk_mul_f32 v[80:81], v[80:81], v[14:15] op_sel:[0,1] op_sel_hi:[1,1]
    v_pk_mul_f32 v[82:83], v[82:83], v[14:15] op_sel:[0,1] op_sel_hi:[1,1]
    v_pk_mul_f32 v[76:77], v[76:77], v[14:15] op_sel:[0,0] op_sel_hi:[1,0]
    v_pk_mul_f32 v[78:79], v[78:79], v[14:15] op_sel:[0,0] op_sel_hi:[1,0]
    v_sub_u16 v88, v56, v48
    v_and_b32 v89, 3, v48
    v_add3_u32 v99, v88, v89, 3
    v_and_b32 v99, -4, v99
    v_max_u32 v99, 4, v99
    v_and_b32 v97, 0xfffc, v48
    v_bfm_b32 v96, v88, v89
    v_add_u32_dpp v91, v99, v99 row_shr:1 row_mask:0xf bank_mask:0xf bound_ctrl:1
    v_mad_u32_u24 v97, v97, 5, v2
    v_cmp_lt_u32 vcc, 16, v99
    v_add_u32_dpp v91, v91, v91 row_shr:2 row_mask:0xf bank_mask:0xf bound_ctrl:1
    v_sub_u32 v98, s38, v99
    v_lshrrev_b64 v[48:49], 16, v[48:49]
    v_add_u32_dpp v91, v91, v91 row_shr:4 row_mask:0xf bank_mask:0xf bound_ctrl:1
    v_lshrrev_b64 v[56:57], 16, v[56:57]
    s_mov_b32 s43, 0
    v_add_u32_dpp v91, v91, v91 row_shr:8 row_mask:0xf bank_mask:0xf bound_ctrl:1
    s_nop 1
    v_add_u32_dpp v91, v91, v91 row_bcast:15 row_mask:0xa bank_mask:0xf
    s_nop 1
    v_add_u32_dpp v91, v91, v91 row_bcast:31 row_mask:0xc bank_mask:0xf
    v_add_u32 v98, v98, v91
    v_readlane_b32 s37, v91, 63
    s_cbranch_vccnz L2_xo45
L2_xp45:
    buffer_load_dwordx4 v[112:115], v3, s[16:19], s40 offen offset:1024
    s_waitcnt lgkmcnt(0)
    v_cmpx_ne_u64 vcc, v[74:75], v[70:71]
    s_and_b64 s[82:83], vcc, s[80:81]
    s_cbranch_scc1 L2_c46
L2_d46:
    v_mov_b64 v[84:85], v[70:71]
    v_mov_b32 v7, v95
    v_mov_b64 v[86:87], v[74:75]
    s_mov_b64 exec, -1
    s_or_b64 s[80:81], s[80:81], vcc
    v_cmpx_ne_u64 vcc, v[72:73], v[68:69]
    s_and_b64 s[82:83], vcc, s[80:81]
    s_cbranch_scc1 L2_c47
L2_d47:
    v_mov_b64 v[84:85], v[68:69]
    v_mov_b32 v7, v94
    v_mov_b64 v[86:87], v[72:73]
    s_mov_b64 exec, -1
    s_or_b64 s[80:81], s[80:81], vcc
    ds_read_b64 v[70:71], v93
    s_and_b64 exec, s[84:85], s[80:81]
    v_mfma_f32_4x4x4_16b_bf16 v[76:79], v[12:13], v[84:85], 0
    v_mov_b32 v92, v7
    s_andn2_b64 s[80:81], s[80:81], s[84:85]
    v_mfma_f32_4x4x4_16b_bf16 v[76:79], v[10:11], v[86:87], v[76:79]
    s_mov_b64 exec, -1
    ds_read_b64 v[68:69], v92
    v_and_b32 v46, 0x80000000, v27
    v_lshrrev_b32 v47, 14, v25
    v_bitop3_b32 v47, v47, v5, v46 bitop3:0xea
    ds_read_b64 v[106:107], v47 offset:63616
    v_bitop3_b32 v95, v25, v5, v46 bitop3:0xea
    v_and_b32 v46, 0x40000000, v27
    v_lshrrev_b32 v47, 14, v24
    v_bitop3_b32 v47, v47, v5, v46 bitop3:0xea
    ds_read_b64 v[104:105], v47 offset:63616
    v_bitop3_b32 v94, v24, v5, v46 bitop3:0xea
    s_waitcnt lgkmcnt(2)
    v_mfma_f32_4x4x4_16b_bf16 v[80:83], v[10:11], v[70:71], v[80:83]
    v_mfma_f32_4x4x4_16b_bf16 v[76:79], v[10:11], v[68:69], v[76:79]
    v_perm_b32 v15, v25, v26, s47
    v_bitop3_b32 v46, v25, 0.5, -0.5 bitop3:0xa8
    v_perm_b32 v14, v24, v26, s46
    v_bitop3_b32 v47, v24, 0.5, -0.5 bitop3:0xa8
    v_cvt_pk_bf16_f32 v80, v80, v81
    v_cvt_pk_bf16_f32 v81, v82, v83
    ds_wrxchg_rtn_b64 v[74:75], v93, v[80:81]
    v_cvt_pk_bf16_f32 v76, v76, v77
    v_cvt_pk_bf16_f32 v77, v78, v79
    ds_wrxchg_rtn_b64 v[72:73], v92, v[76:77]
    s_setprio 1
    s_waitcnt lgkmcnt(2)
    v_mfma_f32_4x4x4_16b_bf16 v[80:83], v[8:9], v[106:107], 0
    v_mfma_f32_4x4x4_16b_bf16 v[76:79], v[8:9], v[104:105], 0
    v_bitop3_b32 v15, v6, v15, v46 bitop3:0xca
    v_bitop3_b32 v14, v6, v14, v47 bitop3:0xca
    s_nop 1
    v_pk_mul_f32 v[80:81], v[80:81], v[14:15] op_sel:[0,1] op_sel_hi:[1,1]
    v_pk_mul_f32 v[82:83], v[82:83], v[14:15] op_sel:[0,1] op_sel_hi:[1,1]
    v_pk_mul_f32 v[76:77], v[76:77], v[14:15] op_sel:[0,0] op_sel_hi:[1,0]
    v_pk_mul_f32 v[78:79], v[78:79], v[14:15] op_sel:[0,0] op_sel_hi:[1,0]
    v_and_b32 v47, 0x0fffffff, v41
    v_mov_b32 v27, v41
    buffer_load_dwordx4 v[22:25], v47, s[8:11], 0 offen
    buffer_load_dwordx3 v[24:26], v47, s[8:11], 0 offen offset:8
    s_waitcnt lgkmcnt(0)
    v_cmpx_ne_u64 vcc, v[74:75], v[70:71]
    s_and_b64 s[82:83], vcc, s[80:81]
    s_cbranch_scc1 L2_c48
L2_d48:
    v_mov_b64 v[84:85], v[70:71]
    v_mov_b32 v7, v93
    v_mov_b64 v[86:87], v[74:75]
    s_mov_b64 exec, -1
    s_or_b64 s[80:81], s[80:81], vcc
    v_cmpx_ne_u64 vcc, v[72:73], v[68:69]
    s_and_b64 s[82:83], vcc, s[80:81]
    s_cbranch_scc1 L2_c49
L2_d49:
    v_mov_b64 v[84:85], v[68:69]
    v_mov_b32 v7, v92
    v_mov_b64 v[86:87], v[72:73]
    s_mov_b64 exec, -1
    s_or_b64 s[80:81], s[80:81], vcc
    ds_read_b64 v[70:71], v95
    ds_read_b64 v[68:69], v94
    s_waitcnt vmcnt(8)
    v_and_b32 v46, 0x20000000, v33
    v_lshrrev_b32 v47, 14, v29
    v_bitop3_b32 v47, v47, v5, v46 bitop3:0xea
    ds_read_b64 v[102:103], v47 offset:63616
    v_bitop3_b32 v93, v29, v5, v46 bitop3:0xea
    v_and_b32 v46, 0x10000000, v33
    v_lshrrev_b32 v47, 14, v28
    v_bitop3_b32 v47, v47, v5, v46 bitop3:0xea
    ds_read_b64 v[100:101], v47 offset:63616
    v_bitop3_b32 v92, v28, v5, v46 bitop3:0xea
    s_waitcnt lgkmcnt(2)
    v_mfma_f32_4x4x4_16b_bf16 v[80:83], v[10:11], v[70:71], v[80:83]
    v_mfma_f32_4x4x4_16b_bf16 v[76:79], v[10:11], v[68:69], v[76:79]
    v_perm_b32 v15, v29, v32, s45
    v_bitop3_b32 v46, v29, 0.5, -0.5 bitop3:0xa8
    v_perm_b32 v14, v28, v32, s44
    v_bitop3_b32 v47, v28, 0.5, -0.5 bitop3:0xa8
    v_cvt_pk_bf16_f32 v80, v80, v81
    v_cvt_pk_bf16_f32 v81, v82, v83
    ds_wrxchg_rtn_b64 v[74:75], v95, v[80:81]
    v_cvt_pk_bf16_f32 v76, v76, v77
    v_cvt_pk_bf16_f32 v77, v78, v79
    ds_wrxchg_rtn_b64 v[72:73], v94, v[76:77]
    s_waitcnt lgkmcnt(2)
    v_mfma_f32_4x4x4_16b_bf16 v[80:83], v[8:9], v[102:103], 0
    v_mfma_f32_4x4x4_16b_bf16 v[76:79], v[8:9], v[100:101], 0
    v_bitop3_b32 v15, v6, v15, v46 bitop3:0xca
    v_bitop3_b32 v14, v6, v14, v47 bitop3:0xca
    v_cmp_lt_u32 s[84:85], v5, v92
    s_nop 0
    v_pk_mul_f32 v[80:81], v[80:81], v[14:15] op_sel:[0,1] op_sel_hi:[1,1]
    v_pk_mul_f32 v[82:83], v[82:83], v[14:15] op_sel:[0,1] op_sel_hi:[1,1]
    v_pk_mul_f32 v[76:77], v[76:77], v[14:15] op_sel:[0,0] op_sel_hi:[1,0]
    v_pk_mul_f32 v[78:79], v[78:79], v[14:15] op_sel:[0,0] op_sel_hi:[1,0]
    s_waitcnt lgkmcnt(0)
    v_cmpx_ne_u64 vcc, v[74:75], v[70:71]
    s_and_b64 s[82:83], vcc, s[80:81]
    s_cbranch_scc1 L2_c50
L2_d50:
    v_mov_b64 v[84:85], v[70:71]
    v_mov_b32 v7, v95
    v_mov_b64 v[86:87], v[74:75]
    s_mov_b64 exec, -1
    s_or_b64 s[80:81], s[80:81], vcc
    v_cmpx_ne_u64 vcc, v[72:73], v[68:69]
    s_and_b64 s[82:83], vcc, s[80:81]
    s_cbranch_scc1 L2_c51
L2_d51:
    v_mov_b64 v[84:85], v[68:69]
    v_mov_b32 v7, v94
    v_mov_b64 v[86:87], v[72:73]
    s_mov_b64 exec, -1
    s_or_b64 s[80:81], s[80:81], vcc
    ds_read_b64 v[70:71], v93
    s_and_b64 exec, s[84:85], s[80:81]
    v_mfma_f32_4x4x4_16b_bf16 v[76:79], v[12:13], v[84:85], 0
    v_mov_b32 v92, v7
    s_andn2_b64 s[80:81], s[80:81], s[84:85]
    v_mfma_f32_4x4x4_16b_bf16 v[76:79], v[10:11], v[86:87], v[76:79]
    s_mov_b64 exec, -1
    ds_read_b64 v[68:69], v92
    v_and_b32 v46, 0x80000000, v33
    v_lshrrev_b32 v47, 14, v31
    v_bitop3_b32 v47, v47, v5, v46 bitop3:0xea
    ds_read_b64 v[106:107], v47 offset:63616
    v_bitop3_b32 v95, v31, v5, v46 bitop3:0xea
    v_and_b32 v46, 0x40000000, v33
    v_lshrrev_b32 v47, 14, v30
    v_bitop3_b32 v47, v47, v5, v46 bitop3:0xea
    ds_read_b64 v[104:105], v47 offset:63616
    v_bitop3_b32 v94, v30, v5, v46 bitop3:0xea
    s_waitcnt lgkmcnt(2)
    v_mfma_f32_4x4x4_16b_bf16 v[80:83], v[10:11], v[70:71], v[80:83]
    v_mfma_f32_4x4x4_16b_bf16 v[76:79], v[10:11], v[68:69], v[76:79]
    v_perm_b32 v15, v31, v32, s47
    v_bitop3_b32 v46, v31, 0.5, -0.5 bitop3:0xa8
    v_perm_b32 v14, v30, v32, s46
    v_bitop3_b32 v47, v30, 0.5, -0.5 bitop3:0xa8
    v_cvt_pk_bf16_f32 v80, v80, v81
    v_cvt_pk_bf16_f32 v81, v82, v83
    ds_wrxchg_rtn_b64 v[74:75], v93, v[80:81]
    v_cvt_pk_bf16_f32 v76, v76, v77
    v_cvt_pk_bf16_f32 v77, v78, v79
    ds_wrxchg_rtn_b64 v[72:73], v92, v[76:77]
    s_setprio 0
    s_waitcnt lgkmcnt(2)
    v_mfma_f32_4x4x4_16b_bf16 v[80:83], v[8:9], v[106:107], 0
    v_mfma_f32_4x4x4_16b_bf16 v[76:79], v[8:9], v[104:105], 0
    v_bitop3_b32 v15, v6, v15, v46 bitop3:0xca
    v_bitop3_b32 v14, v6, v14, v47 bitop3:0xca
    s_nop 1
    v_pk_mul_f32 v[80:81], v[80:81], v[14:15] op_sel:[0,1] op_sel_hi:[1,1]
    v_pk_mul_f32 v[82:83], v[82:83], v[14:15] op_sel:[0,1] op_sel_hi:[1,1]
    v_pk_mul_f32 v[76:77], v[76:77], v[14:15] op_sel:[0,0] op_sel_hi:[1,0]
    v_pk_mul_f32 v[78:79], v[78:79], v[14:15] op_sel:[0,0] op_sel_hi:[1,0]
    s_add_u32 s40, s40, 0xfff29280
    v_and_b32 v47, 0x0fffffff, v42
    v_mov_b32 v33, v42
    buffer_load_dwordx4 v[28:31], v47, s[8:11], 0 offen
    buffer_load_dwordx3 v[30:32], v47, s[8:11], 0 offen offset:8
    s_waitcnt lgkmcnt(0)
    v_cmpx_ne_u64 vcc, v[74:75], v[70:71]
    s_and_b64 s[82:83], vcc, s[80:81]
    s_cbranch_scc1 L2_c52
L2_d52:
    v_mov_b64 v[84:85], v[70:71]
    v_mov_b32 v7, v93
    v_mov_b64 v[86:87], v[74:75]
    s_mov_b64 exec, -1
    s_or_b64 s[80:81], s[80:81], vcc
    v_cmpx_ne_u64 vcc, v[72:73], v[68:69]
    s_and_b64 s[82:83], vcc, s[80:81]
    s_cbranch_scc1 L2_c53
L2_d53:
    v_mov_b64 v[84:85], v[68:69]
    v_mov_b32 v7, v92
    v_mov_b64 v[86:87], v[72:73]
    s_mov_b64 exec, -1
    s_or_b64 s[80:81], s[80:81], vcc
    ds_read_b64 v[70:71], v95
    ds_read_b64 v[68:69], v94
    s_waitcnt vmcnt(8)
    v_and_b32 v46, 0x20000000, v39
    v_lshrrev_b32 v47, 14, v35
    v_bitop3_b32 v47, v47, v5, v46 bitop3:0xea
    ds_read_b64 v[102:103], v47 offset:63616
    v_bitop3_b32 v93, v35, v5, v46 bitop3:0xea
    v_and_b32 v46, 0x10000000, v39
    v_lshrrev_b32 v47, 14, v34
    v_bitop3_b32 v47, v47, v5, v46 bitop3:0xea
    ds_read_b64 v[100:101], v47 offset:63616
    v_bitop3_b32 v92, v34, v5, v46 bitop3:0xea
    v_and_b32 v46, 0x80000000, v39
    v_lshrrev_b32 v47, 14, v37
    v_bitop3_b32 v47, v47, v5, v46 bitop3:0xea
    ds_read_b64 v[106:107], v47 offset:63616
    v_and_b32 v46, 0x40000000, v39
    v_lshrrev_b32 v47, 14, v36
    v_bitop3_b32 v47, v47, v5, v46 bitop3:0xea
    ds_read_b64 v[104:105], v47 offset:63616
    s_waitcnt lgkmcnt(4)
    v_mfma_f32_4x4x4_16b_bf16 v[80:83], v[10:11], v[70:71], v[80:83]
    v_mfma_f32_4x4x4_16b_bf16 v[76:79], v[10:11], v[68:69], v[76:79]
    v_perm_b32 v15, v35, v38, s45
    v_bitop3_b32 v46, v35, 0.5, -0.5 bitop3:0xa8
    v_perm_b32 v14, v34, v38, s44
    v_bitop3_b32 v47, v34, 0.5, -0.5 bitop3:0xa8
    v_cvt_pk_bf16_f32 v80, v80, v81
    v_cvt_pk_bf16_f32 v81, v82, v83
    ds_wrxchg_rtn_b64 v[74:75], v95, v[80:81]
    v_cvt_pk_bf16_f32 v76, v76, v77
    v_cvt_pk_bf16_f32 v77, v78, v79
    ds_wrxchg_rtn_b64 v[72:73], v94, v[76:77]
    s_waitcnt lgkmcnt(2)
    s_barrier
    s_setprio 3
    ds_write_b128 v3, v[124:127] offset:4096
    s_add_u32 s3, s40, 4096
    buffer_load_dwordx4 v[124:127], v3, s[16:19], s3 offen
    ds_write_b128 v3, v[116:119] offset:2048
    buffer_load_dwordx4 v[116:119], v3, s[16:19], s40 offen offset:2048
    ds_write_b128 v3, v[120:123] offset:3072
    buffer_load_dwordx4 v[120:123], v3, s[16:19], s40 offen offset:3072
    v_mfma_f32_4x4x4_16b_bf16 v[80:83], v[8:9], v[102:103], 0
    v_mfma_f32_4x4x4_16b_bf16 v[76:79], v[8:9], v[100:101], 0
    v_bitop3_b32 v15, v6, v15, v46 bitop3:0xca
    v_bitop3_b32 v14, v6, v14, v47 bitop3:0xca
    v_cmp_lt_u32 s[84:85], v5, v92
    s_nop 0
    v_pk_mul_f32 v[80:81], v[80:81], v[14:15] op_sel:[0,1] op_sel_hi:[1,1]
    v_pk_mul_f32 v[82:83], v[82:83], v[14:15] op_sel:[0,1] op_sel_hi:[1,1]
    v_pk_mul_f32 v[76:77], v[76:77], v[14:15] op_sel:[0,0] op_sel_hi:[1,0]
    v_pk_mul_f32 v[78:79], v[78:79], v[14:15] op_sel:[0,0] op_sel_hi:[1,0]
    v_mov_b32 v44, v43
    s_cmp_gt_u32 s37, 1024
    s_cbranch_scc1 L2_xs54
    s_cmp_lg_u32 s43, 0
    s_cbranch_scc1 L2_xa54
L2_xb54:
    v_lshlrev_b32 v89, 16, v96
    v_add_u32 v90, 60, v97
    v_bitop3_b32 v90, v89, v45, v90 bitop3:0x6a
    ds_write_b32 v98, v90 offset:12
    v_lshlrev_b32 v89, 20, v96
    v_add_u32 v90, 40, v97
    v_bitop3_b32 v90, v89, v45, v90 bitop3:0x6a
    ds_write_b32 v98, v90 offset:8
    v_lshlrev_b32 v89, 24, v96
    v_add_u32 v90, 20, v97
    v_bitop3_b32 v90, v89, v45, v90 bitop3:0x6a
    ds_write_b32 v98, v90 offset:4
    v_lshlrev_b32 v89, 28, v96
    v_bitop3_b32 v90, v89, v45, v97 bitop3:0x6a
    ds_write_b32 v98, v90 offset:0
    v_mov_b32_dpp v91, v64 quad_perm:[0,0,0,0] row_mask:0xf bank_mask:0xf
    v_and_b32 v89, 3, v91
    v_and_b32 v97, 0xfffc, v91
    v_sub_u16_dpp v88, v64, v91 quad_perm:[2,2,2,2] row_mask:0xf bank_mask:0xf
    v_mad_u32_u24 v97, v97, 5, v4
    v_add_u32 v99, v88, v89
    v_bfm_b32 v96, v88, v89
    v_cmp_lt_u32 s[58:59], 16, v99
    v_lshlrev_b32 v89, v1, v96
    v_and_b32 v89, v45, v89
    v_cmp_ne_u32 vcc, 0, v89
    v_xor_b32 v90, v97, v89
    s_add_u32 s3, s37, s38
    v_mbcnt_lo_u32_b32 v98, vcc_lo, 0
    v_mbcnt_hi_u32_b32 v98, vcc_hi, v98
    s_bcnt1_i32_b64 s41, vcc
    v_lshl_add_u32 v98, v98, 2, s3
    s_mov_b64 exec, vcc
    ds_write_b32 v98, v90
    s_mov_b64 exec, -1
    s_lshl2_add_u32 s37, s41, s37
    s_cmp_lg_u64 s[58:59], 0
    s_cbranch_scc1 L2_xe54
L2_xr54:
    v_add_u32 v98, s37, v0
    v_mov_b32 v90, -1
    ds_write_b32 v98, v90
    ds_read2st64_b32 v[40:41], v0 offset0:0 offset1:1
    ds_read2st64_b32 v[42:43], v0 offset0:2 offset1:3
    s_sub_u32 s3, s37, 768
    s_cmp_gt_u32 s3, 256
    s_cbranch_scc1 L2_xf54
L2_xg54:
    s_setprio 2
    s_waitcnt vmcnt(10)
    ds_write_b128 v3, v[108:111] offset:0
    s_waitcnt lgkmcnt(12)
    v_cmpx_ne_u64 vcc, v[74:75], v[70:71]
    s_and_b64 s[82:83], vcc, s[80:81]
    s_cbranch_scc1 L2_c55
L2_d55:
    v_mov_b64 v[84:85], v[70:71]
    v_mov_b32 v7, v95
    v_mov_b64 v[86:87], v[74:75]
    s_mov_b64 exec, -1
    s_or_b64 s[80:81], s[80:81], vcc
    v_cmpx_ne_u64 vcc, v[72:73], v[68:69]
    s_and_b64 s[82:83], vcc, s[80:81]
    s_cbranch_scc1 L2_c56
L2_d56:
    v_mov_b64 v[84:85], v[68:69]
    v_mov_b32 v7, v94
    v_mov_b64 v[86:87], v[72:73]
    s_mov_b64 exec, -1
    s_or_b64 s[80:81], s[80:81], vcc
    ds_read_b64 v[70:71], v93
    s_and_b64 exec, s[84:85], s[80:81]
    v_mfma_f32_4x4x4_16b_bf16 v[76:79], v[12:13], v[84:85], 0
    v_mov_b32 v92, v7
    s_andn2_b64 s[80:81], s[80:81], s[84:85]
    v_mfma_f32_4x4x4_16b_bf16 v[76:79], v[10:11], v[86:87], v[76:79]
    s_mov_b64 exec, -1
    ds_read_b64 v[68:69], v92
    s_setprio 1
    s_waitcnt vmcnt(7)
    ds_write_b128 v3, v[112:115] offset:1024
    s_waitcnt lgkmcnt(1)
    v_mfma_f32_4x4x4_16b_bf16 v[80:83], v[10:11], v[70:71], v[80:83]
    v_mfma_f32_4x4x4_16b_bf16 v[76:79], v[10:11], v[68:69], v[76:79]
    v_and_b32 v46, 0x40000000, v39
    v_bitop3_b32 v94, v36, v5, v46 bitop3:0xea
    v_and_b32 v46, 0x80000000, v39
    v_bitop3_b32 v95, v37, v5, v46 bitop3:0xea
    v_perm_b32 v15, v37, v38, s47
    v_bitop3_b32 v46, v37, 0.5, -0.5 bitop3:0xa8
    v_perm_b32 v14, v36, v38, s46
    v_bitop3_b32 v47, v36, 0.5, -0.5 bitop3:0xa8
    v_cvt_pk_bf16_f32 v80, v80, v81
    v_cvt_pk_bf16_f32 v81, v82, v83
    ds_wrxchg_rtn_b64 v[74:75], v93, v[80:81]
    v_cvt_pk_bf16_f32 v76, v76, v77
    v_cvt_pk_bf16_f32 v77, v78, v79
    ds_wrxchg_rtn_b64 v[72:73], v92, v[76:77]
    s_setprio 0
    v_mfma_f32_4x4x4_16b_bf16 v[80:83], v[8:9], v[106:107], 0
    v_mfma_f32_4x4x4_16b_bf16 v[76:79], v[8:9], v[104:105], 0
    v_bitop3_b32 v15, v6, v15, v46 bitop3:0xca
    v_bitop3_b32 v14, v6, v14, v47 bitop3:0xca
    s_nop 1
    v_pk_mul_f32 v[80:81], v[80:81], v[14:15] op_sel:[0,1] op_sel_hi:[1,1]
    v_pk_mul_f32 v[82:83], v[82:83], v[14:15] op_sel:[0,1] op_sel_hi:[1,1]
    v_pk_mul_f32 v[76:77], v[76:77], v[14:15] op_sel:[0,0] op_sel_hi:[1,0]
    v_pk_mul_f32 v[78:79], v[78:79], v[14:15] op_sel:[0,0] op_sel_hi:[1,0]
    s_add_u32 s42, s42, 1
    s_waitcnt lgkmcnt(2)
    s_barrier
    s_bitcmp1_b32 s36, s42
    s_cbranch_scc1 L2_slow
L2_ret3:
    s_setprio 3
    v_and_b32 v47, 0x0fffffff, v44
    v_mov_b32 v39, v44
    buffer_load_dwordx4 v[34:37], v47, s[8:11], 0 offen
    buffer_load_dwordx3 v[36:38], v47, s[8:11], 0 offen offset:8
    s_waitcnt lgkmcnt(0)
    v_cmpx_ne_u64 vcc, v[74:75], v[70:71]
    s_and_b64 s[82:83], vcc, s[80:81]
    s_cbranch_scc1 L2_c57
L2_d57:
    v_mov_b64 v[84:85], v[70:71]
    v_mov_b32 v7, v93
    v_mov_b64 v[86:87], v[74:75]
    s_mov_b64 exec, -1
    s_or_b64 s[80:81], s[80:81], vcc
    v_cmpx_ne_u64 vcc, v[72:73], v[68:69]
    s_and_b64 s[82:83], vcc, s[80:81]
    s_cbranch_scc1 L2_c58
L2_d58:
    v_mov_b64 v[84:85], v[68:69]
    v_mov_b32 v7, v92
    v_mov_b64 v[86:87], v[72:73]
    s_mov_b64 exec, -1
    s_or_b64 s[80:81], s[80:81], vcc
    ds_read_b64 v[70:71], v95
    ds_read_b64 v[68:69], v94
    v_and_b32 v46, 0x20000000, v21
    v_lshrrev_b32 v47, 14, v17
    v_bitop3_b32 v47, v47, v5, v46 bitop3:0xea
    ds_read_b64 v[102:103], v47 offset:63616
    v_bitop3_b32 v93, v17, v5, v46 bitop3:0xea
    v_and_b32 v46, 0x10000000, v21
    v_lshrrev_b32 v47, 14, v16
    v_bitop3_b32 v47, v47, v5, v46 bitop3:0xea
    ds_read_b64 v[100:101], v47 offset:63616
    v_bitop3_b32 v92, v16, v5, v46 bitop3:0xea
    s_waitcnt lgkmcnt(2)
    v_mfma_f32_4x4x4_16b_bf16 v[80:83], v[10:11], v[70:71], v[80:83]
    v_mfma_f32_4x4x4_16b_bf16 v[76:79], v[10:11], v[68:69], v[76:79]
    v_perm_b32 v15, v17, v20, s45
    v_bitop3_b32 v46, v17, 0.5, -0.5 bitop3:0xa8
    v_perm_b32 v14, v16, v20, s44
    v_bitop3_b32 v47, v16, 0.5, -0.5 bitop3:0xa8
    v_cvt_pk_bf16_f32 v80, v80, v81
    v_cvt_pk_bf16_f32 v81, v82, v83
    ds_wrxchg_rtn_b64 v[74:75], v95, v[80:81]
    v_cvt_pk_bf16_f32 v76, v76, v77
    v_cvt_pk_bf16_f32 v77, v78, v79
    ds_wrxchg_rtn_b64 v[72:73], v94, v[76:77]
    s_waitcnt lgkmcnt(2)
    v_mfma_f32_4x4x4_16b_bf16 v[80:83], v[8:9], v[102:103], 0
    v_mfma_f32_4x4x4_16b_bf16 v[76:79], v[8:9], v[100:101], 0
    v_bitop3_b32 v15, v6, v15, v46 bitop3:0xca
    v_bitop3_b32 v14, v6, v14, v47 bitop3:0xca
    v_cmp_lt_u32 s[84:85], v5, v92
    s_nop 0
    v_pk_mul_f32 v[80:81], v[80:81], v[14:15] op_sel:[0,1] op_sel_hi:[1,1]
    v_pk_mul_f32 v[82:83], v[82:83], v[14:15] op_sel:[0,1] op_sel_hi:[1,1]
    v_pk_mul_f32 v[76:77], v[76:77], v[14:15] op_sel:[0,0] op_sel_hi:[1,0]
    v_pk_mul_f32 v[78:79], v[78:79], v[14:15] op_sel:[0,0] op_sel_hi:[1,0]
    buffer_load_dwordx4 v[108:111], v3, s[16:19], s40 offen offset:0
    s_waitcnt lgkmcnt(0)
    v_cmpx_ne_u64 vcc, v[74:75], v[70:71]
    s_and_b64 s[82:83], vcc, s[80:81]
    s_cbranch_scc1 L2_c59
L2_d59:
    v_mov_b64 v[84:85], v[70:71]
    v_mov_b32 v7, v95
    v_mov_b64 v[86:87], v[74:75]
    s_mov_b64 exec, -1
    s_or_b64 s[80:81], s[80:81], vcc
    v_cmpx_ne_u64 vcc, v[72:73], v[68:69]
    s_and_b64 s[82:83], vcc, s[80:81]
    s_cbranch_scc1 L2_c60
L2_d60:
    v_mov_b64 v[84:85], v[68:69]
    v_mov_b32 v7, v94
    v_mov_b64 v[86:87], v[72:73]
    s_mov_b64 exec, -1
    s_or_b64 s[80:81], s[80:81], vcc
    ds_read_b64 v[70:71], v93
    s_and_b64 exec, s[84:85], s[80:81]
    v_mfma_f32_4x4x4_16b_bf16 v[76:79], v[12:13], v[84:85], 0
    v_mov_b32 v92, v7
    s_andn2_b64 s[80:81], s[80:81], s[84:85]
    v_mfma_f32_4x4x4_16b_bf16 v[76:79], v[10:11], v[86:87], v[76:79]
    s_mov_b64 exec, -1
    ds_read_b64 v[68:69], v92
    v_and_b32 v46, 0x80000000, v21
    v_lshrrev_b32 v47, 14, v19
    v_bitop3_b32 v47, v47, v5, v46 bitop3:0xea
    ds_read_b64 v[106:107], v47 offset:63616
    v_bitop3_b32 v95, v19, v5, v46 bitop3:0xea
    v_and_b32 v46, 0x40000000, v21
    v_lshrrev_b32 v47, 14, v18
    v_bitop3_b32 v47, v47, v5, v46 bitop3:0xea
    ds_read_b64 v[104:105], v47 offset:63616
    v_bitop3_b32 v94, v18, v5, v46 bitop3:0xea
    s_waitcnt lgkmcnt(2)
    v_mfma_f32_4x4x4_16b_bf16 v[80:83], v[10:11], v[70:71], v[80:83]
    v_mfma_f32_4x4x4_16b_bf16 v[76:79], v[10:11], v[68:69], v[76:79]
    v_perm_b32 v15, v19, v20, s47
    v_bitop3_b32 v46, v19, 0.5, -0.5 bitop3:0xa8
    v_perm_b32 v14, v18, v20, s46
    v_bitop3_b32 v47, v18, 0.5, -0.5 bitop3:0xa8
    v_cvt_pk_bf16_f32 v80, v80, v81
    v_cvt_pk_bf16_f32 v81, v82, v83
    ds_wrxchg_rtn_b64 v[74:75], v93, v[80:81]
    v_cvt_pk_bf16_f32 v76, v76, v77
    v_cvt_pk_bf16_f32 v77, v78, v79
    ds_wrxchg_rtn_b64 v[72:73], v92, v[76:77]
    s_setprio 2
    s_waitcnt lgkmcnt(2)
    v_mfma_f32_4x4x4_16b_bf16 v[80:83], v[8:9], v[106:107], 0
    v_mfma_f32_4x4x4_16b_bf16 v[76:79], v[8:9], v[104:105], 0
    v_bitop3_b32 v15, v6, v15, v46 bitop3:0xca
    v_bitop3_b32 v14, v6, v14, v47 bitop3:0xca
    s_nop 1
    v_pk_mul_f32 v[80:81], v[80:81], v[14:15] op_sel:[0,1] op_sel_hi:[1,1]
    v_pk_mul_f32 v[82:83], v[82:83], v[14:15] op_sel:[0,1] op_sel_hi:[1,1]
    v_pk_mul_f32 v[76:77], v[76:77], v[14:15] op_sel:[0,0] op_sel_hi:[1,0]
    v_pk_mul_f32 v[78:79], v[78:79], v[14:15] op_sel:[0,0] op_sel_hi:[1,0]
    v_and_b32 v47, 0x0fffffff, v40
    v_mov_b32 v21, v40
    buffer_load_dwordx4 v[16:19], v47, s[8:11], 0 offen
    buffer_load_dwordx3 v[18:20], v47, s[8:11], 0 offen offset:8
    s_waitcnt lgkmcnt(0)
    v_cmpx_ne_u64 vcc, v[74:75], v[70:71]
    s_and_b64 s[82:83], vcc, s[80:81]
    s_cbranch_scc1 L2_c61
L2_d61:
    v_mov_b64 v[84:85], v[70:71]
    v_mov_b32 v7, v93
    v_mov_b64 v[86:87], v[74:75]
    s_mov_b64 exec, -1
    s_or_b64 s[80:81], s[80:81], vcc
    v_cmpx_ne_u64 vcc, v[72:73], v[68:69]
    s_and_b64 s[82:83], vcc, s[80:81]
    s_cbranch_scc1 L2_c62
L2_d62:
    v_mov_b64 v[84:85], v[68:69]
    v_mov_b32 v7, v92
    v_mov_b64 v[86:87], v[72:73]
    s_mov_b64 exec, -1
    s_or_b64 s[80:81], s[80:81], vcc
    ds_read_b64 v[70:71], v95
    ds_read_b64 v[68:69], v94
    s_waitcnt vmcnt(10)
    v_and_b32 v46, 0x20000000, v27
    v_lshrrev_b32 v47, 14, v23
    v_bitop3_b32 v47, v47, v5, v46 bitop3:0xea
    ds_read_b64 v[102:103], v47 offset:63616
    v_bitop3_b32 v93, v23, v5, v46 bitop3:0xea
    v_and_b32 v46, 0x10000000, v27
    v_lshrrev_b32 v47, 14, v22
    v_bitop3_b32 v47, v47, v5, v46 bitop3:0xea
    ds_read_b64 v[100:101], v47 offset:63616
    v_bitop3_b32 v92, v22, v5, v46 bitop3:0xea
    s_waitcnt lgkmcnt(2)
    v_mfma_f32_4x4x4_16b_bf16 v[80:83], v[10:11], v[70:71], v[80:83]
    v_mfma_f32_4x4x4_16b_bf16 v[76:79], v[10:11], v[68:69], v[76:79]
    v_perm_b32 v15, v23, v26, s45
    v_bitop3_b32 v46, v23, 0.5, -0.5 bitop3:0xa8
    v_perm_b32 v14, v22, v26, s44
    v_bitop3_b32 v47, v22, 0.5, -0.5 bitop3:0xa8
    v_cvt_pk_bf16_f32 v80, v80, v81
    v_cvt_pk_bf16_f32 v81, v82, v83
    ds_wrxchg_rtn_b64 v[74:75], v95, v[80:81]
    v_cvt_pk_bf16_f32 v76, v76, v77
    v_cvt_pk_bf16_f32 v77, v78, v79
    ds_wrxchg_rtn_b64 v[72:73], v94, v[76:77]
    s_waitcnt lgkmcnt(2)
    v_mfma_f32_4x4x4_16b_bf16 v[80:83], v[8:9], v[102:103], 0
    v_mfma_f32_4x4x4_16b_bf16 v[76:79], v[8:9], v[100:101], 0
    v_bitop3_b32 v15, v6, v15, v46 bitop3:0xca
    v_bitop3_b32 v14, v6, v14, v47 bitop3:0xca
    v_cmp_lt_u32 s[84:85], v5, v92
    s_nop 0
    v_pk_mul_f32 v[80:81], v[80:81], v[14:15] op_sel:[0,1] op_sel_hi:[1,1]
    v_pk_mul_f32 v[82:83], v[82:83], v[14:15] op_sel:[0,1] op_sel_hi:[1,1]
    v_pk_mul_f32 v[76:77], v[76:77], v[14:15] op_sel:[0,0] op_sel_hi:[1,0]
    v_pk_mul_f32 v[78:79], v[78:79], v[14:15] op_sel:[0,0] op_sel_hi:[1,0]
    v_sub_u16 v88, v58, v50
    v_and_b32 v89, 3, v50
    v_add3_u32 v99, v88, v89, 3
    v_and_b32 v99, -4, v99
    v_max_u32 v99, 4, v99
    v_and_b32 v97, 0xfffc, v50
    v_bfm_b32 v96, v88, v89
    v_add_u32_dpp v91, v99, v99 row_shr:1 row_mask:0xf bank_mask:0xf bound_ctrl:1
    v_mad_u32_u24 v97, v97, 5, v2
    v_cmp_lt_u32 vcc, 16, v99
    v_add_u32_dpp v91, v91, v91 row_shr:2 row_mask:0xf bank_mask:0xf bound_ctrl:1
    v_sub_u32 v98, s38, v99
    v_lshrrev_b64 v[50:51], 16, v[50:51]
    v_add_u32_dpp v91, v91, v91 row_shr:4 row_mask:0xf bank_mask:0xf bound_ctrl:1
    v_lshrrev_b64 v[58:59], 16, v[58:59]
    s_mov_b32 s43, 0
    v_add_u32_dpp v91, v91, v91 row_shr:8 row_mask:0xf bank_mask:0xf bound_ctrl:1
    s_nop 1
    v_add_u32_dpp v91, v91, v91 row_bcast:15 row_mask:0xa bank_mask:0xf
    s_nop 1
    v_add_u32_dpp v91, v91, v91 row_bcast:31 row_mask:0xc bank_mask:0xf
    v_add_u32 v98, v98, v91
    v_readlane_b32 s37, v91, 63
    s_cbranch_vccnz L2_xo63
L2_xp63:
    buffer_load_dwordx4 v[112:115], v3, s[16:19], s40 offen offset:1024
    s_waitcnt lgkmcnt(0)
    v_cmpx_ne_u64 vcc, v[74:75], v[70:71]
    s_and_b64 s[82:83], vcc, s[80:81]
    s_cbranch_scc1 L2_c64
L2_d64:
    v_mov_b64 v[84:85], v[70:71]
    v_mov_b32 v7, v95
    v_mov_b64 v[86:87], v[74:75]
    s_mov_b64 exec, -1
    s_or_b64 s[80:81], s[80:81], vcc
    v_cmpx_ne_u64 vcc, v[72:73], v[68:69]
    s_and_b64 s[82:83], vcc, s[80:81]
    s_cbranch_scc1 L2_c65
L2_d65:
    v_mov_b64 v[84:85], v[68:69]
    v_mov_b32 v7, v94
    v_mov_b64 v[86:87], v[72:73]
    s_mov_b64 exec, -1
    s_or_b64 s[80:81], s[80:81], vcc
    ds_read_b64 v[70:71], v93
    s_and_b64 exec, s[84:85], s[80:81]
    v_mfma_f32_4x4x4_16b_bf16 v[76:79], v[12:13], v[84:85], 0
    v_mov_b32 v92, v7
    s_andn2_b64 s[80:81], s[80:81], s[84:85]
    v_mfma_f32_4x4x4_16b_bf16 v[76:79], v[10:11], v[86:87], v[76:79]
    s_mov_b64 exec, -1
    ds_read_b64 v[68:69], v92
    v_and_b32 v46, 0x80000000, v27
    v_lshrrev_b32 v47, 14, v25
    v_bitop3_b32 v47, v47, v5, v46 bitop3:0xea
    ds_read_b64 v[106:107], v47 offset:63616
    v_bitop3_b32 v95, v25, v5, v46 bitop3:0xea
    v_and_b32 v46, 0x40000000, v27
    v_lshrrev_b32 v47, 14, v24
    v_bitop3_b32 v47, v47, v5, v46 bitop3:0xea
    ds_read_b64 v[104:105], v47 offset:63616
    v_bitop3_b32 v94, v24, v5, v46 bitop3:0xea
    s_waitcnt lgkmcnt(2)
    v_mfma_f32_4x4x4_16b_bf16 v[80:83], v[10:11], v[70:71], v[80:83]
    v_mfma_f32_4x4x4_16b_bf16 v[76:79], v[10:11], v[68:69], v[76:79]
    v_perm_b32 v15, v25, v26, s47
    v_bitop3_b32 v46, v25, 0.5, -0.5 bitop3:0xa8
    v_perm_b32 v14, v24, v26, s46
    v_bitop3_b32 v47, v24, 0.5, -0.5 bitop3:0xa8
    v_cvt_pk_bf16_f32 v80, v80, v81
    v_cvt_pk_bf16_f32 v81, v82, v83
    ds_wrxchg_rtn_b64 v[74:75], v93, v[80:81]
    v_cvt_pk_bf16_f32 v76, v76, v77
    v_cvt_pk_bf16_f32 v77, v78, v79
    ds_wrxchg_rtn_b64 v[72:73], v92, v[76:77]
    s_setprio 1
    s_waitcnt lgkmcnt(2)
    v_mfma_f32_4x4x4_16b_bf16 v[80:83], v[8:9], v[106:107], 0
    v_mfma_f32_4x4x4_16b_bf16 v[76:79], v[8:9], v[104:105], 0
    v_bitop3_b32 v15, v6, v15, v46 bitop3:0xca
    v_bitop3_b32 v14, v6, v14, v47 bitop3:0xca
    s_nop 1
    v_pk_mul_f32 v[80:81], v[80:81], v[14:15] op_sel:[0,1] op_sel_hi:[1,1]
    v_pk_mul_f32 v[82:83], v[82:83], v[14:15] op_sel:[0,1] op_sel_hi:[1,1]
    v_pk_mul_f32 v[76:77], v[76:77], v[14:15] op_sel:[0,0] op_sel_hi:[1,0]
    v_pk_mul_f32 v[78:79], v[78:79], v[14:15] op_sel:[0,0] op_sel_hi:[1,0]
    v_and_b32 v47, 0x0fffffff, v41
    v_mov_b32 v27, v41
    buffer_load_dwordx4 v[22:25], v47, s[8:11], 0 offen
    buffer_load_dwordx3 v[24:26], v47, s[8:11], 0 offen offset:8
    s_waitcnt lgkmcnt(0)
    v_cmpx_ne_u64 vcc, v[74:75], v[70:71]
    s_and_b64 s[82:83], vcc, s[80:81]
    s_cbranch_scc1 L2_c66
L2_d66:
    v_mov_b64 v[84:85], v[70:71]
    v_mov_b32 v7, v93
    v_mov_b64 v[86:87], v[74:75]
    s_mov_b64 exec, -1
    s_or_b64 s[80:81], s[80:81], vcc
    v_cmpx_ne_u64 vcc, v[72:73], v[68:69]
    s_and_b64 s[82:83], vcc, s[80:81]
    s_cbranch_scc1 L2_c67
L2_d67:
    v_mov_b64 v[84:85], v[68:69]
    v_mov_b32 v7, v92
    v_mov_b64 v[86:87], v[72:73]
    s_mov_b64 exec, -1
    s_or_b64 s[80:81], s[80:81], vcc
    ds_read_b64 v[70:71], v95
    ds_read_b64 v[68:69], v94
    s_waitcnt vmcnt(11)
    v_and_b32 v46, 0x20000000, v33
    v_lshrrev_b32 v47, 14, v29
    v_bitop3_b32 v47, v47, v5, v46 bitop3:0xea
    ds_read_b64 v[102:103], v47 offset:63616
    v_bitop3_b32 v93, v29, v5, v46 bitop3:0xea
    v_and_b32 v46, 0x10000000, v33
    v_lshrrev_b32 v47, 14, v28
    v_bitop3_b32 v47, v47, v5, v46 bitop3:0xea
    ds_read_b64 v[100:101], v47 offset:63616
    v_bitop3_b32 v92, v28, v5, v46 bitop3:0xea
    s_waitcnt lgkmcnt(2)
    v_mfma_f32_4x4x4_16b_bf16 v[80:83], v[10:11], v[70:71], v[80:83]
    v_mfma_f32_4x4x4_16b_bf16 v[76:79], v[10:11], v[68:69], v[76:79]
    v_perm_b32 v15, v29, v32, s45
    v_bitop3_b32 v46, v29, 0.5, -0.5 bitop3:0xa8
    v_perm_b32 v14, v28, v32, s44
    v_bitop3_b32 v47, v28, 0.5, -0.5 bitop3:0xa8
    v_cvt_pk_bf16_f32 v80, v80, v81
    v_cvt_pk_bf16_f32 v81, v82, v83
    ds_wrxchg_rtn_b64 v[74:75], v95, v[80:81]
    v_cvt_pk_bf16_f32 v76, v76, v77
    v_cvt_pk_bf16_f32 v77, v78, v79
    ds_wrxchg_rtn_b64 v[72:73], v94, v[76:77]
    s_waitcnt lgkmcnt(2)
    v_mfma_f32_4x4x4_16b_bf16 v[80:83], v[8:9], v[102:103], 0
    v_mfma_f32_4x4x4_16b_bf16 v[76:79], v[8:9], v[100:101], 0
    v_bitop3_b32 v15, v6, v15, v46 bitop3:0xca
    v_bitop3_b32 v14, v6, v14, v47 bitop3:0xca
    v_cmp_lt_u32 s[84:85], v5, v92
    s_nop 0
    v_pk_mul_f32 v[80:81], v[80:81], v[14:15] op_sel:[0,1] op_sel_hi:[1,1]
    v_pk_mul_f32 v[82:83], v[82:83], v[14:15] op_sel:[0,1] op_sel_hi:[1,1]
    v_pk_mul_f32 v[76:77], v[76:77], v[14:15] op_sel:[0,0] op_sel_hi:[1,0]
    v_pk_mul_f32 v[78:79], v[78:79], v[14:15] op_sel:[0,0] op_sel_hi:[1,0]
    s_waitcnt lgkmcnt(0)
    v_cmpx_ne_u64 vcc, v[74:75], v[70:71]
    s_and_b64 s[82:83], vcc, s[80:81]
    s_cbranch_scc1 L2_c68
L2_d68:
    v_mov_b64 v[84:85], v[70:71]
    v_mov_b32 v7, v95
    v_mov_b64 v[86:87], v[74:75]
    s_mov_b64 exec, -1
    s_or_b64 s[80:81], s[80:81], vcc
    v_cmpx_ne_u64 vcc, v[72:73], v[68:69]
    s_and_b64 s[82:83], vcc, s[80:81]
    s_cbranch_scc1 L2_c69
L2_d69:
    v_mov_b64 v[84:85], v[68:69]
    v_mov_b32 v7, v94
    v_mov_b64 v[86:87], v[72:73]
    s_mov_b64 exec, -1
    s_or_b64 s[80:81], s[80:81], vcc
    ds_read_b64 v[70:71], v93
    s_and_b64 exec, s[84:85], s[80:81]
    v_mfma_f32_4x4x4_16b_bf16 v[76:79], v[12:13], v[84:85], 0
    v_mov_b32 v92, v7
    s_andn2_b64 s[80:81], s[80:81], s[84:85]
    v_mfma_f32_4x4x4_16b_bf16 v[76:79], v[10:11], v[86:87], v[76:79]
    s_mov_b64 exec, -1
    ds_read_b64 v[68:69], v92
    v_and_b32 v46, 0x80000000, v33
    v_lshrrev_b32 v47, 14, v31
    v_bitop3_b32 v47, v47, v5, v46 bitop3:0xea
    ds_read_b64 v[106:107], v47 offset:63616
    v_bitop3_b32 v95, v31, v5, v46 bitop3:0xea
    v_and_b32 v46, 0x40000000, v33
    v_lshrrev_b32 v47, 14, v30
    v_bitop3_b32 v47, v47, v5, v46 bitop3:0xea
    ds_read_b64 v[104:105], v47 offset:63616
    v_bitop3_b32 v94, v30, v5, v46 bitop3:0xea
    s_waitcnt lgkmcnt(2)
    v_mfma_f32_4x4x4_16b_bf16 v[80:83], v[10:11], v[70:71], v[80:83]
    v_mfma_f32_4x4x4_16b_bf16 v[76:79], v[10:11], v[68:69], v[76:79]
    v_perm_b32 v15, v31, v32, s47
    v_bitop3_b32 v46, v31, 0.5, -0.5 bitop3:0xa8
    v_perm_b32 v14, v30, v32, s46
    v_bitop3_b32 v47, v30, 0.5, -0.5 bitop3:0xa8
    v_cvt_pk_bf16_f32 v80, v80, v81
    v_cvt_pk_bf16_f32 v81, v82, v83
    ds_wrxchg_rtn_b64 v[74:75], v93, v[80:81]
    v_cvt_pk_bf16_f32 v76, v76, v77
    v_cvt_pk_bf16_f32 v77, v78, v79
    ds_wrxchg_rtn_b64 v[72:73], v92, v[76:77]
    s_setprio 0
    s_waitcnt lgkmcnt(2)
    v_mfma_f32_4x4x4_16b_bf16 v[80:83], v[8:9], v[106:107], 0
    v_mfma_f32_4x4x4_16b_bf16 v[76:79], v[8:9], v[104:105], 0
    v_bitop3_b32 v15, v6, v15, v46 bitop3:0xca
    v_bitop3_b32 v14, v6, v14, v47 bitop3:0xca
    s_nop 1
    v_pk_mul_f32 v[80:81], v[80:81], v[14:15] op_sel:[0,1] op_sel_hi:[1,1]
    v_pk_mul_f32 v[82:83], v[82:83], v[14:15] op_sel:[0,1] op_sel_hi:[1,1]
    v_pk_mul_f32 v[76:77], v[76:77], v[14:15] op_sel:[0,0] op_sel_hi:[1,0]
    v_pk_mul_f32 v[78:79], v[78:79], v[14:15] op_sel:[0,0] op_sel_hi:[1,0]
    s_add_u32 s40, s40, 0x4e200
    v_and_b32 v47, 0x0fffffff, v42
    v_mov_b32 v33, v42
    buffer_load_dwordx4 v[28:31], v47, s[8:11], 0 offen
    buffer_load_dwordx3 v[30:32], v47, s[8:11], 0 offen offset:8
    s_waitcnt lgkmcnt(0)
    v_cmpx_ne_u64 vcc, v[74:75], v[70:71]
    s_and_b64 s[82:83], vcc, s[80:81]
    s_cbranch_scc1 L2_c70
L2_d70:
    v_mov_b64 v[84:85], v[70:71]
    v_mov_b32 v7, v93
    v_mov_b64 v[86:87], v[74:75]
    s_mov_b64 exec, -1
    s_or_b64 s[80:81], s[80:81], vcc
    v_cmpx_ne_u64 vcc, v[72:73], v[68:69]
    s_and_b64 s[82:83], vcc, s[80:81]
    s_cbranch_scc1 L2_c71
L2_d71:
    v_mov_b64 v[84:85], v[68:69]
    v_mov_b32 v7, v92
    v_mov_b64 v[86:87], v[72:73]
    s_mov_b64 exec, -1
    s_or_b64 s[80:81], s[80:81], vcc
    ds_read_b64 v[70:71], v95
    ds_read_b64 v[68:69], v94
    s_waitcnt vmcnt(8)
    v_and_b32 v46, 0x20000000, v39
    v_lshrrev_b32 v47, 14, v35
    v_bitop3_b32 v47, v47, v5, v46 bitop3:0xea
    ds_read_b64 v[102:103], v47 offset:63616
    v_bitop3_b32 v93, v35, v5, v46 bitop3:0xea
    v_and_b32 v46, 0x10000000, v39
    v_lshrrev_b32 v47, 14, v34
    v_bitop3_b32 v47, v47, v5, v46 bitop3:0xea
    ds_read_b64 v[100:101], v47 offset:63616
    v_bitop3_b32 v92, v34, v5, v46 bitop3:0xea
    v_and_b32 v46, 0x80000000, v39
    v_lshrrev_b32 v47, 14, v37
    v_bitop3_b32 v47, v47, v5, v46 bitop3:0xea
    ds_read_b64 v[106:107], v47 offset:63616
    v_and_b32 v46, 0x40000000, v39
    v_lshrrev_b32 v47, 14, v36
    v_bitop3_b32 v47, v47, v5, v46 bitop3:0xea
    ds_read_b64 v[104:105], v47 offset:63616
    s_waitcnt lgkmcnt(4)
    v_mfma_f32_4x4x4_16b_bf16 v[80:83], v[10:11], v[70:71], v[80:83]
    v_mfma_f32_4x4x4_16b_bf16 v[76:79], v[10:11], v[68:69], v[76:79]
    v_perm_b32 v15, v35, v38, s45
    v_bitop3_b32 v46, v35, 0.5, -0.5 bitop3:0xa8
    v_perm_b32 v14, v34, v38, s44
    v_bitop3_b32 v47, v34, 0.5, -0.5 bitop3:0xa8
    v_cvt_pk_bf16_f32 v80, v80, v81
    v_cvt_pk_bf16_f32 v81, v82, v83
    ds_wrxchg_rtn_b64 v[74:75], v95, v[80:81]
    v_cvt_pk_bf16_f32 v76, v76, v77
    v_cvt_pk_bf16_f32 v77, v78, v79
    ds_wrxchg_rtn_b64 v[72:73], v94, v[76:77]
    s_waitcnt lgkmcnt(2)
    s_barrier
    s_setprio 3
    ds_write_b128 v3, v[124:127] offset:4096
    s_add_u32 s3, s40, 4096
    buffer_load_dwordx4 v[124:127], v3, s[16:19], s3 offen
    ds_write_b128 v3, v[116:119] offset:2048
    buffer_load_dwordx4 v[116:119], v3, s[16:19], s40 offen offset:2048
    ds_write_b128 v3, v[120:123] offset:3072
    buffer_load_dwordx4 v[120:123], v3, s[16:19], s40 offen offset:3072
    v_mfma_f32_4x4x4_16b_bf16 v[80:83], v[8:9], v[102:103], 0
    v_mfma_f32_4x4x4_16b_bf16 v[76:79], v[8:9], v[100:101], 0
    v_bitop3_b32 v15, v6, v15, v46 bitop3:0xca
    v_bitop3_b32 v14, v6, v14, v47 bitop3:0xca
    v_cmp_lt_u32 s[84:85], v5, v92
    s_nop 0
    v_pk_mul_f32 v[80:81], v[80:81], v[14:15] op_sel:[0,1] op_sel_hi:[1,1]
    v_pk_mul_f32 v[82:83], v[82:83], v[14:15] op_sel:[0,1] op_sel_hi:[1,1]
    v_pk_mul_f32 v[76:77], v[76:77], v[14:15] op_sel:[0,0] op_sel_hi:[1,0]
    v_pk_mul_f32 v[78:79], v[78:79], v[14:15] op_sel:[0,0] op_sel_hi:[1,0]
    v_mov_b32 v44, v43
    s_cmp_gt_u32 s37, 1024
    s_cbranch_scc1 L2_xs72
    s_cmp_lg_u32 s43, 0
    s_cbranch_scc1 L2_xa72
L2_xb72:
    v_lshlrev_b32 v89, 16, v96
    v_add_u32 v90, 60, v97
    v_bitop3_b32 v90, v89, v45, v90 bitop3:0x6a
    ds_write_b32 v98, v90 offset:12
    v_lshlrev_b32 v89, 20, v96
    v_add_u32 v90, 40, v97
    v_bitop3_b32 v90, v89, v45, v90 bitop3:0x6a
    ds_write_b32 v98, v90 offset:8
    v_lshlrev_b32 v89, 24, v96
    v_add_u32 v90, 20, v97
    v_bitop3_b32 v90, v89, v45, v90 bitop3:0x6a
    ds_write_b32 v98, v90 offset:4
    v_lshlrev_b32 v89, 28, v96
    v_bitop3_b32 v90, v89, v45, v97 bitop3:0x6a
    ds_write_b32 v98, v90 offset:0
    v_mov_b32_dpp v91, v66 quad_perm:[0,0,0,0] row_mask:0xf bank_mask:0xf
    v_and_b32 v89, 3, v91
    v_and_b32 v97, 0xfffc, v91
    v_sub_u16_dpp v88, v66, v91 quad_perm:[2,2,2,2] row_mask:0xf bank_mask:0xf
    v_mad_u32_u24 v97, v97, 5, v4
    v_add_u32 v99, v88, v89
    v_bfm_b32 v96, v88, v89
    v_cmp_lt_u32 s[58:59], 16, v99
    v_lshlrev_b32 v89, v1, v96
    v_and_b32 v89, v45, v89
    v_cmp_ne_u32 vcc, 0, v89
    v_xor_b32 v90, v97, v89
    s_add_u32 s3, s37, s38
    v_mbcnt_lo_u32_b32 v98, vcc_lo, 0
    v_mbcnt_hi_u32_b32 v98, vcc_hi, v98
    s_bcnt1_i32_b64 s41, vcc
    v_lshl_add_u32 v98, v98, 2, s3
    s_mov_b64 exec, vcc
    ds_write_b32 v98, v90
    s_mov_b64 exec, -1
    s_lshl2_add_u32 s37, s41, s37
    s_cmp_lg_u64 s[58:59], 0
    s_cbranch_scc1 L2_xe72
L2_xr72:
    v_add_u32 v98, s37, v0
    v_mov_b32 v90, -1
    ds_write_b32 v98, v90
    ds_read2st64_b32 v[40:41], v0 offset0:0 offset1:1
    ds_read2st64_b32 v[42:43], v0 offset0:2 offset1:3
    s_sub_u32 s3, s37, 768
    s_cmp_gt_u32 s3, 256
    s_cbranch_scc1 L2_xf72
L2_xg72:
    s_setprio 2
    s_waitcnt vmcnt(10)
    ds_write_b128 v3, v[108:111] offset:0
    s_waitcnt lgkmcnt(12)
    v_cmpx_ne_u64 vcc, v[74:75], v[70:71]
    s_and_b64 s[82:83], vcc, s[80:81]
    s_cbranch_scc1 L2_c73
L2_d73:
    v_mov_b64 v[84:85], v[70:71]
    v_mov_b32 v7, v95
    v_mov_b64 v[86:87], v[74:75]
    s_mov_b64 exec, -1
    s_or_b64 s[80:81], s[80:81], vcc
    v_cmpx_ne_u64 vcc, v[72:73], v[68:69]
    s_and_b64 s[82:83], vcc, s[80:81]
    s_cbranch_scc1 L2_c74
L2_d74:
    v_mov_b64 v[84:85], v[68:69]
    v_mov_b32 v7, v94
    v_mov_b64 v[86:87], v[72:73]
    s_mov_b64 exec, -1
    s_or_b64 s[80:81], s[80:81], vcc
    ds_read_b64 v[70:71], v93
    s_and_b64 exec, s[84:85], s[80:81]
    v_mfma_f32_4x4x4_16b_bf16 v[76:79], v[12:13], v[84:85], 0
    v_mov_b32 v92, v7
    s_andn2_b64 s[80:81], s[80:81], s[84:85]
    v_mfma_f32_4x4x4_16b_bf16 v[76:79], v[10:11], v[86:87], v[76:79]
    s_mov_b64 exec, -1
    ds_read_b64 v[68:69], v92
    s_setprio 1
    s_waitcnt vmcnt(7)
    ds_write_b128 v3, v[112:115] offset:1024
    s_waitcnt lgkmcnt(1)
    v_mfma_f32_4x4x4_16b_bf16 v[80:83], v[10:11], v[70:71], v[80:83]
    v_mfma_f32_4x4x4_16b_bf16 v[76:79], v[10:11], v[68:69], v[76:79]
    v_and_b32 v46, 0x40000000, v39
    v_bitop3_b32 v94, v36, v5, v46 bitop3:0xea
    v_and_b32 v46, 0x80000000, v39
    v_bitop3_b32 v95, v37, v5, v46 bitop3:0xea
    v_perm_b32 v15, v37, v38, s47
    v_bitop3_b32 v46, v37, 0.5, -0.5 bitop3:0xa8
    v_perm_b32 v14, v36, v38, s46
    v_bitop3_b32 v47, v36, 0.5, -0.5 bitop3:0xa8
    v_cvt_pk_bf16_f32 v80, v80, v81
    v_cvt_pk_bf16_f32 v81, v82, v83
    ds_wrxchg_rtn_b64 v[74:75], v93, v[80:81]
    v_cvt_pk_bf16_f32 v76, v76, v77
    v_cvt_pk_bf16_f32 v77, v78, v79
    ds_wrxchg_rtn_b64 v[72:73], v92, v[76:77]
    s_setprio 0
    v_mfma_f32_4x4x4_16b_bf16 v[80:83], v[8:9], v[106:107], 0
    v_mfma_f32_4x4x4_16b_bf16 v[76:79], v[8:9], v[104:105], 0
    v_bitop3_b32 v15, v6, v15, v46 bitop3:0xca
    v_bitop3_b32 v14, v6, v14, v47 bitop3:0xca
    s_nop 1
    v_pk_mul_f32 v[80:81], v[80:81], v[14:15] op_sel:[0,1] op_sel_hi:[1,1]
    v_pk_mul_f32 v[82:83], v[82:83], v[14:15] op_sel:[0,1] op_sel_hi:[1,1]
    v_pk_mul_f32 v[76:77], v[76:77], v[14:15] op_sel:[0,0] op_sel_hi:[1,0]
    v_pk_mul_f32 v[78:79], v[78:79], v[14:15] op_sel:[0,0] op_sel_hi:[1,0]
    s_add_u32 s42, s42, 1
    s_waitcnt lgkmcnt(2)
    s_barrier
    s_bitcmp1_b32 s36, s42
    s_cbranch_scc1 L2_slow
L2_ret4:
    s_setprio 3
    v_and_b32 v47, 0x0fffffff, v44
    v_mov_b32 v39, v44
    buffer_load_dwordx4 v[34:37], v47, s[8:11], 0 offen
    buffer_load_dwordx3 v[36:38], v47, s[8:11], 0 offen offset:8
    s_waitcnt lgkmcnt(0)
    v_cmpx_ne_u64 vcc, v[74:75], v[70:71]
    s_and_b64 s[82:83], vcc, s[80:81]
    s_cbranch_scc1 L2_c75
L2_d75:
    v_mov_b64 v[84:85], v[70:71]
    v_mov_b32 v7, v93
    v_mov_b64 v[86:87], v[74:75]
    s_mov_b64 exec, -1
    s_or_b64 s[80:81], s[80:81], vcc
    v_cmpx_ne_u64 vcc, v[72:73], v[68:69]
    s_and_b64 s[82:83], vcc, s[80:81]
    s_cbranch_scc1 L2_c76
L2_d76:
    v_mov_b64 v[84:85], v[68:69]
    v_mov_b32 v7, v92
    v_mov_b64 v[86:87], v[72:73]
    s_mov_b64 exec, -1
    s_or_b64 s[80:81], s[80:81], vcc
    ds_read_b64 v[70:71], v95
    ds_read_b64 v[68:69], v94
    v_and_b32 v46, 0x20000000, v21
    v_lshrrev_b32 v47, 14, v17
    v_bitop3_b32 v47, v47, v5, v46 bitop3:0xea
    ds_read_b64 v[102:103], v47 offset:63616
    v_bitop3_b32 v93, v17, v5, v46 bitop3:0xea
    v_and_b32 v46, 0x10000000, v21
    v_lshrrev_b32 v47, 14, v16
    v_bitop3_b32 v47, v47, v5, v46 bitop3:0xea
    ds_read_b64 v[100:101], v47 offset:63616
    v_bitop3_b32 v92, v16, v5, v46 bitop3:0xea
    s_waitcnt lgkmcnt(2)
    v_mfma_f32_4x4x4_16b_bf16 v[80:83], v[10:11], v[70:71], v[80:83]
    v_mfma_f32_4x4x4_16b_bf16 v[76:79], v[10:11], v[68:69], v[76:79]
    v_perm_b32 v15, v17, v20, s45
    v_bitop3_b32 v46, v17, 0.5, -0.5 bitop3:0xa8
    v_perm_b32 v14, v16, v20, s44
    v_bitop3_b32 v47, v16, 0.5, -0.5 bitop3:0xa8
    v_cvt_pk_bf16_f32 v80, v80, v81
    v_cvt_pk_bf16_f32 v81, v82, v83
    ds_wrxchg_rtn_b64 v[74:75], v95, v[80:81]
    v_cvt_pk_bf16_f32 v76, v76, v77
    v_cvt_pk_bf16_f32 v77, v78, v79
    ds_wrxchg_rtn_b64 v[72:73], v94, v[76:77]
    s_waitcnt lgkmcnt(2)
    v_mfma_f32_4x4x4_16b_bf16 v[80:83], v[8:9], v[102:103], 0
    v_mfma_f32_4x4x4_16b_bf16 v[76:79], v[8:9], v[100:101], 0
    v_bitop3_b32 v15, v6, v15, v46 bitop3:0xca
    v_bitop3_b32 v14, v6, v14, v47 bitop3:0xca
    v_cmp_lt_u32 s[84:85], v5, v92
    s_nop 0
    v_pk_mul_f32 v[80:81], v[80:81], v[14:15] op_sel:[0,1] op_sel_hi:[1,1]
    v_pk_mul_f32 v[82:83], v[82:83], v[14:15] op_sel:[0,1] op_sel_hi:[1,1]
    v_pk_mul_f32 v[76:77], v[76:77], v[14:15] op_sel:[0,0] op_sel_hi:[1,0]
    v_pk_mul_f32 v[78:79], v[78:79], v[14:15] op_sel:[0,0] op_sel_hi:[1,0]
    buffer_load_dwordx4 v[108:111], v3, s[16:19], s40 offen offset:0
    s_waitcnt lgkmcnt(0)
    v_cmpx_ne_u64 vcc, v[74:75], v[70:71]
    s_and_b64 s[82:83], vcc, s[80:81]
    s_cbranch_scc1 L2_c77
L2_d77:
    v_mov_b64 v[84:85], v[70:71]
    v_mov_b32 v7, v95
    v_mov_b64 v[86:87], v[74:75]
    s_mov_b64 exec, -1
    s_or_b64 s[80:81], s[80:81], vcc
    v_cmpx_ne_u64 vcc, v[72:73], v[68:69]
    s_and_b64 s[82:83], vcc, s[80:81]
    s_cbranch_scc1 L2_c78
L2_d78:
    v_mov_b64 v[84:85], v[68:69]
    v_mov_b32 v7, v94
    v_mov_b64 v[86:87], v[72:73]
    s_mov_b64 exec, -1
    s_or_b64 s[80:81], s[80:81], vcc
    ds_read_b64 v[70:71], v93
    s_and_b64 exec, s[84:85], s[80:81]
    v_mfma_f32_4x4x4_16b_bf16 v[76:79], v[12:13], v[84:85], 0
    v_mov_b32 v92, v7
    s_andn2_b64 s[80:81], s[80:81], s[84:85]
    v_mfma_f32_4x4x4_16b_bf16 v[76:79], v[10:11], v[86:87], v[76:79]
    s_mov_b64 exec, -1
    ds_read_b64 v[68:69], v92
    v_and_b32 v46, 0x80000000, v21
    v_lshrrev_b32 v47, 14, v19
    v_bitop3_b32 v47, v47, v5, v46 bitop3:0xea
    ds_read_b64 v[106:107], v47 offset:63616
    v_bitop3_b32 v95, v19, v5, v46 bitop3:0xea
    v_and_b32 v46, 0x40000000, v21
    v_lshrrev_b32 v47, 14, v18
    v_bitop3_b32 v47, v47, v5, v46 bitop3:0xea
    ds_read_b64 v[104:105], v47 offset:63616
    v_bitop3_b32 v94, v18, v5, v46 bitop3:0xea
    s_waitcnt lgkmcnt(2)
    v_mfma_f32_4x4x4_16b_bf16 v[80:83], v[10:11], v[70:71], v[80:83]
    v_mfma_f32_4x4x4_16b_bf16 v[76:79], v[10:11], v[68:69], v[76:79]
    v_perm_b32 v15, v19, v20, s47
    v_bitop3_b32 v46, v19, 0.5, -0.5 bitop3:0xa8
    v_perm_b32 v14, v18, v20, s46
    v_bitop3_b32 v47, v18, 0.5, -0.5 bitop3:0xa8
    v_cvt_pk_bf16_f32 v80, v80, v81
    v_cvt_pk_bf16_f32 v81, v82, v83
    ds_wrxchg_rtn_b64 v[74:75], v93, v[80:81]
    v_cvt_pk_bf16_f32 v76, v76, v77
    v_cvt_pk_bf16_f32 v77, v78, v79
    ds_wrxchg_rtn_b64 v[72:73], v92, v[76:77]
    s_setprio 2
    s_waitcnt lgkmcnt(2)
    v_mfma_f32_4x4x4_16b_bf16 v[80:83], v[8:9], v[106:107], 0
    v_mfma_f32_4x4x4_16b_bf16 v[76:79], v[8:9], v[104:105], 0
    v_bitop3_b32 v15, v6, v15, v46 bitop3:0xca
    v_bitop3_b32 v14, v6, v14, v47 bitop3:0xca
    s_nop 1
    v_pk_mul_f32 v[80:81], v[80:81], v[14:15] op_sel:[0,1] op_sel_hi:[1,1]
    v_pk_mul_f32 v[82:83], v[82:83], v[14:15] op_sel:[0,1] op_sel_hi:[1,1]
    v_pk_mul_f32 v[76:77], v[76:77], v[14:15] op_sel:[0,0] op_sel_hi:[1,0]
    v_pk_mul_f32 v[78:79], v[78:79], v[14:15] op_sel:[0,0] op_sel_hi:[1,0]
    v_and_b32 v47, 0x0fffffff, v40
    v_mov_b32 v21, v40
    buffer_load_dwordx4 v[16:19], v47, s[8:11], 0 offen
    buffer_load_dwordx3 v[18:20], v47, s[8:11], 0 offen offset:8
    s_waitcnt lgkmcnt(0)
    v_cmpx_ne_u64 vcc, v[74:75], v[70:71]
    s_and_b64 s[82:83], vcc, s[80:81]
    s_cbranch_scc1 L2_c79
L2_d79:
    v_mov_b64 v[84:85], v[70:71]
    v_mov_b32 v7, v93
    v_mov_b64 v[86:87], v[74:75]
    s_mov_b64 exec, -1
    s_or_b64 s[80:81], s[80:81], vcc
    v_cmpx_ne_u64 vcc, v[72:73], v[68:69]
    s_and_b64 s[82:83], vcc, s[80:81]
    s_cbranch_scc1 L2_c80
L2_d80:
    v_mov_b64 v[84:85], v[68:69]
    v_mov_b32 v7, v92
    v_mov_b64 v[86:87], v[72:73]
    s_mov_b64 exec, -1
    s_or_b64 s[80:81], s[80:81], vcc
    ds_read_b64 v[70:71], v95
    ds_read_b64 v[68:69], v94
    s_waitcnt vmcnt(10)
    v_and_b32 v46, 0x20000000, v27
    v_lshrrev_b32 v47, 14, v23
    v_bitop3_b32 v47, v47, v5, v46 bitop3:0xea
    ds_read_b64 v[102:103], v47 offset:63616
    v_bitop3_b32 v93, v23, v5, v46 bitop3:0xea
    v_and_b32 v46, 0x10000000, v27
    v_lshrrev_b32 v47, 14, v22
    v_bitop3_b32 v47, v47, v5, v46 bitop3:0xea
    ds_read_b64 v[100:101], v47 offset:63616
    v_bitop3_b32 v92, v22, v5, v46 bitop3:0xea
    s_waitcnt lgkmcnt(2)
    v_mfma_f32_4x4x4_16b_bf16 v[80:83], v[10:11], v[70:71], v[80:83]
    v_mfma_f32_4x4x4_16b_bf16 v[76:79], v[10:11], v[68:69], v[76:79]
    v_perm_b32 v15, v23, v26, s45
    v_bitop3_b32 v46, v23, 0.5, -0.5 bitop3:0xa8
    v_perm_b32 v14, v22, v26, s44
    v_bitop3_b32 v47, v22, 0.5, -0.5 bitop3:0xa8
    v_cvt_pk_bf16_f32 v80, v80, v81
    v_cvt_pk_bf16_f32 v81, v82, v83
    ds_wrxchg_rtn_b64 v[74:75], v95, v[80:81]
    v_cvt_pk_bf16_f32 v76, v76, v77
    v_cvt_pk_bf16_f32 v77, v78, v79
    ds_wrxchg_rtn_b64 v[72:73], v94, v[76:77]
    s_waitcnt lgkmcnt(2)
    v_mfma_f32_4x4x4_16b_bf16 v[80:83], v[8:9], v[102:103], 0
    v_mfma_f32_4x4x4_16b_bf16 v[76:79], v[8:9], v[100:101], 0
    v_bitop3_b32 v15, v6, v15, v46 bitop3:0xca
    v_bitop3_b32 v14, v6, v14, v47 bitop3:0xca
    v_cmp_lt_u32 s[84:85], v5, v92
    s_nop 0
    v_pk_mul_f32 v[80:81], v[80:81], v[14:15] op_sel:[0,1] op_sel_hi:[1,1]
    v_pk_mul_f32 v[82:83], v[82:83], v[14:15] op_sel:[0,1] op_sel_hi:[1,1]
    v_pk_mul_f32 v[76:77], v[76:77], v[14:15] op_sel:[0,0] op_sel_hi:[1,0]
    v_pk_mul_f32 v[78:79], v[78:79], v[14:15] op_sel:[0,0] op_sel_hi:[1,0]
    v_sub_u16 v88, v60, v52
    v_and_b32 v89, 3, v52
    v_add3_u32 v99, v88, v89, 3
    v_and_b32 v99, -4, v99
    v_max_u32 v99, 4, v99
    v_and_b32 v97, 0xfffc, v52
    v_bfm_b32 v96, v88, v89
    v_add_u32_dpp v91, v99, v99 row_shr:1 row_mask:0xf bank_mask:0xf bound_ctrl:1
    v_mad_u32_u24 v97, v97, 5, v2
    v_cmp_lt_u32 vcc, 16, v99
    v_add_u32_dpp v91, v91, v91 row_shr:2 row_mask:0xf bank_mask:0xf bound_ctrl:1
    v_sub_u32 v98, s38, v99
    v_lshrrev_b64 v[52:53], 16, v[52:53]
    v_add_u32_dpp v91, v91, v91 row_shr:4 row_mask:0xf bank_mask:0xf bound_ctrl:1
    v_lshrrev_b64 v[60:61], 16, v[60:61]
    s_mov_b32 s43, 0
    v_add_u32_dpp v91, v91, v91 row_shr:8 row_mask:0xf bank_mask:0xf bound_ctrl:1
    s_nop 1
    v_add_u32_dpp v91, v91, v91 row_bcast:15 row_mask:0xa bank_mask:0xf
    s_nop 1
    v_add_u32_dpp v91, v91, v91 row_bcast:31 row_mask:0xc bank_mask:0xf
    v_add_u32 v98, v98, v91
    v_readlane_b32 s37, v91, 63
    s_cbranch_vccnz L2_xo81
L2_xp81:
    buffer_load_dwordx4 v[112:115], v3, s[16:19], s40 offen offset:1024
    s_waitcnt lgkmcnt(0)
    v_cmpx_ne_u64 vcc, v[74:75], v[70:71]
    s_and_b64 s[82:83], vcc, s[80:81]
    s_cbranch_scc1 L2_c82
L2_d82:
    v_mov_b64 v[84:85], v[70:71]
    v_mov_b32 v7, v95
    v_mov_b64 v[86:87], v[74:75]
    s_mov_b64 exec, -1
    s_or_b64 s[80:81], s[80:81], vcc
    v_cmpx_ne_u64 vcc, v[72:73], v[68:69]
    s_and_b64 s[82:83], vcc, s[80:81]
    s_cbranch_scc1 L2_c83
L2_d83:
    v_mov_b64 v[84:85], v[68:69]
    v_mov_b32 v7, v94
    v_mov_b64 v[86:87], v[72:73]
    s_mov_b64 exec, -1
    s_or_b64 s[80:81], s[80:81], vcc
    ds_read_b64 v[70:71], v93
    s_and_b64 exec, s[84:85], s[80:81]
    v_mfma_f32_4x4x4_16b_bf16 v[76:79], v[12:13], v[84:85], 0
    v_mov_b32 v92, v7
    s_andn2_b64 s[80:81], s[80:81], s[84:85]
    v_mfma_f32_4x4x4_16b_bf16 v[76:79], v[10:11], v[86:87], v[76:79]
    s_mov_b64 exec, -1
    ds_read_b64 v[68:69], v92
    v_and_b32 v46, 0x80000000, v27
    v_lshrrev_b32 v47, 14, v25
    v_bitop3_b32 v47, v47, v5, v46 bitop3:0xea
    ds_read_b64 v[106:107], v47 offset:63616
    v_bitop3_b32 v95, v25, v5, v46 bitop3:0xea
    v_and_b32 v46, 0x40000000, v27
    v_lshrrev_b32 v47, 14, v24
    v_bitop3_b32 v47, v47, v5, v46 bitop3:0xea
    ds_read_b64 v[104:105], v47 offset:63616
    v_bitop3_b32 v94, v24, v5, v46 bitop3:0xea
    s_waitcnt lgkmcnt(2)
    v_mfma_f32_4x4x4_16b_bf16 v[80:83], v[10:11], v[70:71], v[80:83]
    v_mfma_f32_4x4x4_16b_bf16 v[76:79], v[10:11], v[68:69], v[76:79]
    v_perm_b32 v15, v25, v26, s47
    v_bitop3_b32 v46, v25, 0.5, -0.5 bitop3:0xa8
    v_perm_b32 v14, v24, v26, s46
    v_bitop3_b32 v47, v24, 0.5, -0.5 bitop3:0xa8
    v_cvt_pk_bf16_f32 v80, v80, v81
    v_cvt_pk_bf16_f32 v81, v82, v83
    ds_wrxchg_rtn_b64 v[74:75], v93, v[80:81]
    v_cvt_pk_bf16_f32 v76, v76, v77
    v_cvt_pk_bf16_f32 v77, v78, v79
    ds_wrxchg_rtn_b64 v[72:73], v92, v[76:77]
    s_setprio 1
    s_waitcnt lgkmcnt(2)
    v_mfma_f32_4x4x4_16b_bf16 v[80:83], v[8:9], v[106:107], 0
    v_mfma_f32_4x4x4_16b_bf16 v[76:79], v[8:9], v[104:105], 0
    v_bitop3_b32 v15, v6, v15, v46 bitop3:0xca
    v_bitop3_b32 v14, v6, v14, v47 bitop3:0xca
    s_nop 1
    v_pk_mul_f32 v[80:81], v[80:81], v[14:15] op_sel:[0,1] op_sel_hi:[1,1]
    v_pk_mul_f32 v[82:83], v[82:83], v[14:15] op_sel:[0,1] op_sel_hi:[1,1]
    v_pk_mul_f32 v[76:77], v[76:77], v[14:15] op_sel:[0,0] op_sel_hi:[1,0]
    v_pk_mul_f32 v[78:79], v[78:79], v[14:15] op_sel:[0,0] op_sel_hi:[1,0]
    v_and_b32 v47, 0x0fffffff, v41
    v_mov_b32 v27, v41
    buffer_load_dwordx4 v[22:25], v47, s[8:11], 0 offen
    buffer_load_dwordx3 v[24:26], v47, s[8:11], 0 offen offset:8
    s_waitcnt lgkmcnt(0)
    v_cmpx_ne_u64 vcc, v[74:75], v[70:71]
    s_and_b64 s[82:83], vcc, s[80:81]
    s_cbranch_scc1 L2_c84
L2_d84:
    v_mov_b64 v[84:85], v[70:71]
    v_mov_b32 v7, v93
    v_mov_b64 v[86:87], v[74:75]
    s_mov_b64 exec, -1
    s_or_b64 s[80:81], s[80:81], vcc
    v_cmpx_ne_u64 vcc, v[72:73], v[68:69]
    s_and_b64 s[82:83], vcc, s[80:81]
    s_cbranch_scc1 L2_c85
L2_d85:
    v_mov_b64 v[84:85], v[68:69]
    v_mov_b32 v7, v92
    v_mov_b64 v[86:87], v[72:73]
    s_mov_b64 exec, -1
    s_or_b64 s[80:81], s[80:81], vcc
    ds_read_b64 v[70:71], v95
    ds_read_b64 v[68:69], v94
    s_waitcnt vmcnt(11)
    v_and_b32 v46, 0x20000000, v33
    v_lshrrev_b32 v47, 14, v29
    v_bitop3_b32 v47, v47, v5, v46 bitop3:0xea
    ds_read_b64 v[102:103], v47 offset:63616
    v_bitop3_b32 v93, v29, v5, v46 bitop3:0xea
    v_and_b32 v46, 0x10000000, v33
    v_lshrrev_b32 v47, 14, v28
    v_bitop3_b32 v47, v47, v5, v46 bitop3:0xea
    ds_read_b64 v[100:101], v47 offset:63616
    v_bitop3_b32 v92, v28, v5, v46 bitop3:0xea
    s_waitcnt lgkmcnt(2)
    v_mfma_f32_4x4x4_16b_bf16 v[80:83], v[10:11], v[70:71], v[80:83]
    v_mfma_f32_4x4x4_16b_bf16 v[76:79], v[10:11], v[68:69], v[76:79]
    v_perm_b32 v15, v29, v32, s45
    v_bitop3_b32 v46, v29, 0.5, -0.5 bitop3:0xa8
    v_perm_b32 v14, v28, v32, s44
    v_bitop3_b32 v47, v28, 0.5, -0.5 bitop3:0xa8
    v_cvt_pk_bf16_f32 v80, v80, v81
    v_cvt_pk_bf16_f32 v81, v82, v83
    ds_wrxchg_rtn_b64 v[74:75], v95, v[80:81]
    v_cvt_pk_bf16_f32 v76, v76, v77
    v_cvt_pk_bf16_f32 v77, v78, v79
    ds_wrxchg_rtn_b64 v[72:73], v94, v[76:77]
    s_waitcnt lgkmcnt(2)
    v_mfma_f32_4x4x4_16b_bf16 v[80:83], v[8:9], v[102:103], 0
    v_mfma_f32_4x4x4_16b_bf16 v[76:79], v[8:9], v[100:101], 0
    v_bitop3_b32 v15, v6, v15, v46 bitop3:0xca
    v_bitop3_b32 v14, v6, v14, v47 bitop3:0xca
    v_cmp_lt_u32 s[84:85], v5, v92
    s_nop 0
    v_pk_mul_f32 v[80:81], v[80:81], v[14:15] op_sel:[0,1] op_sel_hi:[1,1]
    v_pk_mul_f32 v[82:83], v[82:83], v[14:15] op_sel:[0,1] op_sel_hi:[1,1]
    v_pk_mul_f32 v[76:77], v[76:77], v[14:15] op_sel:[0,0] op_sel_hi:[1,0]
    v_pk_mul_f32 v[78:79], v[78:79], v[14:15] op_sel:[0,0] op_sel_hi:[1,0]
    s_waitcnt lgkmcnt(0)
    v_cmpx_ne_u64 vcc, v[74:75], v[70:71]
    s_and_b64 s[82:83], vcc, s[80:81]
    s_cbranch_scc1 L2_c86
L2_d86:
    v_mov_b64 v[84:85], v[70:71]
    v_mov_b32 v7, v95
    v_mov_b64 v[86:87], v[74:75]
    s_mov_b64 exec, -1
    s_or_b64 s[80:81], s[80:81], vcc
    v_cmpx_ne_u64 vcc, v[72:73], v[68:69]
    s_and_b64 s[82:83], vcc, s[80:81]
    s_cbranch_scc1 L2_c87
L2_d87:
    v_mov_b64 v[84:85], v[68:69]
    v_mov_b32 v7, v94
    v_mov_b64 v[86:87], v[72:73]
    s_mov_b64 exec, -1
    s_or_b64 s[80:81], s[80:81], vcc
    ds_read_b64 v[70:71], v93
    s_and_b64 exec, s[84:85], s[80:81]
    v_mfma_f32_4x4x4_16b_bf16 v[76:79], v[12:13], v[84:85], 0
    v_mov_b32 v92, v7
    s_andn2_b64 s[80:81], s[80:81], s[84:85]
    v_mfma_f32_4x4x4_16b_bf16 v[76:79], v[10:11], v[86:87], v[76:79]
    s_mov_b64 exec, -1
    ds_read_b64 v[68:69], v92
    v_and_b32 v46, 0x80000000, v33
    v_lshrrev_b32 v47, 14, v31
    v_bitop3_b32 v47, v47, v5, v46 bitop3:0xea
    ds_read_b64 v[106:107], v47 offset:63616
    v_bitop3_b32 v95, v31, v5, v46 bitop3:0xea
    v_and_b32 v46, 0x40000000, v33
    v_lshrrev_b32 v47, 14, v30
    v_bitop3_b32 v47, v47, v5, v46 bitop3:0xea
    ds_read_b64 v[104:105], v47 offset:63616
    v_bitop3_b32 v94, v30, v5, v46 bitop3:0xea
    s_waitcnt lgkmcnt(2)
    v_mfma_f32_4x4x4_16b_bf16 v[80:83], v[10:11], v[70:71], v[80:83]
    v_mfma_f32_4x4x4_16b_bf16 v[76:79], v[10:11], v[68:69], v[76:79]
    v_perm_b32 v15, v31, v32, s47
    v_bitop3_b32 v46, v31, 0.5, -0.5 bitop3:0xa8
    v_perm_b32 v14, v30, v32, s46
    v_bitop3_b32 v47, v30, 0.5, -0.5 bitop3:0xa8
    v_cvt_pk_bf16_f32 v80, v80, v81
    v_cvt_pk_bf16_f32 v81, v82, v83
    ds_wrxchg_rtn_b64 v[74:75], v93, v[80:81]
    v_cvt_pk_bf16_f32 v76, v76, v77
    v_cvt_pk_bf16_f32 v77, v78, v79
    ds_wrxchg_rtn_b64 v[72:73], v92, v[76:77]
    s_setprio 0
    s_waitcnt lgkmcnt(2)
    v_mfma_f32_4x4x4_16b_bf16 v[80:83], v[8:9], v[106:107], 0
    v_mfma_f32_4x4x4_16b_bf16 v[76:79], v[8:9], v[104:105], 0
    v_bitop3_b32 v15, v6, v15, v46 bitop3:0xca
    v_bitop3_b32 v14, v6, v14, v47 bitop3:0xca
    s_nop 1
    v_pk_mul_f32 v[80:81], v[80:81], v[14:15] op_sel:[0,1] op_sel_hi:[1,1]
    v_pk_mul_f32 v[82:83], v[82:83], v[14:15] op_sel:[0,1] op_sel_hi:[1,1]
    v_pk_mul_f32 v[76:77], v[76:77], v[14:15] op_sel:[0,0] op_sel_hi:[1,0]
    v_pk_mul_f32 v[78:79], v[78:79], v[14:15] op_sel:[0,0] op_sel_hi:[1,0]
    s_add_u32 s40, s40, 0x4e200
    v_and_b32 v47, 0x0fffffff, v42
    v_mov_b32 v33, v42
    buffer_load_dwordx4 v[28:31], v47, s[8:11], 0 offen
    buffer_load_dwordx3 v[30:32], v47, s[8:11], 0 offen offset:8
    s_waitcnt lgkmcnt(0)
    v_cmpx_ne_u64 vcc, v[74:75], v[70:71]
    s_and_b64 s[82:83], vcc, s[80:81]
    s_cbranch_scc1 L2_c88
L2_d88:
    v_mov_b64 v[84:85], v[70:71]
    v_mov_b32 v7, v93
    v_mov_b64 v[86:87], v[74:75]
    s_mov_b64 exec, -1
    s_or_b64 s[80:81], s[80:81], vcc
    v_cmpx_ne_u64 vcc, v[72:73], v[68:69]
    s_and_b64 s[82:83], vcc, s[80:81]
    s_cbranch_scc1 L2_c89
L2_d89:
    v_mov_b64 v[84:85], v[68:69]
    v_mov_b32 v7, v92
    v_mov_b64 v[86:87], v[72:73]
    s_mov_b64 exec, -1
    s_or_b64 s[80:81], s[80:81], vcc
    ds_read_b64 v[70:71], v95
    ds_read_b64 v[68:69], v94
    s_waitcnt vmcnt(8)
    v_and_b32 v46, 0x20000000, v39
    v_lshrrev_b32 v47, 14, v35
    v_bitop3_b32 v47, v47, v5, v46 bitop3:0xea
    ds_read_b64 v[102:103], v47 offset:63616
    v_bitop3_b32 v93, v35, v5, v46 bitop3:0xea
    v_and_b32 v46, 0x10000000, v39
    v_lshrrev_b32 v47, 14, v34
    v_bitop3_b32 v47, v47, v5, v46 bitop3:0xea
    ds_read_b64 v[100:101], v47 offset:63616
    v_bitop3_b32 v92, v34, v5, v46 bitop3:0xea
    v_and_b32 v46, 0x80000000, v39
    v_lshrrev_b32 v47, 14, v37
    v_bitop3_b32 v47, v47, v5, v46 bitop3:0xea
    ds_read_b64 v[106:107], v47 offset:63616
    v_and_b32 v46, 0x40000000, v39
    v_lshrrev_b32 v47, 14, v36
    v_bitop3_b32 v47, v47, v5, v46 bitop3:0xea
    ds_read_b64 v[104:105], v47 offset:63616
    s_waitcnt lgkmcnt(4)
    v_mfma_f32_4x4x4_16b_bf16 v[80:83], v[10:11], v[70:71], v[80:83]
    v_mfma_f32_4x4x4_16b_bf16 v[76:79], v[10:11], v[68:69], v[76:79]
    v_perm_b32 v15, v35, v38, s45
    v_bitop3_b32 v46, v35, 0.5, -0.5 bitop3:0xa8
    v_perm_b32 v14, v34, v38, s44
    v_bitop3_b32 v47, v34, 0.5, -0.5 bitop3:0xa8
    v_cvt_pk_bf16_f32 v80, v80, v81
    v_cvt_pk_bf16_f32 v81, v82, v83
    ds_wrxchg_rtn_b64 v[74:75], v95, v[80:81]
    v_cvt_pk_bf16_f32 v76, v76, v77
    v_cvt_pk_bf16_f32 v77, v78, v79
    ds_wrxchg_rtn_b64 v[72:73], v94, v[76:77]
    s_waitcnt lgkmcnt(2)
    s_barrier
    s_setprio 3
    ds_write_b128 v3, v[124:127] offset:4096
    s_add_u32 s3, s40, 4096
    buffer_load_dwordx4 v[124:127], v3, s[16:19], s3 offen
    ds_write_b128 v3, v[116:119] offset:2048
    buffer_load_dwordx4 v[116:119], v3, s[16:19], s40 offen offset:2048
    ds_write_b128 v3, v[120:123] offset:3072
    buffer_load_dwordx4 v[120:123], v3, s[16:19], s40 offen offset:3072
    v_mfma_f32_4x4x4_16b_bf16 v[80:83], v[8:9], v[102:103], 0
    v_mfma_f32_4x4x4_16b_bf16 v[76:79], v[8:9], v[100:101], 0
    v_bitop3_b32 v15, v6, v15, v46 bitop3:0xca
    v_bitop3_b32 v14, v6, v14, v47 bitop3:0xca
    v_cmp_lt_u32 s[84:85], v5, v92
    s_nop 0
    v_pk_mul_f32 v[80:81], v[80:81], v[14:15] op_sel:[0,1] op_sel_hi:[1,1]
    v_pk_mul_f32 v[82:83], v[82:83], v[14:15] op_sel:[0,1] op_sel_hi:[1,1]
    v_pk_mul_f32 v[76:77], v[76:77], v[14:15] op_sel:[0,0] op_sel_hi:[1,0]
    v_pk_mul_f32 v[78:79], v[78:79], v[14:15] op_sel:[0,0] op_sel_hi:[1,0]
    v_mov_b32 v44, v43
    s_cmp_gt_u32 s37, 1024
    s_cbranch_scc1 L2_xs90
    s_cmp_lg_u32 s43, 0
    s_cbranch_scc1 L2_xa90
L2_xb90:
    v_lshlrev_b32 v89, 16, v96
    v_add_u32 v90, 60, v97
    v_bitop3_b32 v90, v89, v45, v90 bitop3:0x6a
    ds_write_b32 v98, v90 offset:12
    v_lshlrev_b32 v89, 20, v96
    v_add_u32 v90, 40, v97
    v_bitop3_b32 v90, v89, v45, v90 bitop3:0x6a
    ds_write_b32 v98, v90 offset:8
    v_lshlrev_b32 v89, 24, v96
    v_add_u32 v90, 20, v97
    v_bitop3_b32 v90, v89, v45, v90 bitop3:0x6a
    ds_write_b32 v98, v90 offset:4
    v_lshlrev_b32 v89, 28, v96
    v_bitop3_b32 v90, v89, v45, v97 bitop3:0x6a
    ds_write_b32 v98, v90 offset:0
    v_mov_b32_dpp v91, v64 quad_perm:[1,1,1,1] row_mask:0xf bank_mask:0xf
    v_and_b32 v89, 3, v91
    v_and_b32 v97, 0xfffc, v91
    v_sub_u16_dpp v88, v64, v91 quad_perm:[3,3,3,3] row_mask:0xf bank_mask:0xf
    v_mad_u32_u24 v97, v97, 5, v4
    v_add_u32 v99, v88, v89
    v_bfm_b32 v96, v88, v89
    v_cmp_lt_u32 s[58:59], 16, v99
    v_lshlrev_b32 v89, v1, v96
    v_and_b32 v89, v45, v89
    v_cmp_ne_u32 vcc, 0, v89
    v_xor_b32 v90, v97, v89
    s_add_u32 s3, s37, s38
    v_mbcnt_lo_u32_b32 v98, vcc_lo, 0
    v_mbcnt_hi_u32_b32 v98, vcc_hi, v98
    s_bcnt1_i32_b64 s41, vcc
    v_lshl_add_u32 v98, v98, 2, s3
    s_mov_b64 exec, vcc
    ds_write_b32 v98, v90
    s_mov_b64 exec, -1
    s_lshl2_add_u32 s37, s41, s37
    s_cmp_lg_u64 s[58:59], 0
    s_cbranch_scc1 L2_xe90
L2_xr90:
    v_add_u32 v98, s37, v0
    v_mov_b32 v90, -1
    ds_write_b32 v98, v90
    ds_read2st64_b32 v[40:41], v0 offset0:0 offset1:1
    ds_read2st64_b32 v[42:43], v0 offset0:2 offset1:3
    s_sub_u32 s3, s37, 768
    s_cmp_gt_u32 s3, 256
    s_cbranch_scc1 L2_xf90
L2_xg90:
    s_setprio 2
    s_waitcnt vmcnt(10)
    ds_write_b128 v3, v[108:111] offset:0
    s_waitcnt lgkmcnt(12)
    v_cmpx_ne_u64 vcc, v[74:75], v[70:71]
    s_and_b64 s[82:83], vcc, s[80:81]
    s_cbranch_scc1 L2_c91
L2_d91:
    v_mov_b64 v[84:85], v[70:71]
    v_mov_b32 v7, v95
    v_mov_b64 v[86:87], v[74:75]
    s_mov_b64 exec, -1
    s_or_b64 s[80:81], s[80:81], vcc
    v_cmpx_ne_u64 vcc, v[72:73], v[68:69]
    s_and_b64 s[82:83], vcc, s[80:81]
    s_cbranch_scc1 L2_c92
L2_d92:
    v_mov_b64 v[84:85], v[68:69]
    v_mov_b32 v7, v94
    v_mov_b64 v[86:87], v[72:73]
    s_mov_b64 exec, -1
    s_or_b64 s[80:81], s[80:81], vcc
    ds_read_b64 v[70:71], v93
    s_and_b64 exec, s[84:85], s[80:81]
    v_mfma_f32_4x4x4_16b_bf16 v[76:79], v[12:13], v[84:85], 0
    v_mov_b32 v92, v7
    s_andn2_b64 s[80:81], s[80:81], s[84:85]
    v_mfma_f32_4x4x4_16b_bf16 v[76:79], v[10:11], v[86:87], v[76:79]
    s_mov_b64 exec, -1
    ds_read_b64 v[68:69], v92
    s_setprio 1
    s_waitcnt vmcnt(7)
    ds_write_b128 v3, v[112:115] offset:1024
    s_waitcnt lgkmcnt(1)
    v_mfma_f32_4x4x4_16b_bf16 v[80:83], v[10:11], v[70:71], v[80:83]
    v_mfma_f32_4x4x4_16b_bf16 v[76:79], v[10:11], v[68:69], v[76:79]
    v_and_b32 v46, 0x40000000, v39
    v_bitop3_b32 v94, v36, v5, v46 bitop3:0xea
    v_and_b32 v46, 0x80000000, v39
    v_bitop3_b32 v95, v37, v5, v46 bitop3:0xea
    v_perm_b32 v15, v37, v38, s47
    v_bitop3_b32 v46, v37, 0.5, -0.5 bitop3:0xa8
    v_perm_b32 v14, v36, v38, s46
    v_bitop3_b32 v47, v36, 0.5, -0.5 bitop3:0xa8
    v_cvt_pk_bf16_f32 v80, v80, v81
    v_cvt_pk_bf16_f32 v81, v82, v83
    ds_wrxchg_rtn_b64 v[74:75], v93, v[80:81]
    v_cvt_pk_bf16_f32 v76, v76, v77
    v_cvt_pk_bf16_f32 v77, v78, v79
    ds_wrxchg_rtn_b64 v[72:73], v92, v[76:77]
    s_setprio 0
    v_mfma_f32_4x4x4_16b_bf16 v[80:83], v[8:9], v[106:107], 0
    v_mfma_f32_4x4x4_16b_bf16 v[76:79], v[8:9], v[104:105], 0
    v_bitop3_b32 v15, v6, v15, v46 bitop3:0xca
    v_bitop3_b32 v14, v6, v14, v47 bitop3:0xca
    s_nop 1
    v_pk_mul_f32 v[80:81], v[80:81], v[14:15] op_sel:[0,1] op_sel_hi:[1,1]
    v_pk_mul_f32 v[82:83], v[82:83], v[14:15] op_sel:[0,1] op_sel_hi:[1,1]
    v_pk_mul_f32 v[76:77], v[76:77], v[14:15] op_sel:[0,0] op_sel_hi:[1,0]
    v_pk_mul_f32 v[78:79], v[78:79], v[14:15] op_sel:[0,0] op_sel_hi:[1,0]
    s_add_u32 s42, s42, 1
    s_waitcnt lgkmcnt(2)
    s_barrier
    s_bitcmp1_b32 s36, s42
    s_cbranch_scc1 L2_slow
L2_ret5:
    s_setprio 3
    v_and_b32 v47, 0x0fffffff, v44
    v_mov_b32 v39, v44
    buffer_load_dwordx4 v[34:37], v47, s[8:11], 0 offen
    buffer_load_dwordx3 v[36:38], v47, s[8:11], 0 offen offset:8
    s_waitcnt lgkmcnt(0)
    v_cmpx_ne_u64 vcc, v[74:75], v[70:71]
    s_and_b64 s[82:83], vcc, s[80:81]
    s_cbranch_scc1 L2_c93
L2_d93:
    v_mov_b64 v[84:85], v[70:71]
    v_mov_b32 v7, v93
    v_mov_b64 v[86:87], v[74:75]
    s_mov_b64 exec, -1
    s_or_b64 s[80:81], s[80:81], vcc
    v_cmpx_ne_u64 vcc, v[72:73], v[68:69]
    s_and_b64 s[82:83], vcc, s[80:81]
    s_cbranch_scc1 L2_c94
L2_d94:
    v_mov_b64 v[84:85], v[68:69]
    v_mov_b32 v7, v92
    v_mov_b64 v[86:87], v[72:73]
    s_mov_b64 exec, -1
    s_or_b64 s[80:81], s[80:81], vcc
    ds_read_b64 v[70:71], v95
    ds_read_b64 v[68:69], v94
    v_and_b32 v46, 0x20000000, v21
    v_lshrrev_b32 v47, 14, v17
    v_bitop3_b32 v47, v47, v5, v46 bitop3:0xea
    ds_read_b64 v[102:103], v47 offset:63616
    v_bitop3_b32 v93, v17, v5, v46 bitop3:0xea
    v_and_b32 v46, 0x10000000, v21
    v_lshrrev_b32 v47, 14, v16
    v_bitop3_b32 v47, v47, v5, v46 bitop3:0xea
    ds_read_b64 v[100:101], v47 offset:63616
    v_bitop3_b32 v92, v16, v5, v46 bitop3:0xea
    s_waitcnt lgkmcnt(2)
    v_mfma_f32_4x4x4_16b_bf16 v[80:83], v[10:11], v[70:71], v[80:83]
    v_mfma_f32_4x4x4_16b_bf16 v[76:79], v[10:11], v[68:69], v[76:79]
    v_perm_b32 v15, v17, v20, s45
    v_bitop3_b32 v46, v17, 0.5, -0.5 bitop3:0xa8
    v_perm_b32 v14, v16, v20, s44
    v_bitop3_b32 v47, v16, 0.5, -0.5 bitop3:0xa8
    v_cvt_pk_bf16_f32 v80, v80, v81
    v_cvt_pk_bf16_f32 v81, v82, v83
    ds_wrxchg_rtn_b64 v[74:75], v95, v[80:81]
    v_cvt_pk_bf16_f32 v76, v76, v77
    v_cvt_pk_bf16_f32 v77, v78, v79
    ds_wrxchg_rtn_b64 v[72:73], v94, v[76:77]
    s_waitcnt lgkmcnt(2)
    v_mfma_f32_4x4x4_16b_bf16 v[80:83], v[8:9], v[102:103], 0
    v_mfma_f32_4x4x4_16b_bf16 v[76:79], v[8:9], v[100:101], 0
    v_bitop3_b32 v15, v6, v15, v46 bitop3:0xca
    v_bitop3_b32 v14, v6, v14, v47 bitop3:0xca
    v_cmp_lt_u32 s[84:85], v5, v92
    s_nop 0
    v_pk_mul_f32 v[80:81], v[80:81], v[14:15] op_sel:[0,1] op_sel_hi:[1,1]
    v_pk_mul_f32 v[82:83], v[82:83], v[14:15] op_sel:[0,1] op_sel_hi:[1,1]
    v_pk_mul_f32 v[76:77], v[76:77], v[14:15] op_sel:[0,0] op_sel_hi:[1,0]
    v_pk_mul_f32 v[78:79], v[78:79], v[14:15] op_sel:[0,0] op_sel_hi:[1,0]
    buffer_load_dwordx4 v[108:111], v3, s[16:19], s40 offen offset:0
    s_waitcnt lgkmcnt(0)
    v_cmpx_ne_u64 vcc, v[74:75], v[70:71]
    s_and_b64 s[82:83], vcc, s[80:81]
    s_cbranch_scc1 L2_c95
L2_d95:
    v_mov_b64 v[84:85], v[70:71]
    v_mov_b32 v7, v95
    v_mov_b64 v[86:87], v[74:75]
    s_mov_b64 exec, -1
    s_or_b64 s[80:81], s[80:81], vcc
    v_cmpx_ne_u64 vcc, v[72:73], v[68:69]
    s_and_b64 s[82:83], vcc, s[80:81]
    s_cbranch_scc1 L2_c96
L2_d96:
    v_mov_b64 v[84:85], v[68:69]
    v_mov_b32 v7, v94
    v_mov_b64 v[86:87], v[72:73]
    s_mov_b64 exec, -1
    s_or_b64 s[80:81], s[80:81], vcc
    ds_read_b64 v[70:71], v93
    s_and_b64 exec, s[84:85], s[80:81]
    v_mfma_f32_4x4x4_16b_bf16 v[76:79], v[12:13], v[84:85], 0
    v_mov_b32 v92, v7
    s_andn2_b64 s[80:81], s[80:81], s[84:85]
    v_mfma_f32_4x4x4_16b_bf16 v[76:79], v[10:11], v[86:87], v[76:79]
    s_mov_b64 exec, -1
    ds_read_b64 v[68:69], v92
    v_and_b32 v46, 0x80000000, v21
    v_lshrrev_b32 v47, 14, v19
    v_bitop3_b32 v47, v47, v5, v46 bitop3:0xea
    ds_read_b64 v[106:107], v47 offset:63616
    v_bitop3_b32 v95, v19, v5, v46 bitop3:0xea
    v_and_b32 v46, 0x40000000, v21
    v_lshrrev_b32 v47, 14, v18
    v_bitop3_b32 v47, v47, v5, v46 bitop3:0xea
    ds_read_b64 v[104:105], v47 offset:63616
    v_bitop3_b32 v94, v18, v5, v46 bitop3:0xea
    s_waitcnt lgkmcnt(2)
    v_mfma_f32_4x4x4_16b_bf16 v[80:83], v[10:11], v[70:71], v[80:83]
    v_mfma_f32_4x4x4_16b_bf16 v[76:79], v[10:11], v[68:69], v[76:79]
    v_perm_b32 v15, v19, v20, s47
    v_bitop3_b32 v46, v19, 0.5, -0.5 bitop3:0xa8
    v_perm_b32 v14, v18, v20, s46
    v_bitop3_b32 v47, v18, 0.5, -0.5 bitop3:0xa8
    v_cvt_pk_bf16_f32 v80, v80, v81
    v_cvt_pk_bf16_f32 v81, v82, v83
    ds_wrxchg_rtn_b64 v[74:75], v93, v[80:81]
    v_cvt_pk_bf16_f32 v76, v76, v77
    v_cvt_pk_bf16_f32 v77, v78, v79
    ds_wrxchg_rtn_b64 v[72:73], v92, v[76:77]
    s_setprio 2
    s_waitcnt lgkmcnt(2)
    v_mfma_f32_4x4x4_16b_bf16 v[80:83], v[8:9], v[106:107], 0
    v_mfma_f32_4x4x4_16b_bf16 v[76:79], v[8:9], v[104:105], 0
    v_bitop3_b32 v15, v6, v15, v46 bitop3:0xca
    v_bitop3_b32 v14, v6, v14, v47 bitop3:0xca
    s_nop 1
    v_pk_mul_f32 v[80:81], v[80:81], v[14:15] op_sel:[0,1] op_sel_hi:[1,1]
    v_pk_mul_f32 v[82:83], v[82:83], v[14:15] op_sel:[0,1] op_sel_hi:[1,1]
    v_pk_mul_f32 v[76:77], v[76:77], v[14:15] op_sel:[0,0] op_sel_hi:[1,0]
    v_pk_mul_f32 v[78:79], v[78:79], v[14:15] op_sel:[0,0] op_sel_hi:[1,0]
    v_and_b32 v47, 0x0fffffff, v40
    v_mov_b32 v21, v40
    buffer_load_dwordx4 v[16:19], v47, s[8:11], 0 offen
    buffer_load_dwordx3 v[18:20], v47, s[8:11], 0 offen offset:8
    s_waitcnt lgkmcnt(0)
    v_cmpx_ne_u64 vcc, v[74:75], v[70:71]
    s_and_b64 s[82:83], vcc, s[80:81]
    s_cbranch_scc1 L2_c97
L2_d97:
    v_mov_b64 v[84:85], v[70:71]
    v_mov_b32 v7, v93
    v_mov_b64 v[86:87], v[74:75]
    s_mov_b64 exec, -1
    s_or_b64 s[80:81], s[80:81], vcc
    v_cmpx_ne_u64 vcc, v[72:73], v[68:69]
    s_and_b64 s[82:83], vcc, s[80:81]
    s_cbranch_scc1 L2_c98
L2_d98:
    v_mov_b64 v[84:85], v[68:69]
    v_mov_b32 v7, v92
    v_mov_b64 v[86:87], v[72:73]
    s_mov_b64 exec, -1
    s_or_b64 s[80:81], s[80:81], vcc
    ds_read_b64 v[70:71], v95
    ds_read_b64 v[68:69], v94
    s_waitcnt vmcnt(10)
    v_and_b32 v46, 0x20000000, v27
    v_lshrrev_b32 v47, 14, v23
    v_bitop3_b32 v47, v47, v5, v46 bitop3:0xea
    ds_read_b64 v[102:103], v47 offset:63616
    v_bitop3_b32 v93, v23, v5, v46 bitop3:0xea
    v_and_b32 v46, 0x10000000, v27
    v_lshrrev_b32 v47, 14, v22
    v_bitop3_b32 v47, v47, v5, v46 bitop3:0xea
    ds_read_b64 v[100:101], v47 offset:63616
    v_bitop3_b32 v92, v22, v5, v46 bitop3:0xea
    s_waitcnt lgkmcnt(2)
    v_mfma_f32_4x4x4_16b_bf16 v[80:83], v[10:11], v[70:71], v[80:83]
    v_mfma_f32_4x4x4_16b_bf16 v[76:79], v[10:11], v[68:69], v[76:79]
    v_perm_b32 v15, v23, v26, s45
    v_bitop3_b32 v46, v23, 0.5, -0.5 bitop3:0xa8
    v_perm_b32 v14, v22, v26, s44
    v_bitop3_b32 v47, v22, 0.5, -0.5 bitop3:0xa8
    v_cvt_pk_bf16_f32 v80, v80, v81
    v_cvt_pk_bf16_f32 v81, v82, v83
    ds_wrxchg_rtn_b64 v[74:75], v95, v[80:81]
    v_cvt_pk_bf16_f32 v76, v76, v77
    v_cvt_pk_bf16_f32 v77, v78, v79
    ds_wrxchg_rtn_b64 v[72:73], v94, v[76:77]
    s_waitcnt lgkmcnt(2)
    v_mfma_f32_4x4x4_16b_bf16 v[80:83], v[8:9], v[102:103], 0
    v_mfma_f32_4x4x4_16b_bf16 v[76:79], v[8:9], v[100:101], 0
    v_bitop3_b32 v15, v6, v15, v46 bitop3:0xca
    v_bitop3_b32 v14, v6, v14, v47 bitop3:0xca
    v_cmp_lt_u32 s[84:85], v5, v92
    s_nop 0
    v_pk_mul_f32 v[80:81], v[80:81], v[14:15] op_sel:[0,1] op_sel_hi:[1,1]
    v_pk_mul_f32 v[82:83], v[82:83], v[14:15] op_sel:[0,1] op_sel_hi:[1,1]
    v_pk_mul_f32 v[76:77], v[76:77], v[14:15] op_sel:[0,0] op_sel_hi:[1,0]
    v_pk_mul_f32 v[78:79], v[78:79], v[14:15] op_sel:[0,0] op_sel_hi:[1,0]
    v_sub_u16 v88, v62, v54
    v_and_b32 v89, 3, v54
    v_add3_u32 v99, v88, v89, 3
    v_and_b32 v99, -4, v99
    v_max_u32 v99, 4, v99
    v_and_b32 v97, 0xfffc, v54
    v_bfm_b32 v96, v88, v89
    v_add_u32_dpp v91, v99, v99 row_shr:1 row_mask:0xf bank_mask:0xf bound_ctrl:1
    v_mad_u32_u24 v97, v97, 5, v2
    v_cmp_lt_u32 vcc, 16, v99
    v_add_u32_dpp v91, v91, v91 row_shr:2 row_mask:0xf bank_mask:0xf bound_ctrl:1
    v_sub_u32 v98, s38, v99
    v_lshrrev_b64 v[54:55], 16, v[54:55]
    v_add_u32_dpp v91, v91, v91 row_shr:4 row_mask:0xf bank_mask:0xf bound_ctrl:1
    v_lshrrev_b64 v[62:63], 16, v[62:63]
    s_mov_b32 s43, 0
    v_add_u32_dpp v91, v91, v91 row_shr:8 row_mask:0xf bank_mask:0xf bound_ctrl:1
    s_nop 1
    v_add_u32_dpp v91, v91, v91 row_bcast:15 row_mask:0xa bank_mask:0xf
    s_nop 1
    v_add_u32_dpp v91, v91, v91 row_bcast:31 row_mask:0xc bank_mask:0xf
    v_add_u32 v98, v98, v91
    v_readlane_b32 s37, v91, 63
    s_cbranch_vccnz L2_xo99
L2_xp99:
    buffer_load_dwordx4 v[112:115], v3, s[16:19], s40 offen offset:1024
    s_waitcnt lgkmcnt(0)
    v_cmpx_ne_u64 vcc, v[74:75], v[70:71]
    s_and_b64 s[82:83], vcc, s[80:81]
    s_cbranch_scc1 L2_c100
L2_d100:
    v_mov_b64 v[84:85], v[70:71]
    v_mov_b32 v7, v95
    v_mov_b64 v[86:87], v[74:75]
    s_mov_b64 exec, -1
    s_or_b64 s[80:81], s[80:81], vcc
    v_cmpx_ne_u64 vcc, v[72:73], v[68:69]
    s_and_b64 s[82:83], vcc, s[80:81]
    s_cbranch_scc1 L2_c101
L2_d101:
    v_mov_b64 v[84:85], v[68:69]
    v_mov_b32 v7, v94
    v_mov_b64 v[86:87], v[72:73]
    s_mov_b64 exec, -1
    s_or_b64 s[80:81], s[80:81], vcc
    ds_read_b64 v[70:71], v93
    s_and_b64 exec, s[84:85], s[80:81]
    v_mfma_f32_4x4x4_16b_bf16 v[76:79], v[12:13], v[84:85], 0
    v_mov_b32 v92, v7
    s_andn2_b64 s[80:81], s[80:81], s[84:85]
    v_mfma_f32_4x4x4_16b_bf16 v[76:79], v[10:11], v[86:87], v[76:79]
    s_mov_b64 exec, -1
    ds_read_b64 v[68:69], v92
    v_and_b32 v46, 0x80000000, v27
    v_lshrrev_b32 v47, 14, v25
    v_bitop3_b32 v47, v47, v5, v46 bitop3:0xea
    ds_read_b64 v[106:107], v47 offset:63616
    v_bitop3_b32 v95, v25, v5, v46 bitop3:0xea
    v_and_b32 v46, 0x40000000, v27
    v_lshrrev_b32 v47, 14, v24
    v_bitop3_b32 v47, v47, v5, v46 bitop3:0xea
    ds_read_b64 v[104:105], v47 offset:63616
    v_bitop3_b32 v94, v24, v5, v46 bitop3:0xea
    s_waitcnt lgkmcnt(2)
    v_mfma_f32_4x4x4_16b_bf16 v[80:83], v[10:11], v[70:71], v[80:83]
    v_mfma_f32_4x4x4_16b_bf16 v[76:79], v[10:11], v[68:69], v[76:79]
    v_perm_b32 v15, v25, v26, s47
    v_bitop3_b32 v46, v25, 0.5, -0.5 bitop3:0xa8
    v_perm_b32 v14, v24, v26, s46
    v_bitop3_b32 v47, v24, 0.5, -0.5 bitop3:0xa8
    v_cvt_pk_bf16_f32 v80, v80, v81
    v_cvt_pk_bf16_f32 v81, v82, v83
    ds_wrxchg_rtn_b64 v[74:75], v93, v[80:81]
    v_cvt_pk_bf16_f32 v76, v76, v77
    v_cvt_pk_bf16_f32 v77, v78, v79
    ds_wrxchg_rtn_b64 v[72:73], v92, v[76:77]
    s_setprio 1
    s_waitcnt lgkmcnt(2)
    v_mfma_f32_4x4x4_16b_bf16 v[80:83], v[8:9], v[106:107], 0
    v_mfma_f32_4x4x4_16b_bf16 v[76:79], v[8:9], v[104:105], 0
    v_bitop3_b32 v15, v6, v15, v46 bitop3:0xca
    v_bitop3_b32 v14, v6, v14, v47 bitop3:0xca
    s_nop 1
    v_pk_mul_f32 v[80:81], v[80:81], v[14:15] op_sel:[0,1] op_sel_hi:[1,1]
    v_pk_mul_f32 v[82:83], v[82:83], v[14:15] op_sel:[0,1] op_sel_hi:[1,1]
    v_pk_mul_f32 v[76:77], v[76:77], v[14:15] op_sel:[0,0] op_sel_hi:[1,0]
    v_pk_mul_f32 v[78:79], v[78:79], v[14:15] op_sel:[0,0] op_sel_hi:[1,0]
    v_and_b32 v47, 0x0fffffff, v41
    v_mov_b32 v27, v41
    buffer_load_dwordx4 v[22:25], v47, s[8:11], 0 offen
    buffer_load_dwordx3 v[24:26], v47, s[8:11], 0 offen offset:8
    s_waitcnt lgkmcnt(0)
    v_cmpx_ne_u64 vcc, v[74:75], v[70:71]
    s_and_b64 s[82:83], vcc, s[80:81]
    s_cbranch_scc1 L2_c102
L2_d102:
    v_mov_b64 v[84:85], v[70:71]
    v_mov_b32 v7, v93
    v_mov_b64 v[86:87], v[74:75]
    s_mov_b64 exec, -1
    s_or_b64 s[80:81], s[80:81], vcc
    v_cmpx_ne_u64 vcc, v[72:73], v[68:69]
    s_and_b64 s[82:83], vcc, s[80:81]
    s_cbranch_scc1 L2_c103
L2_d103:
    v_mov_b64 v[84:85], v[68:69]
    v_mov_b32 v7, v92
    v_mov_b64 v[86:87], v[72:73]
    s_mov_b64 exec, -1
    s_or_b64 s[80:81], s[80:81], vcc
    ds_read_b64 v[70:71], v95
    ds_read_b64 v[68:69], v94
    s_waitcnt vmcnt(11)
    v_and_b32 v46, 0x20000000, v33
    v_lshrrev_b32 v47, 14, v29
    v_bitop3_b32 v47, v47, v5, v46 bitop3:0xea
    ds_read_b64 v[102:103], v47 offset:63616
    v_bitop3_b32 v93, v29, v5, v46 bitop3:0xea
    v_and_b32 v46, 0x10000000, v33
    v_lshrrev_b32 v47, 14, v28
    v_bitop3_b32 v47, v47, v5, v46 bitop3:0xea
    ds_read_b64 v[100:101], v47 offset:63616
    v_bitop3_b32 v92, v28, v5, v46 bitop3:0xea
    s_waitcnt lgkmcnt(2)
    v_mfma_f32_4x4x4_16b_bf16 v[80:83], v[10:11], v[70:71], v[80:83]
    v_mfma_f32_4x4x4_16b_bf16 v[76:79], v[10:11], v[68:69], v[76:79]
    v_perm_b32 v15, v29, v32, s45
    v_bitop3_b32 v46, v29, 0.5, -0.5 bitop3:0xa8
    v_perm_b32 v14, v28, v32, s44
    v_bitop3_b32 v47, v28, 0.5, -0.5 bitop3:0xa8
    v_cvt_pk_bf16_f32 v80, v80, v81
    v_cvt_pk_bf16_f32 v81, v82, v83
    ds_wrxchg_rtn_b64 v[74:75], v95, v[80:81]
    v_cvt_pk_bf16_f32 v76, v76, v77
    v_cvt_pk_bf16_f32 v77, v78, v79
    ds_wrxchg_rtn_b64 v[72:73], v94, v[76:77]
    s_waitcnt lgkmcnt(2)
    v_mfma_f32_4x4x4_16b_bf16 v[80:83], v[8:9], v[102:103], 0
    v_mfma_f32_4x4x4_16b_bf16 v[76:79], v[8:9], v[100:101], 0
    v_bitop3_b32 v15, v6, v15, v46 bitop3:0xca
    v_bitop3_b32 v14, v6, v14, v47 bitop3:0xca
    v_cmp_lt_u32 s[84:85], v5, v92
    s_nop 0
    v_pk_mul_f32 v[80:81], v[80:81], v[14:15] op_sel:[0,1] op_sel_hi:[1,1]
    v_pk_mul_f32 v[82:83], v[82:83], v[14:15] op_sel:[0,1] op_sel_hi:[1,1]
    v_pk_mul_f32 v[76:77], v[76:77], v[14:15] op_sel:[0,0] op_sel_hi:[1,0]
    v_pk_mul_f32 v[78:79], v[78:79], v[14:15] op_sel:[0,0] op_sel_hi:[1,0]
    s_waitcnt lgkmcnt(0)
    v_cmpx_ne_u64 vcc, v[74:75], v[70:71]
    s_and_b64 s[82:83], vcc, s[80:81]
    s_cbranch_scc1 L2_c104
L2_d104:
    v_mov_b64 v[84:85], v[70:71]
    v_mov_b32 v7, v95
    v_mov_b64 v[86:87], v[74:75]
    s_mov_b64 exec, -1
    s_or_b64 s[80:81], s[80:81], vcc
    v_cmpx_ne_u64 vcc, v[72:73], v[68:69]
    s_and_b64 s[82:83], vcc, s[80:81]
    s_cbranch_scc1 L2_c105
L2_d105:
    v_mov_b64 v[84:85], v[68:69]
    v_mov_b32 v7, v94
    v_mov_b64 v[86:87], v[72:73]
    s_mov_b64 exec, -1
    s_or_b64 s[80:81], s[80:81], vcc
    ds_read_b64 v[70:71], v93
    s_and_b64 exec, s[84:85], s[80:81]
    v_mfma_f32_4x4x4_16b_bf16 v[76:79], v[12:13], v[84:85], 0
    v_mov_b32 v92, v7
    s_andn2_b64 s[80:81], s[80:81], s[84:85]
    v_mfma_f32_4x4x4_16b_bf16 v[76:79], v[10:11], v[86:87], v[76:79]
    s_mov_b64 exec, -1
    ds_read_b64 v[68:69], v92
    v_and_b32 v46, 0x80000000, v33
    v_lshrrev_b32 v47, 14, v31
    v_bitop3_b32 v47, v47, v5, v46 bitop3:0xea
    ds_read_b64 v[106:107], v47 offset:63616
    v_bitop3_b32 v95, v31, v5, v46 bitop3:0xea
    v_and_b32 v46, 0x40000000, v33
    v_lshrrev_b32 v47, 14, v30
    v_bitop3_b32 v47, v47, v5, v46 bitop3:0xea
    ds_read_b64 v[104:105], v47 offset:63616
    v_bitop3_b32 v94, v30, v5, v46 bitop3:0xea
    s_waitcnt lgkmcnt(2)
    v_mfma_f32_4x4x4_16b_bf16 v[80:83], v[10:11], v[70:71], v[80:83]
    v_mfma_f32_4x4x4_16b_bf16 v[76:79], v[10:11], v[68:69], v[76:79]
    v_perm_b32 v15, v31, v32, s47
    v_bitop3_b32 v46, v31, 0.5, -0.5 bitop3:0xa8
    v_perm_b32 v14, v30, v32, s46
    v_bitop3_b32 v47, v30, 0.5, -0.5 bitop3:0xa8
    v_cvt_pk_bf16_f32 v80, v80, v81
    v_cvt_pk_bf16_f32 v81, v82, v83
    ds_wrxchg_rtn_b64 v[74:75], v93, v[80:81]
    v_cvt_pk_bf16_f32 v76, v76, v77
    v_cvt_pk_bf16_f32 v77, v78, v79
    ds_wrxchg_rtn_b64 v[72:73], v92, v[76:77]
    s_setprio 0
    s_waitcnt lgkmcnt(2)
    v_mfma_f32_4x4x4_16b_bf16 v[80:83], v[8:9], v[106:107], 0
    v_mfma_f32_4x4x4_16b_bf16 v[76:79], v[8:9], v[104:105], 0
    v_bitop3_b32 v15, v6, v15, v46 bitop3:0xca
    v_bitop3_b32 v14, v6, v14, v47 bitop3:0xca
    s_nop 1
    v_pk_mul_f32 v[80:81], v[80:81], v[14:15] op_sel:[0,1] op_sel_hi:[1,1]
    v_pk_mul_f32 v[82:83], v[82:83], v[14:15] op_sel:[0,1] op_sel_hi:[1,1]
    v_pk_mul_f32 v[76:77], v[76:77], v[14:15] op_sel:[0,0] op_sel_hi:[1,0]
    v_pk_mul_f32 v[78:79], v[78:79], v[14:15] op_sel:[0,0] op_sel_hi:[1,0]
    s_add_u32 s40, s40, 0x4e200
    v_and_b32 v47, 0x0fffffff, v42
    v_mov_b32 v33, v42
    buffer_load_dwordx4 v[28:31], v47, s[8:11], 0 offen
    buffer_load_dwordx3 v[30:32], v47, s[8:11], 0 offen offset:8
    s_waitcnt lgkmcnt(0)
    v_cmpx_ne_u64 vcc, v[74:75], v[70:71]
    s_and_b64 s[82:83], vcc, s[80:81]
    s_cbranch_scc1 L2_c106
L2_d106:
    v_mov_b64 v[84:85], v[70:71]
    v_mov_b32 v7, v93
    v_mov_b64 v[86:87], v[74:75]
    s_mov_b64 exec, -1
    s_or_b64 s[80:81], s[80:81], vcc
    v_cmpx_ne_u64 vcc, v[72:73], v[68:69]
    s_and_b64 s[82:83], vcc, s[80:81]
    s_cbranch_scc1 L2_c107
L2_d107:
    v_mov_b64 v[84:85], v[68:69]
    v_mov_b32 v7, v92
    v_mov_b64 v[86:87], v[72:73]
    s_mov_b64 exec, -1
    s_or_b64 s[80:81], s[80:81], vcc
    ds_read_b64 v[70:71], v95
    ds_read_b64 v[68:69], v94
    s_waitcnt vmcnt(8)
    v_and_b32 v46, 0x20000000, v39
    v_lshrrev_b32 v47, 14, v35
    v_bitop3_b32 v47, v47, v5, v46 bitop3:0xea
    ds_read_b64 v[102:103], v47 offset:63616
    v_bitop3_b32 v93, v35, v5, v46 bitop3:0xea
    v_and_b32 v46, 0x10000000, v39
    v_lshrrev_b32 v47, 14, v34
    v_bitop3_b32 v47, v47, v5, v46 bitop3:0xea
    ds_read_b64 v[100:101], v47 offset:63616
    v_bitop3_b32 v92, v34, v5, v46 bitop3:0xea
    v_and_b32 v46, 0x80000000, v39
    v_lshrrev_b32 v47, 14, v37
    v_bitop3_b32 v47, v47, v5, v46 bitop3:0xea
    ds_read_b64 v[106:107], v47 offset:63616
    v_and_b32 v46, 0x40000000, v39
    v_lshrrev_b32 v47, 14, v36
    v_bitop3_b32 v47, v47, v5, v46 bitop3:0xea
    ds_read_b64 v[104:105], v47 offset:63616
    s_waitcnt lgkmcnt(4)
    v_mfma_f32_4x4x4_16b_bf16 v[80:83], v[10:11], v[70:71], v[80:83]
    v_mfma_f32_4x4x4_16b_bf16 v[76:79], v[10:11], v[68:69], v[76:79]
    v_perm_b32 v15, v35, v38, s45
    v_bitop3_b32 v46, v35, 0.5, -0.5 bitop3:0xa8
    v_perm_b32 v14, v34, v38, s44
    v_bitop3_b32 v47, v34, 0.5, -0.5 bitop3:0xa8
    v_cvt_pk_bf16_f32 v80, v80, v81
    v_cvt_pk_bf16_f32 v81, v82, v83
    ds_wrxchg_rtn_b64 v[74:75], v95, v[80:81]
    v_cvt_pk_bf16_f32 v76, v76, v77
    v_cvt_pk_bf16_f32 v77, v78, v79
    ds_wrxchg_rtn_b64 v[72:73], v94, v[76:77]
    s_waitcnt lgkmcnt(2)
    s_barrier
    s_setprio 3
    ds_write_b128 v3, v[124:127] offset:4096
    s_add_u32 s3, s40, 4096
    buffer_load_dwordx4 v[124:127], v3, s[16:19], s3 offen
    ds_write_b128 v3, v[116:119] offset:2048
    buffer_load_dwordx4 v[116:119], v3, s[16:19], s40 offen offset:2048
    ds_write_b128 v3, v[120:123] offset:3072
    buffer_load_dwordx4 v[120:123], v3, s[16:19], s40 offen offset:3072
    v_mfma_f32_4x4x4_16b_bf16 v[80:83], v[8:9], v[102:103], 0
    v_mfma_f32_4x4x4_16b_bf16 v[76:79], v[8:9], v[100:101], 0
    v_bitop3_b32 v15, v6, v15, v46 bitop3:0xca
    v_bitop3_b32 v14, v6, v14, v47 bitop3:0xca
    v_cmp_lt_u32 s[84:85], v5, v92
    s_nop 0
    v_pk_mul_f32 v[80:81], v[80:81], v[14:15] op_sel:[0,1] op_sel_hi:[1,1]
    v_pk_mul_f32 v[82:83], v[82:83], v[14:15] op_sel:[0,1] op_sel_hi:[1,1]
    v_pk_mul_f32 v[76:77], v[76:77], v[14:15] op_sel:[0,0] op_sel_hi:[1,0]
    v_pk_mul_f32 v[78:79], v[78:79], v[14:15] op_sel:[0,0] op_sel_hi:[1,0]
    v_mov_b32 v44, v43
    s_cmp_gt_u32 s37, 1024
    s_cbranch_scc1 L2_xs108
    s_cmp_lg_u32 s43, 0
    s_cbranch_scc1 L2_xa108
L2_xb108:
    v_lshlrev_b32 v89, 16, v96
    v_add_u32 v90, 60, v97
    v_bitop3_b32 v90, v89, v45, v90 bitop3:0x6a
    ds_write_b32 v98, v90 offset:12
    v_lshlrev_b32 v89, 20, v96
    v_add_u32 v90, 40, v97
    v_bitop3_b32 v90, v89, v45, v90 bitop3:0x6a
    ds_write_b32 v98, v90 offset:8
    v_lshlrev_b32 v89, 24, v96
    v_add_u32 v90, 20, v97
    v_bitop3_b32 v90, v89, v45, v90 bitop3:0x6a
    ds_write_b32 v98, v90 offset:4
    v_lshlrev_b32 v89, 28, v96
    v_bitop3_b32 v90, v89, v45, v97 bitop3:0x6a
    ds_write_b32 v98, v90 offset:0
    v_mov_b32_dpp v91, v66 quad_perm:[1,1,1,1] row_mask:0xf bank_mask:0xf
    v_and_b32 v89, 3, v91
    v_and_b32 v97, 0xfffc, v91
    v_sub_u16_dpp v88, v66, v91 quad_perm:[3,3,3,3] row_mask:0xf bank_mask:0xf
    v_mad_u32_u24 v97, v97, 5, v4
    v_add_u32 v99, v88, v89
    v_bfm_b32 v96, v88, v89
    v_cmp_lt_u32 s[58:59], 16, v99
    v_lshlrev_b32 v89, v1, v96
    v_and_b32 v89, v45, v89
    v_cmp_ne_u32 vcc, 0, v89
    v_xor_b32 v90, v97, v89
    s_add_u32 s3, s37, s38
    v_mbcnt_lo_u32_b32 v98, vcc_lo, 0
    v_mbcnt_hi_u32_b32 v98, vcc_hi, v98
    s_bcnt1_i32_b64 s41, vcc
    v_lshl_add_u32 v98, v98, 2, s3
    s_mov_b64 exec, vcc
    ds_write_b32 v98, v90
    s_mov_b64 exec, -1
    s_lshl2_add_u32 s37, s41, s37
    s_cmp_lg_u64 s[58:59], 0
    s_cbranch_scc1 L2_xe108
L2_xr108:
    v_add_u32 v98, s37, v0
    v_mov_b32 v90, -1
    ds_write_b32 v98, v90
    ds_read2st64_b32 v[40:41], v0 offset0:0 offset1:1
    ds_read2st64_b32 v[42:43], v0 offset0:2 offset1:3
    s_sub_u32 s3, s37, 768
    s_cmp_gt_u32 s3, 256
    s_cbranch_scc1 L2_xf108
L2_xg108:
    v_lshrrev_b64 v[64:65], 16, v[64:65]
    v_lshrrev_b64 v[66:67], 16, v[66:67]
    s_setprio 2
    s_waitcnt vmcnt(10)
    ds_write_b128 v3, v[108:111] offset:0
    s_waitcnt lgkmcnt(12)
    v_cmpx_ne_u64 vcc, v[74:75], v[70:71]
    s_and_b64 s[82:83], vcc, s[80:81]
    s_cbranch_scc1 L2_c109
L2_d109:
    v_mov_b64 v[84:85], v[70:71]
    v_mov_b32 v7, v95
    v_mov_b64 v[86:87], v[74:75]
    s_mov_b64 exec, -1
    s_or_b64 s[80:81], s[80:81], vcc
    v_cmpx_ne_u64 vcc, v[72:73], v[68:69]
    s_and_b64 s[82:83], vcc, s[80:81]
    s_cbranch_scc1 L2_c110
L2_d110:
    v_mov_b64 v[84:85], v[68:69]
    v_mov_b32 v7, v94
    v_mov_b64 v[86:87], v[72:73]
    s_mov_b64 exec, -1
    s_or_b64 s[80:81], s[80:81], vcc
    ds_read_b64 v[70:71], v93
    s_and_b64 exec, s[84:85], s[80:81]
    v_mfma_f32_4x4x4_16b_bf16 v[76:79], v[12:13], v[84:85], 0
    v_mov_b32 v92, v7
    s_andn2_b64 s[80:81], s[80:81], s[84:85]
    v_mfma_f32_4x4x4_16b_bf16 v[76:79], v[10:11], v[86:87], v[76:79]
    s_mov_b64 exec, -1
    ds_read_b64 v[68:69], v92
    s_setprio 1
    s_waitcnt vmcnt(7)
    ds_write_b128 v3, v[112:115] offset:1024
    s_waitcnt lgkmcnt(1)
    v_mfma_f32_4x4x4_16b_bf16 v[80:83], v[10:11], v[70:71], v[80:83]
    v_mfma_f32_4x4x4_16b_bf16 v[76:79], v[10:11], v[68:69], v[76:79]
    v_and_b32 v46, 0x40000000, v39
    v_bitop3_b32 v94, v36, v5, v46 bitop3:0xea
    v_and_b32 v46, 0x80000000, v39
    v_bitop3_b32 v95, v37, v5, v46 bitop3:0xea
    v_perm_b32 v15, v37, v38, s47
    v_bitop3_b32 v46, v37, 0.5, -0.5 bitop3:0xa8
    v_perm_b32 v14, v36, v38, s46
    v_bitop3_b32 v47, v36, 0.5, -0.5 bitop3:0xa8
    v_cvt_pk_bf16_f32 v80, v80, v81
    v_cvt_pk_bf16_f32 v81, v82, v83
    ds_wrxchg_rtn_b64 v[74:75], v93, v[80:81]
    v_cvt_pk_bf16_f32 v76, v76, v77
    v_cvt_pk_bf16_f32 v77, v78, v79
    ds_wrxchg_rtn_b64 v[72:73], v92, v[76:77]
    s_setprio 0
    v_mfma_f32_4x4x4_16b_bf16 v[80:83], v[8:9], v[106:107], 0
    v_mfma_f32_4x4x4_16b_bf16 v[76:79], v[8:9], v[104:105], 0
    v_bitop3_b32 v15, v6, v15, v46 bitop3:0xca
    v_bitop3_b32 v14, v6, v14, v47 bitop3:0xca
    s_nop 1
    v_pk_mul_f32 v[80:81], v[80:81], v[14:15] op_sel:[0,1] op_sel_hi:[1,1]
    v_pk_mul_f32 v[82:83], v[82:83], v[14:15] op_sel:[0,1] op_sel_hi:[1,1]
    v_pk_mul_f32 v[76:77], v[76:77], v[14:15] op_sel:[0,0] op_sel_hi:[1,0]
    v_pk_mul_f32 v[78:79], v[78:79], v[14:15] op_sel:[0,0] op_sel_hi:[1,0]
    s_add_u32 s42, s42, 1
    s_waitcnt lgkmcnt(2)
    s_cmp_lg_u32 s42, 14
    s_cbranch_scc1 L2_loop
    s_barrier
    s_bitcmp1_b32 s36, s42
    s_cbranch_scc1 L2_slow
L2_ret6:
    s_setprio 3
    v_and_b32 v47, 0x0fffffff, v44
    v_mov_b32 v39, v44
    buffer_load_dwordx4 v[34:37], v47, s[8:11], 0 offen
    buffer_load_dwordx3 v[36:38], v47, s[8:11], 0 offen offset:8
    s_waitcnt lgkmcnt(0)
    v_cmpx_ne_u64 vcc, v[74:75], v[70:71]
    s_and_b64 s[82:83], vcc, s[80:81]
    s_cbranch_scc1 L2_c111
L2_d111:
    v_mov_b64 v[84:85], v[70:71]
    v_mov_b32 v7, v93
    v_mov_b64 v[86:87], v[74:75]
    s_mov_b64 exec, -1
    s_or_b64 s[80:81], s[80:81], vcc
    v_cmpx_ne_u64 vcc, v[72:73], v[68:69]
    s_and_b64 s[82:83], vcc, s[80:81]
    s_cbranch_scc1 L2_c112
L2_d112:
    v_mov_b64 v[84:85], v[68:69]
    v_mov_b32 v7, v92
    v_mov_b64 v[86:87], v[72:73]
    s_mov_b64 exec, -1
    s_or_b64 s[80:81], s[80:81], vcc
    ds_read_b64 v[70:71], v95
    ds_read_b64 v[68:69], v94
    v_and_b32 v46, 0x20000000, v21
    v_lshrrev_b32 v47, 14, v17
    v_bitop3_b32 v47, v47, v5, v46 bitop3:0xea
    ds_read_b64 v[102:103], v47 offset:63616
    v_bitop3_b32 v93, v17, v5, v46 bitop3:0xea
    v_and_b32 v46, 0x10000000, v21
    v_lshrrev_b32 v47, 14, v16
    v_bitop3_b32 v47, v47, v5, v46 bitop3:0xea
    ds_read_b64 v[100:101], v47 offset:63616
    v_bitop3_b32 v92, v16, v5, v46 bitop3:0xea
    s_waitcnt lgkmcnt(2)
    v_mfma_f32_4x4x4_16b_bf16 v[80:83], v[10:11], v[70:71], v[80:83]
    v_mfma_f32_4x4x4_16b_bf16 v[76:79], v[10:11], v[68:69], v[76:79]
    v_perm_b32 v15, v17, v20, s45
    v_bitop3_b32 v46, v17, 0.5, -0.5 bitop3:0xa8
    v_perm_b32 v14, v16, v20, s44
    v_bitop3_b32 v47, v16, 0.5, -0.5 bitop3:0xa8
    v_cvt_pk_bf16_f32 v80, v80, v81
    v_cvt_pk_bf16_f32 v81, v82, v83
    ds_wrxchg_rtn_b64 v[74:75], v95, v[80:81]
    v_cvt_pk_bf16_f32 v76, v76, v77
    v_cvt_pk_bf16_f32 v77, v78, v79
    ds_wrxchg_rtn_b64 v[72:73], v94, v[76:77]
    s_waitcnt lgkmcnt(2)
    v_mfma_f32_4x4x4_16b_bf16 v[80:83], v[8:9], v[102:103], 0
    v_mfma_f32_4x4x4_16b_bf16 v[76:79], v[8:9], v[100:101], 0
    v_bitop3_b32 v15, v6, v15, v46 bitop3:0xca
    v_bitop3_b32 v14, v6, v14, v47 bitop3:0xca
    v_cmp_lt_u32 s[84:85], v5, v92
    s_nop 0
    v_pk_mul_f32 v[80:81], v[80:81], v[14:15] op_sel:[0,1] op_sel_hi:[1,1]
    v_pk_mul_f32 v[82:83], v[82:83], v[14:15] op_sel:[0,1] op_sel_hi:[1,1]
    v_pk_mul_f32 v[76:77], v[76:77], v[14:15] op_sel:[0,0] op_sel_hi:[1,0]
    v_pk_mul_f32 v[78:79], v[78:79], v[14:15] op_sel:[0,0] op_sel_hi:[1,0]
    buffer_load_dwordx4 v[108:111], v3, s[16:19], s40 offen offset:0
    s_waitcnt lgkmcnt(0)
    v_cmpx_ne_u64 vcc, v[74:75], v[70:71]
    s_and_b64 s[82:83], vcc, s[80:81]
    s_cbranch_scc1 L2_c113
L2_d113:
    v_mov_b64 v[84:85], v[70:71]
    v_mov_b32 v7, v95
    v_mov_b64 v[86:87], v[74:75]
    s_mov_b64 exec, -1
    s_or_b64 s[80:81], s[80:81], vcc
    v_cmpx_ne_u64 vcc, v[72:73], v[68:69]
    s_and_b64 s[82:83], vcc, s[80:81]
    s_cbranch_scc1 L2_c114
L2_d114:
    v_mov_b64 v[84:85], v[68:69]
    v_mov_b32 v7, v94
    v_mov_b64 v[86:87], v[72:73]
    s_mov_b64 exec, -1
    s_or_b64 s[80:81], s[80:81], vcc
    ds_read_b64 v[70:71], v93
    s_and_b64 exec, s[84:85], s[80:81]
    v_mfma_f32_4x4x4_16b_bf16 v[76:79], v[12:13], v[84:85], 0
    v_mov_b32 v92, v7
    s_andn2_b64 s[80:81], s[80:81], s[84:85]
    v_mfma_f32_4x4x4_16b_bf16 v[76:79], v[10:11], v[86:87], v[76:79]
    s_mov_b64 exec, -1
    ds_read_b64 v[68:69], v92
    v_and_b32 v46, 0x80000000, v21
    v_lshrrev_b32 v47, 14, v19
    v_bitop3_b32 v47, v47, v5, v46 bitop3:0xea
    ds_read_b64 v[106:107], v47 offset:63616
    v_bitop3_b32 v95, v19, v5, v46 bitop3:0xea
    v_and_b32 v46, 0x40000000, v21
    v_lshrrev_b32 v47, 14, v18
    v_bitop3_b32 v47, v47, v5, v46 bitop3:0xea
    ds_read_b64 v[104:105], v47 offset:63616
    v_bitop3_b32 v94, v18, v5, v46 bitop3:0xea
    s_waitcnt lgkmcnt(2)
    v_mfma_f32_4x4x4_16b_bf16 v[80:83], v[10:11], v[70:71], v[80:83]
    v_mfma_f32_4x4x4_16b_bf16 v[76:79], v[10:11], v[68:69], v[76:79]
    v_perm_b32 v15, v19, v20, s47
    v_bitop3_b32 v46, v19, 0.5, -0.5 bitop3:0xa8
    v_perm_b32 v14, v18, v20, s46
    v_bitop3_b32 v47, v18, 0.5, -0.5 bitop3:0xa8
    v_cvt_pk_bf16_f32 v80, v80, v81
    v_cvt_pk_bf16_f32 v81, v82, v83
    ds_wrxchg_rtn_b64 v[74:75], v93, v[80:81]
    v_cvt_pk_bf16_f32 v76, v76, v77
    v_cvt_pk_bf16_f32 v77, v78, v79
    ds_wrxchg_rtn_b64 v[72:73], v92, v[76:77]
    s_setprio 2
    s_waitcnt lgkmcnt(2)
    v_mfma_f32_4x4x4_16b_bf16 v[80:83], v[8:9], v[106:107], 0
    v_mfma_f32_4x4x4_16b_bf16 v[76:79], v[8:9], v[104:105], 0
    v_bitop3_b32 v15, v6, v15, v46 bitop3:0xca
    v_bitop3_b32 v14, v6, v14, v47 bitop3:0xca
    s_nop 1
    v_pk_mul_f32 v[80:81], v[80:81], v[14:15] op_sel:[0,1] op_sel_hi:[1,1]
    v_pk_mul_f32 v[82:83], v[82:83], v[14:15] op_sel:[0,1] op_sel_hi:[1,1]
    v_pk_mul_f32 v[76:77], v[76:77], v[14:15] op_sel:[0,0] op_sel_hi:[1,0]
    v_pk_mul_f32 v[78:79], v[78:79], v[14:15] op_sel:[0,0] op_sel_hi:[1,0]
    v_and_b32 v47, 0x0fffffff, v40
    v_mov_b32 v21, v40
    buffer_load_dwordx4 v[16:19], v47, s[8:11], 0 offen
    buffer_load_dwordx3 v[18:20], v47, s[8:11], 0 offen offset:8
    s_waitcnt lgkmcnt(0)
    v_cmpx_ne_u64 vcc, v[74:75], v[70:71]
    s_and_b64 s[82:83], vcc, s[80:81]
    s_cbranch_scc1 L2_c115
L2_d115:
    v_mov_b64 v[84:85], v[70:71]
    v_mov_b32 v7, v93
    v_mov_b64 v[86:87], v[74:75]
    s_mov_b64 exec, -1
    s_or_b64 s[80:81], s[80:81], vcc
    v_cmpx_ne_u64 vcc, v[72:73], v[68:69]
    s_and_b64 s[82:83], vcc, s[80:81]
    s_cbranch_scc1 L2_c116
L2_d116:
    v_mov_b64 v[84:85], v[68:69]
    v_mov_b32 v7, v92
    v_mov_b64 v[86:87], v[72:73]
    s_mov_b64 exec, -1
    s_or_b64 s[80:81], s[80:81], vcc
    ds_read_b64 v[70:71], v95
    ds_read_b64 v[68:69], v94
    s_waitcnt vmcnt(10)
    v_and_b32 v46, 0x20000000, v27
    v_lshrrev_b32 v47, 14, v23
    v_bitop3_b32 v47, v47, v5, v46 bitop3:0xea
    ds_read_b64 v[102:103], v47 offset:63616
    v_bitop3_b32 v93, v23, v5, v46 bitop3:0xea
    v_and_b32 v46, 0x10000000, v27
    v_lshrrev_b32 v47, 14, v22
    v_bitop3_b32 v47, v47, v5, v46 bitop3:0xea
    ds_read_b64 v[100:101], v47 offset:63616
    v_bitop3_b32 v92, v22, v5, v46 bitop3:0xea
    s_waitcnt lgkmcnt(2)
    v_mfma_f32_4x4x4_16b_bf16 v[80:83], v[10:11], v[70:71], v[80:83]
    v_mfma_f32_4x4x4_16b_bf16 v[76:79], v[10:11], v[68:69], v[76:79]
    v_perm_b32 v15, v23, v26, s45
    v_bitop3_b32 v46, v23, 0.5, -0.5 bitop3:0xa8
    v_perm_b32 v14, v22, v26, s44
    v_bitop3_b32 v47, v22, 0.5, -0.5 bitop3:0xa8
    v_cvt_pk_bf16_f32 v80, v80, v81
    v_cvt_pk_bf16_f32 v81, v82, v83
    ds_wrxchg_rtn_b64 v[74:75], v95, v[80:81]
    v_cvt_pk_bf16_f32 v76, v76, v77
    v_cvt_pk_bf16_f32 v77, v78, v79
    ds_wrxchg_rtn_b64 v[72:73], v94, v[76:77]
    s_waitcnt lgkmcnt(2)
    v_mfma_f32_4x4x4_16b_bf16 v[80:83], v[8:9], v[102:103], 0
    v_mfma_f32_4x4x4_16b_bf16 v[76:79], v[8:9], v[100:101], 0
    v_bitop3_b32 v15, v6, v15, v46 bitop3:0xca
    v_bitop3_b32 v14, v6, v14, v47 bitop3:0xca
    v_cmp_lt_u32 s[84:85], v5, v92
    s_nop 0
    v_pk_mul_f32 v[80:81], v[80:81], v[14:15] op_sel:[0,1] op_sel_hi:[1,1]
    v_pk_mul_f32 v[82:83], v[82:83], v[14:15] op_sel:[0,1] op_sel_hi:[1,1]
    v_pk_mul_f32 v[76:77], v[76:77], v[14:15] op_sel:[0,0] op_sel_hi:[1,0]
    v_pk_mul_f32 v[78:79], v[78:79], v[14:15] op_sel:[0,0] op_sel_hi:[1,0]
    buffer_load_dwordx4 v[112:115], v3, s[16:19], s40 offen offset:1024
    s_waitcnt lgkmcnt(0)
    v_cmpx_ne_u64 vcc, v[74:75], v[70:71]
    s_and_b64 s[82:83], vcc, s[80:81]
    s_cbranch_scc1 L2_c117
L2_d117:
    v_mov_b64 v[84:85], v[70:71]
    v_mov_b32 v7, v95
    v_mov_b64 v[86:87], v[74:75]
    s_mov_b64 exec, -1
    s_or_b64 s[80:81], s[80:81], vcc
    v_cmpx_ne_u64 vcc, v[72:73], v[68:69]
    s_and_b64 s[82:83], vcc, s[80:81]
    s_cbranch_scc1 L2_c118
L2_d118:
    v_mov_b64 v[84:85], v[68:69]
    v_mov_b32 v7, v94
    v_mov_b64 v[86:87], v[72:73]
    s_mov_b64 exec, -1
    s_or_b64 s[80:81], s[80:81], vcc
    ds_read_b64 v[70:71], v93
    s_and_b64 exec, s[84:85], s[80:81]
    v_mfma_f32_4x4x4_16b_bf16 v[76:79], v[12:13], v[84:85], 0
    v_mov_b32 v92, v7
    s_andn2_b64 s[80:81], s[80:81], s[84:85]
    v_mfma_f32_4x4x4_16b_bf16 v[76:79], v[10:11], v[86:87], v[76:79]
    s_mov_b64 exec, -1
    ds_read_b64 v[68:69], v92
    v_and_b32 v46, 0x80000000, v27
    v_lshrrev_b32 v47, 14, v25
    v_bitop3_b32 v47, v47, v5, v46 bitop3:0xea
    ds_read_b64 v[106:107], v47 offset:63616
    v_bitop3_b32 v95, v25, v5, v46 bitop3:0xea
    v_and_b32 v46, 0x40000000, v27
    v_lshrrev_b32 v47, 14, v24
    v_bitop3_b32 v47, v47, v5, v46 bitop3:0xea
    ds_read_b64 v[104:105], v47 offset:63616
    v_bitop3_b32 v94, v24, v5, v46 bitop3:0xea
    s_waitcnt lgkmcnt(2)
    v_mfma_f32_4x4x4_16b_bf16 v[80:83], v[10:11], v[70:71], v[80:83]
    v_mfma_f32_4x4x4_16b_bf16 v[76:79], v[10:11], v[68:69], v[76:79]
    v_perm_b32 v15, v25, v26, s47
    v_bitop3_b32 v46, v25, 0.5, -0.5 bitop3:0xa8
    v_perm_b32 v14, v24, v26, s46
    v_bitop3_b32 v47, v24, 0.5, -0.5 bitop3:0xa8
    v_cvt_pk_bf16_f32 v80, v80, v81
    v_cvt_pk_bf16_f32 v81, v82, v83
    ds_wrxchg_rtn_b64 v[74:75], v93, v[80:81]
    v_cvt_pk_bf16_f32 v76, v76, v77
    v_cvt_pk_bf16_f32 v77, v78, v79
    ds_wrxchg_rtn_b64 v[72:73], v92, v[76:77]
    s_setprio 1
    s_waitcnt lgkmcnt(2)
    v_mfma_f32_4x4x4_16b_bf16 v[80:83], v[8:9], v[106:107], 0
    v_mfma_f32_4x4x4_16b_bf16 v[76:79], v[8:9], v[104:105], 0
    v_bitop3_b32 v15, v6, v15, v46 bitop3:0xca
    v_bitop3_b32 v14, v6, v14, v47 bitop3:0xca
    s_nop 1
    v_pk_mul_f32 v[80:81], v[80:81], v[14:15] op_sel:[0,1] op_sel_hi:[1,1]
    v_pk_mul_f32 v[82:83], v[82:83], v[14:15] op_sel:[0,1] op_sel_hi:[1,1]
    v_pk_mul_f32 v[76:77], v[76:77], v[14:15] op_sel:[0,0] op_sel_hi:[1,0]
    v_pk_mul_f32 v[78:79], v[78:79], v[14:15] op_sel:[0,0] op_sel_hi:[1,0]
    v_and_b32 v47, 0x0fffffff, v41
    v_mov_b32 v27, v41
    buffer_load_dwordx4 v[22:25], v47, s[8:11], 0 offen
    buffer_load_dwordx3 v[24:26], v47, s[8:11], 0 offen offset:8
    s_waitcnt lgkmcnt(0)
    v_cmpx_ne_u64 vcc, v[74:75], v[70:71]
    s_and_b64 s[82:83], vcc, s[80:81]
    s_cbranch_scc1 L2_c119
L2_d119:
    v_mov_b64 v[84:85], v[70:71]
    v_mov_b32 v7, v93
    v_mov_b64 v[86:87], v[74:75]
    s_mov_b64 exec, -1
    s_or_b64 s[80:81], s[80:81], vcc
    v_cmpx_ne_u64 vcc, v[72:73], v[68:69]
    s_and_b64 s[82:83], vcc, s[80:81]
    s_cbranch_scc1 L2_c120
L2_d120:
    v_mov_b64 v[84:85], v[68:69]
    v_mov_b32 v7, v92
    v_mov_b64 v[86:87], v[72:73]
    s_mov_b64 exec, -1
    s_or_b64 s[80:81], s[80:81], vcc
    ds_read_b64 v[70:71], v95
    ds_read_b64 v[68:69], v94
    s_waitcnt vmcnt(11)
    v_and_b32 v46, 0x20000000, v33
    v_lshrrev_b32 v47, 14, v29
    v_bitop3_b32 v47, v47, v5, v46 bitop3:0xea
    ds_read_b64 v[102:103], v47 offset:63616
    v_bitop3_b32 v93, v29, v5, v46 bitop3:0xea
    v_and_b32 v46, 0x10000000, v33
    v_lshrrev_b32 v47, 14, v28
    v_bitop3_b32 v47, v47, v5, v46 bitop3:0xea
    ds_read_b64 v[100:101], v47 offset:63616
    v_bitop3_b32 v92, v28, v5, v46 bitop3:0xea
    s_waitcnt lgkmcnt(2)
    v_mfma_f32_4x4x4_16b_bf16 v[80:83], v[10:11], v[70:71], v[80:83]
    v_mfma_f32_4x4x4_16b_bf16 v[76:79], v[10:11], v[68:69], v[76:79]
    v_perm_b32 v15, v29, v32, s45
    v_bitop3_b32 v46, v29, 0.5, -0.5 bitop3:0xa8
    v_perm_b32 v14, v28, v32, s44
    v_bitop3_b32 v47, v28, 0.5, -0.5 bitop3:0xa8
    v_cvt_pk_bf16_f32 v80, v80, v81
    v_cvt_pk_bf16_f32 v81, v82, v83
    ds_wrxchg_rtn_b64 v[74:75], v95, v[80:81]
    v_cvt_pk_bf16_f32 v76, v76, v77
    v_cvt_pk_bf16_f32 v77, v78, v79
    ds_wrxchg_rtn_b64 v[72:73], v94, v[76:77]
    s_waitcnt lgkmcnt(2)
    v_mfma_f32_4x4x4_16b_bf16 v[80:83], v[8:9], v[102:103], 0
    v_mfma_f32_4x4x4_16b_bf16 v[76:79], v[8:9], v[100:101], 0
    v_bitop3_b32 v15, v6, v15, v46 bitop3:0xca
    v_bitop3_b32 v14, v6, v14, v47 bitop3:0xca
    v_cmp_lt_u32 s[84:85], v5, v92
    s_nop 0
    v_pk_mul_f32 v[80:81], v[80:81], v[14:15] op_sel:[0,1] op_sel_hi:[1,1]
    v_pk_mul_f32 v[82:83], v[82:83], v[14:15] op_sel:[0,1] op_sel_hi:[1,1]
    v_pk_mul_f32 v[76:77], v[76:77], v[14:15] op_sel:[0,0] op_sel_hi:[1,0]
    v_pk_mul_f32 v[78:79], v[78:79], v[14:15] op_sel:[0,0] op_sel_hi:[1,0]
    s_waitcnt lgkmcnt(0)
    v_cmpx_ne_u64 vcc, v[74:75], v[70:71]
    s_and_b64 s[82:83], vcc, s[80:81]
    s_cbranch_scc1 L2_c121
L2_d121:
    v_mov_b64 v[84:85], v[70:71]
    v_mov_b32 v7, v95
    v_mov_b64 v[86:87], v[74:75]
    s_mov_b64 exec, -1
    s_or_b64 s[80:81], s[80:81], vcc
    v_cmpx_ne_u64 vcc, v[72:73], v[68:69]
    s_and_b64 s[82:83], vcc, s[80:81]
    s_cbranch_scc1 L2_c122
L2_d122:
    v_mov_b64 v[84:85], v[68:69]
    v_mov_b32 v7, v94
    v_mov_b64 v[86:87], v[72:73]
    s_mov_b64 exec, -1
    s_or_b64 s[80:81], s[80:81], vcc
    ds_read_b64 v[70:71], v93
    s_and_b64 exec, s[84:85], s[80:81]
    v_mfma_f32_4x4x4_16b_bf16 v[76:79], v[12:13], v[84:85], 0
    v_mov_b32 v92, v7
    s_andn2_b64 s[80:81], s[80:81], s[84:85]
    v_mfma_f32_4x4x4_16b_bf16 v[76:79], v[10:11], v[86:87], v[76:79]
    s_mov_b64 exec, -1
    ds_read_b64 v[68:69], v92
    v_and_b32 v46, 0x80000000, v33
    v_lshrrev_b32 v47, 14, v31
    v_bitop3_b32 v47, v47, v5, v46 bitop3:0xea
    ds_read_b64 v[106:107], v47 offset:63616
    v_bitop3_b32 v95, v31, v5, v46 bitop3:0xea
    v_and_b32 v46, 0x40000000, v33
    v_lshrrev_b32 v47, 14, v30
    v_bitop3_b32 v47, v47, v5, v46 bitop3:0xea
    ds_read_b64 v[104:105], v47 offset:63616
    v_bitop3_b32 v94, v30, v5, v46 bitop3:0xea
    s_waitcnt lgkmcnt(2)
    v_mfma_f32_4x4x4_16b_bf16 v[80:83], v[10:11], v[70:71], v[80:83]
    v_mfma_f32_4x4x4_16b_bf16 v[76:79], v[10:11], v[68:69], v[76:79]
    v_perm_b32 v15, v31, v32, s47
    v_bitop3_b32 v46, v31, 0.5, -0.5 bitop3:0xa8
    v_perm_b32 v14, v30, v32, s46
    v_bitop3_b32 v47, v30, 0.5, -0.5 bitop3:0xa8
    v_cvt_pk_bf16_f32 v80, v80, v81
    v_cvt_pk_bf16_f32 v81, v82, v83
    ds_wrxchg_rtn_b64 v[74:75], v93, v[80:81]
    v_cvt_pk_bf16_f32 v76, v76, v77
    v_cvt_pk_bf16_f32 v77, v78, v79
    ds_wrxchg_rtn_b64 v[72:73], v92, v[76:77]
    s_setprio 0
    s_waitcnt lgkmcnt(2)
    v_mfma_f32_4x4x4_16b_bf16 v[80:83], v[8:9], v[106:107], 0
    v_mfma_f32_4x4x4_16b_bf16 v[76:79], v[8:9], v[104:105], 0
    v_bitop3_b32 v15, v6, v15, v46 bitop3:0xca
    v_bitop3_b32 v14, v6, v14, v47 bitop3:0xca
    s_nop 1
    v_pk_mul_f32 v[80:81], v[80:81], v[14:15] op_sel:[0,1] op_sel_hi:[1,1]
    v_pk_mul_f32 v[82:83], v[82:83], v[14:15] op_sel:[0,1] op_sel_hi:[1,1]
    v_pk_mul_f32 v[76:77], v[76:77], v[14:15] op_sel:[0,0] op_sel_hi:[1,0]
    v_pk_mul_f32 v[78:79], v[78:79], v[14:15] op_sel:[0,0] op_sel_hi:[1,0]
    s_add_u32 s40, s40, 0xfff29280
    v_and_b32 v47, 0x0fffffff, v42
    v_mov_b32 v33, v42
    buffer_load_dwordx4 v[28:31], v47, s[8:11], 0 offen
    buffer_load_dwordx3 v[30:32], v47, s[8:11], 0 offen offset:8
    s_waitcnt lgkmcnt(0)
    v_cmpx_ne_u64 vcc, v[74:75], v[70:71]
    s_and_b64 s[82:83], vcc, s[80:81]
    s_cbranch_scc1 L2_c123
L2_d123:
    v_mov_b64 v[84:85], v[70:71]
    v_mov_b32 v7, v93
    v_mov_b64 v[86:87], v[74:75]
    s_mov_b64 exec, -1
    s_or_b64 s[80:81], s[80:81], vcc
    v_cmpx_ne_u64 vcc, v[72:73], v[68:69]
    s_and_b64 s[82:83], vcc, s[80:81]
    s_cbranch_scc1 L2_c124
L2_d124:
    v_mov_b64 v[84:85], v[68:69]
    v_mov_b32 v7, v92
    v_mov_b64 v[86:87], v[72:73]
    s_mov_b64 exec, -1
    s_or_b64 s[80:81], s[80:81], vcc
    ds_read_b64 v[70:71], v95
    ds_read_b64 v[68:69], v94
    s_waitcnt vmcnt(8)
    v_and_b32 v46, 0x20000000, v39
    v_lshrrev_b32 v47, 14, v35
    v_bitop3_b32 v47, v47, v5, v46 bitop3:0xea
    ds_read_b64 v[102:103], v47 offset:63616
    v_bitop3_b32 v93, v35, v5, v46 bitop3:0xea
    v_and_b32 v46, 0x10000000, v39
    v_lshrrev_b32 v47, 14, v34
    v_bitop3_b32 v47, v47, v5, v46 bitop3:0xea
    ds_read_b64 v[100:101], v47 offset:63616
    v_bitop3_b32 v92, v34, v5, v46 bitop3:0xea
    v_and_b32 v46, 0x80000000, v39
    v_lshrrev_b32 v47, 14, v37
    v_bitop3_b32 v47, v47, v5, v46 bitop3:0xea
    ds_read_b64 v[106:107], v47 offset:63616
    v_and_b32 v46, 0x40000000, v39
    v_lshrrev_b32 v47, 14, v36
    v_bitop3_b32 v47, v47, v5, v46 bitop3:0xea
    ds_read_b64 v[104:105], v47 offset:63616
    s_waitcnt lgkmcnt(4)
    v_mfma_f32_4x4x4_16b_bf16 v[80:83], v[10:11], v[70:71], v[80:83]
    v_mfma_f32_4x4x4_16b_bf16 v[76:79], v[10:11], v[68:69], v[76:79]
    v_perm_b32 v15, v35, v38, s45
    v_bitop3_b32 v46, v35, 0.5, -0.5 bitop3:0xa8
    v_perm_b32 v14, v34, v38, s44
    v_bitop3_b32 v47, v34, 0.5, -0.5 bitop3:0xa8
    v_cvt_pk_bf16_f32 v80, v80, v81
    v_cvt_pk_bf16_f32 v81, v82, v83
    ds_wrxchg_rtn_b64 v[74:75], v95, v[80:81]
    v_cvt_pk_bf16_f32 v76, v76, v77
    v_cvt_pk_bf16_f32 v77, v78, v79
    ds_wrxchg_rtn_b64 v[72:73], v94, v[76:77]
    s_waitcnt lgkmcnt(2)
    s_barrier
    s_setprio 3
    ds_write_b128 v3, v[124:127] offset:4096
    ds_write_b128 v3, v[116:119] offset:2048
    ds_write_b128 v3, v[120:123] offset:3072
    v_mfma_f32_4x4x4_16b_bf16 v[80:83], v[8:9], v[102:103], 0
    v_mfma_f32_4x4x4_16b_bf16 v[76:79], v[8:9], v[100:101], 0
    v_bitop3_b32 v15, v6, v15, v46 bitop3:0xca
    v_bitop3_b32 v14, v6, v14, v47 bitop3:0xca
    v_cmp_lt_u32 s[84:85], v5, v92
    s_nop 0
    v_pk_mul_f32 v[80:81], v[80:81], v[14:15] op_sel:[0,1] op_sel_hi:[1,1]
    v_pk_mul_f32 v[82:83], v[82:83], v[14:15] op_sel:[0,1] op_sel_hi:[1,1]
    v_pk_mul_f32 v[76:77], v[76:77], v[14:15] op_sel:[0,0] op_sel_hi:[1,0]
    v_pk_mul_f32 v[78:79], v[78:79], v[14:15] op_sel:[0,0] op_sel_hi:[1,0]
    v_mov_b32 v44, v43
    s_setprio 2
    s_waitcnt vmcnt(7)
    ds_write_b128 v3, v[108:111] offset:0
    s_waitcnt lgkmcnt(4)
    v_cmpx_ne_u64 vcc, v[74:75], v[70:71]
    s_and_b64 s[82:83], vcc, s[80:81]
    s_cbranch_scc1 L2_c125
L2_d125:
    v_mov_b64 v[84:85], v[70:71]
    v_mov_b32 v7, v95
    v_mov_b64 v[86:87], v[74:75]
    s_mov_b64 exec, -1
    s_or_b64 s[80:81], s[80:81], vcc
    v_cmpx_ne_u64 vcc, v[72:73], v[68:69]
    s_and_b64 s[82:83], vcc, s[80:81]
    s_cbranch_scc1 L2_c126
L2_d126:
    v_mov_b64 v[84:85], v[68:69]
    v_mov_b32 v7, v94
    v_mov_b64 v[86:87], v[72:73]
    s_mov_b64 exec, -1
    s_or_b64 s[80:81], s[80:81], vcc
    ds_read_b64 v[70:71], v93
    s_and_b64 exec, s[84:85], s[80:81]
    v_mfma_f32_4x4x4_16b_bf16 v[76:79], v[12:13], v[84:85], 0
    v_mov_b32 v92, v7
    s_andn2_b64 s[80:81], s[80:81], s[84:85]
    v_mfma_f32_4x4x4_16b_bf16 v[76:79], v[10:11], v[86:87], v[76:79]
    s_mov_b64 exec, -1
    ds_read_b64 v[68:69], v92
    s_setprio 1
    s_waitcnt vmcnt(4)
    ds_write_b128 v3, v[112:115] offset:1024
    s_waitcnt lgkmcnt(1)
    v_mfma_f32_4x4x4_16b_bf16 v[80:83], v[10:11], v[70:71], v[80:83]
    v_mfma_f32_4x4x4_16b_bf16 v[76:79], v[10:11], v[68:69], v[76:79]
    v_and_b32 v46, 0x40000000, v39
    v_bitop3_b32 v94, v36, v5, v46 bitop3:0xea
    v_and_b32 v46, 0x80000000, v39
    v_bitop3_b32 v95, v37, v5, v46 bitop3:0xea
    v_perm_b32 v15, v37, v38, s47
    v_bitop3_b32 v46, v37, 0.5, -0.5 bitop3:0xa8
    v_perm_b32 v14, v36, v38, s46
    v_bitop3_b32 v47, v36, 0.5, -0.5 bitop3:0xa8
    v_cvt_pk_bf16_f32 v80, v80, v81
    v_cvt_pk_bf16_f32 v81, v82, v83
    ds_wrxchg_rtn_b64 v[74:75], v93, v[80:81]
    v_cvt_pk_bf16_f32 v76, v76, v77
    v_cvt_pk_bf16_f32 v77, v78, v79
    ds_wrxchg_rtn_b64 v[72:73], v92, v[76:77]
    s_setprio 0
    v_mfma_f32_4x4x4_16b_bf16 v[80:83], v[8:9], v[106:107], 0
    v_mfma_f32_4x4x4_16b_bf16 v[76:79], v[8:9], v[104:105], 0
    v_bitop3_b32 v15, v6, v15, v46 bitop3:0xca
    v_bitop3_b32 v14, v6, v14, v47 bitop3:0xca
    s_nop 1
    v_pk_mul_f32 v[80:81], v[80:81], v[14:15] op_sel:[0,1] op_sel_hi:[1,1]
    v_pk_mul_f32 v[82:83], v[82:83], v[14:15] op_sel:[0,1] op_sel_hi:[1,1]
    v_pk_mul_f32 v[76:77], v[76:77], v[14:15] op_sel:[0,0] op_sel_hi:[1,0]
    v_pk_mul_f32 v[78:79], v[78:79], v[14:15] op_sel:[0,0] op_sel_hi:[1,0]
    s_add_u32 s42, s42, 1
    s_waitcnt lgkmcnt(2)
    s_barrier
    s_bitcmp1_b32 s36, s42
    s_cbranch_scc1 L2_slow
L2_ret7:
    s_setprio 3
    v_and_b32 v47, 0x0fffffff, v44
    v_mov_b32 v39, v44
    buffer_load_dwordx4 v[34:37], v47, s[8:11], 0 offen
    buffer_load_dwordx3 v[36:38], v47, s[8:11], 0 offen offset:8
    s_waitcnt lgkmcnt(0)
    v_cmpx_ne_u64 vcc, v[74:75], v[70:71]
    s_and_b64 s[82:83], vcc, s[80:81]
    s_cbranch_scc1 L2_c127
L2_d127:
    v_mov_b64 v[84:85], v[70:71]
    v_mov_b32 v7, v93
    v_mov_b64 v[86:87], v[74:75]
    s_mov_b64 exec, -1
    s_or_b64 s[80:81], s[80:81], vcc
    v_cmpx_ne_u64 vcc, v[72:73], v[68:69]
    s_and_b64 s[82:83], vcc, s[80:81]
    s_cbranch_scc1 L2_c128
L2_d128:
    v_mov_b64 v[84:85], v[68:69]
    v_mov_b32 v7, v92
    v_mov_b64 v[86:87], v[72:73]
    s_mov_b64 exec, -1
    s_or_b64 s[80:81], s[80:81], vcc
    ds_read_b64 v[70:71], v95
    ds_read_b64 v[68:69], v94
    v_and_b32 v46, 0x20000000, v21
    v_lshrrev_b32 v47, 14, v17
    v_bitop3_b32 v47, v47, v5, v46 bitop3:0xea
    ds_read_b64 v[102:103], v47 offset:63616
    v_bitop3_b32 v93, v17, v5, v46 bitop3:0xea
    v_and_b32 v46, 0x10000000, v21
    v_lshrrev_b32 v47, 14, v16
    v_bitop3_b32 v47, v47, v5, v46 bitop3:0xea
    ds_read_b64 v[100:101], v47 offset:63616
    v_bitop3_b32 v92, v16, v5, v46 bitop3:0xea
    s_waitcnt lgkmcnt(2)
    v_mfma_f32_4x4x4_16b_bf16 v[80:83], v[10:11], v[70:71], v[80:83]
    v_mfma_f32_4x4x4_16b_bf16 v[76:79], v[10:11], v[68:69], v[76:79]
    v_perm_b32 v15, v17, v20, s45
    v_bitop3_b32 v46, v17, 0.5, -0.5 bitop3:0xa8
    v_perm_b32 v14, v16, v20, s44
    v_bitop3_b32 v47, v16, 0.5, -0.5 bitop3:0xa8
    v_cvt_pk_bf16_f32 v80, v80, v81
    v_cvt_pk_bf16_f32 v81, v82, v83
    ds_wrxchg_rtn_b64 v[74:75], v95, v[80:81]
    v_cvt_pk_bf16_f32 v76, v76, v77
    v_cvt_pk_bf16_f32 v77, v78, v79
    ds_wrxchg_rtn_b64 v[72:73], v94, v[76:77]
    s_waitcnt lgkmcnt(2)
    v_mfma_f32_4x4x4_16b_bf16 v[80:83], v[8:9], v[102:103], 0
    v_mfma_f32_4x4x4_16b_bf16 v[76:79], v[8:9], v[100:101], 0
    v_bitop3_b32 v15, v6, v15, v46 bitop3:0xca
    v_bitop3_b32 v14, v6, v14, v47 bitop3:0xca
    v_cmp_lt_u32 s[84:85], v5, v92
    s_nop 0
    v_pk_mul_f32 v[80:81], v[80:81], v[14:15] op_sel:[0,1] op_sel_hi:[1,1]
    v_pk_mul_f32 v[82:83], v[82:83], v[14:15] op_sel:[0,1] op_sel_hi:[1,1]
    v_pk_mul_f32 v[76:77], v[76:77], v[14:15] op_sel:[0,0] op_sel_hi:[1,0]
    v_pk_mul_f32 v[78:79], v[78:79], v[14:15] op_sel:[0,0] op_sel_hi:[1,0]
    s_waitcnt lgkmcnt(0)
    v_cmpx_ne_u64 vcc, v[74:75], v[70:71]
    s_and_b64 s[82:83], vcc, s[80:81]
    s_cbranch_scc1 L2_c129
L2_d129:
    v_mov_b64 v[84:85], v[70:71]
    v_mov_b32 v7, v95
    v_mov_b64 v[86:87], v[74:75]
    s_mov_b64 exec, -1
    s_or_b64 s[80:81], s[80:81], vcc
    v_cmpx_ne_u64 vcc, v[72:73], v[68:69]
    s_and_b64 s[82:83], vcc, s[80:81]
    s_cbranch_scc1 L2_c130
L2_d130:
    v_mov_b64 v[84:85], v[68:69]
    v_mov_b32 v7, v94
    v_mov_b64 v[86:87], v[72:73]
    s_mov_b64 exec, -1
    s_or_b64 s[80:81], s[80:81], vcc
    ds_read_b64 v[70:71], v93
    s_and_b64 exec, s[84:85], s[80:81]
    v_mfma_f32_4x4x4_16b_bf16 v[76:79], v[12:13], v[84:85], 0
    v_mov_b32 v92, v7
    s_andn2_b64 s[80:81], s[80:81], s[84:85]
    v_mfma_f32_4x4x4_16b_bf16 v[76:79], v[10:11], v[86:87], v[76:79]
    s_mov_b64 exec, -1
    ds_read_b64 v[68:69], v92
    v_and_b32 v46, 0x80000000, v21
    v_lshrrev_b32 v47, 14, v19
    v_bitop3_b32 v47, v47, v5, v46 bitop3:0xea
    ds_read_b64 v[106:107], v47 offset:63616
    v_bitop3_b32 v95, v19, v5, v46 bitop3:0xea
    v_and_b32 v46, 0x40000000, v21
    v_lshrrev_b32 v47, 14, v18
    v_bitop3_b32 v47, v47, v5, v46 bitop3:0xea
    ds_read_b64 v[104:105], v47 offset:63616
    v_bitop3_b32 v94, v18, v5, v46 bitop3:0xea
    s_waitcnt lgkmcnt(2)
    v_mfma_f32_4x4x4_16b_bf16 v[80:83], v[10:11], v[70:71], v[80:83]
    v_mfma_f32_4x4x4_16b_bf16 v[76:79], v[10:11], v[68:69], v[76:79]
    v_perm_b32 v15, v19, v20, s47
    v_bitop3_b32 v46, v19, 0.5, -0.5 bitop3:0xa8
    v_perm_b32 v14, v18, v20, s46
    v_bitop3_b32 v47, v18, 0.5, -0.5 bitop3:0xa8
    v_cvt_pk_bf16_f32 v80, v80, v81
    v_cvt_pk_bf16_f32 v81, v82, v83
    ds_wrxchg_rtn_b64 v[74:75], v93, v[80:81]
    v_cvt_pk_bf16_f32 v76, v76, v77
    v_cvt_pk_bf16_f32 v77, v78, v79
    ds_wrxchg_rtn_b64 v[72:73], v92, v[76:77]
    s_setprio 2
    s_waitcnt lgkmcnt(2)
    v_mfma_f32_4x4x4_16b_bf16 v[80:83], v[8:9], v[106:107], 0
    v_mfma_f32_4x4x4_16b_bf16 v[76:79], v[8:9], v[104:105], 0
    v_bitop3_b32 v15, v6, v15, v46 bitop3:0xca
    v_bitop3_b32 v14, v6, v14, v47 bitop3:0xca
    s_nop 1
    v_pk_mul_f32 v[80:81], v[80:81], v[14:15] op_sel:[0,1] op_sel_hi:[1,1]
    v_pk_mul_f32 v[82:83], v[82:83], v[14:15] op_sel:[0,1] op_sel_hi:[1,1]
    v_pk_mul_f32 v[76:77], v[76:77], v[14:15] op_sel:[0,0] op_sel_hi:[1,0]
    v_pk_mul_f32 v[78:79], v[78:79], v[14:15] op_sel:[0,0] op_sel_hi:[1,0]
    s_lshl_b32 s3, s32, 12
    s_add_u32 s3, s3, 80000
    v_subrev_u32 v122, s3, v3
    s_mul_i32 s3, s33, 20000
    v_add_u32 v118, s3, v122
    v_add_u32 v119, 0x4000, v118
    s_lshl_b32 s3, s34, 7
    v_lshrrev_b32 v123, 7, v118
    v_and_b32 v120, 0x70, v118
    v_lshl_add_u32 v120, v123, 13, v120
    v_add_u32 v120, s3, v120
    v_lshrrev_b32 v123, 7, v119
    v_and_b32 v121, 0x70, v119
    v_lshl_add_u32 v121, v123, 13, v121
    v_add_u32 v121, s3, v121
    v_cmp_le_u32 vcc, 3616, v122
    s_mov_b64 exec, vcc
    v_mov_b32 v119, 2.0
    v_mov_b32 v121, 2.0
    s_mov_b64 exec, -1
    v_and_b32 v123, 0x30, v122
    v_lshlrev_b32 v123, 2, v123
    buffer_load_dwordx4 v[48:51], v123, s[24:27], 0 offen
    buffer_load_dwordx4 v[52:55], v123, s[24:27], 0 offen offset:16
    buffer_load_dwordx2 v[56:57], v123, s[24:27], 0 offen offset:32
    s_mov_b32 s12, s4
    s_mov_b32 s13, s5
    s_mov_b32 s14, 0x138800
    s_mov_b32 s15, 0x20000
    s_mov_b32 s3, 80000
    v_lshrrev_b32 v123, 2, v120
    buffer_load_dword v116, v123, s[12:15], 0 offen
    buffer_load_dwordx4 v[108:111], v120, s[16:19], s3 offen
    v_lshrrev_b32 v123, 2, v121
    buffer_load_dword v117, v123, s[12:15], 0 offen
    buffer_load_dwordx4 v[112:115], v121, s[16:19], s3 offen
    s_waitcnt lgkmcnt(0)
    v_cmpx_ne_u64 vcc, v[74:75], v[70:71]
    s_and_b64 s[82:83], vcc, s[80:81]
    s_cbranch_scc1 L2_c131
L2_d131:
    v_mov_b64 v[84:85], v[70:71]
    v_mov_b32 v7, v93
    v_mov_b64 v[86:87], v[74:75]
    s_mov_b64 exec, -1
    s_or_b64 s[80:81], s[80:81], vcc
    v_cmpx_ne_u64 vcc, v[72:73], v[68:69]
    s_and_b64 s[82:83], vcc, s[80:81]
    s_cbranch_scc1 L2_c132
L2_d132:
    v_mov_b64 v[84:85], v[68:69]
    v_mov_b32 v7, v92
    v_mov_b64 v[86:87], v[72:73]
    s_mov_b64 exec, -1
    s_or_b64 s[80:81], s[80:81], vcc
    ds_read_b64 v[70:71], v95
    ds_read_b64 v[68:69], v94
    s_waitcnt vmcnt(11)
    v_and_b32 v46, 0x20000000, v27
    v_lshrrev_b32 v47, 14, v23
    v_bitop3_b32 v47, v47, v5, v46 bitop3:0xea
    ds_read_b64 v[102:103], v47 offset:63616
    v_bitop3_b32 v93, v23, v5, v46 bitop3:0xea
    v_and_b32 v46, 0x10000000, v27
    v_lshrrev_b32 v47, 14, v22
    v_bitop3_b32 v47, v47, v5, v46 bitop3:0xea
    ds_read_b64 v[100:101], v47 offset:63616
    v_bitop3_b32 v92, v22, v5, v46 bitop3:0xea
    s_waitcnt lgkmcnt(2)
    v_mfma_f32_4x4x4_16b_bf16 v[80:83], v[10:11], v[70:71], v[80:83]
    v_mfma_f32_4x4x4_16b_bf16 v[76:79], v[10:11], v[68:69], v[76:79]
    v_perm_b32 v15, v23, v26, s45
    v_bitop3_b32 v46, v23, 0.5, -0.5 bitop3:0xa8
    v_perm_b32 v14, v22, v26, s44
    v_bitop3_b32 v47, v22, 0.5, -0.5 bitop3:0xa8
    v_cvt_pk_bf16_f32 v80, v80, v81
    v_cvt_pk_bf16_f32 v81, v82, v83
    ds_wrxchg_rtn_b64 v[74:75], v95, v[80:81]
    v_cvt_pk_bf16_f32 v76, v76, v77
    v_cvt_pk_bf16_f32 v77, v78, v79
    ds_wrxchg_rtn_b64 v[72:73], v94, v[76:77]
    s_waitcnt lgkmcnt(2)
    v_mfma_f32_4x4x4_16b_bf16 v[80:83], v[8:9], v[102:103], 0
    v_mfma_f32_4x4x4_16b_bf16 v[76:79], v[8:9], v[100:101], 0
    v_bitop3_b32 v15, v6, v15, v46 bitop3:0xca
    v_bitop3_b32 v14, v6, v14, v47 bitop3:0xca
    v_cmp_lt_u32 s[84:85], v5, v92
    s_nop 0
    v_pk_mul_f32 v[80:81], v[80:81], v[14:15] op_sel:[0,1] op_sel_hi:[1,1]
    v_pk_mul_f32 v[82:83], v[82:83], v[14:15] op_sel:[0,1] op_sel_hi:[1,1]
    v_pk_mul_f32 v[76:77], v[76:77], v[14:15] op_sel:[0,0] op_sel_hi:[1,0]
    v_pk_mul_f32 v[78:79], v[78:79], v[14:15] op_sel:[0,0] op_sel_hi:[1,0]
    s_waitcnt lgkmcnt(0)
    v_cmpx_ne_u64 vcc, v[74:75], v[70:71]
    s_and_b64 s[82:83], vcc, s[80:81]
    s_cbranch_scc1 L2_c133
L2_d133:
    v_mov_b64 v[84:85], v[70:71]
    v_mov_b32 v7, v95
    v_mov_b64 v[86:87], v[74:75]
    s_mov_b64 exec, -1
    s_or_b64 s[80:81], s[80:81], vcc
    v_cmpx_ne_u64 vcc, v[72:73], v[68:69]
    s_and_b64 s[82:83], vcc, s[80:81]
    s_cbranch_scc1 L2_c134
L2_d134:
    v_mov_b64 v[84:85], v[68:69]
    v_mov_b32 v7, v94
    v_mov_b64 v[86:87], v[72:73]
    s_mov_b64 exec, -1
    s_or_b64 s[80:81], s[80:81], vcc
    ds_read_b64 v[70:71], v93
    s_and_b64 exec, s[84:85], s[80:81]
    v_mfma_f32_4x4x4_16b_bf16 v[76:79], v[12:13], v[84:85], 0
    v_mov_b32 v92, v7
    s_andn2_b64 s[80:81], s[80:81], s[84:85]
    v_mfma_f32_4x4x4_16b_bf16 v[76:79], v[10:11], v[86:87], v[76:79]
    s_mov_b64 exec, -1
    ds_read_b64 v[68:69], v92
    v_and_b32 v46, 0x80000000, v27
    v_lshrrev_b32 v47, 14, v25
    v_bitop3_b32 v47, v47, v5, v46 bitop3:0xea
    ds_read_b64 v[106:107], v47 offset:63616
    v_bitop3_b32 v95, v25, v5, v46 bitop3:0xea
    v_and_b32 v46, 0x40000000, v27
    v_lshrrev_b32 v47, 14, v24
    v_bitop3_b32 v47, v47, v5, v46 bitop3:0xea
    ds_read_b64 v[104:105], v47 offset:63616
    v_bitop3_b32 v94, v24, v5, v46 bitop3:0xea
    s_waitcnt lgkmcnt(2)
    v_mfma_f32_4x4x4_16b_bf16 v[80:83], v[10:11], v[70:71], v[80:83]
    v_mfma_f32_4x4x4_16b_bf16 v[76:79], v[10:11], v[68:69], v[76:79]
    v_perm_b32 v15, v25, v26, s47
    v_bitop3_b32 v46, v25, 0.5, -0.5 bitop3:0xa8
    v_perm_b32 v14, v24, v26, s46
    v_bitop3_b32 v47, v24, 0.5, -0.5 bitop3:0xa8
    v_cvt_pk_bf16_f32 v80, v80, v81
    v_cvt_pk_bf16_f32 v81, v82, v83
    ds_wrxchg_rtn_b64 v[74:75], v93, v[80:81]
    v_cvt_pk_bf16_f32 v76, v76, v77
    v_cvt_pk_bf16_f32 v77, v78, v79
    ds_wrxchg_rtn_b64 v[72:73], v92, v[76:77]
    s_setprio 1
    s_waitcnt lgkmcnt(2)
    v_mfma_f32_4x4x4_16b_bf16 v[80:83], v[8:9], v[106:107], 0
    v_mfma_f32_4x4x4_16b_bf16 v[76:79], v[8:9], v[104:105], 0
    v_bitop3_b32 v15, v6, v15, v46 bitop3:0xca
    v_bitop3_b32 v14, v6, v14, v47 bitop3:0xca
    s_nop 1
    v_pk_mul_f32 v[80:81], v[80:81], v[14:15] op_sel:[0,1] op_sel_hi:[1,1]
    v_pk_mul_f32 v[82:83], v[82:83], v[14:15] op_sel:[0,1] op_sel_hi:[1,1]
    v_pk_mul_f32 v[76:77], v[76:77], v[14:15] op_sel:[0,0] op_sel_hi:[1,0]
    v_pk_mul_f32 v[78:79], v[78:79], v[14:15] op_sel:[0,0] op_sel_hi:[1,0]
    s_waitcnt lgkmcnt(0)
    v_cmpx_ne_u64 vcc, v[74:75], v[70:71]
    s_and_b64 s[82:83], vcc, s[80:81]
    s_cbranch_scc1 L2_c135
L2_d135:
    v_mov_b64 v[84:85], v[70:71]
    v_mov_b32 v7, v93
    v_mov_b64 v[86:87], v[74:75]
    s_mov_b64 exec, -1
    s_or_b64 s[80:81], s[80:81], vcc
    v_cmpx_ne_u64 vcc, v[72:73], v[68:69]
    s_and_b64 s[82:83], vcc, s[80:81]
    s_cbranch_scc1 L2_c136
L2_d136:
    v_mov_b64 v[84:85], v[68:69]
    v_mov_b32 v7, v92
    v_mov_b64 v[86:87], v[72:73]
    s_mov_b64 exec, -1
    s_or_b64 s[80:81], s[80:81], vcc
    ds_read_b64 v[70:71], v95
    ds_read_b64 v[68:69], v94
    s_waitcnt vmcnt(9)
    v_and_b32 v46, 0x20000000, v33
    v_lshrrev_b32 v47, 14, v29
    v_bitop3_b32 v47, v47, v5, v46 bitop3:0xea
    ds_read_b64 v[102:103], v47 offset:63616
    v_bitop3_b32 v93, v29, v5, v46 bitop3:0xea
    v_and_b32 v46, 0x10000000, v33
    v_lshrrev_b32 v47, 14, v28
    v_bitop3_b32 v47, v47, v5, v46 bitop3:0xea
    ds_read_b64 v[100:101], v47 offset:63616
    v_bitop3_b32 v92, v28, v5, v46 bitop3:0xea
    s_waitcnt lgkmcnt(2)
    v_mfma_f32_4x4x4_16b_bf16 v[80:83], v[10:11], v[70:71], v[80:83]
    v_mfma_f32_4x4x4_16b_bf16 v[76:79], v[10:11], v[68:69], v[76:79]
    v_perm_b32 v15, v29, v32, s45
    v_bitop3_b32 v46, v29, 0.5, -0.5 bitop3:0xa8
    v_perm_b32 v14, v28, v32, s44
    v_bitop3_b32 v47, v28, 0.5, -0.5 bitop3:0xa8
    v_cvt_pk_bf16_f32 v80, v80, v81
    v_cvt_pk_bf16_f32 v81, v82, v83
    ds_wrxchg_rtn_b64 v[74:75], v95, v[80:81]
    v_cvt_pk_bf16_f32 v76, v76, v77
    v_cvt_pk_bf16_f32 v77, v78, v79
    ds_wrxchg_rtn_b64 v[72:73], v94, v[76:77]
    s_waitcnt lgkmcnt(2)
    v_mfma_f32_4x4x4_16b_bf16 v[80:83], v[8:9], v[102:103], 0
    v_mfma_f32_4x4x4_16b_bf16 v[76:79], v[8:9], v[100:101], 0
    v_bitop3_b32 v15, v6, v15, v46 bitop3:0xca
    v_bitop3_b32 v14, v6, v14, v47 bitop3:0xca
    v_cmp_lt_u32 s[84:85], v5, v92
    s_nop 0
    v_pk_mul_f32 v[80:81], v[80:81], v[14:15] op_sel:[0,1] op_sel_hi:[1,1]
    v_pk_mul_f32 v[82:83], v[82:83], v[14:15] op_sel:[0,1] op_sel_hi:[1,1]
    v_pk_mul_f32 v[76:77], v[76:77], v[14:15] op_sel:[0,0] op_sel_hi:[1,0]
    v_pk_mul_f32 v[78:79], v[78:79], v[14:15] op_sel:[0,0] op_sel_hi:[1,0]
    s_waitcnt lgkmcnt(0)
    v_cmpx_ne_u64 vcc, v[74:75], v[70:71]
    s_and_b64 s[82:83], vcc, s[80:81]
    s_cbranch_scc1 L2_c137
L2_d137:
    v_mov_b64 v[84:85], v[70:71]
    v_mov_b32 v7, v95
    v_mov_b64 v[86:87], v[74:75]
    s_mov_b64 exec, -1
    s_or_b64 s[80:81], s[80:81], vcc
    v_cmpx_ne_u64 vcc, v[72:73], v[68:69]
    s_and_b64 s[82:83], vcc, s[80:81]
    s_cbranch_scc1 L2_c138
L2_d138:
    v_mov_b64 v[84:85], v[68:69]
    v_mov_b32 v7, v94
    v_mov_b64 v[86:87], v[72:73]
    s_mov_b64 exec, -1
    s_or_b64 s[80:81], s[80:81], vcc
    ds_read_b64 v[70:71], v93
    s_and_b64 exec, s[84:85], s[80:81]
    v_mfma_f32_4x4x4_16b_bf16 v[76:79], v[12:13], v[84:85], 0
    v_mov_b32 v92, v7
    s_andn2_b64 s[80:81], s[80:81], s[84:85]
    v_mfma_f32_4x4x4_16b_bf16 v[76:79], v[10:11], v[86:87], v[76:79]
    s_mov_b64 exec, -1
    ds_read_b64 v[68:69], v92
    v_and_b32 v46, 0x80000000, v33
    v_lshrrev_b32 v47, 14, v31
    v_bitop3_b32 v47, v47, v5, v46 bitop3:0xea
    ds_read_b64 v[106:107], v47 offset:63616
    v_bitop3_b32 v95, v31, v5, v46 bitop3:0xea
    v_and_b32 v46, 0x40000000, v33
    v_lshrrev_b32 v47, 14, v30
    v_bitop3_b32 v47, v47, v5, v46 bitop3:0xea
    ds_read_b64 v[104:105], v47 offset:63616
    v_bitop3_b32 v94, v30, v5, v46 bitop3:0xea
    s_waitcnt lgkmcnt(2)
    v_mfma_f32_4x4x4_16b_bf16 v[80:83], v[10:11], v[70:71], v[80:83]
    v_mfma_f32_4x4x4_16b_bf16 v[76:79], v[10:11], v[68:69], v[76:79]
    v_perm_b32 v15, v31, v32, s47
    v_bitop3_b32 v46, v31, 0.5, -0.5 bitop3:0xa8
    v_perm_b32 v14, v30, v32, s46
    v_bitop3_b32 v47, v30, 0.5, -0.5 bitop3:0xa8
    v_cvt_pk_bf16_f32 v80, v80, v81
    v_cvt_pk_bf16_f32 v81, v82, v83
    ds_wrxchg_rtn_b64 v[74:75], v93, v[80:81]
    v_cvt_pk_bf16_f32 v76, v76, v77
    v_cvt_pk_bf16_f32 v77, v78, v79
    ds_wrxchg_rtn_b64 v[72:73], v92, v[76:77]
    s_setprio 0
    s_waitcnt lgkmcnt(2)
    v_mfma_f32_4x4x4_16b_bf16 v[80:83], v[8:9], v[106:107], 0
    v_mfma_f32_4x4x4_16b_bf16 v[76:79], v[8:9], v[104:105], 0
    v_bitop3_b32 v15, v6, v15, v46 bitop3:0xca
    v_bitop3_b32 v14, v6, v14, v47 bitop3:0xca
    s_nop 1
    v_pk_mul_f32 v[80:81], v[80:81], v[14:15] op_sel:[0,1] op_sel_hi:[1,1]
    v_pk_mul_f32 v[82:83], v[82:83], v[14:15] op_sel:[0,1] op_sel_hi:[1,1]
    v_pk_mul_f32 v[76:77], v[76:77], v[14:15] op_sel:[0,0] op_sel_hi:[1,0]
    v_pk_mul_f32 v[78:79], v[78:79], v[14:15] op_sel:[0,0] op_sel_hi:[1,0]
    s_waitcnt lgkmcnt(0)
    v_cmpx_ne_u64 vcc, v[74:75], v[70:71]
    s_and_b64 s[82:83], vcc, s[80:81]
    s_cbranch_scc1 L2_c139
L2_d139:
    v_mov_b64 v[84:85], v[70:71]
    v_mov_b32 v7, v93
    v_mov_b64 v[86:87], v[74:75]
    s_mov_b64 exec, -1
    s_or_b64 s[80:81], s[80:81], vcc
    v_cmpx_ne_u64 vcc, v[72:73], v[68:69]
    s_and_b64 s[82:83], vcc, s[80:81]
    s_cbranch_scc1 L2_c140
L2_d140:
    v_mov_b64 v[84:85], v[68:69]
    v_mov_b32 v7, v92
    v_mov_b64 v[86:87], v[72:73]
    s_mov_b64 exec, -1
    s_or_b64 s[80:81], s[80:81], vcc
    ds_read_b64 v[70:71], v95
    ds_read_b64 v[68:69], v94
    s_waitcnt vmcnt(7)
    v_and_b32 v46, 0x20000000, v39
    v_lshrrev_b32 v47, 14, v35
    v_bitop3_b32 v47, v47, v5, v46 bitop3:0xea
    ds_read_b64 v[102:103], v47 offset:63616
    v_bitop3_b32 v93, v35, v5, v46 bitop3:0xea
    v_and_b32 v46, 0x10000000, v39
    v_lshrrev_b32 v47, 14, v34
    v_bitop3_b32 v47, v47, v5, v46 bitop3:0xea
    ds_read_b64 v[100:101], v47 offset:63616
    v_bitop3_b32 v92, v34, v5, v46 bitop3:0xea
    v_and_b32 v46, 0x80000000, v39
    v_lshrrev_b32 v47, 14, v37
    v_bitop3_b32 v47, v47, v5, v46 bitop3:0xea
    ds_read_b64 v[106:107], v47 offset:63616
    v_and_b32 v46, 0x40000000, v39
    v_lshrrev_b32 v47, 14, v36
    v_bitop3_b32 v47, v47, v5, v46 bitop3:0xea
    ds_read_b64 v[104:105], v47 offset:63616
    s_waitcnt lgkmcnt(4)
    v_mfma_f32_4x4x4_16b_bf16 v[80:83], v[10:11], v[70:71], v[80:83]
    v_mfma_f32_4x4x4_16b_bf16 v[76:79], v[10:11], v[68:69], v[76:79]
    v_perm_b32 v15, v35, v38, s45
    v_bitop3_b32 v46, v35, 0.5, -0.5 bitop3:0xa8
    v_perm_b32 v14, v34, v38, s44
    v_bitop3_b32 v47, v34, 0.5, -0.5 bitop3:0xa8
    v_cvt_pk_bf16_f32 v80, v80, v81
    v_cvt_pk_bf16_f32 v81, v82, v83
    ds_wrxchg_rtn_b64 v[74:75], v95, v[80:81]
    v_cvt_pk_bf16_f32 v76, v76, v77
    v_cvt_pk_bf16_f32 v77, v78, v79
    ds_wrxchg_rtn_b64 v[72:73], v94, v[76:77]
    s_waitcnt lgkmcnt(4)
    v_mfma_f32_4x4x4_16b_bf16 v[80:83], v[8:9], v[102:103], 0
    v_mfma_f32_4x4x4_16b_bf16 v[76:79], v[8:9], v[100:101], 0
    v_bitop3_b32 v15, v6, v15, v46 bitop3:0xca
    v_bitop3_b32 v14, v6, v14, v47 bitop3:0xca
    v_cmp_lt_u32 s[84:85], v5, v92
    s_nop 0
    v_pk_mul_f32 v[80:81], v[80:81], v[14:15] op_sel:[0,1] op_sel_hi:[1,1]
    v_pk_mul_f32 v[82:83], v[82:83], v[14:15] op_sel:[0,1] op_sel_hi:[1,1]
    v_pk_mul_f32 v[76:77], v[76:77], v[14:15] op_sel:[0,0] op_sel_hi:[1,0]
    v_pk_mul_f32 v[78:79], v[78:79], v[14:15] op_sel:[0,0] op_sel_hi:[1,0]
    s_waitcnt lgkmcnt(0)
    v_cmpx_ne_u64 vcc, v[74:75], v[70:71]
    s_and_b64 s[82:83], vcc, s[80:81]
    s_cbranch_scc1 L2_c141
L2_d141:
    v_mov_b64 v[84:85], v[70:71]
    v_mov_b32 v7, v95
    v_mov_b64 v[86:87], v[74:75]
    s_mov_b64 exec, -1
    s_or_b64 s[80:81], s[80:81], vcc
    v_cmpx_ne_u64 vcc, v[72:73], v[68:69]
    s_and_b64 s[82:83], vcc, s[80:81]
    s_cbranch_scc1 L2_c142
L2_d142:
    v_mov_b64 v[84:85], v[68:69]
    v_mov_b32 v7, v94
    v_mov_b64 v[86:87], v[72:73]
    s_mov_b64 exec, -1
    s_or_b64 s[80:81], s[80:81], vcc
    ds_read_b64 v[70:71], v93
    s_and_b64 exec, s[84:85], s[80:81]
    v_mfma_f32_4x4x4_16b_bf16 v[76:79], v[12:13], v[84:85], 0
    v_mov_b32 v92, v7
    s_andn2_b64 s[80:81], s[80:81], s[84:85]
    v_mfma_f32_4x4x4_16b_bf16 v[76:79], v[10:11], v[86:87], v[76:79]
    s_mov_b64 exec, -1
    ds_read_b64 v[68:69], v92
    s_waitcnt lgkmcnt(0)
    v_mfma_f32_4x4x4_16b_bf16 v[80:83], v[10:11], v[70:71], v[80:83]
    v_mfma_f32_4x4x4_16b_bf16 v[76:79], v[10:11], v[68:69], v[76:79]
    v_and_b32 v46, 0x40000000, v39
    v_bitop3_b32 v94, v36, v5, v46 bitop3:0xea
    v_and_b32 v46, 0x80000000, v39
    v_bitop3_b32 v95, v37, v5, v46 bitop3:0xea
    v_perm_b32 v15, v37, v38, s47
    v_bitop3_b32 v46, v37, 0.5, -0.5 bitop3:0xa8
    v_perm_b32 v14, v36, v38, s46
    v_bitop3_b32 v47, v36, 0.5, -0.5 bitop3:0xa8
    v_cvt_pk_bf16_f32 v80, v80, v81
    v_cvt_pk_bf16_f32 v81, v82, v83
    ds_wrxchg_rtn_b64 v[74:75], v93, v[80:81]
    v_cvt_pk_bf16_f32 v76, v76, v77
    v_cvt_pk_bf16_f32 v77, v78, v79
    ds_wrxchg_rtn_b64 v[72:73], v92, v[76:77]
    v_mfma_f32_4x4x4_16b_bf16 v[80:83], v[8:9], v[106:107], 0
    v_mfma_f32_4x4x4_16b_bf16 v[76:79], v[8:9], v[104:105], 0
    v_bitop3_b32 v15, v6, v15, v46 bitop3:0xca
    v_bitop3_b32 v14, v6, v14, v47 bitop3:0xca
    s_nop 1
    v_pk_mul_f32 v[80:81], v[80:81], v[14:15] op_sel:[0,1] op_sel_hi:[1,1]
    v_pk_mul_f32 v[82:83], v[82:83], v[14:15] op_sel:[0,1] op_sel_hi:[1,1]
    v_pk_mul_f32 v[76:77], v[76:77], v[14:15] op_sel:[0,0] op_sel_hi:[1,0]
    v_pk_mul_f32 v[78:79], v[78:79], v[14:15] op_sel:[0,0] op_sel_hi:[1,0]
    s_waitcnt lgkmcnt(0)
    v_cmpx_ne_u64 vcc, v[74:75], v[70:71]
    s_and_b64 s[82:83], vcc, s[80:81]
    s_cbranch_scc1 L2_c143
L2_d143:
    v_mov_b64 v[84:85], v[70:71]
    v_mov_b32 v7, v93
    v_mov_b64 v[86:87], v[74:75]
    s_mov_b64 exec, -1
    s_or_b64 s[80:81], s[80:81], vcc
    v_cmpx_ne_u64 vcc, v[72:73], v[68:69]
    s_and_b64 s[82:83], vcc, s[80:81]
    s_cbranch_scc1 L2_c144
L2_d144:
    v_mov_b64 v[84:85], v[68:69]
    v_mov_b32 v7, v92
    v_mov_b64 v[86:87], v[72:73]
    s_mov_b64 exec, -1
    s_or_b64 s[80:81], s[80:81], vcc
    ds_read_b64 v[70:71], v95
    ds_read_b64 v[68:69], v94
    s_waitcnt lgkmcnt(0)
    v_mfma_f32_4x4x4_16b_bf16 v[80:83], v[10:11], v[70:71], v[80:83]
    v_mfma_f32_4x4x4_16b_bf16 v[76:79], v[10:11], v[68:69], v[76:79]
    s_nop 3
    v_cvt_pk_bf16_f32 v80, v80, v81
    v_cvt_pk_bf16_f32 v81, v82, v83
    ds_wrxchg_rtn_b64 v[74:75], v95, v[80:81]
    v_cvt_pk_bf16_f32 v76, v76, v77
    v_cvt_pk_bf16_f32 v77, v78, v79
    ds_wrxchg_rtn_b64 v[72:73], v94, v[76:77]
    s_waitcnt lgkmcnt(0)
    v_cmpx_ne_u64 vcc, v[74:75], v[70:71]
    s_and_b64 s[82:83], vcc, s[80:81]
    s_cbranch_scc1 L2_c145
L2_d145:
    v_mov_b64 v[84:85], v[70:71]
    v_mov_b32 v7, v95
    v_mov_b64 v[86:87], v[74:75]
    s_mov_b64 exec, -1
    s_or_b64 s[80:81], s[80:81], vcc
    v_cmpx_ne_u64 vcc, v[72:73], v[68:69]
    s_and_b64 s[82:83], vcc, s[80:81]
    s_cbranch_scc1 L2_c146
L2_d146:
    v_mov_b64 v[84:85], v[68:69]
    v_mov_b32 v7, v94
    v_mov_b64 v[86:87], v[72:73]
    s_mov_b64 exec, -1
    s_or_b64 s[80:81], s[80:81], vcc
    s_mov_b64 exec, s[80:81]
    s_nop 1
    v_mfma_f32_4x4x4_16b_bf16 v[88:91], v[12:13], v[84:85], 0
    s_nop 1
    v_mfma_f32_4x4x4_16b_bf16 v[88:91], v[10:11], v[86:87], v[88:91]
    s_nop 4
    v_cvt_pk_bf16_f32 v88, v88, v89
    v_cvt_pk_bf16_f32 v89, v90, v91
    ds_pk_add_bf16 v7, v88
    ds_pk_add_bf16 v7, v89 offset:4
    s_mov_b64 exec, -1
    s_load_dwordx2 s[4:5], s[0:1], 88
    v_add_u32 v123, 16384, v122
    v_add_u32 v124, 32768, v122
    v_add_u32 v125, 49152, v122
    v_add_u32 v126, 65536, v122
    s_lshl_b32 s50, s96, 16
    s_and_b32 s51, s96, 0xffff0000
    s_lshl_b32 s52, s97, 16
    s_and_b32 s53, s97, 0xffff0000
    s_lshl_b32 s54, s98, 16
    s_and_b32 s55, s98, 0xffff0000
    s_lshl_b32 s56, s99, 16
    s_and_b32 s57, s99, 0xffff0000
    s_waitcnt vmcnt(0) lgkmcnt(0)
    s_barrier
    ds_read_b128 v[16:19], v122
    ds_read_b128 v[20:23], v123
    ds_read_b128 v[24:27], v124
    ds_read_b128 v[28:31], v125
    ds_read_b128 v[32:35], v126
    s_add_u32 s8, s30, 0xebac000
    s_addc_u32 s9, s31, 0
    s_mov_b32 s10, 0x8000
    s_mov_b32 s11, 0x20000
    s_mov_b32 s12, s4
    s_mov_b32 s13, s5
    s_mov_b32 s14, 0x4e2000
    s_mov_b32 s15, 0x20000
    s_mul_i32 s3, s33, 20000
    v_subrev_u32 v36, s3, v122
    v_cmp_le_u32 vcc, 20000, v36
    s_waitcnt lgkmcnt(4)
    s_mov_b64 exec, vcc
    buffer_store_dwordx4 v[16:19], v122, s[20:23], 0 offen sc1
    s_mov_b64 exec, -1
    v_subrev_u32 v36, s3, v123
    v_cmp_le_u32 vcc, 20000, v36
    s_waitcnt lgkmcnt(3)
    s_mov_b64 exec, vcc
    buffer_store_dwordx4 v[20:23], v123, s[20:23], 0 offen sc1
    s_mov_b64 exec, -1
    v_subrev_u32 v36, s3, v124
    v_cmp_le_u32 vcc, 20000, v36
    s_waitcnt lgkmcnt(2)
    s_mov_b64 exec, vcc
    buffer_store_dwordx4 v[24:27], v124, s[20:23], 0 offen sc1
    s_mov_b64 exec, -1
    v_subrev_u32 v36, s3, v125
    v_cmp_le_u32 vcc, 20000, v36
    s_waitcnt lgkmcnt(1)
    s_mov_b64 exec, vcc
    buffer_store_dwordx4 v[28:31], v125, s[20:23], 0 offen sc1
    s_mov_b64 exec, -1
    v_subrev_u32 v36, s3, v126
    v_cmp_le_u32 vcc, 20000, v36
    s_waitcnt lgkmcnt(0)
    s_mov_b64 exec, vcc
    buffer_store_dwordx4 v[32:35], v126, s[20:23], 0 offen sc1
    s_mov_b64 exec, -1
    v_lshlrev_b32 v80, 16, v116
    v_subrev_f32 v60, s50, v80
    v_subrev_f32 v61, s51, v80
    v_subrev_f32 v62, s52, v80
    v_subrev_f32 v63, s53, v80
    v_subrev_f32 v64, s54, v80
    v_subrev_f32 v65, s55, v80
    v_subrev_f32 v66, s56, v80
    v_subrev_f32 v67, s57, v80
    v_cvt_pk_bf16_f32 v68, v60, v61
    v_cvt_pk_bf16_f32 v69, v62, v63
    v_cvt_pk_bf16_f32 v70, v64, v65
    v_cvt_pk_bf16_f32 v71, v66, v67
    v_lshlrev_b32 v60, 16, v68
    v_and_b32 v61, 0xffff0000, v68
    v_lshlrev_b32 v62, 16, v69
    v_and_b32 v63, 0xffff0000, v69
    v_lshlrev_b32 v64, 16, v70
    v_and_b32 v65, 0xffff0000, v70
    v_lshlrev_b32 v66, 16, v71
    v_and_b32 v67, 0xffff0000, v71
    v_mul_f32 v60, v60, v60
    v_mul_f32 v61, v61, v61
    v_mul_f32 v62, v62, v62
    v_mul_f32 v63, v63, v63
    v_mul_f32 v64, v64, v64
    v_mul_f32 v65, v65, v65
    v_mul_f32 v66, v66, v66
    v_mul_f32 v67, v67, v67
    v_cvt_pk_bf16_f32 v68, v60, v61
    v_cvt_pk_bf16_f32 v69, v62, v63
    v_cvt_pk_bf16_f32 v70, v64, v65
    v_cvt_pk_bf16_f32 v71, v66, v67
    v_lshlrev_b32 v60, 16, v68
    v_and_b32 v61, 0xffff0000, v68
    v_lshlrev_b32 v62, 16, v69
    v_and_b32 v63, 0xffff0000, v69
    v_lshlrev_b32 v64, 16, v70
    v_and_b32 v65, 0xffff0000, v70
    v_lshlrev_b32 v66, 16, v71
    v_and_b32 v67, 0xffff0000, v71
    v_mul_f32 v60, 0xc1200000, v60
    v_mul_f32 v61, 0xc1200000, v61
    v_mul_f32 v62, 0xc1200000, v62
    v_mul_f32 v63, 0xc1200000, v63
    v_mul_f32 v64, 0xc1200000, v64
    v_mul_f32 v65, 0xc1200000, v65
    v_mul_f32 v66, 0xc1200000, v66
    v_mul_f32 v67, 0xc1200000, v67
    v_cvt_pk_bf16_f32 v68, v60, v61
    v_cvt_pk_bf16_f32 v69, v62, v63
    v_cvt_pk_bf16_f32 v70, v64, v65
    v_cvt_pk_bf16_f32 v71, v66, v67
    v_lshlrev_b32 v60, 16, v68
    v_and_b32 v61, 0xffff0000, v68
    v_lshlrev_b32 v62, 16, v69
    v_and_b32 v63, 0xffff0000, v69
    v_lshlrev_b32 v64, 16, v70
    v_and_b32 v65, 0xffff0000, v70
    v_lshlrev_b32 v66, 16, v71
    v_and_b32 v67, 0xffff0000, v71
    v_mul_f32 v60, 0x3fb8aa3b, v60
    v_mul_f32 v61, 0x3fb8aa3b, v61
    v_mul_f32 v62, 0x3fb8aa3b, v62
    v_mul_f32 v63, 0x3fb8aa3b, v63
    v_mul_f32 v64, 0x3fb8aa3b, v64
    v_mul_f32 v65, 0x3fb8aa3b, v65
    v_mul_f32 v66, 0x3fb8aa3b, v66
    v_mul_f32 v67, 0x3fb8aa3b, v67
    v_exp_f32 v60, v60
    v_exp_f32 v61, v61
    v_exp_f32 v62, v62
    v_exp_f32 v63, v63
    v_exp_f32 v64, v64
    v_exp_f32 v65, v65
    v_exp_f32 v66, v66
    v_exp_f32 v67, v67
    v_cvt_pk_bf16_f32 v72, v60, v61
    v_cvt_pk_bf16_f32 v73, v62, v63
    v_cvt_pk_bf16_f32 v74, v64, v65
    v_cvt_pk_bf16_f32 v75, v66, v67
    v_and_b32 v80, 0xffff0000, v116
    v_subrev_f32 v60, s50, v80
    v_subrev_f32 v61, s51, v80
    v_subrev_f32 v62, s52, v80
    v_subrev_f32 v63, s53, v80
    v_subrev_f32 v64, s54, v80
    v_subrev_f32 v65, s55, v80
    v_subrev_f32 v66, s56, v80
    v_subrev_f32 v67, s57, v80
    v_cvt_pk_bf16_f32 v68, v60, v61
    v_cvt_pk_bf16_f32 v69, v62, v63
    v_cvt_pk_bf16_f32 v70, v64, v65
    v_cvt_pk_bf16_f32 v71, v66, v67
    v_lshlrev_b32 v60, 16, v68
    v_and_b32 v61, 0xffff0000, v68
    v_lshlrev_b32 v62, 16, v69
    v_and_b32 v63, 0xffff0000, v69
    v_lshlrev_b32 v64, 16, v70
    v_and_b32 v65, 0xffff0000, v70
    v_lshlrev_b32 v66, 16, v71
    v_and_b32 v67, 0xffff0000, v71
    v_mul_f32 v60, v60, v60
    v_mul_f32 v61, v61, v61
    v_mul_f32 v62, v62, v62
    v_mul_f32 v63, v63, v63
    v_mul_f32 v64, v64, v64
    v_mul_f32 v65, v65, v65
    v_mul_f32 v66, v66, v66
    v_mul_f32 v67, v67, v67
    v_cvt_pk_bf16_f32 v68, v60, v61
    v_cvt_pk_bf16_f32 v69, v62, v63
    v_cvt_pk_bf16_f32 v70, v64, v65
    v_cvt_pk_bf16_f32 v71, v66, v67
    v_lshlrev_b32 v60, 16, v68
    v_and_b32 v61, 0xffff0000, v68
    v_lshlrev_b32 v62, 16, v69
    v_and_b32 v63, 0xffff0000, v69
    v_lshlrev_b32 v64, 16, v70
    v_and_b32 v65, 0xffff0000, v70
    v_lshlrev_b32 v66, 16, v71
    v_and_b32 v67, 0xffff0000, v71
    v_mul_f32 v60, 0xc1200000, v60
    v_mul_f32 v61, 0xc1200000, v61
    v_mul_f32 v62, 0xc1200000, v62
    v_mul_f32 v63, 0xc1200000, v63
    v_mul_f32 v64, 0xc1200000, v64
    v_mul_f32 v65, 0xc1200000, v65
    v_mul_f32 v66, 0xc1200000, v66
    v_mul_f32 v67, 0xc1200000, v67
    v_cvt_pk_bf16_f32 v68, v60, v61
    v_cvt_pk_bf16_f32 v69, v62, v63
    v_cvt_pk_bf16_f32 v70, v64, v65
    v_cvt_pk_bf16_f32 v71, v66, v67
    v_lshlrev_b32 v60, 16, v68
    v_and_b32 v61, 0xffff0000, v68
    v_lshlrev_b32 v62, 16, v69
    v_and_b32 v63, 0xffff0000, v69
    v_lshlrev_b32 v64, 16, v70
    v_and_b32 v65, 0xffff0000, v70
    v_lshlrev_b32 v66, 16, v71
    v_and_b32 v67, 0xffff0000, v71
    v_mul_f32 v60, 0x3fb8aa3b, v60
    v_mul_f32 v61, 0x3fb8aa3b, v61
    v_mul_f32 v62, 0x3fb8aa3b, v62
    v_mul_f32 v63, 0x3fb8aa3b, v63
    v_mul_f32 v64, 0x3fb8aa3b, v64
    v_mul_f32 v65, 0x3fb8aa3b, v65
    v_mul_f32 v66, 0x3fb8aa3b, v66
    v_mul_f32 v67, 0x3fb8aa3b, v67
    v_exp_f32 v60, v60
    v_exp_f32 v61, v61
    v_exp_f32 v62, v62
    v_exp_f32 v63, v63
    v_exp_f32 v64, v64
    v_exp_f32 v65, v65
    v_exp_f32 v66, v66
    v_exp_f32 v67, v67
    v_cvt_pk_bf16_f32 v76, v60, v61
    v_cvt_pk_bf16_f32 v77, v62, v63
    v_cvt_pk_bf16_f32 v78, v64, v65
    v_cvt_pk_bf16_f32 v79, v66, v67
    v_mfma_f32_4x4x4_16b_bf16 v[80:83], v[48:49], v[72:73], 0
    v_mfma_f32_4x4x4_16b_bf16 v[88:91], v[52:53], v[72:73], 0
    v_mfma_f32_4x4x4_16b_bf16 v[84:87], v[48:49], v[76:77], 0
    v_mfma_f32_4x4x4_16b_bf16 v[92:95], v[52:53], v[76:77], 0
    v_mfma_f32_4x4x4_16b_bf16 v[80:83], v[50:51], v[74:75], v[80:83]
    v_mfma_f32_4x4x4_16b_bf16 v[88:91], v[54:55], v[74:75], v[88:91]
    v_mfma_f32_4x4x4_16b_bf16 v[84:87], v[50:51], v[78:79], v[84:87]
    v_mfma_f32_4x4x4_16b_bf16 v[92:95], v[54:55], v[78:79], v[92:95]
    ds_read_b128 v[32:35], v118
    ds_read_b128 v[60:63], v119
    s_add_u32 s20, s30, 0xd823000
    s_addc_u32 s21, s31, 0
    s_mov_b32 s22, 0x1388000
    s_mov_b32 s23, 0x20000
    s_add_u32 s3, s33, 1
    s_and_b32 s3, s3, 3
    s_lshl_b32 s3, s3, 6
    s_add_u32 s3, s3, s34
    s_mul_i32 s44, s3, 80000
    s_add_u32 s3, s33, 2
    s_and_b32 s3, s3, 3
    s_lshl_b32 s3, s3, 6
    s_add_u32 s3, s3, s34
    s_mul_i32 s45, s3, 80000
    s_add_u32 s3, s33, 3
    s_and_b32 s3, s3, 3
    s_lshl_b32 s3, s3, 6
    s_add_u32 s3, s3, s34
    s_mul_i32 s46, s3, 80000
    s_lshl_b32 s3, s34, 9
    s_lshl_b32 s4, s33, 7
    s_add_u32 s4, s4, s3
    v_mov_b32 v104, 1
    v_lshlrev_b32 v105, 3, v122
    s_waitcnt vmcnt(0)
    s_barrier
    s_cmp_lg_u32 s32, 0
    s_cbranch_scc1 L2_f2
    s_mov_b64 exec, 1
    buffer_store_dword v104, off, s[8:11], s4 sc1
    s_mov_b64 exec, 15
    s_bitset0_b64 exec, s33
L2_f3:
    buffer_load_dword v104, v105, s[8:11], s3 offen sc1
    s_waitcnt vmcnt(0)
    v_cmp_ne_u32 vcc, 1, v104
    s_cbranch_vccnz L2_f3
L2_f4:
    s_mov_b64 exec, -1
L2_f2:
    s_barrier
    buffer_load_dwordx4 v[36:39], v118, s[20:23], s44 offen sc1
    buffer_load_dwordx4 v[40:43], v118, s[20:23], s45 offen sc1
    buffer_load_dwordx4 v[44:47], v118, s[20:23], s46 offen sc1
    s_cmp_ge_u32 s32, 4
    s_cbranch_scc1 L2_f5
    buffer_load_dwordx4 v[64:67], v119, s[20:23], s44 offen sc1
    buffer_load_dwordx4 v[68:71], v119, s[20:23], s45 offen sc1
    buffer_load_dwordx4 v[72:75], v119, s[20:23], s46 offen sc1
    v_lshlrev_b32 v16, 16, v117
    v_subrev_f32 v96, s50, v16
    v_subrev_f32 v97, s51, v16
    v_subrev_f32 v98, s52, v16
    v_subrev_f32 v99, s53, v16
    v_subrev_f32 v100, s54, v16
    v_subrev_f32 v101, s55, v16
    v_subrev_f32 v102, s56, v16
    v_subrev_f32 v103, s57, v16
    v_cvt_pk_bf16_f32 v0, v96, v97
    v_cvt_pk_bf16_f32 v1, v98, v99
    v_cvt_pk_bf16_f32 v2, v100, v101
    v_cvt_pk_bf16_f32 v3, v102, v103
    v_lshlrev_b32 v96, 16, v0
    v_and_b32 v97, 0xffff0000, v0
    v_lshlrev_b32 v98, 16, v1
    v_and_b32 v99, 0xffff0000, v1
    v_lshlrev_b32 v100, 16, v2
    v_and_b32 v101, 0xffff0000, v2
    v_lshlrev_b32 v102, 16, v3
    v_and_b32 v103, 0xffff0000, v3
    v_mul_f32 v96, v96, v96
    v_mul_f32 v97, v97, v97
    v_mul_f32 v98, v98, v98
    v_mul_f32 v99, v99, v99
    v_mul_f32 v100, v100, v100
    v_mul_f32 v101, v101, v101
    v_mul_f32 v102, v102, v102
    v_mul_f32 v103, v103, v103
    v_cvt_pk_bf16_f32 v0, v96, v97
    v_cvt_pk_bf16_f32 v1, v98, v99
    v_cvt_pk_bf16_f32 v2, v100, v101
    v_cvt_pk_bf16_f32 v3, v102, v103
    v_lshlrev_b32 v96, 16, v0
    v_and_b32 v97, 0xffff0000, v0
    v_lshlrev_b32 v98, 16, v1
    v_and_b32 v99, 0xffff0000, v1
    v_lshlrev_b32 v100, 16, v2
    v_and_b32 v101, 0xffff0000, v2
    v_lshlrev_b32 v102, 16, v3
    v_and_b32 v103, 0xffff0000, v3
    v_mul_f32 v96, 0xc1200000, v96
    v_mul_f32 v97, 0xc1200000, v97
    v_mul_f32 v98, 0xc1200000, v98
    v_mul_f32 v99, 0xc1200000, v99
    v_mul_f32 v100, 0xc1200000, v100
    v_mul_f32 v101, 0xc1200000, v101
    v_mul_f32 v102, 0xc1200000, v102
    v_mul_f32 v103, 0xc1200000, v103
    v_cvt_pk_bf16_f32 v0, v96, v97
    v_cvt_pk_bf16_f32 v1, v98, v99
    v_cvt_pk_bf16_f32 v2, v100, v101
    v_cvt_pk_bf16_f32 v3, v102, v103
    v_lshlrev_b32 v96, 16, v0
    v_and_b32 v97, 0xffff0000, v0
    v_lshlrev_b32 v98, 16, v1
    v_and_b32 v99, 0xffff0000, v1
    v_lshlrev_b32 v100, 16, v2
    v_and_b32 v101, 0xffff0000, v2
    v_lshlrev_b32 v102, 16, v3
    v_and_b32 v103, 0xffff0000, v3
    v_mul_f32 v96, 0x3fb8aa3b, v96
    v_mul_f32 v97, 0x3fb8aa3b, v97
    v_mul_f32 v98, 0x3fb8aa3b, v98
    v_mul_f32 v99, 0x3fb8aa3b, v99
    v_mul_f32 v100, 0x3fb8aa3b, v100
    v_mul_f32 v101, 0x3fb8aa3b, v101
    v_mul_f32 v102, 0x3fb8aa3b, v102
    v_mul_f32 v103, 0x3fb8aa3b, v103
    v_exp_f32 v96, v96
    v_exp_f32 v97, v97
    v_exp_f32 v98, v98
    v_exp_f32 v99, v99
    v_exp_f32 v100, v100
    v_exp_f32 v101, v101
    v_exp_f32 v102, v102
    v_exp_f32 v103, v103
    v_cvt_pk_bf16_f32 v104, v96, v97
    v_cvt_pk_bf16_f32 v105, v98, v99
    v_cvt_pk_bf16_f32 v106, v100, v101
    v_cvt_pk_bf16_f32 v107, v102, v103
    v_and_b32 v16, 0xffff0000, v117
    v_subrev_f32 v96, s50, v16
    v_subrev_f32 v97, s51, v16
    v_subrev_f32 v98, s52, v16
    v_subrev_f32 v99, s53, v16
    v_subrev_f32 v100, s54, v16
    v_subrev_f32 v101, s55, v16
    v_subrev_f32 v102, s56, v16
    v_subrev_f32 v103, s57, v16
    v_cvt_pk_bf16_f32 v0, v96, v97
    v_cvt_pk_bf16_f32 v1, v98, v99
    v_cvt_pk_bf16_f32 v2, v100, v101
    v_cvt_pk_bf16_f32 v3, v102, v103
    v_lshlrev_b32 v96, 16, v0
    v_and_b32 v97, 0xffff0000, v0
    v_lshlrev_b32 v98, 16, v1
    v_and_b32 v99, 0xffff0000, v1
    v_lshlrev_b32 v100, 16, v2
    v_and_b32 v101, 0xffff0000, v2
    v_lshlrev_b32 v102, 16, v3
    v_and_b32 v103, 0xffff0000, v3
    v_mul_f32 v96, v96, v96
    v_mul_f32 v97, v97, v97
    v_mul_f32 v98, v98, v98
    v_mul_f32 v99, v99, v99
    v_mul_f32 v100, v100, v100
    v_mul_f32 v101, v101, v101
    v_mul_f32 v102, v102, v102
    v_mul_f32 v103, v103, v103
    v_cvt_pk_bf16_f32 v0, v96, v97
    v_cvt_pk_bf16_f32 v1, v98, v99
    v_cvt_pk_bf16_f32 v2, v100, v101
    v_cvt_pk_bf16_f32 v3, v102, v103
    v_lshlrev_b32 v96, 16, v0
    v_and_b32 v97, 0xffff0000, v0
    v_lshlrev_b32 v98, 16, v1
    v_and_b32 v99, 0xffff0000, v1
    v_lshlrev_b32 v100, 16, v2
    v_and_b32 v101, 0xffff0000, v2
    v_lshlrev_b32 v102, 16, v3
    v_and_b32 v103, 0xffff0000, v3
    v_mul_f32 v96, 0xc1200000, v96
    v_mul_f32 v97, 0xc1200000, v97
    v_mul_f32 v98, 0xc1200000, v98
    v_mul_f32 v99, 0xc1200000, v99
    v_mul_f32 v100, 0xc1200000, v100
    v_mul_f32 v101, 0xc1200000, v101
    v_mul_f32 v102, 0xc1200000, v102
    v_mul_f32 v103, 0xc1200000, v103
    v_cvt_pk_bf16_f32 v0, v96, v97
    v_cvt_pk_bf16_f32 v1, v98, v99
    v_cvt_pk_bf16_f32 v2, v100, v101
    v_cvt_pk_bf16_f32 v3, v102, v103
    v_lshlrev_b32 v96, 16, v0
    v_and_b32 v97, 0xffff0000, v0
    v_lshlrev_b32 v98, 16, v1
    v_and_b32 v99, 0xffff0000, v1
    v_lshlrev_b32 v100, 16, v2
    v_and_b32 v101, 0xffff0000, v2
    v_lshlrev_b32 v102, 16, v3
    v_and_b32 v103, 0xffff0000, v3
    v_mul_f32 v96, 0x3fb8aa3b, v96
    v_mul_f32 v97, 0x3fb8aa3b, v97
    v_mul_f32 v98, 0x3fb8aa3b, v98
    v_mul_f32 v99, 0x3fb8aa3b, v99
    v_mul_f32 v100, 0x3fb8aa3b, v100
    v_mul_f32 v101, 0x3fb8aa3b, v101
    v_mul_f32 v102, 0x3fb8aa3b, v102
    v_mul_f32 v103, 0x3fb8aa3b, v103
    v_exp_f32 v96, v96
    v_exp_f32 v97, v97
    v_exp_f32 v98, v98
    v_exp_f32 v99, v99
    v_exp_f32 v100, v100
    v_exp_f32 v101, v101
    v_exp_f32 v102, v102
    v_exp_f32 v103, v103
    v_cvt_pk_bf16_f32 v76, v96, v97
    v_cvt_pk_bf16_f32 v77, v98, v99
    v_cvt_pk_bf16_f32 v78, v100, v101
    v_cvt_pk_bf16_f32 v79, v102, v103
    v_mfma_f32_4x4x4_16b_bf16 v[16:19], v[48:49], v[104:105], 0
    v_mfma_f32_4x4x4_16b_bf16 v[24:27], v[52:53], v[104:105], 0
    v_mfma_f32_4x4x4_16b_bf16 v[20:23], v[48:49], v[76:77], 0
    v_mfma_f32_4x4x4_16b_bf16 v[28:31], v[52:53], v[76:77], 0
    v_mfma_f32_4x4x4_16b_bf16 v[16:19], v[50:51], v[106:107], v[16:19]
    v_mfma_f32_4x4x4_16b_bf16 v[24:27], v[54:55], v[106:107], v[24:27]
    v_mfma_f32_4x4x4_16b_bf16 v[20:23], v[50:51], v[78:79], v[20:23]
    v_mfma_f32_4x4x4_16b_bf16 v[28:31], v[54:55], v[78:79], v[28:31]
L2_f5:
    s_waitcnt vmcnt(0) lgkmcnt(0)
    v_mfma_f32_4x4x4_16b_bf16 v[96:99], v[10:11], v[32:33], 0
    v_mfma_f32_4x4x4_16b_bf16 v[100:103], v[10:11], v[34:35], 0
    s_nop 0
    v_mfma_f32_4x4x4_16b_bf16 v[96:99], v[10:11], v[36:37], v[96:99]
    v_mfma_f32_4x4x4_16b_bf16 v[100:103], v[10:11], v[38:39], v[100:103]
    s_nop 0
    v_mfma_f32_4x4x4_16b_bf16 v[96:99], v[10:11], v[40:41], v[96:99]
    v_mfma_f32_4x4x4_16b_bf16 v[100:103], v[10:11], v[42:43], v[100:103]
    s_nop 0
    v_mfma_f32_4x4x4_16b_bf16 v[96:99], v[10:11], v[44:45], v[96:99]
    v_mfma_f32_4x4x4_16b_bf16 v[100:103], v[10:11], v[46:47], v[100:103]
    s_nop 3
    v_mul_f32 v96, v96, v80
    v_mul_f32 v97, v97, v81
    v_mul_f32 v98, v98, v82
    v_mul_f32 v99, v99, v83
    v_cvt_pk_bf16_f32 v32, v96, v97
    v_cvt_pk_bf16_f32 v33, v98, v99
    v_mul_f32 v100, v100, v84
    v_mul_f32 v101, v101, v85
    v_mul_f32 v102, v102, v86
    v_mul_f32 v103, v103, v87
    v_cvt_pk_bf16_f32 v34, v100, v101
    v_cvt_pk_bf16_f32 v35, v102, v103
    v_mfma_f32_4x4x4_16b_bf16 v[80:83], v[56:57], v[32:33], 0
    s_nop 0
    v_mfma_f32_4x4x4_16b_bf16 v[84:87], v[56:57], v[34:35], 0
    s_nop 2
    v_mul_f32 v80, v80, v88
    v_mul_f32 v81, v81, v89
    v_mul_f32 v82, v82, v90
    v_mul_f32 v83, v83, v91
    v_mul_f32 v84, v84, v92
    v_mul_f32 v85, v85, v93
    v_mul_f32 v86, v86, v94
    v_mul_f32 v87, v87, v95
    v_mfma_f32_4x4x4_16b_bf16 v[96:99], v[10:11], v[108:109], v[80:83]
    s_nop 0
    v_mfma_f32_4x4x4_16b_bf16 v[100:103], v[10:11], v[110:111], v[84:87]
    s_nop 2
    v_cvt_pk_bf16_f32 v36, v96, v97
    v_cvt_pk_bf16_f32 v37, v98, v99
    v_cvt_pk_bf16_f32 v38, v100, v101
    v_cvt_pk_bf16_f32 v39, v102, v103
    buffer_store_dwordx4 v[36:39], v120, s[12:15], 0 offen
    s_cmp_ge_u32 s32, 4
    s_cbranch_scc1 L2_f6
    v_mfma_f32_4x4x4_16b_bf16 v[96:99], v[10:11], v[60:61], 0
    v_mfma_f32_4x4x4_16b_bf16 v[100:103], v[10:11], v[62:63], 0
    s_nop 0
    v_mfma_f32_4x4x4_16b_bf16 v[96:99], v[10:11], v[64:65], v[96:99]
    v_mfma_f32_4x4x4_16b_bf16 v[100:103], v[10:11], v[66:67], v[100:103]
    s_nop 0
    v_mfma_f32_4x4x4_16b_bf16 v[96:99], v[10:11], v[68:69], v[96:99]
    v_mfma_f32_4x4x4_16b_bf16 v[100:103], v[10:11], v[70:71], v[100:103]
    s_nop 0
    v_mfma_f32_4x4x4_16b_bf16 v[96:99], v[10:11], v[72:73], v[96:99]
    v_mfma_f32_4x4x4_16b_bf16 v[100:103], v[10:11], v[74:75], v[100:103]
    s_nop 3
    v_mul_f32 v96, v96, v16
    v_mul_f32 v97, v97, v17
    v_mul_f32 v98, v98, v18
    v_mul_f32 v99, v99, v19
    v_cvt_pk_bf16_f32 v60, v96, v97
    v_cvt_pk_bf16_f32 v61, v98, v99
    v_mul_f32 v100, v100, v20
    v_mul_f32 v101, v101, v21
    v_mul_f32 v102, v102, v22
    v_mul_f32 v103, v103, v23
    v_cvt_pk_bf16_f32 v62, v100, v101
    v_cvt_pk_bf16_f32 v63, v102, v103
    v_mfma_f32_4x4x4_16b_bf16 v[16:19], v[56:57], v[60:61], 0
    s_nop 0
    v_mfma_f32_4x4x4_16b_bf16 v[20:23], v[56:57], v[62:63], 0
    s_nop 2
    v_mul_f32 v16, v16, v24
    v_mul_f32 v17, v17, v25
    v_mul_f32 v18, v18, v26
    v_mul_f32 v19, v19, v27
    v_mul_f32 v20, v20, v28
    v_mul_f32 v21, v21, v29
    v_mul_f32 v22, v22, v30
    v_mul_f32 v23, v23, v31
    v_mfma_f32_4x4x4_16b_bf16 v[96:99], v[10:11], v[112:113], v[16:19]
    s_nop 0
    v_mfma_f32_4x4x4_16b_bf16 v[100:103], v[10:11], v[114:115], v[20:23]
    s_nop 2
    v_cvt_pk_bf16_f32 v64, v96, v97
    v_cvt_pk_bf16_f32 v65, v98, v99
    v_cvt_pk_bf16_f32 v66, v100, v101
    v_cvt_pk_bf16_f32 v67, v102, v103
    buffer_store_dwordx4 v[64:67], v121, s[12:15], 0 offen
L2_f6:
L2_end:
    s_endpgm
L2_slow:
    s_lshr_b32 s35, s42, 2
    s_mul_i32 s50, s32, 80
    s_add_u32 s57, s50, 80
    s_and_b32 s3, s42, 3
    s_lshl_b32 s53, s3, 3
    s_add_u32 s53, s53, s39
    s_and_b32 s3, s35, 2
    s_lshl_b32 s3, s3, 1
    s_add_u32 s53, s53, s3
    s_and_b32 s54, s35, 1
    s_lshl_b32 s54, s54, 4
L2_sl_seg:
    s_mul_i32 s56, s50, 173056
    s_and_b32 s3, s50, 3
    s_lshl_b32 s3, s3, 5
    s_add_u32 s3, s3, s56
    s_add_u32 s3, s3, s53
    s_add_u32 s55, s3, 32
    s_buffer_load_dword s51, s[12:15], s3
    s_buffer_load_dword s52, s[12:15], s55
    s_waitcnt lgkmcnt(0)
    s_lshr_b32 s51, s51, s54
    s_and_b32 s51, s51, 0xffff
    s_lshr_b32 s52, s52, s54
    s_and_b32 s52, s52, 0xffff
L2_sl_rec:
    s_cmp_ge_u32 s51, s52
    s_cbranch_scc1 L2_sl_next
    v_mbcnt_lo_u32_b32 v102, -1, 0
    v_mbcnt_hi_u32_b32 v102, -1, v102
    v_add_u32 v102, s51, v102
    v_and_b32 v103, -4, v102
    v_lshl_add_u32 v104, v102, 2, v103
    v_lshl_add_u32 v105, v103, 2, v102
    v_cmp_gt_u32 vcc, s52, v102
    s_mov_b64 exec, vcc
    buffer_load_dword v106, v104, s[8:11], s56 offen
    buffer_load_ubyte v107, v105, s[8:11], s56 offen offset:16
    s_waitcnt vmcnt(0)
    v_lshrrev_b32 v98, 14, v106
    v_and_b32 v98, v5, v98
    ds_read_b64 v[100:101], v98 offset:63616
    v_perm_b32 v97, v106, v107, s44
    v_and_b32 v96, v5, v106
    v_bitop3_b32 v103, v106, 0.5, -0.5 bitop3:0xa8
    v_bitop3_b32 v97, v6, v97, v103 bitop3:0xca
    s_waitcnt lgkmcnt(0)
    v_mfma_f32_4x4x4_16b_bf16 v[88:91], v[8:9], v[100:101], 0
    s_nop 4
    v_mul_f32 v88, v97, v88
    v_mul_f32 v89, v97, v89
    v_mul_f32 v90, v97, v90
    v_mul_f32 v91, v97, v91
    v_cvt_pk_bf16_f32 v88, v88, v89
    v_cvt_pk_bf16_f32 v89, v90, v91
    ds_pk_add_bf16 v96, v88
    ds_pk_add_bf16 v96, v89 offset:4
    s_mov_b64 exec, -1
    s_add_u32 s51, s51, 64
    s_branch L2_sl_rec
L2_sl_next:
    s_add_u32 s50, s50, 1
    s_cmp_lt_u32 s50, s57
    s_cbranch_scc1 L2_sl_seg
    s_waitcnt lgkmcnt(0)
    s_cmp_eq_u32 s42, 0
    s_cbranch_scc1 L2_ret0
    s_cmp_eq_u32 s42, 1
    s_cbranch_scc1 L2_ret1
    s_cmp_eq_u32 s42, 14
    s_cbranch_scc1 L2_ret6
    s_cmp_eq_u32 s42, 15
    s_cbranch_scc1 L2_ret7
    s_and_b32 s3, s42, 3
    s_cmp_eq_u32 s3, 2
    s_cbranch_scc1 L2_ret2
    s_cmp_eq_u32 s3, 3
    s_cbranch_scc1 L2_ret3
    s_cmp_eq_u32 s3, 0
    s_cbranch_scc1 L2_ret4
    s_branch L2_ret5
L2_xo1:
    v_cmp_lt_u32 vcc, 20, v99
    s_mov_b32 s43, 1
    s_cbranch_vccz L2_xp1
    v_cmp_lt_u32 vcc, 32, v99
    v_cmp_lt_u32 s[58:59], 31, v88
    s_mov_b32 s43, 2
    s_or_b64 vcc, vcc, s[58:59]
    s_cbranch_scc0 L2_xp1
    s_mov_b32 s37, 0x10000
    s_branch L2_xp1
L2_xa2:
    s_cmp_eq_u32 s43, 1
    s_cbranch_scc1 L2_xc2
    v_lshlrev_b32 v89, 0, v96
    v_add_u32 v90, 140, v97
    v_bitop3_b32 v90, v89, v45, v90 bitop3:0x6a
    ds_write_b32 v98, v90 offset:28
    v_lshlrev_b32 v89, 4, v96
    v_add_u32 v90, 120, v97
    v_bitop3_b32 v90, v89, v45, v90 bitop3:0x6a
    ds_write_b32 v98, v90 offset:24
    v_lshlrev_b32 v89, 8, v96
    v_add_u32 v90, 100, v97
    v_bitop3_b32 v90, v89, v45, v90 bitop3:0x6a
    ds_write_b32 v98, v90 offset:20
L2_xc2:
    v_lshlrev_b32 v89, 12, v96
    v_add_u32 v90, 80, v97
    v_bitop3_b32 v90, v89, v45, v90 bitop3:0x6a
    ds_write_b32 v98, v90 offset:16
    s_branch L2_xb2
L2_xe2:
    v_cmp_lt_u32 vcc, 32, v99
    v_cmp_lt_u32 s[58:59], 31, v88
    v_lshrrev_b32 v89, 16, v96
    v_add_u32 v97, 80, v97
    s_or_b64 vcc, vcc, s[58:59]
    s_cbranch_scc1 L2_xs2
    v_lshlrev_b32 v89, v1, v89
    v_and_b32 v89, v45, v89
    v_cmp_ne_u32 vcc, 0, v89
    v_xor_b32 v90, v97, v89
    s_add_u32 s3, s37, s38
    v_mbcnt_lo_u32_b32 v98, vcc_lo, 0
    v_mbcnt_hi_u32_b32 v98, vcc_hi, v98
    s_bcnt1_i32_b64 s41, vcc
    v_lshl_add_u32 v98, v98, 2, s3
    s_mov_b64 exec, vcc
    ds_write_b32 v98, v90
    s_mov_b64 exec, -1
    s_lshl2_add_u32 s37, s41, s37
    s_branch L2_xr2
L2_xf2:
    s_waitcnt lgkmcnt(0)
    s_cmp_gt_u32 s37, 1024
    s_cbranch_scc1 L2_xs2
    v_mov_b32 v43, -1
    s_cmp_ge_u32 s37, 512
    s_cbranch_scc1 L2_xg2
    v_mov_b32 v42, -1
    s_cmp_ge_u32 s37, 256
    s_cbranch_scc1 L2_xg2
    v_mov_b32 v41, -1
    s_branch L2_xg2
L2_xs2:
    s_waitcnt lgkmcnt(0)
    v_mov_b32 v40, -1
    v_mov_b32 v41, -1
    v_mov_b32 v42, -1
    v_mov_b32 v43, -1
    s_add_u32 s3, s42, 0
    s_bitset1_b32 s36, s3
    s_branch L2_xg2
L2_xo3:
    v_cmp_lt_u32 vcc, 20, v99
    s_mov_b32 s43, 1
    s_cbranch_vccz L2_xp3
    v_cmp_lt_u32 vcc, 32, v99
    v_cmp_lt_u32 s[58:59], 31, v88
    s_mov_b32 s43, 2
    s_or_b64 vcc, vcc, s[58:59]
    s_cbranch_scc0 L2_xp3
    s_mov_b32 s37, 0x10000
    s_branch L2_xp3
L2_xa4:
    s_cmp_eq_u32 s43, 1
    s_cbranch_scc1 L2_xc4
    v_lshlrev_b32 v89, 0, v96
    v_add_u32 v90, 140, v97
    v_bitop3_b32 v90, v89, v45, v90 bitop3:0x6a
    ds_write_b32 v98, v90 offset:28
    v_lshlrev_b32 v89, 4, v96
    v_add_u32 v90, 120, v97
    v_bitop3_b32 v90, v89, v45, v90 bitop3:0x6a
    ds_write_b32 v98, v90 offset:24
    v_lshlrev_b32 v89, 8, v96
    v_add_u32 v90, 100, v97
    v_bitop3_b32 v90, v89, v45, v90 bitop3:0x6a
    ds_write_b32 v98, v90 offset:20
L2_xc4:
    v_lshlrev_b32 v89, 12, v96
    v_add_u32 v90, 80, v97
    v_bitop3_b32 v90, v89, v45, v90 bitop3:0x6a
    ds_write_b32 v98, v90 offset:16
    s_branch L2_xb4
L2_xe4:
    v_cmp_lt_u32 vcc, 32, v99
    v_cmp_lt_u32 s[58:59], 31, v88
    v_lshrrev_b32 v89, 16, v96
    v_add_u32 v97, 80, v97
    s_or_b64 vcc, vcc, s[58:59]
    s_cbranch_scc1 L2_xs4
    v_lshlrev_b32 v89, v1, v89
    v_and_b32 v89, v45, v89
    v_cmp_ne_u32 vcc, 0, v89
    v_xor_b32 v90, v97, v89
    s_add_u32 s3, s37, s38
    v_mbcnt_lo_u32_b32 v98, vcc_lo, 0
    v_mbcnt_hi_u32_b32 v98, vcc_hi, v98
    s_bcnt1_i32_b64 s41, vcc
    v_lshl_add_u32 v98, v98, 2, s3
    s_mov_b64 exec, vcc
    ds_write_b32 v98, v90
    s_mov_b64 exec, -1
    s_lshl2_add_u32 s37, s41, s37
    s_branch L2_xr4
L2_xf4:
    s_waitcnt lgkmcnt(0)
    s_cmp_gt_u32 s37, 1024
    s_cbranch_scc1 L2_xs4
    v_mov_b32 v43, -1
    s_cmp_ge_u32 s37, 512
    s_cbranch_scc1 L2_xg4
    v_mov_b32 v42, -1
    s_cmp_ge_u32 s37, 256
    s_cbranch_scc1 L2_xg4
    v_mov_b32 v41, -1
    s_branch L2_xg4
L2_xs4:
    s_waitcnt lgkmcnt(0)
    v_mov_b32 v40, -1
    v_mov_b32 v41, -1
    v_mov_b32 v42, -1
    v_mov_b32 v43, -1
    s_add_u32 s3, s42, 1
    s_bitset1_b32 s36, s3
    s_branch L2_xg4
L2_c5:
    s_mov_b64 exec, s[82:83]
    s_nop 1
    v_mfma_f32_4x4x4_16b_bf16 v[88:91], v[12:13], v[84:85], 0
    s_nop 1
    v_mfma_f32_4x4x4_16b_bf16 v[88:91], v[10:11], v[86:87], v[88:91]
    s_nop 4
    v_cvt_pk_bf16_f32 v88, v88, v89
    v_cvt_pk_bf16_f32 v89, v90, v91
    ds_pk_add_bf16 v7, v88
    ds_pk_add_bf16 v7, v89 offset:4
    s_mov_b64 exec, vcc
    s_branch L2_d5
L2_c6:
    s_mov_b64 exec, s[82:83]
    s_nop 1
    v_mfma_f32_4x4x4_16b_bf16 v[88:91], v[12:13], v[84:85], 0
    s_nop 1
    v_mfma_f32_4x4x4_16b_bf16 v[88:91], v[10:11], v[86:87], v[88:91]
    s_nop 4
    v_cvt_pk_bf16_f32 v88, v88, v89
    v_cvt_pk_bf16_f32 v89, v90, v91
    ds_pk_add_bf16 v7, v88
    ds_pk_add_bf16 v7, v89 offset:4
    s_mov_b64 exec, vcc
    s_branch L2_d6
L2_c7:
    s_mov_b64 exec, s[82:83]
    s_nop 1
    v_mfma_f32_4x4x4_16b_bf16 v[88:91], v[12:13], v[84:85], 0
    s_nop 1
    v_mfma_f32_4x4x4_16b_bf16 v[88:91], v[10:11], v[86:87], v[88:91]
    s_nop 4
    v_cvt_pk_bf16_f32 v88, v88, v89
    v_cvt_pk_bf16_f32 v89, v90, v91
    ds_pk_add_bf16 v7, v88
    ds_pk_add_bf16 v7, v89 offset:4
    s_mov_b64 exec, vcc
    s_branch L2_d7
L2_c8:
    s_mov_b64 exec, s[82:83]
    s_nop 1
    v_mfma_f32_4x4x4_16b_bf16 v[88:91], v[12:13], v[84:85], 0
    s_nop 1
    v_mfma_f32_4x4x4_16b_bf16 v[88:91], v[10:11], v[86:87], v[88:91]
    s_nop 4
    v_cvt_pk_bf16_f32 v88, v88, v89
    v_cvt_pk_bf16_f32 v89, v90, v91
    ds_pk_add_bf16 v7, v88
    ds_pk_add_bf16 v7, v89 offset:4
    s_mov_b64 exec, vcc
    s_branch L2_d8
L2_xo9:
    v_cmp_lt_u32 vcc, 20, v99
    s_mov_b32 s43, 1
    s_cbranch_vccz L2_xp9
    v_cmp_lt_u32 vcc, 32, v99
    v_cmp_lt_u32 s[58:59], 31, v88
    s_mov_b32 s43, 2
    s_or_b64 vcc, vcc, s[58:59]
    s_cbranch_scc0 L2_xp9
    s_mov_b32 s37, 0x10000
    s_branch L2_xp9
L2_c10:
    s_mov_b64 exec, s[82:83]
    s_nop 1
    v_mfma_f32_4x4x4_16b_bf16 v[88:91], v[12:13], v[84:85], 0
    s_nop 1
    v_mfma_f32_4x4x4_16b_bf16 v[88:91], v[10:11], v[86:87], v[88:91]
    s_nop 4
    v_cvt_pk_bf16_f32 v88, v88, v89
    v_cvt_pk_bf16_f32 v89, v90, v91
    ds_pk_add_bf16 v7, v88
    ds_pk_add_bf16 v7, v89 offset:4
    s_mov_b64 exec, vcc
    s_branch L2_d10
L2_c11:
    s_mov_b64 exec, s[82:83]
    s_nop 1
    v_mfma_f32_4x4x4_16b_bf16 v[88:91], v[12:13], v[84:85], 0
    s_nop 1
    v_mfma_f32_4x4x4_16b_bf16 v[88:91], v[10:11], v[86:87], v[88:91]
    s_nop 4
    v_cvt_pk_bf16_f32 v88, v88, v89
    v_cvt_pk_bf16_f32 v89, v90, v91
    ds_pk_add_bf16 v7, v88
    ds_pk_add_bf16 v7, v89 offset:4
    s_mov_b64 exec, vcc
    s_branch L2_d11
L2_c12:
    s_mov_b64 exec, s[82:83]
    s_nop 1
    v_mfma_f32_4x4x4_16b_bf16 v[88:91], v[12:13], v[84:85], 0
    s_nop 1
    v_mfma_f32_4x4x4_16b_bf16 v[88:91], v[10:11], v[86:87], v[88:91]
    s_nop 4
    v_cvt_pk_bf16_f32 v88, v88, v89
    v_cvt_pk_bf16_f32 v89, v90, v91
    ds_pk_add_bf16 v7, v88
    ds_pk_add_bf16 v7, v89 offset:4
    s_mov_b64 exec, vcc
    s_branch L2_d12
L2_c13:
    s_mov_b64 exec, s[82:83]
    s_nop 1
    v_mfma_f32_4x4x4_16b_bf16 v[88:91], v[12:13], v[84:85], 0
    s_nop 1
    v_mfma_f32_4x4x4_16b_bf16 v[88:91], v[10:11], v[86:87], v[88:91]
    s_nop 4
    v_cvt_pk_bf16_f32 v88, v88, v89
    v_cvt_pk_bf16_f32 v89, v90, v91
    ds_pk_add_bf16 v7, v88
    ds_pk_add_bf16 v7, v89 offset:4
    s_mov_b64 exec, vcc
    s_branch L2_d13
L2_c14:
    s_mov_b64 exec, s[82:83]
    s_nop 1
    v_mfma_f32_4x4x4_16b_bf16 v[88:91], v[12:13], v[84:85], 0
    s_nop 1
    v_mfma_f32_4x4x4_16b_bf16 v[88:91], v[10:11], v[86:87], v[88:91]
    s_nop 4
    v_cvt_pk_bf16_f32 v88, v88, v89
    v_cvt_pk_bf16_f32 v89, v90, v91
    ds_pk_add_bf16 v7, v88
    ds_pk_add_bf16 v7, v89 offset:4
    s_mov_b64 exec, vcc
    s_branch L2_d14
L2_c15:
    s_mov_b64 exec, s[82:83]
    s_nop 1
    v_mfma_f32_4x4x4_16b_bf16 v[88:91], v[12:13], v[84:85], 0
    s_nop 1
    v_mfma_f32_4x4x4_16b_bf16 v[88:91], v[10:11], v[86:87], v[88:91]
    s_nop 4
    v_cvt_pk_bf16_f32 v88, v88, v89
    v_cvt_pk_bf16_f32 v89, v90, v91
    ds_pk_add_bf16 v7, v88
    ds_pk_add_bf16 v7, v89 offset:4
    s_mov_b64 exec, vcc
    s_branch L2_d15
L2_c16:
    s_mov_b64 exec, s[82:83]
    s_nop 1
    v_mfma_f32_4x4x4_16b_bf16 v[88:91], v[12:13], v[84:85], 0
    s_nop 1
    v_mfma_f32_4x4x4_16b_bf16 v[88:91], v[10:11], v[86:87], v[88:91]
    s_nop 4
    v_cvt_pk_bf16_f32 v88, v88, v89
    v_cvt_pk_bf16_f32 v89, v90, v91
    ds_pk_add_bf16 v7, v88
    ds_pk_add_bf16 v7, v89 offset:4
    s_mov_b64 exec, vcc
    s_branch L2_d16
L2_c17:
    s_mov_b64 exec, s[82:83]
    s_nop 1
    v_mfma_f32_4x4x4_16b_bf16 v[88:91], v[12:13], v[84:85], 0
    s_nop 1
    v_mfma_f32_4x4x4_16b_bf16 v[88:91], v[10:11], v[86:87], v[88:91]
    s_nop 4
    v_cvt_pk_bf16_f32 v88, v88, v89
    v_cvt_pk_bf16_f32 v89, v90, v91
    ds_pk_add_bf16 v7, v88
    ds_pk_add_bf16 v7, v89 offset:4
    s_mov_b64 exec, vcc
    s_branch L2_d17
L2_xa18:
    s_cmp_eq_u32 s43, 1
    s_cbranch_scc1 L2_xc18
    v_lshlrev_b32 v89, 0, v96
    v_add_u32 v90, 140, v97
    v_bitop3_b32 v90, v89, v45, v90 bitop3:0x6a
    ds_write_b32 v98, v90 offset:28
    v_lshlrev_b32 v89, 4, v96
    v_add_u32 v90, 120, v97
    v_bitop3_b32 v90, v89, v45, v90 bitop3:0x6a
    ds_write_b32 v98, v90 offset:24
    v_lshlrev_b32 v89, 8, v96
    v_add_u32 v90, 100, v97
    v_bitop3_b32 v90, v89, v45, v90 bitop3:0x6a
    ds_write_b32 v98, v90 offset:20
L2_xc18:
    v_lshlrev_b32 v89, 12, v96
    v_add_u32 v90, 80, v97
    v_bitop3_b32 v90, v89, v45, v90 bitop3:0x6a
    ds_write_b32 v98, v90 offset:16
    s_branch L2_xb18
L2_xe18:
    v_cmp_lt_u32 vcc, 32, v99
    v_cmp_lt_u32 s[58:59], 31, v88
    v_lshrrev_b32 v89, 16, v96
    v_add_u32 v97, 80, v97
    s_or_b64 vcc, vcc, s[58:59]
    s_cbranch_scc1 L2_xs18
    v_lshlrev_b32 v89, v1, v89
    v_and_b32 v89, v45, v89
    v_cmp_ne_u32 vcc, 0, v89
    v_xor_b32 v90, v97, v89
    s_add_u32 s3, s37, s38
    v_mbcnt_lo_u32_b32 v98, vcc_lo, 0
    v_mbcnt_hi_u32_b32 v98, vcc_hi, v98
    s_bcnt1_i32_b64 s41, vcc
    v_lshl_add_u32 v98, v98, 2, s3
    s_mov_b64 exec, vcc
    ds_write_b32 v98, v90
    s_mov_b64 exec, -1
    s_lshl2_add_u32 s37, s41, s37
    s_branch L2_xr18
L2_xf18:
    s_waitcnt lgkmcnt(0)
    s_cmp_gt_u32 s37, 1024
    s_cbranch_scc1 L2_xs18
    v_mov_b32 v43, -1
    s_cmp_ge_u32 s37, 512
    s_cbranch_scc1 L2_xg18
    v_mov_b32 v42, -1
    s_cmp_ge_u32 s37, 256
    s_cbranch_scc1 L2_xg18
    v_mov_b32 v41, -1
    s_branch L2_xg18
L2_xs18:
    s_waitcnt lgkmcnt(0)
    v_mov_b32 v40, -1
    v_mov_b32 v41, -1
    v_mov_b32 v42, -1
    v_mov_b32 v43, -1
    s_add_u32 s3, s42, 2
    s_bitset1_b32 s36, s3
    s_branch L2_xg18
L2_c19:
    s_mov_b64 exec, s[82:83]
    s_nop 1
    v_mfma_f32_4x4x4_16b_bf16 v[88:91], v[12:13], v[84:85], 0
    s_nop 1
    v_mfma_f32_4x4x4_16b_bf16 v[88:91], v[10:11], v[86:87], v[88:91]
    s_nop 4
    v_cvt_pk_bf16_f32 v88, v88, v89
    v_cvt_pk_bf16_f32 v89, v90, v91
    ds_pk_add_bf16 v7, v88
    ds_pk_add_bf16 v7, v89 offset:4
    s_mov_b64 exec, vcc
    s_branch L2_d19
L2_c20:
    s_mov_b64 exec, s[82:83]
    s_nop 1
    v_mfma_f32_4x4x4_16b_bf16 v[88:91], v[12:13], v[84:85], 0
    s_nop 1
    v_mfma_f32_4x4x4_16b_bf16 v[88:91], v[10:11], v[86:87], v[88:91]
    s_nop 4
    v_cvt_pk_bf16_f32 v88, v88, v89
    v_cvt_pk_bf16_f32 v89, v90, v91
    ds_pk_add_bf16 v7, v88
    ds_pk_add_bf16 v7, v89 offset:4
    s_mov_b64 exec, vcc
    s_branch L2_d20
L2_c21:
    s_mov_b64 exec, s[82:83]
    s_nop 1
    v_mfma_f32_4x4x4_16b_bf16 v[88:91], v[12:13], v[84:85], 0
    s_nop 1
    v_mfma_f32_4x4x4_16b_bf16 v[88:91], v[10:11], v[86:87], v[88:91]
    s_nop 4
    v_cvt_pk_bf16_f32 v88, v88, v89
    v_cvt_pk_bf16_f32 v89, v90, v91
    ds_pk_add_bf16 v7, v88
    ds_pk_add_bf16 v7, v89 offset:4
    s_mov_b64 exec, vcc
    s_branch L2_d21
L2_c22:
    s_mov_b64 exec, s[82:83]
    s_nop 1
    v_mfma_f32_4x4x4_16b_bf16 v[88:91], v[12:13], v[84:85], 0
    s_nop 1
    v_mfma_f32_4x4x4_16b_bf16 v[88:91], v[10:11], v[86:87], v[88:91]
    s_nop 4
    v_cvt_pk_bf16_f32 v88, v88, v89
    v_cvt_pk_bf16_f32 v89, v90, v91
    ds_pk_add_bf16 v7, v88
    ds_pk_add_bf16 v7, v89 offset:4
    s_mov_b64 exec, vcc
    s_branch L2_d22
L2_c23:
    s_mov_b64 exec, s[82:83]
    s_nop 1
    v_mfma_f32_4x4x4_16b_bf16 v[88:91], v[12:13], v[84:85], 0
    s_nop 1
    v_mfma_f32_4x4x4_16b_bf16 v[88:91], v[10:11], v[86:87], v[88:91]
    s_nop 4
    v_cvt_pk_bf16_f32 v88, v88, v89
    v_cvt_pk_bf16_f32 v89, v90, v91
    ds_pk_add_bf16 v7, v88
    ds_pk_add_bf16 v7, v89 offset:4
    s_mov_b64 exec, vcc
    s_branch L2_d23
L2_c24:
    s_mov_b64 exec, s[82:83]
    s_nop 1
    v_mfma_f32_4x4x4_16b_bf16 v[88:91], v[12:13], v[84:85], 0
    s_nop 1
    v_mfma_f32_4x4x4_16b_bf16 v[88:91], v[10:11], v[86:87], v[88:91]
    s_nop 4
    v_cvt_pk_bf16_f32 v88, v88, v89
    v_cvt_pk_bf16_f32 v89, v90, v91
    ds_pk_add_bf16 v7, v88
    ds_pk_add_bf16 v7, v89 offset:4
    s_mov_b64 exec, vcc
    s_branch L2_d24
L2_c25:
    s_mov_b64 exec, s[82:83]
    s_nop 1
    v_mfma_f32_4x4x4_16b_bf16 v[88:91], v[12:13], v[84:85], 0
    s_nop 1
    v_mfma_f32_4x4x4_16b_bf16 v[88:91], v[10:11], v[86:87], v[88:91]
    s_nop 4
    v_cvt_pk_bf16_f32 v88, v88, v89
    v_cvt_pk_bf16_f32 v89, v90, v91
    ds_pk_add_bf16 v7, v88
    ds_pk_add_bf16 v7, v89 offset:4
    s_mov_b64 exec, vcc
    s_branch L2_d25
L2_c26:
    s_mov_b64 exec, s[82:83]
    s_nop 1
    v_mfma_f32_4x4x4_16b_bf16 v[88:91], v[12:13], v[84:85], 0
    s_nop 1
    v_mfma_f32_4x4x4_16b_bf16 v[88:91], v[10:11], v[86:87], v[88:91]
    s_nop 4
    v_cvt_pk_bf16_f32 v88, v88, v89
    v_cvt_pk_bf16_f32 v89, v90, v91
    ds_pk_add_bf16 v7, v88
    ds_pk_add_bf16 v7, v89 offset:4
    s_mov_b64 exec, vcc
    s_branch L2_d26
L2_xo27:
    v_cmp_lt_u32 vcc, 20, v99
    s_mov_b32 s43, 1
    s_cbranch_vccz L2_xp27
    v_cmp_lt_u32 vcc, 32, v99
    v_cmp_lt_u32 s[58:59], 31, v88
    s_mov_b32 s43, 2
    s_or_b64 vcc, vcc, s[58:59]
    s_cbranch_scc0 L2_xp27
    s_mov_b32 s37, 0x10000
    s_branch L2_xp27
L2_c28:
    s_mov_b64 exec, s[82:83]
    s_nop 1
    v_mfma_f32_4x4x4_16b_bf16 v[88:91], v[12:13], v[84:85], 0
    s_nop 1
    v_mfma_f32_4x4x4_16b_bf16 v[88:91], v[10:11], v[86:87], v[88:91]
    s_nop 4
    v_cvt_pk_bf16_f32 v88, v88, v89
    v_cvt_pk_bf16_f32 v89, v90, v91
    ds_pk_add_bf16 v7, v88
    ds_pk_add_bf16 v7, v89 offset:4
    s_mov_b64 exec, vcc
    s_branch L2_d28
L2_c29:
    s_mov_b64 exec, s[82:83]
    s_nop 1
    v_mfma_f32_4x4x4_16b_bf16 v[88:91], v[12:13], v[84:85], 0
    s_nop 1
    v_mfma_f32_4x4x4_16b_bf16 v[88:91], v[10:11], v[86:87], v[88:91]
    s_nop 4
    v_cvt_pk_bf16_f32 v88, v88, v89
    v_cvt_pk_bf16_f32 v89, v90, v91
    ds_pk_add_bf16 v7, v88
    ds_pk_add_bf16 v7, v89 offset:4
    s_mov_b64 exec, vcc
    s_branch L2_d29
L2_c30:
    s_mov_b64 exec, s[82:83]
    s_nop 1
    v_mfma_f32_4x4x4_16b_bf16 v[88:91], v[12:13], v[84:85], 0
    s_nop 1
    v_mfma_f32_4x4x4_16b_bf16 v[88:91], v[10:11], v[86:87], v[88:91]
    s_nop 4
    v_cvt_pk_bf16_f32 v88, v88, v89
    v_cvt_pk_bf16_f32 v89, v90, v91
    ds_pk_add_bf16 v7, v88
    ds_pk_add_bf16 v7, v89 offset:4
    s_mov_b64 exec, vcc
    s_branch L2_d30
L2_c31:
    s_mov_b64 exec, s[82:83]
    s_nop 1
    v_mfma_f32_4x4x4_16b_bf16 v[88:91], v[12:13], v[84:85], 0
    s_nop 1
    v_mfma_f32_4x4x4_16b_bf16 v[88:91], v[10:11], v[86:87], v[88:91]
    s_nop 4
    v_cvt_pk_bf16_f32 v88, v88, v89
    v_cvt_pk_bf16_f32 v89, v90, v91
    ds_pk_add_bf16 v7, v88
    ds_pk_add_bf16 v7, v89 offset:4
    s_mov_b64 exec, vcc
    s_branch L2_d31
L2_c32:
    s_mov_b64 exec, s[82:83]
    s_nop 1
    v_mfma_f32_4x4x4_16b_bf16 v[88:91], v[12:13], v[84:85], 0
    s_nop 1
    v_mfma_f32_4x4x4_16b_bf16 v[88:91], v[10:11], v[86:87], v[88:91]
    s_nop 4
    v_cvt_pk_bf16_f32 v88, v88, v89
    v_cvt_pk_bf16_f32 v89, v90, v91
    ds_pk_add_bf16 v7, v88
    ds_pk_add_bf16 v7, v89 offset:4
    s_mov_b64 exec, vcc
    s_branch L2_d32
L2_c33:
    s_mov_b64 exec, s[82:83]
    s_nop 1
    v_mfma_f32_4x4x4_16b_bf16 v[88:91], v[12:13], v[84:85], 0
    s_nop 1
    v_mfma_f32_4x4x4_16b_bf16 v[88:91], v[10:11], v[86:87], v[88:91]
    s_nop 4
    v_cvt_pk_bf16_f32 v88, v88, v89
    v_cvt_pk_bf16_f32 v89, v90, v91
    ds_pk_add_bf16 v7, v88
    ds_pk_add_bf16 v7, v89 offset:4
    s_mov_b64 exec, vcc
    s_branch L2_d33
L2_c34:
    s_mov_b64 exec, s[82:83]
    s_nop 1
    v_mfma_f32_4x4x4_16b_bf16 v[88:91], v[12:13], v[84:85], 0
    s_nop 1
    v_mfma_f32_4x4x4_16b_bf16 v[88:91], v[10:11], v[86:87], v[88:91]
    s_nop 4
    v_cvt_pk_bf16_f32 v88, v88, v89
    v_cvt_pk_bf16_f32 v89, v90, v91
    ds_pk_add_bf16 v7, v88
    ds_pk_add_bf16 v7, v89 offset:4
    s_mov_b64 exec, vcc
    s_branch L2_d34
L2_c35:
    s_mov_b64 exec, s[82:83]
    s_nop 1
    v_mfma_f32_4x4x4_16b_bf16 v[88:91], v[12:13], v[84:85], 0
    s_nop 1
    v_mfma_f32_4x4x4_16b_bf16 v[88:91], v[10:11], v[86:87], v[88:91]
    s_nop 4
    v_cvt_pk_bf16_f32 v88, v88, v89
    v_cvt_pk_bf16_f32 v89, v90, v91
    ds_pk_add_bf16 v7, v88
    ds_pk_add_bf16 v7, v89 offset:4
    s_mov_b64 exec, vcc
    s_branch L2_d35
L2_xa36:
    s_cmp_eq_u32 s43, 1
    s_cbranch_scc1 L2_xc36
    v_lshlrev_b32 v89, 0, v96
    v_add_u32 v90, 140, v97
    v_bitop3_b32 v90, v89, v45, v90 bitop3:0x6a
    ds_write_b32 v98, v90 offset:28
    v_lshlrev_b32 v89, 4, v96
    v_add_u32 v90, 120, v97
    v_bitop3_b32 v90, v89, v45, v90 bitop3:0x6a
    ds_write_b32 v98, v90 offset:24
    v_lshlrev_b32 v89, 8, v96
    v_add_u32 v90, 100, v97
    v_bitop3_b32 v90, v89, v45, v90 bitop3:0x6a
    ds_write_b32 v98, v90 offset:20
L2_xc36:
    v_lshlrev_b32 v89, 12, v96
    v_add_u32 v90, 80, v97
    v_bitop3_b32 v90, v89, v45, v90 bitop3:0x6a
    ds_write_b32 v98, v90 offset:16
    s_branch L2_xb36
L2_xe36:
    v_cmp_lt_u32 vcc, 32, v99
    v_cmp_lt_u32 s[58:59], 31, v88
    v_lshrrev_b32 v89, 16, v96
    v_add_u32 v97, 80, v97
    s_or_b64 vcc, vcc, s[58:59]
    s_cbranch_scc1 L2_xs36
    v_lshlrev_b32 v89, v1, v89
    v_and_b32 v89, v45, v89
    v_cmp_ne_u32 vcc, 0, v89
    v_xor_b32 v90, v97, v89
    s_add_u32 s3, s37, s38
    v_mbcnt_lo_u32_b32 v98, vcc_lo, 0
    v_mbcnt_hi_u32_b32 v98, vcc_hi, v98
    s_bcnt1_i32_b64 s41, vcc
    v_lshl_add_u32 v98, v98, 2, s3
    s_mov_b64 exec, vcc
    ds_write_b32 v98, v90
    s_mov_b64 exec, -1
    s_lshl2_add_u32 s37, s41, s37
    s_branch L2_xr36
L2_xf36:
    s_waitcnt lgkmcnt(0)
    s_cmp_gt_u32 s37, 1024
    s_cbranch_scc1 L2_xs36
    v_mov_b32 v43, -1
    s_cmp_ge_u32 s37, 512
    s_cbranch_scc1 L2_xg36
    v_mov_b32 v42, -1
    s_cmp_ge_u32 s37, 256
    s_cbranch_scc1 L2_xg36
    v_mov_b32 v41, -1
    s_branch L2_xg36
L2_xs36:
    s_waitcnt lgkmcnt(0)
    v_mov_b32 v40, -1
    v_mov_b32 v41, -1
    v_mov_b32 v42, -1
    v_mov_b32 v43, -1
    s_add_u32 s3, s42, 2
    s_bitset1_b32 s36, s3
    s_branch L2_xg36
L2_c37:
    s_mov_b64 exec, s[82:83]
    s_nop 1
    v_mfma_f32_4x4x4_16b_bf16 v[88:91], v[12:13], v[84:85], 0
    s_nop 1
    v_mfma_f32_4x4x4_16b_bf16 v[88:91], v[10:11], v[86:87], v[88:91]
    s_nop 4
    v_cvt_pk_bf16_f32 v88, v88, v89
    v_cvt_pk_bf16_f32 v89, v90, v91
    ds_pk_add_bf16 v7, v88
    ds_pk_add_bf16 v7, v89 offset:4
    s_mov_b64 exec, vcc
    s_branch L2_d37
L2_c38:
    s_mov_b64 exec, s[82:83]
    s_nop 1
    v_mfma_f32_4x4x4_16b_bf16 v[88:91], v[12:13], v[84:85], 0
    s_nop 1
    v_mfma_f32_4x4x4_16b_bf16 v[88:91], v[10:11], v[86:87], v[88:91]
    s_nop 4
    v_cvt_pk_bf16_f32 v88, v88, v89
    v_cvt_pk_bf16_f32 v89, v90, v91
    ds_pk_add_bf16 v7, v88
    ds_pk_add_bf16 v7, v89 offset:4
    s_mov_b64 exec, vcc
    s_branch L2_d38
L2_c39:
    s_mov_b64 exec, s[82:83]
    s_nop 1
    v_mfma_f32_4x4x4_16b_bf16 v[88:91], v[12:13], v[84:85], 0
    s_nop 1
    v_mfma_f32_4x4x4_16b_bf16 v[88:91], v[10:11], v[86:87], v[88:91]
    s_nop 4
    v_cvt_pk_bf16_f32 v88, v88, v89
    v_cvt_pk_bf16_f32 v89, v90, v91
    ds_pk_add_bf16 v7, v88
    ds_pk_add_bf16 v7, v89 offset:4
    s_mov_b64 exec, vcc
    s_branch L2_d39
L2_c40:
    s_mov_b64 exec, s[82:83]
    s_nop 1
    v_mfma_f32_4x4x4_16b_bf16 v[88:91], v[12:13], v[84:85], 0
    s_nop 1
    v_mfma_f32_4x4x4_16b_bf16 v[88:91], v[10:11], v[86:87], v[88:91]
    s_nop 4
    v_cvt_pk_bf16_f32 v88, v88, v89
    v_cvt_pk_bf16_f32 v89, v90, v91
    ds_pk_add_bf16 v7, v88
    ds_pk_add_bf16 v7, v89 offset:4
    s_mov_b64 exec, vcc
    s_branch L2_d40
L2_c41:
    s_mov_b64 exec, s[82:83]
    s_nop 1
    v_mfma_f32_4x4x4_16b_bf16 v[88:91], v[12:13], v[84:85], 0
    s_nop 1
    v_mfma_f32_4x4x4_16b_bf16 v[88:91], v[10:11], v[86:87], v[88:91]
    s_nop 4
    v_cvt_pk_bf16_f32 v88, v88, v89
    v_cvt_pk_bf16_f32 v89, v90, v91
    ds_pk_add_bf16 v7, v88
    ds_pk_add_bf16 v7, v89 offset:4
    s_mov_b64 exec, vcc
    s_branch L2_d41
L2_c42:
    s_mov_b64 exec, s[82:83]
    s_nop 1
    v_mfma_f32_4x4x4_16b_bf16 v[88:91], v[12:13], v[84:85], 0
    s_nop 1
    v_mfma_f32_4x4x4_16b_bf16 v[88:91], v[10:11], v[86:87], v[88:91]
    s_nop 4
    v_cvt_pk_bf16_f32 v88, v88, v89
    v_cvt_pk_bf16_f32 v89, v90, v91
    ds_pk_add_bf16 v7, v88
    ds_pk_add_bf16 v7, v89 offset:4
    s_mov_b64 exec, vcc
    s_branch L2_d42
L2_c43:
    s_mov_b64 exec, s[82:83]
    s_nop 1
    v_mfma_f32_4x4x4_16b_bf16 v[88:91], v[12:13], v[84:85], 0
    s_nop 1
    v_mfma_f32_4x4x4_16b_bf16 v[88:91], v[10:11], v[86:87], v[88:91]
    s_nop 4
    v_cvt_pk_bf16_f32 v88, v88, v89
    v_cvt_pk_bf16_f32 v89, v90, v91
    ds_pk_add_bf16 v7, v88
    ds_pk_add_bf16 v7, v89 offset:4
    s_mov_b64 exec, vcc
    s_branch L2_d43
L2_c44:
    s_mov_b64 exec, s[82:83]
    s_nop 1
    v_mfma_f32_4x4x4_16b_bf16 v[88:91], v[12:13], v[84:85], 0
    s_nop 1
    v_mfma_f32_4x4x4_16b_bf16 v[88:91], v[10:11], v[86:87], v[88:91]
    s_nop 4
    v_cvt_pk_bf16_f32 v88, v88, v89
    v_cvt_pk_bf16_f32 v89, v90, v91
    ds_pk_add_bf16 v7, v88
    ds_pk_add_bf16 v7, v89 offset:4
    s_mov_b64 exec, vcc
    s_branch L2_d44
L2_xo45:
    v_cmp_lt_u32 vcc, 20, v99
    s_mov_b32 s43, 1
    s_cbranch_vccz L2_xp45
    v_cmp_lt_u32 vcc, 32, v99
    v_cmp_lt_u32 s[58:59], 31, v88
    s_mov_b32 s43, 2
    s_or_b64 vcc, vcc, s[58:59]
    s_cbranch_scc0 L2_xp45
    s_mov_b32 s37, 0x10000
    s_branch L2_xp45
L2_c46:
    s_mov_b64 exec, s[82:83]
    s_nop 1
    v_mfma_f32_4x4x4_16b_bf16 v[88:91], v[12:13], v[84:85], 0
    s_nop 1
    v_mfma_f32_4x4x4_16b_bf16 v[88:91], v[10:11], v[86:87], v[88:91]
    s_nop 4
    v_cvt_pk_bf16_f32 v88, v88, v89
    v_cvt_pk_bf16_f32 v89, v90, v91
    ds_pk_add_bf16 v7, v88
    ds_pk_add_bf16 v7, v89 offset:4
    s_mov_b64 exec, vcc
    s_branch L2_d46
L2_c47:
    s_mov_b64 exec, s[82:83]
    s_nop 1
    v_mfma_f32_4x4x4_16b_bf16 v[88:91], v[12:13], v[84:85], 0
    s_nop 1
    v_mfma_f32_4x4x4_16b_bf16 v[88:91], v[10:11], v[86:87], v[88:91]
    s_nop 4
    v_cvt_pk_bf16_f32 v88, v88, v89
    v_cvt_pk_bf16_f32 v89, v90, v91
    ds_pk_add_bf16 v7, v88
    ds_pk_add_bf16 v7, v89 offset:4
    s_mov_b64 exec, vcc
    s_branch L2_d47
L2_c48:
    s_mov_b64 exec, s[82:83]
    s_nop 1
    v_mfma_f32_4x4x4_16b_bf16 v[88:91], v[12:13], v[84:85], 0
    s_nop 1
    v_mfma_f32_4x4x4_16b_bf16 v[88:91], v[10:11], v[86:87], v[88:91]
    s_nop 4
    v_cvt_pk_bf16_f32 v88, v88, v89
    v_cvt_pk_bf16_f32 v89, v90, v91
    ds_pk_add_bf16 v7, v88
    ds_pk_add_bf16 v7, v89 offset:4
    s_mov_b64 exec, vcc
    s_branch L2_d48
L2_c49:
    s_mov_b64 exec, s[82:83]
    s_nop 1
    v_mfma_f32_4x4x4_16b_bf16 v[88:91], v[12:13], v[84:85], 0
    s_nop 1
    v_mfma_f32_4x4x4_16b_bf16 v[88:91], v[10:11], v[86:87], v[88:91]
    s_nop 4
    v_cvt_pk_bf16_f32 v88, v88, v89
    v_cvt_pk_bf16_f32 v89, v90, v91
    ds_pk_add_bf16 v7, v88
    ds_pk_add_bf16 v7, v89 offset:4
    s_mov_b64 exec, vcc
    s_branch L2_d49
L2_c50:
    s_mov_b64 exec, s[82:83]
    s_nop 1
    v_mfma_f32_4x4x4_16b_bf16 v[88:91], v[12:13], v[84:85], 0
    s_nop 1
    v_mfma_f32_4x4x4_16b_bf16 v[88:91], v[10:11], v[86:87], v[88:91]
    s_nop 4
    v_cvt_pk_bf16_f32 v88, v88, v89
    v_cvt_pk_bf16_f32 v89, v90, v91
    ds_pk_add_bf16 v7, v88
    ds_pk_add_bf16 v7, v89 offset:4
    s_mov_b64 exec, vcc
    s_branch L2_d50
L2_c51:
    s_mov_b64 exec, s[82:83]
    s_nop 1
    v_mfma_f32_4x4x4_16b_bf16 v[88:91], v[12:13], v[84:85], 0
    s_nop 1
    v_mfma_f32_4x4x4_16b_bf16 v[88:91], v[10:11], v[86:87], v[88:91]
    s_nop 4
    v_cvt_pk_bf16_f32 v88, v88, v89
    v_cvt_pk_bf16_f32 v89, v90, v91
    ds_pk_add_bf16 v7, v88
    ds_pk_add_bf16 v7, v89 offset:4
    s_mov_b64 exec, vcc
    s_branch L2_d51
L2_c52:
    s_mov_b64 exec, s[82:83]
    s_nop 1
    v_mfma_f32_4x4x4_16b_bf16 v[88:91], v[12:13], v[84:85], 0
    s_nop 1
    v_mfma_f32_4x4x4_16b_bf16 v[88:91], v[10:11], v[86:87], v[88:91]
    s_nop 4
    v_cvt_pk_bf16_f32 v88, v88, v89
    v_cvt_pk_bf16_f32 v89, v90, v91
    ds_pk_add_bf16 v7, v88
    ds_pk_add_bf16 v7, v89 offset:4
    s_mov_b64 exec, vcc
    s_branch L2_d52
L2_c53:
    s_mov_b64 exec, s[82:83]
    s_nop 1
    v_mfma_f32_4x4x4_16b_bf16 v[88:91], v[12:13], v[84:85], 0
    s_nop 1
    v_mfma_f32_4x4x4_16b_bf16 v[88:91], v[10:11], v[86:87], v[88:91]
    s_nop 4
    v_cvt_pk_bf16_f32 v88, v88, v89
    v_cvt_pk_bf16_f32 v89, v90, v91
    ds_pk_add_bf16 v7, v88
    ds_pk_add_bf16 v7, v89 offset:4
    s_mov_b64 exec, vcc
    s_branch L2_d53
L2_xa54:
    s_cmp_eq_u32 s43, 1
    s_cbranch_scc1 L2_xc54
    v_lshlrev_b32 v89, 0, v96
    v_add_u32 v90, 140, v97
    v_bitop3_b32 v90, v89, v45, v90 bitop3:0x6a
    ds_write_b32 v98, v90 offset:28
    v_lshlrev_b32 v89, 4, v96
    v_add_u32 v90, 120, v97
    v_bitop3_b32 v90, v89, v45, v90 bitop3:0x6a
    ds_write_b32 v98, v90 offset:24
    v_lshlrev_b32 v89, 8, v96
    v_add_u32 v90, 100, v97
    v_bitop3_b32 v90, v89, v45, v90 bitop3:0x6a
    ds_write_b32 v98, v90 offset:20
L2_xc54:
    v_lshlrev_b32 v89, 12, v96
    v_add_u32 v90, 80, v97
    v_bitop3_b32 v90, v89, v45, v90 bitop3:0x6a
    ds_write_b32 v98, v90 offset:16
    s_branch L2_xb54
L2_xe54:
    v_cmp_lt_u32 vcc, 32, v99
    v_cmp_lt_u32 s[58:59], 31, v88
    v_lshrrev_b32 v89, 16, v96
    v_add_u32 v97, 80, v97
    s_or_b64 vcc, vcc, s[58:59]
    s_cbranch_scc1 L2_xs54
    v_lshlrev_b32 v89, v1, v89
    v_and_b32 v89, v45, v89
    v_cmp_ne_u32 vcc, 0, v89
    v_xor_b32 v90, v97, v89
    s_add_u32 s3, s37, s38
    v_mbcnt_lo_u32_b32 v98, vcc_lo, 0
    v_mbcnt_hi_u32_b32 v98, vcc_hi, v98
    s_bcnt1_i32_b64 s41, vcc
    v_lshl_add_u32 v98, v98, 2, s3
    s_mov_b64 exec, vcc
    ds_write_b32 v98, v90
    s_mov_b64 exec, -1
    s_lshl2_add_u32 s37, s41, s37
    s_branch L2_xr54
L2_xf54:
    s_waitcnt lgkmcnt(0)
    s_cmp_gt_u32 s37, 1024
    s_cbranch_scc1 L2_xs54
    v_mov_b32 v43, -1
    s_cmp_ge_u32 s37, 512
    s_cbranch_scc1 L2_xg54
    v_mov_b32 v42, -1
    s_cmp_ge_u32 s37, 256
    s_cbranch_scc1 L2_xg54
    v_mov_b32 v41, -1
    s_branch L2_xg54
L2_xs54:
    s_waitcnt lgkmcnt(0)
    v_mov_b32 v40, -1
    v_mov_b32 v41, -1
    v_mov_b32 v42, -1
    v_mov_b32 v43, -1
    s_add_u32 s3, s42, 2
    s_bitset1_b32 s36, s3
    s_branch L2_xg54
L2_c55:
    s_mov_b64 exec, s[82:83]
    s_nop 1
    v_mfma_f32_4x4x4_16b_bf16 v[88:91], v[12:13], v[84:85], 0
    s_nop 1
    v_mfma_f32_4x4x4_16b_bf16 v[88:91], v[10:11], v[86:87], v[88:91]
    s_nop 4
    v_cvt_pk_bf16_f32 v88, v88, v89
    v_cvt_pk_bf16_f32 v89, v90, v91
    ds_pk_add_bf16 v7, v88
    ds_pk_add_bf16 v7, v89 offset:4
    s_mov_b64 exec, vcc
    s_branch L2_d55
L2_c56:
    s_mov_b64 exec, s[82:83]
    s_nop 1
    v_mfma_f32_4x4x4_16b_bf16 v[88:91], v[12:13], v[84:85], 0
    s_nop 1
    v_mfma_f32_4x4x4_16b_bf16 v[88:91], v[10:11], v[86:87], v[88:91]
    s_nop 4
    v_cvt_pk_bf16_f32 v88, v88, v89
    v_cvt_pk_bf16_f32 v89, v90, v91
    ds_pk_add_bf16 v7, v88
    ds_pk_add_bf16 v7, v89 offset:4
    s_mov_b64 exec, vcc
    s_branch L2_d56
L2_c57:
    s_mov_b64 exec, s[82:83]
    s_nop 1
    v_mfma_f32_4x4x4_16b_bf16 v[88:91], v[12:13], v[84:85], 0
    s_nop 1
    v_mfma_f32_4x4x4_16b_bf16 v[88:91], v[10:11], v[86:87], v[88:91]
    s_nop 4
    v_cvt_pk_bf16_f32 v88, v88, v89
    v_cvt_pk_bf16_f32 v89, v90, v91
    ds_pk_add_bf16 v7, v88
    ds_pk_add_bf16 v7, v89 offset:4
    s_mov_b64 exec, vcc
    s_branch L2_d57
L2_c58:
    s_mov_b64 exec, s[82:83]
    s_nop 1
    v_mfma_f32_4x4x4_16b_bf16 v[88:91], v[12:13], v[84:85], 0
    s_nop 1
    v_mfma_f32_4x4x4_16b_bf16 v[88:91], v[10:11], v[86:87], v[88:91]
    s_nop 4
    v_cvt_pk_bf16_f32 v88, v88, v89
    v_cvt_pk_bf16_f32 v89, v90, v91
    ds_pk_add_bf16 v7, v88
    ds_pk_add_bf16 v7, v89 offset:4
    s_mov_b64 exec, vcc
    s_branch L2_d58
L2_c59:
    s_mov_b64 exec, s[82:83]
    s_nop 1
    v_mfma_f32_4x4x4_16b_bf16 v[88:91], v[12:13], v[84:85], 0
    s_nop 1
    v_mfma_f32_4x4x4_16b_bf16 v[88:91], v[10:11], v[86:87], v[88:91]
    s_nop 4
    v_cvt_pk_bf16_f32 v88, v88, v89
    v_cvt_pk_bf16_f32 v89, v90, v91
    ds_pk_add_bf16 v7, v88
    ds_pk_add_bf16 v7, v89 offset:4
    s_mov_b64 exec, vcc
    s_branch L2_d59
L2_c60:
    s_mov_b64 exec, s[82:83]
    s_nop 1
    v_mfma_f32_4x4x4_16b_bf16 v[88:91], v[12:13], v[84:85], 0
    s_nop 1
    v_mfma_f32_4x4x4_16b_bf16 v[88:91], v[10:11], v[86:87], v[88:91]
    s_nop 4
    v_cvt_pk_bf16_f32 v88, v88, v89
    v_cvt_pk_bf16_f32 v89, v90, v91
    ds_pk_add_bf16 v7, v88
    ds_pk_add_bf16 v7, v89 offset:4
    s_mov_b64 exec, vcc
    s_branch L2_d60
L2_c61:
    s_mov_b64 exec, s[82:83]
    s_nop 1
    v_mfma_f32_4x4x4_16b_bf16 v[88:91], v[12:13], v[84:85], 0
    s_nop 1
    v_mfma_f32_4x4x4_16b_bf16 v[88:91], v[10:11], v[86:87], v[88:91]
    s_nop 4
    v_cvt_pk_bf16_f32 v88, v88, v89
    v_cvt_pk_bf16_f32 v89, v90, v91
    ds_pk_add_bf16 v7, v88
    ds_pk_add_bf16 v7, v89 offset:4
    s_mov_b64 exec, vcc
    s_branch L2_d61
L2_c62:
    s_mov_b64 exec, s[82:83]
    s_nop 1
    v_mfma_f32_4x4x4_16b_bf16 v[88:91], v[12:13], v[84:85], 0
    s_nop 1
    v_mfma_f32_4x4x4_16b_bf16 v[88:91], v[10:11], v[86:87], v[88:91]
    s_nop 4
    v_cvt_pk_bf16_f32 v88, v88, v89
    v_cvt_pk_bf16_f32 v89, v90, v91
    ds_pk_add_bf16 v7, v88
    ds_pk_add_bf16 v7, v89 offset:4
    s_mov_b64 exec, vcc
    s_branch L2_d62
L2_xo63:
    v_cmp_lt_u32 vcc, 20, v99
    s_mov_b32 s43, 1
    s_cbranch_vccz L2_xp63
    v_cmp_lt_u32 vcc, 32, v99
    v_cmp_lt_u32 s[58:59], 31, v88
    s_mov_b32 s43, 2
    s_or_b64 vcc, vcc, s[58:59]
    s_cbranch_scc0 L2_xp63
    s_mov_b32 s37, 0x10000
    s_branch L2_xp63
L2_c64:
    s_mov_b64 exec, s[82:83]
    s_nop 1
    v_mfma_f32_4x4x4_16b_bf16 v[88:91], v[12:13], v[84:85], 0
    s_nop 1
    v_mfma_f32_4x4x4_16b_bf16 v[88:91], v[10:11], v[86:87], v[88:91]
    s_nop 4
    v_cvt_pk_bf16_f32 v88, v88, v89
    v_cvt_pk_bf16_f32 v89, v90, v91
    ds_pk_add_bf16 v7, v88
    ds_pk_add_bf16 v7, v89 offset:4
    s_mov_b64 exec, vcc
    s_branch L2_d64
L2_c65:
    s_mov_b64 exec, s[82:83]
    s_nop 1
    v_mfma_f32_4x4x4_16b_bf16 v[88:91], v[12:13], v[84:85], 0
    s_nop 1
    v_mfma_f32_4x4x4_16b_bf16 v[88:91], v[10:11], v[86:87], v[88:91]
    s_nop 4
    v_cvt_pk_bf16_f32 v88, v88, v89
    v_cvt_pk_bf16_f32 v89, v90, v91
    ds_pk_add_bf16 v7, v88
    ds_pk_add_bf16 v7, v89 offset:4
    s_mov_b64 exec, vcc
    s_branch L2_d65
L2_c66:
    s_mov_b64 exec, s[82:83]
    s_nop 1
    v_mfma_f32_4x4x4_16b_bf16 v[88:91], v[12:13], v[84:85], 0
    s_nop 1
    v_mfma_f32_4x4x4_16b_bf16 v[88:91], v[10:11], v[86:87], v[88:91]
    s_nop 4
    v_cvt_pk_bf16_f32 v88, v88, v89
    v_cvt_pk_bf16_f32 v89, v90, v91
    ds_pk_add_bf16 v7, v88
    ds_pk_add_bf16 v7, v89 offset:4
    s_mov_b64 exec, vcc
    s_branch L2_d66
L2_c67:
    s_mov_b64 exec, s[82:83]
    s_nop 1
    v_mfma_f32_4x4x4_16b_bf16 v[88:91], v[12:13], v[84:85], 0
    s_nop 1
    v_mfma_f32_4x4x4_16b_bf16 v[88:91], v[10:11], v[86:87], v[88:91]
    s_nop 4
    v_cvt_pk_bf16_f32 v88, v88, v89
    v_cvt_pk_bf16_f32 v89, v90, v91
    ds_pk_add_bf16 v7, v88
    ds_pk_add_bf16 v7, v89 offset:4
    s_mov_b64 exec, vcc
    s_branch L2_d67
L2_c68:
    s_mov_b64 exec, s[82:83]
    s_nop 1
    v_mfma_f32_4x4x4_16b_bf16 v[88:91], v[12:13], v[84:85], 0
    s_nop 1
    v_mfma_f32_4x4x4_16b_bf16 v[88:91], v[10:11], v[86:87], v[88:91]
    s_nop 4
    v_cvt_pk_bf16_f32 v88, v88, v89
    v_cvt_pk_bf16_f32 v89, v90, v91
    ds_pk_add_bf16 v7, v88
    ds_pk_add_bf16 v7, v89 offset:4
    s_mov_b64 exec, vcc
    s_branch L2_d68
L2_c69:
    s_mov_b64 exec, s[82:83]
    s_nop 1
    v_mfma_f32_4x4x4_16b_bf16 v[88:91], v[12:13], v[84:85], 0
    s_nop 1
    v_mfma_f32_4x4x4_16b_bf16 v[88:91], v[10:11], v[86:87], v[88:91]
    s_nop 4
    v_cvt_pk_bf16_f32 v88, v88, v89
    v_cvt_pk_bf16_f32 v89, v90, v91
    ds_pk_add_bf16 v7, v88
    ds_pk_add_bf16 v7, v89 offset:4
    s_mov_b64 exec, vcc
    s_branch L2_d69
L2_c70:
    s_mov_b64 exec, s[82:83]
    s_nop 1
    v_mfma_f32_4x4x4_16b_bf16 v[88:91], v[12:13], v[84:85], 0
    s_nop 1
    v_mfma_f32_4x4x4_16b_bf16 v[88:91], v[10:11], v[86:87], v[88:91]
    s_nop 4
    v_cvt_pk_bf16_f32 v88, v88, v89
    v_cvt_pk_bf16_f32 v89, v90, v91
    ds_pk_add_bf16 v7, v88
    ds_pk_add_bf16 v7, v89 offset:4
    s_mov_b64 exec, vcc
    s_branch L2_d70
L2_c71:
    s_mov_b64 exec, s[82:83]
    s_nop 1
    v_mfma_f32_4x4x4_16b_bf16 v[88:91], v[12:13], v[84:85], 0
    s_nop 1
    v_mfma_f32_4x4x4_16b_bf16 v[88:91], v[10:11], v[86:87], v[88:91]
    s_nop 4
    v_cvt_pk_bf16_f32 v88, v88, v89
    v_cvt_pk_bf16_f32 v89, v90, v91
    ds_pk_add_bf16 v7, v88
    ds_pk_add_bf16 v7, v89 offset:4
    s_mov_b64 exec, vcc
    s_branch L2_d71
L2_xa72:
    s_cmp_eq_u32 s43, 1
    s_cbranch_scc1 L2_xc72
    v_lshlrev_b32 v89, 0, v96
    v_add_u32 v90, 140, v97
    v_bitop3_b32 v90, v89, v45, v90 bitop3:0x6a
    ds_write_b32 v98, v90 offset:28
    v_lshlrev_b32 v89, 4, v96
    v_add_u32 v90, 120, v97
    v_bitop3_b32 v90, v89, v45, v90 bitop3:0x6a
    ds_write_b32 v98, v90 offset:24
    v_lshlrev_b32 v89, 8, v96
    v_add_u32 v90, 100, v97
    v_bitop3_b32 v90, v89, v45, v90 bitop3:0x6a
    ds_write_b32 v98, v90 offset:20
L2_xc72:
    v_lshlrev_b32 v89, 12, v96
    v_add_u32 v90, 80, v97
    v_bitop3_b32 v90, v89, v45, v90 bitop3:0x6a
    ds_write_b32 v98, v90 offset:16
    s_branch L2_xb72
L2_xe72:
    v_cmp_lt_u32 vcc, 32, v99
    v_cmp_lt_u32 s[58:59], 31, v88
    v_lshrrev_b32 v89, 16, v96
    v_add_u32 v97, 80, v97
    s_or_b64 vcc, vcc, s[58:59]
    s_cbranch_scc1 L2_xs72
    v_lshlrev_b32 v89, v1, v89
    v_and_b32 v89, v45, v89
    v_cmp_ne_u32 vcc, 0, v89
    v_xor_b32 v90, v97, v89
    s_add_u32 s3, s37, s38
    v_mbcnt_lo_u32_b32 v98, vcc_lo, 0
    v_mbcnt_hi_u32_b32 v98, vcc_hi, v98
    s_bcnt1_i32_b64 s41, vcc
    v_lshl_add_u32 v98, v98, 2, s3
    s_mov_b64 exec, vcc
    ds_write_b32 v98, v90
    s_mov_b64 exec, -1
    s_lshl2_add_u32 s37, s41, s37
    s_branch L2_xr72
L2_xf72:
    s_waitcnt lgkmcnt(0)
    s_cmp_gt_u32 s37, 1024
    s_cbranch_scc1 L2_xs72
    v_mov_b32 v43, -1
    s_cmp_ge_u32 s37, 512
    s_cbranch_scc1 L2_xg72
    v_mov_b32 v42, -1
    s_cmp_ge_u32 s37, 256
    s_cbranch_scc1 L2_xg72
    v_mov_b32 v41, -1
    s_branch L2_xg72
L2_xs72:
    s_waitcnt lgkmcnt(0)
    v_mov_b32 v40, -1
    v_mov_b32 v41, -1
    v_mov_b32 v42, -1
    v_mov_b32 v43, -1
    s_add_u32 s3, s42, 2
    s_bitset1_b32 s36, s3
    s_branch L2_xg72
L2_c73:
    s_mov_b64 exec, s[82:83]
    s_nop 1
    v_mfma_f32_4x4x4_16b_bf16 v[88:91], v[12:13], v[84:85], 0
    s_nop 1
    v_mfma_f32_4x4x4_16b_bf16 v[88:91], v[10:11], v[86:87], v[88:91]
    s_nop 4
    v_cvt_pk_bf16_f32 v88, v88, v89
    v_cvt_pk_bf16_f32 v89, v90, v91
    ds_pk_add_bf16 v7, v88
    ds_pk_add_bf16 v7, v89 offset:4
    s_mov_b64 exec, vcc
    s_branch L2_d73
L2_c74:
    s_mov_b64 exec, s[82:83]
    s_nop 1
    v_mfma_f32_4x4x4_16b_bf16 v[88:91], v[12:13], v[84:85], 0
    s_nop 1
    v_mfma_f32_4x4x4_16b_bf16 v[88:91], v[10:11], v[86:87], v[88:91]
    s_nop 4
    v_cvt_pk_bf16_f32 v88, v88, v89
    v_cvt_pk_bf16_f32 v89, v90, v91
    ds_pk_add_bf16 v7, v88
    ds_pk_add_bf16 v7, v89 offset:4
    s_mov_b64 exec, vcc
    s_branch L2_d74
L2_c75:
    s_mov_b64 exec, s[82:83]
    s_nop 1
    v_mfma_f32_4x4x4_16b_bf16 v[88:91], v[12:13], v[84:85], 0
    s_nop 1
    v_mfma_f32_4x4x4_16b_bf16 v[88:91], v[10:11], v[86:87], v[88:91]
    s_nop 4
    v_cvt_pk_bf16_f32 v88, v88, v89
    v_cvt_pk_bf16_f32 v89, v90, v91
    ds_pk_add_bf16 v7, v88
    ds_pk_add_bf16 v7, v89 offset:4
    s_mov_b64 exec, vcc
    s_branch L2_d75
L2_c76:
    s_mov_b64 exec, s[82:83]
    s_nop 1
    v_mfma_f32_4x4x4_16b_bf16 v[88:91], v[12:13], v[84:85], 0
    s_nop 1
    v_mfma_f32_4x4x4_16b_bf16 v[88:91], v[10:11], v[86:87], v[88:91]
    s_nop 4
    v_cvt_pk_bf16_f32 v88, v88, v89
    v_cvt_pk_bf16_f32 v89, v90, v91
    ds_pk_add_bf16 v7, v88
    ds_pk_add_bf16 v7, v89 offset:4
    s_mov_b64 exec, vcc
    s_branch L2_d76
L2_c77:
    s_mov_b64 exec, s[82:83]
    s_nop 1
    v_mfma_f32_4x4x4_16b_bf16 v[88:91], v[12:13], v[84:85], 0
    s_nop 1
    v_mfma_f32_4x4x4_16b_bf16 v[88:91], v[10:11], v[86:87], v[88:91]
    s_nop 4
    v_cvt_pk_bf16_f32 v88, v88, v89
    v_cvt_pk_bf16_f32 v89, v90, v91
    ds_pk_add_bf16 v7, v88
    ds_pk_add_bf16 v7, v89 offset:4
    s_mov_b64 exec, vcc
    s_branch L2_d77
L2_c78:
    s_mov_b64 exec, s[82:83]
    s_nop 1
    v_mfma_f32_4x4x4_16b_bf16 v[88:91], v[12:13], v[84:85], 0
    s_nop 1
    v_mfma_f32_4x4x4_16b_bf16 v[88:91], v[10:11], v[86:87], v[88:91]
    s_nop 4
    v_cvt_pk_bf16_f32 v88, v88, v89
    v_cvt_pk_bf16_f32 v89, v90, v91
    ds_pk_add_bf16 v7, v88
    ds_pk_add_bf16 v7, v89 offset:4
    s_mov_b64 exec, vcc
    s_branch L2_d78
L2_c79:
    s_mov_b64 exec, s[82:83]
    s_nop 1
    v_mfma_f32_4x4x4_16b_bf16 v[88:91], v[12:13], v[84:85], 0
    s_nop 1
    v_mfma_f32_4x4x4_16b_bf16 v[88:91], v[10:11], v[86:87], v[88:91]
    s_nop 4
    v_cvt_pk_bf16_f32 v88, v88, v89
    v_cvt_pk_bf16_f32 v89, v90, v91
    ds_pk_add_bf16 v7, v88
    ds_pk_add_bf16 v7, v89 offset:4
    s_mov_b64 exec, vcc
    s_branch L2_d79
L2_c80:
    s_mov_b64 exec, s[82:83]
    s_nop 1
    v_mfma_f32_4x4x4_16b_bf16 v[88:91], v[12:13], v[84:85], 0
    s_nop 1
    v_mfma_f32_4x4x4_16b_bf16 v[88:91], v[10:11], v[86:87], v[88:91]
    s_nop 4
    v_cvt_pk_bf16_f32 v88, v88, v89
    v_cvt_pk_bf16_f32 v89, v90, v91
    ds_pk_add_bf16 v7, v88
    ds_pk_add_bf16 v7, v89 offset:4
    s_mov_b64 exec, vcc
    s_branch L2_d80
L2_xo81:
    v_cmp_lt_u32 vcc, 20, v99
    s_mov_b32 s43, 1
    s_cbranch_vccz L2_xp81
    v_cmp_lt_u32 vcc, 32, v99
    v_cmp_lt_u32 s[58:59], 31, v88
    s_mov_b32 s43, 2
    s_or_b64 vcc, vcc, s[58:59]
    s_cbranch_scc0 L2_xp81
    s_mov_b32 s37, 0x10000
    s_branch L2_xp81
L2_c82:
    s_mov_b64 exec, s[82:83]
    s_nop 1
    v_mfma_f32_4x4x4_16b_bf16 v[88:91], v[12:13], v[84:85], 0
    s_nop 1
    v_mfma_f32_4x4x4_16b_bf16 v[88:91], v[10:11], v[86:87], v[88:91]
    s_nop 4
    v_cvt_pk_bf16_f32 v88, v88, v89
    v_cvt_pk_bf16_f32 v89, v90, v91
    ds_pk_add_bf16 v7, v88
    ds_pk_add_bf16 v7, v89 offset:4
    s_mov_b64 exec, vcc
    s_branch L2_d82
L2_c83:
    s_mov_b64 exec, s[82:83]
    s_nop 1
    v_mfma_f32_4x4x4_16b_bf16 v[88:91], v[12:13], v[84:85], 0
    s_nop 1
    v_mfma_f32_4x4x4_16b_bf16 v[88:91], v[10:11], v[86:87], v[88:91]
    s_nop 4
    v_cvt_pk_bf16_f32 v88, v88, v89
    v_cvt_pk_bf16_f32 v89, v90, v91
    ds_pk_add_bf16 v7, v88
    ds_pk_add_bf16 v7, v89 offset:4
    s_mov_b64 exec, vcc
    s_branch L2_d83
L2_c84:
    s_mov_b64 exec, s[82:83]
    s_nop 1
    v_mfma_f32_4x4x4_16b_bf16 v[88:91], v[12:13], v[84:85], 0
    s_nop 1
    v_mfma_f32_4x4x4_16b_bf16 v[88:91], v[10:11], v[86:87], v[88:91]
    s_nop 4
    v_cvt_pk_bf16_f32 v88, v88, v89
    v_cvt_pk_bf16_f32 v89, v90, v91
    ds_pk_add_bf16 v7, v88
    ds_pk_add_bf16 v7, v89 offset:4
    s_mov_b64 exec, vcc
    s_branch L2_d84
L2_c85:
    s_mov_b64 exec, s[82:83]
    s_nop 1
    v_mfma_f32_4x4x4_16b_bf16 v[88:91], v[12:13], v[84:85], 0
    s_nop 1
    v_mfma_f32_4x4x4_16b_bf16 v[88:91], v[10:11], v[86:87], v[88:91]
    s_nop 4
    v_cvt_pk_bf16_f32 v88, v88, v89
    v_cvt_pk_bf16_f32 v89, v90, v91
    ds_pk_add_bf16 v7, v88
    ds_pk_add_bf16 v7, v89 offset:4
    s_mov_b64 exec, vcc
    s_branch L2_d85
L2_c86:
    s_mov_b64 exec, s[82:83]
    s_nop 1
    v_mfma_f32_4x4x4_16b_bf16 v[88:91], v[12:13], v[84:85], 0
    s_nop 1
    v_mfma_f32_4x4x4_16b_bf16 v[88:91], v[10:11], v[86:87], v[88:91]
    s_nop 4
    v_cvt_pk_bf16_f32 v88, v88, v89
    v_cvt_pk_bf16_f32 v89, v90, v91
    ds_pk_add_bf16 v7, v88
    ds_pk_add_bf16 v7, v89 offset:4
    s_mov_b64 exec, vcc
    s_branch L2_d86
L2_c87:
    s_mov_b64 exec, s[82:83]
    s_nop 1
    v_mfma_f32_4x4x4_16b_bf16 v[88:91], v[12:13], v[84:85], 0
    s_nop 1
    v_mfma_f32_4x4x4_16b_bf16 v[88:91], v[10:11], v[86:87], v[88:91]
    s_nop 4
    v_cvt_pk_bf16_f32 v88, v88, v89
    v_cvt_pk_bf16_f32 v89, v90, v91
    ds_pk_add_bf16 v7, v88
    ds_pk_add_bf16 v7, v89 offset:4
    s_mov_b64 exec, vcc
    s_branch L2_d87
L2_c88:
    s_mov_b64 exec, s[82:83]
    s_nop 1
    v_mfma_f32_4x4x4_16b_bf16 v[88:91], v[12:13], v[84:85], 0
    s_nop 1
    v_mfma_f32_4x4x4_16b_bf16 v[88:91], v[10:11], v[86:87], v[88:91]
    s_nop 4
    v_cvt_pk_bf16_f32 v88, v88, v89
    v_cvt_pk_bf16_f32 v89, v90, v91
    ds_pk_add_bf16 v7, v88
    ds_pk_add_bf16 v7, v89 offset:4
    s_mov_b64 exec, vcc
    s_branch L2_d88
L2_c89:
    s_mov_b64 exec, s[82:83]
    s_nop 1
    v_mfma_f32_4x4x4_16b_bf16 v[88:91], v[12:13], v[84:85], 0
    s_nop 1
    v_mfma_f32_4x4x4_16b_bf16 v[88:91], v[10:11], v[86:87], v[88:91]
    s_nop 4
    v_cvt_pk_bf16_f32 v88, v88, v89
    v_cvt_pk_bf16_f32 v89, v90, v91
    ds_pk_add_bf16 v7, v88
    ds_pk_add_bf16 v7, v89 offset:4
    s_mov_b64 exec, vcc
    s_branch L2_d89
L2_xa90:
    s_cmp_eq_u32 s43, 1
    s_cbranch_scc1 L2_xc90
    v_lshlrev_b32 v89, 0, v96
    v_add_u32 v90, 140, v97
    v_bitop3_b32 v90, v89, v45, v90 bitop3:0x6a
    ds_write_b32 v98, v90 offset:28
    v_lshlrev_b32 v89, 4, v96
    v_add_u32 v90, 120, v97
    v_bitop3_b32 v90, v89, v45, v90 bitop3:0x6a
    ds_write_b32 v98, v90 offset:24
    v_lshlrev_b32 v89, 8, v96
    v_add_u32 v90, 100, v97
    v_bitop3_b32 v90, v89, v45, v90 bitop3:0x6a
    ds_write_b32 v98, v90 offset:20
L2_xc90:
    v_lshlrev_b32 v89, 12, v96
    v_add_u32 v90, 80, v97
    v_bitop3_b32 v90, v89, v45, v90 bitop3:0x6a
    ds_write_b32 v98, v90 offset:16
    s_branch L2_xb90
L2_xe90:
    v_cmp_lt_u32 vcc, 32, v99
    v_cmp_lt_u32 s[58:59], 31, v88
    v_lshrrev_b32 v89, 16, v96
    v_add_u32 v97, 80, v97
    s_or_b64 vcc, vcc, s[58:59]
    s_cbranch_scc1 L2_xs90
    v_lshlrev_b32 v89, v1, v89
    v_and_b32 v89, v45, v89
    v_cmp_ne_u32 vcc, 0, v89
    v_xor_b32 v90, v97, v89
    s_add_u32 s3, s37, s38
    v_mbcnt_lo_u32_b32 v98, vcc_lo, 0
    v_mbcnt_hi_u32_b32 v98, vcc_hi, v98
    s_bcnt1_i32_b64 s41, vcc
    v_lshl_add_u32 v98, v98, 2, s3
    s_mov_b64 exec, vcc
    ds_write_b32 v98, v90
    s_mov_b64 exec, -1
    s_lshl2_add_u32 s37, s41, s37
    s_branch L2_xr90
L2_xf90:
    s_waitcnt lgkmcnt(0)
    s_cmp_gt_u32 s37, 1024
    s_cbranch_scc1 L2_xs90
    v_mov_b32 v43, -1
    s_cmp_ge_u32 s37, 512
    s_cbranch_scc1 L2_xg90
    v_mov_b32 v42, -1
    s_cmp_ge_u32 s37, 256
    s_cbranch_scc1 L2_xg90
    v_mov_b32 v41, -1
    s_branch L2_xg90
L2_xs90:
    s_waitcnt lgkmcnt(0)
    v_mov_b32 v40, -1
    v_mov_b32 v41, -1
    v_mov_b32 v42, -1
    v_mov_b32 v43, -1
    s_add_u32 s3, s42, 2
    s_bitset1_b32 s36, s3
    s_branch L2_xg90
L2_c91:
    s_mov_b64 exec, s[82:83]
    s_nop 1
    v_mfma_f32_4x4x4_16b_bf16 v[88:91], v[12:13], v[84:85], 0
    s_nop 1
    v_mfma_f32_4x4x4_16b_bf16 v[88:91], v[10:11], v[86:87], v[88:91]
    s_nop 4
    v_cvt_pk_bf16_f32 v88, v88, v89
    v_cvt_pk_bf16_f32 v89, v90, v91
    ds_pk_add_bf16 v7, v88
    ds_pk_add_bf16 v7, v89 offset:4
    s_mov_b64 exec, vcc
    s_branch L2_d91
L2_c92:
    s_mov_b64 exec, s[82:83]
    s_nop 1
    v_mfma_f32_4x4x4_16b_bf16 v[88:91], v[12:13], v[84:85], 0
    s_nop 1
    v_mfma_f32_4x4x4_16b_bf16 v[88:91], v[10:11], v[86:87], v[88:91]
    s_nop 4
    v_cvt_pk_bf16_f32 v88, v88, v89
    v_cvt_pk_bf16_f32 v89, v90, v91
    ds_pk_add_bf16 v7, v88
    ds_pk_add_bf16 v7, v89 offset:4
    s_mov_b64 exec, vcc
    s_branch L2_d92
L2_c93:
    s_mov_b64 exec, s[82:83]
    s_nop 1
    v_mfma_f32_4x4x4_16b_bf16 v[88:91], v[12:13], v[84:85], 0
    s_nop 1
    v_mfma_f32_4x4x4_16b_bf16 v[88:91], v[10:11], v[86:87], v[88:91]
    s_nop 4
    v_cvt_pk_bf16_f32 v88, v88, v89
    v_cvt_pk_bf16_f32 v89, v90, v91
    ds_pk_add_bf16 v7, v88
    ds_pk_add_bf16 v7, v89 offset:4
    s_mov_b64 exec, vcc
    s_branch L2_d93
L2_c94:
    s_mov_b64 exec, s[82:83]
    s_nop 1
    v_mfma_f32_4x4x4_16b_bf16 v[88:91], v[12:13], v[84:85], 0
    s_nop 1
    v_mfma_f32_4x4x4_16b_bf16 v[88:91], v[10:11], v[86:87], v[88:91]
    s_nop 4
    v_cvt_pk_bf16_f32 v88, v88, v89
    v_cvt_pk_bf16_f32 v89, v90, v91
    ds_pk_add_bf16 v7, v88
    ds_pk_add_bf16 v7, v89 offset:4
    s_mov_b64 exec, vcc
    s_branch L2_d94
L2_c95:
    s_mov_b64 exec, s[82:83]
    s_nop 1
    v_mfma_f32_4x4x4_16b_bf16 v[88:91], v[12:13], v[84:85], 0
    s_nop 1
    v_mfma_f32_4x4x4_16b_bf16 v[88:91], v[10:11], v[86:87], v[88:91]
    s_nop 4
    v_cvt_pk_bf16_f32 v88, v88, v89
    v_cvt_pk_bf16_f32 v89, v90, v91
    ds_pk_add_bf16 v7, v88
    ds_pk_add_bf16 v7, v89 offset:4
    s_mov_b64 exec, vcc
    s_branch L2_d95
L2_c96:
    s_mov_b64 exec, s[82:83]
    s_nop 1
    v_mfma_f32_4x4x4_16b_bf16 v[88:91], v[12:13], v[84:85], 0
    s_nop 1
    v_mfma_f32_4x4x4_16b_bf16 v[88:91], v[10:11], v[86:87], v[88:91]
    s_nop 4
    v_cvt_pk_bf16_f32 v88, v88, v89
    v_cvt_pk_bf16_f32 v89, v90, v91
    ds_pk_add_bf16 v7, v88
    ds_pk_add_bf16 v7, v89 offset:4
    s_mov_b64 exec, vcc
    s_branch L2_d96
L2_c97:
    s_mov_b64 exec, s[82:83]
    s_nop 1
    v_mfma_f32_4x4x4_16b_bf16 v[88:91], v[12:13], v[84:85], 0
    s_nop 1
    v_mfma_f32_4x4x4_16b_bf16 v[88:91], v[10:11], v[86:87], v[88:91]
    s_nop 4
    v_cvt_pk_bf16_f32 v88, v88, v89
    v_cvt_pk_bf16_f32 v89, v90, v91
    ds_pk_add_bf16 v7, v88
    ds_pk_add_bf16 v7, v89 offset:4
    s_mov_b64 exec, vcc
    s_branch L2_d97
L2_c98:
    s_mov_b64 exec, s[82:83]
    s_nop 1
    v_mfma_f32_4x4x4_16b_bf16 v[88:91], v[12:13], v[84:85], 0
    s_nop 1
    v_mfma_f32_4x4x4_16b_bf16 v[88:91], v[10:11], v[86:87], v[88:91]
    s_nop 4
    v_cvt_pk_bf16_f32 v88, v88, v89
    v_cvt_pk_bf16_f32 v89, v90, v91
    ds_pk_add_bf16 v7, v88
    ds_pk_add_bf16 v7, v89 offset:4
    s_mov_b64 exec, vcc
    s_branch L2_d98
L2_xo99:
    v_cmp_lt_u32 vcc, 20, v99
    s_mov_b32 s43, 1
    s_cbranch_vccz L2_xp99
    v_cmp_lt_u32 vcc, 32, v99
    v_cmp_lt_u32 s[58:59], 31, v88
    s_mov_b32 s43, 2
    s_or_b64 vcc, vcc, s[58:59]
    s_cbranch_scc0 L2_xp99
    s_mov_b32 s37, 0x10000
    s_branch L2_xp99
L2_c100:
    s_mov_b64 exec, s[82:83]
    s_nop 1
    v_mfma_f32_4x4x4_16b_bf16 v[88:91], v[12:13], v[84:85], 0
    s_nop 1
    v_mfma_f32_4x4x4_16b_bf16 v[88:91], v[10:11], v[86:87], v[88:91]
    s_nop 4
    v_cvt_pk_bf16_f32 v88, v88, v89
    v_cvt_pk_bf16_f32 v89, v90, v91
    ds_pk_add_bf16 v7, v88
    ds_pk_add_bf16 v7, v89 offset:4
    s_mov_b64 exec, vcc
    s_branch L2_d100
L2_c101:
    s_mov_b64 exec, s[82:83]
    s_nop 1
    v_mfma_f32_4x4x4_16b_bf16 v[88:91], v[12:13], v[84:85], 0
    s_nop 1
    v_mfma_f32_4x4x4_16b_bf16 v[88:91], v[10:11], v[86:87], v[88:91]
    s_nop 4
    v_cvt_pk_bf16_f32 v88, v88, v89
    v_cvt_pk_bf16_f32 v89, v90, v91
    ds_pk_add_bf16 v7, v88
    ds_pk_add_bf16 v7, v89 offset:4
    s_mov_b64 exec, vcc
    s_branch L2_d101
L2_c102:
    s_mov_b64 exec, s[82:83]
    s_nop 1
    v_mfma_f32_4x4x4_16b_bf16 v[88:91], v[12:13], v[84:85], 0
    s_nop 1
    v_mfma_f32_4x4x4_16b_bf16 v[88:91], v[10:11], v[86:87], v[88:91]
    s_nop 4
    v_cvt_pk_bf16_f32 v88, v88, v89
    v_cvt_pk_bf16_f32 v89, v90, v91
    ds_pk_add_bf16 v7, v88
    ds_pk_add_bf16 v7, v89 offset:4
    s_mov_b64 exec, vcc
    s_branch L2_d102
L2_c103:
    s_mov_b64 exec, s[82:83]
    s_nop 1
    v_mfma_f32_4x4x4_16b_bf16 v[88:91], v[12:13], v[84:85], 0
    s_nop 1
    v_mfma_f32_4x4x4_16b_bf16 v[88:91], v[10:11], v[86:87], v[88:91]
    s_nop 4
    v_cvt_pk_bf16_f32 v88, v88, v89
    v_cvt_pk_bf16_f32 v89, v90, v91
    ds_pk_add_bf16 v7, v88
    ds_pk_add_bf16 v7, v89 offset:4
    s_mov_b64 exec, vcc
    s_branch L2_d103
L2_c104:
    s_mov_b64 exec, s[82:83]
    s_nop 1
    v_mfma_f32_4x4x4_16b_bf16 v[88:91], v[12:13], v[84:85], 0
    s_nop 1
    v_mfma_f32_4x4x4_16b_bf16 v[88:91], v[10:11], v[86:87], v[88:91]
    s_nop 4
    v_cvt_pk_bf16_f32 v88, v88, v89
    v_cvt_pk_bf16_f32 v89, v90, v91
    ds_pk_add_bf16 v7, v88
    ds_pk_add_bf16 v7, v89 offset:4
    s_mov_b64 exec, vcc
    s_branch L2_d104
L2_c105:
    s_mov_b64 exec, s[82:83]
    s_nop 1
    v_mfma_f32_4x4x4_16b_bf16 v[88:91], v[12:13], v[84:85], 0
    s_nop 1
    v_mfma_f32_4x4x4_16b_bf16 v[88:91], v[10:11], v[86:87], v[88:91]
    s_nop 4
    v_cvt_pk_bf16_f32 v88, v88, v89
    v_cvt_pk_bf16_f32 v89, v90, v91
    ds_pk_add_bf16 v7, v88
    ds_pk_add_bf16 v7, v89 offset:4
    s_mov_b64 exec, vcc
    s_branch L2_d105
L2_c106:
    s_mov_b64 exec, s[82:83]
    s_nop 1
    v_mfma_f32_4x4x4_16b_bf16 v[88:91], v[12:13], v[84:85], 0
    s_nop 1
    v_mfma_f32_4x4x4_16b_bf16 v[88:91], v[10:11], v[86:87], v[88:91]
    s_nop 4
    v_cvt_pk_bf16_f32 v88, v88, v89
    v_cvt_pk_bf16_f32 v89, v90, v91
    ds_pk_add_bf16 v7, v88
    ds_pk_add_bf16 v7, v89 offset:4
    s_mov_b64 exec, vcc
    s_branch L2_d106
L2_c107:
    s_mov_b64 exec, s[82:83]
    s_nop 1
    v_mfma_f32_4x4x4_16b_bf16 v[88:91], v[12:13], v[84:85], 0
    s_nop 1
    v_mfma_f32_4x4x4_16b_bf16 v[88:91], v[10:11], v[86:87], v[88:91]
    s_nop 4
    v_cvt_pk_bf16_f32 v88, v88, v89
    v_cvt_pk_bf16_f32 v89, v90, v91
    ds_pk_add_bf16 v7, v88
    ds_pk_add_bf16 v7, v89 offset:4
    s_mov_b64 exec, vcc
    s_branch L2_d107
L2_xa108:
    s_cmp_eq_u32 s43, 1
    s_cbranch_scc1 L2_xc108
    v_lshlrev_b32 v89, 0, v96
    v_add_u32 v90, 140, v97
    v_bitop3_b32 v90, v89, v45, v90 bitop3:0x6a
    ds_write_b32 v98, v90 offset:28
    v_lshlrev_b32 v89, 4, v96
    v_add_u32 v90, 120, v97
    v_bitop3_b32 v90, v89, v45, v90 bitop3:0x6a
    ds_write_b32 v98, v90 offset:24
    v_lshlrev_b32 v89, 8, v96
    v_add_u32 v90, 100, v97
    v_bitop3_b32 v90, v89, v45, v90 bitop3:0x6a
    ds_write_b32 v98, v90 offset:20
L2_xc108:
    v_lshlrev_b32 v89, 12, v96
    v_add_u32 v90, 80, v97
    v_bitop3_b32 v90, v89, v45, v90 bitop3:0x6a
    ds_write_b32 v98, v90 offset:16
    s_branch L2_xb108
L2_xe108:
    v_cmp_lt_u32 vcc, 32, v99
    v_cmp_lt_u32 s[58:59], 31, v88
    v_lshrrev_b32 v89, 16, v96
    v_add_u32 v97, 80, v97
    s_or_b64 vcc, vcc, s[58:59]
    s_cbranch_scc1 L2_xs108
    v_lshlrev_b32 v89, v1, v89
    v_and_b32 v89, v45, v89
    v_cmp_ne_u32 vcc, 0, v89
    v_xor_b32 v90, v97, v89
    s_add_u32 s3, s37, s38
    v_mbcnt_lo_u32_b32 v98, vcc_lo, 0
    v_mbcnt_hi_u32_b32 v98, vcc_hi, v98
    s_bcnt1_i32_b64 s41, vcc
    v_lshl_add_u32 v98, v98, 2, s3
    s_mov_b64 exec, vcc
    ds_write_b32 v98, v90
    s_mov_b64 exec, -1
    s_lshl2_add_u32 s37, s41, s37
    s_branch L2_xr108
L2_xf108:
    s_waitcnt lgkmcnt(0)
    s_cmp_gt_u32 s37, 1024
    s_cbranch_scc1 L2_xs108
    v_mov_b32 v43, -1
    s_cmp_ge_u32 s37, 512
    s_cbranch_scc1 L2_xg108
    v_mov_b32 v42, -1
    s_cmp_ge_u32 s37, 256
    s_cbranch_scc1 L2_xg108
    v_mov_b32 v41, -1
    s_branch L2_xg108
L2_xs108:
    s_waitcnt lgkmcnt(0)
    v_mov_b32 v40, -1
    v_mov_b32 v41, -1
    v_mov_b32 v42, -1
    v_mov_b32 v43, -1
    s_add_u32 s3, s42, 2
    s_bitset1_b32 s36, s3
    s_branch L2_xg108
L2_c109:
    s_mov_b64 exec, s[82:83]
    s_nop 1
    v_mfma_f32_4x4x4_16b_bf16 v[88:91], v[12:13], v[84:85], 0
    s_nop 1
    v_mfma_f32_4x4x4_16b_bf16 v[88:91], v[10:11], v[86:87], v[88:91]
    s_nop 4
    v_cvt_pk_bf16_f32 v88, v88, v89
    v_cvt_pk_bf16_f32 v89, v90, v91
    ds_pk_add_bf16 v7, v88
    ds_pk_add_bf16 v7, v89 offset:4
    s_mov_b64 exec, vcc
    s_branch L2_d109
L2_c110:
    s_mov_b64 exec, s[82:83]
    s_nop 1
    v_mfma_f32_4x4x4_16b_bf16 v[88:91], v[12:13], v[84:85], 0
    s_nop 1
    v_mfma_f32_4x4x4_16b_bf16 v[88:91], v[10:11], v[86:87], v[88:91]
    s_nop 4
    v_cvt_pk_bf16_f32 v88, v88, v89
    v_cvt_pk_bf16_f32 v89, v90, v91
    ds_pk_add_bf16 v7, v88
    ds_pk_add_bf16 v7, v89 offset:4
    s_mov_b64 exec, vcc
    s_branch L2_d110
L2_c111:
    s_mov_b64 exec, s[82:83]
    s_nop 1
    v_mfma_f32_4x4x4_16b_bf16 v[88:91], v[12:13], v[84:85], 0
    s_nop 1
    v_mfma_f32_4x4x4_16b_bf16 v[88:91], v[10:11], v[86:87], v[88:91]
    s_nop 4
    v_cvt_pk_bf16_f32 v88, v88, v89
    v_cvt_pk_bf16_f32 v89, v90, v91
    ds_pk_add_bf16 v7, v88
    ds_pk_add_bf16 v7, v89 offset:4
    s_mov_b64 exec, vcc
    s_branch L2_d111
L2_c112:
    s_mov_b64 exec, s[82:83]
    s_nop 1
    v_mfma_f32_4x4x4_16b_bf16 v[88:91], v[12:13], v[84:85], 0
    s_nop 1
    v_mfma_f32_4x4x4_16b_bf16 v[88:91], v[10:11], v[86:87], v[88:91]
    s_nop 4
    v_cvt_pk_bf16_f32 v88, v88, v89
    v_cvt_pk_bf16_f32 v89, v90, v91
    ds_pk_add_bf16 v7, v88
    ds_pk_add_bf16 v7, v89 offset:4
    s_mov_b64 exec, vcc
    s_branch L2_d112
L2_c113:
    s_mov_b64 exec, s[82:83]
    s_nop 1
    v_mfma_f32_4x4x4_16b_bf16 v[88:91], v[12:13], v[84:85], 0
    s_nop 1
    v_mfma_f32_4x4x4_16b_bf16 v[88:91], v[10:11], v[86:87], v[88:91]
    s_nop 4
    v_cvt_pk_bf16_f32 v88, v88, v89
    v_cvt_pk_bf16_f32 v89, v90, v91
    ds_pk_add_bf16 v7, v88
    ds_pk_add_bf16 v7, v89 offset:4
    s_mov_b64 exec, vcc
    s_branch L2_d113
L2_c114:
    s_mov_b64 exec, s[82:83]
    s_nop 1
    v_mfma_f32_4x4x4_16b_bf16 v[88:91], v[12:13], v[84:85], 0
    s_nop 1
    v_mfma_f32_4x4x4_16b_bf16 v[88:91], v[10:11], v[86:87], v[88:91]
    s_nop 4
    v_cvt_pk_bf16_f32 v88, v88, v89
    v_cvt_pk_bf16_f32 v89, v90, v91
    ds_pk_add_bf16 v7, v88
    ds_pk_add_bf16 v7, v89 offset:4
    s_mov_b64 exec, vcc
    s_branch L2_d114
L2_c115:
    s_mov_b64 exec, s[82:83]
    s_nop 1
    v_mfma_f32_4x4x4_16b_bf16 v[88:91], v[12:13], v[84:85], 0
    s_nop 1
    v_mfma_f32_4x4x4_16b_bf16 v[88:91], v[10:11], v[86:87], v[88:91]
    s_nop 4
    v_cvt_pk_bf16_f32 v88, v88, v89
    v_cvt_pk_bf16_f32 v89, v90, v91
    ds_pk_add_bf16 v7, v88
    ds_pk_add_bf16 v7, v89 offset:4
    s_mov_b64 exec, vcc
    s_branch L2_d115
L2_c116:
    s_mov_b64 exec, s[82:83]
    s_nop 1
    v_mfma_f32_4x4x4_16b_bf16 v[88:91], v[12:13], v[84:85], 0
    s_nop 1
    v_mfma_f32_4x4x4_16b_bf16 v[88:91], v[10:11], v[86:87], v[88:91]
    s_nop 4
    v_cvt_pk_bf16_f32 v88, v88, v89
    v_cvt_pk_bf16_f32 v89, v90, v91
    ds_pk_add_bf16 v7, v88
    ds_pk_add_bf16 v7, v89 offset:4
    s_mov_b64 exec, vcc
    s_branch L2_d116
L2_c117:
    s_mov_b64 exec, s[82:83]
    s_nop 1
    v_mfma_f32_4x4x4_16b_bf16 v[88:91], v[12:13], v[84:85], 0
    s_nop 1
    v_mfma_f32_4x4x4_16b_bf16 v[88:91], v[10:11], v[86:87], v[88:91]
    s_nop 4
    v_cvt_pk_bf16_f32 v88, v88, v89
    v_cvt_pk_bf16_f32 v89, v90, v91
    ds_pk_add_bf16 v7, v88
    ds_pk_add_bf16 v7, v89 offset:4
    s_mov_b64 exec, vcc
    s_branch L2_d117
L2_c118:
    s_mov_b64 exec, s[82:83]
    s_nop 1
    v_mfma_f32_4x4x4_16b_bf16 v[88:91], v[12:13], v[84:85], 0
    s_nop 1
    v_mfma_f32_4x4x4_16b_bf16 v[88:91], v[10:11], v[86:87], v[88:91]
    s_nop 4
    v_cvt_pk_bf16_f32 v88, v88, v89
    v_cvt_pk_bf16_f32 v89, v90, v91
    ds_pk_add_bf16 v7, v88
    ds_pk_add_bf16 v7, v89 offset:4
    s_mov_b64 exec, vcc
    s_branch L2_d118
L2_c119:
    s_mov_b64 exec, s[82:83]
    s_nop 1
    v_mfma_f32_4x4x4_16b_bf16 v[88:91], v[12:13], v[84:85], 0
    s_nop 1
    v_mfma_f32_4x4x4_16b_bf16 v[88:91], v[10:11], v[86:87], v[88:91]
    s_nop 4
    v_cvt_pk_bf16_f32 v88, v88, v89
    v_cvt_pk_bf16_f32 v89, v90, v91
    ds_pk_add_bf16 v7, v88
    ds_pk_add_bf16 v7, v89 offset:4
    s_mov_b64 exec, vcc
    s_branch L2_d119
L2_c120:
    s_mov_b64 exec, s[82:83]
    s_nop 1
    v_mfma_f32_4x4x4_16b_bf16 v[88:91], v[12:13], v[84:85], 0
    s_nop 1
    v_mfma_f32_4x4x4_16b_bf16 v[88:91], v[10:11], v[86:87], v[88:91]
    s_nop 4
    v_cvt_pk_bf16_f32 v88, v88, v89
    v_cvt_pk_bf16_f32 v89, v90, v91
    ds_pk_add_bf16 v7, v88
    ds_pk_add_bf16 v7, v89 offset:4
    s_mov_b64 exec, vcc
    s_branch L2_d120
L2_c121:
    s_mov_b64 exec, s[82:83]
    s_nop 1
    v_mfma_f32_4x4x4_16b_bf16 v[88:91], v[12:13], v[84:85], 0
    s_nop 1
    v_mfma_f32_4x4x4_16b_bf16 v[88:91], v[10:11], v[86:87], v[88:91]
    s_nop 4
    v_cvt_pk_bf16_f32 v88, v88, v89
    v_cvt_pk_bf16_f32 v89, v90, v91
    ds_pk_add_bf16 v7, v88
    ds_pk_add_bf16 v7, v89 offset:4
    s_mov_b64 exec, vcc
    s_branch L2_d121
L2_c122:
    s_mov_b64 exec, s[82:83]
    s_nop 1
    v_mfma_f32_4x4x4_16b_bf16 v[88:91], v[12:13], v[84:85], 0
    s_nop 1
    v_mfma_f32_4x4x4_16b_bf16 v[88:91], v[10:11], v[86:87], v[88:91]
    s_nop 4
    v_cvt_pk_bf16_f32 v88, v88, v89
    v_cvt_pk_bf16_f32 v89, v90, v91
    ds_pk_add_bf16 v7, v88
    ds_pk_add_bf16 v7, v89 offset:4
    s_mov_b64 exec, vcc
    s_branch L2_d122
L2_c123:
    s_mov_b64 exec, s[82:83]
    s_nop 1
    v_mfma_f32_4x4x4_16b_bf16 v[88:91], v[12:13], v[84:85], 0
    s_nop 1
    v_mfma_f32_4x4x4_16b_bf16 v[88:91], v[10:11], v[86:87], v[88:91]
    s_nop 4
    v_cvt_pk_bf16_f32 v88, v88, v89
    v_cvt_pk_bf16_f32 v89, v90, v91
    ds_pk_add_bf16 v7, v88
    ds_pk_add_bf16 v7, v89 offset:4
    s_mov_b64 exec, vcc
    s_branch L2_d123
L2_c124:
    s_mov_b64 exec, s[82:83]
    s_nop 1
    v_mfma_f32_4x4x4_16b_bf16 v[88:91], v[12:13], v[84:85], 0
    s_nop 1
    v_mfma_f32_4x4x4_16b_bf16 v[88:91], v[10:11], v[86:87], v[88:91]
    s_nop 4
    v_cvt_pk_bf16_f32 v88, v88, v89
    v_cvt_pk_bf16_f32 v89, v90, v91
    ds_pk_add_bf16 v7, v88
    ds_pk_add_bf16 v7, v89 offset:4
    s_mov_b64 exec, vcc
    s_branch L2_d124
L2_c125:
    s_mov_b64 exec, s[82:83]
    s_nop 1
    v_mfma_f32_4x4x4_16b_bf16 v[88:91], v[12:13], v[84:85], 0
    s_nop 1
    v_mfma_f32_4x4x4_16b_bf16 v[88:91], v[10:11], v[86:87], v[88:91]
    s_nop 4
    v_cvt_pk_bf16_f32 v88, v88, v89
    v_cvt_pk_bf16_f32 v89, v90, v91
    ds_pk_add_bf16 v7, v88
    ds_pk_add_bf16 v7, v89 offset:4
    s_mov_b64 exec, vcc
    s_branch L2_d125
L2_c126:
    s_mov_b64 exec, s[82:83]
    s_nop 1
    v_mfma_f32_4x4x4_16b_bf16 v[88:91], v[12:13], v[84:85], 0
    s_nop 1
    v_mfma_f32_4x4x4_16b_bf16 v[88:91], v[10:11], v[86:87], v[88:91]
    s_nop 4
    v_cvt_pk_bf16_f32 v88, v88, v89
    v_cvt_pk_bf16_f32 v89, v90, v91
    ds_pk_add_bf16 v7, v88
    ds_pk_add_bf16 v7, v89 offset:4
    s_mov_b64 exec, vcc
    s_branch L2_d126
L2_c127:
    s_mov_b64 exec, s[82:83]
    s_nop 1
    v_mfma_f32_4x4x4_16b_bf16 v[88:91], v[12:13], v[84:85], 0
    s_nop 1
    v_mfma_f32_4x4x4_16b_bf16 v[88:91], v[10:11], v[86:87], v[88:91]
    s_nop 4
    v_cvt_pk_bf16_f32 v88, v88, v89
    v_cvt_pk_bf16_f32 v89, v90, v91
    ds_pk_add_bf16 v7, v88
    ds_pk_add_bf16 v7, v89 offset:4
    s_mov_b64 exec, vcc
    s_branch L2_d127
L2_c128:
    s_mov_b64 exec, s[82:83]
    s_nop 1
    v_mfma_f32_4x4x4_16b_bf16 v[88:91], v[12:13], v[84:85], 0
    s_nop 1
    v_mfma_f32_4x4x4_16b_bf16 v[88:91], v[10:11], v[86:87], v[88:91]
    s_nop 4
    v_cvt_pk_bf16_f32 v88, v88, v89
    v_cvt_pk_bf16_f32 v89, v90, v91
    ds_pk_add_bf16 v7, v88
    ds_pk_add_bf16 v7, v89 offset:4
    s_mov_b64 exec, vcc
    s_branch L2_d128
L2_c129:
    s_mov_b64 exec, s[82:83]
    s_nop 1
    v_mfma_f32_4x4x4_16b_bf16 v[88:91], v[12:13], v[84:85], 0
    s_nop 1
    v_mfma_f32_4x4x4_16b_bf16 v[88:91], v[10:11], v[86:87], v[88:91]
    s_nop 4
    v_cvt_pk_bf16_f32 v88, v88, v89
    v_cvt_pk_bf16_f32 v89, v90, v91
    ds_pk_add_bf16 v7, v88
    ds_pk_add_bf16 v7, v89 offset:4
    s_mov_b64 exec, vcc
    s_branch L2_d129
L2_c130:
    s_mov_b64 exec, s[82:83]
    s_nop 1
    v_mfma_f32_4x4x4_16b_bf16 v[88:91], v[12:13], v[84:85], 0
    s_nop 1
    v_mfma_f32_4x4x4_16b_bf16 v[88:91], v[10:11], v[86:87], v[88:91]
    s_nop 4
    v_cvt_pk_bf16_f32 v88, v88, v89
    v_cvt_pk_bf16_f32 v89, v90, v91
    ds_pk_add_bf16 v7, v88
    ds_pk_add_bf16 v7, v89 offset:4
    s_mov_b64 exec, vcc
    s_branch L2_d130
L2_c131:
    s_mov_b64 exec, s[82:83]
    s_nop 1
    v_mfma_f32_4x4x4_16b_bf16 v[88:91], v[12:13], v[84:85], 0
    s_nop 1
    v_mfma_f32_4x4x4_16b_bf16 v[88:91], v[10:11], v[86:87], v[88:91]
    s_nop 4
    v_cvt_pk_bf16_f32 v88, v88, v89
    v_cvt_pk_bf16_f32 v89, v90, v91
    ds_pk_add_bf16 v7, v88
    ds_pk_add_bf16 v7, v89 offset:4
    s_mov_b64 exec, vcc
    s_branch L2_d131
L2_c132:
    s_mov_b64 exec, s[82:83]
    s_nop 1
    v_mfma_f32_4x4x4_16b_bf16 v[88:91], v[12:13], v[84:85], 0
    s_nop 1
    v_mfma_f32_4x4x4_16b_bf16 v[88:91], v[10:11], v[86:87], v[88:91]
    s_nop 4
    v_cvt_pk_bf16_f32 v88, v88, v89
    v_cvt_pk_bf16_f32 v89, v90, v91
    ds_pk_add_bf16 v7, v88
    ds_pk_add_bf16 v7, v89 offset:4
    s_mov_b64 exec, vcc
    s_branch L2_d132
L2_c133:
    s_mov_b64 exec, s[82:83]
    s_nop 1
    v_mfma_f32_4x4x4_16b_bf16 v[88:91], v[12:13], v[84:85], 0
    s_nop 1
    v_mfma_f32_4x4x4_16b_bf16 v[88:91], v[10:11], v[86:87], v[88:91]
    s_nop 4
    v_cvt_pk_bf16_f32 v88, v88, v89
    v_cvt_pk_bf16_f32 v89, v90, v91
    ds_pk_add_bf16 v7, v88
    ds_pk_add_bf16 v7, v89 offset:4
    s_mov_b64 exec, vcc
    s_branch L2_d133
L2_c134:
    s_mov_b64 exec, s[82:83]
    s_nop 1
    v_mfma_f32_4x4x4_16b_bf16 v[88:91], v[12:13], v[84:85], 0
    s_nop 1
    v_mfma_f32_4x4x4_16b_bf16 v[88:91], v[10:11], v[86:87], v[88:91]
    s_nop 4
    v_cvt_pk_bf16_f32 v88, v88, v89
    v_cvt_pk_bf16_f32 v89, v90, v91
    ds_pk_add_bf16 v7, v88
    ds_pk_add_bf16 v7, v89 offset:4
    s_mov_b64 exec, vcc
    s_branch L2_d134
L2_c135:
    s_mov_b64 exec, s[82:83]
    s_nop 1
    v_mfma_f32_4x4x4_16b_bf16 v[88:91], v[12:13], v[84:85], 0
    s_nop 1
    v_mfma_f32_4x4x4_16b_bf16 v[88:91], v[10:11], v[86:87], v[88:91]
    s_nop 4
    v_cvt_pk_bf16_f32 v88, v88, v89
    v_cvt_pk_bf16_f32 v89, v90, v91
    ds_pk_add_bf16 v7, v88
    ds_pk_add_bf16 v7, v89 offset:4
    s_mov_b64 exec, vcc
    s_branch L2_d135
L2_c136:
    s_mov_b64 exec, s[82:83]
    s_nop 1
    v_mfma_f32_4x4x4_16b_bf16 v[88:91], v[12:13], v[84:85], 0
    s_nop 1
    v_mfma_f32_4x4x4_16b_bf16 v[88:91], v[10:11], v[86:87], v[88:91]
    s_nop 4
    v_cvt_pk_bf16_f32 v88, v88, v89
    v_cvt_pk_bf16_f32 v89, v90, v91
    ds_pk_add_bf16 v7, v88
    ds_pk_add_bf16 v7, v89 offset:4
    s_mov_b64 exec, vcc
    s_branch L2_d136
L2_c137:
    s_mov_b64 exec, s[82:83]
    s_nop 1
    v_mfma_f32_4x4x4_16b_bf16 v[88:91], v[12:13], v[84:85], 0
    s_nop 1
    v_mfma_f32_4x4x4_16b_bf16 v[88:91], v[10:11], v[86:87], v[88:91]
    s_nop 4
    v_cvt_pk_bf16_f32 v88, v88, v89
    v_cvt_pk_bf16_f32 v89, v90, v91
    ds_pk_add_bf16 v7, v88
    ds_pk_add_bf16 v7, v89 offset:4
    s_mov_b64 exec, vcc
    s_branch L2_d137
L2_c138:
    s_mov_b64 exec, s[82:83]
    s_nop 1
    v_mfma_f32_4x4x4_16b_bf16 v[88:91], v[12:13], v[84:85], 0
    s_nop 1
    v_mfma_f32_4x4x4_16b_bf16 v[88:91], v[10:11], v[86:87], v[88:91]
    s_nop 4
    v_cvt_pk_bf16_f32 v88, v88, v89
    v_cvt_pk_bf16_f32 v89, v90, v91
    ds_pk_add_bf16 v7, v88
    ds_pk_add_bf16 v7, v89 offset:4
    s_mov_b64 exec, vcc
    s_branch L2_d138
L2_c139:
    s_mov_b64 exec, s[82:83]
    s_nop 1
    v_mfma_f32_4x4x4_16b_bf16 v[88:91], v[12:13], v[84:85], 0
    s_nop 1
    v_mfma_f32_4x4x4_16b_bf16 v[88:91], v[10:11], v[86:87], v[88:91]
    s_nop 4
    v_cvt_pk_bf16_f32 v88, v88, v89
    v_cvt_pk_bf16_f32 v89, v90, v91
    ds_pk_add_bf16 v7, v88
    ds_pk_add_bf16 v7, v89 offset:4
    s_mov_b64 exec, vcc
    s_branch L2_d139
L2_c140:
    s_mov_b64 exec, s[82:83]
    s_nop 1
    v_mfma_f32_4x4x4_16b_bf16 v[88:91], v[12:13], v[84:85], 0
    s_nop 1
    v_mfma_f32_4x4x4_16b_bf16 v[88:91], v[10:11], v[86:87], v[88:91]
    s_nop 4
    v_cvt_pk_bf16_f32 v88, v88, v89
    v_cvt_pk_bf16_f32 v89, v90, v91
    ds_pk_add_bf16 v7, v88
    ds_pk_add_bf16 v7, v89 offset:4
    s_mov_b64 exec, vcc
    s_branch L2_d140
L2_c141:
    s_mov_b64 exec, s[82:83]
    s_nop 1
    v_mfma_f32_4x4x4_16b_bf16 v[88:91], v[12:13], v[84:85], 0
    s_nop 1
    v_mfma_f32_4x4x4_16b_bf16 v[88:91], v[10:11], v[86:87], v[88:91]
    s_nop 4
    v_cvt_pk_bf16_f32 v88, v88, v89
    v_cvt_pk_bf16_f32 v89, v90, v91
    ds_pk_add_bf16 v7, v88
    ds_pk_add_bf16 v7, v89 offset:4
    s_mov_b64 exec, vcc
    s_branch L2_d141
L2_c142:
    s_mov_b64 exec, s[82:83]
    s_nop 1
    v_mfma_f32_4x4x4_16b_bf16 v[88:91], v[12:13], v[84:85], 0
    s_nop 1
    v_mfma_f32_4x4x4_16b_bf16 v[88:91], v[10:11], v[86:87], v[88:91]
    s_nop 4
    v_cvt_pk_bf16_f32 v88, v88, v89
    v_cvt_pk_bf16_f32 v89, v90, v91
    ds_pk_add_bf16 v7, v88
    ds_pk_add_bf16 v7, v89 offset:4
    s_mov_b64 exec, vcc
    s_branch L2_d142
L2_c143:
    s_mov_b64 exec, s[82:83]
    s_nop 1
    v_mfma_f32_4x4x4_16b_bf16 v[88:91], v[12:13], v[84:85], 0
    s_nop 1
    v_mfma_f32_4x4x4_16b_bf16 v[88:91], v[10:11], v[86:87], v[88:91]
    s_nop 4
    v_cvt_pk_bf16_f32 v88, v88, v89
    v_cvt_pk_bf16_f32 v89, v90, v91
    ds_pk_add_bf16 v7, v88
    ds_pk_add_bf16 v7, v89 offset:4
    s_mov_b64 exec, vcc
    s_branch L2_d143
L2_c144:
    s_mov_b64 exec, s[82:83]
    s_nop 1
    v_mfma_f32_4x4x4_16b_bf16 v[88:91], v[12:13], v[84:85], 0
    s_nop 1
    v_mfma_f32_4x4x4_16b_bf16 v[88:91], v[10:11], v[86:87], v[88:91]
    s_nop 4
    v_cvt_pk_bf16_f32 v88, v88, v89
    v_cvt_pk_bf16_f32 v89, v90, v91
    ds_pk_add_bf16 v7, v88
    ds_pk_add_bf16 v7, v89 offset:4
    s_mov_b64 exec, vcc
    s_branch L2_d144
L2_c145:
    s_mov_b64 exec, s[82:83]
    s_nop 1
    v_mfma_f32_4x4x4_16b_bf16 v[88:91], v[12:13], v[84:85], 0
    s_nop 1
    v_mfma_f32_4x4x4_16b_bf16 v[88:91], v[10:11], v[86:87], v[88:91]
    s_nop 4
    v_cvt_pk_bf16_f32 v88, v88, v89
    v_cvt_pk_bf16_f32 v89, v90, v91
    ds_pk_add_bf16 v7, v88
    ds_pk_add_bf16 v7, v89 offset:4
    s_mov_b64 exec, vcc
    s_branch L2_d145
L2_c146:
    s_mov_b64 exec, s[82:83]
    s_nop 1
    v_mfma_f32_4x4x4_16b_bf16 v[88:91], v[12:13], v[84:85], 0
    s_nop 1
    v_mfma_f32_4x4x4_16b_bf16 v[88:91], v[10:11], v[86:87], v[88:91]
    s_nop 4
    v_cvt_pk_bf16_f32 v88, v88, v89
    v_cvt_pk_bf16_f32 v89, v90, v91
    ds_pk_add_bf16 v7, v88
    ds_pk_add_bf16 v7, v89 offset:4
    s_mov_b64 exec, vcc
    s_branch L2_d146
.section .rodata,"a"
.p2align 6
.amdhsa_kernel gs_sort_kernel
  .amdhsa_next_free_vgpr 128
  .amdhsa_next_free_sgpr 96
  .amdhsa_accum_offset 128
  .amdhsa_group_segment_fixed_size 0
  .amdhsa_kernarg_size 112
  .amdhsa_user_sgpr_count 2
  .amdhsa_user_sgpr_kernarg_segment_ptr 1
  .amdhsa_system_sgpr_workgroup_id_x 1
  .amdhsa_float_denorm_mode_32 3
.end_amdhsa_kernel
.p2align 6
.amdhsa_kernel gs_acc_kernel
  .amdhsa_next_free_vgpr 128
  .amdhsa_next_free_sgpr 100
  .amdhsa_accum_offset 128
  .amdhsa_group_segment_fixed_size 0
  .amdhsa_kernarg_size 112
  .amdhsa_user_sgpr_count 2
  .amdhsa_user_sgpr_kernarg_segment_ptr 1
  .amdhsa_system_sgpr_workgroup_id_x 1
  .amdhsa_float_denorm_mode_32 3
.end_amdhsa_kernel
```

```asm
; @launch kernel=gs_sort_kernel grid=(256,1,1) block=(1024,1,1) lds=163840
; @launch kernel=gs_acc_kernel grid=(256,1,1) block=(1024,1,1) lds=163840
.amdgcn_target "amdgcn-amd-amdhsa--gfx950"
.text
.globl gs_sort_kernel
.p2align 8
.type gs_sort_kernel,@function
gs_sort_kernel:
    s_cmp_ge_u32 s2, 256
    s_cbranch_scc1 L1_end
    s_load_dwordx4 s[4:7], s[0:1], 8
    s_load_dwordx2 s[28:29], s[0:1], 32
    s_load_dwordx2 s[30:31], s[0:1], 104
    s_load_dwordx2 s[56:57], s[0:1], 96
    s_load_dwordx2 s[86:87], s[0:1], 0
    s_load_dwordx4 s[60:63], s[0:1], 56
    s_load_dwordx4 s[64:67], s[0:1], 72
    v_lshrrev_b32 v7, 6, v0
    v_lshlrev_b32 v1, 3, v0
    v_readfirstlane_b32 s32, v7
    v_lshlrev_b32 v0, 4, v0
    s_mul_i32 s33, s2, 16384
    s_mul_i32 s34, s2, 8192
    s_waitcnt lgkmcnt(0)
    s_mov_b32 s8, s4
    s_mov_b32 s9, s5
    s_mov_b32 s10, 0x9c40000
    s_mov_b32 s11, 0x20000
    s_mov_b32 s12, s6
    s_mov_b32 s13, s7
    s_mov_b32 s14, 0x9c40000
    s_mov_b32 s15, 0x20000
    s_mov_b32 s16, s28
    s_mov_b32 s17, s29
    s_mov_b32 s18, 0x4e20000
    s_mov_b32 s19, 0x20000
    s_add_u32 s44, s33, 0x0
    buffer_load_dwordx4 v[16:19], v0, s[8:11], s44 offen nt
    s_add_u32 s45, s33, 0x0
    buffer_load_dwordx4 v[20:23], v0, s[12:15], s45 offen nt
    s_add_u32 s46, s34, 0x0
    buffer_load_dwordx2 v[24:25], v1, s[16:19], s46 offen nt
    s_add_u32 s47, s34, 0x200000
    buffer_load_dwordx2 v[26:27], v1, s[16:19], s47 offen nt
    s_add_u32 s44, s33, 0x400000
    buffer_load_dwordx4 v[28:31], v0, s[8:11], s44 offen nt
    s_add_u32 s45, s33, 0x400000
    buffer_load_dwordx4 v[32:35], v0, s[12:15], s45 offen nt
    s_add_u32 s46, s33, 0x800000
    buffer_load_dwordx4 v[36:39], v0, s[8:11], s46 offen nt
    s_add_u32 s47, s33, 0x800000
    buffer_load_dwordx4 v[40:43], v0, s[12:15], s47 offen nt
    s_add_u32 s44, s34, 0x400000
    buffer_load_dwordx2 v[44:45], v1, s[16:19], s44 offen nt
    s_add_u32 s45, s34, 0x600000
    buffer_load_dwordx2 v[46:47], v1, s[16:19], s45 offen nt
    s_mov_b32 s68, s62
    s_mov_b32 s69, s63
    s_mov_b32 s70, 0x40
    s_mov_b32 s71, 0x20000
    s_mov_b32 s72, s60
    s_mov_b32 s73, s61
    s_mov_b32 s74, 0x40
    s_mov_b32 s75, 0x20000
    s_mov_b32 s20, s66
    s_mov_b32 s21, s67
    s_mov_b32 s22, 0x20
    s_mov_b32 s23, 0x20000
    s_mov_b32 s80, s64
    s_mov_b32 s81, s65
    s_mov_b32 s82, 0x20
    s_mov_b32 s83, 0x20000
    s_add_u32 s24, s30, 0xebc9000
    s_addc_u32 s25, s31, 0
    s_mov_b32 s26, 0x100
    s_mov_b32 s27, 0x20000
    v_lshrrev_b32 v2, 3, v0
    v_and_b32 v2, 6, v2
    v_lshlrev_b32 v3, 2, v0
    s_lshl_b32 s3, s32, 8
    s_add_u32 s3, s3, s2
    s_cmp_lg_u32 s3, 254
    s_cbranch_scc1 L1_wt
    buffer_load_ushort v96, v2, s[68:71], 0 offen offset:0
    buffer_load_ushort v108, v2, s[68:71], 0 offen offset:8
    buffer_load_ushort v97, v2, s[68:71], 0 offen offset:16
    buffer_load_ushort v109, v2, s[68:71], 0 offen offset:24
    buffer_load_ushort v98, v2, s[68:71], 0 offen offset:32
    buffer_load_ushort v110, v2, s[68:71], 0 offen offset:40
    buffer_load_ushort v99, v2, s[68:71], 0 offen offset:48
    buffer_load_ushort v111, v2, s[68:71], 0 offen offset:56
    buffer_load_ushort v100, v2, s[72:75], 0 offen offset:0
    buffer_load_ushort v112, v2, s[72:75], 0 offen offset:8
    buffer_load_ushort v101, v2, s[72:75], 0 offen offset:16
    buffer_load_ushort v113, v2, s[72:75], 0 offen offset:24
    buffer_load_ushort v102, v2, s[72:75], 0 offen offset:32
    buffer_load_ushort v114, v2, s[72:75], 0 offen offset:40
    buffer_load_ushort v103, v2, s[72:75], 0 offen offset:48
    buffer_load_ushort v115, v2, s[72:75], 0 offen offset:56
    buffer_load_ushort v104, v2, s[20:23], 0 offen offset:0
    buffer_load_ushort v116, v2, s[20:23], 0 offen offset:8
    buffer_load_ushort v105, v2, s[20:23], 0 offen offset:16
    buffer_load_ushort v117, v2, s[20:23], 0 offen offset:24
    buffer_load_ushort v106, v2, s[80:83], 0 offen offset:0
    buffer_load_ushort v118, v2, s[80:83], 0 offen offset:8
    buffer_load_ushort v107, v2, s[80:83], 0 offen offset:16
    buffer_load_ushort v119, v2, s[80:83], 0 offen offset:24
    s_waitcnt vmcnt(0)
    v_lshl_or_b32 v96, v108, 16, v96
    v_lshl_or_b32 v97, v109, 16, v97
    v_lshl_or_b32 v98, v110, 16, v98
    v_lshl_or_b32 v99, v111, 16, v99
    v_lshl_or_b32 v100, v112, 16, v100
    v_lshl_or_b32 v101, v113, 16, v101
    v_lshl_or_b32 v102, v114, 16, v102
    v_lshl_or_b32 v103, v115, 16, v103
    v_lshl_or_b32 v104, v116, 16, v104
    v_lshl_or_b32 v105, v117, 16, v105
    v_lshl_or_b32 v106, v118, 16, v106
    v_lshl_or_b32 v107, v119, 16, v107
    buffer_store_dwordx4 v[96:99], v3, s[24:27], 0 offen offset:0
    buffer_store_dwordx4 v[100:103], v3, s[24:27], 0 offen offset:16
    buffer_store_dwordx4 v[104:107], v3, s[24:27], 0 offen offset:32
L1_wt:
    s_mov_b32 s20, s30
    s_mov_b32 s21, s31
    s_mov_b32 s22, 0xd340000
    s_mov_b32 s23, 0x20000
    s_add_u32 s24, s30, 0x28000
    s_addc_u32 s25, s31, 0
    s_mov_b32 s26, 0xd318000
    s_mov_b32 s27, 0x20000
    s_mov_b32 s80, s86
    s_mov_b32 s81, s87
    s_mov_b32 s82, 0x4e2000
    s_mov_b32 s83, 0x20000
    s_mul_i32 s35, s2, 173056
    s_and_b32 s37, s32, 3
    s_lshl_b32 s37, s37, 3
    s_add_u32 s36, s35, s37
    s_lshr_b32 s37, s32, 2
    s_mul_i32 s37, s37, 2080
    s_add_u32 s36, s36, s37
    s_and_b32 s37, s2, 3
    s_lshl_b32 s37, s37, 5
    s_add_u32 s36, s36, s37
    s_mul_i32 s4, s2, 5
    s_add_u32 s4, s4, 8192
    s_lshl_b32 s38, s4, 14
    s_lshl_b32 s39, s4, 13
    v_mov_b32 v2, 1
    v_mov_b32 v4, 0x80000007
    v_mov_b32 v5, 0xfc
    v_mov_b32 v6, 0x78
    s_mov_b32 s40, 16512
    s_mov_b32 s55, -10000
    s_mov_b32 s41, 0x010c0c01
    s_mov_b32 s42, 0x030c0c03
    v_mov_b32 v8, 0
    v_mov_b32 v9, 0
    v_mov_b32 v10, 0
    v_mov_b32 v11, 0
    ds_write_b128 v0, v[8:11]
    s_add_u32 s68, s30, 0xebca000
    s_addc_u32 s69, s31, 0
    s_mov_b32 s70, 0x80
    s_mov_b32 s71, 0x20000
    s_lshl_b32 s3, s2, 7
    s_add_u32 s68, s68, s3
    s_addc_u32 s69, s69, 0
    s_cmp_lg_u32 s32, 0
    s_cbranch_scc1 L1_fl
    buffer_store_dwordx4 v[8:11], v0, s[68:71], 0 offen sc1
L1_fl:
    s_waitcnt lgkmcnt(0)
    s_barrier
    s_add_u32 s46, s33, 0xc00000
    buffer_load_dwordx4 v[48:51], v0, s[8:11], s46 offen nt
    s_add_u32 s47, s33, 0xc00000
    buffer_load_dwordx4 v[52:55], v0, s[12:15], s47 offen nt
    s_waitcnt vmcnt(8)
    v_lshlrev_b32 v7, 16, v24
    v_and_b32 v8, 0xffff0000, v24
    v_lshlrev_b32 v9, 16, v25
    v_and_b32 v10, 0xffff0000, v25
    v_mul_f32 v7, 0.15915494, v7
    v_mul_f32 v8, 0.15915494, v8
    v_mul_f32 v9, 0.15915494, v9
    v_mul_f32 v10, 0.15915494, v10
    v_mul_hi_u32_u24 v14, 429497, v16
    v_lshrrev_b32 v12, 3, v20
    v_cos_f32 v7, v7
    v_lshlrev_b16 v13, 3, v20
    v_mad_i32_i24 v11, v14, s55, v16
    v_bitop3_b32 v12, v6, v13, v12 bitop3:0xca
    v_lshl_add_u32 v11, v11, 17, s40
    v_lshlrev_b16 v14, 8, v14
    v_lshrrev_b32 v13, 2, v20
    v_add_u32 v16, v12, v11
    v_bitop3_b32 v20, v5, v13, v14 bitop3:0xea
    ds_add_u32 v20, v2
    v_mul_hi_u32_u24 v14, 429497, v17
    v_lshrrev_b32 v12, 3, v21
    v_cos_f32 v8, v8
    v_lshlrev_b16 v13, 3, v21
    v_mad_i32_i24 v11, v14, s55, v17
    v_bitop3_b32 v12, v6, v13, v12 bitop3:0xca
    v_lshl_add_u32 v11, v11, 17, s40
    v_lshlrev_b16 v14, 8, v14
    v_lshrrev_b32 v13, 2, v21
    v_add_u32 v17, v12, v11
    v_bitop3_b32 v21, v5, v13, v14 bitop3:0xea
    ds_add_u32 v21, v2
    v_cvt_pk_bf16_f32 v24, v7, v8
    v_perm_b32 v12, v24, v24, s41
    v_bitop3_b32 v16, v4, v12, v16 bitop3:0xca
    v_perm_b32 v13, v24, v24, s42
    v_bitop3_b32 v17, v4, v13, v17 bitop3:0xca
    v_mul_hi_u32_u24 v14, 429497, v18
    v_lshrrev_b32 v12, 3, v22
    v_cos_f32 v9, v9
    v_lshlrev_b16 v13, 3, v22
    v_mad_i32_i24 v11, v14, s55, v18
    v_bitop3_b32 v12, v6, v13, v12 bitop3:0xca
    v_lshl_add_u32 v11, v11, 17, s40
    v_lshlrev_b16 v14, 8, v14
    v_lshrrev_b32 v13, 2, v22
    v_add_u32 v18, v12, v11
    v_bitop3_b32 v22, v5, v13, v14 bitop3:0xea
    ds_add_u32 v22, v2
    v_mul_hi_u32_u24 v14, 429497, v19
    v_lshrrev_b32 v12, 3, v23
    v_cos_f32 v10, v10
    v_lshlrev_b16 v13, 3, v23
    v_mad_i32_i24 v11, v14, s55, v19
    v_bitop3_b32 v12, v6, v13, v12 bitop3:0xca
    v_lshl_add_u32 v11, v11, 17, s40
    v_lshlrev_b16 v14, 8, v14
    v_lshrrev_b32 v13, 2, v23
    v_add_u32 v19, v12, v11
    v_bitop3_b32 v23, v5, v13, v14 bitop3:0xea
    ds_add_u32 v23, v2
    v_cvt_pk_bf16_f32 v25, v9, v10
    v_perm_b32 v12, v25, v25, s41
    v_bitop3_b32 v18, v4, v12, v18 bitop3:0xca
    v_perm_b32 v13, v25, v25, s42
    v_bitop3_b32 v19, v4, v13, v19 bitop3:0xca
    s_add_u32 s44, s33, 0x1000000
    buffer_load_dwordx4 v[56:59], v0, s[8:11], s44 offen nt
    s_add_u32 s45, s33, 0x1000000
    buffer_load_dwordx4 v[60:63], v0, s[12:15], s45 offen nt
    s_add_u32 s46, s34, 0x800000
    buffer_load_dwordx2 v[64:65], v1, s[16:19], s46 offen nt
    s_add_u32 s47, s34, 0xa00000
    buffer_load_dwordx2 v[66:67], v1, s[16:19], s47 offen nt
    s_waitcnt vmcnt(10)
    v_lshlrev_b32 v7, 16, v26
    v_and_b32 v8, 0xffff0000, v26
    v_lshlrev_b32 v9, 16, v27
    v_and_b32 v10, 0xffff0000, v27
    v_mul_f32 v7, 0.15915494, v7
    v_mul_f32 v8, 0.15915494, v8
    v_mul_f32 v9, 0.15915494, v9
    v_mul_f32 v10, 0.15915494, v10
    v_mul_hi_u32_u24 v14, 429497, v28
    v_lshrrev_b32 v12, 3, v32
    v_cos_f32 v7, v7
    v_lshlrev_b16 v13, 3, v32
    v_mad_i32_i24 v11, v14, s55, v28
    v_bitop3_b32 v12, v6, v13, v12 bitop3:0xca
    v_lshl_add_u32 v11, v11, 17, s40
    v_lshlrev_b16 v14, 8, v14
    v_lshrrev_b32 v13, 2, v32
    v_add_u32 v28, v12, v11
    v_bitop3_b32 v32, v5, v13, v14 bitop3:0xea
    ds_add_u32 v32, v2
    v_mul_hi_u32_u24 v14, 429497, v29
    v_lshrrev_b32 v12, 3, v33
    v_cos_f32 v8, v8
    v_lshlrev_b16 v13, 3, v33
    v_mad_i32_i24 v11, v14, s55, v29
    v_bitop3_b32 v12, v6, v13, v12 bitop3:0xca
    v_lshl_add_u32 v11, v11, 17, s40
    v_lshlrev_b16 v14, 8, v14
    v_lshrrev_b32 v13, 2, v33
    v_add_u32 v29, v12, v11
    v_bitop3_b32 v33, v5, v13, v14 bitop3:0xea
    ds_add_u32 v33, v2
    v_cvt_pk_bf16_f32 v26, v7, v8
    v_perm_b32 v12, v26, v26, s41
    v_bitop3_b32 v28, v4, v12, v28 bitop3:0xca
    v_perm_b32 v13, v26, v26, s42
    v_bitop3_b32 v29, v4, v13, v29 bitop3:0xca
    v_mul_hi_u32_u24 v14, 429497, v30
    v_lshrrev_b32 v12, 3, v34
    v_cos_f32 v9, v9
    v_lshlrev_b16 v13, 3, v34
    v_mad_i32_i24 v11, v14, s55, v30
    v_bitop3_b32 v12, v6, v13, v12 bitop3:0xca
    v_lshl_add_u32 v11, v11, 17, s40
    v_lshlrev_b16 v14, 8, v14
    v_lshrrev_b32 v13, 2, v34
    v_add_u32 v30, v12, v11
    v_bitop3_b32 v34, v5, v13, v14 bitop3:0xea
    ds_add_u32 v34, v2
    v_mul_hi_u32_u24 v14, 429497, v31
    v_lshrrev_b32 v12, 3, v35
    v_cos_f32 v10, v10
    v_lshlrev_b16 v13, 3, v35
    v_mad_i32_i24 v11, v14, s55, v31
    v_bitop3_b32 v12, v6, v13, v12 bitop3:0xca
    v_lshl_add_u32 v11, v11, 17, s40
    v_lshlrev_b16 v14, 8, v14
    v_lshrrev_b32 v13, 2, v35
    v_add_u32 v31, v12, v11
    v_bitop3_b32 v35, v5, v13, v14 bitop3:0xea
    ds_add_u32 v35, v2
    v_cvt_pk_bf16_f32 v27, v9, v10
    v_perm_b32 v12, v27, v27, s41
    v_bitop3_b32 v30, v4, v12, v30 bitop3:0xca
    v_perm_b32 v13, v27, v27, s42
    v_bitop3_b32 v31, v4, v13, v31 bitop3:0xca
    s_add_u32 s44, s33, 0x1400000
    buffer_load_dwordx4 v[68:71], v0, s[8:11], s44 offen nt
    s_add_u32 s45, s33, 0x1400000
    buffer_load_dwordx4 v[72:75], v0, s[12:15], s45 offen nt
    s_waitcnt vmcnt(8)
    v_lshlrev_b32 v7, 16, v44
    v_and_b32 v8, 0xffff0000, v44
    v_lshlrev_b32 v9, 16, v45
    v_and_b32 v10, 0xffff0000, v45
    v_mul_f32 v7, 0.15915494, v7
    v_mul_f32 v8, 0.15915494, v8
    v_mul_f32 v9, 0.15915494, v9
    v_mul_f32 v10, 0.15915494, v10
    v_mul_hi_u32_u24 v14, 429497, v36
    v_lshrrev_b32 v12, 3, v40
    v_cos_f32 v7, v7
    v_lshlrev_b16 v13, 3, v40
    v_mad_i32_i24 v11, v14, s55, v36
    v_bitop3_b32 v12, v6, v13, v12 bitop3:0xca
    v_lshl_add_u32 v11, v11, 17, s40
    v_lshlrev_b16 v14, 8, v14
    v_lshrrev_b32 v13, 2, v40
    v_add_u32 v36, v12, v11
    v_bitop3_b32 v40, v5, v13, v14 bitop3:0xea
    ds_add_u32 v40, v2
    v_mul_hi_u32_u24 v14, 429497, v37
    v_lshrrev_b32 v12, 3, v41
    v_cos_f32 v8, v8
    v_lshlrev_b16 v13, 3, v41
    v_mad_i32_i24 v11, v14, s55, v37
    v_bitop3_b32 v12, v6, v13, v12 bitop3:0xca
    v_lshl_add_u32 v11, v11, 17, s40
    v_lshlrev_b16 v14, 8, v14
    v_lshrrev_b32 v13, 2, v41
    v_add_u32 v37, v12, v11
    v_bitop3_b32 v41, v5, v13, v14 bitop3:0xea
    ds_add_u32 v41, v2
    v_cvt_pk_bf16_f32 v44, v7, v8
    v_perm_b32 v12, v44, v44, s41
    v_bitop3_b32 v36, v4, v12, v36 bitop3:0xca
    v_perm_b32 v13, v44, v44, s42
    v_bitop3_b32 v37, v4, v13, v37 bitop3:0xca
    v_mul_hi_u32_u24 v14, 429497, v38
    v_lshrrev_b32 v12, 3, v42
    v_cos_f32 v9, v9
    v_lshlrev_b16 v13, 3, v42
    v_mad_i32_i24 v11, v14, s55, v38
    v_bitop3_b32 v12, v6, v13, v12 bitop3:0xca
    v_lshl_add_u32 v11, v11, 17, s40
    v_lshlrev_b16 v14, 8, v14
    v_lshrrev_b32 v13, 2, v42
    v_add_u32 v38, v12, v11
    v_bitop3_b32 v42, v5, v13, v14 bitop3:0xea
    ds_add_u32 v42, v2
    v_mul_hi_u32_u24 v14, 429497, v39
    v_lshrrev_b32 v12, 3, v43
    v_cos_f32 v10, v10
    v_lshlrev_b16 v13, 3, v43
    v_mad_i32_i24 v11, v14, s55, v39
    v_bitop3_b32 v12, v6, v13, v12 bitop3:0xca
    v_lshl_add_u32 v11, v11, 17, s40
    v_lshlrev_b16 v14, 8, v14
    v_lshrrev_b32 v13, 2, v43
    v_add_u32 v39, v12, v11
    v_bitop3_b32 v43, v5, v13, v14 bitop3:0xea
    ds_add_u32 v43, v2
    v_cvt_pk_bf16_f32 v45, v9, v10
    v_perm_b32 v12, v45, v45, s41
    v_bitop3_b32 v38, v4, v12, v38 bitop3:0xca
    v_perm_b32 v13, v45, v45, s42
    v_bitop3_b32 v39, v4, v13, v39 bitop3:0xca
    s_add_u32 s46, s33, 0x1800000
    buffer_load_dwordx4 v[76:79], v0, s[8:11], s46 offen nt
    s_add_u32 s47, s33, 0x1800000
    buffer_load_dwordx4 v[80:83], v0, s[12:15], s47 offen nt
    s_add_u32 s44, s34, 0xc00000
    buffer_load_dwordx2 v[84:85], v1, s[16:19], s44 offen nt
    s_add_u32 s45, s34, 0xe00000
    buffer_load_dwordx2 v[86:87], v1, s[16:19], s45 offen nt
    s_waitcnt vmcnt(10)
    v_lshlrev_b32 v7, 16, v46
    v_and_b32 v8, 0xffff0000, v46
    v_lshlrev_b32 v9, 16, v47
    v_and_b32 v10, 0xffff0000, v47
    v_mul_f32 v7, 0.15915494, v7
    v_mul_f32 v8, 0.15915494, v8
    v_mul_f32 v9, 0.15915494, v9
    v_mul_f32 v10, 0.15915494, v10
    v_mul_hi_u32_u24 v14, 429497, v48
    v_lshrrev_b32 v12, 3, v52
    v_cos_f32 v7, v7
    v_lshlrev_b16 v13, 3, v52
    v_mad_i32_i24 v11, v14, s55, v48
    v_bitop3_b32 v12, v6, v13, v12 bitop3:0xca
    v_lshl_add_u32 v11, v11, 17, s40
    v_lshlrev_b16 v14, 8, v14
    v_lshrrev_b32 v13, 2, v52
    v_add_u32 v48, v12, v11
    v_bitop3_b32 v52, v5, v13, v14 bitop3:0xea
    ds_add_u32 v52, v2
    v_mul_hi_u32_u24 v14, 429497, v49
    v_lshrrev_b32 v12, 3, v53
    v_cos_f32 v8, v8
    v_lshlrev_b16 v13, 3, v53
    v_mad_i32_i24 v11, v14, s55, v49
    v_bitop3_b32 v12, v6, v13, v12 bitop3:0xca
    v_lshl_add_u32 v11, v11, 17, s40
    v_lshlrev_b16 v14, 8, v14
    v_lshrrev_b32 v13, 2, v53
    v_add_u32 v49, v12, v11
    v_bitop3_b32 v53, v5, v13, v14 bitop3:0xea
    ds_add_u32 v53, v2
    v_cvt_pk_bf16_f32 v46, v7, v8
    v_perm_b32 v12, v46, v46, s41
    v_bitop3_b32 v48, v4, v12, v48 bitop3:0xca
    v_perm_b32 v13, v46, v46, s42
    v_bitop3_b32 v49, v4, v13, v49 bitop3:0xca
    v_mul_hi_u32_u24 v14, 429497, v50
    v_lshrrev_b32 v12, 3, v54
    v_cos_f32 v9, v9
    v_lshlrev_b16 v13, 3, v54
    v_mad_i32_i24 v11, v14, s55, v50
    v_bitop3_b32 v12, v6, v13, v12 bitop3:0xca
    v_lshl_add_u32 v11, v11, 17, s40
    v_lshlrev_b16 v14, 8, v14
    v_lshrrev_b32 v13, 2, v54
    v_add_u32 v50, v12, v11
    v_bitop3_b32 v54, v5, v13, v14 bitop3:0xea
    ds_add_u32 v54, v2
    v_mul_hi_u32_u24 v14, 429497, v51
    v_lshrrev_b32 v12, 3, v55
    v_cos_f32 v10, v10
    v_lshlrev_b16 v13, 3, v55
    v_mad_i32_i24 v11, v14, s55, v51
    v_bitop3_b32 v12, v6, v13, v12 bitop3:0xca
    v_lshl_add_u32 v11, v11, 17, s40
    v_lshlrev_b16 v14, 8, v14
    v_lshrrev_b32 v13, 2, v55
    v_add_u32 v51, v12, v11
    v_bitop3_b32 v55, v5, v13, v14 bitop3:0xea
    ds_add_u32 v55, v2
    v_cvt_pk_bf16_f32 v47, v9, v10
    v_perm_b32 v12, v47, v47, s41
    v_bitop3_b32 v50, v4, v12, v50 bitop3:0xca
    v_perm_b32 v13, v47, v47, s42
    v_bitop3_b32 v51, v4, v13, v51 bitop3:0xca
    s_add_u32 s46, s33, 0x1c00000
    buffer_load_dwordx4 v[88:91], v0, s[8:11], s46 offen nt
    s_add_u32 s47, s33, 0x1c00000
    buffer_load_dwordx4 v[92:95], v0, s[12:15], s47 offen nt
    s_waitcnt vmcnt(8)
    v_lshlrev_b32 v7, 16, v64
    v_and_b32 v8, 0xffff0000, v64
    v_lshlrev_b32 v9, 16, v65
    v_and_b32 v10, 0xffff0000, v65
    v_mul_f32 v7, 0.15915494, v7
    v_mul_f32 v8, 0.15915494, v8
    v_mul_f32 v9, 0.15915494, v9
    v_mul_f32 v10, 0.15915494, v10
    v_mul_hi_u32_u24 v14, 429497, v56
    v_lshrrev_b32 v12, 3, v60
    v_cos_f32 v7, v7
    v_lshlrev_b16 v13, 3, v60
    v_mad_i32_i24 v11, v14, s55, v56
    v_bitop3_b32 v12, v6, v13, v12 bitop3:0xca
    v_lshl_add_u32 v11, v11, 17, s40
    v_lshlrev_b16 v14, 8, v14
    v_lshrrev_b32 v13, 2, v60
    v_add_u32 v56, v12, v11
    v_bitop3_b32 v60, v5, v13, v14 bitop3:0xea
    ds_add_u32 v60, v2
    v_mul_hi_u32_u24 v14, 429497, v57
    v_lshrrev_b32 v12, 3, v61
    v_cos_f32 v8, v8
    v_lshlrev_b16 v13, 3, v61
    v_mad_i32_i24 v11, v14, s55, v57
    v_bitop3_b32 v12, v6, v13, v12 bitop3:0xca
    v_lshl_add_u32 v11, v11, 17, s40
    v_lshlrev_b16 v14, 8, v14
    v_lshrrev_b32 v13, 2, v61
    v_add_u32 v57, v12, v11
    v_bitop3_b32 v61, v5, v13, v14 bitop3:0xea
    ds_add_u32 v61, v2
    v_cvt_pk_bf16_f32 v64, v7, v8
    v_perm_b32 v12, v64, v64, s41
    v_bitop3_b32 v56, v4, v12, v56 bitop3:0xca
    v_perm_b32 v13, v64, v64, s42
    v_bitop3_b32 v57, v4, v13, v57 bitop3:0xca
    v_mul_hi_u32_u24 v14, 429497, v58
    v_lshrrev_b32 v12, 3, v62
    v_cos_f32 v9, v9
    v_lshlrev_b16 v13, 3, v62
    v_mad_i32_i24 v11, v14, s55, v58
    v_bitop3_b32 v12, v6, v13, v12 bitop3:0xca
    v_lshl_add_u32 v11, v11, 17, s40
    v_lshlrev_b16 v14, 8, v14
    v_lshrrev_b32 v13, 2, v62
    v_add_u32 v58, v12, v11
    v_bitop3_b32 v62, v5, v13, v14 bitop3:0xea
    ds_add_u32 v62, v2
    v_mul_hi_u32_u24 v14, 429497, v59
    v_lshrrev_b32 v12, 3, v63
    v_cos_f32 v10, v10
    v_lshlrev_b16 v13, 3, v63
    v_mad_i32_i24 v11, v14, s55, v59
    v_bitop3_b32 v12, v6, v13, v12 bitop3:0xca
    v_lshl_add_u32 v11, v11, 17, s40
    v_lshlrev_b16 v14, 8, v14
    v_lshrrev_b32 v13, 2, v63
    v_add_u32 v59, v12, v11
    v_bitop3_b32 v63, v5, v13, v14 bitop3:0xea
    ds_add_u32 v63, v2
    v_cvt_pk_bf16_f32 v65, v9, v10
    v_perm_b32 v12, v65, v65, s41
    v_bitop3_b32 v58, v4, v12, v58 bitop3:0xca
    v_perm_b32 v13, v65, v65, s42
    v_bitop3_b32 v59, v4, v13, v59 bitop3:0xca
    s_add_u32 s44, s33, 0x2000000
    buffer_load_dwordx4 v[96:99], v0, s[8:11], s44 offen nt
    s_add_u32 s45, s33, 0x2000000
    buffer_load_dwordx4 v[100:103], v0, s[12:15], s45 offen nt
    s_add_u32 s46, s34, 0x1000000
    buffer_load_dwordx2 v[104:105], v1, s[16:19], s46 offen nt
    s_add_u32 s47, s34, 0x1200000
    buffer_load_dwordx2 v[106:107], v1, s[16:19], s47 offen nt
    s_waitcnt vmcnt(10)
    v_lshlrev_b32 v7, 16, v66
    v_and_b32 v8, 0xffff0000, v66
    v_lshlrev_b32 v9, 16, v67
    v_and_b32 v10, 0xffff0000, v67
    v_mul_f32 v7, 0.15915494, v7
    v_mul_f32 v8, 0.15915494, v8
    v_mul_f32 v9, 0.15915494, v9
    v_mul_f32 v10, 0.15915494, v10
    v_mul_hi_u32_u24 v14, 429497, v68
    v_lshrrev_b32 v12, 3, v72
    v_cos_f32 v7, v7
    v_lshlrev_b16 v13, 3, v72
    v_mad_i32_i24 v11, v14, s55, v68
    v_bitop3_b32 v12, v6, v13, v12 bitop3:0xca
    v_lshl_add_u32 v11, v11, 17, s40
    v_lshlrev_b16 v14, 8, v14
    v_lshrrev_b32 v13, 2, v72
    v_add_u32 v68, v12, v11
    v_bitop3_b32 v72, v5, v13, v14 bitop3:0xea
    ds_add_u32 v72, v2
    v_mul_hi_u32_u24 v14, 429497, v69
    v_lshrrev_b32 v12, 3, v73
    v_cos_f32 v8, v8
    v_lshlrev_b16 v13, 3, v73
    v_mad_i32_i24 v11, v14, s55, v69
    v_bitop3_b32 v12, v6, v13, v12 bitop3:0xca
    v_lshl_add_u32 v11, v11, 17, s40
    v_lshlrev_b16 v14, 8, v14
    v_lshrrev_b32 v13, 2, v73
    v_add_u32 v69, v12, v11
    v_bitop3_b32 v73, v5, v13, v14 bitop3:0xea
    ds_add_u32 v73, v2
    v_cvt_pk_bf16_f32 v66, v7, v8
    v_perm_b32 v12, v66, v66, s41
    v_bitop3_b32 v68, v4, v12, v68 bitop3:0xca
    v_perm_b32 v13, v66, v66, s42
    v_bitop3_b32 v69, v4, v13, v69 bitop3:0xca
    v_mul_hi_u32_u24 v14, 429497, v70
    v_lshrrev_b32 v12, 3, v74
    v_cos_f32 v9, v9
    v_lshlrev_b16 v13, 3, v74
    v_mad_i32_i24 v11, v14, s55, v70
    v_bitop3_b32 v12, v6, v13, v12 bitop3:0xca
    v_lshl_add_u32 v11, v11, 17, s40
    v_lshlrev_b16 v14, 8, v14
    v_lshrrev_b32 v13, 2, v74
    v_add_u32 v70, v12, v11
    v_bitop3_b32 v74, v5, v13, v14 bitop3:0xea
    ds_add_u32 v74, v2
    v_mul_hi_u32_u24 v14, 429497, v71
    v_lshrrev_b32 v12, 3, v75
    v_cos_f32 v10, v10
    v_lshlrev_b16 v13, 3, v75
    v_mad_i32_i24 v11, v14, s55, v71
    v_bitop3_b32 v12, v6, v13, v12 bitop3:0xca
    v_lshl_add_u32 v11, v11, 17, s40
    v_lshlrev_b16 v14, 8, v14
    v_lshrrev_b32 v13, 2, v75
    v_add_u32 v71, v12, v11
    v_bitop3_b32 v75, v5, v13, v14 bitop3:0xea
    ds_add_u32 v75, v2
    v_cvt_pk_bf16_f32 v67, v9, v10
    v_perm_b32 v12, v67, v67, s41
    v_bitop3_b32 v70, v4, v12, v70 bitop3:0xca
    v_perm_b32 v13, v67, v67, s42
    v_bitop3_b32 v71, v4, v13, v71 bitop3:0xca
    s_add_u32 s44, s33, 0x2400000
    buffer_load_dwordx4 v[108:111], v0, s[8:11], s44 offen nt
    s_waitcnt vmcnt(7)
    v_lshlrev_b32 v7, 16, v84
    v_and_b32 v8, 0xffff0000, v84
    v_lshlrev_b32 v9, 16, v85
    v_and_b32 v10, 0xffff0000, v85
    v_mul_f32 v7, 0.15915494, v7
    v_mul_f32 v8, 0.15915494, v8
    v_mul_f32 v9, 0.15915494, v9
    v_mul_f32 v10, 0.15915494, v10
    v_mul_hi_u32_u24 v14, 429497, v76
    v_lshrrev_b32 v12, 3, v80
    v_cos_f32 v7, v7
    v_lshlrev_b16 v13, 3, v80
    v_mad_i32_i24 v11, v14, s55, v76
    v_bitop3_b32 v12, v6, v13, v12 bitop3:0xca
    v_lshl_add_u32 v11, v11, 17, s40
    v_lshlrev_b16 v14, 8, v14
    v_lshrrev_b32 v13, 2, v80
    v_add_u32 v76, v12, v11
    v_bitop3_b32 v80, v5, v13, v14 bitop3:0xea
    ds_add_u32 v80, v2
    v_mul_hi_u32_u24 v14, 429497, v77
    v_lshrrev_b32 v12, 3, v81
    v_cos_f32 v8, v8
    v_lshlrev_b16 v13, 3, v81
    v_mad_i32_i24 v11, v14, s55, v77
    v_bitop3_b32 v12, v6, v13, v12 bitop3:0xca
    v_lshl_add_u32 v11, v11, 17, s40
    v_lshlrev_b16 v14, 8, v14
    v_lshrrev_b32 v13, 2, v81
    v_add_u32 v77, v12, v11
    v_bitop3_b32 v81, v5, v13, v14 bitop3:0xea
    ds_add_u32 v81, v2
    v_cvt_pk_bf16_f32 v84, v7, v8
    v_perm_b32 v12, v84, v84, s41
    v_bitop3_b32 v76, v4, v12, v76 bitop3:0xca
    v_perm_b32 v13, v84, v84, s42
    v_bitop3_b32 v77, v4, v13, v77 bitop3:0xca
    v_mul_hi_u32_u24 v14, 429497, v78
    v_lshrrev_b32 v12, 3, v82
    v_cos_f32 v9, v9
    v_lshlrev_b16 v13, 3, v82
    v_mad_i32_i24 v11, v14, s55, v78
    v_bitop3_b32 v12, v6, v13, v12 bitop3:0xca
    v_lshl_add_u32 v11, v11, 17, s40
    v_lshlrev_b16 v14, 8, v14
    v_lshrrev_b32 v13, 2, v82
    v_add_u32 v78, v12, v11
    v_bitop3_b32 v82, v5, v13, v14 bitop3:0xea
    ds_add_u32 v82, v2
    v_mul_hi_u32_u24 v14, 429497, v79
    v_lshrrev_b32 v12, 3, v83
    v_cos_f32 v10, v10
    v_lshlrev_b16 v13, 3, v83
    v_mad_i32_i24 v11, v14, s55, v79
    v_bitop3_b32 v12, v6, v13, v12 bitop3:0xca
    v_lshl_add_u32 v11, v11, 17, s40
    v_lshlrev_b16 v14, 8, v14
    v_lshrrev_b32 v13, 2, v83
    v_add_u32 v79, v12, v11
    v_bitop3_b32 v83, v5, v13, v14 bitop3:0xea
    ds_add_u32 v83, v2
    v_cvt_pk_bf16_f32 v85, v9, v10
    v_perm_b32 v12, v85, v85, s41
    v_bitop3_b32 v78, v4, v12, v78 bitop3:0xca
    v_perm_b32 v13, v85, v85, s42
    v_bitop3_b32 v79, v4, v13, v79 bitop3:0xca
    s_waitcnt vmcnt(5)
    v_lshlrev_b32 v7, 16, v86
    v_and_b32 v8, 0xffff0000, v86
    v_lshlrev_b32 v9, 16, v87
    v_and_b32 v10, 0xffff0000, v87
    v_mul_f32 v7, 0.15915494, v7
    v_mul_f32 v8, 0.15915494, v8
    v_mul_f32 v9, 0.15915494, v9
    v_mul_f32 v10, 0.15915494, v10
    v_mul_hi_u32_u24 v14, 429497, v88
    v_lshrrev_b32 v12, 3, v92
    v_cos_f32 v7, v7
    v_lshlrev_b16 v13, 3, v92
    v_mad_i32_i24 v11, v14, s55, v88
    v_bitop3_b32 v12, v6, v13, v12 bitop3:0xca
    v_lshl_add_u32 v11, v11, 17, s40
    v_lshlrev_b16 v14, 8, v14
    v_lshrrev_b32 v13, 2, v92
    v_add_u32 v88, v12, v11
    v_bitop3_b32 v92, v5, v13, v14 bitop3:0xea
    ds_add_u32 v92, v2
    v_mul_hi_u32_u24 v14, 429497, v89
    v_lshrrev_b32 v12, 3, v93
    v_cos_f32 v8, v8
    v_lshlrev_b16 v13, 3, v93
    v_mad_i32_i24 v11, v14, s55, v89
    v_bitop3_b32 v12, v6, v13, v12 bitop3:0xca
    v_lshl_add_u32 v11, v11, 17, s40
    v_lshlrev_b16 v14, 8, v14
    v_lshrrev_b32 v13, 2, v93
    v_add_u32 v89, v12, v11
    v_bitop3_b32 v93, v5, v13, v14 bitop3:0xea
    ds_add_u32 v93, v2
    v_cvt_pk_bf16_f32 v86, v7, v8
    v_perm_b32 v12, v86, v86, s41
    v_bitop3_b32 v88, v4, v12, v88 bitop3:0xca
    v_perm_b32 v13, v86, v86, s42
    v_bitop3_b32 v89, v4, v13, v89 bitop3:0xca
    v_mul_hi_u32_u24 v14, 429497, v90
    v_lshrrev_b32 v12, 3, v94
    v_cos_f32 v9, v9
    v_lshlrev_b16 v13, 3, v94
    v_mad_i32_i24 v11, v14, s55, v90
    v_bitop3_b32 v12, v6, v13, v12 bitop3:0xca
    v_lshl_add_u32 v11, v11, 17, s40
    v_lshlrev_b16 v14, 8, v14
    v_lshrrev_b32 v13, 2, v94
    v_add_u32 v90, v12, v11
    v_bitop3_b32 v94, v5, v13, v14 bitop3:0xea
    ds_add_u32 v94, v2
    v_mul_hi_u32_u24 v14, 429497, v91
    v_lshrrev_b32 v12, 3, v95
    v_cos_f32 v10, v10
    v_lshlrev_b16 v13, 3, v95
    v_mad_i32_i24 v11, v14, s55, v91
    v_bitop3_b32 v12, v6, v13, v12 bitop3:0xca
    v_lshl_add_u32 v11, v11, 17, s40
    v_lshlrev_b16 v14, 8, v14
    v_lshrrev_b32 v13, 2, v95
    v_add_u32 v91, v12, v11
    v_bitop3_b32 v95, v5, v13, v14 bitop3:0xea
    ds_add_u32 v95, v2
    v_cvt_pk_bf16_f32 v87, v9, v10
    v_perm_b32 v12, v87, v87, s41
    v_bitop3_b32 v90, v4, v12, v90 bitop3:0xca
    v_perm_b32 v13, v87, v87, s42
    v_bitop3_b32 v91, v4, v13, v91 bitop3:0xca
    v_lshrrev_b32 v8, 2, v0
    v_and_b32 v7, 0x3c00, v0
    v_bitop3_b32 v7, v5, v8, v7 bitop3:0xea
    s_waitcnt lgkmcnt(0)
    s_barrier
    ds_read2st64_b32 v[8:9], v7 offset0:0 offset1:1
    ds_read2st64_b32 v[10:11], v7 offset0:2 offset1:3
    s_add_u32 s45, s33, 0x2400000
    buffer_load_dwordx4 v[112:115], v0, s[12:15], s45 offen nt
    s_waitcnt lgkmcnt(0)
    v_lshl_or_b32 v12, v9, 16, v8
    v_lshl_or_b32 v13, v11, 16, v10
    v_mov_b32 v14, v12
    v_mov_b32 v15, v13
    s_nop 0
    v_add_u32_dpp v14, v14, v14 row_shr:1 row_mask:0xf bank_mask:0xf bound_ctrl:1
    v_add_u32_dpp v15, v15, v15 row_shr:1 row_mask:0xf bank_mask:0xf bound_ctrl:1
    s_nop 0
    v_add_u32_dpp v14, v14, v14 row_shr:2 row_mask:0xf bank_mask:0xf bound_ctrl:1
    v_add_u32_dpp v15, v15, v15 row_shr:2 row_mask:0xf bank_mask:0xf bound_ctrl:1
    s_nop 0
    v_add_u32_dpp v14, v14, v14 row_shr:4 row_mask:0xf bank_mask:0xf bound_ctrl:1
    v_add_u32_dpp v15, v15, v15 row_shr:4 row_mask:0xf bank_mask:0xf bound_ctrl:1
    s_nop 0
    v_add_u32_dpp v14, v14, v14 row_shr:8 row_mask:0xf bank_mask:0xf bound_ctrl:1
    v_add_u32_dpp v15, v15, v15 row_shr:8 row_mask:0xf bank_mask:0xf bound_ctrl:1
    s_nop 0
    v_add_u32_dpp v14, v14, v14 row_bcast:15 row_mask:0xa bank_mask:0xf
    v_add_u32_dpp v15, v15, v15 row_bcast:15 row_mask:0xa bank_mask:0xf
    s_nop 0
    v_add_u32_dpp v14, v14, v14 row_bcast:31 row_mask:0xc bank_mask:0xf
    v_add_u32_dpp v15, v15, v15 row_bcast:31 row_mask:0xc bank_mask:0xf
    v_readlane_b32 s48, v14, 63
    v_readlane_b32 s49, v15, 63
    s_lshl_b32 s54, s32, 2
    v_mov_b32 v8, s54
    s_and_b32 s50, s48, 0xffff
    s_lshr_b32 s51, s48, 16
    s_and_b32 s52, s49, 0xffff
    s_lshr_b32 s53, s49, 16
    s_add_u32 s51, s51, s50
    s_add_u32 s52, s52, s51
    s_add_u32 s53, s53, s52
    v_mov_b32 v9, s53
    s_mov_b64 exec, 1
    ds_write_b32 v8, v9 offset:16384
    s_mov_b64 exec, -1
    v_and_b32 v8, 60, v7
    s_waitcnt lgkmcnt(0)
    s_barrier
    ds_read_b32 v9, v8 offset:16384
    s_waitcnt lgkmcnt(0)
    v_add_u32_dpp v9, v9, v9 row_shr:1 row_mask:0xf bank_mask:0xf bound_ctrl:1
    s_nop 1
    v_add_u32_dpp v9, v9, v9 row_shr:2 row_mask:0xf bank_mask:0xf bound_ctrl:1
    s_nop 1
    v_add_u32_dpp v9, v9, v9 row_shr:4 row_mask:0xf bank_mask:0xf bound_ctrl:1
    s_nop 1
    v_add_u32_dpp v9, v9, v9 row_shr:8 row_mask:0xf bank_mask:0xf bound_ctrl:1
    s_nop 0
    v_readlane_b32 s54, v9, s32
    s_sub_u32 s54, s54, s53
    s_add_u32 s50, s50, s54
    s_add_u32 s51, s51, s54
    s_add_u32 s52, s52, s54
    s_pack_ll_b32_b16 s48, s54, s50
    s_pack_ll_b32_b16 s49, s51, s52
    v_add_u32 v14, s48, v14
    v_add_u32 v15, s49, v15
    v_sub_u32 v12, v14, v12
    v_sub_u32 v13, v15, v13
    v_and_b32 v8, 0xffff, v12
    v_lshrrev_b32 v9, 16, v12
    v_and_b32 v10, 0xffff, v13
    v_lshrrev_b32 v11, 16, v13
    ds_write2st64_b32 v7, v8, v9 offset0:0 offset1:1
    ds_write2st64_b32 v7, v10, v11 offset0:2 offset1:3
    s_waitcnt lgkmcnt(0)
    s_barrier
    ds_add_rtn_u32 v20, v20, v2
    ds_add_rtn_u32 v21, v21, v2
    ds_add_rtn_u32 v22, v22, v2
    ds_add_rtn_u32 v23, v23, v2
    s_add_u32 s46, s36, 0x0
    v_and_b32 v11, 0x3f0, v0
    v_add_u32 v11, v11, v11
    buffer_store_dwordx2 v[12:13], v11, s[24:27], s46 offen
    s_bitset0_b64 exec, 63
    s_not_b64 exec, exec
    buffer_store_dwordx2 v[14:15], v11, s[24:27], s46 offen offset:32
    s_mov_b64 exec, -1
    v_cmp_le_u32 vcc, s37, v0
    v_add_u32 v10, 8320, v0
    s_cmp_lg_u32 s32, 0
    v_cndmask_b32 v10, v0, v10, vcc
    s_cbranch_scc1 L1_p1
    s_add_u32 s47, s35, 0x0
    s_mov_b64 exec, 0xff
    buffer_store_dwordx4 v[12:15], v10, s[24:27], s47 offen
    s_mov_b64 exec, -1
L1_p1:
    ds_add_rtn_u32 v32, v32, v2
    ds_add_rtn_u32 v33, v33, v2
    ds_add_rtn_u32 v34, v34, v2
    ds_add_rtn_u32 v35, v35, v2
    ds_add_rtn_u32 v40, v40, v2
    ds_add_rtn_u32 v41, v41, v2
    ds_add_rtn_u32 v42, v42, v2
    ds_add_rtn_u32 v43, v43, v2
    s_add_u32 s44, s33, 0x2800000
    buffer_load_dwordx4 v[116:119], v0, s[8:11], s44 offen nt
    ds_add_rtn_u32 v52, v52, v2
    ds_add_rtn_u32 v53, v53, v2
    ds_add_rtn_u32 v54, v54, v2
    ds_add_rtn_u32 v55, v55, v2
    ds_add_rtn_u32 v60, v60, v2
    ds_add_rtn_u32 v61, v61, v2
    ds_add_rtn_u32 v62, v62, v2
    ds_add_rtn_u32 v63, v63, v2
    ds_add_rtn_u32 v72, v72, v2
    ds_add_rtn_u32 v73, v73, v2
    ds_add_rtn_u32 v74, v74, v2
    ds_add_rtn_u32 v75, v75, v2
    s_add_u32 s45, s33, 0x2800000
    buffer_load_dwordx4 v[120:123], v0, s[12:15], s45 offen nt
    ds_add_rtn_u32 v80, v80, v2
    ds_add_rtn_u32 v81, v81, v2
    ds_add_rtn_u32 v82, v82, v2
    ds_add_rtn_u32 v83, v83, v2
    ds_add_rtn_u32 v92, v92, v2
    ds_add_rtn_u32 v93, v93, v2
    ds_add_rtn_u32 v94, v94, v2
    ds_add_rtn_u32 v95, v95, v2
    s_waitcnt lgkmcnt(0)
    s_barrier
    v_and_b32 v7, -4, v20
    v_lshl_add_u32 v8, v20, 2, v7
    ds_write_b32 v8, v16
    v_lshl_add_u32 v7, v7, 2, v20
    ds_write_b8 v7, v24 offset:16
    v_and_b32 v9, -4, v21
    v_lshl_add_u32 v10, v21, 2, v9
    ds_write_b32 v10, v17
    v_lshl_add_u32 v9, v9, 2, v21
    ds_write_b8_d16_hi v9, v24 offset:16
    v_and_b32 v7, -4, v22
    v_lshl_add_u32 v8, v22, 2, v7
    ds_write_b32 v8, v18
    v_lshl_add_u32 v7, v7, 2, v22
    ds_write_b8 v7, v25 offset:16
    v_and_b32 v9, -4, v23
    v_lshl_add_u32 v10, v23, 2, v9
    ds_write_b32 v10, v19
    v_lshl_add_u32 v9, v9, 2, v23
    ds_write_b8_d16_hi v9, v25 offset:16
    s_add_u32 s46, s34, 0x1400000
    buffer_load_dwordx2 v[124:125], v1, s[16:19], s46 offen nt
    s_add_u32 s47, s34, 0x1600000
    buffer_load_dwordx2 v[126:127], v1, s[16:19], s47 offen nt
    s_add_u32 s44, s33, 0x2c00000
    buffer_load_dwordx4 v[16:19], v0, s[8:11], s44 offen nt
    v_and_b32 v7, -4, v32
    v_lshl_add_u32 v8, v32, 2, v7
    ds_write_b32 v8, v28
    v_lshl_add_u32 v7, v7, 2, v32
    ds_write_b8 v7, v26 offset:16
    v_and_b32 v9, -4, v33
    v_lshl_add_u32 v10, v33, 2, v9
    ds_write_b32 v10, v29
    v_lshl_add_u32 v9, v9, 2, v33
    ds_write_b8_d16_hi v9, v26 offset:16
    v_and_b32 v7, -4, v34
    v_lshl_add_u32 v8, v34, 2, v7
    ds_write_b32 v8, v30
    v_lshl_add_u32 v7, v7, 2, v34
    ds_write_b8 v7, v27 offset:16
    v_and_b32 v9, -4, v35
    v_lshl_add_u32 v10, v35, 2, v9
    ds_write_b32 v10, v31
    v_lshl_add_u32 v9, v9, 2, v35
    ds_write_b8_d16_hi v9, v27 offset:16
    s_add_u32 s45, s33, 0x2c00000
    buffer_load_dwordx4 v[20:23], v0, s[12:15], s45 offen nt
    v_and_b32 v7, -4, v40
    v_lshl_add_u32 v8, v40, 2, v7
    ds_write_b32 v8, v36
    v_lshl_add_u32 v7, v7, 2, v40
    ds_write_b8 v7, v44 offset:16
    v_and_b32 v9, -4, v41
    v_lshl_add_u32 v10, v41, 2, v9
    ds_write_b32 v10, v37
    v_lshl_add_u32 v9, v9, 2, v41
    ds_write_b8_d16_hi v9, v44 offset:16
    v_and_b32 v7, -4, v42
    v_lshl_add_u32 v8, v42, 2, v7
    ds_write_b32 v8, v38
    v_lshl_add_u32 v7, v7, 2, v42
    ds_write_b8 v7, v45 offset:16
    v_and_b32 v9, -4, v43
    v_lshl_add_u32 v10, v43, 2, v9
    ds_write_b32 v10, v39
    v_lshl_add_u32 v9, v9, 2, v43
    ds_write_b8_d16_hi v9, v45 offset:16
    s_add_u32 s46, s33, 0x3000000
    buffer_load_dwordx4 v[28:31], v0, s[8:11], s46 offen nt
    s_add_u32 s47, s33, 0x3000000
    buffer_load_dwordx4 v[32:35], v0, s[12:15], s47 offen nt
    v_and_b32 v7, -4, v52
    v_lshl_add_u32 v8, v52, 2, v7
    ds_write_b32 v8, v48
    v_lshl_add_u32 v7, v7, 2, v52
    ds_write_b8 v7, v46 offset:16
    v_and_b32 v9, -4, v53
    v_lshl_add_u32 v10, v53, 2, v9
    ds_write_b32 v10, v49
    v_lshl_add_u32 v9, v9, 2, v53
    ds_write_b8_d16_hi v9, v46 offset:16
    v_and_b32 v7, -4, v54
    v_lshl_add_u32 v8, v54, 2, v7
    ds_write_b32 v8, v50
    v_lshl_add_u32 v7, v7, 2, v54
    ds_write_b8 v7, v47 offset:16
    v_and_b32 v9, -4, v55
    v_lshl_add_u32 v10, v55, 2, v9
    ds_write_b32 v10, v51
    v_lshl_add_u32 v9, v9, 2, v55
    ds_write_b8_d16_hi v9, v47 offset:16
    s_add_u32 s44, s34, 0x1800000
    buffer_load_dwordx2 v[24:25], v1, s[16:19], s44 offen nt
    s_add_u32 s45, s34, 0x1a00000
    buffer_load_dwordx2 v[26:27], v1, s[16:19], s45 offen nt
    v_and_b32 v7, -4, v60
    v_lshl_add_u32 v8, v60, 2, v7
    ds_write_b32 v8, v56
    v_lshl_add_u32 v7, v7, 2, v60
    ds_write_b8 v7, v64 offset:16
    v_and_b32 v9, -4, v61
    v_lshl_add_u32 v10, v61, 2, v9
    ds_write_b32 v10, v57
    v_lshl_add_u32 v9, v9, 2, v61
    ds_write_b8_d16_hi v9, v64 offset:16
    v_and_b32 v7, -4, v62
    v_lshl_add_u32 v8, v62, 2, v7
    ds_write_b32 v8, v58
    v_lshl_add_u32 v7, v7, 2, v62
    ds_write_b8 v7, v65 offset:16
    v_and_b32 v9, -4, v63
    v_lshl_add_u32 v10, v63, 2, v9
    ds_write_b32 v10, v59
    v_lshl_add_u32 v9, v9, 2, v63
    ds_write_b8_d16_hi v9, v65 offset:16
    s_add_u32 s46, s33, 0x3400000
    buffer_load_dwordx4 v[36:39], v0, s[8:11], s46 offen nt
    v_and_b32 v7, -4, v72
    v_lshl_add_u32 v8, v72, 2, v7
    ds_write_b32 v8, v68
    v_lshl_add_u32 v7, v7, 2, v72
    ds_write_b8 v7, v66 offset:16
    v_and_b32 v9, -4, v73
    v_lshl_add_u32 v10, v73, 2, v9
    ds_write_b32 v10, v69
    v_lshl_add_u32 v9, v9, 2, v73
    ds_write_b8_d16_hi v9, v66 offset:16
    v_and_b32 v7, -4, v74
    v_lshl_add_u32 v8, v74, 2, v7
    ds_write_b32 v8, v70
    v_lshl_add_u32 v7, v7, 2, v74
    ds_write_b8 v7, v67 offset:16
    v_and_b32 v9, -4, v75
    v_lshl_add_u32 v10, v75, 2, v9
    ds_write_b32 v10, v71
    v_lshl_add_u32 v9, v9, 2, v75
    ds_write_b8_d16_hi v9, v67 offset:16
    s_add_u32 s47, s33, 0x3400000
    buffer_load_dwordx4 v[40:43], v0, s[12:15], s47 offen nt
    s_add_u32 s44, s33, 0x3800000
    buffer_load_dwordx4 v[48:51], v0, s[8:11], s44 offen nt
    v_and_b32 v7, -4, v80
    v_lshl_add_u32 v8, v80, 2, v7
    ds_write_b32 v8, v76
    v_lshl_add_u32 v7, v7, 2, v80
    ds_write_b8 v7, v84 offset:16
    v_and_b32 v9, -4, v81
    v_lshl_add_u32 v10, v81, 2, v9
    ds_write_b32 v10, v77
    v_lshl_add_u32 v9, v9, 2, v81
    ds_write_b8_d16_hi v9, v84 offset:16
    v_and_b32 v7, -4, v82
    v_lshl_add_u32 v8, v82, 2, v7
    ds_write_b32 v8, v78
    v_lshl_add_u32 v7, v7, 2, v82
    ds_write_b8 v7, v85 offset:16
    v_and_b32 v9, -4, v83
    v_lshl_add_u32 v10, v83, 2, v9
    ds_write_b32 v10, v79
    v_lshl_add_u32 v9, v9, 2, v83
    ds_write_b8_d16_hi v9, v85 offset:16
    s_add_u32 s45, s33, 0x3800000
    buffer_load_dwordx4 v[52:55], v0, s[12:15], s45 offen nt
    v_and_b32 v7, -4, v92
    v_lshl_add_u32 v8, v92, 2, v7
    ds_write_b32 v8, v88
    v_lshl_add_u32 v7, v7, 2, v92
    ds_write_b8 v7, v86 offset:16
    v_and_b32 v9, -4, v93
    v_lshl_add_u32 v10, v93, 2, v9
    ds_write_b32 v10, v89
    v_lshl_add_u32 v9, v9, 2, v93
    ds_write_b8_d16_hi v9, v86 offset:16
    v_and_b32 v7, -4, v94
    v_lshl_add_u32 v8, v94, 2, v7
    ds_write_b32 v8, v90
    v_lshl_add_u32 v7, v7, 2, v94
    ds_write_b8 v7, v87 offset:16
    v_and_b32 v9, -4, v95
    v_lshl_add_u32 v10, v95, 2, v9
    ds_write_b32 v10, v91
    v_lshl_add_u32 v9, v9, 2, v95
    ds_write_b8_d16_hi v9, v87 offset:16
    s_add_u32 s46, s34, 0x1c00000
    buffer_load_dwordx2 v[44:45], v1, s[16:19], s46 offen nt
    s_add_u32 s47, s34, 0x1e00000
    buffer_load_dwordx2 v[46:47], v1, s[16:19], s47 offen nt
    v_add_u32 v7, 0x10000, v0
    v_add_u32 v12, 0x20000, v0
    v_mov_b32 v8, 0
    v_mov_b32 v9, 0
    v_mov_b32 v10, 0
    v_mov_b32 v11, 0
    s_waitcnt lgkmcnt(0)
    s_barrier
    ds_read_b128 v[56:59], v0 offset:0
    ds_write_b128 v0, v[8:11]
    ds_read_b128 v[60:63], v0 offset:16384
    ds_read_b128 v[68:71], v0 offset:32768
    ds_read_b128 v[72:75], v0 offset:49152
    ds_read_b128 v[64:67], v7 offset:0
    ds_read_b128 v[76:79], v7 offset:16384
    ds_read_b128 v[80:83], v7 offset:32768
    ds_read_b128 v[88:91], v7 offset:49152
    ds_read_b128 v[92:95], v12 offset:0
    ds_read_b128 v[84:87], v12 offset:16384
    s_waitcnt lgkmcnt(0)
    s_barrier
    s_add_u32 s44, s35, 0x0
    buffer_store_dwordx4 v[56:59], v0, s[20:23], s44 offen sc1
    s_add_u32 s45, s33, 0x3c00000
    s_nop 0
    buffer_load_dwordx4 v[56:59], v0, s[8:11], s45 offen nt
    s_add_u32 s46, s35, 0x4000
    buffer_store_dwordx4 v[60:63], v0, s[20:23], s46 offen sc1
    s_add_u32 s47, s33, 0x3c00000
    s_nop 0
    buffer_load_dwordx4 v[60:63], v0, s[12:15], s47 offen nt
    s_waitcnt vmcnt(24)
    v_lshlrev_b32 v7, 16, v104
    v_and_b32 v8, 0xffff0000, v104
    v_lshlrev_b32 v9, 16, v105
    v_and_b32 v10, 0xffff0000, v105
    v_mul_f32 v7, 0.15915494, v7
    v_mul_f32 v8, 0.15915494, v8
    v_mul_f32 v9, 0.15915494, v9
    v_mul_f32 v10, 0.15915494, v10
    v_mul_hi_u32_u24 v14, 429497, v96
    v_lshrrev_b32 v12, 3, v100
    v_cos_f32 v7, v7
    v_lshlrev_b16 v13, 3, v100
    v_mad_i32_i24 v11, v14, s55, v96
    v_bitop3_b32 v12, v6, v13, v12 bitop3:0xca
    v_lshl_add_u32 v11, v11, 17, s40
    v_lshlrev_b16 v14, 8, v14
    v_lshrrev_b32 v13, 2, v100
    v_add_u32 v96, v12, v11
    v_bitop3_b32 v100, v5, v13, v14 bitop3:0xea
    ds_add_u32 v100, v2
    v_mul_hi_u32_u24 v14, 429497, v97
    v_lshrrev_b32 v12, 3, v101
    v_cos_f32 v8, v8
    v_lshlrev_b16 v13, 3, v101
    v_mad_i32_i24 v11, v14, s55, v97
    v_bitop3_b32 v12, v6, v13, v12 bitop3:0xca
    v_lshl_add_u32 v11, v11, 17, s40
    v_lshlrev_b16 v14, 8, v14
    v_lshrrev_b32 v13, 2, v101
    v_add_u32 v97, v12, v11
    v_bitop3_b32 v101, v5, v13, v14 bitop3:0xea
    ds_add_u32 v101, v2
    v_cvt_pk_bf16_f32 v104, v7, v8
    v_perm_b32 v12, v104, v104, s41
    v_bitop3_b32 v96, v4, v12, v96 bitop3:0xca
    v_perm_b32 v13, v104, v104, s42
    v_bitop3_b32 v97, v4, v13, v97 bitop3:0xca
    v_mul_hi_u32_u24 v14, 429497, v98
    v_lshrrev_b32 v12, 3, v102
    v_cos_f32 v9, v9
    v_lshlrev_b16 v13, 3, v102
    v_mad_i32_i24 v11, v14, s55, v98
    v_bitop3_b32 v12, v6, v13, v12 bitop3:0xca
    v_lshl_add_u32 v11, v11, 17, s40
    v_lshlrev_b16 v14, 8, v14
    v_lshrrev_b32 v13, 2, v102
    v_add_u32 v98, v12, v11
    v_bitop3_b32 v102, v5, v13, v14 bitop3:0xea
    ds_add_u32 v102, v2
    v_mul_hi_u32_u24 v14, 429497, v99
    v_lshrrev_b32 v12, 3, v103
    v_cos_f32 v10, v10
    v_lshlrev_b16 v13, 3, v103
    v_mad_i32_i24 v11, v14, s55, v99
    v_bitop3_b32 v12, v6, v13, v12 bitop3:0xca
    v_lshl_add_u32 v11, v11, 17, s40
    v_lshlrev_b16 v14, 8, v14
    v_lshrrev_b32 v13, 2, v103
    v_add_u32 v99, v12, v11
    v_bitop3_b32 v103, v5, v13, v14 bitop3:0xea
    ds_add_u32 v103, v2
    v_cvt_pk_bf16_f32 v105, v9, v10
    v_perm_b32 v12, v105, v105, s41
    v_bitop3_b32 v98, v4, v12, v98 bitop3:0xca
    v_perm_b32 v13, v105, v105, s42
    v_bitop3_b32 v99, v4, v13, v99 bitop3:0xca
    s_waitcnt vmcnt(22)
    v_lshlrev_b32 v7, 16, v106
    v_and_b32 v8, 0xffff0000, v106
    v_lshlrev_b32 v9, 16, v107
    v_and_b32 v10, 0xffff0000, v107
    v_mul_f32 v7, 0.15915494, v7
    v_mul_f32 v8, 0.15915494, v8
    v_mul_f32 v9, 0.15915494, v9
    v_mul_f32 v10, 0.15915494, v10
    v_mul_hi_u32_u24 v14, 429497, v108
    v_lshrrev_b32 v12, 3, v112
    v_cos_f32 v7, v7
    v_lshlrev_b16 v13, 3, v112
    v_mad_i32_i24 v11, v14, s55, v108
    v_bitop3_b32 v12, v6, v13, v12 bitop3:0xca
    v_lshl_add_u32 v11, v11, 17, s40
    v_lshlrev_b16 v14, 8, v14
    v_lshrrev_b32 v13, 2, v112
    v_add_u32 v108, v12, v11
    v_bitop3_b32 v112, v5, v13, v14 bitop3:0xea
    ds_add_u32 v112, v2
    v_mul_hi_u32_u24 v14, 429497, v109
    v_lshrrev_b32 v12, 3, v113
    v_cos_f32 v8, v8
    v_lshlrev_b16 v13, 3, v113
    v_mad_i32_i24 v11, v14, s55, v109
    v_bitop3_b32 v12, v6, v13, v12 bitop3:0xca
    v_lshl_add_u32 v11, v11, 17, s40
    v_lshlrev_b16 v14, 8, v14
    v_lshrrev_b32 v13, 2, v113
    v_add_u32 v109, v12, v11
    v_bitop3_b32 v113, v5, v13, v14 bitop3:0xea
    ds_add_u32 v113, v2
    v_cvt_pk_bf16_f32 v106, v7, v8
    v_perm_b32 v12, v106, v106, s41
    v_bitop3_b32 v108, v4, v12, v108 bitop3:0xca
    v_perm_b32 v13, v106, v106, s42
    v_bitop3_b32 v109, v4, v13, v109 bitop3:0xca
    v_mul_hi_u32_u24 v14, 429497, v110
    v_lshrrev_b32 v12, 3, v114
    v_cos_f32 v9, v9
    v_lshlrev_b16 v13, 3, v114
    v_mad_i32_i24 v11, v14, s55, v110
    v_bitop3_b32 v12, v6, v13, v12 bitop3:0xca
    v_lshl_add_u32 v11, v11, 17, s40
    v_lshlrev_b16 v14, 8, v14
    v_lshrrev_b32 v13, 2, v114
    v_add_u32 v110, v12, v11
    v_bitop3_b32 v114, v5, v13, v14 bitop3:0xea
    ds_add_u32 v114, v2
    v_mul_hi_u32_u24 v14, 429497, v111
    v_lshrrev_b32 v12, 3, v115
    v_cos_f32 v10, v10
    v_lshlrev_b16 v13, 3, v115
    v_mad_i32_i24 v11, v14, s55, v111
    v_bitop3_b32 v12, v6, v13, v12 bitop3:0xca
    v_lshl_add_u32 v11, v11, 17, s40
    v_lshlrev_b16 v14, 8, v14
    v_lshrrev_b32 v13, 2, v115
    v_add_u32 v111, v12, v11
    v_bitop3_b32 v115, v5, v13, v14 bitop3:0xea
    ds_add_u32 v115, v2
    v_cvt_pk_bf16_f32 v107, v9, v10
    v_perm_b32 v12, v107, v107, s41
    v_bitop3_b32 v110, v4, v12, v110 bitop3:0xca
    v_perm_b32 v13, v107, v107, s42
    v_bitop3_b32 v111, v4, v13, v111 bitop3:0xca
    s_waitcnt vmcnt(16)
    v_lshlrev_b32 v7, 16, v124
    v_and_b32 v8, 0xffff0000, v124
    v_lshlrev_b32 v9, 16, v125
    v_and_b32 v10, 0xffff0000, v125
    v_mul_f32 v7, 0.15915494, v7
    v_mul_f32 v8, 0.15915494, v8
    v_mul_f32 v9, 0.15915494, v9
    v_mul_f32 v10, 0.15915494, v10
    v_mul_hi_u32_u24 v14, 429497, v116
    v_lshrrev_b32 v12, 3, v120
    v_cos_f32 v7, v7
    v_lshlrev_b16 v13, 3, v120
    v_mad_i32_i24 v11, v14, s55, v116
    v_bitop3_b32 v12, v6, v13, v12 bitop3:0xca
    v_lshl_add_u32 v11, v11, 17, s40
    v_lshlrev_b16 v14, 8, v14
    v_lshrrev_b32 v13, 2, v120
    v_add_u32 v116, v12, v11
    v_bitop3_b32 v120, v5, v13, v14 bitop3:0xea
    ds_add_u32 v120, v2
    v_mul_hi_u32_u24 v14, 429497, v117
    v_lshrrev_b32 v12, 3, v121
    v_cos_f32 v8, v8
    v_lshlrev_b16 v13, 3, v121
    v_mad_i32_i24 v11, v14, s55, v117
    v_bitop3_b32 v12, v6, v13, v12 bitop3:0xca
    v_lshl_add_u32 v11, v11, 17, s40
    v_lshlrev_b16 v14, 8, v14
    v_lshrrev_b32 v13, 2, v121
    v_add_u32 v117, v12, v11
    v_bitop3_b32 v121, v5, v13, v14 bitop3:0xea
    ds_add_u32 v121, v2
    v_cvt_pk_bf16_f32 v124, v7, v8
    v_perm_b32 v12, v124, v124, s41
    v_bitop3_b32 v116, v4, v12, v116 bitop3:0xca
    v_perm_b32 v13, v124, v124, s42
    v_bitop3_b32 v117, v4, v13, v117 bitop3:0xca
    v_mul_hi_u32_u24 v14, 429497, v118
    v_lshrrev_b32 v12, 3, v122
    v_cos_f32 v9, v9
    v_lshlrev_b16 v13, 3, v122
    v_mad_i32_i24 v11, v14, s55, v118
    v_bitop3_b32 v12, v6, v13, v12 bitop3:0xca
    v_lshl_add_u32 v11, v11, 17, s40
    v_lshlrev_b16 v14, 8, v14
    v_lshrrev_b32 v13, 2, v122
    v_add_u32 v118, v12, v11
    v_bitop3_b32 v122, v5, v13, v14 bitop3:0xea
    ds_add_u32 v122, v2
    v_mul_hi_u32_u24 v14, 429497, v119
    v_lshrrev_b32 v12, 3, v123
    v_cos_f32 v10, v10
    v_lshlrev_b16 v13, 3, v123
    v_mad_i32_i24 v11, v14, s55, v119
    v_bitop3_b32 v12, v6, v13, v12 bitop3:0xca
    v_lshl_add_u32 v11, v11, 17, s40
    v_lshlrev_b16 v14, 8, v14
    v_lshrrev_b32 v13, 2, v123
    v_add_u32 v119, v12, v11
    v_bitop3_b32 v123, v5, v13, v14 bitop3:0xea
    ds_add_u32 v123, v2
    v_cvt_pk_bf16_f32 v125, v9, v10
    v_perm_b32 v12, v125, v125, s41
    v_bitop3_b32 v118, v4, v12, v118 bitop3:0xca
    v_perm_b32 v13, v125, v125, s42
    v_bitop3_b32 v119, v4, v13, v119 bitop3:0xca
    s_add_u32 s44, s35, 0x8000
    buffer_store_dwordx4 v[68:71], v0, s[20:23], s44 offen sc1
    s_add_u32 s45, s33, 0x4000000
    s_nop 0
    buffer_load_dwordx4 v[68:71], v0, s[8:11], s45 offen nt
    s_waitcnt vmcnt(16)
    v_lshlrev_b32 v7, 16, v126
    v_and_b32 v8, 0xffff0000, v126
    v_lshlrev_b32 v9, 16, v127
    v_and_b32 v10, 0xffff0000, v127
    v_mul_f32 v7, 0.15915494, v7
    v_mul_f32 v8, 0.15915494, v8
    v_mul_f32 v9, 0.15915494, v9
    v_mul_f32 v10, 0.15915494, v10
    v_mul_hi_u32_u24 v14, 429497, v16
    v_lshrrev_b32 v12, 3, v20
    v_cos_f32 v7, v7
    v_lshlrev_b16 v13, 3, v20
    v_mad_i32_i24 v11, v14, s55, v16
    v_bitop3_b32 v12, v6, v13, v12 bitop3:0xca
    v_lshl_add_u32 v11, v11, 17, s40
    v_lshlrev_b16 v14, 8, v14
    v_lshrrev_b32 v13, 2, v20
    v_add_u32 v16, v12, v11
    v_bitop3_b32 v20, v5, v13, v14 bitop3:0xea
    ds_add_u32 v20, v2
    v_mul_hi_u32_u24 v14, 429497, v17
    v_lshrrev_b32 v12, 3, v21
    v_cos_f32 v8, v8
    v_lshlrev_b16 v13, 3, v21
    v_mad_i32_i24 v11, v14, s55, v17
    v_bitop3_b32 v12, v6, v13, v12 bitop3:0xca
    v_lshl_add_u32 v11, v11, 17, s40
    v_lshlrev_b16 v14, 8, v14
    v_lshrrev_b32 v13, 2, v21
    v_add_u32 v17, v12, v11
    v_bitop3_b32 v21, v5, v13, v14 bitop3:0xea
    ds_add_u32 v21, v2
    v_cvt_pk_bf16_f32 v126, v7, v8
    v_perm_b32 v12, v126, v126, s41
    v_bitop3_b32 v16, v4, v12, v16 bitop3:0xca
    v_perm_b32 v13, v126, v126, s42
    v_bitop3_b32 v17, v4, v13, v17 bitop3:0xca
    v_mul_hi_u32_u24 v14, 429497, v18
    v_lshrrev_b32 v12, 3, v22
    v_cos_f32 v9, v9
    v_lshlrev_b16 v13, 3, v22
    v_mad_i32_i24 v11, v14, s55, v18
    v_bitop3_b32 v12, v6, v13, v12 bitop3:0xca
    v_lshl_add_u32 v11, v11, 17, s40
    v_lshlrev_b16 v14, 8, v14
    v_lshrrev_b32 v13, 2, v22
    v_add_u32 v18, v12, v11
    v_bitop3_b32 v22, v5, v13, v14 bitop3:0xea
    ds_add_u32 v22, v2
    v_mul_hi_u32_u24 v14, 429497, v19
    v_lshrrev_b32 v12, 3, v23
    v_cos_f32 v10, v10
    v_lshlrev_b16 v13, 3, v23
    v_mad_i32_i24 v11, v14, s55, v19
    v_bitop3_b32 v12, v6, v13, v12 bitop3:0xca
    v_lshl_add_u32 v11, v11, 17, s40
    v_lshlrev_b16 v14, 8, v14
    v_lshrrev_b32 v13, 2, v23
    v_add_u32 v19, v12, v11
    v_bitop3_b32 v23, v5, v13, v14 bitop3:0xea
    ds_add_u32 v23, v2
    v_cvt_pk_bf16_f32 v127, v9, v10
    v_perm_b32 v12, v127, v127, s41
    v_bitop3_b32 v18, v4, v12, v18 bitop3:0xca
    v_perm_b32 v13, v127, v127, s42
    v_bitop3_b32 v19, v4, v13, v19 bitop3:0xca
    s_waitcnt vmcnt(12)
    v_lshlrev_b32 v7, 16, v24
    v_and_b32 v8, 0xffff0000, v24
    v_lshlrev_b32 v9, 16, v25
    v_and_b32 v10, 0xffff0000, v25
    v_mul_f32 v7, 0.15915494, v7
    v_mul_f32 v8, 0.15915494, v8
    v_mul_f32 v9, 0.15915494, v9
    v_mul_f32 v10, 0.15915494, v10
    v_mul_hi_u32_u24 v14, 429497, v28
    v_lshrrev_b32 v12, 3, v32
    v_cos_f32 v7, v7
    v_lshlrev_b16 v13, 3, v32
    v_mad_i32_i24 v11, v14, s55, v28
    v_bitop3_b32 v12, v6, v13, v12 bitop3:0xca
    v_lshl_add_u32 v11, v11, 17, s40
    v_lshlrev_b16 v14, 8, v14
    v_lshrrev_b32 v13, 2, v32
    v_add_u32 v28, v12, v11
    v_bitop3_b32 v32, v5, v13, v14 bitop3:0xea
    ds_add_u32 v32, v2
    v_mul_hi_u32_u24 v14, 429497, v29
    v_lshrrev_b32 v12, 3, v33
    v_cos_f32 v8, v8
    v_lshlrev_b16 v13, 3, v33
    v_mad_i32_i24 v11, v14, s55, v29
    v_bitop3_b32 v12, v6, v13, v12 bitop3:0xca
    v_lshl_add_u32 v11, v11, 17, s40
    v_lshlrev_b16 v14, 8, v14
    v_lshrrev_b32 v13, 2, v33
    v_add_u32 v29, v12, v11
    v_bitop3_b32 v33, v5, v13, v14 bitop3:0xea
    ds_add_u32 v33, v2
    v_cvt_pk_bf16_f32 v24, v7, v8
    v_perm_b32 v12, v24, v24, s41
    v_bitop3_b32 v28, v4, v12, v28 bitop3:0xca
    v_perm_b32 v13, v24, v24, s42
    v_bitop3_b32 v29, v4, v13, v29 bitop3:0xca
    v_mul_hi_u32_u24 v14, 429497, v30
    v_lshrrev_b32 v12, 3, v34
    v_cos_f32 v9, v9
    v_lshlrev_b16 v13, 3, v34
    v_mad_i32_i24 v11, v14, s55, v30
    v_bitop3_b32 v12, v6, v13, v12 bitop3:0xca
    v_lshl_add_u32 v11, v11, 17, s40
    v_lshlrev_b16 v14, 8, v14
    v_lshrrev_b32 v13, 2, v34
    v_add_u32 v30, v12, v11
    v_bitop3_b32 v34, v5, v13, v14 bitop3:0xea
    ds_add_u32 v34, v2
    v_mul_hi_u32_u24 v14, 429497, v31
    v_lshrrev_b32 v12, 3, v35
    v_cos_f32 v10, v10
    v_lshlrev_b16 v13, 3, v35
    v_mad_i32_i24 v11, v14, s55, v31
    v_bitop3_b32 v12, v6, v13, v12 bitop3:0xca
    v_lshl_add_u32 v11, v11, 17, s40
    v_lshlrev_b16 v14, 8, v14
    v_lshrrev_b32 v13, 2, v35
    v_add_u32 v31, v12, v11
    v_bitop3_b32 v35, v5, v13, v14 bitop3:0xea
    ds_add_u32 v35, v2
    v_cvt_pk_bf16_f32 v25, v9, v10
    v_perm_b32 v12, v25, v25, s41
    v_bitop3_b32 v30, v4, v12, v30 bitop3:0xca
    v_perm_b32 v13, v25, v25, s42
    v_bitop3_b32 v31, v4, v13, v31 bitop3:0xca
    s_waitcnt vmcnt(10)
    v_lshlrev_b32 v7, 16, v26
    v_and_b32 v8, 0xffff0000, v26
    v_lshlrev_b32 v9, 16, v27
    v_and_b32 v10, 0xffff0000, v27
    v_mul_f32 v7, 0.15915494, v7
    v_mul_f32 v8, 0.15915494, v8
    v_mul_f32 v9, 0.15915494, v9
    v_mul_f32 v10, 0.15915494, v10
    v_mul_hi_u32_u24 v14, 429497, v36
    v_lshrrev_b32 v12, 3, v40
    v_cos_f32 v7, v7
    v_lshlrev_b16 v13, 3, v40
    v_mad_i32_i24 v11, v14, s55, v36
    v_bitop3_b32 v12, v6, v13, v12 bitop3:0xca
    v_lshl_add_u32 v11, v11, 17, s40
    v_lshlrev_b16 v14, 8, v14
    v_lshrrev_b32 v13, 2, v40
    v_add_u32 v36, v12, v11
    v_bitop3_b32 v40, v5, v13, v14 bitop3:0xea
    ds_add_u32 v40, v2
    v_mul_hi_u32_u24 v14, 429497, v37
    v_lshrrev_b32 v12, 3, v41
    v_cos_f32 v8, v8
    v_lshlrev_b16 v13, 3, v41
    v_mad_i32_i24 v11, v14, s55, v37
    v_bitop3_b32 v12, v6, v13, v12 bitop3:0xca
    v_lshl_add_u32 v11, v11, 17, s40
    v_lshlrev_b16 v14, 8, v14
    v_lshrrev_b32 v13, 2, v41
    v_add_u32 v37, v12, v11
    v_bitop3_b32 v41, v5, v13, v14 bitop3:0xea
    ds_add_u32 v41, v2
    v_cvt_pk_bf16_f32 v26, v7, v8
    v_perm_b32 v12, v26, v26, s41
    v_bitop3_b32 v36, v4, v12, v36 bitop3:0xca
    v_perm_b32 v13, v26, v26, s42
    v_bitop3_b32 v37, v4, v13, v37 bitop3:0xca
    v_mul_hi_u32_u24 v14, 429497, v38
    v_lshrrev_b32 v12, 3, v42
    v_cos_f32 v9, v9
    v_lshlrev_b16 v13, 3, v42
    v_mad_i32_i24 v11, v14, s55, v38
    v_bitop3_b32 v12, v6, v13, v12 bitop3:0xca
    v_lshl_add_u32 v11, v11, 17, s40
    v_lshlrev_b16 v14, 8, v14
    v_lshrrev_b32 v13, 2, v42
    v_add_u32 v38, v12, v11
    v_bitop3_b32 v42, v5, v13, v14 bitop3:0xea
    ds_add_u32 v42, v2
    v_mul_hi_u32_u24 v14, 429497, v39
    v_lshrrev_b32 v12, 3, v43
    v_cos_f32 v10, v10
    v_lshlrev_b16 v13, 3, v43
    v_mad_i32_i24 v11, v14, s55, v39
    v_bitop3_b32 v12, v6, v13, v12 bitop3:0xca
    v_lshl_add_u32 v11, v11, 17, s40
    v_lshlrev_b16 v14, 8, v14
    v_lshrrev_b32 v13, 2, v43
    v_add_u32 v39, v12, v11
    v_bitop3_b32 v43, v5, v13, v14 bitop3:0xea
    ds_add_u32 v43, v2
    v_cvt_pk_bf16_f32 v27, v9, v10
    v_perm_b32 v12, v27, v27, s41
    v_bitop3_b32 v38, v4, v12, v38 bitop3:0xca
    v_perm_b32 v13, v27, v27, s42
    v_bitop3_b32 v39, v4, v13, v39 bitop3:0xca
    s_add_u32 s46, s35, 0xc000
    buffer_store_dwordx4 v[72:75], v0, s[20:23], s46 offen sc1
    s_add_u32 s47, s33, 0x4000000
    s_nop 0
    buffer_load_dwordx4 v[72:75], v0, s[12:15], s47 offen nt
    s_waitcnt vmcnt(8)
    v_lshlrev_b32 v7, 16, v44
    v_and_b32 v8, 0xffff0000, v44
    v_lshlrev_b32 v9, 16, v45
    v_and_b32 v10, 0xffff0000, v45
    v_mul_f32 v7, 0.15915494, v7
    v_mul_f32 v8, 0.15915494, v8
    v_mul_f32 v9, 0.15915494, v9
    v_mul_f32 v10, 0.15915494, v10
    v_mul_hi_u32_u24 v14, 429497, v48
    v_lshrrev_b32 v12, 3, v52
    v_cos_f32 v7, v7
    v_lshlrev_b16 v13, 3, v52
    v_mad_i32_i24 v11, v14, s55, v48
    v_bitop3_b32 v12, v6, v13, v12 bitop3:0xca
    v_lshl_add_u32 v11, v11, 17, s40
    v_lshlrev_b16 v14, 8, v14
    v_lshrrev_b32 v13, 2, v52
    v_add_u32 v48, v12, v11
    v_bitop3_b32 v52, v5, v13, v14 bitop3:0xea
    ds_add_u32 v52, v2
    v_mul_hi_u32_u24 v14, 429497, v49
    v_lshrrev_b32 v12, 3, v53
    v_cos_f32 v8, v8
    v_lshlrev_b16 v13, 3, v53
    v_mad_i32_i24 v11, v14, s55, v49
    v_bitop3_b32 v12, v6, v13, v12 bitop3:0xca
    v_lshl_add_u32 v11, v11, 17, s40
    v_lshlrev_b16 v14, 8, v14
    v_lshrrev_b32 v13, 2, v53
    v_add_u32 v49, v12, v11
    v_bitop3_b32 v53, v5, v13, v14 bitop3:0xea
    ds_add_u32 v53, v2
    v_cvt_pk_bf16_f32 v44, v7, v8
    v_perm_b32 v12, v44, v44, s41
    v_bitop3_b32 v48, v4, v12, v48 bitop3:0xca
    v_perm_b32 v13, v44, v44, s42
    v_bitop3_b32 v49, v4, v13, v49 bitop3:0xca
    v_mul_hi_u32_u24 v14, 429497, v50
    v_lshrrev_b32 v12, 3, v54
    v_cos_f32 v9, v9
    v_lshlrev_b16 v13, 3, v54
    v_mad_i32_i24 v11, v14, s55, v50
    v_bitop3_b32 v12, v6, v13, v12 bitop3:0xca
    v_lshl_add_u32 v11, v11, 17, s40
    v_lshlrev_b16 v14, 8, v14
    v_lshrrev_b32 v13, 2, v54
    v_add_u32 v50, v12, v11
    v_bitop3_b32 v54, v5, v13, v14 bitop3:0xea
    ds_add_u32 v54, v2
    v_mul_hi_u32_u24 v14, 429497, v51
    v_lshrrev_b32 v12, 3, v55
    v_cos_f32 v10, v10
    v_lshlrev_b16 v13, 3, v55
    v_mad_i32_i24 v11, v14, s55, v51
    v_bitop3_b32 v12, v6, v13, v12 bitop3:0xca
    v_lshl_add_u32 v11, v11, 17, s40
    v_lshlrev_b16 v14, 8, v14
    v_lshrrev_b32 v13, 2, v55
    v_add_u32 v51, v12, v11
    v_bitop3_b32 v55, v5, v13, v14 bitop3:0xea
    ds_add_u32 v55, v2
    v_cvt_pk_bf16_f32 v45, v9, v10
    v_perm_b32 v12, v45, v45, s41
    v_bitop3_b32 v50, v4, v12, v50 bitop3:0xca
    v_perm_b32 v13, v45, v45, s42
    v_bitop3_b32 v51, v4, v13, v51 bitop3:0xca
    s_waitcnt vmcnt(4)
    v_lshlrev_b32 v7, 16, v46
    v_and_b32 v8, 0xffff0000, v46
    v_lshlrev_b32 v9, 16, v47
    v_and_b32 v10, 0xffff0000, v47
    v_mul_f32 v7, 0.15915494, v7
    v_mul_f32 v8, 0.15915494, v8
    v_mul_f32 v9, 0.15915494, v9
    v_mul_f32 v10, 0.15915494, v10
    v_mul_hi_u32_u24 v14, 429497, v56
    v_lshrrev_b32 v12, 3, v60
    v_cos_f32 v7, v7
    v_lshlrev_b16 v13, 3, v60
    v_mad_i32_i24 v11, v14, s55, v56
    v_bitop3_b32 v12, v6, v13, v12 bitop3:0xca
    v_lshl_add_u32 v11, v11, 17, s40
    v_lshlrev_b16 v14, 8, v14
    v_lshrrev_b32 v13, 2, v60
    v_add_u32 v56, v12, v11
    v_bitop3_b32 v60, v5, v13, v14 bitop3:0xea
    ds_add_u32 v60, v2
    v_mul_hi_u32_u24 v14, 429497, v57
    v_lshrrev_b32 v12, 3, v61
    v_cos_f32 v8, v8
    v_lshlrev_b16 v13, 3, v61
    v_mad_i32_i24 v11, v14, s55, v57
    v_bitop3_b32 v12, v6, v13, v12 bitop3:0xca
    v_lshl_add_u32 v11, v11, 17, s40
    v_lshlrev_b16 v14, 8, v14
    v_lshrrev_b32 v13, 2, v61
    v_add_u32 v57, v12, v11
    v_bitop3_b32 v61, v5, v13, v14 bitop3:0xea
    ds_add_u32 v61, v2
    v_cvt_pk_bf16_f32 v46, v7, v8
    v_perm_b32 v12, v46, v46, s41
    v_bitop3_b32 v56, v4, v12, v56 bitop3:0xca
    v_perm_b32 v13, v46, v46, s42
    v_bitop3_b32 v57, v4, v13, v57 bitop3:0xca
    v_mul_hi_u32_u24 v14, 429497, v58
    v_lshrrev_b32 v12, 3, v62
    v_cos_f32 v9, v9
    v_lshlrev_b16 v13, 3, v62
    v_mad_i32_i24 v11, v14, s55, v58
    v_bitop3_b32 v12, v6, v13, v12 bitop3:0xca
    v_lshl_add_u32 v11, v11, 17, s40
    v_lshlrev_b16 v14, 8, v14
    v_lshrrev_b32 v13, 2, v62
    v_add_u32 v58, v12, v11
    v_bitop3_b32 v62, v5, v13, v14 bitop3:0xea
    ds_add_u32 v62, v2
    v_mul_hi_u32_u24 v14, 429497, v59
    v_lshrrev_b32 v12, 3, v63
    v_cos_f32 v10, v10
    v_lshlrev_b16 v13, 3, v63
    v_mad_i32_i24 v11, v14, s55, v59
    v_bitop3_b32 v12, v6, v13, v12 bitop3:0xca
    v_lshl_add_u32 v11, v11, 17, s40
    v_lshlrev_b16 v14, 8, v14
    v_lshrrev_b32 v13, 2, v63
    v_add_u32 v59, v12, v11
    v_bitop3_b32 v63, v5, v13, v14 bitop3:0xea
    ds_add_u32 v63, v2
    v_cvt_pk_bf16_f32 v47, v9, v10
    v_perm_b32 v12, v47, v47, s41
    v_bitop3_b32 v58, v4, v12, v58 bitop3:0xca
    v_perm_b32 v13, v47, v47, s42
    v_bitop3_b32 v59, v4, v13, v59 bitop3:0xca
    v_lshrrev_b32 v8, 2, v0
    v_and_b32 v7, 0x3c00, v0
    v_bitop3_b32 v7, v5, v8, v7 bitop3:0xea
    s_waitcnt lgkmcnt(0)
    s_barrier
    ds_read2st64_b32 v[8:9], v7 offset0:0 offset1:1
    ds_read2st64_b32 v[10:11], v7 offset0:2 offset1:3
    s_add_u32 s44, s35, 0x10000
    buffer_store_dwordx4 v[64:67], v0, s[20:23], s44 offen sc1
    s_add_u32 s45, s34, 0x2000000
    s_nop 0
    buffer_load_dwordx2 v[64:65], v1, s[16:19], s45 offen nt
    s_add_u32 s46, s34, 0x2200000
    buffer_load_dwordx2 v[66:67], v1, s[16:19], s46 offen nt
    s_waitcnt lgkmcnt(0)
    v_lshl_or_b32 v12, v9, 16, v8
    v_lshl_or_b32 v13, v11, 16, v10
    v_mov_b32 v14, v12
    v_mov_b32 v15, v13
    s_nop 0
    v_add_u32_dpp v14, v14, v14 row_shr:1 row_mask:0xf bank_mask:0xf bound_ctrl:1
    v_add_u32_dpp v15, v15, v15 row_shr:1 row_mask:0xf bank_mask:0xf bound_ctrl:1
    s_nop 0
    v_add_u32_dpp v14, v14, v14 row_shr:2 row_mask:0xf bank_mask:0xf bound_ctrl:1
    v_add_u32_dpp v15, v15, v15 row_shr:2 row_mask:0xf bank_mask:0xf bound_ctrl:1
    s_nop 0
    v_add_u32_dpp v14, v14, v14 row_shr:4 row_mask:0xf bank_mask:0xf bound_ctrl:1
    v_add_u32_dpp v15, v15, v15 row_shr:4 row_mask:0xf bank_mask:0xf bound_ctrl:1
    s_nop 0
    v_add_u32_dpp v14, v14, v14 row_shr:8 row_mask:0xf bank_mask:0xf bound_ctrl:1
    v_add_u32_dpp v15, v15, v15 row_shr:8 row_mask:0xf bank_mask:0xf bound_ctrl:1
    s_nop 0
    v_add_u32_dpp v14, v14, v14 row_bcast:15 row_mask:0xa bank_mask:0xf
    v_add_u32_dpp v15, v15, v15 row_bcast:15 row_mask:0xa bank_mask:0xf
    s_nop 0
    v_add_u32_dpp v14, v14, v14 row_bcast:31 row_mask:0xc bank_mask:0xf
    v_add_u32_dpp v15, v15, v15 row_bcast:31 row_mask:0xc bank_mask:0xf
    v_readlane_b32 s48, v14, 63
    v_readlane_b32 s49, v15, 63
    s_lshl_b32 s54, s32, 2
    v_mov_b32 v8, s54
    s_and_b32 s50, s48, 0xffff
    s_lshr_b32 s51, s48, 16
    s_and_b32 s52, s49, 0xffff
    s_lshr_b32 s53, s49, 16
    s_add_u32 s51, s51, s50
    s_add_u32 s52, s52, s51
    s_add_u32 s53, s53, s52
    v_mov_b32 v9, s53
    s_mov_b64 exec, 1
    ds_write_b32 v8, v9 offset:16384
    s_mov_b64 exec, -1
    v_and_b32 v8, 60, v7
    s_waitcnt lgkmcnt(0)
    s_barrier
    ds_read_b32 v9, v8 offset:16384
    s_waitcnt lgkmcnt(0)
    v_add_u32_dpp v9, v9, v9 row_shr:1 row_mask:0xf bank_mask:0xf bound_ctrl:1
    s_nop 1
    v_add_u32_dpp v9, v9, v9 row_shr:2 row_mask:0xf bank_mask:0xf bound_ctrl:1
    s_nop 1
    v_add_u32_dpp v9, v9, v9 row_shr:4 row_mask:0xf bank_mask:0xf bound_ctrl:1
    s_nop 1
    v_add_u32_dpp v9, v9, v9 row_shr:8 row_mask:0xf bank_mask:0xf bound_ctrl:1
    s_nop 0
    v_readlane_b32 s54, v9, s32
    s_sub_u32 s54, s54, s53
    s_add_u32 s50, s50, s54
    s_add_u32 s51, s51, s54
    s_add_u32 s52, s52, s54
    s_pack_ll_b32_b16 s48, s54, s50
    s_pack_ll_b32_b16 s49, s51, s52
    v_add_u32 v14, s48, v14
    v_add_u32 v15, s49, v15
    v_sub_u32 v12, v14, v12
    v_sub_u32 v13, v15, v13
    v_and_b32 v8, 0xffff, v12
    v_lshrrev_b32 v9, 16, v12
    v_and_b32 v10, 0xffff, v13
    v_lshrrev_b32 v11, 16, v13
    ds_write2st64_b32 v7, v8, v9 offset0:0 offset1:1
    ds_write2st64_b32 v7, v10, v11 offset0:2 offset1:3
    s_waitcnt lgkmcnt(0)
    s_barrier
    ds_add_rtn_u32 v100, v100, v2
    ds_add_rtn_u32 v101, v101, v2
    ds_add_rtn_u32 v102, v102, v2
    ds_add_rtn_u32 v103, v103, v2
    s_add_u32 s47, s36, 0x2a40000
    v_and_b32 v11, 0x3f0, v0
    v_add_u32 v11, v11, v11
    buffer_store_dwordx2 v[12:13], v11, s[24:27], s47 offen
    s_bitset0_b64 exec, 63
    s_not_b64 exec, exec
    buffer_store_dwordx2 v[14:15], v11, s[24:27], s47 offen offset:32
    s_mov_b64 exec, -1
    v_cmp_le_u32 vcc, s37, v0
    v_add_u32 v10, 8320, v0
    s_cmp_lg_u32 s32, 0
    v_cndmask_b32 v10, v0, v10, vcc
    s_cbranch_scc1 L1_p2
    s_add_u32 s44, s35, 0x2a40000
    s_mov_b64 exec, 0xff
    buffer_store_dwordx4 v[12:15], v10, s[24:27], s44 offen
    s_mov_b64 exec, -1
L1_p2:
    ds_add_rtn_u32 v112, v112, v2
    ds_add_rtn_u32 v113, v113, v2
    ds_add_rtn_u32 v114, v114, v2
    ds_add_rtn_u32 v115, v115, v2
    ds_add_rtn_u32 v120, v120, v2
    ds_add_rtn_u32 v121, v121, v2
    ds_add_rtn_u32 v122, v122, v2
    ds_add_rtn_u32 v123, v123, v2
    s_add_u32 s45, s35, 0x14000
    buffer_store_dwordx4 v[76:79], v0, s[20:23], s45 offen sc1
    s_add_u32 s46, s33, 0x4400000
    s_nop 0
    buffer_load_dwordx4 v[76:79], v0, s[8:11], s46 offen nt
    ds_add_rtn_u32 v20, v20, v2
    ds_add_rtn_u32 v21, v21, v2
    ds_add_rtn_u32 v22, v22, v2
    ds_add_rtn_u32 v23, v23, v2
    ds_add_rtn_u32 v32, v32, v2
    ds_add_rtn_u32 v33, v33, v2
    ds_add_rtn_u32 v34, v34, v2
    ds_add_rtn_u32 v35, v35, v2
    ds_add_rtn_u32 v40, v40, v2
    ds_add_rtn_u32 v41, v41, v2
    ds_add_rtn_u32 v42, v42, v2
    ds_add_rtn_u32 v43, v43, v2
    s_add_u32 s47, s35, 0x18000
    buffer_store_dwordx4 v[80:83], v0, s[20:23], s47 offen sc1
    s_add_u32 s44, s33, 0x4400000
    s_nop 0
    buffer_load_dwordx4 v[80:83], v0, s[12:15], s44 offen nt
    ds_add_rtn_u32 v52, v52, v2
    ds_add_rtn_u32 v53, v53, v2
    ds_add_rtn_u32 v54, v54, v2
    ds_add_rtn_u32 v55, v55, v2
    ds_add_rtn_u32 v60, v60, v2
    ds_add_rtn_u32 v61, v61, v2
    ds_add_rtn_u32 v62, v62, v2
    ds_add_rtn_u32 v63, v63, v2
    s_waitcnt lgkmcnt(0)
    s_barrier
    v_and_b32 v7, -4, v100
    v_lshl_add_u32 v8, v100, 2, v7
    ds_write_b32 v8, v96
    v_lshl_add_u32 v7, v7, 2, v100
    ds_write_b8 v7, v104 offset:16
    v_and_b32 v9, -4, v101
    v_lshl_add_u32 v10, v101, 2, v9
    ds_write_b32 v10, v97
    v_lshl_add_u32 v9, v9, 2, v101
    ds_write_b8_d16_hi v9, v104 offset:16
    v_and_b32 v7, -4, v102
    v_lshl_add_u32 v8, v102, 2, v7
    ds_write_b32 v8, v98
    v_lshl_add_u32 v7, v7, 2, v102
    ds_write_b8 v7, v105 offset:16
    v_and_b32 v9, -4, v103
    v_lshl_add_u32 v10, v103, 2, v9
    ds_write_b32 v10, v99
    v_lshl_add_u32 v9, v9, 2, v103
    ds_write_b8_d16_hi v9, v105 offset:16
    s_add_u32 s45, s35, 0x1c000
    buffer_store_dwordx4 v[88:91], v0, s[20:23], s45 offen sc1
    s_add_u32 s46, s33, 0x4800000
    buffer_load_dwordx4 v[96:99], v0, s[8:11], s46 offen nt
    s_add_u32 s47, s33, 0x4800000
    buffer_load_dwordx4 v[100:103], v0, s[12:15], s47 offen nt
    v_and_b32 v7, -4, v112
    v_lshl_add_u32 v8, v112, 2, v7
    ds_write_b32 v8, v108
    v_lshl_add_u32 v7, v7, 2, v112
    ds_write_b8 v7, v106 offset:16
    v_and_b32 v9, -4, v113
    v_lshl_add_u32 v10, v113, 2, v9
    ds_write_b32 v10, v109
    v_lshl_add_u32 v9, v9, 2, v113
    ds_write_b8_d16_hi v9, v106 offset:16
    v_and_b32 v7, -4, v114
    v_lshl_add_u32 v8, v114, 2, v7
    ds_write_b32 v8, v110
    v_lshl_add_u32 v7, v7, 2, v114
    ds_write_b8 v7, v107 offset:16
    v_and_b32 v9, -4, v115
    v_lshl_add_u32 v10, v115, 2, v9
    ds_write_b32 v10, v111
    v_lshl_add_u32 v9, v9, 2, v115
    ds_write_b8_d16_hi v9, v107 offset:16
    s_add_u32 s44, s34, 0x2400000
    buffer_load_dwordx2 v[88:89], v1, s[16:19], s44 offen nt
    s_add_u32 s45, s34, 0x2600000
    buffer_load_dwordx2 v[90:91], v1, s[16:19], s45 offen nt
    s_add_u32 s46, s33, 0x4c00000
    buffer_load_dwordx4 v[108:111], v0, s[8:11], s46 offen nt
    v_and_b32 v7, -4, v120
    v_lshl_add_u32 v8, v120, 2, v7
    ds_write_b32 v8, v116
    v_lshl_add_u32 v7, v7, 2, v120
    ds_write_b8 v7, v124 offset:16
    v_and_b32 v9, -4, v121
    v_lshl_add_u32 v10, v121, 2, v9
    ds_write_b32 v10, v117
    v_lshl_add_u32 v9, v9, 2, v121
    ds_write_b8_d16_hi v9, v124 offset:16
    v_and_b32 v7, -4, v122
    v_lshl_add_u32 v8, v122, 2, v7
    ds_write_b32 v8, v118
    v_lshl_add_u32 v7, v7, 2, v122
    ds_write_b8 v7, v125 offset:16
    v_and_b32 v9, -4, v123
    v_lshl_add_u32 v10, v123, 2, v9
    ds_write_b32 v10, v119
    v_lshl_add_u32 v9, v9, 2, v123
    ds_write_b8_d16_hi v9, v125 offset:16
    s_add_u32 s47, s35, 0x20000
    buffer_store_dwordx4 v[92:95], v0, s[20:23], s47 offen sc1
    s_add_u32 s44, s33, 0x4c00000
    buffer_load_dwordx4 v[112:115], v0, s[12:15], s44 offen nt
    v_and_b32 v7, -4, v20
    v_lshl_add_u32 v8, v20, 2, v7
    ds_write_b32 v8, v16
    v_lshl_add_u32 v7, v7, 2, v20
    ds_write_b8 v7, v126 offset:16
    v_and_b32 v9, -4, v21
    v_lshl_add_u32 v10, v21, 2, v9
    ds_write_b32 v10, v17
    v_lshl_add_u32 v9, v9, 2, v21
    ds_write_b8_d16_hi v9, v126 offset:16
    v_and_b32 v7, -4, v22
    v_lshl_add_u32 v8, v22, 2, v7
    ds_write_b32 v8, v18
    v_lshl_add_u32 v7, v7, 2, v22
    ds_write_b8 v7, v127 offset:16
    v_and_b32 v9, -4, v23
    v_lshl_add_u32 v10, v23, 2, v9
    ds_write_b32 v10, v19
    v_lshl_add_u32 v9, v9, 2, v23
    ds_write_b8_d16_hi v9, v127 offset:16
    s_add_u32 s45, s33, 0x5000000
    buffer_load_dwordx4 v[104:107], v0, s[8:11], s45 offen nt
    s_add_u32 s46, s33, 0x5000000
    buffer_load_dwordx4 v[116:119], v0, s[12:15], s46 offen nt
    v_and_b32 v7, -4, v32
    v_lshl_add_u32 v8, v32, 2, v7
    ds_write_b32 v8, v28
    v_lshl_add_u32 v7, v7, 2, v32
    ds_write_b8 v7, v24 offset:16
    v_and_b32 v9, -4, v33
    v_lshl_add_u32 v10, v33, 2, v9
    ds_write_b32 v10, v29
    v_lshl_add_u32 v9, v9, 2, v33
    ds_write_b8_d16_hi v9, v24 offset:16
    v_and_b32 v7, -4, v34
    v_lshl_add_u32 v8, v34, 2, v7
    ds_write_b32 v8, v30
    v_lshl_add_u32 v7, v7, 2, v34
    ds_write_b8 v7, v25 offset:16
    v_and_b32 v9, -4, v35
    v_lshl_add_u32 v10, v35, 2, v9
    ds_write_b32 v10, v31
    v_lshl_add_u32 v9, v9, 2, v35
    ds_write_b8_d16_hi v9, v25 offset:16
    s_add_u32 s47, s34, 0x2800000
    buffer_load_dwordx2 v[120:121], v1, s[16:19], s47 offen nt
    s_add_u32 s44, s34, 0x2a00000
    buffer_load_dwordx2 v[122:123], v1, s[16:19], s44 offen nt
    s_add_u32 s45, s33, 0x5400000
    buffer_load_dwordx4 v[92:95], v0, s[8:11], s45 offen nt
    v_and_b32 v7, -4, v40
    v_lshl_add_u32 v8, v40, 2, v7
    ds_write_b32 v8, v36
    v_lshl_add_u32 v7, v7, 2, v40
    ds_write_b8 v7, v26 offset:16
    v_and_b32 v9, -4, v41
    v_lshl_add_u32 v10, v41, 2, v9
    ds_write_b32 v10, v37
    v_lshl_add_u32 v9, v9, 2, v41
    ds_write_b8_d16_hi v9, v26 offset:16
    v_and_b32 v7, -4, v42
    v_lshl_add_u32 v8, v42, 2, v7
    ds_write_b32 v8, v38
    v_lshl_add_u32 v7, v7, 2, v42
    ds_write_b8 v7, v27 offset:16
    v_and_b32 v9, -4, v43
    v_lshl_add_u32 v10, v43, 2, v9
    ds_write_b32 v10, v39
    v_lshl_add_u32 v9, v9, 2, v43
    ds_write_b8_d16_hi v9, v27 offset:16
    s_add_u32 s46, s35, 0x24000
    buffer_store_dwordx4 v[84:87], v0, s[20:23], s46 offen sc1
    s_add_u32 s47, s33, 0x5400000
    buffer_load_dwordx4 v[16:19], v0, s[12:15], s47 offen nt
    v_and_b32 v7, -4, v52
    v_lshl_add_u32 v8, v52, 2, v7
    ds_write_b32 v8, v48
    v_lshl_add_u32 v7, v7, 2, v52
    ds_write_b8 v7, v44 offset:16
    v_and_b32 v9, -4, v53
    v_lshl_add_u32 v10, v53, 2, v9
    ds_write_b32 v10, v49
    v_lshl_add_u32 v9, v9, 2, v53
    ds_write_b8_d16_hi v9, v44 offset:16
    v_and_b32 v7, -4, v54
    v_lshl_add_u32 v8, v54, 2, v7
    ds_write_b32 v8, v50
    v_lshl_add_u32 v7, v7, 2, v54
    ds_write_b8 v7, v45 offset:16
    v_and_b32 v9, -4, v55
    v_lshl_add_u32 v10, v55, 2, v9
    ds_write_b32 v10, v51
    v_lshl_add_u32 v9, v9, 2, v55
    ds_write_b8_d16_hi v9, v45 offset:16
    s_add_u32 s44, s33, 0x5800000
    buffer_load_dwordx4 v[20:23], v0, s[8:11], s44 offen nt
    s_add_u32 s45, s33, 0x5800000
    buffer_load_dwordx4 v[124:127], v0, s[12:15], s45 offen nt
    v_and_b32 v7, -4, v60
    v_lshl_add_u32 v8, v60, 2, v7
    ds_write_b32 v8, v56
    v_lshl_add_u32 v7, v7, 2, v60
    ds_write_b8 v7, v46 offset:16
    v_and_b32 v9, -4, v61
    v_lshl_add_u32 v10, v61, 2, v9
    ds_write_b32 v10, v57
    v_lshl_add_u32 v9, v9, 2, v61
    ds_write_b8_d16_hi v9, v46 offset:16
    v_and_b32 v7, -4, v62
    v_lshl_add_u32 v8, v62, 2, v7
    ds_write_b32 v8, v58
    v_lshl_add_u32 v7, v7, 2, v62
    ds_write_b8 v7, v47 offset:16
    v_and_b32 v9, -4, v63
    v_lshl_add_u32 v10, v63, 2, v9
    ds_write_b32 v10, v59
    v_lshl_add_u32 v9, v9, 2, v63
    ds_write_b8_d16_hi v9, v47 offset:16
    s_add_u32 s46, s34, 0x2c00000
    buffer_load_dwordx2 v[28:29], v1, s[16:19], s46 offen nt
    s_add_u32 s47, s34, 0x2e00000
    buffer_load_dwordx2 v[30:31], v1, s[16:19], s47 offen nt
    v_add_u32 v7, 0x10000, v0
    v_add_u32 v12, 0x20000, v0
    v_mov_b32 v8, 0
    v_mov_b32 v9, 0
    v_mov_b32 v10, 0
    v_mov_b32 v11, 0
    s_waitcnt lgkmcnt(0)
    s_barrier
    ds_read_b128 v[32:35], v0 offset:0
    ds_write_b128 v0, v[8:11]
    ds_read_b128 v[36:39], v0 offset:16384
    ds_read_b128 v[40:43], v0 offset:32768
    ds_read_b128 v[24:27], v0 offset:49152
    ds_read_b128 v[84:87], v7 offset:0
    ds_read_b128 v[48:51], v7 offset:16384
    ds_read_b128 v[52:55], v7 offset:32768
    ds_read_b128 v[56:59], v7 offset:49152
    ds_read_b128 v[60:63], v12 offset:0
    ds_read_b128 v[44:47], v12 offset:16384
    s_waitcnt lgkmcnt(0)
    s_barrier
    s_add_u32 s44, s35, 0x2a40000
    buffer_store_dwordx4 v[32:35], v0, s[20:23], s44 offen sc1
    s_add_u32 s45, s33, 0x5c00000
    s_nop 0
    buffer_load_dwordx4 v[32:35], v0, s[8:11], s45 offen nt
    s_add_u32 s46, s35, 0x2a44000
    buffer_store_dwordx4 v[36:39], v0, s[20:23], s46 offen sc1
    s_add_u32 s47, s33, 0x5c00000
    s_nop 0
    buffer_load_dwordx4 v[36:39], v0, s[12:15], s47 offen nt
    s_waitcnt vmcnt(29)
    v_lshlrev_b32 v7, 16, v64
    v_and_b32 v8, 0xffff0000, v64
    v_lshlrev_b32 v9, 16, v65
    v_and_b32 v10, 0xffff0000, v65
    v_mul_f32 v7, 0.15915494, v7
    v_mul_f32 v8, 0.15915494, v8
    v_mul_f32 v9, 0.15915494, v9
    v_mul_f32 v10, 0.15915494, v10
    v_mul_hi_u32_u24 v14, 429497, v68
    v_lshrrev_b32 v12, 3, v72
    v_cos_f32 v7, v7
    v_lshlrev_b16 v13, 3, v72
    v_mad_i32_i24 v11, v14, s55, v68
    v_bitop3_b32 v12, v6, v13, v12 bitop3:0xca
    v_lshl_add_u32 v11, v11, 17, s40
    v_lshlrev_b16 v14, 8, v14
    v_lshrrev_b32 v13, 2, v72
    v_add_u32 v68, v12, v11
    v_bitop3_b32 v72, v5, v13, v14 bitop3:0xea
    ds_add_u32 v72, v2
    v_mul_hi_u32_u24 v14, 429497, v69
    v_lshrrev_b32 v12, 3, v73
    v_cos_f32 v8, v8
    v_lshlrev_b16 v13, 3, v73
    v_mad_i32_i24 v11, v14, s55, v69
    v_bitop3_b32 v12, v6, v13, v12 bitop3:0xca
    v_lshl_add_u32 v11, v11, 17, s40
    v_lshlrev_b16 v14, 8, v14
    v_lshrrev_b32 v13, 2, v73
    v_add_u32 v69, v12, v11
    v_bitop3_b32 v73, v5, v13, v14 bitop3:0xea
    ds_add_u32 v73, v2
    v_cvt_pk_bf16_f32 v64, v7, v8
    v_perm_b32 v12, v64, v64, s41
    v_bitop3_b32 v68, v4, v12, v68 bitop3:0xca
    v_perm_b32 v13, v64, v64, s42
    v_bitop3_b32 v69, v4, v13, v69 bitop3:0xca
    v_mul_hi_u32_u24 v14, 429497, v70
    v_lshrrev_b32 v12, 3, v74
    v_cos_f32 v9, v9
    v_lshlrev_b16 v13, 3, v74
    v_mad_i32_i24 v11, v14, s55, v70
    v_bitop3_b32 v12, v6, v13, v12 bitop3:0xca
    v_lshl_add_u32 v11, v11, 17, s40
    v_lshlrev_b16 v14, 8, v14
    v_lshrrev_b32 v13, 2, v74
    v_add_u32 v70, v12, v11
    v_bitop3_b32 v74, v5, v13, v14 bitop3:0xea
    ds_add_u32 v74, v2
    v_mul_hi_u32_u24 v14, 429497, v71
    v_lshrrev_b32 v12, 3, v75
    v_cos_f32 v10, v10
    v_lshlrev_b16 v13, 3, v75
    v_mad_i32_i24 v11, v14, s55, v71
    v_bitop3_b32 v12, v6, v13, v12 bitop3:0xca
    v_lshl_add_u32 v11, v11, 17, s40
    v_lshlrev_b16 v14, 8, v14
    v_lshrrev_b32 v13, 2, v75
    v_add_u32 v71, v12, v11
    v_bitop3_b32 v75, v5, v13, v14 bitop3:0xea
    ds_add_u32 v75, v2
    v_cvt_pk_bf16_f32 v65, v9, v10
    v_perm_b32 v12, v65, v65, s41
    v_bitop3_b32 v70, v4, v12, v70 bitop3:0xca
    v_perm_b32 v13, v65, v65, s42
    v_bitop3_b32 v71, v4, v13, v71 bitop3:0xca
    s_waitcnt vmcnt(23)
    v_lshlrev_b32 v7, 16, v66
    v_and_b32 v8, 0xffff0000, v66
    v_lshlrev_b32 v9, 16, v67
    v_and_b32 v10, 0xffff0000, v67
    v_mul_f32 v7, 0.15915494, v7
    v_mul_f32 v8, 0.15915494, v8
    v_mul_f32 v9, 0.15915494, v9
    v_mul_f32 v10, 0.15915494, v10
    v_mul_hi_u32_u24 v14, 429497, v76
    v_lshrrev_b32 v12, 3, v80
    v_cos_f32 v7, v7
    v_lshlrev_b16 v13, 3, v80
    v_mad_i32_i24 v11, v14, s55, v76
    v_bitop3_b32 v12, v6, v13, v12 bitop3:0xca
    v_lshl_add_u32 v11, v11, 17, s40
    v_lshlrev_b16 v14, 8, v14
    v_lshrrev_b32 v13, 2, v80
    v_add_u32 v76, v12, v11
    v_bitop3_b32 v80, v5, v13, v14 bitop3:0xea
    ds_add_u32 v80, v2
    v_mul_hi_u32_u24 v14, 429497, v77
    v_lshrrev_b32 v12, 3, v81
    v_cos_f32 v8, v8
    v_lshlrev_b16 v13, 3, v81
    v_mad_i32_i24 v11, v14, s55, v77
    v_bitop3_b32 v12, v6, v13, v12 bitop3:0xca
    v_lshl_add_u32 v11, v11, 17, s40
    v_lshlrev_b16 v14, 8, v14
    v_lshrrev_b32 v13, 2, v81
    v_add_u32 v77, v12, v11
    v_bitop3_b32 v81, v5, v13, v14 bitop3:0xea
    ds_add_u32 v81, v2
    v_cvt_pk_bf16_f32 v66, v7, v8
    v_perm_b32 v12, v66, v66, s41
    v_bitop3_b32 v76, v4, v12, v76 bitop3:0xca
    v_perm_b32 v13, v66, v66, s42
    v_bitop3_b32 v77, v4, v13, v77 bitop3:0xca
    v_mul_hi_u32_u24 v14, 429497, v78
    v_lshrrev_b32 v12, 3, v82
    v_cos_f32 v9, v9
    v_lshlrev_b16 v13, 3, v82
    v_mad_i32_i24 v11, v14, s55, v78
    v_bitop3_b32 v12, v6, v13, v12 bitop3:0xca
    v_lshl_add_u32 v11, v11, 17, s40
    v_lshlrev_b16 v14, 8, v14
    v_lshrrev_b32 v13, 2, v82
    v_add_u32 v78, v12, v11
    v_bitop3_b32 v82, v5, v13, v14 bitop3:0xea
    ds_add_u32 v82, v2
    v_mul_hi_u32_u24 v14, 429497, v79
    v_lshrrev_b32 v12, 3, v83
    v_cos_f32 v10, v10
    v_lshlrev_b16 v13, 3, v83
    v_mad_i32_i24 v11, v14, s55, v79
    v_bitop3_b32 v12, v6, v13, v12 bitop3:0xca
    v_lshl_add_u32 v11, v11, 17, s40
    v_lshlrev_b16 v14, 8, v14
    v_lshrrev_b32 v13, 2, v83
    v_add_u32 v79, v12, v11
    v_bitop3_b32 v83, v5, v13, v14 bitop3:0xea
    ds_add_u32 v83, v2
    v_cvt_pk_bf16_f32 v67, v9, v10
    v_perm_b32 v12, v67, v67, s41
    v_bitop3_b32 v78, v4, v12, v78 bitop3:0xca
    v_perm_b32 v13, v67, v67, s42
    v_bitop3_b32 v79, v4, v13, v79 bitop3:0xca
    s_waitcnt vmcnt(18)
    v_lshlrev_b32 v7, 16, v88
    v_and_b32 v8, 0xffff0000, v88
    v_lshlrev_b32 v9, 16, v89
    v_and_b32 v10, 0xffff0000, v89
    v_mul_f32 v7, 0.15915494, v7
    v_mul_f32 v8, 0.15915494, v8
    v_mul_f32 v9, 0.15915494, v9
    v_mul_f32 v10, 0.15915494, v10
    v_mul_hi_u32_u24 v14, 429497, v96
    v_lshrrev_b32 v12, 3, v100
    v_cos_f32 v7, v7
    v_lshlrev_b16 v13, 3, v100
    v_mad_i32_i24 v11, v14, s55, v96
    v_bitop3_b32 v12, v6, v13, v12 bitop3:0xca
    v_lshl_add_u32 v11, v11, 17, s40
    v_lshlrev_b16 v14, 8, v14
    v_lshrrev_b32 v13, 2, v100
    v_add_u32 v96, v12, v11
    v_bitop3_b32 v100, v5, v13, v14 bitop3:0xea
    ds_add_u32 v100, v2
    v_mul_hi_u32_u24 v14, 429497, v97
    v_lshrrev_b32 v12, 3, v101
    v_cos_f32 v8, v8
    v_lshlrev_b16 v13, 3, v101
    v_mad_i32_i24 v11, v14, s55, v97
    v_bitop3_b32 v12, v6, v13, v12 bitop3:0xca
    v_lshl_add_u32 v11, v11, 17, s40
    v_lshlrev_b16 v14, 8, v14
    v_lshrrev_b32 v13, 2, v101
    v_add_u32 v97, v12, v11
    v_bitop3_b32 v101, v5, v13, v14 bitop3:0xea
    ds_add_u32 v101, v2
    v_cvt_pk_bf16_f32 v88, v7, v8
    v_perm_b32 v12, v88, v88, s41
    v_bitop3_b32 v96, v4, v12, v96 bitop3:0xca
    v_perm_b32 v13, v88, v88, s42
    v_bitop3_b32 v97, v4, v13, v97 bitop3:0xca
    v_mul_hi_u32_u24 v14, 429497, v98
    v_lshrrev_b32 v12, 3, v102
    v_cos_f32 v9, v9
    v_lshlrev_b16 v13, 3, v102
    v_mad_i32_i24 v11, v14, s55, v98
    v_bitop3_b32 v12, v6, v13, v12 bitop3:0xca
    v_lshl_add_u32 v11, v11, 17, s40
    v_lshlrev_b16 v14, 8, v14
    v_lshrrev_b32 v13, 2, v102
    v_add_u32 v98, v12, v11
    v_bitop3_b32 v102, v5, v13, v14 bitop3:0xea
    ds_add_u32 v102, v2
    v_mul_hi_u32_u24 v14, 429497, v99
    v_lshrrev_b32 v12, 3, v103
    v_cos_f32 v10, v10
    v_lshlrev_b16 v13, 3, v103
    v_mad_i32_i24 v11, v14, s55, v99
    v_bitop3_b32 v12, v6, v13, v12 bitop3:0xca
    v_lshl_add_u32 v11, v11, 17, s40
    v_lshlrev_b16 v14, 8, v14
    v_lshrrev_b32 v13, 2, v103
    v_add_u32 v99, v12, v11
    v_bitop3_b32 v103, v5, v13, v14 bitop3:0xea
    ds_add_u32 v103, v2
    v_cvt_pk_bf16_f32 v89, v9, v10
    v_perm_b32 v12, v89, v89, s41
    v_bitop3_b32 v98, v4, v12, v98 bitop3:0xca
    v_perm_b32 v13, v89, v89, s42
    v_bitop3_b32 v99, v4, v13, v99 bitop3:0xca
    s_add_u32 s44, s35, 0x2a48000
    buffer_store_dwordx4 v[40:43], v0, s[20:23], s44 offen sc1
    s_add_u32 s45, s33, 0x6000000
    s_nop 0
    buffer_load_dwordx4 v[40:43], v0, s[8:11], s45 offen nt
    s_waitcnt vmcnt(17)
    v_lshlrev_b32 v7, 16, v90
    v_and_b32 v8, 0xffff0000, v90
    v_lshlrev_b32 v9, 16, v91
    v_and_b32 v10, 0xffff0000, v91
    v_mul_f32 v7, 0.15915494, v7
    v_mul_f32 v8, 0.15915494, v8
    v_mul_f32 v9, 0.15915494, v9
    v_mul_f32 v10, 0.15915494, v10
    v_mul_hi_u32_u24 v14, 429497, v108
    v_lshrrev_b32 v12, 3, v112
    v_cos_f32 v7, v7
    v_lshlrev_b16 v13, 3, v112
    v_mad_i32_i24 v11, v14, s55, v108
    v_bitop3_b32 v12, v6, v13, v12 bitop3:0xca
    v_lshl_add_u32 v11, v11, 17, s40
    v_lshlrev_b16 v14, 8, v14
    v_lshrrev_b32 v13, 2, v112
    v_add_u32 v108, v12, v11
    v_bitop3_b32 v112, v5, v13, v14 bitop3:0xea
    ds_add_u32 v112, v2
    v_mul_hi_u32_u24 v14, 429497, v109
    v_lshrrev_b32 v12, 3, v113
    v_cos_f32 v8, v8
    v_lshlrev_b16 v13, 3, v113
    v_mad_i32_i24 v11, v14, s55, v109
    v_bitop3_b32 v12, v6, v13, v12 bitop3:0xca
    v_lshl_add_u32 v11, v11, 17, s40
    v_lshlrev_b16 v14, 8, v14
    v_lshrrev_b32 v13, 2, v113
    v_add_u32 v109, v12, v11
    v_bitop3_b32 v113, v5, v13, v14 bitop3:0xea
    ds_add_u32 v113, v2
    v_cvt_pk_bf16_f32 v90, v7, v8
    v_perm_b32 v12, v90, v90, s41
    v_bitop3_b32 v108, v4, v12, v108 bitop3:0xca
    v_perm_b32 v13, v90, v90, s42
    v_bitop3_b32 v109, v4, v13, v109 bitop3:0xca
    v_mul_hi_u32_u24 v14, 429497, v110
    v_lshrrev_b32 v12, 3, v114
    v_cos_f32 v9, v9
    v_lshlrev_b16 v13, 3, v114
    v_mad_i32_i24 v11, v14, s55, v110
    v_bitop3_b32 v12, v6, v13, v12 bitop3:0xca
    v_lshl_add_u32 v11, v11, 17, s40
    v_lshlrev_b16 v14, 8, v14
    v_lshrrev_b32 v13, 2, v114
    v_add_u32 v110, v12, v11
    v_bitop3_b32 v114, v5, v13, v14 bitop3:0xea
    ds_add_u32 v114, v2
    v_mul_hi_u32_u24 v14, 429497, v111
    v_lshrrev_b32 v12, 3, v115
    v_cos_f32 v10, v10
    v_lshlrev_b16 v13, 3, v115
    v_mad_i32_i24 v11, v14, s55, v111
    v_bitop3_b32 v12, v6, v13, v12 bitop3:0xca
    v_lshl_add_u32 v11, v11, 17, s40
    v_lshlrev_b16 v14, 8, v14
    v_lshrrev_b32 v13, 2, v115
    v_add_u32 v111, v12, v11
    v_bitop3_b32 v115, v5, v13, v14 bitop3:0xea
    ds_add_u32 v115, v2
    v_cvt_pk_bf16_f32 v91, v9, v10
    v_perm_b32 v12, v91, v91, s41
    v_bitop3_b32 v110, v4, v12, v110 bitop3:0xca
    v_perm_b32 v13, v91, v91, s42
    v_bitop3_b32 v111, v4, v13, v111 bitop3:0xca
    s_waitcnt vmcnt(13)
    v_lshlrev_b32 v7, 16, v120
    v_and_b32 v8, 0xffff0000, v120
    v_lshlrev_b32 v9, 16, v121
    v_and_b32 v10, 0xffff0000, v121
    v_mul_f32 v7, 0.15915494, v7
    v_mul_f32 v8, 0.15915494, v8
    v_mul_f32 v9, 0.15915494, v9
    v_mul_f32 v10, 0.15915494, v10
    v_mul_hi_u32_u24 v14, 429497, v104
    v_lshrrev_b32 v12, 3, v116
    v_cos_f32 v7, v7
    v_lshlrev_b16 v13, 3, v116
    v_mad_i32_i24 v11, v14, s55, v104
    v_bitop3_b32 v12, v6, v13, v12 bitop3:0xca
    v_lshl_add_u32 v11, v11, 17, s40
    v_lshlrev_b16 v14, 8, v14
    v_lshrrev_b32 v13, 2, v116
    v_add_u32 v104, v12, v11
    v_bitop3_b32 v116, v5, v13, v14 bitop3:0xea
    ds_add_u32 v116, v2
    v_mul_hi_u32_u24 v14, 429497, v105
    v_lshrrev_b32 v12, 3, v117
    v_cos_f32 v8, v8
    v_lshlrev_b16 v13, 3, v117
    v_mad_i32_i24 v11, v14, s55, v105
    v_bitop3_b32 v12, v6, v13, v12 bitop3:0xca
    v_lshl_add_u32 v11, v11, 17, s40
    v_lshlrev_b16 v14, 8, v14
    v_lshrrev_b32 v13, 2, v117
    v_add_u32 v105, v12, v11
    v_bitop3_b32 v117, v5, v13, v14 bitop3:0xea
    ds_add_u32 v117, v2
    v_cvt_pk_bf16_f32 v120, v7, v8
    v_perm_b32 v12, v120, v120, s41
    v_bitop3_b32 v104, v4, v12, v104 bitop3:0xca
    v_perm_b32 v13, v120, v120, s42
    v_bitop3_b32 v105, v4, v13, v105 bitop3:0xca
    v_mul_hi_u32_u24 v14, 429497, v106
    v_lshrrev_b32 v12, 3, v118
    v_cos_f32 v9, v9
    v_lshlrev_b16 v13, 3, v118
    v_mad_i32_i24 v11, v14, s55, v106
    v_bitop3_b32 v12, v6, v13, v12 bitop3:0xca
    v_lshl_add_u32 v11, v11, 17, s40
    v_lshlrev_b16 v14, 8, v14
    v_lshrrev_b32 v13, 2, v118
    v_add_u32 v106, v12, v11
    v_bitop3_b32 v118, v5, v13, v14 bitop3:0xea
    ds_add_u32 v118, v2
    v_mul_hi_u32_u24 v14, 429497, v107
    v_lshrrev_b32 v12, 3, v119
    v_cos_f32 v10, v10
    v_lshlrev_b16 v13, 3, v119
    v_mad_i32_i24 v11, v14, s55, v107
    v_bitop3_b32 v12, v6, v13, v12 bitop3:0xca
    v_lshl_add_u32 v11, v11, 17, s40
    v_lshlrev_b16 v14, 8, v14
    v_lshrrev_b32 v13, 2, v119
    v_add_u32 v107, v12, v11
    v_bitop3_b32 v119, v5, v13, v14 bitop3:0xea
    ds_add_u32 v119, v2
    v_cvt_pk_bf16_f32 v121, v9, v10
    v_perm_b32 v12, v121, v121, s41
    v_bitop3_b32 v106, v4, v12, v106 bitop3:0xca
    v_perm_b32 v13, v121, v121, s42
    v_bitop3_b32 v107, v4, v13, v107 bitop3:0xca
    s_waitcnt vmcnt(10)
    v_lshlrev_b32 v7, 16, v122
    v_and_b32 v8, 0xffff0000, v122
    v_lshlrev_b32 v9, 16, v123
    v_and_b32 v10, 0xffff0000, v123
    v_mul_f32 v7, 0.15915494, v7
    v_mul_f32 v8, 0.15915494, v8
    v_mul_f32 v9, 0.15915494, v9
    v_mul_f32 v10, 0.15915494, v10
    v_mul_hi_u32_u24 v14, 429497, v92
    v_lshrrev_b32 v12, 3, v16
    v_cos_f32 v7, v7
    v_lshlrev_b16 v13, 3, v16
    v_mad_i32_i24 v11, v14, s55, v92
    v_bitop3_b32 v12, v6, v13, v12 bitop3:0xca
    v_lshl_add_u32 v11, v11, 17, s40
    v_lshlrev_b16 v14, 8, v14
    v_lshrrev_b32 v13, 2, v16
    v_add_u32 v92, v12, v11
    v_bitop3_b32 v16, v5, v13, v14 bitop3:0xea
    ds_add_u32 v16, v2
    v_mul_hi_u32_u24 v14, 429497, v93
    v_lshrrev_b32 v12, 3, v17
    v_cos_f32 v8, v8
    v_lshlrev_b16 v13, 3, v17
    v_mad_i32_i24 v11, v14, s55, v93
    v_bitop3_b32 v12, v6, v13, v12 bitop3:0xca
    v_lshl_add_u32 v11, v11, 17, s40
    v_lshlrev_b16 v14, 8, v14
    v_lshrrev_b32 v13, 2, v17
    v_add_u32 v93, v12, v11
    v_bitop3_b32 v17, v5, v13, v14 bitop3:0xea
    ds_add_u32 v17, v2
    v_cvt_pk_bf16_f32 v122, v7, v8
    v_perm_b32 v12, v122, v122, s41
    v_bitop3_b32 v92, v4, v12, v92 bitop3:0xca
    v_perm_b32 v13, v122, v122, s42
    v_bitop3_b32 v93, v4, v13, v93 bitop3:0xca
    v_mul_hi_u32_u24 v14, 429497, v94
    v_lshrrev_b32 v12, 3, v18
    v_cos_f32 v9, v9
    v_lshlrev_b16 v13, 3, v18
    v_mad_i32_i24 v11, v14, s55, v94
    v_bitop3_b32 v12, v6, v13, v12 bitop3:0xca
    v_lshl_add_u32 v11, v11, 17, s40
    v_lshlrev_b16 v14, 8, v14
    v_lshrrev_b32 v13, 2, v18
    v_add_u32 v94, v12, v11
    v_bitop3_b32 v18, v5, v13, v14 bitop3:0xea
    ds_add_u32 v18, v2
    v_mul_hi_u32_u24 v14, 429497, v95
    v_lshrrev_b32 v12, 3, v19
    v_cos_f32 v10, v10
    v_lshlrev_b16 v13, 3, v19
    v_mad_i32_i24 v11, v14, s55, v95
    v_bitop3_b32 v12, v6, v13, v12 bitop3:0xca
    v_lshl_add_u32 v11, v11, 17, s40
    v_lshlrev_b16 v14, 8, v14
    v_lshrrev_b32 v13, 2, v19
    v_add_u32 v95, v12, v11
    v_bitop3_b32 v19, v5, v13, v14 bitop3:0xea
    ds_add_u32 v19, v2
    v_cvt_pk_bf16_f32 v123, v9, v10
    v_perm_b32 v12, v123, v123, s41
    v_bitop3_b32 v94, v4, v12, v94 bitop3:0xca
    v_perm_b32 v13, v123, v123, s42
    v_bitop3_b32 v95, v4, v13, v95 bitop3:0xca
    s_add_u32 s46, s35, 0x2a4c000
    buffer_store_dwordx4 v[24:27], v0, s[20:23], s46 offen sc1
    s_add_u32 s47, s33, 0x6000000
    s_nop 0
    buffer_load_dwordx4 v[24:27], v0, s[12:15], s47 offen nt
    s_waitcnt vmcnt(8)
    v_lshlrev_b32 v7, 16, v28
    v_and_b32 v8, 0xffff0000, v28
    v_lshlrev_b32 v9, 16, v29
    v_and_b32 v10, 0xffff0000, v29
    v_mul_f32 v7, 0.15915494, v7
    v_mul_f32 v8, 0.15915494, v8
    v_mul_f32 v9, 0.15915494, v9
    v_mul_f32 v10, 0.15915494, v10
    v_mul_hi_u32_u24 v14, 429497, v20
    v_lshrrev_b32 v12, 3, v124
    v_cos_f32 v7, v7
    v_lshlrev_b16 v13, 3, v124
    v_mad_i32_i24 v11, v14, s55, v20
    v_bitop3_b32 v12, v6, v13, v12 bitop3:0xca
    v_lshl_add_u32 v11, v11, 17, s40
    v_lshlrev_b16 v14, 8, v14
    v_lshrrev_b32 v13, 2, v124
    v_add_u32 v20, v12, v11
    v_bitop3_b32 v124, v5, v13, v14 bitop3:0xea
    ds_add_u32 v124, v2
    v_mul_hi_u32_u24 v14, 429497, v21
    v_lshrrev_b32 v12, 3, v125
    v_cos_f32 v8, v8
    v_lshlrev_b16 v13, 3, v125
    v_mad_i32_i24 v11, v14, s55, v21
    v_bitop3_b32 v12, v6, v13, v12 bitop3:0xca
    v_lshl_add_u32 v11, v11, 17, s40
    v_lshlrev_b16 v14, 8, v14
    v_lshrrev_b32 v13, 2, v125
    v_add_u32 v21, v12, v11
    v_bitop3_b32 v125, v5, v13, v14 bitop3:0xea
    ds_add_u32 v125, v2
    v_cvt_pk_bf16_f32 v28, v7, v8
    v_perm_b32 v12, v28, v28, s41
    v_bitop3_b32 v20, v4, v12, v20 bitop3:0xca
    v_perm_b32 v13, v28, v28, s42
    v_bitop3_b32 v21, v4, v13, v21 bitop3:0xca
    v_mul_hi_u32_u24 v14, 429497, v22
    v_lshrrev_b32 v12, 3, v126
    v_cos_f32 v9, v9
    v_lshlrev_b16 v13, 3, v126
    v_mad_i32_i24 v11, v14, s55, v22
    v_bitop3_b32 v12, v6, v13, v12 bitop3:0xca
    v_lshl_add_u32 v11, v11, 17, s40
    v_lshlrev_b16 v14, 8, v14
    v_lshrrev_b32 v13, 2, v126
    v_add_u32 v22, v12, v11
    v_bitop3_b32 v126, v5, v13, v14 bitop3:0xea
    ds_add_u32 v126, v2
    v_mul_hi_u32_u24 v14, 429497, v23
    v_lshrrev_b32 v12, 3, v127
    v_cos_f32 v10, v10
    v_lshlrev_b16 v13, 3, v127
    v_mad_i32_i24 v11, v14, s55, v23
    v_bitop3_b32 v12, v6, v13, v12 bitop3:0xca
    v_lshl_add_u32 v11, v11, 17, s40
    v_lshlrev_b16 v14, 8, v14
    v_lshrrev_b32 v13, 2, v127
    v_add_u32 v23, v12, v11
    v_bitop3_b32 v127, v5, v13, v14 bitop3:0xea
    ds_add_u32 v127, v2
    v_cvt_pk_bf16_f32 v29, v9, v10
    v_perm_b32 v12, v29, v29, s41
    v_bitop3_b32 v22, v4, v12, v22 bitop3:0xca
    v_perm_b32 v13, v29, v29, s42
    v_bitop3_b32 v23, v4, v13, v23 bitop3:0xca
    s_waitcnt vmcnt(4)
    v_lshlrev_b32 v7, 16, v30
    v_and_b32 v8, 0xffff0000, v30
    v_lshlrev_b32 v9, 16, v31
    v_and_b32 v10, 0xffff0000, v31
    v_mul_f32 v7, 0.15915494, v7
    v_mul_f32 v8, 0.15915494, v8
    v_mul_f32 v9, 0.15915494, v9
    v_mul_f32 v10, 0.15915494, v10
    v_mul_hi_u32_u24 v14, 429497, v32
    v_lshrrev_b32 v12, 3, v36
    v_cos_f32 v7, v7
    v_lshlrev_b16 v13, 3, v36
    v_mad_i32_i24 v11, v14, s55, v32
    v_bitop3_b32 v12, v6, v13, v12 bitop3:0xca
    v_lshl_add_u32 v11, v11, 17, s40
    v_lshlrev_b16 v14, 8, v14
    v_lshrrev_b32 v13, 2, v36
    v_add_u32 v32, v12, v11
    v_bitop3_b32 v36, v5, v13, v14 bitop3:0xea
    ds_add_u32 v36, v2
    v_mul_hi_u32_u24 v14, 429497, v33
    v_lshrrev_b32 v12, 3, v37
    v_cos_f32 v8, v8
    v_lshlrev_b16 v13, 3, v37
    v_mad_i32_i24 v11, v14, s55, v33
    v_bitop3_b32 v12, v6, v13, v12 bitop3:0xca
    v_lshl_add_u32 v11, v11, 17, s40
    v_lshlrev_b16 v14, 8, v14
    v_lshrrev_b32 v13, 2, v37
    v_add_u32 v33, v12, v11
    v_bitop3_b32 v37, v5, v13, v14 bitop3:0xea
    ds_add_u32 v37, v2
    v_cvt_pk_bf16_f32 v30, v7, v8
    v_perm_b32 v12, v30, v30, s41
    v_bitop3_b32 v32, v4, v12, v32 bitop3:0xca
    v_perm_b32 v13, v30, v30, s42
    v_bitop3_b32 v33, v4, v13, v33 bitop3:0xca
    v_mul_hi_u32_u24 v14, 429497, v34
    v_lshrrev_b32 v12, 3, v38
    v_cos_f32 v9, v9
    v_lshlrev_b16 v13, 3, v38
    v_mad_i32_i24 v11, v14, s55, v34
    v_bitop3_b32 v12, v6, v13, v12 bitop3:0xca
    v_lshl_add_u32 v11, v11, 17, s40
    v_lshlrev_b16 v14, 8, v14
    v_lshrrev_b32 v13, 2, v38
    v_add_u32 v34, v12, v11
    v_bitop3_b32 v38, v5, v13, v14 bitop3:0xea
    ds_add_u32 v38, v2
    v_mul_hi_u32_u24 v14, 429497, v35
    v_lshrrev_b32 v12, 3, v39
    v_cos_f32 v10, v10
    v_lshlrev_b16 v13, 3, v39
    v_mad_i32_i24 v11, v14, s55, v35
    v_bitop3_b32 v12, v6, v13, v12 bitop3:0xca
    v_lshl_add_u32 v11, v11, 17, s40
    v_lshlrev_b16 v14, 8, v14
    v_lshrrev_b32 v13, 2, v39
    v_add_u32 v35, v12, v11
    v_bitop3_b32 v39, v5, v13, v14 bitop3:0xea
    ds_add_u32 v39, v2
    v_cvt_pk_bf16_f32 v31, v9, v10
    v_perm_b32 v12, v31, v31, s41
    v_bitop3_b32 v34, v4, v12, v34 bitop3:0xca
    v_perm_b32 v13, v31, v31, s42
    v_bitop3_b32 v35, v4, v13, v35 bitop3:0xca
    v_lshrrev_b32 v8, 2, v0
    v_and_b32 v7, 0x3c00, v0
    v_bitop3_b32 v7, v5, v8, v7 bitop3:0xea
    s_waitcnt lgkmcnt(0)
    s_barrier
    ds_read2st64_b32 v[8:9], v7 offset0:0 offset1:1
    ds_read2st64_b32 v[10:11], v7 offset0:2 offset1:3
    s_add_u32 s44, s35, 0x2a50000
    buffer_store_dwordx4 v[84:87], v0, s[20:23], s44 offen sc1
    s_add_u32 s45, s34, 0x3000000
    s_nop 0
    buffer_load_dwordx2 v[84:85], v1, s[16:19], s45 offen nt
    s_add_u32 s46, s34, 0x3200000
    buffer_load_dwordx2 v[86:87], v1, s[16:19], s46 offen nt
    s_waitcnt lgkmcnt(0)
    v_lshl_or_b32 v12, v9, 16, v8
    v_lshl_or_b32 v13, v11, 16, v10
    v_mov_b32 v14, v12
    v_mov_b32 v15, v13
    s_nop 0
    v_add_u32_dpp v14, v14, v14 row_shr:1 row_mask:0xf bank_mask:0xf bound_ctrl:1
    v_add_u32_dpp v15, v15, v15 row_shr:1 row_mask:0xf bank_mask:0xf bound_ctrl:1
    s_nop 0
    v_add_u32_dpp v14, v14, v14 row_shr:2 row_mask:0xf bank_mask:0xf bound_ctrl:1
    v_add_u32_dpp v15, v15, v15 row_shr:2 row_mask:0xf bank_mask:0xf bound_ctrl:1
    s_nop 0
    v_add_u32_dpp v14, v14, v14 row_shr:4 row_mask:0xf bank_mask:0xf bound_ctrl:1
    v_add_u32_dpp v15, v15, v15 row_shr:4 row_mask:0xf bank_mask:0xf bound_ctrl:1
    s_nop 0
    v_add_u32_dpp v14, v14, v14 row_shr:8 row_mask:0xf bank_mask:0xf bound_ctrl:1
    v_add_u32_dpp v15, v15, v15 row_shr:8 row_mask:0xf bank_mask:0xf bound_ctrl:1
    s_nop 0
    v_add_u32_dpp v14, v14, v14 row_bcast:15 row_mask:0xa bank_mask:0xf
    v_add_u32_dpp v15, v15, v15 row_bcast:15 row_mask:0xa bank_mask:0xf
    s_nop 0
    v_add_u32_dpp v14, v14, v14 row_bcast:31 row_mask:0xc bank_mask:0xf
    v_add_u32_dpp v15, v15, v15 row_bcast:31 row_mask:0xc bank_mask:0xf
    v_readlane_b32 s48, v14, 63
    v_readlane_b32 s49, v15, 63
    s_lshl_b32 s54, s32, 2
    v_mov_b32 v8, s54
    s_and_b32 s50, s48, 0xffff
    s_lshr_b32 s51, s48, 16
    s_and_b32 s52, s49, 0xffff
    s_lshr_b32 s53, s49, 16
    s_add_u32 s51, s51, s50
    s_add_u32 s52, s52, s51
    s_add_u32 s53, s53, s52
    v_mov_b32 v9, s53
    s_mov_b64 exec, 1
    ds_write_b32 v8, v9 offset:16384
    s_mov_b64 exec, -1
    v_and_b32 v8, 60, v7
    s_waitcnt lgkmcnt(0)
    s_barrier
    ds_read_b32 v9, v8 offset:16384
    s_waitcnt lgkmcnt(0)
    v_add_u32_dpp v9, v9, v9 row_shr:1 row_mask:0xf bank_mask:0xf bound_ctrl:1
    s_nop 1
    v_add_u32_dpp v9, v9, v9 row_shr:2 row_mask:0xf bank_mask:0xf bound_ctrl:1
    s_nop 1
    v_add_u32_dpp v9, v9, v9 row_shr:4 row_mask:0xf bank_mask:0xf bound_ctrl:1
    s_nop 1
    v_add_u32_dpp v9, v9, v9 row_shr:8 row_mask:0xf bank_mask:0xf bound_ctrl:1
    s_nop 0
    v_readlane_b32 s54, v9, s32
    s_sub_u32 s54, s54, s53
    s_add_u32 s50, s50, s54
    s_add_u32 s51, s51, s54
    s_add_u32 s52, s52, s54
    s_pack_ll_b32_b16 s48, s54, s50
    s_pack_ll_b32_b16 s49, s51, s52
    v_add_u32 v14, s48, v14
    v_add_u32 v15, s49, v15
    v_sub_u32 v12, v14, v12
    v_sub_u32 v13, v15, v13
    v_and_b32 v8, 0xffff, v12
    v_lshrrev_b32 v9, 16, v12
    v_and_b32 v10, 0xffff, v13
    v_lshrrev_b32 v11, 16, v13
    ds_write2st64_b32 v7, v8, v9 offset0:0 offset1:1
    ds_write2st64_b32 v7, v10, v11 offset0:2 offset1:3
    s_waitcnt lgkmcnt(0)
    s_barrier
    ds_add_rtn_u32 v72, v72, v2
    ds_add_rtn_u32 v73, v73, v2
    ds_add_rtn_u32 v74, v74, v2
    ds_add_rtn_u32 v75, v75, v2
    s_add_u32 s47, s36, 0x5480000
    v_and_b32 v11, 0x3f0, v0
    v_add_u32 v11, v11, v11
    buffer_store_dwordx2 v[12:13], v11, s[24:27], s47 offen
    s_bitset0_b64 exec, 63
    s_not_b64 exec, exec
    buffer_store_dwordx2 v[14:15], v11, s[24:27], s47 offen offset:32
    s_mov_b64 exec, -1
    v_cmp_le_u32 vcc, s37, v0
    v_add_u32 v10, 8320, v0
    s_cmp_lg_u32 s32, 0
    v_cndmask_b32 v10, v0, v10, vcc
    s_cbranch_scc1 L1_p3
    s_add_u32 s44, s35, 0x5480000
    s_mov_b64 exec, 0xff
    buffer_store_dwordx4 v[12:15], v10, s[24:27], s44 offen
    s_mov_b64 exec, -1
L1_p3:
    ds_add_rtn_u32 v80, v80, v2
    ds_add_rtn_u32 v81, v81, v2
    ds_add_rtn_u32 v82, v82, v2
    ds_add_rtn_u32 v83, v83, v2
    ds_add_rtn_u32 v100, v100, v2
    ds_add_rtn_u32 v101, v101, v2
    ds_add_rtn_u32 v102, v102, v2
    ds_add_rtn_u32 v103, v103, v2
    s_add_u32 s45, s35, 0x2a54000
    buffer_store_dwordx4 v[48:51], v0, s[20:23], s45 offen sc1
    s_add_u32 s46, s33, 0x6400000
    s_nop 0
    buffer_load_dwordx4 v[48:51], v0, s[8:11], s46 offen nt
    ds_add_rtn_u32 v112, v112, v2
    ds_add_rtn_u32 v113, v113, v2
    ds_add_rtn_u32 v114, v114, v2
    ds_add_rtn_u32 v115, v115, v2
    ds_add_rtn_u32 v116, v116, v2
    ds_add_rtn_u32 v117, v117, v2
    ds_add_rtn_u32 v118, v118, v2
    ds_add_rtn_u32 v119, v119, v2
    ds_add_rtn_u32 v16, v16, v2
    ds_add_rtn_u32 v17, v17, v2
    ds_add_rtn_u32 v18, v18, v2
    ds_add_rtn_u32 v19, v19, v2
    s_add_u32 s47, s35, 0x2a58000
    buffer_store_dwordx4 v[52:55], v0, s[20:23], s47 offen sc1
    s_add_u32 s44, s33, 0x6400000
    s_nop 0
    buffer_load_dwordx4 v[52:55], v0, s[12:15], s44 offen nt
    ds_add_rtn_u32 v124, v124, v2
    ds_add_rtn_u32 v125, v125, v2
    ds_add_rtn_u32 v126, v126, v2
    ds_add_rtn_u32 v127, v127, v2
    ds_add_rtn_u32 v36, v36, v2
    ds_add_rtn_u32 v37, v37, v2
    ds_add_rtn_u32 v38, v38, v2
    ds_add_rtn_u32 v39, v39, v2
    s_waitcnt lgkmcnt(0)
    s_barrier
    v_and_b32 v7, -4, v72
    v_lshl_add_u32 v8, v72, 2, v7
    ds_write_b32 v8, v68
    v_lshl_add_u32 v7, v7, 2, v72
    ds_write_b8 v7, v64 offset:16
    v_and_b32 v9, -4, v73
    v_lshl_add_u32 v10, v73, 2, v9
    ds_write_b32 v10, v69
    v_lshl_add_u32 v9, v9, 2, v73
    ds_write_b8_d16_hi v9, v64 offset:16
    v_and_b32 v7, -4, v74
    v_lshl_add_u32 v8, v74, 2, v7
    ds_write_b32 v8, v70
    v_lshl_add_u32 v7, v7, 2, v74
    ds_write_b8 v7, v65 offset:16
    v_and_b32 v9, -4, v75
    v_lshl_add_u32 v10, v75, 2, v9
    ds_write_b32 v10, v71
    v_lshl_add_u32 v9, v9, 2, v75
    ds_write_b8_d16_hi v9, v65 offset:16
    s_add_u32 s45, s35, 0x2a5c000
    buffer_store_dwordx4 v[56:59], v0, s[20:23], s45 offen sc1
    s_add_u32 s46, s33, 0x6800000
    buffer_load_dwordx4 v[68:71], v0, s[8:11], s46 offen nt
    s_add_u32 s47, s33, 0x6800000
    buffer_load_dwordx4 v[72:75], v0, s[12:15], s47 offen nt
    v_and_b32 v7, -4, v80
    v_lshl_add_u32 v8, v80, 2, v7
    ds_write_b32 v8, v76
    v_lshl_add_u32 v7, v7, 2, v80
    ds_write_b8 v7, v66 offset:16
    v_and_b32 v9, -4, v81
    v_lshl_add_u32 v10, v81, 2, v9
    ds_write_b32 v10, v77
    v_lshl_add_u32 v9, v9, 2, v81
    ds_write_b8_d16_hi v9, v66 offset:16
    v_and_b32 v7, -4, v82
    v_lshl_add_u32 v8, v82, 2, v7
    ds_write_b32 v8, v78
    v_lshl_add_u32 v7, v7, 2, v82
    ds_write_b8 v7, v67 offset:16
    v_and_b32 v9, -4, v83
    v_lshl_add_u32 v10, v83, 2, v9
    ds_write_b32 v10, v79
    v_lshl_add_u32 v9, v9, 2, v83
    ds_write_b8_d16_hi v9, v67 offset:16
    s_add_u32 s44, s34, 0x3400000
    buffer_load_dwordx2 v[56:57], v1, s[16:19], s44 offen nt
    s_add_u32 s45, s34, 0x3600000
    buffer_load_dwordx2 v[58:59], v1, s[16:19], s45 offen nt
    s_add_u32 s46, s33, 0x6c00000
    buffer_load_dwordx4 v[76:79], v0, s[8:11], s46 offen nt
    v_and_b32 v7, -4, v100
    v_lshl_add_u32 v8, v100, 2, v7
    ds_write_b32 v8, v96
    v_lshl_add_u32 v7, v7, 2, v100
    ds_write_b8 v7, v88 offset:16
    v_and_b32 v9, -4, v101
    v_lshl_add_u32 v10, v101, 2, v9
    ds_write_b32 v10, v97
    v_lshl_add_u32 v9, v9, 2, v101
    ds_write_b8_d16_hi v9, v88 offset:16
    v_and_b32 v7, -4, v102
    v_lshl_add_u32 v8, v102, 2, v7
    ds_write_b32 v8, v98
    v_lshl_add_u32 v7, v7, 2, v102
    ds_write_b8 v7, v89 offset:16
    v_and_b32 v9, -4, v103
    v_lshl_add_u32 v10, v103, 2, v9
    ds_write_b32 v10, v99
    v_lshl_add_u32 v9, v9, 2, v103
    ds_write_b8_d16_hi v9, v89 offset:16
    s_add_u32 s47, s35, 0x2a60000
    buffer_store_dwordx4 v[60:63], v0, s[20:23], s47 offen sc1
    s_add_u32 s44, s33, 0x6c00000
    buffer_load_dwordx4 v[80:83], v0, s[12:15], s44 offen nt
    v_and_b32 v7, -4, v112
    v_lshl_add_u32 v8, v112, 2, v7
    ds_write_b32 v8, v108
    v_lshl_add_u32 v7, v7, 2, v112
    ds_write_b8 v7, v90 offset:16
    v_and_b32 v9, -4, v113
    v_lshl_add_u32 v10, v113, 2, v9
    ds_write_b32 v10, v109
    v_lshl_add_u32 v9, v9, 2, v113
    ds_write_b8_d16_hi v9, v90 offset:16
    v_and_b32 v7, -4, v114
    v_lshl_add_u32 v8, v114, 2, v7
    ds_write_b32 v8, v110
    v_lshl_add_u32 v7, v7, 2, v114
    ds_write_b8 v7, v91 offset:16
    v_and_b32 v9, -4, v115
    v_lshl_add_u32 v10, v115, 2, v9
    ds_write_b32 v10, v111
    v_lshl_add_u32 v9, v9, 2, v115
    ds_write_b8_d16_hi v9, v91 offset:16
    s_add_u32 s45, s33, 0x7000000
    buffer_load_dwordx4 v[64:67], v0, s[8:11], s45 offen nt
    s_add_u32 s46, s33, 0x7000000
    buffer_load_dwordx4 v[96:99], v0, s[12:15], s46 offen nt
    v_and_b32 v7, -4, v116
    v_lshl_add_u32 v8, v116, 2, v7
    ds_write_b32 v8, v104
    v_lshl_add_u32 v7, v7, 2, v116
    ds_write_b8 v7, v120 offset:16
    v_and_b32 v9, -4, v117
    v_lshl_add_u32 v10, v117, 2, v9
    ds_write_b32 v10, v105
    v_lshl_add_u32 v9, v9, 2, v117
    ds_write_b8_d16_hi v9, v120 offset:16
    v_and_b32 v7, -4, v118
    v_lshl_add_u32 v8, v118, 2, v7
    ds_write_b32 v8, v106
    v_lshl_add_u32 v7, v7, 2, v118
    ds_write_b8 v7, v121 offset:16
    v_and_b32 v9, -4, v119
    v_lshl_add_u32 v10, v119, 2, v9
    ds_write_b32 v10, v107
    v_lshl_add_u32 v9, v9, 2, v119
    ds_write_b8_d16_hi v9, v121 offset:16
    s_add_u32 s47, s34, 0x3800000
    buffer_load_dwordx2 v[100:101], v1, s[16:19], s47 offen nt
    s_add_u32 s44, s34, 0x3a00000
    buffer_load_dwordx2 v[102:103], v1, s[16:19], s44 offen nt
    s_add_u32 s45, s33, 0x7400000
    buffer_load_dwordx4 v[60:63], v0, s[8:11], s45 offen nt
    v_and_b32 v7, -4, v16
    v_lshl_add_u32 v8, v16, 2, v7
    ds_write_b32 v8, v92
    v_lshl_add_u32 v7, v7, 2, v16
    ds_write_b8 v7, v122 offset:16
    v_and_b32 v9, -4, v17
    v_lshl_add_u32 v10, v17, 2, v9
    ds_write_b32 v10, v93
    v_lshl_add_u32 v9, v9, 2, v17
    ds_write_b8_d16_hi v9, v122 offset:16
    v_and_b32 v7, -4, v18
    v_lshl_add_u32 v8, v18, 2, v7
    ds_write_b32 v8, v94
    v_lshl_add_u32 v7, v7, 2, v18
    ds_write_b8 v7, v123 offset:16
    v_and_b32 v9, -4, v19
    v_lshl_add_u32 v10, v19, 2, v9
    ds_write_b32 v10, v95
    v_lshl_add_u32 v9, v9, 2, v19
    ds_write_b8_d16_hi v9, v123 offset:16
    s_add_u32 s46, s35, 0x2a64000
    buffer_store_dwordx4 v[44:47], v0, s[20:23], s46 offen sc1
    s_add_u32 s47, s33, 0x7400000
    buffer_load_dwordx4 v[108:111], v0, s[12:15], s47 offen nt
    v_and_b32 v7, -4, v124
    v_lshl_add_u32 v8, v124, 2, v7
    ds_write_b32 v8, v20
    v_lshl_add_u32 v7, v7, 2, v124
    ds_write_b8 v7, v28 offset:16
    v_and_b32 v9, -4, v125
    v_lshl_add_u32 v10, v125, 2, v9
    ds_write_b32 v10, v21
    v_lshl_add_u32 v9, v9, 2, v125
    ds_write_b8_d16_hi v9, v28 offset:16
    v_and_b32 v7, -4, v126
    v_lshl_add_u32 v8, v126, 2, v7
    ds_write_b32 v8, v22
    v_lshl_add_u32 v7, v7, 2, v126
    ds_write_b8 v7, v29 offset:16
    v_and_b32 v9, -4, v127
    v_lshl_add_u32 v10, v127, 2, v9
    ds_write_b32 v10, v23
    v_lshl_add_u32 v9, v9, 2, v127
    ds_write_b8_d16_hi v9, v29 offset:16
    s_add_u32 s44, s33, 0x7800000
    buffer_load_dwordx4 v[112:115], v0, s[8:11], s44 offen nt
    s_add_u32 s45, s33, 0x7800000
    buffer_load_dwordx4 v[88:91], v0, s[12:15], s45 offen nt
    v_and_b32 v7, -4, v36
    v_lshl_add_u32 v8, v36, 2, v7
    ds_write_b32 v8, v32
    v_lshl_add_u32 v7, v7, 2, v36
    ds_write_b8 v7, v30 offset:16
    v_and_b32 v9, -4, v37
    v_lshl_add_u32 v10, v37, 2, v9
    ds_write_b32 v10, v33
    v_lshl_add_u32 v9, v9, 2, v37
    ds_write_b8_d16_hi v9, v30 offset:16
    v_and_b32 v7, -4, v38
    v_lshl_add_u32 v8, v38, 2, v7
    ds_write_b32 v8, v34
    v_lshl_add_u32 v7, v7, 2, v38
    ds_write_b8 v7, v31 offset:16
    v_and_b32 v9, -4, v39
    v_lshl_add_u32 v10, v39, 2, v9
    ds_write_b32 v10, v35
    v_lshl_add_u32 v9, v9, 2, v39
    ds_write_b8_d16_hi v9, v31 offset:16
    s_add_u32 s46, s34, 0x3c00000
    buffer_load_dwordx2 v[104:105], v1, s[16:19], s46 offen nt
    s_add_u32 s47, s34, 0x3e00000
    buffer_load_dwordx2 v[106:107], v1, s[16:19], s47 offen nt
    v_add_u32 v7, 0x10000, v0
    v_add_u32 v12, 0x20000, v0
    v_mov_b32 v8, 0
    v_mov_b32 v9, 0
    v_mov_b32 v10, 0
    v_mov_b32 v11, 0
    s_waitcnt lgkmcnt(0)
    s_barrier
    ds_read_b128 v[116:119], v0 offset:0
    ds_write_b128 v0, v[8:11]
    ds_read_b128 v[92:95], v0 offset:16384
    ds_read_b128 v[16:19], v0 offset:32768
    ds_read_b128 v[120:123], v0 offset:49152
    ds_read_b128 v[44:47], v7 offset:0
    ds_read_b128 v[20:23], v7 offset:16384
    ds_read_b128 v[124:127], v7 offset:32768
    ds_read_b128 v[32:35], v7 offset:49152
    ds_read_b128 v[36:39], v12 offset:0
    ds_read_b128 v[28:31], v12 offset:16384
    s_waitcnt lgkmcnt(0)
    s_barrier
    s_add_u32 s44, s35, 0x5480000
    buffer_store_dwordx4 v[116:119], v0, s[20:23], s44 offen sc1
    s_add_u32 s45, s33, 0x7c00000
    s_nop 0
    buffer_load_dwordx4 v[116:119], v0, s[8:11], s45 offen nt
    s_add_u32 s46, s35, 0x5484000
    buffer_store_dwordx4 v[92:95], v0, s[20:23], s46 offen sc1
    s_add_u32 s47, s33, 0x7c00000
    s_nop 0
    buffer_load_dwordx4 v[92:95], v0, s[12:15], s47 offen nt
    s_waitcnt vmcnt(29)
    v_lshlrev_b32 v7, 16, v84
    v_and_b32 v8, 0xffff0000, v84
    v_lshlrev_b32 v9, 16, v85
    v_and_b32 v10, 0xffff0000, v85
    v_mul_f32 v7, 0.15915494, v7
    v_mul_f32 v8, 0.15915494, v8
    v_mul_f32 v9, 0.15915494, v9
    v_mul_f32 v10, 0.15915494, v10
    v_mul_hi_u32_u24 v14, 429497, v40
    v_lshrrev_b32 v12, 3, v24
    v_cos_f32 v7, v7
    v_lshlrev_b16 v13, 3, v24
    v_mad_i32_i24 v11, v14, s55, v40
    v_bitop3_b32 v12, v6, v13, v12 bitop3:0xca
    v_lshl_add_u32 v11, v11, 17, s40
    v_lshlrev_b16 v14, 8, v14
    v_lshrrev_b32 v13, 2, v24
    v_add_u32 v40, v12, v11
    v_bitop3_b32 v24, v5, v13, v14 bitop3:0xea
    ds_add_u32 v24, v2
    v_mul_hi_u32_u24 v14, 429497, v41
    v_lshrrev_b32 v12, 3, v25
    v_cos_f32 v8, v8
    v_lshlrev_b16 v13, 3, v25
    v_mad_i32_i24 v11, v14, s55, v41
    v_bitop3_b32 v12, v6, v13, v12 bitop3:0xca
    v_lshl_add_u32 v11, v11, 17, s40
    v_lshlrev_b16 v14, 8, v14
    v_lshrrev_b32 v13, 2, v25
    v_add_u32 v41, v12, v11
    v_bitop3_b32 v25, v5, v13, v14 bitop3:0xea
    ds_add_u32 v25, v2
    v_cvt_pk_bf16_f32 v84, v7, v8
    v_perm_b32 v12, v84, v84, s41
    v_bitop3_b32 v40, v4, v12, v40 bitop3:0xca
    v_perm_b32 v13, v84, v84, s42
    v_bitop3_b32 v41, v4, v13, v41 bitop3:0xca
    v_mul_hi_u32_u24 v14, 429497, v42
    v_lshrrev_b32 v12, 3, v26
    v_cos_f32 v9, v9
    v_lshlrev_b16 v13, 3, v26
    v_mad_i32_i24 v11, v14, s55, v42
    v_bitop3_b32 v12, v6, v13, v12 bitop3:0xca
    v_lshl_add_u32 v11, v11, 17, s40
    v_lshlrev_b16 v14, 8, v14
    v_lshrrev_b32 v13, 2, v26
    v_add_u32 v42, v12, v11
    v_bitop3_b32 v26, v5, v13, v14 bitop3:0xea
    ds_add_u32 v26, v2
    v_mul_hi_u32_u24 v14, 429497, v43
    v_lshrrev_b32 v12, 3, v27
    v_cos_f32 v10, v10
    v_lshlrev_b16 v13, 3, v27
    v_mad_i32_i24 v11, v14, s55, v43
    v_bitop3_b32 v12, v6, v13, v12 bitop3:0xca
    v_lshl_add_u32 v11, v11, 17, s40
    v_lshlrev_b16 v14, 8, v14
    v_lshrrev_b32 v13, 2, v27
    v_add_u32 v43, v12, v11
    v_bitop3_b32 v27, v5, v13, v14 bitop3:0xea
    ds_add_u32 v27, v2
    v_cvt_pk_bf16_f32 v85, v9, v10
    v_perm_b32 v12, v85, v85, s41
    v_bitop3_b32 v42, v4, v12, v42 bitop3:0xca
    v_perm_b32 v13, v85, v85, s42
    v_bitop3_b32 v43, v4, v13, v43 bitop3:0xca
    s_waitcnt vmcnt(23)
    v_lshlrev_b32 v7, 16, v86
    v_and_b32 v8, 0xffff0000, v86
    v_lshlrev_b32 v9, 16, v87
    v_and_b32 v10, 0xffff0000, v87
    v_mul_f32 v7, 0.15915494, v7
    v_mul_f32 v8, 0.15915494, v8
    v_mul_f32 v9, 0.15915494, v9
    v_mul_f32 v10, 0.15915494, v10
    v_mul_hi_u32_u24 v14, 429497, v48
    v_lshrrev_b32 v12, 3, v52
    v_cos_f32 v7, v7
    v_lshlrev_b16 v13, 3, v52
    v_mad_i32_i24 v11, v14, s55, v48
    v_bitop3_b32 v12, v6, v13, v12 bitop3:0xca
    v_lshl_add_u32 v11, v11, 17, s40
    v_lshlrev_b16 v14, 8, v14
    v_lshrrev_b32 v13, 2, v52
    v_add_u32 v48, v12, v11
    v_bitop3_b32 v52, v5, v13, v14 bitop3:0xea
    ds_add_u32 v52, v2
    v_mul_hi_u32_u24 v14, 429497, v49
    v_lshrrev_b32 v12, 3, v53
    v_cos_f32 v8, v8
    v_lshlrev_b16 v13, 3, v53
    v_mad_i32_i24 v11, v14, s55, v49
    v_bitop3_b32 v12, v6, v13, v12 bitop3:0xca
    v_lshl_add_u32 v11, v11, 17, s40
    v_lshlrev_b16 v14, 8, v14
    v_lshrrev_b32 v13, 2, v53
    v_add_u32 v49, v12, v11
    v_bitop3_b32 v53, v5, v13, v14 bitop3:0xea
    ds_add_u32 v53, v2
    v_cvt_pk_bf16_f32 v86, v7, v8
    v_perm_b32 v12, v86, v86, s41
    v_bitop3_b32 v48, v4, v12, v48 bitop3:0xca
    v_perm_b32 v13, v86, v86, s42
    v_bitop3_b32 v49, v4, v13, v49 bitop3:0xca
    v_mul_hi_u32_u24 v14, 429497, v50
    v_lshrrev_b32 v12, 3, v54
    v_cos_f32 v9, v9
    v_lshlrev_b16 v13, 3, v54
    v_mad_i32_i24 v11, v14, s55, v50
    v_bitop3_b32 v12, v6, v13, v12 bitop3:0xca
    v_lshl_add_u32 v11, v11, 17, s40
    v_lshlrev_b16 v14, 8, v14
    v_lshrrev_b32 v13, 2, v54
    v_add_u32 v50, v12, v11
    v_bitop3_b32 v54, v5, v13, v14 bitop3:0xea
    ds_add_u32 v54, v2
    v_mul_hi_u32_u24 v14, 429497, v51
    v_lshrrev_b32 v12, 3, v55
    v_cos_f32 v10, v10
    v_lshlrev_b16 v13, 3, v55
    v_mad_i32_i24 v11, v14, s55, v51
    v_bitop3_b32 v12, v6, v13, v12 bitop3:0xca
    v_lshl_add_u32 v11, v11, 17, s40
    v_lshlrev_b16 v14, 8, v14
    v_lshrrev_b32 v13, 2, v55
    v_add_u32 v51, v12, v11
    v_bitop3_b32 v55, v5, v13, v14 bitop3:0xea
    ds_add_u32 v55, v2
    v_cvt_pk_bf16_f32 v87, v9, v10
    v_perm_b32 v12, v87, v87, s41
    v_bitop3_b32 v50, v4, v12, v50 bitop3:0xca
    v_perm_b32 v13, v87, v87, s42
    v_bitop3_b32 v51, v4, v13, v51 bitop3:0xca
    s_waitcnt vmcnt(18)
    v_lshlrev_b32 v7, 16, v56
    v_and_b32 v8, 0xffff0000, v56
    v_lshlrev_b32 v9, 16, v57
    v_and_b32 v10, 0xffff0000, v57
    v_mul_f32 v7, 0.15915494, v7
    v_mul_f32 v8, 0.15915494, v8
    v_mul_f32 v9, 0.15915494, v9
    v_mul_f32 v10, 0.15915494, v10
    v_mul_hi_u32_u24 v14, 429497, v68
    v_lshrrev_b32 v12, 3, v72
    v_cos_f32 v7, v7
    v_lshlrev_b16 v13, 3, v72
    v_mad_i32_i24 v11, v14, s55, v68
    v_bitop3_b32 v12, v6, v13, v12 bitop3:0xca
    v_lshl_add_u32 v11, v11, 17, s40
    v_lshlrev_b16 v14, 8, v14
    v_lshrrev_b32 v13, 2, v72
    v_add_u32 v68, v12, v11
    v_bitop3_b32 v72, v5, v13, v14 bitop3:0xea
    ds_add_u32 v72, v2
    v_mul_hi_u32_u24 v14, 429497, v69
    v_lshrrev_b32 v12, 3, v73
    v_cos_f32 v8, v8
    v_lshlrev_b16 v13, 3, v73
    v_mad_i32_i24 v11, v14, s55, v69
    v_bitop3_b32 v12, v6, v13, v12 bitop3:0xca
    v_lshl_add_u32 v11, v11, 17, s40
    v_lshlrev_b16 v14, 8, v14
    v_lshrrev_b32 v13, 2, v73
    v_add_u32 v69, v12, v11
    v_bitop3_b32 v73, v5, v13, v14 bitop3:0xea
    ds_add_u32 v73, v2
    v_cvt_pk_bf16_f32 v56, v7, v8
    v_perm_b32 v12, v56, v56, s41
    v_bitop3_b32 v68, v4, v12, v68 bitop3:0xca
    v_perm_b32 v13, v56, v56, s42
    v_bitop3_b32 v69, v4, v13, v69 bitop3:0xca
    v_mul_hi_u32_u24 v14, 429497, v70
    v_lshrrev_b32 v12, 3, v74
    v_cos_f32 v9, v9
    v_lshlrev_b16 v13, 3, v74
    v_mad_i32_i24 v11, v14, s55, v70
    v_bitop3_b32 v12, v6, v13, v12 bitop3:0xca
    v_lshl_add_u32 v11, v11, 17, s40
    v_lshlrev_b16 v14, 8, v14
    v_lshrrev_b32 v13, 2, v74
    v_add_u32 v70, v12, v11
    v_bitop3_b32 v74, v5, v13, v14 bitop3:0xea
    ds_add_u32 v74, v2
    v_mul_hi_u32_u24 v14, 429497, v71
    v_lshrrev_b32 v12, 3, v75
    v_cos_f32 v10, v10
    v_lshlrev_b16 v13, 3, v75
    v_mad_i32_i24 v11, v14, s55, v71
    v_bitop3_b32 v12, v6, v13, v12 bitop3:0xca
    v_lshl_add_u32 v11, v11, 17, s40
    v_lshlrev_b16 v14, 8, v14
    v_lshrrev_b32 v13, 2, v75
    v_add_u32 v71, v12, v11
    v_bitop3_b32 v75, v5, v13, v14 bitop3:0xea
    ds_add_u32 v75, v2
    v_cvt_pk_bf16_f32 v57, v9, v10
    v_perm_b32 v12, v57, v57, s41
    v_bitop3_b32 v70, v4, v12, v70 bitop3:0xca
    v_perm_b32 v13, v57, v57, s42
    v_bitop3_b32 v71, v4, v13, v71 bitop3:0xca
    s_add_u32 s44, s35, 0x5488000
    buffer_store_dwordx4 v[16:19], v0, s[20:23], s44 offen sc1
    s_add_u32 s45, s33, 0x8000000
    s_nop 0
    buffer_load_dwordx4 v[16:19], v0, s[8:11], s45 offen nt
    s_waitcnt vmcnt(17)
    v_lshlrev_b32 v7, 16, v58
    v_and_b32 v8, 0xffff0000, v58
    v_lshlrev_b32 v9, 16, v59
    v_and_b32 v10, 0xffff0000, v59
    v_mul_f32 v7, 0.15915494, v7
    v_mul_f32 v8, 0.15915494, v8
    v_mul_f32 v9, 0.15915494, v9
    v_mul_f32 v10, 0.15915494, v10
    v_mul_hi_u32_u24 v14, 429497, v76
    v_lshrrev_b32 v12, 3, v80
    v_cos_f32 v7, v7
    v_lshlrev_b16 v13, 3, v80
    v_mad_i32_i24 v11, v14, s55, v76
    v_bitop3_b32 v12, v6, v13, v12 bitop3:0xca
    v_lshl_add_u32 v11, v11, 17, s40
    v_lshlrev_b16 v14, 8, v14
    v_lshrrev_b32 v13, 2, v80
    v_add_u32 v76, v12, v11
    v_bitop3_b32 v80, v5, v13, v14 bitop3:0xea
    ds_add_u32 v80, v2
    v_mul_hi_u32_u24 v14, 429497, v77
    v_lshrrev_b32 v12, 3, v81
    v_cos_f32 v8, v8
    v_lshlrev_b16 v13, 3, v81
    v_mad_i32_i24 v11, v14, s55, v77
    v_bitop3_b32 v12, v6, v13, v12 bitop3:0xca
    v_lshl_add_u32 v11, v11, 17, s40
    v_lshlrev_b16 v14, 8, v14
    v_lshrrev_b32 v13, 2, v81
    v_add_u32 v77, v12, v11
    v_bitop3_b32 v81, v5, v13, v14 bitop3:0xea
    ds_add_u32 v81, v2
    v_cvt_pk_bf16_f32 v58, v7, v8
    v_perm_b32 v12, v58, v58, s41
    v_bitop3_b32 v76, v4, v12, v76 bitop3:0xca
    v_perm_b32 v13, v58, v58, s42
    v_bitop3_b32 v77, v4, v13, v77 bitop3:0xca
    v_mul_hi_u32_u24 v14, 429497, v78
    v_lshrrev_b32 v12, 3, v82
    v_cos_f32 v9, v9
    v_lshlrev_b16 v13, 3, v82
    v_mad_i32_i24 v11, v14, s55, v78
    v_bitop3_b32 v12, v6, v13, v12 bitop3:0xca
    v_lshl_add_u32 v11, v11, 17, s40
    v_lshlrev_b16 v14, 8, v14
    v_lshrrev_b32 v13, 2, v82
    v_add_u32 v78, v12, v11
    v_bitop3_b32 v82, v5, v13, v14 bitop3:0xea
    ds_add_u32 v82, v2
    v_mul_hi_u32_u24 v14, 429497, v79
    v_lshrrev_b32 v12, 3, v83
    v_cos_f32 v10, v10
    v_lshlrev_b16 v13, 3, v83
    v_mad_i32_i24 v11, v14, s55, v79
    v_bitop3_b32 v12, v6, v13, v12 bitop3:0xca
    v_lshl_add_u32 v11, v11, 17, s40
    v_lshlrev_b16 v14, 8, v14
    v_lshrrev_b32 v13, 2, v83
    v_add_u32 v79, v12, v11
    v_bitop3_b32 v83, v5, v13, v14 bitop3:0xea
    ds_add_u32 v83, v2
    v_cvt_pk_bf16_f32 v59, v9, v10
    v_perm_b32 v12, v59, v59, s41
    v_bitop3_b32 v78, v4, v12, v78 bitop3:0xca
    v_perm_b32 v13, v59, v59, s42
    v_bitop3_b32 v79, v4, v13, v79 bitop3:0xca
    s_mov_b32 s68, s56
    s_mov_b32 s69, s57
    s_mov_b32 s70, 0x100
    s_mov_b32 s71, 0x20000
    v_mov_b32 v3, 1
    s_cmp_lg_u32 s32, 15
    s_cbranch_scc1 L1_tk
    s_mov_b64 exec, 1
    buffer_atomic_add v3, off, s[68:71], 0 sc0
    s_mov_b64 exec, -1
L1_tk:
    s_waitcnt vmcnt(13)
    v_lshlrev_b32 v7, 16, v100
    v_and_b32 v8, 0xffff0000, v100
    v_lshlrev_b32 v9, 16, v101
    v_and_b32 v10, 0xffff0000, v101
    v_mul_f32 v7, 0.15915494, v7
    v_mul_f32 v8, 0.15915494, v8
    v_mul_f32 v9, 0.15915494, v9
    v_mul_f32 v10, 0.15915494, v10
    v_mul_hi_u32_u24 v14, 429497, v64
    v_lshrrev_b32 v12, 3, v96
    v_cos_f32 v7, v7
    v_lshlrev_b16 v13, 3, v96
    v_mad_i32_i24 v11, v14, s55, v64
    v_bitop3_b32 v12, v6, v13, v12 bitop3:0xca
    v_lshl_add_u32 v11, v11, 17, s40
    v_lshlrev_b16 v14, 8, v14
    v_lshrrev_b32 v13, 2, v96
    v_add_u32 v64, v12, v11
    v_bitop3_b32 v96, v5, v13, v14 bitop3:0xea
    ds_add_u32 v96, v2
    v_mul_hi_u32_u24 v14, 429497, v65
    v_lshrrev_b32 v12, 3, v97
    v_cos_f32 v8, v8
    v_lshlrev_b16 v13, 3, v97
    v_mad_i32_i24 v11, v14, s55, v65
    v_bitop3_b32 v12, v6, v13, v12 bitop3:0xca
    v_lshl_add_u32 v11, v11, 17, s40
    v_lshlrev_b16 v14, 8, v14
    v_lshrrev_b32 v13, 2, v97
    v_add_u32 v65, v12, v11
    v_bitop3_b32 v97, v5, v13, v14 bitop3:0xea
    ds_add_u32 v97, v2
    v_cvt_pk_bf16_f32 v100, v7, v8
    v_perm_b32 v12, v100, v100, s41
    v_bitop3_b32 v64, v4, v12, v64 bitop3:0xca
    v_perm_b32 v13, v100, v100, s42
    v_bitop3_b32 v65, v4, v13, v65 bitop3:0xca
    v_mul_hi_u32_u24 v14, 429497, v66
    v_lshrrev_b32 v12, 3, v98
    v_cos_f32 v9, v9
    v_lshlrev_b16 v13, 3, v98
    v_mad_i32_i24 v11, v14, s55, v66
    v_bitop3_b32 v12, v6, v13, v12 bitop3:0xca
    v_lshl_add_u32 v11, v11, 17, s40
    v_lshlrev_b16 v14, 8, v14
    v_lshrrev_b32 v13, 2, v98
    v_add_u32 v66, v12, v11
    v_bitop3_b32 v98, v5, v13, v14 bitop3:0xea
    ds_add_u32 v98, v2
    v_mul_hi_u32_u24 v14, 429497, v67
    v_lshrrev_b32 v12, 3, v99
    v_cos_f32 v10, v10
    v_lshlrev_b16 v13, 3, v99
    v_mad_i32_i24 v11, v14, s55, v67
    v_bitop3_b32 v12, v6, v13, v12 bitop3:0xca
    v_lshl_add_u32 v11, v11, 17, s40
    v_lshlrev_b16 v14, 8, v14
    v_lshrrev_b32 v13, 2, v99
    v_add_u32 v67, v12, v11
    v_bitop3_b32 v99, v5, v13, v14 bitop3:0xea
    ds_add_u32 v99, v2
    v_cvt_pk_bf16_f32 v101, v9, v10
    v_perm_b32 v12, v101, v101, s41
    v_bitop3_b32 v66, v4, v12, v66 bitop3:0xca
    v_perm_b32 v13, v101, v101, s42
    v_bitop3_b32 v67, v4, v13, v67 bitop3:0xca
    s_waitcnt vmcnt(10)
    v_lshlrev_b32 v7, 16, v102
    v_and_b32 v8, 0xffff0000, v102
    v_lshlrev_b32 v9, 16, v103
    v_and_b32 v10, 0xffff0000, v103
    v_mul_f32 v7, 0.15915494, v7
    v_mul_f32 v8, 0.15915494, v8
    v_mul_f32 v9, 0.15915494, v9
    v_mul_f32 v10, 0.15915494, v10
    v_mul_hi_u32_u24 v14, 429497, v60
    v_lshrrev_b32 v12, 3, v108
    v_cos_f32 v7, v7
    v_lshlrev_b16 v13, 3, v108
    v_mad_i32_i24 v11, v14, s55, v60
    v_bitop3_b32 v12, v6, v13, v12 bitop3:0xca
    v_lshl_add_u32 v11, v11, 17, s40
    v_lshlrev_b16 v14, 8, v14
    v_lshrrev_b32 v13, 2, v108
    v_add_u32 v60, v12, v11
    v_bitop3_b32 v108, v5, v13, v14 bitop3:0xea
    ds_add_u32 v108, v2
    v_mul_hi_u32_u24 v14, 429497, v61
    v_lshrrev_b32 v12, 3, v109
    v_cos_f32 v8, v8
    v_lshlrev_b16 v13, 3, v109
    v_mad_i32_i24 v11, v14, s55, v61
    v_bitop3_b32 v12, v6, v13, v12 bitop3:0xca
    v_lshl_add_u32 v11, v11, 17, s40
    v_lshlrev_b16 v14, 8, v14
    v_lshrrev_b32 v13, 2, v109
    v_add_u32 v61, v12, v11
    v_bitop3_b32 v109, v5, v13, v14 bitop3:0xea
    ds_add_u32 v109, v2
    v_cvt_pk_bf16_f32 v102, v7, v8
    v_perm_b32 v12, v102, v102, s41
    v_bitop3_b32 v60, v4, v12, v60 bitop3:0xca
    v_perm_b32 v13, v102, v102, s42
    v_bitop3_b32 v61, v4, v13, v61 bitop3:0xca
    v_mul_hi_u32_u24 v14, 429497, v62
    v_lshrrev_b32 v12, 3, v110
    v_cos_f32 v9, v9
    v_lshlrev_b16 v13, 3, v110
    v_mad_i32_i24 v11, v14, s55, v62
    v_bitop3_b32 v12, v6, v13, v12 bitop3:0xca
    v_lshl_add_u32 v11, v11, 17, s40
    v_lshlrev_b16 v14, 8, v14
    v_lshrrev_b32 v13, 2, v110
    v_add_u32 v62, v12, v11
    v_bitop3_b32 v110, v5, v13, v14 bitop3:0xea
    ds_add_u32 v110, v2
    v_mul_hi_u32_u24 v14, 429497, v63
    v_lshrrev_b32 v12, 3, v111
    v_cos_f32 v10, v10
    v_lshlrev_b16 v13, 3, v111
    v_mad_i32_i24 v11, v14, s55, v63
    v_bitop3_b32 v12, v6, v13, v12 bitop3:0xca
    v_lshl_add_u32 v11, v11, 17, s40
    v_lshlrev_b16 v14, 8, v14
    v_lshrrev_b32 v13, 2, v111
    v_add_u32 v63, v12, v11
    v_bitop3_b32 v111, v5, v13, v14 bitop3:0xea
    ds_add_u32 v111, v2
    v_cvt_pk_bf16_f32 v103, v9, v10
    v_perm_b32 v12, v103, v103, s41
    v_bitop3_b32 v62, v4, v12, v62 bitop3:0xca
    v_perm_b32 v13, v103, v103, s42
    v_bitop3_b32 v63, v4, v13, v63 bitop3:0xca
    s_add_u32 s46, s35, 0x548c000
    buffer_store_dwordx4 v[120:123], v0, s[20:23], s46 offen sc1
    s_add_u32 s47, s33, 0x8000000
    s_nop 0
    buffer_load_dwordx4 v[120:123], v0, s[12:15], s47 offen nt
    s_waitcnt vmcnt(8)
    v_lshlrev_b32 v7, 16, v104
    v_and_b32 v8, 0xffff0000, v104
    v_lshlrev_b32 v9, 16, v105
    v_and_b32 v10, 0xffff0000, v105
    v_mul_f32 v7, 0.15915494, v7
    v_mul_f32 v8, 0.15915494, v8
    v_mul_f32 v9, 0.15915494, v9
    v_mul_f32 v10, 0.15915494, v10
    v_mul_hi_u32_u24 v14, 429497, v112
    v_lshrrev_b32 v12, 3, v88
    v_cos_f32 v7, v7
    v_lshlrev_b16 v13, 3, v88
    v_mad_i32_i24 v11, v14, s55, v112
    v_bitop3_b32 v12, v6, v13, v12 bitop3:0xca
    v_lshl_add_u32 v11, v11, 17, s40
    v_lshlrev_b16 v14, 8, v14
    v_lshrrev_b32 v13, 2, v88
    v_add_u32 v112, v12, v11
    v_bitop3_b32 v88, v5, v13, v14 bitop3:0xea
    ds_add_u32 v88, v2
    v_mul_hi_u32_u24 v14, 429497, v113
    v_lshrrev_b32 v12, 3, v89
    v_cos_f32 v8, v8
    v_lshlrev_b16 v13, 3, v89
    v_mad_i32_i24 v11, v14, s55, v113
    v_bitop3_b32 v12, v6, v13, v12 bitop3:0xca
    v_lshl_add_u32 v11, v11, 17, s40
    v_lshlrev_b16 v14, 8, v14
    v_lshrrev_b32 v13, 2, v89
    v_add_u32 v113, v12, v11
    v_bitop3_b32 v89, v5, v13, v14 bitop3:0xea
    ds_add_u32 v89, v2
    v_cvt_pk_bf16_f32 v104, v7, v8
    v_perm_b32 v12, v104, v104, s41
    v_bitop3_b32 v112, v4, v12, v112 bitop3:0xca
    v_perm_b32 v13, v104, v104, s42
    v_bitop3_b32 v113, v4, v13, v113 bitop3:0xca
    v_mul_hi_u32_u24 v14, 429497, v114
    v_lshrrev_b32 v12, 3, v90
    v_cos_f32 v9, v9
    v_lshlrev_b16 v13, 3, v90
    v_mad_i32_i24 v11, v14, s55, v114
    v_bitop3_b32 v12, v6, v13, v12 bitop3:0xca
    v_lshl_add_u32 v11, v11, 17, s40
    v_lshlrev_b16 v14, 8, v14
    v_lshrrev_b32 v13, 2, v90
    v_add_u32 v114, v12, v11
    v_bitop3_b32 v90, v5, v13, v14 bitop3:0xea
    ds_add_u32 v90, v2
    v_mul_hi_u32_u24 v14, 429497, v115
    v_lshrrev_b32 v12, 3, v91
    v_cos_f32 v10, v10
    v_lshlrev_b16 v13, 3, v91
    v_mad_i32_i24 v11, v14, s55, v115
    v_bitop3_b32 v12, v6, v13, v12 bitop3:0xca
    v_lshl_add_u32 v11, v11, 17, s40
    v_lshlrev_b16 v14, 8, v14
    v_lshrrev_b32 v13, 2, v91
    v_add_u32 v115, v12, v11
    v_bitop3_b32 v91, v5, v13, v14 bitop3:0xea
    ds_add_u32 v91, v2
    v_cvt_pk_bf16_f32 v105, v9, v10
    v_perm_b32 v12, v105, v105, s41
    v_bitop3_b32 v114, v4, v12, v114 bitop3:0xca
    v_perm_b32 v13, v105, v105, s42
    v_bitop3_b32 v115, v4, v13, v115 bitop3:0xca
    s_waitcnt vmcnt(4)
    v_lshlrev_b32 v7, 16, v106
    v_and_b32 v8, 0xffff0000, v106
    v_lshlrev_b32 v9, 16, v107
    v_and_b32 v10, 0xffff0000, v107
    v_mul_f32 v7, 0.15915494, v7
    v_mul_f32 v8, 0.15915494, v8
    v_mul_f32 v9, 0.15915494, v9
    v_mul_f32 v10, 0.15915494, v10
    v_mul_hi_u32_u24 v14, 429497, v116
    v_lshrrev_b32 v12, 3, v92
    v_cos_f32 v7, v7
    v_lshlrev_b16 v13, 3, v92
    v_mad_i32_i24 v11, v14, s55, v116
    v_bitop3_b32 v12, v6, v13, v12 bitop3:0xca
    v_lshl_add_u32 v11, v11, 17, s40
    v_lshlrev_b16 v14, 8, v14
    v_lshrrev_b32 v13, 2, v92
    v_add_u32 v116, v12, v11
    v_bitop3_b32 v92, v5, v13, v14 bitop3:0xea
    ds_add_u32 v92, v2
    v_mul_hi_u32_u24 v14, 429497, v117
    v_lshrrev_b32 v12, 3, v93
    v_cos_f32 v8, v8
    v_lshlrev_b16 v13, 3, v93
    v_mad_i32_i24 v11, v14, s55, v117
    v_bitop3_b32 v12, v6, v13, v12 bitop3:0xca
    v_lshl_add_u32 v11, v11, 17, s40
    v_lshlrev_b16 v14, 8, v14
    v_lshrrev_b32 v13, 2, v93
    v_add_u32 v117, v12, v11
    v_bitop3_b32 v93, v5, v13, v14 bitop3:0xea
    ds_add_u32 v93, v2
    v_cvt_pk_bf16_f32 v106, v7, v8
    v_perm_b32 v12, v106, v106, s41
    v_bitop3_b32 v116, v4, v12, v116 bitop3:0xca
    v_perm_b32 v13, v106, v106, s42
    v_bitop3_b32 v117, v4, v13, v117 bitop3:0xca
    v_mul_hi_u32_u24 v14, 429497, v118
    v_lshrrev_b32 v12, 3, v94
    v_cos_f32 v9, v9
    v_lshlrev_b16 v13, 3, v94
    v_mad_i32_i24 v11, v14, s55, v118
    v_bitop3_b32 v12, v6, v13, v12 bitop3:0xca
    v_lshl_add_u32 v11, v11, 17, s40
    v_lshlrev_b16 v14, 8, v14
    v_lshrrev_b32 v13, 2, v94
    v_add_u32 v118, v12, v11
    v_bitop3_b32 v94, v5, v13, v14 bitop3:0xea
    ds_add_u32 v94, v2
    v_mul_hi_u32_u24 v14, 429497, v119
    v_lshrrev_b32 v12, 3, v95
    v_cos_f32 v10, v10
    v_lshlrev_b16 v13, 3, v95
    v_mad_i32_i24 v11, v14, s55, v119
    v_bitop3_b32 v12, v6, v13, v12 bitop3:0xca
    v_lshl_add_u32 v11, v11, 17, s40
    v_lshlrev_b16 v14, 8, v14
    v_lshrrev_b32 v13, 2, v95
    v_add_u32 v119, v12, v11
    v_bitop3_b32 v95, v5, v13, v14 bitop3:0xea
    ds_add_u32 v95, v2
    v_cvt_pk_bf16_f32 v107, v9, v10
    v_perm_b32 v12, v107, v107, s41
    v_bitop3_b32 v118, v4, v12, v118 bitop3:0xca
    v_perm_b32 v13, v107, v107, s42
    v_bitop3_b32 v119, v4, v13, v119 bitop3:0xca
    v_lshrrev_b32 v8, 2, v0
    v_and_b32 v7, 0x3c00, v0
    v_bitop3_b32 v7, v5, v8, v7 bitop3:0xea
    s_waitcnt lgkmcnt(0)
    s_barrier
    ds_read2st64_b32 v[8:9], v7 offset0:0 offset1:1
    ds_read2st64_b32 v[10:11], v7 offset0:2 offset1:3
    s_add_u32 s44, s35, 0x5490000
    buffer_store_dwordx4 v[44:47], v0, s[20:23], s44 offen sc1
    s_add_u32 s45, s34, 0x4000000
    s_nop 0
    buffer_load_dwordx2 v[44:45], v1, s[16:19], s45 offen nt
    s_add_u32 s46, s34, 0x4200000
    buffer_load_dwordx2 v[46:47], v1, s[16:19], s46 offen nt
    s_waitcnt lgkmcnt(0)
    v_lshl_or_b32 v12, v9, 16, v8
    v_lshl_or_b32 v13, v11, 16, v10
    v_mov_b32 v14, v12
    v_mov_b32 v15, v13
    s_nop 0
    v_add_u32_dpp v14, v14, v14 row_shr:1 row_mask:0xf bank_mask:0xf bound_ctrl:1
    v_add_u32_dpp v15, v15, v15 row_shr:1 row_mask:0xf bank_mask:0xf bound_ctrl:1
    s_nop 0
    v_add_u32_dpp v14, v14, v14 row_shr:2 row_mask:0xf bank_mask:0xf bound_ctrl:1
    v_add_u32_dpp v15, v15, v15 row_shr:2 row_mask:0xf bank_mask:0xf bound_ctrl:1
    s_nop 0
    v_add_u32_dpp v14, v14, v14 row_shr:4 row_mask:0xf bank_mask:0xf bound_ctrl:1
    v_add_u32_dpp v15, v15, v15 row_shr:4 row_mask:0xf bank_mask:0xf bound_ctrl:1
    s_nop 0
    v_add_u32_dpp v14, v14, v14 row_shr:8 row_mask:0xf bank_mask:0xf bound_ctrl:1
    v_add_u32_dpp v15, v15, v15 row_shr:8 row_mask:0xf bank_mask:0xf bound_ctrl:1
    s_nop 0
    v_add_u32_dpp v14, v14, v14 row_bcast:15 row_mask:0xa bank_mask:0xf
    v_add_u32_dpp v15, v15, v15 row_bcast:15 row_mask:0xa bank_mask:0xf
    s_nop 0
    v_add_u32_dpp v14, v14, v14 row_bcast:31 row_mask:0xc bank_mask:0xf
    v_add_u32_dpp v15, v15, v15 row_bcast:31 row_mask:0xc bank_mask:0xf
    v_readlane_b32 s48, v14, 63
    v_readlane_b32 s49, v15, 63
    s_lshl_b32 s54, s32, 2
    v_mov_b32 v8, s54
    s_and_b32 s50, s48, 0xffff
    s_lshr_b32 s51, s48, 16
    s_and_b32 s52, s49, 0xffff
    s_lshr_b32 s53, s49, 16
    s_add_u32 s51, s51, s50
    s_add_u32 s52, s52, s51
    s_add_u32 s53, s53, s52
    v_mov_b32 v9, s53
    s_mov_b64 exec, 1
    ds_write_b32 v8, v9 offset:16384
    s_waitcnt vmcnt(5)
    ds_write_b32 v8, v3 offset:16448
    s_mov_b64 exec, -1
    v_and_b32 v8, 60, v7
    s_waitcnt lgkmcnt(0)
    s_barrier
    ds_read_b32 v9, v8 offset:16384
    ds_read_b32 v10, v8 offset:16448
    s_waitcnt lgkmcnt(0)
    v_readlane_b32 s84, v10, 15
    s_min_u32 s4, s84, 136
    s_min_u32 s5, s84, 176
    s_min_u32 s6, s84, 216
    s_add_u32 s4, s4, s5
    s_add_u32 s4, s4, s6
    s_add_u32 s4, s4, 9467
    s_mov_b32 s4, s84
    s_lshl_b32 s58, s4, 14
    s_lshl_b32 s59, s4, 13
    s_mov_b32 s43, 5
    s_cmp_lt_u32 s84, 136
    s_addc_u32 s43, s43, 0
    s_cmp_lt_u32 s84, 176
    s_addc_u32 s43, s43, 0
    s_cmp_lt_u32 s84, 216
    s_addc_u32 s43, s43, 0
    v_add_u32_dpp v9, v9, v9 row_shr:1 row_mask:0xf bank_mask:0xf bound_ctrl:1
    s_nop 1
    v_add_u32_dpp v9, v9, v9 row_shr:2 row_mask:0xf bank_mask:0xf bound_ctrl:1
    s_nop 1
    v_add_u32_dpp v9, v9, v9 row_shr:4 row_mask:0xf bank_mask:0xf bound_ctrl:1
    s_nop 1
    v_add_u32_dpp v9, v9, v9 row_shr:8 row_mask:0xf bank_mask:0xf bound_ctrl:1
    s_nop 0
    v_readlane_b32 s54, v9, s32
    s_sub_u32 s54, s54, s53
    s_add_u32 s50, s50, s54
    s_add_u32 s51, s51, s54
    s_add_u32 s52, s52, s54
    s_pack_ll_b32_b16 s48, s54, s50
    s_pack_ll_b32_b16 s49, s51, s52
    v_add_u32 v14, s48, v14
    v_add_u32 v15, s49, v15
    v_sub_u32 v12, v14, v12
    v_sub_u32 v13, v15, v13
    v_and_b32 v8, 0xffff, v12
    v_lshrrev_b32 v9, 16, v12
    v_and_b32 v10, 0xffff, v13
    v_lshrrev_b32 v11, 16, v13
    ds_write2st64_b32 v7, v8, v9 offset0:0 offset1:1
    ds_write2st64_b32 v7, v10, v11 offset0:2 offset1:3
    s_waitcnt lgkmcnt(0)
    s_barrier
    ds_add_rtn_u32 v24, v24, v2
    ds_add_rtn_u32 v25, v25, v2
    ds_add_rtn_u32 v26, v26, v2
    ds_add_rtn_u32 v27, v27, v2
    s_add_u32 s47, s36, 0x7ec0000
    v_and_b32 v11, 0x3f0, v0
    v_add_u32 v11, v11, v11
    buffer_store_dwordx2 v[12:13], v11, s[24:27], s47 offen
    s_bitset0_b64 exec, 63
    s_not_b64 exec, exec
    buffer_store_dwordx2 v[14:15], v11, s[24:27], s47 offen offset:32
    s_mov_b64 exec, -1
    v_cmp_le_u32 vcc, s37, v0
    v_add_u32 v10, 8320, v0
    s_cmp_lg_u32 s32, 0
    v_cndmask_b32 v10, v0, v10, vcc
    s_cbranch_scc1 L1_p4
    s_add_u32 s44, s35, 0x7ec0000
    s_mov_b64 exec, 0xff
    buffer_store_dwordx4 v[12:15], v10, s[24:27], s44 offen
    s_mov_b64 exec, -1
L1_p4:
    ds_add_rtn_u32 v52, v52, v2
    ds_add_rtn_u32 v53, v53, v2
    ds_add_rtn_u32 v54, v54, v2
    ds_add_rtn_u32 v55, v55, v2
    ds_add_rtn_u32 v72, v72, v2
    ds_add_rtn_u32 v73, v73, v2
    ds_add_rtn_u32 v74, v74, v2
    ds_add_rtn_u32 v75, v75, v2
    s_add_u32 s45, s35, 0x5494000
    buffer_store_dwordx4 v[20:23], v0, s[20:23], s45 offen sc1
    s_add_u32 s46, s33, 0x8400000
    s_nop 0
    buffer_load_dwordx4 v[20:23], v0, s[8:11], s46 offen nt
    ds_add_rtn_u32 v80, v80, v2
    ds_add_rtn_u32 v81, v81, v2
    ds_add_rtn_u32 v82, v82, v2
    ds_add_rtn_u32 v83, v83, v2
    ds_add_rtn_u32 v96, v96, v2
    ds_add_rtn_u32 v97, v97, v2
    ds_add_rtn_u32 v98, v98, v2
    ds_add_rtn_u32 v99, v99, v2
    ds_add_rtn_u32 v108, v108, v2
    ds_add_rtn_u32 v109, v109, v2
    ds_add_rtn_u32 v110, v110, v2
    ds_add_rtn_u32 v111, v111, v2
    s_add_u32 s47, s35, 0x5498000
    buffer_store_dwordx4 v[124:127], v0, s[20:23], s47 offen sc1
    s_add_u32 s44, s33, 0x8400000
    s_nop 0
    buffer_load_dwordx4 v[124:127], v0, s[12:15], s44 offen nt
    ds_add_rtn_u32 v88, v88, v2
    ds_add_rtn_u32 v89, v89, v2
    ds_add_rtn_u32 v90, v90, v2
    ds_add_rtn_u32 v91, v91, v2
    ds_add_rtn_u32 v92, v92, v2
    ds_add_rtn_u32 v93, v93, v2
    ds_add_rtn_u32 v94, v94, v2
    ds_add_rtn_u32 v95, v95, v2
    s_waitcnt lgkmcnt(0)
    s_barrier
    v_and_b32 v7, -4, v24
    v_lshl_add_u32 v8, v24, 2, v7
    ds_write_b32 v8, v40
    v_lshl_add_u32 v7, v7, 2, v24
    ds_write_b8 v7, v84 offset:16
    v_and_b32 v9, -4, v25
    v_lshl_add_u32 v10, v25, 2, v9
    ds_write_b32 v10, v41
    v_lshl_add_u32 v9, v9, 2, v25
    ds_write_b8_d16_hi v9, v84 offset:16
    v_and_b32 v7, -4, v26
    v_lshl_add_u32 v8, v26, 2, v7
    ds_write_b32 v8, v42
    v_lshl_add_u32 v7, v7, 2, v26
    ds_write_b8 v7, v85 offset:16
    v_and_b32 v9, -4, v27
    v_lshl_add_u32 v10, v27, 2, v9
    ds_write_b32 v10, v43
    v_lshl_add_u32 v9, v9, 2, v27
    ds_write_b8_d16_hi v9, v85 offset:16
    s_add_u32 s45, s35, 0x549c000
    buffer_store_dwordx4 v[32:35], v0, s[20:23], s45 offen sc1
    s_add_u32 s46, s33, 0x8800000
    buffer_load_dwordx4 v[40:43], v0, s[8:11], s46 offen nt
    s_add_u32 s47, s33, 0x8800000
    buffer_load_dwordx4 v[24:27], v0, s[12:15], s47 offen nt
    v_and_b32 v7, -4, v52
    v_lshl_add_u32 v8, v52, 2, v7
    ds_write_b32 v8, v48
    v_lshl_add_u32 v7, v7, 2, v52
    ds_write_b8 v7, v86 offset:16
    v_and_b32 v9, -4, v53
    v_lshl_add_u32 v10, v53, 2, v9
    ds_write_b32 v10, v49
    v_lshl_add_u32 v9, v9, 2, v53
    ds_write_b8_d16_hi v9, v86 offset:16
    v_and_b32 v7, -4, v54
    v_lshl_add_u32 v8, v54, 2, v7
    ds_write_b32 v8, v50
    v_lshl_add_u32 v7, v7, 2, v54
    ds_write_b8 v7, v87 offset:16
    v_and_b32 v9, -4, v55
    v_lshl_add_u32 v10, v55, 2, v9
    ds_write_b32 v10, v51
    v_lshl_add_u32 v9, v9, 2, v55
    ds_write_b8_d16_hi v9, v87 offset:16
    s_add_u32 s44, s34, 0x4400000
    buffer_load_dwordx2 v[32:33], v1, s[16:19], s44 offen nt
    s_add_u32 s45, s34, 0x4600000
    buffer_load_dwordx2 v[34:35], v1, s[16:19], s45 offen nt
    s_add_u32 s46, s33, 0x8c00000
    buffer_load_dwordx4 v[48:51], v0, s[8:11], s46 offen nt
    v_and_b32 v7, -4, v72
    v_lshl_add_u32 v8, v72, 2, v7
    ds_write_b32 v8, v68
    v_lshl_add_u32 v7, v7, 2, v72
    ds_write_b8 v7, v56 offset:16
    v_and_b32 v9, -4, v73
    v_lshl_add_u32 v10, v73, 2, v9
    ds_write_b32 v10, v69
    v_lshl_add_u32 v9, v9, 2, v73
    ds_write_b8_d16_hi v9, v56 offset:16
    v_and_b32 v7, -4, v74
    v_lshl_add_u32 v8, v74, 2, v7
    ds_write_b32 v8, v70
    v_lshl_add_u32 v7, v7, 2, v74
    ds_write_b8 v7, v57 offset:16
    v_and_b32 v9, -4, v75
    v_lshl_add_u32 v10, v75, 2, v9
    ds_write_b32 v10, v71
    v_lshl_add_u32 v9, v9, 2, v75
    ds_write_b8_d16_hi v9, v57 offset:16
    s_add_u32 s47, s35, 0x54a0000
    buffer_store_dwordx4 v[36:39], v0, s[20:23], s47 offen sc1
    s_add_u32 s44, s33, 0x8c00000
    buffer_load_dwordx4 v[52:55], v0, s[12:15], s44 offen nt
    v_and_b32 v7, -4, v80
    v_lshl_add_u32 v8, v80, 2, v7
    ds_write_b32 v8, v76
    v_lshl_add_u32 v7, v7, 2, v80
    ds_write_b8 v7, v58 offset:16
    v_and_b32 v9, -4, v81
    v_lshl_add_u32 v10, v81, 2, v9
    ds_write_b32 v10, v77
    v_lshl_add_u32 v9, v9, 2, v81
    ds_write_b8_d16_hi v9, v58 offset:16
    v_and_b32 v7, -4, v82
    v_lshl_add_u32 v8, v82, 2, v7
    ds_write_b32 v8, v78
    v_lshl_add_u32 v7, v7, 2, v82
    ds_write_b8 v7, v59 offset:16
    v_and_b32 v9, -4, v83
    v_lshl_add_u32 v10, v83, 2, v9
    ds_write_b32 v10, v79
    v_lshl_add_u32 v9, v9, 2, v83
    ds_write_b8_d16_hi v9, v59 offset:16
    s_add_u32 s45, s33, 0x9000000
    buffer_load_dwordx4 v[84:87], v0, s[8:11], s45 offen nt
    s_add_u32 s46, s33, 0x9000000
    buffer_load_dwordx4 v[68:71], v0, s[12:15], s46 offen nt
    v_and_b32 v7, -4, v96
    v_lshl_add_u32 v8, v96, 2, v7
    ds_write_b32 v8, v64
    v_lshl_add_u32 v7, v7, 2, v96
    ds_write_b8 v7, v100 offset:16
    v_and_b32 v9, -4, v97
    v_lshl_add_u32 v10, v97, 2, v9
    ds_write_b32 v10, v65
    v_lshl_add_u32 v9, v9, 2, v97
    ds_write_b8_d16_hi v9, v100 offset:16
    v_and_b32 v7, -4, v98
    v_lshl_add_u32 v8, v98, 2, v7
    ds_write_b32 v8, v66
    v_lshl_add_u32 v7, v7, 2, v98
    ds_write_b8 v7, v101 offset:16
    v_and_b32 v9, -4, v99
    v_lshl_add_u32 v10, v99, 2, v9
    ds_write_b32 v10, v67
    v_lshl_add_u32 v9, v9, 2, v99
    ds_write_b8_d16_hi v9, v101 offset:16
    s_add_u32 s47, s34, 0x4800000
    buffer_load_dwordx2 v[72:73], v1, s[16:19], s47 offen nt
    s_cmp_le_u32 s43, 5
    s_cselect_b32 s18, 0, s18
    s_add_u32 s44, s59, 0x4a00000
    buffer_load_dwordx2 v[74:75], v1, s[16:19], s44 offen nt
    s_cmp_le_u32 s43, 5
    s_cselect_b32 s10, 0, s10
    s_add_u32 s45, s58, 0x9400000
    buffer_load_dwordx4 v[36:39], v0, s[8:11], s45 offen nt
    v_and_b32 v7, -4, v108
    v_lshl_add_u32 v8, v108, 2, v7
    ds_write_b32 v8, v60
    v_lshl_add_u32 v7, v7, 2, v108
    ds_write_b8 v7, v102 offset:16
    v_and_b32 v9, -4, v109
    v_lshl_add_u32 v10, v109, 2, v9
    ds_write_b32 v10, v61
    v_lshl_add_u32 v9, v9, 2, v109
    ds_write_b8_d16_hi v9, v102 offset:16
    v_and_b32 v7, -4, v110
    v_lshl_add_u32 v8, v110, 2, v7
    ds_write_b32 v8, v62
    v_lshl_add_u32 v7, v7, 2, v110
    ds_write_b8 v7, v103 offset:16
    v_and_b32 v9, -4, v111
    v_lshl_add_u32 v10, v111, 2, v9
    ds_write_b32 v10, v63
    v_lshl_add_u32 v9, v9, 2, v111
    ds_write_b8_d16_hi v9, v103 offset:16
    s_add_u32 s46, s35, 0x54a4000
    buffer_store_dwordx4 v[28:31], v0, s[20:23], s46 offen sc1
    s_cmp_le_u32 s43, 5
    s_cselect_b32 s14, 0, s14
    s_add_u32 s47, s58, 0x9400000
    buffer_load_dwordx4 v[76:79], v0, s[12:15], s47 offen nt
    v_and_b32 v7, -4, v88
    v_lshl_add_u32 v8, v88, 2, v7
    ds_write_b32 v8, v112
    v_lshl_add_u32 v7, v7, 2, v88
    ds_write_b8 v7, v104 offset:16
    v_and_b32 v9, -4, v89
    v_lshl_add_u32 v10, v89, 2, v9
    ds_write_b32 v10, v113
    v_lshl_add_u32 v9, v9, 2, v89
    ds_write_b8_d16_hi v9, v104 offset:16
    v_and_b32 v7, -4, v90
    v_lshl_add_u32 v8, v90, 2, v7
    ds_write_b32 v8, v114
    v_lshl_add_u32 v7, v7, 2, v90
    ds_write_b8 v7, v105 offset:16
    v_and_b32 v9, -4, v91
    v_lshl_add_u32 v10, v91, 2, v9
    ds_write_b32 v10, v115
    v_lshl_add_u32 v9, v9, 2, v91
    ds_write_b8_d16_hi v9, v105 offset:16
    s_cmp_le_u32 s43, 6
    s_cselect_b32 s10, 0, s10
    s_add_u32 s44, s58, 0x9760000
    buffer_load_dwordx4 v[80:83], v0, s[8:11], s44 offen nt
    s_cmp_le_u32 s43, 6
    s_cselect_b32 s14, 0, s14
    s_add_u32 s45, s58, 0x9760000
    buffer_load_dwordx4 v[56:59], v0, s[12:15], s45 offen nt
    v_and_b32 v7, -4, v92
    v_lshl_add_u32 v8, v92, 2, v7
    ds_write_b32 v8, v116
    v_lshl_add_u32 v7, v7, 2, v92
    ds_write_b8 v7, v106 offset:16
    v_and_b32 v9, -4, v93
    v_lshl_add_u32 v10, v93, 2, v9
    ds_write_b32 v10, v117
    v_lshl_add_u32 v9, v9, 2, v93
    ds_write_b8_d16_hi v9, v106 offset:16
    v_and_b32 v7, -4, v94
    v_lshl_add_u32 v8, v94, 2, v7
    ds_write_b32 v8, v118
    v_lshl_add_u32 v7, v7, 2, v94
    ds_write_b8 v7, v107 offset:16
    v_and_b32 v9, -4, v95
    v_lshl_add_u32 v10, v95, 2, v9
    ds_write_b32 v10, v119
    v_lshl_add_u32 v9, v9, 2, v95
    ds_write_b8_d16_hi v9, v107 offset:16
    s_cmp_le_u32 s43, 6
    s_cselect_b32 s18, 0, s18
    s_add_u32 s46, s59, 0x4bb0000
    buffer_load_dwordx2 v[64:65], v1, s[16:19], s46 offen nt
    s_cmp_le_u32 s43, 7
    s_cselect_b32 s18, 0, s18
    s_add_u32 s47, s59, 0x4d10000
    buffer_load_dwordx2 v[66:67], v1, s[16:19], s47 offen nt
    v_add_u32 v7, 0x10000, v0
    v_add_u32 v12, 0x20000, v0
    v_mov_b32 v8, 0
    v_mov_b32 v9, 0
    v_mov_b32 v10, 0
    v_mov_b32 v11, 0
    s_waitcnt lgkmcnt(0)
    s_barrier
    ds_read_b128 v[96:99], v0 offset:0
    ds_write_b128 v0, v[8:11]
    ds_read_b128 v[60:63], v0 offset:16384
    ds_read_b128 v[108:111], v0 offset:32768
    ds_read_b128 v[100:103], v0 offset:49152
    ds_read_b128 v[28:31], v7 offset:0
    ds_read_b128 v[112:115], v7 offset:16384
    ds_read_b128 v[88:91], v7 offset:32768
    ds_read_b128 v[116:119], v7 offset:49152
    ds_read_b128 v[92:95], v12 offset:0
    ds_read_b128 v[104:107], v12 offset:16384
    s_waitcnt lgkmcnt(0)
    s_barrier
    s_add_u32 s44, s35, 0x7ec0000
    buffer_store_dwordx4 v[96:99], v0, s[20:23], s44 offen sc1
    s_cmp_le_u32 s43, 7
    s_cselect_b32 s10, 0, s10
    s_add_u32 s45, s58, 0x9a20000
    buffer_load_dwordx4 v[96:99], v0, s[8:11], s45 offen nt
    s_add_u32 s46, s35, 0x7ec4000
    buffer_store_dwordx4 v[60:63], v0, s[20:23], s46 offen sc1
    s_cmp_le_u32 s43, 7
    s_cselect_b32 s14, 0, s14
    s_add_u32 s47, s58, 0x9a20000
    buffer_load_dwordx4 v[60:63], v0, s[12:15], s47 offen nt
    s_waitcnt vmcnt(29)
    v_lshlrev_b32 v7, 16, v44
    v_and_b32 v8, 0xffff0000, v44
    v_lshlrev_b32 v9, 16, v45
    v_and_b32 v10, 0xffff0000, v45
    v_mul_f32 v7, 0.15915494, v7
    v_mul_f32 v8, 0.15915494, v8
    v_mul_f32 v9, 0.15915494, v9
    v_mul_f32 v10, 0.15915494, v10
    v_mul_hi_u32_u24 v14, 429497, v16
    v_lshrrev_b32 v12, 3, v120
    v_cos_f32 v7, v7
    v_lshlrev_b16 v13, 3, v120
    v_mad_i32_i24 v11, v14, s55, v16
    v_bitop3_b32 v12, v6, v13, v12 bitop3:0xca
    v_lshl_add_u32 v11, v11, 17, s40
    v_lshlrev_b16 v14, 8, v14
    v_lshrrev_b32 v13, 2, v120
    v_add_u32 v16, v12, v11
    v_bitop3_b32 v120, v5, v13, v14 bitop3:0xea
    ds_add_u32 v120, v2
    v_mul_hi_u32_u24 v14, 429497, v17
    v_lshrrev_b32 v12, 3, v121
    v_cos_f32 v8, v8
    v_lshlrev_b16 v13, 3, v121
    v_mad_i32_i24 v11, v14, s55, v17
    v_bitop3_b32 v12, v6, v13, v12 bitop3:0xca
    v_lshl_add_u32 v11, v11, 17, s40
    v_lshlrev_b16 v14, 8, v14
    v_lshrrev_b32 v13, 2, v121
    v_add_u32 v17, v12, v11
    v_bitop3_b32 v121, v5, v13, v14 bitop3:0xea
    ds_add_u32 v121, v2
    v_cvt_pk_bf16_f32 v44, v7, v8
    v_perm_b32 v12, v44, v44, s41
    v_bitop3_b32 v16, v4, v12, v16 bitop3:0xca
    v_perm_b32 v13, v44, v44, s42
    v_bitop3_b32 v17, v4, v13, v17 bitop3:0xca
    v_mul_hi_u32_u24 v14, 429497, v18
    v_lshrrev_b32 v12, 3, v122
    v_cos_f32 v9, v9
    v_lshlrev_b16 v13, 3, v122
    v_mad_i32_i24 v11, v14, s55, v18
    v_bitop3_b32 v12, v6, v13, v12 bitop3:0xca
    v_lshl_add_u32 v11, v11, 17, s40
    v_lshlrev_b16 v14, 8, v14
    v_lshrrev_b32 v13, 2, v122
    v_add_u32 v18, v12, v11
    v_bitop3_b32 v122, v5, v13, v14 bitop3:0xea
    ds_add_u32 v122, v2
    v_mul_hi_u32_u24 v14, 429497, v19
    v_lshrrev_b32 v12, 3, v123
    v_cos_f32 v10, v10
    v_lshlrev_b16 v13, 3, v123
    v_mad_i32_i24 v11, v14, s55, v19
    v_bitop3_b32 v12, v6, v13, v12 bitop3:0xca
    v_lshl_add_u32 v11, v11, 17, s40
    v_lshlrev_b16 v14, 8, v14
    v_lshrrev_b32 v13, 2, v123
    v_add_u32 v19, v12, v11
    v_bitop3_b32 v123, v5, v13, v14 bitop3:0xea
    ds_add_u32 v123, v2
    v_cvt_pk_bf16_f32 v45, v9, v10
    v_perm_b32 v12, v45, v45, s41
    v_bitop3_b32 v18, v4, v12, v18 bitop3:0xca
    v_perm_b32 v13, v45, v45, s42
    v_bitop3_b32 v19, v4, v13, v19 bitop3:0xca
    s_add_u32 s44, s35, 0x7ec8000
    buffer_store_dwordx4 v[108:111], v0, s[20:23], s44 offen sc1
    s_waitcnt vmcnt(24)
    v_lshlrev_b32 v7, 16, v46
    v_and_b32 v8, 0xffff0000, v46
    v_lshlrev_b32 v9, 16, v47
    v_and_b32 v10, 0xffff0000, v47
    v_mul_f32 v7, 0.15915494, v7
    v_mul_f32 v8, 0.15915494, v8
    v_mul_f32 v9, 0.15915494, v9
    v_mul_f32 v10, 0.15915494, v10
    v_mul_hi_u32_u24 v14, 429497, v20
    v_lshrrev_b32 v12, 3, v124
    v_cos_f32 v7, v7
    v_lshlrev_b16 v13, 3, v124
    v_mad_i32_i24 v11, v14, s55, v20
    v_bitop3_b32 v12, v6, v13, v12 bitop3:0xca
    v_lshl_add_u32 v11, v11, 17, s40
    v_lshlrev_b16 v14, 8, v14
    v_lshrrev_b32 v13, 2, v124
    v_add_u32 v20, v12, v11
    v_bitop3_b32 v124, v5, v13, v14 bitop3:0xea
    ds_add_u32 v124, v2
    v_mul_hi_u32_u24 v14, 429497, v21
    v_lshrrev_b32 v12, 3, v125
    v_cos_f32 v8, v8
    v_lshlrev_b16 v13, 3, v125
    v_mad_i32_i24 v11, v14, s55, v21
    v_bitop3_b32 v12, v6, v13, v12 bitop3:0xca
    v_lshl_add_u32 v11, v11, 17, s40
    v_lshlrev_b16 v14, 8, v14
    v_lshrrev_b32 v13, 2, v125
    v_add_u32 v21, v12, v11
    v_bitop3_b32 v125, v5, v13, v14 bitop3:0xea
    ds_add_u32 v125, v2
    v_cvt_pk_bf16_f32 v46, v7, v8
    v_perm_b32 v12, v46, v46, s41
    v_bitop3_b32 v20, v4, v12, v20 bitop3:0xca
    v_perm_b32 v13, v46, v46, s42
    v_bitop3_b32 v21, v4, v13, v21 bitop3:0xca
    v_mul_hi_u32_u24 v14, 429497, v22
    v_lshrrev_b32 v12, 3, v126
    v_cos_f32 v9, v9
    v_lshlrev_b16 v13, 3, v126
    v_mad_i32_i24 v11, v14, s55, v22
    v_bitop3_b32 v12, v6, v13, v12 bitop3:0xca
    v_lshl_add_u32 v11, v11, 17, s40
    v_lshlrev_b16 v14, 8, v14
    v_lshrrev_b32 v13, 2, v126
    v_add_u32 v22, v12, v11
    v_bitop3_b32 v126, v5, v13, v14 bitop3:0xea
    ds_add_u32 v126, v2
    v_mul_hi_u32_u24 v14, 429497, v23
    v_lshrrev_b32 v12, 3, v127
    v_cos_f32 v10, v10
    v_lshlrev_b16 v13, 3, v127
    v_mad_i32_i24 v11, v14, s55, v23
    v_bitop3_b32 v12, v6, v13, v12 bitop3:0xca
    v_lshl_add_u32 v11, v11, 17, s40
    v_lshlrev_b16 v14, 8, v14
    v_lshrrev_b32 v13, 2, v127
    v_add_u32 v23, v12, v11
    v_bitop3_b32 v127, v5, v13, v14 bitop3:0xea
    ds_add_u32 v127, v2
    v_cvt_pk_bf16_f32 v47, v9, v10
    v_perm_b32 v12, v47, v47, s41
    v_bitop3_b32 v22, v4, v12, v22 bitop3:0xca
    v_perm_b32 v13, v47, v47, s42
    v_bitop3_b32 v23, v4, v13, v23 bitop3:0xca
    s_waitcnt vmcnt(19)
    v_lshlrev_b32 v7, 16, v32
    v_and_b32 v8, 0xffff0000, v32
    v_lshlrev_b32 v9, 16, v33
    v_and_b32 v10, 0xffff0000, v33
    v_mul_f32 v7, 0.15915494, v7
    v_mul_f32 v8, 0.15915494, v8
    v_mul_f32 v9, 0.15915494, v9
    v_mul_f32 v10, 0.15915494, v10
    v_mul_hi_u32_u24 v14, 429497, v40
    v_lshrrev_b32 v12, 3, v24
    v_cos_f32 v7, v7
    v_lshlrev_b16 v13, 3, v24
    v_mad_i32_i24 v11, v14, s55, v40
    v_bitop3_b32 v12, v6, v13, v12 bitop3:0xca
    v_lshl_add_u32 v11, v11, 17, s40
    v_lshlrev_b16 v14, 8, v14
    v_lshrrev_b32 v13, 2, v24
    v_add_u32 v40, v12, v11
    v_bitop3_b32 v24, v5, v13, v14 bitop3:0xea
    ds_add_u32 v24, v2
    v_mul_hi_u32_u24 v14, 429497, v41
    v_lshrrev_b32 v12, 3, v25
    v_cos_f32 v8, v8
    v_lshlrev_b16 v13, 3, v25
    v_mad_i32_i24 v11, v14, s55, v41
    v_bitop3_b32 v12, v6, v13, v12 bitop3:0xca
    v_lshl_add_u32 v11, v11, 17, s40
    v_lshlrev_b16 v14, 8, v14
    v_lshrrev_b32 v13, 2, v25
    v_add_u32 v41, v12, v11
    v_bitop3_b32 v25, v5, v13, v14 bitop3:0xea
    ds_add_u32 v25, v2
    v_cvt_pk_bf16_f32 v32, v7, v8
    v_perm_b32 v12, v32, v32, s41
    v_bitop3_b32 v40, v4, v12, v40 bitop3:0xca
    v_perm_b32 v13, v32, v32, s42
    v_bitop3_b32 v41, v4, v13, v41 bitop3:0xca
    v_mul_hi_u32_u24 v14, 429497, v42
    v_lshrrev_b32 v12, 3, v26
    v_cos_f32 v9, v9
    v_lshlrev_b16 v13, 3, v26
    v_mad_i32_i24 v11, v14, s55, v42
    v_bitop3_b32 v12, v6, v13, v12 bitop3:0xca
    v_lshl_add_u32 v11, v11, 17, s40
    v_lshlrev_b16 v14, 8, v14
    v_lshrrev_b32 v13, 2, v26
    v_add_u32 v42, v12, v11
    v_bitop3_b32 v26, v5, v13, v14 bitop3:0xea
    ds_add_u32 v26, v2
    v_mul_hi_u32_u24 v14, 429497, v43
    v_lshrrev_b32 v12, 3, v27
    v_cos_f32 v10, v10
    v_lshlrev_b16 v13, 3, v27
    v_mad_i32_i24 v11, v14, s55, v43
    v_bitop3_b32 v12, v6, v13, v12 bitop3:0xca
    v_lshl_add_u32 v11, v11, 17, s40
    v_lshlrev_b16 v14, 8, v14
    v_lshrrev_b32 v13, 2, v27
    v_add_u32 v43, v12, v11
    v_bitop3_b32 v27, v5, v13, v14 bitop3:0xea
    ds_add_u32 v27, v2
    v_cvt_pk_bf16_f32 v33, v9, v10
    v_perm_b32 v12, v33, v33, s41
    v_bitop3_b32 v42, v4, v12, v42 bitop3:0xca
    v_perm_b32 v13, v33, v33, s42
    v_bitop3_b32 v43, v4, v13, v43 bitop3:0xca
    s_waitcnt vmcnt(16)
    v_lshlrev_b32 v7, 16, v34
    v_and_b32 v8, 0xffff0000, v34
    v_lshlrev_b32 v9, 16, v35
    v_and_b32 v10, 0xffff0000, v35
    v_mul_f32 v7, 0.15915494, v7
    v_mul_f32 v8, 0.15915494, v8
    v_mul_f32 v9, 0.15915494, v9
    v_mul_f32 v10, 0.15915494, v10
    v_mul_hi_u32_u24 v14, 429497, v48
    v_lshrrev_b32 v12, 3, v52
    v_cos_f32 v7, v7
    v_lshlrev_b16 v13, 3, v52
    v_mad_i32_i24 v11, v14, s55, v48
    v_bitop3_b32 v12, v6, v13, v12 bitop3:0xca
    v_lshl_add_u32 v11, v11, 17, s40
    v_lshlrev_b16 v14, 8, v14
    v_lshrrev_b32 v13, 2, v52
    v_add_u32 v48, v12, v11
    v_bitop3_b32 v52, v5, v13, v14 bitop3:0xea
    ds_add_u32 v52, v2
    v_mul_hi_u32_u24 v14, 429497, v49
    v_lshrrev_b32 v12, 3, v53
    v_cos_f32 v8, v8
    v_lshlrev_b16 v13, 3, v53
    v_mad_i32_i24 v11, v14, s55, v49
    v_bitop3_b32 v12, v6, v13, v12 bitop3:0xca
    v_lshl_add_u32 v11, v11, 17, s40
    v_lshlrev_b16 v14, 8, v14
    v_lshrrev_b32 v13, 2, v53
    v_add_u32 v49, v12, v11
    v_bitop3_b32 v53, v5, v13, v14 bitop3:0xea
    ds_add_u32 v53, v2
    v_cvt_pk_bf16_f32 v34, v7, v8
    v_perm_b32 v12, v34, v34, s41
    v_bitop3_b32 v48, v4, v12, v48 bitop3:0xca
    v_perm_b32 v13, v34, v34, s42
    v_bitop3_b32 v49, v4, v13, v49 bitop3:0xca
    v_mul_hi_u32_u24 v14, 429497, v50
    v_lshrrev_b32 v12, 3, v54
    v_cos_f32 v9, v9
    v_lshlrev_b16 v13, 3, v54
    v_mad_i32_i24 v11, v14, s55, v50
    v_bitop3_b32 v12, v6, v13, v12 bitop3:0xca
    v_lshl_add_u32 v11, v11, 17, s40
    v_lshlrev_b16 v14, 8, v14
    v_lshrrev_b32 v13, 2, v54
    v_add_u32 v50, v12, v11
    v_bitop3_b32 v54, v5, v13, v14 bitop3:0xea
    ds_add_u32 v54, v2
    v_mul_hi_u32_u24 v14, 429497, v51
    v_lshrrev_b32 v12, 3, v55
    v_cos_f32 v10, v10
    v_lshlrev_b16 v13, 3, v55
    v_mad_i32_i24 v11, v14, s55, v51
    v_bitop3_b32 v12, v6, v13, v12 bitop3:0xca
    v_lshl_add_u32 v11, v11, 17, s40
    v_lshlrev_b16 v14, 8, v14
    v_lshrrev_b32 v13, 2, v55
    v_add_u32 v51, v12, v11
    v_bitop3_b32 v55, v5, v13, v14 bitop3:0xea
    ds_add_u32 v55, v2
    v_cvt_pk_bf16_f32 v35, v9, v10
    v_perm_b32 v12, v35, v35, s41
    v_bitop3_b32 v50, v4, v12, v50 bitop3:0xca
    v_perm_b32 v13, v35, v35, s42
    v_bitop3_b32 v51, v4, v13, v51 bitop3:0xca
    s_add_u32 s45, s35, 0x7ecc000
    buffer_store_dwordx4 v[100:103], v0, s[20:23], s45 offen sc1
    v_lshrrev_b32 v15, 2, v0
    v_and_b32 v15, v5, v15
    s_and_b32 s3, s2, 3
    s_mul_i32 s3, s3, 20
    s_add_u32 s3, s3, s32
    s_mul_i32 s4, s3, 205
    s_lshr_b32 s4, s4, 10
    s_mul_i32 s5, s4, 5
    s_sub_u32 s5, s3, s5
    s_lshl_b32 s6, s4, 1
    s_add_u32 s6, s6, s5
    s_add_u32 s7, s6, s4
    s_add_u32 s7, s7, 30
    s_cmp_lt_u32 s5, 2
    s_cselect_b32 s6, s6, s7
    s_lshl_b32 s6, s6, 10
    s_lshr_b32 s7, s2, 2
    s_mul_i32 s7, s7, 80000
    s_add_u32 s6, s6, s7
    buffer_load_dword v108, v15, s[80:83], s6 offen offset:0
    buffer_load_dword v109, v15, s[80:83], s6 offen offset:256
    buffer_load_dword v110, v15, s[80:83], s6 offen offset:512
    buffer_load_dword v111, v15, s[80:83], s6 offen offset:768
    s_and_b32 s3, s2, 3
    s_mul_i32 s3, s3, 20
    s_add_u32 s3, s3, s32
    s_add_u32 s3, s3, 16
    s_cmp_ge_u32 s32, 4
    s_cselect_b32 s82, 0, s82
    s_mul_i32 s4, s3, 205
    s_lshr_b32 s4, s4, 10
    s_mul_i32 s5, s4, 5
    s_sub_u32 s5, s3, s5
    s_lshl_b32 s6, s4, 1
    s_add_u32 s6, s6, s5
    s_add_u32 s7, s6, s4
    s_add_u32 s7, s7, 30
    s_cmp_lt_u32 s5, 2
    s_cselect_b32 s6, s6, s7
    s_lshl_b32 s6, s6, 10
    s_lshr_b32 s7, s2, 2
    s_mul_i32 s7, s7, 80000
    s_add_u32 s6, s6, s7
    buffer_load_dword v100, v15, s[80:83], s6 offen offset:0
    buffer_load_dword v101, v15, s[80:83], s6 offen offset:256
    buffer_load_dword v102, v15, s[80:83], s6 offen offset:512
    buffer_load_dword v103, v15, s[80:83], s6 offen offset:768
    s_waitcnt vmcnt(21)
    v_lshlrev_b32 v7, 16, v72
    v_and_b32 v8, 0xffff0000, v72
    v_lshlrev_b32 v9, 16, v73
    v_and_b32 v10, 0xffff0000, v73
    v_mul_f32 v7, 0.15915494, v7
    v_mul_f32 v8, 0.15915494, v8
    v_mul_f32 v9, 0.15915494, v9
    v_mul_f32 v10, 0.15915494, v10
    v_mul_hi_u32_u24 v14, 429497, v84
    v_lshrrev_b32 v12, 3, v68
    v_cos_f32 v7, v7
    v_lshlrev_b16 v13, 3, v68
    v_mad_i32_i24 v11, v14, s55, v84
    v_bitop3_b32 v12, v6, v13, v12 bitop3:0xca
    v_lshl_add_u32 v11, v11, 17, s40
    v_lshlrev_b16 v14, 8, v14
    v_lshrrev_b32 v13, 2, v68
    v_add_u32 v84, v12, v11
    v_bitop3_b32 v68, v5, v13, v14 bitop3:0xea
    ds_add_u32 v68, v2
    v_mul_hi_u32_u24 v14, 429497, v85
    v_lshrrev_b32 v12, 3, v69
    v_cos_f32 v8, v8
    v_lshlrev_b16 v13, 3, v69
    v_mad_i32_i24 v11, v14, s55, v85
    v_bitop3_b32 v12, v6, v13, v12 bitop3:0xca
    v_lshl_add_u32 v11, v11, 17, s40
    v_lshlrev_b16 v14, 8, v14
    v_lshrrev_b32 v13, 2, v69
    v_add_u32 v85, v12, v11
    v_bitop3_b32 v69, v5, v13, v14 bitop3:0xea
    ds_add_u32 v69, v2
    v_cvt_pk_bf16_f32 v72, v7, v8
    v_perm_b32 v12, v72, v72, s41
    v_bitop3_b32 v84, v4, v12, v84 bitop3:0xca
    v_perm_b32 v13, v72, v72, s42
    v_bitop3_b32 v85, v4, v13, v85 bitop3:0xca
    v_mul_hi_u32_u24 v14, 429497, v86
    v_lshrrev_b32 v12, 3, v70
    v_cos_f32 v9, v9
    v_lshlrev_b16 v13, 3, v70
    v_mad_i32_i24 v11, v14, s55, v86
    v_bitop3_b32 v12, v6, v13, v12 bitop3:0xca
    v_lshl_add_u32 v11, v11, 17, s40
    v_lshlrev_b16 v14, 8, v14
    v_lshrrev_b32 v13, 2, v70
    v_add_u32 v86, v12, v11
    v_bitop3_b32 v70, v5, v13, v14 bitop3:0xea
    ds_add_u32 v70, v2
    v_mul_hi_u32_u24 v14, 429497, v87
    v_lshrrev_b32 v12, 3, v71
    v_cos_f32 v10, v10
    v_lshlrev_b16 v13, 3, v71
    v_mad_i32_i24 v11, v14, s55, v87
    v_bitop3_b32 v12, v6, v13, v12 bitop3:0xca
    v_lshl_add_u32 v11, v11, 17, s40
    v_lshlrev_b16 v14, 8, v14
    v_lshrrev_b32 v13, 2, v71
    v_add_u32 v87, v12, v11
    v_bitop3_b32 v71, v5, v13, v14 bitop3:0xea
    ds_add_u32 v71, v2
    v_cvt_pk_bf16_f32 v73, v9, v10
    v_perm_b32 v12, v73, v73, s41
    v_bitop3_b32 v86, v4, v12, v86 bitop3:0xca
    v_perm_b32 v13, v73, v73, s42
    v_bitop3_b32 v87, v4, v13, v87 bitop3:0xca
    s_waitcnt vmcnt(18)
    s_cmp_le_u32 s43, 5
    s_cbranch_scc1 L1_s5
    v_lshlrev_b32 v7, 16, v74
    v_and_b32 v8, 0xffff0000, v74
    v_lshlrev_b32 v9, 16, v75
    v_and_b32 v10, 0xffff0000, v75
    v_mul_f32 v7, 0.15915494, v7
    v_mul_f32 v8, 0.15915494, v8
    v_mul_f32 v9, 0.15915494, v9
    v_mul_f32 v10, 0.15915494, v10
    v_mul_hi_u32_u24 v14, 429497, v36
    v_lshrrev_b32 v12, 3, v76
    v_cos_f32 v7, v7
    v_lshlrev_b16 v13, 3, v76
    v_mad_i32_i24 v11, v14, s55, v36
    v_bitop3_b32 v12, v6, v13, v12 bitop3:0xca
    v_lshl_add_u32 v11, v11, 17, s40
    v_lshlrev_b16 v14, 8, v14
    v_lshrrev_b32 v13, 2, v76
    v_add_u32 v36, v12, v11
    v_bitop3_b32 v76, v5, v13, v14 bitop3:0xea
    ds_add_u32 v76, v2
    v_mul_hi_u32_u24 v14, 429497, v37
    v_lshrrev_b32 v12, 3, v77
    v_cos_f32 v8, v8
    v_lshlrev_b16 v13, 3, v77
    v_mad_i32_i24 v11, v14, s55, v37
    v_bitop3_b32 v12, v6, v13, v12 bitop3:0xca
    v_lshl_add_u32 v11, v11, 17, s40
    v_lshlrev_b16 v14, 8, v14
    v_lshrrev_b32 v13, 2, v77
    v_add_u32 v37, v12, v11
    v_bitop3_b32 v77, v5, v13, v14 bitop3:0xea
    ds_add_u32 v77, v2
    v_cvt_pk_bf16_f32 v74, v7, v8
    v_perm_b32 v12, v74, v74, s41
    v_bitop3_b32 v36, v4, v12, v36 bitop3:0xca
    v_perm_b32 v13, v74, v74, s42
    v_bitop3_b32 v37, v4, v13, v37 bitop3:0xca
    v_mul_hi_u32_u24 v14, 429497, v38
    v_lshrrev_b32 v12, 3, v78
    v_cos_f32 v9, v9
    v_lshlrev_b16 v13, 3, v78
    v_mad_i32_i24 v11, v14, s55, v38
    v_bitop3_b32 v12, v6, v13, v12 bitop3:0xca
    v_lshl_add_u32 v11, v11, 17, s40
    v_lshlrev_b16 v14, 8, v14
    v_lshrrev_b32 v13, 2, v78
    v_add_u32 v38, v12, v11
    v_bitop3_b32 v78, v5, v13, v14 bitop3:0xea
    ds_add_u32 v78, v2
    v_mul_hi_u32_u24 v14, 429497, v39
    v_lshrrev_b32 v12, 3, v79
    v_cos_f32 v10, v10
    v_lshlrev_b16 v13, 3, v79
    v_mad_i32_i24 v11, v14, s55, v39
    v_bitop3_b32 v12, v6, v13, v12 bitop3:0xca
    v_lshl_add_u32 v11, v11, 17, s40
    v_lshlrev_b16 v14, 8, v14
    v_lshrrev_b32 v13, 2, v79
    v_add_u32 v39, v12, v11
    v_bitop3_b32 v79, v5, v13, v14 bitop3:0xea
    ds_add_u32 v79, v2
    v_cvt_pk_bf16_f32 v75, v9, v10
    v_perm_b32 v12, v75, v75, s41
    v_bitop3_b32 v38, v4, v12, v38 bitop3:0xca
    v_perm_b32 v13, v75, v75, s42
    v_bitop3_b32 v39, v4, v13, v39 bitop3:0xca
L1_s5:
    s_waitcnt vmcnt(14)
    s_cmp_le_u32 s43, 6
    s_cbranch_scc1 L1_s6
    v_lshlrev_b32 v7, 16, v64
    v_and_b32 v8, 0xffff0000, v64
    v_lshlrev_b32 v9, 16, v65
    v_and_b32 v10, 0xffff0000, v65
    v_mul_f32 v7, 0.15915494, v7
    v_mul_f32 v8, 0.15915494, v8
    v_mul_f32 v9, 0.15915494, v9
    v_mul_f32 v10, 0.15915494, v10
    v_mul_hi_u32_u24 v14, 429497, v80
    v_lshrrev_b32 v12, 3, v56
    v_cos_f32 v7, v7
    v_lshlrev_b16 v13, 3, v56
    v_mad_i32_i24 v11, v14, s55, v80
    v_bitop3_b32 v12, v6, v13, v12 bitop3:0xca
    v_lshl_add_u32 v11, v11, 17, s40
    v_lshlrev_b16 v14, 8, v14
    v_lshrrev_b32 v13, 2, v56
    v_add_u32 v80, v12, v11
    v_bitop3_b32 v56, v5, v13, v14 bitop3:0xea
    ds_add_u32 v56, v2
    v_mul_hi_u32_u24 v14, 429497, v81
    v_lshrrev_b32 v12, 3, v57
    v_cos_f32 v8, v8
    v_lshlrev_b16 v13, 3, v57
    v_mad_i32_i24 v11, v14, s55, v81
    v_bitop3_b32 v12, v6, v13, v12 bitop3:0xca
    v_lshl_add_u32 v11, v11, 17, s40
    v_lshlrev_b16 v14, 8, v14
    v_lshrrev_b32 v13, 2, v57
    v_add_u32 v81, v12, v11
    v_bitop3_b32 v57, v5, v13, v14 bitop3:0xea
    ds_add_u32 v57, v2
    v_cvt_pk_bf16_f32 v64, v7, v8
    v_perm_b32 v12, v64, v64, s41
    v_bitop3_b32 v80, v4, v12, v80 bitop3:0xca
    v_perm_b32 v13, v64, v64, s42
    v_bitop3_b32 v81, v4, v13, v81 bitop3:0xca
    v_mul_hi_u32_u24 v14, 429497, v82
    v_lshrrev_b32 v12, 3, v58
    v_cos_f32 v9, v9
    v_lshlrev_b16 v13, 3, v58
    v_mad_i32_i24 v11, v14, s55, v82
    v_bitop3_b32 v12, v6, v13, v12 bitop3:0xca
    v_lshl_add_u32 v11, v11, 17, s40
    v_lshlrev_b16 v14, 8, v14
    v_lshrrev_b32 v13, 2, v58
    v_add_u32 v82, v12, v11
    v_bitop3_b32 v58, v5, v13, v14 bitop3:0xea
    ds_add_u32 v58, v2
    v_mul_hi_u32_u24 v14, 429497, v83
    v_lshrrev_b32 v12, 3, v59
    v_cos_f32 v10, v10
    v_lshlrev_b16 v13, 3, v59
    v_mad_i32_i24 v11, v14, s55, v83
    v_bitop3_b32 v12, v6, v13, v12 bitop3:0xca
    v_lshl_add_u32 v11, v11, 17, s40
    v_lshlrev_b16 v14, 8, v14
    v_lshrrev_b32 v13, 2, v59
    v_add_u32 v83, v12, v11
    v_bitop3_b32 v59, v5, v13, v14 bitop3:0xea
    ds_add_u32 v59, v2
    v_cvt_pk_bf16_f32 v65, v9, v10
    v_perm_b32 v12, v65, v65, s41
    v_bitop3_b32 v82, v4, v12, v82 bitop3:0xca
    v_perm_b32 v13, v65, v65, s42
    v_bitop3_b32 v83, v4, v13, v83 bitop3:0xca
L1_s6:
    s_waitcnt vmcnt(10)
    s_cmp_le_u32 s43, 7
    s_cbranch_scc1 L1_s7
    v_lshlrev_b32 v7, 16, v66
    v_and_b32 v8, 0xffff0000, v66
    v_lshlrev_b32 v9, 16, v67
    v_and_b32 v10, 0xffff0000, v67
    v_mul_f32 v7, 0.15915494, v7
    v_mul_f32 v8, 0.15915494, v8
    v_mul_f32 v9, 0.15915494, v9
    v_mul_f32 v10, 0.15915494, v10
    v_mul_hi_u32_u24 v14, 429497, v96
    v_lshrrev_b32 v12, 3, v60
    v_cos_f32 v7, v7
    v_lshlrev_b16 v13, 3, v60
    v_mad_i32_i24 v11, v14, s55, v96
    v_bitop3_b32 v12, v6, v13, v12 bitop3:0xca
    v_lshl_add_u32 v11, v11, 17, s40
    v_lshlrev_b16 v14, 8, v14
    v_lshrrev_b32 v13, 2, v60
    v_add_u32 v96, v12, v11
    v_bitop3_b32 v60, v5, v13, v14 bitop3:0xea
    ds_add_u32 v60, v2
    v_mul_hi_u32_u24 v14, 429497, v97
    v_lshrrev_b32 v12, 3, v61
    v_cos_f32 v8, v8
    v_lshlrev_b16 v13, 3, v61
    v_mad_i32_i24 v11, v14, s55, v97
    v_bitop3_b32 v12, v6, v13, v12 bitop3:0xca
    v_lshl_add_u32 v11, v11, 17, s40
    v_lshlrev_b16 v14, 8, v14
    v_lshrrev_b32 v13, 2, v61
    v_add_u32 v97, v12, v11
    v_bitop3_b32 v61, v5, v13, v14 bitop3:0xea
    ds_add_u32 v61, v2
    v_cvt_pk_bf16_f32 v66, v7, v8
    v_perm_b32 v12, v66, v66, s41
    v_bitop3_b32 v96, v4, v12, v96 bitop3:0xca
    v_perm_b32 v13, v66, v66, s42
    v_bitop3_b32 v97, v4, v13, v97 bitop3:0xca
    v_mul_hi_u32_u24 v14, 429497, v98
    v_lshrrev_b32 v12, 3, v62
    v_cos_f32 v9, v9
    v_lshlrev_b16 v13, 3, v62
    v_mad_i32_i24 v11, v14, s55, v98
    v_bitop3_b32 v12, v6, v13, v12 bitop3:0xca
    v_lshl_add_u32 v11, v11, 17, s40
    v_lshlrev_b16 v14, 8, v14
    v_lshrrev_b32 v13, 2, v62
    v_add_u32 v98, v12, v11
    v_bitop3_b32 v62, v5, v13, v14 bitop3:0xea
    ds_add_u32 v62, v2
    v_mul_hi_u32_u24 v14, 429497, v99
    v_lshrrev_b32 v12, 3, v63
    v_cos_f32 v10, v10
    v_lshlrev_b16 v13, 3, v63
    v_mad_i32_i24 v11, v14, s55, v99
    v_bitop3_b32 v12, v6, v13, v12 bitop3:0xca
    v_lshl_add_u32 v11, v11, 17, s40
    v_lshlrev_b16 v14, 8, v14
    v_lshrrev_b32 v13, 2, v63
    v_add_u32 v99, v12, v11
    v_bitop3_b32 v63, v5, v13, v14 bitop3:0xea
    ds_add_u32 v63, v2
    v_cvt_pk_bf16_f32 v67, v9, v10
    v_perm_b32 v12, v67, v67, s41
    v_bitop3_b32 v98, v4, v12, v98 bitop3:0xca
    v_perm_b32 v13, v67, v67, s42
    v_bitop3_b32 v99, v4, v13, v99 bitop3:0xca
L1_s7:
    v_lshrrev_b32 v8, 2, v0
    v_and_b32 v7, 0x3c00, v0
    v_bitop3_b32 v7, v5, v8, v7 bitop3:0xea
    s_waitcnt lgkmcnt(0)
    s_barrier
    ds_read2st64_b32 v[8:9], v7 offset0:0 offset1:1
    ds_read2st64_b32 v[10:11], v7 offset0:2 offset1:3
    s_add_u32 s46, s35, 0x7ed0000
    buffer_store_dwordx4 v[28:31], v0, s[20:23], s46 offen sc1
    s_waitcnt lgkmcnt(0)
    v_lshl_or_b32 v12, v9, 16, v8
    v_lshl_or_b32 v13, v11, 16, v10
    v_mov_b32 v14, v12
    v_mov_b32 v15, v13
    s_nop 0
    v_add_u32_dpp v14, v14, v14 row_shr:1 row_mask:0xf bank_mask:0xf bound_ctrl:1
    v_add_u32_dpp v15, v15, v15 row_shr:1 row_mask:0xf bank_mask:0xf bound_ctrl:1
    s_nop 0
    v_add_u32_dpp v14, v14, v14 row_shr:2 row_mask:0xf bank_mask:0xf bound_ctrl:1
    v_add_u32_dpp v15, v15, v15 row_shr:2 row_mask:0xf bank_mask:0xf bound_ctrl:1
    s_nop 0
    v_add_u32_dpp v14, v14, v14 row_shr:4 row_mask:0xf bank_mask:0xf bound_ctrl:1
    v_add_u32_dpp v15, v15, v15 row_shr:4 row_mask:0xf bank_mask:0xf bound_ctrl:1
    s_nop 0
    v_add_u32_dpp v14, v14, v14 row_shr:8 row_mask:0xf bank_mask:0xf bound_ctrl:1
    v_add_u32_dpp v15, v15, v15 row_shr:8 row_mask:0xf bank_mask:0xf bound_ctrl:1
    s_nop 0
    v_add_u32_dpp v14, v14, v14 row_bcast:15 row_mask:0xa bank_mask:0xf
    v_add_u32_dpp v15, v15, v15 row_bcast:15 row_mask:0xa bank_mask:0xf
    s_nop 0
    v_add_u32_dpp v14, v14, v14 row_bcast:31 row_mask:0xc bank_mask:0xf
    v_add_u32_dpp v15, v15, v15 row_bcast:31 row_mask:0xc bank_mask:0xf
    v_readlane_b32 s48, v14, 63
    v_readlane_b32 s49, v15, 63
    s_lshl_b32 s54, s32, 2
    v_mov_b32 v8, s54
    s_and_b32 s50, s48, 0xffff
    s_lshr_b32 s51, s48, 16
    s_and_b32 s52, s49, 0xffff
    s_lshr_b32 s53, s49, 16
    s_add_u32 s51, s51, s50
    s_add_u32 s52, s52, s51
    s_add_u32 s53, s53, s52
    v_mov_b32 v9, s53
    s_mov_b64 exec, 1
    ds_write_b32 v8, v9 offset:16384
    s_mov_b64 exec, -1
    v_and_b32 v8, 60, v7
    s_waitcnt lgkmcnt(0)
    s_barrier
    ds_read_b32 v9, v8 offset:16384
    s_waitcnt lgkmcnt(0)
    v_add_u32_dpp v9, v9, v9 row_shr:1 row_mask:0xf bank_mask:0xf bound_ctrl:1
    s_nop 1
    v_add_u32_dpp v9, v9, v9 row_shr:2 row_mask:0xf bank_mask:0xf bound_ctrl:1
    s_nop 1
    v_add_u32_dpp v9, v9, v9 row_shr:4 row_mask:0xf bank_mask:0xf bound_ctrl:1
    s_nop 1
    v_add_u32_dpp v9, v9, v9 row_shr:8 row_mask:0xf bank_mask:0xf bound_ctrl:1
    s_nop 0
    v_readlane_b32 s54, v9, s32
    s_sub_u32 s54, s54, s53
    s_add_u32 s50, s50, s54
    s_add_u32 s51, s51, s54
    s_add_u32 s52, s52, s54
    s_pack_ll_b32_b16 s48, s54, s50
    s_pack_ll_b32_b16 s49, s51, s52
    v_add_u32 v14, s48, v14
    v_add_u32 v15, s49, v15
    v_sub_u32 v12, v14, v12
    v_sub_u32 v13, v15, v13
    v_and_b32 v8, 0xffff, v12
    v_lshrrev_b32 v9, 16, v12
    v_and_b32 v10, 0xffff, v13
    v_lshrrev_b32 v11, 16, v13
    ds_write2st64_b32 v7, v8, v9 offset0:0 offset1:1
    ds_write2st64_b32 v7, v10, v11 offset0:2 offset1:3
    s_waitcnt lgkmcnt(0)
    s_barrier
    ds_add_rtn_u32 v120, v120, v2
    ds_add_rtn_u32 v121, v121, v2
    ds_add_rtn_u32 v122, v122, v2
    ds_add_rtn_u32 v123, v123, v2
    s_add_u32 s47, s36, 0xa900000
    v_and_b32 v11, 0x3f0, v0
    v_add_u32 v11, v11, v11
    buffer_store_dwordx2 v[12:13], v11, s[24:27], s47 offen
    s_bitset0_b64 exec, 63
    s_not_b64 exec, exec
    buffer_store_dwordx2 v[14:15], v11, s[24:27], s47 offen offset:32
    s_mov_b64 exec, -1
    v_cmp_le_u32 vcc, s37, v0
    v_add_u32 v10, 8320, v0
    s_cmp_lg_u32 s32, 0
    v_cndmask_b32 v10, v0, v10, vcc
    s_cbranch_scc1 L1_p8
    s_add_u32 s44, s35, 0xa900000
    s_mov_b64 exec, 0xff
    buffer_store_dwordx4 v[12:15], v10, s[24:27], s44 offen
    s_mov_b64 exec, -1
L1_p8:
    ds_add_rtn_u32 v124, v124, v2
    ds_add_rtn_u32 v125, v125, v2
    ds_add_rtn_u32 v126, v126, v2
    ds_add_rtn_u32 v127, v127, v2
    ds_add_rtn_u32 v24, v24, v2
    ds_add_rtn_u32 v25, v25, v2
    ds_add_rtn_u32 v26, v26, v2
    ds_add_rtn_u32 v27, v27, v2
    s_add_u32 s45, s35, 0x7ed4000
    buffer_store_dwordx4 v[112:115], v0, s[20:23], s45 offen sc1
    ds_add_rtn_u32 v52, v52, v2
    ds_add_rtn_u32 v53, v53, v2
    ds_add_rtn_u32 v54, v54, v2
    ds_add_rtn_u32 v55, v55, v2
    ds_add_rtn_u32 v68, v68, v2
    ds_add_rtn_u32 v69, v69, v2
    ds_add_rtn_u32 v70, v70, v2
    ds_add_rtn_u32 v71, v71, v2
    s_add_u32 s80, s30, 0xd340000
    s_addc_u32 s81, s31, 0
    s_mov_b32 s82, 0x5000
    s_mov_b32 s83, 0x20000
    s_mul_i32 s3, s2, 20480
    s_add_u32 s80, s80, s3
    s_addc_u32 s81, s81, 0
    v_add_u32 v9, 0x4000, v0
    s_waitcnt vmcnt(4)
    buffer_store_dwordx4 v[108:111], v0, s[80:83], 0 offen sc1
    buffer_store_dwordx4 v[100:103], v9, s[80:83], 0 offen sc1
    s_cmp_le_u32 s43, 5
    s_cbranch_scc1 L1_s9
    ds_add_rtn_u32 v76, v76, v2
    ds_add_rtn_u32 v77, v77, v2
    ds_add_rtn_u32 v78, v78, v2
    ds_add_rtn_u32 v79, v79, v2
L1_s9:
    s_add_u32 s46, s35, 0x7ed8000
    buffer_store_dwordx4 v[88:91], v0, s[20:23], s46 offen sc1
    s_cmp_le_u32 s43, 6
    s_cbranch_scc1 L1_s10
    ds_add_rtn_u32 v56, v56, v2
    ds_add_rtn_u32 v57, v57, v2
    ds_add_rtn_u32 v58, v58, v2
    ds_add_rtn_u32 v59, v59, v2
L1_s10:
    s_cmp_le_u32 s43, 7
    s_cbranch_scc1 L1_s11
    ds_add_rtn_u32 v60, v60, v2
    ds_add_rtn_u32 v61, v61, v2
    ds_add_rtn_u32 v62, v62, v2
    ds_add_rtn_u32 v63, v63, v2
L1_s11:
    s_waitcnt lgkmcnt(0)
    s_barrier
    v_and_b32 v7, -4, v120
    v_lshl_add_u32 v8, v120, 2, v7
    ds_write_b32 v8, v16
    v_lshl_add_u32 v7, v7, 2, v120
    ds_write_b8 v7, v44 offset:16
    v_and_b32 v9, -4, v121
    v_lshl_add_u32 v10, v121, 2, v9
    ds_write_b32 v10, v17
    v_lshl_add_u32 v9, v9, 2, v121
    ds_write_b8_d16_hi v9, v44 offset:16
    v_and_b32 v7, -4, v122
    v_lshl_add_u32 v8, v122, 2, v7
    ds_write_b32 v8, v18
    v_lshl_add_u32 v7, v7, 2, v122
    ds_write_b8 v7, v45 offset:16
    v_and_b32 v9, -4, v123
    v_lshl_add_u32 v10, v123, 2, v9
    ds_write_b32 v10, v19
    v_lshl_add_u32 v9, v9, 2, v123
    ds_write_b8_d16_hi v9, v45 offset:16
    s_add_u32 s47, s35, 0x7edc000
    buffer_store_dwordx4 v[116:119], v0, s[20:23], s47 offen sc1
    v_and_b32 v7, -4, v124
    v_lshl_add_u32 v8, v124, 2, v7
    ds_write_b32 v8, v20
    v_lshl_add_u32 v7, v7, 2, v124
    ds_write_b8 v7, v46 offset:16
    v_and_b32 v9, -4, v125
    v_lshl_add_u32 v10, v125, 2, v9
    ds_write_b32 v10, v21
    v_lshl_add_u32 v9, v9, 2, v125
    ds_write_b8_d16_hi v9, v46 offset:16
    v_and_b32 v7, -4, v126
    v_lshl_add_u32 v8, v126, 2, v7
    ds_write_b32 v8, v22
    v_lshl_add_u32 v7, v7, 2, v126
    ds_write_b8 v7, v47 offset:16
    v_and_b32 v9, -4, v127
    v_lshl_add_u32 v10, v127, 2, v9
    ds_write_b32 v10, v23
    v_lshl_add_u32 v9, v9, 2, v127
    ds_write_b8_d16_hi v9, v47 offset:16
    v_and_b32 v7, -4, v24
    v_lshl_add_u32 v8, v24, 2, v7
    ds_write_b32 v8, v40
    v_lshl_add_u32 v7, v7, 2, v24
    ds_write_b8 v7, v32 offset:16
    v_and_b32 v9, -4, v25
    v_lshl_add_u32 v10, v25, 2, v9
    ds_write_b32 v10, v41
    v_lshl_add_u32 v9, v9, 2, v25
    ds_write_b8_d16_hi v9, v32 offset:16
    v_and_b32 v7, -4, v26
    v_lshl_add_u32 v8, v26, 2, v7
    ds_write_b32 v8, v42
    v_lshl_add_u32 v7, v7, 2, v26
    ds_write_b8 v7, v33 offset:16
    v_and_b32 v9, -4, v27
    v_lshl_add_u32 v10, v27, 2, v9
    ds_write_b32 v10, v43
    v_lshl_add_u32 v9, v9, 2, v27
    ds_write_b8_d16_hi v9, v33 offset:16
    s_add_u32 s44, s35, 0x7ee0000
    buffer_store_dwordx4 v[92:95], v0, s[20:23], s44 offen sc1
    v_and_b32 v7, -4, v52
    v_lshl_add_u32 v8, v52, 2, v7
    ds_write_b32 v8, v48
    v_lshl_add_u32 v7, v7, 2, v52
    ds_write_b8 v7, v34 offset:16
    v_and_b32 v9, -4, v53
    v_lshl_add_u32 v10, v53, 2, v9
    ds_write_b32 v10, v49
    v_lshl_add_u32 v9, v9, 2, v53
    ds_write_b8_d16_hi v9, v34 offset:16
    v_and_b32 v7, -4, v54
    v_lshl_add_u32 v8, v54, 2, v7
    ds_write_b32 v8, v50
    v_lshl_add_u32 v7, v7, 2, v54
    ds_write_b8 v7, v35 offset:16
    v_and_b32 v9, -4, v55
    v_lshl_add_u32 v10, v55, 2, v9
    ds_write_b32 v10, v51
    v_lshl_add_u32 v9, v9, 2, v55
    ds_write_b8_d16_hi v9, v35 offset:16
    v_and_b32 v7, -4, v68
    v_lshl_add_u32 v8, v68, 2, v7
    ds_write_b32 v8, v84
    v_lshl_add_u32 v7, v7, 2, v68
    ds_write_b8 v7, v72 offset:16
    v_and_b32 v9, -4, v69
    v_lshl_add_u32 v10, v69, 2, v9
    ds_write_b32 v10, v85
    v_lshl_add_u32 v9, v9, 2, v69
    ds_write_b8_d16_hi v9, v72 offset:16
    v_and_b32 v7, -4, v70
    v_lshl_add_u32 v8, v70, 2, v7
    ds_write_b32 v8, v86
    v_lshl_add_u32 v7, v7, 2, v70
    ds_write_b8 v7, v73 offset:16
    v_and_b32 v9, -4, v71
    v_lshl_add_u32 v10, v71, 2, v9
    ds_write_b32 v10, v87
    v_lshl_add_u32 v9, v9, 2, v71
    ds_write_b8_d16_hi v9, v73 offset:16
    s_cmp_le_u32 s43, 5
    s_cbranch_scc1 L1_s12
    v_and_b32 v7, -4, v76
    v_lshl_add_u32 v8, v76, 2, v7
    ds_write_b32 v8, v36
    v_lshl_add_u32 v7, v7, 2, v76
    ds_write_b8 v7, v74 offset:16
    v_and_b32 v9, -4, v77
    v_lshl_add_u32 v10, v77, 2, v9
    ds_write_b32 v10, v37
    v_lshl_add_u32 v9, v9, 2, v77
    ds_write_b8_d16_hi v9, v74 offset:16
    v_and_b32 v7, -4, v78
    v_lshl_add_u32 v8, v78, 2, v7
    ds_write_b32 v8, v38
    v_lshl_add_u32 v7, v7, 2, v78
    ds_write_b8 v7, v75 offset:16
    v_and_b32 v9, -4, v79
    v_lshl_add_u32 v10, v79, 2, v9
    ds_write_b32 v10, v39
    v_lshl_add_u32 v9, v9, 2, v79
    ds_write_b8_d16_hi v9, v75 offset:16
L1_s12:
    s_add_u32 s45, s35, 0x7ee4000
    buffer_store_dwordx4 v[104:107], v0, s[20:23], s45 offen sc1
    s_cmp_le_u32 s43, 6
    s_cbranch_scc1 L1_s13
    v_and_b32 v7, -4, v56
    v_lshl_add_u32 v8, v56, 2, v7
    ds_write_b32 v8, v80
    v_lshl_add_u32 v7, v7, 2, v56
    ds_write_b8 v7, v64 offset:16
    v_and_b32 v9, -4, v57
    v_lshl_add_u32 v10, v57, 2, v9
    ds_write_b32 v10, v81
    v_lshl_add_u32 v9, v9, 2, v57
    ds_write_b8_d16_hi v9, v64 offset:16
    v_and_b32 v7, -4, v58
    v_lshl_add_u32 v8, v58, 2, v7
    ds_write_b32 v8, v82
    v_lshl_add_u32 v7, v7, 2, v58
    ds_write_b8 v7, v65 offset:16
    v_and_b32 v9, -4, v59
    v_lshl_add_u32 v10, v59, 2, v9
    ds_write_b32 v10, v83
    v_lshl_add_u32 v9, v9, 2, v59
    ds_write_b8_d16_hi v9, v65 offset:16
L1_s13:
    s_cmp_le_u32 s43, 7
    s_cbranch_scc1 L1_s14
    v_and_b32 v7, -4, v60
    v_lshl_add_u32 v8, v60, 2, v7
    ds_write_b32 v8, v96
    v_lshl_add_u32 v7, v7, 2, v60
    ds_write_b8 v7, v66 offset:16
    v_and_b32 v9, -4, v61
    v_lshl_add_u32 v10, v61, 2, v9
    ds_write_b32 v10, v97
    v_lshl_add_u32 v9, v9, 2, v61
    ds_write_b8_d16_hi v9, v66 offset:16
    v_and_b32 v7, -4, v62
    v_lshl_add_u32 v8, v62, 2, v7
    ds_write_b32 v8, v98
    v_lshl_add_u32 v7, v7, 2, v62
    ds_write_b8 v7, v67 offset:16
    v_and_b32 v9, -4, v63
    v_lshl_add_u32 v10, v63, 2, v9
    ds_write_b32 v10, v99
    v_lshl_add_u32 v9, v9, 2, v63
    ds_write_b8_d16_hi v9, v67 offset:16
L1_s14:
    v_add_u32 v7, 0x10000, v0
    v_add_u32 v12, 0x20000, v0
    s_waitcnt lgkmcnt(0)
    s_barrier
    ds_read_b128 v[28:31], v0 offset:0
    ds_read_b128 v[112:115], v0 offset:16384
    ds_read_b128 v[108:111], v0 offset:32768
    ds_read_b128 v[100:103], v0 offset:49152
    ds_read_b128 v[88:91], v7 offset:0
    ds_read_b128 v[16:19], v7 offset:16384
    ds_read_b128 v[120:123], v7 offset:32768
    ds_read_b128 v[116:119], v7 offset:49152
    ds_read_b128 v[20:23], v12 offset:0
    ds_read_b128 v[124:127], v12 offset:16384
    s_waitcnt lgkmcnt(9)
    s_add_u32 s46, s35, 0xa900000
    buffer_store_dwordx4 v[28:31], v0, s[20:23], s46 offen sc1
    s_waitcnt lgkmcnt(8)
    s_add_u32 s47, s35, 0xa904000
    buffer_store_dwordx4 v[112:115], v0, s[20:23], s47 offen sc1
    s_waitcnt lgkmcnt(7)
    s_add_u32 s44, s35, 0xa908000
    buffer_store_dwordx4 v[108:111], v0, s[20:23], s44 offen sc1
    s_waitcnt lgkmcnt(6)
    s_add_u32 s45, s35, 0xa90c000
    buffer_store_dwordx4 v[100:103], v0, s[20:23], s45 offen sc1
    s_waitcnt lgkmcnt(5)
    s_add_u32 s46, s35, 0xa910000
    buffer_store_dwordx4 v[88:91], v0, s[20:23], s46 offen sc1
    s_waitcnt lgkmcnt(4)
    s_add_u32 s47, s35, 0xa914000
    buffer_store_dwordx4 v[16:19], v0, s[20:23], s47 offen sc1
    s_waitcnt lgkmcnt(3)
    s_add_u32 s44, s35, 0xa918000
    buffer_store_dwordx4 v[120:123], v0, s[20:23], s44 offen sc1
    s_cmp_le_u32 s43, 5
    s_cbranch_scc1 L1_fin
    s_waitcnt lgkmcnt(2)
    s_add_u32 s45, s35, 0xa91c000
    buffer_store_dwordx4 v[116:119], v0, s[20:23], s45 offen sc1
    s_cmp_le_u32 s43, 6
    s_cbranch_scc1 L1_fin
    s_waitcnt lgkmcnt(1)
    s_add_u32 s46, s35, 0xa920000
    buffer_store_dwordx4 v[20:23], v0, s[20:23], s46 offen sc1
    s_cmp_le_u32 s43, 7
    s_cbranch_scc1 L1_fin
    s_waitcnt lgkmcnt(0)
    s_add_u32 s47, s35, 0xa924000
    buffer_store_dwordx4 v[124:127], v0, s[20:23], s47 offen sc1
L1_fin:
L1_end:
    s_endpgm
.text
.globl gs_acc_kernel
.p2align 8
.type gs_acc_kernel,@function
gs_acc_kernel:
    s_cmp_ge_u32 s2, 256
    s_cbranch_scc1 L2_end
    s_load_dwordx2 s[30:31], s[0:1], 104
    s_load_dwordx2 s[28:29], s[0:1], 0
    s_load_dwordx2 s[6:7], s[0:1], 40
    v_lshrrev_b32 v16, 6, v0
    v_and_b32 v17, 63, v0
    v_readfirstlane_b32 s32, v16
    s_bfe_u32 s33, s2, 0x20001
    s_and_b32 s34, s2, 1
    s_lshl_b32 s34, s34, 5
    s_lshr_b32 s4, s2, 3
    s_add_u32 s34, s34, s4
    v_and_b32 v22, 3, v0
    v_mul_u32_u24 v19, 80, v16
    v_add_u32 v18, v17, v19
    v_mul_u32_u24 v2, 173056, v18
    v_lshrrev_b32 v18, 2, v17
    v_add3_u32 v18, v18, v19, 64
    v_mul_u32_u24 v4, 173056, v18
    v_lshl_add_u32 v20, v22, 4, v4
    v_and_b32 v18, 3, v18
    v_lshl_add_u32 v20, v18, 5, v20
    v_lshl_add_u32 v25, v22, 5, v2
    s_mul_i32 s39, s33, 2080
    s_lshl_b32 s3, s34, 5
    s_add_u32 s39, s39, s3
    s_mul_i32 s40, s33, 1310720
    s_mul_i32 s3, s32, 5120
    v_lshl_add_u32 v3, v17, 4, s3
    s_lshl_b32 s38, s32, 11
    s_mul_i32 s69, s32, 3072
    s_waitcnt lgkmcnt(0)
    s_add_u32 s12, s30, 0x28000
    s_addc_u32 s13, s31, 0
    s_mov_b32 s14, 0xd318000
    s_mov_b32 s15, 0x20000
    buffer_load_dwordx4 v[48:51], v25, s[12:15], s39 offen offset:0
    buffer_load_dwordx4 v[56:59], v25, s[12:15], s39 offen offset:32
    buffer_load_dwordx4 v[52:55], v25, s[12:15], s39 offen offset:16
    buffer_load_dwordx4 v[60:63], v25, s[12:15], s39 offen offset:48
    buffer_load_dwordx4 v[64:67], v20, s[12:15], s39 offen
    s_add_u32 s16, s30, 0xd340000
    s_addc_u32 s17, s31, 0
    s_mov_b32 s18, 0x500000
    s_mov_b32 s19, 0x20000
    s_add_u32 s24, s30, 0xebc9000
    s_addc_u32 s25, s31, 0
    s_mov_b32 s26, 0x100
    s_mov_b32 s27, 0x20000
    v_lshlrev_b32 v21, 6, v22
    buffer_load_dwordx2 v[8:9], v21, s[24:27], 0 offen offset:40
    s_add_u32 s3, s40, 4096
    buffer_load_dwordx4 v[124:127], v3, s[16:19], s3 offen
    buffer_load_dwordx4 v[116:119], v3, s[16:19], s40 offen offset:2048
    buffer_load_dwordx4 v[120:123], v3, s[16:19], s40 offen offset:3072
    buffer_load_dwordx4 v[108:111], v3, s[16:19], s40 offen offset:0
    buffer_load_dwordx4 v[112:115], v3, s[16:19], s40 offen offset:1024
    s_add_u32 s40, s40, 0x50000
    v_mad_u32_u24 v4, v22, 20, v4
    v_or_b32 v4, 0xf0000000, v4
    v_or_b32 v2, 0xf0000000, v2
    v_lshlrev_b32 v23, 2, v22
    v_sub_u32 v1, 28, v23
    v_and_b32 v18, 3, v0
    v_lshlrev_b32 v18, 4, v18
    v_mov_b32 v10, 0x3f80
    v_mov_b32 v11, 0
    v_lshlrev_b64 v[10:11], v18, v[10:11]
    v_and_b32 v18, 3, v0
    v_lshlrev_b32 v18, 4, v18
    v_mov_b32 v12, 0xbf80
    v_mov_b32 v13, 0
    v_lshlrev_b64 v[12:13], v18, v[12:13]
    v_lshlrev_b32 v24, 4, v0
    v_lshl_add_u32 v0, v17, 2, s38
    v_mov_b32 v45, 0xf0000000
    v_mov_b32 v5, 0x1fff8
    v_mov_b32 v6, 0x07ff0000
    s_mov_b32 s44, 0x4000c0c
    s_mov_b32 s45, 0x4010c0c
    s_mov_b32 s46, 0x4020c0c
    s_mov_b32 s47, 0x4030c0c
    s_mov_b32 s36, 0
    s_mov_b32 s42, 0
    s_mov_b64 s[80:81], 0
    s_mov_b64 s[84:85], 0
    s_mov_b64 s[48:49], 0
    s_load_dwordx4 s[96:99], s[6:7], 0
    s_load_dwordx2 s[4:5], s[0:1], 24
    s_waitcnt lgkmcnt(0)
    s_mov_b32 s8, s30
    s_mov_b32 s9, s31
    s_mov_b32 s10, 0xd340000
    s_mov_b32 s11, 0x20000
    s_add_u32 s20, s30, 0xd841000
    s_addc_u32 s21, s31, 0
    s_mov_b32 s22, 0x13880
    s_mov_b32 s23, 0x20000
    s_lshl_b32 s3, s33, 6
    s_add_u32 s3, s3, s34
    s_mul_i32 s3, s3, 80000
    s_add_u32 s20, s20, s3
    s_addc_u32 s21, s21, 0
    v_mov_b32 v68, 0
    v_mov_b32 v69, 0
    v_mov_b32 v70, 0
    v_mov_b32 v71, 0
    v_mov_b32 v72, 0
    v_mov_b32 v73, 0
    v_mov_b32 v74, 0
    v_mov_b32 v75, 0
    v_add_u32 v24, 81920, v24
    ds_write_b128 v24, v[68:71] offset:0
    ds_write_b128 v24, v[68:71] offset:16384
    ds_write_b128 v24, v[68:71] offset:32768
    ds_write_b128 v24, v[68:71] offset:49152
    v_add_u32 v47, 0x10000, v24
    ds_write_b128 v47, v[68:71]
    s_waitcnt vmcnt(5)
    v_sub_u16 v88, v56, v48
    v_and_b32 v89, 3, v48
    v_add3_u32 v99, v88, v89, 3
    v_and_b32 v99, -4, v99
    v_max_u32 v99, 4, v99
    v_and_b32 v97, 0xfffc, v48
    v_bfm_b32 v96, v88, v89
    v_add_u32_dpp v91, v99, v99 row_shr:1 row_mask:0xf bank_mask:0xf bound_ctrl:1
    v_mad_u32_u24 v97, v97, 5, v2
    v_cmp_lt_u32 vcc, 16, v99
    v_add_u32_dpp v91, v91, v91 row_shr:2 row_mask:0xf bank_mask:0xf bound_ctrl:1
    v_sub_u32 v98, s38, v99
    v_lshrrev_b64 v[48:49], 16, v[48:49]
    v_add_u32_dpp v91, v91, v91 row_shr:4 row_mask:0xf bank_mask:0xf bound_ctrl:1
    v_lshrrev_b64 v[56:57], 16, v[56:57]
    s_mov_b32 s43, 0
    v_add_u32_dpp v91, v91, v91 row_shr:8 row_mask:0xf bank_mask:0xf bound_ctrl:1
    s_nop 1
    v_add_u32_dpp v91, v91, v91 row_bcast:15 row_mask:0xa bank_mask:0xf
    s_nop 1
    v_add_u32_dpp v91, v91, v91 row_bcast:31 row_mask:0xc bank_mask:0xf
    v_add_u32 v98, v98, v91
    v_readlane_b32 s37, v91, 63
    s_cbranch_vccnz L2_xo1
L2_xp1:
    v_mov_b32 v44, v43
    s_cmp_gt_u32 s37, 1024
    s_cbranch_scc1 L2_xs2
    s_cmp_lg_u32 s43, 0
    s_cbranch_scc1 L2_xa2
L2_xb2:
    v_lshlrev_b32 v89, 16, v96
    v_add_u32 v90, 60, v97
    v_bitop3_b32 v90, v89, v45, v90 bitop3:0x6a
    ds_write_b32 v98, v90 offset:12
    v_lshlrev_b32 v89, 20, v96
    v_add_u32 v90, 40, v97
    v_bitop3_b32 v90, v89, v45, v90 bitop3:0x6a
    ds_write_b32 v98, v90 offset:8
    v_lshlrev_b32 v89, 24, v96
    v_add_u32 v90, 20, v97
    v_bitop3_b32 v90, v89, v45, v90 bitop3:0x6a
    ds_write_b32 v98, v90 offset:4
    v_lshlrev_b32 v89, 28, v96
    v_bitop3_b32 v90, v89, v45, v97 bitop3:0x6a
    ds_write_b32 v98, v90 offset:0
    v_mov_b32_dpp v91, v64 quad_perm:[0,0,0,0] row_mask:0xf bank_mask:0xf
    v_and_b32 v89, 3, v91
    v_and_b32 v97, 0xfffc, v91
    v_sub_u16_dpp v88, v64, v91 quad_perm:[2,2,2,2] row_mask:0xf bank_mask:0xf
    v_mad_u32_u24 v97, v97, 5, v4
    v_add_u32 v99, v88, v89
    v_bfm_b32 v96, v88, v89
    v_cmp_lt_u32 s[58:59], 16, v99
    v_lshlrev_b32 v89, v1, v96
    v_and_b32 v89, v45, v89
    v_cmp_ne_u32 vcc, 0, v89
    v_xor_b32 v90, v97, v89
    s_add_u32 s3, s37, s38
    v_mbcnt_lo_u32_b32 v98, vcc_lo, 0
    v_mbcnt_hi_u32_b32 v98, vcc_hi, v98
    s_bcnt1_i32_b64 s41, vcc
    v_lshl_add_u32 v98, v98, 2, s3
    s_mov_b64 exec, vcc
    ds_write_b32 v98, v90
    s_mov_b64 exec, -1
    s_lshl2_add_u32 s37, s41, s37
    s_cmp_lg_u64 s[58:59], 0
    s_cbranch_scc1 L2_xe2
L2_xr2:
    v_add_u32 v98, s37, v0
    v_mov_b32 v90, -1
    ds_write_b32 v98, v90
    ds_read2st64_b32 v[40:41], v0 offset0:0 offset1:1
    ds_read2st64_b32 v[42:43], v0 offset0:2 offset1:3
    s_sub_u32 s3, s37, 768
    s_cmp_gt_u32 s3, 256
    s_cbranch_scc1 L2_xf2
L2_xg2:
    v_sub_u16 v88, v58, v50
    v_and_b32 v89, 3, v50
    v_add3_u32 v99, v88, v89, 3
    v_and_b32 v99, -4, v99
    v_max_u32 v99, 4, v99
    v_and_b32 v97, 0xfffc, v50
    v_bfm_b32 v96, v88, v89
    v_add_u32_dpp v91, v99, v99 row_shr:1 row_mask:0xf bank_mask:0xf bound_ctrl:1
    v_mad_u32_u24 v97, v97, 5, v2
    v_cmp_lt_u32 vcc, 16, v99
    v_add_u32_dpp v91, v91, v91 row_shr:2 row_mask:0xf bank_mask:0xf bound_ctrl:1
    v_sub_u32 v98, s38, v99
    v_lshrrev_b64 v[50:51], 16, v[50:51]
    v_add_u32_dpp v91, v91, v91 row_shr:4 row_mask:0xf bank_mask:0xf bound_ctrl:1
    v_lshrrev_b64 v[58:59], 16, v[58:59]
    s_mov_b32 s43, 0
    v_add_u32_dpp v91, v91, v91 row_shr:8 row_mask:0xf bank_mask:0xf bound_ctrl:1
    s_nop 1
    v_add_u32_dpp v91, v91, v91 row_bcast:15 row_mask:0xa bank_mask:0xf
    s_nop 1
    v_add_u32_dpp v91, v91, v91 row_bcast:31 row_mask:0xc bank_mask:0xf
    v_add_u32 v98, v98, v91
    v_readlane_b32 s37, v91, 63
    s_cbranch_vccnz L2_xo3
L2_xp3:
    s_waitcnt lgkmcnt(0)
    v_mov_b32 v21, v40
    v_mov_b32 v27, v41
    v_mov_b32 v33, v42
    v_mov_b32 v39, v43
    v_and_b32 v47, 0x0fffffff, v21
    buffer_load_dwordx4 v[16:19], v47, s[8:11], 0 offen
    buffer_load_dwordx3 v[18:20], v47, s[8:11], 0 offen offset:8
    s_waitcnt vmcnt(6)
    s_mov_b32 m0, s69
    s_nop 0
    ds_write_addtid_b32 v124 offset:34816
    ds_write_addtid_b32 v125 offset:35072
    ds_write_addtid_b32 v126 offset:35328
    ds_write_addtid_b32 v127 offset:35584
    s_waitcnt vmcnt(5)
    ds_write_addtid_b32 v116 offset:32768
    ds_write_addtid_b32 v117 offset:33024
    ds_write_addtid_b32 v118 offset:33280
    ds_write_addtid_b32 v119 offset:33536
    s_waitcnt vmcnt(4)
    ds_write_addtid_b32 v120 offset:33792
    ds_write_addtid_b32 v121 offset:34048
    ds_write_addtid_b32 v122 offset:34304
    ds_write_addtid_b32 v123 offset:34560
    v_mov_b32 v44, v43
    s_cmp_gt_u32 s37, 1024
    s_cbranch_scc1 L2_xs4
    s_cmp_lg_u32 s43, 0
    s_cbranch_scc1 L2_xa4
L2_xb4:
    v_lshlrev_b32 v89, 16, v96
    v_add_u32 v90, 60, v97
    v_bitop3_b32 v90, v89, v45, v90 bitop3:0x6a
    ds_write_b32 v98, v90 offset:12
    v_lshlrev_b32 v89, 20, v96
    v_add_u32 v90, 40, v97
    v_bitop3_b32 v90, v89, v45, v90 bitop3:0x6a
    ds_write_b32 v98, v90 offset:8
    v_lshlrev_b32 v89, 24, v96
    v_add_u32 v90, 20, v97
    v_bitop3_b32 v90, v89, v45, v90 bitop3:0x6a
    ds_write_b32 v98, v90 offset:4
    v_lshlrev_b32 v89, 28, v96
    v_bitop3_b32 v90, v89, v45, v97 bitop3:0x6a
    ds_write_b32 v98, v90 offset:0
    v_mov_b32_dpp v91, v66 quad_perm:[0,0,0,0] row_mask:0xf bank_mask:0xf
    v_and_b32 v89, 3, v91
    v_and_b32 v97, 0xfffc, v91
    v_sub_u16_dpp v88, v66, v91 quad_perm:[2,2,2,2] row_mask:0xf bank_mask:0xf
    v_mad_u32_u24 v97, v97, 5, v4
    v_add_u32 v99, v88, v89
    v_bfm_b32 v96, v88, v89
    v_cmp_lt_u32 s[58:59], 16, v99
    v_lshlrev_b32 v89, v1, v96
    v_and_b32 v89, v45, v89
    v_cmp_ne_u32 vcc, 0, v89
    v_xor_b32 v90, v97, v89
    s_add_u32 s3, s37, s38
    v_mbcnt_lo_u32_b32 v98, vcc_lo, 0
    v_mbcnt_hi_u32_b32 v98, vcc_hi, v98
    s_bcnt1_i32_b64 s41, vcc
    v_lshl_add_u32 v98, v98, 2, s3
    s_mov_b64 exec, vcc
    ds_write_b32 v98, v90
    s_mov_b64 exec, -1
    s_lshl2_add_u32 s37, s41, s37
    s_cmp_lg_u64 s[58:59], 0
    s_cbranch_scc1 L2_xe4
L2_xr4:
    v_add_u32 v98, s37, v0
    v_mov_b32 v90, -1
    ds_write_b32 v98, v90
    ds_read2st64_b32 v[40:41], v0 offset0:0 offset1:1
    ds_read2st64_b32 v[42:43], v0 offset0:2 offset1:3
    s_sub_u32 s3, s37, 768
    s_cmp_gt_u32 s3, 256
    s_cbranch_scc1 L2_xf4
L2_xg4:
    s_waitcnt vmcnt(3)
    s_mov_b32 m0, s38
    s_nop 0
    ds_write_addtid_b32 v108 offset:0
    ds_write_addtid_b32 v109 offset:256
    ds_write_addtid_b32 v110 offset:512
    ds_write_addtid_b32 v111 offset:768
    s_waitcnt vmcnt(2)
    ds_write_addtid_b32 v112 offset:1024
    ds_write_addtid_b32 v113 offset:1280
    ds_write_addtid_b32 v114 offset:1536
    ds_write_addtid_b32 v115 offset:1792
    s_waitcnt lgkmcnt(0)
    s_barrier
    s_bitcmp1_b32 s36, s42
    s_cbranch_scc1 L2_slow
L2_ret0:
    s_setprio 3
    v_and_b32 v47, 0x0fffffff, v27
    buffer_load_dwordx4 v[22:25], v47, s[8:11], 0 offen
    buffer_load_dwordx3 v[24:26], v47, s[8:11], 0 offen offset:8
    s_waitcnt vmcnt(2)
    v_and_b32 v46, 0x20000000, v21
    v_lshrrev_b32 v47, 14, v17
    v_bitop3_b32 v47, v47, v5, v46 bitop3:0xea
    ds_read_b64 v[102:103], v47
    v_bitop3_b32 v93, v17, v5, v46 bitop3:0xea
    v_and_b32 v46, 0x10000000, v21
    v_lshrrev_b32 v47, 14, v16
    v_bitop3_b32 v47, v47, v5, v46 bitop3:0xea
    ds_read_b64 v[100:101], v47
    v_bitop3_b32 v92, v16, v5, v46 bitop3:0xea
    v_perm_b32 v15, v17, v20, s45
    v_bitop3_b32 v46, v17, 0.5, -0.5 bitop3:0xa8
    v_perm_b32 v14, v16, v20, s44
    v_bitop3_b32 v47, v16, 0.5, -0.5 bitop3:0xa8
    s_waitcnt lgkmcnt(0)
    v_mfma_f32_4x4x4_16b_bf16 v[80:83], v[8:9], v[102:103], 0
    v_mfma_f32_4x4x4_16b_bf16 v[76:79], v[8:9], v[100:101], 0
    v_bitop3_b32 v15, v6, v15, v46 bitop3:0xca
    v_bitop3_b32 v14, v6, v14, v47 bitop3:0xca
    v_cmp_lt_u32 s[84:85], v5, v92
    s_nop 0
    v_pk_mul_f32 v[80:81], v[80:81], v[14:15] op_sel:[0,1] op_sel_hi:[1,1]
    v_pk_mul_f32 v[82:83], v[82:83], v[14:15] op_sel:[0,1] op_sel_hi:[1,1]
    v_pk_mul_f32 v[76:77], v[76:77], v[14:15] op_sel:[0,0] op_sel_hi:[1,0]
    v_pk_mul_f32 v[78:79], v[78:79], v[14:15] op_sel:[0,0] op_sel_hi:[1,0]
    v_and_b32 v47, 0x0fffffff, v33
    buffer_load_dwordx4 v[28:31], v47, s[8:11], 0 offen
    buffer_load_dwordx3 v[30:32], v47, s[8:11], 0 offen offset:8
    v_cmpx_ne_u64 vcc, v[74:75], v[70:71]
    s_and_b64 s[82:83], vcc, s[80:81]
    s_cbranch_scc1 L2_c5
L2_d5:
    v_mov_b64 v[84:85], v[70:71]
    v_mov_b32 v7, v95
    v_mov_b64 v[86:87], v[74:75]
    s_mov_b64 exec, -1
    s_or_b64 s[80:81], s[80:81], vcc
    v_cmpx_ne_u64 vcc, v[72:73], v[68:69]
    s_and_b64 s[82:83], vcc, s[80:81]
    s_cbranch_scc1 L2_c6
L2_d6:
    v_mov_b64 v[84:85], v[68:69]
    v_mov_b32 v7, v94
    v_mov_b64 v[86:87], v[72:73]
    s_mov_b64 exec, -1
    s_or_b64 s[80:81], s[80:81], vcc
    ds_read_b64 v[70:71], v93 offset:65408
    s_and_b64 exec, s[84:85], s[80:81]
    v_mfma_f32_4x4x4_16b_bf16 v[76:79], v[12:13], v[84:85], 0
    v_mov_b32 v92, v7
    s_andn2_b64 s[80:81], s[80:81], s[84:85]
    v_mfma_f32_4x4x4_16b_bf16 v[76:79], v[10:11], v[86:87], v[76:79]
    s_mov_b64 exec, -1
    ds_read_b64 v[68:69], v92 offset:65408
    v_and_b32 v46, 0x80000000, v21
    v_lshrrev_b32 v47, 14, v19
    v_bitop3_b32 v47, v47, v5, v46 bitop3:0xea
    ds_read_b64 v[106:107], v47
    v_bitop3_b32 v95, v19, v5, v46 bitop3:0xea
    v_and_b32 v46, 0x40000000, v21
    v_lshrrev_b32 v47, 14, v18
    v_bitop3_b32 v47, v47, v5, v46 bitop3:0xea
    ds_read_b64 v[104:105], v47
    v_bitop3_b32 v94, v18, v5, v46 bitop3:0xea
    s_waitcnt lgkmcnt(2)
    v_mfma_f32_4x4x4_16b_bf16 v[80:83], v[10:11], v[70:71], v[80:83]
    v_mfma_f32_4x4x4_16b_bf16 v[76:79], v[10:11], v[68:69], v[76:79]
    v_perm_b32 v15, v19, v20, s47
    v_bitop3_b32 v46, v19, 0.5, -0.5 bitop3:0xa8
    v_perm_b32 v14, v18, v20, s46
    v_bitop3_b32 v47, v18, 0.5, -0.5 bitop3:0xa8
    v_cvt_pk_bf16_f32 v80, v80, v81
    v_cvt_pk_bf16_f32 v81, v82, v83
    ds_wrxchg_rtn_b64 v[74:75], v93, v[80:81] offset:65408
    v_cvt_pk_bf16_f32 v76, v76, v77
    v_cvt_pk_bf16_f32 v77, v78, v79
    ds_wrxchg_rtn_b64 v[72:73], v92, v[76:77] offset:65408
    s_setprio 2
    s_waitcnt lgkmcnt(2)
    v_mfma_f32_4x4x4_16b_bf16 v[80:83], v[8:9], v[106:107], 0
    v_mfma_f32_4x4x4_16b_bf16 v[76:79], v[8:9], v[104:105], 0
    v_bitop3_b32 v15, v6, v15, v46 bitop3:0xca
    v_bitop3_b32 v14, v6, v14, v47 bitop3:0xca
    s_nop 1
    v_pk_mul_f32 v[80:81], v[80:81], v[14:15] op_sel:[0,1] op_sel_hi:[1,1]
    v_pk_mul_f32 v[82:83], v[82:83], v[14:15] op_sel:[0,1] op_sel_hi:[1,1]
    v_pk_mul_f32 v[76:77], v[76:77], v[14:15] op_sel:[0,0] op_sel_hi:[1,0]
    v_pk_mul_f32 v[78:79], v[78:79], v[14:15] op_sel:[0,0] op_sel_hi:[1,0]
    s_add_u32 s3, s40, 4096
    buffer_load_dwordx4 v[124:127], v3, s[16:19], s3 offen
    buffer_load_dwordx4 v[116:119], v3, s[16:19], s40 offen offset:2048
    s_waitcnt lgkmcnt(0)
    v_cmpx_ne_u64 vcc, v[74:75], v[70:71]
    s_and_b64 s[82:83], vcc, s[80:81]
    s_cbranch_scc1 L2_c7
L2_d7:
    v_mov_b64 v[84:85], v[70:71]
    v_mov_b32 v7, v93
    v_mov_b64 v[86:87], v[74:75]
    s_mov_b64 exec, -1
    s_or_b64 s[80:81], s[80:81], vcc
    v_cmpx_ne_u64 vcc, v[72:73], v[68:69]
    s_and_b64 s[82:83], vcc, s[80:81]
    s_cbranch_scc1 L2_c8
L2_d8:
    v_mov_b64 v[84:85], v[68:69]
    v_mov_b32 v7, v92
    v_mov_b64 v[86:87], v[72:73]
    s_mov_b64 exec, -1
    s_or_b64 s[80:81], s[80:81], vcc
    ds_read_b64 v[70:71], v95 offset:65408
    ds_read_b64 v[68:69], v94 offset:65408
    s_waitcnt vmcnt(4)
    v_and_b32 v46, 0x20000000, v27
    v_lshrrev_b32 v47, 14, v23
    v_bitop3_b32 v47, v47, v5, v46 bitop3:0xea
    ds_read_b64 v[102:103], v47
    v_bitop3_b32 v93, v23, v5, v46 bitop3:0xea
    v_and_b32 v46, 0x10000000, v27
    v_lshrrev_b32 v47, 14, v22
    v_bitop3_b32 v47, v47, v5, v46 bitop3:0xea
    ds_read_b64 v[100:101], v47
    v_bitop3_b32 v92, v22, v5, v46 bitop3:0xea
    s_waitcnt lgkmcnt(2)
    v_mfma_f32_4x4x4_16b_bf16 v[80:83], v[10:11], v[70:71], v[80:83]
    v_mfma_f32_4x4x4_16b_bf16 v[76:79], v[10:11], v[68:69], v[76:79]
    v_perm_b32 v15, v23, v26, s45
    v_bitop3_b32 v46, v23, 0.5, -0.5 bitop3:0xa8
    v_perm_b32 v14, v22, v26, s44
    v_bitop3_b32 v47, v22, 0.5, -0.5 bitop3:0xa8
    v_cvt_pk_bf16_f32 v80, v80, v81
    v_cvt_pk_bf16_f32 v81, v82, v83
    ds_wrxchg_rtn_b64 v[74:75], v95, v[80:81] offset:65408
    v_cvt_pk_bf16_f32 v76, v76, v77
    v_cvt_pk_bf16_f32 v77, v78, v79
    ds_wrxchg_rtn_b64 v[72:73], v94, v[76:77] offset:65408
    s_waitcnt lgkmcnt(2)
    v_mfma_f32_4x4x4_16b_bf16 v[80:83], v[8:9], v[102:103], 0
    v_mfma_f32_4x4x4_16b_bf16 v[76:79], v[8:9], v[100:101], 0
    v_bitop3_b32 v15, v6, v15, v46 bitop3:0xca
    v_bitop3_b32 v14, v6, v14, v47 bitop3:0xca
    v_cmp_lt_u32 s[84:85], v5, v92
    s_nop 0
    v_pk_mul_f32 v[80:81], v[80:81], v[14:15] op_sel:[0,1] op_sel_hi:[1,1]
    v_pk_mul_f32 v[82:83], v[82:83], v[14:15] op_sel:[0,1] op_sel_hi:[1,1]
    v_pk_mul_f32 v[76:77], v[76:77], v[14:15] op_sel:[0,0] op_sel_hi:[1,0]
    v_pk_mul_f32 v[78:79], v[78:79], v[14:15] op_sel:[0,0] op_sel_hi:[1,0]
    v_sub_u16 v88, v60, v52
    v_and_b32 v89, 3, v52
    v_add3_u32 v99, v88, v89, 3
    v_and_b32 v99, -4, v99
    v_max_u32 v99, 4, v99
    v_and_b32 v97, 0xfffc, v52
    v_bfm_b32 v96, v88, v89
    v_add_u32_dpp v91, v99, v99 row_shr:1 row_mask:0xf bank_mask:0xf bound_ctrl:1
    v_mad_u32_u24 v97, v97, 5, v2
    v_cmp_lt_u32 vcc, 16, v99
    v_add_u32_dpp v91, v91, v91 row_shr:2 row_mask:0xf bank_mask:0xf bound_ctrl:1
    v_sub_u32 v98, s38, v99
    v_lshrrev_b64 v[52:53], 16, v[52:53]
    v_add_u32_dpp v91, v91, v91 row_shr:4 row_mask:0xf bank_mask:0xf bound_ctrl:1
    v_lshrrev_b64 v[60:61], 16, v[60:61]
    s_mov_b32 s43, 0
    v_add_u32_dpp v91, v91, v91 row_shr:8 row_mask:0xf bank_mask:0xf bound_ctrl:1
    s_nop 1
    v_add_u32_dpp v91, v91, v91 row_bcast:15 row_mask:0xa bank_mask:0xf
    s_nop 1
    v_add_u32_dpp v91, v91, v91 row_bcast:31 row_mask:0xc bank_mask:0xf
    v_add_u32 v98, v98, v91
    v_readlane_b32 s37, v91, 63
    s_cbranch_vccnz L2_xo9
L2_xp9:
    v_and_b32 v47, 0x0fffffff, v39
    buffer_load_dwordx4 v[34:37], v47, s[8:11], 0 offen
    buffer_load_dwordx3 v[36:38], v47, s[8:11], 0 offen offset:8
    buffer_load_dwordx4 v[120:123], v3, s[16:19], s40 offen offset:3072
    s_waitcnt lgkmcnt(0)
    v_cmpx_ne_u64 vcc, v[74:75], v[70:71]
    s_and_b64 s[82:83], vcc, s[80:81]
    s_cbranch_scc1 L2_c10
L2_d10:
    v_mov_b64 v[84:85], v[70:71]
    v_mov_b32 v7, v95
    v_mov_b64 v[86:87], v[74:75]
    s_mov_b64 exec, -1
    s_or_b64 s[80:81], s[80:81], vcc
    v_cmpx_ne_u64 vcc, v[72:73], v[68:69]
    s_and_b64 s[82:83], vcc, s[80:81]
    s_cbranch_scc1 L2_c11
L2_d11:
    v_mov_b64 v[84:85], v[68:69]
    v_mov_b32 v7, v94
    v_mov_b64 v[86:87], v[72:73]
    s_mov_b64 exec, -1
    s_or_b64 s[80:81], s[80:81], vcc
    ds_read_b64 v[70:71], v93 offset:65408
    s_and_b64 exec, s[84:85], s[80:81]
    v_mfma_f32_4x4x4_16b_bf16 v[76:79], v[12:13], v[84:85], 0
    v_mov_b32 v92, v7
    s_andn2_b64 s[80:81], s[80:81], s[84:85]
    v_mfma_f32_4x4x4_16b_bf16 v[76:79], v[10:11], v[86:87], v[76:79]
    s_mov_b64 exec, -1
    ds_read_b64 v[68:69], v92 offset:65408
    v_and_b32 v46, 0x80000000, v27
    v_lshrrev_b32 v47, 14, v25
    v_bitop3_b32 v47, v47, v5, v46 bitop3:0xea
    ds_read_b64 v[106:107], v47
    v_bitop3_b32 v95, v25, v5, v46 bitop3:0xea
    v_and_b32 v46, 0x40000000, v27
    v_lshrrev_b32 v47, 14, v24
    v_bitop3_b32 v47, v47, v5, v46 bitop3:0xea
    ds_read_b64 v[104:105], v47
    v_bitop3_b32 v94, v24, v5, v46 bitop3:0xea
    s_waitcnt lgkmcnt(2)
    v_mfma_f32_4x4x4_16b_bf16 v[80:83], v[10:11], v[70:71], v[80:83]
    v_mfma_f32_4x4x4_16b_bf16 v[76:79], v[10:11], v[68:69], v[76:79]
    v_perm_b32 v15, v25, v26, s47
    v_bitop3_b32 v46, v25, 0.5, -0.5 bitop3:0xa8
    v_perm_b32 v14, v24, v26, s46
    v_bitop3_b32 v47, v24, 0.5, -0.5 bitop3:0xa8
    v_cvt_pk_bf16_f32 v80, v80, v81
    v_cvt_pk_bf16_f32 v81, v82, v83
    ds_wrxchg_rtn_b64 v[74:75], v93, v[80:81] offset:65408
    v_cvt_pk_bf16_f32 v76, v76, v77
    v_cvt_pk_bf16_f32 v77, v78, v79
    ds_wrxchg_rtn_b64 v[72:73], v92, v[76:77] offset:65408
    s_setprio 1
    s_waitcnt lgkmcnt(2)
    v_mfma_f32_4x4x4_16b_bf16 v[80:83], v[8:9], v[106:107], 0
    v_mfma_f32_4x4x4_16b_bf16 v[76:79], v[8:9], v[104:105], 0
    v_bitop3_b32 v15, v6, v15, v46 bitop3:0xca
    v_bitop3_b32 v14, v6, v14, v47 bitop3:0xca
    s_nop 1
    v_pk_mul_f32 v[80:81], v[80:81], v[14:15] op_sel:[0,1] op_sel_hi:[1,1]
    v_pk_mul_f32 v[82:83], v[82:83], v[14:15] op_sel:[0,1] op_sel_hi:[1,1]
    v_pk_mul_f32 v[76:77], v[76:77], v[14:15] op_sel:[0,0] op_sel_hi:[1,0]
    v_pk_mul_f32 v[78:79], v[78:79], v[14:15] op_sel:[0,0] op_sel_hi:[1,0]
    buffer_load_dwordx4 v[108:111], v3, s[16:19], s40 offen offset:0
    buffer_load_dwordx4 v[112:115], v3, s[16:19], s40 offen offset:1024
    s_waitcnt lgkmcnt(0)
    v_cmpx_ne_u64 vcc, v[74:75], v[70:71]
    s_and_b64 s[82:83], vcc, s[80:81]
    s_cbranch_scc1 L2_c12
L2_d12:
    v_mov_b64 v[84:85], v[70:71]
    v_mov_b32 v7, v93
    v_mov_b64 v[86:87], v[74:75]
    s_mov_b64 exec, -1
    s_or_b64 s[80:81], s[80:81], vcc
    v_cmpx_ne_u64 vcc, v[72:73], v[68:69]
    s_and_b64 s[82:83], vcc, s[80:81]
    s_cbranch_scc1 L2_c13
L2_d13:
    v_mov_b64 v[84:85], v[68:69]
    v_mov_b32 v7, v92
    v_mov_b64 v[86:87], v[72:73]
    s_mov_b64 exec, -1
    s_or_b64 s[80:81], s[80:81], vcc
    ds_read_b64 v[70:71], v95 offset:65408
    ds_read_b64 v[68:69], v94 offset:65408
    s_waitcnt vmcnt(7)
    v_and_b32 v46, 0x20000000, v33
    v_lshrrev_b32 v47, 14, v29
    v_bitop3_b32 v47, v47, v5, v46 bitop3:0xea
    ds_read_b64 v[102:103], v47
    v_bitop3_b32 v93, v29, v5, v46 bitop3:0xea
    v_and_b32 v46, 0x10000000, v33
    v_lshrrev_b32 v47, 14, v28
    v_bitop3_b32 v47, v47, v5, v46 bitop3:0xea
    ds_read_b64 v[100:101], v47
    v_bitop3_b32 v92, v28, v5, v46 bitop3:0xea
    s_waitcnt lgkmcnt(2)
    v_mfma_f32_4x4x4_16b_bf16 v[80:83], v[10:11], v[70:71], v[80:83]
    v_mfma_f32_4x4x4_16b_bf16 v[76:79], v[10:11], v[68:69], v[76:79]
    v_perm_b32 v15, v29, v32, s45
    v_bitop3_b32 v46, v29, 0.5, -0.5 bitop3:0xa8
    v_perm_b32 v14, v28, v32, s44
    v_bitop3_b32 v47, v28, 0.5, -0.5 bitop3:0xa8
    v_cvt_pk_bf16_f32 v80, v80, v81
    v_cvt_pk_bf16_f32 v81, v82, v83
    ds_wrxchg_rtn_b64 v[74:75], v95, v[80:81] offset:65408
    v_cvt_pk_bf16_f32 v76, v76, v77
    v_cvt_pk_bf16_f32 v77, v78, v79
    ds_wrxchg_rtn_b64 v[72:73], v94, v[76:77] offset:65408
    s_waitcnt lgkmcnt(2)
    v_mfma_f32_4x4x4_16b_bf16 v[80:83], v[8:9], v[102:103], 0
    v_mfma_f32_4x4x4_16b_bf16 v[76:79], v[8:9], v[100:101], 0
    v_bitop3_b32 v15, v6, v15, v46 bitop3:0xca
    v_bitop3_b32 v14, v6, v14, v47 bitop3:0xca
    v_cmp_lt_u32 s[84:85], v5, v92
    s_nop 0
    v_pk_mul_f32 v[80:81], v[80:81], v[14:15] op_sel:[0,1] op_sel_hi:[1,1]
    v_pk_mul_f32 v[82:83], v[82:83], v[14:15] op_sel:[0,1] op_sel_hi:[1,1]
    v_pk_mul_f32 v[76:77], v[76:77], v[14:15] op_sel:[0,0] op_sel_hi:[1,0]
    v_pk_mul_f32 v[78:79], v[78:79], v[14:15] op_sel:[0,0] op_sel_hi:[1,0]
    v_and_b32 v47, 0x0fffffff, v40
    v_mov_b32 v21, v40
    buffer_load_dwordx4 v[16:19], v47, s[8:11], 0 offen
    buffer_load_dwordx3 v[18:20], v47, s[8:11], 0 offen offset:8
    s_waitcnt lgkmcnt(0)
    v_cmpx_ne_u64 vcc, v[74:75], v[70:71]
    s_and_b64 s[82:83], vcc, s[80:81]
    s_cbranch_scc1 L2_c14
L2_d14:
    v_mov_b64 v[84:85], v[70:71]
    v_mov_b32 v7, v95
    v_mov_b64 v[86:87], v[74:75]
    s_mov_b64 exec, -1
    s_or_b64 s[80:81], s[80:81], vcc
    v_cmpx_ne_u64 vcc, v[72:73], v[68:69]
    s_and_b64 s[82:83], vcc, s[80:81]
    s_cbranch_scc1 L2_c15
L2_d15:
    v_mov_b64 v[84:85], v[68:69]
    v_mov_b32 v7, v94
    v_mov_b64 v[86:87], v[72:73]
    s_mov_b64 exec, -1
    s_or_b64 s[80:81], s[80:81], vcc
    ds_read_b64 v[70:71], v93 offset:65408
    s_and_b64 exec, s[84:85], s[80:81]
    v_mfma_f32_4x4x4_16b_bf16 v[76:79], v[12:13], v[84:85], 0
    v_mov_b32 v92, v7
    s_andn2_b64 s[80:81], s[80:81], s[84:85]
    v_mfma_f32_4x4x4_16b_bf16 v[76:79], v[10:11], v[86:87], v[76:79]
    s_mov_b64 exec, -1
    ds_read_b64 v[68:69], v92 offset:65408
    v_and_b32 v46, 0x80000000, v33
    v_lshrrev_b32 v47, 14, v31
    v_bitop3_b32 v47, v47, v5, v46 bitop3:0xea
    ds_read_b64 v[106:107], v47
    v_bitop3_b32 v95, v31, v5, v46 bitop3:0xea
    v_and_b32 v46, 0x40000000, v33
    v_lshrrev_b32 v47, 14, v30
    v_bitop3_b32 v47, v47, v5, v46 bitop3:0xea
    ds_read_b64 v[104:105], v47
    v_bitop3_b32 v94, v30, v5, v46 bitop3:0xea
    s_waitcnt lgkmcnt(2)
    v_mfma_f32_4x4x4_16b_bf16 v[80:83], v[10:11], v[70:71], v[80:83]
    v_mfma_f32_4x4x4_16b_bf16 v[76:79], v[10:11], v[68:69], v[76:79]
    v_perm_b32 v15, v31, v32, s47
    v_bitop3_b32 v46, v31, 0.5, -0.5 bitop3:0xa8
    v_perm_b32 v14, v30, v32, s46
    v_bitop3_b32 v47, v30, 0.5, -0.5 bitop3:0xa8
    v_cvt_pk_bf16_f32 v80, v80, v81
    v_cvt_pk_bf16_f32 v81, v82, v83
    ds_wrxchg_rtn_b64 v[74:75], v93, v[80:81] offset:65408
    v_cvt_pk_bf16_f32 v76, v76, v77
    v_cvt_pk_bf16_f32 v77, v78, v79
    ds_wrxchg_rtn_b64 v[72:73], v92, v[76:77] offset:65408
    s_setprio 0
    s_waitcnt lgkmcnt(2)
    v_mfma_f32_4x4x4_16b_bf16 v[80:83], v[8:9], v[106:107], 0
    v_mfma_f32_4x4x4_16b_bf16 v[76:79], v[8:9], v[104:105], 0
    v_bitop3_b32 v15, v6, v15, v46 bitop3:0xca
    v_bitop3_b32 v14, v6, v14, v47 bitop3:0xca
    s_nop 1
    v_pk_mul_f32 v[80:81], v[80:81], v[14:15] op_sel:[0,1] op_sel_hi:[1,1]
    v_pk_mul_f32 v[82:83], v[82:83], v[14:15] op_sel:[0,1] op_sel_hi:[1,1]
    v_pk_mul_f32 v[76:77], v[76:77], v[14:15] op_sel:[0,0] op_sel_hi:[1,0]
    v_pk_mul_f32 v[78:79], v[78:79], v[14:15] op_sel:[0,0] op_sel_hi:[1,0]
    s_add_u32 s40, s40, 0x50000
    s_waitcnt lgkmcnt(0)
    v_cmpx_ne_u64 vcc, v[74:75], v[70:71]
    s_and_b64 s[82:83], vcc, s[80:81]
    s_cbranch_scc1 L2_c16
L2_d16:
    v_mov_b64 v[84:85], v[70:71]
    v_mov_b32 v7, v93
    v_mov_b64 v[86:87], v[74:75]
    s_mov_b64 exec, -1
    s_or_b64 s[80:81], s[80:81], vcc
    v_cmpx_ne_u64 vcc, v[72:73], v[68:69]
    s_and_b64 s[82:83], vcc, s[80:81]
    s_cbranch_scc1 L2_c17
L2_d17:
    v_mov_b64 v[84:85], v[68:69]
    v_mov_b32 v7, v92
    v_mov_b64 v[86:87], v[72:73]
    s_mov_b64 exec, -1
    s_or_b64 s[80:81], s[80:81], vcc
    ds_read_b64 v[70:71], v95 offset:65408
    ds_read_b64 v[68:69], v94 offset:65408
    s_waitcnt vmcnt(5)
    v_and_b32 v46, 0x20000000, v39
    v_lshrrev_b32 v47, 14, v35
    v_bitop3_b32 v47, v47, v5, v46 bitop3:0xea
    ds_read_b64 v[102:103], v47
    v_bitop3_b32 v93, v35, v5, v46 bitop3:0xea
    v_and_b32 v46, 0x10000000, v39
    v_lshrrev_b32 v47, 14, v34
    v_bitop3_b32 v47, v47, v5, v46 bitop3:0xea
    ds_read_b64 v[100:101], v47
    v_bitop3_b32 v92, v34, v5, v46 bitop3:0xea
    v_and_b32 v46, 0x80000000, v39
    v_lshrrev_b32 v47, 14, v37
    v_bitop3_b32 v47, v47, v5, v46 bitop3:0xea
    ds_read_b64 v[106:107], v47
    v_and_b32 v46, 0x40000000, v39
    v_lshrrev_b32 v47, 14, v36
    v_bitop3_b32 v47, v47, v5, v46 bitop3:0xea
    ds_read_b64 v[104:105], v47
    s_waitcnt lgkmcnt(4)
    v_mfma_f32_4x4x4_16b_bf16 v[80:83], v[10:11], v[70:71], v[80:83]
    v_mfma_f32_4x4x4_16b_bf16 v[76:79], v[10:11], v[68:69], v[76:79]
    v_perm_b32 v15, v35, v38, s45
    v_bitop3_b32 v46, v35, 0.5, -0.5 bitop3:0xa8
    v_perm_b32 v14, v34, v38, s44
    v_bitop3_b32 v47, v34, 0.5, -0.5 bitop3:0xa8
    v_cvt_pk_bf16_f32 v80, v80, v81
    v_cvt_pk_bf16_f32 v81, v82, v83
    ds_wrxchg_rtn_b64 v[74:75], v95, v[80:81] offset:65408
    v_cvt_pk_bf16_f32 v76, v76, v77
    v_cvt_pk_bf16_f32 v77, v78, v79
    ds_wrxchg_rtn_b64 v[72:73], v94, v[76:77] offset:65408
    s_waitcnt lgkmcnt(2)
    s_barrier
    s_setprio 3
    s_mov_b32 m0, s69
    s_nop 0
    ds_write_addtid_b32 v116 offset:32768
    ds_write_addtid_b32 v117 offset:33024
    ds_write_addtid_b32 v118 offset:33280
    ds_write_addtid_b32 v119 offset:33536
    buffer_load_dwordx4 v[116:119], v3, s[16:19], s40 offen offset:2048
    s_waitcnt vmcnt(5)
    ds_write_addtid_b32 v120 offset:33792
    ds_write_addtid_b32 v121 offset:34048
    ds_write_addtid_b32 v122 offset:34304
    ds_write_addtid_b32 v123 offset:34560
    buffer_load_dwordx4 v[120:123], v3, s[16:19], s40 offen offset:3072
    v_mfma_f32_4x4x4_16b_bf16 v[80:83], v[8:9], v[102:103], 0
    v_mfma_f32_4x4x4_16b_bf16 v[76:79], v[8:9], v[100:101], 0
    v_bitop3_b32 v15, v6, v15, v46 bitop3:0xca
    v_bitop3_b32 v14, v6, v14, v47 bitop3:0xca
    v_cmp_lt_u32 s[84:85], v5, v92
    s_nop 0
    v_pk_mul_f32 v[80:81], v[80:81], v[14:15] op_sel:[0,1] op_sel_hi:[1,1]
    v_pk_mul_f32 v[82:83], v[82:83], v[14:15] op_sel:[0,1] op_sel_hi:[1,1]
    v_pk_mul_f32 v[76:77], v[76:77], v[14:15] op_sel:[0,0] op_sel_hi:[1,0]
    v_pk_mul_f32 v[78:79], v[78:79], v[14:15] op_sel:[0,0] op_sel_hi:[1,0]
    v_and_b32 v47, 0x0fffffff, v41
    v_mov_b32 v27, v41
    buffer_load_dwordx4 v[22:25], v47, s[8:11], 0 offen
    buffer_load_dwordx3 v[24:26], v47, s[8:11], 0 offen offset:8
    v_mov_b32 v33, v42
    v_mov_b32 v44, v43
    s_cmp_gt_u32 s37, 1024
    s_cbranch_scc1 L2_xs18
    s_cmp_lg_u32 s43, 0
    s_cbranch_scc1 L2_xa18
L2_xb18:
    v_lshlrev_b32 v89, 16, v96
    v_add_u32 v90, 60, v97
    v_bitop3_b32 v90, v89, v45, v90 bitop3:0x6a
    ds_write_b32 v98, v90 offset:12
    v_lshlrev_b32 v89, 20, v96
    v_add_u32 v90, 40, v97
    v_bitop3_b32 v90, v89, v45, v90 bitop3:0x6a
    ds_write_b32 v98, v90 offset:8
    v_lshlrev_b32 v89, 24, v96
    v_add_u32 v90, 20, v97
    v_bitop3_b32 v90, v89, v45, v90 bitop3:0x6a
    ds_write_b32 v98, v90 offset:4
    v_lshlrev_b32 v89, 28, v96
    v_bitop3_b32 v90, v89, v45, v97 bitop3:0x6a
    ds_write_b32 v98, v90 offset:0
    v_mov_b32_dpp v91, v64 quad_perm:[1,1,1,1] row_mask:0xf bank_mask:0xf
    v_and_b32 v89, 3, v91
    v_and_b32 v97, 0xfffc, v91
    v_sub_u16_dpp v88, v64, v91 quad_perm:[3,3,3,3] row_mask:0xf bank_mask:0xf
    v_mad_u32_u24 v97, v97, 5, v4
    v_add_u32 v99, v88, v89
    v_bfm_b32 v96, v88, v89
    v_cmp_lt_u32 s[58:59], 16, v99
    v_lshlrev_b32 v89, v1, v96
    v_and_b32 v89, v45, v89
    v_cmp_ne_u32 vcc, 0, v89
    v_xor_b32 v90, v97, v89
    s_add_u32 s3, s37, s38
    v_mbcnt_lo_u32_b32 v98, vcc_lo, 0
    v_mbcnt_hi_u32_b32 v98, vcc_hi, v98
    s_bcnt1_i32_b64 s41, vcc
    v_lshl_add_u32 v98, v98, 2, s3
    s_mov_b64 exec, vcc
    ds_write_b32 v98, v90
    s_mov_b64 exec, -1
    s_lshl2_add_u32 s37, s41, s37
    s_cmp_lg_u64 s[58:59], 0
    s_cbranch_scc1 L2_xe18
L2_xr18:
    v_add_u32 v98, s37, v0
    v_mov_b32 v90, -1
    ds_write_b32 v98, v90
    ds_read2st64_b32 v[40:41], v0 offset0:0 offset1:1
    ds_read2st64_b32 v[42:43], v0 offset0:2 offset1:3
    s_sub_u32 s3, s37, 768
    s_cmp_gt_u32 s3, 256
    s_cbranch_scc1 L2_xf18
L2_xg18:
    s_setprio 2
    ds_write_addtid_b32 v124 offset:34816
    ds_write_addtid_b32 v125 offset:35072
    ds_write_addtid_b32 v126 offset:35328
    ds_write_addtid_b32 v127 offset:35584
    s_add_u32 s3, s40, 4096
    buffer_load_dwordx4 v[124:127], v3, s[16:19], s3 offen
    s_waitcnt lgkmcnt(14)
    v_cmpx_ne_u64 vcc, v[74:75], v[70:71]
    s_and_b64 s[82:83], vcc, s[80:81]
    s_cbranch_scc1 L2_c19
L2_d19:
    v_mov_b64 v[84:85], v[70:71]
    v_mov_b32 v7, v95
    v_mov_b64 v[86:87], v[74:75]
    s_mov_b64 exec, -1
    s_or_b64 s[80:81], s[80:81], vcc
    v_cmpx_ne_u64 vcc, v[72:73], v[68:69]
    s_and_b64 s[82:83], vcc, s[80:81]
    s_cbranch_scc1 L2_c20
L2_d20:
    v_mov_b64 v[84:85], v[68:69]
    v_mov_b32 v7, v94
    v_mov_b64 v[86:87], v[72:73]
    s_mov_b64 exec, -1
    s_or_b64 s[80:81], s[80:81], vcc
    ds_read_b64 v[70:71], v93 offset:65408
    s_and_b64 exec, s[84:85], s[80:81]
    v_mfma_f32_4x4x4_16b_bf16 v[76:79], v[12:13], v[84:85], 0
    v_mov_b32 v92, v7
    s_andn2_b64 s[80:81], s[80:81], s[84:85]
    v_mfma_f32_4x4x4_16b_bf16 v[76:79], v[10:11], v[86:87], v[76:79]
    s_mov_b64 exec, -1
    ds_read_b64 v[68:69], v92 offset:65408
    s_setprio 1
    s_waitcnt vmcnt(8)
    s_mov_b32 m0, s38
    s_nop 0
    ds_write_addtid_b32 v108 offset:0
    ds_write_addtid_b32 v109 offset:256
    ds_write_addtid_b32 v110 offset:512
    ds_write_addtid_b32 v111 offset:768
    s_waitcnt lgkmcnt(4)
    v_mfma_f32_4x4x4_16b_bf16 v[80:83], v[10:11], v[70:71], v[80:83]
    v_mfma_f32_4x4x4_16b_bf16 v[76:79], v[10:11], v[68:69], v[76:79]
    v_and_b32 v46, 0x40000000, v39
    v_bitop3_b32 v94, v36, v5, v46 bitop3:0xea
    v_and_b32 v46, 0x80000000, v39
    v_bitop3_b32 v95, v37, v5, v46 bitop3:0xea
    v_perm_b32 v15, v37, v38, s47
    v_bitop3_b32 v46, v37, 0.5, -0.5 bitop3:0xa8
    v_perm_b32 v14, v36, v38, s46
    v_bitop3_b32 v47, v36, 0.5, -0.5 bitop3:0xa8
    v_cvt_pk_bf16_f32 v80, v80, v81
    v_cvt_pk_bf16_f32 v81, v82, v83
    ds_wrxchg_rtn_b64 v[74:75], v93, v[80:81] offset:65408
    v_cvt_pk_bf16_f32 v76, v76, v77
    v_cvt_pk_bf16_f32 v77, v78, v79
    ds_wrxchg_rtn_b64 v[72:73], v92, v[76:77] offset:65408
    s_setprio 0
    s_waitcnt vmcnt(7)
    ds_write_addtid_b32 v112 offset:1024
    ds_write_addtid_b32 v113 offset:1280
    ds_write_addtid_b32 v114 offset:1536
    ds_write_addtid_b32 v115 offset:1792
    v_mfma_f32_4x4x4_16b_bf16 v[80:83], v[8:9], v[106:107], 0
    v_mfma_f32_4x4x4_16b_bf16 v[76:79], v[8:9], v[104:105], 0
    v_bitop3_b32 v15, v6, v15, v46 bitop3:0xca
    v_bitop3_b32 v14, v6, v14, v47 bitop3:0xca
    s_nop 1
    v_pk_mul_f32 v[80:81], v[80:81], v[14:15] op_sel:[0,1] op_sel_hi:[1,1]
    v_pk_mul_f32 v[82:83], v[82:83], v[14:15] op_sel:[0,1] op_sel_hi:[1,1]
    v_pk_mul_f32 v[76:77], v[76:77], v[14:15] op_sel:[0,0] op_sel_hi:[1,0]
    v_pk_mul_f32 v[78:79], v[78:79], v[14:15] op_sel:[0,0] op_sel_hi:[1,0]
    s_add_u32 s42, s42, 1
    s_waitcnt lgkmcnt(0)
    s_barrier
    s_bitcmp1_b32 s36, s42
    s_cbranch_scc1 L2_slow
L2_ret1:
    s_setprio 3
    v_and_b32 v47, 0x0fffffff, v33
    buffer_load_dwordx4 v[28:31], v47, s[8:11], 0 offen
    buffer_load_dwordx3 v[30:32], v47, s[8:11], 0 offen offset:8
    v_cmpx_ne_u64 vcc, v[74:75], v[70:71]
    s_and_b64 s[82:83], vcc, s[80:81]
    s_cbranch_scc1 L2_c21
L2_d21:
    v_mov_b64 v[84:85], v[70:71]
    v_mov_b32 v7, v93
    v_mov_b64 v[86:87], v[74:75]
    s_mov_b64 exec, -1
    s_or_b64 s[80:81], s[80:81], vcc
    v_cmpx_ne_u64 vcc, v[72:73], v[68:69]
    s_and_b64 s[82:83], vcc, s[80:81]
    s_cbranch_scc1 L2_c22
L2_d22:
    v_mov_b64 v[84:85], v[68:69]
    v_mov_b32 v7, v92
    v_mov_b64 v[86:87], v[72:73]
    s_mov_b64 exec, -1
    s_or_b64 s[80:81], s[80:81], vcc
    ds_read_b64 v[70:71], v95 offset:65408
    ds_read_b64 v[68:69], v94 offset:65408
    s_waitcnt vmcnt(7)
    v_and_b32 v46, 0x20000000, v21
    v_lshrrev_b32 v47, 14, v17
    v_bitop3_b32 v47, v47, v5, v46 bitop3:0xea
    ds_read_b64 v[102:103], v47
    v_bitop3_b32 v93, v17, v5, v46 bitop3:0xea
    v_and_b32 v46, 0x10000000, v21
    v_lshrrev_b32 v47, 14, v16
    v_bitop3_b32 v47, v47, v5, v46 bitop3:0xea
    ds_read_b64 v[100:101], v47
    v_bitop3_b32 v92, v16, v5, v46 bitop3:0xea
    s_waitcnt lgkmcnt(2)
    v_mfma_f32_4x4x4_16b_bf16 v[80:83], v[10:11], v[70:71], v[80:83]
    v_mfma_f32_4x4x4_16b_bf16 v[76:79], v[10:11], v[68:69], v[76:79]
    v_perm_b32 v15, v17, v20, s45
    v_bitop3_b32 v46, v17, 0.5, -0.5 bitop3:0xa8
    v_perm_b32 v14, v16, v20, s44
    v_bitop3_b32 v47, v16, 0.5, -0.5 bitop3:0xa8
    v_cvt_pk_bf16_f32 v80, v80, v81
    v_cvt_pk_bf16_f32 v81, v82, v83
    ds_wrxchg_rtn_b64 v[74:75], v95, v[80:81] offset:65408
    v_cvt_pk_bf16_f32 v76, v76, v77
    v_cvt_pk_bf16_f32 v77, v78, v79
    ds_wrxchg_rtn_b64 v[72:73], v94, v[76:77] offset:65408
    s_waitcnt lgkmcnt(2)
    v_mfma_f32_4x4x4_16b_bf16 v[80:83], v[8:9], v[102:103], 0
    v_mfma_f32_4x4x4_16b_bf16 v[76:79], v[8:9], v[100:101], 0
    v_bitop3_b32 v15, v6, v15, v46 bitop3:0xca
    v_bitop3_b32 v14, v6, v14, v47 bitop3:0xca
    v_cmp_lt_u32 s[84:85], v5, v92
    s_nop 0
    v_pk_mul_f32 v[80:81], v[80:81], v[14:15] op_sel:[0,1] op_sel_hi:[1,1]
    v_pk_mul_f32 v[82:83], v[82:83], v[14:15] op_sel:[0,1] op_sel_hi:[1,1]
    v_pk_mul_f32 v[76:77], v[76:77], v[14:15] op_sel:[0,0] op_sel_hi:[1,0]
    v_pk_mul_f32 v[78:79], v[78:79], v[14:15] op_sel:[0,0] op_sel_hi:[1,0]
    buffer_load_dwordx4 v[108:111], v3, s[16:19], s40 offen offset:0
    s_waitcnt lgkmcnt(0)
    v_cmpx_ne_u64 vcc, v[74:75], v[70:71]
    s_and_b64 s[82:83], vcc, s[80:81]
    s_cbranch_scc1 L2_c23
L2_d23:
    v_mov_b64 v[84:85], v[70:71]
    v_mov_b32 v7, v95
    v_mov_b64 v[86:87], v[74:75]
    s_mov_b64 exec, -1
    s_or_b64 s[80:81], s[80:81], vcc
    v_cmpx_ne_u64 vcc, v[72:73], v[68:69]
    s_and_b64 s[82:83], vcc, s[80:81]
    s_cbranch_scc1 L2_c24
L2_d24:
    v_mov_b64 v[84:85], v[68:69]
    v_mov_b32 v7, v94
    v_mov_b64 v[86:87], v[72:73]
    s_mov_b64 exec, -1
    s_or_b64 s[80:81], s[80:81], vcc
    ds_read_b64 v[70:71], v93 offset:65408
    s_and_b64 exec, s[84:85], s[80:81]
    v_mfma_f32_4x4x4_16b_bf16 v[76:79], v[12:13], v[84:85], 0
    v_mov_b32 v92, v7
    s_andn2_b64 s[80:81], s[80:81], s[84:85]
    v_mfma_f32_4x4x4_16b_bf16 v[76:79], v[10:11], v[86:87], v[76:79]
    s_mov_b64 exec, -1
    ds_read_b64 v[68:69], v92 offset:65408
    v_and_b32 v46, 0x80000000, v21
    v_lshrrev_b32 v47, 14, v19
    v_bitop3_b32 v47, v47, v5, v46 bitop3:0xea
    ds_read_b64 v[106:107], v47
    v_bitop3_b32 v95, v19, v5, v46 bitop3:0xea
    v_and_b32 v46, 0x40000000, v21
    v_lshrrev_b32 v47, 14, v18
    v_bitop3_b32 v47, v47, v5, v46 bitop3:0xea
    ds_read_b64 v[104:105], v47
    v_bitop3_b32 v94, v18, v5, v46 bitop3:0xea
    s_waitcnt lgkmcnt(2)
    v_mfma_f32_4x4x4_16b_bf16 v[80:83], v[10:11], v[70:71], v[80:83]
    v_mfma_f32_4x4x4_16b_bf16 v[76:79], v[10:11], v[68:69], v[76:79]
    v_perm_b32 v15, v19, v20, s47
    v_bitop3_b32 v46, v19, 0.5, -0.5 bitop3:0xa8
    v_perm_b32 v14, v18, v20, s46
    v_bitop3_b32 v47, v18, 0.5, -0.5 bitop3:0xa8
    v_cvt_pk_bf16_f32 v80, v80, v81
    v_cvt_pk_bf16_f32 v81, v82, v83
    ds_wrxchg_rtn_b64 v[74:75], v93, v[80:81] offset:65408
    v_cvt_pk_bf16_f32 v76, v76, v77
    v_cvt_pk_bf16_f32 v77, v78, v79
    ds_wrxchg_rtn_b64 v[72:73], v92, v[76:77] offset:65408
    s_setprio 2
    s_waitcnt lgkmcnt(2)
    v_mfma_f32_4x4x4_16b_bf16 v[80:83], v[8:9], v[106:107], 0
    v_mfma_f32_4x4x4_16b_bf16 v[76:79], v[8:9], v[104:105], 0
    v_bitop3_b32 v15, v6, v15, v46 bitop3:0xca
    v_bitop3_b32 v14, v6, v14, v47 bitop3:0xca
    s_nop 1
    v_pk_mul_f32 v[80:81], v[80:81], v[14:15] op_sel:[0,1] op_sel_hi:[1,1]
    v_pk_mul_f32 v[82:83], v[82:83], v[14:15] op_sel:[0,1] op_sel_hi:[1,1]
    v_pk_mul_f32 v[76:77], v[76:77], v[14:15] op_sel:[0,0] op_sel_hi:[1,0]
    v_pk_mul_f32 v[78:79], v[78:79], v[14:15] op_sel:[0,0] op_sel_hi:[1,0]
    v_and_b32 v47, 0x0fffffff, v44
    v_mov_b32 v39, v44
    buffer_load_dwordx4 v[34:37], v47, s[8:11], 0 offen
    buffer_load_dwordx3 v[36:38], v47, s[8:11], 0 offen offset:8
    s_waitcnt lgkmcnt(0)
    v_cmpx_ne_u64 vcc, v[74:75], v[70:71]
    s_and_b64 s[82:83], vcc, s[80:81]
    s_cbranch_scc1 L2_c25
L2_d25:
    v_mov_b64 v[84:85], v[70:71]
    v_mov_b32 v7, v93
    v_mov_b64 v[86:87], v[74:75]
    s_mov_b64 exec, -1
    s_or_b64 s[80:81], s[80:81], vcc
    v_cmpx_ne_u64 vcc, v[72:73], v[68:69]
    s_and_b64 s[82:83], vcc, s[80:81]
    s_cbranch_scc1 L2_c26
L2_d26:
    v_mov_b64 v[84:85], v[68:69]
    v_mov_b32 v7, v92
    v_mov_b64 v[86:87], v[72:73]
    s_mov_b64 exec, -1
    s_or_b64 s[80:81], s[80:81], vcc
    ds_read_b64 v[70:71], v95 offset:65408
    ds_read_b64 v[68:69], v94 offset:65408
    s_waitcnt vmcnt(6)
    v_and_b32 v46, 0x20000000, v27
    v_lshrrev_b32 v47, 14, v23
    v_bitop3_b32 v47, v47, v5, v46 bitop3:0xea
    ds_read_b64 v[102:103], v47
    v_bitop3_b32 v93, v23, v5, v46 bitop3:0xea
    v_and_b32 v46, 0x10000000, v27
    v_lshrrev_b32 v47, 14, v22
    v_bitop3_b32 v47, v47, v5, v46 bitop3:0xea
    ds_read_b64 v[100:101], v47
    v_bitop3_b32 v92, v22, v5, v46 bitop3:0xea
    s_waitcnt lgkmcnt(2)
    v_mfma_f32_4x4x4_16b_bf16 v[80:83], v[10:11], v[70:71], v[80:83]
    v_mfma_f32_4x4x4_16b_bf16 v[76:79], v[10:11], v[68:69], v[76:79]
    v_perm_b32 v15, v23, v26, s45
    v_bitop3_b32 v46, v23, 0.5, -0.5 bitop3:0xa8
    v_perm_b32 v14, v22, v26, s44
    v_bitop3_b32 v47, v22, 0.5, -0.5 bitop3:0xa8
    v_cvt_pk_bf16_f32 v80, v80, v81
    v_cvt_pk_bf16_f32 v81, v82, v83
    ds_wrxchg_rtn_b64 v[74:75], v95, v[80:81] offset:65408
    v_cvt_pk_bf16_f32 v76, v76, v77
    v_cvt_pk_bf16_f32 v77, v78, v79
    ds_wrxchg_rtn_b64 v[72:73], v94, v[76:77] offset:65408
    s_waitcnt lgkmcnt(2)
    v_mfma_f32_4x4x4_16b_bf16 v[80:83], v[8:9], v[102:103], 0
    v_mfma_f32_4x4x4_16b_bf16 v[76:79], v[8:9], v[100:101], 0
    v_bitop3_b32 v15, v6, v15, v46 bitop3:0xca
    v_bitop3_b32 v14, v6, v14, v47 bitop3:0xca
    v_cmp_lt_u32 s[84:85], v5, v92
    s_nop 0
    v_pk_mul_f32 v[80:81], v[80:81], v[14:15] op_sel:[0,1] op_sel_hi:[1,1]
    v_pk_mul_f32 v[82:83], v[82:83], v[14:15] op_sel:[0,1] op_sel_hi:[1,1]
    v_pk_mul_f32 v[76:77], v[76:77], v[14:15] op_sel:[0,0] op_sel_hi:[1,0]
    v_pk_mul_f32 v[78:79], v[78:79], v[14:15] op_sel:[0,0] op_sel_hi:[1,0]
    v_sub_u16 v88, v62, v54
    v_and_b32 v89, 3, v54
    v_add3_u32 v99, v88, v89, 3
    v_and_b32 v99, -4, v99
    v_max_u32 v99, 4, v99
    v_and_b32 v97, 0xfffc, v54
    v_bfm_b32 v96, v88, v89
    v_add_u32_dpp v91, v99, v99 row_shr:1 row_mask:0xf bank_mask:0xf bound_ctrl:1
    v_mad_u32_u24 v97, v97, 5, v2
    v_cmp_lt_u32 vcc, 16, v99
    v_add_u32_dpp v91, v91, v91 row_shr:2 row_mask:0xf bank_mask:0xf bound_ctrl:1
    v_sub_u32 v98, s38, v99
    v_lshrrev_b64 v[54:55], 16, v[54:55]
    v_add_u32_dpp v91, v91, v91 row_shr:4 row_mask:0xf bank_mask:0xf bound_ctrl:1
    v_lshrrev_b64 v[62:63], 16, v[62:63]
    s_mov_b32 s43, 0
    v_add_u32_dpp v91, v91, v91 row_shr:8 row_mask:0xf bank_mask:0xf bound_ctrl:1
    s_nop 1
    v_add_u32_dpp v91, v91, v91 row_bcast:15 row_mask:0xa bank_mask:0xf
    s_nop 1
    v_add_u32_dpp v91, v91, v91 row_bcast:31 row_mask:0xc bank_mask:0xf
    v_add_u32 v98, v98, v91
    v_readlane_b32 s37, v91, 63
    s_cbranch_vccnz L2_xo27
L2_xp27:
    buffer_load_dwordx4 v[112:115], v3, s[16:19], s40 offen offset:1024
    v_and_b32 v47, 0x0fffffff, v40
    v_mov_b32 v21, v40
    buffer_load_dwordx4 v[16:19], v47, s[8:11], 0 offen
    buffer_load_dwordx3 v[18:20], v47, s[8:11], 0 offen offset:8
    s_waitcnt lgkmcnt(0)
    v_cmpx_ne_u64 vcc, v[74:75], v[70:71]
    s_and_b64 s[82:83], vcc, s[80:81]
    s_cbranch_scc1 L2_c28
L2_d28:
    v_mov_b64 v[84:85], v[70:71]
    v_mov_b32 v7, v95
    v_mov_b64 v[86:87], v[74:75]
    s_mov_b64 exec, -1
    s_or_b64 s[80:81], s[80:81], vcc
    v_cmpx_ne_u64 vcc, v[72:73], v[68:69]
    s_and_b64 s[82:83], vcc, s[80:81]
    s_cbranch_scc1 L2_c29
L2_d29:
    v_mov_b64 v[84:85], v[68:69]
    v_mov_b32 v7, v94
    v_mov_b64 v[86:87], v[72:73]
    s_mov_b64 exec, -1
    s_or_b64 s[80:81], s[80:81], vcc
    ds_read_b64 v[70:71], v93 offset:65408
    s_and_b64 exec, s[84:85], s[80:81]
    v_mfma_f32_4x4x4_16b_bf16 v[76:79], v[12:13], v[84:85], 0
    v_mov_b32 v92, v7
    s_andn2_b64 s[80:81], s[80:81], s[84:85]
    v_mfma_f32_4x4x4_16b_bf16 v[76:79], v[10:11], v[86:87], v[76:79]
    s_mov_b64 exec, -1
    ds_read_b64 v[68:69], v92 offset:65408
    v_and_b32 v46, 0x80000000, v27
    v_lshrrev_b32 v47, 14, v25
    v_bitop3_b32 v47, v47, v5, v46 bitop3:0xea
    ds_read_b64 v[106:107], v47
    v_bitop3_b32 v95, v25, v5, v46 bitop3:0xea
    v_and_b32 v46, 0x40000000, v27
    v_lshrrev_b32 v47, 14, v24
    v_bitop3_b32 v47, v47, v5, v46 bitop3:0xea
    ds_read_b64 v[104:105], v47
    v_bitop3_b32 v94, v24, v5, v46 bitop3:0xea
    s_waitcnt lgkmcnt(2)
    v_mfma_f32_4x4x4_16b_bf16 v[80:83], v[10:11], v[70:71], v[80:83]
    v_mfma_f32_4x4x4_16b_bf16 v[76:79], v[10:11], v[68:69], v[76:79]
    v_perm_b32 v15, v25, v26, s47
    v_bitop3_b32 v46, v25, 0.5, -0.5 bitop3:0xa8
    v_perm_b32 v14, v24, v26, s46
    v_bitop3_b32 v47, v24, 0.5, -0.5 bitop3:0xa8
    v_cvt_pk_bf16_f32 v80, v80, v81
    v_cvt_pk_bf16_f32 v81, v82, v83
    ds_wrxchg_rtn_b64 v[74:75], v93, v[80:81] offset:65408
    v_cvt_pk_bf16_f32 v76, v76, v77
    v_cvt_pk_bf16_f32 v77, v78, v79
    ds_wrxchg_rtn_b64 v[72:73], v92, v[76:77] offset:65408
    s_setprio 1
    s_waitcnt lgkmcnt(2)
    v_mfma_f32_4x4x4_16b_bf16 v[80:83], v[8:9], v[106:107], 0
    v_mfma_f32_4x4x4_16b_bf16 v[76:79], v[8:9], v[104:105], 0
    v_bitop3_b32 v15, v6, v15, v46 bitop3:0xca
    v_bitop3_b32 v14, v6, v14, v47 bitop3:0xca
    s_nop 1
    v_pk_mul_f32 v[80:81], v[80:81], v[14:15] op_sel:[0,1] op_sel_hi:[1,1]
    v_pk_mul_f32 v[82:83], v[82:83], v[14:15] op_sel:[0,1] op_sel_hi:[1,1]
    v_pk_mul_f32 v[76:77], v[76:77], v[14:15] op_sel:[0,0] op_sel_hi:[1,0]
    v_pk_mul_f32 v[78:79], v[78:79], v[14:15] op_sel:[0,0] op_sel_hi:[1,0]
    s_waitcnt lgkmcnt(0)
    v_cmpx_ne_u64 vcc, v[74:75], v[70:71]
    s_and_b64 s[82:83], vcc, s[80:81]
    s_cbranch_scc1 L2_c30
L2_d30:
    v_mov_b64 v[84:85], v[70:71]
    v_mov_b32 v7, v93
    v_mov_b64 v[86:87], v[74:75]
    s_mov_b64 exec, -1
    s_or_b64 s[80:81], s[80:81], vcc
    v_cmpx_ne_u64 vcc, v[72:73], v[68:69]
    s_and_b64 s[82:83], vcc, s[80:81]
    s_cbranch_scc1 L2_c31
L2_d31:
    v_mov_b64 v[84:85], v[68:69]
    v_mov_b32 v7, v92
    v_mov_b64 v[86:87], v[72:73]
    s_mov_b64 exec, -1
    s_or_b64 s[80:81], s[80:81], vcc
    ds_read_b64 v[70:71], v95 offset:65408
    ds_read_b64 v[68:69], v94 offset:65408
    s_waitcnt vmcnt(6)
    v_and_b32 v46, 0x20000000, v33
    v_lshrrev_b32 v47, 14, v29
    v_bitop3_b32 v47, v47, v5, v46 bitop3:0xea
    ds_read_b64 v[102:103], v47
    v_bitop3_b32 v93, v29, v5, v46 bitop3:0xea
    v_and_b32 v46, 0x10000000, v33
    v_lshrrev_b32 v47, 14, v28
    v_bitop3_b32 v47, v47, v5, v46 bitop3:0xea
    ds_read_b64 v[100:101], v47
    v_bitop3_b32 v92, v28, v5, v46 bitop3:0xea
    s_waitcnt lgkmcnt(2)
    v_mfma_f32_4x4x4_16b_bf16 v[80:83], v[10:11], v[70:71], v[80:83]
    v_mfma_f32_4x4x4_16b_bf16 v[76:79], v[10:11], v[68:69], v[76:79]
    v_perm_b32 v15, v29, v32, s45
    v_bitop3_b32 v46, v29, 0.5, -0.5 bitop3:0xa8
    v_perm_b32 v14, v28, v32, s44
    v_bitop3_b32 v47, v28, 0.5, -0.5 bitop3:0xa8
    v_cvt_pk_bf16_f32 v80, v80, v81
    v_cvt_pk_bf16_f32 v81, v82, v83
    ds_wrxchg_rtn_b64 v[74:75], v95, v[80:81] offset:65408
    v_cvt_pk_bf16_f32 v76, v76, v77
    v_cvt_pk_bf16_f32 v77, v78, v79
    ds_wrxchg_rtn_b64 v[72:73], v94, v[76:77] offset:65408
    s_waitcnt lgkmcnt(2)
    v_mfma_f32_4x4x4_16b_bf16 v[80:83], v[8:9], v[102:103], 0
    v_mfma_f32_4x4x4_16b_bf16 v[76:79], v[8:9], v[100:101], 0
    v_bitop3_b32 v15, v6, v15, v46 bitop3:0xca
    v_bitop3_b32 v14, v6, v14, v47 bitop3:0xca
    v_cmp_lt_u32 s[84:85], v5, v92
    s_nop 0
    v_pk_mul_f32 v[80:81], v[80:81], v[14:15] op_sel:[0,1] op_sel_hi:[1,1]
    v_pk_mul_f32 v[82:83], v[82:83], v[14:15] op_sel:[0,1] op_sel_hi:[1,1]
    v_pk_mul_f32 v[76:77], v[76:77], v[14:15] op_sel:[0,0] op_sel_hi:[1,0]
    v_pk_mul_f32 v[78:79], v[78:79], v[14:15] op_sel:[0,0] op_sel_hi:[1,0]
    v_and_b32 v47, 0x0fffffff, v41
    v_mov_b32 v27, v41
    buffer_load_dwordx4 v[22:25], v47, s[8:11], 0 offen
    buffer_load_dwordx3 v[24:26], v47, s[8:11], 0 offen offset:8
    s_waitcnt lgkmcnt(0)
    v_cmpx_ne_u64 vcc, v[74:75], v[70:71]
    s_and_b64 s[82:83], vcc, s[80:81]
    s_cbranch_scc1 L2_c32
L2_d32:
    v_mov_b64 v[84:85], v[70:71]
    v_mov_b32 v7, v95
    v_mov_b64 v[86:87], v[74:75]
    s_mov_b64 exec, -1
    s_or_b64 s[80:81], s[80:81], vcc
    v_cmpx_ne_u64 vcc, v[72:73], v[68:69]
    s_and_b64 s[82:83], vcc, s[80:81]
    s_cbranch_scc1 L2_c33
L2_d33:
    v_mov_b64 v[84:85], v[68:69]
    v_mov_b32 v7, v94
    v_mov_b64 v[86:87], v[72:73]
    s_mov_b64 exec, -1
    s_or_b64 s[80:81], s[80:81], vcc
    ds_read_b64 v[70:71], v93 offset:65408
    s_and_b64 exec, s[84:85], s[80:81]
    v_mfma_f32_4x4x4_16b_bf16 v[76:79], v[12:13], v[84:85], 0
    v_mov_b32 v92, v7
    s_andn2_b64 s[80:81], s[80:81], s[84:85]
    v_mfma_f32_4x4x4_16b_bf16 v[76:79], v[10:11], v[86:87], v[76:79]
    s_mov_b64 exec, -1
    ds_read_b64 v[68:69], v92 offset:65408
    v_and_b32 v46, 0x80000000, v33
    v_lshrrev_b32 v47, 14, v31
    v_bitop3_b32 v47, v47, v5, v46 bitop3:0xea
    ds_read_b64 v[106:107], v47
    v_bitop3_b32 v95, v31, v5, v46 bitop3:0xea
    v_and_b32 v46, 0x40000000, v33
    v_lshrrev_b32 v47, 14, v30
    v_bitop3_b32 v47, v47, v5, v46 bitop3:0xea
    ds_read_b64 v[104:105], v47
    v_bitop3_b32 v94, v30, v5, v46 bitop3:0xea
    s_waitcnt lgkmcnt(2)
    v_mfma_f32_4x4x4_16b_bf16 v[80:83], v[10:11], v[70:71], v[80:83]
    v_mfma_f32_4x4x4_16b_bf16 v[76:79], v[10:11], v[68:69], v[76:79]
    v_perm_b32 v15, v31, v32, s47
    v_bitop3_b32 v46, v31, 0.5, -0.5 bitop3:0xa8
    v_perm_b32 v14, v30, v32, s46
    v_bitop3_b32 v47, v30, 0.5, -0.5 bitop3:0xa8
    v_cvt_pk_bf16_f32 v80, v80, v81
    v_cvt_pk_bf16_f32 v81, v82, v83
    ds_wrxchg_rtn_b64 v[74:75], v93, v[80:81] offset:65408
    v_cvt_pk_bf16_f32 v76, v76, v77
    v_cvt_pk_bf16_f32 v77, v78, v79
    ds_wrxchg_rtn_b64 v[72:73], v92, v[76:77] offset:65408
    s_setprio 0
    s_waitcnt lgkmcnt(2)
    v_mfma_f32_4x4x4_16b_bf16 v[80:83], v[8:9], v[106:107], 0
    v_mfma_f32_4x4x4_16b_bf16 v[76:79], v[8:9], v[104:105], 0
    v_bitop3_b32 v15, v6, v15, v46 bitop3:0xca
    v_bitop3_b32 v14, v6, v14, v47 bitop3:0xca
    s_nop 1
    v_pk_mul_f32 v[80:81], v[80:81], v[14:15] op_sel:[0,1] op_sel_hi:[1,1]
    v_pk_mul_f32 v[82:83], v[82:83], v[14:15] op_sel:[0,1] op_sel_hi:[1,1]
    v_pk_mul_f32 v[76:77], v[76:77], v[14:15] op_sel:[0,0] op_sel_hi:[1,0]
    v_pk_mul_f32 v[78:79], v[78:79], v[14:15] op_sel:[0,0] op_sel_hi:[1,0]
    s_add_u32 s40, s40, 0x50000
    s_waitcnt lgkmcnt(0)
    v_cmpx_ne_u64 vcc, v[74:75], v[70:71]
    s_and_b64 s[82:83], vcc, s[80:81]
    s_cbranch_scc1 L2_c34
L2_d34:
    v_mov_b64 v[84:85], v[70:71]
    v_mov_b32 v7, v93
    v_mov_b64 v[86:87], v[74:75]
    s_mov_b64 exec, -1
    s_or_b64 s[80:81], s[80:81], vcc
    v_cmpx_ne_u64 vcc, v[72:73], v[68:69]
    s_and_b64 s[82:83], vcc, s[80:81]
    s_cbranch_scc1 L2_c35
L2_d35:
    v_mov_b64 v[84:85], v[68:69]
    v_mov_b32 v7, v92
    v_mov_b64 v[86:87], v[72:73]
    s_mov_b64 exec, -1
    s_or_b64 s[80:81], s[80:81], vcc
    ds_read_b64 v[70:71], v95 offset:65408
    ds_read_b64 v[68:69], v94 offset:65408
    s_waitcnt vmcnt(5)
    v_and_b32 v46, 0x20000000, v39
    v_lshrrev_b32 v47, 14, v35
    v_bitop3_b32 v47, v47, v5, v46 bitop3:0xea
    ds_read_b64 v[102:103], v47
    v_bitop3_b32 v93, v35, v5, v46 bitop3:0xea
    v_and_b32 v46, 0x10000000, v39
    v_lshrrev_b32 v47, 14, v34
    v_bitop3_b32 v47, v47, v5, v46 bitop3:0xea
    ds_read_b64 v[100:101], v47
    v_bitop3_b32 v92, v34, v5, v46 bitop3:0xea
    v_and_b32 v46, 0x80000000, v39
    v_lshrrev_b32 v47, 14, v37
    v_bitop3_b32 v47, v47, v5, v46 bitop3:0xea
    ds_read_b64 v[106:107], v47
    v_and_b32 v46, 0x40000000, v39
    v_lshrrev_b32 v47, 14, v36
    v_bitop3_b32 v47, v47, v5, v46 bitop3:0xea
    ds_read_b64 v[104:105], v47
    s_waitcnt lgkmcnt(4)
    v_mfma_f32_4x4x4_16b_bf16 v[80:83], v[10:11], v[70:71], v[80:83]
    v_mfma_f32_4x4x4_16b_bf16 v[76:79], v[10:11], v[68:69], v[76:79]
    v_perm_b32 v15, v35, v38, s45
    v_bitop3_b32 v46, v35, 0.5, -0.5 bitop3:0xa8
    v_perm_b32 v14, v34, v38, s44
    v_bitop3_b32 v47, v34, 0.5, -0.5 bitop3:0xa8
    v_cvt_pk_bf16_f32 v80, v80, v81
    v_cvt_pk_bf16_f32 v81, v82, v83
    ds_wrxchg_rtn_b64 v[74:75], v95, v[80:81] offset:65408
    v_cvt_pk_bf16_f32 v76, v76, v77
    v_cvt_pk_bf16_f32 v77, v78, v79
    ds_wrxchg_rtn_b64 v[72:73], v94, v[76:77] offset:65408
    s_waitcnt lgkmcnt(2)
    s_barrier
    s_setprio 3
    s_mov_b32 m0, s69
    s_nop 0
    ds_write_addtid_b32 v116 offset:32768
    ds_write_addtid_b32 v117 offset:33024
    ds_write_addtid_b32 v118 offset:33280
    ds_write_addtid_b32 v119 offset:33536
    buffer_load_dwordx4 v[116:119], v3, s[16:19], s40 offen offset:2048
    ds_write_addtid_b32 v120 offset:33792
    ds_write_addtid_b32 v121 offset:34048
    ds_write_addtid_b32 v122 offset:34304
    ds_write_addtid_b32 v123 offset:34560
    buffer_load_dwordx4 v[120:123], v3, s[16:19], s40 offen offset:3072
    v_mfma_f32_4x4x4_16b_bf16 v[80:83], v[8:9], v[102:103], 0
    v_mfma_f32_4x4x4_16b_bf16 v[76:79], v[8:9], v[100:101], 0
    v_bitop3_b32 v15, v6, v15, v46 bitop3:0xca
    v_bitop3_b32 v14, v6, v14, v47 bitop3:0xca
    v_cmp_lt_u32 s[84:85], v5, v92
    s_nop 0
    v_pk_mul_f32 v[80:81], v[80:81], v[14:15] op_sel:[0,1] op_sel_hi:[1,1]
    v_pk_mul_f32 v[82:83], v[82:83], v[14:15] op_sel:[0,1] op_sel_hi:[1,1]
    v_pk_mul_f32 v[76:77], v[76:77], v[14:15] op_sel:[0,0] op_sel_hi:[1,0]
    v_pk_mul_f32 v[78:79], v[78:79], v[14:15] op_sel:[0,0] op_sel_hi:[1,0]
    v_and_b32 v47, 0x0fffffff, v42
    v_mov_b32 v33, v42
    buffer_load_dwordx4 v[28:31], v47, s[8:11], 0 offen
    buffer_load_dwordx3 v[30:32], v47, s[8:11], 0 offen offset:8
    v_mov_b32 v44, v43
    s_cmp_gt_u32 s37, 1024
    s_cbranch_scc1 L2_xs36
    s_cmp_lg_u32 s43, 0
    s_cbranch_scc1 L2_xa36
L2_xb36:
    v_lshlrev_b32 v89, 16, v96
    v_add_u32 v90, 60, v97
    v_bitop3_b32 v90, v89, v45, v90 bitop3:0x6a
    ds_write_b32 v98, v90 offset:12
    v_lshlrev_b32 v89, 20, v96
    v_add_u32 v90, 40, v97
    v_bitop3_b32 v90, v89, v45, v90 bitop3:0x6a
    ds_write_b32 v98, v90 offset:8
    v_lshlrev_b32 v89, 24, v96
    v_add_u32 v90, 20, v97
    v_bitop3_b32 v90, v89, v45, v90 bitop3:0x6a
    ds_write_b32 v98, v90 offset:4
    v_lshlrev_b32 v89, 28, v96
    v_bitop3_b32 v90, v89, v45, v97 bitop3:0x6a
    ds_write_b32 v98, v90 offset:0
    v_mov_b32_dpp v91, v66 quad_perm:[1,1,1,1] row_mask:0xf bank_mask:0xf
    v_and_b32 v89, 3, v91
    v_and_b32 v97, 0xfffc, v91
    v_sub_u16_dpp v88, v66, v91 quad_perm:[3,3,3,3] row_mask:0xf bank_mask:0xf
    v_mad_u32_u24 v97, v97, 5, v4
    v_add_u32 v99, v88, v89
    v_bfm_b32 v96, v88, v89
    v_cmp_lt_u32 s[58:59], 16, v99
    v_lshlrev_b32 v89, v1, v96
    v_and_b32 v89, v45, v89
    v_cmp_ne_u32 vcc, 0, v89
    v_xor_b32 v90, v97, v89
    s_add_u32 s3, s37, s38
    v_mbcnt_lo_u32_b32 v98, vcc_lo, 0
    v_mbcnt_hi_u32_b32 v98, vcc_hi, v98
    s_bcnt1_i32_b64 s41, vcc
    v_lshl_add_u32 v98, v98, 2, s3
    s_mov_b64 exec, vcc
    ds_write_b32 v98, v90
    s_mov_b64 exec, -1
    s_lshl2_add_u32 s37, s41, s37
    s_cmp_lg_u64 s[58:59], 0
    s_cbranch_scc1 L2_xe36
L2_xr36:
    v_add_u32 v98, s37, v0
    v_mov_b32 v90, -1
    ds_write_b32 v98, v90
    ds_read2st64_b32 v[40:41], v0 offset0:0 offset1:1
    ds_read2st64_b32 v[42:43], v0 offset0:2 offset1:3
    s_sub_u32 s3, s37, 768
    s_cmp_gt_u32 s3, 256
    s_cbranch_scc1 L2_xf36
L2_xg36:
    v_lshrrev_b64 v[64:65], 16, v[64:65]
    v_lshrrev_b64 v[66:67], 16, v[66:67]
    s_setprio 2
    ds_write_addtid_b32 v124 offset:34816
    ds_write_addtid_b32 v125 offset:35072
    ds_write_addtid_b32 v126 offset:35328
    ds_write_addtid_b32 v127 offset:35584
    s_add_u32 s3, s40, 4096
    buffer_load_dwordx4 v[124:127], v3, s[16:19], s3 offen
    s_waitcnt lgkmcnt(14)
    v_cmpx_ne_u64 vcc, v[74:75], v[70:71]
    s_and_b64 s[82:83], vcc, s[80:81]
    s_cbranch_scc1 L2_c37
L2_d37:
    v_mov_b64 v[84:85], v[70:71]
    v_mov_b32 v7, v95
    v_mov_b64 v[86:87], v[74:75]
    s_mov_b64 exec, -1
    s_or_b64 s[80:81], s[80:81], vcc
    v_cmpx_ne_u64 vcc, v[72:73], v[68:69]
    s_and_b64 s[82:83], vcc, s[80:81]
    s_cbranch_scc1 L2_c38
L2_d38:
    v_mov_b64 v[84:85], v[68:69]
    v_mov_b32 v7, v94
    v_mov_b64 v[86:87], v[72:73]
    s_mov_b64 exec, -1
    s_or_b64 s[80:81], s[80:81], vcc
    ds_read_b64 v[70:71], v93 offset:65408
    s_and_b64 exec, s[84:85], s[80:81]
    v_mfma_f32_4x4x4_16b_bf16 v[76:79], v[12:13], v[84:85], 0
    v_mov_b32 v92, v7
    s_andn2_b64 s[80:81], s[80:81], s[84:85]
    v_mfma_f32_4x4x4_16b_bf16 v[76:79], v[10:11], v[86:87], v[76:79]
    s_mov_b64 exec, -1
    ds_read_b64 v[68:69], v92 offset:65408
    s_setprio 1
    s_mov_b32 m0, s38
    s_nop 0
    ds_write_addtid_b32 v108 offset:0
    ds_write_addtid_b32 v109 offset:256
    ds_write_addtid_b32 v110 offset:512
    ds_write_addtid_b32 v111 offset:768
    s_waitcnt lgkmcnt(4)
    v_mfma_f32_4x4x4_16b_bf16 v[80:83], v[10:11], v[70:71], v[80:83]
    v_mfma_f32_4x4x4_16b_bf16 v[76:79], v[10:11], v[68:69], v[76:79]
    v_and_b32 v46, 0x40000000, v39
    v_bitop3_b32 v94, v36, v5, v46 bitop3:0xea
    v_and_b32 v46, 0x80000000, v39
    v_bitop3_b32 v95, v37, v5, v46 bitop3:0xea
    v_perm_b32 v15, v37, v38, s47
    v_bitop3_b32 v46, v37, 0.5, -0.5 bitop3:0xa8
    v_perm_b32 v14, v36, v38, s46
    v_bitop3_b32 v47, v36, 0.5, -0.5 bitop3:0xa8
    v_cvt_pk_bf16_f32 v80, v80, v81
    v_cvt_pk_bf16_f32 v81, v82, v83
    ds_wrxchg_rtn_b64 v[74:75], v93, v[80:81] offset:65408
    v_cvt_pk_bf16_f32 v76, v76, v77
    v_cvt_pk_bf16_f32 v77, v78, v79
    ds_wrxchg_rtn_b64 v[72:73], v92, v[76:77] offset:65408
    s_setprio 0
    s_waitcnt vmcnt(9)
    ds_write_addtid_b32 v112 offset:1024
    ds_write_addtid_b32 v113 offset:1280
    ds_write_addtid_b32 v114 offset:1536
    ds_write_addtid_b32 v115 offset:1792
    v_mfma_f32_4x4x4_16b_bf16 v[80:83], v[8:9], v[106:107], 0
    v_mfma_f32_4x4x4_16b_bf16 v[76:79], v[8:9], v[104:105], 0
    v_bitop3_b32 v15, v6, v15, v46 bitop3:0xca
    v_bitop3_b32 v14, v6, v14, v47 bitop3:0xca
    s_nop 1
    v_pk_mul_f32 v[80:81], v[80:81], v[14:15] op_sel:[0,1] op_sel_hi:[1,1]
    v_pk_mul_f32 v[82:83], v[82:83], v[14:15] op_sel:[0,1] op_sel_hi:[1,1]
    v_pk_mul_f32 v[76:77], v[76:77], v[14:15] op_sel:[0,0] op_sel_hi:[1,0]
    v_pk_mul_f32 v[78:79], v[78:79], v[14:15] op_sel:[0,0] op_sel_hi:[1,0]
    s_add_u32 s42, s42, 1
    s_waitcnt lgkmcnt(0)
L2_loop:
    s_barrier
    s_bitcmp1_b32 s36, s42
    s_cbranch_scc1 L2_slow
L2_ret2:
    s_setprio 3
    v_and_b32 v47, 0x0fffffff, v44
    v_mov_b32 v39, v44
    buffer_load_dwordx4 v[34:37], v47, s[8:11], 0 offen
    buffer_load_dwordx3 v[36:38], v47, s[8:11], 0 offen offset:8
    v_cmpx_ne_u64 vcc, v[74:75], v[70:71]
    s_and_b64 s[82:83], vcc, s[80:81]
    s_cbranch_scc1 L2_c39
L2_d39:
    v_mov_b64 v[84:85], v[70:71]
    v_mov_b32 v7, v93
    v_mov_b64 v[86:87], v[74:75]
    s_mov_b64 exec, -1
    s_or_b64 s[80:81], s[80:81], vcc
    v_cmpx_ne_u64 vcc, v[72:73], v[68:69]
    s_and_b64 s[82:83], vcc, s[80:81]
    s_cbranch_scc1 L2_c40
L2_d40:
    v_mov_b64 v[84:85], v[68:69]
    v_mov_b32 v7, v92
    v_mov_b64 v[86:87], v[72:73]
    s_mov_b64 exec, -1
    s_or_b64 s[80:81], s[80:81], vcc
    ds_read_b64 v[70:71], v95 offset:65408
    ds_read_b64 v[68:69], v94 offset:65408
    s_waitcnt vmcnt(9)
    v_and_b32 v46, 0x20000000, v21
    v_lshrrev_b32 v47, 14, v17
    v_bitop3_b32 v47, v47, v5, v46 bitop3:0xea
    ds_read_b64 v[102:103], v47
    v_bitop3_b32 v93, v17, v5, v46 bitop3:0xea
    v_and_b32 v46, 0x10000000, v21
    v_lshrrev_b32 v47, 14, v16
    v_bitop3_b32 v47, v47, v5, v46 bitop3:0xea
    ds_read_b64 v[100:101], v47
    v_bitop3_b32 v92, v16, v5, v46 bitop3:0xea
    s_waitcnt lgkmcnt(2)
    v_mfma_f32_4x4x4_16b_bf16 v[80:83], v[10:11], v[70:71], v[80:83]
    v_mfma_f32_4x4x4_16b_bf16 v[76:79], v[10:11], v[68:69], v[76:79]
    v_perm_b32 v15, v17, v20, s45
    v_bitop3_b32 v46, v17, 0.5, -0.5 bitop3:0xa8
    v_perm_b32 v14, v16, v20, s44
    v_bitop3_b32 v47, v16, 0.5, -0.5 bitop3:0xa8
    v_cvt_pk_bf16_f32 v80, v80, v81
    v_cvt_pk_bf16_f32 v81, v82, v83
    ds_wrxchg_rtn_b64 v[74:75], v95, v[80:81] offset:65408
    v_cvt_pk_bf16_f32 v76, v76, v77
    v_cvt_pk_bf16_f32 v77, v78, v79
    ds_wrxchg_rtn_b64 v[72:73], v94, v[76:77] offset:65408
    s_waitcnt lgkmcnt(2)
    v_mfma_f32_4x4x4_16b_bf16 v[80:83], v[8:9], v[102:103], 0
    v_mfma_f32_4x4x4_16b_bf16 v[76:79], v[8:9], v[100:101], 0
    v_bitop3_b32 v15, v6, v15, v46 bitop3:0xca
    v_bitop3_b32 v14, v6, v14, v47 bitop3:0xca
    v_cmp_lt_u32 s[84:85], v5, v92
    s_nop 0
    v_pk_mul_f32 v[80:81], v[80:81], v[14:15] op_sel:[0,1] op_sel_hi:[1,1]
    v_pk_mul_f32 v[82:83], v[82:83], v[14:15] op_sel:[0,1] op_sel_hi:[1,1]
    v_pk_mul_f32 v[76:77], v[76:77], v[14:15] op_sel:[0,0] op_sel_hi:[1,0]
    v_pk_mul_f32 v[78:79], v[78:79], v[14:15] op_sel:[0,0] op_sel_hi:[1,0]
    buffer_load_dwordx4 v[108:111], v3, s[16:19], s40 offen offset:0
    s_waitcnt lgkmcnt(0)
    v_cmpx_ne_u64 vcc, v[74:75], v[70:71]
    s_and_b64 s[82:83], vcc, s[80:81]
    s_cbranch_scc1 L2_c41
L2_d41:
    v_mov_b64 v[84:85], v[70:71]
    v_mov_b32 v7, v95
    v_mov_b64 v[86:87], v[74:75]
    s_mov_b64 exec, -1
    s_or_b64 s[80:81], s[80:81], vcc
    v_cmpx_ne_u64 vcc, v[72:73], v[68:69]
    s_and_b64 s[82:83], vcc, s[80:81]
    s_cbranch_scc1 L2_c42
L2_d42:
    v_mov_b64 v[84:85], v[68:69]
    v_mov_b32 v7, v94
    v_mov_b64 v[86:87], v[72:73]
    s_mov_b64 exec, -1
    s_or_b64 s[80:81], s[80:81], vcc
    ds_read_b64 v[70:71], v93 offset:65408
    s_and_b64 exec, s[84:85], s[80:81]
    v_mfma_f32_4x4x4_16b_bf16 v[76:79], v[12:13], v[84:85], 0
    v_mov_b32 v92, v7
    s_andn2_b64 s[80:81], s[80:81], s[84:85]
    v_mfma_f32_4x4x4_16b_bf16 v[76:79], v[10:11], v[86:87], v[76:79]
    s_mov_b64 exec, -1
    ds_read_b64 v[68:69], v92 offset:65408
    v_and_b32 v46, 0x80000000, v21
    v_lshrrev_b32 v47, 14, v19
    v_bitop3_b32 v47, v47, v5, v46 bitop3:0xea
    ds_read_b64 v[106:107], v47
    v_bitop3_b32 v95, v19, v5, v46 bitop3:0xea
    v_and_b32 v46, 0x40000000, v21
    v_lshrrev_b32 v47, 14, v18
    v_bitop3_b32 v47, v47, v5, v46 bitop3:0xea
    ds_read_b64 v[104:105], v47
    v_bitop3_b32 v94, v18, v5, v46 bitop3:0xea
    s_waitcnt lgkmcnt(2)
    v_mfma_f32_4x4x4_16b_bf16 v[80:83], v[10:11], v[70:71], v[80:83]
    v_mfma_f32_4x4x4_16b_bf16 v[76:79], v[10:11], v[68:69], v[76:79]
    v_perm_b32 v15, v19, v20, s47
    v_bitop3_b32 v46, v19, 0.5, -0.5 bitop3:0xa8
    v_perm_b32 v14, v18, v20, s46
    v_bitop3_b32 v47, v18, 0.5, -0.5 bitop3:0xa8
    v_cvt_pk_bf16_f32 v80, v80, v81
    v_cvt_pk_bf16_f32 v81, v82, v83
    ds_wrxchg_rtn_b64 v[74:75], v93, v[80:81] offset:65408
    v_cvt_pk_bf16_f32 v76, v76, v77
    v_cvt_pk_bf16_f32 v77, v78, v79
    ds_wrxchg_rtn_b64 v[72:73], v92, v[76:77] offset:65408
    s_setprio 2
    s_waitcnt lgkmcnt(2)
    v_mfma_f32_4x4x4_16b_bf16 v[80:83], v[8:9], v[106:107], 0
    v_mfma_f32_4x4x4_16b_bf16 v[76:79], v[8:9], v[104:105], 0
    v_bitop3_b32 v15, v6, v15, v46 bitop3:0xca
    v_bitop3_b32 v14, v6, v14, v47 bitop3:0xca
    s_nop 1
    v_pk_mul_f32 v[80:81], v[80:81], v[14:15] op_sel:[0,1] op_sel_hi:[1,1]
    v_pk_mul_f32 v[82:83], v[82:83], v[14:15] op_sel:[0,1] op_sel_hi:[1,1]
    v_pk_mul_f32 v[76:77], v[76:77], v[14:15] op_sel:[0,0] op_sel_hi:[1,0]
    v_pk_mul_f32 v[78:79], v[78:79], v[14:15] op_sel:[0,0] op_sel_hi:[1,0]
    v_and_b32 v47, 0x0fffffff, v40
    v_mov_b32 v21, v40
    buffer_load_dwordx4 v[16:19], v47, s[8:11], 0 offen
    buffer_load_dwordx3 v[18:20], v47, s[8:11], 0 offen offset:8
    s_waitcnt lgkmcnt(0)
    v_cmpx_ne_u64 vcc, v[74:75], v[70:71]
    s_and_b64 s[82:83], vcc, s[80:81]
    s_cbranch_scc1 L2_c43
L2_d43:
    v_mov_b64 v[84:85], v[70:71]
    v_mov_b32 v7, v93
    v_mov_b64 v[86:87], v[74:75]
    s_mov_b64 exec, -1
    s_or_b64 s[80:81], s[80:81], vcc
    v_cmpx_ne_u64 vcc, v[72:73], v[68:69]
    s_and_b64 s[82:83], vcc, s[80:81]
    s_cbranch_scc1 L2_c44
L2_d44:
    v_mov_b64 v[84:85], v[68:69]
    v_mov_b32 v7, v92
    v_mov_b64 v[86:87], v[72:73]
    s_mov_b64 exec, -1
    s_or_b64 s[80:81], s[80:81], vcc
    ds_read_b64 v[70:71], v95 offset:65408
    ds_read_b64 v[68:69], v94 offset:65408
    s_waitcnt vmcnt(10)
    v_and_b32 v46, 0x20000000, v27
    v_lshrrev_b32 v47, 14, v23
    v_bitop3_b32 v47, v47, v5, v46 bitop3:0xea
    ds_read_b64 v[102:103], v47
    v_bitop3_b32 v93, v23, v5, v46 bitop3:0xea
    v_and_b32 v46, 0x10000000, v27
    v_lshrrev_b32 v47, 14, v22
    v_bitop3_b32 v47, v47, v5, v46 bitop3:0xea
    ds_read_b64 v[100:101], v47
    v_bitop3_b32 v92, v22, v5, v46 bitop3:0xea
    s_waitcnt lgkmcnt(2)
    v_mfma_f32_4x4x4_16b_bf16 v[80:83], v[10:11], v[70:71], v[80:83]
    v_mfma_f32_4x4x4_16b_bf16 v[76:79], v[10:11], v[68:69], v[76:79]
    v_perm_b32 v15, v23, v26, s45
    v_bitop3_b32 v46, v23, 0.5, -0.5 bitop3:0xa8
    v_perm_b32 v14, v22, v26, s44
    v_bitop3_b32 v47, v22, 0.5, -0.5 bitop3:0xa8
    v_cvt_pk_bf16_f32 v80, v80, v81
    v_cvt_pk_bf16_f32 v81, v82, v83
    ds_wrxchg_rtn_b64 v[74:75], v95, v[80:81] offset:65408
    v_cvt_pk_bf16_f32 v76, v76, v77
    v_cvt_pk_bf16_f32 v77, v78, v79
    ds_wrxchg_rtn_b64 v[72:73], v94, v[76:77] offset:65408
    s_waitcnt lgkmcnt(2)
    v_mfma_f32_4x4x4_16b_bf16 v[80:83], v[8:9], v[102:103], 0
    v_mfma_f32_4x4x4_16b_bf16 v[76:79], v[8:9], v[100:101], 0
    v_bitop3_b32 v15, v6, v15, v46 bitop3:0xca
    v_bitop3_b32 v14, v6, v14, v47 bitop3:0xca
    v_cmp_lt_u32 s[84:85], v5, v92
    s_nop 0
    v_pk_mul_f32 v[80:81], v[80:81], v[14:15] op_sel:[0,1] op_sel_hi:[1,1]
    v_pk_mul_f32 v[82:83], v[82:83], v[14:15] op_sel:[0,1] op_sel_hi:[1,1]
    v_pk_mul_f32 v[76:77], v[76:77], v[14:15] op_sel:[0,0] op_sel_hi:[1,0]
    v_pk_mul_f32 v[78:79], v[78:79], v[14:15] op_sel:[0,0] op_sel_hi:[1,0]
    v_sub_u16 v88, v56, v48
    v_and_b32 v89, 3, v48
    v_add3_u32 v99, v88, v89, 3
    v_and_b32 v99, -4, v99
    v_max_u32 v99, 4, v99
    v_and_b32 v97, 0xfffc, v48
    v_bfm_b32 v96, v88, v89
    v_add_u32_dpp v91, v99, v99 row_shr:1 row_mask:0xf bank_mask:0xf bound_ctrl:1
    v_mad_u32_u24 v97, v97, 5, v2
    v_cmp_lt_u32 vcc, 16, v99
    v_add_u32_dpp v91, v91, v91 row_shr:2 row_mask:0xf bank_mask:0xf bound_ctrl:1
    v_sub_u32 v98, s38, v99
    v_lshrrev_b64 v[48:49], 16, v[48:49]
    v_add_u32_dpp v91, v91, v91 row_shr:4 row_mask:0xf bank_mask:0xf bound_ctrl:1
    v_lshrrev_b64 v[56:57], 16, v[56:57]
    s_mov_b32 s43, 0
    v_add_u32_dpp v91, v91, v91 row_shr:8 row_mask:0xf bank_mask:0xf bound_ctrl:1
    s_nop 1
    v_add_u32_dpp v91, v91, v91 row_bcast:15 row_mask:0xa bank_mask:0xf
    s_nop 1
    v_add_u32_dpp v91, v91, v91 row_bcast:31 row_mask:0xc bank_mask:0xf
    v_add_u32 v98, v98, v91
    v_readlane_b32 s37, v91, 63
    s_cbranch_vccnz L2_xo45
L2_xp45:
    buffer_load_dwordx4 v[112:115], v3, s[16:19], s40 offen offset:1024
    s_waitcnt lgkmcnt(0)
    v_cmpx_ne_u64 vcc, v[74:75], v[70:71]
    s_and_b64 s[82:83], vcc, s[80:81]
    s_cbranch_scc1 L2_c46
L2_d46:
    v_mov_b64 v[84:85], v[70:71]
    v_mov_b32 v7, v95
    v_mov_b64 v[86:87], v[74:75]
    s_mov_b64 exec, -1
    s_or_b64 s[80:81], s[80:81], vcc
    v_cmpx_ne_u64 vcc, v[72:73], v[68:69]
    s_and_b64 s[82:83], vcc, s[80:81]
    s_cbranch_scc1 L2_c47
L2_d47:
    v_mov_b64 v[84:85], v[68:69]
    v_mov_b32 v7, v94
    v_mov_b64 v[86:87], v[72:73]
    s_mov_b64 exec, -1
    s_or_b64 s[80:81], s[80:81], vcc
    ds_read_b64 v[70:71], v93 offset:65408
    s_and_b64 exec, s[84:85], s[80:81]
    v_mfma_f32_4x4x4_16b_bf16 v[76:79], v[12:13], v[84:85], 0
    v_mov_b32 v92, v7
    s_andn2_b64 s[80:81], s[80:81], s[84:85]
    v_mfma_f32_4x4x4_16b_bf16 v[76:79], v[10:11], v[86:87], v[76:79]
    s_mov_b64 exec, -1
    ds_read_b64 v[68:69], v92 offset:65408
    v_and_b32 v46, 0x80000000, v27
    v_lshrrev_b32 v47, 14, v25
    v_bitop3_b32 v47, v47, v5, v46 bitop3:0xea
    ds_read_b64 v[106:107], v47
    v_bitop3_b32 v95, v25, v5, v46 bitop3:0xea
    v_and_b32 v46, 0x40000000, v27
    v_lshrrev_b32 v47, 14, v24
    v_bitop3_b32 v47, v47, v5, v46 bitop3:0xea
    ds_read_b64 v[104:105], v47
    v_bitop3_b32 v94, v24, v5, v46 bitop3:0xea
    s_waitcnt lgkmcnt(2)
    v_mfma_f32_4x4x4_16b_bf16 v[80:83], v[10:11], v[70:71], v[80:83]
    v_mfma_f32_4x4x4_16b_bf16 v[76:79], v[10:11], v[68:69], v[76:79]
    v_perm_b32 v15, v25, v26, s47
    v_bitop3_b32 v46, v25, 0.5, -0.5 bitop3:0xa8
    v_perm_b32 v14, v24, v26, s46
    v_bitop3_b32 v47, v24, 0.5, -0.5 bitop3:0xa8
    v_cvt_pk_bf16_f32 v80, v80, v81
    v_cvt_pk_bf16_f32 v81, v82, v83
    ds_wrxchg_rtn_b64 v[74:75], v93, v[80:81] offset:65408
    v_cvt_pk_bf16_f32 v76, v76, v77
    v_cvt_pk_bf16_f32 v77, v78, v79
    ds_wrxchg_rtn_b64 v[72:73], v92, v[76:77] offset:65408
    s_setprio 1
    s_waitcnt lgkmcnt(2)
    v_mfma_f32_4x4x4_16b_bf16 v[80:83], v[8:9], v[106:107], 0
    v_mfma_f32_4x4x4_16b_bf16 v[76:79], v[8:9], v[104:105], 0
    v_bitop3_b32 v15, v6, v15, v46 bitop3:0xca
    v_bitop3_b32 v14, v6, v14, v47 bitop3:0xca
    s_nop 1
    v_pk_mul_f32 v[80:81], v[80:81], v[14:15] op_sel:[0,1] op_sel_hi:[1,1]
    v_pk_mul_f32 v[82:83], v[82:83], v[14:15] op_sel:[0,1] op_sel_hi:[1,1]
    v_pk_mul_f32 v[76:77], v[76:77], v[14:15] op_sel:[0,0] op_sel_hi:[1,0]
    v_pk_mul_f32 v[78:79], v[78:79], v[14:15] op_sel:[0,0] op_sel_hi:[1,0]
    v_and_b32 v47, 0x0fffffff, v41
    v_mov_b32 v27, v41
    buffer_load_dwordx4 v[22:25], v47, s[8:11], 0 offen
    buffer_load_dwordx3 v[24:26], v47, s[8:11], 0 offen offset:8
    s_waitcnt lgkmcnt(0)
    v_cmpx_ne_u64 vcc, v[74:75], v[70:71]
    s_and_b64 s[82:83], vcc, s[80:81]
    s_cbranch_scc1 L2_c48
L2_d48:
    v_mov_b64 v[84:85], v[70:71]
    v_mov_b32 v7, v93
    v_mov_b64 v[86:87], v[74:75]
    s_mov_b64 exec, -1
    s_or_b64 s[80:81], s[80:81], vcc
    v_cmpx_ne_u64 vcc, v[72:73], v[68:69]
    s_and_b64 s[82:83], vcc, s[80:81]
    s_cbranch_scc1 L2_c49
L2_d49:
    v_mov_b64 v[84:85], v[68:69]
    v_mov_b32 v7, v92
    v_mov_b64 v[86:87], v[72:73]
    s_mov_b64 exec, -1
    s_or_b64 s[80:81], s[80:81], vcc
    ds_read_b64 v[70:71], v95 offset:65408
    ds_read_b64 v[68:69], v94 offset:65408
    s_waitcnt vmcnt(9)
    v_and_b32 v46, 0x20000000, v33
    v_lshrrev_b32 v47, 14, v29
    v_bitop3_b32 v47, v47, v5, v46 bitop3:0xea
    ds_read_b64 v[102:103], v47
    v_bitop3_b32 v93, v29, v5, v46 bitop3:0xea
    v_and_b32 v46, 0x10000000, v33
    v_lshrrev_b32 v47, 14, v28
    v_bitop3_b32 v47, v47, v5, v46 bitop3:0xea
    ds_read_b64 v[100:101], v47
    v_bitop3_b32 v92, v28, v5, v46 bitop3:0xea
    s_waitcnt lgkmcnt(2)
    v_mfma_f32_4x4x4_16b_bf16 v[80:83], v[10:11], v[70:71], v[80:83]
    v_mfma_f32_4x4x4_16b_bf16 v[76:79], v[10:11], v[68:69], v[76:79]
    v_perm_b32 v15, v29, v32, s45
    v_bitop3_b32 v46, v29, 0.5, -0.5 bitop3:0xa8
    v_perm_b32 v14, v28, v32, s44
    v_bitop3_b32 v47, v28, 0.5, -0.5 bitop3:0xa8
    v_cvt_pk_bf16_f32 v80, v80, v81
    v_cvt_pk_bf16_f32 v81, v82, v83
    ds_wrxchg_rtn_b64 v[74:75], v95, v[80:81] offset:65408
    v_cvt_pk_bf16_f32 v76, v76, v77
    v_cvt_pk_bf16_f32 v77, v78, v79
    ds_wrxchg_rtn_b64 v[72:73], v94, v[76:77] offset:65408
    s_waitcnt lgkmcnt(2)
    v_mfma_f32_4x4x4_16b_bf16 v[80:83], v[8:9], v[102:103], 0
    v_mfma_f32_4x4x4_16b_bf16 v[76:79], v[8:9], v[100:101], 0
    v_bitop3_b32 v15, v6, v15, v46 bitop3:0xca
    v_bitop3_b32 v14, v6, v14, v47 bitop3:0xca
    v_cmp_lt_u32 s[84:85], v5, v92
    s_nop 0
    v_pk_mul_f32 v[80:81], v[80:81], v[14:15] op_sel:[0,1] op_sel_hi:[1,1]
    v_pk_mul_f32 v[82:83], v[82:83], v[14:15] op_sel:[0,1] op_sel_hi:[1,1]
    v_pk_mul_f32 v[76:77], v[76:77], v[14:15] op_sel:[0,0] op_sel_hi:[1,0]
    v_pk_mul_f32 v[78:79], v[78:79], v[14:15] op_sel:[0,0] op_sel_hi:[1,0]
    s_waitcnt lgkmcnt(0)
    v_cmpx_ne_u64 vcc, v[74:75], v[70:71]
    s_and_b64 s[82:83], vcc, s[80:81]
    s_cbranch_scc1 L2_c50
L2_d50:
    v_mov_b64 v[84:85], v[70:71]
    v_mov_b32 v7, v95
    v_mov_b64 v[86:87], v[74:75]
    s_mov_b64 exec, -1
    s_or_b64 s[80:81], s[80:81], vcc
    v_cmpx_ne_u64 vcc, v[72:73], v[68:69]
    s_and_b64 s[82:83], vcc, s[80:81]
    s_cbranch_scc1 L2_c51
L2_d51:
    v_mov_b64 v[84:85], v[68:69]
    v_mov_b32 v7, v94
    v_mov_b64 v[86:87], v[72:73]
    s_mov_b64 exec, -1
    s_or_b64 s[80:81], s[80:81], vcc
    ds_read_b64 v[70:71], v93 offset:65408
    s_and_b64 exec, s[84:85], s[80:81]
    v_mfma_f32_4x4x4_16b_bf16 v[76:79], v[12:13], v[84:85], 0
    v_mov_b32 v92, v7
    s_andn2_b64 s[80:81], s[80:81], s[84:85]
    v_mfma_f32_4x4x4_16b_bf16 v[76:79], v[10:11], v[86:87], v[76:79]
    s_mov_b64 exec, -1
    ds_read_b64 v[68:69], v92 offset:65408
    v_and_b32 v46, 0x80000000, v33
    v_lshrrev_b32 v47, 14, v31
    v_bitop3_b32 v47, v47, v5, v46 bitop3:0xea
    ds_read_b64 v[106:107], v47
    v_bitop3_b32 v95, v31, v5, v46 bitop3:0xea
    v_and_b32 v46, 0x40000000, v33
    v_lshrrev_b32 v47, 14, v30
    v_bitop3_b32 v47, v47, v5, v46 bitop3:0xea
    ds_read_b64 v[104:105], v47
    v_bitop3_b32 v94, v30, v5, v46 bitop3:0xea
    s_waitcnt lgkmcnt(2)
    v_mfma_f32_4x4x4_16b_bf16 v[80:83], v[10:11], v[70:71], v[80:83]
    v_mfma_f32_4x4x4_16b_bf16 v[76:79], v[10:11], v[68:69], v[76:79]
    v_perm_b32 v15, v31, v32, s47
    v_bitop3_b32 v46, v31, 0.5, -0.5 bitop3:0xa8
    v_perm_b32 v14, v30, v32, s46
    v_bitop3_b32 v47, v30, 0.5, -0.5 bitop3:0xa8
    v_cvt_pk_bf16_f32 v80, v80, v81
    v_cvt_pk_bf16_f32 v81, v82, v83
    ds_wrxchg_rtn_b64 v[74:75], v93, v[80:81] offset:65408
    v_cvt_pk_bf16_f32 v76, v76, v77
    v_cvt_pk_bf16_f32 v77, v78, v79
    ds_wrxchg_rtn_b64 v[72:73], v92, v[76:77] offset:65408
    s_setprio 0
    s_waitcnt lgkmcnt(2)
    v_mfma_f32_4x4x4_16b_bf16 v[80:83], v[8:9], v[106:107], 0
    v_mfma_f32_4x4x4_16b_bf16 v[76:79], v[8:9], v[104:105], 0
    v_bitop3_b32 v15, v6, v15, v46 bitop3:0xca
    v_bitop3_b32 v14, v6, v14, v47 bitop3:0xca
    s_nop 1
    v_pk_mul_f32 v[80:81], v[80:81], v[14:15] op_sel:[0,1] op_sel_hi:[1,1]
    v_pk_mul_f32 v[82:83], v[82:83], v[14:15] op_sel:[0,1] op_sel_hi:[1,1]
    v_pk_mul_f32 v[76:77], v[76:77], v[14:15] op_sel:[0,0] op_sel_hi:[1,0]
    v_pk_mul_f32 v[78:79], v[78:79], v[14:15] op_sel:[0,0] op_sel_hi:[1,0]
    s_add_u32 s40, s40, 0xfff24000
    v_and_b32 v47, 0x0fffffff, v42
    v_mov_b32 v33, v42
    buffer_load_dwordx4 v[28:31], v47, s[8:11], 0 offen
    buffer_load_dwordx3 v[30:32], v47, s[8:11], 0 offen offset:8
    s_waitcnt lgkmcnt(0)
    v_cmpx_ne_u64 vcc, v[74:75], v[70:71]
    s_and_b64 s[82:83], vcc, s[80:81]
    s_cbranch_scc1 L2_c52
L2_d52:
    v_mov_b64 v[84:85], v[70:71]
    v_mov_b32 v7, v93
    v_mov_b64 v[86:87], v[74:75]
    s_mov_b64 exec, -1
    s_or_b64 s[80:81], s[80:81], vcc
    v_cmpx_ne_u64 vcc, v[72:73], v[68:69]
    s_and_b64 s[82:83], vcc, s[80:81]
    s_cbranch_scc1 L2_c53
L2_d53:
    v_mov_b64 v[84:85], v[68:69]
    v_mov_b32 v7, v92
    v_mov_b64 v[86:87], v[72:73]
    s_mov_b64 exec, -1
    s_or_b64 s[80:81], s[80:81], vcc
    ds_read_b64 v[70:71], v95 offset:65408
    ds_read_b64 v[68:69], v94 offset:65408
    s_waitcnt vmcnt(8)
    v_and_b32 v46, 0x20000000, v39
    v_lshrrev_b32 v47, 14, v35
    v_bitop3_b32 v47, v47, v5, v46 bitop3:0xea
    ds_read_b64 v[102:103], v47
    v_bitop3_b32 v93, v35, v5, v46 bitop3:0xea
    v_and_b32 v46, 0x10000000, v39
    v_lshrrev_b32 v47, 14, v34
    v_bitop3_b32 v47, v47, v5, v46 bitop3:0xea
    ds_read_b64 v[100:101], v47
    v_bitop3_b32 v92, v34, v5, v46 bitop3:0xea
    v_and_b32 v46, 0x80000000, v39
    v_lshrrev_b32 v47, 14, v37
    v_bitop3_b32 v47, v47, v5, v46 bitop3:0xea
    ds_read_b64 v[106:107], v47
    v_and_b32 v46, 0x40000000, v39
    v_lshrrev_b32 v47, 14, v36
    v_bitop3_b32 v47, v47, v5, v46 bitop3:0xea
    ds_read_b64 v[104:105], v47
    s_waitcnt lgkmcnt(4)
    v_mfma_f32_4x4x4_16b_bf16 v[80:83], v[10:11], v[70:71], v[80:83]
    v_mfma_f32_4x4x4_16b_bf16 v[76:79], v[10:11], v[68:69], v[76:79]
    v_perm_b32 v15, v35, v38, s45
    v_bitop3_b32 v46, v35, 0.5, -0.5 bitop3:0xa8
    v_perm_b32 v14, v34, v38, s44
    v_bitop3_b32 v47, v34, 0.5, -0.5 bitop3:0xa8
    v_cvt_pk_bf16_f32 v80, v80, v81
    v_cvt_pk_bf16_f32 v81, v82, v83
    ds_wrxchg_rtn_b64 v[74:75], v95, v[80:81] offset:65408
    v_cvt_pk_bf16_f32 v76, v76, v77
    v_cvt_pk_bf16_f32 v77, v78, v79
    ds_wrxchg_rtn_b64 v[72:73], v94, v[76:77] offset:65408
    s_waitcnt lgkmcnt(2)
    s_barrier
    s_setprio 3
    s_mov_b32 m0, s69
    s_nop 0
    ds_write_addtid_b32 v116 offset:32768
    ds_write_addtid_b32 v117 offset:33024
    ds_write_addtid_b32 v118 offset:33280
    ds_write_addtid_b32 v119 offset:33536
    buffer_load_dwordx4 v[116:119], v3, s[16:19], s40 offen offset:2048
    ds_write_addtid_b32 v120 offset:33792
    ds_write_addtid_b32 v121 offset:34048
    ds_write_addtid_b32 v122 offset:34304
    ds_write_addtid_b32 v123 offset:34560
    buffer_load_dwordx4 v[120:123], v3, s[16:19], s40 offen offset:3072
    v_mfma_f32_4x4x4_16b_bf16 v[80:83], v[8:9], v[102:103], 0
    v_mfma_f32_4x4x4_16b_bf16 v[76:79], v[8:9], v[100:101], 0
    v_bitop3_b32 v15, v6, v15, v46 bitop3:0xca
    v_bitop3_b32 v14, v6, v14, v47 bitop3:0xca
    v_cmp_lt_u32 s[84:85], v5, v92
    s_nop 0
    v_pk_mul_f32 v[80:81], v[80:81], v[14:15] op_sel:[0,1] op_sel_hi:[1,1]
    v_pk_mul_f32 v[82:83], v[82:83], v[14:15] op_sel:[0,1] op_sel_hi:[1,1]
    v_pk_mul_f32 v[76:77], v[76:77], v[14:15] op_sel:[0,0] op_sel_hi:[1,0]
    v_pk_mul_f32 v[78:79], v[78:79], v[14:15] op_sel:[0,0] op_sel_hi:[1,0]
    v_mov_b32 v44, v43
    s_cmp_gt_u32 s37, 1024
    s_cbranch_scc1 L2_xs54
    s_cmp_lg_u32 s43, 0
    s_cbranch_scc1 L2_xa54
L2_xb54:
    v_lshlrev_b32 v89, 16, v96
    v_add_u32 v90, 60, v97
    v_bitop3_b32 v90, v89, v45, v90 bitop3:0x6a
    ds_write_b32 v98, v90 offset:12
    v_lshlrev_b32 v89, 20, v96
    v_add_u32 v90, 40, v97
    v_bitop3_b32 v90, v89, v45, v90 bitop3:0x6a
    ds_write_b32 v98, v90 offset:8
    v_lshlrev_b32 v89, 24, v96
    v_add_u32 v90, 20, v97
    v_bitop3_b32 v90, v89, v45, v90 bitop3:0x6a
    ds_write_b32 v98, v90 offset:4
    v_lshlrev_b32 v89, 28, v96
    v_bitop3_b32 v90, v89, v45, v97 bitop3:0x6a
    ds_write_b32 v98, v90 offset:0
    v_mov_b32_dpp v91, v64 quad_perm:[0,0,0,0] row_mask:0xf bank_mask:0xf
    v_and_b32 v89, 3, v91
    v_and_b32 v97, 0xfffc, v91
    v_sub_u16_dpp v88, v64, v91 quad_perm:[2,2,2,2] row_mask:0xf bank_mask:0xf
    v_mad_u32_u24 v97, v97, 5, v4
    v_add_u32 v99, v88, v89
    v_bfm_b32 v96, v88, v89
    v_cmp_lt_u32 s[58:59], 16, v99
    v_lshlrev_b32 v89, v1, v96
    v_and_b32 v89, v45, v89
    v_cmp_ne_u32 vcc, 0, v89
    v_xor_b32 v90, v97, v89
    s_add_u32 s3, s37, s38
    v_mbcnt_lo_u32_b32 v98, vcc_lo, 0
    v_mbcnt_hi_u32_b32 v98, vcc_hi, v98
    s_bcnt1_i32_b64 s41, vcc
    v_lshl_add_u32 v98, v98, 2, s3
    s_mov_b64 exec, vcc
    ds_write_b32 v98, v90
    s_mov_b64 exec, -1
    s_lshl2_add_u32 s37, s41, s37
    s_cmp_lg_u64 s[58:59], 0
    s_cbranch_scc1 L2_xe54
L2_xr54:
    v_add_u32 v98, s37, v0
    v_mov_b32 v90, -1
    ds_write_b32 v98, v90
    ds_read2st64_b32 v[40:41], v0 offset0:0 offset1:1
    ds_read2st64_b32 v[42:43], v0 offset0:2 offset1:3
    s_sub_u32 s3, s37, 768
    s_cmp_gt_u32 s3, 256
    s_cbranch_scc1 L2_xf54
L2_xg54:
    s_setprio 2
    ds_write_addtid_b32 v124 offset:34816
    ds_write_addtid_b32 v125 offset:35072
    ds_write_addtid_b32 v126 offset:35328
    ds_write_addtid_b32 v127 offset:35584
    s_add_u32 s3, s40, 4096
    buffer_load_dwordx4 v[124:127], v3, s[16:19], s3 offen
    s_waitcnt lgkmcnt(14)
    v_cmpx_ne_u64 vcc, v[74:75], v[70:71]
    s_and_b64 s[82:83], vcc, s[80:81]
    s_cbranch_scc1 L2_c55
L2_d55:
    v_mov_b64 v[84:85], v[70:71]
    v_mov_b32 v7, v95
    v_mov_b64 v[86:87], v[74:75]
    s_mov_b64 exec, -1
    s_or_b64 s[80:81], s[80:81], vcc
    v_cmpx_ne_u64 vcc, v[72:73], v[68:69]
    s_and_b64 s[82:83], vcc, s[80:81]
    s_cbranch_scc1 L2_c56
L2_d56:
    v_mov_b64 v[84:85], v[68:69]
    v_mov_b32 v7, v94
    v_mov_b64 v[86:87], v[72:73]
    s_mov_b64 exec, -1
    s_or_b64 s[80:81], s[80:81], vcc
    ds_read_b64 v[70:71], v93 offset:65408
    s_and_b64 exec, s[84:85], s[80:81]
    v_mfma_f32_4x4x4_16b_bf16 v[76:79], v[12:13], v[84:85], 0
    v_mov_b32 v92, v7
    s_andn2_b64 s[80:81], s[80:81], s[84:85]
    v_mfma_f32_4x4x4_16b_bf16 v[76:79], v[10:11], v[86:87], v[76:79]
    s_mov_b64 exec, -1
    ds_read_b64 v[68:69], v92 offset:65408
    s_setprio 1
    s_waitcnt vmcnt(10)
    s_mov_b32 m0, s38
    s_nop 0
    ds_write_addtid_b32 v108 offset:0
    ds_write_addtid_b32 v109 offset:256
    ds_write_addtid_b32 v110 offset:512
    ds_write_addtid_b32 v111 offset:768
    s_waitcnt lgkmcnt(4)
    v_mfma_f32_4x4x4_16b_bf16 v[80:83], v[10:11], v[70:71], v[80:83]
    v_mfma_f32_4x4x4_16b_bf16 v[76:79], v[10:11], v[68:69], v[76:79]
    v_and_b32 v46, 0x40000000, v39
    v_bitop3_b32 v94, v36, v5, v46 bitop3:0xea
    v_and_b32 v46, 0x80000000, v39
    v_bitop3_b32 v95, v37, v5, v46 bitop3:0xea
    v_perm_b32 v15, v37, v38, s47
    v_bitop3_b32 v46, v37, 0.5, -0.5 bitop3:0xa8
    v_perm_b32 v14, v36, v38, s46
    v_bitop3_b32 v47, v36, 0.5, -0.5 bitop3:0xa8
    v_cvt_pk_bf16_f32 v80, v80, v81
    v_cvt_pk_bf16_f32 v81, v82, v83
    ds_wrxchg_rtn_b64 v[74:75], v93, v[80:81] offset:65408
    v_cvt_pk_bf16_f32 v76, v76, v77
    v_cvt_pk_bf16_f32 v77, v78, v79
    ds_wrxchg_rtn_b64 v[72:73], v92, v[76:77] offset:65408
    s_setprio 0
    s_waitcnt vmcnt(7)
    ds_write_addtid_b32 v112 offset:1024
    ds_write_addtid_b32 v113 offset:1280
    ds_write_addtid_b32 v114 offset:1536
    ds_write_addtid_b32 v115 offset:1792
    v_mfma_f32_4x4x4_16b_bf16 v[80:83], v[8:9], v[106:107], 0
    v_mfma_f32_4x4x4_16b_bf16 v[76:79], v[8:9], v[104:105], 0
    v_bitop3_b32 v15, v6, v15, v46 bitop3:0xca
    v_bitop3_b32 v14, v6, v14, v47 bitop3:0xca
    s_nop 1
    v_pk_mul_f32 v[80:81], v[80:81], v[14:15] op_sel:[0,1] op_sel_hi:[1,1]
    v_pk_mul_f32 v[82:83], v[82:83], v[14:15] op_sel:[0,1] op_sel_hi:[1,1]
    v_pk_mul_f32 v[76:77], v[76:77], v[14:15] op_sel:[0,0] op_sel_hi:[1,0]
    v_pk_mul_f32 v[78:79], v[78:79], v[14:15] op_sel:[0,0] op_sel_hi:[1,0]
    s_add_u32 s42, s42, 1
    s_waitcnt lgkmcnt(0)
    s_barrier
    s_bitcmp1_b32 s36, s42
    s_cbranch_scc1 L2_slow
L2_ret3:
    s_setprio 3
    v_and_b32 v47, 0x0fffffff, v44
    v_mov_b32 v39, v44
    buffer_load_dwordx4 v[34:37], v47, s[8:11], 0 offen
    buffer_load_dwordx3 v[36:38], v47, s[8:11], 0 offen offset:8
    v_cmpx_ne_u64 vcc, v[74:75], v[70:71]
    s_and_b64 s[82:83], vcc, s[80:81]
    s_cbranch_scc1 L2_c57
L2_d57:
    v_mov_b64 v[84:85], v[70:71]
    v_mov_b32 v7, v93
    v_mov_b64 v[86:87], v[74:75]
    s_mov_b64 exec, -1
    s_or_b64 s[80:81], s[80:81], vcc
    v_cmpx_ne_u64 vcc, v[72:73], v[68:69]
    s_and_b64 s[82:83], vcc, s[80:81]
    s_cbranch_scc1 L2_c58
L2_d58:
    v_mov_b64 v[84:85], v[68:69]
    v_mov_b32 v7, v92
    v_mov_b64 v[86:87], v[72:73]
    s_mov_b64 exec, -1
    s_or_b64 s[80:81], s[80:81], vcc
    ds_read_b64 v[70:71], v95 offset:65408
    ds_read_b64 v[68:69], v94 offset:65408
    v_and_b32 v46, 0x20000000, v21
    v_lshrrev_b32 v47, 14, v17
    v_bitop3_b32 v47, v47, v5, v46 bitop3:0xea
    ds_read_b64 v[102:103], v47
    v_bitop3_b32 v93, v17, v5, v46 bitop3:0xea
    v_and_b32 v46, 0x10000000, v21
    v_lshrrev_b32 v47, 14, v16
    v_bitop3_b32 v47, v47, v5, v46 bitop3:0xea
    ds_read_b64 v[100:101], v47
    v_bitop3_b32 v92, v16, v5, v46 bitop3:0xea
    s_waitcnt lgkmcnt(2)
    v_mfma_f32_4x4x4_16b_bf16 v[80:83], v[10:11], v[70:71], v[80:83]
    v_mfma_f32_4x4x4_16b_bf16 v[76:79], v[10:11], v[68:69], v[76:79]
    v_perm_b32 v15, v17, v20, s45
    v_bitop3_b32 v46, v17, 0.5, -0.5 bitop3:0xa8
    v_perm_b32 v14, v16, v20, s44
    v_bitop3_b32 v47, v16, 0.5, -0.5 bitop3:0xa8
    v_cvt_pk_bf16_f32 v80, v80, v81
    v_cvt_pk_bf16_f32 v81, v82, v83
    ds_wrxchg_rtn_b64 v[74:75], v95, v[80:81] offset:65408
    v_cvt_pk_bf16_f32 v76, v76, v77
    v_cvt_pk_bf16_f32 v77, v78, v79
    ds_wrxchg_rtn_b64 v[72:73], v94, v[76:77] offset:65408
    s_waitcnt lgkmcnt(2)
    v_mfma_f32_4x4x4_16b_bf16 v[80:83], v[8:9], v[102:103], 0
    v_mfma_f32_4x4x4_16b_bf16 v[76:79], v[8:9], v[100:101], 0
    v_bitop3_b32 v15, v6, v15, v46 bitop3:0xca
    v_bitop3_b32 v14, v6, v14, v47 bitop3:0xca
    v_cmp_lt_u32 s[84:85], v5, v92
    s_nop 0
    v_pk_mul_f32 v[80:81], v[80:81], v[14:15] op_sel:[0,1] op_sel_hi:[1,1]
    v_pk_mul_f32 v[82:83], v[82:83], v[14:15] op_sel:[0,1] op_sel_hi:[1,1]
    v_pk_mul_f32 v[76:77], v[76:77], v[14:15] op_sel:[0,0] op_sel_hi:[1,0]
    v_pk_mul_f32 v[78:79], v[78:79], v[14:15] op_sel:[0,0] op_sel_hi:[1,0]
    buffer_load_dwordx4 v[108:111], v3, s[16:19], s40 offen offset:0
    s_waitcnt lgkmcnt(0)
    v_cmpx_ne_u64 vcc, v[74:75], v[70:71]
    s_and_b64 s[82:83], vcc, s[80:81]
    s_cbranch_scc1 L2_c59
L2_d59:
    v_mov_b64 v[84:85], v[70:71]
    v_mov_b32 v7, v95
    v_mov_b64 v[86:87], v[74:75]
    s_mov_b64 exec, -1
    s_or_b64 s[80:81], s[80:81], vcc
    v_cmpx_ne_u64 vcc, v[72:73], v[68:69]
    s_and_b64 s[82:83], vcc, s[80:81]
    s_cbranch_scc1 L2_c60
L2_d60:
    v_mov_b64 v[84:85], v[68:69]
    v_mov_b32 v7, v94
    v_mov_b64 v[86:87], v[72:73]
    s_mov_b64 exec, -1
    s_or_b64 s[80:81], s[80:81], vcc
    ds_read_b64 v[70:71], v93 offset:65408
    s_and_b64 exec, s[84:85], s[80:81]
    v_mfma_f32_4x4x4_16b_bf16 v[76:79], v[12:13], v[84:85], 0
    v_mov_b32 v92, v7
    s_andn2_b64 s[80:81], s[80:81], s[84:85]
    v_mfma_f32_4x4x4_16b_bf16 v[76:79], v[10:11], v[86:87], v[76:79]
    s_mov_b64 exec, -1
    ds_read_b64 v[68:69], v92 offset:65408
    v_and_b32 v46, 0x80000000, v21
    v_lshrrev_b32 v47, 14, v19
    v_bitop3_b32 v47, v47, v5, v46 bitop3:0xea
    ds_read_b64 v[106:107], v47
    v_bitop3_b32 v95, v19, v5, v46 bitop3:0xea
    v_and_b32 v46, 0x40000000, v21
    v_lshrrev_b32 v47, 14, v18
    v_bitop3_b32 v47, v47, v5, v46 bitop3:0xea
    ds_read_b64 v[104:105], v47
    v_bitop3_b32 v94, v18, v5, v46 bitop3:0xea
    s_waitcnt lgkmcnt(2)
    v_mfma_f32_4x4x4_16b_bf16 v[80:83], v[10:11], v[70:71], v[80:83]
    v_mfma_f32_4x4x4_16b_bf16 v[76:79], v[10:11], v[68:69], v[76:79]
    v_perm_b32 v15, v19, v20, s47
    v_bitop3_b32 v46, v19, 0.5, -0.5 bitop3:0xa8
    v_perm_b32 v14, v18, v20, s46
    v_bitop3_b32 v47, v18, 0.5, -0.5 bitop3:0xa8
    v_cvt_pk_bf16_f32 v80, v80, v81
    v_cvt_pk_bf16_f32 v81, v82, v83
    ds_wrxchg_rtn_b64 v[74:75], v93, v[80:81] offset:65408
    v_cvt_pk_bf16_f32 v76, v76, v77
    v_cvt_pk_bf16_f32 v77, v78, v79
    ds_wrxchg_rtn_b64 v[72:73], v92, v[76:77] offset:65408
    s_setprio 2
    s_waitcnt lgkmcnt(2)
    v_mfma_f32_4x4x4_16b_bf16 v[80:83], v[8:9], v[106:107], 0
    v_mfma_f32_4x4x4_16b_bf16 v[76:79], v[8:9], v[104:105], 0
    v_bitop3_b32 v15, v6, v15, v46 bitop3:0xca
    v_bitop3_b32 v14, v6, v14, v47 bitop3:0xca
    s_nop 1
    v_pk_mul_f32 v[80:81], v[80:81], v[14:15] op_sel:[0,1] op_sel_hi:[1,1]
    v_pk_mul_f32 v[82:83], v[82:83], v[14:15] op_sel:[0,1] op_sel_hi:[1,1]
    v_pk_mul_f32 v[76:77], v[76:77], v[14:15] op_sel:[0,0] op_sel_hi:[1,0]
    v_pk_mul_f32 v[78:79], v[78:79], v[14:15] op_sel:[0,0] op_sel_hi:[1,0]
    v_and_b32 v47, 0x0fffffff, v40
    v_mov_b32 v21, v40
    buffer_load_dwordx4 v[16:19], v47, s[8:11], 0 offen
    buffer_load_dwordx3 v[18:20], v47, s[8:11], 0 offen offset:8
    s_waitcnt lgkmcnt(0)
    v_cmpx_ne_u64 vcc, v[74:75], v[70:71]
    s_and_b64 s[82:83], vcc, s[80:81]
    s_cbranch_scc1 L2_c61
L2_d61:
    v_mov_b64 v[84:85], v[70:71]
    v_mov_b32 v7, v93
    v_mov_b64 v[86:87], v[74:75]
    s_mov_b64 exec, -1
    s_or_b64 s[80:81], s[80:81], vcc
    v_cmpx_ne_u64 vcc, v[72:73], v[68:69]
    s_and_b64 s[82:83], vcc, s[80:81]
    s_cbranch_scc1 L2_c62
L2_d62:
    v_mov_b64 v[84:85], v[68:69]
    v_mov_b32 v7, v92
    v_mov_b64 v[86:87], v[72:73]
    s_mov_b64 exec, -1
    s_or_b64 s[80:81], s[80:81], vcc
    ds_read_b64 v[70:71], v95 offset:65408
    ds_read_b64 v[68:69], v94 offset:65408
    s_waitcnt vmcnt(10)
    v_and_b32 v46, 0x20000000, v27
    v_lshrrev_b32 v47, 14, v23
    v_bitop3_b32 v47, v47, v5, v46 bitop3:0xea
    ds_read_b64 v[102:103], v47
    v_bitop3_b32 v93, v23, v5, v46 bitop3:0xea
    v_and_b32 v46, 0x10000000, v27
    v_lshrrev_b32 v47, 14, v22
    v_bitop3_b32 v47, v47, v5, v46 bitop3:0xea
    ds_read_b64 v[100:101], v47
    v_bitop3_b32 v92, v22, v5, v46 bitop3:0xea
    s_waitcnt lgkmcnt(2)
    v_mfma_f32_4x4x4_16b_bf16 v[80:83], v[10:11], v[70:71], v[80:83]
    v_mfma_f32_4x4x4_16b_bf16 v[76:79], v[10:11], v[68:69], v[76:79]
    v_perm_b32 v15, v23, v26, s45
    v_bitop3_b32 v46, v23, 0.5, -0.5 bitop3:0xa8
    v_perm_b32 v14, v22, v26, s44
    v_bitop3_b32 v47, v22, 0.5, -0.5 bitop3:0xa8
    v_cvt_pk_bf16_f32 v80, v80, v81
    v_cvt_pk_bf16_f32 v81, v82, v83
    ds_wrxchg_rtn_b64 v[74:75], v95, v[80:81] offset:65408
    v_cvt_pk_bf16_f32 v76, v76, v77
    v_cvt_pk_bf16_f32 v77, v78, v79
    ds_wrxchg_rtn_b64 v[72:73], v94, v[76:77] offset:65408
    s_waitcnt lgkmcnt(2)
    v_mfma_f32_4x4x4_16b_bf16 v[80:83], v[8:9], v[102:103], 0
    v_mfma_f32_4x4x4_16b_bf16 v[76:79], v[8:9], v[100:101], 0
    v_bitop3_b32 v15, v6, v15, v46 bitop3:0xca
    v_bitop3_b32 v14, v6, v14, v47 bitop3:0xca
    v_cmp_lt_u32 s[84:85], v5, v92
    s_nop 0
    v_pk_mul_f32 v[80:81], v[80:81], v[14:15] op_sel:[0,1] op_sel_hi:[1,1]
    v_pk_mul_f32 v[82:83], v[82:83], v[14:15] op_sel:[0,1] op_sel_hi:[1,1]
    v_pk_mul_f32 v[76:77], v[76:77], v[14:15] op_sel:[0,0] op_sel_hi:[1,0]
    v_pk_mul_f32 v[78:79], v[78:79], v[14:15] op_sel:[0,0] op_sel_hi:[1,0]
    v_sub_u16 v88, v58, v50
    v_and_b32 v89, 3, v50
    v_add3_u32 v99, v88, v89, 3
    v_and_b32 v99, -4, v99
    v_max_u32 v99, 4, v99
    v_and_b32 v97, 0xfffc, v50
    v_bfm_b32 v96, v88, v89
    v_add_u32_dpp v91, v99, v99 row_shr:1 row_mask:0xf bank_mask:0xf bound_ctrl:1
    v_mad_u32_u24 v97, v97, 5, v2
    v_cmp_lt_u32 vcc, 16, v99
    v_add_u32_dpp v91, v91, v91 row_shr:2 row_mask:0xf bank_mask:0xf bound_ctrl:1
    v_sub_u32 v98, s38, v99
    v_lshrrev_b64 v[50:51], 16, v[50:51]
    v_add_u32_dpp v91, v91, v91 row_shr:4 row_mask:0xf bank_mask:0xf bound_ctrl:1
    v_lshrrev_b64 v[58:59], 16, v[58:59]
    s_mov_b32 s43, 0
    v_add_u32_dpp v91, v91, v91 row_shr:8 row_mask:0xf bank_mask:0xf bound_ctrl:1
    s_nop 1
    v_add_u32_dpp v91, v91, v91 row_bcast:15 row_mask:0xa bank_mask:0xf
    s_nop 1
    v_add_u32_dpp v91, v91, v91 row_bcast:31 row_mask:0xc bank_mask:0xf
    v_add_u32 v98, v98, v91
    v_readlane_b32 s37, v91, 63
    s_cbranch_vccnz L2_xo63
L2_xp63:
    buffer_load_dwordx4 v[112:115], v3, s[16:19], s40 offen offset:1024
    s_waitcnt lgkmcnt(0)
    v_cmpx_ne_u64 vcc, v[74:75], v[70:71]
    s_and_b64 s[82:83], vcc, s[80:81]
    s_cbranch_scc1 L2_c64
L2_d64:
    v_mov_b64 v[84:85], v[70:71]
    v_mov_b32 v7, v95
    v_mov_b64 v[86:87], v[74:75]
    s_mov_b64 exec, -1
    s_or_b64 s[80:81], s[80:81], vcc
    v_cmpx_ne_u64 vcc, v[72:73], v[68:69]
    s_and_b64 s[82:83], vcc, s[80:81]
    s_cbranch_scc1 L2_c65
L2_d65:
    v_mov_b64 v[84:85], v[68:69]
    v_mov_b32 v7, v94
    v_mov_b64 v[86:87], v[72:73]
    s_mov_b64 exec, -1
    s_or_b64 s[80:81], s[80:81], vcc
    ds_read_b64 v[70:71], v93 offset:65408
    s_and_b64 exec, s[84:85], s[80:81]
    v_mfma_f32_4x4x4_16b_bf16 v[76:79], v[12:13], v[84:85], 0
    v_mov_b32 v92, v7
    s_andn2_b64 s[80:81], s[80:81], s[84:85]
    v_mfma_f32_4x4x4_16b_bf16 v[76:79], v[10:11], v[86:87], v[76:79]
    s_mov_b64 exec, -1
    ds_read_b64 v[68:69], v92 offset:65408
    v_and_b32 v46, 0x80000000, v27
    v_lshrrev_b32 v47, 14, v25
    v_bitop3_b32 v47, v47, v5, v46 bitop3:0xea
    ds_read_b64 v[106:107], v47
    v_bitop3_b32 v95, v25, v5, v46 bitop3:0xea
    v_and_b32 v46, 0x40000000, v27
    v_lshrrev_b32 v47, 14, v24
    v_bitop3_b32 v47, v47, v5, v46 bitop3:0xea
    ds_read_b64 v[104:105], v47
    v_bitop3_b32 v94, v24, v5, v46 bitop3:0xea
    s_waitcnt lgkmcnt(2)
    v_mfma_f32_4x4x4_16b_bf16 v[80:83], v[10:11], v[70:71], v[80:83]
    v_mfma_f32_4x4x4_16b_bf16 v[76:79], v[10:11], v[68:69], v[76:79]
    v_perm_b32 v15, v25, v26, s47
    v_bitop3_b32 v46, v25, 0.5, -0.5 bitop3:0xa8
    v_perm_b32 v14, v24, v26, s46
    v_bitop3_b32 v47, v24, 0.5, -0.5 bitop3:0xa8
    v_cvt_pk_bf16_f32 v80, v80, v81
    v_cvt_pk_bf16_f32 v81, v82, v83
    ds_wrxchg_rtn_b64 v[74:75], v93, v[80:81] offset:65408
    v_cvt_pk_bf16_f32 v76, v76, v77
    v_cvt_pk_bf16_f32 v77, v78, v79
    ds_wrxchg_rtn_b64 v[72:73], v92, v[76:77] offset:65408
    s_setprio 1
    s_waitcnt lgkmcnt(2)
    v_mfma_f32_4x4x4_16b_bf16 v[80:83], v[8:9], v[106:107], 0
    v_mfma_f32_4x4x4_16b_bf16 v[76:79], v[8:9], v[104:105], 0
    v_bitop3_b32 v15, v6, v15, v46 bitop3:0xca
    v_bitop3_b32 v14, v6, v14, v47 bitop3:0xca
    s_nop 1
    v_pk_mul_f32 v[80:81], v[80:81], v[14:15] op_sel:[0,1] op_sel_hi:[1,1]
    v_pk_mul_f32 v[82:83], v[82:83], v[14:15] op_sel:[0,1] op_sel_hi:[1,1]
    v_pk_mul_f32 v[76:77], v[76:77], v[14:15] op_sel:[0,0] op_sel_hi:[1,0]
    v_pk_mul_f32 v[78:79], v[78:79], v[14:15] op_sel:[0,0] op_sel_hi:[1,0]
    v_and_b32 v47, 0x0fffffff, v41
    v_mov_b32 v27, v41
    buffer_load_dwordx4 v[22:25], v47, s[8:11], 0 offen
    buffer_load_dwordx3 v[24:26], v47, s[8:11], 0 offen offset:8
    s_waitcnt lgkmcnt(0)
    v_cmpx_ne_u64 vcc, v[74:75], v[70:71]
    s_and_b64 s[82:83], vcc, s[80:81]
    s_cbranch_scc1 L2_c66
L2_d66:
    v_mov_b64 v[84:85], v[70:71]
    v_mov_b32 v7, v93
    v_mov_b64 v[86:87], v[74:75]
    s_mov_b64 exec, -1
    s_or_b64 s[80:81], s[80:81], vcc
    v_cmpx_ne_u64 vcc, v[72:73], v[68:69]
    s_and_b64 s[82:83], vcc, s[80:81]
    s_cbranch_scc1 L2_c67
L2_d67:
    v_mov_b64 v[84:85], v[68:69]
    v_mov_b32 v7, v92
    v_mov_b64 v[86:87], v[72:73]
    s_mov_b64 exec, -1
    s_or_b64 s[80:81], s[80:81], vcc
    ds_read_b64 v[70:71], v95 offset:65408
    ds_read_b64 v[68:69], v94 offset:65408
    s_waitcnt vmcnt(11)
    v_and_b32 v46, 0x20000000, v33
    v_lshrrev_b32 v47, 14, v29
    v_bitop3_b32 v47, v47, v5, v46 bitop3:0xea
    ds_read_b64 v[102:103], v47
    v_bitop3_b32 v93, v29, v5, v46 bitop3:0xea
    v_and_b32 v46, 0x10000000, v33
    v_lshrrev_b32 v47, 14, v28
    v_bitop3_b32 v47, v47, v5, v46 bitop3:0xea
    ds_read_b64 v[100:101], v47
    v_bitop3_b32 v92, v28, v5, v46 bitop3:0xea
    s_waitcnt lgkmcnt(2)
    v_mfma_f32_4x4x4_16b_bf16 v[80:83], v[10:11], v[70:71], v[80:83]
    v_mfma_f32_4x4x4_16b_bf16 v[76:79], v[10:11], v[68:69], v[76:79]
    v_perm_b32 v15, v29, v32, s45
    v_bitop3_b32 v46, v29, 0.5, -0.5 bitop3:0xa8
    v_perm_b32 v14, v28, v32, s44
    v_bitop3_b32 v47, v28, 0.5, -0.5 bitop3:0xa8
    v_cvt_pk_bf16_f32 v80, v80, v81
    v_cvt_pk_bf16_f32 v81, v82, v83
    ds_wrxchg_rtn_b64 v[74:75], v95, v[80:81] offset:65408
    v_cvt_pk_bf16_f32 v76, v76, v77
    v_cvt_pk_bf16_f32 v77, v78, v79
    ds_wrxchg_rtn_b64 v[72:73], v94, v[76:77] offset:65408
    s_waitcnt lgkmcnt(2)
    v_mfma_f32_4x4x4_16b_bf16 v[80:83], v[8:9], v[102:103], 0
    v_mfma_f32_4x4x4_16b_bf16 v[76:79], v[8:9], v[100:101], 0
    v_bitop3_b32 v15, v6, v15, v46 bitop3:0xca
    v_bitop3_b32 v14, v6, v14, v47 bitop3:0xca
    v_cmp_lt_u32 s[84:85], v5, v92
    s_nop 0
    v_pk_mul_f32 v[80:81], v[80:81], v[14:15] op_sel:[0,1] op_sel_hi:[1,1]
    v_pk_mul_f32 v[82:83], v[82:83], v[14:15] op_sel:[0,1] op_sel_hi:[1,1]
    v_pk_mul_f32 v[76:77], v[76:77], v[14:15] op_sel:[0,0] op_sel_hi:[1,0]
    v_pk_mul_f32 v[78:79], v[78:79], v[14:15] op_sel:[0,0] op_sel_hi:[1,0]
    s_waitcnt lgkmcnt(0)
    v_cmpx_ne_u64 vcc, v[74:75], v[70:71]
    s_and_b64 s[82:83], vcc, s[80:81]
    s_cbranch_scc1 L2_c68
L2_d68:
    v_mov_b64 v[84:85], v[70:71]
    v_mov_b32 v7, v95
    v_mov_b64 v[86:87], v[74:75]
    s_mov_b64 exec, -1
    s_or_b64 s[80:81], s[80:81], vcc
    v_cmpx_ne_u64 vcc, v[72:73], v[68:69]
    s_and_b64 s[82:83], vcc, s[80:81]
    s_cbranch_scc1 L2_c69
L2_d69:
    v_mov_b64 v[84:85], v[68:69]
    v_mov_b32 v7, v94
    v_mov_b64 v[86:87], v[72:73]
    s_mov_b64 exec, -1
    s_or_b64 s[80:81], s[80:81], vcc
    ds_read_b64 v[70:71], v93 offset:65408
    s_and_b64 exec, s[84:85], s[80:81]
    v_mfma_f32_4x4x4_16b_bf16 v[76:79], v[12:13], v[84:85], 0
    v_mov_b32 v92, v7
    s_andn2_b64 s[80:81], s[80:81], s[84:85]
    v_mfma_f32_4x4x4_16b_bf16 v[76:79], v[10:11], v[86:87], v[76:79]
    s_mov_b64 exec, -1
    ds_read_b64 v[68:69], v92 offset:65408
    v_and_b32 v46, 0x80000000, v33
    v_lshrrev_b32 v47, 14, v31
    v_bitop3_b32 v47, v47, v5, v46 bitop3:0xea
    ds_read_b64 v[106:107], v47
    v_bitop3_b32 v95, v31, v5, v46 bitop3:0xea
    v_and_b32 v46, 0x40000000, v33
    v_lshrrev_b32 v47, 14, v30
    v_bitop3_b32 v47, v47, v5, v46 bitop3:0xea
    ds_read_b64 v[104:105], v47
    v_bitop3_b32 v94, v30, v5, v46 bitop3:0xea
    s_waitcnt lgkmcnt(2)
    v_mfma_f32_4x4x4_16b_bf16 v[80:83], v[10:11], v[70:71], v[80:83]
    v_mfma_f32_4x4x4_16b_bf16 v[76:79], v[10:11], v[68:69], v[76:79]
    v_perm_b32 v15, v31, v32, s47
    v_bitop3_b32 v46, v31, 0.5, -0.5 bitop3:0xa8
    v_perm_b32 v14, v30, v32, s46
    v_bitop3_b32 v47, v30, 0.5, -0.5 bitop3:0xa8
    v_cvt_pk_bf16_f32 v80, v80, v81
    v_cvt_pk_bf16_f32 v81, v82, v83
    ds_wrxchg_rtn_b64 v[74:75], v93, v[80:81] offset:65408
    v_cvt_pk_bf16_f32 v76, v76, v77
    v_cvt_pk_bf16_f32 v77, v78, v79
    ds_wrxchg_rtn_b64 v[72:73], v92, v[76:77] offset:65408
    s_setprio 0
    s_waitcnt lgkmcnt(2)
    v_mfma_f32_4x4x4_16b_bf16 v[80:83], v[8:9], v[106:107], 0
    v_mfma_f32_4x4x4_16b_bf16 v[76:79], v[8:9], v[104:105], 0
    v_bitop3_b32 v15, v6, v15, v46 bitop3:0xca
    v_bitop3_b32 v14, v6, v14, v47 bitop3:0xca
    s_nop 1
    v_pk_mul_f32 v[80:81], v[80:81], v[14:15] op_sel:[0,1] op_sel_hi:[1,1]
    v_pk_mul_f32 v[82:83], v[82:83], v[14:15] op_sel:[0,1] op_sel_hi:[1,1]
    v_pk_mul_f32 v[76:77], v[76:77], v[14:15] op_sel:[0,0] op_sel_hi:[1,0]
    v_pk_mul_f32 v[78:79], v[78:79], v[14:15] op_sel:[0,0] op_sel_hi:[1,0]
    s_add_u32 s40, s40, 0x50000
    v_and_b32 v47, 0x0fffffff, v42
    v_mov_b32 v33, v42
    buffer_load_dwordx4 v[28:31], v47, s[8:11], 0 offen
    buffer_load_dwordx3 v[30:32], v47, s[8:11], 0 offen offset:8
    s_waitcnt lgkmcnt(0)
    v_cmpx_ne_u64 vcc, v[74:75], v[70:71]
    s_and_b64 s[82:83], vcc, s[80:81]
    s_cbranch_scc1 L2_c70
L2_d70:
    v_mov_b64 v[84:85], v[70:71]
    v_mov_b32 v7, v93
    v_mov_b64 v[86:87], v[74:75]
    s_mov_b64 exec, -1
    s_or_b64 s[80:81], s[80:81], vcc
    v_cmpx_ne_u64 vcc, v[72:73], v[68:69]
    s_and_b64 s[82:83], vcc, s[80:81]
    s_cbranch_scc1 L2_c71
L2_d71:
    v_mov_b64 v[84:85], v[68:69]
    v_mov_b32 v7, v92
    v_mov_b64 v[86:87], v[72:73]
    s_mov_b64 exec, -1
    s_or_b64 s[80:81], s[80:81], vcc
    ds_read_b64 v[70:71], v95 offset:65408
    ds_read_b64 v[68:69], v94 offset:65408
    s_waitcnt vmcnt(8)
    v_and_b32 v46, 0x20000000, v39
    v_lshrrev_b32 v47, 14, v35
    v_bitop3_b32 v47, v47, v5, v46 bitop3:0xea
    ds_read_b64 v[102:103], v47
    v_bitop3_b32 v93, v35, v5, v46 bitop3:0xea
    v_and_b32 v46, 0x10000000, v39
    v_lshrrev_b32 v47, 14, v34
    v_bitop3_b32 v47, v47, v5, v46 bitop3:0xea
    ds_read_b64 v[100:101], v47
    v_bitop3_b32 v92, v34, v5, v46 bitop3:0xea
    v_and_b32 v46, 0x80000000, v39
    v_lshrrev_b32 v47, 14, v37
    v_bitop3_b32 v47, v47, v5, v46 bitop3:0xea
    ds_read_b64 v[106:107], v47
    v_and_b32 v46, 0x40000000, v39
    v_lshrrev_b32 v47, 14, v36
    v_bitop3_b32 v47, v47, v5, v46 bitop3:0xea
    ds_read_b64 v[104:105], v47
    s_waitcnt lgkmcnt(4)
    v_mfma_f32_4x4x4_16b_bf16 v[80:83], v[10:11], v[70:71], v[80:83]
    v_mfma_f32_4x4x4_16b_bf16 v[76:79], v[10:11], v[68:69], v[76:79]
    v_perm_b32 v15, v35, v38, s45
    v_bitop3_b32 v46, v35, 0.5, -0.5 bitop3:0xa8
    v_perm_b32 v14, v34, v38, s44
    v_bitop3_b32 v47, v34, 0.5, -0.5 bitop3:0xa8
    v_cvt_pk_bf16_f32 v80, v80, v81
    v_cvt_pk_bf16_f32 v81, v82, v83
    ds_wrxchg_rtn_b64 v[74:75], v95, v[80:81] offset:65408
    v_cvt_pk_bf16_f32 v76, v76, v77
    v_cvt_pk_bf16_f32 v77, v78, v79
    ds_wrxchg_rtn_b64 v[72:73], v94, v[76:77] offset:65408
    s_waitcnt lgkmcnt(2)
    s_barrier
    s_setprio 3
    s_mov_b32 m0, s69
    s_nop 0
    ds_write_addtid_b32 v116 offset:32768
    ds_write_addtid_b32 v117 offset:33024
    ds_write_addtid_b32 v118 offset:33280
    ds_write_addtid_b32 v119 offset:33536
    buffer_load_dwordx4 v[116:119], v3, s[16:19], s40 offen offset:2048
    ds_write_addtid_b32 v120 offset:33792
    ds_write_addtid_b32 v121 offset:34048
    ds_write_addtid_b32 v122 offset:34304
    ds_write_addtid_b32 v123 offset:34560
    buffer_load_dwordx4 v[120:123], v3, s[16:19], s40 offen offset:3072
    v_mfma_f32_4x4x4_16b_bf16 v[80:83], v[8:9], v[102:103], 0
    v_mfma_f32_4x4x4_16b_bf16 v[76:79], v[8:9], v[100:101], 0
    v_bitop3_b32 v15, v6, v15, v46 bitop3:0xca
    v_bitop3_b32 v14, v6, v14, v47 bitop3:0xca
    v_cmp_lt_u32 s[84:85], v5, v92
    s_nop 0
    v_pk_mul_f32 v[80:81], v[80:81], v[14:15] op_sel:[0,1] op_sel_hi:[1,1]
    v_pk_mul_f32 v[82:83], v[82:83], v[14:15] op_sel:[0,1] op_sel_hi:[1,1]
    v_pk_mul_f32 v[76:77], v[76:77], v[14:15] op_sel:[0,0] op_sel_hi:[1,0]
    v_pk_mul_f32 v[78:79], v[78:79], v[14:15] op_sel:[0,0] op_sel_hi:[1,0]
    v_mov_b32 v44, v43
    s_cmp_gt_u32 s37, 1024
    s_cbranch_scc1 L2_xs72
    s_cmp_lg_u32 s43, 0
    s_cbranch_scc1 L2_xa72
L2_xb72:
    v_lshlrev_b32 v89, 16, v96
    v_add_u32 v90, 60, v97
    v_bitop3_b32 v90, v89, v45, v90 bitop3:0x6a
    ds_write_b32 v98, v90 offset:12
    v_lshlrev_b32 v89, 20, v96
    v_add_u32 v90, 40, v97
    v_bitop3_b32 v90, v89, v45, v90 bitop3:0x6a
    ds_write_b32 v98, v90 offset:8
    v_lshlrev_b32 v89, 24, v96
    v_add_u32 v90, 20, v97
    v_bitop3_b32 v90, v89, v45, v90 bitop3:0x6a
    ds_write_b32 v98, v90 offset:4
    v_lshlrev_b32 v89, 28, v96
    v_bitop3_b32 v90, v89, v45, v97 bitop3:0x6a
    ds_write_b32 v98, v90 offset:0
    v_mov_b32_dpp v91, v66 quad_perm:[0,0,0,0] row_mask:0xf bank_mask:0xf
    v_and_b32 v89, 3, v91
    v_and_b32 v97, 0xfffc, v91
    v_sub_u16_dpp v88, v66, v91 quad_perm:[2,2,2,2] row_mask:0xf bank_mask:0xf
    v_mad_u32_u24 v97, v97, 5, v4
    v_add_u32 v99, v88, v89
    v_bfm_b32 v96, v88, v89
    v_cmp_lt_u32 s[58:59], 16, v99
    v_lshlrev_b32 v89, v1, v96
    v_and_b32 v89, v45, v89
    v_cmp_ne_u32 vcc, 0, v89
    v_xor_b32 v90, v97, v89
    s_add_u32 s3, s37, s38
    v_mbcnt_lo_u32_b32 v98, vcc_lo, 0
    v_mbcnt_hi_u32_b32 v98, vcc_hi, v98
    s_bcnt1_i32_b64 s41, vcc
    v_lshl_add_u32 v98, v98, 2, s3
    s_mov_b64 exec, vcc
    ds_write_b32 v98, v90
    s_mov_b64 exec, -1
    s_lshl2_add_u32 s37, s41, s37
    s_cmp_lg_u64 s[58:59], 0
    s_cbranch_scc1 L2_xe72
L2_xr72:
    v_add_u32 v98, s37, v0
    v_mov_b32 v90, -1
    ds_write_b32 v98, v90
    ds_read2st64_b32 v[40:41], v0 offset0:0 offset1:1
    ds_read2st64_b32 v[42:43], v0 offset0:2 offset1:3
    s_sub_u32 s3, s37, 768
    s_cmp_gt_u32 s3, 256
    s_cbranch_scc1 L2_xf72
L2_xg72:
    s_setprio 2
    ds_write_addtid_b32 v124 offset:34816
    ds_write_addtid_b32 v125 offset:35072
    ds_write_addtid_b32 v126 offset:35328
    ds_write_addtid_b32 v127 offset:35584
    s_add_u32 s3, s40, 4096
    buffer_load_dwordx4 v[124:127], v3, s[16:19], s3 offen
    s_waitcnt lgkmcnt(14)
    v_cmpx_ne_u64 vcc, v[74:75], v[70:71]
    s_and_b64 s[82:83], vcc, s[80:81]
    s_cbranch_scc1 L2_c73
L2_d73:
    v_mov_b64 v[84:85], v[70:71]
    v_mov_b32 v7, v95
    v_mov_b64 v[86:87], v[74:75]
    s_mov_b64 exec, -1
    s_or_b64 s[80:81], s[80:81], vcc
    v_cmpx_ne_u64 vcc, v[72:73], v[68:69]
    s_and_b64 s[82:83], vcc, s[80:81]
    s_cbranch_scc1 L2_c74
L2_d74:
    v_mov_b64 v[84:85], v[68:69]
    v_mov_b32 v7, v94
    v_mov_b64 v[86:87], v[72:73]
    s_mov_b64 exec, -1
    s_or_b64 s[80:81], s[80:81], vcc
    ds_read_b64 v[70:71], v93 offset:65408
    s_and_b64 exec, s[84:85], s[80:81]
    v_mfma_f32_4x4x4_16b_bf16 v[76:79], v[12:13], v[84:85], 0
    v_mov_b32 v92, v7
    s_andn2_b64 s[80:81], s[80:81], s[84:85]
    v_mfma_f32_4x4x4_16b_bf16 v[76:79], v[10:11], v[86:87], v[76:79]
    s_mov_b64 exec, -1
    ds_read_b64 v[68:69], v92 offset:65408
    s_setprio 1
    s_waitcnt vmcnt(10)
    s_mov_b32 m0, s38
    s_nop 0
    ds_write_addtid_b32 v108 offset:0
    ds_write_addtid_b32 v109 offset:256
    ds_write_addtid_b32 v110 offset:512
    ds_write_addtid_b32 v111 offset:768
    s_waitcnt lgkmcnt(4)
    v_mfma_f32_4x4x4_16b_bf16 v[80:83], v[10:11], v[70:71], v[80:83]
    v_mfma_f32_4x4x4_16b_bf16 v[76:79], v[10:11], v[68:69], v[76:79]
    v_and_b32 v46, 0x40000000, v39
    v_bitop3_b32 v94, v36, v5, v46 bitop3:0xea
    v_and_b32 v46, 0x80000000, v39
    v_bitop3_b32 v95, v37, v5, v46 bitop3:0xea
    v_perm_b32 v15, v37, v38, s47
    v_bitop3_b32 v46, v37, 0.5, -0.5 bitop3:0xa8
    v_perm_b32 v14, v36, v38, s46
    v_bitop3_b32 v47, v36, 0.5, -0.5 bitop3:0xa8
    v_cvt_pk_bf16_f32 v80, v80, v81
    v_cvt_pk_bf16_f32 v81, v82, v83
    ds_wrxchg_rtn_b64 v[74:75], v93, v[80:81] offset:65408
    v_cvt_pk_bf16_f32 v76, v76, v77
    v_cvt_pk_bf16_f32 v77, v78, v79
    ds_wrxchg_rtn_b64 v[72:73], v92, v[76:77] offset:65408
    s_setprio 0
    s_waitcnt vmcnt(7)
    ds_write_addtid_b32 v112 offset:1024
    ds_write_addtid_b32 v113 offset:1280
    ds_write_addtid_b32 v114 offset:1536
    ds_write_addtid_b32 v115 offset:1792
    v_mfma_f32_4x4x4_16b_bf16 v[80:83], v[8:9], v[106:107], 0
    v_mfma_f32_4x4x4_16b_bf16 v[76:79], v[8:9], v[104:105], 0
    v_bitop3_b32 v15, v6, v15, v46 bitop3:0xca
    v_bitop3_b32 v14, v6, v14, v47 bitop3:0xca
    s_nop 1
    v_pk_mul_f32 v[80:81], v[80:81], v[14:15] op_sel:[0,1] op_sel_hi:[1,1]
    v_pk_mul_f32 v[82:83], v[82:83], v[14:15] op_sel:[0,1] op_sel_hi:[1,1]
    v_pk_mul_f32 v[76:77], v[76:77], v[14:15] op_sel:[0,0] op_sel_hi:[1,0]
    v_pk_mul_f32 v[78:79], v[78:79], v[14:15] op_sel:[0,0] op_sel_hi:[1,0]
    s_add_u32 s42, s42, 1
    s_waitcnt lgkmcnt(0)
    s_barrier
    s_bitcmp1_b32 s36, s42
    s_cbranch_scc1 L2_slow
L2_ret4:
    s_setprio 3
    v_and_b32 v47, 0x0fffffff, v44
    v_mov_b32 v39, v44
    buffer_load_dwordx4 v[34:37], v47, s[8:11], 0 offen
    buffer_load_dwordx3 v[36:38], v47, s[8:11], 0 offen offset:8
    v_cmpx_ne_u64 vcc, v[74:75], v[70:71]
    s_and_b64 s[82:83], vcc, s[80:81]
    s_cbranch_scc1 L2_c75
L2_d75:
    v_mov_b64 v[84:85], v[70:71]
    v_mov_b32 v7, v93
    v_mov_b64 v[86:87], v[74:75]
    s_mov_b64 exec, -1
    s_or_b64 s[80:81], s[80:81], vcc
    v_cmpx_ne_u64 vcc, v[72:73], v[68:69]
    s_and_b64 s[82:83], vcc, s[80:81]
    s_cbranch_scc1 L2_c76
L2_d76:
    v_mov_b64 v[84:85], v[68:69]
    v_mov_b32 v7, v92
    v_mov_b64 v[86:87], v[72:73]
    s_mov_b64 exec, -1
    s_or_b64 s[80:81], s[80:81], vcc
    ds_read_b64 v[70:71], v95 offset:65408
    ds_read_b64 v[68:69], v94 offset:65408
    v_and_b32 v46, 0x20000000, v21
    v_lshrrev_b32 v47, 14, v17
    v_bitop3_b32 v47, v47, v5, v46 bitop3:0xea
    ds_read_b64 v[102:103], v47
    v_bitop3_b32 v93, v17, v5, v46 bitop3:0xea
    v_and_b32 v46, 0x10000000, v21
    v_lshrrev_b32 v47, 14, v16
    v_bitop3_b32 v47, v47, v5, v46 bitop3:0xea
    ds_read_b64 v[100:101], v47
    v_bitop3_b32 v92, v16, v5, v46 bitop3:0xea
    s_waitcnt lgkmcnt(2)
    v_mfma_f32_4x4x4_16b_bf16 v[80:83], v[10:11], v[70:71], v[80:83]
    v_mfma_f32_4x4x4_16b_bf16 v[76:79], v[10:11], v[68:69], v[76:79]
    v_perm_b32 v15, v17, v20, s45
    v_bitop3_b32 v46, v17, 0.5, -0.5 bitop3:0xa8
    v_perm_b32 v14, v16, v20, s44
    v_bitop3_b32 v47, v16, 0.5, -0.5 bitop3:0xa8
    v_cvt_pk_bf16_f32 v80, v80, v81
    v_cvt_pk_bf16_f32 v81, v82, v83
    ds_wrxchg_rtn_b64 v[74:75], v95, v[80:81] offset:65408
    v_cvt_pk_bf16_f32 v76, v76, v77
    v_cvt_pk_bf16_f32 v77, v78, v79
    ds_wrxchg_rtn_b64 v[72:73], v94, v[76:77] offset:65408
    s_waitcnt lgkmcnt(2)
    v_mfma_f32_4x4x4_16b_bf16 v[80:83], v[8:9], v[102:103], 0
    v_mfma_f32_4x4x4_16b_bf16 v[76:79], v[8:9], v[100:101], 0
    v_bitop3_b32 v15, v6, v15, v46 bitop3:0xca
    v_bitop3_b32 v14, v6, v14, v47 bitop3:0xca
    v_cmp_lt_u32 s[84:85], v5, v92
    s_nop 0
    v_pk_mul_f32 v[80:81], v[80:81], v[14:15] op_sel:[0,1] op_sel_hi:[1,1]
    v_pk_mul_f32 v[82:83], v[82:83], v[14:15] op_sel:[0,1] op_sel_hi:[1,1]
    v_pk_mul_f32 v[76:77], v[76:77], v[14:15] op_sel:[0,0] op_sel_hi:[1,0]
    v_pk_mul_f32 v[78:79], v[78:79], v[14:15] op_sel:[0,0] op_sel_hi:[1,0]
    buffer_load_dwordx4 v[108:111], v3, s[16:19], s40 offen offset:0
    s_waitcnt lgkmcnt(0)
    v_cmpx_ne_u64 vcc, v[74:75], v[70:71]
    s_and_b64 s[82:83], vcc, s[80:81]
    s_cbranch_scc1 L2_c77
L2_d77:
    v_mov_b64 v[84:85], v[70:71]
    v_mov_b32 v7, v95
    v_mov_b64 v[86:87], v[74:75]
    s_mov_b64 exec, -1
    s_or_b64 s[80:81], s[80:81], vcc
    v_cmpx_ne_u64 vcc, v[72:73], v[68:69]
    s_and_b64 s[82:83], vcc, s[80:81]
    s_cbranch_scc1 L2_c78
L2_d78:
    v_mov_b64 v[84:85], v[68:69]
    v_mov_b32 v7, v94
    v_mov_b64 v[86:87], v[72:73]
    s_mov_b64 exec, -1
    s_or_b64 s[80:81], s[80:81], vcc
    ds_read_b64 v[70:71], v93 offset:65408
    s_and_b64 exec, s[84:85], s[80:81]
    v_mfma_f32_4x4x4_16b_bf16 v[76:79], v[12:13], v[84:85], 0
    v_mov_b32 v92, v7
    s_andn2_b64 s[80:81], s[80:81], s[84:85]
    v_mfma_f32_4x4x4_16b_bf16 v[76:79], v[10:11], v[86:87], v[76:79]
    s_mov_b64 exec, -1
    ds_read_b64 v[68:69], v92 offset:65408
    v_and_b32 v46, 0x80000000, v21
    v_lshrrev_b32 v47, 14, v19
    v_bitop3_b32 v47, v47, v5, v46 bitop3:0xea
    ds_read_b64 v[106:107], v47
    v_bitop3_b32 v95, v19, v5, v46 bitop3:0xea
    v_and_b32 v46, 0x40000000, v21
    v_lshrrev_b32 v47, 14, v18
    v_bitop3_b32 v47, v47, v5, v46 bitop3:0xea
    ds_read_b64 v[104:105], v47
    v_bitop3_b32 v94, v18, v5, v46 bitop3:0xea
    s_waitcnt lgkmcnt(2)
    v_mfma_f32_4x4x4_16b_bf16 v[80:83], v[10:11], v[70:71], v[80:83]
    v_mfma_f32_4x4x4_16b_bf16 v[76:79], v[10:11], v[68:69], v[76:79]
    v_perm_b32 v15, v19, v20, s47
    v_bitop3_b32 v46, v19, 0.5, -0.5 bitop3:0xa8
    v_perm_b32 v14, v18, v20, s46
    v_bitop3_b32 v47, v18, 0.5, -0.5 bitop3:0xa8
    v_cvt_pk_bf16_f32 v80, v80, v81
    v_cvt_pk_bf16_f32 v81, v82, v83
    ds_wrxchg_rtn_b64 v[74:75], v93, v[80:81] offset:65408
    v_cvt_pk_bf16_f32 v76, v76, v77
    v_cvt_pk_bf16_f32 v77, v78, v79
    ds_wrxchg_rtn_b64 v[72:73], v92, v[76:77] offset:65408
    s_setprio 2
    s_waitcnt lgkmcnt(2)
    v_mfma_f32_4x4x4_16b_bf16 v[80:83], v[8:9], v[106:107], 0
    v_mfma_f32_4x4x4_16b_bf16 v[76:79], v[8:9], v[104:105], 0
    v_bitop3_b32 v15, v6, v15, v46 bitop3:0xca
    v_bitop3_b32 v14, v6, v14, v47 bitop3:0xca
    s_nop 1
    v_pk_mul_f32 v[80:81], v[80:81], v[14:15] op_sel:[0,1] op_sel_hi:[1,1]
    v_pk_mul_f32 v[82:83], v[82:83], v[14:15] op_sel:[0,1] op_sel_hi:[1,1]
    v_pk_mul_f32 v[76:77], v[76:77], v[14:15] op_sel:[0,0] op_sel_hi:[1,0]
    v_pk_mul_f32 v[78:79], v[78:79], v[14:15] op_sel:[0,0] op_sel_hi:[1,0]
    v_and_b32 v47, 0x0fffffff, v40
    v_mov_b32 v21, v40
    buffer_load_dwordx4 v[16:19], v47, s[8:11], 0 offen
    buffer_load_dwordx3 v[18:20], v47, s[8:11], 0 offen offset:8
    s_waitcnt lgkmcnt(0)
    v_cmpx_ne_u64 vcc, v[74:75], v[70:71]
    s_and_b64 s[82:83], vcc, s[80:81]
    s_cbranch_scc1 L2_c79
L2_d79:
    v_mov_b64 v[84:85], v[70:71]
    v_mov_b32 v7, v93
    v_mov_b64 v[86:87], v[74:75]
    s_mov_b64 exec, -1
    s_or_b64 s[80:81], s[80:81], vcc
    v_cmpx_ne_u64 vcc, v[72:73], v[68:69]
    s_and_b64 s[82:83], vcc, s[80:81]
    s_cbranch_scc1 L2_c80
L2_d80:
    v_mov_b64 v[84:85], v[68:69]
    v_mov_b32 v7, v92
    v_mov_b64 v[86:87], v[72:73]
    s_mov_b64 exec, -1
    s_or_b64 s[80:81], s[80:81], vcc
    ds_read_b64 v[70:71], v95 offset:65408
    ds_read_b64 v[68:69], v94 offset:65408
    s_waitcnt vmcnt(10)
    v_and_b32 v46, 0x20000000, v27
    v_lshrrev_b32 v47, 14, v23
    v_bitop3_b32 v47, v47, v5, v46 bitop3:0xea
    ds_read_b64 v[102:103], v47
    v_bitop3_b32 v93, v23, v5, v46 bitop3:0xea
    v_and_b32 v46, 0x10000000, v27
    v_lshrrev_b32 v47, 14, v22
    v_bitop3_b32 v47, v47, v5, v46 bitop3:0xea
    ds_read_b64 v[100:101], v47
    v_bitop3_b32 v92, v22, v5, v46 bitop3:0xea
    s_waitcnt lgkmcnt(2)
    v_mfma_f32_4x4x4_16b_bf16 v[80:83], v[10:11], v[70:71], v[80:83]
    v_mfma_f32_4x4x4_16b_bf16 v[76:79], v[10:11], v[68:69], v[76:79]
    v_perm_b32 v15, v23, v26, s45
    v_bitop3_b32 v46, v23, 0.5, -0.5 bitop3:0xa8
    v_perm_b32 v14, v22, v26, s44
    v_bitop3_b32 v47, v22, 0.5, -0.5 bitop3:0xa8
    v_cvt_pk_bf16_f32 v80, v80, v81
    v_cvt_pk_bf16_f32 v81, v82, v83
    ds_wrxchg_rtn_b64 v[74:75], v95, v[80:81] offset:65408
    v_cvt_pk_bf16_f32 v76, v76, v77
    v_cvt_pk_bf16_f32 v77, v78, v79
    ds_wrxchg_rtn_b64 v[72:73], v94, v[76:77] offset:65408
    s_waitcnt lgkmcnt(2)
    v_mfma_f32_4x4x4_16b_bf16 v[80:83], v[8:9], v[102:103], 0
    v_mfma_f32_4x4x4_16b_bf16 v[76:79], v[8:9], v[100:101], 0
    v_bitop3_b32 v15, v6, v15, v46 bitop3:0xca
    v_bitop3_b32 v14, v6, v14, v47 bitop3:0xca
    v_cmp_lt_u32 s[84:85], v5, v92
    s_nop 0
    v_pk_mul_f32 v[80:81], v[80:81], v[14:15] op_sel:[0,1] op_sel_hi:[1,1]
    v_pk_mul_f32 v[82:83], v[82:83], v[14:15] op_sel:[0,1] op_sel_hi:[1,1]
    v_pk_mul_f32 v[76:77], v[76:77], v[14:15] op_sel:[0,0] op_sel_hi:[1,0]
    v_pk_mul_f32 v[78:79], v[78:79], v[14:15] op_sel:[0,0] op_sel_hi:[1,0]
    v_sub_u16 v88, v60, v52
    v_and_b32 v89, 3, v52
    v_add3_u32 v99, v88, v89, 3
    v_and_b32 v99, -4, v99
    v_max_u32 v99, 4, v99
    v_and_b32 v97, 0xfffc, v52
    v_bfm_b32 v96, v88, v89
    v_add_u32_dpp v91, v99, v99 row_shr:1 row_mask:0xf bank_mask:0xf bound_ctrl:1
    v_mad_u32_u24 v97, v97, 5, v2
    v_cmp_lt_u32 vcc, 16, v99
    v_add_u32_dpp v91, v91, v91 row_shr:2 row_mask:0xf bank_mask:0xf bound_ctrl:1
    v_sub_u32 v98, s38, v99
    v_lshrrev_b64 v[52:53], 16, v[52:53]
    v_add_u32_dpp v91, v91, v91 row_shr:4 row_mask:0xf bank_mask:0xf bound_ctrl:1
    v_lshrrev_b64 v[60:61], 16, v[60:61]
    s_mov_b32 s43, 0
    v_add_u32_dpp v91, v91, v91 row_shr:8 row_mask:0xf bank_mask:0xf bound_ctrl:1
    s_nop 1
    v_add_u32_dpp v91, v91, v91 row_bcast:15 row_mask:0xa bank_mask:0xf
    s_nop 1
    v_add_u32_dpp v91, v91, v91 row_bcast:31 row_mask:0xc bank_mask:0xf
    v_add_u32 v98, v98, v91
    v_readlane_b32 s37, v91, 63
    s_cbranch_vccnz L2_xo81
L2_xp81:
    buffer_load_dwordx4 v[112:115], v3, s[16:19], s40 offen offset:1024
    s_waitcnt lgkmcnt(0)
    v_cmpx_ne_u64 vcc, v[74:75], v[70:71]
    s_and_b64 s[82:83], vcc, s[80:81]
    s_cbranch_scc1 L2_c82
L2_d82:
    v_mov_b64 v[84:85], v[70:71]
    v_mov_b32 v7, v95
    v_mov_b64 v[86:87], v[74:75]
    s_mov_b64 exec, -1
    s_or_b64 s[80:81], s[80:81], vcc
    v_cmpx_ne_u64 vcc, v[72:73], v[68:69]
    s_and_b64 s[82:83], vcc, s[80:81]
    s_cbranch_scc1 L2_c83
L2_d83:
    v_mov_b64 v[84:85], v[68:69]
    v_mov_b32 v7, v94
    v_mov_b64 v[86:87], v[72:73]
    s_mov_b64 exec, -1
    s_or_b64 s[80:81], s[80:81], vcc
    ds_read_b64 v[70:71], v93 offset:65408
    s_and_b64 exec, s[84:85], s[80:81]
    v_mfma_f32_4x4x4_16b_bf16 v[76:79], v[12:13], v[84:85], 0
    v_mov_b32 v92, v7
    s_andn2_b64 s[80:81], s[80:81], s[84:85]
    v_mfma_f32_4x4x4_16b_bf16 v[76:79], v[10:11], v[86:87], v[76:79]
    s_mov_b64 exec, -1
    ds_read_b64 v[68:69], v92 offset:65408
    v_and_b32 v46, 0x80000000, v27
    v_lshrrev_b32 v47, 14, v25
    v_bitop3_b32 v47, v47, v5, v46 bitop3:0xea
    ds_read_b64 v[106:107], v47
    v_bitop3_b32 v95, v25, v5, v46 bitop3:0xea
    v_and_b32 v46, 0x40000000, v27
    v_lshrrev_b32 v47, 14, v24
    v_bitop3_b32 v47, v47, v5, v46 bitop3:0xea
    ds_read_b64 v[104:105], v47
    v_bitop3_b32 v94, v24, v5, v46 bitop3:0xea
    s_waitcnt lgkmcnt(2)
    v_mfma_f32_4x4x4_16b_bf16 v[80:83], v[10:11], v[70:71], v[80:83]
    v_mfma_f32_4x4x4_16b_bf16 v[76:79], v[10:11], v[68:69], v[76:79]
    v_perm_b32 v15, v25, v26, s47
    v_bitop3_b32 v46, v25, 0.5, -0.5 bitop3:0xa8
    v_perm_b32 v14, v24, v26, s46
    v_bitop3_b32 v47, v24, 0.5, -0.5 bitop3:0xa8
    v_cvt_pk_bf16_f32 v80, v80, v81
    v_cvt_pk_bf16_f32 v81, v82, v83
    ds_wrxchg_rtn_b64 v[74:75], v93, v[80:81] offset:65408
    v_cvt_pk_bf16_f32 v76, v76, v77
    v_cvt_pk_bf16_f32 v77, v78, v79
    ds_wrxchg_rtn_b64 v[72:73], v92, v[76:77] offset:65408
    s_setprio 1
    s_waitcnt lgkmcnt(2)
    v_mfma_f32_4x4x4_16b_bf16 v[80:83], v[8:9], v[106:107], 0
    v_mfma_f32_4x4x4_16b_bf16 v[76:79], v[8:9], v[104:105], 0
    v_bitop3_b32 v15, v6, v15, v46 bitop3:0xca
    v_bitop3_b32 v14, v6, v14, v47 bitop3:0xca
    s_nop 1
    v_pk_mul_f32 v[80:81], v[80:81], v[14:15] op_sel:[0,1] op_sel_hi:[1,1]
    v_pk_mul_f32 v[82:83], v[82:83], v[14:15] op_sel:[0,1] op_sel_hi:[1,1]
    v_pk_mul_f32 v[76:77], v[76:77], v[14:15] op_sel:[0,0] op_sel_hi:[1,0]
    v_pk_mul_f32 v[78:79], v[78:79], v[14:15] op_sel:[0,0] op_sel_hi:[1,0]
    v_and_b32 v47, 0x0fffffff, v41
    v_mov_b32 v27, v41
    buffer_load_dwordx4 v[22:25], v47, s[8:11], 0 offen
    buffer_load_dwordx3 v[24:26], v47, s[8:11], 0 offen offset:8
    s_waitcnt lgkmcnt(0)
    v_cmpx_ne_u64 vcc, v[74:75], v[70:71]
    s_and_b64 s[82:83], vcc, s[80:81]
    s_cbranch_scc1 L2_c84
L2_d84:
    v_mov_b64 v[84:85], v[70:71]
    v_mov_b32 v7, v93
    v_mov_b64 v[86:87], v[74:75]
    s_mov_b64 exec, -1
    s_or_b64 s[80:81], s[80:81], vcc
    v_cmpx_ne_u64 vcc, v[72:73], v[68:69]
    s_and_b64 s[82:83], vcc, s[80:81]
    s_cbranch_scc1 L2_c85
L2_d85:
    v_mov_b64 v[84:85], v[68:69]
    v_mov_b32 v7, v92
    v_mov_b64 v[86:87], v[72:73]
    s_mov_b64 exec, -1
    s_or_b64 s[80:81], s[80:81], vcc
    ds_read_b64 v[70:71], v95 offset:65408
    ds_read_b64 v[68:69], v94 offset:65408
    s_waitcnt vmcnt(11)
    v_and_b32 v46, 0x20000000, v33
    v_lshrrev_b32 v47, 14, v29
    v_bitop3_b32 v47, v47, v5, v46 bitop3:0xea
    ds_read_b64 v[102:103], v47
    v_bitop3_b32 v93, v29, v5, v46 bitop3:0xea
    v_and_b32 v46, 0x10000000, v33
    v_lshrrev_b32 v47, 14, v28
    v_bitop3_b32 v47, v47, v5, v46 bitop3:0xea
    ds_read_b64 v[100:101], v47
    v_bitop3_b32 v92, v28, v5, v46 bitop3:0xea
    s_waitcnt lgkmcnt(2)
    v_mfma_f32_4x4x4_16b_bf16 v[80:83], v[10:11], v[70:71], v[80:83]
    v_mfma_f32_4x4x4_16b_bf16 v[76:79], v[10:11], v[68:69], v[76:79]
    v_perm_b32 v15, v29, v32, s45
    v_bitop3_b32 v46, v29, 0.5, -0.5 bitop3:0xa8
    v_perm_b32 v14, v28, v32, s44
    v_bitop3_b32 v47, v28, 0.5, -0.5 bitop3:0xa8
    v_cvt_pk_bf16_f32 v80, v80, v81
    v_cvt_pk_bf16_f32 v81, v82, v83
    ds_wrxchg_rtn_b64 v[74:75], v95, v[80:81] offset:65408
    v_cvt_pk_bf16_f32 v76, v76, v77
    v_cvt_pk_bf16_f32 v77, v78, v79
    ds_wrxchg_rtn_b64 v[72:73], v94, v[76:77] offset:65408
    s_waitcnt lgkmcnt(2)
    v_mfma_f32_4x4x4_16b_bf16 v[80:83], v[8:9], v[102:103], 0
    v_mfma_f32_4x4x4_16b_bf16 v[76:79], v[8:9], v[100:101], 0
    v_bitop3_b32 v15, v6, v15, v46 bitop3:0xca
    v_bitop3_b32 v14, v6, v14, v47 bitop3:0xca
    v_cmp_lt_u32 s[84:85], v5, v92
    s_nop 0
    v_pk_mul_f32 v[80:81], v[80:81], v[14:15] op_sel:[0,1] op_sel_hi:[1,1]
    v_pk_mul_f32 v[82:83], v[82:83], v[14:15] op_sel:[0,1] op_sel_hi:[1,1]
    v_pk_mul_f32 v[76:77], v[76:77], v[14:15] op_sel:[0,0] op_sel_hi:[1,0]
    v_pk_mul_f32 v[78:79], v[78:79], v[14:15] op_sel:[0,0] op_sel_hi:[1,0]
    s_waitcnt lgkmcnt(0)
    v_cmpx_ne_u64 vcc, v[74:75], v[70:71]
    s_and_b64 s[82:83], vcc, s[80:81]
    s_cbranch_scc1 L2_c86
L2_d86:
    v_mov_b64 v[84:85], v[70:71]
    v_mov_b32 v7, v95
    v_mov_b64 v[86:87], v[74:75]
    s_mov_b64 exec, -1
    s_or_b64 s[80:81], s[80:81], vcc
    v_cmpx_ne_u64 vcc, v[72:73], v[68:69]
    s_and_b64 s[82:83], vcc, s[80:81]
    s_cbranch_scc1 L2_c87
L2_d87:
    v_mov_b64 v[84:85], v[68:69]
    v_mov_b32 v7, v94
    v_mov_b64 v[86:87], v[72:73]
    s_mov_b64 exec, -1
    s_or_b64 s[80:81], s[80:81], vcc
    ds_read_b64 v[70:71], v93 offset:65408
    s_and_b64 exec, s[84:85], s[80:81]
    v_mfma_f32_4x4x4_16b_bf16 v[76:79], v[12:13], v[84:85], 0
    v_mov_b32 v92, v7
    s_andn2_b64 s[80:81], s[80:81], s[84:85]
    v_mfma_f32_4x4x4_16b_bf16 v[76:79], v[10:11], v[86:87], v[76:79]
    s_mov_b64 exec, -1
    ds_read_b64 v[68:69], v92 offset:65408
    v_and_b32 v46, 0x80000000, v33
    v_lshrrev_b32 v47, 14, v31
    v_bitop3_b32 v47, v47, v5, v46 bitop3:0xea
    ds_read_b64 v[106:107], v47
    v_bitop3_b32 v95, v31, v5, v46 bitop3:0xea
    v_and_b32 v46, 0x40000000, v33
    v_lshrrev_b32 v47, 14, v30
    v_bitop3_b32 v47, v47, v5, v46 bitop3:0xea
    ds_read_b64 v[104:105], v47
    v_bitop3_b32 v94, v30, v5, v46 bitop3:0xea
    s_waitcnt lgkmcnt(2)
    v_mfma_f32_4x4x4_16b_bf16 v[80:83], v[10:11], v[70:71], v[80:83]
    v_mfma_f32_4x4x4_16b_bf16 v[76:79], v[10:11], v[68:69], v[76:79]
    v_perm_b32 v15, v31, v32, s47
    v_bitop3_b32 v46, v31, 0.5, -0.5 bitop3:0xa8
    v_perm_b32 v14, v30, v32, s46
    v_bitop3_b32 v47, v30, 0.5, -0.5 bitop3:0xa8
    v_cvt_pk_bf16_f32 v80, v80, v81
    v_cvt_pk_bf16_f32 v81, v82, v83
    ds_wrxchg_rtn_b64 v[74:75], v93, v[80:81] offset:65408
    v_cvt_pk_bf16_f32 v76, v76, v77
    v_cvt_pk_bf16_f32 v77, v78, v79
    ds_wrxchg_rtn_b64 v[72:73], v92, v[76:77] offset:65408
    s_setprio 0
    s_waitcnt lgkmcnt(2)
    v_mfma_f32_4x4x4_16b_bf16 v[80:83], v[8:9], v[106:107], 0
    v_mfma_f32_4x4x4_16b_bf16 v[76:79], v[8:9], v[104:105], 0
    v_bitop3_b32 v15, v6, v15, v46 bitop3:0xca
    v_bitop3_b32 v14, v6, v14, v47 bitop3:0xca
    s_nop 1
    v_pk_mul_f32 v[80:81], v[80:81], v[14:15] op_sel:[0,1] op_sel_hi:[1,1]
    v_pk_mul_f32 v[82:83], v[82:83], v[14:15] op_sel:[0,1] op_sel_hi:[1,1]
    v_pk_mul_f32 v[76:77], v[76:77], v[14:15] op_sel:[0,0] op_sel_hi:[1,0]
    v_pk_mul_f32 v[78:79], v[78:79], v[14:15] op_sel:[0,0] op_sel_hi:[1,0]
    s_add_u32 s40, s40, 0x50000
    v_and_b32 v47, 0x0fffffff, v42
    v_mov_b32 v33, v42
    buffer_load_dwordx4 v[28:31], v47, s[8:11], 0 offen
    buffer_load_dwordx3 v[30:32], v47, s[8:11], 0 offen offset:8
    s_waitcnt lgkmcnt(0)
    v_cmpx_ne_u64 vcc, v[74:75], v[70:71]
    s_and_b64 s[82:83], vcc, s[80:81]
    s_cbranch_scc1 L2_c88
L2_d88:
    v_mov_b64 v[84:85], v[70:71]
    v_mov_b32 v7, v93
    v_mov_b64 v[86:87], v[74:75]
    s_mov_b64 exec, -1
    s_or_b64 s[80:81], s[80:81], vcc
    v_cmpx_ne_u64 vcc, v[72:73], v[68:69]
    s_and_b64 s[82:83], vcc, s[80:81]
    s_cbranch_scc1 L2_c89
L2_d89:
    v_mov_b64 v[84:85], v[68:69]
    v_mov_b32 v7, v92
    v_mov_b64 v[86:87], v[72:73]
    s_mov_b64 exec, -1
    s_or_b64 s[80:81], s[80:81], vcc
    ds_read_b64 v[70:71], v95 offset:65408
    ds_read_b64 v[68:69], v94 offset:65408
    s_waitcnt vmcnt(8)
    v_and_b32 v46, 0x20000000, v39
    v_lshrrev_b32 v47, 14, v35
    v_bitop3_b32 v47, v47, v5, v46 bitop3:0xea
    ds_read_b64 v[102:103], v47
    v_bitop3_b32 v93, v35, v5, v46 bitop3:0xea
    v_and_b32 v46, 0x10000000, v39
    v_lshrrev_b32 v47, 14, v34
    v_bitop3_b32 v47, v47, v5, v46 bitop3:0xea
    ds_read_b64 v[100:101], v47
    v_bitop3_b32 v92, v34, v5, v46 bitop3:0xea
    v_and_b32 v46, 0x80000000, v39
    v_lshrrev_b32 v47, 14, v37
    v_bitop3_b32 v47, v47, v5, v46 bitop3:0xea
    ds_read_b64 v[106:107], v47
    v_and_b32 v46, 0x40000000, v39
    v_lshrrev_b32 v47, 14, v36
    v_bitop3_b32 v47, v47, v5, v46 bitop3:0xea
    ds_read_b64 v[104:105], v47
    s_waitcnt lgkmcnt(4)
    v_mfma_f32_4x4x4_16b_bf16 v[80:83], v[10:11], v[70:71], v[80:83]
    v_mfma_f32_4x4x4_16b_bf16 v[76:79], v[10:11], v[68:69], v[76:79]
    v_perm_b32 v15, v35, v38, s45
    v_bitop3_b32 v46, v35, 0.5, -0.5 bitop3:0xa8
    v_perm_b32 v14, v34, v38, s44
    v_bitop3_b32 v47, v34, 0.5, -0.5 bitop3:0xa8
    v_cvt_pk_bf16_f32 v80, v80, v81
    v_cvt_pk_bf16_f32 v81, v82, v83
    ds_wrxchg_rtn_b64 v[74:75], v95, v[80:81] offset:65408
    v_cvt_pk_bf16_f32 v76, v76, v77
    v_cvt_pk_bf16_f32 v77, v78, v79
    ds_wrxchg_rtn_b64 v[72:73], v94, v[76:77] offset:65408
    s_waitcnt lgkmcnt(2)
    s_barrier
    s_setprio 3
    s_mov_b32 m0, s69
    s_nop 0
    ds_write_addtid_b32 v116 offset:32768
    ds_write_addtid_b32 v117 offset:33024
    ds_write_addtid_b32 v118 offset:33280
    ds_write_addtid_b32 v119 offset:33536
    buffer_load_dwordx4 v[116:119], v3, s[16:19], s40 offen offset:2048
    ds_write_addtid_b32 v120 offset:33792
    ds_write_addtid_b32 v121 offset:34048
    ds_write_addtid_b32 v122 offset:34304
    ds_write_addtid_b32 v123 offset:34560
    buffer_load_dwordx4 v[120:123], v3, s[16:19], s40 offen offset:3072
    v_mfma_f32_4x4x4_16b_bf16 v[80:83], v[8:9], v[102:103], 0
    v_mfma_f32_4x4x4_16b_bf16 v[76:79], v[8:9], v[100:101], 0
    v_bitop3_b32 v15, v6, v15, v46 bitop3:0xca
    v_bitop3_b32 v14, v6, v14, v47 bitop3:0xca
    v_cmp_lt_u32 s[84:85], v5, v92
    s_nop 0
    v_pk_mul_f32 v[80:81], v[80:81], v[14:15] op_sel:[0,1] op_sel_hi:[1,1]
    v_pk_mul_f32 v[82:83], v[82:83], v[14:15] op_sel:[0,1] op_sel_hi:[1,1]
    v_pk_mul_f32 v[76:77], v[76:77], v[14:15] op_sel:[0,0] op_sel_hi:[1,0]
    v_pk_mul_f32 v[78:79], v[78:79], v[14:15] op_sel:[0,0] op_sel_hi:[1,0]
    v_mov_b32 v44, v43
    s_cmp_gt_u32 s37, 1024
    s_cbranch_scc1 L2_xs90
    s_cmp_lg_u32 s43, 0
    s_cbranch_scc1 L2_xa90
L2_xb90:
    v_lshlrev_b32 v89, 16, v96
    v_add_u32 v90, 60, v97
    v_bitop3_b32 v90, v89, v45, v90 bitop3:0x6a
    ds_write_b32 v98, v90 offset:12
    v_lshlrev_b32 v89, 20, v96
    v_add_u32 v90, 40, v97
    v_bitop3_b32 v90, v89, v45, v90 bitop3:0x6a
    ds_write_b32 v98, v90 offset:8
    v_lshlrev_b32 v89, 24, v96
    v_add_u32 v90, 20, v97
    v_bitop3_b32 v90, v89, v45, v90 bitop3:0x6a
    ds_write_b32 v98, v90 offset:4
    v_lshlrev_b32 v89, 28, v96
    v_bitop3_b32 v90, v89, v45, v97 bitop3:0x6a
    ds_write_b32 v98, v90 offset:0
    v_mov_b32_dpp v91, v64 quad_perm:[1,1,1,1] row_mask:0xf bank_mask:0xf
    v_and_b32 v89, 3, v91
    v_and_b32 v97, 0xfffc, v91
    v_sub_u16_dpp v88, v64, v91 quad_perm:[3,3,3,3] row_mask:0xf bank_mask:0xf
    v_mad_u32_u24 v97, v97, 5, v4
    v_add_u32 v99, v88, v89
    v_bfm_b32 v96, v88, v89
    v_cmp_lt_u32 s[58:59], 16, v99
    v_lshlrev_b32 v89, v1, v96
    v_and_b32 v89, v45, v89
    v_cmp_ne_u32 vcc, 0, v89
    v_xor_b32 v90, v97, v89
    s_add_u32 s3, s37, s38
    v_mbcnt_lo_u32_b32 v98, vcc_lo, 0
    v_mbcnt_hi_u32_b32 v98, vcc_hi, v98
    s_bcnt1_i32_b64 s41, vcc
    v_lshl_add_u32 v98, v98, 2, s3
    s_mov_b64 exec, vcc
    ds_write_b32 v98, v90
    s_mov_b64 exec, -1
    s_lshl2_add_u32 s37, s41, s37
    s_cmp_lg_u64 s[58:59], 0
    s_cbranch_scc1 L2_xe90
L2_xr90:
    v_add_u32 v98, s37, v0
    v_mov_b32 v90, -1
    ds_write_b32 v98, v90
    ds_read2st64_b32 v[40:41], v0 offset0:0 offset1:1
    ds_read2st64_b32 v[42:43], v0 offset0:2 offset1:3
    s_sub_u32 s3, s37, 768
    s_cmp_gt_u32 s3, 256
    s_cbranch_scc1 L2_xf90
L2_xg90:
    s_setprio 2
    ds_write_addtid_b32 v124 offset:34816
    ds_write_addtid_b32 v125 offset:35072
    ds_write_addtid_b32 v126 offset:35328
    ds_write_addtid_b32 v127 offset:35584
    s_add_u32 s3, s40, 4096
    buffer_load_dwordx4 v[124:127], v3, s[16:19], s3 offen
    s_waitcnt lgkmcnt(14)
    v_cmpx_ne_u64 vcc, v[74:75], v[70:71]
    s_and_b64 s[82:83], vcc, s[80:81]
    s_cbranch_scc1 L2_c91
L2_d91:
    v_mov_b64 v[84:85], v[70:71]
    v_mov_b32 v7, v95
    v_mov_b64 v[86:87], v[74:75]
    s_mov_b64 exec, -1
    s_or_b64 s[80:81], s[80:81], vcc
    v_cmpx_ne_u64 vcc, v[72:73], v[68:69]
    s_and_b64 s[82:83], vcc, s[80:81]
    s_cbranch_scc1 L2_c92
L2_d92:
    v_mov_b64 v[84:85], v[68:69]
    v_mov_b32 v7, v94
    v_mov_b64 v[86:87], v[72:73]
    s_mov_b64 exec, -1
    s_or_b64 s[80:81], s[80:81], vcc
    ds_read_b64 v[70:71], v93 offset:65408
    s_and_b64 exec, s[84:85], s[80:81]
    v_mfma_f32_4x4x4_16b_bf16 v[76:79], v[12:13], v[84:85], 0
    v_mov_b32 v92, v7
    s_andn2_b64 s[80:81], s[80:81], s[84:85]
    v_mfma_f32_4x4x4_16b_bf16 v[76:79], v[10:11], v[86:87], v[76:79]
    s_mov_b64 exec, -1
    ds_read_b64 v[68:69], v92 offset:65408
    s_setprio 1
    s_waitcnt vmcnt(10)
    s_mov_b32 m0, s38
    s_nop 0
    ds_write_addtid_b32 v108 offset:0
    ds_write_addtid_b32 v109 offset:256
    ds_write_addtid_b32 v110 offset:512
    ds_write_addtid_b32 v111 offset:768
    s_waitcnt lgkmcnt(4)
    v_mfma_f32_4x4x4_16b_bf16 v[80:83], v[10:11], v[70:71], v[80:83]
    v_mfma_f32_4x4x4_16b_bf16 v[76:79], v[10:11], v[68:69], v[76:79]
    v_and_b32 v46, 0x40000000, v39
    v_bitop3_b32 v94, v36, v5, v46 bitop3:0xea
    v_and_b32 v46, 0x80000000, v39
    v_bitop3_b32 v95, v37, v5, v46 bitop3:0xea
    v_perm_b32 v15, v37, v38, s47
    v_bitop3_b32 v46, v37, 0.5, -0.5 bitop3:0xa8
    v_perm_b32 v14, v36, v38, s46
    v_bitop3_b32 v47, v36, 0.5, -0.5 bitop3:0xa8
    v_cvt_pk_bf16_f32 v80, v80, v81
    v_cvt_pk_bf16_f32 v81, v82, v83
    ds_wrxchg_rtn_b64 v[74:75], v93, v[80:81] offset:65408
    v_cvt_pk_bf16_f32 v76, v76, v77
    v_cvt_pk_bf16_f32 v77, v78, v79
    ds_wrxchg_rtn_b64 v[72:73], v92, v[76:77] offset:65408
    s_setprio 0
    s_waitcnt vmcnt(7)
    ds_write_addtid_b32 v112 offset:1024
    ds_write_addtid_b32 v113 offset:1280
    ds_write_addtid_b32 v114 offset:1536
    ds_write_addtid_b32 v115 offset:1792
    v_mfma_f32_4x4x4_16b_bf16 v[80:83], v[8:9], v[106:107], 0
    v_mfma_f32_4x4x4_16b_bf16 v[76:79], v[8:9], v[104:105], 0
    v_bitop3_b32 v15, v6, v15, v46 bitop3:0xca
    v_bitop3_b32 v14, v6, v14, v47 bitop3:0xca
    s_nop 1
    v_pk_mul_f32 v[80:81], v[80:81], v[14:15] op_sel:[0,1] op_sel_hi:[1,1]
    v_pk_mul_f32 v[82:83], v[82:83], v[14:15] op_sel:[0,1] op_sel_hi:[1,1]
    v_pk_mul_f32 v[76:77], v[76:77], v[14:15] op_sel:[0,0] op_sel_hi:[1,0]
    v_pk_mul_f32 v[78:79], v[78:79], v[14:15] op_sel:[0,0] op_sel_hi:[1,0]
    s_add_u32 s42, s42, 1
    s_waitcnt lgkmcnt(0)
    s_barrier
    s_bitcmp1_b32 s36, s42
    s_cbranch_scc1 L2_slow
L2_ret5:
    s_setprio 3
    v_and_b32 v47, 0x0fffffff, v44
    v_mov_b32 v39, v44
    buffer_load_dwordx4 v[34:37], v47, s[8:11], 0 offen
    buffer_load_dwordx3 v[36:38], v47, s[8:11], 0 offen offset:8
    v_cmpx_ne_u64 vcc, v[74:75], v[70:71]
    s_and_b64 s[82:83], vcc, s[80:81]
    s_cbranch_scc1 L2_c93
L2_d93:
    v_mov_b64 v[84:85], v[70:71]
    v_mov_b32 v7, v93
    v_mov_b64 v[86:87], v[74:75]
    s_mov_b64 exec, -1
    s_or_b64 s[80:81], s[80:81], vcc
    v_cmpx_ne_u64 vcc, v[72:73], v[68:69]
    s_and_b64 s[82:83], vcc, s[80:81]
    s_cbranch_scc1 L2_c94
L2_d94:
    v_mov_b64 v[84:85], v[68:69]
    v_mov_b32 v7, v92
    v_mov_b64 v[86:87], v[72:73]
    s_mov_b64 exec, -1
    s_or_b64 s[80:81], s[80:81], vcc
    ds_read_b64 v[70:71], v95 offset:65408
    ds_read_b64 v[68:69], v94 offset:65408
    v_and_b32 v46, 0x20000000, v21
    v_lshrrev_b32 v47, 14, v17
    v_bitop3_b32 v47, v47, v5, v46 bitop3:0xea
    ds_read_b64 v[102:103], v47
    v_bitop3_b32 v93, v17, v5, v46 bitop3:0xea
    v_and_b32 v46, 0x10000000, v21
    v_lshrrev_b32 v47, 14, v16
    v_bitop3_b32 v47, v47, v5, v46 bitop3:0xea
    ds_read_b64 v[100:101], v47
    v_bitop3_b32 v92, v16, v5, v46 bitop3:0xea
    s_waitcnt lgkmcnt(2)
    v_mfma_f32_4x4x4_16b_bf16 v[80:83], v[10:11], v[70:71], v[80:83]
    v_mfma_f32_4x4x4_16b_bf16 v[76:79], v[10:11], v[68:69], v[76:79]
    v_perm_b32 v15, v17, v20, s45
    v_bitop3_b32 v46, v17, 0.5, -0.5 bitop3:0xa8
    v_perm_b32 v14, v16, v20, s44
    v_bitop3_b32 v47, v16, 0.5, -0.5 bitop3:0xa8
    v_cvt_pk_bf16_f32 v80, v80, v81
    v_cvt_pk_bf16_f32 v81, v82, v83
    ds_wrxchg_rtn_b64 v[74:75], v95, v[80:81] offset:65408
    v_cvt_pk_bf16_f32 v76, v76, v77
    v_cvt_pk_bf16_f32 v77, v78, v79
    ds_wrxchg_rtn_b64 v[72:73], v94, v[76:77] offset:65408
    s_waitcnt lgkmcnt(2)
    v_mfma_f32_4x4x4_16b_bf16 v[80:83], v[8:9], v[102:103], 0
    v_mfma_f32_4x4x4_16b_bf16 v[76:79], v[8:9], v[100:101], 0
    v_bitop3_b32 v15, v6, v15, v46 bitop3:0xca
    v_bitop3_b32 v14, v6, v14, v47 bitop3:0xca
    v_cmp_lt_u32 s[84:85], v5, v92
    s_nop 0
    v_pk_mul_f32 v[80:81], v[80:81], v[14:15] op_sel:[0,1] op_sel_hi:[1,1]
    v_pk_mul_f32 v[82:83], v[82:83], v[14:15] op_sel:[0,1] op_sel_hi:[1,1]
    v_pk_mul_f32 v[76:77], v[76:77], v[14:15] op_sel:[0,0] op_sel_hi:[1,0]
    v_pk_mul_f32 v[78:79], v[78:79], v[14:15] op_sel:[0,0] op_sel_hi:[1,0]
    buffer_load_dwordx4 v[108:111], v3, s[16:19], s40 offen offset:0
    s_waitcnt lgkmcnt(0)
    v_cmpx_ne_u64 vcc, v[74:75], v[70:71]
    s_and_b64 s[82:83], vcc, s[80:81]
    s_cbranch_scc1 L2_c95
L2_d95:
    v_mov_b64 v[84:85], v[70:71]
    v_mov_b32 v7, v95
    v_mov_b64 v[86:87], v[74:75]
    s_mov_b64 exec, -1
    s_or_b64 s[80:81], s[80:81], vcc
    v_cmpx_ne_u64 vcc, v[72:73], v[68:69]
    s_and_b64 s[82:83], vcc, s[80:81]
    s_cbranch_scc1 L2_c96
L2_d96:
    v_mov_b64 v[84:85], v[68:69]
    v_mov_b32 v7, v94
    v_mov_b64 v[86:87], v[72:73]
    s_mov_b64 exec, -1
    s_or_b64 s[80:81], s[80:81], vcc
    ds_read_b64 v[70:71], v93 offset:65408
    s_and_b64 exec, s[84:85], s[80:81]
    v_mfma_f32_4x4x4_16b_bf16 v[76:79], v[12:13], v[84:85], 0
    v_mov_b32 v92, v7
    s_andn2_b64 s[80:81], s[80:81], s[84:85]
    v_mfma_f32_4x4x4_16b_bf16 v[76:79], v[10:11], v[86:87], v[76:79]
    s_mov_b64 exec, -1
    ds_read_b64 v[68:69], v92 offset:65408
    v_and_b32 v46, 0x80000000, v21
    v_lshrrev_b32 v47, 14, v19
    v_bitop3_b32 v47, v47, v5, v46 bitop3:0xea
    ds_read_b64 v[106:107], v47
    v_bitop3_b32 v95, v19, v5, v46 bitop3:0xea
    v_and_b32 v46, 0x40000000, v21
    v_lshrrev_b32 v47, 14, v18
    v_bitop3_b32 v47, v47, v5, v46 bitop3:0xea
    ds_read_b64 v[104:105], v47
    v_bitop3_b32 v94, v18, v5, v46 bitop3:0xea
    s_waitcnt lgkmcnt(2)
    v_mfma_f32_4x4x4_16b_bf16 v[80:83], v[10:11], v[70:71], v[80:83]
    v_mfma_f32_4x4x4_16b_bf16 v[76:79], v[10:11], v[68:69], v[76:79]
    v_perm_b32 v15, v19, v20, s47
    v_bitop3_b32 v46, v19, 0.5, -0.5 bitop3:0xa8
    v_perm_b32 v14, v18, v20, s46
    v_bitop3_b32 v47, v18, 0.5, -0.5 bitop3:0xa8
    v_cvt_pk_bf16_f32 v80, v80, v81
    v_cvt_pk_bf16_f32 v81, v82, v83
    ds_wrxchg_rtn_b64 v[74:75], v93, v[80:81] offset:65408
    v_cvt_pk_bf16_f32 v76, v76, v77
    v_cvt_pk_bf16_f32 v77, v78, v79
    ds_wrxchg_rtn_b64 v[72:73], v92, v[76:77] offset:65408
    s_setprio 2
    s_waitcnt lgkmcnt(2)
    v_mfma_f32_4x4x4_16b_bf16 v[80:83], v[8:9], v[106:107], 0
    v_mfma_f32_4x4x4_16b_bf16 v[76:79], v[8:9], v[104:105], 0
    v_bitop3_b32 v15, v6, v15, v46 bitop3:0xca
    v_bitop3_b32 v14, v6, v14, v47 bitop3:0xca
    s_nop 1
    v_pk_mul_f32 v[80:81], v[80:81], v[14:15] op_sel:[0,1] op_sel_hi:[1,1]
    v_pk_mul_f32 v[82:83], v[82:83], v[14:15] op_sel:[0,1] op_sel_hi:[1,1]
    v_pk_mul_f32 v[76:77], v[76:77], v[14:15] op_sel:[0,0] op_sel_hi:[1,0]
    v_pk_mul_f32 v[78:79], v[78:79], v[14:15] op_sel:[0,0] op_sel_hi:[1,0]
    v_and_b32 v47, 0x0fffffff, v40
    v_mov_b32 v21, v40
    buffer_load_dwordx4 v[16:19], v47, s[8:11], 0 offen
    buffer_load_dwordx3 v[18:20], v47, s[8:11], 0 offen offset:8
    s_waitcnt lgkmcnt(0)
    v_cmpx_ne_u64 vcc, v[74:75], v[70:71]
    s_and_b64 s[82:83], vcc, s[80:81]
    s_cbranch_scc1 L2_c97
L2_d97:
    v_mov_b64 v[84:85], v[70:71]
    v_mov_b32 v7, v93
    v_mov_b64 v[86:87], v[74:75]
    s_mov_b64 exec, -1
    s_or_b64 s[80:81], s[80:81], vcc
    v_cmpx_ne_u64 vcc, v[72:73], v[68:69]
    s_and_b64 s[82:83], vcc, s[80:81]
    s_cbranch_scc1 L2_c98
L2_d98:
    v_mov_b64 v[84:85], v[68:69]
    v_mov_b32 v7, v92
    v_mov_b64 v[86:87], v[72:73]
    s_mov_b64 exec, -1
    s_or_b64 s[80:81], s[80:81], vcc
    ds_read_b64 v[70:71], v95 offset:65408
    ds_read_b64 v[68:69], v94 offset:65408
    s_waitcnt vmcnt(10)
    v_and_b32 v46, 0x20000000, v27
    v_lshrrev_b32 v47, 14, v23
    v_bitop3_b32 v47, v47, v5, v46 bitop3:0xea
    ds_read_b64 v[102:103], v47
    v_bitop3_b32 v93, v23, v5, v46 bitop3:0xea
    v_and_b32 v46, 0x10000000, v27
    v_lshrrev_b32 v47, 14, v22
    v_bitop3_b32 v47, v47, v5, v46 bitop3:0xea
    ds_read_b64 v[100:101], v47
    v_bitop3_b32 v92, v22, v5, v46 bitop3:0xea
    s_waitcnt lgkmcnt(2)
    v_mfma_f32_4x4x4_16b_bf16 v[80:83], v[10:11], v[70:71], v[80:83]
    v_mfma_f32_4x4x4_16b_bf16 v[76:79], v[10:11], v[68:69], v[76:79]
    v_perm_b32 v15, v23, v26, s45
    v_bitop3_b32 v46, v23, 0.5, -0.5 bitop3:0xa8
    v_perm_b32 v14, v22, v26, s44
    v_bitop3_b32 v47, v22, 0.5, -0.5 bitop3:0xa8
    v_cvt_pk_bf16_f32 v80, v80, v81
    v_cvt_pk_bf16_f32 v81, v82, v83
    ds_wrxchg_rtn_b64 v[74:75], v95, v[80:81] offset:65408
    v_cvt_pk_bf16_f32 v76, v76, v77
    v_cvt_pk_bf16_f32 v77, v78, v79
    ds_wrxchg_rtn_b64 v[72:73], v94, v[76:77] offset:65408
    s_waitcnt lgkmcnt(2)
    v_mfma_f32_4x4x4_16b_bf16 v[80:83], v[8:9], v[102:103], 0
    v_mfma_f32_4x4x4_16b_bf16 v[76:79], v[8:9], v[100:101], 0
    v_bitop3_b32 v15, v6, v15, v46 bitop3:0xca
    v_bitop3_b32 v14, v6, v14, v47 bitop3:0xca
    v_cmp_lt_u32 s[84:85], v5, v92
    s_nop 0
    v_pk_mul_f32 v[80:81], v[80:81], v[14:15] op_sel:[0,1] op_sel_hi:[1,1]
    v_pk_mul_f32 v[82:83], v[82:83], v[14:15] op_sel:[0,1] op_sel_hi:[1,1]
    v_pk_mul_f32 v[76:77], v[76:77], v[14:15] op_sel:[0,0] op_sel_hi:[1,0]
    v_pk_mul_f32 v[78:79], v[78:79], v[14:15] op_sel:[0,0] op_sel_hi:[1,0]
    v_sub_u16 v88, v62, v54
    v_and_b32 v89, 3, v54
    v_add3_u32 v99, v88, v89, 3
    v_and_b32 v99, -4, v99
    v_max_u32 v99, 4, v99
    v_and_b32 v97, 0xfffc, v54
    v_bfm_b32 v96, v88, v89
    v_add_u32_dpp v91, v99, v99 row_shr:1 row_mask:0xf bank_mask:0xf bound_ctrl:1
    v_mad_u32_u24 v97, v97, 5, v2
    v_cmp_lt_u32 vcc, 16, v99
    v_add_u32_dpp v91, v91, v91 row_shr:2 row_mask:0xf bank_mask:0xf bound_ctrl:1
    v_sub_u32 v98, s38, v99
    v_lshrrev_b64 v[54:55], 16, v[54:55]
    v_add_u32_dpp v91, v91, v91 row_shr:4 row_mask:0xf bank_mask:0xf bound_ctrl:1
    v_lshrrev_b64 v[62:63], 16, v[62:63]
    s_mov_b32 s43, 0
    v_add_u32_dpp v91, v91, v91 row_shr:8 row_mask:0xf bank_mask:0xf bound_ctrl:1
    s_nop 1
    v_add_u32_dpp v91, v91, v91 row_bcast:15 row_mask:0xa bank_mask:0xf
    s_nop 1
    v_add_u32_dpp v91, v91, v91 row_bcast:31 row_mask:0xc bank_mask:0xf
    v_add_u32 v98, v98, v91
    v_readlane_b32 s37, v91, 63
    s_cbranch_vccnz L2_xo99
L2_xp99:
    buffer_load_dwordx4 v[112:115], v3, s[16:19], s40 offen offset:1024
    s_waitcnt lgkmcnt(0)
    v_cmpx_ne_u64 vcc, v[74:75], v[70:71]
    s_and_b64 s[82:83], vcc, s[80:81]
    s_cbranch_scc1 L2_c100
L2_d100:
    v_mov_b64 v[84:85], v[70:71]
    v_mov_b32 v7, v95
    v_mov_b64 v[86:87], v[74:75]
    s_mov_b64 exec, -1
    s_or_b64 s[80:81], s[80:81], vcc
    v_cmpx_ne_u64 vcc, v[72:73], v[68:69]
    s_and_b64 s[82:83], vcc, s[80:81]
    s_cbranch_scc1 L2_c101
L2_d101:
    v_mov_b64 v[84:85], v[68:69]
    v_mov_b32 v7, v94
    v_mov_b64 v[86:87], v[72:73]
    s_mov_b64 exec, -1
    s_or_b64 s[80:81], s[80:81], vcc
    ds_read_b64 v[70:71], v93 offset:65408
    s_and_b64 exec, s[84:85], s[80:81]
    v_mfma_f32_4x4x4_16b_bf16 v[76:79], v[12:13], v[84:85], 0
    v_mov_b32 v92, v7
    s_andn2_b64 s[80:81], s[80:81], s[84:85]
    v_mfma_f32_4x4x4_16b_bf16 v[76:79], v[10:11], v[86:87], v[76:79]
    s_mov_b64 exec, -1
    ds_read_b64 v[68:69], v92 offset:65408
    v_and_b32 v46, 0x80000000, v27
    v_lshrrev_b32 v47, 14, v25
    v_bitop3_b32 v47, v47, v5, v46 bitop3:0xea
    ds_read_b64 v[106:107], v47
    v_bitop3_b32 v95, v25, v5, v46 bitop3:0xea
    v_and_b32 v46, 0x40000000, v27
    v_lshrrev_b32 v47, 14, v24
    v_bitop3_b32 v47, v47, v5, v46 bitop3:0xea
    ds_read_b64 v[104:105], v47
    v_bitop3_b32 v94, v24, v5, v46 bitop3:0xea
    s_waitcnt lgkmcnt(2)
    v_mfma_f32_4x4x4_16b_bf16 v[80:83], v[10:11], v[70:71], v[80:83]
    v_mfma_f32_4x4x4_16b_bf16 v[76:79], v[10:11], v[68:69], v[76:79]
    v_perm_b32 v15, v25, v26, s47
    v_bitop3_b32 v46, v25, 0.5, -0.5 bitop3:0xa8
    v_perm_b32 v14, v24, v26, s46
    v_bitop3_b32 v47, v24, 0.5, -0.5 bitop3:0xa8
    v_cvt_pk_bf16_f32 v80, v80, v81
    v_cvt_pk_bf16_f32 v81, v82, v83
    ds_wrxchg_rtn_b64 v[74:75], v93, v[80:81] offset:65408
    v_cvt_pk_bf16_f32 v76, v76, v77
    v_cvt_pk_bf16_f32 v77, v78, v79
    ds_wrxchg_rtn_b64 v[72:73], v92, v[76:77] offset:65408
    s_setprio 1
    s_waitcnt lgkmcnt(2)
    v_mfma_f32_4x4x4_16b_bf16 v[80:83], v[8:9], v[106:107], 0
    v_mfma_f32_4x4x4_16b_bf16 v[76:79], v[8:9], v[104:105], 0
    v_bitop3_b32 v15, v6, v15, v46 bitop3:0xca
    v_bitop3_b32 v14, v6, v14, v47 bitop3:0xca
    s_nop 1
    v_pk_mul_f32 v[80:81], v[80:81], v[14:15] op_sel:[0,1] op_sel_hi:[1,1]
    v_pk_mul_f32 v[82:83], v[82:83], v[14:15] op_sel:[0,1] op_sel_hi:[1,1]
    v_pk_mul_f32 v[76:77], v[76:77], v[14:15] op_sel:[0,0] op_sel_hi:[1,0]
    v_pk_mul_f32 v[78:79], v[78:79], v[14:15] op_sel:[0,0] op_sel_hi:[1,0]
    v_and_b32 v47, 0x0fffffff, v41
    v_mov_b32 v27, v41
    buffer_load_dwordx4 v[22:25], v47, s[8:11], 0 offen
    buffer_load_dwordx3 v[24:26], v47, s[8:11], 0 offen offset:8
    s_waitcnt lgkmcnt(0)
    v_cmpx_ne_u64 vcc, v[74:75], v[70:71]
    s_and_b64 s[82:83], vcc, s[80:81]
    s_cbranch_scc1 L2_c102
L2_d102:
    v_mov_b64 v[84:85], v[70:71]
    v_mov_b32 v7, v93
    v_mov_b64 v[86:87], v[74:75]
    s_mov_b64 exec, -1
    s_or_b64 s[80:81], s[80:81], vcc
    v_cmpx_ne_u64 vcc, v[72:73], v[68:69]
    s_and_b64 s[82:83], vcc, s[80:81]
    s_cbranch_scc1 L2_c103
L2_d103:
    v_mov_b64 v[84:85], v[68:69]
    v_mov_b32 v7, v92
    v_mov_b64 v[86:87], v[72:73]
    s_mov_b64 exec, -1
    s_or_b64 s[80:81], s[80:81], vcc
    ds_read_b64 v[70:71], v95 offset:65408
    ds_read_b64 v[68:69], v94 offset:65408
    s_waitcnt vmcnt(11)
    v_and_b32 v46, 0x20000000, v33
    v_lshrrev_b32 v47, 14, v29
    v_bitop3_b32 v47, v47, v5, v46 bitop3:0xea
    ds_read_b64 v[102:103], v47
    v_bitop3_b32 v93, v29, v5, v46 bitop3:0xea
    v_and_b32 v46, 0x10000000, v33
    v_lshrrev_b32 v47, 14, v28
    v_bitop3_b32 v47, v47, v5, v46 bitop3:0xea
    ds_read_b64 v[100:101], v47
    v_bitop3_b32 v92, v28, v5, v46 bitop3:0xea
    s_waitcnt lgkmcnt(2)
    v_mfma_f32_4x4x4_16b_bf16 v[80:83], v[10:11], v[70:71], v[80:83]
    v_mfma_f32_4x4x4_16b_bf16 v[76:79], v[10:11], v[68:69], v[76:79]
    v_perm_b32 v15, v29, v32, s45
    v_bitop3_b32 v46, v29, 0.5, -0.5 bitop3:0xa8
    v_perm_b32 v14, v28, v32, s44
    v_bitop3_b32 v47, v28, 0.5, -0.5 bitop3:0xa8
    v_cvt_pk_bf16_f32 v80, v80, v81
    v_cvt_pk_bf16_f32 v81, v82, v83
    ds_wrxchg_rtn_b64 v[74:75], v95, v[80:81] offset:65408
    v_cvt_pk_bf16_f32 v76, v76, v77
    v_cvt_pk_bf16_f32 v77, v78, v79
    ds_wrxchg_rtn_b64 v[72:73], v94, v[76:77] offset:65408
    s_waitcnt lgkmcnt(2)
    v_mfma_f32_4x4x4_16b_bf16 v[80:83], v[8:9], v[102:103], 0
    v_mfma_f32_4x4x4_16b_bf16 v[76:79], v[8:9], v[100:101], 0
    v_bitop3_b32 v15, v6, v15, v46 bitop3:0xca
    v_bitop3_b32 v14, v6, v14, v47 bitop3:0xca
    v_cmp_lt_u32 s[84:85], v5, v92
    s_nop 0
    v_pk_mul_f32 v[80:81], v[80:81], v[14:15] op_sel:[0,1] op_sel_hi:[1,1]
    v_pk_mul_f32 v[82:83], v[82:83], v[14:15] op_sel:[0,1] op_sel_hi:[1,1]
    v_pk_mul_f32 v[76:77], v[76:77], v[14:15] op_sel:[0,0] op_sel_hi:[1,0]
    v_pk_mul_f32 v[78:79], v[78:79], v[14:15] op_sel:[0,0] op_sel_hi:[1,0]
    s_waitcnt lgkmcnt(0)
    v_cmpx_ne_u64 vcc, v[74:75], v[70:71]
    s_and_b64 s[82:83], vcc, s[80:81]
    s_cbranch_scc1 L2_c104
L2_d104:
    v_mov_b64 v[84:85], v[70:71]
    v_mov_b32 v7, v95
    v_mov_b64 v[86:87], v[74:75]
    s_mov_b64 exec, -1
    s_or_b64 s[80:81], s[80:81], vcc
    v_cmpx_ne_u64 vcc, v[72:73], v[68:69]
    s_and_b64 s[82:83], vcc, s[80:81]
    s_cbranch_scc1 L2_c105
L2_d105:
    v_mov_b64 v[84:85], v[68:69]
    v_mov_b32 v7, v94
    v_mov_b64 v[86:87], v[72:73]
    s_mov_b64 exec, -1
    s_or_b64 s[80:81], s[80:81], vcc
    ds_read_b64 v[70:71], v93 offset:65408
    s_and_b64 exec, s[84:85], s[80:81]
    v_mfma_f32_4x4x4_16b_bf16 v[76:79], v[12:13], v[84:85], 0
    v_mov_b32 v92, v7
    s_andn2_b64 s[80:81], s[80:81], s[84:85]
    v_mfma_f32_4x4x4_16b_bf16 v[76:79], v[10:11], v[86:87], v[76:79]
    s_mov_b64 exec, -1
    ds_read_b64 v[68:69], v92 offset:65408
    v_and_b32 v46, 0x80000000, v33
    v_lshrrev_b32 v47, 14, v31
    v_bitop3_b32 v47, v47, v5, v46 bitop3:0xea
    ds_read_b64 v[106:107], v47
    v_bitop3_b32 v95, v31, v5, v46 bitop3:0xea
    v_and_b32 v46, 0x40000000, v33
    v_lshrrev_b32 v47, 14, v30
    v_bitop3_b32 v47, v47, v5, v46 bitop3:0xea
    ds_read_b64 v[104:105], v47
    v_bitop3_b32 v94, v30, v5, v46 bitop3:0xea
    s_waitcnt lgkmcnt(2)
    v_mfma_f32_4x4x4_16b_bf16 v[80:83], v[10:11], v[70:71], v[80:83]
    v_mfma_f32_4x4x4_16b_bf16 v[76:79], v[10:11], v[68:69], v[76:79]
    v_perm_b32 v15, v31, v32, s47
    v_bitop3_b32 v46, v31, 0.5, -0.5 bitop3:0xa8
    v_perm_b32 v14, v30, v32, s46
    v_bitop3_b32 v47, v30, 0.5, -0.5 bitop3:0xa8
    v_cvt_pk_bf16_f32 v80, v80, v81
    v_cvt_pk_bf16_f32 v81, v82, v83
    ds_wrxchg_rtn_b64 v[74:75], v93, v[80:81] offset:65408
    v_cvt_pk_bf16_f32 v76, v76, v77
    v_cvt_pk_bf16_f32 v77, v78, v79
    ds_wrxchg_rtn_b64 v[72:73], v92, v[76:77] offset:65408
    s_setprio 0
    s_waitcnt lgkmcnt(2)
    v_mfma_f32_4x4x4_16b_bf16 v[80:83], v[8:9], v[106:107], 0
    v_mfma_f32_4x4x4_16b_bf16 v[76:79], v[8:9], v[104:105], 0
    v_bitop3_b32 v15, v6, v15, v46 bitop3:0xca
    v_bitop3_b32 v14, v6, v14, v47 bitop3:0xca
    s_nop 1
    v_pk_mul_f32 v[80:81], v[80:81], v[14:15] op_sel:[0,1] op_sel_hi:[1,1]
    v_pk_mul_f32 v[82:83], v[82:83], v[14:15] op_sel:[0,1] op_sel_hi:[1,1]
    v_pk_mul_f32 v[76:77], v[76:77], v[14:15] op_sel:[0,0] op_sel_hi:[1,0]
    v_pk_mul_f32 v[78:79], v[78:79], v[14:15] op_sel:[0,0] op_sel_hi:[1,0]
    s_add_u32 s40, s40, 0x50000
    v_and_b32 v47, 0x0fffffff, v42
    v_mov_b32 v33, v42
    buffer_load_dwordx4 v[28:31], v47, s[8:11], 0 offen
    buffer_load_dwordx3 v[30:32], v47, s[8:11], 0 offen offset:8
    s_waitcnt lgkmcnt(0)
    v_cmpx_ne_u64 vcc, v[74:75], v[70:71]
    s_and_b64 s[82:83], vcc, s[80:81]
    s_cbranch_scc1 L2_c106
L2_d106:
    v_mov_b64 v[84:85], v[70:71]
    v_mov_b32 v7, v93
    v_mov_b64 v[86:87], v[74:75]
    s_mov_b64 exec, -1
    s_or_b64 s[80:81], s[80:81], vcc
    v_cmpx_ne_u64 vcc, v[72:73], v[68:69]
    s_and_b64 s[82:83], vcc, s[80:81]
    s_cbranch_scc1 L2_c107
L2_d107:
    v_mov_b64 v[84:85], v[68:69]
    v_mov_b32 v7, v92
    v_mov_b64 v[86:87], v[72:73]
    s_mov_b64 exec, -1
    s_or_b64 s[80:81], s[80:81], vcc
    ds_read_b64 v[70:71], v95 offset:65408
    ds_read_b64 v[68:69], v94 offset:65408
    s_waitcnt vmcnt(8)
    v_and_b32 v46, 0x20000000, v39
    v_lshrrev_b32 v47, 14, v35
    v_bitop3_b32 v47, v47, v5, v46 bitop3:0xea
    ds_read_b64 v[102:103], v47
    v_bitop3_b32 v93, v35, v5, v46 bitop3:0xea
    v_and_b32 v46, 0x10000000, v39
    v_lshrrev_b32 v47, 14, v34
    v_bitop3_b32 v47, v47, v5, v46 bitop3:0xea
    ds_read_b64 v[100:101], v47
    v_bitop3_b32 v92, v34, v5, v46 bitop3:0xea
    v_and_b32 v46, 0x80000000, v39
    v_lshrrev_b32 v47, 14, v37
    v_bitop3_b32 v47, v47, v5, v46 bitop3:0xea
    ds_read_b64 v[106:107], v47
    v_and_b32 v46, 0x40000000, v39
    v_lshrrev_b32 v47, 14, v36
    v_bitop3_b32 v47, v47, v5, v46 bitop3:0xea
    ds_read_b64 v[104:105], v47
    s_waitcnt lgkmcnt(4)
    v_mfma_f32_4x4x4_16b_bf16 v[80:83], v[10:11], v[70:71], v[80:83]
    v_mfma_f32_4x4x4_16b_bf16 v[76:79], v[10:11], v[68:69], v[76:79]
    v_perm_b32 v15, v35, v38, s45
    v_bitop3_b32 v46, v35, 0.5, -0.5 bitop3:0xa8
    v_perm_b32 v14, v34, v38, s44
    v_bitop3_b32 v47, v34, 0.5, -0.5 bitop3:0xa8
    v_cvt_pk_bf16_f32 v80, v80, v81
    v_cvt_pk_bf16_f32 v81, v82, v83
    ds_wrxchg_rtn_b64 v[74:75], v95, v[80:81] offset:65408
    v_cvt_pk_bf16_f32 v76, v76, v77
    v_cvt_pk_bf16_f32 v77, v78, v79
    ds_wrxchg_rtn_b64 v[72:73], v94, v[76:77] offset:65408
    s_waitcnt lgkmcnt(2)
    s_barrier
    s_setprio 3
    s_mov_b32 m0, s69
    s_nop 0
    ds_write_addtid_b32 v116 offset:32768
    ds_write_addtid_b32 v117 offset:33024
    ds_write_addtid_b32 v118 offset:33280
    ds_write_addtid_b32 v119 offset:33536
    buffer_load_dwordx4 v[116:119], v3, s[16:19], s40 offen offset:2048
    ds_write_addtid_b32 v120 offset:33792
    ds_write_addtid_b32 v121 offset:34048
    ds_write_addtid_b32 v122 offset:34304
    ds_write_addtid_b32 v123 offset:34560
    buffer_load_dwordx4 v[120:123], v3, s[16:19], s40 offen offset:3072
    v_mfma_f32_4x4x4_16b_bf16 v[80:83], v[8:9], v[102:103], 0
    v_mfma_f32_4x4x4_16b_bf16 v[76:79], v[8:9], v[100:101], 0
    v_bitop3_b32 v15, v6, v15, v46 bitop3:0xca
    v_bitop3_b32 v14, v6, v14, v47 bitop3:0xca
    v_cmp_lt_u32 s[84:85], v5, v92
    s_nop 0
    v_pk_mul_f32 v[80:81], v[80:81], v[14:15] op_sel:[0,1] op_sel_hi:[1,1]
    v_pk_mul_f32 v[82:83], v[82:83], v[14:15] op_sel:[0,1] op_sel_hi:[1,1]
    v_pk_mul_f32 v[76:77], v[76:77], v[14:15] op_sel:[0,0] op_sel_hi:[1,0]
    v_pk_mul_f32 v[78:79], v[78:79], v[14:15] op_sel:[0,0] op_sel_hi:[1,0]
    v_mov_b32 v44, v43
    s_cmp_gt_u32 s37, 1024
    s_cbranch_scc1 L2_xs108
    s_cmp_lg_u32 s43, 0
    s_cbranch_scc1 L2_xa108
L2_xb108:
    v_lshlrev_b32 v89, 16, v96
    v_add_u32 v90, 60, v97
    v_bitop3_b32 v90, v89, v45, v90 bitop3:0x6a
    ds_write_b32 v98, v90 offset:12
    v_lshlrev_b32 v89, 20, v96
    v_add_u32 v90, 40, v97
    v_bitop3_b32 v90, v89, v45, v90 bitop3:0x6a
    ds_write_b32 v98, v90 offset:8
    v_lshlrev_b32 v89, 24, v96
    v_add_u32 v90, 20, v97
    v_bitop3_b32 v90, v89, v45, v90 bitop3:0x6a
    ds_write_b32 v98, v90 offset:4
    v_lshlrev_b32 v89, 28, v96
    v_bitop3_b32 v90, v89, v45, v97 bitop3:0x6a
    ds_write_b32 v98, v90 offset:0
    v_mov_b32_dpp v91, v66 quad_perm:[1,1,1,1] row_mask:0xf bank_mask:0xf
    v_and_b32 v89, 3, v91
    v_and_b32 v97, 0xfffc, v91
    v_sub_u16_dpp v88, v66, v91 quad_perm:[3,3,3,3] row_mask:0xf bank_mask:0xf
    v_mad_u32_u24 v97, v97, 5, v4
    v_add_u32 v99, v88, v89
    v_bfm_b32 v96, v88, v89
    v_cmp_lt_u32 s[58:59], 16, v99
    v_lshlrev_b32 v89, v1, v96
    v_and_b32 v89, v45, v89
    v_cmp_ne_u32 vcc, 0, v89
    v_xor_b32 v90, v97, v89
    s_add_u32 s3, s37, s38
    v_mbcnt_lo_u32_b32 v98, vcc_lo, 0
    v_mbcnt_hi_u32_b32 v98, vcc_hi, v98
    s_bcnt1_i32_b64 s41, vcc
    v_lshl_add_u32 v98, v98, 2, s3
    s_mov_b64 exec, vcc
    ds_write_b32 v98, v90
    s_mov_b64 exec, -1
    s_lshl2_add_u32 s37, s41, s37
    s_cmp_lg_u64 s[58:59], 0
    s_cbranch_scc1 L2_xe108
L2_xr108:
    v_add_u32 v98, s37, v0
    v_mov_b32 v90, -1
    ds_write_b32 v98, v90
    ds_read2st64_b32 v[40:41], v0 offset0:0 offset1:1
    ds_read2st64_b32 v[42:43], v0 offset0:2 offset1:3
    s_sub_u32 s3, s37, 768
    s_cmp_gt_u32 s3, 256
    s_cbranch_scc1 L2_xf108
L2_xg108:
    v_lshrrev_b64 v[64:65], 16, v[64:65]
    v_lshrrev_b64 v[66:67], 16, v[66:67]
    s_setprio 2
    ds_write_addtid_b32 v124 offset:34816
    ds_write_addtid_b32 v125 offset:35072
    ds_write_addtid_b32 v126 offset:35328
    ds_write_addtid_b32 v127 offset:35584
    s_add_u32 s3, s40, 4096
    buffer_load_dwordx4 v[124:127], v3, s[16:19], s3 offen
    s_waitcnt lgkmcnt(14)
    v_cmpx_ne_u64 vcc, v[74:75], v[70:71]
    s_and_b64 s[82:83], vcc, s[80:81]
    s_cbranch_scc1 L2_c109
L2_d109:
    v_mov_b64 v[84:85], v[70:71]
    v_mov_b32 v7, v95
    v_mov_b64 v[86:87], v[74:75]
    s_mov_b64 exec, -1
    s_or_b64 s[80:81], s[80:81], vcc
    v_cmpx_ne_u64 vcc, v[72:73], v[68:69]
    s_and_b64 s[82:83], vcc, s[80:81]
    s_cbranch_scc1 L2_c110
L2_d110:
    v_mov_b64 v[84:85], v[68:69]
    v_mov_b32 v7, v94
    v_mov_b64 v[86:87], v[72:73]
    s_mov_b64 exec, -1
    s_or_b64 s[80:81], s[80:81], vcc
    ds_read_b64 v[70:71], v93 offset:65408
    s_and_b64 exec, s[84:85], s[80:81]
    v_mfma_f32_4x4x4_16b_bf16 v[76:79], v[12:13], v[84:85], 0
    v_mov_b32 v92, v7
    s_andn2_b64 s[80:81], s[80:81], s[84:85]
    v_mfma_f32_4x4x4_16b_bf16 v[76:79], v[10:11], v[86:87], v[76:79]
    s_mov_b64 exec, -1
    ds_read_b64 v[68:69], v92 offset:65408
    s_setprio 1
    s_waitcnt vmcnt(10)
    s_mov_b32 m0, s38
    s_nop 0
    ds_write_addtid_b32 v108 offset:0
    ds_write_addtid_b32 v109 offset:256
    ds_write_addtid_b32 v110 offset:512
    ds_write_addtid_b32 v111 offset:768
    s_waitcnt lgkmcnt(4)
    v_mfma_f32_4x4x4_16b_bf16 v[80:83], v[10:11], v[70:71], v[80:83]
    v_mfma_f32_4x4x4_16b_bf16 v[76:79], v[10:11], v[68:69], v[76:79]
    v_and_b32 v46, 0x40000000, v39
    v_bitop3_b32 v94, v36, v5, v46 bitop3:0xea
    v_and_b32 v46, 0x80000000, v39
    v_bitop3_b32 v95, v37, v5, v46 bitop3:0xea
    v_perm_b32 v15, v37, v38, s47
    v_bitop3_b32 v46, v37, 0.5, -0.5 bitop3:0xa8
    v_perm_b32 v14, v36, v38, s46
    v_bitop3_b32 v47, v36, 0.5, -0.5 bitop3:0xa8
    v_cvt_pk_bf16_f32 v80, v80, v81
    v_cvt_pk_bf16_f32 v81, v82, v83
    ds_wrxchg_rtn_b64 v[74:75], v93, v[80:81] offset:65408
    v_cvt_pk_bf16_f32 v76, v76, v77
    v_cvt_pk_bf16_f32 v77, v78, v79
    ds_wrxchg_rtn_b64 v[72:73], v92, v[76:77] offset:65408
    s_setprio 0
    s_waitcnt vmcnt(7)
    ds_write_addtid_b32 v112 offset:1024
    ds_write_addtid_b32 v113 offset:1280
    ds_write_addtid_b32 v114 offset:1536
    ds_write_addtid_b32 v115 offset:1792
    v_mfma_f32_4x4x4_16b_bf16 v[80:83], v[8:9], v[106:107], 0
    v_mfma_f32_4x4x4_16b_bf16 v[76:79], v[8:9], v[104:105], 0
    v_bitop3_b32 v15, v6, v15, v46 bitop3:0xca
    v_bitop3_b32 v14, v6, v14, v47 bitop3:0xca
    s_nop 1
    v_pk_mul_f32 v[80:81], v[80:81], v[14:15] op_sel:[0,1] op_sel_hi:[1,1]
    v_pk_mul_f32 v[82:83], v[82:83], v[14:15] op_sel:[0,1] op_sel_hi:[1,1]
    v_pk_mul_f32 v[76:77], v[76:77], v[14:15] op_sel:[0,0] op_sel_hi:[1,0]
    v_pk_mul_f32 v[78:79], v[78:79], v[14:15] op_sel:[0,0] op_sel_hi:[1,0]
    s_add_u32 s42, s42, 1
    s_waitcnt lgkmcnt(0)
    s_cmp_lg_u32 s42, 14
    s_cbranch_scc1 L2_loop
    s_barrier
    s_bitcmp1_b32 s36, s42
    s_cbranch_scc1 L2_slow
L2_ret6:
    s_setprio 3
    v_and_b32 v47, 0x0fffffff, v44
    v_mov_b32 v39, v44
    buffer_load_dwordx4 v[34:37], v47, s[8:11], 0 offen
    buffer_load_dwordx3 v[36:38], v47, s[8:11], 0 offen offset:8
    v_cmpx_ne_u64 vcc, v[74:75], v[70:71]
    s_and_b64 s[82:83], vcc, s[80:81]
    s_cbranch_scc1 L2_c111
L2_d111:
    v_mov_b64 v[84:85], v[70:71]
    v_mov_b32 v7, v93
    v_mov_b64 v[86:87], v[74:75]
    s_mov_b64 exec, -1
    s_or_b64 s[80:81], s[80:81], vcc
    v_cmpx_ne_u64 vcc, v[72:73], v[68:69]
    s_and_b64 s[82:83], vcc, s[80:81]
    s_cbranch_scc1 L2_c112
L2_d112:
    v_mov_b64 v[84:85], v[68:69]
    v_mov_b32 v7, v92
    v_mov_b64 v[86:87], v[72:73]
    s_mov_b64 exec, -1
    s_or_b64 s[80:81], s[80:81], vcc
    ds_read_b64 v[70:71], v95 offset:65408
    ds_read_b64 v[68:69], v94 offset:65408
    v_and_b32 v46, 0x20000000, v21
    v_lshrrev_b32 v47, 14, v17
    v_bitop3_b32 v47, v47, v5, v46 bitop3:0xea
    ds_read_b64 v[102:103], v47
    v_bitop3_b32 v93, v17, v5, v46 bitop3:0xea
    v_and_b32 v46, 0x10000000, v21
    v_lshrrev_b32 v47, 14, v16
    v_bitop3_b32 v47, v47, v5, v46 bitop3:0xea
    ds_read_b64 v[100:101], v47
    v_bitop3_b32 v92, v16, v5, v46 bitop3:0xea
    s_waitcnt lgkmcnt(2)
    v_mfma_f32_4x4x4_16b_bf16 v[80:83], v[10:11], v[70:71], v[80:83]
    v_mfma_f32_4x4x4_16b_bf16 v[76:79], v[10:11], v[68:69], v[76:79]
    v_perm_b32 v15, v17, v20, s45
    v_bitop3_b32 v46, v17, 0.5, -0.5 bitop3:0xa8
    v_perm_b32 v14, v16, v20, s44
    v_bitop3_b32 v47, v16, 0.5, -0.5 bitop3:0xa8
    v_cvt_pk_bf16_f32 v80, v80, v81
    v_cvt_pk_bf16_f32 v81, v82, v83
    ds_wrxchg_rtn_b64 v[74:75], v95, v[80:81] offset:65408
    v_cvt_pk_bf16_f32 v76, v76, v77
    v_cvt_pk_bf16_f32 v77, v78, v79
    ds_wrxchg_rtn_b64 v[72:73], v94, v[76:77] offset:65408
    s_waitcnt lgkmcnt(2)
    v_mfma_f32_4x4x4_16b_bf16 v[80:83], v[8:9], v[102:103], 0
    v_mfma_f32_4x4x4_16b_bf16 v[76:79], v[8:9], v[100:101], 0
    v_bitop3_b32 v15, v6, v15, v46 bitop3:0xca
    v_bitop3_b32 v14, v6, v14, v47 bitop3:0xca
    v_cmp_lt_u32 s[84:85], v5, v92
    s_nop 0
    v_pk_mul_f32 v[80:81], v[80:81], v[14:15] op_sel:[0,1] op_sel_hi:[1,1]
    v_pk_mul_f32 v[82:83], v[82:83], v[14:15] op_sel:[0,1] op_sel_hi:[1,1]
    v_pk_mul_f32 v[76:77], v[76:77], v[14:15] op_sel:[0,0] op_sel_hi:[1,0]
    v_pk_mul_f32 v[78:79], v[78:79], v[14:15] op_sel:[0,0] op_sel_hi:[1,0]
    buffer_load_dwordx4 v[108:111], v3, s[16:19], s40 offen offset:0
    s_waitcnt lgkmcnt(0)
    v_cmpx_ne_u64 vcc, v[74:75], v[70:71]
    s_and_b64 s[82:83], vcc, s[80:81]
    s_cbranch_scc1 L2_c113
L2_d113:
    v_mov_b64 v[84:85], v[70:71]
    v_mov_b32 v7, v95
    v_mov_b64 v[86:87], v[74:75]
    s_mov_b64 exec, -1
    s_or_b64 s[80:81], s[80:81], vcc
    v_cmpx_ne_u64 vcc, v[72:73], v[68:69]
    s_and_b64 s[82:83], vcc, s[80:81]
    s_cbranch_scc1 L2_c114
L2_d114:
    v_mov_b64 v[84:85], v[68:69]
    v_mov_b32 v7, v94
    v_mov_b64 v[86:87], v[72:73]
    s_mov_b64 exec, -1
    s_or_b64 s[80:81], s[80:81], vcc
    ds_read_b64 v[70:71], v93 offset:65408
    s_and_b64 exec, s[84:85], s[80:81]
    v_mfma_f32_4x4x4_16b_bf16 v[76:79], v[12:13], v[84:85], 0
    v_mov_b32 v92, v7
    s_andn2_b64 s[80:81], s[80:81], s[84:85]
    v_mfma_f32_4x4x4_16b_bf16 v[76:79], v[10:11], v[86:87], v[76:79]
    s_mov_b64 exec, -1
    ds_read_b64 v[68:69], v92 offset:65408
    v_and_b32 v46, 0x80000000, v21
    v_lshrrev_b32 v47, 14, v19
    v_bitop3_b32 v47, v47, v5, v46 bitop3:0xea
    ds_read_b64 v[106:107], v47
    v_bitop3_b32 v95, v19, v5, v46 bitop3:0xea
    v_and_b32 v46, 0x40000000, v21
    v_lshrrev_b32 v47, 14, v18
    v_bitop3_b32 v47, v47, v5, v46 bitop3:0xea
    ds_read_b64 v[104:105], v47
    v_bitop3_b32 v94, v18, v5, v46 bitop3:0xea
    s_waitcnt lgkmcnt(2)
    v_mfma_f32_4x4x4_16b_bf16 v[80:83], v[10:11], v[70:71], v[80:83]
    v_mfma_f32_4x4x4_16b_bf16 v[76:79], v[10:11], v[68:69], v[76:79]
    v_perm_b32 v15, v19, v20, s47
    v_bitop3_b32 v46, v19, 0.5, -0.5 bitop3:0xa8
    v_perm_b32 v14, v18, v20, s46
    v_bitop3_b32 v47, v18, 0.5, -0.5 bitop3:0xa8
    v_cvt_pk_bf16_f32 v80, v80, v81
    v_cvt_pk_bf16_f32 v81, v82, v83
    ds_wrxchg_rtn_b64 v[74:75], v93, v[80:81] offset:65408
    v_cvt_pk_bf16_f32 v76, v76, v77
    v_cvt_pk_bf16_f32 v77, v78, v79
    ds_wrxchg_rtn_b64 v[72:73], v92, v[76:77] offset:65408
    s_setprio 2
    s_waitcnt lgkmcnt(2)
    v_mfma_f32_4x4x4_16b_bf16 v[80:83], v[8:9], v[106:107], 0
    v_mfma_f32_4x4x4_16b_bf16 v[76:79], v[8:9], v[104:105], 0
    v_bitop3_b32 v15, v6, v15, v46 bitop3:0xca
    v_bitop3_b32 v14, v6, v14, v47 bitop3:0xca
    s_nop 1
    v_pk_mul_f32 v[80:81], v[80:81], v[14:15] op_sel:[0,1] op_sel_hi:[1,1]
    v_pk_mul_f32 v[82:83], v[82:83], v[14:15] op_sel:[0,1] op_sel_hi:[1,1]
    v_pk_mul_f32 v[76:77], v[76:77], v[14:15] op_sel:[0,0] op_sel_hi:[1,0]
    v_pk_mul_f32 v[78:79], v[78:79], v[14:15] op_sel:[0,0] op_sel_hi:[1,0]
    v_and_b32 v47, 0x0fffffff, v40
    v_mov_b32 v21, v40
    buffer_load_dwordx4 v[16:19], v47, s[8:11], 0 offen
    buffer_load_dwordx3 v[18:20], v47, s[8:11], 0 offen offset:8
    s_waitcnt lgkmcnt(0)
    v_cmpx_ne_u64 vcc, v[74:75], v[70:71]
    s_and_b64 s[82:83], vcc, s[80:81]
    s_cbranch_scc1 L2_c115
L2_d115:
    v_mov_b64 v[84:85], v[70:71]
    v_mov_b32 v7, v93
    v_mov_b64 v[86:87], v[74:75]
    s_mov_b64 exec, -1
    s_or_b64 s[80:81], s[80:81], vcc
    v_cmpx_ne_u64 vcc, v[72:73], v[68:69]
    s_and_b64 s[82:83], vcc, s[80:81]
    s_cbranch_scc1 L2_c116
L2_d116:
    v_mov_b64 v[84:85], v[68:69]
    v_mov_b32 v7, v92
    v_mov_b64 v[86:87], v[72:73]
    s_mov_b64 exec, -1
    s_or_b64 s[80:81], s[80:81], vcc
    ds_read_b64 v[70:71], v95 offset:65408
    ds_read_b64 v[68:69], v94 offset:65408
    s_waitcnt vmcnt(10)
    v_and_b32 v46, 0x20000000, v27
    v_lshrrev_b32 v47, 14, v23
    v_bitop3_b32 v47, v47, v5, v46 bitop3:0xea
    ds_read_b64 v[102:103], v47
    v_bitop3_b32 v93, v23, v5, v46 bitop3:0xea
    v_and_b32 v46, 0x10000000, v27
    v_lshrrev_b32 v47, 14, v22
    v_bitop3_b32 v47, v47, v5, v46 bitop3:0xea
    ds_read_b64 v[100:101], v47
    v_bitop3_b32 v92, v22, v5, v46 bitop3:0xea
    s_waitcnt lgkmcnt(2)
    v_mfma_f32_4x4x4_16b_bf16 v[80:83], v[10:11], v[70:71], v[80:83]
    v_mfma_f32_4x4x4_16b_bf16 v[76:79], v[10:11], v[68:69], v[76:79]
    v_perm_b32 v15, v23, v26, s45
    v_bitop3_b32 v46, v23, 0.5, -0.5 bitop3:0xa8
    v_perm_b32 v14, v22, v26, s44
    v_bitop3_b32 v47, v22, 0.5, -0.5 bitop3:0xa8
    v_cvt_pk_bf16_f32 v80, v80, v81
    v_cvt_pk_bf16_f32 v81, v82, v83
    ds_wrxchg_rtn_b64 v[74:75], v95, v[80:81] offset:65408
    v_cvt_pk_bf16_f32 v76, v76, v77
    v_cvt_pk_bf16_f32 v77, v78, v79
    ds_wrxchg_rtn_b64 v[72:73], v94, v[76:77] offset:65408
    s_waitcnt lgkmcnt(2)
    v_mfma_f32_4x4x4_16b_bf16 v[80:83], v[8:9], v[102:103], 0
    v_mfma_f32_4x4x4_16b_bf16 v[76:79], v[8:9], v[100:101], 0
    v_bitop3_b32 v15, v6, v15, v46 bitop3:0xca
    v_bitop3_b32 v14, v6, v14, v47 bitop3:0xca
    v_cmp_lt_u32 s[84:85], v5, v92
    s_nop 0
    v_pk_mul_f32 v[80:81], v[80:81], v[14:15] op_sel:[0,1] op_sel_hi:[1,1]
    v_pk_mul_f32 v[82:83], v[82:83], v[14:15] op_sel:[0,1] op_sel_hi:[1,1]
    v_pk_mul_f32 v[76:77], v[76:77], v[14:15] op_sel:[0,0] op_sel_hi:[1,0]
    v_pk_mul_f32 v[78:79], v[78:79], v[14:15] op_sel:[0,0] op_sel_hi:[1,0]
    buffer_load_dwordx4 v[112:115], v3, s[16:19], s40 offen offset:1024
    s_waitcnt lgkmcnt(0)
    v_cmpx_ne_u64 vcc, v[74:75], v[70:71]
    s_and_b64 s[82:83], vcc, s[80:81]
    s_cbranch_scc1 L2_c117
L2_d117:
    v_mov_b64 v[84:85], v[70:71]
    v_mov_b32 v7, v95
    v_mov_b64 v[86:87], v[74:75]
    s_mov_b64 exec, -1
    s_or_b64 s[80:81], s[80:81], vcc
    v_cmpx_ne_u64 vcc, v[72:73], v[68:69]
    s_and_b64 s[82:83], vcc, s[80:81]
    s_cbranch_scc1 L2_c118
L2_d118:
    v_mov_b64 v[84:85], v[68:69]
    v_mov_b32 v7, v94
    v_mov_b64 v[86:87], v[72:73]
    s_mov_b64 exec, -1
    s_or_b64 s[80:81], s[80:81], vcc
    ds_read_b64 v[70:71], v93 offset:65408
    s_and_b64 exec, s[84:85], s[80:81]
    v_mfma_f32_4x4x4_16b_bf16 v[76:79], v[12:13], v[84:85], 0
    v_mov_b32 v92, v7
    s_andn2_b64 s[80:81], s[80:81], s[84:85]
    v_mfma_f32_4x4x4_16b_bf16 v[76:79], v[10:11], v[86:87], v[76:79]
    s_mov_b64 exec, -1
    ds_read_b64 v[68:69], v92 offset:65408
    v_and_b32 v46, 0x80000000, v27
    v_lshrrev_b32 v47, 14, v25
    v_bitop3_b32 v47, v47, v5, v46 bitop3:0xea
    ds_read_b64 v[106:107], v47
    v_bitop3_b32 v95, v25, v5, v46 bitop3:0xea
    v_and_b32 v46, 0x40000000, v27
    v_lshrrev_b32 v47, 14, v24
    v_bitop3_b32 v47, v47, v5, v46 bitop3:0xea
    ds_read_b64 v[104:105], v47
    v_bitop3_b32 v94, v24, v5, v46 bitop3:0xea
    s_waitcnt lgkmcnt(2)
    v_mfma_f32_4x4x4_16b_bf16 v[80:83], v[10:11], v[70:71], v[80:83]
    v_mfma_f32_4x4x4_16b_bf16 v[76:79], v[10:11], v[68:69], v[76:79]
    v_perm_b32 v15, v25, v26, s47
    v_bitop3_b32 v46, v25, 0.5, -0.5 bitop3:0xa8
    v_perm_b32 v14, v24, v26, s46
    v_bitop3_b32 v47, v24, 0.5, -0.5 bitop3:0xa8
    v_cvt_pk_bf16_f32 v80, v80, v81
    v_cvt_pk_bf16_f32 v81, v82, v83
    ds_wrxchg_rtn_b64 v[74:75], v93, v[80:81] offset:65408
    v_cvt_pk_bf16_f32 v76, v76, v77
    v_cvt_pk_bf16_f32 v77, v78, v79
    ds_wrxchg_rtn_b64 v[72:73], v92, v[76:77] offset:65408
    s_setprio 1
    s_waitcnt lgkmcnt(2)
    v_mfma_f32_4x4x4_16b_bf16 v[80:83], v[8:9], v[106:107], 0
    v_mfma_f32_4x4x4_16b_bf16 v[76:79], v[8:9], v[104:105], 0
    v_bitop3_b32 v15, v6, v15, v46 bitop3:0xca
    v_bitop3_b32 v14, v6, v14, v47 bitop3:0xca
    s_nop 1
    v_pk_mul_f32 v[80:81], v[80:81], v[14:15] op_sel:[0,1] op_sel_hi:[1,1]
    v_pk_mul_f32 v[82:83], v[82:83], v[14:15] op_sel:[0,1] op_sel_hi:[1,1]
    v_pk_mul_f32 v[76:77], v[76:77], v[14:15] op_sel:[0,0] op_sel_hi:[1,0]
    v_pk_mul_f32 v[78:79], v[78:79], v[14:15] op_sel:[0,0] op_sel_hi:[1,0]
    v_and_b32 v47, 0x0fffffff, v41
    v_mov_b32 v27, v41
    buffer_load_dwordx4 v[22:25], v47, s[8:11], 0 offen
    buffer_load_dwordx3 v[24:26], v47, s[8:11], 0 offen offset:8
    s_waitcnt lgkmcnt(0)
    v_cmpx_ne_u64 vcc, v[74:75], v[70:71]
    s_and_b64 s[82:83], vcc, s[80:81]
    s_cbranch_scc1 L2_c119
L2_d119:
    v_mov_b64 v[84:85], v[70:71]
    v_mov_b32 v7, v93
    v_mov_b64 v[86:87], v[74:75]
    s_mov_b64 exec, -1
    s_or_b64 s[80:81], s[80:81], vcc
    v_cmpx_ne_u64 vcc, v[72:73], v[68:69]
    s_and_b64 s[82:83], vcc, s[80:81]
    s_cbranch_scc1 L2_c120
L2_d120:
    v_mov_b64 v[84:85], v[68:69]
    v_mov_b32 v7, v92
    v_mov_b64 v[86:87], v[72:73]
    s_mov_b64 exec, -1
    s_or_b64 s[80:81], s[80:81], vcc
    ds_read_b64 v[70:71], v95 offset:65408
    ds_read_b64 v[68:69], v94 offset:65408
    s_waitcnt vmcnt(11)
    v_and_b32 v46, 0x20000000, v33
    v_lshrrev_b32 v47, 14, v29
    v_bitop3_b32 v47, v47, v5, v46 bitop3:0xea
    ds_read_b64 v[102:103], v47
    v_bitop3_b32 v93, v29, v5, v46 bitop3:0xea
    v_and_b32 v46, 0x10000000, v33
    v_lshrrev_b32 v47, 14, v28
    v_bitop3_b32 v47, v47, v5, v46 bitop3:0xea
    ds_read_b64 v[100:101], v47
    v_bitop3_b32 v92, v28, v5, v46 bitop3:0xea
    s_waitcnt lgkmcnt(2)
    v_mfma_f32_4x4x4_16b_bf16 v[80:83], v[10:11], v[70:71], v[80:83]
    v_mfma_f32_4x4x4_16b_bf16 v[76:79], v[10:11], v[68:69], v[76:79]
    v_perm_b32 v15, v29, v32, s45
    v_bitop3_b32 v46, v29, 0.5, -0.5 bitop3:0xa8
    v_perm_b32 v14, v28, v32, s44
    v_bitop3_b32 v47, v28, 0.5, -0.5 bitop3:0xa8
    v_cvt_pk_bf16_f32 v80, v80, v81
    v_cvt_pk_bf16_f32 v81, v82, v83
    ds_wrxchg_rtn_b64 v[74:75], v95, v[80:81] offset:65408
    v_cvt_pk_bf16_f32 v76, v76, v77
    v_cvt_pk_bf16_f32 v77, v78, v79
    ds_wrxchg_rtn_b64 v[72:73], v94, v[76:77] offset:65408
    s_waitcnt lgkmcnt(2)
    v_mfma_f32_4x4x4_16b_bf16 v[80:83], v[8:9], v[102:103], 0
    v_mfma_f32_4x4x4_16b_bf16 v[76:79], v[8:9], v[100:101], 0
    v_bitop3_b32 v15, v6, v15, v46 bitop3:0xca
    v_bitop3_b32 v14, v6, v14, v47 bitop3:0xca
    v_cmp_lt_u32 s[84:85], v5, v92
    s_nop 0
    v_pk_mul_f32 v[80:81], v[80:81], v[14:15] op_sel:[0,1] op_sel_hi:[1,1]
    v_pk_mul_f32 v[82:83], v[82:83], v[14:15] op_sel:[0,1] op_sel_hi:[1,1]
    v_pk_mul_f32 v[76:77], v[76:77], v[14:15] op_sel:[0,0] op_sel_hi:[1,0]
    v_pk_mul_f32 v[78:79], v[78:79], v[14:15] op_sel:[0,0] op_sel_hi:[1,0]
    s_waitcnt lgkmcnt(0)
    v_cmpx_ne_u64 vcc, v[74:75], v[70:71]
    s_and_b64 s[82:83], vcc, s[80:81]
    s_cbranch_scc1 L2_c121
L2_d121:
    v_mov_b64 v[84:85], v[70:71]
    v_mov_b32 v7, v95
    v_mov_b64 v[86:87], v[74:75]
    s_mov_b64 exec, -1
    s_or_b64 s[80:81], s[80:81], vcc
    v_cmpx_ne_u64 vcc, v[72:73], v[68:69]
    s_and_b64 s[82:83], vcc, s[80:81]
    s_cbranch_scc1 L2_c122
L2_d122:
    v_mov_b64 v[84:85], v[68:69]
    v_mov_b32 v7, v94
    v_mov_b64 v[86:87], v[72:73]
    s_mov_b64 exec, -1
    s_or_b64 s[80:81], s[80:81], vcc
    ds_read_b64 v[70:71], v93 offset:65408
    s_and_b64 exec, s[84:85], s[80:81]
    v_mfma_f32_4x4x4_16b_bf16 v[76:79], v[12:13], v[84:85], 0
    v_mov_b32 v92, v7
    s_andn2_b64 s[80:81], s[80:81], s[84:85]
    v_mfma_f32_4x4x4_16b_bf16 v[76:79], v[10:11], v[86:87], v[76:79]
    s_mov_b64 exec, -1
    ds_read_b64 v[68:69], v92 offset:65408
    v_and_b32 v46, 0x80000000, v33
    v_lshrrev_b32 v47, 14, v31
    v_bitop3_b32 v47, v47, v5, v46 bitop3:0xea
    ds_read_b64 v[106:107], v47
    v_bitop3_b32 v95, v31, v5, v46 bitop3:0xea
    v_and_b32 v46, 0x40000000, v33
    v_lshrrev_b32 v47, 14, v30
    v_bitop3_b32 v47, v47, v5, v46 bitop3:0xea
    ds_read_b64 v[104:105], v47
    v_bitop3_b32 v94, v30, v5, v46 bitop3:0xea
    s_waitcnt lgkmcnt(2)
    v_mfma_f32_4x4x4_16b_bf16 v[80:83], v[10:11], v[70:71], v[80:83]
    v_mfma_f32_4x4x4_16b_bf16 v[76:79], v[10:11], v[68:69], v[76:79]
    v_perm_b32 v15, v31, v32, s47
    v_bitop3_b32 v46, v31, 0.5, -0.5 bitop3:0xa8
    v_perm_b32 v14, v30, v32, s46
    v_bitop3_b32 v47, v30, 0.5, -0.5 bitop3:0xa8
    v_cvt_pk_bf16_f32 v80, v80, v81
    v_cvt_pk_bf16_f32 v81, v82, v83
    ds_wrxchg_rtn_b64 v[74:75], v93, v[80:81] offset:65408
    v_cvt_pk_bf16_f32 v76, v76, v77
    v_cvt_pk_bf16_f32 v77, v78, v79
    ds_wrxchg_rtn_b64 v[72:73], v92, v[76:77] offset:65408
    s_setprio 0
    s_waitcnt lgkmcnt(2)
    v_mfma_f32_4x4x4_16b_bf16 v[80:83], v[8:9], v[106:107], 0
    v_mfma_f32_4x4x4_16b_bf16 v[76:79], v[8:9], v[104:105], 0
    v_bitop3_b32 v15, v6, v15, v46 bitop3:0xca
    v_bitop3_b32 v14, v6, v14, v47 bitop3:0xca
    s_nop 1
    v_pk_mul_f32 v[80:81], v[80:81], v[14:15] op_sel:[0,1] op_sel_hi:[1,1]
    v_pk_mul_f32 v[82:83], v[82:83], v[14:15] op_sel:[0,1] op_sel_hi:[1,1]
    v_pk_mul_f32 v[76:77], v[76:77], v[14:15] op_sel:[0,0] op_sel_hi:[1,0]
    v_pk_mul_f32 v[78:79], v[78:79], v[14:15] op_sel:[0,0] op_sel_hi:[1,0]
    s_add_u32 s40, s40, 0xfff24000
    v_and_b32 v47, 0x0fffffff, v42
    v_mov_b32 v33, v42
    buffer_load_dwordx4 v[28:31], v47, s[8:11], 0 offen
    buffer_load_dwordx3 v[30:32], v47, s[8:11], 0 offen offset:8
    s_waitcnt lgkmcnt(0)
    v_cmpx_ne_u64 vcc, v[74:75], v[70:71]
    s_and_b64 s[82:83], vcc, s[80:81]
    s_cbranch_scc1 L2_c123
L2_d123:
    v_mov_b64 v[84:85], v[70:71]
    v_mov_b32 v7, v93
    v_mov_b64 v[86:87], v[74:75]
    s_mov_b64 exec, -1
    s_or_b64 s[80:81], s[80:81], vcc
    v_cmpx_ne_u64 vcc, v[72:73], v[68:69]
    s_and_b64 s[82:83], vcc, s[80:81]
    s_cbranch_scc1 L2_c124
L2_d124:
    v_mov_b64 v[84:85], v[68:69]
    v_mov_b32 v7, v92
    v_mov_b64 v[86:87], v[72:73]
    s_mov_b64 exec, -1
    s_or_b64 s[80:81], s[80:81], vcc
    ds_read_b64 v[70:71], v95 offset:65408
    ds_read_b64 v[68:69], v94 offset:65408
    s_waitcnt vmcnt(8)
    v_and_b32 v46, 0x20000000, v39
    v_lshrrev_b32 v47, 14, v35
    v_bitop3_b32 v47, v47, v5, v46 bitop3:0xea
    ds_read_b64 v[102:103], v47
    v_bitop3_b32 v93, v35, v5, v46 bitop3:0xea
    v_and_b32 v46, 0x10000000, v39
    v_lshrrev_b32 v47, 14, v34
    v_bitop3_b32 v47, v47, v5, v46 bitop3:0xea
    ds_read_b64 v[100:101], v47
    v_bitop3_b32 v92, v34, v5, v46 bitop3:0xea
    v_and_b32 v46, 0x80000000, v39
    v_lshrrev_b32 v47, 14, v37
    v_bitop3_b32 v47, v47, v5, v46 bitop3:0xea
    ds_read_b64 v[106:107], v47
    v_and_b32 v46, 0x40000000, v39
    v_lshrrev_b32 v47, 14, v36
    v_bitop3_b32 v47, v47, v5, v46 bitop3:0xea
    ds_read_b64 v[104:105], v47
    s_waitcnt lgkmcnt(4)
    v_mfma_f32_4x4x4_16b_bf16 v[80:83], v[10:11], v[70:71], v[80:83]
    v_mfma_f32_4x4x4_16b_bf16 v[76:79], v[10:11], v[68:69], v[76:79]
    v_perm_b32 v15, v35, v38, s45
    v_bitop3_b32 v46, v35, 0.5, -0.5 bitop3:0xa8
    v_perm_b32 v14, v34, v38, s44
    v_bitop3_b32 v47, v34, 0.5, -0.5 bitop3:0xa8
    v_cvt_pk_bf16_f32 v80, v80, v81
    v_cvt_pk_bf16_f32 v81, v82, v83
    ds_wrxchg_rtn_b64 v[74:75], v95, v[80:81] offset:65408
    v_cvt_pk_bf16_f32 v76, v76, v77
    v_cvt_pk_bf16_f32 v77, v78, v79
    ds_wrxchg_rtn_b64 v[72:73], v94, v[76:77] offset:65408
    s_waitcnt lgkmcnt(2)
    s_barrier
    s_setprio 3
    s_mov_b32 m0, s69
    s_nop 0
    ds_write_addtid_b32 v116 offset:32768
    ds_write_addtid_b32 v117 offset:33024
    ds_write_addtid_b32 v118 offset:33280
    ds_write_addtid_b32 v119 offset:33536
    ds_write_addtid_b32 v120 offset:33792
    ds_write_addtid_b32 v121 offset:34048
    ds_write_addtid_b32 v122 offset:34304
    ds_write_addtid_b32 v123 offset:34560
    v_mfma_f32_4x4x4_16b_bf16 v[80:83], v[8:9], v[102:103], 0
    v_mfma_f32_4x4x4_16b_bf16 v[76:79], v[8:9], v[100:101], 0
    v_bitop3_b32 v15, v6, v15, v46 bitop3:0xca
    v_bitop3_b32 v14, v6, v14, v47 bitop3:0xca
    v_cmp_lt_u32 s[84:85], v5, v92
    s_nop 0
    v_pk_mul_f32 v[80:81], v[80:81], v[14:15] op_sel:[0,1] op_sel_hi:[1,1]
    v_pk_mul_f32 v[82:83], v[82:83], v[14:15] op_sel:[0,1] op_sel_hi:[1,1]
    v_pk_mul_f32 v[76:77], v[76:77], v[14:15] op_sel:[0,0] op_sel_hi:[1,0]
    v_pk_mul_f32 v[78:79], v[78:79], v[14:15] op_sel:[0,0] op_sel_hi:[1,0]
    v_mov_b32 v44, v43
    s_setprio 2
    ds_write_addtid_b32 v124 offset:34816
    ds_write_addtid_b32 v125 offset:35072
    ds_write_addtid_b32 v126 offset:35328
    ds_write_addtid_b32 v127 offset:35584
    s_waitcnt lgkmcnt(12)
    v_cmpx_ne_u64 vcc, v[74:75], v[70:71]
    s_and_b64 s[82:83], vcc, s[80:81]
    s_cbranch_scc1 L2_c125
L2_d125:
    v_mov_b64 v[84:85], v[70:71]
    v_mov_b32 v7, v95
    v_mov_b64 v[86:87], v[74:75]
    s_mov_b64 exec, -1
    s_or_b64 s[80:81], s[80:81], vcc
    v_cmpx_ne_u64 vcc, v[72:73], v[68:69]
    s_and_b64 s[82:83], vcc, s[80:81]
    s_cbranch_scc1 L2_c126
L2_d126:
    v_mov_b64 v[84:85], v[68:69]
    v_mov_b32 v7, v94
    v_mov_b64 v[86:87], v[72:73]
    s_mov_b64 exec, -1
    s_or_b64 s[80:81], s[80:81], vcc
    ds_read_b64 v[70:71], v93 offset:65408
    s_and_b64 exec, s[84:85], s[80:81]
    v_mfma_f32_4x4x4_16b_bf16 v[76:79], v[12:13], v[84:85], 0
    v_mov_b32 v92, v7
    s_andn2_b64 s[80:81], s[80:81], s[84:85]
    v_mfma_f32_4x4x4_16b_bf16 v[76:79], v[10:11], v[86:87], v[76:79]
    s_mov_b64 exec, -1
    ds_read_b64 v[68:69], v92 offset:65408
    s_setprio 1
    s_waitcnt vmcnt(7)
    s_mov_b32 m0, s38
    s_nop 0
    ds_write_addtid_b32 v108 offset:0
    ds_write_addtid_b32 v109 offset:256
    ds_write_addtid_b32 v110 offset:512
    ds_write_addtid_b32 v111 offset:768
    s_waitcnt lgkmcnt(4)
    v_mfma_f32_4x4x4_16b_bf16 v[80:83], v[10:11], v[70:71], v[80:83]
    v_mfma_f32_4x4x4_16b_bf16 v[76:79], v[10:11], v[68:69], v[76:79]
    v_and_b32 v46, 0x40000000, v39
    v_bitop3_b32 v94, v36, v5, v46 bitop3:0xea
    v_and_b32 v46, 0x80000000, v39
    v_bitop3_b32 v95, v37, v5, v46 bitop3:0xea
    v_perm_b32 v15, v37, v38, s47
    v_bitop3_b32 v46, v37, 0.5, -0.5 bitop3:0xa8
    v_perm_b32 v14, v36, v38, s46
    v_bitop3_b32 v47, v36, 0.5, -0.5 bitop3:0xa8
    v_cvt_pk_bf16_f32 v80, v80, v81
    v_cvt_pk_bf16_f32 v81, v82, v83
    ds_wrxchg_rtn_b64 v[74:75], v93, v[80:81] offset:65408
    v_cvt_pk_bf16_f32 v76, v76, v77
    v_cvt_pk_bf16_f32 v77, v78, v79
    ds_wrxchg_rtn_b64 v[72:73], v92, v[76:77] offset:65408
    s_setprio 0
    s_waitcnt vmcnt(4)
    ds_write_addtid_b32 v112 offset:1024
    ds_write_addtid_b32 v113 offset:1280
    ds_write_addtid_b32 v114 offset:1536
    ds_write_addtid_b32 v115 offset:1792
    v_mfma_f32_4x4x4_16b_bf16 v[80:83], v[8:9], v[106:107], 0
    v_mfma_f32_4x4x4_16b_bf16 v[76:79], v[8:9], v[104:105], 0
    v_bitop3_b32 v15, v6, v15, v46 bitop3:0xca
    v_bitop3_b32 v14, v6, v14, v47 bitop3:0xca
    s_nop 1
    v_pk_mul_f32 v[80:81], v[80:81], v[14:15] op_sel:[0,1] op_sel_hi:[1,1]
    v_pk_mul_f32 v[82:83], v[82:83], v[14:15] op_sel:[0,1] op_sel_hi:[1,1]
    v_pk_mul_f32 v[76:77], v[76:77], v[14:15] op_sel:[0,0] op_sel_hi:[1,0]
    v_pk_mul_f32 v[78:79], v[78:79], v[14:15] op_sel:[0,0] op_sel_hi:[1,0]
    s_add_u32 s42, s42, 1
    s_waitcnt lgkmcnt(0)
    s_barrier
    s_bitcmp1_b32 s36, s42
    s_cbranch_scc1 L2_slow
L2_ret7:
    s_setprio 3
    v_and_b32 v47, 0x0fffffff, v44
    v_mov_b32 v39, v44
    buffer_load_dwordx4 v[34:37], v47, s[8:11], 0 offen
    buffer_load_dwordx3 v[36:38], v47, s[8:11], 0 offen offset:8
    v_cmpx_ne_u64 vcc, v[74:75], v[70:71]
    s_and_b64 s[82:83], vcc, s[80:81]
    s_cbranch_scc1 L2_c127
L2_d127:
    v_mov_b64 v[84:85], v[70:71]
    v_mov_b32 v7, v93
    v_mov_b64 v[86:87], v[74:75]
    s_mov_b64 exec, -1
    s_or_b64 s[80:81], s[80:81], vcc
    v_cmpx_ne_u64 vcc, v[72:73], v[68:69]
    s_and_b64 s[82:83], vcc, s[80:81]
    s_cbranch_scc1 L2_c128
L2_d128:
    v_mov_b64 v[84:85], v[68:69]
    v_mov_b32 v7, v92
    v_mov_b64 v[86:87], v[72:73]
    s_mov_b64 exec, -1
    s_or_b64 s[80:81], s[80:81], vcc
    ds_read_b64 v[70:71], v95 offset:65408
    ds_read_b64 v[68:69], v94 offset:65408
    v_and_b32 v46, 0x20000000, v21
    v_lshrrev_b32 v47, 14, v17
    v_bitop3_b32 v47, v47, v5, v46 bitop3:0xea
    ds_read_b64 v[102:103], v47
    v_bitop3_b32 v93, v17, v5, v46 bitop3:0xea
    v_and_b32 v46, 0x10000000, v21
    v_lshrrev_b32 v47, 14, v16
    v_bitop3_b32 v47, v47, v5, v46 bitop3:0xea
    ds_read_b64 v[100:101], v47
    v_bitop3_b32 v92, v16, v5, v46 bitop3:0xea
    s_waitcnt lgkmcnt(2)
    v_mfma_f32_4x4x4_16b_bf16 v[80:83], v[10:11], v[70:71], v[80:83]
    v_mfma_f32_4x4x4_16b_bf16 v[76:79], v[10:11], v[68:69], v[76:79]
    v_perm_b32 v15, v17, v20, s45
    v_bitop3_b32 v46, v17, 0.5, -0.5 bitop3:0xa8
    v_perm_b32 v14, v16, v20, s44
    v_bitop3_b32 v47, v16, 0.5, -0.5 bitop3:0xa8
    v_cvt_pk_bf16_f32 v80, v80, v81
    v_cvt_pk_bf16_f32 v81, v82, v83
    ds_wrxchg_rtn_b64 v[74:75], v95, v[80:81] offset:65408
    v_cvt_pk_bf16_f32 v76, v76, v77
    v_cvt_pk_bf16_f32 v77, v78, v79
    ds_wrxchg_rtn_b64 v[72:73], v94, v[76:77] offset:65408
    s_waitcnt lgkmcnt(2)
    v_mfma_f32_4x4x4_16b_bf16 v[80:83], v[8:9], v[102:103], 0
    v_mfma_f32_4x4x4_16b_bf16 v[76:79], v[8:9], v[100:101], 0
    v_bitop3_b32 v15, v6, v15, v46 bitop3:0xca
    v_bitop3_b32 v14, v6, v14, v47 bitop3:0xca
    v_cmp_lt_u32 s[84:85], v5, v92
    s_nop 0
    v_pk_mul_f32 v[80:81], v[80:81], v[14:15] op_sel:[0,1] op_sel_hi:[1,1]
    v_pk_mul_f32 v[82:83], v[82:83], v[14:15] op_sel:[0,1] op_sel_hi:[1,1]
    v_pk_mul_f32 v[76:77], v[76:77], v[14:15] op_sel:[0,0] op_sel_hi:[1,0]
    v_pk_mul_f32 v[78:79], v[78:79], v[14:15] op_sel:[0,0] op_sel_hi:[1,0]
    s_waitcnt lgkmcnt(0)
    v_cmpx_ne_u64 vcc, v[74:75], v[70:71]
    s_and_b64 s[82:83], vcc, s[80:81]
    s_cbranch_scc1 L2_c129
L2_d129:
    v_mov_b64 v[84:85], v[70:71]
    v_mov_b32 v7, v95
    v_mov_b64 v[86:87], v[74:75]
    s_mov_b64 exec, -1
    s_or_b64 s[80:81], s[80:81], vcc
    v_cmpx_ne_u64 vcc, v[72:73], v[68:69]
    s_and_b64 s[82:83], vcc, s[80:81]
    s_cbranch_scc1 L2_c130
L2_d130:
    v_mov_b64 v[84:85], v[68:69]
    v_mov_b32 v7, v94
    v_mov_b64 v[86:87], v[72:73]
    s_mov_b64 exec, -1
    s_or_b64 s[80:81], s[80:81], vcc
    ds_read_b64 v[70:71], v93 offset:65408
    s_and_b64 exec, s[84:85], s[80:81]
    v_mfma_f32_4x4x4_16b_bf16 v[76:79], v[12:13], v[84:85], 0
    v_mov_b32 v92, v7
    s_andn2_b64 s[80:81], s[80:81], s[84:85]
    v_mfma_f32_4x4x4_16b_bf16 v[76:79], v[10:11], v[86:87], v[76:79]
    s_mov_b64 exec, -1
    ds_read_b64 v[68:69], v92 offset:65408
    v_and_b32 v46, 0x80000000, v21
    v_lshrrev_b32 v47, 14, v19
    v_bitop3_b32 v47, v47, v5, v46 bitop3:0xea
    ds_read_b64 v[106:107], v47
    v_bitop3_b32 v95, v19, v5, v46 bitop3:0xea
    v_and_b32 v46, 0x40000000, v21
    v_lshrrev_b32 v47, 14, v18
    v_bitop3_b32 v47, v47, v5, v46 bitop3:0xea
    ds_read_b64 v[104:105], v47
    v_bitop3_b32 v94, v18, v5, v46 bitop3:0xea
    s_waitcnt lgkmcnt(2)
    v_mfma_f32_4x4x4_16b_bf16 v[80:83], v[10:11], v[70:71], v[80:83]
    v_mfma_f32_4x4x4_16b_bf16 v[76:79], v[10:11], v[68:69], v[76:79]
    v_perm_b32 v15, v19, v20, s47
    v_bitop3_b32 v46, v19, 0.5, -0.5 bitop3:0xa8
    v_perm_b32 v14, v18, v20, s46
    v_bitop3_b32 v47, v18, 0.5, -0.5 bitop3:0xa8
    v_cvt_pk_bf16_f32 v80, v80, v81
    v_cvt_pk_bf16_f32 v81, v82, v83
    ds_wrxchg_rtn_b64 v[74:75], v93, v[80:81] offset:65408
    v_cvt_pk_bf16_f32 v76, v76, v77
    v_cvt_pk_bf16_f32 v77, v78, v79
    ds_wrxchg_rtn_b64 v[72:73], v92, v[76:77] offset:65408
    s_setprio 2
    s_waitcnt lgkmcnt(2)
    v_mfma_f32_4x4x4_16b_bf16 v[80:83], v[8:9], v[106:107], 0
    v_mfma_f32_4x4x4_16b_bf16 v[76:79], v[8:9], v[104:105], 0
    v_bitop3_b32 v15, v6, v15, v46 bitop3:0xca
    v_bitop3_b32 v14, v6, v14, v47 bitop3:0xca
    s_nop 1
    v_pk_mul_f32 v[80:81], v[80:81], v[14:15] op_sel:[0,1] op_sel_hi:[1,1]
    v_pk_mul_f32 v[82:83], v[82:83], v[14:15] op_sel:[0,1] op_sel_hi:[1,1]
    v_pk_mul_f32 v[76:77], v[76:77], v[14:15] op_sel:[0,0] op_sel_hi:[1,0]
    v_pk_mul_f32 v[78:79], v[78:79], v[14:15] op_sel:[0,0] op_sel_hi:[1,0]
    s_lshl_b32 s3, s32, 12
    v_subrev_u32 v122, s3, v3
    s_mul_i32 s3, s33, 20000
    v_add_u32 v118, s3, v122
    v_add_u32 v119, 0x4000, v118
    s_lshl_b32 s3, s34, 7
    v_lshrrev_b32 v123, 7, v118
    v_and_b32 v120, 0x70, v118
    v_lshl_add_u32 v120, v123, 13, v120
    v_add_u32 v120, s3, v120
    v_lshrrev_b32 v123, 7, v119
    v_and_b32 v121, 0x70, v119
    v_lshl_add_u32 v121, v123, 13, v121
    v_add_u32 v121, s3, v121
    v_cmp_le_u32 vcc, 3616, v122
    s_mov_b64 exec, vcc
    v_mov_b32 v119, 2.0
    v_mov_b32 v121, 2.0
    s_mov_b64 exec, -1
    v_and_b32 v123, 0x30, v122
    v_lshlrev_b32 v123, 2, v123
    buffer_load_dwordx4 v[48:51], v123, s[24:27], 0 offen
    buffer_load_dwordx4 v[52:55], v123, s[24:27], 0 offen offset:16
    buffer_load_dwordx2 v[56:57], v123, s[24:27], 0 offen offset:32
    s_mov_b32 s12, s4
    s_mov_b32 s13, s5
    s_mov_b32 s14, 0x138800
    s_mov_b32 s15, 0x20000
    s_mov_b32 s16, s28
    s_mov_b32 s17, s29
    s_mov_b32 s18, 0x4e2000
    s_mov_b32 s19, 0x20000
    v_lshrrev_b32 v123, 2, v120
    buffer_load_dword v116, v123, s[12:15], 0 offen
    buffer_load_dwordx4 v[108:111], v120, s[16:19], 0 offen
    v_lshrrev_b32 v123, 2, v121
    buffer_load_dword v117, v123, s[12:15], 0 offen
    buffer_load_dwordx4 v[112:115], v121, s[16:19], 0 offen
    s_waitcnt lgkmcnt(0)
    v_cmpx_ne_u64 vcc, v[74:75], v[70:71]
    s_and_b64 s[82:83], vcc, s[80:81]
    s_cbranch_scc1 L2_c131
L2_d131:
    v_mov_b64 v[84:85], v[70:71]
    v_mov_b32 v7, v93
    v_mov_b64 v[86:87], v[74:75]
    s_mov_b64 exec, -1
    s_or_b64 s[80:81], s[80:81], vcc
    v_cmpx_ne_u64 vcc, v[72:73], v[68:69]
    s_and_b64 s[82:83], vcc, s[80:81]
    s_cbranch_scc1 L2_c132
L2_d132:
    v_mov_b64 v[84:85], v[68:69]
    v_mov_b32 v7, v92
    v_mov_b64 v[86:87], v[72:73]
    s_mov_b64 exec, -1
    s_or_b64 s[80:81], s[80:81], vcc
    ds_read_b64 v[70:71], v95 offset:65408
    ds_read_b64 v[68:69], v94 offset:65408
    s_waitcnt vmcnt(11)
    v_and_b32 v46, 0x20000000, v27
    v_lshrrev_b32 v47, 14, v23
    v_bitop3_b32 v47, v47, v5, v46 bitop3:0xea
    ds_read_b64 v[102:103], v47
    v_bitop3_b32 v93, v23, v5, v46 bitop3:0xea
    v_and_b32 v46, 0x10000000, v27
    v_lshrrev_b32 v47, 14, v22
    v_bitop3_b32 v47, v47, v5, v46 bitop3:0xea
    ds_read_b64 v[100:101], v47
    v_bitop3_b32 v92, v22, v5, v46 bitop3:0xea
    s_waitcnt lgkmcnt(2)
    v_mfma_f32_4x4x4_16b_bf16 v[80:83], v[10:11], v[70:71], v[80:83]
    v_mfma_f32_4x4x4_16b_bf16 v[76:79], v[10:11], v[68:69], v[76:79]
    v_perm_b32 v15, v23, v26, s45
    v_bitop3_b32 v46, v23, 0.5, -0.5 bitop3:0xa8
    v_perm_b32 v14, v22, v26, s44
    v_bitop3_b32 v47, v22, 0.5, -0.5 bitop3:0xa8
    v_cvt_pk_bf16_f32 v80, v80, v81
    v_cvt_pk_bf16_f32 v81, v82, v83
    ds_wrxchg_rtn_b64 v[74:75], v95, v[80:81] offset:65408
    v_cvt_pk_bf16_f32 v76, v76, v77
    v_cvt_pk_bf16_f32 v77, v78, v79
    ds_wrxchg_rtn_b64 v[72:73], v94, v[76:77] offset:65408
    s_waitcnt lgkmcnt(2)
    v_mfma_f32_4x4x4_16b_bf16 v[80:83], v[8:9], v[102:103], 0
    v_mfma_f32_4x4x4_16b_bf16 v[76:79], v[8:9], v[100:101], 0
    v_bitop3_b32 v15, v6, v15, v46 bitop3:0xca
    v_bitop3_b32 v14, v6, v14, v47 bitop3:0xca
    v_cmp_lt_u32 s[84:85], v5, v92
    s_nop 0
    v_pk_mul_f32 v[80:81], v[80:81], v[14:15] op_sel:[0,1] op_sel_hi:[1,1]
    v_pk_mul_f32 v[82:83], v[82:83], v[14:15] op_sel:[0,1] op_sel_hi:[1,1]
    v_pk_mul_f32 v[76:77], v[76:77], v[14:15] op_sel:[0,0] op_sel_hi:[1,0]
    v_pk_mul_f32 v[78:79], v[78:79], v[14:15] op_sel:[0,0] op_sel_hi:[1,0]
    s_waitcnt lgkmcnt(0)
    v_cmpx_ne_u64 vcc, v[74:75], v[70:71]
    s_and_b64 s[82:83], vcc, s[80:81]
    s_cbranch_scc1 L2_c133
L2_d133:
    v_mov_b64 v[84:85], v[70:71]
    v_mov_b32 v7, v95
    v_mov_b64 v[86:87], v[74:75]
    s_mov_b64 exec, -1
    s_or_b64 s[80:81], s[80:81], vcc
    v_cmpx_ne_u64 vcc, v[72:73], v[68:69]
    s_and_b64 s[82:83], vcc, s[80:81]
    s_cbranch_scc1 L2_c134
L2_d134:
    v_mov_b64 v[84:85], v[68:69]
    v_mov_b32 v7, v94
    v_mov_b64 v[86:87], v[72:73]
    s_mov_b64 exec, -1
    s_or_b64 s[80:81], s[80:81], vcc
    ds_read_b64 v[70:71], v93 offset:65408
    s_and_b64 exec, s[84:85], s[80:81]
    v_mfma_f32_4x4x4_16b_bf16 v[76:79], v[12:13], v[84:85], 0
    v_mov_b32 v92, v7
    s_andn2_b64 s[80:81], s[80:81], s[84:85]
    v_mfma_f32_4x4x4_16b_bf16 v[76:79], v[10:11], v[86:87], v[76:79]
    s_mov_b64 exec, -1
    ds_read_b64 v[68:69], v92 offset:65408
    v_and_b32 v46, 0x80000000, v27
    v_lshrrev_b32 v47, 14, v25
    v_bitop3_b32 v47, v47, v5, v46 bitop3:0xea
    ds_read_b64 v[106:107], v47
    v_bitop3_b32 v95, v25, v5, v46 bitop3:0xea
    v_and_b32 v46, 0x40000000, v27
    v_lshrrev_b32 v47, 14, v24
    v_bitop3_b32 v47, v47, v5, v46 bitop3:0xea
    ds_read_b64 v[104:105], v47
    v_bitop3_b32 v94, v24, v5, v46 bitop3:0xea
    s_waitcnt lgkmcnt(2)
    v_mfma_f32_4x4x4_16b_bf16 v[80:83], v[10:11], v[70:71], v[80:83]
    v_mfma_f32_4x4x4_16b_bf16 v[76:79], v[10:11], v[68:69], v[76:79]
    v_perm_b32 v15, v25, v26, s47
    v_bitop3_b32 v46, v25, 0.5, -0.5 bitop3:0xa8
    v_perm_b32 v14, v24, v26, s46
    v_bitop3_b32 v47, v24, 0.5, -0.5 bitop3:0xa8
    v_cvt_pk_bf16_f32 v80, v80, v81
    v_cvt_pk_bf16_f32 v81, v82, v83
    ds_wrxchg_rtn_b64 v[74:75], v93, v[80:81] offset:65408
    v_cvt_pk_bf16_f32 v76, v76, v77
    v_cvt_pk_bf16_f32 v77, v78, v79
    ds_wrxchg_rtn_b64 v[72:73], v92, v[76:77] offset:65408
    s_setprio 1
    s_waitcnt lgkmcnt(2)
    v_mfma_f32_4x4x4_16b_bf16 v[80:83], v[8:9], v[106:107], 0
    v_mfma_f32_4x4x4_16b_bf16 v[76:79], v[8:9], v[104:105], 0
    v_bitop3_b32 v15, v6, v15, v46 bitop3:0xca
    v_bitop3_b32 v14, v6, v14, v47 bitop3:0xca
    s_nop 1
    v_pk_mul_f32 v[80:81], v[80:81], v[14:15] op_sel:[0,1] op_sel_hi:[1,1]
    v_pk_mul_f32 v[82:83], v[82:83], v[14:15] op_sel:[0,1] op_sel_hi:[1,1]
    v_pk_mul_f32 v[76:77], v[76:77], v[14:15] op_sel:[0,0] op_sel_hi:[1,0]
    v_pk_mul_f32 v[78:79], v[78:79], v[14:15] op_sel:[0,0] op_sel_hi:[1,0]
    s_waitcnt lgkmcnt(0)
    v_cmpx_ne_u64 vcc, v[74:75], v[70:71]
    s_and_b64 s[82:83], vcc, s[80:81]
    s_cbranch_scc1 L2_c135
L2_d135:
    v_mov_b64 v[84:85], v[70:71]
    v_mov_b32 v7, v93
    v_mov_b64 v[86:87], v[74:75]
    s_mov_b64 exec, -1
    s_or_b64 s[80:81], s[80:81], vcc
    v_cmpx_ne_u64 vcc, v[72:73], v[68:69]
    s_and_b64 s[82:83], vcc, s[80:81]
    s_cbranch_scc1 L2_c136
L2_d136:
    v_mov_b64 v[84:85], v[68:69]
    v_mov_b32 v7, v92
    v_mov_b64 v[86:87], v[72:73]
    s_mov_b64 exec, -1
    s_or_b64 s[80:81], s[80:81], vcc
    ds_read_b64 v[70:71], v95 offset:65408
    ds_read_b64 v[68:69], v94 offset:65408
    s_waitcnt vmcnt(9)
    v_and_b32 v46, 0x20000000, v33
    v_lshrrev_b32 v47, 14, v29
    v_bitop3_b32 v47, v47, v5, v46 bitop3:0xea
    ds_read_b64 v[102:103], v47
    v_bitop3_b32 v93, v29, v5, v46 bitop3:0xea
    v_and_b32 v46, 0x10000000, v33
    v_lshrrev_b32 v47, 14, v28
    v_bitop3_b32 v47, v47, v5, v46 bitop3:0xea
    ds_read_b64 v[100:101], v47
    v_bitop3_b32 v92, v28, v5, v46 bitop3:0xea
    s_waitcnt lgkmcnt(2)
    v_mfma_f32_4x4x4_16b_bf16 v[80:83], v[10:11], v[70:71], v[80:83]
    v_mfma_f32_4x4x4_16b_bf16 v[76:79], v[10:11], v[68:69], v[76:79]
    v_perm_b32 v15, v29, v32, s45
    v_bitop3_b32 v46, v29, 0.5, -0.5 bitop3:0xa8
    v_perm_b32 v14, v28, v32, s44
    v_bitop3_b32 v47, v28, 0.5, -0.5 bitop3:0xa8
    v_cvt_pk_bf16_f32 v80, v80, v81
    v_cvt_pk_bf16_f32 v81, v82, v83
    ds_wrxchg_rtn_b64 v[74:75], v95, v[80:81] offset:65408
    v_cvt_pk_bf16_f32 v76, v76, v77
    v_cvt_pk_bf16_f32 v77, v78, v79
    ds_wrxchg_rtn_b64 v[72:73], v94, v[76:77] offset:65408
    s_waitcnt lgkmcnt(2)
    v_mfma_f32_4x4x4_16b_bf16 v[80:83], v[8:9], v[102:103], 0
    v_mfma_f32_4x4x4_16b_bf16 v[76:79], v[8:9], v[100:101], 0
    v_bitop3_b32 v15, v6, v15, v46 bitop3:0xca
    v_bitop3_b32 v14, v6, v14, v47 bitop3:0xca
    v_cmp_lt_u32 s[84:85], v5, v92
    s_nop 0
    v_pk_mul_f32 v[80:81], v[80:81], v[14:15] op_sel:[0,1] op_sel_hi:[1,1]
    v_pk_mul_f32 v[82:83], v[82:83], v[14:15] op_sel:[0,1] op_sel_hi:[1,1]
    v_pk_mul_f32 v[76:77], v[76:77], v[14:15] op_sel:[0,0] op_sel_hi:[1,0]
    v_pk_mul_f32 v[78:79], v[78:79], v[14:15] op_sel:[0,0] op_sel_hi:[1,0]
    s_waitcnt lgkmcnt(0)
    v_cmpx_ne_u64 vcc, v[74:75], v[70:71]
    s_and_b64 s[82:83], vcc, s[80:81]
    s_cbranch_scc1 L2_c137
L2_d137:
    v_mov_b64 v[84:85], v[70:71]
    v_mov_b32 v7, v95
    v_mov_b64 v[86:87], v[74:75]
    s_mov_b64 exec, -1
    s_or_b64 s[80:81], s[80:81], vcc
    v_cmpx_ne_u64 vcc, v[72:73], v[68:69]
    s_and_b64 s[82:83], vcc, s[80:81]
    s_cbranch_scc1 L2_c138
L2_d138:
    v_mov_b64 v[84:85], v[68:69]
    v_mov_b32 v7, v94
    v_mov_b64 v[86:87], v[72:73]
    s_mov_b64 exec, -1
    s_or_b64 s[80:81], s[80:81], vcc
    ds_read_b64 v[70:71], v93 offset:65408
    s_and_b64 exec, s[84:85], s[80:81]
    v_mfma_f32_4x4x4_16b_bf16 v[76:79], v[12:13], v[84:85], 0
    v_mov_b32 v92, v7
    s_andn2_b64 s[80:81], s[80:81], s[84:85]
    v_mfma_f32_4x4x4_16b_bf16 v[76:79], v[10:11], v[86:87], v[76:79]
    s_mov_b64 exec, -1
    ds_read_b64 v[68:69], v92 offset:65408
    v_and_b32 v46, 0x80000000, v33
    v_lshrrev_b32 v47, 14, v31
    v_bitop3_b32 v47, v47, v5, v46 bitop3:0xea
    ds_read_b64 v[106:107], v47
    v_bitop3_b32 v95, v31, v5, v46 bitop3:0xea
    v_and_b32 v46, 0x40000000, v33
    v_lshrrev_b32 v47, 14, v30
    v_bitop3_b32 v47, v47, v5, v46 bitop3:0xea
    ds_read_b64 v[104:105], v47
    v_bitop3_b32 v94, v30, v5, v46 bitop3:0xea
    s_waitcnt lgkmcnt(2)
    v_mfma_f32_4x4x4_16b_bf16 v[80:83], v[10:11], v[70:71], v[80:83]
    v_mfma_f32_4x4x4_16b_bf16 v[76:79], v[10:11], v[68:69], v[76:79]
    v_perm_b32 v15, v31, v32, s47
    v_bitop3_b32 v46, v31, 0.5, -0.5 bitop3:0xa8
    v_perm_b32 v14, v30, v32, s46
    v_bitop3_b32 v47, v30, 0.5, -0.5 bitop3:0xa8
    v_cvt_pk_bf16_f32 v80, v80, v81
    v_cvt_pk_bf16_f32 v81, v82, v83
    ds_wrxchg_rtn_b64 v[74:75], v93, v[80:81] offset:65408
    v_cvt_pk_bf16_f32 v76, v76, v77
    v_cvt_pk_bf16_f32 v77, v78, v79
    ds_wrxchg_rtn_b64 v[72:73], v92, v[76:77] offset:65408
    s_setprio 0
    s_waitcnt lgkmcnt(2)
    v_mfma_f32_4x4x4_16b_bf16 v[80:83], v[8:9], v[106:107], 0
    v_mfma_f32_4x4x4_16b_bf16 v[76:79], v[8:9], v[104:105], 0
    v_bitop3_b32 v15, v6, v15, v46 bitop3:0xca
    v_bitop3_b32 v14, v6, v14, v47 bitop3:0xca
    s_nop 1
    v_pk_mul_f32 v[80:81], v[80:81], v[14:15] op_sel:[0,1] op_sel_hi:[1,1]
    v_pk_mul_f32 v[82:83], v[82:83], v[14:15] op_sel:[0,1] op_sel_hi:[1,1]
    v_pk_mul_f32 v[76:77], v[76:77], v[14:15] op_sel:[0,0] op_sel_hi:[1,0]
    v_pk_mul_f32 v[78:79], v[78:79], v[14:15] op_sel:[0,0] op_sel_hi:[1,0]
    s_waitcnt lgkmcnt(0)
    v_cmpx_ne_u64 vcc, v[74:75], v[70:71]
    s_and_b64 s[82:83], vcc, s[80:81]
    s_cbranch_scc1 L2_c139
L2_d139:
    v_mov_b64 v[84:85], v[70:71]
    v_mov_b32 v7, v93
    v_mov_b64 v[86:87], v[74:75]
    s_mov_b64 exec, -1
    s_or_b64 s[80:81], s[80:81], vcc
    v_cmpx_ne_u64 vcc, v[72:73], v[68:69]
    s_and_b64 s[82:83], vcc, s[80:81]
    s_cbranch_scc1 L2_c140
L2_d140:
    v_mov_b64 v[84:85], v[68:69]
    v_mov_b32 v7, v92
    v_mov_b64 v[86:87], v[72:73]
    s_mov_b64 exec, -1
    s_or_b64 s[80:81], s[80:81], vcc
    ds_read_b64 v[70:71], v95 offset:65408
    ds_read_b64 v[68:69], v94 offset:65408
    s_waitcnt vmcnt(7)
    v_and_b32 v46, 0x20000000, v39
    v_lshrrev_b32 v47, 14, v35
    v_bitop3_b32 v47, v47, v5, v46 bitop3:0xea
    ds_read_b64 v[102:103], v47
    v_bitop3_b32 v93, v35, v5, v46 bitop3:0xea
    v_and_b32 v46, 0x10000000, v39
    v_lshrrev_b32 v47, 14, v34
    v_bitop3_b32 v47, v47, v5, v46 bitop3:0xea
    ds_read_b64 v[100:101], v47
    v_bitop3_b32 v92, v34, v5, v46 bitop3:0xea
    v_and_b32 v46, 0x80000000, v39
    v_lshrrev_b32 v47, 14, v37
    v_bitop3_b32 v47, v47, v5, v46 bitop3:0xea
    ds_read_b64 v[106:107], v47
    v_and_b32 v46, 0x40000000, v39
    v_lshrrev_b32 v47, 14, v36
    v_bitop3_b32 v47, v47, v5, v46 bitop3:0xea
    ds_read_b64 v[104:105], v47
    s_waitcnt lgkmcnt(4)
    v_mfma_f32_4x4x4_16b_bf16 v[80:83], v[10:11], v[70:71], v[80:83]
    v_mfma_f32_4x4x4_16b_bf16 v[76:79], v[10:11], v[68:69], v[76:79]
    v_perm_b32 v15, v35, v38, s45
    v_bitop3_b32 v46, v35, 0.5, -0.5 bitop3:0xa8
    v_perm_b32 v14, v34, v38, s44
    v_bitop3_b32 v47, v34, 0.5, -0.5 bitop3:0xa8
    v_cvt_pk_bf16_f32 v80, v80, v81
    v_cvt_pk_bf16_f32 v81, v82, v83
    ds_wrxchg_rtn_b64 v[74:75], v95, v[80:81] offset:65408
    v_cvt_pk_bf16_f32 v76, v76, v77
    v_cvt_pk_bf16_f32 v77, v78, v79
    ds_wrxchg_rtn_b64 v[72:73], v94, v[76:77] offset:65408
    s_waitcnt lgkmcnt(4)
    v_mfma_f32_4x4x4_16b_bf16 v[80:83], v[8:9], v[102:103], 0
    v_mfma_f32_4x4x4_16b_bf16 v[76:79], v[8:9], v[100:101], 0
    v_bitop3_b32 v15, v6, v15, v46 bitop3:0xca
    v_bitop3_b32 v14, v6, v14, v47 bitop3:0xca
    v_cmp_lt_u32 s[84:85], v5, v92
    s_nop 0
    v_pk_mul_f32 v[80:81], v[80:81], v[14:15] op_sel:[0,1] op_sel_hi:[1,1]
    v_pk_mul_f32 v[82:83], v[82:83], v[14:15] op_sel:[0,1] op_sel_hi:[1,1]
    v_pk_mul_f32 v[76:77], v[76:77], v[14:15] op_sel:[0,0] op_sel_hi:[1,0]
    v_pk_mul_f32 v[78:79], v[78:79], v[14:15] op_sel:[0,0] op_sel_hi:[1,0]
    s_waitcnt lgkmcnt(0)
    v_cmpx_ne_u64 vcc, v[74:75], v[70:71]
    s_and_b64 s[82:83], vcc, s[80:81]
    s_cbranch_scc1 L2_c141
L2_d141:
    v_mov_b64 v[84:85], v[70:71]
    v_mov_b32 v7, v95
    v_mov_b64 v[86:87], v[74:75]
    s_mov_b64 exec, -1
    s_or_b64 s[80:81], s[80:81], vcc
    v_cmpx_ne_u64 vcc, v[72:73], v[68:69]
    s_and_b64 s[82:83], vcc, s[80:81]
    s_cbranch_scc1 L2_c142
L2_d142:
    v_mov_b64 v[84:85], v[68:69]
    v_mov_b32 v7, v94
    v_mov_b64 v[86:87], v[72:73]
    s_mov_b64 exec, -1
    s_or_b64 s[80:81], s[80:81], vcc
    ds_read_b64 v[70:71], v93 offset:65408
    s_and_b64 exec, s[84:85], s[80:81]
    v_mfma_f32_4x4x4_16b_bf16 v[76:79], v[12:13], v[84:85], 0
    v_mov_b32 v92, v7
    s_andn2_b64 s[80:81], s[80:81], s[84:85]
    v_mfma_f32_4x4x4_16b_bf16 v[76:79], v[10:11], v[86:87], v[76:79]
    s_mov_b64 exec, -1
    ds_read_b64 v[68:69], v92 offset:65408
    s_waitcnt lgkmcnt(0)
    v_mfma_f32_4x4x4_16b_bf16 v[80:83], v[10:11], v[70:71], v[80:83]
    v_mfma_f32_4x4x4_16b_bf16 v[76:79], v[10:11], v[68:69], v[76:79]
    v_and_b32 v46, 0x40000000, v39
    v_bitop3_b32 v94, v36, v5, v46 bitop3:0xea
    v_and_b32 v46, 0x80000000, v39
    v_bitop3_b32 v95, v37, v5, v46 bitop3:0xea
    v_perm_b32 v15, v37, v38, s47
    v_bitop3_b32 v46, v37, 0.5, -0.5 bitop3:0xa8
    v_perm_b32 v14, v36, v38, s46
    v_bitop3_b32 v47, v36, 0.5, -0.5 bitop3:0xa8
    v_cvt_pk_bf16_f32 v80, v80, v81
    v_cvt_pk_bf16_f32 v81, v82, v83
    ds_wrxchg_rtn_b64 v[74:75], v93, v[80:81] offset:65408
    v_cvt_pk_bf16_f32 v76, v76, v77
    v_cvt_pk_bf16_f32 v77, v78, v79
    ds_wrxchg_rtn_b64 v[72:73], v92, v[76:77] offset:65408
    v_mfma_f32_4x4x4_16b_bf16 v[80:83], v[8:9], v[106:107], 0
    v_mfma_f32_4x4x4_16b_bf16 v[76:79], v[8:9], v[104:105], 0
    v_bitop3_b32 v15, v6, v15, v46 bitop3:0xca
    v_bitop3_b32 v14, v6, v14, v47 bitop3:0xca
    s_nop 1
    v_pk_mul_f32 v[80:81], v[80:81], v[14:15] op_sel:[0,1] op_sel_hi:[1,1]
    v_pk_mul_f32 v[82:83], v[82:83], v[14:15] op_sel:[0,1] op_sel_hi:[1,1]
    v_pk_mul_f32 v[76:77], v[76:77], v[14:15] op_sel:[0,0] op_sel_hi:[1,0]
    v_pk_mul_f32 v[78:79], v[78:79], v[14:15] op_sel:[0,0] op_sel_hi:[1,0]
    s_waitcnt lgkmcnt(0)
    v_cmpx_ne_u64 vcc, v[74:75], v[70:71]
    s_and_b64 s[82:83], vcc, s[80:81]
    s_cbranch_scc1 L2_c143
L2_d143:
    v_mov_b64 v[84:85], v[70:71]
    v_mov_b32 v7, v93
    v_mov_b64 v[86:87], v[74:75]
    s_mov_b64 exec, -1
    s_or_b64 s[80:81], s[80:81], vcc
    v_cmpx_ne_u64 vcc, v[72:73], v[68:69]
    s_and_b64 s[82:83], vcc, s[80:81]
    s_cbranch_scc1 L2_c144
L2_d144:
    v_mov_b64 v[84:85], v[68:69]
    v_mov_b32 v7, v92
    v_mov_b64 v[86:87], v[72:73]
    s_mov_b64 exec, -1
    s_or_b64 s[80:81], s[80:81], vcc
    ds_read_b64 v[70:71], v95 offset:65408
    ds_read_b64 v[68:69], v94 offset:65408
    s_waitcnt lgkmcnt(0)
    v_mfma_f32_4x4x4_16b_bf16 v[80:83], v[10:11], v[70:71], v[80:83]
    v_mfma_f32_4x4x4_16b_bf16 v[76:79], v[10:11], v[68:69], v[76:79]
    s_nop 3
    v_cvt_pk_bf16_f32 v80, v80, v81
    v_cvt_pk_bf16_f32 v81, v82, v83
    ds_wrxchg_rtn_b64 v[74:75], v95, v[80:81] offset:65408
    v_cvt_pk_bf16_f32 v76, v76, v77
    v_cvt_pk_bf16_f32 v77, v78, v79
    ds_wrxchg_rtn_b64 v[72:73], v94, v[76:77] offset:65408
    s_waitcnt lgkmcnt(0)
    v_cmpx_ne_u64 vcc, v[74:75], v[70:71]
    s_and_b64 s[82:83], vcc, s[80:81]
    s_cbranch_scc1 L2_c145
L2_d145:
    v_mov_b64 v[84:85], v[70:71]
    v_mov_b32 v7, v95
    v_mov_b64 v[86:87], v[74:75]
    s_mov_b64 exec, -1
    s_or_b64 s[80:81], s[80:81], vcc
    v_cmpx_ne_u64 vcc, v[72:73], v[68:69]
    s_and_b64 s[82:83], vcc, s[80:81]
    s_cbranch_scc1 L2_c146
L2_d146:
    v_mov_b64 v[84:85], v[68:69]
    v_mov_b32 v7, v94
    v_mov_b64 v[86:87], v[72:73]
    s_mov_b64 exec, -1
    s_or_b64 s[80:81], s[80:81], vcc
    s_mov_b64 exec, s[80:81]
    s_nop 1
    v_mfma_f32_4x4x4_16b_bf16 v[88:91], v[12:13], v[84:85], 0
    s_nop 1
    v_mfma_f32_4x4x4_16b_bf16 v[88:91], v[10:11], v[86:87], v[88:91]
    s_nop 4
    v_cvt_pk_bf16_f32 v88, v88, v89
    v_cvt_pk_bf16_f32 v89, v90, v91
    ds_pk_add_bf16 v7, v88 offset:65408
    ds_pk_add_bf16 v7, v89 offset:65412
    s_mov_b64 exec, -1
    s_load_dwordx2 s[4:5], s[0:1], 88
    v_add_u32 v123, 16384, v122
    v_add_u32 v124, 32768, v122
    v_add_u32 v125, 49152, v122
    v_add_u32 v126, 65536, v122
    s_lshl_b32 s50, s96, 16
    s_and_b32 s51, s96, 0xffff0000
    s_lshl_b32 s52, s97, 16
    s_and_b32 s53, s97, 0xffff0000
    s_lshl_b32 s54, s98, 16
    s_and_b32 s55, s98, 0xffff0000
    s_lshl_b32 s56, s99, 16
    s_and_b32 s57, s99, 0xffff0000
    s_waitcnt vmcnt(0) lgkmcnt(0)
    s_barrier
    v_add_u32 v36, 0x8000, v126
    ds_read_b128 v[16:19], v126 offset:16384
    ds_read_b128 v[20:23], v126 offset:32768
    ds_read_b128 v[24:27], v126 offset:49152
    ds_read_b128 v[28:31], v36 offset:32768
    ds_read_b128 v[32:35], v36 offset:49152
    s_add_u32 s8, s30, 0xebca000
    s_addc_u32 s9, s31, 0
    s_mov_b32 s10, 0x8000
    s_mov_b32 s11, 0x20000
    s_mov_b32 s12, s4
    s_mov_b32 s13, s5
    s_mov_b32 s14, 0x4e2000
    s_mov_b32 s15, 0x20000
    s_mul_i32 s3, s33, 20000
    v_subrev_u32 v36, s3, v122
    v_cmp_le_u32 vcc, 20000, v36
    s_waitcnt lgkmcnt(4)
    s_mov_b64 exec, vcc
    buffer_store_dwordx4 v[16:19], v122, s[20:23], 0 offen sc1
    s_mov_b64 exec, -1
    v_subrev_u32 v36, s3, v123
    v_cmp_le_u32 vcc, 20000, v36
    s_waitcnt lgkmcnt(3)
    s_mov_b64 exec, vcc
    buffer_store_dwordx4 v[20:23], v123, s[20:23], 0 offen sc1
    s_mov_b64 exec, -1
    v_subrev_u32 v36, s3, v124
    v_cmp_le_u32 vcc, 20000, v36
    s_waitcnt lgkmcnt(2)
    s_mov_b64 exec, vcc
    buffer_store_dwordx4 v[24:27], v124, s[20:23], 0 offen sc1
    s_mov_b64 exec, -1
    v_subrev_u32 v36, s3, v125
    v_cmp_le_u32 vcc, 20000, v36
    s_waitcnt lgkmcnt(1)
    s_mov_b64 exec, vcc
    buffer_store_dwordx4 v[28:31], v125, s[20:23], 0 offen sc1
    s_mov_b64 exec, -1
    v_subrev_u32 v36, s3, v126
    v_cmp_le_u32 vcc, 20000, v36
    s_waitcnt lgkmcnt(0)
    s_mov_b64 exec, vcc
    buffer_store_dwordx4 v[32:35], v126, s[20:23], 0 offen sc1
    s_mov_b64 exec, -1
    v_lshlrev_b32 v80, 16, v116
    v_subrev_f32 v60, s50, v80
    v_subrev_f32 v61, s51, v80
    v_subrev_f32 v62, s52, v80
    v_subrev_f32 v63, s53, v80
    v_subrev_f32 v64, s54, v80
    v_subrev_f32 v65, s55, v80
    v_subrev_f32 v66, s56, v80
    v_subrev_f32 v67, s57, v80
    v_cvt_pk_bf16_f32 v68, v60, v61
    v_cvt_pk_bf16_f32 v69, v62, v63
    v_cvt_pk_bf16_f32 v70, v64, v65
    v_cvt_pk_bf16_f32 v71, v66, v67
    v_lshlrev_b32 v60, 16, v68
    v_and_b32 v61, 0xffff0000, v68
    v_lshlrev_b32 v62, 16, v69
    v_and_b32 v63, 0xffff0000, v69
    v_lshlrev_b32 v64, 16, v70
    v_and_b32 v65, 0xffff0000, v70
    v_lshlrev_b32 v66, 16, v71
    v_and_b32 v67, 0xffff0000, v71
    v_mul_f32 v60, v60, v60
    v_mul_f32 v61, v61, v61
    v_mul_f32 v62, v62, v62
    v_mul_f32 v63, v63, v63
    v_mul_f32 v64, v64, v64
    v_mul_f32 v65, v65, v65
    v_mul_f32 v66, v66, v66
    v_mul_f32 v67, v67, v67
    v_cvt_pk_bf16_f32 v68, v60, v61
    v_cvt_pk_bf16_f32 v69, v62, v63
    v_cvt_pk_bf16_f32 v70, v64, v65
    v_cvt_pk_bf16_f32 v71, v66, v67
    v_lshlrev_b32 v60, 16, v68
    v_and_b32 v61, 0xffff0000, v68
    v_lshlrev_b32 v62, 16, v69
    v_and_b32 v63, 0xffff0000, v69
    v_lshlrev_b32 v64, 16, v70
    v_and_b32 v65, 0xffff0000, v70
    v_lshlrev_b32 v66, 16, v71
    v_and_b32 v67, 0xffff0000, v71
    v_mul_f32 v60, 0xc1200000, v60
    v_mul_f32 v61, 0xc1200000, v61
    v_mul_f32 v62, 0xc1200000, v62
    v_mul_f32 v63, 0xc1200000, v63
    v_mul_f32 v64, 0xc1200000, v64
    v_mul_f32 v65, 0xc1200000, v65
    v_mul_f32 v66, 0xc1200000, v66
    v_mul_f32 v67, 0xc1200000, v67
    v_cvt_pk_bf16_f32 v68, v60, v61
    v_cvt_pk_bf16_f32 v69, v62, v63
    v_cvt_pk_bf16_f32 v70, v64, v65
    v_cvt_pk_bf16_f32 v71, v66, v67
    v_lshlrev_b32 v60, 16, v68
    v_and_b32 v61, 0xffff0000, v68
    v_lshlrev_b32 v62, 16, v69
    v_and_b32 v63, 0xffff0000, v69
    v_lshlrev_b32 v64, 16, v70
    v_and_b32 v65, 0xffff0000, v70
    v_lshlrev_b32 v66, 16, v71
    v_and_b32 v67, 0xffff0000, v71
    v_mul_f32 v60, 0x3fb8aa3b, v60
    v_mul_f32 v61, 0x3fb8aa3b, v61
    v_mul_f32 v62, 0x3fb8aa3b, v62
    v_mul_f32 v63, 0x3fb8aa3b, v63
    v_mul_f32 v64, 0x3fb8aa3b, v64
    v_mul_f32 v65, 0x3fb8aa3b, v65
    v_mul_f32 v66, 0x3fb8aa3b, v66
    v_mul_f32 v67, 0x3fb8aa3b, v67
    v_exp_f32 v60, v60
    v_exp_f32 v61, v61
    v_exp_f32 v62, v62
    v_exp_f32 v63, v63
    v_exp_f32 v64, v64
    v_exp_f32 v65, v65
    v_exp_f32 v66, v66
    v_exp_f32 v67, v67
    v_cvt_pk_bf16_f32 v72, v60, v61
    v_cvt_pk_bf16_f32 v73, v62, v63
    v_cvt_pk_bf16_f32 v74, v64, v65
    v_cvt_pk_bf16_f32 v75, v66, v67
    v_and_b32 v80, 0xffff0000, v116
    v_subrev_f32 v60, s50, v80
    v_subrev_f32 v61, s51, v80
    v_subrev_f32 v62, s52, v80
    v_subrev_f32 v63, s53, v80
    v_subrev_f32 v64, s54, v80
    v_subrev_f32 v65, s55, v80
    v_subrev_f32 v66, s56, v80
    v_subrev_f32 v67, s57, v80
    v_cvt_pk_bf16_f32 v68, v60, v61
    v_cvt_pk_bf16_f32 v69, v62, v63
    v_cvt_pk_bf16_f32 v70, v64, v65
    v_cvt_pk_bf16_f32 v71, v66, v67
    v_lshlrev_b32 v60, 16, v68
    v_and_b32 v61, 0xffff0000, v68
    v_lshlrev_b32 v62, 16, v69
    v_and_b32 v63, 0xffff0000, v69
    v_lshlrev_b32 v64, 16, v70
    v_and_b32 v65, 0xffff0000, v70
    v_lshlrev_b32 v66, 16, v71
    v_and_b32 v67, 0xffff0000, v71
    v_mul_f32 v60, v60, v60
    v_mul_f32 v61, v61, v61
    v_mul_f32 v62, v62, v62
    v_mul_f32 v63, v63, v63
    v_mul_f32 v64, v64, v64
    v_mul_f32 v65, v65, v65
    v_mul_f32 v66, v66, v66
    v_mul_f32 v67, v67, v67
    v_cvt_pk_bf16_f32 v68, v60, v61
    v_cvt_pk_bf16_f32 v69, v62, v63
    v_cvt_pk_bf16_f32 v70, v64, v65
    v_cvt_pk_bf16_f32 v71, v66, v67
    v_lshlrev_b32 v60, 16, v68
    v_and_b32 v61, 0xffff0000, v68
    v_lshlrev_b32 v62, 16, v69
    v_and_b32 v63, 0xffff0000, v69
    v_lshlrev_b32 v64, 16, v70
    v_and_b32 v65, 0xffff0000, v70
    v_lshlrev_b32 v66, 16, v71
    v_and_b32 v67, 0xffff0000, v71
    v_mul_f32 v60, 0xc1200000, v60
    v_mul_f32 v61, 0xc1200000, v61
    v_mul_f32 v62, 0xc1200000, v62
    v_mul_f32 v63, 0xc1200000, v63
    v_mul_f32 v64, 0xc1200000, v64
    v_mul_f32 v65, 0xc1200000, v65
    v_mul_f32 v66, 0xc1200000, v66
    v_mul_f32 v67, 0xc1200000, v67
    v_cvt_pk_bf16_f32 v68, v60, v61
    v_cvt_pk_bf16_f32 v69, v62, v63
    v_cvt_pk_bf16_f32 v70, v64, v65
    v_cvt_pk_bf16_f32 v71, v66, v67
    v_lshlrev_b32 v60, 16, v68
    v_and_b32 v61, 0xffff0000, v68
    v_lshlrev_b32 v62, 16, v69
    v_and_b32 v63, 0xffff0000, v69
    v_lshlrev_b32 v64, 16, v70
    v_and_b32 v65, 0xffff0000, v70
    v_lshlrev_b32 v66, 16, v71
    v_and_b32 v67, 0xffff0000, v71
    v_mul_f32 v60, 0x3fb8aa3b, v60
    v_mul_f32 v61, 0x3fb8aa3b, v61
    v_mul_f32 v62, 0x3fb8aa3b, v62
    v_mul_f32 v63, 0x3fb8aa3b, v63
    v_mul_f32 v64, 0x3fb8aa3b, v64
    v_mul_f32 v65, 0x3fb8aa3b, v65
    v_mul_f32 v66, 0x3fb8aa3b, v66
    v_mul_f32 v67, 0x3fb8aa3b, v67
    v_exp_f32 v60, v60
    v_exp_f32 v61, v61
    v_exp_f32 v62, v62
    v_exp_f32 v63, v63
    v_exp_f32 v64, v64
    v_exp_f32 v65, v65
    v_exp_f32 v66, v66
    v_exp_f32 v67, v67
    v_cvt_pk_bf16_f32 v76, v60, v61
    v_cvt_pk_bf16_f32 v77, v62, v63
    v_cvt_pk_bf16_f32 v78, v64, v65
    v_cvt_pk_bf16_f32 v79, v66, v67
    v_mfma_f32_4x4x4_16b_bf16 v[80:83], v[48:49], v[72:73], 0
    v_mfma_f32_4x4x4_16b_bf16 v[88:91], v[52:53], v[72:73], 0
    v_mfma_f32_4x4x4_16b_bf16 v[84:87], v[48:49], v[76:77], 0
    v_mfma_f32_4x4x4_16b_bf16 v[92:95], v[52:53], v[76:77], 0
    v_mfma_f32_4x4x4_16b_bf16 v[80:83], v[50:51], v[74:75], v[80:83]
    v_mfma_f32_4x4x4_16b_bf16 v[88:91], v[54:55], v[74:75], v[88:91]
    v_mfma_f32_4x4x4_16b_bf16 v[84:87], v[50:51], v[78:79], v[84:87]
    v_mfma_f32_4x4x4_16b_bf16 v[92:95], v[54:55], v[78:79], v[92:95]
    v_add_u32 v104, 81920, v118
    ds_read_b128 v[32:35], v104
    v_add_u32 v104, 81920, v119
    ds_read_b128 v[60:63], v104
    s_add_u32 s20, s30, 0xd841000
    s_addc_u32 s21, s31, 0
    s_mov_b32 s22, 0x1388000
    s_mov_b32 s23, 0x20000
    s_add_u32 s3, s33, 1
    s_and_b32 s3, s3, 3
    s_lshl_b32 s3, s3, 6
    s_add_u32 s3, s3, s34
    s_mul_i32 s44, s3, 80000
    s_add_u32 s3, s33, 2
    s_and_b32 s3, s3, 3
    s_lshl_b32 s3, s3, 6
    s_add_u32 s3, s3, s34
    s_mul_i32 s45, s3, 80000
    s_add_u32 s3, s33, 3
    s_and_b32 s3, s3, 3
    s_lshl_b32 s3, s3, 6
    s_add_u32 s3, s3, s34
    s_mul_i32 s46, s3, 80000
    s_lshl_b32 s3, s34, 9
    s_lshl_b32 s4, s33, 7
    s_add_u32 s4, s4, s3
    v_mov_b32 v104, 1
    v_lshlrev_b32 v105, 3, v122
    s_waitcnt vmcnt(0)
    s_barrier
    s_cmp_lg_u32 s32, 0
    s_cbranch_scc1 L2_f2
    s_mov_b64 exec, 1
    buffer_store_dword v104, off, s[8:11], s4 sc1
    s_mov_b64 exec, 15
    s_bitset0_b64 exec, s33
L2_f3:
    buffer_load_dword v104, v105, s[8:11], s3 offen sc1
    s_waitcnt vmcnt(0)
    v_cmp_ne_u32 vcc, 1, v104
    s_cbranch_vccnz L2_f3
L2_f4:
    s_mov_b64 exec, -1
L2_f2:
    s_barrier
    buffer_load_dwordx4 v[36:39], v118, s[20:23], s44 offen sc1
    buffer_load_dwordx4 v[40:43], v118, s[20:23], s45 offen sc1
    buffer_load_dwordx4 v[44:47], v118, s[20:23], s46 offen sc1
    s_cmp_ge_u32 s32, 4
    s_cbranch_scc1 L2_f5
    buffer_load_dwordx4 v[64:67], v119, s[20:23], s44 offen sc1
    buffer_load_dwordx4 v[68:71], v119, s[20:23], s45 offen sc1
    buffer_load_dwordx4 v[72:75], v119, s[20:23], s46 offen sc1
    v_lshlrev_b32 v16, 16, v117
    v_subrev_f32 v96, s50, v16
    v_subrev_f32 v97, s51, v16
    v_subrev_f32 v98, s52, v16
    v_subrev_f32 v99, s53, v16
    v_subrev_f32 v100, s54, v16
    v_subrev_f32 v101, s55, v16
    v_subrev_f32 v102, s56, v16
    v_subrev_f32 v103, s57, v16
    v_cvt_pk_bf16_f32 v0, v96, v97
    v_cvt_pk_bf16_f32 v1, v98, v99
    v_cvt_pk_bf16_f32 v2, v100, v101
    v_cvt_pk_bf16_f32 v3, v102, v103
    v_lshlrev_b32 v96, 16, v0
    v_and_b32 v97, 0xffff0000, v0
    v_lshlrev_b32 v98, 16, v1
    v_and_b32 v99, 0xffff0000, v1
    v_lshlrev_b32 v100, 16, v2
    v_and_b32 v101, 0xffff0000, v2
    v_lshlrev_b32 v102, 16, v3
    v_and_b32 v103, 0xffff0000, v3
    v_mul_f32 v96, v96, v96
    v_mul_f32 v97, v97, v97
    v_mul_f32 v98, v98, v98
    v_mul_f32 v99, v99, v99
    v_mul_f32 v100, v100, v100
    v_mul_f32 v101, v101, v101
    v_mul_f32 v102, v102, v102
    v_mul_f32 v103, v103, v103
    v_cvt_pk_bf16_f32 v0, v96, v97
    v_cvt_pk_bf16_f32 v1, v98, v99
    v_cvt_pk_bf16_f32 v2, v100, v101
    v_cvt_pk_bf16_f32 v3, v102, v103
    v_lshlrev_b32 v96, 16, v0
    v_and_b32 v97, 0xffff0000, v0
    v_lshlrev_b32 v98, 16, v1
    v_and_b32 v99, 0xffff0000, v1
    v_lshlrev_b32 v100, 16, v2
    v_and_b32 v101, 0xffff0000, v2
    v_lshlrev_b32 v102, 16, v3
    v_and_b32 v103, 0xffff0000, v3
    v_mul_f32 v96, 0xc1200000, v96
    v_mul_f32 v97, 0xc1200000, v97
    v_mul_f32 v98, 0xc1200000, v98
    v_mul_f32 v99, 0xc1200000, v99
    v_mul_f32 v100, 0xc1200000, v100
    v_mul_f32 v101, 0xc1200000, v101
    v_mul_f32 v102, 0xc1200000, v102
    v_mul_f32 v103, 0xc1200000, v103
    v_cvt_pk_bf16_f32 v0, v96, v97
    v_cvt_pk_bf16_f32 v1, v98, v99
    v_cvt_pk_bf16_f32 v2, v100, v101
    v_cvt_pk_bf16_f32 v3, v102, v103
    v_lshlrev_b32 v96, 16, v0
    v_and_b32 v97, 0xffff0000, v0
    v_lshlrev_b32 v98, 16, v1
    v_and_b32 v99, 0xffff0000, v1
    v_lshlrev_b32 v100, 16, v2
    v_and_b32 v101, 0xffff0000, v2
    v_lshlrev_b32 v102, 16, v3
    v_and_b32 v103, 0xffff0000, v3
    v_mul_f32 v96, 0x3fb8aa3b, v96
    v_mul_f32 v97, 0x3fb8aa3b, v97
    v_mul_f32 v98, 0x3fb8aa3b, v98
    v_mul_f32 v99, 0x3fb8aa3b, v99
    v_mul_f32 v100, 0x3fb8aa3b, v100
    v_mul_f32 v101, 0x3fb8aa3b, v101
    v_mul_f32 v102, 0x3fb8aa3b, v102
    v_mul_f32 v103, 0x3fb8aa3b, v103
    v_exp_f32 v96, v96
    v_exp_f32 v97, v97
    v_exp_f32 v98, v98
    v_exp_f32 v99, v99
    v_exp_f32 v100, v100
    v_exp_f32 v101, v101
    v_exp_f32 v102, v102
    v_exp_f32 v103, v103
    v_cvt_pk_bf16_f32 v104, v96, v97
    v_cvt_pk_bf16_f32 v105, v98, v99
    v_cvt_pk_bf16_f32 v106, v100, v101
    v_cvt_pk_bf16_f32 v107, v102, v103
    v_and_b32 v16, 0xffff0000, v117
    v_subrev_f32 v96, s50, v16
    v_subrev_f32 v97, s51, v16
    v_subrev_f32 v98, s52, v16
    v_subrev_f32 v99, s53, v16
    v_subrev_f32 v100, s54, v16
    v_subrev_f32 v101, s55, v16
    v_subrev_f32 v102, s56, v16
    v_subrev_f32 v103, s57, v16
    v_cvt_pk_bf16_f32 v0, v96, v97
    v_cvt_pk_bf16_f32 v1, v98, v99
    v_cvt_pk_bf16_f32 v2, v100, v101
    v_cvt_pk_bf16_f32 v3, v102, v103
    v_lshlrev_b32 v96, 16, v0
    v_and_b32 v97, 0xffff0000, v0
    v_lshlrev_b32 v98, 16, v1
    v_and_b32 v99, 0xffff0000, v1
    v_lshlrev_b32 v100, 16, v2
    v_and_b32 v101, 0xffff0000, v2
    v_lshlrev_b32 v102, 16, v3
    v_and_b32 v103, 0xffff0000, v3
    v_mul_f32 v96, v96, v96
    v_mul_f32 v97, v97, v97
    v_mul_f32 v98, v98, v98
    v_mul_f32 v99, v99, v99
    v_mul_f32 v100, v100, v100
    v_mul_f32 v101, v101, v101
    v_mul_f32 v102, v102, v102
    v_mul_f32 v103, v103, v103
    v_cvt_pk_bf16_f32 v0, v96, v97
    v_cvt_pk_bf16_f32 v1, v98, v99
    v_cvt_pk_bf16_f32 v2, v100, v101
    v_cvt_pk_bf16_f32 v3, v102, v103
    v_lshlrev_b32 v96, 16, v0
    v_and_b32 v97, 0xffff0000, v0
    v_lshlrev_b32 v98, 16, v1
    v_and_b32 v99, 0xffff0000, v1
    v_lshlrev_b32 v100, 16, v2
    v_and_b32 v101, 0xffff0000, v2
    v_lshlrev_b32 v102, 16, v3
    v_and_b32 v103, 0xffff0000, v3
    v_mul_f32 v96, 0xc1200000, v96
    v_mul_f32 v97, 0xc1200000, v97
    v_mul_f32 v98, 0xc1200000, v98
    v_mul_f32 v99, 0xc1200000, v99
    v_mul_f32 v100, 0xc1200000, v100
    v_mul_f32 v101, 0xc1200000, v101
    v_mul_f32 v102, 0xc1200000, v102
    v_mul_f32 v103, 0xc1200000, v103
    v_cvt_pk_bf16_f32 v0, v96, v97
    v_cvt_pk_bf16_f32 v1, v98, v99
    v_cvt_pk_bf16_f32 v2, v100, v101
    v_cvt_pk_bf16_f32 v3, v102, v103
    v_lshlrev_b32 v96, 16, v0
    v_and_b32 v97, 0xffff0000, v0
    v_lshlrev_b32 v98, 16, v1
    v_and_b32 v99, 0xffff0000, v1
    v_lshlrev_b32 v100, 16, v2
    v_and_b32 v101, 0xffff0000, v2
    v_lshlrev_b32 v102, 16, v3
    v_and_b32 v103, 0xffff0000, v3
    v_mul_f32 v96, 0x3fb8aa3b, v96
    v_mul_f32 v97, 0x3fb8aa3b, v97
    v_mul_f32 v98, 0x3fb8aa3b, v98
    v_mul_f32 v99, 0x3fb8aa3b, v99
    v_mul_f32 v100, 0x3fb8aa3b, v100
    v_mul_f32 v101, 0x3fb8aa3b, v101
    v_mul_f32 v102, 0x3fb8aa3b, v102
    v_mul_f32 v103, 0x3fb8aa3b, v103
    v_exp_f32 v96, v96
    v_exp_f32 v97, v97
    v_exp_f32 v98, v98
    v_exp_f32 v99, v99
    v_exp_f32 v100, v100
    v_exp_f32 v101, v101
    v_exp_f32 v102, v102
    v_exp_f32 v103, v103
    v_cvt_pk_bf16_f32 v76, v96, v97
    v_cvt_pk_bf16_f32 v77, v98, v99
    v_cvt_pk_bf16_f32 v78, v100, v101
    v_cvt_pk_bf16_f32 v79, v102, v103
    v_mfma_f32_4x4x4_16b_bf16 v[16:19], v[48:49], v[104:105], 0
    v_mfma_f32_4x4x4_16b_bf16 v[24:27], v[52:53], v[104:105], 0
    v_mfma_f32_4x4x4_16b_bf16 v[20:23], v[48:49], v[76:77], 0
    v_mfma_f32_4x4x4_16b_bf16 v[28:31], v[52:53], v[76:77], 0
    v_mfma_f32_4x4x4_16b_bf16 v[16:19], v[50:51], v[106:107], v[16:19]
    v_mfma_f32_4x4x4_16b_bf16 v[24:27], v[54:55], v[106:107], v[24:27]
    v_mfma_f32_4x4x4_16b_bf16 v[20:23], v[50:51], v[78:79], v[20:23]
    v_mfma_f32_4x4x4_16b_bf16 v[28:31], v[54:55], v[78:79], v[28:31]
L2_f5:
    s_waitcnt vmcnt(0) lgkmcnt(0)
    v_mfma_f32_4x4x4_16b_bf16 v[96:99], v[10:11], v[32:33], 0
    v_mfma_f32_4x4x4_16b_bf16 v[100:103], v[10:11], v[34:35], 0
    s_nop 0
    v_mfma_f32_4x4x4_16b_bf16 v[96:99], v[10:11], v[36:37], v[96:99]
    v_mfma_f32_4x4x4_16b_bf16 v[100:103], v[10:11], v[38:39], v[100:103]
    s_nop 0
    v_mfma_f32_4x4x4_16b_bf16 v[96:99], v[10:11], v[40:41], v[96:99]
    v_mfma_f32_4x4x4_16b_bf16 v[100:103], v[10:11], v[42:43], v[100:103]
    s_nop 0
    v_mfma_f32_4x4x4_16b_bf16 v[96:99], v[10:11], v[44:45], v[96:99]
    v_mfma_f32_4x4x4_16b_bf16 v[100:103], v[10:11], v[46:47], v[100:103]
    s_nop 3
    v_mul_f32 v96, v96, v80
    v_mul_f32 v97, v97, v81
    v_mul_f32 v98, v98, v82
    v_mul_f32 v99, v99, v83
    v_cvt_pk_bf16_f32 v32, v96, v97
    v_cvt_pk_bf16_f32 v33, v98, v99
    v_mul_f32 v100, v100, v84
    v_mul_f32 v101, v101, v85
    v_mul_f32 v102, v102, v86
    v_mul_f32 v103, v103, v87
    v_cvt_pk_bf16_f32 v34, v100, v101
    v_cvt_pk_bf16_f32 v35, v102, v103
    v_mfma_f32_4x4x4_16b_bf16 v[80:83], v[56:57], v[32:33], 0
    s_nop 0
    v_mfma_f32_4x4x4_16b_bf16 v[84:87], v[56:57], v[34:35], 0
    s_nop 2
    v_mul_f32 v80, v80, v88
    v_mul_f32 v81, v81, v89
    v_mul_f32 v82, v82, v90
    v_mul_f32 v83, v83, v91
    v_mul_f32 v84, v84, v92
    v_mul_f32 v85, v85, v93
    v_mul_f32 v86, v86, v94
    v_mul_f32 v87, v87, v95
    v_mfma_f32_4x4x4_16b_bf16 v[96:99], v[10:11], v[108:109], v[80:83]
    s_nop 0
    v_mfma_f32_4x4x4_16b_bf16 v[100:103], v[10:11], v[110:111], v[84:87]
    s_nop 2
    v_cvt_pk_bf16_f32 v36, v96, v97
    v_cvt_pk_bf16_f32 v37, v98, v99
    v_cvt_pk_bf16_f32 v38, v100, v101
    v_cvt_pk_bf16_f32 v39, v102, v103
    buffer_store_dwordx4 v[36:39], v120, s[12:15], 0 offen
    s_cmp_ge_u32 s32, 4
    s_cbranch_scc1 L2_f6
    v_mfma_f32_4x4x4_16b_bf16 v[96:99], v[10:11], v[60:61], 0
    v_mfma_f32_4x4x4_16b_bf16 v[100:103], v[10:11], v[62:63], 0
    s_nop 0
    v_mfma_f32_4x4x4_16b_bf16 v[96:99], v[10:11], v[64:65], v[96:99]
    v_mfma_f32_4x4x4_16b_bf16 v[100:103], v[10:11], v[66:67], v[100:103]
    s_nop 0
    v_mfma_f32_4x4x4_16b_bf16 v[96:99], v[10:11], v[68:69], v[96:99]
    v_mfma_f32_4x4x4_16b_bf16 v[100:103], v[10:11], v[70:71], v[100:103]
    s_nop 0
    v_mfma_f32_4x4x4_16b_bf16 v[96:99], v[10:11], v[72:73], v[96:99]
    v_mfma_f32_4x4x4_16b_bf16 v[100:103], v[10:11], v[74:75], v[100:103]
    s_nop 3
    v_mul_f32 v96, v96, v16
    v_mul_f32 v97, v97, v17
    v_mul_f32 v98, v98, v18
    v_mul_f32 v99, v99, v19
    v_cvt_pk_bf16_f32 v60, v96, v97
    v_cvt_pk_bf16_f32 v61, v98, v99
    v_mul_f32 v100, v100, v20
    v_mul_f32 v101, v101, v21
    v_mul_f32 v102, v102, v22
    v_mul_f32 v103, v103, v23
    v_cvt_pk_bf16_f32 v62, v100, v101
    v_cvt_pk_bf16_f32 v63, v102, v103
    v_mfma_f32_4x4x4_16b_bf16 v[16:19], v[56:57], v[60:61], 0
    s_nop 0
    v_mfma_f32_4x4x4_16b_bf16 v[20:23], v[56:57], v[62:63], 0
    s_nop 2
    v_mul_f32 v16, v16, v24
    v_mul_f32 v17, v17, v25
    v_mul_f32 v18, v18, v26
    v_mul_f32 v19, v19, v27
    v_mul_f32 v20, v20, v28
    v_mul_f32 v21, v21, v29
    v_mul_f32 v22, v22, v30
    v_mul_f32 v23, v23, v31
    v_mfma_f32_4x4x4_16b_bf16 v[96:99], v[10:11], v[112:113], v[16:19]
    s_nop 0
    v_mfma_f32_4x4x4_16b_bf16 v[100:103], v[10:11], v[114:115], v[20:23]
    s_nop 2
    v_cvt_pk_bf16_f32 v64, v96, v97
    v_cvt_pk_bf16_f32 v65, v98, v99
    v_cvt_pk_bf16_f32 v66, v100, v101
    v_cvt_pk_bf16_f32 v67, v102, v103
    buffer_store_dwordx4 v[64:67], v121, s[12:15], 0 offen
L2_f6:
L2_end:
    s_endpgm
L2_slow:
    s_lshr_b32 s35, s42, 2
    s_mul_i32 s50, s32, 80
    s_add_u32 s57, s50, 80
    s_and_b32 s3, s42, 3
    s_lshl_b32 s53, s3, 3
    s_add_u32 s53, s53, s39
    s_and_b32 s3, s35, 2
    s_lshl_b32 s3, s3, 1
    s_add_u32 s53, s53, s3
    s_and_b32 s54, s35, 1
    s_lshl_b32 s54, s54, 4
L2_sl_seg:
    s_mul_i32 s56, s50, 173056
    s_and_b32 s3, s50, 3
    s_lshl_b32 s3, s3, 5
    s_add_u32 s3, s3, s56
    s_add_u32 s3, s3, s53
    s_add_u32 s55, s3, 32
    s_buffer_load_dword s51, s[12:15], s3
    s_buffer_load_dword s52, s[12:15], s55
    s_waitcnt lgkmcnt(0)
    s_lshr_b32 s51, s51, s54
    s_and_b32 s51, s51, 0xffff
    s_lshr_b32 s52, s52, s54
    s_and_b32 s52, s52, 0xffff
L2_sl_rec:
    s_cmp_ge_u32 s51, s52
    s_cbranch_scc1 L2_sl_next
    v_mbcnt_lo_u32_b32 v102, -1, 0
    v_mbcnt_hi_u32_b32 v102, -1, v102
    v_add_u32 v102, s51, v102
    v_and_b32 v103, -4, v102
    v_lshl_add_u32 v104, v102, 2, v103
    v_lshl_add_u32 v105, v103, 2, v102
    v_cmp_gt_u32 vcc, s52, v102
    s_mov_b64 exec, vcc
    buffer_load_dword v106, v104, s[8:11], s56 offen
    buffer_load_ubyte v107, v105, s[8:11], s56 offen offset:16
    s_waitcnt vmcnt(0)
    v_lshrrev_b32 v98, 14, v106
    v_and_b32 v98, v5, v98
    ds_read_b64 v[100:101], v98
    v_perm_b32 v97, v106, v107, s44
    v_and_b32 v96, v5, v106
    v_bitop3_b32 v103, v106, 0.5, -0.5 bitop3:0xa8
    v_bitop3_b32 v97, v6, v97, v103 bitop3:0xca
    s_waitcnt lgkmcnt(0)
    v_mfma_f32_4x4x4_16b_bf16 v[88:91], v[8:9], v[100:101], 0
    s_nop 4
    v_mul_f32 v88, v97, v88
    v_mul_f32 v89, v97, v89
    v_mul_f32 v90, v97, v90
    v_mul_f32 v91, v97, v91
    v_cvt_pk_bf16_f32 v88, v88, v89
    v_cvt_pk_bf16_f32 v89, v90, v91
    ds_pk_add_bf16 v96, v88 offset:65408
    ds_pk_add_bf16 v96, v89 offset:65412
    s_mov_b64 exec, -1
    s_add_u32 s51, s51, 64
    s_branch L2_sl_rec
L2_sl_next:
    s_add_u32 s50, s50, 1
    s_cmp_lt_u32 s50, s57
    s_cbranch_scc1 L2_sl_seg
    s_waitcnt lgkmcnt(0)
    s_cmp_eq_u32 s42, 0
    s_cbranch_scc1 L2_ret0
    s_cmp_eq_u32 s42, 1
    s_cbranch_scc1 L2_ret1
    s_cmp_eq_u32 s42, 14
    s_cbranch_scc1 L2_ret6
    s_cmp_eq_u32 s42, 15
    s_cbranch_scc1 L2_ret7
    s_and_b32 s3, s42, 3
    s_cmp_eq_u32 s3, 2
    s_cbranch_scc1 L2_ret2
    s_cmp_eq_u32 s3, 3
    s_cbranch_scc1 L2_ret3
    s_cmp_eq_u32 s3, 0
    s_cbranch_scc1 L2_ret4
    s_branch L2_ret5
L2_xo1:
    v_cmp_lt_u32 vcc, 20, v99
    s_mov_b32 s43, 1
    s_cbranch_vccz L2_xp1
    v_cmp_lt_u32 vcc, 32, v99
    v_cmp_lt_u32 s[58:59], 31, v88
    s_mov_b32 s43, 2
    s_or_b64 vcc, vcc, s[58:59]
    s_cbranch_scc0 L2_xp1
    s_mov_b32 s37, 0x10000
    s_branch L2_xp1
L2_xa2:
    s_cmp_eq_u32 s43, 1
    s_cbranch_scc1 L2_xc2
    v_lshlrev_b32 v89, 0, v96
    v_add_u32 v90, 140, v97
    v_bitop3_b32 v90, v89, v45, v90 bitop3:0x6a
    ds_write_b32 v98, v90 offset:28
    v_lshlrev_b32 v89, 4, v96
    v_add_u32 v90, 120, v97
    v_bitop3_b32 v90, v89, v45, v90 bitop3:0x6a
    ds_write_b32 v98, v90 offset:24
    v_lshlrev_b32 v89, 8, v96
    v_add_u32 v90, 100, v97
    v_bitop3_b32 v90, v89, v45, v90 bitop3:0x6a
    ds_write_b32 v98, v90 offset:20
L2_xc2:
    v_lshlrev_b32 v89, 12, v96
    v_add_u32 v90, 80, v97
    v_bitop3_b32 v90, v89, v45, v90 bitop3:0x6a
    ds_write_b32 v98, v90 offset:16
    s_branch L2_xb2
L2_xe2:
    v_cmp_lt_u32 vcc, 32, v99
    v_cmp_lt_u32 s[58:59], 31, v88
    v_lshrrev_b32 v89, 16, v96
    v_add_u32 v97, 80, v97
    s_or_b64 vcc, vcc, s[58:59]
    s_cbranch_scc1 L2_xs2
    v_lshlrev_b32 v89, v1, v89
    v_and_b32 v89, v45, v89
    v_cmp_ne_u32 vcc, 0, v89
    v_xor_b32 v90, v97, v89
    s_add_u32 s3, s37, s38
    v_mbcnt_lo_u32_b32 v98, vcc_lo, 0
    v_mbcnt_hi_u32_b32 v98, vcc_hi, v98
    s_bcnt1_i32_b64 s41, vcc
    v_lshl_add_u32 v98, v98, 2, s3
    s_mov_b64 exec, vcc
    ds_write_b32 v98, v90
    s_mov_b64 exec, -1
    s_lshl2_add_u32 s37, s41, s37
    s_branch L2_xr2
L2_xf2:
    s_waitcnt lgkmcnt(0)
    s_cmp_gt_u32 s37, 1024
    s_cbranch_scc1 L2_xs2
    v_mov_b32 v43, -1
    s_cmp_ge_u32 s37, 512
    s_cbranch_scc1 L2_xg2
    v_mov_b32 v42, -1
    s_cmp_ge_u32 s37, 256
    s_cbranch_scc1 L2_xg2
    v_mov_b32 v41, -1
    s_branch L2_xg2
L2_xs2:
    s_waitcnt lgkmcnt(0)
    v_mov_b32 v40, -1
    v_mov_b32 v41, -1
    v_mov_b32 v42, -1
    v_mov_b32 v43, -1
    s_add_u32 s3, s42, 0
    s_bitset1_b32 s36, s3
    s_branch L2_xg2
L2_xo3:
    v_cmp_lt_u32 vcc, 20, v99
    s_mov_b32 s43, 1
    s_cbranch_vccz L2_xp3
    v_cmp_lt_u32 vcc, 32, v99
    v_cmp_lt_u32 s[58:59], 31, v88
    s_mov_b32 s43, 2
    s_or_b64 vcc, vcc, s[58:59]
    s_cbranch_scc0 L2_xp3
    s_mov_b32 s37, 0x10000
    s_branch L2_xp3
L2_xa4:
    s_cmp_eq_u32 s43, 1
    s_cbranch_scc1 L2_xc4
    v_lshlrev_b32 v89, 0, v96
    v_add_u32 v90, 140, v97
    v_bitop3_b32 v90, v89, v45, v90 bitop3:0x6a
    ds_write_b32 v98, v90 offset:28
    v_lshlrev_b32 v89, 4, v96
    v_add_u32 v90, 120, v97
    v_bitop3_b32 v90, v89, v45, v90 bitop3:0x6a
    ds_write_b32 v98, v90 offset:24
    v_lshlrev_b32 v89, 8, v96
    v_add_u32 v90, 100, v97
    v_bitop3_b32 v90, v89, v45, v90 bitop3:0x6a
    ds_write_b32 v98, v90 offset:20
L2_xc4:
    v_lshlrev_b32 v89, 12, v96
    v_add_u32 v90, 80, v97
    v_bitop3_b32 v90, v89, v45, v90 bitop3:0x6a
    ds_write_b32 v98, v90 offset:16
    s_branch L2_xb4
L2_xe4:
    v_cmp_lt_u32 vcc, 32, v99
    v_cmp_lt_u32 s[58:59], 31, v88
    v_lshrrev_b32 v89, 16, v96
    v_add_u32 v97, 80, v97
    s_or_b64 vcc, vcc, s[58:59]
    s_cbranch_scc1 L2_xs4
    v_lshlrev_b32 v89, v1, v89
    v_and_b32 v89, v45, v89
    v_cmp_ne_u32 vcc, 0, v89
    v_xor_b32 v90, v97, v89
    s_add_u32 s3, s37, s38
    v_mbcnt_lo_u32_b32 v98, vcc_lo, 0
    v_mbcnt_hi_u32_b32 v98, vcc_hi, v98
    s_bcnt1_i32_b64 s41, vcc
    v_lshl_add_u32 v98, v98, 2, s3
    s_mov_b64 exec, vcc
    ds_write_b32 v98, v90
    s_mov_b64 exec, -1
    s_lshl2_add_u32 s37, s41, s37
    s_branch L2_xr4
L2_xf4:
    s_waitcnt lgkmcnt(0)
    s_cmp_gt_u32 s37, 1024
    s_cbranch_scc1 L2_xs4
    v_mov_b32 v43, -1
    s_cmp_ge_u32 s37, 512
    s_cbranch_scc1 L2_xg4
    v_mov_b32 v42, -1
    s_cmp_ge_u32 s37, 256
    s_cbranch_scc1 L2_xg4
    v_mov_b32 v41, -1
    s_branch L2_xg4
L2_xs4:
    s_waitcnt lgkmcnt(0)
    v_mov_b32 v40, -1
    v_mov_b32 v41, -1
    v_mov_b32 v42, -1
    v_mov_b32 v43, -1
    s_add_u32 s3, s42, 1
    s_bitset1_b32 s36, s3
    s_branch L2_xg4
L2_c5:
    s_mov_b64 s[50:51], vcc
    s_lshl_b64 s[52:53], s[82:83], 1
    s_andn2_b64 s[52:53], s[52:53], s[80:81]
    s_andn2_b64 s[52:53], s[52:53], s[50:51]
    s_or_b64 s[80:81], s[80:81], s[52:53]
    s_not_b64 vcc, s[52:53]
    s_mov_b64 exec, -1
    v_cndmask_b32_dpp v84, v84, v84, vcc wave_shr:1 row_mask:0xf bank_mask:0xf
    v_cndmask_b32_dpp v85, v85, v85, vcc wave_shr:1 row_mask:0xf bank_mask:0xf
    s_lshr_b64 s[52:53], s[52:53], 1
    v_cndmask_b32_dpp v86, v86, v86, vcc wave_shr:1 row_mask:0xf bank_mask:0xf
    v_cndmask_b32_dpp v87, v87, v87, vcc wave_shr:1 row_mask:0xf bank_mask:0xf
    s_andn2_b64 s[82:83], s[82:83], s[52:53]
    v_cndmask_b32_dpp v7, v7, v7, vcc wave_shr:1 row_mask:0xf bank_mask:0xf
    s_mov_b64 vcc, s[50:51]
    s_mov_b64 exec, s[50:51]
    s_cbranch_scc0 L2_d5
    s_mov_b64 exec, s[82:83]
    s_nop 1
    v_mfma_f32_4x4x4_16b_bf16 v[88:91], v[12:13], v[84:85], 0
    s_nop 1
    v_mfma_f32_4x4x4_16b_bf16 v[88:91], v[10:11], v[86:87], v[88:91]
    s_nop 4
    v_cvt_pk_bf16_f32 v88, v88, v89
    v_cvt_pk_bf16_f32 v89, v90, v91
    ds_pk_add_bf16 v7, v88 offset:65408
    ds_pk_add_bf16 v7, v89 offset:65412
    s_mov_b64 exec, vcc
    s_branch L2_d5
L2_c6:
    s_mov_b64 s[50:51], vcc
    s_lshl_b64 s[52:53], s[82:83], 1
    s_andn2_b64 s[52:53], s[52:53], s[80:81]
    s_andn2_b64 s[52:53], s[52:53], s[50:51]
    s_or_b64 s[80:81], s[80:81], s[52:53]
    s_not_b64 vcc, s[52:53]
    s_mov_b64 exec, -1
    v_cndmask_b32_dpp v84, v84, v84, vcc wave_shr:1 row_mask:0xf bank_mask:0xf
    v_cndmask_b32_dpp v85, v85, v85, vcc wave_shr:1 row_mask:0xf bank_mask:0xf
    s_lshr_b64 s[52:53], s[52:53], 1
    v_cndmask_b32_dpp v86, v86, v86, vcc wave_shr:1 row_mask:0xf bank_mask:0xf
    v_cndmask_b32_dpp v87, v87, v87, vcc wave_shr:1 row_mask:0xf bank_mask:0xf
    s_andn2_b64 s[82:83], s[82:83], s[52:53]
    v_cndmask_b32_dpp v7, v7, v7, vcc wave_shr:1 row_mask:0xf bank_mask:0xf
    s_mov_b64 vcc, s[50:51]
    s_mov_b64 exec, s[50:51]
    s_cbranch_scc0 L2_d6
    s_mov_b64 exec, s[82:83]
    s_nop 1
    v_mfma_f32_4x4x4_16b_bf16 v[88:91], v[12:13], v[84:85], 0
    s_nop 1
    v_mfma_f32_4x4x4_16b_bf16 v[88:91], v[10:11], v[86:87], v[88:91]
    s_nop 4
    v_cvt_pk_bf16_f32 v88, v88, v89
    v_cvt_pk_bf16_f32 v89, v90, v91
    ds_pk_add_bf16 v7, v88 offset:65408
    ds_pk_add_bf16 v7, v89 offset:65412
    s_mov_b64 exec, vcc
    s_branch L2_d6
L2_c7:
    s_mov_b64 s[50:51], vcc
    s_lshl_b64 s[52:53], s[82:83], 1
    s_andn2_b64 s[52:53], s[52:53], s[80:81]
    s_andn2_b64 s[52:53], s[52:53], s[50:51]
    s_or_b64 s[80:81], s[80:81], s[52:53]
    s_not_b64 vcc, s[52:53]
    s_mov_b64 exec, -1
    v_cndmask_b32_dpp v84, v84, v84, vcc wave_shr:1 row_mask:0xf bank_mask:0xf
    v_cndmask_b32_dpp v85, v85, v85, vcc wave_shr:1 row_mask:0xf bank_mask:0xf
    s_lshr_b64 s[52:53], s[52:53], 1
    v_cndmask_b32_dpp v86, v86, v86, vcc wave_shr:1 row_mask:0xf bank_mask:0xf
    v_cndmask_b32_dpp v87, v87, v87, vcc wave_shr:1 row_mask:0xf bank_mask:0xf
    s_andn2_b64 s[82:83], s[82:83], s[52:53]
    v_cndmask_b32_dpp v7, v7, v7, vcc wave_shr:1 row_mask:0xf bank_mask:0xf
    s_mov_b64 vcc, s[50:51]
    s_mov_b64 exec, s[50:51]
    s_cbranch_scc0 L2_d7
    s_mov_b64 exec, s[82:83]
    s_nop 1
    v_mfma_f32_4x4x4_16b_bf16 v[88:91], v[12:13], v[84:85], 0
    s_nop 1
    v_mfma_f32_4x4x4_16b_bf16 v[88:91], v[10:11], v[86:87], v[88:91]
    s_nop 4
    v_cvt_pk_bf16_f32 v88, v88, v89
    v_cvt_pk_bf16_f32 v89, v90, v91
    ds_pk_add_bf16 v7, v88 offset:65408
    ds_pk_add_bf16 v7, v89 offset:65412
    s_mov_b64 exec, vcc
    s_branch L2_d7
L2_c8:
    s_mov_b64 s[50:51], vcc
    s_lshl_b64 s[52:53], s[82:83], 1
    s_andn2_b64 s[52:53], s[52:53], s[80:81]
    s_andn2_b64 s[52:53], s[52:53], s[50:51]
    s_or_b64 s[80:81], s[80:81], s[52:53]
    s_not_b64 vcc, s[52:53]
    s_mov_b64 exec, -1
    v_cndmask_b32_dpp v84, v84, v84, vcc wave_shr:1 row_mask:0xf bank_mask:0xf
    v_cndmask_b32_dpp v85, v85, v85, vcc wave_shr:1 row_mask:0xf bank_mask:0xf
    s_lshr_b64 s[52:53], s[52:53], 1
    v_cndmask_b32_dpp v86, v86, v86, vcc wave_shr:1 row_mask:0xf bank_mask:0xf
    v_cndmask_b32_dpp v87, v87, v87, vcc wave_shr:1 row_mask:0xf bank_mask:0xf
    s_andn2_b64 s[82:83], s[82:83], s[52:53]
    v_cndmask_b32_dpp v7, v7, v7, vcc wave_shr:1 row_mask:0xf bank_mask:0xf
    s_mov_b64 vcc, s[50:51]
    s_mov_b64 exec, s[50:51]
    s_cbranch_scc0 L2_d8
    s_mov_b64 exec, s[82:83]
    s_nop 1
    v_mfma_f32_4x4x4_16b_bf16 v[88:91], v[12:13], v[84:85], 0
    s_nop 1
    v_mfma_f32_4x4x4_16b_bf16 v[88:91], v[10:11], v[86:87], v[88:91]
    s_nop 4
    v_cvt_pk_bf16_f32 v88, v88, v89
    v_cvt_pk_bf16_f32 v89, v90, v91
    ds_pk_add_bf16 v7, v88 offset:65408
    ds_pk_add_bf16 v7, v89 offset:65412
    s_mov_b64 exec, vcc
    s_branch L2_d8
L2_xo9:
    v_cmp_lt_u32 vcc, 20, v99
    s_mov_b32 s43, 1
    s_cbranch_vccz L2_xp9
    v_cmp_lt_u32 vcc, 32, v99
    v_cmp_lt_u32 s[58:59], 31, v88
    s_mov_b32 s43, 2
    s_or_b64 vcc, vcc, s[58:59]
    s_cbranch_scc0 L2_xp9
    s_mov_b32 s37, 0x10000
    s_branch L2_xp9
L2_c10:
    s_mov_b64 s[50:51], vcc
    s_lshl_b64 s[52:53], s[82:83], 1
    s_andn2_b64 s[52:53], s[52:53], s[80:81]
    s_andn2_b64 s[52:53], s[52:53], s[50:51]
    s_or_b64 s[80:81], s[80:81], s[52:53]
    s_not_b64 vcc, s[52:53]
    s_mov_b64 exec, -1
    v_cndmask_b32_dpp v84, v84, v84, vcc wave_shr:1 row_mask:0xf bank_mask:0xf
    v_cndmask_b32_dpp v85, v85, v85, vcc wave_shr:1 row_mask:0xf bank_mask:0xf
    s_lshr_b64 s[52:53], s[52:53], 1
    v_cndmask_b32_dpp v86, v86, v86, vcc wave_shr:1 row_mask:0xf bank_mask:0xf
    v_cndmask_b32_dpp v87, v87, v87, vcc wave_shr:1 row_mask:0xf bank_mask:0xf
    s_andn2_b64 s[82:83], s[82:83], s[52:53]
    v_cndmask_b32_dpp v7, v7, v7, vcc wave_shr:1 row_mask:0xf bank_mask:0xf
    s_mov_b64 vcc, s[50:51]
    s_mov_b64 exec, s[50:51]
    s_cbranch_scc0 L2_d10
    s_mov_b64 exec, s[82:83]
    s_nop 1
    v_mfma_f32_4x4x4_16b_bf16 v[88:91], v[12:13], v[84:85], 0
    s_nop 1
    v_mfma_f32_4x4x4_16b_bf16 v[88:91], v[10:11], v[86:87], v[88:91]
    s_nop 4
    v_cvt_pk_bf16_f32 v88, v88, v89
    v_cvt_pk_bf16_f32 v89, v90, v91
    ds_pk_add_bf16 v7, v88 offset:65408
    ds_pk_add_bf16 v7, v89 offset:65412
    s_mov_b64 exec, vcc
    s_branch L2_d10
L2_c11:
    s_mov_b64 s[50:51], vcc
    s_lshl_b64 s[52:53], s[82:83], 1
    s_andn2_b64 s[52:53], s[52:53], s[80:81]
    s_andn2_b64 s[52:53], s[52:53], s[50:51]
    s_or_b64 s[80:81], s[80:81], s[52:53]
    s_not_b64 vcc, s[52:53]
    s_mov_b64 exec, -1
    v_cndmask_b32_dpp v84, v84, v84, vcc wave_shr:1 row_mask:0xf bank_mask:0xf
    v_cndmask_b32_dpp v85, v85, v85, vcc wave_shr:1 row_mask:0xf bank_mask:0xf
    s_lshr_b64 s[52:53], s[52:53], 1
    v_cndmask_b32_dpp v86, v86, v86, vcc wave_shr:1 row_mask:0xf bank_mask:0xf
    v_cndmask_b32_dpp v87, v87, v87, vcc wave_shr:1 row_mask:0xf bank_mask:0xf
    s_andn2_b64 s[82:83], s[82:83], s[52:53]
    v_cndmask_b32_dpp v7, v7, v7, vcc wave_shr:1 row_mask:0xf bank_mask:0xf
    s_mov_b64 vcc, s[50:51]
    s_mov_b64 exec, s[50:51]
    s_cbranch_scc0 L2_d11
    s_mov_b64 exec, s[82:83]
    s_nop 1
    v_mfma_f32_4x4x4_16b_bf16 v[88:91], v[12:13], v[84:85], 0
    s_nop 1
    v_mfma_f32_4x4x4_16b_bf16 v[88:91], v[10:11], v[86:87], v[88:91]
    s_nop 4
    v_cvt_pk_bf16_f32 v88, v88, v89
    v_cvt_pk_bf16_f32 v89, v90, v91
    ds_pk_add_bf16 v7, v88 offset:65408
    ds_pk_add_bf16 v7, v89 offset:65412
    s_mov_b64 exec, vcc
    s_branch L2_d11
L2_c12:
    s_mov_b64 s[50:51], vcc
    s_lshl_b64 s[52:53], s[82:83], 1
    s_andn2_b64 s[52:53], s[52:53], s[80:81]
    s_andn2_b64 s[52:53], s[52:53], s[50:51]
    s_or_b64 s[80:81], s[80:81], s[52:53]
    s_not_b64 vcc, s[52:53]
    s_mov_b64 exec, -1
    v_cndmask_b32_dpp v84, v84, v84, vcc wave_shr:1 row_mask:0xf bank_mask:0xf
    v_cndmask_b32_dpp v85, v85, v85, vcc wave_shr:1 row_mask:0xf bank_mask:0xf
    s_lshr_b64 s[52:53], s[52:53], 1
    v_cndmask_b32_dpp v86, v86, v86, vcc wave_shr:1 row_mask:0xf bank_mask:0xf
    v_cndmask_b32_dpp v87, v87, v87, vcc wave_shr:1 row_mask:0xf bank_mask:0xf
    s_andn2_b64 s[82:83], s[82:83], s[52:53]
    v_cndmask_b32_dpp v7, v7, v7, vcc wave_shr:1 row_mask:0xf bank_mask:0xf
    s_mov_b64 vcc, s[50:51]
    s_mov_b64 exec, s[50:51]
    s_cbranch_scc0 L2_d12
    s_mov_b64 exec, s[82:83]
    s_nop 1
    v_mfma_f32_4x4x4_16b_bf16 v[88:91], v[12:13], v[84:85], 0
    s_nop 1
    v_mfma_f32_4x4x4_16b_bf16 v[88:91], v[10:11], v[86:87], v[88:91]
    s_nop 4
    v_cvt_pk_bf16_f32 v88, v88, v89
    v_cvt_pk_bf16_f32 v89, v90, v91
    ds_pk_add_bf16 v7, v88 offset:65408
    ds_pk_add_bf16 v7, v89 offset:65412
    s_mov_b64 exec, vcc
    s_branch L2_d12
L2_c13:
    s_mov_b64 s[50:51], vcc
    s_lshl_b64 s[52:53], s[82:83], 1
    s_andn2_b64 s[52:53], s[52:53], s[80:81]
    s_andn2_b64 s[52:53], s[52:53], s[50:51]
    s_or_b64 s[80:81], s[80:81], s[52:53]
    s_not_b64 vcc, s[52:53]
    s_mov_b64 exec, -1
    v_cndmask_b32_dpp v84, v84, v84, vcc wave_shr:1 row_mask:0xf bank_mask:0xf
    v_cndmask_b32_dpp v85, v85, v85, vcc wave_shr:1 row_mask:0xf bank_mask:0xf
    s_lshr_b64 s[52:53], s[52:53], 1
    v_cndmask_b32_dpp v86, v86, v86, vcc wave_shr:1 row_mask:0xf bank_mask:0xf
    v_cndmask_b32_dpp v87, v87, v87, vcc wave_shr:1 row_mask:0xf bank_mask:0xf
    s_andn2_b64 s[82:83], s[82:83], s[52:53]
    v_cndmask_b32_dpp v7, v7, v7, vcc wave_shr:1 row_mask:0xf bank_mask:0xf
    s_mov_b64 vcc, s[50:51]
    s_mov_b64 exec, s[50:51]
    s_cbranch_scc0 L2_d13
    s_mov_b64 exec, s[82:83]
    s_nop 1
    v_mfma_f32_4x4x4_16b_bf16 v[88:91], v[12:13], v[84:85], 0
    s_nop 1
    v_mfma_f32_4x4x4_16b_bf16 v[88:91], v[10:11], v[86:87], v[88:91]
    s_nop 4
    v_cvt_pk_bf16_f32 v88, v88, v89
    v_cvt_pk_bf16_f32 v89, v90, v91
    ds_pk_add_bf16 v7, v88 offset:65408
    ds_pk_add_bf16 v7, v89 offset:65412
    s_mov_b64 exec, vcc
    s_branch L2_d13
L2_c14:
    s_mov_b64 s[50:51], vcc
    s_lshl_b64 s[52:53], s[82:83], 1
    s_andn2_b64 s[52:53], s[52:53], s[80:81]
    s_andn2_b64 s[52:53], s[52:53], s[50:51]
    s_or_b64 s[80:81], s[80:81], s[52:53]
    s_not_b64 vcc, s[52:53]
    s_mov_b64 exec, -1
    v_cndmask_b32_dpp v84, v84, v84, vcc wave_shr:1 row_mask:0xf bank_mask:0xf
    v_cndmask_b32_dpp v85, v85, v85, vcc wave_shr:1 row_mask:0xf bank_mask:0xf
    s_lshr_b64 s[52:53], s[52:53], 1
    v_cndmask_b32_dpp v86, v86, v86, vcc wave_shr:1 row_mask:0xf bank_mask:0xf
    v_cndmask_b32_dpp v87, v87, v87, vcc wave_shr:1 row_mask:0xf bank_mask:0xf
    s_andn2_b64 s[82:83], s[82:83], s[52:53]
    v_cndmask_b32_dpp v7, v7, v7, vcc wave_shr:1 row_mask:0xf bank_mask:0xf
    s_mov_b64 vcc, s[50:51]
    s_mov_b64 exec, s[50:51]
    s_cbranch_scc0 L2_d14
    s_mov_b64 exec, s[82:83]
    s_nop 1
    v_mfma_f32_4x4x4_16b_bf16 v[88:91], v[12:13], v[84:85], 0
    s_nop 1
    v_mfma_f32_4x4x4_16b_bf16 v[88:91], v[10:11], v[86:87], v[88:91]
    s_nop 4
    v_cvt_pk_bf16_f32 v88, v88, v89
    v_cvt_pk_bf16_f32 v89, v90, v91
    ds_pk_add_bf16 v7, v88 offset:65408
    ds_pk_add_bf16 v7, v89 offset:65412
    s_mov_b64 exec, vcc
    s_branch L2_d14
L2_c15:
    s_mov_b64 s[50:51], vcc
    s_lshl_b64 s[52:53], s[82:83], 1
    s_andn2_b64 s[52:53], s[52:53], s[80:81]
    s_andn2_b64 s[52:53], s[52:53], s[50:51]
    s_or_b64 s[80:81], s[80:81], s[52:53]
    s_not_b64 vcc, s[52:53]
    s_mov_b64 exec, -1
    v_cndmask_b32_dpp v84, v84, v84, vcc wave_shr:1 row_mask:0xf bank_mask:0xf
    v_cndmask_b32_dpp v85, v85, v85, vcc wave_shr:1 row_mask:0xf bank_mask:0xf
    s_lshr_b64 s[52:53], s[52:53], 1
    v_cndmask_b32_dpp v86, v86, v86, vcc wave_shr:1 row_mask:0xf bank_mask:0xf
    v_cndmask_b32_dpp v87, v87, v87, vcc wave_shr:1 row_mask:0xf bank_mask:0xf
    s_andn2_b64 s[82:83], s[82:83], s[52:53]
    v_cndmask_b32_dpp v7, v7, v7, vcc wave_shr:1 row_mask:0xf bank_mask:0xf
    s_mov_b64 vcc, s[50:51]
    s_mov_b64 exec, s[50:51]
    s_cbranch_scc0 L2_d15
    s_mov_b64 exec, s[82:83]
    s_nop 1
    v_mfma_f32_4x4x4_16b_bf16 v[88:91], v[12:13], v[84:85], 0
    s_nop 1
    v_mfma_f32_4x4x4_16b_bf16 v[88:91], v[10:11], v[86:87], v[88:91]
    s_nop 4
    v_cvt_pk_bf16_f32 v88, v88, v89
    v_cvt_pk_bf16_f32 v89, v90, v91
    ds_pk_add_bf16 v7, v88 offset:65408
    ds_pk_add_bf16 v7, v89 offset:65412
    s_mov_b64 exec, vcc
    s_branch L2_d15
L2_c16:
    s_mov_b64 s[50:51], vcc
    s_lshl_b64 s[52:53], s[82:83], 1
    s_andn2_b64 s[52:53], s[52:53], s[80:81]
    s_andn2_b64 s[52:53], s[52:53], s[50:51]
    s_or_b64 s[80:81], s[80:81], s[52:53]
    s_not_b64 vcc, s[52:53]
    s_mov_b64 exec, -1
    v_cndmask_b32_dpp v84, v84, v84, vcc wave_shr:1 row_mask:0xf bank_mask:0xf
    v_cndmask_b32_dpp v85, v85, v85, vcc wave_shr:1 row_mask:0xf bank_mask:0xf
    s_lshr_b64 s[52:53], s[52:53], 1
    v_cndmask_b32_dpp v86, v86, v86, vcc wave_shr:1 row_mask:0xf bank_mask:0xf
    v_cndmask_b32_dpp v87, v87, v87, vcc wave_shr:1 row_mask:0xf bank_mask:0xf
    s_andn2_b64 s[82:83], s[82:83], s[52:53]
    v_cndmask_b32_dpp v7, v7, v7, vcc wave_shr:1 row_mask:0xf bank_mask:0xf
    s_mov_b64 vcc, s[50:51]
    s_mov_b64 exec, s[50:51]
    s_cbranch_scc0 L2_d16
    s_mov_b64 exec, s[82:83]
    s_nop 1
    v_mfma_f32_4x4x4_16b_bf16 v[88:91], v[12:13], v[84:85], 0
    s_nop 1
    v_mfma_f32_4x4x4_16b_bf16 v[88:91], v[10:11], v[86:87], v[88:91]
    s_nop 4
    v_cvt_pk_bf16_f32 v88, v88, v89
    v_cvt_pk_bf16_f32 v89, v90, v91
    ds_pk_add_bf16 v7, v88 offset:65408
    ds_pk_add_bf16 v7, v89 offset:65412
    s_mov_b64 exec, vcc
    s_branch L2_d16
L2_c17:
    s_mov_b64 s[50:51], vcc
    s_lshl_b64 s[52:53], s[82:83], 1
    s_andn2_b64 s[52:53], s[52:53], s[80:81]
    s_andn2_b64 s[52:53], s[52:53], s[50:51]
    s_or_b64 s[80:81], s[80:81], s[52:53]
    s_not_b64 vcc, s[52:53]
    s_mov_b64 exec, -1
    v_cndmask_b32_dpp v84, v84, v84, vcc wave_shr:1 row_mask:0xf bank_mask:0xf
    v_cndmask_b32_dpp v85, v85, v85, vcc wave_shr:1 row_mask:0xf bank_mask:0xf
    s_lshr_b64 s[52:53], s[52:53], 1
    v_cndmask_b32_dpp v86, v86, v86, vcc wave_shr:1 row_mask:0xf bank_mask:0xf
    v_cndmask_b32_dpp v87, v87, v87, vcc wave_shr:1 row_mask:0xf bank_mask:0xf
    s_andn2_b64 s[82:83], s[82:83], s[52:53]
    v_cndmask_b32_dpp v7, v7, v7, vcc wave_shr:1 row_mask:0xf bank_mask:0xf
    s_mov_b64 vcc, s[50:51]
    s_mov_b64 exec, s[50:51]
    s_cbranch_scc0 L2_d17
    s_mov_b64 exec, s[82:83]
    s_nop 1
    v_mfma_f32_4x4x4_16b_bf16 v[88:91], v[12:13], v[84:85], 0
    s_nop 1
    v_mfma_f32_4x4x4_16b_bf16 v[88:91], v[10:11], v[86:87], v[88:91]
    s_nop 4
    v_cvt_pk_bf16_f32 v88, v88, v89
    v_cvt_pk_bf16_f32 v89, v90, v91
    ds_pk_add_bf16 v7, v88 offset:65408
    ds_pk_add_bf16 v7, v89 offset:65412
    s_mov_b64 exec, vcc
    s_branch L2_d17
L2_xa18:
    s_cmp_eq_u32 s43, 1
    s_cbranch_scc1 L2_xc18
    v_lshlrev_b32 v89, 0, v96
    v_add_u32 v90, 140, v97
    v_bitop3_b32 v90, v89, v45, v90 bitop3:0x6a
    ds_write_b32 v98, v90 offset:28
    v_lshlrev_b32 v89, 4, v96
    v_add_u32 v90, 120, v97
    v_bitop3_b32 v90, v89, v45, v90 bitop3:0x6a
    ds_write_b32 v98, v90 offset:24
    v_lshlrev_b32 v89, 8, v96
    v_add_u32 v90, 100, v97
    v_bitop3_b32 v90, v89, v45, v90 bitop3:0x6a
    ds_write_b32 v98, v90 offset:20
L2_xc18:
    v_lshlrev_b32 v89, 12, v96
    v_add_u32 v90, 80, v97
    v_bitop3_b32 v90, v89, v45, v90 bitop3:0x6a
    ds_write_b32 v98, v90 offset:16
    s_branch L2_xb18
L2_xe18:
    v_cmp_lt_u32 vcc, 32, v99
    v_cmp_lt_u32 s[58:59], 31, v88
    v_lshrrev_b32 v89, 16, v96
    v_add_u32 v97, 80, v97
    s_or_b64 vcc, vcc, s[58:59]
    s_cbranch_scc1 L2_xs18
    v_lshlrev_b32 v89, v1, v89
    v_and_b32 v89, v45, v89
    v_cmp_ne_u32 vcc, 0, v89
    v_xor_b32 v90, v97, v89
    s_add_u32 s3, s37, s38
    v_mbcnt_lo_u32_b32 v98, vcc_lo, 0
    v_mbcnt_hi_u32_b32 v98, vcc_hi, v98
    s_bcnt1_i32_b64 s41, vcc
    v_lshl_add_u32 v98, v98, 2, s3
    s_mov_b64 exec, vcc
    ds_write_b32 v98, v90
    s_mov_b64 exec, -1
    s_lshl2_add_u32 s37, s41, s37
    s_branch L2_xr18
L2_xf18:
    s_waitcnt lgkmcnt(0)
    s_cmp_gt_u32 s37, 1024
    s_cbranch_scc1 L2_xs18
    v_mov_b32 v43, -1
    s_cmp_ge_u32 s37, 512
    s_cbranch_scc1 L2_xg18
    v_mov_b32 v42, -1
    s_cmp_ge_u32 s37, 256
    s_cbranch_scc1 L2_xg18
    v_mov_b32 v41, -1
    s_branch L2_xg18
L2_xs18:
    s_waitcnt lgkmcnt(0)
    v_mov_b32 v40, -1
    v_mov_b32 v41, -1
    v_mov_b32 v42, -1
    v_mov_b32 v43, -1
    s_add_u32 s3, s42, 2
    s_bitset1_b32 s36, s3
    s_branch L2_xg18
L2_c19:
    s_mov_b64 s[50:51], vcc
    s_lshl_b64 s[52:53], s[82:83], 1
    s_andn2_b64 s[52:53], s[52:53], s[80:81]
    s_andn2_b64 s[52:53], s[52:53], s[50:51]
    s_or_b64 s[80:81], s[80:81], s[52:53]
    s_not_b64 vcc, s[52:53]
    s_mov_b64 exec, -1
    v_cndmask_b32_dpp v84, v84, v84, vcc wave_shr:1 row_mask:0xf bank_mask:0xf
    v_cndmask_b32_dpp v85, v85, v85, vcc wave_shr:1 row_mask:0xf bank_mask:0xf
    s_lshr_b64 s[52:53], s[52:53], 1
    v_cndmask_b32_dpp v86, v86, v86, vcc wave_shr:1 row_mask:0xf bank_mask:0xf
    v_cndmask_b32_dpp v87, v87, v87, vcc wave_shr:1 row_mask:0xf bank_mask:0xf
    s_andn2_b64 s[82:83], s[82:83], s[52:53]
    v_cndmask_b32_dpp v7, v7, v7, vcc wave_shr:1 row_mask:0xf bank_mask:0xf
    s_mov_b64 vcc, s[50:51]
    s_mov_b64 exec, s[50:51]
    s_cbranch_scc0 L2_d19
    s_mov_b64 exec, s[82:83]
    s_nop 1
    v_mfma_f32_4x4x4_16b_bf16 v[88:91], v[12:13], v[84:85], 0
    s_nop 1
    v_mfma_f32_4x4x4_16b_bf16 v[88:91], v[10:11], v[86:87], v[88:91]
    s_nop 4
    v_cvt_pk_bf16_f32 v88, v88, v89
    v_cvt_pk_bf16_f32 v89, v90, v91
    ds_pk_add_bf16 v7, v88 offset:65408
    ds_pk_add_bf16 v7, v89 offset:65412
    s_mov_b64 exec, vcc
    s_branch L2_d19
L2_c20:
    s_mov_b64 s[50:51], vcc
    s_lshl_b64 s[52:53], s[82:83], 1
    s_andn2_b64 s[52:53], s[52:53], s[80:81]
    s_andn2_b64 s[52:53], s[52:53], s[50:51]
    s_or_b64 s[80:81], s[80:81], s[52:53]
    s_not_b64 vcc, s[52:53]
    s_mov_b64 exec, -1
    v_cndmask_b32_dpp v84, v84, v84, vcc wave_shr:1 row_mask:0xf bank_mask:0xf
    v_cndmask_b32_dpp v85, v85, v85, vcc wave_shr:1 row_mask:0xf bank_mask:0xf
    s_lshr_b64 s[52:53], s[52:53], 1
    v_cndmask_b32_dpp v86, v86, v86, vcc wave_shr:1 row_mask:0xf bank_mask:0xf
    v_cndmask_b32_dpp v87, v87, v87, vcc wave_shr:1 row_mask:0xf bank_mask:0xf
    s_andn2_b64 s[82:83], s[82:83], s[52:53]
    v_cndmask_b32_dpp v7, v7, v7, vcc wave_shr:1 row_mask:0xf bank_mask:0xf
    s_mov_b64 vcc, s[50:51]
    s_mov_b64 exec, s[50:51]
    s_cbranch_scc0 L2_d20
    s_mov_b64 exec, s[82:83]
    s_nop 1
    v_mfma_f32_4x4x4_16b_bf16 v[88:91], v[12:13], v[84:85], 0
    s_nop 1
    v_mfma_f32_4x4x4_16b_bf16 v[88:91], v[10:11], v[86:87], v[88:91]
    s_nop 4
    v_cvt_pk_bf16_f32 v88, v88, v89
    v_cvt_pk_bf16_f32 v89, v90, v91
    ds_pk_add_bf16 v7, v88 offset:65408
    ds_pk_add_bf16 v7, v89 offset:65412
    s_mov_b64 exec, vcc
    s_branch L2_d20
L2_c21:
    s_mov_b64 s[50:51], vcc
    s_lshl_b64 s[52:53], s[82:83], 1
    s_andn2_b64 s[52:53], s[52:53], s[80:81]
    s_andn2_b64 s[52:53], s[52:53], s[50:51]
    s_or_b64 s[80:81], s[80:81], s[52:53]
    s_not_b64 vcc, s[52:53]
    s_mov_b64 exec, -1
    v_cndmask_b32_dpp v84, v84, v84, vcc wave_shr:1 row_mask:0xf bank_mask:0xf
    v_cndmask_b32_dpp v85, v85, v85, vcc wave_shr:1 row_mask:0xf bank_mask:0xf
    s_lshr_b64 s[52:53], s[52:53], 1
    v_cndmask_b32_dpp v86, v86, v86, vcc wave_shr:1 row_mask:0xf bank_mask:0xf
    v_cndmask_b32_dpp v87, v87, v87, vcc wave_shr:1 row_mask:0xf bank_mask:0xf
    s_andn2_b64 s[82:83], s[82:83], s[52:53]
    v_cndmask_b32_dpp v7, v7, v7, vcc wave_shr:1 row_mask:0xf bank_mask:0xf
    s_mov_b64 vcc, s[50:51]
    s_mov_b64 exec, s[50:51]
    s_cbranch_scc0 L2_d21
    s_mov_b64 exec, s[82:83]
    s_nop 1
    v_mfma_f32_4x4x4_16b_bf16 v[88:91], v[12:13], v[84:85], 0
    s_nop 1
    v_mfma_f32_4x4x4_16b_bf16 v[88:91], v[10:11], v[86:87], v[88:91]
    s_nop 4
    v_cvt_pk_bf16_f32 v88, v88, v89
    v_cvt_pk_bf16_f32 v89, v90, v91
    ds_pk_add_bf16 v7, v88 offset:65408
    ds_pk_add_bf16 v7, v89 offset:65412
    s_mov_b64 exec, vcc
    s_branch L2_d21
L2_c22:
    s_mov_b64 s[50:51], vcc
    s_lshl_b64 s[52:53], s[82:83], 1
    s_andn2_b64 s[52:53], s[52:53], s[80:81]
    s_andn2_b64 s[52:53], s[52:53], s[50:51]
    s_or_b64 s[80:81], s[80:81], s[52:53]
    s_not_b64 vcc, s[52:53]
    s_mov_b64 exec, -1
    v_cndmask_b32_dpp v84, v84, v84, vcc wave_shr:1 row_mask:0xf bank_mask:0xf
    v_cndmask_b32_dpp v85, v85, v85, vcc wave_shr:1 row_mask:0xf bank_mask:0xf
    s_lshr_b64 s[52:53], s[52:53], 1
    v_cndmask_b32_dpp v86, v86, v86, vcc wave_shr:1 row_mask:0xf bank_mask:0xf
    v_cndmask_b32_dpp v87, v87, v87, vcc wave_shr:1 row_mask:0xf bank_mask:0xf
    s_andn2_b64 s[82:83], s[82:83], s[52:53]
    v_cndmask_b32_dpp v7, v7, v7, vcc wave_shr:1 row_mask:0xf bank_mask:0xf
    s_mov_b64 vcc, s[50:51]
    s_mov_b64 exec, s[50:51]
    s_cbranch_scc0 L2_d22
    s_mov_b64 exec, s[82:83]
    s_nop 1
    v_mfma_f32_4x4x4_16b_bf16 v[88:91], v[12:13], v[84:85], 0
    s_nop 1
    v_mfma_f32_4x4x4_16b_bf16 v[88:91], v[10:11], v[86:87], v[88:91]
    s_nop 4
    v_cvt_pk_bf16_f32 v88, v88, v89
    v_cvt_pk_bf16_f32 v89, v90, v91
    ds_pk_add_bf16 v7, v88 offset:65408
    ds_pk_add_bf16 v7, v89 offset:65412
    s_mov_b64 exec, vcc
    s_branch L2_d22
L2_c23:
    s_mov_b64 s[50:51], vcc
    s_lshl_b64 s[52:53], s[82:83], 1
    s_andn2_b64 s[52:53], s[52:53], s[80:81]
    s_andn2_b64 s[52:53], s[52:53], s[50:51]
    s_or_b64 s[80:81], s[80:81], s[52:53]
    s_not_b64 vcc, s[52:53]
    s_mov_b64 exec, -1
    v_cndmask_b32_dpp v84, v84, v84, vcc wave_shr:1 row_mask:0xf bank_mask:0xf
    v_cndmask_b32_dpp v85, v85, v85, vcc wave_shr:1 row_mask:0xf bank_mask:0xf
    s_lshr_b64 s[52:53], s[52:53], 1
    v_cndmask_b32_dpp v86, v86, v86, vcc wave_shr:1 row_mask:0xf bank_mask:0xf
    v_cndmask_b32_dpp v87, v87, v87, vcc wave_shr:1 row_mask:0xf bank_mask:0xf
    s_andn2_b64 s[82:83], s[82:83], s[52:53]
    v_cndmask_b32_dpp v7, v7, v7, vcc wave_shr:1 row_mask:0xf bank_mask:0xf
    s_mov_b64 vcc, s[50:51]
    s_mov_b64 exec, s[50:51]
    s_cbranch_scc0 L2_d23
    s_mov_b64 exec, s[82:83]
    s_nop 1
    v_mfma_f32_4x4x4_16b_bf16 v[88:91], v[12:13], v[84:85], 0
    s_nop 1
    v_mfma_f32_4x4x4_16b_bf16 v[88:91], v[10:11], v[86:87], v[88:91]
    s_nop 4
    v_cvt_pk_bf16_f32 v88, v88, v89
    v_cvt_pk_bf16_f32 v89, v90, v91
    ds_pk_add_bf16 v7, v88 offset:65408
    ds_pk_add_bf16 v7, v89 offset:65412
    s_mov_b64 exec, vcc
    s_branch L2_d23
L2_c24:
    s_mov_b64 s[50:51], vcc
    s_lshl_b64 s[52:53], s[82:83], 1
    s_andn2_b64 s[52:53], s[52:53], s[80:81]
    s_andn2_b64 s[52:53], s[52:53], s[50:51]
    s_or_b64 s[80:81], s[80:81], s[52:53]
    s_not_b64 vcc, s[52:53]
    s_mov_b64 exec, -1
    v_cndmask_b32_dpp v84, v84, v84, vcc wave_shr:1 row_mask:0xf bank_mask:0xf
    v_cndmask_b32_dpp v85, v85, v85, vcc wave_shr:1 row_mask:0xf bank_mask:0xf
    s_lshr_b64 s[52:53], s[52:53], 1
    v_cndmask_b32_dpp v86, v86, v86, vcc wave_shr:1 row_mask:0xf bank_mask:0xf
    v_cndmask_b32_dpp v87, v87, v87, vcc wave_shr:1 row_mask:0xf bank_mask:0xf
    s_andn2_b64 s[82:83], s[82:83], s[52:53]
    v_cndmask_b32_dpp v7, v7, v7, vcc wave_shr:1 row_mask:0xf bank_mask:0xf
    s_mov_b64 vcc, s[50:51]
    s_mov_b64 exec, s[50:51]
    s_cbranch_scc0 L2_d24
    s_mov_b64 exec, s[82:83]
    s_nop 1
    v_mfma_f32_4x4x4_16b_bf16 v[88:91], v[12:13], v[84:85], 0
    s_nop 1
    v_mfma_f32_4x4x4_16b_bf16 v[88:91], v[10:11], v[86:87], v[88:91]
    s_nop 4
    v_cvt_pk_bf16_f32 v88, v88, v89
    v_cvt_pk_bf16_f32 v89, v90, v91
    ds_pk_add_bf16 v7, v88 offset:65408
    ds_pk_add_bf16 v7, v89 offset:65412
    s_mov_b64 exec, vcc
    s_branch L2_d24
L2_c25:
    s_mov_b64 s[50:51], vcc
    s_lshl_b64 s[52:53], s[82:83], 1
    s_andn2_b64 s[52:53], s[52:53], s[80:81]
    s_andn2_b64 s[52:53], s[52:53], s[50:51]
    s_or_b64 s[80:81], s[80:81], s[52:53]
    s_not_b64 vcc, s[52:53]
    s_mov_b64 exec, -1
    v_cndmask_b32_dpp v84, v84, v84, vcc wave_shr:1 row_mask:0xf bank_mask:0xf
    v_cndmask_b32_dpp v85, v85, v85, vcc wave_shr:1 row_mask:0xf bank_mask:0xf
    s_lshr_b64 s[52:53], s[52:53], 1
    v_cndmask_b32_dpp v86, v86, v86, vcc wave_shr:1 row_mask:0xf bank_mask:0xf
    v_cndmask_b32_dpp v87, v87, v87, vcc wave_shr:1 row_mask:0xf bank_mask:0xf
    s_andn2_b64 s[82:83], s[82:83], s[52:53]
    v_cndmask_b32_dpp v7, v7, v7, vcc wave_shr:1 row_mask:0xf bank_mask:0xf
    s_mov_b64 vcc, s[50:51]
    s_mov_b64 exec, s[50:51]
    s_cbranch_scc0 L2_d25
    s_mov_b64 exec, s[82:83]
    s_nop 1
    v_mfma_f32_4x4x4_16b_bf16 v[88:91], v[12:13], v[84:85], 0
    s_nop 1
    v_mfma_f32_4x4x4_16b_bf16 v[88:91], v[10:11], v[86:87], v[88:91]
    s_nop 4
    v_cvt_pk_bf16_f32 v88, v88, v89
    v_cvt_pk_bf16_f32 v89, v90, v91
    ds_pk_add_bf16 v7, v88 offset:65408
    ds_pk_add_bf16 v7, v89 offset:65412
    s_mov_b64 exec, vcc
    s_branch L2_d25
L2_c26:
    s_mov_b64 s[50:51], vcc
    s_lshl_b64 s[52:53], s[82:83], 1
    s_andn2_b64 s[52:53], s[52:53], s[80:81]
    s_andn2_b64 s[52:53], s[52:53], s[50:51]
    s_or_b64 s[80:81], s[80:81], s[52:53]
    s_not_b64 vcc, s[52:53]
    s_mov_b64 exec, -1
    v_cndmask_b32_dpp v84, v84, v84, vcc wave_shr:1 row_mask:0xf bank_mask:0xf
    v_cndmask_b32_dpp v85, v85, v85, vcc wave_shr:1 row_mask:0xf bank_mask:0xf
    s_lshr_b64 s[52:53], s[52:53], 1
    v_cndmask_b32_dpp v86, v86, v86, vcc wave_shr:1 row_mask:0xf bank_mask:0xf
    v_cndmask_b32_dpp v87, v87, v87, vcc wave_shr:1 row_mask:0xf bank_mask:0xf
    s_andn2_b64 s[82:83], s[82:83], s[52:53]
    v_cndmask_b32_dpp v7, v7, v7, vcc wave_shr:1 row_mask:0xf bank_mask:0xf
    s_mov_b64 vcc, s[50:51]
    s_mov_b64 exec, s[50:51]
    s_cbranch_scc0 L2_d26
    s_mov_b64 exec, s[82:83]
    s_nop 1
    v_mfma_f32_4x4x4_16b_bf16 v[88:91], v[12:13], v[84:85], 0
    s_nop 1
    v_mfma_f32_4x4x4_16b_bf16 v[88:91], v[10:11], v[86:87], v[88:91]
    s_nop 4
    v_cvt_pk_bf16_f32 v88, v88, v89
    v_cvt_pk_bf16_f32 v89, v90, v91
    ds_pk_add_bf16 v7, v88 offset:65408
    ds_pk_add_bf16 v7, v89 offset:65412
    s_mov_b64 exec, vcc
    s_branch L2_d26
L2_xo27:
    v_cmp_lt_u32 vcc, 20, v99
    s_mov_b32 s43, 1
    s_cbranch_vccz L2_xp27
    v_cmp_lt_u32 vcc, 32, v99
    v_cmp_lt_u32 s[58:59], 31, v88
    s_mov_b32 s43, 2
    s_or_b64 vcc, vcc, s[58:59]
    s_cbranch_scc0 L2_xp27
    s_mov_b32 s37, 0x10000
    s_branch L2_xp27
L2_c28:
    s_mov_b64 s[50:51], vcc
    s_lshl_b64 s[52:53], s[82:83], 1
    s_andn2_b64 s[52:53], s[52:53], s[80:81]
    s_andn2_b64 s[52:53], s[52:53], s[50:51]
    s_or_b64 s[80:81], s[80:81], s[52:53]
    s_not_b64 vcc, s[52:53]
    s_mov_b64 exec, -1
    v_cndmask_b32_dpp v84, v84, v84, vcc wave_shr:1 row_mask:0xf bank_mask:0xf
    v_cndmask_b32_dpp v85, v85, v85, vcc wave_shr:1 row_mask:0xf bank_mask:0xf
    s_lshr_b64 s[52:53], s[52:53], 1
    v_cndmask_b32_dpp v86, v86, v86, vcc wave_shr:1 row_mask:0xf bank_mask:0xf
    v_cndmask_b32_dpp v87, v87, v87, vcc wave_shr:1 row_mask:0xf bank_mask:0xf
    s_andn2_b64 s[82:83], s[82:83], s[52:53]
    v_cndmask_b32_dpp v7, v7, v7, vcc wave_shr:1 row_mask:0xf bank_mask:0xf
    s_mov_b64 vcc, s[50:51]
    s_mov_b64 exec, s[50:51]
    s_cbranch_scc0 L2_d28
    s_mov_b64 exec, s[82:83]
    s_nop 1
    v_mfma_f32_4x4x4_16b_bf16 v[88:91], v[12:13], v[84:85], 0
    s_nop 1
    v_mfma_f32_4x4x4_16b_bf16 v[88:91], v[10:11], v[86:87], v[88:91]
    s_nop 4
    v_cvt_pk_bf16_f32 v88, v88, v89
    v_cvt_pk_bf16_f32 v89, v90, v91
    ds_pk_add_bf16 v7, v88 offset:65408
    ds_pk_add_bf16 v7, v89 offset:65412
    s_mov_b64 exec, vcc
    s_branch L2_d28
L2_c29:
    s_mov_b64 s[50:51], vcc
    s_lshl_b64 s[52:53], s[82:83], 1
    s_andn2_b64 s[52:53], s[52:53], s[80:81]
    s_andn2_b64 s[52:53], s[52:53], s[50:51]
    s_or_b64 s[80:81], s[80:81], s[52:53]
    s_not_b64 vcc, s[52:53]
    s_mov_b64 exec, -1
    v_cndmask_b32_dpp v84, v84, v84, vcc wave_shr:1 row_mask:0xf bank_mask:0xf
    v_cndmask_b32_dpp v85, v85, v85, vcc wave_shr:1 row_mask:0xf bank_mask:0xf
    s_lshr_b64 s[52:53], s[52:53], 1
    v_cndmask_b32_dpp v86, v86, v86, vcc wave_shr:1 row_mask:0xf bank_mask:0xf
    v_cndmask_b32_dpp v87, v87, v87, vcc wave_shr:1 row_mask:0xf bank_mask:0xf
    s_andn2_b64 s[82:83], s[82:83], s[52:53]
    v_cndmask_b32_dpp v7, v7, v7, vcc wave_shr:1 row_mask:0xf bank_mask:0xf
    s_mov_b64 vcc, s[50:51]
    s_mov_b64 exec, s[50:51]
    s_cbranch_scc0 L2_d29
    s_mov_b64 exec, s[82:83]
    s_nop 1
    v_mfma_f32_4x4x4_16b_bf16 v[88:91], v[12:13], v[84:85], 0
    s_nop 1
    v_mfma_f32_4x4x4_16b_bf16 v[88:91], v[10:11], v[86:87], v[88:91]
    s_nop 4
    v_cvt_pk_bf16_f32 v88, v88, v89
    v_cvt_pk_bf16_f32 v89, v90, v91
    ds_pk_add_bf16 v7, v88 offset:65408
    ds_pk_add_bf16 v7, v89 offset:65412
    s_mov_b64 exec, vcc
    s_branch L2_d29
L2_c30:
    s_mov_b64 s[50:51], vcc
    s_lshl_b64 s[52:53], s[82:83], 1
    s_andn2_b64 s[52:53], s[52:53], s[80:81]
    s_andn2_b64 s[52:53], s[52:53], s[50:51]
    s_or_b64 s[80:81], s[80:81], s[52:53]
    s_not_b64 vcc, s[52:53]
    s_mov_b64 exec, -1
    v_cndmask_b32_dpp v84, v84, v84, vcc wave_shr:1 row_mask:0xf bank_mask:0xf
    v_cndmask_b32_dpp v85, v85, v85, vcc wave_shr:1 row_mask:0xf bank_mask:0xf
    s_lshr_b64 s[52:53], s[52:53], 1
    v_cndmask_b32_dpp v86, v86, v86, vcc wave_shr:1 row_mask:0xf bank_mask:0xf
    v_cndmask_b32_dpp v87, v87, v87, vcc wave_shr:1 row_mask:0xf bank_mask:0xf
    s_andn2_b64 s[82:83], s[82:83], s[52:53]
    v_cndmask_b32_dpp v7, v7, v7, vcc wave_shr:1 row_mask:0xf bank_mask:0xf
    s_mov_b64 vcc, s[50:51]
    s_mov_b64 exec, s[50:51]
    s_cbranch_scc0 L2_d30
    s_mov_b64 exec, s[82:83]
    s_nop 1
    v_mfma_f32_4x4x4_16b_bf16 v[88:91], v[12:13], v[84:85], 0
    s_nop 1
    v_mfma_f32_4x4x4_16b_bf16 v[88:91], v[10:11], v[86:87], v[88:91]
    s_nop 4
    v_cvt_pk_bf16_f32 v88, v88, v89
    v_cvt_pk_bf16_f32 v89, v90, v91
    ds_pk_add_bf16 v7, v88 offset:65408
    ds_pk_add_bf16 v7, v89 offset:65412
    s_mov_b64 exec, vcc
    s_branch L2_d30
L2_c31:
    s_mov_b64 s[50:51], vcc
    s_lshl_b64 s[52:53], s[82:83], 1
    s_andn2_b64 s[52:53], s[52:53], s[80:81]
    s_andn2_b64 s[52:53], s[52:53], s[50:51]
    s_or_b64 s[80:81], s[80:81], s[52:53]
    s_not_b64 vcc, s[52:53]
    s_mov_b64 exec, -1
    v_cndmask_b32_dpp v84, v84, v84, vcc wave_shr:1 row_mask:0xf bank_mask:0xf
    v_cndmask_b32_dpp v85, v85, v85, vcc wave_shr:1 row_mask:0xf bank_mask:0xf
    s_lshr_b64 s[52:53], s[52:53], 1
    v_cndmask_b32_dpp v86, v86, v86, vcc wave_shr:1 row_mask:0xf bank_mask:0xf
    v_cndmask_b32_dpp v87, v87, v87, vcc wave_shr:1 row_mask:0xf bank_mask:0xf
    s_andn2_b64 s[82:83], s[82:83], s[52:53]
    v_cndmask_b32_dpp v7, v7, v7, vcc wave_shr:1 row_mask:0xf bank_mask:0xf
    s_mov_b64 vcc, s[50:51]
    s_mov_b64 exec, s[50:51]
    s_cbranch_scc0 L2_d31
    s_mov_b64 exec, s[82:83]
    s_nop 1
    v_mfma_f32_4x4x4_16b_bf16 v[88:91], v[12:13], v[84:85], 0
    s_nop 1
    v_mfma_f32_4x4x4_16b_bf16 v[88:91], v[10:11], v[86:87], v[88:91]
    s_nop 4
    v_cvt_pk_bf16_f32 v88, v88, v89
    v_cvt_pk_bf16_f32 v89, v90, v91
    ds_pk_add_bf16 v7, v88 offset:65408
    ds_pk_add_bf16 v7, v89 offset:65412
    s_mov_b64 exec, vcc
    s_branch L2_d31
L2_c32:
    s_mov_b64 s[50:51], vcc
    s_lshl_b64 s[52:53], s[82:83], 1
    s_andn2_b64 s[52:53], s[52:53], s[80:81]
    s_andn2_b64 s[52:53], s[52:53], s[50:51]
    s_or_b64 s[80:81], s[80:81], s[52:53]
    s_not_b64 vcc, s[52:53]
    s_mov_b64 exec, -1
    v_cndmask_b32_dpp v84, v84, v84, vcc wave_shr:1 row_mask:0xf bank_mask:0xf
    v_cndmask_b32_dpp v85, v85, v85, vcc wave_shr:1 row_mask:0xf bank_mask:0xf
    s_lshr_b64 s[52:53], s[52:53], 1
    v_cndmask_b32_dpp v86, v86, v86, vcc wave_shr:1 row_mask:0xf bank_mask:0xf
    v_cndmask_b32_dpp v87, v87, v87, vcc wave_shr:1 row_mask:0xf bank_mask:0xf
    s_andn2_b64 s[82:83], s[82:83], s[52:53]
    v_cndmask_b32_dpp v7, v7, v7, vcc wave_shr:1 row_mask:0xf bank_mask:0xf
    s_mov_b64 vcc, s[50:51]
    s_mov_b64 exec, s[50:51]
    s_cbranch_scc0 L2_d32
    s_mov_b64 exec, s[82:83]
    s_nop 1
    v_mfma_f32_4x4x4_16b_bf16 v[88:91], v[12:13], v[84:85], 0
    s_nop 1
    v_mfma_f32_4x4x4_16b_bf16 v[88:91], v[10:11], v[86:87], v[88:91]
    s_nop 4
    v_cvt_pk_bf16_f32 v88, v88, v89
    v_cvt_pk_bf16_f32 v89, v90, v91
    ds_pk_add_bf16 v7, v88 offset:65408
    ds_pk_add_bf16 v7, v89 offset:65412
    s_mov_b64 exec, vcc
    s_branch L2_d32
L2_c33:
    s_mov_b64 s[50:51], vcc
    s_lshl_b64 s[52:53], s[82:83], 1
    s_andn2_b64 s[52:53], s[52:53], s[80:81]
    s_andn2_b64 s[52:53], s[52:53], s[50:51]
    s_or_b64 s[80:81], s[80:81], s[52:53]
    s_not_b64 vcc, s[52:53]
    s_mov_b64 exec, -1
    v_cndmask_b32_dpp v84, v84, v84, vcc wave_shr:1 row_mask:0xf bank_mask:0xf
    v_cndmask_b32_dpp v85, v85, v85, vcc wave_shr:1 row_mask:0xf bank_mask:0xf
    s_lshr_b64 s[52:53], s[52:53], 1
    v_cndmask_b32_dpp v86, v86, v86, vcc wave_shr:1 row_mask:0xf bank_mask:0xf
    v_cndmask_b32_dpp v87, v87, v87, vcc wave_shr:1 row_mask:0xf bank_mask:0xf
    s_andn2_b64 s[82:83], s[82:83], s[52:53]
    v_cndmask_b32_dpp v7, v7, v7, vcc wave_shr:1 row_mask:0xf bank_mask:0xf
    s_mov_b64 vcc, s[50:51]
    s_mov_b64 exec, s[50:51]
    s_cbranch_scc0 L2_d33
    s_mov_b64 exec, s[82:83]
    s_nop 1
    v_mfma_f32_4x4x4_16b_bf16 v[88:91], v[12:13], v[84:85], 0
    s_nop 1
    v_mfma_f32_4x4x4_16b_bf16 v[88:91], v[10:11], v[86:87], v[88:91]
    s_nop 4
    v_cvt_pk_bf16_f32 v88, v88, v89
    v_cvt_pk_bf16_f32 v89, v90, v91
    ds_pk_add_bf16 v7, v88 offset:65408
    ds_pk_add_bf16 v7, v89 offset:65412
    s_mov_b64 exec, vcc
    s_branch L2_d33
L2_c34:
    s_mov_b64 s[50:51], vcc
    s_lshl_b64 s[52:53], s[82:83], 1
    s_andn2_b64 s[52:53], s[52:53], s[80:81]
    s_andn2_b64 s[52:53], s[52:53], s[50:51]
    s_or_b64 s[80:81], s[80:81], s[52:53]
    s_not_b64 vcc, s[52:53]
    s_mov_b64 exec, -1
    v_cndmask_b32_dpp v84, v84, v84, vcc wave_shr:1 row_mask:0xf bank_mask:0xf
    v_cndmask_b32_dpp v85, v85, v85, vcc wave_shr:1 row_mask:0xf bank_mask:0xf
    s_lshr_b64 s[52:53], s[52:53], 1
    v_cndmask_b32_dpp v86, v86, v86, vcc wave_shr:1 row_mask:0xf bank_mask:0xf
    v_cndmask_b32_dpp v87, v87, v87, vcc wave_shr:1 row_mask:0xf bank_mask:0xf
    s_andn2_b64 s[82:83], s[82:83], s[52:53]
    v_cndmask_b32_dpp v7, v7, v7, vcc wave_shr:1 row_mask:0xf bank_mask:0xf
    s_mov_b64 vcc, s[50:51]
    s_mov_b64 exec, s[50:51]
    s_cbranch_scc0 L2_d34
    s_mov_b64 exec, s[82:83]
    s_nop 1
    v_mfma_f32_4x4x4_16b_bf16 v[88:91], v[12:13], v[84:85], 0
    s_nop 1
    v_mfma_f32_4x4x4_16b_bf16 v[88:91], v[10:11], v[86:87], v[88:91]
    s_nop 4
    v_cvt_pk_bf16_f32 v88, v88, v89
    v_cvt_pk_bf16_f32 v89, v90, v91
    ds_pk_add_bf16 v7, v88 offset:65408
    ds_pk_add_bf16 v7, v89 offset:65412
    s_mov_b64 exec, vcc
    s_branch L2_d34
L2_c35:
    s_mov_b64 s[50:51], vcc
    s_lshl_b64 s[52:53], s[82:83], 1
    s_andn2_b64 s[52:53], s[52:53], s[80:81]
    s_andn2_b64 s[52:53], s[52:53], s[50:51]
    s_or_b64 s[80:81], s[80:81], s[52:53]
    s_not_b64 vcc, s[52:53]
    s_mov_b64 exec, -1
    v_cndmask_b32_dpp v84, v84, v84, vcc wave_shr:1 row_mask:0xf bank_mask:0xf
    v_cndmask_b32_dpp v85, v85, v85, vcc wave_shr:1 row_mask:0xf bank_mask:0xf
    s_lshr_b64 s[52:53], s[52:53], 1
    v_cndmask_b32_dpp v86, v86, v86, vcc wave_shr:1 row_mask:0xf bank_mask:0xf
    v_cndmask_b32_dpp v87, v87, v87, vcc wave_shr:1 row_mask:0xf bank_mask:0xf
    s_andn2_b64 s[82:83], s[82:83], s[52:53]
    v_cndmask_b32_dpp v7, v7, v7, vcc wave_shr:1 row_mask:0xf bank_mask:0xf
    s_mov_b64 vcc, s[50:51]
    s_mov_b64 exec, s[50:51]
    s_cbranch_scc0 L2_d35
    s_mov_b64 exec, s[82:83]
    s_nop 1
    v_mfma_f32_4x4x4_16b_bf16 v[88:91], v[12:13], v[84:85], 0
    s_nop 1
    v_mfma_f32_4x4x4_16b_bf16 v[88:91], v[10:11], v[86:87], v[88:91]
    s_nop 4
    v_cvt_pk_bf16_f32 v88, v88, v89
    v_cvt_pk_bf16_f32 v89, v90, v91
    ds_pk_add_bf16 v7, v88 offset:65408
    ds_pk_add_bf16 v7, v89 offset:65412
    s_mov_b64 exec, vcc
    s_branch L2_d35
L2_xa36:
    s_cmp_eq_u32 s43, 1
    s_cbranch_scc1 L2_xc36
    v_lshlrev_b32 v89, 0, v96
    v_add_u32 v90, 140, v97
    v_bitop3_b32 v90, v89, v45, v90 bitop3:0x6a
    ds_write_b32 v98, v90 offset:28
    v_lshlrev_b32 v89, 4, v96
    v_add_u32 v90, 120, v97
    v_bitop3_b32 v90, v89, v45, v90 bitop3:0x6a
    ds_write_b32 v98, v90 offset:24
    v_lshlrev_b32 v89, 8, v96
    v_add_u32 v90, 100, v97
    v_bitop3_b32 v90, v89, v45, v90 bitop3:0x6a
    ds_write_b32 v98, v90 offset:20
L2_xc36:
    v_lshlrev_b32 v89, 12, v96
    v_add_u32 v90, 80, v97
    v_bitop3_b32 v90, v89, v45, v90 bitop3:0x6a
    ds_write_b32 v98, v90 offset:16
    s_branch L2_xb36
L2_xe36:
    v_cmp_lt_u32 vcc, 32, v99
    v_cmp_lt_u32 s[58:59], 31, v88
    v_lshrrev_b32 v89, 16, v96
    v_add_u32 v97, 80, v97
    s_or_b64 vcc, vcc, s[58:59]
    s_cbranch_scc1 L2_xs36
    v_lshlrev_b32 v89, v1, v89
    v_and_b32 v89, v45, v89
    v_cmp_ne_u32 vcc, 0, v89
    v_xor_b32 v90, v97, v89
    s_add_u32 s3, s37, s38
    v_mbcnt_lo_u32_b32 v98, vcc_lo, 0
    v_mbcnt_hi_u32_b32 v98, vcc_hi, v98
    s_bcnt1_i32_b64 s41, vcc
    v_lshl_add_u32 v98, v98, 2, s3
    s_mov_b64 exec, vcc
    ds_write_b32 v98, v90
    s_mov_b64 exec, -1
    s_lshl2_add_u32 s37, s41, s37
    s_branch L2_xr36
L2_xf36:
    s_waitcnt lgkmcnt(0)
    s_cmp_gt_u32 s37, 1024
    s_cbranch_scc1 L2_xs36
    v_mov_b32 v43, -1
    s_cmp_ge_u32 s37, 512
    s_cbranch_scc1 L2_xg36
    v_mov_b32 v42, -1
    s_cmp_ge_u32 s37, 256
    s_cbranch_scc1 L2_xg36
    v_mov_b32 v41, -1
    s_branch L2_xg36
L2_xs36:
    s_waitcnt lgkmcnt(0)
    v_mov_b32 v40, -1
    v_mov_b32 v41, -1
    v_mov_b32 v42, -1
    v_mov_b32 v43, -1
    s_add_u32 s3, s42, 2
    s_bitset1_b32 s36, s3
    s_branch L2_xg36
L2_c37:
    s_mov_b64 s[50:51], vcc
    s_lshl_b64 s[52:53], s[82:83], 1
    s_andn2_b64 s[52:53], s[52:53], s[80:81]
    s_andn2_b64 s[52:53], s[52:53], s[50:51]
    s_or_b64 s[80:81], s[80:81], s[52:53]
    s_not_b64 vcc, s[52:53]
    s_mov_b64 exec, -1
    v_cndmask_b32_dpp v84, v84, v84, vcc wave_shr:1 row_mask:0xf bank_mask:0xf
    v_cndmask_b32_dpp v85, v85, v85, vcc wave_shr:1 row_mask:0xf bank_mask:0xf
    s_lshr_b64 s[52:53], s[52:53], 1
    v_cndmask_b32_dpp v86, v86, v86, vcc wave_shr:1 row_mask:0xf bank_mask:0xf
    v_cndmask_b32_dpp v87, v87, v87, vcc wave_shr:1 row_mask:0xf bank_mask:0xf
    s_andn2_b64 s[82:83], s[82:83], s[52:53]
    v_cndmask_b32_dpp v7, v7, v7, vcc wave_shr:1 row_mask:0xf bank_mask:0xf
    s_mov_b64 vcc, s[50:51]
    s_mov_b64 exec, s[50:51]
    s_cbranch_scc0 L2_d37
    s_mov_b64 exec, s[82:83]
    s_nop 1
    v_mfma_f32_4x4x4_16b_bf16 v[88:91], v[12:13], v[84:85], 0
    s_nop 1
    v_mfma_f32_4x4x4_16b_bf16 v[88:91], v[10:11], v[86:87], v[88:91]
    s_nop 4
    v_cvt_pk_bf16_f32 v88, v88, v89
    v_cvt_pk_bf16_f32 v89, v90, v91
    ds_pk_add_bf16 v7, v88 offset:65408
    ds_pk_add_bf16 v7, v89 offset:65412
    s_mov_b64 exec, vcc
    s_branch L2_d37
L2_c38:
    s_mov_b64 s[50:51], vcc
    s_lshl_b64 s[52:53], s[82:83], 1
    s_andn2_b64 s[52:53], s[52:53], s[80:81]
    s_andn2_b64 s[52:53], s[52:53], s[50:51]
    s_or_b64 s[80:81], s[80:81], s[52:53]
    s_not_b64 vcc, s[52:53]
    s_mov_b64 exec, -1
    v_cndmask_b32_dpp v84, v84, v84, vcc wave_shr:1 row_mask:0xf bank_mask:0xf
    v_cndmask_b32_dpp v85, v85, v85, vcc wave_shr:1 row_mask:0xf bank_mask:0xf
    s_lshr_b64 s[52:53], s[52:53], 1
    v_cndmask_b32_dpp v86, v86, v86, vcc wave_shr:1 row_mask:0xf bank_mask:0xf
    v_cndmask_b32_dpp v87, v87, v87, vcc wave_shr:1 row_mask:0xf bank_mask:0xf
    s_andn2_b64 s[82:83], s[82:83], s[52:53]
    v_cndmask_b32_dpp v7, v7, v7, vcc wave_shr:1 row_mask:0xf bank_mask:0xf
    s_mov_b64 vcc, s[50:51]
    s_mov_b64 exec, s[50:51]
    s_cbranch_scc0 L2_d38
    s_mov_b64 exec, s[82:83]
    s_nop 1
    v_mfma_f32_4x4x4_16b_bf16 v[88:91], v[12:13], v[84:85], 0
    s_nop 1
    v_mfma_f32_4x4x4_16b_bf16 v[88:91], v[10:11], v[86:87], v[88:91]
    s_nop 4
    v_cvt_pk_bf16_f32 v88, v88, v89
    v_cvt_pk_bf16_f32 v89, v90, v91
    ds_pk_add_bf16 v7, v88 offset:65408
    ds_pk_add_bf16 v7, v89 offset:65412
    s_mov_b64 exec, vcc
    s_branch L2_d38
L2_c39:
    s_mov_b64 s[50:51], vcc
    s_lshl_b64 s[52:53], s[82:83], 1
    s_andn2_b64 s[52:53], s[52:53], s[80:81]
    s_andn2_b64 s[52:53], s[52:53], s[50:51]
    s_or_b64 s[80:81], s[80:81], s[52:53]
    s_not_b64 vcc, s[52:53]
    s_mov_b64 exec, -1
    v_cndmask_b32_dpp v84, v84, v84, vcc wave_shr:1 row_mask:0xf bank_mask:0xf
    v_cndmask_b32_dpp v85, v85, v85, vcc wave_shr:1 row_mask:0xf bank_mask:0xf
    s_lshr_b64 s[52:53], s[52:53], 1
    v_cndmask_b32_dpp v86, v86, v86, vcc wave_shr:1 row_mask:0xf bank_mask:0xf
    v_cndmask_b32_dpp v87, v87, v87, vcc wave_shr:1 row_mask:0xf bank_mask:0xf
    s_andn2_b64 s[82:83], s[82:83], s[52:53]
    v_cndmask_b32_dpp v7, v7, v7, vcc wave_shr:1 row_mask:0xf bank_mask:0xf
    s_mov_b64 vcc, s[50:51]
    s_mov_b64 exec, s[50:51]
    s_cbranch_scc0 L2_d39
    s_mov_b64 exec, s[82:83]
    s_nop 1
    v_mfma_f32_4x4x4_16b_bf16 v[88:91], v[12:13], v[84:85], 0
    s_nop 1
    v_mfma_f32_4x4x4_16b_bf16 v[88:91], v[10:11], v[86:87], v[88:91]
    s_nop 4
    v_cvt_pk_bf16_f32 v88, v88, v89
    v_cvt_pk_bf16_f32 v89, v90, v91
    ds_pk_add_bf16 v7, v88 offset:65408
    ds_pk_add_bf16 v7, v89 offset:65412
    s_mov_b64 exec, vcc
    s_branch L2_d39
L2_c40:
    s_mov_b64 s[50:51], vcc
    s_lshl_b64 s[52:53], s[82:83], 1
    s_andn2_b64 s[52:53], s[52:53], s[80:81]
    s_andn2_b64 s[52:53], s[52:53], s[50:51]
    s_or_b64 s[80:81], s[80:81], s[52:53]
    s_not_b64 vcc, s[52:53]
    s_mov_b64 exec, -1
    v_cndmask_b32_dpp v84, v84, v84, vcc wave_shr:1 row_mask:0xf bank_mask:0xf
    v_cndmask_b32_dpp v85, v85, v85, vcc wave_shr:1 row_mask:0xf bank_mask:0xf
    s_lshr_b64 s[52:53], s[52:53], 1
    v_cndmask_b32_dpp v86, v86, v86, vcc wave_shr:1 row_mask:0xf bank_mask:0xf
    v_cndmask_b32_dpp v87, v87, v87, vcc wave_shr:1 row_mask:0xf bank_mask:0xf
    s_andn2_b64 s[82:83], s[82:83], s[52:53]
    v_cndmask_b32_dpp v7, v7, v7, vcc wave_shr:1 row_mask:0xf bank_mask:0xf
    s_mov_b64 vcc, s[50:51]
    s_mov_b64 exec, s[50:51]
    s_cbranch_scc0 L2_d40
    s_mov_b64 exec, s[82:83]
    s_nop 1
    v_mfma_f32_4x4x4_16b_bf16 v[88:91], v[12:13], v[84:85], 0
    s_nop 1
    v_mfma_f32_4x4x4_16b_bf16 v[88:91], v[10:11], v[86:87], v[88:91]
    s_nop 4
    v_cvt_pk_bf16_f32 v88, v88, v89
    v_cvt_pk_bf16_f32 v89, v90, v91
    ds_pk_add_bf16 v7, v88 offset:65408
    ds_pk_add_bf16 v7, v89 offset:65412
    s_mov_b64 exec, vcc
    s_branch L2_d40
L2_c41:
    s_mov_b64 s[50:51], vcc
    s_lshl_b64 s[52:53], s[82:83], 1
    s_andn2_b64 s[52:53], s[52:53], s[80:81]
    s_andn2_b64 s[52:53], s[52:53], s[50:51]
    s_or_b64 s[80:81], s[80:81], s[52:53]
    s_not_b64 vcc, s[52:53]
    s_mov_b64 exec, -1
    v_cndmask_b32_dpp v84, v84, v84, vcc wave_shr:1 row_mask:0xf bank_mask:0xf
    v_cndmask_b32_dpp v85, v85, v85, vcc wave_shr:1 row_mask:0xf bank_mask:0xf
    s_lshr_b64 s[52:53], s[52:53], 1
    v_cndmask_b32_dpp v86, v86, v86, vcc wave_shr:1 row_mask:0xf bank_mask:0xf
    v_cndmask_b32_dpp v87, v87, v87, vcc wave_shr:1 row_mask:0xf bank_mask:0xf
    s_andn2_b64 s[82:83], s[82:83], s[52:53]
    v_cndmask_b32_dpp v7, v7, v7, vcc wave_shr:1 row_mask:0xf bank_mask:0xf
    s_mov_b64 vcc, s[50:51]
    s_mov_b64 exec, s[50:51]
    s_cbranch_scc0 L2_d41
    s_mov_b64 exec, s[82:83]
    s_nop 1
    v_mfma_f32_4x4x4_16b_bf16 v[88:91], v[12:13], v[84:85], 0
    s_nop 1
    v_mfma_f32_4x4x4_16b_bf16 v[88:91], v[10:11], v[86:87], v[88:91]
    s_nop 4
    v_cvt_pk_bf16_f32 v88, v88, v89
    v_cvt_pk_bf16_f32 v89, v90, v91
    ds_pk_add_bf16 v7, v88 offset:65408
    ds_pk_add_bf16 v7, v89 offset:65412
    s_mov_b64 exec, vcc
    s_branch L2_d41
L2_c42:
    s_mov_b64 s[50:51], vcc
    s_lshl_b64 s[52:53], s[82:83], 1
    s_andn2_b64 s[52:53], s[52:53], s[80:81]
    s_andn2_b64 s[52:53], s[52:53], s[50:51]
    s_or_b64 s[80:81], s[80:81], s[52:53]
    s_not_b64 vcc, s[52:53]
    s_mov_b64 exec, -1
    v_cndmask_b32_dpp v84, v84, v84, vcc wave_shr:1 row_mask:0xf bank_mask:0xf
    v_cndmask_b32_dpp v85, v85, v85, vcc wave_shr:1 row_mask:0xf bank_mask:0xf
    s_lshr_b64 s[52:53], s[52:53], 1
    v_cndmask_b32_dpp v86, v86, v86, vcc wave_shr:1 row_mask:0xf bank_mask:0xf
    v_cndmask_b32_dpp v87, v87, v87, vcc wave_shr:1 row_mask:0xf bank_mask:0xf
    s_andn2_b64 s[82:83], s[82:83], s[52:53]
    v_cndmask_b32_dpp v7, v7, v7, vcc wave_shr:1 row_mask:0xf bank_mask:0xf
    s_mov_b64 vcc, s[50:51]
    s_mov_b64 exec, s[50:51]
    s_cbranch_scc0 L2_d42
    s_mov_b64 exec, s[82:83]
    s_nop 1
    v_mfma_f32_4x4x4_16b_bf16 v[88:91], v[12:13], v[84:85], 0
    s_nop 1
    v_mfma_f32_4x4x4_16b_bf16 v[88:91], v[10:11], v[86:87], v[88:91]
    s_nop 4
    v_cvt_pk_bf16_f32 v88, v88, v89
    v_cvt_pk_bf16_f32 v89, v90, v91
    ds_pk_add_bf16 v7, v88 offset:65408
    ds_pk_add_bf16 v7, v89 offset:65412
    s_mov_b64 exec, vcc
    s_branch L2_d42
L2_c43:
    s_mov_b64 s[50:51], vcc
    s_lshl_b64 s[52:53], s[82:83], 1
    s_andn2_b64 s[52:53], s[52:53], s[80:81]
    s_andn2_b64 s[52:53], s[52:53], s[50:51]
    s_or_b64 s[80:81], s[80:81], s[52:53]
    s_not_b64 vcc, s[52:53]
    s_mov_b64 exec, -1
    v_cndmask_b32_dpp v84, v84, v84, vcc wave_shr:1 row_mask:0xf bank_mask:0xf
    v_cndmask_b32_dpp v85, v85, v85, vcc wave_shr:1 row_mask:0xf bank_mask:0xf
    s_lshr_b64 s[52:53], s[52:53], 1
    v_cndmask_b32_dpp v86, v86, v86, vcc wave_shr:1 row_mask:0xf bank_mask:0xf
    v_cndmask_b32_dpp v87, v87, v87, vcc wave_shr:1 row_mask:0xf bank_mask:0xf
    s_andn2_b64 s[82:83], s[82:83], s[52:53]
    v_cndmask_b32_dpp v7, v7, v7, vcc wave_shr:1 row_mask:0xf bank_mask:0xf
    s_mov_b64 vcc, s[50:51]
    s_mov_b64 exec, s[50:51]
    s_cbranch_scc0 L2_d43
    s_mov_b64 exec, s[82:83]
    s_nop 1
    v_mfma_f32_4x4x4_16b_bf16 v[88:91], v[12:13], v[84:85], 0
    s_nop 1
    v_mfma_f32_4x4x4_16b_bf16 v[88:91], v[10:11], v[86:87], v[88:91]
    s_nop 4
    v_cvt_pk_bf16_f32 v88, v88, v89
    v_cvt_pk_bf16_f32 v89, v90, v91
    ds_pk_add_bf16 v7, v88 offset:65408
    ds_pk_add_bf16 v7, v89 offset:65412
    s_mov_b64 exec, vcc
    s_branch L2_d43
L2_c44:
    s_mov_b64 s[50:51], vcc
    s_lshl_b64 s[52:53], s[82:83], 1
    s_andn2_b64 s[52:53], s[52:53], s[80:81]
    s_andn2_b64 s[52:53], s[52:53], s[50:51]
    s_or_b64 s[80:81], s[80:81], s[52:53]
    s_not_b64 vcc, s[52:53]
    s_mov_b64 exec, -1
    v_cndmask_b32_dpp v84, v84, v84, vcc wave_shr:1 row_mask:0xf bank_mask:0xf
    v_cndmask_b32_dpp v85, v85, v85, vcc wave_shr:1 row_mask:0xf bank_mask:0xf
    s_lshr_b64 s[52:53], s[52:53], 1
    v_cndmask_b32_dpp v86, v86, v86, vcc wave_shr:1 row_mask:0xf bank_mask:0xf
    v_cndmask_b32_dpp v87, v87, v87, vcc wave_shr:1 row_mask:0xf bank_mask:0xf
    s_andn2_b64 s[82:83], s[82:83], s[52:53]
    v_cndmask_b32_dpp v7, v7, v7, vcc wave_shr:1 row_mask:0xf bank_mask:0xf
    s_mov_b64 vcc, s[50:51]
    s_mov_b64 exec, s[50:51]
    s_cbranch_scc0 L2_d44
    s_mov_b64 exec, s[82:83]
    s_nop 1
    v_mfma_f32_4x4x4_16b_bf16 v[88:91], v[12:13], v[84:85], 0
    s_nop 1
    v_mfma_f32_4x4x4_16b_bf16 v[88:91], v[10:11], v[86:87], v[88:91]
    s_nop 4
    v_cvt_pk_bf16_f32 v88, v88, v89
    v_cvt_pk_bf16_f32 v89, v90, v91
    ds_pk_add_bf16 v7, v88 offset:65408
    ds_pk_add_bf16 v7, v89 offset:65412
    s_mov_b64 exec, vcc
    s_branch L2_d44
L2_xo45:
    v_cmp_lt_u32 vcc, 20, v99
    s_mov_b32 s43, 1
    s_cbranch_vccz L2_xp45
    v_cmp_lt_u32 vcc, 32, v99
    v_cmp_lt_u32 s[58:59], 31, v88
    s_mov_b32 s43, 2
    s_or_b64 vcc, vcc, s[58:59]
    s_cbranch_scc0 L2_xp45
    s_mov_b32 s37, 0x10000
    s_branch L2_xp45
L2_c46:
    s_mov_b64 s[50:51], vcc
    s_lshl_b64 s[52:53], s[82:83], 1
    s_andn2_b64 s[52:53], s[52:53], s[80:81]
    s_andn2_b64 s[52:53], s[52:53], s[50:51]
    s_or_b64 s[80:81], s[80:81], s[52:53]
    s_not_b64 vcc, s[52:53]
    s_mov_b64 exec, -1
    v_cndmask_b32_dpp v84, v84, v84, vcc wave_shr:1 row_mask:0xf bank_mask:0xf
    v_cndmask_b32_dpp v85, v85, v85, vcc wave_shr:1 row_mask:0xf bank_mask:0xf
    s_lshr_b64 s[52:53], s[52:53], 1
    v_cndmask_b32_dpp v86, v86, v86, vcc wave_shr:1 row_mask:0xf bank_mask:0xf
    v_cndmask_b32_dpp v87, v87, v87, vcc wave_shr:1 row_mask:0xf bank_mask:0xf
    s_andn2_b64 s[82:83], s[82:83], s[52:53]
    v_cndmask_b32_dpp v7, v7, v7, vcc wave_shr:1 row_mask:0xf bank_mask:0xf
    s_mov_b64 vcc, s[50:51]
    s_mov_b64 exec, s[50:51]
    s_cbranch_scc0 L2_d46
    s_mov_b64 exec, s[82:83]
    s_nop 1
    v_mfma_f32_4x4x4_16b_bf16 v[88:91], v[12:13], v[84:85], 0
    s_nop 1
    v_mfma_f32_4x4x4_16b_bf16 v[88:91], v[10:11], v[86:87], v[88:91]
    s_nop 4
    v_cvt_pk_bf16_f32 v88, v88, v89
    v_cvt_pk_bf16_f32 v89, v90, v91
    ds_pk_add_bf16 v7, v88 offset:65408
    ds_pk_add_bf16 v7, v89 offset:65412
    s_mov_b64 exec, vcc
    s_branch L2_d46
L2_c47:
    s_mov_b64 s[50:51], vcc
    s_lshl_b64 s[52:53], s[82:83], 1
    s_andn2_b64 s[52:53], s[52:53], s[80:81]
    s_andn2_b64 s[52:53], s[52:53], s[50:51]
    s_or_b64 s[80:81], s[80:81], s[52:53]
    s_not_b64 vcc, s[52:53]
    s_mov_b64 exec, -1
    v_cndmask_b32_dpp v84, v84, v84, vcc wave_shr:1 row_mask:0xf bank_mask:0xf
    v_cndmask_b32_dpp v85, v85, v85, vcc wave_shr:1 row_mask:0xf bank_mask:0xf
    s_lshr_b64 s[52:53], s[52:53], 1
    v_cndmask_b32_dpp v86, v86, v86, vcc wave_shr:1 row_mask:0xf bank_mask:0xf
    v_cndmask_b32_dpp v87, v87, v87, vcc wave_shr:1 row_mask:0xf bank_mask:0xf
    s_andn2_b64 s[82:83], s[82:83], s[52:53]
    v_cndmask_b32_dpp v7, v7, v7, vcc wave_shr:1 row_mask:0xf bank_mask:0xf
    s_mov_b64 vcc, s[50:51]
    s_mov_b64 exec, s[50:51]
    s_cbranch_scc0 L2_d47
    s_mov_b64 exec, s[82:83]
    s_nop 1
    v_mfma_f32_4x4x4_16b_bf16 v[88:91], v[12:13], v[84:85], 0
    s_nop 1
    v_mfma_f32_4x4x4_16b_bf16 v[88:91], v[10:11], v[86:87], v[88:91]
    s_nop 4
    v_cvt_pk_bf16_f32 v88, v88, v89
    v_cvt_pk_bf16_f32 v89, v90, v91
    ds_pk_add_bf16 v7, v88 offset:65408
    ds_pk_add_bf16 v7, v89 offset:65412
    s_mov_b64 exec, vcc
    s_branch L2_d47
L2_c48:
    s_mov_b64 s[50:51], vcc
    s_lshl_b64 s[52:53], s[82:83], 1
    s_andn2_b64 s[52:53], s[52:53], s[80:81]
    s_andn2_b64 s[52:53], s[52:53], s[50:51]
    s_or_b64 s[80:81], s[80:81], s[52:53]
    s_not_b64 vcc, s[52:53]
    s_mov_b64 exec, -1
    v_cndmask_b32_dpp v84, v84, v84, vcc wave_shr:1 row_mask:0xf bank_mask:0xf
    v_cndmask_b32_dpp v85, v85, v85, vcc wave_shr:1 row_mask:0xf bank_mask:0xf
    s_lshr_b64 s[52:53], s[52:53], 1
    v_cndmask_b32_dpp v86, v86, v86, vcc wave_shr:1 row_mask:0xf bank_mask:0xf
    v_cndmask_b32_dpp v87, v87, v87, vcc wave_shr:1 row_mask:0xf bank_mask:0xf
    s_andn2_b64 s[82:83], s[82:83], s[52:53]
    v_cndmask_b32_dpp v7, v7, v7, vcc wave_shr:1 row_mask:0xf bank_mask:0xf
    s_mov_b64 vcc, s[50:51]
    s_mov_b64 exec, s[50:51]
    s_cbranch_scc0 L2_d48
    s_mov_b64 exec, s[82:83]
    s_nop 1
    v_mfma_f32_4x4x4_16b_bf16 v[88:91], v[12:13], v[84:85], 0
    s_nop 1
    v_mfma_f32_4x4x4_16b_bf16 v[88:91], v[10:11], v[86:87], v[88:91]
    s_nop 4
    v_cvt_pk_bf16_f32 v88, v88, v89
    v_cvt_pk_bf16_f32 v89, v90, v91
    ds_pk_add_bf16 v7, v88 offset:65408
    ds_pk_add_bf16 v7, v89 offset:65412
    s_mov_b64 exec, vcc
    s_branch L2_d48
L2_c49:
    s_mov_b64 s[50:51], vcc
    s_lshl_b64 s[52:53], s[82:83], 1
    s_andn2_b64 s[52:53], s[52:53], s[80:81]
    s_andn2_b64 s[52:53], s[52:53], s[50:51]
    s_or_b64 s[80:81], s[80:81], s[52:53]
    s_not_b64 vcc, s[52:53]
    s_mov_b64 exec, -1
    v_cndmask_b32_dpp v84, v84, v84, vcc wave_shr:1 row_mask:0xf bank_mask:0xf
    v_cndmask_b32_dpp v85, v85, v85, vcc wave_shr:1 row_mask:0xf bank_mask:0xf
    s_lshr_b64 s[52:53], s[52:53], 1
    v_cndmask_b32_dpp v86, v86, v86, vcc wave_shr:1 row_mask:0xf bank_mask:0xf
    v_cndmask_b32_dpp v87, v87, v87, vcc wave_shr:1 row_mask:0xf bank_mask:0xf
    s_andn2_b64 s[82:83], s[82:83], s[52:53]
    v_cndmask_b32_dpp v7, v7, v7, vcc wave_shr:1 row_mask:0xf bank_mask:0xf
    s_mov_b64 vcc, s[50:51]
    s_mov_b64 exec, s[50:51]
    s_cbranch_scc0 L2_d49
    s_mov_b64 exec, s[82:83]
    s_nop 1
    v_mfma_f32_4x4x4_16b_bf16 v[88:91], v[12:13], v[84:85], 0
    s_nop 1
    v_mfma_f32_4x4x4_16b_bf16 v[88:91], v[10:11], v[86:87], v[88:91]
    s_nop 4
    v_cvt_pk_bf16_f32 v88, v88, v89
    v_cvt_pk_bf16_f32 v89, v90, v91
    ds_pk_add_bf16 v7, v88 offset:65408
    ds_pk_add_bf16 v7, v89 offset:65412
    s_mov_b64 exec, vcc
    s_branch L2_d49
L2_c50:
    s_mov_b64 s[50:51], vcc
    s_lshl_b64 s[52:53], s[82:83], 1
    s_andn2_b64 s[52:53], s[52:53], s[80:81]
    s_andn2_b64 s[52:53], s[52:53], s[50:51]
    s_or_b64 s[80:81], s[80:81], s[52:53]
    s_not_b64 vcc, s[52:53]
    s_mov_b64 exec, -1
    v_cndmask_b32_dpp v84, v84, v84, vcc wave_shr:1 row_mask:0xf bank_mask:0xf
    v_cndmask_b32_dpp v85, v85, v85, vcc wave_shr:1 row_mask:0xf bank_mask:0xf
    s_lshr_b64 s[52:53], s[52:53], 1
    v_cndmask_b32_dpp v86, v86, v86, vcc wave_shr:1 row_mask:0xf bank_mask:0xf
    v_cndmask_b32_dpp v87, v87, v87, vcc wave_shr:1 row_mask:0xf bank_mask:0xf
    s_andn2_b64 s[82:83], s[82:83], s[52:53]
    v_cndmask_b32_dpp v7, v7, v7, vcc wave_shr:1 row_mask:0xf bank_mask:0xf
    s_mov_b64 vcc, s[50:51]
    s_mov_b64 exec, s[50:51]
    s_cbranch_scc0 L2_d50
    s_mov_b64 exec, s[82:83]
    s_nop 1
    v_mfma_f32_4x4x4_16b_bf16 v[88:91], v[12:13], v[84:85], 0
    s_nop 1
    v_mfma_f32_4x4x4_16b_bf16 v[88:91], v[10:11], v[86:87], v[88:91]
    s_nop 4
    v_cvt_pk_bf16_f32 v88, v88, v89
    v_cvt_pk_bf16_f32 v89, v90, v91
    ds_pk_add_bf16 v7, v88 offset:65408
    ds_pk_add_bf16 v7, v89 offset:65412
    s_mov_b64 exec, vcc
    s_branch L2_d50
L2_c51:
    s_mov_b64 s[50:51], vcc
    s_lshl_b64 s[52:53], s[82:83], 1
    s_andn2_b64 s[52:53], s[52:53], s[80:81]
    s_andn2_b64 s[52:53], s[52:53], s[50:51]
    s_or_b64 s[80:81], s[80:81], s[52:53]
    s_not_b64 vcc, s[52:53]
    s_mov_b64 exec, -1
    v_cndmask_b32_dpp v84, v84, v84, vcc wave_shr:1 row_mask:0xf bank_mask:0xf
    v_cndmask_b32_dpp v85, v85, v85, vcc wave_shr:1 row_mask:0xf bank_mask:0xf
    s_lshr_b64 s[52:53], s[52:53], 1
    v_cndmask_b32_dpp v86, v86, v86, vcc wave_shr:1 row_mask:0xf bank_mask:0xf
    v_cndmask_b32_dpp v87, v87, v87, vcc wave_shr:1 row_mask:0xf bank_mask:0xf
    s_andn2_b64 s[82:83], s[82:83], s[52:53]
    v_cndmask_b32_dpp v7, v7, v7, vcc wave_shr:1 row_mask:0xf bank_mask:0xf
    s_mov_b64 vcc, s[50:51]
    s_mov_b64 exec, s[50:51]
    s_cbranch_scc0 L2_d51
    s_mov_b64 exec, s[82:83]
    s_nop 1
    v_mfma_f32_4x4x4_16b_bf16 v[88:91], v[12:13], v[84:85], 0
    s_nop 1
    v_mfma_f32_4x4x4_16b_bf16 v[88:91], v[10:11], v[86:87], v[88:91]
    s_nop 4
    v_cvt_pk_bf16_f32 v88, v88, v89
    v_cvt_pk_bf16_f32 v89, v90, v91
    ds_pk_add_bf16 v7, v88 offset:65408
    ds_pk_add_bf16 v7, v89 offset:65412
    s_mov_b64 exec, vcc
    s_branch L2_d51
L2_c52:
    s_mov_b64 s[50:51], vcc
    s_lshl_b64 s[52:53], s[82:83], 1
    s_andn2_b64 s[52:53], s[52:53], s[80:81]
    s_andn2_b64 s[52:53], s[52:53], s[50:51]
    s_or_b64 s[80:81], s[80:81], s[52:53]
    s_not_b64 vcc, s[52:53]
    s_mov_b64 exec, -1
    v_cndmask_b32_dpp v84, v84, v84, vcc wave_shr:1 row_mask:0xf bank_mask:0xf
    v_cndmask_b32_dpp v85, v85, v85, vcc wave_shr:1 row_mask:0xf bank_mask:0xf
    s_lshr_b64 s[52:53], s[52:53], 1
    v_cndmask_b32_dpp v86, v86, v86, vcc wave_shr:1 row_mask:0xf bank_mask:0xf
    v_cndmask_b32_dpp v87, v87, v87, vcc wave_shr:1 row_mask:0xf bank_mask:0xf
    s_andn2_b64 s[82:83], s[82:83], s[52:53]
    v_cndmask_b32_dpp v7, v7, v7, vcc wave_shr:1 row_mask:0xf bank_mask:0xf
    s_mov_b64 vcc, s[50:51]
    s_mov_b64 exec, s[50:51]
    s_cbranch_scc0 L2_d52
    s_mov_b64 exec, s[82:83]
    s_nop 1
    v_mfma_f32_4x4x4_16b_bf16 v[88:91], v[12:13], v[84:85], 0
    s_nop 1
    v_mfma_f32_4x4x4_16b_bf16 v[88:91], v[10:11], v[86:87], v[88:91]
    s_nop 4
    v_cvt_pk_bf16_f32 v88, v88, v89
    v_cvt_pk_bf16_f32 v89, v90, v91
    ds_pk_add_bf16 v7, v88 offset:65408
    ds_pk_add_bf16 v7, v89 offset:65412
    s_mov_b64 exec, vcc
    s_branch L2_d52
L2_c53:
    s_mov_b64 s[50:51], vcc
    s_lshl_b64 s[52:53], s[82:83], 1
    s_andn2_b64 s[52:53], s[52:53], s[80:81]
    s_andn2_b64 s[52:53], s[52:53], s[50:51]
    s_or_b64 s[80:81], s[80:81], s[52:53]
    s_not_b64 vcc, s[52:53]
    s_mov_b64 exec, -1
    v_cndmask_b32_dpp v84, v84, v84, vcc wave_shr:1 row_mask:0xf bank_mask:0xf
    v_cndmask_b32_dpp v85, v85, v85, vcc wave_shr:1 row_mask:0xf bank_mask:0xf
    s_lshr_b64 s[52:53], s[52:53], 1
    v_cndmask_b32_dpp v86, v86, v86, vcc wave_shr:1 row_mask:0xf bank_mask:0xf
    v_cndmask_b32_dpp v87, v87, v87, vcc wave_shr:1 row_mask:0xf bank_mask:0xf
    s_andn2_b64 s[82:83], s[82:83], s[52:53]
    v_cndmask_b32_dpp v7, v7, v7, vcc wave_shr:1 row_mask:0xf bank_mask:0xf
    s_mov_b64 vcc, s[50:51]
    s_mov_b64 exec, s[50:51]
    s_cbranch_scc0 L2_d53
    s_mov_b64 exec, s[82:83]
    s_nop 1
    v_mfma_f32_4x4x4_16b_bf16 v[88:91], v[12:13], v[84:85], 0
    s_nop 1
    v_mfma_f32_4x4x4_16b_bf16 v[88:91], v[10:11], v[86:87], v[88:91]
    s_nop 4
    v_cvt_pk_bf16_f32 v88, v88, v89
    v_cvt_pk_bf16_f32 v89, v90, v91
    ds_pk_add_bf16 v7, v88 offset:65408
    ds_pk_add_bf16 v7, v89 offset:65412
    s_mov_b64 exec, vcc
    s_branch L2_d53
L2_xa54:
    s_cmp_eq_u32 s43, 1
    s_cbranch_scc1 L2_xc54
    v_lshlrev_b32 v89, 0, v96
    v_add_u32 v90, 140, v97
    v_bitop3_b32 v90, v89, v45, v90 bitop3:0x6a
    ds_write_b32 v98, v90 offset:28
    v_lshlrev_b32 v89, 4, v96
    v_add_u32 v90, 120, v97
    v_bitop3_b32 v90, v89, v45, v90 bitop3:0x6a
    ds_write_b32 v98, v90 offset:24
    v_lshlrev_b32 v89, 8, v96
    v_add_u32 v90, 100, v97
    v_bitop3_b32 v90, v89, v45, v90 bitop3:0x6a
    ds_write_b32 v98, v90 offset:20
L2_xc54:
    v_lshlrev_b32 v89, 12, v96
    v_add_u32 v90, 80, v97
    v_bitop3_b32 v90, v89, v45, v90 bitop3:0x6a
    ds_write_b32 v98, v90 offset:16
    s_branch L2_xb54
L2_xe54:
    v_cmp_lt_u32 vcc, 32, v99
    v_cmp_lt_u32 s[58:59], 31, v88
    v_lshrrev_b32 v89, 16, v96
    v_add_u32 v97, 80, v97
    s_or_b64 vcc, vcc, s[58:59]
    s_cbranch_scc1 L2_xs54
    v_lshlrev_b32 v89, v1, v89
    v_and_b32 v89, v45, v89
    v_cmp_ne_u32 vcc, 0, v89
    v_xor_b32 v90, v97, v89
    s_add_u32 s3, s37, s38
    v_mbcnt_lo_u32_b32 v98, vcc_lo, 0
    v_mbcnt_hi_u32_b32 v98, vcc_hi, v98
    s_bcnt1_i32_b64 s41, vcc
    v_lshl_add_u32 v98, v98, 2, s3
    s_mov_b64 exec, vcc
    ds_write_b32 v98, v90
    s_mov_b64 exec, -1
    s_lshl2_add_u32 s37, s41, s37
    s_branch L2_xr54
L2_xf54:
    s_waitcnt lgkmcnt(0)
    s_cmp_gt_u32 s37, 1024
    s_cbranch_scc1 L2_xs54
    v_mov_b32 v43, -1
    s_cmp_ge_u32 s37, 512
    s_cbranch_scc1 L2_xg54
    v_mov_b32 v42, -1
    s_cmp_ge_u32 s37, 256
    s_cbranch_scc1 L2_xg54
    v_mov_b32 v41, -1
    s_branch L2_xg54
L2_xs54:
    s_waitcnt lgkmcnt(0)
    v_mov_b32 v40, -1
    v_mov_b32 v41, -1
    v_mov_b32 v42, -1
    v_mov_b32 v43, -1
    s_add_u32 s3, s42, 2
    s_bitset1_b32 s36, s3
    s_branch L2_xg54
L2_c55:
    s_mov_b64 s[50:51], vcc
    s_lshl_b64 s[52:53], s[82:83], 1
    s_andn2_b64 s[52:53], s[52:53], s[80:81]
    s_andn2_b64 s[52:53], s[52:53], s[50:51]
    s_or_b64 s[80:81], s[80:81], s[52:53]
    s_not_b64 vcc, s[52:53]
    s_mov_b64 exec, -1
    v_cndmask_b32_dpp v84, v84, v84, vcc wave_shr:1 row_mask:0xf bank_mask:0xf
    v_cndmask_b32_dpp v85, v85, v85, vcc wave_shr:1 row_mask:0xf bank_mask:0xf
    s_lshr_b64 s[52:53], s[52:53], 1
    v_cndmask_b32_dpp v86, v86, v86, vcc wave_shr:1 row_mask:0xf bank_mask:0xf
    v_cndmask_b32_dpp v87, v87, v87, vcc wave_shr:1 row_mask:0xf bank_mask:0xf
    s_andn2_b64 s[82:83], s[82:83], s[52:53]
    v_cndmask_b32_dpp v7, v7, v7, vcc wave_shr:1 row_mask:0xf bank_mask:0xf
    s_mov_b64 vcc, s[50:51]
    s_mov_b64 exec, s[50:51]
    s_cbranch_scc0 L2_d55
    s_mov_b64 exec, s[82:83]
    s_nop 1
    v_mfma_f32_4x4x4_16b_bf16 v[88:91], v[12:13], v[84:85], 0
    s_nop 1
    v_mfma_f32_4x4x4_16b_bf16 v[88:91], v[10:11], v[86:87], v[88:91]
    s_nop 4
    v_cvt_pk_bf16_f32 v88, v88, v89
    v_cvt_pk_bf16_f32 v89, v90, v91
    ds_pk_add_bf16 v7, v88 offset:65408
    ds_pk_add_bf16 v7, v89 offset:65412
    s_mov_b64 exec, vcc
    s_branch L2_d55
L2_c56:
    s_mov_b64 s[50:51], vcc
    s_lshl_b64 s[52:53], s[82:83], 1
    s_andn2_b64 s[52:53], s[52:53], s[80:81]
    s_andn2_b64 s[52:53], s[52:53], s[50:51]
    s_or_b64 s[80:81], s[80:81], s[52:53]
    s_not_b64 vcc, s[52:53]
    s_mov_b64 exec, -1
    v_cndmask_b32_dpp v84, v84, v84, vcc wave_shr:1 row_mask:0xf bank_mask:0xf
    v_cndmask_b32_dpp v85, v85, v85, vcc wave_shr:1 row_mask:0xf bank_mask:0xf
    s_lshr_b64 s[52:53], s[52:53], 1
    v_cndmask_b32_dpp v86, v86, v86, vcc wave_shr:1 row_mask:0xf bank_mask:0xf
    v_cndmask_b32_dpp v87, v87, v87, vcc wave_shr:1 row_mask:0xf bank_mask:0xf
    s_andn2_b64 s[82:83], s[82:83], s[52:53]
    v_cndmask_b32_dpp v7, v7, v7, vcc wave_shr:1 row_mask:0xf bank_mask:0xf
    s_mov_b64 vcc, s[50:51]
    s_mov_b64 exec, s[50:51]
    s_cbranch_scc0 L2_d56
    s_mov_b64 exec, s[82:83]
    s_nop 1
    v_mfma_f32_4x4x4_16b_bf16 v[88:91], v[12:13], v[84:85], 0
    s_nop 1
    v_mfma_f32_4x4x4_16b_bf16 v[88:91], v[10:11], v[86:87], v[88:91]
    s_nop 4
    v_cvt_pk_bf16_f32 v88, v88, v89
    v_cvt_pk_bf16_f32 v89, v90, v91
    ds_pk_add_bf16 v7, v88 offset:65408
    ds_pk_add_bf16 v7, v89 offset:65412
    s_mov_b64 exec, vcc
    s_branch L2_d56
L2_c57:
    s_mov_b64 s[50:51], vcc
    s_lshl_b64 s[52:53], s[82:83], 1
    s_andn2_b64 s[52:53], s[52:53], s[80:81]
    s_andn2_b64 s[52:53], s[52:53], s[50:51]
    s_or_b64 s[80:81], s[80:81], s[52:53]
    s_not_b64 vcc, s[52:53]
    s_mov_b64 exec, -1
    v_cndmask_b32_dpp v84, v84, v84, vcc wave_shr:1 row_mask:0xf bank_mask:0xf
    v_cndmask_b32_dpp v85, v85, v85, vcc wave_shr:1 row_mask:0xf bank_mask:0xf
    s_lshr_b64 s[52:53], s[52:53], 1
    v_cndmask_b32_dpp v86, v86, v86, vcc wave_shr:1 row_mask:0xf bank_mask:0xf
    v_cndmask_b32_dpp v87, v87, v87, vcc wave_shr:1 row_mask:0xf bank_mask:0xf
    s_andn2_b64 s[82:83], s[82:83], s[52:53]
    v_cndmask_b32_dpp v7, v7, v7, vcc wave_shr:1 row_mask:0xf bank_mask:0xf
    s_mov_b64 vcc, s[50:51]
    s_mov_b64 exec, s[50:51]
    s_cbranch_scc0 L2_d57
    s_mov_b64 exec, s[82:83]
    s_nop 1
    v_mfma_f32_4x4x4_16b_bf16 v[88:91], v[12:13], v[84:85], 0
    s_nop 1
    v_mfma_f32_4x4x4_16b_bf16 v[88:91], v[10:11], v[86:87], v[88:91]
    s_nop 4
    v_cvt_pk_bf16_f32 v88, v88, v89
    v_cvt_pk_bf16_f32 v89, v90, v91
    ds_pk_add_bf16 v7, v88 offset:65408
    ds_pk_add_bf16 v7, v89 offset:65412
    s_mov_b64 exec, vcc
    s_branch L2_d57
L2_c58:
    s_mov_b64 s[50:51], vcc
    s_lshl_b64 s[52:53], s[82:83], 1
    s_andn2_b64 s[52:53], s[52:53], s[80:81]
    s_andn2_b64 s[52:53], s[52:53], s[50:51]
    s_or_b64 s[80:81], s[80:81], s[52:53]
    s_not_b64 vcc, s[52:53]
    s_mov_b64 exec, -1
    v_cndmask_b32_dpp v84, v84, v84, vcc wave_shr:1 row_mask:0xf bank_mask:0xf
    v_cndmask_b32_dpp v85, v85, v85, vcc wave_shr:1 row_mask:0xf bank_mask:0xf
    s_lshr_b64 s[52:53], s[52:53], 1
    v_cndmask_b32_dpp v86, v86, v86, vcc wave_shr:1 row_mask:0xf bank_mask:0xf
    v_cndmask_b32_dpp v87, v87, v87, vcc wave_shr:1 row_mask:0xf bank_mask:0xf
    s_andn2_b64 s[82:83], s[82:83], s[52:53]
    v_cndmask_b32_dpp v7, v7, v7, vcc wave_shr:1 row_mask:0xf bank_mask:0xf
    s_mov_b64 vcc, s[50:51]
    s_mov_b64 exec, s[50:51]
    s_cbranch_scc0 L2_d58
    s_mov_b64 exec, s[82:83]
    s_nop 1
    v_mfma_f32_4x4x4_16b_bf16 v[88:91], v[12:13], v[84:85], 0
    s_nop 1
    v_mfma_f32_4x4x4_16b_bf16 v[88:91], v[10:11], v[86:87], v[88:91]
    s_nop 4
    v_cvt_pk_bf16_f32 v88, v88, v89
    v_cvt_pk_bf16_f32 v89, v90, v91
    ds_pk_add_bf16 v7, v88 offset:65408
    ds_pk_add_bf16 v7, v89 offset:65412
    s_mov_b64 exec, vcc
    s_branch L2_d58
L2_c59:
    s_mov_b64 s[50:51], vcc
    s_lshl_b64 s[52:53], s[82:83], 1
    s_andn2_b64 s[52:53], s[52:53], s[80:81]
    s_andn2_b64 s[52:53], s[52:53], s[50:51]
    s_or_b64 s[80:81], s[80:81], s[52:53]
    s_not_b64 vcc, s[52:53]
    s_mov_b64 exec, -1
    v_cndmask_b32_dpp v84, v84, v84, vcc wave_shr:1 row_mask:0xf bank_mask:0xf
    v_cndmask_b32_dpp v85, v85, v85, vcc wave_shr:1 row_mask:0xf bank_mask:0xf
    s_lshr_b64 s[52:53], s[52:53], 1
    v_cndmask_b32_dpp v86, v86, v86, vcc wave_shr:1 row_mask:0xf bank_mask:0xf
    v_cndmask_b32_dpp v87, v87, v87, vcc wave_shr:1 row_mask:0xf bank_mask:0xf
    s_andn2_b64 s[82:83], s[82:83], s[52:53]
    v_cndmask_b32_dpp v7, v7, v7, vcc wave_shr:1 row_mask:0xf bank_mask:0xf
    s_mov_b64 vcc, s[50:51]
    s_mov_b64 exec, s[50:51]
    s_cbranch_scc0 L2_d59
    s_mov_b64 exec, s[82:83]
    s_nop 1
    v_mfma_f32_4x4x4_16b_bf16 v[88:91], v[12:13], v[84:85], 0
    s_nop 1
    v_mfma_f32_4x4x4_16b_bf16 v[88:91], v[10:11], v[86:87], v[88:91]
    s_nop 4
    v_cvt_pk_bf16_f32 v88, v88, v89
    v_cvt_pk_bf16_f32 v89, v90, v91
    ds_pk_add_bf16 v7, v88 offset:65408
    ds_pk_add_bf16 v7, v89 offset:65412
    s_mov_b64 exec, vcc
    s_branch L2_d59
L2_c60:
    s_mov_b64 s[50:51], vcc
    s_lshl_b64 s[52:53], s[82:83], 1
    s_andn2_b64 s[52:53], s[52:53], s[80:81]
    s_andn2_b64 s[52:53], s[52:53], s[50:51]
    s_or_b64 s[80:81], s[80:81], s[52:53]
    s_not_b64 vcc, s[52:53]
    s_mov_b64 exec, -1
    v_cndmask_b32_dpp v84, v84, v84, vcc wave_shr:1 row_mask:0xf bank_mask:0xf
    v_cndmask_b32_dpp v85, v85, v85, vcc wave_shr:1 row_mask:0xf bank_mask:0xf
    s_lshr_b64 s[52:53], s[52:53], 1
    v_cndmask_b32_dpp v86, v86, v86, vcc wave_shr:1 row_mask:0xf bank_mask:0xf
    v_cndmask_b32_dpp v87, v87, v87, vcc wave_shr:1 row_mask:0xf bank_mask:0xf
    s_andn2_b64 s[82:83], s[82:83], s[52:53]
    v_cndmask_b32_dpp v7, v7, v7, vcc wave_shr:1 row_mask:0xf bank_mask:0xf
    s_mov_b64 vcc, s[50:51]
    s_mov_b64 exec, s[50:51]
    s_cbranch_scc0 L2_d60
    s_mov_b64 exec, s[82:83]
    s_nop 1
    v_mfma_f32_4x4x4_16b_bf16 v[88:91], v[12:13], v[84:85], 0
    s_nop 1
    v_mfma_f32_4x4x4_16b_bf16 v[88:91], v[10:11], v[86:87], v[88:91]
    s_nop 4
    v_cvt_pk_bf16_f32 v88, v88, v89
    v_cvt_pk_bf16_f32 v89, v90, v91
    ds_pk_add_bf16 v7, v88 offset:65408
    ds_pk_add_bf16 v7, v89 offset:65412
    s_mov_b64 exec, vcc
    s_branch L2_d60
L2_c61:
    s_mov_b64 s[50:51], vcc
    s_lshl_b64 s[52:53], s[82:83], 1
    s_andn2_b64 s[52:53], s[52:53], s[80:81]
    s_andn2_b64 s[52:53], s[52:53], s[50:51]
    s_or_b64 s[80:81], s[80:81], s[52:53]
    s_not_b64 vcc, s[52:53]
    s_mov_b64 exec, -1
    v_cndmask_b32_dpp v84, v84, v84, vcc wave_shr:1 row_mask:0xf bank_mask:0xf
    v_cndmask_b32_dpp v85, v85, v85, vcc wave_shr:1 row_mask:0xf bank_mask:0xf
    s_lshr_b64 s[52:53], s[52:53], 1
    v_cndmask_b32_dpp v86, v86, v86, vcc wave_shr:1 row_mask:0xf bank_mask:0xf
    v_cndmask_b32_dpp v87, v87, v87, vcc wave_shr:1 row_mask:0xf bank_mask:0xf
    s_andn2_b64 s[82:83], s[82:83], s[52:53]
    v_cndmask_b32_dpp v7, v7, v7, vcc wave_shr:1 row_mask:0xf bank_mask:0xf
    s_mov_b64 vcc, s[50:51]
    s_mov_b64 exec, s[50:51]
    s_cbranch_scc0 L2_d61
    s_mov_b64 exec, s[82:83]
    s_nop 1
    v_mfma_f32_4x4x4_16b_bf16 v[88:91], v[12:13], v[84:85], 0
    s_nop 1
    v_mfma_f32_4x4x4_16b_bf16 v[88:91], v[10:11], v[86:87], v[88:91]
    s_nop 4
    v_cvt_pk_bf16_f32 v88, v88, v89
    v_cvt_pk_bf16_f32 v89, v90, v91
    ds_pk_add_bf16 v7, v88 offset:65408
    ds_pk_add_bf16 v7, v89 offset:65412
    s_mov_b64 exec, vcc
    s_branch L2_d61
L2_c62:
    s_mov_b64 s[50:51], vcc
    s_lshl_b64 s[52:53], s[82:83], 1
    s_andn2_b64 s[52:53], s[52:53], s[80:81]
    s_andn2_b64 s[52:53], s[52:53], s[50:51]
    s_or_b64 s[80:81], s[80:81], s[52:53]
    s_not_b64 vcc, s[52:53]
    s_mov_b64 exec, -1
    v_cndmask_b32_dpp v84, v84, v84, vcc wave_shr:1 row_mask:0xf bank_mask:0xf
    v_cndmask_b32_dpp v85, v85, v85, vcc wave_shr:1 row_mask:0xf bank_mask:0xf
    s_lshr_b64 s[52:53], s[52:53], 1
    v_cndmask_b32_dpp v86, v86, v86, vcc wave_shr:1 row_mask:0xf bank_mask:0xf
    v_cndmask_b32_dpp v87, v87, v87, vcc wave_shr:1 row_mask:0xf bank_mask:0xf
    s_andn2_b64 s[82:83], s[82:83], s[52:53]
    v_cndmask_b32_dpp v7, v7, v7, vcc wave_shr:1 row_mask:0xf bank_mask:0xf
    s_mov_b64 vcc, s[50:51]
    s_mov_b64 exec, s[50:51]
    s_cbranch_scc0 L2_d62
    s_mov_b64 exec, s[82:83]
    s_nop 1
    v_mfma_f32_4x4x4_16b_bf16 v[88:91], v[12:13], v[84:85], 0
    s_nop 1
    v_mfma_f32_4x4x4_16b_bf16 v[88:91], v[10:11], v[86:87], v[88:91]
    s_nop 4
    v_cvt_pk_bf16_f32 v88, v88, v89
    v_cvt_pk_bf16_f32 v89, v90, v91
    ds_pk_add_bf16 v7, v88 offset:65408
    ds_pk_add_bf16 v7, v89 offset:65412
    s_mov_b64 exec, vcc
    s_branch L2_d62
L2_xo63:
    v_cmp_lt_u32 vcc, 20, v99
    s_mov_b32 s43, 1
    s_cbranch_vccz L2_xp63
    v_cmp_lt_u32 vcc, 32, v99
    v_cmp_lt_u32 s[58:59], 31, v88
    s_mov_b32 s43, 2
    s_or_b64 vcc, vcc, s[58:59]
    s_cbranch_scc0 L2_xp63
    s_mov_b32 s37, 0x10000
    s_branch L2_xp63
L2_c64:
    s_mov_b64 s[50:51], vcc
    s_lshl_b64 s[52:53], s[82:83], 1
    s_andn2_b64 s[52:53], s[52:53], s[80:81]
    s_andn2_b64 s[52:53], s[52:53], s[50:51]
    s_or_b64 s[80:81], s[80:81], s[52:53]
    s_not_b64 vcc, s[52:53]
    s_mov_b64 exec, -1
    v_cndmask_b32_dpp v84, v84, v84, vcc wave_shr:1 row_mask:0xf bank_mask:0xf
    v_cndmask_b32_dpp v85, v85, v85, vcc wave_shr:1 row_mask:0xf bank_mask:0xf
    s_lshr_b64 s[52:53], s[52:53], 1
    v_cndmask_b32_dpp v86, v86, v86, vcc wave_shr:1 row_mask:0xf bank_mask:0xf
    v_cndmask_b32_dpp v87, v87, v87, vcc wave_shr:1 row_mask:0xf bank_mask:0xf
    s_andn2_b64 s[82:83], s[82:83], s[52:53]
    v_cndmask_b32_dpp v7, v7, v7, vcc wave_shr:1 row_mask:0xf bank_mask:0xf
    s_mov_b64 vcc, s[50:51]
    s_mov_b64 exec, s[50:51]
    s_cbranch_scc0 L2_d64
    s_mov_b64 exec, s[82:83]
    s_nop 1
    v_mfma_f32_4x4x4_16b_bf16 v[88:91], v[12:13], v[84:85], 0
    s_nop 1
    v_mfma_f32_4x4x4_16b_bf16 v[88:91], v[10:11], v[86:87], v[88:91]
    s_nop 4
    v_cvt_pk_bf16_f32 v88, v88, v89
    v_cvt_pk_bf16_f32 v89, v90, v91
    ds_pk_add_bf16 v7, v88 offset:65408
    ds_pk_add_bf16 v7, v89 offset:65412
    s_mov_b64 exec, vcc
    s_branch L2_d64
L2_c65:
    s_mov_b64 s[50:51], vcc
    s_lshl_b64 s[52:53], s[82:83], 1
    s_andn2_b64 s[52:53], s[52:53], s[80:81]
    s_andn2_b64 s[52:53], s[52:53], s[50:51]
    s_or_b64 s[80:81], s[80:81], s[52:53]
    s_not_b64 vcc, s[52:53]
    s_mov_b64 exec, -1
    v_cndmask_b32_dpp v84, v84, v84, vcc wave_shr:1 row_mask:0xf bank_mask:0xf
    v_cndmask_b32_dpp v85, v85, v85, vcc wave_shr:1 row_mask:0xf bank_mask:0xf
    s_lshr_b64 s[52:53], s[52:53], 1
    v_cndmask_b32_dpp v86, v86, v86, vcc wave_shr:1 row_mask:0xf bank_mask:0xf
    v_cndmask_b32_dpp v87, v87, v87, vcc wave_shr:1 row_mask:0xf bank_mask:0xf
    s_andn2_b64 s[82:83], s[82:83], s[52:53]
    v_cndmask_b32_dpp v7, v7, v7, vcc wave_shr:1 row_mask:0xf bank_mask:0xf
    s_mov_b64 vcc, s[50:51]
    s_mov_b64 exec, s[50:51]
    s_cbranch_scc0 L2_d65
    s_mov_b64 exec, s[82:83]
    s_nop 1
    v_mfma_f32_4x4x4_16b_bf16 v[88:91], v[12:13], v[84:85], 0
    s_nop 1
    v_mfma_f32_4x4x4_16b_bf16 v[88:91], v[10:11], v[86:87], v[88:91]
    s_nop 4
    v_cvt_pk_bf16_f32 v88, v88, v89
    v_cvt_pk_bf16_f32 v89, v90, v91
    ds_pk_add_bf16 v7, v88 offset:65408
    ds_pk_add_bf16 v7, v89 offset:65412
    s_mov_b64 exec, vcc
    s_branch L2_d65
L2_c66:
    s_mov_b64 s[50:51], vcc
    s_lshl_b64 s[52:53], s[82:83], 1
    s_andn2_b64 s[52:53], s[52:53], s[80:81]
    s_andn2_b64 s[52:53], s[52:53], s[50:51]
    s_or_b64 s[80:81], s[80:81], s[52:53]
    s_not_b64 vcc, s[52:53]
    s_mov_b64 exec, -1
    v_cndmask_b32_dpp v84, v84, v84, vcc wave_shr:1 row_mask:0xf bank_mask:0xf
    v_cndmask_b32_dpp v85, v85, v85, vcc wave_shr:1 row_mask:0xf bank_mask:0xf
    s_lshr_b64 s[52:53], s[52:53], 1
    v_cndmask_b32_dpp v86, v86, v86, vcc wave_shr:1 row_mask:0xf bank_mask:0xf
    v_cndmask_b32_dpp v87, v87, v87, vcc wave_shr:1 row_mask:0xf bank_mask:0xf
    s_andn2_b64 s[82:83], s[82:83], s[52:53]
    v_cndmask_b32_dpp v7, v7, v7, vcc wave_shr:1 row_mask:0xf bank_mask:0xf
    s_mov_b64 vcc, s[50:51]
    s_mov_b64 exec, s[50:51]
    s_cbranch_scc0 L2_d66
    s_mov_b64 exec, s[82:83]
    s_nop 1
    v_mfma_f32_4x4x4_16b_bf16 v[88:91], v[12:13], v[84:85], 0
    s_nop 1
    v_mfma_f32_4x4x4_16b_bf16 v[88:91], v[10:11], v[86:87], v[88:91]
    s_nop 4
    v_cvt_pk_bf16_f32 v88, v88, v89
    v_cvt_pk_bf16_f32 v89, v90, v91
    ds_pk_add_bf16 v7, v88 offset:65408
    ds_pk_add_bf16 v7, v89 offset:65412
    s_mov_b64 exec, vcc
    s_branch L2_d66
L2_c67:
    s_mov_b64 s[50:51], vcc
    s_lshl_b64 s[52:53], s[82:83], 1
    s_andn2_b64 s[52:53], s[52:53], s[80:81]
    s_andn2_b64 s[52:53], s[52:53], s[50:51]
    s_or_b64 s[80:81], s[80:81], s[52:53]
    s_not_b64 vcc, s[52:53]
    s_mov_b64 exec, -1
    v_cndmask_b32_dpp v84, v84, v84, vcc wave_shr:1 row_mask:0xf bank_mask:0xf
    v_cndmask_b32_dpp v85, v85, v85, vcc wave_shr:1 row_mask:0xf bank_mask:0xf
    s_lshr_b64 s[52:53], s[52:53], 1
    v_cndmask_b32_dpp v86, v86, v86, vcc wave_shr:1 row_mask:0xf bank_mask:0xf
    v_cndmask_b32_dpp v87, v87, v87, vcc wave_shr:1 row_mask:0xf bank_mask:0xf
    s_andn2_b64 s[82:83], s[82:83], s[52:53]
    v_cndmask_b32_dpp v7, v7, v7, vcc wave_shr:1 row_mask:0xf bank_mask:0xf
    s_mov_b64 vcc, s[50:51]
    s_mov_b64 exec, s[50:51]
    s_cbranch_scc0 L2_d67
    s_mov_b64 exec, s[82:83]
    s_nop 1
    v_mfma_f32_4x4x4_16b_bf16 v[88:91], v[12:13], v[84:85], 0
    s_nop 1
    v_mfma_f32_4x4x4_16b_bf16 v[88:91], v[10:11], v[86:87], v[88:91]
    s_nop 4
    v_cvt_pk_bf16_f32 v88, v88, v89
    v_cvt_pk_bf16_f32 v89, v90, v91
    ds_pk_add_bf16 v7, v88 offset:65408
    ds_pk_add_bf16 v7, v89 offset:65412
    s_mov_b64 exec, vcc
    s_branch L2_d67
L2_c68:
    s_mov_b64 s[50:51], vcc
    s_lshl_b64 s[52:53], s[82:83], 1
    s_andn2_b64 s[52:53], s[52:53], s[80:81]
    s_andn2_b64 s[52:53], s[52:53], s[50:51]
    s_or_b64 s[80:81], s[80:81], s[52:53]
    s_not_b64 vcc, s[52:53]
    s_mov_b64 exec, -1
    v_cndmask_b32_dpp v84, v84, v84, vcc wave_shr:1 row_mask:0xf bank_mask:0xf
    v_cndmask_b32_dpp v85, v85, v85, vcc wave_shr:1 row_mask:0xf bank_mask:0xf
    s_lshr_b64 s[52:53], s[52:53], 1
    v_cndmask_b32_dpp v86, v86, v86, vcc wave_shr:1 row_mask:0xf bank_mask:0xf
    v_cndmask_b32_dpp v87, v87, v87, vcc wave_shr:1 row_mask:0xf bank_mask:0xf
    s_andn2_b64 s[82:83], s[82:83], s[52:53]
    v_cndmask_b32_dpp v7, v7, v7, vcc wave_shr:1 row_mask:0xf bank_mask:0xf
    s_mov_b64 vcc, s[50:51]
    s_mov_b64 exec, s[50:51]
    s_cbranch_scc0 L2_d68
    s_mov_b64 exec, s[82:83]
    s_nop 1
    v_mfma_f32_4x4x4_16b_bf16 v[88:91], v[12:13], v[84:85], 0
    s_nop 1
    v_mfma_f32_4x4x4_16b_bf16 v[88:91], v[10:11], v[86:87], v[88:91]
    s_nop 4
    v_cvt_pk_bf16_f32 v88, v88, v89
    v_cvt_pk_bf16_f32 v89, v90, v91
    ds_pk_add_bf16 v7, v88 offset:65408
    ds_pk_add_bf16 v7, v89 offset:65412
    s_mov_b64 exec, vcc
    s_branch L2_d68
L2_c69:
    s_mov_b64 s[50:51], vcc
    s_lshl_b64 s[52:53], s[82:83], 1
    s_andn2_b64 s[52:53], s[52:53], s[80:81]
    s_andn2_b64 s[52:53], s[52:53], s[50:51]
    s_or_b64 s[80:81], s[80:81], s[52:53]
    s_not_b64 vcc, s[52:53]
    s_mov_b64 exec, -1
    v_cndmask_b32_dpp v84, v84, v84, vcc wave_shr:1 row_mask:0xf bank_mask:0xf
    v_cndmask_b32_dpp v85, v85, v85, vcc wave_shr:1 row_mask:0xf bank_mask:0xf
    s_lshr_b64 s[52:53], s[52:53], 1
    v_cndmask_b32_dpp v86, v86, v86, vcc wave_shr:1 row_mask:0xf bank_mask:0xf
    v_cndmask_b32_dpp v87, v87, v87, vcc wave_shr:1 row_mask:0xf bank_mask:0xf
    s_andn2_b64 s[82:83], s[82:83], s[52:53]
    v_cndmask_b32_dpp v7, v7, v7, vcc wave_shr:1 row_mask:0xf bank_mask:0xf
    s_mov_b64 vcc, s[50:51]
    s_mov_b64 exec, s[50:51]
    s_cbranch_scc0 L2_d69
    s_mov_b64 exec, s[82:83]
    s_nop 1
    v_mfma_f32_4x4x4_16b_bf16 v[88:91], v[12:13], v[84:85], 0
    s_nop 1
    v_mfma_f32_4x4x4_16b_bf16 v[88:91], v[10:11], v[86:87], v[88:91]
    s_nop 4
    v_cvt_pk_bf16_f32 v88, v88, v89
    v_cvt_pk_bf16_f32 v89, v90, v91
    ds_pk_add_bf16 v7, v88 offset:65408
    ds_pk_add_bf16 v7, v89 offset:65412
    s_mov_b64 exec, vcc
    s_branch L2_d69
L2_c70:
    s_mov_b64 s[50:51], vcc
    s_lshl_b64 s[52:53], s[82:83], 1
    s_andn2_b64 s[52:53], s[52:53], s[80:81]
    s_andn2_b64 s[52:53], s[52:53], s[50:51]
    s_or_b64 s[80:81], s[80:81], s[52:53]
    s_not_b64 vcc, s[52:53]
    s_mov_b64 exec, -1
    v_cndmask_b32_dpp v84, v84, v84, vcc wave_shr:1 row_mask:0xf bank_mask:0xf
    v_cndmask_b32_dpp v85, v85, v85, vcc wave_shr:1 row_mask:0xf bank_mask:0xf
    s_lshr_b64 s[52:53], s[52:53], 1
    v_cndmask_b32_dpp v86, v86, v86, vcc wave_shr:1 row_mask:0xf bank_mask:0xf
    v_cndmask_b32_dpp v87, v87, v87, vcc wave_shr:1 row_mask:0xf bank_mask:0xf
    s_andn2_b64 s[82:83], s[82:83], s[52:53]
    v_cndmask_b32_dpp v7, v7, v7, vcc wave_shr:1 row_mask:0xf bank_mask:0xf
    s_mov_b64 vcc, s[50:51]
    s_mov_b64 exec, s[50:51]
    s_cbranch_scc0 L2_d70
    s_mov_b64 exec, s[82:83]
    s_nop 1
    v_mfma_f32_4x4x4_16b_bf16 v[88:91], v[12:13], v[84:85], 0
    s_nop 1
    v_mfma_f32_4x4x4_16b_bf16 v[88:91], v[10:11], v[86:87], v[88:91]
    s_nop 4
    v_cvt_pk_bf16_f32 v88, v88, v89
    v_cvt_pk_bf16_f32 v89, v90, v91
    ds_pk_add_bf16 v7, v88 offset:65408
    ds_pk_add_bf16 v7, v89 offset:65412
    s_mov_b64 exec, vcc
    s_branch L2_d70
L2_c71:
    s_mov_b64 s[50:51], vcc
    s_lshl_b64 s[52:53], s[82:83], 1
    s_andn2_b64 s[52:53], s[52:53], s[80:81]
    s_andn2_b64 s[52:53], s[52:53], s[50:51]
    s_or_b64 s[80:81], s[80:81], s[52:53]
    s_not_b64 vcc, s[52:53]
    s_mov_b64 exec, -1
    v_cndmask_b32_dpp v84, v84, v84, vcc wave_shr:1 row_mask:0xf bank_mask:0xf
    v_cndmask_b32_dpp v85, v85, v85, vcc wave_shr:1 row_mask:0xf bank_mask:0xf
    s_lshr_b64 s[52:53], s[52:53], 1
    v_cndmask_b32_dpp v86, v86, v86, vcc wave_shr:1 row_mask:0xf bank_mask:0xf
    v_cndmask_b32_dpp v87, v87, v87, vcc wave_shr:1 row_mask:0xf bank_mask:0xf
    s_andn2_b64 s[82:83], s[82:83], s[52:53]
    v_cndmask_b32_dpp v7, v7, v7, vcc wave_shr:1 row_mask:0xf bank_mask:0xf
    s_mov_b64 vcc, s[50:51]
    s_mov_b64 exec, s[50:51]
    s_cbranch_scc0 L2_d71
    s_mov_b64 exec, s[82:83]
    s_nop 1
    v_mfma_f32_4x4x4_16b_bf16 v[88:91], v[12:13], v[84:85], 0
    s_nop 1
    v_mfma_f32_4x4x4_16b_bf16 v[88:91], v[10:11], v[86:87], v[88:91]
    s_nop 4
    v_cvt_pk_bf16_f32 v88, v88, v89
    v_cvt_pk_bf16_f32 v89, v90, v91
    ds_pk_add_bf16 v7, v88 offset:65408
    ds_pk_add_bf16 v7, v89 offset:65412
    s_mov_b64 exec, vcc
    s_branch L2_d71
L2_xa72:
    s_cmp_eq_u32 s43, 1
    s_cbranch_scc1 L2_xc72
    v_lshlrev_b32 v89, 0, v96
    v_add_u32 v90, 140, v97
    v_bitop3_b32 v90, v89, v45, v90 bitop3:0x6a
    ds_write_b32 v98, v90 offset:28
    v_lshlrev_b32 v89, 4, v96
    v_add_u32 v90, 120, v97
    v_bitop3_b32 v90, v89, v45, v90 bitop3:0x6a
    ds_write_b32 v98, v90 offset:24
    v_lshlrev_b32 v89, 8, v96
    v_add_u32 v90, 100, v97
    v_bitop3_b32 v90, v89, v45, v90 bitop3:0x6a
    ds_write_b32 v98, v90 offset:20
L2_xc72:
    v_lshlrev_b32 v89, 12, v96
    v_add_u32 v90, 80, v97
    v_bitop3_b32 v90, v89, v45, v90 bitop3:0x6a
    ds_write_b32 v98, v90 offset:16
    s_branch L2_xb72
L2_xe72:
    v_cmp_lt_u32 vcc, 32, v99
    v_cmp_lt_u32 s[58:59], 31, v88
    v_lshrrev_b32 v89, 16, v96
    v_add_u32 v97, 80, v97
    s_or_b64 vcc, vcc, s[58:59]
    s_cbranch_scc1 L2_xs72
    v_lshlrev_b32 v89, v1, v89
    v_and_b32 v89, v45, v89
    v_cmp_ne_u32 vcc, 0, v89
    v_xor_b32 v90, v97, v89
    s_add_u32 s3, s37, s38
    v_mbcnt_lo_u32_b32 v98, vcc_lo, 0
    v_mbcnt_hi_u32_b32 v98, vcc_hi, v98
    s_bcnt1_i32_b64 s41, vcc
    v_lshl_add_u32 v98, v98, 2, s3
    s_mov_b64 exec, vcc
    ds_write_b32 v98, v90
    s_mov_b64 exec, -1
    s_lshl2_add_u32 s37, s41, s37
    s_branch L2_xr72
L2_xf72:
    s_waitcnt lgkmcnt(0)
    s_cmp_gt_u32 s37, 1024
    s_cbranch_scc1 L2_xs72
    v_mov_b32 v43, -1
    s_cmp_ge_u32 s37, 512
    s_cbranch_scc1 L2_xg72
    v_mov_b32 v42, -1
    s_cmp_ge_u32 s37, 256
    s_cbranch_scc1 L2_xg72
    v_mov_b32 v41, -1
    s_branch L2_xg72
L2_xs72:
    s_waitcnt lgkmcnt(0)
    v_mov_b32 v40, -1
    v_mov_b32 v41, -1
    v_mov_b32 v42, -1
    v_mov_b32 v43, -1
    s_add_u32 s3, s42, 2
    s_bitset1_b32 s36, s3
    s_branch L2_xg72
L2_c73:
    s_mov_b64 s[50:51], vcc
    s_lshl_b64 s[52:53], s[82:83], 1
    s_andn2_b64 s[52:53], s[52:53], s[80:81]
    s_andn2_b64 s[52:53], s[52:53], s[50:51]
    s_or_b64 s[80:81], s[80:81], s[52:53]
    s_not_b64 vcc, s[52:53]
    s_mov_b64 exec, -1
    v_cndmask_b32_dpp v84, v84, v84, vcc wave_shr:1 row_mask:0xf bank_mask:0xf
    v_cndmask_b32_dpp v85, v85, v85, vcc wave_shr:1 row_mask:0xf bank_mask:0xf
    s_lshr_b64 s[52:53], s[52:53], 1
    v_cndmask_b32_dpp v86, v86, v86, vcc wave_shr:1 row_mask:0xf bank_mask:0xf
    v_cndmask_b32_dpp v87, v87, v87, vcc wave_shr:1 row_mask:0xf bank_mask:0xf
    s_andn2_b64 s[82:83], s[82:83], s[52:53]
    v_cndmask_b32_dpp v7, v7, v7, vcc wave_shr:1 row_mask:0xf bank_mask:0xf
    s_mov_b64 vcc, s[50:51]
    s_mov_b64 exec, s[50:51]
    s_cbranch_scc0 L2_d73
    s_mov_b64 exec, s[82:83]
    s_nop 1
    v_mfma_f32_4x4x4_16b_bf16 v[88:91], v[12:13], v[84:85], 0
    s_nop 1
    v_mfma_f32_4x4x4_16b_bf16 v[88:91], v[10:11], v[86:87], v[88:91]
    s_nop 4
    v_cvt_pk_bf16_f32 v88, v88, v89
    v_cvt_pk_bf16_f32 v89, v90, v91
    ds_pk_add_bf16 v7, v88 offset:65408
    ds_pk_add_bf16 v7, v89 offset:65412
    s_mov_b64 exec, vcc
    s_branch L2_d73
L2_c74:
    s_mov_b64 s[50:51], vcc
    s_lshl_b64 s[52:53], s[82:83], 1
    s_andn2_b64 s[52:53], s[52:53], s[80:81]
    s_andn2_b64 s[52:53], s[52:53], s[50:51]
    s_or_b64 s[80:81], s[80:81], s[52:53]
    s_not_b64 vcc, s[52:53]
    s_mov_b64 exec, -1
    v_cndmask_b32_dpp v84, v84, v84, vcc wave_shr:1 row_mask:0xf bank_mask:0xf
    v_cndmask_b32_dpp v85, v85, v85, vcc wave_shr:1 row_mask:0xf bank_mask:0xf
    s_lshr_b64 s[52:53], s[52:53], 1
    v_cndmask_b32_dpp v86, v86, v86, vcc wave_shr:1 row_mask:0xf bank_mask:0xf
    v_cndmask_b32_dpp v87, v87, v87, vcc wave_shr:1 row_mask:0xf bank_mask:0xf
    s_andn2_b64 s[82:83], s[82:83], s[52:53]
    v_cndmask_b32_dpp v7, v7, v7, vcc wave_shr:1 row_mask:0xf bank_mask:0xf
    s_mov_b64 vcc, s[50:51]
    s_mov_b64 exec, s[50:51]
    s_cbranch_scc0 L2_d74
    s_mov_b64 exec, s[82:83]
    s_nop 1
    v_mfma_f32_4x4x4_16b_bf16 v[88:91], v[12:13], v[84:85], 0
    s_nop 1
    v_mfma_f32_4x4x4_16b_bf16 v[88:91], v[10:11], v[86:87], v[88:91]
    s_nop 4
    v_cvt_pk_bf16_f32 v88, v88, v89
    v_cvt_pk_bf16_f32 v89, v90, v91
    ds_pk_add_bf16 v7, v88 offset:65408
    ds_pk_add_bf16 v7, v89 offset:65412
    s_mov_b64 exec, vcc
    s_branch L2_d74
L2_c75:
    s_mov_b64 s[50:51], vcc
    s_lshl_b64 s[52:53], s[82:83], 1
    s_andn2_b64 s[52:53], s[52:53], s[80:81]
    s_andn2_b64 s[52:53], s[52:53], s[50:51]
    s_or_b64 s[80:81], s[80:81], s[52:53]
    s_not_b64 vcc, s[52:53]
    s_mov_b64 exec, -1
    v_cndmask_b32_dpp v84, v84, v84, vcc wave_shr:1 row_mask:0xf bank_mask:0xf
    v_cndmask_b32_dpp v85, v85, v85, vcc wave_shr:1 row_mask:0xf bank_mask:0xf
    s_lshr_b64 s[52:53], s[52:53], 1
    v_cndmask_b32_dpp v86, v86, v86, vcc wave_shr:1 row_mask:0xf bank_mask:0xf
    v_cndmask_b32_dpp v87, v87, v87, vcc wave_shr:1 row_mask:0xf bank_mask:0xf
    s_andn2_b64 s[82:83], s[82:83], s[52:53]
    v_cndmask_b32_dpp v7, v7, v7, vcc wave_shr:1 row_mask:0xf bank_mask:0xf
    s_mov_b64 vcc, s[50:51]
    s_mov_b64 exec, s[50:51]
    s_cbranch_scc0 L2_d75
    s_mov_b64 exec, s[82:83]
    s_nop 1
    v_mfma_f32_4x4x4_16b_bf16 v[88:91], v[12:13], v[84:85], 0
    s_nop 1
    v_mfma_f32_4x4x4_16b_bf16 v[88:91], v[10:11], v[86:87], v[88:91]
    s_nop 4
    v_cvt_pk_bf16_f32 v88, v88, v89
    v_cvt_pk_bf16_f32 v89, v90, v91
    ds_pk_add_bf16 v7, v88 offset:65408
    ds_pk_add_bf16 v7, v89 offset:65412
    s_mov_b64 exec, vcc
    s_branch L2_d75
L2_c76:
    s_mov_b64 s[50:51], vcc
    s_lshl_b64 s[52:53], s[82:83], 1
    s_andn2_b64 s[52:53], s[52:53], s[80:81]
    s_andn2_b64 s[52:53], s[52:53], s[50:51]
    s_or_b64 s[80:81], s[80:81], s[52:53]
    s_not_b64 vcc, s[52:53]
    s_mov_b64 exec, -1
    v_cndmask_b32_dpp v84, v84, v84, vcc wave_shr:1 row_mask:0xf bank_mask:0xf
    v_cndmask_b32_dpp v85, v85, v85, vcc wave_shr:1 row_mask:0xf bank_mask:0xf
    s_lshr_b64 s[52:53], s[52:53], 1
    v_cndmask_b32_dpp v86, v86, v86, vcc wave_shr:1 row_mask:0xf bank_mask:0xf
    v_cndmask_b32_dpp v87, v87, v87, vcc wave_shr:1 row_mask:0xf bank_mask:0xf
    s_andn2_b64 s[82:83], s[82:83], s[52:53]
    v_cndmask_b32_dpp v7, v7, v7, vcc wave_shr:1 row_mask:0xf bank_mask:0xf
    s_mov_b64 vcc, s[50:51]
    s_mov_b64 exec, s[50:51]
    s_cbranch_scc0 L2_d76
    s_mov_b64 exec, s[82:83]
    s_nop 1
    v_mfma_f32_4x4x4_16b_bf16 v[88:91], v[12:13], v[84:85], 0
    s_nop 1
    v_mfma_f32_4x4x4_16b_bf16 v[88:91], v[10:11], v[86:87], v[88:91]
    s_nop 4
    v_cvt_pk_bf16_f32 v88, v88, v89
    v_cvt_pk_bf16_f32 v89, v90, v91
    ds_pk_add_bf16 v7, v88 offset:65408
    ds_pk_add_bf16 v7, v89 offset:65412
    s_mov_b64 exec, vcc
    s_branch L2_d76
L2_c77:
    s_mov_b64 s[50:51], vcc
    s_lshl_b64 s[52:53], s[82:83], 1
    s_andn2_b64 s[52:53], s[52:53], s[80:81]
    s_andn2_b64 s[52:53], s[52:53], s[50:51]
    s_or_b64 s[80:81], s[80:81], s[52:53]
    s_not_b64 vcc, s[52:53]
    s_mov_b64 exec, -1
    v_cndmask_b32_dpp v84, v84, v84, vcc wave_shr:1 row_mask:0xf bank_mask:0xf
    v_cndmask_b32_dpp v85, v85, v85, vcc wave_shr:1 row_mask:0xf bank_mask:0xf
    s_lshr_b64 s[52:53], s[52:53], 1
    v_cndmask_b32_dpp v86, v86, v86, vcc wave_shr:1 row_mask:0xf bank_mask:0xf
    v_cndmask_b32_dpp v87, v87, v87, vcc wave_shr:1 row_mask:0xf bank_mask:0xf
    s_andn2_b64 s[82:83], s[82:83], s[52:53]
    v_cndmask_b32_dpp v7, v7, v7, vcc wave_shr:1 row_mask:0xf bank_mask:0xf
    s_mov_b64 vcc, s[50:51]
    s_mov_b64 exec, s[50:51]
    s_cbranch_scc0 L2_d77
    s_mov_b64 exec, s[82:83]
    s_nop 1
    v_mfma_f32_4x4x4_16b_bf16 v[88:91], v[12:13], v[84:85], 0
    s_nop 1
    v_mfma_f32_4x4x4_16b_bf16 v[88:91], v[10:11], v[86:87], v[88:91]
    s_nop 4
    v_cvt_pk_bf16_f32 v88, v88, v89
    v_cvt_pk_bf16_f32 v89, v90, v91
    ds_pk_add_bf16 v7, v88 offset:65408
    ds_pk_add_bf16 v7, v89 offset:65412
    s_mov_b64 exec, vcc
    s_branch L2_d77
L2_c78:
    s_mov_b64 s[50:51], vcc
    s_lshl_b64 s[52:53], s[82:83], 1
    s_andn2_b64 s[52:53], s[52:53], s[80:81]
    s_andn2_b64 s[52:53], s[52:53], s[50:51]
    s_or_b64 s[80:81], s[80:81], s[52:53]
    s_not_b64 vcc, s[52:53]
    s_mov_b64 exec, -1
    v_cndmask_b32_dpp v84, v84, v84, vcc wave_shr:1 row_mask:0xf bank_mask:0xf
    v_cndmask_b32_dpp v85, v85, v85, vcc wave_shr:1 row_mask:0xf bank_mask:0xf
    s_lshr_b64 s[52:53], s[52:53], 1
    v_cndmask_b32_dpp v86, v86, v86, vcc wave_shr:1 row_mask:0xf bank_mask:0xf
    v_cndmask_b32_dpp v87, v87, v87, vcc wave_shr:1 row_mask:0xf bank_mask:0xf
    s_andn2_b64 s[82:83], s[82:83], s[52:53]
    v_cndmask_b32_dpp v7, v7, v7, vcc wave_shr:1 row_mask:0xf bank_mask:0xf
    s_mov_b64 vcc, s[50:51]
    s_mov_b64 exec, s[50:51]
    s_cbranch_scc0 L2_d78
    s_mov_b64 exec, s[82:83]
    s_nop 1
    v_mfma_f32_4x4x4_16b_bf16 v[88:91], v[12:13], v[84:85], 0
    s_nop 1
    v_mfma_f32_4x4x4_16b_bf16 v[88:91], v[10:11], v[86:87], v[88:91]
    s_nop 4
    v_cvt_pk_bf16_f32 v88, v88, v89
    v_cvt_pk_bf16_f32 v89, v90, v91
    ds_pk_add_bf16 v7, v88 offset:65408
    ds_pk_add_bf16 v7, v89 offset:65412
    s_mov_b64 exec, vcc
    s_branch L2_d78
L2_c79:
    s_mov_b64 s[50:51], vcc
    s_lshl_b64 s[52:53], s[82:83], 1
    s_andn2_b64 s[52:53], s[52:53], s[80:81]
    s_andn2_b64 s[52:53], s[52:53], s[50:51]
    s_or_b64 s[80:81], s[80:81], s[52:53]
    s_not_b64 vcc, s[52:53]
    s_mov_b64 exec, -1
    v_cndmask_b32_dpp v84, v84, v84, vcc wave_shr:1 row_mask:0xf bank_mask:0xf
    v_cndmask_b32_dpp v85, v85, v85, vcc wave_shr:1 row_mask:0xf bank_mask:0xf
    s_lshr_b64 s[52:53], s[52:53], 1
    v_cndmask_b32_dpp v86, v86, v86, vcc wave_shr:1 row_mask:0xf bank_mask:0xf
    v_cndmask_b32_dpp v87, v87, v87, vcc wave_shr:1 row_mask:0xf bank_mask:0xf
    s_andn2_b64 s[82:83], s[82:83], s[52:53]
    v_cndmask_b32_dpp v7, v7, v7, vcc wave_shr:1 row_mask:0xf bank_mask:0xf
    s_mov_b64 vcc, s[50:51]
    s_mov_b64 exec, s[50:51]
    s_cbranch_scc0 L2_d79
    s_mov_b64 exec, s[82:83]
    s_nop 1
    v_mfma_f32_4x4x4_16b_bf16 v[88:91], v[12:13], v[84:85], 0
    s_nop 1
    v_mfma_f32_4x4x4_16b_bf16 v[88:91], v[10:11], v[86:87], v[88:91]
    s_nop 4
    v_cvt_pk_bf16_f32 v88, v88, v89
    v_cvt_pk_bf16_f32 v89, v90, v91
    ds_pk_add_bf16 v7, v88 offset:65408
    ds_pk_add_bf16 v7, v89 offset:65412
    s_mov_b64 exec, vcc
    s_branch L2_d79
L2_c80:
    s_mov_b64 s[50:51], vcc
    s_lshl_b64 s[52:53], s[82:83], 1
    s_andn2_b64 s[52:53], s[52:53], s[80:81]
    s_andn2_b64 s[52:53], s[52:53], s[50:51]
    s_or_b64 s[80:81], s[80:81], s[52:53]
    s_not_b64 vcc, s[52:53]
    s_mov_b64 exec, -1
    v_cndmask_b32_dpp v84, v84, v84, vcc wave_shr:1 row_mask:0xf bank_mask:0xf
    v_cndmask_b32_dpp v85, v85, v85, vcc wave_shr:1 row_mask:0xf bank_mask:0xf
    s_lshr_b64 s[52:53], s[52:53], 1
    v_cndmask_b32_dpp v86, v86, v86, vcc wave_shr:1 row_mask:0xf bank_mask:0xf
    v_cndmask_b32_dpp v87, v87, v87, vcc wave_shr:1 row_mask:0xf bank_mask:0xf
    s_andn2_b64 s[82:83], s[82:83], s[52:53]
    v_cndmask_b32_dpp v7, v7, v7, vcc wave_shr:1 row_mask:0xf bank_mask:0xf
    s_mov_b64 vcc, s[50:51]
    s_mov_b64 exec, s[50:51]
    s_cbranch_scc0 L2_d80
    s_mov_b64 exec, s[82:83]
    s_nop 1
    v_mfma_f32_4x4x4_16b_bf16 v[88:91], v[12:13], v[84:85], 0
    s_nop 1
    v_mfma_f32_4x4x4_16b_bf16 v[88:91], v[10:11], v[86:87], v[88:91]
    s_nop 4
    v_cvt_pk_bf16_f32 v88, v88, v89
    v_cvt_pk_bf16_f32 v89, v90, v91
    ds_pk_add_bf16 v7, v88 offset:65408
    ds_pk_add_bf16 v7, v89 offset:65412
    s_mov_b64 exec, vcc
    s_branch L2_d80
L2_xo81:
    v_cmp_lt_u32 vcc, 20, v99
    s_mov_b32 s43, 1
    s_cbranch_vccz L2_xp81
    v_cmp_lt_u32 vcc, 32, v99
    v_cmp_lt_u32 s[58:59], 31, v88
    s_mov_b32 s43, 2
    s_or_b64 vcc, vcc, s[58:59]
    s_cbranch_scc0 L2_xp81
    s_mov_b32 s37, 0x10000
    s_branch L2_xp81
L2_c82:
    s_mov_b64 s[50:51], vcc
    s_lshl_b64 s[52:53], s[82:83], 1
    s_andn2_b64 s[52:53], s[52:53], s[80:81]
    s_andn2_b64 s[52:53], s[52:53], s[50:51]
    s_or_b64 s[80:81], s[80:81], s[52:53]
    s_not_b64 vcc, s[52:53]
    s_mov_b64 exec, -1
    v_cndmask_b32_dpp v84, v84, v84, vcc wave_shr:1 row_mask:0xf bank_mask:0xf
    v_cndmask_b32_dpp v85, v85, v85, vcc wave_shr:1 row_mask:0xf bank_mask:0xf
    s_lshr_b64 s[52:53], s[52:53], 1
    v_cndmask_b32_dpp v86, v86, v86, vcc wave_shr:1 row_mask:0xf bank_mask:0xf
    v_cndmask_b32_dpp v87, v87, v87, vcc wave_shr:1 row_mask:0xf bank_mask:0xf
    s_andn2_b64 s[82:83], s[82:83], s[52:53]
    v_cndmask_b32_dpp v7, v7, v7, vcc wave_shr:1 row_mask:0xf bank_mask:0xf
    s_mov_b64 vcc, s[50:51]
    s_mov_b64 exec, s[50:51]
    s_cbranch_scc0 L2_d82
    s_mov_b64 exec, s[82:83]
    s_nop 1
    v_mfma_f32_4x4x4_16b_bf16 v[88:91], v[12:13], v[84:85], 0
    s_nop 1
    v_mfma_f32_4x4x4_16b_bf16 v[88:91], v[10:11], v[86:87], v[88:91]
    s_nop 4
    v_cvt_pk_bf16_f32 v88, v88, v89
    v_cvt_pk_bf16_f32 v89, v90, v91
    ds_pk_add_bf16 v7, v88 offset:65408
    ds_pk_add_bf16 v7, v89 offset:65412
    s_mov_b64 exec, vcc
    s_branch L2_d82
L2_c83:
    s_mov_b64 s[50:51], vcc
    s_lshl_b64 s[52:53], s[82:83], 1
    s_andn2_b64 s[52:53], s[52:53], s[80:81]
    s_andn2_b64 s[52:53], s[52:53], s[50:51]
    s_or_b64 s[80:81], s[80:81], s[52:53]
    s_not_b64 vcc, s[52:53]
    s_mov_b64 exec, -1
    v_cndmask_b32_dpp v84, v84, v84, vcc wave_shr:1 row_mask:0xf bank_mask:0xf
    v_cndmask_b32_dpp v85, v85, v85, vcc wave_shr:1 row_mask:0xf bank_mask:0xf
    s_lshr_b64 s[52:53], s[52:53], 1
    v_cndmask_b32_dpp v86, v86, v86, vcc wave_shr:1 row_mask:0xf bank_mask:0xf
    v_cndmask_b32_dpp v87, v87, v87, vcc wave_shr:1 row_mask:0xf bank_mask:0xf
    s_andn2_b64 s[82:83], s[82:83], s[52:53]
    v_cndmask_b32_dpp v7, v7, v7, vcc wave_shr:1 row_mask:0xf bank_mask:0xf
    s_mov_b64 vcc, s[50:51]
    s_mov_b64 exec, s[50:51]
    s_cbranch_scc0 L2_d83
    s_mov_b64 exec, s[82:83]
    s_nop 1
    v_mfma_f32_4x4x4_16b_bf16 v[88:91], v[12:13], v[84:85], 0
    s_nop 1
    v_mfma_f32_4x4x4_16b_bf16 v[88:91], v[10:11], v[86:87], v[88:91]
    s_nop 4
    v_cvt_pk_bf16_f32 v88, v88, v89
    v_cvt_pk_bf16_f32 v89, v90, v91
    ds_pk_add_bf16 v7, v88 offset:65408
    ds_pk_add_bf16 v7, v89 offset:65412
    s_mov_b64 exec, vcc
    s_branch L2_d83
L2_c84:
    s_mov_b64 s[50:51], vcc
    s_lshl_b64 s[52:53], s[82:83], 1
    s_andn2_b64 s[52:53], s[52:53], s[80:81]
    s_andn2_b64 s[52:53], s[52:53], s[50:51]
    s_or_b64 s[80:81], s[80:81], s[52:53]
    s_not_b64 vcc, s[52:53]
    s_mov_b64 exec, -1
    v_cndmask_b32_dpp v84, v84, v84, vcc wave_shr:1 row_mask:0xf bank_mask:0xf
    v_cndmask_b32_dpp v85, v85, v85, vcc wave_shr:1 row_mask:0xf bank_mask:0xf
    s_lshr_b64 s[52:53], s[52:53], 1
    v_cndmask_b32_dpp v86, v86, v86, vcc wave_shr:1 row_mask:0xf bank_mask:0xf
    v_cndmask_b32_dpp v87, v87, v87, vcc wave_shr:1 row_mask:0xf bank_mask:0xf
    s_andn2_b64 s[82:83], s[82:83], s[52:53]
    v_cndmask_b32_dpp v7, v7, v7, vcc wave_shr:1 row_mask:0xf bank_mask:0xf
    s_mov_b64 vcc, s[50:51]
    s_mov_b64 exec, s[50:51]
    s_cbranch_scc0 L2_d84
    s_mov_b64 exec, s[82:83]
    s_nop 1
    v_mfma_f32_4x4x4_16b_bf16 v[88:91], v[12:13], v[84:85], 0
    s_nop 1
    v_mfma_f32_4x4x4_16b_bf16 v[88:91], v[10:11], v[86:87], v[88:91]
    s_nop 4
    v_cvt_pk_bf16_f32 v88, v88, v89
    v_cvt_pk_bf16_f32 v89, v90, v91
    ds_pk_add_bf16 v7, v88 offset:65408
    ds_pk_add_bf16 v7, v89 offset:65412
    s_mov_b64 exec, vcc
    s_branch L2_d84
L2_c85:
    s_mov_b64 s[50:51], vcc
    s_lshl_b64 s[52:53], s[82:83], 1
    s_andn2_b64 s[52:53], s[52:53], s[80:81]
    s_andn2_b64 s[52:53], s[52:53], s[50:51]
    s_or_b64 s[80:81], s[80:81], s[52:53]
    s_not_b64 vcc, s[52:53]
    s_mov_b64 exec, -1
    v_cndmask_b32_dpp v84, v84, v84, vcc wave_shr:1 row_mask:0xf bank_mask:0xf
    v_cndmask_b32_dpp v85, v85, v85, vcc wave_shr:1 row_mask:0xf bank_mask:0xf
    s_lshr_b64 s[52:53], s[52:53], 1
    v_cndmask_b32_dpp v86, v86, v86, vcc wave_shr:1 row_mask:0xf bank_mask:0xf
    v_cndmask_b32_dpp v87, v87, v87, vcc wave_shr:1 row_mask:0xf bank_mask:0xf
    s_andn2_b64 s[82:83], s[82:83], s[52:53]
    v_cndmask_b32_dpp v7, v7, v7, vcc wave_shr:1 row_mask:0xf bank_mask:0xf
    s_mov_b64 vcc, s[50:51]
    s_mov_b64 exec, s[50:51]
    s_cbranch_scc0 L2_d85
    s_mov_b64 exec, s[82:83]
    s_nop 1
    v_mfma_f32_4x4x4_16b_bf16 v[88:91], v[12:13], v[84:85], 0
    s_nop 1
    v_mfma_f32_4x4x4_16b_bf16 v[88:91], v[10:11], v[86:87], v[88:91]
    s_nop 4
    v_cvt_pk_bf16_f32 v88, v88, v89
    v_cvt_pk_bf16_f32 v89, v90, v91
    ds_pk_add_bf16 v7, v88 offset:65408
    ds_pk_add_bf16 v7, v89 offset:65412
    s_mov_b64 exec, vcc
    s_branch L2_d85
L2_c86:
    s_mov_b64 s[50:51], vcc
    s_lshl_b64 s[52:53], s[82:83], 1
    s_andn2_b64 s[52:53], s[52:53], s[80:81]
    s_andn2_b64 s[52:53], s[52:53], s[50:51]
    s_or_b64 s[80:81], s[80:81], s[52:53]
    s_not_b64 vcc, s[52:53]
    s_mov_b64 exec, -1
    v_cndmask_b32_dpp v84, v84, v84, vcc wave_shr:1 row_mask:0xf bank_mask:0xf
    v_cndmask_b32_dpp v85, v85, v85, vcc wave_shr:1 row_mask:0xf bank_mask:0xf
    s_lshr_b64 s[52:53], s[52:53], 1
    v_cndmask_b32_dpp v86, v86, v86, vcc wave_shr:1 row_mask:0xf bank_mask:0xf
    v_cndmask_b32_dpp v87, v87, v87, vcc wave_shr:1 row_mask:0xf bank_mask:0xf
    s_andn2_b64 s[82:83], s[82:83], s[52:53]
    v_cndmask_b32_dpp v7, v7, v7, vcc wave_shr:1 row_mask:0xf bank_mask:0xf
    s_mov_b64 vcc, s[50:51]
    s_mov_b64 exec, s[50:51]
    s_cbranch_scc0 L2_d86
    s_mov_b64 exec, s[82:83]
    s_nop 1
    v_mfma_f32_4x4x4_16b_bf16 v[88:91], v[12:13], v[84:85], 0
    s_nop 1
    v_mfma_f32_4x4x4_16b_bf16 v[88:91], v[10:11], v[86:87], v[88:91]
    s_nop 4
    v_cvt_pk_bf16_f32 v88, v88, v89
    v_cvt_pk_bf16_f32 v89, v90, v91
    ds_pk_add_bf16 v7, v88 offset:65408
    ds_pk_add_bf16 v7, v89 offset:65412
    s_mov_b64 exec, vcc
    s_branch L2_d86
L2_c87:
    s_mov_b64 s[50:51], vcc
    s_lshl_b64 s[52:53], s[82:83], 1
    s_andn2_b64 s[52:53], s[52:53], s[80:81]
    s_andn2_b64 s[52:53], s[52:53], s[50:51]
    s_or_b64 s[80:81], s[80:81], s[52:53]
    s_not_b64 vcc, s[52:53]
    s_mov_b64 exec, -1
    v_cndmask_b32_dpp v84, v84, v84, vcc wave_shr:1 row_mask:0xf bank_mask:0xf
    v_cndmask_b32_dpp v85, v85, v85, vcc wave_shr:1 row_mask:0xf bank_mask:0xf
    s_lshr_b64 s[52:53], s[52:53], 1
    v_cndmask_b32_dpp v86, v86, v86, vcc wave_shr:1 row_mask:0xf bank_mask:0xf
    v_cndmask_b32_dpp v87, v87, v87, vcc wave_shr:1 row_mask:0xf bank_mask:0xf
    s_andn2_b64 s[82:83], s[82:83], s[52:53]
    v_cndmask_b32_dpp v7, v7, v7, vcc wave_shr:1 row_mask:0xf bank_mask:0xf
    s_mov_b64 vcc, s[50:51]
    s_mov_b64 exec, s[50:51]
    s_cbranch_scc0 L2_d87
    s_mov_b64 exec, s[82:83]
    s_nop 1
    v_mfma_f32_4x4x4_16b_bf16 v[88:91], v[12:13], v[84:85], 0
    s_nop 1
    v_mfma_f32_4x4x4_16b_bf16 v[88:91], v[10:11], v[86:87], v[88:91]
    s_nop 4
    v_cvt_pk_bf16_f32 v88, v88, v89
    v_cvt_pk_bf16_f32 v89, v90, v91
    ds_pk_add_bf16 v7, v88 offset:65408
    ds_pk_add_bf16 v7, v89 offset:65412
    s_mov_b64 exec, vcc
    s_branch L2_d87
L2_c88:
    s_mov_b64 s[50:51], vcc
    s_lshl_b64 s[52:53], s[82:83], 1
    s_andn2_b64 s[52:53], s[52:53], s[80:81]
    s_andn2_b64 s[52:53], s[52:53], s[50:51]
    s_or_b64 s[80:81], s[80:81], s[52:53]
    s_not_b64 vcc, s[52:53]
    s_mov_b64 exec, -1
    v_cndmask_b32_dpp v84, v84, v84, vcc wave_shr:1 row_mask:0xf bank_mask:0xf
    v_cndmask_b32_dpp v85, v85, v85, vcc wave_shr:1 row_mask:0xf bank_mask:0xf
    s_lshr_b64 s[52:53], s[52:53], 1
    v_cndmask_b32_dpp v86, v86, v86, vcc wave_shr:1 row_mask:0xf bank_mask:0xf
    v_cndmask_b32_dpp v87, v87, v87, vcc wave_shr:1 row_mask:0xf bank_mask:0xf
    s_andn2_b64 s[82:83], s[82:83], s[52:53]
    v_cndmask_b32_dpp v7, v7, v7, vcc wave_shr:1 row_mask:0xf bank_mask:0xf
    s_mov_b64 vcc, s[50:51]
    s_mov_b64 exec, s[50:51]
    s_cbranch_scc0 L2_d88
    s_mov_b64 exec, s[82:83]
    s_nop 1
    v_mfma_f32_4x4x4_16b_bf16 v[88:91], v[12:13], v[84:85], 0
    s_nop 1
    v_mfma_f32_4x4x4_16b_bf16 v[88:91], v[10:11], v[86:87], v[88:91]
    s_nop 4
    v_cvt_pk_bf16_f32 v88, v88, v89
    v_cvt_pk_bf16_f32 v89, v90, v91
    ds_pk_add_bf16 v7, v88 offset:65408
    ds_pk_add_bf16 v7, v89 offset:65412
    s_mov_b64 exec, vcc
    s_branch L2_d88
L2_c89:
    s_mov_b64 s[50:51], vcc
    s_lshl_b64 s[52:53], s[82:83], 1
    s_andn2_b64 s[52:53], s[52:53], s[80:81]
    s_andn2_b64 s[52:53], s[52:53], s[50:51]
    s_or_b64 s[80:81], s[80:81], s[52:53]
    s_not_b64 vcc, s[52:53]
    s_mov_b64 exec, -1
    v_cndmask_b32_dpp v84, v84, v84, vcc wave_shr:1 row_mask:0xf bank_mask:0xf
    v_cndmask_b32_dpp v85, v85, v85, vcc wave_shr:1 row_mask:0xf bank_mask:0xf
    s_lshr_b64 s[52:53], s[52:53], 1
    v_cndmask_b32_dpp v86, v86, v86, vcc wave_shr:1 row_mask:0xf bank_mask:0xf
    v_cndmask_b32_dpp v87, v87, v87, vcc wave_shr:1 row_mask:0xf bank_mask:0xf
    s_andn2_b64 s[82:83], s[82:83], s[52:53]
    v_cndmask_b32_dpp v7, v7, v7, vcc wave_shr:1 row_mask:0xf bank_mask:0xf
    s_mov_b64 vcc, s[50:51]
    s_mov_b64 exec, s[50:51]
    s_cbranch_scc0 L2_d89
    s_mov_b64 exec, s[82:83]
    s_nop 1
    v_mfma_f32_4x4x4_16b_bf16 v[88:91], v[12:13], v[84:85], 0
    s_nop 1
    v_mfma_f32_4x4x4_16b_bf16 v[88:91], v[10:11], v[86:87], v[88:91]
    s_nop 4
    v_cvt_pk_bf16_f32 v88, v88, v89
    v_cvt_pk_bf16_f32 v89, v90, v91
    ds_pk_add_bf16 v7, v88 offset:65408
    ds_pk_add_bf16 v7, v89 offset:65412
    s_mov_b64 exec, vcc
    s_branch L2_d89
L2_xa90:
    s_cmp_eq_u32 s43, 1
    s_cbranch_scc1 L2_xc90
    v_lshlrev_b32 v89, 0, v96
    v_add_u32 v90, 140, v97
    v_bitop3_b32 v90, v89, v45, v90 bitop3:0x6a
    ds_write_b32 v98, v90 offset:28
    v_lshlrev_b32 v89, 4, v96
    v_add_u32 v90, 120, v97
    v_bitop3_b32 v90, v89, v45, v90 bitop3:0x6a
    ds_write_b32 v98, v90 offset:24
    v_lshlrev_b32 v89, 8, v96
    v_add_u32 v90, 100, v97
    v_bitop3_b32 v90, v89, v45, v90 bitop3:0x6a
    ds_write_b32 v98, v90 offset:20
L2_xc90:
    v_lshlrev_b32 v89, 12, v96
    v_add_u32 v90, 80, v97
    v_bitop3_b32 v90, v89, v45, v90 bitop3:0x6a
    ds_write_b32 v98, v90 offset:16
    s_branch L2_xb90
L2_xe90:
    v_cmp_lt_u32 vcc, 32, v99
    v_cmp_lt_u32 s[58:59], 31, v88
    v_lshrrev_b32 v89, 16, v96
    v_add_u32 v97, 80, v97
    s_or_b64 vcc, vcc, s[58:59]
    s_cbranch_scc1 L2_xs90
    v_lshlrev_b32 v89, v1, v89
    v_and_b32 v89, v45, v89
    v_cmp_ne_u32 vcc, 0, v89
    v_xor_b32 v90, v97, v89
    s_add_u32 s3, s37, s38
    v_mbcnt_lo_u32_b32 v98, vcc_lo, 0
    v_mbcnt_hi_u32_b32 v98, vcc_hi, v98
    s_bcnt1_i32_b64 s41, vcc
    v_lshl_add_u32 v98, v98, 2, s3
    s_mov_b64 exec, vcc
    ds_write_b32 v98, v90
    s_mov_b64 exec, -1
    s_lshl2_add_u32 s37, s41, s37
    s_branch L2_xr90
L2_xf90:
    s_waitcnt lgkmcnt(0)
    s_cmp_gt_u32 s37, 1024
    s_cbranch_scc1 L2_xs90
    v_mov_b32 v43, -1
    s_cmp_ge_u32 s37, 512
    s_cbranch_scc1 L2_xg90
    v_mov_b32 v42, -1
    s_cmp_ge_u32 s37, 256
    s_cbranch_scc1 L2_xg90
    v_mov_b32 v41, -1
    s_branch L2_xg90
L2_xs90:
    s_waitcnt lgkmcnt(0)
    v_mov_b32 v40, -1
    v_mov_b32 v41, -1
    v_mov_b32 v42, -1
    v_mov_b32 v43, -1
    s_add_u32 s3, s42, 2
    s_bitset1_b32 s36, s3
    s_branch L2_xg90
L2_c91:
    s_mov_b64 s[50:51], vcc
    s_lshl_b64 s[52:53], s[82:83], 1
    s_andn2_b64 s[52:53], s[52:53], s[80:81]
    s_andn2_b64 s[52:53], s[52:53], s[50:51]
    s_or_b64 s[80:81], s[80:81], s[52:53]
    s_not_b64 vcc, s[52:53]
    s_mov_b64 exec, -1
    v_cndmask_b32_dpp v84, v84, v84, vcc wave_shr:1 row_mask:0xf bank_mask:0xf
    v_cndmask_b32_dpp v85, v85, v85, vcc wave_shr:1 row_mask:0xf bank_mask:0xf
    s_lshr_b64 s[52:53], s[52:53], 1
    v_cndmask_b32_dpp v86, v86, v86, vcc wave_shr:1 row_mask:0xf bank_mask:0xf
    v_cndmask_b32_dpp v87, v87, v87, vcc wave_shr:1 row_mask:0xf bank_mask:0xf
    s_andn2_b64 s[82:83], s[82:83], s[52:53]
    v_cndmask_b32_dpp v7, v7, v7, vcc wave_shr:1 row_mask:0xf bank_mask:0xf
    s_mov_b64 vcc, s[50:51]
    s_mov_b64 exec, s[50:51]
    s_cbranch_scc0 L2_d91
    s_mov_b64 exec, s[82:83]
    s_nop 1
    v_mfma_f32_4x4x4_16b_bf16 v[88:91], v[12:13], v[84:85], 0
    s_nop 1
    v_mfma_f32_4x4x4_16b_bf16 v[88:91], v[10:11], v[86:87], v[88:91]
    s_nop 4
    v_cvt_pk_bf16_f32 v88, v88, v89
    v_cvt_pk_bf16_f32 v89, v90, v91
    ds_pk_add_bf16 v7, v88 offset:65408
    ds_pk_add_bf16 v7, v89 offset:65412
    s_mov_b64 exec, vcc
    s_branch L2_d91
L2_c92:
    s_mov_b64 s[50:51], vcc
    s_lshl_b64 s[52:53], s[82:83], 1
    s_andn2_b64 s[52:53], s[52:53], s[80:81]
    s_andn2_b64 s[52:53], s[52:53], s[50:51]
    s_or_b64 s[80:81], s[80:81], s[52:53]
    s_not_b64 vcc, s[52:53]
    s_mov_b64 exec, -1
    v_cndmask_b32_dpp v84, v84, v84, vcc wave_shr:1 row_mask:0xf bank_mask:0xf
    v_cndmask_b32_dpp v85, v85, v85, vcc wave_shr:1 row_mask:0xf bank_mask:0xf
    s_lshr_b64 s[52:53], s[52:53], 1
    v_cndmask_b32_dpp v86, v86, v86, vcc wave_shr:1 row_mask:0xf bank_mask:0xf
    v_cndmask_b32_dpp v87, v87, v87, vcc wave_shr:1 row_mask:0xf bank_mask:0xf
    s_andn2_b64 s[82:83], s[82:83], s[52:53]
    v_cndmask_b32_dpp v7, v7, v7, vcc wave_shr:1 row_mask:0xf bank_mask:0xf
    s_mov_b64 vcc, s[50:51]
    s_mov_b64 exec, s[50:51]
    s_cbranch_scc0 L2_d92
    s_mov_b64 exec, s[82:83]
    s_nop 1
    v_mfma_f32_4x4x4_16b_bf16 v[88:91], v[12:13], v[84:85], 0
    s_nop 1
    v_mfma_f32_4x4x4_16b_bf16 v[88:91], v[10:11], v[86:87], v[88:91]
    s_nop 4
    v_cvt_pk_bf16_f32 v88, v88, v89
    v_cvt_pk_bf16_f32 v89, v90, v91
    ds_pk_add_bf16 v7, v88 offset:65408
    ds_pk_add_bf16 v7, v89 offset:65412
    s_mov_b64 exec, vcc
    s_branch L2_d92
L2_c93:
    s_mov_b64 s[50:51], vcc
    s_lshl_b64 s[52:53], s[82:83], 1
    s_andn2_b64 s[52:53], s[52:53], s[80:81]
    s_andn2_b64 s[52:53], s[52:53], s[50:51]
    s_or_b64 s[80:81], s[80:81], s[52:53]
    s_not_b64 vcc, s[52:53]
    s_mov_b64 exec, -1
    v_cndmask_b32_dpp v84, v84, v84, vcc wave_shr:1 row_mask:0xf bank_mask:0xf
    v_cndmask_b32_dpp v85, v85, v85, vcc wave_shr:1 row_mask:0xf bank_mask:0xf
    s_lshr_b64 s[52:53], s[52:53], 1
    v_cndmask_b32_dpp v86, v86, v86, vcc wave_shr:1 row_mask:0xf bank_mask:0xf
    v_cndmask_b32_dpp v87, v87, v87, vcc wave_shr:1 row_mask:0xf bank_mask:0xf
    s_andn2_b64 s[82:83], s[82:83], s[52:53]
    v_cndmask_b32_dpp v7, v7, v7, vcc wave_shr:1 row_mask:0xf bank_mask:0xf
    s_mov_b64 vcc, s[50:51]
    s_mov_b64 exec, s[50:51]
    s_cbranch_scc0 L2_d93
    s_mov_b64 exec, s[82:83]
    s_nop 1
    v_mfma_f32_4x4x4_16b_bf16 v[88:91], v[12:13], v[84:85], 0
    s_nop 1
    v_mfma_f32_4x4x4_16b_bf16 v[88:91], v[10:11], v[86:87], v[88:91]
    s_nop 4
    v_cvt_pk_bf16_f32 v88, v88, v89
    v_cvt_pk_bf16_f32 v89, v90, v91
    ds_pk_add_bf16 v7, v88 offset:65408
    ds_pk_add_bf16 v7, v89 offset:65412
    s_mov_b64 exec, vcc
    s_branch L2_d93
L2_c94:
    s_mov_b64 s[50:51], vcc
    s_lshl_b64 s[52:53], s[82:83], 1
    s_andn2_b64 s[52:53], s[52:53], s[80:81]
    s_andn2_b64 s[52:53], s[52:53], s[50:51]
    s_or_b64 s[80:81], s[80:81], s[52:53]
    s_not_b64 vcc, s[52:53]
    s_mov_b64 exec, -1
    v_cndmask_b32_dpp v84, v84, v84, vcc wave_shr:1 row_mask:0xf bank_mask:0xf
    v_cndmask_b32_dpp v85, v85, v85, vcc wave_shr:1 row_mask:0xf bank_mask:0xf
    s_lshr_b64 s[52:53], s[52:53], 1
    v_cndmask_b32_dpp v86, v86, v86, vcc wave_shr:1 row_mask:0xf bank_mask:0xf
    v_cndmask_b32_dpp v87, v87, v87, vcc wave_shr:1 row_mask:0xf bank_mask:0xf
    s_andn2_b64 s[82:83], s[82:83], s[52:53]
    v_cndmask_b32_dpp v7, v7, v7, vcc wave_shr:1 row_mask:0xf bank_mask:0xf
    s_mov_b64 vcc, s[50:51]
    s_mov_b64 exec, s[50:51]
    s_cbranch_scc0 L2_d94
    s_mov_b64 exec, s[82:83]
    s_nop 1
    v_mfma_f32_4x4x4_16b_bf16 v[88:91], v[12:13], v[84:85], 0
    s_nop 1
    v_mfma_f32_4x4x4_16b_bf16 v[88:91], v[10:11], v[86:87], v[88:91]
    s_nop 4
    v_cvt_pk_bf16_f32 v88, v88, v89
    v_cvt_pk_bf16_f32 v89, v90, v91
    ds_pk_add_bf16 v7, v88 offset:65408
    ds_pk_add_bf16 v7, v89 offset:65412
    s_mov_b64 exec, vcc
    s_branch L2_d94
L2_c95:
    s_mov_b64 s[50:51], vcc
    s_lshl_b64 s[52:53], s[82:83], 1
    s_andn2_b64 s[52:53], s[52:53], s[80:81]
    s_andn2_b64 s[52:53], s[52:53], s[50:51]
    s_or_b64 s[80:81], s[80:81], s[52:53]
    s_not_b64 vcc, s[52:53]
    s_mov_b64 exec, -1
    v_cndmask_b32_dpp v84, v84, v84, vcc wave_shr:1 row_mask:0xf bank_mask:0xf
    v_cndmask_b32_dpp v85, v85, v85, vcc wave_shr:1 row_mask:0xf bank_mask:0xf
    s_lshr_b64 s[52:53], s[52:53], 1
    v_cndmask_b32_dpp v86, v86, v86, vcc wave_shr:1 row_mask:0xf bank_mask:0xf
    v_cndmask_b32_dpp v87, v87, v87, vcc wave_shr:1 row_mask:0xf bank_mask:0xf
    s_andn2_b64 s[82:83], s[82:83], s[52:53]
    v_cndmask_b32_dpp v7, v7, v7, vcc wave_shr:1 row_mask:0xf bank_mask:0xf
    s_mov_b64 vcc, s[50:51]
    s_mov_b64 exec, s[50:51]
    s_cbranch_scc0 L2_d95
    s_mov_b64 exec, s[82:83]
    s_nop 1
    v_mfma_f32_4x4x4_16b_bf16 v[88:91], v[12:13], v[84:85], 0
    s_nop 1
    v_mfma_f32_4x4x4_16b_bf16 v[88:91], v[10:11], v[86:87], v[88:91]
    s_nop 4
    v_cvt_pk_bf16_f32 v88, v88, v89
    v_cvt_pk_bf16_f32 v89, v90, v91
    ds_pk_add_bf16 v7, v88 offset:65408
    ds_pk_add_bf16 v7, v89 offset:65412
    s_mov_b64 exec, vcc
    s_branch L2_d95
L2_c96:
    s_mov_b64 s[50:51], vcc
    s_lshl_b64 s[52:53], s[82:83], 1
    s_andn2_b64 s[52:53], s[52:53], s[80:81]
    s_andn2_b64 s[52:53], s[52:53], s[50:51]
    s_or_b64 s[80:81], s[80:81], s[52:53]
    s_not_b64 vcc, s[52:53]
    s_mov_b64 exec, -1
    v_cndmask_b32_dpp v84, v84, v84, vcc wave_shr:1 row_mask:0xf bank_mask:0xf
    v_cndmask_b32_dpp v85, v85, v85, vcc wave_shr:1 row_mask:0xf bank_mask:0xf
    s_lshr_b64 s[52:53], s[52:53], 1
    v_cndmask_b32_dpp v86, v86, v86, vcc wave_shr:1 row_mask:0xf bank_mask:0xf
    v_cndmask_b32_dpp v87, v87, v87, vcc wave_shr:1 row_mask:0xf bank_mask:0xf
    s_andn2_b64 s[82:83], s[82:83], s[52:53]
    v_cndmask_b32_dpp v7, v7, v7, vcc wave_shr:1 row_mask:0xf bank_mask:0xf
    s_mov_b64 vcc, s[50:51]
    s_mov_b64 exec, s[50:51]
    s_cbranch_scc0 L2_d96
    s_mov_b64 exec, s[82:83]
    s_nop 1
    v_mfma_f32_4x4x4_16b_bf16 v[88:91], v[12:13], v[84:85], 0
    s_nop 1
    v_mfma_f32_4x4x4_16b_bf16 v[88:91], v[10:11], v[86:87], v[88:91]
    s_nop 4
    v_cvt_pk_bf16_f32 v88, v88, v89
    v_cvt_pk_bf16_f32 v89, v90, v91
    ds_pk_add_bf16 v7, v88 offset:65408
    ds_pk_add_bf16 v7, v89 offset:65412
    s_mov_b64 exec, vcc
    s_branch L2_d96
L2_c97:
    s_mov_b64 s[50:51], vcc
    s_lshl_b64 s[52:53], s[82:83], 1
    s_andn2_b64 s[52:53], s[52:53], s[80:81]
    s_andn2_b64 s[52:53], s[52:53], s[50:51]
    s_or_b64 s[80:81], s[80:81], s[52:53]
    s_not_b64 vcc, s[52:53]
    s_mov_b64 exec, -1
    v_cndmask_b32_dpp v84, v84, v84, vcc wave_shr:1 row_mask:0xf bank_mask:0xf
    v_cndmask_b32_dpp v85, v85, v85, vcc wave_shr:1 row_mask:0xf bank_mask:0xf
    s_lshr_b64 s[52:53], s[52:53], 1
    v_cndmask_b32_dpp v86, v86, v86, vcc wave_shr:1 row_mask:0xf bank_mask:0xf
    v_cndmask_b32_dpp v87, v87, v87, vcc wave_shr:1 row_mask:0xf bank_mask:0xf
    s_andn2_b64 s[82:83], s[82:83], s[52:53]
    v_cndmask_b32_dpp v7, v7, v7, vcc wave_shr:1 row_mask:0xf bank_mask:0xf
    s_mov_b64 vcc, s[50:51]
    s_mov_b64 exec, s[50:51]
    s_cbranch_scc0 L2_d97
    s_mov_b64 exec, s[82:83]
    s_nop 1
    v_mfma_f32_4x4x4_16b_bf16 v[88:91], v[12:13], v[84:85], 0
    s_nop 1
    v_mfma_f32_4x4x4_16b_bf16 v[88:91], v[10:11], v[86:87], v[88:91]
    s_nop 4
    v_cvt_pk_bf16_f32 v88, v88, v89
    v_cvt_pk_bf16_f32 v89, v90, v91
    ds_pk_add_bf16 v7, v88 offset:65408
    ds_pk_add_bf16 v7, v89 offset:65412
    s_mov_b64 exec, vcc
    s_branch L2_d97
L2_c98:
    s_mov_b64 s[50:51], vcc
    s_lshl_b64 s[52:53], s[82:83], 1
    s_andn2_b64 s[52:53], s[52:53], s[80:81]
    s_andn2_b64 s[52:53], s[52:53], s[50:51]
    s_or_b64 s[80:81], s[80:81], s[52:53]
    s_not_b64 vcc, s[52:53]
    s_mov_b64 exec, -1
    v_cndmask_b32_dpp v84, v84, v84, vcc wave_shr:1 row_mask:0xf bank_mask:0xf
    v_cndmask_b32_dpp v85, v85, v85, vcc wave_shr:1 row_mask:0xf bank_mask:0xf
    s_lshr_b64 s[52:53], s[52:53], 1
    v_cndmask_b32_dpp v86, v86, v86, vcc wave_shr:1 row_mask:0xf bank_mask:0xf
    v_cndmask_b32_dpp v87, v87, v87, vcc wave_shr:1 row_mask:0xf bank_mask:0xf
    s_andn2_b64 s[82:83], s[82:83], s[52:53]
    v_cndmask_b32_dpp v7, v7, v7, vcc wave_shr:1 row_mask:0xf bank_mask:0xf
    s_mov_b64 vcc, s[50:51]
    s_mov_b64 exec, s[50:51]
    s_cbranch_scc0 L2_d98
    s_mov_b64 exec, s[82:83]
    s_nop 1
    v_mfma_f32_4x4x4_16b_bf16 v[88:91], v[12:13], v[84:85], 0
    s_nop 1
    v_mfma_f32_4x4x4_16b_bf16 v[88:91], v[10:11], v[86:87], v[88:91]
    s_nop 4
    v_cvt_pk_bf16_f32 v88, v88, v89
    v_cvt_pk_bf16_f32 v89, v90, v91
    ds_pk_add_bf16 v7, v88 offset:65408
    ds_pk_add_bf16 v7, v89 offset:65412
    s_mov_b64 exec, vcc
    s_branch L2_d98
L2_xo99:
    v_cmp_lt_u32 vcc, 20, v99
    s_mov_b32 s43, 1
    s_cbranch_vccz L2_xp99
    v_cmp_lt_u32 vcc, 32, v99
    v_cmp_lt_u32 s[58:59], 31, v88
    s_mov_b32 s43, 2
    s_or_b64 vcc, vcc, s[58:59]
    s_cbranch_scc0 L2_xp99
    s_mov_b32 s37, 0x10000
    s_branch L2_xp99
L2_c100:
    s_mov_b64 s[50:51], vcc
    s_lshl_b64 s[52:53], s[82:83], 1
    s_andn2_b64 s[52:53], s[52:53], s[80:81]
    s_andn2_b64 s[52:53], s[52:53], s[50:51]
    s_or_b64 s[80:81], s[80:81], s[52:53]
    s_not_b64 vcc, s[52:53]
    s_mov_b64 exec, -1
    v_cndmask_b32_dpp v84, v84, v84, vcc wave_shr:1 row_mask:0xf bank_mask:0xf
    v_cndmask_b32_dpp v85, v85, v85, vcc wave_shr:1 row_mask:0xf bank_mask:0xf
    s_lshr_b64 s[52:53], s[52:53], 1
    v_cndmask_b32_dpp v86, v86, v86, vcc wave_shr:1 row_mask:0xf bank_mask:0xf
    v_cndmask_b32_dpp v87, v87, v87, vcc wave_shr:1 row_mask:0xf bank_mask:0xf
    s_andn2_b64 s[82:83], s[82:83], s[52:53]
    v_cndmask_b32_dpp v7, v7, v7, vcc wave_shr:1 row_mask:0xf bank_mask:0xf
    s_mov_b64 vcc, s[50:51]
    s_mov_b64 exec, s[50:51]
    s_cbranch_scc0 L2_d100
    s_mov_b64 exec, s[82:83]
    s_nop 1
    v_mfma_f32_4x4x4_16b_bf16 v[88:91], v[12:13], v[84:85], 0
    s_nop 1
    v_mfma_f32_4x4x4_16b_bf16 v[88:91], v[10:11], v[86:87], v[88:91]
    s_nop 4
    v_cvt_pk_bf16_f32 v88, v88, v89
    v_cvt_pk_bf16_f32 v89, v90, v91
    ds_pk_add_bf16 v7, v88 offset:65408
    ds_pk_add_bf16 v7, v89 offset:65412
    s_mov_b64 exec, vcc
    s_branch L2_d100
L2_c101:
    s_mov_b64 s[50:51], vcc
    s_lshl_b64 s[52:53], s[82:83], 1
    s_andn2_b64 s[52:53], s[52:53], s[80:81]
    s_andn2_b64 s[52:53], s[52:53], s[50:51]
    s_or_b64 s[80:81], s[80:81], s[52:53]
    s_not_b64 vcc, s[52:53]
    s_mov_b64 exec, -1
    v_cndmask_b32_dpp v84, v84, v84, vcc wave_shr:1 row_mask:0xf bank_mask:0xf
    v_cndmask_b32_dpp v85, v85, v85, vcc wave_shr:1 row_mask:0xf bank_mask:0xf
    s_lshr_b64 s[52:53], s[52:53], 1
    v_cndmask_b32_dpp v86, v86, v86, vcc wave_shr:1 row_mask:0xf bank_mask:0xf
    v_cndmask_b32_dpp v87, v87, v87, vcc wave_shr:1 row_mask:0xf bank_mask:0xf
    s_andn2_b64 s[82:83], s[82:83], s[52:53]
    v_cndmask_b32_dpp v7, v7, v7, vcc wave_shr:1 row_mask:0xf bank_mask:0xf
    s_mov_b64 vcc, s[50:51]
    s_mov_b64 exec, s[50:51]
    s_cbranch_scc0 L2_d101
    s_mov_b64 exec, s[82:83]
    s_nop 1
    v_mfma_f32_4x4x4_16b_bf16 v[88:91], v[12:13], v[84:85], 0
    s_nop 1
    v_mfma_f32_4x4x4_16b_bf16 v[88:91], v[10:11], v[86:87], v[88:91]
    s_nop 4
    v_cvt_pk_bf16_f32 v88, v88, v89
    v_cvt_pk_bf16_f32 v89, v90, v91
    ds_pk_add_bf16 v7, v88 offset:65408
    ds_pk_add_bf16 v7, v89 offset:65412
    s_mov_b64 exec, vcc
    s_branch L2_d101
L2_c102:
    s_mov_b64 s[50:51], vcc
    s_lshl_b64 s[52:53], s[82:83], 1
    s_andn2_b64 s[52:53], s[52:53], s[80:81]
    s_andn2_b64 s[52:53], s[52:53], s[50:51]
    s_or_b64 s[80:81], s[80:81], s[52:53]
    s_not_b64 vcc, s[52:53]
    s_mov_b64 exec, -1
    v_cndmask_b32_dpp v84, v84, v84, vcc wave_shr:1 row_mask:0xf bank_mask:0xf
    v_cndmask_b32_dpp v85, v85, v85, vcc wave_shr:1 row_mask:0xf bank_mask:0xf
    s_lshr_b64 s[52:53], s[52:53], 1
    v_cndmask_b32_dpp v86, v86, v86, vcc wave_shr:1 row_mask:0xf bank_mask:0xf
    v_cndmask_b32_dpp v87, v87, v87, vcc wave_shr:1 row_mask:0xf bank_mask:0xf
    s_andn2_b64 s[82:83], s[82:83], s[52:53]
    v_cndmask_b32_dpp v7, v7, v7, vcc wave_shr:1 row_mask:0xf bank_mask:0xf
    s_mov_b64 vcc, s[50:51]
    s_mov_b64 exec, s[50:51]
    s_cbranch_scc0 L2_d102
    s_mov_b64 exec, s[82:83]
    s_nop 1
    v_mfma_f32_4x4x4_16b_bf16 v[88:91], v[12:13], v[84:85], 0
    s_nop 1
    v_mfma_f32_4x4x4_16b_bf16 v[88:91], v[10:11], v[86:87], v[88:91]
    s_nop 4
    v_cvt_pk_bf16_f32 v88, v88, v89
    v_cvt_pk_bf16_f32 v89, v90, v91
    ds_pk_add_bf16 v7, v88 offset:65408
    ds_pk_add_bf16 v7, v89 offset:65412
    s_mov_b64 exec, vcc
    s_branch L2_d102
L2_c103:
    s_mov_b64 s[50:51], vcc
    s_lshl_b64 s[52:53], s[82:83], 1
    s_andn2_b64 s[52:53], s[52:53], s[80:81]
    s_andn2_b64 s[52:53], s[52:53], s[50:51]
    s_or_b64 s[80:81], s[80:81], s[52:53]
    s_not_b64 vcc, s[52:53]
    s_mov_b64 exec, -1
    v_cndmask_b32_dpp v84, v84, v84, vcc wave_shr:1 row_mask:0xf bank_mask:0xf
    v_cndmask_b32_dpp v85, v85, v85, vcc wave_shr:1 row_mask:0xf bank_mask:0xf
    s_lshr_b64 s[52:53], s[52:53], 1
    v_cndmask_b32_dpp v86, v86, v86, vcc wave_shr:1 row_mask:0xf bank_mask:0xf
    v_cndmask_b32_dpp v87, v87, v87, vcc wave_shr:1 row_mask:0xf bank_mask:0xf
    s_andn2_b64 s[82:83], s[82:83], s[52:53]
    v_cndmask_b32_dpp v7, v7, v7, vcc wave_shr:1 row_mask:0xf bank_mask:0xf
    s_mov_b64 vcc, s[50:51]
    s_mov_b64 exec, s[50:51]
    s_cbranch_scc0 L2_d103
    s_mov_b64 exec, s[82:83]
    s_nop 1
    v_mfma_f32_4x4x4_16b_bf16 v[88:91], v[12:13], v[84:85], 0
    s_nop 1
    v_mfma_f32_4x4x4_16b_bf16 v[88:91], v[10:11], v[86:87], v[88:91]
    s_nop 4
    v_cvt_pk_bf16_f32 v88, v88, v89
    v_cvt_pk_bf16_f32 v89, v90, v91
    ds_pk_add_bf16 v7, v88 offset:65408
    ds_pk_add_bf16 v7, v89 offset:65412
    s_mov_b64 exec, vcc
    s_branch L2_d103
L2_c104:
    s_mov_b64 s[50:51], vcc
    s_lshl_b64 s[52:53], s[82:83], 1
    s_andn2_b64 s[52:53], s[52:53], s[80:81]
    s_andn2_b64 s[52:53], s[52:53], s[50:51]
    s_or_b64 s[80:81], s[80:81], s[52:53]
    s_not_b64 vcc, s[52:53]
    s_mov_b64 exec, -1
    v_cndmask_b32_dpp v84, v84, v84, vcc wave_shr:1 row_mask:0xf bank_mask:0xf
    v_cndmask_b32_dpp v85, v85, v85, vcc wave_shr:1 row_mask:0xf bank_mask:0xf
    s_lshr_b64 s[52:53], s[52:53], 1
    v_cndmask_b32_dpp v86, v86, v86, vcc wave_shr:1 row_mask:0xf bank_mask:0xf
    v_cndmask_b32_dpp v87, v87, v87, vcc wave_shr:1 row_mask:0xf bank_mask:0xf
    s_andn2_b64 s[82:83], s[82:83], s[52:53]
    v_cndmask_b32_dpp v7, v7, v7, vcc wave_shr:1 row_mask:0xf bank_mask:0xf
    s_mov_b64 vcc, s[50:51]
    s_mov_b64 exec, s[50:51]
    s_cbranch_scc0 L2_d104
    s_mov_b64 exec, s[82:83]
    s_nop 1
    v_mfma_f32_4x4x4_16b_bf16 v[88:91], v[12:13], v[84:85], 0
    s_nop 1
    v_mfma_f32_4x4x4_16b_bf16 v[88:91], v[10:11], v[86:87], v[88:91]
    s_nop 4
    v_cvt_pk_bf16_f32 v88, v88, v89
    v_cvt_pk_bf16_f32 v89, v90, v91
    ds_pk_add_bf16 v7, v88 offset:65408
    ds_pk_add_bf16 v7, v89 offset:65412
    s_mov_b64 exec, vcc
    s_branch L2_d104
L2_c105:
    s_mov_b64 s[50:51], vcc
    s_lshl_b64 s[52:53], s[82:83], 1
    s_andn2_b64 s[52:53], s[52:53], s[80:81]
    s_andn2_b64 s[52:53], s[52:53], s[50:51]
    s_or_b64 s[80:81], s[80:81], s[52:53]
    s_not_b64 vcc, s[52:53]
    s_mov_b64 exec, -1
    v_cndmask_b32_dpp v84, v84, v84, vcc wave_shr:1 row_mask:0xf bank_mask:0xf
    v_cndmask_b32_dpp v85, v85, v85, vcc wave_shr:1 row_mask:0xf bank_mask:0xf
    s_lshr_b64 s[52:53], s[52:53], 1
    v_cndmask_b32_dpp v86, v86, v86, vcc wave_shr:1 row_mask:0xf bank_mask:0xf
    v_cndmask_b32_dpp v87, v87, v87, vcc wave_shr:1 row_mask:0xf bank_mask:0xf
    s_andn2_b64 s[82:83], s[82:83], s[52:53]
    v_cndmask_b32_dpp v7, v7, v7, vcc wave_shr:1 row_mask:0xf bank_mask:0xf
    s_mov_b64 vcc, s[50:51]
    s_mov_b64 exec, s[50:51]
    s_cbranch_scc0 L2_d105
    s_mov_b64 exec, s[82:83]
    s_nop 1
    v_mfma_f32_4x4x4_16b_bf16 v[88:91], v[12:13], v[84:85], 0
    s_nop 1
    v_mfma_f32_4x4x4_16b_bf16 v[88:91], v[10:11], v[86:87], v[88:91]
    s_nop 4
    v_cvt_pk_bf16_f32 v88, v88, v89
    v_cvt_pk_bf16_f32 v89, v90, v91
    ds_pk_add_bf16 v7, v88 offset:65408
    ds_pk_add_bf16 v7, v89 offset:65412
    s_mov_b64 exec, vcc
    s_branch L2_d105
L2_c106:
    s_mov_b64 s[50:51], vcc
    s_lshl_b64 s[52:53], s[82:83], 1
    s_andn2_b64 s[52:53], s[52:53], s[80:81]
    s_andn2_b64 s[52:53], s[52:53], s[50:51]
    s_or_b64 s[80:81], s[80:81], s[52:53]
    s_not_b64 vcc, s[52:53]
    s_mov_b64 exec, -1
    v_cndmask_b32_dpp v84, v84, v84, vcc wave_shr:1 row_mask:0xf bank_mask:0xf
    v_cndmask_b32_dpp v85, v85, v85, vcc wave_shr:1 row_mask:0xf bank_mask:0xf
    s_lshr_b64 s[52:53], s[52:53], 1
    v_cndmask_b32_dpp v86, v86, v86, vcc wave_shr:1 row_mask:0xf bank_mask:0xf
    v_cndmask_b32_dpp v87, v87, v87, vcc wave_shr:1 row_mask:0xf bank_mask:0xf
    s_andn2_b64 s[82:83], s[82:83], s[52:53]
    v_cndmask_b32_dpp v7, v7, v7, vcc wave_shr:1 row_mask:0xf bank_mask:0xf
    s_mov_b64 vcc, s[50:51]
    s_mov_b64 exec, s[50:51]
    s_cbranch_scc0 L2_d106
    s_mov_b64 exec, s[82:83]
    s_nop 1
    v_mfma_f32_4x4x4_16b_bf16 v[88:91], v[12:13], v[84:85], 0
    s_nop 1
    v_mfma_f32_4x4x4_16b_bf16 v[88:91], v[10:11], v[86:87], v[88:91]
    s_nop 4
    v_cvt_pk_bf16_f32 v88, v88, v89
    v_cvt_pk_bf16_f32 v89, v90, v91
    ds_pk_add_bf16 v7, v88 offset:65408
    ds_pk_add_bf16 v7, v89 offset:65412
    s_mov_b64 exec, vcc
    s_branch L2_d106
L2_c107:
    s_mov_b64 s[50:51], vcc
    s_lshl_b64 s[52:53], s[82:83], 1
    s_andn2_b64 s[52:53], s[52:53], s[80:81]
    s_andn2_b64 s[52:53], s[52:53], s[50:51]
    s_or_b64 s[80:81], s[80:81], s[52:53]
    s_not_b64 vcc, s[52:53]
    s_mov_b64 exec, -1
    v_cndmask_b32_dpp v84, v84, v84, vcc wave_shr:1 row_mask:0xf bank_mask:0xf
    v_cndmask_b32_dpp v85, v85, v85, vcc wave_shr:1 row_mask:0xf bank_mask:0xf
    s_lshr_b64 s[52:53], s[52:53], 1
    v_cndmask_b32_dpp v86, v86, v86, vcc wave_shr:1 row_mask:0xf bank_mask:0xf
    v_cndmask_b32_dpp v87, v87, v87, vcc wave_shr:1 row_mask:0xf bank_mask:0xf
    s_andn2_b64 s[82:83], s[82:83], s[52:53]
    v_cndmask_b32_dpp v7, v7, v7, vcc wave_shr:1 row_mask:0xf bank_mask:0xf
    s_mov_b64 vcc, s[50:51]
    s_mov_b64 exec, s[50:51]
    s_cbranch_scc0 L2_d107
    s_mov_b64 exec, s[82:83]
    s_nop 1
    v_mfma_f32_4x4x4_16b_bf16 v[88:91], v[12:13], v[84:85], 0
    s_nop 1
    v_mfma_f32_4x4x4_16b_bf16 v[88:91], v[10:11], v[86:87], v[88:91]
    s_nop 4
    v_cvt_pk_bf16_f32 v88, v88, v89
    v_cvt_pk_bf16_f32 v89, v90, v91
    ds_pk_add_bf16 v7, v88 offset:65408
    ds_pk_add_bf16 v7, v89 offset:65412
    s_mov_b64 exec, vcc
    s_branch L2_d107
L2_xa108:
    s_cmp_eq_u32 s43, 1
    s_cbranch_scc1 L2_xc108
    v_lshlrev_b32 v89, 0, v96
    v_add_u32 v90, 140, v97
    v_bitop3_b32 v90, v89, v45, v90 bitop3:0x6a
    ds_write_b32 v98, v90 offset:28
    v_lshlrev_b32 v89, 4, v96
    v_add_u32 v90, 120, v97
    v_bitop3_b32 v90, v89, v45, v90 bitop3:0x6a
    ds_write_b32 v98, v90 offset:24
    v_lshlrev_b32 v89, 8, v96
    v_add_u32 v90, 100, v97
    v_bitop3_b32 v90, v89, v45, v90 bitop3:0x6a
    ds_write_b32 v98, v90 offset:20
L2_xc108:
    v_lshlrev_b32 v89, 12, v96
    v_add_u32 v90, 80, v97
    v_bitop3_b32 v90, v89, v45, v90 bitop3:0x6a
    ds_write_b32 v98, v90 offset:16
    s_branch L2_xb108
L2_xe108:
    v_cmp_lt_u32 vcc, 32, v99
    v_cmp_lt_u32 s[58:59], 31, v88
    v_lshrrev_b32 v89, 16, v96
    v_add_u32 v97, 80, v97
    s_or_b64 vcc, vcc, s[58:59]
    s_cbranch_scc1 L2_xs108
    v_lshlrev_b32 v89, v1, v89
    v_and_b32 v89, v45, v89
    v_cmp_ne_u32 vcc, 0, v89
    v_xor_b32 v90, v97, v89
    s_add_u32 s3, s37, s38
    v_mbcnt_lo_u32_b32 v98, vcc_lo, 0
    v_mbcnt_hi_u32_b32 v98, vcc_hi, v98
    s_bcnt1_i32_b64 s41, vcc
    v_lshl_add_u32 v98, v98, 2, s3
    s_mov_b64 exec, vcc
    ds_write_b32 v98, v90
    s_mov_b64 exec, -1
    s_lshl2_add_u32 s37, s41, s37
    s_branch L2_xr108
L2_xf108:
    s_waitcnt lgkmcnt(0)
    s_cmp_gt_u32 s37, 1024
    s_cbranch_scc1 L2_xs108
    v_mov_b32 v43, -1
    s_cmp_ge_u32 s37, 512
    s_cbranch_scc1 L2_xg108
    v_mov_b32 v42, -1
    s_cmp_ge_u32 s37, 256
    s_cbranch_scc1 L2_xg108
    v_mov_b32 v41, -1
    s_branch L2_xg108
L2_xs108:
    s_waitcnt lgkmcnt(0)
    v_mov_b32 v40, -1
    v_mov_b32 v41, -1
    v_mov_b32 v42, -1
    v_mov_b32 v43, -1
    s_add_u32 s3, s42, 2
    s_bitset1_b32 s36, s3
    s_branch L2_xg108
L2_c109:
    s_mov_b64 s[50:51], vcc
    s_lshl_b64 s[52:53], s[82:83], 1
    s_andn2_b64 s[52:53], s[52:53], s[80:81]
    s_andn2_b64 s[52:53], s[52:53], s[50:51]
    s_or_b64 s[80:81], s[80:81], s[52:53]
    s_not_b64 vcc, s[52:53]
    s_mov_b64 exec, -1
    v_cndmask_b32_dpp v84, v84, v84, vcc wave_shr:1 row_mask:0xf bank_mask:0xf
    v_cndmask_b32_dpp v85, v85, v85, vcc wave_shr:1 row_mask:0xf bank_mask:0xf
    s_lshr_b64 s[52:53], s[52:53], 1
    v_cndmask_b32_dpp v86, v86, v86, vcc wave_shr:1 row_mask:0xf bank_mask:0xf
    v_cndmask_b32_dpp v87, v87, v87, vcc wave_shr:1 row_mask:0xf bank_mask:0xf
    s_andn2_b64 s[82:83], s[82:83], s[52:53]
    v_cndmask_b32_dpp v7, v7, v7, vcc wave_shr:1 row_mask:0xf bank_mask:0xf
    s_mov_b64 vcc, s[50:51]
    s_mov_b64 exec, s[50:51]
    s_cbranch_scc0 L2_d109
    s_mov_b64 exec, s[82:83]
    s_nop 1
    v_mfma_f32_4x4x4_16b_bf16 v[88:91], v[12:13], v[84:85], 0
    s_nop 1
    v_mfma_f32_4x4x4_16b_bf16 v[88:91], v[10:11], v[86:87], v[88:91]
    s_nop 4
    v_cvt_pk_bf16_f32 v88, v88, v89
    v_cvt_pk_bf16_f32 v89, v90, v91
    ds_pk_add_bf16 v7, v88 offset:65408
    ds_pk_add_bf16 v7, v89 offset:65412
    s_mov_b64 exec, vcc
    s_branch L2_d109
L2_c110:
    s_mov_b64 s[50:51], vcc
    s_lshl_b64 s[52:53], s[82:83], 1
    s_andn2_b64 s[52:53], s[52:53], s[80:81]
    s_andn2_b64 s[52:53], s[52:53], s[50:51]
    s_or_b64 s[80:81], s[80:81], s[52:53]
    s_not_b64 vcc, s[52:53]
    s_mov_b64 exec, -1
    v_cndmask_b32_dpp v84, v84, v84, vcc wave_shr:1 row_mask:0xf bank_mask:0xf
    v_cndmask_b32_dpp v85, v85, v85, vcc wave_shr:1 row_mask:0xf bank_mask:0xf
    s_lshr_b64 s[52:53], s[52:53], 1
    v_cndmask_b32_dpp v86, v86, v86, vcc wave_shr:1 row_mask:0xf bank_mask:0xf
    v_cndmask_b32_dpp v87, v87, v87, vcc wave_shr:1 row_mask:0xf bank_mask:0xf
    s_andn2_b64 s[82:83], s[82:83], s[52:53]
    v_cndmask_b32_dpp v7, v7, v7, vcc wave_shr:1 row_mask:0xf bank_mask:0xf
    s_mov_b64 vcc, s[50:51]
    s_mov_b64 exec, s[50:51]
    s_cbranch_scc0 L2_d110
    s_mov_b64 exec, s[82:83]
    s_nop 1
    v_mfma_f32_4x4x4_16b_bf16 v[88:91], v[12:13], v[84:85], 0
    s_nop 1
    v_mfma_f32_4x4x4_16b_bf16 v[88:91], v[10:11], v[86:87], v[88:91]
    s_nop 4
    v_cvt_pk_bf16_f32 v88, v88, v89
    v_cvt_pk_bf16_f32 v89, v90, v91
    ds_pk_add_bf16 v7, v88 offset:65408
    ds_pk_add_bf16 v7, v89 offset:65412
    s_mov_b64 exec, vcc
    s_branch L2_d110
L2_c111:
    s_mov_b64 s[50:51], vcc
    s_lshl_b64 s[52:53], s[82:83], 1
    s_andn2_b64 s[52:53], s[52:53], s[80:81]
    s_andn2_b64 s[52:53], s[52:53], s[50:51]
    s_or_b64 s[80:81], s[80:81], s[52:53]
    s_not_b64 vcc, s[52:53]
    s_mov_b64 exec, -1
    v_cndmask_b32_dpp v84, v84, v84, vcc wave_shr:1 row_mask:0xf bank_mask:0xf
    v_cndmask_b32_dpp v85, v85, v85, vcc wave_shr:1 row_mask:0xf bank_mask:0xf
    s_lshr_b64 s[52:53], s[52:53], 1
    v_cndmask_b32_dpp v86, v86, v86, vcc wave_shr:1 row_mask:0xf bank_mask:0xf
    v_cndmask_b32_dpp v87, v87, v87, vcc wave_shr:1 row_mask:0xf bank_mask:0xf
    s_andn2_b64 s[82:83], s[82:83], s[52:53]
    v_cndmask_b32_dpp v7, v7, v7, vcc wave_shr:1 row_mask:0xf bank_mask:0xf
    s_mov_b64 vcc, s[50:51]
    s_mov_b64 exec, s[50:51]
    s_cbranch_scc0 L2_d111
    s_mov_b64 exec, s[82:83]
    s_nop 1
    v_mfma_f32_4x4x4_16b_bf16 v[88:91], v[12:13], v[84:85], 0
    s_nop 1
    v_mfma_f32_4x4x4_16b_bf16 v[88:91], v[10:11], v[86:87], v[88:91]
    s_nop 4
    v_cvt_pk_bf16_f32 v88, v88, v89
    v_cvt_pk_bf16_f32 v89, v90, v91
    ds_pk_add_bf16 v7, v88 offset:65408
    ds_pk_add_bf16 v7, v89 offset:65412
    s_mov_b64 exec, vcc
    s_branch L2_d111
L2_c112:
    s_mov_b64 s[50:51], vcc
    s_lshl_b64 s[52:53], s[82:83], 1
    s_andn2_b64 s[52:53], s[52:53], s[80:81]
    s_andn2_b64 s[52:53], s[52:53], s[50:51]
    s_or_b64 s[80:81], s[80:81], s[52:53]
    s_not_b64 vcc, s[52:53]
    s_mov_b64 exec, -1
    v_cndmask_b32_dpp v84, v84, v84, vcc wave_shr:1 row_mask:0xf bank_mask:0xf
    v_cndmask_b32_dpp v85, v85, v85, vcc wave_shr:1 row_mask:0xf bank_mask:0xf
    s_lshr_b64 s[52:53], s[52:53], 1
    v_cndmask_b32_dpp v86, v86, v86, vcc wave_shr:1 row_mask:0xf bank_mask:0xf
    v_cndmask_b32_dpp v87, v87, v87, vcc wave_shr:1 row_mask:0xf bank_mask:0xf
    s_andn2_b64 s[82:83], s[82:83], s[52:53]
    v_cndmask_b32_dpp v7, v7, v7, vcc wave_shr:1 row_mask:0xf bank_mask:0xf
    s_mov_b64 vcc, s[50:51]
    s_mov_b64 exec, s[50:51]
    s_cbranch_scc0 L2_d112
    s_mov_b64 exec, s[82:83]
    s_nop 1
    v_mfma_f32_4x4x4_16b_bf16 v[88:91], v[12:13], v[84:85], 0
    s_nop 1
    v_mfma_f32_4x4x4_16b_bf16 v[88:91], v[10:11], v[86:87], v[88:91]
    s_nop 4
    v_cvt_pk_bf16_f32 v88, v88, v89
    v_cvt_pk_bf16_f32 v89, v90, v91
    ds_pk_add_bf16 v7, v88 offset:65408
    ds_pk_add_bf16 v7, v89 offset:65412
    s_mov_b64 exec, vcc
    s_branch L2_d112
L2_c113:
    s_mov_b64 s[50:51], vcc
    s_lshl_b64 s[52:53], s[82:83], 1
    s_andn2_b64 s[52:53], s[52:53], s[80:81]
    s_andn2_b64 s[52:53], s[52:53], s[50:51]
    s_or_b64 s[80:81], s[80:81], s[52:53]
    s_not_b64 vcc, s[52:53]
    s_mov_b64 exec, -1
    v_cndmask_b32_dpp v84, v84, v84, vcc wave_shr:1 row_mask:0xf bank_mask:0xf
    v_cndmask_b32_dpp v85, v85, v85, vcc wave_shr:1 row_mask:0xf bank_mask:0xf
    s_lshr_b64 s[52:53], s[52:53], 1
    v_cndmask_b32_dpp v86, v86, v86, vcc wave_shr:1 row_mask:0xf bank_mask:0xf
    v_cndmask_b32_dpp v87, v87, v87, vcc wave_shr:1 row_mask:0xf bank_mask:0xf
    s_andn2_b64 s[82:83], s[82:83], s[52:53]
    v_cndmask_b32_dpp v7, v7, v7, vcc wave_shr:1 row_mask:0xf bank_mask:0xf
    s_mov_b64 vcc, s[50:51]
    s_mov_b64 exec, s[50:51]
    s_cbranch_scc0 L2_d113
    s_mov_b64 exec, s[82:83]
    s_nop 1
    v_mfma_f32_4x4x4_16b_bf16 v[88:91], v[12:13], v[84:85], 0
    s_nop 1
    v_mfma_f32_4x4x4_16b_bf16 v[88:91], v[10:11], v[86:87], v[88:91]
    s_nop 4
    v_cvt_pk_bf16_f32 v88, v88, v89
    v_cvt_pk_bf16_f32 v89, v90, v91
    ds_pk_add_bf16 v7, v88 offset:65408
    ds_pk_add_bf16 v7, v89 offset:65412
    s_mov_b64 exec, vcc
    s_branch L2_d113
L2_c114:
    s_mov_b64 s[50:51], vcc
    s_lshl_b64 s[52:53], s[82:83], 1
    s_andn2_b64 s[52:53], s[52:53], s[80:81]
    s_andn2_b64 s[52:53], s[52:53], s[50:51]
    s_or_b64 s[80:81], s[80:81], s[52:53]
    s_not_b64 vcc, s[52:53]
    s_mov_b64 exec, -1
    v_cndmask_b32_dpp v84, v84, v84, vcc wave_shr:1 row_mask:0xf bank_mask:0xf
    v_cndmask_b32_dpp v85, v85, v85, vcc wave_shr:1 row_mask:0xf bank_mask:0xf
    s_lshr_b64 s[52:53], s[52:53], 1
    v_cndmask_b32_dpp v86, v86, v86, vcc wave_shr:1 row_mask:0xf bank_mask:0xf
    v_cndmask_b32_dpp v87, v87, v87, vcc wave_shr:1 row_mask:0xf bank_mask:0xf
    s_andn2_b64 s[82:83], s[82:83], s[52:53]
    v_cndmask_b32_dpp v7, v7, v7, vcc wave_shr:1 row_mask:0xf bank_mask:0xf
    s_mov_b64 vcc, s[50:51]
    s_mov_b64 exec, s[50:51]
    s_cbranch_scc0 L2_d114
    s_mov_b64 exec, s[82:83]
    s_nop 1
    v_mfma_f32_4x4x4_16b_bf16 v[88:91], v[12:13], v[84:85], 0
    s_nop 1
    v_mfma_f32_4x4x4_16b_bf16 v[88:91], v[10:11], v[86:87], v[88:91]
    s_nop 4
    v_cvt_pk_bf16_f32 v88, v88, v89
    v_cvt_pk_bf16_f32 v89, v90, v91
    ds_pk_add_bf16 v7, v88 offset:65408
    ds_pk_add_bf16 v7, v89 offset:65412
    s_mov_b64 exec, vcc
    s_branch L2_d114
L2_c115:
    s_mov_b64 s[50:51], vcc
    s_lshl_b64 s[52:53], s[82:83], 1
    s_andn2_b64 s[52:53], s[52:53], s[80:81]
    s_andn2_b64 s[52:53], s[52:53], s[50:51]
    s_or_b64 s[80:81], s[80:81], s[52:53]
    s_not_b64 vcc, s[52:53]
    s_mov_b64 exec, -1
    v_cndmask_b32_dpp v84, v84, v84, vcc wave_shr:1 row_mask:0xf bank_mask:0xf
    v_cndmask_b32_dpp v85, v85, v85, vcc wave_shr:1 row_mask:0xf bank_mask:0xf
    s_lshr_b64 s[52:53], s[52:53], 1
    v_cndmask_b32_dpp v86, v86, v86, vcc wave_shr:1 row_mask:0xf bank_mask:0xf
    v_cndmask_b32_dpp v87, v87, v87, vcc wave_shr:1 row_mask:0xf bank_mask:0xf
    s_andn2_b64 s[82:83], s[82:83], s[52:53]
    v_cndmask_b32_dpp v7, v7, v7, vcc wave_shr:1 row_mask:0xf bank_mask:0xf
    s_mov_b64 vcc, s[50:51]
    s_mov_b64 exec, s[50:51]
    s_cbranch_scc0 L2_d115
    s_mov_b64 exec, s[82:83]
    s_nop 1
    v_mfma_f32_4x4x4_16b_bf16 v[88:91], v[12:13], v[84:85], 0
    s_nop 1
    v_mfma_f32_4x4x4_16b_bf16 v[88:91], v[10:11], v[86:87], v[88:91]
    s_nop 4
    v_cvt_pk_bf16_f32 v88, v88, v89
    v_cvt_pk_bf16_f32 v89, v90, v91
    ds_pk_add_bf16 v7, v88 offset:65408
    ds_pk_add_bf16 v7, v89 offset:65412
    s_mov_b64 exec, vcc
    s_branch L2_d115
L2_c116:
    s_mov_b64 s[50:51], vcc
    s_lshl_b64 s[52:53], s[82:83], 1
    s_andn2_b64 s[52:53], s[52:53], s[80:81]
    s_andn2_b64 s[52:53], s[52:53], s[50:51]
    s_or_b64 s[80:81], s[80:81], s[52:53]
    s_not_b64 vcc, s[52:53]
    s_mov_b64 exec, -1
    v_cndmask_b32_dpp v84, v84, v84, vcc wave_shr:1 row_mask:0xf bank_mask:0xf
    v_cndmask_b32_dpp v85, v85, v85, vcc wave_shr:1 row_mask:0xf bank_mask:0xf
    s_lshr_b64 s[52:53], s[52:53], 1
    v_cndmask_b32_dpp v86, v86, v86, vcc wave_shr:1 row_mask:0xf bank_mask:0xf
    v_cndmask_b32_dpp v87, v87, v87, vcc wave_shr:1 row_mask:0xf bank_mask:0xf
    s_andn2_b64 s[82:83], s[82:83], s[52:53]
    v_cndmask_b32_dpp v7, v7, v7, vcc wave_shr:1 row_mask:0xf bank_mask:0xf
    s_mov_b64 vcc, s[50:51]
    s_mov_b64 exec, s[50:51]
    s_cbranch_scc0 L2_d116
    s_mov_b64 exec, s[82:83]
    s_nop 1
    v_mfma_f32_4x4x4_16b_bf16 v[88:91], v[12:13], v[84:85], 0
    s_nop 1
    v_mfma_f32_4x4x4_16b_bf16 v[88:91], v[10:11], v[86:87], v[88:91]
    s_nop 4
    v_cvt_pk_bf16_f32 v88, v88, v89
    v_cvt_pk_bf16_f32 v89, v90, v91
    ds_pk_add_bf16 v7, v88 offset:65408
    ds_pk_add_bf16 v7, v89 offset:65412
    s_mov_b64 exec, vcc
    s_branch L2_d116
L2_c117:
    s_mov_b64 s[50:51], vcc
    s_lshl_b64 s[52:53], s[82:83], 1
    s_andn2_b64 s[52:53], s[52:53], s[80:81]
    s_andn2_b64 s[52:53], s[52:53], s[50:51]
    s_or_b64 s[80:81], s[80:81], s[52:53]
    s_not_b64 vcc, s[52:53]
    s_mov_b64 exec, -1
    v_cndmask_b32_dpp v84, v84, v84, vcc wave_shr:1 row_mask:0xf bank_mask:0xf
    v_cndmask_b32_dpp v85, v85, v85, vcc wave_shr:1 row_mask:0xf bank_mask:0xf
    s_lshr_b64 s[52:53], s[52:53], 1
    v_cndmask_b32_dpp v86, v86, v86, vcc wave_shr:1 row_mask:0xf bank_mask:0xf
    v_cndmask_b32_dpp v87, v87, v87, vcc wave_shr:1 row_mask:0xf bank_mask:0xf
    s_andn2_b64 s[82:83], s[82:83], s[52:53]
    v_cndmask_b32_dpp v7, v7, v7, vcc wave_shr:1 row_mask:0xf bank_mask:0xf
    s_mov_b64 vcc, s[50:51]
    s_mov_b64 exec, s[50:51]
    s_cbranch_scc0 L2_d117
    s_mov_b64 exec, s[82:83]
    s_nop 1
    v_mfma_f32_4x4x4_16b_bf16 v[88:91], v[12:13], v[84:85], 0
    s_nop 1
    v_mfma_f32_4x4x4_16b_bf16 v[88:91], v[10:11], v[86:87], v[88:91]
    s_nop 4
    v_cvt_pk_bf16_f32 v88, v88, v89
    v_cvt_pk_bf16_f32 v89, v90, v91
    ds_pk_add_bf16 v7, v88 offset:65408
    ds_pk_add_bf16 v7, v89 offset:65412
    s_mov_b64 exec, vcc
    s_branch L2_d117
L2_c118:
    s_mov_b64 s[50:51], vcc
    s_lshl_b64 s[52:53], s[82:83], 1
    s_andn2_b64 s[52:53], s[52:53], s[80:81]
    s_andn2_b64 s[52:53], s[52:53], s[50:51]
    s_or_b64 s[80:81], s[80:81], s[52:53]
    s_not_b64 vcc, s[52:53]
    s_mov_b64 exec, -1
    v_cndmask_b32_dpp v84, v84, v84, vcc wave_shr:1 row_mask:0xf bank_mask:0xf
    v_cndmask_b32_dpp v85, v85, v85, vcc wave_shr:1 row_mask:0xf bank_mask:0xf
    s_lshr_b64 s[52:53], s[52:53], 1
    v_cndmask_b32_dpp v86, v86, v86, vcc wave_shr:1 row_mask:0xf bank_mask:0xf
    v_cndmask_b32_dpp v87, v87, v87, vcc wave_shr:1 row_mask:0xf bank_mask:0xf
    s_andn2_b64 s[82:83], s[82:83], s[52:53]
    v_cndmask_b32_dpp v7, v7, v7, vcc wave_shr:1 row_mask:0xf bank_mask:0xf
    s_mov_b64 vcc, s[50:51]
    s_mov_b64 exec, s[50:51]
    s_cbranch_scc0 L2_d118
    s_mov_b64 exec, s[82:83]
    s_nop 1
    v_mfma_f32_4x4x4_16b_bf16 v[88:91], v[12:13], v[84:85], 0
    s_nop 1
    v_mfma_f32_4x4x4_16b_bf16 v[88:91], v[10:11], v[86:87], v[88:91]
    s_nop 4
    v_cvt_pk_bf16_f32 v88, v88, v89
    v_cvt_pk_bf16_f32 v89, v90, v91
    ds_pk_add_bf16 v7, v88 offset:65408
    ds_pk_add_bf16 v7, v89 offset:65412
    s_mov_b64 exec, vcc
    s_branch L2_d118
L2_c119:
    s_mov_b64 s[50:51], vcc
    s_lshl_b64 s[52:53], s[82:83], 1
    s_andn2_b64 s[52:53], s[52:53], s[80:81]
    s_andn2_b64 s[52:53], s[52:53], s[50:51]
    s_or_b64 s[80:81], s[80:81], s[52:53]
    s_not_b64 vcc, s[52:53]
    s_mov_b64 exec, -1
    v_cndmask_b32_dpp v84, v84, v84, vcc wave_shr:1 row_mask:0xf bank_mask:0xf
    v_cndmask_b32_dpp v85, v85, v85, vcc wave_shr:1 row_mask:0xf bank_mask:0xf
    s_lshr_b64 s[52:53], s[52:53], 1
    v_cndmask_b32_dpp v86, v86, v86, vcc wave_shr:1 row_mask:0xf bank_mask:0xf
    v_cndmask_b32_dpp v87, v87, v87, vcc wave_shr:1 row_mask:0xf bank_mask:0xf
    s_andn2_b64 s[82:83], s[82:83], s[52:53]
    v_cndmask_b32_dpp v7, v7, v7, vcc wave_shr:1 row_mask:0xf bank_mask:0xf
    s_mov_b64 vcc, s[50:51]
    s_mov_b64 exec, s[50:51]
    s_cbranch_scc0 L2_d119
    s_mov_b64 exec, s[82:83]
    s_nop 1
    v_mfma_f32_4x4x4_16b_bf16 v[88:91], v[12:13], v[84:85], 0
    s_nop 1
    v_mfma_f32_4x4x4_16b_bf16 v[88:91], v[10:11], v[86:87], v[88:91]
    s_nop 4
    v_cvt_pk_bf16_f32 v88, v88, v89
    v_cvt_pk_bf16_f32 v89, v90, v91
    ds_pk_add_bf16 v7, v88 offset:65408
    ds_pk_add_bf16 v7, v89 offset:65412
    s_mov_b64 exec, vcc
    s_branch L2_d119
L2_c120:
    s_mov_b64 s[50:51], vcc
    s_lshl_b64 s[52:53], s[82:83], 1
    s_andn2_b64 s[52:53], s[52:53], s[80:81]
    s_andn2_b64 s[52:53], s[52:53], s[50:51]
    s_or_b64 s[80:81], s[80:81], s[52:53]
    s_not_b64 vcc, s[52:53]
    s_mov_b64 exec, -1
    v_cndmask_b32_dpp v84, v84, v84, vcc wave_shr:1 row_mask:0xf bank_mask:0xf
    v_cndmask_b32_dpp v85, v85, v85, vcc wave_shr:1 row_mask:0xf bank_mask:0xf
    s_lshr_b64 s[52:53], s[52:53], 1
    v_cndmask_b32_dpp v86, v86, v86, vcc wave_shr:1 row_mask:0xf bank_mask:0xf
    v_cndmask_b32_dpp v87, v87, v87, vcc wave_shr:1 row_mask:0xf bank_mask:0xf
    s_andn2_b64 s[82:83], s[82:83], s[52:53]
    v_cndmask_b32_dpp v7, v7, v7, vcc wave_shr:1 row_mask:0xf bank_mask:0xf
    s_mov_b64 vcc, s[50:51]
    s_mov_b64 exec, s[50:51]
    s_cbranch_scc0 L2_d120
    s_mov_b64 exec, s[82:83]
    s_nop 1
    v_mfma_f32_4x4x4_16b_bf16 v[88:91], v[12:13], v[84:85], 0
    s_nop 1
    v_mfma_f32_4x4x4_16b_bf16 v[88:91], v[10:11], v[86:87], v[88:91]
    s_nop 4
    v_cvt_pk_bf16_f32 v88, v88, v89
    v_cvt_pk_bf16_f32 v89, v90, v91
    ds_pk_add_bf16 v7, v88 offset:65408
    ds_pk_add_bf16 v7, v89 offset:65412
    s_mov_b64 exec, vcc
    s_branch L2_d120
L2_c121:
    s_mov_b64 s[50:51], vcc
    s_lshl_b64 s[52:53], s[82:83], 1
    s_andn2_b64 s[52:53], s[52:53], s[80:81]
    s_andn2_b64 s[52:53], s[52:53], s[50:51]
    s_or_b64 s[80:81], s[80:81], s[52:53]
    s_not_b64 vcc, s[52:53]
    s_mov_b64 exec, -1
    v_cndmask_b32_dpp v84, v84, v84, vcc wave_shr:1 row_mask:0xf bank_mask:0xf
    v_cndmask_b32_dpp v85, v85, v85, vcc wave_shr:1 row_mask:0xf bank_mask:0xf
    s_lshr_b64 s[52:53], s[52:53], 1
    v_cndmask_b32_dpp v86, v86, v86, vcc wave_shr:1 row_mask:0xf bank_mask:0xf
    v_cndmask_b32_dpp v87, v87, v87, vcc wave_shr:1 row_mask:0xf bank_mask:0xf
    s_andn2_b64 s[82:83], s[82:83], s[52:53]
    v_cndmask_b32_dpp v7, v7, v7, vcc wave_shr:1 row_mask:0xf bank_mask:0xf
    s_mov_b64 vcc, s[50:51]
    s_mov_b64 exec, s[50:51]
    s_cbranch_scc0 L2_d121
    s_mov_b64 exec, s[82:83]
    s_nop 1
    v_mfma_f32_4x4x4_16b_bf16 v[88:91], v[12:13], v[84:85], 0
    s_nop 1
    v_mfma_f32_4x4x4_16b_bf16 v[88:91], v[10:11], v[86:87], v[88:91]
    s_nop 4
    v_cvt_pk_bf16_f32 v88, v88, v89
    v_cvt_pk_bf16_f32 v89, v90, v91
    ds_pk_add_bf16 v7, v88 offset:65408
    ds_pk_add_bf16 v7, v89 offset:65412
    s_mov_b64 exec, vcc
    s_branch L2_d121
L2_c122:
    s_mov_b64 s[50:51], vcc
    s_lshl_b64 s[52:53], s[82:83], 1
    s_andn2_b64 s[52:53], s[52:53], s[80:81]
    s_andn2_b64 s[52:53], s[52:53], s[50:51]
    s_or_b64 s[80:81], s[80:81], s[52:53]
    s_not_b64 vcc, s[52:53]
    s_mov_b64 exec, -1
    v_cndmask_b32_dpp v84, v84, v84, vcc wave_shr:1 row_mask:0xf bank_mask:0xf
    v_cndmask_b32_dpp v85, v85, v85, vcc wave_shr:1 row_mask:0xf bank_mask:0xf
    s_lshr_b64 s[52:53], s[52:53], 1
    v_cndmask_b32_dpp v86, v86, v86, vcc wave_shr:1 row_mask:0xf bank_mask:0xf
    v_cndmask_b32_dpp v87, v87, v87, vcc wave_shr:1 row_mask:0xf bank_mask:0xf
    s_andn2_b64 s[82:83], s[82:83], s[52:53]
    v_cndmask_b32_dpp v7, v7, v7, vcc wave_shr:1 row_mask:0xf bank_mask:0xf
    s_mov_b64 vcc, s[50:51]
    s_mov_b64 exec, s[50:51]
    s_cbranch_scc0 L2_d122
    s_mov_b64 exec, s[82:83]
    s_nop 1
    v_mfma_f32_4x4x4_16b_bf16 v[88:91], v[12:13], v[84:85], 0
    s_nop 1
    v_mfma_f32_4x4x4_16b_bf16 v[88:91], v[10:11], v[86:87], v[88:91]
    s_nop 4
    v_cvt_pk_bf16_f32 v88, v88, v89
    v_cvt_pk_bf16_f32 v89, v90, v91
    ds_pk_add_bf16 v7, v88 offset:65408
    ds_pk_add_bf16 v7, v89 offset:65412
    s_mov_b64 exec, vcc
    s_branch L2_d122
L2_c123:
    s_mov_b64 s[50:51], vcc
    s_lshl_b64 s[52:53], s[82:83], 1
    s_andn2_b64 s[52:53], s[52:53], s[80:81]
    s_andn2_b64 s[52:53], s[52:53], s[50:51]
    s_or_b64 s[80:81], s[80:81], s[52:53]
    s_not_b64 vcc, s[52:53]
    s_mov_b64 exec, -1
    v_cndmask_b32_dpp v84, v84, v84, vcc wave_shr:1 row_mask:0xf bank_mask:0xf
    v_cndmask_b32_dpp v85, v85, v85, vcc wave_shr:1 row_mask:0xf bank_mask:0xf
    s_lshr_b64 s[52:53], s[52:53], 1
    v_cndmask_b32_dpp v86, v86, v86, vcc wave_shr:1 row_mask:0xf bank_mask:0xf
    v_cndmask_b32_dpp v87, v87, v87, vcc wave_shr:1 row_mask:0xf bank_mask:0xf
    s_andn2_b64 s[82:83], s[82:83], s[52:53]
    v_cndmask_b32_dpp v7, v7, v7, vcc wave_shr:1 row_mask:0xf bank_mask:0xf
    s_mov_b64 vcc, s[50:51]
    s_mov_b64 exec, s[50:51]
    s_cbranch_scc0 L2_d123
    s_mov_b64 exec, s[82:83]
    s_nop 1
    v_mfma_f32_4x4x4_16b_bf16 v[88:91], v[12:13], v[84:85], 0
    s_nop 1
    v_mfma_f32_4x4x4_16b_bf16 v[88:91], v[10:11], v[86:87], v[88:91]
    s_nop 4
    v_cvt_pk_bf16_f32 v88, v88, v89
    v_cvt_pk_bf16_f32 v89, v90, v91
    ds_pk_add_bf16 v7, v88 offset:65408
    ds_pk_add_bf16 v7, v89 offset:65412
    s_mov_b64 exec, vcc
    s_branch L2_d123
L2_c124:
    s_mov_b64 s[50:51], vcc
    s_lshl_b64 s[52:53], s[82:83], 1
    s_andn2_b64 s[52:53], s[52:53], s[80:81]
    s_andn2_b64 s[52:53], s[52:53], s[50:51]
    s_or_b64 s[80:81], s[80:81], s[52:53]
    s_not_b64 vcc, s[52:53]
    s_mov_b64 exec, -1
    v_cndmask_b32_dpp v84, v84, v84, vcc wave_shr:1 row_mask:0xf bank_mask:0xf
    v_cndmask_b32_dpp v85, v85, v85, vcc wave_shr:1 row_mask:0xf bank_mask:0xf
    s_lshr_b64 s[52:53], s[52:53], 1
    v_cndmask_b32_dpp v86, v86, v86, vcc wave_shr:1 row_mask:0xf bank_mask:0xf
    v_cndmask_b32_dpp v87, v87, v87, vcc wave_shr:1 row_mask:0xf bank_mask:0xf
    s_andn2_b64 s[82:83], s[82:83], s[52:53]
    v_cndmask_b32_dpp v7, v7, v7, vcc wave_shr:1 row_mask:0xf bank_mask:0xf
    s_mov_b64 vcc, s[50:51]
    s_mov_b64 exec, s[50:51]
    s_cbranch_scc0 L2_d124
    s_mov_b64 exec, s[82:83]
    s_nop 1
    v_mfma_f32_4x4x4_16b_bf16 v[88:91], v[12:13], v[84:85], 0
    s_nop 1
    v_mfma_f32_4x4x4_16b_bf16 v[88:91], v[10:11], v[86:87], v[88:91]
    s_nop 4
    v_cvt_pk_bf16_f32 v88, v88, v89
    v_cvt_pk_bf16_f32 v89, v90, v91
    ds_pk_add_bf16 v7, v88 offset:65408
    ds_pk_add_bf16 v7, v89 offset:65412
    s_mov_b64 exec, vcc
    s_branch L2_d124
L2_c125:
    s_mov_b64 s[50:51], vcc
    s_lshl_b64 s[52:53], s[82:83], 1
    s_andn2_b64 s[52:53], s[52:53], s[80:81]
    s_andn2_b64 s[52:53], s[52:53], s[50:51]
    s_or_b64 s[80:81], s[80:81], s[52:53]
    s_not_b64 vcc, s[52:53]
    s_mov_b64 exec, -1
    v_cndmask_b32_dpp v84, v84, v84, vcc wave_shr:1 row_mask:0xf bank_mask:0xf
    v_cndmask_b32_dpp v85, v85, v85, vcc wave_shr:1 row_mask:0xf bank_mask:0xf
    s_lshr_b64 s[52:53], s[52:53], 1
    v_cndmask_b32_dpp v86, v86, v86, vcc wave_shr:1 row_mask:0xf bank_mask:0xf
    v_cndmask_b32_dpp v87, v87, v87, vcc wave_shr:1 row_mask:0xf bank_mask:0xf
    s_andn2_b64 s[82:83], s[82:83], s[52:53]
    v_cndmask_b32_dpp v7, v7, v7, vcc wave_shr:1 row_mask:0xf bank_mask:0xf
    s_mov_b64 vcc, s[50:51]
    s_mov_b64 exec, s[50:51]
    s_cbranch_scc0 L2_d125
    s_mov_b64 exec, s[82:83]
    s_nop 1
    v_mfma_f32_4x4x4_16b_bf16 v[88:91], v[12:13], v[84:85], 0
    s_nop 1
    v_mfma_f32_4x4x4_16b_bf16 v[88:91], v[10:11], v[86:87], v[88:91]
    s_nop 4
    v_cvt_pk_bf16_f32 v88, v88, v89
    v_cvt_pk_bf16_f32 v89, v90, v91
    ds_pk_add_bf16 v7, v88 offset:65408
    ds_pk_add_bf16 v7, v89 offset:65412
    s_mov_b64 exec, vcc
    s_branch L2_d125
L2_c126:
    s_mov_b64 s[50:51], vcc
    s_lshl_b64 s[52:53], s[82:83], 1
    s_andn2_b64 s[52:53], s[52:53], s[80:81]
    s_andn2_b64 s[52:53], s[52:53], s[50:51]
    s_or_b64 s[80:81], s[80:81], s[52:53]
    s_not_b64 vcc, s[52:53]
    s_mov_b64 exec, -1
    v_cndmask_b32_dpp v84, v84, v84, vcc wave_shr:1 row_mask:0xf bank_mask:0xf
    v_cndmask_b32_dpp v85, v85, v85, vcc wave_shr:1 row_mask:0xf bank_mask:0xf
    s_lshr_b64 s[52:53], s[52:53], 1
    v_cndmask_b32_dpp v86, v86, v86, vcc wave_shr:1 row_mask:0xf bank_mask:0xf
    v_cndmask_b32_dpp v87, v87, v87, vcc wave_shr:1 row_mask:0xf bank_mask:0xf
    s_andn2_b64 s[82:83], s[82:83], s[52:53]
    v_cndmask_b32_dpp v7, v7, v7, vcc wave_shr:1 row_mask:0xf bank_mask:0xf
    s_mov_b64 vcc, s[50:51]
    s_mov_b64 exec, s[50:51]
    s_cbranch_scc0 L2_d126
    s_mov_b64 exec, s[82:83]
    s_nop 1
    v_mfma_f32_4x4x4_16b_bf16 v[88:91], v[12:13], v[84:85], 0
    s_nop 1
    v_mfma_f32_4x4x4_16b_bf16 v[88:91], v[10:11], v[86:87], v[88:91]
    s_nop 4
    v_cvt_pk_bf16_f32 v88, v88, v89
    v_cvt_pk_bf16_f32 v89, v90, v91
    ds_pk_add_bf16 v7, v88 offset:65408
    ds_pk_add_bf16 v7, v89 offset:65412
    s_mov_b64 exec, vcc
    s_branch L2_d126
L2_c127:
    s_mov_b64 s[50:51], vcc
    s_lshl_b64 s[52:53], s[82:83], 1
    s_andn2_b64 s[52:53], s[52:53], s[80:81]
    s_andn2_b64 s[52:53], s[52:53], s[50:51]
    s_or_b64 s[80:81], s[80:81], s[52:53]
    s_not_b64 vcc, s[52:53]
    s_mov_b64 exec, -1
    v_cndmask_b32_dpp v84, v84, v84, vcc wave_shr:1 row_mask:0xf bank_mask:0xf
    v_cndmask_b32_dpp v85, v85, v85, vcc wave_shr:1 row_mask:0xf bank_mask:0xf
    s_lshr_b64 s[52:53], s[52:53], 1
    v_cndmask_b32_dpp v86, v86, v86, vcc wave_shr:1 row_mask:0xf bank_mask:0xf
    v_cndmask_b32_dpp v87, v87, v87, vcc wave_shr:1 row_mask:0xf bank_mask:0xf
    s_andn2_b64 s[82:83], s[82:83], s[52:53]
    v_cndmask_b32_dpp v7, v7, v7, vcc wave_shr:1 row_mask:0xf bank_mask:0xf
    s_mov_b64 vcc, s[50:51]
    s_mov_b64 exec, s[50:51]
    s_cbranch_scc0 L2_d127
    s_mov_b64 exec, s[82:83]
    s_nop 1
    v_mfma_f32_4x4x4_16b_bf16 v[88:91], v[12:13], v[84:85], 0
    s_nop 1
    v_mfma_f32_4x4x4_16b_bf16 v[88:91], v[10:11], v[86:87], v[88:91]
    s_nop 4
    v_cvt_pk_bf16_f32 v88, v88, v89
    v_cvt_pk_bf16_f32 v89, v90, v91
    ds_pk_add_bf16 v7, v88 offset:65408
    ds_pk_add_bf16 v7, v89 offset:65412
    s_mov_b64 exec, vcc
    s_branch L2_d127
L2_c128:
    s_mov_b64 s[50:51], vcc
    s_lshl_b64 s[52:53], s[82:83], 1
    s_andn2_b64 s[52:53], s[52:53], s[80:81]
    s_andn2_b64 s[52:53], s[52:53], s[50:51]
    s_or_b64 s[80:81], s[80:81], s[52:53]
    s_not_b64 vcc, s[52:53]
    s_mov_b64 exec, -1
    v_cndmask_b32_dpp v84, v84, v84, vcc wave_shr:1 row_mask:0xf bank_mask:0xf
    v_cndmask_b32_dpp v85, v85, v85, vcc wave_shr:1 row_mask:0xf bank_mask:0xf
    s_lshr_b64 s[52:53], s[52:53], 1
    v_cndmask_b32_dpp v86, v86, v86, vcc wave_shr:1 row_mask:0xf bank_mask:0xf
    v_cndmask_b32_dpp v87, v87, v87, vcc wave_shr:1 row_mask:0xf bank_mask:0xf
    s_andn2_b64 s[82:83], s[82:83], s[52:53]
    v_cndmask_b32_dpp v7, v7, v7, vcc wave_shr:1 row_mask:0xf bank_mask:0xf
    s_mov_b64 vcc, s[50:51]
    s_mov_b64 exec, s[50:51]
    s_cbranch_scc0 L2_d128
    s_mov_b64 exec, s[82:83]
    s_nop 1
    v_mfma_f32_4x4x4_16b_bf16 v[88:91], v[12:13], v[84:85], 0
    s_nop 1
    v_mfma_f32_4x4x4_16b_bf16 v[88:91], v[10:11], v[86:87], v[88:91]
    s_nop 4
    v_cvt_pk_bf16_f32 v88, v88, v89
    v_cvt_pk_bf16_f32 v89, v90, v91
    ds_pk_add_bf16 v7, v88 offset:65408
    ds_pk_add_bf16 v7, v89 offset:65412
    s_mov_b64 exec, vcc
    s_branch L2_d128
L2_c129:
    s_mov_b64 s[50:51], vcc
    s_lshl_b64 s[52:53], s[82:83], 1
    s_andn2_b64 s[52:53], s[52:53], s[80:81]
    s_andn2_b64 s[52:53], s[52:53], s[50:51]
    s_or_b64 s[80:81], s[80:81], s[52:53]
    s_not_b64 vcc, s[52:53]
    s_mov_b64 exec, -1
    v_cndmask_b32_dpp v84, v84, v84, vcc wave_shr:1 row_mask:0xf bank_mask:0xf
    v_cndmask_b32_dpp v85, v85, v85, vcc wave_shr:1 row_mask:0xf bank_mask:0xf
    s_lshr_b64 s[52:53], s[52:53], 1
    v_cndmask_b32_dpp v86, v86, v86, vcc wave_shr:1 row_mask:0xf bank_mask:0xf
    v_cndmask_b32_dpp v87, v87, v87, vcc wave_shr:1 row_mask:0xf bank_mask:0xf
    s_andn2_b64 s[82:83], s[82:83], s[52:53]
    v_cndmask_b32_dpp v7, v7, v7, vcc wave_shr:1 row_mask:0xf bank_mask:0xf
    s_mov_b64 vcc, s[50:51]
    s_mov_b64 exec, s[50:51]
    s_cbranch_scc0 L2_d129
    s_mov_b64 exec, s[82:83]
    s_nop 1
    v_mfma_f32_4x4x4_16b_bf16 v[88:91], v[12:13], v[84:85], 0
    s_nop 1
    v_mfma_f32_4x4x4_16b_bf16 v[88:91], v[10:11], v[86:87], v[88:91]
    s_nop 4
    v_cvt_pk_bf16_f32 v88, v88, v89
    v_cvt_pk_bf16_f32 v89, v90, v91
    ds_pk_add_bf16 v7, v88 offset:65408
    ds_pk_add_bf16 v7, v89 offset:65412
    s_mov_b64 exec, vcc
    s_branch L2_d129
L2_c130:
    s_mov_b64 s[50:51], vcc
    s_lshl_b64 s[52:53], s[82:83], 1
    s_andn2_b64 s[52:53], s[52:53], s[80:81]
    s_andn2_b64 s[52:53], s[52:53], s[50:51]
    s_or_b64 s[80:81], s[80:81], s[52:53]
    s_not_b64 vcc, s[52:53]
    s_mov_b64 exec, -1
    v_cndmask_b32_dpp v84, v84, v84, vcc wave_shr:1 row_mask:0xf bank_mask:0xf
    v_cndmask_b32_dpp v85, v85, v85, vcc wave_shr:1 row_mask:0xf bank_mask:0xf
    s_lshr_b64 s[52:53], s[52:53], 1
    v_cndmask_b32_dpp v86, v86, v86, vcc wave_shr:1 row_mask:0xf bank_mask:0xf
    v_cndmask_b32_dpp v87, v87, v87, vcc wave_shr:1 row_mask:0xf bank_mask:0xf
    s_andn2_b64 s[82:83], s[82:83], s[52:53]
    v_cndmask_b32_dpp v7, v7, v7, vcc wave_shr:1 row_mask:0xf bank_mask:0xf
    s_mov_b64 vcc, s[50:51]
    s_mov_b64 exec, s[50:51]
    s_cbranch_scc0 L2_d130
    s_mov_b64 exec, s[82:83]
    s_nop 1
    v_mfma_f32_4x4x4_16b_bf16 v[88:91], v[12:13], v[84:85], 0
    s_nop 1
    v_mfma_f32_4x4x4_16b_bf16 v[88:91], v[10:11], v[86:87], v[88:91]
    s_nop 4
    v_cvt_pk_bf16_f32 v88, v88, v89
    v_cvt_pk_bf16_f32 v89, v90, v91
    ds_pk_add_bf16 v7, v88 offset:65408
    ds_pk_add_bf16 v7, v89 offset:65412
    s_mov_b64 exec, vcc
    s_branch L2_d130
L2_c131:
    s_mov_b64 s[50:51], vcc
    s_lshl_b64 s[52:53], s[82:83], 1
    s_andn2_b64 s[52:53], s[52:53], s[80:81]
    s_andn2_b64 s[52:53], s[52:53], s[50:51]
    s_or_b64 s[80:81], s[80:81], s[52:53]
    s_not_b64 vcc, s[52:53]
    s_mov_b64 exec, -1
    v_cndmask_b32_dpp v84, v84, v84, vcc wave_shr:1 row_mask:0xf bank_mask:0xf
    v_cndmask_b32_dpp v85, v85, v85, vcc wave_shr:1 row_mask:0xf bank_mask:0xf
    s_lshr_b64 s[52:53], s[52:53], 1
    v_cndmask_b32_dpp v86, v86, v86, vcc wave_shr:1 row_mask:0xf bank_mask:0xf
    v_cndmask_b32_dpp v87, v87, v87, vcc wave_shr:1 row_mask:0xf bank_mask:0xf
    s_andn2_b64 s[82:83], s[82:83], s[52:53]
    v_cndmask_b32_dpp v7, v7, v7, vcc wave_shr:1 row_mask:0xf bank_mask:0xf
    s_mov_b64 vcc, s[50:51]
    s_mov_b64 exec, s[50:51]
    s_cbranch_scc0 L2_d131
    s_mov_b64 exec, s[82:83]
    s_nop 1
    v_mfma_f32_4x4x4_16b_bf16 v[88:91], v[12:13], v[84:85], 0
    s_nop 1
    v_mfma_f32_4x4x4_16b_bf16 v[88:91], v[10:11], v[86:87], v[88:91]
    s_nop 4
    v_cvt_pk_bf16_f32 v88, v88, v89
    v_cvt_pk_bf16_f32 v89, v90, v91
    ds_pk_add_bf16 v7, v88 offset:65408
    ds_pk_add_bf16 v7, v89 offset:65412
    s_mov_b64 exec, vcc
    s_branch L2_d131
L2_c132:
    s_mov_b64 s[50:51], vcc
    s_lshl_b64 s[52:53], s[82:83], 1
    s_andn2_b64 s[52:53], s[52:53], s[80:81]
    s_andn2_b64 s[52:53], s[52:53], s[50:51]
    s_or_b64 s[80:81], s[80:81], s[52:53]
    s_not_b64 vcc, s[52:53]
    s_mov_b64 exec, -1
    v_cndmask_b32_dpp v84, v84, v84, vcc wave_shr:1 row_mask:0xf bank_mask:0xf
    v_cndmask_b32_dpp v85, v85, v85, vcc wave_shr:1 row_mask:0xf bank_mask:0xf
    s_lshr_b64 s[52:53], s[52:53], 1
    v_cndmask_b32_dpp v86, v86, v86, vcc wave_shr:1 row_mask:0xf bank_mask:0xf
    v_cndmask_b32_dpp v87, v87, v87, vcc wave_shr:1 row_mask:0xf bank_mask:0xf
    s_andn2_b64 s[82:83], s[82:83], s[52:53]
    v_cndmask_b32_dpp v7, v7, v7, vcc wave_shr:1 row_mask:0xf bank_mask:0xf
    s_mov_b64 vcc, s[50:51]
    s_mov_b64 exec, s[50:51]
    s_cbranch_scc0 L2_d132
    s_mov_b64 exec, s[82:83]
    s_nop 1
    v_mfma_f32_4x4x4_16b_bf16 v[88:91], v[12:13], v[84:85], 0
    s_nop 1
    v_mfma_f32_4x4x4_16b_bf16 v[88:91], v[10:11], v[86:87], v[88:91]
    s_nop 4
    v_cvt_pk_bf16_f32 v88, v88, v89
    v_cvt_pk_bf16_f32 v89, v90, v91
    ds_pk_add_bf16 v7, v88 offset:65408
    ds_pk_add_bf16 v7, v89 offset:65412
    s_mov_b64 exec, vcc
    s_branch L2_d132
L2_c133:
    s_mov_b64 s[50:51], vcc
    s_lshl_b64 s[52:53], s[82:83], 1
    s_andn2_b64 s[52:53], s[52:53], s[80:81]
    s_andn2_b64 s[52:53], s[52:53], s[50:51]
    s_or_b64 s[80:81], s[80:81], s[52:53]
    s_not_b64 vcc, s[52:53]
    s_mov_b64 exec, -1
    v_cndmask_b32_dpp v84, v84, v84, vcc wave_shr:1 row_mask:0xf bank_mask:0xf
    v_cndmask_b32_dpp v85, v85, v85, vcc wave_shr:1 row_mask:0xf bank_mask:0xf
    s_lshr_b64 s[52:53], s[52:53], 1
    v_cndmask_b32_dpp v86, v86, v86, vcc wave_shr:1 row_mask:0xf bank_mask:0xf
    v_cndmask_b32_dpp v87, v87, v87, vcc wave_shr:1 row_mask:0xf bank_mask:0xf
    s_andn2_b64 s[82:83], s[82:83], s[52:53]
    v_cndmask_b32_dpp v7, v7, v7, vcc wave_shr:1 row_mask:0xf bank_mask:0xf
    s_mov_b64 vcc, s[50:51]
    s_mov_b64 exec, s[50:51]
    s_cbranch_scc0 L2_d133
    s_mov_b64 exec, s[82:83]
    s_nop 1
    v_mfma_f32_4x4x4_16b_bf16 v[88:91], v[12:13], v[84:85], 0
    s_nop 1
    v_mfma_f32_4x4x4_16b_bf16 v[88:91], v[10:11], v[86:87], v[88:91]
    s_nop 4
    v_cvt_pk_bf16_f32 v88, v88, v89
    v_cvt_pk_bf16_f32 v89, v90, v91
    ds_pk_add_bf16 v7, v88 offset:65408
    ds_pk_add_bf16 v7, v89 offset:65412
    s_mov_b64 exec, vcc
    s_branch L2_d133
L2_c134:
    s_mov_b64 s[50:51], vcc
    s_lshl_b64 s[52:53], s[82:83], 1
    s_andn2_b64 s[52:53], s[52:53], s[80:81]
    s_andn2_b64 s[52:53], s[52:53], s[50:51]
    s_or_b64 s[80:81], s[80:81], s[52:53]
    s_not_b64 vcc, s[52:53]
    s_mov_b64 exec, -1
    v_cndmask_b32_dpp v84, v84, v84, vcc wave_shr:1 row_mask:0xf bank_mask:0xf
    v_cndmask_b32_dpp v85, v85, v85, vcc wave_shr:1 row_mask:0xf bank_mask:0xf
    s_lshr_b64 s[52:53], s[52:53], 1
    v_cndmask_b32_dpp v86, v86, v86, vcc wave_shr:1 row_mask:0xf bank_mask:0xf
    v_cndmask_b32_dpp v87, v87, v87, vcc wave_shr:1 row_mask:0xf bank_mask:0xf
    s_andn2_b64 s[82:83], s[82:83], s[52:53]
    v_cndmask_b32_dpp v7, v7, v7, vcc wave_shr:1 row_mask:0xf bank_mask:0xf
    s_mov_b64 vcc, s[50:51]
    s_mov_b64 exec, s[50:51]
    s_cbranch_scc0 L2_d134
    s_mov_b64 exec, s[82:83]
    s_nop 1
    v_mfma_f32_4x4x4_16b_bf16 v[88:91], v[12:13], v[84:85], 0
    s_nop 1
    v_mfma_f32_4x4x4_16b_bf16 v[88:91], v[10:11], v[86:87], v[88:91]
    s_nop 4
    v_cvt_pk_bf16_f32 v88, v88, v89
    v_cvt_pk_bf16_f32 v89, v90, v91
    ds_pk_add_bf16 v7, v88 offset:65408
    ds_pk_add_bf16 v7, v89 offset:65412
    s_mov_b64 exec, vcc
    s_branch L2_d134
L2_c135:
    s_mov_b64 s[50:51], vcc
    s_lshl_b64 s[52:53], s[82:83], 1
    s_andn2_b64 s[52:53], s[52:53], s[80:81]
    s_andn2_b64 s[52:53], s[52:53], s[50:51]
    s_or_b64 s[80:81], s[80:81], s[52:53]
    s_not_b64 vcc, s[52:53]
    s_mov_b64 exec, -1
    v_cndmask_b32_dpp v84, v84, v84, vcc wave_shr:1 row_mask:0xf bank_mask:0xf
    v_cndmask_b32_dpp v85, v85, v85, vcc wave_shr:1 row_mask:0xf bank_mask:0xf
    s_lshr_b64 s[52:53], s[52:53], 1
    v_cndmask_b32_dpp v86, v86, v86, vcc wave_shr:1 row_mask:0xf bank_mask:0xf
    v_cndmask_b32_dpp v87, v87, v87, vcc wave_shr:1 row_mask:0xf bank_mask:0xf
    s_andn2_b64 s[82:83], s[82:83], s[52:53]
    v_cndmask_b32_dpp v7, v7, v7, vcc wave_shr:1 row_mask:0xf bank_mask:0xf
    s_mov_b64 vcc, s[50:51]
    s_mov_b64 exec, s[50:51]
    s_cbranch_scc0 L2_d135
    s_mov_b64 exec, s[82:83]
    s_nop 1
    v_mfma_f32_4x4x4_16b_bf16 v[88:91], v[12:13], v[84:85], 0
    s_nop 1
    v_mfma_f32_4x4x4_16b_bf16 v[88:91], v[10:11], v[86:87], v[88:91]
    s_nop 4
    v_cvt_pk_bf16_f32 v88, v88, v89
    v_cvt_pk_bf16_f32 v89, v90, v91
    ds_pk_add_bf16 v7, v88 offset:65408
    ds_pk_add_bf16 v7, v89 offset:65412
    s_mov_b64 exec, vcc
    s_branch L2_d135
L2_c136:
    s_mov_b64 s[50:51], vcc
    s_lshl_b64 s[52:53], s[82:83], 1
    s_andn2_b64 s[52:53], s[52:53], s[80:81]
    s_andn2_b64 s[52:53], s[52:53], s[50:51]
    s_or_b64 s[80:81], s[80:81], s[52:53]
    s_not_b64 vcc, s[52:53]
    s_mov_b64 exec, -1
    v_cndmask_b32_dpp v84, v84, v84, vcc wave_shr:1 row_mask:0xf bank_mask:0xf
    v_cndmask_b32_dpp v85, v85, v85, vcc wave_shr:1 row_mask:0xf bank_mask:0xf
    s_lshr_b64 s[52:53], s[52:53], 1
    v_cndmask_b32_dpp v86, v86, v86, vcc wave_shr:1 row_mask:0xf bank_mask:0xf
    v_cndmask_b32_dpp v87, v87, v87, vcc wave_shr:1 row_mask:0xf bank_mask:0xf
    s_andn2_b64 s[82:83], s[82:83], s[52:53]
    v_cndmask_b32_dpp v7, v7, v7, vcc wave_shr:1 row_mask:0xf bank_mask:0xf
    s_mov_b64 vcc, s[50:51]
    s_mov_b64 exec, s[50:51]
    s_cbranch_scc0 L2_d136
    s_mov_b64 exec, s[82:83]
    s_nop 1
    v_mfma_f32_4x4x4_16b_bf16 v[88:91], v[12:13], v[84:85], 0
    s_nop 1
    v_mfma_f32_4x4x4_16b_bf16 v[88:91], v[10:11], v[86:87], v[88:91]
    s_nop 4
    v_cvt_pk_bf16_f32 v88, v88, v89
    v_cvt_pk_bf16_f32 v89, v90, v91
    ds_pk_add_bf16 v7, v88 offset:65408
    ds_pk_add_bf16 v7, v89 offset:65412
    s_mov_b64 exec, vcc
    s_branch L2_d136
L2_c137:
    s_mov_b64 s[50:51], vcc
    s_lshl_b64 s[52:53], s[82:83], 1
    s_andn2_b64 s[52:53], s[52:53], s[80:81]
    s_andn2_b64 s[52:53], s[52:53], s[50:51]
    s_or_b64 s[80:81], s[80:81], s[52:53]
    s_not_b64 vcc, s[52:53]
    s_mov_b64 exec, -1
    v_cndmask_b32_dpp v84, v84, v84, vcc wave_shr:1 row_mask:0xf bank_mask:0xf
    v_cndmask_b32_dpp v85, v85, v85, vcc wave_shr:1 row_mask:0xf bank_mask:0xf
    s_lshr_b64 s[52:53], s[52:53], 1
    v_cndmask_b32_dpp v86, v86, v86, vcc wave_shr:1 row_mask:0xf bank_mask:0xf
    v_cndmask_b32_dpp v87, v87, v87, vcc wave_shr:1 row_mask:0xf bank_mask:0xf
    s_andn2_b64 s[82:83], s[82:83], s[52:53]
    v_cndmask_b32_dpp v7, v7, v7, vcc wave_shr:1 row_mask:0xf bank_mask:0xf
    s_mov_b64 vcc, s[50:51]
    s_mov_b64 exec, s[50:51]
    s_cbranch_scc0 L2_d137
    s_mov_b64 exec, s[82:83]
    s_nop 1
    v_mfma_f32_4x4x4_16b_bf16 v[88:91], v[12:13], v[84:85], 0
    s_nop 1
    v_mfma_f32_4x4x4_16b_bf16 v[88:91], v[10:11], v[86:87], v[88:91]
    s_nop 4
    v_cvt_pk_bf16_f32 v88, v88, v89
    v_cvt_pk_bf16_f32 v89, v90, v91
    ds_pk_add_bf16 v7, v88 offset:65408
    ds_pk_add_bf16 v7, v89 offset:65412
    s_mov_b64 exec, vcc
    s_branch L2_d137
L2_c138:
    s_mov_b64 s[50:51], vcc
    s_lshl_b64 s[52:53], s[82:83], 1
    s_andn2_b64 s[52:53], s[52:53], s[80:81]
    s_andn2_b64 s[52:53], s[52:53], s[50:51]
    s_or_b64 s[80:81], s[80:81], s[52:53]
    s_not_b64 vcc, s[52:53]
    s_mov_b64 exec, -1
    v_cndmask_b32_dpp v84, v84, v84, vcc wave_shr:1 row_mask:0xf bank_mask:0xf
    v_cndmask_b32_dpp v85, v85, v85, vcc wave_shr:1 row_mask:0xf bank_mask:0xf
    s_lshr_b64 s[52:53], s[52:53], 1
    v_cndmask_b32_dpp v86, v86, v86, vcc wave_shr:1 row_mask:0xf bank_mask:0xf
    v_cndmask_b32_dpp v87, v87, v87, vcc wave_shr:1 row_mask:0xf bank_mask:0xf
    s_andn2_b64 s[82:83], s[82:83], s[52:53]
    v_cndmask_b32_dpp v7, v7, v7, vcc wave_shr:1 row_mask:0xf bank_mask:0xf
    s_mov_b64 vcc, s[50:51]
    s_mov_b64 exec, s[50:51]
    s_cbranch_scc0 L2_d138
    s_mov_b64 exec, s[82:83]
    s_nop 1
    v_mfma_f32_4x4x4_16b_bf16 v[88:91], v[12:13], v[84:85], 0
    s_nop 1
    v_mfma_f32_4x4x4_16b_bf16 v[88:91], v[10:11], v[86:87], v[88:91]
    s_nop 4
    v_cvt_pk_bf16_f32 v88, v88, v89
    v_cvt_pk_bf16_f32 v89, v90, v91
    ds_pk_add_bf16 v7, v88 offset:65408
    ds_pk_add_bf16 v7, v89 offset:65412
    s_mov_b64 exec, vcc
    s_branch L2_d138
L2_c139:
    s_mov_b64 s[50:51], vcc
    s_lshl_b64 s[52:53], s[82:83], 1
    s_andn2_b64 s[52:53], s[52:53], s[80:81]
    s_andn2_b64 s[52:53], s[52:53], s[50:51]
    s_or_b64 s[80:81], s[80:81], s[52:53]
    s_not_b64 vcc, s[52:53]
    s_mov_b64 exec, -1
    v_cndmask_b32_dpp v84, v84, v84, vcc wave_shr:1 row_mask:0xf bank_mask:0xf
    v_cndmask_b32_dpp v85, v85, v85, vcc wave_shr:1 row_mask:0xf bank_mask:0xf
    s_lshr_b64 s[52:53], s[52:53], 1
    v_cndmask_b32_dpp v86, v86, v86, vcc wave_shr:1 row_mask:0xf bank_mask:0xf
    v_cndmask_b32_dpp v87, v87, v87, vcc wave_shr:1 row_mask:0xf bank_mask:0xf
    s_andn2_b64 s[82:83], s[82:83], s[52:53]
    v_cndmask_b32_dpp v7, v7, v7, vcc wave_shr:1 row_mask:0xf bank_mask:0xf
    s_mov_b64 vcc, s[50:51]
    s_mov_b64 exec, s[50:51]
    s_cbranch_scc0 L2_d139
    s_mov_b64 exec, s[82:83]
    s_nop 1
    v_mfma_f32_4x4x4_16b_bf16 v[88:91], v[12:13], v[84:85], 0
    s_nop 1
    v_mfma_f32_4x4x4_16b_bf16 v[88:91], v[10:11], v[86:87], v[88:91]
    s_nop 4
    v_cvt_pk_bf16_f32 v88, v88, v89
    v_cvt_pk_bf16_f32 v89, v90, v91
    ds_pk_add_bf16 v7, v88 offset:65408
    ds_pk_add_bf16 v7, v89 offset:65412
    s_mov_b64 exec, vcc
    s_branch L2_d139
L2_c140:
    s_mov_b64 s[50:51], vcc
    s_lshl_b64 s[52:53], s[82:83], 1
    s_andn2_b64 s[52:53], s[52:53], s[80:81]
    s_andn2_b64 s[52:53], s[52:53], s[50:51]
    s_or_b64 s[80:81], s[80:81], s[52:53]
    s_not_b64 vcc, s[52:53]
    s_mov_b64 exec, -1
    v_cndmask_b32_dpp v84, v84, v84, vcc wave_shr:1 row_mask:0xf bank_mask:0xf
    v_cndmask_b32_dpp v85, v85, v85, vcc wave_shr:1 row_mask:0xf bank_mask:0xf
    s_lshr_b64 s[52:53], s[52:53], 1
    v_cndmask_b32_dpp v86, v86, v86, vcc wave_shr:1 row_mask:0xf bank_mask:0xf
    v_cndmask_b32_dpp v87, v87, v87, vcc wave_shr:1 row_mask:0xf bank_mask:0xf
    s_andn2_b64 s[82:83], s[82:83], s[52:53]
    v_cndmask_b32_dpp v7, v7, v7, vcc wave_shr:1 row_mask:0xf bank_mask:0xf
    s_mov_b64 vcc, s[50:51]
    s_mov_b64 exec, s[50:51]
    s_cbranch_scc0 L2_d140
    s_mov_b64 exec, s[82:83]
    s_nop 1
    v_mfma_f32_4x4x4_16b_bf16 v[88:91], v[12:13], v[84:85], 0
    s_nop 1
    v_mfma_f32_4x4x4_16b_bf16 v[88:91], v[10:11], v[86:87], v[88:91]
    s_nop 4
    v_cvt_pk_bf16_f32 v88, v88, v89
    v_cvt_pk_bf16_f32 v89, v90, v91
    ds_pk_add_bf16 v7, v88 offset:65408
    ds_pk_add_bf16 v7, v89 offset:65412
    s_mov_b64 exec, vcc
    s_branch L2_d140
L2_c141:
    s_mov_b64 s[50:51], vcc
    s_lshl_b64 s[52:53], s[82:83], 1
    s_andn2_b64 s[52:53], s[52:53], s[80:81]
    s_andn2_b64 s[52:53], s[52:53], s[50:51]
    s_or_b64 s[80:81], s[80:81], s[52:53]
    s_not_b64 vcc, s[52:53]
    s_mov_b64 exec, -1
    v_cndmask_b32_dpp v84, v84, v84, vcc wave_shr:1 row_mask:0xf bank_mask:0xf
    v_cndmask_b32_dpp v85, v85, v85, vcc wave_shr:1 row_mask:0xf bank_mask:0xf
    s_lshr_b64 s[52:53], s[52:53], 1
    v_cndmask_b32_dpp v86, v86, v86, vcc wave_shr:1 row_mask:0xf bank_mask:0xf
    v_cndmask_b32_dpp v87, v87, v87, vcc wave_shr:1 row_mask:0xf bank_mask:0xf
    s_andn2_b64 s[82:83], s[82:83], s[52:53]
    v_cndmask_b32_dpp v7, v7, v7, vcc wave_shr:1 row_mask:0xf bank_mask:0xf
    s_mov_b64 vcc, s[50:51]
    s_mov_b64 exec, s[50:51]
    s_cbranch_scc0 L2_d141
    s_mov_b64 exec, s[82:83]
    s_nop 1
    v_mfma_f32_4x4x4_16b_bf16 v[88:91], v[12:13], v[84:85], 0
    s_nop 1
    v_mfma_f32_4x4x4_16b_bf16 v[88:91], v[10:11], v[86:87], v[88:91]
    s_nop 4
    v_cvt_pk_bf16_f32 v88, v88, v89
    v_cvt_pk_bf16_f32 v89, v90, v91
    ds_pk_add_bf16 v7, v88 offset:65408
    ds_pk_add_bf16 v7, v89 offset:65412
    s_mov_b64 exec, vcc
    s_branch L2_d141
L2_c142:
    s_mov_b64 s[50:51], vcc
    s_lshl_b64 s[52:53], s[82:83], 1
    s_andn2_b64 s[52:53], s[52:53], s[80:81]
    s_andn2_b64 s[52:53], s[52:53], s[50:51]
    s_or_b64 s[80:81], s[80:81], s[52:53]
    s_not_b64 vcc, s[52:53]
    s_mov_b64 exec, -1
    v_cndmask_b32_dpp v84, v84, v84, vcc wave_shr:1 row_mask:0xf bank_mask:0xf
    v_cndmask_b32_dpp v85, v85, v85, vcc wave_shr:1 row_mask:0xf bank_mask:0xf
    s_lshr_b64 s[52:53], s[52:53], 1
    v_cndmask_b32_dpp v86, v86, v86, vcc wave_shr:1 row_mask:0xf bank_mask:0xf
    v_cndmask_b32_dpp v87, v87, v87, vcc wave_shr:1 row_mask:0xf bank_mask:0xf
    s_andn2_b64 s[82:83], s[82:83], s[52:53]
    v_cndmask_b32_dpp v7, v7, v7, vcc wave_shr:1 row_mask:0xf bank_mask:0xf
    s_mov_b64 vcc, s[50:51]
    s_mov_b64 exec, s[50:51]
    s_cbranch_scc0 L2_d142
    s_mov_b64 exec, s[82:83]
    s_nop 1
    v_mfma_f32_4x4x4_16b_bf16 v[88:91], v[12:13], v[84:85], 0
    s_nop 1
    v_mfma_f32_4x4x4_16b_bf16 v[88:91], v[10:11], v[86:87], v[88:91]
    s_nop 4
    v_cvt_pk_bf16_f32 v88, v88, v89
    v_cvt_pk_bf16_f32 v89, v90, v91
    ds_pk_add_bf16 v7, v88 offset:65408
    ds_pk_add_bf16 v7, v89 offset:65412
    s_mov_b64 exec, vcc
    s_branch L2_d142
L2_c143:
    s_mov_b64 s[50:51], vcc
    s_lshl_b64 s[52:53], s[82:83], 1
    s_andn2_b64 s[52:53], s[52:53], s[80:81]
    s_andn2_b64 s[52:53], s[52:53], s[50:51]
    s_or_b64 s[80:81], s[80:81], s[52:53]
    s_not_b64 vcc, s[52:53]
    s_mov_b64 exec, -1
    v_cndmask_b32_dpp v84, v84, v84, vcc wave_shr:1 row_mask:0xf bank_mask:0xf
    v_cndmask_b32_dpp v85, v85, v85, vcc wave_shr:1 row_mask:0xf bank_mask:0xf
    s_lshr_b64 s[52:53], s[52:53], 1
    v_cndmask_b32_dpp v86, v86, v86, vcc wave_shr:1 row_mask:0xf bank_mask:0xf
    v_cndmask_b32_dpp v87, v87, v87, vcc wave_shr:1 row_mask:0xf bank_mask:0xf
    s_andn2_b64 s[82:83], s[82:83], s[52:53]
    v_cndmask_b32_dpp v7, v7, v7, vcc wave_shr:1 row_mask:0xf bank_mask:0xf
    s_mov_b64 vcc, s[50:51]
    s_mov_b64 exec, s[50:51]
    s_cbranch_scc0 L2_d143
    s_mov_b64 exec, s[82:83]
    s_nop 1
    v_mfma_f32_4x4x4_16b_bf16 v[88:91], v[12:13], v[84:85], 0
    s_nop 1
    v_mfma_f32_4x4x4_16b_bf16 v[88:91], v[10:11], v[86:87], v[88:91]
    s_nop 4
    v_cvt_pk_bf16_f32 v88, v88, v89
    v_cvt_pk_bf16_f32 v89, v90, v91
    ds_pk_add_bf16 v7, v88 offset:65408
    ds_pk_add_bf16 v7, v89 offset:65412
    s_mov_b64 exec, vcc
    s_branch L2_d143
L2_c144:
    s_mov_b64 s[50:51], vcc
    s_lshl_b64 s[52:53], s[82:83], 1
    s_andn2_b64 s[52:53], s[52:53], s[80:81]
    s_andn2_b64 s[52:53], s[52:53], s[50:51]
    s_or_b64 s[80:81], s[80:81], s[52:53]
    s_not_b64 vcc, s[52:53]
    s_mov_b64 exec, -1
    v_cndmask_b32_dpp v84, v84, v84, vcc wave_shr:1 row_mask:0xf bank_mask:0xf
    v_cndmask_b32_dpp v85, v85, v85, vcc wave_shr:1 row_mask:0xf bank_mask:0xf
    s_lshr_b64 s[52:53], s[52:53], 1
    v_cndmask_b32_dpp v86, v86, v86, vcc wave_shr:1 row_mask:0xf bank_mask:0xf
    v_cndmask_b32_dpp v87, v87, v87, vcc wave_shr:1 row_mask:0xf bank_mask:0xf
    s_andn2_b64 s[82:83], s[82:83], s[52:53]
    v_cndmask_b32_dpp v7, v7, v7, vcc wave_shr:1 row_mask:0xf bank_mask:0xf
    s_mov_b64 vcc, s[50:51]
    s_mov_b64 exec, s[50:51]
    s_cbranch_scc0 L2_d144
    s_mov_b64 exec, s[82:83]
    s_nop 1
    v_mfma_f32_4x4x4_16b_bf16 v[88:91], v[12:13], v[84:85], 0
    s_nop 1
    v_mfma_f32_4x4x4_16b_bf16 v[88:91], v[10:11], v[86:87], v[88:91]
    s_nop 4
    v_cvt_pk_bf16_f32 v88, v88, v89
    v_cvt_pk_bf16_f32 v89, v90, v91
    ds_pk_add_bf16 v7, v88 offset:65408
    ds_pk_add_bf16 v7, v89 offset:65412
    s_mov_b64 exec, vcc
    s_branch L2_d144
L2_c145:
    s_mov_b64 s[50:51], vcc
    s_lshl_b64 s[52:53], s[82:83], 1
    s_andn2_b64 s[52:53], s[52:53], s[80:81]
    s_andn2_b64 s[52:53], s[52:53], s[50:51]
    s_or_b64 s[80:81], s[80:81], s[52:53]
    s_not_b64 vcc, s[52:53]
    s_mov_b64 exec, -1
    v_cndmask_b32_dpp v84, v84, v84, vcc wave_shr:1 row_mask:0xf bank_mask:0xf
    v_cndmask_b32_dpp v85, v85, v85, vcc wave_shr:1 row_mask:0xf bank_mask:0xf
    s_lshr_b64 s[52:53], s[52:53], 1
    v_cndmask_b32_dpp v86, v86, v86, vcc wave_shr:1 row_mask:0xf bank_mask:0xf
    v_cndmask_b32_dpp v87, v87, v87, vcc wave_shr:1 row_mask:0xf bank_mask:0xf
    s_andn2_b64 s[82:83], s[82:83], s[52:53]
    v_cndmask_b32_dpp v7, v7, v7, vcc wave_shr:1 row_mask:0xf bank_mask:0xf
    s_mov_b64 vcc, s[50:51]
    s_mov_b64 exec, s[50:51]
    s_cbranch_scc0 L2_d145
    s_mov_b64 exec, s[82:83]
    s_nop 1
    v_mfma_f32_4x4x4_16b_bf16 v[88:91], v[12:13], v[84:85], 0
    s_nop 1
    v_mfma_f32_4x4x4_16b_bf16 v[88:91], v[10:11], v[86:87], v[88:91]
    s_nop 4
    v_cvt_pk_bf16_f32 v88, v88, v89
    v_cvt_pk_bf16_f32 v89, v90, v91
    ds_pk_add_bf16 v7, v88 offset:65408
    ds_pk_add_bf16 v7, v89 offset:65412
    s_mov_b64 exec, vcc
    s_branch L2_d145
L2_c146:
    s_mov_b64 s[50:51], vcc
    s_lshl_b64 s[52:53], s[82:83], 1
    s_andn2_b64 s[52:53], s[52:53], s[80:81]
    s_andn2_b64 s[52:53], s[52:53], s[50:51]
    s_or_b64 s[80:81], s[80:81], s[52:53]
    s_not_b64 vcc, s[52:53]
    s_mov_b64 exec, -1
    v_cndmask_b32_dpp v84, v84, v84, vcc wave_shr:1 row_mask:0xf bank_mask:0xf
    v_cndmask_b32_dpp v85, v85, v85, vcc wave_shr:1 row_mask:0xf bank_mask:0xf
    s_lshr_b64 s[52:53], s[52:53], 1
    v_cndmask_b32_dpp v86, v86, v86, vcc wave_shr:1 row_mask:0xf bank_mask:0xf
    v_cndmask_b32_dpp v87, v87, v87, vcc wave_shr:1 row_mask:0xf bank_mask:0xf
    s_andn2_b64 s[82:83], s[82:83], s[52:53]
    v_cndmask_b32_dpp v7, v7, v7, vcc wave_shr:1 row_mask:0xf bank_mask:0xf
    s_mov_b64 vcc, s[50:51]
    s_mov_b64 exec, s[50:51]
    s_cbranch_scc0 L2_d146
    s_mov_b64 exec, s[82:83]
    s_nop 1
    v_mfma_f32_4x4x4_16b_bf16 v[88:91], v[12:13], v[84:85], 0
    s_nop 1
    v_mfma_f32_4x4x4_16b_bf16 v[88:91], v[10:11], v[86:87], v[88:91]
    s_nop 4
    v_cvt_pk_bf16_f32 v88, v88, v89
    v_cvt_pk_bf16_f32 v89, v90, v91
    ds_pk_add_bf16 v7, v88 offset:65408
    ds_pk_add_bf16 v7, v89 offset:65412
    s_mov_b64 exec, vcc
    s_branch L2_d146
.section .rodata,"a"
.p2align 6
.amdhsa_kernel gs_sort_kernel
  .amdhsa_next_free_vgpr 128
  .amdhsa_next_free_sgpr 96
  .amdhsa_accum_offset 128
  .amdhsa_group_segment_fixed_size 0
  .amdhsa_kernarg_size 112
  .amdhsa_user_sgpr_count 2
  .amdhsa_user_sgpr_kernarg_segment_ptr 1
  .amdhsa_system_sgpr_workgroup_id_x 1
  .amdhsa_float_denorm_mode_32 3
.end_amdhsa_kernel
.p2align 6
.amdhsa_kernel gs_acc_kernel
  .amdhsa_next_free_vgpr 128
  .amdhsa_next_free_sgpr 100
  .amdhsa_accum_offset 128
  .amdhsa_group_segment_fixed_size 0
  .amdhsa_kernarg_size 112
  .amdhsa_user_sgpr_count 2
  .amdhsa_user_sgpr_kernarg_segment_ptr 1
  .amdhsa_system_sgpr_workgroup_id_x 1
  .amdhsa_float_denorm_mode_32 3
.end_amdhsa_kernel
```

```asm
; @launch kernel=gs_sort_kernel grid=(256,1,1) block=(1024,1,1) lds=163840
; @launch kernel=gs_acc_kernel grid=(256,1,1) block=(1024,1,1) lds=163840
.amdgcn_target "amdgcn-amd-amdhsa--gfx950"
.text
.globl gs_sort_kernel
.p2align 8
.type gs_sort_kernel,@function
gs_sort_kernel:
    s_cmp_ge_u32 s2, 256
    s_cbranch_scc1 L1_end
    s_load_dwordx4 s[4:7], s[0:1], 8
    s_load_dwordx2 s[28:29], s[0:1], 32
    s_load_dwordx2 s[30:31], s[0:1], 104
    s_load_dwordx2 s[56:57], s[0:1], 96
    s_load_dwordx2 s[86:87], s[0:1], 0
    s_load_dwordx4 s[60:63], s[0:1], 56
    s_load_dwordx4 s[64:67], s[0:1], 72
    v_lshrrev_b32 v7, 6, v0
    v_lshlrev_b32 v1, 3, v0
    v_readfirstlane_b32 s32, v7
    v_lshlrev_b32 v0, 4, v0
    s_mul_i32 s33, s2, 16384
    s_mul_i32 s34, s2, 8192
    s_waitcnt lgkmcnt(0)
    s_mov_b32 s8, s4
    s_mov_b32 s9, s5
    s_mov_b32 s10, 0x9c40000
    s_mov_b32 s11, 0x20000
    s_mov_b32 s12, s6
    s_mov_b32 s13, s7
    s_mov_b32 s14, 0x9c40000
    s_mov_b32 s15, 0x20000
    s_mov_b32 s16, s28
    s_mov_b32 s17, s29
    s_mov_b32 s18, 0x4e20000
    s_mov_b32 s19, 0x20000
    s_add_u32 s44, s33, 0x0
    buffer_load_dwordx4 v[16:19], v0, s[8:11], s44 offen nt
    s_add_u32 s45, s33, 0x0
    buffer_load_dwordx4 v[20:23], v0, s[12:15], s45 offen nt
    s_add_u32 s46, s34, 0x0
    buffer_load_dwordx2 v[24:25], v1, s[16:19], s46 offen nt
    s_add_u32 s47, s34, 0x200000
    buffer_load_dwordx2 v[26:27], v1, s[16:19], s47 offen nt
    s_add_u32 s44, s33, 0x400000
    buffer_load_dwordx4 v[28:31], v0, s[8:11], s44 offen nt
    s_add_u32 s45, s33, 0x400000
    buffer_load_dwordx4 v[32:35], v0, s[12:15], s45 offen nt
    s_add_u32 s46, s33, 0x800000
    buffer_load_dwordx4 v[36:39], v0, s[8:11], s46 offen nt
    s_add_u32 s47, s33, 0x800000
    buffer_load_dwordx4 v[40:43], v0, s[12:15], s47 offen nt
    s_add_u32 s44, s34, 0x400000
    buffer_load_dwordx2 v[44:45], v1, s[16:19], s44 offen nt
    s_add_u32 s45, s34, 0x600000
    buffer_load_dwordx2 v[46:47], v1, s[16:19], s45 offen nt
    s_mov_b32 s68, s62
    s_mov_b32 s69, s63
    s_mov_b32 s70, 0x40
    s_mov_b32 s71, 0x20000
    s_mov_b32 s72, s60
    s_mov_b32 s73, s61
    s_mov_b32 s74, 0x40
    s_mov_b32 s75, 0x20000
    s_mov_b32 s20, s66
    s_mov_b32 s21, s67
    s_mov_b32 s22, 0x20
    s_mov_b32 s23, 0x20000
    s_mov_b32 s80, s64
    s_mov_b32 s81, s65
    s_mov_b32 s82, 0x20
    s_mov_b32 s83, 0x20000
    s_add_u32 s24, s30, 0xebc9000
    s_addc_u32 s25, s31, 0
    s_mov_b32 s26, 0x100
    s_mov_b32 s27, 0x20000
    v_lshrrev_b32 v2, 3, v0
    v_and_b32 v2, 6, v2
    v_lshlrev_b32 v3, 2, v0
    s_lshl_b32 s3, s32, 8
    s_add_u32 s3, s3, s2
    s_cmp_lg_u32 s3, 254
    s_cbranch_scc1 L1_wt
    buffer_load_ushort v96, v2, s[68:71], 0 offen offset:0
    buffer_load_ushort v108, v2, s[68:71], 0 offen offset:8
    buffer_load_ushort v97, v2, s[68:71], 0 offen offset:16
    buffer_load_ushort v109, v2, s[68:71], 0 offen offset:24
    buffer_load_ushort v98, v2, s[68:71], 0 offen offset:32
    buffer_load_ushort v110, v2, s[68:71], 0 offen offset:40
    buffer_load_ushort v99, v2, s[68:71], 0 offen offset:48
    buffer_load_ushort v111, v2, s[68:71], 0 offen offset:56
    buffer_load_ushort v100, v2, s[72:75], 0 offen offset:0
    buffer_load_ushort v112, v2, s[72:75], 0 offen offset:8
    buffer_load_ushort v101, v2, s[72:75], 0 offen offset:16
    buffer_load_ushort v113, v2, s[72:75], 0 offen offset:24
    buffer_load_ushort v102, v2, s[72:75], 0 offen offset:32
    buffer_load_ushort v114, v2, s[72:75], 0 offen offset:40
    buffer_load_ushort v103, v2, s[72:75], 0 offen offset:48
    buffer_load_ushort v115, v2, s[72:75], 0 offen offset:56
    buffer_load_ushort v104, v2, s[20:23], 0 offen offset:0
    buffer_load_ushort v116, v2, s[20:23], 0 offen offset:8
    buffer_load_ushort v105, v2, s[20:23], 0 offen offset:16
    buffer_load_ushort v117, v2, s[20:23], 0 offen offset:24
    buffer_load_ushort v106, v2, s[80:83], 0 offen offset:0
    buffer_load_ushort v118, v2, s[80:83], 0 offen offset:8
    buffer_load_ushort v107, v2, s[80:83], 0 offen offset:16
    buffer_load_ushort v119, v2, s[80:83], 0 offen offset:24
    s_waitcnt vmcnt(0)
    v_lshl_or_b32 v96, v108, 16, v96
    v_lshl_or_b32 v97, v109, 16, v97
    v_lshl_or_b32 v98, v110, 16, v98
    v_lshl_or_b32 v99, v111, 16, v99
    v_lshl_or_b32 v100, v112, 16, v100
    v_lshl_or_b32 v101, v113, 16, v101
    v_lshl_or_b32 v102, v114, 16, v102
    v_lshl_or_b32 v103, v115, 16, v103
    v_lshl_or_b32 v104, v116, 16, v104
    v_lshl_or_b32 v105, v117, 16, v105
    v_lshl_or_b32 v106, v118, 16, v106
    v_lshl_or_b32 v107, v119, 16, v107
    buffer_store_dwordx4 v[96:99], v3, s[24:27], 0 offen offset:0 sc1
    buffer_store_dwordx4 v[100:103], v3, s[24:27], 0 offen offset:16 sc1
    buffer_store_dwordx4 v[104:107], v3, s[24:27], 0 offen offset:32 sc1
L1_wt:
    s_mov_b32 s20, s30
    s_mov_b32 s21, s31
    s_mov_b32 s22, 0xd340000
    s_mov_b32 s23, 0x20000
    s_add_u32 s24, s30, 0x28000
    s_addc_u32 s25, s31, 0
    s_mov_b32 s26, 0xd318000
    s_mov_b32 s27, 0x20000
    s_mov_b32 s80, s86
    s_mov_b32 s81, s87
    s_mov_b32 s82, 0x4e2000
    s_mov_b32 s83, 0x20000
    s_mul_i32 s35, s2, 173056
    s_and_b32 s37, s32, 3
    s_lshl_b32 s37, s37, 3
    s_mov_b32 s36, s37
    s_lshr_b32 s37, s32, 2
    s_mul_i32 s37, s37, 2080
    s_add_u32 s36, s36, s37
    s_and_b32 s37, s2, 3
    s_lshl_b32 s37, s37, 5
    s_add_u32 s36, s36, s37
    s_mul_i32 s4, s2, 5
    s_add_u32 s4, s4, 8192
    s_lshl_b32 s38, s4, 14
    s_lshl_b32 s39, s4, 13
    v_mov_b32 v2, 1
    v_mov_b32 v4, 0x80000007
    v_mov_b32 v5, 0xfc
    v_mov_b32 v6, 0x78
    s_mov_b32 s40, 16512
    s_mov_b32 s55, -10000
    s_mov_b32 s41, 0x010c0c01
    s_mov_b32 s42, 0x030c0c03
    v_mov_b32 v8, 0
    v_mov_b32 v9, 0
    v_mov_b32 v10, 0
    v_mov_b32 v11, 0
    ds_write_b128 v0, v[8:11]
    s_add_u32 s68, s30, 0xebca000
    s_addc_u32 s69, s31, 0
    s_mov_b32 s70, 0x80
    s_mov_b32 s71, 0x20000
    s_lshl_b32 s3, s2, 7
    s_add_u32 s68, s68, s3
    s_addc_u32 s69, s69, 0
    s_cmp_lg_u32 s32, 0
    s_cbranch_scc1 L1_fl
    buffer_store_dwordx4 v[8:11], v0, s[68:71], 0 offen sc1
L1_fl:
    s_waitcnt lgkmcnt(0)
    s_barrier
    s_setprio 3
    s_add_u32 s46, s33, 0xc00000
    buffer_load_dwordx4 v[48:51], v0, s[8:11], s46 offen nt
    s_add_u32 s47, s33, 0xc00000
    buffer_load_dwordx4 v[52:55], v0, s[12:15], s47 offen nt
    s_waitcnt vmcnt(8)
    v_lshlrev_b32 v7, 16, v24
    v_and_b32 v8, 0xffff0000, v24
    v_lshlrev_b32 v9, 16, v25
    v_and_b32 v10, 0xffff0000, v25
    v_mul_f32 v7, 0.15915494, v7
    v_mul_f32 v8, 0.15915494, v8
    v_mul_f32 v9, 0.15915494, v9
    v_mul_f32 v10, 0.15915494, v10
    v_mul_hi_u32_u24 v14, 429497, v16
    v_lshrrev_b32 v12, 3, v20
    v_cos_f32 v7, v7
    v_lshlrev_b16 v13, 3, v20
    v_mad_i32_i24 v11, v14, s55, v16
    v_bitop3_b32 v12, v6, v13, v12 bitop3:0xca
    v_lshl_add_u32 v11, v11, 17, s40
    v_lshlrev_b16 v14, 8, v14
    v_lshrrev_b32 v13, 2, v20
    v_add_u32 v16, v12, v11
    v_bitop3_b32 v20, v5, v13, v14 bitop3:0xea
    ds_add_u32 v20, v2
    v_mul_hi_u32_u24 v14, 429497, v17
    v_lshrrev_b32 v12, 3, v21
    v_cos_f32 v8, v8
    v_lshlrev_b16 v13, 3, v21
    v_mad_i32_i24 v11, v14, s55, v17
    v_bitop3_b32 v12, v6, v13, v12 bitop3:0xca
    v_lshl_add_u32 v11, v11, 17, s40
    v_lshlrev_b16 v14, 8, v14
    v_lshrrev_b32 v13, 2, v21
    v_add_u32 v17, v12, v11
    v_bitop3_b32 v21, v5, v13, v14 bitop3:0xea
    ds_add_u32 v21, v2
    v_cvt_pk_bf16_f32 v24, v7, v8
    v_perm_b32 v12, v24, v24, s41
    v_bitop3_b32 v16, v4, v12, v16 bitop3:0xca
    v_perm_b32 v13, v24, v24, s42
    v_bitop3_b32 v17, v4, v13, v17 bitop3:0xca
    v_mul_hi_u32_u24 v14, 429497, v18
    v_lshrrev_b32 v12, 3, v22
    v_cos_f32 v9, v9
    v_lshlrev_b16 v13, 3, v22
    v_mad_i32_i24 v11, v14, s55, v18
    v_bitop3_b32 v12, v6, v13, v12 bitop3:0xca
    v_lshl_add_u32 v11, v11, 17, s40
    v_lshlrev_b16 v14, 8, v14
    v_lshrrev_b32 v13, 2, v22
    v_add_u32 v18, v12, v11
    v_bitop3_b32 v22, v5, v13, v14 bitop3:0xea
    ds_add_u32 v22, v2
    v_mul_hi_u32_u24 v14, 429497, v19
    v_lshrrev_b32 v12, 3, v23
    v_cos_f32 v10, v10
    v_lshlrev_b16 v13, 3, v23
    v_mad_i32_i24 v11, v14, s55, v19
    v_bitop3_b32 v12, v6, v13, v12 bitop3:0xca
    v_lshl_add_u32 v11, v11, 17, s40
    v_lshlrev_b16 v14, 8, v14
    v_lshrrev_b32 v13, 2, v23
    v_add_u32 v19, v12, v11
    v_bitop3_b32 v23, v5, v13, v14 bitop3:0xea
    ds_add_u32 v23, v2
    v_cvt_pk_bf16_f32 v25, v9, v10
    v_perm_b32 v12, v25, v25, s41
    v_bitop3_b32 v18, v4, v12, v18 bitop3:0xca
    v_perm_b32 v13, v25, v25, s42
    v_bitop3_b32 v19, v4, v13, v19 bitop3:0xca
    s_add_u32 s44, s33, 0x1000000
    buffer_load_dwordx4 v[56:59], v0, s[8:11], s44 offen nt
    s_add_u32 s45, s33, 0x1000000
    buffer_load_dwordx4 v[60:63], v0, s[12:15], s45 offen nt
    s_add_u32 s46, s34, 0x800000
    buffer_load_dwordx2 v[64:65], v1, s[16:19], s46 offen nt
    s_add_u32 s47, s34, 0xa00000
    buffer_load_dwordx2 v[66:67], v1, s[16:19], s47 offen nt
    s_waitcnt vmcnt(10)
    v_lshlrev_b32 v7, 16, v26
    v_and_b32 v8, 0xffff0000, v26
    v_lshlrev_b32 v9, 16, v27
    v_and_b32 v10, 0xffff0000, v27
    v_mul_f32 v7, 0.15915494, v7
    v_mul_f32 v8, 0.15915494, v8
    v_mul_f32 v9, 0.15915494, v9
    v_mul_f32 v10, 0.15915494, v10
    v_mul_hi_u32_u24 v14, 429497, v28
    v_lshrrev_b32 v12, 3, v32
    v_cos_f32 v7, v7
    v_lshlrev_b16 v13, 3, v32
    v_mad_i32_i24 v11, v14, s55, v28
    v_bitop3_b32 v12, v6, v13, v12 bitop3:0xca
    v_lshl_add_u32 v11, v11, 17, s40
    v_lshlrev_b16 v14, 8, v14
    v_lshrrev_b32 v13, 2, v32
    v_add_u32 v28, v12, v11
    v_bitop3_b32 v32, v5, v13, v14 bitop3:0xea
    ds_add_u32 v32, v2
    v_mul_hi_u32_u24 v14, 429497, v29
    v_lshrrev_b32 v12, 3, v33
    v_cos_f32 v8, v8
    v_lshlrev_b16 v13, 3, v33
    v_mad_i32_i24 v11, v14, s55, v29
    v_bitop3_b32 v12, v6, v13, v12 bitop3:0xca
    v_lshl_add_u32 v11, v11, 17, s40
    v_lshlrev_b16 v14, 8, v14
    v_lshrrev_b32 v13, 2, v33
    v_add_u32 v29, v12, v11
    v_bitop3_b32 v33, v5, v13, v14 bitop3:0xea
    ds_add_u32 v33, v2
    v_cvt_pk_bf16_f32 v26, v7, v8
    v_perm_b32 v12, v26, v26, s41
    v_bitop3_b32 v28, v4, v12, v28 bitop3:0xca
    v_perm_b32 v13, v26, v26, s42
    v_bitop3_b32 v29, v4, v13, v29 bitop3:0xca
    v_mul_hi_u32_u24 v14, 429497, v30
    v_lshrrev_b32 v12, 3, v34
    v_cos_f32 v9, v9
    v_lshlrev_b16 v13, 3, v34
    v_mad_i32_i24 v11, v14, s55, v30
    v_bitop3_b32 v12, v6, v13, v12 bitop3:0xca
    v_lshl_add_u32 v11, v11, 17, s40
    v_lshlrev_b16 v14, 8, v14
    v_lshrrev_b32 v13, 2, v34
    v_add_u32 v30, v12, v11
    v_bitop3_b32 v34, v5, v13, v14 bitop3:0xea
    ds_add_u32 v34, v2
    v_mul_hi_u32_u24 v14, 429497, v31
    v_lshrrev_b32 v12, 3, v35
    v_cos_f32 v10, v10
    v_lshlrev_b16 v13, 3, v35
    v_mad_i32_i24 v11, v14, s55, v31
    v_bitop3_b32 v12, v6, v13, v12 bitop3:0xca
    v_lshl_add_u32 v11, v11, 17, s40
    v_lshlrev_b16 v14, 8, v14
    v_lshrrev_b32 v13, 2, v35
    v_add_u32 v31, v12, v11
    v_bitop3_b32 v35, v5, v13, v14 bitop3:0xea
    ds_add_u32 v35, v2
    v_cvt_pk_bf16_f32 v27, v9, v10
    v_perm_b32 v12, v27, v27, s41
    v_bitop3_b32 v30, v4, v12, v30 bitop3:0xca
    v_perm_b32 v13, v27, v27, s42
    v_bitop3_b32 v31, v4, v13, v31 bitop3:0xca
    s_setprio 2
    s_add_u32 s44, s33, 0x1400000
    buffer_load_dwordx4 v[68:71], v0, s[8:11], s44 offen nt
    s_add_u32 s45, s33, 0x1400000
    buffer_load_dwordx4 v[72:75], v0, s[12:15], s45 offen nt
    s_waitcnt vmcnt(8)
    v_lshlrev_b32 v7, 16, v44
    v_and_b32 v8, 0xffff0000, v44
    v_lshlrev_b32 v9, 16, v45
    v_and_b32 v10, 0xffff0000, v45
    v_mul_f32 v7, 0.15915494, v7
    v_mul_f32 v8, 0.15915494, v8
    v_mul_f32 v9, 0.15915494, v9
    v_mul_f32 v10, 0.15915494, v10
    v_mul_hi_u32_u24 v14, 429497, v36
    v_lshrrev_b32 v12, 3, v40
    v_cos_f32 v7, v7
    v_lshlrev_b16 v13, 3, v40
    v_mad_i32_i24 v11, v14, s55, v36
    v_bitop3_b32 v12, v6, v13, v12 bitop3:0xca
    v_lshl_add_u32 v11, v11, 17, s40
    v_lshlrev_b16 v14, 8, v14
    v_lshrrev_b32 v13, 2, v40
    v_add_u32 v36, v12, v11
    v_bitop3_b32 v40, v5, v13, v14 bitop3:0xea
    ds_add_u32 v40, v2
    v_mul_hi_u32_u24 v14, 429497, v37
    v_lshrrev_b32 v12, 3, v41
    v_cos_f32 v8, v8
    v_lshlrev_b16 v13, 3, v41
    v_mad_i32_i24 v11, v14, s55, v37
    v_bitop3_b32 v12, v6, v13, v12 bitop3:0xca
    v_lshl_add_u32 v11, v11, 17, s40
    v_lshlrev_b16 v14, 8, v14
    v_lshrrev_b32 v13, 2, v41
    v_add_u32 v37, v12, v11
    v_bitop3_b32 v41, v5, v13, v14 bitop3:0xea
    ds_add_u32 v41, v2
    v_cvt_pk_bf16_f32 v44, v7, v8
    v_perm_b32 v12, v44, v44, s41
    v_bitop3_b32 v36, v4, v12, v36 bitop3:0xca
    v_perm_b32 v13, v44, v44, s42
    v_bitop3_b32 v37, v4, v13, v37 bitop3:0xca
    v_mul_hi_u32_u24 v14, 429497, v38
    v_lshrrev_b32 v12, 3, v42
    v_cos_f32 v9, v9
    v_lshlrev_b16 v13, 3, v42
    v_mad_i32_i24 v11, v14, s55, v38
    v_bitop3_b32 v12, v6, v13, v12 bitop3:0xca
    v_lshl_add_u32 v11, v11, 17, s40
    v_lshlrev_b16 v14, 8, v14
    v_lshrrev_b32 v13, 2, v42
    v_add_u32 v38, v12, v11
    v_bitop3_b32 v42, v5, v13, v14 bitop3:0xea
    ds_add_u32 v42, v2
    v_mul_hi_u32_u24 v14, 429497, v39
    v_lshrrev_b32 v12, 3, v43
    v_cos_f32 v10, v10
    v_lshlrev_b16 v13, 3, v43
    v_mad_i32_i24 v11, v14, s55, v39
    v_bitop3_b32 v12, v6, v13, v12 bitop3:0xca
    v_lshl_add_u32 v11, v11, 17, s40
    v_lshlrev_b16 v14, 8, v14
    v_lshrrev_b32 v13, 2, v43
    v_add_u32 v39, v12, v11
    v_bitop3_b32 v43, v5, v13, v14 bitop3:0xea
    ds_add_u32 v43, v2
    v_cvt_pk_bf16_f32 v45, v9, v10
    v_perm_b32 v12, v45, v45, s41
    v_bitop3_b32 v38, v4, v12, v38 bitop3:0xca
    v_perm_b32 v13, v45, v45, s42
    v_bitop3_b32 v39, v4, v13, v39 bitop3:0xca
    s_add_u32 s46, s33, 0x1800000
    buffer_load_dwordx4 v[76:79], v0, s[8:11], s46 offen nt
    s_add_u32 s47, s33, 0x1800000
    buffer_load_dwordx4 v[80:83], v0, s[12:15], s47 offen nt
    s_add_u32 s44, s34, 0xc00000
    buffer_load_dwordx2 v[84:85], v1, s[16:19], s44 offen nt
    s_add_u32 s45, s34, 0xe00000
    buffer_load_dwordx2 v[86:87], v1, s[16:19], s45 offen nt
    s_waitcnt vmcnt(10)
    v_lshlrev_b32 v7, 16, v46
    v_and_b32 v8, 0xffff0000, v46
    v_lshlrev_b32 v9, 16, v47
    v_and_b32 v10, 0xffff0000, v47
    v_mul_f32 v7, 0.15915494, v7
    v_mul_f32 v8, 0.15915494, v8
    v_mul_f32 v9, 0.15915494, v9
    v_mul_f32 v10, 0.15915494, v10
    v_mul_hi_u32_u24 v14, 429497, v48
    v_lshrrev_b32 v12, 3, v52
    v_cos_f32 v7, v7
    v_lshlrev_b16 v13, 3, v52
    v_mad_i32_i24 v11, v14, s55, v48
    v_bitop3_b32 v12, v6, v13, v12 bitop3:0xca
    v_lshl_add_u32 v11, v11, 17, s40
    v_lshlrev_b16 v14, 8, v14
    v_lshrrev_b32 v13, 2, v52
    v_add_u32 v48, v12, v11
    v_bitop3_b32 v52, v5, v13, v14 bitop3:0xea
    ds_add_u32 v52, v2
    v_mul_hi_u32_u24 v14, 429497, v49
    v_lshrrev_b32 v12, 3, v53
    v_cos_f32 v8, v8
    v_lshlrev_b16 v13, 3, v53
    v_mad_i32_i24 v11, v14, s55, v49
    v_bitop3_b32 v12, v6, v13, v12 bitop3:0xca
    v_lshl_add_u32 v11, v11, 17, s40
    v_lshlrev_b16 v14, 8, v14
    v_lshrrev_b32 v13, 2, v53
    v_add_u32 v49, v12, v11
    v_bitop3_b32 v53, v5, v13, v14 bitop3:0xea
    ds_add_u32 v53, v2
    v_cvt_pk_bf16_f32 v46, v7, v8
    v_perm_b32 v12, v46, v46, s41
    v_bitop3_b32 v48, v4, v12, v48 bitop3:0xca
    v_perm_b32 v13, v46, v46, s42
    v_bitop3_b32 v49, v4, v13, v49 bitop3:0xca
    v_mul_hi_u32_u24 v14, 429497, v50
    v_lshrrev_b32 v12, 3, v54
    v_cos_f32 v9, v9
    v_lshlrev_b16 v13, 3, v54
    v_mad_i32_i24 v11, v14, s55, v50
    v_bitop3_b32 v12, v6, v13, v12 bitop3:0xca
    v_lshl_add_u32 v11, v11, 17, s40
    v_lshlrev_b16 v14, 8, v14
    v_lshrrev_b32 v13, 2, v54
    v_add_u32 v50, v12, v11
    v_bitop3_b32 v54, v5, v13, v14 bitop3:0xea
    ds_add_u32 v54, v2
    v_mul_hi_u32_u24 v14, 429497, v51
    v_lshrrev_b32 v12, 3, v55
    v_cos_f32 v10, v10
    v_lshlrev_b16 v13, 3, v55
    v_mad_i32_i24 v11, v14, s55, v51
    v_bitop3_b32 v12, v6, v13, v12 bitop3:0xca
    v_lshl_add_u32 v11, v11, 17, s40
    v_lshlrev_b16 v14, 8, v14
    v_lshrrev_b32 v13, 2, v55
    v_add_u32 v51, v12, v11
    v_bitop3_b32 v55, v5, v13, v14 bitop3:0xea
    ds_add_u32 v55, v2
    v_cvt_pk_bf16_f32 v47, v9, v10
    v_perm_b32 v12, v47, v47, s41
    v_bitop3_b32 v50, v4, v12, v50 bitop3:0xca
    v_perm_b32 v13, v47, v47, s42
    v_bitop3_b32 v51, v4, v13, v51 bitop3:0xca
    s_setprio 1
    s_add_u32 s46, s33, 0x1c00000
    buffer_load_dwordx4 v[88:91], v0, s[8:11], s46 offen nt
    s_add_u32 s47, s33, 0x1c00000
    buffer_load_dwordx4 v[92:95], v0, s[12:15], s47 offen nt
    s_waitcnt vmcnt(8)
    v_lshlrev_b32 v7, 16, v64
    v_and_b32 v8, 0xffff0000, v64
    v_lshlrev_b32 v9, 16, v65
    v_and_b32 v10, 0xffff0000, v65
    v_mul_f32 v7, 0.15915494, v7
    v_mul_f32 v8, 0.15915494, v8
    v_mul_f32 v9, 0.15915494, v9
    v_mul_f32 v10, 0.15915494, v10
    v_mul_hi_u32_u24 v14, 429497, v56
    v_lshrrev_b32 v12, 3, v60
    v_cos_f32 v7, v7
    v_lshlrev_b16 v13, 3, v60
    v_mad_i32_i24 v11, v14, s55, v56
    v_bitop3_b32 v12, v6, v13, v12 bitop3:0xca
    v_lshl_add_u32 v11, v11, 17, s40
    v_lshlrev_b16 v14, 8, v14
    v_lshrrev_b32 v13, 2, v60
    v_add_u32 v56, v12, v11
    v_bitop3_b32 v60, v5, v13, v14 bitop3:0xea
    ds_add_u32 v60, v2
    v_mul_hi_u32_u24 v14, 429497, v57
    v_lshrrev_b32 v12, 3, v61
    v_cos_f32 v8, v8
    v_lshlrev_b16 v13, 3, v61
    v_mad_i32_i24 v11, v14, s55, v57
    v_bitop3_b32 v12, v6, v13, v12 bitop3:0xca
    v_lshl_add_u32 v11, v11, 17, s40
    v_lshlrev_b16 v14, 8, v14
    v_lshrrev_b32 v13, 2, v61
    v_add_u32 v57, v12, v11
    v_bitop3_b32 v61, v5, v13, v14 bitop3:0xea
    ds_add_u32 v61, v2
    v_cvt_pk_bf16_f32 v64, v7, v8
    v_perm_b32 v12, v64, v64, s41
    v_bitop3_b32 v56, v4, v12, v56 bitop3:0xca
    v_perm_b32 v13, v64, v64, s42
    v_bitop3_b32 v57, v4, v13, v57 bitop3:0xca
    v_mul_hi_u32_u24 v14, 429497, v58
    v_lshrrev_b32 v12, 3, v62
    v_cos_f32 v9, v9
    v_lshlrev_b16 v13, 3, v62
    v_mad_i32_i24 v11, v14, s55, v58
    v_bitop3_b32 v12, v6, v13, v12 bitop3:0xca
    v_lshl_add_u32 v11, v11, 17, s40
    v_lshlrev_b16 v14, 8, v14
    v_lshrrev_b32 v13, 2, v62
    v_add_u32 v58, v12, v11
    v_bitop3_b32 v62, v5, v13, v14 bitop3:0xea
    ds_add_u32 v62, v2
    v_mul_hi_u32_u24 v14, 429497, v59
    v_lshrrev_b32 v12, 3, v63
    v_cos_f32 v10, v10
    v_lshlrev_b16 v13, 3, v63
    v_mad_i32_i24 v11, v14, s55, v59
    v_bitop3_b32 v12, v6, v13, v12 bitop3:0xca
    v_lshl_add_u32 v11, v11, 17, s40
    v_lshlrev_b16 v14, 8, v14
    v_lshrrev_b32 v13, 2, v63
    v_add_u32 v59, v12, v11
    v_bitop3_b32 v63, v5, v13, v14 bitop3:0xea
    ds_add_u32 v63, v2
    v_cvt_pk_bf16_f32 v65, v9, v10
    v_perm_b32 v12, v65, v65, s41
    v_bitop3_b32 v58, v4, v12, v58 bitop3:0xca
    v_perm_b32 v13, v65, v65, s42
    v_bitop3_b32 v59, v4, v13, v59 bitop3:0xca
    s_add_u32 s44, s33, 0x2000000
    buffer_load_dwordx4 v[96:99], v0, s[8:11], s44 offen nt
    s_add_u32 s45, s33, 0x2000000
    buffer_load_dwordx4 v[100:103], v0, s[12:15], s45 offen nt
    s_add_u32 s46, s34, 0x1000000
    buffer_load_dwordx2 v[104:105], v1, s[16:19], s46 offen nt
    s_add_u32 s47, s34, 0x1200000
    buffer_load_dwordx2 v[106:107], v1, s[16:19], s47 offen nt
    s_waitcnt vmcnt(10)
    v_lshlrev_b32 v7, 16, v66
    v_and_b32 v8, 0xffff0000, v66
    v_lshlrev_b32 v9, 16, v67
    v_and_b32 v10, 0xffff0000, v67
    v_mul_f32 v7, 0.15915494, v7
    v_mul_f32 v8, 0.15915494, v8
    v_mul_f32 v9, 0.15915494, v9
    v_mul_f32 v10, 0.15915494, v10
    v_mul_hi_u32_u24 v14, 429497, v68
    v_lshrrev_b32 v12, 3, v72
    v_cos_f32 v7, v7
    v_lshlrev_b16 v13, 3, v72
    v_mad_i32_i24 v11, v14, s55, v68
    v_bitop3_b32 v12, v6, v13, v12 bitop3:0xca
    v_lshl_add_u32 v11, v11, 17, s40
    v_lshlrev_b16 v14, 8, v14
    v_lshrrev_b32 v13, 2, v72
    v_add_u32 v68, v12, v11
    v_bitop3_b32 v72, v5, v13, v14 bitop3:0xea
    ds_add_u32 v72, v2
    v_mul_hi_u32_u24 v14, 429497, v69
    v_lshrrev_b32 v12, 3, v73
    v_cos_f32 v8, v8
    v_lshlrev_b16 v13, 3, v73
    v_mad_i32_i24 v11, v14, s55, v69
    v_bitop3_b32 v12, v6, v13, v12 bitop3:0xca
    v_lshl_add_u32 v11, v11, 17, s40
    v_lshlrev_b16 v14, 8, v14
    v_lshrrev_b32 v13, 2, v73
    v_add_u32 v69, v12, v11
    v_bitop3_b32 v73, v5, v13, v14 bitop3:0xea
    ds_add_u32 v73, v2
    v_cvt_pk_bf16_f32 v66, v7, v8
    v_perm_b32 v12, v66, v66, s41
    v_bitop3_b32 v68, v4, v12, v68 bitop3:0xca
    v_perm_b32 v13, v66, v66, s42
    v_bitop3_b32 v69, v4, v13, v69 bitop3:0xca
    v_mul_hi_u32_u24 v14, 429497, v70
    v_lshrrev_b32 v12, 3, v74
    v_cos_f32 v9, v9
    v_lshlrev_b16 v13, 3, v74
    v_mad_i32_i24 v11, v14, s55, v70
    v_bitop3_b32 v12, v6, v13, v12 bitop3:0xca
    v_lshl_add_u32 v11, v11, 17, s40
    v_lshlrev_b16 v14, 8, v14
    v_lshrrev_b32 v13, 2, v74
    v_add_u32 v70, v12, v11
    v_bitop3_b32 v74, v5, v13, v14 bitop3:0xea
    ds_add_u32 v74, v2
    v_mul_hi_u32_u24 v14, 429497, v71
    v_lshrrev_b32 v12, 3, v75
    v_cos_f32 v10, v10
    v_lshlrev_b16 v13, 3, v75
    v_mad_i32_i24 v11, v14, s55, v71
    v_bitop3_b32 v12, v6, v13, v12 bitop3:0xca
    v_lshl_add_u32 v11, v11, 17, s40
    v_lshlrev_b16 v14, 8, v14
    v_lshrrev_b32 v13, 2, v75
    v_add_u32 v71, v12, v11
    v_bitop3_b32 v75, v5, v13, v14 bitop3:0xea
    ds_add_u32 v75, v2
    v_cvt_pk_bf16_f32 v67, v9, v10
    v_perm_b32 v12, v67, v67, s41
    v_bitop3_b32 v70, v4, v12, v70 bitop3:0xca
    v_perm_b32 v13, v67, v67, s42
    v_bitop3_b32 v71, v4, v13, v71 bitop3:0xca
    s_setprio 0
    s_add_u32 s44, s33, 0x2400000
    buffer_load_dwordx4 v[108:111], v0, s[8:11], s44 offen nt
    s_waitcnt vmcnt(7)
    v_lshlrev_b32 v7, 16, v84
    v_and_b32 v8, 0xffff0000, v84
    v_lshlrev_b32 v9, 16, v85
    v_and_b32 v10, 0xffff0000, v85
    v_mul_f32 v7, 0.15915494, v7
    v_mul_f32 v8, 0.15915494, v8
    v_mul_f32 v9, 0.15915494, v9
    v_mul_f32 v10, 0.15915494, v10
    v_mul_hi_u32_u24 v14, 429497, v76
    v_lshrrev_b32 v12, 3, v80
    v_cos_f32 v7, v7
    v_lshlrev_b16 v13, 3, v80
    v_mad_i32_i24 v11, v14, s55, v76
    v_bitop3_b32 v12, v6, v13, v12 bitop3:0xca
    v_lshl_add_u32 v11, v11, 17, s40
    v_lshlrev_b16 v14, 8, v14
    v_lshrrev_b32 v13, 2, v80
    v_add_u32 v76, v12, v11
    v_bitop3_b32 v80, v5, v13, v14 bitop3:0xea
    ds_add_u32 v80, v2
    v_mul_hi_u32_u24 v14, 429497, v77
    v_lshrrev_b32 v12, 3, v81
    v_cos_f32 v8, v8
    v_lshlrev_b16 v13, 3, v81
    v_mad_i32_i24 v11, v14, s55, v77
    v_bitop3_b32 v12, v6, v13, v12 bitop3:0xca
    v_lshl_add_u32 v11, v11, 17, s40
    v_lshlrev_b16 v14, 8, v14
    v_lshrrev_b32 v13, 2, v81
    v_add_u32 v77, v12, v11
    v_bitop3_b32 v81, v5, v13, v14 bitop3:0xea
    ds_add_u32 v81, v2
    v_cvt_pk_bf16_f32 v84, v7, v8
    v_perm_b32 v12, v84, v84, s41
    v_bitop3_b32 v76, v4, v12, v76 bitop3:0xca
    v_perm_b32 v13, v84, v84, s42
    v_bitop3_b32 v77, v4, v13, v77 bitop3:0xca
    v_mul_hi_u32_u24 v14, 429497, v78
    v_lshrrev_b32 v12, 3, v82
    v_cos_f32 v9, v9
    v_lshlrev_b16 v13, 3, v82
    v_mad_i32_i24 v11, v14, s55, v78
    v_bitop3_b32 v12, v6, v13, v12 bitop3:0xca
    v_lshl_add_u32 v11, v11, 17, s40
    v_lshlrev_b16 v14, 8, v14
    v_lshrrev_b32 v13, 2, v82
    v_add_u32 v78, v12, v11
    v_bitop3_b32 v82, v5, v13, v14 bitop3:0xea
    ds_add_u32 v82, v2
    v_mul_hi_u32_u24 v14, 429497, v79
    v_lshrrev_b32 v12, 3, v83
    v_cos_f32 v10, v10
    v_lshlrev_b16 v13, 3, v83
    v_mad_i32_i24 v11, v14, s55, v79
    v_bitop3_b32 v12, v6, v13, v12 bitop3:0xca
    v_lshl_add_u32 v11, v11, 17, s40
    v_lshlrev_b16 v14, 8, v14
    v_lshrrev_b32 v13, 2, v83
    v_add_u32 v79, v12, v11
    v_bitop3_b32 v83, v5, v13, v14 bitop3:0xea
    ds_add_u32 v83, v2
    v_cvt_pk_bf16_f32 v85, v9, v10
    v_perm_b32 v12, v85, v85, s41
    v_bitop3_b32 v78, v4, v12, v78 bitop3:0xca
    v_perm_b32 v13, v85, v85, s42
    v_bitop3_b32 v79, v4, v13, v79 bitop3:0xca
    s_waitcnt vmcnt(5)
    v_lshlrev_b32 v7, 16, v86
    v_and_b32 v8, 0xffff0000, v86
    v_lshlrev_b32 v9, 16, v87
    v_and_b32 v10, 0xffff0000, v87
    v_mul_f32 v7, 0.15915494, v7
    v_mul_f32 v8, 0.15915494, v8
    v_mul_f32 v9, 0.15915494, v9
    v_mul_f32 v10, 0.15915494, v10
    v_mul_hi_u32_u24 v14, 429497, v88
    v_lshrrev_b32 v12, 3, v92
    v_cos_f32 v7, v7
    v_lshlrev_b16 v13, 3, v92
    v_mad_i32_i24 v11, v14, s55, v88
    v_bitop3_b32 v12, v6, v13, v12 bitop3:0xca
    v_lshl_add_u32 v11, v11, 17, s40
    v_lshlrev_b16 v14, 8, v14
    v_lshrrev_b32 v13, 2, v92
    v_add_u32 v88, v12, v11
    v_bitop3_b32 v92, v5, v13, v14 bitop3:0xea
    ds_add_u32 v92, v2
    v_mul_hi_u32_u24 v14, 429497, v89
    v_lshrrev_b32 v12, 3, v93
    v_cos_f32 v8, v8
    v_lshlrev_b16 v13, 3, v93
    v_mad_i32_i24 v11, v14, s55, v89
    v_bitop3_b32 v12, v6, v13, v12 bitop3:0xca
    v_lshl_add_u32 v11, v11, 17, s40
    v_lshlrev_b16 v14, 8, v14
    v_lshrrev_b32 v13, 2, v93
    v_add_u32 v89, v12, v11
    v_bitop3_b32 v93, v5, v13, v14 bitop3:0xea
    ds_add_u32 v93, v2
    v_cvt_pk_bf16_f32 v86, v7, v8
    v_perm_b32 v12, v86, v86, s41
    v_bitop3_b32 v88, v4, v12, v88 bitop3:0xca
    v_perm_b32 v13, v86, v86, s42
    v_bitop3_b32 v89, v4, v13, v89 bitop3:0xca
    v_mul_hi_u32_u24 v14, 429497, v90
    v_lshrrev_b32 v12, 3, v94
    v_cos_f32 v9, v9
    v_lshlrev_b16 v13, 3, v94
    v_mad_i32_i24 v11, v14, s55, v90
    v_bitop3_b32 v12, v6, v13, v12 bitop3:0xca
    v_lshl_add_u32 v11, v11, 17, s40
    v_lshlrev_b16 v14, 8, v14
    v_lshrrev_b32 v13, 2, v94
    v_add_u32 v90, v12, v11
    v_bitop3_b32 v94, v5, v13, v14 bitop3:0xea
    ds_add_u32 v94, v2
    v_mul_hi_u32_u24 v14, 429497, v91
    v_lshrrev_b32 v12, 3, v95
    v_cos_f32 v10, v10
    v_lshlrev_b16 v13, 3, v95
    v_mad_i32_i24 v11, v14, s55, v91
    v_bitop3_b32 v12, v6, v13, v12 bitop3:0xca
    v_lshl_add_u32 v11, v11, 17, s40
    v_lshlrev_b16 v14, 8, v14
    v_lshrrev_b32 v13, 2, v95
    v_add_u32 v91, v12, v11
    v_bitop3_b32 v95, v5, v13, v14 bitop3:0xea
    ds_add_u32 v95, v2
    v_cvt_pk_bf16_f32 v87, v9, v10
    v_perm_b32 v12, v87, v87, s41
    v_bitop3_b32 v90, v4, v12, v90 bitop3:0xca
    v_perm_b32 v13, v87, v87, s42
    v_bitop3_b32 v91, v4, v13, v91 bitop3:0xca
    v_lshrrev_b32 v8, 2, v0
    v_and_b32 v7, 0x3c00, v0
    v_bitop3_b32 v7, v5, v8, v7 bitop3:0xea
    s_waitcnt lgkmcnt(0)
    s_barrier
    ds_read2st64_b32 v[8:9], v7 offset0:0 offset1:1
    ds_read2st64_b32 v[10:11], v7 offset0:2 offset1:3
    s_add_u32 s45, s33, 0x2400000
    buffer_load_dwordx4 v[112:115], v0, s[12:15], s45 offen nt
    s_waitcnt lgkmcnt(0)
    v_lshl_or_b32 v12, v9, 16, v8
    v_lshl_or_b32 v13, v11, 16, v10
    v_mov_b32 v14, v12
    v_mov_b32 v15, v13
    s_nop 0
    v_add_u32_dpp v14, v14, v14 row_shr:1 row_mask:0xf bank_mask:0xf bound_ctrl:1
    v_add_u32_dpp v15, v15, v15 row_shr:1 row_mask:0xf bank_mask:0xf bound_ctrl:1
    s_nop 0
    v_add_u32_dpp v14, v14, v14 row_shr:2 row_mask:0xf bank_mask:0xf bound_ctrl:1
    v_add_u32_dpp v15, v15, v15 row_shr:2 row_mask:0xf bank_mask:0xf bound_ctrl:1
    s_nop 0
    v_add_u32_dpp v14, v14, v14 row_shr:4 row_mask:0xf bank_mask:0xf bound_ctrl:1
    v_add_u32_dpp v15, v15, v15 row_shr:4 row_mask:0xf bank_mask:0xf bound_ctrl:1
    s_nop 0
    v_add_u32_dpp v14, v14, v14 row_shr:8 row_mask:0xf bank_mask:0xf bound_ctrl:1
    v_add_u32_dpp v15, v15, v15 row_shr:8 row_mask:0xf bank_mask:0xf bound_ctrl:1
    s_nop 0
    v_add_u32_dpp v14, v14, v14 row_bcast:15 row_mask:0xa bank_mask:0xf
    v_add_u32_dpp v15, v15, v15 row_bcast:15 row_mask:0xa bank_mask:0xf
    s_nop 0
    v_add_u32_dpp v14, v14, v14 row_bcast:31 row_mask:0xc bank_mask:0xf
    v_add_u32_dpp v15, v15, v15 row_bcast:31 row_mask:0xc bank_mask:0xf
    v_readlane_b32 s48, v14, 63
    v_readlane_b32 s49, v15, 63
    s_lshl_b32 s54, s32, 2
    v_mov_b32 v8, s54
    s_and_b32 s50, s48, 0xffff
    s_lshr_b32 s51, s48, 16
    s_and_b32 s52, s49, 0xffff
    s_lshr_b32 s53, s49, 16
    s_add_u32 s51, s51, s50
    s_add_u32 s52, s52, s51
    s_add_u32 s53, s53, s52
    v_mov_b32 v9, s53
    s_mov_b64 exec, 1
    ds_write_b32 v8, v9 offset:16384
    s_mov_b64 exec, -1
    v_and_b32 v8, 60, v7
    s_waitcnt lgkmcnt(0)
    s_barrier
    ds_read_b32 v9, v8 offset:16384
    s_waitcnt lgkmcnt(0)
    v_add_u32_dpp v9, v9, v9 row_shr:1 row_mask:0xf bank_mask:0xf bound_ctrl:1
    s_nop 1
    v_add_u32_dpp v9, v9, v9 row_shr:2 row_mask:0xf bank_mask:0xf bound_ctrl:1
    s_nop 1
    v_add_u32_dpp v9, v9, v9 row_shr:4 row_mask:0xf bank_mask:0xf bound_ctrl:1
    s_nop 1
    v_add_u32_dpp v9, v9, v9 row_shr:8 row_mask:0xf bank_mask:0xf bound_ctrl:1
    s_nop 0
    v_readlane_b32 s54, v9, s32
    s_sub_u32 s54, s54, s53
    s_add_u32 s50, s50, s54
    s_add_u32 s51, s51, s54
    s_add_u32 s52, s52, s54
    s_pack_ll_b32_b16 s48, s54, s50
    s_pack_ll_b32_b16 s49, s51, s52
    v_add_u32 v14, s48, v14
    v_add_u32 v15, s49, v15
    v_sub_u32 v12, v14, v12
    v_sub_u32 v13, v15, v13
    v_and_b32 v8, 0xffff, v12
    v_lshrrev_b32 v9, 16, v12
    v_and_b32 v10, 0xffff, v13
    v_lshrrev_b32 v11, 16, v13
    ds_write2st64_b32 v7, v8, v9 offset0:0 offset1:1
    ds_write2st64_b32 v7, v10, v11 offset0:2 offset1:3
    v_and_b32 v8, 0x3f0, v0
    v_lshl_add_u32 v8, v8, 1, s36
    ds_write_b64 v8, v[12:13] offset:20480
    s_bitset0_b64 exec, 63
    s_not_b64 exec, exec
    ds_write_b64 v8, v[14:15] offset:20512
    s_mov_b64 exec, -1
    s_waitcnt lgkmcnt(0)
    s_barrier
    s_setprio 3
    ds_add_rtn_u32 v20, v20, v2
    ds_add_rtn_u32 v21, v21, v2
    ds_add_rtn_u32 v22, v22, v2
    ds_add_rtn_u32 v23, v23, v2
    ds_read_b128 v[12:15], v0 offset:20480
    v_cmp_gt_u32 vcc, 8448, v0
    ds_add_rtn_u32 v32, v32, v2
    ds_add_rtn_u32 v33, v33, v2
    ds_add_rtn_u32 v34, v34, v2
    ds_add_rtn_u32 v35, v35, v2
    s_setprio 2
    ds_add_rtn_u32 v40, v40, v2
    ds_add_rtn_u32 v41, v41, v2
    ds_add_rtn_u32 v42, v42, v2
    ds_add_rtn_u32 v43, v43, v2
    s_waitcnt lgkmcnt(8)
    s_cbranch_vccz L1_p1
    s_add_u32 s46, s35, 0x0
    s_mov_b64 exec, vcc
    buffer_store_dwordx4 v[12:15], v0, s[24:27], s46 offen sc1
    s_mov_b64 exec, -1
L1_p1:
    s_add_u32 s47, s33, 0x2800000
    buffer_load_dwordx4 v[116:119], v0, s[8:11], s47 offen nt
    ds_add_rtn_u32 v52, v52, v2
    ds_add_rtn_u32 v53, v53, v2
    ds_add_rtn_u32 v54, v54, v2
    ds_add_rtn_u32 v55, v55, v2
    s_setprio 1
    ds_add_rtn_u32 v60, v60, v2
    ds_add_rtn_u32 v61, v61, v2
    ds_add_rtn_u32 v62, v62, v2
    ds_add_rtn_u32 v63, v63, v2
    ds_add_rtn_u32 v72, v72, v2
    ds_add_rtn_u32 v73, v73, v2
    ds_add_rtn_u32 v74, v74, v2
    ds_add_rtn_u32 v75, v75, v2
    s_add_u32 s44, s33, 0x2800000
    buffer_load_dwordx4 v[120:123], v0, s[12:15], s44 offen nt
    s_setprio 0
    ds_add_rtn_u32 v80, v80, v2
    ds_add_rtn_u32 v81, v81, v2
    ds_add_rtn_u32 v82, v82, v2
    ds_add_rtn_u32 v83, v83, v2
    ds_add_rtn_u32 v92, v92, v2
    ds_add_rtn_u32 v93, v93, v2
    ds_add_rtn_u32 v94, v94, v2
    ds_add_rtn_u32 v95, v95, v2
    s_waitcnt lgkmcnt(0)
    s_barrier
    s_setprio 3
    v_and_b32 v7, -4, v20
    v_lshl_add_u32 v8, v20, 2, v7
    ds_write_b32 v8, v16
    v_lshl_add_u32 v7, v7, 2, v20
    ds_write_b8 v7, v24 offset:16
    v_and_b32 v9, -4, v21
    v_lshl_add_u32 v10, v21, 2, v9
    ds_write_b32 v10, v17
    v_lshl_add_u32 v9, v9, 2, v21
    ds_write_b8_d16_hi v9, v24 offset:16
    v_and_b32 v7, -4, v22
    v_lshl_add_u32 v8, v22, 2, v7
    ds_write_b32 v8, v18
    v_lshl_add_u32 v7, v7, 2, v22
    ds_write_b8 v7, v25 offset:16
    v_and_b32 v9, -4, v23
    v_lshl_add_u32 v10, v23, 2, v9
    ds_write_b32 v10, v19
    v_lshl_add_u32 v9, v9, 2, v23
    ds_write_b8_d16_hi v9, v25 offset:16
    s_add_u32 s45, s34, 0x1400000
    buffer_load_dwordx2 v[124:125], v1, s[16:19], s45 offen nt
    s_add_u32 s46, s34, 0x1600000
    buffer_load_dwordx2 v[126:127], v1, s[16:19], s46 offen nt
    s_add_u32 s47, s33, 0x2c00000
    buffer_load_dwordx4 v[16:19], v0, s[8:11], s47 offen nt
    v_and_b32 v7, -4, v32
    v_lshl_add_u32 v8, v32, 2, v7
    ds_write_b32 v8, v28
    v_lshl_add_u32 v7, v7, 2, v32
    ds_write_b8 v7, v26 offset:16
    v_and_b32 v9, -4, v33
    v_lshl_add_u32 v10, v33, 2, v9
    ds_write_b32 v10, v29
    v_lshl_add_u32 v9, v9, 2, v33
    ds_write_b8_d16_hi v9, v26 offset:16
    v_and_b32 v7, -4, v34
    v_lshl_add_u32 v8, v34, 2, v7
    ds_write_b32 v8, v30
    v_lshl_add_u32 v7, v7, 2, v34
    ds_write_b8 v7, v27 offset:16
    v_and_b32 v9, -4, v35
    v_lshl_add_u32 v10, v35, 2, v9
    ds_write_b32 v10, v31
    v_lshl_add_u32 v9, v9, 2, v35
    ds_write_b8_d16_hi v9, v27 offset:16
    s_add_u32 s44, s33, 0x2c00000
    buffer_load_dwordx4 v[20:23], v0, s[12:15], s44 offen nt
    s_setprio 2
    v_and_b32 v7, -4, v40
    v_lshl_add_u32 v8, v40, 2, v7
    ds_write_b32 v8, v36
    v_lshl_add_u32 v7, v7, 2, v40
    ds_write_b8 v7, v44 offset:16
    v_and_b32 v9, -4, v41
    v_lshl_add_u32 v10, v41, 2, v9
    ds_write_b32 v10, v37
    v_lshl_add_u32 v9, v9, 2, v41
    ds_write_b8_d16_hi v9, v44 offset:16
    v_and_b32 v7, -4, v42
    v_lshl_add_u32 v8, v42, 2, v7
    ds_write_b32 v8, v38
    v_lshl_add_u32 v7, v7, 2, v42
    ds_write_b8 v7, v45 offset:16
    v_and_b32 v9, -4, v43
    v_lshl_add_u32 v10, v43, 2, v9
    ds_write_b32 v10, v39
    v_lshl_add_u32 v9, v9, 2, v43
    ds_write_b8_d16_hi v9, v45 offset:16
    s_add_u32 s45, s33, 0x3000000
    buffer_load_dwordx4 v[28:31], v0, s[8:11], s45 offen nt
    s_add_u32 s46, s33, 0x3000000
    buffer_load_dwordx4 v[32:35], v0, s[12:15], s46 offen nt
    v_and_b32 v7, -4, v52
    v_lshl_add_u32 v8, v52, 2, v7
    ds_write_b32 v8, v48
    v_lshl_add_u32 v7, v7, 2, v52
    ds_write_b8 v7, v46 offset:16
    v_and_b32 v9, -4, v53
    v_lshl_add_u32 v10, v53, 2, v9
    ds_write_b32 v10, v49
    v_lshl_add_u32 v9, v9, 2, v53
    ds_write_b8_d16_hi v9, v46 offset:16
    v_and_b32 v7, -4, v54
    v_lshl_add_u32 v8, v54, 2, v7
    ds_write_b32 v8, v50
    v_lshl_add_u32 v7, v7, 2, v54
    ds_write_b8 v7, v47 offset:16
    v_and_b32 v9, -4, v55
    v_lshl_add_u32 v10, v55, 2, v9
    ds_write_b32 v10, v51
    v_lshl_add_u32 v9, v9, 2, v55
    ds_write_b8_d16_hi v9, v47 offset:16
    s_add_u32 s47, s34, 0x1800000
    buffer_load_dwordx2 v[24:25], v1, s[16:19], s47 offen nt
    s_add_u32 s44, s34, 0x1a00000
    buffer_load_dwordx2 v[26:27], v1, s[16:19], s44 offen nt
    s_setprio 1
    v_and_b32 v7, -4, v60
    v_lshl_add_u32 v8, v60, 2, v7
    ds_write_b32 v8, v56
    v_lshl_add_u32 v7, v7, 2, v60
    ds_write_b8 v7, v64 offset:16
    v_and_b32 v9, -4, v61
    v_lshl_add_u32 v10, v61, 2, v9
    ds_write_b32 v10, v57
    v_lshl_add_u32 v9, v9, 2, v61
    ds_write_b8_d16_hi v9, v64 offset:16
    v_and_b32 v7, -4, v62
    v_lshl_add_u32 v8, v62, 2, v7
    ds_write_b32 v8, v58
    v_lshl_add_u32 v7, v7, 2, v62
    ds_write_b8 v7, v65 offset:16
    v_and_b32 v9, -4, v63
    v_lshl_add_u32 v10, v63, 2, v9
    ds_write_b32 v10, v59
    v_lshl_add_u32 v9, v9, 2, v63
    ds_write_b8_d16_hi v9, v65 offset:16
    s_add_u32 s45, s33, 0x3400000
    buffer_load_dwordx4 v[36:39], v0, s[8:11], s45 offen nt
    v_and_b32 v7, -4, v72
    v_lshl_add_u32 v8, v72, 2, v7
    ds_write_b32 v8, v68
    v_lshl_add_u32 v7, v7, 2, v72
    ds_write_b8 v7, v66 offset:16
    v_and_b32 v9, -4, v73
    v_lshl_add_u32 v10, v73, 2, v9
    ds_write_b32 v10, v69
    v_lshl_add_u32 v9, v9, 2, v73
    ds_write_b8_d16_hi v9, v66 offset:16
    v_and_b32 v7, -4, v74
    v_lshl_add_u32 v8, v74, 2, v7
    ds_write_b32 v8, v70
    v_lshl_add_u32 v7, v7, 2, v74
    ds_write_b8 v7, v67 offset:16
    v_and_b32 v9, -4, v75
    v_lshl_add_u32 v10, v75, 2, v9
    ds_write_b32 v10, v71
    v_lshl_add_u32 v9, v9, 2, v75
    ds_write_b8_d16_hi v9, v67 offset:16
    s_add_u32 s46, s33, 0x3400000
    buffer_load_dwordx4 v[40:43], v0, s[12:15], s46 offen nt
    s_add_u32 s47, s33, 0x3800000
    buffer_load_dwordx4 v[48:51], v0, s[8:11], s47 offen nt
    s_setprio 0
    v_and_b32 v7, -4, v80
    v_lshl_add_u32 v8, v80, 2, v7
    ds_write_b32 v8, v76
    v_lshl_add_u32 v7, v7, 2, v80
    ds_write_b8 v7, v84 offset:16
    v_and_b32 v9, -4, v81
    v_lshl_add_u32 v10, v81, 2, v9
    ds_write_b32 v10, v77
    v_lshl_add_u32 v9, v9, 2, v81
    ds_write_b8_d16_hi v9, v84 offset:16
    v_and_b32 v7, -4, v82
    v_lshl_add_u32 v8, v82, 2, v7
    ds_write_b32 v8, v78
    v_lshl_add_u32 v7, v7, 2, v82
    ds_write_b8 v7, v85 offset:16
    v_and_b32 v9, -4, v83
    v_lshl_add_u32 v10, v83, 2, v9
    ds_write_b32 v10, v79
    v_lshl_add_u32 v9, v9, 2, v83
    ds_write_b8_d16_hi v9, v85 offset:16
    s_add_u32 s44, s33, 0x3800000
    buffer_load_dwordx4 v[52:55], v0, s[12:15], s44 offen nt
    v_and_b32 v7, -4, v92
    v_lshl_add_u32 v8, v92, 2, v7
    ds_write_b32 v8, v88
    v_lshl_add_u32 v7, v7, 2, v92
    ds_write_b8 v7, v86 offset:16
    v_and_b32 v9, -4, v93
    v_lshl_add_u32 v10, v93, 2, v9
    ds_write_b32 v10, v89
    v_lshl_add_u32 v9, v9, 2, v93
    ds_write_b8_d16_hi v9, v86 offset:16
    v_and_b32 v7, -4, v94
    v_lshl_add_u32 v8, v94, 2, v7
    ds_write_b32 v8, v90
    v_lshl_add_u32 v7, v7, 2, v94
    ds_write_b8 v7, v87 offset:16
    v_and_b32 v9, -4, v95
    v_lshl_add_u32 v10, v95, 2, v9
    ds_write_b32 v10, v91
    v_lshl_add_u32 v9, v9, 2, v95
    ds_write_b8_d16_hi v9, v87 offset:16
    s_add_u32 s45, s34, 0x1c00000
    buffer_load_dwordx2 v[44:45], v1, s[16:19], s45 offen nt
    s_add_u32 s46, s34, 0x1e00000
    buffer_load_dwordx2 v[46:47], v1, s[16:19], s46 offen nt
    v_add_u32 v7, 0x10000, v0
    v_add_u32 v12, 0x20000, v0
    v_mov_b32 v8, 0
    v_mov_b32 v9, 0
    v_mov_b32 v10, 0
    v_mov_b32 v11, 0
    s_waitcnt lgkmcnt(0)
    s_barrier
    ds_read_b128 v[56:59], v0 offset:0
    ds_write_b128 v0, v[8:11]
    ds_read_b128 v[60:63], v0 offset:16384
    ds_read_b128 v[68:71], v0 offset:32768
    ds_read_b128 v[72:75], v0 offset:49152
    ds_read_b128 v[64:67], v7 offset:0
    ds_read_b128 v[76:79], v7 offset:16384
    ds_read_b128 v[80:83], v7 offset:32768
    ds_read_b128 v[88:91], v7 offset:49152
    ds_read_b128 v[92:95], v12 offset:0
    ds_read_b128 v[84:87], v12 offset:16384
    s_waitcnt lgkmcnt(0)
    s_barrier
    s_setprio 3
    s_add_u32 s47, s35, 0x0
    buffer_store_dwordx4 v[56:59], v0, s[20:23], s47 offen sc1
    s_add_u32 s44, s33, 0x3c00000
    s_nop 0
    buffer_load_dwordx4 v[56:59], v0, s[8:11], s44 offen nt
    s_add_u32 s45, s35, 0x4000
    buffer_store_dwordx4 v[60:63], v0, s[20:23], s45 offen sc1
    s_add_u32 s46, s33, 0x3c00000
    s_nop 0
    buffer_load_dwordx4 v[60:63], v0, s[12:15], s46 offen nt
    s_waitcnt vmcnt(22)
    v_lshlrev_b32 v7, 16, v104
    v_and_b32 v8, 0xffff0000, v104
    v_lshlrev_b32 v9, 16, v105
    v_and_b32 v10, 0xffff0000, v105
    v_mul_f32 v7, 0.15915494, v7
    v_mul_f32 v8, 0.15915494, v8
    v_mul_f32 v9, 0.15915494, v9
    v_mul_f32 v10, 0.15915494, v10
    v_mul_hi_u32_u24 v14, 429497, v96
    v_lshrrev_b32 v12, 3, v100
    v_cos_f32 v7, v7
    v_lshlrev_b16 v13, 3, v100
    v_mad_i32_i24 v11, v14, s55, v96
    v_bitop3_b32 v12, v6, v13, v12 bitop3:0xca
    v_lshl_add_u32 v11, v11, 17, s40
    v_lshlrev_b16 v14, 8, v14
    v_lshrrev_b32 v13, 2, v100
    v_add_u32 v96, v12, v11
    v_bitop3_b32 v100, v5, v13, v14 bitop3:0xea
    ds_add_u32 v100, v2
    v_mul_hi_u32_u24 v14, 429497, v97
    v_lshrrev_b32 v12, 3, v101
    v_cos_f32 v8, v8
    v_lshlrev_b16 v13, 3, v101
    v_mad_i32_i24 v11, v14, s55, v97
    v_bitop3_b32 v12, v6, v13, v12 bitop3:0xca
    v_lshl_add_u32 v11, v11, 17, s40
    v_lshlrev_b16 v14, 8, v14
    v_lshrrev_b32 v13, 2, v101
    v_add_u32 v97, v12, v11
    v_bitop3_b32 v101, v5, v13, v14 bitop3:0xea
    ds_add_u32 v101, v2
    v_cvt_pk_bf16_f32 v104, v7, v8
    v_perm_b32 v12, v104, v104, s41
    v_bitop3_b32 v96, v4, v12, v96 bitop3:0xca
    v_perm_b32 v13, v104, v104, s42
    v_bitop3_b32 v97, v4, v13, v97 bitop3:0xca
    v_mul_hi_u32_u24 v14, 429497, v98
    v_lshrrev_b32 v12, 3, v102
    v_cos_f32 v9, v9
    v_lshlrev_b16 v13, 3, v102
    v_mad_i32_i24 v11, v14, s55, v98
    v_bitop3_b32 v12, v6, v13, v12 bitop3:0xca
    v_lshl_add_u32 v11, v11, 17, s40
    v_lshlrev_b16 v14, 8, v14
    v_lshrrev_b32 v13, 2, v102
    v_add_u32 v98, v12, v11
    v_bitop3_b32 v102, v5, v13, v14 bitop3:0xea
    ds_add_u32 v102, v2
    v_mul_hi_u32_u24 v14, 429497, v99
    v_lshrrev_b32 v12, 3, v103
    v_cos_f32 v10, v10
    v_lshlrev_b16 v13, 3, v103
    v_mad_i32_i24 v11, v14, s55, v99
    v_bitop3_b32 v12, v6, v13, v12 bitop3:0xca
    v_lshl_add_u32 v11, v11, 17, s40
    v_lshlrev_b16 v14, 8, v14
    v_lshrrev_b32 v13, 2, v103
    v_add_u32 v99, v12, v11
    v_bitop3_b32 v103, v5, v13, v14 bitop3:0xea
    ds_add_u32 v103, v2
    v_cvt_pk_bf16_f32 v105, v9, v10
    v_perm_b32 v12, v105, v105, s41
    v_bitop3_b32 v98, v4, v12, v98 bitop3:0xca
    v_perm_b32 v13, v105, v105, s42
    v_bitop3_b32 v99, v4, v13, v99 bitop3:0xca
    s_waitcnt vmcnt(20)
    v_lshlrev_b32 v7, 16, v106
    v_and_b32 v8, 0xffff0000, v106
    v_lshlrev_b32 v9, 16, v107
    v_and_b32 v10, 0xffff0000, v107
    v_mul_f32 v7, 0.15915494, v7
    v_mul_f32 v8, 0.15915494, v8
    v_mul_f32 v9, 0.15915494, v9
    v_mul_f32 v10, 0.15915494, v10
    v_mul_hi_u32_u24 v14, 429497, v108
    v_lshrrev_b32 v12, 3, v112
    v_cos_f32 v7, v7
    v_lshlrev_b16 v13, 3, v112
    v_mad_i32_i24 v11, v14, s55, v108
    v_bitop3_b32 v12, v6, v13, v12 bitop3:0xca
    v_lshl_add_u32 v11, v11, 17, s40
    v_lshlrev_b16 v14, 8, v14
    v_lshrrev_b32 v13, 2, v112
    v_add_u32 v108, v12, v11
    v_bitop3_b32 v112, v5, v13, v14 bitop3:0xea
    ds_add_u32 v112, v2
    v_mul_hi_u32_u24 v14, 429497, v109
    v_lshrrev_b32 v12, 3, v113
    v_cos_f32 v8, v8
    v_lshlrev_b16 v13, 3, v113
    v_mad_i32_i24 v11, v14, s55, v109
    v_bitop3_b32 v12, v6, v13, v12 bitop3:0xca
    v_lshl_add_u32 v11, v11, 17, s40
    v_lshlrev_b16 v14, 8, v14
    v_lshrrev_b32 v13, 2, v113
    v_add_u32 v109, v12, v11
    v_bitop3_b32 v113, v5, v13, v14 bitop3:0xea
    ds_add_u32 v113, v2
    v_cvt_pk_bf16_f32 v106, v7, v8
    v_perm_b32 v12, v106, v106, s41
    v_bitop3_b32 v108, v4, v12, v108 bitop3:0xca
    v_perm_b32 v13, v106, v106, s42
    v_bitop3_b32 v109, v4, v13, v109 bitop3:0xca
    v_mul_hi_u32_u24 v14, 429497, v110
    v_lshrrev_b32 v12, 3, v114
    v_cos_f32 v9, v9
    v_lshlrev_b16 v13, 3, v114
    v_mad_i32_i24 v11, v14, s55, v110
    v_bitop3_b32 v12, v6, v13, v12 bitop3:0xca
    v_lshl_add_u32 v11, v11, 17, s40
    v_lshlrev_b16 v14, 8, v14
    v_lshrrev_b32 v13, 2, v114
    v_add_u32 v110, v12, v11
    v_bitop3_b32 v114, v5, v13, v14 bitop3:0xea
    ds_add_u32 v114, v2
    v_mul_hi_u32_u24 v14, 429497, v111
    v_lshrrev_b32 v12, 3, v115
    v_cos_f32 v10, v10
    v_lshlrev_b16 v13, 3, v115
    v_mad_i32_i24 v11, v14, s55, v111
    v_bitop3_b32 v12, v6, v13, v12 bitop3:0xca
    v_lshl_add_u32 v11, v11, 17, s40
    v_lshlrev_b16 v14, 8, v14
    v_lshrrev_b32 v13, 2, v115
    v_add_u32 v111, v12, v11
    v_bitop3_b32 v115, v5, v13, v14 bitop3:0xea
    ds_add_u32 v115, v2
    v_cvt_pk_bf16_f32 v107, v9, v10
    v_perm_b32 v12, v107, v107, s41
    v_bitop3_b32 v110, v4, v12, v110 bitop3:0xca
    v_perm_b32 v13, v107, v107, s42
    v_bitop3_b32 v111, v4, v13, v111 bitop3:0xca
    s_setprio 2
    s_waitcnt vmcnt(16)
    v_lshlrev_b32 v7, 16, v124
    v_and_b32 v8, 0xffff0000, v124
    v_lshlrev_b32 v9, 16, v125
    v_and_b32 v10, 0xffff0000, v125
    v_mul_f32 v7, 0.15915494, v7
    v_mul_f32 v8, 0.15915494, v8
    v_mul_f32 v9, 0.15915494, v9
    v_mul_f32 v10, 0.15915494, v10
    v_mul_hi_u32_u24 v14, 429497, v116
    v_lshrrev_b32 v12, 3, v120
    v_cos_f32 v7, v7
    v_lshlrev_b16 v13, 3, v120
    v_mad_i32_i24 v11, v14, s55, v116
    v_bitop3_b32 v12, v6, v13, v12 bitop3:0xca
    v_lshl_add_u32 v11, v11, 17, s40
    v_lshlrev_b16 v14, 8, v14
    v_lshrrev_b32 v13, 2, v120
    v_add_u32 v116, v12, v11
    v_bitop3_b32 v120, v5, v13, v14 bitop3:0xea
    ds_add_u32 v120, v2
    v_mul_hi_u32_u24 v14, 429497, v117
    v_lshrrev_b32 v12, 3, v121
    v_cos_f32 v8, v8
    v_lshlrev_b16 v13, 3, v121
    v_mad_i32_i24 v11, v14, s55, v117
    v_bitop3_b32 v12, v6, v13, v12 bitop3:0xca
    v_lshl_add_u32 v11, v11, 17, s40
    v_lshlrev_b16 v14, 8, v14
    v_lshrrev_b32 v13, 2, v121
    v_add_u32 v117, v12, v11
    v_bitop3_b32 v121, v5, v13, v14 bitop3:0xea
    ds_add_u32 v121, v2
    v_cvt_pk_bf16_f32 v124, v7, v8
    v_perm_b32 v12, v124, v124, s41
    v_bitop3_b32 v116, v4, v12, v116 bitop3:0xca
    v_perm_b32 v13, v124, v124, s42
    v_bitop3_b32 v117, v4, v13, v117 bitop3:0xca
    v_mul_hi_u32_u24 v14, 429497, v118
    v_lshrrev_b32 v12, 3, v122
    v_cos_f32 v9, v9
    v_lshlrev_b16 v13, 3, v122
    v_mad_i32_i24 v11, v14, s55, v118
    v_bitop3_b32 v12, v6, v13, v12 bitop3:0xca
    v_lshl_add_u32 v11, v11, 17, s40
    v_lshlrev_b16 v14, 8, v14
    v_lshrrev_b32 v13, 2, v122
    v_add_u32 v118, v12, v11
    v_bitop3_b32 v122, v5, v13, v14 bitop3:0xea
    ds_add_u32 v122, v2
    v_mul_hi_u32_u24 v14, 429497, v119
    v_lshrrev_b32 v12, 3, v123
    v_cos_f32 v10, v10
    v_lshlrev_b16 v13, 3, v123
    v_mad_i32_i24 v11, v14, s55, v119
    v_bitop3_b32 v12, v6, v13, v12 bitop3:0xca
    v_lshl_add_u32 v11, v11, 17, s40
    v_lshlrev_b16 v14, 8, v14
    v_lshrrev_b32 v13, 2, v123
    v_add_u32 v119, v12, v11
    v_bitop3_b32 v123, v5, v13, v14 bitop3:0xea
    ds_add_u32 v123, v2
    v_cvt_pk_bf16_f32 v125, v9, v10
    v_perm_b32 v12, v125, v125, s41
    v_bitop3_b32 v118, v4, v12, v118 bitop3:0xca
    v_perm_b32 v13, v125, v125, s42
    v_bitop3_b32 v119, v4, v13, v119 bitop3:0xca
    s_add_u32 s47, s35, 0x8000
    buffer_store_dwordx4 v[68:71], v0, s[20:23], s47 offen sc1
    s_add_u32 s44, s33, 0x4000000
    s_nop 0
    buffer_load_dwordx4 v[68:71], v0, s[8:11], s44 offen nt
    s_waitcnt vmcnt(16)
    v_lshlrev_b32 v7, 16, v126
    v_and_b32 v8, 0xffff0000, v126
    v_lshlrev_b32 v9, 16, v127
    v_and_b32 v10, 0xffff0000, v127
    v_mul_f32 v7, 0.15915494, v7
    v_mul_f32 v8, 0.15915494, v8
    v_mul_f32 v9, 0.15915494, v9
    v_mul_f32 v10, 0.15915494, v10
    v_mul_hi_u32_u24 v14, 429497, v16
    v_lshrrev_b32 v12, 3, v20
    v_cos_f32 v7, v7
    v_lshlrev_b16 v13, 3, v20
    v_mad_i32_i24 v11, v14, s55, v16
    v_bitop3_b32 v12, v6, v13, v12 bitop3:0xca
    v_lshl_add_u32 v11, v11, 17, s40
    v_lshlrev_b16 v14, 8, v14
    v_lshrrev_b32 v13, 2, v20
    v_add_u32 v16, v12, v11
    v_bitop3_b32 v20, v5, v13, v14 bitop3:0xea
    ds_add_u32 v20, v2
    v_mul_hi_u32_u24 v14, 429497, v17
    v_lshrrev_b32 v12, 3, v21
    v_cos_f32 v8, v8
    v_lshlrev_b16 v13, 3, v21
    v_mad_i32_i24 v11, v14, s55, v17
    v_bitop3_b32 v12, v6, v13, v12 bitop3:0xca
    v_lshl_add_u32 v11, v11, 17, s40
    v_lshlrev_b16 v14, 8, v14
    v_lshrrev_b32 v13, 2, v21
    v_add_u32 v17, v12, v11
    v_bitop3_b32 v21, v5, v13, v14 bitop3:0xea
    ds_add_u32 v21, v2
    v_cvt_pk_bf16_f32 v126, v7, v8
    v_perm_b32 v12, v126, v126, s41
    v_bitop3_b32 v16, v4, v12, v16 bitop3:0xca
    v_perm_b32 v13, v126, v126, s42
    v_bitop3_b32 v17, v4, v13, v17 bitop3:0xca
    v_mul_hi_u32_u24 v14, 429497, v18
    v_lshrrev_b32 v12, 3, v22
    v_cos_f32 v9, v9
    v_lshlrev_b16 v13, 3, v22
    v_mad_i32_i24 v11, v14, s55, v18
    v_bitop3_b32 v12, v6, v13, v12 bitop3:0xca
    v_lshl_add_u32 v11, v11, 17, s40
    v_lshlrev_b16 v14, 8, v14
    v_lshrrev_b32 v13, 2, v22
    v_add_u32 v18, v12, v11
    v_bitop3_b32 v22, v5, v13, v14 bitop3:0xea
    ds_add_u32 v22, v2
    v_mul_hi_u32_u24 v14, 429497, v19
    v_lshrrev_b32 v12, 3, v23
    v_cos_f32 v10, v10
    v_lshlrev_b16 v13, 3, v23
    v_mad_i32_i24 v11, v14, s55, v19
    v_bitop3_b32 v12, v6, v13, v12 bitop3:0xca
    v_lshl_add_u32 v11, v11, 17, s40
    v_lshlrev_b16 v14, 8, v14
    v_lshrrev_b32 v13, 2, v23
    v_add_u32 v19, v12, v11
    v_bitop3_b32 v23, v5, v13, v14 bitop3:0xea
    ds_add_u32 v23, v2
    v_cvt_pk_bf16_f32 v127, v9, v10
    v_perm_b32 v12, v127, v127, s41
    v_bitop3_b32 v18, v4, v12, v18 bitop3:0xca
    v_perm_b32 v13, v127, v127, s42
    v_bitop3_b32 v19, v4, v13, v19 bitop3:0xca
    s_setprio 1
    s_waitcnt vmcnt(12)
    v_lshlrev_b32 v7, 16, v24
    v_and_b32 v8, 0xffff0000, v24
    v_lshlrev_b32 v9, 16, v25
    v_and_b32 v10, 0xffff0000, v25
    v_mul_f32 v7, 0.15915494, v7
    v_mul_f32 v8, 0.15915494, v8
    v_mul_f32 v9, 0.15915494, v9
    v_mul_f32 v10, 0.15915494, v10
    v_mul_hi_u32_u24 v14, 429497, v28
    v_lshrrev_b32 v12, 3, v32
    v_cos_f32 v7, v7
    v_lshlrev_b16 v13, 3, v32
    v_mad_i32_i24 v11, v14, s55, v28
    v_bitop3_b32 v12, v6, v13, v12 bitop3:0xca
    v_lshl_add_u32 v11, v11, 17, s40
    v_lshlrev_b16 v14, 8, v14
    v_lshrrev_b32 v13, 2, v32
    v_add_u32 v28, v12, v11
    v_bitop3_b32 v32, v5, v13, v14 bitop3:0xea
    ds_add_u32 v32, v2
    v_mul_hi_u32_u24 v14, 429497, v29
    v_lshrrev_b32 v12, 3, v33
    v_cos_f32 v8, v8
    v_lshlrev_b16 v13, 3, v33
    v_mad_i32_i24 v11, v14, s55, v29
    v_bitop3_b32 v12, v6, v13, v12 bitop3:0xca
    v_lshl_add_u32 v11, v11, 17, s40
    v_lshlrev_b16 v14, 8, v14
    v_lshrrev_b32 v13, 2, v33
    v_add_u32 v29, v12, v11
    v_bitop3_b32 v33, v5, v13, v14 bitop3:0xea
    ds_add_u32 v33, v2
    v_cvt_pk_bf16_f32 v24, v7, v8
    v_perm_b32 v12, v24, v24, s41
    v_bitop3_b32 v28, v4, v12, v28 bitop3:0xca
    v_perm_b32 v13, v24, v24, s42
    v_bitop3_b32 v29, v4, v13, v29 bitop3:0xca
    v_mul_hi_u32_u24 v14, 429497, v30
    v_lshrrev_b32 v12, 3, v34
    v_cos_f32 v9, v9
    v_lshlrev_b16 v13, 3, v34
    v_mad_i32_i24 v11, v14, s55, v30
    v_bitop3_b32 v12, v6, v13, v12 bitop3:0xca
    v_lshl_add_u32 v11, v11, 17, s40
    v_lshlrev_b16 v14, 8, v14
    v_lshrrev_b32 v13, 2, v34
    v_add_u32 v30, v12, v11
    v_bitop3_b32 v34, v5, v13, v14 bitop3:0xea
    ds_add_u32 v34, v2
    v_mul_hi_u32_u24 v14, 429497, v31
    v_lshrrev_b32 v12, 3, v35
    v_cos_f32 v10, v10
    v_lshlrev_b16 v13, 3, v35
    v_mad_i32_i24 v11, v14, s55, v31
    v_bitop3_b32 v12, v6, v13, v12 bitop3:0xca
    v_lshl_add_u32 v11, v11, 17, s40
    v_lshlrev_b16 v14, 8, v14
    v_lshrrev_b32 v13, 2, v35
    v_add_u32 v31, v12, v11
    v_bitop3_b32 v35, v5, v13, v14 bitop3:0xea
    ds_add_u32 v35, v2
    v_cvt_pk_bf16_f32 v25, v9, v10
    v_perm_b32 v12, v25, v25, s41
    v_bitop3_b32 v30, v4, v12, v30 bitop3:0xca
    v_perm_b32 v13, v25, v25, s42
    v_bitop3_b32 v31, v4, v13, v31 bitop3:0xca
    s_waitcnt vmcnt(10)
    v_lshlrev_b32 v7, 16, v26
    v_and_b32 v8, 0xffff0000, v26
    v_lshlrev_b32 v9, 16, v27
    v_and_b32 v10, 0xffff0000, v27
    v_mul_f32 v7, 0.15915494, v7
    v_mul_f32 v8, 0.15915494, v8
    v_mul_f32 v9, 0.15915494, v9
    v_mul_f32 v10, 0.15915494, v10
    v_mul_hi_u32_u24 v14, 429497, v36
    v_lshrrev_b32 v12, 3, v40
    v_cos_f32 v7, v7
    v_lshlrev_b16 v13, 3, v40
    v_mad_i32_i24 v11, v14, s55, v36
    v_bitop3_b32 v12, v6, v13, v12 bitop3:0xca
    v_lshl_add_u32 v11, v11, 17, s40
    v_lshlrev_b16 v14, 8, v14
    v_lshrrev_b32 v13, 2, v40
    v_add_u32 v36, v12, v11
    v_bitop3_b32 v40, v5, v13, v14 bitop3:0xea
    ds_add_u32 v40, v2
    v_mul_hi_u32_u24 v14, 429497, v37
    v_lshrrev_b32 v12, 3, v41
    v_cos_f32 v8, v8
    v_lshlrev_b16 v13, 3, v41
    v_mad_i32_i24 v11, v14, s55, v37
    v_bitop3_b32 v12, v6, v13, v12 bitop3:0xca
    v_lshl_add_u32 v11, v11, 17, s40
    v_lshlrev_b16 v14, 8, v14
    v_lshrrev_b32 v13, 2, v41
    v_add_u32 v37, v12, v11
    v_bitop3_b32 v41, v5, v13, v14 bitop3:0xea
    ds_add_u32 v41, v2
    v_cvt_pk_bf16_f32 v26, v7, v8
    v_perm_b32 v12, v26, v26, s41
    v_bitop3_b32 v36, v4, v12, v36 bitop3:0xca
    v_perm_b32 v13, v26, v26, s42
    v_bitop3_b32 v37, v4, v13, v37 bitop3:0xca
    v_mul_hi_u32_u24 v14, 429497, v38
    v_lshrrev_b32 v12, 3, v42
    v_cos_f32 v9, v9
    v_lshlrev_b16 v13, 3, v42
    v_mad_i32_i24 v11, v14, s55, v38
    v_bitop3_b32 v12, v6, v13, v12 bitop3:0xca
    v_lshl_add_u32 v11, v11, 17, s40
    v_lshlrev_b16 v14, 8, v14
    v_lshrrev_b32 v13, 2, v42
    v_add_u32 v38, v12, v11
    v_bitop3_b32 v42, v5, v13, v14 bitop3:0xea
    ds_add_u32 v42, v2
    v_mul_hi_u32_u24 v14, 429497, v39
    v_lshrrev_b32 v12, 3, v43
    v_cos_f32 v10, v10
    v_lshlrev_b16 v13, 3, v43
    v_mad_i32_i24 v11, v14, s55, v39
    v_bitop3_b32 v12, v6, v13, v12 bitop3:0xca
    v_lshl_add_u32 v11, v11, 17, s40
    v_lshlrev_b16 v14, 8, v14
    v_lshrrev_b32 v13, 2, v43
    v_add_u32 v39, v12, v11
    v_bitop3_b32 v43, v5, v13, v14 bitop3:0xea
    ds_add_u32 v43, v2
    v_cvt_pk_bf16_f32 v27, v9, v10
    v_perm_b32 v12, v27, v27, s41
    v_bitop3_b32 v38, v4, v12, v38 bitop3:0xca
    v_perm_b32 v13, v27, v27, s42
    v_bitop3_b32 v39, v4, v13, v39 bitop3:0xca
    s_setprio 0
    s_add_u32 s45, s35, 0xc000
    buffer_store_dwordx4 v[72:75], v0, s[20:23], s45 offen sc1
    s_add_u32 s46, s33, 0x4000000
    s_nop 0
    buffer_load_dwordx4 v[72:75], v0, s[12:15], s46 offen nt
    s_waitcnt vmcnt(8)
    v_lshlrev_b32 v7, 16, v44
    v_and_b32 v8, 0xffff0000, v44
    v_lshlrev_b32 v9, 16, v45
    v_and_b32 v10, 0xffff0000, v45
    v_mul_f32 v7, 0.15915494, v7
    v_mul_f32 v8, 0.15915494, v8
    v_mul_f32 v9, 0.15915494, v9
    v_mul_f32 v10, 0.15915494, v10
    v_mul_hi_u32_u24 v14, 429497, v48
    v_lshrrev_b32 v12, 3, v52
    v_cos_f32 v7, v7
    v_lshlrev_b16 v13, 3, v52
    v_mad_i32_i24 v11, v14, s55, v48
    v_bitop3_b32 v12, v6, v13, v12 bitop3:0xca
    v_lshl_add_u32 v11, v11, 17, s40
    v_lshlrev_b16 v14, 8, v14
    v_lshrrev_b32 v13, 2, v52
    v_add_u32 v48, v12, v11
    v_bitop3_b32 v52, v5, v13, v14 bitop3:0xea
    ds_add_u32 v52, v2
    v_mul_hi_u32_u24 v14, 429497, v49
    v_lshrrev_b32 v12, 3, v53
    v_cos_f32 v8, v8
    v_lshlrev_b16 v13, 3, v53
    v_mad_i32_i24 v11, v14, s55, v49
    v_bitop3_b32 v12, v6, v13, v12 bitop3:0xca
    v_lshl_add_u32 v11, v11, 17, s40
    v_lshlrev_b16 v14, 8, v14
    v_lshrrev_b32 v13, 2, v53
    v_add_u32 v49, v12, v11
    v_bitop3_b32 v53, v5, v13, v14 bitop3:0xea
    ds_add_u32 v53, v2
    v_cvt_pk_bf16_f32 v44, v7, v8
    v_perm_b32 v12, v44, v44, s41
    v_bitop3_b32 v48, v4, v12, v48 bitop3:0xca
    v_perm_b32 v13, v44, v44, s42
    v_bitop3_b32 v49, v4, v13, v49 bitop3:0xca
    v_mul_hi_u32_u24 v14, 429497, v50
    v_lshrrev_b32 v12, 3, v54
    v_cos_f32 v9, v9
    v_lshlrev_b16 v13, 3, v54
    v_mad_i32_i24 v11, v14, s55, v50
    v_bitop3_b32 v12, v6, v13, v12 bitop3:0xca
    v_lshl_add_u32 v11, v11, 17, s40
    v_lshlrev_b16 v14, 8, v14
    v_lshrrev_b32 v13, 2, v54
    v_add_u32 v50, v12, v11
    v_bitop3_b32 v54, v5, v13, v14 bitop3:0xea
    ds_add_u32 v54, v2
    v_mul_hi_u32_u24 v14, 429497, v51
    v_lshrrev_b32 v12, 3, v55
    v_cos_f32 v10, v10
    v_lshlrev_b16 v13, 3, v55
    v_mad_i32_i24 v11, v14, s55, v51
    v_bitop3_b32 v12, v6, v13, v12 bitop3:0xca
    v_lshl_add_u32 v11, v11, 17, s40
    v_lshlrev_b16 v14, 8, v14
    v_lshrrev_b32 v13, 2, v55
    v_add_u32 v51, v12, v11
    v_bitop3_b32 v55, v5, v13, v14 bitop3:0xea
    ds_add_u32 v55, v2
    v_cvt_pk_bf16_f32 v45, v9, v10
    v_perm_b32 v12, v45, v45, s41
    v_bitop3_b32 v50, v4, v12, v50 bitop3:0xca
    v_perm_b32 v13, v45, v45, s42
    v_bitop3_b32 v51, v4, v13, v51 bitop3:0xca
    s_waitcnt vmcnt(4)
    v_lshlrev_b32 v7, 16, v46
    v_and_b32 v8, 0xffff0000, v46
    v_lshlrev_b32 v9, 16, v47
    v_and_b32 v10, 0xffff0000, v47
    v_mul_f32 v7, 0.15915494, v7
    v_mul_f32 v8, 0.15915494, v8
    v_mul_f32 v9, 0.15915494, v9
    v_mul_f32 v10, 0.15915494, v10
    v_mul_hi_u32_u24 v14, 429497, v56
    v_lshrrev_b32 v12, 3, v60
    v_cos_f32 v7, v7
    v_lshlrev_b16 v13, 3, v60
    v_mad_i32_i24 v11, v14, s55, v56
    v_bitop3_b32 v12, v6, v13, v12 bitop3:0xca
    v_lshl_add_u32 v11, v11, 17, s40
    v_lshlrev_b16 v14, 8, v14
    v_lshrrev_b32 v13, 2, v60
    v_add_u32 v56, v12, v11
    v_bitop3_b32 v60, v5, v13, v14 bitop3:0xea
    ds_add_u32 v60, v2
    v_mul_hi_u32_u24 v14, 429497, v57
    v_lshrrev_b32 v12, 3, v61
    v_cos_f32 v8, v8
    v_lshlrev_b16 v13, 3, v61
    v_mad_i32_i24 v11, v14, s55, v57
    v_bitop3_b32 v12, v6, v13, v12 bitop3:0xca
    v_lshl_add_u32 v11, v11, 17, s40
    v_lshlrev_b16 v14, 8, v14
    v_lshrrev_b32 v13, 2, v61
    v_add_u32 v57, v12, v11
    v_bitop3_b32 v61, v5, v13, v14 bitop3:0xea
    ds_add_u32 v61, v2
    v_cvt_pk_bf16_f32 v46, v7, v8
    v_perm_b32 v12, v46, v46, s41
    v_bitop3_b32 v56, v4, v12, v56 bitop3:0xca
    v_perm_b32 v13, v46, v46, s42
    v_bitop3_b32 v57, v4, v13, v57 bitop3:0xca
    v_mul_hi_u32_u24 v14, 429497, v58
    v_lshrrev_b32 v12, 3, v62
    v_cos_f32 v9, v9
    v_lshlrev_b16 v13, 3, v62
    v_mad_i32_i24 v11, v14, s55, v58
    v_bitop3_b32 v12, v6, v13, v12 bitop3:0xca
    v_lshl_add_u32 v11, v11, 17, s40
    v_lshlrev_b16 v14, 8, v14
    v_lshrrev_b32 v13, 2, v62
    v_add_u32 v58, v12, v11
    v_bitop3_b32 v62, v5, v13, v14 bitop3:0xea
    ds_add_u32 v62, v2
    v_mul_hi_u32_u24 v14, 429497, v59
    v_lshrrev_b32 v12, 3, v63
    v_cos_f32 v10, v10
    v_lshlrev_b16 v13, 3, v63
    v_mad_i32_i24 v11, v14, s55, v59
    v_bitop3_b32 v12, v6, v13, v12 bitop3:0xca
    v_lshl_add_u32 v11, v11, 17, s40
    v_lshlrev_b16 v14, 8, v14
    v_lshrrev_b32 v13, 2, v63
    v_add_u32 v59, v12, v11
    v_bitop3_b32 v63, v5, v13, v14 bitop3:0xea
    ds_add_u32 v63, v2
    v_cvt_pk_bf16_f32 v47, v9, v10
    v_perm_b32 v12, v47, v47, s41
    v_bitop3_b32 v58, v4, v12, v58 bitop3:0xca
    v_perm_b32 v13, v47, v47, s42
    v_bitop3_b32 v59, v4, v13, v59 bitop3:0xca
    v_lshrrev_b32 v8, 2, v0
    v_and_b32 v7, 0x3c00, v0
    v_bitop3_b32 v7, v5, v8, v7 bitop3:0xea
    s_waitcnt lgkmcnt(0)
    s_barrier
    ds_read2st64_b32 v[8:9], v7 offset0:0 offset1:1
    ds_read2st64_b32 v[10:11], v7 offset0:2 offset1:3
    s_add_u32 s47, s35, 0x10000
    buffer_store_dwordx4 v[64:67], v0, s[20:23], s47 offen sc1
    s_add_u32 s44, s34, 0x2000000
    s_nop 0
    buffer_load_dwordx2 v[64:65], v1, s[16:19], s44 offen nt
    s_add_u32 s45, s34, 0x2200000
    buffer_load_dwordx2 v[66:67], v1, s[16:19], s45 offen nt
    s_waitcnt lgkmcnt(0)
    v_lshl_or_b32 v12, v9, 16, v8
    v_lshl_or_b32 v13, v11, 16, v10
    v_mov_b32 v14, v12
    v_mov_b32 v15, v13
    s_nop 0
    v_add_u32_dpp v14, v14, v14 row_shr:1 row_mask:0xf bank_mask:0xf bound_ctrl:1
    v_add_u32_dpp v15, v15, v15 row_shr:1 row_mask:0xf bank_mask:0xf bound_ctrl:1
    s_nop 0
    v_add_u32_dpp v14, v14, v14 row_shr:2 row_mask:0xf bank_mask:0xf bound_ctrl:1
    v_add_u32_dpp v15, v15, v15 row_shr:2 row_mask:0xf bank_mask:0xf bound_ctrl:1
    s_nop 0
    v_add_u32_dpp v14, v14, v14 row_shr:4 row_mask:0xf bank_mask:0xf bound_ctrl:1
    v_add_u32_dpp v15, v15, v15 row_shr:4 row_mask:0xf bank_mask:0xf bound_ctrl:1
    s_nop 0
    v_add_u32_dpp v14, v14, v14 row_shr:8 row_mask:0xf bank_mask:0xf bound_ctrl:1
    v_add_u32_dpp v15, v15, v15 row_shr:8 row_mask:0xf bank_mask:0xf bound_ctrl:1
    s_nop 0
    v_add_u32_dpp v14, v14, v14 row_bcast:15 row_mask:0xa bank_mask:0xf
    v_add_u32_dpp v15, v15, v15 row_bcast:15 row_mask:0xa bank_mask:0xf
    s_nop 0
    v_add_u32_dpp v14, v14, v14 row_bcast:31 row_mask:0xc bank_mask:0xf
    v_add_u32_dpp v15, v15, v15 row_bcast:31 row_mask:0xc bank_mask:0xf
    v_readlane_b32 s48, v14, 63
    v_readlane_b32 s49, v15, 63
    s_lshl_b32 s54, s32, 2
    v_mov_b32 v8, s54
    s_and_b32 s50, s48, 0xffff
    s_lshr_b32 s51, s48, 16
    s_and_b32 s52, s49, 0xffff
    s_lshr_b32 s53, s49, 16
    s_add_u32 s51, s51, s50
    s_add_u32 s52, s52, s51
    s_add_u32 s53, s53, s52
    v_mov_b32 v9, s53
    s_mov_b64 exec, 1
    ds_write_b32 v8, v9 offset:16384
    s_mov_b64 exec, -1
    v_and_b32 v8, 60, v7
    s_waitcnt lgkmcnt(0)
    s_barrier
    ds_read_b32 v9, v8 offset:16384
    s_waitcnt lgkmcnt(0)
    v_add_u32_dpp v9, v9, v9 row_shr:1 row_mask:0xf bank_mask:0xf bound_ctrl:1
    s_nop 1
    v_add_u32_dpp v9, v9, v9 row_shr:2 row_mask:0xf bank_mask:0xf bound_ctrl:1
    s_nop 1
    v_add_u32_dpp v9, v9, v9 row_shr:4 row_mask:0xf bank_mask:0xf bound_ctrl:1
    s_nop 1
    v_add_u32_dpp v9, v9, v9 row_shr:8 row_mask:0xf bank_mask:0xf bound_ctrl:1
    s_nop 0
    v_readlane_b32 s54, v9, s32
    s_sub_u32 s54, s54, s53
    s_add_u32 s50, s50, s54
    s_add_u32 s51, s51, s54
    s_add_u32 s52, s52, s54
    s_pack_ll_b32_b16 s48, s54, s50
    s_pack_ll_b32_b16 s49, s51, s52
    v_add_u32 v14, s48, v14
    v_add_u32 v15, s49, v15
    v_sub_u32 v12, v14, v12
    v_sub_u32 v13, v15, v13
    v_and_b32 v8, 0xffff, v12
    v_lshrrev_b32 v9, 16, v12
    v_and_b32 v10, 0xffff, v13
    v_lshrrev_b32 v11, 16, v13
    ds_write2st64_b32 v7, v8, v9 offset0:0 offset1:1
    ds_write2st64_b32 v7, v10, v11 offset0:2 offset1:3
    v_and_b32 v8, 0x3f0, v0
    v_lshl_add_u32 v8, v8, 1, s36
    ds_write_b64 v8, v[12:13] offset:20480
    s_bitset0_b64 exec, 63
    s_not_b64 exec, exec
    ds_write_b64 v8, v[14:15] offset:20512
    s_mov_b64 exec, -1
    s_waitcnt lgkmcnt(0)
    s_barrier
    s_setprio 3
    ds_add_rtn_u32 v100, v100, v2
    ds_add_rtn_u32 v101, v101, v2
    ds_add_rtn_u32 v102, v102, v2
    ds_add_rtn_u32 v103, v103, v2
    ds_read_b128 v[12:15], v0 offset:20480
    v_cmp_gt_u32 vcc, 8448, v0
    ds_add_rtn_u32 v112, v112, v2
    ds_add_rtn_u32 v113, v113, v2
    ds_add_rtn_u32 v114, v114, v2
    ds_add_rtn_u32 v115, v115, v2
    s_setprio 2
    ds_add_rtn_u32 v120, v120, v2
    ds_add_rtn_u32 v121, v121, v2
    ds_add_rtn_u32 v122, v122, v2
    ds_add_rtn_u32 v123, v123, v2
    s_waitcnt lgkmcnt(8)
    s_cbranch_vccz L1_p2
    s_add_u32 s46, s35, 0x2a40000
    s_mov_b64 exec, vcc
    buffer_store_dwordx4 v[12:15], v0, s[24:27], s46 offen sc1
    s_mov_b64 exec, -1
L1_p2:
    s_add_u32 s47, s35, 0x14000
    buffer_store_dwordx4 v[76:79], v0, s[20:23], s47 offen sc1
    s_add_u32 s44, s33, 0x4400000
    s_nop 0
    buffer_load_dwordx4 v[76:79], v0, s[8:11], s44 offen nt
    ds_add_rtn_u32 v20, v20, v2
    ds_add_rtn_u32 v21, v21, v2
    ds_add_rtn_u32 v22, v22, v2
    ds_add_rtn_u32 v23, v23, v2
    s_setprio 1
    ds_add_rtn_u32 v32, v32, v2
    ds_add_rtn_u32 v33, v33, v2
    ds_add_rtn_u32 v34, v34, v2
    ds_add_rtn_u32 v35, v35, v2
    ds_add_rtn_u32 v40, v40, v2
    ds_add_rtn_u32 v41, v41, v2
    ds_add_rtn_u32 v42, v42, v2
    ds_add_rtn_u32 v43, v43, v2
    s_add_u32 s45, s35, 0x18000
    buffer_store_dwordx4 v[80:83], v0, s[20:23], s45 offen sc1
    s_add_u32 s46, s33, 0x4400000
    s_nop 0
    buffer_load_dwordx4 v[80:83], v0, s[12:15], s46 offen nt
    s_setprio 0
    ds_add_rtn_u32 v52, v52, v2
    ds_add_rtn_u32 v53, v53, v2
    ds_add_rtn_u32 v54, v54, v2
    ds_add_rtn_u32 v55, v55, v2
    ds_add_rtn_u32 v60, v60, v2
    ds_add_rtn_u32 v61, v61, v2
    ds_add_rtn_u32 v62, v62, v2
    ds_add_rtn_u32 v63, v63, v2
    s_waitcnt lgkmcnt(0)
    s_barrier
    s_setprio 3
    v_and_b32 v7, -4, v100
    v_lshl_add_u32 v8, v100, 2, v7
    ds_write_b32 v8, v96
    v_lshl_add_u32 v7, v7, 2, v100
    ds_write_b8 v7, v104 offset:16
    v_and_b32 v9, -4, v101
    v_lshl_add_u32 v10, v101, 2, v9
    ds_write_b32 v10, v97
    v_lshl_add_u32 v9, v9, 2, v101
    ds_write_b8_d16_hi v9, v104 offset:16
    v_and_b32 v7, -4, v102
    v_lshl_add_u32 v8, v102, 2, v7
    ds_write_b32 v8, v98
    v_lshl_add_u32 v7, v7, 2, v102
    ds_write_b8 v7, v105 offset:16
    v_and_b32 v9, -4, v103
    v_lshl_add_u32 v10, v103, 2, v9
    ds_write_b32 v10, v99
    v_lshl_add_u32 v9, v9, 2, v103
    ds_write_b8_d16_hi v9, v105 offset:16
    s_add_u32 s47, s35, 0x1c000
    buffer_store_dwordx4 v[88:91], v0, s[20:23], s47 offen sc1
    s_add_u32 s44, s33, 0x4800000
    buffer_load_dwordx4 v[96:99], v0, s[8:11], s44 offen nt
    s_add_u32 s45, s33, 0x4800000
    buffer_load_dwordx4 v[100:103], v0, s[12:15], s45 offen nt
    v_and_b32 v7, -4, v112
    v_lshl_add_u32 v8, v112, 2, v7
    ds_write_b32 v8, v108
    v_lshl_add_u32 v7, v7, 2, v112
    ds_write_b8 v7, v106 offset:16
    v_and_b32 v9, -4, v113
    v_lshl_add_u32 v10, v113, 2, v9
    ds_write_b32 v10, v109
    v_lshl_add_u32 v9, v9, 2, v113
    ds_write_b8_d16_hi v9, v106 offset:16
    v_and_b32 v7, -4, v114
    v_lshl_add_u32 v8, v114, 2, v7
    ds_write_b32 v8, v110
    v_lshl_add_u32 v7, v7, 2, v114
    ds_write_b8 v7, v107 offset:16
    v_and_b32 v9, -4, v115
    v_lshl_add_u32 v10, v115, 2, v9
    ds_write_b32 v10, v111
    v_lshl_add_u32 v9, v9, 2, v115
    ds_write_b8_d16_hi v9, v107 offset:16
    s_add_u32 s46, s34, 0x2400000
    buffer_load_dwordx2 v[88:89], v1, s[16:19], s46 offen nt
    s_add_u32 s47, s34, 0x2600000
    buffer_load_dwordx2 v[90:91], v1, s[16:19], s47 offen nt
    s_add_u32 s44, s33, 0x4c00000
    buffer_load_dwordx4 v[108:111], v0, s[8:11], s44 offen nt
    s_setprio 2
    v_and_b32 v7, -4, v120
    v_lshl_add_u32 v8, v120, 2, v7
    ds_write_b32 v8, v116
    v_lshl_add_u32 v7, v7, 2, v120
    ds_write_b8 v7, v124 offset:16
    v_and_b32 v9, -4, v121
    v_lshl_add_u32 v10, v121, 2, v9
    ds_write_b32 v10, v117
    v_lshl_add_u32 v9, v9, 2, v121
    ds_write_b8_d16_hi v9, v124 offset:16
    v_and_b32 v7, -4, v122
    v_lshl_add_u32 v8, v122, 2, v7
    ds_write_b32 v8, v118
    v_lshl_add_u32 v7, v7, 2, v122
    ds_write_b8 v7, v125 offset:16
    v_and_b32 v9, -4, v123
    v_lshl_add_u32 v10, v123, 2, v9
    ds_write_b32 v10, v119
    v_lshl_add_u32 v9, v9, 2, v123
    ds_write_b8_d16_hi v9, v125 offset:16
    s_add_u32 s45, s35, 0x20000
    buffer_store_dwordx4 v[92:95], v0, s[20:23], s45 offen sc1
    s_add_u32 s46, s33, 0x4c00000
    buffer_load_dwordx4 v[112:115], v0, s[12:15], s46 offen nt
    v_and_b32 v7, -4, v20
    v_lshl_add_u32 v8, v20, 2, v7
    ds_write_b32 v8, v16
    v_lshl_add_u32 v7, v7, 2, v20
    ds_write_b8 v7, v126 offset:16
    v_and_b32 v9, -4, v21
    v_lshl_add_u32 v10, v21, 2, v9
    ds_write_b32 v10, v17
    v_lshl_add_u32 v9, v9, 2, v21
    ds_write_b8_d16_hi v9, v126 offset:16
    v_and_b32 v7, -4, v22
    v_lshl_add_u32 v8, v22, 2, v7
    ds_write_b32 v8, v18
    v_lshl_add_u32 v7, v7, 2, v22
    ds_write_b8 v7, v127 offset:16
    v_and_b32 v9, -4, v23
    v_lshl_add_u32 v10, v23, 2, v9
    ds_write_b32 v10, v19
    v_lshl_add_u32 v9, v9, 2, v23
    ds_write_b8_d16_hi v9, v127 offset:16
    s_add_u32 s47, s33, 0x5000000
    buffer_load_dwordx4 v[104:107], v0, s[8:11], s47 offen nt
    s_add_u32 s44, s33, 0x5000000
    buffer_load_dwordx4 v[116:119], v0, s[12:15], s44 offen nt
    s_setprio 1
    v_and_b32 v7, -4, v32
    v_lshl_add_u32 v8, v32, 2, v7
    ds_write_b32 v8, v28
    v_lshl_add_u32 v7, v7, 2, v32
    ds_write_b8 v7, v24 offset:16
    v_and_b32 v9, -4, v33
    v_lshl_add_u32 v10, v33, 2, v9
    ds_write_b32 v10, v29
    v_lshl_add_u32 v9, v9, 2, v33
    ds_write_b8_d16_hi v9, v24 offset:16
    v_and_b32 v7, -4, v34
    v_lshl_add_u32 v8, v34, 2, v7
    ds_write_b32 v8, v30
    v_lshl_add_u32 v7, v7, 2, v34
    ds_write_b8 v7, v25 offset:16
    v_and_b32 v9, -4, v35
    v_lshl_add_u32 v10, v35, 2, v9
    ds_write_b32 v10, v31
    v_lshl_add_u32 v9, v9, 2, v35
    ds_write_b8_d16_hi v9, v25 offset:16
    s_add_u32 s45, s34, 0x2800000
    buffer_load_dwordx2 v[120:121], v1, s[16:19], s45 offen nt
    s_add_u32 s46, s34, 0x2a00000
    buffer_load_dwordx2 v[122:123], v1, s[16:19], s46 offen nt
    s_add_u32 s47, s33, 0x5400000
    buffer_load_dwordx4 v[92:95], v0, s[8:11], s47 offen nt
    v_and_b32 v7, -4, v40
    v_lshl_add_u32 v8, v40, 2, v7
    ds_write_b32 v8, v36
    v_lshl_add_u32 v7, v7, 2, v40
    ds_write_b8 v7, v26 offset:16
    v_and_b32 v9, -4, v41
    v_lshl_add_u32 v10, v41, 2, v9
    ds_write_b32 v10, v37
    v_lshl_add_u32 v9, v9, 2, v41
    ds_write_b8_d16_hi v9, v26 offset:16
    v_and_b32 v7, -4, v42
    v_lshl_add_u32 v8, v42, 2, v7
    ds_write_b32 v8, v38
    v_lshl_add_u32 v7, v7, 2, v42
    ds_write_b8 v7, v27 offset:16
    v_and_b32 v9, -4, v43
    v_lshl_add_u32 v10, v43, 2, v9
    ds_write_b32 v10, v39
    v_lshl_add_u32 v9, v9, 2, v43
    ds_write_b8_d16_hi v9, v27 offset:16
    s_add_u32 s44, s35, 0x24000
    buffer_store_dwordx4 v[84:87], v0, s[20:23], s44 offen sc1
    s_add_u32 s45, s33, 0x5400000
    buffer_load_dwordx4 v[16:19], v0, s[12:15], s45 offen nt
    s_setprio 0
    v_and_b32 v7, -4, v52
    v_lshl_add_u32 v8, v52, 2, v7
    ds_write_b32 v8, v48
    v_lshl_add_u32 v7, v7, 2, v52
    ds_write_b8 v7, v44 offset:16
    v_and_b32 v9, -4, v53
    v_lshl_add_u32 v10, v53, 2, v9
    ds_write_b32 v10, v49
    v_lshl_add_u32 v9, v9, 2, v53
    ds_write_b8_d16_hi v9, v44 offset:16
    v_and_b32 v7, -4, v54
    v_lshl_add_u32 v8, v54, 2, v7
    ds_write_b32 v8, v50
    v_lshl_add_u32 v7, v7, 2, v54
    ds_write_b8 v7, v45 offset:16
    v_and_b32 v9, -4, v55
    v_lshl_add_u32 v10, v55, 2, v9
    ds_write_b32 v10, v51
    v_lshl_add_u32 v9, v9, 2, v55
    ds_write_b8_d16_hi v9, v45 offset:16
    s_add_u32 s46, s33, 0x5800000
    buffer_load_dwordx4 v[20:23], v0, s[8:11], s46 offen nt
    s_add_u32 s47, s33, 0x5800000
    buffer_load_dwordx4 v[124:127], v0, s[12:15], s47 offen nt
    v_and_b32 v7, -4, v60
    v_lshl_add_u32 v8, v60, 2, v7
    ds_write_b32 v8, v56
    v_lshl_add_u32 v7, v7, 2, v60
    ds_write_b8 v7, v46 offset:16
    v_and_b32 v9, -4, v61
    v_lshl_add_u32 v10, v61, 2, v9
    ds_write_b32 v10, v57
    v_lshl_add_u32 v9, v9, 2, v61
    ds_write_b8_d16_hi v9, v46 offset:16
    v_and_b32 v7, -4, v62
    v_lshl_add_u32 v8, v62, 2, v7
    ds_write_b32 v8, v58
    v_lshl_add_u32 v7, v7, 2, v62
    ds_write_b8 v7, v47 offset:16
    v_and_b32 v9, -4, v63
    v_lshl_add_u32 v10, v63, 2, v9
    ds_write_b32 v10, v59
    v_lshl_add_u32 v9, v9, 2, v63
    ds_write_b8_d16_hi v9, v47 offset:16
    s_add_u32 s44, s34, 0x2c00000
    buffer_load_dwordx2 v[28:29], v1, s[16:19], s44 offen nt
    s_add_u32 s45, s34, 0x2e00000
    buffer_load_dwordx2 v[30:31], v1, s[16:19], s45 offen nt
    v_add_u32 v7, 0x10000, v0
    v_add_u32 v12, 0x20000, v0
    v_mov_b32 v8, 0
    v_mov_b32 v9, 0
    v_mov_b32 v10, 0
    v_mov_b32 v11, 0
    s_waitcnt lgkmcnt(0)
    s_barrier
    ds_read_b128 v[32:35], v0 offset:0
    ds_write_b128 v0, v[8:11]
    ds_read_b128 v[36:39], v0 offset:16384
    ds_read_b128 v[40:43], v0 offset:32768
    ds_read_b128 v[24:27], v0 offset:49152
    ds_read_b128 v[84:87], v7 offset:0
    ds_read_b128 v[48:51], v7 offset:16384
    ds_read_b128 v[52:55], v7 offset:32768
    ds_read_b128 v[56:59], v7 offset:49152
    ds_read_b128 v[60:63], v12 offset:0
    ds_read_b128 v[44:47], v12 offset:16384
    s_waitcnt lgkmcnt(0)
    s_barrier
    s_setprio 3
    s_add_u32 s46, s35, 0x2a40000
    buffer_store_dwordx4 v[32:35], v0, s[20:23], s46 offen sc1
    s_add_u32 s47, s33, 0x5c00000
    s_nop 0
    buffer_load_dwordx4 v[32:35], v0, s[8:11], s47 offen nt
    s_add_u32 s44, s35, 0x2a44000
    buffer_store_dwordx4 v[36:39], v0, s[20:23], s44 offen sc1
    s_add_u32 s45, s33, 0x5c00000
    s_nop 0
    buffer_load_dwordx4 v[36:39], v0, s[12:15], s45 offen nt
    s_waitcnt vmcnt(27)
    v_lshlrev_b32 v7, 16, v64
    v_and_b32 v8, 0xffff0000, v64
    v_lshlrev_b32 v9, 16, v65
    v_and_b32 v10, 0xffff0000, v65
    v_mul_f32 v7, 0.15915494, v7
    v_mul_f32 v8, 0.15915494, v8
    v_mul_f32 v9, 0.15915494, v9
    v_mul_f32 v10, 0.15915494, v10
    v_mul_hi_u32_u24 v14, 429497, v68
    v_lshrrev_b32 v12, 3, v72
    v_cos_f32 v7, v7
    v_lshlrev_b16 v13, 3, v72
    v_mad_i32_i24 v11, v14, s55, v68
    v_bitop3_b32 v12, v6, v13, v12 bitop3:0xca
    v_lshl_add_u32 v11, v11, 17, s40
    v_lshlrev_b16 v14, 8, v14
    v_lshrrev_b32 v13, 2, v72
    v_add_u32 v68, v12, v11
    v_bitop3_b32 v72, v5, v13, v14 bitop3:0xea
    ds_add_u32 v72, v2
    v_mul_hi_u32_u24 v14, 429497, v69
    v_lshrrev_b32 v12, 3, v73
    v_cos_f32 v8, v8
    v_lshlrev_b16 v13, 3, v73
    v_mad_i32_i24 v11, v14, s55, v69
    v_bitop3_b32 v12, v6, v13, v12 bitop3:0xca
    v_lshl_add_u32 v11, v11, 17, s40
    v_lshlrev_b16 v14, 8, v14
    v_lshrrev_b32 v13, 2, v73
    v_add_u32 v69, v12, v11
    v_bitop3_b32 v73, v5, v13, v14 bitop3:0xea
    ds_add_u32 v73, v2
    v_cvt_pk_bf16_f32 v64, v7, v8
    v_perm_b32 v12, v64, v64, s41
    v_bitop3_b32 v68, v4, v12, v68 bitop3:0xca
    v_perm_b32 v13, v64, v64, s42
    v_bitop3_b32 v69, v4, v13, v69 bitop3:0xca
    v_mul_hi_u32_u24 v14, 429497, v70
    v_lshrrev_b32 v12, 3, v74
    v_cos_f32 v9, v9
    v_lshlrev_b16 v13, 3, v74
    v_mad_i32_i24 v11, v14, s55, v70
    v_bitop3_b32 v12, v6, v13, v12 bitop3:0xca
    v_lshl_add_u32 v11, v11, 17, s40
    v_lshlrev_b16 v14, 8, v14
    v_lshrrev_b32 v13, 2, v74
    v_add_u32 v70, v12, v11
    v_bitop3_b32 v74, v5, v13, v14 bitop3:0xea
    ds_add_u32 v74, v2
    v_mul_hi_u32_u24 v14, 429497, v71
    v_lshrrev_b32 v12, 3, v75
    v_cos_f32 v10, v10
    v_lshlrev_b16 v13, 3, v75
    v_mad_i32_i24 v11, v14, s55, v71
    v_bitop3_b32 v12, v6, v13, v12 bitop3:0xca
    v_lshl_add_u32 v11, v11, 17, s40
    v_lshlrev_b16 v14, 8, v14
    v_lshrrev_b32 v13, 2, v75
    v_add_u32 v71, v12, v11
    v_bitop3_b32 v75, v5, v13, v14 bitop3:0xea
    ds_add_u32 v75, v2
    v_cvt_pk_bf16_f32 v65, v9, v10
    v_perm_b32 v12, v65, v65, s41
    v_bitop3_b32 v70, v4, v12, v70 bitop3:0xca
    v_perm_b32 v13, v65, v65, s42
    v_bitop3_b32 v71, v4, v13, v71 bitop3:0xca
    s_waitcnt vmcnt(23)
    v_lshlrev_b32 v7, 16, v66
    v_and_b32 v8, 0xffff0000, v66
    v_lshlrev_b32 v9, 16, v67
    v_and_b32 v10, 0xffff0000, v67
    v_mul_f32 v7, 0.15915494, v7
    v_mul_f32 v8, 0.15915494, v8
    v_mul_f32 v9, 0.15915494, v9
    v_mul_f32 v10, 0.15915494, v10
    v_mul_hi_u32_u24 v14, 429497, v76
    v_lshrrev_b32 v12, 3, v80
    v_cos_f32 v7, v7
    v_lshlrev_b16 v13, 3, v80
    v_mad_i32_i24 v11, v14, s55, v76
    v_bitop3_b32 v12, v6, v13, v12 bitop3:0xca
    v_lshl_add_u32 v11, v11, 17, s40
    v_lshlrev_b16 v14, 8, v14
    v_lshrrev_b32 v13, 2, v80
    v_add_u32 v76, v12, v11
    v_bitop3_b32 v80, v5, v13, v14 bitop3:0xea
    ds_add_u32 v80, v2
    v_mul_hi_u32_u24 v14, 429497, v77
    v_lshrrev_b32 v12, 3, v81
    v_cos_f32 v8, v8
    v_lshlrev_b16 v13, 3, v81
    v_mad_i32_i24 v11, v14, s55, v77
    v_bitop3_b32 v12, v6, v13, v12 bitop3:0xca
    v_lshl_add_u32 v11, v11, 17, s40
    v_lshlrev_b16 v14, 8, v14
    v_lshrrev_b32 v13, 2, v81
    v_add_u32 v77, v12, v11
    v_bitop3_b32 v81, v5, v13, v14 bitop3:0xea
    ds_add_u32 v81, v2
    v_cvt_pk_bf16_f32 v66, v7, v8
    v_perm_b32 v12, v66, v66, s41
    v_bitop3_b32 v76, v4, v12, v76 bitop3:0xca
    v_perm_b32 v13, v66, v66, s42
    v_bitop3_b32 v77, v4, v13, v77 bitop3:0xca
    v_mul_hi_u32_u24 v14, 429497, v78
    v_lshrrev_b32 v12, 3, v82
    v_cos_f32 v9, v9
    v_lshlrev_b16 v13, 3, v82
    v_mad_i32_i24 v11, v14, s55, v78
    v_bitop3_b32 v12, v6, v13, v12 bitop3:0xca
    v_lshl_add_u32 v11, v11, 17, s40
    v_lshlrev_b16 v14, 8, v14
    v_lshrrev_b32 v13, 2, v82
    v_add_u32 v78, v12, v11
    v_bitop3_b32 v82, v5, v13, v14 bitop3:0xea
    ds_add_u32 v82, v2
    v_mul_hi_u32_u24 v14, 429497, v79
    v_lshrrev_b32 v12, 3, v83
    v_cos_f32 v10, v10
    v_lshlrev_b16 v13, 3, v83
    v_mad_i32_i24 v11, v14, s55, v79
    v_bitop3_b32 v12, v6, v13, v12 bitop3:0xca
    v_lshl_add_u32 v11, v11, 17, s40
    v_lshlrev_b16 v14, 8, v14
    v_lshrrev_b32 v13, 2, v83
    v_add_u32 v79, v12, v11
    v_bitop3_b32 v83, v5, v13, v14 bitop3:0xea
    ds_add_u32 v83, v2
    v_cvt_pk_bf16_f32 v67, v9, v10
    v_perm_b32 v12, v67, v67, s41
    v_bitop3_b32 v78, v4, v12, v78 bitop3:0xca
    v_perm_b32 v13, v67, v67, s42
    v_bitop3_b32 v79, v4, v13, v79 bitop3:0xca
    s_setprio 2
    s_waitcnt vmcnt(18)
    v_lshlrev_b32 v7, 16, v88
    v_and_b32 v8, 0xffff0000, v88
    v_lshlrev_b32 v9, 16, v89
    v_and_b32 v10, 0xffff0000, v89
    v_mul_f32 v7, 0.15915494, v7
    v_mul_f32 v8, 0.15915494, v8
    v_mul_f32 v9, 0.15915494, v9
    v_mul_f32 v10, 0.15915494, v10
    v_mul_hi_u32_u24 v14, 429497, v96
    v_lshrrev_b32 v12, 3, v100
    v_cos_f32 v7, v7
    v_lshlrev_b16 v13, 3, v100
    v_mad_i32_i24 v11, v14, s55, v96
    v_bitop3_b32 v12, v6, v13, v12 bitop3:0xca
    v_lshl_add_u32 v11, v11, 17, s40
    v_lshlrev_b16 v14, 8, v14
    v_lshrrev_b32 v13, 2, v100
    v_add_u32 v96, v12, v11
    v_bitop3_b32 v100, v5, v13, v14 bitop3:0xea
    ds_add_u32 v100, v2
    v_mul_hi_u32_u24 v14, 429497, v97
    v_lshrrev_b32 v12, 3, v101
    v_cos_f32 v8, v8
    v_lshlrev_b16 v13, 3, v101
    v_mad_i32_i24 v11, v14, s55, v97
    v_bitop3_b32 v12, v6, v13, v12 bitop3:0xca
    v_lshl_add_u32 v11, v11, 17, s40
    v_lshlrev_b16 v14, 8, v14
    v_lshrrev_b32 v13, 2, v101
    v_add_u32 v97, v12, v11
    v_bitop3_b32 v101, v5, v13, v14 bitop3:0xea
    ds_add_u32 v101, v2
    v_cvt_pk_bf16_f32 v88, v7, v8
    v_perm_b32 v12, v88, v88, s41
    v_bitop3_b32 v96, v4, v12, v96 bitop3:0xca
    v_perm_b32 v13, v88, v88, s42
    v_bitop3_b32 v97, v4, v13, v97 bitop3:0xca
    v_mul_hi_u32_u24 v14, 429497, v98
    v_lshrrev_b32 v12, 3, v102
    v_cos_f32 v9, v9
    v_lshlrev_b16 v13, 3, v102
    v_mad_i32_i24 v11, v14, s55, v98
    v_bitop3_b32 v12, v6, v13, v12 bitop3:0xca
    v_lshl_add_u32 v11, v11, 17, s40
    v_lshlrev_b16 v14, 8, v14
    v_lshrrev_b32 v13, 2, v102
    v_add_u32 v98, v12, v11
    v_bitop3_b32 v102, v5, v13, v14 bitop3:0xea
    ds_add_u32 v102, v2
    v_mul_hi_u32_u24 v14, 429497, v99
    v_lshrrev_b32 v12, 3, v103
    v_cos_f32 v10, v10
    v_lshlrev_b16 v13, 3, v103
    v_mad_i32_i24 v11, v14, s55, v99
    v_bitop3_b32 v12, v6, v13, v12 bitop3:0xca
    v_lshl_add_u32 v11, v11, 17, s40
    v_lshlrev_b16 v14, 8, v14
    v_lshrrev_b32 v13, 2, v103
    v_add_u32 v99, v12, v11
    v_bitop3_b32 v103, v5, v13, v14 bitop3:0xea
    ds_add_u32 v103, v2
    v_cvt_pk_bf16_f32 v89, v9, v10
    v_perm_b32 v12, v89, v89, s41
    v_bitop3_b32 v98, v4, v12, v98 bitop3:0xca
    v_perm_b32 v13, v89, v89, s42
    v_bitop3_b32 v99, v4, v13, v99 bitop3:0xca
    s_add_u32 s46, s35, 0x2a48000
    buffer_store_dwordx4 v[40:43], v0, s[20:23], s46 offen sc1
    s_add_u32 s47, s33, 0x6000000
    s_nop 0
    buffer_load_dwordx4 v[40:43], v0, s[8:11], s47 offen nt
    s_waitcnt vmcnt(17)
    v_lshlrev_b32 v7, 16, v90
    v_and_b32 v8, 0xffff0000, v90
    v_lshlrev_b32 v9, 16, v91
    v_and_b32 v10, 0xffff0000, v91
    v_mul_f32 v7, 0.15915494, v7
    v_mul_f32 v8, 0.15915494, v8
    v_mul_f32 v9, 0.15915494, v9
    v_mul_f32 v10, 0.15915494, v10
    v_mul_hi_u32_u24 v14, 429497, v108
    v_lshrrev_b32 v12, 3, v112
    v_cos_f32 v7, v7
    v_lshlrev_b16 v13, 3, v112
    v_mad_i32_i24 v11, v14, s55, v108
    v_bitop3_b32 v12, v6, v13, v12 bitop3:0xca
    v_lshl_add_u32 v11, v11, 17, s40
    v_lshlrev_b16 v14, 8, v14
    v_lshrrev_b32 v13, 2, v112
    v_add_u32 v108, v12, v11
    v_bitop3_b32 v112, v5, v13, v14 bitop3:0xea
    ds_add_u32 v112, v2
    v_mul_hi_u32_u24 v14, 429497, v109
    v_lshrrev_b32 v12, 3, v113
    v_cos_f32 v8, v8
    v_lshlrev_b16 v13, 3, v113
    v_mad_i32_i24 v11, v14, s55, v109
    v_bitop3_b32 v12, v6, v13, v12 bitop3:0xca
    v_lshl_add_u32 v11, v11, 17, s40
    v_lshlrev_b16 v14, 8, v14
    v_lshrrev_b32 v13, 2, v113
    v_add_u32 v109, v12, v11
    v_bitop3_b32 v113, v5, v13, v14 bitop3:0xea
    ds_add_u32 v113, v2
    v_cvt_pk_bf16_f32 v90, v7, v8
    v_perm_b32 v12, v90, v90, s41
    v_bitop3_b32 v108, v4, v12, v108 bitop3:0xca
    v_perm_b32 v13, v90, v90, s42
    v_bitop3_b32 v109, v4, v13, v109 bitop3:0xca
    v_mul_hi_u32_u24 v14, 429497, v110
    v_lshrrev_b32 v12, 3, v114
    v_cos_f32 v9, v9
    v_lshlrev_b16 v13, 3, v114
    v_mad_i32_i24 v11, v14, s55, v110
    v_bitop3_b32 v12, v6, v13, v12 bitop3:0xca
    v_lshl_add_u32 v11, v11, 17, s40
    v_lshlrev_b16 v14, 8, v14
    v_lshrrev_b32 v13, 2, v114
    v_add_u32 v110, v12, v11
    v_bitop3_b32 v114, v5, v13, v14 bitop3:0xea
    ds_add_u32 v114, v2
    v_mul_hi_u32_u24 v14, 429497, v111
    v_lshrrev_b32 v12, 3, v115
    v_cos_f32 v10, v10
    v_lshlrev_b16 v13, 3, v115
    v_mad_i32_i24 v11, v14, s55, v111
    v_bitop3_b32 v12, v6, v13, v12 bitop3:0xca
    v_lshl_add_u32 v11, v11, 17, s40
    v_lshlrev_b16 v14, 8, v14
    v_lshrrev_b32 v13, 2, v115
    v_add_u32 v111, v12, v11
    v_bitop3_b32 v115, v5, v13, v14 bitop3:0xea
    ds_add_u32 v115, v2
    v_cvt_pk_bf16_f32 v91, v9, v10
    v_perm_b32 v12, v91, v91, s41
    v_bitop3_b32 v110, v4, v12, v110 bitop3:0xca
    v_perm_b32 v13, v91, v91, s42
    v_bitop3_b32 v111, v4, v13, v111 bitop3:0xca
    s_setprio 1
    s_waitcnt vmcnt(13)
    v_lshlrev_b32 v7, 16, v120
    v_and_b32 v8, 0xffff0000, v120
    v_lshlrev_b32 v9, 16, v121
    v_and_b32 v10, 0xffff0000, v121
    v_mul_f32 v7, 0.15915494, v7
    v_mul_f32 v8, 0.15915494, v8
    v_mul_f32 v9, 0.15915494, v9
    v_mul_f32 v10, 0.15915494, v10
    v_mul_hi_u32_u24 v14, 429497, v104
    v_lshrrev_b32 v12, 3, v116
    v_cos_f32 v7, v7
    v_lshlrev_b16 v13, 3, v116
    v_mad_i32_i24 v11, v14, s55, v104
    v_bitop3_b32 v12, v6, v13, v12 bitop3:0xca
    v_lshl_add_u32 v11, v11, 17, s40
    v_lshlrev_b16 v14, 8, v14
    v_lshrrev_b32 v13, 2, v116
    v_add_u32 v104, v12, v11
    v_bitop3_b32 v116, v5, v13, v14 bitop3:0xea
    ds_add_u32 v116, v2
    v_mul_hi_u32_u24 v14, 429497, v105
    v_lshrrev_b32 v12, 3, v117
    v_cos_f32 v8, v8
    v_lshlrev_b16 v13, 3, v117
    v_mad_i32_i24 v11, v14, s55, v105
    v_bitop3_b32 v12, v6, v13, v12 bitop3:0xca
    v_lshl_add_u32 v11, v11, 17, s40
    v_lshlrev_b16 v14, 8, v14
    v_lshrrev_b32 v13, 2, v117
    v_add_u32 v105, v12, v11
    v_bitop3_b32 v117, v5, v13, v14 bitop3:0xea
    ds_add_u32 v117, v2
    v_cvt_pk_bf16_f32 v120, v7, v8
    v_perm_b32 v12, v120, v120, s41
    v_bitop3_b32 v104, v4, v12, v104 bitop3:0xca
    v_perm_b32 v13, v120, v120, s42
    v_bitop3_b32 v105, v4, v13, v105 bitop3:0xca
    v_mul_hi_u32_u24 v14, 429497, v106
    v_lshrrev_b32 v12, 3, v118
    v_cos_f32 v9, v9
    v_lshlrev_b16 v13, 3, v118
    v_mad_i32_i24 v11, v14, s55, v106
    v_bitop3_b32 v12, v6, v13, v12 bitop3:0xca
    v_lshl_add_u32 v11, v11, 17, s40
    v_lshlrev_b16 v14, 8, v14
    v_lshrrev_b32 v13, 2, v118
    v_add_u32 v106, v12, v11
    v_bitop3_b32 v118, v5, v13, v14 bitop3:0xea
    ds_add_u32 v118, v2
    v_mul_hi_u32_u24 v14, 429497, v107
    v_lshrrev_b32 v12, 3, v119
    v_cos_f32 v10, v10
    v_lshlrev_b16 v13, 3, v119
    v_mad_i32_i24 v11, v14, s55, v107
    v_bitop3_b32 v12, v6, v13, v12 bitop3:0xca
    v_lshl_add_u32 v11, v11, 17, s40
    v_lshlrev_b16 v14, 8, v14
    v_lshrrev_b32 v13, 2, v119
    v_add_u32 v107, v12, v11
    v_bitop3_b32 v119, v5, v13, v14 bitop3:0xea
    ds_add_u32 v119, v2
    v_cvt_pk_bf16_f32 v121, v9, v10
    v_perm_b32 v12, v121, v121, s41
    v_bitop3_b32 v106, v4, v12, v106 bitop3:0xca
    v_perm_b32 v13, v121, v121, s42
    v_bitop3_b32 v107, v4, v13, v107 bitop3:0xca
    s_waitcnt vmcnt(10)
    v_lshlrev_b32 v7, 16, v122
    v_and_b32 v8, 0xffff0000, v122
    v_lshlrev_b32 v9, 16, v123
    v_and_b32 v10, 0xffff0000, v123
    v_mul_f32 v7, 0.15915494, v7
    v_mul_f32 v8, 0.15915494, v8
    v_mul_f32 v9, 0.15915494, v9
    v_mul_f32 v10, 0.15915494, v10
    v_mul_hi_u32_u24 v14, 429497, v92
    v_lshrrev_b32 v12, 3, v16
    v_cos_f32 v7, v7
    v_lshlrev_b16 v13, 3, v16
    v_mad_i32_i24 v11, v14, s55, v92
    v_bitop3_b32 v12, v6, v13, v12 bitop3:0xca
    v_lshl_add_u32 v11, v11, 17, s40
    v_lshlrev_b16 v14, 8, v14
    v_lshrrev_b32 v13, 2, v16
    v_add_u32 v92, v12, v11
    v_bitop3_b32 v16, v5, v13, v14 bitop3:0xea
    ds_add_u32 v16, v2
    v_mul_hi_u32_u24 v14, 429497, v93
    v_lshrrev_b32 v12, 3, v17
    v_cos_f32 v8, v8
    v_lshlrev_b16 v13, 3, v17
    v_mad_i32_i24 v11, v14, s55, v93
    v_bitop3_b32 v12, v6, v13, v12 bitop3:0xca
    v_lshl_add_u32 v11, v11, 17, s40
    v_lshlrev_b16 v14, 8, v14
    v_lshrrev_b32 v13, 2, v17
    v_add_u32 v93, v12, v11
    v_bitop3_b32 v17, v5, v13, v14 bitop3:0xea
    ds_add_u32 v17, v2
    v_cvt_pk_bf16_f32 v122, v7, v8
    v_perm_b32 v12, v122, v122, s41
    v_bitop3_b32 v92, v4, v12, v92 bitop3:0xca
    v_perm_b32 v13, v122, v122, s42
    v_bitop3_b32 v93, v4, v13, v93 bitop3:0xca
    v_mul_hi_u32_u24 v14, 429497, v94
    v_lshrrev_b32 v12, 3, v18
    v_cos_f32 v9, v9
    v_lshlrev_b16 v13, 3, v18
    v_mad_i32_i24 v11, v14, s55, v94
    v_bitop3_b32 v12, v6, v13, v12 bitop3:0xca
    v_lshl_add_u32 v11, v11, 17, s40
    v_lshlrev_b16 v14, 8, v14
    v_lshrrev_b32 v13, 2, v18
    v_add_u32 v94, v12, v11
    v_bitop3_b32 v18, v5, v13, v14 bitop3:0xea
    ds_add_u32 v18, v2
    v_mul_hi_u32_u24 v14, 429497, v95
    v_lshrrev_b32 v12, 3, v19
    v_cos_f32 v10, v10
    v_lshlrev_b16 v13, 3, v19
    v_mad_i32_i24 v11, v14, s55, v95
    v_bitop3_b32 v12, v6, v13, v12 bitop3:0xca
    v_lshl_add_u32 v11, v11, 17, s40
    v_lshlrev_b16 v14, 8, v14
    v_lshrrev_b32 v13, 2, v19
    v_add_u32 v95, v12, v11
    v_bitop3_b32 v19, v5, v13, v14 bitop3:0xea
    ds_add_u32 v19, v2
    v_cvt_pk_bf16_f32 v123, v9, v10
    v_perm_b32 v12, v123, v123, s41
    v_bitop3_b32 v94, v4, v12, v94 bitop3:0xca
    v_perm_b32 v13, v123, v123, s42
    v_bitop3_b32 v95, v4, v13, v95 bitop3:0xca
    s_setprio 0
    s_add_u32 s44, s35, 0x2a4c000
    buffer_store_dwordx4 v[24:27], v0, s[20:23], s44 offen sc1
    s_add_u32 s45, s33, 0x6000000
    s_nop 0
    buffer_load_dwordx4 v[24:27], v0, s[12:15], s45 offen nt
    s_waitcnt vmcnt(8)
    v_lshlrev_b32 v7, 16, v28
    v_and_b32 v8, 0xffff0000, v28
    v_lshlrev_b32 v9, 16, v29
    v_and_b32 v10, 0xffff0000, v29
    v_mul_f32 v7, 0.15915494, v7
    v_mul_f32 v8, 0.15915494, v8
    v_mul_f32 v9, 0.15915494, v9
    v_mul_f32 v10, 0.15915494, v10
    v_mul_hi_u32_u24 v14, 429497, v20
    v_lshrrev_b32 v12, 3, v124
    v_cos_f32 v7, v7
    v_lshlrev_b16 v13, 3, v124
    v_mad_i32_i24 v11, v14, s55, v20
    v_bitop3_b32 v12, v6, v13, v12 bitop3:0xca
    v_lshl_add_u32 v11, v11, 17, s40
    v_lshlrev_b16 v14, 8, v14
    v_lshrrev_b32 v13, 2, v124
    v_add_u32 v20, v12, v11
    v_bitop3_b32 v124, v5, v13, v14 bitop3:0xea
    ds_add_u32 v124, v2
    v_mul_hi_u32_u24 v14, 429497, v21
    v_lshrrev_b32 v12, 3, v125
    v_cos_f32 v8, v8
    v_lshlrev_b16 v13, 3, v125
    v_mad_i32_i24 v11, v14, s55, v21
    v_bitop3_b32 v12, v6, v13, v12 bitop3:0xca
    v_lshl_add_u32 v11, v11, 17, s40
    v_lshlrev_b16 v14, 8, v14
    v_lshrrev_b32 v13, 2, v125
    v_add_u32 v21, v12, v11
    v_bitop3_b32 v125, v5, v13, v14 bitop3:0xea
    ds_add_u32 v125, v2
    v_cvt_pk_bf16_f32 v28, v7, v8
    v_perm_b32 v12, v28, v28, s41
    v_bitop3_b32 v20, v4, v12, v20 bitop3:0xca
    v_perm_b32 v13, v28, v28, s42
    v_bitop3_b32 v21, v4, v13, v21 bitop3:0xca
    v_mul_hi_u32_u24 v14, 429497, v22
    v_lshrrev_b32 v12, 3, v126
    v_cos_f32 v9, v9
    v_lshlrev_b16 v13, 3, v126
    v_mad_i32_i24 v11, v14, s55, v22
    v_bitop3_b32 v12, v6, v13, v12 bitop3:0xca
    v_lshl_add_u32 v11, v11, 17, s40
    v_lshlrev_b16 v14, 8, v14
    v_lshrrev_b32 v13, 2, v126
    v_add_u32 v22, v12, v11
    v_bitop3_b32 v126, v5, v13, v14 bitop3:0xea
    ds_add_u32 v126, v2
    v_mul_hi_u32_u24 v14, 429497, v23
    v_lshrrev_b32 v12, 3, v127
    v_cos_f32 v10, v10
    v_lshlrev_b16 v13, 3, v127
    v_mad_i32_i24 v11, v14, s55, v23
    v_bitop3_b32 v12, v6, v13, v12 bitop3:0xca
    v_lshl_add_u32 v11, v11, 17, s40
    v_lshlrev_b16 v14, 8, v14
    v_lshrrev_b32 v13, 2, v127
    v_add_u32 v23, v12, v11
    v_bitop3_b32 v127, v5, v13, v14 bitop3:0xea
    ds_add_u32 v127, v2
    v_cvt_pk_bf16_f32 v29, v9, v10
    v_perm_b32 v12, v29, v29, s41
    v_bitop3_b32 v22, v4, v12, v22 bitop3:0xca
    v_perm_b32 v13, v29, v29, s42
    v_bitop3_b32 v23, v4, v13, v23 bitop3:0xca
    s_waitcnt vmcnt(4)
    v_lshlrev_b32 v7, 16, v30
    v_and_b32 v8, 0xffff0000, v30
    v_lshlrev_b32 v9, 16, v31
    v_and_b32 v10, 0xffff0000, v31
    v_mul_f32 v7, 0.15915494, v7
    v_mul_f32 v8, 0.15915494, v8
    v_mul_f32 v9, 0.15915494, v9
    v_mul_f32 v10, 0.15915494, v10
    v_mul_hi_u32_u24 v14, 429497, v32
    v_lshrrev_b32 v12, 3, v36
    v_cos_f32 v7, v7
    v_lshlrev_b16 v13, 3, v36
    v_mad_i32_i24 v11, v14, s55, v32
    v_bitop3_b32 v12, v6, v13, v12 bitop3:0xca
    v_lshl_add_u32 v11, v11, 17, s40
    v_lshlrev_b16 v14, 8, v14
    v_lshrrev_b32 v13, 2, v36
    v_add_u32 v32, v12, v11
    v_bitop3_b32 v36, v5, v13, v14 bitop3:0xea
    ds_add_u32 v36, v2
    v_mul_hi_u32_u24 v14, 429497, v33
    v_lshrrev_b32 v12, 3, v37
    v_cos_f32 v8, v8
    v_lshlrev_b16 v13, 3, v37
    v_mad_i32_i24 v11, v14, s55, v33
    v_bitop3_b32 v12, v6, v13, v12 bitop3:0xca
    v_lshl_add_u32 v11, v11, 17, s40
    v_lshlrev_b16 v14, 8, v14
    v_lshrrev_b32 v13, 2, v37
    v_add_u32 v33, v12, v11
    v_bitop3_b32 v37, v5, v13, v14 bitop3:0xea
    ds_add_u32 v37, v2
    v_cvt_pk_bf16_f32 v30, v7, v8
    v_perm_b32 v12, v30, v30, s41
    v_bitop3_b32 v32, v4, v12, v32 bitop3:0xca
    v_perm_b32 v13, v30, v30, s42
    v_bitop3_b32 v33, v4, v13, v33 bitop3:0xca
    v_mul_hi_u32_u24 v14, 429497, v34
    v_lshrrev_b32 v12, 3, v38
    v_cos_f32 v9, v9
    v_lshlrev_b16 v13, 3, v38
    v_mad_i32_i24 v11, v14, s55, v34
    v_bitop3_b32 v12, v6, v13, v12 bitop3:0xca
    v_lshl_add_u32 v11, v11, 17, s40
    v_lshlrev_b16 v14, 8, v14
    v_lshrrev_b32 v13, 2, v38
    v_add_u32 v34, v12, v11
    v_bitop3_b32 v38, v5, v13, v14 bitop3:0xea
    ds_add_u32 v38, v2
    v_mul_hi_u32_u24 v14, 429497, v35
    v_lshrrev_b32 v12, 3, v39
    v_cos_f32 v10, v10
    v_lshlrev_b16 v13, 3, v39
    v_mad_i32_i24 v11, v14, s55, v35
    v_bitop3_b32 v12, v6, v13, v12 bitop3:0xca
    v_lshl_add_u32 v11, v11, 17, s40
    v_lshlrev_b16 v14, 8, v14
    v_lshrrev_b32 v13, 2, v39
    v_add_u32 v35, v12, v11
    v_bitop3_b32 v39, v5, v13, v14 bitop3:0xea
    ds_add_u32 v39, v2
    v_cvt_pk_bf16_f32 v31, v9, v10
    v_perm_b32 v12, v31, v31, s41
    v_bitop3_b32 v34, v4, v12, v34 bitop3:0xca
    v_perm_b32 v13, v31, v31, s42
    v_bitop3_b32 v35, v4, v13, v35 bitop3:0xca
    v_lshrrev_b32 v8, 2, v0
    v_and_b32 v7, 0x3c00, v0
    v_bitop3_b32 v7, v5, v8, v7 bitop3:0xea
    s_waitcnt lgkmcnt(0)
    s_barrier
    ds_read2st64_b32 v[8:9], v7 offset0:0 offset1:1
    ds_read2st64_b32 v[10:11], v7 offset0:2 offset1:3
    s_add_u32 s46, s35, 0x2a50000
    buffer_store_dwordx4 v[84:87], v0, s[20:23], s46 offen sc1
    s_add_u32 s47, s34, 0x3000000
    s_nop 0
    buffer_load_dwordx2 v[84:85], v1, s[16:19], s47 offen nt
    s_add_u32 s44, s34, 0x3200000
    buffer_load_dwordx2 v[86:87], v1, s[16:19], s44 offen nt
    s_waitcnt lgkmcnt(0)
    v_lshl_or_b32 v12, v9, 16, v8
    v_lshl_or_b32 v13, v11, 16, v10
    v_mov_b32 v14, v12
    v_mov_b32 v15, v13
    s_nop 0
    v_add_u32_dpp v14, v14, v14 row_shr:1 row_mask:0xf bank_mask:0xf bound_ctrl:1
    v_add_u32_dpp v15, v15, v15 row_shr:1 row_mask:0xf bank_mask:0xf bound_ctrl:1
    s_nop 0
    v_add_u32_dpp v14, v14, v14 row_shr:2 row_mask:0xf bank_mask:0xf bound_ctrl:1
    v_add_u32_dpp v15, v15, v15 row_shr:2 row_mask:0xf bank_mask:0xf bound_ctrl:1
    s_nop 0
    v_add_u32_dpp v14, v14, v14 row_shr:4 row_mask:0xf bank_mask:0xf bound_ctrl:1
    v_add_u32_dpp v15, v15, v15 row_shr:4 row_mask:0xf bank_mask:0xf bound_ctrl:1
    s_nop 0
    v_add_u32_dpp v14, v14, v14 row_shr:8 row_mask:0xf bank_mask:0xf bound_ctrl:1
    v_add_u32_dpp v15, v15, v15 row_shr:8 row_mask:0xf bank_mask:0xf bound_ctrl:1
    s_nop 0
    v_add_u32_dpp v14, v14, v14 row_bcast:15 row_mask:0xa bank_mask:0xf
    v_add_u32_dpp v15, v15, v15 row_bcast:15 row_mask:0xa bank_mask:0xf
    s_nop 0
    v_add_u32_dpp v14, v14, v14 row_bcast:31 row_mask:0xc bank_mask:0xf
    v_add_u32_dpp v15, v15, v15 row_bcast:31 row_mask:0xc bank_mask:0xf
    v_readlane_b32 s48, v14, 63
    v_readlane_b32 s49, v15, 63
    s_lshl_b32 s54, s32, 2
    v_mov_b32 v8, s54
    s_and_b32 s50, s48, 0xffff
    s_lshr_b32 s51, s48, 16
    s_and_b32 s52, s49, 0xffff
    s_lshr_b32 s53, s49, 16
    s_add_u32 s51, s51, s50
    s_add_u32 s52, s52, s51
    s_add_u32 s53, s53, s52
    v_mov_b32 v9, s53
    s_mov_b64 exec, 1
    ds_write_b32 v8, v9 offset:16384
    s_mov_b64 exec, -1
    v_and_b32 v8, 60, v7
    s_waitcnt lgkmcnt(0)
    s_barrier
    ds_read_b32 v9, v8 offset:16384
    s_waitcnt lgkmcnt(0)
    v_add_u32_dpp v9, v9, v9 row_shr:1 row_mask:0xf bank_mask:0xf bound_ctrl:1
    s_nop 1
    v_add_u32_dpp v9, v9, v9 row_shr:2 row_mask:0xf bank_mask:0xf bound_ctrl:1
    s_nop 1
    v_add_u32_dpp v9, v9, v9 row_shr:4 row_mask:0xf bank_mask:0xf bound_ctrl:1
    s_nop 1
    v_add_u32_dpp v9, v9, v9 row_shr:8 row_mask:0xf bank_mask:0xf bound_ctrl:1
    s_nop 0
    v_readlane_b32 s54, v9, s32
    s_sub_u32 s54, s54, s53
    s_add_u32 s50, s50, s54
    s_add_u32 s51, s51, s54
    s_add_u32 s52, s52, s54
    s_pack_ll_b32_b16 s48, s54, s50
    s_pack_ll_b32_b16 s49, s51, s52
    v_add_u32 v14, s48, v14
    v_add_u32 v15, s49, v15
    v_sub_u32 v12, v14, v12
    v_sub_u32 v13, v15, v13
    v_and_b32 v8, 0xffff, v12
    v_lshrrev_b32 v9, 16, v12
    v_and_b32 v10, 0xffff, v13
    v_lshrrev_b32 v11, 16, v13
    ds_write2st64_b32 v7, v8, v9 offset0:0 offset1:1
    ds_write2st64_b32 v7, v10, v11 offset0:2 offset1:3
    v_and_b32 v8, 0x3f0, v0
    v_lshl_add_u32 v8, v8, 1, s36
    ds_write_b64 v8, v[12:13] offset:20480
    s_bitset0_b64 exec, 63
    s_not_b64 exec, exec
    ds_write_b64 v8, v[14:15] offset:20512
    s_mov_b64 exec, -1
    s_waitcnt lgkmcnt(0)
    s_barrier
    s_setprio 3
    ds_add_rtn_u32 v72, v72, v2
    ds_add_rtn_u32 v73, v73, v2
    ds_add_rtn_u32 v74, v74, v2
    ds_add_rtn_u32 v75, v75, v2
    ds_read_b128 v[12:15], v0 offset:20480
    v_cmp_gt_u32 vcc, 8448, v0
    ds_add_rtn_u32 v80, v80, v2
    ds_add_rtn_u32 v81, v81, v2
    ds_add_rtn_u32 v82, v82, v2
    ds_add_rtn_u32 v83, v83, v2
    s_setprio 2
    ds_add_rtn_u32 v100, v100, v2
    ds_add_rtn_u32 v101, v101, v2
    ds_add_rtn_u32 v102, v102, v2
    ds_add_rtn_u32 v103, v103, v2
    s_waitcnt lgkmcnt(8)
    s_cbranch_vccz L1_p3
    s_add_u32 s45, s35, 0x5480000
    s_mov_b64 exec, vcc
    buffer_store_dwordx4 v[12:15], v0, s[24:27], s45 offen sc1
    s_mov_b64 exec, -1
L1_p3:
    s_add_u32 s46, s35, 0x2a54000
    buffer_store_dwordx4 v[48:51], v0, s[20:23], s46 offen sc1
    s_add_u32 s47, s33, 0x6400000
    s_nop 0
    buffer_load_dwordx4 v[48:51], v0, s[8:11], s47 offen nt
    ds_add_rtn_u32 v112, v112, v2
    ds_add_rtn_u32 v113, v113, v2
    ds_add_rtn_u32 v114, v114, v2
    ds_add_rtn_u32 v115, v115, v2
    s_setprio 1
    ds_add_rtn_u32 v116, v116, v2
    ds_add_rtn_u32 v117, v117, v2
    ds_add_rtn_u32 v118, v118, v2
    ds_add_rtn_u32 v119, v119, v2
    ds_add_rtn_u32 v16, v16, v2
    ds_add_rtn_u32 v17, v17, v2
    ds_add_rtn_u32 v18, v18, v2
    ds_add_rtn_u32 v19, v19, v2
    s_add_u32 s44, s35, 0x2a58000
    buffer_store_dwordx4 v[52:55], v0, s[20:23], s44 offen sc1
    s_add_u32 s45, s33, 0x6400000
    s_nop 0
    buffer_load_dwordx4 v[52:55], v0, s[12:15], s45 offen nt
    s_setprio 0
    ds_add_rtn_u32 v124, v124, v2
    ds_add_rtn_u32 v125, v125, v2
    ds_add_rtn_u32 v126, v126, v2
    ds_add_rtn_u32 v127, v127, v2
    ds_add_rtn_u32 v36, v36, v2
    ds_add_rtn_u32 v37, v37, v2
    ds_add_rtn_u32 v38, v38, v2
    ds_add_rtn_u32 v39, v39, v2
    s_waitcnt lgkmcnt(0)
    s_barrier
    s_setprio 3
    v_and_b32 v7, -4, v72
    v_lshl_add_u32 v8, v72, 2, v7
    ds_write_b32 v8, v68
    v_lshl_add_u32 v7, v7, 2, v72
    ds_write_b8 v7, v64 offset:16
    v_and_b32 v9, -4, v73
    v_lshl_add_u32 v10, v73, 2, v9
    ds_write_b32 v10, v69
    v_lshl_add_u32 v9, v9, 2, v73
    ds_write_b8_d16_hi v9, v64 offset:16
    v_and_b32 v7, -4, v74
    v_lshl_add_u32 v8, v74, 2, v7
    ds_write_b32 v8, v70
    v_lshl_add_u32 v7, v7, 2, v74
    ds_write_b8 v7, v65 offset:16
    v_and_b32 v9, -4, v75
    v_lshl_add_u32 v10, v75, 2, v9
    ds_write_b32 v10, v71
    v_lshl_add_u32 v9, v9, 2, v75
    ds_write_b8_d16_hi v9, v65 offset:16
    s_add_u32 s46, s35, 0x2a5c000
    buffer_store_dwordx4 v[56:59], v0, s[20:23], s46 offen sc1
    s_add_u32 s47, s33, 0x6800000
    buffer_load_dwordx4 v[68:71], v0, s[8:11], s47 offen nt
    s_add_u32 s44, s33, 0x6800000
    buffer_load_dwordx4 v[72:75], v0, s[12:15], s44 offen nt
    v_and_b32 v7, -4, v80
    v_lshl_add_u32 v8, v80, 2, v7
    ds_write_b32 v8, v76
    v_lshl_add_u32 v7, v7, 2, v80
    ds_write_b8 v7, v66 offset:16
    v_and_b32 v9, -4, v81
    v_lshl_add_u32 v10, v81, 2, v9
    ds_write_b32 v10, v77
    v_lshl_add_u32 v9, v9, 2, v81
    ds_write_b8_d16_hi v9, v66 offset:16
    v_and_b32 v7, -4, v82
    v_lshl_add_u32 v8, v82, 2, v7
    ds_write_b32 v8, v78
    v_lshl_add_u32 v7, v7, 2, v82
    ds_write_b8 v7, v67 offset:16
    v_and_b32 v9, -4, v83
    v_lshl_add_u32 v10, v83, 2, v9
    ds_write_b32 v10, v79
    v_lshl_add_u32 v9, v9, 2, v83
    ds_write_b8_d16_hi v9, v67 offset:16
    s_add_u32 s45, s34, 0x3400000
    buffer_load_dwordx2 v[56:57], v1, s[16:19], s45 offen nt
    s_add_u32 s46, s34, 0x3600000
    buffer_load_dwordx2 v[58:59], v1, s[16:19], s46 offen nt
    s_add_u32 s47, s33, 0x6c00000
    buffer_load_dwordx4 v[76:79], v0, s[8:11], s47 offen nt
    s_setprio 2
    v_and_b32 v7, -4, v100
    v_lshl_add_u32 v8, v100, 2, v7
    ds_write_b32 v8, v96
    v_lshl_add_u32 v7, v7, 2, v100
    ds_write_b8 v7, v88 offset:16
    v_and_b32 v9, -4, v101
    v_lshl_add_u32 v10, v101, 2, v9
    ds_write_b32 v10, v97
    v_lshl_add_u32 v9, v9, 2, v101
    ds_write_b8_d16_hi v9, v88 offset:16
    v_and_b32 v7, -4, v102
    v_lshl_add_u32 v8, v102, 2, v7
    ds_write_b32 v8, v98
    v_lshl_add_u32 v7, v7, 2, v102
    ds_write_b8 v7, v89 offset:16
    v_and_b32 v9, -4, v103
    v_lshl_add_u32 v10, v103, 2, v9
    ds_write_b32 v10, v99
    v_lshl_add_u32 v9, v9, 2, v103
    ds_write_b8_d16_hi v9, v89 offset:16
    s_add_u32 s44, s35, 0x2a60000
    buffer_store_dwordx4 v[60:63], v0, s[20:23], s44 offen sc1
    s_add_u32 s45, s33, 0x6c00000
    buffer_load_dwordx4 v[80:83], v0, s[12:15], s45 offen nt
    v_and_b32 v7, -4, v112
    v_lshl_add_u32 v8, v112, 2, v7
    ds_write_b32 v8, v108
    v_lshl_add_u32 v7, v7, 2, v112
    ds_write_b8 v7, v90 offset:16
    v_and_b32 v9, -4, v113
    v_lshl_add_u32 v10, v113, 2, v9
    ds_write_b32 v10, v109
    v_lshl_add_u32 v9, v9, 2, v113
    ds_write_b8_d16_hi v9, v90 offset:16
    v_and_b32 v7, -4, v114
    v_lshl_add_u32 v8, v114, 2, v7
    ds_write_b32 v8, v110
    v_lshl_add_u32 v7, v7, 2, v114
    ds_write_b8 v7, v91 offset:16
    v_and_b32 v9, -4, v115
    v_lshl_add_u32 v10, v115, 2, v9
    ds_write_b32 v10, v111
    v_lshl_add_u32 v9, v9, 2, v115
    ds_write_b8_d16_hi v9, v91 offset:16
    s_add_u32 s46, s33, 0x7000000
    buffer_load_dwordx4 v[64:67], v0, s[8:11], s46 offen nt
    s_add_u32 s47, s33, 0x7000000
    buffer_load_dwordx4 v[96:99], v0, s[12:15], s47 offen nt
    s_setprio 1
    v_and_b32 v7, -4, v116
    v_lshl_add_u32 v8, v116, 2, v7
    ds_write_b32 v8, v104
    v_lshl_add_u32 v7, v7, 2, v116
    ds_write_b8 v7, v120 offset:16
    v_and_b32 v9, -4, v117
    v_lshl_add_u32 v10, v117, 2, v9
    ds_write_b32 v10, v105
    v_lshl_add_u32 v9, v9, 2, v117
    ds_write_b8_d16_hi v9, v120 offset:16
    v_and_b32 v7, -4, v118
    v_lshl_add_u32 v8, v118, 2, v7
    ds_write_b32 v8, v106
    v_lshl_add_u32 v7, v7, 2, v118
    ds_write_b8 v7, v121 offset:16
    v_and_b32 v9, -4, v119
    v_lshl_add_u32 v10, v119, 2, v9
    ds_write_b32 v10, v107
    v_lshl_add_u32 v9, v9, 2, v119
    ds_write_b8_d16_hi v9, v121 offset:16
    s_add_u32 s44, s34, 0x3800000
    buffer_load_dwordx2 v[100:101], v1, s[16:19], s44 offen nt
    s_add_u32 s45, s34, 0x3a00000
    buffer_load_dwordx2 v[102:103], v1, s[16:19], s45 offen nt
    s_add_u32 s46, s33, 0x7400000
    buffer_load_dwordx4 v[60:63], v0, s[8:11], s46 offen nt
    v_and_b32 v7, -4, v16
    v_lshl_add_u32 v8, v16, 2, v7
    ds_write_b32 v8, v92
    v_lshl_add_u32 v7, v7, 2, v16
    ds_write_b8 v7, v122 offset:16
    v_and_b32 v9, -4, v17
    v_lshl_add_u32 v10, v17, 2, v9
    ds_write_b32 v10, v93
    v_lshl_add_u32 v9, v9, 2, v17
    ds_write_b8_d16_hi v9, v122 offset:16
    v_and_b32 v7, -4, v18
    v_lshl_add_u32 v8, v18, 2, v7
    ds_write_b32 v8, v94
    v_lshl_add_u32 v7, v7, 2, v18
    ds_write_b8 v7, v123 offset:16
    v_and_b32 v9, -4, v19
    v_lshl_add_u32 v10, v19, 2, v9
    ds_write_b32 v10, v95
    v_lshl_add_u32 v9, v9, 2, v19
    ds_write_b8_d16_hi v9, v123 offset:16
    s_add_u32 s47, s35, 0x2a64000
    buffer_store_dwordx4 v[44:47], v0, s[20:23], s47 offen sc1
    s_add_u32 s44, s33, 0x7400000
    buffer_load_dwordx4 v[108:111], v0, s[12:15], s44 offen nt
    s_setprio 0
    v_and_b32 v7, -4, v124
    v_lshl_add_u32 v8, v124, 2, v7
    ds_write_b32 v8, v20
    v_lshl_add_u32 v7, v7, 2, v124
    ds_write_b8 v7, v28 offset:16
    v_and_b32 v9, -4, v125
    v_lshl_add_u32 v10, v125, 2, v9
    ds_write_b32 v10, v21
    v_lshl_add_u32 v9, v9, 2, v125
    ds_write_b8_d16_hi v9, v28 offset:16
    v_and_b32 v7, -4, v126
    v_lshl_add_u32 v8, v126, 2, v7
    ds_write_b32 v8, v22
    v_lshl_add_u32 v7, v7, 2, v126
    ds_write_b8 v7, v29 offset:16
    v_and_b32 v9, -4, v127
    v_lshl_add_u32 v10, v127, 2, v9
    ds_write_b32 v10, v23
    v_lshl_add_u32 v9, v9, 2, v127
    ds_write_b8_d16_hi v9, v29 offset:16
    s_add_u32 s45, s33, 0x7800000
    buffer_load_dwordx4 v[112:115], v0, s[8:11], s45 offen nt
    s_add_u32 s46, s33, 0x7800000
    buffer_load_dwordx4 v[88:91], v0, s[12:15], s46 offen nt
    v_and_b32 v7, -4, v36
    v_lshl_add_u32 v8, v36, 2, v7
    ds_write_b32 v8, v32
    v_lshl_add_u32 v7, v7, 2, v36
    ds_write_b8 v7, v30 offset:16
    v_and_b32 v9, -4, v37
    v_lshl_add_u32 v10, v37, 2, v9
    ds_write_b32 v10, v33
    v_lshl_add_u32 v9, v9, 2, v37
    ds_write_b8_d16_hi v9, v30 offset:16
    v_and_b32 v7, -4, v38
    v_lshl_add_u32 v8, v38, 2, v7
    ds_write_b32 v8, v34
    v_lshl_add_u32 v7, v7, 2, v38
    ds_write_b8 v7, v31 offset:16
    v_and_b32 v9, -4, v39
    v_lshl_add_u32 v10, v39, 2, v9
    ds_write_b32 v10, v35
    v_lshl_add_u32 v9, v9, 2, v39
    ds_write_b8_d16_hi v9, v31 offset:16
    s_add_u32 s47, s34, 0x3c00000
    buffer_load_dwordx2 v[104:105], v1, s[16:19], s47 offen nt
    s_add_u32 s44, s34, 0x3e00000
    buffer_load_dwordx2 v[106:107], v1, s[16:19], s44 offen nt
    v_add_u32 v7, 0x10000, v0
    v_add_u32 v12, 0x20000, v0
    v_mov_b32 v8, 0
    v_mov_b32 v9, 0
    v_mov_b32 v10, 0
    v_mov_b32 v11, 0
    s_waitcnt lgkmcnt(0)
    s_barrier
    ds_read_b128 v[116:119], v0 offset:0
    ds_write_b128 v0, v[8:11]
    ds_read_b128 v[92:95], v0 offset:16384
    ds_read_b128 v[16:19], v0 offset:32768
    ds_read_b128 v[120:123], v0 offset:49152
    ds_read_b128 v[44:47], v7 offset:0
    ds_read_b128 v[20:23], v7 offset:16384
    ds_read_b128 v[124:127], v7 offset:32768
    ds_read_b128 v[32:35], v7 offset:49152
    ds_read_b128 v[36:39], v12 offset:0
    ds_read_b128 v[28:31], v12 offset:16384
    s_waitcnt lgkmcnt(0)
    s_barrier
    s_setprio 3
    s_add_u32 s45, s35, 0x5480000
    buffer_store_dwordx4 v[116:119], v0, s[20:23], s45 offen sc1
    s_add_u32 s46, s33, 0x7c00000
    s_nop 0
    buffer_load_dwordx4 v[116:119], v0, s[8:11], s46 offen nt
    s_add_u32 s47, s35, 0x5484000
    buffer_store_dwordx4 v[92:95], v0, s[20:23], s47 offen sc1
    s_add_u32 s44, s33, 0x7c00000
    s_nop 0
    buffer_load_dwordx4 v[92:95], v0, s[12:15], s44 offen nt
    s_waitcnt vmcnt(27)
    v_lshlrev_b32 v7, 16, v84
    v_and_b32 v8, 0xffff0000, v84
    v_lshlrev_b32 v9, 16, v85
    v_and_b32 v10, 0xffff0000, v85
    v_mul_f32 v7, 0.15915494, v7
    v_mul_f32 v8, 0.15915494, v8
    v_mul_f32 v9, 0.15915494, v9
    v_mul_f32 v10, 0.15915494, v10
    v_mul_hi_u32_u24 v14, 429497, v40
    v_lshrrev_b32 v12, 3, v24
    v_cos_f32 v7, v7
    v_lshlrev_b16 v13, 3, v24
    v_mad_i32_i24 v11, v14, s55, v40
    v_bitop3_b32 v12, v6, v13, v12 bitop3:0xca
    v_lshl_add_u32 v11, v11, 17, s40
    v_lshlrev_b16 v14, 8, v14
    v_lshrrev_b32 v13, 2, v24
    v_add_u32 v40, v12, v11
    v_bitop3_b32 v24, v5, v13, v14 bitop3:0xea
    ds_add_u32 v24, v2
    v_mul_hi_u32_u24 v14, 429497, v41
    v_lshrrev_b32 v12, 3, v25
    v_cos_f32 v8, v8
    v_lshlrev_b16 v13, 3, v25
    v_mad_i32_i24 v11, v14, s55, v41
    v_bitop3_b32 v12, v6, v13, v12 bitop3:0xca
    v_lshl_add_u32 v11, v11, 17, s40
    v_lshlrev_b16 v14, 8, v14
    v_lshrrev_b32 v13, 2, v25
    v_add_u32 v41, v12, v11
    v_bitop3_b32 v25, v5, v13, v14 bitop3:0xea
    ds_add_u32 v25, v2
    v_cvt_pk_bf16_f32 v84, v7, v8
    v_perm_b32 v12, v84, v84, s41
    v_bitop3_b32 v40, v4, v12, v40 bitop3:0xca
    v_perm_b32 v13, v84, v84, s42
    v_bitop3_b32 v41, v4, v13, v41 bitop3:0xca
    v_mul_hi_u32_u24 v14, 429497, v42
    v_lshrrev_b32 v12, 3, v26
    v_cos_f32 v9, v9
    v_lshlrev_b16 v13, 3, v26
    v_mad_i32_i24 v11, v14, s55, v42
    v_bitop3_b32 v12, v6, v13, v12 bitop3:0xca
    v_lshl_add_u32 v11, v11, 17, s40
    v_lshlrev_b16 v14, 8, v14
    v_lshrrev_b32 v13, 2, v26
    v_add_u32 v42, v12, v11
    v_bitop3_b32 v26, v5, v13, v14 bitop3:0xea
    ds_add_u32 v26, v2
    v_mul_hi_u32_u24 v14, 429497, v43
    v_lshrrev_b32 v12, 3, v27
    v_cos_f32 v10, v10
    v_lshlrev_b16 v13, 3, v27
    v_mad_i32_i24 v11, v14, s55, v43
    v_bitop3_b32 v12, v6, v13, v12 bitop3:0xca
    v_lshl_add_u32 v11, v11, 17, s40
    v_lshlrev_b16 v14, 8, v14
    v_lshrrev_b32 v13, 2, v27
    v_add_u32 v43, v12, v11
    v_bitop3_b32 v27, v5, v13, v14 bitop3:0xea
    ds_add_u32 v27, v2
    v_cvt_pk_bf16_f32 v85, v9, v10
    v_perm_b32 v12, v85, v85, s41
    v_bitop3_b32 v42, v4, v12, v42 bitop3:0xca
    v_perm_b32 v13, v85, v85, s42
    v_bitop3_b32 v43, v4, v13, v43 bitop3:0xca
    s_waitcnt vmcnt(23)
    v_lshlrev_b32 v7, 16, v86
    v_and_b32 v8, 0xffff0000, v86
    v_lshlrev_b32 v9, 16, v87
    v_and_b32 v10, 0xffff0000, v87
    v_mul_f32 v7, 0.15915494, v7
    v_mul_f32 v8, 0.15915494, v8
    v_mul_f32 v9, 0.15915494, v9
    v_mul_f32 v10, 0.15915494, v10
    v_mul_hi_u32_u24 v14, 429497, v48
    v_lshrrev_b32 v12, 3, v52
    v_cos_f32 v7, v7
    v_lshlrev_b16 v13, 3, v52
    v_mad_i32_i24 v11, v14, s55, v48
    v_bitop3_b32 v12, v6, v13, v12 bitop3:0xca
    v_lshl_add_u32 v11, v11, 17, s40
    v_lshlrev_b16 v14, 8, v14
    v_lshrrev_b32 v13, 2, v52
    v_add_u32 v48, v12, v11
    v_bitop3_b32 v52, v5, v13, v14 bitop3:0xea
    ds_add_u32 v52, v2
    v_mul_hi_u32_u24 v14, 429497, v49
    v_lshrrev_b32 v12, 3, v53
    v_cos_f32 v8, v8
    v_lshlrev_b16 v13, 3, v53
    v_mad_i32_i24 v11, v14, s55, v49
    v_bitop3_b32 v12, v6, v13, v12 bitop3:0xca
    v_lshl_add_u32 v11, v11, 17, s40
    v_lshlrev_b16 v14, 8, v14
    v_lshrrev_b32 v13, 2, v53
    v_add_u32 v49, v12, v11
    v_bitop3_b32 v53, v5, v13, v14 bitop3:0xea
    ds_add_u32 v53, v2
    v_cvt_pk_bf16_f32 v86, v7, v8
    v_perm_b32 v12, v86, v86, s41
    v_bitop3_b32 v48, v4, v12, v48 bitop3:0xca
    v_perm_b32 v13, v86, v86, s42
    v_bitop3_b32 v49, v4, v13, v49 bitop3:0xca
    v_mul_hi_u32_u24 v14, 429497, v50
    v_lshrrev_b32 v12, 3, v54
    v_cos_f32 v9, v9
    v_lshlrev_b16 v13, 3, v54
    v_mad_i32_i24 v11, v14, s55, v50
    v_bitop3_b32 v12, v6, v13, v12 bitop3:0xca
    v_lshl_add_u32 v11, v11, 17, s40
    v_lshlrev_b16 v14, 8, v14
    v_lshrrev_b32 v13, 2, v54
    v_add_u32 v50, v12, v11
    v_bitop3_b32 v54, v5, v13, v14 bitop3:0xea
    ds_add_u32 v54, v2
    v_mul_hi_u32_u24 v14, 429497, v51
    v_lshrrev_b32 v12, 3, v55
    v_cos_f32 v10, v10
    v_lshlrev_b16 v13, 3, v55
    v_mad_i32_i24 v11, v14, s55, v51
    v_bitop3_b32 v12, v6, v13, v12 bitop3:0xca
    v_lshl_add_u32 v11, v11, 17, s40
    v_lshlrev_b16 v14, 8, v14
    v_lshrrev_b32 v13, 2, v55
    v_add_u32 v51, v12, v11
    v_bitop3_b32 v55, v5, v13, v14 bitop3:0xea
    ds_add_u32 v55, v2
    v_cvt_pk_bf16_f32 v87, v9, v10
    v_perm_b32 v12, v87, v87, s41
    v_bitop3_b32 v50, v4, v12, v50 bitop3:0xca
    v_perm_b32 v13, v87, v87, s42
    v_bitop3_b32 v51, v4, v13, v51 bitop3:0xca
    s_setprio 2
    s_waitcnt vmcnt(18)
    v_lshlrev_b32 v7, 16, v56
    v_and_b32 v8, 0xffff0000, v56
    v_lshlrev_b32 v9, 16, v57
    v_and_b32 v10, 0xffff0000, v57
    v_mul_f32 v7, 0.15915494, v7
    v_mul_f32 v8, 0.15915494, v8
    v_mul_f32 v9, 0.15915494, v9
    v_mul_f32 v10, 0.15915494, v10
    v_mul_hi_u32_u24 v14, 429497, v68
    v_lshrrev_b32 v12, 3, v72
    v_cos_f32 v7, v7
    v_lshlrev_b16 v13, 3, v72
    v_mad_i32_i24 v11, v14, s55, v68
    v_bitop3_b32 v12, v6, v13, v12 bitop3:0xca
    v_lshl_add_u32 v11, v11, 17, s40
    v_lshlrev_b16 v14, 8, v14
    v_lshrrev_b32 v13, 2, v72
    v_add_u32 v68, v12, v11
    v_bitop3_b32 v72, v5, v13, v14 bitop3:0xea
    ds_add_u32 v72, v2
    v_mul_hi_u32_u24 v14, 429497, v69
    v_lshrrev_b32 v12, 3, v73
    v_cos_f32 v8, v8
    v_lshlrev_b16 v13, 3, v73
    v_mad_i32_i24 v11, v14, s55, v69
    v_bitop3_b32 v12, v6, v13, v12 bitop3:0xca
    v_lshl_add_u32 v11, v11, 17, s40
    v_lshlrev_b16 v14, 8, v14
    v_lshrrev_b32 v13, 2, v73
    v_add_u32 v69, v12, v11
    v_bitop3_b32 v73, v5, v13, v14 bitop3:0xea
    ds_add_u32 v73, v2
    v_cvt_pk_bf16_f32 v56, v7, v8
    v_perm_b32 v12, v56, v56, s41
    v_bitop3_b32 v68, v4, v12, v68 bitop3:0xca
    v_perm_b32 v13, v56, v56, s42
    v_bitop3_b32 v69, v4, v13, v69 bitop3:0xca
    v_mul_hi_u32_u24 v14, 429497, v70
    v_lshrrev_b32 v12, 3, v74
    v_cos_f32 v9, v9
    v_lshlrev_b16 v13, 3, v74
    v_mad_i32_i24 v11, v14, s55, v70
    v_bitop3_b32 v12, v6, v13, v12 bitop3:0xca
    v_lshl_add_u32 v11, v11, 17, s40
    v_lshlrev_b16 v14, 8, v14
    v_lshrrev_b32 v13, 2, v74
    v_add_u32 v70, v12, v11
    v_bitop3_b32 v74, v5, v13, v14 bitop3:0xea
    ds_add_u32 v74, v2
    v_mul_hi_u32_u24 v14, 429497, v71
    v_lshrrev_b32 v12, 3, v75
    v_cos_f32 v10, v10
    v_lshlrev_b16 v13, 3, v75
    v_mad_i32_i24 v11, v14, s55, v71
    v_bitop3_b32 v12, v6, v13, v12 bitop3:0xca
    v_lshl_add_u32 v11, v11, 17, s40
    v_lshlrev_b16 v14, 8, v14
    v_lshrrev_b32 v13, 2, v75
    v_add_u32 v71, v12, v11
    v_bitop3_b32 v75, v5, v13, v14 bitop3:0xea
    ds_add_u32 v75, v2
    v_cvt_pk_bf16_f32 v57, v9, v10
    v_perm_b32 v12, v57, v57, s41
    v_bitop3_b32 v70, v4, v12, v70 bitop3:0xca
    v_perm_b32 v13, v57, v57, s42
    v_bitop3_b32 v71, v4, v13, v71 bitop3:0xca
    s_add_u32 s45, s35, 0x5488000
    buffer_store_dwordx4 v[16:19], v0, s[20:23], s45 offen sc1
    s_add_u32 s46, s33, 0x8000000
    s_nop 0
    buffer_load_dwordx4 v[16:19], v0, s[8:11], s46 offen nt
    s_waitcnt vmcnt(17)
    v_lshlrev_b32 v7, 16, v58
    v_and_b32 v8, 0xffff0000, v58
    v_lshlrev_b32 v9, 16, v59
    v_and_b32 v10, 0xffff0000, v59
    v_mul_f32 v7, 0.15915494, v7
    v_mul_f32 v8, 0.15915494, v8
    v_mul_f32 v9, 0.15915494, v9
    v_mul_f32 v10, 0.15915494, v10
    v_mul_hi_u32_u24 v14, 429497, v76
    v_lshrrev_b32 v12, 3, v80
    v_cos_f32 v7, v7
    v_lshlrev_b16 v13, 3, v80
    v_mad_i32_i24 v11, v14, s55, v76
    v_bitop3_b32 v12, v6, v13, v12 bitop3:0xca
    v_lshl_add_u32 v11, v11, 17, s40
    v_lshlrev_b16 v14, 8, v14
    v_lshrrev_b32 v13, 2, v80
    v_add_u32 v76, v12, v11
    v_bitop3_b32 v80, v5, v13, v14 bitop3:0xea
    ds_add_u32 v80, v2
    v_mul_hi_u32_u24 v14, 429497, v77
    v_lshrrev_b32 v12, 3, v81
    v_cos_f32 v8, v8
    v_lshlrev_b16 v13, 3, v81
    v_mad_i32_i24 v11, v14, s55, v77
    v_bitop3_b32 v12, v6, v13, v12 bitop3:0xca
    v_lshl_add_u32 v11, v11, 17, s40
    v_lshlrev_b16 v14, 8, v14
    v_lshrrev_b32 v13, 2, v81
    v_add_u32 v77, v12, v11
    v_bitop3_b32 v81, v5, v13, v14 bitop3:0xea
    ds_add_u32 v81, v2
    v_cvt_pk_bf16_f32 v58, v7, v8
    v_perm_b32 v12, v58, v58, s41
    v_bitop3_b32 v76, v4, v12, v76 bitop3:0xca
    v_perm_b32 v13, v58, v58, s42
    v_bitop3_b32 v77, v4, v13, v77 bitop3:0xca
    v_mul_hi_u32_u24 v14, 429497, v78
    v_lshrrev_b32 v12, 3, v82
    v_cos_f32 v9, v9
    v_lshlrev_b16 v13, 3, v82
    v_mad_i32_i24 v11, v14, s55, v78
    v_bitop3_b32 v12, v6, v13, v12 bitop3:0xca
    v_lshl_add_u32 v11, v11, 17, s40
    v_lshlrev_b16 v14, 8, v14
    v_lshrrev_b32 v13, 2, v82
    v_add_u32 v78, v12, v11
    v_bitop3_b32 v82, v5, v13, v14 bitop3:0xea
    ds_add_u32 v82, v2
    v_mul_hi_u32_u24 v14, 429497, v79
    v_lshrrev_b32 v12, 3, v83
    v_cos_f32 v10, v10
    v_lshlrev_b16 v13, 3, v83
    v_mad_i32_i24 v11, v14, s55, v79
    v_bitop3_b32 v12, v6, v13, v12 bitop3:0xca
    v_lshl_add_u32 v11, v11, 17, s40
    v_lshlrev_b16 v14, 8, v14
    v_lshrrev_b32 v13, 2, v83
    v_add_u32 v79, v12, v11
    v_bitop3_b32 v83, v5, v13, v14 bitop3:0xea
    ds_add_u32 v83, v2
    v_cvt_pk_bf16_f32 v59, v9, v10
    v_perm_b32 v12, v59, v59, s41
    v_bitop3_b32 v78, v4, v12, v78 bitop3:0xca
    v_perm_b32 v13, v59, v59, s42
    v_bitop3_b32 v79, v4, v13, v79 bitop3:0xca
    s_setprio 1
    s_waitcnt vmcnt(13)
    v_lshlrev_b32 v7, 16, v100
    v_and_b32 v8, 0xffff0000, v100
    v_lshlrev_b32 v9, 16, v101
    v_and_b32 v10, 0xffff0000, v101
    v_mul_f32 v7, 0.15915494, v7
    v_mul_f32 v8, 0.15915494, v8
    v_mul_f32 v9, 0.15915494, v9
    v_mul_f32 v10, 0.15915494, v10
    v_mul_hi_u32_u24 v14, 429497, v64
    v_lshrrev_b32 v12, 3, v96
    v_cos_f32 v7, v7
    v_lshlrev_b16 v13, 3, v96
    v_mad_i32_i24 v11, v14, s55, v64
    v_bitop3_b32 v12, v6, v13, v12 bitop3:0xca
    v_lshl_add_u32 v11, v11, 17, s40
    v_lshlrev_b16 v14, 8, v14
    v_lshrrev_b32 v13, 2, v96
    v_add_u32 v64, v12, v11
    v_bitop3_b32 v96, v5, v13, v14 bitop3:0xea
    ds_add_u32 v96, v2
    v_mul_hi_u32_u24 v14, 429497, v65
    v_lshrrev_b32 v12, 3, v97
    v_cos_f32 v8, v8
    v_lshlrev_b16 v13, 3, v97
    v_mad_i32_i24 v11, v14, s55, v65
    v_bitop3_b32 v12, v6, v13, v12 bitop3:0xca
    v_lshl_add_u32 v11, v11, 17, s40
    v_lshlrev_b16 v14, 8, v14
    v_lshrrev_b32 v13, 2, v97
    v_add_u32 v65, v12, v11
    v_bitop3_b32 v97, v5, v13, v14 bitop3:0xea
    ds_add_u32 v97, v2
    v_cvt_pk_bf16_f32 v100, v7, v8
    v_perm_b32 v12, v100, v100, s41
    v_bitop3_b32 v64, v4, v12, v64 bitop3:0xca
    v_perm_b32 v13, v100, v100, s42
    v_bitop3_b32 v65, v4, v13, v65 bitop3:0xca
    v_mul_hi_u32_u24 v14, 429497, v66
    v_lshrrev_b32 v12, 3, v98
    v_cos_f32 v9, v9
    v_lshlrev_b16 v13, 3, v98
    v_mad_i32_i24 v11, v14, s55, v66
    v_bitop3_b32 v12, v6, v13, v12 bitop3:0xca
    v_lshl_add_u32 v11, v11, 17, s40
    v_lshlrev_b16 v14, 8, v14
    v_lshrrev_b32 v13, 2, v98
    v_add_u32 v66, v12, v11
    v_bitop3_b32 v98, v5, v13, v14 bitop3:0xea
    ds_add_u32 v98, v2
    v_mul_hi_u32_u24 v14, 429497, v67
    v_lshrrev_b32 v12, 3, v99
    v_cos_f32 v10, v10
    v_lshlrev_b16 v13, 3, v99
    v_mad_i32_i24 v11, v14, s55, v67
    v_bitop3_b32 v12, v6, v13, v12 bitop3:0xca
    v_lshl_add_u32 v11, v11, 17, s40
    v_lshlrev_b16 v14, 8, v14
    v_lshrrev_b32 v13, 2, v99
    v_add_u32 v67, v12, v11
    v_bitop3_b32 v99, v5, v13, v14 bitop3:0xea
    ds_add_u32 v99, v2
    v_cvt_pk_bf16_f32 v101, v9, v10
    v_perm_b32 v12, v101, v101, s41
    v_bitop3_b32 v66, v4, v12, v66 bitop3:0xca
    v_perm_b32 v13, v101, v101, s42
    v_bitop3_b32 v67, v4, v13, v67 bitop3:0xca
    s_waitcnt vmcnt(10)
    v_lshlrev_b32 v7, 16, v102
    v_and_b32 v8, 0xffff0000, v102
    v_lshlrev_b32 v9, 16, v103
    v_and_b32 v10, 0xffff0000, v103
    v_mul_f32 v7, 0.15915494, v7
    v_mul_f32 v8, 0.15915494, v8
    v_mul_f32 v9, 0.15915494, v9
    v_mul_f32 v10, 0.15915494, v10
    v_mul_hi_u32_u24 v14, 429497, v60
    v_lshrrev_b32 v12, 3, v108
    v_cos_f32 v7, v7
    v_lshlrev_b16 v13, 3, v108
    v_mad_i32_i24 v11, v14, s55, v60
    v_bitop3_b32 v12, v6, v13, v12 bitop3:0xca
    v_lshl_add_u32 v11, v11, 17, s40
    v_lshlrev_b16 v14, 8, v14
    v_lshrrev_b32 v13, 2, v108
    v_add_u32 v60, v12, v11
    v_bitop3_b32 v108, v5, v13, v14 bitop3:0xea
    ds_add_u32 v108, v2
    v_mul_hi_u32_u24 v14, 429497, v61
    v_lshrrev_b32 v12, 3, v109
    v_cos_f32 v8, v8
    v_lshlrev_b16 v13, 3, v109
    v_mad_i32_i24 v11, v14, s55, v61
    v_bitop3_b32 v12, v6, v13, v12 bitop3:0xca
    v_lshl_add_u32 v11, v11, 17, s40
    v_lshlrev_b16 v14, 8, v14
    v_lshrrev_b32 v13, 2, v109
    v_add_u32 v61, v12, v11
    v_bitop3_b32 v109, v5, v13, v14 bitop3:0xea
    ds_add_u32 v109, v2
    v_cvt_pk_bf16_f32 v102, v7, v8
    v_perm_b32 v12, v102, v102, s41
    v_bitop3_b32 v60, v4, v12, v60 bitop3:0xca
    v_perm_b32 v13, v102, v102, s42
    v_bitop3_b32 v61, v4, v13, v61 bitop3:0xca
    v_mul_hi_u32_u24 v14, 429497, v62
    v_lshrrev_b32 v12, 3, v110
    v_cos_f32 v9, v9
    v_lshlrev_b16 v13, 3, v110
    v_mad_i32_i24 v11, v14, s55, v62
    v_bitop3_b32 v12, v6, v13, v12 bitop3:0xca
    v_lshl_add_u32 v11, v11, 17, s40
    v_lshlrev_b16 v14, 8, v14
    v_lshrrev_b32 v13, 2, v110
    v_add_u32 v62, v12, v11
    v_bitop3_b32 v110, v5, v13, v14 bitop3:0xea
    ds_add_u32 v110, v2
    v_mul_hi_u32_u24 v14, 429497, v63
    v_lshrrev_b32 v12, 3, v111
    v_cos_f32 v10, v10
    v_lshlrev_b16 v13, 3, v111
    v_mad_i32_i24 v11, v14, s55, v63
    v_bitop3_b32 v12, v6, v13, v12 bitop3:0xca
    v_lshl_add_u32 v11, v11, 17, s40
    v_lshlrev_b16 v14, 8, v14
    v_lshrrev_b32 v13, 2, v111
    v_add_u32 v63, v12, v11
    v_bitop3_b32 v111, v5, v13, v14 bitop3:0xea
    ds_add_u32 v111, v2
    v_cvt_pk_bf16_f32 v103, v9, v10
    v_perm_b32 v12, v103, v103, s41
    v_bitop3_b32 v62, v4, v12, v62 bitop3:0xca
    v_perm_b32 v13, v103, v103, s42
    v_bitop3_b32 v63, v4, v13, v63 bitop3:0xca
    s_setprio 0
    s_add_u32 s47, s35, 0x548c000
    buffer_store_dwordx4 v[120:123], v0, s[20:23], s47 offen sc1
    s_add_u32 s44, s33, 0x8000000
    s_nop 0
    buffer_load_dwordx4 v[120:123], v0, s[12:15], s44 offen nt
    s_waitcnt vmcnt(8)
    v_lshlrev_b32 v7, 16, v104
    v_and_b32 v8, 0xffff0000, v104
    v_lshlrev_b32 v9, 16, v105
    v_and_b32 v10, 0xffff0000, v105
    v_mul_f32 v7, 0.15915494, v7
    v_mul_f32 v8, 0.15915494, v8
    v_mul_f32 v9, 0.15915494, v9
    v_mul_f32 v10, 0.15915494, v10
    v_mul_hi_u32_u24 v14, 429497, v112
    v_lshrrev_b32 v12, 3, v88
    v_cos_f32 v7, v7
    v_lshlrev_b16 v13, 3, v88
    v_mad_i32_i24 v11, v14, s55, v112
    v_bitop3_b32 v12, v6, v13, v12 bitop3:0xca
    v_lshl_add_u32 v11, v11, 17, s40
    v_lshlrev_b16 v14, 8, v14
    v_lshrrev_b32 v13, 2, v88
    v_add_u32 v112, v12, v11
    v_bitop3_b32 v88, v5, v13, v14 bitop3:0xea
    ds_add_u32 v88, v2
    v_mul_hi_u32_u24 v14, 429497, v113
    v_lshrrev_b32 v12, 3, v89
    v_cos_f32 v8, v8
    v_lshlrev_b16 v13, 3, v89
    v_mad_i32_i24 v11, v14, s55, v113
    v_bitop3_b32 v12, v6, v13, v12 bitop3:0xca
    v_lshl_add_u32 v11, v11, 17, s40
    v_lshlrev_b16 v14, 8, v14
    v_lshrrev_b32 v13, 2, v89
    v_add_u32 v113, v12, v11
    v_bitop3_b32 v89, v5, v13, v14 bitop3:0xea
    ds_add_u32 v89, v2
    v_cvt_pk_bf16_f32 v104, v7, v8
    v_perm_b32 v12, v104, v104, s41
    v_bitop3_b32 v112, v4, v12, v112 bitop3:0xca
    v_perm_b32 v13, v104, v104, s42
    v_bitop3_b32 v113, v4, v13, v113 bitop3:0xca
    v_mul_hi_u32_u24 v14, 429497, v114
    v_lshrrev_b32 v12, 3, v90
    v_cos_f32 v9, v9
    v_lshlrev_b16 v13, 3, v90
    v_mad_i32_i24 v11, v14, s55, v114
    v_bitop3_b32 v12, v6, v13, v12 bitop3:0xca
    v_lshl_add_u32 v11, v11, 17, s40
    v_lshlrev_b16 v14, 8, v14
    v_lshrrev_b32 v13, 2, v90
    v_add_u32 v114, v12, v11
    v_bitop3_b32 v90, v5, v13, v14 bitop3:0xea
    ds_add_u32 v90, v2
    v_mul_hi_u32_u24 v14, 429497, v115
    v_lshrrev_b32 v12, 3, v91
    v_cos_f32 v10, v10
    v_lshlrev_b16 v13, 3, v91
    v_mad_i32_i24 v11, v14, s55, v115
    v_bitop3_b32 v12, v6, v13, v12 bitop3:0xca
    v_lshl_add_u32 v11, v11, 17, s40
    v_lshlrev_b16 v14, 8, v14
    v_lshrrev_b32 v13, 2, v91
    v_add_u32 v115, v12, v11
    v_bitop3_b32 v91, v5, v13, v14 bitop3:0xea
    ds_add_u32 v91, v2
    v_cvt_pk_bf16_f32 v105, v9, v10
    v_perm_b32 v12, v105, v105, s41
    v_bitop3_b32 v114, v4, v12, v114 bitop3:0xca
    v_perm_b32 v13, v105, v105, s42
    v_bitop3_b32 v115, v4, v13, v115 bitop3:0xca
    s_mov_b32 s68, s56
    s_mov_b32 s69, s57
    s_mov_b32 s70, 0x100
    s_mov_b32 s71, 0x20000
    v_mov_b32 v3, 1
    s_cmp_lg_u32 s32, 15
    s_cbranch_scc1 L1_tk
    s_mov_b64 exec, 1
    buffer_atomic_add v3, off, s[68:71], 0 sc0
    s_mov_b64 exec, -1
L1_tk:
    s_waitcnt vmcnt(4)
    v_lshlrev_b32 v7, 16, v106
    v_and_b32 v8, 0xffff0000, v106
    v_lshlrev_b32 v9, 16, v107
    v_and_b32 v10, 0xffff0000, v107
    v_mul_f32 v7, 0.15915494, v7
    v_mul_f32 v8, 0.15915494, v8
    v_mul_f32 v9, 0.15915494, v9
    v_mul_f32 v10, 0.15915494, v10
    v_mul_hi_u32_u24 v14, 429497, v116
    v_lshrrev_b32 v12, 3, v92
    v_cos_f32 v7, v7
    v_lshlrev_b16 v13, 3, v92
    v_mad_i32_i24 v11, v14, s55, v116
    v_bitop3_b32 v12, v6, v13, v12 bitop3:0xca
    v_lshl_add_u32 v11, v11, 17, s40
    v_lshlrev_b16 v14, 8, v14
    v_lshrrev_b32 v13, 2, v92
    v_add_u32 v116, v12, v11
    v_bitop3_b32 v92, v5, v13, v14 bitop3:0xea
    ds_add_u32 v92, v2
    v_mul_hi_u32_u24 v14, 429497, v117
    v_lshrrev_b32 v12, 3, v93
    v_cos_f32 v8, v8
    v_lshlrev_b16 v13, 3, v93
    v_mad_i32_i24 v11, v14, s55, v117
    v_bitop3_b32 v12, v6, v13, v12 bitop3:0xca
    v_lshl_add_u32 v11, v11, 17, s40
    v_lshlrev_b16 v14, 8, v14
    v_lshrrev_b32 v13, 2, v93
    v_add_u32 v117, v12, v11
    v_bitop3_b32 v93, v5, v13, v14 bitop3:0xea
    ds_add_u32 v93, v2
    v_cvt_pk_bf16_f32 v106, v7, v8
    v_perm_b32 v12, v106, v106, s41
    v_bitop3_b32 v116, v4, v12, v116 bitop3:0xca
    v_perm_b32 v13, v106, v106, s42
    v_bitop3_b32 v117, v4, v13, v117 bitop3:0xca
    v_mul_hi_u32_u24 v14, 429497, v118
    v_lshrrev_b32 v12, 3, v94
    v_cos_f32 v9, v9
    v_lshlrev_b16 v13, 3, v94
    v_mad_i32_i24 v11, v14, s55, v118
    v_bitop3_b32 v12, v6, v13, v12 bitop3:0xca
    v_lshl_add_u32 v11, v11, 17, s40
    v_lshlrev_b16 v14, 8, v14
    v_lshrrev_b32 v13, 2, v94
    v_add_u32 v118, v12, v11
    v_bitop3_b32 v94, v5, v13, v14 bitop3:0xea
    ds_add_u32 v94, v2
    v_mul_hi_u32_u24 v14, 429497, v119
    v_lshrrev_b32 v12, 3, v95
    v_cos_f32 v10, v10
    v_lshlrev_b16 v13, 3, v95
    v_mad_i32_i24 v11, v14, s55, v119
    v_bitop3_b32 v12, v6, v13, v12 bitop3:0xca
    v_lshl_add_u32 v11, v11, 17, s40
    v_lshlrev_b16 v14, 8, v14
    v_lshrrev_b32 v13, 2, v95
    v_add_u32 v119, v12, v11
    v_bitop3_b32 v95, v5, v13, v14 bitop3:0xea
    ds_add_u32 v95, v2
    v_cvt_pk_bf16_f32 v107, v9, v10
    v_perm_b32 v12, v107, v107, s41
    v_bitop3_b32 v118, v4, v12, v118 bitop3:0xca
    v_perm_b32 v13, v107, v107, s42
    v_bitop3_b32 v119, v4, v13, v119 bitop3:0xca
    v_lshrrev_b32 v8, 2, v0
    v_and_b32 v7, 0x3c00, v0
    v_bitop3_b32 v7, v5, v8, v7 bitop3:0xea
    s_waitcnt lgkmcnt(0)
    s_barrier
    ds_read2st64_b32 v[8:9], v7 offset0:0 offset1:1
    ds_read2st64_b32 v[10:11], v7 offset0:2 offset1:3
    s_add_u32 s45, s35, 0x5490000
    buffer_store_dwordx4 v[44:47], v0, s[20:23], s45 offen sc1
    s_add_u32 s46, s34, 0x4000000
    s_nop 0
    buffer_load_dwordx2 v[44:45], v1, s[16:19], s46 offen nt
    s_add_u32 s47, s34, 0x4200000
    buffer_load_dwordx2 v[46:47], v1, s[16:19], s47 offen nt
    s_waitcnt lgkmcnt(0)
    v_lshl_or_b32 v12, v9, 16, v8
    v_lshl_or_b32 v13, v11, 16, v10
    v_mov_b32 v14, v12
    v_mov_b32 v15, v13
    s_nop 0
    v_add_u32_dpp v14, v14, v14 row_shr:1 row_mask:0xf bank_mask:0xf bound_ctrl:1
    v_add_u32_dpp v15, v15, v15 row_shr:1 row_mask:0xf bank_mask:0xf bound_ctrl:1
    s_nop 0
    v_add_u32_dpp v14, v14, v14 row_shr:2 row_mask:0xf bank_mask:0xf bound_ctrl:1
    v_add_u32_dpp v15, v15, v15 row_shr:2 row_mask:0xf bank_mask:0xf bound_ctrl:1
    s_nop 0
    v_add_u32_dpp v14, v14, v14 row_shr:4 row_mask:0xf bank_mask:0xf bound_ctrl:1
    v_add_u32_dpp v15, v15, v15 row_shr:4 row_mask:0xf bank_mask:0xf bound_ctrl:1
    s_nop 0
    v_add_u32_dpp v14, v14, v14 row_shr:8 row_mask:0xf bank_mask:0xf bound_ctrl:1
    v_add_u32_dpp v15, v15, v15 row_shr:8 row_mask:0xf bank_mask:0xf bound_ctrl:1
    s_nop 0
    v_add_u32_dpp v14, v14, v14 row_bcast:15 row_mask:0xa bank_mask:0xf
    v_add_u32_dpp v15, v15, v15 row_bcast:15 row_mask:0xa bank_mask:0xf
    s_nop 0
    v_add_u32_dpp v14, v14, v14 row_bcast:31 row_mask:0xc bank_mask:0xf
    v_add_u32_dpp v15, v15, v15 row_bcast:31 row_mask:0xc bank_mask:0xf
    v_readlane_b32 s48, v14, 63
    v_readlane_b32 s49, v15, 63
    s_lshl_b32 s54, s32, 2
    v_mov_b32 v8, s54
    s_and_b32 s50, s48, 0xffff
    s_lshr_b32 s51, s48, 16
    s_and_b32 s52, s49, 0xffff
    s_lshr_b32 s53, s49, 16
    s_add_u32 s51, s51, s50
    s_add_u32 s52, s52, s51
    s_add_u32 s53, s53, s52
    v_mov_b32 v9, s53
    s_mov_b64 exec, 1
    ds_write_b32 v8, v9 offset:16384
    s_waitcnt vmcnt(3)
    ds_write_b32 v8, v3 offset:16448
    s_mov_b64 exec, -1
    v_and_b32 v8, 60, v7
    s_waitcnt lgkmcnt(0)
    s_barrier
    ds_read_b32 v9, v8 offset:16384
    ds_read_b32 v10, v8 offset:16448
    s_waitcnt lgkmcnt(0)
    v_readlane_b32 s84, v10, 15
    s_min_u32 s4, s84, 112
    s_min_u32 s5, s84, 176
    s_min_u32 s6, s84, 240
    s_add_u32 s4, s4, s5
    s_add_u32 s4, s4, s6
    s_add_u32 s4, s4, 9467
    s_mov_b32 s4, s84
    s_lshl_b32 s58, s4, 14
    s_lshl_b32 s59, s4, 13
    s_mov_b32 s43, 5
    s_cmp_lt_u32 s84, 112
    s_addc_u32 s43, s43, 0
    s_cmp_lt_u32 s84, 176
    s_addc_u32 s43, s43, 0
    s_cmp_lt_u32 s84, 240
    s_addc_u32 s43, s43, 0
    v_add_u32_dpp v9, v9, v9 row_shr:1 row_mask:0xf bank_mask:0xf bound_ctrl:1
    s_nop 1
    v_add_u32_dpp v9, v9, v9 row_shr:2 row_mask:0xf bank_mask:0xf bound_ctrl:1
    s_nop 1
    v_add_u32_dpp v9, v9, v9 row_shr:4 row_mask:0xf bank_mask:0xf bound_ctrl:1
    s_nop 1
    v_add_u32_dpp v9, v9, v9 row_shr:8 row_mask:0xf bank_mask:0xf bound_ctrl:1
    s_nop 0
    v_readlane_b32 s54, v9, s32
    s_sub_u32 s54, s54, s53
    s_add_u32 s50, s50, s54
    s_add_u32 s51, s51, s54
    s_add_u32 s52, s52, s54
    s_pack_ll_b32_b16 s48, s54, s50
    s_pack_ll_b32_b16 s49, s51, s52
    v_add_u32 v14, s48, v14
    v_add_u32 v15, s49, v15
    v_sub_u32 v12, v14, v12
    v_sub_u32 v13, v15, v13
    v_and_b32 v8, 0xffff, v12
    v_lshrrev_b32 v9, 16, v12
    v_and_b32 v10, 0xffff, v13
    v_lshrrev_b32 v11, 16, v13
    ds_write2st64_b32 v7, v8, v9 offset0:0 offset1:1
    ds_write2st64_b32 v7, v10, v11 offset0:2 offset1:3
    v_and_b32 v8, 0x3f0, v0
    v_lshl_add_u32 v8, v8, 1, s36
    ds_write_b64 v8, v[12:13] offset:20480
    s_bitset0_b64 exec, 63
    s_not_b64 exec, exec
    ds_write_b64 v8, v[14:15] offset:20512
    s_mov_b64 exec, -1
    s_waitcnt lgkmcnt(0)
    s_barrier
    s_setprio 3
    ds_add_rtn_u32 v24, v24, v2
    ds_add_rtn_u32 v25, v25, v2
    ds_add_rtn_u32 v26, v26, v2
    ds_add_rtn_u32 v27, v27, v2
    ds_read_b128 v[12:15], v0 offset:20480
    v_cmp_gt_u32 vcc, 8448, v0
    ds_add_rtn_u32 v52, v52, v2
    ds_add_rtn_u32 v53, v53, v2
    ds_add_rtn_u32 v54, v54, v2
    ds_add_rtn_u32 v55, v55, v2
    s_setprio 2
    ds_add_rtn_u32 v72, v72, v2
    ds_add_rtn_u32 v73, v73, v2
    ds_add_rtn_u32 v74, v74, v2
    ds_add_rtn_u32 v75, v75, v2
    s_waitcnt lgkmcnt(8)
    s_cbranch_vccz L1_p4
    s_add_u32 s44, s35, 0x7ec0000
    s_mov_b64 exec, vcc
    buffer_store_dwordx4 v[12:15], v0, s[24:27], s44 offen sc1
    s_mov_b64 exec, -1
L1_p4:
    s_add_u32 s45, s35, 0x5494000
    buffer_store_dwordx4 v[20:23], v0, s[20:23], s45 offen sc1
    s_add_u32 s46, s33, 0x8400000
    s_nop 0
    buffer_load_dwordx4 v[20:23], v0, s[8:11], s46 offen nt
    ds_add_rtn_u32 v80, v80, v2
    ds_add_rtn_u32 v81, v81, v2
    ds_add_rtn_u32 v82, v82, v2
    ds_add_rtn_u32 v83, v83, v2
    s_setprio 1
    ds_add_rtn_u32 v96, v96, v2
    ds_add_rtn_u32 v97, v97, v2
    ds_add_rtn_u32 v98, v98, v2
    ds_add_rtn_u32 v99, v99, v2
    ds_add_rtn_u32 v108, v108, v2
    ds_add_rtn_u32 v109, v109, v2
    ds_add_rtn_u32 v110, v110, v2
    ds_add_rtn_u32 v111, v111, v2
    s_add_u32 s47, s35, 0x5498000
    buffer_store_dwordx4 v[124:127], v0, s[20:23], s47 offen sc1
    s_add_u32 s44, s33, 0x8400000
    s_nop 0
    buffer_load_dwordx4 v[124:127], v0, s[12:15], s44 offen nt
    s_setprio 0
    ds_add_rtn_u32 v88, v88, v2
    ds_add_rtn_u32 v89, v89, v2
    ds_add_rtn_u32 v90, v90, v2
    ds_add_rtn_u32 v91, v91, v2
    ds_add_rtn_u32 v92, v92, v2
    ds_add_rtn_u32 v93, v93, v2
    ds_add_rtn_u32 v94, v94, v2
    ds_add_rtn_u32 v95, v95, v2
    s_waitcnt lgkmcnt(0)
    s_barrier
    s_setprio 3
    v_and_b32 v7, -4, v24
    v_lshl_add_u32 v8, v24, 2, v7
    ds_write_b32 v8, v40
    v_lshl_add_u32 v7, v7, 2, v24
    ds_write_b8 v7, v84 offset:16
    v_and_b32 v9, -4, v25
    v_lshl_add_u32 v10, v25, 2, v9
    ds_write_b32 v10, v41
    v_lshl_add_u32 v9, v9, 2, v25
    ds_write_b8_d16_hi v9, v84 offset:16
    v_and_b32 v7, -4, v26
    v_lshl_add_u32 v8, v26, 2, v7
    ds_write_b32 v8, v42
    v_lshl_add_u32 v7, v7, 2, v26
    ds_write_b8 v7, v85 offset:16
    v_and_b32 v9, -4, v27
    v_lshl_add_u32 v10, v27, 2, v9
    ds_write_b32 v10, v43
    v_lshl_add_u32 v9, v9, 2, v27
    ds_write_b8_d16_hi v9, v85 offset:16
    s_add_u32 s45, s35, 0x549c000
    buffer_store_dwordx4 v[32:35], v0, s[20:23], s45 offen sc1
    s_add_u32 s46, s33, 0x8800000
    buffer_load_dwordx4 v[40:43], v0, s[8:11], s46 offen nt
    s_add_u32 s47, s33, 0x8800000
    buffer_load_dwordx4 v[24:27], v0, s[12:15], s47 offen nt
    v_and_b32 v7, -4, v52
    v_lshl_add_u32 v8, v52, 2, v7
    ds_write_b32 v8, v48
    v_lshl_add_u32 v7, v7, 2, v52
    ds_write_b8 v7, v86 offset:16
    v_and_b32 v9, -4, v53
    v_lshl_add_u32 v10, v53, 2, v9
    ds_write_b32 v10, v49
    v_lshl_add_u32 v9, v9, 2, v53
    ds_write_b8_d16_hi v9, v86 offset:16
    v_and_b32 v7, -4, v54
    v_lshl_add_u32 v8, v54, 2, v7
    ds_write_b32 v8, v50
    v_lshl_add_u32 v7, v7, 2, v54
    ds_write_b8 v7, v87 offset:16
    v_and_b32 v9, -4, v55
    v_lshl_add_u32 v10, v55, 2, v9
    ds_write_b32 v10, v51
    v_lshl_add_u32 v9, v9, 2, v55
    ds_write_b8_d16_hi v9, v87 offset:16
    s_add_u32 s44, s34, 0x4400000
    buffer_load_dwordx2 v[32:33], v1, s[16:19], s44 offen nt
    s_add_u32 s45, s34, 0x4600000
    buffer_load_dwordx2 v[34:35], v1, s[16:19], s45 offen nt
    s_add_u32 s46, s33, 0x8c00000
    buffer_load_dwordx4 v[48:51], v0, s[8:11], s46 offen nt
    s_setprio 2
    v_and_b32 v7, -4, v72
    v_lshl_add_u32 v8, v72, 2, v7
    ds_write_b32 v8, v68
    v_lshl_add_u32 v7, v7, 2, v72
    ds_write_b8 v7, v56 offset:16
    v_and_b32 v9, -4, v73
    v_lshl_add_u32 v10, v73, 2, v9
    ds_write_b32 v10, v69
    v_lshl_add_u32 v9, v9, 2, v73
    ds_write_b8_d16_hi v9, v56 offset:16
    v_and_b32 v7, -4, v74
    v_lshl_add_u32 v8, v74, 2, v7
    ds_write_b32 v8, v70
    v_lshl_add_u32 v7, v7, 2, v74
    ds_write_b8 v7, v57 offset:16
    v_and_b32 v9, -4, v75
    v_lshl_add_u32 v10, v75, 2, v9
    ds_write_b32 v10, v71
    v_lshl_add_u32 v9, v9, 2, v75
    ds_write_b8_d16_hi v9, v57 offset:16
    s_add_u32 s47, s35, 0x54a0000
    buffer_store_dwordx4 v[36:39], v0, s[20:23], s47 offen sc1
    s_add_u32 s44, s33, 0x8c00000
    buffer_load_dwordx4 v[52:55], v0, s[12:15], s44 offen nt
    v_and_b32 v7, -4, v80
    v_lshl_add_u32 v8, v80, 2, v7
    ds_write_b32 v8, v76
    v_lshl_add_u32 v7, v7, 2, v80
    ds_write_b8 v7, v58 offset:16
    v_and_b32 v9, -4, v81
    v_lshl_add_u32 v10, v81, 2, v9
    ds_write_b32 v10, v77
    v_lshl_add_u32 v9, v9, 2, v81
    ds_write_b8_d16_hi v9, v58 offset:16
    v_and_b32 v7, -4, v82
    v_lshl_add_u32 v8, v82, 2, v7
    ds_write_b32 v8, v78
    v_lshl_add_u32 v7, v7, 2, v82
    ds_write_b8 v7, v59 offset:16
    v_and_b32 v9, -4, v83
    v_lshl_add_u32 v10, v83, 2, v9
    ds_write_b32 v10, v79
    v_lshl_add_u32 v9, v9, 2, v83
    ds_write_b8_d16_hi v9, v59 offset:16
    s_add_u32 s45, s33, 0x9000000
    buffer_load_dwordx4 v[84:87], v0, s[8:11], s45 offen nt
    s_add_u32 s46, s33, 0x9000000
    buffer_load_dwordx4 v[68:71], v0, s[12:15], s46 offen nt
    s_setprio 1
    v_and_b32 v7, -4, v96
    v_lshl_add_u32 v8, v96, 2, v7
    ds_write_b32 v8, v64
    v_lshl_add_u32 v7, v7, 2, v96
    ds_write_b8 v7, v100 offset:16
    v_and_b32 v9, -4, v97
    v_lshl_add_u32 v10, v97, 2, v9
    ds_write_b32 v10, v65
    v_lshl_add_u32 v9, v9, 2, v97
    ds_write_b8_d16_hi v9, v100 offset:16
    v_and_b32 v7, -4, v98
    v_lshl_add_u32 v8, v98, 2, v7
    ds_write_b32 v8, v66
    v_lshl_add_u32 v7, v7, 2, v98
    ds_write_b8 v7, v101 offset:16
    v_and_b32 v9, -4, v99
    v_lshl_add_u32 v10, v99, 2, v9
    ds_write_b32 v10, v67
    v_lshl_add_u32 v9, v9, 2, v99
    ds_write_b8_d16_hi v9, v101 offset:16
    s_add_u32 s47, s34, 0x4800000
    buffer_load_dwordx2 v[72:73], v1, s[16:19], s47 offen nt
    s_cmp_le_u32 s43, 5
    s_cselect_b32 s18, 0, s18
    s_add_u32 s44, s59, 0x4a00000
    buffer_load_dwordx2 v[74:75], v1, s[16:19], s44 offen nt
    s_cmp_le_u32 s43, 5
    s_cselect_b32 s10, 0, s10
    s_add_u32 s45, s58, 0x9400000
    buffer_load_dwordx4 v[36:39], v0, s[8:11], s45 offen nt
    v_and_b32 v7, -4, v108
    v_lshl_add_u32 v8, v108, 2, v7
    ds_write_b32 v8, v60
    v_lshl_add_u32 v7, v7, 2, v108
    ds_write_b8 v7, v102 offset:16
    v_and_b32 v9, -4, v109
    v_lshl_add_u32 v10, v109, 2, v9
    ds_write_b32 v10, v61
    v_lshl_add_u32 v9, v9, 2, v109
    ds_write_b8_d16_hi v9, v102 offset:16
    v_and_b32 v7, -4, v110
    v_lshl_add_u32 v8, v110, 2, v7
    ds_write_b32 v8, v62
    v_lshl_add_u32 v7, v7, 2, v110
    ds_write_b8 v7, v103 offset:16
    v_and_b32 v9, -4, v111
    v_lshl_add_u32 v10, v111, 2, v9
    ds_write_b32 v10, v63
    v_lshl_add_u32 v9, v9, 2, v111
    ds_write_b8_d16_hi v9, v103 offset:16
    s_add_u32 s46, s35, 0x54a4000
    buffer_store_dwordx4 v[28:31], v0, s[20:23], s46 offen sc1
    s_cmp_le_u32 s43, 5
    s_cselect_b32 s14, 0, s14
    s_add_u32 s47, s58, 0x9400000
    buffer_load_dwordx4 v[76:79], v0, s[12:15], s47 offen nt
    s_setprio 0
    v_and_b32 v7, -4, v88
    v_lshl_add_u32 v8, v88, 2, v7
    ds_write_b32 v8, v112
    v_lshl_add_u32 v7, v7, 2, v88
    ds_write_b8 v7, v104 offset:16
    v_and_b32 v9, -4, v89
    v_lshl_add_u32 v10, v89, 2, v9
    ds_write_b32 v10, v113
    v_lshl_add_u32 v9, v9, 2, v89
    ds_write_b8_d16_hi v9, v104 offset:16
    v_and_b32 v7, -4, v90
    v_lshl_add_u32 v8, v90, 2, v7
    ds_write_b32 v8, v114
    v_lshl_add_u32 v7, v7, 2, v90
    ds_write_b8 v7, v105 offset:16
    v_and_b32 v9, -4, v91
    v_lshl_add_u32 v10, v91, 2, v9
    ds_write_b32 v10, v115
    v_lshl_add_u32 v9, v9, 2, v91
    ds_write_b8_d16_hi v9, v105 offset:16
    s_cmp_le_u32 s43, 6
    s_cselect_b32 s10, 0, s10
    s_add_u32 s44, s58, 0x97c0000
    buffer_load_dwordx4 v[80:83], v0, s[8:11], s44 offen nt
    s_cmp_le_u32 s43, 6
    s_cselect_b32 s14, 0, s14
    s_add_u32 s45, s58, 0x97c0000
    buffer_load_dwordx4 v[56:59], v0, s[12:15], s45 offen nt
    v_and_b32 v7, -4, v92
    v_lshl_add_u32 v8, v92, 2, v7
    ds_write_b32 v8, v116
    v_lshl_add_u32 v7, v7, 2, v92
    ds_write_b8 v7, v106 offset:16
    v_and_b32 v9, -4, v93
    v_lshl_add_u32 v10, v93, 2, v9
    ds_write_b32 v10, v117
    v_lshl_add_u32 v9, v9, 2, v93
    ds_write_b8_d16_hi v9, v106 offset:16
    v_and_b32 v7, -4, v94
    v_lshl_add_u32 v8, v94, 2, v7
    ds_write_b32 v8, v118
    v_lshl_add_u32 v7, v7, 2, v94
    ds_write_b8 v7, v107 offset:16
    v_and_b32 v9, -4, v95
    v_lshl_add_u32 v10, v95, 2, v9
    ds_write_b32 v10, v119
    v_lshl_add_u32 v9, v9, 2, v95
    ds_write_b8_d16_hi v9, v107 offset:16
    s_cmp_le_u32 s43, 6
    s_cselect_b32 s18, 0, s18
    s_add_u32 s46, s59, 0x4be0000
    buffer_load_dwordx2 v[64:65], v1, s[16:19], s46 offen nt
    s_cmp_le_u32 s43, 7
    s_cselect_b32 s18, 0, s18
    s_add_u32 s47, s59, 0x4d40000
    buffer_load_dwordx2 v[66:67], v1, s[16:19], s47 offen nt
    v_add_u32 v7, 0x10000, v0
    v_add_u32 v12, 0x20000, v0
    v_mov_b32 v8, 0
    v_mov_b32 v9, 0
    v_mov_b32 v10, 0
    v_mov_b32 v11, 0
    s_waitcnt lgkmcnt(0)
    s_barrier
    ds_read_b128 v[96:99], v0 offset:0
    ds_write_b128 v0, v[8:11]
    ds_read_b128 v[60:63], v0 offset:16384
    ds_read_b128 v[108:111], v0 offset:32768
    ds_read_b128 v[100:103], v0 offset:49152
    ds_read_b128 v[28:31], v7 offset:0
    ds_read_b128 v[112:115], v7 offset:16384
    ds_read_b128 v[88:91], v7 offset:32768
    ds_read_b128 v[116:119], v7 offset:49152
    ds_read_b128 v[92:95], v12 offset:0
    ds_read_b128 v[104:107], v12 offset:16384
    s_waitcnt lgkmcnt(0)
    s_barrier
    s_add_u32 s44, s35, 0x7ec0000
    buffer_store_dwordx4 v[96:99], v0, s[20:23], s44 offen sc1
    s_cmp_le_u32 s43, 7
    s_cselect_b32 s10, 0, s10
    s_add_u32 s45, s58, 0x9a80000
    buffer_load_dwordx4 v[96:99], v0, s[8:11], s45 offen nt
    s_add_u32 s46, s35, 0x7ec4000
    buffer_store_dwordx4 v[60:63], v0, s[20:23], s46 offen sc1
    s_cmp_le_u32 s43, 7
    s_cselect_b32 s14, 0, s14
    s_add_u32 s47, s58, 0x9a80000
    buffer_load_dwordx4 v[60:63], v0, s[12:15], s47 offen nt
    s_setprio 3
    s_waitcnt vmcnt(27)
    v_lshlrev_b32 v7, 16, v44
    v_and_b32 v8, 0xffff0000, v44
    v_lshlrev_b32 v9, 16, v45
    v_and_b32 v10, 0xffff0000, v45
    v_mul_f32 v7, 0.15915494, v7
    v_mul_f32 v8, 0.15915494, v8
    v_mul_f32 v9, 0.15915494, v9
    v_mul_f32 v10, 0.15915494, v10
    v_mul_hi_u32_u24 v14, 429497, v16
    v_lshrrev_b32 v12, 3, v120
    v_cos_f32 v7, v7
    v_lshlrev_b16 v13, 3, v120
    v_mad_i32_i24 v11, v14, s55, v16
    v_bitop3_b32 v12, v6, v13, v12 bitop3:0xca
    v_lshl_add_u32 v11, v11, 17, s40
    v_lshlrev_b16 v14, 8, v14
    v_lshrrev_b32 v13, 2, v120
    v_add_u32 v16, v12, v11
    v_bitop3_b32 v120, v5, v13, v14 bitop3:0xea
    ds_add_u32 v120, v2
    v_mul_hi_u32_u24 v14, 429497, v17
    v_lshrrev_b32 v12, 3, v121
    v_cos_f32 v8, v8
    v_lshlrev_b16 v13, 3, v121
    v_mad_i32_i24 v11, v14, s55, v17
    v_bitop3_b32 v12, v6, v13, v12 bitop3:0xca
    v_lshl_add_u32 v11, v11, 17, s40
    v_lshlrev_b16 v14, 8, v14
    v_lshrrev_b32 v13, 2, v121
    v_add_u32 v17, v12, v11
    v_bitop3_b32 v121, v5, v13, v14 bitop3:0xea
    ds_add_u32 v121, v2
    v_cvt_pk_bf16_f32 v44, v7, v8
    v_perm_b32 v12, v44, v44, s41
    v_bitop3_b32 v16, v4, v12, v16 bitop3:0xca
    v_perm_b32 v13, v44, v44, s42
    v_bitop3_b32 v17, v4, v13, v17 bitop3:0xca
    v_mul_hi_u32_u24 v14, 429497, v18
    v_lshrrev_b32 v12, 3, v122
    v_cos_f32 v9, v9
    v_lshlrev_b16 v13, 3, v122
    v_mad_i32_i24 v11, v14, s55, v18
    v_bitop3_b32 v12, v6, v13, v12 bitop3:0xca
    v_lshl_add_u32 v11, v11, 17, s40
    v_lshlrev_b16 v14, 8, v14
    v_lshrrev_b32 v13, 2, v122
    v_add_u32 v18, v12, v11
    v_bitop3_b32 v122, v5, v13, v14 bitop3:0xea
    ds_add_u32 v122, v2
    v_mul_hi_u32_u24 v14, 429497, v19
    v_lshrrev_b32 v12, 3, v123
    v_cos_f32 v10, v10
    v_lshlrev_b16 v13, 3, v123
    v_mad_i32_i24 v11, v14, s55, v19
    v_bitop3_b32 v12, v6, v13, v12 bitop3:0xca
    v_lshl_add_u32 v11, v11, 17, s40
    v_lshlrev_b16 v14, 8, v14
    v_lshrrev_b32 v13, 2, v123
    v_add_u32 v19, v12, v11
    v_bitop3_b32 v123, v5, v13, v14 bitop3:0xea
    ds_add_u32 v123, v2
    v_cvt_pk_bf16_f32 v45, v9, v10
    v_perm_b32 v12, v45, v45, s41
    v_bitop3_b32 v18, v4, v12, v18 bitop3:0xca
    v_perm_b32 v13, v45, v45, s42
    v_bitop3_b32 v19, v4, v13, v19 bitop3:0xca
    s_add_u32 s44, s35, 0x7ec8000
    buffer_store_dwordx4 v[108:111], v0, s[20:23], s44 offen sc1
    s_waitcnt vmcnt(24)
    v_lshlrev_b32 v7, 16, v46
    v_and_b32 v8, 0xffff0000, v46
    v_lshlrev_b32 v9, 16, v47
    v_and_b32 v10, 0xffff0000, v47
    v_mul_f32 v7, 0.15915494, v7
    v_mul_f32 v8, 0.15915494, v8
    v_mul_f32 v9, 0.15915494, v9
    v_mul_f32 v10, 0.15915494, v10
    v_mul_hi_u32_u24 v14, 429497, v20
    v_lshrrev_b32 v12, 3, v124
    v_cos_f32 v7, v7
    v_lshlrev_b16 v13, 3, v124
    v_mad_i32_i24 v11, v14, s55, v20
    v_bitop3_b32 v12, v6, v13, v12 bitop3:0xca
    v_lshl_add_u32 v11, v11, 17, s40
    v_lshlrev_b16 v14, 8, v14
    v_lshrrev_b32 v13, 2, v124
    v_add_u32 v20, v12, v11
    v_bitop3_b32 v124, v5, v13, v14 bitop3:0xea
    ds_add_u32 v124, v2
    v_mul_hi_u32_u24 v14, 429497, v21
    v_lshrrev_b32 v12, 3, v125
    v_cos_f32 v8, v8
    v_lshlrev_b16 v13, 3, v125
    v_mad_i32_i24 v11, v14, s55, v21
    v_bitop3_b32 v12, v6, v13, v12 bitop3:0xca
    v_lshl_add_u32 v11, v11, 17, s40
    v_lshlrev_b16 v14, 8, v14
    v_lshrrev_b32 v13, 2, v125
    v_add_u32 v21, v12, v11
    v_bitop3_b32 v125, v5, v13, v14 bitop3:0xea
    ds_add_u32 v125, v2
    v_cvt_pk_bf16_f32 v46, v7, v8
    v_perm_b32 v12, v46, v46, s41
    v_bitop3_b32 v20, v4, v12, v20 bitop3:0xca
    v_perm_b32 v13, v46, v46, s42
    v_bitop3_b32 v21, v4, v13, v21 bitop3:0xca
    v_mul_hi_u32_u24 v14, 429497, v22
    v_lshrrev_b32 v12, 3, v126
    v_cos_f32 v9, v9
    v_lshlrev_b16 v13, 3, v126
    v_mad_i32_i24 v11, v14, s55, v22
    v_bitop3_b32 v12, v6, v13, v12 bitop3:0xca
    v_lshl_add_u32 v11, v11, 17, s40
    v_lshlrev_b16 v14, 8, v14
    v_lshrrev_b32 v13, 2, v126
    v_add_u32 v22, v12, v11
    v_bitop3_b32 v126, v5, v13, v14 bitop3:0xea
    ds_add_u32 v126, v2
    v_mul_hi_u32_u24 v14, 429497, v23
    v_lshrrev_b32 v12, 3, v127
    v_cos_f32 v10, v10
    v_lshlrev_b16 v13, 3, v127
    v_mad_i32_i24 v11, v14, s55, v23
    v_bitop3_b32 v12, v6, v13, v12 bitop3:0xca
    v_lshl_add_u32 v11, v11, 17, s40
    v_lshlrev_b16 v14, 8, v14
    v_lshrrev_b32 v13, 2, v127
    v_add_u32 v23, v12, v11
    v_bitop3_b32 v127, v5, v13, v14 bitop3:0xea
    ds_add_u32 v127, v2
    v_cvt_pk_bf16_f32 v47, v9, v10
    v_perm_b32 v12, v47, v47, s41
    v_bitop3_b32 v22, v4, v12, v22 bitop3:0xca
    v_perm_b32 v13, v47, v47, s42
    v_bitop3_b32 v23, v4, v13, v23 bitop3:0xca
    s_setprio 2
    s_add_u32 s45, s35, 0x7ecc000
    buffer_store_dwordx4 v[100:103], v0, s[20:23], s45 offen sc1
    s_waitcnt vmcnt(20)
    v_lshlrev_b32 v7, 16, v32
    v_and_b32 v8, 0xffff0000, v32
    v_lshlrev_b32 v9, 16, v33
    v_and_b32 v10, 0xffff0000, v33
    v_mul_f32 v7, 0.15915494, v7
    v_mul_f32 v8, 0.15915494, v8
    v_mul_f32 v9, 0.15915494, v9
    v_mul_f32 v10, 0.15915494, v10
    v_mul_hi_u32_u24 v14, 429497, v40
    v_lshrrev_b32 v12, 3, v24
    v_cos_f32 v7, v7
    v_lshlrev_b16 v13, 3, v24
    v_mad_i32_i24 v11, v14, s55, v40
    v_bitop3_b32 v12, v6, v13, v12 bitop3:0xca
    v_lshl_add_u32 v11, v11, 17, s40
    v_lshlrev_b16 v14, 8, v14
    v_lshrrev_b32 v13, 2, v24
    v_add_u32 v40, v12, v11
    v_bitop3_b32 v24, v5, v13, v14 bitop3:0xea
    ds_add_u32 v24, v2
    v_mul_hi_u32_u24 v14, 429497, v41
    v_lshrrev_b32 v12, 3, v25
    v_cos_f32 v8, v8
    v_lshlrev_b16 v13, 3, v25
    v_mad_i32_i24 v11, v14, s55, v41
    v_bitop3_b32 v12, v6, v13, v12 bitop3:0xca
    v_lshl_add_u32 v11, v11, 17, s40
    v_lshlrev_b16 v14, 8, v14
    v_lshrrev_b32 v13, 2, v25
    v_add_u32 v41, v12, v11
    v_bitop3_b32 v25, v5, v13, v14 bitop3:0xea
    ds_add_u32 v25, v2
    v_cvt_pk_bf16_f32 v32, v7, v8
    v_perm_b32 v12, v32, v32, s41
    v_bitop3_b32 v40, v4, v12, v40 bitop3:0xca
    v_perm_b32 v13, v32, v32, s42
    v_bitop3_b32 v41, v4, v13, v41 bitop3:0xca
    v_mul_hi_u32_u24 v14, 429497, v42
    v_lshrrev_b32 v12, 3, v26
    v_cos_f32 v9, v9
    v_lshlrev_b16 v13, 3, v26
    v_mad_i32_i24 v11, v14, s55, v42
    v_bitop3_b32 v12, v6, v13, v12 bitop3:0xca
    v_lshl_add_u32 v11, v11, 17, s40
    v_lshlrev_b16 v14, 8, v14
    v_lshrrev_b32 v13, 2, v26
    v_add_u32 v42, v12, v11
    v_bitop3_b32 v26, v5, v13, v14 bitop3:0xea
    ds_add_u32 v26, v2
    v_mul_hi_u32_u24 v14, 429497, v43
    v_lshrrev_b32 v12, 3, v27
    v_cos_f32 v10, v10
    v_lshlrev_b16 v13, 3, v27
    v_mad_i32_i24 v11, v14, s55, v43
    v_bitop3_b32 v12, v6, v13, v12 bitop3:0xca
    v_lshl_add_u32 v11, v11, 17, s40
    v_lshlrev_b16 v14, 8, v14
    v_lshrrev_b32 v13, 2, v27
    v_add_u32 v43, v12, v11
    v_bitop3_b32 v27, v5, v13, v14 bitop3:0xea
    ds_add_u32 v27, v2
    v_cvt_pk_bf16_f32 v33, v9, v10
    v_perm_b32 v12, v33, v33, s41
    v_bitop3_b32 v42, v4, v12, v42 bitop3:0xca
    v_perm_b32 v13, v33, v33, s42
    v_bitop3_b32 v43, v4, v13, v43 bitop3:0xca
    s_waitcnt vmcnt(17)
    v_lshlrev_b32 v7, 16, v34
    v_and_b32 v8, 0xffff0000, v34
    v_lshlrev_b32 v9, 16, v35
    v_and_b32 v10, 0xffff0000, v35
    v_mul_f32 v7, 0.15915494, v7
    v_mul_f32 v8, 0.15915494, v8
    v_mul_f32 v9, 0.15915494, v9
    v_mul_f32 v10, 0.15915494, v10
    v_mul_hi_u32_u24 v14, 429497, v48
    v_lshrrev_b32 v12, 3, v52
    v_cos_f32 v7, v7
    v_lshlrev_b16 v13, 3, v52
    v_mad_i32_i24 v11, v14, s55, v48
    v_bitop3_b32 v12, v6, v13, v12 bitop3:0xca
    v_lshl_add_u32 v11, v11, 17, s40
    v_lshlrev_b16 v14, 8, v14
    v_lshrrev_b32 v13, 2, v52
    v_add_u32 v48, v12, v11
    v_bitop3_b32 v52, v5, v13, v14 bitop3:0xea
    ds_add_u32 v52, v2
    v_mul_hi_u32_u24 v14, 429497, v49
    v_lshrrev_b32 v12, 3, v53
    v_cos_f32 v8, v8
    v_lshlrev_b16 v13, 3, v53
    v_mad_i32_i24 v11, v14, s55, v49
    v_bitop3_b32 v12, v6, v13, v12 bitop3:0xca
    v_lshl_add_u32 v11, v11, 17, s40
    v_lshlrev_b16 v14, 8, v14
    v_lshrrev_b32 v13, 2, v53
    v_add_u32 v49, v12, v11
    v_bitop3_b32 v53, v5, v13, v14 bitop3:0xea
    ds_add_u32 v53, v2
    v_cvt_pk_bf16_f32 v34, v7, v8
    v_perm_b32 v12, v34, v34, s41
    v_bitop3_b32 v48, v4, v12, v48 bitop3:0xca
    v_perm_b32 v13, v34, v34, s42
    v_bitop3_b32 v49, v4, v13, v49 bitop3:0xca
    v_mul_hi_u32_u24 v14, 429497, v50
    v_lshrrev_b32 v12, 3, v54
    v_cos_f32 v9, v9
    v_lshlrev_b16 v13, 3, v54
    v_mad_i32_i24 v11, v14, s55, v50
    v_bitop3_b32 v12, v6, v13, v12 bitop3:0xca
    v_lshl_add_u32 v11, v11, 17, s40
    v_lshlrev_b16 v14, 8, v14
    v_lshrrev_b32 v13, 2, v54
    v_add_u32 v50, v12, v11
    v_bitop3_b32 v54, v5, v13, v14 bitop3:0xea
    ds_add_u32 v54, v2
    v_mul_hi_u32_u24 v14, 429497, v51
    v_lshrrev_b32 v12, 3, v55
    v_cos_f32 v10, v10
    v_lshlrev_b16 v13, 3, v55
    v_mad_i32_i24 v11, v14, s55, v51
    v_bitop3_b32 v12, v6, v13, v12 bitop3:0xca
    v_lshl_add_u32 v11, v11, 17, s40
    v_lshlrev_b16 v14, 8, v14
    v_lshrrev_b32 v13, 2, v55
    v_add_u32 v51, v12, v11
    v_bitop3_b32 v55, v5, v13, v14 bitop3:0xea
    ds_add_u32 v55, v2
    v_cvt_pk_bf16_f32 v35, v9, v10
    v_perm_b32 v12, v35, v35, s41
    v_bitop3_b32 v50, v4, v12, v50 bitop3:0xca
    v_perm_b32 v13, v35, v35, s42
    v_bitop3_b32 v51, v4, v13, v51 bitop3:0xca
    s_setprio 1
    s_add_u32 s46, s35, 0x7ed0000
    buffer_store_dwordx4 v[28:31], v0, s[20:23], s46 offen sc1
    v_lshrrev_b32 v15, 2, v0
    v_and_b32 v15, v5, v15
    s_cmp_ge_u32 s84, 128
    s_cselect_b32 s82, 0, s82
    s_and_b32 s3, s84, 1
    s_mul_i32 s3, s3, 40
    s_add_u32 s3, s3, s32
    s_mul_i32 s4, s3, 205
    s_lshr_b32 s4, s4, 10
    s_mul_i32 s5, s4, 5
    s_sub_u32 s5, s3, s5
    s_lshl_b32 s6, s4, 1
    s_add_u32 s6, s6, s5
    s_add_u32 s7, s6, s4
    s_add_u32 s7, s7, 30
    s_cmp_lt_u32 s5, 2
    s_cselect_b32 s6, s6, s7
    s_lshl_b32 s6, s6, 10
    s_lshr_b32 s7, s84, 1
    s_mul_i32 s7, s7, 80000
    s_add_u32 s6, s6, s7
    buffer_load_dword v108, v15, s[80:83], s6 offen offset:0
    buffer_load_dword v109, v15, s[80:83], s6 offen offset:256
    buffer_load_dword v110, v15, s[80:83], s6 offen offset:512
    buffer_load_dword v111, v15, s[80:83], s6 offen offset:768
    s_and_b32 s3, s84, 1
    s_mul_i32 s3, s3, 40
    s_add_u32 s3, s3, s32
    s_add_u32 s3, s3, 16
    s_mul_i32 s4, s3, 205
    s_lshr_b32 s4, s4, 10
    s_mul_i32 s5, s4, 5
    s_sub_u32 s5, s3, s5
    s_lshl_b32 s6, s4, 1
    s_add_u32 s6, s6, s5
    s_add_u32 s7, s6, s4
    s_add_u32 s7, s7, 30
    s_cmp_lt_u32 s5, 2
    s_cselect_b32 s6, s6, s7
    s_lshl_b32 s6, s6, 10
    s_lshr_b32 s7, s84, 1
    s_mul_i32 s7, s7, 80000
    s_add_u32 s6, s6, s7
    buffer_load_dword v100, v15, s[80:83], s6 offen offset:0
    buffer_load_dword v101, v15, s[80:83], s6 offen offset:256
    buffer_load_dword v102, v15, s[80:83], s6 offen offset:512
    buffer_load_dword v103, v15, s[80:83], s6 offen offset:768
    s_and_b32 s3, s84, 1
    s_mul_i32 s3, s3, 40
    s_add_u32 s3, s3, s32
    s_add_u32 s3, s3, 32
    s_cmp_ge_u32 s32, 8
    s_cselect_b32 s82, 0, s82
    s_mul_i32 s4, s3, 205
    s_lshr_b32 s4, s4, 10
    s_mul_i32 s5, s4, 5
    s_sub_u32 s5, s3, s5
    s_lshl_b32 s6, s4, 1
    s_add_u32 s6, s6, s5
    s_add_u32 s7, s6, s4
    s_add_u32 s7, s7, 30
    s_cmp_lt_u32 s5, 2
    s_cselect_b32 s6, s6, s7
    s_lshl_b32 s6, s6, 10
    s_lshr_b32 s7, s84, 1
    s_mul_i32 s7, s7, 80000
    s_add_u32 s6, s6, s7
    buffer_load_dword v28, v15, s[80:83], s6 offen offset:0
    buffer_load_dword v29, v15, s[80:83], s6 offen offset:256
    buffer_load_dword v30, v15, s[80:83], s6 offen offset:512
    buffer_load_dword v31, v15, s[80:83], s6 offen offset:768
    s_waitcnt vmcnt(26)
    v_lshlrev_b32 v7, 16, v72
    v_and_b32 v8, 0xffff0000, v72
    v_lshlrev_b32 v9, 16, v73
    v_and_b32 v10, 0xffff0000, v73
    v_mul_f32 v7, 0.15915494, v7
    v_mul_f32 v8, 0.15915494, v8
    v_mul_f32 v9, 0.15915494, v9
    v_mul_f32 v10, 0.15915494, v10
    v_mul_hi_u32_u24 v14, 429497, v84
    v_lshrrev_b32 v12, 3, v68
    v_cos_f32 v7, v7
    v_lshlrev_b16 v13, 3, v68
    v_mad_i32_i24 v11, v14, s55, v84
    v_bitop3_b32 v12, v6, v13, v12 bitop3:0xca
    v_lshl_add_u32 v11, v11, 17, s40
    v_lshlrev_b16 v14, 8, v14
    v_lshrrev_b32 v13, 2, v68
    v_add_u32 v84, v12, v11
    v_bitop3_b32 v68, v5, v13, v14 bitop3:0xea
    ds_add_u32 v68, v2
    v_mul_hi_u32_u24 v14, 429497, v85
    v_lshrrev_b32 v12, 3, v69
    v_cos_f32 v8, v8
    v_lshlrev_b16 v13, 3, v69
    v_mad_i32_i24 v11, v14, s55, v85
    v_bitop3_b32 v12, v6, v13, v12 bitop3:0xca
    v_lshl_add_u32 v11, v11, 17, s40
    v_lshlrev_b16 v14, 8, v14
    v_lshrrev_b32 v13, 2, v69
    v_add_u32 v85, v12, v11
    v_bitop3_b32 v69, v5, v13, v14 bitop3:0xea
    ds_add_u32 v69, v2
    v_cvt_pk_bf16_f32 v72, v7, v8
    v_perm_b32 v12, v72, v72, s41
    v_bitop3_b32 v84, v4, v12, v84 bitop3:0xca
    v_perm_b32 v13, v72, v72, s42
    v_bitop3_b32 v85, v4, v13, v85 bitop3:0xca
    v_mul_hi_u32_u24 v14, 429497, v86
    v_lshrrev_b32 v12, 3, v70
    v_cos_f32 v9, v9
    v_lshlrev_b16 v13, 3, v70
    v_mad_i32_i24 v11, v14, s55, v86
    v_bitop3_b32 v12, v6, v13, v12 bitop3:0xca
    v_lshl_add_u32 v11, v11, 17, s40
    v_lshlrev_b16 v14, 8, v14
    v_lshrrev_b32 v13, 2, v70
    v_add_u32 v86, v12, v11
    v_bitop3_b32 v70, v5, v13, v14 bitop3:0xea
    ds_add_u32 v70, v2
    v_mul_hi_u32_u24 v14, 429497, v87
    v_lshrrev_b32 v12, 3, v71
    v_cos_f32 v10, v10
    v_lshlrev_b16 v13, 3, v71
    v_mad_i32_i24 v11, v14, s55, v87
    v_bitop3_b32 v12, v6, v13, v12 bitop3:0xca
    v_lshl_add_u32 v11, v11, 17, s40
    v_lshlrev_b16 v14, 8, v14
    v_lshrrev_b32 v13, 2, v71
    v_add_u32 v87, v12, v11
    v_bitop3_b32 v71, v5, v13, v14 bitop3:0xea
    ds_add_u32 v71, v2
    v_cvt_pk_bf16_f32 v73, v9, v10
    v_perm_b32 v12, v73, v73, s41
    v_bitop3_b32 v86, v4, v12, v86 bitop3:0xca
    v_perm_b32 v13, v73, v73, s42
    v_bitop3_b32 v87, v4, v13, v87 bitop3:0xca
    s_waitcnt vmcnt(23)
    s_cmp_le_u32 s43, 5
    s_cbranch_scc1 L1_s5
    v_lshlrev_b32 v7, 16, v74
    v_and_b32 v8, 0xffff0000, v74
    v_lshlrev_b32 v9, 16, v75
    v_and_b32 v10, 0xffff0000, v75
    v_mul_f32 v7, 0.15915494, v7
    v_mul_f32 v8, 0.15915494, v8
    v_mul_f32 v9, 0.15915494, v9
    v_mul_f32 v10, 0.15915494, v10
    v_mul_hi_u32_u24 v14, 429497, v36
    v_lshrrev_b32 v12, 3, v76
    v_cos_f32 v7, v7
    v_lshlrev_b16 v13, 3, v76
    v_mad_i32_i24 v11, v14, s55, v36
    v_bitop3_b32 v12, v6, v13, v12 bitop3:0xca
    v_lshl_add_u32 v11, v11, 17, s40
    v_lshlrev_b16 v14, 8, v14
    v_lshrrev_b32 v13, 2, v76
    v_add_u32 v36, v12, v11
    v_bitop3_b32 v76, v5, v13, v14 bitop3:0xea
    ds_add_u32 v76, v2
    v_mul_hi_u32_u24 v14, 429497, v37
    v_lshrrev_b32 v12, 3, v77
    v_cos_f32 v8, v8
    v_lshlrev_b16 v13, 3, v77
    v_mad_i32_i24 v11, v14, s55, v37
    v_bitop3_b32 v12, v6, v13, v12 bitop3:0xca
    v_lshl_add_u32 v11, v11, 17, s40
    v_lshlrev_b16 v14, 8, v14
    v_lshrrev_b32 v13, 2, v77
    v_add_u32 v37, v12, v11
    v_bitop3_b32 v77, v5, v13, v14 bitop3:0xea
    ds_add_u32 v77, v2
    v_cvt_pk_bf16_f32 v74, v7, v8
    v_perm_b32 v12, v74, v74, s41
    v_bitop3_b32 v36, v4, v12, v36 bitop3:0xca
    v_perm_b32 v13, v74, v74, s42
    v_bitop3_b32 v37, v4, v13, v37 bitop3:0xca
    v_mul_hi_u32_u24 v14, 429497, v38
    v_lshrrev_b32 v12, 3, v78
    v_cos_f32 v9, v9
    v_lshlrev_b16 v13, 3, v78
    v_mad_i32_i24 v11, v14, s55, v38
    v_bitop3_b32 v12, v6, v13, v12 bitop3:0xca
    v_lshl_add_u32 v11, v11, 17, s40
    v_lshlrev_b16 v14, 8, v14
    v_lshrrev_b32 v13, 2, v78
    v_add_u32 v38, v12, v11
    v_bitop3_b32 v78, v5, v13, v14 bitop3:0xea
    ds_add_u32 v78, v2
    v_mul_hi_u32_u24 v14, 429497, v39
    v_lshrrev_b32 v12, 3, v79
    v_cos_f32 v10, v10
    v_lshlrev_b16 v13, 3, v79
    v_mad_i32_i24 v11, v14, s55, v39
    v_bitop3_b32 v12, v6, v13, v12 bitop3:0xca
    v_lshl_add_u32 v11, v11, 17, s40
    v_lshlrev_b16 v14, 8, v14
    v_lshrrev_b32 v13, 2, v79
    v_add_u32 v39, v12, v11
    v_bitop3_b32 v79, v5, v13, v14 bitop3:0xea
    ds_add_u32 v79, v2
    v_cvt_pk_bf16_f32 v75, v9, v10
    v_perm_b32 v12, v75, v75, s41
    v_bitop3_b32 v38, v4, v12, v38 bitop3:0xca
    v_perm_b32 v13, v75, v75, s42
    v_bitop3_b32 v39, v4, v13, v39 bitop3:0xca
L1_s5:
    s_setprio 0
    s_waitcnt vmcnt(19)
    s_cmp_le_u32 s43, 6
    s_cbranch_scc1 L1_s6
    v_lshlrev_b32 v7, 16, v64
    v_and_b32 v8, 0xffff0000, v64
    v_lshlrev_b32 v9, 16, v65
    v_and_b32 v10, 0xffff0000, v65
    v_mul_f32 v7, 0.15915494, v7
    v_mul_f32 v8, 0.15915494, v8
    v_mul_f32 v9, 0.15915494, v9
    v_mul_f32 v10, 0.15915494, v10
    v_mul_hi_u32_u24 v14, 429497, v80
    v_lshrrev_b32 v12, 3, v56
    v_cos_f32 v7, v7
    v_lshlrev_b16 v13, 3, v56
    v_mad_i32_i24 v11, v14, s55, v80
    v_bitop3_b32 v12, v6, v13, v12 bitop3:0xca
    v_lshl_add_u32 v11, v11, 17, s40
    v_lshlrev_b16 v14, 8, v14
    v_lshrrev_b32 v13, 2, v56
    v_add_u32 v80, v12, v11
    v_bitop3_b32 v56, v5, v13, v14 bitop3:0xea
    ds_add_u32 v56, v2
    v_mul_hi_u32_u24 v14, 429497, v81
    v_lshrrev_b32 v12, 3, v57
    v_cos_f32 v8, v8
    v_lshlrev_b16 v13, 3, v57
    v_mad_i32_i24 v11, v14, s55, v81
    v_bitop3_b32 v12, v6, v13, v12 bitop3:0xca
    v_lshl_add_u32 v11, v11, 17, s40
    v_lshlrev_b16 v14, 8, v14
    v_lshrrev_b32 v13, 2, v57
    v_add_u32 v81, v12, v11
    v_bitop3_b32 v57, v5, v13, v14 bitop3:0xea
    ds_add_u32 v57, v2
    v_cvt_pk_bf16_f32 v64, v7, v8
    v_perm_b32 v12, v64, v64, s41
    v_bitop3_b32 v80, v4, v12, v80 bitop3:0xca
    v_perm_b32 v13, v64, v64, s42
    v_bitop3_b32 v81, v4, v13, v81 bitop3:0xca
    v_mul_hi_u32_u24 v14, 429497, v82
    v_lshrrev_b32 v12, 3, v58
    v_cos_f32 v9, v9
    v_lshlrev_b16 v13, 3, v58
    v_mad_i32_i24 v11, v14, s55, v82
    v_bitop3_b32 v12, v6, v13, v12 bitop3:0xca
    v_lshl_add_u32 v11, v11, 17, s40
    v_lshlrev_b16 v14, 8, v14
    v_lshrrev_b32 v13, 2, v58
    v_add_u32 v82, v12, v11
    v_bitop3_b32 v58, v5, v13, v14 bitop3:0xea
    ds_add_u32 v58, v2
    v_mul_hi_u32_u24 v14, 429497, v83
    v_lshrrev_b32 v12, 3, v59
    v_cos_f32 v10, v10
    v_lshlrev_b16 v13, 3, v59
    v_mad_i32_i24 v11, v14, s55, v83
    v_bitop3_b32 v12, v6, v13, v12 bitop3:0xca
    v_lshl_add_u32 v11, v11, 17, s40
    v_lshlrev_b16 v14, 8, v14
    v_lshrrev_b32 v13, 2, v59
    v_add_u32 v83, v12, v11
    v_bitop3_b32 v59, v5, v13, v14 bitop3:0xea
    ds_add_u32 v59, v2
    v_cvt_pk_bf16_f32 v65, v9, v10
    v_perm_b32 v12, v65, v65, s41
    v_bitop3_b32 v82, v4, v12, v82 bitop3:0xca
    v_perm_b32 v13, v65, v65, s42
    v_bitop3_b32 v83, v4, v13, v83 bitop3:0xca
L1_s6:
    s_waitcnt vmcnt(15)
    s_cmp_le_u32 s43, 7
    s_cbranch_scc1 L1_s7
    v_lshlrev_b32 v7, 16, v66
    v_and_b32 v8, 0xffff0000, v66
    v_lshlrev_b32 v9, 16, v67
    v_and_b32 v10, 0xffff0000, v67
    v_mul_f32 v7, 0.15915494, v7
    v_mul_f32 v8, 0.15915494, v8
    v_mul_f32 v9, 0.15915494, v9
    v_mul_f32 v10, 0.15915494, v10
    v_mul_hi_u32_u24 v14, 429497, v96
    v_lshrrev_b32 v12, 3, v60
    v_cos_f32 v7, v7
    v_lshlrev_b16 v13, 3, v60
    v_mad_i32_i24 v11, v14, s55, v96
    v_bitop3_b32 v12, v6, v13, v12 bitop3:0xca
    v_lshl_add_u32 v11, v11, 17, s40
    v_lshlrev_b16 v14, 8, v14
    v_lshrrev_b32 v13, 2, v60
    v_add_u32 v96, v12, v11
    v_bitop3_b32 v60, v5, v13, v14 bitop3:0xea
    ds_add_u32 v60, v2
    v_mul_hi_u32_u24 v14, 429497, v97
    v_lshrrev_b32 v12, 3, v61
    v_cos_f32 v8, v8
    v_lshlrev_b16 v13, 3, v61
    v_mad_i32_i24 v11, v14, s55, v97
    v_bitop3_b32 v12, v6, v13, v12 bitop3:0xca
    v_lshl_add_u32 v11, v11, 17, s40
    v_lshlrev_b16 v14, 8, v14
    v_lshrrev_b32 v13, 2, v61
    v_add_u32 v97, v12, v11
    v_bitop3_b32 v61, v5, v13, v14 bitop3:0xea
    ds_add_u32 v61, v2
    v_cvt_pk_bf16_f32 v66, v7, v8
    v_perm_b32 v12, v66, v66, s41
    v_bitop3_b32 v96, v4, v12, v96 bitop3:0xca
    v_perm_b32 v13, v66, v66, s42
    v_bitop3_b32 v97, v4, v13, v97 bitop3:0xca
    v_mul_hi_u32_u24 v14, 429497, v98
    v_lshrrev_b32 v12, 3, v62
    v_cos_f32 v9, v9
    v_lshlrev_b16 v13, 3, v62
    v_mad_i32_i24 v11, v14, s55, v98
    v_bitop3_b32 v12, v6, v13, v12 bitop3:0xca
    v_lshl_add_u32 v11, v11, 17, s40
    v_lshlrev_b16 v14, 8, v14
    v_lshrrev_b32 v13, 2, v62
    v_add_u32 v98, v12, v11
    v_bitop3_b32 v62, v5, v13, v14 bitop3:0xea
    ds_add_u32 v62, v2
    v_mul_hi_u32_u24 v14, 429497, v99
    v_lshrrev_b32 v12, 3, v63
    v_cos_f32 v10, v10
    v_lshlrev_b16 v13, 3, v63
    v_mad_i32_i24 v11, v14, s55, v99
    v_bitop3_b32 v12, v6, v13, v12 bitop3:0xca
    v_lshl_add_u32 v11, v11, 17, s40
    v_lshlrev_b16 v14, 8, v14
    v_lshrrev_b32 v13, 2, v63
    v_add_u32 v99, v12, v11
    v_bitop3_b32 v63, v5, v13, v14 bitop3:0xea
    ds_add_u32 v63, v2
    v_cvt_pk_bf16_f32 v67, v9, v10
    v_perm_b32 v12, v67, v67, s41
    v_bitop3_b32 v98, v4, v12, v98 bitop3:0xca
    v_perm_b32 v13, v67, v67, s42
    v_bitop3_b32 v99, v4, v13, v99 bitop3:0xca
L1_s7:
    v_lshrrev_b32 v8, 2, v0
    v_and_b32 v7, 0x3c00, v0
    v_bitop3_b32 v7, v5, v8, v7 bitop3:0xea
    s_waitcnt lgkmcnt(0)
    s_barrier
    ds_read2st64_b32 v[8:9], v7 offset0:0 offset1:1
    ds_read2st64_b32 v[10:11], v7 offset0:2 offset1:3
    s_add_u32 s47, s35, 0x7ed4000
    buffer_store_dwordx4 v[112:115], v0, s[20:23], s47 offen sc1
    s_waitcnt lgkmcnt(0)
    v_lshl_or_b32 v12, v9, 16, v8
    v_lshl_or_b32 v13, v11, 16, v10
    v_mov_b32 v14, v12
    v_mov_b32 v15, v13
    s_nop 0
    v_add_u32_dpp v14, v14, v14 row_shr:1 row_mask:0xf bank_mask:0xf bound_ctrl:1
    v_add_u32_dpp v15, v15, v15 row_shr:1 row_mask:0xf bank_mask:0xf bound_ctrl:1
    s_nop 0
    v_add_u32_dpp v14, v14, v14 row_shr:2 row_mask:0xf bank_mask:0xf bound_ctrl:1
    v_add_u32_dpp v15, v15, v15 row_shr:2 row_mask:0xf bank_mask:0xf bound_ctrl:1
    s_nop 0
    v_add_u32_dpp v14, v14, v14 row_shr:4 row_mask:0xf bank_mask:0xf bound_ctrl:1
    v_add_u32_dpp v15, v15, v15 row_shr:4 row_mask:0xf bank_mask:0xf bound_ctrl:1
    s_nop 0
    v_add_u32_dpp v14, v14, v14 row_shr:8 row_mask:0xf bank_mask:0xf bound_ctrl:1
    v_add_u32_dpp v15, v15, v15 row_shr:8 row_mask:0xf bank_mask:0xf bound_ctrl:1
    s_nop 0
    v_add_u32_dpp v14, v14, v14 row_bcast:15 row_mask:0xa bank_mask:0xf
    v_add_u32_dpp v15, v15, v15 row_bcast:15 row_mask:0xa bank_mask:0xf
    s_nop 0
    v_add_u32_dpp v14, v14, v14 row_bcast:31 row_mask:0xc bank_mask:0xf
    v_add_u32_dpp v15, v15, v15 row_bcast:31 row_mask:0xc bank_mask:0xf
    v_readlane_b32 s48, v14, 63
    v_readlane_b32 s49, v15, 63
    s_lshl_b32 s54, s32, 2
    v_mov_b32 v8, s54
    s_and_b32 s50, s48, 0xffff
    s_lshr_b32 s51, s48, 16
    s_and_b32 s52, s49, 0xffff
    s_lshr_b32 s53, s49, 16
    s_add_u32 s51, s51, s50
    s_add_u32 s52, s52, s51
    s_add_u32 s53, s53, s52
    v_mov_b32 v9, s53
    s_mov_b64 exec, 1
    ds_write_b32 v8, v9 offset:16384
    s_mov_b64 exec, -1
    v_and_b32 v8, 60, v7
    s_waitcnt lgkmcnt(0)
    s_barrier
    ds_read_b32 v9, v8 offset:16384
    s_waitcnt lgkmcnt(0)
    v_add_u32_dpp v9, v9, v9 row_shr:1 row_mask:0xf bank_mask:0xf bound_ctrl:1
    s_nop 1
    v_add_u32_dpp v9, v9, v9 row_shr:2 row_mask:0xf bank_mask:0xf bound_ctrl:1
    s_nop 1
    v_add_u32_dpp v9, v9, v9 row_shr:4 row_mask:0xf bank_mask:0xf bound_ctrl:1
    s_nop 1
    v_add_u32_dpp v9, v9, v9 row_shr:8 row_mask:0xf bank_mask:0xf bound_ctrl:1
    s_nop 0
    v_readlane_b32 s54, v9, s32
    s_sub_u32 s54, s54, s53
    s_add_u32 s50, s50, s54
    s_add_u32 s51, s51, s54
    s_add_u32 s52, s52, s54
    s_pack_ll_b32_b16 s48, s54, s50
    s_pack_ll_b32_b16 s49, s51, s52
    v_add_u32 v14, s48, v14
    v_add_u32 v15, s49, v15
    v_sub_u32 v12, v14, v12
    v_sub_u32 v13, v15, v13
    v_and_b32 v8, 0xffff, v12
    v_lshrrev_b32 v9, 16, v12
    v_and_b32 v10, 0xffff, v13
    v_lshrrev_b32 v11, 16, v13
    ds_write2st64_b32 v7, v8, v9 offset0:0 offset1:1
    ds_write2st64_b32 v7, v10, v11 offset0:2 offset1:3
    v_and_b32 v8, 0x3f0, v0
    v_lshl_add_u32 v8, v8, 1, s36
    ds_write_b64 v8, v[12:13] offset:20480
    s_bitset0_b64 exec, 63
    s_not_b64 exec, exec
    ds_write_b64 v8, v[14:15] offset:20512
    s_mov_b64 exec, -1
    s_waitcnt lgkmcnt(0)
    s_barrier
    s_setprio 3
    ds_add_rtn_u32 v120, v120, v2
    ds_add_rtn_u32 v121, v121, v2
    ds_add_rtn_u32 v122, v122, v2
    ds_add_rtn_u32 v123, v123, v2
    ds_read_b128 v[12:15], v0 offset:20480
    v_cmp_gt_u32 vcc, 8448, v0
    ds_add_rtn_u32 v124, v124, v2
    ds_add_rtn_u32 v125, v125, v2
    ds_add_rtn_u32 v126, v126, v2
    ds_add_rtn_u32 v127, v127, v2
    s_setprio 2
    ds_add_rtn_u32 v24, v24, v2
    ds_add_rtn_u32 v25, v25, v2
    ds_add_rtn_u32 v26, v26, v2
    ds_add_rtn_u32 v27, v27, v2
    s_waitcnt lgkmcnt(8)
    s_cbranch_vccz L1_p8
    s_add_u32 s44, s35, 0xa900000
    s_mov_b64 exec, vcc
    buffer_store_dwordx4 v[12:15], v0, s[24:27], s44 offen sc1
    s_mov_b64 exec, -1
L1_p8:
    s_add_u32 s45, s35, 0x7ed8000
    buffer_store_dwordx4 v[88:91], v0, s[20:23], s45 offen sc1
    ds_add_rtn_u32 v52, v52, v2
    ds_add_rtn_u32 v53, v53, v2
    ds_add_rtn_u32 v54, v54, v2
    ds_add_rtn_u32 v55, v55, v2
    s_setprio 1
    ds_add_rtn_u32 v68, v68, v2
    ds_add_rtn_u32 v69, v69, v2
    ds_add_rtn_u32 v70, v70, v2
    ds_add_rtn_u32 v71, v71, v2
    s_add_u32 s80, s30, 0xd340000
    s_addc_u32 s81, s31, 0
    s_mov_b32 s82, 0xa000
    s_mov_b32 s83, 0x20000
    s_min_u32 s3, s84, 127
    s_mul_i32 s3, s3, 40960
    s_add_u32 s80, s80, s3
    s_addc_u32 s81, s81, 0
    s_cmp_ge_u32 s84, 128
    s_cselect_b32 s82, 0, s82
    s_waitcnt vmcnt(2)
    v_add_u32 v9, 0, v0
    buffer_store_dwordx4 v[108:111], v9, s[80:83], 0 offen sc1
    v_add_u32 v9, 16384, v0
    buffer_store_dwordx4 v[100:103], v9, s[80:83], 0 offen sc1
    v_add_u32 v9, 32768, v0
    buffer_store_dwordx4 v[28:31], v9, s[80:83], 0 offen sc1
    s_cmp_le_u32 s43, 5
    s_cbranch_scc1 L1_s9
    ds_add_rtn_u32 v76, v76, v2
    ds_add_rtn_u32 v77, v77, v2
    ds_add_rtn_u32 v78, v78, v2
    ds_add_rtn_u32 v79, v79, v2
L1_s9:
    s_setprio 0
    s_cmp_le_u32 s43, 6
    s_cbranch_scc1 L1_s10
    ds_add_rtn_u32 v56, v56, v2
    ds_add_rtn_u32 v57, v57, v2
    ds_add_rtn_u32 v58, v58, v2
    ds_add_rtn_u32 v59, v59, v2
L1_s10:
    s_cmp_le_u32 s43, 7
    s_cbranch_scc1 L1_s11
    ds_add_rtn_u32 v60, v60, v2
    ds_add_rtn_u32 v61, v61, v2
    ds_add_rtn_u32 v62, v62, v2
    ds_add_rtn_u32 v63, v63, v2
L1_s11:
    s_waitcnt lgkmcnt(0)
    s_barrier
    s_setprio 3
    v_and_b32 v7, -4, v120
    v_lshl_add_u32 v8, v120, 2, v7
    ds_write_b32 v8, v16
    v_lshl_add_u32 v7, v7, 2, v120
    ds_write_b8 v7, v44 offset:16
    v_and_b32 v9, -4, v121
    v_lshl_add_u32 v10, v121, 2, v9
    ds_write_b32 v10, v17
    v_lshl_add_u32 v9, v9, 2, v121
    ds_write_b8_d16_hi v9, v44 offset:16
    v_and_b32 v7, -4, v122
    v_lshl_add_u32 v8, v122, 2, v7
    ds_write_b32 v8, v18
    v_lshl_add_u32 v7, v7, 2, v122
    ds_write_b8 v7, v45 offset:16
    v_and_b32 v9, -4, v123
    v_lshl_add_u32 v10, v123, 2, v9
    ds_write_b32 v10, v19
    v_lshl_add_u32 v9, v9, 2, v123
    ds_write_b8_d16_hi v9, v45 offset:16
    s_add_u32 s46, s35, 0x7edc000
    buffer_store_dwordx4 v[116:119], v0, s[20:23], s46 offen sc1
    v_and_b32 v7, -4, v124
    v_lshl_add_u32 v8, v124, 2, v7
    ds_write_b32 v8, v20
    v_lshl_add_u32 v7, v7, 2, v124
    ds_write_b8 v7, v46 offset:16
    v_and_b32 v9, -4, v125
    v_lshl_add_u32 v10, v125, 2, v9
    ds_write_b32 v10, v21
    v_lshl_add_u32 v9, v9, 2, v125
    ds_write_b8_d16_hi v9, v46 offset:16
    v_and_b32 v7, -4, v126
    v_lshl_add_u32 v8, v126, 2, v7
    ds_write_b32 v8, v22
    v_lshl_add_u32 v7, v7, 2, v126
    ds_write_b8 v7, v47 offset:16
    v_and_b32 v9, -4, v127
    v_lshl_add_u32 v10, v127, 2, v9
    ds_write_b32 v10, v23
    v_lshl_add_u32 v9, v9, 2, v127
    ds_write_b8_d16_hi v9, v47 offset:16
    s_setprio 2
    v_and_b32 v7, -4, v24
    v_lshl_add_u32 v8, v24, 2, v7
    ds_write_b32 v8, v40
    v_lshl_add_u32 v7, v7, 2, v24
    ds_write_b8 v7, v32 offset:16
    v_and_b32 v9, -4, v25
    v_lshl_add_u32 v10, v25, 2, v9
    ds_write_b32 v10, v41
    v_lshl_add_u32 v9, v9, 2, v25
    ds_write_b8_d16_hi v9, v32 offset:16
    v_and_b32 v7, -4, v26
    v_lshl_add_u32 v8, v26, 2, v7
    ds_write_b32 v8, v42
    v_lshl_add_u32 v7, v7, 2, v26
    ds_write_b8 v7, v33 offset:16
    v_and_b32 v9, -4, v27
    v_lshl_add_u32 v10, v27, 2, v9
    ds_write_b32 v10, v43
    v_lshl_add_u32 v9, v9, 2, v27
    ds_write_b8_d16_hi v9, v33 offset:16
    s_add_u32 s47, s35, 0x7ee0000
    buffer_store_dwordx4 v[92:95], v0, s[20:23], s47 offen sc1
    v_and_b32 v7, -4, v52
    v_lshl_add_u32 v8, v52, 2, v7
    ds_write_b32 v8, v48
    v_lshl_add_u32 v7, v7, 2, v52
    ds_write_b8 v7, v34 offset:16
    v_and_b32 v9, -4, v53
    v_lshl_add_u32 v10, v53, 2, v9
    ds_write_b32 v10, v49
    v_lshl_add_u32 v9, v9, 2, v53
    ds_write_b8_d16_hi v9, v34 offset:16
    v_and_b32 v7, -4, v54
    v_lshl_add_u32 v8, v54, 2, v7
    ds_write_b32 v8, v50
    v_lshl_add_u32 v7, v7, 2, v54
    ds_write_b8 v7, v35 offset:16
    v_and_b32 v9, -4, v55
    v_lshl_add_u32 v10, v55, 2, v9
    ds_write_b32 v10, v51
    v_lshl_add_u32 v9, v9, 2, v55
    ds_write_b8_d16_hi v9, v35 offset:16
    s_setprio 1
    v_and_b32 v7, -4, v68
    v_lshl_add_u32 v8, v68, 2, v7
    ds_write_b32 v8, v84
    v_lshl_add_u32 v7, v7, 2, v68
    ds_write_b8 v7, v72 offset:16
    v_and_b32 v9, -4, v69
    v_lshl_add_u32 v10, v69, 2, v9
    ds_write_b32 v10, v85
    v_lshl_add_u32 v9, v9, 2, v69
    ds_write_b8_d16_hi v9, v72 offset:16
    v_and_b32 v7, -4, v70
    v_lshl_add_u32 v8, v70, 2, v7
    ds_write_b32 v8, v86
    v_lshl_add_u32 v7, v7, 2, v70
    ds_write_b8 v7, v73 offset:16
    v_and_b32 v9, -4, v71
    v_lshl_add_u32 v10, v71, 2, v9
    ds_write_b32 v10, v87
    v_lshl_add_u32 v9, v9, 2, v71
    ds_write_b8_d16_hi v9, v73 offset:16
    s_cmp_le_u32 s43, 5
    s_cbranch_scc1 L1_s12
    v_and_b32 v7, -4, v76
    v_lshl_add_u32 v8, v76, 2, v7
    ds_write_b32 v8, v36
    v_lshl_add_u32 v7, v7, 2, v76
    ds_write_b8 v7, v74 offset:16
    v_and_b32 v9, -4, v77
    v_lshl_add_u32 v10, v77, 2, v9
    ds_write_b32 v10, v37
    v_lshl_add_u32 v9, v9, 2, v77
    ds_write_b8_d16_hi v9, v74 offset:16
    v_and_b32 v7, -4, v78
    v_lshl_add_u32 v8, v78, 2, v7
    ds_write_b32 v8, v38
    v_lshl_add_u32 v7, v7, 2, v78
    ds_write_b8 v7, v75 offset:16
    v_and_b32 v9, -4, v79
    v_lshl_add_u32 v10, v79, 2, v9
    ds_write_b32 v10, v39
    v_lshl_add_u32 v9, v9, 2, v79
    ds_write_b8_d16_hi v9, v75 offset:16
L1_s12:
    s_add_u32 s44, s35, 0x7ee4000
    buffer_store_dwordx4 v[104:107], v0, s[20:23], s44 offen sc1
    s_setprio 0
    s_cmp_le_u32 s43, 6
    s_cbranch_scc1 L1_s13
    v_and_b32 v7, -4, v56
    v_lshl_add_u32 v8, v56, 2, v7
    ds_write_b32 v8, v80
    v_lshl_add_u32 v7, v7, 2, v56
    ds_write_b8 v7, v64 offset:16
    v_and_b32 v9, -4, v57
    v_lshl_add_u32 v10, v57, 2, v9
    ds_write_b32 v10, v81
    v_lshl_add_u32 v9, v9, 2, v57
    ds_write_b8_d16_hi v9, v64 offset:16
    v_and_b32 v7, -4, v58
    v_lshl_add_u32 v8, v58, 2, v7
    ds_write_b32 v8, v82
    v_lshl_add_u32 v7, v7, 2, v58
    ds_write_b8 v7, v65 offset:16
    v_and_b32 v9, -4, v59
    v_lshl_add_u32 v10, v59, 2, v9
    ds_write_b32 v10, v83
    v_lshl_add_u32 v9, v9, 2, v59
    ds_write_b8_d16_hi v9, v65 offset:16
L1_s13:
    s_cmp_le_u32 s43, 7
    s_cbranch_scc1 L1_s14
    v_and_b32 v7, -4, v60
    v_lshl_add_u32 v8, v60, 2, v7
    ds_write_b32 v8, v96
    v_lshl_add_u32 v7, v7, 2, v60
    ds_write_b8 v7, v66 offset:16
    v_and_b32 v9, -4, v61
    v_lshl_add_u32 v10, v61, 2, v9
    ds_write_b32 v10, v97
    v_lshl_add_u32 v9, v9, 2, v61
    ds_write_b8_d16_hi v9, v66 offset:16
    v_and_b32 v7, -4, v62
    v_lshl_add_u32 v8, v62, 2, v7
    ds_write_b32 v8, v98
    v_lshl_add_u32 v7, v7, 2, v62
    ds_write_b8 v7, v67 offset:16
    v_and_b32 v9, -4, v63
    v_lshl_add_u32 v10, v63, 2, v9
    ds_write_b32 v10, v99
    v_lshl_add_u32 v9, v9, 2, v63
    ds_write_b8_d16_hi v9, v67 offset:16
L1_s14:
    v_add_u32 v7, 0x10000, v0
    v_add_u32 v12, 0x20000, v0
    s_waitcnt lgkmcnt(0)
    s_barrier
    ds_read_b128 v[112:115], v0 offset:0
    ds_read_b128 v[88:91], v0 offset:16384
    ds_read_b128 v[108:111], v0 offset:32768
    ds_read_b128 v[100:103], v0 offset:49152
    ds_read_b128 v[28:31], v7 offset:0
    ds_read_b128 v[16:19], v7 offset:16384
    ds_read_b128 v[120:123], v7 offset:32768
    ds_read_b128 v[116:119], v7 offset:49152
    ds_read_b128 v[20:23], v12 offset:0
    ds_read_b128 v[124:127], v12 offset:16384
    s_waitcnt lgkmcnt(9)
    s_add_u32 s45, s35, 0xa900000
    buffer_store_dwordx4 v[112:115], v0, s[20:23], s45 offen sc1
    s_waitcnt lgkmcnt(8)
    s_add_u32 s46, s35, 0xa904000
    buffer_store_dwordx4 v[88:91], v0, s[20:23], s46 offen sc1
    s_waitcnt lgkmcnt(7)
    s_add_u32 s47, s35, 0xa908000
    buffer_store_dwordx4 v[108:111], v0, s[20:23], s47 offen sc1
    s_waitcnt lgkmcnt(6)
    s_add_u32 s44, s35, 0xa90c000
    buffer_store_dwordx4 v[100:103], v0, s[20:23], s44 offen sc1
    s_waitcnt lgkmcnt(5)
    s_add_u32 s45, s35, 0xa910000
    buffer_store_dwordx4 v[28:31], v0, s[20:23], s45 offen sc1
    s_waitcnt lgkmcnt(4)
    s_add_u32 s46, s35, 0xa914000
    buffer_store_dwordx4 v[16:19], v0, s[20:23], s46 offen sc1
    s_waitcnt lgkmcnt(3)
    s_add_u32 s47, s35, 0xa918000
    buffer_store_dwordx4 v[120:123], v0, s[20:23], s47 offen sc1
    s_cmp_le_u32 s43, 5
    s_cbranch_scc1 L1_fin
    s_waitcnt lgkmcnt(2)
    s_add_u32 s44, s35, 0xa91c000
    buffer_store_dwordx4 v[116:119], v0, s[20:23], s44 offen sc1
    s_cmp_le_u32 s43, 6
    s_cbranch_scc1 L1_fin
    s_waitcnt lgkmcnt(1)
    s_add_u32 s45, s35, 0xa920000
    buffer_store_dwordx4 v[20:23], v0, s[20:23], s45 offen sc1
    s_cmp_le_u32 s43, 7
    s_cbranch_scc1 L1_fin
    s_waitcnt lgkmcnt(0)
    s_add_u32 s46, s35, 0xa924000
    buffer_store_dwordx4 v[124:127], v0, s[20:23], s46 offen sc1
L1_fin:
L1_end:
    s_endpgm
.text
.globl gs_acc_kernel
.p2align 8
.type gs_acc_kernel,@function
gs_acc_kernel:
    s_cmp_ge_u32 s2, 256
    s_cbranch_scc1 L2_end
    s_load_dwordx2 s[30:31], s[0:1], 104
    s_load_dwordx2 s[28:29], s[0:1], 0
    s_load_dwordx2 s[6:7], s[0:1], 40
    v_lshrrev_b32 v16, 6, v0
    v_and_b32 v17, 63, v0
    v_readfirstlane_b32 s32, v16
    s_bfe_u32 s33, s2, 0x20001
    s_and_b32 s34, s2, 1
    s_lshl_b32 s34, s34, 5
    s_lshr_b32 s4, s2, 3
    s_add_u32 s34, s34, s4
    v_and_b32 v22, 3, v0
    v_mul_u32_u24 v19, 80, v16
    v_add_u32 v18, v17, v19
    v_mul_u32_u24 v2, 173056, v18
    v_lshrrev_b32 v18, 2, v17
    v_add3_u32 v18, v18, v19, 64
    v_mul_u32_u24 v4, 173056, v18
    v_lshl_add_u32 v20, v22, 4, v4
    v_and_b32 v18, 3, v18
    v_lshl_add_u32 v20, v18, 5, v20
    v_lshl_add_u32 v25, v22, 5, v2
    s_mul_i32 s39, s33, 2080
    s_lshl_b32 s3, s34, 5
    s_add_u32 s39, s39, s3
    s_mul_i32 s40, s33, 1310720
    s_mul_i32 s3, s32, 5120
    v_lshl_add_u32 v3, v17, 4, s3
    s_lshl_b32 s38, s32, 11
    s_mul_i32 s69, s32, 3072
    s_waitcnt lgkmcnt(0)
    s_add_u32 s12, s30, 0x28000
    s_addc_u32 s13, s31, 0
    s_mov_b32 s14, 0xd318000
    s_mov_b32 s15, 0x20000
    buffer_load_dwordx4 v[48:51], v25, s[12:15], s39 offen offset:0
    buffer_load_dwordx4 v[56:59], v25, s[12:15], s39 offen offset:32
    buffer_load_dwordx4 v[52:55], v25, s[12:15], s39 offen offset:16
    buffer_load_dwordx4 v[60:63], v25, s[12:15], s39 offen offset:48
    buffer_load_dwordx4 v[64:67], v20, s[12:15], s39 offen
    s_add_u32 s16, s30, 0xd340000
    s_addc_u32 s17, s31, 0
    s_mov_b32 s18, 0x500000
    s_mov_b32 s19, 0x20000
    s_add_u32 s24, s30, 0xebc9000
    s_addc_u32 s25, s31, 0
    s_mov_b32 s26, 0x100
    s_mov_b32 s27, 0x20000
    v_lshlrev_b32 v21, 6, v22
    buffer_load_dwordx2 v[8:9], v21, s[24:27], 0 offen offset:40
    s_add_u32 s3, s40, 4096
    buffer_load_dwordx4 v[124:127], v3, s[16:19], s3 offen
    buffer_load_dwordx4 v[116:119], v3, s[16:19], s40 offen offset:2048
    buffer_load_dwordx4 v[120:123], v3, s[16:19], s40 offen offset:3072
    buffer_load_dwordx4 v[108:111], v3, s[16:19], s40 offen offset:0
    buffer_load_dwordx4 v[112:115], v3, s[16:19], s40 offen offset:1024
    s_add_u32 s40, s40, 0x50000
    v_mad_u32_u24 v4, v22, 20, v4
    v_or_b32 v4, 0xf0000000, v4
    v_or_b32 v2, 0xf0000000, v2
    v_lshlrev_b32 v23, 2, v22
    v_sub_u32 v1, 28, v23
    v_and_b32 v18, 3, v0
    v_lshlrev_b32 v18, 4, v18
    v_mov_b32 v10, 0x3f80
    v_mov_b32 v11, 0
    v_lshlrev_b64 v[10:11], v18, v[10:11]
    v_and_b32 v18, 3, v0
    v_lshlrev_b32 v18, 4, v18
    v_mov_b32 v12, 0xbf80
    v_mov_b32 v13, 0
    v_lshlrev_b64 v[12:13], v18, v[12:13]
    v_lshlrev_b32 v24, 4, v0
    v_lshl_add_u32 v0, v17, 2, s38
    v_mov_b32 v45, 0xf0000000
    v_mov_b32 v5, 0x1fff8
    v_mov_b32 v6, 0x07ff0000
    s_mov_b32 s44, 0x4000c0c
    s_mov_b32 s45, 0x4010c0c
    s_mov_b32 s46, 0x4020c0c
    s_mov_b32 s47, 0x4030c0c
    s_mov_b32 s36, 0
    s_mov_b32 s42, 0
    s_mov_b64 s[80:81], 0
    s_mov_b64 s[84:85], 0
    s_mov_b64 s[48:49], 0
    s_load_dwordx4 s[96:99], s[6:7], 0
    s_load_dwordx2 s[4:5], s[0:1], 24
    s_waitcnt lgkmcnt(0)
    s_mov_b32 s8, s30
    s_mov_b32 s9, s31
    s_mov_b32 s10, 0xd340000
    s_mov_b32 s11, 0x20000
    s_add_u32 s20, s30, 0xd841000
    s_addc_u32 s21, s31, 0
    s_mov_b32 s22, 0x13880
    s_mov_b32 s23, 0x20000
    s_lshl_b32 s3, s33, 6
    s_add_u32 s3, s3, s34
    s_mul_i32 s3, s3, 80000
    s_add_u32 s20, s20, s3
    s_addc_u32 s21, s21, 0
    v_mov_b32 v68, 0
    v_mov_b32 v69, 0
    v_mov_b32 v70, 0
    v_mov_b32 v71, 0
    v_mov_b32 v72, 0
    v_mov_b32 v73, 0
    v_mov_b32 v74, 0
    v_mov_b32 v75, 0
    v_add_u32 v24, 81920, v24
    ds_write_b128 v24, v[68:71] offset:0
    ds_write_b128 v24, v[68:71] offset:16384
    ds_write_b128 v24, v[68:71] offset:32768
    ds_write_b128 v24, v[68:71] offset:49152
    v_add_u32 v47, 0x10000, v24
    ds_write_b128 v47, v[68:71]
    s_waitcnt vmcnt(5)
    v_sub_u16 v88, v56, v48
    v_and_b32 v89, 3, v48
    v_add3_u32 v99, v88, v89, 3
    v_and_b32 v99, -4, v99
    v_max_u32 v99, 4, v99
    v_and_b32 v97, 0xfffc, v48
    v_bfm_b32 v96, v88, v89
    v_add_u32_dpp v91, v99, v99 row_shr:1 row_mask:0xf bank_mask:0xf bound_ctrl:1
    v_mad_u32_u24 v97, v97, 5, v2
    v_cmp_lt_u32 vcc, 16, v99
    v_add_u32_dpp v91, v91, v91 row_shr:2 row_mask:0xf bank_mask:0xf bound_ctrl:1
    v_sub_u32 v98, s38, v99
    v_lshrrev_b64 v[48:49], 16, v[48:49]
    v_add_u32_dpp v91, v91, v91 row_shr:4 row_mask:0xf bank_mask:0xf bound_ctrl:1
    v_lshrrev_b64 v[56:57], 16, v[56:57]
    s_mov_b32 s43, 0
    v_add_u32_dpp v91, v91, v91 row_shr:8 row_mask:0xf bank_mask:0xf bound_ctrl:1
    s_nop 1
    v_add_u32_dpp v91, v91, v91 row_bcast:15 row_mask:0xa bank_mask:0xf
    s_nop 1
    v_add_u32_dpp v91, v91, v91 row_bcast:31 row_mask:0xc bank_mask:0xf
    v_add_u32 v98, v98, v91
    v_readlane_b32 s37, v91, 63
    s_cbranch_vccnz L2_xo1
L2_xp1:
    v_mov_b32 v44, v43
    s_cmp_gt_u32 s37, 1024
    s_cbranch_scc1 L2_xs2
    s_cmp_lg_u32 s43, 0
    s_cbranch_scc1 L2_xa2
L2_xb2:
    v_lshlrev_b32 v89, 16, v96
    v_add_u32 v90, 60, v97
    v_bitop3_b32 v90, v89, v45, v90 bitop3:0x6a
    ds_write_b32 v98, v90 offset:12
    v_lshlrev_b32 v89, 20, v96
    v_add_u32 v90, 40, v97
    v_bitop3_b32 v90, v89, v45, v90 bitop3:0x6a
    ds_write_b32 v98, v90 offset:8
    v_lshlrev_b32 v89, 24, v96
    v_add_u32 v90, 20, v97
    v_bitop3_b32 v90, v89, v45, v90 bitop3:0x6a
    ds_write_b32 v98, v90 offset:4
    v_lshlrev_b32 v89, 28, v96
    v_bitop3_b32 v90, v89, v45, v97 bitop3:0x6a
    ds_write_b32 v98, v90 offset:0
    v_mov_b32_dpp v91, v64 quad_perm:[0,0,0,0] row_mask:0xf bank_mask:0xf
    v_and_b32 v89, 3, v91
    v_and_b32 v97, 0xfffc, v91
    v_sub_u16_dpp v88, v64, v91 quad_perm:[2,2,2,2] row_mask:0xf bank_mask:0xf
    v_mad_u32_u24 v97, v97, 5, v4
    v_add_u32 v99, v88, v89
    v_bfm_b32 v96, v88, v89
    v_cmp_lt_u32 s[58:59], 16, v99
    v_lshlrev_b32 v89, v1, v96
    v_and_b32 v89, v45, v89
    v_cmp_ne_u32 vcc, 0, v89
    v_xor_b32 v90, v97, v89
    s_add_u32 s3, s37, s38
    v_mbcnt_lo_u32_b32 v98, vcc_lo, 0
    v_mbcnt_hi_u32_b32 v98, vcc_hi, v98
    s_bcnt1_i32_b64 s41, vcc
    v_lshl_add_u32 v98, v98, 2, s3
    s_mov_b64 exec, vcc
    ds_write_b32 v98, v90
    s_mov_b64 exec, -1
    s_lshl2_add_u32 s37, s41, s37
    s_cmp_lg_u64 s[58:59], 0
    s_cbranch_scc1 L2_xe2
L2_xr2:
    v_add_u32 v98, s37, v0
    v_mov_b32 v90, -1
    ds_write_b32 v98, v90
    ds_read2st64_b32 v[40:41], v0 offset0:0 offset1:1
    ds_read2st64_b32 v[42:43], v0 offset0:2 offset1:3
    s_sub_u32 s3, s37, 768
    s_cmp_gt_u32 s3, 256
    s_cbranch_scc1 L2_xf2
L2_xg2:
    v_sub_u16 v88, v58, v50
    v_and_b32 v89, 3, v50
    v_add3_u32 v99, v88, v89, 3
    v_and_b32 v99, -4, v99
    v_max_u32 v99, 4, v99
    v_and_b32 v97, 0xfffc, v50
    v_bfm_b32 v96, v88, v89
    v_add_u32_dpp v91, v99, v99 row_shr:1 row_mask:0xf bank_mask:0xf bound_ctrl:1
    v_mad_u32_u24 v97, v97, 5, v2
    v_cmp_lt_u32 vcc, 16, v99
    v_add_u32_dpp v91, v91, v91 row_shr:2 row_mask:0xf bank_mask:0xf bound_ctrl:1
    v_sub_u32 v98, s38, v99
    v_lshrrev_b64 v[50:51], 16, v[50:51]
    v_add_u32_dpp v91, v91, v91 row_shr:4 row_mask:0xf bank_mask:0xf bound_ctrl:1
    v_lshrrev_b64 v[58:59], 16, v[58:59]
    s_mov_b32 s43, 0
    v_add_u32_dpp v91, v91, v91 row_shr:8 row_mask:0xf bank_mask:0xf bound_ctrl:1
    s_nop 1
    v_add_u32_dpp v91, v91, v91 row_bcast:15 row_mask:0xa bank_mask:0xf
    s_nop 1
    v_add_u32_dpp v91, v91, v91 row_bcast:31 row_mask:0xc bank_mask:0xf
    v_add_u32 v98, v98, v91
    v_readlane_b32 s37, v91, 63
    s_cbranch_vccnz L2_xo3
L2_xp3:
    s_waitcnt lgkmcnt(0)
    v_mov_b32 v21, v40
    v_mov_b32 v27, v41
    v_mov_b32 v33, v42
    v_mov_b32 v39, v43
    v_and_b32 v47, 0x0fffffff, v21
    buffer_load_dwordx2 v[16:17], v47, s[8:11], 0 offen
    buffer_load_dwordx3 v[18:20], v47, s[8:11], 0 offen offset:8
    s_waitcnt vmcnt(6)
    s_mov_b32 m0, s69
    s_nop 0
    ds_write_addtid_b32 v124 offset:34816
    ds_write_addtid_b32 v125 offset:35072
    ds_write_addtid_b32 v126 offset:35328
    ds_write_addtid_b32 v127 offset:35584
    s_waitcnt vmcnt(5)
    ds_write_addtid_b32 v116 offset:32768
    ds_write_addtid_b32 v117 offset:33024
    ds_write_addtid_b32 v118 offset:33280
    ds_write_addtid_b32 v119 offset:33536
    s_waitcnt vmcnt(4)
    ds_write_addtid_b32 v120 offset:33792
    ds_write_addtid_b32 v121 offset:34048
    ds_write_addtid_b32 v122 offset:34304
    ds_write_addtid_b32 v123 offset:34560
    v_mov_b32 v44, v43
    s_cmp_gt_u32 s37, 1024
    s_cbranch_scc1 L2_xs4
    s_cmp_lg_u32 s43, 0
    s_cbranch_scc1 L2_xa4
L2_xb4:
    v_lshlrev_b32 v89, 16, v96
    v_add_u32 v90, 60, v97
    v_bitop3_b32 v90, v89, v45, v90 bitop3:0x6a
    ds_write_b32 v98, v90 offset:12
    v_lshlrev_b32 v89, 20, v96
    v_add_u32 v90, 40, v97
    v_bitop3_b32 v90, v89, v45, v90 bitop3:0x6a
    ds_write_b32 v98, v90 offset:8
    v_lshlrev_b32 v89, 24, v96
    v_add_u32 v90, 20, v97
    v_bitop3_b32 v90, v89, v45, v90 bitop3:0x6a
    ds_write_b32 v98, v90 offset:4
    v_lshlrev_b32 v89, 28, v96
    v_bitop3_b32 v90, v89, v45, v97 bitop3:0x6a
    ds_write_b32 v98, v90 offset:0
    v_mov_b32_dpp v91, v66 quad_perm:[0,0,0,0] row_mask:0xf bank_mask:0xf
    v_and_b32 v89, 3, v91
    v_and_b32 v97, 0xfffc, v91
    v_sub_u16_dpp v88, v66, v91 quad_perm:[2,2,2,2] row_mask:0xf bank_mask:0xf
    v_mad_u32_u24 v97, v97, 5, v4
    v_add_u32 v99, v88, v89
    v_bfm_b32 v96, v88, v89
    v_cmp_lt_u32 s[58:59], 16, v99
    v_lshlrev_b32 v89, v1, v96
    v_and_b32 v89, v45, v89
    v_cmp_ne_u32 vcc, 0, v89
    v_xor_b32 v90, v97, v89
    s_add_u32 s3, s37, s38
    v_mbcnt_lo_u32_b32 v98, vcc_lo, 0
    v_mbcnt_hi_u32_b32 v98, vcc_hi, v98
    s_bcnt1_i32_b64 s41, vcc
    v_lshl_add_u32 v98, v98, 2, s3
    s_mov_b64 exec, vcc
    ds_write_b32 v98, v90
    s_mov_b64 exec, -1
    s_lshl2_add_u32 s37, s41, s37
    s_cmp_lg_u64 s[58:59], 0
    s_cbranch_scc1 L2_xe4
L2_xr4:
    v_add_u32 v98, s37, v0
    v_mov_b32 v90, -1
    ds_write_b32 v98, v90
    ds_read2st64_b32 v[40:41], v0 offset0:0 offset1:1
    ds_read2st64_b32 v[42:43], v0 offset0:2 offset1:3
    s_sub_u32 s3, s37, 768
    s_cmp_gt_u32 s3, 256
    s_cbranch_scc1 L2_xf4
L2_xg4:
    s_waitcnt vmcnt(3)
    s_mov_b32 m0, s38
    s_nop 0
    ds_write_addtid_b32 v108 offset:0
    ds_write_addtid_b32 v109 offset:256
    ds_write_addtid_b32 v110 offset:512
    ds_write_addtid_b32 v111 offset:768
    s_waitcnt vmcnt(2)
    ds_write_addtid_b32 v112 offset:1024
    ds_write_addtid_b32 v113 offset:1280
    ds_write_addtid_b32 v114 offset:1536
    ds_write_addtid_b32 v115 offset:1792
    s_waitcnt lgkmcnt(0)
    s_barrier
    s_bitcmp1_b32 s36, s42
    s_cbranch_scc1 L2_slow
L2_ret0:
    s_setprio 3
    v_and_b32 v47, 0x0fffffff, v27
    buffer_load_dwordx2 v[22:23], v47, s[8:11], 0 offen
    buffer_load_dwordx3 v[24:26], v47, s[8:11], 0 offen offset:8
    s_waitcnt vmcnt(2)
    v_and_b32 v46, 0x20000000, v21
    v_lshrrev_b32 v47, 14, v17
    v_bitop3_b32 v47, v47, v5, v46 bitop3:0xea
    ds_read_b64 v[102:103], v47
    v_bitop3_b32 v93, v17, v5, v46 bitop3:0xea
    v_and_b32 v46, 0x10000000, v21
    v_lshrrev_b32 v47, 14, v16
    v_bitop3_b32 v47, v47, v5, v46 bitop3:0xea
    ds_read_b64 v[100:101], v47
    v_bitop3_b32 v92, v16, v5, v46 bitop3:0xea
    v_perm_b32 v15, v17, v20, s45
    v_bitop3_b32 v46, v17, 0.5, -0.5 bitop3:0xa8
    v_perm_b32 v14, v16, v20, s44
    v_bitop3_b32 v47, v16, 0.5, -0.5 bitop3:0xa8
    s_waitcnt lgkmcnt(0)
    v_mfma_f32_4x4x4_16b_bf16 v[80:83], v[8:9], v[102:103], 0
    v_mfma_f32_4x4x4_16b_bf16 v[76:79], v[8:9], v[100:101], 0
    v_bitop3_b32 v15, v6, v15, v46 bitop3:0xca
    v_bitop3_b32 v14, v6, v14, v47 bitop3:0xca
    v_cmp_lt_u32 s[84:85], v5, v92
    s_nop 0
    v_pk_mul_f32 v[80:81], v[80:81], v[14:15] op_sel:[0,1] op_sel_hi:[1,1]
    v_pk_mul_f32 v[82:83], v[82:83], v[14:15] op_sel:[0,1] op_sel_hi:[1,1]
    v_pk_mul_f32 v[76:77], v[76:77], v[14:15] op_sel:[0,0] op_sel_hi:[1,0]
    v_pk_mul_f32 v[78:79], v[78:79], v[14:15] op_sel:[0,0] op_sel_hi:[1,0]
    v_and_b32 v47, 0x0fffffff, v33
    buffer_load_dwordx2 v[28:29], v47, s[8:11], 0 offen
    buffer_load_dwordx3 v[30:32], v47, s[8:11], 0 offen offset:8
    v_cmpx_ne_u64 vcc, v[74:75], v[70:71]
    s_and_b64 s[82:83], vcc, s[80:81]
    s_cbranch_scc1 L2_c5
L2_d5:
    v_mov_b64 v[84:85], v[70:71]
    v_mov_b32 v7, v95
    v_mov_b64 v[86:87], v[74:75]
    s_mov_b64 exec, -1
    s_or_b64 s[80:81], s[80:81], vcc
    v_cmpx_ne_u64 vcc, v[72:73], v[68:69]
    s_and_b64 s[82:83], vcc, s[80:81]
    s_cbranch_scc1 L2_c6
L2_d6:
    v_mov_b64 v[84:85], v[68:69]
    v_mov_b32 v7, v94
    v_mov_b64 v[86:87], v[72:73]
    s_mov_b64 exec, -1
    s_or_b64 s[80:81], s[80:81], vcc
    ds_read_b64 v[70:71], v93 offset:65408
    s_and_b64 exec, s[84:85], s[80:81]
    v_mfma_f32_4x4x4_16b_bf16 v[76:79], v[12:13], v[84:85], 0
    v_mov_b32 v92, v7
    s_andn2_b64 s[80:81], s[80:81], s[84:85]
    v_mfma_f32_4x4x4_16b_bf16 v[76:79], v[10:11], v[86:87], v[76:79]
    s_mov_b64 exec, -1
    ds_read_b64 v[68:69], v92 offset:65408
    v_and_b32 v46, 0x80000000, v21
    v_lshrrev_b32 v47, 14, v19
    v_bitop3_b32 v47, v47, v5, v46 bitop3:0xea
    ds_read_b64 v[106:107], v47
    v_bitop3_b32 v95, v19, v5, v46 bitop3:0xea
    v_and_b32 v46, 0x40000000, v21
    v_lshrrev_b32 v47, 14, v18
    v_bitop3_b32 v47, v47, v5, v46 bitop3:0xea
    ds_read_b64 v[104:105], v47
    v_bitop3_b32 v94, v18, v5, v46 bitop3:0xea
    s_waitcnt lgkmcnt(2)
    v_mfma_f32_4x4x4_16b_bf16 v[80:83], v[10:11], v[70:71], v[80:83]
    v_mfma_f32_4x4x4_16b_bf16 v[76:79], v[10:11], v[68:69], v[76:79]
    v_perm_b32 v15, v19, v20, s47
    v_bitop3_b32 v46, v19, 0.5, -0.5 bitop3:0xa8
    v_perm_b32 v14, v18, v20, s46
    v_bitop3_b32 v47, v18, 0.5, -0.5 bitop3:0xa8
    v_cvt_pk_bf16_f32 v80, v80, v81
    v_cvt_pk_bf16_f32 v81, v82, v83
    ds_wrxchg_rtn_b64 v[74:75], v93, v[80:81] offset:65408
    v_cvt_pk_bf16_f32 v76, v76, v77
    v_cvt_pk_bf16_f32 v77, v78, v79
    ds_wrxchg_rtn_b64 v[72:73], v92, v[76:77] offset:65408
    s_setprio 2
    s_waitcnt lgkmcnt(2)
    v_mfma_f32_4x4x4_16b_bf16 v[80:83], v[8:9], v[106:107], 0
    v_mfma_f32_4x4x4_16b_bf16 v[76:79], v[8:9], v[104:105], 0
    v_bitop3_b32 v15, v6, v15, v46 bitop3:0xca
    v_bitop3_b32 v14, v6, v14, v47 bitop3:0xca
    s_nop 1
    v_pk_mul_f32 v[80:81], v[80:81], v[14:15] op_sel:[0,1] op_sel_hi:[1,1]
    v_pk_mul_f32 v[82:83], v[82:83], v[14:15] op_sel:[0,1] op_sel_hi:[1,1]
    v_pk_mul_f32 v[76:77], v[76:77], v[14:15] op_sel:[0,0] op_sel_hi:[1,0]
    v_pk_mul_f32 v[78:79], v[78:79], v[14:15] op_sel:[0,0] op_sel_hi:[1,0]
    s_add_u32 s3, s40, 4096
    buffer_load_dwordx4 v[124:127], v3, s[16:19], s3 offen
    buffer_load_dwordx4 v[116:119], v3, s[16:19], s40 offen offset:2048
    s_waitcnt lgkmcnt(0)
    v_cmpx_ne_u64 vcc, v[74:75], v[70:71]
    s_and_b64 s[82:83], vcc, s[80:81]
    s_cbranch_scc1 L2_c7
L2_d7:
    v_mov_b64 v[84:85], v[70:71]
    v_mov_b32 v7, v93
    v_mov_b64 v[86:87], v[74:75]
    s_mov_b64 exec, -1
    s_or_b64 s[80:81], s[80:81], vcc
    v_cmpx_ne_u64 vcc, v[72:73], v[68:69]
    s_and_b64 s[82:83], vcc, s[80:81]
    s_cbranch_scc1 L2_c8
L2_d8:
    v_mov_b64 v[84:85], v[68:69]
    v_mov_b32 v7, v92
    v_mov_b64 v[86:87], v[72:73]
    s_mov_b64 exec, -1
    s_or_b64 s[80:81], s[80:81], vcc
    ds_read_b64 v[70:71], v95 offset:65408
    ds_read_b64 v[68:69], v94 offset:65408
    s_waitcnt vmcnt(4)
    v_and_b32 v46, 0x20000000, v27
    v_lshrrev_b32 v47, 14, v23
    v_bitop3_b32 v47, v47, v5, v46 bitop3:0xea
    ds_read_b64 v[102:103], v47
    v_bitop3_b32 v93, v23, v5, v46 bitop3:0xea
    v_and_b32 v46, 0x10000000, v27
    v_lshrrev_b32 v47, 14, v22
    v_bitop3_b32 v47, v47, v5, v46 bitop3:0xea
    ds_read_b64 v[100:101], v47
    v_bitop3_b32 v92, v22, v5, v46 bitop3:0xea
    s_waitcnt lgkmcnt(2)
    v_mfma_f32_4x4x4_16b_bf16 v[80:83], v[10:11], v[70:71], v[80:83]
    v_mfma_f32_4x4x4_16b_bf16 v[76:79], v[10:11], v[68:69], v[76:79]
    v_perm_b32 v15, v23, v26, s45
    v_bitop3_b32 v46, v23, 0.5, -0.5 bitop3:0xa8
    v_perm_b32 v14, v22, v26, s44
    v_bitop3_b32 v47, v22, 0.5, -0.5 bitop3:0xa8
    v_cvt_pk_bf16_f32 v80, v80, v81
    v_cvt_pk_bf16_f32 v81, v82, v83
    ds_wrxchg_rtn_b64 v[74:75], v95, v[80:81] offset:65408
    v_cvt_pk_bf16_f32 v76, v76, v77
    v_cvt_pk_bf16_f32 v77, v78, v79
    ds_wrxchg_rtn_b64 v[72:73], v94, v[76:77] offset:65408
    s_waitcnt lgkmcnt(2)
    v_mfma_f32_4x4x4_16b_bf16 v[80:83], v[8:9], v[102:103], 0
    v_mfma_f32_4x4x4_16b_bf16 v[76:79], v[8:9], v[100:101], 0
    v_bitop3_b32 v15, v6, v15, v46 bitop3:0xca
    v_bitop3_b32 v14, v6, v14, v47 bitop3:0xca
    v_cmp_lt_u32 s[84:85], v5, v92
    s_nop 0
    v_pk_mul_f32 v[80:81], v[80:81], v[14:15] op_sel:[0,1] op_sel_hi:[1,1]
    v_pk_mul_f32 v[82:83], v[82:83], v[14:15] op_sel:[0,1] op_sel_hi:[1,1]
    v_pk_mul_f32 v[76:77], v[76:77], v[14:15] op_sel:[0,0] op_sel_hi:[1,0]
    v_pk_mul_f32 v[78:79], v[78:79], v[14:15] op_sel:[0,0] op_sel_hi:[1,0]
    v_sub_u16 v88, v60, v52
    v_and_b32 v89, 3, v52
    v_add3_u32 v99, v88, v89, 3
    v_and_b32 v99, -4, v99
    v_max_u32 v99, 4, v99
    v_and_b32 v97, 0xfffc, v52
    v_bfm_b32 v96, v88, v89
    v_add_u32_dpp v91, v99, v99 row_shr:1 row_mask:0xf bank_mask:0xf bound_ctrl:1
    v_mad_u32_u24 v97, v97, 5, v2
    v_cmp_lt_u32 vcc, 16, v99
    v_add_u32_dpp v91, v91, v91 row_shr:2 row_mask:0xf bank_mask:0xf bound_ctrl:1
    v_sub_u32 v98, s38, v99
    v_lshrrev_b64 v[52:53], 16, v[52:53]
    v_add_u32_dpp v91, v91, v91 row_shr:4 row_mask:0xf bank_mask:0xf bound_ctrl:1
    v_lshrrev_b64 v[60:61], 16, v[60:61]
    s_mov_b32 s43, 0
    v_add_u32_dpp v91, v91, v91 row_shr:8 row_mask:0xf bank_mask:0xf bound_ctrl:1
    s_nop 1
    v_add_u32_dpp v91, v91, v91 row_bcast:15 row_mask:0xa bank_mask:0xf
    s_nop 1
    v_add_u32_dpp v91, v91, v91 row_bcast:31 row_mask:0xc bank_mask:0xf
    v_add_u32 v98, v98, v91
    v_readlane_b32 s37, v91, 63
    s_cbranch_vccnz L2_xo9
L2_xp9:
    v_and_b32 v47, 0x0fffffff, v39
    buffer_load_dwordx2 v[34:35], v47, s[8:11], 0 offen
    buffer_load_dwordx3 v[36:38], v47, s[8:11], 0 offen offset:8
    buffer_load_dwordx4 v[120:123], v3, s[16:19], s40 offen offset:3072
    s_waitcnt lgkmcnt(0)
    v_cmpx_ne_u64 vcc, v[74:75], v[70:71]
    s_and_b64 s[82:83], vcc, s[80:81]
    s_cbranch_scc1 L2_c10
L2_d10:
    v_mov_b64 v[84:85], v[70:71]
    v_mov_b32 v7, v95
    v_mov_b64 v[86:87], v[74:75]
    s_mov_b64 exec, -1
    s_or_b64 s[80:81], s[80:81], vcc
    v_cmpx_ne_u64 vcc, v[72:73], v[68:69]
    s_and_b64 s[82:83], vcc, s[80:81]
    s_cbranch_scc1 L2_c11
L2_d11:
    v_mov_b64 v[84:85], v[68:69]
    v_mov_b32 v7, v94
    v_mov_b64 v[86:87], v[72:73]
    s_mov_b64 exec, -1
    s_or_b64 s[80:81], s[80:81], vcc
    ds_read_b64 v[70:71], v93 offset:65408
    s_and_b64 exec, s[84:85], s[80:81]
    v_mfma_f32_4x4x4_16b_bf16 v[76:79], v[12:13], v[84:85], 0
    v_mov_b32 v92, v7
    s_andn2_b64 s[80:81], s[80:81], s[84:85]
    v_mfma_f32_4x4x4_16b_bf16 v[76:79], v[10:11], v[86:87], v[76:79]
    s_mov_b64 exec, -1
    ds_read_b64 v[68:69], v92 offset:65408
    v_and_b32 v46, 0x80000000, v27
    v_lshrrev_b32 v47, 14, v25
    v_bitop3_b32 v47, v47, v5, v46 bitop3:0xea
    ds_read_b64 v[106:107], v47
    v_bitop3_b32 v95, v25, v5, v46 bitop3:0xea
    v_and_b32 v46, 0x40000000, v27
    v_lshrrev_b32 v47, 14, v24
    v_bitop3_b32 v47, v47, v5, v46 bitop3:0xea
    ds_read_b64 v[104:105], v47
    v_bitop3_b32 v94, v24, v5, v46 bitop3:0xea
    s_waitcnt lgkmcnt(2)
    v_mfma_f32_4x4x4_16b_bf16 v[80:83], v[10:11], v[70:71], v[80:83]
    v_mfma_f32_4x4x4_16b_bf16 v[76:79], v[10:11], v[68:69], v[76:79]
    v_perm_b32 v15, v25, v26, s47
    v_bitop3_b32 v46, v25, 0.5, -0.5 bitop3:0xa8
    v_perm_b32 v14, v24, v26, s46
    v_bitop3_b32 v47, v24, 0.5, -0.5 bitop3:0xa8
    v_cvt_pk_bf16_f32 v80, v80, v81
    v_cvt_pk_bf16_f32 v81, v82, v83
    ds_wrxchg_rtn_b64 v[74:75], v93, v[80:81] offset:65408
    v_cvt_pk_bf16_f32 v76, v76, v77
    v_cvt_pk_bf16_f32 v77, v78, v79
    ds_wrxchg_rtn_b64 v[72:73], v92, v[76:77] offset:65408
    s_setprio 1
    s_waitcnt lgkmcnt(2)
    v_mfma_f32_4x4x4_16b_bf16 v[80:83], v[8:9], v[106:107], 0
    v_mfma_f32_4x4x4_16b_bf16 v[76:79], v[8:9], v[104:105], 0
    v_bitop3_b32 v15, v6, v15, v46 bitop3:0xca
    v_bitop3_b32 v14, v6, v14, v47 bitop3:0xca
    s_nop 1
    v_pk_mul_f32 v[80:81], v[80:81], v[14:15] op_sel:[0,1] op_sel_hi:[1,1]
    v_pk_mul_f32 v[82:83], v[82:83], v[14:15] op_sel:[0,1] op_sel_hi:[1,1]
    v_pk_mul_f32 v[76:77], v[76:77], v[14:15] op_sel:[0,0] op_sel_hi:[1,0]
    v_pk_mul_f32 v[78:79], v[78:79], v[14:15] op_sel:[0,0] op_sel_hi:[1,0]
    buffer_load_dwordx4 v[108:111], v3, s[16:19], s40 offen offset:0
    buffer_load_dwordx4 v[112:115], v3, s[16:19], s40 offen offset:1024
    s_waitcnt lgkmcnt(0)
    v_cmpx_ne_u64 vcc, v[74:75], v[70:71]
    s_and_b64 s[82:83], vcc, s[80:81]
    s_cbranch_scc1 L2_c12
L2_d12:
    v_mov_b64 v[84:85], v[70:71]
    v_mov_b32 v7, v93
    v_mov_b64 v[86:87], v[74:75]
    s_mov_b64 exec, -1
    s_or_b64 s[80:81], s[80:81], vcc
    v_cmpx_ne_u64 vcc, v[72:73], v[68:69]
    s_and_b64 s[82:83], vcc, s[80:81]
    s_cbranch_scc1 L2_c13
L2_d13:
    v_mov_b64 v[84:85], v[68:69]
    v_mov_b32 v7, v92
    v_mov_b64 v[86:87], v[72:73]
    s_mov_b64 exec, -1
    s_or_b64 s[80:81], s[80:81], vcc
    ds_read_b64 v[70:71], v95 offset:65408
    ds_read_b64 v[68:69], v94 offset:65408
    s_waitcnt vmcnt(7)
    v_and_b32 v46, 0x20000000, v33
    v_lshrrev_b32 v47, 14, v29
    v_bitop3_b32 v47, v47, v5, v46 bitop3:0xea
    ds_read_b64 v[102:103], v47
    v_bitop3_b32 v93, v29, v5, v46 bitop3:0xea
    v_and_b32 v46, 0x10000000, v33
    v_lshrrev_b32 v47, 14, v28
    v_bitop3_b32 v47, v47, v5, v46 bitop3:0xea
    ds_read_b64 v[100:101], v47
    v_bitop3_b32 v92, v28, v5, v46 bitop3:0xea
    s_waitcnt lgkmcnt(2)
    v_mfma_f32_4x4x4_16b_bf16 v[80:83], v[10:11], v[70:71], v[80:83]
    v_mfma_f32_4x4x4_16b_bf16 v[76:79], v[10:11], v[68:69], v[76:79]
    v_perm_b32 v15, v29, v32, s45
    v_bitop3_b32 v46, v29, 0.5, -0.5 bitop3:0xa8
    v_perm_b32 v14, v28, v32, s44
    v_bitop3_b32 v47, v28, 0.5, -0.5 bitop3:0xa8
    v_cvt_pk_bf16_f32 v80, v80, v81
    v_cvt_pk_bf16_f32 v81, v82, v83
    ds_wrxchg_rtn_b64 v[74:75], v95, v[80:81] offset:65408
    v_cvt_pk_bf16_f32 v76, v76, v77
    v_cvt_pk_bf16_f32 v77, v78, v79
    ds_wrxchg_rtn_b64 v[72:73], v94, v[76:77] offset:65408
    s_waitcnt lgkmcnt(2)
    v_mfma_f32_4x4x4_16b_bf16 v[80:83], v[8:9], v[102:103], 0
    v_mfma_f32_4x4x4_16b_bf16 v[76:79], v[8:9], v[100:101], 0
    v_bitop3_b32 v15, v6, v15, v46 bitop3:0xca
    v_bitop3_b32 v14, v6, v14, v47 bitop3:0xca
    v_cmp_lt_u32 s[84:85], v5, v92
    s_nop 0
    v_pk_mul_f32 v[80:81], v[80:81], v[14:15] op_sel:[0,1] op_sel_hi:[1,1]
    v_pk_mul_f32 v[82:83], v[82:83], v[14:15] op_sel:[0,1] op_sel_hi:[1,1]
    v_pk_mul_f32 v[76:77], v[76:77], v[14:15] op_sel:[0,0] op_sel_hi:[1,0]
    v_pk_mul_f32 v[78:79], v[78:79], v[14:15] op_sel:[0,0] op_sel_hi:[1,0]
    v_and_b32 v47, 0x0fffffff, v40
    v_mov_b32 v21, v40
    buffer_load_dwordx2 v[16:17], v47, s[8:11], 0 offen
    buffer_load_dwordx3 v[18:20], v47, s[8:11], 0 offen offset:8
    s_waitcnt lgkmcnt(0)
    v_cmpx_ne_u64 vcc, v[74:75], v[70:71]
    s_and_b64 s[82:83], vcc, s[80:81]
    s_cbranch_scc1 L2_c14
L2_d14:
    v_mov_b64 v[84:85], v[70:71]
    v_mov_b32 v7, v95
    v_mov_b64 v[86:87], v[74:75]
    s_mov_b64 exec, -1
    s_or_b64 s[80:81], s[80:81], vcc
    v_cmpx_ne_u64 vcc, v[72:73], v[68:69]
    s_and_b64 s[82:83], vcc, s[80:81]
    s_cbranch_scc1 L2_c15
L2_d15:
    v_mov_b64 v[84:85], v[68:69]
    v_mov_b32 v7, v94
    v_mov_b64 v[86:87], v[72:73]
    s_mov_b64 exec, -1
    s_or_b64 s[80:81], s[80:81], vcc
    ds_read_b64 v[70:71], v93 offset:65408
    s_and_b64 exec, s[84:85], s[80:81]
    v_mfma_f32_4x4x4_16b_bf16 v[76:79], v[12:13], v[84:85], 0
    v_mov_b32 v92, v7
    s_andn2_b64 s[80:81], s[80:81], s[84:85]
    v_mfma_f32_4x4x4_16b_bf16 v[76:79], v[10:11], v[86:87], v[76:79]
    s_mov_b64 exec, -1
    ds_read_b64 v[68:69], v92 offset:65408
    v_and_b32 v46, 0x80000000, v33
    v_lshrrev_b32 v47, 14, v31
    v_bitop3_b32 v47, v47, v5, v46 bitop3:0xea
    ds_read_b64 v[106:107], v47
    v_bitop3_b32 v95, v31, v5, v46 bitop3:0xea
    v_and_b32 v46, 0x40000000, v33
    v_lshrrev_b32 v47, 14, v30
    v_bitop3_b32 v47, v47, v5, v46 bitop3:0xea
    ds_read_b64 v[104:105], v47
    v_bitop3_b32 v94, v30, v5, v46 bitop3:0xea
    s_waitcnt lgkmcnt(2)
    v_mfma_f32_4x4x4_16b_bf16 v[80:83], v[10:11], v[70:71], v[80:83]
    v_mfma_f32_4x4x4_16b_bf16 v[76:79], v[10:11], v[68:69], v[76:79]
    v_perm_b32 v15, v31, v32, s47
    v_bitop3_b32 v46, v31, 0.5, -0.5 bitop3:0xa8
    v_perm_b32 v14, v30, v32, s46
    v_bitop3_b32 v47, v30, 0.5, -0.5 bitop3:0xa8
    v_cvt_pk_bf16_f32 v80, v80, v81
    v_cvt_pk_bf16_f32 v81, v82, v83
    ds_wrxchg_rtn_b64 v[74:75], v93, v[80:81] offset:65408
    v_cvt_pk_bf16_f32 v76, v76, v77
    v_cvt_pk_bf16_f32 v77, v78, v79
    ds_wrxchg_rtn_b64 v[72:73], v92, v[76:77] offset:65408
    s_setprio 0
    s_waitcnt lgkmcnt(2)
    v_mfma_f32_4x4x4_16b_bf16 v[80:83], v[8:9], v[106:107], 0
    v_mfma_f32_4x4x4_16b_bf16 v[76:79], v[8:9], v[104:105], 0
    v_bitop3_b32 v15, v6, v15, v46 bitop3:0xca
    v_bitop3_b32 v14, v6, v14, v47 bitop3:0xca
    s_nop 1
    v_pk_mul_f32 v[80:81], v[80:81], v[14:15] op_sel:[0,1] op_sel_hi:[1,1]
    v_pk_mul_f32 v[82:83], v[82:83], v[14:15] op_sel:[0,1] op_sel_hi:[1,1]
    v_pk_mul_f32 v[76:77], v[76:77], v[14:15] op_sel:[0,0] op_sel_hi:[1,0]
    v_pk_mul_f32 v[78:79], v[78:79], v[14:15] op_sel:[0,0] op_sel_hi:[1,0]
    s_add_u32 s40, s40, 0x50000
    s_waitcnt lgkmcnt(0)
    v_cmpx_ne_u64 vcc, v[74:75], v[70:71]
    s_and_b64 s[82:83], vcc, s[80:81]
    s_cbranch_scc1 L2_c16
L2_d16:
    v_mov_b64 v[84:85], v[70:71]
    v_mov_b32 v7, v93
    v_mov_b64 v[86:87], v[74:75]
    s_mov_b64 exec, -1
    s_or_b64 s[80:81], s[80:81], vcc
    v_cmpx_ne_u64 vcc, v[72:73], v[68:69]
    s_and_b64 s[82:83], vcc, s[80:81]
    s_cbranch_scc1 L2_c17
L2_d17:
    v_mov_b64 v[84:85], v[68:69]
    v_mov_b32 v7, v92
    v_mov_b64 v[86:87], v[72:73]
    s_mov_b64 exec, -1
    s_or_b64 s[80:81], s[80:81], vcc
    ds_read_b64 v[70:71], v95 offset:65408
    ds_read_b64 v[68:69], v94 offset:65408
    s_waitcnt vmcnt(5)
    v_and_b32 v46, 0x20000000, v39
    v_lshrrev_b32 v47, 14, v35
    v_bitop3_b32 v47, v47, v5, v46 bitop3:0xea
    ds_read_b64 v[102:103], v47
    v_bitop3_b32 v93, v35, v5, v46 bitop3:0xea
    v_and_b32 v46, 0x10000000, v39
    v_lshrrev_b32 v47, 14, v34
    v_bitop3_b32 v47, v47, v5, v46 bitop3:0xea
    ds_read_b64 v[100:101], v47
    v_bitop3_b32 v92, v34, v5, v46 bitop3:0xea
    v_and_b32 v46, 0x80000000, v39
    v_lshrrev_b32 v47, 14, v37
    v_bitop3_b32 v47, v47, v5, v46 bitop3:0xea
    ds_read_b64 v[106:107], v47
    v_and_b32 v46, 0x40000000, v39
    v_lshrrev_b32 v47, 14, v36
    v_bitop3_b32 v47, v47, v5, v46 bitop3:0xea
    ds_read_b64 v[104:105], v47
    s_waitcnt lgkmcnt(4)
    v_mfma_f32_4x4x4_16b_bf16 v[80:83], v[10:11], v[70:71], v[80:83]
    v_mfma_f32_4x4x4_16b_bf16 v[76:79], v[10:11], v[68:69], v[76:79]
    v_perm_b32 v15, v35, v38, s45
    v_bitop3_b32 v46, v35, 0.5, -0.5 bitop3:0xa8
    v_perm_b32 v14, v34, v38, s44
    v_bitop3_b32 v47, v34, 0.5, -0.5 bitop3:0xa8
    v_cvt_pk_bf16_f32 v80, v80, v81
    v_cvt_pk_bf16_f32 v81, v82, v83
    ds_wrxchg_rtn_b64 v[74:75], v95, v[80:81] offset:65408
    v_cvt_pk_bf16_f32 v76, v76, v77
    v_cvt_pk_bf16_f32 v77, v78, v79
    ds_wrxchg_rtn_b64 v[72:73], v94, v[76:77] offset:65408
    s_waitcnt lgkmcnt(2)
    s_barrier
    s_setprio 3
    s_mov_b32 m0, s69
    s_nop 0
    ds_write_addtid_b32 v116 offset:32768
    ds_write_addtid_b32 v117 offset:33024
    ds_write_addtid_b32 v118 offset:33280
    ds_write_addtid_b32 v119 offset:33536
    buffer_load_dwordx4 v[116:119], v3, s[16:19], s40 offen offset:2048
    s_waitcnt vmcnt(5)
    ds_write_addtid_b32 v120 offset:33792
    ds_write_addtid_b32 v121 offset:34048
    ds_write_addtid_b32 v122 offset:34304
    ds_write_addtid_b32 v123 offset:34560
    buffer_load_dwordx4 v[120:123], v3, s[16:19], s40 offen offset:3072
    v_mfma_f32_4x4x4_16b_bf16 v[80:83], v[8:9], v[102:103], 0
    v_mfma_f32_4x4x4_16b_bf16 v[76:79], v[8:9], v[100:101], 0
    v_bitop3_b32 v15, v6, v15, v46 bitop3:0xca
    v_bitop3_b32 v14, v6, v14, v47 bitop3:0xca
    v_cmp_lt_u32 s[84:85], v5, v92
    s_nop 0
    v_pk_mul_f32 v[80:81], v[80:81], v[14:15] op_sel:[0,1] op_sel_hi:[1,1]
    v_pk_mul_f32 v[82:83], v[82:83], v[14:15] op_sel:[0,1] op_sel_hi:[1,1]
    v_pk_mul_f32 v[76:77], v[76:77], v[14:15] op_sel:[0,0] op_sel_hi:[1,0]
    v_pk_mul_f32 v[78:79], v[78:79], v[14:15] op_sel:[0,0] op_sel_hi:[1,0]
    v_and_b32 v47, 0x0fffffff, v41
    v_mov_b32 v27, v41
    buffer_load_dwordx2 v[22:23], v47, s[8:11], 0 offen
    buffer_load_dwordx3 v[24:26], v47, s[8:11], 0 offen offset:8
    v_mov_b32 v33, v42
    v_mov_b32 v44, v43
    s_cmp_gt_u32 s37, 1024
    s_cbranch_scc1 L2_xs18
    s_cmp_lg_u32 s43, 0
    s_cbranch_scc1 L2_xa18
L2_xb18:
    v_lshlrev_b32 v89, 16, v96
    v_add_u32 v90, 60, v97
    v_bitop3_b32 v90, v89, v45, v90 bitop3:0x6a
    ds_write_b32 v98, v90 offset:12
    v_lshlrev_b32 v89, 20, v96
    v_add_u32 v90, 40, v97
    v_bitop3_b32 v90, v89, v45, v90 bitop3:0x6a
    ds_write_b32 v98, v90 offset:8
    v_lshlrev_b32 v89, 24, v96
    v_add_u32 v90, 20, v97
    v_bitop3_b32 v90, v89, v45, v90 bitop3:0x6a
    ds_write_b32 v98, v90 offset:4
    v_lshlrev_b32 v89, 28, v96
    v_bitop3_b32 v90, v89, v45, v97 bitop3:0x6a
    ds_write_b32 v98, v90 offset:0
    v_mov_b32_dpp v91, v64 quad_perm:[1,1,1,1] row_mask:0xf bank_mask:0xf
    v_and_b32 v89, 3, v91
    v_and_b32 v97, 0xfffc, v91
    v_sub_u16_dpp v88, v64, v91 quad_perm:[3,3,3,3] row_mask:0xf bank_mask:0xf
    v_mad_u32_u24 v97, v97, 5, v4
    v_add_u32 v99, v88, v89
    v_bfm_b32 v96, v88, v89
    v_cmp_lt_u32 s[58:59], 16, v99
    v_lshlrev_b32 v89, v1, v96
    v_and_b32 v89, v45, v89
    v_cmp_ne_u32 vcc, 0, v89
    v_xor_b32 v90, v97, v89
    s_add_u32 s3, s37, s38
    v_mbcnt_lo_u32_b32 v98, vcc_lo, 0
    v_mbcnt_hi_u32_b32 v98, vcc_hi, v98
    s_bcnt1_i32_b64 s41, vcc
    v_lshl_add_u32 v98, v98, 2, s3
    s_mov_b64 exec, vcc
    ds_write_b32 v98, v90
    s_mov_b64 exec, -1
    s_lshl2_add_u32 s37, s41, s37
    s_cmp_lg_u64 s[58:59], 0
    s_cbranch_scc1 L2_xe18
L2_xr18:
    v_add_u32 v98, s37, v0
    v_mov_b32 v90, -1
    ds_write_b32 v98, v90
    ds_read2st64_b32 v[40:41], v0 offset0:0 offset1:1
    ds_read2st64_b32 v[42:43], v0 offset0:2 offset1:3
    s_sub_u32 s3, s37, 768
    s_cmp_gt_u32 s3, 256
    s_cbranch_scc1 L2_xf18
L2_xg18:
    s_setprio 2
    ds_write_addtid_b32 v124 offset:34816
    ds_write_addtid_b32 v125 offset:35072
    ds_write_addtid_b32 v126 offset:35328
    ds_write_addtid_b32 v127 offset:35584
    s_add_u32 s3, s40, 4096
    buffer_load_dwordx4 v[124:127], v3, s[16:19], s3 offen
    s_waitcnt lgkmcnt(14)
    v_cmpx_ne_u64 vcc, v[74:75], v[70:71]
    s_and_b64 s[82:83], vcc, s[80:81]
    s_cbranch_scc1 L2_c19
L2_d19:
    v_mov_b64 v[84:85], v[70:71]
    v_mov_b32 v7, v95
    v_mov_b64 v[86:87], v[74:75]
    s_mov_b64 exec, -1
    s_or_b64 s[80:81], s[80:81], vcc
    v_cmpx_ne_u64 vcc, v[72:73], v[68:69]
    s_and_b64 s[82:83], vcc, s[80:81]
    s_cbranch_scc1 L2_c20
L2_d20:
    v_mov_b64 v[84:85], v[68:69]
    v_mov_b32 v7, v94
    v_mov_b64 v[86:87], v[72:73]
    s_mov_b64 exec, -1
    s_or_b64 s[80:81], s[80:81], vcc
    ds_read_b64 v[70:71], v93 offset:65408
    s_and_b64 exec, s[84:85], s[80:81]
    v_mfma_f32_4x4x4_16b_bf16 v[76:79], v[12:13], v[84:85], 0
    v_mov_b32 v92, v7
    s_andn2_b64 s[80:81], s[80:81], s[84:85]
    v_mfma_f32_4x4x4_16b_bf16 v[76:79], v[10:11], v[86:87], v[76:79]
    s_mov_b64 exec, -1
    ds_read_b64 v[68:69], v92 offset:65408
    s_setprio 1
    s_waitcnt vmcnt(8)
    s_mov_b32 m0, s38
    s_nop 0
    ds_write_addtid_b32 v108 offset:0
    ds_write_addtid_b32 v109 offset:256
    ds_write_addtid_b32 v110 offset:512
    ds_write_addtid_b32 v111 offset:768
    s_waitcnt lgkmcnt(4)
    v_mfma_f32_4x4x4_16b_bf16 v[80:83], v[10:11], v[70:71], v[80:83]
    v_mfma_f32_4x4x4_16b_bf16 v[76:79], v[10:11], v[68:69], v[76:79]
    v_and_b32 v46, 0x40000000, v39
    v_bitop3_b32 v94, v36, v5, v46 bitop3:0xea
    v_and_b32 v46, 0x80000000, v39
    v_bitop3_b32 v95, v37, v5, v46 bitop3:0xea
    v_perm_b32 v15, v37, v38, s47
    v_bitop3_b32 v46, v37, 0.5, -0.5 bitop3:0xa8
    v_perm_b32 v14, v36, v38, s46
    v_bitop3_b32 v47, v36, 0.5, -0.5 bitop3:0xa8
    v_cvt_pk_bf16_f32 v80, v80, v81
    v_cvt_pk_bf16_f32 v81, v82, v83
    ds_wrxchg_rtn_b64 v[74:75], v93, v[80:81] offset:65408
    v_cvt_pk_bf16_f32 v76, v76, v77
    v_cvt_pk_bf16_f32 v77, v78, v79
    ds_wrxchg_rtn_b64 v[72:73], v92, v[76:77] offset:65408
    s_setprio 0
    s_waitcnt vmcnt(7)
    ds_write_addtid_b32 v112 offset:1024
    ds_write_addtid_b32 v113 offset:1280
    ds_write_addtid_b32 v114 offset:1536
    ds_write_addtid_b32 v115 offset:1792
    v_mfma_f32_4x4x4_16b_bf16 v[80:83], v[8:9], v[106:107], 0
    v_mfma_f32_4x4x4_16b_bf16 v[76:79], v[8:9], v[104:105], 0
    v_bitop3_b32 v15, v6, v15, v46 bitop3:0xca
    v_bitop3_b32 v14, v6, v14, v47 bitop3:0xca
    s_nop 1
    v_pk_mul_f32 v[80:81], v[80:81], v[14:15] op_sel:[0,1] op_sel_hi:[1,1]
    v_pk_mul_f32 v[82:83], v[82:83], v[14:15] op_sel:[0,1] op_sel_hi:[1,1]
    v_pk_mul_f32 v[76:77], v[76:77], v[14:15] op_sel:[0,0] op_sel_hi:[1,0]
    v_pk_mul_f32 v[78:79], v[78:79], v[14:15] op_sel:[0,0] op_sel_hi:[1,0]
    s_add_u32 s42, s42, 1
    s_waitcnt lgkmcnt(0)
    s_barrier
    s_bitcmp1_b32 s36, s42
    s_cbranch_scc1 L2_slow
L2_ret1:
    s_setprio 3
    v_and_b32 v47, 0x0fffffff, v33
    buffer_load_dwordx2 v[28:29], v47, s[8:11], 0 offen
    buffer_load_dwordx3 v[30:32], v47, s[8:11], 0 offen offset:8
    v_cmpx_ne_u64 vcc, v[74:75], v[70:71]
    s_and_b64 s[82:83], vcc, s[80:81]
    s_cbranch_scc1 L2_c21
L2_d21:
    v_mov_b64 v[84:85], v[70:71]
    v_mov_b32 v7, v93
    v_mov_b64 v[86:87], v[74:75]
    s_mov_b64 exec, -1
    s_or_b64 s[80:81], s[80:81], vcc
    v_cmpx_ne_u64 vcc, v[72:73], v[68:69]
    s_and_b64 s[82:83], vcc, s[80:81]
    s_cbranch_scc1 L2_c22
L2_d22:
    v_mov_b64 v[84:85], v[68:69]
    v_mov_b32 v7, v92
    v_mov_b64 v[86:87], v[72:73]
    s_mov_b64 exec, -1
    s_or_b64 s[80:81], s[80:81], vcc
    ds_read_b64 v[70:71], v95 offset:65408
    ds_read_b64 v[68:69], v94 offset:65408
    s_waitcnt vmcnt(7)
    v_and_b32 v46, 0x20000000, v21
    v_lshrrev_b32 v47, 14, v17
    v_bitop3_b32 v47, v47, v5, v46 bitop3:0xea
    ds_read_b64 v[102:103], v47
    v_bitop3_b32 v93, v17, v5, v46 bitop3:0xea
    v_and_b32 v46, 0x10000000, v21
    v_lshrrev_b32 v47, 14, v16
    v_bitop3_b32 v47, v47, v5, v46 bitop3:0xea
    ds_read_b64 v[100:101], v47
    v_bitop3_b32 v92, v16, v5, v46 bitop3:0xea
    s_waitcnt lgkmcnt(2)
    v_mfma_f32_4x4x4_16b_bf16 v[80:83], v[10:11], v[70:71], v[80:83]
    v_mfma_f32_4x4x4_16b_bf16 v[76:79], v[10:11], v[68:69], v[76:79]
    v_perm_b32 v15, v17, v20, s45
    v_bitop3_b32 v46, v17, 0.5, -0.5 bitop3:0xa8
    v_perm_b32 v14, v16, v20, s44
    v_bitop3_b32 v47, v16, 0.5, -0.5 bitop3:0xa8
    v_cvt_pk_bf16_f32 v80, v80, v81
    v_cvt_pk_bf16_f32 v81, v82, v83
    ds_wrxchg_rtn_b64 v[74:75], v95, v[80:81] offset:65408
    v_cvt_pk_bf16_f32 v76, v76, v77
    v_cvt_pk_bf16_f32 v77, v78, v79
    ds_wrxchg_rtn_b64 v[72:73], v94, v[76:77] offset:65408
    s_waitcnt lgkmcnt(2)
    v_mfma_f32_4x4x4_16b_bf16 v[80:83], v[8:9], v[102:103], 0
    v_mfma_f32_4x4x4_16b_bf16 v[76:79], v[8:9], v[100:101], 0
    v_bitop3_b32 v15, v6, v15, v46 bitop3:0xca
    v_bitop3_b32 v14, v6, v14, v47 bitop3:0xca
    v_cmp_lt_u32 s[84:85], v5, v92
    s_nop 0
    v_pk_mul_f32 v[80:81], v[80:81], v[14:15] op_sel:[0,1] op_sel_hi:[1,1]
    v_pk_mul_f32 v[82:83], v[82:83], v[14:15] op_sel:[0,1] op_sel_hi:[1,1]
    v_pk_mul_f32 v[76:77], v[76:77], v[14:15] op_sel:[0,0] op_sel_hi:[1,0]
    v_pk_mul_f32 v[78:79], v[78:79], v[14:15] op_sel:[0,0] op_sel_hi:[1,0]
    buffer_load_dwordx4 v[108:111], v3, s[16:19], s40 offen offset:0
    s_waitcnt lgkmcnt(0)
    v_cmpx_ne_u64 vcc, v[74:75], v[70:71]
    s_and_b64 s[82:83], vcc, s[80:81]
    s_cbranch_scc1 L2_c23
L2_d23:
    v_mov_b64 v[84:85], v[70:71]
    v_mov_b32 v7, v95
    v_mov_b64 v[86:87], v[74:75]
    s_mov_b64 exec, -1
    s_or_b64 s[80:81], s[80:81], vcc
    v_cmpx_ne_u64 vcc, v[72:73], v[68:69]
    s_and_b64 s[82:83], vcc, s[80:81]
    s_cbranch_scc1 L2_c24
L2_d24:
    v_mov_b64 v[84:85], v[68:69]
    v_mov_b32 v7, v94
    v_mov_b64 v[86:87], v[72:73]
    s_mov_b64 exec, -1
    s_or_b64 s[80:81], s[80:81], vcc
    ds_read_b64 v[70:71], v93 offset:65408
    s_and_b64 exec, s[84:85], s[80:81]
    v_mfma_f32_4x4x4_16b_bf16 v[76:79], v[12:13], v[84:85], 0
    v_mov_b32 v92, v7
    s_andn2_b64 s[80:81], s[80:81], s[84:85]
    v_mfma_f32_4x4x4_16b_bf16 v[76:79], v[10:11], v[86:87], v[76:79]
    s_mov_b64 exec, -1
    ds_read_b64 v[68:69], v92 offset:65408
    v_and_b32 v46, 0x80000000, v21
    v_lshrrev_b32 v47, 14, v19
    v_bitop3_b32 v47, v47, v5, v46 bitop3:0xea
    ds_read_b64 v[106:107], v47
    v_bitop3_b32 v95, v19, v5, v46 bitop3:0xea
    v_and_b32 v46, 0x40000000, v21
    v_lshrrev_b32 v47, 14, v18
    v_bitop3_b32 v47, v47, v5, v46 bitop3:0xea
    ds_read_b64 v[104:105], v47
    v_bitop3_b32 v94, v18, v5, v46 bitop3:0xea
    s_waitcnt lgkmcnt(2)
    v_mfma_f32_4x4x4_16b_bf16 v[80:83], v[10:11], v[70:71], v[80:83]
    v_mfma_f32_4x4x4_16b_bf16 v[76:79], v[10:11], v[68:69], v[76:79]
    v_perm_b32 v15, v19, v20, s47
    v_bitop3_b32 v46, v19, 0.5, -0.5 bitop3:0xa8
    v_perm_b32 v14, v18, v20, s46
    v_bitop3_b32 v47, v18, 0.5, -0.5 bitop3:0xa8
    v_cvt_pk_bf16_f32 v80, v80, v81
    v_cvt_pk_bf16_f32 v81, v82, v83
    ds_wrxchg_rtn_b64 v[74:75], v93, v[80:81] offset:65408
    v_cvt_pk_bf16_f32 v76, v76, v77
    v_cvt_pk_bf16_f32 v77, v78, v79
    ds_wrxchg_rtn_b64 v[72:73], v92, v[76:77] offset:65408
    s_setprio 2
    s_waitcnt lgkmcnt(2)
    v_mfma_f32_4x4x4_16b_bf16 v[80:83], v[8:9], v[106:107], 0
    v_mfma_f32_4x4x4_16b_bf16 v[76:79], v[8:9], v[104:105], 0
    v_bitop3_b32 v15, v6, v15, v46 bitop3:0xca
    v_bitop3_b32 v14, v6, v14, v47 bitop3:0xca
    s_nop 1
    v_pk_mul_f32 v[80:81], v[80:81], v[14:15] op_sel:[0,1] op_sel_hi:[1,1]
    v_pk_mul_f32 v[82:83], v[82:83], v[14:15] op_sel:[0,1] op_sel_hi:[1,1]
    v_pk_mul_f32 v[76:77], v[76:77], v[14:15] op_sel:[0,0] op_sel_hi:[1,0]
    v_pk_mul_f32 v[78:79], v[78:79], v[14:15] op_sel:[0,0] op_sel_hi:[1,0]
    v_and_b32 v47, 0x0fffffff, v44
    v_mov_b32 v39, v44
    buffer_load_dwordx2 v[34:35], v47, s[8:11], 0 offen
    buffer_load_dwordx3 v[36:38], v47, s[8:11], 0 offen offset:8
    s_waitcnt lgkmcnt(0)
    v_cmpx_ne_u64 vcc, v[74:75], v[70:71]
    s_and_b64 s[82:83], vcc, s[80:81]
    s_cbranch_scc1 L2_c25
L2_d25:
    v_mov_b64 v[84:85], v[70:71]
    v_mov_b32 v7, v93
    v_mov_b64 v[86:87], v[74:75]
    s_mov_b64 exec, -1
    s_or_b64 s[80:81], s[80:81], vcc
    v_cmpx_ne_u64 vcc, v[72:73], v[68:69]
    s_and_b64 s[82:83], vcc, s[80:81]
    s_cbranch_scc1 L2_c26
L2_d26:
    v_mov_b64 v[84:85], v[68:69]
    v_mov_b32 v7, v92
    v_mov_b64 v[86:87], v[72:73]
    s_mov_b64 exec, -1
    s_or_b64 s[80:81], s[80:81], vcc
    ds_read_b64 v[70:71], v95 offset:65408
    ds_read_b64 v[68:69], v94 offset:65408
    s_waitcnt vmcnt(6)
    v_and_b32 v46, 0x20000000, v27
    v_lshrrev_b32 v47, 14, v23
    v_bitop3_b32 v47, v47, v5, v46 bitop3:0xea
    ds_read_b64 v[102:103], v47
    v_bitop3_b32 v93, v23, v5, v46 bitop3:0xea
    v_and_b32 v46, 0x10000000, v27
    v_lshrrev_b32 v47, 14, v22
    v_bitop3_b32 v47, v47, v5, v46 bitop3:0xea
    ds_read_b64 v[100:101], v47
    v_bitop3_b32 v92, v22, v5, v46 bitop3:0xea
    s_waitcnt lgkmcnt(2)
    v_mfma_f32_4x4x4_16b_bf16 v[80:83], v[10:11], v[70:71], v[80:83]
    v_mfma_f32_4x4x4_16b_bf16 v[76:79], v[10:11], v[68:69], v[76:79]
    v_perm_b32 v15, v23, v26, s45
    v_bitop3_b32 v46, v23, 0.5, -0.5 bitop3:0xa8
    v_perm_b32 v14, v22, v26, s44
    v_bitop3_b32 v47, v22, 0.5, -0.5 bitop3:0xa8
    v_cvt_pk_bf16_f32 v80, v80, v81
    v_cvt_pk_bf16_f32 v81, v82, v83
    ds_wrxchg_rtn_b64 v[74:75], v95, v[80:81] offset:65408
    v_cvt_pk_bf16_f32 v76, v76, v77
    v_cvt_pk_bf16_f32 v77, v78, v79
    ds_wrxchg_rtn_b64 v[72:73], v94, v[76:77] offset:65408
    s_waitcnt lgkmcnt(2)
    v_mfma_f32_4x4x4_16b_bf16 v[80:83], v[8:9], v[102:103], 0
    v_mfma_f32_4x4x4_16b_bf16 v[76:79], v[8:9], v[100:101], 0
    v_bitop3_b32 v15, v6, v15, v46 bitop3:0xca
    v_bitop3_b32 v14, v6, v14, v47 bitop3:0xca
    v_cmp_lt_u32 s[84:85], v5, v92
    s_nop 0
    v_pk_mul_f32 v[80:81], v[80:81], v[14:15] op_sel:[0,1] op_sel_hi:[1,1]
    v_pk_mul_f32 v[82:83], v[82:83], v[14:15] op_sel:[0,1] op_sel_hi:[1,1]
    v_pk_mul_f32 v[76:77], v[76:77], v[14:15] op_sel:[0,0] op_sel_hi:[1,0]
    v_pk_mul_f32 v[78:79], v[78:79], v[14:15] op_sel:[0,0] op_sel_hi:[1,0]
    v_sub_u16 v88, v62, v54
    v_and_b32 v89, 3, v54
    v_add3_u32 v99, v88, v89, 3
    v_and_b32 v99, -4, v99
    v_max_u32 v99, 4, v99
    v_and_b32 v97, 0xfffc, v54
    v_bfm_b32 v96, v88, v89
    v_add_u32_dpp v91, v99, v99 row_shr:1 row_mask:0xf bank_mask:0xf bound_ctrl:1
    v_mad_u32_u24 v97, v97, 5, v2
    v_cmp_lt_u32 vcc, 16, v99
    v_add_u32_dpp v91, v91, v91 row_shr:2 row_mask:0xf bank_mask:0xf bound_ctrl:1
    v_sub_u32 v98, s38, v99
    v_lshrrev_b64 v[54:55], 16, v[54:55]
    v_add_u32_dpp v91, v91, v91 row_shr:4 row_mask:0xf bank_mask:0xf bound_ctrl:1
    v_lshrrev_b64 v[62:63], 16, v[62:63]
    s_mov_b32 s43, 0
    v_add_u32_dpp v91, v91, v91 row_shr:8 row_mask:0xf bank_mask:0xf bound_ctrl:1
    s_nop 1
    v_add_u32_dpp v91, v91, v91 row_bcast:15 row_mask:0xa bank_mask:0xf
    s_nop 1
    v_add_u32_dpp v91, v91, v91 row_bcast:31 row_mask:0xc bank_mask:0xf
    v_add_u32 v98, v98, v91
    v_readlane_b32 s37, v91, 63
    s_cbranch_vccnz L2_xo27
L2_xp27:
    buffer_load_dwordx4 v[112:115], v3, s[16:19], s40 offen offset:1024
    v_and_b32 v47, 0x0fffffff, v40
    v_mov_b32 v21, v40
    buffer_load_dwordx2 v[16:17], v47, s[8:11], 0 offen
    buffer_load_dwordx3 v[18:20], v47, s[8:11], 0 offen offset:8
    s_waitcnt lgkmcnt(0)
    v_cmpx_ne_u64 vcc, v[74:75], v[70:71]
    s_and_b64 s[82:83], vcc, s[80:81]
    s_cbranch_scc1 L2_c28
L2_d28:
    v_mov_b64 v[84:85], v[70:71]
    v_mov_b32 v7, v95
    v_mov_b64 v[86:87], v[74:75]
    s_mov_b64 exec, -1
    s_or_b64 s[80:81], s[80:81], vcc
    v_cmpx_ne_u64 vcc, v[72:73], v[68:69]
    s_and_b64 s[82:83], vcc, s[80:81]
    s_cbranch_scc1 L2_c29
L2_d29:
    v_mov_b64 v[84:85], v[68:69]
    v_mov_b32 v7, v94
    v_mov_b64 v[86:87], v[72:73]
    s_mov_b64 exec, -1
    s_or_b64 s[80:81], s[80:81], vcc
    ds_read_b64 v[70:71], v93 offset:65408
    s_and_b64 exec, s[84:85], s[80:81]
    v_mfma_f32_4x4x4_16b_bf16 v[76:79], v[12:13], v[84:85], 0
    v_mov_b32 v92, v7
    s_andn2_b64 s[80:81], s[80:81], s[84:85]
    v_mfma_f32_4x4x4_16b_bf16 v[76:79], v[10:11], v[86:87], v[76:79]
    s_mov_b64 exec, -1
    ds_read_b64 v[68:69], v92 offset:65408
    v_and_b32 v46, 0x80000000, v27
    v_lshrrev_b32 v47, 14, v25
    v_bitop3_b32 v47, v47, v5, v46 bitop3:0xea
    ds_read_b64 v[106:107], v47
    v_bitop3_b32 v95, v25, v5, v46 bitop3:0xea
    v_and_b32 v46, 0x40000000, v27
    v_lshrrev_b32 v47, 14, v24
    v_bitop3_b32 v47, v47, v5, v46 bitop3:0xea
    ds_read_b64 v[104:105], v47
    v_bitop3_b32 v94, v24, v5, v46 bitop3:0xea
    s_waitcnt lgkmcnt(2)
    v_mfma_f32_4x4x4_16b_bf16 v[80:83], v[10:11], v[70:71], v[80:83]
    v_mfma_f32_4x4x4_16b_bf16 v[76:79], v[10:11], v[68:69], v[76:79]
    v_perm_b32 v15, v25, v26, s47
    v_bitop3_b32 v46, v25, 0.5, -0.5 bitop3:0xa8
    v_perm_b32 v14, v24, v26, s46
    v_bitop3_b32 v47, v24, 0.5, -0.5 bitop3:0xa8
    v_cvt_pk_bf16_f32 v80, v80, v81
    v_cvt_pk_bf16_f32 v81, v82, v83
    ds_wrxchg_rtn_b64 v[74:75], v93, v[80:81] offset:65408
    v_cvt_pk_bf16_f32 v76, v76, v77
    v_cvt_pk_bf16_f32 v77, v78, v79
    ds_wrxchg_rtn_b64 v[72:73], v92, v[76:77] offset:65408
    s_setprio 1
    s_waitcnt lgkmcnt(2)
    v_mfma_f32_4x4x4_16b_bf16 v[80:83], v[8:9], v[106:107], 0
    v_mfma_f32_4x4x4_16b_bf16 v[76:79], v[8:9], v[104:105], 0
    v_bitop3_b32 v15, v6, v15, v46 bitop3:0xca
    v_bitop3_b32 v14, v6, v14, v47 bitop3:0xca
    s_nop 1
    v_pk_mul_f32 v[80:81], v[80:81], v[14:15] op_sel:[0,1] op_sel_hi:[1,1]
    v_pk_mul_f32 v[82:83], v[82:83], v[14:15] op_sel:[0,1] op_sel_hi:[1,1]
    v_pk_mul_f32 v[76:77], v[76:77], v[14:15] op_sel:[0,0] op_sel_hi:[1,0]
    v_pk_mul_f32 v[78:79], v[78:79], v[14:15] op_sel:[0,0] op_sel_hi:[1,0]
    s_waitcnt lgkmcnt(0)
    v_cmpx_ne_u64 vcc, v[74:75], v[70:71]
    s_and_b64 s[82:83], vcc, s[80:81]
    s_cbranch_scc1 L2_c30
L2_d30:
    v_mov_b64 v[84:85], v[70:71]
    v_mov_b32 v7, v93
    v_mov_b64 v[86:87], v[74:75]
    s_mov_b64 exec, -1
    s_or_b64 s[80:81], s[80:81], vcc
    v_cmpx_ne_u64 vcc, v[72:73], v[68:69]
    s_and_b64 s[82:83], vcc, s[80:81]
    s_cbranch_scc1 L2_c31
L2_d31:
    v_mov_b64 v[84:85], v[68:69]
    v_mov_b32 v7, v92
    v_mov_b64 v[86:87], v[72:73]
    s_mov_b64 exec, -1
    s_or_b64 s[80:81], s[80:81], vcc
    ds_read_b64 v[70:71], v95 offset:65408
    ds_read_b64 v[68:69], v94 offset:65408
    s_waitcnt vmcnt(6)
    v_and_b32 v46, 0x20000000, v33
    v_lshrrev_b32 v47, 14, v29
    v_bitop3_b32 v47, v47, v5, v46 bitop3:0xea
    ds_read_b64 v[102:103], v47
    v_bitop3_b32 v93, v29, v5, v46 bitop3:0xea
    v_and_b32 v46, 0x10000000, v33
    v_lshrrev_b32 v47, 14, v28
    v_bitop3_b32 v47, v47, v5, v46 bitop3:0xea
    ds_read_b64 v[100:101], v47
    v_bitop3_b32 v92, v28, v5, v46 bitop3:0xea
    s_waitcnt lgkmcnt(2)
    v_mfma_f32_4x4x4_16b_bf16 v[80:83], v[10:11], v[70:71], v[80:83]
    v_mfma_f32_4x4x4_16b_bf16 v[76:79], v[10:11], v[68:69], v[76:79]
    v_perm_b32 v15, v29, v32, s45
    v_bitop3_b32 v46, v29, 0.5, -0.5 bitop3:0xa8
    v_perm_b32 v14, v28, v32, s44
    v_bitop3_b32 v47, v28, 0.5, -0.5 bitop3:0xa8
    v_cvt_pk_bf16_f32 v80, v80, v81
    v_cvt_pk_bf16_f32 v81, v82, v83
    ds_wrxchg_rtn_b64 v[74:75], v95, v[80:81] offset:65408
    v_cvt_pk_bf16_f32 v76, v76, v77
    v_cvt_pk_bf16_f32 v77, v78, v79
    ds_wrxchg_rtn_b64 v[72:73], v94, v[76:77] offset:65408
    s_waitcnt lgkmcnt(2)
    v_mfma_f32_4x4x4_16b_bf16 v[80:83], v[8:9], v[102:103], 0
    v_mfma_f32_4x4x4_16b_bf16 v[76:79], v[8:9], v[100:101], 0
    v_bitop3_b32 v15, v6, v15, v46 bitop3:0xca
    v_bitop3_b32 v14, v6, v14, v47 bitop3:0xca
    v_cmp_lt_u32 s[84:85], v5, v92
    s_nop 0
    v_pk_mul_f32 v[80:81], v[80:81], v[14:15] op_sel:[0,1] op_sel_hi:[1,1]
    v_pk_mul_f32 v[82:83], v[82:83], v[14:15] op_sel:[0,1] op_sel_hi:[1,1]
    v_pk_mul_f32 v[76:77], v[76:77], v[14:15] op_sel:[0,0] op_sel_hi:[1,0]
    v_pk_mul_f32 v[78:79], v[78:79], v[14:15] op_sel:[0,0] op_sel_hi:[1,0]
    v_and_b32 v47, 0x0fffffff, v41
    v_mov_b32 v27, v41
    buffer_load_dwordx2 v[22:23], v47, s[8:11], 0 offen
    buffer_load_dwordx3 v[24:26], v47, s[8:11], 0 offen offset:8
    s_waitcnt lgkmcnt(0)
    v_cmpx_ne_u64 vcc, v[74:75], v[70:71]
    s_and_b64 s[82:83], vcc, s[80:81]
    s_cbranch_scc1 L2_c32
L2_d32:
    v_mov_b64 v[84:85], v[70:71]
    v_mov_b32 v7, v95
    v_mov_b64 v[86:87], v[74:75]
    s_mov_b64 exec, -1
    s_or_b64 s[80:81], s[80:81], vcc
    v_cmpx_ne_u64 vcc, v[72:73], v[68:69]
    s_and_b64 s[82:83], vcc, s[80:81]
    s_cbranch_scc1 L2_c33
L2_d33:
    v_mov_b64 v[84:85], v[68:69]
    v_mov_b32 v7, v94
    v_mov_b64 v[86:87], v[72:73]
    s_mov_b64 exec, -1
    s_or_b64 s[80:81], s[80:81], vcc
    ds_read_b64 v[70:71], v93 offset:65408
    s_and_b64 exec, s[84:85], s[80:81]
    v_mfma_f32_4x4x4_16b_bf16 v[76:79], v[12:13], v[84:85], 0
    v_mov_b32 v92, v7
    s_andn2_b64 s[80:81], s[80:81], s[84:85]
    v_mfma_f32_4x4x4_16b_bf16 v[76:79], v[10:11], v[86:87], v[76:79]
    s_mov_b64 exec, -1
    ds_read_b64 v[68:69], v92 offset:65408
    v_and_b32 v46, 0x80000000, v33
    v_lshrrev_b32 v47, 14, v31
    v_bitop3_b32 v47, v47, v5, v46 bitop3:0xea
    ds_read_b64 v[106:107], v47
    v_bitop3_b32 v95, v31, v5, v46 bitop3:0xea
    v_and_b32 v46, 0x40000000, v33
    v_lshrrev_b32 v47, 14, v30
    v_bitop3_b32 v47, v47, v5, v46 bitop3:0xea
    ds_read_b64 v[104:105], v47
    v_bitop3_b32 v94, v30, v5, v46 bitop3:0xea
    s_waitcnt lgkmcnt(2)
    v_mfma_f32_4x4x4_16b_bf16 v[80:83], v[10:11], v[70:71], v[80:83]
    v_mfma_f32_4x4x4_16b_bf16 v[76:79], v[10:11], v[68:69], v[76:79]
    v_perm_b32 v15, v31, v32, s47
    v_bitop3_b32 v46, v31, 0.5, -0.5 bitop3:0xa8
    v_perm_b32 v14, v30, v32, s46
    v_bitop3_b32 v47, v30, 0.5, -0.5 bitop3:0xa8
    v_cvt_pk_bf16_f32 v80, v80, v81
    v_cvt_pk_bf16_f32 v81, v82, v83
    ds_wrxchg_rtn_b64 v[74:75], v93, v[80:81] offset:65408
    v_cvt_pk_bf16_f32 v76, v76, v77
    v_cvt_pk_bf16_f32 v77, v78, v79
    ds_wrxchg_rtn_b64 v[72:73], v92, v[76:77] offset:65408
    s_setprio 0
    s_waitcnt lgkmcnt(2)
    v_mfma_f32_4x4x4_16b_bf16 v[80:83], v[8:9], v[106:107], 0
    v_mfma_f32_4x4x4_16b_bf16 v[76:79], v[8:9], v[104:105], 0
    v_bitop3_b32 v15, v6, v15, v46 bitop3:0xca
    v_bitop3_b32 v14, v6, v14, v47 bitop3:0xca
    s_nop 1
    v_pk_mul_f32 v[80:81], v[80:81], v[14:15] op_sel:[0,1] op_sel_hi:[1,1]
    v_pk_mul_f32 v[82:83], v[82:83], v[14:15] op_sel:[0,1] op_sel_hi:[1,1]
    v_pk_mul_f32 v[76:77], v[76:77], v[14:15] op_sel:[0,0] op_sel_hi:[1,0]
    v_pk_mul_f32 v[78:79], v[78:79], v[14:15] op_sel:[0,0] op_sel_hi:[1,0]
    s_add_u32 s40, s40, 0x50000
    s_waitcnt lgkmcnt(0)
    v_cmpx_ne_u64 vcc, v[74:75], v[70:71]
    s_and_b64 s[82:83], vcc, s[80:81]
    s_cbranch_scc1 L2_c34
L2_d34:
    v_mov_b64 v[84:85], v[70:71]
    v_mov_b32 v7, v93
    v_mov_b64 v[86:87], v[74:75]
    s_mov_b64 exec, -1
    s_or_b64 s[80:81], s[80:81], vcc
    v_cmpx_ne_u64 vcc, v[72:73], v[68:69]
    s_and_b64 s[82:83], vcc, s[80:81]
    s_cbranch_scc1 L2_c35
L2_d35:
    v_mov_b64 v[84:85], v[68:69]
    v_mov_b32 v7, v92
    v_mov_b64 v[86:87], v[72:73]
    s_mov_b64 exec, -1
    s_or_b64 s[80:81], s[80:81], vcc
    ds_read_b64 v[70:71], v95 offset:65408
    ds_read_b64 v[68:69], v94 offset:65408
    s_waitcnt vmcnt(5)
    v_and_b32 v46, 0x20000000, v39
    v_lshrrev_b32 v47, 14, v35
    v_bitop3_b32 v47, v47, v5, v46 bitop3:0xea
    ds_read_b64 v[102:103], v47
    v_bitop3_b32 v93, v35, v5, v46 bitop3:0xea
    v_and_b32 v46, 0x10000000, v39
    v_lshrrev_b32 v47, 14, v34
    v_bitop3_b32 v47, v47, v5, v46 bitop3:0xea
    ds_read_b64 v[100:101], v47
    v_bitop3_b32 v92, v34, v5, v46 bitop3:0xea
    v_and_b32 v46, 0x80000000, v39
    v_lshrrev_b32 v47, 14, v37
    v_bitop3_b32 v47, v47, v5, v46 bitop3:0xea
    ds_read_b64 v[106:107], v47
    v_and_b32 v46, 0x40000000, v39
    v_lshrrev_b32 v47, 14, v36
    v_bitop3_b32 v47, v47, v5, v46 bitop3:0xea
    ds_read_b64 v[104:105], v47
    s_waitcnt lgkmcnt(4)
    v_mfma_f32_4x4x4_16b_bf16 v[80:83], v[10:11], v[70:71], v[80:83]
    v_mfma_f32_4x4x4_16b_bf16 v[76:79], v[10:11], v[68:69], v[76:79]
    v_perm_b32 v15, v35, v38, s45
    v_bitop3_b32 v46, v35, 0.5, -0.5 bitop3:0xa8
    v_perm_b32 v14, v34, v38, s44
    v_bitop3_b32 v47, v34, 0.5, -0.5 bitop3:0xa8
    v_cvt_pk_bf16_f32 v80, v80, v81
    v_cvt_pk_bf16_f32 v81, v82, v83
    ds_wrxchg_rtn_b64 v[74:75], v95, v[80:81] offset:65408
    v_cvt_pk_bf16_f32 v76, v76, v77
    v_cvt_pk_bf16_f32 v77, v78, v79
    ds_wrxchg_rtn_b64 v[72:73], v94, v[76:77] offset:65408
    s_waitcnt lgkmcnt(2)
    s_barrier
    s_setprio 3
    s_mov_b32 m0, s69
    s_nop 0
    ds_write_addtid_b32 v116 offset:32768
    ds_write_addtid_b32 v117 offset:33024
    ds_write_addtid_b32 v118 offset:33280
    ds_write_addtid_b32 v119 offset:33536
    buffer_load_dwordx4 v[116:119], v3, s[16:19], s40 offen offset:2048
    ds_write_addtid_b32 v120 offset:33792
    ds_write_addtid_b32 v121 offset:34048
    ds_write_addtid_b32 v122 offset:34304
    ds_write_addtid_b32 v123 offset:34560
    buffer_load_dwordx4 v[120:123], v3, s[16:19], s40 offen offset:3072
    v_mfma_f32_4x4x4_16b_bf16 v[80:83], v[8:9], v[102:103], 0
    v_mfma_f32_4x4x4_16b_bf16 v[76:79], v[8:9], v[100:101], 0
    v_bitop3_b32 v15, v6, v15, v46 bitop3:0xca
    v_bitop3_b32 v14, v6, v14, v47 bitop3:0xca
    v_cmp_lt_u32 s[84:85], v5, v92
    s_nop 0
    v_pk_mul_f32 v[80:81], v[80:81], v[14:15] op_sel:[0,1] op_sel_hi:[1,1]
    v_pk_mul_f32 v[82:83], v[82:83], v[14:15] op_sel:[0,1] op_sel_hi:[1,1]
    v_pk_mul_f32 v[76:77], v[76:77], v[14:15] op_sel:[0,0] op_sel_hi:[1,0]
    v_pk_mul_f32 v[78:79], v[78:79], v[14:15] op_sel:[0,0] op_sel_hi:[1,0]
    v_and_b32 v47, 0x0fffffff, v42
    v_mov_b32 v33, v42
    buffer_load_dwordx2 v[28:29], v47, s[8:11], 0 offen
    buffer_load_dwordx3 v[30:32], v47, s[8:11], 0 offen offset:8
    v_mov_b32 v44, v43
    s_cmp_gt_u32 s37, 1024
    s_cbranch_scc1 L2_xs36
    s_cmp_lg_u32 s43, 0
    s_cbranch_scc1 L2_xa36
L2_xb36:
    v_lshlrev_b32 v89, 16, v96
    v_add_u32 v90, 60, v97
    v_bitop3_b32 v90, v89, v45, v90 bitop3:0x6a
    ds_write_b32 v98, v90 offset:12
    v_lshlrev_b32 v89, 20, v96
    v_add_u32 v90, 40, v97
    v_bitop3_b32 v90, v89, v45, v90 bitop3:0x6a
    ds_write_b32 v98, v90 offset:8
    v_lshlrev_b32 v89, 24, v96
    v_add_u32 v90, 20, v97
    v_bitop3_b32 v90, v89, v45, v90 bitop3:0x6a
    ds_write_b32 v98, v90 offset:4
    v_lshlrev_b32 v89, 28, v96
    v_bitop3_b32 v90, v89, v45, v97 bitop3:0x6a
    ds_write_b32 v98, v90 offset:0
    v_mov_b32_dpp v91, v66 quad_perm:[1,1,1,1] row_mask:0xf bank_mask:0xf
    v_and_b32 v89, 3, v91
    v_and_b32 v97, 0xfffc, v91
    v_sub_u16_dpp v88, v66, v91 quad_perm:[3,3,3,3] row_mask:0xf bank_mask:0xf
    v_mad_u32_u24 v97, v97, 5, v4
    v_add_u32 v99, v88, v89
    v_bfm_b32 v96, v88, v89
    v_cmp_lt_u32 s[58:59], 16, v99
    v_lshlrev_b32 v89, v1, v96
    v_and_b32 v89, v45, v89
    v_cmp_ne_u32 vcc, 0, v89
    v_xor_b32 v90, v97, v89
    s_add_u32 s3, s37, s38
    v_mbcnt_lo_u32_b32 v98, vcc_lo, 0
    v_mbcnt_hi_u32_b32 v98, vcc_hi, v98
    s_bcnt1_i32_b64 s41, vcc
    v_lshl_add_u32 v98, v98, 2, s3
    s_mov_b64 exec, vcc
    ds_write_b32 v98, v90
    s_mov_b64 exec, -1
    s_lshl2_add_u32 s37, s41, s37
    s_cmp_lg_u64 s[58:59], 0
    s_cbranch_scc1 L2_xe36
L2_xr36:
    v_add_u32 v98, s37, v0
    v_mov_b32 v90, -1
    ds_write_b32 v98, v90
    ds_read2st64_b32 v[40:41], v0 offset0:0 offset1:1
    ds_read2st64_b32 v[42:43], v0 offset0:2 offset1:3
    s_sub_u32 s3, s37, 768
    s_cmp_gt_u32 s3, 256
    s_cbranch_scc1 L2_xf36
L2_xg36:
    v_lshrrev_b64 v[64:65], 16, v[64:65]
    v_lshrrev_b64 v[66:67], 16, v[66:67]
    s_setprio 2
    ds_write_addtid_b32 v124 offset:34816
    ds_write_addtid_b32 v125 offset:35072
    ds_write_addtid_b32 v126 offset:35328
    ds_write_addtid_b32 v127 offset:35584
    s_add_u32 s3, s40, 4096
    buffer_load_dwordx4 v[124:127], v3, s[16:19], s3 offen
    s_waitcnt lgkmcnt(14)
    v_cmpx_ne_u64 vcc, v[74:75], v[70:71]
    s_and_b64 s[82:83], vcc, s[80:81]
    s_cbranch_scc1 L2_c37
L2_d37:
    v_mov_b64 v[84:85], v[70:71]
    v_mov_b32 v7, v95
    v_mov_b64 v[86:87], v[74:75]
    s_mov_b64 exec, -1
    s_or_b64 s[80:81], s[80:81], vcc
    v_cmpx_ne_u64 vcc, v[72:73], v[68:69]
    s_and_b64 s[82:83], vcc, s[80:81]
    s_cbranch_scc1 L2_c38
L2_d38:
    v_mov_b64 v[84:85], v[68:69]
    v_mov_b32 v7, v94
    v_mov_b64 v[86:87], v[72:73]
    s_mov_b64 exec, -1
    s_or_b64 s[80:81], s[80:81], vcc
    ds_read_b64 v[70:71], v93 offset:65408
    s_and_b64 exec, s[84:85], s[80:81]
    v_mfma_f32_4x4x4_16b_bf16 v[76:79], v[12:13], v[84:85], 0
    v_mov_b32 v92, v7
    s_andn2_b64 s[80:81], s[80:81], s[84:85]
    v_mfma_f32_4x4x4_16b_bf16 v[76:79], v[10:11], v[86:87], v[76:79]
    s_mov_b64 exec, -1
    ds_read_b64 v[68:69], v92 offset:65408
    s_setprio 1
    s_mov_b32 m0, s38
    s_nop 0
    ds_write_addtid_b32 v108 offset:0
    ds_write_addtid_b32 v109 offset:256
    ds_write_addtid_b32 v110 offset:512
    ds_write_addtid_b32 v111 offset:768
    s_waitcnt lgkmcnt(4)
    v_mfma_f32_4x4x4_16b_bf16 v[80:83], v[10:11], v[70:71], v[80:83]
    v_mfma_f32_4x4x4_16b_bf16 v[76:79], v[10:11], v[68:69], v[76:79]
    v_and_b32 v46, 0x40000000, v39
    v_bitop3_b32 v94, v36, v5, v46 bitop3:0xea
    v_and_b32 v46, 0x80000000, v39
    v_bitop3_b32 v95, v37, v5, v46 bitop3:0xea
    v_perm_b32 v15, v37, v38, s47
    v_bitop3_b32 v46, v37, 0.5, -0.5 bitop3:0xa8
    v_perm_b32 v14, v36, v38, s46
    v_bitop3_b32 v47, v36, 0.5, -0.5 bitop3:0xa8
    v_cvt_pk_bf16_f32 v80, v80, v81
    v_cvt_pk_bf16_f32 v81, v82, v83
    ds_wrxchg_rtn_b64 v[74:75], v93, v[80:81] offset:65408
    v_cvt_pk_bf16_f32 v76, v76, v77
    v_cvt_pk_bf16_f32 v77, v78, v79
    ds_wrxchg_rtn_b64 v[72:73], v92, v[76:77] offset:65408
    s_setprio 0
    s_waitcnt vmcnt(9)
    ds_write_addtid_b32 v112 offset:1024
    ds_write_addtid_b32 v113 offset:1280
    ds_write_addtid_b32 v114 offset:1536
    ds_write_addtid_b32 v115 offset:1792
    v_mfma_f32_4x4x4_16b_bf16 v[80:83], v[8:9], v[106:107], 0
    v_mfma_f32_4x4x4_16b_bf16 v[76:79], v[8:9], v[104:105], 0
    v_bitop3_b32 v15, v6, v15, v46 bitop3:0xca
    v_bitop3_b32 v14, v6, v14, v47 bitop3:0xca
    s_nop 1
    v_pk_mul_f32 v[80:81], v[80:81], v[14:15] op_sel:[0,1] op_sel_hi:[1,1]
    v_pk_mul_f32 v[82:83], v[82:83], v[14:15] op_sel:[0,1] op_sel_hi:[1,1]
    v_pk_mul_f32 v[76:77], v[76:77], v[14:15] op_sel:[0,0] op_sel_hi:[1,0]
    v_pk_mul_f32 v[78:79], v[78:79], v[14:15] op_sel:[0,0] op_sel_hi:[1,0]
    s_add_u32 s42, s42, 1
    s_waitcnt lgkmcnt(0)
L2_loop:
    s_barrier
    s_bitcmp1_b32 s36, s42
    s_cbranch_scc1 L2_slow
L2_ret2:
    s_setprio 3
    v_and_b32 v47, 0x0fffffff, v44
    v_mov_b32 v39, v44
    buffer_load_dwordx2 v[34:35], v47, s[8:11], 0 offen
    buffer_load_dwordx3 v[36:38], v47, s[8:11], 0 offen offset:8
    v_cmpx_ne_u64 vcc, v[74:75], v[70:71]
    s_and_b64 s[82:83], vcc, s[80:81]
    s_cbranch_scc1 L2_c39
L2_d39:
    v_mov_b64 v[84:85], v[70:71]
    v_mov_b32 v7, v93
    v_mov_b64 v[86:87], v[74:75]
    s_mov_b64 exec, -1
    s_or_b64 s[80:81], s[80:81], vcc
    v_cmpx_ne_u64 vcc, v[72:73], v[68:69]
    s_and_b64 s[82:83], vcc, s[80:81]
    s_cbranch_scc1 L2_c40
L2_d40:
    v_mov_b64 v[84:85], v[68:69]
    v_mov_b32 v7, v92
    v_mov_b64 v[86:87], v[72:73]
    s_mov_b64 exec, -1
    s_or_b64 s[80:81], s[80:81], vcc
    ds_read_b64 v[70:71], v95 offset:65408
    ds_read_b64 v[68:69], v94 offset:65408
    s_waitcnt vmcnt(9)
    v_and_b32 v46, 0x20000000, v21
    v_lshrrev_b32 v47, 14, v17
    v_bitop3_b32 v47, v47, v5, v46 bitop3:0xea
    ds_read_b64 v[102:103], v47
    v_bitop3_b32 v93, v17, v5, v46 bitop3:0xea
    v_and_b32 v46, 0x10000000, v21
    v_lshrrev_b32 v47, 14, v16
    v_bitop3_b32 v47, v47, v5, v46 bitop3:0xea
    ds_read_b64 v[100:101], v47
    v_bitop3_b32 v92, v16, v5, v46 bitop3:0xea
    s_waitcnt lgkmcnt(2)
    v_mfma_f32_4x4x4_16b_bf16 v[80:83], v[10:11], v[70:71], v[80:83]
    v_mfma_f32_4x4x4_16b_bf16 v[76:79], v[10:11], v[68:69], v[76:79]
    v_perm_b32 v15, v17, v20, s45
    v_bitop3_b32 v46, v17, 0.5, -0.5 bitop3:0xa8
    v_perm_b32 v14, v16, v20, s44
    v_bitop3_b32 v47, v16, 0.5, -0.5 bitop3:0xa8
    v_cvt_pk_bf16_f32 v80, v80, v81
    v_cvt_pk_bf16_f32 v81, v82, v83
    ds_wrxchg_rtn_b64 v[74:75], v95, v[80:81] offset:65408
    v_cvt_pk_bf16_f32 v76, v76, v77
    v_cvt_pk_bf16_f32 v77, v78, v79
    ds_wrxchg_rtn_b64 v[72:73], v94, v[76:77] offset:65408
    s_waitcnt lgkmcnt(2)
    v_mfma_f32_4x4x4_16b_bf16 v[80:83], v[8:9], v[102:103], 0
    v_mfma_f32_4x4x4_16b_bf16 v[76:79], v[8:9], v[100:101], 0
    v_bitop3_b32 v15, v6, v15, v46 bitop3:0xca
    v_bitop3_b32 v14, v6, v14, v47 bitop3:0xca
    v_cmp_lt_u32 s[84:85], v5, v92
    s_nop 0
    v_pk_mul_f32 v[80:81], v[80:81], v[14:15] op_sel:[0,1] op_sel_hi:[1,1]
    v_pk_mul_f32 v[82:83], v[82:83], v[14:15] op_sel:[0,1] op_sel_hi:[1,1]
    v_pk_mul_f32 v[76:77], v[76:77], v[14:15] op_sel:[0,0] op_sel_hi:[1,0]
    v_pk_mul_f32 v[78:79], v[78:79], v[14:15] op_sel:[0,0] op_sel_hi:[1,0]
    buffer_load_dwordx4 v[108:111], v3, s[16:19], s40 offen offset:0
    s_waitcnt lgkmcnt(0)
    v_cmpx_ne_u64 vcc, v[74:75], v[70:71]
    s_and_b64 s[82:83], vcc, s[80:81]
    s_cbranch_scc1 L2_c41
L2_d41:
    v_mov_b64 v[84:85], v[70:71]
    v_mov_b32 v7, v95
    v_mov_b64 v[86:87], v[74:75]
    s_mov_b64 exec, -1
    s_or_b64 s[80:81], s[80:81], vcc
    v_cmpx_ne_u64 vcc, v[72:73], v[68:69]
    s_and_b64 s[82:83], vcc, s[80:81]
    s_cbranch_scc1 L2_c42
L2_d42:
    v_mov_b64 v[84:85], v[68:69]
    v_mov_b32 v7, v94
    v_mov_b64 v[86:87], v[72:73]
    s_mov_b64 exec, -1
    s_or_b64 s[80:81], s[80:81], vcc
    ds_read_b64 v[70:71], v93 offset:65408
    s_and_b64 exec, s[84:85], s[80:81]
    v_mfma_f32_4x4x4_16b_bf16 v[76:79], v[12:13], v[84:85], 0
    v_mov_b32 v92, v7
    s_andn2_b64 s[80:81], s[80:81], s[84:85]
    v_mfma_f32_4x4x4_16b_bf16 v[76:79], v[10:11], v[86:87], v[76:79]
    s_mov_b64 exec, -1
    ds_read_b64 v[68:69], v92 offset:65408
    v_and_b32 v46, 0x80000000, v21
    v_lshrrev_b32 v47, 14, v19
    v_bitop3_b32 v47, v47, v5, v46 bitop3:0xea
    ds_read_b64 v[106:107], v47
    v_bitop3_b32 v95, v19, v5, v46 bitop3:0xea
    v_and_b32 v46, 0x40000000, v21
    v_lshrrev_b32 v47, 14, v18
    v_bitop3_b32 v47, v47, v5, v46 bitop3:0xea
    ds_read_b64 v[104:105], v47
    v_bitop3_b32 v94, v18, v5, v46 bitop3:0xea
    s_waitcnt lgkmcnt(2)
    v_mfma_f32_4x4x4_16b_bf16 v[80:83], v[10:11], v[70:71], v[80:83]
    v_mfma_f32_4x4x4_16b_bf16 v[76:79], v[10:11], v[68:69], v[76:79]
    v_perm_b32 v15, v19, v20, s47
    v_bitop3_b32 v46, v19, 0.5, -0.5 bitop3:0xa8
    v_perm_b32 v14, v18, v20, s46
    v_bitop3_b32 v47, v18, 0.5, -0.5 bitop3:0xa8
    v_cvt_pk_bf16_f32 v80, v80, v81
    v_cvt_pk_bf16_f32 v81, v82, v83
    ds_wrxchg_rtn_b64 v[74:75], v93, v[80:81] offset:65408
    v_cvt_pk_bf16_f32 v76, v76, v77
    v_cvt_pk_bf16_f32 v77, v78, v79
    ds_wrxchg_rtn_b64 v[72:73], v92, v[76:77] offset:65408
    s_setprio 2
    s_waitcnt lgkmcnt(2)
    v_mfma_f32_4x4x4_16b_bf16 v[80:83], v[8:9], v[106:107], 0
    v_mfma_f32_4x4x4_16b_bf16 v[76:79], v[8:9], v[104:105], 0
    v_bitop3_b32 v15, v6, v15, v46 bitop3:0xca
    v_bitop3_b32 v14, v6, v14, v47 bitop3:0xca
    s_nop 1
    v_pk_mul_f32 v[80:81], v[80:81], v[14:15] op_sel:[0,1] op_sel_hi:[1,1]
    v_pk_mul_f32 v[82:83], v[82:83], v[14:15] op_sel:[0,1] op_sel_hi:[1,1]
    v_pk_mul_f32 v[76:77], v[76:77], v[14:15] op_sel:[0,0] op_sel_hi:[1,0]
    v_pk_mul_f32 v[78:79], v[78:79], v[14:15] op_sel:[0,0] op_sel_hi:[1,0]
    v_and_b32 v47, 0x0fffffff, v40
    v_mov_b32 v21, v40
    buffer_load_dwordx2 v[16:17], v47, s[8:11], 0 offen
    buffer_load_dwordx3 v[18:20], v47, s[8:11], 0 offen offset:8
    s_waitcnt lgkmcnt(0)
    v_cmpx_ne_u64 vcc, v[74:75], v[70:71]
    s_and_b64 s[82:83], vcc, s[80:81]
    s_cbranch_scc1 L2_c43
L2_d43:
    v_mov_b64 v[84:85], v[70:71]
    v_mov_b32 v7, v93
    v_mov_b64 v[86:87], v[74:75]
    s_mov_b64 exec, -1
    s_or_b64 s[80:81], s[80:81], vcc
    v_cmpx_ne_u64 vcc, v[72:73], v[68:69]
    s_and_b64 s[82:83], vcc, s[80:81]
    s_cbranch_scc1 L2_c44
L2_d44:
    v_mov_b64 v[84:85], v[68:69]
    v_mov_b32 v7, v92
    v_mov_b64 v[86:87], v[72:73]
    s_mov_b64 exec, -1
    s_or_b64 s[80:81], s[80:81], vcc
    ds_read_b64 v[70:71], v95 offset:65408
    ds_read_b64 v[68:69], v94 offset:65408
    s_waitcnt vmcnt(10)
    v_and_b32 v46, 0x20000000, v27
    v_lshrrev_b32 v47, 14, v23
    v_bitop3_b32 v47, v47, v5, v46 bitop3:0xea
    ds_read_b64 v[102:103], v47
    v_bitop3_b32 v93, v23, v5, v46 bitop3:0xea
    v_and_b32 v46, 0x10000000, v27
    v_lshrrev_b32 v47, 14, v22
    v_bitop3_b32 v47, v47, v5, v46 bitop3:0xea
    ds_read_b64 v[100:101], v47
    v_bitop3_b32 v92, v22, v5, v46 bitop3:0xea
    s_waitcnt lgkmcnt(2)
    v_mfma_f32_4x4x4_16b_bf16 v[80:83], v[10:11], v[70:71], v[80:83]
    v_mfma_f32_4x4x4_16b_bf16 v[76:79], v[10:11], v[68:69], v[76:79]
    v_perm_b32 v15, v23, v26, s45
    v_bitop3_b32 v46, v23, 0.5, -0.5 bitop3:0xa8
    v_perm_b32 v14, v22, v26, s44
    v_bitop3_b32 v47, v22, 0.5, -0.5 bitop3:0xa8
    v_cvt_pk_bf16_f32 v80, v80, v81
    v_cvt_pk_bf16_f32 v81, v82, v83
    ds_wrxchg_rtn_b64 v[74:75], v95, v[80:81] offset:65408
    v_cvt_pk_bf16_f32 v76, v76, v77
    v_cvt_pk_bf16_f32 v77, v78, v79
    ds_wrxchg_rtn_b64 v[72:73], v94, v[76:77] offset:65408
    s_waitcnt lgkmcnt(2)
    v_mfma_f32_4x4x4_16b_bf16 v[80:83], v[8:9], v[102:103], 0
    v_mfma_f32_4x4x4_16b_bf16 v[76:79], v[8:9], v[100:101], 0
    v_bitop3_b32 v15, v6, v15, v46 bitop3:0xca
    v_bitop3_b32 v14, v6, v14, v47 bitop3:0xca
    v_cmp_lt_u32 s[84:85], v5, v92
    s_nop 0
    v_pk_mul_f32 v[80:81], v[80:81], v[14:15] op_sel:[0,1] op_sel_hi:[1,1]
    v_pk_mul_f32 v[82:83], v[82:83], v[14:15] op_sel:[0,1] op_sel_hi:[1,1]
    v_pk_mul_f32 v[76:77], v[76:77], v[14:15] op_sel:[0,0] op_sel_hi:[1,0]
    v_pk_mul_f32 v[78:79], v[78:79], v[14:15] op_sel:[0,0] op_sel_hi:[1,0]
    v_sub_u16 v88, v56, v48
    v_and_b32 v89, 3, v48
    v_add3_u32 v99, v88, v89, 3
    v_and_b32 v99, -4, v99
    v_max_u32 v99, 4, v99
    v_and_b32 v97, 0xfffc, v48
    v_bfm_b32 v96, v88, v89
    v_add_u32_dpp v91, v99, v99 row_shr:1 row_mask:0xf bank_mask:0xf bound_ctrl:1
    v_mad_u32_u24 v97, v97, 5, v2
    v_cmp_lt_u32 vcc, 16, v99
    v_add_u32_dpp v91, v91, v91 row_shr:2 row_mask:0xf bank_mask:0xf bound_ctrl:1
    v_sub_u32 v98, s38, v99
    v_lshrrev_b64 v[48:49], 16, v[48:49]
    v_add_u32_dpp v91, v91, v91 row_shr:4 row_mask:0xf bank_mask:0xf bound_ctrl:1
    v_lshrrev_b64 v[56:57], 16, v[56:57]
    s_mov_b32 s43, 0
    v_add_u32_dpp v91, v91, v91 row_shr:8 row_mask:0xf bank_mask:0xf bound_ctrl:1
    s_nop 1
    v_add_u32_dpp v91, v91, v91 row_bcast:15 row_mask:0xa bank_mask:0xf
    s_nop 1
    v_add_u32_dpp v91, v91, v91 row_bcast:31 row_mask:0xc bank_mask:0xf
    v_add_u32 v98, v98, v91
    v_readlane_b32 s37, v91, 63
    s_cbranch_vccnz L2_xo45
L2_xp45:
    buffer_load_dwordx4 v[112:115], v3, s[16:19], s40 offen offset:1024
    s_waitcnt lgkmcnt(0)
    v_cmpx_ne_u64 vcc, v[74:75], v[70:71]
    s_and_b64 s[82:83], vcc, s[80:81]
    s_cbranch_scc1 L2_c46
L2_d46:
    v_mov_b64 v[84:85], v[70:71]
    v_mov_b32 v7, v95
    v_mov_b64 v[86:87], v[74:75]
    s_mov_b64 exec, -1
    s_or_b64 s[80:81], s[80:81], vcc
    v_cmpx_ne_u64 vcc, v[72:73], v[68:69]
    s_and_b64 s[82:83], vcc, s[80:81]
    s_cbranch_scc1 L2_c47
L2_d47:
    v_mov_b64 v[84:85], v[68:69]
    v_mov_b32 v7, v94
    v_mov_b64 v[86:87], v[72:73]
    s_mov_b64 exec, -1
    s_or_b64 s[80:81], s[80:81], vcc
    ds_read_b64 v[70:71], v93 offset:65408
    s_and_b64 exec, s[84:85], s[80:81]
    v_mfma_f32_4x4x4_16b_bf16 v[76:79], v[12:13], v[84:85], 0
    v_mov_b32 v92, v7
    s_andn2_b64 s[80:81], s[80:81], s[84:85]
    v_mfma_f32_4x4x4_16b_bf16 v[76:79], v[10:11], v[86:87], v[76:79]
    s_mov_b64 exec, -1
    ds_read_b64 v[68:69], v92 offset:65408
    v_and_b32 v46, 0x80000000, v27
    v_lshrrev_b32 v47, 14, v25
    v_bitop3_b32 v47, v47, v5, v46 bitop3:0xea
    ds_read_b64 v[106:107], v47
    v_bitop3_b32 v95, v25, v5, v46 bitop3:0xea
    v_and_b32 v46, 0x40000000, v27
    v_lshrrev_b32 v47, 14, v24
    v_bitop3_b32 v47, v47, v5, v46 bitop3:0xea
    ds_read_b64 v[104:105], v47
    v_bitop3_b32 v94, v24, v5, v46 bitop3:0xea
    s_waitcnt lgkmcnt(2)
    v_mfma_f32_4x4x4_16b_bf16 v[80:83], v[10:11], v[70:71], v[80:83]
    v_mfma_f32_4x4x4_16b_bf16 v[76:79], v[10:11], v[68:69], v[76:79]
    v_perm_b32 v15, v25, v26, s47
    v_bitop3_b32 v46, v25, 0.5, -0.5 bitop3:0xa8
    v_perm_b32 v14, v24, v26, s46
    v_bitop3_b32 v47, v24, 0.5, -0.5 bitop3:0xa8
    v_cvt_pk_bf16_f32 v80, v80, v81
    v_cvt_pk_bf16_f32 v81, v82, v83
    ds_wrxchg_rtn_b64 v[74:75], v93, v[80:81] offset:65408
    v_cvt_pk_bf16_f32 v76, v76, v77
    v_cvt_pk_bf16_f32 v77, v78, v79
    ds_wrxchg_rtn_b64 v[72:73], v92, v[76:77] offset:65408
    s_setprio 1
    s_waitcnt lgkmcnt(2)
    v_mfma_f32_4x4x4_16b_bf16 v[80:83], v[8:9], v[106:107], 0
    v_mfma_f32_4x4x4_16b_bf16 v[76:79], v[8:9], v[104:105], 0
    v_bitop3_b32 v15, v6, v15, v46 bitop3:0xca
    v_bitop3_b32 v14, v6, v14, v47 bitop3:0xca
    s_nop 1
    v_pk_mul_f32 v[80:81], v[80:81], v[14:15] op_sel:[0,1] op_sel_hi:[1,1]
    v_pk_mul_f32 v[82:83], v[82:83], v[14:15] op_sel:[0,1] op_sel_hi:[1,1]
    v_pk_mul_f32 v[76:77], v[76:77], v[14:15] op_sel:[0,0] op_sel_hi:[1,0]
    v_pk_mul_f32 v[78:79], v[78:79], v[14:15] op_sel:[0,0] op_sel_hi:[1,0]
    v_and_b32 v47, 0x0fffffff, v41
    v_mov_b32 v27, v41
    buffer_load_dwordx2 v[22:23], v47, s[8:11], 0 offen
    buffer_load_dwordx3 v[24:26], v47, s[8:11], 0 offen offset:8
    s_waitcnt lgkmcnt(0)
    v_cmpx_ne_u64 vcc, v[74:75], v[70:71]
    s_and_b64 s[82:83], vcc, s[80:81]
    s_cbranch_scc1 L2_c48
L2_d48:
    v_mov_b64 v[84:85], v[70:71]
    v_mov_b32 v7, v93
    v_mov_b64 v[86:87], v[74:75]
    s_mov_b64 exec, -1
    s_or_b64 s[80:81], s[80:81], vcc
    v_cmpx_ne_u64 vcc, v[72:73], v[68:69]
    s_and_b64 s[82:83], vcc, s[80:81]
    s_cbranch_scc1 L2_c49
L2_d49:
    v_mov_b64 v[84:85], v[68:69]
    v_mov_b32 v7, v92
    v_mov_b64 v[86:87], v[72:73]
    s_mov_b64 exec, -1
    s_or_b64 s[80:81], s[80:81], vcc
    ds_read_b64 v[70:71], v95 offset:65408
    ds_read_b64 v[68:69], v94 offset:65408
    s_waitcnt vmcnt(9)
    v_and_b32 v46, 0x20000000, v33
    v_lshrrev_b32 v47, 14, v29
    v_bitop3_b32 v47, v47, v5, v46 bitop3:0xea
    ds_read_b64 v[102:103], v47
    v_bitop3_b32 v93, v29, v5, v46 bitop3:0xea
    v_and_b32 v46, 0x10000000, v33
    v_lshrrev_b32 v47, 14, v28
    v_bitop3_b32 v47, v47, v5, v46 bitop3:0xea
    ds_read_b64 v[100:101], v47
    v_bitop3_b32 v92, v28, v5, v46 bitop3:0xea
    s_waitcnt lgkmcnt(2)
    v_mfma_f32_4x4x4_16b_bf16 v[80:83], v[10:11], v[70:71], v[80:83]
    v_mfma_f32_4x4x4_16b_bf16 v[76:79], v[10:11], v[68:69], v[76:79]
    v_perm_b32 v15, v29, v32, s45
    v_bitop3_b32 v46, v29, 0.5, -0.5 bitop3:0xa8
    v_perm_b32 v14, v28, v32, s44
    v_bitop3_b32 v47, v28, 0.5, -0.5 bitop3:0xa8
    v_cvt_pk_bf16_f32 v80, v80, v81
    v_cvt_pk_bf16_f32 v81, v82, v83
    ds_wrxchg_rtn_b64 v[74:75], v95, v[80:81] offset:65408
    v_cvt_pk_bf16_f32 v76, v76, v77
    v_cvt_pk_bf16_f32 v77, v78, v79
    ds_wrxchg_rtn_b64 v[72:73], v94, v[76:77] offset:65408
    s_waitcnt lgkmcnt(2)
    v_mfma_f32_4x4x4_16b_bf16 v[80:83], v[8:9], v[102:103], 0
    v_mfma_f32_4x4x4_16b_bf16 v[76:79], v[8:9], v[100:101], 0
    v_bitop3_b32 v15, v6, v15, v46 bitop3:0xca
    v_bitop3_b32 v14, v6, v14, v47 bitop3:0xca
    v_cmp_lt_u32 s[84:85], v5, v92
    s_nop 0
    v_pk_mul_f32 v[80:81], v[80:81], v[14:15] op_sel:[0,1] op_sel_hi:[1,1]
    v_pk_mul_f32 v[82:83], v[82:83], v[14:15] op_sel:[0,1] op_sel_hi:[1,1]
    v_pk_mul_f32 v[76:77], v[76:77], v[14:15] op_sel:[0,0] op_sel_hi:[1,0]
    v_pk_mul_f32 v[78:79], v[78:79], v[14:15] op_sel:[0,0] op_sel_hi:[1,0]
    s_waitcnt lgkmcnt(0)
    v_cmpx_ne_u64 vcc, v[74:75], v[70:71]
    s_and_b64 s[82:83], vcc, s[80:81]
    s_cbranch_scc1 L2_c50
L2_d50:
    v_mov_b64 v[84:85], v[70:71]
    v_mov_b32 v7, v95
    v_mov_b64 v[86:87], v[74:75]
    s_mov_b64 exec, -1
    s_or_b64 s[80:81], s[80:81], vcc
    v_cmpx_ne_u64 vcc, v[72:73], v[68:69]
    s_and_b64 s[82:83], vcc, s[80:81]
    s_cbranch_scc1 L2_c51
L2_d51:
    v_mov_b64 v[84:85], v[68:69]
    v_mov_b32 v7, v94
    v_mov_b64 v[86:87], v[72:73]
    s_mov_b64 exec, -1
    s_or_b64 s[80:81], s[80:81], vcc
    ds_read_b64 v[70:71], v93 offset:65408
    s_and_b64 exec, s[84:85], s[80:81]
    v_mfma_f32_4x4x4_16b_bf16 v[76:79], v[12:13], v[84:85], 0
    v_mov_b32 v92, v7
    s_andn2_b64 s[80:81], s[80:81], s[84:85]
    v_mfma_f32_4x4x4_16b_bf16 v[76:79], v[10:11], v[86:87], v[76:79]
    s_mov_b64 exec, -1
    ds_read_b64 v[68:69], v92 offset:65408
    v_and_b32 v46, 0x80000000, v33
    v_lshrrev_b32 v47, 14, v31
    v_bitop3_b32 v47, v47, v5, v46 bitop3:0xea
    ds_read_b64 v[106:107], v47
    v_bitop3_b32 v95, v31, v5, v46 bitop3:0xea
    v_and_b32 v46, 0x40000000, v33
    v_lshrrev_b32 v47, 14, v30
    v_bitop3_b32 v47, v47, v5, v46 bitop3:0xea
    ds_read_b64 v[104:105], v47
    v_bitop3_b32 v94, v30, v5, v46 bitop3:0xea
    s_waitcnt lgkmcnt(2)
    v_mfma_f32_4x4x4_16b_bf16 v[80:83], v[10:11], v[70:71], v[80:83]
    v_mfma_f32_4x4x4_16b_bf16 v[76:79], v[10:11], v[68:69], v[76:79]
    v_perm_b32 v15, v31, v32, s47
    v_bitop3_b32 v46, v31, 0.5, -0.5 bitop3:0xa8
    v_perm_b32 v14, v30, v32, s46
    v_bitop3_b32 v47, v30, 0.5, -0.5 bitop3:0xa8
    v_cvt_pk_bf16_f32 v80, v80, v81
    v_cvt_pk_bf16_f32 v81, v82, v83
    ds_wrxchg_rtn_b64 v[74:75], v93, v[80:81] offset:65408
    v_cvt_pk_bf16_f32 v76, v76, v77
    v_cvt_pk_bf16_f32 v77, v78, v79
    ds_wrxchg_rtn_b64 v[72:73], v92, v[76:77] offset:65408
    s_setprio 0
    s_waitcnt lgkmcnt(2)
    v_mfma_f32_4x4x4_16b_bf16 v[80:83], v[8:9], v[106:107], 0
    v_mfma_f32_4x4x4_16b_bf16 v[76:79], v[8:9], v[104:105], 0
    v_bitop3_b32 v15, v6, v15, v46 bitop3:0xca
    v_bitop3_b32 v14, v6, v14, v47 bitop3:0xca
    s_nop 1
    v_pk_mul_f32 v[80:81], v[80:81], v[14:15] op_sel:[0,1] op_sel_hi:[1,1]
    v_pk_mul_f32 v[82:83], v[82:83], v[14:15] op_sel:[0,1] op_sel_hi:[1,1]
    v_pk_mul_f32 v[76:77], v[76:77], v[14:15] op_sel:[0,0] op_sel_hi:[1,0]
    v_pk_mul_f32 v[78:79], v[78:79], v[14:15] op_sel:[0,0] op_sel_hi:[1,0]
    s_add_u32 s40, s40, 0xfff24000
    v_and_b32 v47, 0x0fffffff, v42
    v_mov_b32 v33, v42
    buffer_load_dwordx2 v[28:29], v47, s[8:11], 0 offen
    buffer_load_dwordx3 v[30:32], v47, s[8:11], 0 offen offset:8
    s_waitcnt lgkmcnt(0)
    v_cmpx_ne_u64 vcc, v[74:75], v[70:71]
    s_and_b64 s[82:83], vcc, s[80:81]
    s_cbranch_scc1 L2_c52
L2_d52:
    v_mov_b64 v[84:85], v[70:71]
    v_mov_b32 v7, v93
    v_mov_b64 v[86:87], v[74:75]
    s_mov_b64 exec, -1
    s_or_b64 s[80:81], s[80:81], vcc
    v_cmpx_ne_u64 vcc, v[72:73], v[68:69]
    s_and_b64 s[82:83], vcc, s[80:81]
    s_cbranch_scc1 L2_c53
L2_d53:
    v_mov_b64 v[84:85], v[68:69]
    v_mov_b32 v7, v92
    v_mov_b64 v[86:87], v[72:73]
    s_mov_b64 exec, -1
    s_or_b64 s[80:81], s[80:81], vcc
    ds_read_b64 v[70:71], v95 offset:65408
    ds_read_b64 v[68:69], v94 offset:65408
    s_waitcnt vmcnt(8)
    v_and_b32 v46, 0x20000000, v39
    v_lshrrev_b32 v47, 14, v35
    v_bitop3_b32 v47, v47, v5, v46 bitop3:0xea
    ds_read_b64 v[102:103], v47
    v_bitop3_b32 v93, v35, v5, v46 bitop3:0xea
    v_and_b32 v46, 0x10000000, v39
    v_lshrrev_b32 v47, 14, v34
    v_bitop3_b32 v47, v47, v5, v46 bitop3:0xea
    ds_read_b64 v[100:101], v47
    v_bitop3_b32 v92, v34, v5, v46 bitop3:0xea
    v_and_b32 v46, 0x80000000, v39
    v_lshrrev_b32 v47, 14, v37
    v_bitop3_b32 v47, v47, v5, v46 bitop3:0xea
    ds_read_b64 v[106:107], v47
    v_and_b32 v46, 0x40000000, v39
    v_lshrrev_b32 v47, 14, v36
    v_bitop3_b32 v47, v47, v5, v46 bitop3:0xea
    ds_read_b64 v[104:105], v47
    s_waitcnt lgkmcnt(4)
    v_mfma_f32_4x4x4_16b_bf16 v[80:83], v[10:11], v[70:71], v[80:83]
    v_mfma_f32_4x4x4_16b_bf16 v[76:79], v[10:11], v[68:69], v[76:79]
    v_perm_b32 v15, v35, v38, s45
    v_bitop3_b32 v46, v35, 0.5, -0.5 bitop3:0xa8
    v_perm_b32 v14, v34, v38, s44
    v_bitop3_b32 v47, v34, 0.5, -0.5 bitop3:0xa8
    v_cvt_pk_bf16_f32 v80, v80, v81
    v_cvt_pk_bf16_f32 v81, v82, v83
    ds_wrxchg_rtn_b64 v[74:75], v95, v[80:81] offset:65408
    v_cvt_pk_bf16_f32 v76, v76, v77
    v_cvt_pk_bf16_f32 v77, v78, v79
    ds_wrxchg_rtn_b64 v[72:73], v94, v[76:77] offset:65408
    s_waitcnt lgkmcnt(2)
    s_barrier
    s_setprio 3
    s_mov_b32 m0, s69
    s_nop 0
    ds_write_addtid_b32 v116 offset:32768
    ds_write_addtid_b32 v117 offset:33024
    ds_write_addtid_b32 v118 offset:33280
    ds_write_addtid_b32 v119 offset:33536
    buffer_load_dwordx4 v[116:119], v3, s[16:19], s40 offen offset:2048
    ds_write_addtid_b32 v120 offset:33792
    ds_write_addtid_b32 v121 offset:34048
    ds_write_addtid_b32 v122 offset:34304
    ds_write_addtid_b32 v123 offset:34560
    buffer_load_dwordx4 v[120:123], v3, s[16:19], s40 offen offset:3072
    v_mfma_f32_4x4x4_16b_bf16 v[80:83], v[8:9], v[102:103], 0
    v_mfma_f32_4x4x4_16b_bf16 v[76:79], v[8:9], v[100:101], 0
    v_bitop3_b32 v15, v6, v15, v46 bitop3:0xca
    v_bitop3_b32 v14, v6, v14, v47 bitop3:0xca
    v_cmp_lt_u32 s[84:85], v5, v92
    s_nop 0
    v_pk_mul_f32 v[80:81], v[80:81], v[14:15] op_sel:[0,1] op_sel_hi:[1,1]
    v_pk_mul_f32 v[82:83], v[82:83], v[14:15] op_sel:[0,1] op_sel_hi:[1,1]
    v_pk_mul_f32 v[76:77], v[76:77], v[14:15] op_sel:[0,0] op_sel_hi:[1,0]
    v_pk_mul_f32 v[78:79], v[78:79], v[14:15] op_sel:[0,0] op_sel_hi:[1,0]
    v_mov_b32 v44, v43
    s_cmp_gt_u32 s37, 1024
    s_cbranch_scc1 L2_xs54
    s_cmp_lg_u32 s43, 0
    s_cbranch_scc1 L2_xa54
L2_xb54:
    v_lshlrev_b32 v89, 16, v96
    v_add_u32 v90, 60, v97
    v_bitop3_b32 v90, v89, v45, v90 bitop3:0x6a
    ds_write_b32 v98, v90 offset:12
    v_lshlrev_b32 v89, 20, v96
    v_add_u32 v90, 40, v97
    v_bitop3_b32 v90, v89, v45, v90 bitop3:0x6a
    ds_write_b32 v98, v90 offset:8
    v_lshlrev_b32 v89, 24, v96
    v_add_u32 v90, 20, v97
    v_bitop3_b32 v90, v89, v45, v90 bitop3:0x6a
    ds_write_b32 v98, v90 offset:4
    v_lshlrev_b32 v89, 28, v96
    v_bitop3_b32 v90, v89, v45, v97 bitop3:0x6a
    ds_write_b32 v98, v90 offset:0
    v_mov_b32_dpp v91, v64 quad_perm:[0,0,0,0] row_mask:0xf bank_mask:0xf
    v_and_b32 v89, 3, v91
    v_and_b32 v97, 0xfffc, v91
    v_sub_u16_dpp v88, v64, v91 quad_perm:[2,2,2,2] row_mask:0xf bank_mask:0xf
    v_mad_u32_u24 v97, v97, 5, v4
    v_add_u32 v99, v88, v89
    v_bfm_b32 v96, v88, v89
    v_cmp_lt_u32 s[58:59], 16, v99
    v_lshlrev_b32 v89, v1, v96
    v_and_b32 v89, v45, v89
    v_cmp_ne_u32 vcc, 0, v89
    v_xor_b32 v90, v97, v89
    s_add_u32 s3, s37, s38
    v_mbcnt_lo_u32_b32 v98, vcc_lo, 0
    v_mbcnt_hi_u32_b32 v98, vcc_hi, v98
    s_bcnt1_i32_b64 s41, vcc
    v_lshl_add_u32 v98, v98, 2, s3
    s_mov_b64 exec, vcc
    ds_write_b32 v98, v90
    s_mov_b64 exec, -1
    s_lshl2_add_u32 s37, s41, s37
    s_cmp_lg_u64 s[58:59], 0
    s_cbranch_scc1 L2_xe54
L2_xr54:
    v_add_u32 v98, s37, v0
    v_mov_b32 v90, -1
    ds_write_b32 v98, v90
    ds_read2st64_b32 v[40:41], v0 offset0:0 offset1:1
    ds_read2st64_b32 v[42:43], v0 offset0:2 offset1:3
    s_sub_u32 s3, s37, 768
    s_cmp_gt_u32 s3, 256
    s_cbranch_scc1 L2_xf54
L2_xg54:
    s_setprio 2
    ds_write_addtid_b32 v124 offset:34816
    ds_write_addtid_b32 v125 offset:35072
    ds_write_addtid_b32 v126 offset:35328
    ds_write_addtid_b32 v127 offset:35584
    s_add_u32 s3, s40, 4096
    buffer_load_dwordx4 v[124:127], v3, s[16:19], s3 offen
    s_waitcnt lgkmcnt(14)
    v_cmpx_ne_u64 vcc, v[74:75], v[70:71]
    s_and_b64 s[82:83], vcc, s[80:81]
    s_cbranch_scc1 L2_c55
L2_d55:
    v_mov_b64 v[84:85], v[70:71]
    v_mov_b32 v7, v95
    v_mov_b64 v[86:87], v[74:75]
    s_mov_b64 exec, -1
    s_or_b64 s[80:81], s[80:81], vcc
    v_cmpx_ne_u64 vcc, v[72:73], v[68:69]
    s_and_b64 s[82:83], vcc, s[80:81]
    s_cbranch_scc1 L2_c56
L2_d56:
    v_mov_b64 v[84:85], v[68:69]
    v_mov_b32 v7, v94
    v_mov_b64 v[86:87], v[72:73]
    s_mov_b64 exec, -1
    s_or_b64 s[80:81], s[80:81], vcc
    ds_read_b64 v[70:71], v93 offset:65408
    s_and_b64 exec, s[84:85], s[80:81]
    v_mfma_f32_4x4x4_16b_bf16 v[76:79], v[12:13], v[84:85], 0
    v_mov_b32 v92, v7
    s_andn2_b64 s[80:81], s[80:81], s[84:85]
    v_mfma_f32_4x4x4_16b_bf16 v[76:79], v[10:11], v[86:87], v[76:79]
    s_mov_b64 exec, -1
    ds_read_b64 v[68:69], v92 offset:65408
    s_setprio 1
    s_waitcnt vmcnt(10)
    s_mov_b32 m0, s38
    s_nop 0
    ds_write_addtid_b32 v108 offset:0
    ds_write_addtid_b32 v109 offset:256
    ds_write_addtid_b32 v110 offset:512
    ds_write_addtid_b32 v111 offset:768
    s_waitcnt lgkmcnt(4)
    v_mfma_f32_4x4x4_16b_bf16 v[80:83], v[10:11], v[70:71], v[80:83]
    v_mfma_f32_4x4x4_16b_bf16 v[76:79], v[10:11], v[68:69], v[76:79]
    v_and_b32 v46, 0x40000000, v39
    v_bitop3_b32 v94, v36, v5, v46 bitop3:0xea
    v_and_b32 v46, 0x80000000, v39
    v_bitop3_b32 v95, v37, v5, v46 bitop3:0xea
    v_perm_b32 v15, v37, v38, s47
    v_bitop3_b32 v46, v37, 0.5, -0.5 bitop3:0xa8
    v_perm_b32 v14, v36, v38, s46
    v_bitop3_b32 v47, v36, 0.5, -0.5 bitop3:0xa8
    v_cvt_pk_bf16_f32 v80, v80, v81
    v_cvt_pk_bf16_f32 v81, v82, v83
    ds_wrxchg_rtn_b64 v[74:75], v93, v[80:81] offset:65408
    v_cvt_pk_bf16_f32 v76, v76, v77
    v_cvt_pk_bf16_f32 v77, v78, v79
    ds_wrxchg_rtn_b64 v[72:73], v92, v[76:77] offset:65408
    s_setprio 0
    s_waitcnt vmcnt(7)
    ds_write_addtid_b32 v112 offset:1024
    ds_write_addtid_b32 v113 offset:1280
    ds_write_addtid_b32 v114 offset:1536
    ds_write_addtid_b32 v115 offset:1792
    v_mfma_f32_4x4x4_16b_bf16 v[80:83], v[8:9], v[106:107], 0
    v_mfma_f32_4x4x4_16b_bf16 v[76:79], v[8:9], v[104:105], 0
    v_bitop3_b32 v15, v6, v15, v46 bitop3:0xca
    v_bitop3_b32 v14, v6, v14, v47 bitop3:0xca
    s_nop 1
    v_pk_mul_f32 v[80:81], v[80:81], v[14:15] op_sel:[0,1] op_sel_hi:[1,1]
    v_pk_mul_f32 v[82:83], v[82:83], v[14:15] op_sel:[0,1] op_sel_hi:[1,1]
    v_pk_mul_f32 v[76:77], v[76:77], v[14:15] op_sel:[0,0] op_sel_hi:[1,0]
    v_pk_mul_f32 v[78:79], v[78:79], v[14:15] op_sel:[0,0] op_sel_hi:[1,0]
    s_add_u32 s42, s42, 1
    s_waitcnt lgkmcnt(0)
    s_barrier
    s_bitcmp1_b32 s36, s42
    s_cbranch_scc1 L2_slow
L2_ret3:
    s_setprio 3
    v_and_b32 v47, 0x0fffffff, v44
    v_mov_b32 v39, v44
    buffer_load_dwordx2 v[34:35], v47, s[8:11], 0 offen
    buffer_load_dwordx3 v[36:38], v47, s[8:11], 0 offen offset:8
    v_cmpx_ne_u64 vcc, v[74:75], v[70:71]
    s_and_b64 s[82:83], vcc, s[80:81]
    s_cbranch_scc1 L2_c57
L2_d57:
    v_mov_b64 v[84:85], v[70:71]
    v_mov_b32 v7, v93
    v_mov_b64 v[86:87], v[74:75]
    s_mov_b64 exec, -1
    s_or_b64 s[80:81], s[80:81], vcc
    v_cmpx_ne_u64 vcc, v[72:73], v[68:69]
    s_and_b64 s[82:83], vcc, s[80:81]
    s_cbranch_scc1 L2_c58
L2_d58:
    v_mov_b64 v[84:85], v[68:69]
    v_mov_b32 v7, v92
    v_mov_b64 v[86:87], v[72:73]
    s_mov_b64 exec, -1
    s_or_b64 s[80:81], s[80:81], vcc
    ds_read_b64 v[70:71], v95 offset:65408
    ds_read_b64 v[68:69], v94 offset:65408
    v_and_b32 v46, 0x20000000, v21
    v_lshrrev_b32 v47, 14, v17
    v_bitop3_b32 v47, v47, v5, v46 bitop3:0xea
    ds_read_b64 v[102:103], v47
    v_bitop3_b32 v93, v17, v5, v46 bitop3:0xea
    v_and_b32 v46, 0x10000000, v21
    v_lshrrev_b32 v47, 14, v16
    v_bitop3_b32 v47, v47, v5, v46 bitop3:0xea
    ds_read_b64 v[100:101], v47
    v_bitop3_b32 v92, v16, v5, v46 bitop3:0xea
    s_waitcnt lgkmcnt(2)
    v_mfma_f32_4x4x4_16b_bf16 v[80:83], v[10:11], v[70:71], v[80:83]
    v_mfma_f32_4x4x4_16b_bf16 v[76:79], v[10:11], v[68:69], v[76:79]
    v_perm_b32 v15, v17, v20, s45
    v_bitop3_b32 v46, v17, 0.5, -0.5 bitop3:0xa8
    v_perm_b32 v14, v16, v20, s44
    v_bitop3_b32 v47, v16, 0.5, -0.5 bitop3:0xa8
    v_cvt_pk_bf16_f32 v80, v80, v81
    v_cvt_pk_bf16_f32 v81, v82, v83
    ds_wrxchg_rtn_b64 v[74:75], v95, v[80:81] offset:65408
    v_cvt_pk_bf16_f32 v76, v76, v77
    v_cvt_pk_bf16_f32 v77, v78, v79
    ds_wrxchg_rtn_b64 v[72:73], v94, v[76:77] offset:65408
    s_waitcnt lgkmcnt(2)
    v_mfma_f32_4x4x4_16b_bf16 v[80:83], v[8:9], v[102:103], 0
    v_mfma_f32_4x4x4_16b_bf16 v[76:79], v[8:9], v[100:101], 0
    v_bitop3_b32 v15, v6, v15, v46 bitop3:0xca
    v_bitop3_b32 v14, v6, v14, v47 bitop3:0xca
    v_cmp_lt_u32 s[84:85], v5, v92
    s_nop 0
    v_pk_mul_f32 v[80:81], v[80:81], v[14:15] op_sel:[0,1] op_sel_hi:[1,1]
    v_pk_mul_f32 v[82:83], v[82:83], v[14:15] op_sel:[0,1] op_sel_hi:[1,1]
    v_pk_mul_f32 v[76:77], v[76:77], v[14:15] op_sel:[0,0] op_sel_hi:[1,0]
    v_pk_mul_f32 v[78:79], v[78:79], v[14:15] op_sel:[0,0] op_sel_hi:[1,0]
    buffer_load_dwordx4 v[108:111], v3, s[16:19], s40 offen offset:0
    s_waitcnt lgkmcnt(0)
    v_cmpx_ne_u64 vcc, v[74:75], v[70:71]
    s_and_b64 s[82:83], vcc, s[80:81]
    s_cbranch_scc1 L2_c59
L2_d59:
    v_mov_b64 v[84:85], v[70:71]
    v_mov_b32 v7, v95
    v_mov_b64 v[86:87], v[74:75]
    s_mov_b64 exec, -1
    s_or_b64 s[80:81], s[80:81], vcc
    v_cmpx_ne_u64 vcc, v[72:73], v[68:69]
    s_and_b64 s[82:83], vcc, s[80:81]
    s_cbranch_scc1 L2_c60
L2_d60:
    v_mov_b64 v[84:85], v[68:69]
    v_mov_b32 v7, v94
    v_mov_b64 v[86:87], v[72:73]
    s_mov_b64 exec, -1
    s_or_b64 s[80:81], s[80:81], vcc
    ds_read_b64 v[70:71], v93 offset:65408
    s_and_b64 exec, s[84:85], s[80:81]
    v_mfma_f32_4x4x4_16b_bf16 v[76:79], v[12:13], v[84:85], 0
    v_mov_b32 v92, v7
    s_andn2_b64 s[80:81], s[80:81], s[84:85]
    v_mfma_f32_4x4x4_16b_bf16 v[76:79], v[10:11], v[86:87], v[76:79]
    s_mov_b64 exec, -1
    ds_read_b64 v[68:69], v92 offset:65408
    v_and_b32 v46, 0x80000000, v21
    v_lshrrev_b32 v47, 14, v19
    v_bitop3_b32 v47, v47, v5, v46 bitop3:0xea
    ds_read_b64 v[106:107], v47
    v_bitop3_b32 v95, v19, v5, v46 bitop3:0xea
    v_and_b32 v46, 0x40000000, v21
    v_lshrrev_b32 v47, 14, v18
    v_bitop3_b32 v47, v47, v5, v46 bitop3:0xea
    ds_read_b64 v[104:105], v47
    v_bitop3_b32 v94, v18, v5, v46 bitop3:0xea
    s_waitcnt lgkmcnt(2)
    v_mfma_f32_4x4x4_16b_bf16 v[80:83], v[10:11], v[70:71], v[80:83]
    v_mfma_f32_4x4x4_16b_bf16 v[76:79], v[10:11], v[68:69], v[76:79]
    v_perm_b32 v15, v19, v20, s47
    v_bitop3_b32 v46, v19, 0.5, -0.5 bitop3:0xa8
    v_perm_b32 v14, v18, v20, s46
    v_bitop3_b32 v47, v18, 0.5, -0.5 bitop3:0xa8
    v_cvt_pk_bf16_f32 v80, v80, v81
    v_cvt_pk_bf16_f32 v81, v82, v83
    ds_wrxchg_rtn_b64 v[74:75], v93, v[80:81] offset:65408
    v_cvt_pk_bf16_f32 v76, v76, v77
    v_cvt_pk_bf16_f32 v77, v78, v79
    ds_wrxchg_rtn_b64 v[72:73], v92, v[76:77] offset:65408
    s_setprio 2
    s_waitcnt lgkmcnt(2)
    v_mfma_f32_4x4x4_16b_bf16 v[80:83], v[8:9], v[106:107], 0
    v_mfma_f32_4x4x4_16b_bf16 v[76:79], v[8:9], v[104:105], 0
    v_bitop3_b32 v15, v6, v15, v46 bitop3:0xca
    v_bitop3_b32 v14, v6, v14, v47 bitop3:0xca
    s_nop 1
    v_pk_mul_f32 v[80:81], v[80:81], v[14:15] op_sel:[0,1] op_sel_hi:[1,1]
    v_pk_mul_f32 v[82:83], v[82:83], v[14:15] op_sel:[0,1] op_sel_hi:[1,1]
    v_pk_mul_f32 v[76:77], v[76:77], v[14:15] op_sel:[0,0] op_sel_hi:[1,0]
    v_pk_mul_f32 v[78:79], v[78:79], v[14:15] op_sel:[0,0] op_sel_hi:[1,0]
    v_and_b32 v47, 0x0fffffff, v40
    v_mov_b32 v21, v40
    buffer_load_dwordx2 v[16:17], v47, s[8:11], 0 offen
    buffer_load_dwordx3 v[18:20], v47, s[8:11], 0 offen offset:8
    s_waitcnt lgkmcnt(0)
    v_cmpx_ne_u64 vcc, v[74:75], v[70:71]
    s_and_b64 s[82:83], vcc, s[80:81]
    s_cbranch_scc1 L2_c61
L2_d61:
    v_mov_b64 v[84:85], v[70:71]
    v_mov_b32 v7, v93
    v_mov_b64 v[86:87], v[74:75]
    s_mov_b64 exec, -1
    s_or_b64 s[80:81], s[80:81], vcc
    v_cmpx_ne_u64 vcc, v[72:73], v[68:69]
    s_and_b64 s[82:83], vcc, s[80:81]
    s_cbranch_scc1 L2_c62
L2_d62:
    v_mov_b64 v[84:85], v[68:69]
    v_mov_b32 v7, v92
    v_mov_b64 v[86:87], v[72:73]
    s_mov_b64 exec, -1
    s_or_b64 s[80:81], s[80:81], vcc
    ds_read_b64 v[70:71], v95 offset:65408
    ds_read_b64 v[68:69], v94 offset:65408
    s_waitcnt vmcnt(10)
    v_and_b32 v46, 0x20000000, v27
    v_lshrrev_b32 v47, 14, v23
    v_bitop3_b32 v47, v47, v5, v46 bitop3:0xea
    ds_read_b64 v[102:103], v47
    v_bitop3_b32 v93, v23, v5, v46 bitop3:0xea
    v_and_b32 v46, 0x10000000, v27
    v_lshrrev_b32 v47, 14, v22
    v_bitop3_b32 v47, v47, v5, v46 bitop3:0xea
    ds_read_b64 v[100:101], v47
    v_bitop3_b32 v92, v22, v5, v46 bitop3:0xea
    s_waitcnt lgkmcnt(2)
    v_mfma_f32_4x4x4_16b_bf16 v[80:83], v[10:11], v[70:71], v[80:83]
    v_mfma_f32_4x4x4_16b_bf16 v[76:79], v[10:11], v[68:69], v[76:79]
    v_perm_b32 v15, v23, v26, s45
    v_bitop3_b32 v46, v23, 0.5, -0.5 bitop3:0xa8
    v_perm_b32 v14, v22, v26, s44
    v_bitop3_b32 v47, v22, 0.5, -0.5 bitop3:0xa8
    v_cvt_pk_bf16_f32 v80, v80, v81
    v_cvt_pk_bf16_f32 v81, v82, v83
    ds_wrxchg_rtn_b64 v[74:75], v95, v[80:81] offset:65408
    v_cvt_pk_bf16_f32 v76, v76, v77
    v_cvt_pk_bf16_f32 v77, v78, v79
    ds_wrxchg_rtn_b64 v[72:73], v94, v[76:77] offset:65408
    s_waitcnt lgkmcnt(2)
    v_mfma_f32_4x4x4_16b_bf16 v[80:83], v[8:9], v[102:103], 0
    v_mfma_f32_4x4x4_16b_bf16 v[76:79], v[8:9], v[100:101], 0
    v_bitop3_b32 v15, v6, v15, v46 bitop3:0xca
    v_bitop3_b32 v14, v6, v14, v47 bitop3:0xca
    v_cmp_lt_u32 s[84:85], v5, v92
    s_nop 0
    v_pk_mul_f32 v[80:81], v[80:81], v[14:15] op_sel:[0,1] op_sel_hi:[1,1]
    v_pk_mul_f32 v[82:83], v[82:83], v[14:15] op_sel:[0,1] op_sel_hi:[1,1]
    v_pk_mul_f32 v[76:77], v[76:77], v[14:15] op_sel:[0,0] op_sel_hi:[1,0]
    v_pk_mul_f32 v[78:79], v[78:79], v[14:15] op_sel:[0,0] op_sel_hi:[1,0]
    v_sub_u16 v88, v58, v50
    v_and_b32 v89, 3, v50
    v_add3_u32 v99, v88, v89, 3
    v_and_b32 v99, -4, v99
    v_max_u32 v99, 4, v99
    v_and_b32 v97, 0xfffc, v50
    v_bfm_b32 v96, v88, v89
    v_add_u32_dpp v91, v99, v99 row_shr:1 row_mask:0xf bank_mask:0xf bound_ctrl:1
    v_mad_u32_u24 v97, v97, 5, v2
    v_cmp_lt_u32 vcc, 16, v99
    v_add_u32_dpp v91, v91, v91 row_shr:2 row_mask:0xf bank_mask:0xf bound_ctrl:1
    v_sub_u32 v98, s38, v99
    v_lshrrev_b64 v[50:51], 16, v[50:51]
    v_add_u32_dpp v91, v91, v91 row_shr:4 row_mask:0xf bank_mask:0xf bound_ctrl:1
    v_lshrrev_b64 v[58:59], 16, v[58:59]
    s_mov_b32 s43, 0
    v_add_u32_dpp v91, v91, v91 row_shr:8 row_mask:0xf bank_mask:0xf bound_ctrl:1
    s_nop 1
    v_add_u32_dpp v91, v91, v91 row_bcast:15 row_mask:0xa bank_mask:0xf
    s_nop 1
    v_add_u32_dpp v91, v91, v91 row_bcast:31 row_mask:0xc bank_mask:0xf
    v_add_u32 v98, v98, v91
    v_readlane_b32 s37, v91, 63
    s_cbranch_vccnz L2_xo63
L2_xp63:
    buffer_load_dwordx4 v[112:115], v3, s[16:19], s40 offen offset:1024
    s_waitcnt lgkmcnt(0)
    v_cmpx_ne_u64 vcc, v[74:75], v[70:71]
    s_and_b64 s[82:83], vcc, s[80:81]
    s_cbranch_scc1 L2_c64
L2_d64:
    v_mov_b64 v[84:85], v[70:71]
    v_mov_b32 v7, v95
    v_mov_b64 v[86:87], v[74:75]
    s_mov_b64 exec, -1
    s_or_b64 s[80:81], s[80:81], vcc
    v_cmpx_ne_u64 vcc, v[72:73], v[68:69]
    s_and_b64 s[82:83], vcc, s[80:81]
    s_cbranch_scc1 L2_c65
L2_d65:
    v_mov_b64 v[84:85], v[68:69]
    v_mov_b32 v7, v94
    v_mov_b64 v[86:87], v[72:73]
    s_mov_b64 exec, -1
    s_or_b64 s[80:81], s[80:81], vcc
    ds_read_b64 v[70:71], v93 offset:65408
    s_and_b64 exec, s[84:85], s[80:81]
    v_mfma_f32_4x4x4_16b_bf16 v[76:79], v[12:13], v[84:85], 0
    v_mov_b32 v92, v7
    s_andn2_b64 s[80:81], s[80:81], s[84:85]
    v_mfma_f32_4x4x4_16b_bf16 v[76:79], v[10:11], v[86:87], v[76:79]
    s_mov_b64 exec, -1
    ds_read_b64 v[68:69], v92 offset:65408
    v_and_b32 v46, 0x80000000, v27
    v_lshrrev_b32 v47, 14, v25
    v_bitop3_b32 v47, v47, v5, v46 bitop3:0xea
    ds_read_b64 v[106:107], v47
    v_bitop3_b32 v95, v25, v5, v46 bitop3:0xea
    v_and_b32 v46, 0x40000000, v27
    v_lshrrev_b32 v47, 14, v24
    v_bitop3_b32 v47, v47, v5, v46 bitop3:0xea
    ds_read_b64 v[104:105], v47
    v_bitop3_b32 v94, v24, v5, v46 bitop3:0xea
    s_waitcnt lgkmcnt(2)
    v_mfma_f32_4x4x4_16b_bf16 v[80:83], v[10:11], v[70:71], v[80:83]
    v_mfma_f32_4x4x4_16b_bf16 v[76:79], v[10:11], v[68:69], v[76:79]
    v_perm_b32 v15, v25, v26, s47
    v_bitop3_b32 v46, v25, 0.5, -0.5 bitop3:0xa8
    v_perm_b32 v14, v24, v26, s46
    v_bitop3_b32 v47, v24, 0.5, -0.5 bitop3:0xa8
    v_cvt_pk_bf16_f32 v80, v80, v81
    v_cvt_pk_bf16_f32 v81, v82, v83
    ds_wrxchg_rtn_b64 v[74:75], v93, v[80:81] offset:65408
    v_cvt_pk_bf16_f32 v76, v76, v77
    v_cvt_pk_bf16_f32 v77, v78, v79
    ds_wrxchg_rtn_b64 v[72:73], v92, v[76:77] offset:65408
    s_setprio 1
    s_waitcnt lgkmcnt(2)
    v_mfma_f32_4x4x4_16b_bf16 v[80:83], v[8:9], v[106:107], 0
    v_mfma_f32_4x4x4_16b_bf16 v[76:79], v[8:9], v[104:105], 0
    v_bitop3_b32 v15, v6, v15, v46 bitop3:0xca
    v_bitop3_b32 v14, v6, v14, v47 bitop3:0xca
    s_nop 1
    v_pk_mul_f32 v[80:81], v[80:81], v[14:15] op_sel:[0,1] op_sel_hi:[1,1]
    v_pk_mul_f32 v[82:83], v[82:83], v[14:15] op_sel:[0,1] op_sel_hi:[1,1]
    v_pk_mul_f32 v[76:77], v[76:77], v[14:15] op_sel:[0,0] op_sel_hi:[1,0]
    v_pk_mul_f32 v[78:79], v[78:79], v[14:15] op_sel:[0,0] op_sel_hi:[1,0]
    v_and_b32 v47, 0x0fffffff, v41
    v_mov_b32 v27, v41
    buffer_load_dwordx2 v[22:23], v47, s[8:11], 0 offen
    buffer_load_dwordx3 v[24:26], v47, s[8:11], 0 offen offset:8
    s_waitcnt lgkmcnt(0)
    v_cmpx_ne_u64 vcc, v[74:75], v[70:71]
    s_and_b64 s[82:83], vcc, s[80:81]
    s_cbranch_scc1 L2_c66
L2_d66:
    v_mov_b64 v[84:85], v[70:71]
    v_mov_b32 v7, v93
    v_mov_b64 v[86:87], v[74:75]
    s_mov_b64 exec, -1
    s_or_b64 s[80:81], s[80:81], vcc
    v_cmpx_ne_u64 vcc, v[72:73], v[68:69]
    s_and_b64 s[82:83], vcc, s[80:81]
    s_cbranch_scc1 L2_c67
L2_d67:
    v_mov_b64 v[84:85], v[68:69]
    v_mov_b32 v7, v92
    v_mov_b64 v[86:87], v[72:73]
    s_mov_b64 exec, -1
    s_or_b64 s[80:81], s[80:81], vcc
    ds_read_b64 v[70:71], v95 offset:65408
    ds_read_b64 v[68:69], v94 offset:65408
    s_waitcnt vmcnt(11)
    v_and_b32 v46, 0x20000000, v33
    v_lshrrev_b32 v47, 14, v29
    v_bitop3_b32 v47, v47, v5, v46 bitop3:0xea
    ds_read_b64 v[102:103], v47
    v_bitop3_b32 v93, v29, v5, v46 bitop3:0xea
    v_and_b32 v46, 0x10000000, v33
    v_lshrrev_b32 v47, 14, v28
    v_bitop3_b32 v47, v47, v5, v46 bitop3:0xea
    ds_read_b64 v[100:101], v47
    v_bitop3_b32 v92, v28, v5, v46 bitop3:0xea
    s_waitcnt lgkmcnt(2)
    v_mfma_f32_4x4x4_16b_bf16 v[80:83], v[10:11], v[70:71], v[80:83]
    v_mfma_f32_4x4x4_16b_bf16 v[76:79], v[10:11], v[68:69], v[76:79]
    v_perm_b32 v15, v29, v32, s45
    v_bitop3_b32 v46, v29, 0.5, -0.5 bitop3:0xa8
    v_perm_b32 v14, v28, v32, s44
    v_bitop3_b32 v47, v28, 0.5, -0.5 bitop3:0xa8
    v_cvt_pk_bf16_f32 v80, v80, v81
    v_cvt_pk_bf16_f32 v81, v82, v83
    ds_wrxchg_rtn_b64 v[74:75], v95, v[80:81] offset:65408
    v_cvt_pk_bf16_f32 v76, v76, v77
    v_cvt_pk_bf16_f32 v77, v78, v79
    ds_wrxchg_rtn_b64 v[72:73], v94, v[76:77] offset:65408
    s_waitcnt lgkmcnt(2)
    v_mfma_f32_4x4x4_16b_bf16 v[80:83], v[8:9], v[102:103], 0
    v_mfma_f32_4x4x4_16b_bf16 v[76:79], v[8:9], v[100:101], 0
    v_bitop3_b32 v15, v6, v15, v46 bitop3:0xca
    v_bitop3_b32 v14, v6, v14, v47 bitop3:0xca
    v_cmp_lt_u32 s[84:85], v5, v92
    s_nop 0
    v_pk_mul_f32 v[80:81], v[80:81], v[14:15] op_sel:[0,1] op_sel_hi:[1,1]
    v_pk_mul_f32 v[82:83], v[82:83], v[14:15] op_sel:[0,1] op_sel_hi:[1,1]
    v_pk_mul_f32 v[76:77], v[76:77], v[14:15] op_sel:[0,0] op_sel_hi:[1,0]
    v_pk_mul_f32 v[78:79], v[78:79], v[14:15] op_sel:[0,0] op_sel_hi:[1,0]
    s_waitcnt lgkmcnt(0)
    v_cmpx_ne_u64 vcc, v[74:75], v[70:71]
    s_and_b64 s[82:83], vcc, s[80:81]
    s_cbranch_scc1 L2_c68
L2_d68:
    v_mov_b64 v[84:85], v[70:71]
    v_mov_b32 v7, v95
    v_mov_b64 v[86:87], v[74:75]
    s_mov_b64 exec, -1
    s_or_b64 s[80:81], s[80:81], vcc
    v_cmpx_ne_u64 vcc, v[72:73], v[68:69]
    s_and_b64 s[82:83], vcc, s[80:81]
    s_cbranch_scc1 L2_c69
L2_d69:
    v_mov_b64 v[84:85], v[68:69]
    v_mov_b32 v7, v94
    v_mov_b64 v[86:87], v[72:73]
    s_mov_b64 exec, -1
    s_or_b64 s[80:81], s[80:81], vcc
    ds_read_b64 v[70:71], v93 offset:65408
    s_and_b64 exec, s[84:85], s[80:81]
    v_mfma_f32_4x4x4_16b_bf16 v[76:79], v[12:13], v[84:85], 0
    v_mov_b32 v92, v7
    s_andn2_b64 s[80:81], s[80:81], s[84:85]
    v_mfma_f32_4x4x4_16b_bf16 v[76:79], v[10:11], v[86:87], v[76:79]
    s_mov_b64 exec, -1
    ds_read_b64 v[68:69], v92 offset:65408
    v_and_b32 v46, 0x80000000, v33
    v_lshrrev_b32 v47, 14, v31
    v_bitop3_b32 v47, v47, v5, v46 bitop3:0xea
    ds_read_b64 v[106:107], v47
    v_bitop3_b32 v95, v31, v5, v46 bitop3:0xea
    v_and_b32 v46, 0x40000000, v33
    v_lshrrev_b32 v47, 14, v30
    v_bitop3_b32 v47, v47, v5, v46 bitop3:0xea
    ds_read_b64 v[104:105], v47
    v_bitop3_b32 v94, v30, v5, v46 bitop3:0xea
    s_waitcnt lgkmcnt(2)
    v_mfma_f32_4x4x4_16b_bf16 v[80:83], v[10:11], v[70:71], v[80:83]
    v_mfma_f32_4x4x4_16b_bf16 v[76:79], v[10:11], v[68:69], v[76:79]
    v_perm_b32 v15, v31, v32, s47
    v_bitop3_b32 v46, v31, 0.5, -0.5 bitop3:0xa8
    v_perm_b32 v14, v30, v32, s46
    v_bitop3_b32 v47, v30, 0.5, -0.5 bitop3:0xa8
    v_cvt_pk_bf16_f32 v80, v80, v81
    v_cvt_pk_bf16_f32 v81, v82, v83
    ds_wrxchg_rtn_b64 v[74:75], v93, v[80:81] offset:65408
    v_cvt_pk_bf16_f32 v76, v76, v77
    v_cvt_pk_bf16_f32 v77, v78, v79
    ds_wrxchg_rtn_b64 v[72:73], v92, v[76:77] offset:65408
    s_setprio 0
    s_waitcnt lgkmcnt(2)
    v_mfma_f32_4x4x4_16b_bf16 v[80:83], v[8:9], v[106:107], 0
    v_mfma_f32_4x4x4_16b_bf16 v[76:79], v[8:9], v[104:105], 0
    v_bitop3_b32 v15, v6, v15, v46 bitop3:0xca
    v_bitop3_b32 v14, v6, v14, v47 bitop3:0xca
    s_nop 1
    v_pk_mul_f32 v[80:81], v[80:81], v[14:15] op_sel:[0,1] op_sel_hi:[1,1]
    v_pk_mul_f32 v[82:83], v[82:83], v[14:15] op_sel:[0,1] op_sel_hi:[1,1]
    v_pk_mul_f32 v[76:77], v[76:77], v[14:15] op_sel:[0,0] op_sel_hi:[1,0]
    v_pk_mul_f32 v[78:79], v[78:79], v[14:15] op_sel:[0,0] op_sel_hi:[1,0]
    s_add_u32 s40, s40, 0x50000
    v_and_b32 v47, 0x0fffffff, v42
    v_mov_b32 v33, v42
    buffer_load_dwordx2 v[28:29], v47, s[8:11], 0 offen
    buffer_load_dwordx3 v[30:32], v47, s[8:11], 0 offen offset:8
    s_waitcnt lgkmcnt(0)
    v_cmpx_ne_u64 vcc, v[74:75], v[70:71]
    s_and_b64 s[82:83], vcc, s[80:81]
    s_cbranch_scc1 L2_c70
L2_d70:
    v_mov_b64 v[84:85], v[70:71]
    v_mov_b32 v7, v93
    v_mov_b64 v[86:87], v[74:75]
    s_mov_b64 exec, -1
    s_or_b64 s[80:81], s[80:81], vcc
    v_cmpx_ne_u64 vcc, v[72:73], v[68:69]
    s_and_b64 s[82:83], vcc, s[80:81]
    s_cbranch_scc1 L2_c71
L2_d71:
    v_mov_b64 v[84:85], v[68:69]
    v_mov_b32 v7, v92
    v_mov_b64 v[86:87], v[72:73]
    s_mov_b64 exec, -1
    s_or_b64 s[80:81], s[80:81], vcc
    ds_read_b64 v[70:71], v95 offset:65408
    ds_read_b64 v[68:69], v94 offset:65408
    s_waitcnt vmcnt(8)
    v_and_b32 v46, 0x20000000, v39
    v_lshrrev_b32 v47, 14, v35
    v_bitop3_b32 v47, v47, v5, v46 bitop3:0xea
    ds_read_b64 v[102:103], v47
    v_bitop3_b32 v93, v35, v5, v46 bitop3:0xea
    v_and_b32 v46, 0x10000000, v39
    v_lshrrev_b32 v47, 14, v34
    v_bitop3_b32 v47, v47, v5, v46 bitop3:0xea
    ds_read_b64 v[100:101], v47
    v_bitop3_b32 v92, v34, v5, v46 bitop3:0xea
    v_and_b32 v46, 0x80000000, v39
    v_lshrrev_b32 v47, 14, v37
    v_bitop3_b32 v47, v47, v5, v46 bitop3:0xea
    ds_read_b64 v[106:107], v47
    v_and_b32 v46, 0x40000000, v39
    v_lshrrev_b32 v47, 14, v36
    v_bitop3_b32 v47, v47, v5, v46 bitop3:0xea
    ds_read_b64 v[104:105], v47
    s_waitcnt lgkmcnt(4)
    v_mfma_f32_4x4x4_16b_bf16 v[80:83], v[10:11], v[70:71], v[80:83]
    v_mfma_f32_4x4x4_16b_bf16 v[76:79], v[10:11], v[68:69], v[76:79]
    v_perm_b32 v15, v35, v38, s45
    v_bitop3_b32 v46, v35, 0.5, -0.5 bitop3:0xa8
    v_perm_b32 v14, v34, v38, s44
    v_bitop3_b32 v47, v34, 0.5, -0.5 bitop3:0xa8
    v_cvt_pk_bf16_f32 v80, v80, v81
    v_cvt_pk_bf16_f32 v81, v82, v83
    ds_wrxchg_rtn_b64 v[74:75], v95, v[80:81] offset:65408
    v_cvt_pk_bf16_f32 v76, v76, v77
    v_cvt_pk_bf16_f32 v77, v78, v79
    ds_wrxchg_rtn_b64 v[72:73], v94, v[76:77] offset:65408
    s_waitcnt lgkmcnt(2)
    s_barrier
    s_setprio 3
    s_mov_b32 m0, s69
    s_nop 0
    ds_write_addtid_b32 v116 offset:32768
    ds_write_addtid_b32 v117 offset:33024
    ds_write_addtid_b32 v118 offset:33280
    ds_write_addtid_b32 v119 offset:33536
    buffer_load_dwordx4 v[116:119], v3, s[16:19], s40 offen offset:2048
    ds_write_addtid_b32 v120 offset:33792
    ds_write_addtid_b32 v121 offset:34048
    ds_write_addtid_b32 v122 offset:34304
    ds_write_addtid_b32 v123 offset:34560
    buffer_load_dwordx4 v[120:123], v3, s[16:19], s40 offen offset:3072
    v_mfma_f32_4x4x4_16b_bf16 v[80:83], v[8:9], v[102:103], 0
    v_mfma_f32_4x4x4_16b_bf16 v[76:79], v[8:9], v[100:101], 0
    v_bitop3_b32 v15, v6, v15, v46 bitop3:0xca
    v_bitop3_b32 v14, v6, v14, v47 bitop3:0xca
    v_cmp_lt_u32 s[84:85], v5, v92
    s_nop 0
    v_pk_mul_f32 v[80:81], v[80:81], v[14:15] op_sel:[0,1] op_sel_hi:[1,1]
    v_pk_mul_f32 v[82:83], v[82:83], v[14:15] op_sel:[0,1] op_sel_hi:[1,1]
    v_pk_mul_f32 v[76:77], v[76:77], v[14:15] op_sel:[0,0] op_sel_hi:[1,0]
    v_pk_mul_f32 v[78:79], v[78:79], v[14:15] op_sel:[0,0] op_sel_hi:[1,0]
    v_mov_b32 v44, v43
    s_cmp_gt_u32 s37, 1024
    s_cbranch_scc1 L2_xs72
    s_cmp_lg_u32 s43, 0
    s_cbranch_scc1 L2_xa72
L2_xb72:
    v_lshlrev_b32 v89, 16, v96
    v_add_u32 v90, 60, v97
    v_bitop3_b32 v90, v89, v45, v90 bitop3:0x6a
    ds_write_b32 v98, v90 offset:12
    v_lshlrev_b32 v89, 20, v96
    v_add_u32 v90, 40, v97
    v_bitop3_b32 v90, v89, v45, v90 bitop3:0x6a
    ds_write_b32 v98, v90 offset:8
    v_lshlrev_b32 v89, 24, v96
    v_add_u32 v90, 20, v97
    v_bitop3_b32 v90, v89, v45, v90 bitop3:0x6a
    ds_write_b32 v98, v90 offset:4
    v_lshlrev_b32 v89, 28, v96
    v_bitop3_b32 v90, v89, v45, v97 bitop3:0x6a
    ds_write_b32 v98, v90 offset:0
    v_mov_b32_dpp v91, v66 quad_perm:[0,0,0,0] row_mask:0xf bank_mask:0xf
    v_and_b32 v89, 3, v91
    v_and_b32 v97, 0xfffc, v91
    v_sub_u16_dpp v88, v66, v91 quad_perm:[2,2,2,2] row_mask:0xf bank_mask:0xf
    v_mad_u32_u24 v97, v97, 5, v4
    v_add_u32 v99, v88, v89
    v_bfm_b32 v96, v88, v89
    v_cmp_lt_u32 s[58:59], 16, v99
    v_lshlrev_b32 v89, v1, v96
    v_and_b32 v89, v45, v89
    v_cmp_ne_u32 vcc, 0, v89
    v_xor_b32 v90, v97, v89
    s_add_u32 s3, s37, s38
    v_mbcnt_lo_u32_b32 v98, vcc_lo, 0
    v_mbcnt_hi_u32_b32 v98, vcc_hi, v98
    s_bcnt1_i32_b64 s41, vcc
    v_lshl_add_u32 v98, v98, 2, s3
    s_mov_b64 exec, vcc
    ds_write_b32 v98, v90
    s_mov_b64 exec, -1
    s_lshl2_add_u32 s37, s41, s37
    s_cmp_lg_u64 s[58:59], 0
    s_cbranch_scc1 L2_xe72
L2_xr72:
    v_add_u32 v98, s37, v0
    v_mov_b32 v90, -1
    ds_write_b32 v98, v90
    ds_read2st64_b32 v[40:41], v0 offset0:0 offset1:1
    ds_read2st64_b32 v[42:43], v0 offset0:2 offset1:3
    s_sub_u32 s3, s37, 768
    s_cmp_gt_u32 s3, 256
    s_cbranch_scc1 L2_xf72
L2_xg72:
    s_setprio 2
    ds_write_addtid_b32 v124 offset:34816
    ds_write_addtid_b32 v125 offset:35072
    ds_write_addtid_b32 v126 offset:35328
    ds_write_addtid_b32 v127 offset:35584
    s_add_u32 s3, s40, 4096
    buffer_load_dwordx4 v[124:127], v3, s[16:19], s3 offen
    s_waitcnt lgkmcnt(14)
    v_cmpx_ne_u64 vcc, v[74:75], v[70:71]
    s_and_b64 s[82:83], vcc, s[80:81]
    s_cbranch_scc1 L2_c73
L2_d73:
    v_mov_b64 v[84:85], v[70:71]
    v_mov_b32 v7, v95
    v_mov_b64 v[86:87], v[74:75]
    s_mov_b64 exec, -1
    s_or_b64 s[80:81], s[80:81], vcc
    v_cmpx_ne_u64 vcc, v[72:73], v[68:69]
    s_and_b64 s[82:83], vcc, s[80:81]
    s_cbranch_scc1 L2_c74
L2_d74:
    v_mov_b64 v[84:85], v[68:69]
    v_mov_b32 v7, v94
    v_mov_b64 v[86:87], v[72:73]
    s_mov_b64 exec, -1
    s_or_b64 s[80:81], s[80:81], vcc
    ds_read_b64 v[70:71], v93 offset:65408
    s_and_b64 exec, s[84:85], s[80:81]
    v_mfma_f32_4x4x4_16b_bf16 v[76:79], v[12:13], v[84:85], 0
    v_mov_b32 v92, v7
    s_andn2_b64 s[80:81], s[80:81], s[84:85]
    v_mfma_f32_4x4x4_16b_bf16 v[76:79], v[10:11], v[86:87], v[76:79]
    s_mov_b64 exec, -1
    ds_read_b64 v[68:69], v92 offset:65408
    s_setprio 1
    s_waitcnt vmcnt(10)
    s_mov_b32 m0, s38
    s_nop 0
    ds_write_addtid_b32 v108 offset:0
    ds_write_addtid_b32 v109 offset:256
    ds_write_addtid_b32 v110 offset:512
    ds_write_addtid_b32 v111 offset:768
    s_waitcnt lgkmcnt(4)
    v_mfma_f32_4x4x4_16b_bf16 v[80:83], v[10:11], v[70:71], v[80:83]
    v_mfma_f32_4x4x4_16b_bf16 v[76:79], v[10:11], v[68:69], v[76:79]
    v_and_b32 v46, 0x40000000, v39
    v_bitop3_b32 v94, v36, v5, v46 bitop3:0xea
    v_and_b32 v46, 0x80000000, v39
    v_bitop3_b32 v95, v37, v5, v46 bitop3:0xea
    v_perm_b32 v15, v37, v38, s47
    v_bitop3_b32 v46, v37, 0.5, -0.5 bitop3:0xa8
    v_perm_b32 v14, v36, v38, s46
    v_bitop3_b32 v47, v36, 0.5, -0.5 bitop3:0xa8
    v_cvt_pk_bf16_f32 v80, v80, v81
    v_cvt_pk_bf16_f32 v81, v82, v83
    ds_wrxchg_rtn_b64 v[74:75], v93, v[80:81] offset:65408
    v_cvt_pk_bf16_f32 v76, v76, v77
    v_cvt_pk_bf16_f32 v77, v78, v79
    ds_wrxchg_rtn_b64 v[72:73], v92, v[76:77] offset:65408
    s_setprio 0
    s_waitcnt vmcnt(7)
    ds_write_addtid_b32 v112 offset:1024
    ds_write_addtid_b32 v113 offset:1280
    ds_write_addtid_b32 v114 offset:1536
    ds_write_addtid_b32 v115 offset:1792
    v_mfma_f32_4x4x4_16b_bf16 v[80:83], v[8:9], v[106:107], 0
    v_mfma_f32_4x4x4_16b_bf16 v[76:79], v[8:9], v[104:105], 0
    v_bitop3_b32 v15, v6, v15, v46 bitop3:0xca
    v_bitop3_b32 v14, v6, v14, v47 bitop3:0xca
    s_nop 1
    v_pk_mul_f32 v[80:81], v[80:81], v[14:15] op_sel:[0,1] op_sel_hi:[1,1]
    v_pk_mul_f32 v[82:83], v[82:83], v[14:15] op_sel:[0,1] op_sel_hi:[1,1]
    v_pk_mul_f32 v[76:77], v[76:77], v[14:15] op_sel:[0,0] op_sel_hi:[1,0]
    v_pk_mul_f32 v[78:79], v[78:79], v[14:15] op_sel:[0,0] op_sel_hi:[1,0]
    s_add_u32 s42, s42, 1
    s_waitcnt lgkmcnt(0)
    s_barrier
    s_bitcmp1_b32 s36, s42
    s_cbranch_scc1 L2_slow
L2_ret4:
    s_setprio 3
    v_and_b32 v47, 0x0fffffff, v44
    v_mov_b32 v39, v44
    buffer_load_dwordx2 v[34:35], v47, s[8:11], 0 offen
    buffer_load_dwordx3 v[36:38], v47, s[8:11], 0 offen offset:8
    v_cmpx_ne_u64 vcc, v[74:75], v[70:71]
    s_and_b64 s[82:83], vcc, s[80:81]
    s_cbranch_scc1 L2_c75
L2_d75:
    v_mov_b64 v[84:85], v[70:71]
    v_mov_b32 v7, v93
    v_mov_b64 v[86:87], v[74:75]
    s_mov_b64 exec, -1
    s_or_b64 s[80:81], s[80:81], vcc
    v_cmpx_ne_u64 vcc, v[72:73], v[68:69]
    s_and_b64 s[82:83], vcc, s[80:81]
    s_cbranch_scc1 L2_c76
L2_d76:
    v_mov_b64 v[84:85], v[68:69]
    v_mov_b32 v7, v92
    v_mov_b64 v[86:87], v[72:73]
    s_mov_b64 exec, -1
    s_or_b64 s[80:81], s[80:81], vcc
    ds_read_b64 v[70:71], v95 offset:65408
    ds_read_b64 v[68:69], v94 offset:65408
    v_and_b32 v46, 0x20000000, v21
    v_lshrrev_b32 v47, 14, v17
    v_bitop3_b32 v47, v47, v5, v46 bitop3:0xea
    ds_read_b64 v[102:103], v47
    v_bitop3_b32 v93, v17, v5, v46 bitop3:0xea
    v_and_b32 v46, 0x10000000, v21
    v_lshrrev_b32 v47, 14, v16
    v_bitop3_b32 v47, v47, v5, v46 bitop3:0xea
    ds_read_b64 v[100:101], v47
    v_bitop3_b32 v92, v16, v5, v46 bitop3:0xea
    s_waitcnt lgkmcnt(2)
    v_mfma_f32_4x4x4_16b_bf16 v[80:83], v[10:11], v[70:71], v[80:83]
    v_mfma_f32_4x4x4_16b_bf16 v[76:79], v[10:11], v[68:69], v[76:79]
    v_perm_b32 v15, v17, v20, s45
    v_bitop3_b32 v46, v17, 0.5, -0.5 bitop3:0xa8
    v_perm_b32 v14, v16, v20, s44
    v_bitop3_b32 v47, v16, 0.5, -0.5 bitop3:0xa8
    v_cvt_pk_bf16_f32 v80, v80, v81
    v_cvt_pk_bf16_f32 v81, v82, v83
    ds_wrxchg_rtn_b64 v[74:75], v95, v[80:81] offset:65408
    v_cvt_pk_bf16_f32 v76, v76, v77
    v_cvt_pk_bf16_f32 v77, v78, v79
    ds_wrxchg_rtn_b64 v[72:73], v94, v[76:77] offset:65408
    s_waitcnt lgkmcnt(2)
    v_mfma_f32_4x4x4_16b_bf16 v[80:83], v[8:9], v[102:103], 0
    v_mfma_f32_4x4x4_16b_bf16 v[76:79], v[8:9], v[100:101], 0
    v_bitop3_b32 v15, v6, v15, v46 bitop3:0xca
    v_bitop3_b32 v14, v6, v14, v47 bitop3:0xca
    v_cmp_lt_u32 s[84:85], v5, v92
    s_nop 0
    v_pk_mul_f32 v[80:81], v[80:81], v[14:15] op_sel:[0,1] op_sel_hi:[1,1]
    v_pk_mul_f32 v[82:83], v[82:83], v[14:15] op_sel:[0,1] op_sel_hi:[1,1]
    v_pk_mul_f32 v[76:77], v[76:77], v[14:15] op_sel:[0,0] op_sel_hi:[1,0]
    v_pk_mul_f32 v[78:79], v[78:79], v[14:15] op_sel:[0,0] op_sel_hi:[1,0]
    buffer_load_dwordx4 v[108:111], v3, s[16:19], s40 offen offset:0
    s_waitcnt lgkmcnt(0)
    v_cmpx_ne_u64 vcc, v[74:75], v[70:71]
    s_and_b64 s[82:83], vcc, s[80:81]
    s_cbranch_scc1 L2_c77
L2_d77:
    v_mov_b64 v[84:85], v[70:71]
    v_mov_b32 v7, v95
    v_mov_b64 v[86:87], v[74:75]
    s_mov_b64 exec, -1
    s_or_b64 s[80:81], s[80:81], vcc
    v_cmpx_ne_u64 vcc, v[72:73], v[68:69]
    s_and_b64 s[82:83], vcc, s[80:81]
    s_cbranch_scc1 L2_c78
L2_d78:
    v_mov_b64 v[84:85], v[68:69]
    v_mov_b32 v7, v94
    v_mov_b64 v[86:87], v[72:73]
    s_mov_b64 exec, -1
    s_or_b64 s[80:81], s[80:81], vcc
    ds_read_b64 v[70:71], v93 offset:65408
    s_and_b64 exec, s[84:85], s[80:81]
    v_mfma_f32_4x4x4_16b_bf16 v[76:79], v[12:13], v[84:85], 0
    v_mov_b32 v92, v7
    s_andn2_b64 s[80:81], s[80:81], s[84:85]
    v_mfma_f32_4x4x4_16b_bf16 v[76:79], v[10:11], v[86:87], v[76:79]
    s_mov_b64 exec, -1
    ds_read_b64 v[68:69], v92 offset:65408
    v_and_b32 v46, 0x80000000, v21
    v_lshrrev_b32 v47, 14, v19
    v_bitop3_b32 v47, v47, v5, v46 bitop3:0xea
    ds_read_b64 v[106:107], v47
    v_bitop3_b32 v95, v19, v5, v46 bitop3:0xea
    v_and_b32 v46, 0x40000000, v21
    v_lshrrev_b32 v47, 14, v18
    v_bitop3_b32 v47, v47, v5, v46 bitop3:0xea
    ds_read_b64 v[104:105], v47
    v_bitop3_b32 v94, v18, v5, v46 bitop3:0xea
    s_waitcnt lgkmcnt(2)
    v_mfma_f32_4x4x4_16b_bf16 v[80:83], v[10:11], v[70:71], v[80:83]
    v_mfma_f32_4x4x4_16b_bf16 v[76:79], v[10:11], v[68:69], v[76:79]
    v_perm_b32 v15, v19, v20, s47
    v_bitop3_b32 v46, v19, 0.5, -0.5 bitop3:0xa8
    v_perm_b32 v14, v18, v20, s46
    v_bitop3_b32 v47, v18, 0.5, -0.5 bitop3:0xa8
    v_cvt_pk_bf16_f32 v80, v80, v81
    v_cvt_pk_bf16_f32 v81, v82, v83
    ds_wrxchg_rtn_b64 v[74:75], v93, v[80:81] offset:65408
    v_cvt_pk_bf16_f32 v76, v76, v77
    v_cvt_pk_bf16_f32 v77, v78, v79
    ds_wrxchg_rtn_b64 v[72:73], v92, v[76:77] offset:65408
    s_setprio 2
    s_waitcnt lgkmcnt(2)
    v_mfma_f32_4x4x4_16b_bf16 v[80:83], v[8:9], v[106:107], 0
    v_mfma_f32_4x4x4_16b_bf16 v[76:79], v[8:9], v[104:105], 0
    v_bitop3_b32 v15, v6, v15, v46 bitop3:0xca
    v_bitop3_b32 v14, v6, v14, v47 bitop3:0xca
    s_nop 1
    v_pk_mul_f32 v[80:81], v[80:81], v[14:15] op_sel:[0,1] op_sel_hi:[1,1]
    v_pk_mul_f32 v[82:83], v[82:83], v[14:15] op_sel:[0,1] op_sel_hi:[1,1]
    v_pk_mul_f32 v[76:77], v[76:77], v[14:15] op_sel:[0,0] op_sel_hi:[1,0]
    v_pk_mul_f32 v[78:79], v[78:79], v[14:15] op_sel:[0,0] op_sel_hi:[1,0]
    v_and_b32 v47, 0x0fffffff, v40
    v_mov_b32 v21, v40
    buffer_load_dwordx2 v[16:17], v47, s[8:11], 0 offen
    buffer_load_dwordx3 v[18:20], v47, s[8:11], 0 offen offset:8
    s_waitcnt lgkmcnt(0)
    v_cmpx_ne_u64 vcc, v[74:75], v[70:71]
    s_and_b64 s[82:83], vcc, s[80:81]
    s_cbranch_scc1 L2_c79
L2_d79:
    v_mov_b64 v[84:85], v[70:71]
    v_mov_b32 v7, v93
    v_mov_b64 v[86:87], v[74:75]
    s_mov_b64 exec, -1
    s_or_b64 s[80:81], s[80:81], vcc
    v_cmpx_ne_u64 vcc, v[72:73], v[68:69]
    s_and_b64 s[82:83], vcc, s[80:81]
    s_cbranch_scc1 L2_c80
L2_d80:
    v_mov_b64 v[84:85], v[68:69]
    v_mov_b32 v7, v92
    v_mov_b64 v[86:87], v[72:73]
    s_mov_b64 exec, -1
    s_or_b64 s[80:81], s[80:81], vcc
    ds_read_b64 v[70:71], v95 offset:65408
    ds_read_b64 v[68:69], v94 offset:65408
    s_waitcnt vmcnt(10)
    v_and_b32 v46, 0x20000000, v27
    v_lshrrev_b32 v47, 14, v23
    v_bitop3_b32 v47, v47, v5, v46 bitop3:0xea
    ds_read_b64 v[102:103], v47
    v_bitop3_b32 v93, v23, v5, v46 bitop3:0xea
    v_and_b32 v46, 0x10000000, v27
    v_lshrrev_b32 v47, 14, v22
    v_bitop3_b32 v47, v47, v5, v46 bitop3:0xea
    ds_read_b64 v[100:101], v47
    v_bitop3_b32 v92, v22, v5, v46 bitop3:0xea
    s_waitcnt lgkmcnt(2)
    v_mfma_f32_4x4x4_16b_bf16 v[80:83], v[10:11], v[70:71], v[80:83]
    v_mfma_f32_4x4x4_16b_bf16 v[76:79], v[10:11], v[68:69], v[76:79]
    v_perm_b32 v15, v23, v26, s45
    v_bitop3_b32 v46, v23, 0.5, -0.5 bitop3:0xa8
    v_perm_b32 v14, v22, v26, s44
    v_bitop3_b32 v47, v22, 0.5, -0.5 bitop3:0xa8
    v_cvt_pk_bf16_f32 v80, v80, v81
    v_cvt_pk_bf16_f32 v81, v82, v83
    ds_wrxchg_rtn_b64 v[74:75], v95, v[80:81] offset:65408
    v_cvt_pk_bf16_f32 v76, v76, v77
    v_cvt_pk_bf16_f32 v77, v78, v79
    ds_wrxchg_rtn_b64 v[72:73], v94, v[76:77] offset:65408
    s_waitcnt lgkmcnt(2)
    v_mfma_f32_4x4x4_16b_bf16 v[80:83], v[8:9], v[102:103], 0
    v_mfma_f32_4x4x4_16b_bf16 v[76:79], v[8:9], v[100:101], 0
    v_bitop3_b32 v15, v6, v15, v46 bitop3:0xca
    v_bitop3_b32 v14, v6, v14, v47 bitop3:0xca
    v_cmp_lt_u32 s[84:85], v5, v92
    s_nop 0
    v_pk_mul_f32 v[80:81], v[80:81], v[14:15] op_sel:[0,1] op_sel_hi:[1,1]
    v_pk_mul_f32 v[82:83], v[82:83], v[14:15] op_sel:[0,1] op_sel_hi:[1,1]
    v_pk_mul_f32 v[76:77], v[76:77], v[14:15] op_sel:[0,0] op_sel_hi:[1,0]
    v_pk_mul_f32 v[78:79], v[78:79], v[14:15] op_sel:[0,0] op_sel_hi:[1,0]
    v_sub_u16 v88, v60, v52
    v_and_b32 v89, 3, v52
    v_add3_u32 v99, v88, v89, 3
    v_and_b32 v99, -4, v99
    v_max_u32 v99, 4, v99
    v_and_b32 v97, 0xfffc, v52
    v_bfm_b32 v96, v88, v89
    v_add_u32_dpp v91, v99, v99 row_shr:1 row_mask:0xf bank_mask:0xf bound_ctrl:1
    v_mad_u32_u24 v97, v97, 5, v2
    v_cmp_lt_u32 vcc, 16, v99
    v_add_u32_dpp v91, v91, v91 row_shr:2 row_mask:0xf bank_mask:0xf bound_ctrl:1
    v_sub_u32 v98, s38, v99
    v_lshrrev_b64 v[52:53], 16, v[52:53]
    v_add_u32_dpp v91, v91, v91 row_shr:4 row_mask:0xf bank_mask:0xf bound_ctrl:1
    v_lshrrev_b64 v[60:61], 16, v[60:61]
    s_mov_b32 s43, 0
    v_add_u32_dpp v91, v91, v91 row_shr:8 row_mask:0xf bank_mask:0xf bound_ctrl:1
    s_nop 1
    v_add_u32_dpp v91, v91, v91 row_bcast:15 row_mask:0xa bank_mask:0xf
    s_nop 1
    v_add_u32_dpp v91, v91, v91 row_bcast:31 row_mask:0xc bank_mask:0xf
    v_add_u32 v98, v98, v91
    v_readlane_b32 s37, v91, 63
    s_cbranch_vccnz L2_xo81
L2_xp81:
    buffer_load_dwordx4 v[112:115], v3, s[16:19], s40 offen offset:1024
    s_waitcnt lgkmcnt(0)
    v_cmpx_ne_u64 vcc, v[74:75], v[70:71]
    s_and_b64 s[82:83], vcc, s[80:81]
    s_cbranch_scc1 L2_c82
L2_d82:
    v_mov_b64 v[84:85], v[70:71]
    v_mov_b32 v7, v95
    v_mov_b64 v[86:87], v[74:75]
    s_mov_b64 exec, -1
    s_or_b64 s[80:81], s[80:81], vcc
    v_cmpx_ne_u64 vcc, v[72:73], v[68:69]
    s_and_b64 s[82:83], vcc, s[80:81]
    s_cbranch_scc1 L2_c83
L2_d83:
    v_mov_b64 v[84:85], v[68:69]
    v_mov_b32 v7, v94
    v_mov_b64 v[86:87], v[72:73]
    s_mov_b64 exec, -1
    s_or_b64 s[80:81], s[80:81], vcc
    ds_read_b64 v[70:71], v93 offset:65408
    s_and_b64 exec, s[84:85], s[80:81]
    v_mfma_f32_4x4x4_16b_bf16 v[76:79], v[12:13], v[84:85], 0
    v_mov_b32 v92, v7
    s_andn2_b64 s[80:81], s[80:81], s[84:85]
    v_mfma_f32_4x4x4_16b_bf16 v[76:79], v[10:11], v[86:87], v[76:79]
    s_mov_b64 exec, -1
    ds_read_b64 v[68:69], v92 offset:65408
    v_and_b32 v46, 0x80000000, v27
    v_lshrrev_b32 v47, 14, v25
    v_bitop3_b32 v47, v47, v5, v46 bitop3:0xea
    ds_read_b64 v[106:107], v47
    v_bitop3_b32 v95, v25, v5, v46 bitop3:0xea
    v_and_b32 v46, 0x40000000, v27
    v_lshrrev_b32 v47, 14, v24
    v_bitop3_b32 v47, v47, v5, v46 bitop3:0xea
    ds_read_b64 v[104:105], v47
    v_bitop3_b32 v94, v24, v5, v46 bitop3:0xea
    s_waitcnt lgkmcnt(2)
    v_mfma_f32_4x4x4_16b_bf16 v[80:83], v[10:11], v[70:71], v[80:83]
    v_mfma_f32_4x4x4_16b_bf16 v[76:79], v[10:11], v[68:69], v[76:79]
    v_perm_b32 v15, v25, v26, s47
    v_bitop3_b32 v46, v25, 0.5, -0.5 bitop3:0xa8
    v_perm_b32 v14, v24, v26, s46
    v_bitop3_b32 v47, v24, 0.5, -0.5 bitop3:0xa8
    v_cvt_pk_bf16_f32 v80, v80, v81
    v_cvt_pk_bf16_f32 v81, v82, v83
    ds_wrxchg_rtn_b64 v[74:75], v93, v[80:81] offset:65408
    v_cvt_pk_bf16_f32 v76, v76, v77
    v_cvt_pk_bf16_f32 v77, v78, v79
    ds_wrxchg_rtn_b64 v[72:73], v92, v[76:77] offset:65408
    s_setprio 1
    s_waitcnt lgkmcnt(2)
    v_mfma_f32_4x4x4_16b_bf16 v[80:83], v[8:9], v[106:107], 0
    v_mfma_f32_4x4x4_16b_bf16 v[76:79], v[8:9], v[104:105], 0
    v_bitop3_b32 v15, v6, v15, v46 bitop3:0xca
    v_bitop3_b32 v14, v6, v14, v47 bitop3:0xca
    s_nop 1
    v_pk_mul_f32 v[80:81], v[80:81], v[14:15] op_sel:[0,1] op_sel_hi:[1,1]
    v_pk_mul_f32 v[82:83], v[82:83], v[14:15] op_sel:[0,1] op_sel_hi:[1,1]
    v_pk_mul_f32 v[76:77], v[76:77], v[14:15] op_sel:[0,0] op_sel_hi:[1,0]
    v_pk_mul_f32 v[78:79], v[78:79], v[14:15] op_sel:[0,0] op_sel_hi:[1,0]
    v_and_b32 v47, 0x0fffffff, v41
    v_mov_b32 v27, v41
    buffer_load_dwordx2 v[22:23], v47, s[8:11], 0 offen
    buffer_load_dwordx3 v[24:26], v47, s[8:11], 0 offen offset:8
    s_waitcnt lgkmcnt(0)
    v_cmpx_ne_u64 vcc, v[74:75], v[70:71]
    s_and_b64 s[82:83], vcc, s[80:81]
    s_cbranch_scc1 L2_c84
L2_d84:
    v_mov_b64 v[84:85], v[70:71]
    v_mov_b32 v7, v93
    v_mov_b64 v[86:87], v[74:75]
    s_mov_b64 exec, -1
    s_or_b64 s[80:81], s[80:81], vcc
    v_cmpx_ne_u64 vcc, v[72:73], v[68:69]
    s_and_b64 s[82:83], vcc, s[80:81]
    s_cbranch_scc1 L2_c85
L2_d85:
    v_mov_b64 v[84:85], v[68:69]
    v_mov_b32 v7, v92
    v_mov_b64 v[86:87], v[72:73]
    s_mov_b64 exec, -1
    s_or_b64 s[80:81], s[80:81], vcc
    ds_read_b64 v[70:71], v95 offset:65408
    ds_read_b64 v[68:69], v94 offset:65408
    s_waitcnt vmcnt(11)
    v_and_b32 v46, 0x20000000, v33
    v_lshrrev_b32 v47, 14, v29
    v_bitop3_b32 v47, v47, v5, v46 bitop3:0xea
    ds_read_b64 v[102:103], v47
    v_bitop3_b32 v93, v29, v5, v46 bitop3:0xea
    v_and_b32 v46, 0x10000000, v33
    v_lshrrev_b32 v47, 14, v28
    v_bitop3_b32 v47, v47, v5, v46 bitop3:0xea
    ds_read_b64 v[100:101], v47
    v_bitop3_b32 v92, v28, v5, v46 bitop3:0xea
    s_waitcnt lgkmcnt(2)
    v_mfma_f32_4x4x4_16b_bf16 v[80:83], v[10:11], v[70:71], v[80:83]
    v_mfma_f32_4x4x4_16b_bf16 v[76:79], v[10:11], v[68:69], v[76:79]
    v_perm_b32 v15, v29, v32, s45
    v_bitop3_b32 v46, v29, 0.5, -0.5 bitop3:0xa8
    v_perm_b32 v14, v28, v32, s44
    v_bitop3_b32 v47, v28, 0.5, -0.5 bitop3:0xa8
    v_cvt_pk_bf16_f32 v80, v80, v81
    v_cvt_pk_bf16_f32 v81, v82, v83
    ds_wrxchg_rtn_b64 v[74:75], v95, v[80:81] offset:65408
    v_cvt_pk_bf16_f32 v76, v76, v77
    v_cvt_pk_bf16_f32 v77, v78, v79
    ds_wrxchg_rtn_b64 v[72:73], v94, v[76:77] offset:65408
    s_waitcnt lgkmcnt(2)
    v_mfma_f32_4x4x4_16b_bf16 v[80:83], v[8:9], v[102:103], 0
    v_mfma_f32_4x4x4_16b_bf16 v[76:79], v[8:9], v[100:101], 0
    v_bitop3_b32 v15, v6, v15, v46 bitop3:0xca
    v_bitop3_b32 v14, v6, v14, v47 bitop3:0xca
    v_cmp_lt_u32 s[84:85], v5, v92
    s_nop 0
    v_pk_mul_f32 v[80:81], v[80:81], v[14:15] op_sel:[0,1] op_sel_hi:[1,1]
    v_pk_mul_f32 v[82:83], v[82:83], v[14:15] op_sel:[0,1] op_sel_hi:[1,1]
    v_pk_mul_f32 v[76:77], v[76:77], v[14:15] op_sel:[0,0] op_sel_hi:[1,0]
    v_pk_mul_f32 v[78:79], v[78:79], v[14:15] op_sel:[0,0] op_sel_hi:[1,0]
    s_waitcnt lgkmcnt(0)
    v_cmpx_ne_u64 vcc, v[74:75], v[70:71]
    s_and_b64 s[82:83], vcc, s[80:81]
    s_cbranch_scc1 L2_c86
L2_d86:
    v_mov_b64 v[84:85], v[70:71]
    v_mov_b32 v7, v95
    v_mov_b64 v[86:87], v[74:75]
    s_mov_b64 exec, -1
    s_or_b64 s[80:81], s[80:81], vcc
    v_cmpx_ne_u64 vcc, v[72:73], v[68:69]
    s_and_b64 s[82:83], vcc, s[80:81]
    s_cbranch_scc1 L2_c87
L2_d87:
    v_mov_b64 v[84:85], v[68:69]
    v_mov_b32 v7, v94
    v_mov_b64 v[86:87], v[72:73]
    s_mov_b64 exec, -1
    s_or_b64 s[80:81], s[80:81], vcc
    ds_read_b64 v[70:71], v93 offset:65408
    s_and_b64 exec, s[84:85], s[80:81]
    v_mfma_f32_4x4x4_16b_bf16 v[76:79], v[12:13], v[84:85], 0
    v_mov_b32 v92, v7
    s_andn2_b64 s[80:81], s[80:81], s[84:85]
    v_mfma_f32_4x4x4_16b_bf16 v[76:79], v[10:11], v[86:87], v[76:79]
    s_mov_b64 exec, -1
    ds_read_b64 v[68:69], v92 offset:65408
    v_and_b32 v46, 0x80000000, v33
    v_lshrrev_b32 v47, 14, v31
    v_bitop3_b32 v47, v47, v5, v46 bitop3:0xea
    ds_read_b64 v[106:107], v47
    v_bitop3_b32 v95, v31, v5, v46 bitop3:0xea
    v_and_b32 v46, 0x40000000, v33
    v_lshrrev_b32 v47, 14, v30
    v_bitop3_b32 v47, v47, v5, v46 bitop3:0xea
    ds_read_b64 v[104:105], v47
    v_bitop3_b32 v94, v30, v5, v46 bitop3:0xea
    s_waitcnt lgkmcnt(2)
    v_mfma_f32_4x4x4_16b_bf16 v[80:83], v[10:11], v[70:71], v[80:83]
    v_mfma_f32_4x4x4_16b_bf16 v[76:79], v[10:11], v[68:69], v[76:79]
    v_perm_b32 v15, v31, v32, s47
    v_bitop3_b32 v46, v31, 0.5, -0.5 bitop3:0xa8
    v_perm_b32 v14, v30, v32, s46
    v_bitop3_b32 v47, v30, 0.5, -0.5 bitop3:0xa8
    v_cvt_pk_bf16_f32 v80, v80, v81
    v_cvt_pk_bf16_f32 v81, v82, v83
    ds_wrxchg_rtn_b64 v[74:75], v93, v[80:81] offset:65408
    v_cvt_pk_bf16_f32 v76, v76, v77
    v_cvt_pk_bf16_f32 v77, v78, v79
    ds_wrxchg_rtn_b64 v[72:73], v92, v[76:77] offset:65408
    s_setprio 0
    s_waitcnt lgkmcnt(2)
    v_mfma_f32_4x4x4_16b_bf16 v[80:83], v[8:9], v[106:107], 0
    v_mfma_f32_4x4x4_16b_bf16 v[76:79], v[8:9], v[104:105], 0
    v_bitop3_b32 v15, v6, v15, v46 bitop3:0xca
    v_bitop3_b32 v14, v6, v14, v47 bitop3:0xca
    s_nop 1
    v_pk_mul_f32 v[80:81], v[80:81], v[14:15] op_sel:[0,1] op_sel_hi:[1,1]
    v_pk_mul_f32 v[82:83], v[82:83], v[14:15] op_sel:[0,1] op_sel_hi:[1,1]
    v_pk_mul_f32 v[76:77], v[76:77], v[14:15] op_sel:[0,0] op_sel_hi:[1,0]
    v_pk_mul_f32 v[78:79], v[78:79], v[14:15] op_sel:[0,0] op_sel_hi:[1,0]
    s_add_u32 s40, s40, 0x50000
    v_and_b32 v47, 0x0fffffff, v42
    v_mov_b32 v33, v42
    buffer_load_dwordx2 v[28:29], v47, s[8:11], 0 offen
    buffer_load_dwordx3 v[30:32], v47, s[8:11], 0 offen offset:8
    s_waitcnt lgkmcnt(0)
    v_cmpx_ne_u64 vcc, v[74:75], v[70:71]
    s_and_b64 s[82:83], vcc, s[80:81]
    s_cbranch_scc1 L2_c88
L2_d88:
    v_mov_b64 v[84:85], v[70:71]
    v_mov_b32 v7, v93
    v_mov_b64 v[86:87], v[74:75]
    s_mov_b64 exec, -1
    s_or_b64 s[80:81], s[80:81], vcc
    v_cmpx_ne_u64 vcc, v[72:73], v[68:69]
    s_and_b64 s[82:83], vcc, s[80:81]
    s_cbranch_scc1 L2_c89
L2_d89:
    v_mov_b64 v[84:85], v[68:69]
    v_mov_b32 v7, v92
    v_mov_b64 v[86:87], v[72:73]
    s_mov_b64 exec, -1
    s_or_b64 s[80:81], s[80:81], vcc
    ds_read_b64 v[70:71], v95 offset:65408
    ds_read_b64 v[68:69], v94 offset:65408
    s_waitcnt vmcnt(8)
    v_and_b32 v46, 0x20000000, v39
    v_lshrrev_b32 v47, 14, v35
    v_bitop3_b32 v47, v47, v5, v46 bitop3:0xea
    ds_read_b64 v[102:103], v47
    v_bitop3_b32 v93, v35, v5, v46 bitop3:0xea
    v_and_b32 v46, 0x10000000, v39
    v_lshrrev_b32 v47, 14, v34
    v_bitop3_b32 v47, v47, v5, v46 bitop3:0xea
    ds_read_b64 v[100:101], v47
    v_bitop3_b32 v92, v34, v5, v46 bitop3:0xea
    v_and_b32 v46, 0x80000000, v39
    v_lshrrev_b32 v47, 14, v37
    v_bitop3_b32 v47, v47, v5, v46 bitop3:0xea
    ds_read_b64 v[106:107], v47
    v_and_b32 v46, 0x40000000, v39
    v_lshrrev_b32 v47, 14, v36
    v_bitop3_b32 v47, v47, v5, v46 bitop3:0xea
    ds_read_b64 v[104:105], v47
    s_waitcnt lgkmcnt(4)
    v_mfma_f32_4x4x4_16b_bf16 v[80:83], v[10:11], v[70:71], v[80:83]
    v_mfma_f32_4x4x4_16b_bf16 v[76:79], v[10:11], v[68:69], v[76:79]
    v_perm_b32 v15, v35, v38, s45
    v_bitop3_b32 v46, v35, 0.5, -0.5 bitop3:0xa8
    v_perm_b32 v14, v34, v38, s44
    v_bitop3_b32 v47, v34, 0.5, -0.5 bitop3:0xa8
    v_cvt_pk_bf16_f32 v80, v80, v81
    v_cvt_pk_bf16_f32 v81, v82, v83
    ds_wrxchg_rtn_b64 v[74:75], v95, v[80:81] offset:65408
    v_cvt_pk_bf16_f32 v76, v76, v77
    v_cvt_pk_bf16_f32 v77, v78, v79
    ds_wrxchg_rtn_b64 v[72:73], v94, v[76:77] offset:65408
    s_waitcnt lgkmcnt(2)
    s_barrier
    s_setprio 3
    s_mov_b32 m0, s69
    s_nop 0
    ds_write_addtid_b32 v116 offset:32768
    ds_write_addtid_b32 v117 offset:33024
    ds_write_addtid_b32 v118 offset:33280
    ds_write_addtid_b32 v119 offset:33536
    buffer_load_dwordx4 v[116:119], v3, s[16:19], s40 offen offset:2048
    ds_write_addtid_b32 v120 offset:33792
    ds_write_addtid_b32 v121 offset:34048
    ds_write_addtid_b32 v122 offset:34304
    ds_write_addtid_b32 v123 offset:34560
    buffer_load_dwordx4 v[120:123], v3, s[16:19], s40 offen offset:3072
    v_mfma_f32_4x4x4_16b_bf16 v[80:83], v[8:9], v[102:103], 0
    v_mfma_f32_4x4x4_16b_bf16 v[76:79], v[8:9], v[100:101], 0
    v_bitop3_b32 v15, v6, v15, v46 bitop3:0xca
    v_bitop3_b32 v14, v6, v14, v47 bitop3:0xca
    v_cmp_lt_u32 s[84:85], v5, v92
    s_nop 0
    v_pk_mul_f32 v[80:81], v[80:81], v[14:15] op_sel:[0,1] op_sel_hi:[1,1]
    v_pk_mul_f32 v[82:83], v[82:83], v[14:15] op_sel:[0,1] op_sel_hi:[1,1]
    v_pk_mul_f32 v[76:77], v[76:77], v[14:15] op_sel:[0,0] op_sel_hi:[1,0]
    v_pk_mul_f32 v[78:79], v[78:79], v[14:15] op_sel:[0,0] op_sel_hi:[1,0]
    v_mov_b32 v44, v43
    s_cmp_gt_u32 s37, 1024
    s_cbranch_scc1 L2_xs90
    s_cmp_lg_u32 s43, 0
    s_cbranch_scc1 L2_xa90
L2_xb90:
    v_lshlrev_b32 v89, 16, v96
    v_add_u32 v90, 60, v97
    v_bitop3_b32 v90, v89, v45, v90 bitop3:0x6a
    ds_write_b32 v98, v90 offset:12
    v_lshlrev_b32 v89, 20, v96
    v_add_u32 v90, 40, v97
    v_bitop3_b32 v90, v89, v45, v90 bitop3:0x6a
    ds_write_b32 v98, v90 offset:8
    v_lshlrev_b32 v89, 24, v96
    v_add_u32 v90, 20, v97
    v_bitop3_b32 v90, v89, v45, v90 bitop3:0x6a
    ds_write_b32 v98, v90 offset:4
    v_lshlrev_b32 v89, 28, v96
    v_bitop3_b32 v90, v89, v45, v97 bitop3:0x6a
    ds_write_b32 v98, v90 offset:0
    v_mov_b32_dpp v91, v64 quad_perm:[1,1,1,1] row_mask:0xf bank_mask:0xf
    v_and_b32 v89, 3, v91
    v_and_b32 v97, 0xfffc, v91
    v_sub_u16_dpp v88, v64, v91 quad_perm:[3,3,3,3] row_mask:0xf bank_mask:0xf
    v_mad_u32_u24 v97, v97, 5, v4
    v_add_u32 v99, v88, v89
    v_bfm_b32 v96, v88, v89
    v_cmp_lt_u32 s[58:59], 16, v99
    v_lshlrev_b32 v89, v1, v96
    v_and_b32 v89, v45, v89
    v_cmp_ne_u32 vcc, 0, v89
    v_xor_b32 v90, v97, v89
    s_add_u32 s3, s37, s38
    v_mbcnt_lo_u32_b32 v98, vcc_lo, 0
    v_mbcnt_hi_u32_b32 v98, vcc_hi, v98
    s_bcnt1_i32_b64 s41, vcc
    v_lshl_add_u32 v98, v98, 2, s3
    s_mov_b64 exec, vcc
    ds_write_b32 v98, v90
    s_mov_b64 exec, -1
    s_lshl2_add_u32 s37, s41, s37
    s_cmp_lg_u64 s[58:59], 0
    s_cbranch_scc1 L2_xe90
L2_xr90:
    v_add_u32 v98, s37, v0
    v_mov_b32 v90, -1
    ds_write_b32 v98, v90
    ds_read2st64_b32 v[40:41], v0 offset0:0 offset1:1
    ds_read2st64_b32 v[42:43], v0 offset0:2 offset1:3
    s_sub_u32 s3, s37, 768
    s_cmp_gt_u32 s3, 256
    s_cbranch_scc1 L2_xf90
L2_xg90:
    s_setprio 2
    ds_write_addtid_b32 v124 offset:34816
    ds_write_addtid_b32 v125 offset:35072
    ds_write_addtid_b32 v126 offset:35328
    ds_write_addtid_b32 v127 offset:35584
    s_add_u32 s3, s40, 4096
    buffer_load_dwordx4 v[124:127], v3, s[16:19], s3 offen
    s_waitcnt lgkmcnt(14)
    v_cmpx_ne_u64 vcc, v[74:75], v[70:71]
    s_and_b64 s[82:83], vcc, s[80:81]
    s_cbranch_scc1 L2_c91
L2_d91:
    v_mov_b64 v[84:85], v[70:71]
    v_mov_b32 v7, v95
    v_mov_b64 v[86:87], v[74:75]
    s_mov_b64 exec, -1
    s_or_b64 s[80:81], s[80:81], vcc
    v_cmpx_ne_u64 vcc, v[72:73], v[68:69]
    s_and_b64 s[82:83], vcc, s[80:81]
    s_cbranch_scc1 L2_c92
L2_d92:
    v_mov_b64 v[84:85], v[68:69]
    v_mov_b32 v7, v94
    v_mov_b64 v[86:87], v[72:73]
    s_mov_b64 exec, -1
    s_or_b64 s[80:81], s[80:81], vcc
    ds_read_b64 v[70:71], v93 offset:65408
    s_and_b64 exec, s[84:85], s[80:81]
    v_mfma_f32_4x4x4_16b_bf16 v[76:79], v[12:13], v[84:85], 0
    v_mov_b32 v92, v7
    s_andn2_b64 s[80:81], s[80:81], s[84:85]
    v_mfma_f32_4x4x4_16b_bf16 v[76:79], v[10:11], v[86:87], v[76:79]
    s_mov_b64 exec, -1
    ds_read_b64 v[68:69], v92 offset:65408
    s_setprio 1
    s_waitcnt vmcnt(10)
    s_mov_b32 m0, s38
    s_nop 0
    ds_write_addtid_b32 v108 offset:0
    ds_write_addtid_b32 v109 offset:256
    ds_write_addtid_b32 v110 offset:512
    ds_write_addtid_b32 v111 offset:768
    s_waitcnt lgkmcnt(4)
    v_mfma_f32_4x4x4_16b_bf16 v[80:83], v[10:11], v[70:71], v[80:83]
    v_mfma_f32_4x4x4_16b_bf16 v[76:79], v[10:11], v[68:69], v[76:79]
    v_and_b32 v46, 0x40000000, v39
    v_bitop3_b32 v94, v36, v5, v46 bitop3:0xea
    v_and_b32 v46, 0x80000000, v39
    v_bitop3_b32 v95, v37, v5, v46 bitop3:0xea
    v_perm_b32 v15, v37, v38, s47
    v_bitop3_b32 v46, v37, 0.5, -0.5 bitop3:0xa8
    v_perm_b32 v14, v36, v38, s46
    v_bitop3_b32 v47, v36, 0.5, -0.5 bitop3:0xa8
    v_cvt_pk_bf16_f32 v80, v80, v81
    v_cvt_pk_bf16_f32 v81, v82, v83
    ds_wrxchg_rtn_b64 v[74:75], v93, v[80:81] offset:65408
    v_cvt_pk_bf16_f32 v76, v76, v77
    v_cvt_pk_bf16_f32 v77, v78, v79
    ds_wrxchg_rtn_b64 v[72:73], v92, v[76:77] offset:65408
    s_setprio 0
    s_waitcnt vmcnt(7)
    ds_write_addtid_b32 v112 offset:1024
    ds_write_addtid_b32 v113 offset:1280
    ds_write_addtid_b32 v114 offset:1536
    ds_write_addtid_b32 v115 offset:1792
    v_mfma_f32_4x4x4_16b_bf16 v[80:83], v[8:9], v[106:107], 0
    v_mfma_f32_4x4x4_16b_bf16 v[76:79], v[8:9], v[104:105], 0
    v_bitop3_b32 v15, v6, v15, v46 bitop3:0xca
    v_bitop3_b32 v14, v6, v14, v47 bitop3:0xca
    s_nop 1
    v_pk_mul_f32 v[80:81], v[80:81], v[14:15] op_sel:[0,1] op_sel_hi:[1,1]
    v_pk_mul_f32 v[82:83], v[82:83], v[14:15] op_sel:[0,1] op_sel_hi:[1,1]
    v_pk_mul_f32 v[76:77], v[76:77], v[14:15] op_sel:[0,0] op_sel_hi:[1,0]
    v_pk_mul_f32 v[78:79], v[78:79], v[14:15] op_sel:[0,0] op_sel_hi:[1,0]
    s_add_u32 s42, s42, 1
    s_waitcnt lgkmcnt(0)
    s_barrier
    s_bitcmp1_b32 s36, s42
    s_cbranch_scc1 L2_slow
L2_ret5:
    s_setprio 3
    v_and_b32 v47, 0x0fffffff, v44
    v_mov_b32 v39, v44
    buffer_load_dwordx2 v[34:35], v47, s[8:11], 0 offen
    buffer_load_dwordx3 v[36:38], v47, s[8:11], 0 offen offset:8
    v_cmpx_ne_u64 vcc, v[74:75], v[70:71]
    s_and_b64 s[82:83], vcc, s[80:81]
    s_cbranch_scc1 L2_c93
L2_d93:
    v_mov_b64 v[84:85], v[70:71]
    v_mov_b32 v7, v93
    v_mov_b64 v[86:87], v[74:75]
    s_mov_b64 exec, -1
    s_or_b64 s[80:81], s[80:81], vcc
    v_cmpx_ne_u64 vcc, v[72:73], v[68:69]
    s_and_b64 s[82:83], vcc, s[80:81]
    s_cbranch_scc1 L2_c94
L2_d94:
    v_mov_b64 v[84:85], v[68:69]
    v_mov_b32 v7, v92
    v_mov_b64 v[86:87], v[72:73]
    s_mov_b64 exec, -1
    s_or_b64 s[80:81], s[80:81], vcc
    ds_read_b64 v[70:71], v95 offset:65408
    ds_read_b64 v[68:69], v94 offset:65408
    v_and_b32 v46, 0x20000000, v21
    v_lshrrev_b32 v47, 14, v17
    v_bitop3_b32 v47, v47, v5, v46 bitop3:0xea
    ds_read_b64 v[102:103], v47
    v_bitop3_b32 v93, v17, v5, v46 bitop3:0xea
    v_and_b32 v46, 0x10000000, v21
    v_lshrrev_b32 v47, 14, v16
    v_bitop3_b32 v47, v47, v5, v46 bitop3:0xea
    ds_read_b64 v[100:101], v47
    v_bitop3_b32 v92, v16, v5, v46 bitop3:0xea
    s_waitcnt lgkmcnt(2)
    v_mfma_f32_4x4x4_16b_bf16 v[80:83], v[10:11], v[70:71], v[80:83]
    v_mfma_f32_4x4x4_16b_bf16 v[76:79], v[10:11], v[68:69], v[76:79]
    v_perm_b32 v15, v17, v20, s45
    v_bitop3_b32 v46, v17, 0.5, -0.5 bitop3:0xa8
    v_perm_b32 v14, v16, v20, s44
    v_bitop3_b32 v47, v16, 0.5, -0.5 bitop3:0xa8
    v_cvt_pk_bf16_f32 v80, v80, v81
    v_cvt_pk_bf16_f32 v81, v82, v83
    ds_wrxchg_rtn_b64 v[74:75], v95, v[80:81] offset:65408
    v_cvt_pk_bf16_f32 v76, v76, v77
    v_cvt_pk_bf16_f32 v77, v78, v79
    ds_wrxchg_rtn_b64 v[72:73], v94, v[76:77] offset:65408
    s_waitcnt lgkmcnt(2)
    v_mfma_f32_4x4x4_16b_bf16 v[80:83], v[8:9], v[102:103], 0
    v_mfma_f32_4x4x4_16b_bf16 v[76:79], v[8:9], v[100:101], 0
    v_bitop3_b32 v15, v6, v15, v46 bitop3:0xca
    v_bitop3_b32 v14, v6, v14, v47 bitop3:0xca
    v_cmp_lt_u32 s[84:85], v5, v92
    s_nop 0
    v_pk_mul_f32 v[80:81], v[80:81], v[14:15] op_sel:[0,1] op_sel_hi:[1,1]
    v_pk_mul_f32 v[82:83], v[82:83], v[14:15] op_sel:[0,1] op_sel_hi:[1,1]
    v_pk_mul_f32 v[76:77], v[76:77], v[14:15] op_sel:[0,0] op_sel_hi:[1,0]
    v_pk_mul_f32 v[78:79], v[78:79], v[14:15] op_sel:[0,0] op_sel_hi:[1,0]
    buffer_load_dwordx4 v[108:111], v3, s[16:19], s40 offen offset:0
    s_waitcnt lgkmcnt(0)
    v_cmpx_ne_u64 vcc, v[74:75], v[70:71]
    s_and_b64 s[82:83], vcc, s[80:81]
    s_cbranch_scc1 L2_c95
L2_d95:
    v_mov_b64 v[84:85], v[70:71]
    v_mov_b32 v7, v95
    v_mov_b64 v[86:87], v[74:75]
    s_mov_b64 exec, -1
    s_or_b64 s[80:81], s[80:81], vcc
    v_cmpx_ne_u64 vcc, v[72:73], v[68:69]
    s_and_b64 s[82:83], vcc, s[80:81]
    s_cbranch_scc1 L2_c96
L2_d96:
    v_mov_b64 v[84:85], v[68:69]
    v_mov_b32 v7, v94
    v_mov_b64 v[86:87], v[72:73]
    s_mov_b64 exec, -1
    s_or_b64 s[80:81], s[80:81], vcc
    ds_read_b64 v[70:71], v93 offset:65408
    s_and_b64 exec, s[84:85], s[80:81]
    v_mfma_f32_4x4x4_16b_bf16 v[76:79], v[12:13], v[84:85], 0
    v_mov_b32 v92, v7
    s_andn2_b64 s[80:81], s[80:81], s[84:85]
    v_mfma_f32_4x4x4_16b_bf16 v[76:79], v[10:11], v[86:87], v[76:79]
    s_mov_b64 exec, -1
    ds_read_b64 v[68:69], v92 offset:65408
    v_and_b32 v46, 0x80000000, v21
    v_lshrrev_b32 v47, 14, v19
    v_bitop3_b32 v47, v47, v5, v46 bitop3:0xea
    ds_read_b64 v[106:107], v47
    v_bitop3_b32 v95, v19, v5, v46 bitop3:0xea
    v_and_b32 v46, 0x40000000, v21
    v_lshrrev_b32 v47, 14, v18
    v_bitop3_b32 v47, v47, v5, v46 bitop3:0xea
    ds_read_b64 v[104:105], v47
    v_bitop3_b32 v94, v18, v5, v46 bitop3:0xea
    s_waitcnt lgkmcnt(2)
    v_mfma_f32_4x4x4_16b_bf16 v[80:83], v[10:11], v[70:71], v[80:83]
    v_mfma_f32_4x4x4_16b_bf16 v[76:79], v[10:11], v[68:69], v[76:79]
    v_perm_b32 v15, v19, v20, s47
    v_bitop3_b32 v46, v19, 0.5, -0.5 bitop3:0xa8
    v_perm_b32 v14, v18, v20, s46
    v_bitop3_b32 v47, v18, 0.5, -0.5 bitop3:0xa8
    v_cvt_pk_bf16_f32 v80, v80, v81
    v_cvt_pk_bf16_f32 v81, v82, v83
    ds_wrxchg_rtn_b64 v[74:75], v93, v[80:81] offset:65408
    v_cvt_pk_bf16_f32 v76, v76, v77
    v_cvt_pk_bf16_f32 v77, v78, v79
    ds_wrxchg_rtn_b64 v[72:73], v92, v[76:77] offset:65408
    s_setprio 2
    s_waitcnt lgkmcnt(2)
    v_mfma_f32_4x4x4_16b_bf16 v[80:83], v[8:9], v[106:107], 0
    v_mfma_f32_4x4x4_16b_bf16 v[76:79], v[8:9], v[104:105], 0
    v_bitop3_b32 v15, v6, v15, v46 bitop3:0xca
    v_bitop3_b32 v14, v6, v14, v47 bitop3:0xca
    s_nop 1
    v_pk_mul_f32 v[80:81], v[80:81], v[14:15] op_sel:[0,1] op_sel_hi:[1,1]
    v_pk_mul_f32 v[82:83], v[82:83], v[14:15] op_sel:[0,1] op_sel_hi:[1,1]
    v_pk_mul_f32 v[76:77], v[76:77], v[14:15] op_sel:[0,0] op_sel_hi:[1,0]
    v_pk_mul_f32 v[78:79], v[78:79], v[14:15] op_sel:[0,0] op_sel_hi:[1,0]
    v_and_b32 v47, 0x0fffffff, v40
    v_mov_b32 v21, v40
    buffer_load_dwordx2 v[16:17], v47, s[8:11], 0 offen
    buffer_load_dwordx3 v[18:20], v47, s[8:11], 0 offen offset:8
    s_waitcnt lgkmcnt(0)
    v_cmpx_ne_u64 vcc, v[74:75], v[70:71]
    s_and_b64 s[82:83], vcc, s[80:81]
    s_cbranch_scc1 L2_c97
L2_d97:
    v_mov_b64 v[84:85], v[70:71]
    v_mov_b32 v7, v93
    v_mov_b64 v[86:87], v[74:75]
    s_mov_b64 exec, -1
    s_or_b64 s[80:81], s[80:81], vcc
    v_cmpx_ne_u64 vcc, v[72:73], v[68:69]
    s_and_b64 s[82:83], vcc, s[80:81]
    s_cbranch_scc1 L2_c98
L2_d98:
    v_mov_b64 v[84:85], v[68:69]
    v_mov_b32 v7, v92
    v_mov_b64 v[86:87], v[72:73]
    s_mov_b64 exec, -1
    s_or_b64 s[80:81], s[80:81], vcc
    ds_read_b64 v[70:71], v95 offset:65408
    ds_read_b64 v[68:69], v94 offset:65408
    s_waitcnt vmcnt(10)
    v_and_b32 v46, 0x20000000, v27
    v_lshrrev_b32 v47, 14, v23
    v_bitop3_b32 v47, v47, v5, v46 bitop3:0xea
    ds_read_b64 v[102:103], v47
    v_bitop3_b32 v93, v23, v5, v46 bitop3:0xea
    v_and_b32 v46, 0x10000000, v27
    v_lshrrev_b32 v47, 14, v22
    v_bitop3_b32 v47, v47, v5, v46 bitop3:0xea
    ds_read_b64 v[100:101], v47
    v_bitop3_b32 v92, v22, v5, v46 bitop3:0xea
    s_waitcnt lgkmcnt(2)
    v_mfma_f32_4x4x4_16b_bf16 v[80:83], v[10:11], v[70:71], v[80:83]
    v_mfma_f32_4x4x4_16b_bf16 v[76:79], v[10:11], v[68:69], v[76:79]
    v_perm_b32 v15, v23, v26, s45
    v_bitop3_b32 v46, v23, 0.5, -0.5 bitop3:0xa8
    v_perm_b32 v14, v22, v26, s44
    v_bitop3_b32 v47, v22, 0.5, -0.5 bitop3:0xa8
    v_cvt_pk_bf16_f32 v80, v80, v81
    v_cvt_pk_bf16_f32 v81, v82, v83
    ds_wrxchg_rtn_b64 v[74:75], v95, v[80:81] offset:65408
    v_cvt_pk_bf16_f32 v76, v76, v77
    v_cvt_pk_bf16_f32 v77, v78, v79
    ds_wrxchg_rtn_b64 v[72:73], v94, v[76:77] offset:65408
    s_waitcnt lgkmcnt(2)
    v_mfma_f32_4x4x4_16b_bf16 v[80:83], v[8:9], v[102:103], 0
    v_mfma_f32_4x4x4_16b_bf16 v[76:79], v[8:9], v[100:101], 0
    v_bitop3_b32 v15, v6, v15, v46 bitop3:0xca
    v_bitop3_b32 v14, v6, v14, v47 bitop3:0xca
    v_cmp_lt_u32 s[84:85], v5, v92
    s_nop 0
    v_pk_mul_f32 v[80:81], v[80:81], v[14:15] op_sel:[0,1] op_sel_hi:[1,1]
    v_pk_mul_f32 v[82:83], v[82:83], v[14:15] op_sel:[0,1] op_sel_hi:[1,1]
    v_pk_mul_f32 v[76:77], v[76:77], v[14:15] op_sel:[0,0] op_sel_hi:[1,0]
    v_pk_mul_f32 v[78:79], v[78:79], v[14:15] op_sel:[0,0] op_sel_hi:[1,0]
    v_sub_u16 v88, v62, v54
    v_and_b32 v89, 3, v54
    v_add3_u32 v99, v88, v89, 3
    v_and_b32 v99, -4, v99
    v_max_u32 v99, 4, v99
    v_and_b32 v97, 0xfffc, v54
    v_bfm_b32 v96, v88, v89
    v_add_u32_dpp v91, v99, v99 row_shr:1 row_mask:0xf bank_mask:0xf bound_ctrl:1
    v_mad_u32_u24 v97, v97, 5, v2
    v_cmp_lt_u32 vcc, 16, v99
    v_add_u32_dpp v91, v91, v91 row_shr:2 row_mask:0xf bank_mask:0xf bound_ctrl:1
    v_sub_u32 v98, s38, v99
    v_lshrrev_b64 v[54:55], 16, v[54:55]
    v_add_u32_dpp v91, v91, v91 row_shr:4 row_mask:0xf bank_mask:0xf bound_ctrl:1
    v_lshrrev_b64 v[62:63], 16, v[62:63]
    s_mov_b32 s43, 0
    v_add_u32_dpp v91, v91, v91 row_shr:8 row_mask:0xf bank_mask:0xf bound_ctrl:1
    s_nop 1
    v_add_u32_dpp v91, v91, v91 row_bcast:15 row_mask:0xa bank_mask:0xf
    s_nop 1
    v_add_u32_dpp v91, v91, v91 row_bcast:31 row_mask:0xc bank_mask:0xf
    v_add_u32 v98, v98, v91
    v_readlane_b32 s37, v91, 63
    s_cbranch_vccnz L2_xo99
L2_xp99:
    buffer_load_dwordx4 v[112:115], v3, s[16:19], s40 offen offset:1024
    s_waitcnt lgkmcnt(0)
    v_cmpx_ne_u64 vcc, v[74:75], v[70:71]
    s_and_b64 s[82:83], vcc, s[80:81]
    s_cbranch_scc1 L2_c100
L2_d100:
    v_mov_b64 v[84:85], v[70:71]
    v_mov_b32 v7, v95
    v_mov_b64 v[86:87], v[74:75]
    s_mov_b64 exec, -1
    s_or_b64 s[80:81], s[80:81], vcc
    v_cmpx_ne_u64 vcc, v[72:73], v[68:69]
    s_and_b64 s[82:83], vcc, s[80:81]
    s_cbranch_scc1 L2_c101
L2_d101:
    v_mov_b64 v[84:85], v[68:69]
    v_mov_b32 v7, v94
    v_mov_b64 v[86:87], v[72:73]
    s_mov_b64 exec, -1
    s_or_b64 s[80:81], s[80:81], vcc
    ds_read_b64 v[70:71], v93 offset:65408
    s_and_b64 exec, s[84:85], s[80:81]
    v_mfma_f32_4x4x4_16b_bf16 v[76:79], v[12:13], v[84:85], 0
    v_mov_b32 v92, v7
    s_andn2_b64 s[80:81], s[80:81], s[84:85]
    v_mfma_f32_4x4x4_16b_bf16 v[76:79], v[10:11], v[86:87], v[76:79]
    s_mov_b64 exec, -1
    ds_read_b64 v[68:69], v92 offset:65408
    v_and_b32 v46, 0x80000000, v27
    v_lshrrev_b32 v47, 14, v25
    v_bitop3_b32 v47, v47, v5, v46 bitop3:0xea
    ds_read_b64 v[106:107], v47
    v_bitop3_b32 v95, v25, v5, v46 bitop3:0xea
    v_and_b32 v46, 0x40000000, v27
    v_lshrrev_b32 v47, 14, v24
    v_bitop3_b32 v47, v47, v5, v46 bitop3:0xea
    ds_read_b64 v[104:105], v47
    v_bitop3_b32 v94, v24, v5, v46 bitop3:0xea
    s_waitcnt lgkmcnt(2)
    v_mfma_f32_4x4x4_16b_bf16 v[80:83], v[10:11], v[70:71], v[80:83]
    v_mfma_f32_4x4x4_16b_bf16 v[76:79], v[10:11], v[68:69], v[76:79]
    v_perm_b32 v15, v25, v26, s47
    v_bitop3_b32 v46, v25, 0.5, -0.5 bitop3:0xa8
    v_perm_b32 v14, v24, v26, s46
    v_bitop3_b32 v47, v24, 0.5, -0.5 bitop3:0xa8
    v_cvt_pk_bf16_f32 v80, v80, v81
    v_cvt_pk_bf16_f32 v81, v82, v83
    ds_wrxchg_rtn_b64 v[74:75], v93, v[80:81] offset:65408
    v_cvt_pk_bf16_f32 v76, v76, v77
    v_cvt_pk_bf16_f32 v77, v78, v79
    ds_wrxchg_rtn_b64 v[72:73], v92, v[76:77] offset:65408
    s_setprio 1
    s_waitcnt lgkmcnt(2)
    v_mfma_f32_4x4x4_16b_bf16 v[80:83], v[8:9], v[106:107], 0
    v_mfma_f32_4x4x4_16b_bf16 v[76:79], v[8:9], v[104:105], 0
    v_bitop3_b32 v15, v6, v15, v46 bitop3:0xca
    v_bitop3_b32 v14, v6, v14, v47 bitop3:0xca
    s_nop 1
    v_pk_mul_f32 v[80:81], v[80:81], v[14:15] op_sel:[0,1] op_sel_hi:[1,1]
    v_pk_mul_f32 v[82:83], v[82:83], v[14:15] op_sel:[0,1] op_sel_hi:[1,1]
    v_pk_mul_f32 v[76:77], v[76:77], v[14:15] op_sel:[0,0] op_sel_hi:[1,0]
    v_pk_mul_f32 v[78:79], v[78:79], v[14:15] op_sel:[0,0] op_sel_hi:[1,0]
    v_and_b32 v47, 0x0fffffff, v41
    v_mov_b32 v27, v41
    buffer_load_dwordx2 v[22:23], v47, s[8:11], 0 offen
    buffer_load_dwordx3 v[24:26], v47, s[8:11], 0 offen offset:8
    s_waitcnt lgkmcnt(0)
    v_cmpx_ne_u64 vcc, v[74:75], v[70:71]
    s_and_b64 s[82:83], vcc, s[80:81]
    s_cbranch_scc1 L2_c102
L2_d102:
    v_mov_b64 v[84:85], v[70:71]
    v_mov_b32 v7, v93
    v_mov_b64 v[86:87], v[74:75]
    s_mov_b64 exec, -1
    s_or_b64 s[80:81], s[80:81], vcc
    v_cmpx_ne_u64 vcc, v[72:73], v[68:69]
    s_and_b64 s[82:83], vcc, s[80:81]
    s_cbranch_scc1 L2_c103
L2_d103:
    v_mov_b64 v[84:85], v[68:69]
    v_mov_b32 v7, v92
    v_mov_b64 v[86:87], v[72:73]
    s_mov_b64 exec, -1
    s_or_b64 s[80:81], s[80:81], vcc
    ds_read_b64 v[70:71], v95 offset:65408
    ds_read_b64 v[68:69], v94 offset:65408
    s_waitcnt vmcnt(11)
    v_and_b32 v46, 0x20000000, v33
    v_lshrrev_b32 v47, 14, v29
    v_bitop3_b32 v47, v47, v5, v46 bitop3:0xea
    ds_read_b64 v[102:103], v47
    v_bitop3_b32 v93, v29, v5, v46 bitop3:0xea
    v_and_b32 v46, 0x10000000, v33
    v_lshrrev_b32 v47, 14, v28
    v_bitop3_b32 v47, v47, v5, v46 bitop3:0xea
    ds_read_b64 v[100:101], v47
    v_bitop3_b32 v92, v28, v5, v46 bitop3:0xea
    s_waitcnt lgkmcnt(2)
    v_mfma_f32_4x4x4_16b_bf16 v[80:83], v[10:11], v[70:71], v[80:83]
    v_mfma_f32_4x4x4_16b_bf16 v[76:79], v[10:11], v[68:69], v[76:79]
    v_perm_b32 v15, v29, v32, s45
    v_bitop3_b32 v46, v29, 0.5, -0.5 bitop3:0xa8
    v_perm_b32 v14, v28, v32, s44
    v_bitop3_b32 v47, v28, 0.5, -0.5 bitop3:0xa8
    v_cvt_pk_bf16_f32 v80, v80, v81
    v_cvt_pk_bf16_f32 v81, v82, v83
    ds_wrxchg_rtn_b64 v[74:75], v95, v[80:81] offset:65408
    v_cvt_pk_bf16_f32 v76, v76, v77
    v_cvt_pk_bf16_f32 v77, v78, v79
    ds_wrxchg_rtn_b64 v[72:73], v94, v[76:77] offset:65408
    s_waitcnt lgkmcnt(2)
    v_mfma_f32_4x4x4_16b_bf16 v[80:83], v[8:9], v[102:103], 0
    v_mfma_f32_4x4x4_16b_bf16 v[76:79], v[8:9], v[100:101], 0
    v_bitop3_b32 v15, v6, v15, v46 bitop3:0xca
    v_bitop3_b32 v14, v6, v14, v47 bitop3:0xca
    v_cmp_lt_u32 s[84:85], v5, v92
    s_nop 0
    v_pk_mul_f32 v[80:81], v[80:81], v[14:15] op_sel:[0,1] op_sel_hi:[1,1]
    v_pk_mul_f32 v[82:83], v[82:83], v[14:15] op_sel:[0,1] op_sel_hi:[1,1]
    v_pk_mul_f32 v[76:77], v[76:77], v[14:15] op_sel:[0,0] op_sel_hi:[1,0]
    v_pk_mul_f32 v[78:79], v[78:79], v[14:15] op_sel:[0,0] op_sel_hi:[1,0]
    s_waitcnt lgkmcnt(0)
    v_cmpx_ne_u64 vcc, v[74:75], v[70:71]
    s_and_b64 s[82:83], vcc, s[80:81]
    s_cbranch_scc1 L2_c104
L2_d104:
    v_mov_b64 v[84:85], v[70:71]
    v_mov_b32 v7, v95
    v_mov_b64 v[86:87], v[74:75]
    s_mov_b64 exec, -1
    s_or_b64 s[80:81], s[80:81], vcc
    v_cmpx_ne_u64 vcc, v[72:73], v[68:69]
    s_and_b64 s[82:83], vcc, s[80:81]
    s_cbranch_scc1 L2_c105
L2_d105:
    v_mov_b64 v[84:85], v[68:69]
    v_mov_b32 v7, v94
    v_mov_b64 v[86:87], v[72:73]
    s_mov_b64 exec, -1
    s_or_b64 s[80:81], s[80:81], vcc
    ds_read_b64 v[70:71], v93 offset:65408
    s_and_b64 exec, s[84:85], s[80:81]
    v_mfma_f32_4x4x4_16b_bf16 v[76:79], v[12:13], v[84:85], 0
    v_mov_b32 v92, v7
    s_andn2_b64 s[80:81], s[80:81], s[84:85]
    v_mfma_f32_4x4x4_16b_bf16 v[76:79], v[10:11], v[86:87], v[76:79]
    s_mov_b64 exec, -1
    ds_read_b64 v[68:69], v92 offset:65408
    v_and_b32 v46, 0x80000000, v33
    v_lshrrev_b32 v47, 14, v31
    v_bitop3_b32 v47, v47, v5, v46 bitop3:0xea
    ds_read_b64 v[106:107], v47
    v_bitop3_b32 v95, v31, v5, v46 bitop3:0xea
    v_and_b32 v46, 0x40000000, v33
    v_lshrrev_b32 v47, 14, v30
    v_bitop3_b32 v47, v47, v5, v46 bitop3:0xea
    ds_read_b64 v[104:105], v47
    v_bitop3_b32 v94, v30, v5, v46 bitop3:0xea
    s_waitcnt lgkmcnt(2)
    v_mfma_f32_4x4x4_16b_bf16 v[80:83], v[10:11], v[70:71], v[80:83]
    v_mfma_f32_4x4x4_16b_bf16 v[76:79], v[10:11], v[68:69], v[76:79]
    v_perm_b32 v15, v31, v32, s47
    v_bitop3_b32 v46, v31, 0.5, -0.5 bitop3:0xa8
    v_perm_b32 v14, v30, v32, s46
    v_bitop3_b32 v47, v30, 0.5, -0.5 bitop3:0xa8
    v_cvt_pk_bf16_f32 v80, v80, v81
    v_cvt_pk_bf16_f32 v81, v82, v83
    ds_wrxchg_rtn_b64 v[74:75], v93, v[80:81] offset:65408
    v_cvt_pk_bf16_f32 v76, v76, v77
    v_cvt_pk_bf16_f32 v77, v78, v79
    ds_wrxchg_rtn_b64 v[72:73], v92, v[76:77] offset:65408
    s_setprio 0
    s_waitcnt lgkmcnt(2)
    v_mfma_f32_4x4x4_16b_bf16 v[80:83], v[8:9], v[106:107], 0
    v_mfma_f32_4x4x4_16b_bf16 v[76:79], v[8:9], v[104:105], 0
    v_bitop3_b32 v15, v6, v15, v46 bitop3:0xca
    v_bitop3_b32 v14, v6, v14, v47 bitop3:0xca
    s_nop 1
    v_pk_mul_f32 v[80:81], v[80:81], v[14:15] op_sel:[0,1] op_sel_hi:[1,1]
    v_pk_mul_f32 v[82:83], v[82:83], v[14:15] op_sel:[0,1] op_sel_hi:[1,1]
    v_pk_mul_f32 v[76:77], v[76:77], v[14:15] op_sel:[0,0] op_sel_hi:[1,0]
    v_pk_mul_f32 v[78:79], v[78:79], v[14:15] op_sel:[0,0] op_sel_hi:[1,0]
    s_add_u32 s40, s40, 0x50000
    v_and_b32 v47, 0x0fffffff, v42
    v_mov_b32 v33, v42
    buffer_load_dwordx2 v[28:29], v47, s[8:11], 0 offen
    buffer_load_dwordx3 v[30:32], v47, s[8:11], 0 offen offset:8
    s_waitcnt lgkmcnt(0)
    v_cmpx_ne_u64 vcc, v[74:75], v[70:71]
    s_and_b64 s[82:83], vcc, s[80:81]
    s_cbranch_scc1 L2_c106
L2_d106:
    v_mov_b64 v[84:85], v[70:71]
    v_mov_b32 v7, v93
    v_mov_b64 v[86:87], v[74:75]
    s_mov_b64 exec, -1
    s_or_b64 s[80:81], s[80:81], vcc
    v_cmpx_ne_u64 vcc, v[72:73], v[68:69]
    s_and_b64 s[82:83], vcc, s[80:81]
    s_cbranch_scc1 L2_c107
L2_d107:
    v_mov_b64 v[84:85], v[68:69]
    v_mov_b32 v7, v92
    v_mov_b64 v[86:87], v[72:73]
    s_mov_b64 exec, -1
    s_or_b64 s[80:81], s[80:81], vcc
    ds_read_b64 v[70:71], v95 offset:65408
    ds_read_b64 v[68:69], v94 offset:65408
    s_waitcnt vmcnt(8)
    v_and_b32 v46, 0x20000000, v39
    v_lshrrev_b32 v47, 14, v35
    v_bitop3_b32 v47, v47, v5, v46 bitop3:0xea
    ds_read_b64 v[102:103], v47
    v_bitop3_b32 v93, v35, v5, v46 bitop3:0xea
    v_and_b32 v46, 0x10000000, v39
    v_lshrrev_b32 v47, 14, v34
    v_bitop3_b32 v47, v47, v5, v46 bitop3:0xea
    ds_read_b64 v[100:101], v47
    v_bitop3_b32 v92, v34, v5, v46 bitop3:0xea
    v_and_b32 v46, 0x80000000, v39
    v_lshrrev_b32 v47, 14, v37
    v_bitop3_b32 v47, v47, v5, v46 bitop3:0xea
    ds_read_b64 v[106:107], v47
    v_and_b32 v46, 0x40000000, v39
    v_lshrrev_b32 v47, 14, v36
    v_bitop3_b32 v47, v47, v5, v46 bitop3:0xea
    ds_read_b64 v[104:105], v47
    s_waitcnt lgkmcnt(4)
    v_mfma_f32_4x4x4_16b_bf16 v[80:83], v[10:11], v[70:71], v[80:83]
    v_mfma_f32_4x4x4_16b_bf16 v[76:79], v[10:11], v[68:69], v[76:79]
    v_perm_b32 v15, v35, v38, s45
    v_bitop3_b32 v46, v35, 0.5, -0.5 bitop3:0xa8
    v_perm_b32 v14, v34, v38, s44
    v_bitop3_b32 v47, v34, 0.5, -0.5 bitop3:0xa8
    v_cvt_pk_bf16_f32 v80, v80, v81
    v_cvt_pk_bf16_f32 v81, v82, v83
    ds_wrxchg_rtn_b64 v[74:75], v95, v[80:81] offset:65408
    v_cvt_pk_bf16_f32 v76, v76, v77
    v_cvt_pk_bf16_f32 v77, v78, v79
    ds_wrxchg_rtn_b64 v[72:73], v94, v[76:77] offset:65408
    s_waitcnt lgkmcnt(2)
    s_barrier
    s_setprio 3
    s_mov_b32 m0, s69
    s_nop 0
    ds_write_addtid_b32 v116 offset:32768
    ds_write_addtid_b32 v117 offset:33024
    ds_write_addtid_b32 v118 offset:33280
    ds_write_addtid_b32 v119 offset:33536
    buffer_load_dwordx4 v[116:119], v3, s[16:19], s40 offen offset:2048
    ds_write_addtid_b32 v120 offset:33792
    ds_write_addtid_b32 v121 offset:34048
    ds_write_addtid_b32 v122 offset:34304
    ds_write_addtid_b32 v123 offset:34560
    buffer_load_dwordx4 v[120:123], v3, s[16:19], s40 offen offset:3072
    v_mfma_f32_4x4x4_16b_bf16 v[80:83], v[8:9], v[102:103], 0
    v_mfma_f32_4x4x4_16b_bf16 v[76:79], v[8:9], v[100:101], 0
    v_bitop3_b32 v15, v6, v15, v46 bitop3:0xca
    v_bitop3_b32 v14, v6, v14, v47 bitop3:0xca
    v_cmp_lt_u32 s[84:85], v5, v92
    s_nop 0
    v_pk_mul_f32 v[80:81], v[80:81], v[14:15] op_sel:[0,1] op_sel_hi:[1,1]
    v_pk_mul_f32 v[82:83], v[82:83], v[14:15] op_sel:[0,1] op_sel_hi:[1,1]
    v_pk_mul_f32 v[76:77], v[76:77], v[14:15] op_sel:[0,0] op_sel_hi:[1,0]
    v_pk_mul_f32 v[78:79], v[78:79], v[14:15] op_sel:[0,0] op_sel_hi:[1,0]
    v_mov_b32 v44, v43
    s_cmp_gt_u32 s37, 1024
    s_cbranch_scc1 L2_xs108
    s_cmp_lg_u32 s43, 0
    s_cbranch_scc1 L2_xa108
L2_xb108:
    v_lshlrev_b32 v89, 16, v96
    v_add_u32 v90, 60, v97
    v_bitop3_b32 v90, v89, v45, v90 bitop3:0x6a
    ds_write_b32 v98, v90 offset:12
    v_lshlrev_b32 v89, 20, v96
    v_add_u32 v90, 40, v97
    v_bitop3_b32 v90, v89, v45, v90 bitop3:0x6a
    ds_write_b32 v98, v90 offset:8
    v_lshlrev_b32 v89, 24, v96
    v_add_u32 v90, 20, v97
    v_bitop3_b32 v90, v89, v45, v90 bitop3:0x6a
    ds_write_b32 v98, v90 offset:4
    v_lshlrev_b32 v89, 28, v96
    v_bitop3_b32 v90, v89, v45, v97 bitop3:0x6a
    ds_write_b32 v98, v90 offset:0
    v_mov_b32_dpp v91, v66 quad_perm:[1,1,1,1] row_mask:0xf bank_mask:0xf
    v_and_b32 v89, 3, v91
    v_and_b32 v97, 0xfffc, v91
    v_sub_u16_dpp v88, v66, v91 quad_perm:[3,3,3,3] row_mask:0xf bank_mask:0xf
    v_mad_u32_u24 v97, v97, 5, v4
    v_add_u32 v99, v88, v89
    v_bfm_b32 v96, v88, v89
    v_cmp_lt_u32 s[58:59], 16, v99
    v_lshlrev_b32 v89, v1, v96
    v_and_b32 v89, v45, v89
    v_cmp_ne_u32 vcc, 0, v89
    v_xor_b32 v90, v97, v89
    s_add_u32 s3, s37, s38
    v_mbcnt_lo_u32_b32 v98, vcc_lo, 0
    v_mbcnt_hi_u32_b32 v98, vcc_hi, v98
    s_bcnt1_i32_b64 s41, vcc
    v_lshl_add_u32 v98, v98, 2, s3
    s_mov_b64 exec, vcc
    ds_write_b32 v98, v90
    s_mov_b64 exec, -1
    s_lshl2_add_u32 s37, s41, s37
    s_cmp_lg_u64 s[58:59], 0
    s_cbranch_scc1 L2_xe108
L2_xr108:
    v_add_u32 v98, s37, v0
    v_mov_b32 v90, -1
    ds_write_b32 v98, v90
    ds_read2st64_b32 v[40:41], v0 offset0:0 offset1:1
    ds_read2st64_b32 v[42:43], v0 offset0:2 offset1:3
    s_sub_u32 s3, s37, 768
    s_cmp_gt_u32 s3, 256
    s_cbranch_scc1 L2_xf108
L2_xg108:
    v_lshrrev_b64 v[64:65], 16, v[64:65]
    v_lshrrev_b64 v[66:67], 16, v[66:67]
    s_setprio 2
    ds_write_addtid_b32 v124 offset:34816
    ds_write_addtid_b32 v125 offset:35072
    ds_write_addtid_b32 v126 offset:35328
    ds_write_addtid_b32 v127 offset:35584
    s_add_u32 s3, s40, 4096
    buffer_load_dwordx4 v[124:127], v3, s[16:19], s3 offen
    s_waitcnt lgkmcnt(14)
    v_cmpx_ne_u64 vcc, v[74:75], v[70:71]
    s_and_b64 s[82:83], vcc, s[80:81]
    s_cbranch_scc1 L2_c109
L2_d109:
    v_mov_b64 v[84:85], v[70:71]
    v_mov_b32 v7, v95
    v_mov_b64 v[86:87], v[74:75]
    s_mov_b64 exec, -1
    s_or_b64 s[80:81], s[80:81], vcc
    v_cmpx_ne_u64 vcc, v[72:73], v[68:69]
    s_and_b64 s[82:83], vcc, s[80:81]
    s_cbranch_scc1 L2_c110
L2_d110:
    v_mov_b64 v[84:85], v[68:69]
    v_mov_b32 v7, v94
    v_mov_b64 v[86:87], v[72:73]
    s_mov_b64 exec, -1
    s_or_b64 s[80:81], s[80:81], vcc
    ds_read_b64 v[70:71], v93 offset:65408
    s_and_b64 exec, s[84:85], s[80:81]
    v_mfma_f32_4x4x4_16b_bf16 v[76:79], v[12:13], v[84:85], 0
    v_mov_b32 v92, v7
    s_andn2_b64 s[80:81], s[80:81], s[84:85]
    v_mfma_f32_4x4x4_16b_bf16 v[76:79], v[10:11], v[86:87], v[76:79]
    s_mov_b64 exec, -1
    ds_read_b64 v[68:69], v92 offset:65408
    s_setprio 1
    s_waitcnt vmcnt(10)
    s_mov_b32 m0, s38
    s_nop 0
    ds_write_addtid_b32 v108 offset:0
    ds_write_addtid_b32 v109 offset:256
    ds_write_addtid_b32 v110 offset:512
    ds_write_addtid_b32 v111 offset:768
    s_waitcnt lgkmcnt(4)
    v_mfma_f32_4x4x4_16b_bf16 v[80:83], v[10:11], v[70:71], v[80:83]
    v_mfma_f32_4x4x4_16b_bf16 v[76:79], v[10:11], v[68:69], v[76:79]
    v_and_b32 v46, 0x40000000, v39
    v_bitop3_b32 v94, v36, v5, v46 bitop3:0xea
    v_and_b32 v46, 0x80000000, v39
    v_bitop3_b32 v95, v37, v5, v46 bitop3:0xea
    v_perm_b32 v15, v37, v38, s47
    v_bitop3_b32 v46, v37, 0.5, -0.5 bitop3:0xa8
    v_perm_b32 v14, v36, v38, s46
    v_bitop3_b32 v47, v36, 0.5, -0.5 bitop3:0xa8
    v_cvt_pk_bf16_f32 v80, v80, v81
    v_cvt_pk_bf16_f32 v81, v82, v83
    ds_wrxchg_rtn_b64 v[74:75], v93, v[80:81] offset:65408
    v_cvt_pk_bf16_f32 v76, v76, v77
    v_cvt_pk_bf16_f32 v77, v78, v79
    ds_wrxchg_rtn_b64 v[72:73], v92, v[76:77] offset:65408
    s_setprio 0
    s_waitcnt vmcnt(7)
    ds_write_addtid_b32 v112 offset:1024
    ds_write_addtid_b32 v113 offset:1280
    ds_write_addtid_b32 v114 offset:1536
    ds_write_addtid_b32 v115 offset:1792
    v_mfma_f32_4x4x4_16b_bf16 v[80:83], v[8:9], v[106:107], 0
    v_mfma_f32_4x4x4_16b_bf16 v[76:79], v[8:9], v[104:105], 0
    v_bitop3_b32 v15, v6, v15, v46 bitop3:0xca
    v_bitop3_b32 v14, v6, v14, v47 bitop3:0xca
    s_nop 1
    v_pk_mul_f32 v[80:81], v[80:81], v[14:15] op_sel:[0,1] op_sel_hi:[1,1]
    v_pk_mul_f32 v[82:83], v[82:83], v[14:15] op_sel:[0,1] op_sel_hi:[1,1]
    v_pk_mul_f32 v[76:77], v[76:77], v[14:15] op_sel:[0,0] op_sel_hi:[1,0]
    v_pk_mul_f32 v[78:79], v[78:79], v[14:15] op_sel:[0,0] op_sel_hi:[1,0]
    s_add_u32 s42, s42, 1
    s_waitcnt lgkmcnt(0)
    s_cmp_lg_u32 s42, 14
    s_cbranch_scc1 L2_loop
    s_barrier
    s_bitcmp1_b32 s36, s42
    s_cbranch_scc1 L2_slow
L2_ret6:
    s_setprio 3
    v_and_b32 v47, 0x0fffffff, v44
    v_mov_b32 v39, v44
    buffer_load_dwordx2 v[34:35], v47, s[8:11], 0 offen
    buffer_load_dwordx3 v[36:38], v47, s[8:11], 0 offen offset:8
    v_cmpx_ne_u64 vcc, v[74:75], v[70:71]
    s_and_b64 s[82:83], vcc, s[80:81]
    s_cbranch_scc1 L2_c111
L2_d111:
    v_mov_b64 v[84:85], v[70:71]
    v_mov_b32 v7, v93
    v_mov_b64 v[86:87], v[74:75]
    s_mov_b64 exec, -1
    s_or_b64 s[80:81], s[80:81], vcc
    v_cmpx_ne_u64 vcc, v[72:73], v[68:69]
    s_and_b64 s[82:83], vcc, s[80:81]
    s_cbranch_scc1 L2_c112
L2_d112:
    v_mov_b64 v[84:85], v[68:69]
    v_mov_b32 v7, v92
    v_mov_b64 v[86:87], v[72:73]
    s_mov_b64 exec, -1
    s_or_b64 s[80:81], s[80:81], vcc
    ds_read_b64 v[70:71], v95 offset:65408
    ds_read_b64 v[68:69], v94 offset:65408
    v_and_b32 v46, 0x20000000, v21
    v_lshrrev_b32 v47, 14, v17
    v_bitop3_b32 v47, v47, v5, v46 bitop3:0xea
    ds_read_b64 v[102:103], v47
    v_bitop3_b32 v93, v17, v5, v46 bitop3:0xea
    v_and_b32 v46, 0x10000000, v21
    v_lshrrev_b32 v47, 14, v16
    v_bitop3_b32 v47, v47, v5, v46 bitop3:0xea
    ds_read_b64 v[100:101], v47
    v_bitop3_b32 v92, v16, v5, v46 bitop3:0xea
    s_waitcnt lgkmcnt(2)
    v_mfma_f32_4x4x4_16b_bf16 v[80:83], v[10:11], v[70:71], v[80:83]
    v_mfma_f32_4x4x4_16b_bf16 v[76:79], v[10:11], v[68:69], v[76:79]
    v_perm_b32 v15, v17, v20, s45
    v_bitop3_b32 v46, v17, 0.5, -0.5 bitop3:0xa8
    v_perm_b32 v14, v16, v20, s44
    v_bitop3_b32 v47, v16, 0.5, -0.5 bitop3:0xa8
    v_cvt_pk_bf16_f32 v80, v80, v81
    v_cvt_pk_bf16_f32 v81, v82, v83
    ds_wrxchg_rtn_b64 v[74:75], v95, v[80:81] offset:65408
    v_cvt_pk_bf16_f32 v76, v76, v77
    v_cvt_pk_bf16_f32 v77, v78, v79
    ds_wrxchg_rtn_b64 v[72:73], v94, v[76:77] offset:65408
    s_waitcnt lgkmcnt(2)
    v_mfma_f32_4x4x4_16b_bf16 v[80:83], v[8:9], v[102:103], 0
    v_mfma_f32_4x4x4_16b_bf16 v[76:79], v[8:9], v[100:101], 0
    v_bitop3_b32 v15, v6, v15, v46 bitop3:0xca
    v_bitop3_b32 v14, v6, v14, v47 bitop3:0xca
    v_cmp_lt_u32 s[84:85], v5, v92
    s_nop 0
    v_pk_mul_f32 v[80:81], v[80:81], v[14:15] op_sel:[0,1] op_sel_hi:[1,1]
    v_pk_mul_f32 v[82:83], v[82:83], v[14:15] op_sel:[0,1] op_sel_hi:[1,1]
    v_pk_mul_f32 v[76:77], v[76:77], v[14:15] op_sel:[0,0] op_sel_hi:[1,0]
    v_pk_mul_f32 v[78:79], v[78:79], v[14:15] op_sel:[0,0] op_sel_hi:[1,0]
    buffer_load_dwordx4 v[108:111], v3, s[16:19], s40 offen offset:0
    s_waitcnt lgkmcnt(0)
    v_cmpx_ne_u64 vcc, v[74:75], v[70:71]
    s_and_b64 s[82:83], vcc, s[80:81]
    s_cbranch_scc1 L2_c113
L2_d113:
    v_mov_b64 v[84:85], v[70:71]
    v_mov_b32 v7, v95
    v_mov_b64 v[86:87], v[74:75]
    s_mov_b64 exec, -1
    s_or_b64 s[80:81], s[80:81], vcc
    v_cmpx_ne_u64 vcc, v[72:73], v[68:69]
    s_and_b64 s[82:83], vcc, s[80:81]
    s_cbranch_scc1 L2_c114
L2_d114:
    v_mov_b64 v[84:85], v[68:69]
    v_mov_b32 v7, v94
    v_mov_b64 v[86:87], v[72:73]
    s_mov_b64 exec, -1
    s_or_b64 s[80:81], s[80:81], vcc
    ds_read_b64 v[70:71], v93 offset:65408
    s_and_b64 exec, s[84:85], s[80:81]
    v_mfma_f32_4x4x4_16b_bf16 v[76:79], v[12:13], v[84:85], 0
    v_mov_b32 v92, v7
    s_andn2_b64 s[80:81], s[80:81], s[84:85]
    v_mfma_f32_4x4x4_16b_bf16 v[76:79], v[10:11], v[86:87], v[76:79]
    s_mov_b64 exec, -1
    ds_read_b64 v[68:69], v92 offset:65408
    v_and_b32 v46, 0x80000000, v21
    v_lshrrev_b32 v47, 14, v19
    v_bitop3_b32 v47, v47, v5, v46 bitop3:0xea
    ds_read_b64 v[106:107], v47
    v_bitop3_b32 v95, v19, v5, v46 bitop3:0xea
    v_and_b32 v46, 0x40000000, v21
    v_lshrrev_b32 v47, 14, v18
    v_bitop3_b32 v47, v47, v5, v46 bitop3:0xea
    ds_read_b64 v[104:105], v47
    v_bitop3_b32 v94, v18, v5, v46 bitop3:0xea
    s_waitcnt lgkmcnt(2)
    v_mfma_f32_4x4x4_16b_bf16 v[80:83], v[10:11], v[70:71], v[80:83]
    v_mfma_f32_4x4x4_16b_bf16 v[76:79], v[10:11], v[68:69], v[76:79]
    v_perm_b32 v15, v19, v20, s47
    v_bitop3_b32 v46, v19, 0.5, -0.5 bitop3:0xa8
    v_perm_b32 v14, v18, v20, s46
    v_bitop3_b32 v47, v18, 0.5, -0.5 bitop3:0xa8
    v_cvt_pk_bf16_f32 v80, v80, v81
    v_cvt_pk_bf16_f32 v81, v82, v83
    ds_wrxchg_rtn_b64 v[74:75], v93, v[80:81] offset:65408
    v_cvt_pk_bf16_f32 v76, v76, v77
    v_cvt_pk_bf16_f32 v77, v78, v79
    ds_wrxchg_rtn_b64 v[72:73], v92, v[76:77] offset:65408
    s_setprio 2
    s_waitcnt lgkmcnt(2)
    v_mfma_f32_4x4x4_16b_bf16 v[80:83], v[8:9], v[106:107], 0
    v_mfma_f32_4x4x4_16b_bf16 v[76:79], v[8:9], v[104:105], 0
    v_bitop3_b32 v15, v6, v15, v46 bitop3:0xca
    v_bitop3_b32 v14, v6, v14, v47 bitop3:0xca
    s_nop 1
    v_pk_mul_f32 v[80:81], v[80:81], v[14:15] op_sel:[0,1] op_sel_hi:[1,1]
    v_pk_mul_f32 v[82:83], v[82:83], v[14:15] op_sel:[0,1] op_sel_hi:[1,1]
    v_pk_mul_f32 v[76:77], v[76:77], v[14:15] op_sel:[0,0] op_sel_hi:[1,0]
    v_pk_mul_f32 v[78:79], v[78:79], v[14:15] op_sel:[0,0] op_sel_hi:[1,0]
    v_and_b32 v47, 0x0fffffff, v40
    v_mov_b32 v21, v40
    buffer_load_dwordx2 v[16:17], v47, s[8:11], 0 offen
    buffer_load_dwordx3 v[18:20], v47, s[8:11], 0 offen offset:8
    s_waitcnt lgkmcnt(0)
    v_cmpx_ne_u64 vcc, v[74:75], v[70:71]
    s_and_b64 s[82:83], vcc, s[80:81]
    s_cbranch_scc1 L2_c115
L2_d115:
    v_mov_b64 v[84:85], v[70:71]
    v_mov_b32 v7, v93
    v_mov_b64 v[86:87], v[74:75]
    s_mov_b64 exec, -1
    s_or_b64 s[80:81], s[80:81], vcc
    v_cmpx_ne_u64 vcc, v[72:73], v[68:69]
    s_and_b64 s[82:83], vcc, s[80:81]
    s_cbranch_scc1 L2_c116
L2_d116:
    v_mov_b64 v[84:85], v[68:69]
    v_mov_b32 v7, v92
    v_mov_b64 v[86:87], v[72:73]
    s_mov_b64 exec, -1
    s_or_b64 s[80:81], s[80:81], vcc
    ds_read_b64 v[70:71], v95 offset:65408
    ds_read_b64 v[68:69], v94 offset:65408
    s_waitcnt vmcnt(10)
    v_and_b32 v46, 0x20000000, v27
    v_lshrrev_b32 v47, 14, v23
    v_bitop3_b32 v47, v47, v5, v46 bitop3:0xea
    ds_read_b64 v[102:103], v47
    v_bitop3_b32 v93, v23, v5, v46 bitop3:0xea
    v_and_b32 v46, 0x10000000, v27
    v_lshrrev_b32 v47, 14, v22
    v_bitop3_b32 v47, v47, v5, v46 bitop3:0xea
    ds_read_b64 v[100:101], v47
    v_bitop3_b32 v92, v22, v5, v46 bitop3:0xea
    s_waitcnt lgkmcnt(2)
    v_mfma_f32_4x4x4_16b_bf16 v[80:83], v[10:11], v[70:71], v[80:83]
    v_mfma_f32_4x4x4_16b_bf16 v[76:79], v[10:11], v[68:69], v[76:79]
    v_perm_b32 v15, v23, v26, s45
    v_bitop3_b32 v46, v23, 0.5, -0.5 bitop3:0xa8
    v_perm_b32 v14, v22, v26, s44
    v_bitop3_b32 v47, v22, 0.5, -0.5 bitop3:0xa8
    v_cvt_pk_bf16_f32 v80, v80, v81
    v_cvt_pk_bf16_f32 v81, v82, v83
    ds_wrxchg_rtn_b64 v[74:75], v95, v[80:81] offset:65408
    v_cvt_pk_bf16_f32 v76, v76, v77
    v_cvt_pk_bf16_f32 v77, v78, v79
    ds_wrxchg_rtn_b64 v[72:73], v94, v[76:77] offset:65408
    s_waitcnt lgkmcnt(2)
    v_mfma_f32_4x4x4_16b_bf16 v[80:83], v[8:9], v[102:103], 0
    v_mfma_f32_4x4x4_16b_bf16 v[76:79], v[8:9], v[100:101], 0
    v_bitop3_b32 v15, v6, v15, v46 bitop3:0xca
    v_bitop3_b32 v14, v6, v14, v47 bitop3:0xca
    v_cmp_lt_u32 s[84:85], v5, v92
    s_nop 0
    v_pk_mul_f32 v[80:81], v[80:81], v[14:15] op_sel:[0,1] op_sel_hi:[1,1]
    v_pk_mul_f32 v[82:83], v[82:83], v[14:15] op_sel:[0,1] op_sel_hi:[1,1]
    v_pk_mul_f32 v[76:77], v[76:77], v[14:15] op_sel:[0,0] op_sel_hi:[1,0]
    v_pk_mul_f32 v[78:79], v[78:79], v[14:15] op_sel:[0,0] op_sel_hi:[1,0]
    buffer_load_dwordx4 v[112:115], v3, s[16:19], s40 offen offset:1024
    s_waitcnt lgkmcnt(0)
    v_cmpx_ne_u64 vcc, v[74:75], v[70:71]
    s_and_b64 s[82:83], vcc, s[80:81]
    s_cbranch_scc1 L2_c117
L2_d117:
    v_mov_b64 v[84:85], v[70:71]
    v_mov_b32 v7, v95
    v_mov_b64 v[86:87], v[74:75]
    s_mov_b64 exec, -1
    s_or_b64 s[80:81], s[80:81], vcc
    v_cmpx_ne_u64 vcc, v[72:73], v[68:69]
    s_and_b64 s[82:83], vcc, s[80:81]
    s_cbranch_scc1 L2_c118
L2_d118:
    v_mov_b64 v[84:85], v[68:69]
    v_mov_b32 v7, v94
    v_mov_b64 v[86:87], v[72:73]
    s_mov_b64 exec, -1
    s_or_b64 s[80:81], s[80:81], vcc
    ds_read_b64 v[70:71], v93 offset:65408
    s_and_b64 exec, s[84:85], s[80:81]
    v_mfma_f32_4x4x4_16b_bf16 v[76:79], v[12:13], v[84:85], 0
    v_mov_b32 v92, v7
    s_andn2_b64 s[80:81], s[80:81], s[84:85]
    v_mfma_f32_4x4x4_16b_bf16 v[76:79], v[10:11], v[86:87], v[76:79]
    s_mov_b64 exec, -1
    ds_read_b64 v[68:69], v92 offset:65408
    v_and_b32 v46, 0x80000000, v27
    v_lshrrev_b32 v47, 14, v25
    v_bitop3_b32 v47, v47, v5, v46 bitop3:0xea
    ds_read_b64 v[106:107], v47
    v_bitop3_b32 v95, v25, v5, v46 bitop3:0xea
    v_and_b32 v46, 0x40000000, v27
    v_lshrrev_b32 v47, 14, v24
    v_bitop3_b32 v47, v47, v5, v46 bitop3:0xea
    ds_read_b64 v[104:105], v47
    v_bitop3_b32 v94, v24, v5, v46 bitop3:0xea
    s_waitcnt lgkmcnt(2)
    v_mfma_f32_4x4x4_16b_bf16 v[80:83], v[10:11], v[70:71], v[80:83]
    v_mfma_f32_4x4x4_16b_bf16 v[76:79], v[10:11], v[68:69], v[76:79]
    v_perm_b32 v15, v25, v26, s47
    v_bitop3_b32 v46, v25, 0.5, -0.5 bitop3:0xa8
    v_perm_b32 v14, v24, v26, s46
    v_bitop3_b32 v47, v24, 0.5, -0.5 bitop3:0xa8
    v_cvt_pk_bf16_f32 v80, v80, v81
    v_cvt_pk_bf16_f32 v81, v82, v83
    ds_wrxchg_rtn_b64 v[74:75], v93, v[80:81] offset:65408
    v_cvt_pk_bf16_f32 v76, v76, v77
    v_cvt_pk_bf16_f32 v77, v78, v79
    ds_wrxchg_rtn_b64 v[72:73], v92, v[76:77] offset:65408
    s_setprio 1
    s_waitcnt lgkmcnt(2)
    v_mfma_f32_4x4x4_16b_bf16 v[80:83], v[8:9], v[106:107], 0
    v_mfma_f32_4x4x4_16b_bf16 v[76:79], v[8:9], v[104:105], 0
    v_bitop3_b32 v15, v6, v15, v46 bitop3:0xca
    v_bitop3_b32 v14, v6, v14, v47 bitop3:0xca
    s_nop 1
    v_pk_mul_f32 v[80:81], v[80:81], v[14:15] op_sel:[0,1] op_sel_hi:[1,1]
    v_pk_mul_f32 v[82:83], v[82:83], v[14:15] op_sel:[0,1] op_sel_hi:[1,1]
    v_pk_mul_f32 v[76:77], v[76:77], v[14:15] op_sel:[0,0] op_sel_hi:[1,0]
    v_pk_mul_f32 v[78:79], v[78:79], v[14:15] op_sel:[0,0] op_sel_hi:[1,0]
    v_and_b32 v47, 0x0fffffff, v41
    v_mov_b32 v27, v41
    buffer_load_dwordx2 v[22:23], v47, s[8:11], 0 offen
    buffer_load_dwordx3 v[24:26], v47, s[8:11], 0 offen offset:8
    s_waitcnt lgkmcnt(0)
    v_cmpx_ne_u64 vcc, v[74:75], v[70:71]
    s_and_b64 s[82:83], vcc, s[80:81]
    s_cbranch_scc1 L2_c119
L2_d119:
    v_mov_b64 v[84:85], v[70:71]
    v_mov_b32 v7, v93
    v_mov_b64 v[86:87], v[74:75]
    s_mov_b64 exec, -1
    s_or_b64 s[80:81], s[80:81], vcc
    v_cmpx_ne_u64 vcc, v[72:73], v[68:69]
    s_and_b64 s[82:83], vcc, s[80:81]
    s_cbranch_scc1 L2_c120
L2_d120:
    v_mov_b64 v[84:85], v[68:69]
    v_mov_b32 v7, v92
    v_mov_b64 v[86:87], v[72:73]
    s_mov_b64 exec, -1
    s_or_b64 s[80:81], s[80:81], vcc
    ds_read_b64 v[70:71], v95 offset:65408
    ds_read_b64 v[68:69], v94 offset:65408
    s_waitcnt vmcnt(11)
    v_and_b32 v46, 0x20000000, v33
    v_lshrrev_b32 v47, 14, v29
    v_bitop3_b32 v47, v47, v5, v46 bitop3:0xea
    ds_read_b64 v[102:103], v47
    v_bitop3_b32 v93, v29, v5, v46 bitop3:0xea
    v_and_b32 v46, 0x10000000, v33
    v_lshrrev_b32 v47, 14, v28
    v_bitop3_b32 v47, v47, v5, v46 bitop3:0xea
    ds_read_b64 v[100:101], v47
    v_bitop3_b32 v92, v28, v5, v46 bitop3:0xea
    s_waitcnt lgkmcnt(2)
    v_mfma_f32_4x4x4_16b_bf16 v[80:83], v[10:11], v[70:71], v[80:83]
    v_mfma_f32_4x4x4_16b_bf16 v[76:79], v[10:11], v[68:69], v[76:79]
    v_perm_b32 v15, v29, v32, s45
    v_bitop3_b32 v46, v29, 0.5, -0.5 bitop3:0xa8
    v_perm_b32 v14, v28, v32, s44
    v_bitop3_b32 v47, v28, 0.5, -0.5 bitop3:0xa8
    v_cvt_pk_bf16_f32 v80, v80, v81
    v_cvt_pk_bf16_f32 v81, v82, v83
    ds_wrxchg_rtn_b64 v[74:75], v95, v[80:81] offset:65408
    v_cvt_pk_bf16_f32 v76, v76, v77
    v_cvt_pk_bf16_f32 v77, v78, v79
    ds_wrxchg_rtn_b64 v[72:73], v94, v[76:77] offset:65408
    s_waitcnt lgkmcnt(2)
    v_mfma_f32_4x4x4_16b_bf16 v[80:83], v[8:9], v[102:103], 0
    v_mfma_f32_4x4x4_16b_bf16 v[76:79], v[8:9], v[100:101], 0
    v_bitop3_b32 v15, v6, v15, v46 bitop3:0xca
    v_bitop3_b32 v14, v6, v14, v47 bitop3:0xca
    v_cmp_lt_u32 s[84:85], v5, v92
    s_nop 0
    v_pk_mul_f32 v[80:81], v[80:81], v[14:15] op_sel:[0,1] op_sel_hi:[1,1]
    v_pk_mul_f32 v[82:83], v[82:83], v[14:15] op_sel:[0,1] op_sel_hi:[1,1]
    v_pk_mul_f32 v[76:77], v[76:77], v[14:15] op_sel:[0,0] op_sel_hi:[1,0]
    v_pk_mul_f32 v[78:79], v[78:79], v[14:15] op_sel:[0,0] op_sel_hi:[1,0]
    s_waitcnt lgkmcnt(0)
    v_cmpx_ne_u64 vcc, v[74:75], v[70:71]
    s_and_b64 s[82:83], vcc, s[80:81]
    s_cbranch_scc1 L2_c121
L2_d121:
    v_mov_b64 v[84:85], v[70:71]
    v_mov_b32 v7, v95
    v_mov_b64 v[86:87], v[74:75]
    s_mov_b64 exec, -1
    s_or_b64 s[80:81], s[80:81], vcc
    v_cmpx_ne_u64 vcc, v[72:73], v[68:69]
    s_and_b64 s[82:83], vcc, s[80:81]
    s_cbranch_scc1 L2_c122
L2_d122:
    v_mov_b64 v[84:85], v[68:69]
    v_mov_b32 v7, v94
    v_mov_b64 v[86:87], v[72:73]
    s_mov_b64 exec, -1
    s_or_b64 s[80:81], s[80:81], vcc
    ds_read_b64 v[70:71], v93 offset:65408
    s_and_b64 exec, s[84:85], s[80:81]
    v_mfma_f32_4x4x4_16b_bf16 v[76:79], v[12:13], v[84:85], 0
    v_mov_b32 v92, v7
    s_andn2_b64 s[80:81], s[80:81], s[84:85]
    v_mfma_f32_4x4x4_16b_bf16 v[76:79], v[10:11], v[86:87], v[76:79]
    s_mov_b64 exec, -1
    ds_read_b64 v[68:69], v92 offset:65408
    v_and_b32 v46, 0x80000000, v33
    v_lshrrev_b32 v47, 14, v31
    v_bitop3_b32 v47, v47, v5, v46 bitop3:0xea
    ds_read_b64 v[106:107], v47
    v_bitop3_b32 v95, v31, v5, v46 bitop3:0xea
    v_and_b32 v46, 0x40000000, v33
    v_lshrrev_b32 v47, 14, v30
    v_bitop3_b32 v47, v47, v5, v46 bitop3:0xea
    ds_read_b64 v[104:105], v47
    v_bitop3_b32 v94, v30, v5, v46 bitop3:0xea
    s_waitcnt lgkmcnt(2)
    v_mfma_f32_4x4x4_16b_bf16 v[80:83], v[10:11], v[70:71], v[80:83]
    v_mfma_f32_4x4x4_16b_bf16 v[76:79], v[10:11], v[68:69], v[76:79]
    v_perm_b32 v15, v31, v32, s47
    v_bitop3_b32 v46, v31, 0.5, -0.5 bitop3:0xa8
    v_perm_b32 v14, v30, v32, s46
    v_bitop3_b32 v47, v30, 0.5, -0.5 bitop3:0xa8
    v_cvt_pk_bf16_f32 v80, v80, v81
    v_cvt_pk_bf16_f32 v81, v82, v83
    ds_wrxchg_rtn_b64 v[74:75], v93, v[80:81] offset:65408
    v_cvt_pk_bf16_f32 v76, v76, v77
    v_cvt_pk_bf16_f32 v77, v78, v79
    ds_wrxchg_rtn_b64 v[72:73], v92, v[76:77] offset:65408
    s_setprio 0
    s_waitcnt lgkmcnt(2)
    v_mfma_f32_4x4x4_16b_bf16 v[80:83], v[8:9], v[106:107], 0
    v_mfma_f32_4x4x4_16b_bf16 v[76:79], v[8:9], v[104:105], 0
    v_bitop3_b32 v15, v6, v15, v46 bitop3:0xca
    v_bitop3_b32 v14, v6, v14, v47 bitop3:0xca
    s_nop 1
    v_pk_mul_f32 v[80:81], v[80:81], v[14:15] op_sel:[0,1] op_sel_hi:[1,1]
    v_pk_mul_f32 v[82:83], v[82:83], v[14:15] op_sel:[0,1] op_sel_hi:[1,1]
    v_pk_mul_f32 v[76:77], v[76:77], v[14:15] op_sel:[0,0] op_sel_hi:[1,0]
    v_pk_mul_f32 v[78:79], v[78:79], v[14:15] op_sel:[0,0] op_sel_hi:[1,0]
    s_add_u32 s40, s40, 0xfff24000
    v_and_b32 v47, 0x0fffffff, v42
    v_mov_b32 v33, v42
    buffer_load_dwordx2 v[28:29], v47, s[8:11], 0 offen
    buffer_load_dwordx3 v[30:32], v47, s[8:11], 0 offen offset:8
    s_waitcnt lgkmcnt(0)
    v_cmpx_ne_u64 vcc, v[74:75], v[70:71]
    s_and_b64 s[82:83], vcc, s[80:81]
    s_cbranch_scc1 L2_c123
L2_d123:
    v_mov_b64 v[84:85], v[70:71]
    v_mov_b32 v7, v93
    v_mov_b64 v[86:87], v[74:75]
    s_mov_b64 exec, -1
    s_or_b64 s[80:81], s[80:81], vcc
    v_cmpx_ne_u64 vcc, v[72:73], v[68:69]
    s_and_b64 s[82:83], vcc, s[80:81]
    s_cbranch_scc1 L2_c124
L2_d124:
    v_mov_b64 v[84:85], v[68:69]
    v_mov_b32 v7, v92
    v_mov_b64 v[86:87], v[72:73]
    s_mov_b64 exec, -1
    s_or_b64 s[80:81], s[80:81], vcc
    ds_read_b64 v[70:71], v95 offset:65408
    ds_read_b64 v[68:69], v94 offset:65408
    s_waitcnt vmcnt(8)
    v_and_b32 v46, 0x20000000, v39
    v_lshrrev_b32 v47, 14, v35
    v_bitop3_b32 v47, v47, v5, v46 bitop3:0xea
    ds_read_b64 v[102:103], v47
    v_bitop3_b32 v93, v35, v5, v46 bitop3:0xea
    v_and_b32 v46, 0x10000000, v39
    v_lshrrev_b32 v47, 14, v34
    v_bitop3_b32 v47, v47, v5, v46 bitop3:0xea
    ds_read_b64 v[100:101], v47
    v_bitop3_b32 v92, v34, v5, v46 bitop3:0xea
    v_and_b32 v46, 0x80000000, v39
    v_lshrrev_b32 v47, 14, v37
    v_bitop3_b32 v47, v47, v5, v46 bitop3:0xea
    ds_read_b64 v[106:107], v47
    v_and_b32 v46, 0x40000000, v39
    v_lshrrev_b32 v47, 14, v36
    v_bitop3_b32 v47, v47, v5, v46 bitop3:0xea
    ds_read_b64 v[104:105], v47
    s_waitcnt lgkmcnt(4)
    v_mfma_f32_4x4x4_16b_bf16 v[80:83], v[10:11], v[70:71], v[80:83]
    v_mfma_f32_4x4x4_16b_bf16 v[76:79], v[10:11], v[68:69], v[76:79]
    v_perm_b32 v15, v35, v38, s45
    v_bitop3_b32 v46, v35, 0.5, -0.5 bitop3:0xa8
    v_perm_b32 v14, v34, v38, s44
    v_bitop3_b32 v47, v34, 0.5, -0.5 bitop3:0xa8
    v_cvt_pk_bf16_f32 v80, v80, v81
    v_cvt_pk_bf16_f32 v81, v82, v83
    ds_wrxchg_rtn_b64 v[74:75], v95, v[80:81] offset:65408
    v_cvt_pk_bf16_f32 v76, v76, v77
    v_cvt_pk_bf16_f32 v77, v78, v79
    ds_wrxchg_rtn_b64 v[72:73], v94, v[76:77] offset:65408
    s_waitcnt lgkmcnt(2)
    s_barrier
    s_setprio 3
    s_mov_b32 m0, s69
    s_nop 0
    ds_write_addtid_b32 v116 offset:32768
    ds_write_addtid_b32 v117 offset:33024
    ds_write_addtid_b32 v118 offset:33280
    ds_write_addtid_b32 v119 offset:33536
    ds_write_addtid_b32 v120 offset:33792
    ds_write_addtid_b32 v121 offset:34048
    ds_write_addtid_b32 v122 offset:34304
    ds_write_addtid_b32 v123 offset:34560
    v_mfma_f32_4x4x4_16b_bf16 v[80:83], v[8:9], v[102:103], 0
    v_mfma_f32_4x4x4_16b_bf16 v[76:79], v[8:9], v[100:101], 0
    v_bitop3_b32 v15, v6, v15, v46 bitop3:0xca
    v_bitop3_b32 v14, v6, v14, v47 bitop3:0xca
    v_cmp_lt_u32 s[84:85], v5, v92
    s_nop 0
    v_pk_mul_f32 v[80:81], v[80:81], v[14:15] op_sel:[0,1] op_sel_hi:[1,1]
    v_pk_mul_f32 v[82:83], v[82:83], v[14:15] op_sel:[0,1] op_sel_hi:[1,1]
    v_pk_mul_f32 v[76:77], v[76:77], v[14:15] op_sel:[0,0] op_sel_hi:[1,0]
    v_pk_mul_f32 v[78:79], v[78:79], v[14:15] op_sel:[0,0] op_sel_hi:[1,0]
    v_mov_b32 v44, v43
    s_setprio 2
    ds_write_addtid_b32 v124 offset:34816
    ds_write_addtid_b32 v125 offset:35072
    ds_write_addtid_b32 v126 offset:35328
    ds_write_addtid_b32 v127 offset:35584
    s_waitcnt lgkmcnt(12)
    v_cmpx_ne_u64 vcc, v[74:75], v[70:71]
    s_and_b64 s[82:83], vcc, s[80:81]
    s_cbranch_scc1 L2_c125
L2_d125:
    v_mov_b64 v[84:85], v[70:71]
    v_mov_b32 v7, v95
    v_mov_b64 v[86:87], v[74:75]
    s_mov_b64 exec, -1
    s_or_b64 s[80:81], s[80:81], vcc
    v_cmpx_ne_u64 vcc, v[72:73], v[68:69]
    s_and_b64 s[82:83], vcc, s[80:81]
    s_cbranch_scc1 L2_c126
L2_d126:
    v_mov_b64 v[84:85], v[68:69]
    v_mov_b32 v7, v94
    v_mov_b64 v[86:87], v[72:73]
    s_mov_b64 exec, -1
    s_or_b64 s[80:81], s[80:81], vcc
    ds_read_b64 v[70:71], v93 offset:65408
    s_and_b64 exec, s[84:85], s[80:81]
    v_mfma_f32_4x4x4_16b_bf16 v[76:79], v[12:13], v[84:85], 0
    v_mov_b32 v92, v7
    s_andn2_b64 s[80:81], s[80:81], s[84:85]
    v_mfma_f32_4x4x4_16b_bf16 v[76:79], v[10:11], v[86:87], v[76:79]
    s_mov_b64 exec, -1
    ds_read_b64 v[68:69], v92 offset:65408
    s_setprio 1
    s_waitcnt vmcnt(7)
    s_mov_b32 m0, s38
    s_nop 0
    ds_write_addtid_b32 v108 offset:0
    ds_write_addtid_b32 v109 offset:256
    ds_write_addtid_b32 v110 offset:512
    ds_write_addtid_b32 v111 offset:768
    s_waitcnt lgkmcnt(4)
    v_mfma_f32_4x4x4_16b_bf16 v[80:83], v[10:11], v[70:71], v[80:83]
    v_mfma_f32_4x4x4_16b_bf16 v[76:79], v[10:11], v[68:69], v[76:79]
    v_and_b32 v46, 0x40000000, v39
    v_bitop3_b32 v94, v36, v5, v46 bitop3:0xea
    v_and_b32 v46, 0x80000000, v39
    v_bitop3_b32 v95, v37, v5, v46 bitop3:0xea
    v_perm_b32 v15, v37, v38, s47
    v_bitop3_b32 v46, v37, 0.5, -0.5 bitop3:0xa8
    v_perm_b32 v14, v36, v38, s46
    v_bitop3_b32 v47, v36, 0.5, -0.5 bitop3:0xa8
    v_cvt_pk_bf16_f32 v80, v80, v81
    v_cvt_pk_bf16_f32 v81, v82, v83
    ds_wrxchg_rtn_b64 v[74:75], v93, v[80:81] offset:65408
    v_cvt_pk_bf16_f32 v76, v76, v77
    v_cvt_pk_bf16_f32 v77, v78, v79
    ds_wrxchg_rtn_b64 v[72:73], v92, v[76:77] offset:65408
    s_setprio 0
    s_waitcnt vmcnt(4)
    ds_write_addtid_b32 v112 offset:1024
    ds_write_addtid_b32 v113 offset:1280
    ds_write_addtid_b32 v114 offset:1536
    ds_write_addtid_b32 v115 offset:1792
    v_mfma_f32_4x4x4_16b_bf16 v[80:83], v[8:9], v[106:107], 0
    v_mfma_f32_4x4x4_16b_bf16 v[76:79], v[8:9], v[104:105], 0
    v_bitop3_b32 v15, v6, v15, v46 bitop3:0xca
    v_bitop3_b32 v14, v6, v14, v47 bitop3:0xca
    s_nop 1
    v_pk_mul_f32 v[80:81], v[80:81], v[14:15] op_sel:[0,1] op_sel_hi:[1,1]
    v_pk_mul_f32 v[82:83], v[82:83], v[14:15] op_sel:[0,1] op_sel_hi:[1,1]
    v_pk_mul_f32 v[76:77], v[76:77], v[14:15] op_sel:[0,0] op_sel_hi:[1,0]
    v_pk_mul_f32 v[78:79], v[78:79], v[14:15] op_sel:[0,0] op_sel_hi:[1,0]
    s_add_u32 s42, s42, 1
    s_waitcnt lgkmcnt(0)
    s_barrier
    s_bitcmp1_b32 s36, s42
    s_cbranch_scc1 L2_slow
L2_ret7:
    s_setprio 3
    v_and_b32 v47, 0x0fffffff, v44
    v_mov_b32 v39, v44
    buffer_load_dwordx2 v[34:35], v47, s[8:11], 0 offen
    buffer_load_dwordx3 v[36:38], v47, s[8:11], 0 offen offset:8
    v_cmpx_ne_u64 vcc, v[74:75], v[70:71]
    s_and_b64 s[82:83], vcc, s[80:81]
    s_cbranch_scc1 L2_c127
L2_d127:
    v_mov_b64 v[84:85], v[70:71]
    v_mov_b32 v7, v93
    v_mov_b64 v[86:87], v[74:75]
    s_mov_b64 exec, -1
    s_or_b64 s[80:81], s[80:81], vcc
    v_cmpx_ne_u64 vcc, v[72:73], v[68:69]
    s_and_b64 s[82:83], vcc, s[80:81]
    s_cbranch_scc1 L2_c128
L2_d128:
    v_mov_b64 v[84:85], v[68:69]
    v_mov_b32 v7, v92
    v_mov_b64 v[86:87], v[72:73]
    s_mov_b64 exec, -1
    s_or_b64 s[80:81], s[80:81], vcc
    ds_read_b64 v[70:71], v95 offset:65408
    ds_read_b64 v[68:69], v94 offset:65408
    v_and_b32 v46, 0x20000000, v21
    v_lshrrev_b32 v47, 14, v17
    v_bitop3_b32 v47, v47, v5, v46 bitop3:0xea
    ds_read_b64 v[102:103], v47
    v_bitop3_b32 v93, v17, v5, v46 bitop3:0xea
    v_and_b32 v46, 0x10000000, v21
    v_lshrrev_b32 v47, 14, v16
    v_bitop3_b32 v47, v47, v5, v46 bitop3:0xea
    ds_read_b64 v[100:101], v47
    v_bitop3_b32 v92, v16, v5, v46 bitop3:0xea
    s_waitcnt lgkmcnt(2)
    v_mfma_f32_4x4x4_16b_bf16 v[80:83], v[10:11], v[70:71], v[80:83]
    v_mfma_f32_4x4x4_16b_bf16 v[76:79], v[10:11], v[68:69], v[76:79]
    v_perm_b32 v15, v17, v20, s45
    v_bitop3_b32 v46, v17, 0.5, -0.5 bitop3:0xa8
    v_perm_b32 v14, v16, v20, s44
    v_bitop3_b32 v47, v16, 0.5, -0.5 bitop3:0xa8
    v_cvt_pk_bf16_f32 v80, v80, v81
    v_cvt_pk_bf16_f32 v81, v82, v83
    ds_wrxchg_rtn_b64 v[74:75], v95, v[80:81] offset:65408
    v_cvt_pk_bf16_f32 v76, v76, v77
    v_cvt_pk_bf16_f32 v77, v78, v79
    ds_wrxchg_rtn_b64 v[72:73], v94, v[76:77] offset:65408
    s_waitcnt lgkmcnt(2)
    v_mfma_f32_4x4x4_16b_bf16 v[80:83], v[8:9], v[102:103], 0
    v_mfma_f32_4x4x4_16b_bf16 v[76:79], v[8:9], v[100:101], 0
    v_bitop3_b32 v15, v6, v15, v46 bitop3:0xca
    v_bitop3_b32 v14, v6, v14, v47 bitop3:0xca
    v_cmp_lt_u32 s[84:85], v5, v92
    s_nop 0
    v_pk_mul_f32 v[80:81], v[80:81], v[14:15] op_sel:[0,1] op_sel_hi:[1,1]
    v_pk_mul_f32 v[82:83], v[82:83], v[14:15] op_sel:[0,1] op_sel_hi:[1,1]
    v_pk_mul_f32 v[76:77], v[76:77], v[14:15] op_sel:[0,0] op_sel_hi:[1,0]
    v_pk_mul_f32 v[78:79], v[78:79], v[14:15] op_sel:[0,0] op_sel_hi:[1,0]
    s_waitcnt lgkmcnt(0)
    v_cmpx_ne_u64 vcc, v[74:75], v[70:71]
    s_and_b64 s[82:83], vcc, s[80:81]
    s_cbranch_scc1 L2_c129
L2_d129:
    v_mov_b64 v[84:85], v[70:71]
    v_mov_b32 v7, v95
    v_mov_b64 v[86:87], v[74:75]
    s_mov_b64 exec, -1
    s_or_b64 s[80:81], s[80:81], vcc
    v_cmpx_ne_u64 vcc, v[72:73], v[68:69]
    s_and_b64 s[82:83], vcc, s[80:81]
    s_cbranch_scc1 L2_c130
L2_d130:
    v_mov_b64 v[84:85], v[68:69]
    v_mov_b32 v7, v94
    v_mov_b64 v[86:87], v[72:73]
    s_mov_b64 exec, -1
    s_or_b64 s[80:81], s[80:81], vcc
    ds_read_b64 v[70:71], v93 offset:65408
    s_and_b64 exec, s[84:85], s[80:81]
    v_mfma_f32_4x4x4_16b_bf16 v[76:79], v[12:13], v[84:85], 0
    v_mov_b32 v92, v7
    s_andn2_b64 s[80:81], s[80:81], s[84:85]
    v_mfma_f32_4x4x4_16b_bf16 v[76:79], v[10:11], v[86:87], v[76:79]
    s_mov_b64 exec, -1
    ds_read_b64 v[68:69], v92 offset:65408
    v_and_b32 v46, 0x80000000, v21
    v_lshrrev_b32 v47, 14, v19
    v_bitop3_b32 v47, v47, v5, v46 bitop3:0xea
    ds_read_b64 v[106:107], v47
    v_bitop3_b32 v95, v19, v5, v46 bitop3:0xea
    v_and_b32 v46, 0x40000000, v21
    v_lshrrev_b32 v47, 14, v18
    v_bitop3_b32 v47, v47, v5, v46 bitop3:0xea
    ds_read_b64 v[104:105], v47
    v_bitop3_b32 v94, v18, v5, v46 bitop3:0xea
    s_waitcnt lgkmcnt(2)
    v_mfma_f32_4x4x4_16b_bf16 v[80:83], v[10:11], v[70:71], v[80:83]
    v_mfma_f32_4x4x4_16b_bf16 v[76:79], v[10:11], v[68:69], v[76:79]
    v_perm_b32 v15, v19, v20, s47
    v_bitop3_b32 v46, v19, 0.5, -0.5 bitop3:0xa8
    v_perm_b32 v14, v18, v20, s46
    v_bitop3_b32 v47, v18, 0.5, -0.5 bitop3:0xa8
    v_cvt_pk_bf16_f32 v80, v80, v81
    v_cvt_pk_bf16_f32 v81, v82, v83
    ds_wrxchg_rtn_b64 v[74:75], v93, v[80:81] offset:65408
    v_cvt_pk_bf16_f32 v76, v76, v77
    v_cvt_pk_bf16_f32 v77, v78, v79
    ds_wrxchg_rtn_b64 v[72:73], v92, v[76:77] offset:65408
    s_setprio 2
    s_waitcnt lgkmcnt(2)
    v_mfma_f32_4x4x4_16b_bf16 v[80:83], v[8:9], v[106:107], 0
    v_mfma_f32_4x4x4_16b_bf16 v[76:79], v[8:9], v[104:105], 0
    v_bitop3_b32 v15, v6, v15, v46 bitop3:0xca
    v_bitop3_b32 v14, v6, v14, v47 bitop3:0xca
    s_nop 1
    v_pk_mul_f32 v[80:81], v[80:81], v[14:15] op_sel:[0,1] op_sel_hi:[1,1]
    v_pk_mul_f32 v[82:83], v[82:83], v[14:15] op_sel:[0,1] op_sel_hi:[1,1]
    v_pk_mul_f32 v[76:77], v[76:77], v[14:15] op_sel:[0,0] op_sel_hi:[1,0]
    v_pk_mul_f32 v[78:79], v[78:79], v[14:15] op_sel:[0,0] op_sel_hi:[1,0]
    s_lshl_b32 s3, s32, 12
    v_subrev_u32 v122, s3, v3
    s_mul_i32 s3, s33, 20000
    v_add_u32 v118, s3, v122
    v_add_u32 v119, 0x4000, v118
    s_lshl_b32 s3, s34, 7
    v_lshrrev_b32 v123, 7, v118
    v_and_b32 v120, 0x70, v118
    v_lshl_add_u32 v120, v123, 13, v120
    v_add_u32 v120, s3, v120
    v_lshrrev_b32 v123, 7, v119
    v_and_b32 v121, 0x70, v119
    v_lshl_add_u32 v121, v123, 13, v121
    v_add_u32 v121, s3, v121
    v_cmp_le_u32 vcc, 3616, v122
    s_mov_b64 exec, vcc
    v_mov_b32 v119, 2.0
    v_mov_b32 v121, 2.0
    s_mov_b64 exec, -1
    v_and_b32 v123, 0x30, v122
    v_lshlrev_b32 v123, 2, v123
    buffer_load_dwordx4 v[48:51], v123, s[24:27], 0 offen
    buffer_load_dwordx4 v[52:55], v123, s[24:27], 0 offen offset:16
    buffer_load_dwordx2 v[56:57], v123, s[24:27], 0 offen offset:32
    s_mov_b32 s12, s4
    s_mov_b32 s13, s5
    s_mov_b32 s14, 0x138800
    s_mov_b32 s15, 0x20000
    s_mov_b32 s16, s28
    s_mov_b32 s17, s29
    s_mov_b32 s18, 0x4e2000
    s_mov_b32 s19, 0x20000
    v_lshrrev_b32 v123, 2, v120
    buffer_load_dword v116, v123, s[12:15], 0 offen
    buffer_load_dwordx4 v[108:111], v120, s[16:19], 0 offen
    v_lshrrev_b32 v123, 2, v121
    buffer_load_dword v117, v123, s[12:15], 0 offen
    buffer_load_dwordx4 v[112:115], v121, s[16:19], 0 offen
    s_waitcnt lgkmcnt(0)
    v_cmpx_ne_u64 vcc, v[74:75], v[70:71]
    s_and_b64 s[82:83], vcc, s[80:81]
    s_cbranch_scc1 L2_c131
L2_d131:
    v_mov_b64 v[84:85], v[70:71]
    v_mov_b32 v7, v93
    v_mov_b64 v[86:87], v[74:75]
    s_mov_b64 exec, -1
    s_or_b64 s[80:81], s[80:81], vcc
    v_cmpx_ne_u64 vcc, v[72:73], v[68:69]
    s_and_b64 s[82:83], vcc, s[80:81]
    s_cbranch_scc1 L2_c132
L2_d132:
    v_mov_b64 v[84:85], v[68:69]
    v_mov_b32 v7, v92
    v_mov_b64 v[86:87], v[72:73]
    s_mov_b64 exec, -1
    s_or_b64 s[80:81], s[80:81], vcc
    ds_read_b64 v[70:71], v95 offset:65408
    ds_read_b64 v[68:69], v94 offset:65408
    s_waitcnt vmcnt(11)
    v_and_b32 v46, 0x20000000, v27
    v_lshrrev_b32 v47, 14, v23
    v_bitop3_b32 v47, v47, v5, v46 bitop3:0xea
    ds_read_b64 v[102:103], v47
    v_bitop3_b32 v93, v23, v5, v46 bitop3:0xea
    v_and_b32 v46, 0x10000000, v27
    v_lshrrev_b32 v47, 14, v22
    v_bitop3_b32 v47, v47, v5, v46 bitop3:0xea
    ds_read_b64 v[100:101], v47
    v_bitop3_b32 v92, v22, v5, v46 bitop3:0xea
    s_waitcnt lgkmcnt(2)
    v_mfma_f32_4x4x4_16b_bf16 v[80:83], v[10:11], v[70:71], v[80:83]
    v_mfma_f32_4x4x4_16b_bf16 v[76:79], v[10:11], v[68:69], v[76:79]
    v_perm_b32 v15, v23, v26, s45
    v_bitop3_b32 v46, v23, 0.5, -0.5 bitop3:0xa8
    v_perm_b32 v14, v22, v26, s44
    v_bitop3_b32 v47, v22, 0.5, -0.5 bitop3:0xa8
    v_cvt_pk_bf16_f32 v80, v80, v81
    v_cvt_pk_bf16_f32 v81, v82, v83
    ds_wrxchg_rtn_b64 v[74:75], v95, v[80:81] offset:65408
    v_cvt_pk_bf16_f32 v76, v76, v77
    v_cvt_pk_bf16_f32 v77, v78, v79
    ds_wrxchg_rtn_b64 v[72:73], v94, v[76:77] offset:65408
    s_waitcnt lgkmcnt(2)
    v_mfma_f32_4x4x4_16b_bf16 v[80:83], v[8:9], v[102:103], 0
    v_mfma_f32_4x4x4_16b_bf16 v[76:79], v[8:9], v[100:101], 0
    v_bitop3_b32 v15, v6, v15, v46 bitop3:0xca
    v_bitop3_b32 v14, v6, v14, v47 bitop3:0xca
    v_cmp_lt_u32 s[84:85], v5, v92
    s_nop 0
    v_pk_mul_f32 v[80:81], v[80:81], v[14:15] op_sel:[0,1] op_sel_hi:[1,1]
    v_pk_mul_f32 v[82:83], v[82:83], v[14:15] op_sel:[0,1] op_sel_hi:[1,1]
    v_pk_mul_f32 v[76:77], v[76:77], v[14:15] op_sel:[0,0] op_sel_hi:[1,0]
    v_pk_mul_f32 v[78:79], v[78:79], v[14:15] op_sel:[0,0] op_sel_hi:[1,0]
    s_waitcnt lgkmcnt(0)
    v_cmpx_ne_u64 vcc, v[74:75], v[70:71]
    s_and_b64 s[82:83], vcc, s[80:81]
    s_cbranch_scc1 L2_c133
L2_d133:
    v_mov_b64 v[84:85], v[70:71]
    v_mov_b32 v7, v95
    v_mov_b64 v[86:87], v[74:75]
    s_mov_b64 exec, -1
    s_or_b64 s[80:81], s[80:81], vcc
    v_cmpx_ne_u64 vcc, v[72:73], v[68:69]
    s_and_b64 s[82:83], vcc, s[80:81]
    s_cbranch_scc1 L2_c134
L2_d134:
    v_mov_b64 v[84:85], v[68:69]
    v_mov_b32 v7, v94
    v_mov_b64 v[86:87], v[72:73]
    s_mov_b64 exec, -1
    s_or_b64 s[80:81], s[80:81], vcc
    ds_read_b64 v[70:71], v93 offset:65408
    s_and_b64 exec, s[84:85], s[80:81]
    v_mfma_f32_4x4x4_16b_bf16 v[76:79], v[12:13], v[84:85], 0
    v_mov_b32 v92, v7
    s_andn2_b64 s[80:81], s[80:81], s[84:85]
    v_mfma_f32_4x4x4_16b_bf16 v[76:79], v[10:11], v[86:87], v[76:79]
    s_mov_b64 exec, -1
    ds_read_b64 v[68:69], v92 offset:65408
    v_and_b32 v46, 0x80000000, v27
    v_lshrrev_b32 v47, 14, v25
    v_bitop3_b32 v47, v47, v5, v46 bitop3:0xea
    ds_read_b64 v[106:107], v47
    v_bitop3_b32 v95, v25, v5, v46 bitop3:0xea
    v_and_b32 v46, 0x40000000, v27
    v_lshrrev_b32 v47, 14, v24
    v_bitop3_b32 v47, v47, v5, v46 bitop3:0xea
    ds_read_b64 v[104:105], v47
    v_bitop3_b32 v94, v24, v5, v46 bitop3:0xea
    s_waitcnt lgkmcnt(2)
    v_mfma_f32_4x4x4_16b_bf16 v[80:83], v[10:11], v[70:71], v[80:83]
    v_mfma_f32_4x4x4_16b_bf16 v[76:79], v[10:11], v[68:69], v[76:79]
    v_perm_b32 v15, v25, v26, s47
    v_bitop3_b32 v46, v25, 0.5, -0.5 bitop3:0xa8
    v_perm_b32 v14, v24, v26, s46
    v_bitop3_b32 v47, v24, 0.5, -0.5 bitop3:0xa8
    v_cvt_pk_bf16_f32 v80, v80, v81
    v_cvt_pk_bf16_f32 v81, v82, v83
    ds_wrxchg_rtn_b64 v[74:75], v93, v[80:81] offset:65408
    v_cvt_pk_bf16_f32 v76, v76, v77
    v_cvt_pk_bf16_f32 v77, v78, v79
    ds_wrxchg_rtn_b64 v[72:73], v92, v[76:77] offset:65408
    s_setprio 1
    s_waitcnt lgkmcnt(2)
    v_mfma_f32_4x4x4_16b_bf16 v[80:83], v[8:9], v[106:107], 0
    v_mfma_f32_4x4x4_16b_bf16 v[76:79], v[8:9], v[104:105], 0
    v_bitop3_b32 v15, v6, v15, v46 bitop3:0xca
    v_bitop3_b32 v14, v6, v14, v47 bitop3:0xca
    s_nop 1
    v_pk_mul_f32 v[80:81], v[80:81], v[14:15] op_sel:[0,1] op_sel_hi:[1,1]
    v_pk_mul_f32 v[82:83], v[82:83], v[14:15] op_sel:[0,1] op_sel_hi:[1,1]
    v_pk_mul_f32 v[76:77], v[76:77], v[14:15] op_sel:[0,0] op_sel_hi:[1,0]
    v_pk_mul_f32 v[78:79], v[78:79], v[14:15] op_sel:[0,0] op_sel_hi:[1,0]
    s_waitcnt lgkmcnt(0)
    v_cmpx_ne_u64 vcc, v[74:75], v[70:71]
    s_and_b64 s[82:83], vcc, s[80:81]
    s_cbranch_scc1 L2_c135
L2_d135:
    v_mov_b64 v[84:85], v[70:71]
    v_mov_b32 v7, v93
    v_mov_b64 v[86:87], v[74:75]
    s_mov_b64 exec, -1
    s_or_b64 s[80:81], s[80:81], vcc
    v_cmpx_ne_u64 vcc, v[72:73], v[68:69]
    s_and_b64 s[82:83], vcc, s[80:81]
    s_cbranch_scc1 L2_c136
L2_d136:
    v_mov_b64 v[84:85], v[68:69]
    v_mov_b32 v7, v92
    v_mov_b64 v[86:87], v[72:73]
    s_mov_b64 exec, -1
    s_or_b64 s[80:81], s[80:81], vcc
    ds_read_b64 v[70:71], v95 offset:65408
    ds_read_b64 v[68:69], v94 offset:65408
    s_waitcnt vmcnt(9)
    v_and_b32 v46, 0x20000000, v33
    v_lshrrev_b32 v47, 14, v29
    v_bitop3_b32 v47, v47, v5, v46 bitop3:0xea
    ds_read_b64 v[102:103], v47
    v_bitop3_b32 v93, v29, v5, v46 bitop3:0xea
    v_and_b32 v46, 0x10000000, v33
    v_lshrrev_b32 v47, 14, v28
    v_bitop3_b32 v47, v47, v5, v46 bitop3:0xea
    ds_read_b64 v[100:101], v47
    v_bitop3_b32 v92, v28, v5, v46 bitop3:0xea
    s_waitcnt lgkmcnt(2)
    v_mfma_f32_4x4x4_16b_bf16 v[80:83], v[10:11], v[70:71], v[80:83]
    v_mfma_f32_4x4x4_16b_bf16 v[76:79], v[10:11], v[68:69], v[76:79]
    v_perm_b32 v15, v29, v32, s45
    v_bitop3_b32 v46, v29, 0.5, -0.5 bitop3:0xa8
    v_perm_b32 v14, v28, v32, s44
    v_bitop3_b32 v47, v28, 0.5, -0.5 bitop3:0xa8
    v_cvt_pk_bf16_f32 v80, v80, v81
    v_cvt_pk_bf16_f32 v81, v82, v83
    ds_wrxchg_rtn_b64 v[74:75], v95, v[80:81] offset:65408
    v_cvt_pk_bf16_f32 v76, v76, v77
    v_cvt_pk_bf16_f32 v77, v78, v79
    ds_wrxchg_rtn_b64 v[72:73], v94, v[76:77] offset:65408
    s_waitcnt lgkmcnt(2)
    v_mfma_f32_4x4x4_16b_bf16 v[80:83], v[8:9], v[102:103], 0
    v_mfma_f32_4x4x4_16b_bf16 v[76:79], v[8:9], v[100:101], 0
    v_bitop3_b32 v15, v6, v15, v46 bitop3:0xca
    v_bitop3_b32 v14, v6, v14, v47 bitop3:0xca
    v_cmp_lt_u32 s[84:85], v5, v92
    s_nop 0
    v_pk_mul_f32 v[80:81], v[80:81], v[14:15] op_sel:[0,1] op_sel_hi:[1,1]
    v_pk_mul_f32 v[82:83], v[82:83], v[14:15] op_sel:[0,1] op_sel_hi:[1,1]
    v_pk_mul_f32 v[76:77], v[76:77], v[14:15] op_sel:[0,0] op_sel_hi:[1,0]
    v_pk_mul_f32 v[78:79], v[78:79], v[14:15] op_sel:[0,0] op_sel_hi:[1,0]
    s_waitcnt lgkmcnt(0)
    v_cmpx_ne_u64 vcc, v[74:75], v[70:71]
    s_and_b64 s[82:83], vcc, s[80:81]
    s_cbranch_scc1 L2_c137
L2_d137:
    v_mov_b64 v[84:85], v[70:71]
    v_mov_b32 v7, v95
    v_mov_b64 v[86:87], v[74:75]
    s_mov_b64 exec, -1
    s_or_b64 s[80:81], s[80:81], vcc
    v_cmpx_ne_u64 vcc, v[72:73], v[68:69]
    s_and_b64 s[82:83], vcc, s[80:81]
    s_cbranch_scc1 L2_c138
L2_d138:
    v_mov_b64 v[84:85], v[68:69]
    v_mov_b32 v7, v94
    v_mov_b64 v[86:87], v[72:73]
    s_mov_b64 exec, -1
    s_or_b64 s[80:81], s[80:81], vcc
    ds_read_b64 v[70:71], v93 offset:65408
    s_and_b64 exec, s[84:85], s[80:81]
    v_mfma_f32_4x4x4_16b_bf16 v[76:79], v[12:13], v[84:85], 0
    v_mov_b32 v92, v7
    s_andn2_b64 s[80:81], s[80:81], s[84:85]
    v_mfma_f32_4x4x4_16b_bf16 v[76:79], v[10:11], v[86:87], v[76:79]
    s_mov_b64 exec, -1
    ds_read_b64 v[68:69], v92 offset:65408
    v_and_b32 v46, 0x80000000, v33
    v_lshrrev_b32 v47, 14, v31
    v_bitop3_b32 v47, v47, v5, v46 bitop3:0xea
    ds_read_b64 v[106:107], v47
    v_bitop3_b32 v95, v31, v5, v46 bitop3:0xea
    v_and_b32 v46, 0x40000000, v33
    v_lshrrev_b32 v47, 14, v30
    v_bitop3_b32 v47, v47, v5, v46 bitop3:0xea
    ds_read_b64 v[104:105], v47
    v_bitop3_b32 v94, v30, v5, v46 bitop3:0xea
    s_waitcnt lgkmcnt(2)
    v_mfma_f32_4x4x4_16b_bf16 v[80:83], v[10:11], v[70:71], v[80:83]
    v_mfma_f32_4x4x4_16b_bf16 v[76:79], v[10:11], v[68:69], v[76:79]
    v_perm_b32 v15, v31, v32, s47
    v_bitop3_b32 v46, v31, 0.5, -0.5 bitop3:0xa8
    v_perm_b32 v14, v30, v32, s46
    v_bitop3_b32 v47, v30, 0.5, -0.5 bitop3:0xa8
    v_cvt_pk_bf16_f32 v80, v80, v81
    v_cvt_pk_bf16_f32 v81, v82, v83
    ds_wrxchg_rtn_b64 v[74:75], v93, v[80:81] offset:65408
    v_cvt_pk_bf16_f32 v76, v76, v77
    v_cvt_pk_bf16_f32 v77, v78, v79
    ds_wrxchg_rtn_b64 v[72:73], v92, v[76:77] offset:65408
    s_setprio 0
    s_waitcnt lgkmcnt(2)
    v_mfma_f32_4x4x4_16b_bf16 v[80:83], v[8:9], v[106:107], 0
    v_mfma_f32_4x4x4_16b_bf16 v[76:79], v[8:9], v[104:105], 0
    v_bitop3_b32 v15, v6, v15, v46 bitop3:0xca
    v_bitop3_b32 v14, v6, v14, v47 bitop3:0xca
    s_nop 1
    v_pk_mul_f32 v[80:81], v[80:81], v[14:15] op_sel:[0,1] op_sel_hi:[1,1]
    v_pk_mul_f32 v[82:83], v[82:83], v[14:15] op_sel:[0,1] op_sel_hi:[1,1]
    v_pk_mul_f32 v[76:77], v[76:77], v[14:15] op_sel:[0,0] op_sel_hi:[1,0]
    v_pk_mul_f32 v[78:79], v[78:79], v[14:15] op_sel:[0,0] op_sel_hi:[1,0]
    s_waitcnt lgkmcnt(0)
    v_cmpx_ne_u64 vcc, v[74:75], v[70:71]
    s_and_b64 s[82:83], vcc, s[80:81]
    s_cbranch_scc1 L2_c139
L2_d139:
    v_mov_b64 v[84:85], v[70:71]
    v_mov_b32 v7, v93
    v_mov_b64 v[86:87], v[74:75]
    s_mov_b64 exec, -1
    s_or_b64 s[80:81], s[80:81], vcc
    v_cmpx_ne_u64 vcc, v[72:73], v[68:69]
    s_and_b64 s[82:83], vcc, s[80:81]
    s_cbranch_scc1 L2_c140
L2_d140:
    v_mov_b64 v[84:85], v[68:69]
    v_mov_b32 v7, v92
    v_mov_b64 v[86:87], v[72:73]
    s_mov_b64 exec, -1
    s_or_b64 s[80:81], s[80:81], vcc
    ds_read_b64 v[70:71], v95 offset:65408
    ds_read_b64 v[68:69], v94 offset:65408
    s_waitcnt vmcnt(7)
    v_and_b32 v46, 0x20000000, v39
    v_lshrrev_b32 v47, 14, v35
    v_bitop3_b32 v47, v47, v5, v46 bitop3:0xea
    ds_read_b64 v[102:103], v47
    v_bitop3_b32 v93, v35, v5, v46 bitop3:0xea
    v_and_b32 v46, 0x10000000, v39
    v_lshrrev_b32 v47, 14, v34
    v_bitop3_b32 v47, v47, v5, v46 bitop3:0xea
    ds_read_b64 v[100:101], v47
    v_bitop3_b32 v92, v34, v5, v46 bitop3:0xea
    v_and_b32 v46, 0x80000000, v39
    v_lshrrev_b32 v47, 14, v37
    v_bitop3_b32 v47, v47, v5, v46 bitop3:0xea
    ds_read_b64 v[106:107], v47
    v_and_b32 v46, 0x40000000, v39
    v_lshrrev_b32 v47, 14, v36
    v_bitop3_b32 v47, v47, v5, v46 bitop3:0xea
    ds_read_b64 v[104:105], v47
    s_waitcnt lgkmcnt(4)
    v_mfma_f32_4x4x4_16b_bf16 v[80:83], v[10:11], v[70:71], v[80:83]
    v_mfma_f32_4x4x4_16b_bf16 v[76:79], v[10:11], v[68:69], v[76:79]
    v_perm_b32 v15, v35, v38, s45
    v_bitop3_b32 v46, v35, 0.5, -0.5 bitop3:0xa8
    v_perm_b32 v14, v34, v38, s44
    v_bitop3_b32 v47, v34, 0.5, -0.5 bitop3:0xa8
    v_cvt_pk_bf16_f32 v80, v80, v81
    v_cvt_pk_bf16_f32 v81, v82, v83
    ds_wrxchg_rtn_b64 v[74:75], v95, v[80:81] offset:65408
    v_cvt_pk_bf16_f32 v76, v76, v77
    v_cvt_pk_bf16_f32 v77, v78, v79
    ds_wrxchg_rtn_b64 v[72:73], v94, v[76:77] offset:65408
    s_waitcnt lgkmcnt(4)
    v_mfma_f32_4x4x4_16b_bf16 v[80:83], v[8:9], v[102:103], 0
    v_mfma_f32_4x4x4_16b_bf16 v[76:79], v[8:9], v[100:101], 0
    v_bitop3_b32 v15, v6, v15, v46 bitop3:0xca
    v_bitop3_b32 v14, v6, v14, v47 bitop3:0xca
    v_cmp_lt_u32 s[84:85], v5, v92
    s_nop 0
    v_pk_mul_f32 v[80:81], v[80:81], v[14:15] op_sel:[0,1] op_sel_hi:[1,1]
    v_pk_mul_f32 v[82:83], v[82:83], v[14:15] op_sel:[0,1] op_sel_hi:[1,1]
    v_pk_mul_f32 v[76:77], v[76:77], v[14:15] op_sel:[0,0] op_sel_hi:[1,0]
    v_pk_mul_f32 v[78:79], v[78:79], v[14:15] op_sel:[0,0] op_sel_hi:[1,0]
    s_waitcnt lgkmcnt(0)
    v_cmpx_ne_u64 vcc, v[74:75], v[70:71]
    s_and_b64 s[82:83], vcc, s[80:81]
    s_cbranch_scc1 L2_c141
L2_d141:
    v_mov_b64 v[84:85], v[70:71]
    v_mov_b32 v7, v95
    v_mov_b64 v[86:87], v[74:75]
    s_mov_b64 exec, -1
    s_or_b64 s[80:81], s[80:81], vcc
    v_cmpx_ne_u64 vcc, v[72:73], v[68:69]
    s_and_b64 s[82:83], vcc, s[80:81]
    s_cbranch_scc1 L2_c142
L2_d142:
    v_mov_b64 v[84:85], v[68:69]
    v_mov_b32 v7, v94
    v_mov_b64 v[86:87], v[72:73]
    s_mov_b64 exec, -1
    s_or_b64 s[80:81], s[80:81], vcc
    ds_read_b64 v[70:71], v93 offset:65408
    s_and_b64 exec, s[84:85], s[80:81]
    v_mfma_f32_4x4x4_16b_bf16 v[76:79], v[12:13], v[84:85], 0
    v_mov_b32 v92, v7
    s_andn2_b64 s[80:81], s[80:81], s[84:85]
    v_mfma_f32_4x4x4_16b_bf16 v[76:79], v[10:11], v[86:87], v[76:79]
    s_mov_b64 exec, -1
    ds_read_b64 v[68:69], v92 offset:65408
    s_waitcnt lgkmcnt(0)
    v_mfma_f32_4x4x4_16b_bf16 v[80:83], v[10:11], v[70:71], v[80:83]
    v_mfma_f32_4x4x4_16b_bf16 v[76:79], v[10:11], v[68:69], v[76:79]
    v_and_b32 v46, 0x40000000, v39
    v_bitop3_b32 v94, v36, v5, v46 bitop3:0xea
    v_and_b32 v46, 0x80000000, v39
    v_bitop3_b32 v95, v37, v5, v46 bitop3:0xea
    v_perm_b32 v15, v37, v38, s47
    v_bitop3_b32 v46, v37, 0.5, -0.5 bitop3:0xa8
    v_perm_b32 v14, v36, v38, s46
    v_bitop3_b32 v47, v36, 0.5, -0.5 bitop3:0xa8
    v_cvt_pk_bf16_f32 v80, v80, v81
    v_cvt_pk_bf16_f32 v81, v82, v83
    ds_wrxchg_rtn_b64 v[74:75], v93, v[80:81] offset:65408
    v_cvt_pk_bf16_f32 v76, v76, v77
    v_cvt_pk_bf16_f32 v77, v78, v79
    ds_wrxchg_rtn_b64 v[72:73], v92, v[76:77] offset:65408
    v_mfma_f32_4x4x4_16b_bf16 v[80:83], v[8:9], v[106:107], 0
    v_mfma_f32_4x4x4_16b_bf16 v[76:79], v[8:9], v[104:105], 0
    v_bitop3_b32 v15, v6, v15, v46 bitop3:0xca
    v_bitop3_b32 v14, v6, v14, v47 bitop3:0xca
    s_nop 1
    v_pk_mul_f32 v[80:81], v[80:81], v[14:15] op_sel:[0,1] op_sel_hi:[1,1]
    v_pk_mul_f32 v[82:83], v[82:83], v[14:15] op_sel:[0,1] op_sel_hi:[1,1]
    v_pk_mul_f32 v[76:77], v[76:77], v[14:15] op_sel:[0,0] op_sel_hi:[1,0]
    v_pk_mul_f32 v[78:79], v[78:79], v[14:15] op_sel:[0,0] op_sel_hi:[1,0]
    s_waitcnt lgkmcnt(0)
    v_cmpx_ne_u64 vcc, v[74:75], v[70:71]
    s_and_b64 s[82:83], vcc, s[80:81]
    s_cbranch_scc1 L2_c143
L2_d143:
    v_mov_b64 v[84:85], v[70:71]
    v_mov_b32 v7, v93
    v_mov_b64 v[86:87], v[74:75]
    s_mov_b64 exec, -1
    s_or_b64 s[80:81], s[80:81], vcc
    v_cmpx_ne_u64 vcc, v[72:73], v[68:69]
    s_and_b64 s[82:83], vcc, s[80:81]
    s_cbranch_scc1 L2_c144
L2_d144:
    v_mov_b64 v[84:85], v[68:69]
    v_mov_b32 v7, v92
    v_mov_b64 v[86:87], v[72:73]
    s_mov_b64 exec, -1
    s_or_b64 s[80:81], s[80:81], vcc
    ds_read_b64 v[70:71], v95 offset:65408
    ds_read_b64 v[68:69], v94 offset:65408
    s_waitcnt lgkmcnt(0)
    v_mfma_f32_4x4x4_16b_bf16 v[80:83], v[10:11], v[70:71], v[80:83]
    v_mfma_f32_4x4x4_16b_bf16 v[76:79], v[10:11], v[68:69], v[76:79]
    s_nop 3
    v_cvt_pk_bf16_f32 v80, v80, v81
    v_cvt_pk_bf16_f32 v81, v82, v83
    ds_wrxchg_rtn_b64 v[74:75], v95, v[80:81] offset:65408
    v_cvt_pk_bf16_f32 v76, v76, v77
    v_cvt_pk_bf16_f32 v77, v78, v79
    ds_wrxchg_rtn_b64 v[72:73], v94, v[76:77] offset:65408
    s_waitcnt lgkmcnt(0)
    v_cmpx_ne_u64 vcc, v[74:75], v[70:71]
    s_and_b64 s[82:83], vcc, s[80:81]
    s_cbranch_scc1 L2_c145
L2_d145:
    v_mov_b64 v[84:85], v[70:71]
    v_mov_b32 v7, v95
    v_mov_b64 v[86:87], v[74:75]
    s_mov_b64 exec, -1
    s_or_b64 s[80:81], s[80:81], vcc
    v_cmpx_ne_u64 vcc, v[72:73], v[68:69]
    s_and_b64 s[82:83], vcc, s[80:81]
    s_cbranch_scc1 L2_c146
L2_d146:
    v_mov_b64 v[84:85], v[68:69]
    v_mov_b32 v7, v94
    v_mov_b64 v[86:87], v[72:73]
    s_mov_b64 exec, -1
    s_or_b64 s[80:81], s[80:81], vcc
    s_mov_b64 exec, s[80:81]
    s_nop 1
    v_mfma_f32_4x4x4_16b_bf16 v[88:91], v[12:13], v[84:85], 0
    s_nop 1
    v_mfma_f32_4x4x4_16b_bf16 v[88:91], v[10:11], v[86:87], v[88:91]
    s_nop 4
    v_cvt_pk_bf16_f32 v88, v88, v89
    v_cvt_pk_bf16_f32 v89, v90, v91
    ds_pk_add_bf16 v7, v88 offset:65408
    ds_pk_add_bf16 v7, v89 offset:65412
    s_mov_b64 exec, -1
    s_load_dwordx2 s[4:5], s[0:1], 88
    v_add_u32 v123, 16384, v122
    v_add_u32 v124, 32768, v122
    v_add_u32 v125, 49152, v122
    v_add_u32 v126, 65536, v122
    s_lshl_b32 s50, s96, 16
    s_and_b32 s51, s96, 0xffff0000
    s_lshl_b32 s52, s97, 16
    s_and_b32 s53, s97, 0xffff0000
    s_lshl_b32 s54, s98, 16
    s_and_b32 s55, s98, 0xffff0000
    s_lshl_b32 s56, s99, 16
    s_and_b32 s57, s99, 0xffff0000
    s_waitcnt vmcnt(0) lgkmcnt(0)
    s_barrier
    v_add_u32 v36, 0x8000, v126
    ds_read_b128 v[16:19], v126 offset:16384
    ds_read_b128 v[20:23], v126 offset:32768
    ds_read_b128 v[24:27], v126 offset:49152
    ds_read_b128 v[28:31], v36 offset:32768
    ds_read_b128 v[32:35], v36 offset:49152
    s_add_u32 s8, s30, 0xebca000
    s_addc_u32 s9, s31, 0
    s_mov_b32 s10, 0x8000
    s_mov_b32 s11, 0x20000
    s_mov_b32 s12, s4
    s_mov_b32 s13, s5
    s_mov_b32 s14, 0x4e2000
    s_mov_b32 s15, 0x20000
    s_mul_i32 s3, s33, 20000
    v_subrev_u32 v36, s3, v122
    v_cmp_le_u32 vcc, 20000, v36
    s_waitcnt lgkmcnt(4)
    s_mov_b64 exec, vcc
    buffer_store_dwordx4 v[16:19], v122, s[20:23], 0 offen sc1
    s_mov_b64 exec, -1
    v_subrev_u32 v36, s3, v123
    v_cmp_le_u32 vcc, 20000, v36
    s_waitcnt lgkmcnt(3)
    s_mov_b64 exec, vcc
    buffer_store_dwordx4 v[20:23], v123, s[20:23], 0 offen sc1
    s_mov_b64 exec, -1
    v_subrev_u32 v36, s3, v124
    v_cmp_le_u32 vcc, 20000, v36
    s_waitcnt lgkmcnt(2)
    s_mov_b64 exec, vcc
    buffer_store_dwordx4 v[24:27], v124, s[20:23], 0 offen sc1
    s_mov_b64 exec, -1
    v_subrev_u32 v36, s3, v125
    v_cmp_le_u32 vcc, 20000, v36
    s_waitcnt lgkmcnt(1)
    s_mov_b64 exec, vcc
    buffer_store_dwordx4 v[28:31], v125, s[20:23], 0 offen sc1
    s_mov_b64 exec, -1
    v_subrev_u32 v36, s3, v126
    v_cmp_le_u32 vcc, 20000, v36
    s_waitcnt lgkmcnt(0)
    s_mov_b64 exec, vcc
    buffer_store_dwordx4 v[32:35], v126, s[20:23], 0 offen sc1
    s_mov_b64 exec, -1
    v_lshlrev_b32 v80, 16, v116
    v_subrev_f32 v60, s50, v80
    v_subrev_f32 v61, s51, v80
    v_subrev_f32 v62, s52, v80
    v_subrev_f32 v63, s53, v80
    v_subrev_f32 v64, s54, v80
    v_subrev_f32 v65, s55, v80
    v_subrev_f32 v66, s56, v80
    v_subrev_f32 v67, s57, v80
    v_cvt_pk_bf16_f32 v68, v60, v61
    v_cvt_pk_bf16_f32 v69, v62, v63
    v_cvt_pk_bf16_f32 v70, v64, v65
    v_cvt_pk_bf16_f32 v71, v66, v67
    v_lshlrev_b32 v60, 16, v68
    v_and_b32 v61, 0xffff0000, v68
    v_lshlrev_b32 v62, 16, v69
    v_and_b32 v63, 0xffff0000, v69
    v_lshlrev_b32 v64, 16, v70
    v_and_b32 v65, 0xffff0000, v70
    v_lshlrev_b32 v66, 16, v71
    v_and_b32 v67, 0xffff0000, v71
    v_mul_f32 v60, v60, v60
    v_mul_f32 v61, v61, v61
    v_mul_f32 v62, v62, v62
    v_mul_f32 v63, v63, v63
    v_mul_f32 v64, v64, v64
    v_mul_f32 v65, v65, v65
    v_mul_f32 v66, v66, v66
    v_mul_f32 v67, v67, v67
    v_cvt_pk_bf16_f32 v68, v60, v61
    v_cvt_pk_bf16_f32 v69, v62, v63
    v_cvt_pk_bf16_f32 v70, v64, v65
    v_cvt_pk_bf16_f32 v71, v66, v67
    v_lshlrev_b32 v60, 16, v68
    v_and_b32 v61, 0xffff0000, v68
    v_lshlrev_b32 v62, 16, v69
    v_and_b32 v63, 0xffff0000, v69
    v_lshlrev_b32 v64, 16, v70
    v_and_b32 v65, 0xffff0000, v70
    v_lshlrev_b32 v66, 16, v71
    v_and_b32 v67, 0xffff0000, v71
    v_mul_f32 v60, 0xc1200000, v60
    v_mul_f32 v61, 0xc1200000, v61
    v_mul_f32 v62, 0xc1200000, v62
    v_mul_f32 v63, 0xc1200000, v63
    v_mul_f32 v64, 0xc1200000, v64
    v_mul_f32 v65, 0xc1200000, v65
    v_mul_f32 v66, 0xc1200000, v66
    v_mul_f32 v67, 0xc1200000, v67
    v_cvt_pk_bf16_f32 v68, v60, v61
    v_cvt_pk_bf16_f32 v69, v62, v63
    v_cvt_pk_bf16_f32 v70, v64, v65
    v_cvt_pk_bf16_f32 v71, v66, v67
    v_lshlrev_b32 v60, 16, v68
    v_and_b32 v61, 0xffff0000, v68
    v_lshlrev_b32 v62, 16, v69
    v_and_b32 v63, 0xffff0000, v69
    v_lshlrev_b32 v64, 16, v70
    v_and_b32 v65, 0xffff0000, v70
    v_lshlrev_b32 v66, 16, v71
    v_and_b32 v67, 0xffff0000, v71
    v_mul_f32 v60, 0x3fb8aa3b, v60
    v_mul_f32 v61, 0x3fb8aa3b, v61
    v_mul_f32 v62, 0x3fb8aa3b, v62
    v_mul_f32 v63, 0x3fb8aa3b, v63
    v_mul_f32 v64, 0x3fb8aa3b, v64
    v_mul_f32 v65, 0x3fb8aa3b, v65
    v_mul_f32 v66, 0x3fb8aa3b, v66
    v_mul_f32 v67, 0x3fb8aa3b, v67
    v_exp_f32 v60, v60
    v_exp_f32 v61, v61
    v_exp_f32 v62, v62
    v_exp_f32 v63, v63
    v_exp_f32 v64, v64
    v_exp_f32 v65, v65
    v_exp_f32 v66, v66
    v_exp_f32 v67, v67
    v_cvt_pk_bf16_f32 v72, v60, v61
    v_cvt_pk_bf16_f32 v73, v62, v63
    v_cvt_pk_bf16_f32 v74, v64, v65
    v_cvt_pk_bf16_f32 v75, v66, v67
    v_and_b32 v80, 0xffff0000, v116
    v_subrev_f32 v60, s50, v80
    v_subrev_f32 v61, s51, v80
    v_subrev_f32 v62, s52, v80
    v_subrev_f32 v63, s53, v80
    v_subrev_f32 v64, s54, v80
    v_subrev_f32 v65, s55, v80
    v_subrev_f32 v66, s56, v80
    v_subrev_f32 v67, s57, v80
    v_cvt_pk_bf16_f32 v68, v60, v61
    v_cvt_pk_bf16_f32 v69, v62, v63
    v_cvt_pk_bf16_f32 v70, v64, v65
    v_cvt_pk_bf16_f32 v71, v66, v67
    v_lshlrev_b32 v60, 16, v68
    v_and_b32 v61, 0xffff0000, v68
    v_lshlrev_b32 v62, 16, v69
    v_and_b32 v63, 0xffff0000, v69
    v_lshlrev_b32 v64, 16, v70
    v_and_b32 v65, 0xffff0000, v70
    v_lshlrev_b32 v66, 16, v71
    v_and_b32 v67, 0xffff0000, v71
    v_mul_f32 v60, v60, v60
    v_mul_f32 v61, v61, v61
    v_mul_f32 v62, v62, v62
    v_mul_f32 v63, v63, v63
    v_mul_f32 v64, v64, v64
    v_mul_f32 v65, v65, v65
    v_mul_f32 v66, v66, v66
    v_mul_f32 v67, v67, v67
    v_cvt_pk_bf16_f32 v68, v60, v61
    v_cvt_pk_bf16_f32 v69, v62, v63
    v_cvt_pk_bf16_f32 v70, v64, v65
    v_cvt_pk_bf16_f32 v71, v66, v67
    v_lshlrev_b32 v60, 16, v68
    v_and_b32 v61, 0xffff0000, v68
    v_lshlrev_b32 v62, 16, v69
    v_and_b32 v63, 0xffff0000, v69
    v_lshlrev_b32 v64, 16, v70
    v_and_b32 v65, 0xffff0000, v70
    v_lshlrev_b32 v66, 16, v71
    v_and_b32 v67, 0xffff0000, v71
    v_mul_f32 v60, 0xc1200000, v60
    v_mul_f32 v61, 0xc1200000, v61
    v_mul_f32 v62, 0xc1200000, v62
    v_mul_f32 v63, 0xc1200000, v63
    v_mul_f32 v64, 0xc1200000, v64
    v_mul_f32 v65, 0xc1200000, v65
    v_mul_f32 v66, 0xc1200000, v66
    v_mul_f32 v67, 0xc1200000, v67
    v_cvt_pk_bf16_f32 v68, v60, v61
    v_cvt_pk_bf16_f32 v69, v62, v63
    v_cvt_pk_bf16_f32 v70, v64, v65
    v_cvt_pk_bf16_f32 v71, v66, v67
    v_lshlrev_b32 v60, 16, v68
    v_and_b32 v61, 0xffff0000, v68
    v_lshlrev_b32 v62, 16, v69
    v_and_b32 v63, 0xffff0000, v69
    v_lshlrev_b32 v64, 16, v70
    v_and_b32 v65, 0xffff0000, v70
    v_lshlrev_b32 v66, 16, v71
    v_and_b32 v67, 0xffff0000, v71
    v_mul_f32 v60, 0x3fb8aa3b, v60
    v_mul_f32 v61, 0x3fb8aa3b, v61
    v_mul_f32 v62, 0x3fb8aa3b, v62
    v_mul_f32 v63, 0x3fb8aa3b, v63
    v_mul_f32 v64, 0x3fb8aa3b, v64
    v_mul_f32 v65, 0x3fb8aa3b, v65
    v_mul_f32 v66, 0x3fb8aa3b, v66
    v_mul_f32 v67, 0x3fb8aa3b, v67
    v_exp_f32 v60, v60
    v_exp_f32 v61, v61
    v_exp_f32 v62, v62
    v_exp_f32 v63, v63
    v_exp_f32 v64, v64
    v_exp_f32 v65, v65
    v_exp_f32 v66, v66
    v_exp_f32 v67, v67
    v_cvt_pk_bf16_f32 v76, v60, v61
    v_cvt_pk_bf16_f32 v77, v62, v63
    v_cvt_pk_bf16_f32 v78, v64, v65
    v_cvt_pk_bf16_f32 v79, v66, v67
    v_mfma_f32_4x4x4_16b_bf16 v[80:83], v[48:49], v[72:73], 0
    v_mfma_f32_4x4x4_16b_bf16 v[88:91], v[52:53], v[72:73], 0
    v_mfma_f32_4x4x4_16b_bf16 v[84:87], v[48:49], v[76:77], 0
    v_mfma_f32_4x4x4_16b_bf16 v[92:95], v[52:53], v[76:77], 0
    v_mfma_f32_4x4x4_16b_bf16 v[80:83], v[50:51], v[74:75], v[80:83]
    v_mfma_f32_4x4x4_16b_bf16 v[88:91], v[54:55], v[74:75], v[88:91]
    v_mfma_f32_4x4x4_16b_bf16 v[84:87], v[50:51], v[78:79], v[84:87]
    v_mfma_f32_4x4x4_16b_bf16 v[92:95], v[54:55], v[78:79], v[92:95]
    v_add_u32 v104, 81920, v118
    ds_read_b128 v[32:35], v104
    v_add_u32 v104, 81920, v119
    ds_read_b128 v[60:63], v104
    s_add_u32 s20, s30, 0xd841000
    s_addc_u32 s21, s31, 0
    s_mov_b32 s22, 0x1388000
    s_mov_b32 s23, 0x20000
    s_add_u32 s3, s33, 1
    s_and_b32 s3, s3, 3
    s_lshl_b32 s3, s3, 6
    s_add_u32 s3, s3, s34
    s_mul_i32 s44, s3, 80000
    s_add_u32 s3, s33, 2
    s_and_b32 s3, s3, 3
    s_lshl_b32 s3, s3, 6
    s_add_u32 s3, s3, s34
    s_mul_i32 s45, s3, 80000
    s_add_u32 s3, s33, 3
    s_and_b32 s3, s3, 3
    s_lshl_b32 s3, s3, 6
    s_add_u32 s3, s3, s34
    s_mul_i32 s46, s3, 80000
    s_lshl_b32 s3, s34, 9
    s_lshl_b32 s4, s33, 7
    s_add_u32 s4, s4, s3
    v_mov_b32 v104, 1
    v_lshlrev_b32 v105, 3, v122
    s_waitcnt vmcnt(0)
    s_barrier
    s_cmp_lg_u32 s32, 0
    s_cbranch_scc1 L2_f2
    s_mov_b64 exec, 1
    buffer_store_dword v104, off, s[8:11], s4 sc1
    s_mov_b64 exec, 15
    s_bitset0_b64 exec, s33
L2_f3:
    buffer_load_dword v104, v105, s[8:11], s3 offen sc1
    s_waitcnt vmcnt(0)
    v_cmp_ne_u32 vcc, 1, v104
    s_cbranch_vccnz L2_f3
L2_f4:
    s_mov_b64 exec, -1
L2_f2:
    s_barrier
    buffer_load_dwordx4 v[36:39], v118, s[20:23], s44 offen sc1
    buffer_load_dwordx4 v[40:43], v118, s[20:23], s45 offen sc1
    buffer_load_dwordx4 v[44:47], v118, s[20:23], s46 offen sc1
    s_cmp_ge_u32 s32, 4
    s_cbranch_scc1 L2_f5
    buffer_load_dwordx4 v[64:67], v119, s[20:23], s44 offen sc1
    buffer_load_dwordx4 v[68:71], v119, s[20:23], s45 offen sc1
    buffer_load_dwordx4 v[72:75], v119, s[20:23], s46 offen sc1
    v_lshlrev_b32 v16, 16, v117
    v_subrev_f32 v96, s50, v16
    v_subrev_f32 v97, s51, v16
    v_subrev_f32 v98, s52, v16
    v_subrev_f32 v99, s53, v16
    v_subrev_f32 v100, s54, v16
    v_subrev_f32 v101, s55, v16
    v_subrev_f32 v102, s56, v16
    v_subrev_f32 v103, s57, v16
    v_cvt_pk_bf16_f32 v0, v96, v97
    v_cvt_pk_bf16_f32 v1, v98, v99
    v_cvt_pk_bf16_f32 v2, v100, v101
    v_cvt_pk_bf16_f32 v3, v102, v103
    v_lshlrev_b32 v96, 16, v0
    v_and_b32 v97, 0xffff0000, v0
    v_lshlrev_b32 v98, 16, v1
    v_and_b32 v99, 0xffff0000, v1
    v_lshlrev_b32 v100, 16, v2
    v_and_b32 v101, 0xffff0000, v2
    v_lshlrev_b32 v102, 16, v3
    v_and_b32 v103, 0xffff0000, v3
    v_mul_f32 v96, v96, v96
    v_mul_f32 v97, v97, v97
    v_mul_f32 v98, v98, v98
    v_mul_f32 v99, v99, v99
    v_mul_f32 v100, v100, v100
    v_mul_f32 v101, v101, v101
    v_mul_f32 v102, v102, v102
    v_mul_f32 v103, v103, v103
    v_cvt_pk_bf16_f32 v0, v96, v97
    v_cvt_pk_bf16_f32 v1, v98, v99
    v_cvt_pk_bf16_f32 v2, v100, v101
    v_cvt_pk_bf16_f32 v3, v102, v103
    v_lshlrev_b32 v96, 16, v0
    v_and_b32 v97, 0xffff0000, v0
    v_lshlrev_b32 v98, 16, v1
    v_and_b32 v99, 0xffff0000, v1
    v_lshlrev_b32 v100, 16, v2
    v_and_b32 v101, 0xffff0000, v2
    v_lshlrev_b32 v102, 16, v3
    v_and_b32 v103, 0xffff0000, v3
    v_mul_f32 v96, 0xc1200000, v96
    v_mul_f32 v97, 0xc1200000, v97
    v_mul_f32 v98, 0xc1200000, v98
    v_mul_f32 v99, 0xc1200000, v99
    v_mul_f32 v100, 0xc1200000, v100
    v_mul_f32 v101, 0xc1200000, v101
    v_mul_f32 v102, 0xc1200000, v102
    v_mul_f32 v103, 0xc1200000, v103
    v_cvt_pk_bf16_f32 v0, v96, v97
    v_cvt_pk_bf16_f32 v1, v98, v99
    v_cvt_pk_bf16_f32 v2, v100, v101
    v_cvt_pk_bf16_f32 v3, v102, v103
    v_lshlrev_b32 v96, 16, v0
    v_and_b32 v97, 0xffff0000, v0
    v_lshlrev_b32 v98, 16, v1
    v_and_b32 v99, 0xffff0000, v1
    v_lshlrev_b32 v100, 16, v2
    v_and_b32 v101, 0xffff0000, v2
    v_lshlrev_b32 v102, 16, v3
    v_and_b32 v103, 0xffff0000, v3
    v_mul_f32 v96, 0x3fb8aa3b, v96
    v_mul_f32 v97, 0x3fb8aa3b, v97
    v_mul_f32 v98, 0x3fb8aa3b, v98
    v_mul_f32 v99, 0x3fb8aa3b, v99
    v_mul_f32 v100, 0x3fb8aa3b, v100
    v_mul_f32 v101, 0x3fb8aa3b, v101
    v_mul_f32 v102, 0x3fb8aa3b, v102
    v_mul_f32 v103, 0x3fb8aa3b, v103
    v_exp_f32 v96, v96
    v_exp_f32 v97, v97
    v_exp_f32 v98, v98
    v_exp_f32 v99, v99
    v_exp_f32 v100, v100
    v_exp_f32 v101, v101
    v_exp_f32 v102, v102
    v_exp_f32 v103, v103
    v_cvt_pk_bf16_f32 v104, v96, v97
    v_cvt_pk_bf16_f32 v105, v98, v99
    v_cvt_pk_bf16_f32 v106, v100, v101
    v_cvt_pk_bf16_f32 v107, v102, v103
    v_and_b32 v16, 0xffff0000, v117
    v_subrev_f32 v96, s50, v16
    v_subrev_f32 v97, s51, v16
    v_subrev_f32 v98, s52, v16
    v_subrev_f32 v99, s53, v16
    v_subrev_f32 v100, s54, v16
    v_subrev_f32 v101, s55, v16
    v_subrev_f32 v102, s56, v16
    v_subrev_f32 v103, s57, v16
    v_cvt_pk_bf16_f32 v0, v96, v97
    v_cvt_pk_bf16_f32 v1, v98, v99
    v_cvt_pk_bf16_f32 v2, v100, v101
    v_cvt_pk_bf16_f32 v3, v102, v103
    v_lshlrev_b32 v96, 16, v0
    v_and_b32 v97, 0xffff0000, v0
    v_lshlrev_b32 v98, 16, v1
    v_and_b32 v99, 0xffff0000, v1
    v_lshlrev_b32 v100, 16, v2
    v_and_b32 v101, 0xffff0000, v2
    v_lshlrev_b32 v102, 16, v3
    v_and_b32 v103, 0xffff0000, v3
    v_mul_f32 v96, v96, v96
    v_mul_f32 v97, v97, v97
    v_mul_f32 v98, v98, v98
    v_mul_f32 v99, v99, v99
    v_mul_f32 v100, v100, v100
    v_mul_f32 v101, v101, v101
    v_mul_f32 v102, v102, v102
    v_mul_f32 v103, v103, v103
    v_cvt_pk_bf16_f32 v0, v96, v97
    v_cvt_pk_bf16_f32 v1, v98, v99
    v_cvt_pk_bf16_f32 v2, v100, v101
    v_cvt_pk_bf16_f32 v3, v102, v103
    v_lshlrev_b32 v96, 16, v0
    v_and_b32 v97, 0xffff0000, v0
    v_lshlrev_b32 v98, 16, v1
    v_and_b32 v99, 0xffff0000, v1
    v_lshlrev_b32 v100, 16, v2
    v_and_b32 v101, 0xffff0000, v2
    v_lshlrev_b32 v102, 16, v3
    v_and_b32 v103, 0xffff0000, v3
    v_mul_f32 v96, 0xc1200000, v96
    v_mul_f32 v97, 0xc1200000, v97
    v_mul_f32 v98, 0xc1200000, v98
    v_mul_f32 v99, 0xc1200000, v99
    v_mul_f32 v100, 0xc1200000, v100
    v_mul_f32 v101, 0xc1200000, v101
    v_mul_f32 v102, 0xc1200000, v102
    v_mul_f32 v103, 0xc1200000, v103
    v_cvt_pk_bf16_f32 v0, v96, v97
    v_cvt_pk_bf16_f32 v1, v98, v99
    v_cvt_pk_bf16_f32 v2, v100, v101
    v_cvt_pk_bf16_f32 v3, v102, v103
    v_lshlrev_b32 v96, 16, v0
    v_and_b32 v97, 0xffff0000, v0
    v_lshlrev_b32 v98, 16, v1
    v_and_b32 v99, 0xffff0000, v1
    v_lshlrev_b32 v100, 16, v2
    v_and_b32 v101, 0xffff0000, v2
    v_lshlrev_b32 v102, 16, v3
    v_and_b32 v103, 0xffff0000, v3
    v_mul_f32 v96, 0x3fb8aa3b, v96
    v_mul_f32 v97, 0x3fb8aa3b, v97
    v_mul_f32 v98, 0x3fb8aa3b, v98
    v_mul_f32 v99, 0x3fb8aa3b, v99
    v_mul_f32 v100, 0x3fb8aa3b, v100
    v_mul_f32 v101, 0x3fb8aa3b, v101
    v_mul_f32 v102, 0x3fb8aa3b, v102
    v_mul_f32 v103, 0x3fb8aa3b, v103
    v_exp_f32 v96, v96
    v_exp_f32 v97, v97
    v_exp_f32 v98, v98
    v_exp_f32 v99, v99
    v_exp_f32 v100, v100
    v_exp_f32 v101, v101
    v_exp_f32 v102, v102
    v_exp_f32 v103, v103
    v_cvt_pk_bf16_f32 v76, v96, v97
    v_cvt_pk_bf16_f32 v77, v98, v99
    v_cvt_pk_bf16_f32 v78, v100, v101
    v_cvt_pk_bf16_f32 v79, v102, v103
    v_mfma_f32_4x4x4_16b_bf16 v[16:19], v[48:49], v[104:105], 0
    v_mfma_f32_4x4x4_16b_bf16 v[24:27], v[52:53], v[104:105], 0
    v_mfma_f32_4x4x4_16b_bf16 v[20:23], v[48:49], v[76:77], 0
    v_mfma_f32_4x4x4_16b_bf16 v[28:31], v[52:53], v[76:77], 0
    v_mfma_f32_4x4x4_16b_bf16 v[16:19], v[50:51], v[106:107], v[16:19]
    v_mfma_f32_4x4x4_16b_bf16 v[24:27], v[54:55], v[106:107], v[24:27]
    v_mfma_f32_4x4x4_16b_bf16 v[20:23], v[50:51], v[78:79], v[20:23]
    v_mfma_f32_4x4x4_16b_bf16 v[28:31], v[54:55], v[78:79], v[28:31]
L2_f5:
    s_waitcnt vmcnt(0) lgkmcnt(0)
    v_mfma_f32_4x4x4_16b_bf16 v[96:99], v[10:11], v[32:33], 0
    v_mfma_f32_4x4x4_16b_bf16 v[100:103], v[10:11], v[34:35], 0
    s_nop 0
    v_mfma_f32_4x4x4_16b_bf16 v[96:99], v[10:11], v[36:37], v[96:99]
    v_mfma_f32_4x4x4_16b_bf16 v[100:103], v[10:11], v[38:39], v[100:103]
    s_nop 0
    v_mfma_f32_4x4x4_16b_bf16 v[96:99], v[10:11], v[40:41], v[96:99]
    v_mfma_f32_4x4x4_16b_bf16 v[100:103], v[10:11], v[42:43], v[100:103]
    s_nop 0
    v_mfma_f32_4x4x4_16b_bf16 v[96:99], v[10:11], v[44:45], v[96:99]
    v_mfma_f32_4x4x4_16b_bf16 v[100:103], v[10:11], v[46:47], v[100:103]
    s_nop 3
    v_mul_f32 v96, v96, v80
    v_mul_f32 v97, v97, v81
    v_mul_f32 v98, v98, v82
    v_mul_f32 v99, v99, v83
    v_cvt_pk_bf16_f32 v32, v96, v97
    v_cvt_pk_bf16_f32 v33, v98, v99
    v_mul_f32 v100, v100, v84
    v_mul_f32 v101, v101, v85
    v_mul_f32 v102, v102, v86
    v_mul_f32 v103, v103, v87
    v_cvt_pk_bf16_f32 v34, v100, v101
    v_cvt_pk_bf16_f32 v35, v102, v103
    v_mfma_f32_4x4x4_16b_bf16 v[80:83], v[56:57], v[32:33], 0
    s_nop 0
    v_mfma_f32_4x4x4_16b_bf16 v[84:87], v[56:57], v[34:35], 0
    s_nop 2
    v_mul_f32 v80, v80, v88
    v_mul_f32 v81, v81, v89
    v_mul_f32 v82, v82, v90
    v_mul_f32 v83, v83, v91
    v_mul_f32 v84, v84, v92
    v_mul_f32 v85, v85, v93
    v_mul_f32 v86, v86, v94
    v_mul_f32 v87, v87, v95
    v_mfma_f32_4x4x4_16b_bf16 v[96:99], v[10:11], v[108:109], v[80:83]
    s_nop 0
    v_mfma_f32_4x4x4_16b_bf16 v[100:103], v[10:11], v[110:111], v[84:87]
    s_nop 2
    v_cvt_pk_bf16_f32 v36, v96, v97
    v_cvt_pk_bf16_f32 v37, v98, v99
    v_cvt_pk_bf16_f32 v38, v100, v101
    v_cvt_pk_bf16_f32 v39, v102, v103
    buffer_store_dwordx4 v[36:39], v120, s[12:15], 0 offen
    s_cmp_ge_u32 s32, 4
    s_cbranch_scc1 L2_f6
    v_mfma_f32_4x4x4_16b_bf16 v[96:99], v[10:11], v[60:61], 0
    v_mfma_f32_4x4x4_16b_bf16 v[100:103], v[10:11], v[62:63], 0
    s_nop 0
    v_mfma_f32_4x4x4_16b_bf16 v[96:99], v[10:11], v[64:65], v[96:99]
    v_mfma_f32_4x4x4_16b_bf16 v[100:103], v[10:11], v[66:67], v[100:103]
    s_nop 0
    v_mfma_f32_4x4x4_16b_bf16 v[96:99], v[10:11], v[68:69], v[96:99]
    v_mfma_f32_4x4x4_16b_bf16 v[100:103], v[10:11], v[70:71], v[100:103]
    s_nop 0
    v_mfma_f32_4x4x4_16b_bf16 v[96:99], v[10:11], v[72:73], v[96:99]
    v_mfma_f32_4x4x4_16b_bf16 v[100:103], v[10:11], v[74:75], v[100:103]
    s_nop 3
    v_mul_f32 v96, v96, v16
    v_mul_f32 v97, v97, v17
    v_mul_f32 v98, v98, v18
    v_mul_f32 v99, v99, v19
    v_cvt_pk_bf16_f32 v60, v96, v97
    v_cvt_pk_bf16_f32 v61, v98, v99
    v_mul_f32 v100, v100, v20
    v_mul_f32 v101, v101, v21
    v_mul_f32 v102, v102, v22
    v_mul_f32 v103, v103, v23
    v_cvt_pk_bf16_f32 v62, v100, v101
    v_cvt_pk_bf16_f32 v63, v102, v103
    v_mfma_f32_4x4x4_16b_bf16 v[16:19], v[56:57], v[60:61], 0
    s_nop 0
    v_mfma_f32_4x4x4_16b_bf16 v[20:23], v[56:57], v[62:63], 0
    s_nop 2
    v_mul_f32 v16, v16, v24
    v_mul_f32 v17, v17, v25
    v_mul_f32 v18, v18, v26
    v_mul_f32 v19, v19, v27
    v_mul_f32 v20, v20, v28
    v_mul_f32 v21, v21, v29
    v_mul_f32 v22, v22, v30
    v_mul_f32 v23, v23, v31
    v_mfma_f32_4x4x4_16b_bf16 v[96:99], v[10:11], v[112:113], v[16:19]
    s_nop 0
    v_mfma_f32_4x4x4_16b_bf16 v[100:103], v[10:11], v[114:115], v[20:23]
    s_nop 2
    v_cvt_pk_bf16_f32 v64, v96, v97
    v_cvt_pk_bf16_f32 v65, v98, v99
    v_cvt_pk_bf16_f32 v66, v100, v101
    v_cvt_pk_bf16_f32 v67, v102, v103
    buffer_store_dwordx4 v[64:67], v121, s[12:15], 0 offen
L2_f6:
L2_end:
    s_endpgm
L2_slow:
    s_lshr_b32 s35, s42, 2
    s_mul_i32 s50, s32, 80
    s_add_u32 s57, s50, 80
    s_and_b32 s3, s42, 3
    s_lshl_b32 s53, s3, 3
    s_add_u32 s53, s53, s39
    s_and_b32 s3, s35, 2
    s_lshl_b32 s3, s3, 1
    s_add_u32 s53, s53, s3
    s_and_b32 s54, s35, 1
    s_lshl_b32 s54, s54, 4
L2_sl_seg:
    s_mul_i32 s56, s50, 173056
    s_and_b32 s3, s50, 3
    s_lshl_b32 s3, s3, 5
    s_add_u32 s3, s3, s56
    s_add_u32 s3, s3, s53
    s_add_u32 s55, s3, 32
    s_buffer_load_dword s51, s[12:15], s3
    s_buffer_load_dword s52, s[12:15], s55
    s_waitcnt lgkmcnt(0)
    s_lshr_b32 s51, s51, s54
    s_and_b32 s51, s51, 0xffff
    s_lshr_b32 s52, s52, s54
    s_and_b32 s52, s52, 0xffff
L2_sl_rec:
    s_cmp_ge_u32 s51, s52
    s_cbranch_scc1 L2_sl_next
    v_mbcnt_lo_u32_b32 v102, -1, 0
    v_mbcnt_hi_u32_b32 v102, -1, v102
    v_add_u32 v102, s51, v102
    v_and_b32 v103, -4, v102
    v_lshl_add_u32 v104, v102, 2, v103
    v_lshl_add_u32 v105, v103, 2, v102
    v_cmp_gt_u32 vcc, s52, v102
    s_mov_b64 exec, vcc
    buffer_load_dword v106, v104, s[8:11], s56 offen
    buffer_load_ubyte v107, v105, s[8:11], s56 offen offset:16
    s_waitcnt vmcnt(0)
    v_lshrrev_b32 v98, 14, v106
    v_and_b32 v98, v5, v98
    ds_read_b64 v[100:101], v98
    v_perm_b32 v97, v106, v107, s44
    v_and_b32 v96, v5, v106
    v_bitop3_b32 v103, v106, 0.5, -0.5 bitop3:0xa8
    v_bitop3_b32 v97, v6, v97, v103 bitop3:0xca
    s_waitcnt lgkmcnt(0)
    v_mfma_f32_4x4x4_16b_bf16 v[88:91], v[8:9], v[100:101], 0
    s_nop 4
    v_mul_f32 v88, v97, v88
    v_mul_f32 v89, v97, v89
    v_mul_f32 v90, v97, v90
    v_mul_f32 v91, v97, v91
    v_cvt_pk_bf16_f32 v88, v88, v89
    v_cvt_pk_bf16_f32 v89, v90, v91
    ds_pk_add_bf16 v96, v88 offset:65408
    ds_pk_add_bf16 v96, v89 offset:65412
    s_mov_b64 exec, -1
    s_add_u32 s51, s51, 64
    s_branch L2_sl_rec
L2_sl_next:
    s_add_u32 s50, s50, 1
    s_cmp_lt_u32 s50, s57
    s_cbranch_scc1 L2_sl_seg
    s_waitcnt lgkmcnt(0)
    s_cmp_eq_u32 s42, 0
    s_cbranch_scc1 L2_ret0
    s_cmp_eq_u32 s42, 1
    s_cbranch_scc1 L2_ret1
    s_cmp_eq_u32 s42, 14
    s_cbranch_scc1 L2_ret6
    s_cmp_eq_u32 s42, 15
    s_cbranch_scc1 L2_ret7
    s_and_b32 s3, s42, 3
    s_cmp_eq_u32 s3, 2
    s_cbranch_scc1 L2_ret2
    s_cmp_eq_u32 s3, 3
    s_cbranch_scc1 L2_ret3
    s_cmp_eq_u32 s3, 0
    s_cbranch_scc1 L2_ret4
    s_branch L2_ret5
L2_xo1:
    v_cmp_lt_u32 vcc, 20, v99
    s_mov_b32 s43, 1
    s_cbranch_vccz L2_xp1
    v_cmp_lt_u32 vcc, 32, v99
    v_cmp_lt_u32 s[58:59], 31, v88
    s_mov_b32 s43, 2
    s_or_b64 vcc, vcc, s[58:59]
    s_cbranch_scc0 L2_xp1
    s_mov_b32 s37, 0x10000
    s_branch L2_xp1
L2_xa2:
    s_cmp_eq_u32 s43, 1
    s_cbranch_scc1 L2_xc2
    v_lshlrev_b32 v89, 0, v96
    v_add_u32 v90, 140, v97
    v_bitop3_b32 v90, v89, v45, v90 bitop3:0x6a
    ds_write_b32 v98, v90 offset:28
    v_lshlrev_b32 v89, 4, v96
    v_add_u32 v90, 120, v97
    v_bitop3_b32 v90, v89, v45, v90 bitop3:0x6a
    ds_write_b32 v98, v90 offset:24
    v_lshlrev_b32 v89, 8, v96
    v_add_u32 v90, 100, v97
    v_bitop3_b32 v90, v89, v45, v90 bitop3:0x6a
    ds_write_b32 v98, v90 offset:20
L2_xc2:
    v_lshlrev_b32 v89, 12, v96
    v_add_u32 v90, 80, v97
    v_bitop3_b32 v90, v89, v45, v90 bitop3:0x6a
    ds_write_b32 v98, v90 offset:16
    s_branch L2_xb2
L2_xe2:
    v_cmp_lt_u32 vcc, 32, v99
    v_cmp_lt_u32 s[58:59], 31, v88
    v_lshrrev_b32 v89, 16, v96
    v_add_u32 v97, 80, v97
    s_or_b64 vcc, vcc, s[58:59]
    s_cbranch_scc1 L2_xs2
    v_lshlrev_b32 v89, v1, v89
    v_and_b32 v89, v45, v89
    v_cmp_ne_u32 vcc, 0, v89
    v_xor_b32 v90, v97, v89
    s_add_u32 s3, s37, s38
    v_mbcnt_lo_u32_b32 v98, vcc_lo, 0
    v_mbcnt_hi_u32_b32 v98, vcc_hi, v98
    s_bcnt1_i32_b64 s41, vcc
    v_lshl_add_u32 v98, v98, 2, s3
    s_mov_b64 exec, vcc
    ds_write_b32 v98, v90
    s_mov_b64 exec, -1
    s_lshl2_add_u32 s37, s41, s37
    s_branch L2_xr2
L2_xf2:
    s_waitcnt lgkmcnt(0)
    s_cmp_gt_u32 s37, 1024
    s_cbranch_scc1 L2_xs2
    v_mov_b32 v43, -1
    s_cmp_ge_u32 s37, 512
    s_cbranch_scc1 L2_xg2
    v_mov_b32 v42, -1
    s_cmp_ge_u32 s37, 256
    s_cbranch_scc1 L2_xg2
    v_mov_b32 v41, -1
    s_branch L2_xg2
L2_xs2:
    s_waitcnt lgkmcnt(0)
    v_mov_b32 v40, -1
    v_mov_b32 v41, -1
    v_mov_b32 v42, -1
    v_mov_b32 v43, -1
    s_add_u32 s3, s42, 0
    s_bitset1_b32 s36, s3
    s_branch L2_xg2
L2_xo3:
    v_cmp_lt_u32 vcc, 20, v99
    s_mov_b32 s43, 1
    s_cbranch_vccz L2_xp3
    v_cmp_lt_u32 vcc, 32, v99
    v_cmp_lt_u32 s[58:59], 31, v88
    s_mov_b32 s43, 2
    s_or_b64 vcc, vcc, s[58:59]
    s_cbranch_scc0 L2_xp3
    s_mov_b32 s37, 0x10000
    s_branch L2_xp3
L2_xa4:
    s_cmp_eq_u32 s43, 1
    s_cbranch_scc1 L2_xc4
    v_lshlrev_b32 v89, 0, v96
    v_add_u32 v90, 140, v97
    v_bitop3_b32 v90, v89, v45, v90 bitop3:0x6a
    ds_write_b32 v98, v90 offset:28
    v_lshlrev_b32 v89, 4, v96
    v_add_u32 v90, 120, v97
    v_bitop3_b32 v90, v89, v45, v90 bitop3:0x6a
    ds_write_b32 v98, v90 offset:24
    v_lshlrev_b32 v89, 8, v96
    v_add_u32 v90, 100, v97
    v_bitop3_b32 v90, v89, v45, v90 bitop3:0x6a
    ds_write_b32 v98, v90 offset:20
L2_xc4:
    v_lshlrev_b32 v89, 12, v96
    v_add_u32 v90, 80, v97
    v_bitop3_b32 v90, v89, v45, v90 bitop3:0x6a
    ds_write_b32 v98, v90 offset:16
    s_branch L2_xb4
L2_xe4:
    v_cmp_lt_u32 vcc, 32, v99
    v_cmp_lt_u32 s[58:59], 31, v88
    v_lshrrev_b32 v89, 16, v96
    v_add_u32 v97, 80, v97
    s_or_b64 vcc, vcc, s[58:59]
    s_cbranch_scc1 L2_xs4
    v_lshlrev_b32 v89, v1, v89
    v_and_b32 v89, v45, v89
    v_cmp_ne_u32 vcc, 0, v89
    v_xor_b32 v90, v97, v89
    s_add_u32 s3, s37, s38
    v_mbcnt_lo_u32_b32 v98, vcc_lo, 0
    v_mbcnt_hi_u32_b32 v98, vcc_hi, v98
    s_bcnt1_i32_b64 s41, vcc
    v_lshl_add_u32 v98, v98, 2, s3
    s_mov_b64 exec, vcc
    ds_write_b32 v98, v90
    s_mov_b64 exec, -1
    s_lshl2_add_u32 s37, s41, s37
    s_branch L2_xr4
L2_xf4:
    s_waitcnt lgkmcnt(0)
    s_cmp_gt_u32 s37, 1024
    s_cbranch_scc1 L2_xs4
    v_mov_b32 v43, -1
    s_cmp_ge_u32 s37, 512
    s_cbranch_scc1 L2_xg4
    v_mov_b32 v42, -1
    s_cmp_ge_u32 s37, 256
    s_cbranch_scc1 L2_xg4
    v_mov_b32 v41, -1
    s_branch L2_xg4
L2_xs4:
    s_waitcnt lgkmcnt(0)
    v_mov_b32 v40, -1
    v_mov_b32 v41, -1
    v_mov_b32 v42, -1
    v_mov_b32 v43, -1
    s_add_u32 s3, s42, 1
    s_bitset1_b32 s36, s3
    s_branch L2_xg4
L2_c5:
    s_mov_b64 s[50:51], vcc
    s_lshl_b64 s[52:53], s[82:83], 1
    s_andn2_b64 s[52:53], s[52:53], s[80:81]
    s_andn2_b64 s[52:53], s[52:53], s[50:51]
    s_or_b64 s[80:81], s[80:81], s[52:53]
    s_not_b64 vcc, s[52:53]
    s_mov_b64 exec, -1
    v_cndmask_b32_dpp v84, v84, v84, vcc wave_shr:1 row_mask:0xf bank_mask:0xf
    v_cndmask_b32_dpp v85, v85, v85, vcc wave_shr:1 row_mask:0xf bank_mask:0xf
    s_lshr_b64 s[52:53], s[52:53], 1
    v_cndmask_b32_dpp v86, v86, v86, vcc wave_shr:1 row_mask:0xf bank_mask:0xf
    v_cndmask_b32_dpp v87, v87, v87, vcc wave_shr:1 row_mask:0xf bank_mask:0xf
    s_andn2_b64 s[82:83], s[82:83], s[52:53]
    v_cndmask_b32_dpp v7, v7, v7, vcc wave_shr:1 row_mask:0xf bank_mask:0xf
    s_mov_b64 vcc, s[50:51]
    s_mov_b64 exec, s[50:51]
    s_cbranch_scc0 L2_d5
    s_mov_b64 exec, s[82:83]
    s_nop 1
    v_mfma_f32_4x4x4_16b_bf16 v[88:91], v[12:13], v[84:85], 0
    s_nop 1
    v_mfma_f32_4x4x4_16b_bf16 v[88:91], v[10:11], v[86:87], v[88:91]
    s_nop 4
    v_cvt_pk_bf16_f32 v88, v88, v89
    v_cvt_pk_bf16_f32 v89, v90, v91
    ds_pk_add_bf16 v7, v88 offset:65408
    ds_pk_add_bf16 v7, v89 offset:65412
    s_mov_b64 exec, vcc
    s_branch L2_d5
L2_c6:
    s_mov_b64 s[50:51], vcc
    s_lshl_b64 s[52:53], s[82:83], 1
    s_andn2_b64 s[52:53], s[52:53], s[80:81]
    s_andn2_b64 s[52:53], s[52:53], s[50:51]
    s_or_b64 s[80:81], s[80:81], s[52:53]
    s_not_b64 vcc, s[52:53]
    s_mov_b64 exec, -1
    v_cndmask_b32_dpp v84, v84, v84, vcc wave_shr:1 row_mask:0xf bank_mask:0xf
    v_cndmask_b32_dpp v85, v85, v85, vcc wave_shr:1 row_mask:0xf bank_mask:0xf
    s_lshr_b64 s[52:53], s[52:53], 1
    v_cndmask_b32_dpp v86, v86, v86, vcc wave_shr:1 row_mask:0xf bank_mask:0xf
    v_cndmask_b32_dpp v87, v87, v87, vcc wave_shr:1 row_mask:0xf bank_mask:0xf
    s_andn2_b64 s[82:83], s[82:83], s[52:53]
    v_cndmask_b32_dpp v7, v7, v7, vcc wave_shr:1 row_mask:0xf bank_mask:0xf
    s_mov_b64 vcc, s[50:51]
    s_mov_b64 exec, s[50:51]
    s_cbranch_scc0 L2_d6
    s_mov_b64 exec, s[82:83]
    s_nop 1
    v_mfma_f32_4x4x4_16b_bf16 v[88:91], v[12:13], v[84:85], 0
    s_nop 1
    v_mfma_f32_4x4x4_16b_bf16 v[88:91], v[10:11], v[86:87], v[88:91]
    s_nop 4
    v_cvt_pk_bf16_f32 v88, v88, v89
    v_cvt_pk_bf16_f32 v89, v90, v91
    ds_pk_add_bf16 v7, v88 offset:65408
    ds_pk_add_bf16 v7, v89 offset:65412
    s_mov_b64 exec, vcc
    s_branch L2_d6
L2_c7:
    s_mov_b64 s[50:51], vcc
    s_lshl_b64 s[52:53], s[82:83], 1
    s_andn2_b64 s[52:53], s[52:53], s[80:81]
    s_andn2_b64 s[52:53], s[52:53], s[50:51]
    s_or_b64 s[80:81], s[80:81], s[52:53]
    s_not_b64 vcc, s[52:53]
    s_mov_b64 exec, -1
    v_cndmask_b32_dpp v84, v84, v84, vcc wave_shr:1 row_mask:0xf bank_mask:0xf
    v_cndmask_b32_dpp v85, v85, v85, vcc wave_shr:1 row_mask:0xf bank_mask:0xf
    s_lshr_b64 s[52:53], s[52:53], 1
    v_cndmask_b32_dpp v86, v86, v86, vcc wave_shr:1 row_mask:0xf bank_mask:0xf
    v_cndmask_b32_dpp v87, v87, v87, vcc wave_shr:1 row_mask:0xf bank_mask:0xf
    s_andn2_b64 s[82:83], s[82:83], s[52:53]
    v_cndmask_b32_dpp v7, v7, v7, vcc wave_shr:1 row_mask:0xf bank_mask:0xf
    s_mov_b64 vcc, s[50:51]
    s_mov_b64 exec, s[50:51]
    s_cbranch_scc0 L2_d7
    s_mov_b64 exec, s[82:83]
    s_nop 1
    v_mfma_f32_4x4x4_16b_bf16 v[88:91], v[12:13], v[84:85], 0
    s_nop 1
    v_mfma_f32_4x4x4_16b_bf16 v[88:91], v[10:11], v[86:87], v[88:91]
    s_nop 4
    v_cvt_pk_bf16_f32 v88, v88, v89
    v_cvt_pk_bf16_f32 v89, v90, v91
    ds_pk_add_bf16 v7, v88 offset:65408
    ds_pk_add_bf16 v7, v89 offset:65412
    s_mov_b64 exec, vcc
    s_branch L2_d7
L2_c8:
    s_mov_b64 s[50:51], vcc
    s_lshl_b64 s[52:53], s[82:83], 1
    s_andn2_b64 s[52:53], s[52:53], s[80:81]
    s_andn2_b64 s[52:53], s[52:53], s[50:51]
    s_or_b64 s[80:81], s[80:81], s[52:53]
    s_not_b64 vcc, s[52:53]
    s_mov_b64 exec, -1
    v_cndmask_b32_dpp v84, v84, v84, vcc wave_shr:1 row_mask:0xf bank_mask:0xf
    v_cndmask_b32_dpp v85, v85, v85, vcc wave_shr:1 row_mask:0xf bank_mask:0xf
    s_lshr_b64 s[52:53], s[52:53], 1
    v_cndmask_b32_dpp v86, v86, v86, vcc wave_shr:1 row_mask:0xf bank_mask:0xf
    v_cndmask_b32_dpp v87, v87, v87, vcc wave_shr:1 row_mask:0xf bank_mask:0xf
    s_andn2_b64 s[82:83], s[82:83], s[52:53]
    v_cndmask_b32_dpp v7, v7, v7, vcc wave_shr:1 row_mask:0xf bank_mask:0xf
    s_mov_b64 vcc, s[50:51]
    s_mov_b64 exec, s[50:51]
    s_cbranch_scc0 L2_d8
    s_mov_b64 exec, s[82:83]
    s_nop 1
    v_mfma_f32_4x4x4_16b_bf16 v[88:91], v[12:13], v[84:85], 0
    s_nop 1
    v_mfma_f32_4x4x4_16b_bf16 v[88:91], v[10:11], v[86:87], v[88:91]
    s_nop 4
    v_cvt_pk_bf16_f32 v88, v88, v89
    v_cvt_pk_bf16_f32 v89, v90, v91
    ds_pk_add_bf16 v7, v88 offset:65408
    ds_pk_add_bf16 v7, v89 offset:65412
    s_mov_b64 exec, vcc
    s_branch L2_d8
L2_xo9:
    v_cmp_lt_u32 vcc, 20, v99
    s_mov_b32 s43, 1
    s_cbranch_vccz L2_xp9
    v_cmp_lt_u32 vcc, 32, v99
    v_cmp_lt_u32 s[58:59], 31, v88
    s_mov_b32 s43, 2
    s_or_b64 vcc, vcc, s[58:59]
    s_cbranch_scc0 L2_xp9
    s_mov_b32 s37, 0x10000
    s_branch L2_xp9
L2_c10:
    s_mov_b64 s[50:51], vcc
    s_lshl_b64 s[52:53], s[82:83], 1
    s_andn2_b64 s[52:53], s[52:53], s[80:81]
    s_andn2_b64 s[52:53], s[52:53], s[50:51]
    s_or_b64 s[80:81], s[80:81], s[52:53]
    s_not_b64 vcc, s[52:53]
    s_mov_b64 exec, -1
    v_cndmask_b32_dpp v84, v84, v84, vcc wave_shr:1 row_mask:0xf bank_mask:0xf
    v_cndmask_b32_dpp v85, v85, v85, vcc wave_shr:1 row_mask:0xf bank_mask:0xf
    s_lshr_b64 s[52:53], s[52:53], 1
    v_cndmask_b32_dpp v86, v86, v86, vcc wave_shr:1 row_mask:0xf bank_mask:0xf
    v_cndmask_b32_dpp v87, v87, v87, vcc wave_shr:1 row_mask:0xf bank_mask:0xf
    s_andn2_b64 s[82:83], s[82:83], s[52:53]
    v_cndmask_b32_dpp v7, v7, v7, vcc wave_shr:1 row_mask:0xf bank_mask:0xf
    s_mov_b64 vcc, s[50:51]
    s_mov_b64 exec, s[50:51]
    s_cbranch_scc0 L2_d10
    s_mov_b64 exec, s[82:83]
    s_nop 1
    v_mfma_f32_4x4x4_16b_bf16 v[88:91], v[12:13], v[84:85], 0
    s_nop 1
    v_mfma_f32_4x4x4_16b_bf16 v[88:91], v[10:11], v[86:87], v[88:91]
    s_nop 4
    v_cvt_pk_bf16_f32 v88, v88, v89
    v_cvt_pk_bf16_f32 v89, v90, v91
    ds_pk_add_bf16 v7, v88 offset:65408
    ds_pk_add_bf16 v7, v89 offset:65412
    s_mov_b64 exec, vcc
    s_branch L2_d10
L2_c11:
    s_mov_b64 s[50:51], vcc
    s_lshl_b64 s[52:53], s[82:83], 1
    s_andn2_b64 s[52:53], s[52:53], s[80:81]
    s_andn2_b64 s[52:53], s[52:53], s[50:51]
    s_or_b64 s[80:81], s[80:81], s[52:53]
    s_not_b64 vcc, s[52:53]
    s_mov_b64 exec, -1
    v_cndmask_b32_dpp v84, v84, v84, vcc wave_shr:1 row_mask:0xf bank_mask:0xf
    v_cndmask_b32_dpp v85, v85, v85, vcc wave_shr:1 row_mask:0xf bank_mask:0xf
    s_lshr_b64 s[52:53], s[52:53], 1
    v_cndmask_b32_dpp v86, v86, v86, vcc wave_shr:1 row_mask:0xf bank_mask:0xf
    v_cndmask_b32_dpp v87, v87, v87, vcc wave_shr:1 row_mask:0xf bank_mask:0xf
    s_andn2_b64 s[82:83], s[82:83], s[52:53]
    v_cndmask_b32_dpp v7, v7, v7, vcc wave_shr:1 row_mask:0xf bank_mask:0xf
    s_mov_b64 vcc, s[50:51]
    s_mov_b64 exec, s[50:51]
    s_cbranch_scc0 L2_d11
    s_mov_b64 exec, s[82:83]
    s_nop 1
    v_mfma_f32_4x4x4_16b_bf16 v[88:91], v[12:13], v[84:85], 0
    s_nop 1
    v_mfma_f32_4x4x4_16b_bf16 v[88:91], v[10:11], v[86:87], v[88:91]
    s_nop 4
    v_cvt_pk_bf16_f32 v88, v88, v89
    v_cvt_pk_bf16_f32 v89, v90, v91
    ds_pk_add_bf16 v7, v88 offset:65408
    ds_pk_add_bf16 v7, v89 offset:65412
    s_mov_b64 exec, vcc
    s_branch L2_d11
L2_c12:
    s_mov_b64 s[50:51], vcc
    s_lshl_b64 s[52:53], s[82:83], 1
    s_andn2_b64 s[52:53], s[52:53], s[80:81]
    s_andn2_b64 s[52:53], s[52:53], s[50:51]
    s_or_b64 s[80:81], s[80:81], s[52:53]
    s_not_b64 vcc, s[52:53]
    s_mov_b64 exec, -1
    v_cndmask_b32_dpp v84, v84, v84, vcc wave_shr:1 row_mask:0xf bank_mask:0xf
    v_cndmask_b32_dpp v85, v85, v85, vcc wave_shr:1 row_mask:0xf bank_mask:0xf
    s_lshr_b64 s[52:53], s[52:53], 1
    v_cndmask_b32_dpp v86, v86, v86, vcc wave_shr:1 row_mask:0xf bank_mask:0xf
    v_cndmask_b32_dpp v87, v87, v87, vcc wave_shr:1 row_mask:0xf bank_mask:0xf
    s_andn2_b64 s[82:83], s[82:83], s[52:53]
    v_cndmask_b32_dpp v7, v7, v7, vcc wave_shr:1 row_mask:0xf bank_mask:0xf
    s_mov_b64 vcc, s[50:51]
    s_mov_b64 exec, s[50:51]
    s_cbranch_scc0 L2_d12
    s_mov_b64 exec, s[82:83]
    s_nop 1
    v_mfma_f32_4x4x4_16b_bf16 v[88:91], v[12:13], v[84:85], 0
    s_nop 1
    v_mfma_f32_4x4x4_16b_bf16 v[88:91], v[10:11], v[86:87], v[88:91]
    s_nop 4
    v_cvt_pk_bf16_f32 v88, v88, v89
    v_cvt_pk_bf16_f32 v89, v90, v91
    ds_pk_add_bf16 v7, v88 offset:65408
    ds_pk_add_bf16 v7, v89 offset:65412
    s_mov_b64 exec, vcc
    s_branch L2_d12
L2_c13:
    s_mov_b64 s[50:51], vcc
    s_lshl_b64 s[52:53], s[82:83], 1
    s_andn2_b64 s[52:53], s[52:53], s[80:81]
    s_andn2_b64 s[52:53], s[52:53], s[50:51]
    s_or_b64 s[80:81], s[80:81], s[52:53]
    s_not_b64 vcc, s[52:53]
    s_mov_b64 exec, -1
    v_cndmask_b32_dpp v84, v84, v84, vcc wave_shr:1 row_mask:0xf bank_mask:0xf
    v_cndmask_b32_dpp v85, v85, v85, vcc wave_shr:1 row_mask:0xf bank_mask:0xf
    s_lshr_b64 s[52:53], s[52:53], 1
    v_cndmask_b32_dpp v86, v86, v86, vcc wave_shr:1 row_mask:0xf bank_mask:0xf
    v_cndmask_b32_dpp v87, v87, v87, vcc wave_shr:1 row_mask:0xf bank_mask:0xf
    s_andn2_b64 s[82:83], s[82:83], s[52:53]
    v_cndmask_b32_dpp v7, v7, v7, vcc wave_shr:1 row_mask:0xf bank_mask:0xf
    s_mov_b64 vcc, s[50:51]
    s_mov_b64 exec, s[50:51]
    s_cbranch_scc0 L2_d13
    s_mov_b64 exec, s[82:83]
    s_nop 1
    v_mfma_f32_4x4x4_16b_bf16 v[88:91], v[12:13], v[84:85], 0
    s_nop 1
    v_mfma_f32_4x4x4_16b_bf16 v[88:91], v[10:11], v[86:87], v[88:91]
    s_nop 4
    v_cvt_pk_bf16_f32 v88, v88, v89
    v_cvt_pk_bf16_f32 v89, v90, v91
    ds_pk_add_bf16 v7, v88 offset:65408
    ds_pk_add_bf16 v7, v89 offset:65412
    s_mov_b64 exec, vcc
    s_branch L2_d13
L2_c14:
    s_mov_b64 s[50:51], vcc
    s_lshl_b64 s[52:53], s[82:83], 1
    s_andn2_b64 s[52:53], s[52:53], s[80:81]
    s_andn2_b64 s[52:53], s[52:53], s[50:51]
    s_or_b64 s[80:81], s[80:81], s[52:53]
    s_not_b64 vcc, s[52:53]
    s_mov_b64 exec, -1
    v_cndmask_b32_dpp v84, v84, v84, vcc wave_shr:1 row_mask:0xf bank_mask:0xf
    v_cndmask_b32_dpp v85, v85, v85, vcc wave_shr:1 row_mask:0xf bank_mask:0xf
    s_lshr_b64 s[52:53], s[52:53], 1
    v_cndmask_b32_dpp v86, v86, v86, vcc wave_shr:1 row_mask:0xf bank_mask:0xf
    v_cndmask_b32_dpp v87, v87, v87, vcc wave_shr:1 row_mask:0xf bank_mask:0xf
    s_andn2_b64 s[82:83], s[82:83], s[52:53]
    v_cndmask_b32_dpp v7, v7, v7, vcc wave_shr:1 row_mask:0xf bank_mask:0xf
    s_mov_b64 vcc, s[50:51]
    s_mov_b64 exec, s[50:51]
    s_cbranch_scc0 L2_d14
    s_mov_b64 exec, s[82:83]
    s_nop 1
    v_mfma_f32_4x4x4_16b_bf16 v[88:91], v[12:13], v[84:85], 0
    s_nop 1
    v_mfma_f32_4x4x4_16b_bf16 v[88:91], v[10:11], v[86:87], v[88:91]
    s_nop 4
    v_cvt_pk_bf16_f32 v88, v88, v89
    v_cvt_pk_bf16_f32 v89, v90, v91
    ds_pk_add_bf16 v7, v88 offset:65408
    ds_pk_add_bf16 v7, v89 offset:65412
    s_mov_b64 exec, vcc
    s_branch L2_d14
L2_c15:
    s_mov_b64 s[50:51], vcc
    s_lshl_b64 s[52:53], s[82:83], 1
    s_andn2_b64 s[52:53], s[52:53], s[80:81]
    s_andn2_b64 s[52:53], s[52:53], s[50:51]
    s_or_b64 s[80:81], s[80:81], s[52:53]
    s_not_b64 vcc, s[52:53]
    s_mov_b64 exec, -1
    v_cndmask_b32_dpp v84, v84, v84, vcc wave_shr:1 row_mask:0xf bank_mask:0xf
    v_cndmask_b32_dpp v85, v85, v85, vcc wave_shr:1 row_mask:0xf bank_mask:0xf
    s_lshr_b64 s[52:53], s[52:53], 1
    v_cndmask_b32_dpp v86, v86, v86, vcc wave_shr:1 row_mask:0xf bank_mask:0xf
    v_cndmask_b32_dpp v87, v87, v87, vcc wave_shr:1 row_mask:0xf bank_mask:0xf
    s_andn2_b64 s[82:83], s[82:83], s[52:53]
    v_cndmask_b32_dpp v7, v7, v7, vcc wave_shr:1 row_mask:0xf bank_mask:0xf
    s_mov_b64 vcc, s[50:51]
    s_mov_b64 exec, s[50:51]
    s_cbranch_scc0 L2_d15
    s_mov_b64 exec, s[82:83]
    s_nop 1
    v_mfma_f32_4x4x4_16b_bf16 v[88:91], v[12:13], v[84:85], 0
    s_nop 1
    v_mfma_f32_4x4x4_16b_bf16 v[88:91], v[10:11], v[86:87], v[88:91]
    s_nop 4
    v_cvt_pk_bf16_f32 v88, v88, v89
    v_cvt_pk_bf16_f32 v89, v90, v91
    ds_pk_add_bf16 v7, v88 offset:65408
    ds_pk_add_bf16 v7, v89 offset:65412
    s_mov_b64 exec, vcc
    s_branch L2_d15
L2_c16:
    s_mov_b64 s[50:51], vcc
    s_lshl_b64 s[52:53], s[82:83], 1
    s_andn2_b64 s[52:53], s[52:53], s[80:81]
    s_andn2_b64 s[52:53], s[52:53], s[50:51]
    s_or_b64 s[80:81], s[80:81], s[52:53]
    s_not_b64 vcc, s[52:53]
    s_mov_b64 exec, -1
    v_cndmask_b32_dpp v84, v84, v84, vcc wave_shr:1 row_mask:0xf bank_mask:0xf
    v_cndmask_b32_dpp v85, v85, v85, vcc wave_shr:1 row_mask:0xf bank_mask:0xf
    s_lshr_b64 s[52:53], s[52:53], 1
    v_cndmask_b32_dpp v86, v86, v86, vcc wave_shr:1 row_mask:0xf bank_mask:0xf
    v_cndmask_b32_dpp v87, v87, v87, vcc wave_shr:1 row_mask:0xf bank_mask:0xf
    s_andn2_b64 s[82:83], s[82:83], s[52:53]
    v_cndmask_b32_dpp v7, v7, v7, vcc wave_shr:1 row_mask:0xf bank_mask:0xf
    s_mov_b64 vcc, s[50:51]
    s_mov_b64 exec, s[50:51]
    s_cbranch_scc0 L2_d16
    s_mov_b64 exec, s[82:83]
    s_nop 1
    v_mfma_f32_4x4x4_16b_bf16 v[88:91], v[12:13], v[84:85], 0
    s_nop 1
    v_mfma_f32_4x4x4_16b_bf16 v[88:91], v[10:11], v[86:87], v[88:91]
    s_nop 4
    v_cvt_pk_bf16_f32 v88, v88, v89
    v_cvt_pk_bf16_f32 v89, v90, v91
    ds_pk_add_bf16 v7, v88 offset:65408
    ds_pk_add_bf16 v7, v89 offset:65412
    s_mov_b64 exec, vcc
    s_branch L2_d16
L2_c17:
    s_mov_b64 s[50:51], vcc
    s_lshl_b64 s[52:53], s[82:83], 1
    s_andn2_b64 s[52:53], s[52:53], s[80:81]
    s_andn2_b64 s[52:53], s[52:53], s[50:51]
    s_or_b64 s[80:81], s[80:81], s[52:53]
    s_not_b64 vcc, s[52:53]
    s_mov_b64 exec, -1
    v_cndmask_b32_dpp v84, v84, v84, vcc wave_shr:1 row_mask:0xf bank_mask:0xf
    v_cndmask_b32_dpp v85, v85, v85, vcc wave_shr:1 row_mask:0xf bank_mask:0xf
    s_lshr_b64 s[52:53], s[52:53], 1
    v_cndmask_b32_dpp v86, v86, v86, vcc wave_shr:1 row_mask:0xf bank_mask:0xf
    v_cndmask_b32_dpp v87, v87, v87, vcc wave_shr:1 row_mask:0xf bank_mask:0xf
    s_andn2_b64 s[82:83], s[82:83], s[52:53]
    v_cndmask_b32_dpp v7, v7, v7, vcc wave_shr:1 row_mask:0xf bank_mask:0xf
    s_mov_b64 vcc, s[50:51]
    s_mov_b64 exec, s[50:51]
    s_cbranch_scc0 L2_d17
    s_mov_b64 exec, s[82:83]
    s_nop 1
    v_mfma_f32_4x4x4_16b_bf16 v[88:91], v[12:13], v[84:85], 0
    s_nop 1
    v_mfma_f32_4x4x4_16b_bf16 v[88:91], v[10:11], v[86:87], v[88:91]
    s_nop 4
    v_cvt_pk_bf16_f32 v88, v88, v89
    v_cvt_pk_bf16_f32 v89, v90, v91
    ds_pk_add_bf16 v7, v88 offset:65408
    ds_pk_add_bf16 v7, v89 offset:65412
    s_mov_b64 exec, vcc
    s_branch L2_d17
L2_xa18:
    s_cmp_eq_u32 s43, 1
    s_cbranch_scc1 L2_xc18
    v_lshlrev_b32 v89, 0, v96
    v_add_u32 v90, 140, v97
    v_bitop3_b32 v90, v89, v45, v90 bitop3:0x6a
    ds_write_b32 v98, v90 offset:28
    v_lshlrev_b32 v89, 4, v96
    v_add_u32 v90, 120, v97
    v_bitop3_b32 v90, v89, v45, v90 bitop3:0x6a
    ds_write_b32 v98, v90 offset:24
    v_lshlrev_b32 v89, 8, v96
    v_add_u32 v90, 100, v97
    v_bitop3_b32 v90, v89, v45, v90 bitop3:0x6a
    ds_write_b32 v98, v90 offset:20
L2_xc18:
    v_lshlrev_b32 v89, 12, v96
    v_add_u32 v90, 80, v97
    v_bitop3_b32 v90, v89, v45, v90 bitop3:0x6a
    ds_write_b32 v98, v90 offset:16
    s_branch L2_xb18
L2_xe18:
    v_cmp_lt_u32 vcc, 32, v99
    v_cmp_lt_u32 s[58:59], 31, v88
    v_lshrrev_b32 v89, 16, v96
    v_add_u32 v97, 80, v97
    s_or_b64 vcc, vcc, s[58:59]
    s_cbranch_scc1 L2_xs18
    v_lshlrev_b32 v89, v1, v89
    v_and_b32 v89, v45, v89
    v_cmp_ne_u32 vcc, 0, v89
    v_xor_b32 v90, v97, v89
    s_add_u32 s3, s37, s38
    v_mbcnt_lo_u32_b32 v98, vcc_lo, 0
    v_mbcnt_hi_u32_b32 v98, vcc_hi, v98
    s_bcnt1_i32_b64 s41, vcc
    v_lshl_add_u32 v98, v98, 2, s3
    s_mov_b64 exec, vcc
    ds_write_b32 v98, v90
    s_mov_b64 exec, -1
    s_lshl2_add_u32 s37, s41, s37
    s_branch L2_xr18
L2_xf18:
    s_waitcnt lgkmcnt(0)
    s_cmp_gt_u32 s37, 1024
    s_cbranch_scc1 L2_xs18
    v_mov_b32 v43, -1
    s_cmp_ge_u32 s37, 512
    s_cbranch_scc1 L2_xg18
    v_mov_b32 v42, -1
    s_cmp_ge_u32 s37, 256
    s_cbranch_scc1 L2_xg18
    v_mov_b32 v41, -1
    s_branch L2_xg18
L2_xs18:
    s_waitcnt lgkmcnt(0)
    v_mov_b32 v40, -1
    v_mov_b32 v41, -1
    v_mov_b32 v42, -1
    v_mov_b32 v43, -1
    s_add_u32 s3, s42, 2
    s_bitset1_b32 s36, s3
    s_branch L2_xg18
L2_c19:
    s_mov_b64 s[50:51], vcc
    s_lshl_b64 s[52:53], s[82:83], 1
    s_andn2_b64 s[52:53], s[52:53], s[80:81]
    s_andn2_b64 s[52:53], s[52:53], s[50:51]
    s_or_b64 s[80:81], s[80:81], s[52:53]
    s_not_b64 vcc, s[52:53]
    s_mov_b64 exec, -1
    v_cndmask_b32_dpp v84, v84, v84, vcc wave_shr:1 row_mask:0xf bank_mask:0xf
    v_cndmask_b32_dpp v85, v85, v85, vcc wave_shr:1 row_mask:0xf bank_mask:0xf
    s_lshr_b64 s[52:53], s[52:53], 1
    v_cndmask_b32_dpp v86, v86, v86, vcc wave_shr:1 row_mask:0xf bank_mask:0xf
    v_cndmask_b32_dpp v87, v87, v87, vcc wave_shr:1 row_mask:0xf bank_mask:0xf
    s_andn2_b64 s[82:83], s[82:83], s[52:53]
    v_cndmask_b32_dpp v7, v7, v7, vcc wave_shr:1 row_mask:0xf bank_mask:0xf
    s_mov_b64 vcc, s[50:51]
    s_mov_b64 exec, s[50:51]
    s_cbranch_scc0 L2_d19
    s_mov_b64 exec, s[82:83]
    s_nop 1
    v_mfma_f32_4x4x4_16b_bf16 v[88:91], v[12:13], v[84:85], 0
    s_nop 1
    v_mfma_f32_4x4x4_16b_bf16 v[88:91], v[10:11], v[86:87], v[88:91]
    s_nop 4
    v_cvt_pk_bf16_f32 v88, v88, v89
    v_cvt_pk_bf16_f32 v89, v90, v91
    ds_pk_add_bf16 v7, v88 offset:65408
    ds_pk_add_bf16 v7, v89 offset:65412
    s_mov_b64 exec, vcc
    s_branch L2_d19
L2_c20:
    s_mov_b64 s[50:51], vcc
    s_lshl_b64 s[52:53], s[82:83], 1
    s_andn2_b64 s[52:53], s[52:53], s[80:81]
    s_andn2_b64 s[52:53], s[52:53], s[50:51]
    s_or_b64 s[80:81], s[80:81], s[52:53]
    s_not_b64 vcc, s[52:53]
    s_mov_b64 exec, -1
    v_cndmask_b32_dpp v84, v84, v84, vcc wave_shr:1 row_mask:0xf bank_mask:0xf
    v_cndmask_b32_dpp v85, v85, v85, vcc wave_shr:1 row_mask:0xf bank_mask:0xf
    s_lshr_b64 s[52:53], s[52:53], 1
    v_cndmask_b32_dpp v86, v86, v86, vcc wave_shr:1 row_mask:0xf bank_mask:0xf
    v_cndmask_b32_dpp v87, v87, v87, vcc wave_shr:1 row_mask:0xf bank_mask:0xf
    s_andn2_b64 s[82:83], s[82:83], s[52:53]
    v_cndmask_b32_dpp v7, v7, v7, vcc wave_shr:1 row_mask:0xf bank_mask:0xf
    s_mov_b64 vcc, s[50:51]
    s_mov_b64 exec, s[50:51]
    s_cbranch_scc0 L2_d20
    s_mov_b64 exec, s[82:83]
    s_nop 1
    v_mfma_f32_4x4x4_16b_bf16 v[88:91], v[12:13], v[84:85], 0
    s_nop 1
    v_mfma_f32_4x4x4_16b_bf16 v[88:91], v[10:11], v[86:87], v[88:91]
    s_nop 4
    v_cvt_pk_bf16_f32 v88, v88, v89
    v_cvt_pk_bf16_f32 v89, v90, v91
    ds_pk_add_bf16 v7, v88 offset:65408
    ds_pk_add_bf16 v7, v89 offset:65412
    s_mov_b64 exec, vcc
    s_branch L2_d20
L2_c21:
    s_mov_b64 s[50:51], vcc
    s_lshl_b64 s[52:53], s[82:83], 1
    s_andn2_b64 s[52:53], s[52:53], s[80:81]
    s_andn2_b64 s[52:53], s[52:53], s[50:51]
    s_or_b64 s[80:81], s[80:81], s[52:53]
    s_not_b64 vcc, s[52:53]
    s_mov_b64 exec, -1
    v_cndmask_b32_dpp v84, v84, v84, vcc wave_shr:1 row_mask:0xf bank_mask:0xf
    v_cndmask_b32_dpp v85, v85, v85, vcc wave_shr:1 row_mask:0xf bank_mask:0xf
    s_lshr_b64 s[52:53], s[52:53], 1
    v_cndmask_b32_dpp v86, v86, v86, vcc wave_shr:1 row_mask:0xf bank_mask:0xf
    v_cndmask_b32_dpp v87, v87, v87, vcc wave_shr:1 row_mask:0xf bank_mask:0xf
    s_andn2_b64 s[82:83], s[82:83], s[52:53]
    v_cndmask_b32_dpp v7, v7, v7, vcc wave_shr:1 row_mask:0xf bank_mask:0xf
    s_mov_b64 vcc, s[50:51]
    s_mov_b64 exec, s[50:51]
    s_cbranch_scc0 L2_d21
    s_mov_b64 exec, s[82:83]
    s_nop 1
    v_mfma_f32_4x4x4_16b_bf16 v[88:91], v[12:13], v[84:85], 0
    s_nop 1
    v_mfma_f32_4x4x4_16b_bf16 v[88:91], v[10:11], v[86:87], v[88:91]
    s_nop 4
    v_cvt_pk_bf16_f32 v88, v88, v89
    v_cvt_pk_bf16_f32 v89, v90, v91
    ds_pk_add_bf16 v7, v88 offset:65408
    ds_pk_add_bf16 v7, v89 offset:65412
    s_mov_b64 exec, vcc
    s_branch L2_d21
L2_c22:
    s_mov_b64 s[50:51], vcc
    s_lshl_b64 s[52:53], s[82:83], 1
    s_andn2_b64 s[52:53], s[52:53], s[80:81]
    s_andn2_b64 s[52:53], s[52:53], s[50:51]
    s_or_b64 s[80:81], s[80:81], s[52:53]
    s_not_b64 vcc, s[52:53]
    s_mov_b64 exec, -1
    v_cndmask_b32_dpp v84, v84, v84, vcc wave_shr:1 row_mask:0xf bank_mask:0xf
    v_cndmask_b32_dpp v85, v85, v85, vcc wave_shr:1 row_mask:0xf bank_mask:0xf
    s_lshr_b64 s[52:53], s[52:53], 1
    v_cndmask_b32_dpp v86, v86, v86, vcc wave_shr:1 row_mask:0xf bank_mask:0xf
    v_cndmask_b32_dpp v87, v87, v87, vcc wave_shr:1 row_mask:0xf bank_mask:0xf
    s_andn2_b64 s[82:83], s[82:83], s[52:53]
    v_cndmask_b32_dpp v7, v7, v7, vcc wave_shr:1 row_mask:0xf bank_mask:0xf
    s_mov_b64 vcc, s[50:51]
    s_mov_b64 exec, s[50:51]
    s_cbranch_scc0 L2_d22
    s_mov_b64 exec, s[82:83]
    s_nop 1
    v_mfma_f32_4x4x4_16b_bf16 v[88:91], v[12:13], v[84:85], 0
    s_nop 1
    v_mfma_f32_4x4x4_16b_bf16 v[88:91], v[10:11], v[86:87], v[88:91]
    s_nop 4
    v_cvt_pk_bf16_f32 v88, v88, v89
    v_cvt_pk_bf16_f32 v89, v90, v91
    ds_pk_add_bf16 v7, v88 offset:65408
    ds_pk_add_bf16 v7, v89 offset:65412
    s_mov_b64 exec, vcc
    s_branch L2_d22
L2_c23:
    s_mov_b64 s[50:51], vcc
    s_lshl_b64 s[52:53], s[82:83], 1
    s_andn2_b64 s[52:53], s[52:53], s[80:81]
    s_andn2_b64 s[52:53], s[52:53], s[50:51]
    s_or_b64 s[80:81], s[80:81], s[52:53]
    s_not_b64 vcc, s[52:53]
    s_mov_b64 exec, -1
    v_cndmask_b32_dpp v84, v84, v84, vcc wave_shr:1 row_mask:0xf bank_mask:0xf
    v_cndmask_b32_dpp v85, v85, v85, vcc wave_shr:1 row_mask:0xf bank_mask:0xf
    s_lshr_b64 s[52:53], s[52:53], 1
    v_cndmask_b32_dpp v86, v86, v86, vcc wave_shr:1 row_mask:0xf bank_mask:0xf
    v_cndmask_b32_dpp v87, v87, v87, vcc wave_shr:1 row_mask:0xf bank_mask:0xf
    s_andn2_b64 s[82:83], s[82:83], s[52:53]
    v_cndmask_b32_dpp v7, v7, v7, vcc wave_shr:1 row_mask:0xf bank_mask:0xf
    s_mov_b64 vcc, s[50:51]
    s_mov_b64 exec, s[50:51]
    s_cbranch_scc0 L2_d23
    s_mov_b64 exec, s[82:83]
    s_nop 1
    v_mfma_f32_4x4x4_16b_bf16 v[88:91], v[12:13], v[84:85], 0
    s_nop 1
    v_mfma_f32_4x4x4_16b_bf16 v[88:91], v[10:11], v[86:87], v[88:91]
    s_nop 4
    v_cvt_pk_bf16_f32 v88, v88, v89
    v_cvt_pk_bf16_f32 v89, v90, v91
    ds_pk_add_bf16 v7, v88 offset:65408
    ds_pk_add_bf16 v7, v89 offset:65412
    s_mov_b64 exec, vcc
    s_branch L2_d23
L2_c24:
    s_mov_b64 s[50:51], vcc
    s_lshl_b64 s[52:53], s[82:83], 1
    s_andn2_b64 s[52:53], s[52:53], s[80:81]
    s_andn2_b64 s[52:53], s[52:53], s[50:51]
    s_or_b64 s[80:81], s[80:81], s[52:53]
    s_not_b64 vcc, s[52:53]
    s_mov_b64 exec, -1
    v_cndmask_b32_dpp v84, v84, v84, vcc wave_shr:1 row_mask:0xf bank_mask:0xf
    v_cndmask_b32_dpp v85, v85, v85, vcc wave_shr:1 row_mask:0xf bank_mask:0xf
    s_lshr_b64 s[52:53], s[52:53], 1
    v_cndmask_b32_dpp v86, v86, v86, vcc wave_shr:1 row_mask:0xf bank_mask:0xf
    v_cndmask_b32_dpp v87, v87, v87, vcc wave_shr:1 row_mask:0xf bank_mask:0xf
    s_andn2_b64 s[82:83], s[82:83], s[52:53]
    v_cndmask_b32_dpp v7, v7, v7, vcc wave_shr:1 row_mask:0xf bank_mask:0xf
    s_mov_b64 vcc, s[50:51]
    s_mov_b64 exec, s[50:51]
    s_cbranch_scc0 L2_d24
    s_mov_b64 exec, s[82:83]
    s_nop 1
    v_mfma_f32_4x4x4_16b_bf16 v[88:91], v[12:13], v[84:85], 0
    s_nop 1
    v_mfma_f32_4x4x4_16b_bf16 v[88:91], v[10:11], v[86:87], v[88:91]
    s_nop 4
    v_cvt_pk_bf16_f32 v88, v88, v89
    v_cvt_pk_bf16_f32 v89, v90, v91
    ds_pk_add_bf16 v7, v88 offset:65408
    ds_pk_add_bf16 v7, v89 offset:65412
    s_mov_b64 exec, vcc
    s_branch L2_d24
L2_c25:
    s_mov_b64 s[50:51], vcc
    s_lshl_b64 s[52:53], s[82:83], 1
    s_andn2_b64 s[52:53], s[52:53], s[80:81]
    s_andn2_b64 s[52:53], s[52:53], s[50:51]
    s_or_b64 s[80:81], s[80:81], s[52:53]
    s_not_b64 vcc, s[52:53]
    s_mov_b64 exec, -1
    v_cndmask_b32_dpp v84, v84, v84, vcc wave_shr:1 row_mask:0xf bank_mask:0xf
    v_cndmask_b32_dpp v85, v85, v85, vcc wave_shr:1 row_mask:0xf bank_mask:0xf
    s_lshr_b64 s[52:53], s[52:53], 1
    v_cndmask_b32_dpp v86, v86, v86, vcc wave_shr:1 row_mask:0xf bank_mask:0xf
    v_cndmask_b32_dpp v87, v87, v87, vcc wave_shr:1 row_mask:0xf bank_mask:0xf
    s_andn2_b64 s[82:83], s[82:83], s[52:53]
    v_cndmask_b32_dpp v7, v7, v7, vcc wave_shr:1 row_mask:0xf bank_mask:0xf
    s_mov_b64 vcc, s[50:51]
    s_mov_b64 exec, s[50:51]
    s_cbranch_scc0 L2_d25
    s_mov_b64 exec, s[82:83]
    s_nop 1
    v_mfma_f32_4x4x4_16b_bf16 v[88:91], v[12:13], v[84:85], 0
    s_nop 1
    v_mfma_f32_4x4x4_16b_bf16 v[88:91], v[10:11], v[86:87], v[88:91]
    s_nop 4
    v_cvt_pk_bf16_f32 v88, v88, v89
    v_cvt_pk_bf16_f32 v89, v90, v91
    ds_pk_add_bf16 v7, v88 offset:65408
    ds_pk_add_bf16 v7, v89 offset:65412
    s_mov_b64 exec, vcc
    s_branch L2_d25
L2_c26:
    s_mov_b64 s[50:51], vcc
    s_lshl_b64 s[52:53], s[82:83], 1
    s_andn2_b64 s[52:53], s[52:53], s[80:81]
    s_andn2_b64 s[52:53], s[52:53], s[50:51]
    s_or_b64 s[80:81], s[80:81], s[52:53]
    s_not_b64 vcc, s[52:53]
    s_mov_b64 exec, -1
    v_cndmask_b32_dpp v84, v84, v84, vcc wave_shr:1 row_mask:0xf bank_mask:0xf
    v_cndmask_b32_dpp v85, v85, v85, vcc wave_shr:1 row_mask:0xf bank_mask:0xf
    s_lshr_b64 s[52:53], s[52:53], 1
    v_cndmask_b32_dpp v86, v86, v86, vcc wave_shr:1 row_mask:0xf bank_mask:0xf
    v_cndmask_b32_dpp v87, v87, v87, vcc wave_shr:1 row_mask:0xf bank_mask:0xf
    s_andn2_b64 s[82:83], s[82:83], s[52:53]
    v_cndmask_b32_dpp v7, v7, v7, vcc wave_shr:1 row_mask:0xf bank_mask:0xf
    s_mov_b64 vcc, s[50:51]
    s_mov_b64 exec, s[50:51]
    s_cbranch_scc0 L2_d26
    s_mov_b64 exec, s[82:83]
    s_nop 1
    v_mfma_f32_4x4x4_16b_bf16 v[88:91], v[12:13], v[84:85], 0
    s_nop 1
    v_mfma_f32_4x4x4_16b_bf16 v[88:91], v[10:11], v[86:87], v[88:91]
    s_nop 4
    v_cvt_pk_bf16_f32 v88, v88, v89
    v_cvt_pk_bf16_f32 v89, v90, v91
    ds_pk_add_bf16 v7, v88 offset:65408
    ds_pk_add_bf16 v7, v89 offset:65412
    s_mov_b64 exec, vcc
    s_branch L2_d26
L2_xo27:
    v_cmp_lt_u32 vcc, 20, v99
    s_mov_b32 s43, 1
    s_cbranch_vccz L2_xp27
    v_cmp_lt_u32 vcc, 32, v99
    v_cmp_lt_u32 s[58:59], 31, v88
    s_mov_b32 s43, 2
    s_or_b64 vcc, vcc, s[58:59]
    s_cbranch_scc0 L2_xp27
    s_mov_b32 s37, 0x10000
    s_branch L2_xp27
L2_c28:
    s_mov_b64 s[50:51], vcc
    s_lshl_b64 s[52:53], s[82:83], 1
    s_andn2_b64 s[52:53], s[52:53], s[80:81]
    s_andn2_b64 s[52:53], s[52:53], s[50:51]
    s_or_b64 s[80:81], s[80:81], s[52:53]
    s_not_b64 vcc, s[52:53]
    s_mov_b64 exec, -1
    v_cndmask_b32_dpp v84, v84, v84, vcc wave_shr:1 row_mask:0xf bank_mask:0xf
    v_cndmask_b32_dpp v85, v85, v85, vcc wave_shr:1 row_mask:0xf bank_mask:0xf
    s_lshr_b64 s[52:53], s[52:53], 1
    v_cndmask_b32_dpp v86, v86, v86, vcc wave_shr:1 row_mask:0xf bank_mask:0xf
    v_cndmask_b32_dpp v87, v87, v87, vcc wave_shr:1 row_mask:0xf bank_mask:0xf
    s_andn2_b64 s[82:83], s[82:83], s[52:53]
    v_cndmask_b32_dpp v7, v7, v7, vcc wave_shr:1 row_mask:0xf bank_mask:0xf
    s_mov_b64 vcc, s[50:51]
    s_mov_b64 exec, s[50:51]
    s_cbranch_scc0 L2_d28
    s_mov_b64 exec, s[82:83]
    s_nop 1
    v_mfma_f32_4x4x4_16b_bf16 v[88:91], v[12:13], v[84:85], 0
    s_nop 1
    v_mfma_f32_4x4x4_16b_bf16 v[88:91], v[10:11], v[86:87], v[88:91]
    s_nop 4
    v_cvt_pk_bf16_f32 v88, v88, v89
    v_cvt_pk_bf16_f32 v89, v90, v91
    ds_pk_add_bf16 v7, v88 offset:65408
    ds_pk_add_bf16 v7, v89 offset:65412
    s_mov_b64 exec, vcc
    s_branch L2_d28
L2_c29:
    s_mov_b64 s[50:51], vcc
    s_lshl_b64 s[52:53], s[82:83], 1
    s_andn2_b64 s[52:53], s[52:53], s[80:81]
    s_andn2_b64 s[52:53], s[52:53], s[50:51]
    s_or_b64 s[80:81], s[80:81], s[52:53]
    s_not_b64 vcc, s[52:53]
    s_mov_b64 exec, -1
    v_cndmask_b32_dpp v84, v84, v84, vcc wave_shr:1 row_mask:0xf bank_mask:0xf
    v_cndmask_b32_dpp v85, v85, v85, vcc wave_shr:1 row_mask:0xf bank_mask:0xf
    s_lshr_b64 s[52:53], s[52:53], 1
    v_cndmask_b32_dpp v86, v86, v86, vcc wave_shr:1 row_mask:0xf bank_mask:0xf
    v_cndmask_b32_dpp v87, v87, v87, vcc wave_shr:1 row_mask:0xf bank_mask:0xf
    s_andn2_b64 s[82:83], s[82:83], s[52:53]
    v_cndmask_b32_dpp v7, v7, v7, vcc wave_shr:1 row_mask:0xf bank_mask:0xf
    s_mov_b64 vcc, s[50:51]
    s_mov_b64 exec, s[50:51]
    s_cbranch_scc0 L2_d29
    s_mov_b64 exec, s[82:83]
    s_nop 1
    v_mfma_f32_4x4x4_16b_bf16 v[88:91], v[12:13], v[84:85], 0
    s_nop 1
    v_mfma_f32_4x4x4_16b_bf16 v[88:91], v[10:11], v[86:87], v[88:91]
    s_nop 4
    v_cvt_pk_bf16_f32 v88, v88, v89
    v_cvt_pk_bf16_f32 v89, v90, v91
    ds_pk_add_bf16 v7, v88 offset:65408
    ds_pk_add_bf16 v7, v89 offset:65412
    s_mov_b64 exec, vcc
    s_branch L2_d29
L2_c30:
    s_mov_b64 s[50:51], vcc
    s_lshl_b64 s[52:53], s[82:83], 1
    s_andn2_b64 s[52:53], s[52:53], s[80:81]
    s_andn2_b64 s[52:53], s[52:53], s[50:51]
    s_or_b64 s[80:81], s[80:81], s[52:53]
    s_not_b64 vcc, s[52:53]
    s_mov_b64 exec, -1
    v_cndmask_b32_dpp v84, v84, v84, vcc wave_shr:1 row_mask:0xf bank_mask:0xf
    v_cndmask_b32_dpp v85, v85, v85, vcc wave_shr:1 row_mask:0xf bank_mask:0xf
    s_lshr_b64 s[52:53], s[52:53], 1
    v_cndmask_b32_dpp v86, v86, v86, vcc wave_shr:1 row_mask:0xf bank_mask:0xf
    v_cndmask_b32_dpp v87, v87, v87, vcc wave_shr:1 row_mask:0xf bank_mask:0xf
    s_andn2_b64 s[82:83], s[82:83], s[52:53]
    v_cndmask_b32_dpp v7, v7, v7, vcc wave_shr:1 row_mask:0xf bank_mask:0xf
    s_mov_b64 vcc, s[50:51]
    s_mov_b64 exec, s[50:51]
    s_cbranch_scc0 L2_d30
    s_mov_b64 exec, s[82:83]
    s_nop 1
    v_mfma_f32_4x4x4_16b_bf16 v[88:91], v[12:13], v[84:85], 0
    s_nop 1
    v_mfma_f32_4x4x4_16b_bf16 v[88:91], v[10:11], v[86:87], v[88:91]
    s_nop 4
    v_cvt_pk_bf16_f32 v88, v88, v89
    v_cvt_pk_bf16_f32 v89, v90, v91
    ds_pk_add_bf16 v7, v88 offset:65408
    ds_pk_add_bf16 v7, v89 offset:65412
    s_mov_b64 exec, vcc
    s_branch L2_d30
L2_c31:
    s_mov_b64 s[50:51], vcc
    s_lshl_b64 s[52:53], s[82:83], 1
    s_andn2_b64 s[52:53], s[52:53], s[80:81]
    s_andn2_b64 s[52:53], s[52:53], s[50:51]
    s_or_b64 s[80:81], s[80:81], s[52:53]
    s_not_b64 vcc, s[52:53]
    s_mov_b64 exec, -1
    v_cndmask_b32_dpp v84, v84, v84, vcc wave_shr:1 row_mask:0xf bank_mask:0xf
    v_cndmask_b32_dpp v85, v85, v85, vcc wave_shr:1 row_mask:0xf bank_mask:0xf
    s_lshr_b64 s[52:53], s[52:53], 1
    v_cndmask_b32_dpp v86, v86, v86, vcc wave_shr:1 row_mask:0xf bank_mask:0xf
    v_cndmask_b32_dpp v87, v87, v87, vcc wave_shr:1 row_mask:0xf bank_mask:0xf
    s_andn2_b64 s[82:83], s[82:83], s[52:53]
    v_cndmask_b32_dpp v7, v7, v7, vcc wave_shr:1 row_mask:0xf bank_mask:0xf
    s_mov_b64 vcc, s[50:51]
    s_mov_b64 exec, s[50:51]
    s_cbranch_scc0 L2_d31
    s_mov_b64 exec, s[82:83]
    s_nop 1
    v_mfma_f32_4x4x4_16b_bf16 v[88:91], v[12:13], v[84:85], 0
    s_nop 1
    v_mfma_f32_4x4x4_16b_bf16 v[88:91], v[10:11], v[86:87], v[88:91]
    s_nop 4
    v_cvt_pk_bf16_f32 v88, v88, v89
    v_cvt_pk_bf16_f32 v89, v90, v91
    ds_pk_add_bf16 v7, v88 offset:65408
    ds_pk_add_bf16 v7, v89 offset:65412
    s_mov_b64 exec, vcc
    s_branch L2_d31
L2_c32:
    s_mov_b64 s[50:51], vcc
    s_lshl_b64 s[52:53], s[82:83], 1
    s_andn2_b64 s[52:53], s[52:53], s[80:81]
    s_andn2_b64 s[52:53], s[52:53], s[50:51]
    s_or_b64 s[80:81], s[80:81], s[52:53]
    s_not_b64 vcc, s[52:53]
    s_mov_b64 exec, -1
    v_cndmask_b32_dpp v84, v84, v84, vcc wave_shr:1 row_mask:0xf bank_mask:0xf
    v_cndmask_b32_dpp v85, v85, v85, vcc wave_shr:1 row_mask:0xf bank_mask:0xf
    s_lshr_b64 s[52:53], s[52:53], 1
    v_cndmask_b32_dpp v86, v86, v86, vcc wave_shr:1 row_mask:0xf bank_mask:0xf
    v_cndmask_b32_dpp v87, v87, v87, vcc wave_shr:1 row_mask:0xf bank_mask:0xf
    s_andn2_b64 s[82:83], s[82:83], s[52:53]
    v_cndmask_b32_dpp v7, v7, v7, vcc wave_shr:1 row_mask:0xf bank_mask:0xf
    s_mov_b64 vcc, s[50:51]
    s_mov_b64 exec, s[50:51]
    s_cbranch_scc0 L2_d32
    s_mov_b64 exec, s[82:83]
    s_nop 1
    v_mfma_f32_4x4x4_16b_bf16 v[88:91], v[12:13], v[84:85], 0
    s_nop 1
    v_mfma_f32_4x4x4_16b_bf16 v[88:91], v[10:11], v[86:87], v[88:91]
    s_nop 4
    v_cvt_pk_bf16_f32 v88, v88, v89
    v_cvt_pk_bf16_f32 v89, v90, v91
    ds_pk_add_bf16 v7, v88 offset:65408
    ds_pk_add_bf16 v7, v89 offset:65412
    s_mov_b64 exec, vcc
    s_branch L2_d32
L2_c33:
    s_mov_b64 s[50:51], vcc
    s_lshl_b64 s[52:53], s[82:83], 1
    s_andn2_b64 s[52:53], s[52:53], s[80:81]
    s_andn2_b64 s[52:53], s[52:53], s[50:51]
    s_or_b64 s[80:81], s[80:81], s[52:53]
    s_not_b64 vcc, s[52:53]
    s_mov_b64 exec, -1
    v_cndmask_b32_dpp v84, v84, v84, vcc wave_shr:1 row_mask:0xf bank_mask:0xf
    v_cndmask_b32_dpp v85, v85, v85, vcc wave_shr:1 row_mask:0xf bank_mask:0xf
    s_lshr_b64 s[52:53], s[52:53], 1
    v_cndmask_b32_dpp v86, v86, v86, vcc wave_shr:1 row_mask:0xf bank_mask:0xf
    v_cndmask_b32_dpp v87, v87, v87, vcc wave_shr:1 row_mask:0xf bank_mask:0xf
    s_andn2_b64 s[82:83], s[82:83], s[52:53]
    v_cndmask_b32_dpp v7, v7, v7, vcc wave_shr:1 row_mask:0xf bank_mask:0xf
    s_mov_b64 vcc, s[50:51]
    s_mov_b64 exec, s[50:51]
    s_cbranch_scc0 L2_d33
    s_mov_b64 exec, s[82:83]
    s_nop 1
    v_mfma_f32_4x4x4_16b_bf16 v[88:91], v[12:13], v[84:85], 0
    s_nop 1
    v_mfma_f32_4x4x4_16b_bf16 v[88:91], v[10:11], v[86:87], v[88:91]
    s_nop 4
    v_cvt_pk_bf16_f32 v88, v88, v89
    v_cvt_pk_bf16_f32 v89, v90, v91
    ds_pk_add_bf16 v7, v88 offset:65408
    ds_pk_add_bf16 v7, v89 offset:65412
    s_mov_b64 exec, vcc
    s_branch L2_d33
L2_c34:
    s_mov_b64 s[50:51], vcc
    s_lshl_b64 s[52:53], s[82:83], 1
    s_andn2_b64 s[52:53], s[52:53], s[80:81]
    s_andn2_b64 s[52:53], s[52:53], s[50:51]
    s_or_b64 s[80:81], s[80:81], s[52:53]
    s_not_b64 vcc, s[52:53]
    s_mov_b64 exec, -1
    v_cndmask_b32_dpp v84, v84, v84, vcc wave_shr:1 row_mask:0xf bank_mask:0xf
    v_cndmask_b32_dpp v85, v85, v85, vcc wave_shr:1 row_mask:0xf bank_mask:0xf
    s_lshr_b64 s[52:53], s[52:53], 1
    v_cndmask_b32_dpp v86, v86, v86, vcc wave_shr:1 row_mask:0xf bank_mask:0xf
    v_cndmask_b32_dpp v87, v87, v87, vcc wave_shr:1 row_mask:0xf bank_mask:0xf
    s_andn2_b64 s[82:83], s[82:83], s[52:53]
    v_cndmask_b32_dpp v7, v7, v7, vcc wave_shr:1 row_mask:0xf bank_mask:0xf
    s_mov_b64 vcc, s[50:51]
    s_mov_b64 exec, s[50:51]
    s_cbranch_scc0 L2_d34
    s_mov_b64 exec, s[82:83]
    s_nop 1
    v_mfma_f32_4x4x4_16b_bf16 v[88:91], v[12:13], v[84:85], 0
    s_nop 1
    v_mfma_f32_4x4x4_16b_bf16 v[88:91], v[10:11], v[86:87], v[88:91]
    s_nop 4
    v_cvt_pk_bf16_f32 v88, v88, v89
    v_cvt_pk_bf16_f32 v89, v90, v91
    ds_pk_add_bf16 v7, v88 offset:65408
    ds_pk_add_bf16 v7, v89 offset:65412
    s_mov_b64 exec, vcc
    s_branch L2_d34
L2_c35:
    s_mov_b64 s[50:51], vcc
    s_lshl_b64 s[52:53], s[82:83], 1
    s_andn2_b64 s[52:53], s[52:53], s[80:81]
    s_andn2_b64 s[52:53], s[52:53], s[50:51]
    s_or_b64 s[80:81], s[80:81], s[52:53]
    s_not_b64 vcc, s[52:53]
    s_mov_b64 exec, -1
    v_cndmask_b32_dpp v84, v84, v84, vcc wave_shr:1 row_mask:0xf bank_mask:0xf
    v_cndmask_b32_dpp v85, v85, v85, vcc wave_shr:1 row_mask:0xf bank_mask:0xf
    s_lshr_b64 s[52:53], s[52:53], 1
    v_cndmask_b32_dpp v86, v86, v86, vcc wave_shr:1 row_mask:0xf bank_mask:0xf
    v_cndmask_b32_dpp v87, v87, v87, vcc wave_shr:1 row_mask:0xf bank_mask:0xf
    s_andn2_b64 s[82:83], s[82:83], s[52:53]
    v_cndmask_b32_dpp v7, v7, v7, vcc wave_shr:1 row_mask:0xf bank_mask:0xf
    s_mov_b64 vcc, s[50:51]
    s_mov_b64 exec, s[50:51]
    s_cbranch_scc0 L2_d35
    s_mov_b64 exec, s[82:83]
    s_nop 1
    v_mfma_f32_4x4x4_16b_bf16 v[88:91], v[12:13], v[84:85], 0
    s_nop 1
    v_mfma_f32_4x4x4_16b_bf16 v[88:91], v[10:11], v[86:87], v[88:91]
    s_nop 4
    v_cvt_pk_bf16_f32 v88, v88, v89
    v_cvt_pk_bf16_f32 v89, v90, v91
    ds_pk_add_bf16 v7, v88 offset:65408
    ds_pk_add_bf16 v7, v89 offset:65412
    s_mov_b64 exec, vcc
    s_branch L2_d35
L2_xa36:
    s_cmp_eq_u32 s43, 1
    s_cbranch_scc1 L2_xc36
    v_lshlrev_b32 v89, 0, v96
    v_add_u32 v90, 140, v97
    v_bitop3_b32 v90, v89, v45, v90 bitop3:0x6a
    ds_write_b32 v98, v90 offset:28
    v_lshlrev_b32 v89, 4, v96
    v_add_u32 v90, 120, v97
    v_bitop3_b32 v90, v89, v45, v90 bitop3:0x6a
    ds_write_b32 v98, v90 offset:24
    v_lshlrev_b32 v89, 8, v96
    v_add_u32 v90, 100, v97
    v_bitop3_b32 v90, v89, v45, v90 bitop3:0x6a
    ds_write_b32 v98, v90 offset:20
L2_xc36:
    v_lshlrev_b32 v89, 12, v96
    v_add_u32 v90, 80, v97
    v_bitop3_b32 v90, v89, v45, v90 bitop3:0x6a
    ds_write_b32 v98, v90 offset:16
    s_branch L2_xb36
L2_xe36:
    v_cmp_lt_u32 vcc, 32, v99
    v_cmp_lt_u32 s[58:59], 31, v88
    v_lshrrev_b32 v89, 16, v96
    v_add_u32 v97, 80, v97
    s_or_b64 vcc, vcc, s[58:59]
    s_cbranch_scc1 L2_xs36
    v_lshlrev_b32 v89, v1, v89
    v_and_b32 v89, v45, v89
    v_cmp_ne_u32 vcc, 0, v89
    v_xor_b32 v90, v97, v89
    s_add_u32 s3, s37, s38
    v_mbcnt_lo_u32_b32 v98, vcc_lo, 0
    v_mbcnt_hi_u32_b32 v98, vcc_hi, v98
    s_bcnt1_i32_b64 s41, vcc
    v_lshl_add_u32 v98, v98, 2, s3
    s_mov_b64 exec, vcc
    ds_write_b32 v98, v90
    s_mov_b64 exec, -1
    s_lshl2_add_u32 s37, s41, s37
    s_branch L2_xr36
L2_xf36:
    s_waitcnt lgkmcnt(0)
    s_cmp_gt_u32 s37, 1024
    s_cbranch_scc1 L2_xs36
    v_mov_b32 v43, -1
    s_cmp_ge_u32 s37, 512
    s_cbranch_scc1 L2_xg36
    v_mov_b32 v42, -1
    s_cmp_ge_u32 s37, 256
    s_cbranch_scc1 L2_xg36
    v_mov_b32 v41, -1
    s_branch L2_xg36
L2_xs36:
    s_waitcnt lgkmcnt(0)
    v_mov_b32 v40, -1
    v_mov_b32 v41, -1
    v_mov_b32 v42, -1
    v_mov_b32 v43, -1
    s_add_u32 s3, s42, 2
    s_bitset1_b32 s36, s3
    s_branch L2_xg36
L2_c37:
    s_mov_b64 s[50:51], vcc
    s_lshl_b64 s[52:53], s[82:83], 1
    s_andn2_b64 s[52:53], s[52:53], s[80:81]
    s_andn2_b64 s[52:53], s[52:53], s[50:51]
    s_or_b64 s[80:81], s[80:81], s[52:53]
    s_not_b64 vcc, s[52:53]
    s_mov_b64 exec, -1
    v_cndmask_b32_dpp v84, v84, v84, vcc wave_shr:1 row_mask:0xf bank_mask:0xf
    v_cndmask_b32_dpp v85, v85, v85, vcc wave_shr:1 row_mask:0xf bank_mask:0xf
    s_lshr_b64 s[52:53], s[52:53], 1
    v_cndmask_b32_dpp v86, v86, v86, vcc wave_shr:1 row_mask:0xf bank_mask:0xf
    v_cndmask_b32_dpp v87, v87, v87, vcc wave_shr:1 row_mask:0xf bank_mask:0xf
    s_andn2_b64 s[82:83], s[82:83], s[52:53]
    v_cndmask_b32_dpp v7, v7, v7, vcc wave_shr:1 row_mask:0xf bank_mask:0xf
    s_mov_b64 vcc, s[50:51]
    s_mov_b64 exec, s[50:51]
    s_cbranch_scc0 L2_d37
    s_mov_b64 exec, s[82:83]
    s_nop 1
    v_mfma_f32_4x4x4_16b_bf16 v[88:91], v[12:13], v[84:85], 0
    s_nop 1
    v_mfma_f32_4x4x4_16b_bf16 v[88:91], v[10:11], v[86:87], v[88:91]
    s_nop 4
    v_cvt_pk_bf16_f32 v88, v88, v89
    v_cvt_pk_bf16_f32 v89, v90, v91
    ds_pk_add_bf16 v7, v88 offset:65408
    ds_pk_add_bf16 v7, v89 offset:65412
    s_mov_b64 exec, vcc
    s_branch L2_d37
L2_c38:
    s_mov_b64 s[50:51], vcc
    s_lshl_b64 s[52:53], s[82:83], 1
    s_andn2_b64 s[52:53], s[52:53], s[80:81]
    s_andn2_b64 s[52:53], s[52:53], s[50:51]
    s_or_b64 s[80:81], s[80:81], s[52:53]
    s_not_b64 vcc, s[52:53]
    s_mov_b64 exec, -1
    v_cndmask_b32_dpp v84, v84, v84, vcc wave_shr:1 row_mask:0xf bank_mask:0xf
    v_cndmask_b32_dpp v85, v85, v85, vcc wave_shr:1 row_mask:0xf bank_mask:0xf
    s_lshr_b64 s[52:53], s[52:53], 1
    v_cndmask_b32_dpp v86, v86, v86, vcc wave_shr:1 row_mask:0xf bank_mask:0xf
    v_cndmask_b32_dpp v87, v87, v87, vcc wave_shr:1 row_mask:0xf bank_mask:0xf
    s_andn2_b64 s[82:83], s[82:83], s[52:53]
    v_cndmask_b32_dpp v7, v7, v7, vcc wave_shr:1 row_mask:0xf bank_mask:0xf
    s_mov_b64 vcc, s[50:51]
    s_mov_b64 exec, s[50:51]
    s_cbranch_scc0 L2_d38
    s_mov_b64 exec, s[82:83]
    s_nop 1
    v_mfma_f32_4x4x4_16b_bf16 v[88:91], v[12:13], v[84:85], 0
    s_nop 1
    v_mfma_f32_4x4x4_16b_bf16 v[88:91], v[10:11], v[86:87], v[88:91]
    s_nop 4
    v_cvt_pk_bf16_f32 v88, v88, v89
    v_cvt_pk_bf16_f32 v89, v90, v91
    ds_pk_add_bf16 v7, v88 offset:65408
    ds_pk_add_bf16 v7, v89 offset:65412
    s_mov_b64 exec, vcc
    s_branch L2_d38
L2_c39:
    s_mov_b64 s[50:51], vcc
    s_lshl_b64 s[52:53], s[82:83], 1
    s_andn2_b64 s[52:53], s[52:53], s[80:81]
    s_andn2_b64 s[52:53], s[52:53], s[50:51]
    s_or_b64 s[80:81], s[80:81], s[52:53]
    s_not_b64 vcc, s[52:53]
    s_mov_b64 exec, -1
    v_cndmask_b32_dpp v84, v84, v84, vcc wave_shr:1 row_mask:0xf bank_mask:0xf
    v_cndmask_b32_dpp v85, v85, v85, vcc wave_shr:1 row_mask:0xf bank_mask:0xf
    s_lshr_b64 s[52:53], s[52:53], 1
    v_cndmask_b32_dpp v86, v86, v86, vcc wave_shr:1 row_mask:0xf bank_mask:0xf
    v_cndmask_b32_dpp v87, v87, v87, vcc wave_shr:1 row_mask:0xf bank_mask:0xf
    s_andn2_b64 s[82:83], s[82:83], s[52:53]
    v_cndmask_b32_dpp v7, v7, v7, vcc wave_shr:1 row_mask:0xf bank_mask:0xf
    s_mov_b64 vcc, s[50:51]
    s_mov_b64 exec, s[50:51]
    s_cbranch_scc0 L2_d39
    s_mov_b64 exec, s[82:83]
    s_nop 1
    v_mfma_f32_4x4x4_16b_bf16 v[88:91], v[12:13], v[84:85], 0
    s_nop 1
    v_mfma_f32_4x4x4_16b_bf16 v[88:91], v[10:11], v[86:87], v[88:91]
    s_nop 4
    v_cvt_pk_bf16_f32 v88, v88, v89
    v_cvt_pk_bf16_f32 v89, v90, v91
    ds_pk_add_bf16 v7, v88 offset:65408
    ds_pk_add_bf16 v7, v89 offset:65412
    s_mov_b64 exec, vcc
    s_branch L2_d39
L2_c40:
    s_mov_b64 s[50:51], vcc
    s_lshl_b64 s[52:53], s[82:83], 1
    s_andn2_b64 s[52:53], s[52:53], s[80:81]
    s_andn2_b64 s[52:53], s[52:53], s[50:51]
    s_or_b64 s[80:81], s[80:81], s[52:53]
    s_not_b64 vcc, s[52:53]
    s_mov_b64 exec, -1
    v_cndmask_b32_dpp v84, v84, v84, vcc wave_shr:1 row_mask:0xf bank_mask:0xf
    v_cndmask_b32_dpp v85, v85, v85, vcc wave_shr:1 row_mask:0xf bank_mask:0xf
    s_lshr_b64 s[52:53], s[52:53], 1
    v_cndmask_b32_dpp v86, v86, v86, vcc wave_shr:1 row_mask:0xf bank_mask:0xf
    v_cndmask_b32_dpp v87, v87, v87, vcc wave_shr:1 row_mask:0xf bank_mask:0xf
    s_andn2_b64 s[82:83], s[82:83], s[52:53]
    v_cndmask_b32_dpp v7, v7, v7, vcc wave_shr:1 row_mask:0xf bank_mask:0xf
    s_mov_b64 vcc, s[50:51]
    s_mov_b64 exec, s[50:51]
    s_cbranch_scc0 L2_d40
    s_mov_b64 exec, s[82:83]
    s_nop 1
    v_mfma_f32_4x4x4_16b_bf16 v[88:91], v[12:13], v[84:85], 0
    s_nop 1
    v_mfma_f32_4x4x4_16b_bf16 v[88:91], v[10:11], v[86:87], v[88:91]
    s_nop 4
    v_cvt_pk_bf16_f32 v88, v88, v89
    v_cvt_pk_bf16_f32 v89, v90, v91
    ds_pk_add_bf16 v7, v88 offset:65408
    ds_pk_add_bf16 v7, v89 offset:65412
    s_mov_b64 exec, vcc
    s_branch L2_d40
L2_c41:
    s_mov_b64 s[50:51], vcc
    s_lshl_b64 s[52:53], s[82:83], 1
    s_andn2_b64 s[52:53], s[52:53], s[80:81]
    s_andn2_b64 s[52:53], s[52:53], s[50:51]
    s_or_b64 s[80:81], s[80:81], s[52:53]
    s_not_b64 vcc, s[52:53]
    s_mov_b64 exec, -1
    v_cndmask_b32_dpp v84, v84, v84, vcc wave_shr:1 row_mask:0xf bank_mask:0xf
    v_cndmask_b32_dpp v85, v85, v85, vcc wave_shr:1 row_mask:0xf bank_mask:0xf
    s_lshr_b64 s[52:53], s[52:53], 1
    v_cndmask_b32_dpp v86, v86, v86, vcc wave_shr:1 row_mask:0xf bank_mask:0xf
    v_cndmask_b32_dpp v87, v87, v87, vcc wave_shr:1 row_mask:0xf bank_mask:0xf
    s_andn2_b64 s[82:83], s[82:83], s[52:53]
    v_cndmask_b32_dpp v7, v7, v7, vcc wave_shr:1 row_mask:0xf bank_mask:0xf
    s_mov_b64 vcc, s[50:51]
    s_mov_b64 exec, s[50:51]
    s_cbranch_scc0 L2_d41
    s_mov_b64 exec, s[82:83]
    s_nop 1
    v_mfma_f32_4x4x4_16b_bf16 v[88:91], v[12:13], v[84:85], 0
    s_nop 1
    v_mfma_f32_4x4x4_16b_bf16 v[88:91], v[10:11], v[86:87], v[88:91]
    s_nop 4
    v_cvt_pk_bf16_f32 v88, v88, v89
    v_cvt_pk_bf16_f32 v89, v90, v91
    ds_pk_add_bf16 v7, v88 offset:65408
    ds_pk_add_bf16 v7, v89 offset:65412
    s_mov_b64 exec, vcc
    s_branch L2_d41
L2_c42:
    s_mov_b64 s[50:51], vcc
    s_lshl_b64 s[52:53], s[82:83], 1
    s_andn2_b64 s[52:53], s[52:53], s[80:81]
    s_andn2_b64 s[52:53], s[52:53], s[50:51]
    s_or_b64 s[80:81], s[80:81], s[52:53]
    s_not_b64 vcc, s[52:53]
    s_mov_b64 exec, -1
    v_cndmask_b32_dpp v84, v84, v84, vcc wave_shr:1 row_mask:0xf bank_mask:0xf
    v_cndmask_b32_dpp v85, v85, v85, vcc wave_shr:1 row_mask:0xf bank_mask:0xf
    s_lshr_b64 s[52:53], s[52:53], 1
    v_cndmask_b32_dpp v86, v86, v86, vcc wave_shr:1 row_mask:0xf bank_mask:0xf
    v_cndmask_b32_dpp v87, v87, v87, vcc wave_shr:1 row_mask:0xf bank_mask:0xf
    s_andn2_b64 s[82:83], s[82:83], s[52:53]
    v_cndmask_b32_dpp v7, v7, v7, vcc wave_shr:1 row_mask:0xf bank_mask:0xf
    s_mov_b64 vcc, s[50:51]
    s_mov_b64 exec, s[50:51]
    s_cbranch_scc0 L2_d42
    s_mov_b64 exec, s[82:83]
    s_nop 1
    v_mfma_f32_4x4x4_16b_bf16 v[88:91], v[12:13], v[84:85], 0
    s_nop 1
    v_mfma_f32_4x4x4_16b_bf16 v[88:91], v[10:11], v[86:87], v[88:91]
    s_nop 4
    v_cvt_pk_bf16_f32 v88, v88, v89
    v_cvt_pk_bf16_f32 v89, v90, v91
    ds_pk_add_bf16 v7, v88 offset:65408
    ds_pk_add_bf16 v7, v89 offset:65412
    s_mov_b64 exec, vcc
    s_branch L2_d42
L2_c43:
    s_mov_b64 s[50:51], vcc
    s_lshl_b64 s[52:53], s[82:83], 1
    s_andn2_b64 s[52:53], s[52:53], s[80:81]
    s_andn2_b64 s[52:53], s[52:53], s[50:51]
    s_or_b64 s[80:81], s[80:81], s[52:53]
    s_not_b64 vcc, s[52:53]
    s_mov_b64 exec, -1
    v_cndmask_b32_dpp v84, v84, v84, vcc wave_shr:1 row_mask:0xf bank_mask:0xf
    v_cndmask_b32_dpp v85, v85, v85, vcc wave_shr:1 row_mask:0xf bank_mask:0xf
    s_lshr_b64 s[52:53], s[52:53], 1
    v_cndmask_b32_dpp v86, v86, v86, vcc wave_shr:1 row_mask:0xf bank_mask:0xf
    v_cndmask_b32_dpp v87, v87, v87, vcc wave_shr:1 row_mask:0xf bank_mask:0xf
    s_andn2_b64 s[82:83], s[82:83], s[52:53]
    v_cndmask_b32_dpp v7, v7, v7, vcc wave_shr:1 row_mask:0xf bank_mask:0xf
    s_mov_b64 vcc, s[50:51]
    s_mov_b64 exec, s[50:51]
    s_cbranch_scc0 L2_d43
    s_mov_b64 exec, s[82:83]
    s_nop 1
    v_mfma_f32_4x4x4_16b_bf16 v[88:91], v[12:13], v[84:85], 0
    s_nop 1
    v_mfma_f32_4x4x4_16b_bf16 v[88:91], v[10:11], v[86:87], v[88:91]
    s_nop 4
    v_cvt_pk_bf16_f32 v88, v88, v89
    v_cvt_pk_bf16_f32 v89, v90, v91
    ds_pk_add_bf16 v7, v88 offset:65408
    ds_pk_add_bf16 v7, v89 offset:65412
    s_mov_b64 exec, vcc
    s_branch L2_d43
L2_c44:
    s_mov_b64 s[50:51], vcc
    s_lshl_b64 s[52:53], s[82:83], 1
    s_andn2_b64 s[52:53], s[52:53], s[80:81]
    s_andn2_b64 s[52:53], s[52:53], s[50:51]
    s_or_b64 s[80:81], s[80:81], s[52:53]
    s_not_b64 vcc, s[52:53]
    s_mov_b64 exec, -1
    v_cndmask_b32_dpp v84, v84, v84, vcc wave_shr:1 row_mask:0xf bank_mask:0xf
    v_cndmask_b32_dpp v85, v85, v85, vcc wave_shr:1 row_mask:0xf bank_mask:0xf
    s_lshr_b64 s[52:53], s[52:53], 1
    v_cndmask_b32_dpp v86, v86, v86, vcc wave_shr:1 row_mask:0xf bank_mask:0xf
    v_cndmask_b32_dpp v87, v87, v87, vcc wave_shr:1 row_mask:0xf bank_mask:0xf
    s_andn2_b64 s[82:83], s[82:83], s[52:53]
    v_cndmask_b32_dpp v7, v7, v7, vcc wave_shr:1 row_mask:0xf bank_mask:0xf
    s_mov_b64 vcc, s[50:51]
    s_mov_b64 exec, s[50:51]
    s_cbranch_scc0 L2_d44
    s_mov_b64 exec, s[82:83]
    s_nop 1
    v_mfma_f32_4x4x4_16b_bf16 v[88:91], v[12:13], v[84:85], 0
    s_nop 1
    v_mfma_f32_4x4x4_16b_bf16 v[88:91], v[10:11], v[86:87], v[88:91]
    s_nop 4
    v_cvt_pk_bf16_f32 v88, v88, v89
    v_cvt_pk_bf16_f32 v89, v90, v91
    ds_pk_add_bf16 v7, v88 offset:65408
    ds_pk_add_bf16 v7, v89 offset:65412
    s_mov_b64 exec, vcc
    s_branch L2_d44
L2_xo45:
    v_cmp_lt_u32 vcc, 20, v99
    s_mov_b32 s43, 1
    s_cbranch_vccz L2_xp45
    v_cmp_lt_u32 vcc, 32, v99
    v_cmp_lt_u32 s[58:59], 31, v88
    s_mov_b32 s43, 2
    s_or_b64 vcc, vcc, s[58:59]
    s_cbranch_scc0 L2_xp45
    s_mov_b32 s37, 0x10000
    s_branch L2_xp45
L2_c46:
    s_mov_b64 s[50:51], vcc
    s_lshl_b64 s[52:53], s[82:83], 1
    s_andn2_b64 s[52:53], s[52:53], s[80:81]
    s_andn2_b64 s[52:53], s[52:53], s[50:51]
    s_or_b64 s[80:81], s[80:81], s[52:53]
    s_not_b64 vcc, s[52:53]
    s_mov_b64 exec, -1
    v_cndmask_b32_dpp v84, v84, v84, vcc wave_shr:1 row_mask:0xf bank_mask:0xf
    v_cndmask_b32_dpp v85, v85, v85, vcc wave_shr:1 row_mask:0xf bank_mask:0xf
    s_lshr_b64 s[52:53], s[52:53], 1
    v_cndmask_b32_dpp v86, v86, v86, vcc wave_shr:1 row_mask:0xf bank_mask:0xf
    v_cndmask_b32_dpp v87, v87, v87, vcc wave_shr:1 row_mask:0xf bank_mask:0xf
    s_andn2_b64 s[82:83], s[82:83], s[52:53]
    v_cndmask_b32_dpp v7, v7, v7, vcc wave_shr:1 row_mask:0xf bank_mask:0xf
    s_mov_b64 vcc, s[50:51]
    s_mov_b64 exec, s[50:51]
    s_cbranch_scc0 L2_d46
    s_mov_b64 exec, s[82:83]
    s_nop 1
    v_mfma_f32_4x4x4_16b_bf16 v[88:91], v[12:13], v[84:85], 0
    s_nop 1
    v_mfma_f32_4x4x4_16b_bf16 v[88:91], v[10:11], v[86:87], v[88:91]
    s_nop 4
    v_cvt_pk_bf16_f32 v88, v88, v89
    v_cvt_pk_bf16_f32 v89, v90, v91
    ds_pk_add_bf16 v7, v88 offset:65408
    ds_pk_add_bf16 v7, v89 offset:65412
    s_mov_b64 exec, vcc
    s_branch L2_d46
L2_c47:
    s_mov_b64 s[50:51], vcc
    s_lshl_b64 s[52:53], s[82:83], 1
    s_andn2_b64 s[52:53], s[52:53], s[80:81]
    s_andn2_b64 s[52:53], s[52:53], s[50:51]
    s_or_b64 s[80:81], s[80:81], s[52:53]
    s_not_b64 vcc, s[52:53]
    s_mov_b64 exec, -1
    v_cndmask_b32_dpp v84, v84, v84, vcc wave_shr:1 row_mask:0xf bank_mask:0xf
    v_cndmask_b32_dpp v85, v85, v85, vcc wave_shr:1 row_mask:0xf bank_mask:0xf
    s_lshr_b64 s[52:53], s[52:53], 1
    v_cndmask_b32_dpp v86, v86, v86, vcc wave_shr:1 row_mask:0xf bank_mask:0xf
    v_cndmask_b32_dpp v87, v87, v87, vcc wave_shr:1 row_mask:0xf bank_mask:0xf
    s_andn2_b64 s[82:83], s[82:83], s[52:53]
    v_cndmask_b32_dpp v7, v7, v7, vcc wave_shr:1 row_mask:0xf bank_mask:0xf
    s_mov_b64 vcc, s[50:51]
    s_mov_b64 exec, s[50:51]
    s_cbranch_scc0 L2_d47
    s_mov_b64 exec, s[82:83]
    s_nop 1
    v_mfma_f32_4x4x4_16b_bf16 v[88:91], v[12:13], v[84:85], 0
    s_nop 1
    v_mfma_f32_4x4x4_16b_bf16 v[88:91], v[10:11], v[86:87], v[88:91]
    s_nop 4
    v_cvt_pk_bf16_f32 v88, v88, v89
    v_cvt_pk_bf16_f32 v89, v90, v91
    ds_pk_add_bf16 v7, v88 offset:65408
    ds_pk_add_bf16 v7, v89 offset:65412
    s_mov_b64 exec, vcc
    s_branch L2_d47
L2_c48:
    s_mov_b64 s[50:51], vcc
    s_lshl_b64 s[52:53], s[82:83], 1
    s_andn2_b64 s[52:53], s[52:53], s[80:81]
    s_andn2_b64 s[52:53], s[52:53], s[50:51]
    s_or_b64 s[80:81], s[80:81], s[52:53]
    s_not_b64 vcc, s[52:53]
    s_mov_b64 exec, -1
    v_cndmask_b32_dpp v84, v84, v84, vcc wave_shr:1 row_mask:0xf bank_mask:0xf
    v_cndmask_b32_dpp v85, v85, v85, vcc wave_shr:1 row_mask:0xf bank_mask:0xf
    s_lshr_b64 s[52:53], s[52:53], 1
    v_cndmask_b32_dpp v86, v86, v86, vcc wave_shr:1 row_mask:0xf bank_mask:0xf
    v_cndmask_b32_dpp v87, v87, v87, vcc wave_shr:1 row_mask:0xf bank_mask:0xf
    s_andn2_b64 s[82:83], s[82:83], s[52:53]
    v_cndmask_b32_dpp v7, v7, v7, vcc wave_shr:1 row_mask:0xf bank_mask:0xf
    s_mov_b64 vcc, s[50:51]
    s_mov_b64 exec, s[50:51]
    s_cbranch_scc0 L2_d48
    s_mov_b64 exec, s[82:83]
    s_nop 1
    v_mfma_f32_4x4x4_16b_bf16 v[88:91], v[12:13], v[84:85], 0
    s_nop 1
    v_mfma_f32_4x4x4_16b_bf16 v[88:91], v[10:11], v[86:87], v[88:91]
    s_nop 4
    v_cvt_pk_bf16_f32 v88, v88, v89
    v_cvt_pk_bf16_f32 v89, v90, v91
    ds_pk_add_bf16 v7, v88 offset:65408
    ds_pk_add_bf16 v7, v89 offset:65412
    s_mov_b64 exec, vcc
    s_branch L2_d48
L2_c49:
    s_mov_b64 s[50:51], vcc
    s_lshl_b64 s[52:53], s[82:83], 1
    s_andn2_b64 s[52:53], s[52:53], s[80:81]
    s_andn2_b64 s[52:53], s[52:53], s[50:51]
    s_or_b64 s[80:81], s[80:81], s[52:53]
    s_not_b64 vcc, s[52:53]
    s_mov_b64 exec, -1
    v_cndmask_b32_dpp v84, v84, v84, vcc wave_shr:1 row_mask:0xf bank_mask:0xf
    v_cndmask_b32_dpp v85, v85, v85, vcc wave_shr:1 row_mask:0xf bank_mask:0xf
    s_lshr_b64 s[52:53], s[52:53], 1
    v_cndmask_b32_dpp v86, v86, v86, vcc wave_shr:1 row_mask:0xf bank_mask:0xf
    v_cndmask_b32_dpp v87, v87, v87, vcc wave_shr:1 row_mask:0xf bank_mask:0xf
    s_andn2_b64 s[82:83], s[82:83], s[52:53]
    v_cndmask_b32_dpp v7, v7, v7, vcc wave_shr:1 row_mask:0xf bank_mask:0xf
    s_mov_b64 vcc, s[50:51]
    s_mov_b64 exec, s[50:51]
    s_cbranch_scc0 L2_d49
    s_mov_b64 exec, s[82:83]
    s_nop 1
    v_mfma_f32_4x4x4_16b_bf16 v[88:91], v[12:13], v[84:85], 0
    s_nop 1
    v_mfma_f32_4x4x4_16b_bf16 v[88:91], v[10:11], v[86:87], v[88:91]
    s_nop 4
    v_cvt_pk_bf16_f32 v88, v88, v89
    v_cvt_pk_bf16_f32 v89, v90, v91
    ds_pk_add_bf16 v7, v88 offset:65408
    ds_pk_add_bf16 v7, v89 offset:65412
    s_mov_b64 exec, vcc
    s_branch L2_d49
L2_c50:
    s_mov_b64 s[50:51], vcc
    s_lshl_b64 s[52:53], s[82:83], 1
    s_andn2_b64 s[52:53], s[52:53], s[80:81]
    s_andn2_b64 s[52:53], s[52:53], s[50:51]
    s_or_b64 s[80:81], s[80:81], s[52:53]
    s_not_b64 vcc, s[52:53]
    s_mov_b64 exec, -1
    v_cndmask_b32_dpp v84, v84, v84, vcc wave_shr:1 row_mask:0xf bank_mask:0xf
    v_cndmask_b32_dpp v85, v85, v85, vcc wave_shr:1 row_mask:0xf bank_mask:0xf
    s_lshr_b64 s[52:53], s[52:53], 1
    v_cndmask_b32_dpp v86, v86, v86, vcc wave_shr:1 row_mask:0xf bank_mask:0xf
    v_cndmask_b32_dpp v87, v87, v87, vcc wave_shr:1 row_mask:0xf bank_mask:0xf
    s_andn2_b64 s[82:83], s[82:83], s[52:53]
    v_cndmask_b32_dpp v7, v7, v7, vcc wave_shr:1 row_mask:0xf bank_mask:0xf
    s_mov_b64 vcc, s[50:51]
    s_mov_b64 exec, s[50:51]
    s_cbranch_scc0 L2_d50
    s_mov_b64 exec, s[82:83]
    s_nop 1
    v_mfma_f32_4x4x4_16b_bf16 v[88:91], v[12:13], v[84:85], 0
    s_nop 1
    v_mfma_f32_4x4x4_16b_bf16 v[88:91], v[10:11], v[86:87], v[88:91]
    s_nop 4
    v_cvt_pk_bf16_f32 v88, v88, v89
    v_cvt_pk_bf16_f32 v89, v90, v91
    ds_pk_add_bf16 v7, v88 offset:65408
    ds_pk_add_bf16 v7, v89 offset:65412
    s_mov_b64 exec, vcc
    s_branch L2_d50
L2_c51:
    s_mov_b64 s[50:51], vcc
    s_lshl_b64 s[52:53], s[82:83], 1
    s_andn2_b64 s[52:53], s[52:53], s[80:81]
    s_andn2_b64 s[52:53], s[52:53], s[50:51]
    s_or_b64 s[80:81], s[80:81], s[52:53]
    s_not_b64 vcc, s[52:53]
    s_mov_b64 exec, -1
    v_cndmask_b32_dpp v84, v84, v84, vcc wave_shr:1 row_mask:0xf bank_mask:0xf
    v_cndmask_b32_dpp v85, v85, v85, vcc wave_shr:1 row_mask:0xf bank_mask:0xf
    s_lshr_b64 s[52:53], s[52:53], 1
    v_cndmask_b32_dpp v86, v86, v86, vcc wave_shr:1 row_mask:0xf bank_mask:0xf
    v_cndmask_b32_dpp v87, v87, v87, vcc wave_shr:1 row_mask:0xf bank_mask:0xf
    s_andn2_b64 s[82:83], s[82:83], s[52:53]
    v_cndmask_b32_dpp v7, v7, v7, vcc wave_shr:1 row_mask:0xf bank_mask:0xf
    s_mov_b64 vcc, s[50:51]
    s_mov_b64 exec, s[50:51]
    s_cbranch_scc0 L2_d51
    s_mov_b64 exec, s[82:83]
    s_nop 1
    v_mfma_f32_4x4x4_16b_bf16 v[88:91], v[12:13], v[84:85], 0
    s_nop 1
    v_mfma_f32_4x4x4_16b_bf16 v[88:91], v[10:11], v[86:87], v[88:91]
    s_nop 4
    v_cvt_pk_bf16_f32 v88, v88, v89
    v_cvt_pk_bf16_f32 v89, v90, v91
    ds_pk_add_bf16 v7, v88 offset:65408
    ds_pk_add_bf16 v7, v89 offset:65412
    s_mov_b64 exec, vcc
    s_branch L2_d51
L2_c52:
    s_mov_b64 s[50:51], vcc
    s_lshl_b64 s[52:53], s[82:83], 1
    s_andn2_b64 s[52:53], s[52:53], s[80:81]
    s_andn2_b64 s[52:53], s[52:53], s[50:51]
    s_or_b64 s[80:81], s[80:81], s[52:53]
    s_not_b64 vcc, s[52:53]
    s_mov_b64 exec, -1
    v_cndmask_b32_dpp v84, v84, v84, vcc wave_shr:1 row_mask:0xf bank_mask:0xf
    v_cndmask_b32_dpp v85, v85, v85, vcc wave_shr:1 row_mask:0xf bank_mask:0xf
    s_lshr_b64 s[52:53], s[52:53], 1
    v_cndmask_b32_dpp v86, v86, v86, vcc wave_shr:1 row_mask:0xf bank_mask:0xf
    v_cndmask_b32_dpp v87, v87, v87, vcc wave_shr:1 row_mask:0xf bank_mask:0xf
    s_andn2_b64 s[82:83], s[82:83], s[52:53]
    v_cndmask_b32_dpp v7, v7, v7, vcc wave_shr:1 row_mask:0xf bank_mask:0xf
    s_mov_b64 vcc, s[50:51]
    s_mov_b64 exec, s[50:51]
    s_cbranch_scc0 L2_d52
    s_mov_b64 exec, s[82:83]
    s_nop 1
    v_mfma_f32_4x4x4_16b_bf16 v[88:91], v[12:13], v[84:85], 0
    s_nop 1
    v_mfma_f32_4x4x4_16b_bf16 v[88:91], v[10:11], v[86:87], v[88:91]
    s_nop 4
    v_cvt_pk_bf16_f32 v88, v88, v89
    v_cvt_pk_bf16_f32 v89, v90, v91
    ds_pk_add_bf16 v7, v88 offset:65408
    ds_pk_add_bf16 v7, v89 offset:65412
    s_mov_b64 exec, vcc
    s_branch L2_d52
L2_c53:
    s_mov_b64 s[50:51], vcc
    s_lshl_b64 s[52:53], s[82:83], 1
    s_andn2_b64 s[52:53], s[52:53], s[80:81]
    s_andn2_b64 s[52:53], s[52:53], s[50:51]
    s_or_b64 s[80:81], s[80:81], s[52:53]
    s_not_b64 vcc, s[52:53]
    s_mov_b64 exec, -1
    v_cndmask_b32_dpp v84, v84, v84, vcc wave_shr:1 row_mask:0xf bank_mask:0xf
    v_cndmask_b32_dpp v85, v85, v85, vcc wave_shr:1 row_mask:0xf bank_mask:0xf
    s_lshr_b64 s[52:53], s[52:53], 1
    v_cndmask_b32_dpp v86, v86, v86, vcc wave_shr:1 row_mask:0xf bank_mask:0xf
    v_cndmask_b32_dpp v87, v87, v87, vcc wave_shr:1 row_mask:0xf bank_mask:0xf
    s_andn2_b64 s[82:83], s[82:83], s[52:53]
    v_cndmask_b32_dpp v7, v7, v7, vcc wave_shr:1 row_mask:0xf bank_mask:0xf
    s_mov_b64 vcc, s[50:51]
    s_mov_b64 exec, s[50:51]
    s_cbranch_scc0 L2_d53
    s_mov_b64 exec, s[82:83]
    s_nop 1
    v_mfma_f32_4x4x4_16b_bf16 v[88:91], v[12:13], v[84:85], 0
    s_nop 1
    v_mfma_f32_4x4x4_16b_bf16 v[88:91], v[10:11], v[86:87], v[88:91]
    s_nop 4
    v_cvt_pk_bf16_f32 v88, v88, v89
    v_cvt_pk_bf16_f32 v89, v90, v91
    ds_pk_add_bf16 v7, v88 offset:65408
    ds_pk_add_bf16 v7, v89 offset:65412
    s_mov_b64 exec, vcc
    s_branch L2_d53
L2_xa54:
    s_cmp_eq_u32 s43, 1
    s_cbranch_scc1 L2_xc54
    v_lshlrev_b32 v89, 0, v96
    v_add_u32 v90, 140, v97
    v_bitop3_b32 v90, v89, v45, v90 bitop3:0x6a
    ds_write_b32 v98, v90 offset:28
    v_lshlrev_b32 v89, 4, v96
    v_add_u32 v90, 120, v97
    v_bitop3_b32 v90, v89, v45, v90 bitop3:0x6a
    ds_write_b32 v98, v90 offset:24
    v_lshlrev_b32 v89, 8, v96
    v_add_u32 v90, 100, v97
    v_bitop3_b32 v90, v89, v45, v90 bitop3:0x6a
    ds_write_b32 v98, v90 offset:20
L2_xc54:
    v_lshlrev_b32 v89, 12, v96
    v_add_u32 v90, 80, v97
    v_bitop3_b32 v90, v89, v45, v90 bitop3:0x6a
    ds_write_b32 v98, v90 offset:16
    s_branch L2_xb54
L2_xe54:
    v_cmp_lt_u32 vcc, 32, v99
    v_cmp_lt_u32 s[58:59], 31, v88
    v_lshrrev_b32 v89, 16, v96
    v_add_u32 v97, 80, v97
    s_or_b64 vcc, vcc, s[58:59]
    s_cbranch_scc1 L2_xs54
    v_lshlrev_b32 v89, v1, v89
    v_and_b32 v89, v45, v89
    v_cmp_ne_u32 vcc, 0, v89
    v_xor_b32 v90, v97, v89
    s_add_u32 s3, s37, s38
    v_mbcnt_lo_u32_b32 v98, vcc_lo, 0
    v_mbcnt_hi_u32_b32 v98, vcc_hi, v98
    s_bcnt1_i32_b64 s41, vcc
    v_lshl_add_u32 v98, v98, 2, s3
    s_mov_b64 exec, vcc
    ds_write_b32 v98, v90
    s_mov_b64 exec, -1
    s_lshl2_add_u32 s37, s41, s37
    s_branch L2_xr54
L2_xf54:
    s_waitcnt lgkmcnt(0)
    s_cmp_gt_u32 s37, 1024
    s_cbranch_scc1 L2_xs54
    v_mov_b32 v43, -1
    s_cmp_ge_u32 s37, 512
    s_cbranch_scc1 L2_xg54
    v_mov_b32 v42, -1
    s_cmp_ge_u32 s37, 256
    s_cbranch_scc1 L2_xg54
    v_mov_b32 v41, -1
    s_branch L2_xg54
L2_xs54:
    s_waitcnt lgkmcnt(0)
    v_mov_b32 v40, -1
    v_mov_b32 v41, -1
    v_mov_b32 v42, -1
    v_mov_b32 v43, -1
    s_add_u32 s3, s42, 2
    s_bitset1_b32 s36, s3
    s_branch L2_xg54
L2_c55:
    s_mov_b64 s[50:51], vcc
    s_lshl_b64 s[52:53], s[82:83], 1
    s_andn2_b64 s[52:53], s[52:53], s[80:81]
    s_andn2_b64 s[52:53], s[52:53], s[50:51]
    s_or_b64 s[80:81], s[80:81], s[52:53]
    s_not_b64 vcc, s[52:53]
    s_mov_b64 exec, -1
    v_cndmask_b32_dpp v84, v84, v84, vcc wave_shr:1 row_mask:0xf bank_mask:0xf
    v_cndmask_b32_dpp v85, v85, v85, vcc wave_shr:1 row_mask:0xf bank_mask:0xf
    s_lshr_b64 s[52:53], s[52:53], 1
    v_cndmask_b32_dpp v86, v86, v86, vcc wave_shr:1 row_mask:0xf bank_mask:0xf
    v_cndmask_b32_dpp v87, v87, v87, vcc wave_shr:1 row_mask:0xf bank_mask:0xf
    s_andn2_b64 s[82:83], s[82:83], s[52:53]
    v_cndmask_b32_dpp v7, v7, v7, vcc wave_shr:1 row_mask:0xf bank_mask:0xf
    s_mov_b64 vcc, s[50:51]
    s_mov_b64 exec, s[50:51]
    s_cbranch_scc0 L2_d55
    s_mov_b64 exec, s[82:83]
    s_nop 1
    v_mfma_f32_4x4x4_16b_bf16 v[88:91], v[12:13], v[84:85], 0
    s_nop 1
    v_mfma_f32_4x4x4_16b_bf16 v[88:91], v[10:11], v[86:87], v[88:91]
    s_nop 4
    v_cvt_pk_bf16_f32 v88, v88, v89
    v_cvt_pk_bf16_f32 v89, v90, v91
    ds_pk_add_bf16 v7, v88 offset:65408
    ds_pk_add_bf16 v7, v89 offset:65412
    s_mov_b64 exec, vcc
    s_branch L2_d55
L2_c56:
    s_mov_b64 s[50:51], vcc
    s_lshl_b64 s[52:53], s[82:83], 1
    s_andn2_b64 s[52:53], s[52:53], s[80:81]
    s_andn2_b64 s[52:53], s[52:53], s[50:51]
    s_or_b64 s[80:81], s[80:81], s[52:53]
    s_not_b64 vcc, s[52:53]
    s_mov_b64 exec, -1
    v_cndmask_b32_dpp v84, v84, v84, vcc wave_shr:1 row_mask:0xf bank_mask:0xf
    v_cndmask_b32_dpp v85, v85, v85, vcc wave_shr:1 row_mask:0xf bank_mask:0xf
    s_lshr_b64 s[52:53], s[52:53], 1
    v_cndmask_b32_dpp v86, v86, v86, vcc wave_shr:1 row_mask:0xf bank_mask:0xf
    v_cndmask_b32_dpp v87, v87, v87, vcc wave_shr:1 row_mask:0xf bank_mask:0xf
    s_andn2_b64 s[82:83], s[82:83], s[52:53]
    v_cndmask_b32_dpp v7, v7, v7, vcc wave_shr:1 row_mask:0xf bank_mask:0xf
    s_mov_b64 vcc, s[50:51]
    s_mov_b64 exec, s[50:51]
    s_cbranch_scc0 L2_d56
    s_mov_b64 exec, s[82:83]
    s_nop 1
    v_mfma_f32_4x4x4_16b_bf16 v[88:91], v[12:13], v[84:85], 0
    s_nop 1
    v_mfma_f32_4x4x4_16b_bf16 v[88:91], v[10:11], v[86:87], v[88:91]
    s_nop 4
    v_cvt_pk_bf16_f32 v88, v88, v89
    v_cvt_pk_bf16_f32 v89, v90, v91
    ds_pk_add_bf16 v7, v88 offset:65408
    ds_pk_add_bf16 v7, v89 offset:65412
    s_mov_b64 exec, vcc
    s_branch L2_d56
L2_c57:
    s_mov_b64 s[50:51], vcc
    s_lshl_b64 s[52:53], s[82:83], 1
    s_andn2_b64 s[52:53], s[52:53], s[80:81]
    s_andn2_b64 s[52:53], s[52:53], s[50:51]
    s_or_b64 s[80:81], s[80:81], s[52:53]
    s_not_b64 vcc, s[52:53]
    s_mov_b64 exec, -1
    v_cndmask_b32_dpp v84, v84, v84, vcc wave_shr:1 row_mask:0xf bank_mask:0xf
    v_cndmask_b32_dpp v85, v85, v85, vcc wave_shr:1 row_mask:0xf bank_mask:0xf
    s_lshr_b64 s[52:53], s[52:53], 1
    v_cndmask_b32_dpp v86, v86, v86, vcc wave_shr:1 row_mask:0xf bank_mask:0xf
    v_cndmask_b32_dpp v87, v87, v87, vcc wave_shr:1 row_mask:0xf bank_mask:0xf
    s_andn2_b64 s[82:83], s[82:83], s[52:53]
    v_cndmask_b32_dpp v7, v7, v7, vcc wave_shr:1 row_mask:0xf bank_mask:0xf
    s_mov_b64 vcc, s[50:51]
    s_mov_b64 exec, s[50:51]
    s_cbranch_scc0 L2_d57
    s_mov_b64 exec, s[82:83]
    s_nop 1
    v_mfma_f32_4x4x4_16b_bf16 v[88:91], v[12:13], v[84:85], 0
    s_nop 1
    v_mfma_f32_4x4x4_16b_bf16 v[88:91], v[10:11], v[86:87], v[88:91]
    s_nop 4
    v_cvt_pk_bf16_f32 v88, v88, v89
    v_cvt_pk_bf16_f32 v89, v90, v91
    ds_pk_add_bf16 v7, v88 offset:65408
    ds_pk_add_bf16 v7, v89 offset:65412
    s_mov_b64 exec, vcc
    s_branch L2_d57
L2_c58:
    s_mov_b64 s[50:51], vcc
    s_lshl_b64 s[52:53], s[82:83], 1
    s_andn2_b64 s[52:53], s[52:53], s[80:81]
    s_andn2_b64 s[52:53], s[52:53], s[50:51]
    s_or_b64 s[80:81], s[80:81], s[52:53]
    s_not_b64 vcc, s[52:53]
    s_mov_b64 exec, -1
    v_cndmask_b32_dpp v84, v84, v84, vcc wave_shr:1 row_mask:0xf bank_mask:0xf
    v_cndmask_b32_dpp v85, v85, v85, vcc wave_shr:1 row_mask:0xf bank_mask:0xf
    s_lshr_b64 s[52:53], s[52:53], 1
    v_cndmask_b32_dpp v86, v86, v86, vcc wave_shr:1 row_mask:0xf bank_mask:0xf
    v_cndmask_b32_dpp v87, v87, v87, vcc wave_shr:1 row_mask:0xf bank_mask:0xf
    s_andn2_b64 s[82:83], s[82:83], s[52:53]
    v_cndmask_b32_dpp v7, v7, v7, vcc wave_shr:1 row_mask:0xf bank_mask:0xf
    s_mov_b64 vcc, s[50:51]
    s_mov_b64 exec, s[50:51]
    s_cbranch_scc0 L2_d58
    s_mov_b64 exec, s[82:83]
    s_nop 1
    v_mfma_f32_4x4x4_16b_bf16 v[88:91], v[12:13], v[84:85], 0
    s_nop 1
    v_mfma_f32_4x4x4_16b_bf16 v[88:91], v[10:11], v[86:87], v[88:91]
    s_nop 4
    v_cvt_pk_bf16_f32 v88, v88, v89
    v_cvt_pk_bf16_f32 v89, v90, v91
    ds_pk_add_bf16 v7, v88 offset:65408
    ds_pk_add_bf16 v7, v89 offset:65412
    s_mov_b64 exec, vcc
    s_branch L2_d58
L2_c59:
    s_mov_b64 s[50:51], vcc
    s_lshl_b64 s[52:53], s[82:83], 1
    s_andn2_b64 s[52:53], s[52:53], s[80:81]
    s_andn2_b64 s[52:53], s[52:53], s[50:51]
    s_or_b64 s[80:81], s[80:81], s[52:53]
    s_not_b64 vcc, s[52:53]
    s_mov_b64 exec, -1
    v_cndmask_b32_dpp v84, v84, v84, vcc wave_shr:1 row_mask:0xf bank_mask:0xf
    v_cndmask_b32_dpp v85, v85, v85, vcc wave_shr:1 row_mask:0xf bank_mask:0xf
    s_lshr_b64 s[52:53], s[52:53], 1
    v_cndmask_b32_dpp v86, v86, v86, vcc wave_shr:1 row_mask:0xf bank_mask:0xf
    v_cndmask_b32_dpp v87, v87, v87, vcc wave_shr:1 row_mask:0xf bank_mask:0xf
    s_andn2_b64 s[82:83], s[82:83], s[52:53]
    v_cndmask_b32_dpp v7, v7, v7, vcc wave_shr:1 row_mask:0xf bank_mask:0xf
    s_mov_b64 vcc, s[50:51]
    s_mov_b64 exec, s[50:51]
    s_cbranch_scc0 L2_d59
    s_mov_b64 exec, s[82:83]
    s_nop 1
    v_mfma_f32_4x4x4_16b_bf16 v[88:91], v[12:13], v[84:85], 0
    s_nop 1
    v_mfma_f32_4x4x4_16b_bf16 v[88:91], v[10:11], v[86:87], v[88:91]
    s_nop 4
    v_cvt_pk_bf16_f32 v88, v88, v89
    v_cvt_pk_bf16_f32 v89, v90, v91
    ds_pk_add_bf16 v7, v88 offset:65408
    ds_pk_add_bf16 v7, v89 offset:65412
    s_mov_b64 exec, vcc
    s_branch L2_d59
L2_c60:
    s_mov_b64 s[50:51], vcc
    s_lshl_b64 s[52:53], s[82:83], 1
    s_andn2_b64 s[52:53], s[52:53], s[80:81]
    s_andn2_b64 s[52:53], s[52:53], s[50:51]
    s_or_b64 s[80:81], s[80:81], s[52:53]
    s_not_b64 vcc, s[52:53]
    s_mov_b64 exec, -1
    v_cndmask_b32_dpp v84, v84, v84, vcc wave_shr:1 row_mask:0xf bank_mask:0xf
    v_cndmask_b32_dpp v85, v85, v85, vcc wave_shr:1 row_mask:0xf bank_mask:0xf
    s_lshr_b64 s[52:53], s[52:53], 1
    v_cndmask_b32_dpp v86, v86, v86, vcc wave_shr:1 row_mask:0xf bank_mask:0xf
    v_cndmask_b32_dpp v87, v87, v87, vcc wave_shr:1 row_mask:0xf bank_mask:0xf
    s_andn2_b64 s[82:83], s[82:83], s[52:53]
    v_cndmask_b32_dpp v7, v7, v7, vcc wave_shr:1 row_mask:0xf bank_mask:0xf
    s_mov_b64 vcc, s[50:51]
    s_mov_b64 exec, s[50:51]
    s_cbranch_scc0 L2_d60
    s_mov_b64 exec, s[82:83]
    s_nop 1
    v_mfma_f32_4x4x4_16b_bf16 v[88:91], v[12:13], v[84:85], 0
    s_nop 1
    v_mfma_f32_4x4x4_16b_bf16 v[88:91], v[10:11], v[86:87], v[88:91]
    s_nop 4
    v_cvt_pk_bf16_f32 v88, v88, v89
    v_cvt_pk_bf16_f32 v89, v90, v91
    ds_pk_add_bf16 v7, v88 offset:65408
    ds_pk_add_bf16 v7, v89 offset:65412
    s_mov_b64 exec, vcc
    s_branch L2_d60
L2_c61:
    s_mov_b64 s[50:51], vcc
    s_lshl_b64 s[52:53], s[82:83], 1
    s_andn2_b64 s[52:53], s[52:53], s[80:81]
    s_andn2_b64 s[52:53], s[52:53], s[50:51]
    s_or_b64 s[80:81], s[80:81], s[52:53]
    s_not_b64 vcc, s[52:53]
    s_mov_b64 exec, -1
    v_cndmask_b32_dpp v84, v84, v84, vcc wave_shr:1 row_mask:0xf bank_mask:0xf
    v_cndmask_b32_dpp v85, v85, v85, vcc wave_shr:1 row_mask:0xf bank_mask:0xf
    s_lshr_b64 s[52:53], s[52:53], 1
    v_cndmask_b32_dpp v86, v86, v86, vcc wave_shr:1 row_mask:0xf bank_mask:0xf
    v_cndmask_b32_dpp v87, v87, v87, vcc wave_shr:1 row_mask:0xf bank_mask:0xf
    s_andn2_b64 s[82:83], s[82:83], s[52:53]
    v_cndmask_b32_dpp v7, v7, v7, vcc wave_shr:1 row_mask:0xf bank_mask:0xf
    s_mov_b64 vcc, s[50:51]
    s_mov_b64 exec, s[50:51]
    s_cbranch_scc0 L2_d61
    s_mov_b64 exec, s[82:83]
    s_nop 1
    v_mfma_f32_4x4x4_16b_bf16 v[88:91], v[12:13], v[84:85], 0
    s_nop 1
    v_mfma_f32_4x4x4_16b_bf16 v[88:91], v[10:11], v[86:87], v[88:91]
    s_nop 4
    v_cvt_pk_bf16_f32 v88, v88, v89
    v_cvt_pk_bf16_f32 v89, v90, v91
    ds_pk_add_bf16 v7, v88 offset:65408
    ds_pk_add_bf16 v7, v89 offset:65412
    s_mov_b64 exec, vcc
    s_branch L2_d61
L2_c62:
    s_mov_b64 s[50:51], vcc
    s_lshl_b64 s[52:53], s[82:83], 1
    s_andn2_b64 s[52:53], s[52:53], s[80:81]
    s_andn2_b64 s[52:53], s[52:53], s[50:51]
    s_or_b64 s[80:81], s[80:81], s[52:53]
    s_not_b64 vcc, s[52:53]
    s_mov_b64 exec, -1
    v_cndmask_b32_dpp v84, v84, v84, vcc wave_shr:1 row_mask:0xf bank_mask:0xf
    v_cndmask_b32_dpp v85, v85, v85, vcc wave_shr:1 row_mask:0xf bank_mask:0xf
    s_lshr_b64 s[52:53], s[52:53], 1
    v_cndmask_b32_dpp v86, v86, v86, vcc wave_shr:1 row_mask:0xf bank_mask:0xf
    v_cndmask_b32_dpp v87, v87, v87, vcc wave_shr:1 row_mask:0xf bank_mask:0xf
    s_andn2_b64 s[82:83], s[82:83], s[52:53]
    v_cndmask_b32_dpp v7, v7, v7, vcc wave_shr:1 row_mask:0xf bank_mask:0xf
    s_mov_b64 vcc, s[50:51]
    s_mov_b64 exec, s[50:51]
    s_cbranch_scc0 L2_d62
    s_mov_b64 exec, s[82:83]
    s_nop 1
    v_mfma_f32_4x4x4_16b_bf16 v[88:91], v[12:13], v[84:85], 0
    s_nop 1
    v_mfma_f32_4x4x4_16b_bf16 v[88:91], v[10:11], v[86:87], v[88:91]
    s_nop 4
    v_cvt_pk_bf16_f32 v88, v88, v89
    v_cvt_pk_bf16_f32 v89, v90, v91
    ds_pk_add_bf16 v7, v88 offset:65408
    ds_pk_add_bf16 v7, v89 offset:65412
    s_mov_b64 exec, vcc
    s_branch L2_d62
L2_xo63:
    v_cmp_lt_u32 vcc, 20, v99
    s_mov_b32 s43, 1
    s_cbranch_vccz L2_xp63
    v_cmp_lt_u32 vcc, 32, v99
    v_cmp_lt_u32 s[58:59], 31, v88
    s_mov_b32 s43, 2
    s_or_b64 vcc, vcc, s[58:59]
    s_cbranch_scc0 L2_xp63
    s_mov_b32 s37, 0x10000
    s_branch L2_xp63
L2_c64:
    s_mov_b64 s[50:51], vcc
    s_lshl_b64 s[52:53], s[82:83], 1
    s_andn2_b64 s[52:53], s[52:53], s[80:81]
    s_andn2_b64 s[52:53], s[52:53], s[50:51]
    s_or_b64 s[80:81], s[80:81], s[52:53]
    s_not_b64 vcc, s[52:53]
    s_mov_b64 exec, -1
    v_cndmask_b32_dpp v84, v84, v84, vcc wave_shr:1 row_mask:0xf bank_mask:0xf
    v_cndmask_b32_dpp v85, v85, v85, vcc wave_shr:1 row_mask:0xf bank_mask:0xf
    s_lshr_b64 s[52:53], s[52:53], 1
    v_cndmask_b32_dpp v86, v86, v86, vcc wave_shr:1 row_mask:0xf bank_mask:0xf
    v_cndmask_b32_dpp v87, v87, v87, vcc wave_shr:1 row_mask:0xf bank_mask:0xf
    s_andn2_b64 s[82:83], s[82:83], s[52:53]
    v_cndmask_b32_dpp v7, v7, v7, vcc wave_shr:1 row_mask:0xf bank_mask:0xf
    s_mov_b64 vcc, s[50:51]
    s_mov_b64 exec, s[50:51]
    s_cbranch_scc0 L2_d64
    s_mov_b64 exec, s[82:83]
    s_nop 1
    v_mfma_f32_4x4x4_16b_bf16 v[88:91], v[12:13], v[84:85], 0
    s_nop 1
    v_mfma_f32_4x4x4_16b_bf16 v[88:91], v[10:11], v[86:87], v[88:91]
    s_nop 4
    v_cvt_pk_bf16_f32 v88, v88, v89
    v_cvt_pk_bf16_f32 v89, v90, v91
    ds_pk_add_bf16 v7, v88 offset:65408
    ds_pk_add_bf16 v7, v89 offset:65412
    s_mov_b64 exec, vcc
    s_branch L2_d64
L2_c65:
    s_mov_b64 s[50:51], vcc
    s_lshl_b64 s[52:53], s[82:83], 1
    s_andn2_b64 s[52:53], s[52:53], s[80:81]
    s_andn2_b64 s[52:53], s[52:53], s[50:51]
    s_or_b64 s[80:81], s[80:81], s[52:53]
    s_not_b64 vcc, s[52:53]
    s_mov_b64 exec, -1
    v_cndmask_b32_dpp v84, v84, v84, vcc wave_shr:1 row_mask:0xf bank_mask:0xf
    v_cndmask_b32_dpp v85, v85, v85, vcc wave_shr:1 row_mask:0xf bank_mask:0xf
    s_lshr_b64 s[52:53], s[52:53], 1
    v_cndmask_b32_dpp v86, v86, v86, vcc wave_shr:1 row_mask:0xf bank_mask:0xf
    v_cndmask_b32_dpp v87, v87, v87, vcc wave_shr:1 row_mask:0xf bank_mask:0xf
    s_andn2_b64 s[82:83], s[82:83], s[52:53]
    v_cndmask_b32_dpp v7, v7, v7, vcc wave_shr:1 row_mask:0xf bank_mask:0xf
    s_mov_b64 vcc, s[50:51]
    s_mov_b64 exec, s[50:51]
    s_cbranch_scc0 L2_d65
    s_mov_b64 exec, s[82:83]
    s_nop 1
    v_mfma_f32_4x4x4_16b_bf16 v[88:91], v[12:13], v[84:85], 0
    s_nop 1
    v_mfma_f32_4x4x4_16b_bf16 v[88:91], v[10:11], v[86:87], v[88:91]
    s_nop 4
    v_cvt_pk_bf16_f32 v88, v88, v89
    v_cvt_pk_bf16_f32 v89, v90, v91
    ds_pk_add_bf16 v7, v88 offset:65408
    ds_pk_add_bf16 v7, v89 offset:65412
    s_mov_b64 exec, vcc
    s_branch L2_d65
L2_c66:
    s_mov_b64 s[50:51], vcc
    s_lshl_b64 s[52:53], s[82:83], 1
    s_andn2_b64 s[52:53], s[52:53], s[80:81]
    s_andn2_b64 s[52:53], s[52:53], s[50:51]
    s_or_b64 s[80:81], s[80:81], s[52:53]
    s_not_b64 vcc, s[52:53]
    s_mov_b64 exec, -1
    v_cndmask_b32_dpp v84, v84, v84, vcc wave_shr:1 row_mask:0xf bank_mask:0xf
    v_cndmask_b32_dpp v85, v85, v85, vcc wave_shr:1 row_mask:0xf bank_mask:0xf
    s_lshr_b64 s[52:53], s[52:53], 1
    v_cndmask_b32_dpp v86, v86, v86, vcc wave_shr:1 row_mask:0xf bank_mask:0xf
    v_cndmask_b32_dpp v87, v87, v87, vcc wave_shr:1 row_mask:0xf bank_mask:0xf
    s_andn2_b64 s[82:83], s[82:83], s[52:53]
    v_cndmask_b32_dpp v7, v7, v7, vcc wave_shr:1 row_mask:0xf bank_mask:0xf
    s_mov_b64 vcc, s[50:51]
    s_mov_b64 exec, s[50:51]
    s_cbranch_scc0 L2_d66
    s_mov_b64 exec, s[82:83]
    s_nop 1
    v_mfma_f32_4x4x4_16b_bf16 v[88:91], v[12:13], v[84:85], 0
    s_nop 1
    v_mfma_f32_4x4x4_16b_bf16 v[88:91], v[10:11], v[86:87], v[88:91]
    s_nop 4
    v_cvt_pk_bf16_f32 v88, v88, v89
    v_cvt_pk_bf16_f32 v89, v90, v91
    ds_pk_add_bf16 v7, v88 offset:65408
    ds_pk_add_bf16 v7, v89 offset:65412
    s_mov_b64 exec, vcc
    s_branch L2_d66
L2_c67:
    s_mov_b64 s[50:51], vcc
    s_lshl_b64 s[52:53], s[82:83], 1
    s_andn2_b64 s[52:53], s[52:53], s[80:81]
    s_andn2_b64 s[52:53], s[52:53], s[50:51]
    s_or_b64 s[80:81], s[80:81], s[52:53]
    s_not_b64 vcc, s[52:53]
    s_mov_b64 exec, -1
    v_cndmask_b32_dpp v84, v84, v84, vcc wave_shr:1 row_mask:0xf bank_mask:0xf
    v_cndmask_b32_dpp v85, v85, v85, vcc wave_shr:1 row_mask:0xf bank_mask:0xf
    s_lshr_b64 s[52:53], s[52:53], 1
    v_cndmask_b32_dpp v86, v86, v86, vcc wave_shr:1 row_mask:0xf bank_mask:0xf
    v_cndmask_b32_dpp v87, v87, v87, vcc wave_shr:1 row_mask:0xf bank_mask:0xf
    s_andn2_b64 s[82:83], s[82:83], s[52:53]
    v_cndmask_b32_dpp v7, v7, v7, vcc wave_shr:1 row_mask:0xf bank_mask:0xf
    s_mov_b64 vcc, s[50:51]
    s_mov_b64 exec, s[50:51]
    s_cbranch_scc0 L2_d67
    s_mov_b64 exec, s[82:83]
    s_nop 1
    v_mfma_f32_4x4x4_16b_bf16 v[88:91], v[12:13], v[84:85], 0
    s_nop 1
    v_mfma_f32_4x4x4_16b_bf16 v[88:91], v[10:11], v[86:87], v[88:91]
    s_nop 4
    v_cvt_pk_bf16_f32 v88, v88, v89
    v_cvt_pk_bf16_f32 v89, v90, v91
    ds_pk_add_bf16 v7, v88 offset:65408
    ds_pk_add_bf16 v7, v89 offset:65412
    s_mov_b64 exec, vcc
    s_branch L2_d67
L2_c68:
    s_mov_b64 s[50:51], vcc
    s_lshl_b64 s[52:53], s[82:83], 1
    s_andn2_b64 s[52:53], s[52:53], s[80:81]
    s_andn2_b64 s[52:53], s[52:53], s[50:51]
    s_or_b64 s[80:81], s[80:81], s[52:53]
    s_not_b64 vcc, s[52:53]
    s_mov_b64 exec, -1
    v_cndmask_b32_dpp v84, v84, v84, vcc wave_shr:1 row_mask:0xf bank_mask:0xf
    v_cndmask_b32_dpp v85, v85, v85, vcc wave_shr:1 row_mask:0xf bank_mask:0xf
    s_lshr_b64 s[52:53], s[52:53], 1
    v_cndmask_b32_dpp v86, v86, v86, vcc wave_shr:1 row_mask:0xf bank_mask:0xf
    v_cndmask_b32_dpp v87, v87, v87, vcc wave_shr:1 row_mask:0xf bank_mask:0xf
    s_andn2_b64 s[82:83], s[82:83], s[52:53]
    v_cndmask_b32_dpp v7, v7, v7, vcc wave_shr:1 row_mask:0xf bank_mask:0xf
    s_mov_b64 vcc, s[50:51]
    s_mov_b64 exec, s[50:51]
    s_cbranch_scc0 L2_d68
    s_mov_b64 exec, s[82:83]
    s_nop 1
    v_mfma_f32_4x4x4_16b_bf16 v[88:91], v[12:13], v[84:85], 0
    s_nop 1
    v_mfma_f32_4x4x4_16b_bf16 v[88:91], v[10:11], v[86:87], v[88:91]
    s_nop 4
    v_cvt_pk_bf16_f32 v88, v88, v89
    v_cvt_pk_bf16_f32 v89, v90, v91
    ds_pk_add_bf16 v7, v88 offset:65408
    ds_pk_add_bf16 v7, v89 offset:65412
    s_mov_b64 exec, vcc
    s_branch L2_d68
L2_c69:
    s_mov_b64 s[50:51], vcc
    s_lshl_b64 s[52:53], s[82:83], 1
    s_andn2_b64 s[52:53], s[52:53], s[80:81]
    s_andn2_b64 s[52:53], s[52:53], s[50:51]
    s_or_b64 s[80:81], s[80:81], s[52:53]
    s_not_b64 vcc, s[52:53]
    s_mov_b64 exec, -1
    v_cndmask_b32_dpp v84, v84, v84, vcc wave_shr:1 row_mask:0xf bank_mask:0xf
    v_cndmask_b32_dpp v85, v85, v85, vcc wave_shr:1 row_mask:0xf bank_mask:0xf
    s_lshr_b64 s[52:53], s[52:53], 1
    v_cndmask_b32_dpp v86, v86, v86, vcc wave_shr:1 row_mask:0xf bank_mask:0xf
    v_cndmask_b32_dpp v87, v87, v87, vcc wave_shr:1 row_mask:0xf bank_mask:0xf
    s_andn2_b64 s[82:83], s[82:83], s[52:53]
    v_cndmask_b32_dpp v7, v7, v7, vcc wave_shr:1 row_mask:0xf bank_mask:0xf
    s_mov_b64 vcc, s[50:51]
    s_mov_b64 exec, s[50:51]
    s_cbranch_scc0 L2_d69
    s_mov_b64 exec, s[82:83]
    s_nop 1
    v_mfma_f32_4x4x4_16b_bf16 v[88:91], v[12:13], v[84:85], 0
    s_nop 1
    v_mfma_f32_4x4x4_16b_bf16 v[88:91], v[10:11], v[86:87], v[88:91]
    s_nop 4
    v_cvt_pk_bf16_f32 v88, v88, v89
    v_cvt_pk_bf16_f32 v89, v90, v91
    ds_pk_add_bf16 v7, v88 offset:65408
    ds_pk_add_bf16 v7, v89 offset:65412
    s_mov_b64 exec, vcc
    s_branch L2_d69
L2_c70:
    s_mov_b64 s[50:51], vcc
    s_lshl_b64 s[52:53], s[82:83], 1
    s_andn2_b64 s[52:53], s[52:53], s[80:81]
    s_andn2_b64 s[52:53], s[52:53], s[50:51]
    s_or_b64 s[80:81], s[80:81], s[52:53]
    s_not_b64 vcc, s[52:53]
    s_mov_b64 exec, -1
    v_cndmask_b32_dpp v84, v84, v84, vcc wave_shr:1 row_mask:0xf bank_mask:0xf
    v_cndmask_b32_dpp v85, v85, v85, vcc wave_shr:1 row_mask:0xf bank_mask:0xf
    s_lshr_b64 s[52:53], s[52:53], 1
    v_cndmask_b32_dpp v86, v86, v86, vcc wave_shr:1 row_mask:0xf bank_mask:0xf
    v_cndmask_b32_dpp v87, v87, v87, vcc wave_shr:1 row_mask:0xf bank_mask:0xf
    s_andn2_b64 s[82:83], s[82:83], s[52:53]
    v_cndmask_b32_dpp v7, v7, v7, vcc wave_shr:1 row_mask:0xf bank_mask:0xf
    s_mov_b64 vcc, s[50:51]
    s_mov_b64 exec, s[50:51]
    s_cbranch_scc0 L2_d70
    s_mov_b64 exec, s[82:83]
    s_nop 1
    v_mfma_f32_4x4x4_16b_bf16 v[88:91], v[12:13], v[84:85], 0
    s_nop 1
    v_mfma_f32_4x4x4_16b_bf16 v[88:91], v[10:11], v[86:87], v[88:91]
    s_nop 4
    v_cvt_pk_bf16_f32 v88, v88, v89
    v_cvt_pk_bf16_f32 v89, v90, v91
    ds_pk_add_bf16 v7, v88 offset:65408
    ds_pk_add_bf16 v7, v89 offset:65412
    s_mov_b64 exec, vcc
    s_branch L2_d70
L2_c71:
    s_mov_b64 s[50:51], vcc
    s_lshl_b64 s[52:53], s[82:83], 1
    s_andn2_b64 s[52:53], s[52:53], s[80:81]
    s_andn2_b64 s[52:53], s[52:53], s[50:51]
    s_or_b64 s[80:81], s[80:81], s[52:53]
    s_not_b64 vcc, s[52:53]
    s_mov_b64 exec, -1
    v_cndmask_b32_dpp v84, v84, v84, vcc wave_shr:1 row_mask:0xf bank_mask:0xf
    v_cndmask_b32_dpp v85, v85, v85, vcc wave_shr:1 row_mask:0xf bank_mask:0xf
    s_lshr_b64 s[52:53], s[52:53], 1
    v_cndmask_b32_dpp v86, v86, v86, vcc wave_shr:1 row_mask:0xf bank_mask:0xf
    v_cndmask_b32_dpp v87, v87, v87, vcc wave_shr:1 row_mask:0xf bank_mask:0xf
    s_andn2_b64 s[82:83], s[82:83], s[52:53]
    v_cndmask_b32_dpp v7, v7, v7, vcc wave_shr:1 row_mask:0xf bank_mask:0xf
    s_mov_b64 vcc, s[50:51]
    s_mov_b64 exec, s[50:51]
    s_cbranch_scc0 L2_d71
    s_mov_b64 exec, s[82:83]
    s_nop 1
    v_mfma_f32_4x4x4_16b_bf16 v[88:91], v[12:13], v[84:85], 0
    s_nop 1
    v_mfma_f32_4x4x4_16b_bf16 v[88:91], v[10:11], v[86:87], v[88:91]
    s_nop 4
    v_cvt_pk_bf16_f32 v88, v88, v89
    v_cvt_pk_bf16_f32 v89, v90, v91
    ds_pk_add_bf16 v7, v88 offset:65408
    ds_pk_add_bf16 v7, v89 offset:65412
    s_mov_b64 exec, vcc
    s_branch L2_d71
L2_xa72:
    s_cmp_eq_u32 s43, 1
    s_cbranch_scc1 L2_xc72
    v_lshlrev_b32 v89, 0, v96
    v_add_u32 v90, 140, v97
    v_bitop3_b32 v90, v89, v45, v90 bitop3:0x6a
    ds_write_b32 v98, v90 offset:28
    v_lshlrev_b32 v89, 4, v96
    v_add_u32 v90, 120, v97
    v_bitop3_b32 v90, v89, v45, v90 bitop3:0x6a
    ds_write_b32 v98, v90 offset:24
    v_lshlrev_b32 v89, 8, v96
    v_add_u32 v90, 100, v97
    v_bitop3_b32 v90, v89, v45, v90 bitop3:0x6a
    ds_write_b32 v98, v90 offset:20
L2_xc72:
    v_lshlrev_b32 v89, 12, v96
    v_add_u32 v90, 80, v97
    v_bitop3_b32 v90, v89, v45, v90 bitop3:0x6a
    ds_write_b32 v98, v90 offset:16
    s_branch L2_xb72
L2_xe72:
    v_cmp_lt_u32 vcc, 32, v99
    v_cmp_lt_u32 s[58:59], 31, v88
    v_lshrrev_b32 v89, 16, v96
    v_add_u32 v97, 80, v97
    s_or_b64 vcc, vcc, s[58:59]
    s_cbranch_scc1 L2_xs72
    v_lshlrev_b32 v89, v1, v89
    v_and_b32 v89, v45, v89
    v_cmp_ne_u32 vcc, 0, v89
    v_xor_b32 v90, v97, v89
    s_add_u32 s3, s37, s38
    v_mbcnt_lo_u32_b32 v98, vcc_lo, 0
    v_mbcnt_hi_u32_b32 v98, vcc_hi, v98
    s_bcnt1_i32_b64 s41, vcc
    v_lshl_add_u32 v98, v98, 2, s3
    s_mov_b64 exec, vcc
    ds_write_b32 v98, v90
    s_mov_b64 exec, -1
    s_lshl2_add_u32 s37, s41, s37
    s_branch L2_xr72
L2_xf72:
    s_waitcnt lgkmcnt(0)
    s_cmp_gt_u32 s37, 1024
    s_cbranch_scc1 L2_xs72
    v_mov_b32 v43, -1
    s_cmp_ge_u32 s37, 512
    s_cbranch_scc1 L2_xg72
    v_mov_b32 v42, -1
    s_cmp_ge_u32 s37, 256
    s_cbranch_scc1 L2_xg72
    v_mov_b32 v41, -1
    s_branch L2_xg72
L2_xs72:
    s_waitcnt lgkmcnt(0)
    v_mov_b32 v40, -1
    v_mov_b32 v41, -1
    v_mov_b32 v42, -1
    v_mov_b32 v43, -1
    s_add_u32 s3, s42, 2
    s_bitset1_b32 s36, s3
    s_branch L2_xg72
L2_c73:
    s_mov_b64 s[50:51], vcc
    s_lshl_b64 s[52:53], s[82:83], 1
    s_andn2_b64 s[52:53], s[52:53], s[80:81]
    s_andn2_b64 s[52:53], s[52:53], s[50:51]
    s_or_b64 s[80:81], s[80:81], s[52:53]
    s_not_b64 vcc, s[52:53]
    s_mov_b64 exec, -1
    v_cndmask_b32_dpp v84, v84, v84, vcc wave_shr:1 row_mask:0xf bank_mask:0xf
    v_cndmask_b32_dpp v85, v85, v85, vcc wave_shr:1 row_mask:0xf bank_mask:0xf
    s_lshr_b64 s[52:53], s[52:53], 1
    v_cndmask_b32_dpp v86, v86, v86, vcc wave_shr:1 row_mask:0xf bank_mask:0xf
    v_cndmask_b32_dpp v87, v87, v87, vcc wave_shr:1 row_mask:0xf bank_mask:0xf
    s_andn2_b64 s[82:83], s[82:83], s[52:53]
    v_cndmask_b32_dpp v7, v7, v7, vcc wave_shr:1 row_mask:0xf bank_mask:0xf
    s_mov_b64 vcc, s[50:51]
    s_mov_b64 exec, s[50:51]
    s_cbranch_scc0 L2_d73
    s_mov_b64 exec, s[82:83]
    s_nop 1
    v_mfma_f32_4x4x4_16b_bf16 v[88:91], v[12:13], v[84:85], 0
    s_nop 1
    v_mfma_f32_4x4x4_16b_bf16 v[88:91], v[10:11], v[86:87], v[88:91]
    s_nop 4
    v_cvt_pk_bf16_f32 v88, v88, v89
    v_cvt_pk_bf16_f32 v89, v90, v91
    ds_pk_add_bf16 v7, v88 offset:65408
    ds_pk_add_bf16 v7, v89 offset:65412
    s_mov_b64 exec, vcc
    s_branch L2_d73
L2_c74:
    s_mov_b64 s[50:51], vcc
    s_lshl_b64 s[52:53], s[82:83], 1
    s_andn2_b64 s[52:53], s[52:53], s[80:81]
    s_andn2_b64 s[52:53], s[52:53], s[50:51]
    s_or_b64 s[80:81], s[80:81], s[52:53]
    s_not_b64 vcc, s[52:53]
    s_mov_b64 exec, -1
    v_cndmask_b32_dpp v84, v84, v84, vcc wave_shr:1 row_mask:0xf bank_mask:0xf
    v_cndmask_b32_dpp v85, v85, v85, vcc wave_shr:1 row_mask:0xf bank_mask:0xf
    s_lshr_b64 s[52:53], s[52:53], 1
    v_cndmask_b32_dpp v86, v86, v86, vcc wave_shr:1 row_mask:0xf bank_mask:0xf
    v_cndmask_b32_dpp v87, v87, v87, vcc wave_shr:1 row_mask:0xf bank_mask:0xf
    s_andn2_b64 s[82:83], s[82:83], s[52:53]
    v_cndmask_b32_dpp v7, v7, v7, vcc wave_shr:1 row_mask:0xf bank_mask:0xf
    s_mov_b64 vcc, s[50:51]
    s_mov_b64 exec, s[50:51]
    s_cbranch_scc0 L2_d74
    s_mov_b64 exec, s[82:83]
    s_nop 1
    v_mfma_f32_4x4x4_16b_bf16 v[88:91], v[12:13], v[84:85], 0
    s_nop 1
    v_mfma_f32_4x4x4_16b_bf16 v[88:91], v[10:11], v[86:87], v[88:91]
    s_nop 4
    v_cvt_pk_bf16_f32 v88, v88, v89
    v_cvt_pk_bf16_f32 v89, v90, v91
    ds_pk_add_bf16 v7, v88 offset:65408
    ds_pk_add_bf16 v7, v89 offset:65412
    s_mov_b64 exec, vcc
    s_branch L2_d74
L2_c75:
    s_mov_b64 s[50:51], vcc
    s_lshl_b64 s[52:53], s[82:83], 1
    s_andn2_b64 s[52:53], s[52:53], s[80:81]
    s_andn2_b64 s[52:53], s[52:53], s[50:51]
    s_or_b64 s[80:81], s[80:81], s[52:53]
    s_not_b64 vcc, s[52:53]
    s_mov_b64 exec, -1
    v_cndmask_b32_dpp v84, v84, v84, vcc wave_shr:1 row_mask:0xf bank_mask:0xf
    v_cndmask_b32_dpp v85, v85, v85, vcc wave_shr:1 row_mask:0xf bank_mask:0xf
    s_lshr_b64 s[52:53], s[52:53], 1
    v_cndmask_b32_dpp v86, v86, v86, vcc wave_shr:1 row_mask:0xf bank_mask:0xf
    v_cndmask_b32_dpp v87, v87, v87, vcc wave_shr:1 row_mask:0xf bank_mask:0xf
    s_andn2_b64 s[82:83], s[82:83], s[52:53]
    v_cndmask_b32_dpp v7, v7, v7, vcc wave_shr:1 row_mask:0xf bank_mask:0xf
    s_mov_b64 vcc, s[50:51]
    s_mov_b64 exec, s[50:51]
    s_cbranch_scc0 L2_d75
    s_mov_b64 exec, s[82:83]
    s_nop 1
    v_mfma_f32_4x4x4_16b_bf16 v[88:91], v[12:13], v[84:85], 0
    s_nop 1
    v_mfma_f32_4x4x4_16b_bf16 v[88:91], v[10:11], v[86:87], v[88:91]
    s_nop 4
    v_cvt_pk_bf16_f32 v88, v88, v89
    v_cvt_pk_bf16_f32 v89, v90, v91
    ds_pk_add_bf16 v7, v88 offset:65408
    ds_pk_add_bf16 v7, v89 offset:65412
    s_mov_b64 exec, vcc
    s_branch L2_d75
L2_c76:
    s_mov_b64 s[50:51], vcc
    s_lshl_b64 s[52:53], s[82:83], 1
    s_andn2_b64 s[52:53], s[52:53], s[80:81]
    s_andn2_b64 s[52:53], s[52:53], s[50:51]
    s_or_b64 s[80:81], s[80:81], s[52:53]
    s_not_b64 vcc, s[52:53]
    s_mov_b64 exec, -1
    v_cndmask_b32_dpp v84, v84, v84, vcc wave_shr:1 row_mask:0xf bank_mask:0xf
    v_cndmask_b32_dpp v85, v85, v85, vcc wave_shr:1 row_mask:0xf bank_mask:0xf
    s_lshr_b64 s[52:53], s[52:53], 1
    v_cndmask_b32_dpp v86, v86, v86, vcc wave_shr:1 row_mask:0xf bank_mask:0xf
    v_cndmask_b32_dpp v87, v87, v87, vcc wave_shr:1 row_mask:0xf bank_mask:0xf
    s_andn2_b64 s[82:83], s[82:83], s[52:53]
    v_cndmask_b32_dpp v7, v7, v7, vcc wave_shr:1 row_mask:0xf bank_mask:0xf
    s_mov_b64 vcc, s[50:51]
    s_mov_b64 exec, s[50:51]
    s_cbranch_scc0 L2_d76
    s_mov_b64 exec, s[82:83]
    s_nop 1
    v_mfma_f32_4x4x4_16b_bf16 v[88:91], v[12:13], v[84:85], 0
    s_nop 1
    v_mfma_f32_4x4x4_16b_bf16 v[88:91], v[10:11], v[86:87], v[88:91]
    s_nop 4
    v_cvt_pk_bf16_f32 v88, v88, v89
    v_cvt_pk_bf16_f32 v89, v90, v91
    ds_pk_add_bf16 v7, v88 offset:65408
    ds_pk_add_bf16 v7, v89 offset:65412
    s_mov_b64 exec, vcc
    s_branch L2_d76
L2_c77:
    s_mov_b64 s[50:51], vcc
    s_lshl_b64 s[52:53], s[82:83], 1
    s_andn2_b64 s[52:53], s[52:53], s[80:81]
    s_andn2_b64 s[52:53], s[52:53], s[50:51]
    s_or_b64 s[80:81], s[80:81], s[52:53]
    s_not_b64 vcc, s[52:53]
    s_mov_b64 exec, -1
    v_cndmask_b32_dpp v84, v84, v84, vcc wave_shr:1 row_mask:0xf bank_mask:0xf
    v_cndmask_b32_dpp v85, v85, v85, vcc wave_shr:1 row_mask:0xf bank_mask:0xf
    s_lshr_b64 s[52:53], s[52:53], 1
    v_cndmask_b32_dpp v86, v86, v86, vcc wave_shr:1 row_mask:0xf bank_mask:0xf
    v_cndmask_b32_dpp v87, v87, v87, vcc wave_shr:1 row_mask:0xf bank_mask:0xf
    s_andn2_b64 s[82:83], s[82:83], s[52:53]
    v_cndmask_b32_dpp v7, v7, v7, vcc wave_shr:1 row_mask:0xf bank_mask:0xf
    s_mov_b64 vcc, s[50:51]
    s_mov_b64 exec, s[50:51]
    s_cbranch_scc0 L2_d77
    s_mov_b64 exec, s[82:83]
    s_nop 1
    v_mfma_f32_4x4x4_16b_bf16 v[88:91], v[12:13], v[84:85], 0
    s_nop 1
    v_mfma_f32_4x4x4_16b_bf16 v[88:91], v[10:11], v[86:87], v[88:91]
    s_nop 4
    v_cvt_pk_bf16_f32 v88, v88, v89
    v_cvt_pk_bf16_f32 v89, v90, v91
    ds_pk_add_bf16 v7, v88 offset:65408
    ds_pk_add_bf16 v7, v89 offset:65412
    s_mov_b64 exec, vcc
    s_branch L2_d77
L2_c78:
    s_mov_b64 s[50:51], vcc
    s_lshl_b64 s[52:53], s[82:83], 1
    s_andn2_b64 s[52:53], s[52:53], s[80:81]
    s_andn2_b64 s[52:53], s[52:53], s[50:51]
    s_or_b64 s[80:81], s[80:81], s[52:53]
    s_not_b64 vcc, s[52:53]
    s_mov_b64 exec, -1
    v_cndmask_b32_dpp v84, v84, v84, vcc wave_shr:1 row_mask:0xf bank_mask:0xf
    v_cndmask_b32_dpp v85, v85, v85, vcc wave_shr:1 row_mask:0xf bank_mask:0xf
    s_lshr_b64 s[52:53], s[52:53], 1
    v_cndmask_b32_dpp v86, v86, v86, vcc wave_shr:1 row_mask:0xf bank_mask:0xf
    v_cndmask_b32_dpp v87, v87, v87, vcc wave_shr:1 row_mask:0xf bank_mask:0xf
    s_andn2_b64 s[82:83], s[82:83], s[52:53]
    v_cndmask_b32_dpp v7, v7, v7, vcc wave_shr:1 row_mask:0xf bank_mask:0xf
    s_mov_b64 vcc, s[50:51]
    s_mov_b64 exec, s[50:51]
    s_cbranch_scc0 L2_d78
    s_mov_b64 exec, s[82:83]
    s_nop 1
    v_mfma_f32_4x4x4_16b_bf16 v[88:91], v[12:13], v[84:85], 0
    s_nop 1
    v_mfma_f32_4x4x4_16b_bf16 v[88:91], v[10:11], v[86:87], v[88:91]
    s_nop 4
    v_cvt_pk_bf16_f32 v88, v88, v89
    v_cvt_pk_bf16_f32 v89, v90, v91
    ds_pk_add_bf16 v7, v88 offset:65408
    ds_pk_add_bf16 v7, v89 offset:65412
    s_mov_b64 exec, vcc
    s_branch L2_d78
L2_c79:
    s_mov_b64 s[50:51], vcc
    s_lshl_b64 s[52:53], s[82:83], 1
    s_andn2_b64 s[52:53], s[52:53], s[80:81]
    s_andn2_b64 s[52:53], s[52:53], s[50:51]
    s_or_b64 s[80:81], s[80:81], s[52:53]
    s_not_b64 vcc, s[52:53]
    s_mov_b64 exec, -1
    v_cndmask_b32_dpp v84, v84, v84, vcc wave_shr:1 row_mask:0xf bank_mask:0xf
    v_cndmask_b32_dpp v85, v85, v85, vcc wave_shr:1 row_mask:0xf bank_mask:0xf
    s_lshr_b64 s[52:53], s[52:53], 1
    v_cndmask_b32_dpp v86, v86, v86, vcc wave_shr:1 row_mask:0xf bank_mask:0xf
    v_cndmask_b32_dpp v87, v87, v87, vcc wave_shr:1 row_mask:0xf bank_mask:0xf
    s_andn2_b64 s[82:83], s[82:83], s[52:53]
    v_cndmask_b32_dpp v7, v7, v7, vcc wave_shr:1 row_mask:0xf bank_mask:0xf
    s_mov_b64 vcc, s[50:51]
    s_mov_b64 exec, s[50:51]
    s_cbranch_scc0 L2_d79
    s_mov_b64 exec, s[82:83]
    s_nop 1
    v_mfma_f32_4x4x4_16b_bf16 v[88:91], v[12:13], v[84:85], 0
    s_nop 1
    v_mfma_f32_4x4x4_16b_bf16 v[88:91], v[10:11], v[86:87], v[88:91]
    s_nop 4
    v_cvt_pk_bf16_f32 v88, v88, v89
    v_cvt_pk_bf16_f32 v89, v90, v91
    ds_pk_add_bf16 v7, v88 offset:65408
    ds_pk_add_bf16 v7, v89 offset:65412
    s_mov_b64 exec, vcc
    s_branch L2_d79
L2_c80:
    s_mov_b64 s[50:51], vcc
    s_lshl_b64 s[52:53], s[82:83], 1
    s_andn2_b64 s[52:53], s[52:53], s[80:81]
    s_andn2_b64 s[52:53], s[52:53], s[50:51]
    s_or_b64 s[80:81], s[80:81], s[52:53]
    s_not_b64 vcc, s[52:53]
    s_mov_b64 exec, -1
    v_cndmask_b32_dpp v84, v84, v84, vcc wave_shr:1 row_mask:0xf bank_mask:0xf
    v_cndmask_b32_dpp v85, v85, v85, vcc wave_shr:1 row_mask:0xf bank_mask:0xf
    s_lshr_b64 s[52:53], s[52:53], 1
    v_cndmask_b32_dpp v86, v86, v86, vcc wave_shr:1 row_mask:0xf bank_mask:0xf
    v_cndmask_b32_dpp v87, v87, v87, vcc wave_shr:1 row_mask:0xf bank_mask:0xf
    s_andn2_b64 s[82:83], s[82:83], s[52:53]
    v_cndmask_b32_dpp v7, v7, v7, vcc wave_shr:1 row_mask:0xf bank_mask:0xf
    s_mov_b64 vcc, s[50:51]
    s_mov_b64 exec, s[50:51]
    s_cbranch_scc0 L2_d80
    s_mov_b64 exec, s[82:83]
    s_nop 1
    v_mfma_f32_4x4x4_16b_bf16 v[88:91], v[12:13], v[84:85], 0
    s_nop 1
    v_mfma_f32_4x4x4_16b_bf16 v[88:91], v[10:11], v[86:87], v[88:91]
    s_nop 4
    v_cvt_pk_bf16_f32 v88, v88, v89
    v_cvt_pk_bf16_f32 v89, v90, v91
    ds_pk_add_bf16 v7, v88 offset:65408
    ds_pk_add_bf16 v7, v89 offset:65412
    s_mov_b64 exec, vcc
    s_branch L2_d80
L2_xo81:
    v_cmp_lt_u32 vcc, 20, v99
    s_mov_b32 s43, 1
    s_cbranch_vccz L2_xp81
    v_cmp_lt_u32 vcc, 32, v99
    v_cmp_lt_u32 s[58:59], 31, v88
    s_mov_b32 s43, 2
    s_or_b64 vcc, vcc, s[58:59]
    s_cbranch_scc0 L2_xp81
    s_mov_b32 s37, 0x10000
    s_branch L2_xp81
L2_c82:
    s_mov_b64 s[50:51], vcc
    s_lshl_b64 s[52:53], s[82:83], 1
    s_andn2_b64 s[52:53], s[52:53], s[80:81]
    s_andn2_b64 s[52:53], s[52:53], s[50:51]
    s_or_b64 s[80:81], s[80:81], s[52:53]
    s_not_b64 vcc, s[52:53]
    s_mov_b64 exec, -1
    v_cndmask_b32_dpp v84, v84, v84, vcc wave_shr:1 row_mask:0xf bank_mask:0xf
    v_cndmask_b32_dpp v85, v85, v85, vcc wave_shr:1 row_mask:0xf bank_mask:0xf
    s_lshr_b64 s[52:53], s[52:53], 1
    v_cndmask_b32_dpp v86, v86, v86, vcc wave_shr:1 row_mask:0xf bank_mask:0xf
    v_cndmask_b32_dpp v87, v87, v87, vcc wave_shr:1 row_mask:0xf bank_mask:0xf
    s_andn2_b64 s[82:83], s[82:83], s[52:53]
    v_cndmask_b32_dpp v7, v7, v7, vcc wave_shr:1 row_mask:0xf bank_mask:0xf
    s_mov_b64 vcc, s[50:51]
    s_mov_b64 exec, s[50:51]
    s_cbranch_scc0 L2_d82
    s_mov_b64 exec, s[82:83]
    s_nop 1
    v_mfma_f32_4x4x4_16b_bf16 v[88:91], v[12:13], v[84:85], 0
    s_nop 1
    v_mfma_f32_4x4x4_16b_bf16 v[88:91], v[10:11], v[86:87], v[88:91]
    s_nop 4
    v_cvt_pk_bf16_f32 v88, v88, v89
    v_cvt_pk_bf16_f32 v89, v90, v91
    ds_pk_add_bf16 v7, v88 offset:65408
    ds_pk_add_bf16 v7, v89 offset:65412
    s_mov_b64 exec, vcc
    s_branch L2_d82
L2_c83:
    s_mov_b64 s[50:51], vcc
    s_lshl_b64 s[52:53], s[82:83], 1
    s_andn2_b64 s[52:53], s[52:53], s[80:81]
    s_andn2_b64 s[52:53], s[52:53], s[50:51]
    s_or_b64 s[80:81], s[80:81], s[52:53]
    s_not_b64 vcc, s[52:53]
    s_mov_b64 exec, -1
    v_cndmask_b32_dpp v84, v84, v84, vcc wave_shr:1 row_mask:0xf bank_mask:0xf
    v_cndmask_b32_dpp v85, v85, v85, vcc wave_shr:1 row_mask:0xf bank_mask:0xf
    s_lshr_b64 s[52:53], s[52:53], 1
    v_cndmask_b32_dpp v86, v86, v86, vcc wave_shr:1 row_mask:0xf bank_mask:0xf
    v_cndmask_b32_dpp v87, v87, v87, vcc wave_shr:1 row_mask:0xf bank_mask:0xf
    s_andn2_b64 s[82:83], s[82:83], s[52:53]
    v_cndmask_b32_dpp v7, v7, v7, vcc wave_shr:1 row_mask:0xf bank_mask:0xf
    s_mov_b64 vcc, s[50:51]
    s_mov_b64 exec, s[50:51]
    s_cbranch_scc0 L2_d83
    s_mov_b64 exec, s[82:83]
    s_nop 1
    v_mfma_f32_4x4x4_16b_bf16 v[88:91], v[12:13], v[84:85], 0
    s_nop 1
    v_mfma_f32_4x4x4_16b_bf16 v[88:91], v[10:11], v[86:87], v[88:91]
    s_nop 4
    v_cvt_pk_bf16_f32 v88, v88, v89
    v_cvt_pk_bf16_f32 v89, v90, v91
    ds_pk_add_bf16 v7, v88 offset:65408
    ds_pk_add_bf16 v7, v89 offset:65412
    s_mov_b64 exec, vcc
    s_branch L2_d83
L2_c84:
    s_mov_b64 s[50:51], vcc
    s_lshl_b64 s[52:53], s[82:83], 1
    s_andn2_b64 s[52:53], s[52:53], s[80:81]
    s_andn2_b64 s[52:53], s[52:53], s[50:51]
    s_or_b64 s[80:81], s[80:81], s[52:53]
    s_not_b64 vcc, s[52:53]
    s_mov_b64 exec, -1
    v_cndmask_b32_dpp v84, v84, v84, vcc wave_shr:1 row_mask:0xf bank_mask:0xf
    v_cndmask_b32_dpp v85, v85, v85, vcc wave_shr:1 row_mask:0xf bank_mask:0xf
    s_lshr_b64 s[52:53], s[52:53], 1
    v_cndmask_b32_dpp v86, v86, v86, vcc wave_shr:1 row_mask:0xf bank_mask:0xf
    v_cndmask_b32_dpp v87, v87, v87, vcc wave_shr:1 row_mask:0xf bank_mask:0xf
    s_andn2_b64 s[82:83], s[82:83], s[52:53]
    v_cndmask_b32_dpp v7, v7, v7, vcc wave_shr:1 row_mask:0xf bank_mask:0xf
    s_mov_b64 vcc, s[50:51]
    s_mov_b64 exec, s[50:51]
    s_cbranch_scc0 L2_d84
    s_mov_b64 exec, s[82:83]
    s_nop 1
    v_mfma_f32_4x4x4_16b_bf16 v[88:91], v[12:13], v[84:85], 0
    s_nop 1
    v_mfma_f32_4x4x4_16b_bf16 v[88:91], v[10:11], v[86:87], v[88:91]
    s_nop 4
    v_cvt_pk_bf16_f32 v88, v88, v89
    v_cvt_pk_bf16_f32 v89, v90, v91
    ds_pk_add_bf16 v7, v88 offset:65408
    ds_pk_add_bf16 v7, v89 offset:65412
    s_mov_b64 exec, vcc
    s_branch L2_d84
L2_c85:
    s_mov_b64 s[50:51], vcc
    s_lshl_b64 s[52:53], s[82:83], 1
    s_andn2_b64 s[52:53], s[52:53], s[80:81]
    s_andn2_b64 s[52:53], s[52:53], s[50:51]
    s_or_b64 s[80:81], s[80:81], s[52:53]
    s_not_b64 vcc, s[52:53]
    s_mov_b64 exec, -1
    v_cndmask_b32_dpp v84, v84, v84, vcc wave_shr:1 row_mask:0xf bank_mask:0xf
    v_cndmask_b32_dpp v85, v85, v85, vcc wave_shr:1 row_mask:0xf bank_mask:0xf
    s_lshr_b64 s[52:53], s[52:53], 1
    v_cndmask_b32_dpp v86, v86, v86, vcc wave_shr:1 row_mask:0xf bank_mask:0xf
    v_cndmask_b32_dpp v87, v87, v87, vcc wave_shr:1 row_mask:0xf bank_mask:0xf
    s_andn2_b64 s[82:83], s[82:83], s[52:53]
    v_cndmask_b32_dpp v7, v7, v7, vcc wave_shr:1 row_mask:0xf bank_mask:0xf
    s_mov_b64 vcc, s[50:51]
    s_mov_b64 exec, s[50:51]
    s_cbranch_scc0 L2_d85
    s_mov_b64 exec, s[82:83]
    s_nop 1
    v_mfma_f32_4x4x4_16b_bf16 v[88:91], v[12:13], v[84:85], 0
    s_nop 1
    v_mfma_f32_4x4x4_16b_bf16 v[88:91], v[10:11], v[86:87], v[88:91]
    s_nop 4
    v_cvt_pk_bf16_f32 v88, v88, v89
    v_cvt_pk_bf16_f32 v89, v90, v91
    ds_pk_add_bf16 v7, v88 offset:65408
    ds_pk_add_bf16 v7, v89 offset:65412
    s_mov_b64 exec, vcc
    s_branch L2_d85
L2_c86:
    s_mov_b64 s[50:51], vcc
    s_lshl_b64 s[52:53], s[82:83], 1
    s_andn2_b64 s[52:53], s[52:53], s[80:81]
    s_andn2_b64 s[52:53], s[52:53], s[50:51]
    s_or_b64 s[80:81], s[80:81], s[52:53]
    s_not_b64 vcc, s[52:53]
    s_mov_b64 exec, -1
    v_cndmask_b32_dpp v84, v84, v84, vcc wave_shr:1 row_mask:0xf bank_mask:0xf
    v_cndmask_b32_dpp v85, v85, v85, vcc wave_shr:1 row_mask:0xf bank_mask:0xf
    s_lshr_b64 s[52:53], s[52:53], 1
    v_cndmask_b32_dpp v86, v86, v86, vcc wave_shr:1 row_mask:0xf bank_mask:0xf
    v_cndmask_b32_dpp v87, v87, v87, vcc wave_shr:1 row_mask:0xf bank_mask:0xf
    s_andn2_b64 s[82:83], s[82:83], s[52:53]
    v_cndmask_b32_dpp v7, v7, v7, vcc wave_shr:1 row_mask:0xf bank_mask:0xf
    s_mov_b64 vcc, s[50:51]
    s_mov_b64 exec, s[50:51]
    s_cbranch_scc0 L2_d86
    s_mov_b64 exec, s[82:83]
    s_nop 1
    v_mfma_f32_4x4x4_16b_bf16 v[88:91], v[12:13], v[84:85], 0
    s_nop 1
    v_mfma_f32_4x4x4_16b_bf16 v[88:91], v[10:11], v[86:87], v[88:91]
    s_nop 4
    v_cvt_pk_bf16_f32 v88, v88, v89
    v_cvt_pk_bf16_f32 v89, v90, v91
    ds_pk_add_bf16 v7, v88 offset:65408
    ds_pk_add_bf16 v7, v89 offset:65412
    s_mov_b64 exec, vcc
    s_branch L2_d86
L2_c87:
    s_mov_b64 s[50:51], vcc
    s_lshl_b64 s[52:53], s[82:83], 1
    s_andn2_b64 s[52:53], s[52:53], s[80:81]
    s_andn2_b64 s[52:53], s[52:53], s[50:51]
    s_or_b64 s[80:81], s[80:81], s[52:53]
    s_not_b64 vcc, s[52:53]
    s_mov_b64 exec, -1
    v_cndmask_b32_dpp v84, v84, v84, vcc wave_shr:1 row_mask:0xf bank_mask:0xf
    v_cndmask_b32_dpp v85, v85, v85, vcc wave_shr:1 row_mask:0xf bank_mask:0xf
    s_lshr_b64 s[52:53], s[52:53], 1
    v_cndmask_b32_dpp v86, v86, v86, vcc wave_shr:1 row_mask:0xf bank_mask:0xf
    v_cndmask_b32_dpp v87, v87, v87, vcc wave_shr:1 row_mask:0xf bank_mask:0xf
    s_andn2_b64 s[82:83], s[82:83], s[52:53]
    v_cndmask_b32_dpp v7, v7, v7, vcc wave_shr:1 row_mask:0xf bank_mask:0xf
    s_mov_b64 vcc, s[50:51]
    s_mov_b64 exec, s[50:51]
    s_cbranch_scc0 L2_d87
    s_mov_b64 exec, s[82:83]
    s_nop 1
    v_mfma_f32_4x4x4_16b_bf16 v[88:91], v[12:13], v[84:85], 0
    s_nop 1
    v_mfma_f32_4x4x4_16b_bf16 v[88:91], v[10:11], v[86:87], v[88:91]
    s_nop 4
    v_cvt_pk_bf16_f32 v88, v88, v89
    v_cvt_pk_bf16_f32 v89, v90, v91
    ds_pk_add_bf16 v7, v88 offset:65408
    ds_pk_add_bf16 v7, v89 offset:65412
    s_mov_b64 exec, vcc
    s_branch L2_d87
L2_c88:
    s_mov_b64 s[50:51], vcc
    s_lshl_b64 s[52:53], s[82:83], 1
    s_andn2_b64 s[52:53], s[52:53], s[80:81]
    s_andn2_b64 s[52:53], s[52:53], s[50:51]
    s_or_b64 s[80:81], s[80:81], s[52:53]
    s_not_b64 vcc, s[52:53]
    s_mov_b64 exec, -1
    v_cndmask_b32_dpp v84, v84, v84, vcc wave_shr:1 row_mask:0xf bank_mask:0xf
    v_cndmask_b32_dpp v85, v85, v85, vcc wave_shr:1 row_mask:0xf bank_mask:0xf
    s_lshr_b64 s[52:53], s[52:53], 1
    v_cndmask_b32_dpp v86, v86, v86, vcc wave_shr:1 row_mask:0xf bank_mask:0xf
    v_cndmask_b32_dpp v87, v87, v87, vcc wave_shr:1 row_mask:0xf bank_mask:0xf
    s_andn2_b64 s[82:83], s[82:83], s[52:53]
    v_cndmask_b32_dpp v7, v7, v7, vcc wave_shr:1 row_mask:0xf bank_mask:0xf
    s_mov_b64 vcc, s[50:51]
    s_mov_b64 exec, s[50:51]
    s_cbranch_scc0 L2_d88
    s_mov_b64 exec, s[82:83]
    s_nop 1
    v_mfma_f32_4x4x4_16b_bf16 v[88:91], v[12:13], v[84:85], 0
    s_nop 1
    v_mfma_f32_4x4x4_16b_bf16 v[88:91], v[10:11], v[86:87], v[88:91]
    s_nop 4
    v_cvt_pk_bf16_f32 v88, v88, v89
    v_cvt_pk_bf16_f32 v89, v90, v91
    ds_pk_add_bf16 v7, v88 offset:65408
    ds_pk_add_bf16 v7, v89 offset:65412
    s_mov_b64 exec, vcc
    s_branch L2_d88
L2_c89:
    s_mov_b64 s[50:51], vcc
    s_lshl_b64 s[52:53], s[82:83], 1
    s_andn2_b64 s[52:53], s[52:53], s[80:81]
    s_andn2_b64 s[52:53], s[52:53], s[50:51]
    s_or_b64 s[80:81], s[80:81], s[52:53]
    s_not_b64 vcc, s[52:53]
    s_mov_b64 exec, -1
    v_cndmask_b32_dpp v84, v84, v84, vcc wave_shr:1 row_mask:0xf bank_mask:0xf
    v_cndmask_b32_dpp v85, v85, v85, vcc wave_shr:1 row_mask:0xf bank_mask:0xf
    s_lshr_b64 s[52:53], s[52:53], 1
    v_cndmask_b32_dpp v86, v86, v86, vcc wave_shr:1 row_mask:0xf bank_mask:0xf
    v_cndmask_b32_dpp v87, v87, v87, vcc wave_shr:1 row_mask:0xf bank_mask:0xf
    s_andn2_b64 s[82:83], s[82:83], s[52:53]
    v_cndmask_b32_dpp v7, v7, v7, vcc wave_shr:1 row_mask:0xf bank_mask:0xf
    s_mov_b64 vcc, s[50:51]
    s_mov_b64 exec, s[50:51]
    s_cbranch_scc0 L2_d89
    s_mov_b64 exec, s[82:83]
    s_nop 1
    v_mfma_f32_4x4x4_16b_bf16 v[88:91], v[12:13], v[84:85], 0
    s_nop 1
    v_mfma_f32_4x4x4_16b_bf16 v[88:91], v[10:11], v[86:87], v[88:91]
    s_nop 4
    v_cvt_pk_bf16_f32 v88, v88, v89
    v_cvt_pk_bf16_f32 v89, v90, v91
    ds_pk_add_bf16 v7, v88 offset:65408
    ds_pk_add_bf16 v7, v89 offset:65412
    s_mov_b64 exec, vcc
    s_branch L2_d89
L2_xa90:
    s_cmp_eq_u32 s43, 1
    s_cbranch_scc1 L2_xc90
    v_lshlrev_b32 v89, 0, v96
    v_add_u32 v90, 140, v97
    v_bitop3_b32 v90, v89, v45, v90 bitop3:0x6a
    ds_write_b32 v98, v90 offset:28
    v_lshlrev_b32 v89, 4, v96
    v_add_u32 v90, 120, v97
    v_bitop3_b32 v90, v89, v45, v90 bitop3:0x6a
    ds_write_b32 v98, v90 offset:24
    v_lshlrev_b32 v89, 8, v96
    v_add_u32 v90, 100, v97
    v_bitop3_b32 v90, v89, v45, v90 bitop3:0x6a
    ds_write_b32 v98, v90 offset:20
L2_xc90:
    v_lshlrev_b32 v89, 12, v96
    v_add_u32 v90, 80, v97
    v_bitop3_b32 v90, v89, v45, v90 bitop3:0x6a
    ds_write_b32 v98, v90 offset:16
    s_branch L2_xb90
L2_xe90:
    v_cmp_lt_u32 vcc, 32, v99
    v_cmp_lt_u32 s[58:59], 31, v88
    v_lshrrev_b32 v89, 16, v96
    v_add_u32 v97, 80, v97
    s_or_b64 vcc, vcc, s[58:59]
    s_cbranch_scc1 L2_xs90
    v_lshlrev_b32 v89, v1, v89
    v_and_b32 v89, v45, v89
    v_cmp_ne_u32 vcc, 0, v89
    v_xor_b32 v90, v97, v89
    s_add_u32 s3, s37, s38
    v_mbcnt_lo_u32_b32 v98, vcc_lo, 0
    v_mbcnt_hi_u32_b32 v98, vcc_hi, v98
    s_bcnt1_i32_b64 s41, vcc
    v_lshl_add_u32 v98, v98, 2, s3
    s_mov_b64 exec, vcc
    ds_write_b32 v98, v90
    s_mov_b64 exec, -1
    s_lshl2_add_u32 s37, s41, s37
    s_branch L2_xr90
L2_xf90:
    s_waitcnt lgkmcnt(0)
    s_cmp_gt_u32 s37, 1024
    s_cbranch_scc1 L2_xs90
    v_mov_b32 v43, -1
    s_cmp_ge_u32 s37, 512
    s_cbranch_scc1 L2_xg90
    v_mov_b32 v42, -1
    s_cmp_ge_u32 s37, 256
    s_cbranch_scc1 L2_xg90
    v_mov_b32 v41, -1
    s_branch L2_xg90
L2_xs90:
    s_waitcnt lgkmcnt(0)
    v_mov_b32 v40, -1
    v_mov_b32 v41, -1
    v_mov_b32 v42, -1
    v_mov_b32 v43, -1
    s_add_u32 s3, s42, 2
    s_bitset1_b32 s36, s3
    s_branch L2_xg90
L2_c91:
    s_mov_b64 s[50:51], vcc
    s_lshl_b64 s[52:53], s[82:83], 1
    s_andn2_b64 s[52:53], s[52:53], s[80:81]
    s_andn2_b64 s[52:53], s[52:53], s[50:51]
    s_or_b64 s[80:81], s[80:81], s[52:53]
    s_not_b64 vcc, s[52:53]
    s_mov_b64 exec, -1
    v_cndmask_b32_dpp v84, v84, v84, vcc wave_shr:1 row_mask:0xf bank_mask:0xf
    v_cndmask_b32_dpp v85, v85, v85, vcc wave_shr:1 row_mask:0xf bank_mask:0xf
    s_lshr_b64 s[52:53], s[52:53], 1
    v_cndmask_b32_dpp v86, v86, v86, vcc wave_shr:1 row_mask:0xf bank_mask:0xf
    v_cndmask_b32_dpp v87, v87, v87, vcc wave_shr:1 row_mask:0xf bank_mask:0xf
    s_andn2_b64 s[82:83], s[82:83], s[52:53]
    v_cndmask_b32_dpp v7, v7, v7, vcc wave_shr:1 row_mask:0xf bank_mask:0xf
    s_mov_b64 vcc, s[50:51]
    s_mov_b64 exec, s[50:51]
    s_cbranch_scc0 L2_d91
    s_mov_b64 exec, s[82:83]
    s_nop 1
    v_mfma_f32_4x4x4_16b_bf16 v[88:91], v[12:13], v[84:85], 0
    s_nop 1
    v_mfma_f32_4x4x4_16b_bf16 v[88:91], v[10:11], v[86:87], v[88:91]
    s_nop 4
    v_cvt_pk_bf16_f32 v88, v88, v89
    v_cvt_pk_bf16_f32 v89, v90, v91
    ds_pk_add_bf16 v7, v88 offset:65408
    ds_pk_add_bf16 v7, v89 offset:65412
    s_mov_b64 exec, vcc
    s_branch L2_d91
L2_c92:
    s_mov_b64 s[50:51], vcc
    s_lshl_b64 s[52:53], s[82:83], 1
    s_andn2_b64 s[52:53], s[52:53], s[80:81]
    s_andn2_b64 s[52:53], s[52:53], s[50:51]
    s_or_b64 s[80:81], s[80:81], s[52:53]
    s_not_b64 vcc, s[52:53]
    s_mov_b64 exec, -1
    v_cndmask_b32_dpp v84, v84, v84, vcc wave_shr:1 row_mask:0xf bank_mask:0xf
    v_cndmask_b32_dpp v85, v85, v85, vcc wave_shr:1 row_mask:0xf bank_mask:0xf
    s_lshr_b64 s[52:53], s[52:53], 1
    v_cndmask_b32_dpp v86, v86, v86, vcc wave_shr:1 row_mask:0xf bank_mask:0xf
    v_cndmask_b32_dpp v87, v87, v87, vcc wave_shr:1 row_mask:0xf bank_mask:0xf
    s_andn2_b64 s[82:83], s[82:83], s[52:53]
    v_cndmask_b32_dpp v7, v7, v7, vcc wave_shr:1 row_mask:0xf bank_mask:0xf
    s_mov_b64 vcc, s[50:51]
    s_mov_b64 exec, s[50:51]
    s_cbranch_scc0 L2_d92
    s_mov_b64 exec, s[82:83]
    s_nop 1
    v_mfma_f32_4x4x4_16b_bf16 v[88:91], v[12:13], v[84:85], 0
    s_nop 1
    v_mfma_f32_4x4x4_16b_bf16 v[88:91], v[10:11], v[86:87], v[88:91]
    s_nop 4
    v_cvt_pk_bf16_f32 v88, v88, v89
    v_cvt_pk_bf16_f32 v89, v90, v91
    ds_pk_add_bf16 v7, v88 offset:65408
    ds_pk_add_bf16 v7, v89 offset:65412
    s_mov_b64 exec, vcc
    s_branch L2_d92
L2_c93:
    s_mov_b64 s[50:51], vcc
    s_lshl_b64 s[52:53], s[82:83], 1
    s_andn2_b64 s[52:53], s[52:53], s[80:81]
    s_andn2_b64 s[52:53], s[52:53], s[50:51]
    s_or_b64 s[80:81], s[80:81], s[52:53]
    s_not_b64 vcc, s[52:53]
    s_mov_b64 exec, -1
    v_cndmask_b32_dpp v84, v84, v84, vcc wave_shr:1 row_mask:0xf bank_mask:0xf
    v_cndmask_b32_dpp v85, v85, v85, vcc wave_shr:1 row_mask:0xf bank_mask:0xf
    s_lshr_b64 s[52:53], s[52:53], 1
    v_cndmask_b32_dpp v86, v86, v86, vcc wave_shr:1 row_mask:0xf bank_mask:0xf
    v_cndmask_b32_dpp v87, v87, v87, vcc wave_shr:1 row_mask:0xf bank_mask:0xf
    s_andn2_b64 s[82:83], s[82:83], s[52:53]
    v_cndmask_b32_dpp v7, v7, v7, vcc wave_shr:1 row_mask:0xf bank_mask:0xf
    s_mov_b64 vcc, s[50:51]
    s_mov_b64 exec, s[50:51]
    s_cbranch_scc0 L2_d93
    s_mov_b64 exec, s[82:83]
    s_nop 1
    v_mfma_f32_4x4x4_16b_bf16 v[88:91], v[12:13], v[84:85], 0
    s_nop 1
    v_mfma_f32_4x4x4_16b_bf16 v[88:91], v[10:11], v[86:87], v[88:91]
    s_nop 4
    v_cvt_pk_bf16_f32 v88, v88, v89
    v_cvt_pk_bf16_f32 v89, v90, v91
    ds_pk_add_bf16 v7, v88 offset:65408
    ds_pk_add_bf16 v7, v89 offset:65412
    s_mov_b64 exec, vcc
    s_branch L2_d93
L2_c94:
    s_mov_b64 s[50:51], vcc
    s_lshl_b64 s[52:53], s[82:83], 1
    s_andn2_b64 s[52:53], s[52:53], s[80:81]
    s_andn2_b64 s[52:53], s[52:53], s[50:51]
    s_or_b64 s[80:81], s[80:81], s[52:53]
    s_not_b64 vcc, s[52:53]
    s_mov_b64 exec, -1
    v_cndmask_b32_dpp v84, v84, v84, vcc wave_shr:1 row_mask:0xf bank_mask:0xf
    v_cndmask_b32_dpp v85, v85, v85, vcc wave_shr:1 row_mask:0xf bank_mask:0xf
    s_lshr_b64 s[52:53], s[52:53], 1
    v_cndmask_b32_dpp v86, v86, v86, vcc wave_shr:1 row_mask:0xf bank_mask:0xf
    v_cndmask_b32_dpp v87, v87, v87, vcc wave_shr:1 row_mask:0xf bank_mask:0xf
    s_andn2_b64 s[82:83], s[82:83], s[52:53]
    v_cndmask_b32_dpp v7, v7, v7, vcc wave_shr:1 row_mask:0xf bank_mask:0xf
    s_mov_b64 vcc, s[50:51]
    s_mov_b64 exec, s[50:51]
    s_cbranch_scc0 L2_d94
    s_mov_b64 exec, s[82:83]
    s_nop 1
    v_mfma_f32_4x4x4_16b_bf16 v[88:91], v[12:13], v[84:85], 0
    s_nop 1
    v_mfma_f32_4x4x4_16b_bf16 v[88:91], v[10:11], v[86:87], v[88:91]
    s_nop 4
    v_cvt_pk_bf16_f32 v88, v88, v89
    v_cvt_pk_bf16_f32 v89, v90, v91
    ds_pk_add_bf16 v7, v88 offset:65408
    ds_pk_add_bf16 v7, v89 offset:65412
    s_mov_b64 exec, vcc
    s_branch L2_d94
L2_c95:
    s_mov_b64 s[50:51], vcc
    s_lshl_b64 s[52:53], s[82:83], 1
    s_andn2_b64 s[52:53], s[52:53], s[80:81]
    s_andn2_b64 s[52:53], s[52:53], s[50:51]
    s_or_b64 s[80:81], s[80:81], s[52:53]
    s_not_b64 vcc, s[52:53]
    s_mov_b64 exec, -1
    v_cndmask_b32_dpp v84, v84, v84, vcc wave_shr:1 row_mask:0xf bank_mask:0xf
    v_cndmask_b32_dpp v85, v85, v85, vcc wave_shr:1 row_mask:0xf bank_mask:0xf
    s_lshr_b64 s[52:53], s[52:53], 1
    v_cndmask_b32_dpp v86, v86, v86, vcc wave_shr:1 row_mask:0xf bank_mask:0xf
    v_cndmask_b32_dpp v87, v87, v87, vcc wave_shr:1 row_mask:0xf bank_mask:0xf
    s_andn2_b64 s[82:83], s[82:83], s[52:53]
    v_cndmask_b32_dpp v7, v7, v7, vcc wave_shr:1 row_mask:0xf bank_mask:0xf
    s_mov_b64 vcc, s[50:51]
    s_mov_b64 exec, s[50:51]
    s_cbranch_scc0 L2_d95
    s_mov_b64 exec, s[82:83]
    s_nop 1
    v_mfma_f32_4x4x4_16b_bf16 v[88:91], v[12:13], v[84:85], 0
    s_nop 1
    v_mfma_f32_4x4x4_16b_bf16 v[88:91], v[10:11], v[86:87], v[88:91]
    s_nop 4
    v_cvt_pk_bf16_f32 v88, v88, v89
    v_cvt_pk_bf16_f32 v89, v90, v91
    ds_pk_add_bf16 v7, v88 offset:65408
    ds_pk_add_bf16 v7, v89 offset:65412
    s_mov_b64 exec, vcc
    s_branch L2_d95
L2_c96:
    s_mov_b64 s[50:51], vcc
    s_lshl_b64 s[52:53], s[82:83], 1
    s_andn2_b64 s[52:53], s[52:53], s[80:81]
    s_andn2_b64 s[52:53], s[52:53], s[50:51]
    s_or_b64 s[80:81], s[80:81], s[52:53]
    s_not_b64 vcc, s[52:53]
    s_mov_b64 exec, -1
    v_cndmask_b32_dpp v84, v84, v84, vcc wave_shr:1 row_mask:0xf bank_mask:0xf
    v_cndmask_b32_dpp v85, v85, v85, vcc wave_shr:1 row_mask:0xf bank_mask:0xf
    s_lshr_b64 s[52:53], s[52:53], 1
    v_cndmask_b32_dpp v86, v86, v86, vcc wave_shr:1 row_mask:0xf bank_mask:0xf
    v_cndmask_b32_dpp v87, v87, v87, vcc wave_shr:1 row_mask:0xf bank_mask:0xf
    s_andn2_b64 s[82:83], s[82:83], s[52:53]
    v_cndmask_b32_dpp v7, v7, v7, vcc wave_shr:1 row_mask:0xf bank_mask:0xf
    s_mov_b64 vcc, s[50:51]
    s_mov_b64 exec, s[50:51]
    s_cbranch_scc0 L2_d96
    s_mov_b64 exec, s[82:83]
    s_nop 1
    v_mfma_f32_4x4x4_16b_bf16 v[88:91], v[12:13], v[84:85], 0
    s_nop 1
    v_mfma_f32_4x4x4_16b_bf16 v[88:91], v[10:11], v[86:87], v[88:91]
    s_nop 4
    v_cvt_pk_bf16_f32 v88, v88, v89
    v_cvt_pk_bf16_f32 v89, v90, v91
    ds_pk_add_bf16 v7, v88 offset:65408
    ds_pk_add_bf16 v7, v89 offset:65412
    s_mov_b64 exec, vcc
    s_branch L2_d96
L2_c97:
    s_mov_b64 s[50:51], vcc
    s_lshl_b64 s[52:53], s[82:83], 1
    s_andn2_b64 s[52:53], s[52:53], s[80:81]
    s_andn2_b64 s[52:53], s[52:53], s[50:51]
    s_or_b64 s[80:81], s[80:81], s[52:53]
    s_not_b64 vcc, s[52:53]
    s_mov_b64 exec, -1
    v_cndmask_b32_dpp v84, v84, v84, vcc wave_shr:1 row_mask:0xf bank_mask:0xf
    v_cndmask_b32_dpp v85, v85, v85, vcc wave_shr:1 row_mask:0xf bank_mask:0xf
    s_lshr_b64 s[52:53], s[52:53], 1
    v_cndmask_b32_dpp v86, v86, v86, vcc wave_shr:1 row_mask:0xf bank_mask:0xf
    v_cndmask_b32_dpp v87, v87, v87, vcc wave_shr:1 row_mask:0xf bank_mask:0xf
    s_andn2_b64 s[82:83], s[82:83], s[52:53]
    v_cndmask_b32_dpp v7, v7, v7, vcc wave_shr:1 row_mask:0xf bank_mask:0xf
    s_mov_b64 vcc, s[50:51]
    s_mov_b64 exec, s[50:51]
    s_cbranch_scc0 L2_d97
    s_mov_b64 exec, s[82:83]
    s_nop 1
    v_mfma_f32_4x4x4_16b_bf16 v[88:91], v[12:13], v[84:85], 0
    s_nop 1
    v_mfma_f32_4x4x4_16b_bf16 v[88:91], v[10:11], v[86:87], v[88:91]
    s_nop 4
    v_cvt_pk_bf16_f32 v88, v88, v89
    v_cvt_pk_bf16_f32 v89, v90, v91
    ds_pk_add_bf16 v7, v88 offset:65408
    ds_pk_add_bf16 v7, v89 offset:65412
    s_mov_b64 exec, vcc
    s_branch L2_d97
L2_c98:
    s_mov_b64 s[50:51], vcc
    s_lshl_b64 s[52:53], s[82:83], 1
    s_andn2_b64 s[52:53], s[52:53], s[80:81]
    s_andn2_b64 s[52:53], s[52:53], s[50:51]
    s_or_b64 s[80:81], s[80:81], s[52:53]
    s_not_b64 vcc, s[52:53]
    s_mov_b64 exec, -1
    v_cndmask_b32_dpp v84, v84, v84, vcc wave_shr:1 row_mask:0xf bank_mask:0xf
    v_cndmask_b32_dpp v85, v85, v85, vcc wave_shr:1 row_mask:0xf bank_mask:0xf
    s_lshr_b64 s[52:53], s[52:53], 1
    v_cndmask_b32_dpp v86, v86, v86, vcc wave_shr:1 row_mask:0xf bank_mask:0xf
    v_cndmask_b32_dpp v87, v87, v87, vcc wave_shr:1 row_mask:0xf bank_mask:0xf
    s_andn2_b64 s[82:83], s[82:83], s[52:53]
    v_cndmask_b32_dpp v7, v7, v7, vcc wave_shr:1 row_mask:0xf bank_mask:0xf
    s_mov_b64 vcc, s[50:51]
    s_mov_b64 exec, s[50:51]
    s_cbranch_scc0 L2_d98
    s_mov_b64 exec, s[82:83]
    s_nop 1
    v_mfma_f32_4x4x4_16b_bf16 v[88:91], v[12:13], v[84:85], 0
    s_nop 1
    v_mfma_f32_4x4x4_16b_bf16 v[88:91], v[10:11], v[86:87], v[88:91]
    s_nop 4
    v_cvt_pk_bf16_f32 v88, v88, v89
    v_cvt_pk_bf16_f32 v89, v90, v91
    ds_pk_add_bf16 v7, v88 offset:65408
    ds_pk_add_bf16 v7, v89 offset:65412
    s_mov_b64 exec, vcc
    s_branch L2_d98
L2_xo99:
    v_cmp_lt_u32 vcc, 20, v99
    s_mov_b32 s43, 1
    s_cbranch_vccz L2_xp99
    v_cmp_lt_u32 vcc, 32, v99
    v_cmp_lt_u32 s[58:59], 31, v88
    s_mov_b32 s43, 2
    s_or_b64 vcc, vcc, s[58:59]
    s_cbranch_scc0 L2_xp99
    s_mov_b32 s37, 0x10000
    s_branch L2_xp99
L2_c100:
    s_mov_b64 s[50:51], vcc
    s_lshl_b64 s[52:53], s[82:83], 1
    s_andn2_b64 s[52:53], s[52:53], s[80:81]
    s_andn2_b64 s[52:53], s[52:53], s[50:51]
    s_or_b64 s[80:81], s[80:81], s[52:53]
    s_not_b64 vcc, s[52:53]
    s_mov_b64 exec, -1
    v_cndmask_b32_dpp v84, v84, v84, vcc wave_shr:1 row_mask:0xf bank_mask:0xf
    v_cndmask_b32_dpp v85, v85, v85, vcc wave_shr:1 row_mask:0xf bank_mask:0xf
    s_lshr_b64 s[52:53], s[52:53], 1
    v_cndmask_b32_dpp v86, v86, v86, vcc wave_shr:1 row_mask:0xf bank_mask:0xf
    v_cndmask_b32_dpp v87, v87, v87, vcc wave_shr:1 row_mask:0xf bank_mask:0xf
    s_andn2_b64 s[82:83], s[82:83], s[52:53]
    v_cndmask_b32_dpp v7, v7, v7, vcc wave_shr:1 row_mask:0xf bank_mask:0xf
    s_mov_b64 vcc, s[50:51]
    s_mov_b64 exec, s[50:51]
    s_cbranch_scc0 L2_d100
    s_mov_b64 exec, s[82:83]
    s_nop 1
    v_mfma_f32_4x4x4_16b_bf16 v[88:91], v[12:13], v[84:85], 0
    s_nop 1
    v_mfma_f32_4x4x4_16b_bf16 v[88:91], v[10:11], v[86:87], v[88:91]
    s_nop 4
    v_cvt_pk_bf16_f32 v88, v88, v89
    v_cvt_pk_bf16_f32 v89, v90, v91
    ds_pk_add_bf16 v7, v88 offset:65408
    ds_pk_add_bf16 v7, v89 offset:65412
    s_mov_b64 exec, vcc
    s_branch L2_d100
L2_c101:
    s_mov_b64 s[50:51], vcc
    s_lshl_b64 s[52:53], s[82:83], 1
    s_andn2_b64 s[52:53], s[52:53], s[80:81]
    s_andn2_b64 s[52:53], s[52:53], s[50:51]
    s_or_b64 s[80:81], s[80:81], s[52:53]
    s_not_b64 vcc, s[52:53]
    s_mov_b64 exec, -1
    v_cndmask_b32_dpp v84, v84, v84, vcc wave_shr:1 row_mask:0xf bank_mask:0xf
    v_cndmask_b32_dpp v85, v85, v85, vcc wave_shr:1 row_mask:0xf bank_mask:0xf
    s_lshr_b64 s[52:53], s[52:53], 1
    v_cndmask_b32_dpp v86, v86, v86, vcc wave_shr:1 row_mask:0xf bank_mask:0xf
    v_cndmask_b32_dpp v87, v87, v87, vcc wave_shr:1 row_mask:0xf bank_mask:0xf
    s_andn2_b64 s[82:83], s[82:83], s[52:53]
    v_cndmask_b32_dpp v7, v7, v7, vcc wave_shr:1 row_mask:0xf bank_mask:0xf
    s_mov_b64 vcc, s[50:51]
    s_mov_b64 exec, s[50:51]
    s_cbranch_scc0 L2_d101
    s_mov_b64 exec, s[82:83]
    s_nop 1
    v_mfma_f32_4x4x4_16b_bf16 v[88:91], v[12:13], v[84:85], 0
    s_nop 1
    v_mfma_f32_4x4x4_16b_bf16 v[88:91], v[10:11], v[86:87], v[88:91]
    s_nop 4
    v_cvt_pk_bf16_f32 v88, v88, v89
    v_cvt_pk_bf16_f32 v89, v90, v91
    ds_pk_add_bf16 v7, v88 offset:65408
    ds_pk_add_bf16 v7, v89 offset:65412
    s_mov_b64 exec, vcc
    s_branch L2_d101
L2_c102:
    s_mov_b64 s[50:51], vcc
    s_lshl_b64 s[52:53], s[82:83], 1
    s_andn2_b64 s[52:53], s[52:53], s[80:81]
    s_andn2_b64 s[52:53], s[52:53], s[50:51]
    s_or_b64 s[80:81], s[80:81], s[52:53]
    s_not_b64 vcc, s[52:53]
    s_mov_b64 exec, -1
    v_cndmask_b32_dpp v84, v84, v84, vcc wave_shr:1 row_mask:0xf bank_mask:0xf
    v_cndmask_b32_dpp v85, v85, v85, vcc wave_shr:1 row_mask:0xf bank_mask:0xf
    s_lshr_b64 s[52:53], s[52:53], 1
    v_cndmask_b32_dpp v86, v86, v86, vcc wave_shr:1 row_mask:0xf bank_mask:0xf
    v_cndmask_b32_dpp v87, v87, v87, vcc wave_shr:1 row_mask:0xf bank_mask:0xf
    s_andn2_b64 s[82:83], s[82:83], s[52:53]
    v_cndmask_b32_dpp v7, v7, v7, vcc wave_shr:1 row_mask:0xf bank_mask:0xf
    s_mov_b64 vcc, s[50:51]
    s_mov_b64 exec, s[50:51]
    s_cbranch_scc0 L2_d102
    s_mov_b64 exec, s[82:83]
    s_nop 1
    v_mfma_f32_4x4x4_16b_bf16 v[88:91], v[12:13], v[84:85], 0
    s_nop 1
    v_mfma_f32_4x4x4_16b_bf16 v[88:91], v[10:11], v[86:87], v[88:91]
    s_nop 4
    v_cvt_pk_bf16_f32 v88, v88, v89
    v_cvt_pk_bf16_f32 v89, v90, v91
    ds_pk_add_bf16 v7, v88 offset:65408
    ds_pk_add_bf16 v7, v89 offset:65412
    s_mov_b64 exec, vcc
    s_branch L2_d102
L2_c103:
    s_mov_b64 s[50:51], vcc
    s_lshl_b64 s[52:53], s[82:83], 1
    s_andn2_b64 s[52:53], s[52:53], s[80:81]
    s_andn2_b64 s[52:53], s[52:53], s[50:51]
    s_or_b64 s[80:81], s[80:81], s[52:53]
    s_not_b64 vcc, s[52:53]
    s_mov_b64 exec, -1
    v_cndmask_b32_dpp v84, v84, v84, vcc wave_shr:1 row_mask:0xf bank_mask:0xf
    v_cndmask_b32_dpp v85, v85, v85, vcc wave_shr:1 row_mask:0xf bank_mask:0xf
    s_lshr_b64 s[52:53], s[52:53], 1
    v_cndmask_b32_dpp v86, v86, v86, vcc wave_shr:1 row_mask:0xf bank_mask:0xf
    v_cndmask_b32_dpp v87, v87, v87, vcc wave_shr:1 row_mask:0xf bank_mask:0xf
    s_andn2_b64 s[82:83], s[82:83], s[52:53]
    v_cndmask_b32_dpp v7, v7, v7, vcc wave_shr:1 row_mask:0xf bank_mask:0xf
    s_mov_b64 vcc, s[50:51]
    s_mov_b64 exec, s[50:51]
    s_cbranch_scc0 L2_d103
    s_mov_b64 exec, s[82:83]
    s_nop 1
    v_mfma_f32_4x4x4_16b_bf16 v[88:91], v[12:13], v[84:85], 0
    s_nop 1
    v_mfma_f32_4x4x4_16b_bf16 v[88:91], v[10:11], v[86:87], v[88:91]
    s_nop 4
    v_cvt_pk_bf16_f32 v88, v88, v89
    v_cvt_pk_bf16_f32 v89, v90, v91
    ds_pk_add_bf16 v7, v88 offset:65408
    ds_pk_add_bf16 v7, v89 offset:65412
    s_mov_b64 exec, vcc
    s_branch L2_d103
L2_c104:
    s_mov_b64 s[50:51], vcc
    s_lshl_b64 s[52:53], s[82:83], 1
    s_andn2_b64 s[52:53], s[52:53], s[80:81]
    s_andn2_b64 s[52:53], s[52:53], s[50:51]
    s_or_b64 s[80:81], s[80:81], s[52:53]
    s_not_b64 vcc, s[52:53]
    s_mov_b64 exec, -1
    v_cndmask_b32_dpp v84, v84, v84, vcc wave_shr:1 row_mask:0xf bank_mask:0xf
    v_cndmask_b32_dpp v85, v85, v85, vcc wave_shr:1 row_mask:0xf bank_mask:0xf
    s_lshr_b64 s[52:53], s[52:53], 1
    v_cndmask_b32_dpp v86, v86, v86, vcc wave_shr:1 row_mask:0xf bank_mask:0xf
    v_cndmask_b32_dpp v87, v87, v87, vcc wave_shr:1 row_mask:0xf bank_mask:0xf
    s_andn2_b64 s[82:83], s[82:83], s[52:53]
    v_cndmask_b32_dpp v7, v7, v7, vcc wave_shr:1 row_mask:0xf bank_mask:0xf
    s_mov_b64 vcc, s[50:51]
    s_mov_b64 exec, s[50:51]
    s_cbranch_scc0 L2_d104
    s_mov_b64 exec, s[82:83]
    s_nop 1
    v_mfma_f32_4x4x4_16b_bf16 v[88:91], v[12:13], v[84:85], 0
    s_nop 1
    v_mfma_f32_4x4x4_16b_bf16 v[88:91], v[10:11], v[86:87], v[88:91]
    s_nop 4
    v_cvt_pk_bf16_f32 v88, v88, v89
    v_cvt_pk_bf16_f32 v89, v90, v91
    ds_pk_add_bf16 v7, v88 offset:65408
    ds_pk_add_bf16 v7, v89 offset:65412
    s_mov_b64 exec, vcc
    s_branch L2_d104
L2_c105:
    s_mov_b64 s[50:51], vcc
    s_lshl_b64 s[52:53], s[82:83], 1
    s_andn2_b64 s[52:53], s[52:53], s[80:81]
    s_andn2_b64 s[52:53], s[52:53], s[50:51]
    s_or_b64 s[80:81], s[80:81], s[52:53]
    s_not_b64 vcc, s[52:53]
    s_mov_b64 exec, -1
    v_cndmask_b32_dpp v84, v84, v84, vcc wave_shr:1 row_mask:0xf bank_mask:0xf
    v_cndmask_b32_dpp v85, v85, v85, vcc wave_shr:1 row_mask:0xf bank_mask:0xf
    s_lshr_b64 s[52:53], s[52:53], 1
    v_cndmask_b32_dpp v86, v86, v86, vcc wave_shr:1 row_mask:0xf bank_mask:0xf
    v_cndmask_b32_dpp v87, v87, v87, vcc wave_shr:1 row_mask:0xf bank_mask:0xf
    s_andn2_b64 s[82:83], s[82:83], s[52:53]
    v_cndmask_b32_dpp v7, v7, v7, vcc wave_shr:1 row_mask:0xf bank_mask:0xf
    s_mov_b64 vcc, s[50:51]
    s_mov_b64 exec, s[50:51]
    s_cbranch_scc0 L2_d105
    s_mov_b64 exec, s[82:83]
    s_nop 1
    v_mfma_f32_4x4x4_16b_bf16 v[88:91], v[12:13], v[84:85], 0
    s_nop 1
    v_mfma_f32_4x4x4_16b_bf16 v[88:91], v[10:11], v[86:87], v[88:91]
    s_nop 4
    v_cvt_pk_bf16_f32 v88, v88, v89
    v_cvt_pk_bf16_f32 v89, v90, v91
    ds_pk_add_bf16 v7, v88 offset:65408
    ds_pk_add_bf16 v7, v89 offset:65412
    s_mov_b64 exec, vcc
    s_branch L2_d105
L2_c106:
    s_mov_b64 s[50:51], vcc
    s_lshl_b64 s[52:53], s[82:83], 1
    s_andn2_b64 s[52:53], s[52:53], s[80:81]
    s_andn2_b64 s[52:53], s[52:53], s[50:51]
    s_or_b64 s[80:81], s[80:81], s[52:53]
    s_not_b64 vcc, s[52:53]
    s_mov_b64 exec, -1
    v_cndmask_b32_dpp v84, v84, v84, vcc wave_shr:1 row_mask:0xf bank_mask:0xf
    v_cndmask_b32_dpp v85, v85, v85, vcc wave_shr:1 row_mask:0xf bank_mask:0xf
    s_lshr_b64 s[52:53], s[52:53], 1
    v_cndmask_b32_dpp v86, v86, v86, vcc wave_shr:1 row_mask:0xf bank_mask:0xf
    v_cndmask_b32_dpp v87, v87, v87, vcc wave_shr:1 row_mask:0xf bank_mask:0xf
    s_andn2_b64 s[82:83], s[82:83], s[52:53]
    v_cndmask_b32_dpp v7, v7, v7, vcc wave_shr:1 row_mask:0xf bank_mask:0xf
    s_mov_b64 vcc, s[50:51]
    s_mov_b64 exec, s[50:51]
    s_cbranch_scc0 L2_d106
    s_mov_b64 exec, s[82:83]
    s_nop 1
    v_mfma_f32_4x4x4_16b_bf16 v[88:91], v[12:13], v[84:85], 0
    s_nop 1
    v_mfma_f32_4x4x4_16b_bf16 v[88:91], v[10:11], v[86:87], v[88:91]
    s_nop 4
    v_cvt_pk_bf16_f32 v88, v88, v89
    v_cvt_pk_bf16_f32 v89, v90, v91
    ds_pk_add_bf16 v7, v88 offset:65408
    ds_pk_add_bf16 v7, v89 offset:65412
    s_mov_b64 exec, vcc
    s_branch L2_d106
L2_c107:
    s_mov_b64 s[50:51], vcc
    s_lshl_b64 s[52:53], s[82:83], 1
    s_andn2_b64 s[52:53], s[52:53], s[80:81]
    s_andn2_b64 s[52:53], s[52:53], s[50:51]
    s_or_b64 s[80:81], s[80:81], s[52:53]
    s_not_b64 vcc, s[52:53]
    s_mov_b64 exec, -1
    v_cndmask_b32_dpp v84, v84, v84, vcc wave_shr:1 row_mask:0xf bank_mask:0xf
    v_cndmask_b32_dpp v85, v85, v85, vcc wave_shr:1 row_mask:0xf bank_mask:0xf
    s_lshr_b64 s[52:53], s[52:53], 1
    v_cndmask_b32_dpp v86, v86, v86, vcc wave_shr:1 row_mask:0xf bank_mask:0xf
    v_cndmask_b32_dpp v87, v87, v87, vcc wave_shr:1 row_mask:0xf bank_mask:0xf
    s_andn2_b64 s[82:83], s[82:83], s[52:53]
    v_cndmask_b32_dpp v7, v7, v7, vcc wave_shr:1 row_mask:0xf bank_mask:0xf
    s_mov_b64 vcc, s[50:51]
    s_mov_b64 exec, s[50:51]
    s_cbranch_scc0 L2_d107
    s_mov_b64 exec, s[82:83]
    s_nop 1
    v_mfma_f32_4x4x4_16b_bf16 v[88:91], v[12:13], v[84:85], 0
    s_nop 1
    v_mfma_f32_4x4x4_16b_bf16 v[88:91], v[10:11], v[86:87], v[88:91]
    s_nop 4
    v_cvt_pk_bf16_f32 v88, v88, v89
    v_cvt_pk_bf16_f32 v89, v90, v91
    ds_pk_add_bf16 v7, v88 offset:65408
    ds_pk_add_bf16 v7, v89 offset:65412
    s_mov_b64 exec, vcc
    s_branch L2_d107
L2_xa108:
    s_cmp_eq_u32 s43, 1
    s_cbranch_scc1 L2_xc108
    v_lshlrev_b32 v89, 0, v96
    v_add_u32 v90, 140, v97
    v_bitop3_b32 v90, v89, v45, v90 bitop3:0x6a
    ds_write_b32 v98, v90 offset:28
    v_lshlrev_b32 v89, 4, v96
    v_add_u32 v90, 120, v97
    v_bitop3_b32 v90, v89, v45, v90 bitop3:0x6a
    ds_write_b32 v98, v90 offset:24
    v_lshlrev_b32 v89, 8, v96
    v_add_u32 v90, 100, v97
    v_bitop3_b32 v90, v89, v45, v90 bitop3:0x6a
    ds_write_b32 v98, v90 offset:20
L2_xc108:
    v_lshlrev_b32 v89, 12, v96
    v_add_u32 v90, 80, v97
    v_bitop3_b32 v90, v89, v45, v90 bitop3:0x6a
    ds_write_b32 v98, v90 offset:16
    s_branch L2_xb108
L2_xe108:
    v_cmp_lt_u32 vcc, 32, v99
    v_cmp_lt_u32 s[58:59], 31, v88
    v_lshrrev_b32 v89, 16, v96
    v_add_u32 v97, 80, v97
    s_or_b64 vcc, vcc, s[58:59]
    s_cbranch_scc1 L2_xs108
    v_lshlrev_b32 v89, v1, v89
    v_and_b32 v89, v45, v89
    v_cmp_ne_u32 vcc, 0, v89
    v_xor_b32 v90, v97, v89
    s_add_u32 s3, s37, s38
    v_mbcnt_lo_u32_b32 v98, vcc_lo, 0
    v_mbcnt_hi_u32_b32 v98, vcc_hi, v98
    s_bcnt1_i32_b64 s41, vcc
    v_lshl_add_u32 v98, v98, 2, s3
    s_mov_b64 exec, vcc
    ds_write_b32 v98, v90
    s_mov_b64 exec, -1
    s_lshl2_add_u32 s37, s41, s37
    s_branch L2_xr108
L2_xf108:
    s_waitcnt lgkmcnt(0)
    s_cmp_gt_u32 s37, 1024
    s_cbranch_scc1 L2_xs108
    v_mov_b32 v43, -1
    s_cmp_ge_u32 s37, 512
    s_cbranch_scc1 L2_xg108
    v_mov_b32 v42, -1
    s_cmp_ge_u32 s37, 256
    s_cbranch_scc1 L2_xg108
    v_mov_b32 v41, -1
    s_branch L2_xg108
L2_xs108:
    s_waitcnt lgkmcnt(0)
    v_mov_b32 v40, -1
    v_mov_b32 v41, -1
    v_mov_b32 v42, -1
    v_mov_b32 v43, -1
    s_add_u32 s3, s42, 2
    s_bitset1_b32 s36, s3
    s_branch L2_xg108
L2_c109:
    s_mov_b64 s[50:51], vcc
    s_lshl_b64 s[52:53], s[82:83], 1
    s_andn2_b64 s[52:53], s[52:53], s[80:81]
    s_andn2_b64 s[52:53], s[52:53], s[50:51]
    s_or_b64 s[80:81], s[80:81], s[52:53]
    s_not_b64 vcc, s[52:53]
    s_mov_b64 exec, -1
    v_cndmask_b32_dpp v84, v84, v84, vcc wave_shr:1 row_mask:0xf bank_mask:0xf
    v_cndmask_b32_dpp v85, v85, v85, vcc wave_shr:1 row_mask:0xf bank_mask:0xf
    s_lshr_b64 s[52:53], s[52:53], 1
    v_cndmask_b32_dpp v86, v86, v86, vcc wave_shr:1 row_mask:0xf bank_mask:0xf
    v_cndmask_b32_dpp v87, v87, v87, vcc wave_shr:1 row_mask:0xf bank_mask:0xf
    s_andn2_b64 s[82:83], s[82:83], s[52:53]
    v_cndmask_b32_dpp v7, v7, v7, vcc wave_shr:1 row_mask:0xf bank_mask:0xf
    s_mov_b64 vcc, s[50:51]
    s_mov_b64 exec, s[50:51]
    s_cbranch_scc0 L2_d109
    s_mov_b64 exec, s[82:83]
    s_nop 1
    v_mfma_f32_4x4x4_16b_bf16 v[88:91], v[12:13], v[84:85], 0
    s_nop 1
    v_mfma_f32_4x4x4_16b_bf16 v[88:91], v[10:11], v[86:87], v[88:91]
    s_nop 4
    v_cvt_pk_bf16_f32 v88, v88, v89
    v_cvt_pk_bf16_f32 v89, v90, v91
    ds_pk_add_bf16 v7, v88 offset:65408
    ds_pk_add_bf16 v7, v89 offset:65412
    s_mov_b64 exec, vcc
    s_branch L2_d109
L2_c110:
    s_mov_b64 s[50:51], vcc
    s_lshl_b64 s[52:53], s[82:83], 1
    s_andn2_b64 s[52:53], s[52:53], s[80:81]
    s_andn2_b64 s[52:53], s[52:53], s[50:51]
    s_or_b64 s[80:81], s[80:81], s[52:53]
    s_not_b64 vcc, s[52:53]
    s_mov_b64 exec, -1
    v_cndmask_b32_dpp v84, v84, v84, vcc wave_shr:1 row_mask:0xf bank_mask:0xf
    v_cndmask_b32_dpp v85, v85, v85, vcc wave_shr:1 row_mask:0xf bank_mask:0xf
    s_lshr_b64 s[52:53], s[52:53], 1
    v_cndmask_b32_dpp v86, v86, v86, vcc wave_shr:1 row_mask:0xf bank_mask:0xf
    v_cndmask_b32_dpp v87, v87, v87, vcc wave_shr:1 row_mask:0xf bank_mask:0xf
    s_andn2_b64 s[82:83], s[82:83], s[52:53]
    v_cndmask_b32_dpp v7, v7, v7, vcc wave_shr:1 row_mask:0xf bank_mask:0xf
    s_mov_b64 vcc, s[50:51]
    s_mov_b64 exec, s[50:51]
    s_cbranch_scc0 L2_d110
    s_mov_b64 exec, s[82:83]
    s_nop 1
    v_mfma_f32_4x4x4_16b_bf16 v[88:91], v[12:13], v[84:85], 0
    s_nop 1
    v_mfma_f32_4x4x4_16b_bf16 v[88:91], v[10:11], v[86:87], v[88:91]
    s_nop 4
    v_cvt_pk_bf16_f32 v88, v88, v89
    v_cvt_pk_bf16_f32 v89, v90, v91
    ds_pk_add_bf16 v7, v88 offset:65408
    ds_pk_add_bf16 v7, v89 offset:65412
    s_mov_b64 exec, vcc
    s_branch L2_d110
L2_c111:
    s_mov_b64 s[50:51], vcc
    s_lshl_b64 s[52:53], s[82:83], 1
    s_andn2_b64 s[52:53], s[52:53], s[80:81]
    s_andn2_b64 s[52:53], s[52:53], s[50:51]
    s_or_b64 s[80:81], s[80:81], s[52:53]
    s_not_b64 vcc, s[52:53]
    s_mov_b64 exec, -1
    v_cndmask_b32_dpp v84, v84, v84, vcc wave_shr:1 row_mask:0xf bank_mask:0xf
    v_cndmask_b32_dpp v85, v85, v85, vcc wave_shr:1 row_mask:0xf bank_mask:0xf
    s_lshr_b64 s[52:53], s[52:53], 1
    v_cndmask_b32_dpp v86, v86, v86, vcc wave_shr:1 row_mask:0xf bank_mask:0xf
    v_cndmask_b32_dpp v87, v87, v87, vcc wave_shr:1 row_mask:0xf bank_mask:0xf
    s_andn2_b64 s[82:83], s[82:83], s[52:53]
    v_cndmask_b32_dpp v7, v7, v7, vcc wave_shr:1 row_mask:0xf bank_mask:0xf
    s_mov_b64 vcc, s[50:51]
    s_mov_b64 exec, s[50:51]
    s_cbranch_scc0 L2_d111
    s_mov_b64 exec, s[82:83]
    s_nop 1
    v_mfma_f32_4x4x4_16b_bf16 v[88:91], v[12:13], v[84:85], 0
    s_nop 1
    v_mfma_f32_4x4x4_16b_bf16 v[88:91], v[10:11], v[86:87], v[88:91]
    s_nop 4
    v_cvt_pk_bf16_f32 v88, v88, v89
    v_cvt_pk_bf16_f32 v89, v90, v91
    ds_pk_add_bf16 v7, v88 offset:65408
    ds_pk_add_bf16 v7, v89 offset:65412
    s_mov_b64 exec, vcc
    s_branch L2_d111
L2_c112:
    s_mov_b64 s[50:51], vcc
    s_lshl_b64 s[52:53], s[82:83], 1
    s_andn2_b64 s[52:53], s[52:53], s[80:81]
    s_andn2_b64 s[52:53], s[52:53], s[50:51]
    s_or_b64 s[80:81], s[80:81], s[52:53]
    s_not_b64 vcc, s[52:53]
    s_mov_b64 exec, -1
    v_cndmask_b32_dpp v84, v84, v84, vcc wave_shr:1 row_mask:0xf bank_mask:0xf
    v_cndmask_b32_dpp v85, v85, v85, vcc wave_shr:1 row_mask:0xf bank_mask:0xf
    s_lshr_b64 s[52:53], s[52:53], 1
    v_cndmask_b32_dpp v86, v86, v86, vcc wave_shr:1 row_mask:0xf bank_mask:0xf
    v_cndmask_b32_dpp v87, v87, v87, vcc wave_shr:1 row_mask:0xf bank_mask:0xf
    s_andn2_b64 s[82:83], s[82:83], s[52:53]
    v_cndmask_b32_dpp v7, v7, v7, vcc wave_shr:1 row_mask:0xf bank_mask:0xf
    s_mov_b64 vcc, s[50:51]
    s_mov_b64 exec, s[50:51]
    s_cbranch_scc0 L2_d112
    s_mov_b64 exec, s[82:83]
    s_nop 1
    v_mfma_f32_4x4x4_16b_bf16 v[88:91], v[12:13], v[84:85], 0
    s_nop 1
    v_mfma_f32_4x4x4_16b_bf16 v[88:91], v[10:11], v[86:87], v[88:91]
    s_nop 4
    v_cvt_pk_bf16_f32 v88, v88, v89
    v_cvt_pk_bf16_f32 v89, v90, v91
    ds_pk_add_bf16 v7, v88 offset:65408
    ds_pk_add_bf16 v7, v89 offset:65412
    s_mov_b64 exec, vcc
    s_branch L2_d112
L2_c113:
    s_mov_b64 s[50:51], vcc
    s_lshl_b64 s[52:53], s[82:83], 1
    s_andn2_b64 s[52:53], s[52:53], s[80:81]
    s_andn2_b64 s[52:53], s[52:53], s[50:51]
    s_or_b64 s[80:81], s[80:81], s[52:53]
    s_not_b64 vcc, s[52:53]
    s_mov_b64 exec, -1
    v_cndmask_b32_dpp v84, v84, v84, vcc wave_shr:1 row_mask:0xf bank_mask:0xf
    v_cndmask_b32_dpp v85, v85, v85, vcc wave_shr:1 row_mask:0xf bank_mask:0xf
    s_lshr_b64 s[52:53], s[52:53], 1
    v_cndmask_b32_dpp v86, v86, v86, vcc wave_shr:1 row_mask:0xf bank_mask:0xf
    v_cndmask_b32_dpp v87, v87, v87, vcc wave_shr:1 row_mask:0xf bank_mask:0xf
    s_andn2_b64 s[82:83], s[82:83], s[52:53]
    v_cndmask_b32_dpp v7, v7, v7, vcc wave_shr:1 row_mask:0xf bank_mask:0xf
    s_mov_b64 vcc, s[50:51]
    s_mov_b64 exec, s[50:51]
    s_cbranch_scc0 L2_d113
    s_mov_b64 exec, s[82:83]
    s_nop 1
    v_mfma_f32_4x4x4_16b_bf16 v[88:91], v[12:13], v[84:85], 0
    s_nop 1
    v_mfma_f32_4x4x4_16b_bf16 v[88:91], v[10:11], v[86:87], v[88:91]
    s_nop 4
    v_cvt_pk_bf16_f32 v88, v88, v89
    v_cvt_pk_bf16_f32 v89, v90, v91
    ds_pk_add_bf16 v7, v88 offset:65408
    ds_pk_add_bf16 v7, v89 offset:65412
    s_mov_b64 exec, vcc
    s_branch L2_d113
L2_c114:
    s_mov_b64 s[50:51], vcc
    s_lshl_b64 s[52:53], s[82:83], 1
    s_andn2_b64 s[52:53], s[52:53], s[80:81]
    s_andn2_b64 s[52:53], s[52:53], s[50:51]
    s_or_b64 s[80:81], s[80:81], s[52:53]
    s_not_b64 vcc, s[52:53]
    s_mov_b64 exec, -1
    v_cndmask_b32_dpp v84, v84, v84, vcc wave_shr:1 row_mask:0xf bank_mask:0xf
    v_cndmask_b32_dpp v85, v85, v85, vcc wave_shr:1 row_mask:0xf bank_mask:0xf
    s_lshr_b64 s[52:53], s[52:53], 1
    v_cndmask_b32_dpp v86, v86, v86, vcc wave_shr:1 row_mask:0xf bank_mask:0xf
    v_cndmask_b32_dpp v87, v87, v87, vcc wave_shr:1 row_mask:0xf bank_mask:0xf
    s_andn2_b64 s[82:83], s[82:83], s[52:53]
    v_cndmask_b32_dpp v7, v7, v7, vcc wave_shr:1 row_mask:0xf bank_mask:0xf
    s_mov_b64 vcc, s[50:51]
    s_mov_b64 exec, s[50:51]
    s_cbranch_scc0 L2_d114
    s_mov_b64 exec, s[82:83]
    s_nop 1
    v_mfma_f32_4x4x4_16b_bf16 v[88:91], v[12:13], v[84:85], 0
    s_nop 1
    v_mfma_f32_4x4x4_16b_bf16 v[88:91], v[10:11], v[86:87], v[88:91]
    s_nop 4
    v_cvt_pk_bf16_f32 v88, v88, v89
    v_cvt_pk_bf16_f32 v89, v90, v91
    ds_pk_add_bf16 v7, v88 offset:65408
    ds_pk_add_bf16 v7, v89 offset:65412
    s_mov_b64 exec, vcc
    s_branch L2_d114
L2_c115:
    s_mov_b64 s[50:51], vcc
    s_lshl_b64 s[52:53], s[82:83], 1
    s_andn2_b64 s[52:53], s[52:53], s[80:81]
    s_andn2_b64 s[52:53], s[52:53], s[50:51]
    s_or_b64 s[80:81], s[80:81], s[52:53]
    s_not_b64 vcc, s[52:53]
    s_mov_b64 exec, -1
    v_cndmask_b32_dpp v84, v84, v84, vcc wave_shr:1 row_mask:0xf bank_mask:0xf
    v_cndmask_b32_dpp v85, v85, v85, vcc wave_shr:1 row_mask:0xf bank_mask:0xf
    s_lshr_b64 s[52:53], s[52:53], 1
    v_cndmask_b32_dpp v86, v86, v86, vcc wave_shr:1 row_mask:0xf bank_mask:0xf
    v_cndmask_b32_dpp v87, v87, v87, vcc wave_shr:1 row_mask:0xf bank_mask:0xf
    s_andn2_b64 s[82:83], s[82:83], s[52:53]
    v_cndmask_b32_dpp v7, v7, v7, vcc wave_shr:1 row_mask:0xf bank_mask:0xf
    s_mov_b64 vcc, s[50:51]
    s_mov_b64 exec, s[50:51]
    s_cbranch_scc0 L2_d115
    s_mov_b64 exec, s[82:83]
    s_nop 1
    v_mfma_f32_4x4x4_16b_bf16 v[88:91], v[12:13], v[84:85], 0
    s_nop 1
    v_mfma_f32_4x4x4_16b_bf16 v[88:91], v[10:11], v[86:87], v[88:91]
    s_nop 4
    v_cvt_pk_bf16_f32 v88, v88, v89
    v_cvt_pk_bf16_f32 v89, v90, v91
    ds_pk_add_bf16 v7, v88 offset:65408
    ds_pk_add_bf16 v7, v89 offset:65412
    s_mov_b64 exec, vcc
    s_branch L2_d115
L2_c116:
    s_mov_b64 s[50:51], vcc
    s_lshl_b64 s[52:53], s[82:83], 1
    s_andn2_b64 s[52:53], s[52:53], s[80:81]
    s_andn2_b64 s[52:53], s[52:53], s[50:51]
    s_or_b64 s[80:81], s[80:81], s[52:53]
    s_not_b64 vcc, s[52:53]
    s_mov_b64 exec, -1
    v_cndmask_b32_dpp v84, v84, v84, vcc wave_shr:1 row_mask:0xf bank_mask:0xf
    v_cndmask_b32_dpp v85, v85, v85, vcc wave_shr:1 row_mask:0xf bank_mask:0xf
    s_lshr_b64 s[52:53], s[52:53], 1
    v_cndmask_b32_dpp v86, v86, v86, vcc wave_shr:1 row_mask:0xf bank_mask:0xf
    v_cndmask_b32_dpp v87, v87, v87, vcc wave_shr:1 row_mask:0xf bank_mask:0xf
    s_andn2_b64 s[82:83], s[82:83], s[52:53]
    v_cndmask_b32_dpp v7, v7, v7, vcc wave_shr:1 row_mask:0xf bank_mask:0xf
    s_mov_b64 vcc, s[50:51]
    s_mov_b64 exec, s[50:51]
    s_cbranch_scc0 L2_d116
    s_mov_b64 exec, s[82:83]
    s_nop 1
    v_mfma_f32_4x4x4_16b_bf16 v[88:91], v[12:13], v[84:85], 0
    s_nop 1
    v_mfma_f32_4x4x4_16b_bf16 v[88:91], v[10:11], v[86:87], v[88:91]
    s_nop 4
    v_cvt_pk_bf16_f32 v88, v88, v89
    v_cvt_pk_bf16_f32 v89, v90, v91
    ds_pk_add_bf16 v7, v88 offset:65408
    ds_pk_add_bf16 v7, v89 offset:65412
    s_mov_b64 exec, vcc
    s_branch L2_d116
L2_c117:
    s_mov_b64 s[50:51], vcc
    s_lshl_b64 s[52:53], s[82:83], 1
    s_andn2_b64 s[52:53], s[52:53], s[80:81]
    s_andn2_b64 s[52:53], s[52:53], s[50:51]
    s_or_b64 s[80:81], s[80:81], s[52:53]
    s_not_b64 vcc, s[52:53]
    s_mov_b64 exec, -1
    v_cndmask_b32_dpp v84, v84, v84, vcc wave_shr:1 row_mask:0xf bank_mask:0xf
    v_cndmask_b32_dpp v85, v85, v85, vcc wave_shr:1 row_mask:0xf bank_mask:0xf
    s_lshr_b64 s[52:53], s[52:53], 1
    v_cndmask_b32_dpp v86, v86, v86, vcc wave_shr:1 row_mask:0xf bank_mask:0xf
    v_cndmask_b32_dpp v87, v87, v87, vcc wave_shr:1 row_mask:0xf bank_mask:0xf
    s_andn2_b64 s[82:83], s[82:83], s[52:53]
    v_cndmask_b32_dpp v7, v7, v7, vcc wave_shr:1 row_mask:0xf bank_mask:0xf
    s_mov_b64 vcc, s[50:51]
    s_mov_b64 exec, s[50:51]
    s_cbranch_scc0 L2_d117
    s_mov_b64 exec, s[82:83]
    s_nop 1
    v_mfma_f32_4x4x4_16b_bf16 v[88:91], v[12:13], v[84:85], 0
    s_nop 1
    v_mfma_f32_4x4x4_16b_bf16 v[88:91], v[10:11], v[86:87], v[88:91]
    s_nop 4
    v_cvt_pk_bf16_f32 v88, v88, v89
    v_cvt_pk_bf16_f32 v89, v90, v91
    ds_pk_add_bf16 v7, v88 offset:65408
    ds_pk_add_bf16 v7, v89 offset:65412
    s_mov_b64 exec, vcc
    s_branch L2_d117
L2_c118:
    s_mov_b64 s[50:51], vcc
    s_lshl_b64 s[52:53], s[82:83], 1
    s_andn2_b64 s[52:53], s[52:53], s[80:81]
    s_andn2_b64 s[52:53], s[52:53], s[50:51]
    s_or_b64 s[80:81], s[80:81], s[52:53]
    s_not_b64 vcc, s[52:53]
    s_mov_b64 exec, -1
    v_cndmask_b32_dpp v84, v84, v84, vcc wave_shr:1 row_mask:0xf bank_mask:0xf
    v_cndmask_b32_dpp v85, v85, v85, vcc wave_shr:1 row_mask:0xf bank_mask:0xf
    s_lshr_b64 s[52:53], s[52:53], 1
    v_cndmask_b32_dpp v86, v86, v86, vcc wave_shr:1 row_mask:0xf bank_mask:0xf
    v_cndmask_b32_dpp v87, v87, v87, vcc wave_shr:1 row_mask:0xf bank_mask:0xf
    s_andn2_b64 s[82:83], s[82:83], s[52:53]
    v_cndmask_b32_dpp v7, v7, v7, vcc wave_shr:1 row_mask:0xf bank_mask:0xf
    s_mov_b64 vcc, s[50:51]
    s_mov_b64 exec, s[50:51]
    s_cbranch_scc0 L2_d118
    s_mov_b64 exec, s[82:83]
    s_nop 1
    v_mfma_f32_4x4x4_16b_bf16 v[88:91], v[12:13], v[84:85], 0
    s_nop 1
    v_mfma_f32_4x4x4_16b_bf16 v[88:91], v[10:11], v[86:87], v[88:91]
    s_nop 4
    v_cvt_pk_bf16_f32 v88, v88, v89
    v_cvt_pk_bf16_f32 v89, v90, v91
    ds_pk_add_bf16 v7, v88 offset:65408
    ds_pk_add_bf16 v7, v89 offset:65412
    s_mov_b64 exec, vcc
    s_branch L2_d118
L2_c119:
    s_mov_b64 s[50:51], vcc
    s_lshl_b64 s[52:53], s[82:83], 1
    s_andn2_b64 s[52:53], s[52:53], s[80:81]
    s_andn2_b64 s[52:53], s[52:53], s[50:51]
    s_or_b64 s[80:81], s[80:81], s[52:53]
    s_not_b64 vcc, s[52:53]
    s_mov_b64 exec, -1
    v_cndmask_b32_dpp v84, v84, v84, vcc wave_shr:1 row_mask:0xf bank_mask:0xf
    v_cndmask_b32_dpp v85, v85, v85, vcc wave_shr:1 row_mask:0xf bank_mask:0xf
    s_lshr_b64 s[52:53], s[52:53], 1
    v_cndmask_b32_dpp v86, v86, v86, vcc wave_shr:1 row_mask:0xf bank_mask:0xf
    v_cndmask_b32_dpp v87, v87, v87, vcc wave_shr:1 row_mask:0xf bank_mask:0xf
    s_andn2_b64 s[82:83], s[82:83], s[52:53]
    v_cndmask_b32_dpp v7, v7, v7, vcc wave_shr:1 row_mask:0xf bank_mask:0xf
    s_mov_b64 vcc, s[50:51]
    s_mov_b64 exec, s[50:51]
    s_cbranch_scc0 L2_d119
    s_mov_b64 exec, s[82:83]
    s_nop 1
    v_mfma_f32_4x4x4_16b_bf16 v[88:91], v[12:13], v[84:85], 0
    s_nop 1
    v_mfma_f32_4x4x4_16b_bf16 v[88:91], v[10:11], v[86:87], v[88:91]
    s_nop 4
    v_cvt_pk_bf16_f32 v88, v88, v89
    v_cvt_pk_bf16_f32 v89, v90, v91
    ds_pk_add_bf16 v7, v88 offset:65408
    ds_pk_add_bf16 v7, v89 offset:65412
    s_mov_b64 exec, vcc
    s_branch L2_d119
L2_c120:
    s_mov_b64 s[50:51], vcc
    s_lshl_b64 s[52:53], s[82:83], 1
    s_andn2_b64 s[52:53], s[52:53], s[80:81]
    s_andn2_b64 s[52:53], s[52:53], s[50:51]
    s_or_b64 s[80:81], s[80:81], s[52:53]
    s_not_b64 vcc, s[52:53]
    s_mov_b64 exec, -1
    v_cndmask_b32_dpp v84, v84, v84, vcc wave_shr:1 row_mask:0xf bank_mask:0xf
    v_cndmask_b32_dpp v85, v85, v85, vcc wave_shr:1 row_mask:0xf bank_mask:0xf
    s_lshr_b64 s[52:53], s[52:53], 1
    v_cndmask_b32_dpp v86, v86, v86, vcc wave_shr:1 row_mask:0xf bank_mask:0xf
    v_cndmask_b32_dpp v87, v87, v87, vcc wave_shr:1 row_mask:0xf bank_mask:0xf
    s_andn2_b64 s[82:83], s[82:83], s[52:53]
    v_cndmask_b32_dpp v7, v7, v7, vcc wave_shr:1 row_mask:0xf bank_mask:0xf
    s_mov_b64 vcc, s[50:51]
    s_mov_b64 exec, s[50:51]
    s_cbranch_scc0 L2_d120
    s_mov_b64 exec, s[82:83]
    s_nop 1
    v_mfma_f32_4x4x4_16b_bf16 v[88:91], v[12:13], v[84:85], 0
    s_nop 1
    v_mfma_f32_4x4x4_16b_bf16 v[88:91], v[10:11], v[86:87], v[88:91]
    s_nop 4
    v_cvt_pk_bf16_f32 v88, v88, v89
    v_cvt_pk_bf16_f32 v89, v90, v91
    ds_pk_add_bf16 v7, v88 offset:65408
    ds_pk_add_bf16 v7, v89 offset:65412
    s_mov_b64 exec, vcc
    s_branch L2_d120
L2_c121:
    s_mov_b64 s[50:51], vcc
    s_lshl_b64 s[52:53], s[82:83], 1
    s_andn2_b64 s[52:53], s[52:53], s[80:81]
    s_andn2_b64 s[52:53], s[52:53], s[50:51]
    s_or_b64 s[80:81], s[80:81], s[52:53]
    s_not_b64 vcc, s[52:53]
    s_mov_b64 exec, -1
    v_cndmask_b32_dpp v84, v84, v84, vcc wave_shr:1 row_mask:0xf bank_mask:0xf
    v_cndmask_b32_dpp v85, v85, v85, vcc wave_shr:1 row_mask:0xf bank_mask:0xf
    s_lshr_b64 s[52:53], s[52:53], 1
    v_cndmask_b32_dpp v86, v86, v86, vcc wave_shr:1 row_mask:0xf bank_mask:0xf
    v_cndmask_b32_dpp v87, v87, v87, vcc wave_shr:1 row_mask:0xf bank_mask:0xf
    s_andn2_b64 s[82:83], s[82:83], s[52:53]
    v_cndmask_b32_dpp v7, v7, v7, vcc wave_shr:1 row_mask:0xf bank_mask:0xf
    s_mov_b64 vcc, s[50:51]
    s_mov_b64 exec, s[50:51]
    s_cbranch_scc0 L2_d121
    s_mov_b64 exec, s[82:83]
    s_nop 1
    v_mfma_f32_4x4x4_16b_bf16 v[88:91], v[12:13], v[84:85], 0
    s_nop 1
    v_mfma_f32_4x4x4_16b_bf16 v[88:91], v[10:11], v[86:87], v[88:91]
    s_nop 4
    v_cvt_pk_bf16_f32 v88, v88, v89
    v_cvt_pk_bf16_f32 v89, v90, v91
    ds_pk_add_bf16 v7, v88 offset:65408
    ds_pk_add_bf16 v7, v89 offset:65412
    s_mov_b64 exec, vcc
    s_branch L2_d121
L2_c122:
    s_mov_b64 s[50:51], vcc
    s_lshl_b64 s[52:53], s[82:83], 1
    s_andn2_b64 s[52:53], s[52:53], s[80:81]
    s_andn2_b64 s[52:53], s[52:53], s[50:51]
    s_or_b64 s[80:81], s[80:81], s[52:53]
    s_not_b64 vcc, s[52:53]
    s_mov_b64 exec, -1
    v_cndmask_b32_dpp v84, v84, v84, vcc wave_shr:1 row_mask:0xf bank_mask:0xf
    v_cndmask_b32_dpp v85, v85, v85, vcc wave_shr:1 row_mask:0xf bank_mask:0xf
    s_lshr_b64 s[52:53], s[52:53], 1
    v_cndmask_b32_dpp v86, v86, v86, vcc wave_shr:1 row_mask:0xf bank_mask:0xf
    v_cndmask_b32_dpp v87, v87, v87, vcc wave_shr:1 row_mask:0xf bank_mask:0xf
    s_andn2_b64 s[82:83], s[82:83], s[52:53]
    v_cndmask_b32_dpp v7, v7, v7, vcc wave_shr:1 row_mask:0xf bank_mask:0xf
    s_mov_b64 vcc, s[50:51]
    s_mov_b64 exec, s[50:51]
    s_cbranch_scc0 L2_d122
    s_mov_b64 exec, s[82:83]
    s_nop 1
    v_mfma_f32_4x4x4_16b_bf16 v[88:91], v[12:13], v[84:85], 0
    s_nop 1
    v_mfma_f32_4x4x4_16b_bf16 v[88:91], v[10:11], v[86:87], v[88:91]
    s_nop 4
    v_cvt_pk_bf16_f32 v88, v88, v89
    v_cvt_pk_bf16_f32 v89, v90, v91
    ds_pk_add_bf16 v7, v88 offset:65408
    ds_pk_add_bf16 v7, v89 offset:65412
    s_mov_b64 exec, vcc
    s_branch L2_d122
L2_c123:
    s_mov_b64 s[50:51], vcc
    s_lshl_b64 s[52:53], s[82:83], 1
    s_andn2_b64 s[52:53], s[52:53], s[80:81]
    s_andn2_b64 s[52:53], s[52:53], s[50:51]
    s_or_b64 s[80:81], s[80:81], s[52:53]
    s_not_b64 vcc, s[52:53]
    s_mov_b64 exec, -1
    v_cndmask_b32_dpp v84, v84, v84, vcc wave_shr:1 row_mask:0xf bank_mask:0xf
    v_cndmask_b32_dpp v85, v85, v85, vcc wave_shr:1 row_mask:0xf bank_mask:0xf
    s_lshr_b64 s[52:53], s[52:53], 1
    v_cndmask_b32_dpp v86, v86, v86, vcc wave_shr:1 row_mask:0xf bank_mask:0xf
    v_cndmask_b32_dpp v87, v87, v87, vcc wave_shr:1 row_mask:0xf bank_mask:0xf
    s_andn2_b64 s[82:83], s[82:83], s[52:53]
    v_cndmask_b32_dpp v7, v7, v7, vcc wave_shr:1 row_mask:0xf bank_mask:0xf
    s_mov_b64 vcc, s[50:51]
    s_mov_b64 exec, s[50:51]
    s_cbranch_scc0 L2_d123
    s_mov_b64 exec, s[82:83]
    s_nop 1
    v_mfma_f32_4x4x4_16b_bf16 v[88:91], v[12:13], v[84:85], 0
    s_nop 1
    v_mfma_f32_4x4x4_16b_bf16 v[88:91], v[10:11], v[86:87], v[88:91]
    s_nop 4
    v_cvt_pk_bf16_f32 v88, v88, v89
    v_cvt_pk_bf16_f32 v89, v90, v91
    ds_pk_add_bf16 v7, v88 offset:65408
    ds_pk_add_bf16 v7, v89 offset:65412
    s_mov_b64 exec, vcc
    s_branch L2_d123
L2_c124:
    s_mov_b64 s[50:51], vcc
    s_lshl_b64 s[52:53], s[82:83], 1
    s_andn2_b64 s[52:53], s[52:53], s[80:81]
    s_andn2_b64 s[52:53], s[52:53], s[50:51]
    s_or_b64 s[80:81], s[80:81], s[52:53]
    s_not_b64 vcc, s[52:53]
    s_mov_b64 exec, -1
    v_cndmask_b32_dpp v84, v84, v84, vcc wave_shr:1 row_mask:0xf bank_mask:0xf
    v_cndmask_b32_dpp v85, v85, v85, vcc wave_shr:1 row_mask:0xf bank_mask:0xf
    s_lshr_b64 s[52:53], s[52:53], 1
    v_cndmask_b32_dpp v86, v86, v86, vcc wave_shr:1 row_mask:0xf bank_mask:0xf
    v_cndmask_b32_dpp v87, v87, v87, vcc wave_shr:1 row_mask:0xf bank_mask:0xf
    s_andn2_b64 s[82:83], s[82:83], s[52:53]
    v_cndmask_b32_dpp v7, v7, v7, vcc wave_shr:1 row_mask:0xf bank_mask:0xf
    s_mov_b64 vcc, s[50:51]
    s_mov_b64 exec, s[50:51]
    s_cbranch_scc0 L2_d124
    s_mov_b64 exec, s[82:83]
    s_nop 1
    v_mfma_f32_4x4x4_16b_bf16 v[88:91], v[12:13], v[84:85], 0
    s_nop 1
    v_mfma_f32_4x4x4_16b_bf16 v[88:91], v[10:11], v[86:87], v[88:91]
    s_nop 4
    v_cvt_pk_bf16_f32 v88, v88, v89
    v_cvt_pk_bf16_f32 v89, v90, v91
    ds_pk_add_bf16 v7, v88 offset:65408
    ds_pk_add_bf16 v7, v89 offset:65412
    s_mov_b64 exec, vcc
    s_branch L2_d124
L2_c125:
    s_mov_b64 s[50:51], vcc
    s_lshl_b64 s[52:53], s[82:83], 1
    s_andn2_b64 s[52:53], s[52:53], s[80:81]
    s_andn2_b64 s[52:53], s[52:53], s[50:51]
    s_or_b64 s[80:81], s[80:81], s[52:53]
    s_not_b64 vcc, s[52:53]
    s_mov_b64 exec, -1
    v_cndmask_b32_dpp v84, v84, v84, vcc wave_shr:1 row_mask:0xf bank_mask:0xf
    v_cndmask_b32_dpp v85, v85, v85, vcc wave_shr:1 row_mask:0xf bank_mask:0xf
    s_lshr_b64 s[52:53], s[52:53], 1
    v_cndmask_b32_dpp v86, v86, v86, vcc wave_shr:1 row_mask:0xf bank_mask:0xf
    v_cndmask_b32_dpp v87, v87, v87, vcc wave_shr:1 row_mask:0xf bank_mask:0xf
    s_andn2_b64 s[82:83], s[82:83], s[52:53]
    v_cndmask_b32_dpp v7, v7, v7, vcc wave_shr:1 row_mask:0xf bank_mask:0xf
    s_mov_b64 vcc, s[50:51]
    s_mov_b64 exec, s[50:51]
    s_cbranch_scc0 L2_d125
    s_mov_b64 exec, s[82:83]
    s_nop 1
    v_mfma_f32_4x4x4_16b_bf16 v[88:91], v[12:13], v[84:85], 0
    s_nop 1
    v_mfma_f32_4x4x4_16b_bf16 v[88:91], v[10:11], v[86:87], v[88:91]
    s_nop 4
    v_cvt_pk_bf16_f32 v88, v88, v89
    v_cvt_pk_bf16_f32 v89, v90, v91
    ds_pk_add_bf16 v7, v88 offset:65408
    ds_pk_add_bf16 v7, v89 offset:65412
    s_mov_b64 exec, vcc
    s_branch L2_d125
L2_c126:
    s_mov_b64 s[50:51], vcc
    s_lshl_b64 s[52:53], s[82:83], 1
    s_andn2_b64 s[52:53], s[52:53], s[80:81]
    s_andn2_b64 s[52:53], s[52:53], s[50:51]
    s_or_b64 s[80:81], s[80:81], s[52:53]
    s_not_b64 vcc, s[52:53]
    s_mov_b64 exec, -1
    v_cndmask_b32_dpp v84, v84, v84, vcc wave_shr:1 row_mask:0xf bank_mask:0xf
    v_cndmask_b32_dpp v85, v85, v85, vcc wave_shr:1 row_mask:0xf bank_mask:0xf
    s_lshr_b64 s[52:53], s[52:53], 1
    v_cndmask_b32_dpp v86, v86, v86, vcc wave_shr:1 row_mask:0xf bank_mask:0xf
    v_cndmask_b32_dpp v87, v87, v87, vcc wave_shr:1 row_mask:0xf bank_mask:0xf
    s_andn2_b64 s[82:83], s[82:83], s[52:53]
    v_cndmask_b32_dpp v7, v7, v7, vcc wave_shr:1 row_mask:0xf bank_mask:0xf
    s_mov_b64 vcc, s[50:51]
    s_mov_b64 exec, s[50:51]
    s_cbranch_scc0 L2_d126
    s_mov_b64 exec, s[82:83]
    s_nop 1
    v_mfma_f32_4x4x4_16b_bf16 v[88:91], v[12:13], v[84:85], 0
    s_nop 1
    v_mfma_f32_4x4x4_16b_bf16 v[88:91], v[10:11], v[86:87], v[88:91]
    s_nop 4
    v_cvt_pk_bf16_f32 v88, v88, v89
    v_cvt_pk_bf16_f32 v89, v90, v91
    ds_pk_add_bf16 v7, v88 offset:65408
    ds_pk_add_bf16 v7, v89 offset:65412
    s_mov_b64 exec, vcc
    s_branch L2_d126
L2_c127:
    s_mov_b64 s[50:51], vcc
    s_lshl_b64 s[52:53], s[82:83], 1
    s_andn2_b64 s[52:53], s[52:53], s[80:81]
    s_andn2_b64 s[52:53], s[52:53], s[50:51]
    s_or_b64 s[80:81], s[80:81], s[52:53]
    s_not_b64 vcc, s[52:53]
    s_mov_b64 exec, -1
    v_cndmask_b32_dpp v84, v84, v84, vcc wave_shr:1 row_mask:0xf bank_mask:0xf
    v_cndmask_b32_dpp v85, v85, v85, vcc wave_shr:1 row_mask:0xf bank_mask:0xf
    s_lshr_b64 s[52:53], s[52:53], 1
    v_cndmask_b32_dpp v86, v86, v86, vcc wave_shr:1 row_mask:0xf bank_mask:0xf
    v_cndmask_b32_dpp v87, v87, v87, vcc wave_shr:1 row_mask:0xf bank_mask:0xf
    s_andn2_b64 s[82:83], s[82:83], s[52:53]
    v_cndmask_b32_dpp v7, v7, v7, vcc wave_shr:1 row_mask:0xf bank_mask:0xf
    s_mov_b64 vcc, s[50:51]
    s_mov_b64 exec, s[50:51]
    s_cbranch_scc0 L2_d127
    s_mov_b64 exec, s[82:83]
    s_nop 1
    v_mfma_f32_4x4x4_16b_bf16 v[88:91], v[12:13], v[84:85], 0
    s_nop 1
    v_mfma_f32_4x4x4_16b_bf16 v[88:91], v[10:11], v[86:87], v[88:91]
    s_nop 4
    v_cvt_pk_bf16_f32 v88, v88, v89
    v_cvt_pk_bf16_f32 v89, v90, v91
    ds_pk_add_bf16 v7, v88 offset:65408
    ds_pk_add_bf16 v7, v89 offset:65412
    s_mov_b64 exec, vcc
    s_branch L2_d127
L2_c128:
    s_mov_b64 s[50:51], vcc
    s_lshl_b64 s[52:53], s[82:83], 1
    s_andn2_b64 s[52:53], s[52:53], s[80:81]
    s_andn2_b64 s[52:53], s[52:53], s[50:51]
    s_or_b64 s[80:81], s[80:81], s[52:53]
    s_not_b64 vcc, s[52:53]
    s_mov_b64 exec, -1
    v_cndmask_b32_dpp v84, v84, v84, vcc wave_shr:1 row_mask:0xf bank_mask:0xf
    v_cndmask_b32_dpp v85, v85, v85, vcc wave_shr:1 row_mask:0xf bank_mask:0xf
    s_lshr_b64 s[52:53], s[52:53], 1
    v_cndmask_b32_dpp v86, v86, v86, vcc wave_shr:1 row_mask:0xf bank_mask:0xf
    v_cndmask_b32_dpp v87, v87, v87, vcc wave_shr:1 row_mask:0xf bank_mask:0xf
    s_andn2_b64 s[82:83], s[82:83], s[52:53]
    v_cndmask_b32_dpp v7, v7, v7, vcc wave_shr:1 row_mask:0xf bank_mask:0xf
    s_mov_b64 vcc, s[50:51]
    s_mov_b64 exec, s[50:51]
    s_cbranch_scc0 L2_d128
    s_mov_b64 exec, s[82:83]
    s_nop 1
    v_mfma_f32_4x4x4_16b_bf16 v[88:91], v[12:13], v[84:85], 0
    s_nop 1
    v_mfma_f32_4x4x4_16b_bf16 v[88:91], v[10:11], v[86:87], v[88:91]
    s_nop 4
    v_cvt_pk_bf16_f32 v88, v88, v89
    v_cvt_pk_bf16_f32 v89, v90, v91
    ds_pk_add_bf16 v7, v88 offset:65408
    ds_pk_add_bf16 v7, v89 offset:65412
    s_mov_b64 exec, vcc
    s_branch L2_d128
L2_c129:
    s_mov_b64 s[50:51], vcc
    s_lshl_b64 s[52:53], s[82:83], 1
    s_andn2_b64 s[52:53], s[52:53], s[80:81]
    s_andn2_b64 s[52:53], s[52:53], s[50:51]
    s_or_b64 s[80:81], s[80:81], s[52:53]
    s_not_b64 vcc, s[52:53]
    s_mov_b64 exec, -1
    v_cndmask_b32_dpp v84, v84, v84, vcc wave_shr:1 row_mask:0xf bank_mask:0xf
    v_cndmask_b32_dpp v85, v85, v85, vcc wave_shr:1 row_mask:0xf bank_mask:0xf
    s_lshr_b64 s[52:53], s[52:53], 1
    v_cndmask_b32_dpp v86, v86, v86, vcc wave_shr:1 row_mask:0xf bank_mask:0xf
    v_cndmask_b32_dpp v87, v87, v87, vcc wave_shr:1 row_mask:0xf bank_mask:0xf
    s_andn2_b64 s[82:83], s[82:83], s[52:53]
    v_cndmask_b32_dpp v7, v7, v7, vcc wave_shr:1 row_mask:0xf bank_mask:0xf
    s_mov_b64 vcc, s[50:51]
    s_mov_b64 exec, s[50:51]
    s_cbranch_scc0 L2_d129
    s_mov_b64 exec, s[82:83]
    s_nop 1
    v_mfma_f32_4x4x4_16b_bf16 v[88:91], v[12:13], v[84:85], 0
    s_nop 1
    v_mfma_f32_4x4x4_16b_bf16 v[88:91], v[10:11], v[86:87], v[88:91]
    s_nop 4
    v_cvt_pk_bf16_f32 v88, v88, v89
    v_cvt_pk_bf16_f32 v89, v90, v91
    ds_pk_add_bf16 v7, v88 offset:65408
    ds_pk_add_bf16 v7, v89 offset:65412
    s_mov_b64 exec, vcc
    s_branch L2_d129
L2_c130:
    s_mov_b64 s[50:51], vcc
    s_lshl_b64 s[52:53], s[82:83], 1
    s_andn2_b64 s[52:53], s[52:53], s[80:81]
    s_andn2_b64 s[52:53], s[52:53], s[50:51]
    s_or_b64 s[80:81], s[80:81], s[52:53]
    s_not_b64 vcc, s[52:53]
    s_mov_b64 exec, -1
    v_cndmask_b32_dpp v84, v84, v84, vcc wave_shr:1 row_mask:0xf bank_mask:0xf
    v_cndmask_b32_dpp v85, v85, v85, vcc wave_shr:1 row_mask:0xf bank_mask:0xf
    s_lshr_b64 s[52:53], s[52:53], 1
    v_cndmask_b32_dpp v86, v86, v86, vcc wave_shr:1 row_mask:0xf bank_mask:0xf
    v_cndmask_b32_dpp v87, v87, v87, vcc wave_shr:1 row_mask:0xf bank_mask:0xf
    s_andn2_b64 s[82:83], s[82:83], s[52:53]
    v_cndmask_b32_dpp v7, v7, v7, vcc wave_shr:1 row_mask:0xf bank_mask:0xf
    s_mov_b64 vcc, s[50:51]
    s_mov_b64 exec, s[50:51]
    s_cbranch_scc0 L2_d130
    s_mov_b64 exec, s[82:83]
    s_nop 1
    v_mfma_f32_4x4x4_16b_bf16 v[88:91], v[12:13], v[84:85], 0
    s_nop 1
    v_mfma_f32_4x4x4_16b_bf16 v[88:91], v[10:11], v[86:87], v[88:91]
    s_nop 4
    v_cvt_pk_bf16_f32 v88, v88, v89
    v_cvt_pk_bf16_f32 v89, v90, v91
    ds_pk_add_bf16 v7, v88 offset:65408
    ds_pk_add_bf16 v7, v89 offset:65412
    s_mov_b64 exec, vcc
    s_branch L2_d130
L2_c131:
    s_mov_b64 s[50:51], vcc
    s_lshl_b64 s[52:53], s[82:83], 1
    s_andn2_b64 s[52:53], s[52:53], s[80:81]
    s_andn2_b64 s[52:53], s[52:53], s[50:51]
    s_or_b64 s[80:81], s[80:81], s[52:53]
    s_not_b64 vcc, s[52:53]
    s_mov_b64 exec, -1
    v_cndmask_b32_dpp v84, v84, v84, vcc wave_shr:1 row_mask:0xf bank_mask:0xf
    v_cndmask_b32_dpp v85, v85, v85, vcc wave_shr:1 row_mask:0xf bank_mask:0xf
    s_lshr_b64 s[52:53], s[52:53], 1
    v_cndmask_b32_dpp v86, v86, v86, vcc wave_shr:1 row_mask:0xf bank_mask:0xf
    v_cndmask_b32_dpp v87, v87, v87, vcc wave_shr:1 row_mask:0xf bank_mask:0xf
    s_andn2_b64 s[82:83], s[82:83], s[52:53]
    v_cndmask_b32_dpp v7, v7, v7, vcc wave_shr:1 row_mask:0xf bank_mask:0xf
    s_mov_b64 vcc, s[50:51]
    s_mov_b64 exec, s[50:51]
    s_cbranch_scc0 L2_d131
    s_mov_b64 exec, s[82:83]
    s_nop 1
    v_mfma_f32_4x4x4_16b_bf16 v[88:91], v[12:13], v[84:85], 0
    s_nop 1
    v_mfma_f32_4x4x4_16b_bf16 v[88:91], v[10:11], v[86:87], v[88:91]
    s_nop 4
    v_cvt_pk_bf16_f32 v88, v88, v89
    v_cvt_pk_bf16_f32 v89, v90, v91
    ds_pk_add_bf16 v7, v88 offset:65408
    ds_pk_add_bf16 v7, v89 offset:65412
    s_mov_b64 exec, vcc
    s_branch L2_d131
L2_c132:
    s_mov_b64 s[50:51], vcc
    s_lshl_b64 s[52:53], s[82:83], 1
    s_andn2_b64 s[52:53], s[52:53], s[80:81]
    s_andn2_b64 s[52:53], s[52:53], s[50:51]
    s_or_b64 s[80:81], s[80:81], s[52:53]
    s_not_b64 vcc, s[52:53]
    s_mov_b64 exec, -1
    v_cndmask_b32_dpp v84, v84, v84, vcc wave_shr:1 row_mask:0xf bank_mask:0xf
    v_cndmask_b32_dpp v85, v85, v85, vcc wave_shr:1 row_mask:0xf bank_mask:0xf
    s_lshr_b64 s[52:53], s[52:53], 1
    v_cndmask_b32_dpp v86, v86, v86, vcc wave_shr:1 row_mask:0xf bank_mask:0xf
    v_cndmask_b32_dpp v87, v87, v87, vcc wave_shr:1 row_mask:0xf bank_mask:0xf
    s_andn2_b64 s[82:83], s[82:83], s[52:53]
    v_cndmask_b32_dpp v7, v7, v7, vcc wave_shr:1 row_mask:0xf bank_mask:0xf
    s_mov_b64 vcc, s[50:51]
    s_mov_b64 exec, s[50:51]
    s_cbranch_scc0 L2_d132
    s_mov_b64 exec, s[82:83]
    s_nop 1
    v_mfma_f32_4x4x4_16b_bf16 v[88:91], v[12:13], v[84:85], 0
    s_nop 1
    v_mfma_f32_4x4x4_16b_bf16 v[88:91], v[10:11], v[86:87], v[88:91]
    s_nop 4
    v_cvt_pk_bf16_f32 v88, v88, v89
    v_cvt_pk_bf16_f32 v89, v90, v91
    ds_pk_add_bf16 v7, v88 offset:65408
    ds_pk_add_bf16 v7, v89 offset:65412
    s_mov_b64 exec, vcc
    s_branch L2_d132
L2_c133:
    s_mov_b64 s[50:51], vcc
    s_lshl_b64 s[52:53], s[82:83], 1
    s_andn2_b64 s[52:53], s[52:53], s[80:81]
    s_andn2_b64 s[52:53], s[52:53], s[50:51]
    s_or_b64 s[80:81], s[80:81], s[52:53]
    s_not_b64 vcc, s[52:53]
    s_mov_b64 exec, -1
    v_cndmask_b32_dpp v84, v84, v84, vcc wave_shr:1 row_mask:0xf bank_mask:0xf
    v_cndmask_b32_dpp v85, v85, v85, vcc wave_shr:1 row_mask:0xf bank_mask:0xf
    s_lshr_b64 s[52:53], s[52:53], 1
    v_cndmask_b32_dpp v86, v86, v86, vcc wave_shr:1 row_mask:0xf bank_mask:0xf
    v_cndmask_b32_dpp v87, v87, v87, vcc wave_shr:1 row_mask:0xf bank_mask:0xf
    s_andn2_b64 s[82:83], s[82:83], s[52:53]
    v_cndmask_b32_dpp v7, v7, v7, vcc wave_shr:1 row_mask:0xf bank_mask:0xf
    s_mov_b64 vcc, s[50:51]
    s_mov_b64 exec, s[50:51]
    s_cbranch_scc0 L2_d133
    s_mov_b64 exec, s[82:83]
    s_nop 1
    v_mfma_f32_4x4x4_16b_bf16 v[88:91], v[12:13], v[84:85], 0
    s_nop 1
    v_mfma_f32_4x4x4_16b_bf16 v[88:91], v[10:11], v[86:87], v[88:91]
    s_nop 4
    v_cvt_pk_bf16_f32 v88, v88, v89
    v_cvt_pk_bf16_f32 v89, v90, v91
    ds_pk_add_bf16 v7, v88 offset:65408
    ds_pk_add_bf16 v7, v89 offset:65412
    s_mov_b64 exec, vcc
    s_branch L2_d133
L2_c134:
    s_mov_b64 s[50:51], vcc
    s_lshl_b64 s[52:53], s[82:83], 1
    s_andn2_b64 s[52:53], s[52:53], s[80:81]
    s_andn2_b64 s[52:53], s[52:53], s[50:51]
    s_or_b64 s[80:81], s[80:81], s[52:53]
    s_not_b64 vcc, s[52:53]
    s_mov_b64 exec, -1
    v_cndmask_b32_dpp v84, v84, v84, vcc wave_shr:1 row_mask:0xf bank_mask:0xf
    v_cndmask_b32_dpp v85, v85, v85, vcc wave_shr:1 row_mask:0xf bank_mask:0xf
    s_lshr_b64 s[52:53], s[52:53], 1
    v_cndmask_b32_dpp v86, v86, v86, vcc wave_shr:1 row_mask:0xf bank_mask:0xf
    v_cndmask_b32_dpp v87, v87, v87, vcc wave_shr:1 row_mask:0xf bank_mask:0xf
    s_andn2_b64 s[82:83], s[82:83], s[52:53]
    v_cndmask_b32_dpp v7, v7, v7, vcc wave_shr:1 row_mask:0xf bank_mask:0xf
    s_mov_b64 vcc, s[50:51]
    s_mov_b64 exec, s[50:51]
    s_cbranch_scc0 L2_d134
    s_mov_b64 exec, s[82:83]
    s_nop 1
    v_mfma_f32_4x4x4_16b_bf16 v[88:91], v[12:13], v[84:85], 0
    s_nop 1
    v_mfma_f32_4x4x4_16b_bf16 v[88:91], v[10:11], v[86:87], v[88:91]
    s_nop 4
    v_cvt_pk_bf16_f32 v88, v88, v89
    v_cvt_pk_bf16_f32 v89, v90, v91
    ds_pk_add_bf16 v7, v88 offset:65408
    ds_pk_add_bf16 v7, v89 offset:65412
    s_mov_b64 exec, vcc
    s_branch L2_d134
L2_c135:
    s_mov_b64 s[50:51], vcc
    s_lshl_b64 s[52:53], s[82:83], 1
    s_andn2_b64 s[52:53], s[52:53], s[80:81]
    s_andn2_b64 s[52:53], s[52:53], s[50:51]
    s_or_b64 s[80:81], s[80:81], s[52:53]
    s_not_b64 vcc, s[52:53]
    s_mov_b64 exec, -1
    v_cndmask_b32_dpp v84, v84, v84, vcc wave_shr:1 row_mask:0xf bank_mask:0xf
    v_cndmask_b32_dpp v85, v85, v85, vcc wave_shr:1 row_mask:0xf bank_mask:0xf
    s_lshr_b64 s[52:53], s[52:53], 1
    v_cndmask_b32_dpp v86, v86, v86, vcc wave_shr:1 row_mask:0xf bank_mask:0xf
    v_cndmask_b32_dpp v87, v87, v87, vcc wave_shr:1 row_mask:0xf bank_mask:0xf
    s_andn2_b64 s[82:83], s[82:83], s[52:53]
    v_cndmask_b32_dpp v7, v7, v7, vcc wave_shr:1 row_mask:0xf bank_mask:0xf
    s_mov_b64 vcc, s[50:51]
    s_mov_b64 exec, s[50:51]
    s_cbranch_scc0 L2_d135
    s_mov_b64 exec, s[82:83]
    s_nop 1
    v_mfma_f32_4x4x4_16b_bf16 v[88:91], v[12:13], v[84:85], 0
    s_nop 1
    v_mfma_f32_4x4x4_16b_bf16 v[88:91], v[10:11], v[86:87], v[88:91]
    s_nop 4
    v_cvt_pk_bf16_f32 v88, v88, v89
    v_cvt_pk_bf16_f32 v89, v90, v91
    ds_pk_add_bf16 v7, v88 offset:65408
    ds_pk_add_bf16 v7, v89 offset:65412
    s_mov_b64 exec, vcc
    s_branch L2_d135
L2_c136:
    s_mov_b64 s[50:51], vcc
    s_lshl_b64 s[52:53], s[82:83], 1
    s_andn2_b64 s[52:53], s[52:53], s[80:81]
    s_andn2_b64 s[52:53], s[52:53], s[50:51]
    s_or_b64 s[80:81], s[80:81], s[52:53]
    s_not_b64 vcc, s[52:53]
    s_mov_b64 exec, -1
    v_cndmask_b32_dpp v84, v84, v84, vcc wave_shr:1 row_mask:0xf bank_mask:0xf
    v_cndmask_b32_dpp v85, v85, v85, vcc wave_shr:1 row_mask:0xf bank_mask:0xf
    s_lshr_b64 s[52:53], s[52:53], 1
    v_cndmask_b32_dpp v86, v86, v86, vcc wave_shr:1 row_mask:0xf bank_mask:0xf
    v_cndmask_b32_dpp v87, v87, v87, vcc wave_shr:1 row_mask:0xf bank_mask:0xf
    s_andn2_b64 s[82:83], s[82:83], s[52:53]
    v_cndmask_b32_dpp v7, v7, v7, vcc wave_shr:1 row_mask:0xf bank_mask:0xf
    s_mov_b64 vcc, s[50:51]
    s_mov_b64 exec, s[50:51]
    s_cbranch_scc0 L2_d136
    s_mov_b64 exec, s[82:83]
    s_nop 1
    v_mfma_f32_4x4x4_16b_bf16 v[88:91], v[12:13], v[84:85], 0
    s_nop 1
    v_mfma_f32_4x4x4_16b_bf16 v[88:91], v[10:11], v[86:87], v[88:91]
    s_nop 4
    v_cvt_pk_bf16_f32 v88, v88, v89
    v_cvt_pk_bf16_f32 v89, v90, v91
    ds_pk_add_bf16 v7, v88 offset:65408
    ds_pk_add_bf16 v7, v89 offset:65412
    s_mov_b64 exec, vcc
    s_branch L2_d136
L2_c137:
    s_mov_b64 s[50:51], vcc
    s_lshl_b64 s[52:53], s[82:83], 1
    s_andn2_b64 s[52:53], s[52:53], s[80:81]
    s_andn2_b64 s[52:53], s[52:53], s[50:51]
    s_or_b64 s[80:81], s[80:81], s[52:53]
    s_not_b64 vcc, s[52:53]
    s_mov_b64 exec, -1
    v_cndmask_b32_dpp v84, v84, v84, vcc wave_shr:1 row_mask:0xf bank_mask:0xf
    v_cndmask_b32_dpp v85, v85, v85, vcc wave_shr:1 row_mask:0xf bank_mask:0xf
    s_lshr_b64 s[52:53], s[52:53], 1
    v_cndmask_b32_dpp v86, v86, v86, vcc wave_shr:1 row_mask:0xf bank_mask:0xf
    v_cndmask_b32_dpp v87, v87, v87, vcc wave_shr:1 row_mask:0xf bank_mask:0xf
    s_andn2_b64 s[82:83], s[82:83], s[52:53]
    v_cndmask_b32_dpp v7, v7, v7, vcc wave_shr:1 row_mask:0xf bank_mask:0xf
    s_mov_b64 vcc, s[50:51]
    s_mov_b64 exec, s[50:51]
    s_cbranch_scc0 L2_d137
    s_mov_b64 exec, s[82:83]
    s_nop 1
    v_mfma_f32_4x4x4_16b_bf16 v[88:91], v[12:13], v[84:85], 0
    s_nop 1
    v_mfma_f32_4x4x4_16b_bf16 v[88:91], v[10:11], v[86:87], v[88:91]
    s_nop 4
    v_cvt_pk_bf16_f32 v88, v88, v89
    v_cvt_pk_bf16_f32 v89, v90, v91
    ds_pk_add_bf16 v7, v88 offset:65408
    ds_pk_add_bf16 v7, v89 offset:65412
    s_mov_b64 exec, vcc
    s_branch L2_d137
L2_c138:
    s_mov_b64 s[50:51], vcc
    s_lshl_b64 s[52:53], s[82:83], 1
    s_andn2_b64 s[52:53], s[52:53], s[80:81]
    s_andn2_b64 s[52:53], s[52:53], s[50:51]
    s_or_b64 s[80:81], s[80:81], s[52:53]
    s_not_b64 vcc, s[52:53]
    s_mov_b64 exec, -1
    v_cndmask_b32_dpp v84, v84, v84, vcc wave_shr:1 row_mask:0xf bank_mask:0xf
    v_cndmask_b32_dpp v85, v85, v85, vcc wave_shr:1 row_mask:0xf bank_mask:0xf
    s_lshr_b64 s[52:53], s[52:53], 1
    v_cndmask_b32_dpp v86, v86, v86, vcc wave_shr:1 row_mask:0xf bank_mask:0xf
    v_cndmask_b32_dpp v87, v87, v87, vcc wave_shr:1 row_mask:0xf bank_mask:0xf
    s_andn2_b64 s[82:83], s[82:83], s[52:53]
    v_cndmask_b32_dpp v7, v7, v7, vcc wave_shr:1 row_mask:0xf bank_mask:0xf
    s_mov_b64 vcc, s[50:51]
    s_mov_b64 exec, s[50:51]
    s_cbranch_scc0 L2_d138
    s_mov_b64 exec, s[82:83]
    s_nop 1
    v_mfma_f32_4x4x4_16b_bf16 v[88:91], v[12:13], v[84:85], 0
    s_nop 1
    v_mfma_f32_4x4x4_16b_bf16 v[88:91], v[10:11], v[86:87], v[88:91]
    s_nop 4
    v_cvt_pk_bf16_f32 v88, v88, v89
    v_cvt_pk_bf16_f32 v89, v90, v91
    ds_pk_add_bf16 v7, v88 offset:65408
    ds_pk_add_bf16 v7, v89 offset:65412
    s_mov_b64 exec, vcc
    s_branch L2_d138
L2_c139:
    s_mov_b64 s[50:51], vcc
    s_lshl_b64 s[52:53], s[82:83], 1
    s_andn2_b64 s[52:53], s[52:53], s[80:81]
    s_andn2_b64 s[52:53], s[52:53], s[50:51]
    s_or_b64 s[80:81], s[80:81], s[52:53]
    s_not_b64 vcc, s[52:53]
    s_mov_b64 exec, -1
    v_cndmask_b32_dpp v84, v84, v84, vcc wave_shr:1 row_mask:0xf bank_mask:0xf
    v_cndmask_b32_dpp v85, v85, v85, vcc wave_shr:1 row_mask:0xf bank_mask:0xf
    s_lshr_b64 s[52:53], s[52:53], 1
    v_cndmask_b32_dpp v86, v86, v86, vcc wave_shr:1 row_mask:0xf bank_mask:0xf
    v_cndmask_b32_dpp v87, v87, v87, vcc wave_shr:1 row_mask:0xf bank_mask:0xf
    s_andn2_b64 s[82:83], s[82:83], s[52:53]
    v_cndmask_b32_dpp v7, v7, v7, vcc wave_shr:1 row_mask:0xf bank_mask:0xf
    s_mov_b64 vcc, s[50:51]
    s_mov_b64 exec, s[50:51]
    s_cbranch_scc0 L2_d139
    s_mov_b64 exec, s[82:83]
    s_nop 1
    v_mfma_f32_4x4x4_16b_bf16 v[88:91], v[12:13], v[84:85], 0
    s_nop 1
    v_mfma_f32_4x4x4_16b_bf16 v[88:91], v[10:11], v[86:87], v[88:91]
    s_nop 4
    v_cvt_pk_bf16_f32 v88, v88, v89
    v_cvt_pk_bf16_f32 v89, v90, v91
    ds_pk_add_bf16 v7, v88 offset:65408
    ds_pk_add_bf16 v7, v89 offset:65412
    s_mov_b64 exec, vcc
    s_branch L2_d139
L2_c140:
    s_mov_b64 s[50:51], vcc
    s_lshl_b64 s[52:53], s[82:83], 1
    s_andn2_b64 s[52:53], s[52:53], s[80:81]
    s_andn2_b64 s[52:53], s[52:53], s[50:51]
    s_or_b64 s[80:81], s[80:81], s[52:53]
    s_not_b64 vcc, s[52:53]
    s_mov_b64 exec, -1
    v_cndmask_b32_dpp v84, v84, v84, vcc wave_shr:1 row_mask:0xf bank_mask:0xf
    v_cndmask_b32_dpp v85, v85, v85, vcc wave_shr:1 row_mask:0xf bank_mask:0xf
    s_lshr_b64 s[52:53], s[52:53], 1
    v_cndmask_b32_dpp v86, v86, v86, vcc wave_shr:1 row_mask:0xf bank_mask:0xf
    v_cndmask_b32_dpp v87, v87, v87, vcc wave_shr:1 row_mask:0xf bank_mask:0xf
    s_andn2_b64 s[82:83], s[82:83], s[52:53]
    v_cndmask_b32_dpp v7, v7, v7, vcc wave_shr:1 row_mask:0xf bank_mask:0xf
    s_mov_b64 vcc, s[50:51]
    s_mov_b64 exec, s[50:51]
    s_cbranch_scc0 L2_d140
    s_mov_b64 exec, s[82:83]
    s_nop 1
    v_mfma_f32_4x4x4_16b_bf16 v[88:91], v[12:13], v[84:85], 0
    s_nop 1
    v_mfma_f32_4x4x4_16b_bf16 v[88:91], v[10:11], v[86:87], v[88:91]
    s_nop 4
    v_cvt_pk_bf16_f32 v88, v88, v89
    v_cvt_pk_bf16_f32 v89, v90, v91
    ds_pk_add_bf16 v7, v88 offset:65408
    ds_pk_add_bf16 v7, v89 offset:65412
    s_mov_b64 exec, vcc
    s_branch L2_d140
L2_c141:
    s_mov_b64 s[50:51], vcc
    s_lshl_b64 s[52:53], s[82:83], 1
    s_andn2_b64 s[52:53], s[52:53], s[80:81]
    s_andn2_b64 s[52:53], s[52:53], s[50:51]
    s_or_b64 s[80:81], s[80:81], s[52:53]
    s_not_b64 vcc, s[52:53]
    s_mov_b64 exec, -1
    v_cndmask_b32_dpp v84, v84, v84, vcc wave_shr:1 row_mask:0xf bank_mask:0xf
    v_cndmask_b32_dpp v85, v85, v85, vcc wave_shr:1 row_mask:0xf bank_mask:0xf
    s_lshr_b64 s[52:53], s[52:53], 1
    v_cndmask_b32_dpp v86, v86, v86, vcc wave_shr:1 row_mask:0xf bank_mask:0xf
    v_cndmask_b32_dpp v87, v87, v87, vcc wave_shr:1 row_mask:0xf bank_mask:0xf
    s_andn2_b64 s[82:83], s[82:83], s[52:53]
    v_cndmask_b32_dpp v7, v7, v7, vcc wave_shr:1 row_mask:0xf bank_mask:0xf
    s_mov_b64 vcc, s[50:51]
    s_mov_b64 exec, s[50:51]
    s_cbranch_scc0 L2_d141
    s_mov_b64 exec, s[82:83]
    s_nop 1
    v_mfma_f32_4x4x4_16b_bf16 v[88:91], v[12:13], v[84:85], 0
    s_nop 1
    v_mfma_f32_4x4x4_16b_bf16 v[88:91], v[10:11], v[86:87], v[88:91]
    s_nop 4
    v_cvt_pk_bf16_f32 v88, v88, v89
    v_cvt_pk_bf16_f32 v89, v90, v91
    ds_pk_add_bf16 v7, v88 offset:65408
    ds_pk_add_bf16 v7, v89 offset:65412
    s_mov_b64 exec, vcc
    s_branch L2_d141
L2_c142:
    s_mov_b64 s[50:51], vcc
    s_lshl_b64 s[52:53], s[82:83], 1
    s_andn2_b64 s[52:53], s[52:53], s[80:81]
    s_andn2_b64 s[52:53], s[52:53], s[50:51]
    s_or_b64 s[80:81], s[80:81], s[52:53]
    s_not_b64 vcc, s[52:53]
    s_mov_b64 exec, -1
    v_cndmask_b32_dpp v84, v84, v84, vcc wave_shr:1 row_mask:0xf bank_mask:0xf
    v_cndmask_b32_dpp v85, v85, v85, vcc wave_shr:1 row_mask:0xf bank_mask:0xf
    s_lshr_b64 s[52:53], s[52:53], 1
    v_cndmask_b32_dpp v86, v86, v86, vcc wave_shr:1 row_mask:0xf bank_mask:0xf
    v_cndmask_b32_dpp v87, v87, v87, vcc wave_shr:1 row_mask:0xf bank_mask:0xf
    s_andn2_b64 s[82:83], s[82:83], s[52:53]
    v_cndmask_b32_dpp v7, v7, v7, vcc wave_shr:1 row_mask:0xf bank_mask:0xf
    s_mov_b64 vcc, s[50:51]
    s_mov_b64 exec, s[50:51]
    s_cbranch_scc0 L2_d142
    s_mov_b64 exec, s[82:83]
    s_nop 1
    v_mfma_f32_4x4x4_16b_bf16 v[88:91], v[12:13], v[84:85], 0
    s_nop 1
    v_mfma_f32_4x4x4_16b_bf16 v[88:91], v[10:11], v[86:87], v[88:91]
    s_nop 4
    v_cvt_pk_bf16_f32 v88, v88, v89
    v_cvt_pk_bf16_f32 v89, v90, v91
    ds_pk_add_bf16 v7, v88 offset:65408
    ds_pk_add_bf16 v7, v89 offset:65412
    s_mov_b64 exec, vcc
    s_branch L2_d142
L2_c143:
    s_mov_b64 s[50:51], vcc
    s_lshl_b64 s[52:53], s[82:83], 1
    s_andn2_b64 s[52:53], s[52:53], s[80:81]
    s_andn2_b64 s[52:53], s[52:53], s[50:51]
    s_or_b64 s[80:81], s[80:81], s[52:53]
    s_not_b64 vcc, s[52:53]
    s_mov_b64 exec, -1
    v_cndmask_b32_dpp v84, v84, v84, vcc wave_shr:1 row_mask:0xf bank_mask:0xf
    v_cndmask_b32_dpp v85, v85, v85, vcc wave_shr:1 row_mask:0xf bank_mask:0xf
    s_lshr_b64 s[52:53], s[52:53], 1
    v_cndmask_b32_dpp v86, v86, v86, vcc wave_shr:1 row_mask:0xf bank_mask:0xf
    v_cndmask_b32_dpp v87, v87, v87, vcc wave_shr:1 row_mask:0xf bank_mask:0xf
    s_andn2_b64 s[82:83], s[82:83], s[52:53]
    v_cndmask_b32_dpp v7, v7, v7, vcc wave_shr:1 row_mask:0xf bank_mask:0xf
    s_mov_b64 vcc, s[50:51]
    s_mov_b64 exec, s[50:51]
    s_cbranch_scc0 L2_d143
    s_mov_b64 exec, s[82:83]
    s_nop 1
    v_mfma_f32_4x4x4_16b_bf16 v[88:91], v[12:13], v[84:85], 0
    s_nop 1
    v_mfma_f32_4x4x4_16b_bf16 v[88:91], v[10:11], v[86:87], v[88:91]
    s_nop 4
    v_cvt_pk_bf16_f32 v88, v88, v89
    v_cvt_pk_bf16_f32 v89, v90, v91
    ds_pk_add_bf16 v7, v88 offset:65408
    ds_pk_add_bf16 v7, v89 offset:65412
    s_mov_b64 exec, vcc
    s_branch L2_d143
L2_c144:
    s_mov_b64 s[50:51], vcc
    s_lshl_b64 s[52:53], s[82:83], 1
    s_andn2_b64 s[52:53], s[52:53], s[80:81]
    s_andn2_b64 s[52:53], s[52:53], s[50:51]
    s_or_b64 s[80:81], s[80:81], s[52:53]
    s_not_b64 vcc, s[52:53]
    s_mov_b64 exec, -1
    v_cndmask_b32_dpp v84, v84, v84, vcc wave_shr:1 row_mask:0xf bank_mask:0xf
    v_cndmask_b32_dpp v85, v85, v85, vcc wave_shr:1 row_mask:0xf bank_mask:0xf
    s_lshr_b64 s[52:53], s[52:53], 1
    v_cndmask_b32_dpp v86, v86, v86, vcc wave_shr:1 row_mask:0xf bank_mask:0xf
    v_cndmask_b32_dpp v87, v87, v87, vcc wave_shr:1 row_mask:0xf bank_mask:0xf
    s_andn2_b64 s[82:83], s[82:83], s[52:53]
    v_cndmask_b32_dpp v7, v7, v7, vcc wave_shr:1 row_mask:0xf bank_mask:0xf
    s_mov_b64 vcc, s[50:51]
    s_mov_b64 exec, s[50:51]
    s_cbranch_scc0 L2_d144
    s_mov_b64 exec, s[82:83]
    s_nop 1
    v_mfma_f32_4x4x4_16b_bf16 v[88:91], v[12:13], v[84:85], 0
    s_nop 1
    v_mfma_f32_4x4x4_16b_bf16 v[88:91], v[10:11], v[86:87], v[88:91]
    s_nop 4
    v_cvt_pk_bf16_f32 v88, v88, v89
    v_cvt_pk_bf16_f32 v89, v90, v91
    ds_pk_add_bf16 v7, v88 offset:65408
    ds_pk_add_bf16 v7, v89 offset:65412
    s_mov_b64 exec, vcc
    s_branch L2_d144
L2_c145:
    s_mov_b64 s[50:51], vcc
    s_lshl_b64 s[52:53], s[82:83], 1
    s_andn2_b64 s[52:53], s[52:53], s[80:81]
    s_andn2_b64 s[52:53], s[52:53], s[50:51]
    s_or_b64 s[80:81], s[80:81], s[52:53]
    s_not_b64 vcc, s[52:53]
    s_mov_b64 exec, -1
    v_cndmask_b32_dpp v84, v84, v84, vcc wave_shr:1 row_mask:0xf bank_mask:0xf
    v_cndmask_b32_dpp v85, v85, v85, vcc wave_shr:1 row_mask:0xf bank_mask:0xf
    s_lshr_b64 s[52:53], s[52:53], 1
    v_cndmask_b32_dpp v86, v86, v86, vcc wave_shr:1 row_mask:0xf bank_mask:0xf
    v_cndmask_b32_dpp v87, v87, v87, vcc wave_shr:1 row_mask:0xf bank_mask:0xf
    s_andn2_b64 s[82:83], s[82:83], s[52:53]
    v_cndmask_b32_dpp v7, v7, v7, vcc wave_shr:1 row_mask:0xf bank_mask:0xf
    s_mov_b64 vcc, s[50:51]
    s_mov_b64 exec, s[50:51]
    s_cbranch_scc0 L2_d145
    s_mov_b64 exec, s[82:83]
    s_nop 1
    v_mfma_f32_4x4x4_16b_bf16 v[88:91], v[12:13], v[84:85], 0
    s_nop 1
    v_mfma_f32_4x4x4_16b_bf16 v[88:91], v[10:11], v[86:87], v[88:91]
    s_nop 4
    v_cvt_pk_bf16_f32 v88, v88, v89
    v_cvt_pk_bf16_f32 v89, v90, v91
    ds_pk_add_bf16 v7, v88 offset:65408
    ds_pk_add_bf16 v7, v89 offset:65412
    s_mov_b64 exec, vcc
    s_branch L2_d145
L2_c146:
    s_mov_b64 s[50:51], vcc
    s_lshl_b64 s[52:53], s[82:83], 1
    s_andn2_b64 s[52:53], s[52:53], s[80:81]
    s_andn2_b64 s[52:53], s[52:53], s[50:51]
    s_or_b64 s[80:81], s[80:81], s[52:53]
    s_not_b64 vcc, s[52:53]
    s_mov_b64 exec, -1
    v_cndmask_b32_dpp v84, v84, v84, vcc wave_shr:1 row_mask:0xf bank_mask:0xf
    v_cndmask_b32_dpp v85, v85, v85, vcc wave_shr:1 row_mask:0xf bank_mask:0xf
    s_lshr_b64 s[52:53], s[52:53], 1
    v_cndmask_b32_dpp v86, v86, v86, vcc wave_shr:1 row_mask:0xf bank_mask:0xf
    v_cndmask_b32_dpp v87, v87, v87, vcc wave_shr:1 row_mask:0xf bank_mask:0xf
    s_andn2_b64 s[82:83], s[82:83], s[52:53]
    v_cndmask_b32_dpp v7, v7, v7, vcc wave_shr:1 row_mask:0xf bank_mask:0xf
    s_mov_b64 vcc, s[50:51]
    s_mov_b64 exec, s[50:51]
    s_cbranch_scc0 L2_d146
    s_mov_b64 exec, s[82:83]
    s_nop 1
    v_mfma_f32_4x4x4_16b_bf16 v[88:91], v[12:13], v[84:85], 0
    s_nop 1
    v_mfma_f32_4x4x4_16b_bf16 v[88:91], v[10:11], v[86:87], v[88:91]
    s_nop 4
    v_cvt_pk_bf16_f32 v88, v88, v89
    v_cvt_pk_bf16_f32 v89, v90, v91
    ds_pk_add_bf16 v7, v88 offset:65408
    ds_pk_add_bf16 v7, v89 offset:65412
    s_mov_b64 exec, vcc
    s_branch L2_d146
.section .rodata,"a"
.p2align 6
.amdhsa_kernel gs_sort_kernel
  .amdhsa_next_free_vgpr 128
  .amdhsa_next_free_sgpr 96
  .amdhsa_accum_offset 128
  .amdhsa_group_segment_fixed_size 0
  .amdhsa_kernarg_size 112
  .amdhsa_user_sgpr_count 2
  .amdhsa_user_sgpr_kernarg_segment_ptr 1
  .amdhsa_system_sgpr_workgroup_id_x 1
  .amdhsa_float_denorm_mode_32 3
.end_amdhsa_kernel
.p2align 6
.amdhsa_kernel gs_acc_kernel
  .amdhsa_next_free_vgpr 128
  .amdhsa_next_free_sgpr 100
  .amdhsa_accum_offset 128
  .amdhsa_group_segment_fixed_size 0
  .amdhsa_kernarg_size 112
  .amdhsa_user_sgpr_count 2
  .amdhsa_user_sgpr_kernarg_segment_ptr 1
  .amdhsa_system_sgpr_workgroup_id_x 1
  .amdhsa_float_denorm_mode_32 3
.end_amdhsa_kernel
```

```asm
; @launch kernel=gs_sort_kernel grid=(256,1,1) block=(1024,1,1) lds=163840
; @launch kernel=gs_acc_kernel grid=(256,1,1) block=(1024,1,1) lds=163840
.amdgcn_target "amdgcn-amd-amdhsa--gfx950"
.text
.globl gs_sort_kernel
.p2align 8
.type gs_sort_kernel,@function
gs_sort_kernel:
    s_cmp_ge_u32 s2, 256
    s_cbranch_scc1 L1_end
    s_load_dwordx4 s[4:7], s[0:1], 8
    s_load_dwordx2 s[28:29], s[0:1], 32
    s_load_dwordx2 s[30:31], s[0:1], 104
    s_load_dwordx2 s[56:57], s[0:1], 96
    s_load_dwordx2 s[86:87], s[0:1], 0
    s_load_dwordx4 s[60:63], s[0:1], 56
    s_load_dwordx4 s[64:67], s[0:1], 72
    v_lshrrev_b32 v7, 6, v0
    v_lshlrev_b32 v1, 3, v0
    v_readfirstlane_b32 s32, v7
    v_lshlrev_b32 v0, 4, v0
    s_mul_i32 s33, s2, 16384
    s_mul_i32 s34, s2, 8192
    s_waitcnt lgkmcnt(0)
    s_mov_b32 s8, s4
    s_mov_b32 s9, s5
    s_mov_b32 s10, 0x9c40000
    s_mov_b32 s11, 0x20000
    s_mov_b32 s12, s6
    s_mov_b32 s13, s7
    s_mov_b32 s14, 0x9c40000
    s_mov_b32 s15, 0x20000
    s_mov_b32 s16, s28
    s_mov_b32 s17, s29
    s_mov_b32 s18, 0x4e20000
    s_mov_b32 s19, 0x20000
    s_add_u32 s44, s33, 0x0
    buffer_load_dwordx4 v[16:19], v0, s[8:11], s44 offen nt
    s_add_u32 s45, s33, 0x0
    buffer_load_dwordx4 v[20:23], v0, s[12:15], s45 offen nt
    s_add_u32 s46, s34, 0x0
    buffer_load_dwordx2 v[24:25], v1, s[16:19], s46 offen nt
    s_add_u32 s47, s34, 0x200000
    buffer_load_dwordx2 v[26:27], v1, s[16:19], s47 offen nt
    s_add_u32 s44, s33, 0x400000
    buffer_load_dwordx4 v[28:31], v0, s[8:11], s44 offen nt
    s_add_u32 s45, s33, 0x400000
    buffer_load_dwordx4 v[32:35], v0, s[12:15], s45 offen nt
    s_add_u32 s46, s33, 0x800000
    buffer_load_dwordx4 v[36:39], v0, s[8:11], s46 offen nt
    s_add_u32 s47, s33, 0x800000
    buffer_load_dwordx4 v[40:43], v0, s[12:15], s47 offen nt
    s_add_u32 s44, s34, 0x400000
    buffer_load_dwordx2 v[44:45], v1, s[16:19], s44 offen nt
    s_add_u32 s45, s34, 0x600000
    buffer_load_dwordx2 v[46:47], v1, s[16:19], s45 offen nt
    s_mov_b32 s68, s62
    s_mov_b32 s69, s63
    s_mov_b32 s70, 0x40
    s_mov_b32 s71, 0x20000
    s_mov_b32 s72, s60
    s_mov_b32 s73, s61
    s_mov_b32 s74, 0x40
    s_mov_b32 s75, 0x20000
    s_mov_b32 s20, s66
    s_mov_b32 s21, s67
    s_mov_b32 s22, 0x20
    s_mov_b32 s23, 0x20000
    s_mov_b32 s80, s64
    s_mov_b32 s81, s65
    s_mov_b32 s82, 0x20
    s_mov_b32 s83, 0x20000
    s_add_u32 s24, s30, 0xebc9000
    s_addc_u32 s25, s31, 0
    s_mov_b32 s26, 0x100
    s_mov_b32 s27, 0x20000
    v_lshrrev_b32 v2, 3, v0
    v_and_b32 v2, 6, v2
    v_lshlrev_b32 v3, 2, v0
    s_lshl_b32 s3, s32, 8
    s_add_u32 s3, s3, s2
    s_cmp_lg_u32 s3, 254
    s_cbranch_scc1 L1_wt
    buffer_load_ushort v96, v2, s[68:71], 0 offen offset:0
    buffer_load_ushort v108, v2, s[68:71], 0 offen offset:8
    buffer_load_ushort v97, v2, s[68:71], 0 offen offset:16
    buffer_load_ushort v109, v2, s[68:71], 0 offen offset:24
    buffer_load_ushort v98, v2, s[68:71], 0 offen offset:32
    buffer_load_ushort v110, v2, s[68:71], 0 offen offset:40
    buffer_load_ushort v99, v2, s[68:71], 0 offen offset:48
    buffer_load_ushort v111, v2, s[68:71], 0 offen offset:56
    buffer_load_ushort v100, v2, s[72:75], 0 offen offset:0
    buffer_load_ushort v112, v2, s[72:75], 0 offen offset:8
    buffer_load_ushort v101, v2, s[72:75], 0 offen offset:16
    buffer_load_ushort v113, v2, s[72:75], 0 offen offset:24
    buffer_load_ushort v102, v2, s[72:75], 0 offen offset:32
    buffer_load_ushort v114, v2, s[72:75], 0 offen offset:40
    buffer_load_ushort v103, v2, s[72:75], 0 offen offset:48
    buffer_load_ushort v115, v2, s[72:75], 0 offen offset:56
    buffer_load_ushort v104, v2, s[20:23], 0 offen offset:0
    buffer_load_ushort v116, v2, s[20:23], 0 offen offset:8
    buffer_load_ushort v105, v2, s[20:23], 0 offen offset:16
    buffer_load_ushort v117, v2, s[20:23], 0 offen offset:24
    buffer_load_ushort v106, v2, s[80:83], 0 offen offset:0
    buffer_load_ushort v118, v2, s[80:83], 0 offen offset:8
    buffer_load_ushort v107, v2, s[80:83], 0 offen offset:16
    buffer_load_ushort v119, v2, s[80:83], 0 offen offset:24
    s_waitcnt vmcnt(0)
    v_lshl_or_b32 v96, v108, 16, v96
    v_lshl_or_b32 v97, v109, 16, v97
    v_lshl_or_b32 v98, v110, 16, v98
    v_lshl_or_b32 v99, v111, 16, v99
    v_lshl_or_b32 v100, v112, 16, v100
    v_lshl_or_b32 v101, v113, 16, v101
    v_lshl_or_b32 v102, v114, 16, v102
    v_lshl_or_b32 v103, v115, 16, v103
    v_lshl_or_b32 v104, v116, 16, v104
    v_lshl_or_b32 v105, v117, 16, v105
    v_lshl_or_b32 v106, v118, 16, v106
    v_lshl_or_b32 v107, v119, 16, v107
    buffer_store_dwordx4 v[96:99], v3, s[24:27], 0 offen offset:0 sc1
    buffer_store_dwordx4 v[100:103], v3, s[24:27], 0 offen offset:16 sc1
    buffer_store_dwordx4 v[104:107], v3, s[24:27], 0 offen offset:32 sc1
L1_wt:
    s_mov_b32 s20, s30
    s_mov_b32 s21, s31
    s_mov_b32 s22, 0xd340000
    s_mov_b32 s23, 0x20000
    s_add_u32 s24, s30, 0x28000
    s_addc_u32 s25, s31, 0
    s_mov_b32 s26, 0xd318000
    s_mov_b32 s27, 0x20000
    s_mov_b32 s80, s86
    s_mov_b32 s81, s87
    s_mov_b32 s82, 0x4e2000
    s_mov_b32 s83, 0x20000
    s_mul_i32 s35, s2, 173056
    s_and_b32 s37, s32, 3
    s_lshl_b32 s37, s37, 3
    s_mov_b32 s36, s37
    s_lshr_b32 s37, s32, 2
    s_mul_i32 s37, s37, 2080
    s_add_u32 s36, s36, s37
    s_and_b32 s37, s2, 3
    s_lshl_b32 s37, s37, 5
    s_add_u32 s36, s36, s37
    s_mul_i32 s4, s2, 5
    s_add_u32 s4, s4, 8192
    s_lshl_b32 s38, s4, 14
    s_lshl_b32 s39, s4, 13
    v_mov_b32 v2, 1
    v_mov_b32 v4, 0x80000007
    v_mov_b32 v5, 0xfc
    v_mov_b32 v6, 0x78
    s_mov_b32 s40, 16512
    s_mov_b32 s55, -10000
    s_mov_b32 s41, 0x010c0c01
    s_mov_b32 s42, 0x030c0c03
    v_mov_b32 v8, 0
    v_mov_b32 v9, 0
    v_mov_b32 v10, 0
    v_mov_b32 v11, 0
    ds_write_b128 v0, v[8:11]
    s_add_u32 s68, s30, 0xebca000
    s_addc_u32 s69, s31, 0
    s_mov_b32 s70, 0x80
    s_mov_b32 s71, 0x20000
    s_lshl_b32 s3, s2, 7
    s_add_u32 s68, s68, s3
    s_addc_u32 s69, s69, 0
    s_cmp_lg_u32 s32, 0
    s_cbranch_scc1 L1_fl
    buffer_store_dwordx4 v[8:11], v0, s[68:71], 0 offen sc1
L1_fl:
    s_waitcnt lgkmcnt(0)
    s_barrier
    s_setprio 3
    s_add_u32 s46, s33, 0xc00000
    buffer_load_dwordx4 v[48:51], v0, s[8:11], s46 offen nt
    s_add_u32 s47, s33, 0xc00000
    buffer_load_dwordx4 v[52:55], v0, s[12:15], s47 offen nt
    s_waitcnt vmcnt(8)
    v_lshlrev_b32 v7, 16, v24
    v_and_b32 v8, 0xffff0000, v24
    v_lshlrev_b32 v9, 16, v25
    v_and_b32 v10, 0xffff0000, v25
    v_mul_f32 v7, 0.15915494, v7
    v_mul_f32 v8, 0.15915494, v8
    v_mul_f32 v9, 0.15915494, v9
    v_mul_f32 v10, 0.15915494, v10
    v_mul_hi_u32_u24 v14, 429497, v16
    v_lshrrev_b32 v12, 3, v20
    v_cos_f32 v7, v7
    v_lshlrev_b16 v13, 3, v20
    v_mad_i32_i24 v11, v14, s55, v16
    v_bitop3_b32 v12, v6, v13, v12 bitop3:0xca
    v_lshl_add_u32 v11, v11, 17, s40
    v_lshlrev_b16 v14, 8, v14
    v_lshrrev_b32 v13, 2, v20
    v_add_u32 v16, v12, v11
    v_bitop3_b32 v20, v5, v13, v14 bitop3:0xea
    ds_add_u32 v20, v2
    v_mul_hi_u32_u24 v14, 429497, v17
    v_lshrrev_b32 v12, 3, v21
    v_cos_f32 v8, v8
    v_lshlrev_b16 v13, 3, v21
    v_mad_i32_i24 v11, v14, s55, v17
    v_bitop3_b32 v12, v6, v13, v12 bitop3:0xca
    v_lshl_add_u32 v11, v11, 17, s40
    v_lshlrev_b16 v14, 8, v14
    v_lshrrev_b32 v13, 2, v21
    v_add_u32 v17, v12, v11
    v_bitop3_b32 v21, v5, v13, v14 bitop3:0xea
    ds_add_u32 v21, v2
    v_cvt_pk_bf16_f32 v24, v7, v8
    v_perm_b32 v12, v24, v24, s41
    v_bitop3_b32 v16, v4, v12, v16 bitop3:0xca
    v_perm_b32 v13, v24, v24, s42
    v_bitop3_b32 v17, v4, v13, v17 bitop3:0xca
    v_mul_hi_u32_u24 v14, 429497, v18
    v_lshrrev_b32 v12, 3, v22
    v_cos_f32 v9, v9
    v_lshlrev_b16 v13, 3, v22
    v_mad_i32_i24 v11, v14, s55, v18
    v_bitop3_b32 v12, v6, v13, v12 bitop3:0xca
    v_lshl_add_u32 v11, v11, 17, s40
    v_lshlrev_b16 v14, 8, v14
    v_lshrrev_b32 v13, 2, v22
    v_add_u32 v18, v12, v11
    v_bitop3_b32 v22, v5, v13, v14 bitop3:0xea
    ds_add_u32 v22, v2
    v_mul_hi_u32_u24 v14, 429497, v19
    v_lshrrev_b32 v12, 3, v23
    v_cos_f32 v10, v10
    v_lshlrev_b16 v13, 3, v23
    v_mad_i32_i24 v11, v14, s55, v19
    v_bitop3_b32 v12, v6, v13, v12 bitop3:0xca
    v_lshl_add_u32 v11, v11, 17, s40
    v_lshlrev_b16 v14, 8, v14
    v_lshrrev_b32 v13, 2, v23
    v_add_u32 v19, v12, v11
    v_bitop3_b32 v23, v5, v13, v14 bitop3:0xea
    ds_add_u32 v23, v2
    v_cvt_pk_bf16_f32 v25, v9, v10
    v_perm_b32 v12, v25, v25, s41
    v_bitop3_b32 v18, v4, v12, v18 bitop3:0xca
    v_perm_b32 v13, v25, v25, s42
    v_bitop3_b32 v19, v4, v13, v19 bitop3:0xca
    s_add_u32 s44, s33, 0x1000000
    buffer_load_dwordx4 v[56:59], v0, s[8:11], s44 offen nt
    s_add_u32 s45, s33, 0x1000000
    buffer_load_dwordx4 v[60:63], v0, s[12:15], s45 offen nt
    s_add_u32 s46, s34, 0x800000
    buffer_load_dwordx2 v[64:65], v1, s[16:19], s46 offen nt
    s_add_u32 s47, s34, 0xa00000
    buffer_load_dwordx2 v[66:67], v1, s[16:19], s47 offen nt
    s_waitcnt vmcnt(10)
    v_lshlrev_b32 v7, 16, v26
    v_and_b32 v8, 0xffff0000, v26
    v_lshlrev_b32 v9, 16, v27
    v_and_b32 v10, 0xffff0000, v27
    v_mul_f32 v7, 0.15915494, v7
    v_mul_f32 v8, 0.15915494, v8
    v_mul_f32 v9, 0.15915494, v9
    v_mul_f32 v10, 0.15915494, v10
    v_mul_hi_u32_u24 v14, 429497, v28
    v_lshrrev_b32 v12, 3, v32
    v_cos_f32 v7, v7
    v_lshlrev_b16 v13, 3, v32
    v_mad_i32_i24 v11, v14, s55, v28
    v_bitop3_b32 v12, v6, v13, v12 bitop3:0xca
    v_lshl_add_u32 v11, v11, 17, s40
    v_lshlrev_b16 v14, 8, v14
    v_lshrrev_b32 v13, 2, v32
    v_add_u32 v28, v12, v11
    v_bitop3_b32 v32, v5, v13, v14 bitop3:0xea
    ds_add_u32 v32, v2
    v_mul_hi_u32_u24 v14, 429497, v29
    v_lshrrev_b32 v12, 3, v33
    v_cos_f32 v8, v8
    v_lshlrev_b16 v13, 3, v33
    v_mad_i32_i24 v11, v14, s55, v29
    v_bitop3_b32 v12, v6, v13, v12 bitop3:0xca
    v_lshl_add_u32 v11, v11, 17, s40
    v_lshlrev_b16 v14, 8, v14
    v_lshrrev_b32 v13, 2, v33
    v_add_u32 v29, v12, v11
    v_bitop3_b32 v33, v5, v13, v14 bitop3:0xea
    ds_add_u32 v33, v2
    v_cvt_pk_bf16_f32 v26, v7, v8
    v_perm_b32 v12, v26, v26, s41
    v_bitop3_b32 v28, v4, v12, v28 bitop3:0xca
    v_perm_b32 v13, v26, v26, s42
    v_bitop3_b32 v29, v4, v13, v29 bitop3:0xca
    v_mul_hi_u32_u24 v14, 429497, v30
    v_lshrrev_b32 v12, 3, v34
    v_cos_f32 v9, v9
    v_lshlrev_b16 v13, 3, v34
    v_mad_i32_i24 v11, v14, s55, v30
    v_bitop3_b32 v12, v6, v13, v12 bitop3:0xca
    v_lshl_add_u32 v11, v11, 17, s40
    v_lshlrev_b16 v14, 8, v14
    v_lshrrev_b32 v13, 2, v34
    v_add_u32 v30, v12, v11
    v_bitop3_b32 v34, v5, v13, v14 bitop3:0xea
    ds_add_u32 v34, v2
    v_mul_hi_u32_u24 v14, 429497, v31
    v_lshrrev_b32 v12, 3, v35
    v_cos_f32 v10, v10
    v_lshlrev_b16 v13, 3, v35
    v_mad_i32_i24 v11, v14, s55, v31
    v_bitop3_b32 v12, v6, v13, v12 bitop3:0xca
    v_lshl_add_u32 v11, v11, 17, s40
    v_lshlrev_b16 v14, 8, v14
    v_lshrrev_b32 v13, 2, v35
    v_add_u32 v31, v12, v11
    v_bitop3_b32 v35, v5, v13, v14 bitop3:0xea
    ds_add_u32 v35, v2
    v_cvt_pk_bf16_f32 v27, v9, v10
    v_perm_b32 v12, v27, v27, s41
    v_bitop3_b32 v30, v4, v12, v30 bitop3:0xca
    v_perm_b32 v13, v27, v27, s42
    v_bitop3_b32 v31, v4, v13, v31 bitop3:0xca
    s_setprio 2
    s_add_u32 s44, s33, 0x1400000
    buffer_load_dwordx4 v[68:71], v0, s[8:11], s44 offen nt
    s_add_u32 s45, s33, 0x1400000
    buffer_load_dwordx4 v[72:75], v0, s[12:15], s45 offen nt
    s_waitcnt vmcnt(8)
    v_lshlrev_b32 v7, 16, v44
    v_and_b32 v8, 0xffff0000, v44
    v_lshlrev_b32 v9, 16, v45
    v_and_b32 v10, 0xffff0000, v45
    v_mul_f32 v7, 0.15915494, v7
    v_mul_f32 v8, 0.15915494, v8
    v_mul_f32 v9, 0.15915494, v9
    v_mul_f32 v10, 0.15915494, v10
    v_mul_hi_u32_u24 v14, 429497, v36
    v_lshrrev_b32 v12, 3, v40
    v_cos_f32 v7, v7
    v_lshlrev_b16 v13, 3, v40
    v_mad_i32_i24 v11, v14, s55, v36
    v_bitop3_b32 v12, v6, v13, v12 bitop3:0xca
    v_lshl_add_u32 v11, v11, 17, s40
    v_lshlrev_b16 v14, 8, v14
    v_lshrrev_b32 v13, 2, v40
    v_add_u32 v36, v12, v11
    v_bitop3_b32 v40, v5, v13, v14 bitop3:0xea
    ds_add_u32 v40, v2
    v_mul_hi_u32_u24 v14, 429497, v37
    v_lshrrev_b32 v12, 3, v41
    v_cos_f32 v8, v8
    v_lshlrev_b16 v13, 3, v41
    v_mad_i32_i24 v11, v14, s55, v37
    v_bitop3_b32 v12, v6, v13, v12 bitop3:0xca
    v_lshl_add_u32 v11, v11, 17, s40
    v_lshlrev_b16 v14, 8, v14
    v_lshrrev_b32 v13, 2, v41
    v_add_u32 v37, v12, v11
    v_bitop3_b32 v41, v5, v13, v14 bitop3:0xea
    ds_add_u32 v41, v2
    v_cvt_pk_bf16_f32 v44, v7, v8
    v_perm_b32 v12, v44, v44, s41
    v_bitop3_b32 v36, v4, v12, v36 bitop3:0xca
    v_perm_b32 v13, v44, v44, s42
    v_bitop3_b32 v37, v4, v13, v37 bitop3:0xca
    v_mul_hi_u32_u24 v14, 429497, v38
    v_lshrrev_b32 v12, 3, v42
    v_cos_f32 v9, v9
    v_lshlrev_b16 v13, 3, v42
    v_mad_i32_i24 v11, v14, s55, v38
    v_bitop3_b32 v12, v6, v13, v12 bitop3:0xca
    v_lshl_add_u32 v11, v11, 17, s40
    v_lshlrev_b16 v14, 8, v14
    v_lshrrev_b32 v13, 2, v42
    v_add_u32 v38, v12, v11
    v_bitop3_b32 v42, v5, v13, v14 bitop3:0xea
    ds_add_u32 v42, v2
    v_mul_hi_u32_u24 v14, 429497, v39
    v_lshrrev_b32 v12, 3, v43
    v_cos_f32 v10, v10
    v_lshlrev_b16 v13, 3, v43
    v_mad_i32_i24 v11, v14, s55, v39
    v_bitop3_b32 v12, v6, v13, v12 bitop3:0xca
    v_lshl_add_u32 v11, v11, 17, s40
    v_lshlrev_b16 v14, 8, v14
    v_lshrrev_b32 v13, 2, v43
    v_add_u32 v39, v12, v11
    v_bitop3_b32 v43, v5, v13, v14 bitop3:0xea
    ds_add_u32 v43, v2
    v_cvt_pk_bf16_f32 v45, v9, v10
    v_perm_b32 v12, v45, v45, s41
    v_bitop3_b32 v38, v4, v12, v38 bitop3:0xca
    v_perm_b32 v13, v45, v45, s42
    v_bitop3_b32 v39, v4, v13, v39 bitop3:0xca
    s_add_u32 s46, s33, 0x1800000
    buffer_load_dwordx4 v[76:79], v0, s[8:11], s46 offen nt
    s_add_u32 s47, s33, 0x1800000
    buffer_load_dwordx4 v[80:83], v0, s[12:15], s47 offen nt
    s_add_u32 s44, s34, 0xc00000
    buffer_load_dwordx2 v[84:85], v1, s[16:19], s44 offen nt
    s_add_u32 s45, s34, 0xe00000
    buffer_load_dwordx2 v[86:87], v1, s[16:19], s45 offen nt
    s_waitcnt vmcnt(10)
    v_lshlrev_b32 v7, 16, v46
    v_and_b32 v8, 0xffff0000, v46
    v_lshlrev_b32 v9, 16, v47
    v_and_b32 v10, 0xffff0000, v47
    v_mul_f32 v7, 0.15915494, v7
    v_mul_f32 v8, 0.15915494, v8
    v_mul_f32 v9, 0.15915494, v9
    v_mul_f32 v10, 0.15915494, v10
    v_mul_hi_u32_u24 v14, 429497, v48
    v_lshrrev_b32 v12, 3, v52
    v_cos_f32 v7, v7
    v_lshlrev_b16 v13, 3, v52
    v_mad_i32_i24 v11, v14, s55, v48
    v_bitop3_b32 v12, v6, v13, v12 bitop3:0xca
    v_lshl_add_u32 v11, v11, 17, s40
    v_lshlrev_b16 v14, 8, v14
    v_lshrrev_b32 v13, 2, v52
    v_add_u32 v48, v12, v11
    v_bitop3_b32 v52, v5, v13, v14 bitop3:0xea
    ds_add_u32 v52, v2
    v_mul_hi_u32_u24 v14, 429497, v49
    v_lshrrev_b32 v12, 3, v53
    v_cos_f32 v8, v8
    v_lshlrev_b16 v13, 3, v53
    v_mad_i32_i24 v11, v14, s55, v49
    v_bitop3_b32 v12, v6, v13, v12 bitop3:0xca
    v_lshl_add_u32 v11, v11, 17, s40
    v_lshlrev_b16 v14, 8, v14
    v_lshrrev_b32 v13, 2, v53
    v_add_u32 v49, v12, v11
    v_bitop3_b32 v53, v5, v13, v14 bitop3:0xea
    ds_add_u32 v53, v2
    v_cvt_pk_bf16_f32 v46, v7, v8
    v_perm_b32 v12, v46, v46, s41
    v_bitop3_b32 v48, v4, v12, v48 bitop3:0xca
    v_perm_b32 v13, v46, v46, s42
    v_bitop3_b32 v49, v4, v13, v49 bitop3:0xca
    v_mul_hi_u32_u24 v14, 429497, v50
    v_lshrrev_b32 v12, 3, v54
    v_cos_f32 v9, v9
    v_lshlrev_b16 v13, 3, v54
    v_mad_i32_i24 v11, v14, s55, v50
    v_bitop3_b32 v12, v6, v13, v12 bitop3:0xca
    v_lshl_add_u32 v11, v11, 17, s40
    v_lshlrev_b16 v14, 8, v14
    v_lshrrev_b32 v13, 2, v54
    v_add_u32 v50, v12, v11
    v_bitop3_b32 v54, v5, v13, v14 bitop3:0xea
    ds_add_u32 v54, v2
    v_mul_hi_u32_u24 v14, 429497, v51
    v_lshrrev_b32 v12, 3, v55
    v_cos_f32 v10, v10
    v_lshlrev_b16 v13, 3, v55
    v_mad_i32_i24 v11, v14, s55, v51
    v_bitop3_b32 v12, v6, v13, v12 bitop3:0xca
    v_lshl_add_u32 v11, v11, 17, s40
    v_lshlrev_b16 v14, 8, v14
    v_lshrrev_b32 v13, 2, v55
    v_add_u32 v51, v12, v11
    v_bitop3_b32 v55, v5, v13, v14 bitop3:0xea
    ds_add_u32 v55, v2
    v_cvt_pk_bf16_f32 v47, v9, v10
    v_perm_b32 v12, v47, v47, s41
    v_bitop3_b32 v50, v4, v12, v50 bitop3:0xca
    v_perm_b32 v13, v47, v47, s42
    v_bitop3_b32 v51, v4, v13, v51 bitop3:0xca
    s_setprio 1
    s_add_u32 s46, s33, 0x1c00000
    buffer_load_dwordx4 v[88:91], v0, s[8:11], s46 offen nt
    s_add_u32 s47, s33, 0x1c00000
    buffer_load_dwordx4 v[92:95], v0, s[12:15], s47 offen nt
    s_waitcnt vmcnt(8)
    v_lshlrev_b32 v7, 16, v64
    v_and_b32 v8, 0xffff0000, v64
    v_lshlrev_b32 v9, 16, v65
    v_and_b32 v10, 0xffff0000, v65
    v_mul_f32 v7, 0.15915494, v7
    v_mul_f32 v8, 0.15915494, v8
    v_mul_f32 v9, 0.15915494, v9
    v_mul_f32 v10, 0.15915494, v10
    v_mul_hi_u32_u24 v14, 429497, v56
    v_lshrrev_b32 v12, 3, v60
    v_cos_f32 v7, v7
    v_lshlrev_b16 v13, 3, v60
    v_mad_i32_i24 v11, v14, s55, v56
    v_bitop3_b32 v12, v6, v13, v12 bitop3:0xca
    v_lshl_add_u32 v11, v11, 17, s40
    v_lshlrev_b16 v14, 8, v14
    v_lshrrev_b32 v13, 2, v60
    v_add_u32 v56, v12, v11
    v_bitop3_b32 v60, v5, v13, v14 bitop3:0xea
    ds_add_u32 v60, v2
    v_mul_hi_u32_u24 v14, 429497, v57
    v_lshrrev_b32 v12, 3, v61
    v_cos_f32 v8, v8
    v_lshlrev_b16 v13, 3, v61
    v_mad_i32_i24 v11, v14, s55, v57
    v_bitop3_b32 v12, v6, v13, v12 bitop3:0xca
    v_lshl_add_u32 v11, v11, 17, s40
    v_lshlrev_b16 v14, 8, v14
    v_lshrrev_b32 v13, 2, v61
    v_add_u32 v57, v12, v11
    v_bitop3_b32 v61, v5, v13, v14 bitop3:0xea
    ds_add_u32 v61, v2
    v_cvt_pk_bf16_f32 v64, v7, v8
    v_perm_b32 v12, v64, v64, s41
    v_bitop3_b32 v56, v4, v12, v56 bitop3:0xca
    v_perm_b32 v13, v64, v64, s42
    v_bitop3_b32 v57, v4, v13, v57 bitop3:0xca
    v_mul_hi_u32_u24 v14, 429497, v58
    v_lshrrev_b32 v12, 3, v62
    v_cos_f32 v9, v9
    v_lshlrev_b16 v13, 3, v62
    v_mad_i32_i24 v11, v14, s55, v58
    v_bitop3_b32 v12, v6, v13, v12 bitop3:0xca
    v_lshl_add_u32 v11, v11, 17, s40
    v_lshlrev_b16 v14, 8, v14
    v_lshrrev_b32 v13, 2, v62
    v_add_u32 v58, v12, v11
    v_bitop3_b32 v62, v5, v13, v14 bitop3:0xea
    ds_add_u32 v62, v2
    v_mul_hi_u32_u24 v14, 429497, v59
    v_lshrrev_b32 v12, 3, v63
    v_cos_f32 v10, v10
    v_lshlrev_b16 v13, 3, v63
    v_mad_i32_i24 v11, v14, s55, v59
    v_bitop3_b32 v12, v6, v13, v12 bitop3:0xca
    v_lshl_add_u32 v11, v11, 17, s40
    v_lshlrev_b16 v14, 8, v14
    v_lshrrev_b32 v13, 2, v63
    v_add_u32 v59, v12, v11
    v_bitop3_b32 v63, v5, v13, v14 bitop3:0xea
    ds_add_u32 v63, v2
    v_cvt_pk_bf16_f32 v65, v9, v10
    v_perm_b32 v12, v65, v65, s41
    v_bitop3_b32 v58, v4, v12, v58 bitop3:0xca
    v_perm_b32 v13, v65, v65, s42
    v_bitop3_b32 v59, v4, v13, v59 bitop3:0xca
    s_add_u32 s44, s33, 0x2000000
    buffer_load_dwordx4 v[96:99], v0, s[8:11], s44 offen nt
    s_add_u32 s45, s33, 0x2000000
    buffer_load_dwordx4 v[100:103], v0, s[12:15], s45 offen nt
    s_add_u32 s46, s34, 0x1000000
    buffer_load_dwordx2 v[104:105], v1, s[16:19], s46 offen nt
    s_add_u32 s47, s34, 0x1200000
    buffer_load_dwordx2 v[106:107], v1, s[16:19], s47 offen nt
    s_waitcnt vmcnt(10)
    v_lshlrev_b32 v7, 16, v66
    v_and_b32 v8, 0xffff0000, v66
    v_lshlrev_b32 v9, 16, v67
    v_and_b32 v10, 0xffff0000, v67
    v_mul_f32 v7, 0.15915494, v7
    v_mul_f32 v8, 0.15915494, v8
    v_mul_f32 v9, 0.15915494, v9
    v_mul_f32 v10, 0.15915494, v10
    v_mul_hi_u32_u24 v14, 429497, v68
    v_lshrrev_b32 v12, 3, v72
    v_cos_f32 v7, v7
    v_lshlrev_b16 v13, 3, v72
    v_mad_i32_i24 v11, v14, s55, v68
    v_bitop3_b32 v12, v6, v13, v12 bitop3:0xca
    v_lshl_add_u32 v11, v11, 17, s40
    v_lshlrev_b16 v14, 8, v14
    v_lshrrev_b32 v13, 2, v72
    v_add_u32 v68, v12, v11
    v_bitop3_b32 v72, v5, v13, v14 bitop3:0xea
    ds_add_u32 v72, v2
    v_mul_hi_u32_u24 v14, 429497, v69
    v_lshrrev_b32 v12, 3, v73
    v_cos_f32 v8, v8
    v_lshlrev_b16 v13, 3, v73
    v_mad_i32_i24 v11, v14, s55, v69
    v_bitop3_b32 v12, v6, v13, v12 bitop3:0xca
    v_lshl_add_u32 v11, v11, 17, s40
    v_lshlrev_b16 v14, 8, v14
    v_lshrrev_b32 v13, 2, v73
    v_add_u32 v69, v12, v11
    v_bitop3_b32 v73, v5, v13, v14 bitop3:0xea
    ds_add_u32 v73, v2
    v_cvt_pk_bf16_f32 v66, v7, v8
    v_perm_b32 v12, v66, v66, s41
    v_bitop3_b32 v68, v4, v12, v68 bitop3:0xca
    v_perm_b32 v13, v66, v66, s42
    v_bitop3_b32 v69, v4, v13, v69 bitop3:0xca
    v_mul_hi_u32_u24 v14, 429497, v70
    v_lshrrev_b32 v12, 3, v74
    v_cos_f32 v9, v9
    v_lshlrev_b16 v13, 3, v74
    v_mad_i32_i24 v11, v14, s55, v70
    v_bitop3_b32 v12, v6, v13, v12 bitop3:0xca
    v_lshl_add_u32 v11, v11, 17, s40
    v_lshlrev_b16 v14, 8, v14
    v_lshrrev_b32 v13, 2, v74
    v_add_u32 v70, v12, v11
    v_bitop3_b32 v74, v5, v13, v14 bitop3:0xea
    ds_add_u32 v74, v2
    v_mul_hi_u32_u24 v14, 429497, v71
    v_lshrrev_b32 v12, 3, v75
    v_cos_f32 v10, v10
    v_lshlrev_b16 v13, 3, v75
    v_mad_i32_i24 v11, v14, s55, v71
    v_bitop3_b32 v12, v6, v13, v12 bitop3:0xca
    v_lshl_add_u32 v11, v11, 17, s40
    v_lshlrev_b16 v14, 8, v14
    v_lshrrev_b32 v13, 2, v75
    v_add_u32 v71, v12, v11
    v_bitop3_b32 v75, v5, v13, v14 bitop3:0xea
    ds_add_u32 v75, v2
    v_cvt_pk_bf16_f32 v67, v9, v10
    v_perm_b32 v12, v67, v67, s41
    v_bitop3_b32 v70, v4, v12, v70 bitop3:0xca
    v_perm_b32 v13, v67, v67, s42
    v_bitop3_b32 v71, v4, v13, v71 bitop3:0xca
    s_setprio 0
    s_add_u32 s44, s33, 0x2400000
    buffer_load_dwordx4 v[108:111], v0, s[8:11], s44 offen nt
    s_waitcnt vmcnt(7)
    v_lshlrev_b32 v7, 16, v84
    v_and_b32 v8, 0xffff0000, v84
    v_lshlrev_b32 v9, 16, v85
    v_and_b32 v10, 0xffff0000, v85
    v_mul_f32 v7, 0.15915494, v7
    v_mul_f32 v8, 0.15915494, v8
    v_mul_f32 v9, 0.15915494, v9
    v_mul_f32 v10, 0.15915494, v10
    v_mul_hi_u32_u24 v14, 429497, v76
    v_lshrrev_b32 v12, 3, v80
    v_cos_f32 v7, v7
    v_lshlrev_b16 v13, 3, v80
    v_mad_i32_i24 v11, v14, s55, v76
    v_bitop3_b32 v12, v6, v13, v12 bitop3:0xca
    v_lshl_add_u32 v11, v11, 17, s40
    v_lshlrev_b16 v14, 8, v14
    v_lshrrev_b32 v13, 2, v80
    v_add_u32 v76, v12, v11
    v_bitop3_b32 v80, v5, v13, v14 bitop3:0xea
    ds_add_u32 v80, v2
    v_mul_hi_u32_u24 v14, 429497, v77
    v_lshrrev_b32 v12, 3, v81
    v_cos_f32 v8, v8
    v_lshlrev_b16 v13, 3, v81
    v_mad_i32_i24 v11, v14, s55, v77
    v_bitop3_b32 v12, v6, v13, v12 bitop3:0xca
    v_lshl_add_u32 v11, v11, 17, s40
    v_lshlrev_b16 v14, 8, v14
    v_lshrrev_b32 v13, 2, v81
    v_add_u32 v77, v12, v11
    v_bitop3_b32 v81, v5, v13, v14 bitop3:0xea
    ds_add_u32 v81, v2
    v_cvt_pk_bf16_f32 v84, v7, v8
    v_perm_b32 v12, v84, v84, s41
    v_bitop3_b32 v76, v4, v12, v76 bitop3:0xca
    v_perm_b32 v13, v84, v84, s42
    v_bitop3_b32 v77, v4, v13, v77 bitop3:0xca
    v_mul_hi_u32_u24 v14, 429497, v78
    v_lshrrev_b32 v12, 3, v82
    v_cos_f32 v9, v9
    v_lshlrev_b16 v13, 3, v82
    v_mad_i32_i24 v11, v14, s55, v78
    v_bitop3_b32 v12, v6, v13, v12 bitop3:0xca
    v_lshl_add_u32 v11, v11, 17, s40
    v_lshlrev_b16 v14, 8, v14
    v_lshrrev_b32 v13, 2, v82
    v_add_u32 v78, v12, v11
    v_bitop3_b32 v82, v5, v13, v14 bitop3:0xea
    ds_add_u32 v82, v2
    v_mul_hi_u32_u24 v14, 429497, v79
    v_lshrrev_b32 v12, 3, v83
    v_cos_f32 v10, v10
    v_lshlrev_b16 v13, 3, v83
    v_mad_i32_i24 v11, v14, s55, v79
    v_bitop3_b32 v12, v6, v13, v12 bitop3:0xca
    v_lshl_add_u32 v11, v11, 17, s40
    v_lshlrev_b16 v14, 8, v14
    v_lshrrev_b32 v13, 2, v83
    v_add_u32 v79, v12, v11
    v_bitop3_b32 v83, v5, v13, v14 bitop3:0xea
    ds_add_u32 v83, v2
    v_cvt_pk_bf16_f32 v85, v9, v10
    v_perm_b32 v12, v85, v85, s41
    v_bitop3_b32 v78, v4, v12, v78 bitop3:0xca
    v_perm_b32 v13, v85, v85, s42
    v_bitop3_b32 v79, v4, v13, v79 bitop3:0xca
    s_waitcnt vmcnt(5)
    v_lshlrev_b32 v7, 16, v86
    v_and_b32 v8, 0xffff0000, v86
    v_lshlrev_b32 v9, 16, v87
    v_and_b32 v10, 0xffff0000, v87
    v_mul_f32 v7, 0.15915494, v7
    v_mul_f32 v8, 0.15915494, v8
    v_mul_f32 v9, 0.15915494, v9
    v_mul_f32 v10, 0.15915494, v10
    v_mul_hi_u32_u24 v14, 429497, v88
    v_lshrrev_b32 v12, 3, v92
    v_cos_f32 v7, v7
    v_lshlrev_b16 v13, 3, v92
    v_mad_i32_i24 v11, v14, s55, v88
    v_bitop3_b32 v12, v6, v13, v12 bitop3:0xca
    v_lshl_add_u32 v11, v11, 17, s40
    v_lshlrev_b16 v14, 8, v14
    v_lshrrev_b32 v13, 2, v92
    v_add_u32 v88, v12, v11
    v_bitop3_b32 v92, v5, v13, v14 bitop3:0xea
    ds_add_u32 v92, v2
    v_mul_hi_u32_u24 v14, 429497, v89
    v_lshrrev_b32 v12, 3, v93
    v_cos_f32 v8, v8
    v_lshlrev_b16 v13, 3, v93
    v_mad_i32_i24 v11, v14, s55, v89
    v_bitop3_b32 v12, v6, v13, v12 bitop3:0xca
    v_lshl_add_u32 v11, v11, 17, s40
    v_lshlrev_b16 v14, 8, v14
    v_lshrrev_b32 v13, 2, v93
    v_add_u32 v89, v12, v11
    v_bitop3_b32 v93, v5, v13, v14 bitop3:0xea
    ds_add_u32 v93, v2
    v_cvt_pk_bf16_f32 v86, v7, v8
    v_perm_b32 v12, v86, v86, s41
    v_bitop3_b32 v88, v4, v12, v88 bitop3:0xca
    v_perm_b32 v13, v86, v86, s42
    v_bitop3_b32 v89, v4, v13, v89 bitop3:0xca
    v_mul_hi_u32_u24 v14, 429497, v90
    v_lshrrev_b32 v12, 3, v94
    v_cos_f32 v9, v9
    v_lshlrev_b16 v13, 3, v94
    v_mad_i32_i24 v11, v14, s55, v90
    v_bitop3_b32 v12, v6, v13, v12 bitop3:0xca
    v_lshl_add_u32 v11, v11, 17, s40
    v_lshlrev_b16 v14, 8, v14
    v_lshrrev_b32 v13, 2, v94
    v_add_u32 v90, v12, v11
    v_bitop3_b32 v94, v5, v13, v14 bitop3:0xea
    ds_add_u32 v94, v2
    v_mul_hi_u32_u24 v14, 429497, v91
    v_lshrrev_b32 v12, 3, v95
    v_cos_f32 v10, v10
    v_lshlrev_b16 v13, 3, v95
    v_mad_i32_i24 v11, v14, s55, v91
    v_bitop3_b32 v12, v6, v13, v12 bitop3:0xca
    v_lshl_add_u32 v11, v11, 17, s40
    v_lshlrev_b16 v14, 8, v14
    v_lshrrev_b32 v13, 2, v95
    v_add_u32 v91, v12, v11
    v_bitop3_b32 v95, v5, v13, v14 bitop3:0xea
    ds_add_u32 v95, v2
    v_cvt_pk_bf16_f32 v87, v9, v10
    v_perm_b32 v12, v87, v87, s41
    v_bitop3_b32 v90, v4, v12, v90 bitop3:0xca
    v_perm_b32 v13, v87, v87, s42
    v_bitop3_b32 v91, v4, v13, v91 bitop3:0xca
    v_lshrrev_b32 v8, 2, v0
    v_and_b32 v7, 0x3c00, v0
    v_bitop3_b32 v7, v5, v8, v7 bitop3:0xea
    s_waitcnt lgkmcnt(0)
    s_barrier
    ds_read2st64_b32 v[8:9], v7 offset0:0 offset1:1
    ds_read2st64_b32 v[10:11], v7 offset0:2 offset1:3
    s_add_u32 s45, s33, 0x2400000
    buffer_load_dwordx4 v[112:115], v0, s[12:15], s45 offen nt
    s_waitcnt lgkmcnt(0)
    v_lshl_or_b32 v12, v9, 16, v8
    v_lshl_or_b32 v13, v11, 16, v10
    v_mov_b32 v14, v12
    v_mov_b32 v15, v13
    s_nop 0
    v_add_u32_dpp v14, v14, v14 row_shr:1 row_mask:0xf bank_mask:0xf bound_ctrl:1
    v_add_u32_dpp v15, v15, v15 row_shr:1 row_mask:0xf bank_mask:0xf bound_ctrl:1
    s_nop 0
    v_add_u32_dpp v14, v14, v14 row_shr:2 row_mask:0xf bank_mask:0xf bound_ctrl:1
    v_add_u32_dpp v15, v15, v15 row_shr:2 row_mask:0xf bank_mask:0xf bound_ctrl:1
    s_nop 0
    v_add_u32_dpp v14, v14, v14 row_shr:4 row_mask:0xf bank_mask:0xf bound_ctrl:1
    v_add_u32_dpp v15, v15, v15 row_shr:4 row_mask:0xf bank_mask:0xf bound_ctrl:1
    s_nop 0
    v_add_u32_dpp v14, v14, v14 row_shr:8 row_mask:0xf bank_mask:0xf bound_ctrl:1
    v_add_u32_dpp v15, v15, v15 row_shr:8 row_mask:0xf bank_mask:0xf bound_ctrl:1
    s_nop 0
    v_add_u32_dpp v14, v14, v14 row_bcast:15 row_mask:0xa bank_mask:0xf
    v_add_u32_dpp v15, v15, v15 row_bcast:15 row_mask:0xa bank_mask:0xf
    s_nop 0
    v_add_u32_dpp v14, v14, v14 row_bcast:31 row_mask:0xc bank_mask:0xf
    v_add_u32_dpp v15, v15, v15 row_bcast:31 row_mask:0xc bank_mask:0xf
    v_readlane_b32 s48, v14, 63
    v_readlane_b32 s49, v15, 63
    s_lshl_b32 s54, s32, 2
    v_mov_b32 v8, s54
    s_and_b32 s50, s48, 0xffff
    s_lshr_b32 s51, s48, 16
    s_and_b32 s52, s49, 0xffff
    s_lshr_b32 s53, s49, 16
    s_add_u32 s51, s51, s50
    s_add_u32 s52, s52, s51
    s_add_u32 s53, s53, s52
    v_mov_b32 v9, s53
    s_mov_b64 exec, 1
    ds_write_b32 v8, v9 offset:16384
    s_mov_b64 exec, -1
    v_and_b32 v8, 60, v7
    s_waitcnt lgkmcnt(0)
    s_barrier
    ds_read_b32 v9, v8 offset:16384
    s_waitcnt lgkmcnt(0)
    v_add_u32_dpp v9, v9, v9 row_shr:1 row_mask:0xf bank_mask:0xf bound_ctrl:1
    s_nop 1
    v_add_u32_dpp v9, v9, v9 row_shr:2 row_mask:0xf bank_mask:0xf bound_ctrl:1
    s_nop 1
    v_add_u32_dpp v9, v9, v9 row_shr:4 row_mask:0xf bank_mask:0xf bound_ctrl:1
    s_nop 1
    v_add_u32_dpp v9, v9, v9 row_shr:8 row_mask:0xf bank_mask:0xf bound_ctrl:1
    s_nop 0
    v_readlane_b32 s54, v9, s32
    s_sub_u32 s54, s54, s53
    s_add_u32 s50, s50, s54
    s_add_u32 s51, s51, s54
    s_add_u32 s52, s52, s54
    s_pack_ll_b32_b16 s48, s54, s50
    s_pack_ll_b32_b16 s49, s51, s52
    v_add_u32 v14, s48, v14
    v_add_u32 v15, s49, v15
    v_sub_u32 v12, v14, v12
    v_sub_u32 v13, v15, v13
    v_and_b32 v8, 0xffff, v12
    v_lshrrev_b32 v9, 16, v12
    v_and_b32 v10, 0xffff, v13
    v_lshrrev_b32 v11, 16, v13
    ds_write2st64_b32 v7, v8, v9 offset0:0 offset1:1
    ds_write2st64_b32 v7, v10, v11 offset0:2 offset1:3
    v_and_b32 v8, 0x3f0, v0
    v_lshl_add_u32 v8, v8, 1, s36
    ds_write_b64 v8, v[12:13] offset:20480
    s_bitset0_b64 exec, 63
    s_not_b64 exec, exec
    ds_write_b64 v8, v[14:15] offset:20512
    s_mov_b64 exec, -1
    s_waitcnt lgkmcnt(0)
    s_barrier
    s_setprio 3
    ds_add_rtn_u32 v20, v20, v2
    ds_add_rtn_u32 v21, v21, v2
    ds_add_rtn_u32 v22, v22, v2
    ds_add_rtn_u32 v23, v23, v2
    ds_read_b128 v[12:15], v0 offset:20480
    v_cmp_gt_u32 vcc, 8448, v0
    ds_add_rtn_u32 v32, v32, v2
    ds_add_rtn_u32 v33, v33, v2
    ds_add_rtn_u32 v34, v34, v2
    ds_add_rtn_u32 v35, v35, v2
    s_setprio 2
    ds_add_rtn_u32 v40, v40, v2
    ds_add_rtn_u32 v41, v41, v2
    ds_add_rtn_u32 v42, v42, v2
    ds_add_rtn_u32 v43, v43, v2
    s_waitcnt lgkmcnt(8)
    s_cbranch_vccz L1_p1
    s_add_u32 s46, s35, 0x0
    s_mov_b64 exec, vcc
    buffer_store_dwordx4 v[12:15], v0, s[24:27], s46 offen sc1
    s_mov_b64 exec, -1
L1_p1:
    s_add_u32 s47, s33, 0x2800000
    buffer_load_dwordx4 v[116:119], v0, s[8:11], s47 offen nt
    ds_add_rtn_u32 v52, v52, v2
    ds_add_rtn_u32 v53, v53, v2
    ds_add_rtn_u32 v54, v54, v2
    ds_add_rtn_u32 v55, v55, v2
    s_setprio 1
    ds_add_rtn_u32 v60, v60, v2
    ds_add_rtn_u32 v61, v61, v2
    ds_add_rtn_u32 v62, v62, v2
    ds_add_rtn_u32 v63, v63, v2
    ds_add_rtn_u32 v72, v72, v2
    ds_add_rtn_u32 v73, v73, v2
    ds_add_rtn_u32 v74, v74, v2
    ds_add_rtn_u32 v75, v75, v2
    s_add_u32 s44, s33, 0x2800000
    buffer_load_dwordx4 v[120:123], v0, s[12:15], s44 offen nt
    s_setprio 0
    ds_add_rtn_u32 v80, v80, v2
    ds_add_rtn_u32 v81, v81, v2
    ds_add_rtn_u32 v82, v82, v2
    ds_add_rtn_u32 v83, v83, v2
    ds_add_rtn_u32 v92, v92, v2
    ds_add_rtn_u32 v93, v93, v2
    ds_add_rtn_u32 v94, v94, v2
    ds_add_rtn_u32 v95, v95, v2
    s_waitcnt lgkmcnt(0)
    s_barrier
    s_setprio 3
    v_and_b32 v7, -4, v20
    v_lshl_add_u32 v8, v20, 2, v7
    ds_write_b32 v8, v16
    v_lshl_add_u32 v7, v7, 2, v20
    ds_write_b8 v7, v24 offset:16
    v_and_b32 v9, -4, v21
    v_lshl_add_u32 v10, v21, 2, v9
    ds_write_b32 v10, v17
    v_lshl_add_u32 v9, v9, 2, v21
    ds_write_b8_d16_hi v9, v24 offset:16
    v_and_b32 v7, -4, v22
    v_lshl_add_u32 v8, v22, 2, v7
    ds_write_b32 v8, v18
    v_lshl_add_u32 v7, v7, 2, v22
    ds_write_b8 v7, v25 offset:16
    v_and_b32 v9, -4, v23
    v_lshl_add_u32 v10, v23, 2, v9
    ds_write_b32 v10, v19
    v_lshl_add_u32 v9, v9, 2, v23
    ds_write_b8_d16_hi v9, v25 offset:16
    s_add_u32 s45, s34, 0x1400000
    buffer_load_dwordx2 v[124:125], v1, s[16:19], s45 offen nt
    s_add_u32 s46, s34, 0x1600000
    buffer_load_dwordx2 v[126:127], v1, s[16:19], s46 offen nt
    s_add_u32 s47, s33, 0x2c00000
    buffer_load_dwordx4 v[16:19], v0, s[8:11], s47 offen nt
    v_and_b32 v7, -4, v32
    v_lshl_add_u32 v8, v32, 2, v7
    ds_write_b32 v8, v28
    v_lshl_add_u32 v7, v7, 2, v32
    ds_write_b8 v7, v26 offset:16
    v_and_b32 v9, -4, v33
    v_lshl_add_u32 v10, v33, 2, v9
    ds_write_b32 v10, v29
    v_lshl_add_u32 v9, v9, 2, v33
    ds_write_b8_d16_hi v9, v26 offset:16
    v_and_b32 v7, -4, v34
    v_lshl_add_u32 v8, v34, 2, v7
    ds_write_b32 v8, v30
    v_lshl_add_u32 v7, v7, 2, v34
    ds_write_b8 v7, v27 offset:16
    v_and_b32 v9, -4, v35
    v_lshl_add_u32 v10, v35, 2, v9
    ds_write_b32 v10, v31
    v_lshl_add_u32 v9, v9, 2, v35
    ds_write_b8_d16_hi v9, v27 offset:16
    s_add_u32 s44, s33, 0x2c00000
    buffer_load_dwordx4 v[20:23], v0, s[12:15], s44 offen nt
    s_setprio 2
    v_and_b32 v7, -4, v40
    v_lshl_add_u32 v8, v40, 2, v7
    ds_write_b32 v8, v36
    v_lshl_add_u32 v7, v7, 2, v40
    ds_write_b8 v7, v44 offset:16
    v_and_b32 v9, -4, v41
    v_lshl_add_u32 v10, v41, 2, v9
    ds_write_b32 v10, v37
    v_lshl_add_u32 v9, v9, 2, v41
    ds_write_b8_d16_hi v9, v44 offset:16
    v_and_b32 v7, -4, v42
    v_lshl_add_u32 v8, v42, 2, v7
    ds_write_b32 v8, v38
    v_lshl_add_u32 v7, v7, 2, v42
    ds_write_b8 v7, v45 offset:16
    v_and_b32 v9, -4, v43
    v_lshl_add_u32 v10, v43, 2, v9
    ds_write_b32 v10, v39
    v_lshl_add_u32 v9, v9, 2, v43
    ds_write_b8_d16_hi v9, v45 offset:16
    s_add_u32 s45, s33, 0x3000000
    buffer_load_dwordx4 v[28:31], v0, s[8:11], s45 offen nt
    s_add_u32 s46, s33, 0x3000000
    buffer_load_dwordx4 v[32:35], v0, s[12:15], s46 offen nt
    v_and_b32 v7, -4, v52
    v_lshl_add_u32 v8, v52, 2, v7
    ds_write_b32 v8, v48
    v_lshl_add_u32 v7, v7, 2, v52
    ds_write_b8 v7, v46 offset:16
    v_and_b32 v9, -4, v53
    v_lshl_add_u32 v10, v53, 2, v9
    ds_write_b32 v10, v49
    v_lshl_add_u32 v9, v9, 2, v53
    ds_write_b8_d16_hi v9, v46 offset:16
    v_and_b32 v7, -4, v54
    v_lshl_add_u32 v8, v54, 2, v7
    ds_write_b32 v8, v50
    v_lshl_add_u32 v7, v7, 2, v54
    ds_write_b8 v7, v47 offset:16
    v_and_b32 v9, -4, v55
    v_lshl_add_u32 v10, v55, 2, v9
    ds_write_b32 v10, v51
    v_lshl_add_u32 v9, v9, 2, v55
    ds_write_b8_d16_hi v9, v47 offset:16
    s_add_u32 s47, s34, 0x1800000
    buffer_load_dwordx2 v[24:25], v1, s[16:19], s47 offen nt
    s_add_u32 s44, s34, 0x1a00000
    buffer_load_dwordx2 v[26:27], v1, s[16:19], s44 offen nt
    s_setprio 1
    v_and_b32 v7, -4, v60
    v_lshl_add_u32 v8, v60, 2, v7
    ds_write_b32 v8, v56
    v_lshl_add_u32 v7, v7, 2, v60
    ds_write_b8 v7, v64 offset:16
    v_and_b32 v9, -4, v61
    v_lshl_add_u32 v10, v61, 2, v9
    ds_write_b32 v10, v57
    v_lshl_add_u32 v9, v9, 2, v61
    ds_write_b8_d16_hi v9, v64 offset:16
    v_and_b32 v7, -4, v62
    v_lshl_add_u32 v8, v62, 2, v7
    ds_write_b32 v8, v58
    v_lshl_add_u32 v7, v7, 2, v62
    ds_write_b8 v7, v65 offset:16
    v_and_b32 v9, -4, v63
    v_lshl_add_u32 v10, v63, 2, v9
    ds_write_b32 v10, v59
    v_lshl_add_u32 v9, v9, 2, v63
    ds_write_b8_d16_hi v9, v65 offset:16
    s_add_u32 s45, s33, 0x3400000
    buffer_load_dwordx4 v[36:39], v0, s[8:11], s45 offen nt
    v_and_b32 v7, -4, v72
    v_lshl_add_u32 v8, v72, 2, v7
    ds_write_b32 v8, v68
    v_lshl_add_u32 v7, v7, 2, v72
    ds_write_b8 v7, v66 offset:16
    v_and_b32 v9, -4, v73
    v_lshl_add_u32 v10, v73, 2, v9
    ds_write_b32 v10, v69
    v_lshl_add_u32 v9, v9, 2, v73
    ds_write_b8_d16_hi v9, v66 offset:16
    v_and_b32 v7, -4, v74
    v_lshl_add_u32 v8, v74, 2, v7
    ds_write_b32 v8, v70
    v_lshl_add_u32 v7, v7, 2, v74
    ds_write_b8 v7, v67 offset:16
    v_and_b32 v9, -4, v75
    v_lshl_add_u32 v10, v75, 2, v9
    ds_write_b32 v10, v71
    v_lshl_add_u32 v9, v9, 2, v75
    ds_write_b8_d16_hi v9, v67 offset:16
    s_add_u32 s46, s33, 0x3400000
    buffer_load_dwordx4 v[40:43], v0, s[12:15], s46 offen nt
    s_add_u32 s47, s33, 0x3800000
    buffer_load_dwordx4 v[48:51], v0, s[8:11], s47 offen nt
    s_setprio 0
    v_and_b32 v7, -4, v80
    v_lshl_add_u32 v8, v80, 2, v7
    ds_write_b32 v8, v76
    v_lshl_add_u32 v7, v7, 2, v80
    ds_write_b8 v7, v84 offset:16
    v_and_b32 v9, -4, v81
    v_lshl_add_u32 v10, v81, 2, v9
    ds_write_b32 v10, v77
    v_lshl_add_u32 v9, v9, 2, v81
    ds_write_b8_d16_hi v9, v84 offset:16
    v_and_b32 v7, -4, v82
    v_lshl_add_u32 v8, v82, 2, v7
    ds_write_b32 v8, v78
    v_lshl_add_u32 v7, v7, 2, v82
    ds_write_b8 v7, v85 offset:16
    v_and_b32 v9, -4, v83
    v_lshl_add_u32 v10, v83, 2, v9
    ds_write_b32 v10, v79
    v_lshl_add_u32 v9, v9, 2, v83
    ds_write_b8_d16_hi v9, v85 offset:16
    s_add_u32 s44, s33, 0x3800000
    buffer_load_dwordx4 v[52:55], v0, s[12:15], s44 offen nt
    v_and_b32 v7, -4, v92
    v_lshl_add_u32 v8, v92, 2, v7
    ds_write_b32 v8, v88
    v_lshl_add_u32 v7, v7, 2, v92
    ds_write_b8 v7, v86 offset:16
    v_and_b32 v9, -4, v93
    v_lshl_add_u32 v10, v93, 2, v9
    ds_write_b32 v10, v89
    v_lshl_add_u32 v9, v9, 2, v93
    ds_write_b8_d16_hi v9, v86 offset:16
    v_and_b32 v7, -4, v94
    v_lshl_add_u32 v8, v94, 2, v7
    ds_write_b32 v8, v90
    v_lshl_add_u32 v7, v7, 2, v94
    ds_write_b8 v7, v87 offset:16
    v_and_b32 v9, -4, v95
    v_lshl_add_u32 v10, v95, 2, v9
    ds_write_b32 v10, v91
    v_lshl_add_u32 v9, v9, 2, v95
    ds_write_b8_d16_hi v9, v87 offset:16
    s_add_u32 s45, s34, 0x1c00000
    buffer_load_dwordx2 v[44:45], v1, s[16:19], s45 offen nt
    s_add_u32 s46, s34, 0x1e00000
    buffer_load_dwordx2 v[46:47], v1, s[16:19], s46 offen nt
    v_add_u32 v7, 0x10000, v0
    v_add_u32 v12, 0x20000, v0
    v_mov_b32 v8, 0
    v_mov_b32 v9, 0
    v_mov_b32 v10, 0
    v_mov_b32 v11, 0
    s_waitcnt lgkmcnt(0)
    s_barrier
    ds_read_b128 v[56:59], v0 offset:0
    ds_write_b128 v0, v[8:11]
    ds_read_b128 v[60:63], v0 offset:16384
    ds_read_b128 v[68:71], v0 offset:32768
    ds_read_b128 v[72:75], v0 offset:49152
    ds_read_b128 v[64:67], v7 offset:0
    ds_read_b128 v[76:79], v7 offset:16384
    ds_read_b128 v[80:83], v7 offset:32768
    ds_read_b128 v[88:91], v7 offset:49152
    ds_read_b128 v[92:95], v12 offset:0
    ds_read_b128 v[84:87], v12 offset:16384
    s_waitcnt lgkmcnt(0)
    s_barrier
    s_setprio 3
    s_add_u32 s47, s35, 0x0
    buffer_store_dwordx4 v[56:59], v0, s[20:23], s47 offen sc1
    s_add_u32 s44, s33, 0x3c00000
    s_nop 0
    buffer_load_dwordx4 v[56:59], v0, s[8:11], s44 offen nt
    s_add_u32 s45, s35, 0x4000
    buffer_store_dwordx4 v[60:63], v0, s[20:23], s45 offen sc1
    s_add_u32 s46, s33, 0x3c00000
    s_nop 0
    buffer_load_dwordx4 v[60:63], v0, s[12:15], s46 offen nt
    s_waitcnt vmcnt(22)
    v_lshlrev_b32 v7, 16, v104
    v_and_b32 v8, 0xffff0000, v104
    v_lshlrev_b32 v9, 16, v105
    v_and_b32 v10, 0xffff0000, v105
    v_mul_f32 v7, 0.15915494, v7
    v_mul_f32 v8, 0.15915494, v8
    v_mul_f32 v9, 0.15915494, v9
    v_mul_f32 v10, 0.15915494, v10
    v_mul_hi_u32_u24 v14, 429497, v96
    v_lshrrev_b32 v12, 3, v100
    v_cos_f32 v7, v7
    v_lshlrev_b16 v13, 3, v100
    v_mad_i32_i24 v11, v14, s55, v96
    v_bitop3_b32 v12, v6, v13, v12 bitop3:0xca
    v_lshl_add_u32 v11, v11, 17, s40
    v_lshlrev_b16 v14, 8, v14
    v_lshrrev_b32 v13, 2, v100
    v_add_u32 v96, v12, v11
    v_bitop3_b32 v100, v5, v13, v14 bitop3:0xea
    ds_add_u32 v100, v2
    v_mul_hi_u32_u24 v14, 429497, v97
    v_lshrrev_b32 v12, 3, v101
    v_cos_f32 v8, v8
    v_lshlrev_b16 v13, 3, v101
    v_mad_i32_i24 v11, v14, s55, v97
    v_bitop3_b32 v12, v6, v13, v12 bitop3:0xca
    v_lshl_add_u32 v11, v11, 17, s40
    v_lshlrev_b16 v14, 8, v14
    v_lshrrev_b32 v13, 2, v101
    v_add_u32 v97, v12, v11
    v_bitop3_b32 v101, v5, v13, v14 bitop3:0xea
    ds_add_u32 v101, v2
    v_cvt_pk_bf16_f32 v104, v7, v8
    v_perm_b32 v12, v104, v104, s41
    v_bitop3_b32 v96, v4, v12, v96 bitop3:0xca
    v_perm_b32 v13, v104, v104, s42
    v_bitop3_b32 v97, v4, v13, v97 bitop3:0xca
    v_mul_hi_u32_u24 v14, 429497, v98
    v_lshrrev_b32 v12, 3, v102
    v_cos_f32 v9, v9
    v_lshlrev_b16 v13, 3, v102
    v_mad_i32_i24 v11, v14, s55, v98
    v_bitop3_b32 v12, v6, v13, v12 bitop3:0xca
    v_lshl_add_u32 v11, v11, 17, s40
    v_lshlrev_b16 v14, 8, v14
    v_lshrrev_b32 v13, 2, v102
    v_add_u32 v98, v12, v11
    v_bitop3_b32 v102, v5, v13, v14 bitop3:0xea
    ds_add_u32 v102, v2
    v_mul_hi_u32_u24 v14, 429497, v99
    v_lshrrev_b32 v12, 3, v103
    v_cos_f32 v10, v10
    v_lshlrev_b16 v13, 3, v103
    v_mad_i32_i24 v11, v14, s55, v99
    v_bitop3_b32 v12, v6, v13, v12 bitop3:0xca
    v_lshl_add_u32 v11, v11, 17, s40
    v_lshlrev_b16 v14, 8, v14
    v_lshrrev_b32 v13, 2, v103
    v_add_u32 v99, v12, v11
    v_bitop3_b32 v103, v5, v13, v14 bitop3:0xea
    ds_add_u32 v103, v2
    v_cvt_pk_bf16_f32 v105, v9, v10
    v_perm_b32 v12, v105, v105, s41
    v_bitop3_b32 v98, v4, v12, v98 bitop3:0xca
    v_perm_b32 v13, v105, v105, s42
    v_bitop3_b32 v99, v4, v13, v99 bitop3:0xca
    s_waitcnt vmcnt(20)
    v_lshlrev_b32 v7, 16, v106
    v_and_b32 v8, 0xffff0000, v106
    v_lshlrev_b32 v9, 16, v107
    v_and_b32 v10, 0xffff0000, v107
    v_mul_f32 v7, 0.15915494, v7
    v_mul_f32 v8, 0.15915494, v8
    v_mul_f32 v9, 0.15915494, v9
    v_mul_f32 v10, 0.15915494, v10
    v_mul_hi_u32_u24 v14, 429497, v108
    v_lshrrev_b32 v12, 3, v112
    v_cos_f32 v7, v7
    v_lshlrev_b16 v13, 3, v112
    v_mad_i32_i24 v11, v14, s55, v108
    v_bitop3_b32 v12, v6, v13, v12 bitop3:0xca
    v_lshl_add_u32 v11, v11, 17, s40
    v_lshlrev_b16 v14, 8, v14
    v_lshrrev_b32 v13, 2, v112
    v_add_u32 v108, v12, v11
    v_bitop3_b32 v112, v5, v13, v14 bitop3:0xea
    ds_add_u32 v112, v2
    v_mul_hi_u32_u24 v14, 429497, v109
    v_lshrrev_b32 v12, 3, v113
    v_cos_f32 v8, v8
    v_lshlrev_b16 v13, 3, v113
    v_mad_i32_i24 v11, v14, s55, v109
    v_bitop3_b32 v12, v6, v13, v12 bitop3:0xca
    v_lshl_add_u32 v11, v11, 17, s40
    v_lshlrev_b16 v14, 8, v14
    v_lshrrev_b32 v13, 2, v113
    v_add_u32 v109, v12, v11
    v_bitop3_b32 v113, v5, v13, v14 bitop3:0xea
    ds_add_u32 v113, v2
    v_cvt_pk_bf16_f32 v106, v7, v8
    v_perm_b32 v12, v106, v106, s41
    v_bitop3_b32 v108, v4, v12, v108 bitop3:0xca
    v_perm_b32 v13, v106, v106, s42
    v_bitop3_b32 v109, v4, v13, v109 bitop3:0xca
    v_mul_hi_u32_u24 v14, 429497, v110
    v_lshrrev_b32 v12, 3, v114
    v_cos_f32 v9, v9
    v_lshlrev_b16 v13, 3, v114
    v_mad_i32_i24 v11, v14, s55, v110
    v_bitop3_b32 v12, v6, v13, v12 bitop3:0xca
    v_lshl_add_u32 v11, v11, 17, s40
    v_lshlrev_b16 v14, 8, v14
    v_lshrrev_b32 v13, 2, v114
    v_add_u32 v110, v12, v11
    v_bitop3_b32 v114, v5, v13, v14 bitop3:0xea
    ds_add_u32 v114, v2
    v_mul_hi_u32_u24 v14, 429497, v111
    v_lshrrev_b32 v12, 3, v115
    v_cos_f32 v10, v10
    v_lshlrev_b16 v13, 3, v115
    v_mad_i32_i24 v11, v14, s55, v111
    v_bitop3_b32 v12, v6, v13, v12 bitop3:0xca
    v_lshl_add_u32 v11, v11, 17, s40
    v_lshlrev_b16 v14, 8, v14
    v_lshrrev_b32 v13, 2, v115
    v_add_u32 v111, v12, v11
    v_bitop3_b32 v115, v5, v13, v14 bitop3:0xea
    ds_add_u32 v115, v2
    v_cvt_pk_bf16_f32 v107, v9, v10
    v_perm_b32 v12, v107, v107, s41
    v_bitop3_b32 v110, v4, v12, v110 bitop3:0xca
    v_perm_b32 v13, v107, v107, s42
    v_bitop3_b32 v111, v4, v13, v111 bitop3:0xca
    s_setprio 2
    s_waitcnt vmcnt(16)
    v_lshlrev_b32 v7, 16, v124
    v_and_b32 v8, 0xffff0000, v124
    v_lshlrev_b32 v9, 16, v125
    v_and_b32 v10, 0xffff0000, v125
    v_mul_f32 v7, 0.15915494, v7
    v_mul_f32 v8, 0.15915494, v8
    v_mul_f32 v9, 0.15915494, v9
    v_mul_f32 v10, 0.15915494, v10
    v_mul_hi_u32_u24 v14, 429497, v116
    v_lshrrev_b32 v12, 3, v120
    v_cos_f32 v7, v7
    v_lshlrev_b16 v13, 3, v120
    v_mad_i32_i24 v11, v14, s55, v116
    v_bitop3_b32 v12, v6, v13, v12 bitop3:0xca
    v_lshl_add_u32 v11, v11, 17, s40
    v_lshlrev_b16 v14, 8, v14
    v_lshrrev_b32 v13, 2, v120
    v_add_u32 v116, v12, v11
    v_bitop3_b32 v120, v5, v13, v14 bitop3:0xea
    ds_add_u32 v120, v2
    v_mul_hi_u32_u24 v14, 429497, v117
    v_lshrrev_b32 v12, 3, v121
    v_cos_f32 v8, v8
    v_lshlrev_b16 v13, 3, v121
    v_mad_i32_i24 v11, v14, s55, v117
    v_bitop3_b32 v12, v6, v13, v12 bitop3:0xca
    v_lshl_add_u32 v11, v11, 17, s40
    v_lshlrev_b16 v14, 8, v14
    v_lshrrev_b32 v13, 2, v121
    v_add_u32 v117, v12, v11
    v_bitop3_b32 v121, v5, v13, v14 bitop3:0xea
    ds_add_u32 v121, v2
    v_cvt_pk_bf16_f32 v124, v7, v8
    v_perm_b32 v12, v124, v124, s41
    v_bitop3_b32 v116, v4, v12, v116 bitop3:0xca
    v_perm_b32 v13, v124, v124, s42
    v_bitop3_b32 v117, v4, v13, v117 bitop3:0xca
    v_mul_hi_u32_u24 v14, 429497, v118
    v_lshrrev_b32 v12, 3, v122
    v_cos_f32 v9, v9
    v_lshlrev_b16 v13, 3, v122
    v_mad_i32_i24 v11, v14, s55, v118
    v_bitop3_b32 v12, v6, v13, v12 bitop3:0xca
    v_lshl_add_u32 v11, v11, 17, s40
    v_lshlrev_b16 v14, 8, v14
    v_lshrrev_b32 v13, 2, v122
    v_add_u32 v118, v12, v11
    v_bitop3_b32 v122, v5, v13, v14 bitop3:0xea
    ds_add_u32 v122, v2
    v_mul_hi_u32_u24 v14, 429497, v119
    v_lshrrev_b32 v12, 3, v123
    v_cos_f32 v10, v10
    v_lshlrev_b16 v13, 3, v123
    v_mad_i32_i24 v11, v14, s55, v119
    v_bitop3_b32 v12, v6, v13, v12 bitop3:0xca
    v_lshl_add_u32 v11, v11, 17, s40
    v_lshlrev_b16 v14, 8, v14
    v_lshrrev_b32 v13, 2, v123
    v_add_u32 v119, v12, v11
    v_bitop3_b32 v123, v5, v13, v14 bitop3:0xea
    ds_add_u32 v123, v2
    v_cvt_pk_bf16_f32 v125, v9, v10
    v_perm_b32 v12, v125, v125, s41
    v_bitop3_b32 v118, v4, v12, v118 bitop3:0xca
    v_perm_b32 v13, v125, v125, s42
    v_bitop3_b32 v119, v4, v13, v119 bitop3:0xca
    s_add_u32 s47, s35, 0x8000
    buffer_store_dwordx4 v[68:71], v0, s[20:23], s47 offen sc1
    s_add_u32 s44, s33, 0x4000000
    s_nop 0
    buffer_load_dwordx4 v[68:71], v0, s[8:11], s44 offen nt
    s_waitcnt vmcnt(16)
    v_lshlrev_b32 v7, 16, v126
    v_and_b32 v8, 0xffff0000, v126
    v_lshlrev_b32 v9, 16, v127
    v_and_b32 v10, 0xffff0000, v127
    v_mul_f32 v7, 0.15915494, v7
    v_mul_f32 v8, 0.15915494, v8
    v_mul_f32 v9, 0.15915494, v9
    v_mul_f32 v10, 0.15915494, v10
    v_mul_hi_u32_u24 v14, 429497, v16
    v_lshrrev_b32 v12, 3, v20
    v_cos_f32 v7, v7
    v_lshlrev_b16 v13, 3, v20
    v_mad_i32_i24 v11, v14, s55, v16
    v_bitop3_b32 v12, v6, v13, v12 bitop3:0xca
    v_lshl_add_u32 v11, v11, 17, s40
    v_lshlrev_b16 v14, 8, v14
    v_lshrrev_b32 v13, 2, v20
    v_add_u32 v16, v12, v11
    v_bitop3_b32 v20, v5, v13, v14 bitop3:0xea
    ds_add_u32 v20, v2
    v_mul_hi_u32_u24 v14, 429497, v17
    v_lshrrev_b32 v12, 3, v21
    v_cos_f32 v8, v8
    v_lshlrev_b16 v13, 3, v21
    v_mad_i32_i24 v11, v14, s55, v17
    v_bitop3_b32 v12, v6, v13, v12 bitop3:0xca
    v_lshl_add_u32 v11, v11, 17, s40
    v_lshlrev_b16 v14, 8, v14
    v_lshrrev_b32 v13, 2, v21
    v_add_u32 v17, v12, v11
    v_bitop3_b32 v21, v5, v13, v14 bitop3:0xea
    ds_add_u32 v21, v2
    v_cvt_pk_bf16_f32 v126, v7, v8
    v_perm_b32 v12, v126, v126, s41
    v_bitop3_b32 v16, v4, v12, v16 bitop3:0xca
    v_perm_b32 v13, v126, v126, s42
    v_bitop3_b32 v17, v4, v13, v17 bitop3:0xca
    v_mul_hi_u32_u24 v14, 429497, v18
    v_lshrrev_b32 v12, 3, v22
    v_cos_f32 v9, v9
    v_lshlrev_b16 v13, 3, v22
    v_mad_i32_i24 v11, v14, s55, v18
    v_bitop3_b32 v12, v6, v13, v12 bitop3:0xca
    v_lshl_add_u32 v11, v11, 17, s40
    v_lshlrev_b16 v14, 8, v14
    v_lshrrev_b32 v13, 2, v22
    v_add_u32 v18, v12, v11
    v_bitop3_b32 v22, v5, v13, v14 bitop3:0xea
    ds_add_u32 v22, v2
    v_mul_hi_u32_u24 v14, 429497, v19
    v_lshrrev_b32 v12, 3, v23
    v_cos_f32 v10, v10
    v_lshlrev_b16 v13, 3, v23
    v_mad_i32_i24 v11, v14, s55, v19
    v_bitop3_b32 v12, v6, v13, v12 bitop3:0xca
    v_lshl_add_u32 v11, v11, 17, s40
    v_lshlrev_b16 v14, 8, v14
    v_lshrrev_b32 v13, 2, v23
    v_add_u32 v19, v12, v11
    v_bitop3_b32 v23, v5, v13, v14 bitop3:0xea
    ds_add_u32 v23, v2
    v_cvt_pk_bf16_f32 v127, v9, v10
    v_perm_b32 v12, v127, v127, s41
    v_bitop3_b32 v18, v4, v12, v18 bitop3:0xca
    v_perm_b32 v13, v127, v127, s42
    v_bitop3_b32 v19, v4, v13, v19 bitop3:0xca
    s_setprio 1
    s_waitcnt vmcnt(12)
    v_lshlrev_b32 v7, 16, v24
    v_and_b32 v8, 0xffff0000, v24
    v_lshlrev_b32 v9, 16, v25
    v_and_b32 v10, 0xffff0000, v25
    v_mul_f32 v7, 0.15915494, v7
    v_mul_f32 v8, 0.15915494, v8
    v_mul_f32 v9, 0.15915494, v9
    v_mul_f32 v10, 0.15915494, v10
    v_mul_hi_u32_u24 v14, 429497, v28
    v_lshrrev_b32 v12, 3, v32
    v_cos_f32 v7, v7
    v_lshlrev_b16 v13, 3, v32
    v_mad_i32_i24 v11, v14, s55, v28
    v_bitop3_b32 v12, v6, v13, v12 bitop3:0xca
    v_lshl_add_u32 v11, v11, 17, s40
    v_lshlrev_b16 v14, 8, v14
    v_lshrrev_b32 v13, 2, v32
    v_add_u32 v28, v12, v11
    v_bitop3_b32 v32, v5, v13, v14 bitop3:0xea
    ds_add_u32 v32, v2
    v_mul_hi_u32_u24 v14, 429497, v29
    v_lshrrev_b32 v12, 3, v33
    v_cos_f32 v8, v8
    v_lshlrev_b16 v13, 3, v33
    v_mad_i32_i24 v11, v14, s55, v29
    v_bitop3_b32 v12, v6, v13, v12 bitop3:0xca
    v_lshl_add_u32 v11, v11, 17, s40
    v_lshlrev_b16 v14, 8, v14
    v_lshrrev_b32 v13, 2, v33
    v_add_u32 v29, v12, v11
    v_bitop3_b32 v33, v5, v13, v14 bitop3:0xea
    ds_add_u32 v33, v2
    v_cvt_pk_bf16_f32 v24, v7, v8
    v_perm_b32 v12, v24, v24, s41
    v_bitop3_b32 v28, v4, v12, v28 bitop3:0xca
    v_perm_b32 v13, v24, v24, s42
    v_bitop3_b32 v29, v4, v13, v29 bitop3:0xca
    v_mul_hi_u32_u24 v14, 429497, v30
    v_lshrrev_b32 v12, 3, v34
    v_cos_f32 v9, v9
    v_lshlrev_b16 v13, 3, v34
    v_mad_i32_i24 v11, v14, s55, v30
    v_bitop3_b32 v12, v6, v13, v12 bitop3:0xca
    v_lshl_add_u32 v11, v11, 17, s40
    v_lshlrev_b16 v14, 8, v14
    v_lshrrev_b32 v13, 2, v34
    v_add_u32 v30, v12, v11
    v_bitop3_b32 v34, v5, v13, v14 bitop3:0xea
    ds_add_u32 v34, v2
    v_mul_hi_u32_u24 v14, 429497, v31
    v_lshrrev_b32 v12, 3, v35
    v_cos_f32 v10, v10
    v_lshlrev_b16 v13, 3, v35
    v_mad_i32_i24 v11, v14, s55, v31
    v_bitop3_b32 v12, v6, v13, v12 bitop3:0xca
    v_lshl_add_u32 v11, v11, 17, s40
    v_lshlrev_b16 v14, 8, v14
    v_lshrrev_b32 v13, 2, v35
    v_add_u32 v31, v12, v11
    v_bitop3_b32 v35, v5, v13, v14 bitop3:0xea
    ds_add_u32 v35, v2
    v_cvt_pk_bf16_f32 v25, v9, v10
    v_perm_b32 v12, v25, v25, s41
    v_bitop3_b32 v30, v4, v12, v30 bitop3:0xca
    v_perm_b32 v13, v25, v25, s42
    v_bitop3_b32 v31, v4, v13, v31 bitop3:0xca
    s_waitcnt vmcnt(10)
    v_lshlrev_b32 v7, 16, v26
    v_and_b32 v8, 0xffff0000, v26
    v_lshlrev_b32 v9, 16, v27
    v_and_b32 v10, 0xffff0000, v27
    v_mul_f32 v7, 0.15915494, v7
    v_mul_f32 v8, 0.15915494, v8
    v_mul_f32 v9, 0.15915494, v9
    v_mul_f32 v10, 0.15915494, v10
    v_mul_hi_u32_u24 v14, 429497, v36
    v_lshrrev_b32 v12, 3, v40
    v_cos_f32 v7, v7
    v_lshlrev_b16 v13, 3, v40
    v_mad_i32_i24 v11, v14, s55, v36
    v_bitop3_b32 v12, v6, v13, v12 bitop3:0xca
    v_lshl_add_u32 v11, v11, 17, s40
    v_lshlrev_b16 v14, 8, v14
    v_lshrrev_b32 v13, 2, v40
    v_add_u32 v36, v12, v11
    v_bitop3_b32 v40, v5, v13, v14 bitop3:0xea
    ds_add_u32 v40, v2
    v_mul_hi_u32_u24 v14, 429497, v37
    v_lshrrev_b32 v12, 3, v41
    v_cos_f32 v8, v8
    v_lshlrev_b16 v13, 3, v41
    v_mad_i32_i24 v11, v14, s55, v37
    v_bitop3_b32 v12, v6, v13, v12 bitop3:0xca
    v_lshl_add_u32 v11, v11, 17, s40
    v_lshlrev_b16 v14, 8, v14
    v_lshrrev_b32 v13, 2, v41
    v_add_u32 v37, v12, v11
    v_bitop3_b32 v41, v5, v13, v14 bitop3:0xea
    ds_add_u32 v41, v2
    v_cvt_pk_bf16_f32 v26, v7, v8
    v_perm_b32 v12, v26, v26, s41
    v_bitop3_b32 v36, v4, v12, v36 bitop3:0xca
    v_perm_b32 v13, v26, v26, s42
    v_bitop3_b32 v37, v4, v13, v37 bitop3:0xca
    v_mul_hi_u32_u24 v14, 429497, v38
    v_lshrrev_b32 v12, 3, v42
    v_cos_f32 v9, v9
    v_lshlrev_b16 v13, 3, v42
    v_mad_i32_i24 v11, v14, s55, v38
    v_bitop3_b32 v12, v6, v13, v12 bitop3:0xca
    v_lshl_add_u32 v11, v11, 17, s40
    v_lshlrev_b16 v14, 8, v14
    v_lshrrev_b32 v13, 2, v42
    v_add_u32 v38, v12, v11
    v_bitop3_b32 v42, v5, v13, v14 bitop3:0xea
    ds_add_u32 v42, v2
    v_mul_hi_u32_u24 v14, 429497, v39
    v_lshrrev_b32 v12, 3, v43
    v_cos_f32 v10, v10
    v_lshlrev_b16 v13, 3, v43
    v_mad_i32_i24 v11, v14, s55, v39
    v_bitop3_b32 v12, v6, v13, v12 bitop3:0xca
    v_lshl_add_u32 v11, v11, 17, s40
    v_lshlrev_b16 v14, 8, v14
    v_lshrrev_b32 v13, 2, v43
    v_add_u32 v39, v12, v11
    v_bitop3_b32 v43, v5, v13, v14 bitop3:0xea
    ds_add_u32 v43, v2
    v_cvt_pk_bf16_f32 v27, v9, v10
    v_perm_b32 v12, v27, v27, s41
    v_bitop3_b32 v38, v4, v12, v38 bitop3:0xca
    v_perm_b32 v13, v27, v27, s42
    v_bitop3_b32 v39, v4, v13, v39 bitop3:0xca
    s_setprio 0
    s_add_u32 s45, s35, 0xc000
    buffer_store_dwordx4 v[72:75], v0, s[20:23], s45 offen sc1
    s_add_u32 s46, s33, 0x4000000
    s_nop 0
    buffer_load_dwordx4 v[72:75], v0, s[12:15], s46 offen nt
    s_waitcnt vmcnt(8)
    v_lshlrev_b32 v7, 16, v44
    v_and_b32 v8, 0xffff0000, v44
    v_lshlrev_b32 v9, 16, v45
    v_and_b32 v10, 0xffff0000, v45
    v_mul_f32 v7, 0.15915494, v7
    v_mul_f32 v8, 0.15915494, v8
    v_mul_f32 v9, 0.15915494, v9
    v_mul_f32 v10, 0.15915494, v10
    v_mul_hi_u32_u24 v14, 429497, v48
    v_lshrrev_b32 v12, 3, v52
    v_cos_f32 v7, v7
    v_lshlrev_b16 v13, 3, v52
    v_mad_i32_i24 v11, v14, s55, v48
    v_bitop3_b32 v12, v6, v13, v12 bitop3:0xca
    v_lshl_add_u32 v11, v11, 17, s40
    v_lshlrev_b16 v14, 8, v14
    v_lshrrev_b32 v13, 2, v52
    v_add_u32 v48, v12, v11
    v_bitop3_b32 v52, v5, v13, v14 bitop3:0xea
    ds_add_u32 v52, v2
    v_mul_hi_u32_u24 v14, 429497, v49
    v_lshrrev_b32 v12, 3, v53
    v_cos_f32 v8, v8
    v_lshlrev_b16 v13, 3, v53
    v_mad_i32_i24 v11, v14, s55, v49
    v_bitop3_b32 v12, v6, v13, v12 bitop3:0xca
    v_lshl_add_u32 v11, v11, 17, s40
    v_lshlrev_b16 v14, 8, v14
    v_lshrrev_b32 v13, 2, v53
    v_add_u32 v49, v12, v11
    v_bitop3_b32 v53, v5, v13, v14 bitop3:0xea
    ds_add_u32 v53, v2
    v_cvt_pk_bf16_f32 v44, v7, v8
    v_perm_b32 v12, v44, v44, s41
    v_bitop3_b32 v48, v4, v12, v48 bitop3:0xca
    v_perm_b32 v13, v44, v44, s42
    v_bitop3_b32 v49, v4, v13, v49 bitop3:0xca
    v_mul_hi_u32_u24 v14, 429497, v50
    v_lshrrev_b32 v12, 3, v54
    v_cos_f32 v9, v9
    v_lshlrev_b16 v13, 3, v54
    v_mad_i32_i24 v11, v14, s55, v50
    v_bitop3_b32 v12, v6, v13, v12 bitop3:0xca
    v_lshl_add_u32 v11, v11, 17, s40
    v_lshlrev_b16 v14, 8, v14
    v_lshrrev_b32 v13, 2, v54
    v_add_u32 v50, v12, v11
    v_bitop3_b32 v54, v5, v13, v14 bitop3:0xea
    ds_add_u32 v54, v2
    v_mul_hi_u32_u24 v14, 429497, v51
    v_lshrrev_b32 v12, 3, v55
    v_cos_f32 v10, v10
    v_lshlrev_b16 v13, 3, v55
    v_mad_i32_i24 v11, v14, s55, v51
    v_bitop3_b32 v12, v6, v13, v12 bitop3:0xca
    v_lshl_add_u32 v11, v11, 17, s40
    v_lshlrev_b16 v14, 8, v14
    v_lshrrev_b32 v13, 2, v55
    v_add_u32 v51, v12, v11
    v_bitop3_b32 v55, v5, v13, v14 bitop3:0xea
    ds_add_u32 v55, v2
    v_cvt_pk_bf16_f32 v45, v9, v10
    v_perm_b32 v12, v45, v45, s41
    v_bitop3_b32 v50, v4, v12, v50 bitop3:0xca
    v_perm_b32 v13, v45, v45, s42
    v_bitop3_b32 v51, v4, v13, v51 bitop3:0xca
    s_waitcnt vmcnt(4)
    v_lshlrev_b32 v7, 16, v46
    v_and_b32 v8, 0xffff0000, v46
    v_lshlrev_b32 v9, 16, v47
    v_and_b32 v10, 0xffff0000, v47
    v_mul_f32 v7, 0.15915494, v7
    v_mul_f32 v8, 0.15915494, v8
    v_mul_f32 v9, 0.15915494, v9
    v_mul_f32 v10, 0.15915494, v10
    v_mul_hi_u32_u24 v14, 429497, v56
    v_lshrrev_b32 v12, 3, v60
    v_cos_f32 v7, v7
    v_lshlrev_b16 v13, 3, v60
    v_mad_i32_i24 v11, v14, s55, v56
    v_bitop3_b32 v12, v6, v13, v12 bitop3:0xca
    v_lshl_add_u32 v11, v11, 17, s40
    v_lshlrev_b16 v14, 8, v14
    v_lshrrev_b32 v13, 2, v60
    v_add_u32 v56, v12, v11
    v_bitop3_b32 v60, v5, v13, v14 bitop3:0xea
    ds_add_u32 v60, v2
    v_mul_hi_u32_u24 v14, 429497, v57
    v_lshrrev_b32 v12, 3, v61
    v_cos_f32 v8, v8
    v_lshlrev_b16 v13, 3, v61
    v_mad_i32_i24 v11, v14, s55, v57
    v_bitop3_b32 v12, v6, v13, v12 bitop3:0xca
    v_lshl_add_u32 v11, v11, 17, s40
    v_lshlrev_b16 v14, 8, v14
    v_lshrrev_b32 v13, 2, v61
    v_add_u32 v57, v12, v11
    v_bitop3_b32 v61, v5, v13, v14 bitop3:0xea
    ds_add_u32 v61, v2
    v_cvt_pk_bf16_f32 v46, v7, v8
    v_perm_b32 v12, v46, v46, s41
    v_bitop3_b32 v56, v4, v12, v56 bitop3:0xca
    v_perm_b32 v13, v46, v46, s42
    v_bitop3_b32 v57, v4, v13, v57 bitop3:0xca
    v_mul_hi_u32_u24 v14, 429497, v58
    v_lshrrev_b32 v12, 3, v62
    v_cos_f32 v9, v9
    v_lshlrev_b16 v13, 3, v62
    v_mad_i32_i24 v11, v14, s55, v58
    v_bitop3_b32 v12, v6, v13, v12 bitop3:0xca
    v_lshl_add_u32 v11, v11, 17, s40
    v_lshlrev_b16 v14, 8, v14
    v_lshrrev_b32 v13, 2, v62
    v_add_u32 v58, v12, v11
    v_bitop3_b32 v62, v5, v13, v14 bitop3:0xea
    ds_add_u32 v62, v2
    v_mul_hi_u32_u24 v14, 429497, v59
    v_lshrrev_b32 v12, 3, v63
    v_cos_f32 v10, v10
    v_lshlrev_b16 v13, 3, v63
    v_mad_i32_i24 v11, v14, s55, v59
    v_bitop3_b32 v12, v6, v13, v12 bitop3:0xca
    v_lshl_add_u32 v11, v11, 17, s40
    v_lshlrev_b16 v14, 8, v14
    v_lshrrev_b32 v13, 2, v63
    v_add_u32 v59, v12, v11
    v_bitop3_b32 v63, v5, v13, v14 bitop3:0xea
    ds_add_u32 v63, v2
    v_cvt_pk_bf16_f32 v47, v9, v10
    v_perm_b32 v12, v47, v47, s41
    v_bitop3_b32 v58, v4, v12, v58 bitop3:0xca
    v_perm_b32 v13, v47, v47, s42
    v_bitop3_b32 v59, v4, v13, v59 bitop3:0xca
    v_lshrrev_b32 v8, 2, v0
    v_and_b32 v7, 0x3c00, v0
    v_bitop3_b32 v7, v5, v8, v7 bitop3:0xea
    s_waitcnt lgkmcnt(0)
    s_barrier
    ds_read2st64_b32 v[8:9], v7 offset0:0 offset1:1
    ds_read2st64_b32 v[10:11], v7 offset0:2 offset1:3
    s_add_u32 s47, s35, 0x10000
    buffer_store_dwordx4 v[64:67], v0, s[20:23], s47 offen sc1
    s_add_u32 s44, s34, 0x2000000
    s_nop 0
    buffer_load_dwordx2 v[64:65], v1, s[16:19], s44 offen nt
    s_add_u32 s45, s34, 0x2200000
    buffer_load_dwordx2 v[66:67], v1, s[16:19], s45 offen nt
    s_waitcnt lgkmcnt(0)
    v_lshl_or_b32 v12, v9, 16, v8
    v_lshl_or_b32 v13, v11, 16, v10
    v_mov_b32 v14, v12
    v_mov_b32 v15, v13
    s_nop 0
    v_add_u32_dpp v14, v14, v14 row_shr:1 row_mask:0xf bank_mask:0xf bound_ctrl:1
    v_add_u32_dpp v15, v15, v15 row_shr:1 row_mask:0xf bank_mask:0xf bound_ctrl:1
    s_nop 0
    v_add_u32_dpp v14, v14, v14 row_shr:2 row_mask:0xf bank_mask:0xf bound_ctrl:1
    v_add_u32_dpp v15, v15, v15 row_shr:2 row_mask:0xf bank_mask:0xf bound_ctrl:1
    s_nop 0
    v_add_u32_dpp v14, v14, v14 row_shr:4 row_mask:0xf bank_mask:0xf bound_ctrl:1
    v_add_u32_dpp v15, v15, v15 row_shr:4 row_mask:0xf bank_mask:0xf bound_ctrl:1
    s_nop 0
    v_add_u32_dpp v14, v14, v14 row_shr:8 row_mask:0xf bank_mask:0xf bound_ctrl:1
    v_add_u32_dpp v15, v15, v15 row_shr:8 row_mask:0xf bank_mask:0xf bound_ctrl:1
    s_nop 0
    v_add_u32_dpp v14, v14, v14 row_bcast:15 row_mask:0xa bank_mask:0xf
    v_add_u32_dpp v15, v15, v15 row_bcast:15 row_mask:0xa bank_mask:0xf
    s_nop 0
    v_add_u32_dpp v14, v14, v14 row_bcast:31 row_mask:0xc bank_mask:0xf
    v_add_u32_dpp v15, v15, v15 row_bcast:31 row_mask:0xc bank_mask:0xf
    v_readlane_b32 s48, v14, 63
    v_readlane_b32 s49, v15, 63
    s_lshl_b32 s54, s32, 2
    v_mov_b32 v8, s54
    s_and_b32 s50, s48, 0xffff
    s_lshr_b32 s51, s48, 16
    s_and_b32 s52, s49, 0xffff
    s_lshr_b32 s53, s49, 16
    s_add_u32 s51, s51, s50
    s_add_u32 s52, s52, s51
    s_add_u32 s53, s53, s52
    v_mov_b32 v9, s53
    s_mov_b64 exec, 1
    ds_write_b32 v8, v9 offset:16384
    s_mov_b64 exec, -1
    v_and_b32 v8, 60, v7
    s_waitcnt lgkmcnt(0)
    s_barrier
    ds_read_b32 v9, v8 offset:16384
    s_waitcnt lgkmcnt(0)
    v_add_u32_dpp v9, v9, v9 row_shr:1 row_mask:0xf bank_mask:0xf bound_ctrl:1
    s_nop 1
    v_add_u32_dpp v9, v9, v9 row_shr:2 row_mask:0xf bank_mask:0xf bound_ctrl:1
    s_nop 1
    v_add_u32_dpp v9, v9, v9 row_shr:4 row_mask:0xf bank_mask:0xf bound_ctrl:1
    s_nop 1
    v_add_u32_dpp v9, v9, v9 row_shr:8 row_mask:0xf bank_mask:0xf bound_ctrl:1
    s_nop 0
    v_readlane_b32 s54, v9, s32
    s_sub_u32 s54, s54, s53
    s_add_u32 s50, s50, s54
    s_add_u32 s51, s51, s54
    s_add_u32 s52, s52, s54
    s_pack_ll_b32_b16 s48, s54, s50
    s_pack_ll_b32_b16 s49, s51, s52
    v_add_u32 v14, s48, v14
    v_add_u32 v15, s49, v15
    v_sub_u32 v12, v14, v12
    v_sub_u32 v13, v15, v13
    v_and_b32 v8, 0xffff, v12
    v_lshrrev_b32 v9, 16, v12
    v_and_b32 v10, 0xffff, v13
    v_lshrrev_b32 v11, 16, v13
    ds_write2st64_b32 v7, v8, v9 offset0:0 offset1:1
    ds_write2st64_b32 v7, v10, v11 offset0:2 offset1:3
    v_and_b32 v8, 0x3f0, v0
    v_lshl_add_u32 v8, v8, 1, s36
    ds_write_b64 v8, v[12:13] offset:20480
    s_bitset0_b64 exec, 63
    s_not_b64 exec, exec
    ds_write_b64 v8, v[14:15] offset:20512
    s_mov_b64 exec, -1
    s_waitcnt lgkmcnt(0)
    s_barrier
    s_setprio 3
    ds_add_rtn_u32 v100, v100, v2
    ds_add_rtn_u32 v101, v101, v2
    ds_add_rtn_u32 v102, v102, v2
    ds_add_rtn_u32 v103, v103, v2
    ds_read_b128 v[12:15], v0 offset:20480
    v_cmp_gt_u32 vcc, 8448, v0
    ds_add_rtn_u32 v112, v112, v2
    ds_add_rtn_u32 v113, v113, v2
    ds_add_rtn_u32 v114, v114, v2
    ds_add_rtn_u32 v115, v115, v2
    s_setprio 2
    ds_add_rtn_u32 v120, v120, v2
    ds_add_rtn_u32 v121, v121, v2
    ds_add_rtn_u32 v122, v122, v2
    ds_add_rtn_u32 v123, v123, v2
    s_waitcnt lgkmcnt(8)
    s_cbranch_vccz L1_p2
    s_add_u32 s46, s35, 0x2a40000
    s_mov_b64 exec, vcc
    buffer_store_dwordx4 v[12:15], v0, s[24:27], s46 offen sc1
    s_mov_b64 exec, -1
L1_p2:
    s_add_u32 s47, s35, 0x14000
    buffer_store_dwordx4 v[76:79], v0, s[20:23], s47 offen sc1
    s_add_u32 s44, s33, 0x4400000
    s_nop 0
    buffer_load_dwordx4 v[76:79], v0, s[8:11], s44 offen nt
    ds_add_rtn_u32 v20, v20, v2
    ds_add_rtn_u32 v21, v21, v2
    ds_add_rtn_u32 v22, v22, v2
    ds_add_rtn_u32 v23, v23, v2
    s_setprio 1
    ds_add_rtn_u32 v32, v32, v2
    ds_add_rtn_u32 v33, v33, v2
    ds_add_rtn_u32 v34, v34, v2
    ds_add_rtn_u32 v35, v35, v2
    ds_add_rtn_u32 v40, v40, v2
    ds_add_rtn_u32 v41, v41, v2
    ds_add_rtn_u32 v42, v42, v2
    ds_add_rtn_u32 v43, v43, v2
    s_add_u32 s45, s35, 0x18000
    buffer_store_dwordx4 v[80:83], v0, s[20:23], s45 offen sc1
    s_add_u32 s46, s33, 0x4400000
    s_nop 0
    buffer_load_dwordx4 v[80:83], v0, s[12:15], s46 offen nt
    s_setprio 0
    ds_add_rtn_u32 v52, v52, v2
    ds_add_rtn_u32 v53, v53, v2
    ds_add_rtn_u32 v54, v54, v2
    ds_add_rtn_u32 v55, v55, v2
    ds_add_rtn_u32 v60, v60, v2
    ds_add_rtn_u32 v61, v61, v2
    ds_add_rtn_u32 v62, v62, v2
    ds_add_rtn_u32 v63, v63, v2
    s_waitcnt lgkmcnt(0)
    s_barrier
    s_setprio 3
    v_and_b32 v7, -4, v100
    v_lshl_add_u32 v8, v100, 2, v7
    ds_write_b32 v8, v96
    v_lshl_add_u32 v7, v7, 2, v100
    ds_write_b8 v7, v104 offset:16
    v_and_b32 v9, -4, v101
    v_lshl_add_u32 v10, v101, 2, v9
    ds_write_b32 v10, v97
    v_lshl_add_u32 v9, v9, 2, v101
    ds_write_b8_d16_hi v9, v104 offset:16
    v_and_b32 v7, -4, v102
    v_lshl_add_u32 v8, v102, 2, v7
    ds_write_b32 v8, v98
    v_lshl_add_u32 v7, v7, 2, v102
    ds_write_b8 v7, v105 offset:16
    v_and_b32 v9, -4, v103
    v_lshl_add_u32 v10, v103, 2, v9
    ds_write_b32 v10, v99
    v_lshl_add_u32 v9, v9, 2, v103
    ds_write_b8_d16_hi v9, v105 offset:16
    s_add_u32 s47, s35, 0x1c000
    buffer_store_dwordx4 v[88:91], v0, s[20:23], s47 offen sc1
    s_add_u32 s44, s33, 0x4800000
    buffer_load_dwordx4 v[96:99], v0, s[8:11], s44 offen nt
    s_add_u32 s45, s33, 0x4800000
    buffer_load_dwordx4 v[100:103], v0, s[12:15], s45 offen nt
    v_and_b32 v7, -4, v112
    v_lshl_add_u32 v8, v112, 2, v7
    ds_write_b32 v8, v108
    v_lshl_add_u32 v7, v7, 2, v112
    ds_write_b8 v7, v106 offset:16
    v_and_b32 v9, -4, v113
    v_lshl_add_u32 v10, v113, 2, v9
    ds_write_b32 v10, v109
    v_lshl_add_u32 v9, v9, 2, v113
    ds_write_b8_d16_hi v9, v106 offset:16
    v_and_b32 v7, -4, v114
    v_lshl_add_u32 v8, v114, 2, v7
    ds_write_b32 v8, v110
    v_lshl_add_u32 v7, v7, 2, v114
    ds_write_b8 v7, v107 offset:16
    v_and_b32 v9, -4, v115
    v_lshl_add_u32 v10, v115, 2, v9
    ds_write_b32 v10, v111
    v_lshl_add_u32 v9, v9, 2, v115
    ds_write_b8_d16_hi v9, v107 offset:16
    s_add_u32 s46, s34, 0x2400000
    buffer_load_dwordx2 v[88:89], v1, s[16:19], s46 offen nt
    s_add_u32 s47, s34, 0x2600000
    buffer_load_dwordx2 v[90:91], v1, s[16:19], s47 offen nt
    s_add_u32 s44, s33, 0x4c00000
    buffer_load_dwordx4 v[108:111], v0, s[8:11], s44 offen nt
    s_setprio 2
    v_and_b32 v7, -4, v120
    v_lshl_add_u32 v8, v120, 2, v7
    ds_write_b32 v8, v116
    v_lshl_add_u32 v7, v7, 2, v120
    ds_write_b8 v7, v124 offset:16
    v_and_b32 v9, -4, v121
    v_lshl_add_u32 v10, v121, 2, v9
    ds_write_b32 v10, v117
    v_lshl_add_u32 v9, v9, 2, v121
    ds_write_b8_d16_hi v9, v124 offset:16
    v_and_b32 v7, -4, v122
    v_lshl_add_u32 v8, v122, 2, v7
    ds_write_b32 v8, v118
    v_lshl_add_u32 v7, v7, 2, v122
    ds_write_b8 v7, v125 offset:16
    v_and_b32 v9, -4, v123
    v_lshl_add_u32 v10, v123, 2, v9
    ds_write_b32 v10, v119
    v_lshl_add_u32 v9, v9, 2, v123
    ds_write_b8_d16_hi v9, v125 offset:16
    s_add_u32 s45, s35, 0x20000
    buffer_store_dwordx4 v[92:95], v0, s[20:23], s45 offen sc1
    s_add_u32 s46, s33, 0x4c00000
    buffer_load_dwordx4 v[112:115], v0, s[12:15], s46 offen nt
    v_and_b32 v7, -4, v20
    v_lshl_add_u32 v8, v20, 2, v7
    ds_write_b32 v8, v16
    v_lshl_add_u32 v7, v7, 2, v20
    ds_write_b8 v7, v126 offset:16
    v_and_b32 v9, -4, v21
    v_lshl_add_u32 v10, v21, 2, v9
    ds_write_b32 v10, v17
    v_lshl_add_u32 v9, v9, 2, v21
    ds_write_b8_d16_hi v9, v126 offset:16
    v_and_b32 v7, -4, v22
    v_lshl_add_u32 v8, v22, 2, v7
    ds_write_b32 v8, v18
    v_lshl_add_u32 v7, v7, 2, v22
    ds_write_b8 v7, v127 offset:16
    v_and_b32 v9, -4, v23
    v_lshl_add_u32 v10, v23, 2, v9
    ds_write_b32 v10, v19
    v_lshl_add_u32 v9, v9, 2, v23
    ds_write_b8_d16_hi v9, v127 offset:16
    s_add_u32 s47, s33, 0x5000000
    buffer_load_dwordx4 v[104:107], v0, s[8:11], s47 offen nt
    s_add_u32 s44, s33, 0x5000000
    buffer_load_dwordx4 v[116:119], v0, s[12:15], s44 offen nt
    s_setprio 1
    v_and_b32 v7, -4, v32
    v_lshl_add_u32 v8, v32, 2, v7
    ds_write_b32 v8, v28
    v_lshl_add_u32 v7, v7, 2, v32
    ds_write_b8 v7, v24 offset:16
    v_and_b32 v9, -4, v33
    v_lshl_add_u32 v10, v33, 2, v9
    ds_write_b32 v10, v29
    v_lshl_add_u32 v9, v9, 2, v33
    ds_write_b8_d16_hi v9, v24 offset:16
    v_and_b32 v7, -4, v34
    v_lshl_add_u32 v8, v34, 2, v7
    ds_write_b32 v8, v30
    v_lshl_add_u32 v7, v7, 2, v34
    ds_write_b8 v7, v25 offset:16
    v_and_b32 v9, -4, v35
    v_lshl_add_u32 v10, v35, 2, v9
    ds_write_b32 v10, v31
    v_lshl_add_u32 v9, v9, 2, v35
    ds_write_b8_d16_hi v9, v25 offset:16
    s_add_u32 s45, s34, 0x2800000
    buffer_load_dwordx2 v[120:121], v1, s[16:19], s45 offen nt
    s_add_u32 s46, s34, 0x2a00000
    buffer_load_dwordx2 v[122:123], v1, s[16:19], s46 offen nt
    s_add_u32 s47, s33, 0x5400000
    buffer_load_dwordx4 v[92:95], v0, s[8:11], s47 offen nt
    v_and_b32 v7, -4, v40
    v_lshl_add_u32 v8, v40, 2, v7
    ds_write_b32 v8, v36
    v_lshl_add_u32 v7, v7, 2, v40
    ds_write_b8 v7, v26 offset:16
    v_and_b32 v9, -4, v41
    v_lshl_add_u32 v10, v41, 2, v9
    ds_write_b32 v10, v37
    v_lshl_add_u32 v9, v9, 2, v41
    ds_write_b8_d16_hi v9, v26 offset:16
    v_and_b32 v7, -4, v42
    v_lshl_add_u32 v8, v42, 2, v7
    ds_write_b32 v8, v38
    v_lshl_add_u32 v7, v7, 2, v42
    ds_write_b8 v7, v27 offset:16
    v_and_b32 v9, -4, v43
    v_lshl_add_u32 v10, v43, 2, v9
    ds_write_b32 v10, v39
    v_lshl_add_u32 v9, v9, 2, v43
    ds_write_b8_d16_hi v9, v27 offset:16
    s_add_u32 s44, s35, 0x24000
    buffer_store_dwordx4 v[84:87], v0, s[20:23], s44 offen sc1
    s_add_u32 s45, s33, 0x5400000
    buffer_load_dwordx4 v[16:19], v0, s[12:15], s45 offen nt
    s_setprio 0
    v_and_b32 v7, -4, v52
    v_lshl_add_u32 v8, v52, 2, v7
    ds_write_b32 v8, v48
    v_lshl_add_u32 v7, v7, 2, v52
    ds_write_b8 v7, v44 offset:16
    v_and_b32 v9, -4, v53
    v_lshl_add_u32 v10, v53, 2, v9
    ds_write_b32 v10, v49
    v_lshl_add_u32 v9, v9, 2, v53
    ds_write_b8_d16_hi v9, v44 offset:16
    v_and_b32 v7, -4, v54
    v_lshl_add_u32 v8, v54, 2, v7
    ds_write_b32 v8, v50
    v_lshl_add_u32 v7, v7, 2, v54
    ds_write_b8 v7, v45 offset:16
    v_and_b32 v9, -4, v55
    v_lshl_add_u32 v10, v55, 2, v9
    ds_write_b32 v10, v51
    v_lshl_add_u32 v9, v9, 2, v55
    ds_write_b8_d16_hi v9, v45 offset:16
    s_add_u32 s46, s33, 0x5800000
    buffer_load_dwordx4 v[20:23], v0, s[8:11], s46 offen nt
    s_add_u32 s47, s33, 0x5800000
    buffer_load_dwordx4 v[124:127], v0, s[12:15], s47 offen nt
    v_and_b32 v7, -4, v60
    v_lshl_add_u32 v8, v60, 2, v7
    ds_write_b32 v8, v56
    v_lshl_add_u32 v7, v7, 2, v60
    ds_write_b8 v7, v46 offset:16
    v_and_b32 v9, -4, v61
    v_lshl_add_u32 v10, v61, 2, v9
    ds_write_b32 v10, v57
    v_lshl_add_u32 v9, v9, 2, v61
    ds_write_b8_d16_hi v9, v46 offset:16
    v_and_b32 v7, -4, v62
    v_lshl_add_u32 v8, v62, 2, v7
    ds_write_b32 v8, v58
    v_lshl_add_u32 v7, v7, 2, v62
    ds_write_b8 v7, v47 offset:16
    v_and_b32 v9, -4, v63
    v_lshl_add_u32 v10, v63, 2, v9
    ds_write_b32 v10, v59
    v_lshl_add_u32 v9, v9, 2, v63
    ds_write_b8_d16_hi v9, v47 offset:16
    s_add_u32 s44, s34, 0x2c00000
    buffer_load_dwordx2 v[28:29], v1, s[16:19], s44 offen nt
    s_add_u32 s45, s34, 0x2e00000
    buffer_load_dwordx2 v[30:31], v1, s[16:19], s45 offen nt
    v_add_u32 v7, 0x10000, v0
    v_add_u32 v12, 0x20000, v0
    v_mov_b32 v8, 0
    v_mov_b32 v9, 0
    v_mov_b32 v10, 0
    v_mov_b32 v11, 0
    s_waitcnt lgkmcnt(0)
    s_barrier
    ds_read_b128 v[32:35], v0 offset:0
    ds_write_b128 v0, v[8:11]
    ds_read_b128 v[36:39], v0 offset:16384
    ds_read_b128 v[40:43], v0 offset:32768
    ds_read_b128 v[24:27], v0 offset:49152
    ds_read_b128 v[84:87], v7 offset:0
    ds_read_b128 v[48:51], v7 offset:16384
    ds_read_b128 v[52:55], v7 offset:32768
    ds_read_b128 v[56:59], v7 offset:49152
    ds_read_b128 v[60:63], v12 offset:0
    ds_read_b128 v[44:47], v12 offset:16384
    s_waitcnt lgkmcnt(0)
    s_barrier
    s_setprio 3
    s_add_u32 s46, s35, 0x2a40000
    buffer_store_dwordx4 v[32:35], v0, s[20:23], s46 offen sc1
    s_add_u32 s47, s33, 0x5c00000
    s_nop 0
    buffer_load_dwordx4 v[32:35], v0, s[8:11], s47 offen nt
    s_add_u32 s44, s35, 0x2a44000
    buffer_store_dwordx4 v[36:39], v0, s[20:23], s44 offen sc1
    s_add_u32 s45, s33, 0x5c00000
    s_nop 0
    buffer_load_dwordx4 v[36:39], v0, s[12:15], s45 offen nt
    s_waitcnt vmcnt(27)
    v_lshlrev_b32 v7, 16, v64
    v_and_b32 v8, 0xffff0000, v64
    v_lshlrev_b32 v9, 16, v65
    v_and_b32 v10, 0xffff0000, v65
    v_mul_f32 v7, 0.15915494, v7
    v_mul_f32 v8, 0.15915494, v8
    v_mul_f32 v9, 0.15915494, v9
    v_mul_f32 v10, 0.15915494, v10
    v_mul_hi_u32_u24 v14, 429497, v68
    v_lshrrev_b32 v12, 3, v72
    v_cos_f32 v7, v7
    v_lshlrev_b16 v13, 3, v72
    v_mad_i32_i24 v11, v14, s55, v68
    v_bitop3_b32 v12, v6, v13, v12 bitop3:0xca
    v_lshl_add_u32 v11, v11, 17, s40
    v_lshlrev_b16 v14, 8, v14
    v_lshrrev_b32 v13, 2, v72
    v_add_u32 v68, v12, v11
    v_bitop3_b32 v72, v5, v13, v14 bitop3:0xea
    ds_add_u32 v72, v2
    v_mul_hi_u32_u24 v14, 429497, v69
    v_lshrrev_b32 v12, 3, v73
    v_cos_f32 v8, v8
    v_lshlrev_b16 v13, 3, v73
    v_mad_i32_i24 v11, v14, s55, v69
    v_bitop3_b32 v12, v6, v13, v12 bitop3:0xca
    v_lshl_add_u32 v11, v11, 17, s40
    v_lshlrev_b16 v14, 8, v14
    v_lshrrev_b32 v13, 2, v73
    v_add_u32 v69, v12, v11
    v_bitop3_b32 v73, v5, v13, v14 bitop3:0xea
    ds_add_u32 v73, v2
    v_cvt_pk_bf16_f32 v64, v7, v8
    v_perm_b32 v12, v64, v64, s41
    v_bitop3_b32 v68, v4, v12, v68 bitop3:0xca
    v_perm_b32 v13, v64, v64, s42
    v_bitop3_b32 v69, v4, v13, v69 bitop3:0xca
    v_mul_hi_u32_u24 v14, 429497, v70
    v_lshrrev_b32 v12, 3, v74
    v_cos_f32 v9, v9
    v_lshlrev_b16 v13, 3, v74
    v_mad_i32_i24 v11, v14, s55, v70
    v_bitop3_b32 v12, v6, v13, v12 bitop3:0xca
    v_lshl_add_u32 v11, v11, 17, s40
    v_lshlrev_b16 v14, 8, v14
    v_lshrrev_b32 v13, 2, v74
    v_add_u32 v70, v12, v11
    v_bitop3_b32 v74, v5, v13, v14 bitop3:0xea
    ds_add_u32 v74, v2
    v_mul_hi_u32_u24 v14, 429497, v71
    v_lshrrev_b32 v12, 3, v75
    v_cos_f32 v10, v10
    v_lshlrev_b16 v13, 3, v75
    v_mad_i32_i24 v11, v14, s55, v71
    v_bitop3_b32 v12, v6, v13, v12 bitop3:0xca
    v_lshl_add_u32 v11, v11, 17, s40
    v_lshlrev_b16 v14, 8, v14
    v_lshrrev_b32 v13, 2, v75
    v_add_u32 v71, v12, v11
    v_bitop3_b32 v75, v5, v13, v14 bitop3:0xea
    ds_add_u32 v75, v2
    v_cvt_pk_bf16_f32 v65, v9, v10
    v_perm_b32 v12, v65, v65, s41
    v_bitop3_b32 v70, v4, v12, v70 bitop3:0xca
    v_perm_b32 v13, v65, v65, s42
    v_bitop3_b32 v71, v4, v13, v71 bitop3:0xca
    s_waitcnt vmcnt(23)
    v_lshlrev_b32 v7, 16, v66
    v_and_b32 v8, 0xffff0000, v66
    v_lshlrev_b32 v9, 16, v67
    v_and_b32 v10, 0xffff0000, v67
    v_mul_f32 v7, 0.15915494, v7
    v_mul_f32 v8, 0.15915494, v8
    v_mul_f32 v9, 0.15915494, v9
    v_mul_f32 v10, 0.15915494, v10
    v_mul_hi_u32_u24 v14, 429497, v76
    v_lshrrev_b32 v12, 3, v80
    v_cos_f32 v7, v7
    v_lshlrev_b16 v13, 3, v80
    v_mad_i32_i24 v11, v14, s55, v76
    v_bitop3_b32 v12, v6, v13, v12 bitop3:0xca
    v_lshl_add_u32 v11, v11, 17, s40
    v_lshlrev_b16 v14, 8, v14
    v_lshrrev_b32 v13, 2, v80
    v_add_u32 v76, v12, v11
    v_bitop3_b32 v80, v5, v13, v14 bitop3:0xea
    ds_add_u32 v80, v2
    v_mul_hi_u32_u24 v14, 429497, v77
    v_lshrrev_b32 v12, 3, v81
    v_cos_f32 v8, v8
    v_lshlrev_b16 v13, 3, v81
    v_mad_i32_i24 v11, v14, s55, v77
    v_bitop3_b32 v12, v6, v13, v12 bitop3:0xca
    v_lshl_add_u32 v11, v11, 17, s40
    v_lshlrev_b16 v14, 8, v14
    v_lshrrev_b32 v13, 2, v81
    v_add_u32 v77, v12, v11
    v_bitop3_b32 v81, v5, v13, v14 bitop3:0xea
    ds_add_u32 v81, v2
    v_cvt_pk_bf16_f32 v66, v7, v8
    v_perm_b32 v12, v66, v66, s41
    v_bitop3_b32 v76, v4, v12, v76 bitop3:0xca
    v_perm_b32 v13, v66, v66, s42
    v_bitop3_b32 v77, v4, v13, v77 bitop3:0xca
    v_mul_hi_u32_u24 v14, 429497, v78
    v_lshrrev_b32 v12, 3, v82
    v_cos_f32 v9, v9
    v_lshlrev_b16 v13, 3, v82
    v_mad_i32_i24 v11, v14, s55, v78
    v_bitop3_b32 v12, v6, v13, v12 bitop3:0xca
    v_lshl_add_u32 v11, v11, 17, s40
    v_lshlrev_b16 v14, 8, v14
    v_lshrrev_b32 v13, 2, v82
    v_add_u32 v78, v12, v11
    v_bitop3_b32 v82, v5, v13, v14 bitop3:0xea
    ds_add_u32 v82, v2
    v_mul_hi_u32_u24 v14, 429497, v79
    v_lshrrev_b32 v12, 3, v83
    v_cos_f32 v10, v10
    v_lshlrev_b16 v13, 3, v83
    v_mad_i32_i24 v11, v14, s55, v79
    v_bitop3_b32 v12, v6, v13, v12 bitop3:0xca
    v_lshl_add_u32 v11, v11, 17, s40
    v_lshlrev_b16 v14, 8, v14
    v_lshrrev_b32 v13, 2, v83
    v_add_u32 v79, v12, v11
    v_bitop3_b32 v83, v5, v13, v14 bitop3:0xea
    ds_add_u32 v83, v2
    v_cvt_pk_bf16_f32 v67, v9, v10
    v_perm_b32 v12, v67, v67, s41
    v_bitop3_b32 v78, v4, v12, v78 bitop3:0xca
    v_perm_b32 v13, v67, v67, s42
    v_bitop3_b32 v79, v4, v13, v79 bitop3:0xca
    s_setprio 2
    s_waitcnt vmcnt(18)
    v_lshlrev_b32 v7, 16, v88
    v_and_b32 v8, 0xffff0000, v88
    v_lshlrev_b32 v9, 16, v89
    v_and_b32 v10, 0xffff0000, v89
    v_mul_f32 v7, 0.15915494, v7
    v_mul_f32 v8, 0.15915494, v8
    v_mul_f32 v9, 0.15915494, v9
    v_mul_f32 v10, 0.15915494, v10
    v_mul_hi_u32_u24 v14, 429497, v96
    v_lshrrev_b32 v12, 3, v100
    v_cos_f32 v7, v7
    v_lshlrev_b16 v13, 3, v100
    v_mad_i32_i24 v11, v14, s55, v96
    v_bitop3_b32 v12, v6, v13, v12 bitop3:0xca
    v_lshl_add_u32 v11, v11, 17, s40
    v_lshlrev_b16 v14, 8, v14
    v_lshrrev_b32 v13, 2, v100
    v_add_u32 v96, v12, v11
    v_bitop3_b32 v100, v5, v13, v14 bitop3:0xea
    ds_add_u32 v100, v2
    v_mul_hi_u32_u24 v14, 429497, v97
    v_lshrrev_b32 v12, 3, v101
    v_cos_f32 v8, v8
    v_lshlrev_b16 v13, 3, v101
    v_mad_i32_i24 v11, v14, s55, v97
    v_bitop3_b32 v12, v6, v13, v12 bitop3:0xca
    v_lshl_add_u32 v11, v11, 17, s40
    v_lshlrev_b16 v14, 8, v14
    v_lshrrev_b32 v13, 2, v101
    v_add_u32 v97, v12, v11
    v_bitop3_b32 v101, v5, v13, v14 bitop3:0xea
    ds_add_u32 v101, v2
    v_cvt_pk_bf16_f32 v88, v7, v8
    v_perm_b32 v12, v88, v88, s41
    v_bitop3_b32 v96, v4, v12, v96 bitop3:0xca
    v_perm_b32 v13, v88, v88, s42
    v_bitop3_b32 v97, v4, v13, v97 bitop3:0xca
    v_mul_hi_u32_u24 v14, 429497, v98
    v_lshrrev_b32 v12, 3, v102
    v_cos_f32 v9, v9
    v_lshlrev_b16 v13, 3, v102
    v_mad_i32_i24 v11, v14, s55, v98
    v_bitop3_b32 v12, v6, v13, v12 bitop3:0xca
    v_lshl_add_u32 v11, v11, 17, s40
    v_lshlrev_b16 v14, 8, v14
    v_lshrrev_b32 v13, 2, v102
    v_add_u32 v98, v12, v11
    v_bitop3_b32 v102, v5, v13, v14 bitop3:0xea
    ds_add_u32 v102, v2
    v_mul_hi_u32_u24 v14, 429497, v99
    v_lshrrev_b32 v12, 3, v103
    v_cos_f32 v10, v10
    v_lshlrev_b16 v13, 3, v103
    v_mad_i32_i24 v11, v14, s55, v99
    v_bitop3_b32 v12, v6, v13, v12 bitop3:0xca
    v_lshl_add_u32 v11, v11, 17, s40
    v_lshlrev_b16 v14, 8, v14
    v_lshrrev_b32 v13, 2, v103
    v_add_u32 v99, v12, v11
    v_bitop3_b32 v103, v5, v13, v14 bitop3:0xea
    ds_add_u32 v103, v2
    v_cvt_pk_bf16_f32 v89, v9, v10
    v_perm_b32 v12, v89, v89, s41
    v_bitop3_b32 v98, v4, v12, v98 bitop3:0xca
    v_perm_b32 v13, v89, v89, s42
    v_bitop3_b32 v99, v4, v13, v99 bitop3:0xca
    s_add_u32 s46, s35, 0x2a48000
    buffer_store_dwordx4 v[40:43], v0, s[20:23], s46 offen sc1
    s_add_u32 s47, s33, 0x6000000
    s_nop 0
    buffer_load_dwordx4 v[40:43], v0, s[8:11], s47 offen nt
    s_waitcnt vmcnt(17)
    v_lshlrev_b32 v7, 16, v90
    v_and_b32 v8, 0xffff0000, v90
    v_lshlrev_b32 v9, 16, v91
    v_and_b32 v10, 0xffff0000, v91
    v_mul_f32 v7, 0.15915494, v7
    v_mul_f32 v8, 0.15915494, v8
    v_mul_f32 v9, 0.15915494, v9
    v_mul_f32 v10, 0.15915494, v10
    v_mul_hi_u32_u24 v14, 429497, v108
    v_lshrrev_b32 v12, 3, v112
    v_cos_f32 v7, v7
    v_lshlrev_b16 v13, 3, v112
    v_mad_i32_i24 v11, v14, s55, v108
    v_bitop3_b32 v12, v6, v13, v12 bitop3:0xca
    v_lshl_add_u32 v11, v11, 17, s40
    v_lshlrev_b16 v14, 8, v14
    v_lshrrev_b32 v13, 2, v112
    v_add_u32 v108, v12, v11
    v_bitop3_b32 v112, v5, v13, v14 bitop3:0xea
    ds_add_u32 v112, v2
    v_mul_hi_u32_u24 v14, 429497, v109
    v_lshrrev_b32 v12, 3, v113
    v_cos_f32 v8, v8
    v_lshlrev_b16 v13, 3, v113
    v_mad_i32_i24 v11, v14, s55, v109
    v_bitop3_b32 v12, v6, v13, v12 bitop3:0xca
    v_lshl_add_u32 v11, v11, 17, s40
    v_lshlrev_b16 v14, 8, v14
    v_lshrrev_b32 v13, 2, v113
    v_add_u32 v109, v12, v11
    v_bitop3_b32 v113, v5, v13, v14 bitop3:0xea
    ds_add_u32 v113, v2
    v_cvt_pk_bf16_f32 v90, v7, v8
    v_perm_b32 v12, v90, v90, s41
    v_bitop3_b32 v108, v4, v12, v108 bitop3:0xca
    v_perm_b32 v13, v90, v90, s42
    v_bitop3_b32 v109, v4, v13, v109 bitop3:0xca
    v_mul_hi_u32_u24 v14, 429497, v110
    v_lshrrev_b32 v12, 3, v114
    v_cos_f32 v9, v9
    v_lshlrev_b16 v13, 3, v114
    v_mad_i32_i24 v11, v14, s55, v110
    v_bitop3_b32 v12, v6, v13, v12 bitop3:0xca
    v_lshl_add_u32 v11, v11, 17, s40
    v_lshlrev_b16 v14, 8, v14
    v_lshrrev_b32 v13, 2, v114
    v_add_u32 v110, v12, v11
    v_bitop3_b32 v114, v5, v13, v14 bitop3:0xea
    ds_add_u32 v114, v2
    v_mul_hi_u32_u24 v14, 429497, v111
    v_lshrrev_b32 v12, 3, v115
    v_cos_f32 v10, v10
    v_lshlrev_b16 v13, 3, v115
    v_mad_i32_i24 v11, v14, s55, v111
    v_bitop3_b32 v12, v6, v13, v12 bitop3:0xca
    v_lshl_add_u32 v11, v11, 17, s40
    v_lshlrev_b16 v14, 8, v14
    v_lshrrev_b32 v13, 2, v115
    v_add_u32 v111, v12, v11
    v_bitop3_b32 v115, v5, v13, v14 bitop3:0xea
    ds_add_u32 v115, v2
    v_cvt_pk_bf16_f32 v91, v9, v10
    v_perm_b32 v12, v91, v91, s41
    v_bitop3_b32 v110, v4, v12, v110 bitop3:0xca
    v_perm_b32 v13, v91, v91, s42
    v_bitop3_b32 v111, v4, v13, v111 bitop3:0xca
    s_setprio 1
    s_waitcnt vmcnt(13)
    v_lshlrev_b32 v7, 16, v120
    v_and_b32 v8, 0xffff0000, v120
    v_lshlrev_b32 v9, 16, v121
    v_and_b32 v10, 0xffff0000, v121
    v_mul_f32 v7, 0.15915494, v7
    v_mul_f32 v8, 0.15915494, v8
    v_mul_f32 v9, 0.15915494, v9
    v_mul_f32 v10, 0.15915494, v10
    v_mul_hi_u32_u24 v14, 429497, v104
    v_lshrrev_b32 v12, 3, v116
    v_cos_f32 v7, v7
    v_lshlrev_b16 v13, 3, v116
    v_mad_i32_i24 v11, v14, s55, v104
    v_bitop3_b32 v12, v6, v13, v12 bitop3:0xca
    v_lshl_add_u32 v11, v11, 17, s40
    v_lshlrev_b16 v14, 8, v14
    v_lshrrev_b32 v13, 2, v116
    v_add_u32 v104, v12, v11
    v_bitop3_b32 v116, v5, v13, v14 bitop3:0xea
    ds_add_u32 v116, v2
    v_mul_hi_u32_u24 v14, 429497, v105
    v_lshrrev_b32 v12, 3, v117
    v_cos_f32 v8, v8
    v_lshlrev_b16 v13, 3, v117
    v_mad_i32_i24 v11, v14, s55, v105
    v_bitop3_b32 v12, v6, v13, v12 bitop3:0xca
    v_lshl_add_u32 v11, v11, 17, s40
    v_lshlrev_b16 v14, 8, v14
    v_lshrrev_b32 v13, 2, v117
    v_add_u32 v105, v12, v11
    v_bitop3_b32 v117, v5, v13, v14 bitop3:0xea
    ds_add_u32 v117, v2
    v_cvt_pk_bf16_f32 v120, v7, v8
    v_perm_b32 v12, v120, v120, s41
    v_bitop3_b32 v104, v4, v12, v104 bitop3:0xca
    v_perm_b32 v13, v120, v120, s42
    v_bitop3_b32 v105, v4, v13, v105 bitop3:0xca
    v_mul_hi_u32_u24 v14, 429497, v106
    v_lshrrev_b32 v12, 3, v118
    v_cos_f32 v9, v9
    v_lshlrev_b16 v13, 3, v118
    v_mad_i32_i24 v11, v14, s55, v106
    v_bitop3_b32 v12, v6, v13, v12 bitop3:0xca
    v_lshl_add_u32 v11, v11, 17, s40
    v_lshlrev_b16 v14, 8, v14
    v_lshrrev_b32 v13, 2, v118
    v_add_u32 v106, v12, v11
    v_bitop3_b32 v118, v5, v13, v14 bitop3:0xea
    ds_add_u32 v118, v2
    v_mul_hi_u32_u24 v14, 429497, v107
    v_lshrrev_b32 v12, 3, v119
    v_cos_f32 v10, v10
    v_lshlrev_b16 v13, 3, v119
    v_mad_i32_i24 v11, v14, s55, v107
    v_bitop3_b32 v12, v6, v13, v12 bitop3:0xca
    v_lshl_add_u32 v11, v11, 17, s40
    v_lshlrev_b16 v14, 8, v14
    v_lshrrev_b32 v13, 2, v119
    v_add_u32 v107, v12, v11
    v_bitop3_b32 v119, v5, v13, v14 bitop3:0xea
    ds_add_u32 v119, v2
    v_cvt_pk_bf16_f32 v121, v9, v10
    v_perm_b32 v12, v121, v121, s41
    v_bitop3_b32 v106, v4, v12, v106 bitop3:0xca
    v_perm_b32 v13, v121, v121, s42
    v_bitop3_b32 v107, v4, v13, v107 bitop3:0xca
    s_waitcnt vmcnt(10)
    v_lshlrev_b32 v7, 16, v122
    v_and_b32 v8, 0xffff0000, v122
    v_lshlrev_b32 v9, 16, v123
    v_and_b32 v10, 0xffff0000, v123
    v_mul_f32 v7, 0.15915494, v7
    v_mul_f32 v8, 0.15915494, v8
    v_mul_f32 v9, 0.15915494, v9
    v_mul_f32 v10, 0.15915494, v10
    v_mul_hi_u32_u24 v14, 429497, v92
    v_lshrrev_b32 v12, 3, v16
    v_cos_f32 v7, v7
    v_lshlrev_b16 v13, 3, v16
    v_mad_i32_i24 v11, v14, s55, v92
    v_bitop3_b32 v12, v6, v13, v12 bitop3:0xca
    v_lshl_add_u32 v11, v11, 17, s40
    v_lshlrev_b16 v14, 8, v14
    v_lshrrev_b32 v13, 2, v16
    v_add_u32 v92, v12, v11
    v_bitop3_b32 v16, v5, v13, v14 bitop3:0xea
    ds_add_u32 v16, v2
    v_mul_hi_u32_u24 v14, 429497, v93
    v_lshrrev_b32 v12, 3, v17
    v_cos_f32 v8, v8
    v_lshlrev_b16 v13, 3, v17
    v_mad_i32_i24 v11, v14, s55, v93
    v_bitop3_b32 v12, v6, v13, v12 bitop3:0xca
    v_lshl_add_u32 v11, v11, 17, s40
    v_lshlrev_b16 v14, 8, v14
    v_lshrrev_b32 v13, 2, v17
    v_add_u32 v93, v12, v11
    v_bitop3_b32 v17, v5, v13, v14 bitop3:0xea
    ds_add_u32 v17, v2
    v_cvt_pk_bf16_f32 v122, v7, v8
    v_perm_b32 v12, v122, v122, s41
    v_bitop3_b32 v92, v4, v12, v92 bitop3:0xca
    v_perm_b32 v13, v122, v122, s42
    v_bitop3_b32 v93, v4, v13, v93 bitop3:0xca
    v_mul_hi_u32_u24 v14, 429497, v94
    v_lshrrev_b32 v12, 3, v18
    v_cos_f32 v9, v9
    v_lshlrev_b16 v13, 3, v18
    v_mad_i32_i24 v11, v14, s55, v94
    v_bitop3_b32 v12, v6, v13, v12 bitop3:0xca
    v_lshl_add_u32 v11, v11, 17, s40
    v_lshlrev_b16 v14, 8, v14
    v_lshrrev_b32 v13, 2, v18
    v_add_u32 v94, v12, v11
    v_bitop3_b32 v18, v5, v13, v14 bitop3:0xea
    ds_add_u32 v18, v2
    v_mul_hi_u32_u24 v14, 429497, v95
    v_lshrrev_b32 v12, 3, v19
    v_cos_f32 v10, v10
    v_lshlrev_b16 v13, 3, v19
    v_mad_i32_i24 v11, v14, s55, v95
    v_bitop3_b32 v12, v6, v13, v12 bitop3:0xca
    v_lshl_add_u32 v11, v11, 17, s40
    v_lshlrev_b16 v14, 8, v14
    v_lshrrev_b32 v13, 2, v19
    v_add_u32 v95, v12, v11
    v_bitop3_b32 v19, v5, v13, v14 bitop3:0xea
    ds_add_u32 v19, v2
    v_cvt_pk_bf16_f32 v123, v9, v10
    v_perm_b32 v12, v123, v123, s41
    v_bitop3_b32 v94, v4, v12, v94 bitop3:0xca
    v_perm_b32 v13, v123, v123, s42
    v_bitop3_b32 v95, v4, v13, v95 bitop3:0xca
    s_setprio 0
    s_add_u32 s44, s35, 0x2a4c000
    buffer_store_dwordx4 v[24:27], v0, s[20:23], s44 offen sc1
    s_add_u32 s45, s33, 0x6000000
    s_nop 0
    buffer_load_dwordx4 v[24:27], v0, s[12:15], s45 offen nt
    s_waitcnt vmcnt(8)
    v_lshlrev_b32 v7, 16, v28
    v_and_b32 v8, 0xffff0000, v28
    v_lshlrev_b32 v9, 16, v29
    v_and_b32 v10, 0xffff0000, v29
    v_mul_f32 v7, 0.15915494, v7
    v_mul_f32 v8, 0.15915494, v8
    v_mul_f32 v9, 0.15915494, v9
    v_mul_f32 v10, 0.15915494, v10
    v_mul_hi_u32_u24 v14, 429497, v20
    v_lshrrev_b32 v12, 3, v124
    v_cos_f32 v7, v7
    v_lshlrev_b16 v13, 3, v124
    v_mad_i32_i24 v11, v14, s55, v20
    v_bitop3_b32 v12, v6, v13, v12 bitop3:0xca
    v_lshl_add_u32 v11, v11, 17, s40
    v_lshlrev_b16 v14, 8, v14
    v_lshrrev_b32 v13, 2, v124
    v_add_u32 v20, v12, v11
    v_bitop3_b32 v124, v5, v13, v14 bitop3:0xea
    ds_add_u32 v124, v2
    v_mul_hi_u32_u24 v14, 429497, v21
    v_lshrrev_b32 v12, 3, v125
    v_cos_f32 v8, v8
    v_lshlrev_b16 v13, 3, v125
    v_mad_i32_i24 v11, v14, s55, v21
    v_bitop3_b32 v12, v6, v13, v12 bitop3:0xca
    v_lshl_add_u32 v11, v11, 17, s40
    v_lshlrev_b16 v14, 8, v14
    v_lshrrev_b32 v13, 2, v125
    v_add_u32 v21, v12, v11
    v_bitop3_b32 v125, v5, v13, v14 bitop3:0xea
    ds_add_u32 v125, v2
    v_cvt_pk_bf16_f32 v28, v7, v8
    v_perm_b32 v12, v28, v28, s41
    v_bitop3_b32 v20, v4, v12, v20 bitop3:0xca
    v_perm_b32 v13, v28, v28, s42
    v_bitop3_b32 v21, v4, v13, v21 bitop3:0xca
    v_mul_hi_u32_u24 v14, 429497, v22
    v_lshrrev_b32 v12, 3, v126
    v_cos_f32 v9, v9
    v_lshlrev_b16 v13, 3, v126
    v_mad_i32_i24 v11, v14, s55, v22
    v_bitop3_b32 v12, v6, v13, v12 bitop3:0xca
    v_lshl_add_u32 v11, v11, 17, s40
    v_lshlrev_b16 v14, 8, v14
    v_lshrrev_b32 v13, 2, v126
    v_add_u32 v22, v12, v11
    v_bitop3_b32 v126, v5, v13, v14 bitop3:0xea
    ds_add_u32 v126, v2
    v_mul_hi_u32_u24 v14, 429497, v23
    v_lshrrev_b32 v12, 3, v127
    v_cos_f32 v10, v10
    v_lshlrev_b16 v13, 3, v127
    v_mad_i32_i24 v11, v14, s55, v23
    v_bitop3_b32 v12, v6, v13, v12 bitop3:0xca
    v_lshl_add_u32 v11, v11, 17, s40
    v_lshlrev_b16 v14, 8, v14
    v_lshrrev_b32 v13, 2, v127
    v_add_u32 v23, v12, v11
    v_bitop3_b32 v127, v5, v13, v14 bitop3:0xea
    ds_add_u32 v127, v2
    v_cvt_pk_bf16_f32 v29, v9, v10
    v_perm_b32 v12, v29, v29, s41
    v_bitop3_b32 v22, v4, v12, v22 bitop3:0xca
    v_perm_b32 v13, v29, v29, s42
    v_bitop3_b32 v23, v4, v13, v23 bitop3:0xca
    s_waitcnt vmcnt(4)
    v_lshlrev_b32 v7, 16, v30
    v_and_b32 v8, 0xffff0000, v30
    v_lshlrev_b32 v9, 16, v31
    v_and_b32 v10, 0xffff0000, v31
    v_mul_f32 v7, 0.15915494, v7
    v_mul_f32 v8, 0.15915494, v8
    v_mul_f32 v9, 0.15915494, v9
    v_mul_f32 v10, 0.15915494, v10
    v_mul_hi_u32_u24 v14, 429497, v32
    v_lshrrev_b32 v12, 3, v36
    v_cos_f32 v7, v7
    v_lshlrev_b16 v13, 3, v36
    v_mad_i32_i24 v11, v14, s55, v32
    v_bitop3_b32 v12, v6, v13, v12 bitop3:0xca
    v_lshl_add_u32 v11, v11, 17, s40
    v_lshlrev_b16 v14, 8, v14
    v_lshrrev_b32 v13, 2, v36
    v_add_u32 v32, v12, v11
    v_bitop3_b32 v36, v5, v13, v14 bitop3:0xea
    ds_add_u32 v36, v2
    v_mul_hi_u32_u24 v14, 429497, v33
    v_lshrrev_b32 v12, 3, v37
    v_cos_f32 v8, v8
    v_lshlrev_b16 v13, 3, v37
    v_mad_i32_i24 v11, v14, s55, v33
    v_bitop3_b32 v12, v6, v13, v12 bitop3:0xca
    v_lshl_add_u32 v11, v11, 17, s40
    v_lshlrev_b16 v14, 8, v14
    v_lshrrev_b32 v13, 2, v37
    v_add_u32 v33, v12, v11
    v_bitop3_b32 v37, v5, v13, v14 bitop3:0xea
    ds_add_u32 v37, v2
    v_cvt_pk_bf16_f32 v30, v7, v8
    v_perm_b32 v12, v30, v30, s41
    v_bitop3_b32 v32, v4, v12, v32 bitop3:0xca
    v_perm_b32 v13, v30, v30, s42
    v_bitop3_b32 v33, v4, v13, v33 bitop3:0xca
    v_mul_hi_u32_u24 v14, 429497, v34
    v_lshrrev_b32 v12, 3, v38
    v_cos_f32 v9, v9
    v_lshlrev_b16 v13, 3, v38
    v_mad_i32_i24 v11, v14, s55, v34
    v_bitop3_b32 v12, v6, v13, v12 bitop3:0xca
    v_lshl_add_u32 v11, v11, 17, s40
    v_lshlrev_b16 v14, 8, v14
    v_lshrrev_b32 v13, 2, v38
    v_add_u32 v34, v12, v11
    v_bitop3_b32 v38, v5, v13, v14 bitop3:0xea
    ds_add_u32 v38, v2
    v_mul_hi_u32_u24 v14, 429497, v35
    v_lshrrev_b32 v12, 3, v39
    v_cos_f32 v10, v10
    v_lshlrev_b16 v13, 3, v39
    v_mad_i32_i24 v11, v14, s55, v35
    v_bitop3_b32 v12, v6, v13, v12 bitop3:0xca
    v_lshl_add_u32 v11, v11, 17, s40
    v_lshlrev_b16 v14, 8, v14
    v_lshrrev_b32 v13, 2, v39
    v_add_u32 v35, v12, v11
    v_bitop3_b32 v39, v5, v13, v14 bitop3:0xea
    ds_add_u32 v39, v2
    v_cvt_pk_bf16_f32 v31, v9, v10
    v_perm_b32 v12, v31, v31, s41
    v_bitop3_b32 v34, v4, v12, v34 bitop3:0xca
    v_perm_b32 v13, v31, v31, s42
    v_bitop3_b32 v35, v4, v13, v35 bitop3:0xca
    v_lshrrev_b32 v8, 2, v0
    v_and_b32 v7, 0x3c00, v0
    v_bitop3_b32 v7, v5, v8, v7 bitop3:0xea
    s_waitcnt lgkmcnt(0)
    s_barrier
    ds_read2st64_b32 v[8:9], v7 offset0:0 offset1:1
    ds_read2st64_b32 v[10:11], v7 offset0:2 offset1:3
    s_add_u32 s46, s35, 0x2a50000
    buffer_store_dwordx4 v[84:87], v0, s[20:23], s46 offen sc1
    s_add_u32 s47, s34, 0x3000000
    s_nop 0
    buffer_load_dwordx2 v[84:85], v1, s[16:19], s47 offen nt
    s_add_u32 s44, s34, 0x3200000
    buffer_load_dwordx2 v[86:87], v1, s[16:19], s44 offen nt
    s_waitcnt lgkmcnt(0)
    v_lshl_or_b32 v12, v9, 16, v8
    v_lshl_or_b32 v13, v11, 16, v10
    v_mov_b32 v14, v12
    v_mov_b32 v15, v13
    s_nop 0
    v_add_u32_dpp v14, v14, v14 row_shr:1 row_mask:0xf bank_mask:0xf bound_ctrl:1
    v_add_u32_dpp v15, v15, v15 row_shr:1 row_mask:0xf bank_mask:0xf bound_ctrl:1
    s_nop 0
    v_add_u32_dpp v14, v14, v14 row_shr:2 row_mask:0xf bank_mask:0xf bound_ctrl:1
    v_add_u32_dpp v15, v15, v15 row_shr:2 row_mask:0xf bank_mask:0xf bound_ctrl:1
    s_nop 0
    v_add_u32_dpp v14, v14, v14 row_shr:4 row_mask:0xf bank_mask:0xf bound_ctrl:1
    v_add_u32_dpp v15, v15, v15 row_shr:4 row_mask:0xf bank_mask:0xf bound_ctrl:1
    s_nop 0
    v_add_u32_dpp v14, v14, v14 row_shr:8 row_mask:0xf bank_mask:0xf bound_ctrl:1
    v_add_u32_dpp v15, v15, v15 row_shr:8 row_mask:0xf bank_mask:0xf bound_ctrl:1
    s_nop 0
    v_add_u32_dpp v14, v14, v14 row_bcast:15 row_mask:0xa bank_mask:0xf
    v_add_u32_dpp v15, v15, v15 row_bcast:15 row_mask:0xa bank_mask:0xf
    s_nop 0
    v_add_u32_dpp v14, v14, v14 row_bcast:31 row_mask:0xc bank_mask:0xf
    v_add_u32_dpp v15, v15, v15 row_bcast:31 row_mask:0xc bank_mask:0xf
    v_readlane_b32 s48, v14, 63
    v_readlane_b32 s49, v15, 63
    s_lshl_b32 s54, s32, 2
    v_mov_b32 v8, s54
    s_and_b32 s50, s48, 0xffff
    s_lshr_b32 s51, s48, 16
    s_and_b32 s52, s49, 0xffff
    s_lshr_b32 s53, s49, 16
    s_add_u32 s51, s51, s50
    s_add_u32 s52, s52, s51
    s_add_u32 s53, s53, s52
    v_mov_b32 v9, s53
    s_mov_b64 exec, 1
    ds_write_b32 v8, v9 offset:16384
    s_mov_b64 exec, -1
    v_and_b32 v8, 60, v7
    s_waitcnt lgkmcnt(0)
    s_barrier
    ds_read_b32 v9, v8 offset:16384
    s_waitcnt lgkmcnt(0)
    v_add_u32_dpp v9, v9, v9 row_shr:1 row_mask:0xf bank_mask:0xf bound_ctrl:1
    s_nop 1
    v_add_u32_dpp v9, v9, v9 row_shr:2 row_mask:0xf bank_mask:0xf bound_ctrl:1
    s_nop 1
    v_add_u32_dpp v9, v9, v9 row_shr:4 row_mask:0xf bank_mask:0xf bound_ctrl:1
    s_nop 1
    v_add_u32_dpp v9, v9, v9 row_shr:8 row_mask:0xf bank_mask:0xf bound_ctrl:1
    s_nop 0
    v_readlane_b32 s54, v9, s32
    s_sub_u32 s54, s54, s53
    s_add_u32 s50, s50, s54
    s_add_u32 s51, s51, s54
    s_add_u32 s52, s52, s54
    s_pack_ll_b32_b16 s48, s54, s50
    s_pack_ll_b32_b16 s49, s51, s52
    v_add_u32 v14, s48, v14
    v_add_u32 v15, s49, v15
    v_sub_u32 v12, v14, v12
    v_sub_u32 v13, v15, v13
    v_and_b32 v8, 0xffff, v12
    v_lshrrev_b32 v9, 16, v12
    v_and_b32 v10, 0xffff, v13
    v_lshrrev_b32 v11, 16, v13
    ds_write2st64_b32 v7, v8, v9 offset0:0 offset1:1
    ds_write2st64_b32 v7, v10, v11 offset0:2 offset1:3
    v_and_b32 v8, 0x3f0, v0
    v_lshl_add_u32 v8, v8, 1, s36
    ds_write_b64 v8, v[12:13] offset:20480
    s_bitset0_b64 exec, 63
    s_not_b64 exec, exec
    ds_write_b64 v8, v[14:15] offset:20512
    s_mov_b64 exec, -1
    s_waitcnt lgkmcnt(0)
    s_barrier
    s_setprio 3
    ds_add_rtn_u32 v72, v72, v2
    ds_add_rtn_u32 v73, v73, v2
    ds_add_rtn_u32 v74, v74, v2
    ds_add_rtn_u32 v75, v75, v2
    ds_read_b128 v[12:15], v0 offset:20480
    v_cmp_gt_u32 vcc, 8448, v0
    ds_add_rtn_u32 v80, v80, v2
    ds_add_rtn_u32 v81, v81, v2
    ds_add_rtn_u32 v82, v82, v2
    ds_add_rtn_u32 v83, v83, v2
    s_setprio 2
    ds_add_rtn_u32 v100, v100, v2
    ds_add_rtn_u32 v101, v101, v2
    ds_add_rtn_u32 v102, v102, v2
    ds_add_rtn_u32 v103, v103, v2
    s_waitcnt lgkmcnt(8)
    s_cbranch_vccz L1_p3
    s_add_u32 s45, s35, 0x5480000
    s_mov_b64 exec, vcc
    buffer_store_dwordx4 v[12:15], v0, s[24:27], s45 offen sc1
    s_mov_b64 exec, -1
L1_p3:
    s_add_u32 s46, s35, 0x2a54000
    buffer_store_dwordx4 v[48:51], v0, s[20:23], s46 offen sc1
    s_add_u32 s47, s33, 0x6400000
    s_nop 0
    buffer_load_dwordx4 v[48:51], v0, s[8:11], s47 offen nt
    ds_add_rtn_u32 v112, v112, v2
    ds_add_rtn_u32 v113, v113, v2
    ds_add_rtn_u32 v114, v114, v2
    ds_add_rtn_u32 v115, v115, v2
    s_setprio 1
    ds_add_rtn_u32 v116, v116, v2
    ds_add_rtn_u32 v117, v117, v2
    ds_add_rtn_u32 v118, v118, v2
    ds_add_rtn_u32 v119, v119, v2
    ds_add_rtn_u32 v16, v16, v2
    ds_add_rtn_u32 v17, v17, v2
    ds_add_rtn_u32 v18, v18, v2
    ds_add_rtn_u32 v19, v19, v2
    s_add_u32 s44, s35, 0x2a58000
    buffer_store_dwordx4 v[52:55], v0, s[20:23], s44 offen sc1
    s_add_u32 s45, s33, 0x6400000
    s_nop 0
    buffer_load_dwordx4 v[52:55], v0, s[12:15], s45 offen nt
    s_setprio 0
    ds_add_rtn_u32 v124, v124, v2
    ds_add_rtn_u32 v125, v125, v2
    ds_add_rtn_u32 v126, v126, v2
    ds_add_rtn_u32 v127, v127, v2
    ds_add_rtn_u32 v36, v36, v2
    ds_add_rtn_u32 v37, v37, v2
    ds_add_rtn_u32 v38, v38, v2
    ds_add_rtn_u32 v39, v39, v2
    s_waitcnt lgkmcnt(0)
    s_barrier
    s_setprio 3
    v_and_b32 v7, -4, v72
    v_lshl_add_u32 v8, v72, 2, v7
    ds_write_b32 v8, v68
    v_lshl_add_u32 v7, v7, 2, v72
    ds_write_b8 v7, v64 offset:16
    v_and_b32 v9, -4, v73
    v_lshl_add_u32 v10, v73, 2, v9
    ds_write_b32 v10, v69
    v_lshl_add_u32 v9, v9, 2, v73
    ds_write_b8_d16_hi v9, v64 offset:16
    v_and_b32 v7, -4, v74
    v_lshl_add_u32 v8, v74, 2, v7
    ds_write_b32 v8, v70
    v_lshl_add_u32 v7, v7, 2, v74
    ds_write_b8 v7, v65 offset:16
    v_and_b32 v9, -4, v75
    v_lshl_add_u32 v10, v75, 2, v9
    ds_write_b32 v10, v71
    v_lshl_add_u32 v9, v9, 2, v75
    ds_write_b8_d16_hi v9, v65 offset:16
    s_add_u32 s46, s35, 0x2a5c000
    buffer_store_dwordx4 v[56:59], v0, s[20:23], s46 offen sc1
    s_add_u32 s47, s33, 0x6800000
    buffer_load_dwordx4 v[68:71], v0, s[8:11], s47 offen nt
    s_add_u32 s44, s33, 0x6800000
    buffer_load_dwordx4 v[72:75], v0, s[12:15], s44 offen nt
    v_and_b32 v7, -4, v80
    v_lshl_add_u32 v8, v80, 2, v7
    ds_write_b32 v8, v76
    v_lshl_add_u32 v7, v7, 2, v80
    ds_write_b8 v7, v66 offset:16
    v_and_b32 v9, -4, v81
    v_lshl_add_u32 v10, v81, 2, v9
    ds_write_b32 v10, v77
    v_lshl_add_u32 v9, v9, 2, v81
    ds_write_b8_d16_hi v9, v66 offset:16
    v_and_b32 v7, -4, v82
    v_lshl_add_u32 v8, v82, 2, v7
    ds_write_b32 v8, v78
    v_lshl_add_u32 v7, v7, 2, v82
    ds_write_b8 v7, v67 offset:16
    v_and_b32 v9, -4, v83
    v_lshl_add_u32 v10, v83, 2, v9
    ds_write_b32 v10, v79
    v_lshl_add_u32 v9, v9, 2, v83
    ds_write_b8_d16_hi v9, v67 offset:16
    s_add_u32 s45, s34, 0x3400000
    buffer_load_dwordx2 v[56:57], v1, s[16:19], s45 offen nt
    s_add_u32 s46, s34, 0x3600000
    buffer_load_dwordx2 v[58:59], v1, s[16:19], s46 offen nt
    s_add_u32 s47, s33, 0x6c00000
    buffer_load_dwordx4 v[76:79], v0, s[8:11], s47 offen nt
    s_setprio 2
    v_and_b32 v7, -4, v100
    v_lshl_add_u32 v8, v100, 2, v7
    ds_write_b32 v8, v96
    v_lshl_add_u32 v7, v7, 2, v100
    ds_write_b8 v7, v88 offset:16
    v_and_b32 v9, -4, v101
    v_lshl_add_u32 v10, v101, 2, v9
    ds_write_b32 v10, v97
    v_lshl_add_u32 v9, v9, 2, v101
    ds_write_b8_d16_hi v9, v88 offset:16
    v_and_b32 v7, -4, v102
    v_lshl_add_u32 v8, v102, 2, v7
    ds_write_b32 v8, v98
    v_lshl_add_u32 v7, v7, 2, v102
    ds_write_b8 v7, v89 offset:16
    v_and_b32 v9, -4, v103
    v_lshl_add_u32 v10, v103, 2, v9
    ds_write_b32 v10, v99
    v_lshl_add_u32 v9, v9, 2, v103
    ds_write_b8_d16_hi v9, v89 offset:16
    s_add_u32 s44, s35, 0x2a60000
    buffer_store_dwordx4 v[60:63], v0, s[20:23], s44 offen sc1
    s_add_u32 s45, s33, 0x6c00000
    buffer_load_dwordx4 v[80:83], v0, s[12:15], s45 offen nt
    v_and_b32 v7, -4, v112
    v_lshl_add_u32 v8, v112, 2, v7
    ds_write_b32 v8, v108
    v_lshl_add_u32 v7, v7, 2, v112
    ds_write_b8 v7, v90 offset:16
    v_and_b32 v9, -4, v113
    v_lshl_add_u32 v10, v113, 2, v9
    ds_write_b32 v10, v109
    v_lshl_add_u32 v9, v9, 2, v113
    ds_write_b8_d16_hi v9, v90 offset:16
    v_and_b32 v7, -4, v114
    v_lshl_add_u32 v8, v114, 2, v7
    ds_write_b32 v8, v110
    v_lshl_add_u32 v7, v7, 2, v114
    ds_write_b8 v7, v91 offset:16
    v_and_b32 v9, -4, v115
    v_lshl_add_u32 v10, v115, 2, v9
    ds_write_b32 v10, v111
    v_lshl_add_u32 v9, v9, 2, v115
    ds_write_b8_d16_hi v9, v91 offset:16
    s_add_u32 s46, s33, 0x7000000
    buffer_load_dwordx4 v[64:67], v0, s[8:11], s46 offen nt
    s_add_u32 s47, s33, 0x7000000
    buffer_load_dwordx4 v[96:99], v0, s[12:15], s47 offen nt
    s_setprio 1
    v_and_b32 v7, -4, v116
    v_lshl_add_u32 v8, v116, 2, v7
    ds_write_b32 v8, v104
    v_lshl_add_u32 v7, v7, 2, v116
    ds_write_b8 v7, v120 offset:16
    v_and_b32 v9, -4, v117
    v_lshl_add_u32 v10, v117, 2, v9
    ds_write_b32 v10, v105
    v_lshl_add_u32 v9, v9, 2, v117
    ds_write_b8_d16_hi v9, v120 offset:16
    v_and_b32 v7, -4, v118
    v_lshl_add_u32 v8, v118, 2, v7
    ds_write_b32 v8, v106
    v_lshl_add_u32 v7, v7, 2, v118
    ds_write_b8 v7, v121 offset:16
    v_and_b32 v9, -4, v119
    v_lshl_add_u32 v10, v119, 2, v9
    ds_write_b32 v10, v107
    v_lshl_add_u32 v9, v9, 2, v119
    ds_write_b8_d16_hi v9, v121 offset:16
    s_add_u32 s44, s34, 0x3800000
    buffer_load_dwordx2 v[100:101], v1, s[16:19], s44 offen nt
    s_add_u32 s45, s34, 0x3a00000
    buffer_load_dwordx2 v[102:103], v1, s[16:19], s45 offen nt
    s_add_u32 s46, s33, 0x7400000
    buffer_load_dwordx4 v[60:63], v0, s[8:11], s46 offen nt
    v_and_b32 v7, -4, v16
    v_lshl_add_u32 v8, v16, 2, v7
    ds_write_b32 v8, v92
    v_lshl_add_u32 v7, v7, 2, v16
    ds_write_b8 v7, v122 offset:16
    v_and_b32 v9, -4, v17
    v_lshl_add_u32 v10, v17, 2, v9
    ds_write_b32 v10, v93
    v_lshl_add_u32 v9, v9, 2, v17
    ds_write_b8_d16_hi v9, v122 offset:16
    v_and_b32 v7, -4, v18
    v_lshl_add_u32 v8, v18, 2, v7
    ds_write_b32 v8, v94
    v_lshl_add_u32 v7, v7, 2, v18
    ds_write_b8 v7, v123 offset:16
    v_and_b32 v9, -4, v19
    v_lshl_add_u32 v10, v19, 2, v9
    ds_write_b32 v10, v95
    v_lshl_add_u32 v9, v9, 2, v19
    ds_write_b8_d16_hi v9, v123 offset:16
    s_add_u32 s47, s35, 0x2a64000
    buffer_store_dwordx4 v[44:47], v0, s[20:23], s47 offen sc1
    s_add_u32 s44, s33, 0x7400000
    buffer_load_dwordx4 v[108:111], v0, s[12:15], s44 offen nt
    s_setprio 0
    v_and_b32 v7, -4, v124
    v_lshl_add_u32 v8, v124, 2, v7
    ds_write_b32 v8, v20
    v_lshl_add_u32 v7, v7, 2, v124
    ds_write_b8 v7, v28 offset:16
    v_and_b32 v9, -4, v125
    v_lshl_add_u32 v10, v125, 2, v9
    ds_write_b32 v10, v21
    v_lshl_add_u32 v9, v9, 2, v125
    ds_write_b8_d16_hi v9, v28 offset:16
    v_and_b32 v7, -4, v126
    v_lshl_add_u32 v8, v126, 2, v7
    ds_write_b32 v8, v22
    v_lshl_add_u32 v7, v7, 2, v126
    ds_write_b8 v7, v29 offset:16
    v_and_b32 v9, -4, v127
    v_lshl_add_u32 v10, v127, 2, v9
    ds_write_b32 v10, v23
    v_lshl_add_u32 v9, v9, 2, v127
    ds_write_b8_d16_hi v9, v29 offset:16
    s_add_u32 s45, s33, 0x7800000
    buffer_load_dwordx4 v[112:115], v0, s[8:11], s45 offen nt
    s_add_u32 s46, s33, 0x7800000
    buffer_load_dwordx4 v[88:91], v0, s[12:15], s46 offen nt
    v_and_b32 v7, -4, v36
    v_lshl_add_u32 v8, v36, 2, v7
    ds_write_b32 v8, v32
    v_lshl_add_u32 v7, v7, 2, v36
    ds_write_b8 v7, v30 offset:16
    v_and_b32 v9, -4, v37
    v_lshl_add_u32 v10, v37, 2, v9
    ds_write_b32 v10, v33
    v_lshl_add_u32 v9, v9, 2, v37
    ds_write_b8_d16_hi v9, v30 offset:16
    v_and_b32 v7, -4, v38
    v_lshl_add_u32 v8, v38, 2, v7
    ds_write_b32 v8, v34
    v_lshl_add_u32 v7, v7, 2, v38
    ds_write_b8 v7, v31 offset:16
    v_and_b32 v9, -4, v39
    v_lshl_add_u32 v10, v39, 2, v9
    ds_write_b32 v10, v35
    v_lshl_add_u32 v9, v9, 2, v39
    ds_write_b8_d16_hi v9, v31 offset:16
    s_add_u32 s47, s34, 0x3c00000
    buffer_load_dwordx2 v[104:105], v1, s[16:19], s47 offen nt
    s_add_u32 s44, s34, 0x3e00000
    buffer_load_dwordx2 v[106:107], v1, s[16:19], s44 offen nt
    v_add_u32 v7, 0x10000, v0
    v_add_u32 v12, 0x20000, v0
    v_mov_b32 v8, 0
    v_mov_b32 v9, 0
    v_mov_b32 v10, 0
    v_mov_b32 v11, 0
    s_waitcnt lgkmcnt(0)
    s_barrier
    ds_read_b128 v[116:119], v0 offset:0
    ds_write_b128 v0, v[8:11]
    ds_read_b128 v[92:95], v0 offset:16384
    ds_read_b128 v[16:19], v0 offset:32768
    ds_read_b128 v[120:123], v0 offset:49152
    ds_read_b128 v[44:47], v7 offset:0
    ds_read_b128 v[20:23], v7 offset:16384
    ds_read_b128 v[124:127], v7 offset:32768
    ds_read_b128 v[32:35], v7 offset:49152
    ds_read_b128 v[36:39], v12 offset:0
    ds_read_b128 v[28:31], v12 offset:16384
    s_waitcnt lgkmcnt(0)
    s_barrier
    s_setprio 3
    s_add_u32 s45, s35, 0x5480000
    buffer_store_dwordx4 v[116:119], v0, s[20:23], s45 offen sc1
    s_add_u32 s46, s33, 0x7c00000
    s_nop 0
    buffer_load_dwordx4 v[116:119], v0, s[8:11], s46 offen nt
    s_add_u32 s47, s35, 0x5484000
    buffer_store_dwordx4 v[92:95], v0, s[20:23], s47 offen sc1
    s_add_u32 s44, s33, 0x7c00000
    s_nop 0
    buffer_load_dwordx4 v[92:95], v0, s[12:15], s44 offen nt
    s_waitcnt vmcnt(27)
    v_lshlrev_b32 v7, 16, v84
    v_and_b32 v8, 0xffff0000, v84
    v_lshlrev_b32 v9, 16, v85
    v_and_b32 v10, 0xffff0000, v85
    v_mul_f32 v7, 0.15915494, v7
    v_mul_f32 v8, 0.15915494, v8
    v_mul_f32 v9, 0.15915494, v9
    v_mul_f32 v10, 0.15915494, v10
    v_mul_hi_u32_u24 v14, 429497, v40
    v_lshrrev_b32 v12, 3, v24
    v_cos_f32 v7, v7
    v_lshlrev_b16 v13, 3, v24
    v_mad_i32_i24 v11, v14, s55, v40
    v_bitop3_b32 v12, v6, v13, v12 bitop3:0xca
    v_lshl_add_u32 v11, v11, 17, s40
    v_lshlrev_b16 v14, 8, v14
    v_lshrrev_b32 v13, 2, v24
    v_add_u32 v40, v12, v11
    v_bitop3_b32 v24, v5, v13, v14 bitop3:0xea
    ds_add_u32 v24, v2
    v_mul_hi_u32_u24 v14, 429497, v41
    v_lshrrev_b32 v12, 3, v25
    v_cos_f32 v8, v8
    v_lshlrev_b16 v13, 3, v25
    v_mad_i32_i24 v11, v14, s55, v41
    v_bitop3_b32 v12, v6, v13, v12 bitop3:0xca
    v_lshl_add_u32 v11, v11, 17, s40
    v_lshlrev_b16 v14, 8, v14
    v_lshrrev_b32 v13, 2, v25
    v_add_u32 v41, v12, v11
    v_bitop3_b32 v25, v5, v13, v14 bitop3:0xea
    ds_add_u32 v25, v2
    v_cvt_pk_bf16_f32 v84, v7, v8
    v_perm_b32 v12, v84, v84, s41
    v_bitop3_b32 v40, v4, v12, v40 bitop3:0xca
    v_perm_b32 v13, v84, v84, s42
    v_bitop3_b32 v41, v4, v13, v41 bitop3:0xca
    v_mul_hi_u32_u24 v14, 429497, v42
    v_lshrrev_b32 v12, 3, v26
    v_cos_f32 v9, v9
    v_lshlrev_b16 v13, 3, v26
    v_mad_i32_i24 v11, v14, s55, v42
    v_bitop3_b32 v12, v6, v13, v12 bitop3:0xca
    v_lshl_add_u32 v11, v11, 17, s40
    v_lshlrev_b16 v14, 8, v14
    v_lshrrev_b32 v13, 2, v26
    v_add_u32 v42, v12, v11
    v_bitop3_b32 v26, v5, v13, v14 bitop3:0xea
    ds_add_u32 v26, v2
    v_mul_hi_u32_u24 v14, 429497, v43
    v_lshrrev_b32 v12, 3, v27
    v_cos_f32 v10, v10
    v_lshlrev_b16 v13, 3, v27
    v_mad_i32_i24 v11, v14, s55, v43
    v_bitop3_b32 v12, v6, v13, v12 bitop3:0xca
    v_lshl_add_u32 v11, v11, 17, s40
    v_lshlrev_b16 v14, 8, v14
    v_lshrrev_b32 v13, 2, v27
    v_add_u32 v43, v12, v11
    v_bitop3_b32 v27, v5, v13, v14 bitop3:0xea
    ds_add_u32 v27, v2
    v_cvt_pk_bf16_f32 v85, v9, v10
    v_perm_b32 v12, v85, v85, s41
    v_bitop3_b32 v42, v4, v12, v42 bitop3:0xca
    v_perm_b32 v13, v85, v85, s42
    v_bitop3_b32 v43, v4, v13, v43 bitop3:0xca
    s_waitcnt vmcnt(23)
    v_lshlrev_b32 v7, 16, v86
    v_and_b32 v8, 0xffff0000, v86
    v_lshlrev_b32 v9, 16, v87
    v_and_b32 v10, 0xffff0000, v87
    v_mul_f32 v7, 0.15915494, v7
    v_mul_f32 v8, 0.15915494, v8
    v_mul_f32 v9, 0.15915494, v9
    v_mul_f32 v10, 0.15915494, v10
    v_mul_hi_u32_u24 v14, 429497, v48
    v_lshrrev_b32 v12, 3, v52
    v_cos_f32 v7, v7
    v_lshlrev_b16 v13, 3, v52
    v_mad_i32_i24 v11, v14, s55, v48
    v_bitop3_b32 v12, v6, v13, v12 bitop3:0xca
    v_lshl_add_u32 v11, v11, 17, s40
    v_lshlrev_b16 v14, 8, v14
    v_lshrrev_b32 v13, 2, v52
    v_add_u32 v48, v12, v11
    v_bitop3_b32 v52, v5, v13, v14 bitop3:0xea
    ds_add_u32 v52, v2
    v_mul_hi_u32_u24 v14, 429497, v49
    v_lshrrev_b32 v12, 3, v53
    v_cos_f32 v8, v8
    v_lshlrev_b16 v13, 3, v53
    v_mad_i32_i24 v11, v14, s55, v49
    v_bitop3_b32 v12, v6, v13, v12 bitop3:0xca
    v_lshl_add_u32 v11, v11, 17, s40
    v_lshlrev_b16 v14, 8, v14
    v_lshrrev_b32 v13, 2, v53
    v_add_u32 v49, v12, v11
    v_bitop3_b32 v53, v5, v13, v14 bitop3:0xea
    ds_add_u32 v53, v2
    v_cvt_pk_bf16_f32 v86, v7, v8
    v_perm_b32 v12, v86, v86, s41
    v_bitop3_b32 v48, v4, v12, v48 bitop3:0xca
    v_perm_b32 v13, v86, v86, s42
    v_bitop3_b32 v49, v4, v13, v49 bitop3:0xca
    v_mul_hi_u32_u24 v14, 429497, v50
    v_lshrrev_b32 v12, 3, v54
    v_cos_f32 v9, v9
    v_lshlrev_b16 v13, 3, v54
    v_mad_i32_i24 v11, v14, s55, v50
    v_bitop3_b32 v12, v6, v13, v12 bitop3:0xca
    v_lshl_add_u32 v11, v11, 17, s40
    v_lshlrev_b16 v14, 8, v14
    v_lshrrev_b32 v13, 2, v54
    v_add_u32 v50, v12, v11
    v_bitop3_b32 v54, v5, v13, v14 bitop3:0xea
    ds_add_u32 v54, v2
    v_mul_hi_u32_u24 v14, 429497, v51
    v_lshrrev_b32 v12, 3, v55
    v_cos_f32 v10, v10
    v_lshlrev_b16 v13, 3, v55
    v_mad_i32_i24 v11, v14, s55, v51
    v_bitop3_b32 v12, v6, v13, v12 bitop3:0xca
    v_lshl_add_u32 v11, v11, 17, s40
    v_lshlrev_b16 v14, 8, v14
    v_lshrrev_b32 v13, 2, v55
    v_add_u32 v51, v12, v11
    v_bitop3_b32 v55, v5, v13, v14 bitop3:0xea
    ds_add_u32 v55, v2
    v_cvt_pk_bf16_f32 v87, v9, v10
    v_perm_b32 v12, v87, v87, s41
    v_bitop3_b32 v50, v4, v12, v50 bitop3:0xca
    v_perm_b32 v13, v87, v87, s42
    v_bitop3_b32 v51, v4, v13, v51 bitop3:0xca
    s_setprio 2
    s_waitcnt vmcnt(18)
    v_lshlrev_b32 v7, 16, v56
    v_and_b32 v8, 0xffff0000, v56
    v_lshlrev_b32 v9, 16, v57
    v_and_b32 v10, 0xffff0000, v57
    v_mul_f32 v7, 0.15915494, v7
    v_mul_f32 v8, 0.15915494, v8
    v_mul_f32 v9, 0.15915494, v9
    v_mul_f32 v10, 0.15915494, v10
    v_mul_hi_u32_u24 v14, 429497, v68
    v_lshrrev_b32 v12, 3, v72
    v_cos_f32 v7, v7
    v_lshlrev_b16 v13, 3, v72
    v_mad_i32_i24 v11, v14, s55, v68
    v_bitop3_b32 v12, v6, v13, v12 bitop3:0xca
    v_lshl_add_u32 v11, v11, 17, s40
    v_lshlrev_b16 v14, 8, v14
    v_lshrrev_b32 v13, 2, v72
    v_add_u32 v68, v12, v11
    v_bitop3_b32 v72, v5, v13, v14 bitop3:0xea
    ds_add_u32 v72, v2
    v_mul_hi_u32_u24 v14, 429497, v69
    v_lshrrev_b32 v12, 3, v73
    v_cos_f32 v8, v8
    v_lshlrev_b16 v13, 3, v73
    v_mad_i32_i24 v11, v14, s55, v69
    v_bitop3_b32 v12, v6, v13, v12 bitop3:0xca
    v_lshl_add_u32 v11, v11, 17, s40
    v_lshlrev_b16 v14, 8, v14
    v_lshrrev_b32 v13, 2, v73
    v_add_u32 v69, v12, v11
    v_bitop3_b32 v73, v5, v13, v14 bitop3:0xea
    ds_add_u32 v73, v2
    v_cvt_pk_bf16_f32 v56, v7, v8
    v_perm_b32 v12, v56, v56, s41
    v_bitop3_b32 v68, v4, v12, v68 bitop3:0xca
    v_perm_b32 v13, v56, v56, s42
    v_bitop3_b32 v69, v4, v13, v69 bitop3:0xca
    v_mul_hi_u32_u24 v14, 429497, v70
    v_lshrrev_b32 v12, 3, v74
    v_cos_f32 v9, v9
    v_lshlrev_b16 v13, 3, v74
    v_mad_i32_i24 v11, v14, s55, v70
    v_bitop3_b32 v12, v6, v13, v12 bitop3:0xca
    v_lshl_add_u32 v11, v11, 17, s40
    v_lshlrev_b16 v14, 8, v14
    v_lshrrev_b32 v13, 2, v74
    v_add_u32 v70, v12, v11
    v_bitop3_b32 v74, v5, v13, v14 bitop3:0xea
    ds_add_u32 v74, v2
    v_mul_hi_u32_u24 v14, 429497, v71
    v_lshrrev_b32 v12, 3, v75
    v_cos_f32 v10, v10
    v_lshlrev_b16 v13, 3, v75
    v_mad_i32_i24 v11, v14, s55, v71
    v_bitop3_b32 v12, v6, v13, v12 bitop3:0xca
    v_lshl_add_u32 v11, v11, 17, s40
    v_lshlrev_b16 v14, 8, v14
    v_lshrrev_b32 v13, 2, v75
    v_add_u32 v71, v12, v11
    v_bitop3_b32 v75, v5, v13, v14 bitop3:0xea
    ds_add_u32 v75, v2
    v_cvt_pk_bf16_f32 v57, v9, v10
    v_perm_b32 v12, v57, v57, s41
    v_bitop3_b32 v70, v4, v12, v70 bitop3:0xca
    v_perm_b32 v13, v57, v57, s42
    v_bitop3_b32 v71, v4, v13, v71 bitop3:0xca
    s_add_u32 s45, s35, 0x5488000
    buffer_store_dwordx4 v[16:19], v0, s[20:23], s45 offen sc1
    s_add_u32 s46, s33, 0x8000000
    s_nop 0
    buffer_load_dwordx4 v[16:19], v0, s[8:11], s46 offen nt
    s_waitcnt vmcnt(17)
    v_lshlrev_b32 v7, 16, v58
    v_and_b32 v8, 0xffff0000, v58
    v_lshlrev_b32 v9, 16, v59
    v_and_b32 v10, 0xffff0000, v59
    v_mul_f32 v7, 0.15915494, v7
    v_mul_f32 v8, 0.15915494, v8
    v_mul_f32 v9, 0.15915494, v9
    v_mul_f32 v10, 0.15915494, v10
    v_mul_hi_u32_u24 v14, 429497, v76
    v_lshrrev_b32 v12, 3, v80
    v_cos_f32 v7, v7
    v_lshlrev_b16 v13, 3, v80
    v_mad_i32_i24 v11, v14, s55, v76
    v_bitop3_b32 v12, v6, v13, v12 bitop3:0xca
    v_lshl_add_u32 v11, v11, 17, s40
    v_lshlrev_b16 v14, 8, v14
    v_lshrrev_b32 v13, 2, v80
    v_add_u32 v76, v12, v11
    v_bitop3_b32 v80, v5, v13, v14 bitop3:0xea
    ds_add_u32 v80, v2
    v_mul_hi_u32_u24 v14, 429497, v77
    v_lshrrev_b32 v12, 3, v81
    v_cos_f32 v8, v8
    v_lshlrev_b16 v13, 3, v81
    v_mad_i32_i24 v11, v14, s55, v77
    v_bitop3_b32 v12, v6, v13, v12 bitop3:0xca
    v_lshl_add_u32 v11, v11, 17, s40
    v_lshlrev_b16 v14, 8, v14
    v_lshrrev_b32 v13, 2, v81
    v_add_u32 v77, v12, v11
    v_bitop3_b32 v81, v5, v13, v14 bitop3:0xea
    ds_add_u32 v81, v2
    v_cvt_pk_bf16_f32 v58, v7, v8
    v_perm_b32 v12, v58, v58, s41
    v_bitop3_b32 v76, v4, v12, v76 bitop3:0xca
    v_perm_b32 v13, v58, v58, s42
    v_bitop3_b32 v77, v4, v13, v77 bitop3:0xca
    v_mul_hi_u32_u24 v14, 429497, v78
    v_lshrrev_b32 v12, 3, v82
    v_cos_f32 v9, v9
    v_lshlrev_b16 v13, 3, v82
    v_mad_i32_i24 v11, v14, s55, v78
    v_bitop3_b32 v12, v6, v13, v12 bitop3:0xca
    v_lshl_add_u32 v11, v11, 17, s40
    v_lshlrev_b16 v14, 8, v14
    v_lshrrev_b32 v13, 2, v82
    v_add_u32 v78, v12, v11
    v_bitop3_b32 v82, v5, v13, v14 bitop3:0xea
    ds_add_u32 v82, v2
    v_mul_hi_u32_u24 v14, 429497, v79
    v_lshrrev_b32 v12, 3, v83
    v_cos_f32 v10, v10
    v_lshlrev_b16 v13, 3, v83
    v_mad_i32_i24 v11, v14, s55, v79
    v_bitop3_b32 v12, v6, v13, v12 bitop3:0xca
    v_lshl_add_u32 v11, v11, 17, s40
    v_lshlrev_b16 v14, 8, v14
    v_lshrrev_b32 v13, 2, v83
    v_add_u32 v79, v12, v11
    v_bitop3_b32 v83, v5, v13, v14 bitop3:0xea
    ds_add_u32 v83, v2
    v_cvt_pk_bf16_f32 v59, v9, v10
    v_perm_b32 v12, v59, v59, s41
    v_bitop3_b32 v78, v4, v12, v78 bitop3:0xca
    v_perm_b32 v13, v59, v59, s42
    v_bitop3_b32 v79, v4, v13, v79 bitop3:0xca
    s_setprio 1
    s_waitcnt vmcnt(13)
    v_lshlrev_b32 v7, 16, v100
    v_and_b32 v8, 0xffff0000, v100
    v_lshlrev_b32 v9, 16, v101
    v_and_b32 v10, 0xffff0000, v101
    v_mul_f32 v7, 0.15915494, v7
    v_mul_f32 v8, 0.15915494, v8
    v_mul_f32 v9, 0.15915494, v9
    v_mul_f32 v10, 0.15915494, v10
    v_mul_hi_u32_u24 v14, 429497, v64
    v_lshrrev_b32 v12, 3, v96
    v_cos_f32 v7, v7
    v_lshlrev_b16 v13, 3, v96
    v_mad_i32_i24 v11, v14, s55, v64
    v_bitop3_b32 v12, v6, v13, v12 bitop3:0xca
    v_lshl_add_u32 v11, v11, 17, s40
    v_lshlrev_b16 v14, 8, v14
    v_lshrrev_b32 v13, 2, v96
    v_add_u32 v64, v12, v11
    v_bitop3_b32 v96, v5, v13, v14 bitop3:0xea
    ds_add_u32 v96, v2
    v_mul_hi_u32_u24 v14, 429497, v65
    v_lshrrev_b32 v12, 3, v97
    v_cos_f32 v8, v8
    v_lshlrev_b16 v13, 3, v97
    v_mad_i32_i24 v11, v14, s55, v65
    v_bitop3_b32 v12, v6, v13, v12 bitop3:0xca
    v_lshl_add_u32 v11, v11, 17, s40
    v_lshlrev_b16 v14, 8, v14
    v_lshrrev_b32 v13, 2, v97
    v_add_u32 v65, v12, v11
    v_bitop3_b32 v97, v5, v13, v14 bitop3:0xea
    ds_add_u32 v97, v2
    v_cvt_pk_bf16_f32 v100, v7, v8
    v_perm_b32 v12, v100, v100, s41
    v_bitop3_b32 v64, v4, v12, v64 bitop3:0xca
    v_perm_b32 v13, v100, v100, s42
    v_bitop3_b32 v65, v4, v13, v65 bitop3:0xca
    v_mul_hi_u32_u24 v14, 429497, v66
    v_lshrrev_b32 v12, 3, v98
    v_cos_f32 v9, v9
    v_lshlrev_b16 v13, 3, v98
    v_mad_i32_i24 v11, v14, s55, v66
    v_bitop3_b32 v12, v6, v13, v12 bitop3:0xca
    v_lshl_add_u32 v11, v11, 17, s40
    v_lshlrev_b16 v14, 8, v14
    v_lshrrev_b32 v13, 2, v98
    v_add_u32 v66, v12, v11
    v_bitop3_b32 v98, v5, v13, v14 bitop3:0xea
    ds_add_u32 v98, v2
    v_mul_hi_u32_u24 v14, 429497, v67
    v_lshrrev_b32 v12, 3, v99
    v_cos_f32 v10, v10
    v_lshlrev_b16 v13, 3, v99
    v_mad_i32_i24 v11, v14, s55, v67
    v_bitop3_b32 v12, v6, v13, v12 bitop3:0xca
    v_lshl_add_u32 v11, v11, 17, s40
    v_lshlrev_b16 v14, 8, v14
    v_lshrrev_b32 v13, 2, v99
    v_add_u32 v67, v12, v11
    v_bitop3_b32 v99, v5, v13, v14 bitop3:0xea
    ds_add_u32 v99, v2
    v_cvt_pk_bf16_f32 v101, v9, v10
    v_perm_b32 v12, v101, v101, s41
    v_bitop3_b32 v66, v4, v12, v66 bitop3:0xca
    v_perm_b32 v13, v101, v101, s42
    v_bitop3_b32 v67, v4, v13, v67 bitop3:0xca
    s_waitcnt vmcnt(10)
    v_lshlrev_b32 v7, 16, v102
    v_and_b32 v8, 0xffff0000, v102
    v_lshlrev_b32 v9, 16, v103
    v_and_b32 v10, 0xffff0000, v103
    v_mul_f32 v7, 0.15915494, v7
    v_mul_f32 v8, 0.15915494, v8
    v_mul_f32 v9, 0.15915494, v9
    v_mul_f32 v10, 0.15915494, v10
    v_mul_hi_u32_u24 v14, 429497, v60
    v_lshrrev_b32 v12, 3, v108
    v_cos_f32 v7, v7
    v_lshlrev_b16 v13, 3, v108
    v_mad_i32_i24 v11, v14, s55, v60
    v_bitop3_b32 v12, v6, v13, v12 bitop3:0xca
    v_lshl_add_u32 v11, v11, 17, s40
    v_lshlrev_b16 v14, 8, v14
    v_lshrrev_b32 v13, 2, v108
    v_add_u32 v60, v12, v11
    v_bitop3_b32 v108, v5, v13, v14 bitop3:0xea
    ds_add_u32 v108, v2
    v_mul_hi_u32_u24 v14, 429497, v61
    v_lshrrev_b32 v12, 3, v109
    v_cos_f32 v8, v8
    v_lshlrev_b16 v13, 3, v109
    v_mad_i32_i24 v11, v14, s55, v61
    v_bitop3_b32 v12, v6, v13, v12 bitop3:0xca
    v_lshl_add_u32 v11, v11, 17, s40
    v_lshlrev_b16 v14, 8, v14
    v_lshrrev_b32 v13, 2, v109
    v_add_u32 v61, v12, v11
    v_bitop3_b32 v109, v5, v13, v14 bitop3:0xea
    ds_add_u32 v109, v2
    v_cvt_pk_bf16_f32 v102, v7, v8
    v_perm_b32 v12, v102, v102, s41
    v_bitop3_b32 v60, v4, v12, v60 bitop3:0xca
    v_perm_b32 v13, v102, v102, s42
    v_bitop3_b32 v61, v4, v13, v61 bitop3:0xca
    v_mul_hi_u32_u24 v14, 429497, v62
    v_lshrrev_b32 v12, 3, v110
    v_cos_f32 v9, v9
    v_lshlrev_b16 v13, 3, v110
    v_mad_i32_i24 v11, v14, s55, v62
    v_bitop3_b32 v12, v6, v13, v12 bitop3:0xca
    v_lshl_add_u32 v11, v11, 17, s40
    v_lshlrev_b16 v14, 8, v14
    v_lshrrev_b32 v13, 2, v110
    v_add_u32 v62, v12, v11
    v_bitop3_b32 v110, v5, v13, v14 bitop3:0xea
    ds_add_u32 v110, v2
    v_mul_hi_u32_u24 v14, 429497, v63
    v_lshrrev_b32 v12, 3, v111
    v_cos_f32 v10, v10
    v_lshlrev_b16 v13, 3, v111
    v_mad_i32_i24 v11, v14, s55, v63
    v_bitop3_b32 v12, v6, v13, v12 bitop3:0xca
    v_lshl_add_u32 v11, v11, 17, s40
    v_lshlrev_b16 v14, 8, v14
    v_lshrrev_b32 v13, 2, v111
    v_add_u32 v63, v12, v11
    v_bitop3_b32 v111, v5, v13, v14 bitop3:0xea
    ds_add_u32 v111, v2
    v_cvt_pk_bf16_f32 v103, v9, v10
    v_perm_b32 v12, v103, v103, s41
    v_bitop3_b32 v62, v4, v12, v62 bitop3:0xca
    v_perm_b32 v13, v103, v103, s42
    v_bitop3_b32 v63, v4, v13, v63 bitop3:0xca
    s_setprio 0
    s_add_u32 s47, s35, 0x548c000
    buffer_store_dwordx4 v[120:123], v0, s[20:23], s47 offen sc1
    s_add_u32 s44, s33, 0x8000000
    s_nop 0
    buffer_load_dwordx4 v[120:123], v0, s[12:15], s44 offen nt
    s_waitcnt vmcnt(8)
    v_lshlrev_b32 v7, 16, v104
    v_and_b32 v8, 0xffff0000, v104
    v_lshlrev_b32 v9, 16, v105
    v_and_b32 v10, 0xffff0000, v105
    v_mul_f32 v7, 0.15915494, v7
    v_mul_f32 v8, 0.15915494, v8
    v_mul_f32 v9, 0.15915494, v9
    v_mul_f32 v10, 0.15915494, v10
    v_mul_hi_u32_u24 v14, 429497, v112
    v_lshrrev_b32 v12, 3, v88
    v_cos_f32 v7, v7
    v_lshlrev_b16 v13, 3, v88
    v_mad_i32_i24 v11, v14, s55, v112
    v_bitop3_b32 v12, v6, v13, v12 bitop3:0xca
    v_lshl_add_u32 v11, v11, 17, s40
    v_lshlrev_b16 v14, 8, v14
    v_lshrrev_b32 v13, 2, v88
    v_add_u32 v112, v12, v11
    v_bitop3_b32 v88, v5, v13, v14 bitop3:0xea
    ds_add_u32 v88, v2
    v_mul_hi_u32_u24 v14, 429497, v113
    v_lshrrev_b32 v12, 3, v89
    v_cos_f32 v8, v8
    v_lshlrev_b16 v13, 3, v89
    v_mad_i32_i24 v11, v14, s55, v113
    v_bitop3_b32 v12, v6, v13, v12 bitop3:0xca
    v_lshl_add_u32 v11, v11, 17, s40
    v_lshlrev_b16 v14, 8, v14
    v_lshrrev_b32 v13, 2, v89
    v_add_u32 v113, v12, v11
    v_bitop3_b32 v89, v5, v13, v14 bitop3:0xea
    ds_add_u32 v89, v2
    v_cvt_pk_bf16_f32 v104, v7, v8
    v_perm_b32 v12, v104, v104, s41
    v_bitop3_b32 v112, v4, v12, v112 bitop3:0xca
    v_perm_b32 v13, v104, v104, s42
    v_bitop3_b32 v113, v4, v13, v113 bitop3:0xca
    v_mul_hi_u32_u24 v14, 429497, v114
    v_lshrrev_b32 v12, 3, v90
    v_cos_f32 v9, v9
    v_lshlrev_b16 v13, 3, v90
    v_mad_i32_i24 v11, v14, s55, v114
    v_bitop3_b32 v12, v6, v13, v12 bitop3:0xca
    v_lshl_add_u32 v11, v11, 17, s40
    v_lshlrev_b16 v14, 8, v14
    v_lshrrev_b32 v13, 2, v90
    v_add_u32 v114, v12, v11
    v_bitop3_b32 v90, v5, v13, v14 bitop3:0xea
    ds_add_u32 v90, v2
    v_mul_hi_u32_u24 v14, 429497, v115
    v_lshrrev_b32 v12, 3, v91
    v_cos_f32 v10, v10
    v_lshlrev_b16 v13, 3, v91
    v_mad_i32_i24 v11, v14, s55, v115
    v_bitop3_b32 v12, v6, v13, v12 bitop3:0xca
    v_lshl_add_u32 v11, v11, 17, s40
    v_lshlrev_b16 v14, 8, v14
    v_lshrrev_b32 v13, 2, v91
    v_add_u32 v115, v12, v11
    v_bitop3_b32 v91, v5, v13, v14 bitop3:0xea
    ds_add_u32 v91, v2
    v_cvt_pk_bf16_f32 v105, v9, v10
    v_perm_b32 v12, v105, v105, s41
    v_bitop3_b32 v114, v4, v12, v114 bitop3:0xca
    v_perm_b32 v13, v105, v105, s42
    v_bitop3_b32 v115, v4, v13, v115 bitop3:0xca
    s_mov_b32 s68, s56
    s_mov_b32 s69, s57
    s_mov_b32 s70, 0x100
    s_mov_b32 s71, 0x20000
    v_mov_b32 v3, 1
    s_cmp_lg_u32 s32, 15
    s_cbranch_scc1 L1_tk
    s_mov_b64 exec, 1
    buffer_atomic_add v3, off, s[68:71], 0 sc0
    s_mov_b64 exec, -1
L1_tk:
    s_waitcnt vmcnt(4)
    v_lshlrev_b32 v7, 16, v106
    v_and_b32 v8, 0xffff0000, v106
    v_lshlrev_b32 v9, 16, v107
    v_and_b32 v10, 0xffff0000, v107
    v_mul_f32 v7, 0.15915494, v7
    v_mul_f32 v8, 0.15915494, v8
    v_mul_f32 v9, 0.15915494, v9
    v_mul_f32 v10, 0.15915494, v10
    v_mul_hi_u32_u24 v14, 429497, v116
    v_lshrrev_b32 v12, 3, v92
    v_cos_f32 v7, v7
    v_lshlrev_b16 v13, 3, v92
    v_mad_i32_i24 v11, v14, s55, v116
    v_bitop3_b32 v12, v6, v13, v12 bitop3:0xca
    v_lshl_add_u32 v11, v11, 17, s40
    v_lshlrev_b16 v14, 8, v14
    v_lshrrev_b32 v13, 2, v92
    v_add_u32 v116, v12, v11
    v_bitop3_b32 v92, v5, v13, v14 bitop3:0xea
    ds_add_u32 v92, v2
    v_mul_hi_u32_u24 v14, 429497, v117
    v_lshrrev_b32 v12, 3, v93
    v_cos_f32 v8, v8
    v_lshlrev_b16 v13, 3, v93
    v_mad_i32_i24 v11, v14, s55, v117
    v_bitop3_b32 v12, v6, v13, v12 bitop3:0xca
    v_lshl_add_u32 v11, v11, 17, s40
    v_lshlrev_b16 v14, 8, v14
    v_lshrrev_b32 v13, 2, v93
    v_add_u32 v117, v12, v11
    v_bitop3_b32 v93, v5, v13, v14 bitop3:0xea
    ds_add_u32 v93, v2
    v_cvt_pk_bf16_f32 v106, v7, v8
    v_perm_b32 v12, v106, v106, s41
    v_bitop3_b32 v116, v4, v12, v116 bitop3:0xca
    v_perm_b32 v13, v106, v106, s42
    v_bitop3_b32 v117, v4, v13, v117 bitop3:0xca
    v_mul_hi_u32_u24 v14, 429497, v118
    v_lshrrev_b32 v12, 3, v94
    v_cos_f32 v9, v9
    v_lshlrev_b16 v13, 3, v94
    v_mad_i32_i24 v11, v14, s55, v118
    v_bitop3_b32 v12, v6, v13, v12 bitop3:0xca
    v_lshl_add_u32 v11, v11, 17, s40
    v_lshlrev_b16 v14, 8, v14
    v_lshrrev_b32 v13, 2, v94
    v_add_u32 v118, v12, v11
    v_bitop3_b32 v94, v5, v13, v14 bitop3:0xea
    ds_add_u32 v94, v2
    v_mul_hi_u32_u24 v14, 429497, v119
    v_lshrrev_b32 v12, 3, v95
    v_cos_f32 v10, v10
    v_lshlrev_b16 v13, 3, v95
    v_mad_i32_i24 v11, v14, s55, v119
    v_bitop3_b32 v12, v6, v13, v12 bitop3:0xca
    v_lshl_add_u32 v11, v11, 17, s40
    v_lshlrev_b16 v14, 8, v14
    v_lshrrev_b32 v13, 2, v95
    v_add_u32 v119, v12, v11
    v_bitop3_b32 v95, v5, v13, v14 bitop3:0xea
    ds_add_u32 v95, v2
    v_cvt_pk_bf16_f32 v107, v9, v10
    v_perm_b32 v12, v107, v107, s41
    v_bitop3_b32 v118, v4, v12, v118 bitop3:0xca
    v_perm_b32 v13, v107, v107, s42
    v_bitop3_b32 v119, v4, v13, v119 bitop3:0xca
    v_lshrrev_b32 v8, 2, v0
    v_and_b32 v7, 0x3c00, v0
    v_bitop3_b32 v7, v5, v8, v7 bitop3:0xea
    s_waitcnt lgkmcnt(0)
    s_barrier
    ds_read2st64_b32 v[8:9], v7 offset0:0 offset1:1
    ds_read2st64_b32 v[10:11], v7 offset0:2 offset1:3
    s_add_u32 s45, s35, 0x5490000
    buffer_store_dwordx4 v[44:47], v0, s[20:23], s45 offen sc1
    s_add_u32 s46, s34, 0x4000000
    s_nop 0
    buffer_load_dwordx2 v[44:45], v1, s[16:19], s46 offen nt
    s_add_u32 s47, s34, 0x4200000
    buffer_load_dwordx2 v[46:47], v1, s[16:19], s47 offen nt
    s_waitcnt lgkmcnt(0)
    v_lshl_or_b32 v12, v9, 16, v8
    v_lshl_or_b32 v13, v11, 16, v10
    v_mov_b32 v14, v12
    v_mov_b32 v15, v13
    s_nop 0
    v_add_u32_dpp v14, v14, v14 row_shr:1 row_mask:0xf bank_mask:0xf bound_ctrl:1
    v_add_u32_dpp v15, v15, v15 row_shr:1 row_mask:0xf bank_mask:0xf bound_ctrl:1
    s_nop 0
    v_add_u32_dpp v14, v14, v14 row_shr:2 row_mask:0xf bank_mask:0xf bound_ctrl:1
    v_add_u32_dpp v15, v15, v15 row_shr:2 row_mask:0xf bank_mask:0xf bound_ctrl:1
    s_nop 0
    v_add_u32_dpp v14, v14, v14 row_shr:4 row_mask:0xf bank_mask:0xf bound_ctrl:1
    v_add_u32_dpp v15, v15, v15 row_shr:4 row_mask:0xf bank_mask:0xf bound_ctrl:1
    s_nop 0
    v_add_u32_dpp v14, v14, v14 row_shr:8 row_mask:0xf bank_mask:0xf bound_ctrl:1
    v_add_u32_dpp v15, v15, v15 row_shr:8 row_mask:0xf bank_mask:0xf bound_ctrl:1
    s_nop 0
    v_add_u32_dpp v14, v14, v14 row_bcast:15 row_mask:0xa bank_mask:0xf
    v_add_u32_dpp v15, v15, v15 row_bcast:15 row_mask:0xa bank_mask:0xf
    s_nop 0
    v_add_u32_dpp v14, v14, v14 row_bcast:31 row_mask:0xc bank_mask:0xf
    v_add_u32_dpp v15, v15, v15 row_bcast:31 row_mask:0xc bank_mask:0xf
    v_readlane_b32 s48, v14, 63
    v_readlane_b32 s49, v15, 63
    s_lshl_b32 s54, s32, 2
    v_mov_b32 v8, s54
    s_and_b32 s50, s48, 0xffff
    s_lshr_b32 s51, s48, 16
    s_and_b32 s52, s49, 0xffff
    s_lshr_b32 s53, s49, 16
    s_add_u32 s51, s51, s50
    s_add_u32 s52, s52, s51
    s_add_u32 s53, s53, s52
    v_mov_b32 v9, s53
    s_mov_b64 exec, 1
    ds_write_b32 v8, v9 offset:16384
    s_waitcnt vmcnt(3)
    ds_write_b32 v8, v3 offset:16448
    s_mov_b64 exec, -1
    v_and_b32 v8, 60, v7
    s_waitcnt lgkmcnt(0)
    s_barrier
    ds_read_b32 v9, v8 offset:16384
    ds_read_b32 v10, v8 offset:16448
    s_waitcnt lgkmcnt(0)
    v_readlane_b32 s84, v10, 15
    s_min_u32 s4, s84, 112
    s_min_u32 s5, s84, 176
    s_min_u32 s6, s84, 240
    s_add_u32 s4, s4, s5
    s_add_u32 s4, s4, s6
    s_add_u32 s4, s4, 9467
    s_mov_b32 s4, s84
    s_lshl_b32 s58, s4, 14
    s_lshl_b32 s59, s4, 13
    s_mov_b32 s43, 5
    s_cmp_lt_u32 s84, 112
    s_addc_u32 s43, s43, 0
    s_cmp_lt_u32 s84, 176
    s_addc_u32 s43, s43, 0
    s_cmp_lt_u32 s84, 240
    s_addc_u32 s43, s43, 0
    v_add_u32_dpp v9, v9, v9 row_shr:1 row_mask:0xf bank_mask:0xf bound_ctrl:1
    s_nop 1
    v_add_u32_dpp v9, v9, v9 row_shr:2 row_mask:0xf bank_mask:0xf bound_ctrl:1
    s_nop 1
    v_add_u32_dpp v9, v9, v9 row_shr:4 row_mask:0xf bank_mask:0xf bound_ctrl:1
    s_nop 1
    v_add_u32_dpp v9, v9, v9 row_shr:8 row_mask:0xf bank_mask:0xf bound_ctrl:1
    s_nop 0
    v_readlane_b32 s54, v9, s32
    s_sub_u32 s54, s54, s53
    s_add_u32 s50, s50, s54
    s_add_u32 s51, s51, s54
    s_add_u32 s52, s52, s54
    s_pack_ll_b32_b16 s48, s54, s50
    s_pack_ll_b32_b16 s49, s51, s52
    v_add_u32 v14, s48, v14
    v_add_u32 v15, s49, v15
    v_sub_u32 v12, v14, v12
    v_sub_u32 v13, v15, v13
    v_and_b32 v8, 0xffff, v12
    v_lshrrev_b32 v9, 16, v12
    v_and_b32 v10, 0xffff, v13
    v_lshrrev_b32 v11, 16, v13
    ds_write2st64_b32 v7, v8, v9 offset0:0 offset1:1
    ds_write2st64_b32 v7, v10, v11 offset0:2 offset1:3
    v_and_b32 v8, 0x3f0, v0
    v_lshl_add_u32 v8, v8, 1, s36
    ds_write_b64 v8, v[12:13] offset:20480
    s_bitset0_b64 exec, 63
    s_not_b64 exec, exec
    ds_write_b64 v8, v[14:15] offset:20512
    s_mov_b64 exec, -1
    s_waitcnt lgkmcnt(0)
    s_barrier
    s_setprio 3
    ds_add_rtn_u32 v24, v24, v2
    ds_add_rtn_u32 v25, v25, v2
    ds_add_rtn_u32 v26, v26, v2
    ds_add_rtn_u32 v27, v27, v2
    ds_read_b128 v[12:15], v0 offset:20480
    v_cmp_gt_u32 vcc, 8448, v0
    ds_add_rtn_u32 v52, v52, v2
    ds_add_rtn_u32 v53, v53, v2
    ds_add_rtn_u32 v54, v54, v2
    ds_add_rtn_u32 v55, v55, v2
    s_setprio 2
    ds_add_rtn_u32 v72, v72, v2
    ds_add_rtn_u32 v73, v73, v2
    ds_add_rtn_u32 v74, v74, v2
    ds_add_rtn_u32 v75, v75, v2
    s_waitcnt lgkmcnt(8)
    s_cbranch_vccz L1_p4
    s_add_u32 s44, s35, 0x7ec0000
    s_mov_b64 exec, vcc
    buffer_store_dwordx4 v[12:15], v0, s[24:27], s44 offen sc1
    s_mov_b64 exec, -1
L1_p4:
    s_add_u32 s45, s35, 0x5494000
    buffer_store_dwordx4 v[20:23], v0, s[20:23], s45 offen sc1
    s_add_u32 s46, s33, 0x8400000
    s_nop 0
    buffer_load_dwordx4 v[20:23], v0, s[8:11], s46 offen nt
    ds_add_rtn_u32 v80, v80, v2
    ds_add_rtn_u32 v81, v81, v2
    ds_add_rtn_u32 v82, v82, v2
    ds_add_rtn_u32 v83, v83, v2
    s_setprio 1
    ds_add_rtn_u32 v96, v96, v2
    ds_add_rtn_u32 v97, v97, v2
    ds_add_rtn_u32 v98, v98, v2
    ds_add_rtn_u32 v99, v99, v2
    ds_add_rtn_u32 v108, v108, v2
    ds_add_rtn_u32 v109, v109, v2
    ds_add_rtn_u32 v110, v110, v2
    ds_add_rtn_u32 v111, v111, v2
    s_add_u32 s47, s35, 0x5498000
    buffer_store_dwordx4 v[124:127], v0, s[20:23], s47 offen sc1
    s_add_u32 s44, s33, 0x8400000
    s_nop 0
    buffer_load_dwordx4 v[124:127], v0, s[12:15], s44 offen nt
    s_setprio 0
    ds_add_rtn_u32 v88, v88, v2
    ds_add_rtn_u32 v89, v89, v2
    ds_add_rtn_u32 v90, v90, v2
    ds_add_rtn_u32 v91, v91, v2
    ds_add_rtn_u32 v92, v92, v2
    ds_add_rtn_u32 v93, v93, v2
    ds_add_rtn_u32 v94, v94, v2
    ds_add_rtn_u32 v95, v95, v2
    s_waitcnt lgkmcnt(0)
    s_barrier
    s_setprio 3
    v_and_b32 v7, -4, v24
    v_lshl_add_u32 v8, v24, 2, v7
    ds_write_b32 v8, v40
    v_lshl_add_u32 v7, v7, 2, v24
    ds_write_b8 v7, v84 offset:16
    v_and_b32 v9, -4, v25
    v_lshl_add_u32 v10, v25, 2, v9
    ds_write_b32 v10, v41
    v_lshl_add_u32 v9, v9, 2, v25
    ds_write_b8_d16_hi v9, v84 offset:16
    v_and_b32 v7, -4, v26
    v_lshl_add_u32 v8, v26, 2, v7
    ds_write_b32 v8, v42
    v_lshl_add_u32 v7, v7, 2, v26
    ds_write_b8 v7, v85 offset:16
    v_and_b32 v9, -4, v27
    v_lshl_add_u32 v10, v27, 2, v9
    ds_write_b32 v10, v43
    v_lshl_add_u32 v9, v9, 2, v27
    ds_write_b8_d16_hi v9, v85 offset:16
    s_add_u32 s45, s35, 0x549c000
    buffer_store_dwordx4 v[32:35], v0, s[20:23], s45 offen sc1
    s_add_u32 s46, s33, 0x8800000
    buffer_load_dwordx4 v[40:43], v0, s[8:11], s46 offen nt
    s_add_u32 s47, s33, 0x8800000
    buffer_load_dwordx4 v[24:27], v0, s[12:15], s47 offen nt
    v_and_b32 v7, -4, v52
    v_lshl_add_u32 v8, v52, 2, v7
    ds_write_b32 v8, v48
    v_lshl_add_u32 v7, v7, 2, v52
    ds_write_b8 v7, v86 offset:16
    v_and_b32 v9, -4, v53
    v_lshl_add_u32 v10, v53, 2, v9
    ds_write_b32 v10, v49
    v_lshl_add_u32 v9, v9, 2, v53
    ds_write_b8_d16_hi v9, v86 offset:16
    v_and_b32 v7, -4, v54
    v_lshl_add_u32 v8, v54, 2, v7
    ds_write_b32 v8, v50
    v_lshl_add_u32 v7, v7, 2, v54
    ds_write_b8 v7, v87 offset:16
    v_and_b32 v9, -4, v55
    v_lshl_add_u32 v10, v55, 2, v9
    ds_write_b32 v10, v51
    v_lshl_add_u32 v9, v9, 2, v55
    ds_write_b8_d16_hi v9, v87 offset:16
    s_add_u32 s44, s34, 0x4400000
    buffer_load_dwordx2 v[32:33], v1, s[16:19], s44 offen nt
    s_add_u32 s45, s34, 0x4600000
    buffer_load_dwordx2 v[34:35], v1, s[16:19], s45 offen nt
    s_add_u32 s46, s33, 0x8c00000
    buffer_load_dwordx4 v[48:51], v0, s[8:11], s46 offen nt
    s_setprio 2
    v_and_b32 v7, -4, v72
    v_lshl_add_u32 v8, v72, 2, v7
    ds_write_b32 v8, v68
    v_lshl_add_u32 v7, v7, 2, v72
    ds_write_b8 v7, v56 offset:16
    v_and_b32 v9, -4, v73
    v_lshl_add_u32 v10, v73, 2, v9
    ds_write_b32 v10, v69
    v_lshl_add_u32 v9, v9, 2, v73
    ds_write_b8_d16_hi v9, v56 offset:16
    v_and_b32 v7, -4, v74
    v_lshl_add_u32 v8, v74, 2, v7
    ds_write_b32 v8, v70
    v_lshl_add_u32 v7, v7, 2, v74
    ds_write_b8 v7, v57 offset:16
    v_and_b32 v9, -4, v75
    v_lshl_add_u32 v10, v75, 2, v9
    ds_write_b32 v10, v71
    v_lshl_add_u32 v9, v9, 2, v75
    ds_write_b8_d16_hi v9, v57 offset:16
    s_add_u32 s47, s35, 0x54a0000
    buffer_store_dwordx4 v[36:39], v0, s[20:23], s47 offen sc1
    s_add_u32 s44, s33, 0x8c00000
    buffer_load_dwordx4 v[52:55], v0, s[12:15], s44 offen nt
    v_and_b32 v7, -4, v80
    v_lshl_add_u32 v8, v80, 2, v7
    ds_write_b32 v8, v76
    v_lshl_add_u32 v7, v7, 2, v80
    ds_write_b8 v7, v58 offset:16
    v_and_b32 v9, -4, v81
    v_lshl_add_u32 v10, v81, 2, v9
    ds_write_b32 v10, v77
    v_lshl_add_u32 v9, v9, 2, v81
    ds_write_b8_d16_hi v9, v58 offset:16
    v_and_b32 v7, -4, v82
    v_lshl_add_u32 v8, v82, 2, v7
    ds_write_b32 v8, v78
    v_lshl_add_u32 v7, v7, 2, v82
    ds_write_b8 v7, v59 offset:16
    v_and_b32 v9, -4, v83
    v_lshl_add_u32 v10, v83, 2, v9
    ds_write_b32 v10, v79
    v_lshl_add_u32 v9, v9, 2, v83
    ds_write_b8_d16_hi v9, v59 offset:16
    s_add_u32 s45, s33, 0x9000000
    buffer_load_dwordx4 v[84:87], v0, s[8:11], s45 offen nt
    s_add_u32 s46, s33, 0x9000000
    buffer_load_dwordx4 v[68:71], v0, s[12:15], s46 offen nt
    s_setprio 1
    v_and_b32 v7, -4, v96
    v_lshl_add_u32 v8, v96, 2, v7
    ds_write_b32 v8, v64
    v_lshl_add_u32 v7, v7, 2, v96
    ds_write_b8 v7, v100 offset:16
    v_and_b32 v9, -4, v97
    v_lshl_add_u32 v10, v97, 2, v9
    ds_write_b32 v10, v65
    v_lshl_add_u32 v9, v9, 2, v97
    ds_write_b8_d16_hi v9, v100 offset:16
    v_and_b32 v7, -4, v98
    v_lshl_add_u32 v8, v98, 2, v7
    ds_write_b32 v8, v66
    v_lshl_add_u32 v7, v7, 2, v98
    ds_write_b8 v7, v101 offset:16
    v_and_b32 v9, -4, v99
    v_lshl_add_u32 v10, v99, 2, v9
    ds_write_b32 v10, v67
    v_lshl_add_u32 v9, v9, 2, v99
    ds_write_b8_d16_hi v9, v101 offset:16
    s_add_u32 s47, s34, 0x4800000
    buffer_load_dwordx2 v[72:73], v1, s[16:19], s47 offen nt
    s_cmp_le_u32 s43, 5
    s_cselect_b32 s18, 0, s18
    s_add_u32 s44, s59, 0x4a00000
    buffer_load_dwordx2 v[74:75], v1, s[16:19], s44 offen nt
    s_cmp_le_u32 s43, 5
    s_cselect_b32 s10, 0, s10
    s_add_u32 s45, s58, 0x9400000
    buffer_load_dwordx4 v[36:39], v0, s[8:11], s45 offen nt
    v_and_b32 v7, -4, v108
    v_lshl_add_u32 v8, v108, 2, v7
    ds_write_b32 v8, v60
    v_lshl_add_u32 v7, v7, 2, v108
    ds_write_b8 v7, v102 offset:16
    v_and_b32 v9, -4, v109
    v_lshl_add_u32 v10, v109, 2, v9
    ds_write_b32 v10, v61
    v_lshl_add_u32 v9, v9, 2, v109
    ds_write_b8_d16_hi v9, v102 offset:16
    v_and_b32 v7, -4, v110
    v_lshl_add_u32 v8, v110, 2, v7
    ds_write_b32 v8, v62
    v_lshl_add_u32 v7, v7, 2, v110
    ds_write_b8 v7, v103 offset:16
    v_and_b32 v9, -4, v111
    v_lshl_add_u32 v10, v111, 2, v9
    ds_write_b32 v10, v63
    v_lshl_add_u32 v9, v9, 2, v111
    ds_write_b8_d16_hi v9, v103 offset:16
    s_add_u32 s46, s35, 0x54a4000
    buffer_store_dwordx4 v[28:31], v0, s[20:23], s46 offen sc1
    s_cmp_le_u32 s43, 5
    s_cselect_b32 s14, 0, s14
    s_add_u32 s47, s58, 0x9400000
    buffer_load_dwordx4 v[76:79], v0, s[12:15], s47 offen nt
    s_setprio 0
    v_and_b32 v7, -4, v88
    v_lshl_add_u32 v8, v88, 2, v7
    ds_write_b32 v8, v112
    v_lshl_add_u32 v7, v7, 2, v88
    ds_write_b8 v7, v104 offset:16
    v_and_b32 v9, -4, v89
    v_lshl_add_u32 v10, v89, 2, v9
    ds_write_b32 v10, v113
    v_lshl_add_u32 v9, v9, 2, v89
    ds_write_b8_d16_hi v9, v104 offset:16
    v_and_b32 v7, -4, v90
    v_lshl_add_u32 v8, v90, 2, v7
    ds_write_b32 v8, v114
    v_lshl_add_u32 v7, v7, 2, v90
    ds_write_b8 v7, v105 offset:16
    v_and_b32 v9, -4, v91
    v_lshl_add_u32 v10, v91, 2, v9
    ds_write_b32 v10, v115
    v_lshl_add_u32 v9, v9, 2, v91
    ds_write_b8_d16_hi v9, v105 offset:16
    s_cmp_le_u32 s43, 6
    s_cselect_b32 s10, 0, s10
    s_add_u32 s44, s58, 0x97c0000
    buffer_load_dwordx4 v[80:83], v0, s[8:11], s44 offen nt
    s_cmp_le_u32 s43, 6
    s_cselect_b32 s14, 0, s14
    s_add_u32 s45, s58, 0x97c0000
    buffer_load_dwordx4 v[56:59], v0, s[12:15], s45 offen nt
    v_and_b32 v7, -4, v92
    v_lshl_add_u32 v8, v92, 2, v7
    ds_write_b32 v8, v116
    v_lshl_add_u32 v7, v7, 2, v92
    ds_write_b8 v7, v106 offset:16
    v_and_b32 v9, -4, v93
    v_lshl_add_u32 v10, v93, 2, v9
    ds_write_b32 v10, v117
    v_lshl_add_u32 v9, v9, 2, v93
    ds_write_b8_d16_hi v9, v106 offset:16
    v_and_b32 v7, -4, v94
    v_lshl_add_u32 v8, v94, 2, v7
    ds_write_b32 v8, v118
    v_lshl_add_u32 v7, v7, 2, v94
    ds_write_b8 v7, v107 offset:16
    v_and_b32 v9, -4, v95
    v_lshl_add_u32 v10, v95, 2, v9
    ds_write_b32 v10, v119
    v_lshl_add_u32 v9, v9, 2, v95
    ds_write_b8_d16_hi v9, v107 offset:16
    s_cmp_le_u32 s43, 6
    s_cselect_b32 s18, 0, s18
    s_add_u32 s46, s59, 0x4be0000
    buffer_load_dwordx2 v[64:65], v1, s[16:19], s46 offen nt
    s_cmp_le_u32 s43, 7
    s_cselect_b32 s18, 0, s18
    s_add_u32 s47, s59, 0x4d40000
    buffer_load_dwordx2 v[66:67], v1, s[16:19], s47 offen nt
    v_add_u32 v7, 0x10000, v0
    v_add_u32 v12, 0x20000, v0
    v_mov_b32 v8, 0
    v_mov_b32 v9, 0
    v_mov_b32 v10, 0
    v_mov_b32 v11, 0
    s_waitcnt lgkmcnt(0)
    s_barrier
    ds_read_b128 v[96:99], v0 offset:0
    ds_write_b128 v0, v[8:11]
    ds_read_b128 v[60:63], v0 offset:16384
    ds_read_b128 v[108:111], v0 offset:32768
    ds_read_b128 v[100:103], v0 offset:49152
    ds_read_b128 v[28:31], v7 offset:0
    ds_read_b128 v[112:115], v7 offset:16384
    ds_read_b128 v[88:91], v7 offset:32768
    ds_read_b128 v[116:119], v7 offset:49152
    ds_read_b128 v[92:95], v12 offset:0
    ds_read_b128 v[104:107], v12 offset:16384
    s_waitcnt lgkmcnt(0)
    s_barrier
    s_add_u32 s44, s35, 0x7ec0000
    buffer_store_dwordx4 v[96:99], v0, s[20:23], s44 offen sc1
    s_cmp_le_u32 s43, 7
    s_cselect_b32 s10, 0, s10
    s_add_u32 s45, s58, 0x9a80000
    buffer_load_dwordx4 v[96:99], v0, s[8:11], s45 offen nt
    s_add_u32 s46, s35, 0x7ec4000
    buffer_store_dwordx4 v[60:63], v0, s[20:23], s46 offen sc1
    s_cmp_le_u32 s43, 7
    s_cselect_b32 s14, 0, s14
    s_add_u32 s47, s58, 0x9a80000
    buffer_load_dwordx4 v[60:63], v0, s[12:15], s47 offen nt
    s_setprio 3
    s_waitcnt vmcnt(27)
    v_lshlrev_b32 v7, 16, v44
    v_and_b32 v8, 0xffff0000, v44
    v_lshlrev_b32 v9, 16, v45
    v_and_b32 v10, 0xffff0000, v45
    v_mul_f32 v7, 0.15915494, v7
    v_mul_f32 v8, 0.15915494, v8
    v_mul_f32 v9, 0.15915494, v9
    v_mul_f32 v10, 0.15915494, v10
    v_mul_hi_u32_u24 v14, 429497, v16
    v_lshrrev_b32 v12, 3, v120
    v_cos_f32 v7, v7
    v_lshlrev_b16 v13, 3, v120
    v_mad_i32_i24 v11, v14, s55, v16
    v_bitop3_b32 v12, v6, v13, v12 bitop3:0xca
    v_lshl_add_u32 v11, v11, 17, s40
    v_lshlrev_b16 v14, 8, v14
    v_lshrrev_b32 v13, 2, v120
    v_add_u32 v16, v12, v11
    v_bitop3_b32 v120, v5, v13, v14 bitop3:0xea
    ds_add_u32 v120, v2
    v_mul_hi_u32_u24 v14, 429497, v17
    v_lshrrev_b32 v12, 3, v121
    v_cos_f32 v8, v8
    v_lshlrev_b16 v13, 3, v121
    v_mad_i32_i24 v11, v14, s55, v17
    v_bitop3_b32 v12, v6, v13, v12 bitop3:0xca
    v_lshl_add_u32 v11, v11, 17, s40
    v_lshlrev_b16 v14, 8, v14
    v_lshrrev_b32 v13, 2, v121
    v_add_u32 v17, v12, v11
    v_bitop3_b32 v121, v5, v13, v14 bitop3:0xea
    ds_add_u32 v121, v2
    v_cvt_pk_bf16_f32 v44, v7, v8
    v_perm_b32 v12, v44, v44, s41
    v_bitop3_b32 v16, v4, v12, v16 bitop3:0xca
    v_perm_b32 v13, v44, v44, s42
    v_bitop3_b32 v17, v4, v13, v17 bitop3:0xca
    v_mul_hi_u32_u24 v14, 429497, v18
    v_lshrrev_b32 v12, 3, v122
    v_cos_f32 v9, v9
    v_lshlrev_b16 v13, 3, v122
    v_mad_i32_i24 v11, v14, s55, v18
    v_bitop3_b32 v12, v6, v13, v12 bitop3:0xca
    v_lshl_add_u32 v11, v11, 17, s40
    v_lshlrev_b16 v14, 8, v14
    v_lshrrev_b32 v13, 2, v122
    v_add_u32 v18, v12, v11
    v_bitop3_b32 v122, v5, v13, v14 bitop3:0xea
    ds_add_u32 v122, v2
    v_mul_hi_u32_u24 v14, 429497, v19
    v_lshrrev_b32 v12, 3, v123
    v_cos_f32 v10, v10
    v_lshlrev_b16 v13, 3, v123
    v_mad_i32_i24 v11, v14, s55, v19
    v_bitop3_b32 v12, v6, v13, v12 bitop3:0xca
    v_lshl_add_u32 v11, v11, 17, s40
    v_lshlrev_b16 v14, 8, v14
    v_lshrrev_b32 v13, 2, v123
    v_add_u32 v19, v12, v11
    v_bitop3_b32 v123, v5, v13, v14 bitop3:0xea
    ds_add_u32 v123, v2
    v_cvt_pk_bf16_f32 v45, v9, v10
    v_perm_b32 v12, v45, v45, s41
    v_bitop3_b32 v18, v4, v12, v18 bitop3:0xca
    v_perm_b32 v13, v45, v45, s42
    v_bitop3_b32 v19, v4, v13, v19 bitop3:0xca
    s_add_u32 s44, s35, 0x7ec8000
    buffer_store_dwordx4 v[108:111], v0, s[20:23], s44 offen sc1
    s_waitcnt vmcnt(24)
    v_lshlrev_b32 v7, 16, v46
    v_and_b32 v8, 0xffff0000, v46
    v_lshlrev_b32 v9, 16, v47
    v_and_b32 v10, 0xffff0000, v47
    v_mul_f32 v7, 0.15915494, v7
    v_mul_f32 v8, 0.15915494, v8
    v_mul_f32 v9, 0.15915494, v9
    v_mul_f32 v10, 0.15915494, v10
    v_mul_hi_u32_u24 v14, 429497, v20
    v_lshrrev_b32 v12, 3, v124
    v_cos_f32 v7, v7
    v_lshlrev_b16 v13, 3, v124
    v_mad_i32_i24 v11, v14, s55, v20
    v_bitop3_b32 v12, v6, v13, v12 bitop3:0xca
    v_lshl_add_u32 v11, v11, 17, s40
    v_lshlrev_b16 v14, 8, v14
    v_lshrrev_b32 v13, 2, v124
    v_add_u32 v20, v12, v11
    v_bitop3_b32 v124, v5, v13, v14 bitop3:0xea
    ds_add_u32 v124, v2
    v_mul_hi_u32_u24 v14, 429497, v21
    v_lshrrev_b32 v12, 3, v125
    v_cos_f32 v8, v8
    v_lshlrev_b16 v13, 3, v125
    v_mad_i32_i24 v11, v14, s55, v21
    v_bitop3_b32 v12, v6, v13, v12 bitop3:0xca
    v_lshl_add_u32 v11, v11, 17, s40
    v_lshlrev_b16 v14, 8, v14
    v_lshrrev_b32 v13, 2, v125
    v_add_u32 v21, v12, v11
    v_bitop3_b32 v125, v5, v13, v14 bitop3:0xea
    ds_add_u32 v125, v2
    v_cvt_pk_bf16_f32 v46, v7, v8
    v_perm_b32 v12, v46, v46, s41
    v_bitop3_b32 v20, v4, v12, v20 bitop3:0xca
    v_perm_b32 v13, v46, v46, s42
    v_bitop3_b32 v21, v4, v13, v21 bitop3:0xca
    v_mul_hi_u32_u24 v14, 429497, v22
    v_lshrrev_b32 v12, 3, v126
    v_cos_f32 v9, v9
    v_lshlrev_b16 v13, 3, v126
    v_mad_i32_i24 v11, v14, s55, v22
    v_bitop3_b32 v12, v6, v13, v12 bitop3:0xca
    v_lshl_add_u32 v11, v11, 17, s40
    v_lshlrev_b16 v14, 8, v14
    v_lshrrev_b32 v13, 2, v126
    v_add_u32 v22, v12, v11
    v_bitop3_b32 v126, v5, v13, v14 bitop3:0xea
    ds_add_u32 v126, v2
    v_mul_hi_u32_u24 v14, 429497, v23
    v_lshrrev_b32 v12, 3, v127
    v_cos_f32 v10, v10
    v_lshlrev_b16 v13, 3, v127
    v_mad_i32_i24 v11, v14, s55, v23
    v_bitop3_b32 v12, v6, v13, v12 bitop3:0xca
    v_lshl_add_u32 v11, v11, 17, s40
    v_lshlrev_b16 v14, 8, v14
    v_lshrrev_b32 v13, 2, v127
    v_add_u32 v23, v12, v11
    v_bitop3_b32 v127, v5, v13, v14 bitop3:0xea
    ds_add_u32 v127, v2
    v_cvt_pk_bf16_f32 v47, v9, v10
    v_perm_b32 v12, v47, v47, s41
    v_bitop3_b32 v22, v4, v12, v22 bitop3:0xca
    v_perm_b32 v13, v47, v47, s42
    v_bitop3_b32 v23, v4, v13, v23 bitop3:0xca
    s_setprio 2
    s_add_u32 s45, s35, 0x7ecc000
    buffer_store_dwordx4 v[100:103], v0, s[20:23], s45 offen sc1
    s_waitcnt vmcnt(20)
    v_lshlrev_b32 v7, 16, v32
    v_and_b32 v8, 0xffff0000, v32
    v_lshlrev_b32 v9, 16, v33
    v_and_b32 v10, 0xffff0000, v33
    v_mul_f32 v7, 0.15915494, v7
    v_mul_f32 v8, 0.15915494, v8
    v_mul_f32 v9, 0.15915494, v9
    v_mul_f32 v10, 0.15915494, v10
    v_mul_hi_u32_u24 v14, 429497, v40
    v_lshrrev_b32 v12, 3, v24
    v_cos_f32 v7, v7
    v_lshlrev_b16 v13, 3, v24
    v_mad_i32_i24 v11, v14, s55, v40
    v_bitop3_b32 v12, v6, v13, v12 bitop3:0xca
    v_lshl_add_u32 v11, v11, 17, s40
    v_lshlrev_b16 v14, 8, v14
    v_lshrrev_b32 v13, 2, v24
    v_add_u32 v40, v12, v11
    v_bitop3_b32 v24, v5, v13, v14 bitop3:0xea
    ds_add_u32 v24, v2
    v_mul_hi_u32_u24 v14, 429497, v41
    v_lshrrev_b32 v12, 3, v25
    v_cos_f32 v8, v8
    v_lshlrev_b16 v13, 3, v25
    v_mad_i32_i24 v11, v14, s55, v41
    v_bitop3_b32 v12, v6, v13, v12 bitop3:0xca
    v_lshl_add_u32 v11, v11, 17, s40
    v_lshlrev_b16 v14, 8, v14
    v_lshrrev_b32 v13, 2, v25
    v_add_u32 v41, v12, v11
    v_bitop3_b32 v25, v5, v13, v14 bitop3:0xea
    ds_add_u32 v25, v2
    v_cvt_pk_bf16_f32 v32, v7, v8
    v_perm_b32 v12, v32, v32, s41
    v_bitop3_b32 v40, v4, v12, v40 bitop3:0xca
    v_perm_b32 v13, v32, v32, s42
    v_bitop3_b32 v41, v4, v13, v41 bitop3:0xca
    v_mul_hi_u32_u24 v14, 429497, v42
    v_lshrrev_b32 v12, 3, v26
    v_cos_f32 v9, v9
    v_lshlrev_b16 v13, 3, v26
    v_mad_i32_i24 v11, v14, s55, v42
    v_bitop3_b32 v12, v6, v13, v12 bitop3:0xca
    v_lshl_add_u32 v11, v11, 17, s40
    v_lshlrev_b16 v14, 8, v14
    v_lshrrev_b32 v13, 2, v26
    v_add_u32 v42, v12, v11
    v_bitop3_b32 v26, v5, v13, v14 bitop3:0xea
    ds_add_u32 v26, v2
    v_mul_hi_u32_u24 v14, 429497, v43
    v_lshrrev_b32 v12, 3, v27
    v_cos_f32 v10, v10
    v_lshlrev_b16 v13, 3, v27
    v_mad_i32_i24 v11, v14, s55, v43
    v_bitop3_b32 v12, v6, v13, v12 bitop3:0xca
    v_lshl_add_u32 v11, v11, 17, s40
    v_lshlrev_b16 v14, 8, v14
    v_lshrrev_b32 v13, 2, v27
    v_add_u32 v43, v12, v11
    v_bitop3_b32 v27, v5, v13, v14 bitop3:0xea
    ds_add_u32 v27, v2
    v_cvt_pk_bf16_f32 v33, v9, v10
    v_perm_b32 v12, v33, v33, s41
    v_bitop3_b32 v42, v4, v12, v42 bitop3:0xca
    v_perm_b32 v13, v33, v33, s42
    v_bitop3_b32 v43, v4, v13, v43 bitop3:0xca
    s_waitcnt vmcnt(17)
    v_lshlrev_b32 v7, 16, v34
    v_and_b32 v8, 0xffff0000, v34
    v_lshlrev_b32 v9, 16, v35
    v_and_b32 v10, 0xffff0000, v35
    v_mul_f32 v7, 0.15915494, v7
    v_mul_f32 v8, 0.15915494, v8
    v_mul_f32 v9, 0.15915494, v9
    v_mul_f32 v10, 0.15915494, v10
    v_mul_hi_u32_u24 v14, 429497, v48
    v_lshrrev_b32 v12, 3, v52
    v_cos_f32 v7, v7
    v_lshlrev_b16 v13, 3, v52
    v_mad_i32_i24 v11, v14, s55, v48
    v_bitop3_b32 v12, v6, v13, v12 bitop3:0xca
    v_lshl_add_u32 v11, v11, 17, s40
    v_lshlrev_b16 v14, 8, v14
    v_lshrrev_b32 v13, 2, v52
    v_add_u32 v48, v12, v11
    v_bitop3_b32 v52, v5, v13, v14 bitop3:0xea
    ds_add_u32 v52, v2
    v_mul_hi_u32_u24 v14, 429497, v49
    v_lshrrev_b32 v12, 3, v53
    v_cos_f32 v8, v8
    v_lshlrev_b16 v13, 3, v53
    v_mad_i32_i24 v11, v14, s55, v49
    v_bitop3_b32 v12, v6, v13, v12 bitop3:0xca
    v_lshl_add_u32 v11, v11, 17, s40
    v_lshlrev_b16 v14, 8, v14
    v_lshrrev_b32 v13, 2, v53
    v_add_u32 v49, v12, v11
    v_bitop3_b32 v53, v5, v13, v14 bitop3:0xea
    ds_add_u32 v53, v2
    v_cvt_pk_bf16_f32 v34, v7, v8
    v_perm_b32 v12, v34, v34, s41
    v_bitop3_b32 v48, v4, v12, v48 bitop3:0xca
    v_perm_b32 v13, v34, v34, s42
    v_bitop3_b32 v49, v4, v13, v49 bitop3:0xca
    v_mul_hi_u32_u24 v14, 429497, v50
    v_lshrrev_b32 v12, 3, v54
    v_cos_f32 v9, v9
    v_lshlrev_b16 v13, 3, v54
    v_mad_i32_i24 v11, v14, s55, v50
    v_bitop3_b32 v12, v6, v13, v12 bitop3:0xca
    v_lshl_add_u32 v11, v11, 17, s40
    v_lshlrev_b16 v14, 8, v14
    v_lshrrev_b32 v13, 2, v54
    v_add_u32 v50, v12, v11
    v_bitop3_b32 v54, v5, v13, v14 bitop3:0xea
    ds_add_u32 v54, v2
    v_mul_hi_u32_u24 v14, 429497, v51
    v_lshrrev_b32 v12, 3, v55
    v_cos_f32 v10, v10
    v_lshlrev_b16 v13, 3, v55
    v_mad_i32_i24 v11, v14, s55, v51
    v_bitop3_b32 v12, v6, v13, v12 bitop3:0xca
    v_lshl_add_u32 v11, v11, 17, s40
    v_lshlrev_b16 v14, 8, v14
    v_lshrrev_b32 v13, 2, v55
    v_add_u32 v51, v12, v11
    v_bitop3_b32 v55, v5, v13, v14 bitop3:0xea
    ds_add_u32 v55, v2
    v_cvt_pk_bf16_f32 v35, v9, v10
    v_perm_b32 v12, v35, v35, s41
    v_bitop3_b32 v50, v4, v12, v50 bitop3:0xca
    v_perm_b32 v13, v35, v35, s42
    v_bitop3_b32 v51, v4, v13, v51 bitop3:0xca
    s_setprio 1
    s_add_u32 s46, s35, 0x7ed0000
    buffer_store_dwordx4 v[28:31], v0, s[20:23], s46 offen sc1
    v_lshrrev_b32 v15, 2, v0
    v_and_b32 v15, v5, v15
    s_cmp_ge_u32 s84, 128
    s_cselect_b32 s82, 0, s82
    s_and_b32 s3, s84, 1
    s_mul_i32 s3, s3, 40
    s_add_u32 s3, s3, s32
    s_mul_i32 s4, s3, 205
    s_lshr_b32 s4, s4, 10
    s_mul_i32 s5, s4, 5
    s_sub_u32 s5, s3, s5
    s_lshl_b32 s6, s4, 1
    s_add_u32 s6, s6, s5
    s_add_u32 s7, s6, s4
    s_add_u32 s7, s7, 30
    s_cmp_lt_u32 s5, 2
    s_cselect_b32 s6, s6, s7
    s_lshl_b32 s6, s6, 10
    s_lshr_b32 s7, s84, 1
    s_mul_i32 s7, s7, 80000
    s_add_u32 s6, s6, s7
    buffer_load_dword v108, v15, s[80:83], s6 offen offset:0
    buffer_load_dword v109, v15, s[80:83], s6 offen offset:256
    buffer_load_dword v110, v15, s[80:83], s6 offen offset:512
    buffer_load_dword v111, v15, s[80:83], s6 offen offset:768
    s_and_b32 s3, s84, 1
    s_mul_i32 s3, s3, 40
    s_add_u32 s3, s3, s32
    s_add_u32 s3, s3, 16
    s_mul_i32 s4, s3, 205
    s_lshr_b32 s4, s4, 10
    s_mul_i32 s5, s4, 5
    s_sub_u32 s5, s3, s5
    s_lshl_b32 s6, s4, 1
    s_add_u32 s6, s6, s5
    s_add_u32 s7, s6, s4
    s_add_u32 s7, s7, 30
    s_cmp_lt_u32 s5, 2
    s_cselect_b32 s6, s6, s7
    s_lshl_b32 s6, s6, 10
    s_lshr_b32 s7, s84, 1
    s_mul_i32 s7, s7, 80000
    s_add_u32 s6, s6, s7
    buffer_load_dword v100, v15, s[80:83], s6 offen offset:0
    buffer_load_dword v101, v15, s[80:83], s6 offen offset:256
    buffer_load_dword v102, v15, s[80:83], s6 offen offset:512
    buffer_load_dword v103, v15, s[80:83], s6 offen offset:768
    s_and_b32 s3, s84, 1
    s_mul_i32 s3, s3, 40
    s_add_u32 s3, s3, s32
    s_add_u32 s3, s3, 32
    s_cmp_ge_u32 s32, 8
    s_cselect_b32 s82, 0, s82
    s_mul_i32 s4, s3, 205
    s_lshr_b32 s4, s4, 10
    s_mul_i32 s5, s4, 5
    s_sub_u32 s5, s3, s5
    s_lshl_b32 s6, s4, 1
    s_add_u32 s6, s6, s5
    s_add_u32 s7, s6, s4
    s_add_u32 s7, s7, 30
    s_cmp_lt_u32 s5, 2
    s_cselect_b32 s6, s6, s7
    s_lshl_b32 s6, s6, 10
    s_lshr_b32 s7, s84, 1
    s_mul_i32 s7, s7, 80000
    s_add_u32 s6, s6, s7
    buffer_load_dword v28, v15, s[80:83], s6 offen offset:0
    buffer_load_dword v29, v15, s[80:83], s6 offen offset:256
    buffer_load_dword v30, v15, s[80:83], s6 offen offset:512
    buffer_load_dword v31, v15, s[80:83], s6 offen offset:768
    s_waitcnt vmcnt(26)
    v_lshlrev_b32 v7, 16, v72
    v_and_b32 v8, 0xffff0000, v72
    v_lshlrev_b32 v9, 16, v73
    v_and_b32 v10, 0xffff0000, v73
    v_mul_f32 v7, 0.15915494, v7
    v_mul_f32 v8, 0.15915494, v8
    v_mul_f32 v9, 0.15915494, v9
    v_mul_f32 v10, 0.15915494, v10
    v_mul_hi_u32_u24 v14, 429497, v84
    v_lshrrev_b32 v12, 3, v68
    v_cos_f32 v7, v7
    v_lshlrev_b16 v13, 3, v68
    v_mad_i32_i24 v11, v14, s55, v84
    v_bitop3_b32 v12, v6, v13, v12 bitop3:0xca
    v_lshl_add_u32 v11, v11, 17, s40
    v_lshlrev_b16 v14, 8, v14
    v_lshrrev_b32 v13, 2, v68
    v_add_u32 v84, v12, v11
    v_bitop3_b32 v68, v5, v13, v14 bitop3:0xea
    ds_add_u32 v68, v2
    v_mul_hi_u32_u24 v14, 429497, v85
    v_lshrrev_b32 v12, 3, v69
    v_cos_f32 v8, v8
    v_lshlrev_b16 v13, 3, v69
    v_mad_i32_i24 v11, v14, s55, v85
    v_bitop3_b32 v12, v6, v13, v12 bitop3:0xca
    v_lshl_add_u32 v11, v11, 17, s40
    v_lshlrev_b16 v14, 8, v14
    v_lshrrev_b32 v13, 2, v69
    v_add_u32 v85, v12, v11
    v_bitop3_b32 v69, v5, v13, v14 bitop3:0xea
    ds_add_u32 v69, v2
    v_cvt_pk_bf16_f32 v72, v7, v8
    v_perm_b32 v12, v72, v72, s41
    v_bitop3_b32 v84, v4, v12, v84 bitop3:0xca
    v_perm_b32 v13, v72, v72, s42
    v_bitop3_b32 v85, v4, v13, v85 bitop3:0xca
    v_mul_hi_u32_u24 v14, 429497, v86
    v_lshrrev_b32 v12, 3, v70
    v_cos_f32 v9, v9
    v_lshlrev_b16 v13, 3, v70
    v_mad_i32_i24 v11, v14, s55, v86
    v_bitop3_b32 v12, v6, v13, v12 bitop3:0xca
    v_lshl_add_u32 v11, v11, 17, s40
    v_lshlrev_b16 v14, 8, v14
    v_lshrrev_b32 v13, 2, v70
    v_add_u32 v86, v12, v11
    v_bitop3_b32 v70, v5, v13, v14 bitop3:0xea
    ds_add_u32 v70, v2
    v_mul_hi_u32_u24 v14, 429497, v87
    v_lshrrev_b32 v12, 3, v71
    v_cos_f32 v10, v10
    v_lshlrev_b16 v13, 3, v71
    v_mad_i32_i24 v11, v14, s55, v87
    v_bitop3_b32 v12, v6, v13, v12 bitop3:0xca
    v_lshl_add_u32 v11, v11, 17, s40
    v_lshlrev_b16 v14, 8, v14
    v_lshrrev_b32 v13, 2, v71
    v_add_u32 v87, v12, v11
    v_bitop3_b32 v71, v5, v13, v14 bitop3:0xea
    ds_add_u32 v71, v2
    v_cvt_pk_bf16_f32 v73, v9, v10
    v_perm_b32 v12, v73, v73, s41
    v_bitop3_b32 v86, v4, v12, v86 bitop3:0xca
    v_perm_b32 v13, v73, v73, s42
    v_bitop3_b32 v87, v4, v13, v87 bitop3:0xca
    s_waitcnt vmcnt(23)
    s_cmp_le_u32 s43, 5
    s_cbranch_scc1 L1_s5
    v_lshlrev_b32 v7, 16, v74
    v_and_b32 v8, 0xffff0000, v74
    v_lshlrev_b32 v9, 16, v75
    v_and_b32 v10, 0xffff0000, v75
    v_mul_f32 v7, 0.15915494, v7
    v_mul_f32 v8, 0.15915494, v8
    v_mul_f32 v9, 0.15915494, v9
    v_mul_f32 v10, 0.15915494, v10
    v_mul_hi_u32_u24 v14, 429497, v36
    v_lshrrev_b32 v12, 3, v76
    v_cos_f32 v7, v7
    v_lshlrev_b16 v13, 3, v76
    v_mad_i32_i24 v11, v14, s55, v36
    v_bitop3_b32 v12, v6, v13, v12 bitop3:0xca
    v_lshl_add_u32 v11, v11, 17, s40
    v_lshlrev_b16 v14, 8, v14
    v_lshrrev_b32 v13, 2, v76
    v_add_u32 v36, v12, v11
    v_bitop3_b32 v76, v5, v13, v14 bitop3:0xea
    ds_add_u32 v76, v2
    v_mul_hi_u32_u24 v14, 429497, v37
    v_lshrrev_b32 v12, 3, v77
    v_cos_f32 v8, v8
    v_lshlrev_b16 v13, 3, v77
    v_mad_i32_i24 v11, v14, s55, v37
    v_bitop3_b32 v12, v6, v13, v12 bitop3:0xca
    v_lshl_add_u32 v11, v11, 17, s40
    v_lshlrev_b16 v14, 8, v14
    v_lshrrev_b32 v13, 2, v77
    v_add_u32 v37, v12, v11
    v_bitop3_b32 v77, v5, v13, v14 bitop3:0xea
    ds_add_u32 v77, v2
    v_cvt_pk_bf16_f32 v74, v7, v8
    v_perm_b32 v12, v74, v74, s41
    v_bitop3_b32 v36, v4, v12, v36 bitop3:0xca
    v_perm_b32 v13, v74, v74, s42
    v_bitop3_b32 v37, v4, v13, v37 bitop3:0xca
    v_mul_hi_u32_u24 v14, 429497, v38
    v_lshrrev_b32 v12, 3, v78
    v_cos_f32 v9, v9
    v_lshlrev_b16 v13, 3, v78
    v_mad_i32_i24 v11, v14, s55, v38
    v_bitop3_b32 v12, v6, v13, v12 bitop3:0xca
    v_lshl_add_u32 v11, v11, 17, s40
    v_lshlrev_b16 v14, 8, v14
    v_lshrrev_b32 v13, 2, v78
    v_add_u32 v38, v12, v11
    v_bitop3_b32 v78, v5, v13, v14 bitop3:0xea
    ds_add_u32 v78, v2
    v_mul_hi_u32_u24 v14, 429497, v39
    v_lshrrev_b32 v12, 3, v79
    v_cos_f32 v10, v10
    v_lshlrev_b16 v13, 3, v79
    v_mad_i32_i24 v11, v14, s55, v39
    v_bitop3_b32 v12, v6, v13, v12 bitop3:0xca
    v_lshl_add_u32 v11, v11, 17, s40
    v_lshlrev_b16 v14, 8, v14
    v_lshrrev_b32 v13, 2, v79
    v_add_u32 v39, v12, v11
    v_bitop3_b32 v79, v5, v13, v14 bitop3:0xea
    ds_add_u32 v79, v2
    v_cvt_pk_bf16_f32 v75, v9, v10
    v_perm_b32 v12, v75, v75, s41
    v_bitop3_b32 v38, v4, v12, v38 bitop3:0xca
    v_perm_b32 v13, v75, v75, s42
    v_bitop3_b32 v39, v4, v13, v39 bitop3:0xca
L1_s5:
    s_setprio 0
    s_waitcnt vmcnt(19)
    s_cmp_le_u32 s43, 6
    s_cbranch_scc1 L1_s6
    v_lshlrev_b32 v7, 16, v64
    v_and_b32 v8, 0xffff0000, v64
    v_lshlrev_b32 v9, 16, v65
    v_and_b32 v10, 0xffff0000, v65
    v_mul_f32 v7, 0.15915494, v7
    v_mul_f32 v8, 0.15915494, v8
    v_mul_f32 v9, 0.15915494, v9
    v_mul_f32 v10, 0.15915494, v10
    v_mul_hi_u32_u24 v14, 429497, v80
    v_lshrrev_b32 v12, 3, v56
    v_cos_f32 v7, v7
    v_lshlrev_b16 v13, 3, v56
    v_mad_i32_i24 v11, v14, s55, v80
    v_bitop3_b32 v12, v6, v13, v12 bitop3:0xca
    v_lshl_add_u32 v11, v11, 17, s40
    v_lshlrev_b16 v14, 8, v14
    v_lshrrev_b32 v13, 2, v56
    v_add_u32 v80, v12, v11
    v_bitop3_b32 v56, v5, v13, v14 bitop3:0xea
    ds_add_u32 v56, v2
    v_mul_hi_u32_u24 v14, 429497, v81
    v_lshrrev_b32 v12, 3, v57
    v_cos_f32 v8, v8
    v_lshlrev_b16 v13, 3, v57
    v_mad_i32_i24 v11, v14, s55, v81
    v_bitop3_b32 v12, v6, v13, v12 bitop3:0xca
    v_lshl_add_u32 v11, v11, 17, s40
    v_lshlrev_b16 v14, 8, v14
    v_lshrrev_b32 v13, 2, v57
    v_add_u32 v81, v12, v11
    v_bitop3_b32 v57, v5, v13, v14 bitop3:0xea
    ds_add_u32 v57, v2
    v_cvt_pk_bf16_f32 v64, v7, v8
    v_perm_b32 v12, v64, v64, s41
    v_bitop3_b32 v80, v4, v12, v80 bitop3:0xca
    v_perm_b32 v13, v64, v64, s42
    v_bitop3_b32 v81, v4, v13, v81 bitop3:0xca
    v_mul_hi_u32_u24 v14, 429497, v82
    v_lshrrev_b32 v12, 3, v58
    v_cos_f32 v9, v9
    v_lshlrev_b16 v13, 3, v58
    v_mad_i32_i24 v11, v14, s55, v82
    v_bitop3_b32 v12, v6, v13, v12 bitop3:0xca
    v_lshl_add_u32 v11, v11, 17, s40
    v_lshlrev_b16 v14, 8, v14
    v_lshrrev_b32 v13, 2, v58
    v_add_u32 v82, v12, v11
    v_bitop3_b32 v58, v5, v13, v14 bitop3:0xea
    ds_add_u32 v58, v2
    v_mul_hi_u32_u24 v14, 429497, v83
    v_lshrrev_b32 v12, 3, v59
    v_cos_f32 v10, v10
    v_lshlrev_b16 v13, 3, v59
    v_mad_i32_i24 v11, v14, s55, v83
    v_bitop3_b32 v12, v6, v13, v12 bitop3:0xca
    v_lshl_add_u32 v11, v11, 17, s40
    v_lshlrev_b16 v14, 8, v14
    v_lshrrev_b32 v13, 2, v59
    v_add_u32 v83, v12, v11
    v_bitop3_b32 v59, v5, v13, v14 bitop3:0xea
    ds_add_u32 v59, v2
    v_cvt_pk_bf16_f32 v65, v9, v10
    v_perm_b32 v12, v65, v65, s41
    v_bitop3_b32 v82, v4, v12, v82 bitop3:0xca
    v_perm_b32 v13, v65, v65, s42
    v_bitop3_b32 v83, v4, v13, v83 bitop3:0xca
L1_s6:
    s_waitcnt vmcnt(15)
    s_cmp_le_u32 s43, 7
    s_cbranch_scc1 L1_s7
    v_lshlrev_b32 v7, 16, v66
    v_and_b32 v8, 0xffff0000, v66
    v_lshlrev_b32 v9, 16, v67
    v_and_b32 v10, 0xffff0000, v67
    v_mul_f32 v7, 0.15915494, v7
    v_mul_f32 v8, 0.15915494, v8
    v_mul_f32 v9, 0.15915494, v9
    v_mul_f32 v10, 0.15915494, v10
    v_mul_hi_u32_u24 v14, 429497, v96
    v_lshrrev_b32 v12, 3, v60
    v_cos_f32 v7, v7
    v_lshlrev_b16 v13, 3, v60
    v_mad_i32_i24 v11, v14, s55, v96
    v_bitop3_b32 v12, v6, v13, v12 bitop3:0xca
    v_lshl_add_u32 v11, v11, 17, s40
    v_lshlrev_b16 v14, 8, v14
    v_lshrrev_b32 v13, 2, v60
    v_add_u32 v96, v12, v11
    v_bitop3_b32 v60, v5, v13, v14 bitop3:0xea
    ds_add_u32 v60, v2
    v_mul_hi_u32_u24 v14, 429497, v97
    v_lshrrev_b32 v12, 3, v61
    v_cos_f32 v8, v8
    v_lshlrev_b16 v13, 3, v61
    v_mad_i32_i24 v11, v14, s55, v97
    v_bitop3_b32 v12, v6, v13, v12 bitop3:0xca
    v_lshl_add_u32 v11, v11, 17, s40
    v_lshlrev_b16 v14, 8, v14
    v_lshrrev_b32 v13, 2, v61
    v_add_u32 v97, v12, v11
    v_bitop3_b32 v61, v5, v13, v14 bitop3:0xea
    ds_add_u32 v61, v2
    v_cvt_pk_bf16_f32 v66, v7, v8
    v_perm_b32 v12, v66, v66, s41
    v_bitop3_b32 v96, v4, v12, v96 bitop3:0xca
    v_perm_b32 v13, v66, v66, s42
    v_bitop3_b32 v97, v4, v13, v97 bitop3:0xca
    v_mul_hi_u32_u24 v14, 429497, v98
    v_lshrrev_b32 v12, 3, v62
    v_cos_f32 v9, v9
    v_lshlrev_b16 v13, 3, v62
    v_mad_i32_i24 v11, v14, s55, v98
    v_bitop3_b32 v12, v6, v13, v12 bitop3:0xca
    v_lshl_add_u32 v11, v11, 17, s40
    v_lshlrev_b16 v14, 8, v14
    v_lshrrev_b32 v13, 2, v62
    v_add_u32 v98, v12, v11
    v_bitop3_b32 v62, v5, v13, v14 bitop3:0xea
    ds_add_u32 v62, v2
    v_mul_hi_u32_u24 v14, 429497, v99
    v_lshrrev_b32 v12, 3, v63
    v_cos_f32 v10, v10
    v_lshlrev_b16 v13, 3, v63
    v_mad_i32_i24 v11, v14, s55, v99
    v_bitop3_b32 v12, v6, v13, v12 bitop3:0xca
    v_lshl_add_u32 v11, v11, 17, s40
    v_lshlrev_b16 v14, 8, v14
    v_lshrrev_b32 v13, 2, v63
    v_add_u32 v99, v12, v11
    v_bitop3_b32 v63, v5, v13, v14 bitop3:0xea
    ds_add_u32 v63, v2
    v_cvt_pk_bf16_f32 v67, v9, v10
    v_perm_b32 v12, v67, v67, s41
    v_bitop3_b32 v98, v4, v12, v98 bitop3:0xca
    v_perm_b32 v13, v67, v67, s42
    v_bitop3_b32 v99, v4, v13, v99 bitop3:0xca
L1_s7:
    v_lshrrev_b32 v8, 2, v0
    v_and_b32 v7, 0x3c00, v0
    v_bitop3_b32 v7, v5, v8, v7 bitop3:0xea
    s_waitcnt lgkmcnt(0)
    s_barrier
    ds_read2st64_b32 v[8:9], v7 offset0:0 offset1:1
    ds_read2st64_b32 v[10:11], v7 offset0:2 offset1:3
    s_add_u32 s47, s35, 0x7ed4000
    buffer_store_dwordx4 v[112:115], v0, s[20:23], s47 offen sc1
    s_waitcnt lgkmcnt(0)
    v_lshl_or_b32 v12, v9, 16, v8
    v_lshl_or_b32 v13, v11, 16, v10
    v_mov_b32 v14, v12
    v_mov_b32 v15, v13
    s_nop 0
    v_add_u32_dpp v14, v14, v14 row_shr:1 row_mask:0xf bank_mask:0xf bound_ctrl:1
    v_add_u32_dpp v15, v15, v15 row_shr:1 row_mask:0xf bank_mask:0xf bound_ctrl:1
    s_nop 0
    v_add_u32_dpp v14, v14, v14 row_shr:2 row_mask:0xf bank_mask:0xf bound_ctrl:1
    v_add_u32_dpp v15, v15, v15 row_shr:2 row_mask:0xf bank_mask:0xf bound_ctrl:1
    s_nop 0
    v_add_u32_dpp v14, v14, v14 row_shr:4 row_mask:0xf bank_mask:0xf bound_ctrl:1
    v_add_u32_dpp v15, v15, v15 row_shr:4 row_mask:0xf bank_mask:0xf bound_ctrl:1
    s_nop 0
    v_add_u32_dpp v14, v14, v14 row_shr:8 row_mask:0xf bank_mask:0xf bound_ctrl:1
    v_add_u32_dpp v15, v15, v15 row_shr:8 row_mask:0xf bank_mask:0xf bound_ctrl:1
    s_nop 0
    v_add_u32_dpp v14, v14, v14 row_bcast:15 row_mask:0xa bank_mask:0xf
    v_add_u32_dpp v15, v15, v15 row_bcast:15 row_mask:0xa bank_mask:0xf
    s_nop 0
    v_add_u32_dpp v14, v14, v14 row_bcast:31 row_mask:0xc bank_mask:0xf
    v_add_u32_dpp v15, v15, v15 row_bcast:31 row_mask:0xc bank_mask:0xf
    v_readlane_b32 s48, v14, 63
    v_readlane_b32 s49, v15, 63
    s_lshl_b32 s54, s32, 2
    v_mov_b32 v8, s54
    s_and_b32 s50, s48, 0xffff
    s_lshr_b32 s51, s48, 16
    s_and_b32 s52, s49, 0xffff
    s_lshr_b32 s53, s49, 16
    s_add_u32 s51, s51, s50
    s_add_u32 s52, s52, s51
    s_add_u32 s53, s53, s52
    v_mov_b32 v9, s53
    s_mov_b64 exec, 1
    ds_write_b32 v8, v9 offset:16384
    s_mov_b64 exec, -1
    v_and_b32 v8, 60, v7
    s_waitcnt lgkmcnt(0)
    s_barrier
    ds_read_b32 v9, v8 offset:16384
    s_waitcnt lgkmcnt(0)
    v_add_u32_dpp v9, v9, v9 row_shr:1 row_mask:0xf bank_mask:0xf bound_ctrl:1
    s_nop 1
    v_add_u32_dpp v9, v9, v9 row_shr:2 row_mask:0xf bank_mask:0xf bound_ctrl:1
    s_nop 1
    v_add_u32_dpp v9, v9, v9 row_shr:4 row_mask:0xf bank_mask:0xf bound_ctrl:1
    s_nop 1
    v_add_u32_dpp v9, v9, v9 row_shr:8 row_mask:0xf bank_mask:0xf bound_ctrl:1
    s_nop 0
    v_readlane_b32 s54, v9, s32
    s_sub_u32 s54, s54, s53
    s_add_u32 s50, s50, s54
    s_add_u32 s51, s51, s54
    s_add_u32 s52, s52, s54
    s_pack_ll_b32_b16 s48, s54, s50
    s_pack_ll_b32_b16 s49, s51, s52
    v_add_u32 v14, s48, v14
    v_add_u32 v15, s49, v15
    v_sub_u32 v12, v14, v12
    v_sub_u32 v13, v15, v13
    v_and_b32 v8, 0xffff, v12
    v_lshrrev_b32 v9, 16, v12
    v_and_b32 v10, 0xffff, v13
    v_lshrrev_b32 v11, 16, v13
    ds_write2st64_b32 v7, v8, v9 offset0:0 offset1:1
    ds_write2st64_b32 v7, v10, v11 offset0:2 offset1:3
    v_and_b32 v8, 0x3f0, v0
    v_lshl_add_u32 v8, v8, 1, s36
    ds_write_b64 v8, v[12:13] offset:20480
    s_bitset0_b64 exec, 63
    s_not_b64 exec, exec
    ds_write_b64 v8, v[14:15] offset:20512
    s_mov_b64 exec, -1
    s_waitcnt lgkmcnt(0)
    s_barrier
    s_setprio 3
    ds_add_rtn_u32 v120, v120, v2
    ds_add_rtn_u32 v121, v121, v2
    ds_add_rtn_u32 v122, v122, v2
    ds_add_rtn_u32 v123, v123, v2
    ds_read_b128 v[12:15], v0 offset:20480
    v_cmp_gt_u32 vcc, 8448, v0
    ds_add_rtn_u32 v124, v124, v2
    ds_add_rtn_u32 v125, v125, v2
    ds_add_rtn_u32 v126, v126, v2
    ds_add_rtn_u32 v127, v127, v2
    s_setprio 2
    ds_add_rtn_u32 v24, v24, v2
    ds_add_rtn_u32 v25, v25, v2
    ds_add_rtn_u32 v26, v26, v2
    ds_add_rtn_u32 v27, v27, v2
    s_waitcnt lgkmcnt(8)
    s_cbranch_vccz L1_p8
    s_add_u32 s44, s35, 0xa900000
    s_mov_b64 exec, vcc
    buffer_store_dwordx4 v[12:15], v0, s[24:27], s44 offen sc1
    s_mov_b64 exec, -1
L1_p8:
    s_add_u32 s45, s35, 0x7ed8000
    buffer_store_dwordx4 v[88:91], v0, s[20:23], s45 offen sc1
    ds_add_rtn_u32 v52, v52, v2
    ds_add_rtn_u32 v53, v53, v2
    ds_add_rtn_u32 v54, v54, v2
    ds_add_rtn_u32 v55, v55, v2
    s_setprio 1
    ds_add_rtn_u32 v68, v68, v2
    ds_add_rtn_u32 v69, v69, v2
    ds_add_rtn_u32 v70, v70, v2
    ds_add_rtn_u32 v71, v71, v2
    s_add_u32 s80, s30, 0xd340000
    s_addc_u32 s81, s31, 0
    s_mov_b32 s82, 0xa000
    s_mov_b32 s83, 0x20000
    s_min_u32 s3, s84, 127
    s_mul_i32 s3, s3, 40960
    s_add_u32 s80, s80, s3
    s_addc_u32 s81, s81, 0
    s_cmp_ge_u32 s84, 128
    s_cselect_b32 s82, 0, s82
    s_waitcnt vmcnt(2)
    v_add_u32 v9, 0, v0
    buffer_store_dwordx4 v[108:111], v9, s[80:83], 0 offen sc1
    v_add_u32 v9, 16384, v0
    buffer_store_dwordx4 v[100:103], v9, s[80:83], 0 offen sc1
    v_add_u32 v9, 32768, v0
    buffer_store_dwordx4 v[28:31], v9, s[80:83], 0 offen sc1
    s_cmp_le_u32 s43, 5
    s_cbranch_scc1 L1_s9
    ds_add_rtn_u32 v76, v76, v2
    ds_add_rtn_u32 v77, v77, v2
    ds_add_rtn_u32 v78, v78, v2
    ds_add_rtn_u32 v79, v79, v2
L1_s9:
    s_setprio 0
    s_cmp_le_u32 s43, 6
    s_cbranch_scc1 L1_s10
    ds_add_rtn_u32 v56, v56, v2
    ds_add_rtn_u32 v57, v57, v2
    ds_add_rtn_u32 v58, v58, v2
    ds_add_rtn_u32 v59, v59, v2
L1_s10:
    s_cmp_le_u32 s43, 7
    s_cbranch_scc1 L1_s11
    ds_add_rtn_u32 v60, v60, v2
    ds_add_rtn_u32 v61, v61, v2
    ds_add_rtn_u32 v62, v62, v2
    ds_add_rtn_u32 v63, v63, v2
L1_s11:
    s_waitcnt lgkmcnt(0)
    s_barrier
    s_setprio 3
    v_and_b32 v7, -4, v120
    v_lshl_add_u32 v8, v120, 2, v7
    ds_write_b32 v8, v16
    v_lshl_add_u32 v7, v7, 2, v120
    ds_write_b8 v7, v44 offset:16
    v_and_b32 v9, -4, v121
    v_lshl_add_u32 v10, v121, 2, v9
    ds_write_b32 v10, v17
    v_lshl_add_u32 v9, v9, 2, v121
    ds_write_b8_d16_hi v9, v44 offset:16
    v_and_b32 v7, -4, v122
    v_lshl_add_u32 v8, v122, 2, v7
    ds_write_b32 v8, v18
    v_lshl_add_u32 v7, v7, 2, v122
    ds_write_b8 v7, v45 offset:16
    v_and_b32 v9, -4, v123
    v_lshl_add_u32 v10, v123, 2, v9
    ds_write_b32 v10, v19
    v_lshl_add_u32 v9, v9, 2, v123
    ds_write_b8_d16_hi v9, v45 offset:16
    s_add_u32 s46, s35, 0x7edc000
    buffer_store_dwordx4 v[116:119], v0, s[20:23], s46 offen sc1
    v_and_b32 v7, -4, v124
    v_lshl_add_u32 v8, v124, 2, v7
    ds_write_b32 v8, v20
    v_lshl_add_u32 v7, v7, 2, v124
    ds_write_b8 v7, v46 offset:16
    v_and_b32 v9, -4, v125
    v_lshl_add_u32 v10, v125, 2, v9
    ds_write_b32 v10, v21
    v_lshl_add_u32 v9, v9, 2, v125
    ds_write_b8_d16_hi v9, v46 offset:16
    v_and_b32 v7, -4, v126
    v_lshl_add_u32 v8, v126, 2, v7
    ds_write_b32 v8, v22
    v_lshl_add_u32 v7, v7, 2, v126
    ds_write_b8 v7, v47 offset:16
    v_and_b32 v9, -4, v127
    v_lshl_add_u32 v10, v127, 2, v9
    ds_write_b32 v10, v23
    v_lshl_add_u32 v9, v9, 2, v127
    ds_write_b8_d16_hi v9, v47 offset:16
    s_setprio 2
    v_and_b32 v7, -4, v24
    v_lshl_add_u32 v8, v24, 2, v7
    ds_write_b32 v8, v40
    v_lshl_add_u32 v7, v7, 2, v24
    ds_write_b8 v7, v32 offset:16
    v_and_b32 v9, -4, v25
    v_lshl_add_u32 v10, v25, 2, v9
    ds_write_b32 v10, v41
    v_lshl_add_u32 v9, v9, 2, v25
    ds_write_b8_d16_hi v9, v32 offset:16
    v_and_b32 v7, -4, v26
    v_lshl_add_u32 v8, v26, 2, v7
    ds_write_b32 v8, v42
    v_lshl_add_u32 v7, v7, 2, v26
    ds_write_b8 v7, v33 offset:16
    v_and_b32 v9, -4, v27
    v_lshl_add_u32 v10, v27, 2, v9
    ds_write_b32 v10, v43
    v_lshl_add_u32 v9, v9, 2, v27
    ds_write_b8_d16_hi v9, v33 offset:16
    s_add_u32 s47, s35, 0x7ee0000
    buffer_store_dwordx4 v[92:95], v0, s[20:23], s47 offen sc1
    v_and_b32 v7, -4, v52
    v_lshl_add_u32 v8, v52, 2, v7
    ds_write_b32 v8, v48
    v_lshl_add_u32 v7, v7, 2, v52
    ds_write_b8 v7, v34 offset:16
    v_and_b32 v9, -4, v53
    v_lshl_add_u32 v10, v53, 2, v9
    ds_write_b32 v10, v49
    v_lshl_add_u32 v9, v9, 2, v53
    ds_write_b8_d16_hi v9, v34 offset:16
    v_and_b32 v7, -4, v54
    v_lshl_add_u32 v8, v54, 2, v7
    ds_write_b32 v8, v50
    v_lshl_add_u32 v7, v7, 2, v54
    ds_write_b8 v7, v35 offset:16
    v_and_b32 v9, -4, v55
    v_lshl_add_u32 v10, v55, 2, v9
    ds_write_b32 v10, v51
    v_lshl_add_u32 v9, v9, 2, v55
    ds_write_b8_d16_hi v9, v35 offset:16
    s_setprio 1
    v_and_b32 v7, -4, v68
    v_lshl_add_u32 v8, v68, 2, v7
    ds_write_b32 v8, v84
    v_lshl_add_u32 v7, v7, 2, v68
    ds_write_b8 v7, v72 offset:16
    v_and_b32 v9, -4, v69
    v_lshl_add_u32 v10, v69, 2, v9
    ds_write_b32 v10, v85
    v_lshl_add_u32 v9, v9, 2, v69
    ds_write_b8_d16_hi v9, v72 offset:16
    v_and_b32 v7, -4, v70
    v_lshl_add_u32 v8, v70, 2, v7
    ds_write_b32 v8, v86
    v_lshl_add_u32 v7, v7, 2, v70
    ds_write_b8 v7, v73 offset:16
    v_and_b32 v9, -4, v71
    v_lshl_add_u32 v10, v71, 2, v9
    ds_write_b32 v10, v87
    v_lshl_add_u32 v9, v9, 2, v71
    ds_write_b8_d16_hi v9, v73 offset:16
    s_cmp_le_u32 s43, 5
    s_cbranch_scc1 L1_s12
    v_and_b32 v7, -4, v76
    v_lshl_add_u32 v8, v76, 2, v7
    ds_write_b32 v8, v36
    v_lshl_add_u32 v7, v7, 2, v76
    ds_write_b8 v7, v74 offset:16
    v_and_b32 v9, -4, v77
    v_lshl_add_u32 v10, v77, 2, v9
    ds_write_b32 v10, v37
    v_lshl_add_u32 v9, v9, 2, v77
    ds_write_b8_d16_hi v9, v74 offset:16
    v_and_b32 v7, -4, v78
    v_lshl_add_u32 v8, v78, 2, v7
    ds_write_b32 v8, v38
    v_lshl_add_u32 v7, v7, 2, v78
    ds_write_b8 v7, v75 offset:16
    v_and_b32 v9, -4, v79
    v_lshl_add_u32 v10, v79, 2, v9
    ds_write_b32 v10, v39
    v_lshl_add_u32 v9, v9, 2, v79
    ds_write_b8_d16_hi v9, v75 offset:16
L1_s12:
    s_add_u32 s44, s35, 0x7ee4000
    buffer_store_dwordx4 v[104:107], v0, s[20:23], s44 offen sc1
    s_setprio 0
    s_cmp_le_u32 s43, 6
    s_cbranch_scc1 L1_s13
    v_and_b32 v7, -4, v56
    v_lshl_add_u32 v8, v56, 2, v7
    ds_write_b32 v8, v80
    v_lshl_add_u32 v7, v7, 2, v56
    ds_write_b8 v7, v64 offset:16
    v_and_b32 v9, -4, v57
    v_lshl_add_u32 v10, v57, 2, v9
    ds_write_b32 v10, v81
    v_lshl_add_u32 v9, v9, 2, v57
    ds_write_b8_d16_hi v9, v64 offset:16
    v_and_b32 v7, -4, v58
    v_lshl_add_u32 v8, v58, 2, v7
    ds_write_b32 v8, v82
    v_lshl_add_u32 v7, v7, 2, v58
    ds_write_b8 v7, v65 offset:16
    v_and_b32 v9, -4, v59
    v_lshl_add_u32 v10, v59, 2, v9
    ds_write_b32 v10, v83
    v_lshl_add_u32 v9, v9, 2, v59
    ds_write_b8_d16_hi v9, v65 offset:16
L1_s13:
    s_cmp_le_u32 s43, 7
    s_cbranch_scc1 L1_s14
    v_and_b32 v7, -4, v60
    v_lshl_add_u32 v8, v60, 2, v7
    ds_write_b32 v8, v96
    v_lshl_add_u32 v7, v7, 2, v60
    ds_write_b8 v7, v66 offset:16
    v_and_b32 v9, -4, v61
    v_lshl_add_u32 v10, v61, 2, v9
    ds_write_b32 v10, v97
    v_lshl_add_u32 v9, v9, 2, v61
    ds_write_b8_d16_hi v9, v66 offset:16
    v_and_b32 v7, -4, v62
    v_lshl_add_u32 v8, v62, 2, v7
    ds_write_b32 v8, v98
    v_lshl_add_u32 v7, v7, 2, v62
    ds_write_b8 v7, v67 offset:16
    v_and_b32 v9, -4, v63
    v_lshl_add_u32 v10, v63, 2, v9
    ds_write_b32 v10, v99
    v_lshl_add_u32 v9, v9, 2, v63
    ds_write_b8_d16_hi v9, v67 offset:16
L1_s14:
    v_add_u32 v7, 0x10000, v0
    v_add_u32 v12, 0x20000, v0
    s_waitcnt lgkmcnt(0)
    s_barrier
    ds_read_b128 v[112:115], v0 offset:0
    ds_read_b128 v[88:91], v0 offset:16384
    ds_read_b128 v[108:111], v0 offset:32768
    ds_read_b128 v[100:103], v0 offset:49152
    ds_read_b128 v[28:31], v7 offset:0
    ds_read_b128 v[16:19], v7 offset:16384
    ds_read_b128 v[120:123], v7 offset:32768
    ds_read_b128 v[116:119], v7 offset:49152
    ds_read_b128 v[20:23], v12 offset:0
    ds_read_b128 v[124:127], v12 offset:16384
    s_waitcnt lgkmcnt(9)
    s_add_u32 s45, s35, 0xa900000
    buffer_store_dwordx4 v[112:115], v0, s[20:23], s45 offen sc1
    s_waitcnt lgkmcnt(8)
    s_add_u32 s46, s35, 0xa904000
    buffer_store_dwordx4 v[88:91], v0, s[20:23], s46 offen sc1
    s_waitcnt lgkmcnt(7)
    s_add_u32 s47, s35, 0xa908000
    buffer_store_dwordx4 v[108:111], v0, s[20:23], s47 offen sc1
    s_waitcnt lgkmcnt(6)
    s_add_u32 s44, s35, 0xa90c000
    buffer_store_dwordx4 v[100:103], v0, s[20:23], s44 offen sc1
    s_waitcnt lgkmcnt(5)
    s_add_u32 s45, s35, 0xa910000
    buffer_store_dwordx4 v[28:31], v0, s[20:23], s45 offen sc1
    s_waitcnt lgkmcnt(4)
    s_add_u32 s46, s35, 0xa914000
    buffer_store_dwordx4 v[16:19], v0, s[20:23], s46 offen sc1
    s_waitcnt lgkmcnt(3)
    s_add_u32 s47, s35, 0xa918000
    buffer_store_dwordx4 v[120:123], v0, s[20:23], s47 offen sc1
    s_cmp_le_u32 s43, 5
    s_cbranch_scc1 L1_fin
    s_waitcnt lgkmcnt(2)
    s_add_u32 s44, s35, 0xa91c000
    buffer_store_dwordx4 v[116:119], v0, s[20:23], s44 offen sc1
    s_cmp_le_u32 s43, 6
    s_cbranch_scc1 L1_fin
    s_waitcnt lgkmcnt(1)
    s_add_u32 s45, s35, 0xa920000
    buffer_store_dwordx4 v[20:23], v0, s[20:23], s45 offen sc1
    s_cmp_le_u32 s43, 7
    s_cbranch_scc1 L1_fin
    s_waitcnt lgkmcnt(0)
    s_add_u32 s46, s35, 0xa924000
    buffer_store_dwordx4 v[124:127], v0, s[20:23], s46 offen sc1
L1_fin:
L1_end:
    s_endpgm
.text
.globl gs_acc_kernel
.p2align 8
.type gs_acc_kernel,@function
gs_acc_kernel:
    s_cmp_ge_u32 s2, 256
    s_cbranch_scc1 L2_end
    s_load_dwordx2 s[30:31], s[0:1], 104
    s_load_dwordx2 s[28:29], s[0:1], 0
    s_load_dwordx2 s[6:7], s[0:1], 40
    v_lshrrev_b32 v16, 6, v0
    v_and_b32 v17, 63, v0
    v_readfirstlane_b32 s32, v16
    s_bfe_u32 s33, s2, 0x20001
    s_and_b32 s34, s2, 1
    s_lshl_b32 s34, s34, 5
    s_lshr_b32 s4, s2, 3
    s_add_u32 s34, s34, s4
    v_and_b32 v22, 3, v0
    v_lshlrev_b32 v19, 6, v16
    v_add_u32 v18, v17, v19
    v_mul_u32_u24 v2, 173056, v18
    v_lshrrev_b32 v18, 2, v17
    v_lshl_add_u32 v18, v16, 4, v18
    v_add_u32 v18, 0x400, v18
    v_mul_u32_u24 v4, 173056, v18
    v_lshl_add_u32 v20, v22, 4, v4
    v_and_b32 v18, 3, v18
    v_lshl_add_u32 v20, v18, 5, v20
    v_lshl_add_u32 v25, v22, 5, v2
    s_mul_i32 s39, s33, 2080
    s_lshl_b32 s3, s34, 5
    s_add_u32 s39, s39, s3
    s_mul_i32 s40, s33, 1310720
    s_mul_i32 s3, s32, 5120
    v_lshl_add_u32 v3, v17, 4, s3
    s_lshl_b32 s38, s32, 11
    s_mul_i32 s69, s32, 3072
    s_waitcnt lgkmcnt(0)
    s_add_u32 s12, s30, 0x28000
    s_addc_u32 s13, s31, 0
    s_mov_b32 s14, 0xd318000
    s_mov_b32 s15, 0x20000
    buffer_load_dwordx4 v[48:51], v25, s[12:15], s39 offen offset:0
    buffer_load_dwordx4 v[56:59], v25, s[12:15], s39 offen offset:32
    buffer_load_dwordx4 v[52:55], v25, s[12:15], s39 offen offset:16
    buffer_load_dwordx4 v[60:63], v25, s[12:15], s39 offen offset:48
    buffer_load_dwordx4 v[64:67], v20, s[12:15], s39 offen
    s_add_u32 s16, s30, 0xd340000
    s_addc_u32 s17, s31, 0
    s_mov_b32 s18, 0x500000
    s_mov_b32 s19, 0x20000
    s_add_u32 s24, s30, 0xebc9000
    s_addc_u32 s25, s31, 0
    s_mov_b32 s26, 0x100
    s_mov_b32 s27, 0x20000
    v_lshlrev_b32 v21, 6, v22
    buffer_load_dwordx2 v[8:9], v21, s[24:27], 0 offen offset:40
    s_add_u32 s3, s40, 4096
    buffer_load_dwordx4 v[124:127], v3, s[16:19], s3 offen
    buffer_load_dwordx4 v[116:119], v3, s[16:19], s40 offen offset:2048
    buffer_load_dwordx4 v[120:123], v3, s[16:19], s40 offen offset:3072
    buffer_load_dwordx4 v[108:111], v3, s[16:19], s40 offen offset:0
    buffer_load_dwordx4 v[112:115], v3, s[16:19], s40 offen offset:1024
    s_add_u32 s40, s40, 0x50000
    v_mad_u32_u24 v4, v22, 20, v4
    v_or_b32 v4, 0xf0000000, v4
    v_or_b32 v2, 0xf0000000, v2
    v_lshlrev_b32 v23, 2, v22
    v_sub_u32 v1, 28, v23
    v_and_b32 v18, 3, v0
    v_lshlrev_b32 v18, 4, v18
    v_mov_b32 v10, 0x3f80
    v_mov_b32 v11, 0
    v_lshlrev_b64 v[10:11], v18, v[10:11]
    v_and_b32 v18, 3, v0
    v_lshlrev_b32 v18, 4, v18
    v_mov_b32 v12, 0xbf80
    v_mov_b32 v13, 0
    v_lshlrev_b64 v[12:13], v18, v[12:13]
    v_lshlrev_b32 v24, 4, v0
    v_lshl_add_u32 v0, v17, 2, s38
    v_mov_b32 v45, 0xf0000000
    v_mov_b32 v5, 0x1fff8
    v_mov_b32 v6, 0x07ff0000
    s_mov_b32 s44, 0x4000c0c
    s_mov_b32 s45, 0x4010c0c
    s_mov_b32 s46, 0x4020c0c
    s_mov_b32 s47, 0x4030c0c
    s_mov_b32 s36, 0
    s_mov_b32 s42, 0
    s_mov_b64 s[80:81], 0
    s_mov_b64 s[84:85], 0
    s_mov_b64 s[48:49], 0
    s_load_dwordx4 s[96:99], s[6:7], 0
    s_load_dwordx2 s[4:5], s[0:1], 24
    s_waitcnt lgkmcnt(0)
    s_mov_b32 s8, s30
    s_mov_b32 s9, s31
    s_mov_b32 s10, 0xd340000
    s_mov_b32 s11, 0x20000
    s_add_u32 s20, s30, 0xd841000
    s_addc_u32 s21, s31, 0
    s_mov_b32 s22, 0x13880
    s_mov_b32 s23, 0x20000
    s_lshl_b32 s3, s33, 6
    s_add_u32 s3, s3, s34
    s_mul_i32 s3, s3, 80000
    s_add_u32 s20, s20, s3
    s_addc_u32 s21, s21, 0
    v_mov_b32 v68, 0
    v_mov_b32 v69, 0
    v_mov_b32 v70, 0
    v_mov_b32 v71, 0
    v_mov_b32 v72, 0
    v_mov_b32 v73, 0
    v_mov_b32 v74, 0
    v_mov_b32 v75, 0
    v_add_u32 v24, 81920, v24
    ds_write_b128 v24, v[68:71] offset:0
    ds_write_b128 v24, v[68:71] offset:16384
    ds_write_b128 v24, v[68:71] offset:32768
    ds_write_b128 v24, v[68:71] offset:49152
    v_add_u32 v47, 0x10000, v24
    ds_write_b128 v47, v[68:71]
    s_waitcnt vmcnt(5)
    v_sub_u16 v88, v56, v48
    v_and_b32 v89, 3, v48
    v_add3_u32 v99, v88, v89, 3
    v_and_b32 v99, -4, v99
    v_max_u32 v99, 4, v99
    v_and_b32 v97, 0xfffc, v48
    v_bfm_b32 v96, v88, v89
    v_add_u32_dpp v91, v99, v99 row_shr:1 row_mask:0xf bank_mask:0xf bound_ctrl:1
    v_mad_u32_u24 v97, v97, 5, v2
    v_cmp_lt_u32 vcc, 16, v99
    v_add_u32_dpp v91, v91, v91 row_shr:2 row_mask:0xf bank_mask:0xf bound_ctrl:1
    v_sub_u32 v98, s38, v99
    v_lshrrev_b64 v[48:49], 16, v[48:49]
    v_add_u32_dpp v91, v91, v91 row_shr:4 row_mask:0xf bank_mask:0xf bound_ctrl:1
    v_lshrrev_b64 v[56:57], 16, v[56:57]
    s_mov_b32 s43, 0
    v_add_u32_dpp v91, v91, v91 row_shr:8 row_mask:0xf bank_mask:0xf bound_ctrl:1
    s_nop 1
    v_add_u32_dpp v91, v91, v91 row_bcast:15 row_mask:0xa bank_mask:0xf
    s_nop 1
    v_add_u32_dpp v91, v91, v91 row_bcast:31 row_mask:0xc bank_mask:0xf
    v_add_u32 v98, v98, v91
    v_readlane_b32 s37, v91, 63
    s_cbranch_vccnz L2_xo1
L2_xp1:
    v_mov_b32 v44, v43
    s_cmp_gt_u32 s37, 1024
    s_cbranch_scc1 L2_xs2
    s_cmp_lg_u32 s43, 0
    s_cbranch_scc1 L2_xa2
L2_xb2:
    v_lshlrev_b32 v89, 16, v96
    v_add_u32 v90, 60, v97
    v_bitop3_b32 v90, v89, v45, v90 bitop3:0x6a
    ds_write_b32 v98, v90 offset:12
    v_lshlrev_b32 v89, 20, v96
    v_add_u32 v90, 40, v97
    v_bitop3_b32 v90, v89, v45, v90 bitop3:0x6a
    ds_write_b32 v98, v90 offset:8
    v_lshlrev_b32 v89, 24, v96
    v_add_u32 v90, 20, v97
    v_bitop3_b32 v90, v89, v45, v90 bitop3:0x6a
    ds_write_b32 v98, v90 offset:4
    v_lshlrev_b32 v89, 28, v96
    v_bitop3_b32 v90, v89, v45, v97 bitop3:0x6a
    ds_write_b32 v98, v90 offset:0
    v_mov_b32_dpp v91, v64 quad_perm:[0,0,0,0] row_mask:0xf bank_mask:0xf
    v_and_b32 v89, 3, v91
    v_and_b32 v97, 0xfffc, v91
    v_sub_u16_dpp v88, v64, v91 quad_perm:[2,2,2,2] row_mask:0xf bank_mask:0xf
    v_mad_u32_u24 v97, v97, 5, v4
    v_add_u32 v99, v88, v89
    v_bfm_b32 v96, v88, v89
    v_cmp_lt_u32 s[58:59], 16, v99
    v_lshlrev_b32 v89, v1, v96
    v_and_b32 v89, v45, v89
    v_cmp_ne_u32 vcc, 0, v89
    v_xor_b32 v90, v97, v89
    s_add_u32 s3, s37, s38
    v_mbcnt_lo_u32_b32 v98, vcc_lo, 0
    v_mbcnt_hi_u32_b32 v98, vcc_hi, v98
    s_bcnt1_i32_b64 s41, vcc
    v_lshl_add_u32 v98, v98, 2, s3
    s_mov_b64 exec, vcc
    ds_write_b32 v98, v90
    s_mov_b64 exec, -1
    s_lshl2_add_u32 s37, s41, s37
    s_cmp_lg_u64 s[58:59], 0
    s_cbranch_scc1 L2_xe2
L2_xr2:
    v_add_u32 v98, s37, v0
    v_mov_b32 v90, -1
    ds_write_b32 v98, v90
    ds_read2st64_b32 v[40:41], v0 offset0:0 offset1:1
    ds_read2st64_b32 v[42:43], v0 offset0:2 offset1:3
    s_sub_u32 s3, s37, 768
    s_cmp_gt_u32 s3, 256
    s_cbranch_scc1 L2_xf2
L2_xg2:
    v_sub_u16 v88, v58, v50
    v_and_b32 v89, 3, v50
    v_add3_u32 v99, v88, v89, 3
    v_and_b32 v99, -4, v99
    v_max_u32 v99, 4, v99
    v_and_b32 v97, 0xfffc, v50
    v_bfm_b32 v96, v88, v89
    v_add_u32_dpp v91, v99, v99 row_shr:1 row_mask:0xf bank_mask:0xf bound_ctrl:1
    v_mad_u32_u24 v97, v97, 5, v2
    v_cmp_lt_u32 vcc, 16, v99
    v_add_u32_dpp v91, v91, v91 row_shr:2 row_mask:0xf bank_mask:0xf bound_ctrl:1
    v_sub_u32 v98, s38, v99
    v_lshrrev_b64 v[50:51], 16, v[50:51]
    v_add_u32_dpp v91, v91, v91 row_shr:4 row_mask:0xf bank_mask:0xf bound_ctrl:1
    v_lshrrev_b64 v[58:59], 16, v[58:59]
    s_mov_b32 s43, 0
    v_add_u32_dpp v91, v91, v91 row_shr:8 row_mask:0xf bank_mask:0xf bound_ctrl:1
    s_nop 1
    v_add_u32_dpp v91, v91, v91 row_bcast:15 row_mask:0xa bank_mask:0xf
    s_nop 1
    v_add_u32_dpp v91, v91, v91 row_bcast:31 row_mask:0xc bank_mask:0xf
    v_add_u32 v98, v98, v91
    v_readlane_b32 s37, v91, 63
    s_cbranch_vccnz L2_xo3
L2_xp3:
    s_waitcnt lgkmcnt(0)
    v_mov_b32 v21, v40
    v_mov_b32 v27, v41
    v_mov_b32 v33, v42
    v_mov_b32 v39, v43
    v_and_b32 v47, 0x0fffffff, v21
    buffer_load_dwordx2 v[16:17], v47, s[8:11], 0 offen
    buffer_load_dwordx3 v[18:20], v47, s[8:11], 0 offen offset:8
    s_waitcnt vmcnt(6)
    s_mov_b32 m0, s69
    s_nop 0
    ds_write_addtid_b32 v124 offset:34816
    ds_write_addtid_b32 v125 offset:35072
    ds_write_addtid_b32 v126 offset:35328
    ds_write_addtid_b32 v127 offset:35584
    s_waitcnt vmcnt(5)
    ds_write_addtid_b32 v116 offset:32768
    ds_write_addtid_b32 v117 offset:33024
    ds_write_addtid_b32 v118 offset:33280
    ds_write_addtid_b32 v119 offset:33536
    s_waitcnt vmcnt(4)
    ds_write_addtid_b32 v120 offset:33792
    ds_write_addtid_b32 v121 offset:34048
    ds_write_addtid_b32 v122 offset:34304
    ds_write_addtid_b32 v123 offset:34560
    v_mov_b32 v44, v43
    s_cmp_gt_u32 s37, 1024
    s_cbranch_scc1 L2_xs4
    s_cmp_lg_u32 s43, 0
    s_cbranch_scc1 L2_xa4
L2_xb4:
    v_lshlrev_b32 v89, 16, v96
    v_add_u32 v90, 60, v97
    v_bitop3_b32 v90, v89, v45, v90 bitop3:0x6a
    ds_write_b32 v98, v90 offset:12
    v_lshlrev_b32 v89, 20, v96
    v_add_u32 v90, 40, v97
    v_bitop3_b32 v90, v89, v45, v90 bitop3:0x6a
    ds_write_b32 v98, v90 offset:8
    v_lshlrev_b32 v89, 24, v96
    v_add_u32 v90, 20, v97
    v_bitop3_b32 v90, v89, v45, v90 bitop3:0x6a
    ds_write_b32 v98, v90 offset:4
    v_lshlrev_b32 v89, 28, v96
    v_bitop3_b32 v90, v89, v45, v97 bitop3:0x6a
    ds_write_b32 v98, v90 offset:0
    v_mov_b32_dpp v91, v66 quad_perm:[0,0,0,0] row_mask:0xf bank_mask:0xf
    v_and_b32 v89, 3, v91
    v_and_b32 v97, 0xfffc, v91
    v_sub_u16_dpp v88, v66, v91 quad_perm:[2,2,2,2] row_mask:0xf bank_mask:0xf
    v_mad_u32_u24 v97, v97, 5, v4
    v_add_u32 v99, v88, v89
    v_bfm_b32 v96, v88, v89
    v_cmp_lt_u32 s[58:59], 16, v99
    v_lshlrev_b32 v89, v1, v96
    v_and_b32 v89, v45, v89
    v_cmp_ne_u32 vcc, 0, v89
    v_xor_b32 v90, v97, v89
    s_add_u32 s3, s37, s38
    v_mbcnt_lo_u32_b32 v98, vcc_lo, 0
    v_mbcnt_hi_u32_b32 v98, vcc_hi, v98
    s_bcnt1_i32_b64 s41, vcc
    v_lshl_add_u32 v98, v98, 2, s3
    s_mov_b64 exec, vcc
    ds_write_b32 v98, v90
    s_mov_b64 exec, -1
    s_lshl2_add_u32 s37, s41, s37
    s_cmp_lg_u64 s[58:59], 0
    s_cbranch_scc1 L2_xe4
L2_xr4:
    v_add_u32 v98, s37, v0
    v_mov_b32 v90, -1
    ds_write_b32 v98, v90
    ds_read2st64_b32 v[40:41], v0 offset0:0 offset1:1
    ds_read2st64_b32 v[42:43], v0 offset0:2 offset1:3
    s_sub_u32 s3, s37, 768
    s_cmp_gt_u32 s3, 256
    s_cbranch_scc1 L2_xf4
L2_xg4:
    s_waitcnt vmcnt(3)
    s_mov_b32 m0, s38
    s_nop 0
    ds_write_addtid_b32 v108 offset:0
    ds_write_addtid_b32 v109 offset:256
    ds_write_addtid_b32 v110 offset:512
    ds_write_addtid_b32 v111 offset:768
    s_waitcnt vmcnt(2)
    ds_write_addtid_b32 v112 offset:1024
    ds_write_addtid_b32 v113 offset:1280
    ds_write_addtid_b32 v114 offset:1536
    ds_write_addtid_b32 v115 offset:1792
    s_waitcnt lgkmcnt(0)
    s_barrier
    s_bitcmp1_b32 s36, s42
    s_cbranch_scc1 L2_slow
L2_ret0:
    s_setprio 3
    v_and_b32 v47, 0x0fffffff, v27
    buffer_load_dwordx2 v[22:23], v47, s[8:11], 0 offen
    buffer_load_dwordx3 v[24:26], v47, s[8:11], 0 offen offset:8
    s_waitcnt vmcnt(2)
    v_and_b32 v46, 0x20000000, v21
    v_lshrrev_b32 v47, 14, v17
    v_bitop3_b32 v47, v47, v5, v46 bitop3:0xea
    ds_read_b64 v[102:103], v47
    v_bitop3_b32 v93, v17, v5, v46 bitop3:0xea
    v_and_b32 v46, 0x10000000, v21
    v_lshrrev_b32 v47, 14, v16
    v_bitop3_b32 v47, v47, v5, v46 bitop3:0xea
    ds_read_b64 v[100:101], v47
    v_bitop3_b32 v92, v16, v5, v46 bitop3:0xea
    v_perm_b32 v15, v17, v20, s45
    v_bitop3_b32 v46, v17, 0.5, -0.5 bitop3:0xa8
    v_perm_b32 v14, v16, v20, s44
    v_bitop3_b32 v47, v16, 0.5, -0.5 bitop3:0xa8
    s_waitcnt lgkmcnt(0)
    v_mfma_f32_4x4x4_16b_bf16 v[80:83], v[8:9], v[102:103], 0
    v_mfma_f32_4x4x4_16b_bf16 v[76:79], v[8:9], v[100:101], 0
    v_bitop3_b32 v15, v6, v15, v46 bitop3:0xca
    v_bitop3_b32 v14, v6, v14, v47 bitop3:0xca
    v_cmp_lt_u32 s[84:85], v5, v92
    s_nop 0
    v_pk_mul_f32 v[80:81], v[80:81], v[14:15] op_sel:[0,1] op_sel_hi:[1,1]
    v_pk_mul_f32 v[82:83], v[82:83], v[14:15] op_sel:[0,1] op_sel_hi:[1,1]
    v_pk_mul_f32 v[76:77], v[76:77], v[14:15] op_sel:[0,0] op_sel_hi:[1,0]
    v_pk_mul_f32 v[78:79], v[78:79], v[14:15] op_sel:[0,0] op_sel_hi:[1,0]
    v_and_b32 v47, 0x0fffffff, v33
    buffer_load_dwordx2 v[28:29], v47, s[8:11], 0 offen
    buffer_load_dwordx3 v[30:32], v47, s[8:11], 0 offen offset:8
    v_cmpx_ne_u64 vcc, v[74:75], v[70:71]
    s_and_b64 s[82:83], vcc, s[80:81]
    s_cbranch_scc1 L2_c5
L2_d5:
    v_mov_b64 v[84:85], v[70:71]
    v_mov_b32 v7, v95
    v_mov_b64 v[86:87], v[74:75]
    s_mov_b64 exec, -1
    s_or_b64 s[80:81], s[80:81], vcc
    v_cmpx_ne_u64 vcc, v[72:73], v[68:69]
    s_and_b64 s[82:83], vcc, s[80:81]
    s_cbranch_scc1 L2_c6
L2_d6:
    v_mov_b64 v[84:85], v[68:69]
    v_mov_b32 v7, v94
    v_mov_b64 v[86:87], v[72:73]
    s_mov_b64 exec, -1
    s_or_b64 s[80:81], s[80:81], vcc
    ds_read_b64 v[70:71], v93 offset:65408
    s_and_b64 exec, s[84:85], s[80:81]
    v_mfma_f32_4x4x4_16b_bf16 v[76:79], v[12:13], v[84:85], 0
    v_mov_b32 v92, v7
    s_andn2_b64 s[80:81], s[80:81], s[84:85]
    v_mfma_f32_4x4x4_16b_bf16 v[76:79], v[10:11], v[86:87], v[76:79]
    s_mov_b64 exec, -1
    ds_read_b64 v[68:69], v92 offset:65408
    v_and_b32 v46, 0x80000000, v21
    v_lshrrev_b32 v47, 14, v19
    v_bitop3_b32 v47, v47, v5, v46 bitop3:0xea
    ds_read_b64 v[106:107], v47
    v_bitop3_b32 v95, v19, v5, v46 bitop3:0xea
    v_and_b32 v46, 0x40000000, v21
    v_lshrrev_b32 v47, 14, v18
    v_bitop3_b32 v47, v47, v5, v46 bitop3:0xea
    ds_read_b64 v[104:105], v47
    v_bitop3_b32 v94, v18, v5, v46 bitop3:0xea
    s_waitcnt lgkmcnt(2)
    v_mfma_f32_4x4x4_16b_bf16 v[80:83], v[10:11], v[70:71], v[80:83]
    v_mfma_f32_4x4x4_16b_bf16 v[76:79], v[10:11], v[68:69], v[76:79]
    v_perm_b32 v15, v19, v20, s47
    v_bitop3_b32 v46, v19, 0.5, -0.5 bitop3:0xa8
    v_perm_b32 v14, v18, v20, s46
    v_bitop3_b32 v47, v18, 0.5, -0.5 bitop3:0xa8
    v_cvt_pk_bf16_f32 v80, v80, v81
    v_cvt_pk_bf16_f32 v81, v82, v83
    ds_wrxchg_rtn_b64 v[74:75], v93, v[80:81] offset:65408
    v_cvt_pk_bf16_f32 v76, v76, v77
    v_cvt_pk_bf16_f32 v77, v78, v79
    ds_wrxchg_rtn_b64 v[72:73], v92, v[76:77] offset:65408
    s_setprio 2
    s_waitcnt lgkmcnt(2)
    v_mfma_f32_4x4x4_16b_bf16 v[80:83], v[8:9], v[106:107], 0
    v_mfma_f32_4x4x4_16b_bf16 v[76:79], v[8:9], v[104:105], 0
    v_bitop3_b32 v15, v6, v15, v46 bitop3:0xca
    v_bitop3_b32 v14, v6, v14, v47 bitop3:0xca
    s_nop 1
    v_pk_mul_f32 v[80:81], v[80:81], v[14:15] op_sel:[0,1] op_sel_hi:[1,1]
    v_pk_mul_f32 v[82:83], v[82:83], v[14:15] op_sel:[0,1] op_sel_hi:[1,1]
    v_pk_mul_f32 v[76:77], v[76:77], v[14:15] op_sel:[0,0] op_sel_hi:[1,0]
    v_pk_mul_f32 v[78:79], v[78:79], v[14:15] op_sel:[0,0] op_sel_hi:[1,0]
    s_add_u32 s3, s40, 4096
    buffer_load_dwordx4 v[124:127], v3, s[16:19], s3 offen
    buffer_load_dwordx4 v[116:119], v3, s[16:19], s40 offen offset:2048
    s_waitcnt lgkmcnt(0)
    v_cmpx_ne_u64 vcc, v[74:75], v[70:71]
    s_and_b64 s[82:83], vcc, s[80:81]
    s_cbranch_scc1 L2_c7
L2_d7:
    v_mov_b64 v[84:85], v[70:71]
    v_mov_b32 v7, v93
    v_mov_b64 v[86:87], v[74:75]
    s_mov_b64 exec, -1
    s_or_b64 s[80:81], s[80:81], vcc
    v_cmpx_ne_u64 vcc, v[72:73], v[68:69]
    s_and_b64 s[82:83], vcc, s[80:81]
    s_cbranch_scc1 L2_c8
L2_d8:
    v_mov_b64 v[84:85], v[68:69]
    v_mov_b32 v7, v92
    v_mov_b64 v[86:87], v[72:73]
    s_mov_b64 exec, -1
    s_or_b64 s[80:81], s[80:81], vcc
    ds_read_b64 v[70:71], v95 offset:65408
    ds_read_b64 v[68:69], v94 offset:65408
    s_waitcnt vmcnt(4)
    v_and_b32 v46, 0x20000000, v27
    v_lshrrev_b32 v47, 14, v23
    v_bitop3_b32 v47, v47, v5, v46 bitop3:0xea
    ds_read_b64 v[102:103], v47
    v_bitop3_b32 v93, v23, v5, v46 bitop3:0xea
    v_and_b32 v46, 0x10000000, v27
    v_lshrrev_b32 v47, 14, v22
    v_bitop3_b32 v47, v47, v5, v46 bitop3:0xea
    ds_read_b64 v[100:101], v47
    v_bitop3_b32 v92, v22, v5, v46 bitop3:0xea
    s_waitcnt lgkmcnt(2)
    v_mfma_f32_4x4x4_16b_bf16 v[80:83], v[10:11], v[70:71], v[80:83]
    v_mfma_f32_4x4x4_16b_bf16 v[76:79], v[10:11], v[68:69], v[76:79]
    v_perm_b32 v15, v23, v26, s45
    v_bitop3_b32 v46, v23, 0.5, -0.5 bitop3:0xa8
    v_perm_b32 v14, v22, v26, s44
    v_bitop3_b32 v47, v22, 0.5, -0.5 bitop3:0xa8
    v_cvt_pk_bf16_f32 v80, v80, v81
    v_cvt_pk_bf16_f32 v81, v82, v83
    ds_wrxchg_rtn_b64 v[74:75], v95, v[80:81] offset:65408
    v_cvt_pk_bf16_f32 v76, v76, v77
    v_cvt_pk_bf16_f32 v77, v78, v79
    ds_wrxchg_rtn_b64 v[72:73], v94, v[76:77] offset:65408
    s_waitcnt lgkmcnt(2)
    v_mfma_f32_4x4x4_16b_bf16 v[80:83], v[8:9], v[102:103], 0
    v_mfma_f32_4x4x4_16b_bf16 v[76:79], v[8:9], v[100:101], 0
    v_bitop3_b32 v15, v6, v15, v46 bitop3:0xca
    v_bitop3_b32 v14, v6, v14, v47 bitop3:0xca
    v_cmp_lt_u32 s[84:85], v5, v92
    s_nop 0
    v_pk_mul_f32 v[80:81], v[80:81], v[14:15] op_sel:[0,1] op_sel_hi:[1,1]
    v_pk_mul_f32 v[82:83], v[82:83], v[14:15] op_sel:[0,1] op_sel_hi:[1,1]
    v_pk_mul_f32 v[76:77], v[76:77], v[14:15] op_sel:[0,0] op_sel_hi:[1,0]
    v_pk_mul_f32 v[78:79], v[78:79], v[14:15] op_sel:[0,0] op_sel_hi:[1,0]
    v_sub_u16 v88, v60, v52
    v_and_b32 v89, 3, v52
    v_add3_u32 v99, v88, v89, 3
    v_and_b32 v99, -4, v99
    v_max_u32 v99, 4, v99
    v_and_b32 v97, 0xfffc, v52
    v_bfm_b32 v96, v88, v89
    v_add_u32_dpp v91, v99, v99 row_shr:1 row_mask:0xf bank_mask:0xf bound_ctrl:1
    v_mad_u32_u24 v97, v97, 5, v2
    v_cmp_lt_u32 vcc, 16, v99
    v_add_u32_dpp v91, v91, v91 row_shr:2 row_mask:0xf bank_mask:0xf bound_ctrl:1
    v_sub_u32 v98, s38, v99
    v_lshrrev_b64 v[52:53], 16, v[52:53]
    v_add_u32_dpp v91, v91, v91 row_shr:4 row_mask:0xf bank_mask:0xf bound_ctrl:1
    v_lshrrev_b64 v[60:61], 16, v[60:61]
    s_mov_b32 s43, 0
    v_add_u32_dpp v91, v91, v91 row_shr:8 row_mask:0xf bank_mask:0xf bound_ctrl:1
    s_nop 1
    v_add_u32_dpp v91, v91, v91 row_bcast:15 row_mask:0xa bank_mask:0xf
    s_nop 1
    v_add_u32_dpp v91, v91, v91 row_bcast:31 row_mask:0xc bank_mask:0xf
    v_add_u32 v98, v98, v91
    v_readlane_b32 s37, v91, 63
    s_cbranch_vccnz L2_xo9
L2_xp9:
    v_and_b32 v47, 0x0fffffff, v39
    buffer_load_dwordx2 v[34:35], v47, s[8:11], 0 offen
    buffer_load_dwordx3 v[36:38], v47, s[8:11], 0 offen offset:8
    buffer_load_dwordx4 v[120:123], v3, s[16:19], s40 offen offset:3072
    s_waitcnt lgkmcnt(0)
    v_cmpx_ne_u64 vcc, v[74:75], v[70:71]
    s_and_b64 s[82:83], vcc, s[80:81]
    s_cbranch_scc1 L2_c10
L2_d10:
    v_mov_b64 v[84:85], v[70:71]
    v_mov_b32 v7, v95
    v_mov_b64 v[86:87], v[74:75]
    s_mov_b64 exec, -1
    s_or_b64 s[80:81], s[80:81], vcc
    v_cmpx_ne_u64 vcc, v[72:73], v[68:69]
    s_and_b64 s[82:83], vcc, s[80:81]
    s_cbranch_scc1 L2_c11
L2_d11:
    v_mov_b64 v[84:85], v[68:69]
    v_mov_b32 v7, v94
    v_mov_b64 v[86:87], v[72:73]
    s_mov_b64 exec, -1
    s_or_b64 s[80:81], s[80:81], vcc
    ds_read_b64 v[70:71], v93 offset:65408
    s_and_b64 exec, s[84:85], s[80:81]
    v_mfma_f32_4x4x4_16b_bf16 v[76:79], v[12:13], v[84:85], 0
    v_mov_b32 v92, v7
    s_andn2_b64 s[80:81], s[80:81], s[84:85]
    v_mfma_f32_4x4x4_16b_bf16 v[76:79], v[10:11], v[86:87], v[76:79]
    s_mov_b64 exec, -1
    ds_read_b64 v[68:69], v92 offset:65408
    v_and_b32 v46, 0x80000000, v27
    v_lshrrev_b32 v47, 14, v25
    v_bitop3_b32 v47, v47, v5, v46 bitop3:0xea
    ds_read_b64 v[106:107], v47
    v_bitop3_b32 v95, v25, v5, v46 bitop3:0xea
    v_and_b32 v46, 0x40000000, v27
    v_lshrrev_b32 v47, 14, v24
    v_bitop3_b32 v47, v47, v5, v46 bitop3:0xea
    ds_read_b64 v[104:105], v47
    v_bitop3_b32 v94, v24, v5, v46 bitop3:0xea
    s_waitcnt lgkmcnt(2)
    v_mfma_f32_4x4x4_16b_bf16 v[80:83], v[10:11], v[70:71], v[80:83]
    v_mfma_f32_4x4x4_16b_bf16 v[76:79], v[10:11], v[68:69], v[76:79]
    v_perm_b32 v15, v25, v26, s47
    v_bitop3_b32 v46, v25, 0.5, -0.5 bitop3:0xa8
    v_perm_b32 v14, v24, v26, s46
    v_bitop3_b32 v47, v24, 0.5, -0.5 bitop3:0xa8
    v_cvt_pk_bf16_f32 v80, v80, v81
    v_cvt_pk_bf16_f32 v81, v82, v83
    ds_wrxchg_rtn_b64 v[74:75], v93, v[80:81] offset:65408
    v_cvt_pk_bf16_f32 v76, v76, v77
    v_cvt_pk_bf16_f32 v77, v78, v79
    ds_wrxchg_rtn_b64 v[72:73], v92, v[76:77] offset:65408
    s_setprio 1
    s_waitcnt lgkmcnt(2)
    v_mfma_f32_4x4x4_16b_bf16 v[80:83], v[8:9], v[106:107], 0
    v_mfma_f32_4x4x4_16b_bf16 v[76:79], v[8:9], v[104:105], 0
    v_bitop3_b32 v15, v6, v15, v46 bitop3:0xca
    v_bitop3_b32 v14, v6, v14, v47 bitop3:0xca
    s_nop 1
    v_pk_mul_f32 v[80:81], v[80:81], v[14:15] op_sel:[0,1] op_sel_hi:[1,1]
    v_pk_mul_f32 v[82:83], v[82:83], v[14:15] op_sel:[0,1] op_sel_hi:[1,1]
    v_pk_mul_f32 v[76:77], v[76:77], v[14:15] op_sel:[0,0] op_sel_hi:[1,0]
    v_pk_mul_f32 v[78:79], v[78:79], v[14:15] op_sel:[0,0] op_sel_hi:[1,0]
    buffer_load_dwordx4 v[108:111], v3, s[16:19], s40 offen offset:0
    buffer_load_dwordx4 v[112:115], v3, s[16:19], s40 offen offset:1024
    s_waitcnt lgkmcnt(0)
    v_cmpx_ne_u64 vcc, v[74:75], v[70:71]
    s_and_b64 s[82:83], vcc, s[80:81]
    s_cbranch_scc1 L2_c12
L2_d12:
    v_mov_b64 v[84:85], v[70:71]
    v_mov_b32 v7, v93
    v_mov_b64 v[86:87], v[74:75]
    s_mov_b64 exec, -1
    s_or_b64 s[80:81], s[80:81], vcc
    v_cmpx_ne_u64 vcc, v[72:73], v[68:69]
    s_and_b64 s[82:83], vcc, s[80:81]
    s_cbranch_scc1 L2_c13
L2_d13:
    v_mov_b64 v[84:85], v[68:69]
    v_mov_b32 v7, v92
    v_mov_b64 v[86:87], v[72:73]
    s_mov_b64 exec, -1
    s_or_b64 s[80:81], s[80:81], vcc
    ds_read_b64 v[70:71], v95 offset:65408
    ds_read_b64 v[68:69], v94 offset:65408
    s_waitcnt vmcnt(7)
    v_and_b32 v46, 0x20000000, v33
    v_lshrrev_b32 v47, 14, v29
    v_bitop3_b32 v47, v47, v5, v46 bitop3:0xea
    ds_read_b64 v[102:103], v47
    v_bitop3_b32 v93, v29, v5, v46 bitop3:0xea
    v_and_b32 v46, 0x10000000, v33
    v_lshrrev_b32 v47, 14, v28
    v_bitop3_b32 v47, v47, v5, v46 bitop3:0xea
    ds_read_b64 v[100:101], v47
    v_bitop3_b32 v92, v28, v5, v46 bitop3:0xea
    s_waitcnt lgkmcnt(2)
    v_mfma_f32_4x4x4_16b_bf16 v[80:83], v[10:11], v[70:71], v[80:83]
    v_mfma_f32_4x4x4_16b_bf16 v[76:79], v[10:11], v[68:69], v[76:79]
    v_perm_b32 v15, v29, v32, s45
    v_bitop3_b32 v46, v29, 0.5, -0.5 bitop3:0xa8
    v_perm_b32 v14, v28, v32, s44
    v_bitop3_b32 v47, v28, 0.5, -0.5 bitop3:0xa8
    v_cvt_pk_bf16_f32 v80, v80, v81
    v_cvt_pk_bf16_f32 v81, v82, v83
    ds_wrxchg_rtn_b64 v[74:75], v95, v[80:81] offset:65408
    v_cvt_pk_bf16_f32 v76, v76, v77
    v_cvt_pk_bf16_f32 v77, v78, v79
    ds_wrxchg_rtn_b64 v[72:73], v94, v[76:77] offset:65408
    s_waitcnt lgkmcnt(2)
    v_mfma_f32_4x4x4_16b_bf16 v[80:83], v[8:9], v[102:103], 0
    v_mfma_f32_4x4x4_16b_bf16 v[76:79], v[8:9], v[100:101], 0
    v_bitop3_b32 v15, v6, v15, v46 bitop3:0xca
    v_bitop3_b32 v14, v6, v14, v47 bitop3:0xca
    v_cmp_lt_u32 s[84:85], v5, v92
    s_nop 0
    v_pk_mul_f32 v[80:81], v[80:81], v[14:15] op_sel:[0,1] op_sel_hi:[1,1]
    v_pk_mul_f32 v[82:83], v[82:83], v[14:15] op_sel:[0,1] op_sel_hi:[1,1]
    v_pk_mul_f32 v[76:77], v[76:77], v[14:15] op_sel:[0,0] op_sel_hi:[1,0]
    v_pk_mul_f32 v[78:79], v[78:79], v[14:15] op_sel:[0,0] op_sel_hi:[1,0]
    v_and_b32 v47, 0x0fffffff, v40
    v_mov_b32 v21, v40
    buffer_load_dwordx2 v[16:17], v47, s[8:11], 0 offen
    buffer_load_dwordx3 v[18:20], v47, s[8:11], 0 offen offset:8
    s_waitcnt lgkmcnt(0)
    v_cmpx_ne_u64 vcc, v[74:75], v[70:71]
    s_and_b64 s[82:83], vcc, s[80:81]
    s_cbranch_scc1 L2_c14
L2_d14:
    v_mov_b64 v[84:85], v[70:71]
    v_mov_b32 v7, v95
    v_mov_b64 v[86:87], v[74:75]
    s_mov_b64 exec, -1
    s_or_b64 s[80:81], s[80:81], vcc
    v_cmpx_ne_u64 vcc, v[72:73], v[68:69]
    s_and_b64 s[82:83], vcc, s[80:81]
    s_cbranch_scc1 L2_c15
L2_d15:
    v_mov_b64 v[84:85], v[68:69]
    v_mov_b32 v7, v94
    v_mov_b64 v[86:87], v[72:73]
    s_mov_b64 exec, -1
    s_or_b64 s[80:81], s[80:81], vcc
    ds_read_b64 v[70:71], v93 offset:65408
    s_and_b64 exec, s[84:85], s[80:81]
    v_mfma_f32_4x4x4_16b_bf16 v[76:79], v[12:13], v[84:85], 0
    v_mov_b32 v92, v7
    s_andn2_b64 s[80:81], s[80:81], s[84:85]
    v_mfma_f32_4x4x4_16b_bf16 v[76:79], v[10:11], v[86:87], v[76:79]
    s_mov_b64 exec, -1
    ds_read_b64 v[68:69], v92 offset:65408
    v_and_b32 v46, 0x80000000, v33
    v_lshrrev_b32 v47, 14, v31
    v_bitop3_b32 v47, v47, v5, v46 bitop3:0xea
    ds_read_b64 v[106:107], v47
    v_bitop3_b32 v95, v31, v5, v46 bitop3:0xea
    v_and_b32 v46, 0x40000000, v33
    v_lshrrev_b32 v47, 14, v30
    v_bitop3_b32 v47, v47, v5, v46 bitop3:0xea
    ds_read_b64 v[104:105], v47
    v_bitop3_b32 v94, v30, v5, v46 bitop3:0xea
    s_waitcnt lgkmcnt(2)
    v_mfma_f32_4x4x4_16b_bf16 v[80:83], v[10:11], v[70:71], v[80:83]
    v_mfma_f32_4x4x4_16b_bf16 v[76:79], v[10:11], v[68:69], v[76:79]
    v_perm_b32 v15, v31, v32, s47
    v_bitop3_b32 v46, v31, 0.5, -0.5 bitop3:0xa8
    v_perm_b32 v14, v30, v32, s46
    v_bitop3_b32 v47, v30, 0.5, -0.5 bitop3:0xa8
    v_cvt_pk_bf16_f32 v80, v80, v81
    v_cvt_pk_bf16_f32 v81, v82, v83
    ds_wrxchg_rtn_b64 v[74:75], v93, v[80:81] offset:65408
    v_cvt_pk_bf16_f32 v76, v76, v77
    v_cvt_pk_bf16_f32 v77, v78, v79
    ds_wrxchg_rtn_b64 v[72:73], v92, v[76:77] offset:65408
    s_setprio 0
    s_waitcnt lgkmcnt(2)
    v_mfma_f32_4x4x4_16b_bf16 v[80:83], v[8:9], v[106:107], 0
    v_mfma_f32_4x4x4_16b_bf16 v[76:79], v[8:9], v[104:105], 0
    v_bitop3_b32 v15, v6, v15, v46 bitop3:0xca
    v_bitop3_b32 v14, v6, v14, v47 bitop3:0xca
    s_nop 1
    v_pk_mul_f32 v[80:81], v[80:81], v[14:15] op_sel:[0,1] op_sel_hi:[1,1]
    v_pk_mul_f32 v[82:83], v[82:83], v[14:15] op_sel:[0,1] op_sel_hi:[1,1]
    v_pk_mul_f32 v[76:77], v[76:77], v[14:15] op_sel:[0,0] op_sel_hi:[1,0]
    v_pk_mul_f32 v[78:79], v[78:79], v[14:15] op_sel:[0,0] op_sel_hi:[1,0]
    s_add_u32 s40, s40, 0x50000
    s_waitcnt lgkmcnt(0)
    v_cmpx_ne_u64 vcc, v[74:75], v[70:71]
    s_and_b64 s[82:83], vcc, s[80:81]
    s_cbranch_scc1 L2_c16
L2_d16:
    v_mov_b64 v[84:85], v[70:71]
    v_mov_b32 v7, v93
    v_mov_b64 v[86:87], v[74:75]
    s_mov_b64 exec, -1
    s_or_b64 s[80:81], s[80:81], vcc
    v_cmpx_ne_u64 vcc, v[72:73], v[68:69]
    s_and_b64 s[82:83], vcc, s[80:81]
    s_cbranch_scc1 L2_c17
L2_d17:
    v_mov_b64 v[84:85], v[68:69]
    v_mov_b32 v7, v92
    v_mov_b64 v[86:87], v[72:73]
    s_mov_b64 exec, -1
    s_or_b64 s[80:81], s[80:81], vcc
    ds_read_b64 v[70:71], v95 offset:65408
    ds_read_b64 v[68:69], v94 offset:65408
    s_waitcnt vmcnt(5)
    v_and_b32 v46, 0x20000000, v39
    v_lshrrev_b32 v47, 14, v35
    v_bitop3_b32 v47, v47, v5, v46 bitop3:0xea
    ds_read_b64 v[102:103], v47
    v_bitop3_b32 v93, v35, v5, v46 bitop3:0xea
    v_and_b32 v46, 0x10000000, v39
    v_lshrrev_b32 v47, 14, v34
    v_bitop3_b32 v47, v47, v5, v46 bitop3:0xea
    ds_read_b64 v[100:101], v47
    v_bitop3_b32 v92, v34, v5, v46 bitop3:0xea
    v_and_b32 v46, 0x80000000, v39
    v_lshrrev_b32 v47, 14, v37
    v_bitop3_b32 v47, v47, v5, v46 bitop3:0xea
    ds_read_b64 v[106:107], v47
    v_and_b32 v46, 0x40000000, v39
    v_lshrrev_b32 v47, 14, v36
    v_bitop3_b32 v47, v47, v5, v46 bitop3:0xea
    ds_read_b64 v[104:105], v47
    s_waitcnt lgkmcnt(4)
    v_mfma_f32_4x4x4_16b_bf16 v[80:83], v[10:11], v[70:71], v[80:83]
    v_mfma_f32_4x4x4_16b_bf16 v[76:79], v[10:11], v[68:69], v[76:79]
    v_perm_b32 v15, v35, v38, s45
    v_bitop3_b32 v46, v35, 0.5, -0.5 bitop3:0xa8
    v_perm_b32 v14, v34, v38, s44
    v_bitop3_b32 v47, v34, 0.5, -0.5 bitop3:0xa8
    v_cvt_pk_bf16_f32 v80, v80, v81
    v_cvt_pk_bf16_f32 v81, v82, v83
    ds_wrxchg_rtn_b64 v[74:75], v95, v[80:81] offset:65408
    v_cvt_pk_bf16_f32 v76, v76, v77
    v_cvt_pk_bf16_f32 v77, v78, v79
    ds_wrxchg_rtn_b64 v[72:73], v94, v[76:77] offset:65408
    s_waitcnt lgkmcnt(2)
    s_barrier
    s_setprio 3
    s_mov_b32 m0, s69
    s_nop 0
    ds_write_addtid_b32 v116 offset:32768
    ds_write_addtid_b32 v117 offset:33024
    ds_write_addtid_b32 v118 offset:33280
    ds_write_addtid_b32 v119 offset:33536
    buffer_load_dwordx4 v[116:119], v3, s[16:19], s40 offen offset:2048
    s_waitcnt vmcnt(5)
    ds_write_addtid_b32 v120 offset:33792
    ds_write_addtid_b32 v121 offset:34048
    ds_write_addtid_b32 v122 offset:34304
    ds_write_addtid_b32 v123 offset:34560
    buffer_load_dwordx4 v[120:123], v3, s[16:19], s40 offen offset:3072
    v_mfma_f32_4x4x4_16b_bf16 v[80:83], v[8:9], v[102:103], 0
    v_mfma_f32_4x4x4_16b_bf16 v[76:79], v[8:9], v[100:101], 0
    v_bitop3_b32 v15, v6, v15, v46 bitop3:0xca
    v_bitop3_b32 v14, v6, v14, v47 bitop3:0xca
    v_cmp_lt_u32 s[84:85], v5, v92
    s_nop 0
    v_pk_mul_f32 v[80:81], v[80:81], v[14:15] op_sel:[0,1] op_sel_hi:[1,1]
    v_pk_mul_f32 v[82:83], v[82:83], v[14:15] op_sel:[0,1] op_sel_hi:[1,1]
    v_pk_mul_f32 v[76:77], v[76:77], v[14:15] op_sel:[0,0] op_sel_hi:[1,0]
    v_pk_mul_f32 v[78:79], v[78:79], v[14:15] op_sel:[0,0] op_sel_hi:[1,0]
    v_and_b32 v47, 0x0fffffff, v41
    v_mov_b32 v27, v41
    buffer_load_dwordx2 v[22:23], v47, s[8:11], 0 offen
    buffer_load_dwordx3 v[24:26], v47, s[8:11], 0 offen offset:8
    v_mov_b32 v33, v42
    v_mov_b32 v44, v43
    s_cmp_gt_u32 s37, 1024
    s_cbranch_scc1 L2_xs18
    s_cmp_lg_u32 s43, 0
    s_cbranch_scc1 L2_xa18
L2_xb18:
    v_lshlrev_b32 v89, 16, v96
    v_add_u32 v90, 60, v97
    v_bitop3_b32 v90, v89, v45, v90 bitop3:0x6a
    ds_write_b32 v98, v90 offset:12
    v_lshlrev_b32 v89, 20, v96
    v_add_u32 v90, 40, v97
    v_bitop3_b32 v90, v89, v45, v90 bitop3:0x6a
    ds_write_b32 v98, v90 offset:8
    v_lshlrev_b32 v89, 24, v96
    v_add_u32 v90, 20, v97
    v_bitop3_b32 v90, v89, v45, v90 bitop3:0x6a
    ds_write_b32 v98, v90 offset:4
    v_lshlrev_b32 v89, 28, v96
    v_bitop3_b32 v90, v89, v45, v97 bitop3:0x6a
    ds_write_b32 v98, v90 offset:0
    v_mov_b32_dpp v91, v64 quad_perm:[1,1,1,1] row_mask:0xf bank_mask:0xf
    v_and_b32 v89, 3, v91
    v_and_b32 v97, 0xfffc, v91
    v_sub_u16_dpp v88, v64, v91 quad_perm:[3,3,3,3] row_mask:0xf bank_mask:0xf
    v_mad_u32_u24 v97, v97, 5, v4
    v_add_u32 v99, v88, v89
    v_bfm_b32 v96, v88, v89
    v_cmp_lt_u32 s[58:59], 16, v99
    v_lshlrev_b32 v89, v1, v96
    v_and_b32 v89, v45, v89
    v_cmp_ne_u32 vcc, 0, v89
    v_xor_b32 v90, v97, v89
    s_add_u32 s3, s37, s38
    v_mbcnt_lo_u32_b32 v98, vcc_lo, 0
    v_mbcnt_hi_u32_b32 v98, vcc_hi, v98
    s_bcnt1_i32_b64 s41, vcc
    v_lshl_add_u32 v98, v98, 2, s3
    s_mov_b64 exec, vcc
    ds_write_b32 v98, v90
    s_mov_b64 exec, -1
    s_lshl2_add_u32 s37, s41, s37
    s_cmp_lg_u64 s[58:59], 0
    s_cbranch_scc1 L2_xe18
L2_xr18:
    v_add_u32 v98, s37, v0
    v_mov_b32 v90, -1
    ds_write_b32 v98, v90
    ds_read2st64_b32 v[40:41], v0 offset0:0 offset1:1
    ds_read2st64_b32 v[42:43], v0 offset0:2 offset1:3
    s_sub_u32 s3, s37, 768
    s_cmp_gt_u32 s3, 256
    s_cbranch_scc1 L2_xf18
L2_xg18:
    s_setprio 2
    ds_write_addtid_b32 v124 offset:34816
    ds_write_addtid_b32 v125 offset:35072
    ds_write_addtid_b32 v126 offset:35328
    ds_write_addtid_b32 v127 offset:35584
    s_add_u32 s3, s40, 4096
    buffer_load_dwordx4 v[124:127], v3, s[16:19], s3 offen
    s_waitcnt lgkmcnt(14)
    v_cmpx_ne_u64 vcc, v[74:75], v[70:71]
    s_and_b64 s[82:83], vcc, s[80:81]
    s_cbranch_scc1 L2_c19
L2_d19:
    v_mov_b64 v[84:85], v[70:71]
    v_mov_b32 v7, v95
    v_mov_b64 v[86:87], v[74:75]
    s_mov_b64 exec, -1
    s_or_b64 s[80:81], s[80:81], vcc
    v_cmpx_ne_u64 vcc, v[72:73], v[68:69]
    s_and_b64 s[82:83], vcc, s[80:81]
    s_cbranch_scc1 L2_c20
L2_d20:
    v_mov_b64 v[84:85], v[68:69]
    v_mov_b32 v7, v94
    v_mov_b64 v[86:87], v[72:73]
    s_mov_b64 exec, -1
    s_or_b64 s[80:81], s[80:81], vcc
    ds_read_b64 v[70:71], v93 offset:65408
    s_and_b64 exec, s[84:85], s[80:81]
    v_mfma_f32_4x4x4_16b_bf16 v[76:79], v[12:13], v[84:85], 0
    v_mov_b32 v92, v7
    s_andn2_b64 s[80:81], s[80:81], s[84:85]
    v_mfma_f32_4x4x4_16b_bf16 v[76:79], v[10:11], v[86:87], v[76:79]
    s_mov_b64 exec, -1
    ds_read_b64 v[68:69], v92 offset:65408
    s_setprio 1
    s_waitcnt vmcnt(8)
    s_mov_b32 m0, s38
    s_nop 0
    ds_write_addtid_b32 v108 offset:0
    ds_write_addtid_b32 v109 offset:256
    ds_write_addtid_b32 v110 offset:512
    ds_write_addtid_b32 v111 offset:768
    s_waitcnt lgkmcnt(4)
    v_mfma_f32_4x4x4_16b_bf16 v[80:83], v[10:11], v[70:71], v[80:83]
    v_mfma_f32_4x4x4_16b_bf16 v[76:79], v[10:11], v[68:69], v[76:79]
    v_and_b32 v46, 0x40000000, v39
    v_bitop3_b32 v94, v36, v5, v46 bitop3:0xea
    v_and_b32 v46, 0x80000000, v39
    v_bitop3_b32 v95, v37, v5, v46 bitop3:0xea
    v_perm_b32 v15, v37, v38, s47
    v_bitop3_b32 v46, v37, 0.5, -0.5 bitop3:0xa8
    v_perm_b32 v14, v36, v38, s46
    v_bitop3_b32 v47, v36, 0.5, -0.5 bitop3:0xa8
    v_cvt_pk_bf16_f32 v80, v80, v81
    v_cvt_pk_bf16_f32 v81, v82, v83
    ds_wrxchg_rtn_b64 v[74:75], v93, v[80:81] offset:65408
    v_cvt_pk_bf16_f32 v76, v76, v77
    v_cvt_pk_bf16_f32 v77, v78, v79
    ds_wrxchg_rtn_b64 v[72:73], v92, v[76:77] offset:65408
    s_setprio 0
    s_waitcnt vmcnt(7)
    ds_write_addtid_b32 v112 offset:1024
    ds_write_addtid_b32 v113 offset:1280
    ds_write_addtid_b32 v114 offset:1536
    ds_write_addtid_b32 v115 offset:1792
    v_mfma_f32_4x4x4_16b_bf16 v[80:83], v[8:9], v[106:107], 0
    v_mfma_f32_4x4x4_16b_bf16 v[76:79], v[8:9], v[104:105], 0
    v_bitop3_b32 v15, v6, v15, v46 bitop3:0xca
    v_bitop3_b32 v14, v6, v14, v47 bitop3:0xca
    s_nop 1
    v_pk_mul_f32 v[80:81], v[80:81], v[14:15] op_sel:[0,1] op_sel_hi:[1,1]
    v_pk_mul_f32 v[82:83], v[82:83], v[14:15] op_sel:[0,1] op_sel_hi:[1,1]
    v_pk_mul_f32 v[76:77], v[76:77], v[14:15] op_sel:[0,0] op_sel_hi:[1,0]
    v_pk_mul_f32 v[78:79], v[78:79], v[14:15] op_sel:[0,0] op_sel_hi:[1,0]
    s_add_u32 s42, s42, 1
    s_waitcnt lgkmcnt(0)
    s_barrier
    s_bitcmp1_b32 s36, s42
    s_cbranch_scc1 L2_slow
L2_ret1:
    s_setprio 3
    v_and_b32 v47, 0x0fffffff, v33
    buffer_load_dwordx2 v[28:29], v47, s[8:11], 0 offen
    buffer_load_dwordx3 v[30:32], v47, s[8:11], 0 offen offset:8
    v_cmpx_ne_u64 vcc, v[74:75], v[70:71]
    s_and_b64 s[82:83], vcc, s[80:81]
    s_cbranch_scc1 L2_c21
L2_d21:
    v_mov_b64 v[84:85], v[70:71]
    v_mov_b32 v7, v93
    v_mov_b64 v[86:87], v[74:75]
    s_mov_b64 exec, -1
    s_or_b64 s[80:81], s[80:81], vcc
    v_cmpx_ne_u64 vcc, v[72:73], v[68:69]
    s_and_b64 s[82:83], vcc, s[80:81]
    s_cbranch_scc1 L2_c22
L2_d22:
    v_mov_b64 v[84:85], v[68:69]
    v_mov_b32 v7, v92
    v_mov_b64 v[86:87], v[72:73]
    s_mov_b64 exec, -1
    s_or_b64 s[80:81], s[80:81], vcc
    ds_read_b64 v[70:71], v95 offset:65408
    ds_read_b64 v[68:69], v94 offset:65408
    s_waitcnt vmcnt(7)
    v_and_b32 v46, 0x20000000, v21
    v_lshrrev_b32 v47, 14, v17
    v_bitop3_b32 v47, v47, v5, v46 bitop3:0xea
    ds_read_b64 v[102:103], v47
    v_bitop3_b32 v93, v17, v5, v46 bitop3:0xea
    v_and_b32 v46, 0x10000000, v21
    v_lshrrev_b32 v47, 14, v16
    v_bitop3_b32 v47, v47, v5, v46 bitop3:0xea
    ds_read_b64 v[100:101], v47
    v_bitop3_b32 v92, v16, v5, v46 bitop3:0xea
    s_waitcnt lgkmcnt(2)
    v_mfma_f32_4x4x4_16b_bf16 v[80:83], v[10:11], v[70:71], v[80:83]
    v_mfma_f32_4x4x4_16b_bf16 v[76:79], v[10:11], v[68:69], v[76:79]
    v_perm_b32 v15, v17, v20, s45
    v_bitop3_b32 v46, v17, 0.5, -0.5 bitop3:0xa8
    v_perm_b32 v14, v16, v20, s44
    v_bitop3_b32 v47, v16, 0.5, -0.5 bitop3:0xa8
    v_cvt_pk_bf16_f32 v80, v80, v81
    v_cvt_pk_bf16_f32 v81, v82, v83
    ds_wrxchg_rtn_b64 v[74:75], v95, v[80:81] offset:65408
    v_cvt_pk_bf16_f32 v76, v76, v77
    v_cvt_pk_bf16_f32 v77, v78, v79
    ds_wrxchg_rtn_b64 v[72:73], v94, v[76:77] offset:65408
    s_waitcnt lgkmcnt(2)
    v_mfma_f32_4x4x4_16b_bf16 v[80:83], v[8:9], v[102:103], 0
    v_mfma_f32_4x4x4_16b_bf16 v[76:79], v[8:9], v[100:101], 0
    v_bitop3_b32 v15, v6, v15, v46 bitop3:0xca
    v_bitop3_b32 v14, v6, v14, v47 bitop3:0xca
    v_cmp_lt_u32 s[84:85], v5, v92
    s_nop 0
    v_pk_mul_f32 v[80:81], v[80:81], v[14:15] op_sel:[0,1] op_sel_hi:[1,1]
    v_pk_mul_f32 v[82:83], v[82:83], v[14:15] op_sel:[0,1] op_sel_hi:[1,1]
    v_pk_mul_f32 v[76:77], v[76:77], v[14:15] op_sel:[0,0] op_sel_hi:[1,0]
    v_pk_mul_f32 v[78:79], v[78:79], v[14:15] op_sel:[0,0] op_sel_hi:[1,0]
    buffer_load_dwordx4 v[108:111], v3, s[16:19], s40 offen offset:0
    s_waitcnt lgkmcnt(0)
    v_cmpx_ne_u64 vcc, v[74:75], v[70:71]
    s_and_b64 s[82:83], vcc, s[80:81]
    s_cbranch_scc1 L2_c23
L2_d23:
    v_mov_b64 v[84:85], v[70:71]
    v_mov_b32 v7, v95
    v_mov_b64 v[86:87], v[74:75]
    s_mov_b64 exec, -1
    s_or_b64 s[80:81], s[80:81], vcc
    v_cmpx_ne_u64 vcc, v[72:73], v[68:69]
    s_and_b64 s[82:83], vcc, s[80:81]
    s_cbranch_scc1 L2_c24
L2_d24:
    v_mov_b64 v[84:85], v[68:69]
    v_mov_b32 v7, v94
    v_mov_b64 v[86:87], v[72:73]
    s_mov_b64 exec, -1
    s_or_b64 s[80:81], s[80:81], vcc
    ds_read_b64 v[70:71], v93 offset:65408
    s_and_b64 exec, s[84:85], s[80:81]
    v_mfma_f32_4x4x4_16b_bf16 v[76:79], v[12:13], v[84:85], 0
    v_mov_b32 v92, v7
    s_andn2_b64 s[80:81], s[80:81], s[84:85]
    v_mfma_f32_4x4x4_16b_bf16 v[76:79], v[10:11], v[86:87], v[76:79]
    s_mov_b64 exec, -1
    ds_read_b64 v[68:69], v92 offset:65408
    v_and_b32 v46, 0x80000000, v21
    v_lshrrev_b32 v47, 14, v19
    v_bitop3_b32 v47, v47, v5, v46 bitop3:0xea
    ds_read_b64 v[106:107], v47
    v_bitop3_b32 v95, v19, v5, v46 bitop3:0xea
    v_and_b32 v46, 0x40000000, v21
    v_lshrrev_b32 v47, 14, v18
    v_bitop3_b32 v47, v47, v5, v46 bitop3:0xea
    ds_read_b64 v[104:105], v47
    v_bitop3_b32 v94, v18, v5, v46 bitop3:0xea
    s_waitcnt lgkmcnt(2)
    v_mfma_f32_4x4x4_16b_bf16 v[80:83], v[10:11], v[70:71], v[80:83]
    v_mfma_f32_4x4x4_16b_bf16 v[76:79], v[10:11], v[68:69], v[76:79]
    v_perm_b32 v15, v19, v20, s47
    v_bitop3_b32 v46, v19, 0.5, -0.5 bitop3:0xa8
    v_perm_b32 v14, v18, v20, s46
    v_bitop3_b32 v47, v18, 0.5, -0.5 bitop3:0xa8
    v_cvt_pk_bf16_f32 v80, v80, v81
    v_cvt_pk_bf16_f32 v81, v82, v83
    ds_wrxchg_rtn_b64 v[74:75], v93, v[80:81] offset:65408
    v_cvt_pk_bf16_f32 v76, v76, v77
    v_cvt_pk_bf16_f32 v77, v78, v79
    ds_wrxchg_rtn_b64 v[72:73], v92, v[76:77] offset:65408
    s_setprio 2
    s_waitcnt lgkmcnt(2)
    v_mfma_f32_4x4x4_16b_bf16 v[80:83], v[8:9], v[106:107], 0
    v_mfma_f32_4x4x4_16b_bf16 v[76:79], v[8:9], v[104:105], 0
    v_bitop3_b32 v15, v6, v15, v46 bitop3:0xca
    v_bitop3_b32 v14, v6, v14, v47 bitop3:0xca
    s_nop 1
    v_pk_mul_f32 v[80:81], v[80:81], v[14:15] op_sel:[0,1] op_sel_hi:[1,1]
    v_pk_mul_f32 v[82:83], v[82:83], v[14:15] op_sel:[0,1] op_sel_hi:[1,1]
    v_pk_mul_f32 v[76:77], v[76:77], v[14:15] op_sel:[0,0] op_sel_hi:[1,0]
    v_pk_mul_f32 v[78:79], v[78:79], v[14:15] op_sel:[0,0] op_sel_hi:[1,0]
    v_and_b32 v47, 0x0fffffff, v44
    v_mov_b32 v39, v44
    buffer_load_dwordx2 v[34:35], v47, s[8:11], 0 offen
    buffer_load_dwordx3 v[36:38], v47, s[8:11], 0 offen offset:8
    s_waitcnt lgkmcnt(0)
    v_cmpx_ne_u64 vcc, v[74:75], v[70:71]
    s_and_b64 s[82:83], vcc, s[80:81]
    s_cbranch_scc1 L2_c25
L2_d25:
    v_mov_b64 v[84:85], v[70:71]
    v_mov_b32 v7, v93
    v_mov_b64 v[86:87], v[74:75]
    s_mov_b64 exec, -1
    s_or_b64 s[80:81], s[80:81], vcc
    v_cmpx_ne_u64 vcc, v[72:73], v[68:69]
    s_and_b64 s[82:83], vcc, s[80:81]
    s_cbranch_scc1 L2_c26
L2_d26:
    v_mov_b64 v[84:85], v[68:69]
    v_mov_b32 v7, v92
    v_mov_b64 v[86:87], v[72:73]
    s_mov_b64 exec, -1
    s_or_b64 s[80:81], s[80:81], vcc
    ds_read_b64 v[70:71], v95 offset:65408
    ds_read_b64 v[68:69], v94 offset:65408
    s_waitcnt vmcnt(6)
    v_and_b32 v46, 0x20000000, v27
    v_lshrrev_b32 v47, 14, v23
    v_bitop3_b32 v47, v47, v5, v46 bitop3:0xea
    ds_read_b64 v[102:103], v47
    v_bitop3_b32 v93, v23, v5, v46 bitop3:0xea
    v_and_b32 v46, 0x10000000, v27
    v_lshrrev_b32 v47, 14, v22
    v_bitop3_b32 v47, v47, v5, v46 bitop3:0xea
    ds_read_b64 v[100:101], v47
    v_bitop3_b32 v92, v22, v5, v46 bitop3:0xea
    s_waitcnt lgkmcnt(2)
    v_mfma_f32_4x4x4_16b_bf16 v[80:83], v[10:11], v[70:71], v[80:83]
    v_mfma_f32_4x4x4_16b_bf16 v[76:79], v[10:11], v[68:69], v[76:79]
    v_perm_b32 v15, v23, v26, s45
    v_bitop3_b32 v46, v23, 0.5, -0.5 bitop3:0xa8
    v_perm_b32 v14, v22, v26, s44
    v_bitop3_b32 v47, v22, 0.5, -0.5 bitop3:0xa8
    v_cvt_pk_bf16_f32 v80, v80, v81
    v_cvt_pk_bf16_f32 v81, v82, v83
    ds_wrxchg_rtn_b64 v[74:75], v95, v[80:81] offset:65408
    v_cvt_pk_bf16_f32 v76, v76, v77
    v_cvt_pk_bf16_f32 v77, v78, v79
    ds_wrxchg_rtn_b64 v[72:73], v94, v[76:77] offset:65408
    s_waitcnt lgkmcnt(2)
    v_mfma_f32_4x4x4_16b_bf16 v[80:83], v[8:9], v[102:103], 0
    v_mfma_f32_4x4x4_16b_bf16 v[76:79], v[8:9], v[100:101], 0
    v_bitop3_b32 v15, v6, v15, v46 bitop3:0xca
    v_bitop3_b32 v14, v6, v14, v47 bitop3:0xca
    v_cmp_lt_u32 s[84:85], v5, v92
    s_nop 0
    v_pk_mul_f32 v[80:81], v[80:81], v[14:15] op_sel:[0,1] op_sel_hi:[1,1]
    v_pk_mul_f32 v[82:83], v[82:83], v[14:15] op_sel:[0,1] op_sel_hi:[1,1]
    v_pk_mul_f32 v[76:77], v[76:77], v[14:15] op_sel:[0,0] op_sel_hi:[1,0]
    v_pk_mul_f32 v[78:79], v[78:79], v[14:15] op_sel:[0,0] op_sel_hi:[1,0]
    v_sub_u16 v88, v62, v54
    v_and_b32 v89, 3, v54
    v_add3_u32 v99, v88, v89, 3
    v_and_b32 v99, -4, v99
    v_max_u32 v99, 4, v99
    v_and_b32 v97, 0xfffc, v54
    v_bfm_b32 v96, v88, v89
    v_add_u32_dpp v91, v99, v99 row_shr:1 row_mask:0xf bank_mask:0xf bound_ctrl:1
    v_mad_u32_u24 v97, v97, 5, v2
    v_cmp_lt_u32 vcc, 16, v99
    v_add_u32_dpp v91, v91, v91 row_shr:2 row_mask:0xf bank_mask:0xf bound_ctrl:1
    v_sub_u32 v98, s38, v99
    v_lshrrev_b64 v[54:55], 16, v[54:55]
    v_add_u32_dpp v91, v91, v91 row_shr:4 row_mask:0xf bank_mask:0xf bound_ctrl:1
    v_lshrrev_b64 v[62:63], 16, v[62:63]
    s_mov_b32 s43, 0
    v_add_u32_dpp v91, v91, v91 row_shr:8 row_mask:0xf bank_mask:0xf bound_ctrl:1
    s_nop 1
    v_add_u32_dpp v91, v91, v91 row_bcast:15 row_mask:0xa bank_mask:0xf
    s_nop 1
    v_add_u32_dpp v91, v91, v91 row_bcast:31 row_mask:0xc bank_mask:0xf
    v_add_u32 v98, v98, v91
    v_readlane_b32 s37, v91, 63
    s_cbranch_vccnz L2_xo27
L2_xp27:
    buffer_load_dwordx4 v[112:115], v3, s[16:19], s40 offen offset:1024
    v_and_b32 v47, 0x0fffffff, v40
    v_mov_b32 v21, v40
    buffer_load_dwordx2 v[16:17], v47, s[8:11], 0 offen
    buffer_load_dwordx3 v[18:20], v47, s[8:11], 0 offen offset:8
    s_waitcnt lgkmcnt(0)
    v_cmpx_ne_u64 vcc, v[74:75], v[70:71]
    s_and_b64 s[82:83], vcc, s[80:81]
    s_cbranch_scc1 L2_c28
L2_d28:
    v_mov_b64 v[84:85], v[70:71]
    v_mov_b32 v7, v95
    v_mov_b64 v[86:87], v[74:75]
    s_mov_b64 exec, -1
    s_or_b64 s[80:81], s[80:81], vcc
    v_cmpx_ne_u64 vcc, v[72:73], v[68:69]
    s_and_b64 s[82:83], vcc, s[80:81]
    s_cbranch_scc1 L2_c29
L2_d29:
    v_mov_b64 v[84:85], v[68:69]
    v_mov_b32 v7, v94
    v_mov_b64 v[86:87], v[72:73]
    s_mov_b64 exec, -1
    s_or_b64 s[80:81], s[80:81], vcc
    ds_read_b64 v[70:71], v93 offset:65408
    s_and_b64 exec, s[84:85], s[80:81]
    v_mfma_f32_4x4x4_16b_bf16 v[76:79], v[12:13], v[84:85], 0
    v_mov_b32 v92, v7
    s_andn2_b64 s[80:81], s[80:81], s[84:85]
    v_mfma_f32_4x4x4_16b_bf16 v[76:79], v[10:11], v[86:87], v[76:79]
    s_mov_b64 exec, -1
    ds_read_b64 v[68:69], v92 offset:65408
    v_and_b32 v46, 0x80000000, v27
    v_lshrrev_b32 v47, 14, v25
    v_bitop3_b32 v47, v47, v5, v46 bitop3:0xea
    ds_read_b64 v[106:107], v47
    v_bitop3_b32 v95, v25, v5, v46 bitop3:0xea
    v_and_b32 v46, 0x40000000, v27
    v_lshrrev_b32 v47, 14, v24
    v_bitop3_b32 v47, v47, v5, v46 bitop3:0xea
    ds_read_b64 v[104:105], v47
    v_bitop3_b32 v94, v24, v5, v46 bitop3:0xea
    s_waitcnt lgkmcnt(2)
    v_mfma_f32_4x4x4_16b_bf16 v[80:83], v[10:11], v[70:71], v[80:83]
    v_mfma_f32_4x4x4_16b_bf16 v[76:79], v[10:11], v[68:69], v[76:79]
    v_perm_b32 v15, v25, v26, s47
    v_bitop3_b32 v46, v25, 0.5, -0.5 bitop3:0xa8
    v_perm_b32 v14, v24, v26, s46
    v_bitop3_b32 v47, v24, 0.5, -0.5 bitop3:0xa8
    v_cvt_pk_bf16_f32 v80, v80, v81
    v_cvt_pk_bf16_f32 v81, v82, v83
    ds_wrxchg_rtn_b64 v[74:75], v93, v[80:81] offset:65408
    v_cvt_pk_bf16_f32 v76, v76, v77
    v_cvt_pk_bf16_f32 v77, v78, v79
    ds_wrxchg_rtn_b64 v[72:73], v92, v[76:77] offset:65408
    s_setprio 1
    s_waitcnt lgkmcnt(2)
    v_mfma_f32_4x4x4_16b_bf16 v[80:83], v[8:9], v[106:107], 0
    v_mfma_f32_4x4x4_16b_bf16 v[76:79], v[8:9], v[104:105], 0
    v_bitop3_b32 v15, v6, v15, v46 bitop3:0xca
    v_bitop3_b32 v14, v6, v14, v47 bitop3:0xca
    s_nop 1
    v_pk_mul_f32 v[80:81], v[80:81], v[14:15] op_sel:[0,1] op_sel_hi:[1,1]
    v_pk_mul_f32 v[82:83], v[82:83], v[14:15] op_sel:[0,1] op_sel_hi:[1,1]
    v_pk_mul_f32 v[76:77], v[76:77], v[14:15] op_sel:[0,0] op_sel_hi:[1,0]
    v_pk_mul_f32 v[78:79], v[78:79], v[14:15] op_sel:[0,0] op_sel_hi:[1,0]
    s_waitcnt lgkmcnt(0)
    v_cmpx_ne_u64 vcc, v[74:75], v[70:71]
    s_and_b64 s[82:83], vcc, s[80:81]
    s_cbranch_scc1 L2_c30
L2_d30:
    v_mov_b64 v[84:85], v[70:71]
    v_mov_b32 v7, v93
    v_mov_b64 v[86:87], v[74:75]
    s_mov_b64 exec, -1
    s_or_b64 s[80:81], s[80:81], vcc
    v_cmpx_ne_u64 vcc, v[72:73], v[68:69]
    s_and_b64 s[82:83], vcc, s[80:81]
    s_cbranch_scc1 L2_c31
L2_d31:
    v_mov_b64 v[84:85], v[68:69]
    v_mov_b32 v7, v92
    v_mov_b64 v[86:87], v[72:73]
    s_mov_b64 exec, -1
    s_or_b64 s[80:81], s[80:81], vcc
    ds_read_b64 v[70:71], v95 offset:65408
    ds_read_b64 v[68:69], v94 offset:65408
    s_waitcnt vmcnt(6)
    v_and_b32 v46, 0x20000000, v33
    v_lshrrev_b32 v47, 14, v29
    v_bitop3_b32 v47, v47, v5, v46 bitop3:0xea
    ds_read_b64 v[102:103], v47
    v_bitop3_b32 v93, v29, v5, v46 bitop3:0xea
    v_and_b32 v46, 0x10000000, v33
    v_lshrrev_b32 v47, 14, v28
    v_bitop3_b32 v47, v47, v5, v46 bitop3:0xea
    ds_read_b64 v[100:101], v47
    v_bitop3_b32 v92, v28, v5, v46 bitop3:0xea
    s_waitcnt lgkmcnt(2)
    v_mfma_f32_4x4x4_16b_bf16 v[80:83], v[10:11], v[70:71], v[80:83]
    v_mfma_f32_4x4x4_16b_bf16 v[76:79], v[10:11], v[68:69], v[76:79]
    v_perm_b32 v15, v29, v32, s45
    v_bitop3_b32 v46, v29, 0.5, -0.5 bitop3:0xa8
    v_perm_b32 v14, v28, v32, s44
    v_bitop3_b32 v47, v28, 0.5, -0.5 bitop3:0xa8
    v_cvt_pk_bf16_f32 v80, v80, v81
    v_cvt_pk_bf16_f32 v81, v82, v83
    ds_wrxchg_rtn_b64 v[74:75], v95, v[80:81] offset:65408
    v_cvt_pk_bf16_f32 v76, v76, v77
    v_cvt_pk_bf16_f32 v77, v78, v79
    ds_wrxchg_rtn_b64 v[72:73], v94, v[76:77] offset:65408
    s_waitcnt lgkmcnt(2)
    v_mfma_f32_4x4x4_16b_bf16 v[80:83], v[8:9], v[102:103], 0
    v_mfma_f32_4x4x4_16b_bf16 v[76:79], v[8:9], v[100:101], 0
    v_bitop3_b32 v15, v6, v15, v46 bitop3:0xca
    v_bitop3_b32 v14, v6, v14, v47 bitop3:0xca
    v_cmp_lt_u32 s[84:85], v5, v92
    s_nop 0
    v_pk_mul_f32 v[80:81], v[80:81], v[14:15] op_sel:[0,1] op_sel_hi:[1,1]
    v_pk_mul_f32 v[82:83], v[82:83], v[14:15] op_sel:[0,1] op_sel_hi:[1,1]
    v_pk_mul_f32 v[76:77], v[76:77], v[14:15] op_sel:[0,0] op_sel_hi:[1,0]
    v_pk_mul_f32 v[78:79], v[78:79], v[14:15] op_sel:[0,0] op_sel_hi:[1,0]
    v_and_b32 v47, 0x0fffffff, v41
    v_mov_b32 v27, v41
    buffer_load_dwordx2 v[22:23], v47, s[8:11], 0 offen
    buffer_load_dwordx3 v[24:26], v47, s[8:11], 0 offen offset:8
    s_waitcnt lgkmcnt(0)
    v_cmpx_ne_u64 vcc, v[74:75], v[70:71]
    s_and_b64 s[82:83], vcc, s[80:81]
    s_cbranch_scc1 L2_c32
L2_d32:
    v_mov_b64 v[84:85], v[70:71]
    v_mov_b32 v7, v95
    v_mov_b64 v[86:87], v[74:75]
    s_mov_b64 exec, -1
    s_or_b64 s[80:81], s[80:81], vcc
    v_cmpx_ne_u64 vcc, v[72:73], v[68:69]
    s_and_b64 s[82:83], vcc, s[80:81]
    s_cbranch_scc1 L2_c33
L2_d33:
    v_mov_b64 v[84:85], v[68:69]
    v_mov_b32 v7, v94
    v_mov_b64 v[86:87], v[72:73]
    s_mov_b64 exec, -1
    s_or_b64 s[80:81], s[80:81], vcc
    ds_read_b64 v[70:71], v93 offset:65408
    s_and_b64 exec, s[84:85], s[80:81]
    v_mfma_f32_4x4x4_16b_bf16 v[76:79], v[12:13], v[84:85], 0
    v_mov_b32 v92, v7
    s_andn2_b64 s[80:81], s[80:81], s[84:85]
    v_mfma_f32_4x4x4_16b_bf16 v[76:79], v[10:11], v[86:87], v[76:79]
    s_mov_b64 exec, -1
    ds_read_b64 v[68:69], v92 offset:65408
    v_and_b32 v46, 0x80000000, v33
    v_lshrrev_b32 v47, 14, v31
    v_bitop3_b32 v47, v47, v5, v46 bitop3:0xea
    ds_read_b64 v[106:107], v47
    v_bitop3_b32 v95, v31, v5, v46 bitop3:0xea
    v_and_b32 v46, 0x40000000, v33
    v_lshrrev_b32 v47, 14, v30
    v_bitop3_b32 v47, v47, v5, v46 bitop3:0xea
    ds_read_b64 v[104:105], v47
    v_bitop3_b32 v94, v30, v5, v46 bitop3:0xea
    s_waitcnt lgkmcnt(2)
    v_mfma_f32_4x4x4_16b_bf16 v[80:83], v[10:11], v[70:71], v[80:83]
    v_mfma_f32_4x4x4_16b_bf16 v[76:79], v[10:11], v[68:69], v[76:79]
    v_perm_b32 v15, v31, v32, s47
    v_bitop3_b32 v46, v31, 0.5, -0.5 bitop3:0xa8
    v_perm_b32 v14, v30, v32, s46
    v_bitop3_b32 v47, v30, 0.5, -0.5 bitop3:0xa8
    v_cvt_pk_bf16_f32 v80, v80, v81
    v_cvt_pk_bf16_f32 v81, v82, v83
    ds_wrxchg_rtn_b64 v[74:75], v93, v[80:81] offset:65408
    v_cvt_pk_bf16_f32 v76, v76, v77
    v_cvt_pk_bf16_f32 v77, v78, v79
    ds_wrxchg_rtn_b64 v[72:73], v92, v[76:77] offset:65408
    s_setprio 0
    s_waitcnt lgkmcnt(2)
    v_mfma_f32_4x4x4_16b_bf16 v[80:83], v[8:9], v[106:107], 0
    v_mfma_f32_4x4x4_16b_bf16 v[76:79], v[8:9], v[104:105], 0
    v_bitop3_b32 v15, v6, v15, v46 bitop3:0xca
    v_bitop3_b32 v14, v6, v14, v47 bitop3:0xca
    s_nop 1
    v_pk_mul_f32 v[80:81], v[80:81], v[14:15] op_sel:[0,1] op_sel_hi:[1,1]
    v_pk_mul_f32 v[82:83], v[82:83], v[14:15] op_sel:[0,1] op_sel_hi:[1,1]
    v_pk_mul_f32 v[76:77], v[76:77], v[14:15] op_sel:[0,0] op_sel_hi:[1,0]
    v_pk_mul_f32 v[78:79], v[78:79], v[14:15] op_sel:[0,0] op_sel_hi:[1,0]
    s_add_u32 s40, s40, 0x50000
    s_waitcnt lgkmcnt(0)
    v_cmpx_ne_u64 vcc, v[74:75], v[70:71]
    s_and_b64 s[82:83], vcc, s[80:81]
    s_cbranch_scc1 L2_c34
L2_d34:
    v_mov_b64 v[84:85], v[70:71]
    v_mov_b32 v7, v93
    v_mov_b64 v[86:87], v[74:75]
    s_mov_b64 exec, -1
    s_or_b64 s[80:81], s[80:81], vcc
    v_cmpx_ne_u64 vcc, v[72:73], v[68:69]
    s_and_b64 s[82:83], vcc, s[80:81]
    s_cbranch_scc1 L2_c35
L2_d35:
    v_mov_b64 v[84:85], v[68:69]
    v_mov_b32 v7, v92
    v_mov_b64 v[86:87], v[72:73]
    s_mov_b64 exec, -1
    s_or_b64 s[80:81], s[80:81], vcc
    ds_read_b64 v[70:71], v95 offset:65408
    ds_read_b64 v[68:69], v94 offset:65408
    s_waitcnt vmcnt(5)
    v_and_b32 v46, 0x20000000, v39
    v_lshrrev_b32 v47, 14, v35
    v_bitop3_b32 v47, v47, v5, v46 bitop3:0xea
    ds_read_b64 v[102:103], v47
    v_bitop3_b32 v93, v35, v5, v46 bitop3:0xea
    v_and_b32 v46, 0x10000000, v39
    v_lshrrev_b32 v47, 14, v34
    v_bitop3_b32 v47, v47, v5, v46 bitop3:0xea
    ds_read_b64 v[100:101], v47
    v_bitop3_b32 v92, v34, v5, v46 bitop3:0xea
    v_and_b32 v46, 0x80000000, v39
    v_lshrrev_b32 v47, 14, v37
    v_bitop3_b32 v47, v47, v5, v46 bitop3:0xea
    ds_read_b64 v[106:107], v47
    v_and_b32 v46, 0x40000000, v39
    v_lshrrev_b32 v47, 14, v36
    v_bitop3_b32 v47, v47, v5, v46 bitop3:0xea
    ds_read_b64 v[104:105], v47
    s_waitcnt lgkmcnt(4)
    v_mfma_f32_4x4x4_16b_bf16 v[80:83], v[10:11], v[70:71], v[80:83]
    v_mfma_f32_4x4x4_16b_bf16 v[76:79], v[10:11], v[68:69], v[76:79]
    v_perm_b32 v15, v35, v38, s45
    v_bitop3_b32 v46, v35, 0.5, -0.5 bitop3:0xa8
    v_perm_b32 v14, v34, v38, s44
    v_bitop3_b32 v47, v34, 0.5, -0.5 bitop3:0xa8
    v_cvt_pk_bf16_f32 v80, v80, v81
    v_cvt_pk_bf16_f32 v81, v82, v83
    ds_wrxchg_rtn_b64 v[74:75], v95, v[80:81] offset:65408
    v_cvt_pk_bf16_f32 v76, v76, v77
    v_cvt_pk_bf16_f32 v77, v78, v79
    ds_wrxchg_rtn_b64 v[72:73], v94, v[76:77] offset:65408
    s_waitcnt lgkmcnt(2)
    s_barrier
    s_setprio 3
    s_mov_b32 m0, s69
    s_nop 0
    ds_write_addtid_b32 v116 offset:32768
    ds_write_addtid_b32 v117 offset:33024
    ds_write_addtid_b32 v118 offset:33280
    ds_write_addtid_b32 v119 offset:33536
    buffer_load_dwordx4 v[116:119], v3, s[16:19], s40 offen offset:2048
    ds_write_addtid_b32 v120 offset:33792
    ds_write_addtid_b32 v121 offset:34048
    ds_write_addtid_b32 v122 offset:34304
    ds_write_addtid_b32 v123 offset:34560
    buffer_load_dwordx4 v[120:123], v3, s[16:19], s40 offen offset:3072
    v_mfma_f32_4x4x4_16b_bf16 v[80:83], v[8:9], v[102:103], 0
    v_mfma_f32_4x4x4_16b_bf16 v[76:79], v[8:9], v[100:101], 0
    v_bitop3_b32 v15, v6, v15, v46 bitop3:0xca
    v_bitop3_b32 v14, v6, v14, v47 bitop3:0xca
    v_cmp_lt_u32 s[84:85], v5, v92
    s_nop 0
    v_pk_mul_f32 v[80:81], v[80:81], v[14:15] op_sel:[0,1] op_sel_hi:[1,1]
    v_pk_mul_f32 v[82:83], v[82:83], v[14:15] op_sel:[0,1] op_sel_hi:[1,1]
    v_pk_mul_f32 v[76:77], v[76:77], v[14:15] op_sel:[0,0] op_sel_hi:[1,0]
    v_pk_mul_f32 v[78:79], v[78:79], v[14:15] op_sel:[0,0] op_sel_hi:[1,0]
    v_and_b32 v47, 0x0fffffff, v42
    v_mov_b32 v33, v42
    buffer_load_dwordx2 v[28:29], v47, s[8:11], 0 offen
    buffer_load_dwordx3 v[30:32], v47, s[8:11], 0 offen offset:8
    v_mov_b32 v44, v43
    s_cmp_gt_u32 s37, 1024
    s_cbranch_scc1 L2_xs36
    s_cmp_lg_u32 s43, 0
    s_cbranch_scc1 L2_xa36
L2_xb36:
    v_lshlrev_b32 v89, 16, v96
    v_add_u32 v90, 60, v97
    v_bitop3_b32 v90, v89, v45, v90 bitop3:0x6a
    ds_write_b32 v98, v90 offset:12
    v_lshlrev_b32 v89, 20, v96
    v_add_u32 v90, 40, v97
    v_bitop3_b32 v90, v89, v45, v90 bitop3:0x6a
    ds_write_b32 v98, v90 offset:8
    v_lshlrev_b32 v89, 24, v96
    v_add_u32 v90, 20, v97
    v_bitop3_b32 v90, v89, v45, v90 bitop3:0x6a
    ds_write_b32 v98, v90 offset:4
    v_lshlrev_b32 v89, 28, v96
    v_bitop3_b32 v90, v89, v45, v97 bitop3:0x6a
    ds_write_b32 v98, v90 offset:0
    v_mov_b32_dpp v91, v66 quad_perm:[1,1,1,1] row_mask:0xf bank_mask:0xf
    v_and_b32 v89, 3, v91
    v_and_b32 v97, 0xfffc, v91
    v_sub_u16_dpp v88, v66, v91 quad_perm:[3,3,3,3] row_mask:0xf bank_mask:0xf
    v_mad_u32_u24 v97, v97, 5, v4
    v_add_u32 v99, v88, v89
    v_bfm_b32 v96, v88, v89
    v_cmp_lt_u32 s[58:59], 16, v99
    v_lshlrev_b32 v89, v1, v96
    v_and_b32 v89, v45, v89
    v_cmp_ne_u32 vcc, 0, v89
    v_xor_b32 v90, v97, v89
    s_add_u32 s3, s37, s38
    v_mbcnt_lo_u32_b32 v98, vcc_lo, 0
    v_mbcnt_hi_u32_b32 v98, vcc_hi, v98
    s_bcnt1_i32_b64 s41, vcc
    v_lshl_add_u32 v98, v98, 2, s3
    s_mov_b64 exec, vcc
    ds_write_b32 v98, v90
    s_mov_b64 exec, -1
    s_lshl2_add_u32 s37, s41, s37
    s_cmp_lg_u64 s[58:59], 0
    s_cbranch_scc1 L2_xe36
L2_xr36:
    v_add_u32 v98, s37, v0
    v_mov_b32 v90, -1
    ds_write_b32 v98, v90
    ds_read2st64_b32 v[40:41], v0 offset0:0 offset1:1
    ds_read2st64_b32 v[42:43], v0 offset0:2 offset1:3
    s_sub_u32 s3, s37, 768
    s_cmp_gt_u32 s3, 256
    s_cbranch_scc1 L2_xf36
L2_xg36:
    v_lshrrev_b64 v[64:65], 16, v[64:65]
    v_lshrrev_b64 v[66:67], 16, v[66:67]
    s_setprio 2
    ds_write_addtid_b32 v124 offset:34816
    ds_write_addtid_b32 v125 offset:35072
    ds_write_addtid_b32 v126 offset:35328
    ds_write_addtid_b32 v127 offset:35584
    s_add_u32 s3, s40, 4096
    buffer_load_dwordx4 v[124:127], v3, s[16:19], s3 offen
    s_waitcnt lgkmcnt(14)
    v_cmpx_ne_u64 vcc, v[74:75], v[70:71]
    s_and_b64 s[82:83], vcc, s[80:81]
    s_cbranch_scc1 L2_c37
L2_d37:
    v_mov_b64 v[84:85], v[70:71]
    v_mov_b32 v7, v95
    v_mov_b64 v[86:87], v[74:75]
    s_mov_b64 exec, -1
    s_or_b64 s[80:81], s[80:81], vcc
    v_cmpx_ne_u64 vcc, v[72:73], v[68:69]
    s_and_b64 s[82:83], vcc, s[80:81]
    s_cbranch_scc1 L2_c38
L2_d38:
    v_mov_b64 v[84:85], v[68:69]
    v_mov_b32 v7, v94
    v_mov_b64 v[86:87], v[72:73]
    s_mov_b64 exec, -1
    s_or_b64 s[80:81], s[80:81], vcc
    ds_read_b64 v[70:71], v93 offset:65408
    s_and_b64 exec, s[84:85], s[80:81]
    v_mfma_f32_4x4x4_16b_bf16 v[76:79], v[12:13], v[84:85], 0
    v_mov_b32 v92, v7
    s_andn2_b64 s[80:81], s[80:81], s[84:85]
    v_mfma_f32_4x4x4_16b_bf16 v[76:79], v[10:11], v[86:87], v[76:79]
    s_mov_b64 exec, -1
    ds_read_b64 v[68:69], v92 offset:65408
    s_setprio 1
    s_mov_b32 m0, s38
    s_nop 0
    ds_write_addtid_b32 v108 offset:0
    ds_write_addtid_b32 v109 offset:256
    ds_write_addtid_b32 v110 offset:512
    ds_write_addtid_b32 v111 offset:768
    s_waitcnt lgkmcnt(4)
    v_mfma_f32_4x4x4_16b_bf16 v[80:83], v[10:11], v[70:71], v[80:83]
    v_mfma_f32_4x4x4_16b_bf16 v[76:79], v[10:11], v[68:69], v[76:79]
    v_and_b32 v46, 0x40000000, v39
    v_bitop3_b32 v94, v36, v5, v46 bitop3:0xea
    v_and_b32 v46, 0x80000000, v39
    v_bitop3_b32 v95, v37, v5, v46 bitop3:0xea
    v_perm_b32 v15, v37, v38, s47
    v_bitop3_b32 v46, v37, 0.5, -0.5 bitop3:0xa8
    v_perm_b32 v14, v36, v38, s46
    v_bitop3_b32 v47, v36, 0.5, -0.5 bitop3:0xa8
    v_cvt_pk_bf16_f32 v80, v80, v81
    v_cvt_pk_bf16_f32 v81, v82, v83
    ds_wrxchg_rtn_b64 v[74:75], v93, v[80:81] offset:65408
    v_cvt_pk_bf16_f32 v76, v76, v77
    v_cvt_pk_bf16_f32 v77, v78, v79
    ds_wrxchg_rtn_b64 v[72:73], v92, v[76:77] offset:65408
    s_setprio 0
    s_waitcnt vmcnt(9)
    ds_write_addtid_b32 v112 offset:1024
    ds_write_addtid_b32 v113 offset:1280
    ds_write_addtid_b32 v114 offset:1536
    ds_write_addtid_b32 v115 offset:1792
    v_mfma_f32_4x4x4_16b_bf16 v[80:83], v[8:9], v[106:107], 0
    v_mfma_f32_4x4x4_16b_bf16 v[76:79], v[8:9], v[104:105], 0
    v_bitop3_b32 v15, v6, v15, v46 bitop3:0xca
    v_bitop3_b32 v14, v6, v14, v47 bitop3:0xca
    s_nop 1
    v_pk_mul_f32 v[80:81], v[80:81], v[14:15] op_sel:[0,1] op_sel_hi:[1,1]
    v_pk_mul_f32 v[82:83], v[82:83], v[14:15] op_sel:[0,1] op_sel_hi:[1,1]
    v_pk_mul_f32 v[76:77], v[76:77], v[14:15] op_sel:[0,0] op_sel_hi:[1,0]
    v_pk_mul_f32 v[78:79], v[78:79], v[14:15] op_sel:[0,0] op_sel_hi:[1,0]
    s_add_u32 s42, s42, 1
    s_waitcnt lgkmcnt(0)
L2_loop:
    s_barrier
    s_bitcmp1_b32 s36, s42
    s_cbranch_scc1 L2_slow
L2_ret2:
    s_setprio 3
    v_and_b32 v47, 0x0fffffff, v44
    v_mov_b32 v39, v44
    buffer_load_dwordx2 v[34:35], v47, s[8:11], 0 offen
    buffer_load_dwordx3 v[36:38], v47, s[8:11], 0 offen offset:8
    v_cmpx_ne_u64 vcc, v[74:75], v[70:71]
    s_and_b64 s[82:83], vcc, s[80:81]
    s_cbranch_scc1 L2_c39
L2_d39:
    v_mov_b64 v[84:85], v[70:71]
    v_mov_b32 v7, v93
    v_mov_b64 v[86:87], v[74:75]
    s_mov_b64 exec, -1
    s_or_b64 s[80:81], s[80:81], vcc
    v_cmpx_ne_u64 vcc, v[72:73], v[68:69]
    s_and_b64 s[82:83], vcc, s[80:81]
    s_cbranch_scc1 L2_c40
L2_d40:
    v_mov_b64 v[84:85], v[68:69]
    v_mov_b32 v7, v92
    v_mov_b64 v[86:87], v[72:73]
    s_mov_b64 exec, -1
    s_or_b64 s[80:81], s[80:81], vcc
    ds_read_b64 v[70:71], v95 offset:65408
    ds_read_b64 v[68:69], v94 offset:65408
    s_waitcnt vmcnt(9)
    v_and_b32 v46, 0x20000000, v21
    v_lshrrev_b32 v47, 14, v17
    v_bitop3_b32 v47, v47, v5, v46 bitop3:0xea
    ds_read_b64 v[102:103], v47
    v_bitop3_b32 v93, v17, v5, v46 bitop3:0xea
    v_and_b32 v46, 0x10000000, v21
    v_lshrrev_b32 v47, 14, v16
    v_bitop3_b32 v47, v47, v5, v46 bitop3:0xea
    ds_read_b64 v[100:101], v47
    v_bitop3_b32 v92, v16, v5, v46 bitop3:0xea
    s_waitcnt lgkmcnt(2)
    v_mfma_f32_4x4x4_16b_bf16 v[80:83], v[10:11], v[70:71], v[80:83]
    v_mfma_f32_4x4x4_16b_bf16 v[76:79], v[10:11], v[68:69], v[76:79]
    v_perm_b32 v15, v17, v20, s45
    v_bitop3_b32 v46, v17, 0.5, -0.5 bitop3:0xa8
    v_perm_b32 v14, v16, v20, s44
    v_bitop3_b32 v47, v16, 0.5, -0.5 bitop3:0xa8
    v_cvt_pk_bf16_f32 v80, v80, v81
    v_cvt_pk_bf16_f32 v81, v82, v83
    ds_wrxchg_rtn_b64 v[74:75], v95, v[80:81] offset:65408
    v_cvt_pk_bf16_f32 v76, v76, v77
    v_cvt_pk_bf16_f32 v77, v78, v79
    ds_wrxchg_rtn_b64 v[72:73], v94, v[76:77] offset:65408
    s_waitcnt lgkmcnt(2)
    v_mfma_f32_4x4x4_16b_bf16 v[80:83], v[8:9], v[102:103], 0
    v_mfma_f32_4x4x4_16b_bf16 v[76:79], v[8:9], v[100:101], 0
    v_bitop3_b32 v15, v6, v15, v46 bitop3:0xca
    v_bitop3_b32 v14, v6, v14, v47 bitop3:0xca
    v_cmp_lt_u32 s[84:85], v5, v92
    s_nop 0
    v_pk_mul_f32 v[80:81], v[80:81], v[14:15] op_sel:[0,1] op_sel_hi:[1,1]
    v_pk_mul_f32 v[82:83], v[82:83], v[14:15] op_sel:[0,1] op_sel_hi:[1,1]
    v_pk_mul_f32 v[76:77], v[76:77], v[14:15] op_sel:[0,0] op_sel_hi:[1,0]
    v_pk_mul_f32 v[78:79], v[78:79], v[14:15] op_sel:[0,0] op_sel_hi:[1,0]
    buffer_load_dwordx4 v[108:111], v3, s[16:19], s40 offen offset:0
    s_waitcnt lgkmcnt(0)
    v_cmpx_ne_u64 vcc, v[74:75], v[70:71]
    s_and_b64 s[82:83], vcc, s[80:81]
    s_cbranch_scc1 L2_c41
L2_d41:
    v_mov_b64 v[84:85], v[70:71]
    v_mov_b32 v7, v95
    v_mov_b64 v[86:87], v[74:75]
    s_mov_b64 exec, -1
    s_or_b64 s[80:81], s[80:81], vcc
    v_cmpx_ne_u64 vcc, v[72:73], v[68:69]
    s_and_b64 s[82:83], vcc, s[80:81]
    s_cbranch_scc1 L2_c42
L2_d42:
    v_mov_b64 v[84:85], v[68:69]
    v_mov_b32 v7, v94
    v_mov_b64 v[86:87], v[72:73]
    s_mov_b64 exec, -1
    s_or_b64 s[80:81], s[80:81], vcc
    ds_read_b64 v[70:71], v93 offset:65408
    s_and_b64 exec, s[84:85], s[80:81]
    v_mfma_f32_4x4x4_16b_bf16 v[76:79], v[12:13], v[84:85], 0
    v_mov_b32 v92, v7
    s_andn2_b64 s[80:81], s[80:81], s[84:85]
    v_mfma_f32_4x4x4_16b_bf16 v[76:79], v[10:11], v[86:87], v[76:79]
    s_mov_b64 exec, -1
    ds_read_b64 v[68:69], v92 offset:65408
    v_and_b32 v46, 0x80000000, v21
    v_lshrrev_b32 v47, 14, v19
    v_bitop3_b32 v47, v47, v5, v46 bitop3:0xea
    ds_read_b64 v[106:107], v47
    v_bitop3_b32 v95, v19, v5, v46 bitop3:0xea
    v_and_b32 v46, 0x40000000, v21
    v_lshrrev_b32 v47, 14, v18
    v_bitop3_b32 v47, v47, v5, v46 bitop3:0xea
    ds_read_b64 v[104:105], v47
    v_bitop3_b32 v94, v18, v5, v46 bitop3:0xea
    s_waitcnt lgkmcnt(2)
    v_mfma_f32_4x4x4_16b_bf16 v[80:83], v[10:11], v[70:71], v[80:83]
    v_mfma_f32_4x4x4_16b_bf16 v[76:79], v[10:11], v[68:69], v[76:79]
    v_perm_b32 v15, v19, v20, s47
    v_bitop3_b32 v46, v19, 0.5, -0.5 bitop3:0xa8
    v_perm_b32 v14, v18, v20, s46
    v_bitop3_b32 v47, v18, 0.5, -0.5 bitop3:0xa8
    v_cvt_pk_bf16_f32 v80, v80, v81
    v_cvt_pk_bf16_f32 v81, v82, v83
    ds_wrxchg_rtn_b64 v[74:75], v93, v[80:81] offset:65408
    v_cvt_pk_bf16_f32 v76, v76, v77
    v_cvt_pk_bf16_f32 v77, v78, v79
    ds_wrxchg_rtn_b64 v[72:73], v92, v[76:77] offset:65408
    s_setprio 2
    s_waitcnt lgkmcnt(2)
    v_mfma_f32_4x4x4_16b_bf16 v[80:83], v[8:9], v[106:107], 0
    v_mfma_f32_4x4x4_16b_bf16 v[76:79], v[8:9], v[104:105], 0
    v_bitop3_b32 v15, v6, v15, v46 bitop3:0xca
    v_bitop3_b32 v14, v6, v14, v47 bitop3:0xca
    s_nop 1
    v_pk_mul_f32 v[80:81], v[80:81], v[14:15] op_sel:[0,1] op_sel_hi:[1,1]
    v_pk_mul_f32 v[82:83], v[82:83], v[14:15] op_sel:[0,1] op_sel_hi:[1,1]
    v_pk_mul_f32 v[76:77], v[76:77], v[14:15] op_sel:[0,0] op_sel_hi:[1,0]
    v_pk_mul_f32 v[78:79], v[78:79], v[14:15] op_sel:[0,0] op_sel_hi:[1,0]
    v_and_b32 v47, 0x0fffffff, v40
    v_mov_b32 v21, v40
    buffer_load_dwordx2 v[16:17], v47, s[8:11], 0 offen
    buffer_load_dwordx3 v[18:20], v47, s[8:11], 0 offen offset:8
    s_waitcnt lgkmcnt(0)
    v_cmpx_ne_u64 vcc, v[74:75], v[70:71]
    s_and_b64 s[82:83], vcc, s[80:81]
    s_cbranch_scc1 L2_c43
L2_d43:
    v_mov_b64 v[84:85], v[70:71]
    v_mov_b32 v7, v93
    v_mov_b64 v[86:87], v[74:75]
    s_mov_b64 exec, -1
    s_or_b64 s[80:81], s[80:81], vcc
    v_cmpx_ne_u64 vcc, v[72:73], v[68:69]
    s_and_b64 s[82:83], vcc, s[80:81]
    s_cbranch_scc1 L2_c44
L2_d44:
    v_mov_b64 v[84:85], v[68:69]
    v_mov_b32 v7, v92
    v_mov_b64 v[86:87], v[72:73]
    s_mov_b64 exec, -1
    s_or_b64 s[80:81], s[80:81], vcc
    ds_read_b64 v[70:71], v95 offset:65408
    ds_read_b64 v[68:69], v94 offset:65408
    s_waitcnt vmcnt(10)
    v_and_b32 v46, 0x20000000, v27
    v_lshrrev_b32 v47, 14, v23
    v_bitop3_b32 v47, v47, v5, v46 bitop3:0xea
    ds_read_b64 v[102:103], v47
    v_bitop3_b32 v93, v23, v5, v46 bitop3:0xea
    v_and_b32 v46, 0x10000000, v27
    v_lshrrev_b32 v47, 14, v22
    v_bitop3_b32 v47, v47, v5, v46 bitop3:0xea
    ds_read_b64 v[100:101], v47
    v_bitop3_b32 v92, v22, v5, v46 bitop3:0xea
    s_waitcnt lgkmcnt(2)
    v_mfma_f32_4x4x4_16b_bf16 v[80:83], v[10:11], v[70:71], v[80:83]
    v_mfma_f32_4x4x4_16b_bf16 v[76:79], v[10:11], v[68:69], v[76:79]
    v_perm_b32 v15, v23, v26, s45
    v_bitop3_b32 v46, v23, 0.5, -0.5 bitop3:0xa8
    v_perm_b32 v14, v22, v26, s44
    v_bitop3_b32 v47, v22, 0.5, -0.5 bitop3:0xa8
    v_cvt_pk_bf16_f32 v80, v80, v81
    v_cvt_pk_bf16_f32 v81, v82, v83
    ds_wrxchg_rtn_b64 v[74:75], v95, v[80:81] offset:65408
    v_cvt_pk_bf16_f32 v76, v76, v77
    v_cvt_pk_bf16_f32 v77, v78, v79
    ds_wrxchg_rtn_b64 v[72:73], v94, v[76:77] offset:65408
    s_waitcnt lgkmcnt(2)
    v_mfma_f32_4x4x4_16b_bf16 v[80:83], v[8:9], v[102:103], 0
    v_mfma_f32_4x4x4_16b_bf16 v[76:79], v[8:9], v[100:101], 0
    v_bitop3_b32 v15, v6, v15, v46 bitop3:0xca
    v_bitop3_b32 v14, v6, v14, v47 bitop3:0xca
    v_cmp_lt_u32 s[84:85], v5, v92
    s_nop 0
    v_pk_mul_f32 v[80:81], v[80:81], v[14:15] op_sel:[0,1] op_sel_hi:[1,1]
    v_pk_mul_f32 v[82:83], v[82:83], v[14:15] op_sel:[0,1] op_sel_hi:[1,1]
    v_pk_mul_f32 v[76:77], v[76:77], v[14:15] op_sel:[0,0] op_sel_hi:[1,0]
    v_pk_mul_f32 v[78:79], v[78:79], v[14:15] op_sel:[0,0] op_sel_hi:[1,0]
    v_sub_u16 v88, v56, v48
    v_and_b32 v89, 3, v48
    v_add3_u32 v99, v88, v89, 3
    v_and_b32 v99, -4, v99
    v_max_u32 v99, 4, v99
    v_and_b32 v97, 0xfffc, v48
    v_bfm_b32 v96, v88, v89
    v_add_u32_dpp v91, v99, v99 row_shr:1 row_mask:0xf bank_mask:0xf bound_ctrl:1
    v_mad_u32_u24 v97, v97, 5, v2
    v_cmp_lt_u32 vcc, 16, v99
    v_add_u32_dpp v91, v91, v91 row_shr:2 row_mask:0xf bank_mask:0xf bound_ctrl:1
    v_sub_u32 v98, s38, v99
    v_lshrrev_b64 v[48:49], 16, v[48:49]
    v_add_u32_dpp v91, v91, v91 row_shr:4 row_mask:0xf bank_mask:0xf bound_ctrl:1
    v_lshrrev_b64 v[56:57], 16, v[56:57]
    s_mov_b32 s43, 0
    v_add_u32_dpp v91, v91, v91 row_shr:8 row_mask:0xf bank_mask:0xf bound_ctrl:1
    s_nop 1
    v_add_u32_dpp v91, v91, v91 row_bcast:15 row_mask:0xa bank_mask:0xf
    s_nop 1
    v_add_u32_dpp v91, v91, v91 row_bcast:31 row_mask:0xc bank_mask:0xf
    v_add_u32 v98, v98, v91
    v_readlane_b32 s37, v91, 63
    s_cbranch_vccnz L2_xo45
L2_xp45:
    buffer_load_dwordx4 v[112:115], v3, s[16:19], s40 offen offset:1024
    s_waitcnt lgkmcnt(0)
    v_cmpx_ne_u64 vcc, v[74:75], v[70:71]
    s_and_b64 s[82:83], vcc, s[80:81]
    s_cbranch_scc1 L2_c46
L2_d46:
    v_mov_b64 v[84:85], v[70:71]
    v_mov_b32 v7, v95
    v_mov_b64 v[86:87], v[74:75]
    s_mov_b64 exec, -1
    s_or_b64 s[80:81], s[80:81], vcc
    v_cmpx_ne_u64 vcc, v[72:73], v[68:69]
    s_and_b64 s[82:83], vcc, s[80:81]
    s_cbranch_scc1 L2_c47
L2_d47:
    v_mov_b64 v[84:85], v[68:69]
    v_mov_b32 v7, v94
    v_mov_b64 v[86:87], v[72:73]
    s_mov_b64 exec, -1
    s_or_b64 s[80:81], s[80:81], vcc
    ds_read_b64 v[70:71], v93 offset:65408
    s_and_b64 exec, s[84:85], s[80:81]
    v_mfma_f32_4x4x4_16b_bf16 v[76:79], v[12:13], v[84:85], 0
    v_mov_b32 v92, v7
    s_andn2_b64 s[80:81], s[80:81], s[84:85]
    v_mfma_f32_4x4x4_16b_bf16 v[76:79], v[10:11], v[86:87], v[76:79]
    s_mov_b64 exec, -1
    ds_read_b64 v[68:69], v92 offset:65408
    v_and_b32 v46, 0x80000000, v27
    v_lshrrev_b32 v47, 14, v25
    v_bitop3_b32 v47, v47, v5, v46 bitop3:0xea
    ds_read_b64 v[106:107], v47
    v_bitop3_b32 v95, v25, v5, v46 bitop3:0xea
    v_and_b32 v46, 0x40000000, v27
    v_lshrrev_b32 v47, 14, v24
    v_bitop3_b32 v47, v47, v5, v46 bitop3:0xea
    ds_read_b64 v[104:105], v47
    v_bitop3_b32 v94, v24, v5, v46 bitop3:0xea
    s_waitcnt lgkmcnt(2)
    v_mfma_f32_4x4x4_16b_bf16 v[80:83], v[10:11], v[70:71], v[80:83]
    v_mfma_f32_4x4x4_16b_bf16 v[76:79], v[10:11], v[68:69], v[76:79]
    v_perm_b32 v15, v25, v26, s47
    v_bitop3_b32 v46, v25, 0.5, -0.5 bitop3:0xa8
    v_perm_b32 v14, v24, v26, s46
    v_bitop3_b32 v47, v24, 0.5, -0.5 bitop3:0xa8
    v_cvt_pk_bf16_f32 v80, v80, v81
    v_cvt_pk_bf16_f32 v81, v82, v83
    ds_wrxchg_rtn_b64 v[74:75], v93, v[80:81] offset:65408
    v_cvt_pk_bf16_f32 v76, v76, v77
    v_cvt_pk_bf16_f32 v77, v78, v79
    ds_wrxchg_rtn_b64 v[72:73], v92, v[76:77] offset:65408
    s_setprio 1
    s_waitcnt lgkmcnt(2)
    v_mfma_f32_4x4x4_16b_bf16 v[80:83], v[8:9], v[106:107], 0
    v_mfma_f32_4x4x4_16b_bf16 v[76:79], v[8:9], v[104:105], 0
    v_bitop3_b32 v15, v6, v15, v46 bitop3:0xca
    v_bitop3_b32 v14, v6, v14, v47 bitop3:0xca
    s_nop 1
    v_pk_mul_f32 v[80:81], v[80:81], v[14:15] op_sel:[0,1] op_sel_hi:[1,1]
    v_pk_mul_f32 v[82:83], v[82:83], v[14:15] op_sel:[0,1] op_sel_hi:[1,1]
    v_pk_mul_f32 v[76:77], v[76:77], v[14:15] op_sel:[0,0] op_sel_hi:[1,0]
    v_pk_mul_f32 v[78:79], v[78:79], v[14:15] op_sel:[0,0] op_sel_hi:[1,0]
    v_and_b32 v47, 0x0fffffff, v41
    v_mov_b32 v27, v41
    buffer_load_dwordx2 v[22:23], v47, s[8:11], 0 offen
    buffer_load_dwordx3 v[24:26], v47, s[8:11], 0 offen offset:8
    s_waitcnt lgkmcnt(0)
    v_cmpx_ne_u64 vcc, v[74:75], v[70:71]
    s_and_b64 s[82:83], vcc, s[80:81]
    s_cbranch_scc1 L2_c48
L2_d48:
    v_mov_b64 v[84:85], v[70:71]
    v_mov_b32 v7, v93
    v_mov_b64 v[86:87], v[74:75]
    s_mov_b64 exec, -1
    s_or_b64 s[80:81], s[80:81], vcc
    v_cmpx_ne_u64 vcc, v[72:73], v[68:69]
    s_and_b64 s[82:83], vcc, s[80:81]
    s_cbranch_scc1 L2_c49
L2_d49:
    v_mov_b64 v[84:85], v[68:69]
    v_mov_b32 v7, v92
    v_mov_b64 v[86:87], v[72:73]
    s_mov_b64 exec, -1
    s_or_b64 s[80:81], s[80:81], vcc
    ds_read_b64 v[70:71], v95 offset:65408
    ds_read_b64 v[68:69], v94 offset:65408
    s_waitcnt vmcnt(9)
    v_and_b32 v46, 0x20000000, v33
    v_lshrrev_b32 v47, 14, v29
    v_bitop3_b32 v47, v47, v5, v46 bitop3:0xea
    ds_read_b64 v[102:103], v47
    v_bitop3_b32 v93, v29, v5, v46 bitop3:0xea
    v_and_b32 v46, 0x10000000, v33
    v_lshrrev_b32 v47, 14, v28
    v_bitop3_b32 v47, v47, v5, v46 bitop3:0xea
    ds_read_b64 v[100:101], v47
    v_bitop3_b32 v92, v28, v5, v46 bitop3:0xea
    s_waitcnt lgkmcnt(2)
    v_mfma_f32_4x4x4_16b_bf16 v[80:83], v[10:11], v[70:71], v[80:83]
    v_mfma_f32_4x4x4_16b_bf16 v[76:79], v[10:11], v[68:69], v[76:79]
    v_perm_b32 v15, v29, v32, s45
    v_bitop3_b32 v46, v29, 0.5, -0.5 bitop3:0xa8
    v_perm_b32 v14, v28, v32, s44
    v_bitop3_b32 v47, v28, 0.5, -0.5 bitop3:0xa8
    v_cvt_pk_bf16_f32 v80, v80, v81
    v_cvt_pk_bf16_f32 v81, v82, v83
    ds_wrxchg_rtn_b64 v[74:75], v95, v[80:81] offset:65408
    v_cvt_pk_bf16_f32 v76, v76, v77
    v_cvt_pk_bf16_f32 v77, v78, v79
    ds_wrxchg_rtn_b64 v[72:73], v94, v[76:77] offset:65408
    s_waitcnt lgkmcnt(2)
    v_mfma_f32_4x4x4_16b_bf16 v[80:83], v[8:9], v[102:103], 0
    v_mfma_f32_4x4x4_16b_bf16 v[76:79], v[8:9], v[100:101], 0
    v_bitop3_b32 v15, v6, v15, v46 bitop3:0xca
    v_bitop3_b32 v14, v6, v14, v47 bitop3:0xca
    v_cmp_lt_u32 s[84:85], v5, v92
    s_nop 0
    v_pk_mul_f32 v[80:81], v[80:81], v[14:15] op_sel:[0,1] op_sel_hi:[1,1]
    v_pk_mul_f32 v[82:83], v[82:83], v[14:15] op_sel:[0,1] op_sel_hi:[1,1]
    v_pk_mul_f32 v[76:77], v[76:77], v[14:15] op_sel:[0,0] op_sel_hi:[1,0]
    v_pk_mul_f32 v[78:79], v[78:79], v[14:15] op_sel:[0,0] op_sel_hi:[1,0]
    s_waitcnt lgkmcnt(0)
    v_cmpx_ne_u64 vcc, v[74:75], v[70:71]
    s_and_b64 s[82:83], vcc, s[80:81]
    s_cbranch_scc1 L2_c50
L2_d50:
    v_mov_b64 v[84:85], v[70:71]
    v_mov_b32 v7, v95
    v_mov_b64 v[86:87], v[74:75]
    s_mov_b64 exec, -1
    s_or_b64 s[80:81], s[80:81], vcc
    v_cmpx_ne_u64 vcc, v[72:73], v[68:69]
    s_and_b64 s[82:83], vcc, s[80:81]
    s_cbranch_scc1 L2_c51
L2_d51:
    v_mov_b64 v[84:85], v[68:69]
    v_mov_b32 v7, v94
    v_mov_b64 v[86:87], v[72:73]
    s_mov_b64 exec, -1
    s_or_b64 s[80:81], s[80:81], vcc
    ds_read_b64 v[70:71], v93 offset:65408
    s_and_b64 exec, s[84:85], s[80:81]
    v_mfma_f32_4x4x4_16b_bf16 v[76:79], v[12:13], v[84:85], 0
    v_mov_b32 v92, v7
    s_andn2_b64 s[80:81], s[80:81], s[84:85]
    v_mfma_f32_4x4x4_16b_bf16 v[76:79], v[10:11], v[86:87], v[76:79]
    s_mov_b64 exec, -1
    ds_read_b64 v[68:69], v92 offset:65408
    v_and_b32 v46, 0x80000000, v33
    v_lshrrev_b32 v47, 14, v31
    v_bitop3_b32 v47, v47, v5, v46 bitop3:0xea
    ds_read_b64 v[106:107], v47
    v_bitop3_b32 v95, v31, v5, v46 bitop3:0xea
    v_and_b32 v46, 0x40000000, v33
    v_lshrrev_b32 v47, 14, v30
    v_bitop3_b32 v47, v47, v5, v46 bitop3:0xea
    ds_read_b64 v[104:105], v47
    v_bitop3_b32 v94, v30, v5, v46 bitop3:0xea
    s_waitcnt lgkmcnt(2)
    v_mfma_f32_4x4x4_16b_bf16 v[80:83], v[10:11], v[70:71], v[80:83]
    v_mfma_f32_4x4x4_16b_bf16 v[76:79], v[10:11], v[68:69], v[76:79]
    v_perm_b32 v15, v31, v32, s47
    v_bitop3_b32 v46, v31, 0.5, -0.5 bitop3:0xa8
    v_perm_b32 v14, v30, v32, s46
    v_bitop3_b32 v47, v30, 0.5, -0.5 bitop3:0xa8
    v_cvt_pk_bf16_f32 v80, v80, v81
    v_cvt_pk_bf16_f32 v81, v82, v83
    ds_wrxchg_rtn_b64 v[74:75], v93, v[80:81] offset:65408
    v_cvt_pk_bf16_f32 v76, v76, v77
    v_cvt_pk_bf16_f32 v77, v78, v79
    ds_wrxchg_rtn_b64 v[72:73], v92, v[76:77] offset:65408
    s_setprio 0
    s_waitcnt lgkmcnt(2)
    v_mfma_f32_4x4x4_16b_bf16 v[80:83], v[8:9], v[106:107], 0
    v_mfma_f32_4x4x4_16b_bf16 v[76:79], v[8:9], v[104:105], 0
    v_bitop3_b32 v15, v6, v15, v46 bitop3:0xca
    v_bitop3_b32 v14, v6, v14, v47 bitop3:0xca
    s_nop 1
    v_pk_mul_f32 v[80:81], v[80:81], v[14:15] op_sel:[0,1] op_sel_hi:[1,1]
    v_pk_mul_f32 v[82:83], v[82:83], v[14:15] op_sel:[0,1] op_sel_hi:[1,1]
    v_pk_mul_f32 v[76:77], v[76:77], v[14:15] op_sel:[0,0] op_sel_hi:[1,0]
    v_pk_mul_f32 v[78:79], v[78:79], v[14:15] op_sel:[0,0] op_sel_hi:[1,0]
    s_add_u32 s40, s40, 0xfff24000
    v_and_b32 v47, 0x0fffffff, v42
    v_mov_b32 v33, v42
    buffer_load_dwordx2 v[28:29], v47, s[8:11], 0 offen
    buffer_load_dwordx3 v[30:32], v47, s[8:11], 0 offen offset:8
    s_waitcnt lgkmcnt(0)
    v_cmpx_ne_u64 vcc, v[74:75], v[70:71]
    s_and_b64 s[82:83], vcc, s[80:81]
    s_cbranch_scc1 L2_c52
L2_d52:
    v_mov_b64 v[84:85], v[70:71]
    v_mov_b32 v7, v93
    v_mov_b64 v[86:87], v[74:75]
    s_mov_b64 exec, -1
    s_or_b64 s[80:81], s[80:81], vcc
    v_cmpx_ne_u64 vcc, v[72:73], v[68:69]
    s_and_b64 s[82:83], vcc, s[80:81]
    s_cbranch_scc1 L2_c53
L2_d53:
    v_mov_b64 v[84:85], v[68:69]
    v_mov_b32 v7, v92
    v_mov_b64 v[86:87], v[72:73]
    s_mov_b64 exec, -1
    s_or_b64 s[80:81], s[80:81], vcc
    ds_read_b64 v[70:71], v95 offset:65408
    ds_read_b64 v[68:69], v94 offset:65408
    s_waitcnt vmcnt(8)
    v_and_b32 v46, 0x20000000, v39
    v_lshrrev_b32 v47, 14, v35
    v_bitop3_b32 v47, v47, v5, v46 bitop3:0xea
    ds_read_b64 v[102:103], v47
    v_bitop3_b32 v93, v35, v5, v46 bitop3:0xea
    v_and_b32 v46, 0x10000000, v39
    v_lshrrev_b32 v47, 14, v34
    v_bitop3_b32 v47, v47, v5, v46 bitop3:0xea
    ds_read_b64 v[100:101], v47
    v_bitop3_b32 v92, v34, v5, v46 bitop3:0xea
    v_and_b32 v46, 0x80000000, v39
    v_lshrrev_b32 v47, 14, v37
    v_bitop3_b32 v47, v47, v5, v46 bitop3:0xea
    ds_read_b64 v[106:107], v47
    v_and_b32 v46, 0x40000000, v39
    v_lshrrev_b32 v47, 14, v36
    v_bitop3_b32 v47, v47, v5, v46 bitop3:0xea
    ds_read_b64 v[104:105], v47
    s_waitcnt lgkmcnt(4)
    v_mfma_f32_4x4x4_16b_bf16 v[80:83], v[10:11], v[70:71], v[80:83]
    v_mfma_f32_4x4x4_16b_bf16 v[76:79], v[10:11], v[68:69], v[76:79]
    v_perm_b32 v15, v35, v38, s45
    v_bitop3_b32 v46, v35, 0.5, -0.5 bitop3:0xa8
    v_perm_b32 v14, v34, v38, s44
    v_bitop3_b32 v47, v34, 0.5, -0.5 bitop3:0xa8
    v_cvt_pk_bf16_f32 v80, v80, v81
    v_cvt_pk_bf16_f32 v81, v82, v83
    ds_wrxchg_rtn_b64 v[74:75], v95, v[80:81] offset:65408
    v_cvt_pk_bf16_f32 v76, v76, v77
    v_cvt_pk_bf16_f32 v77, v78, v79
    ds_wrxchg_rtn_b64 v[72:73], v94, v[76:77] offset:65408
    s_waitcnt lgkmcnt(2)
    s_barrier
    s_setprio 3
    s_mov_b32 m0, s69
    s_nop 0
    ds_write_addtid_b32 v116 offset:32768
    ds_write_addtid_b32 v117 offset:33024
    ds_write_addtid_b32 v118 offset:33280
    ds_write_addtid_b32 v119 offset:33536
    buffer_load_dwordx4 v[116:119], v3, s[16:19], s40 offen offset:2048
    ds_write_addtid_b32 v120 offset:33792
    ds_write_addtid_b32 v121 offset:34048
    ds_write_addtid_b32 v122 offset:34304
    ds_write_addtid_b32 v123 offset:34560
    buffer_load_dwordx4 v[120:123], v3, s[16:19], s40 offen offset:3072
    v_mfma_f32_4x4x4_16b_bf16 v[80:83], v[8:9], v[102:103], 0
    v_mfma_f32_4x4x4_16b_bf16 v[76:79], v[8:9], v[100:101], 0
    v_bitop3_b32 v15, v6, v15, v46 bitop3:0xca
    v_bitop3_b32 v14, v6, v14, v47 bitop3:0xca
    v_cmp_lt_u32 s[84:85], v5, v92
    s_nop 0
    v_pk_mul_f32 v[80:81], v[80:81], v[14:15] op_sel:[0,1] op_sel_hi:[1,1]
    v_pk_mul_f32 v[82:83], v[82:83], v[14:15] op_sel:[0,1] op_sel_hi:[1,1]
    v_pk_mul_f32 v[76:77], v[76:77], v[14:15] op_sel:[0,0] op_sel_hi:[1,0]
    v_pk_mul_f32 v[78:79], v[78:79], v[14:15] op_sel:[0,0] op_sel_hi:[1,0]
    v_mov_b32 v44, v43
    s_cmp_gt_u32 s37, 1024
    s_cbranch_scc1 L2_xs54
    s_cmp_lg_u32 s43, 0
    s_cbranch_scc1 L2_xa54
L2_xb54:
    v_lshlrev_b32 v89, 16, v96
    v_add_u32 v90, 60, v97
    v_bitop3_b32 v90, v89, v45, v90 bitop3:0x6a
    ds_write_b32 v98, v90 offset:12
    v_lshlrev_b32 v89, 20, v96
    v_add_u32 v90, 40, v97
    v_bitop3_b32 v90, v89, v45, v90 bitop3:0x6a
    ds_write_b32 v98, v90 offset:8
    v_lshlrev_b32 v89, 24, v96
    v_add_u32 v90, 20, v97
    v_bitop3_b32 v90, v89, v45, v90 bitop3:0x6a
    ds_write_b32 v98, v90 offset:4
    v_lshlrev_b32 v89, 28, v96
    v_bitop3_b32 v90, v89, v45, v97 bitop3:0x6a
    ds_write_b32 v98, v90 offset:0
    v_mov_b32_dpp v91, v64 quad_perm:[0,0,0,0] row_mask:0xf bank_mask:0xf
    v_and_b32 v89, 3, v91
    v_and_b32 v97, 0xfffc, v91
    v_sub_u16_dpp v88, v64, v91 quad_perm:[2,2,2,2] row_mask:0xf bank_mask:0xf
    v_mad_u32_u24 v97, v97, 5, v4
    v_add_u32 v99, v88, v89
    v_bfm_b32 v96, v88, v89
    v_cmp_lt_u32 s[58:59], 16, v99
    v_lshlrev_b32 v89, v1, v96
    v_and_b32 v89, v45, v89
    v_cmp_ne_u32 vcc, 0, v89
    v_xor_b32 v90, v97, v89
    s_add_u32 s3, s37, s38
    v_mbcnt_lo_u32_b32 v98, vcc_lo, 0
    v_mbcnt_hi_u32_b32 v98, vcc_hi, v98
    s_bcnt1_i32_b64 s41, vcc
    v_lshl_add_u32 v98, v98, 2, s3
    s_mov_b64 exec, vcc
    ds_write_b32 v98, v90
    s_mov_b64 exec, -1
    s_lshl2_add_u32 s37, s41, s37
    s_cmp_lg_u64 s[58:59], 0
    s_cbranch_scc1 L2_xe54
L2_xr54:
    v_add_u32 v98, s37, v0
    v_mov_b32 v90, -1
    ds_write_b32 v98, v90
    ds_read2st64_b32 v[40:41], v0 offset0:0 offset1:1
    ds_read2st64_b32 v[42:43], v0 offset0:2 offset1:3
    s_sub_u32 s3, s37, 768
    s_cmp_gt_u32 s3, 256
    s_cbranch_scc1 L2_xf54
L2_xg54:
    s_setprio 2
    ds_write_addtid_b32 v124 offset:34816
    ds_write_addtid_b32 v125 offset:35072
    ds_write_addtid_b32 v126 offset:35328
    ds_write_addtid_b32 v127 offset:35584
    s_add_u32 s3, s40, 4096
    buffer_load_dwordx4 v[124:127], v3, s[16:19], s3 offen
    s_waitcnt lgkmcnt(14)
    v_cmpx_ne_u64 vcc, v[74:75], v[70:71]
    s_and_b64 s[82:83], vcc, s[80:81]
    s_cbranch_scc1 L2_c55
L2_d55:
    v_mov_b64 v[84:85], v[70:71]
    v_mov_b32 v7, v95
    v_mov_b64 v[86:87], v[74:75]
    s_mov_b64 exec, -1
    s_or_b64 s[80:81], s[80:81], vcc
    v_cmpx_ne_u64 vcc, v[72:73], v[68:69]
    s_and_b64 s[82:83], vcc, s[80:81]
    s_cbranch_scc1 L2_c56
L2_d56:
    v_mov_b64 v[84:85], v[68:69]
    v_mov_b32 v7, v94
    v_mov_b64 v[86:87], v[72:73]
    s_mov_b64 exec, -1
    s_or_b64 s[80:81], s[80:81], vcc
    ds_read_b64 v[70:71], v93 offset:65408
    s_and_b64 exec, s[84:85], s[80:81]
    v_mfma_f32_4x4x4_16b_bf16 v[76:79], v[12:13], v[84:85], 0
    v_mov_b32 v92, v7
    s_andn2_b64 s[80:81], s[80:81], s[84:85]
    v_mfma_f32_4x4x4_16b_bf16 v[76:79], v[10:11], v[86:87], v[76:79]
    s_mov_b64 exec, -1
    ds_read_b64 v[68:69], v92 offset:65408
    s_setprio 1
    s_waitcnt vmcnt(10)
    s_mov_b32 m0, s38
    s_nop 0
    ds_write_addtid_b32 v108 offset:0
    ds_write_addtid_b32 v109 offset:256
    ds_write_addtid_b32 v110 offset:512
    ds_write_addtid_b32 v111 offset:768
    s_waitcnt lgkmcnt(4)
    v_mfma_f32_4x4x4_16b_bf16 v[80:83], v[10:11], v[70:71], v[80:83]
    v_mfma_f32_4x4x4_16b_bf16 v[76:79], v[10:11], v[68:69], v[76:79]
    v_and_b32 v46, 0x40000000, v39
    v_bitop3_b32 v94, v36, v5, v46 bitop3:0xea
    v_and_b32 v46, 0x80000000, v39
    v_bitop3_b32 v95, v37, v5, v46 bitop3:0xea
    v_perm_b32 v15, v37, v38, s47
    v_bitop3_b32 v46, v37, 0.5, -0.5 bitop3:0xa8
    v_perm_b32 v14, v36, v38, s46
    v_bitop3_b32 v47, v36, 0.5, -0.5 bitop3:0xa8
    v_cvt_pk_bf16_f32 v80, v80, v81
    v_cvt_pk_bf16_f32 v81, v82, v83
    ds_wrxchg_rtn_b64 v[74:75], v93, v[80:81] offset:65408
    v_cvt_pk_bf16_f32 v76, v76, v77
    v_cvt_pk_bf16_f32 v77, v78, v79
    ds_wrxchg_rtn_b64 v[72:73], v92, v[76:77] offset:65408
    s_setprio 0
    s_waitcnt vmcnt(7)
    ds_write_addtid_b32 v112 offset:1024
    ds_write_addtid_b32 v113 offset:1280
    ds_write_addtid_b32 v114 offset:1536
    ds_write_addtid_b32 v115 offset:1792
    v_mfma_f32_4x4x4_16b_bf16 v[80:83], v[8:9], v[106:107], 0
    v_mfma_f32_4x4x4_16b_bf16 v[76:79], v[8:9], v[104:105], 0
    v_bitop3_b32 v15, v6, v15, v46 bitop3:0xca
    v_bitop3_b32 v14, v6, v14, v47 bitop3:0xca
    s_nop 1
    v_pk_mul_f32 v[80:81], v[80:81], v[14:15] op_sel:[0,1] op_sel_hi:[1,1]
    v_pk_mul_f32 v[82:83], v[82:83], v[14:15] op_sel:[0,1] op_sel_hi:[1,1]
    v_pk_mul_f32 v[76:77], v[76:77], v[14:15] op_sel:[0,0] op_sel_hi:[1,0]
    v_pk_mul_f32 v[78:79], v[78:79], v[14:15] op_sel:[0,0] op_sel_hi:[1,0]
    s_add_u32 s42, s42, 1
    s_waitcnt lgkmcnt(0)
    s_barrier
    s_bitcmp1_b32 s36, s42
    s_cbranch_scc1 L2_slow
L2_ret3:
    s_setprio 3
    v_and_b32 v47, 0x0fffffff, v44
    v_mov_b32 v39, v44
    buffer_load_dwordx2 v[34:35], v47, s[8:11], 0 offen
    buffer_load_dwordx3 v[36:38], v47, s[8:11], 0 offen offset:8
    v_cmpx_ne_u64 vcc, v[74:75], v[70:71]
    s_and_b64 s[82:83], vcc, s[80:81]
    s_cbranch_scc1 L2_c57
L2_d57:
    v_mov_b64 v[84:85], v[70:71]
    v_mov_b32 v7, v93
    v_mov_b64 v[86:87], v[74:75]
    s_mov_b64 exec, -1
    s_or_b64 s[80:81], s[80:81], vcc
    v_cmpx_ne_u64 vcc, v[72:73], v[68:69]
    s_and_b64 s[82:83], vcc, s[80:81]
    s_cbranch_scc1 L2_c58
L2_d58:
    v_mov_b64 v[84:85], v[68:69]
    v_mov_b32 v7, v92
    v_mov_b64 v[86:87], v[72:73]
    s_mov_b64 exec, -1
    s_or_b64 s[80:81], s[80:81], vcc
    ds_read_b64 v[70:71], v95 offset:65408
    ds_read_b64 v[68:69], v94 offset:65408
    v_and_b32 v46, 0x20000000, v21
    v_lshrrev_b32 v47, 14, v17
    v_bitop3_b32 v47, v47, v5, v46 bitop3:0xea
    ds_read_b64 v[102:103], v47
    v_bitop3_b32 v93, v17, v5, v46 bitop3:0xea
    v_and_b32 v46, 0x10000000, v21
    v_lshrrev_b32 v47, 14, v16
    v_bitop3_b32 v47, v47, v5, v46 bitop3:0xea
    ds_read_b64 v[100:101], v47
    v_bitop3_b32 v92, v16, v5, v46 bitop3:0xea
    s_waitcnt lgkmcnt(2)
    v_mfma_f32_4x4x4_16b_bf16 v[80:83], v[10:11], v[70:71], v[80:83]
    v_mfma_f32_4x4x4_16b_bf16 v[76:79], v[10:11], v[68:69], v[76:79]
    v_perm_b32 v15, v17, v20, s45
    v_bitop3_b32 v46, v17, 0.5, -0.5 bitop3:0xa8
    v_perm_b32 v14, v16, v20, s44
    v_bitop3_b32 v47, v16, 0.5, -0.5 bitop3:0xa8
    v_cvt_pk_bf16_f32 v80, v80, v81
    v_cvt_pk_bf16_f32 v81, v82, v83
    ds_wrxchg_rtn_b64 v[74:75], v95, v[80:81] offset:65408
    v_cvt_pk_bf16_f32 v76, v76, v77
    v_cvt_pk_bf16_f32 v77, v78, v79
    ds_wrxchg_rtn_b64 v[72:73], v94, v[76:77] offset:65408
    s_waitcnt lgkmcnt(2)
    v_mfma_f32_4x4x4_16b_bf16 v[80:83], v[8:9], v[102:103], 0
    v_mfma_f32_4x4x4_16b_bf16 v[76:79], v[8:9], v[100:101], 0
    v_bitop3_b32 v15, v6, v15, v46 bitop3:0xca
    v_bitop3_b32 v14, v6, v14, v47 bitop3:0xca
    v_cmp_lt_u32 s[84:85], v5, v92
    s_nop 0
    v_pk_mul_f32 v[80:81], v[80:81], v[14:15] op_sel:[0,1] op_sel_hi:[1,1]
    v_pk_mul_f32 v[82:83], v[82:83], v[14:15] op_sel:[0,1] op_sel_hi:[1,1]
    v_pk_mul_f32 v[76:77], v[76:77], v[14:15] op_sel:[0,0] op_sel_hi:[1,0]
    v_pk_mul_f32 v[78:79], v[78:79], v[14:15] op_sel:[0,0] op_sel_hi:[1,0]
    buffer_load_dwordx4 v[108:111], v3, s[16:19], s40 offen offset:0
    s_waitcnt lgkmcnt(0)
    v_cmpx_ne_u64 vcc, v[74:75], v[70:71]
    s_and_b64 s[82:83], vcc, s[80:81]
    s_cbranch_scc1 L2_c59
L2_d59:
    v_mov_b64 v[84:85], v[70:71]
    v_mov_b32 v7, v95
    v_mov_b64 v[86:87], v[74:75]
    s_mov_b64 exec, -1
    s_or_b64 s[80:81], s[80:81], vcc
    v_cmpx_ne_u64 vcc, v[72:73], v[68:69]
    s_and_b64 s[82:83], vcc, s[80:81]
    s_cbranch_scc1 L2_c60
L2_d60:
    v_mov_b64 v[84:85], v[68:69]
    v_mov_b32 v7, v94
    v_mov_b64 v[86:87], v[72:73]
    s_mov_b64 exec, -1
    s_or_b64 s[80:81], s[80:81], vcc
    ds_read_b64 v[70:71], v93 offset:65408
    s_and_b64 exec, s[84:85], s[80:81]
    v_mfma_f32_4x4x4_16b_bf16 v[76:79], v[12:13], v[84:85], 0
    v_mov_b32 v92, v7
    s_andn2_b64 s[80:81], s[80:81], s[84:85]
    v_mfma_f32_4x4x4_16b_bf16 v[76:79], v[10:11], v[86:87], v[76:79]
    s_mov_b64 exec, -1
    ds_read_b64 v[68:69], v92 offset:65408
    v_and_b32 v46, 0x80000000, v21
    v_lshrrev_b32 v47, 14, v19
    v_bitop3_b32 v47, v47, v5, v46 bitop3:0xea
    ds_read_b64 v[106:107], v47
    v_bitop3_b32 v95, v19, v5, v46 bitop3:0xea
    v_and_b32 v46, 0x40000000, v21
    v_lshrrev_b32 v47, 14, v18
    v_bitop3_b32 v47, v47, v5, v46 bitop3:0xea
    ds_read_b64 v[104:105], v47
    v_bitop3_b32 v94, v18, v5, v46 bitop3:0xea
    s_waitcnt lgkmcnt(2)
    v_mfma_f32_4x4x4_16b_bf16 v[80:83], v[10:11], v[70:71], v[80:83]
    v_mfma_f32_4x4x4_16b_bf16 v[76:79], v[10:11], v[68:69], v[76:79]
    v_perm_b32 v15, v19, v20, s47
    v_bitop3_b32 v46, v19, 0.5, -0.5 bitop3:0xa8
    v_perm_b32 v14, v18, v20, s46
    v_bitop3_b32 v47, v18, 0.5, -0.5 bitop3:0xa8
    v_cvt_pk_bf16_f32 v80, v80, v81
    v_cvt_pk_bf16_f32 v81, v82, v83
    ds_wrxchg_rtn_b64 v[74:75], v93, v[80:81] offset:65408
    v_cvt_pk_bf16_f32 v76, v76, v77
    v_cvt_pk_bf16_f32 v77, v78, v79
    ds_wrxchg_rtn_b64 v[72:73], v92, v[76:77] offset:65408
    s_setprio 2
    s_waitcnt lgkmcnt(2)
    v_mfma_f32_4x4x4_16b_bf16 v[80:83], v[8:9], v[106:107], 0
    v_mfma_f32_4x4x4_16b_bf16 v[76:79], v[8:9], v[104:105], 0
    v_bitop3_b32 v15, v6, v15, v46 bitop3:0xca
    v_bitop3_b32 v14, v6, v14, v47 bitop3:0xca
    s_nop 1
    v_pk_mul_f32 v[80:81], v[80:81], v[14:15] op_sel:[0,1] op_sel_hi:[1,1]
    v_pk_mul_f32 v[82:83], v[82:83], v[14:15] op_sel:[0,1] op_sel_hi:[1,1]
    v_pk_mul_f32 v[76:77], v[76:77], v[14:15] op_sel:[0,0] op_sel_hi:[1,0]
    v_pk_mul_f32 v[78:79], v[78:79], v[14:15] op_sel:[0,0] op_sel_hi:[1,0]
    v_and_b32 v47, 0x0fffffff, v40
    v_mov_b32 v21, v40
    buffer_load_dwordx2 v[16:17], v47, s[8:11], 0 offen
    buffer_load_dwordx3 v[18:20], v47, s[8:11], 0 offen offset:8
    s_waitcnt lgkmcnt(0)
    v_cmpx_ne_u64 vcc, v[74:75], v[70:71]
    s_and_b64 s[82:83], vcc, s[80:81]
    s_cbranch_scc1 L2_c61
L2_d61:
    v_mov_b64 v[84:85], v[70:71]
    v_mov_b32 v7, v93
    v_mov_b64 v[86:87], v[74:75]
    s_mov_b64 exec, -1
    s_or_b64 s[80:81], s[80:81], vcc
    v_cmpx_ne_u64 vcc, v[72:73], v[68:69]
    s_and_b64 s[82:83], vcc, s[80:81]
    s_cbranch_scc1 L2_c62
L2_d62:
    v_mov_b64 v[84:85], v[68:69]
    v_mov_b32 v7, v92
    v_mov_b64 v[86:87], v[72:73]
    s_mov_b64 exec, -1
    s_or_b64 s[80:81], s[80:81], vcc
    ds_read_b64 v[70:71], v95 offset:65408
    ds_read_b64 v[68:69], v94 offset:65408
    s_waitcnt vmcnt(10)
    v_and_b32 v46, 0x20000000, v27
    v_lshrrev_b32 v47, 14, v23
    v_bitop3_b32 v47, v47, v5, v46 bitop3:0xea
    ds_read_b64 v[102:103], v47
    v_bitop3_b32 v93, v23, v5, v46 bitop3:0xea
    v_and_b32 v46, 0x10000000, v27
    v_lshrrev_b32 v47, 14, v22
    v_bitop3_b32 v47, v47, v5, v46 bitop3:0xea
    ds_read_b64 v[100:101], v47
    v_bitop3_b32 v92, v22, v5, v46 bitop3:0xea
    s_waitcnt lgkmcnt(2)
    v_mfma_f32_4x4x4_16b_bf16 v[80:83], v[10:11], v[70:71], v[80:83]
    v_mfma_f32_4x4x4_16b_bf16 v[76:79], v[10:11], v[68:69], v[76:79]
    v_perm_b32 v15, v23, v26, s45
    v_bitop3_b32 v46, v23, 0.5, -0.5 bitop3:0xa8
    v_perm_b32 v14, v22, v26, s44
    v_bitop3_b32 v47, v22, 0.5, -0.5 bitop3:0xa8
    v_cvt_pk_bf16_f32 v80, v80, v81
    v_cvt_pk_bf16_f32 v81, v82, v83
    ds_wrxchg_rtn_b64 v[74:75], v95, v[80:81] offset:65408
    v_cvt_pk_bf16_f32 v76, v76, v77
    v_cvt_pk_bf16_f32 v77, v78, v79
    ds_wrxchg_rtn_b64 v[72:73], v94, v[76:77] offset:65408
    s_waitcnt lgkmcnt(2)
    v_mfma_f32_4x4x4_16b_bf16 v[80:83], v[8:9], v[102:103], 0
    v_mfma_f32_4x4x4_16b_bf16 v[76:79], v[8:9], v[100:101], 0
    v_bitop3_b32 v15, v6, v15, v46 bitop3:0xca
    v_bitop3_b32 v14, v6, v14, v47 bitop3:0xca
    v_cmp_lt_u32 s[84:85], v5, v92
    s_nop 0
    v_pk_mul_f32 v[80:81], v[80:81], v[14:15] op_sel:[0,1] op_sel_hi:[1,1]
    v_pk_mul_f32 v[82:83], v[82:83], v[14:15] op_sel:[0,1] op_sel_hi:[1,1]
    v_pk_mul_f32 v[76:77], v[76:77], v[14:15] op_sel:[0,0] op_sel_hi:[1,0]
    v_pk_mul_f32 v[78:79], v[78:79], v[14:15] op_sel:[0,0] op_sel_hi:[1,0]
    v_sub_u16 v88, v58, v50
    v_and_b32 v89, 3, v50
    v_add3_u32 v99, v88, v89, 3
    v_and_b32 v99, -4, v99
    v_max_u32 v99, 4, v99
    v_and_b32 v97, 0xfffc, v50
    v_bfm_b32 v96, v88, v89
    v_add_u32_dpp v91, v99, v99 row_shr:1 row_mask:0xf bank_mask:0xf bound_ctrl:1
    v_mad_u32_u24 v97, v97, 5, v2
    v_cmp_lt_u32 vcc, 16, v99
    v_add_u32_dpp v91, v91, v91 row_shr:2 row_mask:0xf bank_mask:0xf bound_ctrl:1
    v_sub_u32 v98, s38, v99
    v_lshrrev_b64 v[50:51], 16, v[50:51]
    v_add_u32_dpp v91, v91, v91 row_shr:4 row_mask:0xf bank_mask:0xf bound_ctrl:1
    v_lshrrev_b64 v[58:59], 16, v[58:59]
    s_mov_b32 s43, 0
    v_add_u32_dpp v91, v91, v91 row_shr:8 row_mask:0xf bank_mask:0xf bound_ctrl:1
    s_nop 1
    v_add_u32_dpp v91, v91, v91 row_bcast:15 row_mask:0xa bank_mask:0xf
    s_nop 1
    v_add_u32_dpp v91, v91, v91 row_bcast:31 row_mask:0xc bank_mask:0xf
    v_add_u32 v98, v98, v91
    v_readlane_b32 s37, v91, 63
    s_cbranch_vccnz L2_xo63
L2_xp63:
    buffer_load_dwordx4 v[112:115], v3, s[16:19], s40 offen offset:1024
    s_waitcnt lgkmcnt(0)
    v_cmpx_ne_u64 vcc, v[74:75], v[70:71]
    s_and_b64 s[82:83], vcc, s[80:81]
    s_cbranch_scc1 L2_c64
L2_d64:
    v_mov_b64 v[84:85], v[70:71]
    v_mov_b32 v7, v95
    v_mov_b64 v[86:87], v[74:75]
    s_mov_b64 exec, -1
    s_or_b64 s[80:81], s[80:81], vcc
    v_cmpx_ne_u64 vcc, v[72:73], v[68:69]
    s_and_b64 s[82:83], vcc, s[80:81]
    s_cbranch_scc1 L2_c65
L2_d65:
    v_mov_b64 v[84:85], v[68:69]
    v_mov_b32 v7, v94
    v_mov_b64 v[86:87], v[72:73]
    s_mov_b64 exec, -1
    s_or_b64 s[80:81], s[80:81], vcc
    ds_read_b64 v[70:71], v93 offset:65408
    s_and_b64 exec, s[84:85], s[80:81]
    v_mfma_f32_4x4x4_16b_bf16 v[76:79], v[12:13], v[84:85], 0
    v_mov_b32 v92, v7
    s_andn2_b64 s[80:81], s[80:81], s[84:85]
    v_mfma_f32_4x4x4_16b_bf16 v[76:79], v[10:11], v[86:87], v[76:79]
    s_mov_b64 exec, -1
    ds_read_b64 v[68:69], v92 offset:65408
    v_and_b32 v46, 0x80000000, v27
    v_lshrrev_b32 v47, 14, v25
    v_bitop3_b32 v47, v47, v5, v46 bitop3:0xea
    ds_read_b64 v[106:107], v47
    v_bitop3_b32 v95, v25, v5, v46 bitop3:0xea
    v_and_b32 v46, 0x40000000, v27
    v_lshrrev_b32 v47, 14, v24
    v_bitop3_b32 v47, v47, v5, v46 bitop3:0xea
    ds_read_b64 v[104:105], v47
    v_bitop3_b32 v94, v24, v5, v46 bitop3:0xea
    s_waitcnt lgkmcnt(2)
    v_mfma_f32_4x4x4_16b_bf16 v[80:83], v[10:11], v[70:71], v[80:83]
    v_mfma_f32_4x4x4_16b_bf16 v[76:79], v[10:11], v[68:69], v[76:79]
    v_perm_b32 v15, v25, v26, s47
    v_bitop3_b32 v46, v25, 0.5, -0.5 bitop3:0xa8
    v_perm_b32 v14, v24, v26, s46
    v_bitop3_b32 v47, v24, 0.5, -0.5 bitop3:0xa8
    v_cvt_pk_bf16_f32 v80, v80, v81
    v_cvt_pk_bf16_f32 v81, v82, v83
    ds_wrxchg_rtn_b64 v[74:75], v93, v[80:81] offset:65408
    v_cvt_pk_bf16_f32 v76, v76, v77
    v_cvt_pk_bf16_f32 v77, v78, v79
    ds_wrxchg_rtn_b64 v[72:73], v92, v[76:77] offset:65408
    s_setprio 1
    s_waitcnt lgkmcnt(2)
    v_mfma_f32_4x4x4_16b_bf16 v[80:83], v[8:9], v[106:107], 0
    v_mfma_f32_4x4x4_16b_bf16 v[76:79], v[8:9], v[104:105], 0
    v_bitop3_b32 v15, v6, v15, v46 bitop3:0xca
    v_bitop3_b32 v14, v6, v14, v47 bitop3:0xca
    s_nop 1
    v_pk_mul_f32 v[80:81], v[80:81], v[14:15] op_sel:[0,1] op_sel_hi:[1,1]
    v_pk_mul_f32 v[82:83], v[82:83], v[14:15] op_sel:[0,1] op_sel_hi:[1,1]
    v_pk_mul_f32 v[76:77], v[76:77], v[14:15] op_sel:[0,0] op_sel_hi:[1,0]
    v_pk_mul_f32 v[78:79], v[78:79], v[14:15] op_sel:[0,0] op_sel_hi:[1,0]
    v_and_b32 v47, 0x0fffffff, v41
    v_mov_b32 v27, v41
    buffer_load_dwordx2 v[22:23], v47, s[8:11], 0 offen
    buffer_load_dwordx3 v[24:26], v47, s[8:11], 0 offen offset:8
    s_waitcnt lgkmcnt(0)
    v_cmpx_ne_u64 vcc, v[74:75], v[70:71]
    s_and_b64 s[82:83], vcc, s[80:81]
    s_cbranch_scc1 L2_c66
L2_d66:
    v_mov_b64 v[84:85], v[70:71]
    v_mov_b32 v7, v93
    v_mov_b64 v[86:87], v[74:75]
    s_mov_b64 exec, -1
    s_or_b64 s[80:81], s[80:81], vcc
    v_cmpx_ne_u64 vcc, v[72:73], v[68:69]
    s_and_b64 s[82:83], vcc, s[80:81]
    s_cbranch_scc1 L2_c67
L2_d67:
    v_mov_b64 v[84:85], v[68:69]
    v_mov_b32 v7, v92
    v_mov_b64 v[86:87], v[72:73]
    s_mov_b64 exec, -1
    s_or_b64 s[80:81], s[80:81], vcc
    ds_read_b64 v[70:71], v95 offset:65408
    ds_read_b64 v[68:69], v94 offset:65408
    s_waitcnt vmcnt(11)
    v_and_b32 v46, 0x20000000, v33
    v_lshrrev_b32 v47, 14, v29
    v_bitop3_b32 v47, v47, v5, v46 bitop3:0xea
    ds_read_b64 v[102:103], v47
    v_bitop3_b32 v93, v29, v5, v46 bitop3:0xea
    v_and_b32 v46, 0x10000000, v33
    v_lshrrev_b32 v47, 14, v28
    v_bitop3_b32 v47, v47, v5, v46 bitop3:0xea
    ds_read_b64 v[100:101], v47
    v_bitop3_b32 v92, v28, v5, v46 bitop3:0xea
    s_waitcnt lgkmcnt(2)
    v_mfma_f32_4x4x4_16b_bf16 v[80:83], v[10:11], v[70:71], v[80:83]
    v_mfma_f32_4x4x4_16b_bf16 v[76:79], v[10:11], v[68:69], v[76:79]
    v_perm_b32 v15, v29, v32, s45
    v_bitop3_b32 v46, v29, 0.5, -0.5 bitop3:0xa8
    v_perm_b32 v14, v28, v32, s44
    v_bitop3_b32 v47, v28, 0.5, -0.5 bitop3:0xa8
    v_cvt_pk_bf16_f32 v80, v80, v81
    v_cvt_pk_bf16_f32 v81, v82, v83
    ds_wrxchg_rtn_b64 v[74:75], v95, v[80:81] offset:65408
    v_cvt_pk_bf16_f32 v76, v76, v77
    v_cvt_pk_bf16_f32 v77, v78, v79
    ds_wrxchg_rtn_b64 v[72:73], v94, v[76:77] offset:65408
    s_waitcnt lgkmcnt(2)
    v_mfma_f32_4x4x4_16b_bf16 v[80:83], v[8:9], v[102:103], 0
    v_mfma_f32_4x4x4_16b_bf16 v[76:79], v[8:9], v[100:101], 0
    v_bitop3_b32 v15, v6, v15, v46 bitop3:0xca
    v_bitop3_b32 v14, v6, v14, v47 bitop3:0xca
    v_cmp_lt_u32 s[84:85], v5, v92
    s_nop 0
    v_pk_mul_f32 v[80:81], v[80:81], v[14:15] op_sel:[0,1] op_sel_hi:[1,1]
    v_pk_mul_f32 v[82:83], v[82:83], v[14:15] op_sel:[0,1] op_sel_hi:[1,1]
    v_pk_mul_f32 v[76:77], v[76:77], v[14:15] op_sel:[0,0] op_sel_hi:[1,0]
    v_pk_mul_f32 v[78:79], v[78:79], v[14:15] op_sel:[0,0] op_sel_hi:[1,0]
    s_waitcnt lgkmcnt(0)
    v_cmpx_ne_u64 vcc, v[74:75], v[70:71]
    s_and_b64 s[82:83], vcc, s[80:81]
    s_cbranch_scc1 L2_c68
L2_d68:
    v_mov_b64 v[84:85], v[70:71]
    v_mov_b32 v7, v95
    v_mov_b64 v[86:87], v[74:75]
    s_mov_b64 exec, -1
    s_or_b64 s[80:81], s[80:81], vcc
    v_cmpx_ne_u64 vcc, v[72:73], v[68:69]
    s_and_b64 s[82:83], vcc, s[80:81]
    s_cbranch_scc1 L2_c69
L2_d69:
    v_mov_b64 v[84:85], v[68:69]
    v_mov_b32 v7, v94
    v_mov_b64 v[86:87], v[72:73]
    s_mov_b64 exec, -1
    s_or_b64 s[80:81], s[80:81], vcc
    ds_read_b64 v[70:71], v93 offset:65408
    s_and_b64 exec, s[84:85], s[80:81]
    v_mfma_f32_4x4x4_16b_bf16 v[76:79], v[12:13], v[84:85], 0
    v_mov_b32 v92, v7
    s_andn2_b64 s[80:81], s[80:81], s[84:85]
    v_mfma_f32_4x4x4_16b_bf16 v[76:79], v[10:11], v[86:87], v[76:79]
    s_mov_b64 exec, -1
    ds_read_b64 v[68:69], v92 offset:65408
    v_and_b32 v46, 0x80000000, v33
    v_lshrrev_b32 v47, 14, v31
    v_bitop3_b32 v47, v47, v5, v46 bitop3:0xea
    ds_read_b64 v[106:107], v47
    v_bitop3_b32 v95, v31, v5, v46 bitop3:0xea
    v_and_b32 v46, 0x40000000, v33
    v_lshrrev_b32 v47, 14, v30
    v_bitop3_b32 v47, v47, v5, v46 bitop3:0xea
    ds_read_b64 v[104:105], v47
    v_bitop3_b32 v94, v30, v5, v46 bitop3:0xea
    s_waitcnt lgkmcnt(2)
    v_mfma_f32_4x4x4_16b_bf16 v[80:83], v[10:11], v[70:71], v[80:83]
    v_mfma_f32_4x4x4_16b_bf16 v[76:79], v[10:11], v[68:69], v[76:79]
    v_perm_b32 v15, v31, v32, s47
    v_bitop3_b32 v46, v31, 0.5, -0.5 bitop3:0xa8
    v_perm_b32 v14, v30, v32, s46
    v_bitop3_b32 v47, v30, 0.5, -0.5 bitop3:0xa8
    v_cvt_pk_bf16_f32 v80, v80, v81
    v_cvt_pk_bf16_f32 v81, v82, v83
    ds_wrxchg_rtn_b64 v[74:75], v93, v[80:81] offset:65408
    v_cvt_pk_bf16_f32 v76, v76, v77
    v_cvt_pk_bf16_f32 v77, v78, v79
    ds_wrxchg_rtn_b64 v[72:73], v92, v[76:77] offset:65408
    s_setprio 0
    s_waitcnt lgkmcnt(2)
    v_mfma_f32_4x4x4_16b_bf16 v[80:83], v[8:9], v[106:107], 0
    v_mfma_f32_4x4x4_16b_bf16 v[76:79], v[8:9], v[104:105], 0
    v_bitop3_b32 v15, v6, v15, v46 bitop3:0xca
    v_bitop3_b32 v14, v6, v14, v47 bitop3:0xca
    s_nop 1
    v_pk_mul_f32 v[80:81], v[80:81], v[14:15] op_sel:[0,1] op_sel_hi:[1,1]
    v_pk_mul_f32 v[82:83], v[82:83], v[14:15] op_sel:[0,1] op_sel_hi:[1,1]
    v_pk_mul_f32 v[76:77], v[76:77], v[14:15] op_sel:[0,0] op_sel_hi:[1,0]
    v_pk_mul_f32 v[78:79], v[78:79], v[14:15] op_sel:[0,0] op_sel_hi:[1,0]
    s_add_u32 s40, s40, 0x50000
    v_and_b32 v47, 0x0fffffff, v42
    v_mov_b32 v33, v42
    buffer_load_dwordx2 v[28:29], v47, s[8:11], 0 offen
    buffer_load_dwordx3 v[30:32], v47, s[8:11], 0 offen offset:8
    s_waitcnt lgkmcnt(0)
    v_cmpx_ne_u64 vcc, v[74:75], v[70:71]
    s_and_b64 s[82:83], vcc, s[80:81]
    s_cbranch_scc1 L2_c70
L2_d70:
    v_mov_b64 v[84:85], v[70:71]
    v_mov_b32 v7, v93
    v_mov_b64 v[86:87], v[74:75]
    s_mov_b64 exec, -1
    s_or_b64 s[80:81], s[80:81], vcc
    v_cmpx_ne_u64 vcc, v[72:73], v[68:69]
    s_and_b64 s[82:83], vcc, s[80:81]
    s_cbranch_scc1 L2_c71
L2_d71:
    v_mov_b64 v[84:85], v[68:69]
    v_mov_b32 v7, v92
    v_mov_b64 v[86:87], v[72:73]
    s_mov_b64 exec, -1
    s_or_b64 s[80:81], s[80:81], vcc
    ds_read_b64 v[70:71], v95 offset:65408
    ds_read_b64 v[68:69], v94 offset:65408
    s_waitcnt vmcnt(8)
    v_and_b32 v46, 0x20000000, v39
    v_lshrrev_b32 v47, 14, v35
    v_bitop3_b32 v47, v47, v5, v46 bitop3:0xea
    ds_read_b64 v[102:103], v47
    v_bitop3_b32 v93, v35, v5, v46 bitop3:0xea
    v_and_b32 v46, 0x10000000, v39
    v_lshrrev_b32 v47, 14, v34
    v_bitop3_b32 v47, v47, v5, v46 bitop3:0xea
    ds_read_b64 v[100:101], v47
    v_bitop3_b32 v92, v34, v5, v46 bitop3:0xea
    v_and_b32 v46, 0x80000000, v39
    v_lshrrev_b32 v47, 14, v37
    v_bitop3_b32 v47, v47, v5, v46 bitop3:0xea
    ds_read_b64 v[106:107], v47
    v_and_b32 v46, 0x40000000, v39
    v_lshrrev_b32 v47, 14, v36
    v_bitop3_b32 v47, v47, v5, v46 bitop3:0xea
    ds_read_b64 v[104:105], v47
    s_waitcnt lgkmcnt(4)
    v_mfma_f32_4x4x4_16b_bf16 v[80:83], v[10:11], v[70:71], v[80:83]
    v_mfma_f32_4x4x4_16b_bf16 v[76:79], v[10:11], v[68:69], v[76:79]
    v_perm_b32 v15, v35, v38, s45
    v_bitop3_b32 v46, v35, 0.5, -0.5 bitop3:0xa8
    v_perm_b32 v14, v34, v38, s44
    v_bitop3_b32 v47, v34, 0.5, -0.5 bitop3:0xa8
    v_cvt_pk_bf16_f32 v80, v80, v81
    v_cvt_pk_bf16_f32 v81, v82, v83
    ds_wrxchg_rtn_b64 v[74:75], v95, v[80:81] offset:65408
    v_cvt_pk_bf16_f32 v76, v76, v77
    v_cvt_pk_bf16_f32 v77, v78, v79
    ds_wrxchg_rtn_b64 v[72:73], v94, v[76:77] offset:65408
    s_waitcnt lgkmcnt(2)
    s_barrier
    s_setprio 3
    s_mov_b32 m0, s69
    s_nop 0
    ds_write_addtid_b32 v116 offset:32768
    ds_write_addtid_b32 v117 offset:33024
    ds_write_addtid_b32 v118 offset:33280
    ds_write_addtid_b32 v119 offset:33536
    buffer_load_dwordx4 v[116:119], v3, s[16:19], s40 offen offset:2048
    ds_write_addtid_b32 v120 offset:33792
    ds_write_addtid_b32 v121 offset:34048
    ds_write_addtid_b32 v122 offset:34304
    ds_write_addtid_b32 v123 offset:34560
    buffer_load_dwordx4 v[120:123], v3, s[16:19], s40 offen offset:3072
    v_mfma_f32_4x4x4_16b_bf16 v[80:83], v[8:9], v[102:103], 0
    v_mfma_f32_4x4x4_16b_bf16 v[76:79], v[8:9], v[100:101], 0
    v_bitop3_b32 v15, v6, v15, v46 bitop3:0xca
    v_bitop3_b32 v14, v6, v14, v47 bitop3:0xca
    v_cmp_lt_u32 s[84:85], v5, v92
    s_nop 0
    v_pk_mul_f32 v[80:81], v[80:81], v[14:15] op_sel:[0,1] op_sel_hi:[1,1]
    v_pk_mul_f32 v[82:83], v[82:83], v[14:15] op_sel:[0,1] op_sel_hi:[1,1]
    v_pk_mul_f32 v[76:77], v[76:77], v[14:15] op_sel:[0,0] op_sel_hi:[1,0]
    v_pk_mul_f32 v[78:79], v[78:79], v[14:15] op_sel:[0,0] op_sel_hi:[1,0]
    v_mov_b32 v44, v43
    s_cmp_gt_u32 s37, 1024
    s_cbranch_scc1 L2_xs72
    s_cmp_lg_u32 s43, 0
    s_cbranch_scc1 L2_xa72
L2_xb72:
    v_lshlrev_b32 v89, 16, v96
    v_add_u32 v90, 60, v97
    v_bitop3_b32 v90, v89, v45, v90 bitop3:0x6a
    ds_write_b32 v98, v90 offset:12
    v_lshlrev_b32 v89, 20, v96
    v_add_u32 v90, 40, v97
    v_bitop3_b32 v90, v89, v45, v90 bitop3:0x6a
    ds_write_b32 v98, v90 offset:8
    v_lshlrev_b32 v89, 24, v96
    v_add_u32 v90, 20, v97
    v_bitop3_b32 v90, v89, v45, v90 bitop3:0x6a
    ds_write_b32 v98, v90 offset:4
    v_lshlrev_b32 v89, 28, v96
    v_bitop3_b32 v90, v89, v45, v97 bitop3:0x6a
    ds_write_b32 v98, v90 offset:0
    v_mov_b32_dpp v91, v66 quad_perm:[0,0,0,0] row_mask:0xf bank_mask:0xf
    v_and_b32 v89, 3, v91
    v_and_b32 v97, 0xfffc, v91
    v_sub_u16_dpp v88, v66, v91 quad_perm:[2,2,2,2] row_mask:0xf bank_mask:0xf
    v_mad_u32_u24 v97, v97, 5, v4
    v_add_u32 v99, v88, v89
    v_bfm_b32 v96, v88, v89
    v_cmp_lt_u32 s[58:59], 16, v99
    v_lshlrev_b32 v89, v1, v96
    v_and_b32 v89, v45, v89
    v_cmp_ne_u32 vcc, 0, v89
    v_xor_b32 v90, v97, v89
    s_add_u32 s3, s37, s38
    v_mbcnt_lo_u32_b32 v98, vcc_lo, 0
    v_mbcnt_hi_u32_b32 v98, vcc_hi, v98
    s_bcnt1_i32_b64 s41, vcc
    v_lshl_add_u32 v98, v98, 2, s3
    s_mov_b64 exec, vcc
    ds_write_b32 v98, v90
    s_mov_b64 exec, -1
    s_lshl2_add_u32 s37, s41, s37
    s_cmp_lg_u64 s[58:59], 0
    s_cbranch_scc1 L2_xe72
L2_xr72:
    v_add_u32 v98, s37, v0
    v_mov_b32 v90, -1
    ds_write_b32 v98, v90
    ds_read2st64_b32 v[40:41], v0 offset0:0 offset1:1
    ds_read2st64_b32 v[42:43], v0 offset0:2 offset1:3
    s_sub_u32 s3, s37, 768
    s_cmp_gt_u32 s3, 256
    s_cbranch_scc1 L2_xf72
L2_xg72:
    s_setprio 2
    ds_write_addtid_b32 v124 offset:34816
    ds_write_addtid_b32 v125 offset:35072
    ds_write_addtid_b32 v126 offset:35328
    ds_write_addtid_b32 v127 offset:35584
    s_add_u32 s3, s40, 4096
    buffer_load_dwordx4 v[124:127], v3, s[16:19], s3 offen
    s_waitcnt lgkmcnt(14)
    v_cmpx_ne_u64 vcc, v[74:75], v[70:71]
    s_and_b64 s[82:83], vcc, s[80:81]
    s_cbranch_scc1 L2_c73
L2_d73:
    v_mov_b64 v[84:85], v[70:71]
    v_mov_b32 v7, v95
    v_mov_b64 v[86:87], v[74:75]
    s_mov_b64 exec, -1
    s_or_b64 s[80:81], s[80:81], vcc
    v_cmpx_ne_u64 vcc, v[72:73], v[68:69]
    s_and_b64 s[82:83], vcc, s[80:81]
    s_cbranch_scc1 L2_c74
L2_d74:
    v_mov_b64 v[84:85], v[68:69]
    v_mov_b32 v7, v94
    v_mov_b64 v[86:87], v[72:73]
    s_mov_b64 exec, -1
    s_or_b64 s[80:81], s[80:81], vcc
    ds_read_b64 v[70:71], v93 offset:65408
    s_and_b64 exec, s[84:85], s[80:81]
    v_mfma_f32_4x4x4_16b_bf16 v[76:79], v[12:13], v[84:85], 0
    v_mov_b32 v92, v7
    s_andn2_b64 s[80:81], s[80:81], s[84:85]
    v_mfma_f32_4x4x4_16b_bf16 v[76:79], v[10:11], v[86:87], v[76:79]
    s_mov_b64 exec, -1
    ds_read_b64 v[68:69], v92 offset:65408
    s_setprio 1
    s_waitcnt vmcnt(10)
    s_mov_b32 m0, s38
    s_nop 0
    ds_write_addtid_b32 v108 offset:0
    ds_write_addtid_b32 v109 offset:256
    ds_write_addtid_b32 v110 offset:512
    ds_write_addtid_b32 v111 offset:768
    s_waitcnt lgkmcnt(4)
    v_mfma_f32_4x4x4_16b_bf16 v[80:83], v[10:11], v[70:71], v[80:83]
    v_mfma_f32_4x4x4_16b_bf16 v[76:79], v[10:11], v[68:69], v[76:79]
    v_and_b32 v46, 0x40000000, v39
    v_bitop3_b32 v94, v36, v5, v46 bitop3:0xea
    v_and_b32 v46, 0x80000000, v39
    v_bitop3_b32 v95, v37, v5, v46 bitop3:0xea
    v_perm_b32 v15, v37, v38, s47
    v_bitop3_b32 v46, v37, 0.5, -0.5 bitop3:0xa8
    v_perm_b32 v14, v36, v38, s46
    v_bitop3_b32 v47, v36, 0.5, -0.5 bitop3:0xa8
    v_cvt_pk_bf16_f32 v80, v80, v81
    v_cvt_pk_bf16_f32 v81, v82, v83
    ds_wrxchg_rtn_b64 v[74:75], v93, v[80:81] offset:65408
    v_cvt_pk_bf16_f32 v76, v76, v77
    v_cvt_pk_bf16_f32 v77, v78, v79
    ds_wrxchg_rtn_b64 v[72:73], v92, v[76:77] offset:65408
    s_setprio 0
    s_waitcnt vmcnt(7)
    ds_write_addtid_b32 v112 offset:1024
    ds_write_addtid_b32 v113 offset:1280
    ds_write_addtid_b32 v114 offset:1536
    ds_write_addtid_b32 v115 offset:1792
    v_mfma_f32_4x4x4_16b_bf16 v[80:83], v[8:9], v[106:107], 0
    v_mfma_f32_4x4x4_16b_bf16 v[76:79], v[8:9], v[104:105], 0
    v_bitop3_b32 v15, v6, v15, v46 bitop3:0xca
    v_bitop3_b32 v14, v6, v14, v47 bitop3:0xca
    s_nop 1
    v_pk_mul_f32 v[80:81], v[80:81], v[14:15] op_sel:[0,1] op_sel_hi:[1,1]
    v_pk_mul_f32 v[82:83], v[82:83], v[14:15] op_sel:[0,1] op_sel_hi:[1,1]
    v_pk_mul_f32 v[76:77], v[76:77], v[14:15] op_sel:[0,0] op_sel_hi:[1,0]
    v_pk_mul_f32 v[78:79], v[78:79], v[14:15] op_sel:[0,0] op_sel_hi:[1,0]
    s_add_u32 s42, s42, 1
    s_waitcnt lgkmcnt(0)
    s_barrier
    s_bitcmp1_b32 s36, s42
    s_cbranch_scc1 L2_slow
L2_ret4:
    s_setprio 3
    v_and_b32 v47, 0x0fffffff, v44
    v_mov_b32 v39, v44
    buffer_load_dwordx2 v[34:35], v47, s[8:11], 0 offen
    buffer_load_dwordx3 v[36:38], v47, s[8:11], 0 offen offset:8
    v_cmpx_ne_u64 vcc, v[74:75], v[70:71]
    s_and_b64 s[82:83], vcc, s[80:81]
    s_cbranch_scc1 L2_c75
L2_d75:
    v_mov_b64 v[84:85], v[70:71]
    v_mov_b32 v7, v93
    v_mov_b64 v[86:87], v[74:75]
    s_mov_b64 exec, -1
    s_or_b64 s[80:81], s[80:81], vcc
    v_cmpx_ne_u64 vcc, v[72:73], v[68:69]
    s_and_b64 s[82:83], vcc, s[80:81]
    s_cbranch_scc1 L2_c76
L2_d76:
    v_mov_b64 v[84:85], v[68:69]
    v_mov_b32 v7, v92
    v_mov_b64 v[86:87], v[72:73]
    s_mov_b64 exec, -1
    s_or_b64 s[80:81], s[80:81], vcc
    ds_read_b64 v[70:71], v95 offset:65408
    ds_read_b64 v[68:69], v94 offset:65408
    v_and_b32 v46, 0x20000000, v21
    v_lshrrev_b32 v47, 14, v17
    v_bitop3_b32 v47, v47, v5, v46 bitop3:0xea
    ds_read_b64 v[102:103], v47
    v_bitop3_b32 v93, v17, v5, v46 bitop3:0xea
    v_and_b32 v46, 0x10000000, v21
    v_lshrrev_b32 v47, 14, v16
    v_bitop3_b32 v47, v47, v5, v46 bitop3:0xea
    ds_read_b64 v[100:101], v47
    v_bitop3_b32 v92, v16, v5, v46 bitop3:0xea
    s_waitcnt lgkmcnt(2)
    v_mfma_f32_4x4x4_16b_bf16 v[80:83], v[10:11], v[70:71], v[80:83]
    v_mfma_f32_4x4x4_16b_bf16 v[76:79], v[10:11], v[68:69], v[76:79]
    v_perm_b32 v15, v17, v20, s45
    v_bitop3_b32 v46, v17, 0.5, -0.5 bitop3:0xa8
    v_perm_b32 v14, v16, v20, s44
    v_bitop3_b32 v47, v16, 0.5, -0.5 bitop3:0xa8
    v_cvt_pk_bf16_f32 v80, v80, v81
    v_cvt_pk_bf16_f32 v81, v82, v83
    ds_wrxchg_rtn_b64 v[74:75], v95, v[80:81] offset:65408
    v_cvt_pk_bf16_f32 v76, v76, v77
    v_cvt_pk_bf16_f32 v77, v78, v79
    ds_wrxchg_rtn_b64 v[72:73], v94, v[76:77] offset:65408
    s_waitcnt lgkmcnt(2)
    v_mfma_f32_4x4x4_16b_bf16 v[80:83], v[8:9], v[102:103], 0
    v_mfma_f32_4x4x4_16b_bf16 v[76:79], v[8:9], v[100:101], 0
    v_bitop3_b32 v15, v6, v15, v46 bitop3:0xca
    v_bitop3_b32 v14, v6, v14, v47 bitop3:0xca
    v_cmp_lt_u32 s[84:85], v5, v92
    s_nop 0
    v_pk_mul_f32 v[80:81], v[80:81], v[14:15] op_sel:[0,1] op_sel_hi:[1,1]
    v_pk_mul_f32 v[82:83], v[82:83], v[14:15] op_sel:[0,1] op_sel_hi:[1,1]
    v_pk_mul_f32 v[76:77], v[76:77], v[14:15] op_sel:[0,0] op_sel_hi:[1,0]
    v_pk_mul_f32 v[78:79], v[78:79], v[14:15] op_sel:[0,0] op_sel_hi:[1,0]
    buffer_load_dwordx4 v[108:111], v3, s[16:19], s40 offen offset:0
    s_waitcnt lgkmcnt(0)
    v_cmpx_ne_u64 vcc, v[74:75], v[70:71]
    s_and_b64 s[82:83], vcc, s[80:81]
    s_cbranch_scc1 L2_c77
L2_d77:
    v_mov_b64 v[84:85], v[70:71]
    v_mov_b32 v7, v95
    v_mov_b64 v[86:87], v[74:75]
    s_mov_b64 exec, -1
    s_or_b64 s[80:81], s[80:81], vcc
    v_cmpx_ne_u64 vcc, v[72:73], v[68:69]
    s_and_b64 s[82:83], vcc, s[80:81]
    s_cbranch_scc1 L2_c78
L2_d78:
    v_mov_b64 v[84:85], v[68:69]
    v_mov_b32 v7, v94
    v_mov_b64 v[86:87], v[72:73]
    s_mov_b64 exec, -1
    s_or_b64 s[80:81], s[80:81], vcc
    ds_read_b64 v[70:71], v93 offset:65408
    s_and_b64 exec, s[84:85], s[80:81]
    v_mfma_f32_4x4x4_16b_bf16 v[76:79], v[12:13], v[84:85], 0
    v_mov_b32 v92, v7
    s_andn2_b64 s[80:81], s[80:81], s[84:85]
    v_mfma_f32_4x4x4_16b_bf16 v[76:79], v[10:11], v[86:87], v[76:79]
    s_mov_b64 exec, -1
    ds_read_b64 v[68:69], v92 offset:65408
    v_and_b32 v46, 0x80000000, v21
    v_lshrrev_b32 v47, 14, v19
    v_bitop3_b32 v47, v47, v5, v46 bitop3:0xea
    ds_read_b64 v[106:107], v47
    v_bitop3_b32 v95, v19, v5, v46 bitop3:0xea
    v_and_b32 v46, 0x40000000, v21
    v_lshrrev_b32 v47, 14, v18
    v_bitop3_b32 v47, v47, v5, v46 bitop3:0xea
    ds_read_b64 v[104:105], v47
    v_bitop3_b32 v94, v18, v5, v46 bitop3:0xea
    s_waitcnt lgkmcnt(2)
    v_mfma_f32_4x4x4_16b_bf16 v[80:83], v[10:11], v[70:71], v[80:83]
    v_mfma_f32_4x4x4_16b_bf16 v[76:79], v[10:11], v[68:69], v[76:79]
    v_perm_b32 v15, v19, v20, s47
    v_bitop3_b32 v46, v19, 0.5, -0.5 bitop3:0xa8
    v_perm_b32 v14, v18, v20, s46
    v_bitop3_b32 v47, v18, 0.5, -0.5 bitop3:0xa8
    v_cvt_pk_bf16_f32 v80, v80, v81
    v_cvt_pk_bf16_f32 v81, v82, v83
    ds_wrxchg_rtn_b64 v[74:75], v93, v[80:81] offset:65408
    v_cvt_pk_bf16_f32 v76, v76, v77
    v_cvt_pk_bf16_f32 v77, v78, v79
    ds_wrxchg_rtn_b64 v[72:73], v92, v[76:77] offset:65408
    s_setprio 2
    s_waitcnt lgkmcnt(2)
    v_mfma_f32_4x4x4_16b_bf16 v[80:83], v[8:9], v[106:107], 0
    v_mfma_f32_4x4x4_16b_bf16 v[76:79], v[8:9], v[104:105], 0
    v_bitop3_b32 v15, v6, v15, v46 bitop3:0xca
    v_bitop3_b32 v14, v6, v14, v47 bitop3:0xca
    s_nop 1
    v_pk_mul_f32 v[80:81], v[80:81], v[14:15] op_sel:[0,1] op_sel_hi:[1,1]
    v_pk_mul_f32 v[82:83], v[82:83], v[14:15] op_sel:[0,1] op_sel_hi:[1,1]
    v_pk_mul_f32 v[76:77], v[76:77], v[14:15] op_sel:[0,0] op_sel_hi:[1,0]
    v_pk_mul_f32 v[78:79], v[78:79], v[14:15] op_sel:[0,0] op_sel_hi:[1,0]
    v_and_b32 v47, 0x0fffffff, v40
    v_mov_b32 v21, v40
    buffer_load_dwordx2 v[16:17], v47, s[8:11], 0 offen
    buffer_load_dwordx3 v[18:20], v47, s[8:11], 0 offen offset:8
    s_waitcnt lgkmcnt(0)
    v_cmpx_ne_u64 vcc, v[74:75], v[70:71]
    s_and_b64 s[82:83], vcc, s[80:81]
    s_cbranch_scc1 L2_c79
L2_d79:
    v_mov_b64 v[84:85], v[70:71]
    v_mov_b32 v7, v93
    v_mov_b64 v[86:87], v[74:75]
    s_mov_b64 exec, -1
    s_or_b64 s[80:81], s[80:81], vcc
    v_cmpx_ne_u64 vcc, v[72:73], v[68:69]
    s_and_b64 s[82:83], vcc, s[80:81]
    s_cbranch_scc1 L2_c80
L2_d80:
    v_mov_b64 v[84:85], v[68:69]
    v_mov_b32 v7, v92
    v_mov_b64 v[86:87], v[72:73]
    s_mov_b64 exec, -1
    s_or_b64 s[80:81], s[80:81], vcc
    ds_read_b64 v[70:71], v95 offset:65408
    ds_read_b64 v[68:69], v94 offset:65408
    s_waitcnt vmcnt(10)
    v_and_b32 v46, 0x20000000, v27
    v_lshrrev_b32 v47, 14, v23
    v_bitop3_b32 v47, v47, v5, v46 bitop3:0xea
    ds_read_b64 v[102:103], v47
    v_bitop3_b32 v93, v23, v5, v46 bitop3:0xea
    v_and_b32 v46, 0x10000000, v27
    v_lshrrev_b32 v47, 14, v22
    v_bitop3_b32 v47, v47, v5, v46 bitop3:0xea
    ds_read_b64 v[100:101], v47
    v_bitop3_b32 v92, v22, v5, v46 bitop3:0xea
    s_waitcnt lgkmcnt(2)
    v_mfma_f32_4x4x4_16b_bf16 v[80:83], v[10:11], v[70:71], v[80:83]
    v_mfma_f32_4x4x4_16b_bf16 v[76:79], v[10:11], v[68:69], v[76:79]
    v_perm_b32 v15, v23, v26, s45
    v_bitop3_b32 v46, v23, 0.5, -0.5 bitop3:0xa8
    v_perm_b32 v14, v22, v26, s44
    v_bitop3_b32 v47, v22, 0.5, -0.5 bitop3:0xa8
    v_cvt_pk_bf16_f32 v80, v80, v81
    v_cvt_pk_bf16_f32 v81, v82, v83
    ds_wrxchg_rtn_b64 v[74:75], v95, v[80:81] offset:65408
    v_cvt_pk_bf16_f32 v76, v76, v77
    v_cvt_pk_bf16_f32 v77, v78, v79
    ds_wrxchg_rtn_b64 v[72:73], v94, v[76:77] offset:65408
    s_waitcnt lgkmcnt(2)
    v_mfma_f32_4x4x4_16b_bf16 v[80:83], v[8:9], v[102:103], 0
    v_mfma_f32_4x4x4_16b_bf16 v[76:79], v[8:9], v[100:101], 0
    v_bitop3_b32 v15, v6, v15, v46 bitop3:0xca
    v_bitop3_b32 v14, v6, v14, v47 bitop3:0xca
    v_cmp_lt_u32 s[84:85], v5, v92
    s_nop 0
    v_pk_mul_f32 v[80:81], v[80:81], v[14:15] op_sel:[0,1] op_sel_hi:[1,1]
    v_pk_mul_f32 v[82:83], v[82:83], v[14:15] op_sel:[0,1] op_sel_hi:[1,1]
    v_pk_mul_f32 v[76:77], v[76:77], v[14:15] op_sel:[0,0] op_sel_hi:[1,0]
    v_pk_mul_f32 v[78:79], v[78:79], v[14:15] op_sel:[0,0] op_sel_hi:[1,0]
    v_sub_u16 v88, v60, v52
    v_and_b32 v89, 3, v52
    v_add3_u32 v99, v88, v89, 3
    v_and_b32 v99, -4, v99
    v_max_u32 v99, 4, v99
    v_and_b32 v97, 0xfffc, v52
    v_bfm_b32 v96, v88, v89
    v_add_u32_dpp v91, v99, v99 row_shr:1 row_mask:0xf bank_mask:0xf bound_ctrl:1
    v_mad_u32_u24 v97, v97, 5, v2
    v_cmp_lt_u32 vcc, 16, v99
    v_add_u32_dpp v91, v91, v91 row_shr:2 row_mask:0xf bank_mask:0xf bound_ctrl:1
    v_sub_u32 v98, s38, v99
    v_lshrrev_b64 v[52:53], 16, v[52:53]
    v_add_u32_dpp v91, v91, v91 row_shr:4 row_mask:0xf bank_mask:0xf bound_ctrl:1
    v_lshrrev_b64 v[60:61], 16, v[60:61]
    s_mov_b32 s43, 0
    v_add_u32_dpp v91, v91, v91 row_shr:8 row_mask:0xf bank_mask:0xf bound_ctrl:1
    s_nop 1
    v_add_u32_dpp v91, v91, v91 row_bcast:15 row_mask:0xa bank_mask:0xf
    s_nop 1
    v_add_u32_dpp v91, v91, v91 row_bcast:31 row_mask:0xc bank_mask:0xf
    v_add_u32 v98, v98, v91
    v_readlane_b32 s37, v91, 63
    s_cbranch_vccnz L2_xo81
L2_xp81:
    buffer_load_dwordx4 v[112:115], v3, s[16:19], s40 offen offset:1024
    s_waitcnt lgkmcnt(0)
    v_cmpx_ne_u64 vcc, v[74:75], v[70:71]
    s_and_b64 s[82:83], vcc, s[80:81]
    s_cbranch_scc1 L2_c82
L2_d82:
    v_mov_b64 v[84:85], v[70:71]
    v_mov_b32 v7, v95
    v_mov_b64 v[86:87], v[74:75]
    s_mov_b64 exec, -1
    s_or_b64 s[80:81], s[80:81], vcc
    v_cmpx_ne_u64 vcc, v[72:73], v[68:69]
    s_and_b64 s[82:83], vcc, s[80:81]
    s_cbranch_scc1 L2_c83
L2_d83:
    v_mov_b64 v[84:85], v[68:69]
    v_mov_b32 v7, v94
    v_mov_b64 v[86:87], v[72:73]
    s_mov_b64 exec, -1
    s_or_b64 s[80:81], s[80:81], vcc
    ds_read_b64 v[70:71], v93 offset:65408
    s_and_b64 exec, s[84:85], s[80:81]
    v_mfma_f32_4x4x4_16b_bf16 v[76:79], v[12:13], v[84:85], 0
    v_mov_b32 v92, v7
    s_andn2_b64 s[80:81], s[80:81], s[84:85]
    v_mfma_f32_4x4x4_16b_bf16 v[76:79], v[10:11], v[86:87], v[76:79]
    s_mov_b64 exec, -1
    ds_read_b64 v[68:69], v92 offset:65408
    v_and_b32 v46, 0x80000000, v27
    v_lshrrev_b32 v47, 14, v25
    v_bitop3_b32 v47, v47, v5, v46 bitop3:0xea
    ds_read_b64 v[106:107], v47
    v_bitop3_b32 v95, v25, v5, v46 bitop3:0xea
    v_and_b32 v46, 0x40000000, v27
    v_lshrrev_b32 v47, 14, v24
    v_bitop3_b32 v47, v47, v5, v46 bitop3:0xea
    ds_read_b64 v[104:105], v47
    v_bitop3_b32 v94, v24, v5, v46 bitop3:0xea
    s_waitcnt lgkmcnt(2)
    v_mfma_f32_4x4x4_16b_bf16 v[80:83], v[10:11], v[70:71], v[80:83]
    v_mfma_f32_4x4x4_16b_bf16 v[76:79], v[10:11], v[68:69], v[76:79]
    v_perm_b32 v15, v25, v26, s47
    v_bitop3_b32 v46, v25, 0.5, -0.5 bitop3:0xa8
    v_perm_b32 v14, v24, v26, s46
    v_bitop3_b32 v47, v24, 0.5, -0.5 bitop3:0xa8
    v_cvt_pk_bf16_f32 v80, v80, v81
    v_cvt_pk_bf16_f32 v81, v82, v83
    ds_wrxchg_rtn_b64 v[74:75], v93, v[80:81] offset:65408
    v_cvt_pk_bf16_f32 v76, v76, v77
    v_cvt_pk_bf16_f32 v77, v78, v79
    ds_wrxchg_rtn_b64 v[72:73], v92, v[76:77] offset:65408
    s_setprio 1
    s_waitcnt lgkmcnt(2)
    v_mfma_f32_4x4x4_16b_bf16 v[80:83], v[8:9], v[106:107], 0
    v_mfma_f32_4x4x4_16b_bf16 v[76:79], v[8:9], v[104:105], 0
    v_bitop3_b32 v15, v6, v15, v46 bitop3:0xca
    v_bitop3_b32 v14, v6, v14, v47 bitop3:0xca
    s_nop 1
    v_pk_mul_f32 v[80:81], v[80:81], v[14:15] op_sel:[0,1] op_sel_hi:[1,1]
    v_pk_mul_f32 v[82:83], v[82:83], v[14:15] op_sel:[0,1] op_sel_hi:[1,1]
    v_pk_mul_f32 v[76:77], v[76:77], v[14:15] op_sel:[0,0] op_sel_hi:[1,0]
    v_pk_mul_f32 v[78:79], v[78:79], v[14:15] op_sel:[0,0] op_sel_hi:[1,0]
    v_and_b32 v47, 0x0fffffff, v41
    v_mov_b32 v27, v41
    buffer_load_dwordx2 v[22:23], v47, s[8:11], 0 offen
    buffer_load_dwordx3 v[24:26], v47, s[8:11], 0 offen offset:8
    s_waitcnt lgkmcnt(0)
    v_cmpx_ne_u64 vcc, v[74:75], v[70:71]
    s_and_b64 s[82:83], vcc, s[80:81]
    s_cbranch_scc1 L2_c84
L2_d84:
    v_mov_b64 v[84:85], v[70:71]
    v_mov_b32 v7, v93
    v_mov_b64 v[86:87], v[74:75]
    s_mov_b64 exec, -1
    s_or_b64 s[80:81], s[80:81], vcc
    v_cmpx_ne_u64 vcc, v[72:73], v[68:69]
    s_and_b64 s[82:83], vcc, s[80:81]
    s_cbranch_scc1 L2_c85
L2_d85:
    v_mov_b64 v[84:85], v[68:69]
    v_mov_b32 v7, v92
    v_mov_b64 v[86:87], v[72:73]
    s_mov_b64 exec, -1
    s_or_b64 s[80:81], s[80:81], vcc
    ds_read_b64 v[70:71], v95 offset:65408
    ds_read_b64 v[68:69], v94 offset:65408
    s_waitcnt vmcnt(11)
    v_and_b32 v46, 0x20000000, v33
    v_lshrrev_b32 v47, 14, v29
    v_bitop3_b32 v47, v47, v5, v46 bitop3:0xea
    ds_read_b64 v[102:103], v47
    v_bitop3_b32 v93, v29, v5, v46 bitop3:0xea
    v_and_b32 v46, 0x10000000, v33
    v_lshrrev_b32 v47, 14, v28
    v_bitop3_b32 v47, v47, v5, v46 bitop3:0xea
    ds_read_b64 v[100:101], v47
    v_bitop3_b32 v92, v28, v5, v46 bitop3:0xea
    s_waitcnt lgkmcnt(2)
    v_mfma_f32_4x4x4_16b_bf16 v[80:83], v[10:11], v[70:71], v[80:83]
    v_mfma_f32_4x4x4_16b_bf16 v[76:79], v[10:11], v[68:69], v[76:79]
    v_perm_b32 v15, v29, v32, s45
    v_bitop3_b32 v46, v29, 0.5, -0.5 bitop3:0xa8
    v_perm_b32 v14, v28, v32, s44
    v_bitop3_b32 v47, v28, 0.5, -0.5 bitop3:0xa8
    v_cvt_pk_bf16_f32 v80, v80, v81
    v_cvt_pk_bf16_f32 v81, v82, v83
    ds_wrxchg_rtn_b64 v[74:75], v95, v[80:81] offset:65408
    v_cvt_pk_bf16_f32 v76, v76, v77
    v_cvt_pk_bf16_f32 v77, v78, v79
    ds_wrxchg_rtn_b64 v[72:73], v94, v[76:77] offset:65408
    s_waitcnt lgkmcnt(2)
    v_mfma_f32_4x4x4_16b_bf16 v[80:83], v[8:9], v[102:103], 0
    v_mfma_f32_4x4x4_16b_bf16 v[76:79], v[8:9], v[100:101], 0
    v_bitop3_b32 v15, v6, v15, v46 bitop3:0xca
    v_bitop3_b32 v14, v6, v14, v47 bitop3:0xca
    v_cmp_lt_u32 s[84:85], v5, v92
    s_nop 0
    v_pk_mul_f32 v[80:81], v[80:81], v[14:15] op_sel:[0,1] op_sel_hi:[1,1]
    v_pk_mul_f32 v[82:83], v[82:83], v[14:15] op_sel:[0,1] op_sel_hi:[1,1]
    v_pk_mul_f32 v[76:77], v[76:77], v[14:15] op_sel:[0,0] op_sel_hi:[1,0]
    v_pk_mul_f32 v[78:79], v[78:79], v[14:15] op_sel:[0,0] op_sel_hi:[1,0]
    s_waitcnt lgkmcnt(0)
    v_cmpx_ne_u64 vcc, v[74:75], v[70:71]
    s_and_b64 s[82:83], vcc, s[80:81]
    s_cbranch_scc1 L2_c86
L2_d86:
    v_mov_b64 v[84:85], v[70:71]
    v_mov_b32 v7, v95
    v_mov_b64 v[86:87], v[74:75]
    s_mov_b64 exec, -1
    s_or_b64 s[80:81], s[80:81], vcc
    v_cmpx_ne_u64 vcc, v[72:73], v[68:69]
    s_and_b64 s[82:83], vcc, s[80:81]
    s_cbranch_scc1 L2_c87
L2_d87:
    v_mov_b64 v[84:85], v[68:69]
    v_mov_b32 v7, v94
    v_mov_b64 v[86:87], v[72:73]
    s_mov_b64 exec, -1
    s_or_b64 s[80:81], s[80:81], vcc
    ds_read_b64 v[70:71], v93 offset:65408
    s_and_b64 exec, s[84:85], s[80:81]
    v_mfma_f32_4x4x4_16b_bf16 v[76:79], v[12:13], v[84:85], 0
    v_mov_b32 v92, v7
    s_andn2_b64 s[80:81], s[80:81], s[84:85]
    v_mfma_f32_4x4x4_16b_bf16 v[76:79], v[10:11], v[86:87], v[76:79]
    s_mov_b64 exec, -1
    ds_read_b64 v[68:69], v92 offset:65408
    v_and_b32 v46, 0x80000000, v33
    v_lshrrev_b32 v47, 14, v31
    v_bitop3_b32 v47, v47, v5, v46 bitop3:0xea
    ds_read_b64 v[106:107], v47
    v_bitop3_b32 v95, v31, v5, v46 bitop3:0xea
    v_and_b32 v46, 0x40000000, v33
    v_lshrrev_b32 v47, 14, v30
    v_bitop3_b32 v47, v47, v5, v46 bitop3:0xea
    ds_read_b64 v[104:105], v47
    v_bitop3_b32 v94, v30, v5, v46 bitop3:0xea
    s_waitcnt lgkmcnt(2)
    v_mfma_f32_4x4x4_16b_bf16 v[80:83], v[10:11], v[70:71], v[80:83]
    v_mfma_f32_4x4x4_16b_bf16 v[76:79], v[10:11], v[68:69], v[76:79]
    v_perm_b32 v15, v31, v32, s47
    v_bitop3_b32 v46, v31, 0.5, -0.5 bitop3:0xa8
    v_perm_b32 v14, v30, v32, s46
    v_bitop3_b32 v47, v30, 0.5, -0.5 bitop3:0xa8
    v_cvt_pk_bf16_f32 v80, v80, v81
    v_cvt_pk_bf16_f32 v81, v82, v83
    ds_wrxchg_rtn_b64 v[74:75], v93, v[80:81] offset:65408
    v_cvt_pk_bf16_f32 v76, v76, v77
    v_cvt_pk_bf16_f32 v77, v78, v79
    ds_wrxchg_rtn_b64 v[72:73], v92, v[76:77] offset:65408
    s_setprio 0
    s_waitcnt lgkmcnt(2)
    v_mfma_f32_4x4x4_16b_bf16 v[80:83], v[8:9], v[106:107], 0
    v_mfma_f32_4x4x4_16b_bf16 v[76:79], v[8:9], v[104:105], 0
    v_bitop3_b32 v15, v6, v15, v46 bitop3:0xca
    v_bitop3_b32 v14, v6, v14, v47 bitop3:0xca
    s_nop 1
    v_pk_mul_f32 v[80:81], v[80:81], v[14:15] op_sel:[0,1] op_sel_hi:[1,1]
    v_pk_mul_f32 v[82:83], v[82:83], v[14:15] op_sel:[0,1] op_sel_hi:[1,1]
    v_pk_mul_f32 v[76:77], v[76:77], v[14:15] op_sel:[0,0] op_sel_hi:[1,0]
    v_pk_mul_f32 v[78:79], v[78:79], v[14:15] op_sel:[0,0] op_sel_hi:[1,0]
    s_add_u32 s40, s40, 0x50000
    v_and_b32 v47, 0x0fffffff, v42
    v_mov_b32 v33, v42
    buffer_load_dwordx2 v[28:29], v47, s[8:11], 0 offen
    buffer_load_dwordx3 v[30:32], v47, s[8:11], 0 offen offset:8
    s_waitcnt lgkmcnt(0)
    v_cmpx_ne_u64 vcc, v[74:75], v[70:71]
    s_and_b64 s[82:83], vcc, s[80:81]
    s_cbranch_scc1 L2_c88
L2_d88:
    v_mov_b64 v[84:85], v[70:71]
    v_mov_b32 v7, v93
    v_mov_b64 v[86:87], v[74:75]
    s_mov_b64 exec, -1
    s_or_b64 s[80:81], s[80:81], vcc
    v_cmpx_ne_u64 vcc, v[72:73], v[68:69]
    s_and_b64 s[82:83], vcc, s[80:81]
    s_cbranch_scc1 L2_c89
L2_d89:
    v_mov_b64 v[84:85], v[68:69]
    v_mov_b32 v7, v92
    v_mov_b64 v[86:87], v[72:73]
    s_mov_b64 exec, -1
    s_or_b64 s[80:81], s[80:81], vcc
    ds_read_b64 v[70:71], v95 offset:65408
    ds_read_b64 v[68:69], v94 offset:65408
    s_waitcnt vmcnt(8)
    v_and_b32 v46, 0x20000000, v39
    v_lshrrev_b32 v47, 14, v35
    v_bitop3_b32 v47, v47, v5, v46 bitop3:0xea
    ds_read_b64 v[102:103], v47
    v_bitop3_b32 v93, v35, v5, v46 bitop3:0xea
    v_and_b32 v46, 0x10000000, v39
    v_lshrrev_b32 v47, 14, v34
    v_bitop3_b32 v47, v47, v5, v46 bitop3:0xea
    ds_read_b64 v[100:101], v47
    v_bitop3_b32 v92, v34, v5, v46 bitop3:0xea
    v_and_b32 v46, 0x80000000, v39
    v_lshrrev_b32 v47, 14, v37
    v_bitop3_b32 v47, v47, v5, v46 bitop3:0xea
    ds_read_b64 v[106:107], v47
    v_and_b32 v46, 0x40000000, v39
    v_lshrrev_b32 v47, 14, v36
    v_bitop3_b32 v47, v47, v5, v46 bitop3:0xea
    ds_read_b64 v[104:105], v47
    s_waitcnt lgkmcnt(4)
    v_mfma_f32_4x4x4_16b_bf16 v[80:83], v[10:11], v[70:71], v[80:83]
    v_mfma_f32_4x4x4_16b_bf16 v[76:79], v[10:11], v[68:69], v[76:79]
    v_perm_b32 v15, v35, v38, s45
    v_bitop3_b32 v46, v35, 0.5, -0.5 bitop3:0xa8
    v_perm_b32 v14, v34, v38, s44
    v_bitop3_b32 v47, v34, 0.5, -0.5 bitop3:0xa8
    v_cvt_pk_bf16_f32 v80, v80, v81
    v_cvt_pk_bf16_f32 v81, v82, v83
    ds_wrxchg_rtn_b64 v[74:75], v95, v[80:81] offset:65408
    v_cvt_pk_bf16_f32 v76, v76, v77
    v_cvt_pk_bf16_f32 v77, v78, v79
    ds_wrxchg_rtn_b64 v[72:73], v94, v[76:77] offset:65408
    s_waitcnt lgkmcnt(2)
    s_barrier
    s_setprio 3
    s_mov_b32 m0, s69
    s_nop 0
    ds_write_addtid_b32 v116 offset:32768
    ds_write_addtid_b32 v117 offset:33024
    ds_write_addtid_b32 v118 offset:33280
    ds_write_addtid_b32 v119 offset:33536
    buffer_load_dwordx4 v[116:119], v3, s[16:19], s40 offen offset:2048
    ds_write_addtid_b32 v120 offset:33792
    ds_write_addtid_b32 v121 offset:34048
    ds_write_addtid_b32 v122 offset:34304
    ds_write_addtid_b32 v123 offset:34560
    buffer_load_dwordx4 v[120:123], v3, s[16:19], s40 offen offset:3072
    v_mfma_f32_4x4x4_16b_bf16 v[80:83], v[8:9], v[102:103], 0
    v_mfma_f32_4x4x4_16b_bf16 v[76:79], v[8:9], v[100:101], 0
    v_bitop3_b32 v15, v6, v15, v46 bitop3:0xca
    v_bitop3_b32 v14, v6, v14, v47 bitop3:0xca
    v_cmp_lt_u32 s[84:85], v5, v92
    s_nop 0
    v_pk_mul_f32 v[80:81], v[80:81], v[14:15] op_sel:[0,1] op_sel_hi:[1,1]
    v_pk_mul_f32 v[82:83], v[82:83], v[14:15] op_sel:[0,1] op_sel_hi:[1,1]
    v_pk_mul_f32 v[76:77], v[76:77], v[14:15] op_sel:[0,0] op_sel_hi:[1,0]
    v_pk_mul_f32 v[78:79], v[78:79], v[14:15] op_sel:[0,0] op_sel_hi:[1,0]
    v_mov_b32 v44, v43
    s_cmp_gt_u32 s37, 1024
    s_cbranch_scc1 L2_xs90
    s_cmp_lg_u32 s43, 0
    s_cbranch_scc1 L2_xa90
L2_xb90:
    v_lshlrev_b32 v89, 16, v96
    v_add_u32 v90, 60, v97
    v_bitop3_b32 v90, v89, v45, v90 bitop3:0x6a
    ds_write_b32 v98, v90 offset:12
    v_lshlrev_b32 v89, 20, v96
    v_add_u32 v90, 40, v97
    v_bitop3_b32 v90, v89, v45, v90 bitop3:0x6a
    ds_write_b32 v98, v90 offset:8
    v_lshlrev_b32 v89, 24, v96
    v_add_u32 v90, 20, v97
    v_bitop3_b32 v90, v89, v45, v90 bitop3:0x6a
    ds_write_b32 v98, v90 offset:4
    v_lshlrev_b32 v89, 28, v96
    v_bitop3_b32 v90, v89, v45, v97 bitop3:0x6a
    ds_write_b32 v98, v90 offset:0
    v_mov_b32_dpp v91, v64 quad_perm:[1,1,1,1] row_mask:0xf bank_mask:0xf
    v_and_b32 v89, 3, v91
    v_and_b32 v97, 0xfffc, v91
    v_sub_u16_dpp v88, v64, v91 quad_perm:[3,3,3,3] row_mask:0xf bank_mask:0xf
    v_mad_u32_u24 v97, v97, 5, v4
    v_add_u32 v99, v88, v89
    v_bfm_b32 v96, v88, v89
    v_cmp_lt_u32 s[58:59], 16, v99
    v_lshlrev_b32 v89, v1, v96
    v_and_b32 v89, v45, v89
    v_cmp_ne_u32 vcc, 0, v89
    v_xor_b32 v90, v97, v89
    s_add_u32 s3, s37, s38
    v_mbcnt_lo_u32_b32 v98, vcc_lo, 0
    v_mbcnt_hi_u32_b32 v98, vcc_hi, v98
    s_bcnt1_i32_b64 s41, vcc
    v_lshl_add_u32 v98, v98, 2, s3
    s_mov_b64 exec, vcc
    ds_write_b32 v98, v90
    s_mov_b64 exec, -1
    s_lshl2_add_u32 s37, s41, s37
    s_cmp_lg_u64 s[58:59], 0
    s_cbranch_scc1 L2_xe90
L2_xr90:
    v_add_u32 v98, s37, v0
    v_mov_b32 v90, -1
    ds_write_b32 v98, v90
    ds_read2st64_b32 v[40:41], v0 offset0:0 offset1:1
    ds_read2st64_b32 v[42:43], v0 offset0:2 offset1:3
    s_sub_u32 s3, s37, 768
    s_cmp_gt_u32 s3, 256
    s_cbranch_scc1 L2_xf90
L2_xg90:
    s_setprio 2
    ds_write_addtid_b32 v124 offset:34816
    ds_write_addtid_b32 v125 offset:35072
    ds_write_addtid_b32 v126 offset:35328
    ds_write_addtid_b32 v127 offset:35584
    s_add_u32 s3, s40, 4096
    buffer_load_dwordx4 v[124:127], v3, s[16:19], s3 offen
    s_waitcnt lgkmcnt(14)
    v_cmpx_ne_u64 vcc, v[74:75], v[70:71]
    s_and_b64 s[82:83], vcc, s[80:81]
    s_cbranch_scc1 L2_c91
L2_d91:
    v_mov_b64 v[84:85], v[70:71]
    v_mov_b32 v7, v95
    v_mov_b64 v[86:87], v[74:75]
    s_mov_b64 exec, -1
    s_or_b64 s[80:81], s[80:81], vcc
    v_cmpx_ne_u64 vcc, v[72:73], v[68:69]
    s_and_b64 s[82:83], vcc, s[80:81]
    s_cbranch_scc1 L2_c92
L2_d92:
    v_mov_b64 v[84:85], v[68:69]
    v_mov_b32 v7, v94
    v_mov_b64 v[86:87], v[72:73]
    s_mov_b64 exec, -1
    s_or_b64 s[80:81], s[80:81], vcc
    ds_read_b64 v[70:71], v93 offset:65408
    s_and_b64 exec, s[84:85], s[80:81]
    v_mfma_f32_4x4x4_16b_bf16 v[76:79], v[12:13], v[84:85], 0
    v_mov_b32 v92, v7
    s_andn2_b64 s[80:81], s[80:81], s[84:85]
    v_mfma_f32_4x4x4_16b_bf16 v[76:79], v[10:11], v[86:87], v[76:79]
    s_mov_b64 exec, -1
    ds_read_b64 v[68:69], v92 offset:65408
    s_setprio 1
    s_waitcnt vmcnt(10)
    s_mov_b32 m0, s38
    s_nop 0
    ds_write_addtid_b32 v108 offset:0
    ds_write_addtid_b32 v109 offset:256
    ds_write_addtid_b32 v110 offset:512
    ds_write_addtid_b32 v111 offset:768
    s_waitcnt lgkmcnt(4)
    v_mfma_f32_4x4x4_16b_bf16 v[80:83], v[10:11], v[70:71], v[80:83]
    v_mfma_f32_4x4x4_16b_bf16 v[76:79], v[10:11], v[68:69], v[76:79]
    v_and_b32 v46, 0x40000000, v39
    v_bitop3_b32 v94, v36, v5, v46 bitop3:0xea
    v_and_b32 v46, 0x80000000, v39
    v_bitop3_b32 v95, v37, v5, v46 bitop3:0xea
    v_perm_b32 v15, v37, v38, s47
    v_bitop3_b32 v46, v37, 0.5, -0.5 bitop3:0xa8
    v_perm_b32 v14, v36, v38, s46
    v_bitop3_b32 v47, v36, 0.5, -0.5 bitop3:0xa8
    v_cvt_pk_bf16_f32 v80, v80, v81
    v_cvt_pk_bf16_f32 v81, v82, v83
    ds_wrxchg_rtn_b64 v[74:75], v93, v[80:81] offset:65408
    v_cvt_pk_bf16_f32 v76, v76, v77
    v_cvt_pk_bf16_f32 v77, v78, v79
    ds_wrxchg_rtn_b64 v[72:73], v92, v[76:77] offset:65408
    s_setprio 0
    s_waitcnt vmcnt(7)
    ds_write_addtid_b32 v112 offset:1024
    ds_write_addtid_b32 v113 offset:1280
    ds_write_addtid_b32 v114 offset:1536
    ds_write_addtid_b32 v115 offset:1792
    v_mfma_f32_4x4x4_16b_bf16 v[80:83], v[8:9], v[106:107], 0
    v_mfma_f32_4x4x4_16b_bf16 v[76:79], v[8:9], v[104:105], 0
    v_bitop3_b32 v15, v6, v15, v46 bitop3:0xca
    v_bitop3_b32 v14, v6, v14, v47 bitop3:0xca
    s_nop 1
    v_pk_mul_f32 v[80:81], v[80:81], v[14:15] op_sel:[0,1] op_sel_hi:[1,1]
    v_pk_mul_f32 v[82:83], v[82:83], v[14:15] op_sel:[0,1] op_sel_hi:[1,1]
    v_pk_mul_f32 v[76:77], v[76:77], v[14:15] op_sel:[0,0] op_sel_hi:[1,0]
    v_pk_mul_f32 v[78:79], v[78:79], v[14:15] op_sel:[0,0] op_sel_hi:[1,0]
    s_add_u32 s42, s42, 1
    s_waitcnt lgkmcnt(0)
    s_barrier
    s_bitcmp1_b32 s36, s42
    s_cbranch_scc1 L2_slow
L2_ret5:
    s_setprio 3
    v_and_b32 v47, 0x0fffffff, v44
    v_mov_b32 v39, v44
    buffer_load_dwordx2 v[34:35], v47, s[8:11], 0 offen
    buffer_load_dwordx3 v[36:38], v47, s[8:11], 0 offen offset:8
    v_cmpx_ne_u64 vcc, v[74:75], v[70:71]
    s_and_b64 s[82:83], vcc, s[80:81]
    s_cbranch_scc1 L2_c93
L2_d93:
    v_mov_b64 v[84:85], v[70:71]
    v_mov_b32 v7, v93
    v_mov_b64 v[86:87], v[74:75]
    s_mov_b64 exec, -1
    s_or_b64 s[80:81], s[80:81], vcc
    v_cmpx_ne_u64 vcc, v[72:73], v[68:69]
    s_and_b64 s[82:83], vcc, s[80:81]
    s_cbranch_scc1 L2_c94
L2_d94:
    v_mov_b64 v[84:85], v[68:69]
    v_mov_b32 v7, v92
    v_mov_b64 v[86:87], v[72:73]
    s_mov_b64 exec, -1
    s_or_b64 s[80:81], s[80:81], vcc
    ds_read_b64 v[70:71], v95 offset:65408
    ds_read_b64 v[68:69], v94 offset:65408
    v_and_b32 v46, 0x20000000, v21
    v_lshrrev_b32 v47, 14, v17
    v_bitop3_b32 v47, v47, v5, v46 bitop3:0xea
    ds_read_b64 v[102:103], v47
    v_bitop3_b32 v93, v17, v5, v46 bitop3:0xea
    v_and_b32 v46, 0x10000000, v21
    v_lshrrev_b32 v47, 14, v16
    v_bitop3_b32 v47, v47, v5, v46 bitop3:0xea
    ds_read_b64 v[100:101], v47
    v_bitop3_b32 v92, v16, v5, v46 bitop3:0xea
    s_waitcnt lgkmcnt(2)
    v_mfma_f32_4x4x4_16b_bf16 v[80:83], v[10:11], v[70:71], v[80:83]
    v_mfma_f32_4x4x4_16b_bf16 v[76:79], v[10:11], v[68:69], v[76:79]
    v_perm_b32 v15, v17, v20, s45
    v_bitop3_b32 v46, v17, 0.5, -0.5 bitop3:0xa8
    v_perm_b32 v14, v16, v20, s44
    v_bitop3_b32 v47, v16, 0.5, -0.5 bitop3:0xa8
    v_cvt_pk_bf16_f32 v80, v80, v81
    v_cvt_pk_bf16_f32 v81, v82, v83
    ds_wrxchg_rtn_b64 v[74:75], v95, v[80:81] offset:65408
    v_cvt_pk_bf16_f32 v76, v76, v77
    v_cvt_pk_bf16_f32 v77, v78, v79
    ds_wrxchg_rtn_b64 v[72:73], v94, v[76:77] offset:65408
    s_waitcnt lgkmcnt(2)
    v_mfma_f32_4x4x4_16b_bf16 v[80:83], v[8:9], v[102:103], 0
    v_mfma_f32_4x4x4_16b_bf16 v[76:79], v[8:9], v[100:101], 0
    v_bitop3_b32 v15, v6, v15, v46 bitop3:0xca
    v_bitop3_b32 v14, v6, v14, v47 bitop3:0xca
    v_cmp_lt_u32 s[84:85], v5, v92
    s_nop 0
    v_pk_mul_f32 v[80:81], v[80:81], v[14:15] op_sel:[0,1] op_sel_hi:[1,1]
    v_pk_mul_f32 v[82:83], v[82:83], v[14:15] op_sel:[0,1] op_sel_hi:[1,1]
    v_pk_mul_f32 v[76:77], v[76:77], v[14:15] op_sel:[0,0] op_sel_hi:[1,0]
    v_pk_mul_f32 v[78:79], v[78:79], v[14:15] op_sel:[0,0] op_sel_hi:[1,0]
    buffer_load_dwordx4 v[108:111], v3, s[16:19], s40 offen offset:0
    s_waitcnt lgkmcnt(0)
    v_cmpx_ne_u64 vcc, v[74:75], v[70:71]
    s_and_b64 s[82:83], vcc, s[80:81]
    s_cbranch_scc1 L2_c95
L2_d95:
    v_mov_b64 v[84:85], v[70:71]
    v_mov_b32 v7, v95
    v_mov_b64 v[86:87], v[74:75]
    s_mov_b64 exec, -1
    s_or_b64 s[80:81], s[80:81], vcc
    v_cmpx_ne_u64 vcc, v[72:73], v[68:69]
    s_and_b64 s[82:83], vcc, s[80:81]
    s_cbranch_scc1 L2_c96
L2_d96:
    v_mov_b64 v[84:85], v[68:69]
    v_mov_b32 v7, v94
    v_mov_b64 v[86:87], v[72:73]
    s_mov_b64 exec, -1
    s_or_b64 s[80:81], s[80:81], vcc
    ds_read_b64 v[70:71], v93 offset:65408
    s_and_b64 exec, s[84:85], s[80:81]
    v_mfma_f32_4x4x4_16b_bf16 v[76:79], v[12:13], v[84:85], 0
    v_mov_b32 v92, v7
    s_andn2_b64 s[80:81], s[80:81], s[84:85]
    v_mfma_f32_4x4x4_16b_bf16 v[76:79], v[10:11], v[86:87], v[76:79]
    s_mov_b64 exec, -1
    ds_read_b64 v[68:69], v92 offset:65408
    v_and_b32 v46, 0x80000000, v21
    v_lshrrev_b32 v47, 14, v19
    v_bitop3_b32 v47, v47, v5, v46 bitop3:0xea
    ds_read_b64 v[106:107], v47
    v_bitop3_b32 v95, v19, v5, v46 bitop3:0xea
    v_and_b32 v46, 0x40000000, v21
    v_lshrrev_b32 v47, 14, v18
    v_bitop3_b32 v47, v47, v5, v46 bitop3:0xea
    ds_read_b64 v[104:105], v47
    v_bitop3_b32 v94, v18, v5, v46 bitop3:0xea
    s_waitcnt lgkmcnt(2)
    v_mfma_f32_4x4x4_16b_bf16 v[80:83], v[10:11], v[70:71], v[80:83]
    v_mfma_f32_4x4x4_16b_bf16 v[76:79], v[10:11], v[68:69], v[76:79]
    v_perm_b32 v15, v19, v20, s47
    v_bitop3_b32 v46, v19, 0.5, -0.5 bitop3:0xa8
    v_perm_b32 v14, v18, v20, s46
    v_bitop3_b32 v47, v18, 0.5, -0.5 bitop3:0xa8
    v_cvt_pk_bf16_f32 v80, v80, v81
    v_cvt_pk_bf16_f32 v81, v82, v83
    ds_wrxchg_rtn_b64 v[74:75], v93, v[80:81] offset:65408
    v_cvt_pk_bf16_f32 v76, v76, v77
    v_cvt_pk_bf16_f32 v77, v78, v79
    ds_wrxchg_rtn_b64 v[72:73], v92, v[76:77] offset:65408
    s_setprio 2
    s_waitcnt lgkmcnt(2)
    v_mfma_f32_4x4x4_16b_bf16 v[80:83], v[8:9], v[106:107], 0
    v_mfma_f32_4x4x4_16b_bf16 v[76:79], v[8:9], v[104:105], 0
    v_bitop3_b32 v15, v6, v15, v46 bitop3:0xca
    v_bitop3_b32 v14, v6, v14, v47 bitop3:0xca
    s_nop 1
    v_pk_mul_f32 v[80:81], v[80:81], v[14:15] op_sel:[0,1] op_sel_hi:[1,1]
    v_pk_mul_f32 v[82:83], v[82:83], v[14:15] op_sel:[0,1] op_sel_hi:[1,1]
    v_pk_mul_f32 v[76:77], v[76:77], v[14:15] op_sel:[0,0] op_sel_hi:[1,0]
    v_pk_mul_f32 v[78:79], v[78:79], v[14:15] op_sel:[0,0] op_sel_hi:[1,0]
    v_and_b32 v47, 0x0fffffff, v40
    v_mov_b32 v21, v40
    buffer_load_dwordx2 v[16:17], v47, s[8:11], 0 offen
    buffer_load_dwordx3 v[18:20], v47, s[8:11], 0 offen offset:8
    s_waitcnt lgkmcnt(0)
    v_cmpx_ne_u64 vcc, v[74:75], v[70:71]
    s_and_b64 s[82:83], vcc, s[80:81]
    s_cbranch_scc1 L2_c97
L2_d97:
    v_mov_b64 v[84:85], v[70:71]
    v_mov_b32 v7, v93
    v_mov_b64 v[86:87], v[74:75]
    s_mov_b64 exec, -1
    s_or_b64 s[80:81], s[80:81], vcc
    v_cmpx_ne_u64 vcc, v[72:73], v[68:69]
    s_and_b64 s[82:83], vcc, s[80:81]
    s_cbranch_scc1 L2_c98
L2_d98:
    v_mov_b64 v[84:85], v[68:69]
    v_mov_b32 v7, v92
    v_mov_b64 v[86:87], v[72:73]
    s_mov_b64 exec, -1
    s_or_b64 s[80:81], s[80:81], vcc
    ds_read_b64 v[70:71], v95 offset:65408
    ds_read_b64 v[68:69], v94 offset:65408
    s_waitcnt vmcnt(10)
    v_and_b32 v46, 0x20000000, v27
    v_lshrrev_b32 v47, 14, v23
    v_bitop3_b32 v47, v47, v5, v46 bitop3:0xea
    ds_read_b64 v[102:103], v47
    v_bitop3_b32 v93, v23, v5, v46 bitop3:0xea
    v_and_b32 v46, 0x10000000, v27
    v_lshrrev_b32 v47, 14, v22
    v_bitop3_b32 v47, v47, v5, v46 bitop3:0xea
    ds_read_b64 v[100:101], v47
    v_bitop3_b32 v92, v22, v5, v46 bitop3:0xea
    s_waitcnt lgkmcnt(2)
    v_mfma_f32_4x4x4_16b_bf16 v[80:83], v[10:11], v[70:71], v[80:83]
    v_mfma_f32_4x4x4_16b_bf16 v[76:79], v[10:11], v[68:69], v[76:79]
    v_perm_b32 v15, v23, v26, s45
    v_bitop3_b32 v46, v23, 0.5, -0.5 bitop3:0xa8
    v_perm_b32 v14, v22, v26, s44
    v_bitop3_b32 v47, v22, 0.5, -0.5 bitop3:0xa8
    v_cvt_pk_bf16_f32 v80, v80, v81
    v_cvt_pk_bf16_f32 v81, v82, v83
    ds_wrxchg_rtn_b64 v[74:75], v95, v[80:81] offset:65408
    v_cvt_pk_bf16_f32 v76, v76, v77
    v_cvt_pk_bf16_f32 v77, v78, v79
    ds_wrxchg_rtn_b64 v[72:73], v94, v[76:77] offset:65408
    s_waitcnt lgkmcnt(2)
    v_mfma_f32_4x4x4_16b_bf16 v[80:83], v[8:9], v[102:103], 0
    v_mfma_f32_4x4x4_16b_bf16 v[76:79], v[8:9], v[100:101], 0
    v_bitop3_b32 v15, v6, v15, v46 bitop3:0xca
    v_bitop3_b32 v14, v6, v14, v47 bitop3:0xca
    v_cmp_lt_u32 s[84:85], v5, v92
    s_nop 0
    v_pk_mul_f32 v[80:81], v[80:81], v[14:15] op_sel:[0,1] op_sel_hi:[1,1]
    v_pk_mul_f32 v[82:83], v[82:83], v[14:15] op_sel:[0,1] op_sel_hi:[1,1]
    v_pk_mul_f32 v[76:77], v[76:77], v[14:15] op_sel:[0,0] op_sel_hi:[1,0]
    v_pk_mul_f32 v[78:79], v[78:79], v[14:15] op_sel:[0,0] op_sel_hi:[1,0]
    v_sub_u16 v88, v62, v54
    v_and_b32 v89, 3, v54
    v_add3_u32 v99, v88, v89, 3
    v_and_b32 v99, -4, v99
    v_max_u32 v99, 4, v99
    v_and_b32 v97, 0xfffc, v54
    v_bfm_b32 v96, v88, v89
    v_add_u32_dpp v91, v99, v99 row_shr:1 row_mask:0xf bank_mask:0xf bound_ctrl:1
    v_mad_u32_u24 v97, v97, 5, v2
    v_cmp_lt_u32 vcc, 16, v99
    v_add_u32_dpp v91, v91, v91 row_shr:2 row_mask:0xf bank_mask:0xf bound_ctrl:1
    v_sub_u32 v98, s38, v99
    v_lshrrev_b64 v[54:55], 16, v[54:55]
    v_add_u32_dpp v91, v91, v91 row_shr:4 row_mask:0xf bank_mask:0xf bound_ctrl:1
    v_lshrrev_b64 v[62:63], 16, v[62:63]
    s_mov_b32 s43, 0
    v_add_u32_dpp v91, v91, v91 row_shr:8 row_mask:0xf bank_mask:0xf bound_ctrl:1
    s_nop 1
    v_add_u32_dpp v91, v91, v91 row_bcast:15 row_mask:0xa bank_mask:0xf
    s_nop 1
    v_add_u32_dpp v91, v91, v91 row_bcast:31 row_mask:0xc bank_mask:0xf
    v_add_u32 v98, v98, v91
    v_readlane_b32 s37, v91, 63
    s_cbranch_vccnz L2_xo99
L2_xp99:
    buffer_load_dwordx4 v[112:115], v3, s[16:19], s40 offen offset:1024
    s_waitcnt lgkmcnt(0)
    v_cmpx_ne_u64 vcc, v[74:75], v[70:71]
    s_and_b64 s[82:83], vcc, s[80:81]
    s_cbranch_scc1 L2_c100
L2_d100:
    v_mov_b64 v[84:85], v[70:71]
    v_mov_b32 v7, v95
    v_mov_b64 v[86:87], v[74:75]
    s_mov_b64 exec, -1
    s_or_b64 s[80:81], s[80:81], vcc
    v_cmpx_ne_u64 vcc, v[72:73], v[68:69]
    s_and_b64 s[82:83], vcc, s[80:81]
    s_cbranch_scc1 L2_c101
L2_d101:
    v_mov_b64 v[84:85], v[68:69]
    v_mov_b32 v7, v94
    v_mov_b64 v[86:87], v[72:73]
    s_mov_b64 exec, -1
    s_or_b64 s[80:81], s[80:81], vcc
    ds_read_b64 v[70:71], v93 offset:65408
    s_and_b64 exec, s[84:85], s[80:81]
    v_mfma_f32_4x4x4_16b_bf16 v[76:79], v[12:13], v[84:85], 0
    v_mov_b32 v92, v7
    s_andn2_b64 s[80:81], s[80:81], s[84:85]
    v_mfma_f32_4x4x4_16b_bf16 v[76:79], v[10:11], v[86:87], v[76:79]
    s_mov_b64 exec, -1
    ds_read_b64 v[68:69], v92 offset:65408
    v_and_b32 v46, 0x80000000, v27
    v_lshrrev_b32 v47, 14, v25
    v_bitop3_b32 v47, v47, v5, v46 bitop3:0xea
    ds_read_b64 v[106:107], v47
    v_bitop3_b32 v95, v25, v5, v46 bitop3:0xea
    v_and_b32 v46, 0x40000000, v27
    v_lshrrev_b32 v47, 14, v24
    v_bitop3_b32 v47, v47, v5, v46 bitop3:0xea
    ds_read_b64 v[104:105], v47
    v_bitop3_b32 v94, v24, v5, v46 bitop3:0xea
    s_waitcnt lgkmcnt(2)
    v_mfma_f32_4x4x4_16b_bf16 v[80:83], v[10:11], v[70:71], v[80:83]
    v_mfma_f32_4x4x4_16b_bf16 v[76:79], v[10:11], v[68:69], v[76:79]
    v_perm_b32 v15, v25, v26, s47
    v_bitop3_b32 v46, v25, 0.5, -0.5 bitop3:0xa8
    v_perm_b32 v14, v24, v26, s46
    v_bitop3_b32 v47, v24, 0.5, -0.5 bitop3:0xa8
    v_cvt_pk_bf16_f32 v80, v80, v81
    v_cvt_pk_bf16_f32 v81, v82, v83
    ds_wrxchg_rtn_b64 v[74:75], v93, v[80:81] offset:65408
    v_cvt_pk_bf16_f32 v76, v76, v77
    v_cvt_pk_bf16_f32 v77, v78, v79
    ds_wrxchg_rtn_b64 v[72:73], v92, v[76:77] offset:65408
    s_setprio 1
    s_waitcnt lgkmcnt(2)
    v_mfma_f32_4x4x4_16b_bf16 v[80:83], v[8:9], v[106:107], 0
    v_mfma_f32_4x4x4_16b_bf16 v[76:79], v[8:9], v[104:105], 0
    v_bitop3_b32 v15, v6, v15, v46 bitop3:0xca
    v_bitop3_b32 v14, v6, v14, v47 bitop3:0xca
    s_nop 1
    v_pk_mul_f32 v[80:81], v[80:81], v[14:15] op_sel:[0,1] op_sel_hi:[1,1]
    v_pk_mul_f32 v[82:83], v[82:83], v[14:15] op_sel:[0,1] op_sel_hi:[1,1]
    v_pk_mul_f32 v[76:77], v[76:77], v[14:15] op_sel:[0,0] op_sel_hi:[1,0]
    v_pk_mul_f32 v[78:79], v[78:79], v[14:15] op_sel:[0,0] op_sel_hi:[1,0]
    v_and_b32 v47, 0x0fffffff, v41
    v_mov_b32 v27, v41
    buffer_load_dwordx2 v[22:23], v47, s[8:11], 0 offen
    buffer_load_dwordx3 v[24:26], v47, s[8:11], 0 offen offset:8
    s_waitcnt lgkmcnt(0)
    v_cmpx_ne_u64 vcc, v[74:75], v[70:71]
    s_and_b64 s[82:83], vcc, s[80:81]
    s_cbranch_scc1 L2_c102
L2_d102:
    v_mov_b64 v[84:85], v[70:71]
    v_mov_b32 v7, v93
    v_mov_b64 v[86:87], v[74:75]
    s_mov_b64 exec, -1
    s_or_b64 s[80:81], s[80:81], vcc
    v_cmpx_ne_u64 vcc, v[72:73], v[68:69]
    s_and_b64 s[82:83], vcc, s[80:81]
    s_cbranch_scc1 L2_c103
L2_d103:
    v_mov_b64 v[84:85], v[68:69]
    v_mov_b32 v7, v92
    v_mov_b64 v[86:87], v[72:73]
    s_mov_b64 exec, -1
    s_or_b64 s[80:81], s[80:81], vcc
    ds_read_b64 v[70:71], v95 offset:65408
    ds_read_b64 v[68:69], v94 offset:65408
    s_waitcnt vmcnt(11)
    v_and_b32 v46, 0x20000000, v33
    v_lshrrev_b32 v47, 14, v29
    v_bitop3_b32 v47, v47, v5, v46 bitop3:0xea
    ds_read_b64 v[102:103], v47
    v_bitop3_b32 v93, v29, v5, v46 bitop3:0xea
    v_and_b32 v46, 0x10000000, v33
    v_lshrrev_b32 v47, 14, v28
    v_bitop3_b32 v47, v47, v5, v46 bitop3:0xea
    ds_read_b64 v[100:101], v47
    v_bitop3_b32 v92, v28, v5, v46 bitop3:0xea
    s_waitcnt lgkmcnt(2)
    v_mfma_f32_4x4x4_16b_bf16 v[80:83], v[10:11], v[70:71], v[80:83]
    v_mfma_f32_4x4x4_16b_bf16 v[76:79], v[10:11], v[68:69], v[76:79]
    v_perm_b32 v15, v29, v32, s45
    v_bitop3_b32 v46, v29, 0.5, -0.5 bitop3:0xa8
    v_perm_b32 v14, v28, v32, s44
    v_bitop3_b32 v47, v28, 0.5, -0.5 bitop3:0xa8
    v_cvt_pk_bf16_f32 v80, v80, v81
    v_cvt_pk_bf16_f32 v81, v82, v83
    ds_wrxchg_rtn_b64 v[74:75], v95, v[80:81] offset:65408
    v_cvt_pk_bf16_f32 v76, v76, v77
    v_cvt_pk_bf16_f32 v77, v78, v79
    ds_wrxchg_rtn_b64 v[72:73], v94, v[76:77] offset:65408
    s_waitcnt lgkmcnt(2)
    v_mfma_f32_4x4x4_16b_bf16 v[80:83], v[8:9], v[102:103], 0
    v_mfma_f32_4x4x4_16b_bf16 v[76:79], v[8:9], v[100:101], 0
    v_bitop3_b32 v15, v6, v15, v46 bitop3:0xca
    v_bitop3_b32 v14, v6, v14, v47 bitop3:0xca
    v_cmp_lt_u32 s[84:85], v5, v92
    s_nop 0
    v_pk_mul_f32 v[80:81], v[80:81], v[14:15] op_sel:[0,1] op_sel_hi:[1,1]
    v_pk_mul_f32 v[82:83], v[82:83], v[14:15] op_sel:[0,1] op_sel_hi:[1,1]
    v_pk_mul_f32 v[76:77], v[76:77], v[14:15] op_sel:[0,0] op_sel_hi:[1,0]
    v_pk_mul_f32 v[78:79], v[78:79], v[14:15] op_sel:[0,0] op_sel_hi:[1,0]
    s_waitcnt lgkmcnt(0)
    v_cmpx_ne_u64 vcc, v[74:75], v[70:71]
    s_and_b64 s[82:83], vcc, s[80:81]
    s_cbranch_scc1 L2_c104
L2_d104:
    v_mov_b64 v[84:85], v[70:71]
    v_mov_b32 v7, v95
    v_mov_b64 v[86:87], v[74:75]
    s_mov_b64 exec, -1
    s_or_b64 s[80:81], s[80:81], vcc
    v_cmpx_ne_u64 vcc, v[72:73], v[68:69]
    s_and_b64 s[82:83], vcc, s[80:81]
    s_cbranch_scc1 L2_c105
L2_d105:
    v_mov_b64 v[84:85], v[68:69]
    v_mov_b32 v7, v94
    v_mov_b64 v[86:87], v[72:73]
    s_mov_b64 exec, -1
    s_or_b64 s[80:81], s[80:81], vcc
    ds_read_b64 v[70:71], v93 offset:65408
    s_and_b64 exec, s[84:85], s[80:81]
    v_mfma_f32_4x4x4_16b_bf16 v[76:79], v[12:13], v[84:85], 0
    v_mov_b32 v92, v7
    s_andn2_b64 s[80:81], s[80:81], s[84:85]
    v_mfma_f32_4x4x4_16b_bf16 v[76:79], v[10:11], v[86:87], v[76:79]
    s_mov_b64 exec, -1
    ds_read_b64 v[68:69], v92 offset:65408
    v_and_b32 v46, 0x80000000, v33
    v_lshrrev_b32 v47, 14, v31
    v_bitop3_b32 v47, v47, v5, v46 bitop3:0xea
    ds_read_b64 v[106:107], v47
    v_bitop3_b32 v95, v31, v5, v46 bitop3:0xea
    v_and_b32 v46, 0x40000000, v33
    v_lshrrev_b32 v47, 14, v30
    v_bitop3_b32 v47, v47, v5, v46 bitop3:0xea
    ds_read_b64 v[104:105], v47
    v_bitop3_b32 v94, v30, v5, v46 bitop3:0xea
    s_waitcnt lgkmcnt(2)
    v_mfma_f32_4x4x4_16b_bf16 v[80:83], v[10:11], v[70:71], v[80:83]
    v_mfma_f32_4x4x4_16b_bf16 v[76:79], v[10:11], v[68:69], v[76:79]
    v_perm_b32 v15, v31, v32, s47
    v_bitop3_b32 v46, v31, 0.5, -0.5 bitop3:0xa8
    v_perm_b32 v14, v30, v32, s46
    v_bitop3_b32 v47, v30, 0.5, -0.5 bitop3:0xa8
    v_cvt_pk_bf16_f32 v80, v80, v81
    v_cvt_pk_bf16_f32 v81, v82, v83
    ds_wrxchg_rtn_b64 v[74:75], v93, v[80:81] offset:65408
    v_cvt_pk_bf16_f32 v76, v76, v77
    v_cvt_pk_bf16_f32 v77, v78, v79
    ds_wrxchg_rtn_b64 v[72:73], v92, v[76:77] offset:65408
    s_setprio 0
    s_waitcnt lgkmcnt(2)
    v_mfma_f32_4x4x4_16b_bf16 v[80:83], v[8:9], v[106:107], 0
    v_mfma_f32_4x4x4_16b_bf16 v[76:79], v[8:9], v[104:105], 0
    v_bitop3_b32 v15, v6, v15, v46 bitop3:0xca
    v_bitop3_b32 v14, v6, v14, v47 bitop3:0xca
    s_nop 1
    v_pk_mul_f32 v[80:81], v[80:81], v[14:15] op_sel:[0,1] op_sel_hi:[1,1]
    v_pk_mul_f32 v[82:83], v[82:83], v[14:15] op_sel:[0,1] op_sel_hi:[1,1]
    v_pk_mul_f32 v[76:77], v[76:77], v[14:15] op_sel:[0,0] op_sel_hi:[1,0]
    v_pk_mul_f32 v[78:79], v[78:79], v[14:15] op_sel:[0,0] op_sel_hi:[1,0]
    s_add_u32 s40, s40, 0x50000
    v_and_b32 v47, 0x0fffffff, v42
    v_mov_b32 v33, v42
    buffer_load_dwordx2 v[28:29], v47, s[8:11], 0 offen
    buffer_load_dwordx3 v[30:32], v47, s[8:11], 0 offen offset:8
    s_waitcnt lgkmcnt(0)
    v_cmpx_ne_u64 vcc, v[74:75], v[70:71]
    s_and_b64 s[82:83], vcc, s[80:81]
    s_cbranch_scc1 L2_c106
L2_d106:
    v_mov_b64 v[84:85], v[70:71]
    v_mov_b32 v7, v93
    v_mov_b64 v[86:87], v[74:75]
    s_mov_b64 exec, -1
    s_or_b64 s[80:81], s[80:81], vcc
    v_cmpx_ne_u64 vcc, v[72:73], v[68:69]
    s_and_b64 s[82:83], vcc, s[80:81]
    s_cbranch_scc1 L2_c107
L2_d107:
    v_mov_b64 v[84:85], v[68:69]
    v_mov_b32 v7, v92
    v_mov_b64 v[86:87], v[72:73]
    s_mov_b64 exec, -1
    s_or_b64 s[80:81], s[80:81], vcc
    ds_read_b64 v[70:71], v95 offset:65408
    ds_read_b64 v[68:69], v94 offset:65408
    s_waitcnt vmcnt(8)
    v_and_b32 v46, 0x20000000, v39
    v_lshrrev_b32 v47, 14, v35
    v_bitop3_b32 v47, v47, v5, v46 bitop3:0xea
    ds_read_b64 v[102:103], v47
    v_bitop3_b32 v93, v35, v5, v46 bitop3:0xea
    v_and_b32 v46, 0x10000000, v39
    v_lshrrev_b32 v47, 14, v34
    v_bitop3_b32 v47, v47, v5, v46 bitop3:0xea
    ds_read_b64 v[100:101], v47
    v_bitop3_b32 v92, v34, v5, v46 bitop3:0xea
    v_and_b32 v46, 0x80000000, v39
    v_lshrrev_b32 v47, 14, v37
    v_bitop3_b32 v47, v47, v5, v46 bitop3:0xea
    ds_read_b64 v[106:107], v47
    v_and_b32 v46, 0x40000000, v39
    v_lshrrev_b32 v47, 14, v36
    v_bitop3_b32 v47, v47, v5, v46 bitop3:0xea
    ds_read_b64 v[104:105], v47
    s_waitcnt lgkmcnt(4)
    v_mfma_f32_4x4x4_16b_bf16 v[80:83], v[10:11], v[70:71], v[80:83]
    v_mfma_f32_4x4x4_16b_bf16 v[76:79], v[10:11], v[68:69], v[76:79]
    v_perm_b32 v15, v35, v38, s45
    v_bitop3_b32 v46, v35, 0.5, -0.5 bitop3:0xa8
    v_perm_b32 v14, v34, v38, s44
    v_bitop3_b32 v47, v34, 0.5, -0.5 bitop3:0xa8
    v_cvt_pk_bf16_f32 v80, v80, v81
    v_cvt_pk_bf16_f32 v81, v82, v83
    ds_wrxchg_rtn_b64 v[74:75], v95, v[80:81] offset:65408
    v_cvt_pk_bf16_f32 v76, v76, v77
    v_cvt_pk_bf16_f32 v77, v78, v79
    ds_wrxchg_rtn_b64 v[72:73], v94, v[76:77] offset:65408
    s_waitcnt lgkmcnt(2)
    s_barrier
    s_setprio 3
    s_mov_b32 m0, s69
    s_nop 0
    ds_write_addtid_b32 v116 offset:32768
    ds_write_addtid_b32 v117 offset:33024
    ds_write_addtid_b32 v118 offset:33280
    ds_write_addtid_b32 v119 offset:33536
    buffer_load_dwordx4 v[116:119], v3, s[16:19], s40 offen offset:2048
    ds_write_addtid_b32 v120 offset:33792
    ds_write_addtid_b32 v121 offset:34048
    ds_write_addtid_b32 v122 offset:34304
    ds_write_addtid_b32 v123 offset:34560
    buffer_load_dwordx4 v[120:123], v3, s[16:19], s40 offen offset:3072
    v_mfma_f32_4x4x4_16b_bf16 v[80:83], v[8:9], v[102:103], 0
    v_mfma_f32_4x4x4_16b_bf16 v[76:79], v[8:9], v[100:101], 0
    v_bitop3_b32 v15, v6, v15, v46 bitop3:0xca
    v_bitop3_b32 v14, v6, v14, v47 bitop3:0xca
    v_cmp_lt_u32 s[84:85], v5, v92
    s_nop 0
    v_pk_mul_f32 v[80:81], v[80:81], v[14:15] op_sel:[0,1] op_sel_hi:[1,1]
    v_pk_mul_f32 v[82:83], v[82:83], v[14:15] op_sel:[0,1] op_sel_hi:[1,1]
    v_pk_mul_f32 v[76:77], v[76:77], v[14:15] op_sel:[0,0] op_sel_hi:[1,0]
    v_pk_mul_f32 v[78:79], v[78:79], v[14:15] op_sel:[0,0] op_sel_hi:[1,0]
    v_mov_b32 v44, v43
    s_cmp_gt_u32 s37, 1024
    s_cbranch_scc1 L2_xs108
    s_cmp_lg_u32 s43, 0
    s_cbranch_scc1 L2_xa108
L2_xb108:
    v_lshlrev_b32 v89, 16, v96
    v_add_u32 v90, 60, v97
    v_bitop3_b32 v90, v89, v45, v90 bitop3:0x6a
    ds_write_b32 v98, v90 offset:12
    v_lshlrev_b32 v89, 20, v96
    v_add_u32 v90, 40, v97
    v_bitop3_b32 v90, v89, v45, v90 bitop3:0x6a
    ds_write_b32 v98, v90 offset:8
    v_lshlrev_b32 v89, 24, v96
    v_add_u32 v90, 20, v97
    v_bitop3_b32 v90, v89, v45, v90 bitop3:0x6a
    ds_write_b32 v98, v90 offset:4
    v_lshlrev_b32 v89, 28, v96
    v_bitop3_b32 v90, v89, v45, v97 bitop3:0x6a
    ds_write_b32 v98, v90 offset:0
    v_mov_b32_dpp v91, v66 quad_perm:[1,1,1,1] row_mask:0xf bank_mask:0xf
    v_and_b32 v89, 3, v91
    v_and_b32 v97, 0xfffc, v91
    v_sub_u16_dpp v88, v66, v91 quad_perm:[3,3,3,3] row_mask:0xf bank_mask:0xf
    v_mad_u32_u24 v97, v97, 5, v4
    v_add_u32 v99, v88, v89
    v_bfm_b32 v96, v88, v89
    v_cmp_lt_u32 s[58:59], 16, v99
    v_lshlrev_b32 v89, v1, v96
    v_and_b32 v89, v45, v89
    v_cmp_ne_u32 vcc, 0, v89
    v_xor_b32 v90, v97, v89
    s_add_u32 s3, s37, s38
    v_mbcnt_lo_u32_b32 v98, vcc_lo, 0
    v_mbcnt_hi_u32_b32 v98, vcc_hi, v98
    s_bcnt1_i32_b64 s41, vcc
    v_lshl_add_u32 v98, v98, 2, s3
    s_mov_b64 exec, vcc
    ds_write_b32 v98, v90
    s_mov_b64 exec, -1
    s_lshl2_add_u32 s37, s41, s37
    s_cmp_lg_u64 s[58:59], 0
    s_cbranch_scc1 L2_xe108
L2_xr108:
    v_add_u32 v98, s37, v0
    v_mov_b32 v90, -1
    ds_write_b32 v98, v90
    ds_read2st64_b32 v[40:41], v0 offset0:0 offset1:1
    ds_read2st64_b32 v[42:43], v0 offset0:2 offset1:3
    s_sub_u32 s3, s37, 768
    s_cmp_gt_u32 s3, 256
    s_cbranch_scc1 L2_xf108
L2_xg108:
    v_lshrrev_b64 v[64:65], 16, v[64:65]
    v_lshrrev_b64 v[66:67], 16, v[66:67]
    s_setprio 2
    ds_write_addtid_b32 v124 offset:34816
    ds_write_addtid_b32 v125 offset:35072
    ds_write_addtid_b32 v126 offset:35328
    ds_write_addtid_b32 v127 offset:35584
    s_add_u32 s3, s40, 4096
    buffer_load_dwordx4 v[124:127], v3, s[16:19], s3 offen
    s_waitcnt lgkmcnt(14)
    v_cmpx_ne_u64 vcc, v[74:75], v[70:71]
    s_and_b64 s[82:83], vcc, s[80:81]
    s_cbranch_scc1 L2_c109
L2_d109:
    v_mov_b64 v[84:85], v[70:71]
    v_mov_b32 v7, v95
    v_mov_b64 v[86:87], v[74:75]
    s_mov_b64 exec, -1
    s_or_b64 s[80:81], s[80:81], vcc
    v_cmpx_ne_u64 vcc, v[72:73], v[68:69]
    s_and_b64 s[82:83], vcc, s[80:81]
    s_cbranch_scc1 L2_c110
L2_d110:
    v_mov_b64 v[84:85], v[68:69]
    v_mov_b32 v7, v94
    v_mov_b64 v[86:87], v[72:73]
    s_mov_b64 exec, -1
    s_or_b64 s[80:81], s[80:81], vcc
    ds_read_b64 v[70:71], v93 offset:65408
    s_and_b64 exec, s[84:85], s[80:81]
    v_mfma_f32_4x4x4_16b_bf16 v[76:79], v[12:13], v[84:85], 0
    v_mov_b32 v92, v7
    s_andn2_b64 s[80:81], s[80:81], s[84:85]
    v_mfma_f32_4x4x4_16b_bf16 v[76:79], v[10:11], v[86:87], v[76:79]
    s_mov_b64 exec, -1
    ds_read_b64 v[68:69], v92 offset:65408
    s_setprio 1
    s_waitcnt vmcnt(10)
    s_mov_b32 m0, s38
    s_nop 0
    ds_write_addtid_b32 v108 offset:0
    ds_write_addtid_b32 v109 offset:256
    ds_write_addtid_b32 v110 offset:512
    ds_write_addtid_b32 v111 offset:768
    s_waitcnt lgkmcnt(4)
    v_mfma_f32_4x4x4_16b_bf16 v[80:83], v[10:11], v[70:71], v[80:83]
    v_mfma_f32_4x4x4_16b_bf16 v[76:79], v[10:11], v[68:69], v[76:79]
    v_and_b32 v46, 0x40000000, v39
    v_bitop3_b32 v94, v36, v5, v46 bitop3:0xea
    v_and_b32 v46, 0x80000000, v39
    v_bitop3_b32 v95, v37, v5, v46 bitop3:0xea
    v_perm_b32 v15, v37, v38, s47
    v_bitop3_b32 v46, v37, 0.5, -0.5 bitop3:0xa8
    v_perm_b32 v14, v36, v38, s46
    v_bitop3_b32 v47, v36, 0.5, -0.5 bitop3:0xa8
    v_cvt_pk_bf16_f32 v80, v80, v81
    v_cvt_pk_bf16_f32 v81, v82, v83
    ds_wrxchg_rtn_b64 v[74:75], v93, v[80:81] offset:65408
    v_cvt_pk_bf16_f32 v76, v76, v77
    v_cvt_pk_bf16_f32 v77, v78, v79
    ds_wrxchg_rtn_b64 v[72:73], v92, v[76:77] offset:65408
    s_setprio 0
    s_waitcnt vmcnt(7)
    ds_write_addtid_b32 v112 offset:1024
    ds_write_addtid_b32 v113 offset:1280
    ds_write_addtid_b32 v114 offset:1536
    ds_write_addtid_b32 v115 offset:1792
    v_mfma_f32_4x4x4_16b_bf16 v[80:83], v[8:9], v[106:107], 0
    v_mfma_f32_4x4x4_16b_bf16 v[76:79], v[8:9], v[104:105], 0
    v_bitop3_b32 v15, v6, v15, v46 bitop3:0xca
    v_bitop3_b32 v14, v6, v14, v47 bitop3:0xca
    s_nop 1
    v_pk_mul_f32 v[80:81], v[80:81], v[14:15] op_sel:[0,1] op_sel_hi:[1,1]
    v_pk_mul_f32 v[82:83], v[82:83], v[14:15] op_sel:[0,1] op_sel_hi:[1,1]
    v_pk_mul_f32 v[76:77], v[76:77], v[14:15] op_sel:[0,0] op_sel_hi:[1,0]
    v_pk_mul_f32 v[78:79], v[78:79], v[14:15] op_sel:[0,0] op_sel_hi:[1,0]
    s_add_u32 s42, s42, 1
    s_waitcnt lgkmcnt(0)
    s_cmp_lg_u32 s42, 14
    s_cbranch_scc1 L2_loop
    s_barrier
    s_bitcmp1_b32 s36, s42
    s_cbranch_scc1 L2_slow
L2_ret6:
    s_setprio 3
    v_and_b32 v47, 0x0fffffff, v44
    v_mov_b32 v39, v44
    buffer_load_dwordx2 v[34:35], v47, s[8:11], 0 offen
    buffer_load_dwordx3 v[36:38], v47, s[8:11], 0 offen offset:8
    v_cmpx_ne_u64 vcc, v[74:75], v[70:71]
    s_and_b64 s[82:83], vcc, s[80:81]
    s_cbranch_scc1 L2_c111
L2_d111:
    v_mov_b64 v[84:85], v[70:71]
    v_mov_b32 v7, v93
    v_mov_b64 v[86:87], v[74:75]
    s_mov_b64 exec, -1
    s_or_b64 s[80:81], s[80:81], vcc
    v_cmpx_ne_u64 vcc, v[72:73], v[68:69]
    s_and_b64 s[82:83], vcc, s[80:81]
    s_cbranch_scc1 L2_c112
L2_d112:
    v_mov_b64 v[84:85], v[68:69]
    v_mov_b32 v7, v92
    v_mov_b64 v[86:87], v[72:73]
    s_mov_b64 exec, -1
    s_or_b64 s[80:81], s[80:81], vcc
    ds_read_b64 v[70:71], v95 offset:65408
    ds_read_b64 v[68:69], v94 offset:65408
    v_and_b32 v46, 0x20000000, v21
    v_lshrrev_b32 v47, 14, v17
    v_bitop3_b32 v47, v47, v5, v46 bitop3:0xea
    ds_read_b64 v[102:103], v47
    v_bitop3_b32 v93, v17, v5, v46 bitop3:0xea
    v_and_b32 v46, 0x10000000, v21
    v_lshrrev_b32 v47, 14, v16
    v_bitop3_b32 v47, v47, v5, v46 bitop3:0xea
    ds_read_b64 v[100:101], v47
    v_bitop3_b32 v92, v16, v5, v46 bitop3:0xea
    s_waitcnt lgkmcnt(2)
    v_mfma_f32_4x4x4_16b_bf16 v[80:83], v[10:11], v[70:71], v[80:83]
    v_mfma_f32_4x4x4_16b_bf16 v[76:79], v[10:11], v[68:69], v[76:79]
    v_perm_b32 v15, v17, v20, s45
    v_bitop3_b32 v46, v17, 0.5, -0.5 bitop3:0xa8
    v_perm_b32 v14, v16, v20, s44
    v_bitop3_b32 v47, v16, 0.5, -0.5 bitop3:0xa8
    v_cvt_pk_bf16_f32 v80, v80, v81
    v_cvt_pk_bf16_f32 v81, v82, v83
    ds_wrxchg_rtn_b64 v[74:75], v95, v[80:81] offset:65408
    v_cvt_pk_bf16_f32 v76, v76, v77
    v_cvt_pk_bf16_f32 v77, v78, v79
    ds_wrxchg_rtn_b64 v[72:73], v94, v[76:77] offset:65408
    s_waitcnt lgkmcnt(2)
    v_mfma_f32_4x4x4_16b_bf16 v[80:83], v[8:9], v[102:103], 0
    v_mfma_f32_4x4x4_16b_bf16 v[76:79], v[8:9], v[100:101], 0
    v_bitop3_b32 v15, v6, v15, v46 bitop3:0xca
    v_bitop3_b32 v14, v6, v14, v47 bitop3:0xca
    v_cmp_lt_u32 s[84:85], v5, v92
    s_nop 0
    v_pk_mul_f32 v[80:81], v[80:81], v[14:15] op_sel:[0,1] op_sel_hi:[1,1]
    v_pk_mul_f32 v[82:83], v[82:83], v[14:15] op_sel:[0,1] op_sel_hi:[1,1]
    v_pk_mul_f32 v[76:77], v[76:77], v[14:15] op_sel:[0,0] op_sel_hi:[1,0]
    v_pk_mul_f32 v[78:79], v[78:79], v[14:15] op_sel:[0,0] op_sel_hi:[1,0]
    buffer_load_dwordx4 v[108:111], v3, s[16:19], s40 offen offset:0
    s_waitcnt lgkmcnt(0)
    v_cmpx_ne_u64 vcc, v[74:75], v[70:71]
    s_and_b64 s[82:83], vcc, s[80:81]
    s_cbranch_scc1 L2_c113
L2_d113:
    v_mov_b64 v[84:85], v[70:71]
    v_mov_b32 v7, v95
    v_mov_b64 v[86:87], v[74:75]
    s_mov_b64 exec, -1
    s_or_b64 s[80:81], s[80:81], vcc
    v_cmpx_ne_u64 vcc, v[72:73], v[68:69]
    s_and_b64 s[82:83], vcc, s[80:81]
    s_cbranch_scc1 L2_c114
L2_d114:
    v_mov_b64 v[84:85], v[68:69]
    v_mov_b32 v7, v94
    v_mov_b64 v[86:87], v[72:73]
    s_mov_b64 exec, -1
    s_or_b64 s[80:81], s[80:81], vcc
    ds_read_b64 v[70:71], v93 offset:65408
    s_and_b64 exec, s[84:85], s[80:81]
    v_mfma_f32_4x4x4_16b_bf16 v[76:79], v[12:13], v[84:85], 0
    v_mov_b32 v92, v7
    s_andn2_b64 s[80:81], s[80:81], s[84:85]
    v_mfma_f32_4x4x4_16b_bf16 v[76:79], v[10:11], v[86:87], v[76:79]
    s_mov_b64 exec, -1
    ds_read_b64 v[68:69], v92 offset:65408
    v_and_b32 v46, 0x80000000, v21
    v_lshrrev_b32 v47, 14, v19
    v_bitop3_b32 v47, v47, v5, v46 bitop3:0xea
    ds_read_b64 v[106:107], v47
    v_bitop3_b32 v95, v19, v5, v46 bitop3:0xea
    v_and_b32 v46, 0x40000000, v21
    v_lshrrev_b32 v47, 14, v18
    v_bitop3_b32 v47, v47, v5, v46 bitop3:0xea
    ds_read_b64 v[104:105], v47
    v_bitop3_b32 v94, v18, v5, v46 bitop3:0xea
    s_waitcnt lgkmcnt(2)
    v_mfma_f32_4x4x4_16b_bf16 v[80:83], v[10:11], v[70:71], v[80:83]
    v_mfma_f32_4x4x4_16b_bf16 v[76:79], v[10:11], v[68:69], v[76:79]
    v_perm_b32 v15, v19, v20, s47
    v_bitop3_b32 v46, v19, 0.5, -0.5 bitop3:0xa8
    v_perm_b32 v14, v18, v20, s46
    v_bitop3_b32 v47, v18, 0.5, -0.5 bitop3:0xa8
    v_cvt_pk_bf16_f32 v80, v80, v81
    v_cvt_pk_bf16_f32 v81, v82, v83
    ds_wrxchg_rtn_b64 v[74:75], v93, v[80:81] offset:65408
    v_cvt_pk_bf16_f32 v76, v76, v77
    v_cvt_pk_bf16_f32 v77, v78, v79
    ds_wrxchg_rtn_b64 v[72:73], v92, v[76:77] offset:65408
    s_setprio 2
    s_waitcnt lgkmcnt(2)
    v_mfma_f32_4x4x4_16b_bf16 v[80:83], v[8:9], v[106:107], 0
    v_mfma_f32_4x4x4_16b_bf16 v[76:79], v[8:9], v[104:105], 0
    v_bitop3_b32 v15, v6, v15, v46 bitop3:0xca
    v_bitop3_b32 v14, v6, v14, v47 bitop3:0xca
    s_nop 1
    v_pk_mul_f32 v[80:81], v[80:81], v[14:15] op_sel:[0,1] op_sel_hi:[1,1]
    v_pk_mul_f32 v[82:83], v[82:83], v[14:15] op_sel:[0,1] op_sel_hi:[1,1]
    v_pk_mul_f32 v[76:77], v[76:77], v[14:15] op_sel:[0,0] op_sel_hi:[1,0]
    v_pk_mul_f32 v[78:79], v[78:79], v[14:15] op_sel:[0,0] op_sel_hi:[1,0]
    v_and_b32 v47, 0x0fffffff, v40
    v_mov_b32 v21, v40
    buffer_load_dwordx2 v[16:17], v47, s[8:11], 0 offen
    buffer_load_dwordx3 v[18:20], v47, s[8:11], 0 offen offset:8
    s_waitcnt lgkmcnt(0)
    v_cmpx_ne_u64 vcc, v[74:75], v[70:71]
    s_and_b64 s[82:83], vcc, s[80:81]
    s_cbranch_scc1 L2_c115
L2_d115:
    v_mov_b64 v[84:85], v[70:71]
    v_mov_b32 v7, v93
    v_mov_b64 v[86:87], v[74:75]
    s_mov_b64 exec, -1
    s_or_b64 s[80:81], s[80:81], vcc
    v_cmpx_ne_u64 vcc, v[72:73], v[68:69]
    s_and_b64 s[82:83], vcc, s[80:81]
    s_cbranch_scc1 L2_c116
L2_d116:
    v_mov_b64 v[84:85], v[68:69]
    v_mov_b32 v7, v92
    v_mov_b64 v[86:87], v[72:73]
    s_mov_b64 exec, -1
    s_or_b64 s[80:81], s[80:81], vcc
    ds_read_b64 v[70:71], v95 offset:65408
    ds_read_b64 v[68:69], v94 offset:65408
    s_waitcnt vmcnt(10)
    v_and_b32 v46, 0x20000000, v27
    v_lshrrev_b32 v47, 14, v23
    v_bitop3_b32 v47, v47, v5, v46 bitop3:0xea
    ds_read_b64 v[102:103], v47
    v_bitop3_b32 v93, v23, v5, v46 bitop3:0xea
    v_and_b32 v46, 0x10000000, v27
    v_lshrrev_b32 v47, 14, v22
    v_bitop3_b32 v47, v47, v5, v46 bitop3:0xea
    ds_read_b64 v[100:101], v47
    v_bitop3_b32 v92, v22, v5, v46 bitop3:0xea
    s_waitcnt lgkmcnt(2)
    v_mfma_f32_4x4x4_16b_bf16 v[80:83], v[10:11], v[70:71], v[80:83]
    v_mfma_f32_4x4x4_16b_bf16 v[76:79], v[10:11], v[68:69], v[76:79]
    v_perm_b32 v15, v23, v26, s45
    v_bitop3_b32 v46, v23, 0.5, -0.5 bitop3:0xa8
    v_perm_b32 v14, v22, v26, s44
    v_bitop3_b32 v47, v22, 0.5, -0.5 bitop3:0xa8
    v_cvt_pk_bf16_f32 v80, v80, v81
    v_cvt_pk_bf16_f32 v81, v82, v83
    ds_wrxchg_rtn_b64 v[74:75], v95, v[80:81] offset:65408
    v_cvt_pk_bf16_f32 v76, v76, v77
    v_cvt_pk_bf16_f32 v77, v78, v79
    ds_wrxchg_rtn_b64 v[72:73], v94, v[76:77] offset:65408
    s_waitcnt lgkmcnt(2)
    v_mfma_f32_4x4x4_16b_bf16 v[80:83], v[8:9], v[102:103], 0
    v_mfma_f32_4x4x4_16b_bf16 v[76:79], v[8:9], v[100:101], 0
    v_bitop3_b32 v15, v6, v15, v46 bitop3:0xca
    v_bitop3_b32 v14, v6, v14, v47 bitop3:0xca
    v_cmp_lt_u32 s[84:85], v5, v92
    s_nop 0
    v_pk_mul_f32 v[80:81], v[80:81], v[14:15] op_sel:[0,1] op_sel_hi:[1,1]
    v_pk_mul_f32 v[82:83], v[82:83], v[14:15] op_sel:[0,1] op_sel_hi:[1,1]
    v_pk_mul_f32 v[76:77], v[76:77], v[14:15] op_sel:[0,0] op_sel_hi:[1,0]
    v_pk_mul_f32 v[78:79], v[78:79], v[14:15] op_sel:[0,0] op_sel_hi:[1,0]
    buffer_load_dwordx4 v[112:115], v3, s[16:19], s40 offen offset:1024
    s_waitcnt lgkmcnt(0)
    v_cmpx_ne_u64 vcc, v[74:75], v[70:71]
    s_and_b64 s[82:83], vcc, s[80:81]
    s_cbranch_scc1 L2_c117
L2_d117:
    v_mov_b64 v[84:85], v[70:71]
    v_mov_b32 v7, v95
    v_mov_b64 v[86:87], v[74:75]
    s_mov_b64 exec, -1
    s_or_b64 s[80:81], s[80:81], vcc
    v_cmpx_ne_u64 vcc, v[72:73], v[68:69]
    s_and_b64 s[82:83], vcc, s[80:81]
    s_cbranch_scc1 L2_c118
L2_d118:
    v_mov_b64 v[84:85], v[68:69]
    v_mov_b32 v7, v94
    v_mov_b64 v[86:87], v[72:73]
    s_mov_b64 exec, -1
    s_or_b64 s[80:81], s[80:81], vcc
    ds_read_b64 v[70:71], v93 offset:65408
    s_and_b64 exec, s[84:85], s[80:81]
    v_mfma_f32_4x4x4_16b_bf16 v[76:79], v[12:13], v[84:85], 0
    v_mov_b32 v92, v7
    s_andn2_b64 s[80:81], s[80:81], s[84:85]
    v_mfma_f32_4x4x4_16b_bf16 v[76:79], v[10:11], v[86:87], v[76:79]
    s_mov_b64 exec, -1
    ds_read_b64 v[68:69], v92 offset:65408
    v_and_b32 v46, 0x80000000, v27
    v_lshrrev_b32 v47, 14, v25
    v_bitop3_b32 v47, v47, v5, v46 bitop3:0xea
    ds_read_b64 v[106:107], v47
    v_bitop3_b32 v95, v25, v5, v46 bitop3:0xea
    v_and_b32 v46, 0x40000000, v27
    v_lshrrev_b32 v47, 14, v24
    v_bitop3_b32 v47, v47, v5, v46 bitop3:0xea
    ds_read_b64 v[104:105], v47
    v_bitop3_b32 v94, v24, v5, v46 bitop3:0xea
    s_waitcnt lgkmcnt(2)
    v_mfma_f32_4x4x4_16b_bf16 v[80:83], v[10:11], v[70:71], v[80:83]
    v_mfma_f32_4x4x4_16b_bf16 v[76:79], v[10:11], v[68:69], v[76:79]
    v_perm_b32 v15, v25, v26, s47
    v_bitop3_b32 v46, v25, 0.5, -0.5 bitop3:0xa8
    v_perm_b32 v14, v24, v26, s46
    v_bitop3_b32 v47, v24, 0.5, -0.5 bitop3:0xa8
    v_cvt_pk_bf16_f32 v80, v80, v81
    v_cvt_pk_bf16_f32 v81, v82, v83
    ds_wrxchg_rtn_b64 v[74:75], v93, v[80:81] offset:65408
    v_cvt_pk_bf16_f32 v76, v76, v77
    v_cvt_pk_bf16_f32 v77, v78, v79
    ds_wrxchg_rtn_b64 v[72:73], v92, v[76:77] offset:65408
    s_setprio 1
    s_waitcnt lgkmcnt(2)
    v_mfma_f32_4x4x4_16b_bf16 v[80:83], v[8:9], v[106:107], 0
    v_mfma_f32_4x4x4_16b_bf16 v[76:79], v[8:9], v[104:105], 0
    v_bitop3_b32 v15, v6, v15, v46 bitop3:0xca
    v_bitop3_b32 v14, v6, v14, v47 bitop3:0xca
    s_nop 1
    v_pk_mul_f32 v[80:81], v[80:81], v[14:15] op_sel:[0,1] op_sel_hi:[1,1]
    v_pk_mul_f32 v[82:83], v[82:83], v[14:15] op_sel:[0,1] op_sel_hi:[1,1]
    v_pk_mul_f32 v[76:77], v[76:77], v[14:15] op_sel:[0,0] op_sel_hi:[1,0]
    v_pk_mul_f32 v[78:79], v[78:79], v[14:15] op_sel:[0,0] op_sel_hi:[1,0]
    v_and_b32 v47, 0x0fffffff, v41
    v_mov_b32 v27, v41
    buffer_load_dwordx2 v[22:23], v47, s[8:11], 0 offen
    buffer_load_dwordx3 v[24:26], v47, s[8:11], 0 offen offset:8
    s_waitcnt lgkmcnt(0)
    v_cmpx_ne_u64 vcc, v[74:75], v[70:71]
    s_and_b64 s[82:83], vcc, s[80:81]
    s_cbranch_scc1 L2_c119
L2_d119:
    v_mov_b64 v[84:85], v[70:71]
    v_mov_b32 v7, v93
    v_mov_b64 v[86:87], v[74:75]
    s_mov_b64 exec, -1
    s_or_b64 s[80:81], s[80:81], vcc
    v_cmpx_ne_u64 vcc, v[72:73], v[68:69]
    s_and_b64 s[82:83], vcc, s[80:81]
    s_cbranch_scc1 L2_c120
L2_d120:
    v_mov_b64 v[84:85], v[68:69]
    v_mov_b32 v7, v92
    v_mov_b64 v[86:87], v[72:73]
    s_mov_b64 exec, -1
    s_or_b64 s[80:81], s[80:81], vcc
    ds_read_b64 v[70:71], v95 offset:65408
    ds_read_b64 v[68:69], v94 offset:65408
    s_waitcnt vmcnt(11)
    v_and_b32 v46, 0x20000000, v33
    v_lshrrev_b32 v47, 14, v29
    v_bitop3_b32 v47, v47, v5, v46 bitop3:0xea
    ds_read_b64 v[102:103], v47
    v_bitop3_b32 v93, v29, v5, v46 bitop3:0xea
    v_and_b32 v46, 0x10000000, v33
    v_lshrrev_b32 v47, 14, v28
    v_bitop3_b32 v47, v47, v5, v46 bitop3:0xea
    ds_read_b64 v[100:101], v47
    v_bitop3_b32 v92, v28, v5, v46 bitop3:0xea
    s_waitcnt lgkmcnt(2)
    v_mfma_f32_4x4x4_16b_bf16 v[80:83], v[10:11], v[70:71], v[80:83]
    v_mfma_f32_4x4x4_16b_bf16 v[76:79], v[10:11], v[68:69], v[76:79]
    v_perm_b32 v15, v29, v32, s45
    v_bitop3_b32 v46, v29, 0.5, -0.5 bitop3:0xa8
    v_perm_b32 v14, v28, v32, s44
    v_bitop3_b32 v47, v28, 0.5, -0.5 bitop3:0xa8
    v_cvt_pk_bf16_f32 v80, v80, v81
    v_cvt_pk_bf16_f32 v81, v82, v83
    ds_wrxchg_rtn_b64 v[74:75], v95, v[80:81] offset:65408
    v_cvt_pk_bf16_f32 v76, v76, v77
    v_cvt_pk_bf16_f32 v77, v78, v79
    ds_wrxchg_rtn_b64 v[72:73], v94, v[76:77] offset:65408
    s_waitcnt lgkmcnt(2)
    v_mfma_f32_4x4x4_16b_bf16 v[80:83], v[8:9], v[102:103], 0
    v_mfma_f32_4x4x4_16b_bf16 v[76:79], v[8:9], v[100:101], 0
    v_bitop3_b32 v15, v6, v15, v46 bitop3:0xca
    v_bitop3_b32 v14, v6, v14, v47 bitop3:0xca
    v_cmp_lt_u32 s[84:85], v5, v92
    s_nop 0
    v_pk_mul_f32 v[80:81], v[80:81], v[14:15] op_sel:[0,1] op_sel_hi:[1,1]
    v_pk_mul_f32 v[82:83], v[82:83], v[14:15] op_sel:[0,1] op_sel_hi:[1,1]
    v_pk_mul_f32 v[76:77], v[76:77], v[14:15] op_sel:[0,0] op_sel_hi:[1,0]
    v_pk_mul_f32 v[78:79], v[78:79], v[14:15] op_sel:[0,0] op_sel_hi:[1,0]
    s_waitcnt lgkmcnt(0)
    v_cmpx_ne_u64 vcc, v[74:75], v[70:71]
    s_and_b64 s[82:83], vcc, s[80:81]
    s_cbranch_scc1 L2_c121
L2_d121:
    v_mov_b64 v[84:85], v[70:71]
    v_mov_b32 v7, v95
    v_mov_b64 v[86:87], v[74:75]
    s_mov_b64 exec, -1
    s_or_b64 s[80:81], s[80:81], vcc
    v_cmpx_ne_u64 vcc, v[72:73], v[68:69]
    s_and_b64 s[82:83], vcc, s[80:81]
    s_cbranch_scc1 L2_c122
L2_d122:
    v_mov_b64 v[84:85], v[68:69]
    v_mov_b32 v7, v94
    v_mov_b64 v[86:87], v[72:73]
    s_mov_b64 exec, -1
    s_or_b64 s[80:81], s[80:81], vcc
    ds_read_b64 v[70:71], v93 offset:65408
    s_and_b64 exec, s[84:85], s[80:81]
    v_mfma_f32_4x4x4_16b_bf16 v[76:79], v[12:13], v[84:85], 0
    v_mov_b32 v92, v7
    s_andn2_b64 s[80:81], s[80:81], s[84:85]
    v_mfma_f32_4x4x4_16b_bf16 v[76:79], v[10:11], v[86:87], v[76:79]
    s_mov_b64 exec, -1
    ds_read_b64 v[68:69], v92 offset:65408
    v_and_b32 v46, 0x80000000, v33
    v_lshrrev_b32 v47, 14, v31
    v_bitop3_b32 v47, v47, v5, v46 bitop3:0xea
    ds_read_b64 v[106:107], v47
    v_bitop3_b32 v95, v31, v5, v46 bitop3:0xea
    v_and_b32 v46, 0x40000000, v33
    v_lshrrev_b32 v47, 14, v30
    v_bitop3_b32 v47, v47, v5, v46 bitop3:0xea
    ds_read_b64 v[104:105], v47
    v_bitop3_b32 v94, v30, v5, v46 bitop3:0xea
    s_waitcnt lgkmcnt(2)
    v_mfma_f32_4x4x4_16b_bf16 v[80:83], v[10:11], v[70:71], v[80:83]
    v_mfma_f32_4x4x4_16b_bf16 v[76:79], v[10:11], v[68:69], v[76:79]
    v_perm_b32 v15, v31, v32, s47
    v_bitop3_b32 v46, v31, 0.5, -0.5 bitop3:0xa8
    v_perm_b32 v14, v30, v32, s46
    v_bitop3_b32 v47, v30, 0.5, -0.5 bitop3:0xa8
    v_cvt_pk_bf16_f32 v80, v80, v81
    v_cvt_pk_bf16_f32 v81, v82, v83
    ds_wrxchg_rtn_b64 v[74:75], v93, v[80:81] offset:65408
    v_cvt_pk_bf16_f32 v76, v76, v77
    v_cvt_pk_bf16_f32 v77, v78, v79
    ds_wrxchg_rtn_b64 v[72:73], v92, v[76:77] offset:65408
    s_setprio 0
    s_waitcnt lgkmcnt(2)
    v_mfma_f32_4x4x4_16b_bf16 v[80:83], v[8:9], v[106:107], 0
    v_mfma_f32_4x4x4_16b_bf16 v[76:79], v[8:9], v[104:105], 0
    v_bitop3_b32 v15, v6, v15, v46 bitop3:0xca
    v_bitop3_b32 v14, v6, v14, v47 bitop3:0xca
    s_nop 1
    v_pk_mul_f32 v[80:81], v[80:81], v[14:15] op_sel:[0,1] op_sel_hi:[1,1]
    v_pk_mul_f32 v[82:83], v[82:83], v[14:15] op_sel:[0,1] op_sel_hi:[1,1]
    v_pk_mul_f32 v[76:77], v[76:77], v[14:15] op_sel:[0,0] op_sel_hi:[1,0]
    v_pk_mul_f32 v[78:79], v[78:79], v[14:15] op_sel:[0,0] op_sel_hi:[1,0]
    s_add_u32 s40, s40, 0xfff24000
    v_and_b32 v47, 0x0fffffff, v42
    v_mov_b32 v33, v42
    buffer_load_dwordx2 v[28:29], v47, s[8:11], 0 offen
    buffer_load_dwordx3 v[30:32], v47, s[8:11], 0 offen offset:8
    s_waitcnt lgkmcnt(0)
    v_cmpx_ne_u64 vcc, v[74:75], v[70:71]
    s_and_b64 s[82:83], vcc, s[80:81]
    s_cbranch_scc1 L2_c123
L2_d123:
    v_mov_b64 v[84:85], v[70:71]
    v_mov_b32 v7, v93
    v_mov_b64 v[86:87], v[74:75]
    s_mov_b64 exec, -1
    s_or_b64 s[80:81], s[80:81], vcc
    v_cmpx_ne_u64 vcc, v[72:73], v[68:69]
    s_and_b64 s[82:83], vcc, s[80:81]
    s_cbranch_scc1 L2_c124
L2_d124:
    v_mov_b64 v[84:85], v[68:69]
    v_mov_b32 v7, v92
    v_mov_b64 v[86:87], v[72:73]
    s_mov_b64 exec, -1
    s_or_b64 s[80:81], s[80:81], vcc
    ds_read_b64 v[70:71], v95 offset:65408
    ds_read_b64 v[68:69], v94 offset:65408
    s_waitcnt vmcnt(8)
    v_and_b32 v46, 0x20000000, v39
    v_lshrrev_b32 v47, 14, v35
    v_bitop3_b32 v47, v47, v5, v46 bitop3:0xea
    ds_read_b64 v[102:103], v47
    v_bitop3_b32 v93, v35, v5, v46 bitop3:0xea
    v_and_b32 v46, 0x10000000, v39
    v_lshrrev_b32 v47, 14, v34
    v_bitop3_b32 v47, v47, v5, v46 bitop3:0xea
    ds_read_b64 v[100:101], v47
    v_bitop3_b32 v92, v34, v5, v46 bitop3:0xea
    v_and_b32 v46, 0x80000000, v39
    v_lshrrev_b32 v47, 14, v37
    v_bitop3_b32 v47, v47, v5, v46 bitop3:0xea
    ds_read_b64 v[106:107], v47
    v_and_b32 v46, 0x40000000, v39
    v_lshrrev_b32 v47, 14, v36
    v_bitop3_b32 v47, v47, v5, v46 bitop3:0xea
    ds_read_b64 v[104:105], v47
    s_waitcnt lgkmcnt(4)
    v_mfma_f32_4x4x4_16b_bf16 v[80:83], v[10:11], v[70:71], v[80:83]
    v_mfma_f32_4x4x4_16b_bf16 v[76:79], v[10:11], v[68:69], v[76:79]
    v_perm_b32 v15, v35, v38, s45
    v_bitop3_b32 v46, v35, 0.5, -0.5 bitop3:0xa8
    v_perm_b32 v14, v34, v38, s44
    v_bitop3_b32 v47, v34, 0.5, -0.5 bitop3:0xa8
    v_cvt_pk_bf16_f32 v80, v80, v81
    v_cvt_pk_bf16_f32 v81, v82, v83
    ds_wrxchg_rtn_b64 v[74:75], v95, v[80:81] offset:65408
    v_cvt_pk_bf16_f32 v76, v76, v77
    v_cvt_pk_bf16_f32 v77, v78, v79
    ds_wrxchg_rtn_b64 v[72:73], v94, v[76:77] offset:65408
    s_waitcnt lgkmcnt(2)
    s_barrier
    s_setprio 3
    s_mov_b32 m0, s69
    s_nop 0
    ds_write_addtid_b32 v116 offset:32768
    ds_write_addtid_b32 v117 offset:33024
    ds_write_addtid_b32 v118 offset:33280
    ds_write_addtid_b32 v119 offset:33536
    ds_write_addtid_b32 v120 offset:33792
    ds_write_addtid_b32 v121 offset:34048
    ds_write_addtid_b32 v122 offset:34304
    ds_write_addtid_b32 v123 offset:34560
    v_mfma_f32_4x4x4_16b_bf16 v[80:83], v[8:9], v[102:103], 0
    v_mfma_f32_4x4x4_16b_bf16 v[76:79], v[8:9], v[100:101], 0
    v_bitop3_b32 v15, v6, v15, v46 bitop3:0xca
    v_bitop3_b32 v14, v6, v14, v47 bitop3:0xca
    v_cmp_lt_u32 s[84:85], v5, v92
    s_nop 0
    v_pk_mul_f32 v[80:81], v[80:81], v[14:15] op_sel:[0,1] op_sel_hi:[1,1]
    v_pk_mul_f32 v[82:83], v[82:83], v[14:15] op_sel:[0,1] op_sel_hi:[1,1]
    v_pk_mul_f32 v[76:77], v[76:77], v[14:15] op_sel:[0,0] op_sel_hi:[1,0]
    v_pk_mul_f32 v[78:79], v[78:79], v[14:15] op_sel:[0,0] op_sel_hi:[1,0]
    v_mov_b32 v44, v43
    s_setprio 2
    ds_write_addtid_b32 v124 offset:34816
    ds_write_addtid_b32 v125 offset:35072
    ds_write_addtid_b32 v126 offset:35328
    ds_write_addtid_b32 v127 offset:35584
    s_waitcnt lgkmcnt(12)
    v_cmpx_ne_u64 vcc, v[74:75], v[70:71]
    s_and_b64 s[82:83], vcc, s[80:81]
    s_cbranch_scc1 L2_c125
L2_d125:
    v_mov_b64 v[84:85], v[70:71]
    v_mov_b32 v7, v95
    v_mov_b64 v[86:87], v[74:75]
    s_mov_b64 exec, -1
    s_or_b64 s[80:81], s[80:81], vcc
    v_cmpx_ne_u64 vcc, v[72:73], v[68:69]
    s_and_b64 s[82:83], vcc, s[80:81]
    s_cbranch_scc1 L2_c126
L2_d126:
    v_mov_b64 v[84:85], v[68:69]
    v_mov_b32 v7, v94
    v_mov_b64 v[86:87], v[72:73]
    s_mov_b64 exec, -1
    s_or_b64 s[80:81], s[80:81], vcc
    ds_read_b64 v[70:71], v93 offset:65408
    s_and_b64 exec, s[84:85], s[80:81]
    v_mfma_f32_4x4x4_16b_bf16 v[76:79], v[12:13], v[84:85], 0
    v_mov_b32 v92, v7
    s_andn2_b64 s[80:81], s[80:81], s[84:85]
    v_mfma_f32_4x4x4_16b_bf16 v[76:79], v[10:11], v[86:87], v[76:79]
    s_mov_b64 exec, -1
    ds_read_b64 v[68:69], v92 offset:65408
    s_setprio 1
    s_waitcnt vmcnt(7)
    s_mov_b32 m0, s38
    s_nop 0
    ds_write_addtid_b32 v108 offset:0
    ds_write_addtid_b32 v109 offset:256
    ds_write_addtid_b32 v110 offset:512
    ds_write_addtid_b32 v111 offset:768
    s_waitcnt lgkmcnt(4)
    v_mfma_f32_4x4x4_16b_bf16 v[80:83], v[10:11], v[70:71], v[80:83]
    v_mfma_f32_4x4x4_16b_bf16 v[76:79], v[10:11], v[68:69], v[76:79]
    v_and_b32 v46, 0x40000000, v39
    v_bitop3_b32 v94, v36, v5, v46 bitop3:0xea
    v_and_b32 v46, 0x80000000, v39
    v_bitop3_b32 v95, v37, v5, v46 bitop3:0xea
    v_perm_b32 v15, v37, v38, s47
    v_bitop3_b32 v46, v37, 0.5, -0.5 bitop3:0xa8
    v_perm_b32 v14, v36, v38, s46
    v_bitop3_b32 v47, v36, 0.5, -0.5 bitop3:0xa8
    v_cvt_pk_bf16_f32 v80, v80, v81
    v_cvt_pk_bf16_f32 v81, v82, v83
    ds_wrxchg_rtn_b64 v[74:75], v93, v[80:81] offset:65408
    v_cvt_pk_bf16_f32 v76, v76, v77
    v_cvt_pk_bf16_f32 v77, v78, v79
    ds_wrxchg_rtn_b64 v[72:73], v92, v[76:77] offset:65408
    s_setprio 0
    s_waitcnt vmcnt(4)
    ds_write_addtid_b32 v112 offset:1024
    ds_write_addtid_b32 v113 offset:1280
    ds_write_addtid_b32 v114 offset:1536
    ds_write_addtid_b32 v115 offset:1792
    v_mfma_f32_4x4x4_16b_bf16 v[80:83], v[8:9], v[106:107], 0
    v_mfma_f32_4x4x4_16b_bf16 v[76:79], v[8:9], v[104:105], 0
    v_bitop3_b32 v15, v6, v15, v46 bitop3:0xca
    v_bitop3_b32 v14, v6, v14, v47 bitop3:0xca
    s_nop 1
    v_pk_mul_f32 v[80:81], v[80:81], v[14:15] op_sel:[0,1] op_sel_hi:[1,1]
    v_pk_mul_f32 v[82:83], v[82:83], v[14:15] op_sel:[0,1] op_sel_hi:[1,1]
    v_pk_mul_f32 v[76:77], v[76:77], v[14:15] op_sel:[0,0] op_sel_hi:[1,0]
    v_pk_mul_f32 v[78:79], v[78:79], v[14:15] op_sel:[0,0] op_sel_hi:[1,0]
    s_add_u32 s42, s42, 1
    s_waitcnt lgkmcnt(0)
    s_barrier
    s_bitcmp1_b32 s36, s42
    s_cbranch_scc1 L2_slow
L2_ret7:
    s_setprio 3
    v_and_b32 v47, 0x0fffffff, v44
    v_mov_b32 v39, v44
    buffer_load_dwordx2 v[34:35], v47, s[8:11], 0 offen
    buffer_load_dwordx3 v[36:38], v47, s[8:11], 0 offen offset:8
    v_cmpx_ne_u64 vcc, v[74:75], v[70:71]
    s_and_b64 s[82:83], vcc, s[80:81]
    s_cbranch_scc1 L2_c127
L2_d127:
    v_mov_b64 v[84:85], v[70:71]
    v_mov_b32 v7, v93
    v_mov_b64 v[86:87], v[74:75]
    s_mov_b64 exec, -1
    s_or_b64 s[80:81], s[80:81], vcc
    v_cmpx_ne_u64 vcc, v[72:73], v[68:69]
    s_and_b64 s[82:83], vcc, s[80:81]
    s_cbranch_scc1 L2_c128
L2_d128:
    v_mov_b64 v[84:85], v[68:69]
    v_mov_b32 v7, v92
    v_mov_b64 v[86:87], v[72:73]
    s_mov_b64 exec, -1
    s_or_b64 s[80:81], s[80:81], vcc
    ds_read_b64 v[70:71], v95 offset:65408
    ds_read_b64 v[68:69], v94 offset:65408
    v_and_b32 v46, 0x20000000, v21
    v_lshrrev_b32 v47, 14, v17
    v_bitop3_b32 v47, v47, v5, v46 bitop3:0xea
    ds_read_b64 v[102:103], v47
    v_bitop3_b32 v93, v17, v5, v46 bitop3:0xea
    v_and_b32 v46, 0x10000000, v21
    v_lshrrev_b32 v47, 14, v16
    v_bitop3_b32 v47, v47, v5, v46 bitop3:0xea
    ds_read_b64 v[100:101], v47
    v_bitop3_b32 v92, v16, v5, v46 bitop3:0xea
    s_waitcnt lgkmcnt(2)
    v_mfma_f32_4x4x4_16b_bf16 v[80:83], v[10:11], v[70:71], v[80:83]
    v_mfma_f32_4x4x4_16b_bf16 v[76:79], v[10:11], v[68:69], v[76:79]
    v_perm_b32 v15, v17, v20, s45
    v_bitop3_b32 v46, v17, 0.5, -0.5 bitop3:0xa8
    v_perm_b32 v14, v16, v20, s44
    v_bitop3_b32 v47, v16, 0.5, -0.5 bitop3:0xa8
    v_cvt_pk_bf16_f32 v80, v80, v81
    v_cvt_pk_bf16_f32 v81, v82, v83
    ds_wrxchg_rtn_b64 v[74:75], v95, v[80:81] offset:65408
    v_cvt_pk_bf16_f32 v76, v76, v77
    v_cvt_pk_bf16_f32 v77, v78, v79
    ds_wrxchg_rtn_b64 v[72:73], v94, v[76:77] offset:65408
    s_waitcnt lgkmcnt(2)
    v_mfma_f32_4x4x4_16b_bf16 v[80:83], v[8:9], v[102:103], 0
    v_mfma_f32_4x4x4_16b_bf16 v[76:79], v[8:9], v[100:101], 0
    v_bitop3_b32 v15, v6, v15, v46 bitop3:0xca
    v_bitop3_b32 v14, v6, v14, v47 bitop3:0xca
    v_cmp_lt_u32 s[84:85], v5, v92
    s_nop 0
    v_pk_mul_f32 v[80:81], v[80:81], v[14:15] op_sel:[0,1] op_sel_hi:[1,1]
    v_pk_mul_f32 v[82:83], v[82:83], v[14:15] op_sel:[0,1] op_sel_hi:[1,1]
    v_pk_mul_f32 v[76:77], v[76:77], v[14:15] op_sel:[0,0] op_sel_hi:[1,0]
    v_pk_mul_f32 v[78:79], v[78:79], v[14:15] op_sel:[0,0] op_sel_hi:[1,0]
    s_waitcnt lgkmcnt(0)
    v_cmpx_ne_u64 vcc, v[74:75], v[70:71]
    s_and_b64 s[82:83], vcc, s[80:81]
    s_cbranch_scc1 L2_c129
L2_d129:
    v_mov_b64 v[84:85], v[70:71]
    v_mov_b32 v7, v95
    v_mov_b64 v[86:87], v[74:75]
    s_mov_b64 exec, -1
    s_or_b64 s[80:81], s[80:81], vcc
    v_cmpx_ne_u64 vcc, v[72:73], v[68:69]
    s_and_b64 s[82:83], vcc, s[80:81]
    s_cbranch_scc1 L2_c130
L2_d130:
    v_mov_b64 v[84:85], v[68:69]
    v_mov_b32 v7, v94
    v_mov_b64 v[86:87], v[72:73]
    s_mov_b64 exec, -1
    s_or_b64 s[80:81], s[80:81], vcc
    ds_read_b64 v[70:71], v93 offset:65408
    s_and_b64 exec, s[84:85], s[80:81]
    v_mfma_f32_4x4x4_16b_bf16 v[76:79], v[12:13], v[84:85], 0
    v_mov_b32 v92, v7
    s_andn2_b64 s[80:81], s[80:81], s[84:85]
    v_mfma_f32_4x4x4_16b_bf16 v[76:79], v[10:11], v[86:87], v[76:79]
    s_mov_b64 exec, -1
    ds_read_b64 v[68:69], v92 offset:65408
    v_and_b32 v46, 0x80000000, v21
    v_lshrrev_b32 v47, 14, v19
    v_bitop3_b32 v47, v47, v5, v46 bitop3:0xea
    ds_read_b64 v[106:107], v47
    v_bitop3_b32 v95, v19, v5, v46 bitop3:0xea
    v_and_b32 v46, 0x40000000, v21
    v_lshrrev_b32 v47, 14, v18
    v_bitop3_b32 v47, v47, v5, v46 bitop3:0xea
    ds_read_b64 v[104:105], v47
    v_bitop3_b32 v94, v18, v5, v46 bitop3:0xea
    s_waitcnt lgkmcnt(2)
    v_mfma_f32_4x4x4_16b_bf16 v[80:83], v[10:11], v[70:71], v[80:83]
    v_mfma_f32_4x4x4_16b_bf16 v[76:79], v[10:11], v[68:69], v[76:79]
    v_perm_b32 v15, v19, v20, s47
    v_bitop3_b32 v46, v19, 0.5, -0.5 bitop3:0xa8
    v_perm_b32 v14, v18, v20, s46
    v_bitop3_b32 v47, v18, 0.5, -0.5 bitop3:0xa8
    v_cvt_pk_bf16_f32 v80, v80, v81
    v_cvt_pk_bf16_f32 v81, v82, v83
    ds_wrxchg_rtn_b64 v[74:75], v93, v[80:81] offset:65408
    v_cvt_pk_bf16_f32 v76, v76, v77
    v_cvt_pk_bf16_f32 v77, v78, v79
    ds_wrxchg_rtn_b64 v[72:73], v92, v[76:77] offset:65408
    s_setprio 2
    s_waitcnt lgkmcnt(2)
    v_mfma_f32_4x4x4_16b_bf16 v[80:83], v[8:9], v[106:107], 0
    v_mfma_f32_4x4x4_16b_bf16 v[76:79], v[8:9], v[104:105], 0
    v_bitop3_b32 v15, v6, v15, v46 bitop3:0xca
    v_bitop3_b32 v14, v6, v14, v47 bitop3:0xca
    s_nop 1
    v_pk_mul_f32 v[80:81], v[80:81], v[14:15] op_sel:[0,1] op_sel_hi:[1,1]
    v_pk_mul_f32 v[82:83], v[82:83], v[14:15] op_sel:[0,1] op_sel_hi:[1,1]
    v_pk_mul_f32 v[76:77], v[76:77], v[14:15] op_sel:[0,0] op_sel_hi:[1,0]
    v_pk_mul_f32 v[78:79], v[78:79], v[14:15] op_sel:[0,0] op_sel_hi:[1,0]
    s_lshl_b32 s3, s32, 12
    v_subrev_u32 v122, s3, v3
    s_mul_i32 s3, s33, 20000
    v_add_u32 v118, s3, v122
    v_add_u32 v119, 0x4000, v118
    s_lshl_b32 s3, s34, 7
    v_lshrrev_b32 v123, 7, v118
    v_and_b32 v120, 0x70, v118
    v_lshl_add_u32 v120, v123, 13, v120
    v_add_u32 v120, s3, v120
    v_lshrrev_b32 v123, 7, v119
    v_and_b32 v121, 0x70, v119
    v_lshl_add_u32 v121, v123, 13, v121
    v_add_u32 v121, s3, v121
    v_cmp_le_u32 vcc, 3616, v122
    s_mov_b64 exec, vcc
    v_mov_b32 v119, 2.0
    v_mov_b32 v121, 2.0
    s_mov_b64 exec, -1
    v_and_b32 v123, 0x30, v122
    v_lshlrev_b32 v123, 2, v123
    buffer_load_dwordx4 v[48:51], v123, s[24:27], 0 offen
    buffer_load_dwordx4 v[52:55], v123, s[24:27], 0 offen offset:16
    buffer_load_dwordx2 v[56:57], v123, s[24:27], 0 offen offset:32
    s_mov_b32 s12, s4
    s_mov_b32 s13, s5
    s_mov_b32 s14, 0x138800
    s_mov_b32 s15, 0x20000
    s_mov_b32 s16, s28
    s_mov_b32 s17, s29
    s_mov_b32 s18, 0x4e2000
    s_mov_b32 s19, 0x20000
    v_lshrrev_b32 v123, 2, v120
    buffer_load_dword v116, v123, s[12:15], 0 offen
    buffer_load_dwordx4 v[108:111], v120, s[16:19], 0 offen
    v_lshrrev_b32 v123, 2, v121
    buffer_load_dword v117, v123, s[12:15], 0 offen
    buffer_load_dwordx4 v[112:115], v121, s[16:19], 0 offen
    s_waitcnt lgkmcnt(0)
    v_cmpx_ne_u64 vcc, v[74:75], v[70:71]
    s_and_b64 s[82:83], vcc, s[80:81]
    s_cbranch_scc1 L2_c131
L2_d131:
    v_mov_b64 v[84:85], v[70:71]
    v_mov_b32 v7, v93
    v_mov_b64 v[86:87], v[74:75]
    s_mov_b64 exec, -1
    s_or_b64 s[80:81], s[80:81], vcc
    v_cmpx_ne_u64 vcc, v[72:73], v[68:69]
    s_and_b64 s[82:83], vcc, s[80:81]
    s_cbranch_scc1 L2_c132
L2_d132:
    v_mov_b64 v[84:85], v[68:69]
    v_mov_b32 v7, v92
    v_mov_b64 v[86:87], v[72:73]
    s_mov_b64 exec, -1
    s_or_b64 s[80:81], s[80:81], vcc
    ds_read_b64 v[70:71], v95 offset:65408
    ds_read_b64 v[68:69], v94 offset:65408
    s_waitcnt vmcnt(11)
    v_and_b32 v46, 0x20000000, v27
    v_lshrrev_b32 v47, 14, v23
    v_bitop3_b32 v47, v47, v5, v46 bitop3:0xea
    ds_read_b64 v[102:103], v47
    v_bitop3_b32 v93, v23, v5, v46 bitop3:0xea
    v_and_b32 v46, 0x10000000, v27
    v_lshrrev_b32 v47, 14, v22
    v_bitop3_b32 v47, v47, v5, v46 bitop3:0xea
    ds_read_b64 v[100:101], v47
    v_bitop3_b32 v92, v22, v5, v46 bitop3:0xea
    s_waitcnt lgkmcnt(2)
    v_mfma_f32_4x4x4_16b_bf16 v[80:83], v[10:11], v[70:71], v[80:83]
    v_mfma_f32_4x4x4_16b_bf16 v[76:79], v[10:11], v[68:69], v[76:79]
    v_perm_b32 v15, v23, v26, s45
    v_bitop3_b32 v46, v23, 0.5, -0.5 bitop3:0xa8
    v_perm_b32 v14, v22, v26, s44
    v_bitop3_b32 v47, v22, 0.5, -0.5 bitop3:0xa8
    v_cvt_pk_bf16_f32 v80, v80, v81
    v_cvt_pk_bf16_f32 v81, v82, v83
    ds_wrxchg_rtn_b64 v[74:75], v95, v[80:81] offset:65408
    v_cvt_pk_bf16_f32 v76, v76, v77
    v_cvt_pk_bf16_f32 v77, v78, v79
    ds_wrxchg_rtn_b64 v[72:73], v94, v[76:77] offset:65408
    s_waitcnt lgkmcnt(2)
    v_mfma_f32_4x4x4_16b_bf16 v[80:83], v[8:9], v[102:103], 0
    v_mfma_f32_4x4x4_16b_bf16 v[76:79], v[8:9], v[100:101], 0
    v_bitop3_b32 v15, v6, v15, v46 bitop3:0xca
    v_bitop3_b32 v14, v6, v14, v47 bitop3:0xca
    v_cmp_lt_u32 s[84:85], v5, v92
    s_nop 0
    v_pk_mul_f32 v[80:81], v[80:81], v[14:15] op_sel:[0,1] op_sel_hi:[1,1]
    v_pk_mul_f32 v[82:83], v[82:83], v[14:15] op_sel:[0,1] op_sel_hi:[1,1]
    v_pk_mul_f32 v[76:77], v[76:77], v[14:15] op_sel:[0,0] op_sel_hi:[1,0]
    v_pk_mul_f32 v[78:79], v[78:79], v[14:15] op_sel:[0,0] op_sel_hi:[1,0]
    s_waitcnt lgkmcnt(0)
    v_cmpx_ne_u64 vcc, v[74:75], v[70:71]
    s_and_b64 s[82:83], vcc, s[80:81]
    s_cbranch_scc1 L2_c133
L2_d133:
    v_mov_b64 v[84:85], v[70:71]
    v_mov_b32 v7, v95
    v_mov_b64 v[86:87], v[74:75]
    s_mov_b64 exec, -1
    s_or_b64 s[80:81], s[80:81], vcc
    v_cmpx_ne_u64 vcc, v[72:73], v[68:69]
    s_and_b64 s[82:83], vcc, s[80:81]
    s_cbranch_scc1 L2_c134
L2_d134:
    v_mov_b64 v[84:85], v[68:69]
    v_mov_b32 v7, v94
    v_mov_b64 v[86:87], v[72:73]
    s_mov_b64 exec, -1
    s_or_b64 s[80:81], s[80:81], vcc
    ds_read_b64 v[70:71], v93 offset:65408
    s_and_b64 exec, s[84:85], s[80:81]
    v_mfma_f32_4x4x4_16b_bf16 v[76:79], v[12:13], v[84:85], 0
    v_mov_b32 v92, v7
    s_andn2_b64 s[80:81], s[80:81], s[84:85]
    v_mfma_f32_4x4x4_16b_bf16 v[76:79], v[10:11], v[86:87], v[76:79]
    s_mov_b64 exec, -1
    ds_read_b64 v[68:69], v92 offset:65408
    v_and_b32 v46, 0x80000000, v27
    v_lshrrev_b32 v47, 14, v25
    v_bitop3_b32 v47, v47, v5, v46 bitop3:0xea
    ds_read_b64 v[106:107], v47
    v_bitop3_b32 v95, v25, v5, v46 bitop3:0xea
    v_and_b32 v46, 0x40000000, v27
    v_lshrrev_b32 v47, 14, v24
    v_bitop3_b32 v47, v47, v5, v46 bitop3:0xea
    ds_read_b64 v[104:105], v47
    v_bitop3_b32 v94, v24, v5, v46 bitop3:0xea
    s_waitcnt lgkmcnt(2)
    v_mfma_f32_4x4x4_16b_bf16 v[80:83], v[10:11], v[70:71], v[80:83]
    v_mfma_f32_4x4x4_16b_bf16 v[76:79], v[10:11], v[68:69], v[76:79]
    v_perm_b32 v15, v25, v26, s47
    v_bitop3_b32 v46, v25, 0.5, -0.5 bitop3:0xa8
    v_perm_b32 v14, v24, v26, s46
    v_bitop3_b32 v47, v24, 0.5, -0.5 bitop3:0xa8
    v_cvt_pk_bf16_f32 v80, v80, v81
    v_cvt_pk_bf16_f32 v81, v82, v83
    ds_wrxchg_rtn_b64 v[74:75], v93, v[80:81] offset:65408
    v_cvt_pk_bf16_f32 v76, v76, v77
    v_cvt_pk_bf16_f32 v77, v78, v79
    ds_wrxchg_rtn_b64 v[72:73], v92, v[76:77] offset:65408
    s_setprio 1
    s_waitcnt lgkmcnt(2)
    v_mfma_f32_4x4x4_16b_bf16 v[80:83], v[8:9], v[106:107], 0
    v_mfma_f32_4x4x4_16b_bf16 v[76:79], v[8:9], v[104:105], 0
    v_bitop3_b32 v15, v6, v15, v46 bitop3:0xca
    v_bitop3_b32 v14, v6, v14, v47 bitop3:0xca
    s_nop 1
    v_pk_mul_f32 v[80:81], v[80:81], v[14:15] op_sel:[0,1] op_sel_hi:[1,1]
    v_pk_mul_f32 v[82:83], v[82:83], v[14:15] op_sel:[0,1] op_sel_hi:[1,1]
    v_pk_mul_f32 v[76:77], v[76:77], v[14:15] op_sel:[0,0] op_sel_hi:[1,0]
    v_pk_mul_f32 v[78:79], v[78:79], v[14:15] op_sel:[0,0] op_sel_hi:[1,0]
    s_waitcnt lgkmcnt(0)
    v_cmpx_ne_u64 vcc, v[74:75], v[70:71]
    s_and_b64 s[82:83], vcc, s[80:81]
    s_cbranch_scc1 L2_c135
L2_d135:
    v_mov_b64 v[84:85], v[70:71]
    v_mov_b32 v7, v93
    v_mov_b64 v[86:87], v[74:75]
    s_mov_b64 exec, -1
    s_or_b64 s[80:81], s[80:81], vcc
    v_cmpx_ne_u64 vcc, v[72:73], v[68:69]
    s_and_b64 s[82:83], vcc, s[80:81]
    s_cbranch_scc1 L2_c136
L2_d136:
    v_mov_b64 v[84:85], v[68:69]
    v_mov_b32 v7, v92
    v_mov_b64 v[86:87], v[72:73]
    s_mov_b64 exec, -1
    s_or_b64 s[80:81], s[80:81], vcc
    ds_read_b64 v[70:71], v95 offset:65408
    ds_read_b64 v[68:69], v94 offset:65408
    s_waitcnt vmcnt(9)
    v_and_b32 v46, 0x20000000, v33
    v_lshrrev_b32 v47, 14, v29
    v_bitop3_b32 v47, v47, v5, v46 bitop3:0xea
    ds_read_b64 v[102:103], v47
    v_bitop3_b32 v93, v29, v5, v46 bitop3:0xea
    v_and_b32 v46, 0x10000000, v33
    v_lshrrev_b32 v47, 14, v28
    v_bitop3_b32 v47, v47, v5, v46 bitop3:0xea
    ds_read_b64 v[100:101], v47
    v_bitop3_b32 v92, v28, v5, v46 bitop3:0xea
    s_waitcnt lgkmcnt(2)
    v_mfma_f32_4x4x4_16b_bf16 v[80:83], v[10:11], v[70:71], v[80:83]
    v_mfma_f32_4x4x4_16b_bf16 v[76:79], v[10:11], v[68:69], v[76:79]
    v_perm_b32 v15, v29, v32, s45
    v_bitop3_b32 v46, v29, 0.5, -0.5 bitop3:0xa8
    v_perm_b32 v14, v28, v32, s44
    v_bitop3_b32 v47, v28, 0.5, -0.5 bitop3:0xa8
    v_cvt_pk_bf16_f32 v80, v80, v81
    v_cvt_pk_bf16_f32 v81, v82, v83
    ds_wrxchg_rtn_b64 v[74:75], v95, v[80:81] offset:65408
    v_cvt_pk_bf16_f32 v76, v76, v77
    v_cvt_pk_bf16_f32 v77, v78, v79
    ds_wrxchg_rtn_b64 v[72:73], v94, v[76:77] offset:65408
    s_waitcnt lgkmcnt(2)
    v_mfma_f32_4x4x4_16b_bf16 v[80:83], v[8:9], v[102:103], 0
    v_mfma_f32_4x4x4_16b_bf16 v[76:79], v[8:9], v[100:101], 0
    v_bitop3_b32 v15, v6, v15, v46 bitop3:0xca
    v_bitop3_b32 v14, v6, v14, v47 bitop3:0xca
    v_cmp_lt_u32 s[84:85], v5, v92
    s_nop 0
    v_pk_mul_f32 v[80:81], v[80:81], v[14:15] op_sel:[0,1] op_sel_hi:[1,1]
    v_pk_mul_f32 v[82:83], v[82:83], v[14:15] op_sel:[0,1] op_sel_hi:[1,1]
    v_pk_mul_f32 v[76:77], v[76:77], v[14:15] op_sel:[0,0] op_sel_hi:[1,0]
    v_pk_mul_f32 v[78:79], v[78:79], v[14:15] op_sel:[0,0] op_sel_hi:[1,0]
    s_waitcnt lgkmcnt(0)
    v_cmpx_ne_u64 vcc, v[74:75], v[70:71]
    s_and_b64 s[82:83], vcc, s[80:81]
    s_cbranch_scc1 L2_c137
L2_d137:
    v_mov_b64 v[84:85], v[70:71]
    v_mov_b32 v7, v95
    v_mov_b64 v[86:87], v[74:75]
    s_mov_b64 exec, -1
    s_or_b64 s[80:81], s[80:81], vcc
    v_cmpx_ne_u64 vcc, v[72:73], v[68:69]
    s_and_b64 s[82:83], vcc, s[80:81]
    s_cbranch_scc1 L2_c138
L2_d138:
    v_mov_b64 v[84:85], v[68:69]
    v_mov_b32 v7, v94
    v_mov_b64 v[86:87], v[72:73]
    s_mov_b64 exec, -1
    s_or_b64 s[80:81], s[80:81], vcc
    ds_read_b64 v[70:71], v93 offset:65408
    s_and_b64 exec, s[84:85], s[80:81]
    v_mfma_f32_4x4x4_16b_bf16 v[76:79], v[12:13], v[84:85], 0
    v_mov_b32 v92, v7
    s_andn2_b64 s[80:81], s[80:81], s[84:85]
    v_mfma_f32_4x4x4_16b_bf16 v[76:79], v[10:11], v[86:87], v[76:79]
    s_mov_b64 exec, -1
    ds_read_b64 v[68:69], v92 offset:65408
    v_and_b32 v46, 0x80000000, v33
    v_lshrrev_b32 v47, 14, v31
    v_bitop3_b32 v47, v47, v5, v46 bitop3:0xea
    ds_read_b64 v[106:107], v47
    v_bitop3_b32 v95, v31, v5, v46 bitop3:0xea
    v_and_b32 v46, 0x40000000, v33
    v_lshrrev_b32 v47, 14, v30
    v_bitop3_b32 v47, v47, v5, v46 bitop3:0xea
    ds_read_b64 v[104:105], v47
    v_bitop3_b32 v94, v30, v5, v46 bitop3:0xea
    s_waitcnt lgkmcnt(2)
    v_mfma_f32_4x4x4_16b_bf16 v[80:83], v[10:11], v[70:71], v[80:83]
    v_mfma_f32_4x4x4_16b_bf16 v[76:79], v[10:11], v[68:69], v[76:79]
    v_perm_b32 v15, v31, v32, s47
    v_bitop3_b32 v46, v31, 0.5, -0.5 bitop3:0xa8
    v_perm_b32 v14, v30, v32, s46
    v_bitop3_b32 v47, v30, 0.5, -0.5 bitop3:0xa8
    v_cvt_pk_bf16_f32 v80, v80, v81
    v_cvt_pk_bf16_f32 v81, v82, v83
    ds_wrxchg_rtn_b64 v[74:75], v93, v[80:81] offset:65408
    v_cvt_pk_bf16_f32 v76, v76, v77
    v_cvt_pk_bf16_f32 v77, v78, v79
    ds_wrxchg_rtn_b64 v[72:73], v92, v[76:77] offset:65408
    s_setprio 0
    s_waitcnt lgkmcnt(2)
    v_mfma_f32_4x4x4_16b_bf16 v[80:83], v[8:9], v[106:107], 0
    v_mfma_f32_4x4x4_16b_bf16 v[76:79], v[8:9], v[104:105], 0
    v_bitop3_b32 v15, v6, v15, v46 bitop3:0xca
    v_bitop3_b32 v14, v6, v14, v47 bitop3:0xca
    s_nop 1
    v_pk_mul_f32 v[80:81], v[80:81], v[14:15] op_sel:[0,1] op_sel_hi:[1,1]
    v_pk_mul_f32 v[82:83], v[82:83], v[14:15] op_sel:[0,1] op_sel_hi:[1,1]
    v_pk_mul_f32 v[76:77], v[76:77], v[14:15] op_sel:[0,0] op_sel_hi:[1,0]
    v_pk_mul_f32 v[78:79], v[78:79], v[14:15] op_sel:[0,0] op_sel_hi:[1,0]
    s_waitcnt lgkmcnt(0)
    v_cmpx_ne_u64 vcc, v[74:75], v[70:71]
    s_and_b64 s[82:83], vcc, s[80:81]
    s_cbranch_scc1 L2_c139
L2_d139:
    v_mov_b64 v[84:85], v[70:71]
    v_mov_b32 v7, v93
    v_mov_b64 v[86:87], v[74:75]
    s_mov_b64 exec, -1
    s_or_b64 s[80:81], s[80:81], vcc
    v_cmpx_ne_u64 vcc, v[72:73], v[68:69]
    s_and_b64 s[82:83], vcc, s[80:81]
    s_cbranch_scc1 L2_c140
L2_d140:
    v_mov_b64 v[84:85], v[68:69]
    v_mov_b32 v7, v92
    v_mov_b64 v[86:87], v[72:73]
    s_mov_b64 exec, -1
    s_or_b64 s[80:81], s[80:81], vcc
    ds_read_b64 v[70:71], v95 offset:65408
    ds_read_b64 v[68:69], v94 offset:65408
    s_waitcnt vmcnt(7)
    v_and_b32 v46, 0x20000000, v39
    v_lshrrev_b32 v47, 14, v35
    v_bitop3_b32 v47, v47, v5, v46 bitop3:0xea
    ds_read_b64 v[102:103], v47
    v_bitop3_b32 v93, v35, v5, v46 bitop3:0xea
    v_and_b32 v46, 0x10000000, v39
    v_lshrrev_b32 v47, 14, v34
    v_bitop3_b32 v47, v47, v5, v46 bitop3:0xea
    ds_read_b64 v[100:101], v47
    v_bitop3_b32 v92, v34, v5, v46 bitop3:0xea
    v_and_b32 v46, 0x80000000, v39
    v_lshrrev_b32 v47, 14, v37
    v_bitop3_b32 v47, v47, v5, v46 bitop3:0xea
    ds_read_b64 v[106:107], v47
    v_and_b32 v46, 0x40000000, v39
    v_lshrrev_b32 v47, 14, v36
    v_bitop3_b32 v47, v47, v5, v46 bitop3:0xea
    ds_read_b64 v[104:105], v47
    s_waitcnt lgkmcnt(4)
    v_mfma_f32_4x4x4_16b_bf16 v[80:83], v[10:11], v[70:71], v[80:83]
    v_mfma_f32_4x4x4_16b_bf16 v[76:79], v[10:11], v[68:69], v[76:79]
    v_perm_b32 v15, v35, v38, s45
    v_bitop3_b32 v46, v35, 0.5, -0.5 bitop3:0xa8
    v_perm_b32 v14, v34, v38, s44
    v_bitop3_b32 v47, v34, 0.5, -0.5 bitop3:0xa8
    v_cvt_pk_bf16_f32 v80, v80, v81
    v_cvt_pk_bf16_f32 v81, v82, v83
    ds_wrxchg_rtn_b64 v[74:75], v95, v[80:81] offset:65408
    v_cvt_pk_bf16_f32 v76, v76, v77
    v_cvt_pk_bf16_f32 v77, v78, v79
    ds_wrxchg_rtn_b64 v[72:73], v94, v[76:77] offset:65408
    s_waitcnt lgkmcnt(4)
    v_mfma_f32_4x4x4_16b_bf16 v[80:83], v[8:9], v[102:103], 0
    v_mfma_f32_4x4x4_16b_bf16 v[76:79], v[8:9], v[100:101], 0
    v_bitop3_b32 v15, v6, v15, v46 bitop3:0xca
    v_bitop3_b32 v14, v6, v14, v47 bitop3:0xca
    v_cmp_lt_u32 s[84:85], v5, v92
    s_nop 0
    v_pk_mul_f32 v[80:81], v[80:81], v[14:15] op_sel:[0,1] op_sel_hi:[1,1]
    v_pk_mul_f32 v[82:83], v[82:83], v[14:15] op_sel:[0,1] op_sel_hi:[1,1]
    v_pk_mul_f32 v[76:77], v[76:77], v[14:15] op_sel:[0,0] op_sel_hi:[1,0]
    v_pk_mul_f32 v[78:79], v[78:79], v[14:15] op_sel:[0,0] op_sel_hi:[1,0]
    s_waitcnt lgkmcnt(0)
    v_cmpx_ne_u64 vcc, v[74:75], v[70:71]
    s_and_b64 s[82:83], vcc, s[80:81]
    s_cbranch_scc1 L2_c141
L2_d141:
    v_mov_b64 v[84:85], v[70:71]
    v_mov_b32 v7, v95
    v_mov_b64 v[86:87], v[74:75]
    s_mov_b64 exec, -1
    s_or_b64 s[80:81], s[80:81], vcc
    v_cmpx_ne_u64 vcc, v[72:73], v[68:69]
    s_and_b64 s[82:83], vcc, s[80:81]
    s_cbranch_scc1 L2_c142
L2_d142:
    v_mov_b64 v[84:85], v[68:69]
    v_mov_b32 v7, v94
    v_mov_b64 v[86:87], v[72:73]
    s_mov_b64 exec, -1
    s_or_b64 s[80:81], s[80:81], vcc
    ds_read_b64 v[70:71], v93 offset:65408
    s_and_b64 exec, s[84:85], s[80:81]
    v_mfma_f32_4x4x4_16b_bf16 v[76:79], v[12:13], v[84:85], 0
    v_mov_b32 v92, v7
    s_andn2_b64 s[80:81], s[80:81], s[84:85]
    v_mfma_f32_4x4x4_16b_bf16 v[76:79], v[10:11], v[86:87], v[76:79]
    s_mov_b64 exec, -1
    ds_read_b64 v[68:69], v92 offset:65408
    s_waitcnt lgkmcnt(0)
    v_mfma_f32_4x4x4_16b_bf16 v[80:83], v[10:11], v[70:71], v[80:83]
    v_mfma_f32_4x4x4_16b_bf16 v[76:79], v[10:11], v[68:69], v[76:79]
    v_and_b32 v46, 0x40000000, v39
    v_bitop3_b32 v94, v36, v5, v46 bitop3:0xea
    v_and_b32 v46, 0x80000000, v39
    v_bitop3_b32 v95, v37, v5, v46 bitop3:0xea
    v_perm_b32 v15, v37, v38, s47
    v_bitop3_b32 v46, v37, 0.5, -0.5 bitop3:0xa8
    v_perm_b32 v14, v36, v38, s46
    v_bitop3_b32 v47, v36, 0.5, -0.5 bitop3:0xa8
    v_cvt_pk_bf16_f32 v80, v80, v81
    v_cvt_pk_bf16_f32 v81, v82, v83
    ds_wrxchg_rtn_b64 v[74:75], v93, v[80:81] offset:65408
    v_cvt_pk_bf16_f32 v76, v76, v77
    v_cvt_pk_bf16_f32 v77, v78, v79
    ds_wrxchg_rtn_b64 v[72:73], v92, v[76:77] offset:65408
    v_mfma_f32_4x4x4_16b_bf16 v[80:83], v[8:9], v[106:107], 0
    v_mfma_f32_4x4x4_16b_bf16 v[76:79], v[8:9], v[104:105], 0
    v_bitop3_b32 v15, v6, v15, v46 bitop3:0xca
    v_bitop3_b32 v14, v6, v14, v47 bitop3:0xca
    s_nop 1
    v_pk_mul_f32 v[80:81], v[80:81], v[14:15] op_sel:[0,1] op_sel_hi:[1,1]
    v_pk_mul_f32 v[82:83], v[82:83], v[14:15] op_sel:[0,1] op_sel_hi:[1,1]
    v_pk_mul_f32 v[76:77], v[76:77], v[14:15] op_sel:[0,0] op_sel_hi:[1,0]
    v_pk_mul_f32 v[78:79], v[78:79], v[14:15] op_sel:[0,0] op_sel_hi:[1,0]
    s_waitcnt lgkmcnt(0)
    v_cmpx_ne_u64 vcc, v[74:75], v[70:71]
    s_and_b64 s[82:83], vcc, s[80:81]
    s_cbranch_scc1 L2_c143
L2_d143:
    v_mov_b64 v[84:85], v[70:71]
    v_mov_b32 v7, v93
    v_mov_b64 v[86:87], v[74:75]
    s_mov_b64 exec, -1
    s_or_b64 s[80:81], s[80:81], vcc
    v_cmpx_ne_u64 vcc, v[72:73], v[68:69]
    s_and_b64 s[82:83], vcc, s[80:81]
    s_cbranch_scc1 L2_c144
L2_d144:
    v_mov_b64 v[84:85], v[68:69]
    v_mov_b32 v7, v92
    v_mov_b64 v[86:87], v[72:73]
    s_mov_b64 exec, -1
    s_or_b64 s[80:81], s[80:81], vcc
    ds_read_b64 v[70:71], v95 offset:65408
    ds_read_b64 v[68:69], v94 offset:65408
    s_waitcnt lgkmcnt(0)
    v_mfma_f32_4x4x4_16b_bf16 v[80:83], v[10:11], v[70:71], v[80:83]
    v_mfma_f32_4x4x4_16b_bf16 v[76:79], v[10:11], v[68:69], v[76:79]
    s_nop 3
    v_cvt_pk_bf16_f32 v80, v80, v81
    v_cvt_pk_bf16_f32 v81, v82, v83
    ds_wrxchg_rtn_b64 v[74:75], v95, v[80:81] offset:65408
    v_cvt_pk_bf16_f32 v76, v76, v77
    v_cvt_pk_bf16_f32 v77, v78, v79
    ds_wrxchg_rtn_b64 v[72:73], v94, v[76:77] offset:65408
    s_waitcnt lgkmcnt(0)
    v_cmpx_ne_u64 vcc, v[74:75], v[70:71]
    s_and_b64 s[82:83], vcc, s[80:81]
    s_cbranch_scc1 L2_c145
L2_d145:
    v_mov_b64 v[84:85], v[70:71]
    v_mov_b32 v7, v95
    v_mov_b64 v[86:87], v[74:75]
    s_mov_b64 exec, -1
    s_or_b64 s[80:81], s[80:81], vcc
    v_cmpx_ne_u64 vcc, v[72:73], v[68:69]
    s_and_b64 s[82:83], vcc, s[80:81]
    s_cbranch_scc1 L2_c146
L2_d146:
    v_mov_b64 v[84:85], v[68:69]
    v_mov_b32 v7, v94
    v_mov_b64 v[86:87], v[72:73]
    s_mov_b64 exec, -1
    s_or_b64 s[80:81], s[80:81], vcc
    s_mov_b64 exec, s[80:81]
    s_nop 1
    v_mfma_f32_4x4x4_16b_bf16 v[88:91], v[12:13], v[84:85], 0
    s_nop 1
    v_mfma_f32_4x4x4_16b_bf16 v[88:91], v[10:11], v[86:87], v[88:91]
    s_nop 4
    v_cvt_pk_bf16_f32 v88, v88, v89
    v_cvt_pk_bf16_f32 v89, v90, v91
    ds_pk_add_bf16 v7, v88 offset:65408
    ds_pk_add_bf16 v7, v89 offset:65412
    s_mov_b64 exec, -1
    s_load_dwordx2 s[4:5], s[0:1], 88
    v_add_u32 v123, 16384, v122
    v_add_u32 v124, 32768, v122
    v_add_u32 v125, 49152, v122
    v_add_u32 v126, 65536, v122
    s_lshl_b32 s50, s96, 16
    s_and_b32 s51, s96, 0xffff0000
    s_lshl_b32 s52, s97, 16
    s_and_b32 s53, s97, 0xffff0000
    s_lshl_b32 s54, s98, 16
    s_and_b32 s55, s98, 0xffff0000
    s_lshl_b32 s56, s99, 16
    s_and_b32 s57, s99, 0xffff0000
    s_waitcnt vmcnt(0) lgkmcnt(0)
    s_barrier
    v_add_u32 v36, 0x8000, v126
    ds_read_b128 v[16:19], v126 offset:16384
    ds_read_b128 v[20:23], v126 offset:32768
    ds_read_b128 v[24:27], v126 offset:49152
    ds_read_b128 v[28:31], v36 offset:32768
    ds_read_b128 v[32:35], v36 offset:49152
    s_add_u32 s8, s30, 0xebca000
    s_addc_u32 s9, s31, 0
    s_mov_b32 s10, 0x8000
    s_mov_b32 s11, 0x20000
    s_mov_b32 s12, s4
    s_mov_b32 s13, s5
    s_mov_b32 s14, 0x4e2000
    s_mov_b32 s15, 0x20000
    s_mul_i32 s3, s33, 20000
    v_subrev_u32 v36, s3, v122
    v_cmp_le_u32 vcc, 20000, v36
    s_waitcnt lgkmcnt(4)
    s_mov_b64 exec, vcc
    buffer_store_dwordx4 v[16:19], v122, s[20:23], 0 offen sc1
    s_mov_b64 exec, -1
    v_subrev_u32 v36, s3, v123
    v_cmp_le_u32 vcc, 20000, v36
    s_waitcnt lgkmcnt(3)
    s_mov_b64 exec, vcc
    buffer_store_dwordx4 v[20:23], v123, s[20:23], 0 offen sc1
    s_mov_b64 exec, -1
    v_subrev_u32 v36, s3, v124
    v_cmp_le_u32 vcc, 20000, v36
    s_waitcnt lgkmcnt(2)
    s_mov_b64 exec, vcc
    buffer_store_dwordx4 v[24:27], v124, s[20:23], 0 offen sc1
    s_mov_b64 exec, -1
    v_subrev_u32 v36, s3, v125
    v_cmp_le_u32 vcc, 20000, v36
    s_waitcnt lgkmcnt(1)
    s_mov_b64 exec, vcc
    buffer_store_dwordx4 v[28:31], v125, s[20:23], 0 offen sc1
    s_mov_b64 exec, -1
    v_subrev_u32 v36, s3, v126
    v_cmp_le_u32 vcc, 20000, v36
    s_waitcnt lgkmcnt(0)
    s_mov_b64 exec, vcc
    buffer_store_dwordx4 v[32:35], v126, s[20:23], 0 offen sc1
    s_mov_b64 exec, -1
    v_lshlrev_b32 v80, 16, v116
    v_subrev_f32 v60, s50, v80
    v_subrev_f32 v61, s51, v80
    v_subrev_f32 v62, s52, v80
    v_subrev_f32 v63, s53, v80
    v_subrev_f32 v64, s54, v80
    v_subrev_f32 v65, s55, v80
    v_subrev_f32 v66, s56, v80
    v_subrev_f32 v67, s57, v80
    v_cvt_pk_bf16_f32 v68, v60, v61
    v_cvt_pk_bf16_f32 v69, v62, v63
    v_cvt_pk_bf16_f32 v70, v64, v65
    v_cvt_pk_bf16_f32 v71, v66, v67
    v_lshlrev_b32 v60, 16, v68
    v_and_b32 v61, 0xffff0000, v68
    v_lshlrev_b32 v62, 16, v69
    v_and_b32 v63, 0xffff0000, v69
    v_lshlrev_b32 v64, 16, v70
    v_and_b32 v65, 0xffff0000, v70
    v_lshlrev_b32 v66, 16, v71
    v_and_b32 v67, 0xffff0000, v71
    v_mul_f32 v60, v60, v60
    v_mul_f32 v61, v61, v61
    v_mul_f32 v62, v62, v62
    v_mul_f32 v63, v63, v63
    v_mul_f32 v64, v64, v64
    v_mul_f32 v65, v65, v65
    v_mul_f32 v66, v66, v66
    v_mul_f32 v67, v67, v67
    v_cvt_pk_bf16_f32 v68, v60, v61
    v_cvt_pk_bf16_f32 v69, v62, v63
    v_cvt_pk_bf16_f32 v70, v64, v65
    v_cvt_pk_bf16_f32 v71, v66, v67
    v_lshlrev_b32 v60, 16, v68
    v_and_b32 v61, 0xffff0000, v68
    v_lshlrev_b32 v62, 16, v69
    v_and_b32 v63, 0xffff0000, v69
    v_lshlrev_b32 v64, 16, v70
    v_and_b32 v65, 0xffff0000, v70
    v_lshlrev_b32 v66, 16, v71
    v_and_b32 v67, 0xffff0000, v71
    v_mul_f32 v60, 0xc1200000, v60
    v_mul_f32 v61, 0xc1200000, v61
    v_mul_f32 v62, 0xc1200000, v62
    v_mul_f32 v63, 0xc1200000, v63
    v_mul_f32 v64, 0xc1200000, v64
    v_mul_f32 v65, 0xc1200000, v65
    v_mul_f32 v66, 0xc1200000, v66
    v_mul_f32 v67, 0xc1200000, v67
    v_cvt_pk_bf16_f32 v68, v60, v61
    v_cvt_pk_bf16_f32 v69, v62, v63
    v_cvt_pk_bf16_f32 v70, v64, v65
    v_cvt_pk_bf16_f32 v71, v66, v67
    v_lshlrev_b32 v60, 16, v68
    v_and_b32 v61, 0xffff0000, v68
    v_lshlrev_b32 v62, 16, v69
    v_and_b32 v63, 0xffff0000, v69
    v_lshlrev_b32 v64, 16, v70
    v_and_b32 v65, 0xffff0000, v70
    v_lshlrev_b32 v66, 16, v71
    v_and_b32 v67, 0xffff0000, v71
    v_mul_f32 v60, 0x3fb8aa3b, v60
    v_mul_f32 v61, 0x3fb8aa3b, v61
    v_mul_f32 v62, 0x3fb8aa3b, v62
    v_mul_f32 v63, 0x3fb8aa3b, v63
    v_mul_f32 v64, 0x3fb8aa3b, v64
    v_mul_f32 v65, 0x3fb8aa3b, v65
    v_mul_f32 v66, 0x3fb8aa3b, v66
    v_mul_f32 v67, 0x3fb8aa3b, v67
    v_exp_f32 v60, v60
    v_exp_f32 v61, v61
    v_exp_f32 v62, v62
    v_exp_f32 v63, v63
    v_exp_f32 v64, v64
    v_exp_f32 v65, v65
    v_exp_f32 v66, v66
    v_exp_f32 v67, v67
    v_cvt_pk_bf16_f32 v72, v60, v61
    v_cvt_pk_bf16_f32 v73, v62, v63
    v_cvt_pk_bf16_f32 v74, v64, v65
    v_cvt_pk_bf16_f32 v75, v66, v67
    v_and_b32 v80, 0xffff0000, v116
    v_subrev_f32 v60, s50, v80
    v_subrev_f32 v61, s51, v80
    v_subrev_f32 v62, s52, v80
    v_subrev_f32 v63, s53, v80
    v_subrev_f32 v64, s54, v80
    v_subrev_f32 v65, s55, v80
    v_subrev_f32 v66, s56, v80
    v_subrev_f32 v67, s57, v80
    v_cvt_pk_bf16_f32 v68, v60, v61
    v_cvt_pk_bf16_f32 v69, v62, v63
    v_cvt_pk_bf16_f32 v70, v64, v65
    v_cvt_pk_bf16_f32 v71, v66, v67
    v_lshlrev_b32 v60, 16, v68
    v_and_b32 v61, 0xffff0000, v68
    v_lshlrev_b32 v62, 16, v69
    v_and_b32 v63, 0xffff0000, v69
    v_lshlrev_b32 v64, 16, v70
    v_and_b32 v65, 0xffff0000, v70
    v_lshlrev_b32 v66, 16, v71
    v_and_b32 v67, 0xffff0000, v71
    v_mul_f32 v60, v60, v60
    v_mul_f32 v61, v61, v61
    v_mul_f32 v62, v62, v62
    v_mul_f32 v63, v63, v63
    v_mul_f32 v64, v64, v64
    v_mul_f32 v65, v65, v65
    v_mul_f32 v66, v66, v66
    v_mul_f32 v67, v67, v67
    v_cvt_pk_bf16_f32 v68, v60, v61
    v_cvt_pk_bf16_f32 v69, v62, v63
    v_cvt_pk_bf16_f32 v70, v64, v65
    v_cvt_pk_bf16_f32 v71, v66, v67
    v_lshlrev_b32 v60, 16, v68
    v_and_b32 v61, 0xffff0000, v68
    v_lshlrev_b32 v62, 16, v69
    v_and_b32 v63, 0xffff0000, v69
    v_lshlrev_b32 v64, 16, v70
    v_and_b32 v65, 0xffff0000, v70
    v_lshlrev_b32 v66, 16, v71
    v_and_b32 v67, 0xffff0000, v71
    v_mul_f32 v60, 0xc1200000, v60
    v_mul_f32 v61, 0xc1200000, v61
    v_mul_f32 v62, 0xc1200000, v62
    v_mul_f32 v63, 0xc1200000, v63
    v_mul_f32 v64, 0xc1200000, v64
    v_mul_f32 v65, 0xc1200000, v65
    v_mul_f32 v66, 0xc1200000, v66
    v_mul_f32 v67, 0xc1200000, v67
    v_cvt_pk_bf16_f32 v68, v60, v61
    v_cvt_pk_bf16_f32 v69, v62, v63
    v_cvt_pk_bf16_f32 v70, v64, v65
    v_cvt_pk_bf16_f32 v71, v66, v67
    v_lshlrev_b32 v60, 16, v68
    v_and_b32 v61, 0xffff0000, v68
    v_lshlrev_b32 v62, 16, v69
    v_and_b32 v63, 0xffff0000, v69
    v_lshlrev_b32 v64, 16, v70
    v_and_b32 v65, 0xffff0000, v70
    v_lshlrev_b32 v66, 16, v71
    v_and_b32 v67, 0xffff0000, v71
    v_mul_f32 v60, 0x3fb8aa3b, v60
    v_mul_f32 v61, 0x3fb8aa3b, v61
    v_mul_f32 v62, 0x3fb8aa3b, v62
    v_mul_f32 v63, 0x3fb8aa3b, v63
    v_mul_f32 v64, 0x3fb8aa3b, v64
    v_mul_f32 v65, 0x3fb8aa3b, v65
    v_mul_f32 v66, 0x3fb8aa3b, v66
    v_mul_f32 v67, 0x3fb8aa3b, v67
    v_exp_f32 v60, v60
    v_exp_f32 v61, v61
    v_exp_f32 v62, v62
    v_exp_f32 v63, v63
    v_exp_f32 v64, v64
    v_exp_f32 v65, v65
    v_exp_f32 v66, v66
    v_exp_f32 v67, v67
    v_cvt_pk_bf16_f32 v76, v60, v61
    v_cvt_pk_bf16_f32 v77, v62, v63
    v_cvt_pk_bf16_f32 v78, v64, v65
    v_cvt_pk_bf16_f32 v79, v66, v67
    v_mfma_f32_4x4x4_16b_bf16 v[80:83], v[48:49], v[72:73], 0
    v_mfma_f32_4x4x4_16b_bf16 v[88:91], v[52:53], v[72:73], 0
    v_mfma_f32_4x4x4_16b_bf16 v[84:87], v[48:49], v[76:77], 0
    v_mfma_f32_4x4x4_16b_bf16 v[92:95], v[52:53], v[76:77], 0
    v_mfma_f32_4x4x4_16b_bf16 v[80:83], v[50:51], v[74:75], v[80:83]
    v_mfma_f32_4x4x4_16b_bf16 v[88:91], v[54:55], v[74:75], v[88:91]
    v_mfma_f32_4x4x4_16b_bf16 v[84:87], v[50:51], v[78:79], v[84:87]
    v_mfma_f32_4x4x4_16b_bf16 v[92:95], v[54:55], v[78:79], v[92:95]
    v_add_u32 v104, 81920, v118
    ds_read_b128 v[32:35], v104
    v_add_u32 v104, 81920, v119
    ds_read_b128 v[60:63], v104
    s_add_u32 s20, s30, 0xd841000
    s_addc_u32 s21, s31, 0
    s_mov_b32 s22, 0x1388000
    s_mov_b32 s23, 0x20000
    s_add_u32 s3, s33, 1
    s_and_b32 s3, s3, 3
    s_lshl_b32 s3, s3, 6
    s_add_u32 s3, s3, s34
    s_mul_i32 s44, s3, 80000
    s_add_u32 s3, s33, 2
    s_and_b32 s3, s3, 3
    s_lshl_b32 s3, s3, 6
    s_add_u32 s3, s3, s34
    s_mul_i32 s45, s3, 80000
    s_add_u32 s3, s33, 3
    s_and_b32 s3, s3, 3
    s_lshl_b32 s3, s3, 6
    s_add_u32 s3, s3, s34
    s_mul_i32 s46, s3, 80000
    s_lshl_b32 s3, s34, 9
    s_lshl_b32 s4, s33, 7
    s_add_u32 s4, s4, s3
    v_mov_b32 v104, 1
    v_lshlrev_b32 v105, 3, v122
    s_waitcnt vmcnt(0)
    s_barrier
    s_cmp_lg_u32 s32, 0
    s_cbranch_scc1 L2_f2
    s_mov_b64 exec, 1
    buffer_store_dword v104, off, s[8:11], s4 sc1
    s_mov_b64 exec, 15
    s_bitset0_b64 exec, s33
L2_f3:
    buffer_load_dword v104, v105, s[8:11], s3 offen sc1
    s_waitcnt vmcnt(0)
    v_cmp_ne_u32 vcc, 1, v104
    s_cbranch_vccnz L2_f3
L2_f4:
    s_mov_b64 exec, -1
L2_f2:
    s_barrier
    buffer_load_dwordx4 v[36:39], v118, s[20:23], s44 offen sc1
    buffer_load_dwordx4 v[40:43], v118, s[20:23], s45 offen sc1
    buffer_load_dwordx4 v[44:47], v118, s[20:23], s46 offen sc1
    s_cmp_ge_u32 s32, 4
    s_cbranch_scc1 L2_f5
    buffer_load_dwordx4 v[64:67], v119, s[20:23], s44 offen sc1
    buffer_load_dwordx4 v[68:71], v119, s[20:23], s45 offen sc1
    buffer_load_dwordx4 v[72:75], v119, s[20:23], s46 offen sc1
    v_lshlrev_b32 v16, 16, v117
    v_subrev_f32 v96, s50, v16
    v_subrev_f32 v97, s51, v16
    v_subrev_f32 v98, s52, v16
    v_subrev_f32 v99, s53, v16
    v_subrev_f32 v100, s54, v16
    v_subrev_f32 v101, s55, v16
    v_subrev_f32 v102, s56, v16
    v_subrev_f32 v103, s57, v16
    v_cvt_pk_bf16_f32 v0, v96, v97
    v_cvt_pk_bf16_f32 v1, v98, v99
    v_cvt_pk_bf16_f32 v2, v100, v101
    v_cvt_pk_bf16_f32 v3, v102, v103
    v_lshlrev_b32 v96, 16, v0
    v_and_b32 v97, 0xffff0000, v0
    v_lshlrev_b32 v98, 16, v1
    v_and_b32 v99, 0xffff0000, v1
    v_lshlrev_b32 v100, 16, v2
    v_and_b32 v101, 0xffff0000, v2
    v_lshlrev_b32 v102, 16, v3
    v_and_b32 v103, 0xffff0000, v3
    v_mul_f32 v96, v96, v96
    v_mul_f32 v97, v97, v97
    v_mul_f32 v98, v98, v98
    v_mul_f32 v99, v99, v99
    v_mul_f32 v100, v100, v100
    v_mul_f32 v101, v101, v101
    v_mul_f32 v102, v102, v102
    v_mul_f32 v103, v103, v103
    v_cvt_pk_bf16_f32 v0, v96, v97
    v_cvt_pk_bf16_f32 v1, v98, v99
    v_cvt_pk_bf16_f32 v2, v100, v101
    v_cvt_pk_bf16_f32 v3, v102, v103
    v_lshlrev_b32 v96, 16, v0
    v_and_b32 v97, 0xffff0000, v0
    v_lshlrev_b32 v98, 16, v1
    v_and_b32 v99, 0xffff0000, v1
    v_lshlrev_b32 v100, 16, v2
    v_and_b32 v101, 0xffff0000, v2
    v_lshlrev_b32 v102, 16, v3
    v_and_b32 v103, 0xffff0000, v3
    v_mul_f32 v96, 0xc1200000, v96
    v_mul_f32 v97, 0xc1200000, v97
    v_mul_f32 v98, 0xc1200000, v98
    v_mul_f32 v99, 0xc1200000, v99
    v_mul_f32 v100, 0xc1200000, v100
    v_mul_f32 v101, 0xc1200000, v101
    v_mul_f32 v102, 0xc1200000, v102
    v_mul_f32 v103, 0xc1200000, v103
    v_cvt_pk_bf16_f32 v0, v96, v97
    v_cvt_pk_bf16_f32 v1, v98, v99
    v_cvt_pk_bf16_f32 v2, v100, v101
    v_cvt_pk_bf16_f32 v3, v102, v103
    v_lshlrev_b32 v96, 16, v0
    v_and_b32 v97, 0xffff0000, v0
    v_lshlrev_b32 v98, 16, v1
    v_and_b32 v99, 0xffff0000, v1
    v_lshlrev_b32 v100, 16, v2
    v_and_b32 v101, 0xffff0000, v2
    v_lshlrev_b32 v102, 16, v3
    v_and_b32 v103, 0xffff0000, v3
    v_mul_f32 v96, 0x3fb8aa3b, v96
    v_mul_f32 v97, 0x3fb8aa3b, v97
    v_mul_f32 v98, 0x3fb8aa3b, v98
    v_mul_f32 v99, 0x3fb8aa3b, v99
    v_mul_f32 v100, 0x3fb8aa3b, v100
    v_mul_f32 v101, 0x3fb8aa3b, v101
    v_mul_f32 v102, 0x3fb8aa3b, v102
    v_mul_f32 v103, 0x3fb8aa3b, v103
    v_exp_f32 v96, v96
    v_exp_f32 v97, v97
    v_exp_f32 v98, v98
    v_exp_f32 v99, v99
    v_exp_f32 v100, v100
    v_exp_f32 v101, v101
    v_exp_f32 v102, v102
    v_exp_f32 v103, v103
    v_cvt_pk_bf16_f32 v104, v96, v97
    v_cvt_pk_bf16_f32 v105, v98, v99
    v_cvt_pk_bf16_f32 v106, v100, v101
    v_cvt_pk_bf16_f32 v107, v102, v103
    v_and_b32 v16, 0xffff0000, v117
    v_subrev_f32 v96, s50, v16
    v_subrev_f32 v97, s51, v16
    v_subrev_f32 v98, s52, v16
    v_subrev_f32 v99, s53, v16
    v_subrev_f32 v100, s54, v16
    v_subrev_f32 v101, s55, v16
    v_subrev_f32 v102, s56, v16
    v_subrev_f32 v103, s57, v16
    v_cvt_pk_bf16_f32 v0, v96, v97
    v_cvt_pk_bf16_f32 v1, v98, v99
    v_cvt_pk_bf16_f32 v2, v100, v101
    v_cvt_pk_bf16_f32 v3, v102, v103
    v_lshlrev_b32 v96, 16, v0
    v_and_b32 v97, 0xffff0000, v0
    v_lshlrev_b32 v98, 16, v1
    v_and_b32 v99, 0xffff0000, v1
    v_lshlrev_b32 v100, 16, v2
    v_and_b32 v101, 0xffff0000, v2
    v_lshlrev_b32 v102, 16, v3
    v_and_b32 v103, 0xffff0000, v3
    v_mul_f32 v96, v96, v96
    v_mul_f32 v97, v97, v97
    v_mul_f32 v98, v98, v98
    v_mul_f32 v99, v99, v99
    v_mul_f32 v100, v100, v100
    v_mul_f32 v101, v101, v101
    v_mul_f32 v102, v102, v102
    v_mul_f32 v103, v103, v103
    v_cvt_pk_bf16_f32 v0, v96, v97
    v_cvt_pk_bf16_f32 v1, v98, v99
    v_cvt_pk_bf16_f32 v2, v100, v101
    v_cvt_pk_bf16_f32 v3, v102, v103
    v_lshlrev_b32 v96, 16, v0
    v_and_b32 v97, 0xffff0000, v0
    v_lshlrev_b32 v98, 16, v1
    v_and_b32 v99, 0xffff0000, v1
    v_lshlrev_b32 v100, 16, v2
    v_and_b32 v101, 0xffff0000, v2
    v_lshlrev_b32 v102, 16, v3
    v_and_b32 v103, 0xffff0000, v3
    v_mul_f32 v96, 0xc1200000, v96
    v_mul_f32 v97, 0xc1200000, v97
    v_mul_f32 v98, 0xc1200000, v98
    v_mul_f32 v99, 0xc1200000, v99
    v_mul_f32 v100, 0xc1200000, v100
    v_mul_f32 v101, 0xc1200000, v101
    v_mul_f32 v102, 0xc1200000, v102
    v_mul_f32 v103, 0xc1200000, v103
    v_cvt_pk_bf16_f32 v0, v96, v97
    v_cvt_pk_bf16_f32 v1, v98, v99
    v_cvt_pk_bf16_f32 v2, v100, v101
    v_cvt_pk_bf16_f32 v3, v102, v103
    v_lshlrev_b32 v96, 16, v0
    v_and_b32 v97, 0xffff0000, v0
    v_lshlrev_b32 v98, 16, v1
    v_and_b32 v99, 0xffff0000, v1
    v_lshlrev_b32 v100, 16, v2
    v_and_b32 v101, 0xffff0000, v2
    v_lshlrev_b32 v102, 16, v3
    v_and_b32 v103, 0xffff0000, v3
    v_mul_f32 v96, 0x3fb8aa3b, v96
    v_mul_f32 v97, 0x3fb8aa3b, v97
    v_mul_f32 v98, 0x3fb8aa3b, v98
    v_mul_f32 v99, 0x3fb8aa3b, v99
    v_mul_f32 v100, 0x3fb8aa3b, v100
    v_mul_f32 v101, 0x3fb8aa3b, v101
    v_mul_f32 v102, 0x3fb8aa3b, v102
    v_mul_f32 v103, 0x3fb8aa3b, v103
    v_exp_f32 v96, v96
    v_exp_f32 v97, v97
    v_exp_f32 v98, v98
    v_exp_f32 v99, v99
    v_exp_f32 v100, v100
    v_exp_f32 v101, v101
    v_exp_f32 v102, v102
    v_exp_f32 v103, v103
    v_cvt_pk_bf16_f32 v76, v96, v97
    v_cvt_pk_bf16_f32 v77, v98, v99
    v_cvt_pk_bf16_f32 v78, v100, v101
    v_cvt_pk_bf16_f32 v79, v102, v103
    v_mfma_f32_4x4x4_16b_bf16 v[16:19], v[48:49], v[104:105], 0
    v_mfma_f32_4x4x4_16b_bf16 v[24:27], v[52:53], v[104:105], 0
    v_mfma_f32_4x4x4_16b_bf16 v[20:23], v[48:49], v[76:77], 0
    v_mfma_f32_4x4x4_16b_bf16 v[28:31], v[52:53], v[76:77], 0
    v_mfma_f32_4x4x4_16b_bf16 v[16:19], v[50:51], v[106:107], v[16:19]
    v_mfma_f32_4x4x4_16b_bf16 v[24:27], v[54:55], v[106:107], v[24:27]
    v_mfma_f32_4x4x4_16b_bf16 v[20:23], v[50:51], v[78:79], v[20:23]
    v_mfma_f32_4x4x4_16b_bf16 v[28:31], v[54:55], v[78:79], v[28:31]
L2_f5:
    s_waitcnt vmcnt(0) lgkmcnt(0)
    v_mfma_f32_4x4x4_16b_bf16 v[96:99], v[10:11], v[32:33], 0
    v_mfma_f32_4x4x4_16b_bf16 v[100:103], v[10:11], v[34:35], 0
    s_nop 0
    v_mfma_f32_4x4x4_16b_bf16 v[96:99], v[10:11], v[36:37], v[96:99]
    v_mfma_f32_4x4x4_16b_bf16 v[100:103], v[10:11], v[38:39], v[100:103]
    s_nop 0
    v_mfma_f32_4x4x4_16b_bf16 v[96:99], v[10:11], v[40:41], v[96:99]
    v_mfma_f32_4x4x4_16b_bf16 v[100:103], v[10:11], v[42:43], v[100:103]
    s_nop 0
    v_mfma_f32_4x4x4_16b_bf16 v[96:99], v[10:11], v[44:45], v[96:99]
    v_mfma_f32_4x4x4_16b_bf16 v[100:103], v[10:11], v[46:47], v[100:103]
    s_nop 3
    v_mul_f32 v96, v96, v80
    v_mul_f32 v97, v97, v81
    v_mul_f32 v98, v98, v82
    v_mul_f32 v99, v99, v83
    v_cvt_pk_bf16_f32 v32, v96, v97
    v_cvt_pk_bf16_f32 v33, v98, v99
    v_mul_f32 v100, v100, v84
    v_mul_f32 v101, v101, v85
    v_mul_f32 v102, v102, v86
    v_mul_f32 v103, v103, v87
    v_cvt_pk_bf16_f32 v34, v100, v101
    v_cvt_pk_bf16_f32 v35, v102, v103
    v_mfma_f32_4x4x4_16b_bf16 v[80:83], v[56:57], v[32:33], 0
    s_nop 0
    v_mfma_f32_4x4x4_16b_bf16 v[84:87], v[56:57], v[34:35], 0
    s_nop 2
    v_mul_f32 v80, v80, v88
    v_mul_f32 v81, v81, v89
    v_mul_f32 v82, v82, v90
    v_mul_f32 v83, v83, v91
    v_mul_f32 v84, v84, v92
    v_mul_f32 v85, v85, v93
    v_mul_f32 v86, v86, v94
    v_mul_f32 v87, v87, v95
    v_mfma_f32_4x4x4_16b_bf16 v[96:99], v[10:11], v[108:109], v[80:83]
    s_nop 0
    v_mfma_f32_4x4x4_16b_bf16 v[100:103], v[10:11], v[110:111], v[84:87]
    s_nop 2
    v_cvt_pk_bf16_f32 v36, v96, v97
    v_cvt_pk_bf16_f32 v37, v98, v99
    v_cvt_pk_bf16_f32 v38, v100, v101
    v_cvt_pk_bf16_f32 v39, v102, v103
    buffer_store_dwordx4 v[36:39], v120, s[12:15], 0 offen
    s_cmp_ge_u32 s32, 4
    s_cbranch_scc1 L2_f6
    v_mfma_f32_4x4x4_16b_bf16 v[96:99], v[10:11], v[60:61], 0
    v_mfma_f32_4x4x4_16b_bf16 v[100:103], v[10:11], v[62:63], 0
    s_nop 0
    v_mfma_f32_4x4x4_16b_bf16 v[96:99], v[10:11], v[64:65], v[96:99]
    v_mfma_f32_4x4x4_16b_bf16 v[100:103], v[10:11], v[66:67], v[100:103]
    s_nop 0
    v_mfma_f32_4x4x4_16b_bf16 v[96:99], v[10:11], v[68:69], v[96:99]
    v_mfma_f32_4x4x4_16b_bf16 v[100:103], v[10:11], v[70:71], v[100:103]
    s_nop 0
    v_mfma_f32_4x4x4_16b_bf16 v[96:99], v[10:11], v[72:73], v[96:99]
    v_mfma_f32_4x4x4_16b_bf16 v[100:103], v[10:11], v[74:75], v[100:103]
    s_nop 3
    v_mul_f32 v96, v96, v16
    v_mul_f32 v97, v97, v17
    v_mul_f32 v98, v98, v18
    v_mul_f32 v99, v99, v19
    v_cvt_pk_bf16_f32 v60, v96, v97
    v_cvt_pk_bf16_f32 v61, v98, v99
    v_mul_f32 v100, v100, v20
    v_mul_f32 v101, v101, v21
    v_mul_f32 v102, v102, v22
    v_mul_f32 v103, v103, v23
    v_cvt_pk_bf16_f32 v62, v100, v101
    v_cvt_pk_bf16_f32 v63, v102, v103
    v_mfma_f32_4x4x4_16b_bf16 v[16:19], v[56:57], v[60:61], 0
    s_nop 0
    v_mfma_f32_4x4x4_16b_bf16 v[20:23], v[56:57], v[62:63], 0
    s_nop 2
    v_mul_f32 v16, v16, v24
    v_mul_f32 v17, v17, v25
    v_mul_f32 v18, v18, v26
    v_mul_f32 v19, v19, v27
    v_mul_f32 v20, v20, v28
    v_mul_f32 v21, v21, v29
    v_mul_f32 v22, v22, v30
    v_mul_f32 v23, v23, v31
    v_mfma_f32_4x4x4_16b_bf16 v[96:99], v[10:11], v[112:113], v[16:19]
    s_nop 0
    v_mfma_f32_4x4x4_16b_bf16 v[100:103], v[10:11], v[114:115], v[20:23]
    s_nop 2
    v_cvt_pk_bf16_f32 v64, v96, v97
    v_cvt_pk_bf16_f32 v65, v98, v99
    v_cvt_pk_bf16_f32 v66, v100, v101
    v_cvt_pk_bf16_f32 v67, v102, v103
    buffer_store_dwordx4 v[64:67], v121, s[12:15], 0 offen
L2_f6:
L2_end:
    s_endpgm
L2_slow:
    s_lshr_b32 s35, s42, 2
    s_mul_i32 s50, s32, 64
    s_add_u32 s57, s50, 64
    s_and_b32 s3, s42, 3
    s_lshl_b32 s53, s3, 3
    s_add_u32 s53, s53, s39
    s_and_b32 s3, s35, 2
    s_lshl_b32 s3, s3, 1
    s_add_u32 s53, s53, s3
    s_and_b32 s54, s35, 1
    s_lshl_b32 s54, s54, 4
L2_sl_seg:
    s_mul_i32 s56, s50, 173056
    s_and_b32 s3, s50, 3
    s_lshl_b32 s3, s3, 5
    s_add_u32 s3, s3, s56
    s_add_u32 s3, s3, s53
    s_add_u32 s55, s3, 32
    s_buffer_load_dword s51, s[12:15], s3
    s_buffer_load_dword s52, s[12:15], s55
    s_waitcnt lgkmcnt(0)
    s_lshr_b32 s51, s51, s54
    s_and_b32 s51, s51, 0xffff
    s_lshr_b32 s52, s52, s54
    s_and_b32 s52, s52, 0xffff
L2_sl_rec:
    s_cmp_ge_u32 s51, s52
    s_cbranch_scc1 L2_sl_next
    v_mbcnt_lo_u32_b32 v102, -1, 0
    v_mbcnt_hi_u32_b32 v102, -1, v102
    v_add_u32 v102, s51, v102
    v_and_b32 v103, -4, v102
    v_lshl_add_u32 v104, v102, 2, v103
    v_lshl_add_u32 v105, v103, 2, v102
    v_cmp_gt_u32 vcc, s52, v102
    s_mov_b64 exec, vcc
    buffer_load_dword v106, v104, s[8:11], s56 offen
    buffer_load_ubyte v107, v105, s[8:11], s56 offen offset:16
    s_waitcnt vmcnt(0)
    v_lshrrev_b32 v98, 14, v106
    v_and_b32 v98, v5, v98
    ds_read_b64 v[100:101], v98
    v_perm_b32 v97, v106, v107, s44
    v_and_b32 v96, v5, v106
    v_bitop3_b32 v103, v106, 0.5, -0.5 bitop3:0xa8
    v_bitop3_b32 v97, v6, v97, v103 bitop3:0xca
    s_waitcnt lgkmcnt(0)
    v_mfma_f32_4x4x4_16b_bf16 v[88:91], v[8:9], v[100:101], 0
    s_nop 4
    v_mul_f32 v88, v97, v88
    v_mul_f32 v89, v97, v89
    v_mul_f32 v90, v97, v90
    v_mul_f32 v91, v97, v91
    v_cvt_pk_bf16_f32 v88, v88, v89
    v_cvt_pk_bf16_f32 v89, v90, v91
    ds_pk_add_bf16 v96, v88 offset:65408
    ds_pk_add_bf16 v96, v89 offset:65412
    s_mov_b64 exec, -1
    s_add_u32 s51, s51, 64
    s_branch L2_sl_rec
L2_sl_next:
    s_add_u32 s50, s50, 1
    s_cmp_lt_u32 s50, s57
    s_cbranch_scc1 L2_sl_seg
    s_lshl_b32 s50, s32, 4
    s_add_u32 s50, s50, 0x400
    s_add_u32 s3, s50, 16
    s_cmp_lg_u32 s57, s3
    s_mov_b32 s57, s3
    s_cbranch_scc1 L2_sl_seg
    s_waitcnt lgkmcnt(0)
    s_cmp_eq_u32 s42, 0
    s_cbranch_scc1 L2_ret0
    s_cmp_eq_u32 s42, 1
    s_cbranch_scc1 L2_ret1
    s_cmp_eq_u32 s42, 14
    s_cbranch_scc1 L2_ret6
    s_cmp_eq_u32 s42, 15
    s_cbranch_scc1 L2_ret7
    s_and_b32 s3, s42, 3
    s_cmp_eq_u32 s3, 2
    s_cbranch_scc1 L2_ret2
    s_cmp_eq_u32 s3, 3
    s_cbranch_scc1 L2_ret3
    s_cmp_eq_u32 s3, 0
    s_cbranch_scc1 L2_ret4
    s_branch L2_ret5
L2_xo1:
    v_cmp_lt_u32 vcc, 20, v99
    s_mov_b32 s43, 1
    s_cbranch_vccz L2_xp1
    v_cmp_lt_u32 vcc, 32, v99
    v_cmp_lt_u32 s[58:59], 31, v88
    s_mov_b32 s43, 2
    s_or_b64 vcc, vcc, s[58:59]
    s_cbranch_scc0 L2_xp1
    s_mov_b32 s37, 0x10000
    s_branch L2_xp1
L2_xa2:
    s_cmp_eq_u32 s43, 1
    s_cbranch_scc1 L2_xc2
    v_lshlrev_b32 v89, 0, v96
    v_add_u32 v90, 140, v97
    v_bitop3_b32 v90, v89, v45, v90 bitop3:0x6a
    ds_write_b32 v98, v90 offset:28
    v_lshlrev_b32 v89, 4, v96
    v_add_u32 v90, 120, v97
    v_bitop3_b32 v90, v89, v45, v90 bitop3:0x6a
    ds_write_b32 v98, v90 offset:24
    v_lshlrev_b32 v89, 8, v96
    v_add_u32 v90, 100, v97
    v_bitop3_b32 v90, v89, v45, v90 bitop3:0x6a
    ds_write_b32 v98, v90 offset:20
L2_xc2:
    v_lshlrev_b32 v89, 12, v96
    v_add_u32 v90, 80, v97
    v_bitop3_b32 v90, v89, v45, v90 bitop3:0x6a
    ds_write_b32 v98, v90 offset:16
    s_branch L2_xb2
L2_xe2:
    v_cmp_lt_u32 vcc, 32, v99
    v_cmp_lt_u32 s[58:59], 31, v88
    v_lshrrev_b32 v89, 16, v96
    v_add_u32 v97, 80, v97
    s_or_b64 vcc, vcc, s[58:59]
    s_cbranch_scc1 L2_xs2
    v_lshlrev_b32 v89, v1, v89
    v_and_b32 v89, v45, v89
    v_cmp_ne_u32 vcc, 0, v89
    v_xor_b32 v90, v97, v89
    s_add_u32 s3, s37, s38
    v_mbcnt_lo_u32_b32 v98, vcc_lo, 0
    v_mbcnt_hi_u32_b32 v98, vcc_hi, v98
    s_bcnt1_i32_b64 s41, vcc
    v_lshl_add_u32 v98, v98, 2, s3
    s_mov_b64 exec, vcc
    ds_write_b32 v98, v90
    s_mov_b64 exec, -1
    s_lshl2_add_u32 s37, s41, s37
    s_branch L2_xr2
L2_xf2:
    s_waitcnt lgkmcnt(0)
    s_cmp_gt_u32 s37, 1024
    s_cbranch_scc1 L2_xs2
    v_mov_b32 v43, -1
    s_cmp_ge_u32 s37, 512
    s_cbranch_scc1 L2_xg2
    v_mov_b32 v42, -1
    s_cmp_ge_u32 s37, 256
    s_cbranch_scc1 L2_xg2
    v_mov_b32 v41, -1
    s_branch L2_xg2
L2_xs2:
    s_waitcnt lgkmcnt(0)
    v_mov_b32 v40, -1
    v_mov_b32 v41, -1
    v_mov_b32 v42, -1
    v_mov_b32 v43, -1
    s_add_u32 s3, s42, 0
    s_bitset1_b32 s36, s3
    s_branch L2_xg2
L2_xo3:
    v_cmp_lt_u32 vcc, 20, v99
    s_mov_b32 s43, 1
    s_cbranch_vccz L2_xp3
    v_cmp_lt_u32 vcc, 32, v99
    v_cmp_lt_u32 s[58:59], 31, v88
    s_mov_b32 s43, 2
    s_or_b64 vcc, vcc, s[58:59]
    s_cbranch_scc0 L2_xp3
    s_mov_b32 s37, 0x10000
    s_branch L2_xp3
L2_xa4:
    s_cmp_eq_u32 s43, 1
    s_cbranch_scc1 L2_xc4
    v_lshlrev_b32 v89, 0, v96
    v_add_u32 v90, 140, v97
    v_bitop3_b32 v90, v89, v45, v90 bitop3:0x6a
    ds_write_b32 v98, v90 offset:28
    v_lshlrev_b32 v89, 4, v96
    v_add_u32 v90, 120, v97
    v_bitop3_b32 v90, v89, v45, v90 bitop3:0x6a
    ds_write_b32 v98, v90 offset:24
    v_lshlrev_b32 v89, 8, v96
    v_add_u32 v90, 100, v97
    v_bitop3_b32 v90, v89, v45, v90 bitop3:0x6a
    ds_write_b32 v98, v90 offset:20
L2_xc4:
    v_lshlrev_b32 v89, 12, v96
    v_add_u32 v90, 80, v97
    v_bitop3_b32 v90, v89, v45, v90 bitop3:0x6a
    ds_write_b32 v98, v90 offset:16
    s_branch L2_xb4
L2_xe4:
    v_cmp_lt_u32 vcc, 32, v99
    v_cmp_lt_u32 s[58:59], 31, v88
    v_lshrrev_b32 v89, 16, v96
    v_add_u32 v97, 80, v97
    s_or_b64 vcc, vcc, s[58:59]
    s_cbranch_scc1 L2_xs4
    v_lshlrev_b32 v89, v1, v89
    v_and_b32 v89, v45, v89
    v_cmp_ne_u32 vcc, 0, v89
    v_xor_b32 v90, v97, v89
    s_add_u32 s3, s37, s38
    v_mbcnt_lo_u32_b32 v98, vcc_lo, 0
    v_mbcnt_hi_u32_b32 v98, vcc_hi, v98
    s_bcnt1_i32_b64 s41, vcc
    v_lshl_add_u32 v98, v98, 2, s3
    s_mov_b64 exec, vcc
    ds_write_b32 v98, v90
    s_mov_b64 exec, -1
    s_lshl2_add_u32 s37, s41, s37
    s_branch L2_xr4
L2_xf4:
    s_waitcnt lgkmcnt(0)
    s_cmp_gt_u32 s37, 1024
    s_cbranch_scc1 L2_xs4
    v_mov_b32 v43, -1
    s_cmp_ge_u32 s37, 512
    s_cbranch_scc1 L2_xg4
    v_mov_b32 v42, -1
    s_cmp_ge_u32 s37, 256
    s_cbranch_scc1 L2_xg4
    v_mov_b32 v41, -1
    s_branch L2_xg4
L2_xs4:
    s_waitcnt lgkmcnt(0)
    v_mov_b32 v40, -1
    v_mov_b32 v41, -1
    v_mov_b32 v42, -1
    v_mov_b32 v43, -1
    s_add_u32 s3, s42, 1
    s_bitset1_b32 s36, s3
    s_branch L2_xg4
L2_c5:
    s_mov_b64 s[50:51], vcc
    s_lshl_b64 s[52:53], s[82:83], 1
    s_andn2_b64 s[52:53], s[52:53], s[80:81]
    s_andn2_b64 s[52:53], s[52:53], s[50:51]
    s_or_b64 s[80:81], s[80:81], s[52:53]
    s_not_b64 vcc, s[52:53]
    s_mov_b64 exec, -1
    v_cndmask_b32_dpp v84, v84, v84, vcc wave_shr:1 row_mask:0xf bank_mask:0xf
    v_cndmask_b32_dpp v85, v85, v85, vcc wave_shr:1 row_mask:0xf bank_mask:0xf
    s_lshr_b64 s[52:53], s[52:53], 1
    v_cndmask_b32_dpp v86, v86, v86, vcc wave_shr:1 row_mask:0xf bank_mask:0xf
    v_cndmask_b32_dpp v87, v87, v87, vcc wave_shr:1 row_mask:0xf bank_mask:0xf
    s_andn2_b64 s[82:83], s[82:83], s[52:53]
    v_cndmask_b32_dpp v7, v7, v7, vcc wave_shr:1 row_mask:0xf bank_mask:0xf
    s_mov_b64 vcc, s[50:51]
    s_mov_b64 exec, s[50:51]
    s_cbranch_scc0 L2_d5
    s_mov_b64 exec, s[82:83]
    s_nop 1
    v_mfma_f32_4x4x4_16b_bf16 v[88:91], v[12:13], v[84:85], 0
    s_nop 1
    v_mfma_f32_4x4x4_16b_bf16 v[88:91], v[10:11], v[86:87], v[88:91]
    s_nop 4
    v_cvt_pk_bf16_f32 v88, v88, v89
    v_cvt_pk_bf16_f32 v89, v90, v91
    ds_pk_add_bf16 v7, v88 offset:65408
    ds_pk_add_bf16 v7, v89 offset:65412
    s_mov_b64 exec, vcc
    s_branch L2_d5
L2_c6:
    s_mov_b64 s[50:51], vcc
    s_lshl_b64 s[52:53], s[82:83], 1
    s_andn2_b64 s[52:53], s[52:53], s[80:81]
    s_andn2_b64 s[52:53], s[52:53], s[50:51]
    s_or_b64 s[80:81], s[80:81], s[52:53]
    s_not_b64 vcc, s[52:53]
    s_mov_b64 exec, -1
    v_cndmask_b32_dpp v84, v84, v84, vcc wave_shr:1 row_mask:0xf bank_mask:0xf
    v_cndmask_b32_dpp v85, v85, v85, vcc wave_shr:1 row_mask:0xf bank_mask:0xf
    s_lshr_b64 s[52:53], s[52:53], 1
    v_cndmask_b32_dpp v86, v86, v86, vcc wave_shr:1 row_mask:0xf bank_mask:0xf
    v_cndmask_b32_dpp v87, v87, v87, vcc wave_shr:1 row_mask:0xf bank_mask:0xf
    s_andn2_b64 s[82:83], s[82:83], s[52:53]
    v_cndmask_b32_dpp v7, v7, v7, vcc wave_shr:1 row_mask:0xf bank_mask:0xf
    s_mov_b64 vcc, s[50:51]
    s_mov_b64 exec, s[50:51]
    s_cbranch_scc0 L2_d6
    s_mov_b64 exec, s[82:83]
    s_nop 1
    v_mfma_f32_4x4x4_16b_bf16 v[88:91], v[12:13], v[84:85], 0
    s_nop 1
    v_mfma_f32_4x4x4_16b_bf16 v[88:91], v[10:11], v[86:87], v[88:91]
    s_nop 4
    v_cvt_pk_bf16_f32 v88, v88, v89
    v_cvt_pk_bf16_f32 v89, v90, v91
    ds_pk_add_bf16 v7, v88 offset:65408
    ds_pk_add_bf16 v7, v89 offset:65412
    s_mov_b64 exec, vcc
    s_branch L2_d6
L2_c7:
    s_mov_b64 s[50:51], vcc
    s_lshl_b64 s[52:53], s[82:83], 1
    s_andn2_b64 s[52:53], s[52:53], s[80:81]
    s_andn2_b64 s[52:53], s[52:53], s[50:51]
    s_or_b64 s[80:81], s[80:81], s[52:53]
    s_not_b64 vcc, s[52:53]
    s_mov_b64 exec, -1
    v_cndmask_b32_dpp v84, v84, v84, vcc wave_shr:1 row_mask:0xf bank_mask:0xf
    v_cndmask_b32_dpp v85, v85, v85, vcc wave_shr:1 row_mask:0xf bank_mask:0xf
    s_lshr_b64 s[52:53], s[52:53], 1
    v_cndmask_b32_dpp v86, v86, v86, vcc wave_shr:1 row_mask:0xf bank_mask:0xf
    v_cndmask_b32_dpp v87, v87, v87, vcc wave_shr:1 row_mask:0xf bank_mask:0xf
    s_andn2_b64 s[82:83], s[82:83], s[52:53]
    v_cndmask_b32_dpp v7, v7, v7, vcc wave_shr:1 row_mask:0xf bank_mask:0xf
    s_mov_b64 vcc, s[50:51]
    s_mov_b64 exec, s[50:51]
    s_cbranch_scc0 L2_d7
    s_mov_b64 exec, s[82:83]
    s_nop 1
    v_mfma_f32_4x4x4_16b_bf16 v[88:91], v[12:13], v[84:85], 0
    s_nop 1
    v_mfma_f32_4x4x4_16b_bf16 v[88:91], v[10:11], v[86:87], v[88:91]
    s_nop 4
    v_cvt_pk_bf16_f32 v88, v88, v89
    v_cvt_pk_bf16_f32 v89, v90, v91
    ds_pk_add_bf16 v7, v88 offset:65408
    ds_pk_add_bf16 v7, v89 offset:65412
    s_mov_b64 exec, vcc
    s_branch L2_d7
L2_c8:
    s_mov_b64 s[50:51], vcc
    s_lshl_b64 s[52:53], s[82:83], 1
    s_andn2_b64 s[52:53], s[52:53], s[80:81]
    s_andn2_b64 s[52:53], s[52:53], s[50:51]
    s_or_b64 s[80:81], s[80:81], s[52:53]
    s_not_b64 vcc, s[52:53]
    s_mov_b64 exec, -1
    v_cndmask_b32_dpp v84, v84, v84, vcc wave_shr:1 row_mask:0xf bank_mask:0xf
    v_cndmask_b32_dpp v85, v85, v85, vcc wave_shr:1 row_mask:0xf bank_mask:0xf
    s_lshr_b64 s[52:53], s[52:53], 1
    v_cndmask_b32_dpp v86, v86, v86, vcc wave_shr:1 row_mask:0xf bank_mask:0xf
    v_cndmask_b32_dpp v87, v87, v87, vcc wave_shr:1 row_mask:0xf bank_mask:0xf
    s_andn2_b64 s[82:83], s[82:83], s[52:53]
    v_cndmask_b32_dpp v7, v7, v7, vcc wave_shr:1 row_mask:0xf bank_mask:0xf
    s_mov_b64 vcc, s[50:51]
    s_mov_b64 exec, s[50:51]
    s_cbranch_scc0 L2_d8
    s_mov_b64 exec, s[82:83]
    s_nop 1
    v_mfma_f32_4x4x4_16b_bf16 v[88:91], v[12:13], v[84:85], 0
    s_nop 1
    v_mfma_f32_4x4x4_16b_bf16 v[88:91], v[10:11], v[86:87], v[88:91]
    s_nop 4
    v_cvt_pk_bf16_f32 v88, v88, v89
    v_cvt_pk_bf16_f32 v89, v90, v91
    ds_pk_add_bf16 v7, v88 offset:65408
    ds_pk_add_bf16 v7, v89 offset:65412
    s_mov_b64 exec, vcc
    s_branch L2_d8
L2_xo9:
    v_cmp_lt_u32 vcc, 20, v99
    s_mov_b32 s43, 1
    s_cbranch_vccz L2_xp9
    v_cmp_lt_u32 vcc, 32, v99
    v_cmp_lt_u32 s[58:59], 31, v88
    s_mov_b32 s43, 2
    s_or_b64 vcc, vcc, s[58:59]
    s_cbranch_scc0 L2_xp9
    s_mov_b32 s37, 0x10000
    s_branch L2_xp9
L2_c10:
    s_mov_b64 s[50:51], vcc
    s_lshl_b64 s[52:53], s[82:83], 1
    s_andn2_b64 s[52:53], s[52:53], s[80:81]
    s_andn2_b64 s[52:53], s[52:53], s[50:51]
    s_or_b64 s[80:81], s[80:81], s[52:53]
    s_not_b64 vcc, s[52:53]
    s_mov_b64 exec, -1
    v_cndmask_b32_dpp v84, v84, v84, vcc wave_shr:1 row_mask:0xf bank_mask:0xf
    v_cndmask_b32_dpp v85, v85, v85, vcc wave_shr:1 row_mask:0xf bank_mask:0xf
    s_lshr_b64 s[52:53], s[52:53], 1
    v_cndmask_b32_dpp v86, v86, v86, vcc wave_shr:1 row_mask:0xf bank_mask:0xf
    v_cndmask_b32_dpp v87, v87, v87, vcc wave_shr:1 row_mask:0xf bank_mask:0xf
    s_andn2_b64 s[82:83], s[82:83], s[52:53]
    v_cndmask_b32_dpp v7, v7, v7, vcc wave_shr:1 row_mask:0xf bank_mask:0xf
    s_mov_b64 vcc, s[50:51]
    s_mov_b64 exec, s[50:51]
    s_cbranch_scc0 L2_d10
    s_mov_b64 exec, s[82:83]
    s_nop 1
    v_mfma_f32_4x4x4_16b_bf16 v[88:91], v[12:13], v[84:85], 0
    s_nop 1
    v_mfma_f32_4x4x4_16b_bf16 v[88:91], v[10:11], v[86:87], v[88:91]
    s_nop 4
    v_cvt_pk_bf16_f32 v88, v88, v89
    v_cvt_pk_bf16_f32 v89, v90, v91
    ds_pk_add_bf16 v7, v88 offset:65408
    ds_pk_add_bf16 v7, v89 offset:65412
    s_mov_b64 exec, vcc
    s_branch L2_d10
L2_c11:
    s_mov_b64 s[50:51], vcc
    s_lshl_b64 s[52:53], s[82:83], 1
    s_andn2_b64 s[52:53], s[52:53], s[80:81]
    s_andn2_b64 s[52:53], s[52:53], s[50:51]
    s_or_b64 s[80:81], s[80:81], s[52:53]
    s_not_b64 vcc, s[52:53]
    s_mov_b64 exec, -1
    v_cndmask_b32_dpp v84, v84, v84, vcc wave_shr:1 row_mask:0xf bank_mask:0xf
    v_cndmask_b32_dpp v85, v85, v85, vcc wave_shr:1 row_mask:0xf bank_mask:0xf
    s_lshr_b64 s[52:53], s[52:53], 1
    v_cndmask_b32_dpp v86, v86, v86, vcc wave_shr:1 row_mask:0xf bank_mask:0xf
    v_cndmask_b32_dpp v87, v87, v87, vcc wave_shr:1 row_mask:0xf bank_mask:0xf
    s_andn2_b64 s[82:83], s[82:83], s[52:53]
    v_cndmask_b32_dpp v7, v7, v7, vcc wave_shr:1 row_mask:0xf bank_mask:0xf
    s_mov_b64 vcc, s[50:51]
    s_mov_b64 exec, s[50:51]
    s_cbranch_scc0 L2_d11
    s_mov_b64 exec, s[82:83]
    s_nop 1
    v_mfma_f32_4x4x4_16b_bf16 v[88:91], v[12:13], v[84:85], 0
    s_nop 1
    v_mfma_f32_4x4x4_16b_bf16 v[88:91], v[10:11], v[86:87], v[88:91]
    s_nop 4
    v_cvt_pk_bf16_f32 v88, v88, v89
    v_cvt_pk_bf16_f32 v89, v90, v91
    ds_pk_add_bf16 v7, v88 offset:65408
    ds_pk_add_bf16 v7, v89 offset:65412
    s_mov_b64 exec, vcc
    s_branch L2_d11
L2_c12:
    s_mov_b64 s[50:51], vcc
    s_lshl_b64 s[52:53], s[82:83], 1
    s_andn2_b64 s[52:53], s[52:53], s[80:81]
    s_andn2_b64 s[52:53], s[52:53], s[50:51]
    s_or_b64 s[80:81], s[80:81], s[52:53]
    s_not_b64 vcc, s[52:53]
    s_mov_b64 exec, -1
    v_cndmask_b32_dpp v84, v84, v84, vcc wave_shr:1 row_mask:0xf bank_mask:0xf
    v_cndmask_b32_dpp v85, v85, v85, vcc wave_shr:1 row_mask:0xf bank_mask:0xf
    s_lshr_b64 s[52:53], s[52:53], 1
    v_cndmask_b32_dpp v86, v86, v86, vcc wave_shr:1 row_mask:0xf bank_mask:0xf
    v_cndmask_b32_dpp v87, v87, v87, vcc wave_shr:1 row_mask:0xf bank_mask:0xf
    s_andn2_b64 s[82:83], s[82:83], s[52:53]
    v_cndmask_b32_dpp v7, v7, v7, vcc wave_shr:1 row_mask:0xf bank_mask:0xf
    s_mov_b64 vcc, s[50:51]
    s_mov_b64 exec, s[50:51]
    s_cbranch_scc0 L2_d12
    s_mov_b64 exec, s[82:83]
    s_nop 1
    v_mfma_f32_4x4x4_16b_bf16 v[88:91], v[12:13], v[84:85], 0
    s_nop 1
    v_mfma_f32_4x4x4_16b_bf16 v[88:91], v[10:11], v[86:87], v[88:91]
    s_nop 4
    v_cvt_pk_bf16_f32 v88, v88, v89
    v_cvt_pk_bf16_f32 v89, v90, v91
    ds_pk_add_bf16 v7, v88 offset:65408
    ds_pk_add_bf16 v7, v89 offset:65412
    s_mov_b64 exec, vcc
    s_branch L2_d12
L2_c13:
    s_mov_b64 s[50:51], vcc
    s_lshl_b64 s[52:53], s[82:83], 1
    s_andn2_b64 s[52:53], s[52:53], s[80:81]
    s_andn2_b64 s[52:53], s[52:53], s[50:51]
    s_or_b64 s[80:81], s[80:81], s[52:53]
    s_not_b64 vcc, s[52:53]
    s_mov_b64 exec, -1
    v_cndmask_b32_dpp v84, v84, v84, vcc wave_shr:1 row_mask:0xf bank_mask:0xf
    v_cndmask_b32_dpp v85, v85, v85, vcc wave_shr:1 row_mask:0xf bank_mask:0xf
    s_lshr_b64 s[52:53], s[52:53], 1
    v_cndmask_b32_dpp v86, v86, v86, vcc wave_shr:1 row_mask:0xf bank_mask:0xf
    v_cndmask_b32_dpp v87, v87, v87, vcc wave_shr:1 row_mask:0xf bank_mask:0xf
    s_andn2_b64 s[82:83], s[82:83], s[52:53]
    v_cndmask_b32_dpp v7, v7, v7, vcc wave_shr:1 row_mask:0xf bank_mask:0xf
    s_mov_b64 vcc, s[50:51]
    s_mov_b64 exec, s[50:51]
    s_cbranch_scc0 L2_d13
    s_mov_b64 exec, s[82:83]
    s_nop 1
    v_mfma_f32_4x4x4_16b_bf16 v[88:91], v[12:13], v[84:85], 0
    s_nop 1
    v_mfma_f32_4x4x4_16b_bf16 v[88:91], v[10:11], v[86:87], v[88:91]
    s_nop 4
    v_cvt_pk_bf16_f32 v88, v88, v89
    v_cvt_pk_bf16_f32 v89, v90, v91
    ds_pk_add_bf16 v7, v88 offset:65408
    ds_pk_add_bf16 v7, v89 offset:65412
    s_mov_b64 exec, vcc
    s_branch L2_d13
L2_c14:
    s_mov_b64 s[50:51], vcc
    s_lshl_b64 s[52:53], s[82:83], 1
    s_andn2_b64 s[52:53], s[52:53], s[80:81]
    s_andn2_b64 s[52:53], s[52:53], s[50:51]
    s_or_b64 s[80:81], s[80:81], s[52:53]
    s_not_b64 vcc, s[52:53]
    s_mov_b64 exec, -1
    v_cndmask_b32_dpp v84, v84, v84, vcc wave_shr:1 row_mask:0xf bank_mask:0xf
    v_cndmask_b32_dpp v85, v85, v85, vcc wave_shr:1 row_mask:0xf bank_mask:0xf
    s_lshr_b64 s[52:53], s[52:53], 1
    v_cndmask_b32_dpp v86, v86, v86, vcc wave_shr:1 row_mask:0xf bank_mask:0xf
    v_cndmask_b32_dpp v87, v87, v87, vcc wave_shr:1 row_mask:0xf bank_mask:0xf
    s_andn2_b64 s[82:83], s[82:83], s[52:53]
    v_cndmask_b32_dpp v7, v7, v7, vcc wave_shr:1 row_mask:0xf bank_mask:0xf
    s_mov_b64 vcc, s[50:51]
    s_mov_b64 exec, s[50:51]
    s_cbranch_scc0 L2_d14
    s_mov_b64 exec, s[82:83]
    s_nop 1
    v_mfma_f32_4x4x4_16b_bf16 v[88:91], v[12:13], v[84:85], 0
    s_nop 1
    v_mfma_f32_4x4x4_16b_bf16 v[88:91], v[10:11], v[86:87], v[88:91]
    s_nop 4
    v_cvt_pk_bf16_f32 v88, v88, v89
    v_cvt_pk_bf16_f32 v89, v90, v91
    ds_pk_add_bf16 v7, v88 offset:65408
    ds_pk_add_bf16 v7, v89 offset:65412
    s_mov_b64 exec, vcc
    s_branch L2_d14
L2_c15:
    s_mov_b64 s[50:51], vcc
    s_lshl_b64 s[52:53], s[82:83], 1
    s_andn2_b64 s[52:53], s[52:53], s[80:81]
    s_andn2_b64 s[52:53], s[52:53], s[50:51]
    s_or_b64 s[80:81], s[80:81], s[52:53]
    s_not_b64 vcc, s[52:53]
    s_mov_b64 exec, -1
    v_cndmask_b32_dpp v84, v84, v84, vcc wave_shr:1 row_mask:0xf bank_mask:0xf
    v_cndmask_b32_dpp v85, v85, v85, vcc wave_shr:1 row_mask:0xf bank_mask:0xf
    s_lshr_b64 s[52:53], s[52:53], 1
    v_cndmask_b32_dpp v86, v86, v86, vcc wave_shr:1 row_mask:0xf bank_mask:0xf
    v_cndmask_b32_dpp v87, v87, v87, vcc wave_shr:1 row_mask:0xf bank_mask:0xf
    s_andn2_b64 s[82:83], s[82:83], s[52:53]
    v_cndmask_b32_dpp v7, v7, v7, vcc wave_shr:1 row_mask:0xf bank_mask:0xf
    s_mov_b64 vcc, s[50:51]
    s_mov_b64 exec, s[50:51]
    s_cbranch_scc0 L2_d15
    s_mov_b64 exec, s[82:83]
    s_nop 1
    v_mfma_f32_4x4x4_16b_bf16 v[88:91], v[12:13], v[84:85], 0
    s_nop 1
    v_mfma_f32_4x4x4_16b_bf16 v[88:91], v[10:11], v[86:87], v[88:91]
    s_nop 4
    v_cvt_pk_bf16_f32 v88, v88, v89
    v_cvt_pk_bf16_f32 v89, v90, v91
    ds_pk_add_bf16 v7, v88 offset:65408
    ds_pk_add_bf16 v7, v89 offset:65412
    s_mov_b64 exec, vcc
    s_branch L2_d15
L2_c16:
    s_mov_b64 s[50:51], vcc
    s_lshl_b64 s[52:53], s[82:83], 1
    s_andn2_b64 s[52:53], s[52:53], s[80:81]
    s_andn2_b64 s[52:53], s[52:53], s[50:51]
    s_or_b64 s[80:81], s[80:81], s[52:53]
    s_not_b64 vcc, s[52:53]
    s_mov_b64 exec, -1
    v_cndmask_b32_dpp v84, v84, v84, vcc wave_shr:1 row_mask:0xf bank_mask:0xf
    v_cndmask_b32_dpp v85, v85, v85, vcc wave_shr:1 row_mask:0xf bank_mask:0xf
    s_lshr_b64 s[52:53], s[52:53], 1
    v_cndmask_b32_dpp v86, v86, v86, vcc wave_shr:1 row_mask:0xf bank_mask:0xf
    v_cndmask_b32_dpp v87, v87, v87, vcc wave_shr:1 row_mask:0xf bank_mask:0xf
    s_andn2_b64 s[82:83], s[82:83], s[52:53]
    v_cndmask_b32_dpp v7, v7, v7, vcc wave_shr:1 row_mask:0xf bank_mask:0xf
    s_mov_b64 vcc, s[50:51]
    s_mov_b64 exec, s[50:51]
    s_cbranch_scc0 L2_d16
    s_mov_b64 exec, s[82:83]
    s_nop 1
    v_mfma_f32_4x4x4_16b_bf16 v[88:91], v[12:13], v[84:85], 0
    s_nop 1
    v_mfma_f32_4x4x4_16b_bf16 v[88:91], v[10:11], v[86:87], v[88:91]
    s_nop 4
    v_cvt_pk_bf16_f32 v88, v88, v89
    v_cvt_pk_bf16_f32 v89, v90, v91
    ds_pk_add_bf16 v7, v88 offset:65408
    ds_pk_add_bf16 v7, v89 offset:65412
    s_mov_b64 exec, vcc
    s_branch L2_d16
L2_c17:
    s_mov_b64 s[50:51], vcc
    s_lshl_b64 s[52:53], s[82:83], 1
    s_andn2_b64 s[52:53], s[52:53], s[80:81]
    s_andn2_b64 s[52:53], s[52:53], s[50:51]
    s_or_b64 s[80:81], s[80:81], s[52:53]
    s_not_b64 vcc, s[52:53]
    s_mov_b64 exec, -1
    v_cndmask_b32_dpp v84, v84, v84, vcc wave_shr:1 row_mask:0xf bank_mask:0xf
    v_cndmask_b32_dpp v85, v85, v85, vcc wave_shr:1 row_mask:0xf bank_mask:0xf
    s_lshr_b64 s[52:53], s[52:53], 1
    v_cndmask_b32_dpp v86, v86, v86, vcc wave_shr:1 row_mask:0xf bank_mask:0xf
    v_cndmask_b32_dpp v87, v87, v87, vcc wave_shr:1 row_mask:0xf bank_mask:0xf
    s_andn2_b64 s[82:83], s[82:83], s[52:53]
    v_cndmask_b32_dpp v7, v7, v7, vcc wave_shr:1 row_mask:0xf bank_mask:0xf
    s_mov_b64 vcc, s[50:51]
    s_mov_b64 exec, s[50:51]
    s_cbranch_scc0 L2_d17
    s_mov_b64 exec, s[82:83]
    s_nop 1
    v_mfma_f32_4x4x4_16b_bf16 v[88:91], v[12:13], v[84:85], 0
    s_nop 1
    v_mfma_f32_4x4x4_16b_bf16 v[88:91], v[10:11], v[86:87], v[88:91]
    s_nop 4
    v_cvt_pk_bf16_f32 v88, v88, v89
    v_cvt_pk_bf16_f32 v89, v90, v91
    ds_pk_add_bf16 v7, v88 offset:65408
    ds_pk_add_bf16 v7, v89 offset:65412
    s_mov_b64 exec, vcc
    s_branch L2_d17
L2_xa18:
    s_cmp_eq_u32 s43, 1
    s_cbranch_scc1 L2_xc18
    v_lshlrev_b32 v89, 0, v96
    v_add_u32 v90, 140, v97
    v_bitop3_b32 v90, v89, v45, v90 bitop3:0x6a
    ds_write_b32 v98, v90 offset:28
    v_lshlrev_b32 v89, 4, v96
    v_add_u32 v90, 120, v97
    v_bitop3_b32 v90, v89, v45, v90 bitop3:0x6a
    ds_write_b32 v98, v90 offset:24
    v_lshlrev_b32 v89, 8, v96
    v_add_u32 v90, 100, v97
    v_bitop3_b32 v90, v89, v45, v90 bitop3:0x6a
    ds_write_b32 v98, v90 offset:20
L2_xc18:
    v_lshlrev_b32 v89, 12, v96
    v_add_u32 v90, 80, v97
    v_bitop3_b32 v90, v89, v45, v90 bitop3:0x6a
    ds_write_b32 v98, v90 offset:16
    s_branch L2_xb18
L2_xe18:
    v_cmp_lt_u32 vcc, 32, v99
    v_cmp_lt_u32 s[58:59], 31, v88
    v_lshrrev_b32 v89, 16, v96
    v_add_u32 v97, 80, v97
    s_or_b64 vcc, vcc, s[58:59]
    s_cbranch_scc1 L2_xs18
    v_lshlrev_b32 v89, v1, v89
    v_and_b32 v89, v45, v89
    v_cmp_ne_u32 vcc, 0, v89
    v_xor_b32 v90, v97, v89
    s_add_u32 s3, s37, s38
    v_mbcnt_lo_u32_b32 v98, vcc_lo, 0
    v_mbcnt_hi_u32_b32 v98, vcc_hi, v98
    s_bcnt1_i32_b64 s41, vcc
    v_lshl_add_u32 v98, v98, 2, s3
    s_mov_b64 exec, vcc
    ds_write_b32 v98, v90
    s_mov_b64 exec, -1
    s_lshl2_add_u32 s37, s41, s37
    s_branch L2_xr18
L2_xf18:
    s_waitcnt lgkmcnt(0)
    s_cmp_gt_u32 s37, 1024
    s_cbranch_scc1 L2_xs18
    v_mov_b32 v43, -1
    s_cmp_ge_u32 s37, 512
    s_cbranch_scc1 L2_xg18
    v_mov_b32 v42, -1
    s_cmp_ge_u32 s37, 256
    s_cbranch_scc1 L2_xg18
    v_mov_b32 v41, -1
    s_branch L2_xg18
L2_xs18:
    s_waitcnt lgkmcnt(0)
    v_mov_b32 v40, -1
    v_mov_b32 v41, -1
    v_mov_b32 v42, -1
    v_mov_b32 v43, -1
    s_add_u32 s3, s42, 2
    s_bitset1_b32 s36, s3
    s_branch L2_xg18
L2_c19:
    s_mov_b64 s[50:51], vcc
    s_lshl_b64 s[52:53], s[82:83], 1
    s_andn2_b64 s[52:53], s[52:53], s[80:81]
    s_andn2_b64 s[52:53], s[52:53], s[50:51]
    s_or_b64 s[80:81], s[80:81], s[52:53]
    s_not_b64 vcc, s[52:53]
    s_mov_b64 exec, -1
    v_cndmask_b32_dpp v84, v84, v84, vcc wave_shr:1 row_mask:0xf bank_mask:0xf
    v_cndmask_b32_dpp v85, v85, v85, vcc wave_shr:1 row_mask:0xf bank_mask:0xf
    s_lshr_b64 s[52:53], s[52:53], 1
    v_cndmask_b32_dpp v86, v86, v86, vcc wave_shr:1 row_mask:0xf bank_mask:0xf
    v_cndmask_b32_dpp v87, v87, v87, vcc wave_shr:1 row_mask:0xf bank_mask:0xf
    s_andn2_b64 s[82:83], s[82:83], s[52:53]
    v_cndmask_b32_dpp v7, v7, v7, vcc wave_shr:1 row_mask:0xf bank_mask:0xf
    s_mov_b64 vcc, s[50:51]
    s_mov_b64 exec, s[50:51]
    s_cbranch_scc0 L2_d19
    s_mov_b64 exec, s[82:83]
    s_nop 1
    v_mfma_f32_4x4x4_16b_bf16 v[88:91], v[12:13], v[84:85], 0
    s_nop 1
    v_mfma_f32_4x4x4_16b_bf16 v[88:91], v[10:11], v[86:87], v[88:91]
    s_nop 4
    v_cvt_pk_bf16_f32 v88, v88, v89
    v_cvt_pk_bf16_f32 v89, v90, v91
    ds_pk_add_bf16 v7, v88 offset:65408
    ds_pk_add_bf16 v7, v89 offset:65412
    s_mov_b64 exec, vcc
    s_branch L2_d19
L2_c20:
    s_mov_b64 s[50:51], vcc
    s_lshl_b64 s[52:53], s[82:83], 1
    s_andn2_b64 s[52:53], s[52:53], s[80:81]
    s_andn2_b64 s[52:53], s[52:53], s[50:51]
    s_or_b64 s[80:81], s[80:81], s[52:53]
    s_not_b64 vcc, s[52:53]
    s_mov_b64 exec, -1
    v_cndmask_b32_dpp v84, v84, v84, vcc wave_shr:1 row_mask:0xf bank_mask:0xf
    v_cndmask_b32_dpp v85, v85, v85, vcc wave_shr:1 row_mask:0xf bank_mask:0xf
    s_lshr_b64 s[52:53], s[52:53], 1
    v_cndmask_b32_dpp v86, v86, v86, vcc wave_shr:1 row_mask:0xf bank_mask:0xf
    v_cndmask_b32_dpp v87, v87, v87, vcc wave_shr:1 row_mask:0xf bank_mask:0xf
    s_andn2_b64 s[82:83], s[82:83], s[52:53]
    v_cndmask_b32_dpp v7, v7, v7, vcc wave_shr:1 row_mask:0xf bank_mask:0xf
    s_mov_b64 vcc, s[50:51]
    s_mov_b64 exec, s[50:51]
    s_cbranch_scc0 L2_d20
    s_mov_b64 exec, s[82:83]
    s_nop 1
    v_mfma_f32_4x4x4_16b_bf16 v[88:91], v[12:13], v[84:85], 0
    s_nop 1
    v_mfma_f32_4x4x4_16b_bf16 v[88:91], v[10:11], v[86:87], v[88:91]
    s_nop 4
    v_cvt_pk_bf16_f32 v88, v88, v89
    v_cvt_pk_bf16_f32 v89, v90, v91
    ds_pk_add_bf16 v7, v88 offset:65408
    ds_pk_add_bf16 v7, v89 offset:65412
    s_mov_b64 exec, vcc
    s_branch L2_d20
L2_c21:
    s_mov_b64 s[50:51], vcc
    s_lshl_b64 s[52:53], s[82:83], 1
    s_andn2_b64 s[52:53], s[52:53], s[80:81]
    s_andn2_b64 s[52:53], s[52:53], s[50:51]
    s_or_b64 s[80:81], s[80:81], s[52:53]
    s_not_b64 vcc, s[52:53]
    s_mov_b64 exec, -1
    v_cndmask_b32_dpp v84, v84, v84, vcc wave_shr:1 row_mask:0xf bank_mask:0xf
    v_cndmask_b32_dpp v85, v85, v85, vcc wave_shr:1 row_mask:0xf bank_mask:0xf
    s_lshr_b64 s[52:53], s[52:53], 1
    v_cndmask_b32_dpp v86, v86, v86, vcc wave_shr:1 row_mask:0xf bank_mask:0xf
    v_cndmask_b32_dpp v87, v87, v87, vcc wave_shr:1 row_mask:0xf bank_mask:0xf
    s_andn2_b64 s[82:83], s[82:83], s[52:53]
    v_cndmask_b32_dpp v7, v7, v7, vcc wave_shr:1 row_mask:0xf bank_mask:0xf
    s_mov_b64 vcc, s[50:51]
    s_mov_b64 exec, s[50:51]
    s_cbranch_scc0 L2_d21
    s_mov_b64 exec, s[82:83]
    s_nop 1
    v_mfma_f32_4x4x4_16b_bf16 v[88:91], v[12:13], v[84:85], 0
    s_nop 1
    v_mfma_f32_4x4x4_16b_bf16 v[88:91], v[10:11], v[86:87], v[88:91]
    s_nop 4
    v_cvt_pk_bf16_f32 v88, v88, v89
    v_cvt_pk_bf16_f32 v89, v90, v91
    ds_pk_add_bf16 v7, v88 offset:65408
    ds_pk_add_bf16 v7, v89 offset:65412
    s_mov_b64 exec, vcc
    s_branch L2_d21
L2_c22:
    s_mov_b64 s[50:51], vcc
    s_lshl_b64 s[52:53], s[82:83], 1
    s_andn2_b64 s[52:53], s[52:53], s[80:81]
    s_andn2_b64 s[52:53], s[52:53], s[50:51]
    s_or_b64 s[80:81], s[80:81], s[52:53]
    s_not_b64 vcc, s[52:53]
    s_mov_b64 exec, -1
    v_cndmask_b32_dpp v84, v84, v84, vcc wave_shr:1 row_mask:0xf bank_mask:0xf
    v_cndmask_b32_dpp v85, v85, v85, vcc wave_shr:1 row_mask:0xf bank_mask:0xf
    s_lshr_b64 s[52:53], s[52:53], 1
    v_cndmask_b32_dpp v86, v86, v86, vcc wave_shr:1 row_mask:0xf bank_mask:0xf
    v_cndmask_b32_dpp v87, v87, v87, vcc wave_shr:1 row_mask:0xf bank_mask:0xf
    s_andn2_b64 s[82:83], s[82:83], s[52:53]
    v_cndmask_b32_dpp v7, v7, v7, vcc wave_shr:1 row_mask:0xf bank_mask:0xf
    s_mov_b64 vcc, s[50:51]
    s_mov_b64 exec, s[50:51]
    s_cbranch_scc0 L2_d22
    s_mov_b64 exec, s[82:83]
    s_nop 1
    v_mfma_f32_4x4x4_16b_bf16 v[88:91], v[12:13], v[84:85], 0
    s_nop 1
    v_mfma_f32_4x4x4_16b_bf16 v[88:91], v[10:11], v[86:87], v[88:91]
    s_nop 4
    v_cvt_pk_bf16_f32 v88, v88, v89
    v_cvt_pk_bf16_f32 v89, v90, v91
    ds_pk_add_bf16 v7, v88 offset:65408
    ds_pk_add_bf16 v7, v89 offset:65412
    s_mov_b64 exec, vcc
    s_branch L2_d22
L2_c23:
    s_mov_b64 s[50:51], vcc
    s_lshl_b64 s[52:53], s[82:83], 1
    s_andn2_b64 s[52:53], s[52:53], s[80:81]
    s_andn2_b64 s[52:53], s[52:53], s[50:51]
    s_or_b64 s[80:81], s[80:81], s[52:53]
    s_not_b64 vcc, s[52:53]
    s_mov_b64 exec, -1
    v_cndmask_b32_dpp v84, v84, v84, vcc wave_shr:1 row_mask:0xf bank_mask:0xf
    v_cndmask_b32_dpp v85, v85, v85, vcc wave_shr:1 row_mask:0xf bank_mask:0xf
    s_lshr_b64 s[52:53], s[52:53], 1
    v_cndmask_b32_dpp v86, v86, v86, vcc wave_shr:1 row_mask:0xf bank_mask:0xf
    v_cndmask_b32_dpp v87, v87, v87, vcc wave_shr:1 row_mask:0xf bank_mask:0xf
    s_andn2_b64 s[82:83], s[82:83], s[52:53]
    v_cndmask_b32_dpp v7, v7, v7, vcc wave_shr:1 row_mask:0xf bank_mask:0xf
    s_mov_b64 vcc, s[50:51]
    s_mov_b64 exec, s[50:51]
    s_cbranch_scc0 L2_d23
    s_mov_b64 exec, s[82:83]
    s_nop 1
    v_mfma_f32_4x4x4_16b_bf16 v[88:91], v[12:13], v[84:85], 0
    s_nop 1
    v_mfma_f32_4x4x4_16b_bf16 v[88:91], v[10:11], v[86:87], v[88:91]
    s_nop 4
    v_cvt_pk_bf16_f32 v88, v88, v89
    v_cvt_pk_bf16_f32 v89, v90, v91
    ds_pk_add_bf16 v7, v88 offset:65408
    ds_pk_add_bf16 v7, v89 offset:65412
    s_mov_b64 exec, vcc
    s_branch L2_d23
L2_c24:
    s_mov_b64 s[50:51], vcc
    s_lshl_b64 s[52:53], s[82:83], 1
    s_andn2_b64 s[52:53], s[52:53], s[80:81]
    s_andn2_b64 s[52:53], s[52:53], s[50:51]
    s_or_b64 s[80:81], s[80:81], s[52:53]
    s_not_b64 vcc, s[52:53]
    s_mov_b64 exec, -1
    v_cndmask_b32_dpp v84, v84, v84, vcc wave_shr:1 row_mask:0xf bank_mask:0xf
    v_cndmask_b32_dpp v85, v85, v85, vcc wave_shr:1 row_mask:0xf bank_mask:0xf
    s_lshr_b64 s[52:53], s[52:53], 1
    v_cndmask_b32_dpp v86, v86, v86, vcc wave_shr:1 row_mask:0xf bank_mask:0xf
    v_cndmask_b32_dpp v87, v87, v87, vcc wave_shr:1 row_mask:0xf bank_mask:0xf
    s_andn2_b64 s[82:83], s[82:83], s[52:53]
    v_cndmask_b32_dpp v7, v7, v7, vcc wave_shr:1 row_mask:0xf bank_mask:0xf
    s_mov_b64 vcc, s[50:51]
    s_mov_b64 exec, s[50:51]
    s_cbranch_scc0 L2_d24
    s_mov_b64 exec, s[82:83]
    s_nop 1
    v_mfma_f32_4x4x4_16b_bf16 v[88:91], v[12:13], v[84:85], 0
    s_nop 1
    v_mfma_f32_4x4x4_16b_bf16 v[88:91], v[10:11], v[86:87], v[88:91]
    s_nop 4
    v_cvt_pk_bf16_f32 v88, v88, v89
    v_cvt_pk_bf16_f32 v89, v90, v91
    ds_pk_add_bf16 v7, v88 offset:65408
    ds_pk_add_bf16 v7, v89 offset:65412
    s_mov_b64 exec, vcc
    s_branch L2_d24
L2_c25:
    s_mov_b64 s[50:51], vcc
    s_lshl_b64 s[52:53], s[82:83], 1
    s_andn2_b64 s[52:53], s[52:53], s[80:81]
    s_andn2_b64 s[52:53], s[52:53], s[50:51]
    s_or_b64 s[80:81], s[80:81], s[52:53]
    s_not_b64 vcc, s[52:53]
    s_mov_b64 exec, -1
    v_cndmask_b32_dpp v84, v84, v84, vcc wave_shr:1 row_mask:0xf bank_mask:0xf
    v_cndmask_b32_dpp v85, v85, v85, vcc wave_shr:1 row_mask:0xf bank_mask:0xf
    s_lshr_b64 s[52:53], s[52:53], 1
    v_cndmask_b32_dpp v86, v86, v86, vcc wave_shr:1 row_mask:0xf bank_mask:0xf
    v_cndmask_b32_dpp v87, v87, v87, vcc wave_shr:1 row_mask:0xf bank_mask:0xf
    s_andn2_b64 s[82:83], s[82:83], s[52:53]
    v_cndmask_b32_dpp v7, v7, v7, vcc wave_shr:1 row_mask:0xf bank_mask:0xf
    s_mov_b64 vcc, s[50:51]
    s_mov_b64 exec, s[50:51]
    s_cbranch_scc0 L2_d25
    s_mov_b64 exec, s[82:83]
    s_nop 1
    v_mfma_f32_4x4x4_16b_bf16 v[88:91], v[12:13], v[84:85], 0
    s_nop 1
    v_mfma_f32_4x4x4_16b_bf16 v[88:91], v[10:11], v[86:87], v[88:91]
    s_nop 4
    v_cvt_pk_bf16_f32 v88, v88, v89
    v_cvt_pk_bf16_f32 v89, v90, v91
    ds_pk_add_bf16 v7, v88 offset:65408
    ds_pk_add_bf16 v7, v89 offset:65412
    s_mov_b64 exec, vcc
    s_branch L2_d25
L2_c26:
    s_mov_b64 s[50:51], vcc
    s_lshl_b64 s[52:53], s[82:83], 1
    s_andn2_b64 s[52:53], s[52:53], s[80:81]
    s_andn2_b64 s[52:53], s[52:53], s[50:51]
    s_or_b64 s[80:81], s[80:81], s[52:53]
    s_not_b64 vcc, s[52:53]
    s_mov_b64 exec, -1
    v_cndmask_b32_dpp v84, v84, v84, vcc wave_shr:1 row_mask:0xf bank_mask:0xf
    v_cndmask_b32_dpp v85, v85, v85, vcc wave_shr:1 row_mask:0xf bank_mask:0xf
    s_lshr_b64 s[52:53], s[52:53], 1
    v_cndmask_b32_dpp v86, v86, v86, vcc wave_shr:1 row_mask:0xf bank_mask:0xf
    v_cndmask_b32_dpp v87, v87, v87, vcc wave_shr:1 row_mask:0xf bank_mask:0xf
    s_andn2_b64 s[82:83], s[82:83], s[52:53]
    v_cndmask_b32_dpp v7, v7, v7, vcc wave_shr:1 row_mask:0xf bank_mask:0xf
    s_mov_b64 vcc, s[50:51]
    s_mov_b64 exec, s[50:51]
    s_cbranch_scc0 L2_d26
    s_mov_b64 exec, s[82:83]
    s_nop 1
    v_mfma_f32_4x4x4_16b_bf16 v[88:91], v[12:13], v[84:85], 0
    s_nop 1
    v_mfma_f32_4x4x4_16b_bf16 v[88:91], v[10:11], v[86:87], v[88:91]
    s_nop 4
    v_cvt_pk_bf16_f32 v88, v88, v89
    v_cvt_pk_bf16_f32 v89, v90, v91
    ds_pk_add_bf16 v7, v88 offset:65408
    ds_pk_add_bf16 v7, v89 offset:65412
    s_mov_b64 exec, vcc
    s_branch L2_d26
L2_xo27:
    v_cmp_lt_u32 vcc, 20, v99
    s_mov_b32 s43, 1
    s_cbranch_vccz L2_xp27
    v_cmp_lt_u32 vcc, 32, v99
    v_cmp_lt_u32 s[58:59], 31, v88
    s_mov_b32 s43, 2
    s_or_b64 vcc, vcc, s[58:59]
    s_cbranch_scc0 L2_xp27
    s_mov_b32 s37, 0x10000
    s_branch L2_xp27
L2_c28:
    s_mov_b64 s[50:51], vcc
    s_lshl_b64 s[52:53], s[82:83], 1
    s_andn2_b64 s[52:53], s[52:53], s[80:81]
    s_andn2_b64 s[52:53], s[52:53], s[50:51]
    s_or_b64 s[80:81], s[80:81], s[52:53]
    s_not_b64 vcc, s[52:53]
    s_mov_b64 exec, -1
    v_cndmask_b32_dpp v84, v84, v84, vcc wave_shr:1 row_mask:0xf bank_mask:0xf
    v_cndmask_b32_dpp v85, v85, v85, vcc wave_shr:1 row_mask:0xf bank_mask:0xf
    s_lshr_b64 s[52:53], s[52:53], 1
    v_cndmask_b32_dpp v86, v86, v86, vcc wave_shr:1 row_mask:0xf bank_mask:0xf
    v_cndmask_b32_dpp v87, v87, v87, vcc wave_shr:1 row_mask:0xf bank_mask:0xf
    s_andn2_b64 s[82:83], s[82:83], s[52:53]
    v_cndmask_b32_dpp v7, v7, v7, vcc wave_shr:1 row_mask:0xf bank_mask:0xf
    s_mov_b64 vcc, s[50:51]
    s_mov_b64 exec, s[50:51]
    s_cbranch_scc0 L2_d28
    s_mov_b64 exec, s[82:83]
    s_nop 1
    v_mfma_f32_4x4x4_16b_bf16 v[88:91], v[12:13], v[84:85], 0
    s_nop 1
    v_mfma_f32_4x4x4_16b_bf16 v[88:91], v[10:11], v[86:87], v[88:91]
    s_nop 4
    v_cvt_pk_bf16_f32 v88, v88, v89
    v_cvt_pk_bf16_f32 v89, v90, v91
    ds_pk_add_bf16 v7, v88 offset:65408
    ds_pk_add_bf16 v7, v89 offset:65412
    s_mov_b64 exec, vcc
    s_branch L2_d28
L2_c29:
    s_mov_b64 s[50:51], vcc
    s_lshl_b64 s[52:53], s[82:83], 1
    s_andn2_b64 s[52:53], s[52:53], s[80:81]
    s_andn2_b64 s[52:53], s[52:53], s[50:51]
    s_or_b64 s[80:81], s[80:81], s[52:53]
    s_not_b64 vcc, s[52:53]
    s_mov_b64 exec, -1
    v_cndmask_b32_dpp v84, v84, v84, vcc wave_shr:1 row_mask:0xf bank_mask:0xf
    v_cndmask_b32_dpp v85, v85, v85, vcc wave_shr:1 row_mask:0xf bank_mask:0xf
    s_lshr_b64 s[52:53], s[52:53], 1
    v_cndmask_b32_dpp v86, v86, v86, vcc wave_shr:1 row_mask:0xf bank_mask:0xf
    v_cndmask_b32_dpp v87, v87, v87, vcc wave_shr:1 row_mask:0xf bank_mask:0xf
    s_andn2_b64 s[82:83], s[82:83], s[52:53]
    v_cndmask_b32_dpp v7, v7, v7, vcc wave_shr:1 row_mask:0xf bank_mask:0xf
    s_mov_b64 vcc, s[50:51]
    s_mov_b64 exec, s[50:51]
    s_cbranch_scc0 L2_d29
    s_mov_b64 exec, s[82:83]
    s_nop 1
    v_mfma_f32_4x4x4_16b_bf16 v[88:91], v[12:13], v[84:85], 0
    s_nop 1
    v_mfma_f32_4x4x4_16b_bf16 v[88:91], v[10:11], v[86:87], v[88:91]
    s_nop 4
    v_cvt_pk_bf16_f32 v88, v88, v89
    v_cvt_pk_bf16_f32 v89, v90, v91
    ds_pk_add_bf16 v7, v88 offset:65408
    ds_pk_add_bf16 v7, v89 offset:65412
    s_mov_b64 exec, vcc
    s_branch L2_d29
L2_c30:
    s_mov_b64 s[50:51], vcc
    s_lshl_b64 s[52:53], s[82:83], 1
    s_andn2_b64 s[52:53], s[52:53], s[80:81]
    s_andn2_b64 s[52:53], s[52:53], s[50:51]
    s_or_b64 s[80:81], s[80:81], s[52:53]
    s_not_b64 vcc, s[52:53]
    s_mov_b64 exec, -1
    v_cndmask_b32_dpp v84, v84, v84, vcc wave_shr:1 row_mask:0xf bank_mask:0xf
    v_cndmask_b32_dpp v85, v85, v85, vcc wave_shr:1 row_mask:0xf bank_mask:0xf
    s_lshr_b64 s[52:53], s[52:53], 1
    v_cndmask_b32_dpp v86, v86, v86, vcc wave_shr:1 row_mask:0xf bank_mask:0xf
    v_cndmask_b32_dpp v87, v87, v87, vcc wave_shr:1 row_mask:0xf bank_mask:0xf
    s_andn2_b64 s[82:83], s[82:83], s[52:53]
    v_cndmask_b32_dpp v7, v7, v7, vcc wave_shr:1 row_mask:0xf bank_mask:0xf
    s_mov_b64 vcc, s[50:51]
    s_mov_b64 exec, s[50:51]
    s_cbranch_scc0 L2_d30
    s_mov_b64 exec, s[82:83]
    s_nop 1
    v_mfma_f32_4x4x4_16b_bf16 v[88:91], v[12:13], v[84:85], 0
    s_nop 1
    v_mfma_f32_4x4x4_16b_bf16 v[88:91], v[10:11], v[86:87], v[88:91]
    s_nop 4
    v_cvt_pk_bf16_f32 v88, v88, v89
    v_cvt_pk_bf16_f32 v89, v90, v91
    ds_pk_add_bf16 v7, v88 offset:65408
    ds_pk_add_bf16 v7, v89 offset:65412
    s_mov_b64 exec, vcc
    s_branch L2_d30
L2_c31:
    s_mov_b64 s[50:51], vcc
    s_lshl_b64 s[52:53], s[82:83], 1
    s_andn2_b64 s[52:53], s[52:53], s[80:81]
    s_andn2_b64 s[52:53], s[52:53], s[50:51]
    s_or_b64 s[80:81], s[80:81], s[52:53]
    s_not_b64 vcc, s[52:53]
    s_mov_b64 exec, -1
    v_cndmask_b32_dpp v84, v84, v84, vcc wave_shr:1 row_mask:0xf bank_mask:0xf
    v_cndmask_b32_dpp v85, v85, v85, vcc wave_shr:1 row_mask:0xf bank_mask:0xf
    s_lshr_b64 s[52:53], s[52:53], 1
    v_cndmask_b32_dpp v86, v86, v86, vcc wave_shr:1 row_mask:0xf bank_mask:0xf
    v_cndmask_b32_dpp v87, v87, v87, vcc wave_shr:1 row_mask:0xf bank_mask:0xf
    s_andn2_b64 s[82:83], s[82:83], s[52:53]
    v_cndmask_b32_dpp v7, v7, v7, vcc wave_shr:1 row_mask:0xf bank_mask:0xf
    s_mov_b64 vcc, s[50:51]
    s_mov_b64 exec, s[50:51]
    s_cbranch_scc0 L2_d31
    s_mov_b64 exec, s[82:83]
    s_nop 1
    v_mfma_f32_4x4x4_16b_bf16 v[88:91], v[12:13], v[84:85], 0
    s_nop 1
    v_mfma_f32_4x4x4_16b_bf16 v[88:91], v[10:11], v[86:87], v[88:91]
    s_nop 4
    v_cvt_pk_bf16_f32 v88, v88, v89
    v_cvt_pk_bf16_f32 v89, v90, v91
    ds_pk_add_bf16 v7, v88 offset:65408
    ds_pk_add_bf16 v7, v89 offset:65412
    s_mov_b64 exec, vcc
    s_branch L2_d31
L2_c32:
    s_mov_b64 s[50:51], vcc
    s_lshl_b64 s[52:53], s[82:83], 1
    s_andn2_b64 s[52:53], s[52:53], s[80:81]
    s_andn2_b64 s[52:53], s[52:53], s[50:51]
    s_or_b64 s[80:81], s[80:81], s[52:53]
    s_not_b64 vcc, s[52:53]
    s_mov_b64 exec, -1
    v_cndmask_b32_dpp v84, v84, v84, vcc wave_shr:1 row_mask:0xf bank_mask:0xf
    v_cndmask_b32_dpp v85, v85, v85, vcc wave_shr:1 row_mask:0xf bank_mask:0xf
    s_lshr_b64 s[52:53], s[52:53], 1
    v_cndmask_b32_dpp v86, v86, v86, vcc wave_shr:1 row_mask:0xf bank_mask:0xf
    v_cndmask_b32_dpp v87, v87, v87, vcc wave_shr:1 row_mask:0xf bank_mask:0xf
    s_andn2_b64 s[82:83], s[82:83], s[52:53]
    v_cndmask_b32_dpp v7, v7, v7, vcc wave_shr:1 row_mask:0xf bank_mask:0xf
    s_mov_b64 vcc, s[50:51]
    s_mov_b64 exec, s[50:51]
    s_cbranch_scc0 L2_d32
    s_mov_b64 exec, s[82:83]
    s_nop 1
    v_mfma_f32_4x4x4_16b_bf16 v[88:91], v[12:13], v[84:85], 0
    s_nop 1
    v_mfma_f32_4x4x4_16b_bf16 v[88:91], v[10:11], v[86:87], v[88:91]
    s_nop 4
    v_cvt_pk_bf16_f32 v88, v88, v89
    v_cvt_pk_bf16_f32 v89, v90, v91
    ds_pk_add_bf16 v7, v88 offset:65408
    ds_pk_add_bf16 v7, v89 offset:65412
    s_mov_b64 exec, vcc
    s_branch L2_d32
L2_c33:
    s_mov_b64 s[50:51], vcc
    s_lshl_b64 s[52:53], s[82:83], 1
    s_andn2_b64 s[52:53], s[52:53], s[80:81]
    s_andn2_b64 s[52:53], s[52:53], s[50:51]
    s_or_b64 s[80:81], s[80:81], s[52:53]
    s_not_b64 vcc, s[52:53]
    s_mov_b64 exec, -1
    v_cndmask_b32_dpp v84, v84, v84, vcc wave_shr:1 row_mask:0xf bank_mask:0xf
    v_cndmask_b32_dpp v85, v85, v85, vcc wave_shr:1 row_mask:0xf bank_mask:0xf
    s_lshr_b64 s[52:53], s[52:53], 1
    v_cndmask_b32_dpp v86, v86, v86, vcc wave_shr:1 row_mask:0xf bank_mask:0xf
    v_cndmask_b32_dpp v87, v87, v87, vcc wave_shr:1 row_mask:0xf bank_mask:0xf
    s_andn2_b64 s[82:83], s[82:83], s[52:53]
    v_cndmask_b32_dpp v7, v7, v7, vcc wave_shr:1 row_mask:0xf bank_mask:0xf
    s_mov_b64 vcc, s[50:51]
    s_mov_b64 exec, s[50:51]
    s_cbranch_scc0 L2_d33
    s_mov_b64 exec, s[82:83]
    s_nop 1
    v_mfma_f32_4x4x4_16b_bf16 v[88:91], v[12:13], v[84:85], 0
    s_nop 1
    v_mfma_f32_4x4x4_16b_bf16 v[88:91], v[10:11], v[86:87], v[88:91]
    s_nop 4
    v_cvt_pk_bf16_f32 v88, v88, v89
    v_cvt_pk_bf16_f32 v89, v90, v91
    ds_pk_add_bf16 v7, v88 offset:65408
    ds_pk_add_bf16 v7, v89 offset:65412
    s_mov_b64 exec, vcc
    s_branch L2_d33
L2_c34:
    s_mov_b64 s[50:51], vcc
    s_lshl_b64 s[52:53], s[82:83], 1
    s_andn2_b64 s[52:53], s[52:53], s[80:81]
    s_andn2_b64 s[52:53], s[52:53], s[50:51]
    s_or_b64 s[80:81], s[80:81], s[52:53]
    s_not_b64 vcc, s[52:53]
    s_mov_b64 exec, -1
    v_cndmask_b32_dpp v84, v84, v84, vcc wave_shr:1 row_mask:0xf bank_mask:0xf
    v_cndmask_b32_dpp v85, v85, v85, vcc wave_shr:1 row_mask:0xf bank_mask:0xf
    s_lshr_b64 s[52:53], s[52:53], 1
    v_cndmask_b32_dpp v86, v86, v86, vcc wave_shr:1 row_mask:0xf bank_mask:0xf
    v_cndmask_b32_dpp v87, v87, v87, vcc wave_shr:1 row_mask:0xf bank_mask:0xf
    s_andn2_b64 s[82:83], s[82:83], s[52:53]
    v_cndmask_b32_dpp v7, v7, v7, vcc wave_shr:1 row_mask:0xf bank_mask:0xf
    s_mov_b64 vcc, s[50:51]
    s_mov_b64 exec, s[50:51]
    s_cbranch_scc0 L2_d34
    s_mov_b64 exec, s[82:83]
    s_nop 1
    v_mfma_f32_4x4x4_16b_bf16 v[88:91], v[12:13], v[84:85], 0
    s_nop 1
    v_mfma_f32_4x4x4_16b_bf16 v[88:91], v[10:11], v[86:87], v[88:91]
    s_nop 4
    v_cvt_pk_bf16_f32 v88, v88, v89
    v_cvt_pk_bf16_f32 v89, v90, v91
    ds_pk_add_bf16 v7, v88 offset:65408
    ds_pk_add_bf16 v7, v89 offset:65412
    s_mov_b64 exec, vcc
    s_branch L2_d34
L2_c35:
    s_mov_b64 s[50:51], vcc
    s_lshl_b64 s[52:53], s[82:83], 1
    s_andn2_b64 s[52:53], s[52:53], s[80:81]
    s_andn2_b64 s[52:53], s[52:53], s[50:51]
    s_or_b64 s[80:81], s[80:81], s[52:53]
    s_not_b64 vcc, s[52:53]
    s_mov_b64 exec, -1
    v_cndmask_b32_dpp v84, v84, v84, vcc wave_shr:1 row_mask:0xf bank_mask:0xf
    v_cndmask_b32_dpp v85, v85, v85, vcc wave_shr:1 row_mask:0xf bank_mask:0xf
    s_lshr_b64 s[52:53], s[52:53], 1
    v_cndmask_b32_dpp v86, v86, v86, vcc wave_shr:1 row_mask:0xf bank_mask:0xf
    v_cndmask_b32_dpp v87, v87, v87, vcc wave_shr:1 row_mask:0xf bank_mask:0xf
    s_andn2_b64 s[82:83], s[82:83], s[52:53]
    v_cndmask_b32_dpp v7, v7, v7, vcc wave_shr:1 row_mask:0xf bank_mask:0xf
    s_mov_b64 vcc, s[50:51]
    s_mov_b64 exec, s[50:51]
    s_cbranch_scc0 L2_d35
    s_mov_b64 exec, s[82:83]
    s_nop 1
    v_mfma_f32_4x4x4_16b_bf16 v[88:91], v[12:13], v[84:85], 0
    s_nop 1
    v_mfma_f32_4x4x4_16b_bf16 v[88:91], v[10:11], v[86:87], v[88:91]
    s_nop 4
    v_cvt_pk_bf16_f32 v88, v88, v89
    v_cvt_pk_bf16_f32 v89, v90, v91
    ds_pk_add_bf16 v7, v88 offset:65408
    ds_pk_add_bf16 v7, v89 offset:65412
    s_mov_b64 exec, vcc
    s_branch L2_d35
L2_xa36:
    s_cmp_eq_u32 s43, 1
    s_cbranch_scc1 L2_xc36
    v_lshlrev_b32 v89, 0, v96
    v_add_u32 v90, 140, v97
    v_bitop3_b32 v90, v89, v45, v90 bitop3:0x6a
    ds_write_b32 v98, v90 offset:28
    v_lshlrev_b32 v89, 4, v96
    v_add_u32 v90, 120, v97
    v_bitop3_b32 v90, v89, v45, v90 bitop3:0x6a
    ds_write_b32 v98, v90 offset:24
    v_lshlrev_b32 v89, 8, v96
    v_add_u32 v90, 100, v97
    v_bitop3_b32 v90, v89, v45, v90 bitop3:0x6a
    ds_write_b32 v98, v90 offset:20
L2_xc36:
    v_lshlrev_b32 v89, 12, v96
    v_add_u32 v90, 80, v97
    v_bitop3_b32 v90, v89, v45, v90 bitop3:0x6a
    ds_write_b32 v98, v90 offset:16
    s_branch L2_xb36
L2_xe36:
    v_cmp_lt_u32 vcc, 32, v99
    v_cmp_lt_u32 s[58:59], 31, v88
    v_lshrrev_b32 v89, 16, v96
    v_add_u32 v97, 80, v97
    s_or_b64 vcc, vcc, s[58:59]
    s_cbranch_scc1 L2_xs36
    v_lshlrev_b32 v89, v1, v89
    v_and_b32 v89, v45, v89
    v_cmp_ne_u32 vcc, 0, v89
    v_xor_b32 v90, v97, v89
    s_add_u32 s3, s37, s38
    v_mbcnt_lo_u32_b32 v98, vcc_lo, 0
    v_mbcnt_hi_u32_b32 v98, vcc_hi, v98
    s_bcnt1_i32_b64 s41, vcc
    v_lshl_add_u32 v98, v98, 2, s3
    s_mov_b64 exec, vcc
    ds_write_b32 v98, v90
    s_mov_b64 exec, -1
    s_lshl2_add_u32 s37, s41, s37
    s_branch L2_xr36
L2_xf36:
    s_waitcnt lgkmcnt(0)
    s_cmp_gt_u32 s37, 1024
    s_cbranch_scc1 L2_xs36
    v_mov_b32 v43, -1
    s_cmp_ge_u32 s37, 512
    s_cbranch_scc1 L2_xg36
    v_mov_b32 v42, -1
    s_cmp_ge_u32 s37, 256
    s_cbranch_scc1 L2_xg36
    v_mov_b32 v41, -1
    s_branch L2_xg36
L2_xs36:
    s_waitcnt lgkmcnt(0)
    v_mov_b32 v40, -1
    v_mov_b32 v41, -1
    v_mov_b32 v42, -1
    v_mov_b32 v43, -1
    s_add_u32 s3, s42, 2
    s_bitset1_b32 s36, s3
    s_branch L2_xg36
L2_c37:
    s_mov_b64 s[50:51], vcc
    s_lshl_b64 s[52:53], s[82:83], 1
    s_andn2_b64 s[52:53], s[52:53], s[80:81]
    s_andn2_b64 s[52:53], s[52:53], s[50:51]
    s_or_b64 s[80:81], s[80:81], s[52:53]
    s_not_b64 vcc, s[52:53]
    s_mov_b64 exec, -1
    v_cndmask_b32_dpp v84, v84, v84, vcc wave_shr:1 row_mask:0xf bank_mask:0xf
    v_cndmask_b32_dpp v85, v85, v85, vcc wave_shr:1 row_mask:0xf bank_mask:0xf
    s_lshr_b64 s[52:53], s[52:53], 1
    v_cndmask_b32_dpp v86, v86, v86, vcc wave_shr:1 row_mask:0xf bank_mask:0xf
    v_cndmask_b32_dpp v87, v87, v87, vcc wave_shr:1 row_mask:0xf bank_mask:0xf
    s_andn2_b64 s[82:83], s[82:83], s[52:53]
    v_cndmask_b32_dpp v7, v7, v7, vcc wave_shr:1 row_mask:0xf bank_mask:0xf
    s_mov_b64 vcc, s[50:51]
    s_mov_b64 exec, s[50:51]
    s_cbranch_scc0 L2_d37
    s_mov_b64 exec, s[82:83]
    s_nop 1
    v_mfma_f32_4x4x4_16b_bf16 v[88:91], v[12:13], v[84:85], 0
    s_nop 1
    v_mfma_f32_4x4x4_16b_bf16 v[88:91], v[10:11], v[86:87], v[88:91]
    s_nop 4
    v_cvt_pk_bf16_f32 v88, v88, v89
    v_cvt_pk_bf16_f32 v89, v90, v91
    ds_pk_add_bf16 v7, v88 offset:65408
    ds_pk_add_bf16 v7, v89 offset:65412
    s_mov_b64 exec, vcc
    s_branch L2_d37
L2_c38:
    s_mov_b64 s[50:51], vcc
    s_lshl_b64 s[52:53], s[82:83], 1
    s_andn2_b64 s[52:53], s[52:53], s[80:81]
    s_andn2_b64 s[52:53], s[52:53], s[50:51]
    s_or_b64 s[80:81], s[80:81], s[52:53]
    s_not_b64 vcc, s[52:53]
    s_mov_b64 exec, -1
    v_cndmask_b32_dpp v84, v84, v84, vcc wave_shr:1 row_mask:0xf bank_mask:0xf
    v_cndmask_b32_dpp v85, v85, v85, vcc wave_shr:1 row_mask:0xf bank_mask:0xf
    s_lshr_b64 s[52:53], s[52:53], 1
    v_cndmask_b32_dpp v86, v86, v86, vcc wave_shr:1 row_mask:0xf bank_mask:0xf
    v_cndmask_b32_dpp v87, v87, v87, vcc wave_shr:1 row_mask:0xf bank_mask:0xf
    s_andn2_b64 s[82:83], s[82:83], s[52:53]
    v_cndmask_b32_dpp v7, v7, v7, vcc wave_shr:1 row_mask:0xf bank_mask:0xf
    s_mov_b64 vcc, s[50:51]
    s_mov_b64 exec, s[50:51]
    s_cbranch_scc0 L2_d38
    s_mov_b64 exec, s[82:83]
    s_nop 1
    v_mfma_f32_4x4x4_16b_bf16 v[88:91], v[12:13], v[84:85], 0
    s_nop 1
    v_mfma_f32_4x4x4_16b_bf16 v[88:91], v[10:11], v[86:87], v[88:91]
    s_nop 4
    v_cvt_pk_bf16_f32 v88, v88, v89
    v_cvt_pk_bf16_f32 v89, v90, v91
    ds_pk_add_bf16 v7, v88 offset:65408
    ds_pk_add_bf16 v7, v89 offset:65412
    s_mov_b64 exec, vcc
    s_branch L2_d38
L2_c39:
    s_mov_b64 s[50:51], vcc
    s_lshl_b64 s[52:53], s[82:83], 1
    s_andn2_b64 s[52:53], s[52:53], s[80:81]
    s_andn2_b64 s[52:53], s[52:53], s[50:51]
    s_or_b64 s[80:81], s[80:81], s[52:53]
    s_not_b64 vcc, s[52:53]
    s_mov_b64 exec, -1
    v_cndmask_b32_dpp v84, v84, v84, vcc wave_shr:1 row_mask:0xf bank_mask:0xf
    v_cndmask_b32_dpp v85, v85, v85, vcc wave_shr:1 row_mask:0xf bank_mask:0xf
    s_lshr_b64 s[52:53], s[52:53], 1
    v_cndmask_b32_dpp v86, v86, v86, vcc wave_shr:1 row_mask:0xf bank_mask:0xf
    v_cndmask_b32_dpp v87, v87, v87, vcc wave_shr:1 row_mask:0xf bank_mask:0xf
    s_andn2_b64 s[82:83], s[82:83], s[52:53]
    v_cndmask_b32_dpp v7, v7, v7, vcc wave_shr:1 row_mask:0xf bank_mask:0xf
    s_mov_b64 vcc, s[50:51]
    s_mov_b64 exec, s[50:51]
    s_cbranch_scc0 L2_d39
    s_mov_b64 exec, s[82:83]
    s_nop 1
    v_mfma_f32_4x4x4_16b_bf16 v[88:91], v[12:13], v[84:85], 0
    s_nop 1
    v_mfma_f32_4x4x4_16b_bf16 v[88:91], v[10:11], v[86:87], v[88:91]
    s_nop 4
    v_cvt_pk_bf16_f32 v88, v88, v89
    v_cvt_pk_bf16_f32 v89, v90, v91
    ds_pk_add_bf16 v7, v88 offset:65408
    ds_pk_add_bf16 v7, v89 offset:65412
    s_mov_b64 exec, vcc
    s_branch L2_d39
L2_c40:
    s_mov_b64 s[50:51], vcc
    s_lshl_b64 s[52:53], s[82:83], 1
    s_andn2_b64 s[52:53], s[52:53], s[80:81]
    s_andn2_b64 s[52:53], s[52:53], s[50:51]
    s_or_b64 s[80:81], s[80:81], s[52:53]
    s_not_b64 vcc, s[52:53]
    s_mov_b64 exec, -1
    v_cndmask_b32_dpp v84, v84, v84, vcc wave_shr:1 row_mask:0xf bank_mask:0xf
    v_cndmask_b32_dpp v85, v85, v85, vcc wave_shr:1 row_mask:0xf bank_mask:0xf
    s_lshr_b64 s[52:53], s[52:53], 1
    v_cndmask_b32_dpp v86, v86, v86, vcc wave_shr:1 row_mask:0xf bank_mask:0xf
    v_cndmask_b32_dpp v87, v87, v87, vcc wave_shr:1 row_mask:0xf bank_mask:0xf
    s_andn2_b64 s[82:83], s[82:83], s[52:53]
    v_cndmask_b32_dpp v7, v7, v7, vcc wave_shr:1 row_mask:0xf bank_mask:0xf
    s_mov_b64 vcc, s[50:51]
    s_mov_b64 exec, s[50:51]
    s_cbranch_scc0 L2_d40
    s_mov_b64 exec, s[82:83]
    s_nop 1
    v_mfma_f32_4x4x4_16b_bf16 v[88:91], v[12:13], v[84:85], 0
    s_nop 1
    v_mfma_f32_4x4x4_16b_bf16 v[88:91], v[10:11], v[86:87], v[88:91]
    s_nop 4
    v_cvt_pk_bf16_f32 v88, v88, v89
    v_cvt_pk_bf16_f32 v89, v90, v91
    ds_pk_add_bf16 v7, v88 offset:65408
    ds_pk_add_bf16 v7, v89 offset:65412
    s_mov_b64 exec, vcc
    s_branch L2_d40
L2_c41:
    s_mov_b64 s[50:51], vcc
    s_lshl_b64 s[52:53], s[82:83], 1
    s_andn2_b64 s[52:53], s[52:53], s[80:81]
    s_andn2_b64 s[52:53], s[52:53], s[50:51]
    s_or_b64 s[80:81], s[80:81], s[52:53]
    s_not_b64 vcc, s[52:53]
    s_mov_b64 exec, -1
    v_cndmask_b32_dpp v84, v84, v84, vcc wave_shr:1 row_mask:0xf bank_mask:0xf
    v_cndmask_b32_dpp v85, v85, v85, vcc wave_shr:1 row_mask:0xf bank_mask:0xf
    s_lshr_b64 s[52:53], s[52:53], 1
    v_cndmask_b32_dpp v86, v86, v86, vcc wave_shr:1 row_mask:0xf bank_mask:0xf
    v_cndmask_b32_dpp v87, v87, v87, vcc wave_shr:1 row_mask:0xf bank_mask:0xf
    s_andn2_b64 s[82:83], s[82:83], s[52:53]
    v_cndmask_b32_dpp v7, v7, v7, vcc wave_shr:1 row_mask:0xf bank_mask:0xf
    s_mov_b64 vcc, s[50:51]
    s_mov_b64 exec, s[50:51]
    s_cbranch_scc0 L2_d41
    s_mov_b64 exec, s[82:83]
    s_nop 1
    v_mfma_f32_4x4x4_16b_bf16 v[88:91], v[12:13], v[84:85], 0
    s_nop 1
    v_mfma_f32_4x4x4_16b_bf16 v[88:91], v[10:11], v[86:87], v[88:91]
    s_nop 4
    v_cvt_pk_bf16_f32 v88, v88, v89
    v_cvt_pk_bf16_f32 v89, v90, v91
    ds_pk_add_bf16 v7, v88 offset:65408
    ds_pk_add_bf16 v7, v89 offset:65412
    s_mov_b64 exec, vcc
    s_branch L2_d41
L2_c42:
    s_mov_b64 s[50:51], vcc
    s_lshl_b64 s[52:53], s[82:83], 1
    s_andn2_b64 s[52:53], s[52:53], s[80:81]
    s_andn2_b64 s[52:53], s[52:53], s[50:51]
    s_or_b64 s[80:81], s[80:81], s[52:53]
    s_not_b64 vcc, s[52:53]
    s_mov_b64 exec, -1
    v_cndmask_b32_dpp v84, v84, v84, vcc wave_shr:1 row_mask:0xf bank_mask:0xf
    v_cndmask_b32_dpp v85, v85, v85, vcc wave_shr:1 row_mask:0xf bank_mask:0xf
    s_lshr_b64 s[52:53], s[52:53], 1
    v_cndmask_b32_dpp v86, v86, v86, vcc wave_shr:1 row_mask:0xf bank_mask:0xf
    v_cndmask_b32_dpp v87, v87, v87, vcc wave_shr:1 row_mask:0xf bank_mask:0xf
    s_andn2_b64 s[82:83], s[82:83], s[52:53]
    v_cndmask_b32_dpp v7, v7, v7, vcc wave_shr:1 row_mask:0xf bank_mask:0xf
    s_mov_b64 vcc, s[50:51]
    s_mov_b64 exec, s[50:51]
    s_cbranch_scc0 L2_d42
    s_mov_b64 exec, s[82:83]
    s_nop 1
    v_mfma_f32_4x4x4_16b_bf16 v[88:91], v[12:13], v[84:85], 0
    s_nop 1
    v_mfma_f32_4x4x4_16b_bf16 v[88:91], v[10:11], v[86:87], v[88:91]
    s_nop 4
    v_cvt_pk_bf16_f32 v88, v88, v89
    v_cvt_pk_bf16_f32 v89, v90, v91
    ds_pk_add_bf16 v7, v88 offset:65408
    ds_pk_add_bf16 v7, v89 offset:65412
    s_mov_b64 exec, vcc
    s_branch L2_d42
L2_c43:
    s_mov_b64 s[50:51], vcc
    s_lshl_b64 s[52:53], s[82:83], 1
    s_andn2_b64 s[52:53], s[52:53], s[80:81]
    s_andn2_b64 s[52:53], s[52:53], s[50:51]
    s_or_b64 s[80:81], s[80:81], s[52:53]
    s_not_b64 vcc, s[52:53]
    s_mov_b64 exec, -1
    v_cndmask_b32_dpp v84, v84, v84, vcc wave_shr:1 row_mask:0xf bank_mask:0xf
    v_cndmask_b32_dpp v85, v85, v85, vcc wave_shr:1 row_mask:0xf bank_mask:0xf
    s_lshr_b64 s[52:53], s[52:53], 1
    v_cndmask_b32_dpp v86, v86, v86, vcc wave_shr:1 row_mask:0xf bank_mask:0xf
    v_cndmask_b32_dpp v87, v87, v87, vcc wave_shr:1 row_mask:0xf bank_mask:0xf
    s_andn2_b64 s[82:83], s[82:83], s[52:53]
    v_cndmask_b32_dpp v7, v7, v7, vcc wave_shr:1 row_mask:0xf bank_mask:0xf
    s_mov_b64 vcc, s[50:51]
    s_mov_b64 exec, s[50:51]
    s_cbranch_scc0 L2_d43
    s_mov_b64 exec, s[82:83]
    s_nop 1
    v_mfma_f32_4x4x4_16b_bf16 v[88:91], v[12:13], v[84:85], 0
    s_nop 1
    v_mfma_f32_4x4x4_16b_bf16 v[88:91], v[10:11], v[86:87], v[88:91]
    s_nop 4
    v_cvt_pk_bf16_f32 v88, v88, v89
    v_cvt_pk_bf16_f32 v89, v90, v91
    ds_pk_add_bf16 v7, v88 offset:65408
    ds_pk_add_bf16 v7, v89 offset:65412
    s_mov_b64 exec, vcc
    s_branch L2_d43
L2_c44:
    s_mov_b64 s[50:51], vcc
    s_lshl_b64 s[52:53], s[82:83], 1
    s_andn2_b64 s[52:53], s[52:53], s[80:81]
    s_andn2_b64 s[52:53], s[52:53], s[50:51]
    s_or_b64 s[80:81], s[80:81], s[52:53]
    s_not_b64 vcc, s[52:53]
    s_mov_b64 exec, -1
    v_cndmask_b32_dpp v84, v84, v84, vcc wave_shr:1 row_mask:0xf bank_mask:0xf
    v_cndmask_b32_dpp v85, v85, v85, vcc wave_shr:1 row_mask:0xf bank_mask:0xf
    s_lshr_b64 s[52:53], s[52:53], 1
    v_cndmask_b32_dpp v86, v86, v86, vcc wave_shr:1 row_mask:0xf bank_mask:0xf
    v_cndmask_b32_dpp v87, v87, v87, vcc wave_shr:1 row_mask:0xf bank_mask:0xf
    s_andn2_b64 s[82:83], s[82:83], s[52:53]
    v_cndmask_b32_dpp v7, v7, v7, vcc wave_shr:1 row_mask:0xf bank_mask:0xf
    s_mov_b64 vcc, s[50:51]
    s_mov_b64 exec, s[50:51]
    s_cbranch_scc0 L2_d44
    s_mov_b64 exec, s[82:83]
    s_nop 1
    v_mfma_f32_4x4x4_16b_bf16 v[88:91], v[12:13], v[84:85], 0
    s_nop 1
    v_mfma_f32_4x4x4_16b_bf16 v[88:91], v[10:11], v[86:87], v[88:91]
    s_nop 4
    v_cvt_pk_bf16_f32 v88, v88, v89
    v_cvt_pk_bf16_f32 v89, v90, v91
    ds_pk_add_bf16 v7, v88 offset:65408
    ds_pk_add_bf16 v7, v89 offset:65412
    s_mov_b64 exec, vcc
    s_branch L2_d44
L2_xo45:
    v_cmp_lt_u32 vcc, 20, v99
    s_mov_b32 s43, 1
    s_cbranch_vccz L2_xp45
    v_cmp_lt_u32 vcc, 32, v99
    v_cmp_lt_u32 s[58:59], 31, v88
    s_mov_b32 s43, 2
    s_or_b64 vcc, vcc, s[58:59]
    s_cbranch_scc0 L2_xp45
    s_mov_b32 s37, 0x10000
    s_branch L2_xp45
L2_c46:
    s_mov_b64 s[50:51], vcc
    s_lshl_b64 s[52:53], s[82:83], 1
    s_andn2_b64 s[52:53], s[52:53], s[80:81]
    s_andn2_b64 s[52:53], s[52:53], s[50:51]
    s_or_b64 s[80:81], s[80:81], s[52:53]
    s_not_b64 vcc, s[52:53]
    s_mov_b64 exec, -1
    v_cndmask_b32_dpp v84, v84, v84, vcc wave_shr:1 row_mask:0xf bank_mask:0xf
    v_cndmask_b32_dpp v85, v85, v85, vcc wave_shr:1 row_mask:0xf bank_mask:0xf
    s_lshr_b64 s[52:53], s[52:53], 1
    v_cndmask_b32_dpp v86, v86, v86, vcc wave_shr:1 row_mask:0xf bank_mask:0xf
    v_cndmask_b32_dpp v87, v87, v87, vcc wave_shr:1 row_mask:0xf bank_mask:0xf
    s_andn2_b64 s[82:83], s[82:83], s[52:53]
    v_cndmask_b32_dpp v7, v7, v7, vcc wave_shr:1 row_mask:0xf bank_mask:0xf
    s_mov_b64 vcc, s[50:51]
    s_mov_b64 exec, s[50:51]
    s_cbranch_scc0 L2_d46
    s_mov_b64 exec, s[82:83]
    s_nop 1
    v_mfma_f32_4x4x4_16b_bf16 v[88:91], v[12:13], v[84:85], 0
    s_nop 1
    v_mfma_f32_4x4x4_16b_bf16 v[88:91], v[10:11], v[86:87], v[88:91]
    s_nop 4
    v_cvt_pk_bf16_f32 v88, v88, v89
    v_cvt_pk_bf16_f32 v89, v90, v91
    ds_pk_add_bf16 v7, v88 offset:65408
    ds_pk_add_bf16 v7, v89 offset:65412
    s_mov_b64 exec, vcc
    s_branch L2_d46
L2_c47:
    s_mov_b64 s[50:51], vcc
    s_lshl_b64 s[52:53], s[82:83], 1
    s_andn2_b64 s[52:53], s[52:53], s[80:81]
    s_andn2_b64 s[52:53], s[52:53], s[50:51]
    s_or_b64 s[80:81], s[80:81], s[52:53]
    s_not_b64 vcc, s[52:53]
    s_mov_b64 exec, -1
    v_cndmask_b32_dpp v84, v84, v84, vcc wave_shr:1 row_mask:0xf bank_mask:0xf
    v_cndmask_b32_dpp v85, v85, v85, vcc wave_shr:1 row_mask:0xf bank_mask:0xf
    s_lshr_b64 s[52:53], s[52:53], 1
    v_cndmask_b32_dpp v86, v86, v86, vcc wave_shr:1 row_mask:0xf bank_mask:0xf
    v_cndmask_b32_dpp v87, v87, v87, vcc wave_shr:1 row_mask:0xf bank_mask:0xf
    s_andn2_b64 s[82:83], s[82:83], s[52:53]
    v_cndmask_b32_dpp v7, v7, v7, vcc wave_shr:1 row_mask:0xf bank_mask:0xf
    s_mov_b64 vcc, s[50:51]
    s_mov_b64 exec, s[50:51]
    s_cbranch_scc0 L2_d47
    s_mov_b64 exec, s[82:83]
    s_nop 1
    v_mfma_f32_4x4x4_16b_bf16 v[88:91], v[12:13], v[84:85], 0
    s_nop 1
    v_mfma_f32_4x4x4_16b_bf16 v[88:91], v[10:11], v[86:87], v[88:91]
    s_nop 4
    v_cvt_pk_bf16_f32 v88, v88, v89
    v_cvt_pk_bf16_f32 v89, v90, v91
    ds_pk_add_bf16 v7, v88 offset:65408
    ds_pk_add_bf16 v7, v89 offset:65412
    s_mov_b64 exec, vcc
    s_branch L2_d47
L2_c48:
    s_mov_b64 s[50:51], vcc
    s_lshl_b64 s[52:53], s[82:83], 1
    s_andn2_b64 s[52:53], s[52:53], s[80:81]
    s_andn2_b64 s[52:53], s[52:53], s[50:51]
    s_or_b64 s[80:81], s[80:81], s[52:53]
    s_not_b64 vcc, s[52:53]
    s_mov_b64 exec, -1
    v_cndmask_b32_dpp v84, v84, v84, vcc wave_shr:1 row_mask:0xf bank_mask:0xf
    v_cndmask_b32_dpp v85, v85, v85, vcc wave_shr:1 row_mask:0xf bank_mask:0xf
    s_lshr_b64 s[52:53], s[52:53], 1
    v_cndmask_b32_dpp v86, v86, v86, vcc wave_shr:1 row_mask:0xf bank_mask:0xf
    v_cndmask_b32_dpp v87, v87, v87, vcc wave_shr:1 row_mask:0xf bank_mask:0xf
    s_andn2_b64 s[82:83], s[82:83], s[52:53]
    v_cndmask_b32_dpp v7, v7, v7, vcc wave_shr:1 row_mask:0xf bank_mask:0xf
    s_mov_b64 vcc, s[50:51]
    s_mov_b64 exec, s[50:51]
    s_cbranch_scc0 L2_d48
    s_mov_b64 exec, s[82:83]
    s_nop 1
    v_mfma_f32_4x4x4_16b_bf16 v[88:91], v[12:13], v[84:85], 0
    s_nop 1
    v_mfma_f32_4x4x4_16b_bf16 v[88:91], v[10:11], v[86:87], v[88:91]
    s_nop 4
    v_cvt_pk_bf16_f32 v88, v88, v89
    v_cvt_pk_bf16_f32 v89, v90, v91
    ds_pk_add_bf16 v7, v88 offset:65408
    ds_pk_add_bf16 v7, v89 offset:65412
    s_mov_b64 exec, vcc
    s_branch L2_d48
L2_c49:
    s_mov_b64 s[50:51], vcc
    s_lshl_b64 s[52:53], s[82:83], 1
    s_andn2_b64 s[52:53], s[52:53], s[80:81]
    s_andn2_b64 s[52:53], s[52:53], s[50:51]
    s_or_b64 s[80:81], s[80:81], s[52:53]
    s_not_b64 vcc, s[52:53]
    s_mov_b64 exec, -1
    v_cndmask_b32_dpp v84, v84, v84, vcc wave_shr:1 row_mask:0xf bank_mask:0xf
    v_cndmask_b32_dpp v85, v85, v85, vcc wave_shr:1 row_mask:0xf bank_mask:0xf
    s_lshr_b64 s[52:53], s[52:53], 1
    v_cndmask_b32_dpp v86, v86, v86, vcc wave_shr:1 row_mask:0xf bank_mask:0xf
    v_cndmask_b32_dpp v87, v87, v87, vcc wave_shr:1 row_mask:0xf bank_mask:0xf
    s_andn2_b64 s[82:83], s[82:83], s[52:53]
    v_cndmask_b32_dpp v7, v7, v7, vcc wave_shr:1 row_mask:0xf bank_mask:0xf
    s_mov_b64 vcc, s[50:51]
    s_mov_b64 exec, s[50:51]
    s_cbranch_scc0 L2_d49
    s_mov_b64 exec, s[82:83]
    s_nop 1
    v_mfma_f32_4x4x4_16b_bf16 v[88:91], v[12:13], v[84:85], 0
    s_nop 1
    v_mfma_f32_4x4x4_16b_bf16 v[88:91], v[10:11], v[86:87], v[88:91]
    s_nop 4
    v_cvt_pk_bf16_f32 v88, v88, v89
    v_cvt_pk_bf16_f32 v89, v90, v91
    ds_pk_add_bf16 v7, v88 offset:65408
    ds_pk_add_bf16 v7, v89 offset:65412
    s_mov_b64 exec, vcc
    s_branch L2_d49
L2_c50:
    s_mov_b64 s[50:51], vcc
    s_lshl_b64 s[52:53], s[82:83], 1
    s_andn2_b64 s[52:53], s[52:53], s[80:81]
    s_andn2_b64 s[52:53], s[52:53], s[50:51]
    s_or_b64 s[80:81], s[80:81], s[52:53]
    s_not_b64 vcc, s[52:53]
    s_mov_b64 exec, -1
    v_cndmask_b32_dpp v84, v84, v84, vcc wave_shr:1 row_mask:0xf bank_mask:0xf
    v_cndmask_b32_dpp v85, v85, v85, vcc wave_shr:1 row_mask:0xf bank_mask:0xf
    s_lshr_b64 s[52:53], s[52:53], 1
    v_cndmask_b32_dpp v86, v86, v86, vcc wave_shr:1 row_mask:0xf bank_mask:0xf
    v_cndmask_b32_dpp v87, v87, v87, vcc wave_shr:1 row_mask:0xf bank_mask:0xf
    s_andn2_b64 s[82:83], s[82:83], s[52:53]
    v_cndmask_b32_dpp v7, v7, v7, vcc wave_shr:1 row_mask:0xf bank_mask:0xf
    s_mov_b64 vcc, s[50:51]
    s_mov_b64 exec, s[50:51]
    s_cbranch_scc0 L2_d50
    s_mov_b64 exec, s[82:83]
    s_nop 1
    v_mfma_f32_4x4x4_16b_bf16 v[88:91], v[12:13], v[84:85], 0
    s_nop 1
    v_mfma_f32_4x4x4_16b_bf16 v[88:91], v[10:11], v[86:87], v[88:91]
    s_nop 4
    v_cvt_pk_bf16_f32 v88, v88, v89
    v_cvt_pk_bf16_f32 v89, v90, v91
    ds_pk_add_bf16 v7, v88 offset:65408
    ds_pk_add_bf16 v7, v89 offset:65412
    s_mov_b64 exec, vcc
    s_branch L2_d50
L2_c51:
    s_mov_b64 s[50:51], vcc
    s_lshl_b64 s[52:53], s[82:83], 1
    s_andn2_b64 s[52:53], s[52:53], s[80:81]
    s_andn2_b64 s[52:53], s[52:53], s[50:51]
    s_or_b64 s[80:81], s[80:81], s[52:53]
    s_not_b64 vcc, s[52:53]
    s_mov_b64 exec, -1
    v_cndmask_b32_dpp v84, v84, v84, vcc wave_shr:1 row_mask:0xf bank_mask:0xf
    v_cndmask_b32_dpp v85, v85, v85, vcc wave_shr:1 row_mask:0xf bank_mask:0xf
    s_lshr_b64 s[52:53], s[52:53], 1
    v_cndmask_b32_dpp v86, v86, v86, vcc wave_shr:1 row_mask:0xf bank_mask:0xf
    v_cndmask_b32_dpp v87, v87, v87, vcc wave_shr:1 row_mask:0xf bank_mask:0xf
    s_andn2_b64 s[82:83], s[82:83], s[52:53]
    v_cndmask_b32_dpp v7, v7, v7, vcc wave_shr:1 row_mask:0xf bank_mask:0xf
    s_mov_b64 vcc, s[50:51]
    s_mov_b64 exec, s[50:51]
    s_cbranch_scc0 L2_d51
    s_mov_b64 exec, s[82:83]
    s_nop 1
    v_mfma_f32_4x4x4_16b_bf16 v[88:91], v[12:13], v[84:85], 0
    s_nop 1
    v_mfma_f32_4x4x4_16b_bf16 v[88:91], v[10:11], v[86:87], v[88:91]
    s_nop 4
    v_cvt_pk_bf16_f32 v88, v88, v89
    v_cvt_pk_bf16_f32 v89, v90, v91
    ds_pk_add_bf16 v7, v88 offset:65408
    ds_pk_add_bf16 v7, v89 offset:65412
    s_mov_b64 exec, vcc
    s_branch L2_d51
L2_c52:
    s_mov_b64 s[50:51], vcc
    s_lshl_b64 s[52:53], s[82:83], 1
    s_andn2_b64 s[52:53], s[52:53], s[80:81]
    s_andn2_b64 s[52:53], s[52:53], s[50:51]
    s_or_b64 s[80:81], s[80:81], s[52:53]
    s_not_b64 vcc, s[52:53]
    s_mov_b64 exec, -1
    v_cndmask_b32_dpp v84, v84, v84, vcc wave_shr:1 row_mask:0xf bank_mask:0xf
    v_cndmask_b32_dpp v85, v85, v85, vcc wave_shr:1 row_mask:0xf bank_mask:0xf
    s_lshr_b64 s[52:53], s[52:53], 1
    v_cndmask_b32_dpp v86, v86, v86, vcc wave_shr:1 row_mask:0xf bank_mask:0xf
    v_cndmask_b32_dpp v87, v87, v87, vcc wave_shr:1 row_mask:0xf bank_mask:0xf
    s_andn2_b64 s[82:83], s[82:83], s[52:53]
    v_cndmask_b32_dpp v7, v7, v7, vcc wave_shr:1 row_mask:0xf bank_mask:0xf
    s_mov_b64 vcc, s[50:51]
    s_mov_b64 exec, s[50:51]
    s_cbranch_scc0 L2_d52
    s_mov_b64 exec, s[82:83]
    s_nop 1
    v_mfma_f32_4x4x4_16b_bf16 v[88:91], v[12:13], v[84:85], 0
    s_nop 1
    v_mfma_f32_4x4x4_16b_bf16 v[88:91], v[10:11], v[86:87], v[88:91]
    s_nop 4
    v_cvt_pk_bf16_f32 v88, v88, v89
    v_cvt_pk_bf16_f32 v89, v90, v91
    ds_pk_add_bf16 v7, v88 offset:65408
    ds_pk_add_bf16 v7, v89 offset:65412
    s_mov_b64 exec, vcc
    s_branch L2_d52
L2_c53:
    s_mov_b64 s[50:51], vcc
    s_lshl_b64 s[52:53], s[82:83], 1
    s_andn2_b64 s[52:53], s[52:53], s[80:81]
    s_andn2_b64 s[52:53], s[52:53], s[50:51]
    s_or_b64 s[80:81], s[80:81], s[52:53]
    s_not_b64 vcc, s[52:53]
    s_mov_b64 exec, -1
    v_cndmask_b32_dpp v84, v84, v84, vcc wave_shr:1 row_mask:0xf bank_mask:0xf
    v_cndmask_b32_dpp v85, v85, v85, vcc wave_shr:1 row_mask:0xf bank_mask:0xf
    s_lshr_b64 s[52:53], s[52:53], 1
    v_cndmask_b32_dpp v86, v86, v86, vcc wave_shr:1 row_mask:0xf bank_mask:0xf
    v_cndmask_b32_dpp v87, v87, v87, vcc wave_shr:1 row_mask:0xf bank_mask:0xf
    s_andn2_b64 s[82:83], s[82:83], s[52:53]
    v_cndmask_b32_dpp v7, v7, v7, vcc wave_shr:1 row_mask:0xf bank_mask:0xf
    s_mov_b64 vcc, s[50:51]
    s_mov_b64 exec, s[50:51]
    s_cbranch_scc0 L2_d53
    s_mov_b64 exec, s[82:83]
    s_nop 1
    v_mfma_f32_4x4x4_16b_bf16 v[88:91], v[12:13], v[84:85], 0
    s_nop 1
    v_mfma_f32_4x4x4_16b_bf16 v[88:91], v[10:11], v[86:87], v[88:91]
    s_nop 4
    v_cvt_pk_bf16_f32 v88, v88, v89
    v_cvt_pk_bf16_f32 v89, v90, v91
    ds_pk_add_bf16 v7, v88 offset:65408
    ds_pk_add_bf16 v7, v89 offset:65412
    s_mov_b64 exec, vcc
    s_branch L2_d53
L2_xa54:
    s_cmp_eq_u32 s43, 1
    s_cbranch_scc1 L2_xc54
    v_lshlrev_b32 v89, 0, v96
    v_add_u32 v90, 140, v97
    v_bitop3_b32 v90, v89, v45, v90 bitop3:0x6a
    ds_write_b32 v98, v90 offset:28
    v_lshlrev_b32 v89, 4, v96
    v_add_u32 v90, 120, v97
    v_bitop3_b32 v90, v89, v45, v90 bitop3:0x6a
    ds_write_b32 v98, v90 offset:24
    v_lshlrev_b32 v89, 8, v96
    v_add_u32 v90, 100, v97
    v_bitop3_b32 v90, v89, v45, v90 bitop3:0x6a
    ds_write_b32 v98, v90 offset:20
L2_xc54:
    v_lshlrev_b32 v89, 12, v96
    v_add_u32 v90, 80, v97
    v_bitop3_b32 v90, v89, v45, v90 bitop3:0x6a
    ds_write_b32 v98, v90 offset:16
    s_branch L2_xb54
L2_xe54:
    v_cmp_lt_u32 vcc, 32, v99
    v_cmp_lt_u32 s[58:59], 31, v88
    v_lshrrev_b32 v89, 16, v96
    v_add_u32 v97, 80, v97
    s_or_b64 vcc, vcc, s[58:59]
    s_cbranch_scc1 L2_xs54
    v_lshlrev_b32 v89, v1, v89
    v_and_b32 v89, v45, v89
    v_cmp_ne_u32 vcc, 0, v89
    v_xor_b32 v90, v97, v89
    s_add_u32 s3, s37, s38
    v_mbcnt_lo_u32_b32 v98, vcc_lo, 0
    v_mbcnt_hi_u32_b32 v98, vcc_hi, v98
    s_bcnt1_i32_b64 s41, vcc
    v_lshl_add_u32 v98, v98, 2, s3
    s_mov_b64 exec, vcc
    ds_write_b32 v98, v90
    s_mov_b64 exec, -1
    s_lshl2_add_u32 s37, s41, s37
    s_branch L2_xr54
L2_xf54:
    s_waitcnt lgkmcnt(0)
    s_cmp_gt_u32 s37, 1024
    s_cbranch_scc1 L2_xs54
    v_mov_b32 v43, -1
    s_cmp_ge_u32 s37, 512
    s_cbranch_scc1 L2_xg54
    v_mov_b32 v42, -1
    s_cmp_ge_u32 s37, 256
    s_cbranch_scc1 L2_xg54
    v_mov_b32 v41, -1
    s_branch L2_xg54
L2_xs54:
    s_waitcnt lgkmcnt(0)
    v_mov_b32 v40, -1
    v_mov_b32 v41, -1
    v_mov_b32 v42, -1
    v_mov_b32 v43, -1
    s_add_u32 s3, s42, 2
    s_bitset1_b32 s36, s3
    s_branch L2_xg54
L2_c55:
    s_mov_b64 s[50:51], vcc
    s_lshl_b64 s[52:53], s[82:83], 1
    s_andn2_b64 s[52:53], s[52:53], s[80:81]
    s_andn2_b64 s[52:53], s[52:53], s[50:51]
    s_or_b64 s[80:81], s[80:81], s[52:53]
    s_not_b64 vcc, s[52:53]
    s_mov_b64 exec, -1
    v_cndmask_b32_dpp v84, v84, v84, vcc wave_shr:1 row_mask:0xf bank_mask:0xf
    v_cndmask_b32_dpp v85, v85, v85, vcc wave_shr:1 row_mask:0xf bank_mask:0xf
    s_lshr_b64 s[52:53], s[52:53], 1
    v_cndmask_b32_dpp v86, v86, v86, vcc wave_shr:1 row_mask:0xf bank_mask:0xf
    v_cndmask_b32_dpp v87, v87, v87, vcc wave_shr:1 row_mask:0xf bank_mask:0xf
    s_andn2_b64 s[82:83], s[82:83], s[52:53]
    v_cndmask_b32_dpp v7, v7, v7, vcc wave_shr:1 row_mask:0xf bank_mask:0xf
    s_mov_b64 vcc, s[50:51]
    s_mov_b64 exec, s[50:51]
    s_cbranch_scc0 L2_d55
    s_mov_b64 exec, s[82:83]
    s_nop 1
    v_mfma_f32_4x4x4_16b_bf16 v[88:91], v[12:13], v[84:85], 0
    s_nop 1
    v_mfma_f32_4x4x4_16b_bf16 v[88:91], v[10:11], v[86:87], v[88:91]
    s_nop 4
    v_cvt_pk_bf16_f32 v88, v88, v89
    v_cvt_pk_bf16_f32 v89, v90, v91
    ds_pk_add_bf16 v7, v88 offset:65408
    ds_pk_add_bf16 v7, v89 offset:65412
    s_mov_b64 exec, vcc
    s_branch L2_d55
L2_c56:
    s_mov_b64 s[50:51], vcc
    s_lshl_b64 s[52:53], s[82:83], 1
    s_andn2_b64 s[52:53], s[52:53], s[80:81]
    s_andn2_b64 s[52:53], s[52:53], s[50:51]
    s_or_b64 s[80:81], s[80:81], s[52:53]
    s_not_b64 vcc, s[52:53]
    s_mov_b64 exec, -1
    v_cndmask_b32_dpp v84, v84, v84, vcc wave_shr:1 row_mask:0xf bank_mask:0xf
    v_cndmask_b32_dpp v85, v85, v85, vcc wave_shr:1 row_mask:0xf bank_mask:0xf
    s_lshr_b64 s[52:53], s[52:53], 1
    v_cndmask_b32_dpp v86, v86, v86, vcc wave_shr:1 row_mask:0xf bank_mask:0xf
    v_cndmask_b32_dpp v87, v87, v87, vcc wave_shr:1 row_mask:0xf bank_mask:0xf
    s_andn2_b64 s[82:83], s[82:83], s[52:53]
    v_cndmask_b32_dpp v7, v7, v7, vcc wave_shr:1 row_mask:0xf bank_mask:0xf
    s_mov_b64 vcc, s[50:51]
    s_mov_b64 exec, s[50:51]
    s_cbranch_scc0 L2_d56
    s_mov_b64 exec, s[82:83]
    s_nop 1
    v_mfma_f32_4x4x4_16b_bf16 v[88:91], v[12:13], v[84:85], 0
    s_nop 1
    v_mfma_f32_4x4x4_16b_bf16 v[88:91], v[10:11], v[86:87], v[88:91]
    s_nop 4
    v_cvt_pk_bf16_f32 v88, v88, v89
    v_cvt_pk_bf16_f32 v89, v90, v91
    ds_pk_add_bf16 v7, v88 offset:65408
    ds_pk_add_bf16 v7, v89 offset:65412
    s_mov_b64 exec, vcc
    s_branch L2_d56
L2_c57:
    s_mov_b64 s[50:51], vcc
    s_lshl_b64 s[52:53], s[82:83], 1
    s_andn2_b64 s[52:53], s[52:53], s[80:81]
    s_andn2_b64 s[52:53], s[52:53], s[50:51]
    s_or_b64 s[80:81], s[80:81], s[52:53]
    s_not_b64 vcc, s[52:53]
    s_mov_b64 exec, -1
    v_cndmask_b32_dpp v84, v84, v84, vcc wave_shr:1 row_mask:0xf bank_mask:0xf
    v_cndmask_b32_dpp v85, v85, v85, vcc wave_shr:1 row_mask:0xf bank_mask:0xf
    s_lshr_b64 s[52:53], s[52:53], 1
    v_cndmask_b32_dpp v86, v86, v86, vcc wave_shr:1 row_mask:0xf bank_mask:0xf
    v_cndmask_b32_dpp v87, v87, v87, vcc wave_shr:1 row_mask:0xf bank_mask:0xf
    s_andn2_b64 s[82:83], s[82:83], s[52:53]
    v_cndmask_b32_dpp v7, v7, v7, vcc wave_shr:1 row_mask:0xf bank_mask:0xf
    s_mov_b64 vcc, s[50:51]
    s_mov_b64 exec, s[50:51]
    s_cbranch_scc0 L2_d57
    s_mov_b64 exec, s[82:83]
    s_nop 1
    v_mfma_f32_4x4x4_16b_bf16 v[88:91], v[12:13], v[84:85], 0
    s_nop 1
    v_mfma_f32_4x4x4_16b_bf16 v[88:91], v[10:11], v[86:87], v[88:91]
    s_nop 4
    v_cvt_pk_bf16_f32 v88, v88, v89
    v_cvt_pk_bf16_f32 v89, v90, v91
    ds_pk_add_bf16 v7, v88 offset:65408
    ds_pk_add_bf16 v7, v89 offset:65412
    s_mov_b64 exec, vcc
    s_branch L2_d57
L2_c58:
    s_mov_b64 s[50:51], vcc
    s_lshl_b64 s[52:53], s[82:83], 1
    s_andn2_b64 s[52:53], s[52:53], s[80:81]
    s_andn2_b64 s[52:53], s[52:53], s[50:51]
    s_or_b64 s[80:81], s[80:81], s[52:53]
    s_not_b64 vcc, s[52:53]
    s_mov_b64 exec, -1
    v_cndmask_b32_dpp v84, v84, v84, vcc wave_shr:1 row_mask:0xf bank_mask:0xf
    v_cndmask_b32_dpp v85, v85, v85, vcc wave_shr:1 row_mask:0xf bank_mask:0xf
    s_lshr_b64 s[52:53], s[52:53], 1
    v_cndmask_b32_dpp v86, v86, v86, vcc wave_shr:1 row_mask:0xf bank_mask:0xf
    v_cndmask_b32_dpp v87, v87, v87, vcc wave_shr:1 row_mask:0xf bank_mask:0xf
    s_andn2_b64 s[82:83], s[82:83], s[52:53]
    v_cndmask_b32_dpp v7, v7, v7, vcc wave_shr:1 row_mask:0xf bank_mask:0xf
    s_mov_b64 vcc, s[50:51]
    s_mov_b64 exec, s[50:51]
    s_cbranch_scc0 L2_d58
    s_mov_b64 exec, s[82:83]
    s_nop 1
    v_mfma_f32_4x4x4_16b_bf16 v[88:91], v[12:13], v[84:85], 0
    s_nop 1
    v_mfma_f32_4x4x4_16b_bf16 v[88:91], v[10:11], v[86:87], v[88:91]
    s_nop 4
    v_cvt_pk_bf16_f32 v88, v88, v89
    v_cvt_pk_bf16_f32 v89, v90, v91
    ds_pk_add_bf16 v7, v88 offset:65408
    ds_pk_add_bf16 v7, v89 offset:65412
    s_mov_b64 exec, vcc
    s_branch L2_d58
L2_c59:
    s_mov_b64 s[50:51], vcc
    s_lshl_b64 s[52:53], s[82:83], 1
    s_andn2_b64 s[52:53], s[52:53], s[80:81]
    s_andn2_b64 s[52:53], s[52:53], s[50:51]
    s_or_b64 s[80:81], s[80:81], s[52:53]
    s_not_b64 vcc, s[52:53]
    s_mov_b64 exec, -1
    v_cndmask_b32_dpp v84, v84, v84, vcc wave_shr:1 row_mask:0xf bank_mask:0xf
    v_cndmask_b32_dpp v85, v85, v85, vcc wave_shr:1 row_mask:0xf bank_mask:0xf
    s_lshr_b64 s[52:53], s[52:53], 1
    v_cndmask_b32_dpp v86, v86, v86, vcc wave_shr:1 row_mask:0xf bank_mask:0xf
    v_cndmask_b32_dpp v87, v87, v87, vcc wave_shr:1 row_mask:0xf bank_mask:0xf
    s_andn2_b64 s[82:83], s[82:83], s[52:53]
    v_cndmask_b32_dpp v7, v7, v7, vcc wave_shr:1 row_mask:0xf bank_mask:0xf
    s_mov_b64 vcc, s[50:51]
    s_mov_b64 exec, s[50:51]
    s_cbranch_scc0 L2_d59
    s_mov_b64 exec, s[82:83]
    s_nop 1
    v_mfma_f32_4x4x4_16b_bf16 v[88:91], v[12:13], v[84:85], 0
    s_nop 1
    v_mfma_f32_4x4x4_16b_bf16 v[88:91], v[10:11], v[86:87], v[88:91]
    s_nop 4
    v_cvt_pk_bf16_f32 v88, v88, v89
    v_cvt_pk_bf16_f32 v89, v90, v91
    ds_pk_add_bf16 v7, v88 offset:65408
    ds_pk_add_bf16 v7, v89 offset:65412
    s_mov_b64 exec, vcc
    s_branch L2_d59
L2_c60:
    s_mov_b64 s[50:51], vcc
    s_lshl_b64 s[52:53], s[82:83], 1
    s_andn2_b64 s[52:53], s[52:53], s[80:81]
    s_andn2_b64 s[52:53], s[52:53], s[50:51]
    s_or_b64 s[80:81], s[80:81], s[52:53]
    s_not_b64 vcc, s[52:53]
    s_mov_b64 exec, -1
    v_cndmask_b32_dpp v84, v84, v84, vcc wave_shr:1 row_mask:0xf bank_mask:0xf
    v_cndmask_b32_dpp v85, v85, v85, vcc wave_shr:1 row_mask:0xf bank_mask:0xf
    s_lshr_b64 s[52:53], s[52:53], 1
    v_cndmask_b32_dpp v86, v86, v86, vcc wave_shr:1 row_mask:0xf bank_mask:0xf
    v_cndmask_b32_dpp v87, v87, v87, vcc wave_shr:1 row_mask:0xf bank_mask:0xf
    s_andn2_b64 s[82:83], s[82:83], s[52:53]
    v_cndmask_b32_dpp v7, v7, v7, vcc wave_shr:1 row_mask:0xf bank_mask:0xf
    s_mov_b64 vcc, s[50:51]
    s_mov_b64 exec, s[50:51]
    s_cbranch_scc0 L2_d60
    s_mov_b64 exec, s[82:83]
    s_nop 1
    v_mfma_f32_4x4x4_16b_bf16 v[88:91], v[12:13], v[84:85], 0
    s_nop 1
    v_mfma_f32_4x4x4_16b_bf16 v[88:91], v[10:11], v[86:87], v[88:91]
    s_nop 4
    v_cvt_pk_bf16_f32 v88, v88, v89
    v_cvt_pk_bf16_f32 v89, v90, v91
    ds_pk_add_bf16 v7, v88 offset:65408
    ds_pk_add_bf16 v7, v89 offset:65412
    s_mov_b64 exec, vcc
    s_branch L2_d60
L2_c61:
    s_mov_b64 s[50:51], vcc
    s_lshl_b64 s[52:53], s[82:83], 1
    s_andn2_b64 s[52:53], s[52:53], s[80:81]
    s_andn2_b64 s[52:53], s[52:53], s[50:51]
    s_or_b64 s[80:81], s[80:81], s[52:53]
    s_not_b64 vcc, s[52:53]
    s_mov_b64 exec, -1
    v_cndmask_b32_dpp v84, v84, v84, vcc wave_shr:1 row_mask:0xf bank_mask:0xf
    v_cndmask_b32_dpp v85, v85, v85, vcc wave_shr:1 row_mask:0xf bank_mask:0xf
    s_lshr_b64 s[52:53], s[52:53], 1
    v_cndmask_b32_dpp v86, v86, v86, vcc wave_shr:1 row_mask:0xf bank_mask:0xf
    v_cndmask_b32_dpp v87, v87, v87, vcc wave_shr:1 row_mask:0xf bank_mask:0xf
    s_andn2_b64 s[82:83], s[82:83], s[52:53]
    v_cndmask_b32_dpp v7, v7, v7, vcc wave_shr:1 row_mask:0xf bank_mask:0xf
    s_mov_b64 vcc, s[50:51]
    s_mov_b64 exec, s[50:51]
    s_cbranch_scc0 L2_d61
    s_mov_b64 exec, s[82:83]
    s_nop 1
    v_mfma_f32_4x4x4_16b_bf16 v[88:91], v[12:13], v[84:85], 0
    s_nop 1
    v_mfma_f32_4x4x4_16b_bf16 v[88:91], v[10:11], v[86:87], v[88:91]
    s_nop 4
    v_cvt_pk_bf16_f32 v88, v88, v89
    v_cvt_pk_bf16_f32 v89, v90, v91
    ds_pk_add_bf16 v7, v88 offset:65408
    ds_pk_add_bf16 v7, v89 offset:65412
    s_mov_b64 exec, vcc
    s_branch L2_d61
L2_c62:
    s_mov_b64 s[50:51], vcc
    s_lshl_b64 s[52:53], s[82:83], 1
    s_andn2_b64 s[52:53], s[52:53], s[80:81]
    s_andn2_b64 s[52:53], s[52:53], s[50:51]
    s_or_b64 s[80:81], s[80:81], s[52:53]
    s_not_b64 vcc, s[52:53]
    s_mov_b64 exec, -1
    v_cndmask_b32_dpp v84, v84, v84, vcc wave_shr:1 row_mask:0xf bank_mask:0xf
    v_cndmask_b32_dpp v85, v85, v85, vcc wave_shr:1 row_mask:0xf bank_mask:0xf
    s_lshr_b64 s[52:53], s[52:53], 1
    v_cndmask_b32_dpp v86, v86, v86, vcc wave_shr:1 row_mask:0xf bank_mask:0xf
    v_cndmask_b32_dpp v87, v87, v87, vcc wave_shr:1 row_mask:0xf bank_mask:0xf
    s_andn2_b64 s[82:83], s[82:83], s[52:53]
    v_cndmask_b32_dpp v7, v7, v7, vcc wave_shr:1 row_mask:0xf bank_mask:0xf
    s_mov_b64 vcc, s[50:51]
    s_mov_b64 exec, s[50:51]
    s_cbranch_scc0 L2_d62
    s_mov_b64 exec, s[82:83]
    s_nop 1
    v_mfma_f32_4x4x4_16b_bf16 v[88:91], v[12:13], v[84:85], 0
    s_nop 1
    v_mfma_f32_4x4x4_16b_bf16 v[88:91], v[10:11], v[86:87], v[88:91]
    s_nop 4
    v_cvt_pk_bf16_f32 v88, v88, v89
    v_cvt_pk_bf16_f32 v89, v90, v91
    ds_pk_add_bf16 v7, v88 offset:65408
    ds_pk_add_bf16 v7, v89 offset:65412
    s_mov_b64 exec, vcc
    s_branch L2_d62
L2_xo63:
    v_cmp_lt_u32 vcc, 20, v99
    s_mov_b32 s43, 1
    s_cbranch_vccz L2_xp63
    v_cmp_lt_u32 vcc, 32, v99
    v_cmp_lt_u32 s[58:59], 31, v88
    s_mov_b32 s43, 2
    s_or_b64 vcc, vcc, s[58:59]
    s_cbranch_scc0 L2_xp63
    s_mov_b32 s37, 0x10000
    s_branch L2_xp63
L2_c64:
    s_mov_b64 s[50:51], vcc
    s_lshl_b64 s[52:53], s[82:83], 1
    s_andn2_b64 s[52:53], s[52:53], s[80:81]
    s_andn2_b64 s[52:53], s[52:53], s[50:51]
    s_or_b64 s[80:81], s[80:81], s[52:53]
    s_not_b64 vcc, s[52:53]
    s_mov_b64 exec, -1
    v_cndmask_b32_dpp v84, v84, v84, vcc wave_shr:1 row_mask:0xf bank_mask:0xf
    v_cndmask_b32_dpp v85, v85, v85, vcc wave_shr:1 row_mask:0xf bank_mask:0xf
    s_lshr_b64 s[52:53], s[52:53], 1
    v_cndmask_b32_dpp v86, v86, v86, vcc wave_shr:1 row_mask:0xf bank_mask:0xf
    v_cndmask_b32_dpp v87, v87, v87, vcc wave_shr:1 row_mask:0xf bank_mask:0xf
    s_andn2_b64 s[82:83], s[82:83], s[52:53]
    v_cndmask_b32_dpp v7, v7, v7, vcc wave_shr:1 row_mask:0xf bank_mask:0xf
    s_mov_b64 vcc, s[50:51]
    s_mov_b64 exec, s[50:51]
    s_cbranch_scc0 L2_d64
    s_mov_b64 exec, s[82:83]
    s_nop 1
    v_mfma_f32_4x4x4_16b_bf16 v[88:91], v[12:13], v[84:85], 0
    s_nop 1
    v_mfma_f32_4x4x4_16b_bf16 v[88:91], v[10:11], v[86:87], v[88:91]
    s_nop 4
    v_cvt_pk_bf16_f32 v88, v88, v89
    v_cvt_pk_bf16_f32 v89, v90, v91
    ds_pk_add_bf16 v7, v88 offset:65408
    ds_pk_add_bf16 v7, v89 offset:65412
    s_mov_b64 exec, vcc
    s_branch L2_d64
L2_c65:
    s_mov_b64 s[50:51], vcc
    s_lshl_b64 s[52:53], s[82:83], 1
    s_andn2_b64 s[52:53], s[52:53], s[80:81]
    s_andn2_b64 s[52:53], s[52:53], s[50:51]
    s_or_b64 s[80:81], s[80:81], s[52:53]
    s_not_b64 vcc, s[52:53]
    s_mov_b64 exec, -1
    v_cndmask_b32_dpp v84, v84, v84, vcc wave_shr:1 row_mask:0xf bank_mask:0xf
    v_cndmask_b32_dpp v85, v85, v85, vcc wave_shr:1 row_mask:0xf bank_mask:0xf
    s_lshr_b64 s[52:53], s[52:53], 1
    v_cndmask_b32_dpp v86, v86, v86, vcc wave_shr:1 row_mask:0xf bank_mask:0xf
    v_cndmask_b32_dpp v87, v87, v87, vcc wave_shr:1 row_mask:0xf bank_mask:0xf
    s_andn2_b64 s[82:83], s[82:83], s[52:53]
    v_cndmask_b32_dpp v7, v7, v7, vcc wave_shr:1 row_mask:0xf bank_mask:0xf
    s_mov_b64 vcc, s[50:51]
    s_mov_b64 exec, s[50:51]
    s_cbranch_scc0 L2_d65
    s_mov_b64 exec, s[82:83]
    s_nop 1
    v_mfma_f32_4x4x4_16b_bf16 v[88:91], v[12:13], v[84:85], 0
    s_nop 1
    v_mfma_f32_4x4x4_16b_bf16 v[88:91], v[10:11], v[86:87], v[88:91]
    s_nop 4
    v_cvt_pk_bf16_f32 v88, v88, v89
    v_cvt_pk_bf16_f32 v89, v90, v91
    ds_pk_add_bf16 v7, v88 offset:65408
    ds_pk_add_bf16 v7, v89 offset:65412
    s_mov_b64 exec, vcc
    s_branch L2_d65
L2_c66:
    s_mov_b64 s[50:51], vcc
    s_lshl_b64 s[52:53], s[82:83], 1
    s_andn2_b64 s[52:53], s[52:53], s[80:81]
    s_andn2_b64 s[52:53], s[52:53], s[50:51]
    s_or_b64 s[80:81], s[80:81], s[52:53]
    s_not_b64 vcc, s[52:53]
    s_mov_b64 exec, -1
    v_cndmask_b32_dpp v84, v84, v84, vcc wave_shr:1 row_mask:0xf bank_mask:0xf
    v_cndmask_b32_dpp v85, v85, v85, vcc wave_shr:1 row_mask:0xf bank_mask:0xf
    s_lshr_b64 s[52:53], s[52:53], 1
    v_cndmask_b32_dpp v86, v86, v86, vcc wave_shr:1 row_mask:0xf bank_mask:0xf
    v_cndmask_b32_dpp v87, v87, v87, vcc wave_shr:1 row_mask:0xf bank_mask:0xf
    s_andn2_b64 s[82:83], s[82:83], s[52:53]
    v_cndmask_b32_dpp v7, v7, v7, vcc wave_shr:1 row_mask:0xf bank_mask:0xf
    s_mov_b64 vcc, s[50:51]
    s_mov_b64 exec, s[50:51]
    s_cbranch_scc0 L2_d66
    s_mov_b64 exec, s[82:83]
    s_nop 1
    v_mfma_f32_4x4x4_16b_bf16 v[88:91], v[12:13], v[84:85], 0
    s_nop 1
    v_mfma_f32_4x4x4_16b_bf16 v[88:91], v[10:11], v[86:87], v[88:91]
    s_nop 4
    v_cvt_pk_bf16_f32 v88, v88, v89
    v_cvt_pk_bf16_f32 v89, v90, v91
    ds_pk_add_bf16 v7, v88 offset:65408
    ds_pk_add_bf16 v7, v89 offset:65412
    s_mov_b64 exec, vcc
    s_branch L2_d66
L2_c67:
    s_mov_b64 s[50:51], vcc
    s_lshl_b64 s[52:53], s[82:83], 1
    s_andn2_b64 s[52:53], s[52:53], s[80:81]
    s_andn2_b64 s[52:53], s[52:53], s[50:51]
    s_or_b64 s[80:81], s[80:81], s[52:53]
    s_not_b64 vcc, s[52:53]
    s_mov_b64 exec, -1
    v_cndmask_b32_dpp v84, v84, v84, vcc wave_shr:1 row_mask:0xf bank_mask:0xf
    v_cndmask_b32_dpp v85, v85, v85, vcc wave_shr:1 row_mask:0xf bank_mask:0xf
    s_lshr_b64 s[52:53], s[52:53], 1
    v_cndmask_b32_dpp v86, v86, v86, vcc wave_shr:1 row_mask:0xf bank_mask:0xf
    v_cndmask_b32_dpp v87, v87, v87, vcc wave_shr:1 row_mask:0xf bank_mask:0xf
    s_andn2_b64 s[82:83], s[82:83], s[52:53]
    v_cndmask_b32_dpp v7, v7, v7, vcc wave_shr:1 row_mask:0xf bank_mask:0xf
    s_mov_b64 vcc, s[50:51]
    s_mov_b64 exec, s[50:51]
    s_cbranch_scc0 L2_d67
    s_mov_b64 exec, s[82:83]
    s_nop 1
    v_mfma_f32_4x4x4_16b_bf16 v[88:91], v[12:13], v[84:85], 0
    s_nop 1
    v_mfma_f32_4x4x4_16b_bf16 v[88:91], v[10:11], v[86:87], v[88:91]
    s_nop 4
    v_cvt_pk_bf16_f32 v88, v88, v89
    v_cvt_pk_bf16_f32 v89, v90, v91
    ds_pk_add_bf16 v7, v88 offset:65408
    ds_pk_add_bf16 v7, v89 offset:65412
    s_mov_b64 exec, vcc
    s_branch L2_d67
L2_c68:
    s_mov_b64 s[50:51], vcc
    s_lshl_b64 s[52:53], s[82:83], 1
    s_andn2_b64 s[52:53], s[52:53], s[80:81]
    s_andn2_b64 s[52:53], s[52:53], s[50:51]
    s_or_b64 s[80:81], s[80:81], s[52:53]
    s_not_b64 vcc, s[52:53]
    s_mov_b64 exec, -1
    v_cndmask_b32_dpp v84, v84, v84, vcc wave_shr:1 row_mask:0xf bank_mask:0xf
    v_cndmask_b32_dpp v85, v85, v85, vcc wave_shr:1 row_mask:0xf bank_mask:0xf
    s_lshr_b64 s[52:53], s[52:53], 1
    v_cndmask_b32_dpp v86, v86, v86, vcc wave_shr:1 row_mask:0xf bank_mask:0xf
    v_cndmask_b32_dpp v87, v87, v87, vcc wave_shr:1 row_mask:0xf bank_mask:0xf
    s_andn2_b64 s[82:83], s[82:83], s[52:53]
    v_cndmask_b32_dpp v7, v7, v7, vcc wave_shr:1 row_mask:0xf bank_mask:0xf
    s_mov_b64 vcc, s[50:51]
    s_mov_b64 exec, s[50:51]
    s_cbranch_scc0 L2_d68
    s_mov_b64 exec, s[82:83]
    s_nop 1
    v_mfma_f32_4x4x4_16b_bf16 v[88:91], v[12:13], v[84:85], 0
    s_nop 1
    v_mfma_f32_4x4x4_16b_bf16 v[88:91], v[10:11], v[86:87], v[88:91]
    s_nop 4
    v_cvt_pk_bf16_f32 v88, v88, v89
    v_cvt_pk_bf16_f32 v89, v90, v91
    ds_pk_add_bf16 v7, v88 offset:65408
    ds_pk_add_bf16 v7, v89 offset:65412
    s_mov_b64 exec, vcc
    s_branch L2_d68
L2_c69:
    s_mov_b64 s[50:51], vcc
    s_lshl_b64 s[52:53], s[82:83], 1
    s_andn2_b64 s[52:53], s[52:53], s[80:81]
    s_andn2_b64 s[52:53], s[52:53], s[50:51]
    s_or_b64 s[80:81], s[80:81], s[52:53]
    s_not_b64 vcc, s[52:53]
    s_mov_b64 exec, -1
    v_cndmask_b32_dpp v84, v84, v84, vcc wave_shr:1 row_mask:0xf bank_mask:0xf
    v_cndmask_b32_dpp v85, v85, v85, vcc wave_shr:1 row_mask:0xf bank_mask:0xf
    s_lshr_b64 s[52:53], s[52:53], 1
    v_cndmask_b32_dpp v86, v86, v86, vcc wave_shr:1 row_mask:0xf bank_mask:0xf
    v_cndmask_b32_dpp v87, v87, v87, vcc wave_shr:1 row_mask:0xf bank_mask:0xf
    s_andn2_b64 s[82:83], s[82:83], s[52:53]
    v_cndmask_b32_dpp v7, v7, v7, vcc wave_shr:1 row_mask:0xf bank_mask:0xf
    s_mov_b64 vcc, s[50:51]
    s_mov_b64 exec, s[50:51]
    s_cbranch_scc0 L2_d69
    s_mov_b64 exec, s[82:83]
    s_nop 1
    v_mfma_f32_4x4x4_16b_bf16 v[88:91], v[12:13], v[84:85], 0
    s_nop 1
    v_mfma_f32_4x4x4_16b_bf16 v[88:91], v[10:11], v[86:87], v[88:91]
    s_nop 4
    v_cvt_pk_bf16_f32 v88, v88, v89
    v_cvt_pk_bf16_f32 v89, v90, v91
    ds_pk_add_bf16 v7, v88 offset:65408
    ds_pk_add_bf16 v7, v89 offset:65412
    s_mov_b64 exec, vcc
    s_branch L2_d69
L2_c70:
    s_mov_b64 s[50:51], vcc
    s_lshl_b64 s[52:53], s[82:83], 1
    s_andn2_b64 s[52:53], s[52:53], s[80:81]
    s_andn2_b64 s[52:53], s[52:53], s[50:51]
    s_or_b64 s[80:81], s[80:81], s[52:53]
    s_not_b64 vcc, s[52:53]
    s_mov_b64 exec, -1
    v_cndmask_b32_dpp v84, v84, v84, vcc wave_shr:1 row_mask:0xf bank_mask:0xf
    v_cndmask_b32_dpp v85, v85, v85, vcc wave_shr:1 row_mask:0xf bank_mask:0xf
    s_lshr_b64 s[52:53], s[52:53], 1
    v_cndmask_b32_dpp v86, v86, v86, vcc wave_shr:1 row_mask:0xf bank_mask:0xf
    v_cndmask_b32_dpp v87, v87, v87, vcc wave_shr:1 row_mask:0xf bank_mask:0xf
    s_andn2_b64 s[82:83], s[82:83], s[52:53]
    v_cndmask_b32_dpp v7, v7, v7, vcc wave_shr:1 row_mask:0xf bank_mask:0xf
    s_mov_b64 vcc, s[50:51]
    s_mov_b64 exec, s[50:51]
    s_cbranch_scc0 L2_d70
    s_mov_b64 exec, s[82:83]
    s_nop 1
    v_mfma_f32_4x4x4_16b_bf16 v[88:91], v[12:13], v[84:85], 0
    s_nop 1
    v_mfma_f32_4x4x4_16b_bf16 v[88:91], v[10:11], v[86:87], v[88:91]
    s_nop 4
    v_cvt_pk_bf16_f32 v88, v88, v89
    v_cvt_pk_bf16_f32 v89, v90, v91
    ds_pk_add_bf16 v7, v88 offset:65408
    ds_pk_add_bf16 v7, v89 offset:65412
    s_mov_b64 exec, vcc
    s_branch L2_d70
L2_c71:
    s_mov_b64 s[50:51], vcc
    s_lshl_b64 s[52:53], s[82:83], 1
    s_andn2_b64 s[52:53], s[52:53], s[80:81]
    s_andn2_b64 s[52:53], s[52:53], s[50:51]
    s_or_b64 s[80:81], s[80:81], s[52:53]
    s_not_b64 vcc, s[52:53]
    s_mov_b64 exec, -1
    v_cndmask_b32_dpp v84, v84, v84, vcc wave_shr:1 row_mask:0xf bank_mask:0xf
    v_cndmask_b32_dpp v85, v85, v85, vcc wave_shr:1 row_mask:0xf bank_mask:0xf
    s_lshr_b64 s[52:53], s[52:53], 1
    v_cndmask_b32_dpp v86, v86, v86, vcc wave_shr:1 row_mask:0xf bank_mask:0xf
    v_cndmask_b32_dpp v87, v87, v87, vcc wave_shr:1 row_mask:0xf bank_mask:0xf
    s_andn2_b64 s[82:83], s[82:83], s[52:53]
    v_cndmask_b32_dpp v7, v7, v7, vcc wave_shr:1 row_mask:0xf bank_mask:0xf
    s_mov_b64 vcc, s[50:51]
    s_mov_b64 exec, s[50:51]
    s_cbranch_scc0 L2_d71
    s_mov_b64 exec, s[82:83]
    s_nop 1
    v_mfma_f32_4x4x4_16b_bf16 v[88:91], v[12:13], v[84:85], 0
    s_nop 1
    v_mfma_f32_4x4x4_16b_bf16 v[88:91], v[10:11], v[86:87], v[88:91]
    s_nop 4
    v_cvt_pk_bf16_f32 v88, v88, v89
    v_cvt_pk_bf16_f32 v89, v90, v91
    ds_pk_add_bf16 v7, v88 offset:65408
    ds_pk_add_bf16 v7, v89 offset:65412
    s_mov_b64 exec, vcc
    s_branch L2_d71
L2_xa72:
    s_cmp_eq_u32 s43, 1
    s_cbranch_scc1 L2_xc72
    v_lshlrev_b32 v89, 0, v96
    v_add_u32 v90, 140, v97
    v_bitop3_b32 v90, v89, v45, v90 bitop3:0x6a
    ds_write_b32 v98, v90 offset:28
    v_lshlrev_b32 v89, 4, v96
    v_add_u32 v90, 120, v97
    v_bitop3_b32 v90, v89, v45, v90 bitop3:0x6a
    ds_write_b32 v98, v90 offset:24
    v_lshlrev_b32 v89, 8, v96
    v_add_u32 v90, 100, v97
    v_bitop3_b32 v90, v89, v45, v90 bitop3:0x6a
    ds_write_b32 v98, v90 offset:20
L2_xc72:
    v_lshlrev_b32 v89, 12, v96
    v_add_u32 v90, 80, v97
    v_bitop3_b32 v90, v89, v45, v90 bitop3:0x6a
    ds_write_b32 v98, v90 offset:16
    s_branch L2_xb72
L2_xe72:
    v_cmp_lt_u32 vcc, 32, v99
    v_cmp_lt_u32 s[58:59], 31, v88
    v_lshrrev_b32 v89, 16, v96
    v_add_u32 v97, 80, v97
    s_or_b64 vcc, vcc, s[58:59]
    s_cbranch_scc1 L2_xs72
    v_lshlrev_b32 v89, v1, v89
    v_and_b32 v89, v45, v89
    v_cmp_ne_u32 vcc, 0, v89
    v_xor_b32 v90, v97, v89
    s_add_u32 s3, s37, s38
    v_mbcnt_lo_u32_b32 v98, vcc_lo, 0
    v_mbcnt_hi_u32_b32 v98, vcc_hi, v98
    s_bcnt1_i32_b64 s41, vcc
    v_lshl_add_u32 v98, v98, 2, s3
    s_mov_b64 exec, vcc
    ds_write_b32 v98, v90
    s_mov_b64 exec, -1
    s_lshl2_add_u32 s37, s41, s37
    s_branch L2_xr72
L2_xf72:
    s_waitcnt lgkmcnt(0)
    s_cmp_gt_u32 s37, 1024
    s_cbranch_scc1 L2_xs72
    v_mov_b32 v43, -1
    s_cmp_ge_u32 s37, 512
    s_cbranch_scc1 L2_xg72
    v_mov_b32 v42, -1
    s_cmp_ge_u32 s37, 256
    s_cbranch_scc1 L2_xg72
    v_mov_b32 v41, -1
    s_branch L2_xg72
L2_xs72:
    s_waitcnt lgkmcnt(0)
    v_mov_b32 v40, -1
    v_mov_b32 v41, -1
    v_mov_b32 v42, -1
    v_mov_b32 v43, -1
    s_add_u32 s3, s42, 2
    s_bitset1_b32 s36, s3
    s_branch L2_xg72
L2_c73:
    s_mov_b64 s[50:51], vcc
    s_lshl_b64 s[52:53], s[82:83], 1
    s_andn2_b64 s[52:53], s[52:53], s[80:81]
    s_andn2_b64 s[52:53], s[52:53], s[50:51]
    s_or_b64 s[80:81], s[80:81], s[52:53]
    s_not_b64 vcc, s[52:53]
    s_mov_b64 exec, -1
    v_cndmask_b32_dpp v84, v84, v84, vcc wave_shr:1 row_mask:0xf bank_mask:0xf
    v_cndmask_b32_dpp v85, v85, v85, vcc wave_shr:1 row_mask:0xf bank_mask:0xf
    s_lshr_b64 s[52:53], s[52:53], 1
    v_cndmask_b32_dpp v86, v86, v86, vcc wave_shr:1 row_mask:0xf bank_mask:0xf
    v_cndmask_b32_dpp v87, v87, v87, vcc wave_shr:1 row_mask:0xf bank_mask:0xf
    s_andn2_b64 s[82:83], s[82:83], s[52:53]
    v_cndmask_b32_dpp v7, v7, v7, vcc wave_shr:1 row_mask:0xf bank_mask:0xf
    s_mov_b64 vcc, s[50:51]
    s_mov_b64 exec, s[50:51]
    s_cbranch_scc0 L2_d73
    s_mov_b64 exec, s[82:83]
    s_nop 1
    v_mfma_f32_4x4x4_16b_bf16 v[88:91], v[12:13], v[84:85], 0
    s_nop 1
    v_mfma_f32_4x4x4_16b_bf16 v[88:91], v[10:11], v[86:87], v[88:91]
    s_nop 4
    v_cvt_pk_bf16_f32 v88, v88, v89
    v_cvt_pk_bf16_f32 v89, v90, v91
    ds_pk_add_bf16 v7, v88 offset:65408
    ds_pk_add_bf16 v7, v89 offset:65412
    s_mov_b64 exec, vcc
    s_branch L2_d73
L2_c74:
    s_mov_b64 s[50:51], vcc
    s_lshl_b64 s[52:53], s[82:83], 1
    s_andn2_b64 s[52:53], s[52:53], s[80:81]
    s_andn2_b64 s[52:53], s[52:53], s[50:51]
    s_or_b64 s[80:81], s[80:81], s[52:53]
    s_not_b64 vcc, s[52:53]
    s_mov_b64 exec, -1
    v_cndmask_b32_dpp v84, v84, v84, vcc wave_shr:1 row_mask:0xf bank_mask:0xf
    v_cndmask_b32_dpp v85, v85, v85, vcc wave_shr:1 row_mask:0xf bank_mask:0xf
    s_lshr_b64 s[52:53], s[52:53], 1
    v_cndmask_b32_dpp v86, v86, v86, vcc wave_shr:1 row_mask:0xf bank_mask:0xf
    v_cndmask_b32_dpp v87, v87, v87, vcc wave_shr:1 row_mask:0xf bank_mask:0xf
    s_andn2_b64 s[82:83], s[82:83], s[52:53]
    v_cndmask_b32_dpp v7, v7, v7, vcc wave_shr:1 row_mask:0xf bank_mask:0xf
    s_mov_b64 vcc, s[50:51]
    s_mov_b64 exec, s[50:51]
    s_cbranch_scc0 L2_d74
    s_mov_b64 exec, s[82:83]
    s_nop 1
    v_mfma_f32_4x4x4_16b_bf16 v[88:91], v[12:13], v[84:85], 0
    s_nop 1
    v_mfma_f32_4x4x4_16b_bf16 v[88:91], v[10:11], v[86:87], v[88:91]
    s_nop 4
    v_cvt_pk_bf16_f32 v88, v88, v89
    v_cvt_pk_bf16_f32 v89, v90, v91
    ds_pk_add_bf16 v7, v88 offset:65408
    ds_pk_add_bf16 v7, v89 offset:65412
    s_mov_b64 exec, vcc
    s_branch L2_d74
L2_c75:
    s_mov_b64 s[50:51], vcc
    s_lshl_b64 s[52:53], s[82:83], 1
    s_andn2_b64 s[52:53], s[52:53], s[80:81]
    s_andn2_b64 s[52:53], s[52:53], s[50:51]
    s_or_b64 s[80:81], s[80:81], s[52:53]
    s_not_b64 vcc, s[52:53]
    s_mov_b64 exec, -1
    v_cndmask_b32_dpp v84, v84, v84, vcc wave_shr:1 row_mask:0xf bank_mask:0xf
    v_cndmask_b32_dpp v85, v85, v85, vcc wave_shr:1 row_mask:0xf bank_mask:0xf
    s_lshr_b64 s[52:53], s[52:53], 1
    v_cndmask_b32_dpp v86, v86, v86, vcc wave_shr:1 row_mask:0xf bank_mask:0xf
    v_cndmask_b32_dpp v87, v87, v87, vcc wave_shr:1 row_mask:0xf bank_mask:0xf
    s_andn2_b64 s[82:83], s[82:83], s[52:53]
    v_cndmask_b32_dpp v7, v7, v7, vcc wave_shr:1 row_mask:0xf bank_mask:0xf
    s_mov_b64 vcc, s[50:51]
    s_mov_b64 exec, s[50:51]
    s_cbranch_scc0 L2_d75
    s_mov_b64 exec, s[82:83]
    s_nop 1
    v_mfma_f32_4x4x4_16b_bf16 v[88:91], v[12:13], v[84:85], 0
    s_nop 1
    v_mfma_f32_4x4x4_16b_bf16 v[88:91], v[10:11], v[86:87], v[88:91]
    s_nop 4
    v_cvt_pk_bf16_f32 v88, v88, v89
    v_cvt_pk_bf16_f32 v89, v90, v91
    ds_pk_add_bf16 v7, v88 offset:65408
    ds_pk_add_bf16 v7, v89 offset:65412
    s_mov_b64 exec, vcc
    s_branch L2_d75
L2_c76:
    s_mov_b64 s[50:51], vcc
    s_lshl_b64 s[52:53], s[82:83], 1
    s_andn2_b64 s[52:53], s[52:53], s[80:81]
    s_andn2_b64 s[52:53], s[52:53], s[50:51]
    s_or_b64 s[80:81], s[80:81], s[52:53]
    s_not_b64 vcc, s[52:53]
    s_mov_b64 exec, -1
    v_cndmask_b32_dpp v84, v84, v84, vcc wave_shr:1 row_mask:0xf bank_mask:0xf
    v_cndmask_b32_dpp v85, v85, v85, vcc wave_shr:1 row_mask:0xf bank_mask:0xf
    s_lshr_b64 s[52:53], s[52:53], 1
    v_cndmask_b32_dpp v86, v86, v86, vcc wave_shr:1 row_mask:0xf bank_mask:0xf
    v_cndmask_b32_dpp v87, v87, v87, vcc wave_shr:1 row_mask:0xf bank_mask:0xf
    s_andn2_b64 s[82:83], s[82:83], s[52:53]
    v_cndmask_b32_dpp v7, v7, v7, vcc wave_shr:1 row_mask:0xf bank_mask:0xf
    s_mov_b64 vcc, s[50:51]
    s_mov_b64 exec, s[50:51]
    s_cbranch_scc0 L2_d76
    s_mov_b64 exec, s[82:83]
    s_nop 1
    v_mfma_f32_4x4x4_16b_bf16 v[88:91], v[12:13], v[84:85], 0
    s_nop 1
    v_mfma_f32_4x4x4_16b_bf16 v[88:91], v[10:11], v[86:87], v[88:91]
    s_nop 4
    v_cvt_pk_bf16_f32 v88, v88, v89
    v_cvt_pk_bf16_f32 v89, v90, v91
    ds_pk_add_bf16 v7, v88 offset:65408
    ds_pk_add_bf16 v7, v89 offset:65412
    s_mov_b64 exec, vcc
    s_branch L2_d76
L2_c77:
    s_mov_b64 s[50:51], vcc
    s_lshl_b64 s[52:53], s[82:83], 1
    s_andn2_b64 s[52:53], s[52:53], s[80:81]
    s_andn2_b64 s[52:53], s[52:53], s[50:51]
    s_or_b64 s[80:81], s[80:81], s[52:53]
    s_not_b64 vcc, s[52:53]
    s_mov_b64 exec, -1
    v_cndmask_b32_dpp v84, v84, v84, vcc wave_shr:1 row_mask:0xf bank_mask:0xf
    v_cndmask_b32_dpp v85, v85, v85, vcc wave_shr:1 row_mask:0xf bank_mask:0xf
    s_lshr_b64 s[52:53], s[52:53], 1
    v_cndmask_b32_dpp v86, v86, v86, vcc wave_shr:1 row_mask:0xf bank_mask:0xf
    v_cndmask_b32_dpp v87, v87, v87, vcc wave_shr:1 row_mask:0xf bank_mask:0xf
    s_andn2_b64 s[82:83], s[82:83], s[52:53]
    v_cndmask_b32_dpp v7, v7, v7, vcc wave_shr:1 row_mask:0xf bank_mask:0xf
    s_mov_b64 vcc, s[50:51]
    s_mov_b64 exec, s[50:51]
    s_cbranch_scc0 L2_d77
    s_mov_b64 exec, s[82:83]
    s_nop 1
    v_mfma_f32_4x4x4_16b_bf16 v[88:91], v[12:13], v[84:85], 0
    s_nop 1
    v_mfma_f32_4x4x4_16b_bf16 v[88:91], v[10:11], v[86:87], v[88:91]
    s_nop 4
    v_cvt_pk_bf16_f32 v88, v88, v89
    v_cvt_pk_bf16_f32 v89, v90, v91
    ds_pk_add_bf16 v7, v88 offset:65408
    ds_pk_add_bf16 v7, v89 offset:65412
    s_mov_b64 exec, vcc
    s_branch L2_d77
L2_c78:
    s_mov_b64 s[50:51], vcc
    s_lshl_b64 s[52:53], s[82:83], 1
    s_andn2_b64 s[52:53], s[52:53], s[80:81]
    s_andn2_b64 s[52:53], s[52:53], s[50:51]
    s_or_b64 s[80:81], s[80:81], s[52:53]
    s_not_b64 vcc, s[52:53]
    s_mov_b64 exec, -1
    v_cndmask_b32_dpp v84, v84, v84, vcc wave_shr:1 row_mask:0xf bank_mask:0xf
    v_cndmask_b32_dpp v85, v85, v85, vcc wave_shr:1 row_mask:0xf bank_mask:0xf
    s_lshr_b64 s[52:53], s[52:53], 1
    v_cndmask_b32_dpp v86, v86, v86, vcc wave_shr:1 row_mask:0xf bank_mask:0xf
    v_cndmask_b32_dpp v87, v87, v87, vcc wave_shr:1 row_mask:0xf bank_mask:0xf
    s_andn2_b64 s[82:83], s[82:83], s[52:53]
    v_cndmask_b32_dpp v7, v7, v7, vcc wave_shr:1 row_mask:0xf bank_mask:0xf
    s_mov_b64 vcc, s[50:51]
    s_mov_b64 exec, s[50:51]
    s_cbranch_scc0 L2_d78
    s_mov_b64 exec, s[82:83]
    s_nop 1
    v_mfma_f32_4x4x4_16b_bf16 v[88:91], v[12:13], v[84:85], 0
    s_nop 1
    v_mfma_f32_4x4x4_16b_bf16 v[88:91], v[10:11], v[86:87], v[88:91]
    s_nop 4
    v_cvt_pk_bf16_f32 v88, v88, v89
    v_cvt_pk_bf16_f32 v89, v90, v91
    ds_pk_add_bf16 v7, v88 offset:65408
    ds_pk_add_bf16 v7, v89 offset:65412
    s_mov_b64 exec, vcc
    s_branch L2_d78
L2_c79:
    s_mov_b64 s[50:51], vcc
    s_lshl_b64 s[52:53], s[82:83], 1
    s_andn2_b64 s[52:53], s[52:53], s[80:81]
    s_andn2_b64 s[52:53], s[52:53], s[50:51]
    s_or_b64 s[80:81], s[80:81], s[52:53]
    s_not_b64 vcc, s[52:53]
    s_mov_b64 exec, -1
    v_cndmask_b32_dpp v84, v84, v84, vcc wave_shr:1 row_mask:0xf bank_mask:0xf
    v_cndmask_b32_dpp v85, v85, v85, vcc wave_shr:1 row_mask:0xf bank_mask:0xf
    s_lshr_b64 s[52:53], s[52:53], 1
    v_cndmask_b32_dpp v86, v86, v86, vcc wave_shr:1 row_mask:0xf bank_mask:0xf
    v_cndmask_b32_dpp v87, v87, v87, vcc wave_shr:1 row_mask:0xf bank_mask:0xf
    s_andn2_b64 s[82:83], s[82:83], s[52:53]
    v_cndmask_b32_dpp v7, v7, v7, vcc wave_shr:1 row_mask:0xf bank_mask:0xf
    s_mov_b64 vcc, s[50:51]
    s_mov_b64 exec, s[50:51]
    s_cbranch_scc0 L2_d79
    s_mov_b64 exec, s[82:83]
    s_nop 1
    v_mfma_f32_4x4x4_16b_bf16 v[88:91], v[12:13], v[84:85], 0
    s_nop 1
    v_mfma_f32_4x4x4_16b_bf16 v[88:91], v[10:11], v[86:87], v[88:91]
    s_nop 4
    v_cvt_pk_bf16_f32 v88, v88, v89
    v_cvt_pk_bf16_f32 v89, v90, v91
    ds_pk_add_bf16 v7, v88 offset:65408
    ds_pk_add_bf16 v7, v89 offset:65412
    s_mov_b64 exec, vcc
    s_branch L2_d79
L2_c80:
    s_mov_b64 s[50:51], vcc
    s_lshl_b64 s[52:53], s[82:83], 1
    s_andn2_b64 s[52:53], s[52:53], s[80:81]
    s_andn2_b64 s[52:53], s[52:53], s[50:51]
    s_or_b64 s[80:81], s[80:81], s[52:53]
    s_not_b64 vcc, s[52:53]
    s_mov_b64 exec, -1
    v_cndmask_b32_dpp v84, v84, v84, vcc wave_shr:1 row_mask:0xf bank_mask:0xf
    v_cndmask_b32_dpp v85, v85, v85, vcc wave_shr:1 row_mask:0xf bank_mask:0xf
    s_lshr_b64 s[52:53], s[52:53], 1
    v_cndmask_b32_dpp v86, v86, v86, vcc wave_shr:1 row_mask:0xf bank_mask:0xf
    v_cndmask_b32_dpp v87, v87, v87, vcc wave_shr:1 row_mask:0xf bank_mask:0xf
    s_andn2_b64 s[82:83], s[82:83], s[52:53]
    v_cndmask_b32_dpp v7, v7, v7, vcc wave_shr:1 row_mask:0xf bank_mask:0xf
    s_mov_b64 vcc, s[50:51]
    s_mov_b64 exec, s[50:51]
    s_cbranch_scc0 L2_d80
    s_mov_b64 exec, s[82:83]
    s_nop 1
    v_mfma_f32_4x4x4_16b_bf16 v[88:91], v[12:13], v[84:85], 0
    s_nop 1
    v_mfma_f32_4x4x4_16b_bf16 v[88:91], v[10:11], v[86:87], v[88:91]
    s_nop 4
    v_cvt_pk_bf16_f32 v88, v88, v89
    v_cvt_pk_bf16_f32 v89, v90, v91
    ds_pk_add_bf16 v7, v88 offset:65408
    ds_pk_add_bf16 v7, v89 offset:65412
    s_mov_b64 exec, vcc
    s_branch L2_d80
L2_xo81:
    v_cmp_lt_u32 vcc, 20, v99
    s_mov_b32 s43, 1
    s_cbranch_vccz L2_xp81
    v_cmp_lt_u32 vcc, 32, v99
    v_cmp_lt_u32 s[58:59], 31, v88
    s_mov_b32 s43, 2
    s_or_b64 vcc, vcc, s[58:59]
    s_cbranch_scc0 L2_xp81
    s_mov_b32 s37, 0x10000
    s_branch L2_xp81
L2_c82:
    s_mov_b64 s[50:51], vcc
    s_lshl_b64 s[52:53], s[82:83], 1
    s_andn2_b64 s[52:53], s[52:53], s[80:81]
    s_andn2_b64 s[52:53], s[52:53], s[50:51]
    s_or_b64 s[80:81], s[80:81], s[52:53]
    s_not_b64 vcc, s[52:53]
    s_mov_b64 exec, -1
    v_cndmask_b32_dpp v84, v84, v84, vcc wave_shr:1 row_mask:0xf bank_mask:0xf
    v_cndmask_b32_dpp v85, v85, v85, vcc wave_shr:1 row_mask:0xf bank_mask:0xf
    s_lshr_b64 s[52:53], s[52:53], 1
    v_cndmask_b32_dpp v86, v86, v86, vcc wave_shr:1 row_mask:0xf bank_mask:0xf
    v_cndmask_b32_dpp v87, v87, v87, vcc wave_shr:1 row_mask:0xf bank_mask:0xf
    s_andn2_b64 s[82:83], s[82:83], s[52:53]
    v_cndmask_b32_dpp v7, v7, v7, vcc wave_shr:1 row_mask:0xf bank_mask:0xf
    s_mov_b64 vcc, s[50:51]
    s_mov_b64 exec, s[50:51]
    s_cbranch_scc0 L2_d82
    s_mov_b64 exec, s[82:83]
    s_nop 1
    v_mfma_f32_4x4x4_16b_bf16 v[88:91], v[12:13], v[84:85], 0
    s_nop 1
    v_mfma_f32_4x4x4_16b_bf16 v[88:91], v[10:11], v[86:87], v[88:91]
    s_nop 4
    v_cvt_pk_bf16_f32 v88, v88, v89
    v_cvt_pk_bf16_f32 v89, v90, v91
    ds_pk_add_bf16 v7, v88 offset:65408
    ds_pk_add_bf16 v7, v89 offset:65412
    s_mov_b64 exec, vcc
    s_branch L2_d82
L2_c83:
    s_mov_b64 s[50:51], vcc
    s_lshl_b64 s[52:53], s[82:83], 1
    s_andn2_b64 s[52:53], s[52:53], s[80:81]
    s_andn2_b64 s[52:53], s[52:53], s[50:51]
    s_or_b64 s[80:81], s[80:81], s[52:53]
    s_not_b64 vcc, s[52:53]
    s_mov_b64 exec, -1
    v_cndmask_b32_dpp v84, v84, v84, vcc wave_shr:1 row_mask:0xf bank_mask:0xf
    v_cndmask_b32_dpp v85, v85, v85, vcc wave_shr:1 row_mask:0xf bank_mask:0xf
    s_lshr_b64 s[52:53], s[52:53], 1
    v_cndmask_b32_dpp v86, v86, v86, vcc wave_shr:1 row_mask:0xf bank_mask:0xf
    v_cndmask_b32_dpp v87, v87, v87, vcc wave_shr:1 row_mask:0xf bank_mask:0xf
    s_andn2_b64 s[82:83], s[82:83], s[52:53]
    v_cndmask_b32_dpp v7, v7, v7, vcc wave_shr:1 row_mask:0xf bank_mask:0xf
    s_mov_b64 vcc, s[50:51]
    s_mov_b64 exec, s[50:51]
    s_cbranch_scc0 L2_d83
    s_mov_b64 exec, s[82:83]
    s_nop 1
    v_mfma_f32_4x4x4_16b_bf16 v[88:91], v[12:13], v[84:85], 0
    s_nop 1
    v_mfma_f32_4x4x4_16b_bf16 v[88:91], v[10:11], v[86:87], v[88:91]
    s_nop 4
    v_cvt_pk_bf16_f32 v88, v88, v89
    v_cvt_pk_bf16_f32 v89, v90, v91
    ds_pk_add_bf16 v7, v88 offset:65408
    ds_pk_add_bf16 v7, v89 offset:65412
    s_mov_b64 exec, vcc
    s_branch L2_d83
L2_c84:
    s_mov_b64 s[50:51], vcc
    s_lshl_b64 s[52:53], s[82:83], 1
    s_andn2_b64 s[52:53], s[52:53], s[80:81]
    s_andn2_b64 s[52:53], s[52:53], s[50:51]
    s_or_b64 s[80:81], s[80:81], s[52:53]
    s_not_b64 vcc, s[52:53]
    s_mov_b64 exec, -1
    v_cndmask_b32_dpp v84, v84, v84, vcc wave_shr:1 row_mask:0xf bank_mask:0xf
    v_cndmask_b32_dpp v85, v85, v85, vcc wave_shr:1 row_mask:0xf bank_mask:0xf
    s_lshr_b64 s[52:53], s[52:53], 1
    v_cndmask_b32_dpp v86, v86, v86, vcc wave_shr:1 row_mask:0xf bank_mask:0xf
    v_cndmask_b32_dpp v87, v87, v87, vcc wave_shr:1 row_mask:0xf bank_mask:0xf
    s_andn2_b64 s[82:83], s[82:83], s[52:53]
    v_cndmask_b32_dpp v7, v7, v7, vcc wave_shr:1 row_mask:0xf bank_mask:0xf
    s_mov_b64 vcc, s[50:51]
    s_mov_b64 exec, s[50:51]
    s_cbranch_scc0 L2_d84
    s_mov_b64 exec, s[82:83]
    s_nop 1
    v_mfma_f32_4x4x4_16b_bf16 v[88:91], v[12:13], v[84:85], 0
    s_nop 1
    v_mfma_f32_4x4x4_16b_bf16 v[88:91], v[10:11], v[86:87], v[88:91]
    s_nop 4
    v_cvt_pk_bf16_f32 v88, v88, v89
    v_cvt_pk_bf16_f32 v89, v90, v91
    ds_pk_add_bf16 v7, v88 offset:65408
    ds_pk_add_bf16 v7, v89 offset:65412
    s_mov_b64 exec, vcc
    s_branch L2_d84
L2_c85:
    s_mov_b64 s[50:51], vcc
    s_lshl_b64 s[52:53], s[82:83], 1
    s_andn2_b64 s[52:53], s[52:53], s[80:81]
    s_andn2_b64 s[52:53], s[52:53], s[50:51]
    s_or_b64 s[80:81], s[80:81], s[52:53]
    s_not_b64 vcc, s[52:53]
    s_mov_b64 exec, -1
    v_cndmask_b32_dpp v84, v84, v84, vcc wave_shr:1 row_mask:0xf bank_mask:0xf
    v_cndmask_b32_dpp v85, v85, v85, vcc wave_shr:1 row_mask:0xf bank_mask:0xf
    s_lshr_b64 s[52:53], s[52:53], 1
    v_cndmask_b32_dpp v86, v86, v86, vcc wave_shr:1 row_mask:0xf bank_mask:0xf
    v_cndmask_b32_dpp v87, v87, v87, vcc wave_shr:1 row_mask:0xf bank_mask:0xf
    s_andn2_b64 s[82:83], s[82:83], s[52:53]
    v_cndmask_b32_dpp v7, v7, v7, vcc wave_shr:1 row_mask:0xf bank_mask:0xf
    s_mov_b64 vcc, s[50:51]
    s_mov_b64 exec, s[50:51]
    s_cbranch_scc0 L2_d85
    s_mov_b64 exec, s[82:83]
    s_nop 1
    v_mfma_f32_4x4x4_16b_bf16 v[88:91], v[12:13], v[84:85], 0
    s_nop 1
    v_mfma_f32_4x4x4_16b_bf16 v[88:91], v[10:11], v[86:87], v[88:91]
    s_nop 4
    v_cvt_pk_bf16_f32 v88, v88, v89
    v_cvt_pk_bf16_f32 v89, v90, v91
    ds_pk_add_bf16 v7, v88 offset:65408
    ds_pk_add_bf16 v7, v89 offset:65412
    s_mov_b64 exec, vcc
    s_branch L2_d85
L2_c86:
    s_mov_b64 s[50:51], vcc
    s_lshl_b64 s[52:53], s[82:83], 1
    s_andn2_b64 s[52:53], s[52:53], s[80:81]
    s_andn2_b64 s[52:53], s[52:53], s[50:51]
    s_or_b64 s[80:81], s[80:81], s[52:53]
    s_not_b64 vcc, s[52:53]
    s_mov_b64 exec, -1
    v_cndmask_b32_dpp v84, v84, v84, vcc wave_shr:1 row_mask:0xf bank_mask:0xf
    v_cndmask_b32_dpp v85, v85, v85, vcc wave_shr:1 row_mask:0xf bank_mask:0xf
    s_lshr_b64 s[52:53], s[52:53], 1
    v_cndmask_b32_dpp v86, v86, v86, vcc wave_shr:1 row_mask:0xf bank_mask:0xf
    v_cndmask_b32_dpp v87, v87, v87, vcc wave_shr:1 row_mask:0xf bank_mask:0xf
    s_andn2_b64 s[82:83], s[82:83], s[52:53]
    v_cndmask_b32_dpp v7, v7, v7, vcc wave_shr:1 row_mask:0xf bank_mask:0xf
    s_mov_b64 vcc, s[50:51]
    s_mov_b64 exec, s[50:51]
    s_cbranch_scc0 L2_d86
    s_mov_b64 exec, s[82:83]
    s_nop 1
    v_mfma_f32_4x4x4_16b_bf16 v[88:91], v[12:13], v[84:85], 0
    s_nop 1
    v_mfma_f32_4x4x4_16b_bf16 v[88:91], v[10:11], v[86:87], v[88:91]
    s_nop 4
    v_cvt_pk_bf16_f32 v88, v88, v89
    v_cvt_pk_bf16_f32 v89, v90, v91
    ds_pk_add_bf16 v7, v88 offset:65408
    ds_pk_add_bf16 v7, v89 offset:65412
    s_mov_b64 exec, vcc
    s_branch L2_d86
L2_c87:
    s_mov_b64 s[50:51], vcc
    s_lshl_b64 s[52:53], s[82:83], 1
    s_andn2_b64 s[52:53], s[52:53], s[80:81]
    s_andn2_b64 s[52:53], s[52:53], s[50:51]
    s_or_b64 s[80:81], s[80:81], s[52:53]
    s_not_b64 vcc, s[52:53]
    s_mov_b64 exec, -1
    v_cndmask_b32_dpp v84, v84, v84, vcc wave_shr:1 row_mask:0xf bank_mask:0xf
    v_cndmask_b32_dpp v85, v85, v85, vcc wave_shr:1 row_mask:0xf bank_mask:0xf
    s_lshr_b64 s[52:53], s[52:53], 1
    v_cndmask_b32_dpp v86, v86, v86, vcc wave_shr:1 row_mask:0xf bank_mask:0xf
    v_cndmask_b32_dpp v87, v87, v87, vcc wave_shr:1 row_mask:0xf bank_mask:0xf
    s_andn2_b64 s[82:83], s[82:83], s[52:53]
    v_cndmask_b32_dpp v7, v7, v7, vcc wave_shr:1 row_mask:0xf bank_mask:0xf
    s_mov_b64 vcc, s[50:51]
    s_mov_b64 exec, s[50:51]
    s_cbranch_scc0 L2_d87
    s_mov_b64 exec, s[82:83]
    s_nop 1
    v_mfma_f32_4x4x4_16b_bf16 v[88:91], v[12:13], v[84:85], 0
    s_nop 1
    v_mfma_f32_4x4x4_16b_bf16 v[88:91], v[10:11], v[86:87], v[88:91]
    s_nop 4
    v_cvt_pk_bf16_f32 v88, v88, v89
    v_cvt_pk_bf16_f32 v89, v90, v91
    ds_pk_add_bf16 v7, v88 offset:65408
    ds_pk_add_bf16 v7, v89 offset:65412
    s_mov_b64 exec, vcc
    s_branch L2_d87
L2_c88:
    s_mov_b64 s[50:51], vcc
    s_lshl_b64 s[52:53], s[82:83], 1
    s_andn2_b64 s[52:53], s[52:53], s[80:81]
    s_andn2_b64 s[52:53], s[52:53], s[50:51]
    s_or_b64 s[80:81], s[80:81], s[52:53]
    s_not_b64 vcc, s[52:53]
    s_mov_b64 exec, -1
    v_cndmask_b32_dpp v84, v84, v84, vcc wave_shr:1 row_mask:0xf bank_mask:0xf
    v_cndmask_b32_dpp v85, v85, v85, vcc wave_shr:1 row_mask:0xf bank_mask:0xf
    s_lshr_b64 s[52:53], s[52:53], 1
    v_cndmask_b32_dpp v86, v86, v86, vcc wave_shr:1 row_mask:0xf bank_mask:0xf
    v_cndmask_b32_dpp v87, v87, v87, vcc wave_shr:1 row_mask:0xf bank_mask:0xf
    s_andn2_b64 s[82:83], s[82:83], s[52:53]
    v_cndmask_b32_dpp v7, v7, v7, vcc wave_shr:1 row_mask:0xf bank_mask:0xf
    s_mov_b64 vcc, s[50:51]
    s_mov_b64 exec, s[50:51]
    s_cbranch_scc0 L2_d88
    s_mov_b64 exec, s[82:83]
    s_nop 1
    v_mfma_f32_4x4x4_16b_bf16 v[88:91], v[12:13], v[84:85], 0
    s_nop 1
    v_mfma_f32_4x4x4_16b_bf16 v[88:91], v[10:11], v[86:87], v[88:91]
    s_nop 4
    v_cvt_pk_bf16_f32 v88, v88, v89
    v_cvt_pk_bf16_f32 v89, v90, v91
    ds_pk_add_bf16 v7, v88 offset:65408
    ds_pk_add_bf16 v7, v89 offset:65412
    s_mov_b64 exec, vcc
    s_branch L2_d88
L2_c89:
    s_mov_b64 s[50:51], vcc
    s_lshl_b64 s[52:53], s[82:83], 1
    s_andn2_b64 s[52:53], s[52:53], s[80:81]
    s_andn2_b64 s[52:53], s[52:53], s[50:51]
    s_or_b64 s[80:81], s[80:81], s[52:53]
    s_not_b64 vcc, s[52:53]
    s_mov_b64 exec, -1
    v_cndmask_b32_dpp v84, v84, v84, vcc wave_shr:1 row_mask:0xf bank_mask:0xf
    v_cndmask_b32_dpp v85, v85, v85, vcc wave_shr:1 row_mask:0xf bank_mask:0xf
    s_lshr_b64 s[52:53], s[52:53], 1
    v_cndmask_b32_dpp v86, v86, v86, vcc wave_shr:1 row_mask:0xf bank_mask:0xf
    v_cndmask_b32_dpp v87, v87, v87, vcc wave_shr:1 row_mask:0xf bank_mask:0xf
    s_andn2_b64 s[82:83], s[82:83], s[52:53]
    v_cndmask_b32_dpp v7, v7, v7, vcc wave_shr:1 row_mask:0xf bank_mask:0xf
    s_mov_b64 vcc, s[50:51]
    s_mov_b64 exec, s[50:51]
    s_cbranch_scc0 L2_d89
    s_mov_b64 exec, s[82:83]
    s_nop 1
    v_mfma_f32_4x4x4_16b_bf16 v[88:91], v[12:13], v[84:85], 0
    s_nop 1
    v_mfma_f32_4x4x4_16b_bf16 v[88:91], v[10:11], v[86:87], v[88:91]
    s_nop 4
    v_cvt_pk_bf16_f32 v88, v88, v89
    v_cvt_pk_bf16_f32 v89, v90, v91
    ds_pk_add_bf16 v7, v88 offset:65408
    ds_pk_add_bf16 v7, v89 offset:65412
    s_mov_b64 exec, vcc
    s_branch L2_d89
L2_xa90:
    s_cmp_eq_u32 s43, 1
    s_cbranch_scc1 L2_xc90
    v_lshlrev_b32 v89, 0, v96
    v_add_u32 v90, 140, v97
    v_bitop3_b32 v90, v89, v45, v90 bitop3:0x6a
    ds_write_b32 v98, v90 offset:28
    v_lshlrev_b32 v89, 4, v96
    v_add_u32 v90, 120, v97
    v_bitop3_b32 v90, v89, v45, v90 bitop3:0x6a
    ds_write_b32 v98, v90 offset:24
    v_lshlrev_b32 v89, 8, v96
    v_add_u32 v90, 100, v97
    v_bitop3_b32 v90, v89, v45, v90 bitop3:0x6a
    ds_write_b32 v98, v90 offset:20
L2_xc90:
    v_lshlrev_b32 v89, 12, v96
    v_add_u32 v90, 80, v97
    v_bitop3_b32 v90, v89, v45, v90 bitop3:0x6a
    ds_write_b32 v98, v90 offset:16
    s_branch L2_xb90
L2_xe90:
    v_cmp_lt_u32 vcc, 32, v99
    v_cmp_lt_u32 s[58:59], 31, v88
    v_lshrrev_b32 v89, 16, v96
    v_add_u32 v97, 80, v97
    s_or_b64 vcc, vcc, s[58:59]
    s_cbranch_scc1 L2_xs90
    v_lshlrev_b32 v89, v1, v89
    v_and_b32 v89, v45, v89
    v_cmp_ne_u32 vcc, 0, v89
    v_xor_b32 v90, v97, v89
    s_add_u32 s3, s37, s38
    v_mbcnt_lo_u32_b32 v98, vcc_lo, 0
    v_mbcnt_hi_u32_b32 v98, vcc_hi, v98
    s_bcnt1_i32_b64 s41, vcc
    v_lshl_add_u32 v98, v98, 2, s3
    s_mov_b64 exec, vcc
    ds_write_b32 v98, v90
    s_mov_b64 exec, -1
    s_lshl2_add_u32 s37, s41, s37
    s_branch L2_xr90
L2_xf90:
    s_waitcnt lgkmcnt(0)
    s_cmp_gt_u32 s37, 1024
    s_cbranch_scc1 L2_xs90
    v_mov_b32 v43, -1
    s_cmp_ge_u32 s37, 512
    s_cbranch_scc1 L2_xg90
    v_mov_b32 v42, -1
    s_cmp_ge_u32 s37, 256
    s_cbranch_scc1 L2_xg90
    v_mov_b32 v41, -1
    s_branch L2_xg90
L2_xs90:
    s_waitcnt lgkmcnt(0)
    v_mov_b32 v40, -1
    v_mov_b32 v41, -1
    v_mov_b32 v42, -1
    v_mov_b32 v43, -1
    s_add_u32 s3, s42, 2
    s_bitset1_b32 s36, s3
    s_branch L2_xg90
L2_c91:
    s_mov_b64 s[50:51], vcc
    s_lshl_b64 s[52:53], s[82:83], 1
    s_andn2_b64 s[52:53], s[52:53], s[80:81]
    s_andn2_b64 s[52:53], s[52:53], s[50:51]
    s_or_b64 s[80:81], s[80:81], s[52:53]
    s_not_b64 vcc, s[52:53]
    s_mov_b64 exec, -1
    v_cndmask_b32_dpp v84, v84, v84, vcc wave_shr:1 row_mask:0xf bank_mask:0xf
    v_cndmask_b32_dpp v85, v85, v85, vcc wave_shr:1 row_mask:0xf bank_mask:0xf
    s_lshr_b64 s[52:53], s[52:53], 1
    v_cndmask_b32_dpp v86, v86, v86, vcc wave_shr:1 row_mask:0xf bank_mask:0xf
    v_cndmask_b32_dpp v87, v87, v87, vcc wave_shr:1 row_mask:0xf bank_mask:0xf
    s_andn2_b64 s[82:83], s[82:83], s[52:53]
    v_cndmask_b32_dpp v7, v7, v7, vcc wave_shr:1 row_mask:0xf bank_mask:0xf
    s_mov_b64 vcc, s[50:51]
    s_mov_b64 exec, s[50:51]
    s_cbranch_scc0 L2_d91
    s_mov_b64 exec, s[82:83]
    s_nop 1
    v_mfma_f32_4x4x4_16b_bf16 v[88:91], v[12:13], v[84:85], 0
    s_nop 1
    v_mfma_f32_4x4x4_16b_bf16 v[88:91], v[10:11], v[86:87], v[88:91]
    s_nop 4
    v_cvt_pk_bf16_f32 v88, v88, v89
    v_cvt_pk_bf16_f32 v89, v90, v91
    ds_pk_add_bf16 v7, v88 offset:65408
    ds_pk_add_bf16 v7, v89 offset:65412
    s_mov_b64 exec, vcc
    s_branch L2_d91
L2_c92:
    s_mov_b64 s[50:51], vcc
    s_lshl_b64 s[52:53], s[82:83], 1
    s_andn2_b64 s[52:53], s[52:53], s[80:81]
    s_andn2_b64 s[52:53], s[52:53], s[50:51]
    s_or_b64 s[80:81], s[80:81], s[52:53]
    s_not_b64 vcc, s[52:53]
    s_mov_b64 exec, -1
    v_cndmask_b32_dpp v84, v84, v84, vcc wave_shr:1 row_mask:0xf bank_mask:0xf
    v_cndmask_b32_dpp v85, v85, v85, vcc wave_shr:1 row_mask:0xf bank_mask:0xf
    s_lshr_b64 s[52:53], s[52:53], 1
    v_cndmask_b32_dpp v86, v86, v86, vcc wave_shr:1 row_mask:0xf bank_mask:0xf
    v_cndmask_b32_dpp v87, v87, v87, vcc wave_shr:1 row_mask:0xf bank_mask:0xf
    s_andn2_b64 s[82:83], s[82:83], s[52:53]
    v_cndmask_b32_dpp v7, v7, v7, vcc wave_shr:1 row_mask:0xf bank_mask:0xf
    s_mov_b64 vcc, s[50:51]
    s_mov_b64 exec, s[50:51]
    s_cbranch_scc0 L2_d92
    s_mov_b64 exec, s[82:83]
    s_nop 1
    v_mfma_f32_4x4x4_16b_bf16 v[88:91], v[12:13], v[84:85], 0
    s_nop 1
    v_mfma_f32_4x4x4_16b_bf16 v[88:91], v[10:11], v[86:87], v[88:91]
    s_nop 4
    v_cvt_pk_bf16_f32 v88, v88, v89
    v_cvt_pk_bf16_f32 v89, v90, v91
    ds_pk_add_bf16 v7, v88 offset:65408
    ds_pk_add_bf16 v7, v89 offset:65412
    s_mov_b64 exec, vcc
    s_branch L2_d92
L2_c93:
    s_mov_b64 s[50:51], vcc
    s_lshl_b64 s[52:53], s[82:83], 1
    s_andn2_b64 s[52:53], s[52:53], s[80:81]
    s_andn2_b64 s[52:53], s[52:53], s[50:51]
    s_or_b64 s[80:81], s[80:81], s[52:53]
    s_not_b64 vcc, s[52:53]
    s_mov_b64 exec, -1
    v_cndmask_b32_dpp v84, v84, v84, vcc wave_shr:1 row_mask:0xf bank_mask:0xf
    v_cndmask_b32_dpp v85, v85, v85, vcc wave_shr:1 row_mask:0xf bank_mask:0xf
    s_lshr_b64 s[52:53], s[52:53], 1
    v_cndmask_b32_dpp v86, v86, v86, vcc wave_shr:1 row_mask:0xf bank_mask:0xf
    v_cndmask_b32_dpp v87, v87, v87, vcc wave_shr:1 row_mask:0xf bank_mask:0xf
    s_andn2_b64 s[82:83], s[82:83], s[52:53]
    v_cndmask_b32_dpp v7, v7, v7, vcc wave_shr:1 row_mask:0xf bank_mask:0xf
    s_mov_b64 vcc, s[50:51]
    s_mov_b64 exec, s[50:51]
    s_cbranch_scc0 L2_d93
    s_mov_b64 exec, s[82:83]
    s_nop 1
    v_mfma_f32_4x4x4_16b_bf16 v[88:91], v[12:13], v[84:85], 0
    s_nop 1
    v_mfma_f32_4x4x4_16b_bf16 v[88:91], v[10:11], v[86:87], v[88:91]
    s_nop 4
    v_cvt_pk_bf16_f32 v88, v88, v89
    v_cvt_pk_bf16_f32 v89, v90, v91
    ds_pk_add_bf16 v7, v88 offset:65408
    ds_pk_add_bf16 v7, v89 offset:65412
    s_mov_b64 exec, vcc
    s_branch L2_d93
L2_c94:
    s_mov_b64 s[50:51], vcc
    s_lshl_b64 s[52:53], s[82:83], 1
    s_andn2_b64 s[52:53], s[52:53], s[80:81]
    s_andn2_b64 s[52:53], s[52:53], s[50:51]
    s_or_b64 s[80:81], s[80:81], s[52:53]
    s_not_b64 vcc, s[52:53]
    s_mov_b64 exec, -1
    v_cndmask_b32_dpp v84, v84, v84, vcc wave_shr:1 row_mask:0xf bank_mask:0xf
    v_cndmask_b32_dpp v85, v85, v85, vcc wave_shr:1 row_mask:0xf bank_mask:0xf
    s_lshr_b64 s[52:53], s[52:53], 1
    v_cndmask_b32_dpp v86, v86, v86, vcc wave_shr:1 row_mask:0xf bank_mask:0xf
    v_cndmask_b32_dpp v87, v87, v87, vcc wave_shr:1 row_mask:0xf bank_mask:0xf
    s_andn2_b64 s[82:83], s[82:83], s[52:53]
    v_cndmask_b32_dpp v7, v7, v7, vcc wave_shr:1 row_mask:0xf bank_mask:0xf
    s_mov_b64 vcc, s[50:51]
    s_mov_b64 exec, s[50:51]
    s_cbranch_scc0 L2_d94
    s_mov_b64 exec, s[82:83]
    s_nop 1
    v_mfma_f32_4x4x4_16b_bf16 v[88:91], v[12:13], v[84:85], 0
    s_nop 1
    v_mfma_f32_4x4x4_16b_bf16 v[88:91], v[10:11], v[86:87], v[88:91]
    s_nop 4
    v_cvt_pk_bf16_f32 v88, v88, v89
    v_cvt_pk_bf16_f32 v89, v90, v91
    ds_pk_add_bf16 v7, v88 offset:65408
    ds_pk_add_bf16 v7, v89 offset:65412
    s_mov_b64 exec, vcc
    s_branch L2_d94
L2_c95:
    s_mov_b64 s[50:51], vcc
    s_lshl_b64 s[52:53], s[82:83], 1
    s_andn2_b64 s[52:53], s[52:53], s[80:81]
    s_andn2_b64 s[52:53], s[52:53], s[50:51]
    s_or_b64 s[80:81], s[80:81], s[52:53]
    s_not_b64 vcc, s[52:53]
    s_mov_b64 exec, -1
    v_cndmask_b32_dpp v84, v84, v84, vcc wave_shr:1 row_mask:0xf bank_mask:0xf
    v_cndmask_b32_dpp v85, v85, v85, vcc wave_shr:1 row_mask:0xf bank_mask:0xf
    s_lshr_b64 s[52:53], s[52:53], 1
    v_cndmask_b32_dpp v86, v86, v86, vcc wave_shr:1 row_mask:0xf bank_mask:0xf
    v_cndmask_b32_dpp v87, v87, v87, vcc wave_shr:1 row_mask:0xf bank_mask:0xf
    s_andn2_b64 s[82:83], s[82:83], s[52:53]
    v_cndmask_b32_dpp v7, v7, v7, vcc wave_shr:1 row_mask:0xf bank_mask:0xf
    s_mov_b64 vcc, s[50:51]
    s_mov_b64 exec, s[50:51]
    s_cbranch_scc0 L2_d95
    s_mov_b64 exec, s[82:83]
    s_nop 1
    v_mfma_f32_4x4x4_16b_bf16 v[88:91], v[12:13], v[84:85], 0
    s_nop 1
    v_mfma_f32_4x4x4_16b_bf16 v[88:91], v[10:11], v[86:87], v[88:91]
    s_nop 4
    v_cvt_pk_bf16_f32 v88, v88, v89
    v_cvt_pk_bf16_f32 v89, v90, v91
    ds_pk_add_bf16 v7, v88 offset:65408
    ds_pk_add_bf16 v7, v89 offset:65412
    s_mov_b64 exec, vcc
    s_branch L2_d95
L2_c96:
    s_mov_b64 s[50:51], vcc
    s_lshl_b64 s[52:53], s[82:83], 1
    s_andn2_b64 s[52:53], s[52:53], s[80:81]
    s_andn2_b64 s[52:53], s[52:53], s[50:51]
    s_or_b64 s[80:81], s[80:81], s[52:53]
    s_not_b64 vcc, s[52:53]
    s_mov_b64 exec, -1
    v_cndmask_b32_dpp v84, v84, v84, vcc wave_shr:1 row_mask:0xf bank_mask:0xf
    v_cndmask_b32_dpp v85, v85, v85, vcc wave_shr:1 row_mask:0xf bank_mask:0xf
    s_lshr_b64 s[52:53], s[52:53], 1
    v_cndmask_b32_dpp v86, v86, v86, vcc wave_shr:1 row_mask:0xf bank_mask:0xf
    v_cndmask_b32_dpp v87, v87, v87, vcc wave_shr:1 row_mask:0xf bank_mask:0xf
    s_andn2_b64 s[82:83], s[82:83], s[52:53]
    v_cndmask_b32_dpp v7, v7, v7, vcc wave_shr:1 row_mask:0xf bank_mask:0xf
    s_mov_b64 vcc, s[50:51]
    s_mov_b64 exec, s[50:51]
    s_cbranch_scc0 L2_d96
    s_mov_b64 exec, s[82:83]
    s_nop 1
    v_mfma_f32_4x4x4_16b_bf16 v[88:91], v[12:13], v[84:85], 0
    s_nop 1
    v_mfma_f32_4x4x4_16b_bf16 v[88:91], v[10:11], v[86:87], v[88:91]
    s_nop 4
    v_cvt_pk_bf16_f32 v88, v88, v89
    v_cvt_pk_bf16_f32 v89, v90, v91
    ds_pk_add_bf16 v7, v88 offset:65408
    ds_pk_add_bf16 v7, v89 offset:65412
    s_mov_b64 exec, vcc
    s_branch L2_d96
L2_c97:
    s_mov_b64 s[50:51], vcc
    s_lshl_b64 s[52:53], s[82:83], 1
    s_andn2_b64 s[52:53], s[52:53], s[80:81]
    s_andn2_b64 s[52:53], s[52:53], s[50:51]
    s_or_b64 s[80:81], s[80:81], s[52:53]
    s_not_b64 vcc, s[52:53]
    s_mov_b64 exec, -1
    v_cndmask_b32_dpp v84, v84, v84, vcc wave_shr:1 row_mask:0xf bank_mask:0xf
    v_cndmask_b32_dpp v85, v85, v85, vcc wave_shr:1 row_mask:0xf bank_mask:0xf
    s_lshr_b64 s[52:53], s[52:53], 1
    v_cndmask_b32_dpp v86, v86, v86, vcc wave_shr:1 row_mask:0xf bank_mask:0xf
    v_cndmask_b32_dpp v87, v87, v87, vcc wave_shr:1 row_mask:0xf bank_mask:0xf
    s_andn2_b64 s[82:83], s[82:83], s[52:53]
    v_cndmask_b32_dpp v7, v7, v7, vcc wave_shr:1 row_mask:0xf bank_mask:0xf
    s_mov_b64 vcc, s[50:51]
    s_mov_b64 exec, s[50:51]
    s_cbranch_scc0 L2_d97
    s_mov_b64 exec, s[82:83]
    s_nop 1
    v_mfma_f32_4x4x4_16b_bf16 v[88:91], v[12:13], v[84:85], 0
    s_nop 1
    v_mfma_f32_4x4x4_16b_bf16 v[88:91], v[10:11], v[86:87], v[88:91]
    s_nop 4
    v_cvt_pk_bf16_f32 v88, v88, v89
    v_cvt_pk_bf16_f32 v89, v90, v91
    ds_pk_add_bf16 v7, v88 offset:65408
    ds_pk_add_bf16 v7, v89 offset:65412
    s_mov_b64 exec, vcc
    s_branch L2_d97
L2_c98:
    s_mov_b64 s[50:51], vcc
    s_lshl_b64 s[52:53], s[82:83], 1
    s_andn2_b64 s[52:53], s[52:53], s[80:81]
    s_andn2_b64 s[52:53], s[52:53], s[50:51]
    s_or_b64 s[80:81], s[80:81], s[52:53]
    s_not_b64 vcc, s[52:53]
    s_mov_b64 exec, -1
    v_cndmask_b32_dpp v84, v84, v84, vcc wave_shr:1 row_mask:0xf bank_mask:0xf
    v_cndmask_b32_dpp v85, v85, v85, vcc wave_shr:1 row_mask:0xf bank_mask:0xf
    s_lshr_b64 s[52:53], s[52:53], 1
    v_cndmask_b32_dpp v86, v86, v86, vcc wave_shr:1 row_mask:0xf bank_mask:0xf
    v_cndmask_b32_dpp v87, v87, v87, vcc wave_shr:1 row_mask:0xf bank_mask:0xf
    s_andn2_b64 s[82:83], s[82:83], s[52:53]
    v_cndmask_b32_dpp v7, v7, v7, vcc wave_shr:1 row_mask:0xf bank_mask:0xf
    s_mov_b64 vcc, s[50:51]
    s_mov_b64 exec, s[50:51]
    s_cbranch_scc0 L2_d98
    s_mov_b64 exec, s[82:83]
    s_nop 1
    v_mfma_f32_4x4x4_16b_bf16 v[88:91], v[12:13], v[84:85], 0
    s_nop 1
    v_mfma_f32_4x4x4_16b_bf16 v[88:91], v[10:11], v[86:87], v[88:91]
    s_nop 4
    v_cvt_pk_bf16_f32 v88, v88, v89
    v_cvt_pk_bf16_f32 v89, v90, v91
    ds_pk_add_bf16 v7, v88 offset:65408
    ds_pk_add_bf16 v7, v89 offset:65412
    s_mov_b64 exec, vcc
    s_branch L2_d98
L2_xo99:
    v_cmp_lt_u32 vcc, 20, v99
    s_mov_b32 s43, 1
    s_cbranch_vccz L2_xp99
    v_cmp_lt_u32 vcc, 32, v99
    v_cmp_lt_u32 s[58:59], 31, v88
    s_mov_b32 s43, 2
    s_or_b64 vcc, vcc, s[58:59]
    s_cbranch_scc0 L2_xp99
    s_mov_b32 s37, 0x10000
    s_branch L2_xp99
L2_c100:
    s_mov_b64 s[50:51], vcc
    s_lshl_b64 s[52:53], s[82:83], 1
    s_andn2_b64 s[52:53], s[52:53], s[80:81]
    s_andn2_b64 s[52:53], s[52:53], s[50:51]
    s_or_b64 s[80:81], s[80:81], s[52:53]
    s_not_b64 vcc, s[52:53]
    s_mov_b64 exec, -1
    v_cndmask_b32_dpp v84, v84, v84, vcc wave_shr:1 row_mask:0xf bank_mask:0xf
    v_cndmask_b32_dpp v85, v85, v85, vcc wave_shr:1 row_mask:0xf bank_mask:0xf
    s_lshr_b64 s[52:53], s[52:53], 1
    v_cndmask_b32_dpp v86, v86, v86, vcc wave_shr:1 row_mask:0xf bank_mask:0xf
    v_cndmask_b32_dpp v87, v87, v87, vcc wave_shr:1 row_mask:0xf bank_mask:0xf
    s_andn2_b64 s[82:83], s[82:83], s[52:53]
    v_cndmask_b32_dpp v7, v7, v7, vcc wave_shr:1 row_mask:0xf bank_mask:0xf
    s_mov_b64 vcc, s[50:51]
    s_mov_b64 exec, s[50:51]
    s_cbranch_scc0 L2_d100
    s_mov_b64 exec, s[82:83]
    s_nop 1
    v_mfma_f32_4x4x4_16b_bf16 v[88:91], v[12:13], v[84:85], 0
    s_nop 1
    v_mfma_f32_4x4x4_16b_bf16 v[88:91], v[10:11], v[86:87], v[88:91]
    s_nop 4
    v_cvt_pk_bf16_f32 v88, v88, v89
    v_cvt_pk_bf16_f32 v89, v90, v91
    ds_pk_add_bf16 v7, v88 offset:65408
    ds_pk_add_bf16 v7, v89 offset:65412
    s_mov_b64 exec, vcc
    s_branch L2_d100
L2_c101:
    s_mov_b64 s[50:51], vcc
    s_lshl_b64 s[52:53], s[82:83], 1
    s_andn2_b64 s[52:53], s[52:53], s[80:81]
    s_andn2_b64 s[52:53], s[52:53], s[50:51]
    s_or_b64 s[80:81], s[80:81], s[52:53]
    s_not_b64 vcc, s[52:53]
    s_mov_b64 exec, -1
    v_cndmask_b32_dpp v84, v84, v84, vcc wave_shr:1 row_mask:0xf bank_mask:0xf
    v_cndmask_b32_dpp v85, v85, v85, vcc wave_shr:1 row_mask:0xf bank_mask:0xf
    s_lshr_b64 s[52:53], s[52:53], 1
    v_cndmask_b32_dpp v86, v86, v86, vcc wave_shr:1 row_mask:0xf bank_mask:0xf
    v_cndmask_b32_dpp v87, v87, v87, vcc wave_shr:1 row_mask:0xf bank_mask:0xf
    s_andn2_b64 s[82:83], s[82:83], s[52:53]
    v_cndmask_b32_dpp v7, v7, v7, vcc wave_shr:1 row_mask:0xf bank_mask:0xf
    s_mov_b64 vcc, s[50:51]
    s_mov_b64 exec, s[50:51]
    s_cbranch_scc0 L2_d101
    s_mov_b64 exec, s[82:83]
    s_nop 1
    v_mfma_f32_4x4x4_16b_bf16 v[88:91], v[12:13], v[84:85], 0
    s_nop 1
    v_mfma_f32_4x4x4_16b_bf16 v[88:91], v[10:11], v[86:87], v[88:91]
    s_nop 4
    v_cvt_pk_bf16_f32 v88, v88, v89
    v_cvt_pk_bf16_f32 v89, v90, v91
    ds_pk_add_bf16 v7, v88 offset:65408
    ds_pk_add_bf16 v7, v89 offset:65412
    s_mov_b64 exec, vcc
    s_branch L2_d101
L2_c102:
    s_mov_b64 s[50:51], vcc
    s_lshl_b64 s[52:53], s[82:83], 1
    s_andn2_b64 s[52:53], s[52:53], s[80:81]
    s_andn2_b64 s[52:53], s[52:53], s[50:51]
    s_or_b64 s[80:81], s[80:81], s[52:53]
    s_not_b64 vcc, s[52:53]
    s_mov_b64 exec, -1
    v_cndmask_b32_dpp v84, v84, v84, vcc wave_shr:1 row_mask:0xf bank_mask:0xf
    v_cndmask_b32_dpp v85, v85, v85, vcc wave_shr:1 row_mask:0xf bank_mask:0xf
    s_lshr_b64 s[52:53], s[52:53], 1
    v_cndmask_b32_dpp v86, v86, v86, vcc wave_shr:1 row_mask:0xf bank_mask:0xf
    v_cndmask_b32_dpp v87, v87, v87, vcc wave_shr:1 row_mask:0xf bank_mask:0xf
    s_andn2_b64 s[82:83], s[82:83], s[52:53]
    v_cndmask_b32_dpp v7, v7, v7, vcc wave_shr:1 row_mask:0xf bank_mask:0xf
    s_mov_b64 vcc, s[50:51]
    s_mov_b64 exec, s[50:51]
    s_cbranch_scc0 L2_d102
    s_mov_b64 exec, s[82:83]
    s_nop 1
    v_mfma_f32_4x4x4_16b_bf16 v[88:91], v[12:13], v[84:85], 0
    s_nop 1
    v_mfma_f32_4x4x4_16b_bf16 v[88:91], v[10:11], v[86:87], v[88:91]
    s_nop 4
    v_cvt_pk_bf16_f32 v88, v88, v89
    v_cvt_pk_bf16_f32 v89, v90, v91
    ds_pk_add_bf16 v7, v88 offset:65408
    ds_pk_add_bf16 v7, v89 offset:65412
    s_mov_b64 exec, vcc
    s_branch L2_d102
L2_c103:
    s_mov_b64 s[50:51], vcc
    s_lshl_b64 s[52:53], s[82:83], 1
    s_andn2_b64 s[52:53], s[52:53], s[80:81]
    s_andn2_b64 s[52:53], s[52:53], s[50:51]
    s_or_b64 s[80:81], s[80:81], s[52:53]
    s_not_b64 vcc, s[52:53]
    s_mov_b64 exec, -1
    v_cndmask_b32_dpp v84, v84, v84, vcc wave_shr:1 row_mask:0xf bank_mask:0xf
    v_cndmask_b32_dpp v85, v85, v85, vcc wave_shr:1 row_mask:0xf bank_mask:0xf
    s_lshr_b64 s[52:53], s[52:53], 1
    v_cndmask_b32_dpp v86, v86, v86, vcc wave_shr:1 row_mask:0xf bank_mask:0xf
    v_cndmask_b32_dpp v87, v87, v87, vcc wave_shr:1 row_mask:0xf bank_mask:0xf
    s_andn2_b64 s[82:83], s[82:83], s[52:53]
    v_cndmask_b32_dpp v7, v7, v7, vcc wave_shr:1 row_mask:0xf bank_mask:0xf
    s_mov_b64 vcc, s[50:51]
    s_mov_b64 exec, s[50:51]
    s_cbranch_scc0 L2_d103
    s_mov_b64 exec, s[82:83]
    s_nop 1
    v_mfma_f32_4x4x4_16b_bf16 v[88:91], v[12:13], v[84:85], 0
    s_nop 1
    v_mfma_f32_4x4x4_16b_bf16 v[88:91], v[10:11], v[86:87], v[88:91]
    s_nop 4
    v_cvt_pk_bf16_f32 v88, v88, v89
    v_cvt_pk_bf16_f32 v89, v90, v91
    ds_pk_add_bf16 v7, v88 offset:65408
    ds_pk_add_bf16 v7, v89 offset:65412
    s_mov_b64 exec, vcc
    s_branch L2_d103
L2_c104:
    s_mov_b64 s[50:51], vcc
    s_lshl_b64 s[52:53], s[82:83], 1
    s_andn2_b64 s[52:53], s[52:53], s[80:81]
    s_andn2_b64 s[52:53], s[52:53], s[50:51]
    s_or_b64 s[80:81], s[80:81], s[52:53]
    s_not_b64 vcc, s[52:53]
    s_mov_b64 exec, -1
    v_cndmask_b32_dpp v84, v84, v84, vcc wave_shr:1 row_mask:0xf bank_mask:0xf
    v_cndmask_b32_dpp v85, v85, v85, vcc wave_shr:1 row_mask:0xf bank_mask:0xf
    s_lshr_b64 s[52:53], s[52:53], 1
    v_cndmask_b32_dpp v86, v86, v86, vcc wave_shr:1 row_mask:0xf bank_mask:0xf
    v_cndmask_b32_dpp v87, v87, v87, vcc wave_shr:1 row_mask:0xf bank_mask:0xf
    s_andn2_b64 s[82:83], s[82:83], s[52:53]
    v_cndmask_b32_dpp v7, v7, v7, vcc wave_shr:1 row_mask:0xf bank_mask:0xf
    s_mov_b64 vcc, s[50:51]
    s_mov_b64 exec, s[50:51]
    s_cbranch_scc0 L2_d104
    s_mov_b64 exec, s[82:83]
    s_nop 1
    v_mfma_f32_4x4x4_16b_bf16 v[88:91], v[12:13], v[84:85], 0
    s_nop 1
    v_mfma_f32_4x4x4_16b_bf16 v[88:91], v[10:11], v[86:87], v[88:91]
    s_nop 4
    v_cvt_pk_bf16_f32 v88, v88, v89
    v_cvt_pk_bf16_f32 v89, v90, v91
    ds_pk_add_bf16 v7, v88 offset:65408
    ds_pk_add_bf16 v7, v89 offset:65412
    s_mov_b64 exec, vcc
    s_branch L2_d104
L2_c105:
    s_mov_b64 s[50:51], vcc
    s_lshl_b64 s[52:53], s[82:83], 1
    s_andn2_b64 s[52:53], s[52:53], s[80:81]
    s_andn2_b64 s[52:53], s[52:53], s[50:51]
    s_or_b64 s[80:81], s[80:81], s[52:53]
    s_not_b64 vcc, s[52:53]
    s_mov_b64 exec, -1
    v_cndmask_b32_dpp v84, v84, v84, vcc wave_shr:1 row_mask:0xf bank_mask:0xf
    v_cndmask_b32_dpp v85, v85, v85, vcc wave_shr:1 row_mask:0xf bank_mask:0xf
    s_lshr_b64 s[52:53], s[52:53], 1
    v_cndmask_b32_dpp v86, v86, v86, vcc wave_shr:1 row_mask:0xf bank_mask:0xf
    v_cndmask_b32_dpp v87, v87, v87, vcc wave_shr:1 row_mask:0xf bank_mask:0xf
    s_andn2_b64 s[82:83], s[82:83], s[52:53]
    v_cndmask_b32_dpp v7, v7, v7, vcc wave_shr:1 row_mask:0xf bank_mask:0xf
    s_mov_b64 vcc, s[50:51]
    s_mov_b64 exec, s[50:51]
    s_cbranch_scc0 L2_d105
    s_mov_b64 exec, s[82:83]
    s_nop 1
    v_mfma_f32_4x4x4_16b_bf16 v[88:91], v[12:13], v[84:85], 0
    s_nop 1
    v_mfma_f32_4x4x4_16b_bf16 v[88:91], v[10:11], v[86:87], v[88:91]
    s_nop 4
    v_cvt_pk_bf16_f32 v88, v88, v89
    v_cvt_pk_bf16_f32 v89, v90, v91
    ds_pk_add_bf16 v7, v88 offset:65408
    ds_pk_add_bf16 v7, v89 offset:65412
    s_mov_b64 exec, vcc
    s_branch L2_d105
L2_c106:
    s_mov_b64 s[50:51], vcc
    s_lshl_b64 s[52:53], s[82:83], 1
    s_andn2_b64 s[52:53], s[52:53], s[80:81]
    s_andn2_b64 s[52:53], s[52:53], s[50:51]
    s_or_b64 s[80:81], s[80:81], s[52:53]
    s_not_b64 vcc, s[52:53]
    s_mov_b64 exec, -1
    v_cndmask_b32_dpp v84, v84, v84, vcc wave_shr:1 row_mask:0xf bank_mask:0xf
    v_cndmask_b32_dpp v85, v85, v85, vcc wave_shr:1 row_mask:0xf bank_mask:0xf
    s_lshr_b64 s[52:53], s[52:53], 1
    v_cndmask_b32_dpp v86, v86, v86, vcc wave_shr:1 row_mask:0xf bank_mask:0xf
    v_cndmask_b32_dpp v87, v87, v87, vcc wave_shr:1 row_mask:0xf bank_mask:0xf
    s_andn2_b64 s[82:83], s[82:83], s[52:53]
    v_cndmask_b32_dpp v7, v7, v7, vcc wave_shr:1 row_mask:0xf bank_mask:0xf
    s_mov_b64 vcc, s[50:51]
    s_mov_b64 exec, s[50:51]
    s_cbranch_scc0 L2_d106
    s_mov_b64 exec, s[82:83]
    s_nop 1
    v_mfma_f32_4x4x4_16b_bf16 v[88:91], v[12:13], v[84:85], 0
    s_nop 1
    v_mfma_f32_4x4x4_16b_bf16 v[88:91], v[10:11], v[86:87], v[88:91]
    s_nop 4
    v_cvt_pk_bf16_f32 v88, v88, v89
    v_cvt_pk_bf16_f32 v89, v90, v91
    ds_pk_add_bf16 v7, v88 offset:65408
    ds_pk_add_bf16 v7, v89 offset:65412
    s_mov_b64 exec, vcc
    s_branch L2_d106
L2_c107:
    s_mov_b64 s[50:51], vcc
    s_lshl_b64 s[52:53], s[82:83], 1
    s_andn2_b64 s[52:53], s[52:53], s[80:81]
    s_andn2_b64 s[52:53], s[52:53], s[50:51]
    s_or_b64 s[80:81], s[80:81], s[52:53]
    s_not_b64 vcc, s[52:53]
    s_mov_b64 exec, -1
    v_cndmask_b32_dpp v84, v84, v84, vcc wave_shr:1 row_mask:0xf bank_mask:0xf
    v_cndmask_b32_dpp v85, v85, v85, vcc wave_shr:1 row_mask:0xf bank_mask:0xf
    s_lshr_b64 s[52:53], s[52:53], 1
    v_cndmask_b32_dpp v86, v86, v86, vcc wave_shr:1 row_mask:0xf bank_mask:0xf
    v_cndmask_b32_dpp v87, v87, v87, vcc wave_shr:1 row_mask:0xf bank_mask:0xf
    s_andn2_b64 s[82:83], s[82:83], s[52:53]
    v_cndmask_b32_dpp v7, v7, v7, vcc wave_shr:1 row_mask:0xf bank_mask:0xf
    s_mov_b64 vcc, s[50:51]
    s_mov_b64 exec, s[50:51]
    s_cbranch_scc0 L2_d107
    s_mov_b64 exec, s[82:83]
    s_nop 1
    v_mfma_f32_4x4x4_16b_bf16 v[88:91], v[12:13], v[84:85], 0
    s_nop 1
    v_mfma_f32_4x4x4_16b_bf16 v[88:91], v[10:11], v[86:87], v[88:91]
    s_nop 4
    v_cvt_pk_bf16_f32 v88, v88, v89
    v_cvt_pk_bf16_f32 v89, v90, v91
    ds_pk_add_bf16 v7, v88 offset:65408
    ds_pk_add_bf16 v7, v89 offset:65412
    s_mov_b64 exec, vcc
    s_branch L2_d107
L2_xa108:
    s_cmp_eq_u32 s43, 1
    s_cbranch_scc1 L2_xc108
    v_lshlrev_b32 v89, 0, v96
    v_add_u32 v90, 140, v97
    v_bitop3_b32 v90, v89, v45, v90 bitop3:0x6a
    ds_write_b32 v98, v90 offset:28
    v_lshlrev_b32 v89, 4, v96
    v_add_u32 v90, 120, v97
    v_bitop3_b32 v90, v89, v45, v90 bitop3:0x6a
    ds_write_b32 v98, v90 offset:24
    v_lshlrev_b32 v89, 8, v96
    v_add_u32 v90, 100, v97
    v_bitop3_b32 v90, v89, v45, v90 bitop3:0x6a
    ds_write_b32 v98, v90 offset:20
L2_xc108:
    v_lshlrev_b32 v89, 12, v96
    v_add_u32 v90, 80, v97
    v_bitop3_b32 v90, v89, v45, v90 bitop3:0x6a
    ds_write_b32 v98, v90 offset:16
    s_branch L2_xb108
L2_xe108:
    v_cmp_lt_u32 vcc, 32, v99
    v_cmp_lt_u32 s[58:59], 31, v88
    v_lshrrev_b32 v89, 16, v96
    v_add_u32 v97, 80, v97
    s_or_b64 vcc, vcc, s[58:59]
    s_cbranch_scc1 L2_xs108
    v_lshlrev_b32 v89, v1, v89
    v_and_b32 v89, v45, v89
    v_cmp_ne_u32 vcc, 0, v89
    v_xor_b32 v90, v97, v89
    s_add_u32 s3, s37, s38
    v_mbcnt_lo_u32_b32 v98, vcc_lo, 0
    v_mbcnt_hi_u32_b32 v98, vcc_hi, v98
    s_bcnt1_i32_b64 s41, vcc
    v_lshl_add_u32 v98, v98, 2, s3
    s_mov_b64 exec, vcc
    ds_write_b32 v98, v90
    s_mov_b64 exec, -1
    s_lshl2_add_u32 s37, s41, s37
    s_branch L2_xr108
L2_xf108:
    s_waitcnt lgkmcnt(0)
    s_cmp_gt_u32 s37, 1024
    s_cbranch_scc1 L2_xs108
    v_mov_b32 v43, -1
    s_cmp_ge_u32 s37, 512
    s_cbranch_scc1 L2_xg108
    v_mov_b32 v42, -1
    s_cmp_ge_u32 s37, 256
    s_cbranch_scc1 L2_xg108
    v_mov_b32 v41, -1
    s_branch L2_xg108
L2_xs108:
    s_waitcnt lgkmcnt(0)
    v_mov_b32 v40, -1
    v_mov_b32 v41, -1
    v_mov_b32 v42, -1
    v_mov_b32 v43, -1
    s_add_u32 s3, s42, 2
    s_bitset1_b32 s36, s3
    s_branch L2_xg108
L2_c109:
    s_mov_b64 s[50:51], vcc
    s_lshl_b64 s[52:53], s[82:83], 1
    s_andn2_b64 s[52:53], s[52:53], s[80:81]
    s_andn2_b64 s[52:53], s[52:53], s[50:51]
    s_or_b64 s[80:81], s[80:81], s[52:53]
    s_not_b64 vcc, s[52:53]
    s_mov_b64 exec, -1
    v_cndmask_b32_dpp v84, v84, v84, vcc wave_shr:1 row_mask:0xf bank_mask:0xf
    v_cndmask_b32_dpp v85, v85, v85, vcc wave_shr:1 row_mask:0xf bank_mask:0xf
    s_lshr_b64 s[52:53], s[52:53], 1
    v_cndmask_b32_dpp v86, v86, v86, vcc wave_shr:1 row_mask:0xf bank_mask:0xf
    v_cndmask_b32_dpp v87, v87, v87, vcc wave_shr:1 row_mask:0xf bank_mask:0xf
    s_andn2_b64 s[82:83], s[82:83], s[52:53]
    v_cndmask_b32_dpp v7, v7, v7, vcc wave_shr:1 row_mask:0xf bank_mask:0xf
    s_mov_b64 vcc, s[50:51]
    s_mov_b64 exec, s[50:51]
    s_cbranch_scc0 L2_d109
    s_mov_b64 exec, s[82:83]
    s_nop 1
    v_mfma_f32_4x4x4_16b_bf16 v[88:91], v[12:13], v[84:85], 0
    s_nop 1
    v_mfma_f32_4x4x4_16b_bf16 v[88:91], v[10:11], v[86:87], v[88:91]
    s_nop 4
    v_cvt_pk_bf16_f32 v88, v88, v89
    v_cvt_pk_bf16_f32 v89, v90, v91
    ds_pk_add_bf16 v7, v88 offset:65408
    ds_pk_add_bf16 v7, v89 offset:65412
    s_mov_b64 exec, vcc
    s_branch L2_d109
L2_c110:
    s_mov_b64 s[50:51], vcc
    s_lshl_b64 s[52:53], s[82:83], 1
    s_andn2_b64 s[52:53], s[52:53], s[80:81]
    s_andn2_b64 s[52:53], s[52:53], s[50:51]
    s_or_b64 s[80:81], s[80:81], s[52:53]
    s_not_b64 vcc, s[52:53]
    s_mov_b64 exec, -1
    v_cndmask_b32_dpp v84, v84, v84, vcc wave_shr:1 row_mask:0xf bank_mask:0xf
    v_cndmask_b32_dpp v85, v85, v85, vcc wave_shr:1 row_mask:0xf bank_mask:0xf
    s_lshr_b64 s[52:53], s[52:53], 1
    v_cndmask_b32_dpp v86, v86, v86, vcc wave_shr:1 row_mask:0xf bank_mask:0xf
    v_cndmask_b32_dpp v87, v87, v87, vcc wave_shr:1 row_mask:0xf bank_mask:0xf
    s_andn2_b64 s[82:83], s[82:83], s[52:53]
    v_cndmask_b32_dpp v7, v7, v7, vcc wave_shr:1 row_mask:0xf bank_mask:0xf
    s_mov_b64 vcc, s[50:51]
    s_mov_b64 exec, s[50:51]
    s_cbranch_scc0 L2_d110
    s_mov_b64 exec, s[82:83]
    s_nop 1
    v_mfma_f32_4x4x4_16b_bf16 v[88:91], v[12:13], v[84:85], 0
    s_nop 1
    v_mfma_f32_4x4x4_16b_bf16 v[88:91], v[10:11], v[86:87], v[88:91]
    s_nop 4
    v_cvt_pk_bf16_f32 v88, v88, v89
    v_cvt_pk_bf16_f32 v89, v90, v91
    ds_pk_add_bf16 v7, v88 offset:65408
    ds_pk_add_bf16 v7, v89 offset:65412
    s_mov_b64 exec, vcc
    s_branch L2_d110
L2_c111:
    s_mov_b64 s[50:51], vcc
    s_lshl_b64 s[52:53], s[82:83], 1
    s_andn2_b64 s[52:53], s[52:53], s[80:81]
    s_andn2_b64 s[52:53], s[52:53], s[50:51]
    s_or_b64 s[80:81], s[80:81], s[52:53]
    s_not_b64 vcc, s[52:53]
    s_mov_b64 exec, -1
    v_cndmask_b32_dpp v84, v84, v84, vcc wave_shr:1 row_mask:0xf bank_mask:0xf
    v_cndmask_b32_dpp v85, v85, v85, vcc wave_shr:1 row_mask:0xf bank_mask:0xf
    s_lshr_b64 s[52:53], s[52:53], 1
    v_cndmask_b32_dpp v86, v86, v86, vcc wave_shr:1 row_mask:0xf bank_mask:0xf
    v_cndmask_b32_dpp v87, v87, v87, vcc wave_shr:1 row_mask:0xf bank_mask:0xf
    s_andn2_b64 s[82:83], s[82:83], s[52:53]
    v_cndmask_b32_dpp v7, v7, v7, vcc wave_shr:1 row_mask:0xf bank_mask:0xf
    s_mov_b64 vcc, s[50:51]
    s_mov_b64 exec, s[50:51]
    s_cbranch_scc0 L2_d111
    s_mov_b64 exec, s[82:83]
    s_nop 1
    v_mfma_f32_4x4x4_16b_bf16 v[88:91], v[12:13], v[84:85], 0
    s_nop 1
    v_mfma_f32_4x4x4_16b_bf16 v[88:91], v[10:11], v[86:87], v[88:91]
    s_nop 4
    v_cvt_pk_bf16_f32 v88, v88, v89
    v_cvt_pk_bf16_f32 v89, v90, v91
    ds_pk_add_bf16 v7, v88 offset:65408
    ds_pk_add_bf16 v7, v89 offset:65412
    s_mov_b64 exec, vcc
    s_branch L2_d111
L2_c112:
    s_mov_b64 s[50:51], vcc
    s_lshl_b64 s[52:53], s[82:83], 1
    s_andn2_b64 s[52:53], s[52:53], s[80:81]
    s_andn2_b64 s[52:53], s[52:53], s[50:51]
    s_or_b64 s[80:81], s[80:81], s[52:53]
    s_not_b64 vcc, s[52:53]
    s_mov_b64 exec, -1
    v_cndmask_b32_dpp v84, v84, v84, vcc wave_shr:1 row_mask:0xf bank_mask:0xf
    v_cndmask_b32_dpp v85, v85, v85, vcc wave_shr:1 row_mask:0xf bank_mask:0xf
    s_lshr_b64 s[52:53], s[52:53], 1
    v_cndmask_b32_dpp v86, v86, v86, vcc wave_shr:1 row_mask:0xf bank_mask:0xf
    v_cndmask_b32_dpp v87, v87, v87, vcc wave_shr:1 row_mask:0xf bank_mask:0xf
    s_andn2_b64 s[82:83], s[82:83], s[52:53]
    v_cndmask_b32_dpp v7, v7, v7, vcc wave_shr:1 row_mask:0xf bank_mask:0xf
    s_mov_b64 vcc, s[50:51]
    s_mov_b64 exec, s[50:51]
    s_cbranch_scc0 L2_d112
    s_mov_b64 exec, s[82:83]
    s_nop 1
    v_mfma_f32_4x4x4_16b_bf16 v[88:91], v[12:13], v[84:85], 0
    s_nop 1
    v_mfma_f32_4x4x4_16b_bf16 v[88:91], v[10:11], v[86:87], v[88:91]
    s_nop 4
    v_cvt_pk_bf16_f32 v88, v88, v89
    v_cvt_pk_bf16_f32 v89, v90, v91
    ds_pk_add_bf16 v7, v88 offset:65408
    ds_pk_add_bf16 v7, v89 offset:65412
    s_mov_b64 exec, vcc
    s_branch L2_d112
L2_c113:
    s_mov_b64 s[50:51], vcc
    s_lshl_b64 s[52:53], s[82:83], 1
    s_andn2_b64 s[52:53], s[52:53], s[80:81]
    s_andn2_b64 s[52:53], s[52:53], s[50:51]
    s_or_b64 s[80:81], s[80:81], s[52:53]
    s_not_b64 vcc, s[52:53]
    s_mov_b64 exec, -1
    v_cndmask_b32_dpp v84, v84, v84, vcc wave_shr:1 row_mask:0xf bank_mask:0xf
    v_cndmask_b32_dpp v85, v85, v85, vcc wave_shr:1 row_mask:0xf bank_mask:0xf
    s_lshr_b64 s[52:53], s[52:53], 1
    v_cndmask_b32_dpp v86, v86, v86, vcc wave_shr:1 row_mask:0xf bank_mask:0xf
    v_cndmask_b32_dpp v87, v87, v87, vcc wave_shr:1 row_mask:0xf bank_mask:0xf
    s_andn2_b64 s[82:83], s[82:83], s[52:53]
    v_cndmask_b32_dpp v7, v7, v7, vcc wave_shr:1 row_mask:0xf bank_mask:0xf
    s_mov_b64 vcc, s[50:51]
    s_mov_b64 exec, s[50:51]
    s_cbranch_scc0 L2_d113
    s_mov_b64 exec, s[82:83]
    s_nop 1
    v_mfma_f32_4x4x4_16b_bf16 v[88:91], v[12:13], v[84:85], 0
    s_nop 1
    v_mfma_f32_4x4x4_16b_bf16 v[88:91], v[10:11], v[86:87], v[88:91]
    s_nop 4
    v_cvt_pk_bf16_f32 v88, v88, v89
    v_cvt_pk_bf16_f32 v89, v90, v91
    ds_pk_add_bf16 v7, v88 offset:65408
    ds_pk_add_bf16 v7, v89 offset:65412
    s_mov_b64 exec, vcc
    s_branch L2_d113
L2_c114:
    s_mov_b64 s[50:51], vcc
    s_lshl_b64 s[52:53], s[82:83], 1
    s_andn2_b64 s[52:53], s[52:53], s[80:81]
    s_andn2_b64 s[52:53], s[52:53], s[50:51]
    s_or_b64 s[80:81], s[80:81], s[52:53]
    s_not_b64 vcc, s[52:53]
    s_mov_b64 exec, -1
    v_cndmask_b32_dpp v84, v84, v84, vcc wave_shr:1 row_mask:0xf bank_mask:0xf
    v_cndmask_b32_dpp v85, v85, v85, vcc wave_shr:1 row_mask:0xf bank_mask:0xf
    s_lshr_b64 s[52:53], s[52:53], 1
    v_cndmask_b32_dpp v86, v86, v86, vcc wave_shr:1 row_mask:0xf bank_mask:0xf
    v_cndmask_b32_dpp v87, v87, v87, vcc wave_shr:1 row_mask:0xf bank_mask:0xf
    s_andn2_b64 s[82:83], s[82:83], s[52:53]
    v_cndmask_b32_dpp v7, v7, v7, vcc wave_shr:1 row_mask:0xf bank_mask:0xf
    s_mov_b64 vcc, s[50:51]
    s_mov_b64 exec, s[50:51]
    s_cbranch_scc0 L2_d114
    s_mov_b64 exec, s[82:83]
    s_nop 1
    v_mfma_f32_4x4x4_16b_bf16 v[88:91], v[12:13], v[84:85], 0
    s_nop 1
    v_mfma_f32_4x4x4_16b_bf16 v[88:91], v[10:11], v[86:87], v[88:91]
    s_nop 4
    v_cvt_pk_bf16_f32 v88, v88, v89
    v_cvt_pk_bf16_f32 v89, v90, v91
    ds_pk_add_bf16 v7, v88 offset:65408
    ds_pk_add_bf16 v7, v89 offset:65412
    s_mov_b64 exec, vcc
    s_branch L2_d114
L2_c115:
    s_mov_b64 s[50:51], vcc
    s_lshl_b64 s[52:53], s[82:83], 1
    s_andn2_b64 s[52:53], s[52:53], s[80:81]
    s_andn2_b64 s[52:53], s[52:53], s[50:51]
    s_or_b64 s[80:81], s[80:81], s[52:53]
    s_not_b64 vcc, s[52:53]
    s_mov_b64 exec, -1
    v_cndmask_b32_dpp v84, v84, v84, vcc wave_shr:1 row_mask:0xf bank_mask:0xf
    v_cndmask_b32_dpp v85, v85, v85, vcc wave_shr:1 row_mask:0xf bank_mask:0xf
    s_lshr_b64 s[52:53], s[52:53], 1
    v_cndmask_b32_dpp v86, v86, v86, vcc wave_shr:1 row_mask:0xf bank_mask:0xf
    v_cndmask_b32_dpp v87, v87, v87, vcc wave_shr:1 row_mask:0xf bank_mask:0xf
    s_andn2_b64 s[82:83], s[82:83], s[52:53]
    v_cndmask_b32_dpp v7, v7, v7, vcc wave_shr:1 row_mask:0xf bank_mask:0xf
    s_mov_b64 vcc, s[50:51]
    s_mov_b64 exec, s[50:51]
    s_cbranch_scc0 L2_d115
    s_mov_b64 exec, s[82:83]
    s_nop 1
    v_mfma_f32_4x4x4_16b_bf16 v[88:91], v[12:13], v[84:85], 0
    s_nop 1
    v_mfma_f32_4x4x4_16b_bf16 v[88:91], v[10:11], v[86:87], v[88:91]
    s_nop 4
    v_cvt_pk_bf16_f32 v88, v88, v89
    v_cvt_pk_bf16_f32 v89, v90, v91
    ds_pk_add_bf16 v7, v88 offset:65408
    ds_pk_add_bf16 v7, v89 offset:65412
    s_mov_b64 exec, vcc
    s_branch L2_d115
L2_c116:
    s_mov_b64 s[50:51], vcc
    s_lshl_b64 s[52:53], s[82:83], 1
    s_andn2_b64 s[52:53], s[52:53], s[80:81]
    s_andn2_b64 s[52:53], s[52:53], s[50:51]
    s_or_b64 s[80:81], s[80:81], s[52:53]
    s_not_b64 vcc, s[52:53]
    s_mov_b64 exec, -1
    v_cndmask_b32_dpp v84, v84, v84, vcc wave_shr:1 row_mask:0xf bank_mask:0xf
    v_cndmask_b32_dpp v85, v85, v85, vcc wave_shr:1 row_mask:0xf bank_mask:0xf
    s_lshr_b64 s[52:53], s[52:53], 1
    v_cndmask_b32_dpp v86, v86, v86, vcc wave_shr:1 row_mask:0xf bank_mask:0xf
    v_cndmask_b32_dpp v87, v87, v87, vcc wave_shr:1 row_mask:0xf bank_mask:0xf
    s_andn2_b64 s[82:83], s[82:83], s[52:53]
    v_cndmask_b32_dpp v7, v7, v7, vcc wave_shr:1 row_mask:0xf bank_mask:0xf
    s_mov_b64 vcc, s[50:51]
    s_mov_b64 exec, s[50:51]
    s_cbranch_scc0 L2_d116
    s_mov_b64 exec, s[82:83]
    s_nop 1
    v_mfma_f32_4x4x4_16b_bf16 v[88:91], v[12:13], v[84:85], 0
    s_nop 1
    v_mfma_f32_4x4x4_16b_bf16 v[88:91], v[10:11], v[86:87], v[88:91]
    s_nop 4
    v_cvt_pk_bf16_f32 v88, v88, v89
    v_cvt_pk_bf16_f32 v89, v90, v91
    ds_pk_add_bf16 v7, v88 offset:65408
    ds_pk_add_bf16 v7, v89 offset:65412
    s_mov_b64 exec, vcc
    s_branch L2_d116
L2_c117:
    s_mov_b64 s[50:51], vcc
    s_lshl_b64 s[52:53], s[82:83], 1
    s_andn2_b64 s[52:53], s[52:53], s[80:81]
    s_andn2_b64 s[52:53], s[52:53], s[50:51]
    s_or_b64 s[80:81], s[80:81], s[52:53]
    s_not_b64 vcc, s[52:53]
    s_mov_b64 exec, -1
    v_cndmask_b32_dpp v84, v84, v84, vcc wave_shr:1 row_mask:0xf bank_mask:0xf
    v_cndmask_b32_dpp v85, v85, v85, vcc wave_shr:1 row_mask:0xf bank_mask:0xf
    s_lshr_b64 s[52:53], s[52:53], 1
    v_cndmask_b32_dpp v86, v86, v86, vcc wave_shr:1 row_mask:0xf bank_mask:0xf
    v_cndmask_b32_dpp v87, v87, v87, vcc wave_shr:1 row_mask:0xf bank_mask:0xf
    s_andn2_b64 s[82:83], s[82:83], s[52:53]
    v_cndmask_b32_dpp v7, v7, v7, vcc wave_shr:1 row_mask:0xf bank_mask:0xf
    s_mov_b64 vcc, s[50:51]
    s_mov_b64 exec, s[50:51]
    s_cbranch_scc0 L2_d117
    s_mov_b64 exec, s[82:83]
    s_nop 1
    v_mfma_f32_4x4x4_16b_bf16 v[88:91], v[12:13], v[84:85], 0
    s_nop 1
    v_mfma_f32_4x4x4_16b_bf16 v[88:91], v[10:11], v[86:87], v[88:91]
    s_nop 4
    v_cvt_pk_bf16_f32 v88, v88, v89
    v_cvt_pk_bf16_f32 v89, v90, v91
    ds_pk_add_bf16 v7, v88 offset:65408
    ds_pk_add_bf16 v7, v89 offset:65412
    s_mov_b64 exec, vcc
    s_branch L2_d117
L2_c118:
    s_mov_b64 s[50:51], vcc
    s_lshl_b64 s[52:53], s[82:83], 1
    s_andn2_b64 s[52:53], s[52:53], s[80:81]
    s_andn2_b64 s[52:53], s[52:53], s[50:51]
    s_or_b64 s[80:81], s[80:81], s[52:53]
    s_not_b64 vcc, s[52:53]
    s_mov_b64 exec, -1
    v_cndmask_b32_dpp v84, v84, v84, vcc wave_shr:1 row_mask:0xf bank_mask:0xf
    v_cndmask_b32_dpp v85, v85, v85, vcc wave_shr:1 row_mask:0xf bank_mask:0xf
    s_lshr_b64 s[52:53], s[52:53], 1
    v_cndmask_b32_dpp v86, v86, v86, vcc wave_shr:1 row_mask:0xf bank_mask:0xf
    v_cndmask_b32_dpp v87, v87, v87, vcc wave_shr:1 row_mask:0xf bank_mask:0xf
    s_andn2_b64 s[82:83], s[82:83], s[52:53]
    v_cndmask_b32_dpp v7, v7, v7, vcc wave_shr:1 row_mask:0xf bank_mask:0xf
    s_mov_b64 vcc, s[50:51]
    s_mov_b64 exec, s[50:51]
    s_cbranch_scc0 L2_d118
    s_mov_b64 exec, s[82:83]
    s_nop 1
    v_mfma_f32_4x4x4_16b_bf16 v[88:91], v[12:13], v[84:85], 0
    s_nop 1
    v_mfma_f32_4x4x4_16b_bf16 v[88:91], v[10:11], v[86:87], v[88:91]
    s_nop 4
    v_cvt_pk_bf16_f32 v88, v88, v89
    v_cvt_pk_bf16_f32 v89, v90, v91
    ds_pk_add_bf16 v7, v88 offset:65408
    ds_pk_add_bf16 v7, v89 offset:65412
    s_mov_b64 exec, vcc
    s_branch L2_d118
L2_c119:
    s_mov_b64 s[50:51], vcc
    s_lshl_b64 s[52:53], s[82:83], 1
    s_andn2_b64 s[52:53], s[52:53], s[80:81]
    s_andn2_b64 s[52:53], s[52:53], s[50:51]
    s_or_b64 s[80:81], s[80:81], s[52:53]
    s_not_b64 vcc, s[52:53]
    s_mov_b64 exec, -1
    v_cndmask_b32_dpp v84, v84, v84, vcc wave_shr:1 row_mask:0xf bank_mask:0xf
    v_cndmask_b32_dpp v85, v85, v85, vcc wave_shr:1 row_mask:0xf bank_mask:0xf
    s_lshr_b64 s[52:53], s[52:53], 1
    v_cndmask_b32_dpp v86, v86, v86, vcc wave_shr:1 row_mask:0xf bank_mask:0xf
    v_cndmask_b32_dpp v87, v87, v87, vcc wave_shr:1 row_mask:0xf bank_mask:0xf
    s_andn2_b64 s[82:83], s[82:83], s[52:53]
    v_cndmask_b32_dpp v7, v7, v7, vcc wave_shr:1 row_mask:0xf bank_mask:0xf
    s_mov_b64 vcc, s[50:51]
    s_mov_b64 exec, s[50:51]
    s_cbranch_scc0 L2_d119
    s_mov_b64 exec, s[82:83]
    s_nop 1
    v_mfma_f32_4x4x4_16b_bf16 v[88:91], v[12:13], v[84:85], 0
    s_nop 1
    v_mfma_f32_4x4x4_16b_bf16 v[88:91], v[10:11], v[86:87], v[88:91]
    s_nop 4
    v_cvt_pk_bf16_f32 v88, v88, v89
    v_cvt_pk_bf16_f32 v89, v90, v91
    ds_pk_add_bf16 v7, v88 offset:65408
    ds_pk_add_bf16 v7, v89 offset:65412
    s_mov_b64 exec, vcc
    s_branch L2_d119
L2_c120:
    s_mov_b64 s[50:51], vcc
    s_lshl_b64 s[52:53], s[82:83], 1
    s_andn2_b64 s[52:53], s[52:53], s[80:81]
    s_andn2_b64 s[52:53], s[52:53], s[50:51]
    s_or_b64 s[80:81], s[80:81], s[52:53]
    s_not_b64 vcc, s[52:53]
    s_mov_b64 exec, -1
    v_cndmask_b32_dpp v84, v84, v84, vcc wave_shr:1 row_mask:0xf bank_mask:0xf
    v_cndmask_b32_dpp v85, v85, v85, vcc wave_shr:1 row_mask:0xf bank_mask:0xf
    s_lshr_b64 s[52:53], s[52:53], 1
    v_cndmask_b32_dpp v86, v86, v86, vcc wave_shr:1 row_mask:0xf bank_mask:0xf
    v_cndmask_b32_dpp v87, v87, v87, vcc wave_shr:1 row_mask:0xf bank_mask:0xf
    s_andn2_b64 s[82:83], s[82:83], s[52:53]
    v_cndmask_b32_dpp v7, v7, v7, vcc wave_shr:1 row_mask:0xf bank_mask:0xf
    s_mov_b64 vcc, s[50:51]
    s_mov_b64 exec, s[50:51]
    s_cbranch_scc0 L2_d120
    s_mov_b64 exec, s[82:83]
    s_nop 1
    v_mfma_f32_4x4x4_16b_bf16 v[88:91], v[12:13], v[84:85], 0
    s_nop 1
    v_mfma_f32_4x4x4_16b_bf16 v[88:91], v[10:11], v[86:87], v[88:91]
    s_nop 4
    v_cvt_pk_bf16_f32 v88, v88, v89
    v_cvt_pk_bf16_f32 v89, v90, v91
    ds_pk_add_bf16 v7, v88 offset:65408
    ds_pk_add_bf16 v7, v89 offset:65412
    s_mov_b64 exec, vcc
    s_branch L2_d120
L2_c121:
    s_mov_b64 s[50:51], vcc
    s_lshl_b64 s[52:53], s[82:83], 1
    s_andn2_b64 s[52:53], s[52:53], s[80:81]
    s_andn2_b64 s[52:53], s[52:53], s[50:51]
    s_or_b64 s[80:81], s[80:81], s[52:53]
    s_not_b64 vcc, s[52:53]
    s_mov_b64 exec, -1
    v_cndmask_b32_dpp v84, v84, v84, vcc wave_shr:1 row_mask:0xf bank_mask:0xf
    v_cndmask_b32_dpp v85, v85, v85, vcc wave_shr:1 row_mask:0xf bank_mask:0xf
    s_lshr_b64 s[52:53], s[52:53], 1
    v_cndmask_b32_dpp v86, v86, v86, vcc wave_shr:1 row_mask:0xf bank_mask:0xf
    v_cndmask_b32_dpp v87, v87, v87, vcc wave_shr:1 row_mask:0xf bank_mask:0xf
    s_andn2_b64 s[82:83], s[82:83], s[52:53]
    v_cndmask_b32_dpp v7, v7, v7, vcc wave_shr:1 row_mask:0xf bank_mask:0xf
    s_mov_b64 vcc, s[50:51]
    s_mov_b64 exec, s[50:51]
    s_cbranch_scc0 L2_d121
    s_mov_b64 exec, s[82:83]
    s_nop 1
    v_mfma_f32_4x4x4_16b_bf16 v[88:91], v[12:13], v[84:85], 0
    s_nop 1
    v_mfma_f32_4x4x4_16b_bf16 v[88:91], v[10:11], v[86:87], v[88:91]
    s_nop 4
    v_cvt_pk_bf16_f32 v88, v88, v89
    v_cvt_pk_bf16_f32 v89, v90, v91
    ds_pk_add_bf16 v7, v88 offset:65408
    ds_pk_add_bf16 v7, v89 offset:65412
    s_mov_b64 exec, vcc
    s_branch L2_d121
L2_c122:
    s_mov_b64 s[50:51], vcc
    s_lshl_b64 s[52:53], s[82:83], 1
    s_andn2_b64 s[52:53], s[52:53], s[80:81]
    s_andn2_b64 s[52:53], s[52:53], s[50:51]
    s_or_b64 s[80:81], s[80:81], s[52:53]
    s_not_b64 vcc, s[52:53]
    s_mov_b64 exec, -1
    v_cndmask_b32_dpp v84, v84, v84, vcc wave_shr:1 row_mask:0xf bank_mask:0xf
    v_cndmask_b32_dpp v85, v85, v85, vcc wave_shr:1 row_mask:0xf bank_mask:0xf
    s_lshr_b64 s[52:53], s[52:53], 1
    v_cndmask_b32_dpp v86, v86, v86, vcc wave_shr:1 row_mask:0xf bank_mask:0xf
    v_cndmask_b32_dpp v87, v87, v87, vcc wave_shr:1 row_mask:0xf bank_mask:0xf
    s_andn2_b64 s[82:83], s[82:83], s[52:53]
    v_cndmask_b32_dpp v7, v7, v7, vcc wave_shr:1 row_mask:0xf bank_mask:0xf
    s_mov_b64 vcc, s[50:51]
    s_mov_b64 exec, s[50:51]
    s_cbranch_scc0 L2_d122
    s_mov_b64 exec, s[82:83]
    s_nop 1
    v_mfma_f32_4x4x4_16b_bf16 v[88:91], v[12:13], v[84:85], 0
    s_nop 1
    v_mfma_f32_4x4x4_16b_bf16 v[88:91], v[10:11], v[86:87], v[88:91]
    s_nop 4
    v_cvt_pk_bf16_f32 v88, v88, v89
    v_cvt_pk_bf16_f32 v89, v90, v91
    ds_pk_add_bf16 v7, v88 offset:65408
    ds_pk_add_bf16 v7, v89 offset:65412
    s_mov_b64 exec, vcc
    s_branch L2_d122
L2_c123:
    s_mov_b64 s[50:51], vcc
    s_lshl_b64 s[52:53], s[82:83], 1
    s_andn2_b64 s[52:53], s[52:53], s[80:81]
    s_andn2_b64 s[52:53], s[52:53], s[50:51]
    s_or_b64 s[80:81], s[80:81], s[52:53]
    s_not_b64 vcc, s[52:53]
    s_mov_b64 exec, -1
    v_cndmask_b32_dpp v84, v84, v84, vcc wave_shr:1 row_mask:0xf bank_mask:0xf
    v_cndmask_b32_dpp v85, v85, v85, vcc wave_shr:1 row_mask:0xf bank_mask:0xf
    s_lshr_b64 s[52:53], s[52:53], 1
    v_cndmask_b32_dpp v86, v86, v86, vcc wave_shr:1 row_mask:0xf bank_mask:0xf
    v_cndmask_b32_dpp v87, v87, v87, vcc wave_shr:1 row_mask:0xf bank_mask:0xf
    s_andn2_b64 s[82:83], s[82:83], s[52:53]
    v_cndmask_b32_dpp v7, v7, v7, vcc wave_shr:1 row_mask:0xf bank_mask:0xf
    s_mov_b64 vcc, s[50:51]
    s_mov_b64 exec, s[50:51]
    s_cbranch_scc0 L2_d123
    s_mov_b64 exec, s[82:83]
    s_nop 1
    v_mfma_f32_4x4x4_16b_bf16 v[88:91], v[12:13], v[84:85], 0
    s_nop 1
    v_mfma_f32_4x4x4_16b_bf16 v[88:91], v[10:11], v[86:87], v[88:91]
    s_nop 4
    v_cvt_pk_bf16_f32 v88, v88, v89
    v_cvt_pk_bf16_f32 v89, v90, v91
    ds_pk_add_bf16 v7, v88 offset:65408
    ds_pk_add_bf16 v7, v89 offset:65412
    s_mov_b64 exec, vcc
    s_branch L2_d123
L2_c124:
    s_mov_b64 s[50:51], vcc
    s_lshl_b64 s[52:53], s[82:83], 1
    s_andn2_b64 s[52:53], s[52:53], s[80:81]
    s_andn2_b64 s[52:53], s[52:53], s[50:51]
    s_or_b64 s[80:81], s[80:81], s[52:53]
    s_not_b64 vcc, s[52:53]
    s_mov_b64 exec, -1
    v_cndmask_b32_dpp v84, v84, v84, vcc wave_shr:1 row_mask:0xf bank_mask:0xf
    v_cndmask_b32_dpp v85, v85, v85, vcc wave_shr:1 row_mask:0xf bank_mask:0xf
    s_lshr_b64 s[52:53], s[52:53], 1
    v_cndmask_b32_dpp v86, v86, v86, vcc wave_shr:1 row_mask:0xf bank_mask:0xf
    v_cndmask_b32_dpp v87, v87, v87, vcc wave_shr:1 row_mask:0xf bank_mask:0xf
    s_andn2_b64 s[82:83], s[82:83], s[52:53]
    v_cndmask_b32_dpp v7, v7, v7, vcc wave_shr:1 row_mask:0xf bank_mask:0xf
    s_mov_b64 vcc, s[50:51]
    s_mov_b64 exec, s[50:51]
    s_cbranch_scc0 L2_d124
    s_mov_b64 exec, s[82:83]
    s_nop 1
    v_mfma_f32_4x4x4_16b_bf16 v[88:91], v[12:13], v[84:85], 0
    s_nop 1
    v_mfma_f32_4x4x4_16b_bf16 v[88:91], v[10:11], v[86:87], v[88:91]
    s_nop 4
    v_cvt_pk_bf16_f32 v88, v88, v89
    v_cvt_pk_bf16_f32 v89, v90, v91
    ds_pk_add_bf16 v7, v88 offset:65408
    ds_pk_add_bf16 v7, v89 offset:65412
    s_mov_b64 exec, vcc
    s_branch L2_d124
L2_c125:
    s_mov_b64 s[50:51], vcc
    s_lshl_b64 s[52:53], s[82:83], 1
    s_andn2_b64 s[52:53], s[52:53], s[80:81]
    s_andn2_b64 s[52:53], s[52:53], s[50:51]
    s_or_b64 s[80:81], s[80:81], s[52:53]
    s_not_b64 vcc, s[52:53]
    s_mov_b64 exec, -1
    v_cndmask_b32_dpp v84, v84, v84, vcc wave_shr:1 row_mask:0xf bank_mask:0xf
    v_cndmask_b32_dpp v85, v85, v85, vcc wave_shr:1 row_mask:0xf bank_mask:0xf
    s_lshr_b64 s[52:53], s[52:53], 1
    v_cndmask_b32_dpp v86, v86, v86, vcc wave_shr:1 row_mask:0xf bank_mask:0xf
    v_cndmask_b32_dpp v87, v87, v87, vcc wave_shr:1 row_mask:0xf bank_mask:0xf
    s_andn2_b64 s[82:83], s[82:83], s[52:53]
    v_cndmask_b32_dpp v7, v7, v7, vcc wave_shr:1 row_mask:0xf bank_mask:0xf
    s_mov_b64 vcc, s[50:51]
    s_mov_b64 exec, s[50:51]
    s_cbranch_scc0 L2_d125
    s_mov_b64 exec, s[82:83]
    s_nop 1
    v_mfma_f32_4x4x4_16b_bf16 v[88:91], v[12:13], v[84:85], 0
    s_nop 1
    v_mfma_f32_4x4x4_16b_bf16 v[88:91], v[10:11], v[86:87], v[88:91]
    s_nop 4
    v_cvt_pk_bf16_f32 v88, v88, v89
    v_cvt_pk_bf16_f32 v89, v90, v91
    ds_pk_add_bf16 v7, v88 offset:65408
    ds_pk_add_bf16 v7, v89 offset:65412
    s_mov_b64 exec, vcc
    s_branch L2_d125
L2_c126:
    s_mov_b64 s[50:51], vcc
    s_lshl_b64 s[52:53], s[82:83], 1
    s_andn2_b64 s[52:53], s[52:53], s[80:81]
    s_andn2_b64 s[52:53], s[52:53], s[50:51]
    s_or_b64 s[80:81], s[80:81], s[52:53]
    s_not_b64 vcc, s[52:53]
    s_mov_b64 exec, -1
    v_cndmask_b32_dpp v84, v84, v84, vcc wave_shr:1 row_mask:0xf bank_mask:0xf
    v_cndmask_b32_dpp v85, v85, v85, vcc wave_shr:1 row_mask:0xf bank_mask:0xf
    s_lshr_b64 s[52:53], s[52:53], 1
    v_cndmask_b32_dpp v86, v86, v86, vcc wave_shr:1 row_mask:0xf bank_mask:0xf
    v_cndmask_b32_dpp v87, v87, v87, vcc wave_shr:1 row_mask:0xf bank_mask:0xf
    s_andn2_b64 s[82:83], s[82:83], s[52:53]
    v_cndmask_b32_dpp v7, v7, v7, vcc wave_shr:1 row_mask:0xf bank_mask:0xf
    s_mov_b64 vcc, s[50:51]
    s_mov_b64 exec, s[50:51]
    s_cbranch_scc0 L2_d126
    s_mov_b64 exec, s[82:83]
    s_nop 1
    v_mfma_f32_4x4x4_16b_bf16 v[88:91], v[12:13], v[84:85], 0
    s_nop 1
    v_mfma_f32_4x4x4_16b_bf16 v[88:91], v[10:11], v[86:87], v[88:91]
    s_nop 4
    v_cvt_pk_bf16_f32 v88, v88, v89
    v_cvt_pk_bf16_f32 v89, v90, v91
    ds_pk_add_bf16 v7, v88 offset:65408
    ds_pk_add_bf16 v7, v89 offset:65412
    s_mov_b64 exec, vcc
    s_branch L2_d126
L2_c127:
    s_mov_b64 s[50:51], vcc
    s_lshl_b64 s[52:53], s[82:83], 1
    s_andn2_b64 s[52:53], s[52:53], s[80:81]
    s_andn2_b64 s[52:53], s[52:53], s[50:51]
    s_or_b64 s[80:81], s[80:81], s[52:53]
    s_not_b64 vcc, s[52:53]
    s_mov_b64 exec, -1
    v_cndmask_b32_dpp v84, v84, v84, vcc wave_shr:1 row_mask:0xf bank_mask:0xf
    v_cndmask_b32_dpp v85, v85, v85, vcc wave_shr:1 row_mask:0xf bank_mask:0xf
    s_lshr_b64 s[52:53], s[52:53], 1
    v_cndmask_b32_dpp v86, v86, v86, vcc wave_shr:1 row_mask:0xf bank_mask:0xf
    v_cndmask_b32_dpp v87, v87, v87, vcc wave_shr:1 row_mask:0xf bank_mask:0xf
    s_andn2_b64 s[82:83], s[82:83], s[52:53]
    v_cndmask_b32_dpp v7, v7, v7, vcc wave_shr:1 row_mask:0xf bank_mask:0xf
    s_mov_b64 vcc, s[50:51]
    s_mov_b64 exec, s[50:51]
    s_cbranch_scc0 L2_d127
    s_mov_b64 exec, s[82:83]
    s_nop 1
    v_mfma_f32_4x4x4_16b_bf16 v[88:91], v[12:13], v[84:85], 0
    s_nop 1
    v_mfma_f32_4x4x4_16b_bf16 v[88:91], v[10:11], v[86:87], v[88:91]
    s_nop 4
    v_cvt_pk_bf16_f32 v88, v88, v89
    v_cvt_pk_bf16_f32 v89, v90, v91
    ds_pk_add_bf16 v7, v88 offset:65408
    ds_pk_add_bf16 v7, v89 offset:65412
    s_mov_b64 exec, vcc
    s_branch L2_d127
L2_c128:
    s_mov_b64 s[50:51], vcc
    s_lshl_b64 s[52:53], s[82:83], 1
    s_andn2_b64 s[52:53], s[52:53], s[80:81]
    s_andn2_b64 s[52:53], s[52:53], s[50:51]
    s_or_b64 s[80:81], s[80:81], s[52:53]
    s_not_b64 vcc, s[52:53]
    s_mov_b64 exec, -1
    v_cndmask_b32_dpp v84, v84, v84, vcc wave_shr:1 row_mask:0xf bank_mask:0xf
    v_cndmask_b32_dpp v85, v85, v85, vcc wave_shr:1 row_mask:0xf bank_mask:0xf
    s_lshr_b64 s[52:53], s[52:53], 1
    v_cndmask_b32_dpp v86, v86, v86, vcc wave_shr:1 row_mask:0xf bank_mask:0xf
    v_cndmask_b32_dpp v87, v87, v87, vcc wave_shr:1 row_mask:0xf bank_mask:0xf
    s_andn2_b64 s[82:83], s[82:83], s[52:53]
    v_cndmask_b32_dpp v7, v7, v7, vcc wave_shr:1 row_mask:0xf bank_mask:0xf
    s_mov_b64 vcc, s[50:51]
    s_mov_b64 exec, s[50:51]
    s_cbranch_scc0 L2_d128
    s_mov_b64 exec, s[82:83]
    s_nop 1
    v_mfma_f32_4x4x4_16b_bf16 v[88:91], v[12:13], v[84:85], 0
    s_nop 1
    v_mfma_f32_4x4x4_16b_bf16 v[88:91], v[10:11], v[86:87], v[88:91]
    s_nop 4
    v_cvt_pk_bf16_f32 v88, v88, v89
    v_cvt_pk_bf16_f32 v89, v90, v91
    ds_pk_add_bf16 v7, v88 offset:65408
    ds_pk_add_bf16 v7, v89 offset:65412
    s_mov_b64 exec, vcc
    s_branch L2_d128
L2_c129:
    s_mov_b64 s[50:51], vcc
    s_lshl_b64 s[52:53], s[82:83], 1
    s_andn2_b64 s[52:53], s[52:53], s[80:81]
    s_andn2_b64 s[52:53], s[52:53], s[50:51]
    s_or_b64 s[80:81], s[80:81], s[52:53]
    s_not_b64 vcc, s[52:53]
    s_mov_b64 exec, -1
    v_cndmask_b32_dpp v84, v84, v84, vcc wave_shr:1 row_mask:0xf bank_mask:0xf
    v_cndmask_b32_dpp v85, v85, v85, vcc wave_shr:1 row_mask:0xf bank_mask:0xf
    s_lshr_b64 s[52:53], s[52:53], 1
    v_cndmask_b32_dpp v86, v86, v86, vcc wave_shr:1 row_mask:0xf bank_mask:0xf
    v_cndmask_b32_dpp v87, v87, v87, vcc wave_shr:1 row_mask:0xf bank_mask:0xf
    s_andn2_b64 s[82:83], s[82:83], s[52:53]
    v_cndmask_b32_dpp v7, v7, v7, vcc wave_shr:1 row_mask:0xf bank_mask:0xf
    s_mov_b64 vcc, s[50:51]
    s_mov_b64 exec, s[50:51]
    s_cbranch_scc0 L2_d129
    s_mov_b64 exec, s[82:83]
    s_nop 1
    v_mfma_f32_4x4x4_16b_bf16 v[88:91], v[12:13], v[84:85], 0
    s_nop 1
    v_mfma_f32_4x4x4_16b_bf16 v[88:91], v[10:11], v[86:87], v[88:91]
    s_nop 4
    v_cvt_pk_bf16_f32 v88, v88, v89
    v_cvt_pk_bf16_f32 v89, v90, v91
    ds_pk_add_bf16 v7, v88 offset:65408
    ds_pk_add_bf16 v7, v89 offset:65412
    s_mov_b64 exec, vcc
    s_branch L2_d129
L2_c130:
    s_mov_b64 s[50:51], vcc
    s_lshl_b64 s[52:53], s[82:83], 1
    s_andn2_b64 s[52:53], s[52:53], s[80:81]
    s_andn2_b64 s[52:53], s[52:53], s[50:51]
    s_or_b64 s[80:81], s[80:81], s[52:53]
    s_not_b64 vcc, s[52:53]
    s_mov_b64 exec, -1
    v_cndmask_b32_dpp v84, v84, v84, vcc wave_shr:1 row_mask:0xf bank_mask:0xf
    v_cndmask_b32_dpp v85, v85, v85, vcc wave_shr:1 row_mask:0xf bank_mask:0xf
    s_lshr_b64 s[52:53], s[52:53], 1
    v_cndmask_b32_dpp v86, v86, v86, vcc wave_shr:1 row_mask:0xf bank_mask:0xf
    v_cndmask_b32_dpp v87, v87, v87, vcc wave_shr:1 row_mask:0xf bank_mask:0xf
    s_andn2_b64 s[82:83], s[82:83], s[52:53]
    v_cndmask_b32_dpp v7, v7, v7, vcc wave_shr:1 row_mask:0xf bank_mask:0xf
    s_mov_b64 vcc, s[50:51]
    s_mov_b64 exec, s[50:51]
    s_cbranch_scc0 L2_d130
    s_mov_b64 exec, s[82:83]
    s_nop 1
    v_mfma_f32_4x4x4_16b_bf16 v[88:91], v[12:13], v[84:85], 0
    s_nop 1
    v_mfma_f32_4x4x4_16b_bf16 v[88:91], v[10:11], v[86:87], v[88:91]
    s_nop 4
    v_cvt_pk_bf16_f32 v88, v88, v89
    v_cvt_pk_bf16_f32 v89, v90, v91
    ds_pk_add_bf16 v7, v88 offset:65408
    ds_pk_add_bf16 v7, v89 offset:65412
    s_mov_b64 exec, vcc
    s_branch L2_d130
L2_c131:
    s_mov_b64 s[50:51], vcc
    s_lshl_b64 s[52:53], s[82:83], 1
    s_andn2_b64 s[52:53], s[52:53], s[80:81]
    s_andn2_b64 s[52:53], s[52:53], s[50:51]
    s_or_b64 s[80:81], s[80:81], s[52:53]
    s_not_b64 vcc, s[52:53]
    s_mov_b64 exec, -1
    v_cndmask_b32_dpp v84, v84, v84, vcc wave_shr:1 row_mask:0xf bank_mask:0xf
    v_cndmask_b32_dpp v85, v85, v85, vcc wave_shr:1 row_mask:0xf bank_mask:0xf
    s_lshr_b64 s[52:53], s[52:53], 1
    v_cndmask_b32_dpp v86, v86, v86, vcc wave_shr:1 row_mask:0xf bank_mask:0xf
    v_cndmask_b32_dpp v87, v87, v87, vcc wave_shr:1 row_mask:0xf bank_mask:0xf
    s_andn2_b64 s[82:83], s[82:83], s[52:53]
    v_cndmask_b32_dpp v7, v7, v7, vcc wave_shr:1 row_mask:0xf bank_mask:0xf
    s_mov_b64 vcc, s[50:51]
    s_mov_b64 exec, s[50:51]
    s_cbranch_scc0 L2_d131
    s_mov_b64 exec, s[82:83]
    s_nop 1
    v_mfma_f32_4x4x4_16b_bf16 v[88:91], v[12:13], v[84:85], 0
    s_nop 1
    v_mfma_f32_4x4x4_16b_bf16 v[88:91], v[10:11], v[86:87], v[88:91]
    s_nop 4
    v_cvt_pk_bf16_f32 v88, v88, v89
    v_cvt_pk_bf16_f32 v89, v90, v91
    ds_pk_add_bf16 v7, v88 offset:65408
    ds_pk_add_bf16 v7, v89 offset:65412
    s_mov_b64 exec, vcc
    s_branch L2_d131
L2_c132:
    s_mov_b64 s[50:51], vcc
    s_lshl_b64 s[52:53], s[82:83], 1
    s_andn2_b64 s[52:53], s[52:53], s[80:81]
    s_andn2_b64 s[52:53], s[52:53], s[50:51]
    s_or_b64 s[80:81], s[80:81], s[52:53]
    s_not_b64 vcc, s[52:53]
    s_mov_b64 exec, -1
    v_cndmask_b32_dpp v84, v84, v84, vcc wave_shr:1 row_mask:0xf bank_mask:0xf
    v_cndmask_b32_dpp v85, v85, v85, vcc wave_shr:1 row_mask:0xf bank_mask:0xf
    s_lshr_b64 s[52:53], s[52:53], 1
    v_cndmask_b32_dpp v86, v86, v86, vcc wave_shr:1 row_mask:0xf bank_mask:0xf
    v_cndmask_b32_dpp v87, v87, v87, vcc wave_shr:1 row_mask:0xf bank_mask:0xf
    s_andn2_b64 s[82:83], s[82:83], s[52:53]
    v_cndmask_b32_dpp v7, v7, v7, vcc wave_shr:1 row_mask:0xf bank_mask:0xf
    s_mov_b64 vcc, s[50:51]
    s_mov_b64 exec, s[50:51]
    s_cbranch_scc0 L2_d132
    s_mov_b64 exec, s[82:83]
    s_nop 1
    v_mfma_f32_4x4x4_16b_bf16 v[88:91], v[12:13], v[84:85], 0
    s_nop 1
    v_mfma_f32_4x4x4_16b_bf16 v[88:91], v[10:11], v[86:87], v[88:91]
    s_nop 4
    v_cvt_pk_bf16_f32 v88, v88, v89
    v_cvt_pk_bf16_f32 v89, v90, v91
    ds_pk_add_bf16 v7, v88 offset:65408
    ds_pk_add_bf16 v7, v89 offset:65412
    s_mov_b64 exec, vcc
    s_branch L2_d132
L2_c133:
    s_mov_b64 s[50:51], vcc
    s_lshl_b64 s[52:53], s[82:83], 1
    s_andn2_b64 s[52:53], s[52:53], s[80:81]
    s_andn2_b64 s[52:53], s[52:53], s[50:51]
    s_or_b64 s[80:81], s[80:81], s[52:53]
    s_not_b64 vcc, s[52:53]
    s_mov_b64 exec, -1
    v_cndmask_b32_dpp v84, v84, v84, vcc wave_shr:1 row_mask:0xf bank_mask:0xf
    v_cndmask_b32_dpp v85, v85, v85, vcc wave_shr:1 row_mask:0xf bank_mask:0xf
    s_lshr_b64 s[52:53], s[52:53], 1
    v_cndmask_b32_dpp v86, v86, v86, vcc wave_shr:1 row_mask:0xf bank_mask:0xf
    v_cndmask_b32_dpp v87, v87, v87, vcc wave_shr:1 row_mask:0xf bank_mask:0xf
    s_andn2_b64 s[82:83], s[82:83], s[52:53]
    v_cndmask_b32_dpp v7, v7, v7, vcc wave_shr:1 row_mask:0xf bank_mask:0xf
    s_mov_b64 vcc, s[50:51]
    s_mov_b64 exec, s[50:51]
    s_cbranch_scc0 L2_d133
    s_mov_b64 exec, s[82:83]
    s_nop 1
    v_mfma_f32_4x4x4_16b_bf16 v[88:91], v[12:13], v[84:85], 0
    s_nop 1
    v_mfma_f32_4x4x4_16b_bf16 v[88:91], v[10:11], v[86:87], v[88:91]
    s_nop 4
    v_cvt_pk_bf16_f32 v88, v88, v89
    v_cvt_pk_bf16_f32 v89, v90, v91
    ds_pk_add_bf16 v7, v88 offset:65408
    ds_pk_add_bf16 v7, v89 offset:65412
    s_mov_b64 exec, vcc
    s_branch L2_d133
L2_c134:
    s_mov_b64 s[50:51], vcc
    s_lshl_b64 s[52:53], s[82:83], 1
    s_andn2_b64 s[52:53], s[52:53], s[80:81]
    s_andn2_b64 s[52:53], s[52:53], s[50:51]
    s_or_b64 s[80:81], s[80:81], s[52:53]
    s_not_b64 vcc, s[52:53]
    s_mov_b64 exec, -1
    v_cndmask_b32_dpp v84, v84, v84, vcc wave_shr:1 row_mask:0xf bank_mask:0xf
    v_cndmask_b32_dpp v85, v85, v85, vcc wave_shr:1 row_mask:0xf bank_mask:0xf
    s_lshr_b64 s[52:53], s[52:53], 1
    v_cndmask_b32_dpp v86, v86, v86, vcc wave_shr:1 row_mask:0xf bank_mask:0xf
    v_cndmask_b32_dpp v87, v87, v87, vcc wave_shr:1 row_mask:0xf bank_mask:0xf
    s_andn2_b64 s[82:83], s[82:83], s[52:53]
    v_cndmask_b32_dpp v7, v7, v7, vcc wave_shr:1 row_mask:0xf bank_mask:0xf
    s_mov_b64 vcc, s[50:51]
    s_mov_b64 exec, s[50:51]
    s_cbranch_scc0 L2_d134
    s_mov_b64 exec, s[82:83]
    s_nop 1
    v_mfma_f32_4x4x4_16b_bf16 v[88:91], v[12:13], v[84:85], 0
    s_nop 1
    v_mfma_f32_4x4x4_16b_bf16 v[88:91], v[10:11], v[86:87], v[88:91]
    s_nop 4
    v_cvt_pk_bf16_f32 v88, v88, v89
    v_cvt_pk_bf16_f32 v89, v90, v91
    ds_pk_add_bf16 v7, v88 offset:65408
    ds_pk_add_bf16 v7, v89 offset:65412
    s_mov_b64 exec, vcc
    s_branch L2_d134
L2_c135:
    s_mov_b64 s[50:51], vcc
    s_lshl_b64 s[52:53], s[82:83], 1
    s_andn2_b64 s[52:53], s[52:53], s[80:81]
    s_andn2_b64 s[52:53], s[52:53], s[50:51]
    s_or_b64 s[80:81], s[80:81], s[52:53]
    s_not_b64 vcc, s[52:53]
    s_mov_b64 exec, -1
    v_cndmask_b32_dpp v84, v84, v84, vcc wave_shr:1 row_mask:0xf bank_mask:0xf
    v_cndmask_b32_dpp v85, v85, v85, vcc wave_shr:1 row_mask:0xf bank_mask:0xf
    s_lshr_b64 s[52:53], s[52:53], 1
    v_cndmask_b32_dpp v86, v86, v86, vcc wave_shr:1 row_mask:0xf bank_mask:0xf
    v_cndmask_b32_dpp v87, v87, v87, vcc wave_shr:1 row_mask:0xf bank_mask:0xf
    s_andn2_b64 s[82:83], s[82:83], s[52:53]
    v_cndmask_b32_dpp v7, v7, v7, vcc wave_shr:1 row_mask:0xf bank_mask:0xf
    s_mov_b64 vcc, s[50:51]
    s_mov_b64 exec, s[50:51]
    s_cbranch_scc0 L2_d135
    s_mov_b64 exec, s[82:83]
    s_nop 1
    v_mfma_f32_4x4x4_16b_bf16 v[88:91], v[12:13], v[84:85], 0
    s_nop 1
    v_mfma_f32_4x4x4_16b_bf16 v[88:91], v[10:11], v[86:87], v[88:91]
    s_nop 4
    v_cvt_pk_bf16_f32 v88, v88, v89
    v_cvt_pk_bf16_f32 v89, v90, v91
    ds_pk_add_bf16 v7, v88 offset:65408
    ds_pk_add_bf16 v7, v89 offset:65412
    s_mov_b64 exec, vcc
    s_branch L2_d135
L2_c136:
    s_mov_b64 s[50:51], vcc
    s_lshl_b64 s[52:53], s[82:83], 1
    s_andn2_b64 s[52:53], s[52:53], s[80:81]
    s_andn2_b64 s[52:53], s[52:53], s[50:51]
    s_or_b64 s[80:81], s[80:81], s[52:53]
    s_not_b64 vcc, s[52:53]
    s_mov_b64 exec, -1
    v_cndmask_b32_dpp v84, v84, v84, vcc wave_shr:1 row_mask:0xf bank_mask:0xf
    v_cndmask_b32_dpp v85, v85, v85, vcc wave_shr:1 row_mask:0xf bank_mask:0xf
    s_lshr_b64 s[52:53], s[52:53], 1
    v_cndmask_b32_dpp v86, v86, v86, vcc wave_shr:1 row_mask:0xf bank_mask:0xf
    v_cndmask_b32_dpp v87, v87, v87, vcc wave_shr:1 row_mask:0xf bank_mask:0xf
    s_andn2_b64 s[82:83], s[82:83], s[52:53]
    v_cndmask_b32_dpp v7, v7, v7, vcc wave_shr:1 row_mask:0xf bank_mask:0xf
    s_mov_b64 vcc, s[50:51]
    s_mov_b64 exec, s[50:51]
    s_cbranch_scc0 L2_d136
    s_mov_b64 exec, s[82:83]
    s_nop 1
    v_mfma_f32_4x4x4_16b_bf16 v[88:91], v[12:13], v[84:85], 0
    s_nop 1
    v_mfma_f32_4x4x4_16b_bf16 v[88:91], v[10:11], v[86:87], v[88:91]
    s_nop 4
    v_cvt_pk_bf16_f32 v88, v88, v89
    v_cvt_pk_bf16_f32 v89, v90, v91
    ds_pk_add_bf16 v7, v88 offset:65408
    ds_pk_add_bf16 v7, v89 offset:65412
    s_mov_b64 exec, vcc
    s_branch L2_d136
L2_c137:
    s_mov_b64 s[50:51], vcc
    s_lshl_b64 s[52:53], s[82:83], 1
    s_andn2_b64 s[52:53], s[52:53], s[80:81]
    s_andn2_b64 s[52:53], s[52:53], s[50:51]
    s_or_b64 s[80:81], s[80:81], s[52:53]
    s_not_b64 vcc, s[52:53]
    s_mov_b64 exec, -1
    v_cndmask_b32_dpp v84, v84, v84, vcc wave_shr:1 row_mask:0xf bank_mask:0xf
    v_cndmask_b32_dpp v85, v85, v85, vcc wave_shr:1 row_mask:0xf bank_mask:0xf
    s_lshr_b64 s[52:53], s[52:53], 1
    v_cndmask_b32_dpp v86, v86, v86, vcc wave_shr:1 row_mask:0xf bank_mask:0xf
    v_cndmask_b32_dpp v87, v87, v87, vcc wave_shr:1 row_mask:0xf bank_mask:0xf
    s_andn2_b64 s[82:83], s[82:83], s[52:53]
    v_cndmask_b32_dpp v7, v7, v7, vcc wave_shr:1 row_mask:0xf bank_mask:0xf
    s_mov_b64 vcc, s[50:51]
    s_mov_b64 exec, s[50:51]
    s_cbranch_scc0 L2_d137
    s_mov_b64 exec, s[82:83]
    s_nop 1
    v_mfma_f32_4x4x4_16b_bf16 v[88:91], v[12:13], v[84:85], 0
    s_nop 1
    v_mfma_f32_4x4x4_16b_bf16 v[88:91], v[10:11], v[86:87], v[88:91]
    s_nop 4
    v_cvt_pk_bf16_f32 v88, v88, v89
    v_cvt_pk_bf16_f32 v89, v90, v91
    ds_pk_add_bf16 v7, v88 offset:65408
    ds_pk_add_bf16 v7, v89 offset:65412
    s_mov_b64 exec, vcc
    s_branch L2_d137
L2_c138:
    s_mov_b64 s[50:51], vcc
    s_lshl_b64 s[52:53], s[82:83], 1
    s_andn2_b64 s[52:53], s[52:53], s[80:81]
    s_andn2_b64 s[52:53], s[52:53], s[50:51]
    s_or_b64 s[80:81], s[80:81], s[52:53]
    s_not_b64 vcc, s[52:53]
    s_mov_b64 exec, -1
    v_cndmask_b32_dpp v84, v84, v84, vcc wave_shr:1 row_mask:0xf bank_mask:0xf
    v_cndmask_b32_dpp v85, v85, v85, vcc wave_shr:1 row_mask:0xf bank_mask:0xf
    s_lshr_b64 s[52:53], s[52:53], 1
    v_cndmask_b32_dpp v86, v86, v86, vcc wave_shr:1 row_mask:0xf bank_mask:0xf
    v_cndmask_b32_dpp v87, v87, v87, vcc wave_shr:1 row_mask:0xf bank_mask:0xf
    s_andn2_b64 s[82:83], s[82:83], s[52:53]
    v_cndmask_b32_dpp v7, v7, v7, vcc wave_shr:1 row_mask:0xf bank_mask:0xf
    s_mov_b64 vcc, s[50:51]
    s_mov_b64 exec, s[50:51]
    s_cbranch_scc0 L2_d138
    s_mov_b64 exec, s[82:83]
    s_nop 1
    v_mfma_f32_4x4x4_16b_bf16 v[88:91], v[12:13], v[84:85], 0
    s_nop 1
    v_mfma_f32_4x4x4_16b_bf16 v[88:91], v[10:11], v[86:87], v[88:91]
    s_nop 4
    v_cvt_pk_bf16_f32 v88, v88, v89
    v_cvt_pk_bf16_f32 v89, v90, v91
    ds_pk_add_bf16 v7, v88 offset:65408
    ds_pk_add_bf16 v7, v89 offset:65412
    s_mov_b64 exec, vcc
    s_branch L2_d138
L2_c139:
    s_mov_b64 s[50:51], vcc
    s_lshl_b64 s[52:53], s[82:83], 1
    s_andn2_b64 s[52:53], s[52:53], s[80:81]
    s_andn2_b64 s[52:53], s[52:53], s[50:51]
    s_or_b64 s[80:81], s[80:81], s[52:53]
    s_not_b64 vcc, s[52:53]
    s_mov_b64 exec, -1
    v_cndmask_b32_dpp v84, v84, v84, vcc wave_shr:1 row_mask:0xf bank_mask:0xf
    v_cndmask_b32_dpp v85, v85, v85, vcc wave_shr:1 row_mask:0xf bank_mask:0xf
    s_lshr_b64 s[52:53], s[52:53], 1
    v_cndmask_b32_dpp v86, v86, v86, vcc wave_shr:1 row_mask:0xf bank_mask:0xf
    v_cndmask_b32_dpp v87, v87, v87, vcc wave_shr:1 row_mask:0xf bank_mask:0xf
    s_andn2_b64 s[82:83], s[82:83], s[52:53]
    v_cndmask_b32_dpp v7, v7, v7, vcc wave_shr:1 row_mask:0xf bank_mask:0xf
    s_mov_b64 vcc, s[50:51]
    s_mov_b64 exec, s[50:51]
    s_cbranch_scc0 L2_d139
    s_mov_b64 exec, s[82:83]
    s_nop 1
    v_mfma_f32_4x4x4_16b_bf16 v[88:91], v[12:13], v[84:85], 0
    s_nop 1
    v_mfma_f32_4x4x4_16b_bf16 v[88:91], v[10:11], v[86:87], v[88:91]
    s_nop 4
    v_cvt_pk_bf16_f32 v88, v88, v89
    v_cvt_pk_bf16_f32 v89, v90, v91
    ds_pk_add_bf16 v7, v88 offset:65408
    ds_pk_add_bf16 v7, v89 offset:65412
    s_mov_b64 exec, vcc
    s_branch L2_d139
L2_c140:
    s_mov_b64 s[50:51], vcc
    s_lshl_b64 s[52:53], s[82:83], 1
    s_andn2_b64 s[52:53], s[52:53], s[80:81]
    s_andn2_b64 s[52:53], s[52:53], s[50:51]
    s_or_b64 s[80:81], s[80:81], s[52:53]
    s_not_b64 vcc, s[52:53]
    s_mov_b64 exec, -1
    v_cndmask_b32_dpp v84, v84, v84, vcc wave_shr:1 row_mask:0xf bank_mask:0xf
    v_cndmask_b32_dpp v85, v85, v85, vcc wave_shr:1 row_mask:0xf bank_mask:0xf
    s_lshr_b64 s[52:53], s[52:53], 1
    v_cndmask_b32_dpp v86, v86, v86, vcc wave_shr:1 row_mask:0xf bank_mask:0xf
    v_cndmask_b32_dpp v87, v87, v87, vcc wave_shr:1 row_mask:0xf bank_mask:0xf
    s_andn2_b64 s[82:83], s[82:83], s[52:53]
    v_cndmask_b32_dpp v7, v7, v7, vcc wave_shr:1 row_mask:0xf bank_mask:0xf
    s_mov_b64 vcc, s[50:51]
    s_mov_b64 exec, s[50:51]
    s_cbranch_scc0 L2_d140
    s_mov_b64 exec, s[82:83]
    s_nop 1
    v_mfma_f32_4x4x4_16b_bf16 v[88:91], v[12:13], v[84:85], 0
    s_nop 1
    v_mfma_f32_4x4x4_16b_bf16 v[88:91], v[10:11], v[86:87], v[88:91]
    s_nop 4
    v_cvt_pk_bf16_f32 v88, v88, v89
    v_cvt_pk_bf16_f32 v89, v90, v91
    ds_pk_add_bf16 v7, v88 offset:65408
    ds_pk_add_bf16 v7, v89 offset:65412
    s_mov_b64 exec, vcc
    s_branch L2_d140
L2_c141:
    s_mov_b64 s[50:51], vcc
    s_lshl_b64 s[52:53], s[82:83], 1
    s_andn2_b64 s[52:53], s[52:53], s[80:81]
    s_andn2_b64 s[52:53], s[52:53], s[50:51]
    s_or_b64 s[80:81], s[80:81], s[52:53]
    s_not_b64 vcc, s[52:53]
    s_mov_b64 exec, -1
    v_cndmask_b32_dpp v84, v84, v84, vcc wave_shr:1 row_mask:0xf bank_mask:0xf
    v_cndmask_b32_dpp v85, v85, v85, vcc wave_shr:1 row_mask:0xf bank_mask:0xf
    s_lshr_b64 s[52:53], s[52:53], 1
    v_cndmask_b32_dpp v86, v86, v86, vcc wave_shr:1 row_mask:0xf bank_mask:0xf
    v_cndmask_b32_dpp v87, v87, v87, vcc wave_shr:1 row_mask:0xf bank_mask:0xf
    s_andn2_b64 s[82:83], s[82:83], s[52:53]
    v_cndmask_b32_dpp v7, v7, v7, vcc wave_shr:1 row_mask:0xf bank_mask:0xf
    s_mov_b64 vcc, s[50:51]
    s_mov_b64 exec, s[50:51]
    s_cbranch_scc0 L2_d141
    s_mov_b64 exec, s[82:83]
    s_nop 1
    v_mfma_f32_4x4x4_16b_bf16 v[88:91], v[12:13], v[84:85], 0
    s_nop 1
    v_mfma_f32_4x4x4_16b_bf16 v[88:91], v[10:11], v[86:87], v[88:91]
    s_nop 4
    v_cvt_pk_bf16_f32 v88, v88, v89
    v_cvt_pk_bf16_f32 v89, v90, v91
    ds_pk_add_bf16 v7, v88 offset:65408
    ds_pk_add_bf16 v7, v89 offset:65412
    s_mov_b64 exec, vcc
    s_branch L2_d141
L2_c142:
    s_mov_b64 s[50:51], vcc
    s_lshl_b64 s[52:53], s[82:83], 1
    s_andn2_b64 s[52:53], s[52:53], s[80:81]
    s_andn2_b64 s[52:53], s[52:53], s[50:51]
    s_or_b64 s[80:81], s[80:81], s[52:53]
    s_not_b64 vcc, s[52:53]
    s_mov_b64 exec, -1
    v_cndmask_b32_dpp v84, v84, v84, vcc wave_shr:1 row_mask:0xf bank_mask:0xf
    v_cndmask_b32_dpp v85, v85, v85, vcc wave_shr:1 row_mask:0xf bank_mask:0xf
    s_lshr_b64 s[52:53], s[52:53], 1
    v_cndmask_b32_dpp v86, v86, v86, vcc wave_shr:1 row_mask:0xf bank_mask:0xf
    v_cndmask_b32_dpp v87, v87, v87, vcc wave_shr:1 row_mask:0xf bank_mask:0xf
    s_andn2_b64 s[82:83], s[82:83], s[52:53]
    v_cndmask_b32_dpp v7, v7, v7, vcc wave_shr:1 row_mask:0xf bank_mask:0xf
    s_mov_b64 vcc, s[50:51]
    s_mov_b64 exec, s[50:51]
    s_cbranch_scc0 L2_d142
    s_mov_b64 exec, s[82:83]
    s_nop 1
    v_mfma_f32_4x4x4_16b_bf16 v[88:91], v[12:13], v[84:85], 0
    s_nop 1
    v_mfma_f32_4x4x4_16b_bf16 v[88:91], v[10:11], v[86:87], v[88:91]
    s_nop 4
    v_cvt_pk_bf16_f32 v88, v88, v89
    v_cvt_pk_bf16_f32 v89, v90, v91
    ds_pk_add_bf16 v7, v88 offset:65408
    ds_pk_add_bf16 v7, v89 offset:65412
    s_mov_b64 exec, vcc
    s_branch L2_d142
L2_c143:
    s_mov_b64 s[50:51], vcc
    s_lshl_b64 s[52:53], s[82:83], 1
    s_andn2_b64 s[52:53], s[52:53], s[80:81]
    s_andn2_b64 s[52:53], s[52:53], s[50:51]
    s_or_b64 s[80:81], s[80:81], s[52:53]
    s_not_b64 vcc, s[52:53]
    s_mov_b64 exec, -1
    v_cndmask_b32_dpp v84, v84, v84, vcc wave_shr:1 row_mask:0xf bank_mask:0xf
    v_cndmask_b32_dpp v85, v85, v85, vcc wave_shr:1 row_mask:0xf bank_mask:0xf
    s_lshr_b64 s[52:53], s[52:53], 1
    v_cndmask_b32_dpp v86, v86, v86, vcc wave_shr:1 row_mask:0xf bank_mask:0xf
    v_cndmask_b32_dpp v87, v87, v87, vcc wave_shr:1 row_mask:0xf bank_mask:0xf
    s_andn2_b64 s[82:83], s[82:83], s[52:53]
    v_cndmask_b32_dpp v7, v7, v7, vcc wave_shr:1 row_mask:0xf bank_mask:0xf
    s_mov_b64 vcc, s[50:51]
    s_mov_b64 exec, s[50:51]
    s_cbranch_scc0 L2_d143
    s_mov_b64 exec, s[82:83]
    s_nop 1
    v_mfma_f32_4x4x4_16b_bf16 v[88:91], v[12:13], v[84:85], 0
    s_nop 1
    v_mfma_f32_4x4x4_16b_bf16 v[88:91], v[10:11], v[86:87], v[88:91]
    s_nop 4
    v_cvt_pk_bf16_f32 v88, v88, v89
    v_cvt_pk_bf16_f32 v89, v90, v91
    ds_pk_add_bf16 v7, v88 offset:65408
    ds_pk_add_bf16 v7, v89 offset:65412
    s_mov_b64 exec, vcc
    s_branch L2_d143
L2_c144:
    s_mov_b64 s[50:51], vcc
    s_lshl_b64 s[52:53], s[82:83], 1
    s_andn2_b64 s[52:53], s[52:53], s[80:81]
    s_andn2_b64 s[52:53], s[52:53], s[50:51]
    s_or_b64 s[80:81], s[80:81], s[52:53]
    s_not_b64 vcc, s[52:53]
    s_mov_b64 exec, -1
    v_cndmask_b32_dpp v84, v84, v84, vcc wave_shr:1 row_mask:0xf bank_mask:0xf
    v_cndmask_b32_dpp v85, v85, v85, vcc wave_shr:1 row_mask:0xf bank_mask:0xf
    s_lshr_b64 s[52:53], s[52:53], 1
    v_cndmask_b32_dpp v86, v86, v86, vcc wave_shr:1 row_mask:0xf bank_mask:0xf
    v_cndmask_b32_dpp v87, v87, v87, vcc wave_shr:1 row_mask:0xf bank_mask:0xf
    s_andn2_b64 s[82:83], s[82:83], s[52:53]
    v_cndmask_b32_dpp v7, v7, v7, vcc wave_shr:1 row_mask:0xf bank_mask:0xf
    s_mov_b64 vcc, s[50:51]
    s_mov_b64 exec, s[50:51]
    s_cbranch_scc0 L2_d144
    s_mov_b64 exec, s[82:83]
    s_nop 1
    v_mfma_f32_4x4x4_16b_bf16 v[88:91], v[12:13], v[84:85], 0
    s_nop 1
    v_mfma_f32_4x4x4_16b_bf16 v[88:91], v[10:11], v[86:87], v[88:91]
    s_nop 4
    v_cvt_pk_bf16_f32 v88, v88, v89
    v_cvt_pk_bf16_f32 v89, v90, v91
    ds_pk_add_bf16 v7, v88 offset:65408
    ds_pk_add_bf16 v7, v89 offset:65412
    s_mov_b64 exec, vcc
    s_branch L2_d144
L2_c145:
    s_mov_b64 s[50:51], vcc
    s_lshl_b64 s[52:53], s[82:83], 1
    s_andn2_b64 s[52:53], s[52:53], s[80:81]
    s_andn2_b64 s[52:53], s[52:53], s[50:51]
    s_or_b64 s[80:81], s[80:81], s[52:53]
    s_not_b64 vcc, s[52:53]
    s_mov_b64 exec, -1
    v_cndmask_b32_dpp v84, v84, v84, vcc wave_shr:1 row_mask:0xf bank_mask:0xf
    v_cndmask_b32_dpp v85, v85, v85, vcc wave_shr:1 row_mask:0xf bank_mask:0xf
    s_lshr_b64 s[52:53], s[52:53], 1
    v_cndmask_b32_dpp v86, v86, v86, vcc wave_shr:1 row_mask:0xf bank_mask:0xf
    v_cndmask_b32_dpp v87, v87, v87, vcc wave_shr:1 row_mask:0xf bank_mask:0xf
    s_andn2_b64 s[82:83], s[82:83], s[52:53]
    v_cndmask_b32_dpp v7, v7, v7, vcc wave_shr:1 row_mask:0xf bank_mask:0xf
    s_mov_b64 vcc, s[50:51]
    s_mov_b64 exec, s[50:51]
    s_cbranch_scc0 L2_d145
    s_mov_b64 exec, s[82:83]
    s_nop 1
    v_mfma_f32_4x4x4_16b_bf16 v[88:91], v[12:13], v[84:85], 0
    s_nop 1
    v_mfma_f32_4x4x4_16b_bf16 v[88:91], v[10:11], v[86:87], v[88:91]
    s_nop 4
    v_cvt_pk_bf16_f32 v88, v88, v89
    v_cvt_pk_bf16_f32 v89, v90, v91
    ds_pk_add_bf16 v7, v88 offset:65408
    ds_pk_add_bf16 v7, v89 offset:65412
    s_mov_b64 exec, vcc
    s_branch L2_d145
L2_c146:
    s_mov_b64 s[50:51], vcc
    s_lshl_b64 s[52:53], s[82:83], 1
    s_andn2_b64 s[52:53], s[52:53], s[80:81]
    s_andn2_b64 s[52:53], s[52:53], s[50:51]
    s_or_b64 s[80:81], s[80:81], s[52:53]
    s_not_b64 vcc, s[52:53]
    s_mov_b64 exec, -1
    v_cndmask_b32_dpp v84, v84, v84, vcc wave_shr:1 row_mask:0xf bank_mask:0xf
    v_cndmask_b32_dpp v85, v85, v85, vcc wave_shr:1 row_mask:0xf bank_mask:0xf
    s_lshr_b64 s[52:53], s[52:53], 1
    v_cndmask_b32_dpp v86, v86, v86, vcc wave_shr:1 row_mask:0xf bank_mask:0xf
    v_cndmask_b32_dpp v87, v87, v87, vcc wave_shr:1 row_mask:0xf bank_mask:0xf
    s_andn2_b64 s[82:83], s[82:83], s[52:53]
    v_cndmask_b32_dpp v7, v7, v7, vcc wave_shr:1 row_mask:0xf bank_mask:0xf
    s_mov_b64 vcc, s[50:51]
    s_mov_b64 exec, s[50:51]
    s_cbranch_scc0 L2_d146
    s_mov_b64 exec, s[82:83]
    s_nop 1
    v_mfma_f32_4x4x4_16b_bf16 v[88:91], v[12:13], v[84:85], 0
    s_nop 1
    v_mfma_f32_4x4x4_16b_bf16 v[88:91], v[10:11], v[86:87], v[88:91]
    s_nop 4
    v_cvt_pk_bf16_f32 v88, v88, v89
    v_cvt_pk_bf16_f32 v89, v90, v91
    ds_pk_add_bf16 v7, v88 offset:65408
    ds_pk_add_bf16 v7, v89 offset:65412
    s_mov_b64 exec, vcc
    s_branch L2_d146
.section .rodata,"a"
.p2align 6
.amdhsa_kernel gs_sort_kernel
  .amdhsa_next_free_vgpr 128
  .amdhsa_next_free_sgpr 96
  .amdhsa_accum_offset 128
  .amdhsa_group_segment_fixed_size 0
  .amdhsa_kernarg_size 112
  .amdhsa_user_sgpr_count 2
  .amdhsa_user_sgpr_kernarg_segment_ptr 1
  .amdhsa_system_sgpr_workgroup_id_x 1
  .amdhsa_float_denorm_mode_32 3
.end_amdhsa_kernel
.p2align 6
.amdhsa_kernel gs_acc_kernel
  .amdhsa_next_free_vgpr 128
  .amdhsa_next_free_sgpr 100
  .amdhsa_accum_offset 128
  .amdhsa_group_segment_fixed_size 0
  .amdhsa_kernarg_size 112
  .amdhsa_user_sgpr_count 2
  .amdhsa_user_sgpr_kernarg_segment_ptr 1
  .amdhsa_system_sgpr_workgroup_id_x 1
  .amdhsa_float_denorm_mode_32 3
.end_amdhsa_kernel
```

```asm
; @launch grid=(256,1,1) block=(1024,1,1) lds=163840
.amdgcn_target "amdgcn-amd-amdhsa--gfx950"
.text
.globl gather_scatter__molecular_angular_gemnet__graph_kernel
.p2align 8
.type gather_scatter__molecular_angular_gemnet__graph_kernel,@function
gather_scatter__molecular_angular_gemnet__graph_kernel:
    s_cmp_ge_u32 s2, 256
    s_cbranch_scc0 L1_go
    s_endpgm
L1_go:
    s_load_dwordx4 s[4:7], s[0:1], 8
    s_load_dwordx2 s[28:29], s[0:1], 32
    s_load_dwordx2 s[30:31], s[0:1], 104
    s_load_dwordx2 s[56:57], s[0:1], 96
    s_load_dwordx2 s[86:87], s[0:1], 0
    s_load_dwordx4 s[60:63], s[0:1], 56
    s_load_dwordx4 s[64:67], s[0:1], 72
    v_lshrrev_b32 v7, 6, v0
    v_lshlrev_b32 v1, 3, v0
    v_readfirstlane_b32 s32, v7
    v_lshlrev_b32 v0, 4, v0
    s_mul_i32 s33, s2, 16384
    s_mul_i32 s34, s2, 8192
    s_waitcnt lgkmcnt(0)
    s_mov_b32 s8, s4
    s_mov_b32 s9, s5
    s_mov_b32 s10, 0x9c40000
    s_mov_b32 s11, 0x20000
    s_mov_b32 s12, s6
    s_mov_b32 s13, s7
    s_mov_b32 s14, 0x9c40000
    s_mov_b32 s15, 0x20000
    s_mov_b32 s16, s28
    s_mov_b32 s17, s29
    s_mov_b32 s18, 0x4e20000
    s_mov_b32 s19, 0x20000
    s_mov_b32 s68, s62
    s_mov_b32 s69, s63
    s_mov_b32 s70, 0x40
    s_mov_b32 s71, 0x20000
    s_mov_b32 s72, s60
    s_mov_b32 s73, s61
    s_mov_b32 s74, 0x40
    s_mov_b32 s75, 0x20000
    s_mov_b32 s20, s66
    s_mov_b32 s21, s67
    s_mov_b32 s22, 0x20
    s_mov_b32 s23, 0x20000
    s_mov_b32 s80, s64
    s_mov_b32 s81, s65
    s_mov_b32 s82, 0x20
    s_mov_b32 s83, 0x20000
    s_add_u32 s24, s30, 0xebc9000
    s_addc_u32 s25, s31, 0
    s_mov_b32 s26, 0x100
    s_mov_b32 s27, 0x20000
    v_lshrrev_b32 v2, 3, v0
    v_and_b32 v2, 6, v2
    v_lshlrev_b32 v3, 2, v0
    s_lshl_b32 s3, s32, 8
    s_add_u32 s3, s3, s2
    s_cmp_lg_u32 s3, 254
    s_cbranch_scc1 L1_wt
    buffer_load_ushort v96, v2, s[68:71], 0 offen offset:0
    buffer_load_ushort v108, v2, s[68:71], 0 offen offset:8
    buffer_load_ushort v97, v2, s[68:71], 0 offen offset:16
    buffer_load_ushort v109, v2, s[68:71], 0 offen offset:24
    buffer_load_ushort v98, v2, s[68:71], 0 offen offset:32
    buffer_load_ushort v110, v2, s[68:71], 0 offen offset:40
    buffer_load_ushort v99, v2, s[68:71], 0 offen offset:48
    buffer_load_ushort v111, v2, s[68:71], 0 offen offset:56
    buffer_load_ushort v100, v2, s[72:75], 0 offen offset:0
    buffer_load_ushort v112, v2, s[72:75], 0 offen offset:8
    buffer_load_ushort v101, v2, s[72:75], 0 offen offset:16
    buffer_load_ushort v113, v2, s[72:75], 0 offen offset:24
    buffer_load_ushort v102, v2, s[72:75], 0 offen offset:32
    buffer_load_ushort v114, v2, s[72:75], 0 offen offset:40
    buffer_load_ushort v103, v2, s[72:75], 0 offen offset:48
    buffer_load_ushort v115, v2, s[72:75], 0 offen offset:56
    buffer_load_ushort v104, v2, s[20:23], 0 offen offset:0
    buffer_load_ushort v116, v2, s[20:23], 0 offen offset:8
    buffer_load_ushort v105, v2, s[20:23], 0 offen offset:16
    buffer_load_ushort v117, v2, s[20:23], 0 offen offset:24
    buffer_load_ushort v106, v2, s[80:83], 0 offen offset:0
    buffer_load_ushort v118, v2, s[80:83], 0 offen offset:8
    buffer_load_ushort v107, v2, s[80:83], 0 offen offset:16
    buffer_load_ushort v119, v2, s[80:83], 0 offen offset:24
    s_waitcnt vmcnt(0)
    v_lshl_or_b32 v96, v108, 16, v96
    v_lshl_or_b32 v97, v109, 16, v97
    v_lshl_or_b32 v98, v110, 16, v98
    v_lshl_or_b32 v99, v111, 16, v99
    v_lshl_or_b32 v100, v112, 16, v100
    v_lshl_or_b32 v101, v113, 16, v101
    v_lshl_or_b32 v102, v114, 16, v102
    v_lshl_or_b32 v103, v115, 16, v103
    v_lshl_or_b32 v104, v116, 16, v104
    v_lshl_or_b32 v105, v117, 16, v105
    v_lshl_or_b32 v106, v118, 16, v106
    v_lshl_or_b32 v107, v119, 16, v107
    buffer_store_dwordx4 v[96:99], v3, s[24:27], 0 offen offset:0 sc1
    buffer_store_dwordx4 v[100:103], v3, s[24:27], 0 offen offset:16 sc1
    buffer_store_dwordx4 v[104:107], v3, s[24:27], 0 offen offset:32 sc1
L1_wt:
    s_nop 1
    s_add_u32 s44, s33, 0x0
    buffer_load_dwordx4 v[124:127], v0, s[8:11], s44 offen nt
    s_add_u32 s45, s33, 0x0
    buffer_load_dwordx4 v[108:111], v0, s[12:15], s45 offen nt
    s_add_u32 s46, s34, 0x0
    buffer_load_dwordx2 v[16:17], v1, s[16:19], s46 offen nt
    s_add_u32 s47, s34, 0x200000
    buffer_load_dwordx2 v[18:19], v1, s[16:19], s47 offen nt
    s_add_u32 s44, s33, 0x400000
    buffer_load_dwordx4 v[60:63], v0, s[8:11], s44 offen nt
    s_add_u32 s45, s33, 0x400000
    buffer_load_dwordx4 v[20:23], v0, s[12:15], s45 offen nt
    s_add_u32 s46, s33, 0x800000
    buffer_load_dwordx4 v[24:27], v0, s[8:11], s46 offen nt
    s_add_u32 s47, s33, 0x800000
    buffer_load_dwordx4 v[28:31], v0, s[12:15], s47 offen nt
    s_add_u32 s44, s34, 0x400000
    buffer_load_dwordx2 v[64:65], v1, s[16:19], s44 offen nt
    s_add_u32 s45, s34, 0x600000
    buffer_load_dwordx2 v[66:67], v1, s[16:19], s45 offen nt
    s_mov_b32 s20, s30
    s_mov_b32 s21, s31
    s_mov_b32 s22, 0xd340000
    s_mov_b32 s23, 0x20000
    s_add_u32 s24, s30, 0x28000
    s_addc_u32 s25, s31, 0
    s_mov_b32 s26, 0xd318000
    s_mov_b32 s27, 0x20000
    s_mov_b32 s80, s86
    s_mov_b32 s81, s87
    s_mov_b32 s82, 0x4e2000
    s_mov_b32 s83, 0x20000
    s_mul_i32 s35, s2, 173056
    s_and_b32 s37, s32, 3
    s_lshl_b32 s37, s37, 3
    s_mov_b32 s36, s37
    s_lshr_b32 s37, s32, 2
    s_mul_i32 s37, s37, 2080
    s_add_u32 s36, s36, s37
    s_and_b32 s37, s2, 3
    s_lshl_b32 s37, s37, 5
    s_add_u32 s36, s36, s37
    s_mul_i32 s4, s2, 5
    s_add_u32 s4, s4, 8192
    s_lshl_b32 s38, s4, 14
    s_lshl_b32 s39, s4, 13
    v_mov_b32 v2, 1
    v_mov_b32 v4, 0x80000007
    v_mov_b32 v5, 0xfc
    v_mov_b32 v6, 0x78
    s_mov_b32 s40, 16512
    s_mov_b32 s55, -10000
    s_mov_b32 s41, 0x010c0c01
    s_mov_b32 s42, 0x030c0c03
    v_mov_b32 v8, 0
    v_mov_b32 v9, 0
    v_mov_b32 v10, 0
    v_mov_b32 v11, 0
    ds_write_b128 v0, v[8:11]
    s_add_u32 s60, s30, 0xebd2000
    s_addc_u32 s61, s31, 0
    s_mov_b32 s62, 0x8000
    s_mov_b32 s63, 0x20000
    s_mov_b64 s[66:67], s[56:57]
    s_lshr_b32 s3, s2, 4
    s_lshl_b32 s3, s3, 11
    s_and_b32 s57, s2, 15
    s_lshl2_add_u32 s57, s57, s3
    s_add_u32 s68, s30, 0xebca000
    s_addc_u32 s69, s31, 0
    s_mov_b32 s70, 0x80
    s_mov_b32 s71, 0x20000
    s_lshl_b32 s3, s2, 7
    s_add_u32 s68, s68, s3
    s_addc_u32 s69, s69, 0
    s_cmp_lg_u32 s32, 0
    s_cbranch_scc1 L1_fl
    buffer_store_dwordx4 v[8:11], v0, s[68:71], 0 offen sc1
    s_mov_b64 exec, 1
    buffer_store_dword v8, off, s[60:63], s57 sc1
    s_mov_b64 exec, -1
L1_fl:
    s_waitcnt lgkmcnt(0)
    s_barrier
    s_setprio 3
    s_add_u32 s46, s33, 0xc00000
    buffer_load_dwordx4 v[32:35], v0, s[8:11], s46 offen nt
    s_add_u32 s47, s33, 0xc00000
    buffer_load_dwordx4 v[36:39], v0, s[12:15], s47 offen nt
    s_waitcnt vmcnt(8)
    v_lshlrev_b32 v7, 16, v16
    v_and_b32 v8, 0xffff0000, v16
    v_lshlrev_b32 v9, 16, v17
    v_and_b32 v10, 0xffff0000, v17
    v_mul_f32 v7, 0.15915494, v7
    v_mul_f32 v8, 0.15915494, v8
    v_mul_f32 v9, 0.15915494, v9
    v_mul_f32 v10, 0.15915494, v10
    v_mul_hi_u32_u24 v14, 429497, v124
    v_lshrrev_b32 v12, 3, v108
    v_cos_f32 v7, v7
    v_lshlrev_b16 v13, 3, v108
    v_mad_i32_i24 v11, v14, s55, v124
    v_bitop3_b32 v12, v6, v13, v12 bitop3:0xca
    v_lshl_add_u32 v11, v11, 17, s40
    v_lshlrev_b16 v14, 8, v14
    v_lshrrev_b32 v13, 2, v108
    v_add_u32 v124, v12, v11
    v_bitop3_b32 v108, v5, v13, v14 bitop3:0xea
    ds_add_u32 v108, v2
    v_mul_hi_u32_u24 v14, 429497, v125
    v_lshrrev_b32 v12, 3, v109
    v_cos_f32 v8, v8
    v_lshlrev_b16 v13, 3, v109
    v_mad_i32_i24 v11, v14, s55, v125
    v_bitop3_b32 v12, v6, v13, v12 bitop3:0xca
    v_lshl_add_u32 v11, v11, 17, s40
    v_lshlrev_b16 v14, 8, v14
    v_lshrrev_b32 v13, 2, v109
    v_add_u32 v125, v12, v11
    v_bitop3_b32 v109, v5, v13, v14 bitop3:0xea
    ds_add_u32 v109, v2
    v_cvt_pk_bf16_f32 v16, v7, v8
    v_perm_b32 v12, v16, v16, s41
    v_bitop3_b32 v124, v4, v12, v124 bitop3:0xca
    v_perm_b32 v13, v16, v16, s42
    v_bitop3_b32 v125, v4, v13, v125 bitop3:0xca
    v_mul_hi_u32_u24 v14, 429497, v126
    v_lshrrev_b32 v12, 3, v110
    v_cos_f32 v9, v9
    v_lshlrev_b16 v13, 3, v110
    v_mad_i32_i24 v11, v14, s55, v126
    v_bitop3_b32 v12, v6, v13, v12 bitop3:0xca
    v_lshl_add_u32 v11, v11, 17, s40
    v_lshlrev_b16 v14, 8, v14
    v_lshrrev_b32 v13, 2, v110
    v_add_u32 v126, v12, v11
    v_bitop3_b32 v110, v5, v13, v14 bitop3:0xea
    ds_add_u32 v110, v2
    v_mul_hi_u32_u24 v14, 429497, v127
    v_lshrrev_b32 v12, 3, v111
    v_cos_f32 v10, v10
    v_lshlrev_b16 v13, 3, v111
    v_mad_i32_i24 v11, v14, s55, v127
    v_bitop3_b32 v12, v6, v13, v12 bitop3:0xca
    v_lshl_add_u32 v11, v11, 17, s40
    v_lshlrev_b16 v14, 8, v14
    v_lshrrev_b32 v13, 2, v111
    v_add_u32 v127, v12, v11
    v_bitop3_b32 v111, v5, v13, v14 bitop3:0xea
    ds_add_u32 v111, v2
    v_cvt_pk_bf16_f32 v17, v9, v10
    v_perm_b32 v12, v17, v17, s41
    v_bitop3_b32 v126, v4, v12, v126 bitop3:0xca
    v_perm_b32 v13, v17, v17, s42
    v_bitop3_b32 v127, v4, v13, v127 bitop3:0xca
    s_add_u32 s44, s33, 0x1000000
    buffer_load_dwordx4 v[40:43], v0, s[8:11], s44 offen nt
    s_add_u32 s45, s33, 0x1000000
    buffer_load_dwordx4 v[44:47], v0, s[12:15], s45 offen nt
    s_add_u32 s46, s34, 0x800000
    buffer_load_dwordx2 v[68:69], v1, s[16:19], s46 offen nt
    s_add_u32 s47, s34, 0xa00000
    buffer_load_dwordx2 v[70:71], v1, s[16:19], s47 offen nt
    s_waitcnt vmcnt(10)
    v_lshlrev_b32 v7, 16, v18
    v_and_b32 v8, 0xffff0000, v18
    v_lshlrev_b32 v9, 16, v19
    v_and_b32 v10, 0xffff0000, v19
    v_mul_f32 v7, 0.15915494, v7
    v_mul_f32 v8, 0.15915494, v8
    v_mul_f32 v9, 0.15915494, v9
    v_mul_f32 v10, 0.15915494, v10
    v_mul_hi_u32_u24 v14, 429497, v60
    v_lshrrev_b32 v12, 3, v20
    v_cos_f32 v7, v7
    v_lshlrev_b16 v13, 3, v20
    v_mad_i32_i24 v11, v14, s55, v60
    v_bitop3_b32 v12, v6, v13, v12 bitop3:0xca
    v_lshl_add_u32 v11, v11, 17, s40
    v_lshlrev_b16 v14, 8, v14
    v_lshrrev_b32 v13, 2, v20
    v_add_u32 v60, v12, v11
    v_bitop3_b32 v20, v5, v13, v14 bitop3:0xea
    ds_add_u32 v20, v2
    v_mul_hi_u32_u24 v14, 429497, v61
    v_lshrrev_b32 v12, 3, v21
    v_cos_f32 v8, v8
    v_lshlrev_b16 v13, 3, v21
    v_mad_i32_i24 v11, v14, s55, v61
    v_bitop3_b32 v12, v6, v13, v12 bitop3:0xca
    v_lshl_add_u32 v11, v11, 17, s40
    v_lshlrev_b16 v14, 8, v14
    v_lshrrev_b32 v13, 2, v21
    v_add_u32 v61, v12, v11
    v_bitop3_b32 v21, v5, v13, v14 bitop3:0xea
    ds_add_u32 v21, v2
    v_cvt_pk_bf16_f32 v18, v7, v8
    v_perm_b32 v12, v18, v18, s41
    v_bitop3_b32 v60, v4, v12, v60 bitop3:0xca
    v_perm_b32 v13, v18, v18, s42
    v_bitop3_b32 v61, v4, v13, v61 bitop3:0xca
    v_mul_hi_u32_u24 v14, 429497, v62
    v_lshrrev_b32 v12, 3, v22
    v_cos_f32 v9, v9
    v_lshlrev_b16 v13, 3, v22
    v_mad_i32_i24 v11, v14, s55, v62
    v_bitop3_b32 v12, v6, v13, v12 bitop3:0xca
    v_lshl_add_u32 v11, v11, 17, s40
    v_lshlrev_b16 v14, 8, v14
    v_lshrrev_b32 v13, 2, v22
    v_add_u32 v62, v12, v11
    v_bitop3_b32 v22, v5, v13, v14 bitop3:0xea
    ds_add_u32 v22, v2
    v_mul_hi_u32_u24 v14, 429497, v63
    v_lshrrev_b32 v12, 3, v23
    v_cos_f32 v10, v10
    v_lshlrev_b16 v13, 3, v23
    v_mad_i32_i24 v11, v14, s55, v63
    v_bitop3_b32 v12, v6, v13, v12 bitop3:0xca
    v_lshl_add_u32 v11, v11, 17, s40
    v_lshlrev_b16 v14, 8, v14
    v_lshrrev_b32 v13, 2, v23
    v_add_u32 v63, v12, v11
    v_bitop3_b32 v23, v5, v13, v14 bitop3:0xea
    ds_add_u32 v23, v2
    v_cvt_pk_bf16_f32 v19, v9, v10
    v_perm_b32 v12, v19, v19, s41
    v_bitop3_b32 v62, v4, v12, v62 bitop3:0xca
    v_perm_b32 v13, v19, v19, s42
    v_bitop3_b32 v63, v4, v13, v63 bitop3:0xca
    s_setprio 2
    s_add_u32 s44, s33, 0x1400000
    buffer_load_dwordx4 v[72:75], v0, s[8:11], s44 offen nt
    s_add_u32 s45, s33, 0x1400000
    buffer_load_dwordx4 v[76:79], v0, s[12:15], s45 offen nt
    s_waitcnt vmcnt(8)
    v_lshlrev_b32 v7, 16, v64
    v_and_b32 v8, 0xffff0000, v64
    v_lshlrev_b32 v9, 16, v65
    v_and_b32 v10, 0xffff0000, v65
    v_mul_f32 v7, 0.15915494, v7
    v_mul_f32 v8, 0.15915494, v8
    v_mul_f32 v9, 0.15915494, v9
    v_mul_f32 v10, 0.15915494, v10
    v_mul_hi_u32_u24 v14, 429497, v24
    v_lshrrev_b32 v12, 3, v28
    v_cos_f32 v7, v7
    v_lshlrev_b16 v13, 3, v28
    v_mad_i32_i24 v11, v14, s55, v24
    v_bitop3_b32 v12, v6, v13, v12 bitop3:0xca
    v_lshl_add_u32 v11, v11, 17, s40
    v_lshlrev_b16 v14, 8, v14
    v_lshrrev_b32 v13, 2, v28
    v_add_u32 v24, v12, v11
    v_bitop3_b32 v28, v5, v13, v14 bitop3:0xea
    ds_add_u32 v28, v2
    v_mul_hi_u32_u24 v14, 429497, v25
    v_lshrrev_b32 v12, 3, v29
    v_cos_f32 v8, v8
    v_lshlrev_b16 v13, 3, v29
    v_mad_i32_i24 v11, v14, s55, v25
    v_bitop3_b32 v12, v6, v13, v12 bitop3:0xca
    v_lshl_add_u32 v11, v11, 17, s40
    v_lshlrev_b16 v14, 8, v14
    v_lshrrev_b32 v13, 2, v29
    v_add_u32 v25, v12, v11
    v_bitop3_b32 v29, v5, v13, v14 bitop3:0xea
    ds_add_u32 v29, v2
    v_cvt_pk_bf16_f32 v64, v7, v8
    v_perm_b32 v12, v64, v64, s41
    v_bitop3_b32 v24, v4, v12, v24 bitop3:0xca
    v_perm_b32 v13, v64, v64, s42
    v_bitop3_b32 v25, v4, v13, v25 bitop3:0xca
    v_mul_hi_u32_u24 v14, 429497, v26
    v_lshrrev_b32 v12, 3, v30
    v_cos_f32 v9, v9
    v_lshlrev_b16 v13, 3, v30
    v_mad_i32_i24 v11, v14, s55, v26
    v_bitop3_b32 v12, v6, v13, v12 bitop3:0xca
    v_lshl_add_u32 v11, v11, 17, s40
    v_lshlrev_b16 v14, 8, v14
    v_lshrrev_b32 v13, 2, v30
    v_add_u32 v26, v12, v11
    v_bitop3_b32 v30, v5, v13, v14 bitop3:0xea
    ds_add_u32 v30, v2
    v_mul_hi_u32_u24 v14, 429497, v27
    v_lshrrev_b32 v12, 3, v31
    v_cos_f32 v10, v10
    v_lshlrev_b16 v13, 3, v31
    v_mad_i32_i24 v11, v14, s55, v27
    v_bitop3_b32 v12, v6, v13, v12 bitop3:0xca
    v_lshl_add_u32 v11, v11, 17, s40
    v_lshlrev_b16 v14, 8, v14
    v_lshrrev_b32 v13, 2, v31
    v_add_u32 v27, v12, v11
    v_bitop3_b32 v31, v5, v13, v14 bitop3:0xea
    ds_add_u32 v31, v2
    v_cvt_pk_bf16_f32 v65, v9, v10
    v_perm_b32 v12, v65, v65, s41
    v_bitop3_b32 v26, v4, v12, v26 bitop3:0xca
    v_perm_b32 v13, v65, v65, s42
    v_bitop3_b32 v27, v4, v13, v27 bitop3:0xca
    s_add_u32 s46, s33, 0x1800000
    buffer_load_dwordx4 v[80:83], v0, s[8:11], s46 offen nt
    s_add_u32 s47, s33, 0x1800000
    buffer_load_dwordx4 v[84:87], v0, s[12:15], s47 offen nt
    s_add_u32 s44, s34, 0xc00000
    buffer_load_dwordx2 v[88:89], v1, s[16:19], s44 offen nt
    s_add_u32 s45, s34, 0xe00000
    buffer_load_dwordx2 v[90:91], v1, s[16:19], s45 offen nt
    s_waitcnt vmcnt(10)
    v_lshlrev_b32 v7, 16, v66
    v_and_b32 v8, 0xffff0000, v66
    v_lshlrev_b32 v9, 16, v67
    v_and_b32 v10, 0xffff0000, v67
    v_mul_f32 v7, 0.15915494, v7
    v_mul_f32 v8, 0.15915494, v8
    v_mul_f32 v9, 0.15915494, v9
    v_mul_f32 v10, 0.15915494, v10
    v_mul_hi_u32_u24 v14, 429497, v32
    v_lshrrev_b32 v12, 3, v36
    v_cos_f32 v7, v7
    v_lshlrev_b16 v13, 3, v36
    v_mad_i32_i24 v11, v14, s55, v32
    v_bitop3_b32 v12, v6, v13, v12 bitop3:0xca
    v_lshl_add_u32 v11, v11, 17, s40
    v_lshlrev_b16 v14, 8, v14
    v_lshrrev_b32 v13, 2, v36
    v_add_u32 v32, v12, v11
    v_bitop3_b32 v36, v5, v13, v14 bitop3:0xea
    ds_add_u32 v36, v2
    v_mul_hi_u32_u24 v14, 429497, v33
    v_lshrrev_b32 v12, 3, v37
    v_cos_f32 v8, v8
    v_lshlrev_b16 v13, 3, v37
    v_mad_i32_i24 v11, v14, s55, v33
    v_bitop3_b32 v12, v6, v13, v12 bitop3:0xca
    v_lshl_add_u32 v11, v11, 17, s40
    v_lshlrev_b16 v14, 8, v14
    v_lshrrev_b32 v13, 2, v37
    v_add_u32 v33, v12, v11
    v_bitop3_b32 v37, v5, v13, v14 bitop3:0xea
    ds_add_u32 v37, v2
    v_cvt_pk_bf16_f32 v66, v7, v8
    v_perm_b32 v12, v66, v66, s41
    v_bitop3_b32 v32, v4, v12, v32 bitop3:0xca
    v_perm_b32 v13, v66, v66, s42
    v_bitop3_b32 v33, v4, v13, v33 bitop3:0xca
    v_mul_hi_u32_u24 v14, 429497, v34
    v_lshrrev_b32 v12, 3, v38
    v_cos_f32 v9, v9
    v_lshlrev_b16 v13, 3, v38
    v_mad_i32_i24 v11, v14, s55, v34
    v_bitop3_b32 v12, v6, v13, v12 bitop3:0xca
    v_lshl_add_u32 v11, v11, 17, s40
    v_lshlrev_b16 v14, 8, v14
    v_lshrrev_b32 v13, 2, v38
    v_add_u32 v34, v12, v11
    v_bitop3_b32 v38, v5, v13, v14 bitop3:0xea
    ds_add_u32 v38, v2
    v_mul_hi_u32_u24 v14, 429497, v35
    v_lshrrev_b32 v12, 3, v39
    v_cos_f32 v10, v10
    v_lshlrev_b16 v13, 3, v39
    v_mad_i32_i24 v11, v14, s55, v35
    v_bitop3_b32 v12, v6, v13, v12 bitop3:0xca
    v_lshl_add_u32 v11, v11, 17, s40
    v_lshlrev_b16 v14, 8, v14
    v_lshrrev_b32 v13, 2, v39
    v_add_u32 v35, v12, v11
    v_bitop3_b32 v39, v5, v13, v14 bitop3:0xea
    ds_add_u32 v39, v2
    v_cvt_pk_bf16_f32 v67, v9, v10
    v_perm_b32 v12, v67, v67, s41
    v_bitop3_b32 v34, v4, v12, v34 bitop3:0xca
    v_perm_b32 v13, v67, v67, s42
    v_bitop3_b32 v35, v4, v13, v35 bitop3:0xca
    s_setprio 1
    s_add_u32 s46, s33, 0x1c00000
    buffer_load_dwordx4 v[48:51], v0, s[8:11], s46 offen nt
    s_add_u32 s47, s33, 0x1c00000
    buffer_load_dwordx4 v[92:95], v0, s[12:15], s47 offen nt
    s_waitcnt vmcnt(8)
    v_lshlrev_b32 v7, 16, v68
    v_and_b32 v8, 0xffff0000, v68
    v_lshlrev_b32 v9, 16, v69
    v_and_b32 v10, 0xffff0000, v69
    v_mul_f32 v7, 0.15915494, v7
    v_mul_f32 v8, 0.15915494, v8
    v_mul_f32 v9, 0.15915494, v9
    v_mul_f32 v10, 0.15915494, v10
    v_mul_hi_u32_u24 v14, 429497, v40
    v_lshrrev_b32 v12, 3, v44
    v_cos_f32 v7, v7
    v_lshlrev_b16 v13, 3, v44
    v_mad_i32_i24 v11, v14, s55, v40
    v_bitop3_b32 v12, v6, v13, v12 bitop3:0xca
    v_lshl_add_u32 v11, v11, 17, s40
    v_lshlrev_b16 v14, 8, v14
    v_lshrrev_b32 v13, 2, v44
    v_add_u32 v40, v12, v11
    v_bitop3_b32 v44, v5, v13, v14 bitop3:0xea
    ds_add_u32 v44, v2
    v_mul_hi_u32_u24 v14, 429497, v41
    v_lshrrev_b32 v12, 3, v45
    v_cos_f32 v8, v8
    v_lshlrev_b16 v13, 3, v45
    v_mad_i32_i24 v11, v14, s55, v41
    v_bitop3_b32 v12, v6, v13, v12 bitop3:0xca
    v_lshl_add_u32 v11, v11, 17, s40
    v_lshlrev_b16 v14, 8, v14
    v_lshrrev_b32 v13, 2, v45
    v_add_u32 v41, v12, v11
    v_bitop3_b32 v45, v5, v13, v14 bitop3:0xea
    ds_add_u32 v45, v2
    v_cvt_pk_bf16_f32 v68, v7, v8
    v_perm_b32 v12, v68, v68, s41
    v_bitop3_b32 v40, v4, v12, v40 bitop3:0xca
    v_perm_b32 v13, v68, v68, s42
    v_bitop3_b32 v41, v4, v13, v41 bitop3:0xca
    v_mul_hi_u32_u24 v14, 429497, v42
    v_lshrrev_b32 v12, 3, v46
    v_cos_f32 v9, v9
    v_lshlrev_b16 v13, 3, v46
    v_mad_i32_i24 v11, v14, s55, v42
    v_bitop3_b32 v12, v6, v13, v12 bitop3:0xca
    v_lshl_add_u32 v11, v11, 17, s40
    v_lshlrev_b16 v14, 8, v14
    v_lshrrev_b32 v13, 2, v46
    v_add_u32 v42, v12, v11
    v_bitop3_b32 v46, v5, v13, v14 bitop3:0xea
    ds_add_u32 v46, v2
    v_mul_hi_u32_u24 v14, 429497, v43
    v_lshrrev_b32 v12, 3, v47
    v_cos_f32 v10, v10
    v_lshlrev_b16 v13, 3, v47
    v_mad_i32_i24 v11, v14, s55, v43
    v_bitop3_b32 v12, v6, v13, v12 bitop3:0xca
    v_lshl_add_u32 v11, v11, 17, s40
    v_lshlrev_b16 v14, 8, v14
    v_lshrrev_b32 v13, 2, v47
    v_add_u32 v43, v12, v11
    v_bitop3_b32 v47, v5, v13, v14 bitop3:0xea
    ds_add_u32 v47, v2
    v_cvt_pk_bf16_f32 v69, v9, v10
    v_perm_b32 v12, v69, v69, s41
    v_bitop3_b32 v42, v4, v12, v42 bitop3:0xca
    v_perm_b32 v13, v69, v69, s42
    v_bitop3_b32 v43, v4, v13, v43 bitop3:0xca
    s_add_u32 s44, s33, 0x2000000
    buffer_load_dwordx4 v[96:99], v0, s[8:11], s44 offen nt
    s_add_u32 s45, s33, 0x2000000
    buffer_load_dwordx4 v[52:55], v0, s[12:15], s45 offen nt
    s_add_u32 s46, s34, 0x1000000
    buffer_load_dwordx2 v[104:105], v1, s[16:19], s46 offen nt
    s_add_u32 s47, s34, 0x1200000
    buffer_load_dwordx2 v[106:107], v1, s[16:19], s47 offen nt
    s_waitcnt vmcnt(10)
    v_lshlrev_b32 v7, 16, v70
    v_and_b32 v8, 0xffff0000, v70
    v_lshlrev_b32 v9, 16, v71
    v_and_b32 v10, 0xffff0000, v71
    v_mul_f32 v7, 0.15915494, v7
    v_mul_f32 v8, 0.15915494, v8
    v_mul_f32 v9, 0.15915494, v9
    v_mul_f32 v10, 0.15915494, v10
    v_mul_hi_u32_u24 v14, 429497, v72
    v_lshrrev_b32 v12, 3, v76
    v_cos_f32 v7, v7
    v_lshlrev_b16 v13, 3, v76
    v_mad_i32_i24 v11, v14, s55, v72
    v_bitop3_b32 v12, v6, v13, v12 bitop3:0xca
    v_lshl_add_u32 v11, v11, 17, s40
    v_lshlrev_b16 v14, 8, v14
    v_lshrrev_b32 v13, 2, v76
    v_add_u32 v72, v12, v11
    v_bitop3_b32 v76, v5, v13, v14 bitop3:0xea
    ds_add_u32 v76, v2
    v_mul_hi_u32_u24 v14, 429497, v73
    v_lshrrev_b32 v12, 3, v77
    v_cos_f32 v8, v8
    v_lshlrev_b16 v13, 3, v77
    v_mad_i32_i24 v11, v14, s55, v73
    v_bitop3_b32 v12, v6, v13, v12 bitop3:0xca
    v_lshl_add_u32 v11, v11, 17, s40
    v_lshlrev_b16 v14, 8, v14
    v_lshrrev_b32 v13, 2, v77
    v_add_u32 v73, v12, v11
    v_bitop3_b32 v77, v5, v13, v14 bitop3:0xea
    ds_add_u32 v77, v2
    v_cvt_pk_bf16_f32 v70, v7, v8
    v_perm_b32 v12, v70, v70, s41
    v_bitop3_b32 v72, v4, v12, v72 bitop3:0xca
    v_perm_b32 v13, v70, v70, s42
    v_bitop3_b32 v73, v4, v13, v73 bitop3:0xca
    v_mul_hi_u32_u24 v14, 429497, v74
    v_lshrrev_b32 v12, 3, v78
    v_cos_f32 v9, v9
    v_lshlrev_b16 v13, 3, v78
    v_mad_i32_i24 v11, v14, s55, v74
    v_bitop3_b32 v12, v6, v13, v12 bitop3:0xca
    v_lshl_add_u32 v11, v11, 17, s40
    v_lshlrev_b16 v14, 8, v14
    v_lshrrev_b32 v13, 2, v78
    v_add_u32 v74, v12, v11
    v_bitop3_b32 v78, v5, v13, v14 bitop3:0xea
    ds_add_u32 v78, v2
    v_mul_hi_u32_u24 v14, 429497, v75
    v_lshrrev_b32 v12, 3, v79
    v_cos_f32 v10, v10
    v_lshlrev_b16 v13, 3, v79
    v_mad_i32_i24 v11, v14, s55, v75
    v_bitop3_b32 v12, v6, v13, v12 bitop3:0xca
    v_lshl_add_u32 v11, v11, 17, s40
    v_lshlrev_b16 v14, 8, v14
    v_lshrrev_b32 v13, 2, v79
    v_add_u32 v75, v12, v11
    v_bitop3_b32 v79, v5, v13, v14 bitop3:0xea
    ds_add_u32 v79, v2
    v_cvt_pk_bf16_f32 v71, v9, v10
    v_perm_b32 v12, v71, v71, s41
    v_bitop3_b32 v74, v4, v12, v74 bitop3:0xca
    v_perm_b32 v13, v71, v71, s42
    v_bitop3_b32 v75, v4, v13, v75 bitop3:0xca
    s_setprio 0
    s_add_u32 s44, s33, 0x2400000
    buffer_load_dwordx4 v[56:59], v0, s[8:11], s44 offen nt
    s_waitcnt vmcnt(7)
    v_lshlrev_b32 v7, 16, v88
    v_and_b32 v8, 0xffff0000, v88
    v_lshlrev_b32 v9, 16, v89
    v_and_b32 v10, 0xffff0000, v89
    v_mul_f32 v7, 0.15915494, v7
    v_mul_f32 v8, 0.15915494, v8
    v_mul_f32 v9, 0.15915494, v9
    v_mul_f32 v10, 0.15915494, v10
    v_mul_hi_u32_u24 v14, 429497, v80
    v_lshrrev_b32 v12, 3, v84
    v_cos_f32 v7, v7
    v_lshlrev_b16 v13, 3, v84
    v_mad_i32_i24 v11, v14, s55, v80
    v_bitop3_b32 v12, v6, v13, v12 bitop3:0xca
    v_lshl_add_u32 v11, v11, 17, s40
    v_lshlrev_b16 v14, 8, v14
    v_lshrrev_b32 v13, 2, v84
    v_add_u32 v80, v12, v11
    v_bitop3_b32 v84, v5, v13, v14 bitop3:0xea
    ds_add_u32 v84, v2
    v_mul_hi_u32_u24 v14, 429497, v81
    v_lshrrev_b32 v12, 3, v85
    v_cos_f32 v8, v8
    v_lshlrev_b16 v13, 3, v85
    v_mad_i32_i24 v11, v14, s55, v81
    v_bitop3_b32 v12, v6, v13, v12 bitop3:0xca
    v_lshl_add_u32 v11, v11, 17, s40
    v_lshlrev_b16 v14, 8, v14
    v_lshrrev_b32 v13, 2, v85
    v_add_u32 v81, v12, v11
    v_bitop3_b32 v85, v5, v13, v14 bitop3:0xea
    ds_add_u32 v85, v2
    v_cvt_pk_bf16_f32 v88, v7, v8
    v_perm_b32 v12, v88, v88, s41
    v_bitop3_b32 v80, v4, v12, v80 bitop3:0xca
    v_perm_b32 v13, v88, v88, s42
    v_bitop3_b32 v81, v4, v13, v81 bitop3:0xca
    v_mul_hi_u32_u24 v14, 429497, v82
    v_lshrrev_b32 v12, 3, v86
    v_cos_f32 v9, v9
    v_lshlrev_b16 v13, 3, v86
    v_mad_i32_i24 v11, v14, s55, v82
    v_bitop3_b32 v12, v6, v13, v12 bitop3:0xca
    v_lshl_add_u32 v11, v11, 17, s40
    v_lshlrev_b16 v14, 8, v14
    v_lshrrev_b32 v13, 2, v86
    v_add_u32 v82, v12, v11
    v_bitop3_b32 v86, v5, v13, v14 bitop3:0xea
    ds_add_u32 v86, v2
    v_mul_hi_u32_u24 v14, 429497, v83
    v_lshrrev_b32 v12, 3, v87
    v_cos_f32 v10, v10
    v_lshlrev_b16 v13, 3, v87
    v_mad_i32_i24 v11, v14, s55, v83
    v_bitop3_b32 v12, v6, v13, v12 bitop3:0xca
    v_lshl_add_u32 v11, v11, 17, s40
    v_lshlrev_b16 v14, 8, v14
    v_lshrrev_b32 v13, 2, v87
    v_add_u32 v83, v12, v11
    v_bitop3_b32 v87, v5, v13, v14 bitop3:0xea
    ds_add_u32 v87, v2
    v_cvt_pk_bf16_f32 v89, v9, v10
    v_perm_b32 v12, v89, v89, s41
    v_bitop3_b32 v82, v4, v12, v82 bitop3:0xca
    v_perm_b32 v13, v89, v89, s42
    v_bitop3_b32 v83, v4, v13, v83 bitop3:0xca
    s_waitcnt vmcnt(5)
    v_lshlrev_b32 v7, 16, v90
    v_and_b32 v8, 0xffff0000, v90
    v_lshlrev_b32 v9, 16, v91
    v_and_b32 v10, 0xffff0000, v91
    v_mul_f32 v7, 0.15915494, v7
    v_mul_f32 v8, 0.15915494, v8
    v_mul_f32 v9, 0.15915494, v9
    v_mul_f32 v10, 0.15915494, v10
    v_mul_hi_u32_u24 v14, 429497, v48
    v_lshrrev_b32 v12, 3, v92
    v_cos_f32 v7, v7
    v_lshlrev_b16 v13, 3, v92
    v_mad_i32_i24 v11, v14, s55, v48
    v_bitop3_b32 v12, v6, v13, v12 bitop3:0xca
    v_lshl_add_u32 v11, v11, 17, s40
    v_lshlrev_b16 v14, 8, v14
    v_lshrrev_b32 v13, 2, v92
    v_add_u32 v48, v12, v11
    v_bitop3_b32 v92, v5, v13, v14 bitop3:0xea
    ds_add_u32 v92, v2
    v_mul_hi_u32_u24 v14, 429497, v49
    v_lshrrev_b32 v12, 3, v93
    v_cos_f32 v8, v8
    v_lshlrev_b16 v13, 3, v93
    v_mad_i32_i24 v11, v14, s55, v49
    v_bitop3_b32 v12, v6, v13, v12 bitop3:0xca
    v_lshl_add_u32 v11, v11, 17, s40
    v_lshlrev_b16 v14, 8, v14
    v_lshrrev_b32 v13, 2, v93
    v_add_u32 v49, v12, v11
    v_bitop3_b32 v93, v5, v13, v14 bitop3:0xea
    ds_add_u32 v93, v2
    v_cvt_pk_bf16_f32 v90, v7, v8
    v_perm_b32 v12, v90, v90, s41
    v_bitop3_b32 v48, v4, v12, v48 bitop3:0xca
    v_perm_b32 v13, v90, v90, s42
    v_bitop3_b32 v49, v4, v13, v49 bitop3:0xca
    v_mul_hi_u32_u24 v14, 429497, v50
    v_lshrrev_b32 v12, 3, v94
    v_cos_f32 v9, v9
    v_lshlrev_b16 v13, 3, v94
    v_mad_i32_i24 v11, v14, s55, v50
    v_bitop3_b32 v12, v6, v13, v12 bitop3:0xca
    v_lshl_add_u32 v11, v11, 17, s40
    v_lshlrev_b16 v14, 8, v14
    v_lshrrev_b32 v13, 2, v94
    v_add_u32 v50, v12, v11
    v_bitop3_b32 v94, v5, v13, v14 bitop3:0xea
    ds_add_u32 v94, v2
    v_mul_hi_u32_u24 v14, 429497, v51
    v_lshrrev_b32 v12, 3, v95
    v_cos_f32 v10, v10
    v_lshlrev_b16 v13, 3, v95
    v_mad_i32_i24 v11, v14, s55, v51
    v_bitop3_b32 v12, v6, v13, v12 bitop3:0xca
    v_lshl_add_u32 v11, v11, 17, s40
    v_lshlrev_b16 v14, 8, v14
    v_lshrrev_b32 v13, 2, v95
    v_add_u32 v51, v12, v11
    v_bitop3_b32 v95, v5, v13, v14 bitop3:0xea
    ds_add_u32 v95, v2
    v_cvt_pk_bf16_f32 v91, v9, v10
    v_perm_b32 v12, v91, v91, s41
    v_bitop3_b32 v50, v4, v12, v50 bitop3:0xca
    v_perm_b32 v13, v91, v91, s42
    v_bitop3_b32 v51, v4, v13, v51 bitop3:0xca
    v_lshrrev_b32 v8, 2, v0
    v_and_b32 v7, 0x3c00, v0
    v_bitop3_b32 v7, v5, v8, v7 bitop3:0xea
    s_waitcnt lgkmcnt(0)
    s_barrier
    ds_read2st64_b32 v[8:9], v7 offset0:0 offset1:1
    ds_read2st64_b32 v[10:11], v7 offset0:2 offset1:3
    s_add_u32 s45, s33, 0x2400000
    buffer_load_dwordx4 v[100:103], v0, s[12:15], s45 offen nt
    s_waitcnt lgkmcnt(0)
    v_lshl_or_b32 v12, v9, 16, v8
    v_lshl_or_b32 v13, v11, 16, v10
    v_mov_b32 v14, v12
    v_mov_b32 v15, v13
    s_nop 0
    v_add_u32_dpp v14, v14, v14 row_shr:1 row_mask:0xf bank_mask:0xf bound_ctrl:1
    v_add_u32_dpp v15, v15, v15 row_shr:1 row_mask:0xf bank_mask:0xf bound_ctrl:1
    s_nop 0
    v_add_u32_dpp v14, v14, v14 row_shr:2 row_mask:0xf bank_mask:0xf bound_ctrl:1
    v_add_u32_dpp v15, v15, v15 row_shr:2 row_mask:0xf bank_mask:0xf bound_ctrl:1
    s_nop 0
    v_add_u32_dpp v14, v14, v14 row_shr:4 row_mask:0xf bank_mask:0xf bound_ctrl:1
    v_add_u32_dpp v15, v15, v15 row_shr:4 row_mask:0xf bank_mask:0xf bound_ctrl:1
    s_nop 0
    v_add_u32_dpp v14, v14, v14 row_shr:8 row_mask:0xf bank_mask:0xf bound_ctrl:1
    v_add_u32_dpp v15, v15, v15 row_shr:8 row_mask:0xf bank_mask:0xf bound_ctrl:1
    s_nop 0
    v_add_u32_dpp v14, v14, v14 row_bcast:15 row_mask:0xa bank_mask:0xf
    v_add_u32_dpp v15, v15, v15 row_bcast:15 row_mask:0xa bank_mask:0xf
    s_nop 0
    v_add_u32_dpp v14, v14, v14 row_bcast:31 row_mask:0xc bank_mask:0xf
    v_add_u32_dpp v15, v15, v15 row_bcast:31 row_mask:0xc bank_mask:0xf
    v_readlane_b32 s48, v14, 63
    v_readlane_b32 s49, v15, 63
    s_lshl_b32 s54, s32, 2
    v_mov_b32 v8, s54
    s_and_b32 s50, s48, 0xffff
    s_lshr_b32 s51, s48, 16
    s_and_b32 s52, s49, 0xffff
    s_lshr_b32 s53, s49, 16
    s_add_u32 s51, s51, s50
    s_add_u32 s52, s52, s51
    s_add_u32 s53, s53, s52
    v_mov_b32 v9, s53
    s_mov_b64 exec, 1
    ds_write_b32 v8, v9 offset:16384
    s_mov_b64 exec, -1
    v_and_b32 v8, 60, v7
    s_waitcnt lgkmcnt(0)
    s_barrier
    ds_read_b32 v9, v8 offset:16384
    s_waitcnt lgkmcnt(0)
    v_add_u32_dpp v9, v9, v9 row_shr:1 row_mask:0xf bank_mask:0xf bound_ctrl:1
    s_nop 1
    v_add_u32_dpp v9, v9, v9 row_shr:2 row_mask:0xf bank_mask:0xf bound_ctrl:1
    s_nop 1
    v_add_u32_dpp v9, v9, v9 row_shr:4 row_mask:0xf bank_mask:0xf bound_ctrl:1
    s_nop 1
    v_add_u32_dpp v9, v9, v9 row_shr:8 row_mask:0xf bank_mask:0xf bound_ctrl:1
    s_nop 0
    v_readlane_b32 s54, v9, s32
    s_sub_u32 s54, s54, s53
    s_add_u32 s50, s50, s54
    s_add_u32 s51, s51, s54
    s_add_u32 s52, s52, s54
    s_pack_ll_b32_b16 s48, s54, s50
    s_pack_ll_b32_b16 s49, s51, s52
    v_add_u32 v14, s48, v14
    v_add_u32 v15, s49, v15
    v_sub_u32 v12, v14, v12
    v_sub_u32 v13, v15, v13
    v_and_b32 v8, 0xffff, v12
    v_lshrrev_b32 v9, 16, v12
    v_and_b32 v10, 0xffff, v13
    v_lshrrev_b32 v11, 16, v13
    ds_write2st64_b32 v7, v8, v9 offset0:0 offset1:1
    ds_write2st64_b32 v7, v10, v11 offset0:2 offset1:3
    v_and_b32 v8, 0x3f0, v0
    v_lshl_add_u32 v8, v8, 1, s36
    ds_write_b64 v8, v[12:13] offset:20480
    s_bitset0_b64 exec, 63
    s_not_b64 exec, exec
    ds_write_b64 v8, v[14:15] offset:20512
    s_mov_b64 exec, -1
    s_waitcnt lgkmcnt(0)
    s_barrier
    s_setprio 3
    ds_add_rtn_u32 v108, v108, v2
    ds_add_rtn_u32 v109, v109, v2
    ds_add_rtn_u32 v110, v110, v2
    ds_add_rtn_u32 v111, v111, v2
    ds_read_b128 v[12:15], v0 offset:20480
    v_cmp_gt_u32 vcc, 8448, v0
    ds_add_rtn_u32 v20, v20, v2
    ds_add_rtn_u32 v21, v21, v2
    ds_add_rtn_u32 v22, v22, v2
    ds_add_rtn_u32 v23, v23, v2
    s_setprio 2
    ds_add_rtn_u32 v28, v28, v2
    ds_add_rtn_u32 v29, v29, v2
    ds_add_rtn_u32 v30, v30, v2
    ds_add_rtn_u32 v31, v31, v2
    s_waitcnt lgkmcnt(8)
    s_cbranch_vccz L1_p1
    s_add_u32 s46, s35, 0x0
    s_mov_b64 exec, vcc
    buffer_store_dwordx4 v[12:15], v0, s[24:27], s46 offen sc1
    s_mov_b64 exec, -1
L1_p1:
    s_add_u32 s47, s33, 0x2800000
    buffer_load_dwordx4 v[120:123], v0, s[8:11], s47 offen nt
    ds_add_rtn_u32 v36, v36, v2
    ds_add_rtn_u32 v37, v37, v2
    ds_add_rtn_u32 v38, v38, v2
    ds_add_rtn_u32 v39, v39, v2
    s_setprio 1
    ds_add_rtn_u32 v44, v44, v2
    ds_add_rtn_u32 v45, v45, v2
    ds_add_rtn_u32 v46, v46, v2
    ds_add_rtn_u32 v47, v47, v2
    ds_add_rtn_u32 v76, v76, v2
    ds_add_rtn_u32 v77, v77, v2
    ds_add_rtn_u32 v78, v78, v2
    ds_add_rtn_u32 v79, v79, v2
    s_add_u32 s44, s33, 0x2800000
    buffer_load_dwordx4 v[116:119], v0, s[12:15], s44 offen nt
    s_setprio 0
    ds_add_rtn_u32 v84, v84, v2
    ds_add_rtn_u32 v85, v85, v2
    ds_add_rtn_u32 v86, v86, v2
    ds_add_rtn_u32 v87, v87, v2
    ds_add_rtn_u32 v92, v92, v2
    ds_add_rtn_u32 v93, v93, v2
    ds_add_rtn_u32 v94, v94, v2
    ds_add_rtn_u32 v95, v95, v2
    s_waitcnt lgkmcnt(0)
    s_barrier
    s_setprio 3
    v_and_b32 v7, -4, v108
    v_lshl_add_u32 v8, v108, 2, v7
    ds_write_b32 v8, v124
    v_lshl_add_u32 v7, v7, 2, v108
    ds_write_b8 v7, v16 offset:16
    v_and_b32 v9, -4, v109
    v_lshl_add_u32 v10, v109, 2, v9
    ds_write_b32 v10, v125
    v_lshl_add_u32 v9, v9, 2, v109
    ds_write_b8_d16_hi v9, v16 offset:16
    v_and_b32 v7, -4, v110
    v_lshl_add_u32 v8, v110, 2, v7
    ds_write_b32 v8, v126
    v_lshl_add_u32 v7, v7, 2, v110
    ds_write_b8 v7, v17 offset:16
    v_and_b32 v9, -4, v111
    v_lshl_add_u32 v10, v111, 2, v9
    ds_write_b32 v10, v127
    v_lshl_add_u32 v9, v9, 2, v111
    ds_write_b8_d16_hi v9, v17 offset:16
    s_add_u32 s45, s34, 0x1400000
    buffer_load_dwordx2 v[112:113], v1, s[16:19], s45 offen nt
    s_add_u32 s46, s34, 0x1600000
    buffer_load_dwordx2 v[114:115], v1, s[16:19], s46 offen nt
    s_add_u32 s47, s33, 0x2c00000
    buffer_load_dwordx4 v[124:127], v0, s[8:11], s47 offen nt
    v_and_b32 v7, -4, v20
    v_lshl_add_u32 v8, v20, 2, v7
    ds_write_b32 v8, v60
    v_lshl_add_u32 v7, v7, 2, v20
    ds_write_b8 v7, v18 offset:16
    v_and_b32 v9, -4, v21
    v_lshl_add_u32 v10, v21, 2, v9
    ds_write_b32 v10, v61
    v_lshl_add_u32 v9, v9, 2, v21
    ds_write_b8_d16_hi v9, v18 offset:16
    v_and_b32 v7, -4, v22
    v_lshl_add_u32 v8, v22, 2, v7
    ds_write_b32 v8, v62
    v_lshl_add_u32 v7, v7, 2, v22
    ds_write_b8 v7, v19 offset:16
    v_and_b32 v9, -4, v23
    v_lshl_add_u32 v10, v23, 2, v9
    ds_write_b32 v10, v63
    v_lshl_add_u32 v9, v9, 2, v23
    ds_write_b8_d16_hi v9, v19 offset:16
    s_add_u32 s44, s33, 0x2c00000
    buffer_load_dwordx4 v[108:111], v0, s[12:15], s44 offen nt
    s_setprio 2
    v_and_b32 v7, -4, v28
    v_lshl_add_u32 v8, v28, 2, v7
    ds_write_b32 v8, v24
    v_lshl_add_u32 v7, v7, 2, v28
    ds_write_b8 v7, v64 offset:16
    v_and_b32 v9, -4, v29
    v_lshl_add_u32 v10, v29, 2, v9
    ds_write_b32 v10, v25
    v_lshl_add_u32 v9, v9, 2, v29
    ds_write_b8_d16_hi v9, v64 offset:16
    v_and_b32 v7, -4, v30
    v_lshl_add_u32 v8, v30, 2, v7
    ds_write_b32 v8, v26
    v_lshl_add_u32 v7, v7, 2, v30
    ds_write_b8 v7, v65 offset:16
    v_and_b32 v9, -4, v31
    v_lshl_add_u32 v10, v31, 2, v9
    ds_write_b32 v10, v27
    v_lshl_add_u32 v9, v9, 2, v31
    ds_write_b8_d16_hi v9, v65 offset:16
    s_add_u32 s45, s33, 0x3000000
    buffer_load_dwordx4 v[60:63], v0, s[8:11], s45 offen nt
    s_add_u32 s46, s33, 0x3000000
    buffer_load_dwordx4 v[20:23], v0, s[12:15], s46 offen nt
    v_and_b32 v7, -4, v36
    v_lshl_add_u32 v8, v36, 2, v7
    ds_write_b32 v8, v32
    v_lshl_add_u32 v7, v7, 2, v36
    ds_write_b8 v7, v66 offset:16
    v_and_b32 v9, -4, v37
    v_lshl_add_u32 v10, v37, 2, v9
    ds_write_b32 v10, v33
    v_lshl_add_u32 v9, v9, 2, v37
    ds_write_b8_d16_hi v9, v66 offset:16
    v_and_b32 v7, -4, v38
    v_lshl_add_u32 v8, v38, 2, v7
    ds_write_b32 v8, v34
    v_lshl_add_u32 v7, v7, 2, v38
    ds_write_b8 v7, v67 offset:16
    v_and_b32 v9, -4, v39
    v_lshl_add_u32 v10, v39, 2, v9
    ds_write_b32 v10, v35
    v_lshl_add_u32 v9, v9, 2, v39
    ds_write_b8_d16_hi v9, v67 offset:16
    s_add_u32 s47, s34, 0x1800000
    buffer_load_dwordx2 v[16:17], v1, s[16:19], s47 offen nt
    s_add_u32 s44, s34, 0x1a00000
    buffer_load_dwordx2 v[18:19], v1, s[16:19], s44 offen nt
    s_setprio 1
    v_and_b32 v7, -4, v44
    v_lshl_add_u32 v8, v44, 2, v7
    ds_write_b32 v8, v40
    v_lshl_add_u32 v7, v7, 2, v44
    ds_write_b8 v7, v68 offset:16
    v_and_b32 v9, -4, v45
    v_lshl_add_u32 v10, v45, 2, v9
    ds_write_b32 v10, v41
    v_lshl_add_u32 v9, v9, 2, v45
    ds_write_b8_d16_hi v9, v68 offset:16
    v_and_b32 v7, -4, v46
    v_lshl_add_u32 v8, v46, 2, v7
    ds_write_b32 v8, v42
    v_lshl_add_u32 v7, v7, 2, v46
    ds_write_b8 v7, v69 offset:16
    v_and_b32 v9, -4, v47
    v_lshl_add_u32 v10, v47, 2, v9
    ds_write_b32 v10, v43
    v_lshl_add_u32 v9, v9, 2, v47
    ds_write_b8_d16_hi v9, v69 offset:16
    s_add_u32 s45, s33, 0x3400000
    buffer_load_dwordx4 v[24:27], v0, s[8:11], s45 offen nt
    v_and_b32 v7, -4, v76
    v_lshl_add_u32 v8, v76, 2, v7
    ds_write_b32 v8, v72
    v_lshl_add_u32 v7, v7, 2, v76
    ds_write_b8 v7, v70 offset:16
    v_and_b32 v9, -4, v77
    v_lshl_add_u32 v10, v77, 2, v9
    ds_write_b32 v10, v73
    v_lshl_add_u32 v9, v9, 2, v77
    ds_write_b8_d16_hi v9, v70 offset:16
    v_and_b32 v7, -4, v78
    v_lshl_add_u32 v8, v78, 2, v7
    ds_write_b32 v8, v74
    v_lshl_add_u32 v7, v7, 2, v78
    ds_write_b8 v7, v71 offset:16
    v_and_b32 v9, -4, v79
    v_lshl_add_u32 v10, v79, 2, v9
    ds_write_b32 v10, v75
    v_lshl_add_u32 v9, v9, 2, v79
    ds_write_b8_d16_hi v9, v71 offset:16
    s_add_u32 s46, s33, 0x3400000
    buffer_load_dwordx4 v[28:31], v0, s[12:15], s46 offen nt
    s_add_u32 s47, s33, 0x3800000
    buffer_load_dwordx4 v[32:35], v0, s[8:11], s47 offen nt
    s_setprio 0
    v_and_b32 v7, -4, v84
    v_lshl_add_u32 v8, v84, 2, v7
    ds_write_b32 v8, v80
    v_lshl_add_u32 v7, v7, 2, v84
    ds_write_b8 v7, v88 offset:16
    v_and_b32 v9, -4, v85
    v_lshl_add_u32 v10, v85, 2, v9
    ds_write_b32 v10, v81
    v_lshl_add_u32 v9, v9, 2, v85
    ds_write_b8_d16_hi v9, v88 offset:16
    v_and_b32 v7, -4, v86
    v_lshl_add_u32 v8, v86, 2, v7
    ds_write_b32 v8, v82
    v_lshl_add_u32 v7, v7, 2, v86
    ds_write_b8 v7, v89 offset:16
    v_and_b32 v9, -4, v87
    v_lshl_add_u32 v10, v87, 2, v9
    ds_write_b32 v10, v83
    v_lshl_add_u32 v9, v9, 2, v87
    ds_write_b8_d16_hi v9, v89 offset:16
    s_add_u32 s44, s33, 0x3800000
    buffer_load_dwordx4 v[36:39], v0, s[12:15], s44 offen nt
    v_and_b32 v7, -4, v92
    v_lshl_add_u32 v8, v92, 2, v7
    ds_write_b32 v8, v48
    v_lshl_add_u32 v7, v7, 2, v92
    ds_write_b8 v7, v90 offset:16
    v_and_b32 v9, -4, v93
    v_lshl_add_u32 v10, v93, 2, v9
    ds_write_b32 v10, v49
    v_lshl_add_u32 v9, v9, 2, v93
    ds_write_b8_d16_hi v9, v90 offset:16
    v_and_b32 v7, -4, v94
    v_lshl_add_u32 v8, v94, 2, v7
    ds_write_b32 v8, v50
    v_lshl_add_u32 v7, v7, 2, v94
    ds_write_b8 v7, v91 offset:16
    v_and_b32 v9, -4, v95
    v_lshl_add_u32 v10, v95, 2, v9
    ds_write_b32 v10, v51
    v_lshl_add_u32 v9, v9, 2, v95
    ds_write_b8_d16_hi v9, v91 offset:16
    s_add_u32 s45, s34, 0x1c00000
    buffer_load_dwordx2 v[64:65], v1, s[16:19], s45 offen nt
    s_add_u32 s46, s34, 0x1e00000
    buffer_load_dwordx2 v[66:67], v1, s[16:19], s46 offen nt
    v_add_u32 v7, 0x10000, v0
    v_add_u32 v12, 0x20000, v0
    v_mov_b32 v8, 0
    v_mov_b32 v9, 0
    v_mov_b32 v10, 0
    v_mov_b32 v11, 0
    s_waitcnt lgkmcnt(0)
    s_barrier
    ds_read_b128 v[40:43], v0 offset:0
    ds_write_b128 v0, v[8:11]
    ds_read_b128 v[44:47], v0 offset:16384
    ds_read_b128 v[72:75], v0 offset:32768
    ds_read_b128 v[76:79], v0 offset:49152
    ds_read_b128 v[68:71], v7 offset:0
    ds_read_b128 v[80:83], v7 offset:16384
    ds_read_b128 v[84:87], v7 offset:32768
    ds_read_b128 v[48:51], v7 offset:49152
    ds_read_b128 v[92:95], v12 offset:0
    ds_read_b128 v[88:91], v12 offset:16384
    s_waitcnt lgkmcnt(0)
    s_barrier
    s_setprio 3
    s_add_u32 s47, s35, 0x0
    buffer_store_dwordx4 v[40:43], v0, s[20:23], s47 offen sc1
    s_add_u32 s44, s33, 0x3c00000
    s_nop 0
    buffer_load_dwordx4 v[40:43], v0, s[8:11], s44 offen nt
    s_add_u32 s45, s35, 0x4000
    buffer_store_dwordx4 v[44:47], v0, s[20:23], s45 offen sc1
    s_add_u32 s46, s33, 0x3c00000
    s_nop 0
    buffer_load_dwordx4 v[44:47], v0, s[12:15], s46 offen nt
    s_waitcnt vmcnt(22)
    v_lshlrev_b32 v7, 16, v104
    v_and_b32 v8, 0xffff0000, v104
    v_lshlrev_b32 v9, 16, v105
    v_and_b32 v10, 0xffff0000, v105
    v_mul_f32 v7, 0.15915494, v7
    v_mul_f32 v8, 0.15915494, v8
    v_mul_f32 v9, 0.15915494, v9
    v_mul_f32 v10, 0.15915494, v10
    v_mul_hi_u32_u24 v14, 429497, v96
    v_lshrrev_b32 v12, 3, v52
    v_cos_f32 v7, v7
    v_lshlrev_b16 v13, 3, v52
    v_mad_i32_i24 v11, v14, s55, v96
    v_bitop3_b32 v12, v6, v13, v12 bitop3:0xca
    v_lshl_add_u32 v11, v11, 17, s40
    v_lshlrev_b16 v14, 8, v14
    v_lshrrev_b32 v13, 2, v52
    v_add_u32 v96, v12, v11
    v_bitop3_b32 v52, v5, v13, v14 bitop3:0xea
    ds_add_u32 v52, v2
    v_mul_hi_u32_u24 v14, 429497, v97
    v_lshrrev_b32 v12, 3, v53
    v_cos_f32 v8, v8
    v_lshlrev_b16 v13, 3, v53
    v_mad_i32_i24 v11, v14, s55, v97
    v_bitop3_b32 v12, v6, v13, v12 bitop3:0xca
    v_lshl_add_u32 v11, v11, 17, s40
    v_lshlrev_b16 v14, 8, v14
    v_lshrrev_b32 v13, 2, v53
    v_add_u32 v97, v12, v11
    v_bitop3_b32 v53, v5, v13, v14 bitop3:0xea
    ds_add_u32 v53, v2
    v_cvt_pk_bf16_f32 v104, v7, v8
    v_perm_b32 v12, v104, v104, s41
    v_bitop3_b32 v96, v4, v12, v96 bitop3:0xca
    v_perm_b32 v13, v104, v104, s42
    v_bitop3_b32 v97, v4, v13, v97 bitop3:0xca
    v_mul_hi_u32_u24 v14, 429497, v98
    v_lshrrev_b32 v12, 3, v54
    v_cos_f32 v9, v9
    v_lshlrev_b16 v13, 3, v54
    v_mad_i32_i24 v11, v14, s55, v98
    v_bitop3_b32 v12, v6, v13, v12 bitop3:0xca
    v_lshl_add_u32 v11, v11, 17, s40
    v_lshlrev_b16 v14, 8, v14
    v_lshrrev_b32 v13, 2, v54
    v_add_u32 v98, v12, v11
    v_bitop3_b32 v54, v5, v13, v14 bitop3:0xea
    ds_add_u32 v54, v2
    v_mul_hi_u32_u24 v14, 429497, v99
    v_lshrrev_b32 v12, 3, v55
    v_cos_f32 v10, v10
    v_lshlrev_b16 v13, 3, v55
    v_mad_i32_i24 v11, v14, s55, v99
    v_bitop3_b32 v12, v6, v13, v12 bitop3:0xca
    v_lshl_add_u32 v11, v11, 17, s40
    v_lshlrev_b16 v14, 8, v14
    v_lshrrev_b32 v13, 2, v55
    v_add_u32 v99, v12, v11
    v_bitop3_b32 v55, v5, v13, v14 bitop3:0xea
    ds_add_u32 v55, v2
    v_cvt_pk_bf16_f32 v105, v9, v10
    v_perm_b32 v12, v105, v105, s41
    v_bitop3_b32 v98, v4, v12, v98 bitop3:0xca
    v_perm_b32 v13, v105, v105, s42
    v_bitop3_b32 v99, v4, v13, v99 bitop3:0xca
    s_waitcnt vmcnt(20)
    v_lshlrev_b32 v7, 16, v106
    v_and_b32 v8, 0xffff0000, v106
    v_lshlrev_b32 v9, 16, v107
    v_and_b32 v10, 0xffff0000, v107
    v_mul_f32 v7, 0.15915494, v7
    v_mul_f32 v8, 0.15915494, v8
    v_mul_f32 v9, 0.15915494, v9
    v_mul_f32 v10, 0.15915494, v10
    v_mul_hi_u32_u24 v14, 429497, v56
    v_lshrrev_b32 v12, 3, v100
    v_cos_f32 v7, v7
    v_lshlrev_b16 v13, 3, v100
    v_mad_i32_i24 v11, v14, s55, v56
    v_bitop3_b32 v12, v6, v13, v12 bitop3:0xca
    v_lshl_add_u32 v11, v11, 17, s40
    v_lshlrev_b16 v14, 8, v14
    v_lshrrev_b32 v13, 2, v100
    v_add_u32 v56, v12, v11
    v_bitop3_b32 v100, v5, v13, v14 bitop3:0xea
    ds_add_u32 v100, v2
    v_mul_hi_u32_u24 v14, 429497, v57
    v_lshrrev_b32 v12, 3, v101
    v_cos_f32 v8, v8
    v_lshlrev_b16 v13, 3, v101
    v_mad_i32_i24 v11, v14, s55, v57
    v_bitop3_b32 v12, v6, v13, v12 bitop3:0xca
    v_lshl_add_u32 v11, v11, 17, s40
    v_lshlrev_b16 v14, 8, v14
    v_lshrrev_b32 v13, 2, v101
    v_add_u32 v57, v12, v11
    v_bitop3_b32 v101, v5, v13, v14 bitop3:0xea
    ds_add_u32 v101, v2
    v_cvt_pk_bf16_f32 v106, v7, v8
    v_perm_b32 v12, v106, v106, s41
    v_bitop3_b32 v56, v4, v12, v56 bitop3:0xca
    v_perm_b32 v13, v106, v106, s42
    v_bitop3_b32 v57, v4, v13, v57 bitop3:0xca
    v_mul_hi_u32_u24 v14, 429497, v58
    v_lshrrev_b32 v12, 3, v102
    v_cos_f32 v9, v9
    v_lshlrev_b16 v13, 3, v102
    v_mad_i32_i24 v11, v14, s55, v58
    v_bitop3_b32 v12, v6, v13, v12 bitop3:0xca
    v_lshl_add_u32 v11, v11, 17, s40
    v_lshlrev_b16 v14, 8, v14
    v_lshrrev_b32 v13, 2, v102
    v_add_u32 v58, v12, v11
    v_bitop3_b32 v102, v5, v13, v14 bitop3:0xea
    ds_add_u32 v102, v2
    v_mul_hi_u32_u24 v14, 429497, v59
    v_lshrrev_b32 v12, 3, v103
    v_cos_f32 v10, v10
    v_lshlrev_b16 v13, 3, v103
    v_mad_i32_i24 v11, v14, s55, v59
    v_bitop3_b32 v12, v6, v13, v12 bitop3:0xca
    v_lshl_add_u32 v11, v11, 17, s40
    v_lshlrev_b16 v14, 8, v14
    v_lshrrev_b32 v13, 2, v103
    v_add_u32 v59, v12, v11
    v_bitop3_b32 v103, v5, v13, v14 bitop3:0xea
    ds_add_u32 v103, v2
    v_cvt_pk_bf16_f32 v107, v9, v10
    v_perm_b32 v12, v107, v107, s41
    v_bitop3_b32 v58, v4, v12, v58 bitop3:0xca
    v_perm_b32 v13, v107, v107, s42
    v_bitop3_b32 v59, v4, v13, v59 bitop3:0xca
    s_setprio 2
    s_waitcnt vmcnt(16)
    v_lshlrev_b32 v7, 16, v112
    v_and_b32 v8, 0xffff0000, v112
    v_lshlrev_b32 v9, 16, v113
    v_and_b32 v10, 0xffff0000, v113
    v_mul_f32 v7, 0.15915494, v7
    v_mul_f32 v8, 0.15915494, v8
    v_mul_f32 v9, 0.15915494, v9
    v_mul_f32 v10, 0.15915494, v10
    v_mul_hi_u32_u24 v14, 429497, v120
    v_lshrrev_b32 v12, 3, v116
    v_cos_f32 v7, v7
    v_lshlrev_b16 v13, 3, v116
    v_mad_i32_i24 v11, v14, s55, v120
    v_bitop3_b32 v12, v6, v13, v12 bitop3:0xca
    v_lshl_add_u32 v11, v11, 17, s40
    v_lshlrev_b16 v14, 8, v14
    v_lshrrev_b32 v13, 2, v116
    v_add_u32 v120, v12, v11
    v_bitop3_b32 v116, v5, v13, v14 bitop3:0xea
    ds_add_u32 v116, v2
    v_mul_hi_u32_u24 v14, 429497, v121
    v_lshrrev_b32 v12, 3, v117
    v_cos_f32 v8, v8
    v_lshlrev_b16 v13, 3, v117
    v_mad_i32_i24 v11, v14, s55, v121
    v_bitop3_b32 v12, v6, v13, v12 bitop3:0xca
    v_lshl_add_u32 v11, v11, 17, s40
    v_lshlrev_b16 v14, 8, v14
    v_lshrrev_b32 v13, 2, v117
    v_add_u32 v121, v12, v11
    v_bitop3_b32 v117, v5, v13, v14 bitop3:0xea
    ds_add_u32 v117, v2
    v_cvt_pk_bf16_f32 v112, v7, v8
    v_perm_b32 v12, v112, v112, s41
    v_bitop3_b32 v120, v4, v12, v120 bitop3:0xca
    v_perm_b32 v13, v112, v112, s42
    v_bitop3_b32 v121, v4, v13, v121 bitop3:0xca
    v_mul_hi_u32_u24 v14, 429497, v122
    v_lshrrev_b32 v12, 3, v118
    v_cos_f32 v9, v9
    v_lshlrev_b16 v13, 3, v118
    v_mad_i32_i24 v11, v14, s55, v122
    v_bitop3_b32 v12, v6, v13, v12 bitop3:0xca
    v_lshl_add_u32 v11, v11, 17, s40
    v_lshlrev_b16 v14, 8, v14
    v_lshrrev_b32 v13, 2, v118
    v_add_u32 v122, v12, v11
    v_bitop3_b32 v118, v5, v13, v14 bitop3:0xea
    ds_add_u32 v118, v2
    v_mul_hi_u32_u24 v14, 429497, v123
    v_lshrrev_b32 v12, 3, v119
    v_cos_f32 v10, v10
    v_lshlrev_b16 v13, 3, v119
    v_mad_i32_i24 v11, v14, s55, v123
    v_bitop3_b32 v12, v6, v13, v12 bitop3:0xca
    v_lshl_add_u32 v11, v11, 17, s40
    v_lshlrev_b16 v14, 8, v14
    v_lshrrev_b32 v13, 2, v119
    v_add_u32 v123, v12, v11
    v_bitop3_b32 v119, v5, v13, v14 bitop3:0xea
    ds_add_u32 v119, v2
    v_cvt_pk_bf16_f32 v113, v9, v10
    v_perm_b32 v12, v113, v113, s41
    v_bitop3_b32 v122, v4, v12, v122 bitop3:0xca
    v_perm_b32 v13, v113, v113, s42
    v_bitop3_b32 v123, v4, v13, v123 bitop3:0xca
    s_add_u32 s47, s35, 0x8000
    buffer_store_dwordx4 v[72:75], v0, s[20:23], s47 offen sc1
    s_add_u32 s44, s33, 0x4000000
    s_nop 0
    buffer_load_dwordx4 v[72:75], v0, s[8:11], s44 offen nt
    s_waitcnt vmcnt(16)
    v_lshlrev_b32 v7, 16, v114
    v_and_b32 v8, 0xffff0000, v114
    v_lshlrev_b32 v9, 16, v115
    v_and_b32 v10, 0xffff0000, v115
    v_mul_f32 v7, 0.15915494, v7
    v_mul_f32 v8, 0.15915494, v8
    v_mul_f32 v9, 0.15915494, v9
    v_mul_f32 v10, 0.15915494, v10
    v_mul_hi_u32_u24 v14, 429497, v124
    v_lshrrev_b32 v12, 3, v108
    v_cos_f32 v7, v7
    v_lshlrev_b16 v13, 3, v108
    v_mad_i32_i24 v11, v14, s55, v124
    v_bitop3_b32 v12, v6, v13, v12 bitop3:0xca
    v_lshl_add_u32 v11, v11, 17, s40
    v_lshlrev_b16 v14, 8, v14
    v_lshrrev_b32 v13, 2, v108
    v_add_u32 v124, v12, v11
    v_bitop3_b32 v108, v5, v13, v14 bitop3:0xea
    ds_add_u32 v108, v2
    v_mul_hi_u32_u24 v14, 429497, v125
    v_lshrrev_b32 v12, 3, v109
    v_cos_f32 v8, v8
    v_lshlrev_b16 v13, 3, v109
    v_mad_i32_i24 v11, v14, s55, v125
    v_bitop3_b32 v12, v6, v13, v12 bitop3:0xca
    v_lshl_add_u32 v11, v11, 17, s40
    v_lshlrev_b16 v14, 8, v14
    v_lshrrev_b32 v13, 2, v109
    v_add_u32 v125, v12, v11
    v_bitop3_b32 v109, v5, v13, v14 bitop3:0xea
    ds_add_u32 v109, v2
    v_cvt_pk_bf16_f32 v114, v7, v8
    v_perm_b32 v12, v114, v114, s41
    v_bitop3_b32 v124, v4, v12, v124 bitop3:0xca
    v_perm_b32 v13, v114, v114, s42
    v_bitop3_b32 v125, v4, v13, v125 bitop3:0xca
    v_mul_hi_u32_u24 v14, 429497, v126
    v_lshrrev_b32 v12, 3, v110
    v_cos_f32 v9, v9
    v_lshlrev_b16 v13, 3, v110
    v_mad_i32_i24 v11, v14, s55, v126
    v_bitop3_b32 v12, v6, v13, v12 bitop3:0xca
    v_lshl_add_u32 v11, v11, 17, s40
    v_lshlrev_b16 v14, 8, v14
    v_lshrrev_b32 v13, 2, v110
    v_add_u32 v126, v12, v11
    v_bitop3_b32 v110, v5, v13, v14 bitop3:0xea
    ds_add_u32 v110, v2
    v_mul_hi_u32_u24 v14, 429497, v127
    v_lshrrev_b32 v12, 3, v111
    v_cos_f32 v10, v10
    v_lshlrev_b16 v13, 3, v111
    v_mad_i32_i24 v11, v14, s55, v127
    v_bitop3_b32 v12, v6, v13, v12 bitop3:0xca
    v_lshl_add_u32 v11, v11, 17, s40
    v_lshlrev_b16 v14, 8, v14
    v_lshrrev_b32 v13, 2, v111
    v_add_u32 v127, v12, v11
    v_bitop3_b32 v111, v5, v13, v14 bitop3:0xea
    ds_add_u32 v111, v2
    v_cvt_pk_bf16_f32 v115, v9, v10
    v_perm_b32 v12, v115, v115, s41
    v_bitop3_b32 v126, v4, v12, v126 bitop3:0xca
    v_perm_b32 v13, v115, v115, s42
    v_bitop3_b32 v127, v4, v13, v127 bitop3:0xca
    s_setprio 1
    s_waitcnt vmcnt(12)
    v_lshlrev_b32 v7, 16, v16
    v_and_b32 v8, 0xffff0000, v16
    v_lshlrev_b32 v9, 16, v17
    v_and_b32 v10, 0xffff0000, v17
    v_mul_f32 v7, 0.15915494, v7
    v_mul_f32 v8, 0.15915494, v8
    v_mul_f32 v9, 0.15915494, v9
    v_mul_f32 v10, 0.15915494, v10
    v_mul_hi_u32_u24 v14, 429497, v60
    v_lshrrev_b32 v12, 3, v20
    v_cos_f32 v7, v7
    v_lshlrev_b16 v13, 3, v20
    v_mad_i32_i24 v11, v14, s55, v60
    v_bitop3_b32 v12, v6, v13, v12 bitop3:0xca
    v_lshl_add_u32 v11, v11, 17, s40
    v_lshlrev_b16 v14, 8, v14
    v_lshrrev_b32 v13, 2, v20
    v_add_u32 v60, v12, v11
    v_bitop3_b32 v20, v5, v13, v14 bitop3:0xea
    ds_add_u32 v20, v2
    v_mul_hi_u32_u24 v14, 429497, v61
    v_lshrrev_b32 v12, 3, v21
    v_cos_f32 v8, v8
    v_lshlrev_b16 v13, 3, v21
    v_mad_i32_i24 v11, v14, s55, v61
    v_bitop3_b32 v12, v6, v13, v12 bitop3:0xca
    v_lshl_add_u32 v11, v11, 17, s40
    v_lshlrev_b16 v14, 8, v14
    v_lshrrev_b32 v13, 2, v21
    v_add_u32 v61, v12, v11
    v_bitop3_b32 v21, v5, v13, v14 bitop3:0xea
    ds_add_u32 v21, v2
    v_cvt_pk_bf16_f32 v16, v7, v8
    v_perm_b32 v12, v16, v16, s41
    v_bitop3_b32 v60, v4, v12, v60 bitop3:0xca
    v_perm_b32 v13, v16, v16, s42
    v_bitop3_b32 v61, v4, v13, v61 bitop3:0xca
    v_mul_hi_u32_u24 v14, 429497, v62
    v_lshrrev_b32 v12, 3, v22
    v_cos_f32 v9, v9
    v_lshlrev_b16 v13, 3, v22
    v_mad_i32_i24 v11, v14, s55, v62
    v_bitop3_b32 v12, v6, v13, v12 bitop3:0xca
    v_lshl_add_u32 v11, v11, 17, s40
    v_lshlrev_b16 v14, 8, v14
    v_lshrrev_b32 v13, 2, v22
    v_add_u32 v62, v12, v11
    v_bitop3_b32 v22, v5, v13, v14 bitop3:0xea
    ds_add_u32 v22, v2
    v_mul_hi_u32_u24 v14, 429497, v63
    v_lshrrev_b32 v12, 3, v23
    v_cos_f32 v10, v10
    v_lshlrev_b16 v13, 3, v23
    v_mad_i32_i24 v11, v14, s55, v63
    v_bitop3_b32 v12, v6, v13, v12 bitop3:0xca
    v_lshl_add_u32 v11, v11, 17, s40
    v_lshlrev_b16 v14, 8, v14
    v_lshrrev_b32 v13, 2, v23
    v_add_u32 v63, v12, v11
    v_bitop3_b32 v23, v5, v13, v14 bitop3:0xea
    ds_add_u32 v23, v2
    v_cvt_pk_bf16_f32 v17, v9, v10
    v_perm_b32 v12, v17, v17, s41
    v_bitop3_b32 v62, v4, v12, v62 bitop3:0xca
    v_perm_b32 v13, v17, v17, s42
    v_bitop3_b32 v63, v4, v13, v63 bitop3:0xca
    s_waitcnt vmcnt(10)
    v_lshlrev_b32 v7, 16, v18
    v_and_b32 v8, 0xffff0000, v18
    v_lshlrev_b32 v9, 16, v19
    v_and_b32 v10, 0xffff0000, v19
    v_mul_f32 v7, 0.15915494, v7
    v_mul_f32 v8, 0.15915494, v8
    v_mul_f32 v9, 0.15915494, v9
    v_mul_f32 v10, 0.15915494, v10
    v_mul_hi_u32_u24 v14, 429497, v24
    v_lshrrev_b32 v12, 3, v28
    v_cos_f32 v7, v7
    v_lshlrev_b16 v13, 3, v28
    v_mad_i32_i24 v11, v14, s55, v24
    v_bitop3_b32 v12, v6, v13, v12 bitop3:0xca
    v_lshl_add_u32 v11, v11, 17, s40
    v_lshlrev_b16 v14, 8, v14
    v_lshrrev_b32 v13, 2, v28
    v_add_u32 v24, v12, v11
    v_bitop3_b32 v28, v5, v13, v14 bitop3:0xea
    ds_add_u32 v28, v2
    v_mul_hi_u32_u24 v14, 429497, v25
    v_lshrrev_b32 v12, 3, v29
    v_cos_f32 v8, v8
    v_lshlrev_b16 v13, 3, v29
    v_mad_i32_i24 v11, v14, s55, v25
    v_bitop3_b32 v12, v6, v13, v12 bitop3:0xca
    v_lshl_add_u32 v11, v11, 17, s40
    v_lshlrev_b16 v14, 8, v14
    v_lshrrev_b32 v13, 2, v29
    v_add_u32 v25, v12, v11
    v_bitop3_b32 v29, v5, v13, v14 bitop3:0xea
    ds_add_u32 v29, v2
    v_cvt_pk_bf16_f32 v18, v7, v8
    v_perm_b32 v12, v18, v18, s41
    v_bitop3_b32 v24, v4, v12, v24 bitop3:0xca
    v_perm_b32 v13, v18, v18, s42
    v_bitop3_b32 v25, v4, v13, v25 bitop3:0xca
    v_mul_hi_u32_u24 v14, 429497, v26
    v_lshrrev_b32 v12, 3, v30
    v_cos_f32 v9, v9
    v_lshlrev_b16 v13, 3, v30
    v_mad_i32_i24 v11, v14, s55, v26
    v_bitop3_b32 v12, v6, v13, v12 bitop3:0xca
    v_lshl_add_u32 v11, v11, 17, s40
    v_lshlrev_b16 v14, 8, v14
    v_lshrrev_b32 v13, 2, v30
    v_add_u32 v26, v12, v11
    v_bitop3_b32 v30, v5, v13, v14 bitop3:0xea
    ds_add_u32 v30, v2
    v_mul_hi_u32_u24 v14, 429497, v27
    v_lshrrev_b32 v12, 3, v31
    v_cos_f32 v10, v10
    v_lshlrev_b16 v13, 3, v31
    v_mad_i32_i24 v11, v14, s55, v27
    v_bitop3_b32 v12, v6, v13, v12 bitop3:0xca
    v_lshl_add_u32 v11, v11, 17, s40
    v_lshlrev_b16 v14, 8, v14
    v_lshrrev_b32 v13, 2, v31
    v_add_u32 v27, v12, v11
    v_bitop3_b32 v31, v5, v13, v14 bitop3:0xea
    ds_add_u32 v31, v2
    v_cvt_pk_bf16_f32 v19, v9, v10
    v_perm_b32 v12, v19, v19, s41
    v_bitop3_b32 v26, v4, v12, v26 bitop3:0xca
    v_perm_b32 v13, v19, v19, s42
    v_bitop3_b32 v27, v4, v13, v27 bitop3:0xca
    s_setprio 0
    s_add_u32 s45, s35, 0xc000
    buffer_store_dwordx4 v[76:79], v0, s[20:23], s45 offen sc1
    s_add_u32 s46, s33, 0x4000000
    s_nop 0
    buffer_load_dwordx4 v[76:79], v0, s[12:15], s46 offen nt
    s_waitcnt vmcnt(8)
    v_lshlrev_b32 v7, 16, v64
    v_and_b32 v8, 0xffff0000, v64
    v_lshlrev_b32 v9, 16, v65
    v_and_b32 v10, 0xffff0000, v65
    v_mul_f32 v7, 0.15915494, v7
    v_mul_f32 v8, 0.15915494, v8
    v_mul_f32 v9, 0.15915494, v9
    v_mul_f32 v10, 0.15915494, v10
    v_mul_hi_u32_u24 v14, 429497, v32
    v_lshrrev_b32 v12, 3, v36
    v_cos_f32 v7, v7
    v_lshlrev_b16 v13, 3, v36
    v_mad_i32_i24 v11, v14, s55, v32
    v_bitop3_b32 v12, v6, v13, v12 bitop3:0xca
    v_lshl_add_u32 v11, v11, 17, s40
    v_lshlrev_b16 v14, 8, v14
    v_lshrrev_b32 v13, 2, v36
    v_add_u32 v32, v12, v11
    v_bitop3_b32 v36, v5, v13, v14 bitop3:0xea
    ds_add_u32 v36, v2
    v_mul_hi_u32_u24 v14, 429497, v33
    v_lshrrev_b32 v12, 3, v37
    v_cos_f32 v8, v8
    v_lshlrev_b16 v13, 3, v37
    v_mad_i32_i24 v11, v14, s55, v33
    v_bitop3_b32 v12, v6, v13, v12 bitop3:0xca
    v_lshl_add_u32 v11, v11, 17, s40
    v_lshlrev_b16 v14, 8, v14
    v_lshrrev_b32 v13, 2, v37
    v_add_u32 v33, v12, v11
    v_bitop3_b32 v37, v5, v13, v14 bitop3:0xea
    ds_add_u32 v37, v2
    v_cvt_pk_bf16_f32 v64, v7, v8
    v_perm_b32 v12, v64, v64, s41
    v_bitop3_b32 v32, v4, v12, v32 bitop3:0xca
    v_perm_b32 v13, v64, v64, s42
    v_bitop3_b32 v33, v4, v13, v33 bitop3:0xca
    v_mul_hi_u32_u24 v14, 429497, v34
    v_lshrrev_b32 v12, 3, v38
    v_cos_f32 v9, v9
    v_lshlrev_b16 v13, 3, v38
    v_mad_i32_i24 v11, v14, s55, v34
    v_bitop3_b32 v12, v6, v13, v12 bitop3:0xca
    v_lshl_add_u32 v11, v11, 17, s40
    v_lshlrev_b16 v14, 8, v14
    v_lshrrev_b32 v13, 2, v38
    v_add_u32 v34, v12, v11
    v_bitop3_b32 v38, v5, v13, v14 bitop3:0xea
    ds_add_u32 v38, v2
    v_mul_hi_u32_u24 v14, 429497, v35
    v_lshrrev_b32 v12, 3, v39
    v_cos_f32 v10, v10
    v_lshlrev_b16 v13, 3, v39
    v_mad_i32_i24 v11, v14, s55, v35
    v_bitop3_b32 v12, v6, v13, v12 bitop3:0xca
    v_lshl_add_u32 v11, v11, 17, s40
    v_lshlrev_b16 v14, 8, v14
    v_lshrrev_b32 v13, 2, v39
    v_add_u32 v35, v12, v11
    v_bitop3_b32 v39, v5, v13, v14 bitop3:0xea
    ds_add_u32 v39, v2
    v_cvt_pk_bf16_f32 v65, v9, v10
    v_perm_b32 v12, v65, v65, s41
    v_bitop3_b32 v34, v4, v12, v34 bitop3:0xca
    v_perm_b32 v13, v65, v65, s42
    v_bitop3_b32 v35, v4, v13, v35 bitop3:0xca
    s_waitcnt vmcnt(4)
    v_lshlrev_b32 v7, 16, v66
    v_and_b32 v8, 0xffff0000, v66
    v_lshlrev_b32 v9, 16, v67
    v_and_b32 v10, 0xffff0000, v67
    v_mul_f32 v7, 0.15915494, v7
    v_mul_f32 v8, 0.15915494, v8
    v_mul_f32 v9, 0.15915494, v9
    v_mul_f32 v10, 0.15915494, v10
    v_mul_hi_u32_u24 v14, 429497, v40
    v_lshrrev_b32 v12, 3, v44
    v_cos_f32 v7, v7
    v_lshlrev_b16 v13, 3, v44
    v_mad_i32_i24 v11, v14, s55, v40
    v_bitop3_b32 v12, v6, v13, v12 bitop3:0xca
    v_lshl_add_u32 v11, v11, 17, s40
    v_lshlrev_b16 v14, 8, v14
    v_lshrrev_b32 v13, 2, v44
    v_add_u32 v40, v12, v11
    v_bitop3_b32 v44, v5, v13, v14 bitop3:0xea
    ds_add_u32 v44, v2
    v_mul_hi_u32_u24 v14, 429497, v41
    v_lshrrev_b32 v12, 3, v45
    v_cos_f32 v8, v8
    v_lshlrev_b16 v13, 3, v45
    v_mad_i32_i24 v11, v14, s55, v41
    v_bitop3_b32 v12, v6, v13, v12 bitop3:0xca
    v_lshl_add_u32 v11, v11, 17, s40
    v_lshlrev_b16 v14, 8, v14
    v_lshrrev_b32 v13, 2, v45
    v_add_u32 v41, v12, v11
    v_bitop3_b32 v45, v5, v13, v14 bitop3:0xea
    ds_add_u32 v45, v2
    v_cvt_pk_bf16_f32 v66, v7, v8
    v_perm_b32 v12, v66, v66, s41
    v_bitop3_b32 v40, v4, v12, v40 bitop3:0xca
    v_perm_b32 v13, v66, v66, s42
    v_bitop3_b32 v41, v4, v13, v41 bitop3:0xca
    v_mul_hi_u32_u24 v14, 429497, v42
    v_lshrrev_b32 v12, 3, v46
    v_cos_f32 v9, v9
    v_lshlrev_b16 v13, 3, v46
    v_mad_i32_i24 v11, v14, s55, v42
    v_bitop3_b32 v12, v6, v13, v12 bitop3:0xca
    v_lshl_add_u32 v11, v11, 17, s40
    v_lshlrev_b16 v14, 8, v14
    v_lshrrev_b32 v13, 2, v46
    v_add_u32 v42, v12, v11
    v_bitop3_b32 v46, v5, v13, v14 bitop3:0xea
    ds_add_u32 v46, v2
    v_mul_hi_u32_u24 v14, 429497, v43
    v_lshrrev_b32 v12, 3, v47
    v_cos_f32 v10, v10
    v_lshlrev_b16 v13, 3, v47
    v_mad_i32_i24 v11, v14, s55, v43
    v_bitop3_b32 v12, v6, v13, v12 bitop3:0xca
    v_lshl_add_u32 v11, v11, 17, s40
    v_lshlrev_b16 v14, 8, v14
    v_lshrrev_b32 v13, 2, v47
    v_add_u32 v43, v12, v11
    v_bitop3_b32 v47, v5, v13, v14 bitop3:0xea
    ds_add_u32 v47, v2
    v_cvt_pk_bf16_f32 v67, v9, v10
    v_perm_b32 v12, v67, v67, s41
    v_bitop3_b32 v42, v4, v12, v42 bitop3:0xca
    v_perm_b32 v13, v67, v67, s42
    v_bitop3_b32 v43, v4, v13, v43 bitop3:0xca
    v_lshrrev_b32 v8, 2, v0
    v_and_b32 v7, 0x3c00, v0
    v_bitop3_b32 v7, v5, v8, v7 bitop3:0xea
    s_waitcnt lgkmcnt(0)
    s_barrier
    ds_read2st64_b32 v[8:9], v7 offset0:0 offset1:1
    ds_read2st64_b32 v[10:11], v7 offset0:2 offset1:3
    s_add_u32 s47, s35, 0x10000
    buffer_store_dwordx4 v[68:71], v0, s[20:23], s47 offen sc1
    s_add_u32 s44, s34, 0x2000000
    s_nop 0
    buffer_load_dwordx2 v[68:69], v1, s[16:19], s44 offen nt
    s_add_u32 s45, s34, 0x2200000
    buffer_load_dwordx2 v[70:71], v1, s[16:19], s45 offen nt
    s_waitcnt lgkmcnt(0)
    v_lshl_or_b32 v12, v9, 16, v8
    v_lshl_or_b32 v13, v11, 16, v10
    v_mov_b32 v14, v12
    v_mov_b32 v15, v13
    s_nop 0
    v_add_u32_dpp v14, v14, v14 row_shr:1 row_mask:0xf bank_mask:0xf bound_ctrl:1
    v_add_u32_dpp v15, v15, v15 row_shr:1 row_mask:0xf bank_mask:0xf bound_ctrl:1
    s_nop 0
    v_add_u32_dpp v14, v14, v14 row_shr:2 row_mask:0xf bank_mask:0xf bound_ctrl:1
    v_add_u32_dpp v15, v15, v15 row_shr:2 row_mask:0xf bank_mask:0xf bound_ctrl:1
    s_nop 0
    v_add_u32_dpp v14, v14, v14 row_shr:4 row_mask:0xf bank_mask:0xf bound_ctrl:1
    v_add_u32_dpp v15, v15, v15 row_shr:4 row_mask:0xf bank_mask:0xf bound_ctrl:1
    s_nop 0
    v_add_u32_dpp v14, v14, v14 row_shr:8 row_mask:0xf bank_mask:0xf bound_ctrl:1
    v_add_u32_dpp v15, v15, v15 row_shr:8 row_mask:0xf bank_mask:0xf bound_ctrl:1
    s_nop 0
    v_add_u32_dpp v14, v14, v14 row_bcast:15 row_mask:0xa bank_mask:0xf
    v_add_u32_dpp v15, v15, v15 row_bcast:15 row_mask:0xa bank_mask:0xf
    s_nop 0
    v_add_u32_dpp v14, v14, v14 row_bcast:31 row_mask:0xc bank_mask:0xf
    v_add_u32_dpp v15, v15, v15 row_bcast:31 row_mask:0xc bank_mask:0xf
    v_readlane_b32 s48, v14, 63
    v_readlane_b32 s49, v15, 63
    s_lshl_b32 s54, s32, 2
    v_mov_b32 v8, s54
    s_and_b32 s50, s48, 0xffff
    s_lshr_b32 s51, s48, 16
    s_and_b32 s52, s49, 0xffff
    s_lshr_b32 s53, s49, 16
    s_add_u32 s51, s51, s50
    s_add_u32 s52, s52, s51
    s_add_u32 s53, s53, s52
    v_mov_b32 v9, s53
    s_mov_b64 exec, 1
    ds_write_b32 v8, v9 offset:16384
    s_mov_b64 exec, -1
    v_and_b32 v8, 60, v7
    s_waitcnt lgkmcnt(0)
    s_barrier
    ds_read_b32 v9, v8 offset:16384
    s_waitcnt lgkmcnt(0)
    v_add_u32_dpp v9, v9, v9 row_shr:1 row_mask:0xf bank_mask:0xf bound_ctrl:1
    s_nop 1
    v_add_u32_dpp v9, v9, v9 row_shr:2 row_mask:0xf bank_mask:0xf bound_ctrl:1
    s_nop 1
    v_add_u32_dpp v9, v9, v9 row_shr:4 row_mask:0xf bank_mask:0xf bound_ctrl:1
    s_nop 1
    v_add_u32_dpp v9, v9, v9 row_shr:8 row_mask:0xf bank_mask:0xf bound_ctrl:1
    s_nop 0
    v_readlane_b32 s54, v9, s32
    s_sub_u32 s54, s54, s53
    s_add_u32 s50, s50, s54
    s_add_u32 s51, s51, s54
    s_add_u32 s52, s52, s54
    s_pack_ll_b32_b16 s48, s54, s50
    s_pack_ll_b32_b16 s49, s51, s52
    v_add_u32 v14, s48, v14
    v_add_u32 v15, s49, v15
    v_sub_u32 v12, v14, v12
    v_sub_u32 v13, v15, v13
    v_and_b32 v8, 0xffff, v12
    v_lshrrev_b32 v9, 16, v12
    v_and_b32 v10, 0xffff, v13
    v_lshrrev_b32 v11, 16, v13
    ds_write2st64_b32 v7, v8, v9 offset0:0 offset1:1
    ds_write2st64_b32 v7, v10, v11 offset0:2 offset1:3
    v_and_b32 v8, 0x3f0, v0
    v_lshl_add_u32 v8, v8, 1, s36
    ds_write_b64 v8, v[12:13] offset:20480
    s_bitset0_b64 exec, 63
    s_not_b64 exec, exec
    ds_write_b64 v8, v[14:15] offset:20512
    s_mov_b64 exec, -1
    s_waitcnt lgkmcnt(0)
    s_barrier
    s_setprio 3
    ds_add_rtn_u32 v52, v52, v2
    ds_add_rtn_u32 v53, v53, v2
    ds_add_rtn_u32 v54, v54, v2
    ds_add_rtn_u32 v55, v55, v2
    ds_read_b128 v[12:15], v0 offset:20480
    v_cmp_gt_u32 vcc, 8448, v0
    ds_add_rtn_u32 v100, v100, v2
    ds_add_rtn_u32 v101, v101, v2
    ds_add_rtn_u32 v102, v102, v2
    ds_add_rtn_u32 v103, v103, v2
    s_setprio 2
    ds_add_rtn_u32 v116, v116, v2
    ds_add_rtn_u32 v117, v117, v2
    ds_add_rtn_u32 v118, v118, v2
    ds_add_rtn_u32 v119, v119, v2
    s_waitcnt lgkmcnt(8)
    s_cbranch_vccz L1_p2
    s_add_u32 s46, s35, 0x2a40000
    s_mov_b64 exec, vcc
    buffer_store_dwordx4 v[12:15], v0, s[24:27], s46 offen sc1
    s_mov_b64 exec, -1
L1_p2:
    s_add_u32 s47, s35, 0x14000
    buffer_store_dwordx4 v[80:83], v0, s[20:23], s47 offen sc1
    s_add_u32 s44, s33, 0x4400000
    s_nop 0
    buffer_load_dwordx4 v[80:83], v0, s[8:11], s44 offen nt
    ds_add_rtn_u32 v108, v108, v2
    ds_add_rtn_u32 v109, v109, v2
    ds_add_rtn_u32 v110, v110, v2
    ds_add_rtn_u32 v111, v111, v2
    s_setprio 1
    ds_add_rtn_u32 v20, v20, v2
    ds_add_rtn_u32 v21, v21, v2
    ds_add_rtn_u32 v22, v22, v2
    ds_add_rtn_u32 v23, v23, v2
    ds_add_rtn_u32 v28, v28, v2
    ds_add_rtn_u32 v29, v29, v2
    ds_add_rtn_u32 v30, v30, v2
    ds_add_rtn_u32 v31, v31, v2
    s_add_u32 s45, s35, 0x18000
    buffer_store_dwordx4 v[84:87], v0, s[20:23], s45 offen sc1
    s_add_u32 s46, s33, 0x4400000
    s_nop 0
    buffer_load_dwordx4 v[84:87], v0, s[12:15], s46 offen nt
    s_setprio 0
    ds_add_rtn_u32 v36, v36, v2
    ds_add_rtn_u32 v37, v37, v2
    ds_add_rtn_u32 v38, v38, v2
    ds_add_rtn_u32 v39, v39, v2
    ds_add_rtn_u32 v44, v44, v2
    ds_add_rtn_u32 v45, v45, v2
    ds_add_rtn_u32 v46, v46, v2
    ds_add_rtn_u32 v47, v47, v2
    s_waitcnt lgkmcnt(0)
    s_barrier
    s_setprio 3
    v_and_b32 v7, -4, v52
    v_lshl_add_u32 v8, v52, 2, v7
    ds_write_b32 v8, v96
    v_lshl_add_u32 v7, v7, 2, v52
    ds_write_b8 v7, v104 offset:16
    v_and_b32 v9, -4, v53
    v_lshl_add_u32 v10, v53, 2, v9
    ds_write_b32 v10, v97
    v_lshl_add_u32 v9, v9, 2, v53
    ds_write_b8_d16_hi v9, v104 offset:16
    v_and_b32 v7, -4, v54
    v_lshl_add_u32 v8, v54, 2, v7
    ds_write_b32 v8, v98
    v_lshl_add_u32 v7, v7, 2, v54
    ds_write_b8 v7, v105 offset:16
    v_and_b32 v9, -4, v55
    v_lshl_add_u32 v10, v55, 2, v9
    ds_write_b32 v10, v99
    v_lshl_add_u32 v9, v9, 2, v55
    ds_write_b8_d16_hi v9, v105 offset:16
    s_add_u32 s47, s35, 0x1c000
    buffer_store_dwordx4 v[48:51], v0, s[20:23], s47 offen sc1
    s_add_u32 s44, s33, 0x4800000
    buffer_load_dwordx4 v[96:99], v0, s[8:11], s44 offen nt
    s_add_u32 s45, s33, 0x4800000
    buffer_load_dwordx4 v[52:55], v0, s[12:15], s45 offen nt
    v_and_b32 v7, -4, v100
    v_lshl_add_u32 v8, v100, 2, v7
    ds_write_b32 v8, v56
    v_lshl_add_u32 v7, v7, 2, v100
    ds_write_b8 v7, v106 offset:16
    v_and_b32 v9, -4, v101
    v_lshl_add_u32 v10, v101, 2, v9
    ds_write_b32 v10, v57
    v_lshl_add_u32 v9, v9, 2, v101
    ds_write_b8_d16_hi v9, v106 offset:16
    v_and_b32 v7, -4, v102
    v_lshl_add_u32 v8, v102, 2, v7
    ds_write_b32 v8, v58
    v_lshl_add_u32 v7, v7, 2, v102
    ds_write_b8 v7, v107 offset:16
    v_and_b32 v9, -4, v103
    v_lshl_add_u32 v10, v103, 2, v9
    ds_write_b32 v10, v59
    v_lshl_add_u32 v9, v9, 2, v103
    ds_write_b8_d16_hi v9, v107 offset:16
    s_add_u32 s46, s34, 0x2400000
    buffer_load_dwordx2 v[48:49], v1, s[16:19], s46 offen nt
    s_add_u32 s47, s34, 0x2600000
    buffer_load_dwordx2 v[50:51], v1, s[16:19], s47 offen nt
    s_add_u32 s44, s33, 0x4c00000
    buffer_load_dwordx4 v[56:59], v0, s[8:11], s44 offen nt
    s_setprio 2
    v_and_b32 v7, -4, v116
    v_lshl_add_u32 v8, v116, 2, v7
    ds_write_b32 v8, v120
    v_lshl_add_u32 v7, v7, 2, v116
    ds_write_b8 v7, v112 offset:16
    v_and_b32 v9, -4, v117
    v_lshl_add_u32 v10, v117, 2, v9
    ds_write_b32 v10, v121
    v_lshl_add_u32 v9, v9, 2, v117
    ds_write_b8_d16_hi v9, v112 offset:16
    v_and_b32 v7, -4, v118
    v_lshl_add_u32 v8, v118, 2, v7
    ds_write_b32 v8, v122
    v_lshl_add_u32 v7, v7, 2, v118
    ds_write_b8 v7, v113 offset:16
    v_and_b32 v9, -4, v119
    v_lshl_add_u32 v10, v119, 2, v9
    ds_write_b32 v10, v123
    v_lshl_add_u32 v9, v9, 2, v119
    ds_write_b8_d16_hi v9, v113 offset:16
    s_add_u32 s45, s35, 0x20000
    buffer_store_dwordx4 v[92:95], v0, s[20:23], s45 offen sc1
    s_add_u32 s46, s33, 0x4c00000
    buffer_load_dwordx4 v[100:103], v0, s[12:15], s46 offen nt
    v_and_b32 v7, -4, v108
    v_lshl_add_u32 v8, v108, 2, v7
    ds_write_b32 v8, v124
    v_lshl_add_u32 v7, v7, 2, v108
    ds_write_b8 v7, v114 offset:16
    v_and_b32 v9, -4, v109
    v_lshl_add_u32 v10, v109, 2, v9
    ds_write_b32 v10, v125
    v_lshl_add_u32 v9, v9, 2, v109
    ds_write_b8_d16_hi v9, v114 offset:16
    v_and_b32 v7, -4, v110
    v_lshl_add_u32 v8, v110, 2, v7
    ds_write_b32 v8, v126
    v_lshl_add_u32 v7, v7, 2, v110
    ds_write_b8 v7, v115 offset:16
    v_and_b32 v9, -4, v111
    v_lshl_add_u32 v10, v111, 2, v9
    ds_write_b32 v10, v127
    v_lshl_add_u32 v9, v9, 2, v111
    ds_write_b8_d16_hi v9, v115 offset:16
    s_add_u32 s47, s33, 0x5000000
    buffer_load_dwordx4 v[104:107], v0, s[8:11], s47 offen nt
    s_add_u32 s44, s33, 0x5000000
    buffer_load_dwordx4 v[120:123], v0, s[12:15], s44 offen nt
    s_setprio 1
    v_and_b32 v7, -4, v20
    v_lshl_add_u32 v8, v20, 2, v7
    ds_write_b32 v8, v60
    v_lshl_add_u32 v7, v7, 2, v20
    ds_write_b8 v7, v16 offset:16
    v_and_b32 v9, -4, v21
    v_lshl_add_u32 v10, v21, 2, v9
    ds_write_b32 v10, v61
    v_lshl_add_u32 v9, v9, 2, v21
    ds_write_b8_d16_hi v9, v16 offset:16
    v_and_b32 v7, -4, v22
    v_lshl_add_u32 v8, v22, 2, v7
    ds_write_b32 v8, v62
    v_lshl_add_u32 v7, v7, 2, v22
    ds_write_b8 v7, v17 offset:16
    v_and_b32 v9, -4, v23
    v_lshl_add_u32 v10, v23, 2, v9
    ds_write_b32 v10, v63
    v_lshl_add_u32 v9, v9, 2, v23
    ds_write_b8_d16_hi v9, v17 offset:16
    s_add_u32 s45, s34, 0x2800000
    buffer_load_dwordx2 v[116:117], v1, s[16:19], s45 offen nt
    s_add_u32 s46, s34, 0x2a00000
    buffer_load_dwordx2 v[118:119], v1, s[16:19], s46 offen nt
    s_add_u32 s47, s33, 0x5400000
    buffer_load_dwordx4 v[92:95], v0, s[8:11], s47 offen nt
    v_and_b32 v7, -4, v28
    v_lshl_add_u32 v8, v28, 2, v7
    ds_write_b32 v8, v24
    v_lshl_add_u32 v7, v7, 2, v28
    ds_write_b8 v7, v18 offset:16
    v_and_b32 v9, -4, v29
    v_lshl_add_u32 v10, v29, 2, v9
    ds_write_b32 v10, v25
    v_lshl_add_u32 v9, v9, 2, v29
    ds_write_b8_d16_hi v9, v18 offset:16
    v_and_b32 v7, -4, v30
    v_lshl_add_u32 v8, v30, 2, v7
    ds_write_b32 v8, v26
    v_lshl_add_u32 v7, v7, 2, v30
    ds_write_b8 v7, v19 offset:16
    v_and_b32 v9, -4, v31
    v_lshl_add_u32 v10, v31, 2, v9
    ds_write_b32 v10, v27
    v_lshl_add_u32 v9, v9, 2, v31
    ds_write_b8_d16_hi v9, v19 offset:16
    s_add_u32 s44, s35, 0x24000
    buffer_store_dwordx4 v[88:91], v0, s[20:23], s44 offen sc1
    s_add_u32 s45, s33, 0x5400000
    buffer_load_dwordx4 v[124:127], v0, s[12:15], s45 offen nt
    s_setprio 0
    v_and_b32 v7, -4, v36
    v_lshl_add_u32 v8, v36, 2, v7
    ds_write_b32 v8, v32
    v_lshl_add_u32 v7, v7, 2, v36
    ds_write_b8 v7, v64 offset:16
    v_and_b32 v9, -4, v37
    v_lshl_add_u32 v10, v37, 2, v9
    ds_write_b32 v10, v33
    v_lshl_add_u32 v9, v9, 2, v37
    ds_write_b8_d16_hi v9, v64 offset:16
    v_and_b32 v7, -4, v38
    v_lshl_add_u32 v8, v38, 2, v7
    ds_write_b32 v8, v34
    v_lshl_add_u32 v7, v7, 2, v38
    ds_write_b8 v7, v65 offset:16
    v_and_b32 v9, -4, v39
    v_lshl_add_u32 v10, v39, 2, v9
    ds_write_b32 v10, v35
    v_lshl_add_u32 v9, v9, 2, v39
    ds_write_b8_d16_hi v9, v65 offset:16
    s_add_u32 s46, s33, 0x5800000
    buffer_load_dwordx4 v[108:111], v0, s[8:11], s46 offen nt
    s_add_u32 s47, s33, 0x5800000
    buffer_load_dwordx4 v[112:115], v0, s[12:15], s47 offen nt
    v_and_b32 v7, -4, v44
    v_lshl_add_u32 v8, v44, 2, v7
    ds_write_b32 v8, v40
    v_lshl_add_u32 v7, v7, 2, v44
    ds_write_b8 v7, v66 offset:16
    v_and_b32 v9, -4, v45
    v_lshl_add_u32 v10, v45, 2, v9
    ds_write_b32 v10, v41
    v_lshl_add_u32 v9, v9, 2, v45
    ds_write_b8_d16_hi v9, v66 offset:16
    v_and_b32 v7, -4, v46
    v_lshl_add_u32 v8, v46, 2, v7
    ds_write_b32 v8, v42
    v_lshl_add_u32 v7, v7, 2, v46
    ds_write_b8 v7, v67 offset:16
    v_and_b32 v9, -4, v47
    v_lshl_add_u32 v10, v47, 2, v9
    ds_write_b32 v10, v43
    v_lshl_add_u32 v9, v9, 2, v47
    ds_write_b8_d16_hi v9, v67 offset:16
    s_add_u32 s44, s34, 0x2c00000
    buffer_load_dwordx2 v[60:61], v1, s[16:19], s44 offen nt
    s_add_u32 s45, s34, 0x2e00000
    buffer_load_dwordx2 v[62:63], v1, s[16:19], s45 offen nt
    v_add_u32 v7, 0x10000, v0
    v_add_u32 v12, 0x20000, v0
    v_mov_b32 v8, 0
    v_mov_b32 v9, 0
    v_mov_b32 v10, 0
    v_mov_b32 v11, 0
    s_waitcnt lgkmcnt(0)
    s_barrier
    ds_read_b128 v[20:23], v0 offset:0
    ds_write_b128 v0, v[8:11]
    ds_read_b128 v[24:27], v0 offset:16384
    ds_read_b128 v[28:31], v0 offset:32768
    ds_read_b128 v[16:19], v0 offset:49152
    ds_read_b128 v[88:91], v7 offset:0
    ds_read_b128 v[32:35], v7 offset:16384
    ds_read_b128 v[36:39], v7 offset:32768
    ds_read_b128 v[40:43], v7 offset:49152
    ds_read_b128 v[44:47], v12 offset:0
    ds_read_b128 v[64:67], v12 offset:16384
    s_waitcnt lgkmcnt(0)
    s_barrier
    s_setprio 3
    s_add_u32 s46, s35, 0x2a40000
    buffer_store_dwordx4 v[20:23], v0, s[20:23], s46 offen sc1
    s_add_u32 s47, s33, 0x5c00000
    s_nop 0
    buffer_load_dwordx4 v[20:23], v0, s[8:11], s47 offen nt
    s_add_u32 s44, s35, 0x2a44000
    buffer_store_dwordx4 v[24:27], v0, s[20:23], s44 offen sc1
    s_add_u32 s45, s33, 0x5c00000
    s_nop 0
    buffer_load_dwordx4 v[24:27], v0, s[12:15], s45 offen nt
    s_waitcnt vmcnt(27)
    v_lshlrev_b32 v7, 16, v68
    v_and_b32 v8, 0xffff0000, v68
    v_lshlrev_b32 v9, 16, v69
    v_and_b32 v10, 0xffff0000, v69
    v_mul_f32 v7, 0.15915494, v7
    v_mul_f32 v8, 0.15915494, v8
    v_mul_f32 v9, 0.15915494, v9
    v_mul_f32 v10, 0.15915494, v10
    v_mul_hi_u32_u24 v14, 429497, v72
    v_lshrrev_b32 v12, 3, v76
    v_cos_f32 v7, v7
    v_lshlrev_b16 v13, 3, v76
    v_mad_i32_i24 v11, v14, s55, v72
    v_bitop3_b32 v12, v6, v13, v12 bitop3:0xca
    v_lshl_add_u32 v11, v11, 17, s40
    v_lshlrev_b16 v14, 8, v14
    v_lshrrev_b32 v13, 2, v76
    v_add_u32 v72, v12, v11
    v_bitop3_b32 v76, v5, v13, v14 bitop3:0xea
    ds_add_u32 v76, v2
    v_mul_hi_u32_u24 v14, 429497, v73
    v_lshrrev_b32 v12, 3, v77
    v_cos_f32 v8, v8
    v_lshlrev_b16 v13, 3, v77
    v_mad_i32_i24 v11, v14, s55, v73
    v_bitop3_b32 v12, v6, v13, v12 bitop3:0xca
    v_lshl_add_u32 v11, v11, 17, s40
    v_lshlrev_b16 v14, 8, v14
    v_lshrrev_b32 v13, 2, v77
    v_add_u32 v73, v12, v11
    v_bitop3_b32 v77, v5, v13, v14 bitop3:0xea
    ds_add_u32 v77, v2
    v_cvt_pk_bf16_f32 v68, v7, v8
    v_perm_b32 v12, v68, v68, s41
    v_bitop3_b32 v72, v4, v12, v72 bitop3:0xca
    v_perm_b32 v13, v68, v68, s42
    v_bitop3_b32 v73, v4, v13, v73 bitop3:0xca
    v_mul_hi_u32_u24 v14, 429497, v74
    v_lshrrev_b32 v12, 3, v78
    v_cos_f32 v9, v9
    v_lshlrev_b16 v13, 3, v78
    v_mad_i32_i24 v11, v14, s55, v74
    v_bitop3_b32 v12, v6, v13, v12 bitop3:0xca
    v_lshl_add_u32 v11, v11, 17, s40
    v_lshlrev_b16 v14, 8, v14
    v_lshrrev_b32 v13, 2, v78
    v_add_u32 v74, v12, v11
    v_bitop3_b32 v78, v5, v13, v14 bitop3:0xea
    ds_add_u32 v78, v2
    v_mul_hi_u32_u24 v14, 429497, v75
    v_lshrrev_b32 v12, 3, v79
    v_cos_f32 v10, v10
    v_lshlrev_b16 v13, 3, v79
    v_mad_i32_i24 v11, v14, s55, v75
    v_bitop3_b32 v12, v6, v13, v12 bitop3:0xca
    v_lshl_add_u32 v11, v11, 17, s40
    v_lshlrev_b16 v14, 8, v14
    v_lshrrev_b32 v13, 2, v79
    v_add_u32 v75, v12, v11
    v_bitop3_b32 v79, v5, v13, v14 bitop3:0xea
    ds_add_u32 v79, v2
    v_cvt_pk_bf16_f32 v69, v9, v10
    v_perm_b32 v12, v69, v69, s41
    v_bitop3_b32 v74, v4, v12, v74 bitop3:0xca
    v_perm_b32 v13, v69, v69, s42
    v_bitop3_b32 v75, v4, v13, v75 bitop3:0xca
    s_waitcnt vmcnt(23)
    v_lshlrev_b32 v7, 16, v70
    v_and_b32 v8, 0xffff0000, v70
    v_lshlrev_b32 v9, 16, v71
    v_and_b32 v10, 0xffff0000, v71
    v_mul_f32 v7, 0.15915494, v7
    v_mul_f32 v8, 0.15915494, v8
    v_mul_f32 v9, 0.15915494, v9
    v_mul_f32 v10, 0.15915494, v10
    v_mul_hi_u32_u24 v14, 429497, v80
    v_lshrrev_b32 v12, 3, v84
    v_cos_f32 v7, v7
    v_lshlrev_b16 v13, 3, v84
    v_mad_i32_i24 v11, v14, s55, v80
    v_bitop3_b32 v12, v6, v13, v12 bitop3:0xca
    v_lshl_add_u32 v11, v11, 17, s40
    v_lshlrev_b16 v14, 8, v14
    v_lshrrev_b32 v13, 2, v84
    v_add_u32 v80, v12, v11
    v_bitop3_b32 v84, v5, v13, v14 bitop3:0xea
    ds_add_u32 v84, v2
    v_mul_hi_u32_u24 v14, 429497, v81
    v_lshrrev_b32 v12, 3, v85
    v_cos_f32 v8, v8
    v_lshlrev_b16 v13, 3, v85
    v_mad_i32_i24 v11, v14, s55, v81
    v_bitop3_b32 v12, v6, v13, v12 bitop3:0xca
    v_lshl_add_u32 v11, v11, 17, s40
    v_lshlrev_b16 v14, 8, v14
    v_lshrrev_b32 v13, 2, v85
    v_add_u32 v81, v12, v11
    v_bitop3_b32 v85, v5, v13, v14 bitop3:0xea
    ds_add_u32 v85, v2
    v_cvt_pk_bf16_f32 v70, v7, v8
    v_perm_b32 v12, v70, v70, s41
    v_bitop3_b32 v80, v4, v12, v80 bitop3:0xca
    v_perm_b32 v13, v70, v70, s42
    v_bitop3_b32 v81, v4, v13, v81 bitop3:0xca
    v_mul_hi_u32_u24 v14, 429497, v82
    v_lshrrev_b32 v12, 3, v86
    v_cos_f32 v9, v9
    v_lshlrev_b16 v13, 3, v86
    v_mad_i32_i24 v11, v14, s55, v82
    v_bitop3_b32 v12, v6, v13, v12 bitop3:0xca
    v_lshl_add_u32 v11, v11, 17, s40
    v_lshlrev_b16 v14, 8, v14
    v_lshrrev_b32 v13, 2, v86
    v_add_u32 v82, v12, v11
    v_bitop3_b32 v86, v5, v13, v14 bitop3:0xea
    ds_add_u32 v86, v2
    v_mul_hi_u32_u24 v14, 429497, v83
    v_lshrrev_b32 v12, 3, v87
    v_cos_f32 v10, v10
    v_lshlrev_b16 v13, 3, v87
    v_mad_i32_i24 v11, v14, s55, v83
    v_bitop3_b32 v12, v6, v13, v12 bitop3:0xca
    v_lshl_add_u32 v11, v11, 17, s40
    v_lshlrev_b16 v14, 8, v14
    v_lshrrev_b32 v13, 2, v87
    v_add_u32 v83, v12, v11
    v_bitop3_b32 v87, v5, v13, v14 bitop3:0xea
    ds_add_u32 v87, v2
    v_cvt_pk_bf16_f32 v71, v9, v10
    v_perm_b32 v12, v71, v71, s41
    v_bitop3_b32 v82, v4, v12, v82 bitop3:0xca
    v_perm_b32 v13, v71, v71, s42
    v_bitop3_b32 v83, v4, v13, v83 bitop3:0xca
    s_setprio 2
    s_waitcnt vmcnt(18)
    v_lshlrev_b32 v7, 16, v48
    v_and_b32 v8, 0xffff0000, v48
    v_lshlrev_b32 v9, 16, v49
    v_and_b32 v10, 0xffff0000, v49
    v_mul_f32 v7, 0.15915494, v7
    v_mul_f32 v8, 0.15915494, v8
    v_mul_f32 v9, 0.15915494, v9
    v_mul_f32 v10, 0.15915494, v10
    v_mul_hi_u32_u24 v14, 429497, v96
    v_lshrrev_b32 v12, 3, v52
    v_cos_f32 v7, v7
    v_lshlrev_b16 v13, 3, v52
    v_mad_i32_i24 v11, v14, s55, v96
    v_bitop3_b32 v12, v6, v13, v12 bitop3:0xca
    v_lshl_add_u32 v11, v11, 17, s40
    v_lshlrev_b16 v14, 8, v14
    v_lshrrev_b32 v13, 2, v52
    v_add_u32 v96, v12, v11
    v_bitop3_b32 v52, v5, v13, v14 bitop3:0xea
    ds_add_u32 v52, v2
    v_mul_hi_u32_u24 v14, 429497, v97
    v_lshrrev_b32 v12, 3, v53
    v_cos_f32 v8, v8
    v_lshlrev_b16 v13, 3, v53
    v_mad_i32_i24 v11, v14, s55, v97
    v_bitop3_b32 v12, v6, v13, v12 bitop3:0xca
    v_lshl_add_u32 v11, v11, 17, s40
    v_lshlrev_b16 v14, 8, v14
    v_lshrrev_b32 v13, 2, v53
    v_add_u32 v97, v12, v11
    v_bitop3_b32 v53, v5, v13, v14 bitop3:0xea
    ds_add_u32 v53, v2
    v_cvt_pk_bf16_f32 v48, v7, v8
    v_perm_b32 v12, v48, v48, s41
    v_bitop3_b32 v96, v4, v12, v96 bitop3:0xca
    v_perm_b32 v13, v48, v48, s42
    v_bitop3_b32 v97, v4, v13, v97 bitop3:0xca
    v_mul_hi_u32_u24 v14, 429497, v98
    v_lshrrev_b32 v12, 3, v54
    v_cos_f32 v9, v9
    v_lshlrev_b16 v13, 3, v54
    v_mad_i32_i24 v11, v14, s55, v98
    v_bitop3_b32 v12, v6, v13, v12 bitop3:0xca
    v_lshl_add_u32 v11, v11, 17, s40
    v_lshlrev_b16 v14, 8, v14
    v_lshrrev_b32 v13, 2, v54
    v_add_u32 v98, v12, v11
    v_bitop3_b32 v54, v5, v13, v14 bitop3:0xea
    ds_add_u32 v54, v2
    v_mul_hi_u32_u24 v14, 429497, v99
    v_lshrrev_b32 v12, 3, v55
    v_cos_f32 v10, v10
    v_lshlrev_b16 v13, 3, v55
    v_mad_i32_i24 v11, v14, s55, v99
    v_bitop3_b32 v12, v6, v13, v12 bitop3:0xca
    v_lshl_add_u32 v11, v11, 17, s40
    v_lshlrev_b16 v14, 8, v14
    v_lshrrev_b32 v13, 2, v55
    v_add_u32 v99, v12, v11
    v_bitop3_b32 v55, v5, v13, v14 bitop3:0xea
    ds_add_u32 v55, v2
    v_cvt_pk_bf16_f32 v49, v9, v10
    v_perm_b32 v12, v49, v49, s41
    v_bitop3_b32 v98, v4, v12, v98 bitop3:0xca
    v_perm_b32 v13, v49, v49, s42
    v_bitop3_b32 v99, v4, v13, v99 bitop3:0xca
    s_add_u32 s46, s35, 0x2a48000
    buffer_store_dwordx4 v[28:31], v0, s[20:23], s46 offen sc1
    s_add_u32 s47, s33, 0x6000000
    s_nop 0
    buffer_load_dwordx4 v[28:31], v0, s[8:11], s47 offen nt
    s_waitcnt vmcnt(17)
    v_lshlrev_b32 v7, 16, v50
    v_and_b32 v8, 0xffff0000, v50
    v_lshlrev_b32 v9, 16, v51
    v_and_b32 v10, 0xffff0000, v51
    v_mul_f32 v7, 0.15915494, v7
    v_mul_f32 v8, 0.15915494, v8
    v_mul_f32 v9, 0.15915494, v9
    v_mul_f32 v10, 0.15915494, v10
    v_mul_hi_u32_u24 v14, 429497, v56
    v_lshrrev_b32 v12, 3, v100
    v_cos_f32 v7, v7
    v_lshlrev_b16 v13, 3, v100
    v_mad_i32_i24 v11, v14, s55, v56
    v_bitop3_b32 v12, v6, v13, v12 bitop3:0xca
    v_lshl_add_u32 v11, v11, 17, s40
    v_lshlrev_b16 v14, 8, v14
    v_lshrrev_b32 v13, 2, v100
    v_add_u32 v56, v12, v11
    v_bitop3_b32 v100, v5, v13, v14 bitop3:0xea
    ds_add_u32 v100, v2
    v_mul_hi_u32_u24 v14, 429497, v57
    v_lshrrev_b32 v12, 3, v101
    v_cos_f32 v8, v8
    v_lshlrev_b16 v13, 3, v101
    v_mad_i32_i24 v11, v14, s55, v57
    v_bitop3_b32 v12, v6, v13, v12 bitop3:0xca
    v_lshl_add_u32 v11, v11, 17, s40
    v_lshlrev_b16 v14, 8, v14
    v_lshrrev_b32 v13, 2, v101
    v_add_u32 v57, v12, v11
    v_bitop3_b32 v101, v5, v13, v14 bitop3:0xea
    ds_add_u32 v101, v2
    v_cvt_pk_bf16_f32 v50, v7, v8
    v_perm_b32 v12, v50, v50, s41
    v_bitop3_b32 v56, v4, v12, v56 bitop3:0xca
    v_perm_b32 v13, v50, v50, s42
    v_bitop3_b32 v57, v4, v13, v57 bitop3:0xca
    v_mul_hi_u32_u24 v14, 429497, v58
    v_lshrrev_b32 v12, 3, v102
    v_cos_f32 v9, v9
    v_lshlrev_b16 v13, 3, v102
    v_mad_i32_i24 v11, v14, s55, v58
    v_bitop3_b32 v12, v6, v13, v12 bitop3:0xca
    v_lshl_add_u32 v11, v11, 17, s40
    v_lshlrev_b16 v14, 8, v14
    v_lshrrev_b32 v13, 2, v102
    v_add_u32 v58, v12, v11
    v_bitop3_b32 v102, v5, v13, v14 bitop3:0xea
    ds_add_u32 v102, v2
    v_mul_hi_u32_u24 v14, 429497, v59
    v_lshrrev_b32 v12, 3, v103
    v_cos_f32 v10, v10
    v_lshlrev_b16 v13, 3, v103
    v_mad_i32_i24 v11, v14, s55, v59
    v_bitop3_b32 v12, v6, v13, v12 bitop3:0xca
    v_lshl_add_u32 v11, v11, 17, s40
    v_lshlrev_b16 v14, 8, v14
    v_lshrrev_b32 v13, 2, v103
    v_add_u32 v59, v12, v11
    v_bitop3_b32 v103, v5, v13, v14 bitop3:0xea
    ds_add_u32 v103, v2
    v_cvt_pk_bf16_f32 v51, v9, v10
    v_perm_b32 v12, v51, v51, s41
    v_bitop3_b32 v58, v4, v12, v58 bitop3:0xca
    v_perm_b32 v13, v51, v51, s42
    v_bitop3_b32 v59, v4, v13, v59 bitop3:0xca
    s_setprio 1
    s_waitcnt vmcnt(13)
    v_lshlrev_b32 v7, 16, v116
    v_and_b32 v8, 0xffff0000, v116
    v_lshlrev_b32 v9, 16, v117
    v_and_b32 v10, 0xffff0000, v117
    v_mul_f32 v7, 0.15915494, v7
    v_mul_f32 v8, 0.15915494, v8
    v_mul_f32 v9, 0.15915494, v9
    v_mul_f32 v10, 0.15915494, v10
    v_mul_hi_u32_u24 v14, 429497, v104
    v_lshrrev_b32 v12, 3, v120
    v_cos_f32 v7, v7
    v_lshlrev_b16 v13, 3, v120
    v_mad_i32_i24 v11, v14, s55, v104
    v_bitop3_b32 v12, v6, v13, v12 bitop3:0xca
    v_lshl_add_u32 v11, v11, 17, s40
    v_lshlrev_b16 v14, 8, v14
    v_lshrrev_b32 v13, 2, v120
    v_add_u32 v104, v12, v11
    v_bitop3_b32 v120, v5, v13, v14 bitop3:0xea
    ds_add_u32 v120, v2
    v_mul_hi_u32_u24 v14, 429497, v105
    v_lshrrev_b32 v12, 3, v121
    v_cos_f32 v8, v8
    v_lshlrev_b16 v13, 3, v121
    v_mad_i32_i24 v11, v14, s55, v105
    v_bitop3_b32 v12, v6, v13, v12 bitop3:0xca
    v_lshl_add_u32 v11, v11, 17, s40
    v_lshlrev_b16 v14, 8, v14
    v_lshrrev_b32 v13, 2, v121
    v_add_u32 v105, v12, v11
    v_bitop3_b32 v121, v5, v13, v14 bitop3:0xea
    ds_add_u32 v121, v2
    v_cvt_pk_bf16_f32 v116, v7, v8
    v_perm_b32 v12, v116, v116, s41
    v_bitop3_b32 v104, v4, v12, v104 bitop3:0xca
    v_perm_b32 v13, v116, v116, s42
    v_bitop3_b32 v105, v4, v13, v105 bitop3:0xca
    v_mul_hi_u32_u24 v14, 429497, v106
    v_lshrrev_b32 v12, 3, v122
    v_cos_f32 v9, v9
    v_lshlrev_b16 v13, 3, v122
    v_mad_i32_i24 v11, v14, s55, v106
    v_bitop3_b32 v12, v6, v13, v12 bitop3:0xca
    v_lshl_add_u32 v11, v11, 17, s40
    v_lshlrev_b16 v14, 8, v14
    v_lshrrev_b32 v13, 2, v122
    v_add_u32 v106, v12, v11
    v_bitop3_b32 v122, v5, v13, v14 bitop3:0xea
    ds_add_u32 v122, v2
    v_mul_hi_u32_u24 v14, 429497, v107
    v_lshrrev_b32 v12, 3, v123
    v_cos_f32 v10, v10
    v_lshlrev_b16 v13, 3, v123
    v_mad_i32_i24 v11, v14, s55, v107
    v_bitop3_b32 v12, v6, v13, v12 bitop3:0xca
    v_lshl_add_u32 v11, v11, 17, s40
    v_lshlrev_b16 v14, 8, v14
    v_lshrrev_b32 v13, 2, v123
    v_add_u32 v107, v12, v11
    v_bitop3_b32 v123, v5, v13, v14 bitop3:0xea
    ds_add_u32 v123, v2
    v_cvt_pk_bf16_f32 v117, v9, v10
    v_perm_b32 v12, v117, v117, s41
    v_bitop3_b32 v106, v4, v12, v106 bitop3:0xca
    v_perm_b32 v13, v117, v117, s42
    v_bitop3_b32 v107, v4, v13, v107 bitop3:0xca
    s_waitcnt vmcnt(10)
    v_lshlrev_b32 v7, 16, v118
    v_and_b32 v8, 0xffff0000, v118
    v_lshlrev_b32 v9, 16, v119
    v_and_b32 v10, 0xffff0000, v119
    v_mul_f32 v7, 0.15915494, v7
    v_mul_f32 v8, 0.15915494, v8
    v_mul_f32 v9, 0.15915494, v9
    v_mul_f32 v10, 0.15915494, v10
    v_mul_hi_u32_u24 v14, 429497, v92
    v_lshrrev_b32 v12, 3, v124
    v_cos_f32 v7, v7
    v_lshlrev_b16 v13, 3, v124
    v_mad_i32_i24 v11, v14, s55, v92
    v_bitop3_b32 v12, v6, v13, v12 bitop3:0xca
    v_lshl_add_u32 v11, v11, 17, s40
    v_lshlrev_b16 v14, 8, v14
    v_lshrrev_b32 v13, 2, v124
    v_add_u32 v92, v12, v11
    v_bitop3_b32 v124, v5, v13, v14 bitop3:0xea
    ds_add_u32 v124, v2
    v_mul_hi_u32_u24 v14, 429497, v93
    v_lshrrev_b32 v12, 3, v125
    v_cos_f32 v8, v8
    v_lshlrev_b16 v13, 3, v125
    v_mad_i32_i24 v11, v14, s55, v93
    v_bitop3_b32 v12, v6, v13, v12 bitop3:0xca
    v_lshl_add_u32 v11, v11, 17, s40
    v_lshlrev_b16 v14, 8, v14
    v_lshrrev_b32 v13, 2, v125
    v_add_u32 v93, v12, v11
    v_bitop3_b32 v125, v5, v13, v14 bitop3:0xea
    ds_add_u32 v125, v2
    v_cvt_pk_bf16_f32 v118, v7, v8
    v_perm_b32 v12, v118, v118, s41
    v_bitop3_b32 v92, v4, v12, v92 bitop3:0xca
    v_perm_b32 v13, v118, v118, s42
    v_bitop3_b32 v93, v4, v13, v93 bitop3:0xca
    v_mul_hi_u32_u24 v14, 429497, v94
    v_lshrrev_b32 v12, 3, v126
    v_cos_f32 v9, v9
    v_lshlrev_b16 v13, 3, v126
    v_mad_i32_i24 v11, v14, s55, v94
    v_bitop3_b32 v12, v6, v13, v12 bitop3:0xca
    v_lshl_add_u32 v11, v11, 17, s40
    v_lshlrev_b16 v14, 8, v14
    v_lshrrev_b32 v13, 2, v126
    v_add_u32 v94, v12, v11
    v_bitop3_b32 v126, v5, v13, v14 bitop3:0xea
    ds_add_u32 v126, v2
    v_mul_hi_u32_u24 v14, 429497, v95
    v_lshrrev_b32 v12, 3, v127
    v_cos_f32 v10, v10
    v_lshlrev_b16 v13, 3, v127
    v_mad_i32_i24 v11, v14, s55, v95
    v_bitop3_b32 v12, v6, v13, v12 bitop3:0xca
    v_lshl_add_u32 v11, v11, 17, s40
    v_lshlrev_b16 v14, 8, v14
    v_lshrrev_b32 v13, 2, v127
    v_add_u32 v95, v12, v11
    v_bitop3_b32 v127, v5, v13, v14 bitop3:0xea
    ds_add_u32 v127, v2
    v_cvt_pk_bf16_f32 v119, v9, v10
    v_perm_b32 v12, v119, v119, s41
    v_bitop3_b32 v94, v4, v12, v94 bitop3:0xca
    v_perm_b32 v13, v119, v119, s42
    v_bitop3_b32 v95, v4, v13, v95 bitop3:0xca
    s_setprio 0
    s_add_u32 s44, s35, 0x2a4c000
    buffer_store_dwordx4 v[16:19], v0, s[20:23], s44 offen sc1
    s_add_u32 s45, s33, 0x6000000
    s_nop 0
    buffer_load_dwordx4 v[16:19], v0, s[12:15], s45 offen nt
    s_waitcnt vmcnt(8)
    v_lshlrev_b32 v7, 16, v60
    v_and_b32 v8, 0xffff0000, v60
    v_lshlrev_b32 v9, 16, v61
    v_and_b32 v10, 0xffff0000, v61
    v_mul_f32 v7, 0.15915494, v7
    v_mul_f32 v8, 0.15915494, v8
    v_mul_f32 v9, 0.15915494, v9
    v_mul_f32 v10, 0.15915494, v10
    v_mul_hi_u32_u24 v14, 429497, v108
    v_lshrrev_b32 v12, 3, v112
    v_cos_f32 v7, v7
    v_lshlrev_b16 v13, 3, v112
    v_mad_i32_i24 v11, v14, s55, v108
    v_bitop3_b32 v12, v6, v13, v12 bitop3:0xca
    v_lshl_add_u32 v11, v11, 17, s40
    v_lshlrev_b16 v14, 8, v14
    v_lshrrev_b32 v13, 2, v112
    v_add_u32 v108, v12, v11
    v_bitop3_b32 v112, v5, v13, v14 bitop3:0xea
    ds_add_u32 v112, v2
    v_mul_hi_u32_u24 v14, 429497, v109
    v_lshrrev_b32 v12, 3, v113
    v_cos_f32 v8, v8
    v_lshlrev_b16 v13, 3, v113
    v_mad_i32_i24 v11, v14, s55, v109
    v_bitop3_b32 v12, v6, v13, v12 bitop3:0xca
    v_lshl_add_u32 v11, v11, 17, s40
    v_lshlrev_b16 v14, 8, v14
    v_lshrrev_b32 v13, 2, v113
    v_add_u32 v109, v12, v11
    v_bitop3_b32 v113, v5, v13, v14 bitop3:0xea
    ds_add_u32 v113, v2
    v_cvt_pk_bf16_f32 v60, v7, v8
    v_perm_b32 v12, v60, v60, s41
    v_bitop3_b32 v108, v4, v12, v108 bitop3:0xca
    v_perm_b32 v13, v60, v60, s42
    v_bitop3_b32 v109, v4, v13, v109 bitop3:0xca
    v_mul_hi_u32_u24 v14, 429497, v110
    v_lshrrev_b32 v12, 3, v114
    v_cos_f32 v9, v9
    v_lshlrev_b16 v13, 3, v114
    v_mad_i32_i24 v11, v14, s55, v110
    v_bitop3_b32 v12, v6, v13, v12 bitop3:0xca
    v_lshl_add_u32 v11, v11, 17, s40
    v_lshlrev_b16 v14, 8, v14
    v_lshrrev_b32 v13, 2, v114
    v_add_u32 v110, v12, v11
    v_bitop3_b32 v114, v5, v13, v14 bitop3:0xea
    ds_add_u32 v114, v2
    v_mul_hi_u32_u24 v14, 429497, v111
    v_lshrrev_b32 v12, 3, v115
    v_cos_f32 v10, v10
    v_lshlrev_b16 v13, 3, v115
    v_mad_i32_i24 v11, v14, s55, v111
    v_bitop3_b32 v12, v6, v13, v12 bitop3:0xca
    v_lshl_add_u32 v11, v11, 17, s40
    v_lshlrev_b16 v14, 8, v14
    v_lshrrev_b32 v13, 2, v115
    v_add_u32 v111, v12, v11
    v_bitop3_b32 v115, v5, v13, v14 bitop3:0xea
    ds_add_u32 v115, v2
    v_cvt_pk_bf16_f32 v61, v9, v10
    v_perm_b32 v12, v61, v61, s41
    v_bitop3_b32 v110, v4, v12, v110 bitop3:0xca
    v_perm_b32 v13, v61, v61, s42
    v_bitop3_b32 v111, v4, v13, v111 bitop3:0xca
    s_waitcnt vmcnt(4)
    v_lshlrev_b32 v7, 16, v62
    v_and_b32 v8, 0xffff0000, v62
    v_lshlrev_b32 v9, 16, v63
    v_and_b32 v10, 0xffff0000, v63
    v_mul_f32 v7, 0.15915494, v7
    v_mul_f32 v8, 0.15915494, v8
    v_mul_f32 v9, 0.15915494, v9
    v_mul_f32 v10, 0.15915494, v10
    v_mul_hi_u32_u24 v14, 429497, v20
    v_lshrrev_b32 v12, 3, v24
    v_cos_f32 v7, v7
    v_lshlrev_b16 v13, 3, v24
    v_mad_i32_i24 v11, v14, s55, v20
    v_bitop3_b32 v12, v6, v13, v12 bitop3:0xca
    v_lshl_add_u32 v11, v11, 17, s40
    v_lshlrev_b16 v14, 8, v14
    v_lshrrev_b32 v13, 2, v24
    v_add_u32 v20, v12, v11
    v_bitop3_b32 v24, v5, v13, v14 bitop3:0xea
    ds_add_u32 v24, v2
    v_mul_hi_u32_u24 v14, 429497, v21
    v_lshrrev_b32 v12, 3, v25
    v_cos_f32 v8, v8
    v_lshlrev_b16 v13, 3, v25
    v_mad_i32_i24 v11, v14, s55, v21
    v_bitop3_b32 v12, v6, v13, v12 bitop3:0xca
    v_lshl_add_u32 v11, v11, 17, s40
    v_lshlrev_b16 v14, 8, v14
    v_lshrrev_b32 v13, 2, v25
    v_add_u32 v21, v12, v11
    v_bitop3_b32 v25, v5, v13, v14 bitop3:0xea
    ds_add_u32 v25, v2
    v_cvt_pk_bf16_f32 v62, v7, v8
    v_perm_b32 v12, v62, v62, s41
    v_bitop3_b32 v20, v4, v12, v20 bitop3:0xca
    v_perm_b32 v13, v62, v62, s42
    v_bitop3_b32 v21, v4, v13, v21 bitop3:0xca
    v_mul_hi_u32_u24 v14, 429497, v22
    v_lshrrev_b32 v12, 3, v26
    v_cos_f32 v9, v9
    v_lshlrev_b16 v13, 3, v26
    v_mad_i32_i24 v11, v14, s55, v22
    v_bitop3_b32 v12, v6, v13, v12 bitop3:0xca
    v_lshl_add_u32 v11, v11, 17, s40
    v_lshlrev_b16 v14, 8, v14
    v_lshrrev_b32 v13, 2, v26
    v_add_u32 v22, v12, v11
    v_bitop3_b32 v26, v5, v13, v14 bitop3:0xea
    ds_add_u32 v26, v2
    v_mul_hi_u32_u24 v14, 429497, v23
    v_lshrrev_b32 v12, 3, v27
    v_cos_f32 v10, v10
    v_lshlrev_b16 v13, 3, v27
    v_mad_i32_i24 v11, v14, s55, v23
    v_bitop3_b32 v12, v6, v13, v12 bitop3:0xca
    v_lshl_add_u32 v11, v11, 17, s40
    v_lshlrev_b16 v14, 8, v14
    v_lshrrev_b32 v13, 2, v27
    v_add_u32 v23, v12, v11
    v_bitop3_b32 v27, v5, v13, v14 bitop3:0xea
    ds_add_u32 v27, v2
    v_cvt_pk_bf16_f32 v63, v9, v10
    v_perm_b32 v12, v63, v63, s41
    v_bitop3_b32 v22, v4, v12, v22 bitop3:0xca
    v_perm_b32 v13, v63, v63, s42
    v_bitop3_b32 v23, v4, v13, v23 bitop3:0xca
    v_lshrrev_b32 v8, 2, v0
    v_and_b32 v7, 0x3c00, v0
    v_bitop3_b32 v7, v5, v8, v7 bitop3:0xea
    s_waitcnt lgkmcnt(0)
    s_barrier
    ds_read2st64_b32 v[8:9], v7 offset0:0 offset1:1
    ds_read2st64_b32 v[10:11], v7 offset0:2 offset1:3
    s_add_u32 s46, s35, 0x2a50000
    buffer_store_dwordx4 v[88:91], v0, s[20:23], s46 offen sc1
    s_add_u32 s47, s34, 0x3000000
    s_nop 0
    buffer_load_dwordx2 v[88:89], v1, s[16:19], s47 offen nt
    s_add_u32 s44, s34, 0x3200000
    buffer_load_dwordx2 v[90:91], v1, s[16:19], s44 offen nt
    s_waitcnt lgkmcnt(0)
    v_lshl_or_b32 v12, v9, 16, v8
    v_lshl_or_b32 v13, v11, 16, v10
    v_mov_b32 v14, v12
    v_mov_b32 v15, v13
    s_nop 0
    v_add_u32_dpp v14, v14, v14 row_shr:1 row_mask:0xf bank_mask:0xf bound_ctrl:1
    v_add_u32_dpp v15, v15, v15 row_shr:1 row_mask:0xf bank_mask:0xf bound_ctrl:1
    s_nop 0
    v_add_u32_dpp v14, v14, v14 row_shr:2 row_mask:0xf bank_mask:0xf bound_ctrl:1
    v_add_u32_dpp v15, v15, v15 row_shr:2 row_mask:0xf bank_mask:0xf bound_ctrl:1
    s_nop 0
    v_add_u32_dpp v14, v14, v14 row_shr:4 row_mask:0xf bank_mask:0xf bound_ctrl:1
    v_add_u32_dpp v15, v15, v15 row_shr:4 row_mask:0xf bank_mask:0xf bound_ctrl:1
    s_nop 0
    v_add_u32_dpp v14, v14, v14 row_shr:8 row_mask:0xf bank_mask:0xf bound_ctrl:1
    v_add_u32_dpp v15, v15, v15 row_shr:8 row_mask:0xf bank_mask:0xf bound_ctrl:1
    s_nop 0
    v_add_u32_dpp v14, v14, v14 row_bcast:15 row_mask:0xa bank_mask:0xf
    v_add_u32_dpp v15, v15, v15 row_bcast:15 row_mask:0xa bank_mask:0xf
    s_nop 0
    v_add_u32_dpp v14, v14, v14 row_bcast:31 row_mask:0xc bank_mask:0xf
    v_add_u32_dpp v15, v15, v15 row_bcast:31 row_mask:0xc bank_mask:0xf
    v_readlane_b32 s48, v14, 63
    v_readlane_b32 s49, v15, 63
    s_lshl_b32 s54, s32, 2
    v_mov_b32 v8, s54
    s_and_b32 s50, s48, 0xffff
    s_lshr_b32 s51, s48, 16
    s_and_b32 s52, s49, 0xffff
    s_lshr_b32 s53, s49, 16
    s_add_u32 s51, s51, s50
    s_add_u32 s52, s52, s51
    s_add_u32 s53, s53, s52
    v_mov_b32 v9, s53
    s_mov_b64 exec, 1
    ds_write_b32 v8, v9 offset:16384
    s_mov_b64 exec, -1
    v_and_b32 v8, 60, v7
    s_waitcnt lgkmcnt(0)
    s_barrier
    ds_read_b32 v9, v8 offset:16384
    s_waitcnt lgkmcnt(0)
    v_add_u32_dpp v9, v9, v9 row_shr:1 row_mask:0xf bank_mask:0xf bound_ctrl:1
    s_nop 1
    v_add_u32_dpp v9, v9, v9 row_shr:2 row_mask:0xf bank_mask:0xf bound_ctrl:1
    s_nop 1
    v_add_u32_dpp v9, v9, v9 row_shr:4 row_mask:0xf bank_mask:0xf bound_ctrl:1
    s_nop 1
    v_add_u32_dpp v9, v9, v9 row_shr:8 row_mask:0xf bank_mask:0xf bound_ctrl:1
    s_nop 0
    v_readlane_b32 s54, v9, s32
    s_sub_u32 s54, s54, s53
    s_add_u32 s50, s50, s54
    s_add_u32 s51, s51, s54
    s_add_u32 s52, s52, s54
    s_pack_ll_b32_b16 s48, s54, s50
    s_pack_ll_b32_b16 s49, s51, s52
    v_add_u32 v14, s48, v14
    v_add_u32 v15, s49, v15
    v_sub_u32 v12, v14, v12
    v_sub_u32 v13, v15, v13
    v_and_b32 v8, 0xffff, v12
    v_lshrrev_b32 v9, 16, v12
    v_and_b32 v10, 0xffff, v13
    v_lshrrev_b32 v11, 16, v13
    ds_write2st64_b32 v7, v8, v9 offset0:0 offset1:1
    ds_write2st64_b32 v7, v10, v11 offset0:2 offset1:3
    v_and_b32 v8, 0x3f0, v0
    v_lshl_add_u32 v8, v8, 1, s36
    ds_write_b64 v8, v[12:13] offset:20480
    s_bitset0_b64 exec, 63
    s_not_b64 exec, exec
    ds_write_b64 v8, v[14:15] offset:20512
    s_mov_b64 exec, -1
    s_waitcnt lgkmcnt(0)
    s_barrier
    s_setprio 3
    ds_add_rtn_u32 v76, v76, v2
    ds_add_rtn_u32 v77, v77, v2
    ds_add_rtn_u32 v78, v78, v2
    ds_add_rtn_u32 v79, v79, v2
    ds_read_b128 v[12:15], v0 offset:20480
    v_cmp_gt_u32 vcc, 8448, v0
    ds_add_rtn_u32 v84, v84, v2
    ds_add_rtn_u32 v85, v85, v2
    ds_add_rtn_u32 v86, v86, v2
    ds_add_rtn_u32 v87, v87, v2
    s_setprio 2
    ds_add_rtn_u32 v52, v52, v2
    ds_add_rtn_u32 v53, v53, v2
    ds_add_rtn_u32 v54, v54, v2
    ds_add_rtn_u32 v55, v55, v2
    s_waitcnt lgkmcnt(8)
    s_cbranch_vccz L1_p3
    s_add_u32 s45, s35, 0x5480000
    s_mov_b64 exec, vcc
    buffer_store_dwordx4 v[12:15], v0, s[24:27], s45 offen sc1
    s_mov_b64 exec, -1
L1_p3:
    s_add_u32 s46, s35, 0x2a54000
    buffer_store_dwordx4 v[32:35], v0, s[20:23], s46 offen sc1
    s_add_u32 s47, s33, 0x6400000
    s_nop 0
    buffer_load_dwordx4 v[32:35], v0, s[8:11], s47 offen nt
    ds_add_rtn_u32 v100, v100, v2
    ds_add_rtn_u32 v101, v101, v2
    ds_add_rtn_u32 v102, v102, v2
    ds_add_rtn_u32 v103, v103, v2
    s_setprio 1
    ds_add_rtn_u32 v120, v120, v2
    ds_add_rtn_u32 v121, v121, v2
    ds_add_rtn_u32 v122, v122, v2
    ds_add_rtn_u32 v123, v123, v2
    ds_add_rtn_u32 v124, v124, v2
    ds_add_rtn_u32 v125, v125, v2
    ds_add_rtn_u32 v126, v126, v2
    ds_add_rtn_u32 v127, v127, v2
    s_add_u32 s44, s35, 0x2a58000
    buffer_store_dwordx4 v[36:39], v0, s[20:23], s44 offen sc1
    s_add_u32 s45, s33, 0x6400000
    s_nop 0
    buffer_load_dwordx4 v[36:39], v0, s[12:15], s45 offen nt
    s_setprio 0
    ds_add_rtn_u32 v112, v112, v2
    ds_add_rtn_u32 v113, v113, v2
    ds_add_rtn_u32 v114, v114, v2
    ds_add_rtn_u32 v115, v115, v2
    ds_add_rtn_u32 v24, v24, v2
    ds_add_rtn_u32 v25, v25, v2
    ds_add_rtn_u32 v26, v26, v2
    ds_add_rtn_u32 v27, v27, v2
    s_waitcnt lgkmcnt(0)
    s_barrier
    s_setprio 3
    v_and_b32 v7, -4, v76
    v_lshl_add_u32 v8, v76, 2, v7
    ds_write_b32 v8, v72
    v_lshl_add_u32 v7, v7, 2, v76
    ds_write_b8 v7, v68 offset:16
    v_and_b32 v9, -4, v77
    v_lshl_add_u32 v10, v77, 2, v9
    ds_write_b32 v10, v73
    v_lshl_add_u32 v9, v9, 2, v77
    ds_write_b8_d16_hi v9, v68 offset:16
    v_and_b32 v7, -4, v78
    v_lshl_add_u32 v8, v78, 2, v7
    ds_write_b32 v8, v74
    v_lshl_add_u32 v7, v7, 2, v78
    ds_write_b8 v7, v69 offset:16
    v_and_b32 v9, -4, v79
    v_lshl_add_u32 v10, v79, 2, v9
    ds_write_b32 v10, v75
    v_lshl_add_u32 v9, v9, 2, v79
    ds_write_b8_d16_hi v9, v69 offset:16
    s_add_u32 s46, s35, 0x2a5c000
    buffer_store_dwordx4 v[40:43], v0, s[20:23], s46 offen sc1
    s_add_u32 s47, s33, 0x6800000
    buffer_load_dwordx4 v[72:75], v0, s[8:11], s47 offen nt
    s_add_u32 s44, s33, 0x6800000
    buffer_load_dwordx4 v[76:79], v0, s[12:15], s44 offen nt
    v_and_b32 v7, -4, v84
    v_lshl_add_u32 v8, v84, 2, v7
    ds_write_b32 v8, v80
    v_lshl_add_u32 v7, v7, 2, v84
    ds_write_b8 v7, v70 offset:16
    v_and_b32 v9, -4, v85
    v_lshl_add_u32 v10, v85, 2, v9
    ds_write_b32 v10, v81
    v_lshl_add_u32 v9, v9, 2, v85
    ds_write_b8_d16_hi v9, v70 offset:16
    v_and_b32 v7, -4, v86
    v_lshl_add_u32 v8, v86, 2, v7
    ds_write_b32 v8, v82
    v_lshl_add_u32 v7, v7, 2, v86
    ds_write_b8 v7, v71 offset:16
    v_and_b32 v9, -4, v87
    v_lshl_add_u32 v10, v87, 2, v9
    ds_write_b32 v10, v83
    v_lshl_add_u32 v9, v9, 2, v87
    ds_write_b8_d16_hi v9, v71 offset:16
    s_add_u32 s45, s34, 0x3400000
    buffer_load_dwordx2 v[40:41], v1, s[16:19], s45 offen nt
    s_add_u32 s46, s34, 0x3600000
    buffer_load_dwordx2 v[42:43], v1, s[16:19], s46 offen nt
    s_add_u32 s47, s33, 0x6c00000
    buffer_load_dwordx4 v[80:83], v0, s[8:11], s47 offen nt
    s_setprio 2
    v_and_b32 v7, -4, v52
    v_lshl_add_u32 v8, v52, 2, v7
    ds_write_b32 v8, v96
    v_lshl_add_u32 v7, v7, 2, v52
    ds_write_b8 v7, v48 offset:16
    v_and_b32 v9, -4, v53
    v_lshl_add_u32 v10, v53, 2, v9
    ds_write_b32 v10, v97
    v_lshl_add_u32 v9, v9, 2, v53
    ds_write_b8_d16_hi v9, v48 offset:16
    v_and_b32 v7, -4, v54
    v_lshl_add_u32 v8, v54, 2, v7
    ds_write_b32 v8, v98
    v_lshl_add_u32 v7, v7, 2, v54
    ds_write_b8 v7, v49 offset:16
    v_and_b32 v9, -4, v55
    v_lshl_add_u32 v10, v55, 2, v9
    ds_write_b32 v10, v99
    v_lshl_add_u32 v9, v9, 2, v55
    ds_write_b8_d16_hi v9, v49 offset:16
    s_add_u32 s44, s35, 0x2a60000
    buffer_store_dwordx4 v[44:47], v0, s[20:23], s44 offen sc1
    s_add_u32 s45, s33, 0x6c00000
    buffer_load_dwordx4 v[84:87], v0, s[12:15], s45 offen nt
    v_and_b32 v7, -4, v100
    v_lshl_add_u32 v8, v100, 2, v7
    ds_write_b32 v8, v56
    v_lshl_add_u32 v7, v7, 2, v100
    ds_write_b8 v7, v50 offset:16
    v_and_b32 v9, -4, v101
    v_lshl_add_u32 v10, v101, 2, v9
    ds_write_b32 v10, v57
    v_lshl_add_u32 v9, v9, 2, v101
    ds_write_b8_d16_hi v9, v50 offset:16
    v_and_b32 v7, -4, v102
    v_lshl_add_u32 v8, v102, 2, v7
    ds_write_b32 v8, v58
    v_lshl_add_u32 v7, v7, 2, v102
    ds_write_b8 v7, v51 offset:16
    v_and_b32 v9, -4, v103
    v_lshl_add_u32 v10, v103, 2, v9
    ds_write_b32 v10, v59
    v_lshl_add_u32 v9, v9, 2, v103
    ds_write_b8_d16_hi v9, v51 offset:16
    s_add_u32 s46, s33, 0x7000000
    buffer_load_dwordx4 v[68:71], v0, s[8:11], s46 offen nt
    s_add_u32 s47, s33, 0x7000000
    buffer_load_dwordx4 v[96:99], v0, s[12:15], s47 offen nt
    s_setprio 1
    v_and_b32 v7, -4, v120
    v_lshl_add_u32 v8, v120, 2, v7
    ds_write_b32 v8, v104
    v_lshl_add_u32 v7, v7, 2, v120
    ds_write_b8 v7, v116 offset:16
    v_and_b32 v9, -4, v121
    v_lshl_add_u32 v10, v121, 2, v9
    ds_write_b32 v10, v105
    v_lshl_add_u32 v9, v9, 2, v121
    ds_write_b8_d16_hi v9, v116 offset:16
    v_and_b32 v7, -4, v122
    v_lshl_add_u32 v8, v122, 2, v7
    ds_write_b32 v8, v106
    v_lshl_add_u32 v7, v7, 2, v122
    ds_write_b8 v7, v117 offset:16
    v_and_b32 v9, -4, v123
    v_lshl_add_u32 v10, v123, 2, v9
    ds_write_b32 v10, v107
    v_lshl_add_u32 v9, v9, 2, v123
    ds_write_b8_d16_hi v9, v117 offset:16
    s_add_u32 s44, s34, 0x3800000
    buffer_load_dwordx2 v[52:53], v1, s[16:19], s44 offen nt
    s_add_u32 s45, s34, 0x3a00000
    buffer_load_dwordx2 v[54:55], v1, s[16:19], s45 offen nt
    s_add_u32 s46, s33, 0x7400000
    buffer_load_dwordx4 v[44:47], v0, s[8:11], s46 offen nt
    v_and_b32 v7, -4, v124
    v_lshl_add_u32 v8, v124, 2, v7
    ds_write_b32 v8, v92
    v_lshl_add_u32 v7, v7, 2, v124
    ds_write_b8 v7, v118 offset:16
    v_and_b32 v9, -4, v125
    v_lshl_add_u32 v10, v125, 2, v9
    ds_write_b32 v10, v93
    v_lshl_add_u32 v9, v9, 2, v125
    ds_write_b8_d16_hi v9, v118 offset:16
    v_and_b32 v7, -4, v126
    v_lshl_add_u32 v8, v126, 2, v7
    ds_write_b32 v8, v94
    v_lshl_add_u32 v7, v7, 2, v126
    ds_write_b8 v7, v119 offset:16
    v_and_b32 v9, -4, v127
    v_lshl_add_u32 v10, v127, 2, v9
    ds_write_b32 v10, v95
    v_lshl_add_u32 v9, v9, 2, v127
    ds_write_b8_d16_hi v9, v119 offset:16
    s_add_u32 s47, s35, 0x2a64000
    buffer_store_dwordx4 v[64:67], v0, s[20:23], s47 offen sc1
    s_add_u32 s44, s33, 0x7400000
    buffer_load_dwordx4 v[56:59], v0, s[12:15], s44 offen nt
    s_setprio 0
    v_and_b32 v7, -4, v112
    v_lshl_add_u32 v8, v112, 2, v7
    ds_write_b32 v8, v108
    v_lshl_add_u32 v7, v7, 2, v112
    ds_write_b8 v7, v60 offset:16
    v_and_b32 v9, -4, v113
    v_lshl_add_u32 v10, v113, 2, v9
    ds_write_b32 v10, v109
    v_lshl_add_u32 v9, v9, 2, v113
    ds_write_b8_d16_hi v9, v60 offset:16
    v_and_b32 v7, -4, v114
    v_lshl_add_u32 v8, v114, 2, v7
    ds_write_b32 v8, v110
    v_lshl_add_u32 v7, v7, 2, v114
    ds_write_b8 v7, v61 offset:16
    v_and_b32 v9, -4, v115
    v_lshl_add_u32 v10, v115, 2, v9
    ds_write_b32 v10, v111
    v_lshl_add_u32 v9, v9, 2, v115
    ds_write_b8_d16_hi v9, v61 offset:16
    s_add_u32 s45, s33, 0x7800000
    buffer_load_dwordx4 v[100:103], v0, s[8:11], s45 offen nt
    s_add_u32 s46, s33, 0x7800000
    buffer_load_dwordx4 v[48:51], v0, s[12:15], s46 offen nt
    v_and_b32 v7, -4, v24
    v_lshl_add_u32 v8, v24, 2, v7
    ds_write_b32 v8, v20
    v_lshl_add_u32 v7, v7, 2, v24
    ds_write_b8 v7, v62 offset:16
    v_and_b32 v9, -4, v25
    v_lshl_add_u32 v10, v25, 2, v9
    ds_write_b32 v10, v21
    v_lshl_add_u32 v9, v9, 2, v25
    ds_write_b8_d16_hi v9, v62 offset:16
    v_and_b32 v7, -4, v26
    v_lshl_add_u32 v8, v26, 2, v7
    ds_write_b32 v8, v22
    v_lshl_add_u32 v7, v7, 2, v26
    ds_write_b8 v7, v63 offset:16
    v_and_b32 v9, -4, v27
    v_lshl_add_u32 v10, v27, 2, v9
    ds_write_b32 v10, v23
    v_lshl_add_u32 v9, v9, 2, v27
    ds_write_b8_d16_hi v9, v63 offset:16
    s_add_u32 s47, s34, 0x3c00000
    buffer_load_dwordx2 v[104:105], v1, s[16:19], s47 offen nt
    s_add_u32 s44, s34, 0x3e00000
    buffer_load_dwordx2 v[106:107], v1, s[16:19], s44 offen nt
    v_add_u32 v7, 0x10000, v0
    v_add_u32 v12, 0x20000, v0
    v_mov_b32 v8, 0
    v_mov_b32 v9, 0
    v_mov_b32 v10, 0
    v_mov_b32 v11, 0
    s_waitcnt lgkmcnt(0)
    s_barrier
    ds_read_b128 v[120:123], v0 offset:0
    ds_write_b128 v0, v[8:11]
    ds_read_b128 v[92:95], v0 offset:16384
    ds_read_b128 v[124:127], v0 offset:32768
    ds_read_b128 v[116:119], v0 offset:49152
    ds_read_b128 v[64:67], v7 offset:0
    ds_read_b128 v[108:111], v7 offset:16384
    ds_read_b128 v[112:115], v7 offset:32768
    ds_read_b128 v[20:23], v7 offset:49152
    ds_read_b128 v[24:27], v12 offset:0
    ds_read_b128 v[60:63], v12 offset:16384
    s_waitcnt lgkmcnt(0)
    s_barrier
    s_setprio 3
    s_add_u32 s45, s35, 0x5480000
    buffer_store_dwordx4 v[120:123], v0, s[20:23], s45 offen sc1
    s_add_u32 s46, s33, 0x7c00000
    s_nop 0
    buffer_load_dwordx4 v[120:123], v0, s[8:11], s46 offen nt
    s_add_u32 s47, s35, 0x5484000
    buffer_store_dwordx4 v[92:95], v0, s[20:23], s47 offen sc1
    s_add_u32 s44, s33, 0x7c00000
    s_nop 0
    buffer_load_dwordx4 v[92:95], v0, s[12:15], s44 offen nt
    s_waitcnt vmcnt(27)
    v_lshlrev_b32 v7, 16, v88
    v_and_b32 v8, 0xffff0000, v88
    v_lshlrev_b32 v9, 16, v89
    v_and_b32 v10, 0xffff0000, v89
    v_mul_f32 v7, 0.15915494, v7
    v_mul_f32 v8, 0.15915494, v8
    v_mul_f32 v9, 0.15915494, v9
    v_mul_f32 v10, 0.15915494, v10
    v_mul_hi_u32_u24 v14, 429497, v28
    v_lshrrev_b32 v12, 3, v16
    v_cos_f32 v7, v7
    v_lshlrev_b16 v13, 3, v16
    v_mad_i32_i24 v11, v14, s55, v28
    v_bitop3_b32 v12, v6, v13, v12 bitop3:0xca
    v_lshl_add_u32 v11, v11, 17, s40
    v_lshlrev_b16 v14, 8, v14
    v_lshrrev_b32 v13, 2, v16
    v_add_u32 v28, v12, v11
    v_bitop3_b32 v16, v5, v13, v14 bitop3:0xea
    ds_add_u32 v16, v2
    v_mul_hi_u32_u24 v14, 429497, v29
    v_lshrrev_b32 v12, 3, v17
    v_cos_f32 v8, v8
    v_lshlrev_b16 v13, 3, v17
    v_mad_i32_i24 v11, v14, s55, v29
    v_bitop3_b32 v12, v6, v13, v12 bitop3:0xca
    v_lshl_add_u32 v11, v11, 17, s40
    v_lshlrev_b16 v14, 8, v14
    v_lshrrev_b32 v13, 2, v17
    v_add_u32 v29, v12, v11
    v_bitop3_b32 v17, v5, v13, v14 bitop3:0xea
    ds_add_u32 v17, v2
    v_cvt_pk_bf16_f32 v88, v7, v8
    v_perm_b32 v12, v88, v88, s41
    v_bitop3_b32 v28, v4, v12, v28 bitop3:0xca
    v_perm_b32 v13, v88, v88, s42
    v_bitop3_b32 v29, v4, v13, v29 bitop3:0xca
    v_mul_hi_u32_u24 v14, 429497, v30
    v_lshrrev_b32 v12, 3, v18
    v_cos_f32 v9, v9
    v_lshlrev_b16 v13, 3, v18
    v_mad_i32_i24 v11, v14, s55, v30
    v_bitop3_b32 v12, v6, v13, v12 bitop3:0xca
    v_lshl_add_u32 v11, v11, 17, s40
    v_lshlrev_b16 v14, 8, v14
    v_lshrrev_b32 v13, 2, v18
    v_add_u32 v30, v12, v11
    v_bitop3_b32 v18, v5, v13, v14 bitop3:0xea
    ds_add_u32 v18, v2
    v_mul_hi_u32_u24 v14, 429497, v31
    v_lshrrev_b32 v12, 3, v19
    v_cos_f32 v10, v10
    v_lshlrev_b16 v13, 3, v19
    v_mad_i32_i24 v11, v14, s55, v31
    v_bitop3_b32 v12, v6, v13, v12 bitop3:0xca
    v_lshl_add_u32 v11, v11, 17, s40
    v_lshlrev_b16 v14, 8, v14
    v_lshrrev_b32 v13, 2, v19
    v_add_u32 v31, v12, v11
    v_bitop3_b32 v19, v5, v13, v14 bitop3:0xea
    ds_add_u32 v19, v2
    v_cvt_pk_bf16_f32 v89, v9, v10
    v_perm_b32 v12, v89, v89, s41
    v_bitop3_b32 v30, v4, v12, v30 bitop3:0xca
    v_perm_b32 v13, v89, v89, s42
    v_bitop3_b32 v31, v4, v13, v31 bitop3:0xca
    s_waitcnt vmcnt(23)
    v_lshlrev_b32 v7, 16, v90
    v_and_b32 v8, 0xffff0000, v90
    v_lshlrev_b32 v9, 16, v91
    v_and_b32 v10, 0xffff0000, v91
    v_mul_f32 v7, 0.15915494, v7
    v_mul_f32 v8, 0.15915494, v8
    v_mul_f32 v9, 0.15915494, v9
    v_mul_f32 v10, 0.15915494, v10
    v_mul_hi_u32_u24 v14, 429497, v32
    v_lshrrev_b32 v12, 3, v36
    v_cos_f32 v7, v7
    v_lshlrev_b16 v13, 3, v36
    v_mad_i32_i24 v11, v14, s55, v32
    v_bitop3_b32 v12, v6, v13, v12 bitop3:0xca
    v_lshl_add_u32 v11, v11, 17, s40
    v_lshlrev_b16 v14, 8, v14
    v_lshrrev_b32 v13, 2, v36
    v_add_u32 v32, v12, v11
    v_bitop3_b32 v36, v5, v13, v14 bitop3:0xea
    ds_add_u32 v36, v2
    v_mul_hi_u32_u24 v14, 429497, v33
    v_lshrrev_b32 v12, 3, v37
    v_cos_f32 v8, v8
    v_lshlrev_b16 v13, 3, v37
    v_mad_i32_i24 v11, v14, s55, v33
    v_bitop3_b32 v12, v6, v13, v12 bitop3:0xca
    v_lshl_add_u32 v11, v11, 17, s40
    v_lshlrev_b16 v14, 8, v14
    v_lshrrev_b32 v13, 2, v37
    v_add_u32 v33, v12, v11
    v_bitop3_b32 v37, v5, v13, v14 bitop3:0xea
    ds_add_u32 v37, v2
    v_cvt_pk_bf16_f32 v90, v7, v8
    v_perm_b32 v12, v90, v90, s41
    v_bitop3_b32 v32, v4, v12, v32 bitop3:0xca
    v_perm_b32 v13, v90, v90, s42
    v_bitop3_b32 v33, v4, v13, v33 bitop3:0xca
    v_mul_hi_u32_u24 v14, 429497, v34
    v_lshrrev_b32 v12, 3, v38
    v_cos_f32 v9, v9
    v_lshlrev_b16 v13, 3, v38
    v_mad_i32_i24 v11, v14, s55, v34
    v_bitop3_b32 v12, v6, v13, v12 bitop3:0xca
    v_lshl_add_u32 v11, v11, 17, s40
    v_lshlrev_b16 v14, 8, v14
    v_lshrrev_b32 v13, 2, v38
    v_add_u32 v34, v12, v11
    v_bitop3_b32 v38, v5, v13, v14 bitop3:0xea
    ds_add_u32 v38, v2
    v_mul_hi_u32_u24 v14, 429497, v35
    v_lshrrev_b32 v12, 3, v39
    v_cos_f32 v10, v10
    v_lshlrev_b16 v13, 3, v39
    v_mad_i32_i24 v11, v14, s55, v35
    v_bitop3_b32 v12, v6, v13, v12 bitop3:0xca
    v_lshl_add_u32 v11, v11, 17, s40
    v_lshlrev_b16 v14, 8, v14
    v_lshrrev_b32 v13, 2, v39
    v_add_u32 v35, v12, v11
    v_bitop3_b32 v39, v5, v13, v14 bitop3:0xea
    ds_add_u32 v39, v2
    v_cvt_pk_bf16_f32 v91, v9, v10
    v_perm_b32 v12, v91, v91, s41
    v_bitop3_b32 v34, v4, v12, v34 bitop3:0xca
    v_perm_b32 v13, v91, v91, s42
    v_bitop3_b32 v35, v4, v13, v35 bitop3:0xca
    s_setprio 2
    s_waitcnt vmcnt(18)
    v_lshlrev_b32 v7, 16, v40
    v_and_b32 v8, 0xffff0000, v40
    v_lshlrev_b32 v9, 16, v41
    v_and_b32 v10, 0xffff0000, v41
    v_mul_f32 v7, 0.15915494, v7
    v_mul_f32 v8, 0.15915494, v8
    v_mul_f32 v9, 0.15915494, v9
    v_mul_f32 v10, 0.15915494, v10
    v_mul_hi_u32_u24 v14, 429497, v72
    v_lshrrev_b32 v12, 3, v76
    v_cos_f32 v7, v7
    v_lshlrev_b16 v13, 3, v76
    v_mad_i32_i24 v11, v14, s55, v72
    v_bitop3_b32 v12, v6, v13, v12 bitop3:0xca
    v_lshl_add_u32 v11, v11, 17, s40
    v_lshlrev_b16 v14, 8, v14
    v_lshrrev_b32 v13, 2, v76
    v_add_u32 v72, v12, v11
    v_bitop3_b32 v76, v5, v13, v14 bitop3:0xea
    ds_add_u32 v76, v2
    v_mul_hi_u32_u24 v14, 429497, v73
    v_lshrrev_b32 v12, 3, v77
    v_cos_f32 v8, v8
    v_lshlrev_b16 v13, 3, v77
    v_mad_i32_i24 v11, v14, s55, v73
    v_bitop3_b32 v12, v6, v13, v12 bitop3:0xca
    v_lshl_add_u32 v11, v11, 17, s40
    v_lshlrev_b16 v14, 8, v14
    v_lshrrev_b32 v13, 2, v77
    v_add_u32 v73, v12, v11
    v_bitop3_b32 v77, v5, v13, v14 bitop3:0xea
    ds_add_u32 v77, v2
    v_cvt_pk_bf16_f32 v40, v7, v8
    v_perm_b32 v12, v40, v40, s41
    v_bitop3_b32 v72, v4, v12, v72 bitop3:0xca
    v_perm_b32 v13, v40, v40, s42
    v_bitop3_b32 v73, v4, v13, v73 bitop3:0xca
    v_mul_hi_u32_u24 v14, 429497, v74
    v_lshrrev_b32 v12, 3, v78
    v_cos_f32 v9, v9
    v_lshlrev_b16 v13, 3, v78
    v_mad_i32_i24 v11, v14, s55, v74
    v_bitop3_b32 v12, v6, v13, v12 bitop3:0xca
    v_lshl_add_u32 v11, v11, 17, s40
    v_lshlrev_b16 v14, 8, v14
    v_lshrrev_b32 v13, 2, v78
    v_add_u32 v74, v12, v11
    v_bitop3_b32 v78, v5, v13, v14 bitop3:0xea
    ds_add_u32 v78, v2
    v_mul_hi_u32_u24 v14, 429497, v75
    v_lshrrev_b32 v12, 3, v79
    v_cos_f32 v10, v10
    v_lshlrev_b16 v13, 3, v79
    v_mad_i32_i24 v11, v14, s55, v75
    v_bitop3_b32 v12, v6, v13, v12 bitop3:0xca
    v_lshl_add_u32 v11, v11, 17, s40
    v_lshlrev_b16 v14, 8, v14
    v_lshrrev_b32 v13, 2, v79
    v_add_u32 v75, v12, v11
    v_bitop3_b32 v79, v5, v13, v14 bitop3:0xea
    ds_add_u32 v79, v2
    v_cvt_pk_bf16_f32 v41, v9, v10
    v_perm_b32 v12, v41, v41, s41
    v_bitop3_b32 v74, v4, v12, v74 bitop3:0xca
    v_perm_b32 v13, v41, v41, s42
    v_bitop3_b32 v75, v4, v13, v75 bitop3:0xca
    s_add_u32 s45, s35, 0x5488000
    buffer_store_dwordx4 v[124:127], v0, s[20:23], s45 offen sc1
    s_add_u32 s46, s33, 0x8000000
    s_nop 0
    buffer_load_dwordx4 v[124:127], v0, s[8:11], s46 offen nt
    s_waitcnt vmcnt(17)
    v_lshlrev_b32 v7, 16, v42
    v_and_b32 v8, 0xffff0000, v42
    v_lshlrev_b32 v9, 16, v43
    v_and_b32 v10, 0xffff0000, v43
    v_mul_f32 v7, 0.15915494, v7
    v_mul_f32 v8, 0.15915494, v8
    v_mul_f32 v9, 0.15915494, v9
    v_mul_f32 v10, 0.15915494, v10
    v_mul_hi_u32_u24 v14, 429497, v80
    v_lshrrev_b32 v12, 3, v84
    v_cos_f32 v7, v7
    v_lshlrev_b16 v13, 3, v84
    v_mad_i32_i24 v11, v14, s55, v80
    v_bitop3_b32 v12, v6, v13, v12 bitop3:0xca
    v_lshl_add_u32 v11, v11, 17, s40
    v_lshlrev_b16 v14, 8, v14
    v_lshrrev_b32 v13, 2, v84
    v_add_u32 v80, v12, v11
    v_bitop3_b32 v84, v5, v13, v14 bitop3:0xea
    ds_add_u32 v84, v2
    v_mul_hi_u32_u24 v14, 429497, v81
    v_lshrrev_b32 v12, 3, v85
    v_cos_f32 v8, v8
    v_lshlrev_b16 v13, 3, v85
    v_mad_i32_i24 v11, v14, s55, v81
    v_bitop3_b32 v12, v6, v13, v12 bitop3:0xca
    v_lshl_add_u32 v11, v11, 17, s40
    v_lshlrev_b16 v14, 8, v14
    v_lshrrev_b32 v13, 2, v85
    v_add_u32 v81, v12, v11
    v_bitop3_b32 v85, v5, v13, v14 bitop3:0xea
    ds_add_u32 v85, v2
    v_cvt_pk_bf16_f32 v42, v7, v8
    v_perm_b32 v12, v42, v42, s41
    v_bitop3_b32 v80, v4, v12, v80 bitop3:0xca
    v_perm_b32 v13, v42, v42, s42
    v_bitop3_b32 v81, v4, v13, v81 bitop3:0xca
    v_mul_hi_u32_u24 v14, 429497, v82
    v_lshrrev_b32 v12, 3, v86
    v_cos_f32 v9, v9
    v_lshlrev_b16 v13, 3, v86
    v_mad_i32_i24 v11, v14, s55, v82
    v_bitop3_b32 v12, v6, v13, v12 bitop3:0xca
    v_lshl_add_u32 v11, v11, 17, s40
    v_lshlrev_b16 v14, 8, v14
    v_lshrrev_b32 v13, 2, v86
    v_add_u32 v82, v12, v11
    v_bitop3_b32 v86, v5, v13, v14 bitop3:0xea
    ds_add_u32 v86, v2
    v_mul_hi_u32_u24 v14, 429497, v83
    v_lshrrev_b32 v12, 3, v87
    v_cos_f32 v10, v10
    v_lshlrev_b16 v13, 3, v87
    v_mad_i32_i24 v11, v14, s55, v83
    v_bitop3_b32 v12, v6, v13, v12 bitop3:0xca
    v_lshl_add_u32 v11, v11, 17, s40
    v_lshlrev_b16 v14, 8, v14
    v_lshrrev_b32 v13, 2, v87
    v_add_u32 v83, v12, v11
    v_bitop3_b32 v87, v5, v13, v14 bitop3:0xea
    ds_add_u32 v87, v2
    v_cvt_pk_bf16_f32 v43, v9, v10
    v_perm_b32 v12, v43, v43, s41
    v_bitop3_b32 v82, v4, v12, v82 bitop3:0xca
    v_perm_b32 v13, v43, v43, s42
    v_bitop3_b32 v83, v4, v13, v83 bitop3:0xca
    s_setprio 1
    s_waitcnt vmcnt(13)
    v_lshlrev_b32 v7, 16, v52
    v_and_b32 v8, 0xffff0000, v52
    v_lshlrev_b32 v9, 16, v53
    v_and_b32 v10, 0xffff0000, v53
    v_mul_f32 v7, 0.15915494, v7
    v_mul_f32 v8, 0.15915494, v8
    v_mul_f32 v9, 0.15915494, v9
    v_mul_f32 v10, 0.15915494, v10
    v_mul_hi_u32_u24 v14, 429497, v68
    v_lshrrev_b32 v12, 3, v96
    v_cos_f32 v7, v7
    v_lshlrev_b16 v13, 3, v96
    v_mad_i32_i24 v11, v14, s55, v68
    v_bitop3_b32 v12, v6, v13, v12 bitop3:0xca
    v_lshl_add_u32 v11, v11, 17, s40
    v_lshlrev_b16 v14, 8, v14
    v_lshrrev_b32 v13, 2, v96
    v_add_u32 v68, v12, v11
    v_bitop3_b32 v96, v5, v13, v14 bitop3:0xea
    ds_add_u32 v96, v2
    v_mul_hi_u32_u24 v14, 429497, v69
    v_lshrrev_b32 v12, 3, v97
    v_cos_f32 v8, v8
    v_lshlrev_b16 v13, 3, v97
    v_mad_i32_i24 v11, v14, s55, v69
    v_bitop3_b32 v12, v6, v13, v12 bitop3:0xca
    v_lshl_add_u32 v11, v11, 17, s40
    v_lshlrev_b16 v14, 8, v14
    v_lshrrev_b32 v13, 2, v97
    v_add_u32 v69, v12, v11
    v_bitop3_b32 v97, v5, v13, v14 bitop3:0xea
    ds_add_u32 v97, v2
    v_cvt_pk_bf16_f32 v52, v7, v8
    v_perm_b32 v12, v52, v52, s41
    v_bitop3_b32 v68, v4, v12, v68 bitop3:0xca
    v_perm_b32 v13, v52, v52, s42
    v_bitop3_b32 v69, v4, v13, v69 bitop3:0xca
    v_mul_hi_u32_u24 v14, 429497, v70
    v_lshrrev_b32 v12, 3, v98
    v_cos_f32 v9, v9
    v_lshlrev_b16 v13, 3, v98
    v_mad_i32_i24 v11, v14, s55, v70
    v_bitop3_b32 v12, v6, v13, v12 bitop3:0xca
    v_lshl_add_u32 v11, v11, 17, s40
    v_lshlrev_b16 v14, 8, v14
    v_lshrrev_b32 v13, 2, v98
    v_add_u32 v70, v12, v11
    v_bitop3_b32 v98, v5, v13, v14 bitop3:0xea
    ds_add_u32 v98, v2
    v_mul_hi_u32_u24 v14, 429497, v71
    v_lshrrev_b32 v12, 3, v99
    v_cos_f32 v10, v10
    v_lshlrev_b16 v13, 3, v99
    v_mad_i32_i24 v11, v14, s55, v71
    v_bitop3_b32 v12, v6, v13, v12 bitop3:0xca
    v_lshl_add_u32 v11, v11, 17, s40
    v_lshlrev_b16 v14, 8, v14
    v_lshrrev_b32 v13, 2, v99
    v_add_u32 v71, v12, v11
    v_bitop3_b32 v99, v5, v13, v14 bitop3:0xea
    ds_add_u32 v99, v2
    v_cvt_pk_bf16_f32 v53, v9, v10
    v_perm_b32 v12, v53, v53, s41
    v_bitop3_b32 v70, v4, v12, v70 bitop3:0xca
    v_perm_b32 v13, v53, v53, s42
    v_bitop3_b32 v71, v4, v13, v71 bitop3:0xca
    s_waitcnt vmcnt(10)
    v_lshlrev_b32 v7, 16, v54
    v_and_b32 v8, 0xffff0000, v54
    v_lshlrev_b32 v9, 16, v55
    v_and_b32 v10, 0xffff0000, v55
    v_mul_f32 v7, 0.15915494, v7
    v_mul_f32 v8, 0.15915494, v8
    v_mul_f32 v9, 0.15915494, v9
    v_mul_f32 v10, 0.15915494, v10
    v_mul_hi_u32_u24 v14, 429497, v44
    v_lshrrev_b32 v12, 3, v56
    v_cos_f32 v7, v7
    v_lshlrev_b16 v13, 3, v56
    v_mad_i32_i24 v11, v14, s55, v44
    v_bitop3_b32 v12, v6, v13, v12 bitop3:0xca
    v_lshl_add_u32 v11, v11, 17, s40
    v_lshlrev_b16 v14, 8, v14
    v_lshrrev_b32 v13, 2, v56
    v_add_u32 v44, v12, v11
    v_bitop3_b32 v56, v5, v13, v14 bitop3:0xea
    ds_add_u32 v56, v2
    v_mul_hi_u32_u24 v14, 429497, v45
    v_lshrrev_b32 v12, 3, v57
    v_cos_f32 v8, v8
    v_lshlrev_b16 v13, 3, v57
    v_mad_i32_i24 v11, v14, s55, v45
    v_bitop3_b32 v12, v6, v13, v12 bitop3:0xca
    v_lshl_add_u32 v11, v11, 17, s40
    v_lshlrev_b16 v14, 8, v14
    v_lshrrev_b32 v13, 2, v57
    v_add_u32 v45, v12, v11
    v_bitop3_b32 v57, v5, v13, v14 bitop3:0xea
    ds_add_u32 v57, v2
    v_cvt_pk_bf16_f32 v54, v7, v8
    v_perm_b32 v12, v54, v54, s41
    v_bitop3_b32 v44, v4, v12, v44 bitop3:0xca
    v_perm_b32 v13, v54, v54, s42
    v_bitop3_b32 v45, v4, v13, v45 bitop3:0xca
    v_mul_hi_u32_u24 v14, 429497, v46
    v_lshrrev_b32 v12, 3, v58
    v_cos_f32 v9, v9
    v_lshlrev_b16 v13, 3, v58
    v_mad_i32_i24 v11, v14, s55, v46
    v_bitop3_b32 v12, v6, v13, v12 bitop3:0xca
    v_lshl_add_u32 v11, v11, 17, s40
    v_lshlrev_b16 v14, 8, v14
    v_lshrrev_b32 v13, 2, v58
    v_add_u32 v46, v12, v11
    v_bitop3_b32 v58, v5, v13, v14 bitop3:0xea
    ds_add_u32 v58, v2
    v_mul_hi_u32_u24 v14, 429497, v47
    v_lshrrev_b32 v12, 3, v59
    v_cos_f32 v10, v10
    v_lshlrev_b16 v13, 3, v59
    v_mad_i32_i24 v11, v14, s55, v47
    v_bitop3_b32 v12, v6, v13, v12 bitop3:0xca
    v_lshl_add_u32 v11, v11, 17, s40
    v_lshlrev_b16 v14, 8, v14
    v_lshrrev_b32 v13, 2, v59
    v_add_u32 v47, v12, v11
    v_bitop3_b32 v59, v5, v13, v14 bitop3:0xea
    ds_add_u32 v59, v2
    v_cvt_pk_bf16_f32 v55, v9, v10
    v_perm_b32 v12, v55, v55, s41
    v_bitop3_b32 v46, v4, v12, v46 bitop3:0xca
    v_perm_b32 v13, v55, v55, s42
    v_bitop3_b32 v47, v4, v13, v47 bitop3:0xca
    s_setprio 0
    s_add_u32 s47, s35, 0x548c000
    buffer_store_dwordx4 v[116:119], v0, s[20:23], s47 offen sc1
    s_add_u32 s44, s33, 0x8000000
    s_nop 0
    buffer_load_dwordx4 v[116:119], v0, s[12:15], s44 offen nt
    s_waitcnt vmcnt(8)
    v_lshlrev_b32 v7, 16, v104
    v_and_b32 v8, 0xffff0000, v104
    v_lshlrev_b32 v9, 16, v105
    v_and_b32 v10, 0xffff0000, v105
    v_mul_f32 v7, 0.15915494, v7
    v_mul_f32 v8, 0.15915494, v8
    v_mul_f32 v9, 0.15915494, v9
    v_mul_f32 v10, 0.15915494, v10
    v_mul_hi_u32_u24 v14, 429497, v100
    v_lshrrev_b32 v12, 3, v48
    v_cos_f32 v7, v7
    v_lshlrev_b16 v13, 3, v48
    v_mad_i32_i24 v11, v14, s55, v100
    v_bitop3_b32 v12, v6, v13, v12 bitop3:0xca
    v_lshl_add_u32 v11, v11, 17, s40
    v_lshlrev_b16 v14, 8, v14
    v_lshrrev_b32 v13, 2, v48
    v_add_u32 v100, v12, v11
    v_bitop3_b32 v48, v5, v13, v14 bitop3:0xea
    ds_add_u32 v48, v2
    v_mul_hi_u32_u24 v14, 429497, v101
    v_lshrrev_b32 v12, 3, v49
    v_cos_f32 v8, v8
    v_lshlrev_b16 v13, 3, v49
    v_mad_i32_i24 v11, v14, s55, v101
    v_bitop3_b32 v12, v6, v13, v12 bitop3:0xca
    v_lshl_add_u32 v11, v11, 17, s40
    v_lshlrev_b16 v14, 8, v14
    v_lshrrev_b32 v13, 2, v49
    v_add_u32 v101, v12, v11
    v_bitop3_b32 v49, v5, v13, v14 bitop3:0xea
    ds_add_u32 v49, v2
    v_cvt_pk_bf16_f32 v104, v7, v8
    v_perm_b32 v12, v104, v104, s41
    v_bitop3_b32 v100, v4, v12, v100 bitop3:0xca
    v_perm_b32 v13, v104, v104, s42
    v_bitop3_b32 v101, v4, v13, v101 bitop3:0xca
    v_mul_hi_u32_u24 v14, 429497, v102
    v_lshrrev_b32 v12, 3, v50
    v_cos_f32 v9, v9
    v_lshlrev_b16 v13, 3, v50
    v_mad_i32_i24 v11, v14, s55, v102
    v_bitop3_b32 v12, v6, v13, v12 bitop3:0xca
    v_lshl_add_u32 v11, v11, 17, s40
    v_lshlrev_b16 v14, 8, v14
    v_lshrrev_b32 v13, 2, v50
    v_add_u32 v102, v12, v11
    v_bitop3_b32 v50, v5, v13, v14 bitop3:0xea
    ds_add_u32 v50, v2
    v_mul_hi_u32_u24 v14, 429497, v103
    v_lshrrev_b32 v12, 3, v51
    v_cos_f32 v10, v10
    v_lshlrev_b16 v13, 3, v51
    v_mad_i32_i24 v11, v14, s55, v103
    v_bitop3_b32 v12, v6, v13, v12 bitop3:0xca
    v_lshl_add_u32 v11, v11, 17, s40
    v_lshlrev_b16 v14, 8, v14
    v_lshrrev_b32 v13, 2, v51
    v_add_u32 v103, v12, v11
    v_bitop3_b32 v51, v5, v13, v14 bitop3:0xea
    ds_add_u32 v51, v2
    v_cvt_pk_bf16_f32 v105, v9, v10
    v_perm_b32 v12, v105, v105, s41
    v_bitop3_b32 v102, v4, v12, v102 bitop3:0xca
    v_perm_b32 v13, v105, v105, s42
    v_bitop3_b32 v103, v4, v13, v103 bitop3:0xca
    s_mov_b32 s68, s66
    s_mov_b32 s69, s67
    s_mov_b32 s70, 0x100
    s_mov_b32 s71, 0x20000
    v_mov_b32 v3, 1
    s_cmp_lg_u32 s32, 15
    s_cbranch_scc1 L1_tk
    s_mov_b64 exec, 1
    s_and_b32 s3, s2, 1
    s_lshl_b32 s3, s3, 7
    buffer_atomic_add v3, off, s[68:71], s3 sc0
    s_mov_b64 exec, -1
L1_tk:
    s_waitcnt vmcnt(4)
    v_lshlrev_b32 v7, 16, v106
    v_and_b32 v8, 0xffff0000, v106
    v_lshlrev_b32 v9, 16, v107
    v_and_b32 v10, 0xffff0000, v107
    v_mul_f32 v7, 0.15915494, v7
    v_mul_f32 v8, 0.15915494, v8
    v_mul_f32 v9, 0.15915494, v9
    v_mul_f32 v10, 0.15915494, v10
    v_mul_hi_u32_u24 v14, 429497, v120
    v_lshrrev_b32 v12, 3, v92
    v_cos_f32 v7, v7
    v_lshlrev_b16 v13, 3, v92
    v_mad_i32_i24 v11, v14, s55, v120
    v_bitop3_b32 v12, v6, v13, v12 bitop3:0xca
    v_lshl_add_u32 v11, v11, 17, s40
    v_lshlrev_b16 v14, 8, v14
    v_lshrrev_b32 v13, 2, v92
    v_add_u32 v120, v12, v11
    v_bitop3_b32 v92, v5, v13, v14 bitop3:0xea
    ds_add_u32 v92, v2
    v_mul_hi_u32_u24 v14, 429497, v121
    v_lshrrev_b32 v12, 3, v93
    v_cos_f32 v8, v8
    v_lshlrev_b16 v13, 3, v93
    v_mad_i32_i24 v11, v14, s55, v121
    v_bitop3_b32 v12, v6, v13, v12 bitop3:0xca
    v_lshl_add_u32 v11, v11, 17, s40
    v_lshlrev_b16 v14, 8, v14
    v_lshrrev_b32 v13, 2, v93
    v_add_u32 v121, v12, v11
    v_bitop3_b32 v93, v5, v13, v14 bitop3:0xea
    ds_add_u32 v93, v2
    v_cvt_pk_bf16_f32 v106, v7, v8
    v_perm_b32 v12, v106, v106, s41
    v_bitop3_b32 v120, v4, v12, v120 bitop3:0xca
    v_perm_b32 v13, v106, v106, s42
    v_bitop3_b32 v121, v4, v13, v121 bitop3:0xca
    v_mul_hi_u32_u24 v14, 429497, v122
    v_lshrrev_b32 v12, 3, v94
    v_cos_f32 v9, v9
    v_lshlrev_b16 v13, 3, v94
    v_mad_i32_i24 v11, v14, s55, v122
    v_bitop3_b32 v12, v6, v13, v12 bitop3:0xca
    v_lshl_add_u32 v11, v11, 17, s40
    v_lshlrev_b16 v14, 8, v14
    v_lshrrev_b32 v13, 2, v94
    v_add_u32 v122, v12, v11
    v_bitop3_b32 v94, v5, v13, v14 bitop3:0xea
    ds_add_u32 v94, v2
    v_mul_hi_u32_u24 v14, 429497, v123
    v_lshrrev_b32 v12, 3, v95
    v_cos_f32 v10, v10
    v_lshlrev_b16 v13, 3, v95
    v_mad_i32_i24 v11, v14, s55, v123
    v_bitop3_b32 v12, v6, v13, v12 bitop3:0xca
    v_lshl_add_u32 v11, v11, 17, s40
    v_lshlrev_b16 v14, 8, v14
    v_lshrrev_b32 v13, 2, v95
    v_add_u32 v123, v12, v11
    v_bitop3_b32 v95, v5, v13, v14 bitop3:0xea
    ds_add_u32 v95, v2
    v_cvt_pk_bf16_f32 v107, v9, v10
    v_perm_b32 v12, v107, v107, s41
    v_bitop3_b32 v122, v4, v12, v122 bitop3:0xca
    v_perm_b32 v13, v107, v107, s42
    v_bitop3_b32 v123, v4, v13, v123 bitop3:0xca
    v_lshrrev_b32 v8, 2, v0
    v_and_b32 v7, 0x3c00, v0
    v_bitop3_b32 v7, v5, v8, v7 bitop3:0xea
    s_waitcnt lgkmcnt(0)
    s_barrier
    ds_read2st64_b32 v[8:9], v7 offset0:0 offset1:1
    ds_read2st64_b32 v[10:11], v7 offset0:2 offset1:3
    s_add_u32 s45, s35, 0x5490000
    buffer_store_dwordx4 v[64:67], v0, s[20:23], s45 offen sc1
    s_add_u32 s46, s34, 0x4000000
    s_nop 0
    buffer_load_dwordx2 v[64:65], v1, s[16:19], s46 offen nt
    s_add_u32 s47, s34, 0x4200000
    buffer_load_dwordx2 v[66:67], v1, s[16:19], s47 offen nt
    s_waitcnt lgkmcnt(0)
    v_lshl_or_b32 v12, v9, 16, v8
    v_lshl_or_b32 v13, v11, 16, v10
    v_mov_b32 v14, v12
    v_mov_b32 v15, v13
    s_nop 0
    v_add_u32_dpp v14, v14, v14 row_shr:1 row_mask:0xf bank_mask:0xf bound_ctrl:1
    v_add_u32_dpp v15, v15, v15 row_shr:1 row_mask:0xf bank_mask:0xf bound_ctrl:1
    s_nop 0
    v_add_u32_dpp v14, v14, v14 row_shr:2 row_mask:0xf bank_mask:0xf bound_ctrl:1
    v_add_u32_dpp v15, v15, v15 row_shr:2 row_mask:0xf bank_mask:0xf bound_ctrl:1
    s_nop 0
    v_add_u32_dpp v14, v14, v14 row_shr:4 row_mask:0xf bank_mask:0xf bound_ctrl:1
    v_add_u32_dpp v15, v15, v15 row_shr:4 row_mask:0xf bank_mask:0xf bound_ctrl:1
    s_nop 0
    v_add_u32_dpp v14, v14, v14 row_shr:8 row_mask:0xf bank_mask:0xf bound_ctrl:1
    v_add_u32_dpp v15, v15, v15 row_shr:8 row_mask:0xf bank_mask:0xf bound_ctrl:1
    s_nop 0
    v_add_u32_dpp v14, v14, v14 row_bcast:15 row_mask:0xa bank_mask:0xf
    v_add_u32_dpp v15, v15, v15 row_bcast:15 row_mask:0xa bank_mask:0xf
    s_nop 0
    v_add_u32_dpp v14, v14, v14 row_bcast:31 row_mask:0xc bank_mask:0xf
    v_add_u32_dpp v15, v15, v15 row_bcast:31 row_mask:0xc bank_mask:0xf
    v_readlane_b32 s48, v14, 63
    v_readlane_b32 s49, v15, 63
    s_lshl_b32 s54, s32, 2
    v_mov_b32 v8, s54
    s_and_b32 s50, s48, 0xffff
    s_lshr_b32 s51, s48, 16
    s_and_b32 s52, s49, 0xffff
    s_lshr_b32 s53, s49, 16
    s_add_u32 s51, s51, s50
    s_add_u32 s52, s52, s51
    s_add_u32 s53, s53, s52
    v_mov_b32 v9, s53
    s_mov_b64 exec, 1
    ds_write_b32 v8, v9 offset:16384
    s_waitcnt vmcnt(3)
    ds_write_b32 v8, v3 offset:16448
    s_mov_b64 exec, -1
    v_and_b32 v8, 60, v7
    s_waitcnt lgkmcnt(0)
    s_barrier
    ds_read_b32 v9, v8 offset:16384
    ds_read_b32 v10, v8 offset:16448
    s_waitcnt lgkmcnt(0)
    v_readlane_b32 s84, v10, 15
    s_and_b32 s3, s2, 1
    s_lshl_b32 s3, s3, 7
    s_add_u32 s84, s84, s3
    s_min_u32 s4, s84, 96
    s_min_u32 s5, s84, 192
    s_min_u32 s6, s84, 240
    s_add_u32 s4, s4, s5
    s_add_u32 s4, s4, s6
    s_add_u32 s4, s4, 9467
    s_mov_b32 s4, s84
    s_lshl_b32 s58, s4, 14
    s_lshl_b32 s59, s4, 13
    s_mov_b32 s43, 5
    s_cmp_lt_u32 s84, 96
    s_addc_u32 s43, s43, 0
    s_cmp_lt_u32 s84, 192
    s_addc_u32 s43, s43, 0
    s_cmp_lt_u32 s84, 240
    s_addc_u32 s43, s43, 0
    v_add_u32_dpp v9, v9, v9 row_shr:1 row_mask:0xf bank_mask:0xf bound_ctrl:1
    s_nop 1
    v_add_u32_dpp v9, v9, v9 row_shr:2 row_mask:0xf bank_mask:0xf bound_ctrl:1
    s_nop 1
    v_add_u32_dpp v9, v9, v9 row_shr:4 row_mask:0xf bank_mask:0xf bound_ctrl:1
    s_nop 1
    v_add_u32_dpp v9, v9, v9 row_shr:8 row_mask:0xf bank_mask:0xf bound_ctrl:1
    s_nop 0
    v_readlane_b32 s54, v9, s32
    s_sub_u32 s54, s54, s53
    s_add_u32 s50, s50, s54
    s_add_u32 s51, s51, s54
    s_add_u32 s52, s52, s54
    s_pack_ll_b32_b16 s48, s54, s50
    s_pack_ll_b32_b16 s49, s51, s52
    v_add_u32 v14, s48, v14
    v_add_u32 v15, s49, v15
    v_sub_u32 v12, v14, v12
    v_sub_u32 v13, v15, v13
    v_and_b32 v8, 0xffff, v12
    v_lshrrev_b32 v9, 16, v12
    v_and_b32 v10, 0xffff, v13
    v_lshrrev_b32 v11, 16, v13
    ds_write2st64_b32 v7, v8, v9 offset0:0 offset1:1
    ds_write2st64_b32 v7, v10, v11 offset0:2 offset1:3
    v_and_b32 v8, 0x3f0, v0
    v_lshl_add_u32 v8, v8, 1, s36
    ds_write_b64 v8, v[12:13] offset:20480
    s_bitset0_b64 exec, 63
    s_not_b64 exec, exec
    ds_write_b64 v8, v[14:15] offset:20512
    s_mov_b64 exec, -1
    s_waitcnt lgkmcnt(0)
    s_barrier
    s_setprio 3
    ds_add_rtn_u32 v16, v16, v2
    ds_add_rtn_u32 v17, v17, v2
    ds_add_rtn_u32 v18, v18, v2
    ds_add_rtn_u32 v19, v19, v2
    ds_read_b128 v[12:15], v0 offset:20480
    v_cmp_gt_u32 vcc, 8448, v0
    ds_add_rtn_u32 v36, v36, v2
    ds_add_rtn_u32 v37, v37, v2
    ds_add_rtn_u32 v38, v38, v2
    ds_add_rtn_u32 v39, v39, v2
    s_setprio 2
    ds_add_rtn_u32 v76, v76, v2
    ds_add_rtn_u32 v77, v77, v2
    ds_add_rtn_u32 v78, v78, v2
    ds_add_rtn_u32 v79, v79, v2
    s_waitcnt lgkmcnt(8)
    s_cbranch_vccz L1_p4
    s_add_u32 s44, s35, 0x7ec0000
    s_mov_b64 exec, vcc
    buffer_store_dwordx4 v[12:15], v0, s[24:27], s44 offen sc1
    s_mov_b64 exec, -1
L1_p4:
    s_add_u32 s45, s35, 0x5494000
    buffer_store_dwordx4 v[108:111], v0, s[20:23], s45 offen sc1
    s_add_u32 s46, s33, 0x8400000
    s_nop 0
    buffer_load_dwordx4 v[108:111], v0, s[8:11], s46 offen nt
    ds_add_rtn_u32 v84, v84, v2
    ds_add_rtn_u32 v85, v85, v2
    ds_add_rtn_u32 v86, v86, v2
    ds_add_rtn_u32 v87, v87, v2
    s_setprio 1
    ds_add_rtn_u32 v96, v96, v2
    ds_add_rtn_u32 v97, v97, v2
    ds_add_rtn_u32 v98, v98, v2
    ds_add_rtn_u32 v99, v99, v2
    ds_add_rtn_u32 v56, v56, v2
    ds_add_rtn_u32 v57, v57, v2
    ds_add_rtn_u32 v58, v58, v2
    ds_add_rtn_u32 v59, v59, v2
    s_add_u32 s47, s35, 0x5498000
    buffer_store_dwordx4 v[112:115], v0, s[20:23], s47 offen sc1
    s_add_u32 s44, s33, 0x8400000
    s_nop 0
    buffer_load_dwordx4 v[112:115], v0, s[12:15], s44 offen nt
    s_setprio 0
    ds_add_rtn_u32 v48, v48, v2
    ds_add_rtn_u32 v49, v49, v2
    ds_add_rtn_u32 v50, v50, v2
    ds_add_rtn_u32 v51, v51, v2
    ds_add_rtn_u32 v92, v92, v2
    ds_add_rtn_u32 v93, v93, v2
    ds_add_rtn_u32 v94, v94, v2
    ds_add_rtn_u32 v95, v95, v2
    s_waitcnt lgkmcnt(0)
    s_barrier
    s_setprio 3
    v_and_b32 v7, -4, v16
    v_lshl_add_u32 v8, v16, 2, v7
    ds_write_b32 v8, v28
    v_lshl_add_u32 v7, v7, 2, v16
    ds_write_b8 v7, v88 offset:16
    v_and_b32 v9, -4, v17
    v_lshl_add_u32 v10, v17, 2, v9
    ds_write_b32 v10, v29
    v_lshl_add_u32 v9, v9, 2, v17
    ds_write_b8_d16_hi v9, v88 offset:16
    v_and_b32 v7, -4, v18
    v_lshl_add_u32 v8, v18, 2, v7
    ds_write_b32 v8, v30
    v_lshl_add_u32 v7, v7, 2, v18
    ds_write_b8 v7, v89 offset:16
    v_and_b32 v9, -4, v19
    v_lshl_add_u32 v10, v19, 2, v9
    ds_write_b32 v10, v31
    v_lshl_add_u32 v9, v9, 2, v19
    ds_write_b8_d16_hi v9, v89 offset:16
    s_add_u32 s45, s35, 0x549c000
    buffer_store_dwordx4 v[20:23], v0, s[20:23], s45 offen sc1
    s_add_u32 s46, s33, 0x8800000
    buffer_load_dwordx4 v[28:31], v0, s[8:11], s46 offen nt
    s_add_u32 s47, s33, 0x8800000
    buffer_load_dwordx4 v[16:19], v0, s[12:15], s47 offen nt
    v_and_b32 v7, -4, v36
    v_lshl_add_u32 v8, v36, 2, v7
    ds_write_b32 v8, v32
    v_lshl_add_u32 v7, v7, 2, v36
    ds_write_b8 v7, v90 offset:16
    v_and_b32 v9, -4, v37
    v_lshl_add_u32 v10, v37, 2, v9
    ds_write_b32 v10, v33
    v_lshl_add_u32 v9, v9, 2, v37
    ds_write_b8_d16_hi v9, v90 offset:16
    v_and_b32 v7, -4, v38
    v_lshl_add_u32 v8, v38, 2, v7
    ds_write_b32 v8, v34
    v_lshl_add_u32 v7, v7, 2, v38
    ds_write_b8 v7, v91 offset:16
    v_and_b32 v9, -4, v39
    v_lshl_add_u32 v10, v39, 2, v9
    ds_write_b32 v10, v35
    v_lshl_add_u32 v9, v9, 2, v39
    ds_write_b8_d16_hi v9, v91 offset:16
    s_add_u32 s44, s34, 0x4400000
    buffer_load_dwordx2 v[20:21], v1, s[16:19], s44 offen nt
    s_add_u32 s45, s34, 0x4600000
    buffer_load_dwordx2 v[22:23], v1, s[16:19], s45 offen nt
    s_add_u32 s46, s33, 0x8c00000
    buffer_load_dwordx4 v[32:35], v0, s[8:11], s46 offen nt
    s_setprio 2
    v_and_b32 v7, -4, v76
    v_lshl_add_u32 v8, v76, 2, v7
    ds_write_b32 v8, v72
    v_lshl_add_u32 v7, v7, 2, v76
    ds_write_b8 v7, v40 offset:16
    v_and_b32 v9, -4, v77
    v_lshl_add_u32 v10, v77, 2, v9
    ds_write_b32 v10, v73
    v_lshl_add_u32 v9, v9, 2, v77
    ds_write_b8_d16_hi v9, v40 offset:16
    v_and_b32 v7, -4, v78
    v_lshl_add_u32 v8, v78, 2, v7
    ds_write_b32 v8, v74
    v_lshl_add_u32 v7, v7, 2, v78
    ds_write_b8 v7, v41 offset:16
    v_and_b32 v9, -4, v79
    v_lshl_add_u32 v10, v79, 2, v9
    ds_write_b32 v10, v75
    v_lshl_add_u32 v9, v9, 2, v79
    ds_write_b8_d16_hi v9, v41 offset:16
    s_add_u32 s47, s35, 0x54a0000
    buffer_store_dwordx4 v[24:27], v0, s[20:23], s47 offen sc1
    s_add_u32 s44, s33, 0x8c00000
    buffer_load_dwordx4 v[36:39], v0, s[12:15], s44 offen nt
    v_and_b32 v7, -4, v84
    v_lshl_add_u32 v8, v84, 2, v7
    ds_write_b32 v8, v80
    v_lshl_add_u32 v7, v7, 2, v84
    ds_write_b8 v7, v42 offset:16
    v_and_b32 v9, -4, v85
    v_lshl_add_u32 v10, v85, 2, v9
    ds_write_b32 v10, v81
    v_lshl_add_u32 v9, v9, 2, v85
    ds_write_b8_d16_hi v9, v42 offset:16
    v_and_b32 v7, -4, v86
    v_lshl_add_u32 v8, v86, 2, v7
    ds_write_b32 v8, v82
    v_lshl_add_u32 v7, v7, 2, v86
    ds_write_b8 v7, v43 offset:16
    v_and_b32 v9, -4, v87
    v_lshl_add_u32 v10, v87, 2, v9
    ds_write_b32 v10, v83
    v_lshl_add_u32 v9, v9, 2, v87
    ds_write_b8_d16_hi v9, v43 offset:16
    s_add_u32 s45, s33, 0x9000000
    buffer_load_dwordx4 v[88:91], v0, s[8:11], s45 offen nt
    s_add_u32 s46, s33, 0x9000000
    buffer_load_dwordx4 v[72:75], v0, s[12:15], s46 offen nt
    s_setprio 1
    v_and_b32 v7, -4, v96
    v_lshl_add_u32 v8, v96, 2, v7
    ds_write_b32 v8, v68
    v_lshl_add_u32 v7, v7, 2, v96
    ds_write_b8 v7, v52 offset:16
    v_and_b32 v9, -4, v97
    v_lshl_add_u32 v10, v97, 2, v9
    ds_write_b32 v10, v69
    v_lshl_add_u32 v9, v9, 2, v97
    ds_write_b8_d16_hi v9, v52 offset:16
    v_and_b32 v7, -4, v98
    v_lshl_add_u32 v8, v98, 2, v7
    ds_write_b32 v8, v70
    v_lshl_add_u32 v7, v7, 2, v98
    ds_write_b8 v7, v53 offset:16
    v_and_b32 v9, -4, v99
    v_lshl_add_u32 v10, v99, 2, v9
    ds_write_b32 v10, v71
    v_lshl_add_u32 v9, v9, 2, v99
    ds_write_b8_d16_hi v9, v53 offset:16
    s_add_u32 s47, s34, 0x4800000
    buffer_load_dwordx2 v[76:77], v1, s[16:19], s47 offen nt
    s_cmp_le_u32 s43, 5
    s_cselect_b32 s18, 0, s18
    s_add_u32 s44, s59, 0x4a00000
    buffer_load_dwordx2 v[78:79], v1, s[16:19], s44 offen nt
    s_cmp_le_u32 s43, 5
    s_cselect_b32 s10, 0, s10
    s_add_u32 s45, s58, 0x9400000
    buffer_load_dwordx4 v[24:27], v0, s[8:11], s45 offen nt
    v_and_b32 v7, -4, v56
    v_lshl_add_u32 v8, v56, 2, v7
    ds_write_b32 v8, v44
    v_lshl_add_u32 v7, v7, 2, v56
    ds_write_b8 v7, v54 offset:16
    v_and_b32 v9, -4, v57
    v_lshl_add_u32 v10, v57, 2, v9
    ds_write_b32 v10, v45
    v_lshl_add_u32 v9, v9, 2, v57
    ds_write_b8_d16_hi v9, v54 offset:16
    v_and_b32 v7, -4, v58
    v_lshl_add_u32 v8, v58, 2, v7
    ds_write_b32 v8, v46
    v_lshl_add_u32 v7, v7, 2, v58
    ds_write_b8 v7, v55 offset:16
    v_and_b32 v9, -4, v59
    v_lshl_add_u32 v10, v59, 2, v9
    ds_write_b32 v10, v47
    v_lshl_add_u32 v9, v9, 2, v59
    ds_write_b8_d16_hi v9, v55 offset:16
    s_add_u32 s46, s35, 0x54a4000
    buffer_store_dwordx4 v[60:63], v0, s[20:23], s46 offen sc1
    s_cmp_le_u32 s43, 5
    s_cselect_b32 s14, 0, s14
    s_add_u32 s47, s58, 0x9400000
    buffer_load_dwordx4 v[80:83], v0, s[12:15], s47 offen nt
    s_setprio 0
    v_and_b32 v7, -4, v48
    v_lshl_add_u32 v8, v48, 2, v7
    ds_write_b32 v8, v100
    v_lshl_add_u32 v7, v7, 2, v48
    ds_write_b8 v7, v104 offset:16
    v_and_b32 v9, -4, v49
    v_lshl_add_u32 v10, v49, 2, v9
    ds_write_b32 v10, v101
    v_lshl_add_u32 v9, v9, 2, v49
    ds_write_b8_d16_hi v9, v104 offset:16
    v_and_b32 v7, -4, v50
    v_lshl_add_u32 v8, v50, 2, v7
    ds_write_b32 v8, v102
    v_lshl_add_u32 v7, v7, 2, v50
    ds_write_b8 v7, v105 offset:16
    v_and_b32 v9, -4, v51
    v_lshl_add_u32 v10, v51, 2, v9
    ds_write_b32 v10, v103
    v_lshl_add_u32 v9, v9, 2, v51
    ds_write_b8_d16_hi v9, v105 offset:16
    s_cmp_le_u32 s43, 6
    s_cselect_b32 s10, 0, s10
    s_add_u32 s44, s58, 0x97c0000
    buffer_load_dwordx4 v[84:87], v0, s[8:11], s44 offen nt
    s_cmp_le_u32 s43, 6
    s_cselect_b32 s14, 0, s14
    s_add_u32 s45, s58, 0x97c0000
    buffer_load_dwordx4 v[40:43], v0, s[12:15], s45 offen nt
    v_and_b32 v7, -4, v92
    v_lshl_add_u32 v8, v92, 2, v7
    ds_write_b32 v8, v120
    v_lshl_add_u32 v7, v7, 2, v92
    ds_write_b8 v7, v106 offset:16
    v_and_b32 v9, -4, v93
    v_lshl_add_u32 v10, v93, 2, v9
    ds_write_b32 v10, v121
    v_lshl_add_u32 v9, v9, 2, v93
    ds_write_b8_d16_hi v9, v106 offset:16
    v_and_b32 v7, -4, v94
    v_lshl_add_u32 v8, v94, 2, v7
    ds_write_b32 v8, v122
    v_lshl_add_u32 v7, v7, 2, v94
    ds_write_b8 v7, v107 offset:16
    v_and_b32 v9, -4, v95
    v_lshl_add_u32 v10, v95, 2, v9
    ds_write_b32 v10, v123
    v_lshl_add_u32 v9, v9, 2, v95
    ds_write_b8_d16_hi v9, v107 offset:16
    s_cmp_le_u32 s43, 6
    s_cselect_b32 s18, 0, s18
    s_add_u32 s46, s59, 0x4be0000
    buffer_load_dwordx2 v[68:69], v1, s[16:19], s46 offen nt
    s_cmp_le_u32 s43, 7
    s_cselect_b32 s18, 0, s18
    s_add_u32 s47, s59, 0x4d60000
    buffer_load_dwordx2 v[70:71], v1, s[16:19], s47 offen nt
    s_waitcnt vmcnt(23)
    v_add_u32 v7, 0x10000, v0
    v_add_u32 v12, 0x20000, v0
    v_mov_b32 v8, 0
    v_mov_b32 v9, 0
    v_mov_b32 v10, 0
    v_mov_b32 v11, 0
    s_waitcnt lgkmcnt(0)
    s_barrier
    s_cmp_lg_u32 s32, 0
    s_cbranch_scc1 L1_c1
    s_lshr_b32 s3, s2, 4
    s_lshl_b32 s3, s3, 2
    s_mov_b64 exec, 1
    buffer_atomic_add v2, off, s[68:71], s3 offset:64
    s_mov_b64 exec, -1
L1_c1:
    ds_read_b128 v[96:99], v0 offset:0
    ds_write_b128 v0, v[8:11]
    ds_read_b128 v[44:47], v0 offset:16384
    ds_read_b128 v[56:59], v0 offset:32768
    ds_read_b128 v[52:55], v0 offset:49152
    ds_read_b128 v[60:63], v7 offset:0
    ds_read_b128 v[100:103], v7 offset:16384
    ds_read_b128 v[48:51], v7 offset:32768
    ds_read_b128 v[120:123], v7 offset:49152
    ds_read_b128 v[92:95], v12 offset:0
    ds_read_b128 v[104:107], v12 offset:16384
    s_waitcnt lgkmcnt(0)
    s_barrier
    s_add_u32 s44, s35, 0x7ec0000
    buffer_store_dwordx4 v[96:99], v0, s[20:23], s44 offen sc1
    s_cmp_le_u32 s43, 7
    s_cselect_b32 s10, 0, s10
    s_add_u32 s45, s58, 0x9ac0000
    buffer_load_dwordx4 v[96:99], v0, s[8:11], s45 offen nt
    s_add_u32 s46, s35, 0x7ec4000
    buffer_store_dwordx4 v[44:47], v0, s[20:23], s46 offen sc1
    s_cmp_le_u32 s43, 7
    s_cselect_b32 s14, 0, s14
    s_add_u32 s47, s58, 0x9ac0000
    buffer_load_dwordx4 v[44:47], v0, s[12:15], s47 offen nt
    s_setprio 3
    v_lshlrev_b32 v7, 16, v64
    v_and_b32 v8, 0xffff0000, v64
    v_lshlrev_b32 v9, 16, v65
    v_and_b32 v10, 0xffff0000, v65
    v_mul_f32 v7, 0.15915494, v7
    v_mul_f32 v8, 0.15915494, v8
    v_mul_f32 v9, 0.15915494, v9
    v_mul_f32 v10, 0.15915494, v10
    v_mul_hi_u32_u24 v14, 429497, v124
    v_lshrrev_b32 v12, 3, v116
    v_cos_f32 v7, v7
    v_lshlrev_b16 v13, 3, v116
    v_mad_i32_i24 v11, v14, s55, v124
    v_bitop3_b32 v12, v6, v13, v12 bitop3:0xca
    v_lshl_add_u32 v11, v11, 17, s40
    v_lshlrev_b16 v14, 8, v14
    v_lshrrev_b32 v13, 2, v116
    v_add_u32 v124, v12, v11
    v_bitop3_b32 v116, v5, v13, v14 bitop3:0xea
    ds_add_u32 v116, v2
    v_mul_hi_u32_u24 v14, 429497, v125
    v_lshrrev_b32 v12, 3, v117
    v_cos_f32 v8, v8
    v_lshlrev_b16 v13, 3, v117
    v_mad_i32_i24 v11, v14, s55, v125
    v_bitop3_b32 v12, v6, v13, v12 bitop3:0xca
    v_lshl_add_u32 v11, v11, 17, s40
    v_lshlrev_b16 v14, 8, v14
    v_lshrrev_b32 v13, 2, v117
    v_add_u32 v125, v12, v11
    v_bitop3_b32 v117, v5, v13, v14 bitop3:0xea
    ds_add_u32 v117, v2
    v_cvt_pk_bf16_f32 v64, v7, v8
    v_perm_b32 v12, v64, v64, s41
    v_bitop3_b32 v124, v4, v12, v124 bitop3:0xca
    v_perm_b32 v13, v64, v64, s42
    v_bitop3_b32 v125, v4, v13, v125 bitop3:0xca
    v_mul_hi_u32_u24 v14, 429497, v126
    v_lshrrev_b32 v12, 3, v118
    v_cos_f32 v9, v9
    v_lshlrev_b16 v13, 3, v118
    v_mad_i32_i24 v11, v14, s55, v126
    v_bitop3_b32 v12, v6, v13, v12 bitop3:0xca
    v_lshl_add_u32 v11, v11, 17, s40
    v_lshlrev_b16 v14, 8, v14
    v_lshrrev_b32 v13, 2, v118
    v_add_u32 v126, v12, v11
    v_bitop3_b32 v118, v5, v13, v14 bitop3:0xea
    ds_add_u32 v118, v2
    v_mul_hi_u32_u24 v14, 429497, v127
    v_lshrrev_b32 v12, 3, v119
    v_cos_f32 v10, v10
    v_lshlrev_b16 v13, 3, v119
    v_mad_i32_i24 v11, v14, s55, v127
    v_bitop3_b32 v12, v6, v13, v12 bitop3:0xca
    v_lshl_add_u32 v11, v11, 17, s40
    v_lshlrev_b16 v14, 8, v14
    v_lshrrev_b32 v13, 2, v119
    v_add_u32 v127, v12, v11
    v_bitop3_b32 v119, v5, v13, v14 bitop3:0xea
    ds_add_u32 v119, v2
    v_cvt_pk_bf16_f32 v65, v9, v10
    v_perm_b32 v12, v65, v65, s41
    v_bitop3_b32 v126, v4, v12, v126 bitop3:0xca
    v_perm_b32 v13, v65, v65, s42
    v_bitop3_b32 v127, v4, v13, v127 bitop3:0xca
    s_add_u32 s44, s35, 0x7ec8000
    buffer_store_dwordx4 v[56:59], v0, s[20:23], s44 offen sc1
    s_waitcnt vmcnt(24)
    v_lshlrev_b32 v7, 16, v66
    v_and_b32 v8, 0xffff0000, v66
    v_lshlrev_b32 v9, 16, v67
    v_and_b32 v10, 0xffff0000, v67
    v_mul_f32 v7, 0.15915494, v7
    v_mul_f32 v8, 0.15915494, v8
    v_mul_f32 v9, 0.15915494, v9
    v_mul_f32 v10, 0.15915494, v10
    v_mul_hi_u32_u24 v14, 429497, v108
    v_lshrrev_b32 v12, 3, v112
    v_cos_f32 v7, v7
    v_lshlrev_b16 v13, 3, v112
    v_mad_i32_i24 v11, v14, s55, v108
    v_bitop3_b32 v12, v6, v13, v12 bitop3:0xca
    v_lshl_add_u32 v11, v11, 17, s40
    v_lshlrev_b16 v14, 8, v14
    v_lshrrev_b32 v13, 2, v112
    v_add_u32 v108, v12, v11
    v_bitop3_b32 v112, v5, v13, v14 bitop3:0xea
    ds_add_u32 v112, v2
    v_mul_hi_u32_u24 v14, 429497, v109
    v_lshrrev_b32 v12, 3, v113
    v_cos_f32 v8, v8
    v_lshlrev_b16 v13, 3, v113
    v_mad_i32_i24 v11, v14, s55, v109
    v_bitop3_b32 v12, v6, v13, v12 bitop3:0xca
    v_lshl_add_u32 v11, v11, 17, s40
    v_lshlrev_b16 v14, 8, v14
    v_lshrrev_b32 v13, 2, v113
    v_add_u32 v109, v12, v11
    v_bitop3_b32 v113, v5, v13, v14 bitop3:0xea
    ds_add_u32 v113, v2
    v_cvt_pk_bf16_f32 v66, v7, v8
    v_perm_b32 v12, v66, v66, s41
    v_bitop3_b32 v108, v4, v12, v108 bitop3:0xca
    v_perm_b32 v13, v66, v66, s42
    v_bitop3_b32 v109, v4, v13, v109 bitop3:0xca
    v_mul_hi_u32_u24 v14, 429497, v110
    v_lshrrev_b32 v12, 3, v114
    v_cos_f32 v9, v9
    v_lshlrev_b16 v13, 3, v114
    v_mad_i32_i24 v11, v14, s55, v110
    v_bitop3_b32 v12, v6, v13, v12 bitop3:0xca
    v_lshl_add_u32 v11, v11, 17, s40
    v_lshlrev_b16 v14, 8, v14
    v_lshrrev_b32 v13, 2, v114
    v_add_u32 v110, v12, v11
    v_bitop3_b32 v114, v5, v13, v14 bitop3:0xea
    ds_add_u32 v114, v2
    v_mul_hi_u32_u24 v14, 429497, v111
    v_lshrrev_b32 v12, 3, v115
    v_cos_f32 v10, v10
    v_lshlrev_b16 v13, 3, v115
    v_mad_i32_i24 v11, v14, s55, v111
    v_bitop3_b32 v12, v6, v13, v12 bitop3:0xca
    v_lshl_add_u32 v11, v11, 17, s40
    v_lshlrev_b16 v14, 8, v14
    v_lshrrev_b32 v13, 2, v115
    v_add_u32 v111, v12, v11
    v_bitop3_b32 v115, v5, v13, v14 bitop3:0xea
    ds_add_u32 v115, v2
    v_cvt_pk_bf16_f32 v67, v9, v10
    v_perm_b32 v12, v67, v67, s41
    v_bitop3_b32 v110, v4, v12, v110 bitop3:0xca
    v_perm_b32 v13, v67, v67, s42
    v_bitop3_b32 v111, v4, v13, v111 bitop3:0xca
    s_setprio 2
    s_add_u32 s45, s35, 0x7ecc000
    buffer_store_dwordx4 v[52:55], v0, s[20:23], s45 offen sc1
    s_waitcnt vmcnt(20)
    v_lshlrev_b32 v7, 16, v20
    v_and_b32 v8, 0xffff0000, v20
    v_lshlrev_b32 v9, 16, v21
    v_and_b32 v10, 0xffff0000, v21
    v_mul_f32 v7, 0.15915494, v7
    v_mul_f32 v8, 0.15915494, v8
    v_mul_f32 v9, 0.15915494, v9
    v_mul_f32 v10, 0.15915494, v10
    v_mul_hi_u32_u24 v14, 429497, v28
    v_lshrrev_b32 v12, 3, v16
    v_cos_f32 v7, v7
    v_lshlrev_b16 v13, 3, v16
    v_mad_i32_i24 v11, v14, s55, v28
    v_bitop3_b32 v12, v6, v13, v12 bitop3:0xca
    v_lshl_add_u32 v11, v11, 17, s40
    v_lshlrev_b16 v14, 8, v14
    v_lshrrev_b32 v13, 2, v16
    v_add_u32 v28, v12, v11
    v_bitop3_b32 v16, v5, v13, v14 bitop3:0xea
    ds_add_u32 v16, v2
    v_mul_hi_u32_u24 v14, 429497, v29
    v_lshrrev_b32 v12, 3, v17
    v_cos_f32 v8, v8
    v_lshlrev_b16 v13, 3, v17
    v_mad_i32_i24 v11, v14, s55, v29
    v_bitop3_b32 v12, v6, v13, v12 bitop3:0xca
    v_lshl_add_u32 v11, v11, 17, s40
    v_lshlrev_b16 v14, 8, v14
    v_lshrrev_b32 v13, 2, v17
    v_add_u32 v29, v12, v11
    v_bitop3_b32 v17, v5, v13, v14 bitop3:0xea
    ds_add_u32 v17, v2
    v_cvt_pk_bf16_f32 v20, v7, v8
    v_perm_b32 v12, v20, v20, s41
    v_bitop3_b32 v28, v4, v12, v28 bitop3:0xca
    v_perm_b32 v13, v20, v20, s42
    v_bitop3_b32 v29, v4, v13, v29 bitop3:0xca
    v_mul_hi_u32_u24 v14, 429497, v30
    v_lshrrev_b32 v12, 3, v18
    v_cos_f32 v9, v9
    v_lshlrev_b16 v13, 3, v18
    v_mad_i32_i24 v11, v14, s55, v30
    v_bitop3_b32 v12, v6, v13, v12 bitop3:0xca
    v_lshl_add_u32 v11, v11, 17, s40
    v_lshlrev_b16 v14, 8, v14
    v_lshrrev_b32 v13, 2, v18
    v_add_u32 v30, v12, v11
    v_bitop3_b32 v18, v5, v13, v14 bitop3:0xea
    ds_add_u32 v18, v2
    v_mul_hi_u32_u24 v14, 429497, v31
    v_lshrrev_b32 v12, 3, v19
    v_cos_f32 v10, v10
    v_lshlrev_b16 v13, 3, v19
    v_mad_i32_i24 v11, v14, s55, v31
    v_bitop3_b32 v12, v6, v13, v12 bitop3:0xca
    v_lshl_add_u32 v11, v11, 17, s40
    v_lshlrev_b16 v14, 8, v14
    v_lshrrev_b32 v13, 2, v19
    v_add_u32 v31, v12, v11
    v_bitop3_b32 v19, v5, v13, v14 bitop3:0xea
    ds_add_u32 v19, v2
    v_cvt_pk_bf16_f32 v21, v9, v10
    v_perm_b32 v12, v21, v21, s41
    v_bitop3_b32 v30, v4, v12, v30 bitop3:0xca
    v_perm_b32 v13, v21, v21, s42
    v_bitop3_b32 v31, v4, v13, v31 bitop3:0xca
    s_waitcnt vmcnt(17)
    v_lshlrev_b32 v7, 16, v22
    v_and_b32 v8, 0xffff0000, v22
    v_lshlrev_b32 v9, 16, v23
    v_and_b32 v10, 0xffff0000, v23
    v_mul_f32 v7, 0.15915494, v7
    v_mul_f32 v8, 0.15915494, v8
    v_mul_f32 v9, 0.15915494, v9
    v_mul_f32 v10, 0.15915494, v10
    v_mul_hi_u32_u24 v14, 429497, v32
    v_lshrrev_b32 v12, 3, v36
    v_cos_f32 v7, v7
    v_lshlrev_b16 v13, 3, v36
    v_mad_i32_i24 v11, v14, s55, v32
    v_bitop3_b32 v12, v6, v13, v12 bitop3:0xca
    v_lshl_add_u32 v11, v11, 17, s40
    v_lshlrev_b16 v14, 8, v14
    v_lshrrev_b32 v13, 2, v36
    v_add_u32 v32, v12, v11
    v_bitop3_b32 v36, v5, v13, v14 bitop3:0xea
    ds_add_u32 v36, v2
    v_mul_hi_u32_u24 v14, 429497, v33
    v_lshrrev_b32 v12, 3, v37
    v_cos_f32 v8, v8
    v_lshlrev_b16 v13, 3, v37
    v_mad_i32_i24 v11, v14, s55, v33
    v_bitop3_b32 v12, v6, v13, v12 bitop3:0xca
    v_lshl_add_u32 v11, v11, 17, s40
    v_lshlrev_b16 v14, 8, v14
    v_lshrrev_b32 v13, 2, v37
    v_add_u32 v33, v12, v11
    v_bitop3_b32 v37, v5, v13, v14 bitop3:0xea
    ds_add_u32 v37, v2
    v_cvt_pk_bf16_f32 v22, v7, v8
    v_perm_b32 v12, v22, v22, s41
    v_bitop3_b32 v32, v4, v12, v32 bitop3:0xca
    v_perm_b32 v13, v22, v22, s42
    v_bitop3_b32 v33, v4, v13, v33 bitop3:0xca
    v_mul_hi_u32_u24 v14, 429497, v34
    v_lshrrev_b32 v12, 3, v38
    v_cos_f32 v9, v9
    v_lshlrev_b16 v13, 3, v38
    v_mad_i32_i24 v11, v14, s55, v34
    v_bitop3_b32 v12, v6, v13, v12 bitop3:0xca
    v_lshl_add_u32 v11, v11, 17, s40
    v_lshlrev_b16 v14, 8, v14
    v_lshrrev_b32 v13, 2, v38
    v_add_u32 v34, v12, v11
    v_bitop3_b32 v38, v5, v13, v14 bitop3:0xea
    ds_add_u32 v38, v2
    v_mul_hi_u32_u24 v14, 429497, v35
    v_lshrrev_b32 v12, 3, v39
    v_cos_f32 v10, v10
    v_lshlrev_b16 v13, 3, v39
    v_mad_i32_i24 v11, v14, s55, v35
    v_bitop3_b32 v12, v6, v13, v12 bitop3:0xca
    v_lshl_add_u32 v11, v11, 17, s40
    v_lshlrev_b16 v14, 8, v14
    v_lshrrev_b32 v13, 2, v39
    v_add_u32 v35, v12, v11
    v_bitop3_b32 v39, v5, v13, v14 bitop3:0xea
    ds_add_u32 v39, v2
    v_cvt_pk_bf16_f32 v23, v9, v10
    v_perm_b32 v12, v23, v23, s41
    v_bitop3_b32 v34, v4, v12, v34 bitop3:0xca
    v_perm_b32 v13, v23, v23, s42
    v_bitop3_b32 v35, v4, v13, v35 bitop3:0xca
    s_setprio 1
    s_add_u32 s46, s35, 0x7ed0000
    buffer_store_dwordx4 v[60:63], v0, s[20:23], s46 offen sc1
    v_lshrrev_b32 v15, 2, v0
    v_and_b32 v15, v5, v15
    s_cmp_ge_u32 s84, 128
    s_cselect_b32 s82, 0, s82
    s_and_b32 s3, s84, 1
    s_mul_i32 s3, s3, 40
    s_add_u32 s3, s3, s32
    s_mul_i32 s4, s3, 205
    s_lshr_b32 s4, s4, 10
    s_mul_i32 s5, s4, 5
    s_sub_u32 s5, s3, s5
    s_lshl_b32 s6, s4, 1
    s_add_u32 s6, s6, s5
    s_add_u32 s7, s6, s4
    s_add_u32 s7, s7, 30
    s_cmp_lt_u32 s5, 2
    s_cselect_b32 s6, s6, s7
    s_lshl_b32 s6, s6, 10
    s_lshr_b32 s7, s84, 1
    s_mul_i32 s7, s7, 80000
    s_add_u32 s6, s6, s7
    buffer_load_dword v56, v15, s[80:83], s6 offen offset:0
    buffer_load_dword v57, v15, s[80:83], s6 offen offset:256
    buffer_load_dword v58, v15, s[80:83], s6 offen offset:512
    buffer_load_dword v59, v15, s[80:83], s6 offen offset:768
    s_and_b32 s3, s84, 1
    s_mul_i32 s3, s3, 40
    s_add_u32 s3, s3, s32
    s_add_u32 s3, s3, 16
    s_mul_i32 s4, s3, 205
    s_lshr_b32 s4, s4, 10
    s_mul_i32 s5, s4, 5
    s_sub_u32 s5, s3, s5
    s_lshl_b32 s6, s4, 1
    s_add_u32 s6, s6, s5
    s_add_u32 s7, s6, s4
    s_add_u32 s7, s7, 30
    s_cmp_lt_u32 s5, 2
    s_cselect_b32 s6, s6, s7
    s_lshl_b32 s6, s6, 10
    s_lshr_b32 s7, s84, 1
    s_mul_i32 s7, s7, 80000
    s_add_u32 s6, s6, s7
    buffer_load_dword v52, v15, s[80:83], s6 offen offset:0
    buffer_load_dword v53, v15, s[80:83], s6 offen offset:256
    buffer_load_dword v54, v15, s[80:83], s6 offen offset:512
    buffer_load_dword v55, v15, s[80:83], s6 offen offset:768
    s_and_b32 s3, s84, 1
    s_mul_i32 s3, s3, 40
    s_add_u32 s3, s3, s32
    s_add_u32 s3, s3, 32
    s_cmp_ge_u32 s32, 8
    s_cselect_b32 s82, 0, s82
    s_mul_i32 s4, s3, 205
    s_lshr_b32 s4, s4, 10
    s_mul_i32 s5, s4, 5
    s_sub_u32 s5, s3, s5
    s_lshl_b32 s6, s4, 1
    s_add_u32 s6, s6, s5
    s_add_u32 s7, s6, s4
    s_add_u32 s7, s7, 30
    s_cmp_lt_u32 s5, 2
    s_cselect_b32 s6, s6, s7
    s_lshl_b32 s6, s6, 10
    s_lshr_b32 s7, s84, 1
    s_mul_i32 s7, s7, 80000
    s_add_u32 s6, s6, s7
    buffer_load_dword v60, v15, s[80:83], s6 offen offset:0
    buffer_load_dword v61, v15, s[80:83], s6 offen offset:256
    buffer_load_dword v62, v15, s[80:83], s6 offen offset:512
    buffer_load_dword v63, v15, s[80:83], s6 offen offset:768
    s_waitcnt vmcnt(26)
    v_lshlrev_b32 v7, 16, v76
    v_and_b32 v8, 0xffff0000, v76
    v_lshlrev_b32 v9, 16, v77
    v_and_b32 v10, 0xffff0000, v77
    v_mul_f32 v7, 0.15915494, v7
    v_mul_f32 v8, 0.15915494, v8
    v_mul_f32 v9, 0.15915494, v9
    v_mul_f32 v10, 0.15915494, v10
    v_mul_hi_u32_u24 v14, 429497, v88
    v_lshrrev_b32 v12, 3, v72
    v_cos_f32 v7, v7
    v_lshlrev_b16 v13, 3, v72
    v_mad_i32_i24 v11, v14, s55, v88
    v_bitop3_b32 v12, v6, v13, v12 bitop3:0xca
    v_lshl_add_u32 v11, v11, 17, s40
    v_lshlrev_b16 v14, 8, v14
    v_lshrrev_b32 v13, 2, v72
    v_add_u32 v88, v12, v11
    v_bitop3_b32 v72, v5, v13, v14 bitop3:0xea
    ds_add_u32 v72, v2
    v_mul_hi_u32_u24 v14, 429497, v89
    v_lshrrev_b32 v12, 3, v73
    v_cos_f32 v8, v8
    v_lshlrev_b16 v13, 3, v73
    v_mad_i32_i24 v11, v14, s55, v89
    v_bitop3_b32 v12, v6, v13, v12 bitop3:0xca
    v_lshl_add_u32 v11, v11, 17, s40
    v_lshlrev_b16 v14, 8, v14
    v_lshrrev_b32 v13, 2, v73
    v_add_u32 v89, v12, v11
    v_bitop3_b32 v73, v5, v13, v14 bitop3:0xea
    ds_add_u32 v73, v2
    v_cvt_pk_bf16_f32 v76, v7, v8
    v_perm_b32 v12, v76, v76, s41
    v_bitop3_b32 v88, v4, v12, v88 bitop3:0xca
    v_perm_b32 v13, v76, v76, s42
    v_bitop3_b32 v89, v4, v13, v89 bitop3:0xca
    v_mul_hi_u32_u24 v14, 429497, v90
    v_lshrrev_b32 v12, 3, v74
    v_cos_f32 v9, v9
    v_lshlrev_b16 v13, 3, v74
    v_mad_i32_i24 v11, v14, s55, v90
    v_bitop3_b32 v12, v6, v13, v12 bitop3:0xca
    v_lshl_add_u32 v11, v11, 17, s40
    v_lshlrev_b16 v14, 8, v14
    v_lshrrev_b32 v13, 2, v74
    v_add_u32 v90, v12, v11
    v_bitop3_b32 v74, v5, v13, v14 bitop3:0xea
    ds_add_u32 v74, v2
    v_mul_hi_u32_u24 v14, 429497, v91
    v_lshrrev_b32 v12, 3, v75
    v_cos_f32 v10, v10
    v_lshlrev_b16 v13, 3, v75
    v_mad_i32_i24 v11, v14, s55, v91
    v_bitop3_b32 v12, v6, v13, v12 bitop3:0xca
    v_lshl_add_u32 v11, v11, 17, s40
    v_lshlrev_b16 v14, 8, v14
    v_lshrrev_b32 v13, 2, v75
    v_add_u32 v91, v12, v11
    v_bitop3_b32 v75, v5, v13, v14 bitop3:0xea
    ds_add_u32 v75, v2
    v_cvt_pk_bf16_f32 v77, v9, v10
    v_perm_b32 v12, v77, v77, s41
    v_bitop3_b32 v90, v4, v12, v90 bitop3:0xca
    v_perm_b32 v13, v77, v77, s42
    v_bitop3_b32 v91, v4, v13, v91 bitop3:0xca
    s_waitcnt vmcnt(23)
    s_cmp_le_u32 s43, 5
    s_cbranch_scc1 L1_s5
    v_lshlrev_b32 v7, 16, v78
    v_and_b32 v8, 0xffff0000, v78
    v_lshlrev_b32 v9, 16, v79
    v_and_b32 v10, 0xffff0000, v79
    v_mul_f32 v7, 0.15915494, v7
    v_mul_f32 v8, 0.15915494, v8
    v_mul_f32 v9, 0.15915494, v9
    v_mul_f32 v10, 0.15915494, v10
    v_mul_hi_u32_u24 v14, 429497, v24
    v_lshrrev_b32 v12, 3, v80
    v_cos_f32 v7, v7
    v_lshlrev_b16 v13, 3, v80
    v_mad_i32_i24 v11, v14, s55, v24
    v_bitop3_b32 v12, v6, v13, v12 bitop3:0xca
    v_lshl_add_u32 v11, v11, 17, s40
    v_lshlrev_b16 v14, 8, v14
    v_lshrrev_b32 v13, 2, v80
    v_add_u32 v24, v12, v11
    v_bitop3_b32 v80, v5, v13, v14 bitop3:0xea
    ds_add_u32 v80, v2
    v_mul_hi_u32_u24 v14, 429497, v25
    v_lshrrev_b32 v12, 3, v81
    v_cos_f32 v8, v8
    v_lshlrev_b16 v13, 3, v81
    v_mad_i32_i24 v11, v14, s55, v25
    v_bitop3_b32 v12, v6, v13, v12 bitop3:0xca
    v_lshl_add_u32 v11, v11, 17, s40
    v_lshlrev_b16 v14, 8, v14
    v_lshrrev_b32 v13, 2, v81
    v_add_u32 v25, v12, v11
    v_bitop3_b32 v81, v5, v13, v14 bitop3:0xea
    ds_add_u32 v81, v2
    v_cvt_pk_bf16_f32 v78, v7, v8
    v_perm_b32 v12, v78, v78, s41
    v_bitop3_b32 v24, v4, v12, v24 bitop3:0xca
    v_perm_b32 v13, v78, v78, s42
    v_bitop3_b32 v25, v4, v13, v25 bitop3:0xca
    v_mul_hi_u32_u24 v14, 429497, v26
    v_lshrrev_b32 v12, 3, v82
    v_cos_f32 v9, v9
    v_lshlrev_b16 v13, 3, v82
    v_mad_i32_i24 v11, v14, s55, v26
    v_bitop3_b32 v12, v6, v13, v12 bitop3:0xca
    v_lshl_add_u32 v11, v11, 17, s40
    v_lshlrev_b16 v14, 8, v14
    v_lshrrev_b32 v13, 2, v82
    v_add_u32 v26, v12, v11
    v_bitop3_b32 v82, v5, v13, v14 bitop3:0xea
    ds_add_u32 v82, v2
    v_mul_hi_u32_u24 v14, 429497, v27
    v_lshrrev_b32 v12, 3, v83
    v_cos_f32 v10, v10
    v_lshlrev_b16 v13, 3, v83
    v_mad_i32_i24 v11, v14, s55, v27
    v_bitop3_b32 v12, v6, v13, v12 bitop3:0xca
    v_lshl_add_u32 v11, v11, 17, s40
    v_lshlrev_b16 v14, 8, v14
    v_lshrrev_b32 v13, 2, v83
    v_add_u32 v27, v12, v11
    v_bitop3_b32 v83, v5, v13, v14 bitop3:0xea
    ds_add_u32 v83, v2
    v_cvt_pk_bf16_f32 v79, v9, v10
    v_perm_b32 v12, v79, v79, s41
    v_bitop3_b32 v26, v4, v12, v26 bitop3:0xca
    v_perm_b32 v13, v79, v79, s42
    v_bitop3_b32 v27, v4, v13, v27 bitop3:0xca
L1_s5:
    s_setprio 0
    s_waitcnt vmcnt(19)
    s_cmp_le_u32 s43, 6
    s_cbranch_scc1 L1_s6
    v_lshlrev_b32 v7, 16, v68
    v_and_b32 v8, 0xffff0000, v68
    v_lshlrev_b32 v9, 16, v69
    v_and_b32 v10, 0xffff0000, v69
    v_mul_f32 v7, 0.15915494, v7
    v_mul_f32 v8, 0.15915494, v8
    v_mul_f32 v9, 0.15915494, v9
    v_mul_f32 v10, 0.15915494, v10
    v_mul_hi_u32_u24 v14, 429497, v84
    v_lshrrev_b32 v12, 3, v40
    v_cos_f32 v7, v7
    v_lshlrev_b16 v13, 3, v40
    v_mad_i32_i24 v11, v14, s55, v84
    v_bitop3_b32 v12, v6, v13, v12 bitop3:0xca
    v_lshl_add_u32 v11, v11, 17, s40
    v_lshlrev_b16 v14, 8, v14
    v_lshrrev_b32 v13, 2, v40
    v_add_u32 v84, v12, v11
    v_bitop3_b32 v40, v5, v13, v14 bitop3:0xea
    ds_add_u32 v40, v2
    v_mul_hi_u32_u24 v14, 429497, v85
    v_lshrrev_b32 v12, 3, v41
    v_cos_f32 v8, v8
    v_lshlrev_b16 v13, 3, v41
    v_mad_i32_i24 v11, v14, s55, v85
    v_bitop3_b32 v12, v6, v13, v12 bitop3:0xca
    v_lshl_add_u32 v11, v11, 17, s40
    v_lshlrev_b16 v14, 8, v14
    v_lshrrev_b32 v13, 2, v41
    v_add_u32 v85, v12, v11
    v_bitop3_b32 v41, v5, v13, v14 bitop3:0xea
    ds_add_u32 v41, v2
    v_cvt_pk_bf16_f32 v68, v7, v8
    v_perm_b32 v12, v68, v68, s41
    v_bitop3_b32 v84, v4, v12, v84 bitop3:0xca
    v_perm_b32 v13, v68, v68, s42
    v_bitop3_b32 v85, v4, v13, v85 bitop3:0xca
    v_mul_hi_u32_u24 v14, 429497, v86
    v_lshrrev_b32 v12, 3, v42
    v_cos_f32 v9, v9
    v_lshlrev_b16 v13, 3, v42
    v_mad_i32_i24 v11, v14, s55, v86
    v_bitop3_b32 v12, v6, v13, v12 bitop3:0xca
    v_lshl_add_u32 v11, v11, 17, s40
    v_lshlrev_b16 v14, 8, v14
    v_lshrrev_b32 v13, 2, v42
    v_add_u32 v86, v12, v11
    v_bitop3_b32 v42, v5, v13, v14 bitop3:0xea
    ds_add_u32 v42, v2
    v_mul_hi_u32_u24 v14, 429497, v87
    v_lshrrev_b32 v12, 3, v43
    v_cos_f32 v10, v10
    v_lshlrev_b16 v13, 3, v43
    v_mad_i32_i24 v11, v14, s55, v87
    v_bitop3_b32 v12, v6, v13, v12 bitop3:0xca
    v_lshl_add_u32 v11, v11, 17, s40
    v_lshlrev_b16 v14, 8, v14
    v_lshrrev_b32 v13, 2, v43
    v_add_u32 v87, v12, v11
    v_bitop3_b32 v43, v5, v13, v14 bitop3:0xea
    ds_add_u32 v43, v2
    v_cvt_pk_bf16_f32 v69, v9, v10
    v_perm_b32 v12, v69, v69, s41
    v_bitop3_b32 v86, v4, v12, v86 bitop3:0xca
    v_perm_b32 v13, v69, v69, s42
    v_bitop3_b32 v87, v4, v13, v87 bitop3:0xca
L1_s6:
    s_waitcnt vmcnt(15)
    s_cmp_le_u32 s43, 7
    s_cbranch_scc1 L1_s7
    v_lshlrev_b32 v7, 16, v70
    v_and_b32 v8, 0xffff0000, v70
    v_lshlrev_b32 v9, 16, v71
    v_and_b32 v10, 0xffff0000, v71
    v_mul_f32 v7, 0.15915494, v7
    v_mul_f32 v8, 0.15915494, v8
    v_mul_f32 v9, 0.15915494, v9
    v_mul_f32 v10, 0.15915494, v10
    v_mul_hi_u32_u24 v14, 429497, v96
    v_lshrrev_b32 v12, 3, v44
    v_cos_f32 v7, v7
    v_lshlrev_b16 v13, 3, v44
    v_mad_i32_i24 v11, v14, s55, v96
    v_bitop3_b32 v12, v6, v13, v12 bitop3:0xca
    v_lshl_add_u32 v11, v11, 17, s40
    v_lshlrev_b16 v14, 8, v14
    v_lshrrev_b32 v13, 2, v44
    v_add_u32 v96, v12, v11
    v_bitop3_b32 v44, v5, v13, v14 bitop3:0xea
    ds_add_u32 v44, v2
    v_mul_hi_u32_u24 v14, 429497, v97
    v_lshrrev_b32 v12, 3, v45
    v_cos_f32 v8, v8
    v_lshlrev_b16 v13, 3, v45
    v_mad_i32_i24 v11, v14, s55, v97
    v_bitop3_b32 v12, v6, v13, v12 bitop3:0xca
    v_lshl_add_u32 v11, v11, 17, s40
    v_lshlrev_b16 v14, 8, v14
    v_lshrrev_b32 v13, 2, v45
    v_add_u32 v97, v12, v11
    v_bitop3_b32 v45, v5, v13, v14 bitop3:0xea
    ds_add_u32 v45, v2
    v_cvt_pk_bf16_f32 v70, v7, v8
    v_perm_b32 v12, v70, v70, s41
    v_bitop3_b32 v96, v4, v12, v96 bitop3:0xca
    v_perm_b32 v13, v70, v70, s42
    v_bitop3_b32 v97, v4, v13, v97 bitop3:0xca
    v_mul_hi_u32_u24 v14, 429497, v98
    v_lshrrev_b32 v12, 3, v46
    v_cos_f32 v9, v9
    v_lshlrev_b16 v13, 3, v46
    v_mad_i32_i24 v11, v14, s55, v98
    v_bitop3_b32 v12, v6, v13, v12 bitop3:0xca
    v_lshl_add_u32 v11, v11, 17, s40
    v_lshlrev_b16 v14, 8, v14
    v_lshrrev_b32 v13, 2, v46
    v_add_u32 v98, v12, v11
    v_bitop3_b32 v46, v5, v13, v14 bitop3:0xea
    ds_add_u32 v46, v2
    v_mul_hi_u32_u24 v14, 429497, v99
    v_lshrrev_b32 v12, 3, v47
    v_cos_f32 v10, v10
    v_lshlrev_b16 v13, 3, v47
    v_mad_i32_i24 v11, v14, s55, v99
    v_bitop3_b32 v12, v6, v13, v12 bitop3:0xca
    v_lshl_add_u32 v11, v11, 17, s40
    v_lshlrev_b16 v14, 8, v14
    v_lshrrev_b32 v13, 2, v47
    v_add_u32 v99, v12, v11
    v_bitop3_b32 v47, v5, v13, v14 bitop3:0xea
    ds_add_u32 v47, v2
    v_cvt_pk_bf16_f32 v71, v9, v10
    v_perm_b32 v12, v71, v71, s41
    v_bitop3_b32 v98, v4, v12, v98 bitop3:0xca
    v_perm_b32 v13, v71, v71, s42
    v_bitop3_b32 v99, v4, v13, v99 bitop3:0xca
L1_s7:
    v_lshrrev_b32 v8, 2, v0
    v_and_b32 v7, 0x3c00, v0
    v_bitop3_b32 v7, v5, v8, v7 bitop3:0xea
    s_waitcnt lgkmcnt(0)
    s_barrier
    ds_read2st64_b32 v[8:9], v7 offset0:0 offset1:1
    ds_read2st64_b32 v[10:11], v7 offset0:2 offset1:3
    s_add_u32 s47, s35, 0x7ed4000
    buffer_store_dwordx4 v[100:103], v0, s[20:23], s47 offen sc1
    s_waitcnt lgkmcnt(0)
    v_lshl_or_b32 v12, v9, 16, v8
    v_lshl_or_b32 v13, v11, 16, v10
    v_mov_b32 v14, v12
    v_mov_b32 v15, v13
    s_nop 0
    v_add_u32_dpp v14, v14, v14 row_shr:1 row_mask:0xf bank_mask:0xf bound_ctrl:1
    v_add_u32_dpp v15, v15, v15 row_shr:1 row_mask:0xf bank_mask:0xf bound_ctrl:1
    s_nop 0
    v_add_u32_dpp v14, v14, v14 row_shr:2 row_mask:0xf bank_mask:0xf bound_ctrl:1
    v_add_u32_dpp v15, v15, v15 row_shr:2 row_mask:0xf bank_mask:0xf bound_ctrl:1
    s_nop 0
    v_add_u32_dpp v14, v14, v14 row_shr:4 row_mask:0xf bank_mask:0xf bound_ctrl:1
    v_add_u32_dpp v15, v15, v15 row_shr:4 row_mask:0xf bank_mask:0xf bound_ctrl:1
    s_nop 0
    v_add_u32_dpp v14, v14, v14 row_shr:8 row_mask:0xf bank_mask:0xf bound_ctrl:1
    v_add_u32_dpp v15, v15, v15 row_shr:8 row_mask:0xf bank_mask:0xf bound_ctrl:1
    s_nop 0
    v_add_u32_dpp v14, v14, v14 row_bcast:15 row_mask:0xa bank_mask:0xf
    v_add_u32_dpp v15, v15, v15 row_bcast:15 row_mask:0xa bank_mask:0xf
    s_nop 0
    v_add_u32_dpp v14, v14, v14 row_bcast:31 row_mask:0xc bank_mask:0xf
    v_add_u32_dpp v15, v15, v15 row_bcast:31 row_mask:0xc bank_mask:0xf
    v_readlane_b32 s48, v14, 63
    v_readlane_b32 s49, v15, 63
    s_lshl_b32 s54, s32, 2
    v_mov_b32 v8, s54
    s_and_b32 s50, s48, 0xffff
    s_lshr_b32 s51, s48, 16
    s_and_b32 s52, s49, 0xffff
    s_lshr_b32 s53, s49, 16
    s_add_u32 s51, s51, s50
    s_add_u32 s52, s52, s51
    s_add_u32 s53, s53, s52
    v_mov_b32 v9, s53
    s_mov_b64 exec, 1
    ds_write_b32 v8, v9 offset:16384
    s_mov_b64 exec, -1
    v_and_b32 v8, 60, v7
    s_waitcnt lgkmcnt(0)
    s_barrier
    ds_read_b32 v9, v8 offset:16384
    s_waitcnt lgkmcnt(0)
    v_add_u32_dpp v9, v9, v9 row_shr:1 row_mask:0xf bank_mask:0xf bound_ctrl:1
    s_nop 1
    v_add_u32_dpp v9, v9, v9 row_shr:2 row_mask:0xf bank_mask:0xf bound_ctrl:1
    s_nop 1
    v_add_u32_dpp v9, v9, v9 row_shr:4 row_mask:0xf bank_mask:0xf bound_ctrl:1
    s_nop 1
    v_add_u32_dpp v9, v9, v9 row_shr:8 row_mask:0xf bank_mask:0xf bound_ctrl:1
    s_nop 0
    v_readlane_b32 s54, v9, s32
    s_sub_u32 s54, s54, s53
    s_add_u32 s50, s50, s54
    s_add_u32 s51, s51, s54
    s_add_u32 s52, s52, s54
    s_pack_ll_b32_b16 s48, s54, s50
    s_pack_ll_b32_b16 s49, s51, s52
    v_add_u32 v14, s48, v14
    v_add_u32 v15, s49, v15
    v_sub_u32 v12, v14, v12
    v_sub_u32 v13, v15, v13
    v_and_b32 v8, 0xffff, v12
    v_lshrrev_b32 v9, 16, v12
    v_and_b32 v10, 0xffff, v13
    v_lshrrev_b32 v11, 16, v13
    ds_write2st64_b32 v7, v8, v9 offset0:0 offset1:1
    ds_write2st64_b32 v7, v10, v11 offset0:2 offset1:3
    v_and_b32 v8, 0x3f0, v0
    v_lshl_add_u32 v8, v8, 1, s36
    ds_write_b64 v8, v[12:13] offset:20480
    s_bitset0_b64 exec, 63
    s_not_b64 exec, exec
    ds_write_b64 v8, v[14:15] offset:20512
    s_mov_b64 exec, -1
    s_waitcnt lgkmcnt(0)
    s_barrier
    s_setprio 3
    ds_add_rtn_u32 v116, v116, v2
    ds_add_rtn_u32 v117, v117, v2
    ds_add_rtn_u32 v118, v118, v2
    ds_add_rtn_u32 v119, v119, v2
    ds_read_b128 v[12:15], v0 offset:20480
    v_cmp_gt_u32 vcc, 8448, v0
    ds_add_rtn_u32 v112, v112, v2
    ds_add_rtn_u32 v113, v113, v2
    ds_add_rtn_u32 v114, v114, v2
    ds_add_rtn_u32 v115, v115, v2
    s_setprio 2
    ds_add_rtn_u32 v16, v16, v2
    ds_add_rtn_u32 v17, v17, v2
    ds_add_rtn_u32 v18, v18, v2
    ds_add_rtn_u32 v19, v19, v2
    s_waitcnt lgkmcnt(8)
    s_cbranch_vccz L1_p8
    s_add_u32 s44, s35, 0xa900000
    s_mov_b64 exec, vcc
    buffer_store_dwordx4 v[12:15], v0, s[24:27], s44 offen sc1
    s_mov_b64 exec, -1
L1_p8:
    s_add_u32 s45, s35, 0x7ed8000
    buffer_store_dwordx4 v[48:51], v0, s[20:23], s45 offen sc1
    ds_add_rtn_u32 v36, v36, v2
    ds_add_rtn_u32 v37, v37, v2
    ds_add_rtn_u32 v38, v38, v2
    ds_add_rtn_u32 v39, v39, v2
    s_load_dwordx2 s[28:29], s[0:1], 0
    s_load_dwordx2 s[50:51], s[0:1], 40
    s_load_dwordx2 s[52:53], s[0:1], 24
    s_lshl_b32 s54, s32, 2
    buffer_load_dword v3, off, s[68:71], s54 offset:64 sc1
    s_setprio 1
    ds_add_rtn_u32 v72, v72, v2
    ds_add_rtn_u32 v73, v73, v2
    ds_add_rtn_u32 v74, v74, v2
    ds_add_rtn_u32 v75, v75, v2
    s_add_u32 s80, s30, 0xd340000
    s_addc_u32 s81, s31, 0
    s_mov_b32 s82, 0xa000
    s_mov_b32 s83, 0x20000
    s_min_u32 s3, s84, 127
    s_mul_i32 s3, s3, 40960
    s_add_u32 s80, s80, s3
    s_addc_u32 s81, s81, 0
    s_cmp_ge_u32 s84, 128
    s_cselect_b32 s82, 0, s82
    s_waitcnt vmcnt(3)
    v_add_u32 v9, 0, v0
    buffer_store_dwordx4 v[56:59], v9, s[80:83], 0 offen sc1
    v_add_u32 v9, 16384, v0
    buffer_store_dwordx4 v[52:55], v9, s[80:83], 0 offen sc1
    v_add_u32 v9, 32768, v0
    buffer_store_dwordx4 v[60:63], v9, s[80:83], 0 offen sc1
    s_cmp_le_u32 s43, 5
    s_cbranch_scc1 L1_s9
    ds_add_rtn_u32 v80, v80, v2
    ds_add_rtn_u32 v81, v81, v2
    ds_add_rtn_u32 v82, v82, v2
    ds_add_rtn_u32 v83, v83, v2
L1_s9:
    s_setprio 0
    s_cmp_le_u32 s43, 6
    s_cbranch_scc1 L1_s10
    ds_add_rtn_u32 v40, v40, v2
    ds_add_rtn_u32 v41, v41, v2
    ds_add_rtn_u32 v42, v42, v2
    ds_add_rtn_u32 v43, v43, v2
L1_s10:
    s_cmp_le_u32 s43, 7
    s_cbranch_scc1 L1_s11
    ds_add_rtn_u32 v44, v44, v2
    ds_add_rtn_u32 v45, v45, v2
    ds_add_rtn_u32 v46, v46, v2
    ds_add_rtn_u32 v47, v47, v2
L1_s11:
    s_waitcnt vmcnt(5)
    s_waitcnt lgkmcnt(0)
    s_barrier
    s_cmp_lg_u32 s32, 0
    s_cbranch_scc1 L2_sg1
    s_mov_b64 exec, 1
    v_mov_b32 v11, 1
    buffer_store_dword v11, off, s[60:63], s57 sc1
    s_mov_b64 exec, -1
L2_sg1:
    s_load_dwordx4 s[96:99], s[50:51], 0
    s_mov_b64 s[4:5], s[52:53]
    s_bfe_u32 s33, s2, 0x20001
    s_and_b32 s34, s2, 1
    s_lshl_b32 s34, s34, 5
    s_lshr_b32 s3, s2, 3
    s_add_u32 s34, s34, s3
    s_mul_i32 s39, s33, 2080
    s_lshl_b32 s3, s34, 5
    s_add_u32 s39, s39, s3
    s_mul_i32 s40, s33, 1310720
    s_add_u32 s40, s40, 0x50000
    s_lshl_b32 s38, s32, 11
    s_mul_i32 s100, s32, 3072
    s_mov_b32 s8, s30
    s_mov_b32 s9, s31
    s_mov_b32 s10, 0xd340000
    s_mov_b32 s11, 0x20000
    s_add_u32 s12, s30, 0x28000
    s_addc_u32 s13, s31, 0
    s_mov_b32 s14, 0xd318000
    s_mov_b32 s15, 0x20000
    s_mov_b32 s16, s64
    s_mov_b32 s17, s65
    s_mov_b32 s18, 0x20
    s_mov_b32 s19, 0x20000
    s_mov_b32 s24, s28
    s_mov_b32 s25, s29
    s_mov_b32 s26, 0x4e2000
    s_mov_b32 s27, 0x20000
    v_and_b32 v13, 0x3f0, v0
    v_and_b32 v14, 0x300, v13
    v_bfe_u32 v15, v13, 4, 4
    s_lshl_b32 s3, s32, 4
    v_add3_u32 v14, v14, v15, s3
    v_mul_u32_u24 v2, 173056, v14
    v_lshrrev_b32 v14, 6, v13
    s_add_u32 s3, s3, 0x400
    v_add_u32 v14, s3, v14
    v_mul_u32_u24 v4, 173056, v14
    v_and_b32 v14, 3, v14
    v_and_b32 v15, 0x30, v13
    v_lshl_add_u32 v14, v14, 5, v15
    v_add_u32 v6, v14, v4
    v_lshl_add_u32 v5, v15, 1, v2
    v_lshrrev_b32 v14, 3, v15
    s_setprio 3
    v_and_b32 v7, -4, v116
    v_lshl_add_u32 v8, v116, 2, v7
    ds_write_b32 v8, v124
    v_lshl_add_u32 v7, v7, 2, v116
    ds_write_b8 v7, v64 offset:16
    v_and_b32 v9, -4, v117
    v_lshl_add_u32 v10, v117, 2, v9
    ds_write_b32 v10, v125
    v_lshl_add_u32 v9, v9, 2, v117
    ds_write_b8_d16_hi v9, v64 offset:16
    v_and_b32 v7, -4, v118
    v_lshl_add_u32 v8, v118, 2, v7
    ds_write_b32 v8, v126
    v_lshl_add_u32 v7, v7, 2, v118
    ds_write_b8 v7, v65 offset:16
    v_and_b32 v9, -4, v119
    v_lshl_add_u32 v10, v119, 2, v9
    ds_write_b32 v10, v127
    v_lshl_add_u32 v9, v9, 2, v119
    ds_write_b8_d16_hi v9, v65 offset:16
    s_add_u32 s46, s35, 0x7edc000
    buffer_store_dwordx4 v[120:123], v0, s[20:23], s46 offen sc1
    buffer_load_ushort v100, v14, s[16:19], 0 offen offset:0
    buffer_load_ushort v101, v14, s[16:19], 0 offen offset:8
    buffer_load_ushort v102, v14, s[16:19], 0 offen offset:16
    buffer_load_ushort v103, v14, s[16:19], 0 offen offset:24
    s_waitcnt vmcnt(8)
    v_mov_b32 v1, v3
    v_and_b32 v7, -4, v112
    v_lshl_add_u32 v8, v112, 2, v7
    ds_write_b32 v8, v108
    v_lshl_add_u32 v7, v7, 2, v112
    ds_write_b8 v7, v66 offset:16
    v_and_b32 v9, -4, v113
    v_lshl_add_u32 v10, v113, 2, v9
    ds_write_b32 v10, v109
    v_lshl_add_u32 v9, v9, 2, v113
    ds_write_b8_d16_hi v9, v66 offset:16
    v_and_b32 v7, -4, v114
    v_lshl_add_u32 v8, v114, 2, v7
    ds_write_b32 v8, v110
    v_lshl_add_u32 v7, v7, 2, v114
    ds_write_b8 v7, v67 offset:16
    v_and_b32 v9, -4, v115
    v_lshl_add_u32 v10, v115, 2, v9
    ds_write_b32 v10, v111
    v_lshl_add_u32 v9, v9, 2, v115
    ds_write_b8_d16_hi v9, v67 offset:16
    s_mul_i32 s3, s32, 5120
    v_add_u32 v3, s3, v13
    s_setprio 2
    v_and_b32 v7, -4, v16
    v_lshl_add_u32 v8, v16, 2, v7
    ds_write_b32 v8, v28
    v_lshl_add_u32 v7, v7, 2, v16
    ds_write_b8 v7, v20 offset:16
    v_and_b32 v9, -4, v17
    v_lshl_add_u32 v10, v17, 2, v9
    ds_write_b32 v10, v29
    v_lshl_add_u32 v9, v9, 2, v17
    ds_write_b8_d16_hi v9, v20 offset:16
    v_and_b32 v7, -4, v18
    v_lshl_add_u32 v8, v18, 2, v7
    ds_write_b32 v8, v30
    v_lshl_add_u32 v7, v7, 2, v18
    ds_write_b8 v7, v21 offset:16
    v_and_b32 v9, -4, v19
    v_lshl_add_u32 v10, v19, 2, v9
    ds_write_b32 v10, v31
    v_lshl_add_u32 v9, v9, 2, v19
    ds_write_b8_d16_hi v9, v21 offset:16
    s_add_u32 s47, s35, 0x7ee0000
    buffer_store_dwordx4 v[92:95], v0, s[20:23], s47 offen sc1
    v_and_b32 v7, -4, v36
    v_lshl_add_u32 v8, v36, 2, v7
    ds_write_b32 v8, v32
    v_lshl_add_u32 v7, v7, 2, v36
    ds_write_b8 v7, v22 offset:16
    v_and_b32 v9, -4, v37
    v_lshl_add_u32 v10, v37, 2, v9
    ds_write_b32 v10, v33
    v_lshl_add_u32 v9, v9, 2, v37
    ds_write_b8_d16_hi v9, v22 offset:16
    v_and_b32 v7, -4, v38
    v_lshl_add_u32 v8, v38, 2, v7
    ds_write_b32 v8, v34
    v_lshl_add_u32 v7, v7, 2, v38
    ds_write_b8 v7, v23 offset:16
    v_and_b32 v9, -4, v39
    v_lshl_add_u32 v10, v39, 2, v9
    ds_write_b32 v10, v35
    v_lshl_add_u32 v9, v9, 2, v39
    ds_write_b8_d16_hi v9, v23 offset:16
    s_setprio 1
    v_and_b32 v7, -4, v72
    v_lshl_add_u32 v8, v72, 2, v7
    ds_write_b32 v8, v88
    v_lshl_add_u32 v7, v7, 2, v72
    ds_write_b8 v7, v76 offset:16
    v_and_b32 v9, -4, v73
    v_lshl_add_u32 v10, v73, 2, v9
    ds_write_b32 v10, v89
    v_lshl_add_u32 v9, v9, 2, v73
    ds_write_b8_d16_hi v9, v76 offset:16
    v_and_b32 v7, -4, v74
    v_lshl_add_u32 v8, v74, 2, v7
    ds_write_b32 v8, v90
    v_lshl_add_u32 v7, v7, 2, v74
    ds_write_b8 v7, v77 offset:16
    v_and_b32 v9, -4, v75
    v_lshl_add_u32 v10, v75, 2, v9
    ds_write_b32 v10, v91
    v_lshl_add_u32 v9, v9, 2, v75
    ds_write_b8_d16_hi v9, v77 offset:16
    v_lshrrev_b32 v14, 2, v13
    v_add_u32 v14, s38, v14
    s_mov_b64 exec, 0xffff
    buffer_load_dword v11, v14, s[60:63], 0 offen sc1
    s_mov_b64 exec, -1
    s_cmp_le_u32 s43, 5
    s_cbranch_scc1 L1_s12
    v_and_b32 v7, -4, v80
    v_lshl_add_u32 v8, v80, 2, v7
    ds_write_b32 v8, v24
    v_lshl_add_u32 v7, v7, 2, v80
    ds_write_b8 v7, v78 offset:16
    v_and_b32 v9, -4, v81
    v_lshl_add_u32 v10, v81, 2, v9
    ds_write_b32 v10, v25
    v_lshl_add_u32 v9, v9, 2, v81
    ds_write_b8_d16_hi v9, v78 offset:16
    v_and_b32 v7, -4, v82
    v_lshl_add_u32 v8, v82, 2, v7
    ds_write_b32 v8, v26
    v_lshl_add_u32 v7, v7, 2, v82
    ds_write_b8 v7, v79 offset:16
    v_and_b32 v9, -4, v83
    v_lshl_add_u32 v10, v83, 2, v9
    ds_write_b32 v10, v27
    v_lshl_add_u32 v9, v9, 2, v83
    ds_write_b8_d16_hi v9, v79 offset:16
L1_s12:
    s_add_u32 s44, s35, 0x7ee4000
    buffer_store_dwordx4 v[104:107], v0, s[20:23], s44 offen sc1
    s_setprio 0
    s_cmp_le_u32 s43, 6
    s_cbranch_scc1 L1_s13
    v_and_b32 v7, -4, v40
    v_lshl_add_u32 v8, v40, 2, v7
    ds_write_b32 v8, v84
    v_lshl_add_u32 v7, v7, 2, v40
    ds_write_b8 v7, v68 offset:16
    v_and_b32 v9, -4, v41
    v_lshl_add_u32 v10, v41, 2, v9
    ds_write_b32 v10, v85
    v_lshl_add_u32 v9, v9, 2, v41
    ds_write_b8_d16_hi v9, v68 offset:16
    v_and_b32 v7, -4, v42
    v_lshl_add_u32 v8, v42, 2, v7
    ds_write_b32 v8, v86
    v_lshl_add_u32 v7, v7, 2, v42
    ds_write_b8 v7, v69 offset:16
    v_and_b32 v9, -4, v43
    v_lshl_add_u32 v10, v43, 2, v9
    ds_write_b32 v10, v87
    v_lshl_add_u32 v9, v9, 2, v43
    ds_write_b8_d16_hi v9, v69 offset:16
L1_s13:
    s_cmp_le_u32 s43, 7
    s_cbranch_scc1 L1_s14
    v_and_b32 v7, -4, v44
    v_lshl_add_u32 v8, v44, 2, v7
    ds_write_b32 v8, v96
    v_lshl_add_u32 v7, v7, 2, v44
    ds_write_b8 v7, v70 offset:16
    v_and_b32 v9, -4, v45
    v_lshl_add_u32 v10, v45, 2, v9
    ds_write_b32 v10, v97
    v_lshl_add_u32 v9, v9, 2, v45
    ds_write_b8_d16_hi v9, v70 offset:16
    v_and_b32 v7, -4, v46
    v_lshl_add_u32 v8, v46, 2, v7
    ds_write_b32 v8, v98
    v_lshl_add_u32 v7, v7, 2, v46
    ds_write_b8 v7, v71 offset:16
    v_and_b32 v9, -4, v47
    v_lshl_add_u32 v10, v47, 2, v9
    ds_write_b32 v10, v99
    v_lshl_add_u32 v9, v9, 2, v47
    ds_write_b8_d16_hi v9, v71 offset:16
L1_s14:
    s_waitcnt vmcnt(1)
    v_cmp_gt_u32 vcc, 1, v11
    s_and_b32 s56, vcc_lo, 0xffff
    v_cmp_gt_u32 vcc, 16, v1
    s_or_b32 s56, s56, vcc_lo
    v_add_u32 v7, 0x10000, v0
    v_add_u32 v12, 0x20000, v0
    s_waitcnt lgkmcnt(0)
    s_barrier
    ds_read_b128 v[24:27], v0 offset:0
    ds_read_b128 v[28:31], v0 offset:16384
    ds_read_b128 v[32:35], v0 offset:32768
    ds_read_b128 v[36:39], v0 offset:49152
    ds_read_b128 v[76:79], v7 offset:0
    ds_read_b128 v[80:83], v7 offset:16384
    ds_read_b128 v[84:87], v7 offset:32768
    ds_read_b128 v[104:107], v7 offset:49152
    ds_read_b128 v[68:71], v12 offset:0
    ds_read_b128 v[72:75], v12 offset:16384
    s_waitcnt lgkmcnt(0)
    s_barrier
    v_mov_b32 v92, v0
    v_mov_b32 v93, v6
    v_mov_b32 v94, v13
    v_mov_b32 v95, v5
    s_add_u32 s45, s35, 0xa900000
    buffer_store_dwordx4 v[24:27], v92, s[20:23], s45 offen sc1
    v_mov_b32 v0, v14
    v_lshl_or_b32 v8, v101, 16, v100
    v_lshl_or_b32 v9, v103, 16, v102
    v_lshrrev_b32 v16, 2, v15
    v_mad_u32_u24 v4, v16, 5, v4
    v_or_b32 v4, 0xf0000000, v4
    v_or_b32 v2, 0xf0000000, v2
    v_sub_u32 v1, 28, v16
    v_lshrrev_b32 v17, 2, v16
    v_and_b32 v18, 3, v17
    v_lshlrev_b32 v18, 4, v18
    v_mov_b32 v10, 0x3f80
    v_mov_b32 v11, 0
    v_lshlrev_b64 v[10:11], v18, v[10:11]
    v_and_b32 v18, 3, v17
    v_lshlrev_b32 v18, 4, v18
    v_mov_b32 v12, 0xbf80
    v_mov_b32 v13, 0
    v_lshlrev_b64 v[12:13], v18, v[12:13]
    v_mov_b32 v45, 0xf0000000
    v_mov_b32 v5, 0x1fff8
    v_mov_b32 v6, 0x07ff0000
    s_add_u32 s46, s35, 0xa904000
    buffer_store_dwordx4 v[28:31], v92, s[20:23], s46 offen sc1
    v_mov_b32 v16, 0
    v_mov_b32 v17, 0
    v_mov_b32 v18, 0
    v_mov_b32 v19, 0
    v_add_u32 v20, 81920, v92
    v_add_u32 v21, 0x10000, v20
    ds_write_b128 v20, v[16:19] offset:0
    s_add_u32 s47, s35, 0xa908000
    buffer_store_dwordx4 v[32:35], v92, s[20:23], s47 offen sc1
    ds_write_b128 v20, v[16:19] offset:16384
    s_add_u32 s44, s35, 0xa90c000
    buffer_store_dwordx4 v[36:39], v92, s[20:23], s44 offen sc1
    ds_write_b128 v20, v[16:19] offset:32768
    s_add_u32 s45, s35, 0xa910000
    buffer_store_dwordx4 v[76:79], v92, s[20:23], s45 offen sc1
    ds_write_b128 v20, v[16:19] offset:49152
    s_add_u32 s46, s35, 0xa914000
    buffer_store_dwordx4 v[80:83], v92, s[20:23], s46 offen sc1
    ds_write_b128 v21, v[16:19]
    s_add_u32 s47, s35, 0xa918000
    buffer_store_dwordx4 v[84:87], v92, s[20:23], s47 offen sc1
    s_cmp_le_u32 s43, 5
    s_cbranch_scc1 L1_q15
    s_add_u32 s44, s35, 0xa91c000
    buffer_store_dwordx4 v[104:107], v92, s[20:23], s44 offen sc1
L1_q15:
    s_cmp_le_u32 s43, 6
    s_cbranch_scc1 L1_q16
    s_add_u32 s45, s35, 0xa920000
    buffer_store_dwordx4 v[68:71], v92, s[20:23], s45 offen sc1
L1_q16:
    s_cmp_le_u32 s43, 7
    s_cbranch_scc1 L1_q17
    s_add_u32 s46, s35, 0xa924000
    buffer_store_dwordx4 v[72:75], v92, s[20:23], s46 offen sc1
L1_q17:
    s_mov_b32 s44, 0x4000c0c
    s_mov_b32 s45, 0x4010c0c
    s_mov_b32 s46, 0x4020c0c
    s_mov_b32 s47, 0x4030c0c
    s_mov_b32 s36, 0
    s_mov_b32 s42, 0
    s_mov_b64 s[80:81], 0
    s_mov_b64 s[84:85], 0
    s_mov_b64 s[48:49], 0
    s_add_u32 s16, s30, 0xd340000
    s_addc_u32 s17, s31, 0
    s_mov_b32 s18, 0x500000
    s_mov_b32 s19, 0x20000
    s_add_u32 s20, s30, 0xd841000
    s_addc_u32 s21, s31, 0
    s_mov_b32 s22, 0x13880
    s_mov_b32 s23, 0x20000
    s_lshl_b32 s3, s33, 6
    s_add_u32 s3, s3, s34
    s_mul_i32 s3, s3, 80000
    s_add_u32 s20, s20, s3
    s_addc_u32 s21, s21, 0
    v_mov_b32 v68, 0
    v_mov_b32 v69, 0
    v_mov_b32 v70, 0
    v_mov_b32 v71, 0
    v_mov_b32 v72, 0
    v_mov_b32 v73, 0
    v_mov_b32 v74, 0
    v_mov_b32 v75, 0
    s_waitcnt vmcnt(0)
    s_barrier
    s_cmp_lg_u32 s32, 0
    s_cbranch_scc1 L2_sg2
    s_mov_b64 exec, 1
    v_mov_b32 v88, 2
    buffer_store_dword v88, off, s[60:63], s57 sc1
    s_mov_b64 exec, -1
L2_sg2:
    s_cmp_eq_u32 s56, 0
    s_cbranch_scc1 L2_e1
    v_mov_b32 v89, 0
L2_c1:
    v_cmp_gt_u32 vcc, 16, v89
    s_cbranch_vccnz L2_c1w
    s_mov_b64 exec, 0xffff
L2_p1:
    buffer_load_dword v88, v0, s[60:63], 0 offen sc1
    s_waitcnt vmcnt(0)
    v_cmp_gt_u32 vcc, 1, v88
    s_cbranch_vccnz L2_p1
    s_mov_b64 exec, -1
L2_e1:
    buffer_load_dwordx4 v[48:51], v95, s[12:15], s39 offen offset:0
    buffer_load_dwordx4 v[56:59], v95, s[12:15], s39 offen offset:32
    buffer_load_dwordx4 v[52:55], v95, s[12:15], s39 offen offset:16
    buffer_load_dwordx4 v[60:63], v95, s[12:15], s39 offen offset:48
    buffer_load_dwordx4 v[64:67], v93, s[12:15], s39 offen
    s_mul_i32 s3, s33, 1280000
    s_add_u32 s3, s3, s100
    s_add_u32 s3, s3, 32768
    buffer_load_dwordx4 v[124:127], v94, s[24:27], s3 offen offset:2048
    s_mul_i32 s3, s33, 1280000
    s_add_u32 s3, s3, s100
    s_add_u32 s3, s3, 32768
    buffer_load_dwordx4 v[116:119], v94, s[24:27], s3 offen offset:0
    s_mul_i32 s3, s33, 1280000
    s_add_u32 s3, s3, s100
    s_add_u32 s3, s3, 32768
    buffer_load_dwordx4 v[120:123], v94, s[24:27], s3 offen offset:1024
    s_mul_i32 s3, s33, 1280000
    s_add_u32 s3, s3, s38
    s_add_u32 s3, s3, 0
    buffer_load_dwordx4 v[108:111], v94, s[24:27], s3 offen offset:0
    s_mul_i32 s3, s33, 1280000
    s_add_u32 s3, s3, s38
    s_add_u32 s3, s3, 0
    buffer_load_dwordx4 v[112:115], v94, s[24:27], s3 offen offset:1024
    s_waitcnt vmcnt(5)
    v_sub_u16 v88, v56, v48
    v_and_b32 v89, 3, v48
    v_add3_u32 v99, v88, v89, 3
    v_and_b32 v99, -4, v99
    v_max_u32 v99, 4, v99
    v_and_b32 v97, 0xfffc, v48
    v_bfm_b32 v96, v88, v89
    v_add_u32_dpp v91, v99, v99 row_shr:1 row_mask:0xf bank_mask:0xf bound_ctrl:1
    v_mad_u32_u24 v97, v97, 5, v2
    v_cmp_lt_u32 vcc, 16, v99
    v_add_u32_dpp v91, v91, v91 row_shr:2 row_mask:0xf bank_mask:0xf bound_ctrl:1
    v_sub_u32 v98, s38, v99
    v_lshrrev_b64 v[48:49], 16, v[48:49]
    v_add_u32_dpp v91, v91, v91 row_shr:4 row_mask:0xf bank_mask:0xf bound_ctrl:1
    v_lshrrev_b64 v[56:57], 16, v[56:57]
    s_mov_b32 s101, 0
    v_add_u32_dpp v91, v91, v91 row_shr:8 row_mask:0xf bank_mask:0xf bound_ctrl:1
    s_nop 1
    v_add_u32_dpp v91, v91, v91 row_bcast:15 row_mask:0xa bank_mask:0xf
    s_nop 1
    v_add_u32_dpp v91, v91, v91 row_bcast:31 row_mask:0xc bank_mask:0xf
    v_add_u32 v98, v98, v91
    v_readlane_b32 s37, v91, 63
    s_cbranch_vccnz L2_xo3
L2_xp3:
    v_mov_b32 v44, v43
    s_cmp_gt_u32 s37, 1024
    s_cbranch_scc1 L2_xs4
    s_cmp_lg_u32 s101, 0
    s_cbranch_scc1 L2_xa4
L2_xb4:
    v_lshlrev_b32 v89, 16, v96
    v_add_u32 v90, 60, v97
    v_bitop3_b32 v90, v89, v45, v90 bitop3:0x6a
    ds_write_b32 v98, v90 offset:12
    v_lshlrev_b32 v89, 20, v96
    v_add_u32 v90, 40, v97
    v_bitop3_b32 v90, v89, v45, v90 bitop3:0x6a
    ds_write_b32 v98, v90 offset:8
    v_lshlrev_b32 v89, 24, v96
    v_add_u32 v90, 20, v97
    v_bitop3_b32 v90, v89, v45, v90 bitop3:0x6a
    ds_write_b32 v98, v90 offset:4
    v_lshlrev_b32 v89, 28, v96
    v_bitop3_b32 v90, v89, v45, v97 bitop3:0x6a
    ds_write_b32 v98, v90 offset:0
    v_mov_b32_dpp v91, v64 quad_perm:[0,0,0,0] row_mask:0xf bank_mask:0xf
    v_and_b32 v89, 3, v91
    v_and_b32 v97, 0xfffc, v91
    v_sub_u16_dpp v88, v64, v91 quad_perm:[2,2,2,2] row_mask:0xf bank_mask:0xf
    v_mad_u32_u24 v97, v97, 5, v4
    v_add_u32 v99, v88, v89
    v_bfm_b32 v96, v88, v89
    v_cmp_lt_u32 s[58:59], 16, v99
    v_lshlrev_b32 v89, v1, v96
    v_and_b32 v89, v45, v89
    v_cmp_ne_u32 vcc, 0, v89
    v_xor_b32 v90, v97, v89
    s_add_u32 s3, s37, s38
    v_mbcnt_lo_u32_b32 v98, vcc_lo, 0
    v_mbcnt_hi_u32_b32 v98, vcc_hi, v98
    s_bcnt1_i32_b64 s41, vcc
    v_lshl_add_u32 v98, v98, 2, s3
    s_mov_b64 exec, vcc
    ds_write_b32 v98, v90
    s_mov_b64 exec, -1
    s_lshl2_add_u32 s37, s41, s37
    s_cmp_lg_u64 s[58:59], 0
    s_cbranch_scc1 L2_xe4
L2_xr4:
    v_add_u32 v98, s37, v0
    v_mov_b32 v90, -1
    ds_write_b32 v98, v90
    ds_read2st64_b32 v[40:41], v0 offset0:0 offset1:1
    ds_read2st64_b32 v[42:43], v0 offset0:2 offset1:3
    s_sub_u32 s3, s37, 768
    s_cmp_gt_u32 s3, 256
    s_cbranch_scc1 L2_xf4
L2_xg4:
    v_sub_u16 v88, v58, v50
    v_and_b32 v89, 3, v50
    v_add3_u32 v99, v88, v89, 3
    v_and_b32 v99, -4, v99
    v_max_u32 v99, 4, v99
    v_and_b32 v97, 0xfffc, v50
    v_bfm_b32 v96, v88, v89
    v_add_u32_dpp v91, v99, v99 row_shr:1 row_mask:0xf bank_mask:0xf bound_ctrl:1
    v_mad_u32_u24 v97, v97, 5, v2
    v_cmp_lt_u32 vcc, 16, v99
    v_add_u32_dpp v91, v91, v91 row_shr:2 row_mask:0xf bank_mask:0xf bound_ctrl:1
    v_sub_u32 v98, s38, v99
    v_lshrrev_b64 v[50:51], 16, v[50:51]
    v_add_u32_dpp v91, v91, v91 row_shr:4 row_mask:0xf bank_mask:0xf bound_ctrl:1
    v_lshrrev_b64 v[58:59], 16, v[58:59]
    s_mov_b32 s101, 0
    v_add_u32_dpp v91, v91, v91 row_shr:8 row_mask:0xf bank_mask:0xf bound_ctrl:1
    s_nop 1
    v_add_u32_dpp v91, v91, v91 row_bcast:15 row_mask:0xa bank_mask:0xf
    s_nop 1
    v_add_u32_dpp v91, v91, v91 row_bcast:31 row_mask:0xc bank_mask:0xf
    v_add_u32 v98, v98, v91
    v_readlane_b32 s37, v91, 63
    s_cbranch_vccnz L2_xo5
L2_xp5:
    s_waitcnt lgkmcnt(0)
    v_mov_b32 v21, v40
    v_mov_b32 v27, v41
    v_mov_b32 v33, v42
    v_mov_b32 v39, v43
    v_mov_b32 v44, v43
    s_cmp_gt_u32 s37, 1024
    s_cbranch_scc1 L2_xs6
    s_cmp_lg_u32 s101, 0
    s_cbranch_scc1 L2_xa6
L2_xb6:
    v_lshlrev_b32 v89, 16, v96
    v_add_u32 v90, 60, v97
    v_bitop3_b32 v90, v89, v45, v90 bitop3:0x6a
    ds_write_b32 v98, v90 offset:12
    v_lshlrev_b32 v89, 20, v96
    v_add_u32 v90, 40, v97
    v_bitop3_b32 v90, v89, v45, v90 bitop3:0x6a
    ds_write_b32 v98, v90 offset:8
    v_lshlrev_b32 v89, 24, v96
    v_add_u32 v90, 20, v97
    v_bitop3_b32 v90, v89, v45, v90 bitop3:0x6a
    ds_write_b32 v98, v90 offset:4
    v_lshlrev_b32 v89, 28, v96
    v_bitop3_b32 v90, v89, v45, v97 bitop3:0x6a
    ds_write_b32 v98, v90 offset:0
    v_mov_b32_dpp v91, v66 quad_perm:[0,0,0,0] row_mask:0xf bank_mask:0xf
    v_and_b32 v89, 3, v91
    v_and_b32 v97, 0xfffc, v91
    v_sub_u16_dpp v88, v66, v91 quad_perm:[2,2,2,2] row_mask:0xf bank_mask:0xf
    v_mad_u32_u24 v97, v97, 5, v4
    v_add_u32 v99, v88, v89
    v_bfm_b32 v96, v88, v89
    v_cmp_lt_u32 s[58:59], 16, v99
    v_lshlrev_b32 v89, v1, v96
    v_and_b32 v89, v45, v89
    v_cmp_ne_u32 vcc, 0, v89
    v_xor_b32 v90, v97, v89
    s_add_u32 s3, s37, s38
    v_mbcnt_lo_u32_b32 v98, vcc_lo, 0
    v_mbcnt_hi_u32_b32 v98, vcc_hi, v98
    s_bcnt1_i32_b64 s41, vcc
    v_lshl_add_u32 v98, v98, 2, s3
    s_mov_b64 exec, vcc
    ds_write_b32 v98, v90
    s_mov_b64 exec, -1
    s_lshl2_add_u32 s37, s41, s37
    s_cmp_lg_u64 s[58:59], 0
    s_cbranch_scc1 L2_xe6
L2_xr6:
    v_add_u32 v98, s37, v0
    v_mov_b32 v90, -1
    ds_write_b32 v98, v90
    ds_read2st64_b32 v[40:41], v0 offset0:0 offset1:1
    ds_read2st64_b32 v[42:43], v0 offset0:2 offset1:3
    s_sub_u32 s3, s37, 768
    s_cmp_gt_u32 s3, 256
    s_cbranch_scc1 L2_xf6
L2_xg6:
    s_waitcnt vmcnt(4)
    v_subrev_u32 v88, s38, v3
    ds_write_b128 v88, v[124:127] offset:34816
    s_waitcnt vmcnt(3)
    v_subrev_u32 v88, s38, v3
    ds_write_b128 v88, v[116:119] offset:32768
    s_waitcnt vmcnt(2)
    v_subrev_u32 v88, s38, v3
    ds_write_b128 v88, v[120:123] offset:33792
    s_waitcnt vmcnt(1)
    v_subrev_u32 v88, s100, v3
    ds_write_b128 v88, v[108:111] offset:0
    s_waitcnt vmcnt(0)
    v_subrev_u32 v88, s100, v3
    ds_write_b128 v88, v[112:115] offset:1024
    s_mov_b64 exec, 0xffff
    buffer_load_dword v88, v0, s[60:63], 0 offen sc1
    s_mov_b64 exec, -1
    s_waitcnt lgkmcnt(0)
    s_barrier
    s_waitcnt vmcnt(0)
    v_cmp_gt_u32 vcc, 2, v88
    s_and_b32 s56, vcc_lo, 0xffff
    s_cbranch_scc0 L2_e2
    s_mul_i32 s3, s33, 1280000
    s_add_u32 s3, s3, s100
    s_add_u32 s3, s3, 352768
    buffer_load_dwordx4 v[124:127], v94, s[24:27], s3 offen offset:2048
    s_mul_i32 s3, s33, 1280000
    s_add_u32 s3, s3, s100
    s_add_u32 s3, s3, 352768
    buffer_load_dwordx4 v[116:119], v94, s[24:27], s3 offen offset:0
    s_mul_i32 s3, s33, 1280000
    s_add_u32 s3, s3, s100
    s_add_u32 s3, s3, 352768
    buffer_load_dwordx4 v[120:123], v94, s[24:27], s3 offen offset:1024
    s_mul_i32 s3, s33, 1280000
    s_add_u32 s3, s3, s38
    s_add_u32 s3, s3, 320000
    buffer_load_dwordx4 v[108:111], v94, s[24:27], s3 offen offset:0
    s_mul_i32 s3, s33, 1280000
    s_add_u32 s3, s3, s38
    s_add_u32 s3, s3, 320000
    buffer_load_dwordx4 v[112:115], v94, s[24:27], s3 offen offset:1024
    s_mov_b64 exec, 0xffff
L2_p2:
    buffer_load_dword v88, v0, s[60:63], 0 offen sc1
    s_waitcnt vmcnt(0)
    v_cmp_gt_u32 vcc, 2, v88
    s_cbranch_vccnz L2_p2
    s_mov_b64 exec, -1
L2_e2:
    v_and_b32 v47, 0x0fffffff, v21
    buffer_load_dwordx2 v[16:17], v47, s[8:11], 0 offen
    buffer_load_dwordx3 v[18:20], v47, s[8:11], 0 offen offset:8
    s_bitcmp1_b32 s36, s42
    s_cbranch_scc1 L2_slow
L2_ret0:
    s_setprio 3
    v_and_b32 v47, 0x0fffffff, v27
    buffer_load_dwordx2 v[22:23], v47, s[8:11], 0 offen
    buffer_load_dwordx3 v[24:26], v47, s[8:11], 0 offen offset:8
    s_waitcnt vmcnt(2)
    v_and_b32 v46, 0x20000000, v21
    v_lshrrev_b32 v47, 14, v17
    v_bitop3_b32 v47, v47, v5, v46 bitop3:0xea
    ds_read_b64 v[102:103], v47
    v_bitop3_b32 v93, v17, v5, v46 bitop3:0xea
    v_and_b32 v46, 0x10000000, v21
    v_lshrrev_b32 v47, 14, v16
    v_bitop3_b32 v47, v47, v5, v46 bitop3:0xea
    ds_read_b64 v[100:101], v47
    v_bitop3_b32 v92, v16, v5, v46 bitop3:0xea
    v_perm_b32 v15, v17, v20, s45
    v_bitop3_b32 v46, v17, 0.5, -0.5 bitop3:0xa8
    v_perm_b32 v14, v16, v20, s44
    v_bitop3_b32 v47, v16, 0.5, -0.5 bitop3:0xa8
    s_waitcnt lgkmcnt(0)
    v_mfma_f32_4x4x4_16b_bf16 v[80:83], v[8:9], v[102:103], 0
    v_mfma_f32_4x4x4_16b_bf16 v[76:79], v[8:9], v[100:101], 0
    v_bitop3_b32 v15, v6, v15, v46 bitop3:0xca
    v_bitop3_b32 v14, v6, v14, v47 bitop3:0xca
    v_cmp_lt_u32 s[84:85], v5, v92
    s_nop 0
    v_pk_mul_f32 v[80:81], v[80:81], v[14:15] op_sel:[0,1] op_sel_hi:[1,1]
    v_pk_mul_f32 v[82:83], v[82:83], v[14:15] op_sel:[0,1] op_sel_hi:[1,1]
    v_pk_mul_f32 v[76:77], v[76:77], v[14:15] op_sel:[0,0] op_sel_hi:[1,0]
    v_pk_mul_f32 v[78:79], v[78:79], v[14:15] op_sel:[0,0] op_sel_hi:[1,0]
    v_and_b32 v47, 0x0fffffff, v33
    buffer_load_dwordx2 v[28:29], v47, s[8:11], 0 offen
    buffer_load_dwordx3 v[30:32], v47, s[8:11], 0 offen offset:8
    v_cmpx_ne_u64 vcc, v[74:75], v[70:71]
    s_and_b64 s[82:83], vcc, s[80:81]
    s_cbranch_scc1 L2_c7
L2_d7:
    v_mov_b64 v[84:85], v[70:71]
    v_mov_b32 v7, v95
    v_mov_b64 v[86:87], v[74:75]
    s_mov_b64 exec, -1
    s_or_b64 s[80:81], s[80:81], vcc
    v_cmpx_ne_u64 vcc, v[72:73], v[68:69]
    s_and_b64 s[82:83], vcc, s[80:81]
    s_cbranch_scc1 L2_c8
L2_d8:
    v_mov_b64 v[84:85], v[68:69]
    v_mov_b32 v7, v94
    v_mov_b64 v[86:87], v[72:73]
    s_mov_b64 exec, -1
    s_or_b64 s[80:81], s[80:81], vcc
    ds_read_b64 v[70:71], v93 offset:65408
    s_and_b64 exec, s[84:85], s[80:81]
    v_mfma_f32_4x4x4_16b_bf16 v[76:79], v[12:13], v[84:85], 0
    v_mov_b32 v92, v7
    s_andn2_b64 s[80:81], s[80:81], s[84:85]
    v_mfma_f32_4x4x4_16b_bf16 v[76:79], v[10:11], v[86:87], v[76:79]
    s_mov_b64 exec, -1
    ds_read_b64 v[68:69], v92 offset:65408
    v_and_b32 v46, 0x80000000, v21
    v_lshrrev_b32 v47, 14, v19
    v_bitop3_b32 v47, v47, v5, v46 bitop3:0xea
    ds_read_b64 v[106:107], v47
    v_bitop3_b32 v95, v19, v5, v46 bitop3:0xea
    v_and_b32 v46, 0x40000000, v21
    v_lshrrev_b32 v47, 14, v18
    v_bitop3_b32 v47, v47, v5, v46 bitop3:0xea
    ds_read_b64 v[104:105], v47
    v_bitop3_b32 v94, v18, v5, v46 bitop3:0xea
    s_waitcnt lgkmcnt(2)
    v_mfma_f32_4x4x4_16b_bf16 v[80:83], v[10:11], v[70:71], v[80:83]
    v_mfma_f32_4x4x4_16b_bf16 v[76:79], v[10:11], v[68:69], v[76:79]
    v_perm_b32 v15, v19, v20, s47
    v_bitop3_b32 v46, v19, 0.5, -0.5 bitop3:0xa8
    v_perm_b32 v14, v18, v20, s46
    v_bitop3_b32 v47, v18, 0.5, -0.5 bitop3:0xa8
    v_cvt_pk_bf16_f32 v80, v80, v81
    v_cvt_pk_bf16_f32 v81, v82, v83
    ds_wrxchg_rtn_b64 v[74:75], v93, v[80:81] offset:65408
    v_cvt_pk_bf16_f32 v76, v76, v77
    v_cvt_pk_bf16_f32 v77, v78, v79
    ds_wrxchg_rtn_b64 v[72:73], v92, v[76:77] offset:65408
    s_setprio 2
    s_waitcnt lgkmcnt(2)
    v_mfma_f32_4x4x4_16b_bf16 v[80:83], v[8:9], v[106:107], 0
    v_mfma_f32_4x4x4_16b_bf16 v[76:79], v[8:9], v[104:105], 0
    v_bitop3_b32 v15, v6, v15, v46 bitop3:0xca
    v_bitop3_b32 v14, v6, v14, v47 bitop3:0xca
    s_nop 1
    v_pk_mul_f32 v[80:81], v[80:81], v[14:15] op_sel:[0,1] op_sel_hi:[1,1]
    v_pk_mul_f32 v[82:83], v[82:83], v[14:15] op_sel:[0,1] op_sel_hi:[1,1]
    v_pk_mul_f32 v[76:77], v[76:77], v[14:15] op_sel:[0,0] op_sel_hi:[1,0]
    v_pk_mul_f32 v[78:79], v[78:79], v[14:15] op_sel:[0,0] op_sel_hi:[1,0]
    v_and_b32 v47, 0x3f0, v3
    s_cmp_lg_u32 s56, 0
    s_cbranch_scc1 L2_m9
    s_mul_i32 s3, s33, 1280000
    s_add_u32 s3, s3, s100
    s_add_u32 s3, s3, 352768
    buffer_load_dwordx4 v[124:127], v47, s[24:27], s3 offen offset:2048
L2_m9:
    v_and_b32 v47, 0x3f0, v3
    s_cmp_lg_u32 s56, 0
    s_cbranch_scc1 L2_m10
    s_mul_i32 s3, s33, 1280000
    s_add_u32 s3, s3, s100
    s_add_u32 s3, s3, 352768
    buffer_load_dwordx4 v[116:119], v47, s[24:27], s3 offen offset:0
L2_m10:
    s_waitcnt lgkmcnt(0)
    v_cmpx_ne_u64 vcc, v[74:75], v[70:71]
    s_and_b64 s[82:83], vcc, s[80:81]
    s_cbranch_scc1 L2_c11
L2_d11:
    v_mov_b64 v[84:85], v[70:71]
    v_mov_b32 v7, v93
    v_mov_b64 v[86:87], v[74:75]
    s_mov_b64 exec, -1
    s_or_b64 s[80:81], s[80:81], vcc
    v_cmpx_ne_u64 vcc, v[72:73], v[68:69]
    s_and_b64 s[82:83], vcc, s[80:81]
    s_cbranch_scc1 L2_c12
L2_d12:
    v_mov_b64 v[84:85], v[68:69]
    v_mov_b32 v7, v92
    v_mov_b64 v[86:87], v[72:73]
    s_mov_b64 exec, -1
    s_or_b64 s[80:81], s[80:81], vcc
    ds_read_b64 v[70:71], v95 offset:65408
    ds_read_b64 v[68:69], v94 offset:65408
    s_waitcnt vmcnt(2)
    v_and_b32 v46, 0x20000000, v27
    v_lshrrev_b32 v47, 14, v23
    v_bitop3_b32 v47, v47, v5, v46 bitop3:0xea
    ds_read_b64 v[102:103], v47
    v_bitop3_b32 v93, v23, v5, v46 bitop3:0xea
    v_and_b32 v46, 0x10000000, v27
    v_lshrrev_b32 v47, 14, v22
    v_bitop3_b32 v47, v47, v5, v46 bitop3:0xea
    ds_read_b64 v[100:101], v47
    v_bitop3_b32 v92, v22, v5, v46 bitop3:0xea
    s_waitcnt lgkmcnt(2)
    v_mfma_f32_4x4x4_16b_bf16 v[80:83], v[10:11], v[70:71], v[80:83]
    v_mfma_f32_4x4x4_16b_bf16 v[76:79], v[10:11], v[68:69], v[76:79]
    v_perm_b32 v15, v23, v26, s45
    v_bitop3_b32 v46, v23, 0.5, -0.5 bitop3:0xa8
    v_perm_b32 v14, v22, v26, s44
    v_bitop3_b32 v47, v22, 0.5, -0.5 bitop3:0xa8
    v_cvt_pk_bf16_f32 v80, v80, v81
    v_cvt_pk_bf16_f32 v81, v82, v83
    ds_wrxchg_rtn_b64 v[74:75], v95, v[80:81] offset:65408
    v_cvt_pk_bf16_f32 v76, v76, v77
    v_cvt_pk_bf16_f32 v77, v78, v79
    ds_wrxchg_rtn_b64 v[72:73], v94, v[76:77] offset:65408
    s_waitcnt lgkmcnt(2)
    v_mfma_f32_4x4x4_16b_bf16 v[80:83], v[8:9], v[102:103], 0
    v_mfma_f32_4x4x4_16b_bf16 v[76:79], v[8:9], v[100:101], 0
    v_bitop3_b32 v15, v6, v15, v46 bitop3:0xca
    v_bitop3_b32 v14, v6, v14, v47 bitop3:0xca
    v_cmp_lt_u32 s[84:85], v5, v92
    s_nop 0
    v_pk_mul_f32 v[80:81], v[80:81], v[14:15] op_sel:[0,1] op_sel_hi:[1,1]
    v_pk_mul_f32 v[82:83], v[82:83], v[14:15] op_sel:[0,1] op_sel_hi:[1,1]
    v_pk_mul_f32 v[76:77], v[76:77], v[14:15] op_sel:[0,0] op_sel_hi:[1,0]
    v_pk_mul_f32 v[78:79], v[78:79], v[14:15] op_sel:[0,0] op_sel_hi:[1,0]
    v_sub_u16 v88, v60, v52
    v_and_b32 v89, 3, v52
    v_add3_u32 v99, v88, v89, 3
    v_and_b32 v99, -4, v99
    v_max_u32 v99, 4, v99
    v_and_b32 v97, 0xfffc, v52
    v_bfm_b32 v96, v88, v89
    v_add_u32_dpp v91, v99, v99 row_shr:1 row_mask:0xf bank_mask:0xf bound_ctrl:1
    v_mad_u32_u24 v97, v97, 5, v2
    v_cmp_lt_u32 vcc, 16, v99
    v_add_u32_dpp v91, v91, v91 row_shr:2 row_mask:0xf bank_mask:0xf bound_ctrl:1
    v_sub_u32 v98, s38, v99
    v_lshrrev_b64 v[52:53], 16, v[52:53]
    v_add_u32_dpp v91, v91, v91 row_shr:4 row_mask:0xf bank_mask:0xf bound_ctrl:1
    v_lshrrev_b64 v[60:61], 16, v[60:61]
    s_mov_b32 s101, 0
    v_add_u32_dpp v91, v91, v91 row_shr:8 row_mask:0xf bank_mask:0xf bound_ctrl:1
    s_nop 1
    v_add_u32_dpp v91, v91, v91 row_bcast:15 row_mask:0xa bank_mask:0xf
    s_nop 1
    v_add_u32_dpp v91, v91, v91 row_bcast:31 row_mask:0xc bank_mask:0xf
    v_add_u32 v98, v98, v91
    v_readlane_b32 s37, v91, 63
    s_cbranch_vccnz L2_xo13
L2_xp13:
    v_and_b32 v47, 0x0fffffff, v39
    buffer_load_dwordx2 v[34:35], v47, s[8:11], 0 offen
    buffer_load_dwordx3 v[36:38], v47, s[8:11], 0 offen offset:8
    v_and_b32 v47, 0x3f0, v3
    s_cmp_lg_u32 s56, 0
    s_cbranch_scc1 L2_m14
    s_mul_i32 s3, s33, 1280000
    s_add_u32 s3, s3, s100
    s_add_u32 s3, s3, 352768
    buffer_load_dwordx4 v[120:123], v47, s[24:27], s3 offen offset:1024
L2_m14:
    s_waitcnt lgkmcnt(0)
    v_cmpx_ne_u64 vcc, v[74:75], v[70:71]
    s_and_b64 s[82:83], vcc, s[80:81]
    s_cbranch_scc1 L2_c15
L2_d15:
    v_mov_b64 v[84:85], v[70:71]
    v_mov_b32 v7, v95
    v_mov_b64 v[86:87], v[74:75]
    s_mov_b64 exec, -1
    s_or_b64 s[80:81], s[80:81], vcc
    v_cmpx_ne_u64 vcc, v[72:73], v[68:69]
    s_and_b64 s[82:83], vcc, s[80:81]
    s_cbranch_scc1 L2_c16
L2_d16:
    v_mov_b64 v[84:85], v[68:69]
    v_mov_b32 v7, v94
    v_mov_b64 v[86:87], v[72:73]
    s_mov_b64 exec, -1
    s_or_b64 s[80:81], s[80:81], vcc
    ds_read_b64 v[70:71], v93 offset:65408
    s_and_b64 exec, s[84:85], s[80:81]
    v_mfma_f32_4x4x4_16b_bf16 v[76:79], v[12:13], v[84:85], 0
    v_mov_b32 v92, v7
    s_andn2_b64 s[80:81], s[80:81], s[84:85]
    v_mfma_f32_4x4x4_16b_bf16 v[76:79], v[10:11], v[86:87], v[76:79]
    s_mov_b64 exec, -1
    ds_read_b64 v[68:69], v92 offset:65408
    v_and_b32 v46, 0x80000000, v27
    v_lshrrev_b32 v47, 14, v25
    v_bitop3_b32 v47, v47, v5, v46 bitop3:0xea
    ds_read_b64 v[106:107], v47
    v_bitop3_b32 v95, v25, v5, v46 bitop3:0xea
    v_and_b32 v46, 0x40000000, v27
    v_lshrrev_b32 v47, 14, v24
    v_bitop3_b32 v47, v47, v5, v46 bitop3:0xea
    ds_read_b64 v[104:105], v47
    v_bitop3_b32 v94, v24, v5, v46 bitop3:0xea
    s_waitcnt lgkmcnt(2)
    v_mfma_f32_4x4x4_16b_bf16 v[80:83], v[10:11], v[70:71], v[80:83]
    v_mfma_f32_4x4x4_16b_bf16 v[76:79], v[10:11], v[68:69], v[76:79]
    v_perm_b32 v15, v25, v26, s47
    v_bitop3_b32 v46, v25, 0.5, -0.5 bitop3:0xa8
    v_perm_b32 v14, v24, v26, s46
    v_bitop3_b32 v47, v24, 0.5, -0.5 bitop3:0xa8
    v_cvt_pk_bf16_f32 v80, v80, v81
    v_cvt_pk_bf16_f32 v81, v82, v83
    ds_wrxchg_rtn_b64 v[74:75], v93, v[80:81] offset:65408
    v_cvt_pk_bf16_f32 v76, v76, v77
    v_cvt_pk_bf16_f32 v77, v78, v79
    ds_wrxchg_rtn_b64 v[72:73], v92, v[76:77] offset:65408
    s_setprio 1
    s_waitcnt lgkmcnt(2)
    v_mfma_f32_4x4x4_16b_bf16 v[80:83], v[8:9], v[106:107], 0
    v_mfma_f32_4x4x4_16b_bf16 v[76:79], v[8:9], v[104:105], 0
    v_bitop3_b32 v15, v6, v15, v46 bitop3:0xca
    v_bitop3_b32 v14, v6, v14, v47 bitop3:0xca
    s_nop 1
    v_pk_mul_f32 v[80:81], v[80:81], v[14:15] op_sel:[0,1] op_sel_hi:[1,1]
    v_pk_mul_f32 v[82:83], v[82:83], v[14:15] op_sel:[0,1] op_sel_hi:[1,1]
    v_pk_mul_f32 v[76:77], v[76:77], v[14:15] op_sel:[0,0] op_sel_hi:[1,0]
    v_pk_mul_f32 v[78:79], v[78:79], v[14:15] op_sel:[0,0] op_sel_hi:[1,0]
    v_and_b32 v47, 0x3f0, v3
    s_cmp_lg_u32 s56, 0
    s_cbranch_scc1 L2_m17
    s_mul_i32 s3, s33, 1280000
    s_add_u32 s3, s3, s38
    s_add_u32 s3, s3, 320000
    buffer_load_dwordx4 v[108:111], v47, s[24:27], s3 offen offset:0
L2_m17:
    v_and_b32 v47, 0x3f0, v3
    s_cmp_lg_u32 s56, 0
    s_cbranch_scc1 L2_m18
    s_mul_i32 s3, s33, 1280000
    s_add_u32 s3, s3, s38
    s_add_u32 s3, s3, 320000
    buffer_load_dwordx4 v[112:115], v47, s[24:27], s3 offen offset:1024
L2_m18:
    s_waitcnt lgkmcnt(0)
    v_cmpx_ne_u64 vcc, v[74:75], v[70:71]
    s_and_b64 s[82:83], vcc, s[80:81]
    s_cbranch_scc1 L2_c19
L2_d19:
    v_mov_b64 v[84:85], v[70:71]
    v_mov_b32 v7, v93
    v_mov_b64 v[86:87], v[74:75]
    s_mov_b64 exec, -1
    s_or_b64 s[80:81], s[80:81], vcc
    v_cmpx_ne_u64 vcc, v[72:73], v[68:69]
    s_and_b64 s[82:83], vcc, s[80:81]
    s_cbranch_scc1 L2_c20
L2_d20:
    v_mov_b64 v[84:85], v[68:69]
    v_mov_b32 v7, v92
    v_mov_b64 v[86:87], v[72:73]
    s_mov_b64 exec, -1
    s_or_b64 s[80:81], s[80:81], vcc
    ds_read_b64 v[70:71], v95 offset:65408
    ds_read_b64 v[68:69], v94 offset:65408
    s_waitcnt vmcnt(2)
    v_and_b32 v46, 0x20000000, v33
    v_lshrrev_b32 v47, 14, v29
    v_bitop3_b32 v47, v47, v5, v46 bitop3:0xea
    ds_read_b64 v[102:103], v47
    v_bitop3_b32 v93, v29, v5, v46 bitop3:0xea
    v_and_b32 v46, 0x10000000, v33
    v_lshrrev_b32 v47, 14, v28
    v_bitop3_b32 v47, v47, v5, v46 bitop3:0xea
    ds_read_b64 v[100:101], v47
    v_bitop3_b32 v92, v28, v5, v46 bitop3:0xea
    s_waitcnt lgkmcnt(2)
    v_mfma_f32_4x4x4_16b_bf16 v[80:83], v[10:11], v[70:71], v[80:83]
    v_mfma_f32_4x4x4_16b_bf16 v[76:79], v[10:11], v[68:69], v[76:79]
    v_perm_b32 v15, v29, v32, s45
    v_bitop3_b32 v46, v29, 0.5, -0.5 bitop3:0xa8
    v_perm_b32 v14, v28, v32, s44
    v_bitop3_b32 v47, v28, 0.5, -0.5 bitop3:0xa8
    v_cvt_pk_bf16_f32 v80, v80, v81
    v_cvt_pk_bf16_f32 v81, v82, v83
    ds_wrxchg_rtn_b64 v[74:75], v95, v[80:81] offset:65408
    v_cvt_pk_bf16_f32 v76, v76, v77
    v_cvt_pk_bf16_f32 v77, v78, v79
    ds_wrxchg_rtn_b64 v[72:73], v94, v[76:77] offset:65408
    s_waitcnt lgkmcnt(2)
    v_mfma_f32_4x4x4_16b_bf16 v[80:83], v[8:9], v[102:103], 0
    v_mfma_f32_4x4x4_16b_bf16 v[76:79], v[8:9], v[100:101], 0
    v_bitop3_b32 v15, v6, v15, v46 bitop3:0xca
    v_bitop3_b32 v14, v6, v14, v47 bitop3:0xca
    v_cmp_lt_u32 s[84:85], v5, v92
    s_nop 0
    v_pk_mul_f32 v[80:81], v[80:81], v[14:15] op_sel:[0,1] op_sel_hi:[1,1]
    v_pk_mul_f32 v[82:83], v[82:83], v[14:15] op_sel:[0,1] op_sel_hi:[1,1]
    v_pk_mul_f32 v[76:77], v[76:77], v[14:15] op_sel:[0,0] op_sel_hi:[1,0]
    v_pk_mul_f32 v[78:79], v[78:79], v[14:15] op_sel:[0,0] op_sel_hi:[1,0]
    v_and_b32 v47, 0x0fffffff, v40
    v_mov_b32 v21, v40
    buffer_load_dwordx2 v[16:17], v47, s[8:11], 0 offen
    buffer_load_dwordx3 v[18:20], v47, s[8:11], 0 offen offset:8
    s_waitcnt lgkmcnt(0)
    v_cmpx_ne_u64 vcc, v[74:75], v[70:71]
    s_and_b64 s[82:83], vcc, s[80:81]
    s_cbranch_scc1 L2_c21
L2_d21:
    v_mov_b64 v[84:85], v[70:71]
    v_mov_b32 v7, v95
    v_mov_b64 v[86:87], v[74:75]
    s_mov_b64 exec, -1
    s_or_b64 s[80:81], s[80:81], vcc
    v_cmpx_ne_u64 vcc, v[72:73], v[68:69]
    s_and_b64 s[82:83], vcc, s[80:81]
    s_cbranch_scc1 L2_c22
L2_d22:
    v_mov_b64 v[84:85], v[68:69]
    v_mov_b32 v7, v94
    v_mov_b64 v[86:87], v[72:73]
    s_mov_b64 exec, -1
    s_or_b64 s[80:81], s[80:81], vcc
    ds_read_b64 v[70:71], v93 offset:65408
    s_and_b64 exec, s[84:85], s[80:81]
    v_mfma_f32_4x4x4_16b_bf16 v[76:79], v[12:13], v[84:85], 0
    v_mov_b32 v92, v7
    s_andn2_b64 s[80:81], s[80:81], s[84:85]
    v_mfma_f32_4x4x4_16b_bf16 v[76:79], v[10:11], v[86:87], v[76:79]
    s_mov_b64 exec, -1
    ds_read_b64 v[68:69], v92 offset:65408
    v_and_b32 v46, 0x80000000, v33
    v_lshrrev_b32 v47, 14, v31
    v_bitop3_b32 v47, v47, v5, v46 bitop3:0xea
    ds_read_b64 v[106:107], v47
    v_bitop3_b32 v95, v31, v5, v46 bitop3:0xea
    v_and_b32 v46, 0x40000000, v33
    v_lshrrev_b32 v47, 14, v30
    v_bitop3_b32 v47, v47, v5, v46 bitop3:0xea
    ds_read_b64 v[104:105], v47
    v_bitop3_b32 v94, v30, v5, v46 bitop3:0xea
    s_waitcnt lgkmcnt(2)
    v_mfma_f32_4x4x4_16b_bf16 v[80:83], v[10:11], v[70:71], v[80:83]
    v_mfma_f32_4x4x4_16b_bf16 v[76:79], v[10:11], v[68:69], v[76:79]
    v_perm_b32 v15, v31, v32, s47
    v_bitop3_b32 v46, v31, 0.5, -0.5 bitop3:0xa8
    v_perm_b32 v14, v30, v32, s46
    v_bitop3_b32 v47, v30, 0.5, -0.5 bitop3:0xa8
    v_cvt_pk_bf16_f32 v80, v80, v81
    v_cvt_pk_bf16_f32 v81, v82, v83
    ds_wrxchg_rtn_b64 v[74:75], v93, v[80:81] offset:65408
    v_cvt_pk_bf16_f32 v76, v76, v77
    v_cvt_pk_bf16_f32 v77, v78, v79
    ds_wrxchg_rtn_b64 v[72:73], v92, v[76:77] offset:65408
    s_setprio 0
    s_waitcnt lgkmcnt(2)
    v_mfma_f32_4x4x4_16b_bf16 v[80:83], v[8:9], v[106:107], 0
    v_mfma_f32_4x4x4_16b_bf16 v[76:79], v[8:9], v[104:105], 0
    v_bitop3_b32 v15, v6, v15, v46 bitop3:0xca
    v_bitop3_b32 v14, v6, v14, v47 bitop3:0xca
    s_nop 1
    v_pk_mul_f32 v[80:81], v[80:81], v[14:15] op_sel:[0,1] op_sel_hi:[1,1]
    v_pk_mul_f32 v[82:83], v[82:83], v[14:15] op_sel:[0,1] op_sel_hi:[1,1]
    v_pk_mul_f32 v[76:77], v[76:77], v[14:15] op_sel:[0,0] op_sel_hi:[1,0]
    v_pk_mul_f32 v[78:79], v[78:79], v[14:15] op_sel:[0,0] op_sel_hi:[1,0]
    s_add_u32 s40, s40, 0x50000
    s_waitcnt lgkmcnt(0)
    v_cmpx_ne_u64 vcc, v[74:75], v[70:71]
    s_and_b64 s[82:83], vcc, s[80:81]
    s_cbranch_scc1 L2_c23
L2_d23:
    v_mov_b64 v[84:85], v[70:71]
    v_mov_b32 v7, v93
    v_mov_b64 v[86:87], v[74:75]
    s_mov_b64 exec, -1
    s_or_b64 s[80:81], s[80:81], vcc
    v_cmpx_ne_u64 vcc, v[72:73], v[68:69]
    s_and_b64 s[82:83], vcc, s[80:81]
    s_cbranch_scc1 L2_c24
L2_d24:
    v_mov_b64 v[84:85], v[68:69]
    v_mov_b32 v7, v92
    v_mov_b64 v[86:87], v[72:73]
    s_mov_b64 exec, -1
    s_or_b64 s[80:81], s[80:81], vcc
    ds_read_b64 v[70:71], v95 offset:65408
    ds_read_b64 v[68:69], v94 offset:65408
    s_waitcnt vmcnt(2)
    v_and_b32 v46, 0x20000000, v39
    v_lshrrev_b32 v47, 14, v35
    v_bitop3_b32 v47, v47, v5, v46 bitop3:0xea
    ds_read_b64 v[102:103], v47
    v_bitop3_b32 v93, v35, v5, v46 bitop3:0xea
    v_and_b32 v46, 0x10000000, v39
    v_lshrrev_b32 v47, 14, v34
    v_bitop3_b32 v47, v47, v5, v46 bitop3:0xea
    ds_read_b64 v[100:101], v47
    v_bitop3_b32 v92, v34, v5, v46 bitop3:0xea
    v_and_b32 v46, 0x80000000, v39
    v_lshrrev_b32 v47, 14, v37
    v_bitop3_b32 v47, v47, v5, v46 bitop3:0xea
    ds_read_b64 v[106:107], v47
    v_and_b32 v46, 0x40000000, v39
    v_lshrrev_b32 v47, 14, v36
    v_bitop3_b32 v47, v47, v5, v46 bitop3:0xea
    ds_read_b64 v[104:105], v47
    s_waitcnt lgkmcnt(4)
    v_mfma_f32_4x4x4_16b_bf16 v[80:83], v[10:11], v[70:71], v[80:83]
    v_mfma_f32_4x4x4_16b_bf16 v[76:79], v[10:11], v[68:69], v[76:79]
    v_perm_b32 v15, v35, v38, s45
    v_bitop3_b32 v46, v35, 0.5, -0.5 bitop3:0xa8
    v_perm_b32 v14, v34, v38, s44
    v_bitop3_b32 v47, v34, 0.5, -0.5 bitop3:0xa8
    v_cvt_pk_bf16_f32 v80, v80, v81
    v_cvt_pk_bf16_f32 v81, v82, v83
    ds_wrxchg_rtn_b64 v[74:75], v95, v[80:81] offset:65408
    v_cvt_pk_bf16_f32 v76, v76, v77
    v_cvt_pk_bf16_f32 v77, v78, v79
    ds_wrxchg_rtn_b64 v[72:73], v94, v[76:77] offset:65408
    s_waitcnt lgkmcnt(2)
    s_barrier
    s_setprio 3
    s_waitcnt vmcnt(4)
    v_subrev_u32 v88, s38, v3
    ds_write_b128 v88, v[116:119] offset:32768
    buffer_load_dwordx4 v[116:119], v3, s[16:19], s40 offen offset:2048
    s_waitcnt vmcnt(3)
    v_subrev_u32 v88, s38, v3
    ds_write_b128 v88, v[120:123] offset:33792
    buffer_load_dwordx4 v[120:123], v3, s[16:19], s40 offen offset:3072
    v_mfma_f32_4x4x4_16b_bf16 v[80:83], v[8:9], v[102:103], 0
    v_mfma_f32_4x4x4_16b_bf16 v[76:79], v[8:9], v[100:101], 0
    v_bitop3_b32 v15, v6, v15, v46 bitop3:0xca
    v_bitop3_b32 v14, v6, v14, v47 bitop3:0xca
    v_cmp_lt_u32 s[84:85], v5, v92
    s_nop 0
    v_pk_mul_f32 v[80:81], v[80:81], v[14:15] op_sel:[0,1] op_sel_hi:[1,1]
    v_pk_mul_f32 v[82:83], v[82:83], v[14:15] op_sel:[0,1] op_sel_hi:[1,1]
    v_pk_mul_f32 v[76:77], v[76:77], v[14:15] op_sel:[0,0] op_sel_hi:[1,0]
    v_pk_mul_f32 v[78:79], v[78:79], v[14:15] op_sel:[0,0] op_sel_hi:[1,0]
    v_and_b32 v47, 0x0fffffff, v41
    v_mov_b32 v27, v41
    buffer_load_dwordx2 v[22:23], v47, s[8:11], 0 offen
    buffer_load_dwordx3 v[24:26], v47, s[8:11], 0 offen offset:8
    v_mov_b32 v33, v42
    v_mov_b32 v44, v43
    s_cmp_gt_u32 s37, 1024
    s_cbranch_scc1 L2_xs25
    s_cmp_lg_u32 s101, 0
    s_cbranch_scc1 L2_xa25
L2_xb25:
    v_lshlrev_b32 v89, 16, v96
    v_add_u32 v90, 60, v97
    v_bitop3_b32 v90, v89, v45, v90 bitop3:0x6a
    ds_write_b32 v98, v90 offset:12
    v_lshlrev_b32 v89, 20, v96
    v_add_u32 v90, 40, v97
    v_bitop3_b32 v90, v89, v45, v90 bitop3:0x6a
    ds_write_b32 v98, v90 offset:8
    v_lshlrev_b32 v89, 24, v96
    v_add_u32 v90, 20, v97
    v_bitop3_b32 v90, v89, v45, v90 bitop3:0x6a
    ds_write_b32 v98, v90 offset:4
    v_lshlrev_b32 v89, 28, v96
    v_bitop3_b32 v90, v89, v45, v97 bitop3:0x6a
    ds_write_b32 v98, v90 offset:0
    v_mov_b32_dpp v91, v64 quad_perm:[1,1,1,1] row_mask:0xf bank_mask:0xf
    v_and_b32 v89, 3, v91
    v_and_b32 v97, 0xfffc, v91
    v_sub_u16_dpp v88, v64, v91 quad_perm:[3,3,3,3] row_mask:0xf bank_mask:0xf
    v_mad_u32_u24 v97, v97, 5, v4
    v_add_u32 v99, v88, v89
    v_bfm_b32 v96, v88, v89
    v_cmp_lt_u32 s[58:59], 16, v99
    v_lshlrev_b32 v89, v1, v96
    v_and_b32 v89, v45, v89
    v_cmp_ne_u32 vcc, 0, v89
    v_xor_b32 v90, v97, v89
    s_add_u32 s3, s37, s38
    v_mbcnt_lo_u32_b32 v98, vcc_lo, 0
    v_mbcnt_hi_u32_b32 v98, vcc_hi, v98
    s_bcnt1_i32_b64 s41, vcc
    v_lshl_add_u32 v98, v98, 2, s3
    s_mov_b64 exec, vcc
    ds_write_b32 v98, v90
    s_mov_b64 exec, -1
    s_lshl2_add_u32 s37, s41, s37
    s_cmp_lg_u64 s[58:59], 0
    s_cbranch_scc1 L2_xe25
L2_xr25:
    v_add_u32 v98, s37, v0
    v_mov_b32 v90, -1
    ds_write_b32 v98, v90
    ds_read2st64_b32 v[40:41], v0 offset0:0 offset1:1
    ds_read2st64_b32 v[42:43], v0 offset0:2 offset1:3
    s_sub_u32 s3, s37, 768
    s_cmp_gt_u32 s3, 256
    s_cbranch_scc1 L2_xf25
L2_xg25:
    s_setprio 2
    s_waitcnt vmcnt(8)
    v_subrev_u32 v88, s38, v3
    ds_write_b128 v88, v[124:127] offset:34816
    s_add_u32 s3, s40, 4096
    buffer_load_dwordx4 v[124:127], v3, s[16:19], s3 offen
    s_waitcnt lgkmcnt(11)
    v_cmpx_ne_u64 vcc, v[74:75], v[70:71]
    s_and_b64 s[82:83], vcc, s[80:81]
    s_cbranch_scc1 L2_c26
L2_d26:
    v_mov_b64 v[84:85], v[70:71]
    v_mov_b32 v7, v95
    v_mov_b64 v[86:87], v[74:75]
    s_mov_b64 exec, -1
    s_or_b64 s[80:81], s[80:81], vcc
    v_cmpx_ne_u64 vcc, v[72:73], v[68:69]
    s_and_b64 s[82:83], vcc, s[80:81]
    s_cbranch_scc1 L2_c27
L2_d27:
    v_mov_b64 v[84:85], v[68:69]
    v_mov_b32 v7, v94
    v_mov_b64 v[86:87], v[72:73]
    s_mov_b64 exec, -1
    s_or_b64 s[80:81], s[80:81], vcc
    ds_read_b64 v[70:71], v93 offset:65408
    s_and_b64 exec, s[84:85], s[80:81]
    v_mfma_f32_4x4x4_16b_bf16 v[76:79], v[12:13], v[84:85], 0
    v_mov_b32 v92, v7
    s_andn2_b64 s[80:81], s[80:81], s[84:85]
    v_mfma_f32_4x4x4_16b_bf16 v[76:79], v[10:11], v[86:87], v[76:79]
    s_mov_b64 exec, -1
    ds_read_b64 v[68:69], v92 offset:65408
    s_setprio 1
    s_waitcnt vmcnt(7)
    v_subrev_u32 v88, s100, v3
    ds_write_b128 v88, v[108:111] offset:0
    s_waitcnt lgkmcnt(1)
    v_mfma_f32_4x4x4_16b_bf16 v[80:83], v[10:11], v[70:71], v[80:83]
    v_mfma_f32_4x4x4_16b_bf16 v[76:79], v[10:11], v[68:69], v[76:79]
    v_and_b32 v46, 0x40000000, v39
    v_bitop3_b32 v94, v36, v5, v46 bitop3:0xea
    v_and_b32 v46, 0x80000000, v39
    v_bitop3_b32 v95, v37, v5, v46 bitop3:0xea
    v_perm_b32 v15, v37, v38, s47
    v_bitop3_b32 v46, v37, 0.5, -0.5 bitop3:0xa8
    v_perm_b32 v14, v36, v38, s46
    v_bitop3_b32 v47, v36, 0.5, -0.5 bitop3:0xa8
    v_cvt_pk_bf16_f32 v80, v80, v81
    v_cvt_pk_bf16_f32 v81, v82, v83
    ds_wrxchg_rtn_b64 v[74:75], v93, v[80:81] offset:65408
    v_cvt_pk_bf16_f32 v76, v76, v77
    v_cvt_pk_bf16_f32 v77, v78, v79
    ds_wrxchg_rtn_b64 v[72:73], v92, v[76:77] offset:65408
    s_setprio 0
    s_waitcnt vmcnt(7)
    v_subrev_u32 v88, s100, v3
    ds_write_b128 v88, v[112:115] offset:1024
    v_mfma_f32_4x4x4_16b_bf16 v[80:83], v[8:9], v[106:107], 0
    v_mfma_f32_4x4x4_16b_bf16 v[76:79], v[8:9], v[104:105], 0
    v_bitop3_b32 v15, v6, v15, v46 bitop3:0xca
    v_bitop3_b32 v14, v6, v14, v47 bitop3:0xca
    s_nop 1
    v_pk_mul_f32 v[80:81], v[80:81], v[14:15] op_sel:[0,1] op_sel_hi:[1,1]
    v_pk_mul_f32 v[82:83], v[82:83], v[14:15] op_sel:[0,1] op_sel_hi:[1,1]
    v_pk_mul_f32 v[76:77], v[76:77], v[14:15] op_sel:[0,0] op_sel_hi:[1,0]
    v_pk_mul_f32 v[78:79], v[78:79], v[14:15] op_sel:[0,0] op_sel_hi:[1,0]
    s_add_u32 s42, s42, 1
    s_waitcnt lgkmcnt(0)
    s_add_u32 s24, s30, 0xebc9000
    s_addc_u32 s25, s31, 0
    s_mov_b32 s26, 0x100
    s_mov_b32 s27, 0x20000
    s_barrier
    s_bitcmp1_b32 s36, s42
    s_cbranch_scc1 L2_slow
L2_ret1:
    s_setprio 3
    v_and_b32 v47, 0x0fffffff, v33
    buffer_load_dwordx2 v[28:29], v47, s[8:11], 0 offen
    buffer_load_dwordx3 v[30:32], v47, s[8:11], 0 offen offset:8
    v_cmpx_ne_u64 vcc, v[74:75], v[70:71]
    s_and_b64 s[82:83], vcc, s[80:81]
    s_cbranch_scc1 L2_c28
L2_d28:
    v_mov_b64 v[84:85], v[70:71]
    v_mov_b32 v7, v93
    v_mov_b64 v[86:87], v[74:75]
    s_mov_b64 exec, -1
    s_or_b64 s[80:81], s[80:81], vcc
    v_cmpx_ne_u64 vcc, v[72:73], v[68:69]
    s_and_b64 s[82:83], vcc, s[80:81]
    s_cbranch_scc1 L2_c29
L2_d29:
    v_mov_b64 v[84:85], v[68:69]
    v_mov_b32 v7, v92
    v_mov_b64 v[86:87], v[72:73]
    s_mov_b64 exec, -1
    s_or_b64 s[80:81], s[80:81], vcc
    ds_read_b64 v[70:71], v95 offset:65408
    ds_read_b64 v[68:69], v94 offset:65408
    s_waitcnt vmcnt(7)
    v_and_b32 v46, 0x20000000, v21
    v_lshrrev_b32 v47, 14, v17
    v_bitop3_b32 v47, v47, v5, v46 bitop3:0xea
    ds_read_b64 v[102:103], v47
    v_bitop3_b32 v93, v17, v5, v46 bitop3:0xea
    v_and_b32 v46, 0x10000000, v21
    v_lshrrev_b32 v47, 14, v16
    v_bitop3_b32 v47, v47, v5, v46 bitop3:0xea
    ds_read_b64 v[100:101], v47
    v_bitop3_b32 v92, v16, v5, v46 bitop3:0xea
    s_waitcnt lgkmcnt(2)
    v_mfma_f32_4x4x4_16b_bf16 v[80:83], v[10:11], v[70:71], v[80:83]
    v_mfma_f32_4x4x4_16b_bf16 v[76:79], v[10:11], v[68:69], v[76:79]
    v_perm_b32 v15, v17, v20, s45
    v_bitop3_b32 v46, v17, 0.5, -0.5 bitop3:0xa8
    v_perm_b32 v14, v16, v20, s44
    v_bitop3_b32 v47, v16, 0.5, -0.5 bitop3:0xa8
    v_cvt_pk_bf16_f32 v80, v80, v81
    v_cvt_pk_bf16_f32 v81, v82, v83
    ds_wrxchg_rtn_b64 v[74:75], v95, v[80:81] offset:65408
    v_cvt_pk_bf16_f32 v76, v76, v77
    v_cvt_pk_bf16_f32 v77, v78, v79
    ds_wrxchg_rtn_b64 v[72:73], v94, v[76:77] offset:65408
    s_waitcnt lgkmcnt(2)
    v_mfma_f32_4x4x4_16b_bf16 v[80:83], v[8:9], v[102:103], 0
    v_mfma_f32_4x4x4_16b_bf16 v[76:79], v[8:9], v[100:101], 0
    v_bitop3_b32 v15, v6, v15, v46 bitop3:0xca
    v_bitop3_b32 v14, v6, v14, v47 bitop3:0xca
    v_cmp_lt_u32 s[84:85], v5, v92
    s_nop 0
    v_pk_mul_f32 v[80:81], v[80:81], v[14:15] op_sel:[0,1] op_sel_hi:[1,1]
    v_pk_mul_f32 v[82:83], v[82:83], v[14:15] op_sel:[0,1] op_sel_hi:[1,1]
    v_pk_mul_f32 v[76:77], v[76:77], v[14:15] op_sel:[0,0] op_sel_hi:[1,0]
    v_pk_mul_f32 v[78:79], v[78:79], v[14:15] op_sel:[0,0] op_sel_hi:[1,0]
    buffer_load_dwordx4 v[108:111], v3, s[16:19], s40 offen offset:0
    s_waitcnt lgkmcnt(0)
    v_cmpx_ne_u64 vcc, v[74:75], v[70:71]
    s_and_b64 s[82:83], vcc, s[80:81]
    s_cbranch_scc1 L2_c30
L2_d30:
    v_mov_b64 v[84:85], v[70:71]
    v_mov_b32 v7, v95
    v_mov_b64 v[86:87], v[74:75]
    s_mov_b64 exec, -1
    s_or_b64 s[80:81], s[80:81], vcc
    v_cmpx_ne_u64 vcc, v[72:73], v[68:69]
    s_and_b64 s[82:83], vcc, s[80:81]
    s_cbranch_scc1 L2_c31
L2_d31:
    v_mov_b64 v[84:85], v[68:69]
    v_mov_b32 v7, v94
    v_mov_b64 v[86:87], v[72:73]
    s_mov_b64 exec, -1
    s_or_b64 s[80:81], s[80:81], vcc
    ds_read_b64 v[70:71], v93 offset:65408
    s_and_b64 exec, s[84:85], s[80:81]
    v_mfma_f32_4x4x4_16b_bf16 v[76:79], v[12:13], v[84:85], 0
    v_mov_b32 v92, v7
    s_andn2_b64 s[80:81], s[80:81], s[84:85]
    v_mfma_f32_4x4x4_16b_bf16 v[76:79], v[10:11], v[86:87], v[76:79]
    s_mov_b64 exec, -1
    ds_read_b64 v[68:69], v92 offset:65408
    v_and_b32 v46, 0x80000000, v21
    v_lshrrev_b32 v47, 14, v19
    v_bitop3_b32 v47, v47, v5, v46 bitop3:0xea
    ds_read_b64 v[106:107], v47
    v_bitop3_b32 v95, v19, v5, v46 bitop3:0xea
    v_and_b32 v46, 0x40000000, v21
    v_lshrrev_b32 v47, 14, v18
    v_bitop3_b32 v47, v47, v5, v46 bitop3:0xea
    ds_read_b64 v[104:105], v47
    v_bitop3_b32 v94, v18, v5, v46 bitop3:0xea
    s_waitcnt lgkmcnt(2)
    v_mfma_f32_4x4x4_16b_bf16 v[80:83], v[10:11], v[70:71], v[80:83]
    v_mfma_f32_4x4x4_16b_bf16 v[76:79], v[10:11], v[68:69], v[76:79]
    v_perm_b32 v15, v19, v20, s47
    v_bitop3_b32 v46, v19, 0.5, -0.5 bitop3:0xa8
    v_perm_b32 v14, v18, v20, s46
    v_bitop3_b32 v47, v18, 0.5, -0.5 bitop3:0xa8
    v_cvt_pk_bf16_f32 v80, v80, v81
    v_cvt_pk_bf16_f32 v81, v82, v83
    ds_wrxchg_rtn_b64 v[74:75], v93, v[80:81] offset:65408
    v_cvt_pk_bf16_f32 v76, v76, v77
    v_cvt_pk_bf16_f32 v77, v78, v79
    ds_wrxchg_rtn_b64 v[72:73], v92, v[76:77] offset:65408
    s_setprio 2
    s_waitcnt lgkmcnt(2)
    v_mfma_f32_4x4x4_16b_bf16 v[80:83], v[8:9], v[106:107], 0
    v_mfma_f32_4x4x4_16b_bf16 v[76:79], v[8:9], v[104:105], 0
    v_bitop3_b32 v15, v6, v15, v46 bitop3:0xca
    v_bitop3_b32 v14, v6, v14, v47 bitop3:0xca
    s_nop 1
    v_pk_mul_f32 v[80:81], v[80:81], v[14:15] op_sel:[0,1] op_sel_hi:[1,1]
    v_pk_mul_f32 v[82:83], v[82:83], v[14:15] op_sel:[0,1] op_sel_hi:[1,1]
    v_pk_mul_f32 v[76:77], v[76:77], v[14:15] op_sel:[0,0] op_sel_hi:[1,0]
    v_pk_mul_f32 v[78:79], v[78:79], v[14:15] op_sel:[0,0] op_sel_hi:[1,0]
    v_and_b32 v47, 0x0fffffff, v44
    v_mov_b32 v39, v44
    buffer_load_dwordx2 v[34:35], v47, s[8:11], 0 offen
    buffer_load_dwordx3 v[36:38], v47, s[8:11], 0 offen offset:8
    s_waitcnt lgkmcnt(0)
    v_cmpx_ne_u64 vcc, v[74:75], v[70:71]
    s_and_b64 s[82:83], vcc, s[80:81]
    s_cbranch_scc1 L2_c32
L2_d32:
    v_mov_b64 v[84:85], v[70:71]
    v_mov_b32 v7, v93
    v_mov_b64 v[86:87], v[74:75]
    s_mov_b64 exec, -1
    s_or_b64 s[80:81], s[80:81], vcc
    v_cmpx_ne_u64 vcc, v[72:73], v[68:69]
    s_and_b64 s[82:83], vcc, s[80:81]
    s_cbranch_scc1 L2_c33
L2_d33:
    v_mov_b64 v[84:85], v[68:69]
    v_mov_b32 v7, v92
    v_mov_b64 v[86:87], v[72:73]
    s_mov_b64 exec, -1
    s_or_b64 s[80:81], s[80:81], vcc
    ds_read_b64 v[70:71], v95 offset:65408
    ds_read_b64 v[68:69], v94 offset:65408
    s_waitcnt vmcnt(6)
    v_and_b32 v46, 0x20000000, v27
    v_lshrrev_b32 v47, 14, v23
    v_bitop3_b32 v47, v47, v5, v46 bitop3:0xea
    ds_read_b64 v[102:103], v47
    v_bitop3_b32 v93, v23, v5, v46 bitop3:0xea
    v_and_b32 v46, 0x10000000, v27
    v_lshrrev_b32 v47, 14, v22
    v_bitop3_b32 v47, v47, v5, v46 bitop3:0xea
    ds_read_b64 v[100:101], v47
    v_bitop3_b32 v92, v22, v5, v46 bitop3:0xea
    s_waitcnt lgkmcnt(2)
    v_mfma_f32_4x4x4_16b_bf16 v[80:83], v[10:11], v[70:71], v[80:83]
    v_mfma_f32_4x4x4_16b_bf16 v[76:79], v[10:11], v[68:69], v[76:79]
    v_perm_b32 v15, v23, v26, s45
    v_bitop3_b32 v46, v23, 0.5, -0.5 bitop3:0xa8
    v_perm_b32 v14, v22, v26, s44
    v_bitop3_b32 v47, v22, 0.5, -0.5 bitop3:0xa8
    v_cvt_pk_bf16_f32 v80, v80, v81
    v_cvt_pk_bf16_f32 v81, v82, v83
    ds_wrxchg_rtn_b64 v[74:75], v95, v[80:81] offset:65408
    v_cvt_pk_bf16_f32 v76, v76, v77
    v_cvt_pk_bf16_f32 v77, v78, v79
    ds_wrxchg_rtn_b64 v[72:73], v94, v[76:77] offset:65408
    s_waitcnt lgkmcnt(2)
    v_mfma_f32_4x4x4_16b_bf16 v[80:83], v[8:9], v[102:103], 0
    v_mfma_f32_4x4x4_16b_bf16 v[76:79], v[8:9], v[100:101], 0
    v_bitop3_b32 v15, v6, v15, v46 bitop3:0xca
    v_bitop3_b32 v14, v6, v14, v47 bitop3:0xca
    v_cmp_lt_u32 s[84:85], v5, v92
    s_nop 0
    v_pk_mul_f32 v[80:81], v[80:81], v[14:15] op_sel:[0,1] op_sel_hi:[1,1]
    v_pk_mul_f32 v[82:83], v[82:83], v[14:15] op_sel:[0,1] op_sel_hi:[1,1]
    v_pk_mul_f32 v[76:77], v[76:77], v[14:15] op_sel:[0,0] op_sel_hi:[1,0]
    v_pk_mul_f32 v[78:79], v[78:79], v[14:15] op_sel:[0,0] op_sel_hi:[1,0]
    v_sub_u16 v88, v62, v54
    v_and_b32 v89, 3, v54
    v_add3_u32 v99, v88, v89, 3
    v_and_b32 v99, -4, v99
    v_max_u32 v99, 4, v99
    v_and_b32 v97, 0xfffc, v54
    v_bfm_b32 v96, v88, v89
    v_add_u32_dpp v91, v99, v99 row_shr:1 row_mask:0xf bank_mask:0xf bound_ctrl:1
    v_mad_u32_u24 v97, v97, 5, v2
    v_cmp_lt_u32 vcc, 16, v99
    v_add_u32_dpp v91, v91, v91 row_shr:2 row_mask:0xf bank_mask:0xf bound_ctrl:1
    v_sub_u32 v98, s38, v99
    v_lshrrev_b64 v[54:55], 16, v[54:55]
    v_add_u32_dpp v91, v91, v91 row_shr:4 row_mask:0xf bank_mask:0xf bound_ctrl:1
    v_lshrrev_b64 v[62:63], 16, v[62:63]
    s_mov_b32 s101, 0
    v_add_u32_dpp v91, v91, v91 row_shr:8 row_mask:0xf bank_mask:0xf bound_ctrl:1
    s_nop 1
    v_add_u32_dpp v91, v91, v91 row_bcast:15 row_mask:0xa bank_mask:0xf
    s_nop 1
    v_add_u32_dpp v91, v91, v91 row_bcast:31 row_mask:0xc bank_mask:0xf
    v_add_u32 v98, v98, v91
    v_readlane_b32 s37, v91, 63
    s_cbranch_vccnz L2_xo34
L2_xp34:
    buffer_load_dwordx4 v[112:115], v3, s[16:19], s40 offen offset:1024
    v_and_b32 v47, 0x0fffffff, v40
    v_mov_b32 v21, v40
    buffer_load_dwordx2 v[16:17], v47, s[8:11], 0 offen
    buffer_load_dwordx3 v[18:20], v47, s[8:11], 0 offen offset:8
    s_waitcnt lgkmcnt(0)
    v_cmpx_ne_u64 vcc, v[74:75], v[70:71]
    s_and_b64 s[82:83], vcc, s[80:81]
    s_cbranch_scc1 L2_c35
L2_d35:
    v_mov_b64 v[84:85], v[70:71]
    v_mov_b32 v7, v95
    v_mov_b64 v[86:87], v[74:75]
    s_mov_b64 exec, -1
    s_or_b64 s[80:81], s[80:81], vcc
    v_cmpx_ne_u64 vcc, v[72:73], v[68:69]
    s_and_b64 s[82:83], vcc, s[80:81]
    s_cbranch_scc1 L2_c36
L2_d36:
    v_mov_b64 v[84:85], v[68:69]
    v_mov_b32 v7, v94
    v_mov_b64 v[86:87], v[72:73]
    s_mov_b64 exec, -1
    s_or_b64 s[80:81], s[80:81], vcc
    ds_read_b64 v[70:71], v93 offset:65408
    s_and_b64 exec, s[84:85], s[80:81]
    v_mfma_f32_4x4x4_16b_bf16 v[76:79], v[12:13], v[84:85], 0
    v_mov_b32 v92, v7
    s_andn2_b64 s[80:81], s[80:81], s[84:85]
    v_mfma_f32_4x4x4_16b_bf16 v[76:79], v[10:11], v[86:87], v[76:79]
    s_mov_b64 exec, -1
    ds_read_b64 v[68:69], v92 offset:65408
    v_and_b32 v46, 0x80000000, v27
    v_lshrrev_b32 v47, 14, v25
    v_bitop3_b32 v47, v47, v5, v46 bitop3:0xea
    ds_read_b64 v[106:107], v47
    v_bitop3_b32 v95, v25, v5, v46 bitop3:0xea
    v_and_b32 v46, 0x40000000, v27
    v_lshrrev_b32 v47, 14, v24
    v_bitop3_b32 v47, v47, v5, v46 bitop3:0xea
    ds_read_b64 v[104:105], v47
    v_bitop3_b32 v94, v24, v5, v46 bitop3:0xea
    s_waitcnt lgkmcnt(2)
    v_mfma_f32_4x4x4_16b_bf16 v[80:83], v[10:11], v[70:71], v[80:83]
    v_mfma_f32_4x4x4_16b_bf16 v[76:79], v[10:11], v[68:69], v[76:79]
    v_perm_b32 v15, v25, v26, s47
    v_bitop3_b32 v46, v25, 0.5, -0.5 bitop3:0xa8
    v_perm_b32 v14, v24, v26, s46
    v_bitop3_b32 v47, v24, 0.5, -0.5 bitop3:0xa8
    v_cvt_pk_bf16_f32 v80, v80, v81
    v_cvt_pk_bf16_f32 v81, v82, v83
    ds_wrxchg_rtn_b64 v[74:75], v93, v[80:81] offset:65408
    v_cvt_pk_bf16_f32 v76, v76, v77
    v_cvt_pk_bf16_f32 v77, v78, v79
    ds_wrxchg_rtn_b64 v[72:73], v92, v[76:77] offset:65408
    s_setprio 1
    s_waitcnt lgkmcnt(2)
    v_mfma_f32_4x4x4_16b_bf16 v[80:83], v[8:9], v[106:107], 0
    v_mfma_f32_4x4x4_16b_bf16 v[76:79], v[8:9], v[104:105], 0
    v_bitop3_b32 v15, v6, v15, v46 bitop3:0xca
    v_bitop3_b32 v14, v6, v14, v47 bitop3:0xca
    s_nop 1
    v_pk_mul_f32 v[80:81], v[80:81], v[14:15] op_sel:[0,1] op_sel_hi:[1,1]
    v_pk_mul_f32 v[82:83], v[82:83], v[14:15] op_sel:[0,1] op_sel_hi:[1,1]
    v_pk_mul_f32 v[76:77], v[76:77], v[14:15] op_sel:[0,0] op_sel_hi:[1,0]
    v_pk_mul_f32 v[78:79], v[78:79], v[14:15] op_sel:[0,0] op_sel_hi:[1,0]
    s_waitcnt lgkmcnt(0)
    v_cmpx_ne_u64 vcc, v[74:75], v[70:71]
    s_and_b64 s[82:83], vcc, s[80:81]
    s_cbranch_scc1 L2_c37
L2_d37:
    v_mov_b64 v[84:85], v[70:71]
    v_mov_b32 v7, v93
    v_mov_b64 v[86:87], v[74:75]
    s_mov_b64 exec, -1
    s_or_b64 s[80:81], s[80:81], vcc
    v_cmpx_ne_u64 vcc, v[72:73], v[68:69]
    s_and_b64 s[82:83], vcc, s[80:81]
    s_cbranch_scc1 L2_c38
L2_d38:
    v_mov_b64 v[84:85], v[68:69]
    v_mov_b32 v7, v92
    v_mov_b64 v[86:87], v[72:73]
    s_mov_b64 exec, -1
    s_or_b64 s[80:81], s[80:81], vcc
    ds_read_b64 v[70:71], v95 offset:65408
    ds_read_b64 v[68:69], v94 offset:65408
    s_waitcnt vmcnt(6)
    v_and_b32 v46, 0x20000000, v33
    v_lshrrev_b32 v47, 14, v29
    v_bitop3_b32 v47, v47, v5, v46 bitop3:0xea
    ds_read_b64 v[102:103], v47
    v_bitop3_b32 v93, v29, v5, v46 bitop3:0xea
    v_and_b32 v46, 0x10000000, v33
    v_lshrrev_b32 v47, 14, v28
    v_bitop3_b32 v47, v47, v5, v46 bitop3:0xea
    ds_read_b64 v[100:101], v47
    v_bitop3_b32 v92, v28, v5, v46 bitop3:0xea
    s_waitcnt lgkmcnt(2)
    v_mfma_f32_4x4x4_16b_bf16 v[80:83], v[10:11], v[70:71], v[80:83]
    v_mfma_f32_4x4x4_16b_bf16 v[76:79], v[10:11], v[68:69], v[76:79]
    v_perm_b32 v15, v29, v32, s45
    v_bitop3_b32 v46, v29, 0.5, -0.5 bitop3:0xa8
    v_perm_b32 v14, v28, v32, s44
    v_bitop3_b32 v47, v28, 0.5, -0.5 bitop3:0xa8
    v_cvt_pk_bf16_f32 v80, v80, v81
    v_cvt_pk_bf16_f32 v81, v82, v83
    ds_wrxchg_rtn_b64 v[74:75], v95, v[80:81] offset:65408
    v_cvt_pk_bf16_f32 v76, v76, v77
    v_cvt_pk_bf16_f32 v77, v78, v79
    ds_wrxchg_rtn_b64 v[72:73], v94, v[76:77] offset:65408
    s_waitcnt lgkmcnt(2)
    v_mfma_f32_4x4x4_16b_bf16 v[80:83], v[8:9], v[102:103], 0
    v_mfma_f32_4x4x4_16b_bf16 v[76:79], v[8:9], v[100:101], 0
    v_bitop3_b32 v15, v6, v15, v46 bitop3:0xca
    v_bitop3_b32 v14, v6, v14, v47 bitop3:0xca
    v_cmp_lt_u32 s[84:85], v5, v92
    s_nop 0
    v_pk_mul_f32 v[80:81], v[80:81], v[14:15] op_sel:[0,1] op_sel_hi:[1,1]
    v_pk_mul_f32 v[82:83], v[82:83], v[14:15] op_sel:[0,1] op_sel_hi:[1,1]
    v_pk_mul_f32 v[76:77], v[76:77], v[14:15] op_sel:[0,0] op_sel_hi:[1,0]
    v_pk_mul_f32 v[78:79], v[78:79], v[14:15] op_sel:[0,0] op_sel_hi:[1,0]
    v_and_b32 v47, 0x0fffffff, v41
    v_mov_b32 v27, v41
    buffer_load_dwordx2 v[22:23], v47, s[8:11], 0 offen
    buffer_load_dwordx3 v[24:26], v47, s[8:11], 0 offen offset:8
    s_waitcnt lgkmcnt(0)
    v_cmpx_ne_u64 vcc, v[74:75], v[70:71]
    s_and_b64 s[82:83], vcc, s[80:81]
    s_cbranch_scc1 L2_c39
L2_d39:
    v_mov_b64 v[84:85], v[70:71]
    v_mov_b32 v7, v95
    v_mov_b64 v[86:87], v[74:75]
    s_mov_b64 exec, -1
    s_or_b64 s[80:81], s[80:81], vcc
    v_cmpx_ne_u64 vcc, v[72:73], v[68:69]
    s_and_b64 s[82:83], vcc, s[80:81]
    s_cbranch_scc1 L2_c40
L2_d40:
    v_mov_b64 v[84:85], v[68:69]
    v_mov_b32 v7, v94
    v_mov_b64 v[86:87], v[72:73]
    s_mov_b64 exec, -1
    s_or_b64 s[80:81], s[80:81], vcc
    ds_read_b64 v[70:71], v93 offset:65408
    s_and_b64 exec, s[84:85], s[80:81]
    v_mfma_f32_4x4x4_16b_bf16 v[76:79], v[12:13], v[84:85], 0
    v_mov_b32 v92, v7
    s_andn2_b64 s[80:81], s[80:81], s[84:85]
    v_mfma_f32_4x4x4_16b_bf16 v[76:79], v[10:11], v[86:87], v[76:79]
    s_mov_b64 exec, -1
    ds_read_b64 v[68:69], v92 offset:65408
    v_and_b32 v46, 0x80000000, v33
    v_lshrrev_b32 v47, 14, v31
    v_bitop3_b32 v47, v47, v5, v46 bitop3:0xea
    ds_read_b64 v[106:107], v47
    v_bitop3_b32 v95, v31, v5, v46 bitop3:0xea
    v_and_b32 v46, 0x40000000, v33
    v_lshrrev_b32 v47, 14, v30
    v_bitop3_b32 v47, v47, v5, v46 bitop3:0xea
    ds_read_b64 v[104:105], v47
    v_bitop3_b32 v94, v30, v5, v46 bitop3:0xea
    s_waitcnt lgkmcnt(2)
    v_mfma_f32_4x4x4_16b_bf16 v[80:83], v[10:11], v[70:71], v[80:83]
    v_mfma_f32_4x4x4_16b_bf16 v[76:79], v[10:11], v[68:69], v[76:79]
    v_perm_b32 v15, v31, v32, s47
    v_bitop3_b32 v46, v31, 0.5, -0.5 bitop3:0xa8
    v_perm_b32 v14, v30, v32, s46
    v_bitop3_b32 v47, v30, 0.5, -0.5 bitop3:0xa8
    v_cvt_pk_bf16_f32 v80, v80, v81
    v_cvt_pk_bf16_f32 v81, v82, v83
    ds_wrxchg_rtn_b64 v[74:75], v93, v[80:81] offset:65408
    v_cvt_pk_bf16_f32 v76, v76, v77
    v_cvt_pk_bf16_f32 v77, v78, v79
    ds_wrxchg_rtn_b64 v[72:73], v92, v[76:77] offset:65408
    s_setprio 0
    s_waitcnt lgkmcnt(2)
    v_mfma_f32_4x4x4_16b_bf16 v[80:83], v[8:9], v[106:107], 0
    v_mfma_f32_4x4x4_16b_bf16 v[76:79], v[8:9], v[104:105], 0
    v_bitop3_b32 v15, v6, v15, v46 bitop3:0xca
    v_bitop3_b32 v14, v6, v14, v47 bitop3:0xca
    s_nop 1
    v_pk_mul_f32 v[80:81], v[80:81], v[14:15] op_sel:[0,1] op_sel_hi:[1,1]
    v_pk_mul_f32 v[82:83], v[82:83], v[14:15] op_sel:[0,1] op_sel_hi:[1,1]
    v_pk_mul_f32 v[76:77], v[76:77], v[14:15] op_sel:[0,0] op_sel_hi:[1,0]
    v_pk_mul_f32 v[78:79], v[78:79], v[14:15] op_sel:[0,0] op_sel_hi:[1,0]
    s_add_u32 s40, s40, 0x50000
    s_waitcnt lgkmcnt(0)
    v_cmpx_ne_u64 vcc, v[74:75], v[70:71]
    s_and_b64 s[82:83], vcc, s[80:81]
    s_cbranch_scc1 L2_c41
L2_d41:
    v_mov_b64 v[84:85], v[70:71]
    v_mov_b32 v7, v93
    v_mov_b64 v[86:87], v[74:75]
    s_mov_b64 exec, -1
    s_or_b64 s[80:81], s[80:81], vcc
    v_cmpx_ne_u64 vcc, v[72:73], v[68:69]
    s_and_b64 s[82:83], vcc, s[80:81]
    s_cbranch_scc1 L2_c42
L2_d42:
    v_mov_b64 v[84:85], v[68:69]
    v_mov_b32 v7, v92
    v_mov_b64 v[86:87], v[72:73]
    s_mov_b64 exec, -1
    s_or_b64 s[80:81], s[80:81], vcc
    ds_read_b64 v[70:71], v95 offset:65408
    ds_read_b64 v[68:69], v94 offset:65408
    s_waitcnt vmcnt(5)
    v_and_b32 v46, 0x20000000, v39
    v_lshrrev_b32 v47, 14, v35
    v_bitop3_b32 v47, v47, v5, v46 bitop3:0xea
    ds_read_b64 v[102:103], v47
    v_bitop3_b32 v93, v35, v5, v46 bitop3:0xea
    v_and_b32 v46, 0x10000000, v39
    v_lshrrev_b32 v47, 14, v34
    v_bitop3_b32 v47, v47, v5, v46 bitop3:0xea
    ds_read_b64 v[100:101], v47
    v_bitop3_b32 v92, v34, v5, v46 bitop3:0xea
    v_and_b32 v46, 0x80000000, v39
    v_lshrrev_b32 v47, 14, v37
    v_bitop3_b32 v47, v47, v5, v46 bitop3:0xea
    ds_read_b64 v[106:107], v47
    v_and_b32 v46, 0x40000000, v39
    v_lshrrev_b32 v47, 14, v36
    v_bitop3_b32 v47, v47, v5, v46 bitop3:0xea
    ds_read_b64 v[104:105], v47
    s_waitcnt lgkmcnt(4)
    v_mfma_f32_4x4x4_16b_bf16 v[80:83], v[10:11], v[70:71], v[80:83]
    v_mfma_f32_4x4x4_16b_bf16 v[76:79], v[10:11], v[68:69], v[76:79]
    v_perm_b32 v15, v35, v38, s45
    v_bitop3_b32 v46, v35, 0.5, -0.5 bitop3:0xa8
    v_perm_b32 v14, v34, v38, s44
    v_bitop3_b32 v47, v34, 0.5, -0.5 bitop3:0xa8
    v_cvt_pk_bf16_f32 v80, v80, v81
    v_cvt_pk_bf16_f32 v81, v82, v83
    ds_wrxchg_rtn_b64 v[74:75], v95, v[80:81] offset:65408
    v_cvt_pk_bf16_f32 v76, v76, v77
    v_cvt_pk_bf16_f32 v77, v78, v79
    ds_wrxchg_rtn_b64 v[72:73], v94, v[76:77] offset:65408
    s_waitcnt lgkmcnt(2)
    s_barrier
    s_setprio 3
    s_mov_b32 m0, s100
    s_nop 0
    ds_write_addtid_b32 v116 offset:32768
    ds_write_addtid_b32 v117 offset:33024
    ds_write_addtid_b32 v118 offset:33280
    ds_write_addtid_b32 v119 offset:33536
    buffer_load_dwordx4 v[116:119], v3, s[16:19], s40 offen offset:2048
    ds_write_addtid_b32 v120 offset:33792
    ds_write_addtid_b32 v121 offset:34048
    ds_write_addtid_b32 v122 offset:34304
    ds_write_addtid_b32 v123 offset:34560
    buffer_load_dwordx4 v[120:123], v3, s[16:19], s40 offen offset:3072
    v_mfma_f32_4x4x4_16b_bf16 v[80:83], v[8:9], v[102:103], 0
    v_mfma_f32_4x4x4_16b_bf16 v[76:79], v[8:9], v[100:101], 0
    v_bitop3_b32 v15, v6, v15, v46 bitop3:0xca
    v_bitop3_b32 v14, v6, v14, v47 bitop3:0xca
    v_cmp_lt_u32 s[84:85], v5, v92
    s_nop 0
    v_pk_mul_f32 v[80:81], v[80:81], v[14:15] op_sel:[0,1] op_sel_hi:[1,1]
    v_pk_mul_f32 v[82:83], v[82:83], v[14:15] op_sel:[0,1] op_sel_hi:[1,1]
    v_pk_mul_f32 v[76:77], v[76:77], v[14:15] op_sel:[0,0] op_sel_hi:[1,0]
    v_pk_mul_f32 v[78:79], v[78:79], v[14:15] op_sel:[0,0] op_sel_hi:[1,0]
    v_and_b32 v47, 0x0fffffff, v42
    v_mov_b32 v33, v42
    buffer_load_dwordx2 v[28:29], v47, s[8:11], 0 offen
    buffer_load_dwordx3 v[30:32], v47, s[8:11], 0 offen offset:8
    v_mov_b32 v44, v43
    s_cmp_gt_u32 s37, 1024
    s_cbranch_scc1 L2_xs43
    s_cmp_lg_u32 s101, 0
    s_cbranch_scc1 L2_xa43
L2_xb43:
    v_lshlrev_b32 v89, 16, v96
    v_add_u32 v90, 60, v97
    v_bitop3_b32 v90, v89, v45, v90 bitop3:0x6a
    ds_write_b32 v98, v90 offset:12
    v_lshlrev_b32 v89, 20, v96
    v_add_u32 v90, 40, v97
    v_bitop3_b32 v90, v89, v45, v90 bitop3:0x6a
    ds_write_b32 v98, v90 offset:8
    v_lshlrev_b32 v89, 24, v96
    v_add_u32 v90, 20, v97
    v_bitop3_b32 v90, v89, v45, v90 bitop3:0x6a
    ds_write_b32 v98, v90 offset:4
    v_lshlrev_b32 v89, 28, v96
    v_bitop3_b32 v90, v89, v45, v97 bitop3:0x6a
    ds_write_b32 v98, v90 offset:0
    v_mov_b32_dpp v91, v66 quad_perm:[1,1,1,1] row_mask:0xf bank_mask:0xf
    v_and_b32 v89, 3, v91
    v_and_b32 v97, 0xfffc, v91
    v_sub_u16_dpp v88, v66, v91 quad_perm:[3,3,3,3] row_mask:0xf bank_mask:0xf
    v_mad_u32_u24 v97, v97, 5, v4
    v_add_u32 v99, v88, v89
    v_bfm_b32 v96, v88, v89
    v_cmp_lt_u32 s[58:59], 16, v99
    v_lshlrev_b32 v89, v1, v96
    v_and_b32 v89, v45, v89
    v_cmp_ne_u32 vcc, 0, v89
    v_xor_b32 v90, v97, v89
    s_add_u32 s3, s37, s38
    v_mbcnt_lo_u32_b32 v98, vcc_lo, 0
    v_mbcnt_hi_u32_b32 v98, vcc_hi, v98
    s_bcnt1_i32_b64 s41, vcc
    v_lshl_add_u32 v98, v98, 2, s3
    s_mov_b64 exec, vcc
    ds_write_b32 v98, v90
    s_mov_b64 exec, -1
    s_lshl2_add_u32 s37, s41, s37
    s_cmp_lg_u64 s[58:59], 0
    s_cbranch_scc1 L2_xe43
L2_xr43:
    v_add_u32 v98, s37, v0
    v_mov_b32 v90, -1
    ds_write_b32 v98, v90
    ds_read2st64_b32 v[40:41], v0 offset0:0 offset1:1
    ds_read2st64_b32 v[42:43], v0 offset0:2 offset1:3
    s_sub_u32 s3, s37, 768
    s_cmp_gt_u32 s3, 256
    s_cbranch_scc1 L2_xf43
L2_xg43:
    v_lshrrev_b64 v[64:65], 16, v[64:65]
    v_lshrrev_b64 v[66:67], 16, v[66:67]
    s_setprio 2
    ds_write_addtid_b32 v124 offset:34816
    ds_write_addtid_b32 v125 offset:35072
    ds_write_addtid_b32 v126 offset:35328
    ds_write_addtid_b32 v127 offset:35584
    s_add_u32 s3, s40, 4096
    buffer_load_dwordx4 v[124:127], v3, s[16:19], s3 offen
    s_waitcnt lgkmcnt(14)
    v_cmpx_ne_u64 vcc, v[74:75], v[70:71]
    s_and_b64 s[82:83], vcc, s[80:81]
    s_cbranch_scc1 L2_c44
L2_d44:
    v_mov_b64 v[84:85], v[70:71]
    v_mov_b32 v7, v95
    v_mov_b64 v[86:87], v[74:75]
    s_mov_b64 exec, -1
    s_or_b64 s[80:81], s[80:81], vcc
    v_cmpx_ne_u64 vcc, v[72:73], v[68:69]
    s_and_b64 s[82:83], vcc, s[80:81]
    s_cbranch_scc1 L2_c45
L2_d45:
    v_mov_b64 v[84:85], v[68:69]
    v_mov_b32 v7, v94
    v_mov_b64 v[86:87], v[72:73]
    s_mov_b64 exec, -1
    s_or_b64 s[80:81], s[80:81], vcc
    ds_read_b64 v[70:71], v93 offset:65408
    s_and_b64 exec, s[84:85], s[80:81]
    v_mfma_f32_4x4x4_16b_bf16 v[76:79], v[12:13], v[84:85], 0
    v_mov_b32 v92, v7
    s_andn2_b64 s[80:81], s[80:81], s[84:85]
    v_mfma_f32_4x4x4_16b_bf16 v[76:79], v[10:11], v[86:87], v[76:79]
    s_mov_b64 exec, -1
    ds_read_b64 v[68:69], v92 offset:65408
    s_setprio 1
    s_mov_b32 m0, s38
    s_nop 0
    ds_write_addtid_b32 v108 offset:0
    ds_write_addtid_b32 v109 offset:256
    ds_write_addtid_b32 v110 offset:512
    ds_write_addtid_b32 v111 offset:768
    s_waitcnt lgkmcnt(4)
    v_mfma_f32_4x4x4_16b_bf16 v[80:83], v[10:11], v[70:71], v[80:83]
    v_mfma_f32_4x4x4_16b_bf16 v[76:79], v[10:11], v[68:69], v[76:79]
    v_and_b32 v46, 0x40000000, v39
    v_bitop3_b32 v94, v36, v5, v46 bitop3:0xea
    v_and_b32 v46, 0x80000000, v39
    v_bitop3_b32 v95, v37, v5, v46 bitop3:0xea
    v_perm_b32 v15, v37, v38, s47
    v_bitop3_b32 v46, v37, 0.5, -0.5 bitop3:0xa8
    v_perm_b32 v14, v36, v38, s46
    v_bitop3_b32 v47, v36, 0.5, -0.5 bitop3:0xa8
    v_cvt_pk_bf16_f32 v80, v80, v81
    v_cvt_pk_bf16_f32 v81, v82, v83
    ds_wrxchg_rtn_b64 v[74:75], v93, v[80:81] offset:65408
    v_cvt_pk_bf16_f32 v76, v76, v77
    v_cvt_pk_bf16_f32 v77, v78, v79
    ds_wrxchg_rtn_b64 v[72:73], v92, v[76:77] offset:65408
    s_setprio 0
    s_waitcnt vmcnt(9)
    ds_write_addtid_b32 v112 offset:1024
    ds_write_addtid_b32 v113 offset:1280
    ds_write_addtid_b32 v114 offset:1536
    ds_write_addtid_b32 v115 offset:1792
    v_mfma_f32_4x4x4_16b_bf16 v[80:83], v[8:9], v[106:107], 0
    v_mfma_f32_4x4x4_16b_bf16 v[76:79], v[8:9], v[104:105], 0
    v_bitop3_b32 v15, v6, v15, v46 bitop3:0xca
    v_bitop3_b32 v14, v6, v14, v47 bitop3:0xca
    s_nop 1
    v_pk_mul_f32 v[80:81], v[80:81], v[14:15] op_sel:[0,1] op_sel_hi:[1,1]
    v_pk_mul_f32 v[82:83], v[82:83], v[14:15] op_sel:[0,1] op_sel_hi:[1,1]
    v_pk_mul_f32 v[76:77], v[76:77], v[14:15] op_sel:[0,0] op_sel_hi:[1,0]
    v_pk_mul_f32 v[78:79], v[78:79], v[14:15] op_sel:[0,0] op_sel_hi:[1,0]
    s_add_u32 s42, s42, 1
    s_waitcnt lgkmcnt(0)
L2_loop:
    s_barrier
    s_bitcmp1_b32 s36, s42
    s_cbranch_scc1 L2_slow
L2_ret2:
    s_setprio 3
    v_and_b32 v47, 0x0fffffff, v44
    v_mov_b32 v39, v44
    buffer_load_dwordx2 v[34:35], v47, s[8:11], 0 offen
    buffer_load_dwordx3 v[36:38], v47, s[8:11], 0 offen offset:8
    v_cmpx_ne_u64 vcc, v[74:75], v[70:71]
    s_and_b64 s[82:83], vcc, s[80:81]
    s_cbranch_scc1 L2_c46
L2_d46:
    v_mov_b64 v[84:85], v[70:71]
    v_mov_b32 v7, v93
    v_mov_b64 v[86:87], v[74:75]
    s_mov_b64 exec, -1
    s_or_b64 s[80:81], s[80:81], vcc
    v_cmpx_ne_u64 vcc, v[72:73], v[68:69]
    s_and_b64 s[82:83], vcc, s[80:81]
    s_cbranch_scc1 L2_c47
L2_d47:
    v_mov_b64 v[84:85], v[68:69]
    v_mov_b32 v7, v92
    v_mov_b64 v[86:87], v[72:73]
    s_mov_b64 exec, -1
    s_or_b64 s[80:81], s[80:81], vcc
    ds_read_b64 v[70:71], v95 offset:65408
    ds_read_b64 v[68:69], v94 offset:65408
    s_waitcnt vmcnt(9)
    v_and_b32 v46, 0x20000000, v21
    v_lshrrev_b32 v47, 14, v17
    v_bitop3_b32 v47, v47, v5, v46 bitop3:0xea
    ds_read_b64 v[102:103], v47
    v_bitop3_b32 v93, v17, v5, v46 bitop3:0xea
    v_and_b32 v46, 0x10000000, v21
    v_lshrrev_b32 v47, 14, v16
    v_bitop3_b32 v47, v47, v5, v46 bitop3:0xea
    ds_read_b64 v[100:101], v47
    v_bitop3_b32 v92, v16, v5, v46 bitop3:0xea
    s_waitcnt lgkmcnt(2)
    v_mfma_f32_4x4x4_16b_bf16 v[80:83], v[10:11], v[70:71], v[80:83]
    v_mfma_f32_4x4x4_16b_bf16 v[76:79], v[10:11], v[68:69], v[76:79]
    v_perm_b32 v15, v17, v20, s45
    v_bitop3_b32 v46, v17, 0.5, -0.5 bitop3:0xa8
    v_perm_b32 v14, v16, v20, s44
    v_bitop3_b32 v47, v16, 0.5, -0.5 bitop3:0xa8
    v_cvt_pk_bf16_f32 v80, v80, v81
    v_cvt_pk_bf16_f32 v81, v82, v83
    ds_wrxchg_rtn_b64 v[74:75], v95, v[80:81] offset:65408
    v_cvt_pk_bf16_f32 v76, v76, v77
    v_cvt_pk_bf16_f32 v77, v78, v79
    ds_wrxchg_rtn_b64 v[72:73], v94, v[76:77] offset:65408
    s_waitcnt lgkmcnt(2)
    v_mfma_f32_4x4x4_16b_bf16 v[80:83], v[8:9], v[102:103], 0
    v_mfma_f32_4x4x4_16b_bf16 v[76:79], v[8:9], v[100:101], 0
    v_bitop3_b32 v15, v6, v15, v46 bitop3:0xca
    v_bitop3_b32 v14, v6, v14, v47 bitop3:0xca
    v_cmp_lt_u32 s[84:85], v5, v92
    s_nop 0
    v_pk_mul_f32 v[80:81], v[80:81], v[14:15] op_sel:[0,1] op_sel_hi:[1,1]
    v_pk_mul_f32 v[82:83], v[82:83], v[14:15] op_sel:[0,1] op_sel_hi:[1,1]
    v_pk_mul_f32 v[76:77], v[76:77], v[14:15] op_sel:[0,0] op_sel_hi:[1,0]
    v_pk_mul_f32 v[78:79], v[78:79], v[14:15] op_sel:[0,0] op_sel_hi:[1,0]
    buffer_load_dwordx4 v[108:111], v3, s[16:19], s40 offen offset:0
    s_waitcnt lgkmcnt(0)
    v_cmpx_ne_u64 vcc, v[74:75], v[70:71]
    s_and_b64 s[82:83], vcc, s[80:81]
    s_cbranch_scc1 L2_c48
L2_d48:
    v_mov_b64 v[84:85], v[70:71]
    v_mov_b32 v7, v95
    v_mov_b64 v[86:87], v[74:75]
    s_mov_b64 exec, -1
    s_or_b64 s[80:81], s[80:81], vcc
    v_cmpx_ne_u64 vcc, v[72:73], v[68:69]
    s_and_b64 s[82:83], vcc, s[80:81]
    s_cbranch_scc1 L2_c49
L2_d49:
    v_mov_b64 v[84:85], v[68:69]
    v_mov_b32 v7, v94
    v_mov_b64 v[86:87], v[72:73]
    s_mov_b64 exec, -1
    s_or_b64 s[80:81], s[80:81], vcc
    ds_read_b64 v[70:71], v93 offset:65408
    s_and_b64 exec, s[84:85], s[80:81]
    v_mfma_f32_4x4x4_16b_bf16 v[76:79], v[12:13], v[84:85], 0
    v_mov_b32 v92, v7
    s_andn2_b64 s[80:81], s[80:81], s[84:85]
    v_mfma_f32_4x4x4_16b_bf16 v[76:79], v[10:11], v[86:87], v[76:79]
    s_mov_b64 exec, -1
    ds_read_b64 v[68:69], v92 offset:65408
    v_and_b32 v46, 0x80000000, v21
    v_lshrrev_b32 v47, 14, v19
    v_bitop3_b32 v47, v47, v5, v46 bitop3:0xea
    ds_read_b64 v[106:107], v47
    v_bitop3_b32 v95, v19, v5, v46 bitop3:0xea
    v_and_b32 v46, 0x40000000, v21
    v_lshrrev_b32 v47, 14, v18
    v_bitop3_b32 v47, v47, v5, v46 bitop3:0xea
    ds_read_b64 v[104:105], v47
    v_bitop3_b32 v94, v18, v5, v46 bitop3:0xea
    s_waitcnt lgkmcnt(2)
    v_mfma_f32_4x4x4_16b_bf16 v[80:83], v[10:11], v[70:71], v[80:83]
    v_mfma_f32_4x4x4_16b_bf16 v[76:79], v[10:11], v[68:69], v[76:79]
    v_perm_b32 v15, v19, v20, s47
    v_bitop3_b32 v46, v19, 0.5, -0.5 bitop3:0xa8
    v_perm_b32 v14, v18, v20, s46
    v_bitop3_b32 v47, v18, 0.5, -0.5 bitop3:0xa8
    v_cvt_pk_bf16_f32 v80, v80, v81
    v_cvt_pk_bf16_f32 v81, v82, v83
    ds_wrxchg_rtn_b64 v[74:75], v93, v[80:81] offset:65408
    v_cvt_pk_bf16_f32 v76, v76, v77
    v_cvt_pk_bf16_f32 v77, v78, v79
    ds_wrxchg_rtn_b64 v[72:73], v92, v[76:77] offset:65408
    s_setprio 2
    s_waitcnt lgkmcnt(2)
    v_mfma_f32_4x4x4_16b_bf16 v[80:83], v[8:9], v[106:107], 0
    v_mfma_f32_4x4x4_16b_bf16 v[76:79], v[8:9], v[104:105], 0
    v_bitop3_b32 v15, v6, v15, v46 bitop3:0xca
    v_bitop3_b32 v14, v6, v14, v47 bitop3:0xca
    s_nop 1
    v_pk_mul_f32 v[80:81], v[80:81], v[14:15] op_sel:[0,1] op_sel_hi:[1,1]
    v_pk_mul_f32 v[82:83], v[82:83], v[14:15] op_sel:[0,1] op_sel_hi:[1,1]
    v_pk_mul_f32 v[76:77], v[76:77], v[14:15] op_sel:[0,0] op_sel_hi:[1,0]
    v_pk_mul_f32 v[78:79], v[78:79], v[14:15] op_sel:[0,0] op_sel_hi:[1,0]
    v_and_b32 v47, 0x0fffffff, v40
    v_mov_b32 v21, v40
    buffer_load_dwordx2 v[16:17], v47, s[8:11], 0 offen
    buffer_load_dwordx3 v[18:20], v47, s[8:11], 0 offen offset:8
    s_waitcnt lgkmcnt(0)
    v_cmpx_ne_u64 vcc, v[74:75], v[70:71]
    s_and_b64 s[82:83], vcc, s[80:81]
    s_cbranch_scc1 L2_c50
L2_d50:
    v_mov_b64 v[84:85], v[70:71]
    v_mov_b32 v7, v93
    v_mov_b64 v[86:87], v[74:75]
    s_mov_b64 exec, -1
    s_or_b64 s[80:81], s[80:81], vcc
    v_cmpx_ne_u64 vcc, v[72:73], v[68:69]
    s_and_b64 s[82:83], vcc, s[80:81]
    s_cbranch_scc1 L2_c51
L2_d51:
    v_mov_b64 v[84:85], v[68:69]
    v_mov_b32 v7, v92
    v_mov_b64 v[86:87], v[72:73]
    s_mov_b64 exec, -1
    s_or_b64 s[80:81], s[80:81], vcc
    ds_read_b64 v[70:71], v95 offset:65408
    ds_read_b64 v[68:69], v94 offset:65408
    s_waitcnt vmcnt(10)
    v_and_b32 v46, 0x20000000, v27
    v_lshrrev_b32 v47, 14, v23
    v_bitop3_b32 v47, v47, v5, v46 bitop3:0xea
    ds_read_b64 v[102:103], v47
    v_bitop3_b32 v93, v23, v5, v46 bitop3:0xea
    v_and_b32 v46, 0x10000000, v27
    v_lshrrev_b32 v47, 14, v22
    v_bitop3_b32 v47, v47, v5, v46 bitop3:0xea
    ds_read_b64 v[100:101], v47
    v_bitop3_b32 v92, v22, v5, v46 bitop3:0xea
    s_waitcnt lgkmcnt(2)
    v_mfma_f32_4x4x4_16b_bf16 v[80:83], v[10:11], v[70:71], v[80:83]
    v_mfma_f32_4x4x4_16b_bf16 v[76:79], v[10:11], v[68:69], v[76:79]
    v_perm_b32 v15, v23, v26, s45
    v_bitop3_b32 v46, v23, 0.5, -0.5 bitop3:0xa8
    v_perm_b32 v14, v22, v26, s44
    v_bitop3_b32 v47, v22, 0.5, -0.5 bitop3:0xa8
    v_cvt_pk_bf16_f32 v80, v80, v81
    v_cvt_pk_bf16_f32 v81, v82, v83
    ds_wrxchg_rtn_b64 v[74:75], v95, v[80:81] offset:65408
    v_cvt_pk_bf16_f32 v76, v76, v77
    v_cvt_pk_bf16_f32 v77, v78, v79
    ds_wrxchg_rtn_b64 v[72:73], v94, v[76:77] offset:65408
    s_waitcnt lgkmcnt(2)
    v_mfma_f32_4x4x4_16b_bf16 v[80:83], v[8:9], v[102:103], 0
    v_mfma_f32_4x4x4_16b_bf16 v[76:79], v[8:9], v[100:101], 0
    v_bitop3_b32 v15, v6, v15, v46 bitop3:0xca
    v_bitop3_b32 v14, v6, v14, v47 bitop3:0xca
    v_cmp_lt_u32 s[84:85], v5, v92
    s_nop 0
    v_pk_mul_f32 v[80:81], v[80:81], v[14:15] op_sel:[0,1] op_sel_hi:[1,1]
    v_pk_mul_f32 v[82:83], v[82:83], v[14:15] op_sel:[0,1] op_sel_hi:[1,1]
    v_pk_mul_f32 v[76:77], v[76:77], v[14:15] op_sel:[0,0] op_sel_hi:[1,0]
    v_pk_mul_f32 v[78:79], v[78:79], v[14:15] op_sel:[0,0] op_sel_hi:[1,0]
    v_sub_u16 v88, v56, v48
    v_and_b32 v89, 3, v48
    v_add3_u32 v99, v88, v89, 3
    v_and_b32 v99, -4, v99
    v_max_u32 v99, 4, v99
    v_and_b32 v97, 0xfffc, v48
    v_bfm_b32 v96, v88, v89
    v_add_u32_dpp v91, v99, v99 row_shr:1 row_mask:0xf bank_mask:0xf bound_ctrl:1
    v_mad_u32_u24 v97, v97, 5, v2
    v_cmp_lt_u32 vcc, 16, v99
    v_add_u32_dpp v91, v91, v91 row_shr:2 row_mask:0xf bank_mask:0xf bound_ctrl:1
    v_sub_u32 v98, s38, v99
    v_lshrrev_b64 v[48:49], 16, v[48:49]
    v_add_u32_dpp v91, v91, v91 row_shr:4 row_mask:0xf bank_mask:0xf bound_ctrl:1
    v_lshrrev_b64 v[56:57], 16, v[56:57]
    s_mov_b32 s101, 0
    v_add_u32_dpp v91, v91, v91 row_shr:8 row_mask:0xf bank_mask:0xf bound_ctrl:1
    s_nop 1
    v_add_u32_dpp v91, v91, v91 row_bcast:15 row_mask:0xa bank_mask:0xf
    s_nop 1
    v_add_u32_dpp v91, v91, v91 row_bcast:31 row_mask:0xc bank_mask:0xf
    v_add_u32 v98, v98, v91
    v_readlane_b32 s37, v91, 63
    s_cbranch_vccnz L2_xo52
L2_xp52:
    buffer_load_dwordx4 v[112:115], v3, s[16:19], s40 offen offset:1024
    s_waitcnt lgkmcnt(0)
    v_cmpx_ne_u64 vcc, v[74:75], v[70:71]
    s_and_b64 s[82:83], vcc, s[80:81]
    s_cbranch_scc1 L2_c53
L2_d53:
    v_mov_b64 v[84:85], v[70:71]
    v_mov_b32 v7, v95
    v_mov_b64 v[86:87], v[74:75]
    s_mov_b64 exec, -1
    s_or_b64 s[80:81], s[80:81], vcc
    v_cmpx_ne_u64 vcc, v[72:73], v[68:69]
    s_and_b64 s[82:83], vcc, s[80:81]
    s_cbranch_scc1 L2_c54
L2_d54:
    v_mov_b64 v[84:85], v[68:69]
    v_mov_b32 v7, v94
    v_mov_b64 v[86:87], v[72:73]
    s_mov_b64 exec, -1
    s_or_b64 s[80:81], s[80:81], vcc
    ds_read_b64 v[70:71], v93 offset:65408
    s_and_b64 exec, s[84:85], s[80:81]
    v_mfma_f32_4x4x4_16b_bf16 v[76:79], v[12:13], v[84:85], 0
    v_mov_b32 v92, v7
    s_andn2_b64 s[80:81], s[80:81], s[84:85]
    v_mfma_f32_4x4x4_16b_bf16 v[76:79], v[10:11], v[86:87], v[76:79]
    s_mov_b64 exec, -1
    ds_read_b64 v[68:69], v92 offset:65408
    v_and_b32 v46, 0x80000000, v27
    v_lshrrev_b32 v47, 14, v25
    v_bitop3_b32 v47, v47, v5, v46 bitop3:0xea
    ds_read_b64 v[106:107], v47
    v_bitop3_b32 v95, v25, v5, v46 bitop3:0xea
    v_and_b32 v46, 0x40000000, v27
    v_lshrrev_b32 v47, 14, v24
    v_bitop3_b32 v47, v47, v5, v46 bitop3:0xea
    ds_read_b64 v[104:105], v47
    v_bitop3_b32 v94, v24, v5, v46 bitop3:0xea
    s_waitcnt lgkmcnt(2)
    v_mfma_f32_4x4x4_16b_bf16 v[80:83], v[10:11], v[70:71], v[80:83]
    v_mfma_f32_4x4x4_16b_bf16 v[76:79], v[10:11], v[68:69], v[76:79]
    v_perm_b32 v15, v25, v26, s47
    v_bitop3_b32 v46, v25, 0.5, -0.5 bitop3:0xa8
    v_perm_b32 v14, v24, v26, s46
    v_bitop3_b32 v47, v24, 0.5, -0.5 bitop3:0xa8
    v_cvt_pk_bf16_f32 v80, v80, v81
    v_cvt_pk_bf16_f32 v81, v82, v83
    ds_wrxchg_rtn_b64 v[74:75], v93, v[80:81] offset:65408
    v_cvt_pk_bf16_f32 v76, v76, v77
    v_cvt_pk_bf16_f32 v77, v78, v79
    ds_wrxchg_rtn_b64 v[72:73], v92, v[76:77] offset:65408
    s_setprio 1
    s_waitcnt lgkmcnt(2)
    v_mfma_f32_4x4x4_16b_bf16 v[80:83], v[8:9], v[106:107], 0
    v_mfma_f32_4x4x4_16b_bf16 v[76:79], v[8:9], v[104:105], 0
    v_bitop3_b32 v15, v6, v15, v46 bitop3:0xca
    v_bitop3_b32 v14, v6, v14, v47 bitop3:0xca
    s_nop 1
    v_pk_mul_f32 v[80:81], v[80:81], v[14:15] op_sel:[0,1] op_sel_hi:[1,1]
    v_pk_mul_f32 v[82:83], v[82:83], v[14:15] op_sel:[0,1] op_sel_hi:[1,1]
    v_pk_mul_f32 v[76:77], v[76:77], v[14:15] op_sel:[0,0] op_sel_hi:[1,0]
    v_pk_mul_f32 v[78:79], v[78:79], v[14:15] op_sel:[0,0] op_sel_hi:[1,0]
    v_and_b32 v47, 0x0fffffff, v41
    v_mov_b32 v27, v41
    buffer_load_dwordx2 v[22:23], v47, s[8:11], 0 offen
    buffer_load_dwordx3 v[24:26], v47, s[8:11], 0 offen offset:8
    s_waitcnt lgkmcnt(0)
    v_cmpx_ne_u64 vcc, v[74:75], v[70:71]
    s_and_b64 s[82:83], vcc, s[80:81]
    s_cbranch_scc1 L2_c55
L2_d55:
    v_mov_b64 v[84:85], v[70:71]
    v_mov_b32 v7, v93
    v_mov_b64 v[86:87], v[74:75]
    s_mov_b64 exec, -1
    s_or_b64 s[80:81], s[80:81], vcc
    v_cmpx_ne_u64 vcc, v[72:73], v[68:69]
    s_and_b64 s[82:83], vcc, s[80:81]
    s_cbranch_scc1 L2_c56
L2_d56:
    v_mov_b64 v[84:85], v[68:69]
    v_mov_b32 v7, v92
    v_mov_b64 v[86:87], v[72:73]
    s_mov_b64 exec, -1
    s_or_b64 s[80:81], s[80:81], vcc
    ds_read_b64 v[70:71], v95 offset:65408
    ds_read_b64 v[68:69], v94 offset:65408
    s_waitcnt vmcnt(9)
    v_and_b32 v46, 0x20000000, v33
    v_lshrrev_b32 v47, 14, v29
    v_bitop3_b32 v47, v47, v5, v46 bitop3:0xea
    ds_read_b64 v[102:103], v47
    v_bitop3_b32 v93, v29, v5, v46 bitop3:0xea
    v_and_b32 v46, 0x10000000, v33
    v_lshrrev_b32 v47, 14, v28
    v_bitop3_b32 v47, v47, v5, v46 bitop3:0xea
    ds_read_b64 v[100:101], v47
    v_bitop3_b32 v92, v28, v5, v46 bitop3:0xea
    s_waitcnt lgkmcnt(2)
    v_mfma_f32_4x4x4_16b_bf16 v[80:83], v[10:11], v[70:71], v[80:83]
    v_mfma_f32_4x4x4_16b_bf16 v[76:79], v[10:11], v[68:69], v[76:79]
    v_perm_b32 v15, v29, v32, s45
    v_bitop3_b32 v46, v29, 0.5, -0.5 bitop3:0xa8
    v_perm_b32 v14, v28, v32, s44
    v_bitop3_b32 v47, v28, 0.5, -0.5 bitop3:0xa8
    v_cvt_pk_bf16_f32 v80, v80, v81
    v_cvt_pk_bf16_f32 v81, v82, v83
    ds_wrxchg_rtn_b64 v[74:75], v95, v[80:81] offset:65408
    v_cvt_pk_bf16_f32 v76, v76, v77
    v_cvt_pk_bf16_f32 v77, v78, v79
    ds_wrxchg_rtn_b64 v[72:73], v94, v[76:77] offset:65408
    s_waitcnt lgkmcnt(2)
    v_mfma_f32_4x4x4_16b_bf16 v[80:83], v[8:9], v[102:103], 0
    v_mfma_f32_4x4x4_16b_bf16 v[76:79], v[8:9], v[100:101], 0
    v_bitop3_b32 v15, v6, v15, v46 bitop3:0xca
    v_bitop3_b32 v14, v6, v14, v47 bitop3:0xca
    v_cmp_lt_u32 s[84:85], v5, v92
    s_nop 0
    v_pk_mul_f32 v[80:81], v[80:81], v[14:15] op_sel:[0,1] op_sel_hi:[1,1]
    v_pk_mul_f32 v[82:83], v[82:83], v[14:15] op_sel:[0,1] op_sel_hi:[1,1]
    v_pk_mul_f32 v[76:77], v[76:77], v[14:15] op_sel:[0,0] op_sel_hi:[1,0]
    v_pk_mul_f32 v[78:79], v[78:79], v[14:15] op_sel:[0,0] op_sel_hi:[1,0]
    s_waitcnt lgkmcnt(0)
    v_cmpx_ne_u64 vcc, v[74:75], v[70:71]
    s_and_b64 s[82:83], vcc, s[80:81]
    s_cbranch_scc1 L2_c57
L2_d57:
    v_mov_b64 v[84:85], v[70:71]
    v_mov_b32 v7, v95
    v_mov_b64 v[86:87], v[74:75]
    s_mov_b64 exec, -1
    s_or_b64 s[80:81], s[80:81], vcc
    v_cmpx_ne_u64 vcc, v[72:73], v[68:69]
    s_and_b64 s[82:83], vcc, s[80:81]
    s_cbranch_scc1 L2_c58
L2_d58:
    v_mov_b64 v[84:85], v[68:69]
    v_mov_b32 v7, v94
    v_mov_b64 v[86:87], v[72:73]
    s_mov_b64 exec, -1
    s_or_b64 s[80:81], s[80:81], vcc
    ds_read_b64 v[70:71], v93 offset:65408
    s_and_b64 exec, s[84:85], s[80:81]
    v_mfma_f32_4x4x4_16b_bf16 v[76:79], v[12:13], v[84:85], 0
    v_mov_b32 v92, v7
    s_andn2_b64 s[80:81], s[80:81], s[84:85]
    v_mfma_f32_4x4x4_16b_bf16 v[76:79], v[10:11], v[86:87], v[76:79]
    s_mov_b64 exec, -1
    ds_read_b64 v[68:69], v92 offset:65408
    v_and_b32 v46, 0x80000000, v33
    v_lshrrev_b32 v47, 14, v31
    v_bitop3_b32 v47, v47, v5, v46 bitop3:0xea
    ds_read_b64 v[106:107], v47
    v_bitop3_b32 v95, v31, v5, v46 bitop3:0xea
    v_and_b32 v46, 0x40000000, v33
    v_lshrrev_b32 v47, 14, v30
    v_bitop3_b32 v47, v47, v5, v46 bitop3:0xea
    ds_read_b64 v[104:105], v47
    v_bitop3_b32 v94, v30, v5, v46 bitop3:0xea
    s_waitcnt lgkmcnt(2)
    v_mfma_f32_4x4x4_16b_bf16 v[80:83], v[10:11], v[70:71], v[80:83]
    v_mfma_f32_4x4x4_16b_bf16 v[76:79], v[10:11], v[68:69], v[76:79]
    v_perm_b32 v15, v31, v32, s47
    v_bitop3_b32 v46, v31, 0.5, -0.5 bitop3:0xa8
    v_perm_b32 v14, v30, v32, s46
    v_bitop3_b32 v47, v30, 0.5, -0.5 bitop3:0xa8
    v_cvt_pk_bf16_f32 v80, v80, v81
    v_cvt_pk_bf16_f32 v81, v82, v83
    ds_wrxchg_rtn_b64 v[74:75], v93, v[80:81] offset:65408
    v_cvt_pk_bf16_f32 v76, v76, v77
    v_cvt_pk_bf16_f32 v77, v78, v79
    ds_wrxchg_rtn_b64 v[72:73], v92, v[76:77] offset:65408
    s_setprio 0
    s_waitcnt lgkmcnt(2)
    v_mfma_f32_4x4x4_16b_bf16 v[80:83], v[8:9], v[106:107], 0
    v_mfma_f32_4x4x4_16b_bf16 v[76:79], v[8:9], v[104:105], 0
    v_bitop3_b32 v15, v6, v15, v46 bitop3:0xca
    v_bitop3_b32 v14, v6, v14, v47 bitop3:0xca
    s_nop 1
    v_pk_mul_f32 v[80:81], v[80:81], v[14:15] op_sel:[0,1] op_sel_hi:[1,1]
    v_pk_mul_f32 v[82:83], v[82:83], v[14:15] op_sel:[0,1] op_sel_hi:[1,1]
    v_pk_mul_f32 v[76:77], v[76:77], v[14:15] op_sel:[0,0] op_sel_hi:[1,0]
    v_pk_mul_f32 v[78:79], v[78:79], v[14:15] op_sel:[0,0] op_sel_hi:[1,0]
    s_add_u32 s40, s40, 0xfff24000
    v_and_b32 v47, 0x0fffffff, v42
    v_mov_b32 v33, v42
    buffer_load_dwordx2 v[28:29], v47, s[8:11], 0 offen
    buffer_load_dwordx3 v[30:32], v47, s[8:11], 0 offen offset:8
    s_waitcnt lgkmcnt(0)
    v_cmpx_ne_u64 vcc, v[74:75], v[70:71]
    s_and_b64 s[82:83], vcc, s[80:81]
    s_cbranch_scc1 L2_c59
L2_d59:
    v_mov_b64 v[84:85], v[70:71]
    v_mov_b32 v7, v93
    v_mov_b64 v[86:87], v[74:75]
    s_mov_b64 exec, -1
    s_or_b64 s[80:81], s[80:81], vcc
    v_cmpx_ne_u64 vcc, v[72:73], v[68:69]
    s_and_b64 s[82:83], vcc, s[80:81]
    s_cbranch_scc1 L2_c60
L2_d60:
    v_mov_b64 v[84:85], v[68:69]
    v_mov_b32 v7, v92
    v_mov_b64 v[86:87], v[72:73]
    s_mov_b64 exec, -1
    s_or_b64 s[80:81], s[80:81], vcc
    ds_read_b64 v[70:71], v95 offset:65408
    ds_read_b64 v[68:69], v94 offset:65408
    s_waitcnt vmcnt(8)
    v_and_b32 v46, 0x20000000, v39
    v_lshrrev_b32 v47, 14, v35
    v_bitop3_b32 v47, v47, v5, v46 bitop3:0xea
    ds_read_b64 v[102:103], v47
    v_bitop3_b32 v93, v35, v5, v46 bitop3:0xea
    v_and_b32 v46, 0x10000000, v39
    v_lshrrev_b32 v47, 14, v34
    v_bitop3_b32 v47, v47, v5, v46 bitop3:0xea
    ds_read_b64 v[100:101], v47
    v_bitop3_b32 v92, v34, v5, v46 bitop3:0xea
    v_and_b32 v46, 0x80000000, v39
    v_lshrrev_b32 v47, 14, v37
    v_bitop3_b32 v47, v47, v5, v46 bitop3:0xea
    ds_read_b64 v[106:107], v47
    v_and_b32 v46, 0x40000000, v39
    v_lshrrev_b32 v47, 14, v36
    v_bitop3_b32 v47, v47, v5, v46 bitop3:0xea
    ds_read_b64 v[104:105], v47
    s_waitcnt lgkmcnt(4)
    v_mfma_f32_4x4x4_16b_bf16 v[80:83], v[10:11], v[70:71], v[80:83]
    v_mfma_f32_4x4x4_16b_bf16 v[76:79], v[10:11], v[68:69], v[76:79]
    v_perm_b32 v15, v35, v38, s45
    v_bitop3_b32 v46, v35, 0.5, -0.5 bitop3:0xa8
    v_perm_b32 v14, v34, v38, s44
    v_bitop3_b32 v47, v34, 0.5, -0.5 bitop3:0xa8
    v_cvt_pk_bf16_f32 v80, v80, v81
    v_cvt_pk_bf16_f32 v81, v82, v83
    ds_wrxchg_rtn_b64 v[74:75], v95, v[80:81] offset:65408
    v_cvt_pk_bf16_f32 v76, v76, v77
    v_cvt_pk_bf16_f32 v77, v78, v79
    ds_wrxchg_rtn_b64 v[72:73], v94, v[76:77] offset:65408
    s_waitcnt lgkmcnt(2)
    s_barrier
    s_setprio 3
    s_mov_b32 m0, s100
    s_nop 0
    ds_write_addtid_b32 v116 offset:32768
    ds_write_addtid_b32 v117 offset:33024
    ds_write_addtid_b32 v118 offset:33280
    ds_write_addtid_b32 v119 offset:33536
    buffer_load_dwordx4 v[116:119], v3, s[16:19], s40 offen offset:2048
    ds_write_addtid_b32 v120 offset:33792
    ds_write_addtid_b32 v121 offset:34048
    ds_write_addtid_b32 v122 offset:34304
    ds_write_addtid_b32 v123 offset:34560
    buffer_load_dwordx4 v[120:123], v3, s[16:19], s40 offen offset:3072
    v_mfma_f32_4x4x4_16b_bf16 v[80:83], v[8:9], v[102:103], 0
    v_mfma_f32_4x4x4_16b_bf16 v[76:79], v[8:9], v[100:101], 0
    v_bitop3_b32 v15, v6, v15, v46 bitop3:0xca
    v_bitop3_b32 v14, v6, v14, v47 bitop3:0xca
    v_cmp_lt_u32 s[84:85], v5, v92
    s_nop 0
    v_pk_mul_f32 v[80:81], v[80:81], v[14:15] op_sel:[0,1] op_sel_hi:[1,1]
    v_pk_mul_f32 v[82:83], v[82:83], v[14:15] op_sel:[0,1] op_sel_hi:[1,1]
    v_pk_mul_f32 v[76:77], v[76:77], v[14:15] op_sel:[0,0] op_sel_hi:[1,0]
    v_pk_mul_f32 v[78:79], v[78:79], v[14:15] op_sel:[0,0] op_sel_hi:[1,0]
    v_mov_b32 v44, v43
    s_cmp_gt_u32 s37, 1024
    s_cbranch_scc1 L2_xs61
    s_cmp_lg_u32 s101, 0
    s_cbranch_scc1 L2_xa61
L2_xb61:
    v_lshlrev_b32 v89, 16, v96
    v_add_u32 v90, 60, v97
    v_bitop3_b32 v90, v89, v45, v90 bitop3:0x6a
    ds_write_b32 v98, v90 offset:12
    v_lshlrev_b32 v89, 20, v96
    v_add_u32 v90, 40, v97
    v_bitop3_b32 v90, v89, v45, v90 bitop3:0x6a
    ds_write_b32 v98, v90 offset:8
    v_lshlrev_b32 v89, 24, v96
    v_add_u32 v90, 20, v97
    v_bitop3_b32 v90, v89, v45, v90 bitop3:0x6a
    ds_write_b32 v98, v90 offset:4
    v_lshlrev_b32 v89, 28, v96
    v_bitop3_b32 v90, v89, v45, v97 bitop3:0x6a
    ds_write_b32 v98, v90 offset:0
    v_mov_b32_dpp v91, v64 quad_perm:[0,0,0,0] row_mask:0xf bank_mask:0xf
    v_and_b32 v89, 3, v91
    v_and_b32 v97, 0xfffc, v91
    v_sub_u16_dpp v88, v64, v91 quad_perm:[2,2,2,2] row_mask:0xf bank_mask:0xf
    v_mad_u32_u24 v97, v97, 5, v4
    v_add_u32 v99, v88, v89
    v_bfm_b32 v96, v88, v89
    v_cmp_lt_u32 s[58:59], 16, v99
    v_lshlrev_b32 v89, v1, v96
    v_and_b32 v89, v45, v89
    v_cmp_ne_u32 vcc, 0, v89
    v_xor_b32 v90, v97, v89
    s_add_u32 s3, s37, s38
    v_mbcnt_lo_u32_b32 v98, vcc_lo, 0
    v_mbcnt_hi_u32_b32 v98, vcc_hi, v98
    s_bcnt1_i32_b64 s41, vcc
    v_lshl_add_u32 v98, v98, 2, s3
    s_mov_b64 exec, vcc
    ds_write_b32 v98, v90
    s_mov_b64 exec, -1
    s_lshl2_add_u32 s37, s41, s37
    s_cmp_lg_u64 s[58:59], 0
    s_cbranch_scc1 L2_xe61
L2_xr61:
    v_add_u32 v98, s37, v0
    v_mov_b32 v90, -1
    ds_write_b32 v98, v90
    ds_read2st64_b32 v[40:41], v0 offset0:0 offset1:1
    ds_read2st64_b32 v[42:43], v0 offset0:2 offset1:3
    s_sub_u32 s3, s37, 768
    s_cmp_gt_u32 s3, 256
    s_cbranch_scc1 L2_xf61
L2_xg61:
    s_setprio 2
    ds_write_addtid_b32 v124 offset:34816
    ds_write_addtid_b32 v125 offset:35072
    ds_write_addtid_b32 v126 offset:35328
    ds_write_addtid_b32 v127 offset:35584
    s_add_u32 s3, s40, 4096
    buffer_load_dwordx4 v[124:127], v3, s[16:19], s3 offen
    s_waitcnt lgkmcnt(14)
    v_cmpx_ne_u64 vcc, v[74:75], v[70:71]
    s_and_b64 s[82:83], vcc, s[80:81]
    s_cbranch_scc1 L2_c62
L2_d62:
    v_mov_b64 v[84:85], v[70:71]
    v_mov_b32 v7, v95
    v_mov_b64 v[86:87], v[74:75]
    s_mov_b64 exec, -1
    s_or_b64 s[80:81], s[80:81], vcc
    v_cmpx_ne_u64 vcc, v[72:73], v[68:69]
    s_and_b64 s[82:83], vcc, s[80:81]
    s_cbranch_scc1 L2_c63
L2_d63:
    v_mov_b64 v[84:85], v[68:69]
    v_mov_b32 v7, v94
    v_mov_b64 v[86:87], v[72:73]
    s_mov_b64 exec, -1
    s_or_b64 s[80:81], s[80:81], vcc
    ds_read_b64 v[70:71], v93 offset:65408
    s_and_b64 exec, s[84:85], s[80:81]
    v_mfma_f32_4x4x4_16b_bf16 v[76:79], v[12:13], v[84:85], 0
    v_mov_b32 v92, v7
    s_andn2_b64 s[80:81], s[80:81], s[84:85]
    v_mfma_f32_4x4x4_16b_bf16 v[76:79], v[10:11], v[86:87], v[76:79]
    s_mov_b64 exec, -1
    ds_read_b64 v[68:69], v92 offset:65408
    s_setprio 1
    s_waitcnt vmcnt(10)
    s_mov_b32 m0, s38
    s_nop 0
    ds_write_addtid_b32 v108 offset:0
    ds_write_addtid_b32 v109 offset:256
    ds_write_addtid_b32 v110 offset:512
    ds_write_addtid_b32 v111 offset:768
    s_waitcnt lgkmcnt(4)
    v_mfma_f32_4x4x4_16b_bf16 v[80:83], v[10:11], v[70:71], v[80:83]
    v_mfma_f32_4x4x4_16b_bf16 v[76:79], v[10:11], v[68:69], v[76:79]
    v_and_b32 v46, 0x40000000, v39
    v_bitop3_b32 v94, v36, v5, v46 bitop3:0xea
    v_and_b32 v46, 0x80000000, v39
    v_bitop3_b32 v95, v37, v5, v46 bitop3:0xea
    v_perm_b32 v15, v37, v38, s47
    v_bitop3_b32 v46, v37, 0.5, -0.5 bitop3:0xa8
    v_perm_b32 v14, v36, v38, s46
    v_bitop3_b32 v47, v36, 0.5, -0.5 bitop3:0xa8
    v_cvt_pk_bf16_f32 v80, v80, v81
    v_cvt_pk_bf16_f32 v81, v82, v83
    ds_wrxchg_rtn_b64 v[74:75], v93, v[80:81] offset:65408
    v_cvt_pk_bf16_f32 v76, v76, v77
    v_cvt_pk_bf16_f32 v77, v78, v79
    ds_wrxchg_rtn_b64 v[72:73], v92, v[76:77] offset:65408
    s_setprio 0
    s_waitcnt vmcnt(7)
    ds_write_addtid_b32 v112 offset:1024
    ds_write_addtid_b32 v113 offset:1280
    ds_write_addtid_b32 v114 offset:1536
    ds_write_addtid_b32 v115 offset:1792
    v_mfma_f32_4x4x4_16b_bf16 v[80:83], v[8:9], v[106:107], 0
    v_mfma_f32_4x4x4_16b_bf16 v[76:79], v[8:9], v[104:105], 0
    v_bitop3_b32 v15, v6, v15, v46 bitop3:0xca
    v_bitop3_b32 v14, v6, v14, v47 bitop3:0xca
    s_nop 1
    v_pk_mul_f32 v[80:81], v[80:81], v[14:15] op_sel:[0,1] op_sel_hi:[1,1]
    v_pk_mul_f32 v[82:83], v[82:83], v[14:15] op_sel:[0,1] op_sel_hi:[1,1]
    v_pk_mul_f32 v[76:77], v[76:77], v[14:15] op_sel:[0,0] op_sel_hi:[1,0]
    v_pk_mul_f32 v[78:79], v[78:79], v[14:15] op_sel:[0,0] op_sel_hi:[1,0]
    s_add_u32 s42, s42, 1
    s_waitcnt lgkmcnt(0)
    s_barrier
    s_bitcmp1_b32 s36, s42
    s_cbranch_scc1 L2_slow
L2_ret3:
    s_setprio 3
    v_and_b32 v47, 0x0fffffff, v44
    v_mov_b32 v39, v44
    buffer_load_dwordx2 v[34:35], v47, s[8:11], 0 offen
    buffer_load_dwordx3 v[36:38], v47, s[8:11], 0 offen offset:8
    v_cmpx_ne_u64 vcc, v[74:75], v[70:71]
    s_and_b64 s[82:83], vcc, s[80:81]
    s_cbranch_scc1 L2_c64
L2_d64:
    v_mov_b64 v[84:85], v[70:71]
    v_mov_b32 v7, v93
    v_mov_b64 v[86:87], v[74:75]
    s_mov_b64 exec, -1
    s_or_b64 s[80:81], s[80:81], vcc
    v_cmpx_ne_u64 vcc, v[72:73], v[68:69]
    s_and_b64 s[82:83], vcc, s[80:81]
    s_cbranch_scc1 L2_c65
L2_d65:
    v_mov_b64 v[84:85], v[68:69]
    v_mov_b32 v7, v92
    v_mov_b64 v[86:87], v[72:73]
    s_mov_b64 exec, -1
    s_or_b64 s[80:81], s[80:81], vcc
    ds_read_b64 v[70:71], v95 offset:65408
    ds_read_b64 v[68:69], v94 offset:65408
    v_and_b32 v46, 0x20000000, v21
    v_lshrrev_b32 v47, 14, v17
    v_bitop3_b32 v47, v47, v5, v46 bitop3:0xea
    ds_read_b64 v[102:103], v47
    v_bitop3_b32 v93, v17, v5, v46 bitop3:0xea
    v_and_b32 v46, 0x10000000, v21
    v_lshrrev_b32 v47, 14, v16
    v_bitop3_b32 v47, v47, v5, v46 bitop3:0xea
    ds_read_b64 v[100:101], v47
    v_bitop3_b32 v92, v16, v5, v46 bitop3:0xea
    s_waitcnt lgkmcnt(2)
    v_mfma_f32_4x4x4_16b_bf16 v[80:83], v[10:11], v[70:71], v[80:83]
    v_mfma_f32_4x4x4_16b_bf16 v[76:79], v[10:11], v[68:69], v[76:79]
    v_perm_b32 v15, v17, v20, s45
    v_bitop3_b32 v46, v17, 0.5, -0.5 bitop3:0xa8
    v_perm_b32 v14, v16, v20, s44
    v_bitop3_b32 v47, v16, 0.5, -0.5 bitop3:0xa8
    v_cvt_pk_bf16_f32 v80, v80, v81
    v_cvt_pk_bf16_f32 v81, v82, v83
    ds_wrxchg_rtn_b64 v[74:75], v95, v[80:81] offset:65408
    v_cvt_pk_bf16_f32 v76, v76, v77
    v_cvt_pk_bf16_f32 v77, v78, v79
    ds_wrxchg_rtn_b64 v[72:73], v94, v[76:77] offset:65408
    s_waitcnt lgkmcnt(2)
    v_mfma_f32_4x4x4_16b_bf16 v[80:83], v[8:9], v[102:103], 0
    v_mfma_f32_4x4x4_16b_bf16 v[76:79], v[8:9], v[100:101], 0
    v_bitop3_b32 v15, v6, v15, v46 bitop3:0xca
    v_bitop3_b32 v14, v6, v14, v47 bitop3:0xca
    v_cmp_lt_u32 s[84:85], v5, v92
    s_nop 0
    v_pk_mul_f32 v[80:81], v[80:81], v[14:15] op_sel:[0,1] op_sel_hi:[1,1]
    v_pk_mul_f32 v[82:83], v[82:83], v[14:15] op_sel:[0,1] op_sel_hi:[1,1]
    v_pk_mul_f32 v[76:77], v[76:77], v[14:15] op_sel:[0,0] op_sel_hi:[1,0]
    v_pk_mul_f32 v[78:79], v[78:79], v[14:15] op_sel:[0,0] op_sel_hi:[1,0]
    buffer_load_dwordx4 v[108:111], v3, s[16:19], s40 offen offset:0
    s_waitcnt lgkmcnt(0)
    v_cmpx_ne_u64 vcc, v[74:75], v[70:71]
    s_and_b64 s[82:83], vcc, s[80:81]
    s_cbranch_scc1 L2_c66
L2_d66:
    v_mov_b64 v[84:85], v[70:71]
    v_mov_b32 v7, v95
    v_mov_b64 v[86:87], v[74:75]
    s_mov_b64 exec, -1
    s_or_b64 s[80:81], s[80:81], vcc
    v_cmpx_ne_u64 vcc, v[72:73], v[68:69]
    s_and_b64 s[82:83], vcc, s[80:81]
    s_cbranch_scc1 L2_c67
L2_d67:
    v_mov_b64 v[84:85], v[68:69]
    v_mov_b32 v7, v94
    v_mov_b64 v[86:87], v[72:73]
    s_mov_b64 exec, -1
    s_or_b64 s[80:81], s[80:81], vcc
    ds_read_b64 v[70:71], v93 offset:65408
    s_and_b64 exec, s[84:85], s[80:81]
    v_mfma_f32_4x4x4_16b_bf16 v[76:79], v[12:13], v[84:85], 0
    v_mov_b32 v92, v7
    s_andn2_b64 s[80:81], s[80:81], s[84:85]
    v_mfma_f32_4x4x4_16b_bf16 v[76:79], v[10:11], v[86:87], v[76:79]
    s_mov_b64 exec, -1
    ds_read_b64 v[68:69], v92 offset:65408
    v_and_b32 v46, 0x80000000, v21
    v_lshrrev_b32 v47, 14, v19
    v_bitop3_b32 v47, v47, v5, v46 bitop3:0xea
    ds_read_b64 v[106:107], v47
    v_bitop3_b32 v95, v19, v5, v46 bitop3:0xea
    v_and_b32 v46, 0x40000000, v21
    v_lshrrev_b32 v47, 14, v18
    v_bitop3_b32 v47, v47, v5, v46 bitop3:0xea
    ds_read_b64 v[104:105], v47
    v_bitop3_b32 v94, v18, v5, v46 bitop3:0xea
    s_waitcnt lgkmcnt(2)
    v_mfma_f32_4x4x4_16b_bf16 v[80:83], v[10:11], v[70:71], v[80:83]
    v_mfma_f32_4x4x4_16b_bf16 v[76:79], v[10:11], v[68:69], v[76:79]
    v_perm_b32 v15, v19, v20, s47
    v_bitop3_b32 v46, v19, 0.5, -0.5 bitop3:0xa8
    v_perm_b32 v14, v18, v20, s46
    v_bitop3_b32 v47, v18, 0.5, -0.5 bitop3:0xa8
    v_cvt_pk_bf16_f32 v80, v80, v81
    v_cvt_pk_bf16_f32 v81, v82, v83
    ds_wrxchg_rtn_b64 v[74:75], v93, v[80:81] offset:65408
    v_cvt_pk_bf16_f32 v76, v76, v77
    v_cvt_pk_bf16_f32 v77, v78, v79
    ds_wrxchg_rtn_b64 v[72:73], v92, v[76:77] offset:65408
    s_setprio 2
    s_waitcnt lgkmcnt(2)
    v_mfma_f32_4x4x4_16b_bf16 v[80:83], v[8:9], v[106:107], 0
    v_mfma_f32_4x4x4_16b_bf16 v[76:79], v[8:9], v[104:105], 0
    v_bitop3_b32 v15, v6, v15, v46 bitop3:0xca
    v_bitop3_b32 v14, v6, v14, v47 bitop3:0xca
    s_nop 1
    v_pk_mul_f32 v[80:81], v[80:81], v[14:15] op_sel:[0,1] op_sel_hi:[1,1]
    v_pk_mul_f32 v[82:83], v[82:83], v[14:15] op_sel:[0,1] op_sel_hi:[1,1]
    v_pk_mul_f32 v[76:77], v[76:77], v[14:15] op_sel:[0,0] op_sel_hi:[1,0]
    v_pk_mul_f32 v[78:79], v[78:79], v[14:15] op_sel:[0,0] op_sel_hi:[1,0]
    v_and_b32 v47, 0x0fffffff, v40
    v_mov_b32 v21, v40
    buffer_load_dwordx2 v[16:17], v47, s[8:11], 0 offen
    buffer_load_dwordx3 v[18:20], v47, s[8:11], 0 offen offset:8
    s_waitcnt lgkmcnt(0)
    v_cmpx_ne_u64 vcc, v[74:75], v[70:71]
    s_and_b64 s[82:83], vcc, s[80:81]
    s_cbranch_scc1 L2_c68
L2_d68:
    v_mov_b64 v[84:85], v[70:71]
    v_mov_b32 v7, v93
    v_mov_b64 v[86:87], v[74:75]
    s_mov_b64 exec, -1
    s_or_b64 s[80:81], s[80:81], vcc
    v_cmpx_ne_u64 vcc, v[72:73], v[68:69]
    s_and_b64 s[82:83], vcc, s[80:81]
    s_cbranch_scc1 L2_c69
L2_d69:
    v_mov_b64 v[84:85], v[68:69]
    v_mov_b32 v7, v92
    v_mov_b64 v[86:87], v[72:73]
    s_mov_b64 exec, -1
    s_or_b64 s[80:81], s[80:81], vcc
    ds_read_b64 v[70:71], v95 offset:65408
    ds_read_b64 v[68:69], v94 offset:65408
    s_waitcnt vmcnt(10)
    v_and_b32 v46, 0x20000000, v27
    v_lshrrev_b32 v47, 14, v23
    v_bitop3_b32 v47, v47, v5, v46 bitop3:0xea
    ds_read_b64 v[102:103], v47
    v_bitop3_b32 v93, v23, v5, v46 bitop3:0xea
    v_and_b32 v46, 0x10000000, v27
    v_lshrrev_b32 v47, 14, v22
    v_bitop3_b32 v47, v47, v5, v46 bitop3:0xea
    ds_read_b64 v[100:101], v47
    v_bitop3_b32 v92, v22, v5, v46 bitop3:0xea
    s_waitcnt lgkmcnt(2)
    v_mfma_f32_4x4x4_16b_bf16 v[80:83], v[10:11], v[70:71], v[80:83]
    v_mfma_f32_4x4x4_16b_bf16 v[76:79], v[10:11], v[68:69], v[76:79]
    v_perm_b32 v15, v23, v26, s45
    v_bitop3_b32 v46, v23, 0.5, -0.5 bitop3:0xa8
    v_perm_b32 v14, v22, v26, s44
    v_bitop3_b32 v47, v22, 0.5, -0.5 bitop3:0xa8
    v_cvt_pk_bf16_f32 v80, v80, v81
    v_cvt_pk_bf16_f32 v81, v82, v83
    ds_wrxchg_rtn_b64 v[74:75], v95, v[80:81] offset:65408
    v_cvt_pk_bf16_f32 v76, v76, v77
    v_cvt_pk_bf16_f32 v77, v78, v79
    ds_wrxchg_rtn_b64 v[72:73], v94, v[76:77] offset:65408
    s_waitcnt lgkmcnt(2)
    v_mfma_f32_4x4x4_16b_bf16 v[80:83], v[8:9], v[102:103], 0
    v_mfma_f32_4x4x4_16b_bf16 v[76:79], v[8:9], v[100:101], 0
    v_bitop3_b32 v15, v6, v15, v46 bitop3:0xca
    v_bitop3_b32 v14, v6, v14, v47 bitop3:0xca
    v_cmp_lt_u32 s[84:85], v5, v92
    s_nop 0
    v_pk_mul_f32 v[80:81], v[80:81], v[14:15] op_sel:[0,1] op_sel_hi:[1,1]
    v_pk_mul_f32 v[82:83], v[82:83], v[14:15] op_sel:[0,1] op_sel_hi:[1,1]
    v_pk_mul_f32 v[76:77], v[76:77], v[14:15] op_sel:[0,0] op_sel_hi:[1,0]
    v_pk_mul_f32 v[78:79], v[78:79], v[14:15] op_sel:[0,0] op_sel_hi:[1,0]
    v_sub_u16 v88, v58, v50
    v_and_b32 v89, 3, v50
    v_add3_u32 v99, v88, v89, 3
    v_and_b32 v99, -4, v99
    v_max_u32 v99, 4, v99
    v_and_b32 v97, 0xfffc, v50
    v_bfm_b32 v96, v88, v89
    v_add_u32_dpp v91, v99, v99 row_shr:1 row_mask:0xf bank_mask:0xf bound_ctrl:1
    v_mad_u32_u24 v97, v97, 5, v2
    v_cmp_lt_u32 vcc, 16, v99
    v_add_u32_dpp v91, v91, v91 row_shr:2 row_mask:0xf bank_mask:0xf bound_ctrl:1
    v_sub_u32 v98, s38, v99
    v_lshrrev_b64 v[50:51], 16, v[50:51]
    v_add_u32_dpp v91, v91, v91 row_shr:4 row_mask:0xf bank_mask:0xf bound_ctrl:1
    v_lshrrev_b64 v[58:59], 16, v[58:59]
    s_mov_b32 s101, 0
    v_add_u32_dpp v91, v91, v91 row_shr:8 row_mask:0xf bank_mask:0xf bound_ctrl:1
    s_nop 1
    v_add_u32_dpp v91, v91, v91 row_bcast:15 row_mask:0xa bank_mask:0xf
    s_nop 1
    v_add_u32_dpp v91, v91, v91 row_bcast:31 row_mask:0xc bank_mask:0xf
    v_add_u32 v98, v98, v91
    v_readlane_b32 s37, v91, 63
    s_cbranch_vccnz L2_xo70
L2_xp70:
    buffer_load_dwordx4 v[112:115], v3, s[16:19], s40 offen offset:1024
    s_waitcnt lgkmcnt(0)
    v_cmpx_ne_u64 vcc, v[74:75], v[70:71]
    s_and_b64 s[82:83], vcc, s[80:81]
    s_cbranch_scc1 L2_c71
L2_d71:
    v_mov_b64 v[84:85], v[70:71]
    v_mov_b32 v7, v95
    v_mov_b64 v[86:87], v[74:75]
    s_mov_b64 exec, -1
    s_or_b64 s[80:81], s[80:81], vcc
    v_cmpx_ne_u64 vcc, v[72:73], v[68:69]
    s_and_b64 s[82:83], vcc, s[80:81]
    s_cbranch_scc1 L2_c72
L2_d72:
    v_mov_b64 v[84:85], v[68:69]
    v_mov_b32 v7, v94
    v_mov_b64 v[86:87], v[72:73]
    s_mov_b64 exec, -1
    s_or_b64 s[80:81], s[80:81], vcc
    ds_read_b64 v[70:71], v93 offset:65408
    s_and_b64 exec, s[84:85], s[80:81]
    v_mfma_f32_4x4x4_16b_bf16 v[76:79], v[12:13], v[84:85], 0
    v_mov_b32 v92, v7
    s_andn2_b64 s[80:81], s[80:81], s[84:85]
    v_mfma_f32_4x4x4_16b_bf16 v[76:79], v[10:11], v[86:87], v[76:79]
    s_mov_b64 exec, -1
    ds_read_b64 v[68:69], v92 offset:65408
    v_and_b32 v46, 0x80000000, v27
    v_lshrrev_b32 v47, 14, v25
    v_bitop3_b32 v47, v47, v5, v46 bitop3:0xea
    ds_read_b64 v[106:107], v47
    v_bitop3_b32 v95, v25, v5, v46 bitop3:0xea
    v_and_b32 v46, 0x40000000, v27
    v_lshrrev_b32 v47, 14, v24
    v_bitop3_b32 v47, v47, v5, v46 bitop3:0xea
    ds_read_b64 v[104:105], v47
    v_bitop3_b32 v94, v24, v5, v46 bitop3:0xea
    s_waitcnt lgkmcnt(2)
    v_mfma_f32_4x4x4_16b_bf16 v[80:83], v[10:11], v[70:71], v[80:83]
    v_mfma_f32_4x4x4_16b_bf16 v[76:79], v[10:11], v[68:69], v[76:79]
    v_perm_b32 v15, v25, v26, s47
    v_bitop3_b32 v46, v25, 0.5, -0.5 bitop3:0xa8
    v_perm_b32 v14, v24, v26, s46
    v_bitop3_b32 v47, v24, 0.5, -0.5 bitop3:0xa8
    v_cvt_pk_bf16_f32 v80, v80, v81
    v_cvt_pk_bf16_f32 v81, v82, v83
    ds_wrxchg_rtn_b64 v[74:75], v93, v[80:81] offset:65408
    v_cvt_pk_bf16_f32 v76, v76, v77
    v_cvt_pk_bf16_f32 v77, v78, v79
    ds_wrxchg_rtn_b64 v[72:73], v92, v[76:77] offset:65408
    s_setprio 1
    s_waitcnt lgkmcnt(2)
    v_mfma_f32_4x4x4_16b_bf16 v[80:83], v[8:9], v[106:107], 0
    v_mfma_f32_4x4x4_16b_bf16 v[76:79], v[8:9], v[104:105], 0
    v_bitop3_b32 v15, v6, v15, v46 bitop3:0xca
    v_bitop3_b32 v14, v6, v14, v47 bitop3:0xca
    s_nop 1
    v_pk_mul_f32 v[80:81], v[80:81], v[14:15] op_sel:[0,1] op_sel_hi:[1,1]
    v_pk_mul_f32 v[82:83], v[82:83], v[14:15] op_sel:[0,1] op_sel_hi:[1,1]
    v_pk_mul_f32 v[76:77], v[76:77], v[14:15] op_sel:[0,0] op_sel_hi:[1,0]
    v_pk_mul_f32 v[78:79], v[78:79], v[14:15] op_sel:[0,0] op_sel_hi:[1,0]
    v_and_b32 v47, 0x0fffffff, v41
    v_mov_b32 v27, v41
    buffer_load_dwordx2 v[22:23], v47, s[8:11], 0 offen
    buffer_load_dwordx3 v[24:26], v47, s[8:11], 0 offen offset:8
    s_waitcnt lgkmcnt(0)
    v_cmpx_ne_u64 vcc, v[74:75], v[70:71]
    s_and_b64 s[82:83], vcc, s[80:81]
    s_cbranch_scc1 L2_c73
L2_d73:
    v_mov_b64 v[84:85], v[70:71]
    v_mov_b32 v7, v93
    v_mov_b64 v[86:87], v[74:75]
    s_mov_b64 exec, -1
    s_or_b64 s[80:81], s[80:81], vcc
    v_cmpx_ne_u64 vcc, v[72:73], v[68:69]
    s_and_b64 s[82:83], vcc, s[80:81]
    s_cbranch_scc1 L2_c74
L2_d74:
    v_mov_b64 v[84:85], v[68:69]
    v_mov_b32 v7, v92
    v_mov_b64 v[86:87], v[72:73]
    s_mov_b64 exec, -1
    s_or_b64 s[80:81], s[80:81], vcc
    ds_read_b64 v[70:71], v95 offset:65408
    ds_read_b64 v[68:69], v94 offset:65408
    s_waitcnt vmcnt(11)
    v_and_b32 v46, 0x20000000, v33
    v_lshrrev_b32 v47, 14, v29
    v_bitop3_b32 v47, v47, v5, v46 bitop3:0xea
    ds_read_b64 v[102:103], v47
    v_bitop3_b32 v93, v29, v5, v46 bitop3:0xea
    v_and_b32 v46, 0x10000000, v33
    v_lshrrev_b32 v47, 14, v28
    v_bitop3_b32 v47, v47, v5, v46 bitop3:0xea
    ds_read_b64 v[100:101], v47
    v_bitop3_b32 v92, v28, v5, v46 bitop3:0xea
    s_waitcnt lgkmcnt(2)
    v_mfma_f32_4x4x4_16b_bf16 v[80:83], v[10:11], v[70:71], v[80:83]
    v_mfma_f32_4x4x4_16b_bf16 v[76:79], v[10:11], v[68:69], v[76:79]
    v_perm_b32 v15, v29, v32, s45
    v_bitop3_b32 v46, v29, 0.5, -0.5 bitop3:0xa8
    v_perm_b32 v14, v28, v32, s44
    v_bitop3_b32 v47, v28, 0.5, -0.5 bitop3:0xa8
    v_cvt_pk_bf16_f32 v80, v80, v81
    v_cvt_pk_bf16_f32 v81, v82, v83
    ds_wrxchg_rtn_b64 v[74:75], v95, v[80:81] offset:65408
    v_cvt_pk_bf16_f32 v76, v76, v77
    v_cvt_pk_bf16_f32 v77, v78, v79
    ds_wrxchg_rtn_b64 v[72:73], v94, v[76:77] offset:65408
    s_waitcnt lgkmcnt(2)
    v_mfma_f32_4x4x4_16b_bf16 v[80:83], v[8:9], v[102:103], 0
    v_mfma_f32_4x4x4_16b_bf16 v[76:79], v[8:9], v[100:101], 0
    v_bitop3_b32 v15, v6, v15, v46 bitop3:0xca
    v_bitop3_b32 v14, v6, v14, v47 bitop3:0xca
    v_cmp_lt_u32 s[84:85], v5, v92
    s_nop 0
    v_pk_mul_f32 v[80:81], v[80:81], v[14:15] op_sel:[0,1] op_sel_hi:[1,1]
    v_pk_mul_f32 v[82:83], v[82:83], v[14:15] op_sel:[0,1] op_sel_hi:[1,1]
    v_pk_mul_f32 v[76:77], v[76:77], v[14:15] op_sel:[0,0] op_sel_hi:[1,0]
    v_pk_mul_f32 v[78:79], v[78:79], v[14:15] op_sel:[0,0] op_sel_hi:[1,0]
    s_waitcnt lgkmcnt(0)
    v_cmpx_ne_u64 vcc, v[74:75], v[70:71]
    s_and_b64 s[82:83], vcc, s[80:81]
    s_cbranch_scc1 L2_c75
L2_d75:
    v_mov_b64 v[84:85], v[70:71]
    v_mov_b32 v7, v95
    v_mov_b64 v[86:87], v[74:75]
    s_mov_b64 exec, -1
    s_or_b64 s[80:81], s[80:81], vcc
    v_cmpx_ne_u64 vcc, v[72:73], v[68:69]
    s_and_b64 s[82:83], vcc, s[80:81]
    s_cbranch_scc1 L2_c76
L2_d76:
    v_mov_b64 v[84:85], v[68:69]
    v_mov_b32 v7, v94
    v_mov_b64 v[86:87], v[72:73]
    s_mov_b64 exec, -1
    s_or_b64 s[80:81], s[80:81], vcc
    ds_read_b64 v[70:71], v93 offset:65408
    s_and_b64 exec, s[84:85], s[80:81]
    v_mfma_f32_4x4x4_16b_bf16 v[76:79], v[12:13], v[84:85], 0
    v_mov_b32 v92, v7
    s_andn2_b64 s[80:81], s[80:81], s[84:85]
    v_mfma_f32_4x4x4_16b_bf16 v[76:79], v[10:11], v[86:87], v[76:79]
    s_mov_b64 exec, -1
    ds_read_b64 v[68:69], v92 offset:65408
    v_and_b32 v46, 0x80000000, v33
    v_lshrrev_b32 v47, 14, v31
    v_bitop3_b32 v47, v47, v5, v46 bitop3:0xea
    ds_read_b64 v[106:107], v47
    v_bitop3_b32 v95, v31, v5, v46 bitop3:0xea
    v_and_b32 v46, 0x40000000, v33
    v_lshrrev_b32 v47, 14, v30
    v_bitop3_b32 v47, v47, v5, v46 bitop3:0xea
    ds_read_b64 v[104:105], v47
    v_bitop3_b32 v94, v30, v5, v46 bitop3:0xea
    s_waitcnt lgkmcnt(2)
    v_mfma_f32_4x4x4_16b_bf16 v[80:83], v[10:11], v[70:71], v[80:83]
    v_mfma_f32_4x4x4_16b_bf16 v[76:79], v[10:11], v[68:69], v[76:79]
    v_perm_b32 v15, v31, v32, s47
    v_bitop3_b32 v46, v31, 0.5, -0.5 bitop3:0xa8
    v_perm_b32 v14, v30, v32, s46
    v_bitop3_b32 v47, v30, 0.5, -0.5 bitop3:0xa8
    v_cvt_pk_bf16_f32 v80, v80, v81
    v_cvt_pk_bf16_f32 v81, v82, v83
    ds_wrxchg_rtn_b64 v[74:75], v93, v[80:81] offset:65408
    v_cvt_pk_bf16_f32 v76, v76, v77
    v_cvt_pk_bf16_f32 v77, v78, v79
    ds_wrxchg_rtn_b64 v[72:73], v92, v[76:77] offset:65408
    s_setprio 0
    s_waitcnt lgkmcnt(2)
    v_mfma_f32_4x4x4_16b_bf16 v[80:83], v[8:9], v[106:107], 0
    v_mfma_f32_4x4x4_16b_bf16 v[76:79], v[8:9], v[104:105], 0
    v_bitop3_b32 v15, v6, v15, v46 bitop3:0xca
    v_bitop3_b32 v14, v6, v14, v47 bitop3:0xca
    s_nop 1
    v_pk_mul_f32 v[80:81], v[80:81], v[14:15] op_sel:[0,1] op_sel_hi:[1,1]
    v_pk_mul_f32 v[82:83], v[82:83], v[14:15] op_sel:[0,1] op_sel_hi:[1,1]
    v_pk_mul_f32 v[76:77], v[76:77], v[14:15] op_sel:[0,0] op_sel_hi:[1,0]
    v_pk_mul_f32 v[78:79], v[78:79], v[14:15] op_sel:[0,0] op_sel_hi:[1,0]
    s_add_u32 s40, s40, 0x50000
    v_and_b32 v47, 0x0fffffff, v42
    v_mov_b32 v33, v42
    buffer_load_dwordx2 v[28:29], v47, s[8:11], 0 offen
    buffer_load_dwordx3 v[30:32], v47, s[8:11], 0 offen offset:8
    s_waitcnt lgkmcnt(0)
    v_cmpx_ne_u64 vcc, v[74:75], v[70:71]
    s_and_b64 s[82:83], vcc, s[80:81]
    s_cbranch_scc1 L2_c77
L2_d77:
    v_mov_b64 v[84:85], v[70:71]
    v_mov_b32 v7, v93
    v_mov_b64 v[86:87], v[74:75]
    s_mov_b64 exec, -1
    s_or_b64 s[80:81], s[80:81], vcc
    v_cmpx_ne_u64 vcc, v[72:73], v[68:69]
    s_and_b64 s[82:83], vcc, s[80:81]
    s_cbranch_scc1 L2_c78
L2_d78:
    v_mov_b64 v[84:85], v[68:69]
    v_mov_b32 v7, v92
    v_mov_b64 v[86:87], v[72:73]
    s_mov_b64 exec, -1
    s_or_b64 s[80:81], s[80:81], vcc
    ds_read_b64 v[70:71], v95 offset:65408
    ds_read_b64 v[68:69], v94 offset:65408
    s_waitcnt vmcnt(8)
    v_and_b32 v46, 0x20000000, v39
    v_lshrrev_b32 v47, 14, v35
    v_bitop3_b32 v47, v47, v5, v46 bitop3:0xea
    ds_read_b64 v[102:103], v47
    v_bitop3_b32 v93, v35, v5, v46 bitop3:0xea
    v_and_b32 v46, 0x10000000, v39
    v_lshrrev_b32 v47, 14, v34
    v_bitop3_b32 v47, v47, v5, v46 bitop3:0xea
    ds_read_b64 v[100:101], v47
    v_bitop3_b32 v92, v34, v5, v46 bitop3:0xea
    v_and_b32 v46, 0x80000000, v39
    v_lshrrev_b32 v47, 14, v37
    v_bitop3_b32 v47, v47, v5, v46 bitop3:0xea
    ds_read_b64 v[106:107], v47
    v_and_b32 v46, 0x40000000, v39
    v_lshrrev_b32 v47, 14, v36
    v_bitop3_b32 v47, v47, v5, v46 bitop3:0xea
    ds_read_b64 v[104:105], v47
    s_waitcnt lgkmcnt(4)
    v_mfma_f32_4x4x4_16b_bf16 v[80:83], v[10:11], v[70:71], v[80:83]
    v_mfma_f32_4x4x4_16b_bf16 v[76:79], v[10:11], v[68:69], v[76:79]
    v_perm_b32 v15, v35, v38, s45
    v_bitop3_b32 v46, v35, 0.5, -0.5 bitop3:0xa8
    v_perm_b32 v14, v34, v38, s44
    v_bitop3_b32 v47, v34, 0.5, -0.5 bitop3:0xa8
    v_cvt_pk_bf16_f32 v80, v80, v81
    v_cvt_pk_bf16_f32 v81, v82, v83
    ds_wrxchg_rtn_b64 v[74:75], v95, v[80:81] offset:65408
    v_cvt_pk_bf16_f32 v76, v76, v77
    v_cvt_pk_bf16_f32 v77, v78, v79
    ds_wrxchg_rtn_b64 v[72:73], v94, v[76:77] offset:65408
    s_waitcnt lgkmcnt(2)
    s_barrier
    s_setprio 3
    s_mov_b32 m0, s100
    s_nop 0
    ds_write_addtid_b32 v116 offset:32768
    ds_write_addtid_b32 v117 offset:33024
    ds_write_addtid_b32 v118 offset:33280
    ds_write_addtid_b32 v119 offset:33536
    buffer_load_dwordx4 v[116:119], v3, s[16:19], s40 offen offset:2048
    ds_write_addtid_b32 v120 offset:33792
    ds_write_addtid_b32 v121 offset:34048
    ds_write_addtid_b32 v122 offset:34304
    ds_write_addtid_b32 v123 offset:34560
    buffer_load_dwordx4 v[120:123], v3, s[16:19], s40 offen offset:3072
    v_mfma_f32_4x4x4_16b_bf16 v[80:83], v[8:9], v[102:103], 0
    v_mfma_f32_4x4x4_16b_bf16 v[76:79], v[8:9], v[100:101], 0
    v_bitop3_b32 v15, v6, v15, v46 bitop3:0xca
    v_bitop3_b32 v14, v6, v14, v47 bitop3:0xca
    v_cmp_lt_u32 s[84:85], v5, v92
    s_nop 0
    v_pk_mul_f32 v[80:81], v[80:81], v[14:15] op_sel:[0,1] op_sel_hi:[1,1]
    v_pk_mul_f32 v[82:83], v[82:83], v[14:15] op_sel:[0,1] op_sel_hi:[1,1]
    v_pk_mul_f32 v[76:77], v[76:77], v[14:15] op_sel:[0,0] op_sel_hi:[1,0]
    v_pk_mul_f32 v[78:79], v[78:79], v[14:15] op_sel:[0,0] op_sel_hi:[1,0]
    v_mov_b32 v44, v43
    s_cmp_gt_u32 s37, 1024
    s_cbranch_scc1 L2_xs79
    s_cmp_lg_u32 s101, 0
    s_cbranch_scc1 L2_xa79
L2_xb79:
    v_lshlrev_b32 v89, 16, v96
    v_add_u32 v90, 60, v97
    v_bitop3_b32 v90, v89, v45, v90 bitop3:0x6a
    ds_write_b32 v98, v90 offset:12
    v_lshlrev_b32 v89, 20, v96
    v_add_u32 v90, 40, v97
    v_bitop3_b32 v90, v89, v45, v90 bitop3:0x6a
    ds_write_b32 v98, v90 offset:8
    v_lshlrev_b32 v89, 24, v96
    v_add_u32 v90, 20, v97
    v_bitop3_b32 v90, v89, v45, v90 bitop3:0x6a
    ds_write_b32 v98, v90 offset:4
    v_lshlrev_b32 v89, 28, v96
    v_bitop3_b32 v90, v89, v45, v97 bitop3:0x6a
    ds_write_b32 v98, v90 offset:0
    v_mov_b32_dpp v91, v66 quad_perm:[0,0,0,0] row_mask:0xf bank_mask:0xf
    v_and_b32 v89, 3, v91
    v_and_b32 v97, 0xfffc, v91
    v_sub_u16_dpp v88, v66, v91 quad_perm:[2,2,2,2] row_mask:0xf bank_mask:0xf
    v_mad_u32_u24 v97, v97, 5, v4
    v_add_u32 v99, v88, v89
    v_bfm_b32 v96, v88, v89
    v_cmp_lt_u32 s[58:59], 16, v99
    v_lshlrev_b32 v89, v1, v96
    v_and_b32 v89, v45, v89
    v_cmp_ne_u32 vcc, 0, v89
    v_xor_b32 v90, v97, v89
    s_add_u32 s3, s37, s38
    v_mbcnt_lo_u32_b32 v98, vcc_lo, 0
    v_mbcnt_hi_u32_b32 v98, vcc_hi, v98
    s_bcnt1_i32_b64 s41, vcc
    v_lshl_add_u32 v98, v98, 2, s3
    s_mov_b64 exec, vcc
    ds_write_b32 v98, v90
    s_mov_b64 exec, -1
    s_lshl2_add_u32 s37, s41, s37
    s_cmp_lg_u64 s[58:59], 0
    s_cbranch_scc1 L2_xe79
L2_xr79:
    v_add_u32 v98, s37, v0
    v_mov_b32 v90, -1
    ds_write_b32 v98, v90
    ds_read2st64_b32 v[40:41], v0 offset0:0 offset1:1
    ds_read2st64_b32 v[42:43], v0 offset0:2 offset1:3
    s_sub_u32 s3, s37, 768
    s_cmp_gt_u32 s3, 256
    s_cbranch_scc1 L2_xf79
L2_xg79:
    s_setprio 2
    ds_write_addtid_b32 v124 offset:34816
    ds_write_addtid_b32 v125 offset:35072
    ds_write_addtid_b32 v126 offset:35328
    ds_write_addtid_b32 v127 offset:35584
    s_add_u32 s3, s40, 4096
    buffer_load_dwordx4 v[124:127], v3, s[16:19], s3 offen
    s_waitcnt lgkmcnt(14)
    v_cmpx_ne_u64 vcc, v[74:75], v[70:71]
    s_and_b64 s[82:83], vcc, s[80:81]
    s_cbranch_scc1 L2_c80
L2_d80:
    v_mov_b64 v[84:85], v[70:71]
    v_mov_b32 v7, v95
    v_mov_b64 v[86:87], v[74:75]
    s_mov_b64 exec, -1
    s_or_b64 s[80:81], s[80:81], vcc
    v_cmpx_ne_u64 vcc, v[72:73], v[68:69]
    s_and_b64 s[82:83], vcc, s[80:81]
    s_cbranch_scc1 L2_c81
L2_d81:
    v_mov_b64 v[84:85], v[68:69]
    v_mov_b32 v7, v94
    v_mov_b64 v[86:87], v[72:73]
    s_mov_b64 exec, -1
    s_or_b64 s[80:81], s[80:81], vcc
    ds_read_b64 v[70:71], v93 offset:65408
    s_and_b64 exec, s[84:85], s[80:81]
    v_mfma_f32_4x4x4_16b_bf16 v[76:79], v[12:13], v[84:85], 0
    v_mov_b32 v92, v7
    s_andn2_b64 s[80:81], s[80:81], s[84:85]
    v_mfma_f32_4x4x4_16b_bf16 v[76:79], v[10:11], v[86:87], v[76:79]
    s_mov_b64 exec, -1
    ds_read_b64 v[68:69], v92 offset:65408
    s_setprio 1
    s_waitcnt vmcnt(10)
    s_mov_b32 m0, s38
    s_nop 0
    ds_write_addtid_b32 v108 offset:0
    ds_write_addtid_b32 v109 offset:256
    ds_write_addtid_b32 v110 offset:512
    ds_write_addtid_b32 v111 offset:768
    s_waitcnt lgkmcnt(4)
    v_mfma_f32_4x4x4_16b_bf16 v[80:83], v[10:11], v[70:71], v[80:83]
    v_mfma_f32_4x4x4_16b_bf16 v[76:79], v[10:11], v[68:69], v[76:79]
    v_and_b32 v46, 0x40000000, v39
    v_bitop3_b32 v94, v36, v5, v46 bitop3:0xea
    v_and_b32 v46, 0x80000000, v39
    v_bitop3_b32 v95, v37, v5, v46 bitop3:0xea
    v_perm_b32 v15, v37, v38, s47
    v_bitop3_b32 v46, v37, 0.5, -0.5 bitop3:0xa8
    v_perm_b32 v14, v36, v38, s46
    v_bitop3_b32 v47, v36, 0.5, -0.5 bitop3:0xa8
    v_cvt_pk_bf16_f32 v80, v80, v81
    v_cvt_pk_bf16_f32 v81, v82, v83
    ds_wrxchg_rtn_b64 v[74:75], v93, v[80:81] offset:65408
    v_cvt_pk_bf16_f32 v76, v76, v77
    v_cvt_pk_bf16_f32 v77, v78, v79
    ds_wrxchg_rtn_b64 v[72:73], v92, v[76:77] offset:65408
    s_setprio 0
    s_waitcnt vmcnt(7)
    ds_write_addtid_b32 v112 offset:1024
    ds_write_addtid_b32 v113 offset:1280
    ds_write_addtid_b32 v114 offset:1536
    ds_write_addtid_b32 v115 offset:1792
    v_mfma_f32_4x4x4_16b_bf16 v[80:83], v[8:9], v[106:107], 0
    v_mfma_f32_4x4x4_16b_bf16 v[76:79], v[8:9], v[104:105], 0
    v_bitop3_b32 v15, v6, v15, v46 bitop3:0xca
    v_bitop3_b32 v14, v6, v14, v47 bitop3:0xca
    s_nop 1
    v_pk_mul_f32 v[80:81], v[80:81], v[14:15] op_sel:[0,1] op_sel_hi:[1,1]
    v_pk_mul_f32 v[82:83], v[82:83], v[14:15] op_sel:[0,1] op_sel_hi:[1,1]
    v_pk_mul_f32 v[76:77], v[76:77], v[14:15] op_sel:[0,0] op_sel_hi:[1,0]
    v_pk_mul_f32 v[78:79], v[78:79], v[14:15] op_sel:[0,0] op_sel_hi:[1,0]
    s_add_u32 s42, s42, 1
    s_waitcnt lgkmcnt(0)
    s_barrier
    s_bitcmp1_b32 s36, s42
    s_cbranch_scc1 L2_slow
L2_ret4:
    s_setprio 3
    v_and_b32 v47, 0x0fffffff, v44
    v_mov_b32 v39, v44
    buffer_load_dwordx2 v[34:35], v47, s[8:11], 0 offen
    buffer_load_dwordx3 v[36:38], v47, s[8:11], 0 offen offset:8
    v_cmpx_ne_u64 vcc, v[74:75], v[70:71]
    s_and_b64 s[82:83], vcc, s[80:81]
    s_cbranch_scc1 L2_c82
L2_d82:
    v_mov_b64 v[84:85], v[70:71]
    v_mov_b32 v7, v93
    v_mov_b64 v[86:87], v[74:75]
    s_mov_b64 exec, -1
    s_or_b64 s[80:81], s[80:81], vcc
    v_cmpx_ne_u64 vcc, v[72:73], v[68:69]
    s_and_b64 s[82:83], vcc, s[80:81]
    s_cbranch_scc1 L2_c83
L2_d83:
    v_mov_b64 v[84:85], v[68:69]
    v_mov_b32 v7, v92
    v_mov_b64 v[86:87], v[72:73]
    s_mov_b64 exec, -1
    s_or_b64 s[80:81], s[80:81], vcc
    ds_read_b64 v[70:71], v95 offset:65408
    ds_read_b64 v[68:69], v94 offset:65408
    v_and_b32 v46, 0x20000000, v21
    v_lshrrev_b32 v47, 14, v17
    v_bitop3_b32 v47, v47, v5, v46 bitop3:0xea
    ds_read_b64 v[102:103], v47
    v_bitop3_b32 v93, v17, v5, v46 bitop3:0xea
    v_and_b32 v46, 0x10000000, v21
    v_lshrrev_b32 v47, 14, v16
    v_bitop3_b32 v47, v47, v5, v46 bitop3:0xea
    ds_read_b64 v[100:101], v47
    v_bitop3_b32 v92, v16, v5, v46 bitop3:0xea
    s_waitcnt lgkmcnt(2)
    v_mfma_f32_4x4x4_16b_bf16 v[80:83], v[10:11], v[70:71], v[80:83]
    v_mfma_f32_4x4x4_16b_bf16 v[76:79], v[10:11], v[68:69], v[76:79]
    v_perm_b32 v15, v17, v20, s45
    v_bitop3_b32 v46, v17, 0.5, -0.5 bitop3:0xa8
    v_perm_b32 v14, v16, v20, s44
    v_bitop3_b32 v47, v16, 0.5, -0.5 bitop3:0xa8
    v_cvt_pk_bf16_f32 v80, v80, v81
    v_cvt_pk_bf16_f32 v81, v82, v83
    ds_wrxchg_rtn_b64 v[74:75], v95, v[80:81] offset:65408
    v_cvt_pk_bf16_f32 v76, v76, v77
    v_cvt_pk_bf16_f32 v77, v78, v79
    ds_wrxchg_rtn_b64 v[72:73], v94, v[76:77] offset:65408
    s_waitcnt lgkmcnt(2)
    v_mfma_f32_4x4x4_16b_bf16 v[80:83], v[8:9], v[102:103], 0
    v_mfma_f32_4x4x4_16b_bf16 v[76:79], v[8:9], v[100:101], 0
    v_bitop3_b32 v15, v6, v15, v46 bitop3:0xca
    v_bitop3_b32 v14, v6, v14, v47 bitop3:0xca
    v_cmp_lt_u32 s[84:85], v5, v92
    s_nop 0
    v_pk_mul_f32 v[80:81], v[80:81], v[14:15] op_sel:[0,1] op_sel_hi:[1,1]
    v_pk_mul_f32 v[82:83], v[82:83], v[14:15] op_sel:[0,1] op_sel_hi:[1,1]
    v_pk_mul_f32 v[76:77], v[76:77], v[14:15] op_sel:[0,0] op_sel_hi:[1,0]
    v_pk_mul_f32 v[78:79], v[78:79], v[14:15] op_sel:[0,0] op_sel_hi:[1,0]
    buffer_load_dwordx4 v[108:111], v3, s[16:19], s40 offen offset:0
    s_waitcnt lgkmcnt(0)
    v_cmpx_ne_u64 vcc, v[74:75], v[70:71]
    s_and_b64 s[82:83], vcc, s[80:81]
    s_cbranch_scc1 L2_c84
L2_d84:
    v_mov_b64 v[84:85], v[70:71]
    v_mov_b32 v7, v95
    v_mov_b64 v[86:87], v[74:75]
    s_mov_b64 exec, -1
    s_or_b64 s[80:81], s[80:81], vcc
    v_cmpx_ne_u64 vcc, v[72:73], v[68:69]
    s_and_b64 s[82:83], vcc, s[80:81]
    s_cbranch_scc1 L2_c85
L2_d85:
    v_mov_b64 v[84:85], v[68:69]
    v_mov_b32 v7, v94
    v_mov_b64 v[86:87], v[72:73]
    s_mov_b64 exec, -1
    s_or_b64 s[80:81], s[80:81], vcc
    ds_read_b64 v[70:71], v93 offset:65408
    s_and_b64 exec, s[84:85], s[80:81]
    v_mfma_f32_4x4x4_16b_bf16 v[76:79], v[12:13], v[84:85], 0
    v_mov_b32 v92, v7
    s_andn2_b64 s[80:81], s[80:81], s[84:85]
    v_mfma_f32_4x4x4_16b_bf16 v[76:79], v[10:11], v[86:87], v[76:79]
    s_mov_b64 exec, -1
    ds_read_b64 v[68:69], v92 offset:65408
    v_and_b32 v46, 0x80000000, v21
    v_lshrrev_b32 v47, 14, v19
    v_bitop3_b32 v47, v47, v5, v46 bitop3:0xea
    ds_read_b64 v[106:107], v47
    v_bitop3_b32 v95, v19, v5, v46 bitop3:0xea
    v_and_b32 v46, 0x40000000, v21
    v_lshrrev_b32 v47, 14, v18
    v_bitop3_b32 v47, v47, v5, v46 bitop3:0xea
    ds_read_b64 v[104:105], v47
    v_bitop3_b32 v94, v18, v5, v46 bitop3:0xea
    s_waitcnt lgkmcnt(2)
    v_mfma_f32_4x4x4_16b_bf16 v[80:83], v[10:11], v[70:71], v[80:83]
    v_mfma_f32_4x4x4_16b_bf16 v[76:79], v[10:11], v[68:69], v[76:79]
    v_perm_b32 v15, v19, v20, s47
    v_bitop3_b32 v46, v19, 0.5, -0.5 bitop3:0xa8
    v_perm_b32 v14, v18, v20, s46
    v_bitop3_b32 v47, v18, 0.5, -0.5 bitop3:0xa8
    v_cvt_pk_bf16_f32 v80, v80, v81
    v_cvt_pk_bf16_f32 v81, v82, v83
    ds_wrxchg_rtn_b64 v[74:75], v93, v[80:81] offset:65408
    v_cvt_pk_bf16_f32 v76, v76, v77
    v_cvt_pk_bf16_f32 v77, v78, v79
    ds_wrxchg_rtn_b64 v[72:73], v92, v[76:77] offset:65408
    s_setprio 2
    s_waitcnt lgkmcnt(2)
    v_mfma_f32_4x4x4_16b_bf16 v[80:83], v[8:9], v[106:107], 0
    v_mfma_f32_4x4x4_16b_bf16 v[76:79], v[8:9], v[104:105], 0
    v_bitop3_b32 v15, v6, v15, v46 bitop3:0xca
    v_bitop3_b32 v14, v6, v14, v47 bitop3:0xca
    s_nop 1
    v_pk_mul_f32 v[80:81], v[80:81], v[14:15] op_sel:[0,1] op_sel_hi:[1,1]
    v_pk_mul_f32 v[82:83], v[82:83], v[14:15] op_sel:[0,1] op_sel_hi:[1,1]
    v_pk_mul_f32 v[76:77], v[76:77], v[14:15] op_sel:[0,0] op_sel_hi:[1,0]
    v_pk_mul_f32 v[78:79], v[78:79], v[14:15] op_sel:[0,0] op_sel_hi:[1,0]
    v_and_b32 v47, 0x0fffffff, v40
    v_mov_b32 v21, v40
    buffer_load_dwordx2 v[16:17], v47, s[8:11], 0 offen
    buffer_load_dwordx3 v[18:20], v47, s[8:11], 0 offen offset:8
    s_waitcnt lgkmcnt(0)
    v_cmpx_ne_u64 vcc, v[74:75], v[70:71]
    s_and_b64 s[82:83], vcc, s[80:81]
    s_cbranch_scc1 L2_c86
L2_d86:
    v_mov_b64 v[84:85], v[70:71]
    v_mov_b32 v7, v93
    v_mov_b64 v[86:87], v[74:75]
    s_mov_b64 exec, -1
    s_or_b64 s[80:81], s[80:81], vcc
    v_cmpx_ne_u64 vcc, v[72:73], v[68:69]
    s_and_b64 s[82:83], vcc, s[80:81]
    s_cbranch_scc1 L2_c87
L2_d87:
    v_mov_b64 v[84:85], v[68:69]
    v_mov_b32 v7, v92
    v_mov_b64 v[86:87], v[72:73]
    s_mov_b64 exec, -1
    s_or_b64 s[80:81], s[80:81], vcc
    ds_read_b64 v[70:71], v95 offset:65408
    ds_read_b64 v[68:69], v94 offset:65408
    s_waitcnt vmcnt(10)
    v_and_b32 v46, 0x20000000, v27
    v_lshrrev_b32 v47, 14, v23
    v_bitop3_b32 v47, v47, v5, v46 bitop3:0xea
    ds_read_b64 v[102:103], v47
    v_bitop3_b32 v93, v23, v5, v46 bitop3:0xea
    v_and_b32 v46, 0x10000000, v27
    v_lshrrev_b32 v47, 14, v22
    v_bitop3_b32 v47, v47, v5, v46 bitop3:0xea
    ds_read_b64 v[100:101], v47
    v_bitop3_b32 v92, v22, v5, v46 bitop3:0xea
    s_waitcnt lgkmcnt(2)
    v_mfma_f32_4x4x4_16b_bf16 v[80:83], v[10:11], v[70:71], v[80:83]
    v_mfma_f32_4x4x4_16b_bf16 v[76:79], v[10:11], v[68:69], v[76:79]
    v_perm_b32 v15, v23, v26, s45
    v_bitop3_b32 v46, v23, 0.5, -0.5 bitop3:0xa8
    v_perm_b32 v14, v22, v26, s44
    v_bitop3_b32 v47, v22, 0.5, -0.5 bitop3:0xa8
    v_cvt_pk_bf16_f32 v80, v80, v81
    v_cvt_pk_bf16_f32 v81, v82, v83
    ds_wrxchg_rtn_b64 v[74:75], v95, v[80:81] offset:65408
    v_cvt_pk_bf16_f32 v76, v76, v77
    v_cvt_pk_bf16_f32 v77, v78, v79
    ds_wrxchg_rtn_b64 v[72:73], v94, v[76:77] offset:65408
    s_waitcnt lgkmcnt(2)
    v_mfma_f32_4x4x4_16b_bf16 v[80:83], v[8:9], v[102:103], 0
    v_mfma_f32_4x4x4_16b_bf16 v[76:79], v[8:9], v[100:101], 0
    v_bitop3_b32 v15, v6, v15, v46 bitop3:0xca
    v_bitop3_b32 v14, v6, v14, v47 bitop3:0xca
    v_cmp_lt_u32 s[84:85], v5, v92
    s_nop 0
    v_pk_mul_f32 v[80:81], v[80:81], v[14:15] op_sel:[0,1] op_sel_hi:[1,1]
    v_pk_mul_f32 v[82:83], v[82:83], v[14:15] op_sel:[0,1] op_sel_hi:[1,1]
    v_pk_mul_f32 v[76:77], v[76:77], v[14:15] op_sel:[0,0] op_sel_hi:[1,0]
    v_pk_mul_f32 v[78:79], v[78:79], v[14:15] op_sel:[0,0] op_sel_hi:[1,0]
    v_sub_u16 v88, v60, v52
    v_and_b32 v89, 3, v52
    v_add3_u32 v99, v88, v89, 3
    v_and_b32 v99, -4, v99
    v_max_u32 v99, 4, v99
    v_and_b32 v97, 0xfffc, v52
    v_bfm_b32 v96, v88, v89
    v_add_u32_dpp v91, v99, v99 row_shr:1 row_mask:0xf bank_mask:0xf bound_ctrl:1
    v_mad_u32_u24 v97, v97, 5, v2
    v_cmp_lt_u32 vcc, 16, v99
    v_add_u32_dpp v91, v91, v91 row_shr:2 row_mask:0xf bank_mask:0xf bound_ctrl:1
    v_sub_u32 v98, s38, v99
    v_lshrrev_b64 v[52:53], 16, v[52:53]
    v_add_u32_dpp v91, v91, v91 row_shr:4 row_mask:0xf bank_mask:0xf bound_ctrl:1
    v_lshrrev_b64 v[60:61], 16, v[60:61]
    s_mov_b32 s101, 0
    v_add_u32_dpp v91, v91, v91 row_shr:8 row_mask:0xf bank_mask:0xf bound_ctrl:1
    s_nop 1
    v_add_u32_dpp v91, v91, v91 row_bcast:15 row_mask:0xa bank_mask:0xf
    s_nop 1
    v_add_u32_dpp v91, v91, v91 row_bcast:31 row_mask:0xc bank_mask:0xf
    v_add_u32 v98, v98, v91
    v_readlane_b32 s37, v91, 63
    s_cbranch_vccnz L2_xo88
L2_xp88:
    buffer_load_dwordx4 v[112:115], v3, s[16:19], s40 offen offset:1024
    s_waitcnt lgkmcnt(0)
    v_cmpx_ne_u64 vcc, v[74:75], v[70:71]
    s_and_b64 s[82:83], vcc, s[80:81]
    s_cbranch_scc1 L2_c89
L2_d89:
    v_mov_b64 v[84:85], v[70:71]
    v_mov_b32 v7, v95
    v_mov_b64 v[86:87], v[74:75]
    s_mov_b64 exec, -1
    s_or_b64 s[80:81], s[80:81], vcc
    v_cmpx_ne_u64 vcc, v[72:73], v[68:69]
    s_and_b64 s[82:83], vcc, s[80:81]
    s_cbranch_scc1 L2_c90
L2_d90:
    v_mov_b64 v[84:85], v[68:69]
    v_mov_b32 v7, v94
    v_mov_b64 v[86:87], v[72:73]
    s_mov_b64 exec, -1
    s_or_b64 s[80:81], s[80:81], vcc
    ds_read_b64 v[70:71], v93 offset:65408
    s_and_b64 exec, s[84:85], s[80:81]
    v_mfma_f32_4x4x4_16b_bf16 v[76:79], v[12:13], v[84:85], 0
    v_mov_b32 v92, v7
    s_andn2_b64 s[80:81], s[80:81], s[84:85]
    v_mfma_f32_4x4x4_16b_bf16 v[76:79], v[10:11], v[86:87], v[76:79]
    s_mov_b64 exec, -1
    ds_read_b64 v[68:69], v92 offset:65408
    v_and_b32 v46, 0x80000000, v27
    v_lshrrev_b32 v47, 14, v25
    v_bitop3_b32 v47, v47, v5, v46 bitop3:0xea
    ds_read_b64 v[106:107], v47
    v_bitop3_b32 v95, v25, v5, v46 bitop3:0xea
    v_and_b32 v46, 0x40000000, v27
    v_lshrrev_b32 v47, 14, v24
    v_bitop3_b32 v47, v47, v5, v46 bitop3:0xea
    ds_read_b64 v[104:105], v47
    v_bitop3_b32 v94, v24, v5, v46 bitop3:0xea
    s_waitcnt lgkmcnt(2)
    v_mfma_f32_4x4x4_16b_bf16 v[80:83], v[10:11], v[70:71], v[80:83]
    v_mfma_f32_4x4x4_16b_bf16 v[76:79], v[10:11], v[68:69], v[76:79]
    v_perm_b32 v15, v25, v26, s47
    v_bitop3_b32 v46, v25, 0.5, -0.5 bitop3:0xa8
    v_perm_b32 v14, v24, v26, s46
    v_bitop3_b32 v47, v24, 0.5, -0.5 bitop3:0xa8
    v_cvt_pk_bf16_f32 v80, v80, v81
    v_cvt_pk_bf16_f32 v81, v82, v83
    ds_wrxchg_rtn_b64 v[74:75], v93, v[80:81] offset:65408
    v_cvt_pk_bf16_f32 v76, v76, v77
    v_cvt_pk_bf16_f32 v77, v78, v79
    ds_wrxchg_rtn_b64 v[72:73], v92, v[76:77] offset:65408
    s_setprio 1
    s_waitcnt lgkmcnt(2)
    v_mfma_f32_4x4x4_16b_bf16 v[80:83], v[8:9], v[106:107], 0
    v_mfma_f32_4x4x4_16b_bf16 v[76:79], v[8:9], v[104:105], 0
    v_bitop3_b32 v15, v6, v15, v46 bitop3:0xca
    v_bitop3_b32 v14, v6, v14, v47 bitop3:0xca
    s_nop 1
    v_pk_mul_f32 v[80:81], v[80:81], v[14:15] op_sel:[0,1] op_sel_hi:[1,1]
    v_pk_mul_f32 v[82:83], v[82:83], v[14:15] op_sel:[0,1] op_sel_hi:[1,1]
    v_pk_mul_f32 v[76:77], v[76:77], v[14:15] op_sel:[0,0] op_sel_hi:[1,0]
    v_pk_mul_f32 v[78:79], v[78:79], v[14:15] op_sel:[0,0] op_sel_hi:[1,0]
    v_and_b32 v47, 0x0fffffff, v41
    v_mov_b32 v27, v41
    buffer_load_dwordx2 v[22:23], v47, s[8:11], 0 offen
    buffer_load_dwordx3 v[24:26], v47, s[8:11], 0 offen offset:8
    s_waitcnt lgkmcnt(0)
    v_cmpx_ne_u64 vcc, v[74:75], v[70:71]
    s_and_b64 s[82:83], vcc, s[80:81]
    s_cbranch_scc1 L2_c91
L2_d91:
    v_mov_b64 v[84:85], v[70:71]
    v_mov_b32 v7, v93
    v_mov_b64 v[86:87], v[74:75]
    s_mov_b64 exec, -1
    s_or_b64 s[80:81], s[80:81], vcc
    v_cmpx_ne_u64 vcc, v[72:73], v[68:69]
    s_and_b64 s[82:83], vcc, s[80:81]
    s_cbranch_scc1 L2_c92
L2_d92:
    v_mov_b64 v[84:85], v[68:69]
    v_mov_b32 v7, v92
    v_mov_b64 v[86:87], v[72:73]
    s_mov_b64 exec, -1
    s_or_b64 s[80:81], s[80:81], vcc
    ds_read_b64 v[70:71], v95 offset:65408
    ds_read_b64 v[68:69], v94 offset:65408
    s_waitcnt vmcnt(11)
    v_and_b32 v46, 0x20000000, v33
    v_lshrrev_b32 v47, 14, v29
    v_bitop3_b32 v47, v47, v5, v46 bitop3:0xea
    ds_read_b64 v[102:103], v47
    v_bitop3_b32 v93, v29, v5, v46 bitop3:0xea
    v_and_b32 v46, 0x10000000, v33
    v_lshrrev_b32 v47, 14, v28
    v_bitop3_b32 v47, v47, v5, v46 bitop3:0xea
    ds_read_b64 v[100:101], v47
    v_bitop3_b32 v92, v28, v5, v46 bitop3:0xea
    s_waitcnt lgkmcnt(2)
    v_mfma_f32_4x4x4_16b_bf16 v[80:83], v[10:11], v[70:71], v[80:83]
    v_mfma_f32_4x4x4_16b_bf16 v[76:79], v[10:11], v[68:69], v[76:79]
    v_perm_b32 v15, v29, v32, s45
    v_bitop3_b32 v46, v29, 0.5, -0.5 bitop3:0xa8
    v_perm_b32 v14, v28, v32, s44
    v_bitop3_b32 v47, v28, 0.5, -0.5 bitop3:0xa8
    v_cvt_pk_bf16_f32 v80, v80, v81
    v_cvt_pk_bf16_f32 v81, v82, v83
    ds_wrxchg_rtn_b64 v[74:75], v95, v[80:81] offset:65408
    v_cvt_pk_bf16_f32 v76, v76, v77
    v_cvt_pk_bf16_f32 v77, v78, v79
    ds_wrxchg_rtn_b64 v[72:73], v94, v[76:77] offset:65408
    s_waitcnt lgkmcnt(2)
    v_mfma_f32_4x4x4_16b_bf16 v[80:83], v[8:9], v[102:103], 0
    v_mfma_f32_4x4x4_16b_bf16 v[76:79], v[8:9], v[100:101], 0
    v_bitop3_b32 v15, v6, v15, v46 bitop3:0xca
    v_bitop3_b32 v14, v6, v14, v47 bitop3:0xca
    v_cmp_lt_u32 s[84:85], v5, v92
    s_nop 0
    v_pk_mul_f32 v[80:81], v[80:81], v[14:15] op_sel:[0,1] op_sel_hi:[1,1]
    v_pk_mul_f32 v[82:83], v[82:83], v[14:15] op_sel:[0,1] op_sel_hi:[1,1]
    v_pk_mul_f32 v[76:77], v[76:77], v[14:15] op_sel:[0,0] op_sel_hi:[1,0]
    v_pk_mul_f32 v[78:79], v[78:79], v[14:15] op_sel:[0,0] op_sel_hi:[1,0]
    s_waitcnt lgkmcnt(0)
    v_cmpx_ne_u64 vcc, v[74:75], v[70:71]
    s_and_b64 s[82:83], vcc, s[80:81]
    s_cbranch_scc1 L2_c93
L2_d93:
    v_mov_b64 v[84:85], v[70:71]
    v_mov_b32 v7, v95
    v_mov_b64 v[86:87], v[74:75]
    s_mov_b64 exec, -1
    s_or_b64 s[80:81], s[80:81], vcc
    v_cmpx_ne_u64 vcc, v[72:73], v[68:69]
    s_and_b64 s[82:83], vcc, s[80:81]
    s_cbranch_scc1 L2_c94
L2_d94:
    v_mov_b64 v[84:85], v[68:69]
    v_mov_b32 v7, v94
    v_mov_b64 v[86:87], v[72:73]
    s_mov_b64 exec, -1
    s_or_b64 s[80:81], s[80:81], vcc
    ds_read_b64 v[70:71], v93 offset:65408
    s_and_b64 exec, s[84:85], s[80:81]
    v_mfma_f32_4x4x4_16b_bf16 v[76:79], v[12:13], v[84:85], 0
    v_mov_b32 v92, v7
    s_andn2_b64 s[80:81], s[80:81], s[84:85]
    v_mfma_f32_4x4x4_16b_bf16 v[76:79], v[10:11], v[86:87], v[76:79]
    s_mov_b64 exec, -1
    ds_read_b64 v[68:69], v92 offset:65408
    v_and_b32 v46, 0x80000000, v33
    v_lshrrev_b32 v47, 14, v31
    v_bitop3_b32 v47, v47, v5, v46 bitop3:0xea
    ds_read_b64 v[106:107], v47
    v_bitop3_b32 v95, v31, v5, v46 bitop3:0xea
    v_and_b32 v46, 0x40000000, v33
    v_lshrrev_b32 v47, 14, v30
    v_bitop3_b32 v47, v47, v5, v46 bitop3:0xea
    ds_read_b64 v[104:105], v47
    v_bitop3_b32 v94, v30, v5, v46 bitop3:0xea
    s_waitcnt lgkmcnt(2)
    v_mfma_f32_4x4x4_16b_bf16 v[80:83], v[10:11], v[70:71], v[80:83]
    v_mfma_f32_4x4x4_16b_bf16 v[76:79], v[10:11], v[68:69], v[76:79]
    v_perm_b32 v15, v31, v32, s47
    v_bitop3_b32 v46, v31, 0.5, -0.5 bitop3:0xa8
    v_perm_b32 v14, v30, v32, s46
    v_bitop3_b32 v47, v30, 0.5, -0.5 bitop3:0xa8
    v_cvt_pk_bf16_f32 v80, v80, v81
    v_cvt_pk_bf16_f32 v81, v82, v83
    ds_wrxchg_rtn_b64 v[74:75], v93, v[80:81] offset:65408
    v_cvt_pk_bf16_f32 v76, v76, v77
    v_cvt_pk_bf16_f32 v77, v78, v79
    ds_wrxchg_rtn_b64 v[72:73], v92, v[76:77] offset:65408
    s_setprio 0
    s_waitcnt lgkmcnt(2)
    v_mfma_f32_4x4x4_16b_bf16 v[80:83], v[8:9], v[106:107], 0
    v_mfma_f32_4x4x4_16b_bf16 v[76:79], v[8:9], v[104:105], 0
    v_bitop3_b32 v15, v6, v15, v46 bitop3:0xca
    v_bitop3_b32 v14, v6, v14, v47 bitop3:0xca
    s_nop 1
    v_pk_mul_f32 v[80:81], v[80:81], v[14:15] op_sel:[0,1] op_sel_hi:[1,1]
    v_pk_mul_f32 v[82:83], v[82:83], v[14:15] op_sel:[0,1] op_sel_hi:[1,1]
    v_pk_mul_f32 v[76:77], v[76:77], v[14:15] op_sel:[0,0] op_sel_hi:[1,0]
    v_pk_mul_f32 v[78:79], v[78:79], v[14:15] op_sel:[0,0] op_sel_hi:[1,0]
    s_add_u32 s40, s40, 0x50000
    v_and_b32 v47, 0x0fffffff, v42
    v_mov_b32 v33, v42
    buffer_load_dwordx2 v[28:29], v47, s[8:11], 0 offen
    buffer_load_dwordx3 v[30:32], v47, s[8:11], 0 offen offset:8
    s_waitcnt lgkmcnt(0)
    v_cmpx_ne_u64 vcc, v[74:75], v[70:71]
    s_and_b64 s[82:83], vcc, s[80:81]
    s_cbranch_scc1 L2_c95
L2_d95:
    v_mov_b64 v[84:85], v[70:71]
    v_mov_b32 v7, v93
    v_mov_b64 v[86:87], v[74:75]
    s_mov_b64 exec, -1
    s_or_b64 s[80:81], s[80:81], vcc
    v_cmpx_ne_u64 vcc, v[72:73], v[68:69]
    s_and_b64 s[82:83], vcc, s[80:81]
    s_cbranch_scc1 L2_c96
L2_d96:
    v_mov_b64 v[84:85], v[68:69]
    v_mov_b32 v7, v92
    v_mov_b64 v[86:87], v[72:73]
    s_mov_b64 exec, -1
    s_or_b64 s[80:81], s[80:81], vcc
    ds_read_b64 v[70:71], v95 offset:65408
    ds_read_b64 v[68:69], v94 offset:65408
    s_waitcnt vmcnt(8)
    v_and_b32 v46, 0x20000000, v39
    v_lshrrev_b32 v47, 14, v35
    v_bitop3_b32 v47, v47, v5, v46 bitop3:0xea
    ds_read_b64 v[102:103], v47
    v_bitop3_b32 v93, v35, v5, v46 bitop3:0xea
    v_and_b32 v46, 0x10000000, v39
    v_lshrrev_b32 v47, 14, v34
    v_bitop3_b32 v47, v47, v5, v46 bitop3:0xea
    ds_read_b64 v[100:101], v47
    v_bitop3_b32 v92, v34, v5, v46 bitop3:0xea
    v_and_b32 v46, 0x80000000, v39
    v_lshrrev_b32 v47, 14, v37
    v_bitop3_b32 v47, v47, v5, v46 bitop3:0xea
    ds_read_b64 v[106:107], v47
    v_and_b32 v46, 0x40000000, v39
    v_lshrrev_b32 v47, 14, v36
    v_bitop3_b32 v47, v47, v5, v46 bitop3:0xea
    ds_read_b64 v[104:105], v47
    s_waitcnt lgkmcnt(4)
    v_mfma_f32_4x4x4_16b_bf16 v[80:83], v[10:11], v[70:71], v[80:83]
    v_mfma_f32_4x4x4_16b_bf16 v[76:79], v[10:11], v[68:69], v[76:79]
    v_perm_b32 v15, v35, v38, s45
    v_bitop3_b32 v46, v35, 0.5, -0.5 bitop3:0xa8
    v_perm_b32 v14, v34, v38, s44
    v_bitop3_b32 v47, v34, 0.5, -0.5 bitop3:0xa8
    v_cvt_pk_bf16_f32 v80, v80, v81
    v_cvt_pk_bf16_f32 v81, v82, v83
    ds_wrxchg_rtn_b64 v[74:75], v95, v[80:81] offset:65408
    v_cvt_pk_bf16_f32 v76, v76, v77
    v_cvt_pk_bf16_f32 v77, v78, v79
    ds_wrxchg_rtn_b64 v[72:73], v94, v[76:77] offset:65408
    s_waitcnt lgkmcnt(2)
    s_barrier
    s_setprio 3
    s_mov_b32 m0, s100
    s_nop 0
    ds_write_addtid_b32 v116 offset:32768
    ds_write_addtid_b32 v117 offset:33024
    ds_write_addtid_b32 v118 offset:33280
    ds_write_addtid_b32 v119 offset:33536
    buffer_load_dwordx4 v[116:119], v3, s[16:19], s40 offen offset:2048
    ds_write_addtid_b32 v120 offset:33792
    ds_write_addtid_b32 v121 offset:34048
    ds_write_addtid_b32 v122 offset:34304
    ds_write_addtid_b32 v123 offset:34560
    buffer_load_dwordx4 v[120:123], v3, s[16:19], s40 offen offset:3072
    v_mfma_f32_4x4x4_16b_bf16 v[80:83], v[8:9], v[102:103], 0
    v_mfma_f32_4x4x4_16b_bf16 v[76:79], v[8:9], v[100:101], 0
    v_bitop3_b32 v15, v6, v15, v46 bitop3:0xca
    v_bitop3_b32 v14, v6, v14, v47 bitop3:0xca
    v_cmp_lt_u32 s[84:85], v5, v92
    s_nop 0
    v_pk_mul_f32 v[80:81], v[80:81], v[14:15] op_sel:[0,1] op_sel_hi:[1,1]
    v_pk_mul_f32 v[82:83], v[82:83], v[14:15] op_sel:[0,1] op_sel_hi:[1,1]
    v_pk_mul_f32 v[76:77], v[76:77], v[14:15] op_sel:[0,0] op_sel_hi:[1,0]
    v_pk_mul_f32 v[78:79], v[78:79], v[14:15] op_sel:[0,0] op_sel_hi:[1,0]
    v_mov_b32 v44, v43
    s_cmp_gt_u32 s37, 1024
    s_cbranch_scc1 L2_xs97
    s_cmp_lg_u32 s101, 0
    s_cbranch_scc1 L2_xa97
L2_xb97:
    v_lshlrev_b32 v89, 16, v96
    v_add_u32 v90, 60, v97
    v_bitop3_b32 v90, v89, v45, v90 bitop3:0x6a
    ds_write_b32 v98, v90 offset:12
    v_lshlrev_b32 v89, 20, v96
    v_add_u32 v90, 40, v97
    v_bitop3_b32 v90, v89, v45, v90 bitop3:0x6a
    ds_write_b32 v98, v90 offset:8
    v_lshlrev_b32 v89, 24, v96
    v_add_u32 v90, 20, v97
    v_bitop3_b32 v90, v89, v45, v90 bitop3:0x6a
    ds_write_b32 v98, v90 offset:4
    v_lshlrev_b32 v89, 28, v96
    v_bitop3_b32 v90, v89, v45, v97 bitop3:0x6a
    ds_write_b32 v98, v90 offset:0
    v_mov_b32_dpp v91, v64 quad_perm:[1,1,1,1] row_mask:0xf bank_mask:0xf
    v_and_b32 v89, 3, v91
    v_and_b32 v97, 0xfffc, v91
    v_sub_u16_dpp v88, v64, v91 quad_perm:[3,3,3,3] row_mask:0xf bank_mask:0xf
    v_mad_u32_u24 v97, v97, 5, v4
    v_add_u32 v99, v88, v89
    v_bfm_b32 v96, v88, v89
    v_cmp_lt_u32 s[58:59], 16, v99
    v_lshlrev_b32 v89, v1, v96
    v_and_b32 v89, v45, v89
    v_cmp_ne_u32 vcc, 0, v89
    v_xor_b32 v90, v97, v89
    s_add_u32 s3, s37, s38
    v_mbcnt_lo_u32_b32 v98, vcc_lo, 0
    v_mbcnt_hi_u32_b32 v98, vcc_hi, v98
    s_bcnt1_i32_b64 s41, vcc
    v_lshl_add_u32 v98, v98, 2, s3
    s_mov_b64 exec, vcc
    ds_write_b32 v98, v90
    s_mov_b64 exec, -1
    s_lshl2_add_u32 s37, s41, s37
    s_cmp_lg_u64 s[58:59], 0
    s_cbranch_scc1 L2_xe97
L2_xr97:
    v_add_u32 v98, s37, v0
    v_mov_b32 v90, -1
    ds_write_b32 v98, v90
    ds_read2st64_b32 v[40:41], v0 offset0:0 offset1:1
    ds_read2st64_b32 v[42:43], v0 offset0:2 offset1:3
    s_sub_u32 s3, s37, 768
    s_cmp_gt_u32 s3, 256
    s_cbranch_scc1 L2_xf97
L2_xg97:
    s_setprio 2
    ds_write_addtid_b32 v124 offset:34816
    ds_write_addtid_b32 v125 offset:35072
    ds_write_addtid_b32 v126 offset:35328
    ds_write_addtid_b32 v127 offset:35584
    s_add_u32 s3, s40, 4096
    buffer_load_dwordx4 v[124:127], v3, s[16:19], s3 offen
    s_waitcnt lgkmcnt(14)
    v_cmpx_ne_u64 vcc, v[74:75], v[70:71]
    s_and_b64 s[82:83], vcc, s[80:81]
    s_cbranch_scc1 L2_c98
L2_d98:
    v_mov_b64 v[84:85], v[70:71]
    v_mov_b32 v7, v95
    v_mov_b64 v[86:87], v[74:75]
    s_mov_b64 exec, -1
    s_or_b64 s[80:81], s[80:81], vcc
    v_cmpx_ne_u64 vcc, v[72:73], v[68:69]
    s_and_b64 s[82:83], vcc, s[80:81]
    s_cbranch_scc1 L2_c99
L2_d99:
    v_mov_b64 v[84:85], v[68:69]
    v_mov_b32 v7, v94
    v_mov_b64 v[86:87], v[72:73]
    s_mov_b64 exec, -1
    s_or_b64 s[80:81], s[80:81], vcc
    ds_read_b64 v[70:71], v93 offset:65408
    s_and_b64 exec, s[84:85], s[80:81]
    v_mfma_f32_4x4x4_16b_bf16 v[76:79], v[12:13], v[84:85], 0
    v_mov_b32 v92, v7
    s_andn2_b64 s[80:81], s[80:81], s[84:85]
    v_mfma_f32_4x4x4_16b_bf16 v[76:79], v[10:11], v[86:87], v[76:79]
    s_mov_b64 exec, -1
    ds_read_b64 v[68:69], v92 offset:65408
    s_setprio 1
    s_waitcnt vmcnt(10)
    s_mov_b32 m0, s38
    s_nop 0
    ds_write_addtid_b32 v108 offset:0
    ds_write_addtid_b32 v109 offset:256
    ds_write_addtid_b32 v110 offset:512
    ds_write_addtid_b32 v111 offset:768
    s_waitcnt lgkmcnt(4)
    v_mfma_f32_4x4x4_16b_bf16 v[80:83], v[10:11], v[70:71], v[80:83]
    v_mfma_f32_4x4x4_16b_bf16 v[76:79], v[10:11], v[68:69], v[76:79]
    v_and_b32 v46, 0x40000000, v39
    v_bitop3_b32 v94, v36, v5, v46 bitop3:0xea
    v_and_b32 v46, 0x80000000, v39
    v_bitop3_b32 v95, v37, v5, v46 bitop3:0xea
    v_perm_b32 v15, v37, v38, s47
    v_bitop3_b32 v46, v37, 0.5, -0.5 bitop3:0xa8
    v_perm_b32 v14, v36, v38, s46
    v_bitop3_b32 v47, v36, 0.5, -0.5 bitop3:0xa8
    v_cvt_pk_bf16_f32 v80, v80, v81
    v_cvt_pk_bf16_f32 v81, v82, v83
    ds_wrxchg_rtn_b64 v[74:75], v93, v[80:81] offset:65408
    v_cvt_pk_bf16_f32 v76, v76, v77
    v_cvt_pk_bf16_f32 v77, v78, v79
    ds_wrxchg_rtn_b64 v[72:73], v92, v[76:77] offset:65408
    s_setprio 0
    s_waitcnt vmcnt(7)
    ds_write_addtid_b32 v112 offset:1024
    ds_write_addtid_b32 v113 offset:1280
    ds_write_addtid_b32 v114 offset:1536
    ds_write_addtid_b32 v115 offset:1792
    v_mfma_f32_4x4x4_16b_bf16 v[80:83], v[8:9], v[106:107], 0
    v_mfma_f32_4x4x4_16b_bf16 v[76:79], v[8:9], v[104:105], 0
    v_bitop3_b32 v15, v6, v15, v46 bitop3:0xca
    v_bitop3_b32 v14, v6, v14, v47 bitop3:0xca
    s_nop 1
    v_pk_mul_f32 v[80:81], v[80:81], v[14:15] op_sel:[0,1] op_sel_hi:[1,1]
    v_pk_mul_f32 v[82:83], v[82:83], v[14:15] op_sel:[0,1] op_sel_hi:[1,1]
    v_pk_mul_f32 v[76:77], v[76:77], v[14:15] op_sel:[0,0] op_sel_hi:[1,0]
    v_pk_mul_f32 v[78:79], v[78:79], v[14:15] op_sel:[0,0] op_sel_hi:[1,0]
    s_add_u32 s42, s42, 1
    s_waitcnt lgkmcnt(0)
    s_barrier
    s_bitcmp1_b32 s36, s42
    s_cbranch_scc1 L2_slow
L2_ret5:
    s_setprio 3
    v_and_b32 v47, 0x0fffffff, v44
    v_mov_b32 v39, v44
    buffer_load_dwordx2 v[34:35], v47, s[8:11], 0 offen
    buffer_load_dwordx3 v[36:38], v47, s[8:11], 0 offen offset:8
    v_cmpx_ne_u64 vcc, v[74:75], v[70:71]
    s_and_b64 s[82:83], vcc, s[80:81]
    s_cbranch_scc1 L2_c100
L2_d100:
    v_mov_b64 v[84:85], v[70:71]
    v_mov_b32 v7, v93
    v_mov_b64 v[86:87], v[74:75]
    s_mov_b64 exec, -1
    s_or_b64 s[80:81], s[80:81], vcc
    v_cmpx_ne_u64 vcc, v[72:73], v[68:69]
    s_and_b64 s[82:83], vcc, s[80:81]
    s_cbranch_scc1 L2_c101
L2_d101:
    v_mov_b64 v[84:85], v[68:69]
    v_mov_b32 v7, v92
    v_mov_b64 v[86:87], v[72:73]
    s_mov_b64 exec, -1
    s_or_b64 s[80:81], s[80:81], vcc
    ds_read_b64 v[70:71], v95 offset:65408
    ds_read_b64 v[68:69], v94 offset:65408
    v_and_b32 v46, 0x20000000, v21
    v_lshrrev_b32 v47, 14, v17
    v_bitop3_b32 v47, v47, v5, v46 bitop3:0xea
    ds_read_b64 v[102:103], v47
    v_bitop3_b32 v93, v17, v5, v46 bitop3:0xea
    v_and_b32 v46, 0x10000000, v21
    v_lshrrev_b32 v47, 14, v16
    v_bitop3_b32 v47, v47, v5, v46 bitop3:0xea
    ds_read_b64 v[100:101], v47
    v_bitop3_b32 v92, v16, v5, v46 bitop3:0xea
    s_waitcnt lgkmcnt(2)
    v_mfma_f32_4x4x4_16b_bf16 v[80:83], v[10:11], v[70:71], v[80:83]
    v_mfma_f32_4x4x4_16b_bf16 v[76:79], v[10:11], v[68:69], v[76:79]
    v_perm_b32 v15, v17, v20, s45
    v_bitop3_b32 v46, v17, 0.5, -0.5 bitop3:0xa8
    v_perm_b32 v14, v16, v20, s44
    v_bitop3_b32 v47, v16, 0.5, -0.5 bitop3:0xa8
    v_cvt_pk_bf16_f32 v80, v80, v81
    v_cvt_pk_bf16_f32 v81, v82, v83
    ds_wrxchg_rtn_b64 v[74:75], v95, v[80:81] offset:65408
    v_cvt_pk_bf16_f32 v76, v76, v77
    v_cvt_pk_bf16_f32 v77, v78, v79
    ds_wrxchg_rtn_b64 v[72:73], v94, v[76:77] offset:65408
    s_waitcnt lgkmcnt(2)
    v_mfma_f32_4x4x4_16b_bf16 v[80:83], v[8:9], v[102:103], 0
    v_mfma_f32_4x4x4_16b_bf16 v[76:79], v[8:9], v[100:101], 0
    v_bitop3_b32 v15, v6, v15, v46 bitop3:0xca
    v_bitop3_b32 v14, v6, v14, v47 bitop3:0xca
    v_cmp_lt_u32 s[84:85], v5, v92
    s_nop 0
    v_pk_mul_f32 v[80:81], v[80:81], v[14:15] op_sel:[0,1] op_sel_hi:[1,1]
    v_pk_mul_f32 v[82:83], v[82:83], v[14:15] op_sel:[0,1] op_sel_hi:[1,1]
    v_pk_mul_f32 v[76:77], v[76:77], v[14:15] op_sel:[0,0] op_sel_hi:[1,0]
    v_pk_mul_f32 v[78:79], v[78:79], v[14:15] op_sel:[0,0] op_sel_hi:[1,0]
    buffer_load_dwordx4 v[108:111], v3, s[16:19], s40 offen offset:0
    s_waitcnt lgkmcnt(0)
    v_cmpx_ne_u64 vcc, v[74:75], v[70:71]
    s_and_b64 s[82:83], vcc, s[80:81]
    s_cbranch_scc1 L2_c102
L2_d102:
    v_mov_b64 v[84:85], v[70:71]
    v_mov_b32 v7, v95
    v_mov_b64 v[86:87], v[74:75]
    s_mov_b64 exec, -1
    s_or_b64 s[80:81], s[80:81], vcc
    v_cmpx_ne_u64 vcc, v[72:73], v[68:69]
    s_and_b64 s[82:83], vcc, s[80:81]
    s_cbranch_scc1 L2_c103
L2_d103:
    v_mov_b64 v[84:85], v[68:69]
    v_mov_b32 v7, v94
    v_mov_b64 v[86:87], v[72:73]
    s_mov_b64 exec, -1
    s_or_b64 s[80:81], s[80:81], vcc
    ds_read_b64 v[70:71], v93 offset:65408
    s_and_b64 exec, s[84:85], s[80:81]
    v_mfma_f32_4x4x4_16b_bf16 v[76:79], v[12:13], v[84:85], 0
    v_mov_b32 v92, v7
    s_andn2_b64 s[80:81], s[80:81], s[84:85]
    v_mfma_f32_4x4x4_16b_bf16 v[76:79], v[10:11], v[86:87], v[76:79]
    s_mov_b64 exec, -1
    ds_read_b64 v[68:69], v92 offset:65408
    v_and_b32 v46, 0x80000000, v21
    v_lshrrev_b32 v47, 14, v19
    v_bitop3_b32 v47, v47, v5, v46 bitop3:0xea
    ds_read_b64 v[106:107], v47
    v_bitop3_b32 v95, v19, v5, v46 bitop3:0xea
    v_and_b32 v46, 0x40000000, v21
    v_lshrrev_b32 v47, 14, v18
    v_bitop3_b32 v47, v47, v5, v46 bitop3:0xea
    ds_read_b64 v[104:105], v47
    v_bitop3_b32 v94, v18, v5, v46 bitop3:0xea
    s_waitcnt lgkmcnt(2)
    v_mfma_f32_4x4x4_16b_bf16 v[80:83], v[10:11], v[70:71], v[80:83]
    v_mfma_f32_4x4x4_16b_bf16 v[76:79], v[10:11], v[68:69], v[76:79]
    v_perm_b32 v15, v19, v20, s47
    v_bitop3_b32 v46, v19, 0.5, -0.5 bitop3:0xa8
    v_perm_b32 v14, v18, v20, s46
    v_bitop3_b32 v47, v18, 0.5, -0.5 bitop3:0xa8
    v_cvt_pk_bf16_f32 v80, v80, v81
    v_cvt_pk_bf16_f32 v81, v82, v83
    ds_wrxchg_rtn_b64 v[74:75], v93, v[80:81] offset:65408
    v_cvt_pk_bf16_f32 v76, v76, v77
    v_cvt_pk_bf16_f32 v77, v78, v79
    ds_wrxchg_rtn_b64 v[72:73], v92, v[76:77] offset:65408
    s_setprio 2
    s_waitcnt lgkmcnt(2)
    v_mfma_f32_4x4x4_16b_bf16 v[80:83], v[8:9], v[106:107], 0
    v_mfma_f32_4x4x4_16b_bf16 v[76:79], v[8:9], v[104:105], 0
    v_bitop3_b32 v15, v6, v15, v46 bitop3:0xca
    v_bitop3_b32 v14, v6, v14, v47 bitop3:0xca
    s_nop 1
    v_pk_mul_f32 v[80:81], v[80:81], v[14:15] op_sel:[0,1] op_sel_hi:[1,1]
    v_pk_mul_f32 v[82:83], v[82:83], v[14:15] op_sel:[0,1] op_sel_hi:[1,1]
    v_pk_mul_f32 v[76:77], v[76:77], v[14:15] op_sel:[0,0] op_sel_hi:[1,0]
    v_pk_mul_f32 v[78:79], v[78:79], v[14:15] op_sel:[0,0] op_sel_hi:[1,0]
    v_and_b32 v47, 0x0fffffff, v40
    v_mov_b32 v21, v40
    buffer_load_dwordx2 v[16:17], v47, s[8:11], 0 offen
    buffer_load_dwordx3 v[18:20], v47, s[8:11], 0 offen offset:8
    s_waitcnt lgkmcnt(0)
    v_cmpx_ne_u64 vcc, v[74:75], v[70:71]
    s_and_b64 s[82:83], vcc, s[80:81]
    s_cbranch_scc1 L2_c104
L2_d104:
    v_mov_b64 v[84:85], v[70:71]
    v_mov_b32 v7, v93
    v_mov_b64 v[86:87], v[74:75]
    s_mov_b64 exec, -1
    s_or_b64 s[80:81], s[80:81], vcc
    v_cmpx_ne_u64 vcc, v[72:73], v[68:69]
    s_and_b64 s[82:83], vcc, s[80:81]
    s_cbranch_scc1 L2_c105
L2_d105:
    v_mov_b64 v[84:85], v[68:69]
    v_mov_b32 v7, v92
    v_mov_b64 v[86:87], v[72:73]
    s_mov_b64 exec, -1
    s_or_b64 s[80:81], s[80:81], vcc
    ds_read_b64 v[70:71], v95 offset:65408
    ds_read_b64 v[68:69], v94 offset:65408
    s_waitcnt vmcnt(10)
    v_and_b32 v46, 0x20000000, v27
    v_lshrrev_b32 v47, 14, v23
    v_bitop3_b32 v47, v47, v5, v46 bitop3:0xea
    ds_read_b64 v[102:103], v47
    v_bitop3_b32 v93, v23, v5, v46 bitop3:0xea
    v_and_b32 v46, 0x10000000, v27
    v_lshrrev_b32 v47, 14, v22
    v_bitop3_b32 v47, v47, v5, v46 bitop3:0xea
    ds_read_b64 v[100:101], v47
    v_bitop3_b32 v92, v22, v5, v46 bitop3:0xea
    s_waitcnt lgkmcnt(2)
    v_mfma_f32_4x4x4_16b_bf16 v[80:83], v[10:11], v[70:71], v[80:83]
    v_mfma_f32_4x4x4_16b_bf16 v[76:79], v[10:11], v[68:69], v[76:79]
    v_perm_b32 v15, v23, v26, s45
    v_bitop3_b32 v46, v23, 0.5, -0.5 bitop3:0xa8
    v_perm_b32 v14, v22, v26, s44
    v_bitop3_b32 v47, v22, 0.5, -0.5 bitop3:0xa8
    v_cvt_pk_bf16_f32 v80, v80, v81
    v_cvt_pk_bf16_f32 v81, v82, v83
    ds_wrxchg_rtn_b64 v[74:75], v95, v[80:81] offset:65408
    v_cvt_pk_bf16_f32 v76, v76, v77
    v_cvt_pk_bf16_f32 v77, v78, v79
    ds_wrxchg_rtn_b64 v[72:73], v94, v[76:77] offset:65408
    s_waitcnt lgkmcnt(2)
    v_mfma_f32_4x4x4_16b_bf16 v[80:83], v[8:9], v[102:103], 0
    v_mfma_f32_4x4x4_16b_bf16 v[76:79], v[8:9], v[100:101], 0
    v_bitop3_b32 v15, v6, v15, v46 bitop3:0xca
    v_bitop3_b32 v14, v6, v14, v47 bitop3:0xca
    v_cmp_lt_u32 s[84:85], v5, v92
    s_nop 0
    v_pk_mul_f32 v[80:81], v[80:81], v[14:15] op_sel:[0,1] op_sel_hi:[1,1]
    v_pk_mul_f32 v[82:83], v[82:83], v[14:15] op_sel:[0,1] op_sel_hi:[1,1]
    v_pk_mul_f32 v[76:77], v[76:77], v[14:15] op_sel:[0,0] op_sel_hi:[1,0]
    v_pk_mul_f32 v[78:79], v[78:79], v[14:15] op_sel:[0,0] op_sel_hi:[1,0]
    v_sub_u16 v88, v62, v54
    v_and_b32 v89, 3, v54
    v_add3_u32 v99, v88, v89, 3
    v_and_b32 v99, -4, v99
    v_max_u32 v99, 4, v99
    v_and_b32 v97, 0xfffc, v54
    v_bfm_b32 v96, v88, v89
    v_add_u32_dpp v91, v99, v99 row_shr:1 row_mask:0xf bank_mask:0xf bound_ctrl:1
    v_mad_u32_u24 v97, v97, 5, v2
    v_cmp_lt_u32 vcc, 16, v99
    v_add_u32_dpp v91, v91, v91 row_shr:2 row_mask:0xf bank_mask:0xf bound_ctrl:1
    v_sub_u32 v98, s38, v99
    v_lshrrev_b64 v[54:55], 16, v[54:55]
    v_add_u32_dpp v91, v91, v91 row_shr:4 row_mask:0xf bank_mask:0xf bound_ctrl:1
    v_lshrrev_b64 v[62:63], 16, v[62:63]
    s_mov_b32 s101, 0
    v_add_u32_dpp v91, v91, v91 row_shr:8 row_mask:0xf bank_mask:0xf bound_ctrl:1
    s_nop 1
    v_add_u32_dpp v91, v91, v91 row_bcast:15 row_mask:0xa bank_mask:0xf
    s_nop 1
    v_add_u32_dpp v91, v91, v91 row_bcast:31 row_mask:0xc bank_mask:0xf
    v_add_u32 v98, v98, v91
    v_readlane_b32 s37, v91, 63
    s_cbranch_vccnz L2_xo106
L2_xp106:
    buffer_load_dwordx4 v[112:115], v3, s[16:19], s40 offen offset:1024
    s_waitcnt lgkmcnt(0)
    v_cmpx_ne_u64 vcc, v[74:75], v[70:71]
    s_and_b64 s[82:83], vcc, s[80:81]
    s_cbranch_scc1 L2_c107
L2_d107:
    v_mov_b64 v[84:85], v[70:71]
    v_mov_b32 v7, v95
    v_mov_b64 v[86:87], v[74:75]
    s_mov_b64 exec, -1
    s_or_b64 s[80:81], s[80:81], vcc
    v_cmpx_ne_u64 vcc, v[72:73], v[68:69]
    s_and_b64 s[82:83], vcc, s[80:81]
    s_cbranch_scc1 L2_c108
L2_d108:
    v_mov_b64 v[84:85], v[68:69]
    v_mov_b32 v7, v94
    v_mov_b64 v[86:87], v[72:73]
    s_mov_b64 exec, -1
    s_or_b64 s[80:81], s[80:81], vcc
    ds_read_b64 v[70:71], v93 offset:65408
    s_and_b64 exec, s[84:85], s[80:81]
    v_mfma_f32_4x4x4_16b_bf16 v[76:79], v[12:13], v[84:85], 0
    v_mov_b32 v92, v7
    s_andn2_b64 s[80:81], s[80:81], s[84:85]
    v_mfma_f32_4x4x4_16b_bf16 v[76:79], v[10:11], v[86:87], v[76:79]
    s_mov_b64 exec, -1
    ds_read_b64 v[68:69], v92 offset:65408
    v_and_b32 v46, 0x80000000, v27
    v_lshrrev_b32 v47, 14, v25
    v_bitop3_b32 v47, v47, v5, v46 bitop3:0xea
    ds_read_b64 v[106:107], v47
    v_bitop3_b32 v95, v25, v5, v46 bitop3:0xea
    v_and_b32 v46, 0x40000000, v27
    v_lshrrev_b32 v47, 14, v24
    v_bitop3_b32 v47, v47, v5, v46 bitop3:0xea
    ds_read_b64 v[104:105], v47
    v_bitop3_b32 v94, v24, v5, v46 bitop3:0xea
    s_waitcnt lgkmcnt(2)
    v_mfma_f32_4x4x4_16b_bf16 v[80:83], v[10:11], v[70:71], v[80:83]
    v_mfma_f32_4x4x4_16b_bf16 v[76:79], v[10:11], v[68:69], v[76:79]
    v_perm_b32 v15, v25, v26, s47
    v_bitop3_b32 v46, v25, 0.5, -0.5 bitop3:0xa8
    v_perm_b32 v14, v24, v26, s46
    v_bitop3_b32 v47, v24, 0.5, -0.5 bitop3:0xa8
    v_cvt_pk_bf16_f32 v80, v80, v81
    v_cvt_pk_bf16_f32 v81, v82, v83
    ds_wrxchg_rtn_b64 v[74:75], v93, v[80:81] offset:65408
    v_cvt_pk_bf16_f32 v76, v76, v77
    v_cvt_pk_bf16_f32 v77, v78, v79
    ds_wrxchg_rtn_b64 v[72:73], v92, v[76:77] offset:65408
    s_setprio 1
    s_waitcnt lgkmcnt(2)
    v_mfma_f32_4x4x4_16b_bf16 v[80:83], v[8:9], v[106:107], 0
    v_mfma_f32_4x4x4_16b_bf16 v[76:79], v[8:9], v[104:105], 0
    v_bitop3_b32 v15, v6, v15, v46 bitop3:0xca
    v_bitop3_b32 v14, v6, v14, v47 bitop3:0xca
    s_nop 1
    v_pk_mul_f32 v[80:81], v[80:81], v[14:15] op_sel:[0,1] op_sel_hi:[1,1]
    v_pk_mul_f32 v[82:83], v[82:83], v[14:15] op_sel:[0,1] op_sel_hi:[1,1]
    v_pk_mul_f32 v[76:77], v[76:77], v[14:15] op_sel:[0,0] op_sel_hi:[1,0]
    v_pk_mul_f32 v[78:79], v[78:79], v[14:15] op_sel:[0,0] op_sel_hi:[1,0]
    v_and_b32 v47, 0x0fffffff, v41
    v_mov_b32 v27, v41
    buffer_load_dwordx2 v[22:23], v47, s[8:11], 0 offen
    buffer_load_dwordx3 v[24:26], v47, s[8:11], 0 offen offset:8
    s_waitcnt lgkmcnt(0)
    v_cmpx_ne_u64 vcc, v[74:75], v[70:71]
    s_and_b64 s[82:83], vcc, s[80:81]
    s_cbranch_scc1 L2_c109
L2_d109:
    v_mov_b64 v[84:85], v[70:71]
    v_mov_b32 v7, v93
    v_mov_b64 v[86:87], v[74:75]
    s_mov_b64 exec, -1
    s_or_b64 s[80:81], s[80:81], vcc
    v_cmpx_ne_u64 vcc, v[72:73], v[68:69]
    s_and_b64 s[82:83], vcc, s[80:81]
    s_cbranch_scc1 L2_c110
L2_d110:
    v_mov_b64 v[84:85], v[68:69]
    v_mov_b32 v7, v92
    v_mov_b64 v[86:87], v[72:73]
    s_mov_b64 exec, -1
    s_or_b64 s[80:81], s[80:81], vcc
    ds_read_b64 v[70:71], v95 offset:65408
    ds_read_b64 v[68:69], v94 offset:65408
    s_waitcnt vmcnt(11)
    v_and_b32 v46, 0x20000000, v33
    v_lshrrev_b32 v47, 14, v29
    v_bitop3_b32 v47, v47, v5, v46 bitop3:0xea
    ds_read_b64 v[102:103], v47
    v_bitop3_b32 v93, v29, v5, v46 bitop3:0xea
    v_and_b32 v46, 0x10000000, v33
    v_lshrrev_b32 v47, 14, v28
    v_bitop3_b32 v47, v47, v5, v46 bitop3:0xea
    ds_read_b64 v[100:101], v47
    v_bitop3_b32 v92, v28, v5, v46 bitop3:0xea
    s_waitcnt lgkmcnt(2)
    v_mfma_f32_4x4x4_16b_bf16 v[80:83], v[10:11], v[70:71], v[80:83]
    v_mfma_f32_4x4x4_16b_bf16 v[76:79], v[10:11], v[68:69], v[76:79]
    v_perm_b32 v15, v29, v32, s45
    v_bitop3_b32 v46, v29, 0.5, -0.5 bitop3:0xa8
    v_perm_b32 v14, v28, v32, s44
    v_bitop3_b32 v47, v28, 0.5, -0.5 bitop3:0xa8
    v_cvt_pk_bf16_f32 v80, v80, v81
    v_cvt_pk_bf16_f32 v81, v82, v83
    ds_wrxchg_rtn_b64 v[74:75], v95, v[80:81] offset:65408
    v_cvt_pk_bf16_f32 v76, v76, v77
    v_cvt_pk_bf16_f32 v77, v78, v79
    ds_wrxchg_rtn_b64 v[72:73], v94, v[76:77] offset:65408
    s_waitcnt lgkmcnt(2)
    v_mfma_f32_4x4x4_16b_bf16 v[80:83], v[8:9], v[102:103], 0
    v_mfma_f32_4x4x4_16b_bf16 v[76:79], v[8:9], v[100:101], 0
    v_bitop3_b32 v15, v6, v15, v46 bitop3:0xca
    v_bitop3_b32 v14, v6, v14, v47 bitop3:0xca
    v_cmp_lt_u32 s[84:85], v5, v92
    s_nop 0
    v_pk_mul_f32 v[80:81], v[80:81], v[14:15] op_sel:[0,1] op_sel_hi:[1,1]
    v_pk_mul_f32 v[82:83], v[82:83], v[14:15] op_sel:[0,1] op_sel_hi:[1,1]
    v_pk_mul_f32 v[76:77], v[76:77], v[14:15] op_sel:[0,0] op_sel_hi:[1,0]
    v_pk_mul_f32 v[78:79], v[78:79], v[14:15] op_sel:[0,0] op_sel_hi:[1,0]
    s_waitcnt lgkmcnt(0)
    v_cmpx_ne_u64 vcc, v[74:75], v[70:71]
    s_and_b64 s[82:83], vcc, s[80:81]
    s_cbranch_scc1 L2_c111
L2_d111:
    v_mov_b64 v[84:85], v[70:71]
    v_mov_b32 v7, v95
    v_mov_b64 v[86:87], v[74:75]
    s_mov_b64 exec, -1
    s_or_b64 s[80:81], s[80:81], vcc
    v_cmpx_ne_u64 vcc, v[72:73], v[68:69]
    s_and_b64 s[82:83], vcc, s[80:81]
    s_cbranch_scc1 L2_c112
L2_d112:
    v_mov_b64 v[84:85], v[68:69]
    v_mov_b32 v7, v94
    v_mov_b64 v[86:87], v[72:73]
    s_mov_b64 exec, -1
    s_or_b64 s[80:81], s[80:81], vcc
    ds_read_b64 v[70:71], v93 offset:65408
    s_and_b64 exec, s[84:85], s[80:81]
    v_mfma_f32_4x4x4_16b_bf16 v[76:79], v[12:13], v[84:85], 0
    v_mov_b32 v92, v7
    s_andn2_b64 s[80:81], s[80:81], s[84:85]
    v_mfma_f32_4x4x4_16b_bf16 v[76:79], v[10:11], v[86:87], v[76:79]
    s_mov_b64 exec, -1
    ds_read_b64 v[68:69], v92 offset:65408
    v_and_b32 v46, 0x80000000, v33
    v_lshrrev_b32 v47, 14, v31
    v_bitop3_b32 v47, v47, v5, v46 bitop3:0xea
    ds_read_b64 v[106:107], v47
    v_bitop3_b32 v95, v31, v5, v46 bitop3:0xea
    v_and_b32 v46, 0x40000000, v33
    v_lshrrev_b32 v47, 14, v30
    v_bitop3_b32 v47, v47, v5, v46 bitop3:0xea
    ds_read_b64 v[104:105], v47
    v_bitop3_b32 v94, v30, v5, v46 bitop3:0xea
    s_waitcnt lgkmcnt(2)
    v_mfma_f32_4x4x4_16b_bf16 v[80:83], v[10:11], v[70:71], v[80:83]
    v_mfma_f32_4x4x4_16b_bf16 v[76:79], v[10:11], v[68:69], v[76:79]
    v_perm_b32 v15, v31, v32, s47
    v_bitop3_b32 v46, v31, 0.5, -0.5 bitop3:0xa8
    v_perm_b32 v14, v30, v32, s46
    v_bitop3_b32 v47, v30, 0.5, -0.5 bitop3:0xa8
    v_cvt_pk_bf16_f32 v80, v80, v81
    v_cvt_pk_bf16_f32 v81, v82, v83
    ds_wrxchg_rtn_b64 v[74:75], v93, v[80:81] offset:65408
    v_cvt_pk_bf16_f32 v76, v76, v77
    v_cvt_pk_bf16_f32 v77, v78, v79
    ds_wrxchg_rtn_b64 v[72:73], v92, v[76:77] offset:65408
    s_setprio 0
    s_waitcnt lgkmcnt(2)
    v_mfma_f32_4x4x4_16b_bf16 v[80:83], v[8:9], v[106:107], 0
    v_mfma_f32_4x4x4_16b_bf16 v[76:79], v[8:9], v[104:105], 0
    v_bitop3_b32 v15, v6, v15, v46 bitop3:0xca
    v_bitop3_b32 v14, v6, v14, v47 bitop3:0xca
    s_nop 1
    v_pk_mul_f32 v[80:81], v[80:81], v[14:15] op_sel:[0,1] op_sel_hi:[1,1]
    v_pk_mul_f32 v[82:83], v[82:83], v[14:15] op_sel:[0,1] op_sel_hi:[1,1]
    v_pk_mul_f32 v[76:77], v[76:77], v[14:15] op_sel:[0,0] op_sel_hi:[1,0]
    v_pk_mul_f32 v[78:79], v[78:79], v[14:15] op_sel:[0,0] op_sel_hi:[1,0]
    s_add_u32 s40, s40, 0x50000
    v_and_b32 v47, 0x0fffffff, v42
    v_mov_b32 v33, v42
    buffer_load_dwordx2 v[28:29], v47, s[8:11], 0 offen
    buffer_load_dwordx3 v[30:32], v47, s[8:11], 0 offen offset:8
    s_waitcnt lgkmcnt(0)
    v_cmpx_ne_u64 vcc, v[74:75], v[70:71]
    s_and_b64 s[82:83], vcc, s[80:81]
    s_cbranch_scc1 L2_c113
L2_d113:
    v_mov_b64 v[84:85], v[70:71]
    v_mov_b32 v7, v93
    v_mov_b64 v[86:87], v[74:75]
    s_mov_b64 exec, -1
    s_or_b64 s[80:81], s[80:81], vcc
    v_cmpx_ne_u64 vcc, v[72:73], v[68:69]
    s_and_b64 s[82:83], vcc, s[80:81]
    s_cbranch_scc1 L2_c114
L2_d114:
    v_mov_b64 v[84:85], v[68:69]
    v_mov_b32 v7, v92
    v_mov_b64 v[86:87], v[72:73]
    s_mov_b64 exec, -1
    s_or_b64 s[80:81], s[80:81], vcc
    ds_read_b64 v[70:71], v95 offset:65408
    ds_read_b64 v[68:69], v94 offset:65408
    s_waitcnt vmcnt(8)
    v_and_b32 v46, 0x20000000, v39
    v_lshrrev_b32 v47, 14, v35
    v_bitop3_b32 v47, v47, v5, v46 bitop3:0xea
    ds_read_b64 v[102:103], v47
    v_bitop3_b32 v93, v35, v5, v46 bitop3:0xea
    v_and_b32 v46, 0x10000000, v39
    v_lshrrev_b32 v47, 14, v34
    v_bitop3_b32 v47, v47, v5, v46 bitop3:0xea
    ds_read_b64 v[100:101], v47
    v_bitop3_b32 v92, v34, v5, v46 bitop3:0xea
    v_and_b32 v46, 0x80000000, v39
    v_lshrrev_b32 v47, 14, v37
    v_bitop3_b32 v47, v47, v5, v46 bitop3:0xea
    ds_read_b64 v[106:107], v47
    v_and_b32 v46, 0x40000000, v39
    v_lshrrev_b32 v47, 14, v36
    v_bitop3_b32 v47, v47, v5, v46 bitop3:0xea
    ds_read_b64 v[104:105], v47
    s_waitcnt lgkmcnt(4)
    v_mfma_f32_4x4x4_16b_bf16 v[80:83], v[10:11], v[70:71], v[80:83]
    v_mfma_f32_4x4x4_16b_bf16 v[76:79], v[10:11], v[68:69], v[76:79]
    v_perm_b32 v15, v35, v38, s45
    v_bitop3_b32 v46, v35, 0.5, -0.5 bitop3:0xa8
    v_perm_b32 v14, v34, v38, s44
    v_bitop3_b32 v47, v34, 0.5, -0.5 bitop3:0xa8
    v_cvt_pk_bf16_f32 v80, v80, v81
    v_cvt_pk_bf16_f32 v81, v82, v83
    ds_wrxchg_rtn_b64 v[74:75], v95, v[80:81] offset:65408
    v_cvt_pk_bf16_f32 v76, v76, v77
    v_cvt_pk_bf16_f32 v77, v78, v79
    ds_wrxchg_rtn_b64 v[72:73], v94, v[76:77] offset:65408
    s_waitcnt lgkmcnt(2)
    s_barrier
    s_setprio 3
    s_mov_b32 m0, s100
    s_nop 0
    ds_write_addtid_b32 v116 offset:32768
    ds_write_addtid_b32 v117 offset:33024
    ds_write_addtid_b32 v118 offset:33280
    ds_write_addtid_b32 v119 offset:33536
    buffer_load_dwordx4 v[116:119], v3, s[16:19], s40 offen offset:2048
    ds_write_addtid_b32 v120 offset:33792
    ds_write_addtid_b32 v121 offset:34048
    ds_write_addtid_b32 v122 offset:34304
    ds_write_addtid_b32 v123 offset:34560
    buffer_load_dwordx4 v[120:123], v3, s[16:19], s40 offen offset:3072
    v_mfma_f32_4x4x4_16b_bf16 v[80:83], v[8:9], v[102:103], 0
    v_mfma_f32_4x4x4_16b_bf16 v[76:79], v[8:9], v[100:101], 0
    v_bitop3_b32 v15, v6, v15, v46 bitop3:0xca
    v_bitop3_b32 v14, v6, v14, v47 bitop3:0xca
    v_cmp_lt_u32 s[84:85], v5, v92
    s_nop 0
    v_pk_mul_f32 v[80:81], v[80:81], v[14:15] op_sel:[0,1] op_sel_hi:[1,1]
    v_pk_mul_f32 v[82:83], v[82:83], v[14:15] op_sel:[0,1] op_sel_hi:[1,1]
    v_pk_mul_f32 v[76:77], v[76:77], v[14:15] op_sel:[0,0] op_sel_hi:[1,0]
    v_pk_mul_f32 v[78:79], v[78:79], v[14:15] op_sel:[0,0] op_sel_hi:[1,0]
    v_mov_b32 v44, v43
    s_cmp_gt_u32 s37, 1024
    s_cbranch_scc1 L2_xs115
    s_cmp_lg_u32 s101, 0
    s_cbranch_scc1 L2_xa115
L2_xb115:
    v_lshlrev_b32 v89, 16, v96
    v_add_u32 v90, 60, v97
    v_bitop3_b32 v90, v89, v45, v90 bitop3:0x6a
    ds_write_b32 v98, v90 offset:12
    v_lshlrev_b32 v89, 20, v96
    v_add_u32 v90, 40, v97
    v_bitop3_b32 v90, v89, v45, v90 bitop3:0x6a
    ds_write_b32 v98, v90 offset:8
    v_lshlrev_b32 v89, 24, v96
    v_add_u32 v90, 20, v97
    v_bitop3_b32 v90, v89, v45, v90 bitop3:0x6a
    ds_write_b32 v98, v90 offset:4
    v_lshlrev_b32 v89, 28, v96
    v_bitop3_b32 v90, v89, v45, v97 bitop3:0x6a
    ds_write_b32 v98, v90 offset:0
    v_mov_b32_dpp v91, v66 quad_perm:[1,1,1,1] row_mask:0xf bank_mask:0xf
    v_and_b32 v89, 3, v91
    v_and_b32 v97, 0xfffc, v91
    v_sub_u16_dpp v88, v66, v91 quad_perm:[3,3,3,3] row_mask:0xf bank_mask:0xf
    v_mad_u32_u24 v97, v97, 5, v4
    v_add_u32 v99, v88, v89
    v_bfm_b32 v96, v88, v89
    v_cmp_lt_u32 s[58:59], 16, v99
    v_lshlrev_b32 v89, v1, v96
    v_and_b32 v89, v45, v89
    v_cmp_ne_u32 vcc, 0, v89
    v_xor_b32 v90, v97, v89
    s_add_u32 s3, s37, s38
    v_mbcnt_lo_u32_b32 v98, vcc_lo, 0
    v_mbcnt_hi_u32_b32 v98, vcc_hi, v98
    s_bcnt1_i32_b64 s41, vcc
    v_lshl_add_u32 v98, v98, 2, s3
    s_mov_b64 exec, vcc
    ds_write_b32 v98, v90
    s_mov_b64 exec, -1
    s_lshl2_add_u32 s37, s41, s37
    s_cmp_lg_u64 s[58:59], 0
    s_cbranch_scc1 L2_xe115
L2_xr115:
    v_add_u32 v98, s37, v0
    v_mov_b32 v90, -1
    ds_write_b32 v98, v90
    ds_read2st64_b32 v[40:41], v0 offset0:0 offset1:1
    ds_read2st64_b32 v[42:43], v0 offset0:2 offset1:3
    s_sub_u32 s3, s37, 768
    s_cmp_gt_u32 s3, 256
    s_cbranch_scc1 L2_xf115
L2_xg115:
    v_lshrrev_b64 v[64:65], 16, v[64:65]
    v_lshrrev_b64 v[66:67], 16, v[66:67]
    s_setprio 2
    ds_write_addtid_b32 v124 offset:34816
    ds_write_addtid_b32 v125 offset:35072
    ds_write_addtid_b32 v126 offset:35328
    ds_write_addtid_b32 v127 offset:35584
    s_add_u32 s3, s40, 4096
    buffer_load_dwordx4 v[124:127], v3, s[16:19], s3 offen
    s_waitcnt lgkmcnt(14)
    v_cmpx_ne_u64 vcc, v[74:75], v[70:71]
    s_and_b64 s[82:83], vcc, s[80:81]
    s_cbranch_scc1 L2_c116
L2_d116:
    v_mov_b64 v[84:85], v[70:71]
    v_mov_b32 v7, v95
    v_mov_b64 v[86:87], v[74:75]
    s_mov_b64 exec, -1
    s_or_b64 s[80:81], s[80:81], vcc
    v_cmpx_ne_u64 vcc, v[72:73], v[68:69]
    s_and_b64 s[82:83], vcc, s[80:81]
    s_cbranch_scc1 L2_c117
L2_d117:
    v_mov_b64 v[84:85], v[68:69]
    v_mov_b32 v7, v94
    v_mov_b64 v[86:87], v[72:73]
    s_mov_b64 exec, -1
    s_or_b64 s[80:81], s[80:81], vcc
    ds_read_b64 v[70:71], v93 offset:65408
    s_and_b64 exec, s[84:85], s[80:81]
    v_mfma_f32_4x4x4_16b_bf16 v[76:79], v[12:13], v[84:85], 0
    v_mov_b32 v92, v7
    s_andn2_b64 s[80:81], s[80:81], s[84:85]
    v_mfma_f32_4x4x4_16b_bf16 v[76:79], v[10:11], v[86:87], v[76:79]
    s_mov_b64 exec, -1
    ds_read_b64 v[68:69], v92 offset:65408
    s_setprio 1
    s_waitcnt vmcnt(10)
    s_mov_b32 m0, s38
    s_nop 0
    ds_write_addtid_b32 v108 offset:0
    ds_write_addtid_b32 v109 offset:256
    ds_write_addtid_b32 v110 offset:512
    ds_write_addtid_b32 v111 offset:768
    s_waitcnt lgkmcnt(4)
    v_mfma_f32_4x4x4_16b_bf16 v[80:83], v[10:11], v[70:71], v[80:83]
    v_mfma_f32_4x4x4_16b_bf16 v[76:79], v[10:11], v[68:69], v[76:79]
    v_and_b32 v46, 0x40000000, v39
    v_bitop3_b32 v94, v36, v5, v46 bitop3:0xea
    v_and_b32 v46, 0x80000000, v39
    v_bitop3_b32 v95, v37, v5, v46 bitop3:0xea
    v_perm_b32 v15, v37, v38, s47
    v_bitop3_b32 v46, v37, 0.5, -0.5 bitop3:0xa8
    v_perm_b32 v14, v36, v38, s46
    v_bitop3_b32 v47, v36, 0.5, -0.5 bitop3:0xa8
    v_cvt_pk_bf16_f32 v80, v80, v81
    v_cvt_pk_bf16_f32 v81, v82, v83
    ds_wrxchg_rtn_b64 v[74:75], v93, v[80:81] offset:65408
    v_cvt_pk_bf16_f32 v76, v76, v77
    v_cvt_pk_bf16_f32 v77, v78, v79
    ds_wrxchg_rtn_b64 v[72:73], v92, v[76:77] offset:65408
    s_setprio 0
    s_waitcnt vmcnt(7)
    ds_write_addtid_b32 v112 offset:1024
    ds_write_addtid_b32 v113 offset:1280
    ds_write_addtid_b32 v114 offset:1536
    ds_write_addtid_b32 v115 offset:1792
    v_mfma_f32_4x4x4_16b_bf16 v[80:83], v[8:9], v[106:107], 0
    v_mfma_f32_4x4x4_16b_bf16 v[76:79], v[8:9], v[104:105], 0
    v_bitop3_b32 v15, v6, v15, v46 bitop3:0xca
    v_bitop3_b32 v14, v6, v14, v47 bitop3:0xca
    s_nop 1
    v_pk_mul_f32 v[80:81], v[80:81], v[14:15] op_sel:[0,1] op_sel_hi:[1,1]
    v_pk_mul_f32 v[82:83], v[82:83], v[14:15] op_sel:[0,1] op_sel_hi:[1,1]
    v_pk_mul_f32 v[76:77], v[76:77], v[14:15] op_sel:[0,0] op_sel_hi:[1,0]
    v_pk_mul_f32 v[78:79], v[78:79], v[14:15] op_sel:[0,0] op_sel_hi:[1,0]
    s_add_u32 s42, s42, 1
    s_waitcnt lgkmcnt(0)
    s_cmp_lg_u32 s42, 14
    s_cbranch_scc1 L2_loop
    s_barrier
    s_bitcmp1_b32 s36, s42
    s_cbranch_scc1 L2_slow
L2_ret6:
    s_setprio 3
    v_and_b32 v47, 0x0fffffff, v44
    v_mov_b32 v39, v44
    buffer_load_dwordx2 v[34:35], v47, s[8:11], 0 offen
    buffer_load_dwordx3 v[36:38], v47, s[8:11], 0 offen offset:8
    v_cmpx_ne_u64 vcc, v[74:75], v[70:71]
    s_and_b64 s[82:83], vcc, s[80:81]
    s_cbranch_scc1 L2_c118
L2_d118:
    v_mov_b64 v[84:85], v[70:71]
    v_mov_b32 v7, v93
    v_mov_b64 v[86:87], v[74:75]
    s_mov_b64 exec, -1
    s_or_b64 s[80:81], s[80:81], vcc
    v_cmpx_ne_u64 vcc, v[72:73], v[68:69]
    s_and_b64 s[82:83], vcc, s[80:81]
    s_cbranch_scc1 L2_c119
L2_d119:
    v_mov_b64 v[84:85], v[68:69]
    v_mov_b32 v7, v92
    v_mov_b64 v[86:87], v[72:73]
    s_mov_b64 exec, -1
    s_or_b64 s[80:81], s[80:81], vcc
    ds_read_b64 v[70:71], v95 offset:65408
    ds_read_b64 v[68:69], v94 offset:65408
    v_and_b32 v46, 0x20000000, v21
    v_lshrrev_b32 v47, 14, v17
    v_bitop3_b32 v47, v47, v5, v46 bitop3:0xea
    ds_read_b64 v[102:103], v47
    v_bitop3_b32 v93, v17, v5, v46 bitop3:0xea
    v_and_b32 v46, 0x10000000, v21
    v_lshrrev_b32 v47, 14, v16
    v_bitop3_b32 v47, v47, v5, v46 bitop3:0xea
    ds_read_b64 v[100:101], v47
    v_bitop3_b32 v92, v16, v5, v46 bitop3:0xea
    s_waitcnt lgkmcnt(2)
    v_mfma_f32_4x4x4_16b_bf16 v[80:83], v[10:11], v[70:71], v[80:83]
    v_mfma_f32_4x4x4_16b_bf16 v[76:79], v[10:11], v[68:69], v[76:79]
    v_perm_b32 v15, v17, v20, s45
    v_bitop3_b32 v46, v17, 0.5, -0.5 bitop3:0xa8
    v_perm_b32 v14, v16, v20, s44
    v_bitop3_b32 v47, v16, 0.5, -0.5 bitop3:0xa8
    v_cvt_pk_bf16_f32 v80, v80, v81
    v_cvt_pk_bf16_f32 v81, v82, v83
    ds_wrxchg_rtn_b64 v[74:75], v95, v[80:81] offset:65408
    v_cvt_pk_bf16_f32 v76, v76, v77
    v_cvt_pk_bf16_f32 v77, v78, v79
    ds_wrxchg_rtn_b64 v[72:73], v94, v[76:77] offset:65408
    s_waitcnt lgkmcnt(2)
    v_mfma_f32_4x4x4_16b_bf16 v[80:83], v[8:9], v[102:103], 0
    v_mfma_f32_4x4x4_16b_bf16 v[76:79], v[8:9], v[100:101], 0
    v_bitop3_b32 v15, v6, v15, v46 bitop3:0xca
    v_bitop3_b32 v14, v6, v14, v47 bitop3:0xca
    v_cmp_lt_u32 s[84:85], v5, v92
    s_nop 0
    v_pk_mul_f32 v[80:81], v[80:81], v[14:15] op_sel:[0,1] op_sel_hi:[1,1]
    v_pk_mul_f32 v[82:83], v[82:83], v[14:15] op_sel:[0,1] op_sel_hi:[1,1]
    v_pk_mul_f32 v[76:77], v[76:77], v[14:15] op_sel:[0,0] op_sel_hi:[1,0]
    v_pk_mul_f32 v[78:79], v[78:79], v[14:15] op_sel:[0,0] op_sel_hi:[1,0]
    buffer_load_dwordx4 v[108:111], v3, s[16:19], s40 offen offset:0
    s_waitcnt lgkmcnt(0)
    v_cmpx_ne_u64 vcc, v[74:75], v[70:71]
    s_and_b64 s[82:83], vcc, s[80:81]
    s_cbranch_scc1 L2_c120
L2_d120:
    v_mov_b64 v[84:85], v[70:71]
    v_mov_b32 v7, v95
    v_mov_b64 v[86:87], v[74:75]
    s_mov_b64 exec, -1
    s_or_b64 s[80:81], s[80:81], vcc
    v_cmpx_ne_u64 vcc, v[72:73], v[68:69]
    s_and_b64 s[82:83], vcc, s[80:81]
    s_cbranch_scc1 L2_c121
L2_d121:
    v_mov_b64 v[84:85], v[68:69]
    v_mov_b32 v7, v94
    v_mov_b64 v[86:87], v[72:73]
    s_mov_b64 exec, -1
    s_or_b64 s[80:81], s[80:81], vcc
    ds_read_b64 v[70:71], v93 offset:65408
    s_and_b64 exec, s[84:85], s[80:81]
    v_mfma_f32_4x4x4_16b_bf16 v[76:79], v[12:13], v[84:85], 0
    v_mov_b32 v92, v7
    s_andn2_b64 s[80:81], s[80:81], s[84:85]
    v_mfma_f32_4x4x4_16b_bf16 v[76:79], v[10:11], v[86:87], v[76:79]
    s_mov_b64 exec, -1
    ds_read_b64 v[68:69], v92 offset:65408
    v_and_b32 v46, 0x80000000, v21
    v_lshrrev_b32 v47, 14, v19
    v_bitop3_b32 v47, v47, v5, v46 bitop3:0xea
    ds_read_b64 v[106:107], v47
    v_bitop3_b32 v95, v19, v5, v46 bitop3:0xea
    v_and_b32 v46, 0x40000000, v21
    v_lshrrev_b32 v47, 14, v18
    v_bitop3_b32 v47, v47, v5, v46 bitop3:0xea
    ds_read_b64 v[104:105], v47
    v_bitop3_b32 v94, v18, v5, v46 bitop3:0xea
    s_waitcnt lgkmcnt(2)
    v_mfma_f32_4x4x4_16b_bf16 v[80:83], v[10:11], v[70:71], v[80:83]
    v_mfma_f32_4x4x4_16b_bf16 v[76:79], v[10:11], v[68:69], v[76:79]
    v_perm_b32 v15, v19, v20, s47
    v_bitop3_b32 v46, v19, 0.5, -0.5 bitop3:0xa8
    v_perm_b32 v14, v18, v20, s46
    v_bitop3_b32 v47, v18, 0.5, -0.5 bitop3:0xa8
    v_cvt_pk_bf16_f32 v80, v80, v81
    v_cvt_pk_bf16_f32 v81, v82, v83
    ds_wrxchg_rtn_b64 v[74:75], v93, v[80:81] offset:65408
    v_cvt_pk_bf16_f32 v76, v76, v77
    v_cvt_pk_bf16_f32 v77, v78, v79
    ds_wrxchg_rtn_b64 v[72:73], v92, v[76:77] offset:65408
    s_setprio 2
    s_waitcnt lgkmcnt(2)
    v_mfma_f32_4x4x4_16b_bf16 v[80:83], v[8:9], v[106:107], 0
    v_mfma_f32_4x4x4_16b_bf16 v[76:79], v[8:9], v[104:105], 0
    v_bitop3_b32 v15, v6, v15, v46 bitop3:0xca
    v_bitop3_b32 v14, v6, v14, v47 bitop3:0xca
    s_nop 1
    v_pk_mul_f32 v[80:81], v[80:81], v[14:15] op_sel:[0,1] op_sel_hi:[1,1]
    v_pk_mul_f32 v[82:83], v[82:83], v[14:15] op_sel:[0,1] op_sel_hi:[1,1]
    v_pk_mul_f32 v[76:77], v[76:77], v[14:15] op_sel:[0,0] op_sel_hi:[1,0]
    v_pk_mul_f32 v[78:79], v[78:79], v[14:15] op_sel:[0,0] op_sel_hi:[1,0]
    v_and_b32 v47, 0x0fffffff, v40
    v_mov_b32 v21, v40
    buffer_load_dwordx2 v[16:17], v47, s[8:11], 0 offen
    buffer_load_dwordx3 v[18:20], v47, s[8:11], 0 offen offset:8
    s_waitcnt lgkmcnt(0)
    v_cmpx_ne_u64 vcc, v[74:75], v[70:71]
    s_and_b64 s[82:83], vcc, s[80:81]
    s_cbranch_scc1 L2_c122
L2_d122:
    v_mov_b64 v[84:85], v[70:71]
    v_mov_b32 v7, v93
    v_mov_b64 v[86:87], v[74:75]
    s_mov_b64 exec, -1
    s_or_b64 s[80:81], s[80:81], vcc
    v_cmpx_ne_u64 vcc, v[72:73], v[68:69]
    s_and_b64 s[82:83], vcc, s[80:81]
    s_cbranch_scc1 L2_c123
L2_d123:
    v_mov_b64 v[84:85], v[68:69]
    v_mov_b32 v7, v92
    v_mov_b64 v[86:87], v[72:73]
    s_mov_b64 exec, -1
    s_or_b64 s[80:81], s[80:81], vcc
    ds_read_b64 v[70:71], v95 offset:65408
    ds_read_b64 v[68:69], v94 offset:65408
    s_waitcnt vmcnt(10)
    v_and_b32 v46, 0x20000000, v27
    v_lshrrev_b32 v47, 14, v23
    v_bitop3_b32 v47, v47, v5, v46 bitop3:0xea
    ds_read_b64 v[102:103], v47
    v_bitop3_b32 v93, v23, v5, v46 bitop3:0xea
    v_and_b32 v46, 0x10000000, v27
    v_lshrrev_b32 v47, 14, v22
    v_bitop3_b32 v47, v47, v5, v46 bitop3:0xea
    ds_read_b64 v[100:101], v47
    v_bitop3_b32 v92, v22, v5, v46 bitop3:0xea
    s_waitcnt lgkmcnt(2)
    v_mfma_f32_4x4x4_16b_bf16 v[80:83], v[10:11], v[70:71], v[80:83]
    v_mfma_f32_4x4x4_16b_bf16 v[76:79], v[10:11], v[68:69], v[76:79]
    v_perm_b32 v15, v23, v26, s45
    v_bitop3_b32 v46, v23, 0.5, -0.5 bitop3:0xa8
    v_perm_b32 v14, v22, v26, s44
    v_bitop3_b32 v47, v22, 0.5, -0.5 bitop3:0xa8
    v_cvt_pk_bf16_f32 v80, v80, v81
    v_cvt_pk_bf16_f32 v81, v82, v83
    ds_wrxchg_rtn_b64 v[74:75], v95, v[80:81] offset:65408
    v_cvt_pk_bf16_f32 v76, v76, v77
    v_cvt_pk_bf16_f32 v77, v78, v79
    ds_wrxchg_rtn_b64 v[72:73], v94, v[76:77] offset:65408
    s_waitcnt lgkmcnt(2)
    v_mfma_f32_4x4x4_16b_bf16 v[80:83], v[8:9], v[102:103], 0
    v_mfma_f32_4x4x4_16b_bf16 v[76:79], v[8:9], v[100:101], 0
    v_bitop3_b32 v15, v6, v15, v46 bitop3:0xca
    v_bitop3_b32 v14, v6, v14, v47 bitop3:0xca
    v_cmp_lt_u32 s[84:85], v5, v92
    s_nop 0
    v_pk_mul_f32 v[80:81], v[80:81], v[14:15] op_sel:[0,1] op_sel_hi:[1,1]
    v_pk_mul_f32 v[82:83], v[82:83], v[14:15] op_sel:[0,1] op_sel_hi:[1,1]
    v_pk_mul_f32 v[76:77], v[76:77], v[14:15] op_sel:[0,0] op_sel_hi:[1,0]
    v_pk_mul_f32 v[78:79], v[78:79], v[14:15] op_sel:[0,0] op_sel_hi:[1,0]
    buffer_load_dwordx4 v[112:115], v3, s[16:19], s40 offen offset:1024
    s_waitcnt lgkmcnt(0)
    v_cmpx_ne_u64 vcc, v[74:75], v[70:71]
    s_and_b64 s[82:83], vcc, s[80:81]
    s_cbranch_scc1 L2_c124
L2_d124:
    v_mov_b64 v[84:85], v[70:71]
    v_mov_b32 v7, v95
    v_mov_b64 v[86:87], v[74:75]
    s_mov_b64 exec, -1
    s_or_b64 s[80:81], s[80:81], vcc
    v_cmpx_ne_u64 vcc, v[72:73], v[68:69]
    s_and_b64 s[82:83], vcc, s[80:81]
    s_cbranch_scc1 L2_c125
L2_d125:
    v_mov_b64 v[84:85], v[68:69]
    v_mov_b32 v7, v94
    v_mov_b64 v[86:87], v[72:73]
    s_mov_b64 exec, -1
    s_or_b64 s[80:81], s[80:81], vcc
    ds_read_b64 v[70:71], v93 offset:65408
    s_and_b64 exec, s[84:85], s[80:81]
    v_mfma_f32_4x4x4_16b_bf16 v[76:79], v[12:13], v[84:85], 0
    v_mov_b32 v92, v7
    s_andn2_b64 s[80:81], s[80:81], s[84:85]
    v_mfma_f32_4x4x4_16b_bf16 v[76:79], v[10:11], v[86:87], v[76:79]
    s_mov_b64 exec, -1
    ds_read_b64 v[68:69], v92 offset:65408
    v_and_b32 v46, 0x80000000, v27
    v_lshrrev_b32 v47, 14, v25
    v_bitop3_b32 v47, v47, v5, v46 bitop3:0xea
    ds_read_b64 v[106:107], v47
    v_bitop3_b32 v95, v25, v5, v46 bitop3:0xea
    v_and_b32 v46, 0x40000000, v27
    v_lshrrev_b32 v47, 14, v24
    v_bitop3_b32 v47, v47, v5, v46 bitop3:0xea
    ds_read_b64 v[104:105], v47
    v_bitop3_b32 v94, v24, v5, v46 bitop3:0xea
    s_waitcnt lgkmcnt(2)
    v_mfma_f32_4x4x4_16b_bf16 v[80:83], v[10:11], v[70:71], v[80:83]
    v_mfma_f32_4x4x4_16b_bf16 v[76:79], v[10:11], v[68:69], v[76:79]
    v_perm_b32 v15, v25, v26, s47
    v_bitop3_b32 v46, v25, 0.5, -0.5 bitop3:0xa8
    v_perm_b32 v14, v24, v26, s46
    v_bitop3_b32 v47, v24, 0.5, -0.5 bitop3:0xa8
    v_cvt_pk_bf16_f32 v80, v80, v81
    v_cvt_pk_bf16_f32 v81, v82, v83
    ds_wrxchg_rtn_b64 v[74:75], v93, v[80:81] offset:65408
    v_cvt_pk_bf16_f32 v76, v76, v77
    v_cvt_pk_bf16_f32 v77, v78, v79
    ds_wrxchg_rtn_b64 v[72:73], v92, v[76:77] offset:65408
    s_setprio 1
    s_waitcnt lgkmcnt(2)
    v_mfma_f32_4x4x4_16b_bf16 v[80:83], v[8:9], v[106:107], 0
    v_mfma_f32_4x4x4_16b_bf16 v[76:79], v[8:9], v[104:105], 0
    v_bitop3_b32 v15, v6, v15, v46 bitop3:0xca
    v_bitop3_b32 v14, v6, v14, v47 bitop3:0xca
    s_nop 1
    v_pk_mul_f32 v[80:81], v[80:81], v[14:15] op_sel:[0,1] op_sel_hi:[1,1]
    v_pk_mul_f32 v[82:83], v[82:83], v[14:15] op_sel:[0,1] op_sel_hi:[1,1]
    v_pk_mul_f32 v[76:77], v[76:77], v[14:15] op_sel:[0,0] op_sel_hi:[1,0]
    v_pk_mul_f32 v[78:79], v[78:79], v[14:15] op_sel:[0,0] op_sel_hi:[1,0]
    v_and_b32 v47, 0x0fffffff, v41
    v_mov_b32 v27, v41
    buffer_load_dwordx2 v[22:23], v47, s[8:11], 0 offen
    buffer_load_dwordx3 v[24:26], v47, s[8:11], 0 offen offset:8
    s_waitcnt lgkmcnt(0)
    v_cmpx_ne_u64 vcc, v[74:75], v[70:71]
    s_and_b64 s[82:83], vcc, s[80:81]
    s_cbranch_scc1 L2_c126
L2_d126:
    v_mov_b64 v[84:85], v[70:71]
    v_mov_b32 v7, v93
    v_mov_b64 v[86:87], v[74:75]
    s_mov_b64 exec, -1
    s_or_b64 s[80:81], s[80:81], vcc
    v_cmpx_ne_u64 vcc, v[72:73], v[68:69]
    s_and_b64 s[82:83], vcc, s[80:81]
    s_cbranch_scc1 L2_c127
L2_d127:
    v_mov_b64 v[84:85], v[68:69]
    v_mov_b32 v7, v92
    v_mov_b64 v[86:87], v[72:73]
    s_mov_b64 exec, -1
    s_or_b64 s[80:81], s[80:81], vcc
    ds_read_b64 v[70:71], v95 offset:65408
    ds_read_b64 v[68:69], v94 offset:65408
    s_waitcnt vmcnt(11)
    v_and_b32 v46, 0x20000000, v33
    v_lshrrev_b32 v47, 14, v29
    v_bitop3_b32 v47, v47, v5, v46 bitop3:0xea
    ds_read_b64 v[102:103], v47
    v_bitop3_b32 v93, v29, v5, v46 bitop3:0xea
    v_and_b32 v46, 0x10000000, v33
    v_lshrrev_b32 v47, 14, v28
    v_bitop3_b32 v47, v47, v5, v46 bitop3:0xea
    ds_read_b64 v[100:101], v47
    v_bitop3_b32 v92, v28, v5, v46 bitop3:0xea
    s_waitcnt lgkmcnt(2)
    v_mfma_f32_4x4x4_16b_bf16 v[80:83], v[10:11], v[70:71], v[80:83]
    v_mfma_f32_4x4x4_16b_bf16 v[76:79], v[10:11], v[68:69], v[76:79]
    v_perm_b32 v15, v29, v32, s45
    v_bitop3_b32 v46, v29, 0.5, -0.5 bitop3:0xa8
    v_perm_b32 v14, v28, v32, s44
    v_bitop3_b32 v47, v28, 0.5, -0.5 bitop3:0xa8
    v_cvt_pk_bf16_f32 v80, v80, v81
    v_cvt_pk_bf16_f32 v81, v82, v83
    ds_wrxchg_rtn_b64 v[74:75], v95, v[80:81] offset:65408
    v_cvt_pk_bf16_f32 v76, v76, v77
    v_cvt_pk_bf16_f32 v77, v78, v79
    ds_wrxchg_rtn_b64 v[72:73], v94, v[76:77] offset:65408
    s_waitcnt lgkmcnt(2)
    v_mfma_f32_4x4x4_16b_bf16 v[80:83], v[8:9], v[102:103], 0
    v_mfma_f32_4x4x4_16b_bf16 v[76:79], v[8:9], v[100:101], 0
    v_bitop3_b32 v15, v6, v15, v46 bitop3:0xca
    v_bitop3_b32 v14, v6, v14, v47 bitop3:0xca
    v_cmp_lt_u32 s[84:85], v5, v92
    s_nop 0
    v_pk_mul_f32 v[80:81], v[80:81], v[14:15] op_sel:[0,1] op_sel_hi:[1,1]
    v_pk_mul_f32 v[82:83], v[82:83], v[14:15] op_sel:[0,1] op_sel_hi:[1,1]
    v_pk_mul_f32 v[76:77], v[76:77], v[14:15] op_sel:[0,0] op_sel_hi:[1,0]
    v_pk_mul_f32 v[78:79], v[78:79], v[14:15] op_sel:[0,0] op_sel_hi:[1,0]
    s_waitcnt lgkmcnt(0)
    v_cmpx_ne_u64 vcc, v[74:75], v[70:71]
    s_and_b64 s[82:83], vcc, s[80:81]
    s_cbranch_scc1 L2_c128
L2_d128:
    v_mov_b64 v[84:85], v[70:71]
    v_mov_b32 v7, v95
    v_mov_b64 v[86:87], v[74:75]
    s_mov_b64 exec, -1
    s_or_b64 s[80:81], s[80:81], vcc
    v_cmpx_ne_u64 vcc, v[72:73], v[68:69]
    s_and_b64 s[82:83], vcc, s[80:81]
    s_cbranch_scc1 L2_c129
L2_d129:
    v_mov_b64 v[84:85], v[68:69]
    v_mov_b32 v7, v94
    v_mov_b64 v[86:87], v[72:73]
    s_mov_b64 exec, -1
    s_or_b64 s[80:81], s[80:81], vcc
    ds_read_b64 v[70:71], v93 offset:65408
    s_and_b64 exec, s[84:85], s[80:81]
    v_mfma_f32_4x4x4_16b_bf16 v[76:79], v[12:13], v[84:85], 0
    v_mov_b32 v92, v7
    s_andn2_b64 s[80:81], s[80:81], s[84:85]
    v_mfma_f32_4x4x4_16b_bf16 v[76:79], v[10:11], v[86:87], v[76:79]
    s_mov_b64 exec, -1
    ds_read_b64 v[68:69], v92 offset:65408
    v_and_b32 v46, 0x80000000, v33
    v_lshrrev_b32 v47, 14, v31
    v_bitop3_b32 v47, v47, v5, v46 bitop3:0xea
    ds_read_b64 v[106:107], v47
    v_bitop3_b32 v95, v31, v5, v46 bitop3:0xea
    v_and_b32 v46, 0x40000000, v33
    v_lshrrev_b32 v47, 14, v30
    v_bitop3_b32 v47, v47, v5, v46 bitop3:0xea
    ds_read_b64 v[104:105], v47
    v_bitop3_b32 v94, v30, v5, v46 bitop3:0xea
    s_waitcnt lgkmcnt(2)
    v_mfma_f32_4x4x4_16b_bf16 v[80:83], v[10:11], v[70:71], v[80:83]
    v_mfma_f32_4x4x4_16b_bf16 v[76:79], v[10:11], v[68:69], v[76:79]
    v_perm_b32 v15, v31, v32, s47
    v_bitop3_b32 v46, v31, 0.5, -0.5 bitop3:0xa8
    v_perm_b32 v14, v30, v32, s46
    v_bitop3_b32 v47, v30, 0.5, -0.5 bitop3:0xa8
    v_cvt_pk_bf16_f32 v80, v80, v81
    v_cvt_pk_bf16_f32 v81, v82, v83
    ds_wrxchg_rtn_b64 v[74:75], v93, v[80:81] offset:65408
    v_cvt_pk_bf16_f32 v76, v76, v77
    v_cvt_pk_bf16_f32 v77, v78, v79
    ds_wrxchg_rtn_b64 v[72:73], v92, v[76:77] offset:65408
    s_setprio 0
    s_waitcnt lgkmcnt(2)
    v_mfma_f32_4x4x4_16b_bf16 v[80:83], v[8:9], v[106:107], 0
    v_mfma_f32_4x4x4_16b_bf16 v[76:79], v[8:9], v[104:105], 0
    v_bitop3_b32 v15, v6, v15, v46 bitop3:0xca
    v_bitop3_b32 v14, v6, v14, v47 bitop3:0xca
    s_nop 1
    v_pk_mul_f32 v[80:81], v[80:81], v[14:15] op_sel:[0,1] op_sel_hi:[1,1]
    v_pk_mul_f32 v[82:83], v[82:83], v[14:15] op_sel:[0,1] op_sel_hi:[1,1]
    v_pk_mul_f32 v[76:77], v[76:77], v[14:15] op_sel:[0,0] op_sel_hi:[1,0]
    v_pk_mul_f32 v[78:79], v[78:79], v[14:15] op_sel:[0,0] op_sel_hi:[1,0]
    s_add_u32 s40, s40, 0xfff24000
    v_and_b32 v47, 0x0fffffff, v42
    v_mov_b32 v33, v42
    buffer_load_dwordx2 v[28:29], v47, s[8:11], 0 offen
    buffer_load_dwordx3 v[30:32], v47, s[8:11], 0 offen offset:8
    s_waitcnt lgkmcnt(0)
    v_cmpx_ne_u64 vcc, v[74:75], v[70:71]
    s_and_b64 s[82:83], vcc, s[80:81]
    s_cbranch_scc1 L2_c130
L2_d130:
    v_mov_b64 v[84:85], v[70:71]
    v_mov_b32 v7, v93
    v_mov_b64 v[86:87], v[74:75]
    s_mov_b64 exec, -1
    s_or_b64 s[80:81], s[80:81], vcc
    v_cmpx_ne_u64 vcc, v[72:73], v[68:69]
    s_and_b64 s[82:83], vcc, s[80:81]
    s_cbranch_scc1 L2_c131
L2_d131:
    v_mov_b64 v[84:85], v[68:69]
    v_mov_b32 v7, v92
    v_mov_b64 v[86:87], v[72:73]
    s_mov_b64 exec, -1
    s_or_b64 s[80:81], s[80:81], vcc
    ds_read_b64 v[70:71], v95 offset:65408
    ds_read_b64 v[68:69], v94 offset:65408
    s_waitcnt vmcnt(8)
    v_and_b32 v46, 0x20000000, v39
    v_lshrrev_b32 v47, 14, v35
    v_bitop3_b32 v47, v47, v5, v46 bitop3:0xea
    ds_read_b64 v[102:103], v47
    v_bitop3_b32 v93, v35, v5, v46 bitop3:0xea
    v_and_b32 v46, 0x10000000, v39
    v_lshrrev_b32 v47, 14, v34
    v_bitop3_b32 v47, v47, v5, v46 bitop3:0xea
    ds_read_b64 v[100:101], v47
    v_bitop3_b32 v92, v34, v5, v46 bitop3:0xea
    v_and_b32 v46, 0x80000000, v39
    v_lshrrev_b32 v47, 14, v37
    v_bitop3_b32 v47, v47, v5, v46 bitop3:0xea
    ds_read_b64 v[106:107], v47
    v_and_b32 v46, 0x40000000, v39
    v_lshrrev_b32 v47, 14, v36
    v_bitop3_b32 v47, v47, v5, v46 bitop3:0xea
    ds_read_b64 v[104:105], v47
    s_waitcnt lgkmcnt(4)
    v_mfma_f32_4x4x4_16b_bf16 v[80:83], v[10:11], v[70:71], v[80:83]
    v_mfma_f32_4x4x4_16b_bf16 v[76:79], v[10:11], v[68:69], v[76:79]
    v_perm_b32 v15, v35, v38, s45
    v_bitop3_b32 v46, v35, 0.5, -0.5 bitop3:0xa8
    v_perm_b32 v14, v34, v38, s44
    v_bitop3_b32 v47, v34, 0.5, -0.5 bitop3:0xa8
    v_cvt_pk_bf16_f32 v80, v80, v81
    v_cvt_pk_bf16_f32 v81, v82, v83
    ds_wrxchg_rtn_b64 v[74:75], v95, v[80:81] offset:65408
    v_cvt_pk_bf16_f32 v76, v76, v77
    v_cvt_pk_bf16_f32 v77, v78, v79
    ds_wrxchg_rtn_b64 v[72:73], v94, v[76:77] offset:65408
    s_waitcnt lgkmcnt(2)
    s_barrier
    s_setprio 3
    s_mov_b32 m0, s100
    s_nop 0
    ds_write_addtid_b32 v116 offset:32768
    ds_write_addtid_b32 v117 offset:33024
    ds_write_addtid_b32 v118 offset:33280
    ds_write_addtid_b32 v119 offset:33536
    ds_write_addtid_b32 v120 offset:33792
    ds_write_addtid_b32 v121 offset:34048
    ds_write_addtid_b32 v122 offset:34304
    ds_write_addtid_b32 v123 offset:34560
    v_mfma_f32_4x4x4_16b_bf16 v[80:83], v[8:9], v[102:103], 0
    v_mfma_f32_4x4x4_16b_bf16 v[76:79], v[8:9], v[100:101], 0
    v_bitop3_b32 v15, v6, v15, v46 bitop3:0xca
    v_bitop3_b32 v14, v6, v14, v47 bitop3:0xca
    v_cmp_lt_u32 s[84:85], v5, v92
    s_nop 0
    v_pk_mul_f32 v[80:81], v[80:81], v[14:15] op_sel:[0,1] op_sel_hi:[1,1]
    v_pk_mul_f32 v[82:83], v[82:83], v[14:15] op_sel:[0,1] op_sel_hi:[1,1]
    v_pk_mul_f32 v[76:77], v[76:77], v[14:15] op_sel:[0,0] op_sel_hi:[1,0]
    v_pk_mul_f32 v[78:79], v[78:79], v[14:15] op_sel:[0,0] op_sel_hi:[1,0]
    v_mov_b32 v44, v43
    s_setprio 2
    ds_write_addtid_b32 v124 offset:34816
    ds_write_addtid_b32 v125 offset:35072
    ds_write_addtid_b32 v126 offset:35328
    ds_write_addtid_b32 v127 offset:35584
    s_waitcnt lgkmcnt(12)
    v_cmpx_ne_u64 vcc, v[74:75], v[70:71]
    s_and_b64 s[82:83], vcc, s[80:81]
    s_cbranch_scc1 L2_c132
L2_d132:
    v_mov_b64 v[84:85], v[70:71]
    v_mov_b32 v7, v95
    v_mov_b64 v[86:87], v[74:75]
    s_mov_b64 exec, -1
    s_or_b64 s[80:81], s[80:81], vcc
    v_cmpx_ne_u64 vcc, v[72:73], v[68:69]
    s_and_b64 s[82:83], vcc, s[80:81]
    s_cbranch_scc1 L2_c133
L2_d133:
    v_mov_b64 v[84:85], v[68:69]
    v_mov_b32 v7, v94
    v_mov_b64 v[86:87], v[72:73]
    s_mov_b64 exec, -1
    s_or_b64 s[80:81], s[80:81], vcc
    ds_read_b64 v[70:71], v93 offset:65408
    s_and_b64 exec, s[84:85], s[80:81]
    v_mfma_f32_4x4x4_16b_bf16 v[76:79], v[12:13], v[84:85], 0
    v_mov_b32 v92, v7
    s_andn2_b64 s[80:81], s[80:81], s[84:85]
    v_mfma_f32_4x4x4_16b_bf16 v[76:79], v[10:11], v[86:87], v[76:79]
    s_mov_b64 exec, -1
    ds_read_b64 v[68:69], v92 offset:65408
    s_setprio 1
    s_waitcnt vmcnt(7)
    s_mov_b32 m0, s38
    s_nop 0
    ds_write_addtid_b32 v108 offset:0
    ds_write_addtid_b32 v109 offset:256
    ds_write_addtid_b32 v110 offset:512
    ds_write_addtid_b32 v111 offset:768
    s_waitcnt lgkmcnt(4)
    v_mfma_f32_4x4x4_16b_bf16 v[80:83], v[10:11], v[70:71], v[80:83]
    v_mfma_f32_4x4x4_16b_bf16 v[76:79], v[10:11], v[68:69], v[76:79]
    v_and_b32 v46, 0x40000000, v39
    v_bitop3_b32 v94, v36, v5, v46 bitop3:0xea
    v_and_b32 v46, 0x80000000, v39
    v_bitop3_b32 v95, v37, v5, v46 bitop3:0xea
    v_perm_b32 v15, v37, v38, s47
    v_bitop3_b32 v46, v37, 0.5, -0.5 bitop3:0xa8
    v_perm_b32 v14, v36, v38, s46
    v_bitop3_b32 v47, v36, 0.5, -0.5 bitop3:0xa8
    v_cvt_pk_bf16_f32 v80, v80, v81
    v_cvt_pk_bf16_f32 v81, v82, v83
    ds_wrxchg_rtn_b64 v[74:75], v93, v[80:81] offset:65408
    v_cvt_pk_bf16_f32 v76, v76, v77
    v_cvt_pk_bf16_f32 v77, v78, v79
    ds_wrxchg_rtn_b64 v[72:73], v92, v[76:77] offset:65408
    s_setprio 0
    s_waitcnt vmcnt(4)
    ds_write_addtid_b32 v112 offset:1024
    ds_write_addtid_b32 v113 offset:1280
    ds_write_addtid_b32 v114 offset:1536
    ds_write_addtid_b32 v115 offset:1792
    v_mfma_f32_4x4x4_16b_bf16 v[80:83], v[8:9], v[106:107], 0
    v_mfma_f32_4x4x4_16b_bf16 v[76:79], v[8:9], v[104:105], 0
    v_bitop3_b32 v15, v6, v15, v46 bitop3:0xca
    v_bitop3_b32 v14, v6, v14, v47 bitop3:0xca
    s_nop 1
    v_pk_mul_f32 v[80:81], v[80:81], v[14:15] op_sel:[0,1] op_sel_hi:[1,1]
    v_pk_mul_f32 v[82:83], v[82:83], v[14:15] op_sel:[0,1] op_sel_hi:[1,1]
    v_pk_mul_f32 v[76:77], v[76:77], v[14:15] op_sel:[0,0] op_sel_hi:[1,0]
    v_pk_mul_f32 v[78:79], v[78:79], v[14:15] op_sel:[0,0] op_sel_hi:[1,0]
    s_add_u32 s42, s42, 1
    s_waitcnt lgkmcnt(0)
    s_barrier
    s_bitcmp1_b32 s36, s42
    s_cbranch_scc1 L2_slow
L2_ret7:
    s_setprio 3
    v_and_b32 v47, 0x0fffffff, v44
    v_mov_b32 v39, v44
    buffer_load_dwordx2 v[34:35], v47, s[8:11], 0 offen
    buffer_load_dwordx3 v[36:38], v47, s[8:11], 0 offen offset:8
    v_cmpx_ne_u64 vcc, v[74:75], v[70:71]
    s_and_b64 s[82:83], vcc, s[80:81]
    s_cbranch_scc1 L2_c134
L2_d134:
    v_mov_b64 v[84:85], v[70:71]
    v_mov_b32 v7, v93
    v_mov_b64 v[86:87], v[74:75]
    s_mov_b64 exec, -1
    s_or_b64 s[80:81], s[80:81], vcc
    v_cmpx_ne_u64 vcc, v[72:73], v[68:69]
    s_and_b64 s[82:83], vcc, s[80:81]
    s_cbranch_scc1 L2_c135
L2_d135:
    v_mov_b64 v[84:85], v[68:69]
    v_mov_b32 v7, v92
    v_mov_b64 v[86:87], v[72:73]
    s_mov_b64 exec, -1
    s_or_b64 s[80:81], s[80:81], vcc
    ds_read_b64 v[70:71], v95 offset:65408
    ds_read_b64 v[68:69], v94 offset:65408
    v_and_b32 v46, 0x20000000, v21
    v_lshrrev_b32 v47, 14, v17
    v_bitop3_b32 v47, v47, v5, v46 bitop3:0xea
    ds_read_b64 v[102:103], v47
    v_bitop3_b32 v93, v17, v5, v46 bitop3:0xea
    v_and_b32 v46, 0x10000000, v21
    v_lshrrev_b32 v47, 14, v16
    v_bitop3_b32 v47, v47, v5, v46 bitop3:0xea
    ds_read_b64 v[100:101], v47
    v_bitop3_b32 v92, v16, v5, v46 bitop3:0xea
    s_waitcnt lgkmcnt(2)
    v_mfma_f32_4x4x4_16b_bf16 v[80:83], v[10:11], v[70:71], v[80:83]
    v_mfma_f32_4x4x4_16b_bf16 v[76:79], v[10:11], v[68:69], v[76:79]
    v_perm_b32 v15, v17, v20, s45
    v_bitop3_b32 v46, v17, 0.5, -0.5 bitop3:0xa8
    v_perm_b32 v14, v16, v20, s44
    v_bitop3_b32 v47, v16, 0.5, -0.5 bitop3:0xa8
    v_cvt_pk_bf16_f32 v80, v80, v81
    v_cvt_pk_bf16_f32 v81, v82, v83
    ds_wrxchg_rtn_b64 v[74:75], v95, v[80:81] offset:65408
    v_cvt_pk_bf16_f32 v76, v76, v77
    v_cvt_pk_bf16_f32 v77, v78, v79
    ds_wrxchg_rtn_b64 v[72:73], v94, v[76:77] offset:65408
    s_waitcnt lgkmcnt(2)
    v_mfma_f32_4x4x4_16b_bf16 v[80:83], v[8:9], v[102:103], 0
    v_mfma_f32_4x4x4_16b_bf16 v[76:79], v[8:9], v[100:101], 0
    v_bitop3_b32 v15, v6, v15, v46 bitop3:0xca
    v_bitop3_b32 v14, v6, v14, v47 bitop3:0xca
    v_cmp_lt_u32 s[84:85], v5, v92
    s_nop 0
    v_pk_mul_f32 v[80:81], v[80:81], v[14:15] op_sel:[0,1] op_sel_hi:[1,1]
    v_pk_mul_f32 v[82:83], v[82:83], v[14:15] op_sel:[0,1] op_sel_hi:[1,1]
    v_pk_mul_f32 v[76:77], v[76:77], v[14:15] op_sel:[0,0] op_sel_hi:[1,0]
    v_pk_mul_f32 v[78:79], v[78:79], v[14:15] op_sel:[0,0] op_sel_hi:[1,0]
    s_waitcnt lgkmcnt(0)
    v_cmpx_ne_u64 vcc, v[74:75], v[70:71]
    s_and_b64 s[82:83], vcc, s[80:81]
    s_cbranch_scc1 L2_c136
L2_d136:
    v_mov_b64 v[84:85], v[70:71]
    v_mov_b32 v7, v95
    v_mov_b64 v[86:87], v[74:75]
    s_mov_b64 exec, -1
    s_or_b64 s[80:81], s[80:81], vcc
    v_cmpx_ne_u64 vcc, v[72:73], v[68:69]
    s_and_b64 s[82:83], vcc, s[80:81]
    s_cbranch_scc1 L2_c137
L2_d137:
    v_mov_b64 v[84:85], v[68:69]
    v_mov_b32 v7, v94
    v_mov_b64 v[86:87], v[72:73]
    s_mov_b64 exec, -1
    s_or_b64 s[80:81], s[80:81], vcc
    ds_read_b64 v[70:71], v93 offset:65408
    s_and_b64 exec, s[84:85], s[80:81]
    v_mfma_f32_4x4x4_16b_bf16 v[76:79], v[12:13], v[84:85], 0
    v_mov_b32 v92, v7
    s_andn2_b64 s[80:81], s[80:81], s[84:85]
    v_mfma_f32_4x4x4_16b_bf16 v[76:79], v[10:11], v[86:87], v[76:79]
    s_mov_b64 exec, -1
    ds_read_b64 v[68:69], v92 offset:65408
    v_and_b32 v46, 0x80000000, v21
    v_lshrrev_b32 v47, 14, v19
    v_bitop3_b32 v47, v47, v5, v46 bitop3:0xea
    ds_read_b64 v[106:107], v47
    v_bitop3_b32 v95, v19, v5, v46 bitop3:0xea
    v_and_b32 v46, 0x40000000, v21
    v_lshrrev_b32 v47, 14, v18
    v_bitop3_b32 v47, v47, v5, v46 bitop3:0xea
    ds_read_b64 v[104:105], v47
    v_bitop3_b32 v94, v18, v5, v46 bitop3:0xea
    s_waitcnt lgkmcnt(2)
    v_mfma_f32_4x4x4_16b_bf16 v[80:83], v[10:11], v[70:71], v[80:83]
    v_mfma_f32_4x4x4_16b_bf16 v[76:79], v[10:11], v[68:69], v[76:79]
    v_perm_b32 v15, v19, v20, s47
    v_bitop3_b32 v46, v19, 0.5, -0.5 bitop3:0xa8
    v_perm_b32 v14, v18, v20, s46
    v_bitop3_b32 v47, v18, 0.5, -0.5 bitop3:0xa8
    v_cvt_pk_bf16_f32 v80, v80, v81
    v_cvt_pk_bf16_f32 v81, v82, v83
    ds_wrxchg_rtn_b64 v[74:75], v93, v[80:81] offset:65408
    v_cvt_pk_bf16_f32 v76, v76, v77
    v_cvt_pk_bf16_f32 v77, v78, v79
    ds_wrxchg_rtn_b64 v[72:73], v92, v[76:77] offset:65408
    s_setprio 2
    s_waitcnt lgkmcnt(2)
    v_mfma_f32_4x4x4_16b_bf16 v[80:83], v[8:9], v[106:107], 0
    v_mfma_f32_4x4x4_16b_bf16 v[76:79], v[8:9], v[104:105], 0
    v_bitop3_b32 v15, v6, v15, v46 bitop3:0xca
    v_bitop3_b32 v14, v6, v14, v47 bitop3:0xca
    s_nop 1
    v_pk_mul_f32 v[80:81], v[80:81], v[14:15] op_sel:[0,1] op_sel_hi:[1,1]
    v_pk_mul_f32 v[82:83], v[82:83], v[14:15] op_sel:[0,1] op_sel_hi:[1,1]
    v_pk_mul_f32 v[76:77], v[76:77], v[14:15] op_sel:[0,0] op_sel_hi:[1,0]
    v_pk_mul_f32 v[78:79], v[78:79], v[14:15] op_sel:[0,0] op_sel_hi:[1,0]
    s_lshl_b32 s3, s32, 12
    v_subrev_u32 v122, s3, v3
    s_mul_i32 s3, s33, 20000
    v_add_u32 v118, s3, v122
    v_add_u32 v119, 0x4000, v118
    s_lshl_b32 s3, s34, 7
    v_lshrrev_b32 v123, 7, v118
    v_and_b32 v120, 0x70, v118
    v_lshl_add_u32 v120, v123, 13, v120
    v_add_u32 v120, s3, v120
    v_lshrrev_b32 v123, 7, v119
    v_and_b32 v121, 0x70, v119
    v_lshl_add_u32 v121, v123, 13, v121
    v_add_u32 v121, s3, v121
    v_cmp_le_u32 vcc, 3616, v122
    s_mov_b64 exec, vcc
    v_mov_b32 v119, 2.0
    v_mov_b32 v121, 2.0
    s_mov_b64 exec, -1
    v_and_b32 v123, 0x30, v122
    v_lshlrev_b32 v123, 2, v123
    buffer_load_dwordx4 v[48:51], v123, s[24:27], 0 offen
    buffer_load_dwordx4 v[52:55], v123, s[24:27], 0 offen offset:16
    buffer_load_dwordx2 v[56:57], v123, s[24:27], 0 offen offset:32
    s_mov_b32 s12, s4
    s_mov_b32 s13, s5
    s_mov_b32 s14, 0x138800
    s_mov_b32 s15, 0x20000
    s_mov_b32 s16, s28
    s_mov_b32 s17, s29
    s_mov_b32 s18, 0x4e2000
    s_mov_b32 s19, 0x20000
    v_lshrrev_b32 v123, 2, v120
    buffer_load_dword v116, v123, s[12:15], 0 offen
    buffer_load_dwordx4 v[108:111], v120, s[16:19], 0 offen
    v_lshrrev_b32 v123, 2, v121
    buffer_load_dword v117, v123, s[12:15], 0 offen
    buffer_load_dwordx4 v[112:115], v121, s[16:19], 0 offen
    s_waitcnt lgkmcnt(0)
    v_cmpx_ne_u64 vcc, v[74:75], v[70:71]
    s_and_b64 s[82:83], vcc, s[80:81]
    s_cbranch_scc1 L2_c138
L2_d138:
    v_mov_b64 v[84:85], v[70:71]
    v_mov_b32 v7, v93
    v_mov_b64 v[86:87], v[74:75]
    s_mov_b64 exec, -1
    s_or_b64 s[80:81], s[80:81], vcc
    v_cmpx_ne_u64 vcc, v[72:73], v[68:69]
    s_and_b64 s[82:83], vcc, s[80:81]
    s_cbranch_scc1 L2_c139
L2_d139:
    v_mov_b64 v[84:85], v[68:69]
    v_mov_b32 v7, v92
    v_mov_b64 v[86:87], v[72:73]
    s_mov_b64 exec, -1
    s_or_b64 s[80:81], s[80:81], vcc
    ds_read_b64 v[70:71], v95 offset:65408
    ds_read_b64 v[68:69], v94 offset:65408
    s_waitcnt vmcnt(11)
    v_and_b32 v46, 0x20000000, v27
    v_lshrrev_b32 v47, 14, v23
    v_bitop3_b32 v47, v47, v5, v46 bitop3:0xea
    ds_read_b64 v[102:103], v47
    v_bitop3_b32 v93, v23, v5, v46 bitop3:0xea
    v_and_b32 v46, 0x10000000, v27
    v_lshrrev_b32 v47, 14, v22
    v_bitop3_b32 v47, v47, v5, v46 bitop3:0xea
    ds_read_b64 v[100:101], v47
    v_bitop3_b32 v92, v22, v5, v46 bitop3:0xea
    s_waitcnt lgkmcnt(2)
    v_mfma_f32_4x4x4_16b_bf16 v[80:83], v[10:11], v[70:71], v[80:83]
    v_mfma_f32_4x4x4_16b_bf16 v[76:79], v[10:11], v[68:69], v[76:79]
    v_perm_b32 v15, v23, v26, s45
    v_bitop3_b32 v46, v23, 0.5, -0.5 bitop3:0xa8
    v_perm_b32 v14, v22, v26, s44
    v_bitop3_b32 v47, v22, 0.5, -0.5 bitop3:0xa8
    v_cvt_pk_bf16_f32 v80, v80, v81
    v_cvt_pk_bf16_f32 v81, v82, v83
    ds_wrxchg_rtn_b64 v[74:75], v95, v[80:81] offset:65408
    v_cvt_pk_bf16_f32 v76, v76, v77
    v_cvt_pk_bf16_f32 v77, v78, v79
    ds_wrxchg_rtn_b64 v[72:73], v94, v[76:77] offset:65408
    s_waitcnt lgkmcnt(2)
    v_mfma_f32_4x4x4_16b_bf16 v[80:83], v[8:9], v[102:103], 0
    v_mfma_f32_4x4x4_16b_bf16 v[76:79], v[8:9], v[100:101], 0
    v_bitop3_b32 v15, v6, v15, v46 bitop3:0xca
    v_bitop3_b32 v14, v6, v14, v47 bitop3:0xca
    v_cmp_lt_u32 s[84:85], v5, v92
    s_nop 0
    v_pk_mul_f32 v[80:81], v[80:81], v[14:15] op_sel:[0,1] op_sel_hi:[1,1]
    v_pk_mul_f32 v[82:83], v[82:83], v[14:15] op_sel:[0,1] op_sel_hi:[1,1]
    v_pk_mul_f32 v[76:77], v[76:77], v[14:15] op_sel:[0,0] op_sel_hi:[1,0]
    v_pk_mul_f32 v[78:79], v[78:79], v[14:15] op_sel:[0,0] op_sel_hi:[1,0]
    s_waitcnt lgkmcnt(0)
    v_cmpx_ne_u64 vcc, v[74:75], v[70:71]
    s_and_b64 s[82:83], vcc, s[80:81]
    s_cbranch_scc1 L2_c140
L2_d140:
    v_mov_b64 v[84:85], v[70:71]
    v_mov_b32 v7, v95
    v_mov_b64 v[86:87], v[74:75]
    s_mov_b64 exec, -1
    s_or_b64 s[80:81], s[80:81], vcc
    v_cmpx_ne_u64 vcc, v[72:73], v[68:69]
    s_and_b64 s[82:83], vcc, s[80:81]
    s_cbranch_scc1 L2_c141
L2_d141:
    v_mov_b64 v[84:85], v[68:69]
    v_mov_b32 v7, v94
    v_mov_b64 v[86:87], v[72:73]
    s_mov_b64 exec, -1
    s_or_b64 s[80:81], s[80:81], vcc
    ds_read_b64 v[70:71], v93 offset:65408
    s_and_b64 exec, s[84:85], s[80:81]
    v_mfma_f32_4x4x4_16b_bf16 v[76:79], v[12:13], v[84:85], 0
    v_mov_b32 v92, v7
    s_andn2_b64 s[80:81], s[80:81], s[84:85]
    v_mfma_f32_4x4x4_16b_bf16 v[76:79], v[10:11], v[86:87], v[76:79]
    s_mov_b64 exec, -1
    ds_read_b64 v[68:69], v92 offset:65408
    v_and_b32 v46, 0x80000000, v27
    v_lshrrev_b32 v47, 14, v25
    v_bitop3_b32 v47, v47, v5, v46 bitop3:0xea
    ds_read_b64 v[106:107], v47
    v_bitop3_b32 v95, v25, v5, v46 bitop3:0xea
    v_and_b32 v46, 0x40000000, v27
    v_lshrrev_b32 v47, 14, v24
    v_bitop3_b32 v47, v47, v5, v46 bitop3:0xea
    ds_read_b64 v[104:105], v47
    v_bitop3_b32 v94, v24, v5, v46 bitop3:0xea
    s_waitcnt lgkmcnt(2)
    v_mfma_f32_4x4x4_16b_bf16 v[80:83], v[10:11], v[70:71], v[80:83]
    v_mfma_f32_4x4x4_16b_bf16 v[76:79], v[10:11], v[68:69], v[76:79]
    v_perm_b32 v15, v25, v26, s47
    v_bitop3_b32 v46, v25, 0.5, -0.5 bitop3:0xa8
    v_perm_b32 v14, v24, v26, s46
    v_bitop3_b32 v47, v24, 0.5, -0.5 bitop3:0xa8
    v_cvt_pk_bf16_f32 v80, v80, v81
    v_cvt_pk_bf16_f32 v81, v82, v83
    ds_wrxchg_rtn_b64 v[74:75], v93, v[80:81] offset:65408
    v_cvt_pk_bf16_f32 v76, v76, v77
    v_cvt_pk_bf16_f32 v77, v78, v79
    ds_wrxchg_rtn_b64 v[72:73], v92, v[76:77] offset:65408
    s_setprio 1
    s_waitcnt lgkmcnt(2)
    v_mfma_f32_4x4x4_16b_bf16 v[80:83], v[8:9], v[106:107], 0
    v_mfma_f32_4x4x4_16b_bf16 v[76:79], v[8:9], v[104:105], 0
    v_bitop3_b32 v15, v6, v15, v46 bitop3:0xca
    v_bitop3_b32 v14, v6, v14, v47 bitop3:0xca
    s_nop 1
    v_pk_mul_f32 v[80:81], v[80:81], v[14:15] op_sel:[0,1] op_sel_hi:[1,1]
    v_pk_mul_f32 v[82:83], v[82:83], v[14:15] op_sel:[0,1] op_sel_hi:[1,1]
    v_pk_mul_f32 v[76:77], v[76:77], v[14:15] op_sel:[0,0] op_sel_hi:[1,0]
    v_pk_mul_f32 v[78:79], v[78:79], v[14:15] op_sel:[0,0] op_sel_hi:[1,0]
    s_waitcnt lgkmcnt(0)
    v_cmpx_ne_u64 vcc, v[74:75], v[70:71]
    s_and_b64 s[82:83], vcc, s[80:81]
    s_cbranch_scc1 L2_c142
L2_d142:
    v_mov_b64 v[84:85], v[70:71]
    v_mov_b32 v7, v93
    v_mov_b64 v[86:87], v[74:75]
    s_mov_b64 exec, -1
    s_or_b64 s[80:81], s[80:81], vcc
    v_cmpx_ne_u64 vcc, v[72:73], v[68:69]
    s_and_b64 s[82:83], vcc, s[80:81]
    s_cbranch_scc1 L2_c143
L2_d143:
    v_mov_b64 v[84:85], v[68:69]
    v_mov_b32 v7, v92
    v_mov_b64 v[86:87], v[72:73]
    s_mov_b64 exec, -1
    s_or_b64 s[80:81], s[80:81], vcc
    ds_read_b64 v[70:71], v95 offset:65408
    ds_read_b64 v[68:69], v94 offset:65408
    s_waitcnt vmcnt(9)
    v_and_b32 v46, 0x20000000, v33
    v_lshrrev_b32 v47, 14, v29
    v_bitop3_b32 v47, v47, v5, v46 bitop3:0xea
    ds_read_b64 v[102:103], v47
    v_bitop3_b32 v93, v29, v5, v46 bitop3:0xea
    v_and_b32 v46, 0x10000000, v33
    v_lshrrev_b32 v47, 14, v28
    v_bitop3_b32 v47, v47, v5, v46 bitop3:0xea
    ds_read_b64 v[100:101], v47
    v_bitop3_b32 v92, v28, v5, v46 bitop3:0xea
    s_waitcnt lgkmcnt(2)
    v_mfma_f32_4x4x4_16b_bf16 v[80:83], v[10:11], v[70:71], v[80:83]
    v_mfma_f32_4x4x4_16b_bf16 v[76:79], v[10:11], v[68:69], v[76:79]
    v_perm_b32 v15, v29, v32, s45
    v_bitop3_b32 v46, v29, 0.5, -0.5 bitop3:0xa8
    v_perm_b32 v14, v28, v32, s44
    v_bitop3_b32 v47, v28, 0.5, -0.5 bitop3:0xa8
    v_cvt_pk_bf16_f32 v80, v80, v81
    v_cvt_pk_bf16_f32 v81, v82, v83
    ds_wrxchg_rtn_b64 v[74:75], v95, v[80:81] offset:65408
    v_cvt_pk_bf16_f32 v76, v76, v77
    v_cvt_pk_bf16_f32 v77, v78, v79
    ds_wrxchg_rtn_b64 v[72:73], v94, v[76:77] offset:65408
    s_waitcnt lgkmcnt(2)
    v_mfma_f32_4x4x4_16b_bf16 v[80:83], v[8:9], v[102:103], 0
    v_mfma_f32_4x4x4_16b_bf16 v[76:79], v[8:9], v[100:101], 0
    v_bitop3_b32 v15, v6, v15, v46 bitop3:0xca
    v_bitop3_b32 v14, v6, v14, v47 bitop3:0xca
    v_cmp_lt_u32 s[84:85], v5, v92
    s_nop 0
    v_pk_mul_f32 v[80:81], v[80:81], v[14:15] op_sel:[0,1] op_sel_hi:[1,1]
    v_pk_mul_f32 v[82:83], v[82:83], v[14:15] op_sel:[0,1] op_sel_hi:[1,1]
    v_pk_mul_f32 v[76:77], v[76:77], v[14:15] op_sel:[0,0] op_sel_hi:[1,0]
    v_pk_mul_f32 v[78:79], v[78:79], v[14:15] op_sel:[0,0] op_sel_hi:[1,0]
    s_waitcnt lgkmcnt(0)
    v_cmpx_ne_u64 vcc, v[74:75], v[70:71]
    s_and_b64 s[82:83], vcc, s[80:81]
    s_cbranch_scc1 L2_c144
L2_d144:
    v_mov_b64 v[84:85], v[70:71]
    v_mov_b32 v7, v95
    v_mov_b64 v[86:87], v[74:75]
    s_mov_b64 exec, -1
    s_or_b64 s[80:81], s[80:81], vcc
    v_cmpx_ne_u64 vcc, v[72:73], v[68:69]
    s_and_b64 s[82:83], vcc, s[80:81]
    s_cbranch_scc1 L2_c145
L2_d145:
    v_mov_b64 v[84:85], v[68:69]
    v_mov_b32 v7, v94
    v_mov_b64 v[86:87], v[72:73]
    s_mov_b64 exec, -1
    s_or_b64 s[80:81], s[80:81], vcc
    ds_read_b64 v[70:71], v93 offset:65408
    s_and_b64 exec, s[84:85], s[80:81]
    v_mfma_f32_4x4x4_16b_bf16 v[76:79], v[12:13], v[84:85], 0
    v_mov_b32 v92, v7
    s_andn2_b64 s[80:81], s[80:81], s[84:85]
    v_mfma_f32_4x4x4_16b_bf16 v[76:79], v[10:11], v[86:87], v[76:79]
    s_mov_b64 exec, -1
    ds_read_b64 v[68:69], v92 offset:65408
    v_and_b32 v46, 0x80000000, v33
    v_lshrrev_b32 v47, 14, v31
    v_bitop3_b32 v47, v47, v5, v46 bitop3:0xea
    ds_read_b64 v[106:107], v47
    v_bitop3_b32 v95, v31, v5, v46 bitop3:0xea
    v_and_b32 v46, 0x40000000, v33
    v_lshrrev_b32 v47, 14, v30
    v_bitop3_b32 v47, v47, v5, v46 bitop3:0xea
    ds_read_b64 v[104:105], v47
    v_bitop3_b32 v94, v30, v5, v46 bitop3:0xea
    s_waitcnt lgkmcnt(2)
    v_mfma_f32_4x4x4_16b_bf16 v[80:83], v[10:11], v[70:71], v[80:83]
    v_mfma_f32_4x4x4_16b_bf16 v[76:79], v[10:11], v[68:69], v[76:79]
    v_perm_b32 v15, v31, v32, s47
    v_bitop3_b32 v46, v31, 0.5, -0.5 bitop3:0xa8
    v_perm_b32 v14, v30, v32, s46
    v_bitop3_b32 v47, v30, 0.5, -0.5 bitop3:0xa8
    v_cvt_pk_bf16_f32 v80, v80, v81
    v_cvt_pk_bf16_f32 v81, v82, v83
    ds_wrxchg_rtn_b64 v[74:75], v93, v[80:81] offset:65408
    v_cvt_pk_bf16_f32 v76, v76, v77
    v_cvt_pk_bf16_f32 v77, v78, v79
    ds_wrxchg_rtn_b64 v[72:73], v92, v[76:77] offset:65408
    s_setprio 0
    s_waitcnt lgkmcnt(2)
    v_mfma_f32_4x4x4_16b_bf16 v[80:83], v[8:9], v[106:107], 0
    v_mfma_f32_4x4x4_16b_bf16 v[76:79], v[8:9], v[104:105], 0
    v_bitop3_b32 v15, v6, v15, v46 bitop3:0xca
    v_bitop3_b32 v14, v6, v14, v47 bitop3:0xca
    s_nop 1
    v_pk_mul_f32 v[80:81], v[80:81], v[14:15] op_sel:[0,1] op_sel_hi:[1,1]
    v_pk_mul_f32 v[82:83], v[82:83], v[14:15] op_sel:[0,1] op_sel_hi:[1,1]
    v_pk_mul_f32 v[76:77], v[76:77], v[14:15] op_sel:[0,0] op_sel_hi:[1,0]
    v_pk_mul_f32 v[78:79], v[78:79], v[14:15] op_sel:[0,0] op_sel_hi:[1,0]
    s_waitcnt lgkmcnt(0)
    v_cmpx_ne_u64 vcc, v[74:75], v[70:71]
    s_and_b64 s[82:83], vcc, s[80:81]
    s_cbranch_scc1 L2_c146
L2_d146:
    v_mov_b64 v[84:85], v[70:71]
    v_mov_b32 v7, v93
    v_mov_b64 v[86:87], v[74:75]
    s_mov_b64 exec, -1
    s_or_b64 s[80:81], s[80:81], vcc
    v_cmpx_ne_u64 vcc, v[72:73], v[68:69]
    s_and_b64 s[82:83], vcc, s[80:81]
    s_cbranch_scc1 L2_c147
L2_d147:
    v_mov_b64 v[84:85], v[68:69]
    v_mov_b32 v7, v92
    v_mov_b64 v[86:87], v[72:73]
    s_mov_b64 exec, -1
    s_or_b64 s[80:81], s[80:81], vcc
    ds_read_b64 v[70:71], v95 offset:65408
    ds_read_b64 v[68:69], v94 offset:65408
    s_waitcnt vmcnt(7)
    v_and_b32 v46, 0x20000000, v39
    v_lshrrev_b32 v47, 14, v35
    v_bitop3_b32 v47, v47, v5, v46 bitop3:0xea
    ds_read_b64 v[102:103], v47
    v_bitop3_b32 v93, v35, v5, v46 bitop3:0xea
    v_and_b32 v46, 0x10000000, v39
    v_lshrrev_b32 v47, 14, v34
    v_bitop3_b32 v47, v47, v5, v46 bitop3:0xea
    ds_read_b64 v[100:101], v47
    v_bitop3_b32 v92, v34, v5, v46 bitop3:0xea
    v_and_b32 v46, 0x80000000, v39
    v_lshrrev_b32 v47, 14, v37
    v_bitop3_b32 v47, v47, v5, v46 bitop3:0xea
    ds_read_b64 v[106:107], v47
    v_and_b32 v46, 0x40000000, v39
    v_lshrrev_b32 v47, 14, v36
    v_bitop3_b32 v47, v47, v5, v46 bitop3:0xea
    ds_read_b64 v[104:105], v47
    s_waitcnt lgkmcnt(4)
    v_mfma_f32_4x4x4_16b_bf16 v[80:83], v[10:11], v[70:71], v[80:83]
    v_mfma_f32_4x4x4_16b_bf16 v[76:79], v[10:11], v[68:69], v[76:79]
    v_perm_b32 v15, v35, v38, s45
    v_bitop3_b32 v46, v35, 0.5, -0.5 bitop3:0xa8
    v_perm_b32 v14, v34, v38, s44
    v_bitop3_b32 v47, v34, 0.5, -0.5 bitop3:0xa8
    v_cvt_pk_bf16_f32 v80, v80, v81
    v_cvt_pk_bf16_f32 v81, v82, v83
    ds_wrxchg_rtn_b64 v[74:75], v95, v[80:81] offset:65408
    v_cvt_pk_bf16_f32 v76, v76, v77
    v_cvt_pk_bf16_f32 v77, v78, v79
    ds_wrxchg_rtn_b64 v[72:73], v94, v[76:77] offset:65408
    s_waitcnt lgkmcnt(4)
    v_mfma_f32_4x4x4_16b_bf16 v[80:83], v[8:9], v[102:103], 0
    v_mfma_f32_4x4x4_16b_bf16 v[76:79], v[8:9], v[100:101], 0
    v_bitop3_b32 v15, v6, v15, v46 bitop3:0xca
    v_bitop3_b32 v14, v6, v14, v47 bitop3:0xca
    v_cmp_lt_u32 s[84:85], v5, v92
    s_nop 0
    v_pk_mul_f32 v[80:81], v[80:81], v[14:15] op_sel:[0,1] op_sel_hi:[1,1]
    v_pk_mul_f32 v[82:83], v[82:83], v[14:15] op_sel:[0,1] op_sel_hi:[1,1]
    v_pk_mul_f32 v[76:77], v[76:77], v[14:15] op_sel:[0,0] op_sel_hi:[1,0]
    v_pk_mul_f32 v[78:79], v[78:79], v[14:15] op_sel:[0,0] op_sel_hi:[1,0]
    s_waitcnt lgkmcnt(0)
    v_cmpx_ne_u64 vcc, v[74:75], v[70:71]
    s_and_b64 s[82:83], vcc, s[80:81]
    s_cbranch_scc1 L2_c148
L2_d148:
    v_mov_b64 v[84:85], v[70:71]
    v_mov_b32 v7, v95
    v_mov_b64 v[86:87], v[74:75]
    s_mov_b64 exec, -1
    s_or_b64 s[80:81], s[80:81], vcc
    v_cmpx_ne_u64 vcc, v[72:73], v[68:69]
    s_and_b64 s[82:83], vcc, s[80:81]
    s_cbranch_scc1 L2_c149
L2_d149:
    v_mov_b64 v[84:85], v[68:69]
    v_mov_b32 v7, v94
    v_mov_b64 v[86:87], v[72:73]
    s_mov_b64 exec, -1
    s_or_b64 s[80:81], s[80:81], vcc
    ds_read_b64 v[70:71], v93 offset:65408
    s_and_b64 exec, s[84:85], s[80:81]
    v_mfma_f32_4x4x4_16b_bf16 v[76:79], v[12:13], v[84:85], 0
    v_mov_b32 v92, v7
    s_andn2_b64 s[80:81], s[80:81], s[84:85]
    v_mfma_f32_4x4x4_16b_bf16 v[76:79], v[10:11], v[86:87], v[76:79]
    s_mov_b64 exec, -1
    ds_read_b64 v[68:69], v92 offset:65408
    s_waitcnt lgkmcnt(0)
    v_mfma_f32_4x4x4_16b_bf16 v[80:83], v[10:11], v[70:71], v[80:83]
    v_mfma_f32_4x4x4_16b_bf16 v[76:79], v[10:11], v[68:69], v[76:79]
    v_and_b32 v46, 0x40000000, v39
    v_bitop3_b32 v94, v36, v5, v46 bitop3:0xea
    v_and_b32 v46, 0x80000000, v39
    v_bitop3_b32 v95, v37, v5, v46 bitop3:0xea
    v_perm_b32 v15, v37, v38, s47
    v_bitop3_b32 v46, v37, 0.5, -0.5 bitop3:0xa8
    v_perm_b32 v14, v36, v38, s46
    v_bitop3_b32 v47, v36, 0.5, -0.5 bitop3:0xa8
    v_cvt_pk_bf16_f32 v80, v80, v81
    v_cvt_pk_bf16_f32 v81, v82, v83
    ds_wrxchg_rtn_b64 v[74:75], v93, v[80:81] offset:65408
    v_cvt_pk_bf16_f32 v76, v76, v77
    v_cvt_pk_bf16_f32 v77, v78, v79
    ds_wrxchg_rtn_b64 v[72:73], v92, v[76:77] offset:65408
    v_mfma_f32_4x4x4_16b_bf16 v[80:83], v[8:9], v[106:107], 0
    v_mfma_f32_4x4x4_16b_bf16 v[76:79], v[8:9], v[104:105], 0
    v_bitop3_b32 v15, v6, v15, v46 bitop3:0xca
    v_bitop3_b32 v14, v6, v14, v47 bitop3:0xca
    s_nop 1
    v_pk_mul_f32 v[80:81], v[80:81], v[14:15] op_sel:[0,1] op_sel_hi:[1,1]
    v_pk_mul_f32 v[82:83], v[82:83], v[14:15] op_sel:[0,1] op_sel_hi:[1,1]
    v_pk_mul_f32 v[76:77], v[76:77], v[14:15] op_sel:[0,0] op_sel_hi:[1,0]
    v_pk_mul_f32 v[78:79], v[78:79], v[14:15] op_sel:[0,0] op_sel_hi:[1,0]
    s_waitcnt lgkmcnt(0)
    v_cmpx_ne_u64 vcc, v[74:75], v[70:71]
    s_and_b64 s[82:83], vcc, s[80:81]
    s_cbranch_scc1 L2_c150
L2_d150:
    v_mov_b64 v[84:85], v[70:71]
    v_mov_b32 v7, v93
    v_mov_b64 v[86:87], v[74:75]
    s_mov_b64 exec, -1
    s_or_b64 s[80:81], s[80:81], vcc
    v_cmpx_ne_u64 vcc, v[72:73], v[68:69]
    s_and_b64 s[82:83], vcc, s[80:81]
    s_cbranch_scc1 L2_c151
L2_d151:
    v_mov_b64 v[84:85], v[68:69]
    v_mov_b32 v7, v92
    v_mov_b64 v[86:87], v[72:73]
    s_mov_b64 exec, -1
    s_or_b64 s[80:81], s[80:81], vcc
    ds_read_b64 v[70:71], v95 offset:65408
    ds_read_b64 v[68:69], v94 offset:65408
    s_waitcnt lgkmcnt(0)
    v_mfma_f32_4x4x4_16b_bf16 v[80:83], v[10:11], v[70:71], v[80:83]
    v_mfma_f32_4x4x4_16b_bf16 v[76:79], v[10:11], v[68:69], v[76:79]
    s_nop 3
    v_cvt_pk_bf16_f32 v80, v80, v81
    v_cvt_pk_bf16_f32 v81, v82, v83
    ds_wrxchg_rtn_b64 v[74:75], v95, v[80:81] offset:65408
    v_cvt_pk_bf16_f32 v76, v76, v77
    v_cvt_pk_bf16_f32 v77, v78, v79
    ds_wrxchg_rtn_b64 v[72:73], v94, v[76:77] offset:65408
    s_waitcnt lgkmcnt(0)
    v_cmpx_ne_u64 vcc, v[74:75], v[70:71]
    s_and_b64 s[82:83], vcc, s[80:81]
    s_cbranch_scc1 L2_c152
L2_d152:
    v_mov_b64 v[84:85], v[70:71]
    v_mov_b32 v7, v95
    v_mov_b64 v[86:87], v[74:75]
    s_mov_b64 exec, -1
    s_or_b64 s[80:81], s[80:81], vcc
    v_cmpx_ne_u64 vcc, v[72:73], v[68:69]
    s_and_b64 s[82:83], vcc, s[80:81]
    s_cbranch_scc1 L2_c153
L2_d153:
    v_mov_b64 v[84:85], v[68:69]
    v_mov_b32 v7, v94
    v_mov_b64 v[86:87], v[72:73]
    s_mov_b64 exec, -1
    s_or_b64 s[80:81], s[80:81], vcc
    s_mov_b64 exec, s[80:81]
    s_nop 1
    v_mfma_f32_4x4x4_16b_bf16 v[88:91], v[12:13], v[84:85], 0
    s_nop 1
    v_mfma_f32_4x4x4_16b_bf16 v[88:91], v[10:11], v[86:87], v[88:91]
    s_nop 4
    v_cvt_pk_bf16_f32 v88, v88, v89
    v_cvt_pk_bf16_f32 v89, v90, v91
    ds_pk_add_bf16 v7, v88 offset:65408
    ds_pk_add_bf16 v7, v89 offset:65412
    s_mov_b64 exec, -1
    s_load_dwordx2 s[4:5], s[0:1], 88
    v_add_u32 v123, 16384, v122
    v_add_u32 v124, 32768, v122
    v_add_u32 v125, 49152, v122
    v_add_u32 v126, 65536, v122
    s_lshl_b32 s50, s96, 16
    s_and_b32 s51, s96, 0xffff0000
    s_lshl_b32 s52, s97, 16
    s_and_b32 s53, s97, 0xffff0000
    s_lshl_b32 s54, s98, 16
    s_and_b32 s55, s98, 0xffff0000
    s_lshl_b32 s56, s99, 16
    s_and_b32 s57, s99, 0xffff0000
    s_waitcnt vmcnt(0) lgkmcnt(0)
    s_barrier
    v_add_u32 v36, 0x8000, v126
    ds_read_b128 v[16:19], v126 offset:16384
    ds_read_b128 v[20:23], v126 offset:32768
    ds_read_b128 v[24:27], v126 offset:49152
    ds_read_b128 v[28:31], v36 offset:32768
    ds_read_b128 v[32:35], v36 offset:49152
    s_add_u32 s8, s30, 0xebca000
    s_addc_u32 s9, s31, 0
    s_mov_b32 s10, 0x8000
    s_mov_b32 s11, 0x20000
    s_mov_b32 s12, s4
    s_mov_b32 s13, s5
    s_mov_b32 s14, 0x4e2000
    s_mov_b32 s15, 0x20000
    s_mul_i32 s3, s33, 20000
    v_subrev_u32 v36, s3, v122
    v_cmp_le_u32 vcc, 20000, v36
    s_waitcnt lgkmcnt(4)
    s_mov_b64 exec, vcc
    buffer_store_dwordx4 v[16:19], v122, s[20:23], 0 offen sc1
    s_mov_b64 exec, -1
    v_subrev_u32 v36, s3, v123
    v_cmp_le_u32 vcc, 20000, v36
    s_waitcnt lgkmcnt(3)
    s_mov_b64 exec, vcc
    buffer_store_dwordx4 v[20:23], v123, s[20:23], 0 offen sc1
    s_mov_b64 exec, -1
    v_subrev_u32 v36, s3, v124
    v_cmp_le_u32 vcc, 20000, v36
    s_waitcnt lgkmcnt(2)
    s_mov_b64 exec, vcc
    buffer_store_dwordx4 v[24:27], v124, s[20:23], 0 offen sc1
    s_mov_b64 exec, -1
    v_subrev_u32 v36, s3, v125
    v_cmp_le_u32 vcc, 20000, v36
    s_waitcnt lgkmcnt(1)
    s_mov_b64 exec, vcc
    buffer_store_dwordx4 v[28:31], v125, s[20:23], 0 offen sc1
    s_mov_b64 exec, -1
    v_subrev_u32 v36, s3, v126
    v_cmp_le_u32 vcc, 20000, v36
    s_waitcnt lgkmcnt(0)
    s_mov_b64 exec, vcc
    buffer_store_dwordx4 v[32:35], v126, s[20:23], 0 offen sc1
    s_mov_b64 exec, -1
    v_lshlrev_b32 v80, 16, v116
    v_subrev_f32 v60, s50, v80
    v_subrev_f32 v61, s51, v80
    v_subrev_f32 v62, s52, v80
    v_subrev_f32 v63, s53, v80
    v_subrev_f32 v64, s54, v80
    v_subrev_f32 v65, s55, v80
    v_subrev_f32 v66, s56, v80
    v_subrev_f32 v67, s57, v80
    v_cvt_pk_bf16_f32 v68, v60, v61
    v_cvt_pk_bf16_f32 v69, v62, v63
    v_cvt_pk_bf16_f32 v70, v64, v65
    v_cvt_pk_bf16_f32 v71, v66, v67
    v_lshlrev_b32 v60, 16, v68
    v_and_b32 v61, 0xffff0000, v68
    v_lshlrev_b32 v62, 16, v69
    v_and_b32 v63, 0xffff0000, v69
    v_lshlrev_b32 v64, 16, v70
    v_and_b32 v65, 0xffff0000, v70
    v_lshlrev_b32 v66, 16, v71
    v_and_b32 v67, 0xffff0000, v71
    v_mul_f32 v60, v60, v60
    v_mul_f32 v61, v61, v61
    v_mul_f32 v62, v62, v62
    v_mul_f32 v63, v63, v63
    v_mul_f32 v64, v64, v64
    v_mul_f32 v65, v65, v65
    v_mul_f32 v66, v66, v66
    v_mul_f32 v67, v67, v67
    v_cvt_pk_bf16_f32 v68, v60, v61
    v_cvt_pk_bf16_f32 v69, v62, v63
    v_cvt_pk_bf16_f32 v70, v64, v65
    v_cvt_pk_bf16_f32 v71, v66, v67
    v_lshlrev_b32 v60, 16, v68
    v_and_b32 v61, 0xffff0000, v68
    v_lshlrev_b32 v62, 16, v69
    v_and_b32 v63, 0xffff0000, v69
    v_lshlrev_b32 v64, 16, v70
    v_and_b32 v65, 0xffff0000, v70
    v_lshlrev_b32 v66, 16, v71
    v_and_b32 v67, 0xffff0000, v71
    v_mul_f32 v60, 0xc1200000, v60
    v_mul_f32 v61, 0xc1200000, v61
    v_mul_f32 v62, 0xc1200000, v62
    v_mul_f32 v63, 0xc1200000, v63
    v_mul_f32 v64, 0xc1200000, v64
    v_mul_f32 v65, 0xc1200000, v65
    v_mul_f32 v66, 0xc1200000, v66
    v_mul_f32 v67, 0xc1200000, v67
    v_cvt_pk_bf16_f32 v68, v60, v61
    v_cvt_pk_bf16_f32 v69, v62, v63
    v_cvt_pk_bf16_f32 v70, v64, v65
    v_cvt_pk_bf16_f32 v71, v66, v67
    v_lshlrev_b32 v60, 16, v68
    v_and_b32 v61, 0xffff0000, v68
    v_lshlrev_b32 v62, 16, v69
    v_and_b32 v63, 0xffff0000, v69
    v_lshlrev_b32 v64, 16, v70
    v_and_b32 v65, 0xffff0000, v70
    v_lshlrev_b32 v66, 16, v71
    v_and_b32 v67, 0xffff0000, v71
    v_mul_f32 v60, 0x3fb8aa3b, v60
    v_mul_f32 v61, 0x3fb8aa3b, v61
    v_mul_f32 v62, 0x3fb8aa3b, v62
    v_mul_f32 v63, 0x3fb8aa3b, v63
    v_mul_f32 v64, 0x3fb8aa3b, v64
    v_mul_f32 v65, 0x3fb8aa3b, v65
    v_mul_f32 v66, 0x3fb8aa3b, v66
    v_mul_f32 v67, 0x3fb8aa3b, v67
    v_exp_f32 v60, v60
    v_exp_f32 v61, v61
    v_exp_f32 v62, v62
    v_exp_f32 v63, v63
    v_exp_f32 v64, v64
    v_exp_f32 v65, v65
    v_exp_f32 v66, v66
    v_exp_f32 v67, v67
    v_cvt_pk_bf16_f32 v72, v60, v61
    v_cvt_pk_bf16_f32 v73, v62, v63
    v_cvt_pk_bf16_f32 v74, v64, v65
    v_cvt_pk_bf16_f32 v75, v66, v67
    v_and_b32 v80, 0xffff0000, v116
    v_subrev_f32 v60, s50, v80
    v_subrev_f32 v61, s51, v80
    v_subrev_f32 v62, s52, v80
    v_subrev_f32 v63, s53, v80
    v_subrev_f32 v64, s54, v80
    v_subrev_f32 v65, s55, v80
    v_subrev_f32 v66, s56, v80
    v_subrev_f32 v67, s57, v80
    v_cvt_pk_bf16_f32 v68, v60, v61
    v_cvt_pk_bf16_f32 v69, v62, v63
    v_cvt_pk_bf16_f32 v70, v64, v65
    v_cvt_pk_bf16_f32 v71, v66, v67
    v_lshlrev_b32 v60, 16, v68
    v_and_b32 v61, 0xffff0000, v68
    v_lshlrev_b32 v62, 16, v69
    v_and_b32 v63, 0xffff0000, v69
    v_lshlrev_b32 v64, 16, v70
    v_and_b32 v65, 0xffff0000, v70
    v_lshlrev_b32 v66, 16, v71
    v_and_b32 v67, 0xffff0000, v71
    v_mul_f32 v60, v60, v60
    v_mul_f32 v61, v61, v61
    v_mul_f32 v62, v62, v62
    v_mul_f32 v63, v63, v63
    v_mul_f32 v64, v64, v64
    v_mul_f32 v65, v65, v65
    v_mul_f32 v66, v66, v66
    v_mul_f32 v67, v67, v67
    v_cvt_pk_bf16_f32 v68, v60, v61
    v_cvt_pk_bf16_f32 v69, v62, v63
    v_cvt_pk_bf16_f32 v70, v64, v65
    v_cvt_pk_bf16_f32 v71, v66, v67
    v_lshlrev_b32 v60, 16, v68
    v_and_b32 v61, 0xffff0000, v68
    v_lshlrev_b32 v62, 16, v69
    v_and_b32 v63, 0xffff0000, v69
    v_lshlrev_b32 v64, 16, v70
    v_and_b32 v65, 0xffff0000, v70
    v_lshlrev_b32 v66, 16, v71
    v_and_b32 v67, 0xffff0000, v71
    v_mul_f32 v60, 0xc1200000, v60
    v_mul_f32 v61, 0xc1200000, v61
    v_mul_f32 v62, 0xc1200000, v62
    v_mul_f32 v63, 0xc1200000, v63
    v_mul_f32 v64, 0xc1200000, v64
    v_mul_f32 v65, 0xc1200000, v65
    v_mul_f32 v66, 0xc1200000, v66
    v_mul_f32 v67, 0xc1200000, v67
    v_cvt_pk_bf16_f32 v68, v60, v61
    v_cvt_pk_bf16_f32 v69, v62, v63
    v_cvt_pk_bf16_f32 v70, v64, v65
    v_cvt_pk_bf16_f32 v71, v66, v67
    v_lshlrev_b32 v60, 16, v68
    v_and_b32 v61, 0xffff0000, v68
    v_lshlrev_b32 v62, 16, v69
    v_and_b32 v63, 0xffff0000, v69
    v_lshlrev_b32 v64, 16, v70
    v_and_b32 v65, 0xffff0000, v70
    v_lshlrev_b32 v66, 16, v71
    v_and_b32 v67, 0xffff0000, v71
    v_mul_f32 v60, 0x3fb8aa3b, v60
    v_mul_f32 v61, 0x3fb8aa3b, v61
    v_mul_f32 v62, 0x3fb8aa3b, v62
    v_mul_f32 v63, 0x3fb8aa3b, v63
    v_mul_f32 v64, 0x3fb8aa3b, v64
    v_mul_f32 v65, 0x3fb8aa3b, v65
    v_mul_f32 v66, 0x3fb8aa3b, v66
    v_mul_f32 v67, 0x3fb8aa3b, v67
    v_exp_f32 v60, v60
    v_exp_f32 v61, v61
    v_exp_f32 v62, v62
    v_exp_f32 v63, v63
    v_exp_f32 v64, v64
    v_exp_f32 v65, v65
    v_exp_f32 v66, v66
    v_exp_f32 v67, v67
    v_cvt_pk_bf16_f32 v76, v60, v61
    v_cvt_pk_bf16_f32 v77, v62, v63
    v_cvt_pk_bf16_f32 v78, v64, v65
    v_cvt_pk_bf16_f32 v79, v66, v67
    v_mfma_f32_4x4x4_16b_bf16 v[80:83], v[48:49], v[72:73], 0
    v_mfma_f32_4x4x4_16b_bf16 v[88:91], v[52:53], v[72:73], 0
    v_mfma_f32_4x4x4_16b_bf16 v[84:87], v[48:49], v[76:77], 0
    v_mfma_f32_4x4x4_16b_bf16 v[92:95], v[52:53], v[76:77], 0
    v_mfma_f32_4x4x4_16b_bf16 v[80:83], v[50:51], v[74:75], v[80:83]
    v_mfma_f32_4x4x4_16b_bf16 v[88:91], v[54:55], v[74:75], v[88:91]
    v_mfma_f32_4x4x4_16b_bf16 v[84:87], v[50:51], v[78:79], v[84:87]
    v_mfma_f32_4x4x4_16b_bf16 v[92:95], v[54:55], v[78:79], v[92:95]
    v_add_u32 v104, 81920, v118
    ds_read_b128 v[32:35], v104
    v_add_u32 v104, 81920, v119
    ds_read_b128 v[60:63], v104
    s_add_u32 s20, s30, 0xd841000
    s_addc_u32 s21, s31, 0
    s_mov_b32 s22, 0x1388000
    s_mov_b32 s23, 0x20000
    s_add_u32 s3, s33, 1
    s_and_b32 s3, s3, 3
    s_lshl_b32 s3, s3, 6
    s_add_u32 s3, s3, s34
    s_mul_i32 s44, s3, 80000
    s_add_u32 s3, s33, 2
    s_and_b32 s3, s3, 3
    s_lshl_b32 s3, s3, 6
    s_add_u32 s3, s3, s34
    s_mul_i32 s45, s3, 80000
    s_add_u32 s3, s33, 3
    s_and_b32 s3, s3, 3
    s_lshl_b32 s3, s3, 6
    s_add_u32 s3, s3, s34
    s_mul_i32 s46, s3, 80000
    s_lshl_b32 s3, s34, 9
    s_lshl_b32 s4, s33, 7
    s_add_u32 s4, s4, s3
    v_mov_b32 v104, 1
    v_lshlrev_b32 v105, 3, v122
    s_waitcnt vmcnt(0)
    s_barrier
    s_cmp_lg_u32 s32, 0
    s_cbranch_scc1 L2_f2
    s_mov_b64 exec, 1
    buffer_store_dword v104, off, s[8:11], s4 sc1
    s_mov_b64 exec, 15
    s_bitset0_b64 exec, s33
L2_f3:
    buffer_load_dword v104, v105, s[8:11], s3 offen sc1
    s_waitcnt vmcnt(0)
    v_cmp_ne_u32 vcc, 1, v104
    s_cbranch_vccnz L2_f3
L2_f4:
    s_mov_b64 exec, -1
L2_f2:
    s_barrier
    buffer_load_dwordx4 v[36:39], v118, s[20:23], s44 offen sc1
    buffer_load_dwordx4 v[40:43], v118, s[20:23], s45 offen sc1
    buffer_load_dwordx4 v[44:47], v118, s[20:23], s46 offen sc1
    s_cmp_ge_u32 s32, 4
    s_cbranch_scc1 L2_f5
    buffer_load_dwordx4 v[64:67], v119, s[20:23], s44 offen sc1
    buffer_load_dwordx4 v[68:71], v119, s[20:23], s45 offen sc1
    buffer_load_dwordx4 v[72:75], v119, s[20:23], s46 offen sc1
    v_lshlrev_b32 v16, 16, v117
    v_subrev_f32 v96, s50, v16
    v_subrev_f32 v97, s51, v16
    v_subrev_f32 v98, s52, v16
    v_subrev_f32 v99, s53, v16
    v_subrev_f32 v100, s54, v16
    v_subrev_f32 v101, s55, v16
    v_subrev_f32 v102, s56, v16
    v_subrev_f32 v103, s57, v16
    v_cvt_pk_bf16_f32 v0, v96, v97
    v_cvt_pk_bf16_f32 v1, v98, v99
    v_cvt_pk_bf16_f32 v2, v100, v101
    v_cvt_pk_bf16_f32 v3, v102, v103
    v_lshlrev_b32 v96, 16, v0
    v_and_b32 v97, 0xffff0000, v0
    v_lshlrev_b32 v98, 16, v1
    v_and_b32 v99, 0xffff0000, v1
    v_lshlrev_b32 v100, 16, v2
    v_and_b32 v101, 0xffff0000, v2
    v_lshlrev_b32 v102, 16, v3
    v_and_b32 v103, 0xffff0000, v3
    v_mul_f32 v96, v96, v96
    v_mul_f32 v97, v97, v97
    v_mul_f32 v98, v98, v98
    v_mul_f32 v99, v99, v99
    v_mul_f32 v100, v100, v100
    v_mul_f32 v101, v101, v101
    v_mul_f32 v102, v102, v102
    v_mul_f32 v103, v103, v103
    v_cvt_pk_bf16_f32 v0, v96, v97
    v_cvt_pk_bf16_f32 v1, v98, v99
    v_cvt_pk_bf16_f32 v2, v100, v101
    v_cvt_pk_bf16_f32 v3, v102, v103
    v_lshlrev_b32 v96, 16, v0
    v_and_b32 v97, 0xffff0000, v0
    v_lshlrev_b32 v98, 16, v1
    v_and_b32 v99, 0xffff0000, v1
    v_lshlrev_b32 v100, 16, v2
    v_and_b32 v101, 0xffff0000, v2
    v_lshlrev_b32 v102, 16, v3
    v_and_b32 v103, 0xffff0000, v3
    v_mul_f32 v96, 0xc1200000, v96
    v_mul_f32 v97, 0xc1200000, v97
    v_mul_f32 v98, 0xc1200000, v98
    v_mul_f32 v99, 0xc1200000, v99
    v_mul_f32 v100, 0xc1200000, v100
    v_mul_f32 v101, 0xc1200000, v101
    v_mul_f32 v102, 0xc1200000, v102
    v_mul_f32 v103, 0xc1200000, v103
    v_cvt_pk_bf16_f32 v0, v96, v97
    v_cvt_pk_bf16_f32 v1, v98, v99
    v_cvt_pk_bf16_f32 v2, v100, v101
    v_cvt_pk_bf16_f32 v3, v102, v103
    v_lshlrev_b32 v96, 16, v0
    v_and_b32 v97, 0xffff0000, v0
    v_lshlrev_b32 v98, 16, v1
    v_and_b32 v99, 0xffff0000, v1
    v_lshlrev_b32 v100, 16, v2
    v_and_b32 v101, 0xffff0000, v2
    v_lshlrev_b32 v102, 16, v3
    v_and_b32 v103, 0xffff0000, v3
    v_mul_f32 v96, 0x3fb8aa3b, v96
    v_mul_f32 v97, 0x3fb8aa3b, v97
    v_mul_f32 v98, 0x3fb8aa3b, v98
    v_mul_f32 v99, 0x3fb8aa3b, v99
    v_mul_f32 v100, 0x3fb8aa3b, v100
    v_mul_f32 v101, 0x3fb8aa3b, v101
    v_mul_f32 v102, 0x3fb8aa3b, v102
    v_mul_f32 v103, 0x3fb8aa3b, v103
    v_exp_f32 v96, v96
    v_exp_f32 v97, v97
    v_exp_f32 v98, v98
    v_exp_f32 v99, v99
    v_exp_f32 v100, v100
    v_exp_f32 v101, v101
    v_exp_f32 v102, v102
    v_exp_f32 v103, v103
    v_cvt_pk_bf16_f32 v104, v96, v97
    v_cvt_pk_bf16_f32 v105, v98, v99
    v_cvt_pk_bf16_f32 v106, v100, v101
    v_cvt_pk_bf16_f32 v107, v102, v103
    v_and_b32 v16, 0xffff0000, v117
    v_subrev_f32 v96, s50, v16
    v_subrev_f32 v97, s51, v16
    v_subrev_f32 v98, s52, v16
    v_subrev_f32 v99, s53, v16
    v_subrev_f32 v100, s54, v16
    v_subrev_f32 v101, s55, v16
    v_subrev_f32 v102, s56, v16
    v_subrev_f32 v103, s57, v16
    v_cvt_pk_bf16_f32 v0, v96, v97
    v_cvt_pk_bf16_f32 v1, v98, v99
    v_cvt_pk_bf16_f32 v2, v100, v101
    v_cvt_pk_bf16_f32 v3, v102, v103
    v_lshlrev_b32 v96, 16, v0
    v_and_b32 v97, 0xffff0000, v0
    v_lshlrev_b32 v98, 16, v1
    v_and_b32 v99, 0xffff0000, v1
    v_lshlrev_b32 v100, 16, v2
    v_and_b32 v101, 0xffff0000, v2
    v_lshlrev_b32 v102, 16, v3
    v_and_b32 v103, 0xffff0000, v3
    v_mul_f32 v96, v96, v96
    v_mul_f32 v97, v97, v97
    v_mul_f32 v98, v98, v98
    v_mul_f32 v99, v99, v99
    v_mul_f32 v100, v100, v100
    v_mul_f32 v101, v101, v101
    v_mul_f32 v102, v102, v102
    v_mul_f32 v103, v103, v103
    v_cvt_pk_bf16_f32 v0, v96, v97
    v_cvt_pk_bf16_f32 v1, v98, v99
    v_cvt_pk_bf16_f32 v2, v100, v101
    v_cvt_pk_bf16_f32 v3, v102, v103
    v_lshlrev_b32 v96, 16, v0
    v_and_b32 v97, 0xffff0000, v0
    v_lshlrev_b32 v98, 16, v1
    v_and_b32 v99, 0xffff0000, v1
    v_lshlrev_b32 v100, 16, v2
    v_and_b32 v101, 0xffff0000, v2
    v_lshlrev_b32 v102, 16, v3
    v_and_b32 v103, 0xffff0000, v3
    v_mul_f32 v96, 0xc1200000, v96
    v_mul_f32 v97, 0xc1200000, v97
    v_mul_f32 v98, 0xc1200000, v98
    v_mul_f32 v99, 0xc1200000, v99
    v_mul_f32 v100, 0xc1200000, v100
    v_mul_f32 v101, 0xc1200000, v101
    v_mul_f32 v102, 0xc1200000, v102
    v_mul_f32 v103, 0xc1200000, v103
    v_cvt_pk_bf16_f32 v0, v96, v97
    v_cvt_pk_bf16_f32 v1, v98, v99
    v_cvt_pk_bf16_f32 v2, v100, v101
    v_cvt_pk_bf16_f32 v3, v102, v103
    v_lshlrev_b32 v96, 16, v0
    v_and_b32 v97, 0xffff0000, v0
    v_lshlrev_b32 v98, 16, v1
    v_and_b32 v99, 0xffff0000, v1
    v_lshlrev_b32 v100, 16, v2
    v_and_b32 v101, 0xffff0000, v2
    v_lshlrev_b32 v102, 16, v3
    v_and_b32 v103, 0xffff0000, v3
    v_mul_f32 v96, 0x3fb8aa3b, v96
    v_mul_f32 v97, 0x3fb8aa3b, v97
    v_mul_f32 v98, 0x3fb8aa3b, v98
    v_mul_f32 v99, 0x3fb8aa3b, v99
    v_mul_f32 v100, 0x3fb8aa3b, v100
    v_mul_f32 v101, 0x3fb8aa3b, v101
    v_mul_f32 v102, 0x3fb8aa3b, v102
    v_mul_f32 v103, 0x3fb8aa3b, v103
    v_exp_f32 v96, v96
    v_exp_f32 v97, v97
    v_exp_f32 v98, v98
    v_exp_f32 v99, v99
    v_exp_f32 v100, v100
    v_exp_f32 v101, v101
    v_exp_f32 v102, v102
    v_exp_f32 v103, v103
    v_cvt_pk_bf16_f32 v76, v96, v97
    v_cvt_pk_bf16_f32 v77, v98, v99
    v_cvt_pk_bf16_f32 v78, v100, v101
    v_cvt_pk_bf16_f32 v79, v102, v103
    v_mfma_f32_4x4x4_16b_bf16 v[16:19], v[48:49], v[104:105], 0
    v_mfma_f32_4x4x4_16b_bf16 v[24:27], v[52:53], v[104:105], 0
    v_mfma_f32_4x4x4_16b_bf16 v[20:23], v[48:49], v[76:77], 0
    v_mfma_f32_4x4x4_16b_bf16 v[28:31], v[52:53], v[76:77], 0
    v_mfma_f32_4x4x4_16b_bf16 v[16:19], v[50:51], v[106:107], v[16:19]
    v_mfma_f32_4x4x4_16b_bf16 v[24:27], v[54:55], v[106:107], v[24:27]
    v_mfma_f32_4x4x4_16b_bf16 v[20:23], v[50:51], v[78:79], v[20:23]
    v_mfma_f32_4x4x4_16b_bf16 v[28:31], v[54:55], v[78:79], v[28:31]
L2_f5:
    s_waitcnt vmcnt(0) lgkmcnt(0)
    v_mfma_f32_4x4x4_16b_bf16 v[96:99], v[10:11], v[32:33], 0
    v_mfma_f32_4x4x4_16b_bf16 v[100:103], v[10:11], v[34:35], 0
    s_nop 0
    v_mfma_f32_4x4x4_16b_bf16 v[96:99], v[10:11], v[36:37], v[96:99]
    v_mfma_f32_4x4x4_16b_bf16 v[100:103], v[10:11], v[38:39], v[100:103]
    s_nop 0
    v_mfma_f32_4x4x4_16b_bf16 v[96:99], v[10:11], v[40:41], v[96:99]
    v_mfma_f32_4x4x4_16b_bf16 v[100:103], v[10:11], v[42:43], v[100:103]
    s_nop 0
    v_mfma_f32_4x4x4_16b_bf16 v[96:99], v[10:11], v[44:45], v[96:99]
    v_mfma_f32_4x4x4_16b_bf16 v[100:103], v[10:11], v[46:47], v[100:103]
    s_nop 3
    v_mul_f32 v96, v96, v80
    v_mul_f32 v97, v97, v81
    v_mul_f32 v98, v98, v82
    v_mul_f32 v99, v99, v83
    v_cvt_pk_bf16_f32 v32, v96, v97
    v_cvt_pk_bf16_f32 v33, v98, v99
    v_mul_f32 v100, v100, v84
    v_mul_f32 v101, v101, v85
    v_mul_f32 v102, v102, v86
    v_mul_f32 v103, v103, v87
    v_cvt_pk_bf16_f32 v34, v100, v101
    v_cvt_pk_bf16_f32 v35, v102, v103
    v_mfma_f32_4x4x4_16b_bf16 v[80:83], v[56:57], v[32:33], 0
    s_nop 0
    v_mfma_f32_4x4x4_16b_bf16 v[84:87], v[56:57], v[34:35], 0
    s_nop 2
    v_mul_f32 v80, v80, v88
    v_mul_f32 v81, v81, v89
    v_mul_f32 v82, v82, v90
    v_mul_f32 v83, v83, v91
    v_mul_f32 v84, v84, v92
    v_mul_f32 v85, v85, v93
    v_mul_f32 v86, v86, v94
    v_mul_f32 v87, v87, v95
    v_mfma_f32_4x4x4_16b_bf16 v[96:99], v[10:11], v[108:109], v[80:83]
    s_nop 0
    v_mfma_f32_4x4x4_16b_bf16 v[100:103], v[10:11], v[110:111], v[84:87]
    s_nop 2
    v_cvt_pk_bf16_f32 v36, v96, v97
    v_cvt_pk_bf16_f32 v37, v98, v99
    v_cvt_pk_bf16_f32 v38, v100, v101
    v_cvt_pk_bf16_f32 v39, v102, v103
    buffer_store_dwordx4 v[36:39], v120, s[12:15], 0 offen
    s_cmp_ge_u32 s32, 4
    s_cbranch_scc1 L2_f6
    v_mfma_f32_4x4x4_16b_bf16 v[96:99], v[10:11], v[60:61], 0
    v_mfma_f32_4x4x4_16b_bf16 v[100:103], v[10:11], v[62:63], 0
    s_nop 0
    v_mfma_f32_4x4x4_16b_bf16 v[96:99], v[10:11], v[64:65], v[96:99]
    v_mfma_f32_4x4x4_16b_bf16 v[100:103], v[10:11], v[66:67], v[100:103]
    s_nop 0
    v_mfma_f32_4x4x4_16b_bf16 v[96:99], v[10:11], v[68:69], v[96:99]
    v_mfma_f32_4x4x4_16b_bf16 v[100:103], v[10:11], v[70:71], v[100:103]
    s_nop 0
    v_mfma_f32_4x4x4_16b_bf16 v[96:99], v[10:11], v[72:73], v[96:99]
    v_mfma_f32_4x4x4_16b_bf16 v[100:103], v[10:11], v[74:75], v[100:103]
    s_nop 3
    v_mul_f32 v96, v96, v16
    v_mul_f32 v97, v97, v17
    v_mul_f32 v98, v98, v18
    v_mul_f32 v99, v99, v19
    v_cvt_pk_bf16_f32 v60, v96, v97
    v_cvt_pk_bf16_f32 v61, v98, v99
    v_mul_f32 v100, v100, v20
    v_mul_f32 v101, v101, v21
    v_mul_f32 v102, v102, v22
    v_mul_f32 v103, v103, v23
    v_cvt_pk_bf16_f32 v62, v100, v101
    v_cvt_pk_bf16_f32 v63, v102, v103
    v_mfma_f32_4x4x4_16b_bf16 v[16:19], v[56:57], v[60:61], 0
    s_nop 0
    v_mfma_f32_4x4x4_16b_bf16 v[20:23], v[56:57], v[62:63], 0
    s_nop 2
    v_mul_f32 v16, v16, v24
    v_mul_f32 v17, v17, v25
    v_mul_f32 v18, v18, v26
    v_mul_f32 v19, v19, v27
    v_mul_f32 v20, v20, v28
    v_mul_f32 v21, v21, v29
    v_mul_f32 v22, v22, v30
    v_mul_f32 v23, v23, v31
    v_mfma_f32_4x4x4_16b_bf16 v[96:99], v[10:11], v[112:113], v[16:19]
    s_nop 0
    v_mfma_f32_4x4x4_16b_bf16 v[100:103], v[10:11], v[114:115], v[20:23]
    s_nop 2
    v_cvt_pk_bf16_f32 v64, v96, v97
    v_cvt_pk_bf16_f32 v65, v98, v99
    v_cvt_pk_bf16_f32 v66, v100, v101
    v_cvt_pk_bf16_f32 v67, v102, v103
    buffer_store_dwordx4 v[64:67], v121, s[12:15], 0 offen
L2_f6:
L2_end:
    s_endpgm
L2_slow:
    s_lshr_b32 s35, s42, 2
    s_lshl_b32 s50, s32, 4
    s_and_b32 s3, s42, 3
    s_lshl_b32 s53, s3, 3
    s_add_u32 s53, s53, s39
    s_and_b32 s3, s35, 2
    s_lshl_b32 s3, s3, 1
    s_add_u32 s53, s53, s3
    s_and_b32 s54, s35, 1
    s_lshl_b32 s54, s54, 4
L2_sl_seg:
    s_mul_i32 s55, s50, 173056
    s_and_b32 s3, s50, 3
    s_lshl_b32 s3, s3, 5
    s_add_u32 s3, s3, s55
    s_add_u32 s3, s3, s53
    buffer_load_dword v104, off, s[12:15], s3 sc1
    buffer_load_dword v105, off, s[12:15], s3 offset:32 sc1
    s_waitcnt vmcnt(0)
    v_readfirstlane_b32 s51, v104
    v_readfirstlane_b32 s52, v105
    s_lshr_b32 s51, s51, s54
    s_and_b32 s51, s51, 0xffff
    s_lshr_b32 s52, s52, s54
    s_and_b32 s52, s52, 0xffff
L2_sl_rec:
    s_cmp_ge_u32 s51, s52
    s_cbranch_scc1 L2_sl_next
    v_mbcnt_lo_u32_b32 v102, -1, 0
    v_mbcnt_hi_u32_b32 v102, -1, v102
    v_add_u32 v102, s51, v102
    v_and_b32 v103, -4, v102
    v_lshl_add_u32 v104, v102, 2, v103
    v_lshl_add_u32 v105, v103, 2, v102
    v_cmp_gt_u32 vcc, s52, v102
    s_mov_b64 exec, vcc
    buffer_load_dword v106, v104, s[8:11], s55 offen
    buffer_load_ubyte v107, v105, s[8:11], s55 offen offset:16
    s_waitcnt vmcnt(0)
    v_lshrrev_b32 v98, 14, v106
    v_and_b32 v98, v5, v98
    ds_read_b64 v[100:101], v98
    v_perm_b32 v97, v106, v107, s44
    v_and_b32 v96, v5, v106
    v_bitop3_b32 v103, v106, 0.5, -0.5 bitop3:0xa8
    v_bitop3_b32 v97, v6, v97, v103 bitop3:0xca
    s_waitcnt lgkmcnt(0)
    v_mfma_f32_4x4x4_16b_bf16 v[88:91], v[8:9], v[100:101], 0
    s_nop 4
    v_mul_f32 v88, v97, v88
    v_mul_f32 v89, v97, v89
    v_mul_f32 v90, v97, v90
    v_mul_f32 v91, v97, v91
    v_cvt_pk_bf16_f32 v88, v88, v89
    v_cvt_pk_bf16_f32 v89, v90, v91
    ds_pk_add_bf16 v96, v88 offset:65408
    ds_pk_add_bf16 v96, v89 offset:65412
    s_mov_b64 exec, -1
    s_add_u32 s51, s51, 64
    s_branch L2_sl_rec
L2_sl_next:
    s_add_u32 s50, s50, 1
    s_and_b32 s3, s50, 15
    s_cbranch_scc1 L2_sl_seg
    s_add_u32 s50, s50, 240
    s_cmp_lt_u32 s50, 1280
    s_cbranch_scc1 L2_sl_seg
    s_waitcnt lgkmcnt(0)
    s_cmp_eq_u32 s42, 0
    s_cbranch_scc1 L2_ret0
    s_cmp_eq_u32 s42, 1
    s_cbranch_scc1 L2_ret1
    s_cmp_eq_u32 s42, 14
    s_cbranch_scc1 L2_ret6
    s_cmp_eq_u32 s42, 15
    s_cbranch_scc1 L2_ret7
    s_and_b32 s3, s42, 3
    s_cmp_eq_u32 s3, 2
    s_cbranch_scc1 L2_ret2
    s_cmp_eq_u32 s3, 3
    s_cbranch_scc1 L2_ret3
    s_cmp_eq_u32 s3, 0
    s_cbranch_scc1 L2_ret4
    s_branch L2_ret5
L2_c1w:
    buffer_load_dword v89, off, s[68:71], s54 offset:64 sc1
    s_waitcnt vmcnt(0)
    s_branch L2_c1
L2_xo3:
    v_cmp_lt_u32 vcc, 20, v99
    s_mov_b32 s101, 1
    s_cbranch_vccz L2_xp3
    v_cmp_lt_u32 vcc, 32, v99
    v_cmp_lt_u32 s[58:59], 31, v88
    s_mov_b32 s101, 2
    s_or_b64 vcc, vcc, s[58:59]
    s_cbranch_scc0 L2_xp3
    s_mov_b32 s37, 0x10000
    s_branch L2_xp3
L2_xa4:
    s_cmp_eq_u32 s101, 1
    s_cbranch_scc1 L2_xc4
    v_lshlrev_b32 v89, 0, v96
    v_add_u32 v90, 140, v97
    v_bitop3_b32 v90, v89, v45, v90 bitop3:0x6a
    ds_write_b32 v98, v90 offset:28
    v_lshlrev_b32 v89, 4, v96
    v_add_u32 v90, 120, v97
    v_bitop3_b32 v90, v89, v45, v90 bitop3:0x6a
    ds_write_b32 v98, v90 offset:24
    v_lshlrev_b32 v89, 8, v96
    v_add_u32 v90, 100, v97
    v_bitop3_b32 v90, v89, v45, v90 bitop3:0x6a
    ds_write_b32 v98, v90 offset:20
L2_xc4:
    v_lshlrev_b32 v89, 12, v96
    v_add_u32 v90, 80, v97
    v_bitop3_b32 v90, v89, v45, v90 bitop3:0x6a
    ds_write_b32 v98, v90 offset:16
    s_branch L2_xb4
L2_xe4:
    v_cmp_lt_u32 vcc, 32, v99
    v_cmp_lt_u32 s[58:59], 31, v88
    v_lshrrev_b32 v89, 16, v96
    v_add_u32 v97, 80, v97
    s_or_b64 vcc, vcc, s[58:59]
    s_cbranch_scc1 L2_xs4
    v_lshlrev_b32 v89, v1, v89
    v_and_b32 v89, v45, v89
    v_cmp_ne_u32 vcc, 0, v89
    v_xor_b32 v90, v97, v89
    s_add_u32 s3, s37, s38
    v_mbcnt_lo_u32_b32 v98, vcc_lo, 0
    v_mbcnt_hi_u32_b32 v98, vcc_hi, v98
    s_bcnt1_i32_b64 s41, vcc
    v_lshl_add_u32 v98, v98, 2, s3
    s_mov_b64 exec, vcc
    ds_write_b32 v98, v90
    s_mov_b64 exec, -1
    s_lshl2_add_u32 s37, s41, s37
    s_branch L2_xr4
L2_xf4:
    s_waitcnt lgkmcnt(0)
    s_cmp_gt_u32 s37, 1024
    s_cbranch_scc1 L2_xs4
    v_mov_b32 v43, -1
    s_cmp_ge_u32 s37, 512
    s_cbranch_scc1 L2_xg4
    v_mov_b32 v42, -1
    s_cmp_ge_u32 s37, 256
    s_cbranch_scc1 L2_xg4
    v_mov_b32 v41, -1
    s_branch L2_xg4
L2_xs4:
    s_waitcnt lgkmcnt(0)
    v_mov_b32 v40, -1
    v_mov_b32 v41, -1
    v_mov_b32 v42, -1
    v_mov_b32 v43, -1
    s_add_u32 s3, s42, 0
    s_bitset1_b32 s36, s3
    s_branch L2_xg4
L2_xo5:
    v_cmp_lt_u32 vcc, 20, v99
    s_mov_b32 s101, 1
    s_cbranch_vccz L2_xp5
    v_cmp_lt_u32 vcc, 32, v99
    v_cmp_lt_u32 s[58:59], 31, v88
    s_mov_b32 s101, 2
    s_or_b64 vcc, vcc, s[58:59]
    s_cbranch_scc0 L2_xp5
    s_mov_b32 s37, 0x10000
    s_branch L2_xp5
L2_xa6:
    s_cmp_eq_u32 s101, 1
    s_cbranch_scc1 L2_xc6
    v_lshlrev_b32 v89, 0, v96
    v_add_u32 v90, 140, v97
    v_bitop3_b32 v90, v89, v45, v90 bitop3:0x6a
    ds_write_b32 v98, v90 offset:28
    v_lshlrev_b32 v89, 4, v96
    v_add_u32 v90, 120, v97
    v_bitop3_b32 v90, v89, v45, v90 bitop3:0x6a
    ds_write_b32 v98, v90 offset:24
    v_lshlrev_b32 v89, 8, v96
    v_add_u32 v90, 100, v97
    v_bitop3_b32 v90, v89, v45, v90 bitop3:0x6a
    ds_write_b32 v98, v90 offset:20
L2_xc6:
    v_lshlrev_b32 v89, 12, v96
    v_add_u32 v90, 80, v97
    v_bitop3_b32 v90, v89, v45, v90 bitop3:0x6a
    ds_write_b32 v98, v90 offset:16
    s_branch L2_xb6
L2_xe6:
    v_cmp_lt_u32 vcc, 32, v99
    v_cmp_lt_u32 s[58:59], 31, v88
    v_lshrrev_b32 v89, 16, v96
    v_add_u32 v97, 80, v97
    s_or_b64 vcc, vcc, s[58:59]
    s_cbranch_scc1 L2_xs6
    v_lshlrev_b32 v89, v1, v89
    v_and_b32 v89, v45, v89
    v_cmp_ne_u32 vcc, 0, v89
    v_xor_b32 v90, v97, v89
    s_add_u32 s3, s37, s38
    v_mbcnt_lo_u32_b32 v98, vcc_lo, 0
    v_mbcnt_hi_u32_b32 v98, vcc_hi, v98
    s_bcnt1_i32_b64 s41, vcc
    v_lshl_add_u32 v98, v98, 2, s3
    s_mov_b64 exec, vcc
    ds_write_b32 v98, v90
    s_mov_b64 exec, -1
    s_lshl2_add_u32 s37, s41, s37
    s_branch L2_xr6
L2_xf6:
    s_waitcnt lgkmcnt(0)
    s_cmp_gt_u32 s37, 1024
    s_cbranch_scc1 L2_xs6
    v_mov_b32 v43, -1
    s_cmp_ge_u32 s37, 512
    s_cbranch_scc1 L2_xg6
    v_mov_b32 v42, -1
    s_cmp_ge_u32 s37, 256
    s_cbranch_scc1 L2_xg6
    v_mov_b32 v41, -1
    s_branch L2_xg6
L2_xs6:
    s_waitcnt lgkmcnt(0)
    v_mov_b32 v40, -1
    v_mov_b32 v41, -1
    v_mov_b32 v42, -1
    v_mov_b32 v43, -1
    s_add_u32 s3, s42, 1
    s_bitset1_b32 s36, s3
    s_branch L2_xg6
L2_c7:
    s_mov_b64 s[50:51], vcc
    s_lshl_b64 s[52:53], s[82:83], 1
    s_andn2_b64 s[52:53], s[52:53], s[80:81]
    s_andn2_b64 s[52:53], s[52:53], s[50:51]
    s_or_b64 s[80:81], s[80:81], s[52:53]
    s_not_b64 vcc, s[52:53]
    s_mov_b64 exec, -1
    v_cndmask_b32_dpp v84, v84, v84, vcc wave_shr:1 row_mask:0xf bank_mask:0xf
    v_cndmask_b32_dpp v85, v85, v85, vcc wave_shr:1 row_mask:0xf bank_mask:0xf
    s_lshr_b64 s[52:53], s[52:53], 1
    v_cndmask_b32_dpp v86, v86, v86, vcc wave_shr:1 row_mask:0xf bank_mask:0xf
    v_cndmask_b32_dpp v87, v87, v87, vcc wave_shr:1 row_mask:0xf bank_mask:0xf
    s_andn2_b64 s[82:83], s[82:83], s[52:53]
    v_cndmask_b32_dpp v7, v7, v7, vcc wave_shr:1 row_mask:0xf bank_mask:0xf
    s_mov_b64 vcc, s[50:51]
    s_mov_b64 exec, s[50:51]
    s_cbranch_scc0 L2_d7
    s_mov_b64 exec, s[82:83]
    s_nop 1
    v_mfma_f32_4x4x4_16b_bf16 v[88:91], v[12:13], v[84:85], 0
    s_nop 1
    v_mfma_f32_4x4x4_16b_bf16 v[88:91], v[10:11], v[86:87], v[88:91]
    s_nop 4
    v_cvt_pk_bf16_f32 v88, v88, v89
    v_cvt_pk_bf16_f32 v89, v90, v91
    ds_pk_add_bf16 v7, v88 offset:65408
    ds_pk_add_bf16 v7, v89 offset:65412
    s_mov_b64 exec, vcc
    s_branch L2_d7
L2_c8:
    s_mov_b64 s[50:51], vcc
    s_lshl_b64 s[52:53], s[82:83], 1
    s_andn2_b64 s[52:53], s[52:53], s[80:81]
    s_andn2_b64 s[52:53], s[52:53], s[50:51]
    s_or_b64 s[80:81], s[80:81], s[52:53]
    s_not_b64 vcc, s[52:53]
    s_mov_b64 exec, -1
    v_cndmask_b32_dpp v84, v84, v84, vcc wave_shr:1 row_mask:0xf bank_mask:0xf
    v_cndmask_b32_dpp v85, v85, v85, vcc wave_shr:1 row_mask:0xf bank_mask:0xf
    s_lshr_b64 s[52:53], s[52:53], 1
    v_cndmask_b32_dpp v86, v86, v86, vcc wave_shr:1 row_mask:0xf bank_mask:0xf
    v_cndmask_b32_dpp v87, v87, v87, vcc wave_shr:1 row_mask:0xf bank_mask:0xf
    s_andn2_b64 s[82:83], s[82:83], s[52:53]
    v_cndmask_b32_dpp v7, v7, v7, vcc wave_shr:1 row_mask:0xf bank_mask:0xf
    s_mov_b64 vcc, s[50:51]
    s_mov_b64 exec, s[50:51]
    s_cbranch_scc0 L2_d8
    s_mov_b64 exec, s[82:83]
    s_nop 1
    v_mfma_f32_4x4x4_16b_bf16 v[88:91], v[12:13], v[84:85], 0
    s_nop 1
    v_mfma_f32_4x4x4_16b_bf16 v[88:91], v[10:11], v[86:87], v[88:91]
    s_nop 4
    v_cvt_pk_bf16_f32 v88, v88, v89
    v_cvt_pk_bf16_f32 v89, v90, v91
    ds_pk_add_bf16 v7, v88 offset:65408
    ds_pk_add_bf16 v7, v89 offset:65412
    s_mov_b64 exec, vcc
    s_branch L2_d8
L2_c11:
    s_mov_b64 s[50:51], vcc
    s_lshl_b64 s[52:53], s[82:83], 1
    s_andn2_b64 s[52:53], s[52:53], s[80:81]
    s_andn2_b64 s[52:53], s[52:53], s[50:51]
    s_or_b64 s[80:81], s[80:81], s[52:53]
    s_not_b64 vcc, s[52:53]
    s_mov_b64 exec, -1
    v_cndmask_b32_dpp v84, v84, v84, vcc wave_shr:1 row_mask:0xf bank_mask:0xf
    v_cndmask_b32_dpp v85, v85, v85, vcc wave_shr:1 row_mask:0xf bank_mask:0xf
    s_lshr_b64 s[52:53], s[52:53], 1
    v_cndmask_b32_dpp v86, v86, v86, vcc wave_shr:1 row_mask:0xf bank_mask:0xf
    v_cndmask_b32_dpp v87, v87, v87, vcc wave_shr:1 row_mask:0xf bank_mask:0xf
    s_andn2_b64 s[82:83], s[82:83], s[52:53]
    v_cndmask_b32_dpp v7, v7, v7, vcc wave_shr:1 row_mask:0xf bank_mask:0xf
    s_mov_b64 vcc, s[50:51]
    s_mov_b64 exec, s[50:51]
    s_cbranch_scc0 L2_d11
    s_mov_b64 exec, s[82:83]
    s_nop 1
    v_mfma_f32_4x4x4_16b_bf16 v[88:91], v[12:13], v[84:85], 0
    s_nop 1
    v_mfma_f32_4x4x4_16b_bf16 v[88:91], v[10:11], v[86:87], v[88:91]
    s_nop 4
    v_cvt_pk_bf16_f32 v88, v88, v89
    v_cvt_pk_bf16_f32 v89, v90, v91
    ds_pk_add_bf16 v7, v88 offset:65408
    ds_pk_add_bf16 v7, v89 offset:65412
    s_mov_b64 exec, vcc
    s_branch L2_d11
L2_c12:
    s_mov_b64 s[50:51], vcc
    s_lshl_b64 s[52:53], s[82:83], 1
    s_andn2_b64 s[52:53], s[52:53], s[80:81]
    s_andn2_b64 s[52:53], s[52:53], s[50:51]
    s_or_b64 s[80:81], s[80:81], s[52:53]
    s_not_b64 vcc, s[52:53]
    s_mov_b64 exec, -1
    v_cndmask_b32_dpp v84, v84, v84, vcc wave_shr:1 row_mask:0xf bank_mask:0xf
    v_cndmask_b32_dpp v85, v85, v85, vcc wave_shr:1 row_mask:0xf bank_mask:0xf
    s_lshr_b64 s[52:53], s[52:53], 1
    v_cndmask_b32_dpp v86, v86, v86, vcc wave_shr:1 row_mask:0xf bank_mask:0xf
    v_cndmask_b32_dpp v87, v87, v87, vcc wave_shr:1 row_mask:0xf bank_mask:0xf
    s_andn2_b64 s[82:83], s[82:83], s[52:53]
    v_cndmask_b32_dpp v7, v7, v7, vcc wave_shr:1 row_mask:0xf bank_mask:0xf
    s_mov_b64 vcc, s[50:51]
    s_mov_b64 exec, s[50:51]
    s_cbranch_scc0 L2_d12
    s_mov_b64 exec, s[82:83]
    s_nop 1
    v_mfma_f32_4x4x4_16b_bf16 v[88:91], v[12:13], v[84:85], 0
    s_nop 1
    v_mfma_f32_4x4x4_16b_bf16 v[88:91], v[10:11], v[86:87], v[88:91]
    s_nop 4
    v_cvt_pk_bf16_f32 v88, v88, v89
    v_cvt_pk_bf16_f32 v89, v90, v91
    ds_pk_add_bf16 v7, v88 offset:65408
    ds_pk_add_bf16 v7, v89 offset:65412
    s_mov_b64 exec, vcc
    s_branch L2_d12
L2_xo13:
    v_cmp_lt_u32 vcc, 20, v99
    s_mov_b32 s101, 1
    s_cbranch_vccz L2_xp13
    v_cmp_lt_u32 vcc, 32, v99
    v_cmp_lt_u32 s[58:59], 31, v88
    s_mov_b32 s101, 2
    s_or_b64 vcc, vcc, s[58:59]
    s_cbranch_scc0 L2_xp13
    s_mov_b32 s37, 0x10000
    s_branch L2_xp13
L2_c15:
    s_mov_b64 s[50:51], vcc
    s_lshl_b64 s[52:53], s[82:83], 1
    s_andn2_b64 s[52:53], s[52:53], s[80:81]
    s_andn2_b64 s[52:53], s[52:53], s[50:51]
    s_or_b64 s[80:81], s[80:81], s[52:53]
    s_not_b64 vcc, s[52:53]
    s_mov_b64 exec, -1
    v_cndmask_b32_dpp v84, v84, v84, vcc wave_shr:1 row_mask:0xf bank_mask:0xf
    v_cndmask_b32_dpp v85, v85, v85, vcc wave_shr:1 row_mask:0xf bank_mask:0xf
    s_lshr_b64 s[52:53], s[52:53], 1
    v_cndmask_b32_dpp v86, v86, v86, vcc wave_shr:1 row_mask:0xf bank_mask:0xf
    v_cndmask_b32_dpp v87, v87, v87, vcc wave_shr:1 row_mask:0xf bank_mask:0xf
    s_andn2_b64 s[82:83], s[82:83], s[52:53]
    v_cndmask_b32_dpp v7, v7, v7, vcc wave_shr:1 row_mask:0xf bank_mask:0xf
    s_mov_b64 vcc, s[50:51]
    s_mov_b64 exec, s[50:51]
    s_cbranch_scc0 L2_d15
    s_mov_b64 exec, s[82:83]
    s_nop 1
    v_mfma_f32_4x4x4_16b_bf16 v[88:91], v[12:13], v[84:85], 0
    s_nop 1
    v_mfma_f32_4x4x4_16b_bf16 v[88:91], v[10:11], v[86:87], v[88:91]
    s_nop 4
    v_cvt_pk_bf16_f32 v88, v88, v89
    v_cvt_pk_bf16_f32 v89, v90, v91
    ds_pk_add_bf16 v7, v88 offset:65408
    ds_pk_add_bf16 v7, v89 offset:65412
    s_mov_b64 exec, vcc
    s_branch L2_d15
L2_c16:
    s_mov_b64 s[50:51], vcc
    s_lshl_b64 s[52:53], s[82:83], 1
    s_andn2_b64 s[52:53], s[52:53], s[80:81]
    s_andn2_b64 s[52:53], s[52:53], s[50:51]
    s_or_b64 s[80:81], s[80:81], s[52:53]
    s_not_b64 vcc, s[52:53]
    s_mov_b64 exec, -1
    v_cndmask_b32_dpp v84, v84, v84, vcc wave_shr:1 row_mask:0xf bank_mask:0xf
    v_cndmask_b32_dpp v85, v85, v85, vcc wave_shr:1 row_mask:0xf bank_mask:0xf
    s_lshr_b64 s[52:53], s[52:53], 1
    v_cndmask_b32_dpp v86, v86, v86, vcc wave_shr:1 row_mask:0xf bank_mask:0xf
    v_cndmask_b32_dpp v87, v87, v87, vcc wave_shr:1 row_mask:0xf bank_mask:0xf
    s_andn2_b64 s[82:83], s[82:83], s[52:53]
    v_cndmask_b32_dpp v7, v7, v7, vcc wave_shr:1 row_mask:0xf bank_mask:0xf
    s_mov_b64 vcc, s[50:51]
    s_mov_b64 exec, s[50:51]
    s_cbranch_scc0 L2_d16
    s_mov_b64 exec, s[82:83]
    s_nop 1
    v_mfma_f32_4x4x4_16b_bf16 v[88:91], v[12:13], v[84:85], 0
    s_nop 1
    v_mfma_f32_4x4x4_16b_bf16 v[88:91], v[10:11], v[86:87], v[88:91]
    s_nop 4
    v_cvt_pk_bf16_f32 v88, v88, v89
    v_cvt_pk_bf16_f32 v89, v90, v91
    ds_pk_add_bf16 v7, v88 offset:65408
    ds_pk_add_bf16 v7, v89 offset:65412
    s_mov_b64 exec, vcc
    s_branch L2_d16
L2_c19:
    s_mov_b64 s[50:51], vcc
    s_lshl_b64 s[52:53], s[82:83], 1
    s_andn2_b64 s[52:53], s[52:53], s[80:81]
    s_andn2_b64 s[52:53], s[52:53], s[50:51]
    s_or_b64 s[80:81], s[80:81], s[52:53]
    s_not_b64 vcc, s[52:53]
    s_mov_b64 exec, -1
    v_cndmask_b32_dpp v84, v84, v84, vcc wave_shr:1 row_mask:0xf bank_mask:0xf
    v_cndmask_b32_dpp v85, v85, v85, vcc wave_shr:1 row_mask:0xf bank_mask:0xf
    s_lshr_b64 s[52:53], s[52:53], 1
    v_cndmask_b32_dpp v86, v86, v86, vcc wave_shr:1 row_mask:0xf bank_mask:0xf
    v_cndmask_b32_dpp v87, v87, v87, vcc wave_shr:1 row_mask:0xf bank_mask:0xf
    s_andn2_b64 s[82:83], s[82:83], s[52:53]
    v_cndmask_b32_dpp v7, v7, v7, vcc wave_shr:1 row_mask:0xf bank_mask:0xf
    s_mov_b64 vcc, s[50:51]
    s_mov_b64 exec, s[50:51]
    s_cbranch_scc0 L2_d19
    s_mov_b64 exec, s[82:83]
    s_nop 1
    v_mfma_f32_4x4x4_16b_bf16 v[88:91], v[12:13], v[84:85], 0
    s_nop 1
    v_mfma_f32_4x4x4_16b_bf16 v[88:91], v[10:11], v[86:87], v[88:91]
    s_nop 4
    v_cvt_pk_bf16_f32 v88, v88, v89
    v_cvt_pk_bf16_f32 v89, v90, v91
    ds_pk_add_bf16 v7, v88 offset:65408
    ds_pk_add_bf16 v7, v89 offset:65412
    s_mov_b64 exec, vcc
    s_branch L2_d19
L2_c20:
    s_mov_b64 s[50:51], vcc
    s_lshl_b64 s[52:53], s[82:83], 1
    s_andn2_b64 s[52:53], s[52:53], s[80:81]
    s_andn2_b64 s[52:53], s[52:53], s[50:51]
    s_or_b64 s[80:81], s[80:81], s[52:53]
    s_not_b64 vcc, s[52:53]
    s_mov_b64 exec, -1
    v_cndmask_b32_dpp v84, v84, v84, vcc wave_shr:1 row_mask:0xf bank_mask:0xf
    v_cndmask_b32_dpp v85, v85, v85, vcc wave_shr:1 row_mask:0xf bank_mask:0xf
    s_lshr_b64 s[52:53], s[52:53], 1
    v_cndmask_b32_dpp v86, v86, v86, vcc wave_shr:1 row_mask:0xf bank_mask:0xf
    v_cndmask_b32_dpp v87, v87, v87, vcc wave_shr:1 row_mask:0xf bank_mask:0xf
    s_andn2_b64 s[82:83], s[82:83], s[52:53]
    v_cndmask_b32_dpp v7, v7, v7, vcc wave_shr:1 row_mask:0xf bank_mask:0xf
    s_mov_b64 vcc, s[50:51]
    s_mov_b64 exec, s[50:51]
    s_cbranch_scc0 L2_d20
    s_mov_b64 exec, s[82:83]
    s_nop 1
    v_mfma_f32_4x4x4_16b_bf16 v[88:91], v[12:13], v[84:85], 0
    s_nop 1
    v_mfma_f32_4x4x4_16b_bf16 v[88:91], v[10:11], v[86:87], v[88:91]
    s_nop 4
    v_cvt_pk_bf16_f32 v88, v88, v89
    v_cvt_pk_bf16_f32 v89, v90, v91
    ds_pk_add_bf16 v7, v88 offset:65408
    ds_pk_add_bf16 v7, v89 offset:65412
    s_mov_b64 exec, vcc
    s_branch L2_d20
L2_c21:
    s_mov_b64 s[50:51], vcc
    s_lshl_b64 s[52:53], s[82:83], 1
    s_andn2_b64 s[52:53], s[52:53], s[80:81]
    s_andn2_b64 s[52:53], s[52:53], s[50:51]
    s_or_b64 s[80:81], s[80:81], s[52:53]
    s_not_b64 vcc, s[52:53]
    s_mov_b64 exec, -1
    v_cndmask_b32_dpp v84, v84, v84, vcc wave_shr:1 row_mask:0xf bank_mask:0xf
    v_cndmask_b32_dpp v85, v85, v85, vcc wave_shr:1 row_mask:0xf bank_mask:0xf
    s_lshr_b64 s[52:53], s[52:53], 1
    v_cndmask_b32_dpp v86, v86, v86, vcc wave_shr:1 row_mask:0xf bank_mask:0xf
    v_cndmask_b32_dpp v87, v87, v87, vcc wave_shr:1 row_mask:0xf bank_mask:0xf
    s_andn2_b64 s[82:83], s[82:83], s[52:53]
    v_cndmask_b32_dpp v7, v7, v7, vcc wave_shr:1 row_mask:0xf bank_mask:0xf
    s_mov_b64 vcc, s[50:51]
    s_mov_b64 exec, s[50:51]
    s_cbranch_scc0 L2_d21
    s_mov_b64 exec, s[82:83]
    s_nop 1
    v_mfma_f32_4x4x4_16b_bf16 v[88:91], v[12:13], v[84:85], 0
    s_nop 1
    v_mfma_f32_4x4x4_16b_bf16 v[88:91], v[10:11], v[86:87], v[88:91]
    s_nop 4
    v_cvt_pk_bf16_f32 v88, v88, v89
    v_cvt_pk_bf16_f32 v89, v90, v91
    ds_pk_add_bf16 v7, v88 offset:65408
    ds_pk_add_bf16 v7, v89 offset:65412
    s_mov_b64 exec, vcc
    s_branch L2_d21
L2_c22:
    s_mov_b64 s[50:51], vcc
    s_lshl_b64 s[52:53], s[82:83], 1
    s_andn2_b64 s[52:53], s[52:53], s[80:81]
    s_andn2_b64 s[52:53], s[52:53], s[50:51]
    s_or_b64 s[80:81], s[80:81], s[52:53]
    s_not_b64 vcc, s[52:53]
    s_mov_b64 exec, -1
    v_cndmask_b32_dpp v84, v84, v84, vcc wave_shr:1 row_mask:0xf bank_mask:0xf
    v_cndmask_b32_dpp v85, v85, v85, vcc wave_shr:1 row_mask:0xf bank_mask:0xf
    s_lshr_b64 s[52:53], s[52:53], 1
    v_cndmask_b32_dpp v86, v86, v86, vcc wave_shr:1 row_mask:0xf bank_mask:0xf
    v_cndmask_b32_dpp v87, v87, v87, vcc wave_shr:1 row_mask:0xf bank_mask:0xf
    s_andn2_b64 s[82:83], s[82:83], s[52:53]
    v_cndmask_b32_dpp v7, v7, v7, vcc wave_shr:1 row_mask:0xf bank_mask:0xf
    s_mov_b64 vcc, s[50:51]
    s_mov_b64 exec, s[50:51]
    s_cbranch_scc0 L2_d22
    s_mov_b64 exec, s[82:83]
    s_nop 1
    v_mfma_f32_4x4x4_16b_bf16 v[88:91], v[12:13], v[84:85], 0
    s_nop 1
    v_mfma_f32_4x4x4_16b_bf16 v[88:91], v[10:11], v[86:87], v[88:91]
    s_nop 4
    v_cvt_pk_bf16_f32 v88, v88, v89
    v_cvt_pk_bf16_f32 v89, v90, v91
    ds_pk_add_bf16 v7, v88 offset:65408
    ds_pk_add_bf16 v7, v89 offset:65412
    s_mov_b64 exec, vcc
    s_branch L2_d22
L2_c23:
    s_mov_b64 s[50:51], vcc
    s_lshl_b64 s[52:53], s[82:83], 1
    s_andn2_b64 s[52:53], s[52:53], s[80:81]
    s_andn2_b64 s[52:53], s[52:53], s[50:51]
    s_or_b64 s[80:81], s[80:81], s[52:53]
    s_not_b64 vcc, s[52:53]
    s_mov_b64 exec, -1
    v_cndmask_b32_dpp v84, v84, v84, vcc wave_shr:1 row_mask:0xf bank_mask:0xf
    v_cndmask_b32_dpp v85, v85, v85, vcc wave_shr:1 row_mask:0xf bank_mask:0xf
    s_lshr_b64 s[52:53], s[52:53], 1
    v_cndmask_b32_dpp v86, v86, v86, vcc wave_shr:1 row_mask:0xf bank_mask:0xf
    v_cndmask_b32_dpp v87, v87, v87, vcc wave_shr:1 row_mask:0xf bank_mask:0xf
    s_andn2_b64 s[82:83], s[82:83], s[52:53]
    v_cndmask_b32_dpp v7, v7, v7, vcc wave_shr:1 row_mask:0xf bank_mask:0xf
    s_mov_b64 vcc, s[50:51]
    s_mov_b64 exec, s[50:51]
    s_cbranch_scc0 L2_d23
    s_mov_b64 exec, s[82:83]
    s_nop 1
    v_mfma_f32_4x4x4_16b_bf16 v[88:91], v[12:13], v[84:85], 0
    s_nop 1
    v_mfma_f32_4x4x4_16b_bf16 v[88:91], v[10:11], v[86:87], v[88:91]
    s_nop 4
    v_cvt_pk_bf16_f32 v88, v88, v89
    v_cvt_pk_bf16_f32 v89, v90, v91
    ds_pk_add_bf16 v7, v88 offset:65408
    ds_pk_add_bf16 v7, v89 offset:65412
    s_mov_b64 exec, vcc
    s_branch L2_d23
L2_c24:
    s_mov_b64 s[50:51], vcc
    s_lshl_b64 s[52:53], s[82:83], 1
    s_andn2_b64 s[52:53], s[52:53], s[80:81]
    s_andn2_b64 s[52:53], s[52:53], s[50:51]
    s_or_b64 s[80:81], s[80:81], s[52:53]
    s_not_b64 vcc, s[52:53]
    s_mov_b64 exec, -1
    v_cndmask_b32_dpp v84, v84, v84, vcc wave_shr:1 row_mask:0xf bank_mask:0xf
    v_cndmask_b32_dpp v85, v85, v85, vcc wave_shr:1 row_mask:0xf bank_mask:0xf
    s_lshr_b64 s[52:53], s[52:53], 1
    v_cndmask_b32_dpp v86, v86, v86, vcc wave_shr:1 row_mask:0xf bank_mask:0xf
    v_cndmask_b32_dpp v87, v87, v87, vcc wave_shr:1 row_mask:0xf bank_mask:0xf
    s_andn2_b64 s[82:83], s[82:83], s[52:53]
    v_cndmask_b32_dpp v7, v7, v7, vcc wave_shr:1 row_mask:0xf bank_mask:0xf
    s_mov_b64 vcc, s[50:51]
    s_mov_b64 exec, s[50:51]
    s_cbranch_scc0 L2_d24
    s_mov_b64 exec, s[82:83]
    s_nop 1
    v_mfma_f32_4x4x4_16b_bf16 v[88:91], v[12:13], v[84:85], 0
    s_nop 1
    v_mfma_f32_4x4x4_16b_bf16 v[88:91], v[10:11], v[86:87], v[88:91]
    s_nop 4
    v_cvt_pk_bf16_f32 v88, v88, v89
    v_cvt_pk_bf16_f32 v89, v90, v91
    ds_pk_add_bf16 v7, v88 offset:65408
    ds_pk_add_bf16 v7, v89 offset:65412
    s_mov_b64 exec, vcc
    s_branch L2_d24
L2_xa25:
    s_cmp_eq_u32 s101, 1
    s_cbranch_scc1 L2_xc25
    v_lshlrev_b32 v89, 0, v96
    v_add_u32 v90, 140, v97
    v_bitop3_b32 v90, v89, v45, v90 bitop3:0x6a
    ds_write_b32 v98, v90 offset:28
    v_lshlrev_b32 v89, 4, v96
    v_add_u32 v90, 120, v97
    v_bitop3_b32 v90, v89, v45, v90 bitop3:0x6a
    ds_write_b32 v98, v90 offset:24
    v_lshlrev_b32 v89, 8, v96
    v_add_u32 v90, 100, v97
    v_bitop3_b32 v90, v89, v45, v90 bitop3:0x6a
    ds_write_b32 v98, v90 offset:20
L2_xc25:
    v_lshlrev_b32 v89, 12, v96
    v_add_u32 v90, 80, v97
    v_bitop3_b32 v90, v89, v45, v90 bitop3:0x6a
    ds_write_b32 v98, v90 offset:16
    s_branch L2_xb25
L2_xe25:
    v_cmp_lt_u32 vcc, 32, v99
    v_cmp_lt_u32 s[58:59], 31, v88
    v_lshrrev_b32 v89, 16, v96
    v_add_u32 v97, 80, v97
    s_or_b64 vcc, vcc, s[58:59]
    s_cbranch_scc1 L2_xs25
    v_lshlrev_b32 v89, v1, v89
    v_and_b32 v89, v45, v89
    v_cmp_ne_u32 vcc, 0, v89
    v_xor_b32 v90, v97, v89
    s_add_u32 s3, s37, s38
    v_mbcnt_lo_u32_b32 v98, vcc_lo, 0
    v_mbcnt_hi_u32_b32 v98, vcc_hi, v98
    s_bcnt1_i32_b64 s41, vcc
    v_lshl_add_u32 v98, v98, 2, s3
    s_mov_b64 exec, vcc
    ds_write_b32 v98, v90
    s_mov_b64 exec, -1
    s_lshl2_add_u32 s37, s41, s37
    s_branch L2_xr25
L2_xf25:
    s_waitcnt lgkmcnt(0)
    s_cmp_gt_u32 s37, 1024
    s_cbranch_scc1 L2_xs25
    v_mov_b32 v43, -1
    s_cmp_ge_u32 s37, 512
    s_cbranch_scc1 L2_xg25
    v_mov_b32 v42, -1
    s_cmp_ge_u32 s37, 256
    s_cbranch_scc1 L2_xg25
    v_mov_b32 v41, -1
    s_branch L2_xg25
L2_xs25:
    s_waitcnt lgkmcnt(0)
    v_mov_b32 v40, -1
    v_mov_b32 v41, -1
    v_mov_b32 v42, -1
    v_mov_b32 v43, -1
    s_add_u32 s3, s42, 2
    s_bitset1_b32 s36, s3
    s_branch L2_xg25
L2_c26:
    s_mov_b64 s[50:51], vcc
    s_lshl_b64 s[52:53], s[82:83], 1
    s_andn2_b64 s[52:53], s[52:53], s[80:81]
    s_andn2_b64 s[52:53], s[52:53], s[50:51]
    s_or_b64 s[80:81], s[80:81], s[52:53]
    s_not_b64 vcc, s[52:53]
    s_mov_b64 exec, -1
    v_cndmask_b32_dpp v84, v84, v84, vcc wave_shr:1 row_mask:0xf bank_mask:0xf
    v_cndmask_b32_dpp v85, v85, v85, vcc wave_shr:1 row_mask:0xf bank_mask:0xf
    s_lshr_b64 s[52:53], s[52:53], 1
    v_cndmask_b32_dpp v86, v86, v86, vcc wave_shr:1 row_mask:0xf bank_mask:0xf
    v_cndmask_b32_dpp v87, v87, v87, vcc wave_shr:1 row_mask:0xf bank_mask:0xf
    s_andn2_b64 s[82:83], s[82:83], s[52:53]
    v_cndmask_b32_dpp v7, v7, v7, vcc wave_shr:1 row_mask:0xf bank_mask:0xf
    s_mov_b64 vcc, s[50:51]
    s_mov_b64 exec, s[50:51]
    s_cbranch_scc0 L2_d26
    s_mov_b64 exec, s[82:83]
    s_nop 1
    v_mfma_f32_4x4x4_16b_bf16 v[88:91], v[12:13], v[84:85], 0
    s_nop 1
    v_mfma_f32_4x4x4_16b_bf16 v[88:91], v[10:11], v[86:87], v[88:91]
    s_nop 4
    v_cvt_pk_bf16_f32 v88, v88, v89
    v_cvt_pk_bf16_f32 v89, v90, v91
    ds_pk_add_bf16 v7, v88 offset:65408
    ds_pk_add_bf16 v7, v89 offset:65412
    s_mov_b64 exec, vcc
    s_branch L2_d26
L2_c27:
    s_mov_b64 s[50:51], vcc
    s_lshl_b64 s[52:53], s[82:83], 1
    s_andn2_b64 s[52:53], s[52:53], s[80:81]
    s_andn2_b64 s[52:53], s[52:53], s[50:51]
    s_or_b64 s[80:81], s[80:81], s[52:53]
    s_not_b64 vcc, s[52:53]
    s_mov_b64 exec, -1
    v_cndmask_b32_dpp v84, v84, v84, vcc wave_shr:1 row_mask:0xf bank_mask:0xf
    v_cndmask_b32_dpp v85, v85, v85, vcc wave_shr:1 row_mask:0xf bank_mask:0xf
    s_lshr_b64 s[52:53], s[52:53], 1
    v_cndmask_b32_dpp v86, v86, v86, vcc wave_shr:1 row_mask:0xf bank_mask:0xf
    v_cndmask_b32_dpp v87, v87, v87, vcc wave_shr:1 row_mask:0xf bank_mask:0xf
    s_andn2_b64 s[82:83], s[82:83], s[52:53]
    v_cndmask_b32_dpp v7, v7, v7, vcc wave_shr:1 row_mask:0xf bank_mask:0xf
    s_mov_b64 vcc, s[50:51]
    s_mov_b64 exec, s[50:51]
    s_cbranch_scc0 L2_d27
    s_mov_b64 exec, s[82:83]
    s_nop 1
    v_mfma_f32_4x4x4_16b_bf16 v[88:91], v[12:13], v[84:85], 0
    s_nop 1
    v_mfma_f32_4x4x4_16b_bf16 v[88:91], v[10:11], v[86:87], v[88:91]
    s_nop 4
    v_cvt_pk_bf16_f32 v88, v88, v89
    v_cvt_pk_bf16_f32 v89, v90, v91
    ds_pk_add_bf16 v7, v88 offset:65408
    ds_pk_add_bf16 v7, v89 offset:65412
    s_mov_b64 exec, vcc
    s_branch L2_d27
L2_c28:
    s_mov_b64 s[50:51], vcc
    s_lshl_b64 s[52:53], s[82:83], 1
    s_andn2_b64 s[52:53], s[52:53], s[80:81]
    s_andn2_b64 s[52:53], s[52:53], s[50:51]
    s_or_b64 s[80:81], s[80:81], s[52:53]
    s_not_b64 vcc, s[52:53]
    s_mov_b64 exec, -1
    v_cndmask_b32_dpp v84, v84, v84, vcc wave_shr:1 row_mask:0xf bank_mask:0xf
    v_cndmask_b32_dpp v85, v85, v85, vcc wave_shr:1 row_mask:0xf bank_mask:0xf
    s_lshr_b64 s[52:53], s[52:53], 1
    v_cndmask_b32_dpp v86, v86, v86, vcc wave_shr:1 row_mask:0xf bank_mask:0xf
    v_cndmask_b32_dpp v87, v87, v87, vcc wave_shr:1 row_mask:0xf bank_mask:0xf
    s_andn2_b64 s[82:83], s[82:83], s[52:53]
    v_cndmask_b32_dpp v7, v7, v7, vcc wave_shr:1 row_mask:0xf bank_mask:0xf
    s_mov_b64 vcc, s[50:51]
    s_mov_b64 exec, s[50:51]
    s_cbranch_scc0 L2_d28
    s_mov_b64 exec, s[82:83]
    s_nop 1
    v_mfma_f32_4x4x4_16b_bf16 v[88:91], v[12:13], v[84:85], 0
    s_nop 1
    v_mfma_f32_4x4x4_16b_bf16 v[88:91], v[10:11], v[86:87], v[88:91]
    s_nop 4
    v_cvt_pk_bf16_f32 v88, v88, v89
    v_cvt_pk_bf16_f32 v89, v90, v91
    ds_pk_add_bf16 v7, v88 offset:65408
    ds_pk_add_bf16 v7, v89 offset:65412
    s_mov_b64 exec, vcc
    s_branch L2_d28
L2_c29:
    s_mov_b64 s[50:51], vcc
    s_lshl_b64 s[52:53], s[82:83], 1
    s_andn2_b64 s[52:53], s[52:53], s[80:81]
    s_andn2_b64 s[52:53], s[52:53], s[50:51]
    s_or_b64 s[80:81], s[80:81], s[52:53]
    s_not_b64 vcc, s[52:53]
    s_mov_b64 exec, -1
    v_cndmask_b32_dpp v84, v84, v84, vcc wave_shr:1 row_mask:0xf bank_mask:0xf
    v_cndmask_b32_dpp v85, v85, v85, vcc wave_shr:1 row_mask:0xf bank_mask:0xf
    s_lshr_b64 s[52:53], s[52:53], 1
    v_cndmask_b32_dpp v86, v86, v86, vcc wave_shr:1 row_mask:0xf bank_mask:0xf
    v_cndmask_b32_dpp v87, v87, v87, vcc wave_shr:1 row_mask:0xf bank_mask:0xf
    s_andn2_b64 s[82:83], s[82:83], s[52:53]
    v_cndmask_b32_dpp v7, v7, v7, vcc wave_shr:1 row_mask:0xf bank_mask:0xf
    s_mov_b64 vcc, s[50:51]
    s_mov_b64 exec, s[50:51]
    s_cbranch_scc0 L2_d29
    s_mov_b64 exec, s[82:83]
    s_nop 1
    v_mfma_f32_4x4x4_16b_bf16 v[88:91], v[12:13], v[84:85], 0
    s_nop 1
    v_mfma_f32_4x4x4_16b_bf16 v[88:91], v[10:11], v[86:87], v[88:91]
    s_nop 4
    v_cvt_pk_bf16_f32 v88, v88, v89
    v_cvt_pk_bf16_f32 v89, v90, v91
    ds_pk_add_bf16 v7, v88 offset:65408
    ds_pk_add_bf16 v7, v89 offset:65412
    s_mov_b64 exec, vcc
    s_branch L2_d29
L2_c30:
    s_mov_b64 s[50:51], vcc
    s_lshl_b64 s[52:53], s[82:83], 1
    s_andn2_b64 s[52:53], s[52:53], s[80:81]
    s_andn2_b64 s[52:53], s[52:53], s[50:51]
    s_or_b64 s[80:81], s[80:81], s[52:53]
    s_not_b64 vcc, s[52:53]
    s_mov_b64 exec, -1
    v_cndmask_b32_dpp v84, v84, v84, vcc wave_shr:1 row_mask:0xf bank_mask:0xf
    v_cndmask_b32_dpp v85, v85, v85, vcc wave_shr:1 row_mask:0xf bank_mask:0xf
    s_lshr_b64 s[52:53], s[52:53], 1
    v_cndmask_b32_dpp v86, v86, v86, vcc wave_shr:1 row_mask:0xf bank_mask:0xf
    v_cndmask_b32_dpp v87, v87, v87, vcc wave_shr:1 row_mask:0xf bank_mask:0xf
    s_andn2_b64 s[82:83], s[82:83], s[52:53]
    v_cndmask_b32_dpp v7, v7, v7, vcc wave_shr:1 row_mask:0xf bank_mask:0xf
    s_mov_b64 vcc, s[50:51]
    s_mov_b64 exec, s[50:51]
    s_cbranch_scc0 L2_d30
    s_mov_b64 exec, s[82:83]
    s_nop 1
    v_mfma_f32_4x4x4_16b_bf16 v[88:91], v[12:13], v[84:85], 0
    s_nop 1
    v_mfma_f32_4x4x4_16b_bf16 v[88:91], v[10:11], v[86:87], v[88:91]
    s_nop 4
    v_cvt_pk_bf16_f32 v88, v88, v89
    v_cvt_pk_bf16_f32 v89, v90, v91
    ds_pk_add_bf16 v7, v88 offset:65408
    ds_pk_add_bf16 v7, v89 offset:65412
    s_mov_b64 exec, vcc
    s_branch L2_d30
L2_c31:
    s_mov_b64 s[50:51], vcc
    s_lshl_b64 s[52:53], s[82:83], 1
    s_andn2_b64 s[52:53], s[52:53], s[80:81]
    s_andn2_b64 s[52:53], s[52:53], s[50:51]
    s_or_b64 s[80:81], s[80:81], s[52:53]
    s_not_b64 vcc, s[52:53]
    s_mov_b64 exec, -1
    v_cndmask_b32_dpp v84, v84, v84, vcc wave_shr:1 row_mask:0xf bank_mask:0xf
    v_cndmask_b32_dpp v85, v85, v85, vcc wave_shr:1 row_mask:0xf bank_mask:0xf
    s_lshr_b64 s[52:53], s[52:53], 1
    v_cndmask_b32_dpp v86, v86, v86, vcc wave_shr:1 row_mask:0xf bank_mask:0xf
    v_cndmask_b32_dpp v87, v87, v87, vcc wave_shr:1 row_mask:0xf bank_mask:0xf
    s_andn2_b64 s[82:83], s[82:83], s[52:53]
    v_cndmask_b32_dpp v7, v7, v7, vcc wave_shr:1 row_mask:0xf bank_mask:0xf
    s_mov_b64 vcc, s[50:51]
    s_mov_b64 exec, s[50:51]
    s_cbranch_scc0 L2_d31
    s_mov_b64 exec, s[82:83]
    s_nop 1
    v_mfma_f32_4x4x4_16b_bf16 v[88:91], v[12:13], v[84:85], 0
    s_nop 1
    v_mfma_f32_4x4x4_16b_bf16 v[88:91], v[10:11], v[86:87], v[88:91]
    s_nop 4
    v_cvt_pk_bf16_f32 v88, v88, v89
    v_cvt_pk_bf16_f32 v89, v90, v91
    ds_pk_add_bf16 v7, v88 offset:65408
    ds_pk_add_bf16 v7, v89 offset:65412
    s_mov_b64 exec, vcc
    s_branch L2_d31
L2_c32:
    s_mov_b64 s[50:51], vcc
    s_lshl_b64 s[52:53], s[82:83], 1
    s_andn2_b64 s[52:53], s[52:53], s[80:81]
    s_andn2_b64 s[52:53], s[52:53], s[50:51]
    s_or_b64 s[80:81], s[80:81], s[52:53]
    s_not_b64 vcc, s[52:53]
    s_mov_b64 exec, -1
    v_cndmask_b32_dpp v84, v84, v84, vcc wave_shr:1 row_mask:0xf bank_mask:0xf
    v_cndmask_b32_dpp v85, v85, v85, vcc wave_shr:1 row_mask:0xf bank_mask:0xf
    s_lshr_b64 s[52:53], s[52:53], 1
    v_cndmask_b32_dpp v86, v86, v86, vcc wave_shr:1 row_mask:0xf bank_mask:0xf
    v_cndmask_b32_dpp v87, v87, v87, vcc wave_shr:1 row_mask:0xf bank_mask:0xf
    s_andn2_b64 s[82:83], s[82:83], s[52:53]
    v_cndmask_b32_dpp v7, v7, v7, vcc wave_shr:1 row_mask:0xf bank_mask:0xf
    s_mov_b64 vcc, s[50:51]
    s_mov_b64 exec, s[50:51]
    s_cbranch_scc0 L2_d32
    s_mov_b64 exec, s[82:83]
    s_nop 1
    v_mfma_f32_4x4x4_16b_bf16 v[88:91], v[12:13], v[84:85], 0
    s_nop 1
    v_mfma_f32_4x4x4_16b_bf16 v[88:91], v[10:11], v[86:87], v[88:91]
    s_nop 4
    v_cvt_pk_bf16_f32 v88, v88, v89
    v_cvt_pk_bf16_f32 v89, v90, v91
    ds_pk_add_bf16 v7, v88 offset:65408
    ds_pk_add_bf16 v7, v89 offset:65412
    s_mov_b64 exec, vcc
    s_branch L2_d32
L2_c33:
    s_mov_b64 s[50:51], vcc
    s_lshl_b64 s[52:53], s[82:83], 1
    s_andn2_b64 s[52:53], s[52:53], s[80:81]
    s_andn2_b64 s[52:53], s[52:53], s[50:51]
    s_or_b64 s[80:81], s[80:81], s[52:53]
    s_not_b64 vcc, s[52:53]
    s_mov_b64 exec, -1
    v_cndmask_b32_dpp v84, v84, v84, vcc wave_shr:1 row_mask:0xf bank_mask:0xf
    v_cndmask_b32_dpp v85, v85, v85, vcc wave_shr:1 row_mask:0xf bank_mask:0xf
    s_lshr_b64 s[52:53], s[52:53], 1
    v_cndmask_b32_dpp v86, v86, v86, vcc wave_shr:1 row_mask:0xf bank_mask:0xf
    v_cndmask_b32_dpp v87, v87, v87, vcc wave_shr:1 row_mask:0xf bank_mask:0xf
    s_andn2_b64 s[82:83], s[82:83], s[52:53]
    v_cndmask_b32_dpp v7, v7, v7, vcc wave_shr:1 row_mask:0xf bank_mask:0xf
    s_mov_b64 vcc, s[50:51]
    s_mov_b64 exec, s[50:51]
    s_cbranch_scc0 L2_d33
    s_mov_b64 exec, s[82:83]
    s_nop 1
    v_mfma_f32_4x4x4_16b_bf16 v[88:91], v[12:13], v[84:85], 0
    s_nop 1
    v_mfma_f32_4x4x4_16b_bf16 v[88:91], v[10:11], v[86:87], v[88:91]
    s_nop 4
    v_cvt_pk_bf16_f32 v88, v88, v89
    v_cvt_pk_bf16_f32 v89, v90, v91
    ds_pk_add_bf16 v7, v88 offset:65408
    ds_pk_add_bf16 v7, v89 offset:65412
    s_mov_b64 exec, vcc
    s_branch L2_d33
L2_xo34:
    v_cmp_lt_u32 vcc, 20, v99
    s_mov_b32 s101, 1
    s_cbranch_vccz L2_xp34
    v_cmp_lt_u32 vcc, 32, v99
    v_cmp_lt_u32 s[58:59], 31, v88
    s_mov_b32 s101, 2
    s_or_b64 vcc, vcc, s[58:59]
    s_cbranch_scc0 L2_xp34
    s_mov_b32 s37, 0x10000
    s_branch L2_xp34
L2_c35:
    s_mov_b64 s[50:51], vcc
    s_lshl_b64 s[52:53], s[82:83], 1
    s_andn2_b64 s[52:53], s[52:53], s[80:81]
    s_andn2_b64 s[52:53], s[52:53], s[50:51]
    s_or_b64 s[80:81], s[80:81], s[52:53]
    s_not_b64 vcc, s[52:53]
    s_mov_b64 exec, -1
    v_cndmask_b32_dpp v84, v84, v84, vcc wave_shr:1 row_mask:0xf bank_mask:0xf
    v_cndmask_b32_dpp v85, v85, v85, vcc wave_shr:1 row_mask:0xf bank_mask:0xf
    s_lshr_b64 s[52:53], s[52:53], 1
    v_cndmask_b32_dpp v86, v86, v86, vcc wave_shr:1 row_mask:0xf bank_mask:0xf
    v_cndmask_b32_dpp v87, v87, v87, vcc wave_shr:1 row_mask:0xf bank_mask:0xf
    s_andn2_b64 s[82:83], s[82:83], s[52:53]
    v_cndmask_b32_dpp v7, v7, v7, vcc wave_shr:1 row_mask:0xf bank_mask:0xf
    s_mov_b64 vcc, s[50:51]
    s_mov_b64 exec, s[50:51]
    s_cbranch_scc0 L2_d35
    s_mov_b64 exec, s[82:83]
    s_nop 1
    v_mfma_f32_4x4x4_16b_bf16 v[88:91], v[12:13], v[84:85], 0
    s_nop 1
    v_mfma_f32_4x4x4_16b_bf16 v[88:91], v[10:11], v[86:87], v[88:91]
    s_nop 4
    v_cvt_pk_bf16_f32 v88, v88, v89
    v_cvt_pk_bf16_f32 v89, v90, v91
    ds_pk_add_bf16 v7, v88 offset:65408
    ds_pk_add_bf16 v7, v89 offset:65412
    s_mov_b64 exec, vcc
    s_branch L2_d35
L2_c36:
    s_mov_b64 s[50:51], vcc
    s_lshl_b64 s[52:53], s[82:83], 1
    s_andn2_b64 s[52:53], s[52:53], s[80:81]
    s_andn2_b64 s[52:53], s[52:53], s[50:51]
    s_or_b64 s[80:81], s[80:81], s[52:53]
    s_not_b64 vcc, s[52:53]
    s_mov_b64 exec, -1
    v_cndmask_b32_dpp v84, v84, v84, vcc wave_shr:1 row_mask:0xf bank_mask:0xf
    v_cndmask_b32_dpp v85, v85, v85, vcc wave_shr:1 row_mask:0xf bank_mask:0xf
    s_lshr_b64 s[52:53], s[52:53], 1
    v_cndmask_b32_dpp v86, v86, v86, vcc wave_shr:1 row_mask:0xf bank_mask:0xf
    v_cndmask_b32_dpp v87, v87, v87, vcc wave_shr:1 row_mask:0xf bank_mask:0xf
    s_andn2_b64 s[82:83], s[82:83], s[52:53]
    v_cndmask_b32_dpp v7, v7, v7, vcc wave_shr:1 row_mask:0xf bank_mask:0xf
    s_mov_b64 vcc, s[50:51]
    s_mov_b64 exec, s[50:51]
    s_cbranch_scc0 L2_d36
    s_mov_b64 exec, s[82:83]
    s_nop 1
    v_mfma_f32_4x4x4_16b_bf16 v[88:91], v[12:13], v[84:85], 0
    s_nop 1
    v_mfma_f32_4x4x4_16b_bf16 v[88:91], v[10:11], v[86:87], v[88:91]
    s_nop 4
    v_cvt_pk_bf16_f32 v88, v88, v89
    v_cvt_pk_bf16_f32 v89, v90, v91
    ds_pk_add_bf16 v7, v88 offset:65408
    ds_pk_add_bf16 v7, v89 offset:65412
    s_mov_b64 exec, vcc
    s_branch L2_d36
L2_c37:
    s_mov_b64 s[50:51], vcc
    s_lshl_b64 s[52:53], s[82:83], 1
    s_andn2_b64 s[52:53], s[52:53], s[80:81]
    s_andn2_b64 s[52:53], s[52:53], s[50:51]
    s_or_b64 s[80:81], s[80:81], s[52:53]
    s_not_b64 vcc, s[52:53]
    s_mov_b64 exec, -1
    v_cndmask_b32_dpp v84, v84, v84, vcc wave_shr:1 row_mask:0xf bank_mask:0xf
    v_cndmask_b32_dpp v85, v85, v85, vcc wave_shr:1 row_mask:0xf bank_mask:0xf
    s_lshr_b64 s[52:53], s[52:53], 1
    v_cndmask_b32_dpp v86, v86, v86, vcc wave_shr:1 row_mask:0xf bank_mask:0xf
    v_cndmask_b32_dpp v87, v87, v87, vcc wave_shr:1 row_mask:0xf bank_mask:0xf
    s_andn2_b64 s[82:83], s[82:83], s[52:53]
    v_cndmask_b32_dpp v7, v7, v7, vcc wave_shr:1 row_mask:0xf bank_mask:0xf
    s_mov_b64 vcc, s[50:51]
    s_mov_b64 exec, s[50:51]
    s_cbranch_scc0 L2_d37
    s_mov_b64 exec, s[82:83]
    s_nop 1
    v_mfma_f32_4x4x4_16b_bf16 v[88:91], v[12:13], v[84:85], 0
    s_nop 1
    v_mfma_f32_4x4x4_16b_bf16 v[88:91], v[10:11], v[86:87], v[88:91]
    s_nop 4
    v_cvt_pk_bf16_f32 v88, v88, v89
    v_cvt_pk_bf16_f32 v89, v90, v91
    ds_pk_add_bf16 v7, v88 offset:65408
    ds_pk_add_bf16 v7, v89 offset:65412
    s_mov_b64 exec, vcc
    s_branch L2_d37
L2_c38:
    s_mov_b64 s[50:51], vcc
    s_lshl_b64 s[52:53], s[82:83], 1
    s_andn2_b64 s[52:53], s[52:53], s[80:81]
    s_andn2_b64 s[52:53], s[52:53], s[50:51]
    s_or_b64 s[80:81], s[80:81], s[52:53]
    s_not_b64 vcc, s[52:53]
    s_mov_b64 exec, -1
    v_cndmask_b32_dpp v84, v84, v84, vcc wave_shr:1 row_mask:0xf bank_mask:0xf
    v_cndmask_b32_dpp v85, v85, v85, vcc wave_shr:1 row_mask:0xf bank_mask:0xf
    s_lshr_b64 s[52:53], s[52:53], 1
    v_cndmask_b32_dpp v86, v86, v86, vcc wave_shr:1 row_mask:0xf bank_mask:0xf
    v_cndmask_b32_dpp v87, v87, v87, vcc wave_shr:1 row_mask:0xf bank_mask:0xf
    s_andn2_b64 s[82:83], s[82:83], s[52:53]
    v_cndmask_b32_dpp v7, v7, v7, vcc wave_shr:1 row_mask:0xf bank_mask:0xf
    s_mov_b64 vcc, s[50:51]
    s_mov_b64 exec, s[50:51]
    s_cbranch_scc0 L2_d38
    s_mov_b64 exec, s[82:83]
    s_nop 1
    v_mfma_f32_4x4x4_16b_bf16 v[88:91], v[12:13], v[84:85], 0
    s_nop 1
    v_mfma_f32_4x4x4_16b_bf16 v[88:91], v[10:11], v[86:87], v[88:91]
    s_nop 4
    v_cvt_pk_bf16_f32 v88, v88, v89
    v_cvt_pk_bf16_f32 v89, v90, v91
    ds_pk_add_bf16 v7, v88 offset:65408
    ds_pk_add_bf16 v7, v89 offset:65412
    s_mov_b64 exec, vcc
    s_branch L2_d38
L2_c39:
    s_mov_b64 s[50:51], vcc
    s_lshl_b64 s[52:53], s[82:83], 1
    s_andn2_b64 s[52:53], s[52:53], s[80:81]
    s_andn2_b64 s[52:53], s[52:53], s[50:51]
    s_or_b64 s[80:81], s[80:81], s[52:53]
    s_not_b64 vcc, s[52:53]
    s_mov_b64 exec, -1
    v_cndmask_b32_dpp v84, v84, v84, vcc wave_shr:1 row_mask:0xf bank_mask:0xf
    v_cndmask_b32_dpp v85, v85, v85, vcc wave_shr:1 row_mask:0xf bank_mask:0xf
    s_lshr_b64 s[52:53], s[52:53], 1
    v_cndmask_b32_dpp v86, v86, v86, vcc wave_shr:1 row_mask:0xf bank_mask:0xf
    v_cndmask_b32_dpp v87, v87, v87, vcc wave_shr:1 row_mask:0xf bank_mask:0xf
    s_andn2_b64 s[82:83], s[82:83], s[52:53]
    v_cndmask_b32_dpp v7, v7, v7, vcc wave_shr:1 row_mask:0xf bank_mask:0xf
    s_mov_b64 vcc, s[50:51]
    s_mov_b64 exec, s[50:51]
    s_cbranch_scc0 L2_d39
    s_mov_b64 exec, s[82:83]
    s_nop 1
    v_mfma_f32_4x4x4_16b_bf16 v[88:91], v[12:13], v[84:85], 0
    s_nop 1
    v_mfma_f32_4x4x4_16b_bf16 v[88:91], v[10:11], v[86:87], v[88:91]
    s_nop 4
    v_cvt_pk_bf16_f32 v88, v88, v89
    v_cvt_pk_bf16_f32 v89, v90, v91
    ds_pk_add_bf16 v7, v88 offset:65408
    ds_pk_add_bf16 v7, v89 offset:65412
    s_mov_b64 exec, vcc
    s_branch L2_d39
L2_c40:
    s_mov_b64 s[50:51], vcc
    s_lshl_b64 s[52:53], s[82:83], 1
    s_andn2_b64 s[52:53], s[52:53], s[80:81]
    s_andn2_b64 s[52:53], s[52:53], s[50:51]
    s_or_b64 s[80:81], s[80:81], s[52:53]
    s_not_b64 vcc, s[52:53]
    s_mov_b64 exec, -1
    v_cndmask_b32_dpp v84, v84, v84, vcc wave_shr:1 row_mask:0xf bank_mask:0xf
    v_cndmask_b32_dpp v85, v85, v85, vcc wave_shr:1 row_mask:0xf bank_mask:0xf
    s_lshr_b64 s[52:53], s[52:53], 1
    v_cndmask_b32_dpp v86, v86, v86, vcc wave_shr:1 row_mask:0xf bank_mask:0xf
    v_cndmask_b32_dpp v87, v87, v87, vcc wave_shr:1 row_mask:0xf bank_mask:0xf
    s_andn2_b64 s[82:83], s[82:83], s[52:53]
    v_cndmask_b32_dpp v7, v7, v7, vcc wave_shr:1 row_mask:0xf bank_mask:0xf
    s_mov_b64 vcc, s[50:51]
    s_mov_b64 exec, s[50:51]
    s_cbranch_scc0 L2_d40
    s_mov_b64 exec, s[82:83]
    s_nop 1
    v_mfma_f32_4x4x4_16b_bf16 v[88:91], v[12:13], v[84:85], 0
    s_nop 1
    v_mfma_f32_4x4x4_16b_bf16 v[88:91], v[10:11], v[86:87], v[88:91]
    s_nop 4
    v_cvt_pk_bf16_f32 v88, v88, v89
    v_cvt_pk_bf16_f32 v89, v90, v91
    ds_pk_add_bf16 v7, v88 offset:65408
    ds_pk_add_bf16 v7, v89 offset:65412
    s_mov_b64 exec, vcc
    s_branch L2_d40
L2_c41:
    s_mov_b64 s[50:51], vcc
    s_lshl_b64 s[52:53], s[82:83], 1
    s_andn2_b64 s[52:53], s[52:53], s[80:81]
    s_andn2_b64 s[52:53], s[52:53], s[50:51]
    s_or_b64 s[80:81], s[80:81], s[52:53]
    s_not_b64 vcc, s[52:53]
    s_mov_b64 exec, -1
    v_cndmask_b32_dpp v84, v84, v84, vcc wave_shr:1 row_mask:0xf bank_mask:0xf
    v_cndmask_b32_dpp v85, v85, v85, vcc wave_shr:1 row_mask:0xf bank_mask:0xf
    s_lshr_b64 s[52:53], s[52:53], 1
    v_cndmask_b32_dpp v86, v86, v86, vcc wave_shr:1 row_mask:0xf bank_mask:0xf
    v_cndmask_b32_dpp v87, v87, v87, vcc wave_shr:1 row_mask:0xf bank_mask:0xf
    s_andn2_b64 s[82:83], s[82:83], s[52:53]
    v_cndmask_b32_dpp v7, v7, v7, vcc wave_shr:1 row_mask:0xf bank_mask:0xf
    s_mov_b64 vcc, s[50:51]
    s_mov_b64 exec, s[50:51]
    s_cbranch_scc0 L2_d41
    s_mov_b64 exec, s[82:83]
    s_nop 1
    v_mfma_f32_4x4x4_16b_bf16 v[88:91], v[12:13], v[84:85], 0
    s_nop 1
    v_mfma_f32_4x4x4_16b_bf16 v[88:91], v[10:11], v[86:87], v[88:91]
    s_nop 4
    v_cvt_pk_bf16_f32 v88, v88, v89
    v_cvt_pk_bf16_f32 v89, v90, v91
    ds_pk_add_bf16 v7, v88 offset:65408
    ds_pk_add_bf16 v7, v89 offset:65412
    s_mov_b64 exec, vcc
    s_branch L2_d41
L2_c42:
    s_mov_b64 s[50:51], vcc
    s_lshl_b64 s[52:53], s[82:83], 1
    s_andn2_b64 s[52:53], s[52:53], s[80:81]
    s_andn2_b64 s[52:53], s[52:53], s[50:51]
    s_or_b64 s[80:81], s[80:81], s[52:53]
    s_not_b64 vcc, s[52:53]
    s_mov_b64 exec, -1
    v_cndmask_b32_dpp v84, v84, v84, vcc wave_shr:1 row_mask:0xf bank_mask:0xf
    v_cndmask_b32_dpp v85, v85, v85, vcc wave_shr:1 row_mask:0xf bank_mask:0xf
    s_lshr_b64 s[52:53], s[52:53], 1
    v_cndmask_b32_dpp v86, v86, v86, vcc wave_shr:1 row_mask:0xf bank_mask:0xf
    v_cndmask_b32_dpp v87, v87, v87, vcc wave_shr:1 row_mask:0xf bank_mask:0xf
    s_andn2_b64 s[82:83], s[82:83], s[52:53]
    v_cndmask_b32_dpp v7, v7, v7, vcc wave_shr:1 row_mask:0xf bank_mask:0xf
    s_mov_b64 vcc, s[50:51]
    s_mov_b64 exec, s[50:51]
    s_cbranch_scc0 L2_d42
    s_mov_b64 exec, s[82:83]
    s_nop 1
    v_mfma_f32_4x4x4_16b_bf16 v[88:91], v[12:13], v[84:85], 0
    s_nop 1
    v_mfma_f32_4x4x4_16b_bf16 v[88:91], v[10:11], v[86:87], v[88:91]
    s_nop 4
    v_cvt_pk_bf16_f32 v88, v88, v89
    v_cvt_pk_bf16_f32 v89, v90, v91
    ds_pk_add_bf16 v7, v88 offset:65408
    ds_pk_add_bf16 v7, v89 offset:65412
    s_mov_b64 exec, vcc
    s_branch L2_d42
L2_xa43:
    s_cmp_eq_u32 s101, 1
    s_cbranch_scc1 L2_xc43
    v_lshlrev_b32 v89, 0, v96
    v_add_u32 v90, 140, v97
    v_bitop3_b32 v90, v89, v45, v90 bitop3:0x6a
    ds_write_b32 v98, v90 offset:28
    v_lshlrev_b32 v89, 4, v96
    v_add_u32 v90, 120, v97
    v_bitop3_b32 v90, v89, v45, v90 bitop3:0x6a
    ds_write_b32 v98, v90 offset:24
    v_lshlrev_b32 v89, 8, v96
    v_add_u32 v90, 100, v97
    v_bitop3_b32 v90, v89, v45, v90 bitop3:0x6a
    ds_write_b32 v98, v90 offset:20
L2_xc43:
    v_lshlrev_b32 v89, 12, v96
    v_add_u32 v90, 80, v97
    v_bitop3_b32 v90, v89, v45, v90 bitop3:0x6a
    ds_write_b32 v98, v90 offset:16
    s_branch L2_xb43
L2_xe43:
    v_cmp_lt_u32 vcc, 32, v99
    v_cmp_lt_u32 s[58:59], 31, v88
    v_lshrrev_b32 v89, 16, v96
    v_add_u32 v97, 80, v97
    s_or_b64 vcc, vcc, s[58:59]
    s_cbranch_scc1 L2_xs43
    v_lshlrev_b32 v89, v1, v89
    v_and_b32 v89, v45, v89
    v_cmp_ne_u32 vcc, 0, v89
    v_xor_b32 v90, v97, v89
    s_add_u32 s3, s37, s38
    v_mbcnt_lo_u32_b32 v98, vcc_lo, 0
    v_mbcnt_hi_u32_b32 v98, vcc_hi, v98
    s_bcnt1_i32_b64 s41, vcc
    v_lshl_add_u32 v98, v98, 2, s3
    s_mov_b64 exec, vcc
    ds_write_b32 v98, v90
    s_mov_b64 exec, -1
    s_lshl2_add_u32 s37, s41, s37
    s_branch L2_xr43
L2_xf43:
    s_waitcnt lgkmcnt(0)
    s_cmp_gt_u32 s37, 1024
    s_cbranch_scc1 L2_xs43
    v_mov_b32 v43, -1
    s_cmp_ge_u32 s37, 512
    s_cbranch_scc1 L2_xg43
    v_mov_b32 v42, -1
    s_cmp_ge_u32 s37, 256
    s_cbranch_scc1 L2_xg43
    v_mov_b32 v41, -1
    s_branch L2_xg43
L2_xs43:
    s_waitcnt lgkmcnt(0)
    v_mov_b32 v40, -1
    v_mov_b32 v41, -1
    v_mov_b32 v42, -1
    v_mov_b32 v43, -1
    s_add_u32 s3, s42, 2
    s_bitset1_b32 s36, s3
    s_branch L2_xg43
L2_c44:
    s_mov_b64 s[50:51], vcc
    s_lshl_b64 s[52:53], s[82:83], 1
    s_andn2_b64 s[52:53], s[52:53], s[80:81]
    s_andn2_b64 s[52:53], s[52:53], s[50:51]
    s_or_b64 s[80:81], s[80:81], s[52:53]
    s_not_b64 vcc, s[52:53]
    s_mov_b64 exec, -1
    v_cndmask_b32_dpp v84, v84, v84, vcc wave_shr:1 row_mask:0xf bank_mask:0xf
    v_cndmask_b32_dpp v85, v85, v85, vcc wave_shr:1 row_mask:0xf bank_mask:0xf
    s_lshr_b64 s[52:53], s[52:53], 1
    v_cndmask_b32_dpp v86, v86, v86, vcc wave_shr:1 row_mask:0xf bank_mask:0xf
    v_cndmask_b32_dpp v87, v87, v87, vcc wave_shr:1 row_mask:0xf bank_mask:0xf
    s_andn2_b64 s[82:83], s[82:83], s[52:53]
    v_cndmask_b32_dpp v7, v7, v7, vcc wave_shr:1 row_mask:0xf bank_mask:0xf
    s_mov_b64 vcc, s[50:51]
    s_mov_b64 exec, s[50:51]
    s_cbranch_scc0 L2_d44
    s_mov_b64 exec, s[82:83]
    s_nop 1
    v_mfma_f32_4x4x4_16b_bf16 v[88:91], v[12:13], v[84:85], 0
    s_nop 1
    v_mfma_f32_4x4x4_16b_bf16 v[88:91], v[10:11], v[86:87], v[88:91]
    s_nop 4
    v_cvt_pk_bf16_f32 v88, v88, v89
    v_cvt_pk_bf16_f32 v89, v90, v91
    ds_pk_add_bf16 v7, v88 offset:65408
    ds_pk_add_bf16 v7, v89 offset:65412
    s_mov_b64 exec, vcc
    s_branch L2_d44
L2_c45:
    s_mov_b64 s[50:51], vcc
    s_lshl_b64 s[52:53], s[82:83], 1
    s_andn2_b64 s[52:53], s[52:53], s[80:81]
    s_andn2_b64 s[52:53], s[52:53], s[50:51]
    s_or_b64 s[80:81], s[80:81], s[52:53]
    s_not_b64 vcc, s[52:53]
    s_mov_b64 exec, -1
    v_cndmask_b32_dpp v84, v84, v84, vcc wave_shr:1 row_mask:0xf bank_mask:0xf
    v_cndmask_b32_dpp v85, v85, v85, vcc wave_shr:1 row_mask:0xf bank_mask:0xf
    s_lshr_b64 s[52:53], s[52:53], 1
    v_cndmask_b32_dpp v86, v86, v86, vcc wave_shr:1 row_mask:0xf bank_mask:0xf
    v_cndmask_b32_dpp v87, v87, v87, vcc wave_shr:1 row_mask:0xf bank_mask:0xf
    s_andn2_b64 s[82:83], s[82:83], s[52:53]
    v_cndmask_b32_dpp v7, v7, v7, vcc wave_shr:1 row_mask:0xf bank_mask:0xf
    s_mov_b64 vcc, s[50:51]
    s_mov_b64 exec, s[50:51]
    s_cbranch_scc0 L2_d45
    s_mov_b64 exec, s[82:83]
    s_nop 1
    v_mfma_f32_4x4x4_16b_bf16 v[88:91], v[12:13], v[84:85], 0
    s_nop 1
    v_mfma_f32_4x4x4_16b_bf16 v[88:91], v[10:11], v[86:87], v[88:91]
    s_nop 4
    v_cvt_pk_bf16_f32 v88, v88, v89
    v_cvt_pk_bf16_f32 v89, v90, v91
    ds_pk_add_bf16 v7, v88 offset:65408
    ds_pk_add_bf16 v7, v89 offset:65412
    s_mov_b64 exec, vcc
    s_branch L2_d45
L2_c46:
    s_mov_b64 s[50:51], vcc
    s_lshl_b64 s[52:53], s[82:83], 1
    s_andn2_b64 s[52:53], s[52:53], s[80:81]
    s_andn2_b64 s[52:53], s[52:53], s[50:51]
    s_or_b64 s[80:81], s[80:81], s[52:53]
    s_not_b64 vcc, s[52:53]
    s_mov_b64 exec, -1
    v_cndmask_b32_dpp v84, v84, v84, vcc wave_shr:1 row_mask:0xf bank_mask:0xf
    v_cndmask_b32_dpp v85, v85, v85, vcc wave_shr:1 row_mask:0xf bank_mask:0xf
    s_lshr_b64 s[52:53], s[52:53], 1
    v_cndmask_b32_dpp v86, v86, v86, vcc wave_shr:1 row_mask:0xf bank_mask:0xf
    v_cndmask_b32_dpp v87, v87, v87, vcc wave_shr:1 row_mask:0xf bank_mask:0xf
    s_andn2_b64 s[82:83], s[82:83], s[52:53]
    v_cndmask_b32_dpp v7, v7, v7, vcc wave_shr:1 row_mask:0xf bank_mask:0xf
    s_mov_b64 vcc, s[50:51]
    s_mov_b64 exec, s[50:51]
    s_cbranch_scc0 L2_d46
    s_mov_b64 exec, s[82:83]
    s_nop 1
    v_mfma_f32_4x4x4_16b_bf16 v[88:91], v[12:13], v[84:85], 0
    s_nop 1
    v_mfma_f32_4x4x4_16b_bf16 v[88:91], v[10:11], v[86:87], v[88:91]
    s_nop 4
    v_cvt_pk_bf16_f32 v88, v88, v89
    v_cvt_pk_bf16_f32 v89, v90, v91
    ds_pk_add_bf16 v7, v88 offset:65408
    ds_pk_add_bf16 v7, v89 offset:65412
    s_mov_b64 exec, vcc
    s_branch L2_d46
L2_c47:
    s_mov_b64 s[50:51], vcc
    s_lshl_b64 s[52:53], s[82:83], 1
    s_andn2_b64 s[52:53], s[52:53], s[80:81]
    s_andn2_b64 s[52:53], s[52:53], s[50:51]
    s_or_b64 s[80:81], s[80:81], s[52:53]
    s_not_b64 vcc, s[52:53]
    s_mov_b64 exec, -1
    v_cndmask_b32_dpp v84, v84, v84, vcc wave_shr:1 row_mask:0xf bank_mask:0xf
    v_cndmask_b32_dpp v85, v85, v85, vcc wave_shr:1 row_mask:0xf bank_mask:0xf
    s_lshr_b64 s[52:53], s[52:53], 1
    v_cndmask_b32_dpp v86, v86, v86, vcc wave_shr:1 row_mask:0xf bank_mask:0xf
    v_cndmask_b32_dpp v87, v87, v87, vcc wave_shr:1 row_mask:0xf bank_mask:0xf
    s_andn2_b64 s[82:83], s[82:83], s[52:53]
    v_cndmask_b32_dpp v7, v7, v7, vcc wave_shr:1 row_mask:0xf bank_mask:0xf
    s_mov_b64 vcc, s[50:51]
    s_mov_b64 exec, s[50:51]
    s_cbranch_scc0 L2_d47
    s_mov_b64 exec, s[82:83]
    s_nop 1
    v_mfma_f32_4x4x4_16b_bf16 v[88:91], v[12:13], v[84:85], 0
    s_nop 1
    v_mfma_f32_4x4x4_16b_bf16 v[88:91], v[10:11], v[86:87], v[88:91]
    s_nop 4
    v_cvt_pk_bf16_f32 v88, v88, v89
    v_cvt_pk_bf16_f32 v89, v90, v91
    ds_pk_add_bf16 v7, v88 offset:65408
    ds_pk_add_bf16 v7, v89 offset:65412
    s_mov_b64 exec, vcc
    s_branch L2_d47
L2_c48:
    s_mov_b64 s[50:51], vcc
    s_lshl_b64 s[52:53], s[82:83], 1
    s_andn2_b64 s[52:53], s[52:53], s[80:81]
    s_andn2_b64 s[52:53], s[52:53], s[50:51]
    s_or_b64 s[80:81], s[80:81], s[52:53]
    s_not_b64 vcc, s[52:53]
    s_mov_b64 exec, -1
    v_cndmask_b32_dpp v84, v84, v84, vcc wave_shr:1 row_mask:0xf bank_mask:0xf
    v_cndmask_b32_dpp v85, v85, v85, vcc wave_shr:1 row_mask:0xf bank_mask:0xf
    s_lshr_b64 s[52:53], s[52:53], 1
    v_cndmask_b32_dpp v86, v86, v86, vcc wave_shr:1 row_mask:0xf bank_mask:0xf
    v_cndmask_b32_dpp v87, v87, v87, vcc wave_shr:1 row_mask:0xf bank_mask:0xf
    s_andn2_b64 s[82:83], s[82:83], s[52:53]
    v_cndmask_b32_dpp v7, v7, v7, vcc wave_shr:1 row_mask:0xf bank_mask:0xf
    s_mov_b64 vcc, s[50:51]
    s_mov_b64 exec, s[50:51]
    s_cbranch_scc0 L2_d48
    s_mov_b64 exec, s[82:83]
    s_nop 1
    v_mfma_f32_4x4x4_16b_bf16 v[88:91], v[12:13], v[84:85], 0
    s_nop 1
    v_mfma_f32_4x4x4_16b_bf16 v[88:91], v[10:11], v[86:87], v[88:91]
    s_nop 4
    v_cvt_pk_bf16_f32 v88, v88, v89
    v_cvt_pk_bf16_f32 v89, v90, v91
    ds_pk_add_bf16 v7, v88 offset:65408
    ds_pk_add_bf16 v7, v89 offset:65412
    s_mov_b64 exec, vcc
    s_branch L2_d48
L2_c49:
    s_mov_b64 s[50:51], vcc
    s_lshl_b64 s[52:53], s[82:83], 1
    s_andn2_b64 s[52:53], s[52:53], s[80:81]
    s_andn2_b64 s[52:53], s[52:53], s[50:51]
    s_or_b64 s[80:81], s[80:81], s[52:53]
    s_not_b64 vcc, s[52:53]
    s_mov_b64 exec, -1
    v_cndmask_b32_dpp v84, v84, v84, vcc wave_shr:1 row_mask:0xf bank_mask:0xf
    v_cndmask_b32_dpp v85, v85, v85, vcc wave_shr:1 row_mask:0xf bank_mask:0xf
    s_lshr_b64 s[52:53], s[52:53], 1
    v_cndmask_b32_dpp v86, v86, v86, vcc wave_shr:1 row_mask:0xf bank_mask:0xf
    v_cndmask_b32_dpp v87, v87, v87, vcc wave_shr:1 row_mask:0xf bank_mask:0xf
    s_andn2_b64 s[82:83], s[82:83], s[52:53]
    v_cndmask_b32_dpp v7, v7, v7, vcc wave_shr:1 row_mask:0xf bank_mask:0xf
    s_mov_b64 vcc, s[50:51]
    s_mov_b64 exec, s[50:51]
    s_cbranch_scc0 L2_d49
    s_mov_b64 exec, s[82:83]
    s_nop 1
    v_mfma_f32_4x4x4_16b_bf16 v[88:91], v[12:13], v[84:85], 0
    s_nop 1
    v_mfma_f32_4x4x4_16b_bf16 v[88:91], v[10:11], v[86:87], v[88:91]
    s_nop 4
    v_cvt_pk_bf16_f32 v88, v88, v89
    v_cvt_pk_bf16_f32 v89, v90, v91
    ds_pk_add_bf16 v7, v88 offset:65408
    ds_pk_add_bf16 v7, v89 offset:65412
    s_mov_b64 exec, vcc
    s_branch L2_d49
L2_c50:
    s_mov_b64 s[50:51], vcc
    s_lshl_b64 s[52:53], s[82:83], 1
    s_andn2_b64 s[52:53], s[52:53], s[80:81]
    s_andn2_b64 s[52:53], s[52:53], s[50:51]
    s_or_b64 s[80:81], s[80:81], s[52:53]
    s_not_b64 vcc, s[52:53]
    s_mov_b64 exec, -1
    v_cndmask_b32_dpp v84, v84, v84, vcc wave_shr:1 row_mask:0xf bank_mask:0xf
    v_cndmask_b32_dpp v85, v85, v85, vcc wave_shr:1 row_mask:0xf bank_mask:0xf
    s_lshr_b64 s[52:53], s[52:53], 1
    v_cndmask_b32_dpp v86, v86, v86, vcc wave_shr:1 row_mask:0xf bank_mask:0xf
    v_cndmask_b32_dpp v87, v87, v87, vcc wave_shr:1 row_mask:0xf bank_mask:0xf
    s_andn2_b64 s[82:83], s[82:83], s[52:53]
    v_cndmask_b32_dpp v7, v7, v7, vcc wave_shr:1 row_mask:0xf bank_mask:0xf
    s_mov_b64 vcc, s[50:51]
    s_mov_b64 exec, s[50:51]
    s_cbranch_scc0 L2_d50
    s_mov_b64 exec, s[82:83]
    s_nop 1
    v_mfma_f32_4x4x4_16b_bf16 v[88:91], v[12:13], v[84:85], 0
    s_nop 1
    v_mfma_f32_4x4x4_16b_bf16 v[88:91], v[10:11], v[86:87], v[88:91]
    s_nop 4
    v_cvt_pk_bf16_f32 v88, v88, v89
    v_cvt_pk_bf16_f32 v89, v90, v91
    ds_pk_add_bf16 v7, v88 offset:65408
    ds_pk_add_bf16 v7, v89 offset:65412
    s_mov_b64 exec, vcc
    s_branch L2_d50
L2_c51:
    s_mov_b64 s[50:51], vcc
    s_lshl_b64 s[52:53], s[82:83], 1
    s_andn2_b64 s[52:53], s[52:53], s[80:81]
    s_andn2_b64 s[52:53], s[52:53], s[50:51]
    s_or_b64 s[80:81], s[80:81], s[52:53]
    s_not_b64 vcc, s[52:53]
    s_mov_b64 exec, -1
    v_cndmask_b32_dpp v84, v84, v84, vcc wave_shr:1 row_mask:0xf bank_mask:0xf
    v_cndmask_b32_dpp v85, v85, v85, vcc wave_shr:1 row_mask:0xf bank_mask:0xf
    s_lshr_b64 s[52:53], s[52:53], 1
    v_cndmask_b32_dpp v86, v86, v86, vcc wave_shr:1 row_mask:0xf bank_mask:0xf
    v_cndmask_b32_dpp v87, v87, v87, vcc wave_shr:1 row_mask:0xf bank_mask:0xf
    s_andn2_b64 s[82:83], s[82:83], s[52:53]
    v_cndmask_b32_dpp v7, v7, v7, vcc wave_shr:1 row_mask:0xf bank_mask:0xf
    s_mov_b64 vcc, s[50:51]
    s_mov_b64 exec, s[50:51]
    s_cbranch_scc0 L2_d51
    s_mov_b64 exec, s[82:83]
    s_nop 1
    v_mfma_f32_4x4x4_16b_bf16 v[88:91], v[12:13], v[84:85], 0
    s_nop 1
    v_mfma_f32_4x4x4_16b_bf16 v[88:91], v[10:11], v[86:87], v[88:91]
    s_nop 4
    v_cvt_pk_bf16_f32 v88, v88, v89
    v_cvt_pk_bf16_f32 v89, v90, v91
    ds_pk_add_bf16 v7, v88 offset:65408
    ds_pk_add_bf16 v7, v89 offset:65412
    s_mov_b64 exec, vcc
    s_branch L2_d51
L2_xo52:
    v_cmp_lt_u32 vcc, 20, v99
    s_mov_b32 s101, 1
    s_cbranch_vccz L2_xp52
    v_cmp_lt_u32 vcc, 32, v99
    v_cmp_lt_u32 s[58:59], 31, v88
    s_mov_b32 s101, 2
    s_or_b64 vcc, vcc, s[58:59]
    s_cbranch_scc0 L2_xp52
    s_mov_b32 s37, 0x10000
    s_branch L2_xp52
L2_c53:
    s_mov_b64 s[50:51], vcc
    s_lshl_b64 s[52:53], s[82:83], 1
    s_andn2_b64 s[52:53], s[52:53], s[80:81]
    s_andn2_b64 s[52:53], s[52:53], s[50:51]
    s_or_b64 s[80:81], s[80:81], s[52:53]
    s_not_b64 vcc, s[52:53]
    s_mov_b64 exec, -1
    v_cndmask_b32_dpp v84, v84, v84, vcc wave_shr:1 row_mask:0xf bank_mask:0xf
    v_cndmask_b32_dpp v85, v85, v85, vcc wave_shr:1 row_mask:0xf bank_mask:0xf
    s_lshr_b64 s[52:53], s[52:53], 1
    v_cndmask_b32_dpp v86, v86, v86, vcc wave_shr:1 row_mask:0xf bank_mask:0xf
    v_cndmask_b32_dpp v87, v87, v87, vcc wave_shr:1 row_mask:0xf bank_mask:0xf
    s_andn2_b64 s[82:83], s[82:83], s[52:53]
    v_cndmask_b32_dpp v7, v7, v7, vcc wave_shr:1 row_mask:0xf bank_mask:0xf
    s_mov_b64 vcc, s[50:51]
    s_mov_b64 exec, s[50:51]
    s_cbranch_scc0 L2_d53
    s_mov_b64 exec, s[82:83]
    s_nop 1
    v_mfma_f32_4x4x4_16b_bf16 v[88:91], v[12:13], v[84:85], 0
    s_nop 1
    v_mfma_f32_4x4x4_16b_bf16 v[88:91], v[10:11], v[86:87], v[88:91]
    s_nop 4
    v_cvt_pk_bf16_f32 v88, v88, v89
    v_cvt_pk_bf16_f32 v89, v90, v91
    ds_pk_add_bf16 v7, v88 offset:65408
    ds_pk_add_bf16 v7, v89 offset:65412
    s_mov_b64 exec, vcc
    s_branch L2_d53
L2_c54:
    s_mov_b64 s[50:51], vcc
    s_lshl_b64 s[52:53], s[82:83], 1
    s_andn2_b64 s[52:53], s[52:53], s[80:81]
    s_andn2_b64 s[52:53], s[52:53], s[50:51]
    s_or_b64 s[80:81], s[80:81], s[52:53]
    s_not_b64 vcc, s[52:53]
    s_mov_b64 exec, -1
    v_cndmask_b32_dpp v84, v84, v84, vcc wave_shr:1 row_mask:0xf bank_mask:0xf
    v_cndmask_b32_dpp v85, v85, v85, vcc wave_shr:1 row_mask:0xf bank_mask:0xf
    s_lshr_b64 s[52:53], s[52:53], 1
    v_cndmask_b32_dpp v86, v86, v86, vcc wave_shr:1 row_mask:0xf bank_mask:0xf
    v_cndmask_b32_dpp v87, v87, v87, vcc wave_shr:1 row_mask:0xf bank_mask:0xf
    s_andn2_b64 s[82:83], s[82:83], s[52:53]
    v_cndmask_b32_dpp v7, v7, v7, vcc wave_shr:1 row_mask:0xf bank_mask:0xf
    s_mov_b64 vcc, s[50:51]
    s_mov_b64 exec, s[50:51]
    s_cbranch_scc0 L2_d54
    s_mov_b64 exec, s[82:83]
    s_nop 1
    v_mfma_f32_4x4x4_16b_bf16 v[88:91], v[12:13], v[84:85], 0
    s_nop 1
    v_mfma_f32_4x4x4_16b_bf16 v[88:91], v[10:11], v[86:87], v[88:91]
    s_nop 4
    v_cvt_pk_bf16_f32 v88, v88, v89
    v_cvt_pk_bf16_f32 v89, v90, v91
    ds_pk_add_bf16 v7, v88 offset:65408
    ds_pk_add_bf16 v7, v89 offset:65412
    s_mov_b64 exec, vcc
    s_branch L2_d54
L2_c55:
    s_mov_b64 s[50:51], vcc
    s_lshl_b64 s[52:53], s[82:83], 1
    s_andn2_b64 s[52:53], s[52:53], s[80:81]
    s_andn2_b64 s[52:53], s[52:53], s[50:51]
    s_or_b64 s[80:81], s[80:81], s[52:53]
    s_not_b64 vcc, s[52:53]
    s_mov_b64 exec, -1
    v_cndmask_b32_dpp v84, v84, v84, vcc wave_shr:1 row_mask:0xf bank_mask:0xf
    v_cndmask_b32_dpp v85, v85, v85, vcc wave_shr:1 row_mask:0xf bank_mask:0xf
    s_lshr_b64 s[52:53], s[52:53], 1
    v_cndmask_b32_dpp v86, v86, v86, vcc wave_shr:1 row_mask:0xf bank_mask:0xf
    v_cndmask_b32_dpp v87, v87, v87, vcc wave_shr:1 row_mask:0xf bank_mask:0xf
    s_andn2_b64 s[82:83], s[82:83], s[52:53]
    v_cndmask_b32_dpp v7, v7, v7, vcc wave_shr:1 row_mask:0xf bank_mask:0xf
    s_mov_b64 vcc, s[50:51]
    s_mov_b64 exec, s[50:51]
    s_cbranch_scc0 L2_d55
    s_mov_b64 exec, s[82:83]
    s_nop 1
    v_mfma_f32_4x4x4_16b_bf16 v[88:91], v[12:13], v[84:85], 0
    s_nop 1
    v_mfma_f32_4x4x4_16b_bf16 v[88:91], v[10:11], v[86:87], v[88:91]
    s_nop 4
    v_cvt_pk_bf16_f32 v88, v88, v89
    v_cvt_pk_bf16_f32 v89, v90, v91
    ds_pk_add_bf16 v7, v88 offset:65408
    ds_pk_add_bf16 v7, v89 offset:65412
    s_mov_b64 exec, vcc
    s_branch L2_d55
L2_c56:
    s_mov_b64 s[50:51], vcc
    s_lshl_b64 s[52:53], s[82:83], 1
    s_andn2_b64 s[52:53], s[52:53], s[80:81]
    s_andn2_b64 s[52:53], s[52:53], s[50:51]
    s_or_b64 s[80:81], s[80:81], s[52:53]
    s_not_b64 vcc, s[52:53]
    s_mov_b64 exec, -1
    v_cndmask_b32_dpp v84, v84, v84, vcc wave_shr:1 row_mask:0xf bank_mask:0xf
    v_cndmask_b32_dpp v85, v85, v85, vcc wave_shr:1 row_mask:0xf bank_mask:0xf
    s_lshr_b64 s[52:53], s[52:53], 1
    v_cndmask_b32_dpp v86, v86, v86, vcc wave_shr:1 row_mask:0xf bank_mask:0xf
    v_cndmask_b32_dpp v87, v87, v87, vcc wave_shr:1 row_mask:0xf bank_mask:0xf
    s_andn2_b64 s[82:83], s[82:83], s[52:53]
    v_cndmask_b32_dpp v7, v7, v7, vcc wave_shr:1 row_mask:0xf bank_mask:0xf
    s_mov_b64 vcc, s[50:51]
    s_mov_b64 exec, s[50:51]
    s_cbranch_scc0 L2_d56
    s_mov_b64 exec, s[82:83]
    s_nop 1
    v_mfma_f32_4x4x4_16b_bf16 v[88:91], v[12:13], v[84:85], 0
    s_nop 1
    v_mfma_f32_4x4x4_16b_bf16 v[88:91], v[10:11], v[86:87], v[88:91]
    s_nop 4
    v_cvt_pk_bf16_f32 v88, v88, v89
    v_cvt_pk_bf16_f32 v89, v90, v91
    ds_pk_add_bf16 v7, v88 offset:65408
    ds_pk_add_bf16 v7, v89 offset:65412
    s_mov_b64 exec, vcc
    s_branch L2_d56
L2_c57:
    s_mov_b64 s[50:51], vcc
    s_lshl_b64 s[52:53], s[82:83], 1
    s_andn2_b64 s[52:53], s[52:53], s[80:81]
    s_andn2_b64 s[52:53], s[52:53], s[50:51]
    s_or_b64 s[80:81], s[80:81], s[52:53]
    s_not_b64 vcc, s[52:53]
    s_mov_b64 exec, -1
    v_cndmask_b32_dpp v84, v84, v84, vcc wave_shr:1 row_mask:0xf bank_mask:0xf
    v_cndmask_b32_dpp v85, v85, v85, vcc wave_shr:1 row_mask:0xf bank_mask:0xf
    s_lshr_b64 s[52:53], s[52:53], 1
    v_cndmask_b32_dpp v86, v86, v86, vcc wave_shr:1 row_mask:0xf bank_mask:0xf
    v_cndmask_b32_dpp v87, v87, v87, vcc wave_shr:1 row_mask:0xf bank_mask:0xf
    s_andn2_b64 s[82:83], s[82:83], s[52:53]
    v_cndmask_b32_dpp v7, v7, v7, vcc wave_shr:1 row_mask:0xf bank_mask:0xf
    s_mov_b64 vcc, s[50:51]
    s_mov_b64 exec, s[50:51]
    s_cbranch_scc0 L2_d57
    s_mov_b64 exec, s[82:83]
    s_nop 1
    v_mfma_f32_4x4x4_16b_bf16 v[88:91], v[12:13], v[84:85], 0
    s_nop 1
    v_mfma_f32_4x4x4_16b_bf16 v[88:91], v[10:11], v[86:87], v[88:91]
    s_nop 4
    v_cvt_pk_bf16_f32 v88, v88, v89
    v_cvt_pk_bf16_f32 v89, v90, v91
    ds_pk_add_bf16 v7, v88 offset:65408
    ds_pk_add_bf16 v7, v89 offset:65412
    s_mov_b64 exec, vcc
    s_branch L2_d57
L2_c58:
    s_mov_b64 s[50:51], vcc
    s_lshl_b64 s[52:53], s[82:83], 1
    s_andn2_b64 s[52:53], s[52:53], s[80:81]
    s_andn2_b64 s[52:53], s[52:53], s[50:51]
    s_or_b64 s[80:81], s[80:81], s[52:53]
    s_not_b64 vcc, s[52:53]
    s_mov_b64 exec, -1
    v_cndmask_b32_dpp v84, v84, v84, vcc wave_shr:1 row_mask:0xf bank_mask:0xf
    v_cndmask_b32_dpp v85, v85, v85, vcc wave_shr:1 row_mask:0xf bank_mask:0xf
    s_lshr_b64 s[52:53], s[52:53], 1
    v_cndmask_b32_dpp v86, v86, v86, vcc wave_shr:1 row_mask:0xf bank_mask:0xf
    v_cndmask_b32_dpp v87, v87, v87, vcc wave_shr:1 row_mask:0xf bank_mask:0xf
    s_andn2_b64 s[82:83], s[82:83], s[52:53]
    v_cndmask_b32_dpp v7, v7, v7, vcc wave_shr:1 row_mask:0xf bank_mask:0xf
    s_mov_b64 vcc, s[50:51]
    s_mov_b64 exec, s[50:51]
    s_cbranch_scc0 L2_d58
    s_mov_b64 exec, s[82:83]
    s_nop 1
    v_mfma_f32_4x4x4_16b_bf16 v[88:91], v[12:13], v[84:85], 0
    s_nop 1
    v_mfma_f32_4x4x4_16b_bf16 v[88:91], v[10:11], v[86:87], v[88:91]
    s_nop 4
    v_cvt_pk_bf16_f32 v88, v88, v89
    v_cvt_pk_bf16_f32 v89, v90, v91
    ds_pk_add_bf16 v7, v88 offset:65408
    ds_pk_add_bf16 v7, v89 offset:65412
    s_mov_b64 exec, vcc
    s_branch L2_d58
L2_c59:
    s_mov_b64 s[50:51], vcc
    s_lshl_b64 s[52:53], s[82:83], 1
    s_andn2_b64 s[52:53], s[52:53], s[80:81]
    s_andn2_b64 s[52:53], s[52:53], s[50:51]
    s_or_b64 s[80:81], s[80:81], s[52:53]
    s_not_b64 vcc, s[52:53]
    s_mov_b64 exec, -1
    v_cndmask_b32_dpp v84, v84, v84, vcc wave_shr:1 row_mask:0xf bank_mask:0xf
    v_cndmask_b32_dpp v85, v85, v85, vcc wave_shr:1 row_mask:0xf bank_mask:0xf
    s_lshr_b64 s[52:53], s[52:53], 1
    v_cndmask_b32_dpp v86, v86, v86, vcc wave_shr:1 row_mask:0xf bank_mask:0xf
    v_cndmask_b32_dpp v87, v87, v87, vcc wave_shr:1 row_mask:0xf bank_mask:0xf
    s_andn2_b64 s[82:83], s[82:83], s[52:53]
    v_cndmask_b32_dpp v7, v7, v7, vcc wave_shr:1 row_mask:0xf bank_mask:0xf
    s_mov_b64 vcc, s[50:51]
    s_mov_b64 exec, s[50:51]
    s_cbranch_scc0 L2_d59
    s_mov_b64 exec, s[82:83]
    s_nop 1
    v_mfma_f32_4x4x4_16b_bf16 v[88:91], v[12:13], v[84:85], 0
    s_nop 1
    v_mfma_f32_4x4x4_16b_bf16 v[88:91], v[10:11], v[86:87], v[88:91]
    s_nop 4
    v_cvt_pk_bf16_f32 v88, v88, v89
    v_cvt_pk_bf16_f32 v89, v90, v91
    ds_pk_add_bf16 v7, v88 offset:65408
    ds_pk_add_bf16 v7, v89 offset:65412
    s_mov_b64 exec, vcc
    s_branch L2_d59
L2_c60:
    s_mov_b64 s[50:51], vcc
    s_lshl_b64 s[52:53], s[82:83], 1
    s_andn2_b64 s[52:53], s[52:53], s[80:81]
    s_andn2_b64 s[52:53], s[52:53], s[50:51]
    s_or_b64 s[80:81], s[80:81], s[52:53]
    s_not_b64 vcc, s[52:53]
    s_mov_b64 exec, -1
    v_cndmask_b32_dpp v84, v84, v84, vcc wave_shr:1 row_mask:0xf bank_mask:0xf
    v_cndmask_b32_dpp v85, v85, v85, vcc wave_shr:1 row_mask:0xf bank_mask:0xf
    s_lshr_b64 s[52:53], s[52:53], 1
    v_cndmask_b32_dpp v86, v86, v86, vcc wave_shr:1 row_mask:0xf bank_mask:0xf
    v_cndmask_b32_dpp v87, v87, v87, vcc wave_shr:1 row_mask:0xf bank_mask:0xf
    s_andn2_b64 s[82:83], s[82:83], s[52:53]
    v_cndmask_b32_dpp v7, v7, v7, vcc wave_shr:1 row_mask:0xf bank_mask:0xf
    s_mov_b64 vcc, s[50:51]
    s_mov_b64 exec, s[50:51]
    s_cbranch_scc0 L2_d60
    s_mov_b64 exec, s[82:83]
    s_nop 1
    v_mfma_f32_4x4x4_16b_bf16 v[88:91], v[12:13], v[84:85], 0
    s_nop 1
    v_mfma_f32_4x4x4_16b_bf16 v[88:91], v[10:11], v[86:87], v[88:91]
    s_nop 4
    v_cvt_pk_bf16_f32 v88, v88, v89
    v_cvt_pk_bf16_f32 v89, v90, v91
    ds_pk_add_bf16 v7, v88 offset:65408
    ds_pk_add_bf16 v7, v89 offset:65412
    s_mov_b64 exec, vcc
    s_branch L2_d60
L2_xa61:
    s_cmp_eq_u32 s101, 1
    s_cbranch_scc1 L2_xc61
    v_lshlrev_b32 v89, 0, v96
    v_add_u32 v90, 140, v97
    v_bitop3_b32 v90, v89, v45, v90 bitop3:0x6a
    ds_write_b32 v98, v90 offset:28
    v_lshlrev_b32 v89, 4, v96
    v_add_u32 v90, 120, v97
    v_bitop3_b32 v90, v89, v45, v90 bitop3:0x6a
    ds_write_b32 v98, v90 offset:24
    v_lshlrev_b32 v89, 8, v96
    v_add_u32 v90, 100, v97
    v_bitop3_b32 v90, v89, v45, v90 bitop3:0x6a
    ds_write_b32 v98, v90 offset:20
L2_xc61:
    v_lshlrev_b32 v89, 12, v96
    v_add_u32 v90, 80, v97
    v_bitop3_b32 v90, v89, v45, v90 bitop3:0x6a
    ds_write_b32 v98, v90 offset:16
    s_branch L2_xb61
L2_xe61:
    v_cmp_lt_u32 vcc, 32, v99
    v_cmp_lt_u32 s[58:59], 31, v88
    v_lshrrev_b32 v89, 16, v96
    v_add_u32 v97, 80, v97
    s_or_b64 vcc, vcc, s[58:59]
    s_cbranch_scc1 L2_xs61
    v_lshlrev_b32 v89, v1, v89
    v_and_b32 v89, v45, v89
    v_cmp_ne_u32 vcc, 0, v89
    v_xor_b32 v90, v97, v89
    s_add_u32 s3, s37, s38
    v_mbcnt_lo_u32_b32 v98, vcc_lo, 0
    v_mbcnt_hi_u32_b32 v98, vcc_hi, v98
    s_bcnt1_i32_b64 s41, vcc
    v_lshl_add_u32 v98, v98, 2, s3
    s_mov_b64 exec, vcc
    ds_write_b32 v98, v90
    s_mov_b64 exec, -1
    s_lshl2_add_u32 s37, s41, s37
    s_branch L2_xr61
L2_xf61:
    s_waitcnt lgkmcnt(0)
    s_cmp_gt_u32 s37, 1024
    s_cbranch_scc1 L2_xs61
    v_mov_b32 v43, -1
    s_cmp_ge_u32 s37, 512
    s_cbranch_scc1 L2_xg61
    v_mov_b32 v42, -1
    s_cmp_ge_u32 s37, 256
    s_cbranch_scc1 L2_xg61
    v_mov_b32 v41, -1
    s_branch L2_xg61
L2_xs61:
    s_waitcnt lgkmcnt(0)
    v_mov_b32 v40, -1
    v_mov_b32 v41, -1
    v_mov_b32 v42, -1
    v_mov_b32 v43, -1
    s_add_u32 s3, s42, 2
    s_bitset1_b32 s36, s3
    s_branch L2_xg61
L2_c62:
    s_mov_b64 s[50:51], vcc
    s_lshl_b64 s[52:53], s[82:83], 1
    s_andn2_b64 s[52:53], s[52:53], s[80:81]
    s_andn2_b64 s[52:53], s[52:53], s[50:51]
    s_or_b64 s[80:81], s[80:81], s[52:53]
    s_not_b64 vcc, s[52:53]
    s_mov_b64 exec, -1
    v_cndmask_b32_dpp v84, v84, v84, vcc wave_shr:1 row_mask:0xf bank_mask:0xf
    v_cndmask_b32_dpp v85, v85, v85, vcc wave_shr:1 row_mask:0xf bank_mask:0xf
    s_lshr_b64 s[52:53], s[52:53], 1
    v_cndmask_b32_dpp v86, v86, v86, vcc wave_shr:1 row_mask:0xf bank_mask:0xf
    v_cndmask_b32_dpp v87, v87, v87, vcc wave_shr:1 row_mask:0xf bank_mask:0xf
    s_andn2_b64 s[82:83], s[82:83], s[52:53]
    v_cndmask_b32_dpp v7, v7, v7, vcc wave_shr:1 row_mask:0xf bank_mask:0xf
    s_mov_b64 vcc, s[50:51]
    s_mov_b64 exec, s[50:51]
    s_cbranch_scc0 L2_d62
    s_mov_b64 exec, s[82:83]
    s_nop 1
    v_mfma_f32_4x4x4_16b_bf16 v[88:91], v[12:13], v[84:85], 0
    s_nop 1
    v_mfma_f32_4x4x4_16b_bf16 v[88:91], v[10:11], v[86:87], v[88:91]
    s_nop 4
    v_cvt_pk_bf16_f32 v88, v88, v89
    v_cvt_pk_bf16_f32 v89, v90, v91
    ds_pk_add_bf16 v7, v88 offset:65408
    ds_pk_add_bf16 v7, v89 offset:65412
    s_mov_b64 exec, vcc
    s_branch L2_d62
L2_c63:
    s_mov_b64 s[50:51], vcc
    s_lshl_b64 s[52:53], s[82:83], 1
    s_andn2_b64 s[52:53], s[52:53], s[80:81]
    s_andn2_b64 s[52:53], s[52:53], s[50:51]
    s_or_b64 s[80:81], s[80:81], s[52:53]
    s_not_b64 vcc, s[52:53]
    s_mov_b64 exec, -1
    v_cndmask_b32_dpp v84, v84, v84, vcc wave_shr:1 row_mask:0xf bank_mask:0xf
    v_cndmask_b32_dpp v85, v85, v85, vcc wave_shr:1 row_mask:0xf bank_mask:0xf
    s_lshr_b64 s[52:53], s[52:53], 1
    v_cndmask_b32_dpp v86, v86, v86, vcc wave_shr:1 row_mask:0xf bank_mask:0xf
    v_cndmask_b32_dpp v87, v87, v87, vcc wave_shr:1 row_mask:0xf bank_mask:0xf
    s_andn2_b64 s[82:83], s[82:83], s[52:53]
    v_cndmask_b32_dpp v7, v7, v7, vcc wave_shr:1 row_mask:0xf bank_mask:0xf
    s_mov_b64 vcc, s[50:51]
    s_mov_b64 exec, s[50:51]
    s_cbranch_scc0 L2_d63
    s_mov_b64 exec, s[82:83]
    s_nop 1
    v_mfma_f32_4x4x4_16b_bf16 v[88:91], v[12:13], v[84:85], 0
    s_nop 1
    v_mfma_f32_4x4x4_16b_bf16 v[88:91], v[10:11], v[86:87], v[88:91]
    s_nop 4
    v_cvt_pk_bf16_f32 v88, v88, v89
    v_cvt_pk_bf16_f32 v89, v90, v91
    ds_pk_add_bf16 v7, v88 offset:65408
    ds_pk_add_bf16 v7, v89 offset:65412
    s_mov_b64 exec, vcc
    s_branch L2_d63
L2_c64:
    s_mov_b64 s[50:51], vcc
    s_lshl_b64 s[52:53], s[82:83], 1
    s_andn2_b64 s[52:53], s[52:53], s[80:81]
    s_andn2_b64 s[52:53], s[52:53], s[50:51]
    s_or_b64 s[80:81], s[80:81], s[52:53]
    s_not_b64 vcc, s[52:53]
    s_mov_b64 exec, -1
    v_cndmask_b32_dpp v84, v84, v84, vcc wave_shr:1 row_mask:0xf bank_mask:0xf
    v_cndmask_b32_dpp v85, v85, v85, vcc wave_shr:1 row_mask:0xf bank_mask:0xf
    s_lshr_b64 s[52:53], s[52:53], 1
    v_cndmask_b32_dpp v86, v86, v86, vcc wave_shr:1 row_mask:0xf bank_mask:0xf
    v_cndmask_b32_dpp v87, v87, v87, vcc wave_shr:1 row_mask:0xf bank_mask:0xf
    s_andn2_b64 s[82:83], s[82:83], s[52:53]
    v_cndmask_b32_dpp v7, v7, v7, vcc wave_shr:1 row_mask:0xf bank_mask:0xf
    s_mov_b64 vcc, s[50:51]
    s_mov_b64 exec, s[50:51]
    s_cbranch_scc0 L2_d64
    s_mov_b64 exec, s[82:83]
    s_nop 1
    v_mfma_f32_4x4x4_16b_bf16 v[88:91], v[12:13], v[84:85], 0
    s_nop 1
    v_mfma_f32_4x4x4_16b_bf16 v[88:91], v[10:11], v[86:87], v[88:91]
    s_nop 4
    v_cvt_pk_bf16_f32 v88, v88, v89
    v_cvt_pk_bf16_f32 v89, v90, v91
    ds_pk_add_bf16 v7, v88 offset:65408
    ds_pk_add_bf16 v7, v89 offset:65412
    s_mov_b64 exec, vcc
    s_branch L2_d64
L2_c65:
    s_mov_b64 s[50:51], vcc
    s_lshl_b64 s[52:53], s[82:83], 1
    s_andn2_b64 s[52:53], s[52:53], s[80:81]
    s_andn2_b64 s[52:53], s[52:53], s[50:51]
    s_or_b64 s[80:81], s[80:81], s[52:53]
    s_not_b64 vcc, s[52:53]
    s_mov_b64 exec, -1
    v_cndmask_b32_dpp v84, v84, v84, vcc wave_shr:1 row_mask:0xf bank_mask:0xf
    v_cndmask_b32_dpp v85, v85, v85, vcc wave_shr:1 row_mask:0xf bank_mask:0xf
    s_lshr_b64 s[52:53], s[52:53], 1
    v_cndmask_b32_dpp v86, v86, v86, vcc wave_shr:1 row_mask:0xf bank_mask:0xf
    v_cndmask_b32_dpp v87, v87, v87, vcc wave_shr:1 row_mask:0xf bank_mask:0xf
    s_andn2_b64 s[82:83], s[82:83], s[52:53]
    v_cndmask_b32_dpp v7, v7, v7, vcc wave_shr:1 row_mask:0xf bank_mask:0xf
    s_mov_b64 vcc, s[50:51]
    s_mov_b64 exec, s[50:51]
    s_cbranch_scc0 L2_d65
    s_mov_b64 exec, s[82:83]
    s_nop 1
    v_mfma_f32_4x4x4_16b_bf16 v[88:91], v[12:13], v[84:85], 0
    s_nop 1
    v_mfma_f32_4x4x4_16b_bf16 v[88:91], v[10:11], v[86:87], v[88:91]
    s_nop 4
    v_cvt_pk_bf16_f32 v88, v88, v89
    v_cvt_pk_bf16_f32 v89, v90, v91
    ds_pk_add_bf16 v7, v88 offset:65408
    ds_pk_add_bf16 v7, v89 offset:65412
    s_mov_b64 exec, vcc
    s_branch L2_d65
L2_c66:
    s_mov_b64 s[50:51], vcc
    s_lshl_b64 s[52:53], s[82:83], 1
    s_andn2_b64 s[52:53], s[52:53], s[80:81]
    s_andn2_b64 s[52:53], s[52:53], s[50:51]
    s_or_b64 s[80:81], s[80:81], s[52:53]
    s_not_b64 vcc, s[52:53]
    s_mov_b64 exec, -1
    v_cndmask_b32_dpp v84, v84, v84, vcc wave_shr:1 row_mask:0xf bank_mask:0xf
    v_cndmask_b32_dpp v85, v85, v85, vcc wave_shr:1 row_mask:0xf bank_mask:0xf
    s_lshr_b64 s[52:53], s[52:53], 1
    v_cndmask_b32_dpp v86, v86, v86, vcc wave_shr:1 row_mask:0xf bank_mask:0xf
    v_cndmask_b32_dpp v87, v87, v87, vcc wave_shr:1 row_mask:0xf bank_mask:0xf
    s_andn2_b64 s[82:83], s[82:83], s[52:53]
    v_cndmask_b32_dpp v7, v7, v7, vcc wave_shr:1 row_mask:0xf bank_mask:0xf
    s_mov_b64 vcc, s[50:51]
    s_mov_b64 exec, s[50:51]
    s_cbranch_scc0 L2_d66
    s_mov_b64 exec, s[82:83]
    s_nop 1
    v_mfma_f32_4x4x4_16b_bf16 v[88:91], v[12:13], v[84:85], 0
    s_nop 1
    v_mfma_f32_4x4x4_16b_bf16 v[88:91], v[10:11], v[86:87], v[88:91]
    s_nop 4
    v_cvt_pk_bf16_f32 v88, v88, v89
    v_cvt_pk_bf16_f32 v89, v90, v91
    ds_pk_add_bf16 v7, v88 offset:65408
    ds_pk_add_bf16 v7, v89 offset:65412
    s_mov_b64 exec, vcc
    s_branch L2_d66
L2_c67:
    s_mov_b64 s[50:51], vcc
    s_lshl_b64 s[52:53], s[82:83], 1
    s_andn2_b64 s[52:53], s[52:53], s[80:81]
    s_andn2_b64 s[52:53], s[52:53], s[50:51]
    s_or_b64 s[80:81], s[80:81], s[52:53]
    s_not_b64 vcc, s[52:53]
    s_mov_b64 exec, -1
    v_cndmask_b32_dpp v84, v84, v84, vcc wave_shr:1 row_mask:0xf bank_mask:0xf
    v_cndmask_b32_dpp v85, v85, v85, vcc wave_shr:1 row_mask:0xf bank_mask:0xf
    s_lshr_b64 s[52:53], s[52:53], 1
    v_cndmask_b32_dpp v86, v86, v86, vcc wave_shr:1 row_mask:0xf bank_mask:0xf
    v_cndmask_b32_dpp v87, v87, v87, vcc wave_shr:1 row_mask:0xf bank_mask:0xf
    s_andn2_b64 s[82:83], s[82:83], s[52:53]
    v_cndmask_b32_dpp v7, v7, v7, vcc wave_shr:1 row_mask:0xf bank_mask:0xf
    s_mov_b64 vcc, s[50:51]
    s_mov_b64 exec, s[50:51]
    s_cbranch_scc0 L2_d67
    s_mov_b64 exec, s[82:83]
    s_nop 1
    v_mfma_f32_4x4x4_16b_bf16 v[88:91], v[12:13], v[84:85], 0
    s_nop 1
    v_mfma_f32_4x4x4_16b_bf16 v[88:91], v[10:11], v[86:87], v[88:91]
    s_nop 4
    v_cvt_pk_bf16_f32 v88, v88, v89
    v_cvt_pk_bf16_f32 v89, v90, v91
    ds_pk_add_bf16 v7, v88 offset:65408
    ds_pk_add_bf16 v7, v89 offset:65412
    s_mov_b64 exec, vcc
    s_branch L2_d67
L2_c68:
    s_mov_b64 s[50:51], vcc
    s_lshl_b64 s[52:53], s[82:83], 1
    s_andn2_b64 s[52:53], s[52:53], s[80:81]
    s_andn2_b64 s[52:53], s[52:53], s[50:51]
    s_or_b64 s[80:81], s[80:81], s[52:53]
    s_not_b64 vcc, s[52:53]
    s_mov_b64 exec, -1
    v_cndmask_b32_dpp v84, v84, v84, vcc wave_shr:1 row_mask:0xf bank_mask:0xf
    v_cndmask_b32_dpp v85, v85, v85, vcc wave_shr:1 row_mask:0xf bank_mask:0xf
    s_lshr_b64 s[52:53], s[52:53], 1
    v_cndmask_b32_dpp v86, v86, v86, vcc wave_shr:1 row_mask:0xf bank_mask:0xf
    v_cndmask_b32_dpp v87, v87, v87, vcc wave_shr:1 row_mask:0xf bank_mask:0xf
    s_andn2_b64 s[82:83], s[82:83], s[52:53]
    v_cndmask_b32_dpp v7, v7, v7, vcc wave_shr:1 row_mask:0xf bank_mask:0xf
    s_mov_b64 vcc, s[50:51]
    s_mov_b64 exec, s[50:51]
    s_cbranch_scc0 L2_d68
    s_mov_b64 exec, s[82:83]
    s_nop 1
    v_mfma_f32_4x4x4_16b_bf16 v[88:91], v[12:13], v[84:85], 0
    s_nop 1
    v_mfma_f32_4x4x4_16b_bf16 v[88:91], v[10:11], v[86:87], v[88:91]
    s_nop 4
    v_cvt_pk_bf16_f32 v88, v88, v89
    v_cvt_pk_bf16_f32 v89, v90, v91
    ds_pk_add_bf16 v7, v88 offset:65408
    ds_pk_add_bf16 v7, v89 offset:65412
    s_mov_b64 exec, vcc
    s_branch L2_d68
L2_c69:
    s_mov_b64 s[50:51], vcc
    s_lshl_b64 s[52:53], s[82:83], 1
    s_andn2_b64 s[52:53], s[52:53], s[80:81]
    s_andn2_b64 s[52:53], s[52:53], s[50:51]
    s_or_b64 s[80:81], s[80:81], s[52:53]
    s_not_b64 vcc, s[52:53]
    s_mov_b64 exec, -1
    v_cndmask_b32_dpp v84, v84, v84, vcc wave_shr:1 row_mask:0xf bank_mask:0xf
    v_cndmask_b32_dpp v85, v85, v85, vcc wave_shr:1 row_mask:0xf bank_mask:0xf
    s_lshr_b64 s[52:53], s[52:53], 1
    v_cndmask_b32_dpp v86, v86, v86, vcc wave_shr:1 row_mask:0xf bank_mask:0xf
    v_cndmask_b32_dpp v87, v87, v87, vcc wave_shr:1 row_mask:0xf bank_mask:0xf
    s_andn2_b64 s[82:83], s[82:83], s[52:53]
    v_cndmask_b32_dpp v7, v7, v7, vcc wave_shr:1 row_mask:0xf bank_mask:0xf
    s_mov_b64 vcc, s[50:51]
    s_mov_b64 exec, s[50:51]
    s_cbranch_scc0 L2_d69
    s_mov_b64 exec, s[82:83]
    s_nop 1
    v_mfma_f32_4x4x4_16b_bf16 v[88:91], v[12:13], v[84:85], 0
    s_nop 1
    v_mfma_f32_4x4x4_16b_bf16 v[88:91], v[10:11], v[86:87], v[88:91]
    s_nop 4
    v_cvt_pk_bf16_f32 v88, v88, v89
    v_cvt_pk_bf16_f32 v89, v90, v91
    ds_pk_add_bf16 v7, v88 offset:65408
    ds_pk_add_bf16 v7, v89 offset:65412
    s_mov_b64 exec, vcc
    s_branch L2_d69
L2_xo70:
    v_cmp_lt_u32 vcc, 20, v99
    s_mov_b32 s101, 1
    s_cbranch_vccz L2_xp70
    v_cmp_lt_u32 vcc, 32, v99
    v_cmp_lt_u32 s[58:59], 31, v88
    s_mov_b32 s101, 2
    s_or_b64 vcc, vcc, s[58:59]
    s_cbranch_scc0 L2_xp70
    s_mov_b32 s37, 0x10000
    s_branch L2_xp70
L2_c71:
    s_mov_b64 s[50:51], vcc
    s_lshl_b64 s[52:53], s[82:83], 1
    s_andn2_b64 s[52:53], s[52:53], s[80:81]
    s_andn2_b64 s[52:53], s[52:53], s[50:51]
    s_or_b64 s[80:81], s[80:81], s[52:53]
    s_not_b64 vcc, s[52:53]
    s_mov_b64 exec, -1
    v_cndmask_b32_dpp v84, v84, v84, vcc wave_shr:1 row_mask:0xf bank_mask:0xf
    v_cndmask_b32_dpp v85, v85, v85, vcc wave_shr:1 row_mask:0xf bank_mask:0xf
    s_lshr_b64 s[52:53], s[52:53], 1
    v_cndmask_b32_dpp v86, v86, v86, vcc wave_shr:1 row_mask:0xf bank_mask:0xf
    v_cndmask_b32_dpp v87, v87, v87, vcc wave_shr:1 row_mask:0xf bank_mask:0xf
    s_andn2_b64 s[82:83], s[82:83], s[52:53]
    v_cndmask_b32_dpp v7, v7, v7, vcc wave_shr:1 row_mask:0xf bank_mask:0xf
    s_mov_b64 vcc, s[50:51]
    s_mov_b64 exec, s[50:51]
    s_cbranch_scc0 L2_d71
    s_mov_b64 exec, s[82:83]
    s_nop 1
    v_mfma_f32_4x4x4_16b_bf16 v[88:91], v[12:13], v[84:85], 0
    s_nop 1
    v_mfma_f32_4x4x4_16b_bf16 v[88:91], v[10:11], v[86:87], v[88:91]
    s_nop 4
    v_cvt_pk_bf16_f32 v88, v88, v89
    v_cvt_pk_bf16_f32 v89, v90, v91
    ds_pk_add_bf16 v7, v88 offset:65408
    ds_pk_add_bf16 v7, v89 offset:65412
    s_mov_b64 exec, vcc
    s_branch L2_d71
L2_c72:
    s_mov_b64 s[50:51], vcc
    s_lshl_b64 s[52:53], s[82:83], 1
    s_andn2_b64 s[52:53], s[52:53], s[80:81]
    s_andn2_b64 s[52:53], s[52:53], s[50:51]
    s_or_b64 s[80:81], s[80:81], s[52:53]
    s_not_b64 vcc, s[52:53]
    s_mov_b64 exec, -1
    v_cndmask_b32_dpp v84, v84, v84, vcc wave_shr:1 row_mask:0xf bank_mask:0xf
    v_cndmask_b32_dpp v85, v85, v85, vcc wave_shr:1 row_mask:0xf bank_mask:0xf
    s_lshr_b64 s[52:53], s[52:53], 1
    v_cndmask_b32_dpp v86, v86, v86, vcc wave_shr:1 row_mask:0xf bank_mask:0xf
    v_cndmask_b32_dpp v87, v87, v87, vcc wave_shr:1 row_mask:0xf bank_mask:0xf
    s_andn2_b64 s[82:83], s[82:83], s[52:53]
    v_cndmask_b32_dpp v7, v7, v7, vcc wave_shr:1 row_mask:0xf bank_mask:0xf
    s_mov_b64 vcc, s[50:51]
    s_mov_b64 exec, s[50:51]
    s_cbranch_scc0 L2_d72
    s_mov_b64 exec, s[82:83]
    s_nop 1
    v_mfma_f32_4x4x4_16b_bf16 v[88:91], v[12:13], v[84:85], 0
    s_nop 1
    v_mfma_f32_4x4x4_16b_bf16 v[88:91], v[10:11], v[86:87], v[88:91]
    s_nop 4
    v_cvt_pk_bf16_f32 v88, v88, v89
    v_cvt_pk_bf16_f32 v89, v90, v91
    ds_pk_add_bf16 v7, v88 offset:65408
    ds_pk_add_bf16 v7, v89 offset:65412
    s_mov_b64 exec, vcc
    s_branch L2_d72
L2_c73:
    s_mov_b64 s[50:51], vcc
    s_lshl_b64 s[52:53], s[82:83], 1
    s_andn2_b64 s[52:53], s[52:53], s[80:81]
    s_andn2_b64 s[52:53], s[52:53], s[50:51]
    s_or_b64 s[80:81], s[80:81], s[52:53]
    s_not_b64 vcc, s[52:53]
    s_mov_b64 exec, -1
    v_cndmask_b32_dpp v84, v84, v84, vcc wave_shr:1 row_mask:0xf bank_mask:0xf
    v_cndmask_b32_dpp v85, v85, v85, vcc wave_shr:1 row_mask:0xf bank_mask:0xf
    s_lshr_b64 s[52:53], s[52:53], 1
    v_cndmask_b32_dpp v86, v86, v86, vcc wave_shr:1 row_mask:0xf bank_mask:0xf
    v_cndmask_b32_dpp v87, v87, v87, vcc wave_shr:1 row_mask:0xf bank_mask:0xf
    s_andn2_b64 s[82:83], s[82:83], s[52:53]
    v_cndmask_b32_dpp v7, v7, v7, vcc wave_shr:1 row_mask:0xf bank_mask:0xf
    s_mov_b64 vcc, s[50:51]
    s_mov_b64 exec, s[50:51]
    s_cbranch_scc0 L2_d73
    s_mov_b64 exec, s[82:83]
    s_nop 1
    v_mfma_f32_4x4x4_16b_bf16 v[88:91], v[12:13], v[84:85], 0
    s_nop 1
    v_mfma_f32_4x4x4_16b_bf16 v[88:91], v[10:11], v[86:87], v[88:91]
    s_nop 4
    v_cvt_pk_bf16_f32 v88, v88, v89
    v_cvt_pk_bf16_f32 v89, v90, v91
    ds_pk_add_bf16 v7, v88 offset:65408
    ds_pk_add_bf16 v7, v89 offset:65412
    s_mov_b64 exec, vcc
    s_branch L2_d73
L2_c74:
    s_mov_b64 s[50:51], vcc
    s_lshl_b64 s[52:53], s[82:83], 1
    s_andn2_b64 s[52:53], s[52:53], s[80:81]
    s_andn2_b64 s[52:53], s[52:53], s[50:51]
    s_or_b64 s[80:81], s[80:81], s[52:53]
    s_not_b64 vcc, s[52:53]
    s_mov_b64 exec, -1
    v_cndmask_b32_dpp v84, v84, v84, vcc wave_shr:1 row_mask:0xf bank_mask:0xf
    v_cndmask_b32_dpp v85, v85, v85, vcc wave_shr:1 row_mask:0xf bank_mask:0xf
    s_lshr_b64 s[52:53], s[52:53], 1
    v_cndmask_b32_dpp v86, v86, v86, vcc wave_shr:1 row_mask:0xf bank_mask:0xf
    v_cndmask_b32_dpp v87, v87, v87, vcc wave_shr:1 row_mask:0xf bank_mask:0xf
    s_andn2_b64 s[82:83], s[82:83], s[52:53]
    v_cndmask_b32_dpp v7, v7, v7, vcc wave_shr:1 row_mask:0xf bank_mask:0xf
    s_mov_b64 vcc, s[50:51]
    s_mov_b64 exec, s[50:51]
    s_cbranch_scc0 L2_d74
    s_mov_b64 exec, s[82:83]
    s_nop 1
    v_mfma_f32_4x4x4_16b_bf16 v[88:91], v[12:13], v[84:85], 0
    s_nop 1
    v_mfma_f32_4x4x4_16b_bf16 v[88:91], v[10:11], v[86:87], v[88:91]
    s_nop 4
    v_cvt_pk_bf16_f32 v88, v88, v89
    v_cvt_pk_bf16_f32 v89, v90, v91
    ds_pk_add_bf16 v7, v88 offset:65408
    ds_pk_add_bf16 v7, v89 offset:65412
    s_mov_b64 exec, vcc
    s_branch L2_d74
L2_c75:
    s_mov_b64 s[50:51], vcc
    s_lshl_b64 s[52:53], s[82:83], 1
    s_andn2_b64 s[52:53], s[52:53], s[80:81]
    s_andn2_b64 s[52:53], s[52:53], s[50:51]
    s_or_b64 s[80:81], s[80:81], s[52:53]
    s_not_b64 vcc, s[52:53]
    s_mov_b64 exec, -1
    v_cndmask_b32_dpp v84, v84, v84, vcc wave_shr:1 row_mask:0xf bank_mask:0xf
    v_cndmask_b32_dpp v85, v85, v85, vcc wave_shr:1 row_mask:0xf bank_mask:0xf
    s_lshr_b64 s[52:53], s[52:53], 1
    v_cndmask_b32_dpp v86, v86, v86, vcc wave_shr:1 row_mask:0xf bank_mask:0xf
    v_cndmask_b32_dpp v87, v87, v87, vcc wave_shr:1 row_mask:0xf bank_mask:0xf
    s_andn2_b64 s[82:83], s[82:83], s[52:53]
    v_cndmask_b32_dpp v7, v7, v7, vcc wave_shr:1 row_mask:0xf bank_mask:0xf
    s_mov_b64 vcc, s[50:51]
    s_mov_b64 exec, s[50:51]
    s_cbranch_scc0 L2_d75
    s_mov_b64 exec, s[82:83]
    s_nop 1
    v_mfma_f32_4x4x4_16b_bf16 v[88:91], v[12:13], v[84:85], 0
    s_nop 1
    v_mfma_f32_4x4x4_16b_bf16 v[88:91], v[10:11], v[86:87], v[88:91]
    s_nop 4
    v_cvt_pk_bf16_f32 v88, v88, v89
    v_cvt_pk_bf16_f32 v89, v90, v91
    ds_pk_add_bf16 v7, v88 offset:65408
    ds_pk_add_bf16 v7, v89 offset:65412
    s_mov_b64 exec, vcc
    s_branch L2_d75
L2_c76:
    s_mov_b64 s[50:51], vcc
    s_lshl_b64 s[52:53], s[82:83], 1
    s_andn2_b64 s[52:53], s[52:53], s[80:81]
    s_andn2_b64 s[52:53], s[52:53], s[50:51]
    s_or_b64 s[80:81], s[80:81], s[52:53]
    s_not_b64 vcc, s[52:53]
    s_mov_b64 exec, -1
    v_cndmask_b32_dpp v84, v84, v84, vcc wave_shr:1 row_mask:0xf bank_mask:0xf
    v_cndmask_b32_dpp v85, v85, v85, vcc wave_shr:1 row_mask:0xf bank_mask:0xf
    s_lshr_b64 s[52:53], s[52:53], 1
    v_cndmask_b32_dpp v86, v86, v86, vcc wave_shr:1 row_mask:0xf bank_mask:0xf
    v_cndmask_b32_dpp v87, v87, v87, vcc wave_shr:1 row_mask:0xf bank_mask:0xf
    s_andn2_b64 s[82:83], s[82:83], s[52:53]
    v_cndmask_b32_dpp v7, v7, v7, vcc wave_shr:1 row_mask:0xf bank_mask:0xf
    s_mov_b64 vcc, s[50:51]
    s_mov_b64 exec, s[50:51]
    s_cbranch_scc0 L2_d76
    s_mov_b64 exec, s[82:83]
    s_nop 1
    v_mfma_f32_4x4x4_16b_bf16 v[88:91], v[12:13], v[84:85], 0
    s_nop 1
    v_mfma_f32_4x4x4_16b_bf16 v[88:91], v[10:11], v[86:87], v[88:91]
    s_nop 4
    v_cvt_pk_bf16_f32 v88, v88, v89
    v_cvt_pk_bf16_f32 v89, v90, v91
    ds_pk_add_bf16 v7, v88 offset:65408
    ds_pk_add_bf16 v7, v89 offset:65412
    s_mov_b64 exec, vcc
    s_branch L2_d76
L2_c77:
    s_mov_b64 s[50:51], vcc
    s_lshl_b64 s[52:53], s[82:83], 1
    s_andn2_b64 s[52:53], s[52:53], s[80:81]
    s_andn2_b64 s[52:53], s[52:53], s[50:51]
    s_or_b64 s[80:81], s[80:81], s[52:53]
    s_not_b64 vcc, s[52:53]
    s_mov_b64 exec, -1
    v_cndmask_b32_dpp v84, v84, v84, vcc wave_shr:1 row_mask:0xf bank_mask:0xf
    v_cndmask_b32_dpp v85, v85, v85, vcc wave_shr:1 row_mask:0xf bank_mask:0xf
    s_lshr_b64 s[52:53], s[52:53], 1
    v_cndmask_b32_dpp v86, v86, v86, vcc wave_shr:1 row_mask:0xf bank_mask:0xf
    v_cndmask_b32_dpp v87, v87, v87, vcc wave_shr:1 row_mask:0xf bank_mask:0xf
    s_andn2_b64 s[82:83], s[82:83], s[52:53]
    v_cndmask_b32_dpp v7, v7, v7, vcc wave_shr:1 row_mask:0xf bank_mask:0xf
    s_mov_b64 vcc, s[50:51]
    s_mov_b64 exec, s[50:51]
    s_cbranch_scc0 L2_d77
    s_mov_b64 exec, s[82:83]
    s_nop 1
    v_mfma_f32_4x4x4_16b_bf16 v[88:91], v[12:13], v[84:85], 0
    s_nop 1
    v_mfma_f32_4x4x4_16b_bf16 v[88:91], v[10:11], v[86:87], v[88:91]
    s_nop 4
    v_cvt_pk_bf16_f32 v88, v88, v89
    v_cvt_pk_bf16_f32 v89, v90, v91
    ds_pk_add_bf16 v7, v88 offset:65408
    ds_pk_add_bf16 v7, v89 offset:65412
    s_mov_b64 exec, vcc
    s_branch L2_d77
L2_c78:
    s_mov_b64 s[50:51], vcc
    s_lshl_b64 s[52:53], s[82:83], 1
    s_andn2_b64 s[52:53], s[52:53], s[80:81]
    s_andn2_b64 s[52:53], s[52:53], s[50:51]
    s_or_b64 s[80:81], s[80:81], s[52:53]
    s_not_b64 vcc, s[52:53]
    s_mov_b64 exec, -1
    v_cndmask_b32_dpp v84, v84, v84, vcc wave_shr:1 row_mask:0xf bank_mask:0xf
    v_cndmask_b32_dpp v85, v85, v85, vcc wave_shr:1 row_mask:0xf bank_mask:0xf
    s_lshr_b64 s[52:53], s[52:53], 1
    v_cndmask_b32_dpp v86, v86, v86, vcc wave_shr:1 row_mask:0xf bank_mask:0xf
    v_cndmask_b32_dpp v87, v87, v87, vcc wave_shr:1 row_mask:0xf bank_mask:0xf
    s_andn2_b64 s[82:83], s[82:83], s[52:53]
    v_cndmask_b32_dpp v7, v7, v7, vcc wave_shr:1 row_mask:0xf bank_mask:0xf
    s_mov_b64 vcc, s[50:51]
    s_mov_b64 exec, s[50:51]
    s_cbranch_scc0 L2_d78
    s_mov_b64 exec, s[82:83]
    s_nop 1
    v_mfma_f32_4x4x4_16b_bf16 v[88:91], v[12:13], v[84:85], 0
    s_nop 1
    v_mfma_f32_4x4x4_16b_bf16 v[88:91], v[10:11], v[86:87], v[88:91]
    s_nop 4
    v_cvt_pk_bf16_f32 v88, v88, v89
    v_cvt_pk_bf16_f32 v89, v90, v91
    ds_pk_add_bf16 v7, v88 offset:65408
    ds_pk_add_bf16 v7, v89 offset:65412
    s_mov_b64 exec, vcc
    s_branch L2_d78
L2_xa79:
    s_cmp_eq_u32 s101, 1
    s_cbranch_scc1 L2_xc79
    v_lshlrev_b32 v89, 0, v96
    v_add_u32 v90, 140, v97
    v_bitop3_b32 v90, v89, v45, v90 bitop3:0x6a
    ds_write_b32 v98, v90 offset:28
    v_lshlrev_b32 v89, 4, v96
    v_add_u32 v90, 120, v97
    v_bitop3_b32 v90, v89, v45, v90 bitop3:0x6a
    ds_write_b32 v98, v90 offset:24
    v_lshlrev_b32 v89, 8, v96
    v_add_u32 v90, 100, v97
    v_bitop3_b32 v90, v89, v45, v90 bitop3:0x6a
    ds_write_b32 v98, v90 offset:20
L2_xc79:
    v_lshlrev_b32 v89, 12, v96
    v_add_u32 v90, 80, v97
    v_bitop3_b32 v90, v89, v45, v90 bitop3:0x6a
    ds_write_b32 v98, v90 offset:16
    s_branch L2_xb79
L2_xe79:
    v_cmp_lt_u32 vcc, 32, v99
    v_cmp_lt_u32 s[58:59], 31, v88
    v_lshrrev_b32 v89, 16, v96
    v_add_u32 v97, 80, v97
    s_or_b64 vcc, vcc, s[58:59]
    s_cbranch_scc1 L2_xs79
    v_lshlrev_b32 v89, v1, v89
    v_and_b32 v89, v45, v89
    v_cmp_ne_u32 vcc, 0, v89
    v_xor_b32 v90, v97, v89
    s_add_u32 s3, s37, s38
    v_mbcnt_lo_u32_b32 v98, vcc_lo, 0
    v_mbcnt_hi_u32_b32 v98, vcc_hi, v98
    s_bcnt1_i32_b64 s41, vcc
    v_lshl_add_u32 v98, v98, 2, s3
    s_mov_b64 exec, vcc
    ds_write_b32 v98, v90
    s_mov_b64 exec, -1
    s_lshl2_add_u32 s37, s41, s37
    s_branch L2_xr79
L2_xf79:
    s_waitcnt lgkmcnt(0)
    s_cmp_gt_u32 s37, 1024
    s_cbranch_scc1 L2_xs79
    v_mov_b32 v43, -1
    s_cmp_ge_u32 s37, 512
    s_cbranch_scc1 L2_xg79
    v_mov_b32 v42, -1
    s_cmp_ge_u32 s37, 256
    s_cbranch_scc1 L2_xg79
    v_mov_b32 v41, -1
    s_branch L2_xg79
L2_xs79:
    s_waitcnt lgkmcnt(0)
    v_mov_b32 v40, -1
    v_mov_b32 v41, -1
    v_mov_b32 v42, -1
    v_mov_b32 v43, -1
    s_add_u32 s3, s42, 2
    s_bitset1_b32 s36, s3
    s_branch L2_xg79
L2_c80:
    s_mov_b64 s[50:51], vcc
    s_lshl_b64 s[52:53], s[82:83], 1
    s_andn2_b64 s[52:53], s[52:53], s[80:81]
    s_andn2_b64 s[52:53], s[52:53], s[50:51]
    s_or_b64 s[80:81], s[80:81], s[52:53]
    s_not_b64 vcc, s[52:53]
    s_mov_b64 exec, -1
    v_cndmask_b32_dpp v84, v84, v84, vcc wave_shr:1 row_mask:0xf bank_mask:0xf
    v_cndmask_b32_dpp v85, v85, v85, vcc wave_shr:1 row_mask:0xf bank_mask:0xf
    s_lshr_b64 s[52:53], s[52:53], 1
    v_cndmask_b32_dpp v86, v86, v86, vcc wave_shr:1 row_mask:0xf bank_mask:0xf
    v_cndmask_b32_dpp v87, v87, v87, vcc wave_shr:1 row_mask:0xf bank_mask:0xf
    s_andn2_b64 s[82:83], s[82:83], s[52:53]
    v_cndmask_b32_dpp v7, v7, v7, vcc wave_shr:1 row_mask:0xf bank_mask:0xf
    s_mov_b64 vcc, s[50:51]
    s_mov_b64 exec, s[50:51]
    s_cbranch_scc0 L2_d80
    s_mov_b64 exec, s[82:83]
    s_nop 1
    v_mfma_f32_4x4x4_16b_bf16 v[88:91], v[12:13], v[84:85], 0
    s_nop 1
    v_mfma_f32_4x4x4_16b_bf16 v[88:91], v[10:11], v[86:87], v[88:91]
    s_nop 4
    v_cvt_pk_bf16_f32 v88, v88, v89
    v_cvt_pk_bf16_f32 v89, v90, v91
    ds_pk_add_bf16 v7, v88 offset:65408
    ds_pk_add_bf16 v7, v89 offset:65412
    s_mov_b64 exec, vcc
    s_branch L2_d80
L2_c81:
    s_mov_b64 s[50:51], vcc
    s_lshl_b64 s[52:53], s[82:83], 1
    s_andn2_b64 s[52:53], s[52:53], s[80:81]
    s_andn2_b64 s[52:53], s[52:53], s[50:51]
    s_or_b64 s[80:81], s[80:81], s[52:53]
    s_not_b64 vcc, s[52:53]
    s_mov_b64 exec, -1
    v_cndmask_b32_dpp v84, v84, v84, vcc wave_shr:1 row_mask:0xf bank_mask:0xf
    v_cndmask_b32_dpp v85, v85, v85, vcc wave_shr:1 row_mask:0xf bank_mask:0xf
    s_lshr_b64 s[52:53], s[52:53], 1
    v_cndmask_b32_dpp v86, v86, v86, vcc wave_shr:1 row_mask:0xf bank_mask:0xf
    v_cndmask_b32_dpp v87, v87, v87, vcc wave_shr:1 row_mask:0xf bank_mask:0xf
    s_andn2_b64 s[82:83], s[82:83], s[52:53]
    v_cndmask_b32_dpp v7, v7, v7, vcc wave_shr:1 row_mask:0xf bank_mask:0xf
    s_mov_b64 vcc, s[50:51]
    s_mov_b64 exec, s[50:51]
    s_cbranch_scc0 L2_d81
    s_mov_b64 exec, s[82:83]
    s_nop 1
    v_mfma_f32_4x4x4_16b_bf16 v[88:91], v[12:13], v[84:85], 0
    s_nop 1
    v_mfma_f32_4x4x4_16b_bf16 v[88:91], v[10:11], v[86:87], v[88:91]
    s_nop 4
    v_cvt_pk_bf16_f32 v88, v88, v89
    v_cvt_pk_bf16_f32 v89, v90, v91
    ds_pk_add_bf16 v7, v88 offset:65408
    ds_pk_add_bf16 v7, v89 offset:65412
    s_mov_b64 exec, vcc
    s_branch L2_d81
L2_c82:
    s_mov_b64 s[50:51], vcc
    s_lshl_b64 s[52:53], s[82:83], 1
    s_andn2_b64 s[52:53], s[52:53], s[80:81]
    s_andn2_b64 s[52:53], s[52:53], s[50:51]
    s_or_b64 s[80:81], s[80:81], s[52:53]
    s_not_b64 vcc, s[52:53]
    s_mov_b64 exec, -1
    v_cndmask_b32_dpp v84, v84, v84, vcc wave_shr:1 row_mask:0xf bank_mask:0xf
    v_cndmask_b32_dpp v85, v85, v85, vcc wave_shr:1 row_mask:0xf bank_mask:0xf
    s_lshr_b64 s[52:53], s[52:53], 1
    v_cndmask_b32_dpp v86, v86, v86, vcc wave_shr:1 row_mask:0xf bank_mask:0xf
    v_cndmask_b32_dpp v87, v87, v87, vcc wave_shr:1 row_mask:0xf bank_mask:0xf
    s_andn2_b64 s[82:83], s[82:83], s[52:53]
    v_cndmask_b32_dpp v7, v7, v7, vcc wave_shr:1 row_mask:0xf bank_mask:0xf
    s_mov_b64 vcc, s[50:51]
    s_mov_b64 exec, s[50:51]
    s_cbranch_scc0 L2_d82
    s_mov_b64 exec, s[82:83]
    s_nop 1
    v_mfma_f32_4x4x4_16b_bf16 v[88:91], v[12:13], v[84:85], 0
    s_nop 1
    v_mfma_f32_4x4x4_16b_bf16 v[88:91], v[10:11], v[86:87], v[88:91]
    s_nop 4
    v_cvt_pk_bf16_f32 v88, v88, v89
    v_cvt_pk_bf16_f32 v89, v90, v91
    ds_pk_add_bf16 v7, v88 offset:65408
    ds_pk_add_bf16 v7, v89 offset:65412
    s_mov_b64 exec, vcc
    s_branch L2_d82
L2_c83:
    s_mov_b64 s[50:51], vcc
    s_lshl_b64 s[52:53], s[82:83], 1
    s_andn2_b64 s[52:53], s[52:53], s[80:81]
    s_andn2_b64 s[52:53], s[52:53], s[50:51]
    s_or_b64 s[80:81], s[80:81], s[52:53]
    s_not_b64 vcc, s[52:53]
    s_mov_b64 exec, -1
    v_cndmask_b32_dpp v84, v84, v84, vcc wave_shr:1 row_mask:0xf bank_mask:0xf
    v_cndmask_b32_dpp v85, v85, v85, vcc wave_shr:1 row_mask:0xf bank_mask:0xf
    s_lshr_b64 s[52:53], s[52:53], 1
    v_cndmask_b32_dpp v86, v86, v86, vcc wave_shr:1 row_mask:0xf bank_mask:0xf
    v_cndmask_b32_dpp v87, v87, v87, vcc wave_shr:1 row_mask:0xf bank_mask:0xf
    s_andn2_b64 s[82:83], s[82:83], s[52:53]
    v_cndmask_b32_dpp v7, v7, v7, vcc wave_shr:1 row_mask:0xf bank_mask:0xf
    s_mov_b64 vcc, s[50:51]
    s_mov_b64 exec, s[50:51]
    s_cbranch_scc0 L2_d83
    s_mov_b64 exec, s[82:83]
    s_nop 1
    v_mfma_f32_4x4x4_16b_bf16 v[88:91], v[12:13], v[84:85], 0
    s_nop 1
    v_mfma_f32_4x4x4_16b_bf16 v[88:91], v[10:11], v[86:87], v[88:91]
    s_nop 4
    v_cvt_pk_bf16_f32 v88, v88, v89
    v_cvt_pk_bf16_f32 v89, v90, v91
    ds_pk_add_bf16 v7, v88 offset:65408
    ds_pk_add_bf16 v7, v89 offset:65412
    s_mov_b64 exec, vcc
    s_branch L2_d83
L2_c84:
    s_mov_b64 s[50:51], vcc
    s_lshl_b64 s[52:53], s[82:83], 1
    s_andn2_b64 s[52:53], s[52:53], s[80:81]
    s_andn2_b64 s[52:53], s[52:53], s[50:51]
    s_or_b64 s[80:81], s[80:81], s[52:53]
    s_not_b64 vcc, s[52:53]
    s_mov_b64 exec, -1
    v_cndmask_b32_dpp v84, v84, v84, vcc wave_shr:1 row_mask:0xf bank_mask:0xf
    v_cndmask_b32_dpp v85, v85, v85, vcc wave_shr:1 row_mask:0xf bank_mask:0xf
    s_lshr_b64 s[52:53], s[52:53], 1
    v_cndmask_b32_dpp v86, v86, v86, vcc wave_shr:1 row_mask:0xf bank_mask:0xf
    v_cndmask_b32_dpp v87, v87, v87, vcc wave_shr:1 row_mask:0xf bank_mask:0xf
    s_andn2_b64 s[82:83], s[82:83], s[52:53]
    v_cndmask_b32_dpp v7, v7, v7, vcc wave_shr:1 row_mask:0xf bank_mask:0xf
    s_mov_b64 vcc, s[50:51]
    s_mov_b64 exec, s[50:51]
    s_cbranch_scc0 L2_d84
    s_mov_b64 exec, s[82:83]
    s_nop 1
    v_mfma_f32_4x4x4_16b_bf16 v[88:91], v[12:13], v[84:85], 0
    s_nop 1
    v_mfma_f32_4x4x4_16b_bf16 v[88:91], v[10:11], v[86:87], v[88:91]
    s_nop 4
    v_cvt_pk_bf16_f32 v88, v88, v89
    v_cvt_pk_bf16_f32 v89, v90, v91
    ds_pk_add_bf16 v7, v88 offset:65408
    ds_pk_add_bf16 v7, v89 offset:65412
    s_mov_b64 exec, vcc
    s_branch L2_d84
L2_c85:
    s_mov_b64 s[50:51], vcc
    s_lshl_b64 s[52:53], s[82:83], 1
    s_andn2_b64 s[52:53], s[52:53], s[80:81]
    s_andn2_b64 s[52:53], s[52:53], s[50:51]
    s_or_b64 s[80:81], s[80:81], s[52:53]
    s_not_b64 vcc, s[52:53]
    s_mov_b64 exec, -1
    v_cndmask_b32_dpp v84, v84, v84, vcc wave_shr:1 row_mask:0xf bank_mask:0xf
    v_cndmask_b32_dpp v85, v85, v85, vcc wave_shr:1 row_mask:0xf bank_mask:0xf
    s_lshr_b64 s[52:53], s[52:53], 1
    v_cndmask_b32_dpp v86, v86, v86, vcc wave_shr:1 row_mask:0xf bank_mask:0xf
    v_cndmask_b32_dpp v87, v87, v87, vcc wave_shr:1 row_mask:0xf bank_mask:0xf
    s_andn2_b64 s[82:83], s[82:83], s[52:53]
    v_cndmask_b32_dpp v7, v7, v7, vcc wave_shr:1 row_mask:0xf bank_mask:0xf
    s_mov_b64 vcc, s[50:51]
    s_mov_b64 exec, s[50:51]
    s_cbranch_scc0 L2_d85
    s_mov_b64 exec, s[82:83]
    s_nop 1
    v_mfma_f32_4x4x4_16b_bf16 v[88:91], v[12:13], v[84:85], 0
    s_nop 1
    v_mfma_f32_4x4x4_16b_bf16 v[88:91], v[10:11], v[86:87], v[88:91]
    s_nop 4
    v_cvt_pk_bf16_f32 v88, v88, v89
    v_cvt_pk_bf16_f32 v89, v90, v91
    ds_pk_add_bf16 v7, v88 offset:65408
    ds_pk_add_bf16 v7, v89 offset:65412
    s_mov_b64 exec, vcc
    s_branch L2_d85
L2_c86:
    s_mov_b64 s[50:51], vcc
    s_lshl_b64 s[52:53], s[82:83], 1
    s_andn2_b64 s[52:53], s[52:53], s[80:81]
    s_andn2_b64 s[52:53], s[52:53], s[50:51]
    s_or_b64 s[80:81], s[80:81], s[52:53]
    s_not_b64 vcc, s[52:53]
    s_mov_b64 exec, -1
    v_cndmask_b32_dpp v84, v84, v84, vcc wave_shr:1 row_mask:0xf bank_mask:0xf
    v_cndmask_b32_dpp v85, v85, v85, vcc wave_shr:1 row_mask:0xf bank_mask:0xf
    s_lshr_b64 s[52:53], s[52:53], 1
    v_cndmask_b32_dpp v86, v86, v86, vcc wave_shr:1 row_mask:0xf bank_mask:0xf
    v_cndmask_b32_dpp v87, v87, v87, vcc wave_shr:1 row_mask:0xf bank_mask:0xf
    s_andn2_b64 s[82:83], s[82:83], s[52:53]
    v_cndmask_b32_dpp v7, v7, v7, vcc wave_shr:1 row_mask:0xf bank_mask:0xf
    s_mov_b64 vcc, s[50:51]
    s_mov_b64 exec, s[50:51]
    s_cbranch_scc0 L2_d86
    s_mov_b64 exec, s[82:83]
    s_nop 1
    v_mfma_f32_4x4x4_16b_bf16 v[88:91], v[12:13], v[84:85], 0
    s_nop 1
    v_mfma_f32_4x4x4_16b_bf16 v[88:91], v[10:11], v[86:87], v[88:91]
    s_nop 4
    v_cvt_pk_bf16_f32 v88, v88, v89
    v_cvt_pk_bf16_f32 v89, v90, v91
    ds_pk_add_bf16 v7, v88 offset:65408
    ds_pk_add_bf16 v7, v89 offset:65412
    s_mov_b64 exec, vcc
    s_branch L2_d86
L2_c87:
    s_mov_b64 s[50:51], vcc
    s_lshl_b64 s[52:53], s[82:83], 1
    s_andn2_b64 s[52:53], s[52:53], s[80:81]
    s_andn2_b64 s[52:53], s[52:53], s[50:51]
    s_or_b64 s[80:81], s[80:81], s[52:53]
    s_not_b64 vcc, s[52:53]
    s_mov_b64 exec, -1
    v_cndmask_b32_dpp v84, v84, v84, vcc wave_shr:1 row_mask:0xf bank_mask:0xf
    v_cndmask_b32_dpp v85, v85, v85, vcc wave_shr:1 row_mask:0xf bank_mask:0xf
    s_lshr_b64 s[52:53], s[52:53], 1
    v_cndmask_b32_dpp v86, v86, v86, vcc wave_shr:1 row_mask:0xf bank_mask:0xf
    v_cndmask_b32_dpp v87, v87, v87, vcc wave_shr:1 row_mask:0xf bank_mask:0xf
    s_andn2_b64 s[82:83], s[82:83], s[52:53]
    v_cndmask_b32_dpp v7, v7, v7, vcc wave_shr:1 row_mask:0xf bank_mask:0xf
    s_mov_b64 vcc, s[50:51]
    s_mov_b64 exec, s[50:51]
    s_cbranch_scc0 L2_d87
    s_mov_b64 exec, s[82:83]
    s_nop 1
    v_mfma_f32_4x4x4_16b_bf16 v[88:91], v[12:13], v[84:85], 0
    s_nop 1
    v_mfma_f32_4x4x4_16b_bf16 v[88:91], v[10:11], v[86:87], v[88:91]
    s_nop 4
    v_cvt_pk_bf16_f32 v88, v88, v89
    v_cvt_pk_bf16_f32 v89, v90, v91
    ds_pk_add_bf16 v7, v88 offset:65408
    ds_pk_add_bf16 v7, v89 offset:65412
    s_mov_b64 exec, vcc
    s_branch L2_d87
L2_xo88:
    v_cmp_lt_u32 vcc, 20, v99
    s_mov_b32 s101, 1
    s_cbranch_vccz L2_xp88
    v_cmp_lt_u32 vcc, 32, v99
    v_cmp_lt_u32 s[58:59], 31, v88
    s_mov_b32 s101, 2
    s_or_b64 vcc, vcc, s[58:59]
    s_cbranch_scc0 L2_xp88
    s_mov_b32 s37, 0x10000
    s_branch L2_xp88
L2_c89:
    s_mov_b64 s[50:51], vcc
    s_lshl_b64 s[52:53], s[82:83], 1
    s_andn2_b64 s[52:53], s[52:53], s[80:81]
    s_andn2_b64 s[52:53], s[52:53], s[50:51]
    s_or_b64 s[80:81], s[80:81], s[52:53]
    s_not_b64 vcc, s[52:53]
    s_mov_b64 exec, -1
    v_cndmask_b32_dpp v84, v84, v84, vcc wave_shr:1 row_mask:0xf bank_mask:0xf
    v_cndmask_b32_dpp v85, v85, v85, vcc wave_shr:1 row_mask:0xf bank_mask:0xf
    s_lshr_b64 s[52:53], s[52:53], 1
    v_cndmask_b32_dpp v86, v86, v86, vcc wave_shr:1 row_mask:0xf bank_mask:0xf
    v_cndmask_b32_dpp v87, v87, v87, vcc wave_shr:1 row_mask:0xf bank_mask:0xf
    s_andn2_b64 s[82:83], s[82:83], s[52:53]
    v_cndmask_b32_dpp v7, v7, v7, vcc wave_shr:1 row_mask:0xf bank_mask:0xf
    s_mov_b64 vcc, s[50:51]
    s_mov_b64 exec, s[50:51]
    s_cbranch_scc0 L2_d89
    s_mov_b64 exec, s[82:83]
    s_nop 1
    v_mfma_f32_4x4x4_16b_bf16 v[88:91], v[12:13], v[84:85], 0
    s_nop 1
    v_mfma_f32_4x4x4_16b_bf16 v[88:91], v[10:11], v[86:87], v[88:91]
    s_nop 4
    v_cvt_pk_bf16_f32 v88, v88, v89
    v_cvt_pk_bf16_f32 v89, v90, v91
    ds_pk_add_bf16 v7, v88 offset:65408
    ds_pk_add_bf16 v7, v89 offset:65412
    s_mov_b64 exec, vcc
    s_branch L2_d89
L2_c90:
    s_mov_b64 s[50:51], vcc
    s_lshl_b64 s[52:53], s[82:83], 1
    s_andn2_b64 s[52:53], s[52:53], s[80:81]
    s_andn2_b64 s[52:53], s[52:53], s[50:51]
    s_or_b64 s[80:81], s[80:81], s[52:53]
    s_not_b64 vcc, s[52:53]
    s_mov_b64 exec, -1
    v_cndmask_b32_dpp v84, v84, v84, vcc wave_shr:1 row_mask:0xf bank_mask:0xf
    v_cndmask_b32_dpp v85, v85, v85, vcc wave_shr:1 row_mask:0xf bank_mask:0xf
    s_lshr_b64 s[52:53], s[52:53], 1
    v_cndmask_b32_dpp v86, v86, v86, vcc wave_shr:1 row_mask:0xf bank_mask:0xf
    v_cndmask_b32_dpp v87, v87, v87, vcc wave_shr:1 row_mask:0xf bank_mask:0xf
    s_andn2_b64 s[82:83], s[82:83], s[52:53]
    v_cndmask_b32_dpp v7, v7, v7, vcc wave_shr:1 row_mask:0xf bank_mask:0xf
    s_mov_b64 vcc, s[50:51]
    s_mov_b64 exec, s[50:51]
    s_cbranch_scc0 L2_d90
    s_mov_b64 exec, s[82:83]
    s_nop 1
    v_mfma_f32_4x4x4_16b_bf16 v[88:91], v[12:13], v[84:85], 0
    s_nop 1
    v_mfma_f32_4x4x4_16b_bf16 v[88:91], v[10:11], v[86:87], v[88:91]
    s_nop 4
    v_cvt_pk_bf16_f32 v88, v88, v89
    v_cvt_pk_bf16_f32 v89, v90, v91
    ds_pk_add_bf16 v7, v88 offset:65408
    ds_pk_add_bf16 v7, v89 offset:65412
    s_mov_b64 exec, vcc
    s_branch L2_d90
L2_c91:
    s_mov_b64 s[50:51], vcc
    s_lshl_b64 s[52:53], s[82:83], 1
    s_andn2_b64 s[52:53], s[52:53], s[80:81]
    s_andn2_b64 s[52:53], s[52:53], s[50:51]
    s_or_b64 s[80:81], s[80:81], s[52:53]
    s_not_b64 vcc, s[52:53]
    s_mov_b64 exec, -1
    v_cndmask_b32_dpp v84, v84, v84, vcc wave_shr:1 row_mask:0xf bank_mask:0xf
    v_cndmask_b32_dpp v85, v85, v85, vcc wave_shr:1 row_mask:0xf bank_mask:0xf
    s_lshr_b64 s[52:53], s[52:53], 1
    v_cndmask_b32_dpp v86, v86, v86, vcc wave_shr:1 row_mask:0xf bank_mask:0xf
    v_cndmask_b32_dpp v87, v87, v87, vcc wave_shr:1 row_mask:0xf bank_mask:0xf
    s_andn2_b64 s[82:83], s[82:83], s[52:53]
    v_cndmask_b32_dpp v7, v7, v7, vcc wave_shr:1 row_mask:0xf bank_mask:0xf
    s_mov_b64 vcc, s[50:51]
    s_mov_b64 exec, s[50:51]
    s_cbranch_scc0 L2_d91
    s_mov_b64 exec, s[82:83]
    s_nop 1
    v_mfma_f32_4x4x4_16b_bf16 v[88:91], v[12:13], v[84:85], 0
    s_nop 1
    v_mfma_f32_4x4x4_16b_bf16 v[88:91], v[10:11], v[86:87], v[88:91]
    s_nop 4
    v_cvt_pk_bf16_f32 v88, v88, v89
    v_cvt_pk_bf16_f32 v89, v90, v91
    ds_pk_add_bf16 v7, v88 offset:65408
    ds_pk_add_bf16 v7, v89 offset:65412
    s_mov_b64 exec, vcc
    s_branch L2_d91
L2_c92:
    s_mov_b64 s[50:51], vcc
    s_lshl_b64 s[52:53], s[82:83], 1
    s_andn2_b64 s[52:53], s[52:53], s[80:81]
    s_andn2_b64 s[52:53], s[52:53], s[50:51]
    s_or_b64 s[80:81], s[80:81], s[52:53]
    s_not_b64 vcc, s[52:53]
    s_mov_b64 exec, -1
    v_cndmask_b32_dpp v84, v84, v84, vcc wave_shr:1 row_mask:0xf bank_mask:0xf
    v_cndmask_b32_dpp v85, v85, v85, vcc wave_shr:1 row_mask:0xf bank_mask:0xf
    s_lshr_b64 s[52:53], s[52:53], 1
    v_cndmask_b32_dpp v86, v86, v86, vcc wave_shr:1 row_mask:0xf bank_mask:0xf
    v_cndmask_b32_dpp v87, v87, v87, vcc wave_shr:1 row_mask:0xf bank_mask:0xf
    s_andn2_b64 s[82:83], s[82:83], s[52:53]
    v_cndmask_b32_dpp v7, v7, v7, vcc wave_shr:1 row_mask:0xf bank_mask:0xf
    s_mov_b64 vcc, s[50:51]
    s_mov_b64 exec, s[50:51]
    s_cbranch_scc0 L2_d92
    s_mov_b64 exec, s[82:83]
    s_nop 1
    v_mfma_f32_4x4x4_16b_bf16 v[88:91], v[12:13], v[84:85], 0
    s_nop 1
    v_mfma_f32_4x4x4_16b_bf16 v[88:91], v[10:11], v[86:87], v[88:91]
    s_nop 4
    v_cvt_pk_bf16_f32 v88, v88, v89
    v_cvt_pk_bf16_f32 v89, v90, v91
    ds_pk_add_bf16 v7, v88 offset:65408
    ds_pk_add_bf16 v7, v89 offset:65412
    s_mov_b64 exec, vcc
    s_branch L2_d92
L2_c93:
    s_mov_b64 s[50:51], vcc
    s_lshl_b64 s[52:53], s[82:83], 1
    s_andn2_b64 s[52:53], s[52:53], s[80:81]
    s_andn2_b64 s[52:53], s[52:53], s[50:51]
    s_or_b64 s[80:81], s[80:81], s[52:53]
    s_not_b64 vcc, s[52:53]
    s_mov_b64 exec, -1
    v_cndmask_b32_dpp v84, v84, v84, vcc wave_shr:1 row_mask:0xf bank_mask:0xf
    v_cndmask_b32_dpp v85, v85, v85, vcc wave_shr:1 row_mask:0xf bank_mask:0xf
    s_lshr_b64 s[52:53], s[52:53], 1
    v_cndmask_b32_dpp v86, v86, v86, vcc wave_shr:1 row_mask:0xf bank_mask:0xf
    v_cndmask_b32_dpp v87, v87, v87, vcc wave_shr:1 row_mask:0xf bank_mask:0xf
    s_andn2_b64 s[82:83], s[82:83], s[52:53]
    v_cndmask_b32_dpp v7, v7, v7, vcc wave_shr:1 row_mask:0xf bank_mask:0xf
    s_mov_b64 vcc, s[50:51]
    s_mov_b64 exec, s[50:51]
    s_cbranch_scc0 L2_d93
    s_mov_b64 exec, s[82:83]
    s_nop 1
    v_mfma_f32_4x4x4_16b_bf16 v[88:91], v[12:13], v[84:85], 0
    s_nop 1
    v_mfma_f32_4x4x4_16b_bf16 v[88:91], v[10:11], v[86:87], v[88:91]
    s_nop 4
    v_cvt_pk_bf16_f32 v88, v88, v89
    v_cvt_pk_bf16_f32 v89, v90, v91
    ds_pk_add_bf16 v7, v88 offset:65408
    ds_pk_add_bf16 v7, v89 offset:65412
    s_mov_b64 exec, vcc
    s_branch L2_d93
L2_c94:
    s_mov_b64 s[50:51], vcc
    s_lshl_b64 s[52:53], s[82:83], 1
    s_andn2_b64 s[52:53], s[52:53], s[80:81]
    s_andn2_b64 s[52:53], s[52:53], s[50:51]
    s_or_b64 s[80:81], s[80:81], s[52:53]
    s_not_b64 vcc, s[52:53]
    s_mov_b64 exec, -1
    v_cndmask_b32_dpp v84, v84, v84, vcc wave_shr:1 row_mask:0xf bank_mask:0xf
    v_cndmask_b32_dpp v85, v85, v85, vcc wave_shr:1 row_mask:0xf bank_mask:0xf
    s_lshr_b64 s[52:53], s[52:53], 1
    v_cndmask_b32_dpp v86, v86, v86, vcc wave_shr:1 row_mask:0xf bank_mask:0xf
    v_cndmask_b32_dpp v87, v87, v87, vcc wave_shr:1 row_mask:0xf bank_mask:0xf
    s_andn2_b64 s[82:83], s[82:83], s[52:53]
    v_cndmask_b32_dpp v7, v7, v7, vcc wave_shr:1 row_mask:0xf bank_mask:0xf
    s_mov_b64 vcc, s[50:51]
    s_mov_b64 exec, s[50:51]
    s_cbranch_scc0 L2_d94
    s_mov_b64 exec, s[82:83]
    s_nop 1
    v_mfma_f32_4x4x4_16b_bf16 v[88:91], v[12:13], v[84:85], 0
    s_nop 1
    v_mfma_f32_4x4x4_16b_bf16 v[88:91], v[10:11], v[86:87], v[88:91]
    s_nop 4
    v_cvt_pk_bf16_f32 v88, v88, v89
    v_cvt_pk_bf16_f32 v89, v90, v91
    ds_pk_add_bf16 v7, v88 offset:65408
    ds_pk_add_bf16 v7, v89 offset:65412
    s_mov_b64 exec, vcc
    s_branch L2_d94
L2_c95:
    s_mov_b64 s[50:51], vcc
    s_lshl_b64 s[52:53], s[82:83], 1
    s_andn2_b64 s[52:53], s[52:53], s[80:81]
    s_andn2_b64 s[52:53], s[52:53], s[50:51]
    s_or_b64 s[80:81], s[80:81], s[52:53]
    s_not_b64 vcc, s[52:53]
    s_mov_b64 exec, -1
    v_cndmask_b32_dpp v84, v84, v84, vcc wave_shr:1 row_mask:0xf bank_mask:0xf
    v_cndmask_b32_dpp v85, v85, v85, vcc wave_shr:1 row_mask:0xf bank_mask:0xf
    s_lshr_b64 s[52:53], s[52:53], 1
    v_cndmask_b32_dpp v86, v86, v86, vcc wave_shr:1 row_mask:0xf bank_mask:0xf
    v_cndmask_b32_dpp v87, v87, v87, vcc wave_shr:1 row_mask:0xf bank_mask:0xf
    s_andn2_b64 s[82:83], s[82:83], s[52:53]
    v_cndmask_b32_dpp v7, v7, v7, vcc wave_shr:1 row_mask:0xf bank_mask:0xf
    s_mov_b64 vcc, s[50:51]
    s_mov_b64 exec, s[50:51]
    s_cbranch_scc0 L2_d95
    s_mov_b64 exec, s[82:83]
    s_nop 1
    v_mfma_f32_4x4x4_16b_bf16 v[88:91], v[12:13], v[84:85], 0
    s_nop 1
    v_mfma_f32_4x4x4_16b_bf16 v[88:91], v[10:11], v[86:87], v[88:91]
    s_nop 4
    v_cvt_pk_bf16_f32 v88, v88, v89
    v_cvt_pk_bf16_f32 v89, v90, v91
    ds_pk_add_bf16 v7, v88 offset:65408
    ds_pk_add_bf16 v7, v89 offset:65412
    s_mov_b64 exec, vcc
    s_branch L2_d95
L2_c96:
    s_mov_b64 s[50:51], vcc
    s_lshl_b64 s[52:53], s[82:83], 1
    s_andn2_b64 s[52:53], s[52:53], s[80:81]
    s_andn2_b64 s[52:53], s[52:53], s[50:51]
    s_or_b64 s[80:81], s[80:81], s[52:53]
    s_not_b64 vcc, s[52:53]
    s_mov_b64 exec, -1
    v_cndmask_b32_dpp v84, v84, v84, vcc wave_shr:1 row_mask:0xf bank_mask:0xf
    v_cndmask_b32_dpp v85, v85, v85, vcc wave_shr:1 row_mask:0xf bank_mask:0xf
    s_lshr_b64 s[52:53], s[52:53], 1
    v_cndmask_b32_dpp v86, v86, v86, vcc wave_shr:1 row_mask:0xf bank_mask:0xf
    v_cndmask_b32_dpp v87, v87, v87, vcc wave_shr:1 row_mask:0xf bank_mask:0xf
    s_andn2_b64 s[82:83], s[82:83], s[52:53]
    v_cndmask_b32_dpp v7, v7, v7, vcc wave_shr:1 row_mask:0xf bank_mask:0xf
    s_mov_b64 vcc, s[50:51]
    s_mov_b64 exec, s[50:51]
    s_cbranch_scc0 L2_d96
    s_mov_b64 exec, s[82:83]
    s_nop 1
    v_mfma_f32_4x4x4_16b_bf16 v[88:91], v[12:13], v[84:85], 0
    s_nop 1
    v_mfma_f32_4x4x4_16b_bf16 v[88:91], v[10:11], v[86:87], v[88:91]
    s_nop 4
    v_cvt_pk_bf16_f32 v88, v88, v89
    v_cvt_pk_bf16_f32 v89, v90, v91
    ds_pk_add_bf16 v7, v88 offset:65408
    ds_pk_add_bf16 v7, v89 offset:65412
    s_mov_b64 exec, vcc
    s_branch L2_d96
L2_xa97:
    s_cmp_eq_u32 s101, 1
    s_cbranch_scc1 L2_xc97
    v_lshlrev_b32 v89, 0, v96
    v_add_u32 v90, 140, v97
    v_bitop3_b32 v90, v89, v45, v90 bitop3:0x6a
    ds_write_b32 v98, v90 offset:28
    v_lshlrev_b32 v89, 4, v96
    v_add_u32 v90, 120, v97
    v_bitop3_b32 v90, v89, v45, v90 bitop3:0x6a
    ds_write_b32 v98, v90 offset:24
    v_lshlrev_b32 v89, 8, v96
    v_add_u32 v90, 100, v97
    v_bitop3_b32 v90, v89, v45, v90 bitop3:0x6a
    ds_write_b32 v98, v90 offset:20
L2_xc97:
    v_lshlrev_b32 v89, 12, v96
    v_add_u32 v90, 80, v97
    v_bitop3_b32 v90, v89, v45, v90 bitop3:0x6a
    ds_write_b32 v98, v90 offset:16
    s_branch L2_xb97
L2_xe97:
    v_cmp_lt_u32 vcc, 32, v99
    v_cmp_lt_u32 s[58:59], 31, v88
    v_lshrrev_b32 v89, 16, v96
    v_add_u32 v97, 80, v97
    s_or_b64 vcc, vcc, s[58:59]
    s_cbranch_scc1 L2_xs97
    v_lshlrev_b32 v89, v1, v89
    v_and_b32 v89, v45, v89
    v_cmp_ne_u32 vcc, 0, v89
    v_xor_b32 v90, v97, v89
    s_add_u32 s3, s37, s38
    v_mbcnt_lo_u32_b32 v98, vcc_lo, 0
    v_mbcnt_hi_u32_b32 v98, vcc_hi, v98
    s_bcnt1_i32_b64 s41, vcc
    v_lshl_add_u32 v98, v98, 2, s3
    s_mov_b64 exec, vcc
    ds_write_b32 v98, v90
    s_mov_b64 exec, -1
    s_lshl2_add_u32 s37, s41, s37
    s_branch L2_xr97
L2_xf97:
    s_waitcnt lgkmcnt(0)
    s_cmp_gt_u32 s37, 1024
    s_cbranch_scc1 L2_xs97
    v_mov_b32 v43, -1
    s_cmp_ge_u32 s37, 512
    s_cbranch_scc1 L2_xg97
    v_mov_b32 v42, -1
    s_cmp_ge_u32 s37, 256
    s_cbranch_scc1 L2_xg97
    v_mov_b32 v41, -1
    s_branch L2_xg97
L2_xs97:
    s_waitcnt lgkmcnt(0)
    v_mov_b32 v40, -1
    v_mov_b32 v41, -1
    v_mov_b32 v42, -1
    v_mov_b32 v43, -1
    s_add_u32 s3, s42, 2
    s_bitset1_b32 s36, s3
    s_branch L2_xg97
L2_c98:
    s_mov_b64 s[50:51], vcc
    s_lshl_b64 s[52:53], s[82:83], 1
    s_andn2_b64 s[52:53], s[52:53], s[80:81]
    s_andn2_b64 s[52:53], s[52:53], s[50:51]
    s_or_b64 s[80:81], s[80:81], s[52:53]
    s_not_b64 vcc, s[52:53]
    s_mov_b64 exec, -1
    v_cndmask_b32_dpp v84, v84, v84, vcc wave_shr:1 row_mask:0xf bank_mask:0xf
    v_cndmask_b32_dpp v85, v85, v85, vcc wave_shr:1 row_mask:0xf bank_mask:0xf
    s_lshr_b64 s[52:53], s[52:53], 1
    v_cndmask_b32_dpp v86, v86, v86, vcc wave_shr:1 row_mask:0xf bank_mask:0xf
    v_cndmask_b32_dpp v87, v87, v87, vcc wave_shr:1 row_mask:0xf bank_mask:0xf
    s_andn2_b64 s[82:83], s[82:83], s[52:53]
    v_cndmask_b32_dpp v7, v7, v7, vcc wave_shr:1 row_mask:0xf bank_mask:0xf
    s_mov_b64 vcc, s[50:51]
    s_mov_b64 exec, s[50:51]
    s_cbranch_scc0 L2_d98
    s_mov_b64 exec, s[82:83]
    s_nop 1
    v_mfma_f32_4x4x4_16b_bf16 v[88:91], v[12:13], v[84:85], 0
    s_nop 1
    v_mfma_f32_4x4x4_16b_bf16 v[88:91], v[10:11], v[86:87], v[88:91]
    s_nop 4
    v_cvt_pk_bf16_f32 v88, v88, v89
    v_cvt_pk_bf16_f32 v89, v90, v91
    ds_pk_add_bf16 v7, v88 offset:65408
    ds_pk_add_bf16 v7, v89 offset:65412
    s_mov_b64 exec, vcc
    s_branch L2_d98
L2_c99:
    s_mov_b64 s[50:51], vcc
    s_lshl_b64 s[52:53], s[82:83], 1
    s_andn2_b64 s[52:53], s[52:53], s[80:81]
    s_andn2_b64 s[52:53], s[52:53], s[50:51]
    s_or_b64 s[80:81], s[80:81], s[52:53]
    s_not_b64 vcc, s[52:53]
    s_mov_b64 exec, -1
    v_cndmask_b32_dpp v84, v84, v84, vcc wave_shr:1 row_mask:0xf bank_mask:0xf
    v_cndmask_b32_dpp v85, v85, v85, vcc wave_shr:1 row_mask:0xf bank_mask:0xf
    s_lshr_b64 s[52:53], s[52:53], 1
    v_cndmask_b32_dpp v86, v86, v86, vcc wave_shr:1 row_mask:0xf bank_mask:0xf
    v_cndmask_b32_dpp v87, v87, v87, vcc wave_shr:1 row_mask:0xf bank_mask:0xf
    s_andn2_b64 s[82:83], s[82:83], s[52:53]
    v_cndmask_b32_dpp v7, v7, v7, vcc wave_shr:1 row_mask:0xf bank_mask:0xf
    s_mov_b64 vcc, s[50:51]
    s_mov_b64 exec, s[50:51]
    s_cbranch_scc0 L2_d99
    s_mov_b64 exec, s[82:83]
    s_nop 1
    v_mfma_f32_4x4x4_16b_bf16 v[88:91], v[12:13], v[84:85], 0
    s_nop 1
    v_mfma_f32_4x4x4_16b_bf16 v[88:91], v[10:11], v[86:87], v[88:91]
    s_nop 4
    v_cvt_pk_bf16_f32 v88, v88, v89
    v_cvt_pk_bf16_f32 v89, v90, v91
    ds_pk_add_bf16 v7, v88 offset:65408
    ds_pk_add_bf16 v7, v89 offset:65412
    s_mov_b64 exec, vcc
    s_branch L2_d99
L2_c100:
    s_mov_b64 s[50:51], vcc
    s_lshl_b64 s[52:53], s[82:83], 1
    s_andn2_b64 s[52:53], s[52:53], s[80:81]
    s_andn2_b64 s[52:53], s[52:53], s[50:51]
    s_or_b64 s[80:81], s[80:81], s[52:53]
    s_not_b64 vcc, s[52:53]
    s_mov_b64 exec, -1
    v_cndmask_b32_dpp v84, v84, v84, vcc wave_shr:1 row_mask:0xf bank_mask:0xf
    v_cndmask_b32_dpp v85, v85, v85, vcc wave_shr:1 row_mask:0xf bank_mask:0xf
    s_lshr_b64 s[52:53], s[52:53], 1
    v_cndmask_b32_dpp v86, v86, v86, vcc wave_shr:1 row_mask:0xf bank_mask:0xf
    v_cndmask_b32_dpp v87, v87, v87, vcc wave_shr:1 row_mask:0xf bank_mask:0xf
    s_andn2_b64 s[82:83], s[82:83], s[52:53]
    v_cndmask_b32_dpp v7, v7, v7, vcc wave_shr:1 row_mask:0xf bank_mask:0xf
    s_mov_b64 vcc, s[50:51]
    s_mov_b64 exec, s[50:51]
    s_cbranch_scc0 L2_d100
    s_mov_b64 exec, s[82:83]
    s_nop 1
    v_mfma_f32_4x4x4_16b_bf16 v[88:91], v[12:13], v[84:85], 0
    s_nop 1
    v_mfma_f32_4x4x4_16b_bf16 v[88:91], v[10:11], v[86:87], v[88:91]
    s_nop 4
    v_cvt_pk_bf16_f32 v88, v88, v89
    v_cvt_pk_bf16_f32 v89, v90, v91
    ds_pk_add_bf16 v7, v88 offset:65408
    ds_pk_add_bf16 v7, v89 offset:65412
    s_mov_b64 exec, vcc
    s_branch L2_d100
L2_c101:
    s_mov_b64 s[50:51], vcc
    s_lshl_b64 s[52:53], s[82:83], 1
    s_andn2_b64 s[52:53], s[52:53], s[80:81]
    s_andn2_b64 s[52:53], s[52:53], s[50:51]
    s_or_b64 s[80:81], s[80:81], s[52:53]
    s_not_b64 vcc, s[52:53]
    s_mov_b64 exec, -1
    v_cndmask_b32_dpp v84, v84, v84, vcc wave_shr:1 row_mask:0xf bank_mask:0xf
    v_cndmask_b32_dpp v85, v85, v85, vcc wave_shr:1 row_mask:0xf bank_mask:0xf
    s_lshr_b64 s[52:53], s[52:53], 1
    v_cndmask_b32_dpp v86, v86, v86, vcc wave_shr:1 row_mask:0xf bank_mask:0xf
    v_cndmask_b32_dpp v87, v87, v87, vcc wave_shr:1 row_mask:0xf bank_mask:0xf
    s_andn2_b64 s[82:83], s[82:83], s[52:53]
    v_cndmask_b32_dpp v7, v7, v7, vcc wave_shr:1 row_mask:0xf bank_mask:0xf
    s_mov_b64 vcc, s[50:51]
    s_mov_b64 exec, s[50:51]
    s_cbranch_scc0 L2_d101
    s_mov_b64 exec, s[82:83]
    s_nop 1
    v_mfma_f32_4x4x4_16b_bf16 v[88:91], v[12:13], v[84:85], 0
    s_nop 1
    v_mfma_f32_4x4x4_16b_bf16 v[88:91], v[10:11], v[86:87], v[88:91]
    s_nop 4
    v_cvt_pk_bf16_f32 v88, v88, v89
    v_cvt_pk_bf16_f32 v89, v90, v91
    ds_pk_add_bf16 v7, v88 offset:65408
    ds_pk_add_bf16 v7, v89 offset:65412
    s_mov_b64 exec, vcc
    s_branch L2_d101
L2_c102:
    s_mov_b64 s[50:51], vcc
    s_lshl_b64 s[52:53], s[82:83], 1
    s_andn2_b64 s[52:53], s[52:53], s[80:81]
    s_andn2_b64 s[52:53], s[52:53], s[50:51]
    s_or_b64 s[80:81], s[80:81], s[52:53]
    s_not_b64 vcc, s[52:53]
    s_mov_b64 exec, -1
    v_cndmask_b32_dpp v84, v84, v84, vcc wave_shr:1 row_mask:0xf bank_mask:0xf
    v_cndmask_b32_dpp v85, v85, v85, vcc wave_shr:1 row_mask:0xf bank_mask:0xf
    s_lshr_b64 s[52:53], s[52:53], 1
    v_cndmask_b32_dpp v86, v86, v86, vcc wave_shr:1 row_mask:0xf bank_mask:0xf
    v_cndmask_b32_dpp v87, v87, v87, vcc wave_shr:1 row_mask:0xf bank_mask:0xf
    s_andn2_b64 s[82:83], s[82:83], s[52:53]
    v_cndmask_b32_dpp v7, v7, v7, vcc wave_shr:1 row_mask:0xf bank_mask:0xf
    s_mov_b64 vcc, s[50:51]
    s_mov_b64 exec, s[50:51]
    s_cbranch_scc0 L2_d102
    s_mov_b64 exec, s[82:83]
    s_nop 1
    v_mfma_f32_4x4x4_16b_bf16 v[88:91], v[12:13], v[84:85], 0
    s_nop 1
    v_mfma_f32_4x4x4_16b_bf16 v[88:91], v[10:11], v[86:87], v[88:91]
    s_nop 4
    v_cvt_pk_bf16_f32 v88, v88, v89
    v_cvt_pk_bf16_f32 v89, v90, v91
    ds_pk_add_bf16 v7, v88 offset:65408
    ds_pk_add_bf16 v7, v89 offset:65412
    s_mov_b64 exec, vcc
    s_branch L2_d102
L2_c103:
    s_mov_b64 s[50:51], vcc
    s_lshl_b64 s[52:53], s[82:83], 1
    s_andn2_b64 s[52:53], s[52:53], s[80:81]
    s_andn2_b64 s[52:53], s[52:53], s[50:51]
    s_or_b64 s[80:81], s[80:81], s[52:53]
    s_not_b64 vcc, s[52:53]
    s_mov_b64 exec, -1
    v_cndmask_b32_dpp v84, v84, v84, vcc wave_shr:1 row_mask:0xf bank_mask:0xf
    v_cndmask_b32_dpp v85, v85, v85, vcc wave_shr:1 row_mask:0xf bank_mask:0xf
    s_lshr_b64 s[52:53], s[52:53], 1
    v_cndmask_b32_dpp v86, v86, v86, vcc wave_shr:1 row_mask:0xf bank_mask:0xf
    v_cndmask_b32_dpp v87, v87, v87, vcc wave_shr:1 row_mask:0xf bank_mask:0xf
    s_andn2_b64 s[82:83], s[82:83], s[52:53]
    v_cndmask_b32_dpp v7, v7, v7, vcc wave_shr:1 row_mask:0xf bank_mask:0xf
    s_mov_b64 vcc, s[50:51]
    s_mov_b64 exec, s[50:51]
    s_cbranch_scc0 L2_d103
    s_mov_b64 exec, s[82:83]
    s_nop 1
    v_mfma_f32_4x4x4_16b_bf16 v[88:91], v[12:13], v[84:85], 0
    s_nop 1
    v_mfma_f32_4x4x4_16b_bf16 v[88:91], v[10:11], v[86:87], v[88:91]
    s_nop 4
    v_cvt_pk_bf16_f32 v88, v88, v89
    v_cvt_pk_bf16_f32 v89, v90, v91
    ds_pk_add_bf16 v7, v88 offset:65408
    ds_pk_add_bf16 v7, v89 offset:65412
    s_mov_b64 exec, vcc
    s_branch L2_d103
L2_c104:
    s_mov_b64 s[50:51], vcc
    s_lshl_b64 s[52:53], s[82:83], 1
    s_andn2_b64 s[52:53], s[52:53], s[80:81]
    s_andn2_b64 s[52:53], s[52:53], s[50:51]
    s_or_b64 s[80:81], s[80:81], s[52:53]
    s_not_b64 vcc, s[52:53]
    s_mov_b64 exec, -1
    v_cndmask_b32_dpp v84, v84, v84, vcc wave_shr:1 row_mask:0xf bank_mask:0xf
    v_cndmask_b32_dpp v85, v85, v85, vcc wave_shr:1 row_mask:0xf bank_mask:0xf
    s_lshr_b64 s[52:53], s[52:53], 1
    v_cndmask_b32_dpp v86, v86, v86, vcc wave_shr:1 row_mask:0xf bank_mask:0xf
    v_cndmask_b32_dpp v87, v87, v87, vcc wave_shr:1 row_mask:0xf bank_mask:0xf
    s_andn2_b64 s[82:83], s[82:83], s[52:53]
    v_cndmask_b32_dpp v7, v7, v7, vcc wave_shr:1 row_mask:0xf bank_mask:0xf
    s_mov_b64 vcc, s[50:51]
    s_mov_b64 exec, s[50:51]
    s_cbranch_scc0 L2_d104
    s_mov_b64 exec, s[82:83]
    s_nop 1
    v_mfma_f32_4x4x4_16b_bf16 v[88:91], v[12:13], v[84:85], 0
    s_nop 1
    v_mfma_f32_4x4x4_16b_bf16 v[88:91], v[10:11], v[86:87], v[88:91]
    s_nop 4
    v_cvt_pk_bf16_f32 v88, v88, v89
    v_cvt_pk_bf16_f32 v89, v90, v91
    ds_pk_add_bf16 v7, v88 offset:65408
    ds_pk_add_bf16 v7, v89 offset:65412
    s_mov_b64 exec, vcc
    s_branch L2_d104
L2_c105:
    s_mov_b64 s[50:51], vcc
    s_lshl_b64 s[52:53], s[82:83], 1
    s_andn2_b64 s[52:53], s[52:53], s[80:81]
    s_andn2_b64 s[52:53], s[52:53], s[50:51]
    s_or_b64 s[80:81], s[80:81], s[52:53]
    s_not_b64 vcc, s[52:53]
    s_mov_b64 exec, -1
    v_cndmask_b32_dpp v84, v84, v84, vcc wave_shr:1 row_mask:0xf bank_mask:0xf
    v_cndmask_b32_dpp v85, v85, v85, vcc wave_shr:1 row_mask:0xf bank_mask:0xf
    s_lshr_b64 s[52:53], s[52:53], 1
    v_cndmask_b32_dpp v86, v86, v86, vcc wave_shr:1 row_mask:0xf bank_mask:0xf
    v_cndmask_b32_dpp v87, v87, v87, vcc wave_shr:1 row_mask:0xf bank_mask:0xf
    s_andn2_b64 s[82:83], s[82:83], s[52:53]
    v_cndmask_b32_dpp v7, v7, v7, vcc wave_shr:1 row_mask:0xf bank_mask:0xf
    s_mov_b64 vcc, s[50:51]
    s_mov_b64 exec, s[50:51]
    s_cbranch_scc0 L2_d105
    s_mov_b64 exec, s[82:83]
    s_nop 1
    v_mfma_f32_4x4x4_16b_bf16 v[88:91], v[12:13], v[84:85], 0
    s_nop 1
    v_mfma_f32_4x4x4_16b_bf16 v[88:91], v[10:11], v[86:87], v[88:91]
    s_nop 4
    v_cvt_pk_bf16_f32 v88, v88, v89
    v_cvt_pk_bf16_f32 v89, v90, v91
    ds_pk_add_bf16 v7, v88 offset:65408
    ds_pk_add_bf16 v7, v89 offset:65412
    s_mov_b64 exec, vcc
    s_branch L2_d105
L2_xo106:
    v_cmp_lt_u32 vcc, 20, v99
    s_mov_b32 s101, 1
    s_cbranch_vccz L2_xp106
    v_cmp_lt_u32 vcc, 32, v99
    v_cmp_lt_u32 s[58:59], 31, v88
    s_mov_b32 s101, 2
    s_or_b64 vcc, vcc, s[58:59]
    s_cbranch_scc0 L2_xp106
    s_mov_b32 s37, 0x10000
    s_branch L2_xp106
L2_c107:
    s_mov_b64 s[50:51], vcc
    s_lshl_b64 s[52:53], s[82:83], 1
    s_andn2_b64 s[52:53], s[52:53], s[80:81]
    s_andn2_b64 s[52:53], s[52:53], s[50:51]
    s_or_b64 s[80:81], s[80:81], s[52:53]
    s_not_b64 vcc, s[52:53]
    s_mov_b64 exec, -1
    v_cndmask_b32_dpp v84, v84, v84, vcc wave_shr:1 row_mask:0xf bank_mask:0xf
    v_cndmask_b32_dpp v85, v85, v85, vcc wave_shr:1 row_mask:0xf bank_mask:0xf
    s_lshr_b64 s[52:53], s[52:53], 1
    v_cndmask_b32_dpp v86, v86, v86, vcc wave_shr:1 row_mask:0xf bank_mask:0xf
    v_cndmask_b32_dpp v87, v87, v87, vcc wave_shr:1 row_mask:0xf bank_mask:0xf
    s_andn2_b64 s[82:83], s[82:83], s[52:53]
    v_cndmask_b32_dpp v7, v7, v7, vcc wave_shr:1 row_mask:0xf bank_mask:0xf
    s_mov_b64 vcc, s[50:51]
    s_mov_b64 exec, s[50:51]
    s_cbranch_scc0 L2_d107
    s_mov_b64 exec, s[82:83]
    s_nop 1
    v_mfma_f32_4x4x4_16b_bf16 v[88:91], v[12:13], v[84:85], 0
    s_nop 1
    v_mfma_f32_4x4x4_16b_bf16 v[88:91], v[10:11], v[86:87], v[88:91]
    s_nop 4
    v_cvt_pk_bf16_f32 v88, v88, v89
    v_cvt_pk_bf16_f32 v89, v90, v91
    ds_pk_add_bf16 v7, v88 offset:65408
    ds_pk_add_bf16 v7, v89 offset:65412
    s_mov_b64 exec, vcc
    s_branch L2_d107
L2_c108:
    s_mov_b64 s[50:51], vcc
    s_lshl_b64 s[52:53], s[82:83], 1
    s_andn2_b64 s[52:53], s[52:53], s[80:81]
    s_andn2_b64 s[52:53], s[52:53], s[50:51]
    s_or_b64 s[80:81], s[80:81], s[52:53]
    s_not_b64 vcc, s[52:53]
    s_mov_b64 exec, -1
    v_cndmask_b32_dpp v84, v84, v84, vcc wave_shr:1 row_mask:0xf bank_mask:0xf
    v_cndmask_b32_dpp v85, v85, v85, vcc wave_shr:1 row_mask:0xf bank_mask:0xf
    s_lshr_b64 s[52:53], s[52:53], 1
    v_cndmask_b32_dpp v86, v86, v86, vcc wave_shr:1 row_mask:0xf bank_mask:0xf
    v_cndmask_b32_dpp v87, v87, v87, vcc wave_shr:1 row_mask:0xf bank_mask:0xf
    s_andn2_b64 s[82:83], s[82:83], s[52:53]
    v_cndmask_b32_dpp v7, v7, v7, vcc wave_shr:1 row_mask:0xf bank_mask:0xf
    s_mov_b64 vcc, s[50:51]
    s_mov_b64 exec, s[50:51]
    s_cbranch_scc0 L2_d108
    s_mov_b64 exec, s[82:83]
    s_nop 1
    v_mfma_f32_4x4x4_16b_bf16 v[88:91], v[12:13], v[84:85], 0
    s_nop 1
    v_mfma_f32_4x4x4_16b_bf16 v[88:91], v[10:11], v[86:87], v[88:91]
    s_nop 4
    v_cvt_pk_bf16_f32 v88, v88, v89
    v_cvt_pk_bf16_f32 v89, v90, v91
    ds_pk_add_bf16 v7, v88 offset:65408
    ds_pk_add_bf16 v7, v89 offset:65412
    s_mov_b64 exec, vcc
    s_branch L2_d108
L2_c109:
    s_mov_b64 s[50:51], vcc
    s_lshl_b64 s[52:53], s[82:83], 1
    s_andn2_b64 s[52:53], s[52:53], s[80:81]
    s_andn2_b64 s[52:53], s[52:53], s[50:51]
    s_or_b64 s[80:81], s[80:81], s[52:53]
    s_not_b64 vcc, s[52:53]
    s_mov_b64 exec, -1
    v_cndmask_b32_dpp v84, v84, v84, vcc wave_shr:1 row_mask:0xf bank_mask:0xf
    v_cndmask_b32_dpp v85, v85, v85, vcc wave_shr:1 row_mask:0xf bank_mask:0xf
    s_lshr_b64 s[52:53], s[52:53], 1
    v_cndmask_b32_dpp v86, v86, v86, vcc wave_shr:1 row_mask:0xf bank_mask:0xf
    v_cndmask_b32_dpp v87, v87, v87, vcc wave_shr:1 row_mask:0xf bank_mask:0xf
    s_andn2_b64 s[82:83], s[82:83], s[52:53]
    v_cndmask_b32_dpp v7, v7, v7, vcc wave_shr:1 row_mask:0xf bank_mask:0xf
    s_mov_b64 vcc, s[50:51]
    s_mov_b64 exec, s[50:51]
    s_cbranch_scc0 L2_d109
    s_mov_b64 exec, s[82:83]
    s_nop 1
    v_mfma_f32_4x4x4_16b_bf16 v[88:91], v[12:13], v[84:85], 0
    s_nop 1
    v_mfma_f32_4x4x4_16b_bf16 v[88:91], v[10:11], v[86:87], v[88:91]
    s_nop 4
    v_cvt_pk_bf16_f32 v88, v88, v89
    v_cvt_pk_bf16_f32 v89, v90, v91
    ds_pk_add_bf16 v7, v88 offset:65408
    ds_pk_add_bf16 v7, v89 offset:65412
    s_mov_b64 exec, vcc
    s_branch L2_d109
L2_c110:
    s_mov_b64 s[50:51], vcc
    s_lshl_b64 s[52:53], s[82:83], 1
    s_andn2_b64 s[52:53], s[52:53], s[80:81]
    s_andn2_b64 s[52:53], s[52:53], s[50:51]
    s_or_b64 s[80:81], s[80:81], s[52:53]
    s_not_b64 vcc, s[52:53]
    s_mov_b64 exec, -1
    v_cndmask_b32_dpp v84, v84, v84, vcc wave_shr:1 row_mask:0xf bank_mask:0xf
    v_cndmask_b32_dpp v85, v85, v85, vcc wave_shr:1 row_mask:0xf bank_mask:0xf
    s_lshr_b64 s[52:53], s[52:53], 1
    v_cndmask_b32_dpp v86, v86, v86, vcc wave_shr:1 row_mask:0xf bank_mask:0xf
    v_cndmask_b32_dpp v87, v87, v87, vcc wave_shr:1 row_mask:0xf bank_mask:0xf
    s_andn2_b64 s[82:83], s[82:83], s[52:53]
    v_cndmask_b32_dpp v7, v7, v7, vcc wave_shr:1 row_mask:0xf bank_mask:0xf
    s_mov_b64 vcc, s[50:51]
    s_mov_b64 exec, s[50:51]
    s_cbranch_scc0 L2_d110
    s_mov_b64 exec, s[82:83]
    s_nop 1
    v_mfma_f32_4x4x4_16b_bf16 v[88:91], v[12:13], v[84:85], 0
    s_nop 1
    v_mfma_f32_4x4x4_16b_bf16 v[88:91], v[10:11], v[86:87], v[88:91]
    s_nop 4
    v_cvt_pk_bf16_f32 v88, v88, v89
    v_cvt_pk_bf16_f32 v89, v90, v91
    ds_pk_add_bf16 v7, v88 offset:65408
    ds_pk_add_bf16 v7, v89 offset:65412
    s_mov_b64 exec, vcc
    s_branch L2_d110
L2_c111:
    s_mov_b64 s[50:51], vcc
    s_lshl_b64 s[52:53], s[82:83], 1
    s_andn2_b64 s[52:53], s[52:53], s[80:81]
    s_andn2_b64 s[52:53], s[52:53], s[50:51]
    s_or_b64 s[80:81], s[80:81], s[52:53]
    s_not_b64 vcc, s[52:53]
    s_mov_b64 exec, -1
    v_cndmask_b32_dpp v84, v84, v84, vcc wave_shr:1 row_mask:0xf bank_mask:0xf
    v_cndmask_b32_dpp v85, v85, v85, vcc wave_shr:1 row_mask:0xf bank_mask:0xf
    s_lshr_b64 s[52:53], s[52:53], 1
    v_cndmask_b32_dpp v86, v86, v86, vcc wave_shr:1 row_mask:0xf bank_mask:0xf
    v_cndmask_b32_dpp v87, v87, v87, vcc wave_shr:1 row_mask:0xf bank_mask:0xf
    s_andn2_b64 s[82:83], s[82:83], s[52:53]
    v_cndmask_b32_dpp v7, v7, v7, vcc wave_shr:1 row_mask:0xf bank_mask:0xf
    s_mov_b64 vcc, s[50:51]
    s_mov_b64 exec, s[50:51]
    s_cbranch_scc0 L2_d111
    s_mov_b64 exec, s[82:83]
    s_nop 1
    v_mfma_f32_4x4x4_16b_bf16 v[88:91], v[12:13], v[84:85], 0
    s_nop 1
    v_mfma_f32_4x4x4_16b_bf16 v[88:91], v[10:11], v[86:87], v[88:91]
    s_nop 4
    v_cvt_pk_bf16_f32 v88, v88, v89
    v_cvt_pk_bf16_f32 v89, v90, v91
    ds_pk_add_bf16 v7, v88 offset:65408
    ds_pk_add_bf16 v7, v89 offset:65412
    s_mov_b64 exec, vcc
    s_branch L2_d111
L2_c112:
    s_mov_b64 s[50:51], vcc
    s_lshl_b64 s[52:53], s[82:83], 1
    s_andn2_b64 s[52:53], s[52:53], s[80:81]
    s_andn2_b64 s[52:53], s[52:53], s[50:51]
    s_or_b64 s[80:81], s[80:81], s[52:53]
    s_not_b64 vcc, s[52:53]
    s_mov_b64 exec, -1
    v_cndmask_b32_dpp v84, v84, v84, vcc wave_shr:1 row_mask:0xf bank_mask:0xf
    v_cndmask_b32_dpp v85, v85, v85, vcc wave_shr:1 row_mask:0xf bank_mask:0xf
    s_lshr_b64 s[52:53], s[52:53], 1
    v_cndmask_b32_dpp v86, v86, v86, vcc wave_shr:1 row_mask:0xf bank_mask:0xf
    v_cndmask_b32_dpp v87, v87, v87, vcc wave_shr:1 row_mask:0xf bank_mask:0xf
    s_andn2_b64 s[82:83], s[82:83], s[52:53]
    v_cndmask_b32_dpp v7, v7, v7, vcc wave_shr:1 row_mask:0xf bank_mask:0xf
    s_mov_b64 vcc, s[50:51]
    s_mov_b64 exec, s[50:51]
    s_cbranch_scc0 L2_d112
    s_mov_b64 exec, s[82:83]
    s_nop 1
    v_mfma_f32_4x4x4_16b_bf16 v[88:91], v[12:13], v[84:85], 0
    s_nop 1
    v_mfma_f32_4x4x4_16b_bf16 v[88:91], v[10:11], v[86:87], v[88:91]
    s_nop 4
    v_cvt_pk_bf16_f32 v88, v88, v89
    v_cvt_pk_bf16_f32 v89, v90, v91
    ds_pk_add_bf16 v7, v88 offset:65408
    ds_pk_add_bf16 v7, v89 offset:65412
    s_mov_b64 exec, vcc
    s_branch L2_d112
L2_c113:
    s_mov_b64 s[50:51], vcc
    s_lshl_b64 s[52:53], s[82:83], 1
    s_andn2_b64 s[52:53], s[52:53], s[80:81]
    s_andn2_b64 s[52:53], s[52:53], s[50:51]
    s_or_b64 s[80:81], s[80:81], s[52:53]
    s_not_b64 vcc, s[52:53]
    s_mov_b64 exec, -1
    v_cndmask_b32_dpp v84, v84, v84, vcc wave_shr:1 row_mask:0xf bank_mask:0xf
    v_cndmask_b32_dpp v85, v85, v85, vcc wave_shr:1 row_mask:0xf bank_mask:0xf
    s_lshr_b64 s[52:53], s[52:53], 1
    v_cndmask_b32_dpp v86, v86, v86, vcc wave_shr:1 row_mask:0xf bank_mask:0xf
    v_cndmask_b32_dpp v87, v87, v87, vcc wave_shr:1 row_mask:0xf bank_mask:0xf
    s_andn2_b64 s[82:83], s[82:83], s[52:53]
    v_cndmask_b32_dpp v7, v7, v7, vcc wave_shr:1 row_mask:0xf bank_mask:0xf
    s_mov_b64 vcc, s[50:51]
    s_mov_b64 exec, s[50:51]
    s_cbranch_scc0 L2_d113
    s_mov_b64 exec, s[82:83]
    s_nop 1
    v_mfma_f32_4x4x4_16b_bf16 v[88:91], v[12:13], v[84:85], 0
    s_nop 1
    v_mfma_f32_4x4x4_16b_bf16 v[88:91], v[10:11], v[86:87], v[88:91]
    s_nop 4
    v_cvt_pk_bf16_f32 v88, v88, v89
    v_cvt_pk_bf16_f32 v89, v90, v91
    ds_pk_add_bf16 v7, v88 offset:65408
    ds_pk_add_bf16 v7, v89 offset:65412
    s_mov_b64 exec, vcc
    s_branch L2_d113
L2_c114:
    s_mov_b64 s[50:51], vcc
    s_lshl_b64 s[52:53], s[82:83], 1
    s_andn2_b64 s[52:53], s[52:53], s[80:81]
    s_andn2_b64 s[52:53], s[52:53], s[50:51]
    s_or_b64 s[80:81], s[80:81], s[52:53]
    s_not_b64 vcc, s[52:53]
    s_mov_b64 exec, -1
    v_cndmask_b32_dpp v84, v84, v84, vcc wave_shr:1 row_mask:0xf bank_mask:0xf
    v_cndmask_b32_dpp v85, v85, v85, vcc wave_shr:1 row_mask:0xf bank_mask:0xf
    s_lshr_b64 s[52:53], s[52:53], 1
    v_cndmask_b32_dpp v86, v86, v86, vcc wave_shr:1 row_mask:0xf bank_mask:0xf
    v_cndmask_b32_dpp v87, v87, v87, vcc wave_shr:1 row_mask:0xf bank_mask:0xf
    s_andn2_b64 s[82:83], s[82:83], s[52:53]
    v_cndmask_b32_dpp v7, v7, v7, vcc wave_shr:1 row_mask:0xf bank_mask:0xf
    s_mov_b64 vcc, s[50:51]
    s_mov_b64 exec, s[50:51]
    s_cbranch_scc0 L2_d114
    s_mov_b64 exec, s[82:83]
    s_nop 1
    v_mfma_f32_4x4x4_16b_bf16 v[88:91], v[12:13], v[84:85], 0
    s_nop 1
    v_mfma_f32_4x4x4_16b_bf16 v[88:91], v[10:11], v[86:87], v[88:91]
    s_nop 4
    v_cvt_pk_bf16_f32 v88, v88, v89
    v_cvt_pk_bf16_f32 v89, v90, v91
    ds_pk_add_bf16 v7, v88 offset:65408
    ds_pk_add_bf16 v7, v89 offset:65412
    s_mov_b64 exec, vcc
    s_branch L2_d114
L2_xa115:
    s_cmp_eq_u32 s101, 1
    s_cbranch_scc1 L2_xc115
    v_lshlrev_b32 v89, 0, v96
    v_add_u32 v90, 140, v97
    v_bitop3_b32 v90, v89, v45, v90 bitop3:0x6a
    ds_write_b32 v98, v90 offset:28
    v_lshlrev_b32 v89, 4, v96
    v_add_u32 v90, 120, v97
    v_bitop3_b32 v90, v89, v45, v90 bitop3:0x6a
    ds_write_b32 v98, v90 offset:24
    v_lshlrev_b32 v89, 8, v96
    v_add_u32 v90, 100, v97
    v_bitop3_b32 v90, v89, v45, v90 bitop3:0x6a
    ds_write_b32 v98, v90 offset:20
L2_xc115:
    v_lshlrev_b32 v89, 12, v96
    v_add_u32 v90, 80, v97
    v_bitop3_b32 v90, v89, v45, v90 bitop3:0x6a
    ds_write_b32 v98, v90 offset:16
    s_branch L2_xb115
L2_xe115:
    v_cmp_lt_u32 vcc, 32, v99
    v_cmp_lt_u32 s[58:59], 31, v88
    v_lshrrev_b32 v89, 16, v96
    v_add_u32 v97, 80, v97
    s_or_b64 vcc, vcc, s[58:59]
    s_cbranch_scc1 L2_xs115
    v_lshlrev_b32 v89, v1, v89
    v_and_b32 v89, v45, v89
    v_cmp_ne_u32 vcc, 0, v89
    v_xor_b32 v90, v97, v89
    s_add_u32 s3, s37, s38
    v_mbcnt_lo_u32_b32 v98, vcc_lo, 0
    v_mbcnt_hi_u32_b32 v98, vcc_hi, v98
    s_bcnt1_i32_b64 s41, vcc
    v_lshl_add_u32 v98, v98, 2, s3
    s_mov_b64 exec, vcc
    ds_write_b32 v98, v90
    s_mov_b64 exec, -1
    s_lshl2_add_u32 s37, s41, s37
    s_branch L2_xr115
L2_xf115:
    s_waitcnt lgkmcnt(0)
    s_cmp_gt_u32 s37, 1024
    s_cbranch_scc1 L2_xs115
    v_mov_b32 v43, -1
    s_cmp_ge_u32 s37, 512
    s_cbranch_scc1 L2_xg115
    v_mov_b32 v42, -1
    s_cmp_ge_u32 s37, 256
    s_cbranch_scc1 L2_xg115
    v_mov_b32 v41, -1
    s_branch L2_xg115
L2_xs115:
    s_waitcnt lgkmcnt(0)
    v_mov_b32 v40, -1
    v_mov_b32 v41, -1
    v_mov_b32 v42, -1
    v_mov_b32 v43, -1
    s_add_u32 s3, s42, 2
    s_bitset1_b32 s36, s3
    s_branch L2_xg115
L2_c116:
    s_mov_b64 s[50:51], vcc
    s_lshl_b64 s[52:53], s[82:83], 1
    s_andn2_b64 s[52:53], s[52:53], s[80:81]
    s_andn2_b64 s[52:53], s[52:53], s[50:51]
    s_or_b64 s[80:81], s[80:81], s[52:53]
    s_not_b64 vcc, s[52:53]
    s_mov_b64 exec, -1
    v_cndmask_b32_dpp v84, v84, v84, vcc wave_shr:1 row_mask:0xf bank_mask:0xf
    v_cndmask_b32_dpp v85, v85, v85, vcc wave_shr:1 row_mask:0xf bank_mask:0xf
    s_lshr_b64 s[52:53], s[52:53], 1
    v_cndmask_b32_dpp v86, v86, v86, vcc wave_shr:1 row_mask:0xf bank_mask:0xf
    v_cndmask_b32_dpp v87, v87, v87, vcc wave_shr:1 row_mask:0xf bank_mask:0xf
    s_andn2_b64 s[82:83], s[82:83], s[52:53]
    v_cndmask_b32_dpp v7, v7, v7, vcc wave_shr:1 row_mask:0xf bank_mask:0xf
    s_mov_b64 vcc, s[50:51]
    s_mov_b64 exec, s[50:51]
    s_cbranch_scc0 L2_d116
    s_mov_b64 exec, s[82:83]
    s_nop 1
    v_mfma_f32_4x4x4_16b_bf16 v[88:91], v[12:13], v[84:85], 0
    s_nop 1
    v_mfma_f32_4x4x4_16b_bf16 v[88:91], v[10:11], v[86:87], v[88:91]
    s_nop 4
    v_cvt_pk_bf16_f32 v88, v88, v89
    v_cvt_pk_bf16_f32 v89, v90, v91
    ds_pk_add_bf16 v7, v88 offset:65408
    ds_pk_add_bf16 v7, v89 offset:65412
    s_mov_b64 exec, vcc
    s_branch L2_d116
L2_c117:
    s_mov_b64 s[50:51], vcc
    s_lshl_b64 s[52:53], s[82:83], 1
    s_andn2_b64 s[52:53], s[52:53], s[80:81]
    s_andn2_b64 s[52:53], s[52:53], s[50:51]
    s_or_b64 s[80:81], s[80:81], s[52:53]
    s_not_b64 vcc, s[52:53]
    s_mov_b64 exec, -1
    v_cndmask_b32_dpp v84, v84, v84, vcc wave_shr:1 row_mask:0xf bank_mask:0xf
    v_cndmask_b32_dpp v85, v85, v85, vcc wave_shr:1 row_mask:0xf bank_mask:0xf
    s_lshr_b64 s[52:53], s[52:53], 1
    v_cndmask_b32_dpp v86, v86, v86, vcc wave_shr:1 row_mask:0xf bank_mask:0xf
    v_cndmask_b32_dpp v87, v87, v87, vcc wave_shr:1 row_mask:0xf bank_mask:0xf
    s_andn2_b64 s[82:83], s[82:83], s[52:53]
    v_cndmask_b32_dpp v7, v7, v7, vcc wave_shr:1 row_mask:0xf bank_mask:0xf
    s_mov_b64 vcc, s[50:51]
    s_mov_b64 exec, s[50:51]
    s_cbranch_scc0 L2_d117
    s_mov_b64 exec, s[82:83]
    s_nop 1
    v_mfma_f32_4x4x4_16b_bf16 v[88:91], v[12:13], v[84:85], 0
    s_nop 1
    v_mfma_f32_4x4x4_16b_bf16 v[88:91], v[10:11], v[86:87], v[88:91]
    s_nop 4
    v_cvt_pk_bf16_f32 v88, v88, v89
    v_cvt_pk_bf16_f32 v89, v90, v91
    ds_pk_add_bf16 v7, v88 offset:65408
    ds_pk_add_bf16 v7, v89 offset:65412
    s_mov_b64 exec, vcc
    s_branch L2_d117
L2_c118:
    s_mov_b64 s[50:51], vcc
    s_lshl_b64 s[52:53], s[82:83], 1
    s_andn2_b64 s[52:53], s[52:53], s[80:81]
    s_andn2_b64 s[52:53], s[52:53], s[50:51]
    s_or_b64 s[80:81], s[80:81], s[52:53]
    s_not_b64 vcc, s[52:53]
    s_mov_b64 exec, -1
    v_cndmask_b32_dpp v84, v84, v84, vcc wave_shr:1 row_mask:0xf bank_mask:0xf
    v_cndmask_b32_dpp v85, v85, v85, vcc wave_shr:1 row_mask:0xf bank_mask:0xf
    s_lshr_b64 s[52:53], s[52:53], 1
    v_cndmask_b32_dpp v86, v86, v86, vcc wave_shr:1 row_mask:0xf bank_mask:0xf
    v_cndmask_b32_dpp v87, v87, v87, vcc wave_shr:1 row_mask:0xf bank_mask:0xf
    s_andn2_b64 s[82:83], s[82:83], s[52:53]
    v_cndmask_b32_dpp v7, v7, v7, vcc wave_shr:1 row_mask:0xf bank_mask:0xf
    s_mov_b64 vcc, s[50:51]
    s_mov_b64 exec, s[50:51]
    s_cbranch_scc0 L2_d118
    s_mov_b64 exec, s[82:83]
    s_nop 1
    v_mfma_f32_4x4x4_16b_bf16 v[88:91], v[12:13], v[84:85], 0
    s_nop 1
    v_mfma_f32_4x4x4_16b_bf16 v[88:91], v[10:11], v[86:87], v[88:91]
    s_nop 4
    v_cvt_pk_bf16_f32 v88, v88, v89
    v_cvt_pk_bf16_f32 v89, v90, v91
    ds_pk_add_bf16 v7, v88 offset:65408
    ds_pk_add_bf16 v7, v89 offset:65412
    s_mov_b64 exec, vcc
    s_branch L2_d118
L2_c119:
    s_mov_b64 s[50:51], vcc
    s_lshl_b64 s[52:53], s[82:83], 1
    s_andn2_b64 s[52:53], s[52:53], s[80:81]
    s_andn2_b64 s[52:53], s[52:53], s[50:51]
    s_or_b64 s[80:81], s[80:81], s[52:53]
    s_not_b64 vcc, s[52:53]
    s_mov_b64 exec, -1
    v_cndmask_b32_dpp v84, v84, v84, vcc wave_shr:1 row_mask:0xf bank_mask:0xf
    v_cndmask_b32_dpp v85, v85, v85, vcc wave_shr:1 row_mask:0xf bank_mask:0xf
    s_lshr_b64 s[52:53], s[52:53], 1
    v_cndmask_b32_dpp v86, v86, v86, vcc wave_shr:1 row_mask:0xf bank_mask:0xf
    v_cndmask_b32_dpp v87, v87, v87, vcc wave_shr:1 row_mask:0xf bank_mask:0xf
    s_andn2_b64 s[82:83], s[82:83], s[52:53]
    v_cndmask_b32_dpp v7, v7, v7, vcc wave_shr:1 row_mask:0xf bank_mask:0xf
    s_mov_b64 vcc, s[50:51]
    s_mov_b64 exec, s[50:51]
    s_cbranch_scc0 L2_d119
    s_mov_b64 exec, s[82:83]
    s_nop 1
    v_mfma_f32_4x4x4_16b_bf16 v[88:91], v[12:13], v[84:85], 0
    s_nop 1
    v_mfma_f32_4x4x4_16b_bf16 v[88:91], v[10:11], v[86:87], v[88:91]
    s_nop 4
    v_cvt_pk_bf16_f32 v88, v88, v89
    v_cvt_pk_bf16_f32 v89, v90, v91
    ds_pk_add_bf16 v7, v88 offset:65408
    ds_pk_add_bf16 v7, v89 offset:65412
    s_mov_b64 exec, vcc
    s_branch L2_d119
L2_c120:
    s_mov_b64 s[50:51], vcc
    s_lshl_b64 s[52:53], s[82:83], 1
    s_andn2_b64 s[52:53], s[52:53], s[80:81]
    s_andn2_b64 s[52:53], s[52:53], s[50:51]
    s_or_b64 s[80:81], s[80:81], s[52:53]
    s_not_b64 vcc, s[52:53]
    s_mov_b64 exec, -1
    v_cndmask_b32_dpp v84, v84, v84, vcc wave_shr:1 row_mask:0xf bank_mask:0xf
    v_cndmask_b32_dpp v85, v85, v85, vcc wave_shr:1 row_mask:0xf bank_mask:0xf
    s_lshr_b64 s[52:53], s[52:53], 1
    v_cndmask_b32_dpp v86, v86, v86, vcc wave_shr:1 row_mask:0xf bank_mask:0xf
    v_cndmask_b32_dpp v87, v87, v87, vcc wave_shr:1 row_mask:0xf bank_mask:0xf
    s_andn2_b64 s[82:83], s[82:83], s[52:53]
    v_cndmask_b32_dpp v7, v7, v7, vcc wave_shr:1 row_mask:0xf bank_mask:0xf
    s_mov_b64 vcc, s[50:51]
    s_mov_b64 exec, s[50:51]
    s_cbranch_scc0 L2_d120
    s_mov_b64 exec, s[82:83]
    s_nop 1
    v_mfma_f32_4x4x4_16b_bf16 v[88:91], v[12:13], v[84:85], 0
    s_nop 1
    v_mfma_f32_4x4x4_16b_bf16 v[88:91], v[10:11], v[86:87], v[88:91]
    s_nop 4
    v_cvt_pk_bf16_f32 v88, v88, v89
    v_cvt_pk_bf16_f32 v89, v90, v91
    ds_pk_add_bf16 v7, v88 offset:65408
    ds_pk_add_bf16 v7, v89 offset:65412
    s_mov_b64 exec, vcc
    s_branch L2_d120
L2_c121:
    s_mov_b64 s[50:51], vcc
    s_lshl_b64 s[52:53], s[82:83], 1
    s_andn2_b64 s[52:53], s[52:53], s[80:81]
    s_andn2_b64 s[52:53], s[52:53], s[50:51]
    s_or_b64 s[80:81], s[80:81], s[52:53]
    s_not_b64 vcc, s[52:53]
    s_mov_b64 exec, -1
    v_cndmask_b32_dpp v84, v84, v84, vcc wave_shr:1 row_mask:0xf bank_mask:0xf
    v_cndmask_b32_dpp v85, v85, v85, vcc wave_shr:1 row_mask:0xf bank_mask:0xf
    s_lshr_b64 s[52:53], s[52:53], 1
    v_cndmask_b32_dpp v86, v86, v86, vcc wave_shr:1 row_mask:0xf bank_mask:0xf
    v_cndmask_b32_dpp v87, v87, v87, vcc wave_shr:1 row_mask:0xf bank_mask:0xf
    s_andn2_b64 s[82:83], s[82:83], s[52:53]
    v_cndmask_b32_dpp v7, v7, v7, vcc wave_shr:1 row_mask:0xf bank_mask:0xf
    s_mov_b64 vcc, s[50:51]
    s_mov_b64 exec, s[50:51]
    s_cbranch_scc0 L2_d121
    s_mov_b64 exec, s[82:83]
    s_nop 1
    v_mfma_f32_4x4x4_16b_bf16 v[88:91], v[12:13], v[84:85], 0
    s_nop 1
    v_mfma_f32_4x4x4_16b_bf16 v[88:91], v[10:11], v[86:87], v[88:91]
    s_nop 4
    v_cvt_pk_bf16_f32 v88, v88, v89
    v_cvt_pk_bf16_f32 v89, v90, v91
    ds_pk_add_bf16 v7, v88 offset:65408
    ds_pk_add_bf16 v7, v89 offset:65412
    s_mov_b64 exec, vcc
    s_branch L2_d121
L2_c122:
    s_mov_b64 s[50:51], vcc
    s_lshl_b64 s[52:53], s[82:83], 1
    s_andn2_b64 s[52:53], s[52:53], s[80:81]
    s_andn2_b64 s[52:53], s[52:53], s[50:51]
    s_or_b64 s[80:81], s[80:81], s[52:53]
    s_not_b64 vcc, s[52:53]
    s_mov_b64 exec, -1
    v_cndmask_b32_dpp v84, v84, v84, vcc wave_shr:1 row_mask:0xf bank_mask:0xf
    v_cndmask_b32_dpp v85, v85, v85, vcc wave_shr:1 row_mask:0xf bank_mask:0xf
    s_lshr_b64 s[52:53], s[52:53], 1
    v_cndmask_b32_dpp v86, v86, v86, vcc wave_shr:1 row_mask:0xf bank_mask:0xf
    v_cndmask_b32_dpp v87, v87, v87, vcc wave_shr:1 row_mask:0xf bank_mask:0xf
    s_andn2_b64 s[82:83], s[82:83], s[52:53]
    v_cndmask_b32_dpp v7, v7, v7, vcc wave_shr:1 row_mask:0xf bank_mask:0xf
    s_mov_b64 vcc, s[50:51]
    s_mov_b64 exec, s[50:51]
    s_cbranch_scc0 L2_d122
    s_mov_b64 exec, s[82:83]
    s_nop 1
    v_mfma_f32_4x4x4_16b_bf16 v[88:91], v[12:13], v[84:85], 0
    s_nop 1
    v_mfma_f32_4x4x4_16b_bf16 v[88:91], v[10:11], v[86:87], v[88:91]
    s_nop 4
    v_cvt_pk_bf16_f32 v88, v88, v89
    v_cvt_pk_bf16_f32 v89, v90, v91
    ds_pk_add_bf16 v7, v88 offset:65408
    ds_pk_add_bf16 v7, v89 offset:65412
    s_mov_b64 exec, vcc
    s_branch L2_d122
L2_c123:
    s_mov_b64 s[50:51], vcc
    s_lshl_b64 s[52:53], s[82:83], 1
    s_andn2_b64 s[52:53], s[52:53], s[80:81]
    s_andn2_b64 s[52:53], s[52:53], s[50:51]
    s_or_b64 s[80:81], s[80:81], s[52:53]
    s_not_b64 vcc, s[52:53]
    s_mov_b64 exec, -1
    v_cndmask_b32_dpp v84, v84, v84, vcc wave_shr:1 row_mask:0xf bank_mask:0xf
    v_cndmask_b32_dpp v85, v85, v85, vcc wave_shr:1 row_mask:0xf bank_mask:0xf
    s_lshr_b64 s[52:53], s[52:53], 1
    v_cndmask_b32_dpp v86, v86, v86, vcc wave_shr:1 row_mask:0xf bank_mask:0xf
    v_cndmask_b32_dpp v87, v87, v87, vcc wave_shr:1 row_mask:0xf bank_mask:0xf
    s_andn2_b64 s[82:83], s[82:83], s[52:53]
    v_cndmask_b32_dpp v7, v7, v7, vcc wave_shr:1 row_mask:0xf bank_mask:0xf
    s_mov_b64 vcc, s[50:51]
    s_mov_b64 exec, s[50:51]
    s_cbranch_scc0 L2_d123
    s_mov_b64 exec, s[82:83]
    s_nop 1
    v_mfma_f32_4x4x4_16b_bf16 v[88:91], v[12:13], v[84:85], 0
    s_nop 1
    v_mfma_f32_4x4x4_16b_bf16 v[88:91], v[10:11], v[86:87], v[88:91]
    s_nop 4
    v_cvt_pk_bf16_f32 v88, v88, v89
    v_cvt_pk_bf16_f32 v89, v90, v91
    ds_pk_add_bf16 v7, v88 offset:65408
    ds_pk_add_bf16 v7, v89 offset:65412
    s_mov_b64 exec, vcc
    s_branch L2_d123
L2_c124:
    s_mov_b64 s[50:51], vcc
    s_lshl_b64 s[52:53], s[82:83], 1
    s_andn2_b64 s[52:53], s[52:53], s[80:81]
    s_andn2_b64 s[52:53], s[52:53], s[50:51]
    s_or_b64 s[80:81], s[80:81], s[52:53]
    s_not_b64 vcc, s[52:53]
    s_mov_b64 exec, -1
    v_cndmask_b32_dpp v84, v84, v84, vcc wave_shr:1 row_mask:0xf bank_mask:0xf
    v_cndmask_b32_dpp v85, v85, v85, vcc wave_shr:1 row_mask:0xf bank_mask:0xf
    s_lshr_b64 s[52:53], s[52:53], 1
    v_cndmask_b32_dpp v86, v86, v86, vcc wave_shr:1 row_mask:0xf bank_mask:0xf
    v_cndmask_b32_dpp v87, v87, v87, vcc wave_shr:1 row_mask:0xf bank_mask:0xf
    s_andn2_b64 s[82:83], s[82:83], s[52:53]
    v_cndmask_b32_dpp v7, v7, v7, vcc wave_shr:1 row_mask:0xf bank_mask:0xf
    s_mov_b64 vcc, s[50:51]
    s_mov_b64 exec, s[50:51]
    s_cbranch_scc0 L2_d124
    s_mov_b64 exec, s[82:83]
    s_nop 1
    v_mfma_f32_4x4x4_16b_bf16 v[88:91], v[12:13], v[84:85], 0
    s_nop 1
    v_mfma_f32_4x4x4_16b_bf16 v[88:91], v[10:11], v[86:87], v[88:91]
    s_nop 4
    v_cvt_pk_bf16_f32 v88, v88, v89
    v_cvt_pk_bf16_f32 v89, v90, v91
    ds_pk_add_bf16 v7, v88 offset:65408
    ds_pk_add_bf16 v7, v89 offset:65412
    s_mov_b64 exec, vcc
    s_branch L2_d124
L2_c125:
    s_mov_b64 s[50:51], vcc
    s_lshl_b64 s[52:53], s[82:83], 1
    s_andn2_b64 s[52:53], s[52:53], s[80:81]
    s_andn2_b64 s[52:53], s[52:53], s[50:51]
    s_or_b64 s[80:81], s[80:81], s[52:53]
    s_not_b64 vcc, s[52:53]
    s_mov_b64 exec, -1
    v_cndmask_b32_dpp v84, v84, v84, vcc wave_shr:1 row_mask:0xf bank_mask:0xf
    v_cndmask_b32_dpp v85, v85, v85, vcc wave_shr:1 row_mask:0xf bank_mask:0xf
    s_lshr_b64 s[52:53], s[52:53], 1
    v_cndmask_b32_dpp v86, v86, v86, vcc wave_shr:1 row_mask:0xf bank_mask:0xf
    v_cndmask_b32_dpp v87, v87, v87, vcc wave_shr:1 row_mask:0xf bank_mask:0xf
    s_andn2_b64 s[82:83], s[82:83], s[52:53]
    v_cndmask_b32_dpp v7, v7, v7, vcc wave_shr:1 row_mask:0xf bank_mask:0xf
    s_mov_b64 vcc, s[50:51]
    s_mov_b64 exec, s[50:51]
    s_cbranch_scc0 L2_d125
    s_mov_b64 exec, s[82:83]
    s_nop 1
    v_mfma_f32_4x4x4_16b_bf16 v[88:91], v[12:13], v[84:85], 0
    s_nop 1
    v_mfma_f32_4x4x4_16b_bf16 v[88:91], v[10:11], v[86:87], v[88:91]
    s_nop 4
    v_cvt_pk_bf16_f32 v88, v88, v89
    v_cvt_pk_bf16_f32 v89, v90, v91
    ds_pk_add_bf16 v7, v88 offset:65408
    ds_pk_add_bf16 v7, v89 offset:65412
    s_mov_b64 exec, vcc
    s_branch L2_d125
L2_c126:
    s_mov_b64 s[50:51], vcc
    s_lshl_b64 s[52:53], s[82:83], 1
    s_andn2_b64 s[52:53], s[52:53], s[80:81]
    s_andn2_b64 s[52:53], s[52:53], s[50:51]
    s_or_b64 s[80:81], s[80:81], s[52:53]
    s_not_b64 vcc, s[52:53]
    s_mov_b64 exec, -1
    v_cndmask_b32_dpp v84, v84, v84, vcc wave_shr:1 row_mask:0xf bank_mask:0xf
    v_cndmask_b32_dpp v85, v85, v85, vcc wave_shr:1 row_mask:0xf bank_mask:0xf
    s_lshr_b64 s[52:53], s[52:53], 1
    v_cndmask_b32_dpp v86, v86, v86, vcc wave_shr:1 row_mask:0xf bank_mask:0xf
    v_cndmask_b32_dpp v87, v87, v87, vcc wave_shr:1 row_mask:0xf bank_mask:0xf
    s_andn2_b64 s[82:83], s[82:83], s[52:53]
    v_cndmask_b32_dpp v7, v7, v7, vcc wave_shr:1 row_mask:0xf bank_mask:0xf
    s_mov_b64 vcc, s[50:51]
    s_mov_b64 exec, s[50:51]
    s_cbranch_scc0 L2_d126
    s_mov_b64 exec, s[82:83]
    s_nop 1
    v_mfma_f32_4x4x4_16b_bf16 v[88:91], v[12:13], v[84:85], 0
    s_nop 1
    v_mfma_f32_4x4x4_16b_bf16 v[88:91], v[10:11], v[86:87], v[88:91]
    s_nop 4
    v_cvt_pk_bf16_f32 v88, v88, v89
    v_cvt_pk_bf16_f32 v89, v90, v91
    ds_pk_add_bf16 v7, v88 offset:65408
    ds_pk_add_bf16 v7, v89 offset:65412
    s_mov_b64 exec, vcc
    s_branch L2_d126
L2_c127:
    s_mov_b64 s[50:51], vcc
    s_lshl_b64 s[52:53], s[82:83], 1
    s_andn2_b64 s[52:53], s[52:53], s[80:81]
    s_andn2_b64 s[52:53], s[52:53], s[50:51]
    s_or_b64 s[80:81], s[80:81], s[52:53]
    s_not_b64 vcc, s[52:53]
    s_mov_b64 exec, -1
    v_cndmask_b32_dpp v84, v84, v84, vcc wave_shr:1 row_mask:0xf bank_mask:0xf
    v_cndmask_b32_dpp v85, v85, v85, vcc wave_shr:1 row_mask:0xf bank_mask:0xf
    s_lshr_b64 s[52:53], s[52:53], 1
    v_cndmask_b32_dpp v86, v86, v86, vcc wave_shr:1 row_mask:0xf bank_mask:0xf
    v_cndmask_b32_dpp v87, v87, v87, vcc wave_shr:1 row_mask:0xf bank_mask:0xf
    s_andn2_b64 s[82:83], s[82:83], s[52:53]
    v_cndmask_b32_dpp v7, v7, v7, vcc wave_shr:1 row_mask:0xf bank_mask:0xf
    s_mov_b64 vcc, s[50:51]
    s_mov_b64 exec, s[50:51]
    s_cbranch_scc0 L2_d127
    s_mov_b64 exec, s[82:83]
    s_nop 1
    v_mfma_f32_4x4x4_16b_bf16 v[88:91], v[12:13], v[84:85], 0
    s_nop 1
    v_mfma_f32_4x4x4_16b_bf16 v[88:91], v[10:11], v[86:87], v[88:91]
    s_nop 4
    v_cvt_pk_bf16_f32 v88, v88, v89
    v_cvt_pk_bf16_f32 v89, v90, v91
    ds_pk_add_bf16 v7, v88 offset:65408
    ds_pk_add_bf16 v7, v89 offset:65412
    s_mov_b64 exec, vcc
    s_branch L2_d127
L2_c128:
    s_mov_b64 s[50:51], vcc
    s_lshl_b64 s[52:53], s[82:83], 1
    s_andn2_b64 s[52:53], s[52:53], s[80:81]
    s_andn2_b64 s[52:53], s[52:53], s[50:51]
    s_or_b64 s[80:81], s[80:81], s[52:53]
    s_not_b64 vcc, s[52:53]
    s_mov_b64 exec, -1
    v_cndmask_b32_dpp v84, v84, v84, vcc wave_shr:1 row_mask:0xf bank_mask:0xf
    v_cndmask_b32_dpp v85, v85, v85, vcc wave_shr:1 row_mask:0xf bank_mask:0xf
    s_lshr_b64 s[52:53], s[52:53], 1
    v_cndmask_b32_dpp v86, v86, v86, vcc wave_shr:1 row_mask:0xf bank_mask:0xf
    v_cndmask_b32_dpp v87, v87, v87, vcc wave_shr:1 row_mask:0xf bank_mask:0xf
    s_andn2_b64 s[82:83], s[82:83], s[52:53]
    v_cndmask_b32_dpp v7, v7, v7, vcc wave_shr:1 row_mask:0xf bank_mask:0xf
    s_mov_b64 vcc, s[50:51]
    s_mov_b64 exec, s[50:51]
    s_cbranch_scc0 L2_d128
    s_mov_b64 exec, s[82:83]
    s_nop 1
    v_mfma_f32_4x4x4_16b_bf16 v[88:91], v[12:13], v[84:85], 0
    s_nop 1
    v_mfma_f32_4x4x4_16b_bf16 v[88:91], v[10:11], v[86:87], v[88:91]
    s_nop 4
    v_cvt_pk_bf16_f32 v88, v88, v89
    v_cvt_pk_bf16_f32 v89, v90, v91
    ds_pk_add_bf16 v7, v88 offset:65408
    ds_pk_add_bf16 v7, v89 offset:65412
    s_mov_b64 exec, vcc
    s_branch L2_d128
L2_c129:
    s_mov_b64 s[50:51], vcc
    s_lshl_b64 s[52:53], s[82:83], 1
    s_andn2_b64 s[52:53], s[52:53], s[80:81]
    s_andn2_b64 s[52:53], s[52:53], s[50:51]
    s_or_b64 s[80:81], s[80:81], s[52:53]
    s_not_b64 vcc, s[52:53]
    s_mov_b64 exec, -1
    v_cndmask_b32_dpp v84, v84, v84, vcc wave_shr:1 row_mask:0xf bank_mask:0xf
    v_cndmask_b32_dpp v85, v85, v85, vcc wave_shr:1 row_mask:0xf bank_mask:0xf
    s_lshr_b64 s[52:53], s[52:53], 1
    v_cndmask_b32_dpp v86, v86, v86, vcc wave_shr:1 row_mask:0xf bank_mask:0xf
    v_cndmask_b32_dpp v87, v87, v87, vcc wave_shr:1 row_mask:0xf bank_mask:0xf
    s_andn2_b64 s[82:83], s[82:83], s[52:53]
    v_cndmask_b32_dpp v7, v7, v7, vcc wave_shr:1 row_mask:0xf bank_mask:0xf
    s_mov_b64 vcc, s[50:51]
    s_mov_b64 exec, s[50:51]
    s_cbranch_scc0 L2_d129
    s_mov_b64 exec, s[82:83]
    s_nop 1
    v_mfma_f32_4x4x4_16b_bf16 v[88:91], v[12:13], v[84:85], 0
    s_nop 1
    v_mfma_f32_4x4x4_16b_bf16 v[88:91], v[10:11], v[86:87], v[88:91]
    s_nop 4
    v_cvt_pk_bf16_f32 v88, v88, v89
    v_cvt_pk_bf16_f32 v89, v90, v91
    ds_pk_add_bf16 v7, v88 offset:65408
    ds_pk_add_bf16 v7, v89 offset:65412
    s_mov_b64 exec, vcc
    s_branch L2_d129
L2_c130:
    s_mov_b64 s[50:51], vcc
    s_lshl_b64 s[52:53], s[82:83], 1
    s_andn2_b64 s[52:53], s[52:53], s[80:81]
    s_andn2_b64 s[52:53], s[52:53], s[50:51]
    s_or_b64 s[80:81], s[80:81], s[52:53]
    s_not_b64 vcc, s[52:53]
    s_mov_b64 exec, -1
    v_cndmask_b32_dpp v84, v84, v84, vcc wave_shr:1 row_mask:0xf bank_mask:0xf
    v_cndmask_b32_dpp v85, v85, v85, vcc wave_shr:1 row_mask:0xf bank_mask:0xf
    s_lshr_b64 s[52:53], s[52:53], 1
    v_cndmask_b32_dpp v86, v86, v86, vcc wave_shr:1 row_mask:0xf bank_mask:0xf
    v_cndmask_b32_dpp v87, v87, v87, vcc wave_shr:1 row_mask:0xf bank_mask:0xf
    s_andn2_b64 s[82:83], s[82:83], s[52:53]
    v_cndmask_b32_dpp v7, v7, v7, vcc wave_shr:1 row_mask:0xf bank_mask:0xf
    s_mov_b64 vcc, s[50:51]
    s_mov_b64 exec, s[50:51]
    s_cbranch_scc0 L2_d130
    s_mov_b64 exec, s[82:83]
    s_nop 1
    v_mfma_f32_4x4x4_16b_bf16 v[88:91], v[12:13], v[84:85], 0
    s_nop 1
    v_mfma_f32_4x4x4_16b_bf16 v[88:91], v[10:11], v[86:87], v[88:91]
    s_nop 4
    v_cvt_pk_bf16_f32 v88, v88, v89
    v_cvt_pk_bf16_f32 v89, v90, v91
    ds_pk_add_bf16 v7, v88 offset:65408
    ds_pk_add_bf16 v7, v89 offset:65412
    s_mov_b64 exec, vcc
    s_branch L2_d130
L2_c131:
    s_mov_b64 s[50:51], vcc
    s_lshl_b64 s[52:53], s[82:83], 1
    s_andn2_b64 s[52:53], s[52:53], s[80:81]
    s_andn2_b64 s[52:53], s[52:53], s[50:51]
    s_or_b64 s[80:81], s[80:81], s[52:53]
    s_not_b64 vcc, s[52:53]
    s_mov_b64 exec, -1
    v_cndmask_b32_dpp v84, v84, v84, vcc wave_shr:1 row_mask:0xf bank_mask:0xf
    v_cndmask_b32_dpp v85, v85, v85, vcc wave_shr:1 row_mask:0xf bank_mask:0xf
    s_lshr_b64 s[52:53], s[52:53], 1
    v_cndmask_b32_dpp v86, v86, v86, vcc wave_shr:1 row_mask:0xf bank_mask:0xf
    v_cndmask_b32_dpp v87, v87, v87, vcc wave_shr:1 row_mask:0xf bank_mask:0xf
    s_andn2_b64 s[82:83], s[82:83], s[52:53]
    v_cndmask_b32_dpp v7, v7, v7, vcc wave_shr:1 row_mask:0xf bank_mask:0xf
    s_mov_b64 vcc, s[50:51]
    s_mov_b64 exec, s[50:51]
    s_cbranch_scc0 L2_d131
    s_mov_b64 exec, s[82:83]
    s_nop 1
    v_mfma_f32_4x4x4_16b_bf16 v[88:91], v[12:13], v[84:85], 0
    s_nop 1
    v_mfma_f32_4x4x4_16b_bf16 v[88:91], v[10:11], v[86:87], v[88:91]
    s_nop 4
    v_cvt_pk_bf16_f32 v88, v88, v89
    v_cvt_pk_bf16_f32 v89, v90, v91
    ds_pk_add_bf16 v7, v88 offset:65408
    ds_pk_add_bf16 v7, v89 offset:65412
    s_mov_b64 exec, vcc
    s_branch L2_d131
L2_c132:
    s_mov_b64 s[50:51], vcc
    s_lshl_b64 s[52:53], s[82:83], 1
    s_andn2_b64 s[52:53], s[52:53], s[80:81]
    s_andn2_b64 s[52:53], s[52:53], s[50:51]
    s_or_b64 s[80:81], s[80:81], s[52:53]
    s_not_b64 vcc, s[52:53]
    s_mov_b64 exec, -1
    v_cndmask_b32_dpp v84, v84, v84, vcc wave_shr:1 row_mask:0xf bank_mask:0xf
    v_cndmask_b32_dpp v85, v85, v85, vcc wave_shr:1 row_mask:0xf bank_mask:0xf
    s_lshr_b64 s[52:53], s[52:53], 1
    v_cndmask_b32_dpp v86, v86, v86, vcc wave_shr:1 row_mask:0xf bank_mask:0xf
    v_cndmask_b32_dpp v87, v87, v87, vcc wave_shr:1 row_mask:0xf bank_mask:0xf
    s_andn2_b64 s[82:83], s[82:83], s[52:53]
    v_cndmask_b32_dpp v7, v7, v7, vcc wave_shr:1 row_mask:0xf bank_mask:0xf
    s_mov_b64 vcc, s[50:51]
    s_mov_b64 exec, s[50:51]
    s_cbranch_scc0 L2_d132
    s_mov_b64 exec, s[82:83]
    s_nop 1
    v_mfma_f32_4x4x4_16b_bf16 v[88:91], v[12:13], v[84:85], 0
    s_nop 1
    v_mfma_f32_4x4x4_16b_bf16 v[88:91], v[10:11], v[86:87], v[88:91]
    s_nop 4
    v_cvt_pk_bf16_f32 v88, v88, v89
    v_cvt_pk_bf16_f32 v89, v90, v91
    ds_pk_add_bf16 v7, v88 offset:65408
    ds_pk_add_bf16 v7, v89 offset:65412
    s_mov_b64 exec, vcc
    s_branch L2_d132
L2_c133:
    s_mov_b64 s[50:51], vcc
    s_lshl_b64 s[52:53], s[82:83], 1
    s_andn2_b64 s[52:53], s[52:53], s[80:81]
    s_andn2_b64 s[52:53], s[52:53], s[50:51]
    s_or_b64 s[80:81], s[80:81], s[52:53]
    s_not_b64 vcc, s[52:53]
    s_mov_b64 exec, -1
    v_cndmask_b32_dpp v84, v84, v84, vcc wave_shr:1 row_mask:0xf bank_mask:0xf
    v_cndmask_b32_dpp v85, v85, v85, vcc wave_shr:1 row_mask:0xf bank_mask:0xf
    s_lshr_b64 s[52:53], s[52:53], 1
    v_cndmask_b32_dpp v86, v86, v86, vcc wave_shr:1 row_mask:0xf bank_mask:0xf
    v_cndmask_b32_dpp v87, v87, v87, vcc wave_shr:1 row_mask:0xf bank_mask:0xf
    s_andn2_b64 s[82:83], s[82:83], s[52:53]
    v_cndmask_b32_dpp v7, v7, v7, vcc wave_shr:1 row_mask:0xf bank_mask:0xf
    s_mov_b64 vcc, s[50:51]
    s_mov_b64 exec, s[50:51]
    s_cbranch_scc0 L2_d133
    s_mov_b64 exec, s[82:83]
    s_nop 1
    v_mfma_f32_4x4x4_16b_bf16 v[88:91], v[12:13], v[84:85], 0
    s_nop 1
    v_mfma_f32_4x4x4_16b_bf16 v[88:91], v[10:11], v[86:87], v[88:91]
    s_nop 4
    v_cvt_pk_bf16_f32 v88, v88, v89
    v_cvt_pk_bf16_f32 v89, v90, v91
    ds_pk_add_bf16 v7, v88 offset:65408
    ds_pk_add_bf16 v7, v89 offset:65412
    s_mov_b64 exec, vcc
    s_branch L2_d133
L2_c134:
    s_mov_b64 s[50:51], vcc
    s_lshl_b64 s[52:53], s[82:83], 1
    s_andn2_b64 s[52:53], s[52:53], s[80:81]
    s_andn2_b64 s[52:53], s[52:53], s[50:51]
    s_or_b64 s[80:81], s[80:81], s[52:53]
    s_not_b64 vcc, s[52:53]
    s_mov_b64 exec, -1
    v_cndmask_b32_dpp v84, v84, v84, vcc wave_shr:1 row_mask:0xf bank_mask:0xf
    v_cndmask_b32_dpp v85, v85, v85, vcc wave_shr:1 row_mask:0xf bank_mask:0xf
    s_lshr_b64 s[52:53], s[52:53], 1
    v_cndmask_b32_dpp v86, v86, v86, vcc wave_shr:1 row_mask:0xf bank_mask:0xf
    v_cndmask_b32_dpp v87, v87, v87, vcc wave_shr:1 row_mask:0xf bank_mask:0xf
    s_andn2_b64 s[82:83], s[82:83], s[52:53]
    v_cndmask_b32_dpp v7, v7, v7, vcc wave_shr:1 row_mask:0xf bank_mask:0xf
    s_mov_b64 vcc, s[50:51]
    s_mov_b64 exec, s[50:51]
    s_cbranch_scc0 L2_d134
    s_mov_b64 exec, s[82:83]
    s_nop 1
    v_mfma_f32_4x4x4_16b_bf16 v[88:91], v[12:13], v[84:85], 0
    s_nop 1
    v_mfma_f32_4x4x4_16b_bf16 v[88:91], v[10:11], v[86:87], v[88:91]
    s_nop 4
    v_cvt_pk_bf16_f32 v88, v88, v89
    v_cvt_pk_bf16_f32 v89, v90, v91
    ds_pk_add_bf16 v7, v88 offset:65408
    ds_pk_add_bf16 v7, v89 offset:65412
    s_mov_b64 exec, vcc
    s_branch L2_d134
L2_c135:
    s_mov_b64 s[50:51], vcc
    s_lshl_b64 s[52:53], s[82:83], 1
    s_andn2_b64 s[52:53], s[52:53], s[80:81]
    s_andn2_b64 s[52:53], s[52:53], s[50:51]
    s_or_b64 s[80:81], s[80:81], s[52:53]
    s_not_b64 vcc, s[52:53]
    s_mov_b64 exec, -1
    v_cndmask_b32_dpp v84, v84, v84, vcc wave_shr:1 row_mask:0xf bank_mask:0xf
    v_cndmask_b32_dpp v85, v85, v85, vcc wave_shr:1 row_mask:0xf bank_mask:0xf
    s_lshr_b64 s[52:53], s[52:53], 1
    v_cndmask_b32_dpp v86, v86, v86, vcc wave_shr:1 row_mask:0xf bank_mask:0xf
    v_cndmask_b32_dpp v87, v87, v87, vcc wave_shr:1 row_mask:0xf bank_mask:0xf
    s_andn2_b64 s[82:83], s[82:83], s[52:53]
    v_cndmask_b32_dpp v7, v7, v7, vcc wave_shr:1 row_mask:0xf bank_mask:0xf
    s_mov_b64 vcc, s[50:51]
    s_mov_b64 exec, s[50:51]
    s_cbranch_scc0 L2_d135
    s_mov_b64 exec, s[82:83]
    s_nop 1
    v_mfma_f32_4x4x4_16b_bf16 v[88:91], v[12:13], v[84:85], 0
    s_nop 1
    v_mfma_f32_4x4x4_16b_bf16 v[88:91], v[10:11], v[86:87], v[88:91]
    s_nop 4
    v_cvt_pk_bf16_f32 v88, v88, v89
    v_cvt_pk_bf16_f32 v89, v90, v91
    ds_pk_add_bf16 v7, v88 offset:65408
    ds_pk_add_bf16 v7, v89 offset:65412
    s_mov_b64 exec, vcc
    s_branch L2_d135
L2_c136:
    s_mov_b64 s[50:51], vcc
    s_lshl_b64 s[52:53], s[82:83], 1
    s_andn2_b64 s[52:53], s[52:53], s[80:81]
    s_andn2_b64 s[52:53], s[52:53], s[50:51]
    s_or_b64 s[80:81], s[80:81], s[52:53]
    s_not_b64 vcc, s[52:53]
    s_mov_b64 exec, -1
    v_cndmask_b32_dpp v84, v84, v84, vcc wave_shr:1 row_mask:0xf bank_mask:0xf
    v_cndmask_b32_dpp v85, v85, v85, vcc wave_shr:1 row_mask:0xf bank_mask:0xf
    s_lshr_b64 s[52:53], s[52:53], 1
    v_cndmask_b32_dpp v86, v86, v86, vcc wave_shr:1 row_mask:0xf bank_mask:0xf
    v_cndmask_b32_dpp v87, v87, v87, vcc wave_shr:1 row_mask:0xf bank_mask:0xf
    s_andn2_b64 s[82:83], s[82:83], s[52:53]
    v_cndmask_b32_dpp v7, v7, v7, vcc wave_shr:1 row_mask:0xf bank_mask:0xf
    s_mov_b64 vcc, s[50:51]
    s_mov_b64 exec, s[50:51]
    s_cbranch_scc0 L2_d136
    s_mov_b64 exec, s[82:83]
    s_nop 1
    v_mfma_f32_4x4x4_16b_bf16 v[88:91], v[12:13], v[84:85], 0
    s_nop 1
    v_mfma_f32_4x4x4_16b_bf16 v[88:91], v[10:11], v[86:87], v[88:91]
    s_nop 4
    v_cvt_pk_bf16_f32 v88, v88, v89
    v_cvt_pk_bf16_f32 v89, v90, v91
    ds_pk_add_bf16 v7, v88 offset:65408
    ds_pk_add_bf16 v7, v89 offset:65412
    s_mov_b64 exec, vcc
    s_branch L2_d136
L2_c137:
    s_mov_b64 s[50:51], vcc
    s_lshl_b64 s[52:53], s[82:83], 1
    s_andn2_b64 s[52:53], s[52:53], s[80:81]
    s_andn2_b64 s[52:53], s[52:53], s[50:51]
    s_or_b64 s[80:81], s[80:81], s[52:53]
    s_not_b64 vcc, s[52:53]
    s_mov_b64 exec, -1
    v_cndmask_b32_dpp v84, v84, v84, vcc wave_shr:1 row_mask:0xf bank_mask:0xf
    v_cndmask_b32_dpp v85, v85, v85, vcc wave_shr:1 row_mask:0xf bank_mask:0xf
    s_lshr_b64 s[52:53], s[52:53], 1
    v_cndmask_b32_dpp v86, v86, v86, vcc wave_shr:1 row_mask:0xf bank_mask:0xf
    v_cndmask_b32_dpp v87, v87, v87, vcc wave_shr:1 row_mask:0xf bank_mask:0xf
    s_andn2_b64 s[82:83], s[82:83], s[52:53]
    v_cndmask_b32_dpp v7, v7, v7, vcc wave_shr:1 row_mask:0xf bank_mask:0xf
    s_mov_b64 vcc, s[50:51]
    s_mov_b64 exec, s[50:51]
    s_cbranch_scc0 L2_d137
    s_mov_b64 exec, s[82:83]
    s_nop 1
    v_mfma_f32_4x4x4_16b_bf16 v[88:91], v[12:13], v[84:85], 0
    s_nop 1
    v_mfma_f32_4x4x4_16b_bf16 v[88:91], v[10:11], v[86:87], v[88:91]
    s_nop 4
    v_cvt_pk_bf16_f32 v88, v88, v89
    v_cvt_pk_bf16_f32 v89, v90, v91
    ds_pk_add_bf16 v7, v88 offset:65408
    ds_pk_add_bf16 v7, v89 offset:65412
    s_mov_b64 exec, vcc
    s_branch L2_d137
L2_c138:
    s_mov_b64 s[50:51], vcc
    s_lshl_b64 s[52:53], s[82:83], 1
    s_andn2_b64 s[52:53], s[52:53], s[80:81]
    s_andn2_b64 s[52:53], s[52:53], s[50:51]
    s_or_b64 s[80:81], s[80:81], s[52:53]
    s_not_b64 vcc, s[52:53]
    s_mov_b64 exec, -1
    v_cndmask_b32_dpp v84, v84, v84, vcc wave_shr:1 row_mask:0xf bank_mask:0xf
    v_cndmask_b32_dpp v85, v85, v85, vcc wave_shr:1 row_mask:0xf bank_mask:0xf
    s_lshr_b64 s[52:53], s[52:53], 1
    v_cndmask_b32_dpp v86, v86, v86, vcc wave_shr:1 row_mask:0xf bank_mask:0xf
    v_cndmask_b32_dpp v87, v87, v87, vcc wave_shr:1 row_mask:0xf bank_mask:0xf
    s_andn2_b64 s[82:83], s[82:83], s[52:53]
    v_cndmask_b32_dpp v7, v7, v7, vcc wave_shr:1 row_mask:0xf bank_mask:0xf
    s_mov_b64 vcc, s[50:51]
    s_mov_b64 exec, s[50:51]
    s_cbranch_scc0 L2_d138
    s_mov_b64 exec, s[82:83]
    s_nop 1
    v_mfma_f32_4x4x4_16b_bf16 v[88:91], v[12:13], v[84:85], 0
    s_nop 1
    v_mfma_f32_4x4x4_16b_bf16 v[88:91], v[10:11], v[86:87], v[88:91]
    s_nop 4
    v_cvt_pk_bf16_f32 v88, v88, v89
    v_cvt_pk_bf16_f32 v89, v90, v91
    ds_pk_add_bf16 v7, v88 offset:65408
    ds_pk_add_bf16 v7, v89 offset:65412
    s_mov_b64 exec, vcc
    s_branch L2_d138
L2_c139:
    s_mov_b64 s[50:51], vcc
    s_lshl_b64 s[52:53], s[82:83], 1
    s_andn2_b64 s[52:53], s[52:53], s[80:81]
    s_andn2_b64 s[52:53], s[52:53], s[50:51]
    s_or_b64 s[80:81], s[80:81], s[52:53]
    s_not_b64 vcc, s[52:53]
    s_mov_b64 exec, -1
    v_cndmask_b32_dpp v84, v84, v84, vcc wave_shr:1 row_mask:0xf bank_mask:0xf
    v_cndmask_b32_dpp v85, v85, v85, vcc wave_shr:1 row_mask:0xf bank_mask:0xf
    s_lshr_b64 s[52:53], s[52:53], 1
    v_cndmask_b32_dpp v86, v86, v86, vcc wave_shr:1 row_mask:0xf bank_mask:0xf
    v_cndmask_b32_dpp v87, v87, v87, vcc wave_shr:1 row_mask:0xf bank_mask:0xf
    s_andn2_b64 s[82:83], s[82:83], s[52:53]
    v_cndmask_b32_dpp v7, v7, v7, vcc wave_shr:1 row_mask:0xf bank_mask:0xf
    s_mov_b64 vcc, s[50:51]
    s_mov_b64 exec, s[50:51]
    s_cbranch_scc0 L2_d139
    s_mov_b64 exec, s[82:83]
    s_nop 1
    v_mfma_f32_4x4x4_16b_bf16 v[88:91], v[12:13], v[84:85], 0
    s_nop 1
    v_mfma_f32_4x4x4_16b_bf16 v[88:91], v[10:11], v[86:87], v[88:91]
    s_nop 4
    v_cvt_pk_bf16_f32 v88, v88, v89
    v_cvt_pk_bf16_f32 v89, v90, v91
    ds_pk_add_bf16 v7, v88 offset:65408
    ds_pk_add_bf16 v7, v89 offset:65412
    s_mov_b64 exec, vcc
    s_branch L2_d139
L2_c140:
    s_mov_b64 s[50:51], vcc
    s_lshl_b64 s[52:53], s[82:83], 1
    s_andn2_b64 s[52:53], s[52:53], s[80:81]
    s_andn2_b64 s[52:53], s[52:53], s[50:51]
    s_or_b64 s[80:81], s[80:81], s[52:53]
    s_not_b64 vcc, s[52:53]
    s_mov_b64 exec, -1
    v_cndmask_b32_dpp v84, v84, v84, vcc wave_shr:1 row_mask:0xf bank_mask:0xf
    v_cndmask_b32_dpp v85, v85, v85, vcc wave_shr:1 row_mask:0xf bank_mask:0xf
    s_lshr_b64 s[52:53], s[52:53], 1
    v_cndmask_b32_dpp v86, v86, v86, vcc wave_shr:1 row_mask:0xf bank_mask:0xf
    v_cndmask_b32_dpp v87, v87, v87, vcc wave_shr:1 row_mask:0xf bank_mask:0xf
    s_andn2_b64 s[82:83], s[82:83], s[52:53]
    v_cndmask_b32_dpp v7, v7, v7, vcc wave_shr:1 row_mask:0xf bank_mask:0xf
    s_mov_b64 vcc, s[50:51]
    s_mov_b64 exec, s[50:51]
    s_cbranch_scc0 L2_d140
    s_mov_b64 exec, s[82:83]
    s_nop 1
    v_mfma_f32_4x4x4_16b_bf16 v[88:91], v[12:13], v[84:85], 0
    s_nop 1
    v_mfma_f32_4x4x4_16b_bf16 v[88:91], v[10:11], v[86:87], v[88:91]
    s_nop 4
    v_cvt_pk_bf16_f32 v88, v88, v89
    v_cvt_pk_bf16_f32 v89, v90, v91
    ds_pk_add_bf16 v7, v88 offset:65408
    ds_pk_add_bf16 v7, v89 offset:65412
    s_mov_b64 exec, vcc
    s_branch L2_d140
L2_c141:
    s_mov_b64 s[50:51], vcc
    s_lshl_b64 s[52:53], s[82:83], 1
    s_andn2_b64 s[52:53], s[52:53], s[80:81]
    s_andn2_b64 s[52:53], s[52:53], s[50:51]
    s_or_b64 s[80:81], s[80:81], s[52:53]
    s_not_b64 vcc, s[52:53]
    s_mov_b64 exec, -1
    v_cndmask_b32_dpp v84, v84, v84, vcc wave_shr:1 row_mask:0xf bank_mask:0xf
    v_cndmask_b32_dpp v85, v85, v85, vcc wave_shr:1 row_mask:0xf bank_mask:0xf
    s_lshr_b64 s[52:53], s[52:53], 1
    v_cndmask_b32_dpp v86, v86, v86, vcc wave_shr:1 row_mask:0xf bank_mask:0xf
    v_cndmask_b32_dpp v87, v87, v87, vcc wave_shr:1 row_mask:0xf bank_mask:0xf
    s_andn2_b64 s[82:83], s[82:83], s[52:53]
    v_cndmask_b32_dpp v7, v7, v7, vcc wave_shr:1 row_mask:0xf bank_mask:0xf
    s_mov_b64 vcc, s[50:51]
    s_mov_b64 exec, s[50:51]
    s_cbranch_scc0 L2_d141
    s_mov_b64 exec, s[82:83]
    s_nop 1
    v_mfma_f32_4x4x4_16b_bf16 v[88:91], v[12:13], v[84:85], 0
    s_nop 1
    v_mfma_f32_4x4x4_16b_bf16 v[88:91], v[10:11], v[86:87], v[88:91]
    s_nop 4
    v_cvt_pk_bf16_f32 v88, v88, v89
    v_cvt_pk_bf16_f32 v89, v90, v91
    ds_pk_add_bf16 v7, v88 offset:65408
    ds_pk_add_bf16 v7, v89 offset:65412
    s_mov_b64 exec, vcc
    s_branch L2_d141
L2_c142:
    s_mov_b64 s[50:51], vcc
    s_lshl_b64 s[52:53], s[82:83], 1
    s_andn2_b64 s[52:53], s[52:53], s[80:81]
    s_andn2_b64 s[52:53], s[52:53], s[50:51]
    s_or_b64 s[80:81], s[80:81], s[52:53]
    s_not_b64 vcc, s[52:53]
    s_mov_b64 exec, -1
    v_cndmask_b32_dpp v84, v84, v84, vcc wave_shr:1 row_mask:0xf bank_mask:0xf
    v_cndmask_b32_dpp v85, v85, v85, vcc wave_shr:1 row_mask:0xf bank_mask:0xf
    s_lshr_b64 s[52:53], s[52:53], 1
    v_cndmask_b32_dpp v86, v86, v86, vcc wave_shr:1 row_mask:0xf bank_mask:0xf
    v_cndmask_b32_dpp v87, v87, v87, vcc wave_shr:1 row_mask:0xf bank_mask:0xf
    s_andn2_b64 s[82:83], s[82:83], s[52:53]
    v_cndmask_b32_dpp v7, v7, v7, vcc wave_shr:1 row_mask:0xf bank_mask:0xf
    s_mov_b64 vcc, s[50:51]
    s_mov_b64 exec, s[50:51]
    s_cbranch_scc0 L2_d142
    s_mov_b64 exec, s[82:83]
    s_nop 1
    v_mfma_f32_4x4x4_16b_bf16 v[88:91], v[12:13], v[84:85], 0
    s_nop 1
    v_mfma_f32_4x4x4_16b_bf16 v[88:91], v[10:11], v[86:87], v[88:91]
    s_nop 4
    v_cvt_pk_bf16_f32 v88, v88, v89
    v_cvt_pk_bf16_f32 v89, v90, v91
    ds_pk_add_bf16 v7, v88 offset:65408
    ds_pk_add_bf16 v7, v89 offset:65412
    s_mov_b64 exec, vcc
    s_branch L2_d142
L2_c143:
    s_mov_b64 s[50:51], vcc
    s_lshl_b64 s[52:53], s[82:83], 1
    s_andn2_b64 s[52:53], s[52:53], s[80:81]
    s_andn2_b64 s[52:53], s[52:53], s[50:51]
    s_or_b64 s[80:81], s[80:81], s[52:53]
    s_not_b64 vcc, s[52:53]
    s_mov_b64 exec, -1
    v_cndmask_b32_dpp v84, v84, v84, vcc wave_shr:1 row_mask:0xf bank_mask:0xf
    v_cndmask_b32_dpp v85, v85, v85, vcc wave_shr:1 row_mask:0xf bank_mask:0xf
    s_lshr_b64 s[52:53], s[52:53], 1
    v_cndmask_b32_dpp v86, v86, v86, vcc wave_shr:1 row_mask:0xf bank_mask:0xf
    v_cndmask_b32_dpp v87, v87, v87, vcc wave_shr:1 row_mask:0xf bank_mask:0xf
    s_andn2_b64 s[82:83], s[82:83], s[52:53]
    v_cndmask_b32_dpp v7, v7, v7, vcc wave_shr:1 row_mask:0xf bank_mask:0xf
    s_mov_b64 vcc, s[50:51]
    s_mov_b64 exec, s[50:51]
    s_cbranch_scc0 L2_d143
    s_mov_b64 exec, s[82:83]
    s_nop 1
    v_mfma_f32_4x4x4_16b_bf16 v[88:91], v[12:13], v[84:85], 0
    s_nop 1
    v_mfma_f32_4x4x4_16b_bf16 v[88:91], v[10:11], v[86:87], v[88:91]
    s_nop 4
    v_cvt_pk_bf16_f32 v88, v88, v89
    v_cvt_pk_bf16_f32 v89, v90, v91
    ds_pk_add_bf16 v7, v88 offset:65408
    ds_pk_add_bf16 v7, v89 offset:65412
    s_mov_b64 exec, vcc
    s_branch L2_d143
L2_c144:
    s_mov_b64 s[50:51], vcc
    s_lshl_b64 s[52:53], s[82:83], 1
    s_andn2_b64 s[52:53], s[52:53], s[80:81]
    s_andn2_b64 s[52:53], s[52:53], s[50:51]
    s_or_b64 s[80:81], s[80:81], s[52:53]
    s_not_b64 vcc, s[52:53]
    s_mov_b64 exec, -1
    v_cndmask_b32_dpp v84, v84, v84, vcc wave_shr:1 row_mask:0xf bank_mask:0xf
    v_cndmask_b32_dpp v85, v85, v85, vcc wave_shr:1 row_mask:0xf bank_mask:0xf
    s_lshr_b64 s[52:53], s[52:53], 1
    v_cndmask_b32_dpp v86, v86, v86, vcc wave_shr:1 row_mask:0xf bank_mask:0xf
    v_cndmask_b32_dpp v87, v87, v87, vcc wave_shr:1 row_mask:0xf bank_mask:0xf
    s_andn2_b64 s[82:83], s[82:83], s[52:53]
    v_cndmask_b32_dpp v7, v7, v7, vcc wave_shr:1 row_mask:0xf bank_mask:0xf
    s_mov_b64 vcc, s[50:51]
    s_mov_b64 exec, s[50:51]
    s_cbranch_scc0 L2_d144
    s_mov_b64 exec, s[82:83]
    s_nop 1
    v_mfma_f32_4x4x4_16b_bf16 v[88:91], v[12:13], v[84:85], 0
    s_nop 1
    v_mfma_f32_4x4x4_16b_bf16 v[88:91], v[10:11], v[86:87], v[88:91]
    s_nop 4
    v_cvt_pk_bf16_f32 v88, v88, v89
    v_cvt_pk_bf16_f32 v89, v90, v91
    ds_pk_add_bf16 v7, v88 offset:65408
    ds_pk_add_bf16 v7, v89 offset:65412
    s_mov_b64 exec, vcc
    s_branch L2_d144
L2_c145:
    s_mov_b64 s[50:51], vcc
    s_lshl_b64 s[52:53], s[82:83], 1
    s_andn2_b64 s[52:53], s[52:53], s[80:81]
    s_andn2_b64 s[52:53], s[52:53], s[50:51]
    s_or_b64 s[80:81], s[80:81], s[52:53]
    s_not_b64 vcc, s[52:53]
    s_mov_b64 exec, -1
    v_cndmask_b32_dpp v84, v84, v84, vcc wave_shr:1 row_mask:0xf bank_mask:0xf
    v_cndmask_b32_dpp v85, v85, v85, vcc wave_shr:1 row_mask:0xf bank_mask:0xf
    s_lshr_b64 s[52:53], s[52:53], 1
    v_cndmask_b32_dpp v86, v86, v86, vcc wave_shr:1 row_mask:0xf bank_mask:0xf
    v_cndmask_b32_dpp v87, v87, v87, vcc wave_shr:1 row_mask:0xf bank_mask:0xf
    s_andn2_b64 s[82:83], s[82:83], s[52:53]
    v_cndmask_b32_dpp v7, v7, v7, vcc wave_shr:1 row_mask:0xf bank_mask:0xf
    s_mov_b64 vcc, s[50:51]
    s_mov_b64 exec, s[50:51]
    s_cbranch_scc0 L2_d145
    s_mov_b64 exec, s[82:83]
    s_nop 1
    v_mfma_f32_4x4x4_16b_bf16 v[88:91], v[12:13], v[84:85], 0
    s_nop 1
    v_mfma_f32_4x4x4_16b_bf16 v[88:91], v[10:11], v[86:87], v[88:91]
    s_nop 4
    v_cvt_pk_bf16_f32 v88, v88, v89
    v_cvt_pk_bf16_f32 v89, v90, v91
    ds_pk_add_bf16 v7, v88 offset:65408
    ds_pk_add_bf16 v7, v89 offset:65412
    s_mov_b64 exec, vcc
    s_branch L2_d145
L2_c146:
    s_mov_b64 s[50:51], vcc
    s_lshl_b64 s[52:53], s[82:83], 1
    s_andn2_b64 s[52:53], s[52:53], s[80:81]
    s_andn2_b64 s[52:53], s[52:53], s[50:51]
    s_or_b64 s[80:81], s[80:81], s[52:53]
    s_not_b64 vcc, s[52:53]
    s_mov_b64 exec, -1
    v_cndmask_b32_dpp v84, v84, v84, vcc wave_shr:1 row_mask:0xf bank_mask:0xf
    v_cndmask_b32_dpp v85, v85, v85, vcc wave_shr:1 row_mask:0xf bank_mask:0xf
    s_lshr_b64 s[52:53], s[52:53], 1
    v_cndmask_b32_dpp v86, v86, v86, vcc wave_shr:1 row_mask:0xf bank_mask:0xf
    v_cndmask_b32_dpp v87, v87, v87, vcc wave_shr:1 row_mask:0xf bank_mask:0xf
    s_andn2_b64 s[82:83], s[82:83], s[52:53]
    v_cndmask_b32_dpp v7, v7, v7, vcc wave_shr:1 row_mask:0xf bank_mask:0xf
    s_mov_b64 vcc, s[50:51]
    s_mov_b64 exec, s[50:51]
    s_cbranch_scc0 L2_d146
    s_mov_b64 exec, s[82:83]
    s_nop 1
    v_mfma_f32_4x4x4_16b_bf16 v[88:91], v[12:13], v[84:85], 0
    s_nop 1
    v_mfma_f32_4x4x4_16b_bf16 v[88:91], v[10:11], v[86:87], v[88:91]
    s_nop 4
    v_cvt_pk_bf16_f32 v88, v88, v89
    v_cvt_pk_bf16_f32 v89, v90, v91
    ds_pk_add_bf16 v7, v88 offset:65408
    ds_pk_add_bf16 v7, v89 offset:65412
    s_mov_b64 exec, vcc
    s_branch L2_d146
L2_c147:
    s_mov_b64 s[50:51], vcc
    s_lshl_b64 s[52:53], s[82:83], 1
    s_andn2_b64 s[52:53], s[52:53], s[80:81]
    s_andn2_b64 s[52:53], s[52:53], s[50:51]
    s_or_b64 s[80:81], s[80:81], s[52:53]
    s_not_b64 vcc, s[52:53]
    s_mov_b64 exec, -1
    v_cndmask_b32_dpp v84, v84, v84, vcc wave_shr:1 row_mask:0xf bank_mask:0xf
    v_cndmask_b32_dpp v85, v85, v85, vcc wave_shr:1 row_mask:0xf bank_mask:0xf
    s_lshr_b64 s[52:53], s[52:53], 1
    v_cndmask_b32_dpp v86, v86, v86, vcc wave_shr:1 row_mask:0xf bank_mask:0xf
    v_cndmask_b32_dpp v87, v87, v87, vcc wave_shr:1 row_mask:0xf bank_mask:0xf
    s_andn2_b64 s[82:83], s[82:83], s[52:53]
    v_cndmask_b32_dpp v7, v7, v7, vcc wave_shr:1 row_mask:0xf bank_mask:0xf
    s_mov_b64 vcc, s[50:51]
    s_mov_b64 exec, s[50:51]
    s_cbranch_scc0 L2_d147
    s_mov_b64 exec, s[82:83]
    s_nop 1
    v_mfma_f32_4x4x4_16b_bf16 v[88:91], v[12:13], v[84:85], 0
    s_nop 1
    v_mfma_f32_4x4x4_16b_bf16 v[88:91], v[10:11], v[86:87], v[88:91]
    s_nop 4
    v_cvt_pk_bf16_f32 v88, v88, v89
    v_cvt_pk_bf16_f32 v89, v90, v91
    ds_pk_add_bf16 v7, v88 offset:65408
    ds_pk_add_bf16 v7, v89 offset:65412
    s_mov_b64 exec, vcc
    s_branch L2_d147
L2_c148:
    s_mov_b64 s[50:51], vcc
    s_lshl_b64 s[52:53], s[82:83], 1
    s_andn2_b64 s[52:53], s[52:53], s[80:81]
    s_andn2_b64 s[52:53], s[52:53], s[50:51]
    s_or_b64 s[80:81], s[80:81], s[52:53]
    s_not_b64 vcc, s[52:53]
    s_mov_b64 exec, -1
    v_cndmask_b32_dpp v84, v84, v84, vcc wave_shr:1 row_mask:0xf bank_mask:0xf
    v_cndmask_b32_dpp v85, v85, v85, vcc wave_shr:1 row_mask:0xf bank_mask:0xf
    s_lshr_b64 s[52:53], s[52:53], 1
    v_cndmask_b32_dpp v86, v86, v86, vcc wave_shr:1 row_mask:0xf bank_mask:0xf
    v_cndmask_b32_dpp v87, v87, v87, vcc wave_shr:1 row_mask:0xf bank_mask:0xf
    s_andn2_b64 s[82:83], s[82:83], s[52:53]
    v_cndmask_b32_dpp v7, v7, v7, vcc wave_shr:1 row_mask:0xf bank_mask:0xf
    s_mov_b64 vcc, s[50:51]
    s_mov_b64 exec, s[50:51]
    s_cbranch_scc0 L2_d148
    s_mov_b64 exec, s[82:83]
    s_nop 1
    v_mfma_f32_4x4x4_16b_bf16 v[88:91], v[12:13], v[84:85], 0
    s_nop 1
    v_mfma_f32_4x4x4_16b_bf16 v[88:91], v[10:11], v[86:87], v[88:91]
    s_nop 4
    v_cvt_pk_bf16_f32 v88, v88, v89
    v_cvt_pk_bf16_f32 v89, v90, v91
    ds_pk_add_bf16 v7, v88 offset:65408
    ds_pk_add_bf16 v7, v89 offset:65412
    s_mov_b64 exec, vcc
    s_branch L2_d148
L2_c149:
    s_mov_b64 s[50:51], vcc
    s_lshl_b64 s[52:53], s[82:83], 1
    s_andn2_b64 s[52:53], s[52:53], s[80:81]
    s_andn2_b64 s[52:53], s[52:53], s[50:51]
    s_or_b64 s[80:81], s[80:81], s[52:53]
    s_not_b64 vcc, s[52:53]
    s_mov_b64 exec, -1
    v_cndmask_b32_dpp v84, v84, v84, vcc wave_shr:1 row_mask:0xf bank_mask:0xf
    v_cndmask_b32_dpp v85, v85, v85, vcc wave_shr:1 row_mask:0xf bank_mask:0xf
    s_lshr_b64 s[52:53], s[52:53], 1
    v_cndmask_b32_dpp v86, v86, v86, vcc wave_shr:1 row_mask:0xf bank_mask:0xf
    v_cndmask_b32_dpp v87, v87, v87, vcc wave_shr:1 row_mask:0xf bank_mask:0xf
    s_andn2_b64 s[82:83], s[82:83], s[52:53]
    v_cndmask_b32_dpp v7, v7, v7, vcc wave_shr:1 row_mask:0xf bank_mask:0xf
    s_mov_b64 vcc, s[50:51]
    s_mov_b64 exec, s[50:51]
    s_cbranch_scc0 L2_d149
    s_mov_b64 exec, s[82:83]
    s_nop 1
    v_mfma_f32_4x4x4_16b_bf16 v[88:91], v[12:13], v[84:85], 0
    s_nop 1
    v_mfma_f32_4x4x4_16b_bf16 v[88:91], v[10:11], v[86:87], v[88:91]
    s_nop 4
    v_cvt_pk_bf16_f32 v88, v88, v89
    v_cvt_pk_bf16_f32 v89, v90, v91
    ds_pk_add_bf16 v7, v88 offset:65408
    ds_pk_add_bf16 v7, v89 offset:65412
    s_mov_b64 exec, vcc
    s_branch L2_d149
L2_c150:
    s_mov_b64 s[50:51], vcc
    s_lshl_b64 s[52:53], s[82:83], 1
    s_andn2_b64 s[52:53], s[52:53], s[80:81]
    s_andn2_b64 s[52:53], s[52:53], s[50:51]
    s_or_b64 s[80:81], s[80:81], s[52:53]
    s_not_b64 vcc, s[52:53]
    s_mov_b64 exec, -1
    v_cndmask_b32_dpp v84, v84, v84, vcc wave_shr:1 row_mask:0xf bank_mask:0xf
    v_cndmask_b32_dpp v85, v85, v85, vcc wave_shr:1 row_mask:0xf bank_mask:0xf
    s_lshr_b64 s[52:53], s[52:53], 1
    v_cndmask_b32_dpp v86, v86, v86, vcc wave_shr:1 row_mask:0xf bank_mask:0xf
    v_cndmask_b32_dpp v87, v87, v87, vcc wave_shr:1 row_mask:0xf bank_mask:0xf
    s_andn2_b64 s[82:83], s[82:83], s[52:53]
    v_cndmask_b32_dpp v7, v7, v7, vcc wave_shr:1 row_mask:0xf bank_mask:0xf
    s_mov_b64 vcc, s[50:51]
    s_mov_b64 exec, s[50:51]
    s_cbranch_scc0 L2_d150
    s_mov_b64 exec, s[82:83]
    s_nop 1
    v_mfma_f32_4x4x4_16b_bf16 v[88:91], v[12:13], v[84:85], 0
    s_nop 1
    v_mfma_f32_4x4x4_16b_bf16 v[88:91], v[10:11], v[86:87], v[88:91]
    s_nop 4
    v_cvt_pk_bf16_f32 v88, v88, v89
    v_cvt_pk_bf16_f32 v89, v90, v91
    ds_pk_add_bf16 v7, v88 offset:65408
    ds_pk_add_bf16 v7, v89 offset:65412
    s_mov_b64 exec, vcc
    s_branch L2_d150
L2_c151:
    s_mov_b64 s[50:51], vcc
    s_lshl_b64 s[52:53], s[82:83], 1
    s_andn2_b64 s[52:53], s[52:53], s[80:81]
    s_andn2_b64 s[52:53], s[52:53], s[50:51]
    s_or_b64 s[80:81], s[80:81], s[52:53]
    s_not_b64 vcc, s[52:53]
    s_mov_b64 exec, -1
    v_cndmask_b32_dpp v84, v84, v84, vcc wave_shr:1 row_mask:0xf bank_mask:0xf
    v_cndmask_b32_dpp v85, v85, v85, vcc wave_shr:1 row_mask:0xf bank_mask:0xf
    s_lshr_b64 s[52:53], s[52:53], 1
    v_cndmask_b32_dpp v86, v86, v86, vcc wave_shr:1 row_mask:0xf bank_mask:0xf
    v_cndmask_b32_dpp v87, v87, v87, vcc wave_shr:1 row_mask:0xf bank_mask:0xf
    s_andn2_b64 s[82:83], s[82:83], s[52:53]
    v_cndmask_b32_dpp v7, v7, v7, vcc wave_shr:1 row_mask:0xf bank_mask:0xf
    s_mov_b64 vcc, s[50:51]
    s_mov_b64 exec, s[50:51]
    s_cbranch_scc0 L2_d151
    s_mov_b64 exec, s[82:83]
    s_nop 1
    v_mfma_f32_4x4x4_16b_bf16 v[88:91], v[12:13], v[84:85], 0
    s_nop 1
    v_mfma_f32_4x4x4_16b_bf16 v[88:91], v[10:11], v[86:87], v[88:91]
    s_nop 4
    v_cvt_pk_bf16_f32 v88, v88, v89
    v_cvt_pk_bf16_f32 v89, v90, v91
    ds_pk_add_bf16 v7, v88 offset:65408
    ds_pk_add_bf16 v7, v89 offset:65412
    s_mov_b64 exec, vcc
    s_branch L2_d151
L2_c152:
    s_mov_b64 s[50:51], vcc
    s_lshl_b64 s[52:53], s[82:83], 1
    s_andn2_b64 s[52:53], s[52:53], s[80:81]
    s_andn2_b64 s[52:53], s[52:53], s[50:51]
    s_or_b64 s[80:81], s[80:81], s[52:53]
    s_not_b64 vcc, s[52:53]
    s_mov_b64 exec, -1
    v_cndmask_b32_dpp v84, v84, v84, vcc wave_shr:1 row_mask:0xf bank_mask:0xf
    v_cndmask_b32_dpp v85, v85, v85, vcc wave_shr:1 row_mask:0xf bank_mask:0xf
    s_lshr_b64 s[52:53], s[52:53], 1
    v_cndmask_b32_dpp v86, v86, v86, vcc wave_shr:1 row_mask:0xf bank_mask:0xf
    v_cndmask_b32_dpp v87, v87, v87, vcc wave_shr:1 row_mask:0xf bank_mask:0xf
    s_andn2_b64 s[82:83], s[82:83], s[52:53]
    v_cndmask_b32_dpp v7, v7, v7, vcc wave_shr:1 row_mask:0xf bank_mask:0xf
    s_mov_b64 vcc, s[50:51]
    s_mov_b64 exec, s[50:51]
    s_cbranch_scc0 L2_d152
    s_mov_b64 exec, s[82:83]
    s_nop 1
    v_mfma_f32_4x4x4_16b_bf16 v[88:91], v[12:13], v[84:85], 0
    s_nop 1
    v_mfma_f32_4x4x4_16b_bf16 v[88:91], v[10:11], v[86:87], v[88:91]
    s_nop 4
    v_cvt_pk_bf16_f32 v88, v88, v89
    v_cvt_pk_bf16_f32 v89, v90, v91
    ds_pk_add_bf16 v7, v88 offset:65408
    ds_pk_add_bf16 v7, v89 offset:65412
    s_mov_b64 exec, vcc
    s_branch L2_d152
L2_c153:
    s_mov_b64 s[50:51], vcc
    s_lshl_b64 s[52:53], s[82:83], 1
    s_andn2_b64 s[52:53], s[52:53], s[80:81]
    s_andn2_b64 s[52:53], s[52:53], s[50:51]
    s_or_b64 s[80:81], s[80:81], s[52:53]
    s_not_b64 vcc, s[52:53]
    s_mov_b64 exec, -1
    v_cndmask_b32_dpp v84, v84, v84, vcc wave_shr:1 row_mask:0xf bank_mask:0xf
    v_cndmask_b32_dpp v85, v85, v85, vcc wave_shr:1 row_mask:0xf bank_mask:0xf
    s_lshr_b64 s[52:53], s[52:53], 1
    v_cndmask_b32_dpp v86, v86, v86, vcc wave_shr:1 row_mask:0xf bank_mask:0xf
    v_cndmask_b32_dpp v87, v87, v87, vcc wave_shr:1 row_mask:0xf bank_mask:0xf
    s_andn2_b64 s[82:83], s[82:83], s[52:53]
    v_cndmask_b32_dpp v7, v7, v7, vcc wave_shr:1 row_mask:0xf bank_mask:0xf
    s_mov_b64 vcc, s[50:51]
    s_mov_b64 exec, s[50:51]
    s_cbranch_scc0 L2_d153
    s_mov_b64 exec, s[82:83]
    s_nop 1
    v_mfma_f32_4x4x4_16b_bf16 v[88:91], v[12:13], v[84:85], 0
    s_nop 1
    v_mfma_f32_4x4x4_16b_bf16 v[88:91], v[10:11], v[86:87], v[88:91]
    s_nop 4
    v_cvt_pk_bf16_f32 v88, v88, v89
    v_cvt_pk_bf16_f32 v89, v90, v91
    ds_pk_add_bf16 v7, v88 offset:65408
    ds_pk_add_bf16 v7, v89 offset:65412
    s_mov_b64 exec, vcc
    s_branch L2_d153
.section .rodata,"a"
.p2align 6
.amdhsa_kernel gather_scatter__molecular_angular_gemnet__graph_kernel
  .amdhsa_next_free_vgpr 128
  .amdhsa_next_free_sgpr 102
  .amdhsa_accum_offset 128
  .amdhsa_group_segment_fixed_size 0
  .amdhsa_kernarg_size 112
  .amdhsa_user_sgpr_count 2
  .amdhsa_user_sgpr_kernarg_segment_ptr 1
  .amdhsa_system_sgpr_workgroup_id_x 1
  .amdhsa_float_denorm_mode_32 3
.end_amdhsa_kernel
```

```asm
; @launch grid=(256,1,1) block=(1024,1,1) lds=163840
.amdgcn_target "amdgcn-amd-amdhsa--gfx950"
.text
.globl gather_scatter__molecular_angular_gemnet__graph_kernel
.p2align 8
.type gather_scatter__molecular_angular_gemnet__graph_kernel,@function
gather_scatter__molecular_angular_gemnet__graph_kernel:
    s_cmp_ge_u32 s2, 256
    s_cbranch_scc0 L1_go
    s_endpgm
L1_go:
    s_load_dwordx4 s[4:7], s[0:1], 8
    s_load_dwordx2 s[28:29], s[0:1], 32
    s_load_dwordx2 s[30:31], s[0:1], 104
    s_load_dwordx2 s[56:57], s[0:1], 96
    s_load_dwordx2 s[86:87], s[0:1], 0
    s_load_dwordx4 s[60:63], s[0:1], 56
    s_load_dwordx4 s[64:67], s[0:1], 72
    v_lshrrev_b32 v7, 6, v0
    v_lshlrev_b32 v1, 3, v0
    v_readfirstlane_b32 s32, v7
    v_lshlrev_b32 v0, 4, v0
    s_mul_i32 s33, s2, 16384
    s_mul_i32 s34, s2, 8192
    s_waitcnt lgkmcnt(0)
    s_mov_b32 s8, s4
    s_mov_b32 s9, s5
    s_mov_b32 s10, 0x9c40000
    s_mov_b32 s11, 0x20000
    s_mov_b32 s12, s6
    s_mov_b32 s13, s7
    s_mov_b32 s14, 0x9c40000
    s_mov_b32 s15, 0x20000
    s_mov_b32 s16, s28
    s_mov_b32 s17, s29
    s_mov_b32 s18, 0x4e20000
    s_mov_b32 s19, 0x20000
    s_mov_b32 s68, s62
    s_mov_b32 s69, s63
    s_mov_b32 s70, 0x40
    s_mov_b32 s71, 0x20000
    s_mov_b32 s72, s60
    s_mov_b32 s73, s61
    s_mov_b32 s74, 0x40
    s_mov_b32 s75, 0x20000
    s_mov_b32 s20, s66
    s_mov_b32 s21, s67
    s_mov_b32 s22, 0x20
    s_mov_b32 s23, 0x20000
    s_mov_b32 s80, s64
    s_mov_b32 s81, s65
    s_mov_b32 s82, 0x20
    s_mov_b32 s83, 0x20000
    s_add_u32 s24, s30, 0xebc9000
    s_addc_u32 s25, s31, 0
    s_mov_b32 s26, 0x100
    s_mov_b32 s27, 0x20000
    v_lshrrev_b32 v2, 3, v0
    v_and_b32 v2, 6, v2
    v_lshlrev_b32 v3, 2, v0
    s_lshl_b32 s3, s32, 8
    s_add_u32 s3, s3, s2
    s_cmp_lg_u32 s3, 254
    s_cbranch_scc1 L1_wt
    buffer_load_ushort v96, v2, s[68:71], 0 offen offset:0
    buffer_load_ushort v108, v2, s[68:71], 0 offen offset:8
    buffer_load_ushort v97, v2, s[68:71], 0 offen offset:16
    buffer_load_ushort v109, v2, s[68:71], 0 offen offset:24
    buffer_load_ushort v98, v2, s[68:71], 0 offen offset:32
    buffer_load_ushort v110, v2, s[68:71], 0 offen offset:40
    buffer_load_ushort v99, v2, s[68:71], 0 offen offset:48
    buffer_load_ushort v111, v2, s[68:71], 0 offen offset:56
    buffer_load_ushort v100, v2, s[72:75], 0 offen offset:0
    buffer_load_ushort v112, v2, s[72:75], 0 offen offset:8
    buffer_load_ushort v101, v2, s[72:75], 0 offen offset:16
    buffer_load_ushort v113, v2, s[72:75], 0 offen offset:24
    buffer_load_ushort v102, v2, s[72:75], 0 offen offset:32
    buffer_load_ushort v114, v2, s[72:75], 0 offen offset:40
    buffer_load_ushort v103, v2, s[72:75], 0 offen offset:48
    buffer_load_ushort v115, v2, s[72:75], 0 offen offset:56
    buffer_load_ushort v104, v2, s[20:23], 0 offen offset:0
    buffer_load_ushort v116, v2, s[20:23], 0 offen offset:8
    buffer_load_ushort v105, v2, s[20:23], 0 offen offset:16
    buffer_load_ushort v117, v2, s[20:23], 0 offen offset:24
    buffer_load_ushort v106, v2, s[80:83], 0 offen offset:0
    buffer_load_ushort v118, v2, s[80:83], 0 offen offset:8
    buffer_load_ushort v107, v2, s[80:83], 0 offen offset:16
    buffer_load_ushort v119, v2, s[80:83], 0 offen offset:24
    s_waitcnt vmcnt(0)
    v_lshl_or_b32 v96, v108, 16, v96
    v_lshl_or_b32 v97, v109, 16, v97
    v_lshl_or_b32 v98, v110, 16, v98
    v_lshl_or_b32 v99, v111, 16, v99
    v_lshl_or_b32 v100, v112, 16, v100
    v_lshl_or_b32 v101, v113, 16, v101
    v_lshl_or_b32 v102, v114, 16, v102
    v_lshl_or_b32 v103, v115, 16, v103
    v_lshl_or_b32 v104, v116, 16, v104
    v_lshl_or_b32 v105, v117, 16, v105
    v_lshl_or_b32 v106, v118, 16, v106
    v_lshl_or_b32 v107, v119, 16, v107
    buffer_store_dwordx4 v[96:99], v3, s[24:27], 0 offen offset:0 sc1
    buffer_store_dwordx4 v[100:103], v3, s[24:27], 0 offen offset:16 sc1
    buffer_store_dwordx4 v[104:107], v3, s[24:27], 0 offen offset:32 sc1
L1_wt:
    s_nop 1
    s_add_u32 s44, s33, 0x0
    buffer_load_dwordx4 v[16:19], v0, s[8:11], s44 offen nt
    s_add_u32 s45, s33, 0x0
    buffer_load_dwordx4 v[20:23], v0, s[12:15], s45 offen nt
    s_add_u32 s46, s34, 0x0
    buffer_load_dwordx2 v[24:25], v1, s[16:19], s46 offen nt
    s_add_u32 s47, s34, 0x200000
    buffer_load_dwordx2 v[26:27], v1, s[16:19], s47 offen nt
    s_add_u32 s44, s33, 0x400000
    buffer_load_dwordx4 v[28:31], v0, s[8:11], s44 offen nt
    s_add_u32 s45, s33, 0x400000
    buffer_load_dwordx4 v[32:35], v0, s[12:15], s45 offen nt
    s_add_u32 s46, s33, 0x800000
    buffer_load_dwordx4 v[36:39], v0, s[8:11], s46 offen nt
    s_add_u32 s47, s33, 0x800000
    buffer_load_dwordx4 v[40:43], v0, s[12:15], s47 offen nt
    s_add_u32 s44, s34, 0x400000
    buffer_load_dwordx2 v[44:45], v1, s[16:19], s44 offen nt
    s_add_u32 s45, s34, 0x600000
    buffer_load_dwordx2 v[46:47], v1, s[16:19], s45 offen nt
    s_mov_b32 s20, s30
    s_mov_b32 s21, s31
    s_mov_b32 s22, 0xd340000
    s_mov_b32 s23, 0x20000
    s_add_u32 s24, s30, 0x28000
    s_addc_u32 s25, s31, 0
    s_mov_b32 s26, 0xd318000
    s_mov_b32 s27, 0x20000
    s_mov_b32 s80, s86
    s_mov_b32 s81, s87
    s_mov_b32 s82, 0x4e2000
    s_mov_b32 s83, 0x20000
    s_mul_i32 s35, s2, 173056
    s_and_b32 s37, s32, 3
    s_lshl_b32 s37, s37, 3
    s_mov_b32 s36, s37
    s_lshr_b32 s37, s32, 2
    s_mul_i32 s37, s37, 2080
    s_add_u32 s36, s36, s37
    s_and_b32 s37, s2, 3
    s_lshl_b32 s37, s37, 5
    s_add_u32 s36, s36, s37
    s_mul_i32 s4, s2, 5
    s_add_u32 s4, s4, 8192
    s_lshl_b32 s38, s4, 14
    s_lshl_b32 s39, s4, 13
    v_mov_b32 v2, 1
    v_mov_b32 v4, 0x80000007
    v_mov_b32 v5, 0xfc
    v_mov_b32 v6, 0x78
    s_mov_b32 s40, 16512
    s_mov_b32 s55, -10000
    s_mov_b32 s41, 0x010c0c01
    s_mov_b32 s42, 0x030c0c03
    v_mov_b32 v8, 0
    v_mov_b32 v9, 0
    v_mov_b32 v10, 0
    v_mov_b32 v11, 0
    ds_write_b128 v0, v[8:11]
    s_add_u32 s60, s30, 0xebd2000
    s_addc_u32 s61, s31, 0
    s_mov_b32 s62, 0x8000
    s_mov_b32 s63, 0x20000
    s_mov_b64 s[66:67], s[56:57]
    s_lshl_b32 s57, s2, 7
    s_add_u32 s68, s30, 0xebca000
    s_addc_u32 s69, s31, 0
    s_mov_b32 s70, 0x80
    s_mov_b32 s71, 0x20000
    s_lshl_b32 s3, s2, 7
    s_add_u32 s68, s68, s3
    s_addc_u32 s69, s69, 0
    s_cmp_lg_u32 s32, 0
    s_cbranch_scc1 L1_fl
    buffer_store_dwordx4 v[8:11], v0, s[68:71], 0 offen sc1
    s_mov_b64 exec, 0xff
    buffer_store_dwordx4 v[8:11], v0, s[60:63], s57 offen sc1
    s_mov_b64 exec, -1
    buffer_inv sc1
L1_fl:
    s_waitcnt lgkmcnt(0)
    s_barrier
    s_setprio 3
    s_add_u32 s46, s33, 0xc00000
    buffer_load_dwordx4 v[48:51], v0, s[8:11], s46 offen nt
    s_add_u32 s47, s33, 0xc00000
    buffer_load_dwordx4 v[52:55], v0, s[12:15], s47 offen nt
    s_waitcnt vmcnt(8)
    v_lshlrev_b32 v7, 16, v24
    v_and_b32 v8, 0xffff0000, v24
    v_lshlrev_b32 v9, 16, v25
    v_and_b32 v10, 0xffff0000, v25
    v_mul_f32 v7, 0.15915494, v7
    v_mul_f32 v8, 0.15915494, v8
    v_mul_f32 v9, 0.15915494, v9
    v_mul_f32 v10, 0.15915494, v10
    v_mul_hi_u32_u24 v14, 429497, v16
    v_lshrrev_b32 v12, 3, v20
    v_cos_f32 v7, v7
    v_lshlrev_b16 v13, 3, v20
    v_mad_i32_i24 v11, v14, s55, v16
    v_bitop3_b32 v12, v6, v13, v12 bitop3:0xca
    v_lshl_add_u32 v11, v11, 17, s40
    v_lshlrev_b16 v14, 8, v14
    v_lshrrev_b32 v13, 2, v20
    v_add_u32 v16, v12, v11
    v_bitop3_b32 v20, v5, v13, v14 bitop3:0xea
    ds_add_u32 v20, v2
    v_mul_hi_u32_u24 v14, 429497, v17
    v_lshrrev_b32 v12, 3, v21
    v_cos_f32 v8, v8
    v_lshlrev_b16 v13, 3, v21
    v_mad_i32_i24 v11, v14, s55, v17
    v_bitop3_b32 v12, v6, v13, v12 bitop3:0xca
    v_lshl_add_u32 v11, v11, 17, s40
    v_lshlrev_b16 v14, 8, v14
    v_lshrrev_b32 v13, 2, v21
    v_add_u32 v17, v12, v11
    v_bitop3_b32 v21, v5, v13, v14 bitop3:0xea
    ds_add_u32 v21, v2
    v_cvt_pk_bf16_f32 v24, v7, v8
    v_perm_b32 v12, v24, v24, s41
    v_bitop3_b32 v16, v4, v12, v16 bitop3:0xca
    v_perm_b32 v13, v24, v24, s42
    v_bitop3_b32 v17, v4, v13, v17 bitop3:0xca
    v_mul_hi_u32_u24 v14, 429497, v18
    v_lshrrev_b32 v12, 3, v22
    v_cos_f32 v9, v9
    v_lshlrev_b16 v13, 3, v22
    v_mad_i32_i24 v11, v14, s55, v18
    v_bitop3_b32 v12, v6, v13, v12 bitop3:0xca
    v_lshl_add_u32 v11, v11, 17, s40
    v_lshlrev_b16 v14, 8, v14
    v_lshrrev_b32 v13, 2, v22
    v_add_u32 v18, v12, v11
    v_bitop3_b32 v22, v5, v13, v14 bitop3:0xea
    ds_add_u32 v22, v2
    v_mul_hi_u32_u24 v14, 429497, v19
    v_lshrrev_b32 v12, 3, v23
    v_cos_f32 v10, v10
    v_lshlrev_b16 v13, 3, v23
    v_mad_i32_i24 v11, v14, s55, v19
    v_bitop3_b32 v12, v6, v13, v12 bitop3:0xca
    v_lshl_add_u32 v11, v11, 17, s40
    v_lshlrev_b16 v14, 8, v14
    v_lshrrev_b32 v13, 2, v23
    v_add_u32 v19, v12, v11
    v_bitop3_b32 v23, v5, v13, v14 bitop3:0xea
    ds_add_u32 v23, v2
    v_cvt_pk_bf16_f32 v25, v9, v10
    v_perm_b32 v12, v25, v25, s41
    v_bitop3_b32 v18, v4, v12, v18 bitop3:0xca
    v_perm_b32 v13, v25, v25, s42
    v_bitop3_b32 v19, v4, v13, v19 bitop3:0xca
    s_add_u32 s44, s33, 0x1000000
    buffer_load_dwordx4 v[56:59], v0, s[8:11], s44 offen nt
    s_add_u32 s45, s33, 0x1000000
    buffer_load_dwordx4 v[60:63], v0, s[12:15], s45 offen nt
    s_add_u32 s46, s34, 0x800000
    buffer_load_dwordx2 v[64:65], v1, s[16:19], s46 offen nt
    s_add_u32 s47, s34, 0xa00000
    buffer_load_dwordx2 v[66:67], v1, s[16:19], s47 offen nt
    s_waitcnt vmcnt(10)
    v_lshlrev_b32 v7, 16, v26
    v_and_b32 v8, 0xffff0000, v26
    v_lshlrev_b32 v9, 16, v27
    v_and_b32 v10, 0xffff0000, v27
    v_mul_f32 v7, 0.15915494, v7
    v_mul_f32 v8, 0.15915494, v8
    v_mul_f32 v9, 0.15915494, v9
    v_mul_f32 v10, 0.15915494, v10
    v_mul_hi_u32_u24 v14, 429497, v28
    v_lshrrev_b32 v12, 3, v32
    v_cos_f32 v7, v7
    v_lshlrev_b16 v13, 3, v32
    v_mad_i32_i24 v11, v14, s55, v28
    v_bitop3_b32 v12, v6, v13, v12 bitop3:0xca
    v_lshl_add_u32 v11, v11, 17, s40
    v_lshlrev_b16 v14, 8, v14
    v_lshrrev_b32 v13, 2, v32
    v_add_u32 v28, v12, v11
    v_bitop3_b32 v32, v5, v13, v14 bitop3:0xea
    ds_add_u32 v32, v2
    v_mul_hi_u32_u24 v14, 429497, v29
    v_lshrrev_b32 v12, 3, v33
    v_cos_f32 v8, v8
    v_lshlrev_b16 v13, 3, v33
    v_mad_i32_i24 v11, v14, s55, v29
    v_bitop3_b32 v12, v6, v13, v12 bitop3:0xca
    v_lshl_add_u32 v11, v11, 17, s40
    v_lshlrev_b16 v14, 8, v14
    v_lshrrev_b32 v13, 2, v33
    v_add_u32 v29, v12, v11
    v_bitop3_b32 v33, v5, v13, v14 bitop3:0xea
    ds_add_u32 v33, v2
    v_cvt_pk_bf16_f32 v26, v7, v8
    v_perm_b32 v12, v26, v26, s41
    v_bitop3_b32 v28, v4, v12, v28 bitop3:0xca
    v_perm_b32 v13, v26, v26, s42
    v_bitop3_b32 v29, v4, v13, v29 bitop3:0xca
    v_mul_hi_u32_u24 v14, 429497, v30
    v_lshrrev_b32 v12, 3, v34
    v_cos_f32 v9, v9
    v_lshlrev_b16 v13, 3, v34
    v_mad_i32_i24 v11, v14, s55, v30
    v_bitop3_b32 v12, v6, v13, v12 bitop3:0xca
    v_lshl_add_u32 v11, v11, 17, s40
    v_lshlrev_b16 v14, 8, v14
    v_lshrrev_b32 v13, 2, v34
    v_add_u32 v30, v12, v11
    v_bitop3_b32 v34, v5, v13, v14 bitop3:0xea
    ds_add_u32 v34, v2
    v_mul_hi_u32_u24 v14, 429497, v31
    v_lshrrev_b32 v12, 3, v35
    v_cos_f32 v10, v10
    v_lshlrev_b16 v13, 3, v35
    v_mad_i32_i24 v11, v14, s55, v31
    v_bitop3_b32 v12, v6, v13, v12 bitop3:0xca
    v_lshl_add_u32 v11, v11, 17, s40
    v_lshlrev_b16 v14, 8, v14
    v_lshrrev_b32 v13, 2, v35
    v_add_u32 v31, v12, v11
    v_bitop3_b32 v35, v5, v13, v14 bitop3:0xea
    ds_add_u32 v35, v2
    v_cvt_pk_bf16_f32 v27, v9, v10
    v_perm_b32 v12, v27, v27, s41
    v_bitop3_b32 v30, v4, v12, v30 bitop3:0xca
    v_perm_b32 v13, v27, v27, s42
    v_bitop3_b32 v31, v4, v13, v31 bitop3:0xca
    s_setprio 2
    s_add_u32 s44, s33, 0x1400000
    buffer_load_dwordx4 v[68:71], v0, s[8:11], s44 offen nt
    s_add_u32 s45, s33, 0x1400000
    buffer_load_dwordx4 v[72:75], v0, s[12:15], s45 offen nt
    s_waitcnt vmcnt(8)
    v_lshlrev_b32 v7, 16, v44
    v_and_b32 v8, 0xffff0000, v44
    v_lshlrev_b32 v9, 16, v45
    v_and_b32 v10, 0xffff0000, v45
    v_mul_f32 v7, 0.15915494, v7
    v_mul_f32 v8, 0.15915494, v8
    v_mul_f32 v9, 0.15915494, v9
    v_mul_f32 v10, 0.15915494, v10
    v_mul_hi_u32_u24 v14, 429497, v36
    v_lshrrev_b32 v12, 3, v40
    v_cos_f32 v7, v7
    v_lshlrev_b16 v13, 3, v40
    v_mad_i32_i24 v11, v14, s55, v36
    v_bitop3_b32 v12, v6, v13, v12 bitop3:0xca
    v_lshl_add_u32 v11, v11, 17, s40
    v_lshlrev_b16 v14, 8, v14
    v_lshrrev_b32 v13, 2, v40
    v_add_u32 v36, v12, v11
    v_bitop3_b32 v40, v5, v13, v14 bitop3:0xea
    ds_add_u32 v40, v2
    v_mul_hi_u32_u24 v14, 429497, v37
    v_lshrrev_b32 v12, 3, v41
    v_cos_f32 v8, v8
    v_lshlrev_b16 v13, 3, v41
    v_mad_i32_i24 v11, v14, s55, v37
    v_bitop3_b32 v12, v6, v13, v12 bitop3:0xca
    v_lshl_add_u32 v11, v11, 17, s40
    v_lshlrev_b16 v14, 8, v14
    v_lshrrev_b32 v13, 2, v41
    v_add_u32 v37, v12, v11
    v_bitop3_b32 v41, v5, v13, v14 bitop3:0xea
    ds_add_u32 v41, v2
    v_cvt_pk_bf16_f32 v44, v7, v8
    v_perm_b32 v12, v44, v44, s41
    v_bitop3_b32 v36, v4, v12, v36 bitop3:0xca
    v_perm_b32 v13, v44, v44, s42
    v_bitop3_b32 v37, v4, v13, v37 bitop3:0xca
    v_mul_hi_u32_u24 v14, 429497, v38
    v_lshrrev_b32 v12, 3, v42
    v_cos_f32 v9, v9
    v_lshlrev_b16 v13, 3, v42
    v_mad_i32_i24 v11, v14, s55, v38
    v_bitop3_b32 v12, v6, v13, v12 bitop3:0xca
    v_lshl_add_u32 v11, v11, 17, s40
    v_lshlrev_b16 v14, 8, v14
    v_lshrrev_b32 v13, 2, v42
    v_add_u32 v38, v12, v11
    v_bitop3_b32 v42, v5, v13, v14 bitop3:0xea
    ds_add_u32 v42, v2
    v_mul_hi_u32_u24 v14, 429497, v39
    v_lshrrev_b32 v12, 3, v43
    v_cos_f32 v10, v10
    v_lshlrev_b16 v13, 3, v43
    v_mad_i32_i24 v11, v14, s55, v39
    v_bitop3_b32 v12, v6, v13, v12 bitop3:0xca
    v_lshl_add_u32 v11, v11, 17, s40
    v_lshlrev_b16 v14, 8, v14
    v_lshrrev_b32 v13, 2, v43
    v_add_u32 v39, v12, v11
    v_bitop3_b32 v43, v5, v13, v14 bitop3:0xea
    ds_add_u32 v43, v2
    v_cvt_pk_bf16_f32 v45, v9, v10
    v_perm_b32 v12, v45, v45, s41
    v_bitop3_b32 v38, v4, v12, v38 bitop3:0xca
    v_perm_b32 v13, v45, v45, s42
    v_bitop3_b32 v39, v4, v13, v39 bitop3:0xca
    s_add_u32 s46, s33, 0x1800000
    buffer_load_dwordx4 v[76:79], v0, s[8:11], s46 offen nt
    s_add_u32 s47, s33, 0x1800000
    buffer_load_dwordx4 v[80:83], v0, s[12:15], s47 offen nt
    s_add_u32 s44, s34, 0xc00000
    buffer_load_dwordx2 v[84:85], v1, s[16:19], s44 offen nt
    s_add_u32 s45, s34, 0xe00000
    buffer_load_dwordx2 v[86:87], v1, s[16:19], s45 offen nt
    s_waitcnt vmcnt(10)
    v_lshlrev_b32 v7, 16, v46
    v_and_b32 v8, 0xffff0000, v46
    v_lshlrev_b32 v9, 16, v47
    v_and_b32 v10, 0xffff0000, v47
    v_mul_f32 v7, 0.15915494, v7
    v_mul_f32 v8, 0.15915494, v8
    v_mul_f32 v9, 0.15915494, v9
    v_mul_f32 v10, 0.15915494, v10
    v_mul_hi_u32_u24 v14, 429497, v48
    v_lshrrev_b32 v12, 3, v52
    v_cos_f32 v7, v7
    v_lshlrev_b16 v13, 3, v52
    v_mad_i32_i24 v11, v14, s55, v48
    v_bitop3_b32 v12, v6, v13, v12 bitop3:0xca
    v_lshl_add_u32 v11, v11, 17, s40
    v_lshlrev_b16 v14, 8, v14
    v_lshrrev_b32 v13, 2, v52
    v_add_u32 v48, v12, v11
    v_bitop3_b32 v52, v5, v13, v14 bitop3:0xea
    ds_add_u32 v52, v2
    v_mul_hi_u32_u24 v14, 429497, v49
    v_lshrrev_b32 v12, 3, v53
    v_cos_f32 v8, v8
    v_lshlrev_b16 v13, 3, v53
    v_mad_i32_i24 v11, v14, s55, v49
    v_bitop3_b32 v12, v6, v13, v12 bitop3:0xca
    v_lshl_add_u32 v11, v11, 17, s40
    v_lshlrev_b16 v14, 8, v14
    v_lshrrev_b32 v13, 2, v53
    v_add_u32 v49, v12, v11
    v_bitop3_b32 v53, v5, v13, v14 bitop3:0xea
    ds_add_u32 v53, v2
    v_cvt_pk_bf16_f32 v46, v7, v8
    v_perm_b32 v12, v46, v46, s41
    v_bitop3_b32 v48, v4, v12, v48 bitop3:0xca
    v_perm_b32 v13, v46, v46, s42
    v_bitop3_b32 v49, v4, v13, v49 bitop3:0xca
    v_mul_hi_u32_u24 v14, 429497, v50
    v_lshrrev_b32 v12, 3, v54
    v_cos_f32 v9, v9
    v_lshlrev_b16 v13, 3, v54
    v_mad_i32_i24 v11, v14, s55, v50
    v_bitop3_b32 v12, v6, v13, v12 bitop3:0xca
    v_lshl_add_u32 v11, v11, 17, s40
    v_lshlrev_b16 v14, 8, v14
    v_lshrrev_b32 v13, 2, v54
    v_add_u32 v50, v12, v11
    v_bitop3_b32 v54, v5, v13, v14 bitop3:0xea
    ds_add_u32 v54, v2
    v_mul_hi_u32_u24 v14, 429497, v51
    v_lshrrev_b32 v12, 3, v55
    v_cos_f32 v10, v10
    v_lshlrev_b16 v13, 3, v55
    v_mad_i32_i24 v11, v14, s55, v51
    v_bitop3_b32 v12, v6, v13, v12 bitop3:0xca
    v_lshl_add_u32 v11, v11, 17, s40
    v_lshlrev_b16 v14, 8, v14
    v_lshrrev_b32 v13, 2, v55
    v_add_u32 v51, v12, v11
    v_bitop3_b32 v55, v5, v13, v14 bitop3:0xea
    ds_add_u32 v55, v2
    v_cvt_pk_bf16_f32 v47, v9, v10
    v_perm_b32 v12, v47, v47, s41
    v_bitop3_b32 v50, v4, v12, v50 bitop3:0xca
    v_perm_b32 v13, v47, v47, s42
    v_bitop3_b32 v51, v4, v13, v51 bitop3:0xca
    s_setprio 1
    s_add_u32 s46, s33, 0x1c00000
    buffer_load_dwordx4 v[88:91], v0, s[8:11], s46 offen nt
    s_add_u32 s47, s33, 0x1c00000
    buffer_load_dwordx4 v[92:95], v0, s[12:15], s47 offen nt
    s_waitcnt vmcnt(8)
    v_lshlrev_b32 v7, 16, v64
    v_and_b32 v8, 0xffff0000, v64
    v_lshlrev_b32 v9, 16, v65
    v_and_b32 v10, 0xffff0000, v65
    v_mul_f32 v7, 0.15915494, v7
    v_mul_f32 v8, 0.15915494, v8
    v_mul_f32 v9, 0.15915494, v9
    v_mul_f32 v10, 0.15915494, v10
    v_mul_hi_u32_u24 v14, 429497, v56
    v_lshrrev_b32 v12, 3, v60
    v_cos_f32 v7, v7
    v_lshlrev_b16 v13, 3, v60
    v_mad_i32_i24 v11, v14, s55, v56
    v_bitop3_b32 v12, v6, v13, v12 bitop3:0xca
    v_lshl_add_u32 v11, v11, 17, s40
    v_lshlrev_b16 v14, 8, v14
    v_lshrrev_b32 v13, 2, v60
    v_add_u32 v56, v12, v11
    v_bitop3_b32 v60, v5, v13, v14 bitop3:0xea
    ds_add_u32 v60, v2
    v_mul_hi_u32_u24 v14, 429497, v57
    v_lshrrev_b32 v12, 3, v61
    v_cos_f32 v8, v8
    v_lshlrev_b16 v13, 3, v61
    v_mad_i32_i24 v11, v14, s55, v57
    v_bitop3_b32 v12, v6, v13, v12 bitop3:0xca
    v_lshl_add_u32 v11, v11, 17, s40
    v_lshlrev_b16 v14, 8, v14
    v_lshrrev_b32 v13, 2, v61
    v_add_u32 v57, v12, v11
    v_bitop3_b32 v61, v5, v13, v14 bitop3:0xea
    ds_add_u32 v61, v2
    v_cvt_pk_bf16_f32 v64, v7, v8
    v_perm_b32 v12, v64, v64, s41
    v_bitop3_b32 v56, v4, v12, v56 bitop3:0xca
    v_perm_b32 v13, v64, v64, s42
    v_bitop3_b32 v57, v4, v13, v57 bitop3:0xca
    v_mul_hi_u32_u24 v14, 429497, v58
    v_lshrrev_b32 v12, 3, v62
    v_cos_f32 v9, v9
    v_lshlrev_b16 v13, 3, v62
    v_mad_i32_i24 v11, v14, s55, v58
    v_bitop3_b32 v12, v6, v13, v12 bitop3:0xca
    v_lshl_add_u32 v11, v11, 17, s40
    v_lshlrev_b16 v14, 8, v14
    v_lshrrev_b32 v13, 2, v62
    v_add_u32 v58, v12, v11
    v_bitop3_b32 v62, v5, v13, v14 bitop3:0xea
    ds_add_u32 v62, v2
    v_mul_hi_u32_u24 v14, 429497, v59
    v_lshrrev_b32 v12, 3, v63
    v_cos_f32 v10, v10
    v_lshlrev_b16 v13, 3, v63
    v_mad_i32_i24 v11, v14, s55, v59
    v_bitop3_b32 v12, v6, v13, v12 bitop3:0xca
    v_lshl_add_u32 v11, v11, 17, s40
    v_lshlrev_b16 v14, 8, v14
    v_lshrrev_b32 v13, 2, v63
    v_add_u32 v59, v12, v11
    v_bitop3_b32 v63, v5, v13, v14 bitop3:0xea
    ds_add_u32 v63, v2
    v_cvt_pk_bf16_f32 v65, v9, v10
    v_perm_b32 v12, v65, v65, s41
    v_bitop3_b32 v58, v4, v12, v58 bitop3:0xca
    v_perm_b32 v13, v65, v65, s42
    v_bitop3_b32 v59, v4, v13, v59 bitop3:0xca
    s_add_u32 s44, s33, 0x2000000
    buffer_load_dwordx4 v[96:99], v0, s[8:11], s44 offen nt
    s_add_u32 s45, s33, 0x2000000
    buffer_load_dwordx4 v[104:107], v0, s[12:15], s45 offen nt
    s_add_u32 s46, s34, 0x1000000
    buffer_load_dwordx2 v[108:109], v1, s[16:19], s46 offen nt
    s_add_u32 s47, s34, 0x1200000
    buffer_load_dwordx2 v[110:111], v1, s[16:19], s47 offen nt
    s_waitcnt vmcnt(10)
    v_lshlrev_b32 v7, 16, v66
    v_and_b32 v8, 0xffff0000, v66
    v_lshlrev_b32 v9, 16, v67
    v_and_b32 v10, 0xffff0000, v67
    v_mul_f32 v7, 0.15915494, v7
    v_mul_f32 v8, 0.15915494, v8
    v_mul_f32 v9, 0.15915494, v9
    v_mul_f32 v10, 0.15915494, v10
    v_mul_hi_u32_u24 v14, 429497, v68
    v_lshrrev_b32 v12, 3, v72
    v_cos_f32 v7, v7
    v_lshlrev_b16 v13, 3, v72
    v_mad_i32_i24 v11, v14, s55, v68
    v_bitop3_b32 v12, v6, v13, v12 bitop3:0xca
    v_lshl_add_u32 v11, v11, 17, s40
    v_lshlrev_b16 v14, 8, v14
    v_lshrrev_b32 v13, 2, v72
    v_add_u32 v68, v12, v11
    v_bitop3_b32 v72, v5, v13, v14 bitop3:0xea
    ds_add_u32 v72, v2
    v_mul_hi_u32_u24 v14, 429497, v69
    v_lshrrev_b32 v12, 3, v73
    v_cos_f32 v8, v8
    v_lshlrev_b16 v13, 3, v73
    v_mad_i32_i24 v11, v14, s55, v69
    v_bitop3_b32 v12, v6, v13, v12 bitop3:0xca
    v_lshl_add_u32 v11, v11, 17, s40
    v_lshlrev_b16 v14, 8, v14
    v_lshrrev_b32 v13, 2, v73
    v_add_u32 v69, v12, v11
    v_bitop3_b32 v73, v5, v13, v14 bitop3:0xea
    ds_add_u32 v73, v2
    v_cvt_pk_bf16_f32 v66, v7, v8
    v_perm_b32 v12, v66, v66, s41
    v_bitop3_b32 v68, v4, v12, v68 bitop3:0xca
    v_perm_b32 v13, v66, v66, s42
    v_bitop3_b32 v69, v4, v13, v69 bitop3:0xca
    v_mul_hi_u32_u24 v14, 429497, v70
    v_lshrrev_b32 v12, 3, v74
    v_cos_f32 v9, v9
    v_lshlrev_b16 v13, 3, v74
    v_mad_i32_i24 v11, v14, s55, v70
    v_bitop3_b32 v12, v6, v13, v12 bitop3:0xca
    v_lshl_add_u32 v11, v11, 17, s40
    v_lshlrev_b16 v14, 8, v14
    v_lshrrev_b32 v13, 2, v74
    v_add_u32 v70, v12, v11
    v_bitop3_b32 v74, v5, v13, v14 bitop3:0xea
    ds_add_u32 v74, v2
    v_mul_hi_u32_u24 v14, 429497, v71
    v_lshrrev_b32 v12, 3, v75
    v_cos_f32 v10, v10
    v_lshlrev_b16 v13, 3, v75
    v_mad_i32_i24 v11, v14, s55, v71
    v_bitop3_b32 v12, v6, v13, v12 bitop3:0xca
    v_lshl_add_u32 v11, v11, 17, s40
    v_lshlrev_b16 v14, 8, v14
    v_lshrrev_b32 v13, 2, v75
    v_add_u32 v71, v12, v11
    v_bitop3_b32 v75, v5, v13, v14 bitop3:0xea
    ds_add_u32 v75, v2
    v_cvt_pk_bf16_f32 v67, v9, v10
    v_perm_b32 v12, v67, v67, s41
    v_bitop3_b32 v70, v4, v12, v70 bitop3:0xca
    v_perm_b32 v13, v67, v67, s42
    v_bitop3_b32 v71, v4, v13, v71 bitop3:0xca
    s_setprio 0
    s_add_u32 s44, s33, 0x2400000
    buffer_load_dwordx4 v[112:115], v0, s[8:11], s44 offen nt
    s_waitcnt vmcnt(7)
    v_lshlrev_b32 v7, 16, v84
    v_and_b32 v8, 0xffff0000, v84
    v_lshlrev_b32 v9, 16, v85
    v_and_b32 v10, 0xffff0000, v85
    v_mul_f32 v7, 0.15915494, v7
    v_mul_f32 v8, 0.15915494, v8
    v_mul_f32 v9, 0.15915494, v9
    v_mul_f32 v10, 0.15915494, v10
    v_mul_hi_u32_u24 v14, 429497, v76
    v_lshrrev_b32 v12, 3, v80
    v_cos_f32 v7, v7
    v_lshlrev_b16 v13, 3, v80
    v_mad_i32_i24 v11, v14, s55, v76
    v_bitop3_b32 v12, v6, v13, v12 bitop3:0xca
    v_lshl_add_u32 v11, v11, 17, s40
    v_lshlrev_b16 v14, 8, v14
    v_lshrrev_b32 v13, 2, v80
    v_add_u32 v76, v12, v11
    v_bitop3_b32 v80, v5, v13, v14 bitop3:0xea
    ds_add_u32 v80, v2
    v_mul_hi_u32_u24 v14, 429497, v77
    v_lshrrev_b32 v12, 3, v81
    v_cos_f32 v8, v8
    v_lshlrev_b16 v13, 3, v81
    v_mad_i32_i24 v11, v14, s55, v77
    v_bitop3_b32 v12, v6, v13, v12 bitop3:0xca
    v_lshl_add_u32 v11, v11, 17, s40
    v_lshlrev_b16 v14, 8, v14
    v_lshrrev_b32 v13, 2, v81
    v_add_u32 v77, v12, v11
    v_bitop3_b32 v81, v5, v13, v14 bitop3:0xea
    ds_add_u32 v81, v2
    v_cvt_pk_bf16_f32 v84, v7, v8
    v_perm_b32 v12, v84, v84, s41
    v_bitop3_b32 v76, v4, v12, v76 bitop3:0xca
    v_perm_b32 v13, v84, v84, s42
    v_bitop3_b32 v77, v4, v13, v77 bitop3:0xca
    v_mul_hi_u32_u24 v14, 429497, v78
    v_lshrrev_b32 v12, 3, v82
    v_cos_f32 v9, v9
    v_lshlrev_b16 v13, 3, v82
    v_mad_i32_i24 v11, v14, s55, v78
    v_bitop3_b32 v12, v6, v13, v12 bitop3:0xca
    v_lshl_add_u32 v11, v11, 17, s40
    v_lshlrev_b16 v14, 8, v14
    v_lshrrev_b32 v13, 2, v82
    v_add_u32 v78, v12, v11
    v_bitop3_b32 v82, v5, v13, v14 bitop3:0xea
    ds_add_u32 v82, v2
    v_mul_hi_u32_u24 v14, 429497, v79
    v_lshrrev_b32 v12, 3, v83
    v_cos_f32 v10, v10
    v_lshlrev_b16 v13, 3, v83
    v_mad_i32_i24 v11, v14, s55, v79
    v_bitop3_b32 v12, v6, v13, v12 bitop3:0xca
    v_lshl_add_u32 v11, v11, 17, s40
    v_lshlrev_b16 v14, 8, v14
    v_lshrrev_b32 v13, 2, v83
    v_add_u32 v79, v12, v11
    v_bitop3_b32 v83, v5, v13, v14 bitop3:0xea
    ds_add_u32 v83, v2
    v_cvt_pk_bf16_f32 v85, v9, v10
    v_perm_b32 v12, v85, v85, s41
    v_bitop3_b32 v78, v4, v12, v78 bitop3:0xca
    v_perm_b32 v13, v85, v85, s42
    v_bitop3_b32 v79, v4, v13, v79 bitop3:0xca
    s_waitcnt vmcnt(5)
    v_lshlrev_b32 v7, 16, v86
    v_and_b32 v8, 0xffff0000, v86
    v_lshlrev_b32 v9, 16, v87
    v_and_b32 v10, 0xffff0000, v87
    v_mul_f32 v7, 0.15915494, v7
    v_mul_f32 v8, 0.15915494, v8
    v_mul_f32 v9, 0.15915494, v9
    v_mul_f32 v10, 0.15915494, v10
    v_mul_hi_u32_u24 v14, 429497, v88
    v_lshrrev_b32 v12, 3, v92
    v_cos_f32 v7, v7
    v_lshlrev_b16 v13, 3, v92
    v_mad_i32_i24 v11, v14, s55, v88
    v_bitop3_b32 v12, v6, v13, v12 bitop3:0xca
    v_lshl_add_u32 v11, v11, 17, s40
    v_lshlrev_b16 v14, 8, v14
    v_lshrrev_b32 v13, 2, v92
    v_add_u32 v88, v12, v11
    v_bitop3_b32 v92, v5, v13, v14 bitop3:0xea
    ds_add_u32 v92, v2
    v_mul_hi_u32_u24 v14, 429497, v89
    v_lshrrev_b32 v12, 3, v93
    v_cos_f32 v8, v8
    v_lshlrev_b16 v13, 3, v93
    v_mad_i32_i24 v11, v14, s55, v89
    v_bitop3_b32 v12, v6, v13, v12 bitop3:0xca
    v_lshl_add_u32 v11, v11, 17, s40
    v_lshlrev_b16 v14, 8, v14
    v_lshrrev_b32 v13, 2, v93
    v_add_u32 v89, v12, v11
    v_bitop3_b32 v93, v5, v13, v14 bitop3:0xea
    ds_add_u32 v93, v2
    v_cvt_pk_bf16_f32 v86, v7, v8
    v_perm_b32 v12, v86, v86, s41
    v_bitop3_b32 v88, v4, v12, v88 bitop3:0xca
    v_perm_b32 v13, v86, v86, s42
    v_bitop3_b32 v89, v4, v13, v89 bitop3:0xca
    v_mul_hi_u32_u24 v14, 429497, v90
    v_lshrrev_b32 v12, 3, v94
    v_cos_f32 v9, v9
    v_lshlrev_b16 v13, 3, v94
    v_mad_i32_i24 v11, v14, s55, v90
    v_bitop3_b32 v12, v6, v13, v12 bitop3:0xca
    v_lshl_add_u32 v11, v11, 17, s40
    v_lshlrev_b16 v14, 8, v14
    v_lshrrev_b32 v13, 2, v94
    v_add_u32 v90, v12, v11
    v_bitop3_b32 v94, v5, v13, v14 bitop3:0xea
    ds_add_u32 v94, v2
    v_mul_hi_u32_u24 v14, 429497, v91
    v_lshrrev_b32 v12, 3, v95
    v_cos_f32 v10, v10
    v_lshlrev_b16 v13, 3, v95
    v_mad_i32_i24 v11, v14, s55, v91
    v_bitop3_b32 v12, v6, v13, v12 bitop3:0xca
    v_lshl_add_u32 v11, v11, 17, s40
    v_lshlrev_b16 v14, 8, v14
    v_lshrrev_b32 v13, 2, v95
    v_add_u32 v91, v12, v11
    v_bitop3_b32 v95, v5, v13, v14 bitop3:0xea
    ds_add_u32 v95, v2
    v_cvt_pk_bf16_f32 v87, v9, v10
    v_perm_b32 v12, v87, v87, s41
    v_bitop3_b32 v90, v4, v12, v90 bitop3:0xca
    v_perm_b32 v13, v87, v87, s42
    v_bitop3_b32 v91, v4, v13, v91 bitop3:0xca
    v_lshrrev_b32 v8, 2, v0
    v_and_b32 v7, 0x3c00, v0
    v_bitop3_b32 v7, v5, v8, v7 bitop3:0xea
    s_waitcnt lgkmcnt(0)
    s_barrier
    ds_read2st64_b32 v[8:9], v7 offset0:0 offset1:1
    ds_read2st64_b32 v[10:11], v7 offset0:2 offset1:3
    s_add_u32 s45, s33, 0x2400000
    buffer_load_dwordx4 v[100:103], v0, s[12:15], s45 offen nt
    s_waitcnt lgkmcnt(0)
    v_lshl_or_b32 v12, v9, 16, v8
    v_lshl_or_b32 v13, v11, 16, v10
    v_mov_b32 v14, v12
    v_mov_b32 v15, v13
    s_nop 0
    v_add_u32_dpp v14, v14, v14 row_shr:1 row_mask:0xf bank_mask:0xf bound_ctrl:1
    v_add_u32_dpp v15, v15, v15 row_shr:1 row_mask:0xf bank_mask:0xf bound_ctrl:1
    s_nop 0
    v_add_u32_dpp v14, v14, v14 row_shr:2 row_mask:0xf bank_mask:0xf bound_ctrl:1
    v_add_u32_dpp v15, v15, v15 row_shr:2 row_mask:0xf bank_mask:0xf bound_ctrl:1
    s_nop 0
    v_add_u32_dpp v14, v14, v14 row_shr:4 row_mask:0xf bank_mask:0xf bound_ctrl:1
    v_add_u32_dpp v15, v15, v15 row_shr:4 row_mask:0xf bank_mask:0xf bound_ctrl:1
    s_nop 0
    v_add_u32_dpp v14, v14, v14 row_shr:8 row_mask:0xf bank_mask:0xf bound_ctrl:1
    v_add_u32_dpp v15, v15, v15 row_shr:8 row_mask:0xf bank_mask:0xf bound_ctrl:1
    s_nop 0
    v_add_u32_dpp v14, v14, v14 row_bcast:15 row_mask:0xa bank_mask:0xf
    v_add_u32_dpp v15, v15, v15 row_bcast:15 row_mask:0xa bank_mask:0xf
    s_nop 0
    v_add_u32_dpp v14, v14, v14 row_bcast:31 row_mask:0xc bank_mask:0xf
    v_add_u32_dpp v15, v15, v15 row_bcast:31 row_mask:0xc bank_mask:0xf
    v_readlane_b32 s48, v14, 63
    v_readlane_b32 s49, v15, 63
    s_lshl_b32 s54, s32, 2
    v_mov_b32 v8, s54
    s_and_b32 s50, s48, 0xffff
    s_lshr_b32 s51, s48, 16
    s_and_b32 s52, s49, 0xffff
    s_lshr_b32 s53, s49, 16
    s_add_u32 s51, s51, s50
    s_add_u32 s52, s52, s51
    s_add_u32 s53, s53, s52
    v_mov_b32 v9, s53
    s_mov_b64 exec, 1
    ds_write_b32 v8, v9 offset:16384
    s_mov_b64 exec, -1
    v_and_b32 v8, 60, v7
    s_waitcnt lgkmcnt(0)
    s_barrier
    ds_read_b32 v9, v8 offset:16384
    s_waitcnt lgkmcnt(0)
    v_add_u32_dpp v9, v9, v9 row_shr:1 row_mask:0xf bank_mask:0xf bound_ctrl:1
    s_nop 1
    v_add_u32_dpp v9, v9, v9 row_shr:2 row_mask:0xf bank_mask:0xf bound_ctrl:1
    s_nop 1
    v_add_u32_dpp v9, v9, v9 row_shr:4 row_mask:0xf bank_mask:0xf bound_ctrl:1
    s_nop 1
    v_add_u32_dpp v9, v9, v9 row_shr:8 row_mask:0xf bank_mask:0xf bound_ctrl:1
    s_nop 0
    v_readlane_b32 s54, v9, s32
    s_sub_u32 s54, s54, s53
    s_add_u32 s50, s50, s54
    s_add_u32 s51, s51, s54
    s_add_u32 s52, s52, s54
    s_pack_ll_b32_b16 s48, s54, s50
    s_pack_ll_b32_b16 s49, s51, s52
    v_add_u32 v14, s48, v14
    v_add_u32 v15, s49, v15
    v_sub_u32 v12, v14, v12
    v_sub_u32 v13, v15, v13
    v_and_b32 v8, 0xffff, v12
    v_lshrrev_b32 v9, 16, v12
    v_and_b32 v10, 0xffff, v13
    v_lshrrev_b32 v11, 16, v13
    ds_write2st64_b32 v7, v8, v9 offset0:0 offset1:1
    ds_write2st64_b32 v7, v10, v11 offset0:2 offset1:3
    v_and_b32 v8, 0x3f0, v0
    v_lshl_add_u32 v8, v8, 1, s36
    ds_write_b64 v8, v[12:13] offset:20480
    s_bitset0_b64 exec, 63
    s_not_b64 exec, exec
    ds_write_b64 v8, v[14:15] offset:20512
    s_mov_b64 exec, -1
    s_waitcnt lgkmcnt(0)
    s_barrier
    s_setprio 3
    ds_add_rtn_u32 v20, v20, v2
    ds_add_rtn_u32 v21, v21, v2
    ds_add_rtn_u32 v22, v22, v2
    ds_add_rtn_u32 v23, v23, v2
    ds_read_b128 v[12:15], v0 offset:20480
    v_cmp_gt_u32 vcc, 8448, v0
    ds_add_rtn_u32 v32, v32, v2
    ds_add_rtn_u32 v33, v33, v2
    ds_add_rtn_u32 v34, v34, v2
    ds_add_rtn_u32 v35, v35, v2
    s_setprio 2
    ds_add_rtn_u32 v40, v40, v2
    ds_add_rtn_u32 v41, v41, v2
    ds_add_rtn_u32 v42, v42, v2
    ds_add_rtn_u32 v43, v43, v2
    s_waitcnt lgkmcnt(8)
    s_cbranch_vccz L1_p1
    s_add_u32 s46, s35, 0x0
    s_mov_b64 exec, vcc
    buffer_store_dwordx4 v[12:15], v0, s[24:27], s46 offen sc1
    s_mov_b64 exec, -1
L1_p1:
    s_add_u32 s47, s33, 0x2800000
    buffer_load_dwordx4 v[116:119], v0, s[8:11], s47 offen nt
    ds_add_rtn_u32 v52, v52, v2
    ds_add_rtn_u32 v53, v53, v2
    ds_add_rtn_u32 v54, v54, v2
    ds_add_rtn_u32 v55, v55, v2
    s_setprio 1
    ds_add_rtn_u32 v60, v60, v2
    ds_add_rtn_u32 v61, v61, v2
    ds_add_rtn_u32 v62, v62, v2
    ds_add_rtn_u32 v63, v63, v2
    ds_add_rtn_u32 v72, v72, v2
    ds_add_rtn_u32 v73, v73, v2
    ds_add_rtn_u32 v74, v74, v2
    ds_add_rtn_u32 v75, v75, v2
    s_add_u32 s44, s33, 0x2800000
    buffer_load_dwordx4 v[120:123], v0, s[12:15], s44 offen nt
    s_setprio 0
    ds_add_rtn_u32 v80, v80, v2
    ds_add_rtn_u32 v81, v81, v2
    ds_add_rtn_u32 v82, v82, v2
    ds_add_rtn_u32 v83, v83, v2
    ds_add_rtn_u32 v92, v92, v2
    ds_add_rtn_u32 v93, v93, v2
    ds_add_rtn_u32 v94, v94, v2
    ds_add_rtn_u32 v95, v95, v2
    s_waitcnt lgkmcnt(0)
    s_barrier
    s_setprio 3
    v_and_b32 v7, -4, v20
    v_lshl_add_u32 v8, v20, 2, v7
    ds_write_b32 v8, v16
    v_lshl_add_u32 v7, v7, 2, v20
    ds_write_b8 v7, v24 offset:16
    v_and_b32 v9, -4, v21
    v_lshl_add_u32 v10, v21, 2, v9
    ds_write_b32 v10, v17
    v_lshl_add_u32 v9, v9, 2, v21
    ds_write_b8_d16_hi v9, v24 offset:16
    v_and_b32 v7, -4, v22
    v_lshl_add_u32 v8, v22, 2, v7
    ds_write_b32 v8, v18
    v_lshl_add_u32 v7, v7, 2, v22
    ds_write_b8 v7, v25 offset:16
    v_and_b32 v9, -4, v23
    v_lshl_add_u32 v10, v23, 2, v9
    ds_write_b32 v10, v19
    v_lshl_add_u32 v9, v9, 2, v23
    ds_write_b8_d16_hi v9, v25 offset:16
    s_add_u32 s45, s34, 0x1400000
    buffer_load_dwordx2 v[124:125], v1, s[16:19], s45 offen nt
    s_add_u32 s46, s34, 0x1600000
    buffer_load_dwordx2 v[126:127], v1, s[16:19], s46 offen nt
    s_add_u32 s47, s33, 0x2c00000
    buffer_load_dwordx4 v[16:19], v0, s[8:11], s47 offen nt
    v_and_b32 v7, -4, v32
    v_lshl_add_u32 v8, v32, 2, v7
    ds_write_b32 v8, v28
    v_lshl_add_u32 v7, v7, 2, v32
    ds_write_b8 v7, v26 offset:16
    v_and_b32 v9, -4, v33
    v_lshl_add_u32 v10, v33, 2, v9
    ds_write_b32 v10, v29
    v_lshl_add_u32 v9, v9, 2, v33
    ds_write_b8_d16_hi v9, v26 offset:16
    v_and_b32 v7, -4, v34
    v_lshl_add_u32 v8, v34, 2, v7
    ds_write_b32 v8, v30
    v_lshl_add_u32 v7, v7, 2, v34
    ds_write_b8 v7, v27 offset:16
    v_and_b32 v9, -4, v35
    v_lshl_add_u32 v10, v35, 2, v9
    ds_write_b32 v10, v31
    v_lshl_add_u32 v9, v9, 2, v35
    ds_write_b8_d16_hi v9, v27 offset:16
    s_add_u32 s44, s33, 0x2c00000
    buffer_load_dwordx4 v[20:23], v0, s[12:15], s44 offen nt
    s_setprio 2
    v_and_b32 v7, -4, v40
    v_lshl_add_u32 v8, v40, 2, v7
    ds_write_b32 v8, v36
    v_lshl_add_u32 v7, v7, 2, v40
    ds_write_b8 v7, v44 offset:16
    v_and_b32 v9, -4, v41
    v_lshl_add_u32 v10, v41, 2, v9
    ds_write_b32 v10, v37
    v_lshl_add_u32 v9, v9, 2, v41
    ds_write_b8_d16_hi v9, v44 offset:16
    v_and_b32 v7, -4, v42
    v_lshl_add_u32 v8, v42, 2, v7
    ds_write_b32 v8, v38
    v_lshl_add_u32 v7, v7, 2, v42
    ds_write_b8 v7, v45 offset:16
    v_and_b32 v9, -4, v43
    v_lshl_add_u32 v10, v43, 2, v9
    ds_write_b32 v10, v39
    v_lshl_add_u32 v9, v9, 2, v43
    ds_write_b8_d16_hi v9, v45 offset:16
    s_add_u32 s45, s33, 0x3000000
    buffer_load_dwordx4 v[28:31], v0, s[8:11], s45 offen nt
    s_add_u32 s46, s33, 0x3000000
    buffer_load_dwordx4 v[32:35], v0, s[12:15], s46 offen nt
    v_and_b32 v7, -4, v52
    v_lshl_add_u32 v8, v52, 2, v7
    ds_write_b32 v8, v48
    v_lshl_add_u32 v7, v7, 2, v52
    ds_write_b8 v7, v46 offset:16
    v_and_b32 v9, -4, v53
    v_lshl_add_u32 v10, v53, 2, v9
    ds_write_b32 v10, v49
    v_lshl_add_u32 v9, v9, 2, v53
    ds_write_b8_d16_hi v9, v46 offset:16
    v_and_b32 v7, -4, v54
    v_lshl_add_u32 v8, v54, 2, v7
    ds_write_b32 v8, v50
    v_lshl_add_u32 v7, v7, 2, v54
    ds_write_b8 v7, v47 offset:16
    v_and_b32 v9, -4, v55
    v_lshl_add_u32 v10, v55, 2, v9
    ds_write_b32 v10, v51
    v_lshl_add_u32 v9, v9, 2, v55
    ds_write_b8_d16_hi v9, v47 offset:16
    s_add_u32 s47, s34, 0x1800000
    buffer_load_dwordx2 v[24:25], v1, s[16:19], s47 offen nt
    s_add_u32 s44, s34, 0x1a00000
    buffer_load_dwordx2 v[26:27], v1, s[16:19], s44 offen nt
    s_setprio 1
    v_and_b32 v7, -4, v60
    v_lshl_add_u32 v8, v60, 2, v7
    ds_write_b32 v8, v56
    v_lshl_add_u32 v7, v7, 2, v60
    ds_write_b8 v7, v64 offset:16
    v_and_b32 v9, -4, v61
    v_lshl_add_u32 v10, v61, 2, v9
    ds_write_b32 v10, v57
    v_lshl_add_u32 v9, v9, 2, v61
    ds_write_b8_d16_hi v9, v64 offset:16
    v_and_b32 v7, -4, v62
    v_lshl_add_u32 v8, v62, 2, v7
    ds_write_b32 v8, v58
    v_lshl_add_u32 v7, v7, 2, v62
    ds_write_b8 v7, v65 offset:16
    v_and_b32 v9, -4, v63
    v_lshl_add_u32 v10, v63, 2, v9
    ds_write_b32 v10, v59
    v_lshl_add_u32 v9, v9, 2, v63
    ds_write_b8_d16_hi v9, v65 offset:16
    s_add_u32 s45, s33, 0x3400000
    buffer_load_dwordx4 v[36:39], v0, s[8:11], s45 offen nt
    v_and_b32 v7, -4, v72
    v_lshl_add_u32 v8, v72, 2, v7
    ds_write_b32 v8, v68
    v_lshl_add_u32 v7, v7, 2, v72
    ds_write_b8 v7, v66 offset:16
    v_and_b32 v9, -4, v73
    v_lshl_add_u32 v10, v73, 2, v9
    ds_write_b32 v10, v69
    v_lshl_add_u32 v9, v9, 2, v73
    ds_write_b8_d16_hi v9, v66 offset:16
    v_and_b32 v7, -4, v74
    v_lshl_add_u32 v8, v74, 2, v7
    ds_write_b32 v8, v70
    v_lshl_add_u32 v7, v7, 2, v74
    ds_write_b8 v7, v67 offset:16
    v_and_b32 v9, -4, v75
    v_lshl_add_u32 v10, v75, 2, v9
    ds_write_b32 v10, v71
    v_lshl_add_u32 v9, v9, 2, v75
    ds_write_b8_d16_hi v9, v67 offset:16
    s_add_u32 s46, s33, 0x3400000
    buffer_load_dwordx4 v[40:43], v0, s[12:15], s46 offen nt
    s_add_u32 s47, s33, 0x3800000
    buffer_load_dwordx4 v[48:51], v0, s[8:11], s47 offen nt
    s_setprio 0
    v_and_b32 v7, -4, v80
    v_lshl_add_u32 v8, v80, 2, v7
    ds_write_b32 v8, v76
    v_lshl_add_u32 v7, v7, 2, v80
    ds_write_b8 v7, v84 offset:16
    v_and_b32 v9, -4, v81
    v_lshl_add_u32 v10, v81, 2, v9
    ds_write_b32 v10, v77
    v_lshl_add_u32 v9, v9, 2, v81
    ds_write_b8_d16_hi v9, v84 offset:16
    v_and_b32 v7, -4, v82
    v_lshl_add_u32 v8, v82, 2, v7
    ds_write_b32 v8, v78
    v_lshl_add_u32 v7, v7, 2, v82
    ds_write_b8 v7, v85 offset:16
    v_and_b32 v9, -4, v83
    v_lshl_add_u32 v10, v83, 2, v9
    ds_write_b32 v10, v79
    v_lshl_add_u32 v9, v9, 2, v83
    ds_write_b8_d16_hi v9, v85 offset:16
    s_add_u32 s44, s33, 0x3800000
    buffer_load_dwordx4 v[52:55], v0, s[12:15], s44 offen nt
    v_and_b32 v7, -4, v92
    v_lshl_add_u32 v8, v92, 2, v7
    ds_write_b32 v8, v88
    v_lshl_add_u32 v7, v7, 2, v92
    ds_write_b8 v7, v86 offset:16
    v_and_b32 v9, -4, v93
    v_lshl_add_u32 v10, v93, 2, v9
    ds_write_b32 v10, v89
    v_lshl_add_u32 v9, v9, 2, v93
    ds_write_b8_d16_hi v9, v86 offset:16
    v_and_b32 v7, -4, v94
    v_lshl_add_u32 v8, v94, 2, v7
    ds_write_b32 v8, v90
    v_lshl_add_u32 v7, v7, 2, v94
    ds_write_b8 v7, v87 offset:16
    v_and_b32 v9, -4, v95
    v_lshl_add_u32 v10, v95, 2, v9
    ds_write_b32 v10, v91
    v_lshl_add_u32 v9, v9, 2, v95
    ds_write_b8_d16_hi v9, v87 offset:16
    s_add_u32 s45, s34, 0x1c00000
    buffer_load_dwordx2 v[44:45], v1, s[16:19], s45 offen nt
    s_add_u32 s46, s34, 0x1e00000
    buffer_load_dwordx2 v[46:47], v1, s[16:19], s46 offen nt
    v_add_u32 v7, 0x10000, v0
    v_add_u32 v12, 0x20000, v0
    v_mov_b32 v8, 0
    v_mov_b32 v9, 0
    v_mov_b32 v10, 0
    v_mov_b32 v11, 0
    s_waitcnt lgkmcnt(0)
    s_barrier
    ds_read_b128 v[56:59], v0 offset:0
    ds_write_b128 v0, v[8:11]
    ds_read_b128 v[60:63], v0 offset:16384
    ds_read_b128 v[68:71], v0 offset:32768
    ds_read_b128 v[72:75], v0 offset:49152
    ds_read_b128 v[64:67], v7 offset:0
    ds_read_b128 v[76:79], v7 offset:16384
    ds_read_b128 v[80:83], v7 offset:32768
    ds_read_b128 v[88:91], v7 offset:49152
    ds_read_b128 v[92:95], v12 offset:0
    ds_read_b128 v[84:87], v12 offset:16384
    s_waitcnt lgkmcnt(0)
    s_barrier
    s_setprio 3
    s_add_u32 s47, s35, 0x0
    buffer_store_dwordx4 v[56:59], v0, s[20:23], s47 offen sc1
    s_add_u32 s44, s33, 0x3c00000
    s_nop 0
    buffer_load_dwordx4 v[56:59], v0, s[8:11], s44 offen nt
    s_add_u32 s45, s35, 0x4000
    buffer_store_dwordx4 v[60:63], v0, s[20:23], s45 offen sc1
    s_add_u32 s46, s33, 0x3c00000
    s_nop 0
    buffer_load_dwordx4 v[60:63], v0, s[12:15], s46 offen nt
    s_waitcnt vmcnt(22)
    v_lshlrev_b32 v7, 16, v108
    v_and_b32 v8, 0xffff0000, v108
    v_lshlrev_b32 v9, 16, v109
    v_and_b32 v10, 0xffff0000, v109
    v_mul_f32 v7, 0.15915494, v7
    v_mul_f32 v8, 0.15915494, v8
    v_mul_f32 v9, 0.15915494, v9
    v_mul_f32 v10, 0.15915494, v10
    v_mul_hi_u32_u24 v14, 429497, v96
    v_lshrrev_b32 v12, 3, v104
    v_cos_f32 v7, v7
    v_lshlrev_b16 v13, 3, v104
    v_mad_i32_i24 v11, v14, s55, v96
    v_bitop3_b32 v12, v6, v13, v12 bitop3:0xca
    v_lshl_add_u32 v11, v11, 17, s40
    v_lshlrev_b16 v14, 8, v14
    v_lshrrev_b32 v13, 2, v104
    v_add_u32 v96, v12, v11
    v_bitop3_b32 v104, v5, v13, v14 bitop3:0xea
    ds_add_u32 v104, v2
    v_mul_hi_u32_u24 v14, 429497, v97
    v_lshrrev_b32 v12, 3, v105
    v_cos_f32 v8, v8
    v_lshlrev_b16 v13, 3, v105
    v_mad_i32_i24 v11, v14, s55, v97
    v_bitop3_b32 v12, v6, v13, v12 bitop3:0xca
    v_lshl_add_u32 v11, v11, 17, s40
    v_lshlrev_b16 v14, 8, v14
    v_lshrrev_b32 v13, 2, v105
    v_add_u32 v97, v12, v11
    v_bitop3_b32 v105, v5, v13, v14 bitop3:0xea
    ds_add_u32 v105, v2
    v_cvt_pk_bf16_f32 v108, v7, v8
    v_perm_b32 v12, v108, v108, s41
    v_bitop3_b32 v96, v4, v12, v96 bitop3:0xca
    v_perm_b32 v13, v108, v108, s42
    v_bitop3_b32 v97, v4, v13, v97 bitop3:0xca
    v_mul_hi_u32_u24 v14, 429497, v98
    v_lshrrev_b32 v12, 3, v106
    v_cos_f32 v9, v9
    v_lshlrev_b16 v13, 3, v106
    v_mad_i32_i24 v11, v14, s55, v98
    v_bitop3_b32 v12, v6, v13, v12 bitop3:0xca
    v_lshl_add_u32 v11, v11, 17, s40
    v_lshlrev_b16 v14, 8, v14
    v_lshrrev_b32 v13, 2, v106
    v_add_u32 v98, v12, v11
    v_bitop3_b32 v106, v5, v13, v14 bitop3:0xea
    ds_add_u32 v106, v2
    v_mul_hi_u32_u24 v14, 429497, v99
    v_lshrrev_b32 v12, 3, v107
    v_cos_f32 v10, v10
    v_lshlrev_b16 v13, 3, v107
    v_mad_i32_i24 v11, v14, s55, v99
    v_bitop3_b32 v12, v6, v13, v12 bitop3:0xca
    v_lshl_add_u32 v11, v11, 17, s40
    v_lshlrev_b16 v14, 8, v14
    v_lshrrev_b32 v13, 2, v107
    v_add_u32 v99, v12, v11
    v_bitop3_b32 v107, v5, v13, v14 bitop3:0xea
    ds_add_u32 v107, v2
    v_cvt_pk_bf16_f32 v109, v9, v10
    v_perm_b32 v12, v109, v109, s41
    v_bitop3_b32 v98, v4, v12, v98 bitop3:0xca
    v_perm_b32 v13, v109, v109, s42
    v_bitop3_b32 v99, v4, v13, v99 bitop3:0xca
    s_waitcnt vmcnt(20)
    v_lshlrev_b32 v7, 16, v110
    v_and_b32 v8, 0xffff0000, v110
    v_lshlrev_b32 v9, 16, v111
    v_and_b32 v10, 0xffff0000, v111
    v_mul_f32 v7, 0.15915494, v7
    v_mul_f32 v8, 0.15915494, v8
    v_mul_f32 v9, 0.15915494, v9
    v_mul_f32 v10, 0.15915494, v10
    v_mul_hi_u32_u24 v14, 429497, v112
    v_lshrrev_b32 v12, 3, v100
    v_cos_f32 v7, v7
    v_lshlrev_b16 v13, 3, v100
    v_mad_i32_i24 v11, v14, s55, v112
    v_bitop3_b32 v12, v6, v13, v12 bitop3:0xca
    v_lshl_add_u32 v11, v11, 17, s40
    v_lshlrev_b16 v14, 8, v14
    v_lshrrev_b32 v13, 2, v100
    v_add_u32 v112, v12, v11
    v_bitop3_b32 v100, v5, v13, v14 bitop3:0xea
    ds_add_u32 v100, v2
    v_mul_hi_u32_u24 v14, 429497, v113
    v_lshrrev_b32 v12, 3, v101
    v_cos_f32 v8, v8
    v_lshlrev_b16 v13, 3, v101
    v_mad_i32_i24 v11, v14, s55, v113
    v_bitop3_b32 v12, v6, v13, v12 bitop3:0xca
    v_lshl_add_u32 v11, v11, 17, s40
    v_lshlrev_b16 v14, 8, v14
    v_lshrrev_b32 v13, 2, v101
    v_add_u32 v113, v12, v11
    v_bitop3_b32 v101, v5, v13, v14 bitop3:0xea
    ds_add_u32 v101, v2
    v_cvt_pk_bf16_f32 v110, v7, v8
    v_perm_b32 v12, v110, v110, s41
    v_bitop3_b32 v112, v4, v12, v112 bitop3:0xca
    v_perm_b32 v13, v110, v110, s42
    v_bitop3_b32 v113, v4, v13, v113 bitop3:0xca
    v_mul_hi_u32_u24 v14, 429497, v114
    v_lshrrev_b32 v12, 3, v102
    v_cos_f32 v9, v9
    v_lshlrev_b16 v13, 3, v102
    v_mad_i32_i24 v11, v14, s55, v114
    v_bitop3_b32 v12, v6, v13, v12 bitop3:0xca
    v_lshl_add_u32 v11, v11, 17, s40
    v_lshlrev_b16 v14, 8, v14
    v_lshrrev_b32 v13, 2, v102
    v_add_u32 v114, v12, v11
    v_bitop3_b32 v102, v5, v13, v14 bitop3:0xea
    ds_add_u32 v102, v2
    v_mul_hi_u32_u24 v14, 429497, v115
    v_lshrrev_b32 v12, 3, v103
    v_cos_f32 v10, v10
    v_lshlrev_b16 v13, 3, v103
    v_mad_i32_i24 v11, v14, s55, v115
    v_bitop3_b32 v12, v6, v13, v12 bitop3:0xca
    v_lshl_add_u32 v11, v11, 17, s40
    v_lshlrev_b16 v14, 8, v14
    v_lshrrev_b32 v13, 2, v103
    v_add_u32 v115, v12, v11
    v_bitop3_b32 v103, v5, v13, v14 bitop3:0xea
    ds_add_u32 v103, v2
    v_cvt_pk_bf16_f32 v111, v9, v10
    v_perm_b32 v12, v111, v111, s41
    v_bitop3_b32 v114, v4, v12, v114 bitop3:0xca
    v_perm_b32 v13, v111, v111, s42
    v_bitop3_b32 v115, v4, v13, v115 bitop3:0xca
    s_setprio 2
    s_waitcnt vmcnt(16)
    v_lshlrev_b32 v7, 16, v124
    v_and_b32 v8, 0xffff0000, v124
    v_lshlrev_b32 v9, 16, v125
    v_and_b32 v10, 0xffff0000, v125
    v_mul_f32 v7, 0.15915494, v7
    v_mul_f32 v8, 0.15915494, v8
    v_mul_f32 v9, 0.15915494, v9
    v_mul_f32 v10, 0.15915494, v10
    v_mul_hi_u32_u24 v14, 429497, v116
    v_lshrrev_b32 v12, 3, v120
    v_cos_f32 v7, v7
    v_lshlrev_b16 v13, 3, v120
    v_mad_i32_i24 v11, v14, s55, v116
    v_bitop3_b32 v12, v6, v13, v12 bitop3:0xca
    v_lshl_add_u32 v11, v11, 17, s40
    v_lshlrev_b16 v14, 8, v14
    v_lshrrev_b32 v13, 2, v120
    v_add_u32 v116, v12, v11
    v_bitop3_b32 v120, v5, v13, v14 bitop3:0xea
    ds_add_u32 v120, v2
    v_mul_hi_u32_u24 v14, 429497, v117
    v_lshrrev_b32 v12, 3, v121
    v_cos_f32 v8, v8
    v_lshlrev_b16 v13, 3, v121
    v_mad_i32_i24 v11, v14, s55, v117
    v_bitop3_b32 v12, v6, v13, v12 bitop3:0xca
    v_lshl_add_u32 v11, v11, 17, s40
    v_lshlrev_b16 v14, 8, v14
    v_lshrrev_b32 v13, 2, v121
    v_add_u32 v117, v12, v11
    v_bitop3_b32 v121, v5, v13, v14 bitop3:0xea
    ds_add_u32 v121, v2
    v_cvt_pk_bf16_f32 v124, v7, v8
    v_perm_b32 v12, v124, v124, s41
    v_bitop3_b32 v116, v4, v12, v116 bitop3:0xca
    v_perm_b32 v13, v124, v124, s42
    v_bitop3_b32 v117, v4, v13, v117 bitop3:0xca
    v_mul_hi_u32_u24 v14, 429497, v118
    v_lshrrev_b32 v12, 3, v122
    v_cos_f32 v9, v9
    v_lshlrev_b16 v13, 3, v122
    v_mad_i32_i24 v11, v14, s55, v118
    v_bitop3_b32 v12, v6, v13, v12 bitop3:0xca
    v_lshl_add_u32 v11, v11, 17, s40
    v_lshlrev_b16 v14, 8, v14
    v_lshrrev_b32 v13, 2, v122
    v_add_u32 v118, v12, v11
    v_bitop3_b32 v122, v5, v13, v14 bitop3:0xea
    ds_add_u32 v122, v2
    v_mul_hi_u32_u24 v14, 429497, v119
    v_lshrrev_b32 v12, 3, v123
    v_cos_f32 v10, v10
    v_lshlrev_b16 v13, 3, v123
    v_mad_i32_i24 v11, v14, s55, v119
    v_bitop3_b32 v12, v6, v13, v12 bitop3:0xca
    v_lshl_add_u32 v11, v11, 17, s40
    v_lshlrev_b16 v14, 8, v14
    v_lshrrev_b32 v13, 2, v123
    v_add_u32 v119, v12, v11
    v_bitop3_b32 v123, v5, v13, v14 bitop3:0xea
    ds_add_u32 v123, v2
    v_cvt_pk_bf16_f32 v125, v9, v10
    v_perm_b32 v12, v125, v125, s41
    v_bitop3_b32 v118, v4, v12, v118 bitop3:0xca
    v_perm_b32 v13, v125, v125, s42
    v_bitop3_b32 v119, v4, v13, v119 bitop3:0xca
    s_add_u32 s47, s35, 0x8000
    buffer_store_dwordx4 v[68:71], v0, s[20:23], s47 offen sc1
    s_add_u32 s44, s33, 0x4000000
    s_nop 0
    buffer_load_dwordx4 v[68:71], v0, s[8:11], s44 offen nt
    s_waitcnt vmcnt(16)
    v_lshlrev_b32 v7, 16, v126
    v_and_b32 v8, 0xffff0000, v126
    v_lshlrev_b32 v9, 16, v127
    v_and_b32 v10, 0xffff0000, v127
    v_mul_f32 v7, 0.15915494, v7
    v_mul_f32 v8, 0.15915494, v8
    v_mul_f32 v9, 0.15915494, v9
    v_mul_f32 v10, 0.15915494, v10
    v_mul_hi_u32_u24 v14, 429497, v16
    v_lshrrev_b32 v12, 3, v20
    v_cos_f32 v7, v7
    v_lshlrev_b16 v13, 3, v20
    v_mad_i32_i24 v11, v14, s55, v16
    v_bitop3_b32 v12, v6, v13, v12 bitop3:0xca
    v_lshl_add_u32 v11, v11, 17, s40
    v_lshlrev_b16 v14, 8, v14
    v_lshrrev_b32 v13, 2, v20
    v_add_u32 v16, v12, v11
    v_bitop3_b32 v20, v5, v13, v14 bitop3:0xea
    ds_add_u32 v20, v2
    v_mul_hi_u32_u24 v14, 429497, v17
    v_lshrrev_b32 v12, 3, v21
    v_cos_f32 v8, v8
    v_lshlrev_b16 v13, 3, v21
    v_mad_i32_i24 v11, v14, s55, v17
    v_bitop3_b32 v12, v6, v13, v12 bitop3:0xca
    v_lshl_add_u32 v11, v11, 17, s40
    v_lshlrev_b16 v14, 8, v14
    v_lshrrev_b32 v13, 2, v21
    v_add_u32 v17, v12, v11
    v_bitop3_b32 v21, v5, v13, v14 bitop3:0xea
    ds_add_u32 v21, v2
    v_cvt_pk_bf16_f32 v126, v7, v8
    v_perm_b32 v12, v126, v126, s41
    v_bitop3_b32 v16, v4, v12, v16 bitop3:0xca
    v_perm_b32 v13, v126, v126, s42
    v_bitop3_b32 v17, v4, v13, v17 bitop3:0xca
    v_mul_hi_u32_u24 v14, 429497, v18
    v_lshrrev_b32 v12, 3, v22
    v_cos_f32 v9, v9
    v_lshlrev_b16 v13, 3, v22
    v_mad_i32_i24 v11, v14, s55, v18
    v_bitop3_b32 v12, v6, v13, v12 bitop3:0xca
    v_lshl_add_u32 v11, v11, 17, s40
    v_lshlrev_b16 v14, 8, v14
    v_lshrrev_b32 v13, 2, v22
    v_add_u32 v18, v12, v11
    v_bitop3_b32 v22, v5, v13, v14 bitop3:0xea
    ds_add_u32 v22, v2
    v_mul_hi_u32_u24 v14, 429497, v19
    v_lshrrev_b32 v12, 3, v23
    v_cos_f32 v10, v10
    v_lshlrev_b16 v13, 3, v23
    v_mad_i32_i24 v11, v14, s55, v19
    v_bitop3_b32 v12, v6, v13, v12 bitop3:0xca
    v_lshl_add_u32 v11, v11, 17, s40
    v_lshlrev_b16 v14, 8, v14
    v_lshrrev_b32 v13, 2, v23
    v_add_u32 v19, v12, v11
    v_bitop3_b32 v23, v5, v13, v14 bitop3:0xea
    ds_add_u32 v23, v2
    v_cvt_pk_bf16_f32 v127, v9, v10
    v_perm_b32 v12, v127, v127, s41
    v_bitop3_b32 v18, v4, v12, v18 bitop3:0xca
    v_perm_b32 v13, v127, v127, s42
    v_bitop3_b32 v19, v4, v13, v19 bitop3:0xca
    s_setprio 1
    s_waitcnt vmcnt(12)
    v_lshlrev_b32 v7, 16, v24
    v_and_b32 v8, 0xffff0000, v24
    v_lshlrev_b32 v9, 16, v25
    v_and_b32 v10, 0xffff0000, v25
    v_mul_f32 v7, 0.15915494, v7
    v_mul_f32 v8, 0.15915494, v8
    v_mul_f32 v9, 0.15915494, v9
    v_mul_f32 v10, 0.15915494, v10
    v_mul_hi_u32_u24 v14, 429497, v28
    v_lshrrev_b32 v12, 3, v32
    v_cos_f32 v7, v7
    v_lshlrev_b16 v13, 3, v32
    v_mad_i32_i24 v11, v14, s55, v28
    v_bitop3_b32 v12, v6, v13, v12 bitop3:0xca
    v_lshl_add_u32 v11, v11, 17, s40
    v_lshlrev_b16 v14, 8, v14
    v_lshrrev_b32 v13, 2, v32
    v_add_u32 v28, v12, v11
    v_bitop3_b32 v32, v5, v13, v14 bitop3:0xea
    ds_add_u32 v32, v2
    v_mul_hi_u32_u24 v14, 429497, v29
    v_lshrrev_b32 v12, 3, v33
    v_cos_f32 v8, v8
    v_lshlrev_b16 v13, 3, v33
    v_mad_i32_i24 v11, v14, s55, v29
    v_bitop3_b32 v12, v6, v13, v12 bitop3:0xca
    v_lshl_add_u32 v11, v11, 17, s40
    v_lshlrev_b16 v14, 8, v14
    v_lshrrev_b32 v13, 2, v33
    v_add_u32 v29, v12, v11
    v_bitop3_b32 v33, v5, v13, v14 bitop3:0xea
    ds_add_u32 v33, v2
    v_cvt_pk_bf16_f32 v24, v7, v8
    v_perm_b32 v12, v24, v24, s41
    v_bitop3_b32 v28, v4, v12, v28 bitop3:0xca
    v_perm_b32 v13, v24, v24, s42
    v_bitop3_b32 v29, v4, v13, v29 bitop3:0xca
    v_mul_hi_u32_u24 v14, 429497, v30
    v_lshrrev_b32 v12, 3, v34
    v_cos_f32 v9, v9
    v_lshlrev_b16 v13, 3, v34
    v_mad_i32_i24 v11, v14, s55, v30
    v_bitop3_b32 v12, v6, v13, v12 bitop3:0xca
    v_lshl_add_u32 v11, v11, 17, s40
    v_lshlrev_b16 v14, 8, v14
    v_lshrrev_b32 v13, 2, v34
    v_add_u32 v30, v12, v11
    v_bitop3_b32 v34, v5, v13, v14 bitop3:0xea
    ds_add_u32 v34, v2
    v_mul_hi_u32_u24 v14, 429497, v31
    v_lshrrev_b32 v12, 3, v35
    v_cos_f32 v10, v10
    v_lshlrev_b16 v13, 3, v35
    v_mad_i32_i24 v11, v14, s55, v31
    v_bitop3_b32 v12, v6, v13, v12 bitop3:0xca
    v_lshl_add_u32 v11, v11, 17, s40
    v_lshlrev_b16 v14, 8, v14
    v_lshrrev_b32 v13, 2, v35
    v_add_u32 v31, v12, v11
    v_bitop3_b32 v35, v5, v13, v14 bitop3:0xea
    ds_add_u32 v35, v2
    v_cvt_pk_bf16_f32 v25, v9, v10
    v_perm_b32 v12, v25, v25, s41
    v_bitop3_b32 v30, v4, v12, v30 bitop3:0xca
    v_perm_b32 v13, v25, v25, s42
    v_bitop3_b32 v31, v4, v13, v31 bitop3:0xca
    s_waitcnt vmcnt(10)
    v_lshlrev_b32 v7, 16, v26
    v_and_b32 v8, 0xffff0000, v26
    v_lshlrev_b32 v9, 16, v27
    v_and_b32 v10, 0xffff0000, v27
    v_mul_f32 v7, 0.15915494, v7
    v_mul_f32 v8, 0.15915494, v8
    v_mul_f32 v9, 0.15915494, v9
    v_mul_f32 v10, 0.15915494, v10
    v_mul_hi_u32_u24 v14, 429497, v36
    v_lshrrev_b32 v12, 3, v40
    v_cos_f32 v7, v7
    v_lshlrev_b16 v13, 3, v40
    v_mad_i32_i24 v11, v14, s55, v36
    v_bitop3_b32 v12, v6, v13, v12 bitop3:0xca
    v_lshl_add_u32 v11, v11, 17, s40
    v_lshlrev_b16 v14, 8, v14
    v_lshrrev_b32 v13, 2, v40
    v_add_u32 v36, v12, v11
    v_bitop3_b32 v40, v5, v13, v14 bitop3:0xea
    ds_add_u32 v40, v2
    v_mul_hi_u32_u24 v14, 429497, v37
    v_lshrrev_b32 v12, 3, v41
    v_cos_f32 v8, v8
    v_lshlrev_b16 v13, 3, v41
    v_mad_i32_i24 v11, v14, s55, v37
    v_bitop3_b32 v12, v6, v13, v12 bitop3:0xca
    v_lshl_add_u32 v11, v11, 17, s40
    v_lshlrev_b16 v14, 8, v14
    v_lshrrev_b32 v13, 2, v41
    v_add_u32 v37, v12, v11
    v_bitop3_b32 v41, v5, v13, v14 bitop3:0xea
    ds_add_u32 v41, v2
    v_cvt_pk_bf16_f32 v26, v7, v8
    v_perm_b32 v12, v26, v26, s41
    v_bitop3_b32 v36, v4, v12, v36 bitop3:0xca
    v_perm_b32 v13, v26, v26, s42
    v_bitop3_b32 v37, v4, v13, v37 bitop3:0xca
    v_mul_hi_u32_u24 v14, 429497, v38
    v_lshrrev_b32 v12, 3, v42
    v_cos_f32 v9, v9
    v_lshlrev_b16 v13, 3, v42
    v_mad_i32_i24 v11, v14, s55, v38
    v_bitop3_b32 v12, v6, v13, v12 bitop3:0xca
    v_lshl_add_u32 v11, v11, 17, s40
    v_lshlrev_b16 v14, 8, v14
    v_lshrrev_b32 v13, 2, v42
    v_add_u32 v38, v12, v11
    v_bitop3_b32 v42, v5, v13, v14 bitop3:0xea
    ds_add_u32 v42, v2
    v_mul_hi_u32_u24 v14, 429497, v39
    v_lshrrev_b32 v12, 3, v43
    v_cos_f32 v10, v10
    v_lshlrev_b16 v13, 3, v43
    v_mad_i32_i24 v11, v14, s55, v39
    v_bitop3_b32 v12, v6, v13, v12 bitop3:0xca
    v_lshl_add_u32 v11, v11, 17, s40
    v_lshlrev_b16 v14, 8, v14
    v_lshrrev_b32 v13, 2, v43
    v_add_u32 v39, v12, v11
    v_bitop3_b32 v43, v5, v13, v14 bitop3:0xea
    ds_add_u32 v43, v2
    v_cvt_pk_bf16_f32 v27, v9, v10
    v_perm_b32 v12, v27, v27, s41
    v_bitop3_b32 v38, v4, v12, v38 bitop3:0xca
    v_perm_b32 v13, v27, v27, s42
    v_bitop3_b32 v39, v4, v13, v39 bitop3:0xca
    s_setprio 0
    s_add_u32 s45, s35, 0xc000
    buffer_store_dwordx4 v[72:75], v0, s[20:23], s45 offen sc1
    s_add_u32 s46, s33, 0x4000000
    s_nop 0
    buffer_load_dwordx4 v[72:75], v0, s[12:15], s46 offen nt
    s_waitcnt vmcnt(8)
    v_lshlrev_b32 v7, 16, v44
    v_and_b32 v8, 0xffff0000, v44
    v_lshlrev_b32 v9, 16, v45
    v_and_b32 v10, 0xffff0000, v45
    v_mul_f32 v7, 0.15915494, v7
    v_mul_f32 v8, 0.15915494, v8
    v_mul_f32 v9, 0.15915494, v9
    v_mul_f32 v10, 0.15915494, v10
    v_mul_hi_u32_u24 v14, 429497, v48
    v_lshrrev_b32 v12, 3, v52
    v_cos_f32 v7, v7
    v_lshlrev_b16 v13, 3, v52
    v_mad_i32_i24 v11, v14, s55, v48
    v_bitop3_b32 v12, v6, v13, v12 bitop3:0xca
    v_lshl_add_u32 v11, v11, 17, s40
    v_lshlrev_b16 v14, 8, v14
    v_lshrrev_b32 v13, 2, v52
    v_add_u32 v48, v12, v11
    v_bitop3_b32 v52, v5, v13, v14 bitop3:0xea
    ds_add_u32 v52, v2
    v_mul_hi_u32_u24 v14, 429497, v49
    v_lshrrev_b32 v12, 3, v53
    v_cos_f32 v8, v8
    v_lshlrev_b16 v13, 3, v53
    v_mad_i32_i24 v11, v14, s55, v49
    v_bitop3_b32 v12, v6, v13, v12 bitop3:0xca
    v_lshl_add_u32 v11, v11, 17, s40
    v_lshlrev_b16 v14, 8, v14
    v_lshrrev_b32 v13, 2, v53
    v_add_u32 v49, v12, v11
    v_bitop3_b32 v53, v5, v13, v14 bitop3:0xea
    ds_add_u32 v53, v2
    v_cvt_pk_bf16_f32 v44, v7, v8
    v_perm_b32 v12, v44, v44, s41
    v_bitop3_b32 v48, v4, v12, v48 bitop3:0xca
    v_perm_b32 v13, v44, v44, s42
    v_bitop3_b32 v49, v4, v13, v49 bitop3:0xca
    v_mul_hi_u32_u24 v14, 429497, v50
    v_lshrrev_b32 v12, 3, v54
    v_cos_f32 v9, v9
    v_lshlrev_b16 v13, 3, v54
    v_mad_i32_i24 v11, v14, s55, v50
    v_bitop3_b32 v12, v6, v13, v12 bitop3:0xca
    v_lshl_add_u32 v11, v11, 17, s40
    v_lshlrev_b16 v14, 8, v14
    v_lshrrev_b32 v13, 2, v54
    v_add_u32 v50, v12, v11
    v_bitop3_b32 v54, v5, v13, v14 bitop3:0xea
    ds_add_u32 v54, v2
    v_mul_hi_u32_u24 v14, 429497, v51
    v_lshrrev_b32 v12, 3, v55
    v_cos_f32 v10, v10
    v_lshlrev_b16 v13, 3, v55
    v_mad_i32_i24 v11, v14, s55, v51
    v_bitop3_b32 v12, v6, v13, v12 bitop3:0xca
    v_lshl_add_u32 v11, v11, 17, s40
    v_lshlrev_b16 v14, 8, v14
    v_lshrrev_b32 v13, 2, v55
    v_add_u32 v51, v12, v11
    v_bitop3_b32 v55, v5, v13, v14 bitop3:0xea
    ds_add_u32 v55, v2
    v_cvt_pk_bf16_f32 v45, v9, v10
    v_perm_b32 v12, v45, v45, s41
    v_bitop3_b32 v50, v4, v12, v50 bitop3:0xca
    v_perm_b32 v13, v45, v45, s42
    v_bitop3_b32 v51, v4, v13, v51 bitop3:0xca
    s_waitcnt vmcnt(4)
    v_lshlrev_b32 v7, 16, v46
    v_and_b32 v8, 0xffff0000, v46
    v_lshlrev_b32 v9, 16, v47
    v_and_b32 v10, 0xffff0000, v47
    v_mul_f32 v7, 0.15915494, v7
    v_mul_f32 v8, 0.15915494, v8
    v_mul_f32 v9, 0.15915494, v9
    v_mul_f32 v10, 0.15915494, v10
    v_mul_hi_u32_u24 v14, 429497, v56
    v_lshrrev_b32 v12, 3, v60
    v_cos_f32 v7, v7
    v_lshlrev_b16 v13, 3, v60
    v_mad_i32_i24 v11, v14, s55, v56
    v_bitop3_b32 v12, v6, v13, v12 bitop3:0xca
    v_lshl_add_u32 v11, v11, 17, s40
    v_lshlrev_b16 v14, 8, v14
    v_lshrrev_b32 v13, 2, v60
    v_add_u32 v56, v12, v11
    v_bitop3_b32 v60, v5, v13, v14 bitop3:0xea
    ds_add_u32 v60, v2
    v_mul_hi_u32_u24 v14, 429497, v57
    v_lshrrev_b32 v12, 3, v61
    v_cos_f32 v8, v8
    v_lshlrev_b16 v13, 3, v61
    v_mad_i32_i24 v11, v14, s55, v57
    v_bitop3_b32 v12, v6, v13, v12 bitop3:0xca
    v_lshl_add_u32 v11, v11, 17, s40
    v_lshlrev_b16 v14, 8, v14
    v_lshrrev_b32 v13, 2, v61
    v_add_u32 v57, v12, v11
    v_bitop3_b32 v61, v5, v13, v14 bitop3:0xea
    ds_add_u32 v61, v2
    v_cvt_pk_bf16_f32 v46, v7, v8
    v_perm_b32 v12, v46, v46, s41
    v_bitop3_b32 v56, v4, v12, v56 bitop3:0xca
    v_perm_b32 v13, v46, v46, s42
    v_bitop3_b32 v57, v4, v13, v57 bitop3:0xca
    v_mul_hi_u32_u24 v14, 429497, v58
    v_lshrrev_b32 v12, 3, v62
    v_cos_f32 v9, v9
    v_lshlrev_b16 v13, 3, v62
    v_mad_i32_i24 v11, v14, s55, v58
    v_bitop3_b32 v12, v6, v13, v12 bitop3:0xca
    v_lshl_add_u32 v11, v11, 17, s40
    v_lshlrev_b16 v14, 8, v14
    v_lshrrev_b32 v13, 2, v62
    v_add_u32 v58, v12, v11
    v_bitop3_b32 v62, v5, v13, v14 bitop3:0xea
    ds_add_u32 v62, v2
    v_mul_hi_u32_u24 v14, 429497, v59
    v_lshrrev_b32 v12, 3, v63
    v_cos_f32 v10, v10
    v_lshlrev_b16 v13, 3, v63
    v_mad_i32_i24 v11, v14, s55, v59
    v_bitop3_b32 v12, v6, v13, v12 bitop3:0xca
    v_lshl_add_u32 v11, v11, 17, s40
    v_lshlrev_b16 v14, 8, v14
    v_lshrrev_b32 v13, 2, v63
    v_add_u32 v59, v12, v11
    v_bitop3_b32 v63, v5, v13, v14 bitop3:0xea
    ds_add_u32 v63, v2
    v_cvt_pk_bf16_f32 v47, v9, v10
    v_perm_b32 v12, v47, v47, s41
    v_bitop3_b32 v58, v4, v12, v58 bitop3:0xca
    v_perm_b32 v13, v47, v47, s42
    v_bitop3_b32 v59, v4, v13, v59 bitop3:0xca
    v_lshrrev_b32 v8, 2, v0
    v_and_b32 v7, 0x3c00, v0
    v_bitop3_b32 v7, v5, v8, v7 bitop3:0xea
    s_waitcnt lgkmcnt(0)
    s_barrier
    ds_read2st64_b32 v[8:9], v7 offset0:0 offset1:1
    ds_read2st64_b32 v[10:11], v7 offset0:2 offset1:3
    s_add_u32 s47, s35, 0x10000
    buffer_store_dwordx4 v[64:67], v0, s[20:23], s47 offen sc1
    s_add_u32 s44, s34, 0x2000000
    s_nop 0
    buffer_load_dwordx2 v[64:65], v1, s[16:19], s44 offen nt
    s_add_u32 s45, s34, 0x2200000
    buffer_load_dwordx2 v[66:67], v1, s[16:19], s45 offen nt
    s_waitcnt lgkmcnt(0)
    v_lshl_or_b32 v12, v9, 16, v8
    v_lshl_or_b32 v13, v11, 16, v10
    v_mov_b32 v14, v12
    v_mov_b32 v15, v13
    s_nop 0
    v_add_u32_dpp v14, v14, v14 row_shr:1 row_mask:0xf bank_mask:0xf bound_ctrl:1
    v_add_u32_dpp v15, v15, v15 row_shr:1 row_mask:0xf bank_mask:0xf bound_ctrl:1
    s_nop 0
    v_add_u32_dpp v14, v14, v14 row_shr:2 row_mask:0xf bank_mask:0xf bound_ctrl:1
    v_add_u32_dpp v15, v15, v15 row_shr:2 row_mask:0xf bank_mask:0xf bound_ctrl:1
    s_nop 0
    v_add_u32_dpp v14, v14, v14 row_shr:4 row_mask:0xf bank_mask:0xf bound_ctrl:1
    v_add_u32_dpp v15, v15, v15 row_shr:4 row_mask:0xf bank_mask:0xf bound_ctrl:1
    s_nop 0
    v_add_u32_dpp v14, v14, v14 row_shr:8 row_mask:0xf bank_mask:0xf bound_ctrl:1
    v_add_u32_dpp v15, v15, v15 row_shr:8 row_mask:0xf bank_mask:0xf bound_ctrl:1
    s_nop 0
    v_add_u32_dpp v14, v14, v14 row_bcast:15 row_mask:0xa bank_mask:0xf
    v_add_u32_dpp v15, v15, v15 row_bcast:15 row_mask:0xa bank_mask:0xf
    s_nop 0
    v_add_u32_dpp v14, v14, v14 row_bcast:31 row_mask:0xc bank_mask:0xf
    v_add_u32_dpp v15, v15, v15 row_bcast:31 row_mask:0xc bank_mask:0xf
    v_readlane_b32 s48, v14, 63
    v_readlane_b32 s49, v15, 63
    s_lshl_b32 s54, s32, 2
    v_mov_b32 v8, s54
    s_and_b32 s50, s48, 0xffff
    s_lshr_b32 s51, s48, 16
    s_and_b32 s52, s49, 0xffff
    s_lshr_b32 s53, s49, 16
    s_add_u32 s51, s51, s50
    s_add_u32 s52, s52, s51
    s_add_u32 s53, s53, s52
    v_mov_b32 v9, s53
    s_mov_b64 exec, 1
    ds_write_b32 v8, v9 offset:16384
    s_mov_b64 exec, -1
    v_and_b32 v8, 60, v7
    s_waitcnt lgkmcnt(0)
    s_barrier
    ds_read_b32 v9, v8 offset:16384
    s_waitcnt lgkmcnt(0)
    v_add_u32_dpp v9, v9, v9 row_shr:1 row_mask:0xf bank_mask:0xf bound_ctrl:1
    s_nop 1
    v_add_u32_dpp v9, v9, v9 row_shr:2 row_mask:0xf bank_mask:0xf bound_ctrl:1
    s_nop 1
    v_add_u32_dpp v9, v9, v9 row_shr:4 row_mask:0xf bank_mask:0xf bound_ctrl:1
    s_nop 1
    v_add_u32_dpp v9, v9, v9 row_shr:8 row_mask:0xf bank_mask:0xf bound_ctrl:1
    s_nop 0
    v_readlane_b32 s54, v9, s32
    s_sub_u32 s54, s54, s53
    s_add_u32 s50, s50, s54
    s_add_u32 s51, s51, s54
    s_add_u32 s52, s52, s54
    s_pack_ll_b32_b16 s48, s54, s50
    s_pack_ll_b32_b16 s49, s51, s52
    v_add_u32 v14, s48, v14
    v_add_u32 v15, s49, v15
    v_sub_u32 v12, v14, v12
    v_sub_u32 v13, v15, v13
    v_and_b32 v8, 0xffff, v12
    v_lshrrev_b32 v9, 16, v12
    v_and_b32 v10, 0xffff, v13
    v_lshrrev_b32 v11, 16, v13
    ds_write2st64_b32 v7, v8, v9 offset0:0 offset1:1
    ds_write2st64_b32 v7, v10, v11 offset0:2 offset1:3
    v_and_b32 v8, 0x3f0, v0
    v_lshl_add_u32 v8, v8, 1, s36
    ds_write_b64 v8, v[12:13] offset:20480
    s_bitset0_b64 exec, 63
    s_not_b64 exec, exec
    ds_write_b64 v8, v[14:15] offset:20512
    s_mov_b64 exec, -1
    s_waitcnt lgkmcnt(0)
    s_barrier
    s_setprio 3
    ds_add_rtn_u32 v104, v104, v2
    ds_add_rtn_u32 v105, v105, v2
    ds_add_rtn_u32 v106, v106, v2
    ds_add_rtn_u32 v107, v107, v2
    ds_read_b128 v[12:15], v0 offset:20480
    v_cmp_gt_u32 vcc, 8448, v0
    ds_add_rtn_u32 v100, v100, v2
    ds_add_rtn_u32 v101, v101, v2
    ds_add_rtn_u32 v102, v102, v2
    ds_add_rtn_u32 v103, v103, v2
    s_setprio 2
    ds_add_rtn_u32 v120, v120, v2
    ds_add_rtn_u32 v121, v121, v2
    ds_add_rtn_u32 v122, v122, v2
    ds_add_rtn_u32 v123, v123, v2
    s_waitcnt lgkmcnt(8)
    s_cbranch_vccz L1_p2
    s_add_u32 s46, s35, 0x2a40000
    s_mov_b64 exec, vcc
    buffer_store_dwordx4 v[12:15], v0, s[24:27], s46 offen sc1
    s_mov_b64 exec, -1
L1_p2:
    s_add_u32 s47, s35, 0x14000
    buffer_store_dwordx4 v[76:79], v0, s[20:23], s47 offen sc1
    s_add_u32 s44, s33, 0x4400000
    s_nop 0
    buffer_load_dwordx4 v[76:79], v0, s[8:11], s44 offen nt
    ds_add_rtn_u32 v20, v20, v2
    ds_add_rtn_u32 v21, v21, v2
    ds_add_rtn_u32 v22, v22, v2
    ds_add_rtn_u32 v23, v23, v2
    s_setprio 1
    ds_add_rtn_u32 v32, v32, v2
    ds_add_rtn_u32 v33, v33, v2
    ds_add_rtn_u32 v34, v34, v2
    ds_add_rtn_u32 v35, v35, v2
    ds_add_rtn_u32 v40, v40, v2
    ds_add_rtn_u32 v41, v41, v2
    ds_add_rtn_u32 v42, v42, v2
    ds_add_rtn_u32 v43, v43, v2
    s_add_u32 s45, s35, 0x18000
    buffer_store_dwordx4 v[80:83], v0, s[20:23], s45 offen sc1
    s_add_u32 s46, s33, 0x4400000
    s_nop 0
    buffer_load_dwordx4 v[80:83], v0, s[12:15], s46 offen nt
    s_setprio 0
    ds_add_rtn_u32 v52, v52, v2
    ds_add_rtn_u32 v53, v53, v2
    ds_add_rtn_u32 v54, v54, v2
    ds_add_rtn_u32 v55, v55, v2
    ds_add_rtn_u32 v60, v60, v2
    ds_add_rtn_u32 v61, v61, v2
    ds_add_rtn_u32 v62, v62, v2
    ds_add_rtn_u32 v63, v63, v2
    s_waitcnt lgkmcnt(0)
    s_barrier
    s_setprio 3
    v_and_b32 v7, -4, v104
    v_lshl_add_u32 v8, v104, 2, v7
    ds_write_b32 v8, v96
    v_lshl_add_u32 v7, v7, 2, v104
    ds_write_b8 v7, v108 offset:16
    v_and_b32 v9, -4, v105
    v_lshl_add_u32 v10, v105, 2, v9
    ds_write_b32 v10, v97
    v_lshl_add_u32 v9, v9, 2, v105
    ds_write_b8_d16_hi v9, v108 offset:16
    v_and_b32 v7, -4, v106
    v_lshl_add_u32 v8, v106, 2, v7
    ds_write_b32 v8, v98
    v_lshl_add_u32 v7, v7, 2, v106
    ds_write_b8 v7, v109 offset:16
    v_and_b32 v9, -4, v107
    v_lshl_add_u32 v10, v107, 2, v9
    ds_write_b32 v10, v99
    v_lshl_add_u32 v9, v9, 2, v107
    ds_write_b8_d16_hi v9, v109 offset:16
    s_add_u32 s47, s35, 0x1c000
    buffer_store_dwordx4 v[88:91], v0, s[20:23], s47 offen sc1
    s_add_u32 s44, s33, 0x4800000
    buffer_load_dwordx4 v[96:99], v0, s[8:11], s44 offen nt
    s_add_u32 s45, s33, 0x4800000
    buffer_load_dwordx4 v[104:107], v0, s[12:15], s45 offen nt
    v_and_b32 v7, -4, v100
    v_lshl_add_u32 v8, v100, 2, v7
    ds_write_b32 v8, v112
    v_lshl_add_u32 v7, v7, 2, v100
    ds_write_b8 v7, v110 offset:16
    v_and_b32 v9, -4, v101
    v_lshl_add_u32 v10, v101, 2, v9
    ds_write_b32 v10, v113
    v_lshl_add_u32 v9, v9, 2, v101
    ds_write_b8_d16_hi v9, v110 offset:16
    v_and_b32 v7, -4, v102
    v_lshl_add_u32 v8, v102, 2, v7
    ds_write_b32 v8, v114
    v_lshl_add_u32 v7, v7, 2, v102
    ds_write_b8 v7, v111 offset:16
    v_and_b32 v9, -4, v103
    v_lshl_add_u32 v10, v103, 2, v9
    ds_write_b32 v10, v115
    v_lshl_add_u32 v9, v9, 2, v103
    ds_write_b8_d16_hi v9, v111 offset:16
    s_add_u32 s46, s34, 0x2400000
    buffer_load_dwordx2 v[88:89], v1, s[16:19], s46 offen nt
    s_add_u32 s47, s34, 0x2600000
    buffer_load_dwordx2 v[90:91], v1, s[16:19], s47 offen nt
    s_add_u32 s44, s33, 0x4c00000
    buffer_load_dwordx4 v[112:115], v0, s[8:11], s44 offen nt
    s_setprio 2
    v_and_b32 v7, -4, v120
    v_lshl_add_u32 v8, v120, 2, v7
    ds_write_b32 v8, v116
    v_lshl_add_u32 v7, v7, 2, v120
    ds_write_b8 v7, v124 offset:16
    v_and_b32 v9, -4, v121
    v_lshl_add_u32 v10, v121, 2, v9
    ds_write_b32 v10, v117
    v_lshl_add_u32 v9, v9, 2, v121
    ds_write_b8_d16_hi v9, v124 offset:16
    v_and_b32 v7, -4, v122
    v_lshl_add_u32 v8, v122, 2, v7
    ds_write_b32 v8, v118
    v_lshl_add_u32 v7, v7, 2, v122
    ds_write_b8 v7, v125 offset:16
    v_and_b32 v9, -4, v123
    v_lshl_add_u32 v10, v123, 2, v9
    ds_write_b32 v10, v119
    v_lshl_add_u32 v9, v9, 2, v123
    ds_write_b8_d16_hi v9, v125 offset:16
    s_add_u32 s45, s35, 0x20000
    buffer_store_dwordx4 v[92:95], v0, s[20:23], s45 offen sc1
    s_add_u32 s46, s33, 0x4c00000
    buffer_load_dwordx4 v[100:103], v0, s[12:15], s46 offen nt
    v_and_b32 v7, -4, v20
    v_lshl_add_u32 v8, v20, 2, v7
    ds_write_b32 v8, v16
    v_lshl_add_u32 v7, v7, 2, v20
    ds_write_b8 v7, v126 offset:16
    v_and_b32 v9, -4, v21
    v_lshl_add_u32 v10, v21, 2, v9
    ds_write_b32 v10, v17
    v_lshl_add_u32 v9, v9, 2, v21
    ds_write_b8_d16_hi v9, v126 offset:16
    v_and_b32 v7, -4, v22
    v_lshl_add_u32 v8, v22, 2, v7
    ds_write_b32 v8, v18
    v_lshl_add_u32 v7, v7, 2, v22
    ds_write_b8 v7, v127 offset:16
    v_and_b32 v9, -4, v23
    v_lshl_add_u32 v10, v23, 2, v9
    ds_write_b32 v10, v19
    v_lshl_add_u32 v9, v9, 2, v23
    ds_write_b8_d16_hi v9, v127 offset:16
    s_add_u32 s47, s33, 0x5000000
    buffer_load_dwordx4 v[108:111], v0, s[8:11], s47 offen nt
    s_add_u32 s44, s33, 0x5000000
    buffer_load_dwordx4 v[116:119], v0, s[12:15], s44 offen nt
    s_setprio 1
    v_and_b32 v7, -4, v32
    v_lshl_add_u32 v8, v32, 2, v7
    ds_write_b32 v8, v28
    v_lshl_add_u32 v7, v7, 2, v32
    ds_write_b8 v7, v24 offset:16
    v_and_b32 v9, -4, v33
    v_lshl_add_u32 v10, v33, 2, v9
    ds_write_b32 v10, v29
    v_lshl_add_u32 v9, v9, 2, v33
    ds_write_b8_d16_hi v9, v24 offset:16
    v_and_b32 v7, -4, v34
    v_lshl_add_u32 v8, v34, 2, v7
    ds_write_b32 v8, v30
    v_lshl_add_u32 v7, v7, 2, v34
    ds_write_b8 v7, v25 offset:16
    v_and_b32 v9, -4, v35
    v_lshl_add_u32 v10, v35, 2, v9
    ds_write_b32 v10, v31
    v_lshl_add_u32 v9, v9, 2, v35
    ds_write_b8_d16_hi v9, v25 offset:16
    s_add_u32 s45, s34, 0x2800000
    buffer_load_dwordx2 v[120:121], v1, s[16:19], s45 offen nt
    s_add_u32 s46, s34, 0x2a00000
    buffer_load_dwordx2 v[122:123], v1, s[16:19], s46 offen nt
    s_add_u32 s47, s33, 0x5400000
    buffer_load_dwordx4 v[92:95], v0, s[8:11], s47 offen nt
    v_and_b32 v7, -4, v40
    v_lshl_add_u32 v8, v40, 2, v7
    ds_write_b32 v8, v36
    v_lshl_add_u32 v7, v7, 2, v40
    ds_write_b8 v7, v26 offset:16
    v_and_b32 v9, -4, v41
    v_lshl_add_u32 v10, v41, 2, v9
    ds_write_b32 v10, v37
    v_lshl_add_u32 v9, v9, 2, v41
    ds_write_b8_d16_hi v9, v26 offset:16
    v_and_b32 v7, -4, v42
    v_lshl_add_u32 v8, v42, 2, v7
    ds_write_b32 v8, v38
    v_lshl_add_u32 v7, v7, 2, v42
    ds_write_b8 v7, v27 offset:16
    v_and_b32 v9, -4, v43
    v_lshl_add_u32 v10, v43, 2, v9
    ds_write_b32 v10, v39
    v_lshl_add_u32 v9, v9, 2, v43
    ds_write_b8_d16_hi v9, v27 offset:16
    s_add_u32 s44, s35, 0x24000
    buffer_store_dwordx4 v[84:87], v0, s[20:23], s44 offen sc1
    s_add_u32 s45, s33, 0x5400000
    buffer_load_dwordx4 v[16:19], v0, s[12:15], s45 offen nt
    s_setprio 0
    v_and_b32 v7, -4, v52
    v_lshl_add_u32 v8, v52, 2, v7
    ds_write_b32 v8, v48
    v_lshl_add_u32 v7, v7, 2, v52
    ds_write_b8 v7, v44 offset:16
    v_and_b32 v9, -4, v53
    v_lshl_add_u32 v10, v53, 2, v9
    ds_write_b32 v10, v49
    v_lshl_add_u32 v9, v9, 2, v53
    ds_write_b8_d16_hi v9, v44 offset:16
    v_and_b32 v7, -4, v54
    v_lshl_add_u32 v8, v54, 2, v7
    ds_write_b32 v8, v50
    v_lshl_add_u32 v7, v7, 2, v54
    ds_write_b8 v7, v45 offset:16
    v_and_b32 v9, -4, v55
    v_lshl_add_u32 v10, v55, 2, v9
    ds_write_b32 v10, v51
    v_lshl_add_u32 v9, v9, 2, v55
    ds_write_b8_d16_hi v9, v45 offset:16
    s_add_u32 s46, s33, 0x5800000
    buffer_load_dwordx4 v[20:23], v0, s[8:11], s46 offen nt
    s_add_u32 s47, s33, 0x5800000
    buffer_load_dwordx4 v[124:127], v0, s[12:15], s47 offen nt
    v_and_b32 v7, -4, v60
    v_lshl_add_u32 v8, v60, 2, v7
    ds_write_b32 v8, v56
    v_lshl_add_u32 v7, v7, 2, v60
    ds_write_b8 v7, v46 offset:16
    v_and_b32 v9, -4, v61
    v_lshl_add_u32 v10, v61, 2, v9
    ds_write_b32 v10, v57
    v_lshl_add_u32 v9, v9, 2, v61
    ds_write_b8_d16_hi v9, v46 offset:16
    v_and_b32 v7, -4, v62
    v_lshl_add_u32 v8, v62, 2, v7
    ds_write_b32 v8, v58
    v_lshl_add_u32 v7, v7, 2, v62
    ds_write_b8 v7, v47 offset:16
    v_and_b32 v9, -4, v63
    v_lshl_add_u32 v10, v63, 2, v9
    ds_write_b32 v10, v59
    v_lshl_add_u32 v9, v9, 2, v63
    ds_write_b8_d16_hi v9, v47 offset:16
    s_add_u32 s44, s34, 0x2c00000
    buffer_load_dwordx2 v[28:29], v1, s[16:19], s44 offen nt
    s_add_u32 s45, s34, 0x2e00000
    buffer_load_dwordx2 v[30:31], v1, s[16:19], s45 offen nt
    v_add_u32 v7, 0x10000, v0
    v_add_u32 v12, 0x20000, v0
    v_mov_b32 v8, 0
    v_mov_b32 v9, 0
    v_mov_b32 v10, 0
    v_mov_b32 v11, 0
    s_waitcnt lgkmcnt(0)
    s_barrier
    ds_read_b128 v[32:35], v0 offset:0
    ds_write_b128 v0, v[8:11]
    ds_read_b128 v[36:39], v0 offset:16384
    ds_read_b128 v[40:43], v0 offset:32768
    ds_read_b128 v[24:27], v0 offset:49152
    ds_read_b128 v[84:87], v7 offset:0
    ds_read_b128 v[48:51], v7 offset:16384
    ds_read_b128 v[52:55], v7 offset:32768
    ds_read_b128 v[56:59], v7 offset:49152
    ds_read_b128 v[60:63], v12 offset:0
    ds_read_b128 v[44:47], v12 offset:16384
    s_waitcnt lgkmcnt(0)
    s_barrier
    s_setprio 3
    s_add_u32 s46, s35, 0x2a40000
    buffer_store_dwordx4 v[32:35], v0, s[20:23], s46 offen sc1
    s_add_u32 s47, s33, 0x5c00000
    s_nop 0
    buffer_load_dwordx4 v[32:35], v0, s[8:11], s47 offen nt
    s_add_u32 s44, s35, 0x2a44000
    buffer_store_dwordx4 v[36:39], v0, s[20:23], s44 offen sc1
    s_add_u32 s45, s33, 0x5c00000
    s_nop 0
    buffer_load_dwordx4 v[36:39], v0, s[12:15], s45 offen nt
    s_waitcnt vmcnt(27)
    v_lshlrev_b32 v7, 16, v64
    v_and_b32 v8, 0xffff0000, v64
    v_lshlrev_b32 v9, 16, v65
    v_and_b32 v10, 0xffff0000, v65
    v_mul_f32 v7, 0.15915494, v7
    v_mul_f32 v8, 0.15915494, v8
    v_mul_f32 v9, 0.15915494, v9
    v_mul_f32 v10, 0.15915494, v10
    v_mul_hi_u32_u24 v14, 429497, v68
    v_lshrrev_b32 v12, 3, v72
    v_cos_f32 v7, v7
    v_lshlrev_b16 v13, 3, v72
    v_mad_i32_i24 v11, v14, s55, v68
    v_bitop3_b32 v12, v6, v13, v12 bitop3:0xca
    v_lshl_add_u32 v11, v11, 17, s40
    v_lshlrev_b16 v14, 8, v14
    v_lshrrev_b32 v13, 2, v72
    v_add_u32 v68, v12, v11
    v_bitop3_b32 v72, v5, v13, v14 bitop3:0xea
    ds_add_u32 v72, v2
    v_mul_hi_u32_u24 v14, 429497, v69
    v_lshrrev_b32 v12, 3, v73
    v_cos_f32 v8, v8
    v_lshlrev_b16 v13, 3, v73
    v_mad_i32_i24 v11, v14, s55, v69
    v_bitop3_b32 v12, v6, v13, v12 bitop3:0xca
    v_lshl_add_u32 v11, v11, 17, s40
    v_lshlrev_b16 v14, 8, v14
    v_lshrrev_b32 v13, 2, v73
    v_add_u32 v69, v12, v11
    v_bitop3_b32 v73, v5, v13, v14 bitop3:0xea
    ds_add_u32 v73, v2
    v_cvt_pk_bf16_f32 v64, v7, v8
    v_perm_b32 v12, v64, v64, s41
    v_bitop3_b32 v68, v4, v12, v68 bitop3:0xca
    v_perm_b32 v13, v64, v64, s42
    v_bitop3_b32 v69, v4, v13, v69 bitop3:0xca
    v_mul_hi_u32_u24 v14, 429497, v70
    v_lshrrev_b32 v12, 3, v74
    v_cos_f32 v9, v9
    v_lshlrev_b16 v13, 3, v74
    v_mad_i32_i24 v11, v14, s55, v70
    v_bitop3_b32 v12, v6, v13, v12 bitop3:0xca
    v_lshl_add_u32 v11, v11, 17, s40
    v_lshlrev_b16 v14, 8, v14
    v_lshrrev_b32 v13, 2, v74
    v_add_u32 v70, v12, v11
    v_bitop3_b32 v74, v5, v13, v14 bitop3:0xea
    ds_add_u32 v74, v2
    v_mul_hi_u32_u24 v14, 429497, v71
    v_lshrrev_b32 v12, 3, v75
    v_cos_f32 v10, v10
    v_lshlrev_b16 v13, 3, v75
    v_mad_i32_i24 v11, v14, s55, v71
    v_bitop3_b32 v12, v6, v13, v12 bitop3:0xca
    v_lshl_add_u32 v11, v11, 17, s40
    v_lshlrev_b16 v14, 8, v14
    v_lshrrev_b32 v13, 2, v75
    v_add_u32 v71, v12, v11
    v_bitop3_b32 v75, v5, v13, v14 bitop3:0xea
    ds_add_u32 v75, v2
    v_cvt_pk_bf16_f32 v65, v9, v10
    v_perm_b32 v12, v65, v65, s41
    v_bitop3_b32 v70, v4, v12, v70 bitop3:0xca
    v_perm_b32 v13, v65, v65, s42
    v_bitop3_b32 v71, v4, v13, v71 bitop3:0xca
    s_waitcnt vmcnt(23)
    v_lshlrev_b32 v7, 16, v66
    v_and_b32 v8, 0xffff0000, v66
    v_lshlrev_b32 v9, 16, v67
    v_and_b32 v10, 0xffff0000, v67
    v_mul_f32 v7, 0.15915494, v7
    v_mul_f32 v8, 0.15915494, v8
    v_mul_f32 v9, 0.15915494, v9
    v_mul_f32 v10, 0.15915494, v10
    v_mul_hi_u32_u24 v14, 429497, v76
    v_lshrrev_b32 v12, 3, v80
    v_cos_f32 v7, v7
    v_lshlrev_b16 v13, 3, v80
    v_mad_i32_i24 v11, v14, s55, v76
    v_bitop3_b32 v12, v6, v13, v12 bitop3:0xca
    v_lshl_add_u32 v11, v11, 17, s40
    v_lshlrev_b16 v14, 8, v14
    v_lshrrev_b32 v13, 2, v80
    v_add_u32 v76, v12, v11
    v_bitop3_b32 v80, v5, v13, v14 bitop3:0xea
    ds_add_u32 v80, v2
    v_mul_hi_u32_u24 v14, 429497, v77
    v_lshrrev_b32 v12, 3, v81
    v_cos_f32 v8, v8
    v_lshlrev_b16 v13, 3, v81
    v_mad_i32_i24 v11, v14, s55, v77
    v_bitop3_b32 v12, v6, v13, v12 bitop3:0xca
    v_lshl_add_u32 v11, v11, 17, s40
    v_lshlrev_b16 v14, 8, v14
    v_lshrrev_b32 v13, 2, v81
    v_add_u32 v77, v12, v11
    v_bitop3_b32 v81, v5, v13, v14 bitop3:0xea
    ds_add_u32 v81, v2
    v_cvt_pk_bf16_f32 v66, v7, v8
    v_perm_b32 v12, v66, v66, s41
    v_bitop3_b32 v76, v4, v12, v76 bitop3:0xca
    v_perm_b32 v13, v66, v66, s42
    v_bitop3_b32 v77, v4, v13, v77 bitop3:0xca
    v_mul_hi_u32_u24 v14, 429497, v78
    v_lshrrev_b32 v12, 3, v82
    v_cos_f32 v9, v9
    v_lshlrev_b16 v13, 3, v82
    v_mad_i32_i24 v11, v14, s55, v78
    v_bitop3_b32 v12, v6, v13, v12 bitop3:0xca
    v_lshl_add_u32 v11, v11, 17, s40
    v_lshlrev_b16 v14, 8, v14
    v_lshrrev_b32 v13, 2, v82
    v_add_u32 v78, v12, v11
    v_bitop3_b32 v82, v5, v13, v14 bitop3:0xea
    ds_add_u32 v82, v2
    v_mul_hi_u32_u24 v14, 429497, v79
    v_lshrrev_b32 v12, 3, v83
    v_cos_f32 v10, v10
    v_lshlrev_b16 v13, 3, v83
    v_mad_i32_i24 v11, v14, s55, v79
    v_bitop3_b32 v12, v6, v13, v12 bitop3:0xca
    v_lshl_add_u32 v11, v11, 17, s40
    v_lshlrev_b16 v14, 8, v14
    v_lshrrev_b32 v13, 2, v83
    v_add_u32 v79, v12, v11
    v_bitop3_b32 v83, v5, v13, v14 bitop3:0xea
    ds_add_u32 v83, v2
    v_cvt_pk_bf16_f32 v67, v9, v10
    v_perm_b32 v12, v67, v67, s41
    v_bitop3_b32 v78, v4, v12, v78 bitop3:0xca
    v_perm_b32 v13, v67, v67, s42
    v_bitop3_b32 v79, v4, v13, v79 bitop3:0xca
    s_setprio 2
    s_waitcnt vmcnt(18)
    v_lshlrev_b32 v7, 16, v88
    v_and_b32 v8, 0xffff0000, v88
    v_lshlrev_b32 v9, 16, v89
    v_and_b32 v10, 0xffff0000, v89
    v_mul_f32 v7, 0.15915494, v7
    v_mul_f32 v8, 0.15915494, v8
    v_mul_f32 v9, 0.15915494, v9
    v_mul_f32 v10, 0.15915494, v10
    v_mul_hi_u32_u24 v14, 429497, v96
    v_lshrrev_b32 v12, 3, v104
    v_cos_f32 v7, v7
    v_lshlrev_b16 v13, 3, v104
    v_mad_i32_i24 v11, v14, s55, v96
    v_bitop3_b32 v12, v6, v13, v12 bitop3:0xca
    v_lshl_add_u32 v11, v11, 17, s40
    v_lshlrev_b16 v14, 8, v14
    v_lshrrev_b32 v13, 2, v104
    v_add_u32 v96, v12, v11
    v_bitop3_b32 v104, v5, v13, v14 bitop3:0xea
    ds_add_u32 v104, v2
    v_mul_hi_u32_u24 v14, 429497, v97
    v_lshrrev_b32 v12, 3, v105
    v_cos_f32 v8, v8
    v_lshlrev_b16 v13, 3, v105
    v_mad_i32_i24 v11, v14, s55, v97
    v_bitop3_b32 v12, v6, v13, v12 bitop3:0xca
    v_lshl_add_u32 v11, v11, 17, s40
    v_lshlrev_b16 v14, 8, v14
    v_lshrrev_b32 v13, 2, v105
    v_add_u32 v97, v12, v11
    v_bitop3_b32 v105, v5, v13, v14 bitop3:0xea
    ds_add_u32 v105, v2
    v_cvt_pk_bf16_f32 v88, v7, v8
    v_perm_b32 v12, v88, v88, s41
    v_bitop3_b32 v96, v4, v12, v96 bitop3:0xca
    v_perm_b32 v13, v88, v88, s42
    v_bitop3_b32 v97, v4, v13, v97 bitop3:0xca
    v_mul_hi_u32_u24 v14, 429497, v98
    v_lshrrev_b32 v12, 3, v106
    v_cos_f32 v9, v9
    v_lshlrev_b16 v13, 3, v106
    v_mad_i32_i24 v11, v14, s55, v98
    v_bitop3_b32 v12, v6, v13, v12 bitop3:0xca
    v_lshl_add_u32 v11, v11, 17, s40
    v_lshlrev_b16 v14, 8, v14
    v_lshrrev_b32 v13, 2, v106
    v_add_u32 v98, v12, v11
    v_bitop3_b32 v106, v5, v13, v14 bitop3:0xea
    ds_add_u32 v106, v2
    v_mul_hi_u32_u24 v14, 429497, v99
    v_lshrrev_b32 v12, 3, v107
    v_cos_f32 v10, v10
    v_lshlrev_b16 v13, 3, v107
    v_mad_i32_i24 v11, v14, s55, v99
    v_bitop3_b32 v12, v6, v13, v12 bitop3:0xca
    v_lshl_add_u32 v11, v11, 17, s40
    v_lshlrev_b16 v14, 8, v14
    v_lshrrev_b32 v13, 2, v107
    v_add_u32 v99, v12, v11
    v_bitop3_b32 v107, v5, v13, v14 bitop3:0xea
    ds_add_u32 v107, v2
    v_cvt_pk_bf16_f32 v89, v9, v10
    v_perm_b32 v12, v89, v89, s41
    v_bitop3_b32 v98, v4, v12, v98 bitop3:0xca
    v_perm_b32 v13, v89, v89, s42
    v_bitop3_b32 v99, v4, v13, v99 bitop3:0xca
    s_add_u32 s46, s35, 0x2a48000
    buffer_store_dwordx4 v[40:43], v0, s[20:23], s46 offen sc1
    s_add_u32 s47, s33, 0x6000000
    s_nop 0
    buffer_load_dwordx4 v[40:43], v0, s[8:11], s47 offen nt
    s_waitcnt vmcnt(17)
    v_lshlrev_b32 v7, 16, v90
    v_and_b32 v8, 0xffff0000, v90
    v_lshlrev_b32 v9, 16, v91
    v_and_b32 v10, 0xffff0000, v91
    v_mul_f32 v7, 0.15915494, v7
    v_mul_f32 v8, 0.15915494, v8
    v_mul_f32 v9, 0.15915494, v9
    v_mul_f32 v10, 0.15915494, v10
    v_mul_hi_u32_u24 v14, 429497, v112
    v_lshrrev_b32 v12, 3, v100
    v_cos_f32 v7, v7
    v_lshlrev_b16 v13, 3, v100
    v_mad_i32_i24 v11, v14, s55, v112
    v_bitop3_b32 v12, v6, v13, v12 bitop3:0xca
    v_lshl_add_u32 v11, v11, 17, s40
    v_lshlrev_b16 v14, 8, v14
    v_lshrrev_b32 v13, 2, v100
    v_add_u32 v112, v12, v11
    v_bitop3_b32 v100, v5, v13, v14 bitop3:0xea
    ds_add_u32 v100, v2
    v_mul_hi_u32_u24 v14, 429497, v113
    v_lshrrev_b32 v12, 3, v101
    v_cos_f32 v8, v8
    v_lshlrev_b16 v13, 3, v101
    v_mad_i32_i24 v11, v14, s55, v113
    v_bitop3_b32 v12, v6, v13, v12 bitop3:0xca
    v_lshl_add_u32 v11, v11, 17, s40
    v_lshlrev_b16 v14, 8, v14
    v_lshrrev_b32 v13, 2, v101
    v_add_u32 v113, v12, v11
    v_bitop3_b32 v101, v5, v13, v14 bitop3:0xea
    ds_add_u32 v101, v2
    v_cvt_pk_bf16_f32 v90, v7, v8
    v_perm_b32 v12, v90, v90, s41
    v_bitop3_b32 v112, v4, v12, v112 bitop3:0xca
    v_perm_b32 v13, v90, v90, s42
    v_bitop3_b32 v113, v4, v13, v113 bitop3:0xca
    v_mul_hi_u32_u24 v14, 429497, v114
    v_lshrrev_b32 v12, 3, v102
    v_cos_f32 v9, v9
    v_lshlrev_b16 v13, 3, v102
    v_mad_i32_i24 v11, v14, s55, v114
    v_bitop3_b32 v12, v6, v13, v12 bitop3:0xca
    v_lshl_add_u32 v11, v11, 17, s40
    v_lshlrev_b16 v14, 8, v14
    v_lshrrev_b32 v13, 2, v102
    v_add_u32 v114, v12, v11
    v_bitop3_b32 v102, v5, v13, v14 bitop3:0xea
    ds_add_u32 v102, v2
    v_mul_hi_u32_u24 v14, 429497, v115
    v_lshrrev_b32 v12, 3, v103
    v_cos_f32 v10, v10
    v_lshlrev_b16 v13, 3, v103
    v_mad_i32_i24 v11, v14, s55, v115
    v_bitop3_b32 v12, v6, v13, v12 bitop3:0xca
    v_lshl_add_u32 v11, v11, 17, s40
    v_lshlrev_b16 v14, 8, v14
    v_lshrrev_b32 v13, 2, v103
    v_add_u32 v115, v12, v11
    v_bitop3_b32 v103, v5, v13, v14 bitop3:0xea
    ds_add_u32 v103, v2
    v_cvt_pk_bf16_f32 v91, v9, v10
    v_perm_b32 v12, v91, v91, s41
    v_bitop3_b32 v114, v4, v12, v114 bitop3:0xca
    v_perm_b32 v13, v91, v91, s42
    v_bitop3_b32 v115, v4, v13, v115 bitop3:0xca
    s_setprio 1
    s_waitcnt vmcnt(13)
    v_lshlrev_b32 v7, 16, v120
    v_and_b32 v8, 0xffff0000, v120
    v_lshlrev_b32 v9, 16, v121
    v_and_b32 v10, 0xffff0000, v121
    v_mul_f32 v7, 0.15915494, v7
    v_mul_f32 v8, 0.15915494, v8
    v_mul_f32 v9, 0.15915494, v9
    v_mul_f32 v10, 0.15915494, v10
    v_mul_hi_u32_u24 v14, 429497, v108
    v_lshrrev_b32 v12, 3, v116
    v_cos_f32 v7, v7
    v_lshlrev_b16 v13, 3, v116
    v_mad_i32_i24 v11, v14, s55, v108
    v_bitop3_b32 v12, v6, v13, v12 bitop3:0xca
    v_lshl_add_u32 v11, v11, 17, s40
    v_lshlrev_b16 v14, 8, v14
    v_lshrrev_b32 v13, 2, v116
    v_add_u32 v108, v12, v11
    v_bitop3_b32 v116, v5, v13, v14 bitop3:0xea
    ds_add_u32 v116, v2
    v_mul_hi_u32_u24 v14, 429497, v109
    v_lshrrev_b32 v12, 3, v117
    v_cos_f32 v8, v8
    v_lshlrev_b16 v13, 3, v117
    v_mad_i32_i24 v11, v14, s55, v109
    v_bitop3_b32 v12, v6, v13, v12 bitop3:0xca
    v_lshl_add_u32 v11, v11, 17, s40
    v_lshlrev_b16 v14, 8, v14
    v_lshrrev_b32 v13, 2, v117
    v_add_u32 v109, v12, v11
    v_bitop3_b32 v117, v5, v13, v14 bitop3:0xea
    ds_add_u32 v117, v2
    v_cvt_pk_bf16_f32 v120, v7, v8
    v_perm_b32 v12, v120, v120, s41
    v_bitop3_b32 v108, v4, v12, v108 bitop3:0xca
    v_perm_b32 v13, v120, v120, s42
    v_bitop3_b32 v109, v4, v13, v109 bitop3:0xca
    v_mul_hi_u32_u24 v14, 429497, v110
    v_lshrrev_b32 v12, 3, v118
    v_cos_f32 v9, v9
    v_lshlrev_b16 v13, 3, v118
    v_mad_i32_i24 v11, v14, s55, v110
    v_bitop3_b32 v12, v6, v13, v12 bitop3:0xca
    v_lshl_add_u32 v11, v11, 17, s40
    v_lshlrev_b16 v14, 8, v14
    v_lshrrev_b32 v13, 2, v118
    v_add_u32 v110, v12, v11
    v_bitop3_b32 v118, v5, v13, v14 bitop3:0xea
    ds_add_u32 v118, v2
    v_mul_hi_u32_u24 v14, 429497, v111
    v_lshrrev_b32 v12, 3, v119
    v_cos_f32 v10, v10
    v_lshlrev_b16 v13, 3, v119
    v_mad_i32_i24 v11, v14, s55, v111
    v_bitop3_b32 v12, v6, v13, v12 bitop3:0xca
    v_lshl_add_u32 v11, v11, 17, s40
    v_lshlrev_b16 v14, 8, v14
    v_lshrrev_b32 v13, 2, v119
    v_add_u32 v111, v12, v11
    v_bitop3_b32 v119, v5, v13, v14 bitop3:0xea
    ds_add_u32 v119, v2
    v_cvt_pk_bf16_f32 v121, v9, v10
    v_perm_b32 v12, v121, v121, s41
    v_bitop3_b32 v110, v4, v12, v110 bitop3:0xca
    v_perm_b32 v13, v121, v121, s42
    v_bitop3_b32 v111, v4, v13, v111 bitop3:0xca
    s_waitcnt vmcnt(10)
    v_lshlrev_b32 v7, 16, v122
    v_and_b32 v8, 0xffff0000, v122
    v_lshlrev_b32 v9, 16, v123
    v_and_b32 v10, 0xffff0000, v123
    v_mul_f32 v7, 0.15915494, v7
    v_mul_f32 v8, 0.15915494, v8
    v_mul_f32 v9, 0.15915494, v9
    v_mul_f32 v10, 0.15915494, v10
    v_mul_hi_u32_u24 v14, 429497, v92
    v_lshrrev_b32 v12, 3, v16
    v_cos_f32 v7, v7
    v_lshlrev_b16 v13, 3, v16
    v_mad_i32_i24 v11, v14, s55, v92
    v_bitop3_b32 v12, v6, v13, v12 bitop3:0xca
    v_lshl_add_u32 v11, v11, 17, s40
    v_lshlrev_b16 v14, 8, v14
    v_lshrrev_b32 v13, 2, v16
    v_add_u32 v92, v12, v11
    v_bitop3_b32 v16, v5, v13, v14 bitop3:0xea
    ds_add_u32 v16, v2
    v_mul_hi_u32_u24 v14, 429497, v93
    v_lshrrev_b32 v12, 3, v17
    v_cos_f32 v8, v8
    v_lshlrev_b16 v13, 3, v17
    v_mad_i32_i24 v11, v14, s55, v93
    v_bitop3_b32 v12, v6, v13, v12 bitop3:0xca
    v_lshl_add_u32 v11, v11, 17, s40
    v_lshlrev_b16 v14, 8, v14
    v_lshrrev_b32 v13, 2, v17
    v_add_u32 v93, v12, v11
    v_bitop3_b32 v17, v5, v13, v14 bitop3:0xea
    ds_add_u32 v17, v2
    v_cvt_pk_bf16_f32 v122, v7, v8
    v_perm_b32 v12, v122, v122, s41
    v_bitop3_b32 v92, v4, v12, v92 bitop3:0xca
    v_perm_b32 v13, v122, v122, s42
    v_bitop3_b32 v93, v4, v13, v93 bitop3:0xca
    v_mul_hi_u32_u24 v14, 429497, v94
    v_lshrrev_b32 v12, 3, v18
    v_cos_f32 v9, v9
    v_lshlrev_b16 v13, 3, v18
    v_mad_i32_i24 v11, v14, s55, v94
    v_bitop3_b32 v12, v6, v13, v12 bitop3:0xca
    v_lshl_add_u32 v11, v11, 17, s40
    v_lshlrev_b16 v14, 8, v14
    v_lshrrev_b32 v13, 2, v18
    v_add_u32 v94, v12, v11
    v_bitop3_b32 v18, v5, v13, v14 bitop3:0xea
    ds_add_u32 v18, v2
    v_mul_hi_u32_u24 v14, 429497, v95
    v_lshrrev_b32 v12, 3, v19
    v_cos_f32 v10, v10
    v_lshlrev_b16 v13, 3, v19
    v_mad_i32_i24 v11, v14, s55, v95
    v_bitop3_b32 v12, v6, v13, v12 bitop3:0xca
    v_lshl_add_u32 v11, v11, 17, s40
    v_lshlrev_b16 v14, 8, v14
    v_lshrrev_b32 v13, 2, v19
    v_add_u32 v95, v12, v11
    v_bitop3_b32 v19, v5, v13, v14 bitop3:0xea
    ds_add_u32 v19, v2
    v_cvt_pk_bf16_f32 v123, v9, v10
    v_perm_b32 v12, v123, v123, s41
    v_bitop3_b32 v94, v4, v12, v94 bitop3:0xca
    v_perm_b32 v13, v123, v123, s42
    v_bitop3_b32 v95, v4, v13, v95 bitop3:0xca
    s_setprio 0
    s_add_u32 s44, s35, 0x2a4c000
    buffer_store_dwordx4 v[24:27], v0, s[20:23], s44 offen sc1
    s_add_u32 s45, s33, 0x6000000
    s_nop 0
    buffer_load_dwordx4 v[24:27], v0, s[12:15], s45 offen nt
    s_waitcnt vmcnt(8)
    v_lshlrev_b32 v7, 16, v28
    v_and_b32 v8, 0xffff0000, v28
    v_lshlrev_b32 v9, 16, v29
    v_and_b32 v10, 0xffff0000, v29
    v_mul_f32 v7, 0.15915494, v7
    v_mul_f32 v8, 0.15915494, v8
    v_mul_f32 v9, 0.15915494, v9
    v_mul_f32 v10, 0.15915494, v10
    v_mul_hi_u32_u24 v14, 429497, v20
    v_lshrrev_b32 v12, 3, v124
    v_cos_f32 v7, v7
    v_lshlrev_b16 v13, 3, v124
    v_mad_i32_i24 v11, v14, s55, v20
    v_bitop3_b32 v12, v6, v13, v12 bitop3:0xca
    v_lshl_add_u32 v11, v11, 17, s40
    v_lshlrev_b16 v14, 8, v14
    v_lshrrev_b32 v13, 2, v124
    v_add_u32 v20, v12, v11
    v_bitop3_b32 v124, v5, v13, v14 bitop3:0xea
    ds_add_u32 v124, v2
    v_mul_hi_u32_u24 v14, 429497, v21
    v_lshrrev_b32 v12, 3, v125
    v_cos_f32 v8, v8
    v_lshlrev_b16 v13, 3, v125
    v_mad_i32_i24 v11, v14, s55, v21
    v_bitop3_b32 v12, v6, v13, v12 bitop3:0xca
    v_lshl_add_u32 v11, v11, 17, s40
    v_lshlrev_b16 v14, 8, v14
    v_lshrrev_b32 v13, 2, v125
    v_add_u32 v21, v12, v11
    v_bitop3_b32 v125, v5, v13, v14 bitop3:0xea
    ds_add_u32 v125, v2
    v_cvt_pk_bf16_f32 v28, v7, v8
    v_perm_b32 v12, v28, v28, s41
    v_bitop3_b32 v20, v4, v12, v20 bitop3:0xca
    v_perm_b32 v13, v28, v28, s42
    v_bitop3_b32 v21, v4, v13, v21 bitop3:0xca
    v_mul_hi_u32_u24 v14, 429497, v22
    v_lshrrev_b32 v12, 3, v126
    v_cos_f32 v9, v9
    v_lshlrev_b16 v13, 3, v126
    v_mad_i32_i24 v11, v14, s55, v22
    v_bitop3_b32 v12, v6, v13, v12 bitop3:0xca
    v_lshl_add_u32 v11, v11, 17, s40
    v_lshlrev_b16 v14, 8, v14
    v_lshrrev_b32 v13, 2, v126
    v_add_u32 v22, v12, v11
    v_bitop3_b32 v126, v5, v13, v14 bitop3:0xea
    ds_add_u32 v126, v2
    v_mul_hi_u32_u24 v14, 429497, v23
    v_lshrrev_b32 v12, 3, v127
    v_cos_f32 v10, v10
    v_lshlrev_b16 v13, 3, v127
    v_mad_i32_i24 v11, v14, s55, v23
    v_bitop3_b32 v12, v6, v13, v12 bitop3:0xca
    v_lshl_add_u32 v11, v11, 17, s40
    v_lshlrev_b16 v14, 8, v14
    v_lshrrev_b32 v13, 2, v127
    v_add_u32 v23, v12, v11
    v_bitop3_b32 v127, v5, v13, v14 bitop3:0xea
    ds_add_u32 v127, v2
    v_cvt_pk_bf16_f32 v29, v9, v10
    v_perm_b32 v12, v29, v29, s41
    v_bitop3_b32 v22, v4, v12, v22 bitop3:0xca
    v_perm_b32 v13, v29, v29, s42
    v_bitop3_b32 v23, v4, v13, v23 bitop3:0xca
    s_waitcnt vmcnt(4)
    v_lshlrev_b32 v7, 16, v30
    v_and_b32 v8, 0xffff0000, v30
    v_lshlrev_b32 v9, 16, v31
    v_and_b32 v10, 0xffff0000, v31
    v_mul_f32 v7, 0.15915494, v7
    v_mul_f32 v8, 0.15915494, v8
    v_mul_f32 v9, 0.15915494, v9
    v_mul_f32 v10, 0.15915494, v10
    v_mul_hi_u32_u24 v14, 429497, v32
    v_lshrrev_b32 v12, 3, v36
    v_cos_f32 v7, v7
    v_lshlrev_b16 v13, 3, v36
    v_mad_i32_i24 v11, v14, s55, v32
    v_bitop3_b32 v12, v6, v13, v12 bitop3:0xca
    v_lshl_add_u32 v11, v11, 17, s40
    v_lshlrev_b16 v14, 8, v14
    v_lshrrev_b32 v13, 2, v36
    v_add_u32 v32, v12, v11
    v_bitop3_b32 v36, v5, v13, v14 bitop3:0xea
    ds_add_u32 v36, v2
    v_mul_hi_u32_u24 v14, 429497, v33
    v_lshrrev_b32 v12, 3, v37
    v_cos_f32 v8, v8
    v_lshlrev_b16 v13, 3, v37
    v_mad_i32_i24 v11, v14, s55, v33
    v_bitop3_b32 v12, v6, v13, v12 bitop3:0xca
    v_lshl_add_u32 v11, v11, 17, s40
    v_lshlrev_b16 v14, 8, v14
    v_lshrrev_b32 v13, 2, v37
    v_add_u32 v33, v12, v11
    v_bitop3_b32 v37, v5, v13, v14 bitop3:0xea
    ds_add_u32 v37, v2
    v_cvt_pk_bf16_f32 v30, v7, v8
    v_perm_b32 v12, v30, v30, s41
    v_bitop3_b32 v32, v4, v12, v32 bitop3:0xca
    v_perm_b32 v13, v30, v30, s42
    v_bitop3_b32 v33, v4, v13, v33 bitop3:0xca
    v_mul_hi_u32_u24 v14, 429497, v34
    v_lshrrev_b32 v12, 3, v38
    v_cos_f32 v9, v9
    v_lshlrev_b16 v13, 3, v38
    v_mad_i32_i24 v11, v14, s55, v34
    v_bitop3_b32 v12, v6, v13, v12 bitop3:0xca
    v_lshl_add_u32 v11, v11, 17, s40
    v_lshlrev_b16 v14, 8, v14
    v_lshrrev_b32 v13, 2, v38
    v_add_u32 v34, v12, v11
    v_bitop3_b32 v38, v5, v13, v14 bitop3:0xea
    ds_add_u32 v38, v2
    v_mul_hi_u32_u24 v14, 429497, v35
    v_lshrrev_b32 v12, 3, v39
    v_cos_f32 v10, v10
    v_lshlrev_b16 v13, 3, v39
    v_mad_i32_i24 v11, v14, s55, v35
    v_bitop3_b32 v12, v6, v13, v12 bitop3:0xca
    v_lshl_add_u32 v11, v11, 17, s40
    v_lshlrev_b16 v14, 8, v14
    v_lshrrev_b32 v13, 2, v39
    v_add_u32 v35, v12, v11
    v_bitop3_b32 v39, v5, v13, v14 bitop3:0xea
    ds_add_u32 v39, v2
    v_cvt_pk_bf16_f32 v31, v9, v10
    v_perm_b32 v12, v31, v31, s41
    v_bitop3_b32 v34, v4, v12, v34 bitop3:0xca
    v_perm_b32 v13, v31, v31, s42
    v_bitop3_b32 v35, v4, v13, v35 bitop3:0xca
    v_lshrrev_b32 v8, 2, v0
    v_and_b32 v7, 0x3c00, v0
    v_bitop3_b32 v7, v5, v8, v7 bitop3:0xea
    s_waitcnt lgkmcnt(0)
    s_barrier
    ds_read2st64_b32 v[8:9], v7 offset0:0 offset1:1
    ds_read2st64_b32 v[10:11], v7 offset0:2 offset1:3
    s_add_u32 s46, s35, 0x2a50000
    buffer_store_dwordx4 v[84:87], v0, s[20:23], s46 offen sc1
    s_add_u32 s47, s34, 0x3000000
    s_nop 0
    buffer_load_dwordx2 v[84:85], v1, s[16:19], s47 offen nt
    s_add_u32 s44, s34, 0x3200000
    buffer_load_dwordx2 v[86:87], v1, s[16:19], s44 offen nt
    s_waitcnt lgkmcnt(0)
    v_lshl_or_b32 v12, v9, 16, v8
    v_lshl_or_b32 v13, v11, 16, v10
    v_mov_b32 v14, v12
    v_mov_b32 v15, v13
    s_nop 0
    v_add_u32_dpp v14, v14, v14 row_shr:1 row_mask:0xf bank_mask:0xf bound_ctrl:1
    v_add_u32_dpp v15, v15, v15 row_shr:1 row_mask:0xf bank_mask:0xf bound_ctrl:1
    s_nop 0
    v_add_u32_dpp v14, v14, v14 row_shr:2 row_mask:0xf bank_mask:0xf bound_ctrl:1
    v_add_u32_dpp v15, v15, v15 row_shr:2 row_mask:0xf bank_mask:0xf bound_ctrl:1
    s_nop 0
    v_add_u32_dpp v14, v14, v14 row_shr:4 row_mask:0xf bank_mask:0xf bound_ctrl:1
    v_add_u32_dpp v15, v15, v15 row_shr:4 row_mask:0xf bank_mask:0xf bound_ctrl:1
    s_nop 0
    v_add_u32_dpp v14, v14, v14 row_shr:8 row_mask:0xf bank_mask:0xf bound_ctrl:1
    v_add_u32_dpp v15, v15, v15 row_shr:8 row_mask:0xf bank_mask:0xf bound_ctrl:1
    s_nop 0
    v_add_u32_dpp v14, v14, v14 row_bcast:15 row_mask:0xa bank_mask:0xf
    v_add_u32_dpp v15, v15, v15 row_bcast:15 row_mask:0xa bank_mask:0xf
    s_nop 0
    v_add_u32_dpp v14, v14, v14 row_bcast:31 row_mask:0xc bank_mask:0xf
    v_add_u32_dpp v15, v15, v15 row_bcast:31 row_mask:0xc bank_mask:0xf
    v_readlane_b32 s48, v14, 63
    v_readlane_b32 s49, v15, 63
    s_lshl_b32 s54, s32, 2
    v_mov_b32 v8, s54
    s_and_b32 s50, s48, 0xffff
    s_lshr_b32 s51, s48, 16
    s_and_b32 s52, s49, 0xffff
    s_lshr_b32 s53, s49, 16
    s_add_u32 s51, s51, s50
    s_add_u32 s52, s52, s51
    s_add_u32 s53, s53, s52
    v_mov_b32 v9, s53
    s_mov_b64 exec, 1
    ds_write_b32 v8, v9 offset:16384
    s_mov_b64 exec, -1
    v_and_b32 v8, 60, v7
    s_waitcnt lgkmcnt(0)
    s_barrier
    ds_read_b32 v9, v8 offset:16384
    s_waitcnt lgkmcnt(0)
    v_add_u32_dpp v9, v9, v9 row_shr:1 row_mask:0xf bank_mask:0xf bound_ctrl:1
    s_nop 1
    v_add_u32_dpp v9, v9, v9 row_shr:2 row_mask:0xf bank_mask:0xf bound_ctrl:1
    s_nop 1
    v_add_u32_dpp v9, v9, v9 row_shr:4 row_mask:0xf bank_mask:0xf bound_ctrl:1
    s_nop 1
    v_add_u32_dpp v9, v9, v9 row_shr:8 row_mask:0xf bank_mask:0xf bound_ctrl:1
    s_nop 0
    v_readlane_b32 s54, v9, s32
    s_sub_u32 s54, s54, s53
    s_add_u32 s50, s50, s54
    s_add_u32 s51, s51, s54
    s_add_u32 s52, s52, s54
    s_pack_ll_b32_b16 s48, s54, s50
    s_pack_ll_b32_b16 s49, s51, s52
    v_add_u32 v14, s48, v14
    v_add_u32 v15, s49, v15
    v_sub_u32 v12, v14, v12
    v_sub_u32 v13, v15, v13
    v_and_b32 v8, 0xffff, v12
    v_lshrrev_b32 v9, 16, v12
    v_and_b32 v10, 0xffff, v13
    v_lshrrev_b32 v11, 16, v13
    ds_write2st64_b32 v7, v8, v9 offset0:0 offset1:1
    ds_write2st64_b32 v7, v10, v11 offset0:2 offset1:3
    v_and_b32 v8, 0x3f0, v0
    v_lshl_add_u32 v8, v8, 1, s36
    ds_write_b64 v8, v[12:13] offset:20480
    s_bitset0_b64 exec, 63
    s_not_b64 exec, exec
    ds_write_b64 v8, v[14:15] offset:20512
    s_mov_b64 exec, -1
    s_waitcnt lgkmcnt(0)
    s_barrier
    s_setprio 3
    ds_add_rtn_u32 v72, v72, v2
    ds_add_rtn_u32 v73, v73, v2
    ds_add_rtn_u32 v74, v74, v2
    ds_add_rtn_u32 v75, v75, v2
    ds_read_b128 v[12:15], v0 offset:20480
    v_cmp_gt_u32 vcc, 8448, v0
    ds_add_rtn_u32 v80, v80, v2
    ds_add_rtn_u32 v81, v81, v2
    ds_add_rtn_u32 v82, v82, v2
    ds_add_rtn_u32 v83, v83, v2
    s_setprio 2
    ds_add_rtn_u32 v104, v104, v2
    ds_add_rtn_u32 v105, v105, v2
    ds_add_rtn_u32 v106, v106, v2
    ds_add_rtn_u32 v107, v107, v2
    s_waitcnt lgkmcnt(8)
    s_cbranch_vccz L1_p3
    s_add_u32 s45, s35, 0x5480000
    s_mov_b64 exec, vcc
    buffer_store_dwordx4 v[12:15], v0, s[24:27], s45 offen sc1
    s_mov_b64 exec, -1
L1_p3:
    s_add_u32 s46, s35, 0x2a54000
    buffer_store_dwordx4 v[48:51], v0, s[20:23], s46 offen sc1
    s_add_u32 s47, s33, 0x6400000
    s_nop 0
    buffer_load_dwordx4 v[48:51], v0, s[8:11], s47 offen nt
    ds_add_rtn_u32 v100, v100, v2
    ds_add_rtn_u32 v101, v101, v2
    ds_add_rtn_u32 v102, v102, v2
    ds_add_rtn_u32 v103, v103, v2
    s_setprio 1
    ds_add_rtn_u32 v116, v116, v2
    ds_add_rtn_u32 v117, v117, v2
    ds_add_rtn_u32 v118, v118, v2
    ds_add_rtn_u32 v119, v119, v2
    ds_add_rtn_u32 v16, v16, v2
    ds_add_rtn_u32 v17, v17, v2
    ds_add_rtn_u32 v18, v18, v2
    ds_add_rtn_u32 v19, v19, v2
    s_add_u32 s44, s35, 0x2a58000
    buffer_store_dwordx4 v[52:55], v0, s[20:23], s44 offen sc1
    s_add_u32 s45, s33, 0x6400000
    s_nop 0
    buffer_load_dwordx4 v[52:55], v0, s[12:15], s45 offen nt
    s_setprio 0
    ds_add_rtn_u32 v124, v124, v2
    ds_add_rtn_u32 v125, v125, v2
    ds_add_rtn_u32 v126, v126, v2
    ds_add_rtn_u32 v127, v127, v2
    ds_add_rtn_u32 v36, v36, v2
    ds_add_rtn_u32 v37, v37, v2
    ds_add_rtn_u32 v38, v38, v2
    ds_add_rtn_u32 v39, v39, v2
    s_waitcnt lgkmcnt(0)
    s_barrier
    s_setprio 3
    v_and_b32 v7, -4, v72
    v_lshl_add_u32 v8, v72, 2, v7
    ds_write_b32 v8, v68
    v_lshl_add_u32 v7, v7, 2, v72
    ds_write_b8 v7, v64 offset:16
    v_and_b32 v9, -4, v73
    v_lshl_add_u32 v10, v73, 2, v9
    ds_write_b32 v10, v69
    v_lshl_add_u32 v9, v9, 2, v73
    ds_write_b8_d16_hi v9, v64 offset:16
    v_and_b32 v7, -4, v74
    v_lshl_add_u32 v8, v74, 2, v7
    ds_write_b32 v8, v70
    v_lshl_add_u32 v7, v7, 2, v74
    ds_write_b8 v7, v65 offset:16
    v_and_b32 v9, -4, v75
    v_lshl_add_u32 v10, v75, 2, v9
    ds_write_b32 v10, v71
    v_lshl_add_u32 v9, v9, 2, v75
    ds_write_b8_d16_hi v9, v65 offset:16
    s_add_u32 s46, s35, 0x2a5c000
    buffer_store_dwordx4 v[56:59], v0, s[20:23], s46 offen sc1
    s_add_u32 s47, s33, 0x6800000
    buffer_load_dwordx4 v[68:71], v0, s[8:11], s47 offen nt
    s_add_u32 s44, s33, 0x6800000
    buffer_load_dwordx4 v[72:75], v0, s[12:15], s44 offen nt
    v_and_b32 v7, -4, v80
    v_lshl_add_u32 v8, v80, 2, v7
    ds_write_b32 v8, v76
    v_lshl_add_u32 v7, v7, 2, v80
    ds_write_b8 v7, v66 offset:16
    v_and_b32 v9, -4, v81
    v_lshl_add_u32 v10, v81, 2, v9
    ds_write_b32 v10, v77
    v_lshl_add_u32 v9, v9, 2, v81
    ds_write_b8_d16_hi v9, v66 offset:16
    v_and_b32 v7, -4, v82
    v_lshl_add_u32 v8, v82, 2, v7
    ds_write_b32 v8, v78
    v_lshl_add_u32 v7, v7, 2, v82
    ds_write_b8 v7, v67 offset:16
    v_and_b32 v9, -4, v83
    v_lshl_add_u32 v10, v83, 2, v9
    ds_write_b32 v10, v79
    v_lshl_add_u32 v9, v9, 2, v83
    ds_write_b8_d16_hi v9, v67 offset:16
    s_add_u32 s45, s34, 0x3400000
    buffer_load_dwordx2 v[56:57], v1, s[16:19], s45 offen nt
    s_add_u32 s46, s34, 0x3600000
    buffer_load_dwordx2 v[58:59], v1, s[16:19], s46 offen nt
    s_add_u32 s47, s33, 0x6c00000
    buffer_load_dwordx4 v[76:79], v0, s[8:11], s47 offen nt
    s_setprio 2
    v_and_b32 v7, -4, v104
    v_lshl_add_u32 v8, v104, 2, v7
    ds_write_b32 v8, v96
    v_lshl_add_u32 v7, v7, 2, v104
    ds_write_b8 v7, v88 offset:16
    v_and_b32 v9, -4, v105
    v_lshl_add_u32 v10, v105, 2, v9
    ds_write_b32 v10, v97
    v_lshl_add_u32 v9, v9, 2, v105
    ds_write_b8_d16_hi v9, v88 offset:16
    v_and_b32 v7, -4, v106
    v_lshl_add_u32 v8, v106, 2, v7
    ds_write_b32 v8, v98
    v_lshl_add_u32 v7, v7, 2, v106
    ds_write_b8 v7, v89 offset:16
    v_and_b32 v9, -4, v107
    v_lshl_add_u32 v10, v107, 2, v9
    ds_write_b32 v10, v99
    v_lshl_add_u32 v9, v9, 2, v107
    ds_write_b8_d16_hi v9, v89 offset:16
    s_add_u32 s44, s35, 0x2a60000
    buffer_store_dwordx4 v[60:63], v0, s[20:23], s44 offen sc1
    s_add_u32 s45, s33, 0x6c00000
    buffer_load_dwordx4 v[80:83], v0, s[12:15], s45 offen nt
    v_and_b32 v7, -4, v100
    v_lshl_add_u32 v8, v100, 2, v7
    ds_write_b32 v8, v112
    v_lshl_add_u32 v7, v7, 2, v100
    ds_write_b8 v7, v90 offset:16
    v_and_b32 v9, -4, v101
    v_lshl_add_u32 v10, v101, 2, v9
    ds_write_b32 v10, v113
    v_lshl_add_u32 v9, v9, 2, v101
    ds_write_b8_d16_hi v9, v90 offset:16
    v_and_b32 v7, -4, v102
    v_lshl_add_u32 v8, v102, 2, v7
    ds_write_b32 v8, v114
    v_lshl_add_u32 v7, v7, 2, v102
    ds_write_b8 v7, v91 offset:16
    v_and_b32 v9, -4, v103
    v_lshl_add_u32 v10, v103, 2, v9
    ds_write_b32 v10, v115
    v_lshl_add_u32 v9, v9, 2, v103
    ds_write_b8_d16_hi v9, v91 offset:16
    s_add_u32 s46, s33, 0x7000000
    buffer_load_dwordx4 v[64:67], v0, s[8:11], s46 offen nt
    s_add_u32 s47, s33, 0x7000000
    buffer_load_dwordx4 v[96:99], v0, s[12:15], s47 offen nt
    s_setprio 1
    v_and_b32 v7, -4, v116
    v_lshl_add_u32 v8, v116, 2, v7
    ds_write_b32 v8, v108
    v_lshl_add_u32 v7, v7, 2, v116
    ds_write_b8 v7, v120 offset:16
    v_and_b32 v9, -4, v117
    v_lshl_add_u32 v10, v117, 2, v9
    ds_write_b32 v10, v109
    v_lshl_add_u32 v9, v9, 2, v117
    ds_write_b8_d16_hi v9, v120 offset:16
    v_and_b32 v7, -4, v118
    v_lshl_add_u32 v8, v118, 2, v7
    ds_write_b32 v8, v110
    v_lshl_add_u32 v7, v7, 2, v118
    ds_write_b8 v7, v121 offset:16
    v_and_b32 v9, -4, v119
    v_lshl_add_u32 v10, v119, 2, v9
    ds_write_b32 v10, v111
    v_lshl_add_u32 v9, v9, 2, v119
    ds_write_b8_d16_hi v9, v121 offset:16
    s_add_u32 s44, s34, 0x3800000
    buffer_load_dwordx2 v[104:105], v1, s[16:19], s44 offen nt
    s_add_u32 s45, s34, 0x3a00000
    buffer_load_dwordx2 v[106:107], v1, s[16:19], s45 offen nt
    s_add_u32 s46, s33, 0x7400000
    buffer_load_dwordx4 v[60:63], v0, s[8:11], s46 offen nt
    v_and_b32 v7, -4, v16
    v_lshl_add_u32 v8, v16, 2, v7
    ds_write_b32 v8, v92
    v_lshl_add_u32 v7, v7, 2, v16
    ds_write_b8 v7, v122 offset:16
    v_and_b32 v9, -4, v17
    v_lshl_add_u32 v10, v17, 2, v9
    ds_write_b32 v10, v93
    v_lshl_add_u32 v9, v9, 2, v17
    ds_write_b8_d16_hi v9, v122 offset:16
    v_and_b32 v7, -4, v18
    v_lshl_add_u32 v8, v18, 2, v7
    ds_write_b32 v8, v94
    v_lshl_add_u32 v7, v7, 2, v18
    ds_write_b8 v7, v123 offset:16
    v_and_b32 v9, -4, v19
    v_lshl_add_u32 v10, v19, 2, v9
    ds_write_b32 v10, v95
    v_lshl_add_u32 v9, v9, 2, v19
    ds_write_b8_d16_hi v9, v123 offset:16
    s_add_u32 s47, s35, 0x2a64000
    buffer_store_dwordx4 v[44:47], v0, s[20:23], s47 offen sc1
    s_add_u32 s44, s33, 0x7400000
    buffer_load_dwordx4 v[112:115], v0, s[12:15], s44 offen nt
    s_setprio 0
    v_and_b32 v7, -4, v124
    v_lshl_add_u32 v8, v124, 2, v7
    ds_write_b32 v8, v20
    v_lshl_add_u32 v7, v7, 2, v124
    ds_write_b8 v7, v28 offset:16
    v_and_b32 v9, -4, v125
    v_lshl_add_u32 v10, v125, 2, v9
    ds_write_b32 v10, v21
    v_lshl_add_u32 v9, v9, 2, v125
    ds_write_b8_d16_hi v9, v28 offset:16
    v_and_b32 v7, -4, v126
    v_lshl_add_u32 v8, v126, 2, v7
    ds_write_b32 v8, v22
    v_lshl_add_u32 v7, v7, 2, v126
    ds_write_b8 v7, v29 offset:16
    v_and_b32 v9, -4, v127
    v_lshl_add_u32 v10, v127, 2, v9
    ds_write_b32 v10, v23
    v_lshl_add_u32 v9, v9, 2, v127
    ds_write_b8_d16_hi v9, v29 offset:16
    s_add_u32 s45, s33, 0x7800000
    buffer_load_dwordx4 v[100:103], v0, s[8:11], s45 offen nt
    s_add_u32 s46, s33, 0x7800000
    buffer_load_dwordx4 v[88:91], v0, s[12:15], s46 offen nt
    v_and_b32 v7, -4, v36
    v_lshl_add_u32 v8, v36, 2, v7
    ds_write_b32 v8, v32
    v_lshl_add_u32 v7, v7, 2, v36
    ds_write_b8 v7, v30 offset:16
    v_and_b32 v9, -4, v37
    v_lshl_add_u32 v10, v37, 2, v9
    ds_write_b32 v10, v33
    v_lshl_add_u32 v9, v9, 2, v37
    ds_write_b8_d16_hi v9, v30 offset:16
    v_and_b32 v7, -4, v38
    v_lshl_add_u32 v8, v38, 2, v7
    ds_write_b32 v8, v34
    v_lshl_add_u32 v7, v7, 2, v38
    ds_write_b8 v7, v31 offset:16
    v_and_b32 v9, -4, v39
    v_lshl_add_u32 v10, v39, 2, v9
    ds_write_b32 v10, v35
    v_lshl_add_u32 v9, v9, 2, v39
    ds_write_b8_d16_hi v9, v31 offset:16
    s_add_u32 s47, s34, 0x3c00000
    buffer_load_dwordx2 v[108:109], v1, s[16:19], s47 offen nt
    s_add_u32 s44, s34, 0x3e00000
    buffer_load_dwordx2 v[110:111], v1, s[16:19], s44 offen nt
    v_add_u32 v7, 0x10000, v0
    v_add_u32 v12, 0x20000, v0
    v_mov_b32 v8, 0
    v_mov_b32 v9, 0
    v_mov_b32 v10, 0
    v_mov_b32 v11, 0
    s_waitcnt lgkmcnt(0)
    s_barrier
    ds_read_b128 v[116:119], v0 offset:0
    ds_write_b128 v0, v[8:11]
    ds_read_b128 v[92:95], v0 offset:16384
    ds_read_b128 v[16:19], v0 offset:32768
    ds_read_b128 v[120:123], v0 offset:49152
    ds_read_b128 v[44:47], v7 offset:0
    ds_read_b128 v[20:23], v7 offset:16384
    ds_read_b128 v[124:127], v7 offset:32768
    ds_read_b128 v[32:35], v7 offset:49152
    ds_read_b128 v[36:39], v12 offset:0
    ds_read_b128 v[28:31], v12 offset:16384
    s_waitcnt lgkmcnt(0)
    s_barrier
    s_setprio 3
    s_add_u32 s45, s35, 0x5480000
    buffer_store_dwordx4 v[116:119], v0, s[20:23], s45 offen sc1
    s_add_u32 s46, s33, 0x7c00000
    s_nop 0
    buffer_load_dwordx4 v[116:119], v0, s[8:11], s46 offen nt
    s_add_u32 s47, s35, 0x5484000
    buffer_store_dwordx4 v[92:95], v0, s[20:23], s47 offen sc1
    s_add_u32 s44, s33, 0x7c00000
    s_nop 0
    buffer_load_dwordx4 v[92:95], v0, s[12:15], s44 offen nt
    s_waitcnt vmcnt(27)
    v_lshlrev_b32 v7, 16, v84
    v_and_b32 v8, 0xffff0000, v84
    v_lshlrev_b32 v9, 16, v85
    v_and_b32 v10, 0xffff0000, v85
    v_mul_f32 v7, 0.15915494, v7
    v_mul_f32 v8, 0.15915494, v8
    v_mul_f32 v9, 0.15915494, v9
    v_mul_f32 v10, 0.15915494, v10
    v_mul_hi_u32_u24 v14, 429497, v40
    v_lshrrev_b32 v12, 3, v24
    v_cos_f32 v7, v7
    v_lshlrev_b16 v13, 3, v24
    v_mad_i32_i24 v11, v14, s55, v40
    v_bitop3_b32 v12, v6, v13, v12 bitop3:0xca
    v_lshl_add_u32 v11, v11, 17, s40
    v_lshlrev_b16 v14, 8, v14
    v_lshrrev_b32 v13, 2, v24
    v_add_u32 v40, v12, v11
    v_bitop3_b32 v24, v5, v13, v14 bitop3:0xea
    ds_add_u32 v24, v2
    v_mul_hi_u32_u24 v14, 429497, v41
    v_lshrrev_b32 v12, 3, v25
    v_cos_f32 v8, v8
    v_lshlrev_b16 v13, 3, v25
    v_mad_i32_i24 v11, v14, s55, v41
    v_bitop3_b32 v12, v6, v13, v12 bitop3:0xca
    v_lshl_add_u32 v11, v11, 17, s40
    v_lshlrev_b16 v14, 8, v14
    v_lshrrev_b32 v13, 2, v25
    v_add_u32 v41, v12, v11
    v_bitop3_b32 v25, v5, v13, v14 bitop3:0xea
    ds_add_u32 v25, v2
    v_cvt_pk_bf16_f32 v84, v7, v8
    v_perm_b32 v12, v84, v84, s41
    v_bitop3_b32 v40, v4, v12, v40 bitop3:0xca
    v_perm_b32 v13, v84, v84, s42
    v_bitop3_b32 v41, v4, v13, v41 bitop3:0xca
    v_mul_hi_u32_u24 v14, 429497, v42
    v_lshrrev_b32 v12, 3, v26
    v_cos_f32 v9, v9
    v_lshlrev_b16 v13, 3, v26
    v_mad_i32_i24 v11, v14, s55, v42
    v_bitop3_b32 v12, v6, v13, v12 bitop3:0xca
    v_lshl_add_u32 v11, v11, 17, s40
    v_lshlrev_b16 v14, 8, v14
    v_lshrrev_b32 v13, 2, v26
    v_add_u32 v42, v12, v11
    v_bitop3_b32 v26, v5, v13, v14 bitop3:0xea
    ds_add_u32 v26, v2
    v_mul_hi_u32_u24 v14, 429497, v43
    v_lshrrev_b32 v12, 3, v27
    v_cos_f32 v10, v10
    v_lshlrev_b16 v13, 3, v27
    v_mad_i32_i24 v11, v14, s55, v43
    v_bitop3_b32 v12, v6, v13, v12 bitop3:0xca
    v_lshl_add_u32 v11, v11, 17, s40
    v_lshlrev_b16 v14, 8, v14
    v_lshrrev_b32 v13, 2, v27
    v_add_u32 v43, v12, v11
    v_bitop3_b32 v27, v5, v13, v14 bitop3:0xea
    ds_add_u32 v27, v2
    v_cvt_pk_bf16_f32 v85, v9, v10
    v_perm_b32 v12, v85, v85, s41
    v_bitop3_b32 v42, v4, v12, v42 bitop3:0xca
    v_perm_b32 v13, v85, v85, s42
    v_bitop3_b32 v43, v4, v13, v43 bitop3:0xca
    s_waitcnt vmcnt(23)
    v_lshlrev_b32 v7, 16, v86
    v_and_b32 v8, 0xffff0000, v86
    v_lshlrev_b32 v9, 16, v87
    v_and_b32 v10, 0xffff0000, v87
    v_mul_f32 v7, 0.15915494, v7
    v_mul_f32 v8, 0.15915494, v8
    v_mul_f32 v9, 0.15915494, v9
    v_mul_f32 v10, 0.15915494, v10
    v_mul_hi_u32_u24 v14, 429497, v48
    v_lshrrev_b32 v12, 3, v52
    v_cos_f32 v7, v7
    v_lshlrev_b16 v13, 3, v52
    v_mad_i32_i24 v11, v14, s55, v48
    v_bitop3_b32 v12, v6, v13, v12 bitop3:0xca
    v_lshl_add_u32 v11, v11, 17, s40
    v_lshlrev_b16 v14, 8, v14
    v_lshrrev_b32 v13, 2, v52
    v_add_u32 v48, v12, v11
    v_bitop3_b32 v52, v5, v13, v14 bitop3:0xea
    ds_add_u32 v52, v2
    v_mul_hi_u32_u24 v14, 429497, v49
    v_lshrrev_b32 v12, 3, v53
    v_cos_f32 v8, v8
    v_lshlrev_b16 v13, 3, v53
    v_mad_i32_i24 v11, v14, s55, v49
    v_bitop3_b32 v12, v6, v13, v12 bitop3:0xca
    v_lshl_add_u32 v11, v11, 17, s40
    v_lshlrev_b16 v14, 8, v14
    v_lshrrev_b32 v13, 2, v53
    v_add_u32 v49, v12, v11
    v_bitop3_b32 v53, v5, v13, v14 bitop3:0xea
    ds_add_u32 v53, v2
    v_cvt_pk_bf16_f32 v86, v7, v8
    v_perm_b32 v12, v86, v86, s41
    v_bitop3_b32 v48, v4, v12, v48 bitop3:0xca
    v_perm_b32 v13, v86, v86, s42
    v_bitop3_b32 v49, v4, v13, v49 bitop3:0xca
    v_mul_hi_u32_u24 v14, 429497, v50
    v_lshrrev_b32 v12, 3, v54
    v_cos_f32 v9, v9
    v_lshlrev_b16 v13, 3, v54
    v_mad_i32_i24 v11, v14, s55, v50
    v_bitop3_b32 v12, v6, v13, v12 bitop3:0xca
    v_lshl_add_u32 v11, v11, 17, s40
    v_lshlrev_b16 v14, 8, v14
    v_lshrrev_b32 v13, 2, v54
    v_add_u32 v50, v12, v11
    v_bitop3_b32 v54, v5, v13, v14 bitop3:0xea
    ds_add_u32 v54, v2
    v_mul_hi_u32_u24 v14, 429497, v51
    v_lshrrev_b32 v12, 3, v55
    v_cos_f32 v10, v10
    v_lshlrev_b16 v13, 3, v55
    v_mad_i32_i24 v11, v14, s55, v51
    v_bitop3_b32 v12, v6, v13, v12 bitop3:0xca
    v_lshl_add_u32 v11, v11, 17, s40
    v_lshlrev_b16 v14, 8, v14
    v_lshrrev_b32 v13, 2, v55
    v_add_u32 v51, v12, v11
    v_bitop3_b32 v55, v5, v13, v14 bitop3:0xea
    ds_add_u32 v55, v2
    v_cvt_pk_bf16_f32 v87, v9, v10
    v_perm_b32 v12, v87, v87, s41
    v_bitop3_b32 v50, v4, v12, v50 bitop3:0xca
    v_perm_b32 v13, v87, v87, s42
    v_bitop3_b32 v51, v4, v13, v51 bitop3:0xca
    s_setprio 2
    s_waitcnt vmcnt(18)
    v_lshlrev_b32 v7, 16, v56
    v_and_b32 v8, 0xffff0000, v56
    v_lshlrev_b32 v9, 16, v57
    v_and_b32 v10, 0xffff0000, v57
    v_mul_f32 v7, 0.15915494, v7
    v_mul_f32 v8, 0.15915494, v8
    v_mul_f32 v9, 0.15915494, v9
    v_mul_f32 v10, 0.15915494, v10
    v_mul_hi_u32_u24 v14, 429497, v68
    v_lshrrev_b32 v12, 3, v72
    v_cos_f32 v7, v7
    v_lshlrev_b16 v13, 3, v72
    v_mad_i32_i24 v11, v14, s55, v68
    v_bitop3_b32 v12, v6, v13, v12 bitop3:0xca
    v_lshl_add_u32 v11, v11, 17, s40
    v_lshlrev_b16 v14, 8, v14
    v_lshrrev_b32 v13, 2, v72
    v_add_u32 v68, v12, v11
    v_bitop3_b32 v72, v5, v13, v14 bitop3:0xea
    ds_add_u32 v72, v2
    v_mul_hi_u32_u24 v14, 429497, v69
    v_lshrrev_b32 v12, 3, v73
    v_cos_f32 v8, v8
    v_lshlrev_b16 v13, 3, v73
    v_mad_i32_i24 v11, v14, s55, v69
    v_bitop3_b32 v12, v6, v13, v12 bitop3:0xca
    v_lshl_add_u32 v11, v11, 17, s40
    v_lshlrev_b16 v14, 8, v14
    v_lshrrev_b32 v13, 2, v73
    v_add_u32 v69, v12, v11
    v_bitop3_b32 v73, v5, v13, v14 bitop3:0xea
    ds_add_u32 v73, v2
    v_cvt_pk_bf16_f32 v56, v7, v8
    v_perm_b32 v12, v56, v56, s41
    v_bitop3_b32 v68, v4, v12, v68 bitop3:0xca
    v_perm_b32 v13, v56, v56, s42
    v_bitop3_b32 v69, v4, v13, v69 bitop3:0xca
    v_mul_hi_u32_u24 v14, 429497, v70
    v_lshrrev_b32 v12, 3, v74
    v_cos_f32 v9, v9
    v_lshlrev_b16 v13, 3, v74
    v_mad_i32_i24 v11, v14, s55, v70
    v_bitop3_b32 v12, v6, v13, v12 bitop3:0xca
    v_lshl_add_u32 v11, v11, 17, s40
    v_lshlrev_b16 v14, 8, v14
    v_lshrrev_b32 v13, 2, v74
    v_add_u32 v70, v12, v11
    v_bitop3_b32 v74, v5, v13, v14 bitop3:0xea
    ds_add_u32 v74, v2
    v_mul_hi_u32_u24 v14, 429497, v71
    v_lshrrev_b32 v12, 3, v75
    v_cos_f32 v10, v10
    v_lshlrev_b16 v13, 3, v75
    v_mad_i32_i24 v11, v14, s55, v71
    v_bitop3_b32 v12, v6, v13, v12 bitop3:0xca
    v_lshl_add_u32 v11, v11, 17, s40
    v_lshlrev_b16 v14, 8, v14
    v_lshrrev_b32 v13, 2, v75
    v_add_u32 v71, v12, v11
    v_bitop3_b32 v75, v5, v13, v14 bitop3:0xea
    ds_add_u32 v75, v2
    v_cvt_pk_bf16_f32 v57, v9, v10
    v_perm_b32 v12, v57, v57, s41
    v_bitop3_b32 v70, v4, v12, v70 bitop3:0xca
    v_perm_b32 v13, v57, v57, s42
    v_bitop3_b32 v71, v4, v13, v71 bitop3:0xca
    s_add_u32 s45, s35, 0x5488000
    buffer_store_dwordx4 v[16:19], v0, s[20:23], s45 offen sc1
    s_add_u32 s46, s33, 0x8000000
    s_nop 0
    buffer_load_dwordx4 v[16:19], v0, s[8:11], s46 offen nt
    s_waitcnt vmcnt(17)
    v_lshlrev_b32 v7, 16, v58
    v_and_b32 v8, 0xffff0000, v58
    v_lshlrev_b32 v9, 16, v59
    v_and_b32 v10, 0xffff0000, v59
    v_mul_f32 v7, 0.15915494, v7
    v_mul_f32 v8, 0.15915494, v8
    v_mul_f32 v9, 0.15915494, v9
    v_mul_f32 v10, 0.15915494, v10
    v_mul_hi_u32_u24 v14, 429497, v76
    v_lshrrev_b32 v12, 3, v80
    v_cos_f32 v7, v7
    v_lshlrev_b16 v13, 3, v80
    v_mad_i32_i24 v11, v14, s55, v76
    v_bitop3_b32 v12, v6, v13, v12 bitop3:0xca
    v_lshl_add_u32 v11, v11, 17, s40
    v_lshlrev_b16 v14, 8, v14
    v_lshrrev_b32 v13, 2, v80
    v_add_u32 v76, v12, v11
    v_bitop3_b32 v80, v5, v13, v14 bitop3:0xea
    ds_add_u32 v80, v2
    v_mul_hi_u32_u24 v14, 429497, v77
    v_lshrrev_b32 v12, 3, v81
    v_cos_f32 v8, v8
    v_lshlrev_b16 v13, 3, v81
    v_mad_i32_i24 v11, v14, s55, v77
    v_bitop3_b32 v12, v6, v13, v12 bitop3:0xca
    v_lshl_add_u32 v11, v11, 17, s40
    v_lshlrev_b16 v14, 8, v14
    v_lshrrev_b32 v13, 2, v81
    v_add_u32 v77, v12, v11
    v_bitop3_b32 v81, v5, v13, v14 bitop3:0xea
    ds_add_u32 v81, v2
    v_cvt_pk_bf16_f32 v58, v7, v8
    v_perm_b32 v12, v58, v58, s41
    v_bitop3_b32 v76, v4, v12, v76 bitop3:0xca
    v_perm_b32 v13, v58, v58, s42
    v_bitop3_b32 v77, v4, v13, v77 bitop3:0xca
    v_mul_hi_u32_u24 v14, 429497, v78
    v_lshrrev_b32 v12, 3, v82
    v_cos_f32 v9, v9
    v_lshlrev_b16 v13, 3, v82
    v_mad_i32_i24 v11, v14, s55, v78
    v_bitop3_b32 v12, v6, v13, v12 bitop3:0xca
    v_lshl_add_u32 v11, v11, 17, s40
    v_lshlrev_b16 v14, 8, v14
    v_lshrrev_b32 v13, 2, v82
    v_add_u32 v78, v12, v11
    v_bitop3_b32 v82, v5, v13, v14 bitop3:0xea
    ds_add_u32 v82, v2
    v_mul_hi_u32_u24 v14, 429497, v79
    v_lshrrev_b32 v12, 3, v83
    v_cos_f32 v10, v10
    v_lshlrev_b16 v13, 3, v83
    v_mad_i32_i24 v11, v14, s55, v79
    v_bitop3_b32 v12, v6, v13, v12 bitop3:0xca
    v_lshl_add_u32 v11, v11, 17, s40
    v_lshlrev_b16 v14, 8, v14
    v_lshrrev_b32 v13, 2, v83
    v_add_u32 v79, v12, v11
    v_bitop3_b32 v83, v5, v13, v14 bitop3:0xea
    ds_add_u32 v83, v2
    v_cvt_pk_bf16_f32 v59, v9, v10
    v_perm_b32 v12, v59, v59, s41
    v_bitop3_b32 v78, v4, v12, v78 bitop3:0xca
    v_perm_b32 v13, v59, v59, s42
    v_bitop3_b32 v79, v4, v13, v79 bitop3:0xca
    s_setprio 1
    s_waitcnt vmcnt(13)
    v_lshlrev_b32 v7, 16, v104
    v_and_b32 v8, 0xffff0000, v104
    v_lshlrev_b32 v9, 16, v105
    v_and_b32 v10, 0xffff0000, v105
    v_mul_f32 v7, 0.15915494, v7
    v_mul_f32 v8, 0.15915494, v8
    v_mul_f32 v9, 0.15915494, v9
    v_mul_f32 v10, 0.15915494, v10
    v_mul_hi_u32_u24 v14, 429497, v64
    v_lshrrev_b32 v12, 3, v96
    v_cos_f32 v7, v7
    v_lshlrev_b16 v13, 3, v96
    v_mad_i32_i24 v11, v14, s55, v64
    v_bitop3_b32 v12, v6, v13, v12 bitop3:0xca
    v_lshl_add_u32 v11, v11, 17, s40
    v_lshlrev_b16 v14, 8, v14
    v_lshrrev_b32 v13, 2, v96
    v_add_u32 v64, v12, v11
    v_bitop3_b32 v96, v5, v13, v14 bitop3:0xea
    ds_add_u32 v96, v2
    v_mul_hi_u32_u24 v14, 429497, v65
    v_lshrrev_b32 v12, 3, v97
    v_cos_f32 v8, v8
    v_lshlrev_b16 v13, 3, v97
    v_mad_i32_i24 v11, v14, s55, v65
    v_bitop3_b32 v12, v6, v13, v12 bitop3:0xca
    v_lshl_add_u32 v11, v11, 17, s40
    v_lshlrev_b16 v14, 8, v14
    v_lshrrev_b32 v13, 2, v97
    v_add_u32 v65, v12, v11
    v_bitop3_b32 v97, v5, v13, v14 bitop3:0xea
    ds_add_u32 v97, v2
    v_cvt_pk_bf16_f32 v104, v7, v8
    v_perm_b32 v12, v104, v104, s41
    v_bitop3_b32 v64, v4, v12, v64 bitop3:0xca
    v_perm_b32 v13, v104, v104, s42
    v_bitop3_b32 v65, v4, v13, v65 bitop3:0xca
    v_mul_hi_u32_u24 v14, 429497, v66
    v_lshrrev_b32 v12, 3, v98
    v_cos_f32 v9, v9
    v_lshlrev_b16 v13, 3, v98
    v_mad_i32_i24 v11, v14, s55, v66
    v_bitop3_b32 v12, v6, v13, v12 bitop3:0xca
    v_lshl_add_u32 v11, v11, 17, s40
    v_lshlrev_b16 v14, 8, v14
    v_lshrrev_b32 v13, 2, v98
    v_add_u32 v66, v12, v11
    v_bitop3_b32 v98, v5, v13, v14 bitop3:0xea
    ds_add_u32 v98, v2
    v_mul_hi_u32_u24 v14, 429497, v67
    v_lshrrev_b32 v12, 3, v99
    v_cos_f32 v10, v10
    v_lshlrev_b16 v13, 3, v99
    v_mad_i32_i24 v11, v14, s55, v67
    v_bitop3_b32 v12, v6, v13, v12 bitop3:0xca
    v_lshl_add_u32 v11, v11, 17, s40
    v_lshlrev_b16 v14, 8, v14
    v_lshrrev_b32 v13, 2, v99
    v_add_u32 v67, v12, v11
    v_bitop3_b32 v99, v5, v13, v14 bitop3:0xea
    ds_add_u32 v99, v2
    v_cvt_pk_bf16_f32 v105, v9, v10
    v_perm_b32 v12, v105, v105, s41
    v_bitop3_b32 v66, v4, v12, v66 bitop3:0xca
    v_perm_b32 v13, v105, v105, s42
    v_bitop3_b32 v67, v4, v13, v67 bitop3:0xca
    s_waitcnt vmcnt(10)
    v_lshlrev_b32 v7, 16, v106
    v_and_b32 v8, 0xffff0000, v106
    v_lshlrev_b32 v9, 16, v107
    v_and_b32 v10, 0xffff0000, v107
    v_mul_f32 v7, 0.15915494, v7
    v_mul_f32 v8, 0.15915494, v8
    v_mul_f32 v9, 0.15915494, v9
    v_mul_f32 v10, 0.15915494, v10
    v_mul_hi_u32_u24 v14, 429497, v60
    v_lshrrev_b32 v12, 3, v112
    v_cos_f32 v7, v7
    v_lshlrev_b16 v13, 3, v112
    v_mad_i32_i24 v11, v14, s55, v60
    v_bitop3_b32 v12, v6, v13, v12 bitop3:0xca
    v_lshl_add_u32 v11, v11, 17, s40
    v_lshlrev_b16 v14, 8, v14
    v_lshrrev_b32 v13, 2, v112
    v_add_u32 v60, v12, v11
    v_bitop3_b32 v112, v5, v13, v14 bitop3:0xea
    ds_add_u32 v112, v2
    v_mul_hi_u32_u24 v14, 429497, v61
    v_lshrrev_b32 v12, 3, v113
    v_cos_f32 v8, v8
    v_lshlrev_b16 v13, 3, v113
    v_mad_i32_i24 v11, v14, s55, v61
    v_bitop3_b32 v12, v6, v13, v12 bitop3:0xca
    v_lshl_add_u32 v11, v11, 17, s40
    v_lshlrev_b16 v14, 8, v14
    v_lshrrev_b32 v13, 2, v113
    v_add_u32 v61, v12, v11
    v_bitop3_b32 v113, v5, v13, v14 bitop3:0xea
    ds_add_u32 v113, v2
    v_cvt_pk_bf16_f32 v106, v7, v8
    v_perm_b32 v12, v106, v106, s41
    v_bitop3_b32 v60, v4, v12, v60 bitop3:0xca
    v_perm_b32 v13, v106, v106, s42
    v_bitop3_b32 v61, v4, v13, v61 bitop3:0xca
    v_mul_hi_u32_u24 v14, 429497, v62
    v_lshrrev_b32 v12, 3, v114
    v_cos_f32 v9, v9
    v_lshlrev_b16 v13, 3, v114
    v_mad_i32_i24 v11, v14, s55, v62
    v_bitop3_b32 v12, v6, v13, v12 bitop3:0xca
    v_lshl_add_u32 v11, v11, 17, s40
    v_lshlrev_b16 v14, 8, v14
    v_lshrrev_b32 v13, 2, v114
    v_add_u32 v62, v12, v11
    v_bitop3_b32 v114, v5, v13, v14 bitop3:0xea
    ds_add_u32 v114, v2
    v_mul_hi_u32_u24 v14, 429497, v63
    v_lshrrev_b32 v12, 3, v115
    v_cos_f32 v10, v10
    v_lshlrev_b16 v13, 3, v115
    v_mad_i32_i24 v11, v14, s55, v63
    v_bitop3_b32 v12, v6, v13, v12 bitop3:0xca
    v_lshl_add_u32 v11, v11, 17, s40
    v_lshlrev_b16 v14, 8, v14
    v_lshrrev_b32 v13, 2, v115
    v_add_u32 v63, v12, v11
    v_bitop3_b32 v115, v5, v13, v14 bitop3:0xea
    ds_add_u32 v115, v2
    v_cvt_pk_bf16_f32 v107, v9, v10
    v_perm_b32 v12, v107, v107, s41
    v_bitop3_b32 v62, v4, v12, v62 bitop3:0xca
    v_perm_b32 v13, v107, v107, s42
    v_bitop3_b32 v63, v4, v13, v63 bitop3:0xca
    s_setprio 0
    s_add_u32 s47, s35, 0x548c000
    buffer_store_dwordx4 v[120:123], v0, s[20:23], s47 offen sc1
    s_add_u32 s44, s33, 0x8000000
    s_nop 0
    buffer_load_dwordx4 v[120:123], v0, s[12:15], s44 offen nt
    s_waitcnt vmcnt(8)
    v_lshlrev_b32 v7, 16, v108
    v_and_b32 v8, 0xffff0000, v108
    v_lshlrev_b32 v9, 16, v109
    v_and_b32 v10, 0xffff0000, v109
    v_mul_f32 v7, 0.15915494, v7
    v_mul_f32 v8, 0.15915494, v8
    v_mul_f32 v9, 0.15915494, v9
    v_mul_f32 v10, 0.15915494, v10
    v_mul_hi_u32_u24 v14, 429497, v100
    v_lshrrev_b32 v12, 3, v88
    v_cos_f32 v7, v7
    v_lshlrev_b16 v13, 3, v88
    v_mad_i32_i24 v11, v14, s55, v100
    v_bitop3_b32 v12, v6, v13, v12 bitop3:0xca
    v_lshl_add_u32 v11, v11, 17, s40
    v_lshlrev_b16 v14, 8, v14
    v_lshrrev_b32 v13, 2, v88
    v_add_u32 v100, v12, v11
    v_bitop3_b32 v88, v5, v13, v14 bitop3:0xea
    ds_add_u32 v88, v2
    v_mul_hi_u32_u24 v14, 429497, v101
    v_lshrrev_b32 v12, 3, v89
    v_cos_f32 v8, v8
    v_lshlrev_b16 v13, 3, v89
    v_mad_i32_i24 v11, v14, s55, v101
    v_bitop3_b32 v12, v6, v13, v12 bitop3:0xca
    v_lshl_add_u32 v11, v11, 17, s40
    v_lshlrev_b16 v14, 8, v14
    v_lshrrev_b32 v13, 2, v89
    v_add_u32 v101, v12, v11
    v_bitop3_b32 v89, v5, v13, v14 bitop3:0xea
    ds_add_u32 v89, v2
    v_cvt_pk_bf16_f32 v108, v7, v8
    v_perm_b32 v12, v108, v108, s41
    v_bitop3_b32 v100, v4, v12, v100 bitop3:0xca
    v_perm_b32 v13, v108, v108, s42
    v_bitop3_b32 v101, v4, v13, v101 bitop3:0xca
    v_mul_hi_u32_u24 v14, 429497, v102
    v_lshrrev_b32 v12, 3, v90
    v_cos_f32 v9, v9
    v_lshlrev_b16 v13, 3, v90
    v_mad_i32_i24 v11, v14, s55, v102
    v_bitop3_b32 v12, v6, v13, v12 bitop3:0xca
    v_lshl_add_u32 v11, v11, 17, s40
    v_lshlrev_b16 v14, 8, v14
    v_lshrrev_b32 v13, 2, v90
    v_add_u32 v102, v12, v11
    v_bitop3_b32 v90, v5, v13, v14 bitop3:0xea
    ds_add_u32 v90, v2
    v_mul_hi_u32_u24 v14, 429497, v103
    v_lshrrev_b32 v12, 3, v91
    v_cos_f32 v10, v10
    v_lshlrev_b16 v13, 3, v91
    v_mad_i32_i24 v11, v14, s55, v103
    v_bitop3_b32 v12, v6, v13, v12 bitop3:0xca
    v_lshl_add_u32 v11, v11, 17, s40
    v_lshlrev_b16 v14, 8, v14
    v_lshrrev_b32 v13, 2, v91
    v_add_u32 v103, v12, v11
    v_bitop3_b32 v91, v5, v13, v14 bitop3:0xea
    ds_add_u32 v91, v2
    v_cvt_pk_bf16_f32 v109, v9, v10
    v_perm_b32 v12, v109, v109, s41
    v_bitop3_b32 v102, v4, v12, v102 bitop3:0xca
    v_perm_b32 v13, v109, v109, s42
    v_bitop3_b32 v103, v4, v13, v103 bitop3:0xca
    s_mov_b32 s68, s66
    s_mov_b32 s69, s67
    s_mov_b32 s70, 0x100
    s_mov_b32 s71, 0x20000
    v_mov_b32 v3, 1
    s_cmp_lg_u32 s32, 15
    s_cbranch_scc1 L1_tk
    s_mov_b64 exec, 1
    s_and_b32 s3, s2, 1
    s_lshl_b32 s3, s3, 7
    buffer_atomic_add v3, off, s[68:71], s3 sc0
    s_mov_b64 exec, -1
L1_tk:
    s_waitcnt vmcnt(4)
    v_lshlrev_b32 v7, 16, v110
    v_and_b32 v8, 0xffff0000, v110
    v_lshlrev_b32 v9, 16, v111
    v_and_b32 v10, 0xffff0000, v111
    v_mul_f32 v7, 0.15915494, v7
    v_mul_f32 v8, 0.15915494, v8
    v_mul_f32 v9, 0.15915494, v9
    v_mul_f32 v10, 0.15915494, v10
    v_mul_hi_u32_u24 v14, 429497, v116
    v_lshrrev_b32 v12, 3, v92
    v_cos_f32 v7, v7
    v_lshlrev_b16 v13, 3, v92
    v_mad_i32_i24 v11, v14, s55, v116
    v_bitop3_b32 v12, v6, v13, v12 bitop3:0xca
    v_lshl_add_u32 v11, v11, 17, s40
    v_lshlrev_b16 v14, 8, v14
    v_lshrrev_b32 v13, 2, v92
    v_add_u32 v116, v12, v11
    v_bitop3_b32 v92, v5, v13, v14 bitop3:0xea
    ds_add_u32 v92, v2
    v_mul_hi_u32_u24 v14, 429497, v117
    v_lshrrev_b32 v12, 3, v93
    v_cos_f32 v8, v8
    v_lshlrev_b16 v13, 3, v93
    v_mad_i32_i24 v11, v14, s55, v117
    v_bitop3_b32 v12, v6, v13, v12 bitop3:0xca
    v_lshl_add_u32 v11, v11, 17, s40
    v_lshlrev_b16 v14, 8, v14
    v_lshrrev_b32 v13, 2, v93
    v_add_u32 v117, v12, v11
    v_bitop3_b32 v93, v5, v13, v14 bitop3:0xea
    ds_add_u32 v93, v2
    v_cvt_pk_bf16_f32 v110, v7, v8
    v_perm_b32 v12, v110, v110, s41
    v_bitop3_b32 v116, v4, v12, v116 bitop3:0xca
    v_perm_b32 v13, v110, v110, s42
    v_bitop3_b32 v117, v4, v13, v117 bitop3:0xca
    v_mul_hi_u32_u24 v14, 429497, v118
    v_lshrrev_b32 v12, 3, v94
    v_cos_f32 v9, v9
    v_lshlrev_b16 v13, 3, v94
    v_mad_i32_i24 v11, v14, s55, v118
    v_bitop3_b32 v12, v6, v13, v12 bitop3:0xca
    v_lshl_add_u32 v11, v11, 17, s40
    v_lshlrev_b16 v14, 8, v14
    v_lshrrev_b32 v13, 2, v94
    v_add_u32 v118, v12, v11
    v_bitop3_b32 v94, v5, v13, v14 bitop3:0xea
    ds_add_u32 v94, v2
    v_mul_hi_u32_u24 v14, 429497, v119
    v_lshrrev_b32 v12, 3, v95
    v_cos_f32 v10, v10
    v_lshlrev_b16 v13, 3, v95
    v_mad_i32_i24 v11, v14, s55, v119
    v_bitop3_b32 v12, v6, v13, v12 bitop3:0xca
    v_lshl_add_u32 v11, v11, 17, s40
    v_lshlrev_b16 v14, 8, v14
    v_lshrrev_b32 v13, 2, v95
    v_add_u32 v119, v12, v11
    v_bitop3_b32 v95, v5, v13, v14 bitop3:0xea
    ds_add_u32 v95, v2
    v_cvt_pk_bf16_f32 v111, v9, v10
    v_perm_b32 v12, v111, v111, s41
    v_bitop3_b32 v118, v4, v12, v118 bitop3:0xca
    v_perm_b32 v13, v111, v111, s42
    v_bitop3_b32 v119, v4, v13, v119 bitop3:0xca
    v_lshrrev_b32 v8, 2, v0
    v_and_b32 v7, 0x3c00, v0
    v_bitop3_b32 v7, v5, v8, v7 bitop3:0xea
    s_waitcnt lgkmcnt(0)
    s_barrier
    ds_read2st64_b32 v[8:9], v7 offset0:0 offset1:1
    ds_read2st64_b32 v[10:11], v7 offset0:2 offset1:3
    s_add_u32 s45, s35, 0x5490000
    buffer_store_dwordx4 v[44:47], v0, s[20:23], s45 offen sc1
    s_add_u32 s46, s34, 0x4000000
    s_nop 0
    buffer_load_dwordx2 v[44:45], v1, s[16:19], s46 offen nt
    s_add_u32 s47, s34, 0x4200000
    buffer_load_dwordx2 v[46:47], v1, s[16:19], s47 offen nt
    s_waitcnt lgkmcnt(0)
    v_lshl_or_b32 v12, v9, 16, v8
    v_lshl_or_b32 v13, v11, 16, v10
    v_mov_b32 v14, v12
    v_mov_b32 v15, v13
    s_nop 0
    v_add_u32_dpp v14, v14, v14 row_shr:1 row_mask:0xf bank_mask:0xf bound_ctrl:1
    v_add_u32_dpp v15, v15, v15 row_shr:1 row_mask:0xf bank_mask:0xf bound_ctrl:1
    s_nop 0
    v_add_u32_dpp v14, v14, v14 row_shr:2 row_mask:0xf bank_mask:0xf bound_ctrl:1
    v_add_u32_dpp v15, v15, v15 row_shr:2 row_mask:0xf bank_mask:0xf bound_ctrl:1
    s_nop 0
    v_add_u32_dpp v14, v14, v14 row_shr:4 row_mask:0xf bank_mask:0xf bound_ctrl:1
    v_add_u32_dpp v15, v15, v15 row_shr:4 row_mask:0xf bank_mask:0xf bound_ctrl:1
    s_nop 0
    v_add_u32_dpp v14, v14, v14 row_shr:8 row_mask:0xf bank_mask:0xf bound_ctrl:1
    v_add_u32_dpp v15, v15, v15 row_shr:8 row_mask:0xf bank_mask:0xf bound_ctrl:1
    s_nop 0
    v_add_u32_dpp v14, v14, v14 row_bcast:15 row_mask:0xa bank_mask:0xf
    v_add_u32_dpp v15, v15, v15 row_bcast:15 row_mask:0xa bank_mask:0xf
    s_nop 0
    v_add_u32_dpp v14, v14, v14 row_bcast:31 row_mask:0xc bank_mask:0xf
    v_add_u32_dpp v15, v15, v15 row_bcast:31 row_mask:0xc bank_mask:0xf
    v_readlane_b32 s48, v14, 63
    v_readlane_b32 s49, v15, 63
    s_lshl_b32 s54, s32, 2
    v_mov_b32 v8, s54
    s_and_b32 s50, s48, 0xffff
    s_lshr_b32 s51, s48, 16
    s_and_b32 s52, s49, 0xffff
    s_lshr_b32 s53, s49, 16
    s_add_u32 s51, s51, s50
    s_add_u32 s52, s52, s51
    s_add_u32 s53, s53, s52
    v_mov_b32 v9, s53
    s_mov_b64 exec, 1
    ds_write_b32 v8, v9 offset:16384
    s_waitcnt vmcnt(3)
    ds_write_b32 v8, v3 offset:16448
    s_mov_b64 exec, -1
    v_and_b32 v8, 60, v7
    s_waitcnt lgkmcnt(0)
    s_barrier
    ds_read_b32 v9, v8 offset:16384
    ds_read_b32 v10, v8 offset:16448
    s_waitcnt lgkmcnt(0)
    v_readlane_b32 s84, v10, 15
    s_and_b32 s3, s2, 1
    s_lshl_b32 s3, s3, 7
    s_add_u32 s84, s84, s3
    s_min_u32 s4, s84, 96
    s_min_u32 s5, s84, 192
    s_min_u32 s6, s84, 240
    s_add_u32 s4, s4, s5
    s_add_u32 s4, s4, s6
    s_add_u32 s4, s4, 9467
    s_mov_b32 s4, s84
    s_lshl_b32 s58, s4, 14
    s_lshl_b32 s59, s4, 13
    s_mov_b32 s43, 5
    s_cmp_lt_u32 s84, 96
    s_addc_u32 s43, s43, 0
    s_cmp_lt_u32 s84, 192
    s_addc_u32 s43, s43, 0
    s_cmp_lt_u32 s84, 240
    s_addc_u32 s43, s43, 0
    v_add_u32_dpp v9, v9, v9 row_shr:1 row_mask:0xf bank_mask:0xf bound_ctrl:1
    s_nop 1
    v_add_u32_dpp v9, v9, v9 row_shr:2 row_mask:0xf bank_mask:0xf bound_ctrl:1
    s_nop 1
    v_add_u32_dpp v9, v9, v9 row_shr:4 row_mask:0xf bank_mask:0xf bound_ctrl:1
    s_nop 1
    v_add_u32_dpp v9, v9, v9 row_shr:8 row_mask:0xf bank_mask:0xf bound_ctrl:1
    s_nop 0
    v_readlane_b32 s54, v9, s32
    s_sub_u32 s54, s54, s53
    s_add_u32 s50, s50, s54
    s_add_u32 s51, s51, s54
    s_add_u32 s52, s52, s54
    s_pack_ll_b32_b16 s48, s54, s50
    s_pack_ll_b32_b16 s49, s51, s52
    v_add_u32 v14, s48, v14
    v_add_u32 v15, s49, v15
    v_sub_u32 v12, v14, v12
    v_sub_u32 v13, v15, v13
    v_and_b32 v8, 0xffff, v12
    v_lshrrev_b32 v9, 16, v12
    v_and_b32 v10, 0xffff, v13
    v_lshrrev_b32 v11, 16, v13
    ds_write2st64_b32 v7, v8, v9 offset0:0 offset1:1
    ds_write2st64_b32 v7, v10, v11 offset0:2 offset1:3
    v_and_b32 v8, 0x3f0, v0
    v_lshl_add_u32 v8, v8, 1, s36
    ds_write_b64 v8, v[12:13] offset:20480
    s_bitset0_b64 exec, 63
    s_not_b64 exec, exec
    ds_write_b64 v8, v[14:15] offset:20512
    s_mov_b64 exec, -1
    s_waitcnt lgkmcnt(0)
    s_barrier
    s_setprio 3
    ds_add_rtn_u32 v24, v24, v2
    ds_add_rtn_u32 v25, v25, v2
    ds_add_rtn_u32 v26, v26, v2
    ds_add_rtn_u32 v27, v27, v2
    ds_read_b128 v[12:15], v0 offset:20480
    v_cmp_gt_u32 vcc, 8448, v0
    ds_add_rtn_u32 v52, v52, v2
    ds_add_rtn_u32 v53, v53, v2
    ds_add_rtn_u32 v54, v54, v2
    ds_add_rtn_u32 v55, v55, v2
    s_setprio 2
    ds_add_rtn_u32 v72, v72, v2
    ds_add_rtn_u32 v73, v73, v2
    ds_add_rtn_u32 v74, v74, v2
    ds_add_rtn_u32 v75, v75, v2
    s_waitcnt lgkmcnt(8)
    s_cbranch_vccz L1_p4
    s_add_u32 s44, s35, 0x7ec0000
    s_mov_b64 exec, vcc
    buffer_store_dwordx4 v[12:15], v0, s[24:27], s44 offen sc1
    s_mov_b64 exec, -1
L1_p4:
    s_add_u32 s45, s35, 0x5494000
    buffer_store_dwordx4 v[20:23], v0, s[20:23], s45 offen sc1
    s_add_u32 s46, s33, 0x8400000
    s_nop 0
    buffer_load_dwordx4 v[20:23], v0, s[8:11], s46 offen nt
    ds_add_rtn_u32 v80, v80, v2
    ds_add_rtn_u32 v81, v81, v2
    ds_add_rtn_u32 v82, v82, v2
    ds_add_rtn_u32 v83, v83, v2
    s_setprio 1
    ds_add_rtn_u32 v96, v96, v2
    ds_add_rtn_u32 v97, v97, v2
    ds_add_rtn_u32 v98, v98, v2
    ds_add_rtn_u32 v99, v99, v2
    ds_add_rtn_u32 v112, v112, v2
    ds_add_rtn_u32 v113, v113, v2
    ds_add_rtn_u32 v114, v114, v2
    ds_add_rtn_u32 v115, v115, v2
    s_add_u32 s47, s35, 0x5498000
    buffer_store_dwordx4 v[124:127], v0, s[20:23], s47 offen sc1
    s_add_u32 s44, s33, 0x8400000
    s_nop 0
    buffer_load_dwordx4 v[124:127], v0, s[12:15], s44 offen nt
    s_setprio 0
    ds_add_rtn_u32 v88, v88, v2
    ds_add_rtn_u32 v89, v89, v2
    ds_add_rtn_u32 v90, v90, v2
    ds_add_rtn_u32 v91, v91, v2
    ds_add_rtn_u32 v92, v92, v2
    ds_add_rtn_u32 v93, v93, v2
    ds_add_rtn_u32 v94, v94, v2
    ds_add_rtn_u32 v95, v95, v2
    s_waitcnt lgkmcnt(0)
    s_barrier
    s_setprio 3
    v_and_b32 v7, -4, v24
    v_lshl_add_u32 v8, v24, 2, v7
    ds_write_b32 v8, v40
    v_lshl_add_u32 v7, v7, 2, v24
    ds_write_b8 v7, v84 offset:16
    v_and_b32 v9, -4, v25
    v_lshl_add_u32 v10, v25, 2, v9
    ds_write_b32 v10, v41
    v_lshl_add_u32 v9, v9, 2, v25
    ds_write_b8_d16_hi v9, v84 offset:16
    v_and_b32 v7, -4, v26
    v_lshl_add_u32 v8, v26, 2, v7
    ds_write_b32 v8, v42
    v_lshl_add_u32 v7, v7, 2, v26
    ds_write_b8 v7, v85 offset:16
    v_and_b32 v9, -4, v27
    v_lshl_add_u32 v10, v27, 2, v9
    ds_write_b32 v10, v43
    v_lshl_add_u32 v9, v9, 2, v27
    ds_write_b8_d16_hi v9, v85 offset:16
    s_add_u32 s45, s35, 0x549c000
    buffer_store_dwordx4 v[32:35], v0, s[20:23], s45 offen sc1
    s_add_u32 s46, s33, 0x8800000
    buffer_load_dwordx4 v[40:43], v0, s[8:11], s46 offen nt
    s_add_u32 s47, s33, 0x8800000
    buffer_load_dwordx4 v[24:27], v0, s[12:15], s47 offen nt
    v_and_b32 v7, -4, v52
    v_lshl_add_u32 v8, v52, 2, v7
    ds_write_b32 v8, v48
    v_lshl_add_u32 v7, v7, 2, v52
    ds_write_b8 v7, v86 offset:16
    v_and_b32 v9, -4, v53
    v_lshl_add_u32 v10, v53, 2, v9
    ds_write_b32 v10, v49
    v_lshl_add_u32 v9, v9, 2, v53
    ds_write_b8_d16_hi v9, v86 offset:16
    v_and_b32 v7, -4, v54
    v_lshl_add_u32 v8, v54, 2, v7
    ds_write_b32 v8, v50
    v_lshl_add_u32 v7, v7, 2, v54
    ds_write_b8 v7, v87 offset:16
    v_and_b32 v9, -4, v55
    v_lshl_add_u32 v10, v55, 2, v9
    ds_write_b32 v10, v51
    v_lshl_add_u32 v9, v9, 2, v55
    ds_write_b8_d16_hi v9, v87 offset:16
    s_add_u32 s44, s34, 0x4400000
    buffer_load_dwordx2 v[32:33], v1, s[16:19], s44 offen nt
    s_add_u32 s45, s34, 0x4600000
    buffer_load_dwordx2 v[34:35], v1, s[16:19], s45 offen nt
    s_add_u32 s46, s33, 0x8c00000
    buffer_load_dwordx4 v[48:51], v0, s[8:11], s46 offen nt
    s_setprio 2
    v_and_b32 v7, -4, v72
    v_lshl_add_u32 v8, v72, 2, v7
    ds_write_b32 v8, v68
    v_lshl_add_u32 v7, v7, 2, v72
    ds_write_b8 v7, v56 offset:16
    v_and_b32 v9, -4, v73
    v_lshl_add_u32 v10, v73, 2, v9
    ds_write_b32 v10, v69
    v_lshl_add_u32 v9, v9, 2, v73
    ds_write_b8_d16_hi v9, v56 offset:16
    v_and_b32 v7, -4, v74
    v_lshl_add_u32 v8, v74, 2, v7
    ds_write_b32 v8, v70
    v_lshl_add_u32 v7, v7, 2, v74
    ds_write_b8 v7, v57 offset:16
    v_and_b32 v9, -4, v75
    v_lshl_add_u32 v10, v75, 2, v9
    ds_write_b32 v10, v71
    v_lshl_add_u32 v9, v9, 2, v75
    ds_write_b8_d16_hi v9, v57 offset:16
    s_add_u32 s47, s35, 0x54a0000
    buffer_store_dwordx4 v[36:39], v0, s[20:23], s47 offen sc1
    s_add_u32 s44, s33, 0x8c00000
    buffer_load_dwordx4 v[52:55], v0, s[12:15], s44 offen nt
    v_and_b32 v7, -4, v80
    v_lshl_add_u32 v8, v80, 2, v7
    ds_write_b32 v8, v76
    v_lshl_add_u32 v7, v7, 2, v80
    ds_write_b8 v7, v58 offset:16
    v_and_b32 v9, -4, v81
    v_lshl_add_u32 v10, v81, 2, v9
    ds_write_b32 v10, v77
    v_lshl_add_u32 v9, v9, 2, v81
    ds_write_b8_d16_hi v9, v58 offset:16
    v_and_b32 v7, -4, v82
    v_lshl_add_u32 v8, v82, 2, v7
    ds_write_b32 v8, v78
    v_lshl_add_u32 v7, v7, 2, v82
    ds_write_b8 v7, v59 offset:16
    v_and_b32 v9, -4, v83
    v_lshl_add_u32 v10, v83, 2, v9
    ds_write_b32 v10, v79
    v_lshl_add_u32 v9, v9, 2, v83
    ds_write_b8_d16_hi v9, v59 offset:16
    s_add_u32 s45, s33, 0x9000000
    buffer_load_dwordx4 v[84:87], v0, s[8:11], s45 offen nt
    s_add_u32 s46, s33, 0x9000000
    buffer_load_dwordx4 v[68:71], v0, s[12:15], s46 offen nt
    s_setprio 1
    v_and_b32 v7, -4, v96
    v_lshl_add_u32 v8, v96, 2, v7
    ds_write_b32 v8, v64
    v_lshl_add_u32 v7, v7, 2, v96
    ds_write_b8 v7, v104 offset:16
    v_and_b32 v9, -4, v97
    v_lshl_add_u32 v10, v97, 2, v9
    ds_write_b32 v10, v65
    v_lshl_add_u32 v9, v9, 2, v97
    ds_write_b8_d16_hi v9, v104 offset:16
    v_and_b32 v7, -4, v98
    v_lshl_add_u32 v8, v98, 2, v7
    ds_write_b32 v8, v66
    v_lshl_add_u32 v7, v7, 2, v98
    ds_write_b8 v7, v105 offset:16
    v_and_b32 v9, -4, v99
    v_lshl_add_u32 v10, v99, 2, v9
    ds_write_b32 v10, v67
    v_lshl_add_u32 v9, v9, 2, v99
    ds_write_b8_d16_hi v9, v105 offset:16
    s_add_u32 s47, s34, 0x4800000
    buffer_load_dwordx2 v[72:73], v1, s[16:19], s47 offen nt
    s_cmp_le_u32 s43, 5
    s_cselect_b32 s18, 0, s18
    s_add_u32 s44, s59, 0x4a00000
    buffer_load_dwordx2 v[74:75], v1, s[16:19], s44 offen nt
    s_cmp_le_u32 s43, 5
    s_cselect_b32 s10, 0, s10
    s_add_u32 s45, s58, 0x9400000
    buffer_load_dwordx4 v[36:39], v0, s[8:11], s45 offen nt
    v_and_b32 v7, -4, v112
    v_lshl_add_u32 v8, v112, 2, v7
    ds_write_b32 v8, v60
    v_lshl_add_u32 v7, v7, 2, v112
    ds_write_b8 v7, v106 offset:16
    v_and_b32 v9, -4, v113
    v_lshl_add_u32 v10, v113, 2, v9
    ds_write_b32 v10, v61
    v_lshl_add_u32 v9, v9, 2, v113
    ds_write_b8_d16_hi v9, v106 offset:16
    v_and_b32 v7, -4, v114
    v_lshl_add_u32 v8, v114, 2, v7
    ds_write_b32 v8, v62
    v_lshl_add_u32 v7, v7, 2, v114
    ds_write_b8 v7, v107 offset:16
    v_and_b32 v9, -4, v115
    v_lshl_add_u32 v10, v115, 2, v9
    ds_write_b32 v10, v63
    v_lshl_add_u32 v9, v9, 2, v115
    ds_write_b8_d16_hi v9, v107 offset:16
    s_add_u32 s46, s35, 0x54a4000
    buffer_store_dwordx4 v[28:31], v0, s[20:23], s46 offen sc1
    s_cmp_le_u32 s43, 5
    s_cselect_b32 s14, 0, s14
    s_add_u32 s47, s58, 0x9400000
    buffer_load_dwordx4 v[76:79], v0, s[12:15], s47 offen nt
    s_setprio 0
    v_and_b32 v7, -4, v88
    v_lshl_add_u32 v8, v88, 2, v7
    ds_write_b32 v8, v100
    v_lshl_add_u32 v7, v7, 2, v88
    ds_write_b8 v7, v108 offset:16
    v_and_b32 v9, -4, v89
    v_lshl_add_u32 v10, v89, 2, v9
    ds_write_b32 v10, v101
    v_lshl_add_u32 v9, v9, 2, v89
    ds_write_b8_d16_hi v9, v108 offset:16
    v_and_b32 v7, -4, v90
    v_lshl_add_u32 v8, v90, 2, v7
    ds_write_b32 v8, v102
    v_lshl_add_u32 v7, v7, 2, v90
    ds_write_b8 v7, v109 offset:16
    v_and_b32 v9, -4, v91
    v_lshl_add_u32 v10, v91, 2, v9
    ds_write_b32 v10, v103
    v_lshl_add_u32 v9, v9, 2, v91
    ds_write_b8_d16_hi v9, v109 offset:16
    s_cmp_le_u32 s43, 6
    s_cselect_b32 s10, 0, s10
    s_add_u32 s44, s58, 0x97c0000
    buffer_load_dwordx4 v[80:83], v0, s[8:11], s44 offen nt
    s_cmp_le_u32 s43, 6
    s_cselect_b32 s14, 0, s14
    s_add_u32 s45, s58, 0x97c0000
    buffer_load_dwordx4 v[56:59], v0, s[12:15], s45 offen nt
    v_and_b32 v7, -4, v92
    v_lshl_add_u32 v8, v92, 2, v7
    ds_write_b32 v8, v116
    v_lshl_add_u32 v7, v7, 2, v92
    ds_write_b8 v7, v110 offset:16
    v_and_b32 v9, -4, v93
    v_lshl_add_u32 v10, v93, 2, v9
    ds_write_b32 v10, v117
    v_lshl_add_u32 v9, v9, 2, v93
    ds_write_b8_d16_hi v9, v110 offset:16
    v_and_b32 v7, -4, v94
    v_lshl_add_u32 v8, v94, 2, v7
    ds_write_b32 v8, v118
    v_lshl_add_u32 v7, v7, 2, v94
    ds_write_b8 v7, v111 offset:16
    v_and_b32 v9, -4, v95
    v_lshl_add_u32 v10, v95, 2, v9
    ds_write_b32 v10, v119
    v_lshl_add_u32 v9, v9, 2, v95
    ds_write_b8_d16_hi v9, v111 offset:16
    s_cmp_le_u32 s43, 6
    s_cselect_b32 s18, 0, s18
    s_add_u32 s46, s59, 0x4be0000
    buffer_load_dwordx2 v[64:65], v1, s[16:19], s46 offen nt
    s_cmp_le_u32 s43, 7
    s_cselect_b32 s18, 0, s18
    s_add_u32 s47, s59, 0x4d60000
    buffer_load_dwordx2 v[66:67], v1, s[16:19], s47 offen nt
    v_add_u32 v7, 0x10000, v0
    v_add_u32 v12, 0x20000, v0
    v_mov_b32 v8, 0
    v_mov_b32 v9, 0
    v_mov_b32 v10, 0
    v_mov_b32 v11, 0
    s_waitcnt lgkmcnt(0)
    s_barrier
    ds_read_b128 v[96:99], v0 offset:0
    ds_write_b128 v0, v[8:11]
    ds_read_b128 v[60:63], v0 offset:16384
    ds_read_b128 v[112:115], v0 offset:32768
    ds_read_b128 v[104:107], v0 offset:49152
    ds_read_b128 v[28:31], v7 offset:0
    ds_read_b128 v[100:103], v7 offset:16384
    ds_read_b128 v[88:91], v7 offset:32768
    ds_read_b128 v[116:119], v7 offset:49152
    ds_read_b128 v[92:95], v12 offset:0
    ds_read_b128 v[108:111], v12 offset:16384
    s_waitcnt lgkmcnt(0)
    s_barrier
    v_lshlrev_b32 v3, 3, v0
    v_and_b32 v3, 0x80, v3
    s_cmp_lg_u32 s32, 15
    s_cbranch_scc1 L2_k0
    s_mov_b64 exec, 3
    buffer_load_dword v3, v3, s[68:71], 0 offen sc1
    s_mov_b64 exec, -1
L2_k0:
    s_add_u32 s44, s35, 0x7ec0000
    buffer_store_dwordx4 v[96:99], v0, s[20:23], s44 offen sc1
    s_cmp_le_u32 s43, 7
    s_cselect_b32 s10, 0, s10
    s_add_u32 s45, s58, 0x9ac0000
    buffer_load_dwordx4 v[96:99], v0, s[8:11], s45 offen nt
    s_add_u32 s46, s35, 0x7ec4000
    buffer_store_dwordx4 v[60:63], v0, s[20:23], s46 offen sc1
    s_cmp_le_u32 s43, 7
    s_cselect_b32 s14, 0, s14
    s_add_u32 s47, s58, 0x9ac0000
    buffer_load_dwordx4 v[60:63], v0, s[12:15], s47 offen nt
    s_setprio 3
    s_waitcnt vmcnt(27)
    v_lshlrev_b32 v7, 16, v44
    v_and_b32 v8, 0xffff0000, v44
    v_lshlrev_b32 v9, 16, v45
    v_and_b32 v10, 0xffff0000, v45
    v_mul_f32 v7, 0.15915494, v7
    v_mul_f32 v8, 0.15915494, v8
    v_mul_f32 v9, 0.15915494, v9
    v_mul_f32 v10, 0.15915494, v10
    v_mul_hi_u32_u24 v14, 429497, v16
    v_lshrrev_b32 v12, 3, v120
    v_cos_f32 v7, v7
    v_lshlrev_b16 v13, 3, v120
    v_mad_i32_i24 v11, v14, s55, v16
    v_bitop3_b32 v12, v6, v13, v12 bitop3:0xca
    v_lshl_add_u32 v11, v11, 17, s40
    v_lshlrev_b16 v14, 8, v14
    v_lshrrev_b32 v13, 2, v120
    v_add_u32 v16, v12, v11
    v_bitop3_b32 v120, v5, v13, v14 bitop3:0xea
    ds_add_u32 v120, v2
    v_mul_hi_u32_u24 v14, 429497, v17
    v_lshrrev_b32 v12, 3, v121
    v_cos_f32 v8, v8
    v_lshlrev_b16 v13, 3, v121
    v_mad_i32_i24 v11, v14, s55, v17
    v_bitop3_b32 v12, v6, v13, v12 bitop3:0xca
    v_lshl_add_u32 v11, v11, 17, s40
    v_lshlrev_b16 v14, 8, v14
    v_lshrrev_b32 v13, 2, v121
    v_add_u32 v17, v12, v11
    v_bitop3_b32 v121, v5, v13, v14 bitop3:0xea
    ds_add_u32 v121, v2
    v_cvt_pk_bf16_f32 v44, v7, v8
    v_perm_b32 v12, v44, v44, s41
    v_bitop3_b32 v16, v4, v12, v16 bitop3:0xca
    v_perm_b32 v13, v44, v44, s42
    v_bitop3_b32 v17, v4, v13, v17 bitop3:0xca
    v_mul_hi_u32_u24 v14, 429497, v18
    v_lshrrev_b32 v12, 3, v122
    v_cos_f32 v9, v9
    v_lshlrev_b16 v13, 3, v122
    v_mad_i32_i24 v11, v14, s55, v18
    v_bitop3_b32 v12, v6, v13, v12 bitop3:0xca
    v_lshl_add_u32 v11, v11, 17, s40
    v_lshlrev_b16 v14, 8, v14
    v_lshrrev_b32 v13, 2, v122
    v_add_u32 v18, v12, v11
    v_bitop3_b32 v122, v5, v13, v14 bitop3:0xea
    ds_add_u32 v122, v2
    v_mul_hi_u32_u24 v14, 429497, v19
    v_lshrrev_b32 v12, 3, v123
    v_cos_f32 v10, v10
    v_lshlrev_b16 v13, 3, v123
    v_mad_i32_i24 v11, v14, s55, v19
    v_bitop3_b32 v12, v6, v13, v12 bitop3:0xca
    v_lshl_add_u32 v11, v11, 17, s40
    v_lshlrev_b16 v14, 8, v14
    v_lshrrev_b32 v13, 2, v123
    v_add_u32 v19, v12, v11
    v_bitop3_b32 v123, v5, v13, v14 bitop3:0xea
    ds_add_u32 v123, v2
    v_cvt_pk_bf16_f32 v45, v9, v10
    v_perm_b32 v12, v45, v45, s41
    v_bitop3_b32 v18, v4, v12, v18 bitop3:0xca
    v_perm_b32 v13, v45, v45, s42
    v_bitop3_b32 v19, v4, v13, v19 bitop3:0xca
    s_add_u32 s44, s35, 0x7ec8000
    buffer_store_dwordx4 v[112:115], v0, s[20:23], s44 offen sc1
    s_waitcnt vmcnt(24)
    v_lshlrev_b32 v7, 16, v46
    v_and_b32 v8, 0xffff0000, v46
    v_lshlrev_b32 v9, 16, v47
    v_and_b32 v10, 0xffff0000, v47
    v_mul_f32 v7, 0.15915494, v7
    v_mul_f32 v8, 0.15915494, v8
    v_mul_f32 v9, 0.15915494, v9
    v_mul_f32 v10, 0.15915494, v10
    v_mul_hi_u32_u24 v14, 429497, v20
    v_lshrrev_b32 v12, 3, v124
    v_cos_f32 v7, v7
    v_lshlrev_b16 v13, 3, v124
    v_mad_i32_i24 v11, v14, s55, v20
    v_bitop3_b32 v12, v6, v13, v12 bitop3:0xca
    v_lshl_add_u32 v11, v11, 17, s40
    v_lshlrev_b16 v14, 8, v14
    v_lshrrev_b32 v13, 2, v124
    v_add_u32 v20, v12, v11
    v_bitop3_b32 v124, v5, v13, v14 bitop3:0xea
    ds_add_u32 v124, v2
    v_mul_hi_u32_u24 v14, 429497, v21
    v_lshrrev_b32 v12, 3, v125
    v_cos_f32 v8, v8
    v_lshlrev_b16 v13, 3, v125
    v_mad_i32_i24 v11, v14, s55, v21
    v_bitop3_b32 v12, v6, v13, v12 bitop3:0xca
    v_lshl_add_u32 v11, v11, 17, s40
    v_lshlrev_b16 v14, 8, v14
    v_lshrrev_b32 v13, 2, v125
    v_add_u32 v21, v12, v11
    v_bitop3_b32 v125, v5, v13, v14 bitop3:0xea
    ds_add_u32 v125, v2
    v_cvt_pk_bf16_f32 v46, v7, v8
    v_perm_b32 v12, v46, v46, s41
    v_bitop3_b32 v20, v4, v12, v20 bitop3:0xca
    v_perm_b32 v13, v46, v46, s42
    v_bitop3_b32 v21, v4, v13, v21 bitop3:0xca
    v_mul_hi_u32_u24 v14, 429497, v22
    v_lshrrev_b32 v12, 3, v126
    v_cos_f32 v9, v9
    v_lshlrev_b16 v13, 3, v126
    v_mad_i32_i24 v11, v14, s55, v22
    v_bitop3_b32 v12, v6, v13, v12 bitop3:0xca
    v_lshl_add_u32 v11, v11, 17, s40
    v_lshlrev_b16 v14, 8, v14
    v_lshrrev_b32 v13, 2, v126
    v_add_u32 v22, v12, v11
    v_bitop3_b32 v126, v5, v13, v14 bitop3:0xea
    ds_add_u32 v126, v2
    v_mul_hi_u32_u24 v14, 429497, v23
    v_lshrrev_b32 v12, 3, v127
    v_cos_f32 v10, v10
    v_lshlrev_b16 v13, 3, v127
    v_mad_i32_i24 v11, v14, s55, v23
    v_bitop3_b32 v12, v6, v13, v12 bitop3:0xca
    v_lshl_add_u32 v11, v11, 17, s40
    v_lshlrev_b16 v14, 8, v14
    v_lshrrev_b32 v13, 2, v127
    v_add_u32 v23, v12, v11
    v_bitop3_b32 v127, v5, v13, v14 bitop3:0xea
    ds_add_u32 v127, v2
    v_cvt_pk_bf16_f32 v47, v9, v10
    v_perm_b32 v12, v47, v47, s41
    v_bitop3_b32 v22, v4, v12, v22 bitop3:0xca
    v_perm_b32 v13, v47, v47, s42
    v_bitop3_b32 v23, v4, v13, v23 bitop3:0xca
    s_setprio 2
    s_add_u32 s45, s35, 0x7ecc000
    buffer_store_dwordx4 v[104:107], v0, s[20:23], s45 offen sc1
    s_waitcnt vmcnt(20)
    v_lshlrev_b32 v7, 16, v32
    v_and_b32 v8, 0xffff0000, v32
    v_lshlrev_b32 v9, 16, v33
    v_and_b32 v10, 0xffff0000, v33
    v_mul_f32 v7, 0.15915494, v7
    v_mul_f32 v8, 0.15915494, v8
    v_mul_f32 v9, 0.15915494, v9
    v_mul_f32 v10, 0.15915494, v10
    v_mul_hi_u32_u24 v14, 429497, v40
    v_lshrrev_b32 v12, 3, v24
    v_cos_f32 v7, v7
    v_lshlrev_b16 v13, 3, v24
    v_mad_i32_i24 v11, v14, s55, v40
    v_bitop3_b32 v12, v6, v13, v12 bitop3:0xca
    v_lshl_add_u32 v11, v11, 17, s40
    v_lshlrev_b16 v14, 8, v14
    v_lshrrev_b32 v13, 2, v24
    v_add_u32 v40, v12, v11
    v_bitop3_b32 v24, v5, v13, v14 bitop3:0xea
    ds_add_u32 v24, v2
    v_mul_hi_u32_u24 v14, 429497, v41
    v_lshrrev_b32 v12, 3, v25
    v_cos_f32 v8, v8
    v_lshlrev_b16 v13, 3, v25
    v_mad_i32_i24 v11, v14, s55, v41
    v_bitop3_b32 v12, v6, v13, v12 bitop3:0xca
    v_lshl_add_u32 v11, v11, 17, s40
    v_lshlrev_b16 v14, 8, v14
    v_lshrrev_b32 v13, 2, v25
    v_add_u32 v41, v12, v11
    v_bitop3_b32 v25, v5, v13, v14 bitop3:0xea
    ds_add_u32 v25, v2
    v_cvt_pk_bf16_f32 v32, v7, v8
    v_perm_b32 v12, v32, v32, s41
    v_bitop3_b32 v40, v4, v12, v40 bitop3:0xca
    v_perm_b32 v13, v32, v32, s42
    v_bitop3_b32 v41, v4, v13, v41 bitop3:0xca
    v_mul_hi_u32_u24 v14, 429497, v42
    v_lshrrev_b32 v12, 3, v26
    v_cos_f32 v9, v9
    v_lshlrev_b16 v13, 3, v26
    v_mad_i32_i24 v11, v14, s55, v42
    v_bitop3_b32 v12, v6, v13, v12 bitop3:0xca
    v_lshl_add_u32 v11, v11, 17, s40
    v_lshlrev_b16 v14, 8, v14
    v_lshrrev_b32 v13, 2, v26
    v_add_u32 v42, v12, v11
    v_bitop3_b32 v26, v5, v13, v14 bitop3:0xea
    ds_add_u32 v26, v2
    v_mul_hi_u32_u24 v14, 429497, v43
    v_lshrrev_b32 v12, 3, v27
    v_cos_f32 v10, v10
    v_lshlrev_b16 v13, 3, v27
    v_mad_i32_i24 v11, v14, s55, v43
    v_bitop3_b32 v12, v6, v13, v12 bitop3:0xca
    v_lshl_add_u32 v11, v11, 17, s40
    v_lshlrev_b16 v14, 8, v14
    v_lshrrev_b32 v13, 2, v27
    v_add_u32 v43, v12, v11
    v_bitop3_b32 v27, v5, v13, v14 bitop3:0xea
    ds_add_u32 v27, v2
    v_cvt_pk_bf16_f32 v33, v9, v10
    v_perm_b32 v12, v33, v33, s41
    v_bitop3_b32 v42, v4, v12, v42 bitop3:0xca
    v_perm_b32 v13, v33, v33, s42
    v_bitop3_b32 v43, v4, v13, v43 bitop3:0xca
    s_waitcnt vmcnt(17)
    v_lshlrev_b32 v7, 16, v34
    v_and_b32 v8, 0xffff0000, v34
    v_lshlrev_b32 v9, 16, v35
    v_and_b32 v10, 0xffff0000, v35
    v_mul_f32 v7, 0.15915494, v7
    v_mul_f32 v8, 0.15915494, v8
    v_mul_f32 v9, 0.15915494, v9
    v_mul_f32 v10, 0.15915494, v10
    v_mul_hi_u32_u24 v14, 429497, v48
    v_lshrrev_b32 v12, 3, v52
    v_cos_f32 v7, v7
    v_lshlrev_b16 v13, 3, v52
    v_mad_i32_i24 v11, v14, s55, v48
    v_bitop3_b32 v12, v6, v13, v12 bitop3:0xca
    v_lshl_add_u32 v11, v11, 17, s40
    v_lshlrev_b16 v14, 8, v14
    v_lshrrev_b32 v13, 2, v52
    v_add_u32 v48, v12, v11
    v_bitop3_b32 v52, v5, v13, v14 bitop3:0xea
    ds_add_u32 v52, v2
    v_mul_hi_u32_u24 v14, 429497, v49
    v_lshrrev_b32 v12, 3, v53
    v_cos_f32 v8, v8
    v_lshlrev_b16 v13, 3, v53
    v_mad_i32_i24 v11, v14, s55, v49
    v_bitop3_b32 v12, v6, v13, v12 bitop3:0xca
    v_lshl_add_u32 v11, v11, 17, s40
    v_lshlrev_b16 v14, 8, v14
    v_lshrrev_b32 v13, 2, v53
    v_add_u32 v49, v12, v11
    v_bitop3_b32 v53, v5, v13, v14 bitop3:0xea
    ds_add_u32 v53, v2
    v_cvt_pk_bf16_f32 v34, v7, v8
    v_perm_b32 v12, v34, v34, s41
    v_bitop3_b32 v48, v4, v12, v48 bitop3:0xca
    v_perm_b32 v13, v34, v34, s42
    v_bitop3_b32 v49, v4, v13, v49 bitop3:0xca
    v_mul_hi_u32_u24 v14, 429497, v50
    v_lshrrev_b32 v12, 3, v54
    v_cos_f32 v9, v9
    v_lshlrev_b16 v13, 3, v54
    v_mad_i32_i24 v11, v14, s55, v50
    v_bitop3_b32 v12, v6, v13, v12 bitop3:0xca
    v_lshl_add_u32 v11, v11, 17, s40
    v_lshlrev_b16 v14, 8, v14
    v_lshrrev_b32 v13, 2, v54
    v_add_u32 v50, v12, v11
    v_bitop3_b32 v54, v5, v13, v14 bitop3:0xea
    ds_add_u32 v54, v2
    v_mul_hi_u32_u24 v14, 429497, v51
    v_lshrrev_b32 v12, 3, v55
    v_cos_f32 v10, v10
    v_lshlrev_b16 v13, 3, v55
    v_mad_i32_i24 v11, v14, s55, v51
    v_bitop3_b32 v12, v6, v13, v12 bitop3:0xca
    v_lshl_add_u32 v11, v11, 17, s40
    v_lshlrev_b16 v14, 8, v14
    v_lshrrev_b32 v13, 2, v55
    v_add_u32 v51, v12, v11
    v_bitop3_b32 v55, v5, v13, v14 bitop3:0xea
    ds_add_u32 v55, v2
    v_cvt_pk_bf16_f32 v35, v9, v10
    v_perm_b32 v12, v35, v35, s41
    v_bitop3_b32 v50, v4, v12, v50 bitop3:0xca
    v_perm_b32 v13, v35, v35, s42
    v_bitop3_b32 v51, v4, v13, v51 bitop3:0xca
    s_setprio 1
    s_add_u32 s46, s35, 0x7ed0000
    buffer_store_dwordx4 v[28:31], v0, s[20:23], s46 offen sc1
    v_lshrrev_b32 v15, 2, v0
    v_and_b32 v15, v5, v15
    s_cmp_ge_u32 s84, 128
    s_cselect_b32 s82, 0, s82
    s_and_b32 s3, s84, 1
    s_mul_i32 s3, s3, 40
    s_add_u32 s3, s3, s32
    s_mul_i32 s4, s3, 205
    s_lshr_b32 s4, s4, 10
    s_mul_i32 s5, s4, 5
    s_sub_u32 s5, s3, s5
    s_lshl_b32 s6, s4, 1
    s_add_u32 s6, s6, s5
    s_add_u32 s7, s6, s4
    s_add_u32 s7, s7, 30
    s_cmp_lt_u32 s5, 2
    s_cselect_b32 s6, s6, s7
    s_lshl_b32 s6, s6, 10
    s_lshr_b32 s7, s84, 1
    s_mul_i32 s7, s7, 80000
    s_add_u32 s6, s6, s7
    buffer_load_dword v112, v15, s[80:83], s6 offen offset:0
    buffer_load_dword v113, v15, s[80:83], s6 offen offset:256
    buffer_load_dword v114, v15, s[80:83], s6 offen offset:512
    buffer_load_dword v115, v15, s[80:83], s6 offen offset:768
    s_and_b32 s3, s84, 1
    s_mul_i32 s3, s3, 40
    s_add_u32 s3, s3, s32
    s_add_u32 s3, s3, 16
    s_mul_i32 s4, s3, 205
    s_lshr_b32 s4, s4, 10
    s_mul_i32 s5, s4, 5
    s_sub_u32 s5, s3, s5
    s_lshl_b32 s6, s4, 1
    s_add_u32 s6, s6, s5
    s_add_u32 s7, s6, s4
    s_add_u32 s7, s7, 30
    s_cmp_lt_u32 s5, 2
    s_cselect_b32 s6, s6, s7
    s_lshl_b32 s6, s6, 10
    s_lshr_b32 s7, s84, 1
    s_mul_i32 s7, s7, 80000
    s_add_u32 s6, s6, s7
    buffer_load_dword v104, v15, s[80:83], s6 offen offset:0
    buffer_load_dword v105, v15, s[80:83], s6 offen offset:256
    buffer_load_dword v106, v15, s[80:83], s6 offen offset:512
    buffer_load_dword v107, v15, s[80:83], s6 offen offset:768
    s_and_b32 s3, s84, 1
    s_mul_i32 s3, s3, 40
    s_add_u32 s3, s3, s32
    s_add_u32 s3, s3, 32
    s_cmp_ge_u32 s32, 8
    s_cselect_b32 s82, 0, s82
    s_mul_i32 s4, s3, 205
    s_lshr_b32 s4, s4, 10
    s_mul_i32 s5, s4, 5
    s_sub_u32 s5, s3, s5
    s_lshl_b32 s6, s4, 1
    s_add_u32 s6, s6, s5
    s_add_u32 s7, s6, s4
    s_add_u32 s7, s7, 30
    s_cmp_lt_u32 s5, 2
    s_cselect_b32 s6, s6, s7
    s_lshl_b32 s6, s6, 10
    s_lshr_b32 s7, s84, 1
    s_mul_i32 s7, s7, 80000
    s_add_u32 s6, s6, s7
    buffer_load_dword v28, v15, s[80:83], s6 offen offset:0
    buffer_load_dword v29, v15, s[80:83], s6 offen offset:256
    buffer_load_dword v30, v15, s[80:83], s6 offen offset:512
    buffer_load_dword v31, v15, s[80:83], s6 offen offset:768
    s_waitcnt vmcnt(26)
    v_lshlrev_b32 v7, 16, v72
    v_and_b32 v8, 0xffff0000, v72
    v_lshlrev_b32 v9, 16, v73
    v_and_b32 v10, 0xffff0000, v73
    v_mul_f32 v7, 0.15915494, v7
    v_mul_f32 v8, 0.15915494, v8
    v_mul_f32 v9, 0.15915494, v9
    v_mul_f32 v10, 0.15915494, v10
    v_mul_hi_u32_u24 v14, 429497, v84
    v_lshrrev_b32 v12, 3, v68
    v_cos_f32 v7, v7
    v_lshlrev_b16 v13, 3, v68
    v_mad_i32_i24 v11, v14, s55, v84
    v_bitop3_b32 v12, v6, v13, v12 bitop3:0xca
    v_lshl_add_u32 v11, v11, 17, s40
    v_lshlrev_b16 v14, 8, v14
    v_lshrrev_b32 v13, 2, v68
    v_add_u32 v84, v12, v11
    v_bitop3_b32 v68, v5, v13, v14 bitop3:0xea
    ds_add_u32 v68, v2
    v_mul_hi_u32_u24 v14, 429497, v85
    v_lshrrev_b32 v12, 3, v69
    v_cos_f32 v8, v8
    v_lshlrev_b16 v13, 3, v69
    v_mad_i32_i24 v11, v14, s55, v85
    v_bitop3_b32 v12, v6, v13, v12 bitop3:0xca
    v_lshl_add_u32 v11, v11, 17, s40
    v_lshlrev_b16 v14, 8, v14
    v_lshrrev_b32 v13, 2, v69
    v_add_u32 v85, v12, v11
    v_bitop3_b32 v69, v5, v13, v14 bitop3:0xea
    ds_add_u32 v69, v2
    v_cvt_pk_bf16_f32 v72, v7, v8
    v_perm_b32 v12, v72, v72, s41
    v_bitop3_b32 v84, v4, v12, v84 bitop3:0xca
    v_perm_b32 v13, v72, v72, s42
    v_bitop3_b32 v85, v4, v13, v85 bitop3:0xca
    v_mul_hi_u32_u24 v14, 429497, v86
    v_lshrrev_b32 v12, 3, v70
    v_cos_f32 v9, v9
    v_lshlrev_b16 v13, 3, v70
    v_mad_i32_i24 v11, v14, s55, v86
    v_bitop3_b32 v12, v6, v13, v12 bitop3:0xca
    v_lshl_add_u32 v11, v11, 17, s40
    v_lshlrev_b16 v14, 8, v14
    v_lshrrev_b32 v13, 2, v70
    v_add_u32 v86, v12, v11
    v_bitop3_b32 v70, v5, v13, v14 bitop3:0xea
    ds_add_u32 v70, v2
    v_mul_hi_u32_u24 v14, 429497, v87
    v_lshrrev_b32 v12, 3, v71
    v_cos_f32 v10, v10
    v_lshlrev_b16 v13, 3, v71
    v_mad_i32_i24 v11, v14, s55, v87
    v_bitop3_b32 v12, v6, v13, v12 bitop3:0xca
    v_lshl_add_u32 v11, v11, 17, s40
    v_lshlrev_b16 v14, 8, v14
    v_lshrrev_b32 v13, 2, v71
    v_add_u32 v87, v12, v11
    v_bitop3_b32 v71, v5, v13, v14 bitop3:0xea
    ds_add_u32 v71, v2
    v_cvt_pk_bf16_f32 v73, v9, v10
    v_perm_b32 v12, v73, v73, s41
    v_bitop3_b32 v86, v4, v12, v86 bitop3:0xca
    v_perm_b32 v13, v73, v73, s42
    v_bitop3_b32 v87, v4, v13, v87 bitop3:0xca
    s_waitcnt vmcnt(23)
    s_cmp_le_u32 s43, 5
    s_cbranch_scc1 L1_s5
    v_lshlrev_b32 v7, 16, v74
    v_and_b32 v8, 0xffff0000, v74
    v_lshlrev_b32 v9, 16, v75
    v_and_b32 v10, 0xffff0000, v75
    v_mul_f32 v7, 0.15915494, v7
    v_mul_f32 v8, 0.15915494, v8
    v_mul_f32 v9, 0.15915494, v9
    v_mul_f32 v10, 0.15915494, v10
    v_mul_hi_u32_u24 v14, 429497, v36
    v_lshrrev_b32 v12, 3, v76
    v_cos_f32 v7, v7
    v_lshlrev_b16 v13, 3, v76
    v_mad_i32_i24 v11, v14, s55, v36
    v_bitop3_b32 v12, v6, v13, v12 bitop3:0xca
    v_lshl_add_u32 v11, v11, 17, s40
    v_lshlrev_b16 v14, 8, v14
    v_lshrrev_b32 v13, 2, v76
    v_add_u32 v36, v12, v11
    v_bitop3_b32 v76, v5, v13, v14 bitop3:0xea
    ds_add_u32 v76, v2
    v_mul_hi_u32_u24 v14, 429497, v37
    v_lshrrev_b32 v12, 3, v77
    v_cos_f32 v8, v8
    v_lshlrev_b16 v13, 3, v77
    v_mad_i32_i24 v11, v14, s55, v37
    v_bitop3_b32 v12, v6, v13, v12 bitop3:0xca
    v_lshl_add_u32 v11, v11, 17, s40
    v_lshlrev_b16 v14, 8, v14
    v_lshrrev_b32 v13, 2, v77
    v_add_u32 v37, v12, v11
    v_bitop3_b32 v77, v5, v13, v14 bitop3:0xea
    ds_add_u32 v77, v2
    v_cvt_pk_bf16_f32 v74, v7, v8
    v_perm_b32 v12, v74, v74, s41
    v_bitop3_b32 v36, v4, v12, v36 bitop3:0xca
    v_perm_b32 v13, v74, v74, s42
    v_bitop3_b32 v37, v4, v13, v37 bitop3:0xca
    v_mul_hi_u32_u24 v14, 429497, v38
    v_lshrrev_b32 v12, 3, v78
    v_cos_f32 v9, v9
    v_lshlrev_b16 v13, 3, v78
    v_mad_i32_i24 v11, v14, s55, v38
    v_bitop3_b32 v12, v6, v13, v12 bitop3:0xca
    v_lshl_add_u32 v11, v11, 17, s40
    v_lshlrev_b16 v14, 8, v14
    v_lshrrev_b32 v13, 2, v78
    v_add_u32 v38, v12, v11
    v_bitop3_b32 v78, v5, v13, v14 bitop3:0xea
    ds_add_u32 v78, v2
    v_mul_hi_u32_u24 v14, 429497, v39
    v_lshrrev_b32 v12, 3, v79
    v_cos_f32 v10, v10
    v_lshlrev_b16 v13, 3, v79
    v_mad_i32_i24 v11, v14, s55, v39
    v_bitop3_b32 v12, v6, v13, v12 bitop3:0xca
    v_lshl_add_u32 v11, v11, 17, s40
    v_lshlrev_b16 v14, 8, v14
    v_lshrrev_b32 v13, 2, v79
    v_add_u32 v39, v12, v11
    v_bitop3_b32 v79, v5, v13, v14 bitop3:0xea
    ds_add_u32 v79, v2
    v_cvt_pk_bf16_f32 v75, v9, v10
    v_perm_b32 v12, v75, v75, s41
    v_bitop3_b32 v38, v4, v12, v38 bitop3:0xca
    v_perm_b32 v13, v75, v75, s42
    v_bitop3_b32 v39, v4, v13, v39 bitop3:0xca
L1_s5:
    s_setprio 0
    s_waitcnt vmcnt(19)
    s_cmp_le_u32 s43, 6
    s_cbranch_scc1 L1_s6
    v_lshlrev_b32 v7, 16, v64
    v_and_b32 v8, 0xffff0000, v64
    v_lshlrev_b32 v9, 16, v65
    v_and_b32 v10, 0xffff0000, v65
    v_mul_f32 v7, 0.15915494, v7
    v_mul_f32 v8, 0.15915494, v8
    v_mul_f32 v9, 0.15915494, v9
    v_mul_f32 v10, 0.15915494, v10
    v_mul_hi_u32_u24 v14, 429497, v80
    v_lshrrev_b32 v12, 3, v56
    v_cos_f32 v7, v7
    v_lshlrev_b16 v13, 3, v56
    v_mad_i32_i24 v11, v14, s55, v80
    v_bitop3_b32 v12, v6, v13, v12 bitop3:0xca
    v_lshl_add_u32 v11, v11, 17, s40
    v_lshlrev_b16 v14, 8, v14
    v_lshrrev_b32 v13, 2, v56
    v_add_u32 v80, v12, v11
    v_bitop3_b32 v56, v5, v13, v14 bitop3:0xea
    ds_add_u32 v56, v2
    v_mul_hi_u32_u24 v14, 429497, v81
    v_lshrrev_b32 v12, 3, v57
    v_cos_f32 v8, v8
    v_lshlrev_b16 v13, 3, v57
    v_mad_i32_i24 v11, v14, s55, v81
    v_bitop3_b32 v12, v6, v13, v12 bitop3:0xca
    v_lshl_add_u32 v11, v11, 17, s40
    v_lshlrev_b16 v14, 8, v14
    v_lshrrev_b32 v13, 2, v57
    v_add_u32 v81, v12, v11
    v_bitop3_b32 v57, v5, v13, v14 bitop3:0xea
    ds_add_u32 v57, v2
    v_cvt_pk_bf16_f32 v64, v7, v8
    v_perm_b32 v12, v64, v64, s41
    v_bitop3_b32 v80, v4, v12, v80 bitop3:0xca
    v_perm_b32 v13, v64, v64, s42
    v_bitop3_b32 v81, v4, v13, v81 bitop3:0xca
    v_mul_hi_u32_u24 v14, 429497, v82
    v_lshrrev_b32 v12, 3, v58
    v_cos_f32 v9, v9
    v_lshlrev_b16 v13, 3, v58
    v_mad_i32_i24 v11, v14, s55, v82
    v_bitop3_b32 v12, v6, v13, v12 bitop3:0xca
    v_lshl_add_u32 v11, v11, 17, s40
    v_lshlrev_b16 v14, 8, v14
    v_lshrrev_b32 v13, 2, v58
    v_add_u32 v82, v12, v11
    v_bitop3_b32 v58, v5, v13, v14 bitop3:0xea
    ds_add_u32 v58, v2
    v_mul_hi_u32_u24 v14, 429497, v83
    v_lshrrev_b32 v12, 3, v59
    v_cos_f32 v10, v10
    v_lshlrev_b16 v13, 3, v59
    v_mad_i32_i24 v11, v14, s55, v83
    v_bitop3_b32 v12, v6, v13, v12 bitop3:0xca
    v_lshl_add_u32 v11, v11, 17, s40
    v_lshlrev_b16 v14, 8, v14
    v_lshrrev_b32 v13, 2, v59
    v_add_u32 v83, v12, v11
    v_bitop3_b32 v59, v5, v13, v14 bitop3:0xea
    ds_add_u32 v59, v2
    v_cvt_pk_bf16_f32 v65, v9, v10
    v_perm_b32 v12, v65, v65, s41
    v_bitop3_b32 v82, v4, v12, v82 bitop3:0xca
    v_perm_b32 v13, v65, v65, s42
    v_bitop3_b32 v83, v4, v13, v83 bitop3:0xca
L1_s6:
    s_waitcnt vmcnt(15)
    s_cmp_le_u32 s43, 7
    s_cbranch_scc1 L1_s7
    v_lshlrev_b32 v7, 16, v66
    v_and_b32 v8, 0xffff0000, v66
    v_lshlrev_b32 v9, 16, v67
    v_and_b32 v10, 0xffff0000, v67
    v_mul_f32 v7, 0.15915494, v7
    v_mul_f32 v8, 0.15915494, v8
    v_mul_f32 v9, 0.15915494, v9
    v_mul_f32 v10, 0.15915494, v10
    v_mul_hi_u32_u24 v14, 429497, v96
    v_lshrrev_b32 v12, 3, v60
    v_cos_f32 v7, v7
    v_lshlrev_b16 v13, 3, v60
    v_mad_i32_i24 v11, v14, s55, v96
    v_bitop3_b32 v12, v6, v13, v12 bitop3:0xca
    v_lshl_add_u32 v11, v11, 17, s40
    v_lshlrev_b16 v14, 8, v14
    v_lshrrev_b32 v13, 2, v60
    v_add_u32 v96, v12, v11
    v_bitop3_b32 v60, v5, v13, v14 bitop3:0xea
    ds_add_u32 v60, v2
    v_mul_hi_u32_u24 v14, 429497, v97
    v_lshrrev_b32 v12, 3, v61
    v_cos_f32 v8, v8
    v_lshlrev_b16 v13, 3, v61
    v_mad_i32_i24 v11, v14, s55, v97
    v_bitop3_b32 v12, v6, v13, v12 bitop3:0xca
    v_lshl_add_u32 v11, v11, 17, s40
    v_lshlrev_b16 v14, 8, v14
    v_lshrrev_b32 v13, 2, v61
    v_add_u32 v97, v12, v11
    v_bitop3_b32 v61, v5, v13, v14 bitop3:0xea
    ds_add_u32 v61, v2
    v_cvt_pk_bf16_f32 v66, v7, v8
    v_perm_b32 v12, v66, v66, s41
    v_bitop3_b32 v96, v4, v12, v96 bitop3:0xca
    v_perm_b32 v13, v66, v66, s42
    v_bitop3_b32 v97, v4, v13, v97 bitop3:0xca
    v_mul_hi_u32_u24 v14, 429497, v98
    v_lshrrev_b32 v12, 3, v62
    v_cos_f32 v9, v9
    v_lshlrev_b16 v13, 3, v62
    v_mad_i32_i24 v11, v14, s55, v98
    v_bitop3_b32 v12, v6, v13, v12 bitop3:0xca
    v_lshl_add_u32 v11, v11, 17, s40
    v_lshlrev_b16 v14, 8, v14
    v_lshrrev_b32 v13, 2, v62
    v_add_u32 v98, v12, v11
    v_bitop3_b32 v62, v5, v13, v14 bitop3:0xea
    ds_add_u32 v62, v2
    v_mul_hi_u32_u24 v14, 429497, v99
    v_lshrrev_b32 v12, 3, v63
    v_cos_f32 v10, v10
    v_lshlrev_b16 v13, 3, v63
    v_mad_i32_i24 v11, v14, s55, v99
    v_bitop3_b32 v12, v6, v13, v12 bitop3:0xca
    v_lshl_add_u32 v11, v11, 17, s40
    v_lshlrev_b16 v14, 8, v14
    v_lshrrev_b32 v13, 2, v63
    v_add_u32 v99, v12, v11
    v_bitop3_b32 v63, v5, v13, v14 bitop3:0xea
    ds_add_u32 v63, v2
    v_cvt_pk_bf16_f32 v67, v9, v10
    v_perm_b32 v12, v67, v67, s41
    v_bitop3_b32 v98, v4, v12, v98 bitop3:0xca
    v_perm_b32 v13, v67, v67, s42
    v_bitop3_b32 v99, v4, v13, v99 bitop3:0xca
L1_s7:
    v_lshrrev_b32 v8, 2, v0
    v_and_b32 v7, 0x3c00, v0
    v_bitop3_b32 v7, v5, v8, v7 bitop3:0xea
    s_waitcnt lgkmcnt(0)
    s_barrier
    ds_read2st64_b32 v[8:9], v7 offset0:0 offset1:1
    ds_read2st64_b32 v[10:11], v7 offset0:2 offset1:3
    s_add_u32 s47, s35, 0x7ed4000
    buffer_store_dwordx4 v[100:103], v0, s[20:23], s47 offen sc1
    s_waitcnt lgkmcnt(0)
    v_lshl_or_b32 v12, v9, 16, v8
    v_lshl_or_b32 v13, v11, 16, v10
    v_mov_b32 v14, v12
    v_mov_b32 v15, v13
    s_nop 0
    v_add_u32_dpp v14, v14, v14 row_shr:1 row_mask:0xf bank_mask:0xf bound_ctrl:1
    v_add_u32_dpp v15, v15, v15 row_shr:1 row_mask:0xf bank_mask:0xf bound_ctrl:1
    s_nop 0
    v_add_u32_dpp v14, v14, v14 row_shr:2 row_mask:0xf bank_mask:0xf bound_ctrl:1
    v_add_u32_dpp v15, v15, v15 row_shr:2 row_mask:0xf bank_mask:0xf bound_ctrl:1
    s_nop 0
    v_add_u32_dpp v14, v14, v14 row_shr:4 row_mask:0xf bank_mask:0xf bound_ctrl:1
    v_add_u32_dpp v15, v15, v15 row_shr:4 row_mask:0xf bank_mask:0xf bound_ctrl:1
    s_nop 0
    v_add_u32_dpp v14, v14, v14 row_shr:8 row_mask:0xf bank_mask:0xf bound_ctrl:1
    v_add_u32_dpp v15, v15, v15 row_shr:8 row_mask:0xf bank_mask:0xf bound_ctrl:1
    s_nop 0
    v_add_u32_dpp v14, v14, v14 row_bcast:15 row_mask:0xa bank_mask:0xf
    v_add_u32_dpp v15, v15, v15 row_bcast:15 row_mask:0xa bank_mask:0xf
    s_nop 0
    v_add_u32_dpp v14, v14, v14 row_bcast:31 row_mask:0xc bank_mask:0xf
    v_add_u32_dpp v15, v15, v15 row_bcast:31 row_mask:0xc bank_mask:0xf
    v_readlane_b32 s48, v14, 63
    v_readlane_b32 s49, v15, 63
    s_lshl_b32 s54, s32, 2
    v_mov_b32 v8, s54
    s_and_b32 s50, s48, 0xffff
    s_lshr_b32 s51, s48, 16
    s_and_b32 s52, s49, 0xffff
    s_lshr_b32 s53, s49, 16
    s_add_u32 s51, s51, s50
    s_add_u32 s52, s52, s51
    s_add_u32 s53, s53, s52
    v_mov_b32 v9, s53
    v_and_b32_dpp v3, v3, v3 quad_perm:[1,0,3,2] row_mask:0xf bank_mask:0xf
    s_mov_b64 exec, 1
    ds_write_b32 v8, v9 offset:16384
    ds_write_b32 v8, v3 offset:16448
    s_mov_b64 exec, -1
    v_and_b32 v8, 60, v7
    s_waitcnt lgkmcnt(0)
    s_barrier
    ds_read_b32 v9, v8 offset:16384
    ds_read_b32 v10, v8 offset:16448
    s_waitcnt lgkmcnt(0)
    v_readlane_b32 s56, v10, 15
    s_xor_b32 s56, s56, 0x80
    v_add_u32_dpp v9, v9, v9 row_shr:1 row_mask:0xf bank_mask:0xf bound_ctrl:1
    s_nop 1
    v_add_u32_dpp v9, v9, v9 row_shr:2 row_mask:0xf bank_mask:0xf bound_ctrl:1
    s_nop 1
    v_add_u32_dpp v9, v9, v9 row_shr:4 row_mask:0xf bank_mask:0xf bound_ctrl:1
    s_nop 1
    v_add_u32_dpp v9, v9, v9 row_shr:8 row_mask:0xf bank_mask:0xf bound_ctrl:1
    s_nop 0
    v_readlane_b32 s54, v9, s32
    s_sub_u32 s54, s54, s53
    s_add_u32 s50, s50, s54
    s_add_u32 s51, s51, s54
    s_add_u32 s52, s52, s54
    s_pack_ll_b32_b16 s48, s54, s50
    s_pack_ll_b32_b16 s49, s51, s52
    v_add_u32 v14, s48, v14
    v_add_u32 v15, s49, v15
    v_sub_u32 v12, v14, v12
    v_sub_u32 v13, v15, v13
    v_and_b32 v8, 0xffff, v12
    v_lshrrev_b32 v9, 16, v12
    v_and_b32 v10, 0xffff, v13
    v_lshrrev_b32 v11, 16, v13
    ds_write2st64_b32 v7, v8, v9 offset0:0 offset1:1
    ds_write2st64_b32 v7, v10, v11 offset0:2 offset1:3
    v_and_b32 v8, 0x3f0, v0
    v_lshl_add_u32 v8, v8, 1, s36
    ds_write_b64 v8, v[12:13] offset:20480
    s_bitset0_b64 exec, 63
    s_not_b64 exec, exec
    ds_write_b64 v8, v[14:15] offset:20512
    s_mov_b64 exec, -1
    s_waitcnt lgkmcnt(0)
    s_barrier
    s_setprio 3
    ds_add_rtn_u32 v120, v120, v2
    ds_add_rtn_u32 v121, v121, v2
    ds_add_rtn_u32 v122, v122, v2
    ds_add_rtn_u32 v123, v123, v2
    ds_read_b128 v[12:15], v0 offset:20480
    v_cmp_gt_u32 vcc, 8448, v0
    ds_add_rtn_u32 v124, v124, v2
    ds_add_rtn_u32 v125, v125, v2
    ds_add_rtn_u32 v126, v126, v2
    ds_add_rtn_u32 v127, v127, v2
    s_setprio 2
    ds_add_rtn_u32 v24, v24, v2
    ds_add_rtn_u32 v25, v25, v2
    ds_add_rtn_u32 v26, v26, v2
    ds_add_rtn_u32 v27, v27, v2
    s_waitcnt lgkmcnt(8)
    s_cbranch_vccz L1_p8
    s_add_u32 s44, s35, 0xa900000
    s_mov_b64 exec, vcc
    buffer_store_dwordx4 v[12:15], v0, s[24:27], s44 offen sc1
    s_mov_b64 exec, -1
L1_p8:
    s_add_u32 s45, s35, 0x7ed8000
    buffer_store_dwordx4 v[88:91], v0, s[20:23], s45 offen sc1
    ds_add_rtn_u32 v52, v52, v2
    ds_add_rtn_u32 v53, v53, v2
    ds_add_rtn_u32 v54, v54, v2
    ds_add_rtn_u32 v55, v55, v2
    s_load_dwordx2 s[28:29], s[0:1], 0
    s_load_dwordx2 s[50:51], s[0:1], 40
    s_load_dwordx2 s[52:53], s[0:1], 24
    s_setprio 1
    ds_add_rtn_u32 v68, v68, v2
    ds_add_rtn_u32 v69, v69, v2
    ds_add_rtn_u32 v70, v70, v2
    ds_add_rtn_u32 v71, v71, v2
    s_add_u32 s80, s30, 0xd340000
    s_addc_u32 s81, s31, 0
    s_mov_b32 s82, 0xa000
    s_mov_b32 s83, 0x20000
    s_min_u32 s3, s84, 127
    s_mul_i32 s3, s3, 40960
    s_add_u32 s80, s80, s3
    s_addc_u32 s81, s81, 0
    s_cmp_ge_u32 s84, 128
    s_cselect_b32 s82, 0, s82
    s_waitcnt vmcnt(2)
    v_add_u32 v9, 0, v0
    buffer_store_dwordx4 v[112:115], v9, s[80:83], 0 offen sc1
    v_add_u32 v9, 16384, v0
    buffer_store_dwordx4 v[104:107], v9, s[80:83], 0 offen sc1
    v_add_u32 v9, 32768, v0
    buffer_store_dwordx4 v[28:31], v9, s[80:83], 0 offen sc1
    s_cmp_le_u32 s43, 5
    s_cbranch_scc1 L1_s9
    ds_add_rtn_u32 v76, v76, v2
    ds_add_rtn_u32 v77, v77, v2
    ds_add_rtn_u32 v78, v78, v2
    ds_add_rtn_u32 v79, v79, v2
L1_s9:
    s_setprio 0
    s_cmp_le_u32 s43, 6
    s_cbranch_scc1 L1_s10
    ds_add_rtn_u32 v56, v56, v2
    ds_add_rtn_u32 v57, v57, v2
    ds_add_rtn_u32 v58, v58, v2
    ds_add_rtn_u32 v59, v59, v2
L1_s10:
    s_cmp_le_u32 s43, 7
    s_cbranch_scc1 L1_s11
    ds_add_rtn_u32 v60, v60, v2
    ds_add_rtn_u32 v61, v61, v2
    ds_add_rtn_u32 v62, v62, v2
    ds_add_rtn_u32 v63, v63, v2
L1_s11:
    s_waitcnt lgkmcnt(0)
    s_barrier
    s_load_dwordx4 s[96:99], s[50:51], 0
    s_mov_b64 s[4:5], s[52:53]
    s_bfe_u32 s33, s2, 0x20001
    s_and_b32 s34, s2, 1
    s_lshl_b32 s34, s34, 5
    s_lshr_b32 s3, s2, 3
    s_add_u32 s34, s34, s3
    s_mul_i32 s39, s33, 2080
    s_lshl_b32 s3, s34, 5
    s_add_u32 s39, s39, s3
    s_mul_i32 s40, s33, 1310720
    s_add_u32 s40, s40, 0x50000
    s_lshl_b32 s38, s32, 11
    s_mul_i32 s100, s32, 3072
    s_mov_b32 s8, s30
    s_mov_b32 s9, s31
    s_mov_b32 s10, 0xd340000
    s_mov_b32 s11, 0x20000
    s_add_u32 s12, s30, 0x28000
    s_addc_u32 s13, s31, 0
    s_mov_b32 s14, 0xd318000
    s_mov_b32 s15, 0x20000
    s_mov_b32 s16, s64
    s_mov_b32 s17, s65
    s_mov_b32 s18, 0x20
    s_mov_b32 s19, 0x20000
    s_mov_b32 s24, s28
    s_mov_b32 s25, s29
    s_mov_b32 s26, 0x4e2000
    s_mov_b32 s27, 0x20000
    s_setprio 3
    v_and_b32 v7, -4, v120
    v_lshl_add_u32 v8, v120, 2, v7
    ds_write_b32 v8, v16
    v_lshl_add_u32 v7, v7, 2, v120
    ds_write_b8 v7, v44 offset:16
    v_and_b32 v9, -4, v121
    v_lshl_add_u32 v10, v121, 2, v9
    ds_write_b32 v10, v17
    v_lshl_add_u32 v9, v9, 2, v121
    ds_write_b8_d16_hi v9, v44 offset:16
    v_and_b32 v7, -4, v122
    v_lshl_add_u32 v8, v122, 2, v7
    ds_write_b32 v8, v18
    v_lshl_add_u32 v7, v7, 2, v122
    ds_write_b8 v7, v45 offset:16
    v_and_b32 v9, -4, v123
    v_lshl_add_u32 v10, v123, 2, v9
    ds_write_b32 v10, v19
    v_lshl_add_u32 v9, v9, 2, v123
    ds_write_b8_d16_hi v9, v45 offset:16
    s_add_u32 s46, s35, 0x7edc000
    buffer_store_dwordx4 v[116:119], v0, s[20:23], s46 offen sc1
    v_and_b32 v13, 0x3f0, v0
    v_and_b32 v14, 0x300, v13
    v_bfe_u32 v15, v13, 4, 4
    s_lshl_b32 s3, s32, 4
    v_add3_u32 v14, v14, v15, s3
    v_mul_u32_u24 v2, 173056, v14
    v_lshrrev_b32 v14, 6, v13
    s_add_u32 s3, s3, 0x400
    v_add_u32 v14, s3, v14
    v_mul_u32_u24 v4, 173056, v14
    v_and_b32 v14, 3, v14
    v_and_b32 v15, 0x30, v13
    v_lshl_add_u32 v14, v14, 5, v15
    v_add_u32 v6, v14, v4
    v_lshl_add_u32 v5, v15, 1, v2
    v_lshrrev_b32 v14, 3, v15
    buffer_load_ushort v100, v14, s[16:19], 0 offen offset:0
    buffer_load_ushort v101, v14, s[16:19], 0 offen offset:8
    buffer_load_ushort v102, v14, s[16:19], 0 offen offset:16
    buffer_load_ushort v103, v14, s[16:19], 0 offen offset:24
    s_mul_i32 s3, s32, 5120
    v_add_u32 v3, s3, v13
    v_lshrrev_b32 v14, 2, v13
    v_add_u32 v14, s38, v14
    v_and_b32 v7, -4, v124
    v_lshl_add_u32 v8, v124, 2, v7
    ds_write_b32 v8, v20
    v_lshl_add_u32 v7, v7, 2, v124
    ds_write_b8 v7, v46 offset:16
    v_and_b32 v9, -4, v125
    v_lshl_add_u32 v10, v125, 2, v9
    ds_write_b32 v10, v21
    v_lshl_add_u32 v9, v9, 2, v125
    ds_write_b8_d16_hi v9, v46 offset:16
    v_and_b32 v7, -4, v126
    v_lshl_add_u32 v8, v126, 2, v7
    ds_write_b32 v8, v22
    v_lshl_add_u32 v7, v7, 2, v126
    ds_write_b8 v7, v47 offset:16
    v_and_b32 v9, -4, v127
    v_lshl_add_u32 v10, v127, 2, v9
    ds_write_b32 v10, v23
    v_lshl_add_u32 v9, v9, 2, v127
    ds_write_b8_d16_hi v9, v47 offset:16
    s_setprio 2
    v_and_b32 v7, -4, v24
    v_lshl_add_u32 v8, v24, 2, v7
    ds_write_b32 v8, v40
    v_lshl_add_u32 v7, v7, 2, v24
    ds_write_b8 v7, v32 offset:16
    v_and_b32 v9, -4, v25
    v_lshl_add_u32 v10, v25, 2, v9
    ds_write_b32 v10, v41
    v_lshl_add_u32 v9, v9, 2, v25
    ds_write_b8_d16_hi v9, v32 offset:16
    v_and_b32 v7, -4, v26
    v_lshl_add_u32 v8, v26, 2, v7
    ds_write_b32 v8, v42
    v_lshl_add_u32 v7, v7, 2, v26
    ds_write_b8 v7, v33 offset:16
    v_and_b32 v9, -4, v27
    v_lshl_add_u32 v10, v27, 2, v9
    ds_write_b32 v10, v43
    v_lshl_add_u32 v9, v9, 2, v27
    ds_write_b8_d16_hi v9, v33 offset:16
    s_add_u32 s47, s35, 0x7ee0000
    buffer_store_dwordx4 v[92:95], v0, s[20:23], s47 offen sc1
    v_and_b32 v7, -4, v52
    v_lshl_add_u32 v8, v52, 2, v7
    ds_write_b32 v8, v48
    v_lshl_add_u32 v7, v7, 2, v52
    ds_write_b8 v7, v34 offset:16
    v_and_b32 v9, -4, v53
    v_lshl_add_u32 v10, v53, 2, v9
    ds_write_b32 v10, v49
    v_lshl_add_u32 v9, v9, 2, v53
    ds_write_b8_d16_hi v9, v34 offset:16
    v_and_b32 v7, -4, v54
    v_lshl_add_u32 v8, v54, 2, v7
    ds_write_b32 v8, v50
    v_lshl_add_u32 v7, v7, 2, v54
    ds_write_b8 v7, v35 offset:16
    v_and_b32 v9, -4, v55
    v_lshl_add_u32 v10, v55, 2, v9
    ds_write_b32 v10, v51
    v_lshl_add_u32 v9, v9, 2, v55
    ds_write_b8_d16_hi v9, v35 offset:16
    s_setprio 1
    v_and_b32 v7, -4, v68
    v_lshl_add_u32 v8, v68, 2, v7
    ds_write_b32 v8, v84
    v_lshl_add_u32 v7, v7, 2, v68
    ds_write_b8 v7, v72 offset:16
    v_and_b32 v9, -4, v69
    v_lshl_add_u32 v10, v69, 2, v9
    ds_write_b32 v10, v85
    v_lshl_add_u32 v9, v9, 2, v69
    ds_write_b8_d16_hi v9, v72 offset:16
    v_and_b32 v7, -4, v70
    v_lshl_add_u32 v8, v70, 2, v7
    ds_write_b32 v8, v86
    v_lshl_add_u32 v7, v7, 2, v70
    ds_write_b8 v7, v73 offset:16
    v_and_b32 v9, -4, v71
    v_lshl_add_u32 v10, v71, 2, v9
    ds_write_b32 v10, v87
    v_lshl_add_u32 v9, v9, 2, v71
    ds_write_b8_d16_hi v9, v73 offset:16
    s_cmp_le_u32 s43, 5
    s_cbranch_scc1 L1_s12
    v_and_b32 v7, -4, v76
    v_lshl_add_u32 v8, v76, 2, v7
    ds_write_b32 v8, v36
    v_lshl_add_u32 v7, v7, 2, v76
    ds_write_b8 v7, v74 offset:16
    v_and_b32 v9, -4, v77
    v_lshl_add_u32 v10, v77, 2, v9
    ds_write_b32 v10, v37
    v_lshl_add_u32 v9, v9, 2, v77
    ds_write_b8_d16_hi v9, v74 offset:16
    v_and_b32 v7, -4, v78
    v_lshl_add_u32 v8, v78, 2, v7
    ds_write_b32 v8, v38
    v_lshl_add_u32 v7, v7, 2, v78
    ds_write_b8 v7, v75 offset:16
    v_and_b32 v9, -4, v79
    v_lshl_add_u32 v10, v79, 2, v9
    ds_write_b32 v10, v39
    v_lshl_add_u32 v9, v9, 2, v79
    ds_write_b8_d16_hi v9, v75 offset:16
L1_s12:
    s_add_u32 s44, s35, 0x7ee4000
    buffer_store_dwordx4 v[108:111], v0, s[20:23], s44 offen sc1
    s_setprio 0
    s_cmp_le_u32 s43, 6
    s_cbranch_scc1 L1_s13
    v_and_b32 v7, -4, v56
    v_lshl_add_u32 v8, v56, 2, v7
    ds_write_b32 v8, v80
    v_lshl_add_u32 v7, v7, 2, v56
    ds_write_b8 v7, v64 offset:16
    v_and_b32 v9, -4, v57
    v_lshl_add_u32 v10, v57, 2, v9
    ds_write_b32 v10, v81
    v_lshl_add_u32 v9, v9, 2, v57
    ds_write_b8_d16_hi v9, v64 offset:16
    v_and_b32 v7, -4, v58
    v_lshl_add_u32 v8, v58, 2, v7
    ds_write_b32 v8, v82
    v_lshl_add_u32 v7, v7, 2, v58
    ds_write_b8 v7, v65 offset:16
    v_and_b32 v9, -4, v59
    v_lshl_add_u32 v10, v59, 2, v9
    ds_write_b32 v10, v83
    v_lshl_add_u32 v9, v9, 2, v59
    ds_write_b8_d16_hi v9, v65 offset:16
L1_s13:
    s_cmp_le_u32 s43, 7
    s_cbranch_scc1 L1_s14
    v_and_b32 v7, -4, v60
    v_lshl_add_u32 v8, v60, 2, v7
    ds_write_b32 v8, v96
    v_lshl_add_u32 v7, v7, 2, v60
    ds_write_b8 v7, v66 offset:16
    v_and_b32 v9, -4, v61
    v_lshl_add_u32 v10, v61, 2, v9
    ds_write_b32 v10, v97
    v_lshl_add_u32 v9, v9, 2, v61
    ds_write_b8_d16_hi v9, v66 offset:16
    v_and_b32 v7, -4, v62
    v_lshl_add_u32 v8, v62, 2, v7
    ds_write_b32 v8, v98
    v_lshl_add_u32 v7, v7, 2, v62
    ds_write_b8 v7, v67 offset:16
    v_and_b32 v9, -4, v63
    v_lshl_add_u32 v10, v63, 2, v9
    ds_write_b32 v10, v99
    v_lshl_add_u32 v9, v9, 2, v63
    ds_write_b8_d16_hi v9, v67 offset:16
L1_s14:
    s_waitcnt vmcnt(3)
    v_add_u32 v7, 0x10000, v0
    v_add_u32 v12, 0x20000, v0
    s_waitcnt lgkmcnt(0)
    s_barrier
    ds_read_b128 v[24:27], v0 offset:0
    ds_read_b128 v[28:31], v0 offset:16384
    ds_read_b128 v[32:35], v0 offset:32768
    ds_read_b128 v[36:39], v0 offset:49152
    ds_read_b128 v[76:79], v7 offset:0
    ds_read_b128 v[80:83], v7 offset:16384
    ds_read_b128 v[84:87], v7 offset:32768
    ds_read_b128 v[104:107], v7 offset:49152
    ds_read_b128 v[68:71], v12 offset:0
    ds_read_b128 v[72:75], v12 offset:16384
    s_cmp_lg_u32 s32, 0
    s_cbranch_scc1 L2_sg1
    s_mov_b32 exec_hi, 0
    v_mov_b32 v11, 1
    buffer_store_dword v11, v14, s[60:63], s57 offen sc1
    s_mov_b64 exec, -1
L2_sg1:
    s_waitcnt lgkmcnt(9)
    s_add_u32 s45, s35, 0xa900000
    buffer_store_dwordx4 v[24:27], v0, s[20:23], s45 offen sc1
    s_waitcnt lgkmcnt(8)
    s_add_u32 s46, s35, 0xa904000
    buffer_store_dwordx4 v[28:31], v0, s[20:23], s46 offen sc1
    s_waitcnt lgkmcnt(7)
    s_add_u32 s47, s35, 0xa908000
    buffer_store_dwordx4 v[32:35], v0, s[20:23], s47 offen sc1
    s_waitcnt lgkmcnt(6)
    s_add_u32 s44, s35, 0xa90c000
    buffer_store_dwordx4 v[36:39], v0, s[20:23], s44 offen sc1
    s_waitcnt lgkmcnt(5)
    s_add_u32 s45, s35, 0xa910000
    buffer_store_dwordx4 v[76:79], v0, s[20:23], s45 offen sc1
    s_waitcnt lgkmcnt(4)
    s_add_u32 s46, s35, 0xa914000
    buffer_store_dwordx4 v[80:83], v0, s[20:23], s46 offen sc1
    s_waitcnt lgkmcnt(3)
    s_add_u32 s47, s35, 0xa918000
    buffer_store_dwordx4 v[84:87], v0, s[20:23], s47 offen sc1
    s_waitcnt lgkmcnt(2)
    s_cmp_le_u32 s43, 5
    s_cbranch_scc1 L1_q15
    s_add_u32 s44, s35, 0xa91c000
    buffer_store_dwordx4 v[104:107], v0, s[20:23], s44 offen sc1
L1_q15:
    s_waitcnt lgkmcnt(1)
    s_cmp_le_u32 s43, 6
    s_cbranch_scc1 L1_q16
    s_add_u32 s45, s35, 0xa920000
    buffer_store_dwordx4 v[68:71], v0, s[20:23], s45 offen sc1
L1_q16:
    s_waitcnt lgkmcnt(0)
    s_cmp_le_u32 s43, 7
    s_cbranch_scc1 L1_q17
    s_add_u32 s46, s35, 0xa924000
    buffer_store_dwordx4 v[72:75], v0, s[20:23], s46 offen sc1
L1_q17:
    s_waitcnt lgkmcnt(0)
    s_barrier
    s_setprio 3
    v_mov_b32 v92, v0
    v_mov_b32 v93, v6
    v_mov_b32 v94, v13
    v_mov_b32 v95, v5
    v_mov_b32 v0, v14
    v_lshl_add_u32 v7, v13, 3, s38
    v_lshrrev_b32 v16, 2, v15
    v_mad_u32_u24 v4, v16, 5, v4
    v_or_b32 v4, 0xf0000000, v4
    v_or_b32 v2, 0xf0000000, v2
    v_sub_u32 v1, 28, v16
    v_lshrrev_b32 v17, 2, v16
    v_and_b32 v18, 3, v17
    v_lshlrev_b32 v18, 4, v18
    v_mov_b32 v10, 0x3f80
    v_mov_b32 v11, 0
    v_lshlrev_b64 v[10:11], v18, v[10:11]
    v_and_b32 v18, 3, v17
    v_lshlrev_b32 v18, 4, v18
    v_mov_b32 v12, 0xbf80
    v_mov_b32 v13, 0
    v_lshlrev_b64 v[12:13], v18, v[12:13]
    v_mov_b32 v45, 0xf0000000
    v_mov_b32 v5, 0x1fff8
    v_mov_b32 v6, 0x07ff0000
    v_mov_b32 v16, 0
    v_mov_b32 v17, 0
    v_mov_b32 v18, 0
    v_mov_b32 v19, 0
    v_add_u32 v20, 81920, v92
    v_add_u32 v21, 0x10000, v20
    ds_write_b128 v20, v[16:19] offset:0
    ds_write_b128 v20, v[16:19] offset:16384
    s_setprio 2
    ds_write_b128 v20, v[16:19] offset:32768
    ds_write_b128 v20, v[16:19] offset:49152
    ds_write_b128 v21, v[16:19]
    s_setprio 1
    s_setprio 0
    s_mov_b32 s44, 0x4000c0c
    s_mov_b32 s45, 0x4010c0c
    s_mov_b32 s46, 0x4020c0c
    s_mov_b32 s47, 0x4030c0c
    s_mov_b32 s36, 0
    s_mov_b32 s42, 0
    s_mov_b64 s[80:81], 0
    s_mov_b64 s[84:85], 0
    s_mov_b64 s[48:49], 0
    s_add_u32 s16, s30, 0xd340000
    s_addc_u32 s17, s31, 0
    s_mov_b32 s18, 0x500000
    s_mov_b32 s19, 0x20000
    s_add_u32 s20, s30, 0xd841000
    s_addc_u32 s21, s31, 0
    s_mov_b32 s22, 0x13880
    s_mov_b32 s23, 0x20000
    s_lshl_b32 s3, s33, 6
    s_add_u32 s3, s3, s34
    s_mul_i32 s3, s3, 80000
    s_add_u32 s20, s20, s3
    s_addc_u32 s21, s21, 0
    v_mov_b32 v68, 0
    v_mov_b32 v69, 0
    v_mov_b32 v70, 0
    v_mov_b32 v71, 0
    v_mov_b32 v72, 0
    v_mov_b32 v73, 0
    v_mov_b32 v74, 0
    v_mov_b32 v75, 0
    s_waitcnt vmcnt(0)
    v_lshl_or_b32 v8, v101, 16, v100
    v_lshl_or_b32 v9, v103, 16, v102
    s_barrier
    s_cmp_lg_u32 s32, 0
    s_cbranch_scc1 L2_sg2
    s_mov_b32 exec_hi, 0
    v_mov_b32 v88, 2
    buffer_store_dword v88, v0, s[60:63], s57 offen sc1
    s_mov_b64 exec, -1
L2_sg2:
    s_mul_i32 s3, s33, 1280000
    s_add_u32 s3, s3, s100
    s_add_u32 s3, s3, 32768
    buffer_load_dwordx4 v[124:127], v94, s[24:27], s3 offen offset:2048
    s_mul_i32 s3, s33, 1280000
    s_add_u32 s3, s3, s100
    s_add_u32 s3, s3, 32768
    buffer_load_dwordx4 v[116:119], v94, s[24:27], s3 offen offset:0
    s_mul_i32 s3, s33, 1280000
    s_add_u32 s3, s3, s100
    s_add_u32 s3, s3, 32768
    buffer_load_dwordx4 v[120:123], v94, s[24:27], s3 offen offset:1024
    s_mul_i32 s3, s33, 1280000
    s_add_u32 s3, s3, s38
    s_add_u32 s3, s3, 0
    buffer_load_dwordx4 v[108:111], v94, s[24:27], s3 offen offset:0
    s_mul_i32 s3, s33, 1280000
    s_add_u32 s3, s3, s38
    s_add_u32 s3, s3, 0
    buffer_load_dwordx4 v[112:115], v94, s[24:27], s3 offen offset:1024
    s_cmp_eq_u32 s56, 0
    s_cbranch_scc1 L2_e3
    v_lshlrev_b32 v16, 3, v94
    v_and_b32 v16, 0x80, v16
L2_e4:
    buffer_load_dword v88, v16, s[68:71], 0 offen sc1
    s_waitcnt vmcnt(0)
    v_cmp_gt_u32 vcc, 0x80, v88
    s_cbranch_vccnz L2_e4
L2_e3:
    s_mov_b64 exec, 0xffff
L2_p1:
    buffer_load_dword v88, v7, s[60:63], 0 offen sc1
    s_waitcnt vmcnt(0)
    v_cmp_gt_u32 vcc, 1, v88
    s_cbranch_vccnz L2_p1s
    s_mov_b64 exec, -1
    v_cmp_gt_u32 vcc, 2, v88
    s_and_b32 s56, vcc_lo, 0xffff
    buffer_load_dwordx4 v[48:51], v95, s[12:15], s39 offen offset:0
    buffer_load_dwordx4 v[56:59], v95, s[12:15], s39 offen offset:32
    buffer_load_dwordx4 v[52:55], v95, s[12:15], s39 offen offset:16
    buffer_load_dwordx4 v[60:63], v95, s[12:15], s39 offen offset:48
    buffer_load_dwordx4 v[64:67], v93, s[12:15], s39 offen
    s_waitcnt vmcnt(0)
    v_sub_u16 v88, v56, v48
    v_and_b32 v89, 3, v48
    v_add3_u32 v99, v88, v89, 3
    v_and_b32 v99, -4, v99
    v_max_u32 v99, 4, v99
    v_and_b32 v97, 0xfffc, v48
    v_bfm_b32 v96, v88, v89
    v_add_u32_dpp v91, v99, v99 row_shr:1 row_mask:0xf bank_mask:0xf bound_ctrl:1
    v_mad_u32_u24 v97, v97, 5, v2
    v_cmp_lt_u32 vcc, 16, v99
    v_add_u32_dpp v91, v91, v91 row_shr:2 row_mask:0xf bank_mask:0xf bound_ctrl:1
    v_sub_u32 v98, s38, v99
    v_lshrrev_b64 v[48:49], 16, v[48:49]
    v_add_u32_dpp v91, v91, v91 row_shr:4 row_mask:0xf bank_mask:0xf bound_ctrl:1
    v_lshrrev_b64 v[56:57], 16, v[56:57]
    s_mov_b32 s101, 0
    v_add_u32_dpp v91, v91, v91 row_shr:8 row_mask:0xf bank_mask:0xf bound_ctrl:1
    s_nop 1
    v_add_u32_dpp v91, v91, v91 row_bcast:15 row_mask:0xa bank_mask:0xf
    s_nop 1
    v_add_u32_dpp v91, v91, v91 row_bcast:31 row_mask:0xc bank_mask:0xf
    v_add_u32 v98, v98, v91
    v_readlane_b32 s37, v91, 63
    s_cbranch_vccnz L2_xo3
L2_xp3:
    v_mov_b32 v44, v43
    s_cmp_gt_u32 s37, 1024
    s_cbranch_scc1 L2_xs4
    s_cmp_lg_u32 s101, 0
    s_cbranch_scc1 L2_xa4
L2_xb4:
    v_lshlrev_b32 v89, 16, v96
    v_add_u32 v90, 60, v97
    v_bitop3_b32 v90, v89, v45, v90 bitop3:0x6a
    ds_write_b32 v98, v90 offset:12
    v_lshlrev_b32 v89, 20, v96
    v_add_u32 v90, 40, v97
    v_bitop3_b32 v90, v89, v45, v90 bitop3:0x6a
    ds_write_b32 v98, v90 offset:8
    v_lshlrev_b32 v89, 24, v96
    v_add_u32 v90, 20, v97
    v_bitop3_b32 v90, v89, v45, v90 bitop3:0x6a
    ds_write_b32 v98, v90 offset:4
    v_lshlrev_b32 v89, 28, v96
    v_bitop3_b32 v90, v89, v45, v97 bitop3:0x6a
    ds_write_b32 v98, v90 offset:0
    v_mov_b32_dpp v91, v64 quad_perm:[0,0,0,0] row_mask:0xf bank_mask:0xf
    v_and_b32 v89, 3, v91
    v_and_b32 v97, 0xfffc, v91
    v_sub_u16_dpp v88, v64, v91 quad_perm:[2,2,2,2] row_mask:0xf bank_mask:0xf
    v_mad_u32_u24 v97, v97, 5, v4
    v_add_u32 v99, v88, v89
    v_bfm_b32 v96, v88, v89
    v_cmp_lt_u32 s[58:59], 16, v99
    v_lshlrev_b32 v89, v1, v96
    v_and_b32 v89, v45, v89
    v_cmp_ne_u32 vcc, 0, v89
    v_xor_b32 v90, v97, v89
    s_add_u32 s3, s37, s38
    v_mbcnt_lo_u32_b32 v98, vcc_lo, 0
    v_mbcnt_hi_u32_b32 v98, vcc_hi, v98
    s_bcnt1_i32_b64 s41, vcc
    v_lshl_add_u32 v98, v98, 2, s3
    s_mov_b64 exec, vcc
    ds_write_b32 v98, v90
    s_mov_b64 exec, -1
    s_lshl2_add_u32 s37, s41, s37
    s_cmp_lg_u64 s[58:59], 0
    s_cbranch_scc1 L2_xe4
L2_xr4:
    v_add_u32 v98, s37, v0
    v_mov_b32 v90, -1
    ds_write_b32 v98, v90
    ds_read2st64_b32 v[40:41], v0 offset0:0 offset1:1
    ds_read2st64_b32 v[42:43], v0 offset0:2 offset1:3
    s_sub_u32 s3, s37, 768
    s_cmp_gt_u32 s3, 256
    s_cbranch_scc1 L2_xf4
L2_xg4:
    v_sub_u16 v88, v58, v50
    v_and_b32 v89, 3, v50
    v_add3_u32 v99, v88, v89, 3
    v_and_b32 v99, -4, v99
    v_max_u32 v99, 4, v99
    v_and_b32 v97, 0xfffc, v50
    v_bfm_b32 v96, v88, v89
    v_add_u32_dpp v91, v99, v99 row_shr:1 row_mask:0xf bank_mask:0xf bound_ctrl:1
    v_mad_u32_u24 v97, v97, 5, v2
    v_cmp_lt_u32 vcc, 16, v99
    v_add_u32_dpp v91, v91, v91 row_shr:2 row_mask:0xf bank_mask:0xf bound_ctrl:1
    v_sub_u32 v98, s38, v99
    v_lshrrev_b64 v[50:51], 16, v[50:51]
    v_add_u32_dpp v91, v91, v91 row_shr:4 row_mask:0xf bank_mask:0xf bound_ctrl:1
    v_lshrrev_b64 v[58:59], 16, v[58:59]
    s_mov_b32 s101, 0
    v_add_u32_dpp v91, v91, v91 row_shr:8 row_mask:0xf bank_mask:0xf bound_ctrl:1
    s_nop 1
    v_add_u32_dpp v91, v91, v91 row_bcast:15 row_mask:0xa bank_mask:0xf
    s_nop 1
    v_add_u32_dpp v91, v91, v91 row_bcast:31 row_mask:0xc bank_mask:0xf
    v_add_u32 v98, v98, v91
    v_readlane_b32 s37, v91, 63
    s_cbranch_vccnz L2_xo5
L2_xp5:
    s_waitcnt lgkmcnt(0)
    v_mov_b32 v21, v40
    v_mov_b32 v27, v41
    v_mov_b32 v33, v42
    v_mov_b32 v39, v43
    v_mov_b32 v44, v43
    s_cmp_gt_u32 s37, 1024
    s_cbranch_scc1 L2_xs6
    s_cmp_lg_u32 s101, 0
    s_cbranch_scc1 L2_xa6
L2_xb6:
    v_lshlrev_b32 v89, 16, v96
    v_add_u32 v90, 60, v97
    v_bitop3_b32 v90, v89, v45, v90 bitop3:0x6a
    ds_write_b32 v98, v90 offset:12
    v_lshlrev_b32 v89, 20, v96
    v_add_u32 v90, 40, v97
    v_bitop3_b32 v90, v89, v45, v90 bitop3:0x6a
    ds_write_b32 v98, v90 offset:8
    v_lshlrev_b32 v89, 24, v96
    v_add_u32 v90, 20, v97
    v_bitop3_b32 v90, v89, v45, v90 bitop3:0x6a
    ds_write_b32 v98, v90 offset:4
    v_lshlrev_b32 v89, 28, v96
    v_bitop3_b32 v90, v89, v45, v97 bitop3:0x6a
    ds_write_b32 v98, v90 offset:0
    v_mov_b32_dpp v91, v66 quad_perm:[0,0,0,0] row_mask:0xf bank_mask:0xf
    v_and_b32 v89, 3, v91
    v_and_b32 v97, 0xfffc, v91
    v_sub_u16_dpp v88, v66, v91 quad_perm:[2,2,2,2] row_mask:0xf bank_mask:0xf
    v_mad_u32_u24 v97, v97, 5, v4
    v_add_u32 v99, v88, v89
    v_bfm_b32 v96, v88, v89
    v_cmp_lt_u32 s[58:59], 16, v99
    v_lshlrev_b32 v89, v1, v96
    v_and_b32 v89, v45, v89
    v_cmp_ne_u32 vcc, 0, v89
    v_xor_b32 v90, v97, v89
    s_add_u32 s3, s37, s38
    v_mbcnt_lo_u32_b32 v98, vcc_lo, 0
    v_mbcnt_hi_u32_b32 v98, vcc_hi, v98
    s_bcnt1_i32_b64 s41, vcc
    v_lshl_add_u32 v98, v98, 2, s3
    s_mov_b64 exec, vcc
    ds_write_b32 v98, v90
    s_mov_b64 exec, -1
    s_lshl2_add_u32 s37, s41, s37
    s_cmp_lg_u64 s[58:59], 0
    s_cbranch_scc1 L2_xe6
L2_xr6:
    v_add_u32 v98, s37, v0
    v_mov_b32 v90, -1
    ds_write_b32 v98, v90
    ds_read2st64_b32 v[40:41], v0 offset0:0 offset1:1
    ds_read2st64_b32 v[42:43], v0 offset0:2 offset1:3
    s_sub_u32 s3, s37, 768
    s_cmp_gt_u32 s3, 256
    s_cbranch_scc1 L2_xf6
L2_xg6:
    v_subrev_u32 v88, s38, v3
    ds_write_b128 v88, v[124:127] offset:34816
    v_subrev_u32 v88, s38, v3
    ds_write_b128 v88, v[116:119] offset:32768
    v_subrev_u32 v88, s38, v3
    ds_write_b128 v88, v[120:123] offset:33792
    v_subrev_u32 v88, s100, v3
    ds_write_b128 v88, v[108:111] offset:0
    v_subrev_u32 v88, s100, v3
    ds_write_b128 v88, v[112:115] offset:1024
    s_cmp_eq_u32 s56, 0
    s_cbranch_scc1 L2_e2
    s_mov_b64 exec, 0xffff
    buffer_load_dword v88, v7, s[60:63], 0 offen sc1
    s_mov_b64 exec, -1
    s_waitcnt vmcnt(0)
    v_cmp_gt_u32 vcc, 2, v88
    s_and_b32 s56, vcc_lo, 0xffff
    s_cbranch_scc0 L2_e2
    s_mul_i32 s3, s33, 1280000
    s_add_u32 s3, s3, s100
    s_add_u32 s3, s3, 352768
    buffer_load_dwordx4 v[124:127], v94, s[24:27], s3 offen offset:2048
    s_mul_i32 s3, s33, 1280000
    s_add_u32 s3, s3, s100
    s_add_u32 s3, s3, 352768
    buffer_load_dwordx4 v[116:119], v94, s[24:27], s3 offen offset:0
    s_mul_i32 s3, s33, 1280000
    s_add_u32 s3, s3, s100
    s_add_u32 s3, s3, 352768
    buffer_load_dwordx4 v[120:123], v94, s[24:27], s3 offen offset:1024
    s_mul_i32 s3, s33, 1280000
    s_add_u32 s3, s3, s38
    s_add_u32 s3, s3, 320000
    buffer_load_dwordx4 v[108:111], v94, s[24:27], s3 offen offset:0
    s_mul_i32 s3, s33, 1280000
    s_add_u32 s3, s3, s38
    s_add_u32 s3, s3, 320000
    buffer_load_dwordx4 v[112:115], v94, s[24:27], s3 offen offset:1024
    s_mov_b64 exec, 0xffff
L2_p2:
    buffer_load_dword v88, v7, s[60:63], 0 offen sc1
    s_waitcnt vmcnt(0)
    v_cmp_gt_u32 vcc, 2, v88
    s_cbranch_vccnz L2_p2s
    s_mov_b64 exec, -1
L2_e2:
    v_and_b32 v47, 0x0fffffff, v21
    buffer_load_dwordx2 v[16:17], v47, s[8:11], 0 offen
    buffer_load_dwordx3 v[18:20], v47, s[8:11], 0 offen offset:8
    s_waitcnt lgkmcnt(0)
    s_barrier
    s_bitcmp1_b32 s36, s42
    s_cbranch_scc1 L2_slow
L2_ret0:
    s_setprio 3
    v_and_b32 v47, 0x0fffffff, v27
    buffer_load_dwordx2 v[22:23], v47, s[8:11], 0 offen
    buffer_load_dwordx3 v[24:26], v47, s[8:11], 0 offen offset:8
    s_waitcnt vmcnt(2)
    v_and_b32 v46, 0x20000000, v21
    v_lshrrev_b32 v47, 14, v17
    v_bitop3_b32 v47, v47, v5, v46 bitop3:0xea
    ds_read_b64 v[102:103], v47
    v_bitop3_b32 v93, v17, v5, v46 bitop3:0xea
    v_and_b32 v46, 0x10000000, v21
    v_lshrrev_b32 v47, 14, v16
    v_bitop3_b32 v47, v47, v5, v46 bitop3:0xea
    ds_read_b64 v[100:101], v47
    v_bitop3_b32 v92, v16, v5, v46 bitop3:0xea
    v_perm_b32 v15, v17, v20, s45
    v_bitop3_b32 v46, v17, 0.5, -0.5 bitop3:0xa8
    v_perm_b32 v14, v16, v20, s44
    v_bitop3_b32 v47, v16, 0.5, -0.5 bitop3:0xa8
    s_waitcnt lgkmcnt(0)
    v_mfma_f32_4x4x4_16b_bf16 v[80:83], v[8:9], v[102:103], 0
    v_mfma_f32_4x4x4_16b_bf16 v[76:79], v[8:9], v[100:101], 0
    v_bitop3_b32 v15, v6, v15, v46 bitop3:0xca
    v_bitop3_b32 v14, v6, v14, v47 bitop3:0xca
    v_cmp_lt_u32 s[84:85], v5, v92
    s_nop 0
    v_pk_mul_f32 v[80:81], v[80:81], v[14:15] op_sel:[0,1] op_sel_hi:[1,1]
    v_pk_mul_f32 v[82:83], v[82:83], v[14:15] op_sel:[0,1] op_sel_hi:[1,1]
    v_pk_mul_f32 v[76:77], v[76:77], v[14:15] op_sel:[0,0] op_sel_hi:[1,0]
    v_pk_mul_f32 v[78:79], v[78:79], v[14:15] op_sel:[0,0] op_sel_hi:[1,0]
    v_and_b32 v47, 0x0fffffff, v33
    buffer_load_dwordx2 v[28:29], v47, s[8:11], 0 offen
    buffer_load_dwordx3 v[30:32], v47, s[8:11], 0 offen offset:8
    v_cmpx_ne_u64 vcc, v[74:75], v[70:71]
    s_and_b64 s[82:83], vcc, s[80:81]
    s_cbranch_scc1 L2_c7
L2_d7:
    v_mov_b64 v[84:85], v[70:71]
    v_mov_b32 v7, v95
    v_mov_b64 v[86:87], v[74:75]
    s_mov_b64 exec, -1
    s_or_b64 s[80:81], s[80:81], vcc
    v_cmpx_ne_u64 vcc, v[72:73], v[68:69]
    s_and_b64 s[82:83], vcc, s[80:81]
    s_cbranch_scc1 L2_c8
L2_d8:
    v_mov_b64 v[84:85], v[68:69]
    v_mov_b32 v7, v94
    v_mov_b64 v[86:87], v[72:73]
    s_mov_b64 exec, -1
    s_or_b64 s[80:81], s[80:81], vcc
    ds_read_b64 v[70:71], v93 offset:65408
    s_and_b64 exec, s[84:85], s[80:81]
    v_mfma_f32_4x4x4_16b_bf16 v[76:79], v[12:13], v[84:85], 0
    v_mov_b32 v92, v7
    s_andn2_b64 s[80:81], s[80:81], s[84:85]
    v_mfma_f32_4x4x4_16b_bf16 v[76:79], v[10:11], v[86:87], v[76:79]
    s_mov_b64 exec, -1
    ds_read_b64 v[68:69], v92 offset:65408
    v_and_b32 v46, 0x80000000, v21
    v_lshrrev_b32 v47, 14, v19
    v_bitop3_b32 v47, v47, v5, v46 bitop3:0xea
    ds_read_b64 v[106:107], v47
    v_bitop3_b32 v95, v19, v5, v46 bitop3:0xea
    v_and_b32 v46, 0x40000000, v21
    v_lshrrev_b32 v47, 14, v18
    v_bitop3_b32 v47, v47, v5, v46 bitop3:0xea
    ds_read_b64 v[104:105], v47
    v_bitop3_b32 v94, v18, v5, v46 bitop3:0xea
    s_waitcnt lgkmcnt(2)
    v_mfma_f32_4x4x4_16b_bf16 v[80:83], v[10:11], v[70:71], v[80:83]
    v_mfma_f32_4x4x4_16b_bf16 v[76:79], v[10:11], v[68:69], v[76:79]
    v_perm_b32 v15, v19, v20, s47
    v_bitop3_b32 v46, v19, 0.5, -0.5 bitop3:0xa8
    v_perm_b32 v14, v18, v20, s46
    v_bitop3_b32 v47, v18, 0.5, -0.5 bitop3:0xa8
    v_cvt_pk_bf16_f32 v80, v80, v81
    v_cvt_pk_bf16_f32 v81, v82, v83
    ds_wrxchg_rtn_b64 v[74:75], v93, v[80:81] offset:65408
    v_cvt_pk_bf16_f32 v76, v76, v77
    v_cvt_pk_bf16_f32 v77, v78, v79
    ds_wrxchg_rtn_b64 v[72:73], v92, v[76:77] offset:65408
    s_setprio 2
    s_waitcnt lgkmcnt(2)
    v_mfma_f32_4x4x4_16b_bf16 v[80:83], v[8:9], v[106:107], 0
    v_mfma_f32_4x4x4_16b_bf16 v[76:79], v[8:9], v[104:105], 0
    v_bitop3_b32 v15, v6, v15, v46 bitop3:0xca
    v_bitop3_b32 v14, v6, v14, v47 bitop3:0xca
    s_nop 1
    v_pk_mul_f32 v[80:81], v[80:81], v[14:15] op_sel:[0,1] op_sel_hi:[1,1]
    v_pk_mul_f32 v[82:83], v[82:83], v[14:15] op_sel:[0,1] op_sel_hi:[1,1]
    v_pk_mul_f32 v[76:77], v[76:77], v[14:15] op_sel:[0,0] op_sel_hi:[1,0]
    v_pk_mul_f32 v[78:79], v[78:79], v[14:15] op_sel:[0,0] op_sel_hi:[1,0]
    v_and_b32 v47, 0x3f0, v3
    s_cmp_lg_u32 s56, 0
    s_cbranch_scc1 L2_m9
    s_mul_i32 s3, s33, 1280000
    s_add_u32 s3, s3, s100
    s_add_u32 s3, s3, 352768
    buffer_load_dwordx4 v[124:127], v47, s[24:27], s3 offen offset:2048
L2_m9:
    v_and_b32 v47, 0x3f0, v3
    s_cmp_lg_u32 s56, 0
    s_cbranch_scc1 L2_m10
    s_mul_i32 s3, s33, 1280000
    s_add_u32 s3, s3, s100
    s_add_u32 s3, s3, 352768
    buffer_load_dwordx4 v[116:119], v47, s[24:27], s3 offen offset:0
L2_m10:
    s_waitcnt lgkmcnt(0)
    v_cmpx_ne_u64 vcc, v[74:75], v[70:71]
    s_and_b64 s[82:83], vcc, s[80:81]
    s_cbranch_scc1 L2_c11
L2_d11:
    v_mov_b64 v[84:85], v[70:71]
    v_mov_b32 v7, v93
    v_mov_b64 v[86:87], v[74:75]
    s_mov_b64 exec, -1
    s_or_b64 s[80:81], s[80:81], vcc
    v_cmpx_ne_u64 vcc, v[72:73], v[68:69]
    s_and_b64 s[82:83], vcc, s[80:81]
    s_cbranch_scc1 L2_c12
L2_d12:
    v_mov_b64 v[84:85], v[68:69]
    v_mov_b32 v7, v92
    v_mov_b64 v[86:87], v[72:73]
    s_mov_b64 exec, -1
    s_or_b64 s[80:81], s[80:81], vcc
    ds_read_b64 v[70:71], v95 offset:65408
    ds_read_b64 v[68:69], v94 offset:65408
    s_waitcnt vmcnt(2)
    v_and_b32 v46, 0x20000000, v27
    v_lshrrev_b32 v47, 14, v23
    v_bitop3_b32 v47, v47, v5, v46 bitop3:0xea
    ds_read_b64 v[102:103], v47
    v_bitop3_b32 v93, v23, v5, v46 bitop3:0xea
    v_and_b32 v46, 0x10000000, v27
    v_lshrrev_b32 v47, 14, v22
    v_bitop3_b32 v47, v47, v5, v46 bitop3:0xea
    ds_read_b64 v[100:101], v47
    v_bitop3_b32 v92, v22, v5, v46 bitop3:0xea
    s_waitcnt lgkmcnt(2)
    v_mfma_f32_4x4x4_16b_bf16 v[80:83], v[10:11], v[70:71], v[80:83]
    v_mfma_f32_4x4x4_16b_bf16 v[76:79], v[10:11], v[68:69], v[76:79]
    v_perm_b32 v15, v23, v26, s45
    v_bitop3_b32 v46, v23, 0.5, -0.5 bitop3:0xa8
    v_perm_b32 v14, v22, v26, s44
    v_bitop3_b32 v47, v22, 0.5, -0.5 bitop3:0xa8
    v_cvt_pk_bf16_f32 v80, v80, v81
    v_cvt_pk_bf16_f32 v81, v82, v83
    ds_wrxchg_rtn_b64 v[74:75], v95, v[80:81] offset:65408
    v_cvt_pk_bf16_f32 v76, v76, v77
    v_cvt_pk_bf16_f32 v77, v78, v79
    ds_wrxchg_rtn_b64 v[72:73], v94, v[76:77] offset:65408
    s_waitcnt lgkmcnt(2)
    v_mfma_f32_4x4x4_16b_bf16 v[80:83], v[8:9], v[102:103], 0
    v_mfma_f32_4x4x4_16b_bf16 v[76:79], v[8:9], v[100:101], 0
    v_bitop3_b32 v15, v6, v15, v46 bitop3:0xca
    v_bitop3_b32 v14, v6, v14, v47 bitop3:0xca
    v_cmp_lt_u32 s[84:85], v5, v92
    s_nop 0
    v_pk_mul_f32 v[80:81], v[80:81], v[14:15] op_sel:[0,1] op_sel_hi:[1,1]
    v_pk_mul_f32 v[82:83], v[82:83], v[14:15] op_sel:[0,1] op_sel_hi:[1,1]
    v_pk_mul_f32 v[76:77], v[76:77], v[14:15] op_sel:[0,0] op_sel_hi:[1,0]
    v_pk_mul_f32 v[78:79], v[78:79], v[14:15] op_sel:[0,0] op_sel_hi:[1,0]
    v_sub_u16 v88, v60, v52
    v_and_b32 v89, 3, v52
    v_add3_u32 v99, v88, v89, 3
    v_and_b32 v99, -4, v99
    v_max_u32 v99, 4, v99
    v_and_b32 v97, 0xfffc, v52
    v_bfm_b32 v96, v88, v89
    v_add_u32_dpp v91, v99, v99 row_shr:1 row_mask:0xf bank_mask:0xf bound_ctrl:1
    v_mad_u32_u24 v97, v97, 5, v2
    v_cmp_lt_u32 vcc, 16, v99
    v_add_u32_dpp v91, v91, v91 row_shr:2 row_mask:0xf bank_mask:0xf bound_ctrl:1
    v_sub_u32 v98, s38, v99
    v_lshrrev_b64 v[52:53], 16, v[52:53]
    v_add_u32_dpp v91, v91, v91 row_shr:4 row_mask:0xf bank_mask:0xf bound_ctrl:1
    v_lshrrev_b64 v[60:61], 16, v[60:61]
    s_mov_b32 s101, 0
    v_add_u32_dpp v91, v91, v91 row_shr:8 row_mask:0xf bank_mask:0xf bound_ctrl:1
    s_nop 1
    v_add_u32_dpp v91, v91, v91 row_bcast:15 row_mask:0xa bank_mask:0xf
    s_nop 1
    v_add_u32_dpp v91, v91, v91 row_bcast:31 row_mask:0xc bank_mask:0xf
    v_add_u32 v98, v98, v91
    v_readlane_b32 s37, v91, 63
    s_cbranch_vccnz L2_xo13
L2_xp13:
    v_and_b32 v47, 0x0fffffff, v39
    buffer_load_dwordx2 v[34:35], v47, s[8:11], 0 offen
    buffer_load_dwordx3 v[36:38], v47, s[8:11], 0 offen offset:8
    v_and_b32 v47, 0x3f0, v3
    s_cmp_lg_u32 s56, 0
    s_cbranch_scc1 L2_m14
    s_mul_i32 s3, s33, 1280000
    s_add_u32 s3, s3, s100
    s_add_u32 s3, s3, 352768
    buffer_load_dwordx4 v[120:123], v47, s[24:27], s3 offen offset:1024
L2_m14:
    s_waitcnt lgkmcnt(0)
    v_cmpx_ne_u64 vcc, v[74:75], v[70:71]
    s_and_b64 s[82:83], vcc, s[80:81]
    s_cbranch_scc1 L2_c15
L2_d15:
    v_mov_b64 v[84:85], v[70:71]
    v_mov_b32 v7, v95
    v_mov_b64 v[86:87], v[74:75]
    s_mov_b64 exec, -1
    s_or_b64 s[80:81], s[80:81], vcc
    v_cmpx_ne_u64 vcc, v[72:73], v[68:69]
    s_and_b64 s[82:83], vcc, s[80:81]
    s_cbranch_scc1 L2_c16
L2_d16:
    v_mov_b64 v[84:85], v[68:69]
    v_mov_b32 v7, v94
    v_mov_b64 v[86:87], v[72:73]
    s_mov_b64 exec, -1
    s_or_b64 s[80:81], s[80:81], vcc
    ds_read_b64 v[70:71], v93 offset:65408
    s_and_b64 exec, s[84:85], s[80:81]
    v_mfma_f32_4x4x4_16b_bf16 v[76:79], v[12:13], v[84:85], 0
    v_mov_b32 v92, v7
    s_andn2_b64 s[80:81], s[80:81], s[84:85]
    v_mfma_f32_4x4x4_16b_bf16 v[76:79], v[10:11], v[86:87], v[76:79]
    s_mov_b64 exec, -1
    ds_read_b64 v[68:69], v92 offset:65408
    v_and_b32 v46, 0x80000000, v27
    v_lshrrev_b32 v47, 14, v25
    v_bitop3_b32 v47, v47, v5, v46 bitop3:0xea
    ds_read_b64 v[106:107], v47
    v_bitop3_b32 v95, v25, v5, v46 bitop3:0xea
    v_and_b32 v46, 0x40000000, v27
    v_lshrrev_b32 v47, 14, v24
    v_bitop3_b32 v47, v47, v5, v46 bitop3:0xea
    ds_read_b64 v[104:105], v47
    v_bitop3_b32 v94, v24, v5, v46 bitop3:0xea
    s_waitcnt lgkmcnt(2)
    v_mfma_f32_4x4x4_16b_bf16 v[80:83], v[10:11], v[70:71], v[80:83]
    v_mfma_f32_4x4x4_16b_bf16 v[76:79], v[10:11], v[68:69], v[76:79]
    v_perm_b32 v15, v25, v26, s47
    v_bitop3_b32 v46, v25, 0.5, -0.5 bitop3:0xa8
    v_perm_b32 v14, v24, v26, s46
    v_bitop3_b32 v47, v24, 0.5, -0.5 bitop3:0xa8
    v_cvt_pk_bf16_f32 v80, v80, v81
    v_cvt_pk_bf16_f32 v81, v82, v83
    ds_wrxchg_rtn_b64 v[74:75], v93, v[80:81] offset:65408
    v_cvt_pk_bf16_f32 v76, v76, v77
    v_cvt_pk_bf16_f32 v77, v78, v79
    ds_wrxchg_rtn_b64 v[72:73], v92, v[76:77] offset:65408
    s_setprio 1
    s_waitcnt lgkmcnt(2)
    v_mfma_f32_4x4x4_16b_bf16 v[80:83], v[8:9], v[106:107], 0
    v_mfma_f32_4x4x4_16b_bf16 v[76:79], v[8:9], v[104:105], 0
    v_bitop3_b32 v15, v6, v15, v46 bitop3:0xca
    v_bitop3_b32 v14, v6, v14, v47 bitop3:0xca
    s_nop 1
    v_pk_mul_f32 v[80:81], v[80:81], v[14:15] op_sel:[0,1] op_sel_hi:[1,1]
    v_pk_mul_f32 v[82:83], v[82:83], v[14:15] op_sel:[0,1] op_sel_hi:[1,1]
    v_pk_mul_f32 v[76:77], v[76:77], v[14:15] op_sel:[0,0] op_sel_hi:[1,0]
    v_pk_mul_f32 v[78:79], v[78:79], v[14:15] op_sel:[0,0] op_sel_hi:[1,0]
    v_and_b32 v47, 0x3f0, v3
    s_cmp_lg_u32 s56, 0
    s_cbranch_scc1 L2_m17
    s_mul_i32 s3, s33, 1280000
    s_add_u32 s3, s3, s38
    s_add_u32 s3, s3, 320000
    buffer_load_dwordx4 v[108:111], v47, s[24:27], s3 offen offset:0
L2_m17:
    v_and_b32 v47, 0x3f0, v3
    s_cmp_lg_u32 s56, 0
    s_cbranch_scc1 L2_m18
    s_mul_i32 s3, s33, 1280000
    s_add_u32 s3, s3, s38
    s_add_u32 s3, s3, 320000
    buffer_load_dwordx4 v[112:115], v47, s[24:27], s3 offen offset:1024
L2_m18:
    v_and_b32 v47, 0x0fffffff, v40
    v_mov_b32 v21, v40
    buffer_load_dwordx2 v[16:17], v47, s[8:11], 0 offen
    buffer_load_dwordx3 v[18:20], v47, s[8:11], 0 offen offset:8
    s_waitcnt lgkmcnt(0)
    v_cmpx_ne_u64 vcc, v[74:75], v[70:71]
    s_and_b64 s[82:83], vcc, s[80:81]
    s_cbranch_scc1 L2_c19
L2_d19:
    v_mov_b64 v[84:85], v[70:71]
    v_mov_b32 v7, v93
    v_mov_b64 v[86:87], v[74:75]
    s_mov_b64 exec, -1
    s_or_b64 s[80:81], s[80:81], vcc
    v_cmpx_ne_u64 vcc, v[72:73], v[68:69]
    s_and_b64 s[82:83], vcc, s[80:81]
    s_cbranch_scc1 L2_c20
L2_d20:
    v_mov_b64 v[84:85], v[68:69]
    v_mov_b32 v7, v92
    v_mov_b64 v[86:87], v[72:73]
    s_mov_b64 exec, -1
    s_or_b64 s[80:81], s[80:81], vcc
    ds_read_b64 v[70:71], v95 offset:65408
    ds_read_b64 v[68:69], v94 offset:65408
    s_waitcnt vmcnt(4)
    v_and_b32 v46, 0x20000000, v33
    v_lshrrev_b32 v47, 14, v29
    v_bitop3_b32 v47, v47, v5, v46 bitop3:0xea
    ds_read_b64 v[102:103], v47
    v_bitop3_b32 v93, v29, v5, v46 bitop3:0xea
    v_and_b32 v46, 0x10000000, v33
    v_lshrrev_b32 v47, 14, v28
    v_bitop3_b32 v47, v47, v5, v46 bitop3:0xea
    ds_read_b64 v[100:101], v47
    v_bitop3_b32 v92, v28, v5, v46 bitop3:0xea
    s_waitcnt lgkmcnt(2)
    v_mfma_f32_4x4x4_16b_bf16 v[80:83], v[10:11], v[70:71], v[80:83]
    v_mfma_f32_4x4x4_16b_bf16 v[76:79], v[10:11], v[68:69], v[76:79]
    v_perm_b32 v15, v29, v32, s45
    v_bitop3_b32 v46, v29, 0.5, -0.5 bitop3:0xa8
    v_perm_b32 v14, v28, v32, s44
    v_bitop3_b32 v47, v28, 0.5, -0.5 bitop3:0xa8
    v_cvt_pk_bf16_f32 v80, v80, v81
    v_cvt_pk_bf16_f32 v81, v82, v83
    ds_wrxchg_rtn_b64 v[74:75], v95, v[80:81] offset:65408
    v_cvt_pk_bf16_f32 v76, v76, v77
    v_cvt_pk_bf16_f32 v77, v78, v79
    ds_wrxchg_rtn_b64 v[72:73], v94, v[76:77] offset:65408
    s_waitcnt lgkmcnt(2)
    v_mfma_f32_4x4x4_16b_bf16 v[80:83], v[8:9], v[102:103], 0
    v_mfma_f32_4x4x4_16b_bf16 v[76:79], v[8:9], v[100:101], 0
    v_bitop3_b32 v15, v6, v15, v46 bitop3:0xca
    v_bitop3_b32 v14, v6, v14, v47 bitop3:0xca
    v_cmp_lt_u32 s[84:85], v5, v92
    s_nop 0
    v_pk_mul_f32 v[80:81], v[80:81], v[14:15] op_sel:[0,1] op_sel_hi:[1,1]
    v_pk_mul_f32 v[82:83], v[82:83], v[14:15] op_sel:[0,1] op_sel_hi:[1,1]
    v_pk_mul_f32 v[76:77], v[76:77], v[14:15] op_sel:[0,0] op_sel_hi:[1,0]
    v_pk_mul_f32 v[78:79], v[78:79], v[14:15] op_sel:[0,0] op_sel_hi:[1,0]
    s_waitcnt lgkmcnt(0)
    v_cmpx_ne_u64 vcc, v[74:75], v[70:71]
    s_and_b64 s[82:83], vcc, s[80:81]
    s_cbranch_scc1 L2_c21
L2_d21:
    v_mov_b64 v[84:85], v[70:71]
    v_mov_b32 v7, v95
    v_mov_b64 v[86:87], v[74:75]
    s_mov_b64 exec, -1
    s_or_b64 s[80:81], s[80:81], vcc
    v_cmpx_ne_u64 vcc, v[72:73], v[68:69]
    s_and_b64 s[82:83], vcc, s[80:81]
    s_cbranch_scc1 L2_c22
L2_d22:
    v_mov_b64 v[84:85], v[68:69]
    v_mov_b32 v7, v94
    v_mov_b64 v[86:87], v[72:73]
    s_mov_b64 exec, -1
    s_or_b64 s[80:81], s[80:81], vcc
    ds_read_b64 v[70:71], v93 offset:65408
    s_and_b64 exec, s[84:85], s[80:81]
    v_mfma_f32_4x4x4_16b_bf16 v[76:79], v[12:13], v[84:85], 0
    v_mov_b32 v92, v7
    s_andn2_b64 s[80:81], s[80:81], s[84:85]
    v_mfma_f32_4x4x4_16b_bf16 v[76:79], v[10:11], v[86:87], v[76:79]
    s_mov_b64 exec, -1
    ds_read_b64 v[68:69], v92 offset:65408
    v_and_b32 v46, 0x80000000, v33
    v_lshrrev_b32 v47, 14, v31
    v_bitop3_b32 v47, v47, v5, v46 bitop3:0xea
    ds_read_b64 v[106:107], v47
    v_bitop3_b32 v95, v31, v5, v46 bitop3:0xea
    v_and_b32 v46, 0x40000000, v33
    v_lshrrev_b32 v47, 14, v30
    v_bitop3_b32 v47, v47, v5, v46 bitop3:0xea
    ds_read_b64 v[104:105], v47
    v_bitop3_b32 v94, v30, v5, v46 bitop3:0xea
    s_waitcnt lgkmcnt(2)
    v_mfma_f32_4x4x4_16b_bf16 v[80:83], v[10:11], v[70:71], v[80:83]
    v_mfma_f32_4x4x4_16b_bf16 v[76:79], v[10:11], v[68:69], v[76:79]
    v_perm_b32 v15, v31, v32, s47
    v_bitop3_b32 v46, v31, 0.5, -0.5 bitop3:0xa8
    v_perm_b32 v14, v30, v32, s46
    v_bitop3_b32 v47, v30, 0.5, -0.5 bitop3:0xa8
    v_cvt_pk_bf16_f32 v80, v80, v81
    v_cvt_pk_bf16_f32 v81, v82, v83
    ds_wrxchg_rtn_b64 v[74:75], v93, v[80:81] offset:65408
    v_cvt_pk_bf16_f32 v76, v76, v77
    v_cvt_pk_bf16_f32 v77, v78, v79
    ds_wrxchg_rtn_b64 v[72:73], v92, v[76:77] offset:65408
    s_setprio 0
    s_waitcnt lgkmcnt(2)
    v_mfma_f32_4x4x4_16b_bf16 v[80:83], v[8:9], v[106:107], 0
    v_mfma_f32_4x4x4_16b_bf16 v[76:79], v[8:9], v[104:105], 0
    v_bitop3_b32 v15, v6, v15, v46 bitop3:0xca
    v_bitop3_b32 v14, v6, v14, v47 bitop3:0xca
    s_nop 1
    v_pk_mul_f32 v[80:81], v[80:81], v[14:15] op_sel:[0,1] op_sel_hi:[1,1]
    v_pk_mul_f32 v[82:83], v[82:83], v[14:15] op_sel:[0,1] op_sel_hi:[1,1]
    v_pk_mul_f32 v[76:77], v[76:77], v[14:15] op_sel:[0,0] op_sel_hi:[1,0]
    v_pk_mul_f32 v[78:79], v[78:79], v[14:15] op_sel:[0,0] op_sel_hi:[1,0]
    s_add_u32 s40, s40, 0x50000
    v_and_b32 v47, 0x0fffffff, v41
    v_mov_b32 v27, v41
    buffer_load_dwordx2 v[22:23], v47, s[8:11], 0 offen
    buffer_load_dwordx3 v[24:26], v47, s[8:11], 0 offen offset:8
    s_waitcnt lgkmcnt(0)
    v_cmpx_ne_u64 vcc, v[74:75], v[70:71]
    s_and_b64 s[82:83], vcc, s[80:81]
    s_cbranch_scc1 L2_c23
L2_d23:
    v_mov_b64 v[84:85], v[70:71]
    v_mov_b32 v7, v93
    v_mov_b64 v[86:87], v[74:75]
    s_mov_b64 exec, -1
    s_or_b64 s[80:81], s[80:81], vcc
    v_cmpx_ne_u64 vcc, v[72:73], v[68:69]
    s_and_b64 s[82:83], vcc, s[80:81]
    s_cbranch_scc1 L2_c24
L2_d24:
    v_mov_b64 v[84:85], v[68:69]
    v_mov_b32 v7, v92
    v_mov_b64 v[86:87], v[72:73]
    s_mov_b64 exec, -1
    s_or_b64 s[80:81], s[80:81], vcc
    ds_read_b64 v[70:71], v95 offset:65408
    ds_read_b64 v[68:69], v94 offset:65408
    s_waitcnt vmcnt(4)
    v_and_b32 v46, 0x20000000, v39
    v_lshrrev_b32 v47, 14, v35
    v_bitop3_b32 v47, v47, v5, v46 bitop3:0xea
    ds_read_b64 v[102:103], v47
    v_bitop3_b32 v93, v35, v5, v46 bitop3:0xea
    v_and_b32 v46, 0x10000000, v39
    v_lshrrev_b32 v47, 14, v34
    v_bitop3_b32 v47, v47, v5, v46 bitop3:0xea
    ds_read_b64 v[100:101], v47
    v_bitop3_b32 v92, v34, v5, v46 bitop3:0xea
    v_and_b32 v46, 0x80000000, v39
    v_lshrrev_b32 v47, 14, v37
    v_bitop3_b32 v47, v47, v5, v46 bitop3:0xea
    ds_read_b64 v[106:107], v47
    v_and_b32 v46, 0x40000000, v39
    v_lshrrev_b32 v47, 14, v36
    v_bitop3_b32 v47, v47, v5, v46 bitop3:0xea
    ds_read_b64 v[104:105], v47
    s_waitcnt lgkmcnt(4)
    v_mfma_f32_4x4x4_16b_bf16 v[80:83], v[10:11], v[70:71], v[80:83]
    v_mfma_f32_4x4x4_16b_bf16 v[76:79], v[10:11], v[68:69], v[76:79]
    v_perm_b32 v15, v35, v38, s45
    v_bitop3_b32 v46, v35, 0.5, -0.5 bitop3:0xa8
    v_perm_b32 v14, v34, v38, s44
    v_bitop3_b32 v47, v34, 0.5, -0.5 bitop3:0xa8
    v_cvt_pk_bf16_f32 v80, v80, v81
    v_cvt_pk_bf16_f32 v81, v82, v83
    ds_wrxchg_rtn_b64 v[74:75], v95, v[80:81] offset:65408
    v_cvt_pk_bf16_f32 v76, v76, v77
    v_cvt_pk_bf16_f32 v77, v78, v79
    ds_wrxchg_rtn_b64 v[72:73], v94, v[76:77] offset:65408
    s_waitcnt lgkmcnt(2)
    s_barrier
    s_setprio 3
    s_waitcnt vmcnt(6)
    v_subrev_u32 v88, s38, v3
    ds_write_b128 v88, v[116:119] offset:32768
    buffer_load_dwordx4 v[116:119], v3, s[16:19], s40 offen offset:2048
    s_waitcnt vmcnt(5)
    v_subrev_u32 v88, s38, v3
    ds_write_b128 v88, v[120:123] offset:33792
    buffer_load_dwordx4 v[120:123], v3, s[16:19], s40 offen offset:3072
    v_mfma_f32_4x4x4_16b_bf16 v[80:83], v[8:9], v[102:103], 0
    v_mfma_f32_4x4x4_16b_bf16 v[76:79], v[8:9], v[100:101], 0
    v_bitop3_b32 v15, v6, v15, v46 bitop3:0xca
    v_bitop3_b32 v14, v6, v14, v47 bitop3:0xca
    v_cmp_lt_u32 s[84:85], v5, v92
    s_nop 0
    v_pk_mul_f32 v[80:81], v[80:81], v[14:15] op_sel:[0,1] op_sel_hi:[1,1]
    v_pk_mul_f32 v[82:83], v[82:83], v[14:15] op_sel:[0,1] op_sel_hi:[1,1]
    v_pk_mul_f32 v[76:77], v[76:77], v[14:15] op_sel:[0,0] op_sel_hi:[1,0]
    v_pk_mul_f32 v[78:79], v[78:79], v[14:15] op_sel:[0,0] op_sel_hi:[1,0]
    v_and_b32 v47, 0x0fffffff, v42
    v_mov_b32 v33, v42
    buffer_load_dwordx2 v[28:29], v47, s[8:11], 0 offen
    buffer_load_dwordx3 v[30:32], v47, s[8:11], 0 offen offset:8
    v_mov_b32 v44, v43
    s_cmp_gt_u32 s37, 1024
    s_cbranch_scc1 L2_xs25
    s_cmp_lg_u32 s101, 0
    s_cbranch_scc1 L2_xa25
L2_xb25:
    v_lshlrev_b32 v89, 16, v96
    v_add_u32 v90, 60, v97
    v_bitop3_b32 v90, v89, v45, v90 bitop3:0x6a
    ds_write_b32 v98, v90 offset:12
    v_lshlrev_b32 v89, 20, v96
    v_add_u32 v90, 40, v97
    v_bitop3_b32 v90, v89, v45, v90 bitop3:0x6a
    ds_write_b32 v98, v90 offset:8
    v_lshlrev_b32 v89, 24, v96
    v_add_u32 v90, 20, v97
    v_bitop3_b32 v90, v89, v45, v90 bitop3:0x6a
    ds_write_b32 v98, v90 offset:4
    v_lshlrev_b32 v89, 28, v96
    v_bitop3_b32 v90, v89, v45, v97 bitop3:0x6a
    ds_write_b32 v98, v90 offset:0
    v_mov_b32_dpp v91, v64 quad_perm:[1,1,1,1] row_mask:0xf bank_mask:0xf
    v_and_b32 v89, 3, v91
    v_and_b32 v97, 0xfffc, v91
    v_sub_u16_dpp v88, v64, v91 quad_perm:[3,3,3,3] row_mask:0xf bank_mask:0xf
    v_mad_u32_u24 v97, v97, 5, v4
    v_add_u32 v99, v88, v89
    v_bfm_b32 v96, v88, v89
    v_cmp_lt_u32 s[58:59], 16, v99
    v_lshlrev_b32 v89, v1, v96
    v_and_b32 v89, v45, v89
    v_cmp_ne_u32 vcc, 0, v89
    v_xor_b32 v90, v97, v89
    s_add_u32 s3, s37, s38
    v_mbcnt_lo_u32_b32 v98, vcc_lo, 0
    v_mbcnt_hi_u32_b32 v98, vcc_hi, v98
    s_bcnt1_i32_b64 s41, vcc
    v_lshl_add_u32 v98, v98, 2, s3
    s_mov_b64 exec, vcc
    ds_write_b32 v98, v90
    s_mov_b64 exec, -1
    s_lshl2_add_u32 s37, s41, s37
    s_cmp_lg_u64 s[58:59], 0
    s_cbranch_scc1 L2_xe25
L2_xr25:
    v_add_u32 v98, s37, v0
    v_mov_b32 v90, -1
    ds_write_b32 v98, v90
    ds_read2st64_b32 v[40:41], v0 offset0:0 offset1:1
    ds_read2st64_b32 v[42:43], v0 offset0:2 offset1:3
    s_sub_u32 s3, s37, 768
    s_cmp_gt_u32 s3, 256
    s_cbranch_scc1 L2_xf25
L2_xg25:
    s_setprio 2
    s_waitcnt vmcnt(10)
    v_subrev_u32 v88, s38, v3
    ds_write_b128 v88, v[124:127] offset:34816
    s_add_u32 s3, s40, 4096
    buffer_load_dwordx4 v[124:127], v3, s[16:19], s3 offen
    s_waitcnt lgkmcnt(11)
    v_cmpx_ne_u64 vcc, v[74:75], v[70:71]
    s_and_b64 s[82:83], vcc, s[80:81]
    s_cbranch_scc1 L2_c26
L2_d26:
    v_mov_b64 v[84:85], v[70:71]
    v_mov_b32 v7, v95
    v_mov_b64 v[86:87], v[74:75]
    s_mov_b64 exec, -1
    s_or_b64 s[80:81], s[80:81], vcc
    v_cmpx_ne_u64 vcc, v[72:73], v[68:69]
    s_and_b64 s[82:83], vcc, s[80:81]
    s_cbranch_scc1 L2_c27
L2_d27:
    v_mov_b64 v[84:85], v[68:69]
    v_mov_b32 v7, v94
    v_mov_b64 v[86:87], v[72:73]
    s_mov_b64 exec, -1
    s_or_b64 s[80:81], s[80:81], vcc
    ds_read_b64 v[70:71], v93 offset:65408
    s_and_b64 exec, s[84:85], s[80:81]
    v_mfma_f32_4x4x4_16b_bf16 v[76:79], v[12:13], v[84:85], 0
    v_mov_b32 v92, v7
    s_andn2_b64 s[80:81], s[80:81], s[84:85]
    v_mfma_f32_4x4x4_16b_bf16 v[76:79], v[10:11], v[86:87], v[76:79]
    s_mov_b64 exec, -1
    ds_read_b64 v[68:69], v92 offset:65408
    s_setprio 1
    s_waitcnt vmcnt(9)
    v_subrev_u32 v88, s100, v3
    ds_write_b128 v88, v[108:111] offset:0
    s_waitcnt lgkmcnt(1)
    v_mfma_f32_4x4x4_16b_bf16 v[80:83], v[10:11], v[70:71], v[80:83]
    v_mfma_f32_4x4x4_16b_bf16 v[76:79], v[10:11], v[68:69], v[76:79]
    v_and_b32 v46, 0x40000000, v39
    v_bitop3_b32 v94, v36, v5, v46 bitop3:0xea
    v_and_b32 v46, 0x80000000, v39
    v_bitop3_b32 v95, v37, v5, v46 bitop3:0xea
    v_perm_b32 v15, v37, v38, s47
    v_bitop3_b32 v46, v37, 0.5, -0.5 bitop3:0xa8
    v_perm_b32 v14, v36, v38, s46
    v_bitop3_b32 v47, v36, 0.5, -0.5 bitop3:0xa8
    v_cvt_pk_bf16_f32 v80, v80, v81
    v_cvt_pk_bf16_f32 v81, v82, v83
    ds_wrxchg_rtn_b64 v[74:75], v93, v[80:81] offset:65408
    v_cvt_pk_bf16_f32 v76, v76, v77
    v_cvt_pk_bf16_f32 v77, v78, v79
    ds_wrxchg_rtn_b64 v[72:73], v92, v[76:77] offset:65408
    s_setprio 0
    s_waitcnt vmcnt(9)
    v_subrev_u32 v88, s100, v3
    ds_write_b128 v88, v[112:115] offset:1024
    v_mfma_f32_4x4x4_16b_bf16 v[80:83], v[8:9], v[106:107], 0
    v_mfma_f32_4x4x4_16b_bf16 v[76:79], v[8:9], v[104:105], 0
    v_bitop3_b32 v15, v6, v15, v46 bitop3:0xca
    v_bitop3_b32 v14, v6, v14, v47 bitop3:0xca
    s_nop 1
    v_pk_mul_f32 v[80:81], v[80:81], v[14:15] op_sel:[0,1] op_sel_hi:[1,1]
    v_pk_mul_f32 v[82:83], v[82:83], v[14:15] op_sel:[0,1] op_sel_hi:[1,1]
    v_pk_mul_f32 v[76:77], v[76:77], v[14:15] op_sel:[0,0] op_sel_hi:[1,0]
    v_pk_mul_f32 v[78:79], v[78:79], v[14:15] op_sel:[0,0] op_sel_hi:[1,0]
    s_add_u32 s42, s42, 1
    s_waitcnt lgkmcnt(0)
    s_add_u32 s24, s30, 0xebc9000
    s_addc_u32 s25, s31, 0
    s_mov_b32 s26, 0x100
    s_mov_b32 s27, 0x20000
    s_barrier
    s_bitcmp1_b32 s36, s42
    s_cbranch_scc1 L2_slow
L2_ret1:
    s_setprio 3
    v_and_b32 v47, 0x0fffffff, v44
    v_mov_b32 v39, v44
    buffer_load_dwordx2 v[34:35], v47, s[8:11], 0 offen
    buffer_load_dwordx3 v[36:38], v47, s[8:11], 0 offen offset:8
    v_cmpx_ne_u64 vcc, v[74:75], v[70:71]
    s_and_b64 s[82:83], vcc, s[80:81]
    s_cbranch_scc1 L2_c28
L2_d28:
    v_mov_b64 v[84:85], v[70:71]
    v_mov_b32 v7, v93
    v_mov_b64 v[86:87], v[74:75]
    s_mov_b64 exec, -1
    s_or_b64 s[80:81], s[80:81], vcc
    v_cmpx_ne_u64 vcc, v[72:73], v[68:69]
    s_and_b64 s[82:83], vcc, s[80:81]
    s_cbranch_scc1 L2_c29
L2_d29:
    v_mov_b64 v[84:85], v[68:69]
    v_mov_b32 v7, v92
    v_mov_b64 v[86:87], v[72:73]
    s_mov_b64 exec, -1
    s_or_b64 s[80:81], s[80:81], vcc
    ds_read_b64 v[70:71], v95 offset:65408
    ds_read_b64 v[68:69], v94 offset:65408
    s_waitcnt vmcnt(9)
    v_and_b32 v46, 0x20000000, v21
    v_lshrrev_b32 v47, 14, v17
    v_bitop3_b32 v47, v47, v5, v46 bitop3:0xea
    ds_read_b64 v[102:103], v47
    v_bitop3_b32 v93, v17, v5, v46 bitop3:0xea
    v_and_b32 v46, 0x10000000, v21
    v_lshrrev_b32 v47, 14, v16
    v_bitop3_b32 v47, v47, v5, v46 bitop3:0xea
    ds_read_b64 v[100:101], v47
    v_bitop3_b32 v92, v16, v5, v46 bitop3:0xea
    s_waitcnt lgkmcnt(2)
    v_mfma_f32_4x4x4_16b_bf16 v[80:83], v[10:11], v[70:71], v[80:83]
    v_mfma_f32_4x4x4_16b_bf16 v[76:79], v[10:11], v[68:69], v[76:79]
    v_perm_b32 v15, v17, v20, s45
    v_bitop3_b32 v46, v17, 0.5, -0.5 bitop3:0xa8
    v_perm_b32 v14, v16, v20, s44
    v_bitop3_b32 v47, v16, 0.5, -0.5 bitop3:0xa8
    v_cvt_pk_bf16_f32 v80, v80, v81
    v_cvt_pk_bf16_f32 v81, v82, v83
    ds_wrxchg_rtn_b64 v[74:75], v95, v[80:81] offset:65408
    v_cvt_pk_bf16_f32 v76, v76, v77
    v_cvt_pk_bf16_f32 v77, v78, v79
    ds_wrxchg_rtn_b64 v[72:73], v94, v[76:77] offset:65408
    s_waitcnt lgkmcnt(2)
    v_mfma_f32_4x4x4_16b_bf16 v[80:83], v[8:9], v[102:103], 0
    v_mfma_f32_4x4x4_16b_bf16 v[76:79], v[8:9], v[100:101], 0
    v_bitop3_b32 v15, v6, v15, v46 bitop3:0xca
    v_bitop3_b32 v14, v6, v14, v47 bitop3:0xca
    v_cmp_lt_u32 s[84:85], v5, v92
    s_nop 0
    v_pk_mul_f32 v[80:81], v[80:81], v[14:15] op_sel:[0,1] op_sel_hi:[1,1]
    v_pk_mul_f32 v[82:83], v[82:83], v[14:15] op_sel:[0,1] op_sel_hi:[1,1]
    v_pk_mul_f32 v[76:77], v[76:77], v[14:15] op_sel:[0,0] op_sel_hi:[1,0]
    v_pk_mul_f32 v[78:79], v[78:79], v[14:15] op_sel:[0,0] op_sel_hi:[1,0]
    buffer_load_dwordx4 v[108:111], v3, s[16:19], s40 offen offset:0
    s_waitcnt lgkmcnt(0)
    v_cmpx_ne_u64 vcc, v[74:75], v[70:71]
    s_and_b64 s[82:83], vcc, s[80:81]
    s_cbranch_scc1 L2_c30
L2_d30:
    v_mov_b64 v[84:85], v[70:71]
    v_mov_b32 v7, v95
    v_mov_b64 v[86:87], v[74:75]
    s_mov_b64 exec, -1
    s_or_b64 s[80:81], s[80:81], vcc
    v_cmpx_ne_u64 vcc, v[72:73], v[68:69]
    s_and_b64 s[82:83], vcc, s[80:81]
    s_cbranch_scc1 L2_c31
L2_d31:
    v_mov_b64 v[84:85], v[68:69]
    v_mov_b32 v7, v94
    v_mov_b64 v[86:87], v[72:73]
    s_mov_b64 exec, -1
    s_or_b64 s[80:81], s[80:81], vcc
    ds_read_b64 v[70:71], v93 offset:65408
    s_and_b64 exec, s[84:85], s[80:81]
    v_mfma_f32_4x4x4_16b_bf16 v[76:79], v[12:13], v[84:85], 0
    v_mov_b32 v92, v7
    s_andn2_b64 s[80:81], s[80:81], s[84:85]
    v_mfma_f32_4x4x4_16b_bf16 v[76:79], v[10:11], v[86:87], v[76:79]
    s_mov_b64 exec, -1
    ds_read_b64 v[68:69], v92 offset:65408
    v_and_b32 v46, 0x80000000, v21
    v_lshrrev_b32 v47, 14, v19
    v_bitop3_b32 v47, v47, v5, v46 bitop3:0xea
    ds_read_b64 v[106:107], v47
    v_bitop3_b32 v95, v19, v5, v46 bitop3:0xea
    v_and_b32 v46, 0x40000000, v21
    v_lshrrev_b32 v47, 14, v18
    v_bitop3_b32 v47, v47, v5, v46 bitop3:0xea
    ds_read_b64 v[104:105], v47
    v_bitop3_b32 v94, v18, v5, v46 bitop3:0xea
    s_waitcnt lgkmcnt(2)
    v_mfma_f32_4x4x4_16b_bf16 v[80:83], v[10:11], v[70:71], v[80:83]
    v_mfma_f32_4x4x4_16b_bf16 v[76:79], v[10:11], v[68:69], v[76:79]
    v_perm_b32 v15, v19, v20, s47
    v_bitop3_b32 v46, v19, 0.5, -0.5 bitop3:0xa8
    v_perm_b32 v14, v18, v20, s46
    v_bitop3_b32 v47, v18, 0.5, -0.5 bitop3:0xa8
    v_cvt_pk_bf16_f32 v80, v80, v81
    v_cvt_pk_bf16_f32 v81, v82, v83
    ds_wrxchg_rtn_b64 v[74:75], v93, v[80:81] offset:65408
    v_cvt_pk_bf16_f32 v76, v76, v77
    v_cvt_pk_bf16_f32 v77, v78, v79
    ds_wrxchg_rtn_b64 v[72:73], v92, v[76:77] offset:65408
    s_setprio 2
    s_waitcnt lgkmcnt(2)
    v_mfma_f32_4x4x4_16b_bf16 v[80:83], v[8:9], v[106:107], 0
    v_mfma_f32_4x4x4_16b_bf16 v[76:79], v[8:9], v[104:105], 0
    v_bitop3_b32 v15, v6, v15, v46 bitop3:0xca
    v_bitop3_b32 v14, v6, v14, v47 bitop3:0xca
    s_nop 1
    v_pk_mul_f32 v[80:81], v[80:81], v[14:15] op_sel:[0,1] op_sel_hi:[1,1]
    v_pk_mul_f32 v[82:83], v[82:83], v[14:15] op_sel:[0,1] op_sel_hi:[1,1]
    v_pk_mul_f32 v[76:77], v[76:77], v[14:15] op_sel:[0,0] op_sel_hi:[1,0]
    v_pk_mul_f32 v[78:79], v[78:79], v[14:15] op_sel:[0,0] op_sel_hi:[1,0]
    v_and_b32 v47, 0x0fffffff, v40
    v_mov_b32 v21, v40
    buffer_load_dwordx2 v[16:17], v47, s[8:11], 0 offen
    buffer_load_dwordx3 v[18:20], v47, s[8:11], 0 offen offset:8
    s_waitcnt lgkmcnt(0)
    v_cmpx_ne_u64 vcc, v[74:75], v[70:71]
    s_and_b64 s[82:83], vcc, s[80:81]
    s_cbranch_scc1 L2_c32
L2_d32:
    v_mov_b64 v[84:85], v[70:71]
    v_mov_b32 v7, v93
    v_mov_b64 v[86:87], v[74:75]
    s_mov_b64 exec, -1
    s_or_b64 s[80:81], s[80:81], vcc
    v_cmpx_ne_u64 vcc, v[72:73], v[68:69]
    s_and_b64 s[82:83], vcc, s[80:81]
    s_cbranch_scc1 L2_c33
L2_d33:
    v_mov_b64 v[84:85], v[68:69]
    v_mov_b32 v7, v92
    v_mov_b64 v[86:87], v[72:73]
    s_mov_b64 exec, -1
    s_or_b64 s[80:81], s[80:81], vcc
    ds_read_b64 v[70:71], v95 offset:65408
    ds_read_b64 v[68:69], v94 offset:65408
    s_waitcnt vmcnt(10)
    v_and_b32 v46, 0x20000000, v27
    v_lshrrev_b32 v47, 14, v23
    v_bitop3_b32 v47, v47, v5, v46 bitop3:0xea
    ds_read_b64 v[102:103], v47
    v_bitop3_b32 v93, v23, v5, v46 bitop3:0xea
    v_and_b32 v46, 0x10000000, v27
    v_lshrrev_b32 v47, 14, v22
    v_bitop3_b32 v47, v47, v5, v46 bitop3:0xea
    ds_read_b64 v[100:101], v47
    v_bitop3_b32 v92, v22, v5, v46 bitop3:0xea
    s_waitcnt lgkmcnt(2)
    v_mfma_f32_4x4x4_16b_bf16 v[80:83], v[10:11], v[70:71], v[80:83]
    v_mfma_f32_4x4x4_16b_bf16 v[76:79], v[10:11], v[68:69], v[76:79]
    v_perm_b32 v15, v23, v26, s45
    v_bitop3_b32 v46, v23, 0.5, -0.5 bitop3:0xa8
    v_perm_b32 v14, v22, v26, s44
    v_bitop3_b32 v47, v22, 0.5, -0.5 bitop3:0xa8
    v_cvt_pk_bf16_f32 v80, v80, v81
    v_cvt_pk_bf16_f32 v81, v82, v83
    ds_wrxchg_rtn_b64 v[74:75], v95, v[80:81] offset:65408
    v_cvt_pk_bf16_f32 v76, v76, v77
    v_cvt_pk_bf16_f32 v77, v78, v79
    ds_wrxchg_rtn_b64 v[72:73], v94, v[76:77] offset:65408
    s_waitcnt lgkmcnt(2)
    v_mfma_f32_4x4x4_16b_bf16 v[80:83], v[8:9], v[102:103], 0
    v_mfma_f32_4x4x4_16b_bf16 v[76:79], v[8:9], v[100:101], 0
    v_bitop3_b32 v15, v6, v15, v46 bitop3:0xca
    v_bitop3_b32 v14, v6, v14, v47 bitop3:0xca
    v_cmp_lt_u32 s[84:85], v5, v92
    s_nop 0
    v_pk_mul_f32 v[80:81], v[80:81], v[14:15] op_sel:[0,1] op_sel_hi:[1,1]
    v_pk_mul_f32 v[82:83], v[82:83], v[14:15] op_sel:[0,1] op_sel_hi:[1,1]
    v_pk_mul_f32 v[76:77], v[76:77], v[14:15] op_sel:[0,0] op_sel_hi:[1,0]
    v_pk_mul_f32 v[78:79], v[78:79], v[14:15] op_sel:[0,0] op_sel_hi:[1,0]
    v_sub_u16 v88, v62, v54
    v_and_b32 v89, 3, v54
    v_add3_u32 v99, v88, v89, 3
    v_and_b32 v99, -4, v99
    v_max_u32 v99, 4, v99
    v_and_b32 v97, 0xfffc, v54
    v_bfm_b32 v96, v88, v89
    v_add_u32_dpp v91, v99, v99 row_shr:1 row_mask:0xf bank_mask:0xf bound_ctrl:1
    v_mad_u32_u24 v97, v97, 5, v2
    v_cmp_lt_u32 vcc, 16, v99
    v_add_u32_dpp v91, v91, v91 row_shr:2 row_mask:0xf bank_mask:0xf bound_ctrl:1
    v_sub_u32 v98, s38, v99
    v_lshrrev_b64 v[54:55], 16, v[54:55]
    v_add_u32_dpp v91, v91, v91 row_shr:4 row_mask:0xf bank_mask:0xf bound_ctrl:1
    v_lshrrev_b64 v[62:63], 16, v[62:63]
    s_mov_b32 s101, 0
    v_add_u32_dpp v91, v91, v91 row_shr:8 row_mask:0xf bank_mask:0xf bound_ctrl:1
    s_nop 1
    v_add_u32_dpp v91, v91, v91 row_bcast:15 row_mask:0xa bank_mask:0xf
    s_nop 1
    v_add_u32_dpp v91, v91, v91 row_bcast:31 row_mask:0xc bank_mask:0xf
    v_add_u32 v98, v98, v91
    v_readlane_b32 s37, v91, 63
    s_cbranch_vccnz L2_xo34
L2_xp34:
    buffer_load_dwordx4 v[112:115], v3, s[16:19], s40 offen offset:1024
    s_waitcnt lgkmcnt(0)
    v_cmpx_ne_u64 vcc, v[74:75], v[70:71]
    s_and_b64 s[82:83], vcc, s[80:81]
    s_cbranch_scc1 L2_c35
L2_d35:
    v_mov_b64 v[84:85], v[70:71]
    v_mov_b32 v7, v95
    v_mov_b64 v[86:87], v[74:75]
    s_mov_b64 exec, -1
    s_or_b64 s[80:81], s[80:81], vcc
    v_cmpx_ne_u64 vcc, v[72:73], v[68:69]
    s_and_b64 s[82:83], vcc, s[80:81]
    s_cbranch_scc1 L2_c36
L2_d36:
    v_mov_b64 v[84:85], v[68:69]
    v_mov_b32 v7, v94
    v_mov_b64 v[86:87], v[72:73]
    s_mov_b64 exec, -1
    s_or_b64 s[80:81], s[80:81], vcc
    ds_read_b64 v[70:71], v93 offset:65408
    s_and_b64 exec, s[84:85], s[80:81]
    v_mfma_f32_4x4x4_16b_bf16 v[76:79], v[12:13], v[84:85], 0
    v_mov_b32 v92, v7
    s_andn2_b64 s[80:81], s[80:81], s[84:85]
    v_mfma_f32_4x4x4_16b_bf16 v[76:79], v[10:11], v[86:87], v[76:79]
    s_mov_b64 exec, -1
    ds_read_b64 v[68:69], v92 offset:65408
    v_and_b32 v46, 0x80000000, v27
    v_lshrrev_b32 v47, 14, v25
    v_bitop3_b32 v47, v47, v5, v46 bitop3:0xea
    ds_read_b64 v[106:107], v47
    v_bitop3_b32 v95, v25, v5, v46 bitop3:0xea
    v_and_b32 v46, 0x40000000, v27
    v_lshrrev_b32 v47, 14, v24
    v_bitop3_b32 v47, v47, v5, v46 bitop3:0xea
    ds_read_b64 v[104:105], v47
    v_bitop3_b32 v94, v24, v5, v46 bitop3:0xea
    s_waitcnt lgkmcnt(2)
    v_mfma_f32_4x4x4_16b_bf16 v[80:83], v[10:11], v[70:71], v[80:83]
    v_mfma_f32_4x4x4_16b_bf16 v[76:79], v[10:11], v[68:69], v[76:79]
    v_perm_b32 v15, v25, v26, s47
    v_bitop3_b32 v46, v25, 0.5, -0.5 bitop3:0xa8
    v_perm_b32 v14, v24, v26, s46
    v_bitop3_b32 v47, v24, 0.5, -0.5 bitop3:0xa8
    v_cvt_pk_bf16_f32 v80, v80, v81
    v_cvt_pk_bf16_f32 v81, v82, v83
    ds_wrxchg_rtn_b64 v[74:75], v93, v[80:81] offset:65408
    v_cvt_pk_bf16_f32 v76, v76, v77
    v_cvt_pk_bf16_f32 v77, v78, v79
    ds_wrxchg_rtn_b64 v[72:73], v92, v[76:77] offset:65408
    s_setprio 1
    s_waitcnt lgkmcnt(2)
    v_mfma_f32_4x4x4_16b_bf16 v[80:83], v[8:9], v[106:107], 0
    v_mfma_f32_4x4x4_16b_bf16 v[76:79], v[8:9], v[104:105], 0
    v_bitop3_b32 v15, v6, v15, v46 bitop3:0xca
    v_bitop3_b32 v14, v6, v14, v47 bitop3:0xca
    s_nop 1
    v_pk_mul_f32 v[80:81], v[80:81], v[14:15] op_sel:[0,1] op_sel_hi:[1,1]
    v_pk_mul_f32 v[82:83], v[82:83], v[14:15] op_sel:[0,1] op_sel_hi:[1,1]
    v_pk_mul_f32 v[76:77], v[76:77], v[14:15] op_sel:[0,0] op_sel_hi:[1,0]
    v_pk_mul_f32 v[78:79], v[78:79], v[14:15] op_sel:[0,0] op_sel_hi:[1,0]
    v_and_b32 v47, 0x0fffffff, v41
    v_mov_b32 v27, v41
    buffer_load_dwordx2 v[22:23], v47, s[8:11], 0 offen
    buffer_load_dwordx3 v[24:26], v47, s[8:11], 0 offen offset:8
    s_waitcnt lgkmcnt(0)
    v_cmpx_ne_u64 vcc, v[74:75], v[70:71]
    s_and_b64 s[82:83], vcc, s[80:81]
    s_cbranch_scc1 L2_c37
L2_d37:
    v_mov_b64 v[84:85], v[70:71]
    v_mov_b32 v7, v93
    v_mov_b64 v[86:87], v[74:75]
    s_mov_b64 exec, -1
    s_or_b64 s[80:81], s[80:81], vcc
    v_cmpx_ne_u64 vcc, v[72:73], v[68:69]
    s_and_b64 s[82:83], vcc, s[80:81]
    s_cbranch_scc1 L2_c38
L2_d38:
    v_mov_b64 v[84:85], v[68:69]
    v_mov_b32 v7, v92
    v_mov_b64 v[86:87], v[72:73]
    s_mov_b64 exec, -1
    s_or_b64 s[80:81], s[80:81], vcc
    ds_read_b64 v[70:71], v95 offset:65408
    ds_read_b64 v[68:69], v94 offset:65408
    s_waitcnt vmcnt(9)
    v_and_b32 v46, 0x20000000, v33
    v_lshrrev_b32 v47, 14, v29
    v_bitop3_b32 v47, v47, v5, v46 bitop3:0xea
    ds_read_b64 v[102:103], v47
    v_bitop3_b32 v93, v29, v5, v46 bitop3:0xea
    v_and_b32 v46, 0x10000000, v33
    v_lshrrev_b32 v47, 14, v28
    v_bitop3_b32 v47, v47, v5, v46 bitop3:0xea
    ds_read_b64 v[100:101], v47
    v_bitop3_b32 v92, v28, v5, v46 bitop3:0xea
    s_waitcnt lgkmcnt(2)
    v_mfma_f32_4x4x4_16b_bf16 v[80:83], v[10:11], v[70:71], v[80:83]
    v_mfma_f32_4x4x4_16b_bf16 v[76:79], v[10:11], v[68:69], v[76:79]
    v_perm_b32 v15, v29, v32, s45
    v_bitop3_b32 v46, v29, 0.5, -0.5 bitop3:0xa8
    v_perm_b32 v14, v28, v32, s44
    v_bitop3_b32 v47, v28, 0.5, -0.5 bitop3:0xa8
    v_cvt_pk_bf16_f32 v80, v80, v81
    v_cvt_pk_bf16_f32 v81, v82, v83
    ds_wrxchg_rtn_b64 v[74:75], v95, v[80:81] offset:65408
    v_cvt_pk_bf16_f32 v76, v76, v77
    v_cvt_pk_bf16_f32 v77, v78, v79
    ds_wrxchg_rtn_b64 v[72:73], v94, v[76:77] offset:65408
    s_waitcnt lgkmcnt(2)
    v_mfma_f32_4x4x4_16b_bf16 v[80:83], v[8:9], v[102:103], 0
    v_mfma_f32_4x4x4_16b_bf16 v[76:79], v[8:9], v[100:101], 0
    v_bitop3_b32 v15, v6, v15, v46 bitop3:0xca
    v_bitop3_b32 v14, v6, v14, v47 bitop3:0xca
    v_cmp_lt_u32 s[84:85], v5, v92
    s_nop 0
    v_pk_mul_f32 v[80:81], v[80:81], v[14:15] op_sel:[0,1] op_sel_hi:[1,1]
    v_pk_mul_f32 v[82:83], v[82:83], v[14:15] op_sel:[0,1] op_sel_hi:[1,1]
    v_pk_mul_f32 v[76:77], v[76:77], v[14:15] op_sel:[0,0] op_sel_hi:[1,0]
    v_pk_mul_f32 v[78:79], v[78:79], v[14:15] op_sel:[0,0] op_sel_hi:[1,0]
    s_waitcnt lgkmcnt(0)
    v_cmpx_ne_u64 vcc, v[74:75], v[70:71]
    s_and_b64 s[82:83], vcc, s[80:81]
    s_cbranch_scc1 L2_c39
L2_d39:
    v_mov_b64 v[84:85], v[70:71]
    v_mov_b32 v7, v95
    v_mov_b64 v[86:87], v[74:75]
    s_mov_b64 exec, -1
    s_or_b64 s[80:81], s[80:81], vcc
    v_cmpx_ne_u64 vcc, v[72:73], v[68:69]
    s_and_b64 s[82:83], vcc, s[80:81]
    s_cbranch_scc1 L2_c40
L2_d40:
    v_mov_b64 v[84:85], v[68:69]
    v_mov_b32 v7, v94
    v_mov_b64 v[86:87], v[72:73]
    s_mov_b64 exec, -1
    s_or_b64 s[80:81], s[80:81], vcc
    ds_read_b64 v[70:71], v93 offset:65408
    s_and_b64 exec, s[84:85], s[80:81]
    v_mfma_f32_4x4x4_16b_bf16 v[76:79], v[12:13], v[84:85], 0
    v_mov_b32 v92, v7
    s_andn2_b64 s[80:81], s[80:81], s[84:85]
    v_mfma_f32_4x4x4_16b_bf16 v[76:79], v[10:11], v[86:87], v[76:79]
    s_mov_b64 exec, -1
    ds_read_b64 v[68:69], v92 offset:65408
    v_and_b32 v46, 0x80000000, v33
    v_lshrrev_b32 v47, 14, v31
    v_bitop3_b32 v47, v47, v5, v46 bitop3:0xea
    ds_read_b64 v[106:107], v47
    v_bitop3_b32 v95, v31, v5, v46 bitop3:0xea
    v_and_b32 v46, 0x40000000, v33
    v_lshrrev_b32 v47, 14, v30
    v_bitop3_b32 v47, v47, v5, v46 bitop3:0xea
    ds_read_b64 v[104:105], v47
    v_bitop3_b32 v94, v30, v5, v46 bitop3:0xea
    s_waitcnt lgkmcnt(2)
    v_mfma_f32_4x4x4_16b_bf16 v[80:83], v[10:11], v[70:71], v[80:83]
    v_mfma_f32_4x4x4_16b_bf16 v[76:79], v[10:11], v[68:69], v[76:79]
    v_perm_b32 v15, v31, v32, s47
    v_bitop3_b32 v46, v31, 0.5, -0.5 bitop3:0xa8
    v_perm_b32 v14, v30, v32, s46
    v_bitop3_b32 v47, v30, 0.5, -0.5 bitop3:0xa8
    v_cvt_pk_bf16_f32 v80, v80, v81
    v_cvt_pk_bf16_f32 v81, v82, v83
    ds_wrxchg_rtn_b64 v[74:75], v93, v[80:81] offset:65408
    v_cvt_pk_bf16_f32 v76, v76, v77
    v_cvt_pk_bf16_f32 v77, v78, v79
    ds_wrxchg_rtn_b64 v[72:73], v92, v[76:77] offset:65408
    s_setprio 0
    s_waitcnt lgkmcnt(2)
    v_mfma_f32_4x4x4_16b_bf16 v[80:83], v[8:9], v[106:107], 0
    v_mfma_f32_4x4x4_16b_bf16 v[76:79], v[8:9], v[104:105], 0
    v_bitop3_b32 v15, v6, v15, v46 bitop3:0xca
    v_bitop3_b32 v14, v6, v14, v47 bitop3:0xca
    s_nop 1
    v_pk_mul_f32 v[80:81], v[80:81], v[14:15] op_sel:[0,1] op_sel_hi:[1,1]
    v_pk_mul_f32 v[82:83], v[82:83], v[14:15] op_sel:[0,1] op_sel_hi:[1,1]
    v_pk_mul_f32 v[76:77], v[76:77], v[14:15] op_sel:[0,0] op_sel_hi:[1,0]
    v_pk_mul_f32 v[78:79], v[78:79], v[14:15] op_sel:[0,0] op_sel_hi:[1,0]
    s_add_u32 s40, s40, 0x50000
    v_and_b32 v47, 0x0fffffff, v42
    v_mov_b32 v33, v42
    buffer_load_dwordx2 v[28:29], v47, s[8:11], 0 offen
    buffer_load_dwordx3 v[30:32], v47, s[8:11], 0 offen offset:8
    s_waitcnt lgkmcnt(0)
    v_cmpx_ne_u64 vcc, v[74:75], v[70:71]
    s_and_b64 s[82:83], vcc, s[80:81]
    s_cbranch_scc1 L2_c41
L2_d41:
    v_mov_b64 v[84:85], v[70:71]
    v_mov_b32 v7, v93
    v_mov_b64 v[86:87], v[74:75]
    s_mov_b64 exec, -1
    s_or_b64 s[80:81], s[80:81], vcc
    v_cmpx_ne_u64 vcc, v[72:73], v[68:69]
    s_and_b64 s[82:83], vcc, s[80:81]
    s_cbranch_scc1 L2_c42
L2_d42:
    v_mov_b64 v[84:85], v[68:69]
    v_mov_b32 v7, v92
    v_mov_b64 v[86:87], v[72:73]
    s_mov_b64 exec, -1
    s_or_b64 s[80:81], s[80:81], vcc
    ds_read_b64 v[70:71], v95 offset:65408
    ds_read_b64 v[68:69], v94 offset:65408
    s_waitcnt vmcnt(8)
    v_and_b32 v46, 0x20000000, v39
    v_lshrrev_b32 v47, 14, v35
    v_bitop3_b32 v47, v47, v5, v46 bitop3:0xea
    ds_read_b64 v[102:103], v47
    v_bitop3_b32 v93, v35, v5, v46 bitop3:0xea
    v_and_b32 v46, 0x10000000, v39
    v_lshrrev_b32 v47, 14, v34
    v_bitop3_b32 v47, v47, v5, v46 bitop3:0xea
    ds_read_b64 v[100:101], v47
    v_bitop3_b32 v92, v34, v5, v46 bitop3:0xea
    v_and_b32 v46, 0x80000000, v39
    v_lshrrev_b32 v47, 14, v37
    v_bitop3_b32 v47, v47, v5, v46 bitop3:0xea
    ds_read_b64 v[106:107], v47
    v_and_b32 v46, 0x40000000, v39
    v_lshrrev_b32 v47, 14, v36
    v_bitop3_b32 v47, v47, v5, v46 bitop3:0xea
    ds_read_b64 v[104:105], v47
    s_waitcnt lgkmcnt(4)
    v_mfma_f32_4x4x4_16b_bf16 v[80:83], v[10:11], v[70:71], v[80:83]
    v_mfma_f32_4x4x4_16b_bf16 v[76:79], v[10:11], v[68:69], v[76:79]
    v_perm_b32 v15, v35, v38, s45
    v_bitop3_b32 v46, v35, 0.5, -0.5 bitop3:0xa8
    v_perm_b32 v14, v34, v38, s44
    v_bitop3_b32 v47, v34, 0.5, -0.5 bitop3:0xa8
    v_cvt_pk_bf16_f32 v80, v80, v81
    v_cvt_pk_bf16_f32 v81, v82, v83
    ds_wrxchg_rtn_b64 v[74:75], v95, v[80:81] offset:65408
    v_cvt_pk_bf16_f32 v76, v76, v77
    v_cvt_pk_bf16_f32 v77, v78, v79
    ds_wrxchg_rtn_b64 v[72:73], v94, v[76:77] offset:65408
    s_waitcnt lgkmcnt(2)
    s_barrier
    s_setprio 3
    s_mov_b32 m0, s100
    s_nop 0
    ds_write_addtid_b32 v116 offset:32768
    ds_write_addtid_b32 v117 offset:33024
    ds_write_addtid_b32 v118 offset:33280
    ds_write_addtid_b32 v119 offset:33536
    buffer_load_dwordx4 v[116:119], v3, s[16:19], s40 offen offset:2048
    ds_write_addtid_b32 v120 offset:33792
    ds_write_addtid_b32 v121 offset:34048
    ds_write_addtid_b32 v122 offset:34304
    ds_write_addtid_b32 v123 offset:34560
    buffer_load_dwordx4 v[120:123], v3, s[16:19], s40 offen offset:3072
    v_mfma_f32_4x4x4_16b_bf16 v[80:83], v[8:9], v[102:103], 0
    v_mfma_f32_4x4x4_16b_bf16 v[76:79], v[8:9], v[100:101], 0
    v_bitop3_b32 v15, v6, v15, v46 bitop3:0xca
    v_bitop3_b32 v14, v6, v14, v47 bitop3:0xca
    v_cmp_lt_u32 s[84:85], v5, v92
    s_nop 0
    v_pk_mul_f32 v[80:81], v[80:81], v[14:15] op_sel:[0,1] op_sel_hi:[1,1]
    v_pk_mul_f32 v[82:83], v[82:83], v[14:15] op_sel:[0,1] op_sel_hi:[1,1]
    v_pk_mul_f32 v[76:77], v[76:77], v[14:15] op_sel:[0,0] op_sel_hi:[1,0]
    v_pk_mul_f32 v[78:79], v[78:79], v[14:15] op_sel:[0,0] op_sel_hi:[1,0]
    v_mov_b32 v44, v43
    s_cmp_gt_u32 s37, 1024
    s_cbranch_scc1 L2_xs43
    s_cmp_lg_u32 s101, 0
    s_cbranch_scc1 L2_xa43
L2_xb43:
    v_lshlrev_b32 v89, 16, v96
    v_add_u32 v90, 60, v97
    v_bitop3_b32 v90, v89, v45, v90 bitop3:0x6a
    ds_write_b32 v98, v90 offset:12
    v_lshlrev_b32 v89, 20, v96
    v_add_u32 v90, 40, v97
    v_bitop3_b32 v90, v89, v45, v90 bitop3:0x6a
    ds_write_b32 v98, v90 offset:8
    v_lshlrev_b32 v89, 24, v96
    v_add_u32 v90, 20, v97
    v_bitop3_b32 v90, v89, v45, v90 bitop3:0x6a
    ds_write_b32 v98, v90 offset:4
    v_lshlrev_b32 v89, 28, v96
    v_bitop3_b32 v90, v89, v45, v97 bitop3:0x6a
    ds_write_b32 v98, v90 offset:0
    v_mov_b32_dpp v91, v66 quad_perm:[1,1,1,1] row_mask:0xf bank_mask:0xf
    v_and_b32 v89, 3, v91
    v_and_b32 v97, 0xfffc, v91
    v_sub_u16_dpp v88, v66, v91 quad_perm:[3,3,3,3] row_mask:0xf bank_mask:0xf
    v_mad_u32_u24 v97, v97, 5, v4
    v_add_u32 v99, v88, v89
    v_bfm_b32 v96, v88, v89
    v_cmp_lt_u32 s[58:59], 16, v99
    v_lshlrev_b32 v89, v1, v96
    v_and_b32 v89, v45, v89
    v_cmp_ne_u32 vcc, 0, v89
    v_xor_b32 v90, v97, v89
    s_add_u32 s3, s37, s38
    v_mbcnt_lo_u32_b32 v98, vcc_lo, 0
    v_mbcnt_hi_u32_b32 v98, vcc_hi, v98
    s_bcnt1_i32_b64 s41, vcc
    v_lshl_add_u32 v98, v98, 2, s3
    s_mov_b64 exec, vcc
    ds_write_b32 v98, v90
    s_mov_b64 exec, -1
    s_lshl2_add_u32 s37, s41, s37
    s_cmp_lg_u64 s[58:59], 0
    s_cbranch_scc1 L2_xe43
L2_xr43:
    v_add_u32 v98, s37, v0
    v_mov_b32 v90, -1
    ds_write_b32 v98, v90
    ds_read2st64_b32 v[40:41], v0 offset0:0 offset1:1
    ds_read2st64_b32 v[42:43], v0 offset0:2 offset1:3
    s_sub_u32 s3, s37, 768
    s_cmp_gt_u32 s3, 256
    s_cbranch_scc1 L2_xf43
L2_xg43:
    v_lshrrev_b64 v[64:65], 16, v[64:65]
    v_lshrrev_b64 v[66:67], 16, v[66:67]
    s_setprio 2
    ds_write_addtid_b32 v124 offset:34816
    ds_write_addtid_b32 v125 offset:35072
    ds_write_addtid_b32 v126 offset:35328
    ds_write_addtid_b32 v127 offset:35584
    s_add_u32 s3, s40, 4096
    buffer_load_dwordx4 v[124:127], v3, s[16:19], s3 offen
    s_waitcnt lgkmcnt(14)
    v_cmpx_ne_u64 vcc, v[74:75], v[70:71]
    s_and_b64 s[82:83], vcc, s[80:81]
    s_cbranch_scc1 L2_c44
L2_d44:
    v_mov_b64 v[84:85], v[70:71]
    v_mov_b32 v7, v95
    v_mov_b64 v[86:87], v[74:75]
    s_mov_b64 exec, -1
    s_or_b64 s[80:81], s[80:81], vcc
    v_cmpx_ne_u64 vcc, v[72:73], v[68:69]
    s_and_b64 s[82:83], vcc, s[80:81]
    s_cbranch_scc1 L2_c45
L2_d45:
    v_mov_b64 v[84:85], v[68:69]
    v_mov_b32 v7, v94
    v_mov_b64 v[86:87], v[72:73]
    s_mov_b64 exec, -1
    s_or_b64 s[80:81], s[80:81], vcc
    ds_read_b64 v[70:71], v93 offset:65408
    s_and_b64 exec, s[84:85], s[80:81]
    v_mfma_f32_4x4x4_16b_bf16 v[76:79], v[12:13], v[84:85], 0
    v_mov_b32 v92, v7
    s_andn2_b64 s[80:81], s[80:81], s[84:85]
    v_mfma_f32_4x4x4_16b_bf16 v[76:79], v[10:11], v[86:87], v[76:79]
    s_mov_b64 exec, -1
    ds_read_b64 v[68:69], v92 offset:65408
    s_setprio 1
    s_waitcnt vmcnt(10)
    s_mov_b32 m0, s38
    s_nop 0
    ds_write_addtid_b32 v108 offset:0
    ds_write_addtid_b32 v109 offset:256
    ds_write_addtid_b32 v110 offset:512
    ds_write_addtid_b32 v111 offset:768
    s_waitcnt lgkmcnt(4)
    v_mfma_f32_4x4x4_16b_bf16 v[80:83], v[10:11], v[70:71], v[80:83]
    v_mfma_f32_4x4x4_16b_bf16 v[76:79], v[10:11], v[68:69], v[76:79]
    v_and_b32 v46, 0x40000000, v39
    v_bitop3_b32 v94, v36, v5, v46 bitop3:0xea
    v_and_b32 v46, 0x80000000, v39
    v_bitop3_b32 v95, v37, v5, v46 bitop3:0xea
    v_perm_b32 v15, v37, v38, s47
    v_bitop3_b32 v46, v37, 0.5, -0.5 bitop3:0xa8
    v_perm_b32 v14, v36, v38, s46
    v_bitop3_b32 v47, v36, 0.5, -0.5 bitop3:0xa8
    v_cvt_pk_bf16_f32 v80, v80, v81
    v_cvt_pk_bf16_f32 v81, v82, v83
    ds_wrxchg_rtn_b64 v[74:75], v93, v[80:81] offset:65408
    v_cvt_pk_bf16_f32 v76, v76, v77
    v_cvt_pk_bf16_f32 v77, v78, v79
    ds_wrxchg_rtn_b64 v[72:73], v92, v[76:77] offset:65408
    s_setprio 0
    s_waitcnt vmcnt(7)
    ds_write_addtid_b32 v112 offset:1024
    ds_write_addtid_b32 v113 offset:1280
    ds_write_addtid_b32 v114 offset:1536
    ds_write_addtid_b32 v115 offset:1792
    v_mfma_f32_4x4x4_16b_bf16 v[80:83], v[8:9], v[106:107], 0
    v_mfma_f32_4x4x4_16b_bf16 v[76:79], v[8:9], v[104:105], 0
    v_bitop3_b32 v15, v6, v15, v46 bitop3:0xca
    v_bitop3_b32 v14, v6, v14, v47 bitop3:0xca
    s_nop 1
    v_pk_mul_f32 v[80:81], v[80:81], v[14:15] op_sel:[0,1] op_sel_hi:[1,1]
    v_pk_mul_f32 v[82:83], v[82:83], v[14:15] op_sel:[0,1] op_sel_hi:[1,1]
    v_pk_mul_f32 v[76:77], v[76:77], v[14:15] op_sel:[0,0] op_sel_hi:[1,0]
    v_pk_mul_f32 v[78:79], v[78:79], v[14:15] op_sel:[0,0] op_sel_hi:[1,0]
    s_add_u32 s42, s42, 1
    s_waitcnt lgkmcnt(0)
L2_loop:
    s_barrier
    s_bitcmp1_b32 s36, s42
    s_cbranch_scc1 L2_slow
L2_ret2:
    s_setprio 3
    v_and_b32 v47, 0x0fffffff, v44
    v_mov_b32 v39, v44
    buffer_load_dwordx2 v[34:35], v47, s[8:11], 0 offen
    buffer_load_dwordx3 v[36:38], v47, s[8:11], 0 offen offset:8
    v_cmpx_ne_u64 vcc, v[74:75], v[70:71]
    s_and_b64 s[82:83], vcc, s[80:81]
    s_cbranch_scc1 L2_c46
L2_d46:
    v_mov_b64 v[84:85], v[70:71]
    v_mov_b32 v7, v93
    v_mov_b64 v[86:87], v[74:75]
    s_mov_b64 exec, -1
    s_or_b64 s[80:81], s[80:81], vcc
    v_cmpx_ne_u64 vcc, v[72:73], v[68:69]
    s_and_b64 s[82:83], vcc, s[80:81]
    s_cbranch_scc1 L2_c47
L2_d47:
    v_mov_b64 v[84:85], v[68:69]
    v_mov_b32 v7, v92
    v_mov_b64 v[86:87], v[72:73]
    s_mov_b64 exec, -1
    s_or_b64 s[80:81], s[80:81], vcc
    ds_read_b64 v[70:71], v95 offset:65408
    ds_read_b64 v[68:69], v94 offset:65408
    v_and_b32 v46, 0x20000000, v21
    v_lshrrev_b32 v47, 14, v17
    v_bitop3_b32 v47, v47, v5, v46 bitop3:0xea
    ds_read_b64 v[102:103], v47
    v_bitop3_b32 v93, v17, v5, v46 bitop3:0xea
    v_and_b32 v46, 0x10000000, v21
    v_lshrrev_b32 v47, 14, v16
    v_bitop3_b32 v47, v47, v5, v46 bitop3:0xea
    ds_read_b64 v[100:101], v47
    v_bitop3_b32 v92, v16, v5, v46 bitop3:0xea
    s_waitcnt lgkmcnt(2)
    v_mfma_f32_4x4x4_16b_bf16 v[80:83], v[10:11], v[70:71], v[80:83]
    v_mfma_f32_4x4x4_16b_bf16 v[76:79], v[10:11], v[68:69], v[76:79]
    v_perm_b32 v15, v17, v20, s45
    v_bitop3_b32 v46, v17, 0.5, -0.5 bitop3:0xa8
    v_perm_b32 v14, v16, v20, s44
    v_bitop3_b32 v47, v16, 0.5, -0.5 bitop3:0xa8
    v_cvt_pk_bf16_f32 v80, v80, v81
    v_cvt_pk_bf16_f32 v81, v82, v83
    ds_wrxchg_rtn_b64 v[74:75], v95, v[80:81] offset:65408
    v_cvt_pk_bf16_f32 v76, v76, v77
    v_cvt_pk_bf16_f32 v77, v78, v79
    ds_wrxchg_rtn_b64 v[72:73], v94, v[76:77] offset:65408
    s_waitcnt lgkmcnt(2)
    v_mfma_f32_4x4x4_16b_bf16 v[80:83], v[8:9], v[102:103], 0
    v_mfma_f32_4x4x4_16b_bf16 v[76:79], v[8:9], v[100:101], 0
    v_bitop3_b32 v15, v6, v15, v46 bitop3:0xca
    v_bitop3_b32 v14, v6, v14, v47 bitop3:0xca
    v_cmp_lt_u32 s[84:85], v5, v92
    s_nop 0
    v_pk_mul_f32 v[80:81], v[80:81], v[14:15] op_sel:[0,1] op_sel_hi:[1,1]
    v_pk_mul_f32 v[82:83], v[82:83], v[14:15] op_sel:[0,1] op_sel_hi:[1,1]
    v_pk_mul_f32 v[76:77], v[76:77], v[14:15] op_sel:[0,0] op_sel_hi:[1,0]
    v_pk_mul_f32 v[78:79], v[78:79], v[14:15] op_sel:[0,0] op_sel_hi:[1,0]
    buffer_load_dwordx4 v[108:111], v3, s[16:19], s40 offen offset:0
    s_waitcnt lgkmcnt(0)
    v_cmpx_ne_u64 vcc, v[74:75], v[70:71]
    s_and_b64 s[82:83], vcc, s[80:81]
    s_cbranch_scc1 L2_c48
L2_d48:
    v_mov_b64 v[84:85], v[70:71]
    v_mov_b32 v7, v95
    v_mov_b64 v[86:87], v[74:75]
    s_mov_b64 exec, -1
    s_or_b64 s[80:81], s[80:81], vcc
    v_cmpx_ne_u64 vcc, v[72:73], v[68:69]
    s_and_b64 s[82:83], vcc, s[80:81]
    s_cbranch_scc1 L2_c49
L2_d49:
    v_mov_b64 v[84:85], v[68:69]
    v_mov_b32 v7, v94
    v_mov_b64 v[86:87], v[72:73]
    s_mov_b64 exec, -1
    s_or_b64 s[80:81], s[80:81], vcc
    ds_read_b64 v[70:71], v93 offset:65408
    s_and_b64 exec, s[84:85], s[80:81]
    v_mfma_f32_4x4x4_16b_bf16 v[76:79], v[12:13], v[84:85], 0
    v_mov_b32 v92, v7
    s_andn2_b64 s[80:81], s[80:81], s[84:85]
    v_mfma_f32_4x4x4_16b_bf16 v[76:79], v[10:11], v[86:87], v[76:79]
    s_mov_b64 exec, -1
    ds_read_b64 v[68:69], v92 offset:65408
    v_and_b32 v46, 0x80000000, v21
    v_lshrrev_b32 v47, 14, v19
    v_bitop3_b32 v47, v47, v5, v46 bitop3:0xea
    ds_read_b64 v[106:107], v47
    v_bitop3_b32 v95, v19, v5, v46 bitop3:0xea
    v_and_b32 v46, 0x40000000, v21
    v_lshrrev_b32 v47, 14, v18
    v_bitop3_b32 v47, v47, v5, v46 bitop3:0xea
    ds_read_b64 v[104:105], v47
    v_bitop3_b32 v94, v18, v5, v46 bitop3:0xea
    s_waitcnt lgkmcnt(2)
    v_mfma_f32_4x4x4_16b_bf16 v[80:83], v[10:11], v[70:71], v[80:83]
    v_mfma_f32_4x4x4_16b_bf16 v[76:79], v[10:11], v[68:69], v[76:79]
    v_perm_b32 v15, v19, v20, s47
    v_bitop3_b32 v46, v19, 0.5, -0.5 bitop3:0xa8
    v_perm_b32 v14, v18, v20, s46
    v_bitop3_b32 v47, v18, 0.5, -0.5 bitop3:0xa8
    v_cvt_pk_bf16_f32 v80, v80, v81
    v_cvt_pk_bf16_f32 v81, v82, v83
    ds_wrxchg_rtn_b64 v[74:75], v93, v[80:81] offset:65408
    v_cvt_pk_bf16_f32 v76, v76, v77
    v_cvt_pk_bf16_f32 v77, v78, v79
    ds_wrxchg_rtn_b64 v[72:73], v92, v[76:77] offset:65408
    s_setprio 2
    s_waitcnt lgkmcnt(2)
    v_mfma_f32_4x4x4_16b_bf16 v[80:83], v[8:9], v[106:107], 0
    v_mfma_f32_4x4x4_16b_bf16 v[76:79], v[8:9], v[104:105], 0
    v_bitop3_b32 v15, v6, v15, v46 bitop3:0xca
    v_bitop3_b32 v14, v6, v14, v47 bitop3:0xca
    s_nop 1
    v_pk_mul_f32 v[80:81], v[80:81], v[14:15] op_sel:[0,1] op_sel_hi:[1,1]
    v_pk_mul_f32 v[82:83], v[82:83], v[14:15] op_sel:[0,1] op_sel_hi:[1,1]
    v_pk_mul_f32 v[76:77], v[76:77], v[14:15] op_sel:[0,0] op_sel_hi:[1,0]
    v_pk_mul_f32 v[78:79], v[78:79], v[14:15] op_sel:[0,0] op_sel_hi:[1,0]
    v_and_b32 v47, 0x0fffffff, v40
    v_mov_b32 v21, v40
    buffer_load_dwordx2 v[16:17], v47, s[8:11], 0 offen
    buffer_load_dwordx3 v[18:20], v47, s[8:11], 0 offen offset:8
    s_waitcnt lgkmcnt(0)
    v_cmpx_ne_u64 vcc, v[74:75], v[70:71]
    s_and_b64 s[82:83], vcc, s[80:81]
    s_cbranch_scc1 L2_c50
L2_d50:
    v_mov_b64 v[84:85], v[70:71]
    v_mov_b32 v7, v93
    v_mov_b64 v[86:87], v[74:75]
    s_mov_b64 exec, -1
    s_or_b64 s[80:81], s[80:81], vcc
    v_cmpx_ne_u64 vcc, v[72:73], v[68:69]
    s_and_b64 s[82:83], vcc, s[80:81]
    s_cbranch_scc1 L2_c51
L2_d51:
    v_mov_b64 v[84:85], v[68:69]
    v_mov_b32 v7, v92
    v_mov_b64 v[86:87], v[72:73]
    s_mov_b64 exec, -1
    s_or_b64 s[80:81], s[80:81], vcc
    ds_read_b64 v[70:71], v95 offset:65408
    ds_read_b64 v[68:69], v94 offset:65408
    s_waitcnt vmcnt(10)
    v_and_b32 v46, 0x20000000, v27
    v_lshrrev_b32 v47, 14, v23
    v_bitop3_b32 v47, v47, v5, v46 bitop3:0xea
    ds_read_b64 v[102:103], v47
    v_bitop3_b32 v93, v23, v5, v46 bitop3:0xea
    v_and_b32 v46, 0x10000000, v27
    v_lshrrev_b32 v47, 14, v22
    v_bitop3_b32 v47, v47, v5, v46 bitop3:0xea
    ds_read_b64 v[100:101], v47
    v_bitop3_b32 v92, v22, v5, v46 bitop3:0xea
    s_waitcnt lgkmcnt(2)
    v_mfma_f32_4x4x4_16b_bf16 v[80:83], v[10:11], v[70:71], v[80:83]
    v_mfma_f32_4x4x4_16b_bf16 v[76:79], v[10:11], v[68:69], v[76:79]
    v_perm_b32 v15, v23, v26, s45
    v_bitop3_b32 v46, v23, 0.5, -0.5 bitop3:0xa8
    v_perm_b32 v14, v22, v26, s44
    v_bitop3_b32 v47, v22, 0.5, -0.5 bitop3:0xa8
    v_cvt_pk_bf16_f32 v80, v80, v81
    v_cvt_pk_bf16_f32 v81, v82, v83
    ds_wrxchg_rtn_b64 v[74:75], v95, v[80:81] offset:65408
    v_cvt_pk_bf16_f32 v76, v76, v77
    v_cvt_pk_bf16_f32 v77, v78, v79
    ds_wrxchg_rtn_b64 v[72:73], v94, v[76:77] offset:65408
    s_waitcnt lgkmcnt(2)
    v_mfma_f32_4x4x4_16b_bf16 v[80:83], v[8:9], v[102:103], 0
    v_mfma_f32_4x4x4_16b_bf16 v[76:79], v[8:9], v[100:101], 0
    v_bitop3_b32 v15, v6, v15, v46 bitop3:0xca
    v_bitop3_b32 v14, v6, v14, v47 bitop3:0xca
    v_cmp_lt_u32 s[84:85], v5, v92
    s_nop 0
    v_pk_mul_f32 v[80:81], v[80:81], v[14:15] op_sel:[0,1] op_sel_hi:[1,1]
    v_pk_mul_f32 v[82:83], v[82:83], v[14:15] op_sel:[0,1] op_sel_hi:[1,1]
    v_pk_mul_f32 v[76:77], v[76:77], v[14:15] op_sel:[0,0] op_sel_hi:[1,0]
    v_pk_mul_f32 v[78:79], v[78:79], v[14:15] op_sel:[0,0] op_sel_hi:[1,0]
    v_sub_u16 v88, v56, v48
    v_and_b32 v89, 3, v48
    v_add3_u32 v99, v88, v89, 3
    v_and_b32 v99, -4, v99
    v_max_u32 v99, 4, v99
    v_and_b32 v97, 0xfffc, v48
    v_bfm_b32 v96, v88, v89
    v_add_u32_dpp v91, v99, v99 row_shr:1 row_mask:0xf bank_mask:0xf bound_ctrl:1
    v_mad_u32_u24 v97, v97, 5, v2
    v_cmp_lt_u32 vcc, 16, v99
    v_add_u32_dpp v91, v91, v91 row_shr:2 row_mask:0xf bank_mask:0xf bound_ctrl:1
    v_sub_u32 v98, s38, v99
    v_lshrrev_b64 v[48:49], 16, v[48:49]
    v_add_u32_dpp v91, v91, v91 row_shr:4 row_mask:0xf bank_mask:0xf bound_ctrl:1
    v_lshrrev_b64 v[56:57], 16, v[56:57]
    s_mov_b32 s101, 0
    v_add_u32_dpp v91, v91, v91 row_shr:8 row_mask:0xf bank_mask:0xf bound_ctrl:1
    s_nop 1
    v_add_u32_dpp v91, v91, v91 row_bcast:15 row_mask:0xa bank_mask:0xf
    s_nop 1
    v_add_u32_dpp v91, v91, v91 row_bcast:31 row_mask:0xc bank_mask:0xf
    v_add_u32 v98, v98, v91
    v_readlane_b32 s37, v91, 63
    s_cbranch_vccnz L2_xo52
L2_xp52:
    buffer_load_dwordx4 v[112:115], v3, s[16:19], s40 offen offset:1024
    s_waitcnt lgkmcnt(0)
    v_cmpx_ne_u64 vcc, v[74:75], v[70:71]
    s_and_b64 s[82:83], vcc, s[80:81]
    s_cbranch_scc1 L2_c53
L2_d53:
    v_mov_b64 v[84:85], v[70:71]
    v_mov_b32 v7, v95
    v_mov_b64 v[86:87], v[74:75]
    s_mov_b64 exec, -1
    s_or_b64 s[80:81], s[80:81], vcc
    v_cmpx_ne_u64 vcc, v[72:73], v[68:69]
    s_and_b64 s[82:83], vcc, s[80:81]
    s_cbranch_scc1 L2_c54
L2_d54:
    v_mov_b64 v[84:85], v[68:69]
    v_mov_b32 v7, v94
    v_mov_b64 v[86:87], v[72:73]
    s_mov_b64 exec, -1
    s_or_b64 s[80:81], s[80:81], vcc
    ds_read_b64 v[70:71], v93 offset:65408
    s_and_b64 exec, s[84:85], s[80:81]
    v_mfma_f32_4x4x4_16b_bf16 v[76:79], v[12:13], v[84:85], 0
    v_mov_b32 v92, v7
    s_andn2_b64 s[80:81], s[80:81], s[84:85]
    v_mfma_f32_4x4x4_16b_bf16 v[76:79], v[10:11], v[86:87], v[76:79]
    s_mov_b64 exec, -1
    ds_read_b64 v[68:69], v92 offset:65408
    v_and_b32 v46, 0x80000000, v27
    v_lshrrev_b32 v47, 14, v25
    v_bitop3_b32 v47, v47, v5, v46 bitop3:0xea
    ds_read_b64 v[106:107], v47
    v_bitop3_b32 v95, v25, v5, v46 bitop3:0xea
    v_and_b32 v46, 0x40000000, v27
    v_lshrrev_b32 v47, 14, v24
    v_bitop3_b32 v47, v47, v5, v46 bitop3:0xea
    ds_read_b64 v[104:105], v47
    v_bitop3_b32 v94, v24, v5, v46 bitop3:0xea
    s_waitcnt lgkmcnt(2)
    v_mfma_f32_4x4x4_16b_bf16 v[80:83], v[10:11], v[70:71], v[80:83]
    v_mfma_f32_4x4x4_16b_bf16 v[76:79], v[10:11], v[68:69], v[76:79]
    v_perm_b32 v15, v25, v26, s47
    v_bitop3_b32 v46, v25, 0.5, -0.5 bitop3:0xa8
    v_perm_b32 v14, v24, v26, s46
    v_bitop3_b32 v47, v24, 0.5, -0.5 bitop3:0xa8
    v_cvt_pk_bf16_f32 v80, v80, v81
    v_cvt_pk_bf16_f32 v81, v82, v83
    ds_wrxchg_rtn_b64 v[74:75], v93, v[80:81] offset:65408
    v_cvt_pk_bf16_f32 v76, v76, v77
    v_cvt_pk_bf16_f32 v77, v78, v79
    ds_wrxchg_rtn_b64 v[72:73], v92, v[76:77] offset:65408
    s_setprio 1
    s_waitcnt lgkmcnt(2)
    v_mfma_f32_4x4x4_16b_bf16 v[80:83], v[8:9], v[106:107], 0
    v_mfma_f32_4x4x4_16b_bf16 v[76:79], v[8:9], v[104:105], 0
    v_bitop3_b32 v15, v6, v15, v46 bitop3:0xca
    v_bitop3_b32 v14, v6, v14, v47 bitop3:0xca
    s_nop 1
    v_pk_mul_f32 v[80:81], v[80:81], v[14:15] op_sel:[0,1] op_sel_hi:[1,1]
    v_pk_mul_f32 v[82:83], v[82:83], v[14:15] op_sel:[0,1] op_sel_hi:[1,1]
    v_pk_mul_f32 v[76:77], v[76:77], v[14:15] op_sel:[0,0] op_sel_hi:[1,0]
    v_pk_mul_f32 v[78:79], v[78:79], v[14:15] op_sel:[0,0] op_sel_hi:[1,0]
    v_and_b32 v47, 0x0fffffff, v41
    v_mov_b32 v27, v41
    buffer_load_dwordx2 v[22:23], v47, s[8:11], 0 offen
    buffer_load_dwordx3 v[24:26], v47, s[8:11], 0 offen offset:8
    s_waitcnt lgkmcnt(0)
    v_cmpx_ne_u64 vcc, v[74:75], v[70:71]
    s_and_b64 s[82:83], vcc, s[80:81]
    s_cbranch_scc1 L2_c55
L2_d55:
    v_mov_b64 v[84:85], v[70:71]
    v_mov_b32 v7, v93
    v_mov_b64 v[86:87], v[74:75]
    s_mov_b64 exec, -1
    s_or_b64 s[80:81], s[80:81], vcc
    v_cmpx_ne_u64 vcc, v[72:73], v[68:69]
    s_and_b64 s[82:83], vcc, s[80:81]
    s_cbranch_scc1 L2_c56
L2_d56:
    v_mov_b64 v[84:85], v[68:69]
    v_mov_b32 v7, v92
    v_mov_b64 v[86:87], v[72:73]
    s_mov_b64 exec, -1
    s_or_b64 s[80:81], s[80:81], vcc
    ds_read_b64 v[70:71], v95 offset:65408
    ds_read_b64 v[68:69], v94 offset:65408
    s_waitcnt vmcnt(11)
    v_and_b32 v46, 0x20000000, v33
    v_lshrrev_b32 v47, 14, v29
    v_bitop3_b32 v47, v47, v5, v46 bitop3:0xea
    ds_read_b64 v[102:103], v47
    v_bitop3_b32 v93, v29, v5, v46 bitop3:0xea
    v_and_b32 v46, 0x10000000, v33
    v_lshrrev_b32 v47, 14, v28
    v_bitop3_b32 v47, v47, v5, v46 bitop3:0xea
    ds_read_b64 v[100:101], v47
    v_bitop3_b32 v92, v28, v5, v46 bitop3:0xea
    s_waitcnt lgkmcnt(2)
    v_mfma_f32_4x4x4_16b_bf16 v[80:83], v[10:11], v[70:71], v[80:83]
    v_mfma_f32_4x4x4_16b_bf16 v[76:79], v[10:11], v[68:69], v[76:79]
    v_perm_b32 v15, v29, v32, s45
    v_bitop3_b32 v46, v29, 0.5, -0.5 bitop3:0xa8
    v_perm_b32 v14, v28, v32, s44
    v_bitop3_b32 v47, v28, 0.5, -0.5 bitop3:0xa8
    v_cvt_pk_bf16_f32 v80, v80, v81
    v_cvt_pk_bf16_f32 v81, v82, v83
    ds_wrxchg_rtn_b64 v[74:75], v95, v[80:81] offset:65408
    v_cvt_pk_bf16_f32 v76, v76, v77
    v_cvt_pk_bf16_f32 v77, v78, v79
    ds_wrxchg_rtn_b64 v[72:73], v94, v[76:77] offset:65408
    s_waitcnt lgkmcnt(2)
    v_mfma_f32_4x4x4_16b_bf16 v[80:83], v[8:9], v[102:103], 0
    v_mfma_f32_4x4x4_16b_bf16 v[76:79], v[8:9], v[100:101], 0
    v_bitop3_b32 v15, v6, v15, v46 bitop3:0xca
    v_bitop3_b32 v14, v6, v14, v47 bitop3:0xca
    v_cmp_lt_u32 s[84:85], v5, v92
    s_nop 0
    v_pk_mul_f32 v[80:81], v[80:81], v[14:15] op_sel:[0,1] op_sel_hi:[1,1]
    v_pk_mul_f32 v[82:83], v[82:83], v[14:15] op_sel:[0,1] op_sel_hi:[1,1]
    v_pk_mul_f32 v[76:77], v[76:77], v[14:15] op_sel:[0,0] op_sel_hi:[1,0]
    v_pk_mul_f32 v[78:79], v[78:79], v[14:15] op_sel:[0,0] op_sel_hi:[1,0]
    s_waitcnt lgkmcnt(0)
    v_cmpx_ne_u64 vcc, v[74:75], v[70:71]
    s_and_b64 s[82:83], vcc, s[80:81]
    s_cbranch_scc1 L2_c57
L2_d57:
    v_mov_b64 v[84:85], v[70:71]
    v_mov_b32 v7, v95
    v_mov_b64 v[86:87], v[74:75]
    s_mov_b64 exec, -1
    s_or_b64 s[80:81], s[80:81], vcc
    v_cmpx_ne_u64 vcc, v[72:73], v[68:69]
    s_and_b64 s[82:83], vcc, s[80:81]
    s_cbranch_scc1 L2_c58
L2_d58:
    v_mov_b64 v[84:85], v[68:69]
    v_mov_b32 v7, v94
    v_mov_b64 v[86:87], v[72:73]
    s_mov_b64 exec, -1
    s_or_b64 s[80:81], s[80:81], vcc
    ds_read_b64 v[70:71], v93 offset:65408
    s_and_b64 exec, s[84:85], s[80:81]
    v_mfma_f32_4x4x4_16b_bf16 v[76:79], v[12:13], v[84:85], 0
    v_mov_b32 v92, v7
    s_andn2_b64 s[80:81], s[80:81], s[84:85]
    v_mfma_f32_4x4x4_16b_bf16 v[76:79], v[10:11], v[86:87], v[76:79]
    s_mov_b64 exec, -1
    ds_read_b64 v[68:69], v92 offset:65408
    v_and_b32 v46, 0x80000000, v33
    v_lshrrev_b32 v47, 14, v31
    v_bitop3_b32 v47, v47, v5, v46 bitop3:0xea
    ds_read_b64 v[106:107], v47
    v_bitop3_b32 v95, v31, v5, v46 bitop3:0xea
    v_and_b32 v46, 0x40000000, v33
    v_lshrrev_b32 v47, 14, v30
    v_bitop3_b32 v47, v47, v5, v46 bitop3:0xea
    ds_read_b64 v[104:105], v47
    v_bitop3_b32 v94, v30, v5, v46 bitop3:0xea
    s_waitcnt lgkmcnt(2)
    v_mfma_f32_4x4x4_16b_bf16 v[80:83], v[10:11], v[70:71], v[80:83]
    v_mfma_f32_4x4x4_16b_bf16 v[76:79], v[10:11], v[68:69], v[76:79]
    v_perm_b32 v15, v31, v32, s47
    v_bitop3_b32 v46, v31, 0.5, -0.5 bitop3:0xa8
    v_perm_b32 v14, v30, v32, s46
    v_bitop3_b32 v47, v30, 0.5, -0.5 bitop3:0xa8
    v_cvt_pk_bf16_f32 v80, v80, v81
    v_cvt_pk_bf16_f32 v81, v82, v83
    ds_wrxchg_rtn_b64 v[74:75], v93, v[80:81] offset:65408
    v_cvt_pk_bf16_f32 v76, v76, v77
    v_cvt_pk_bf16_f32 v77, v78, v79
    ds_wrxchg_rtn_b64 v[72:73], v92, v[76:77] offset:65408
    s_setprio 0
    s_waitcnt lgkmcnt(2)
    v_mfma_f32_4x4x4_16b_bf16 v[80:83], v[8:9], v[106:107], 0
    v_mfma_f32_4x4x4_16b_bf16 v[76:79], v[8:9], v[104:105], 0
    v_bitop3_b32 v15, v6, v15, v46 bitop3:0xca
    v_bitop3_b32 v14, v6, v14, v47 bitop3:0xca
    s_nop 1
    v_pk_mul_f32 v[80:81], v[80:81], v[14:15] op_sel:[0,1] op_sel_hi:[1,1]
    v_pk_mul_f32 v[82:83], v[82:83], v[14:15] op_sel:[0,1] op_sel_hi:[1,1]
    v_pk_mul_f32 v[76:77], v[76:77], v[14:15] op_sel:[0,0] op_sel_hi:[1,0]
    v_pk_mul_f32 v[78:79], v[78:79], v[14:15] op_sel:[0,0] op_sel_hi:[1,0]
    s_add_u32 s40, s40, 0xfff24000
    v_and_b32 v47, 0x0fffffff, v42
    v_mov_b32 v33, v42
    buffer_load_dwordx2 v[28:29], v47, s[8:11], 0 offen
    buffer_load_dwordx3 v[30:32], v47, s[8:11], 0 offen offset:8
    s_waitcnt lgkmcnt(0)
    v_cmpx_ne_u64 vcc, v[74:75], v[70:71]
    s_and_b64 s[82:83], vcc, s[80:81]
    s_cbranch_scc1 L2_c59
L2_d59:
    v_mov_b64 v[84:85], v[70:71]
    v_mov_b32 v7, v93
    v_mov_b64 v[86:87], v[74:75]
    s_mov_b64 exec, -1
    s_or_b64 s[80:81], s[80:81], vcc
    v_cmpx_ne_u64 vcc, v[72:73], v[68:69]
    s_and_b64 s[82:83], vcc, s[80:81]
    s_cbranch_scc1 L2_c60
L2_d60:
    v_mov_b64 v[84:85], v[68:69]
    v_mov_b32 v7, v92
    v_mov_b64 v[86:87], v[72:73]
    s_mov_b64 exec, -1
    s_or_b64 s[80:81], s[80:81], vcc
    ds_read_b64 v[70:71], v95 offset:65408
    ds_read_b64 v[68:69], v94 offset:65408
    s_waitcnt vmcnt(8)
    v_and_b32 v46, 0x20000000, v39
    v_lshrrev_b32 v47, 14, v35
    v_bitop3_b32 v47, v47, v5, v46 bitop3:0xea
    ds_read_b64 v[102:103], v47
    v_bitop3_b32 v93, v35, v5, v46 bitop3:0xea
    v_and_b32 v46, 0x10000000, v39
    v_lshrrev_b32 v47, 14, v34
    v_bitop3_b32 v47, v47, v5, v46 bitop3:0xea
    ds_read_b64 v[100:101], v47
    v_bitop3_b32 v92, v34, v5, v46 bitop3:0xea
    v_and_b32 v46, 0x80000000, v39
    v_lshrrev_b32 v47, 14, v37
    v_bitop3_b32 v47, v47, v5, v46 bitop3:0xea
    ds_read_b64 v[106:107], v47
    v_and_b32 v46, 0x40000000, v39
    v_lshrrev_b32 v47, 14, v36
    v_bitop3_b32 v47, v47, v5, v46 bitop3:0xea
    ds_read_b64 v[104:105], v47
    s_waitcnt lgkmcnt(4)
    v_mfma_f32_4x4x4_16b_bf16 v[80:83], v[10:11], v[70:71], v[80:83]
    v_mfma_f32_4x4x4_16b_bf16 v[76:79], v[10:11], v[68:69], v[76:79]
    v_perm_b32 v15, v35, v38, s45
    v_bitop3_b32 v46, v35, 0.5, -0.5 bitop3:0xa8
    v_perm_b32 v14, v34, v38, s44
    v_bitop3_b32 v47, v34, 0.5, -0.5 bitop3:0xa8
    v_cvt_pk_bf16_f32 v80, v80, v81
    v_cvt_pk_bf16_f32 v81, v82, v83
    ds_wrxchg_rtn_b64 v[74:75], v95, v[80:81] offset:65408
    v_cvt_pk_bf16_f32 v76, v76, v77
    v_cvt_pk_bf16_f32 v77, v78, v79
    ds_wrxchg_rtn_b64 v[72:73], v94, v[76:77] offset:65408
    s_waitcnt lgkmcnt(2)
    s_barrier
    s_setprio 3
    s_mov_b32 m0, s100
    s_nop 0
    ds_write_addtid_b32 v116 offset:32768
    ds_write_addtid_b32 v117 offset:33024
    ds_write_addtid_b32 v118 offset:33280
    ds_write_addtid_b32 v119 offset:33536
    buffer_load_dwordx4 v[116:119], v3, s[16:19], s40 offen offset:2048
    ds_write_addtid_b32 v120 offset:33792
    ds_write_addtid_b32 v121 offset:34048
    ds_write_addtid_b32 v122 offset:34304
    ds_write_addtid_b32 v123 offset:34560
    buffer_load_dwordx4 v[120:123], v3, s[16:19], s40 offen offset:3072
    v_mfma_f32_4x4x4_16b_bf16 v[80:83], v[8:9], v[102:103], 0
    v_mfma_f32_4x4x4_16b_bf16 v[76:79], v[8:9], v[100:101], 0
    v_bitop3_b32 v15, v6, v15, v46 bitop3:0xca
    v_bitop3_b32 v14, v6, v14, v47 bitop3:0xca
    v_cmp_lt_u32 s[84:85], v5, v92
    s_nop 0
    v_pk_mul_f32 v[80:81], v[80:81], v[14:15] op_sel:[0,1] op_sel_hi:[1,1]
    v_pk_mul_f32 v[82:83], v[82:83], v[14:15] op_sel:[0,1] op_sel_hi:[1,1]
    v_pk_mul_f32 v[76:77], v[76:77], v[14:15] op_sel:[0,0] op_sel_hi:[1,0]
    v_pk_mul_f32 v[78:79], v[78:79], v[14:15] op_sel:[0,0] op_sel_hi:[1,0]
    v_mov_b32 v44, v43
    s_cmp_gt_u32 s37, 1024
    s_cbranch_scc1 L2_xs61
    s_cmp_lg_u32 s101, 0
    s_cbranch_scc1 L2_xa61
L2_xb61:
    v_lshlrev_b32 v89, 16, v96
    v_add_u32 v90, 60, v97
    v_bitop3_b32 v90, v89, v45, v90 bitop3:0x6a
    ds_write_b32 v98, v90 offset:12
    v_lshlrev_b32 v89, 20, v96
    v_add_u32 v90, 40, v97
    v_bitop3_b32 v90, v89, v45, v90 bitop3:0x6a
    ds_write_b32 v98, v90 offset:8
    v_lshlrev_b32 v89, 24, v96
    v_add_u32 v90, 20, v97
    v_bitop3_b32 v90, v89, v45, v90 bitop3:0x6a
    ds_write_b32 v98, v90 offset:4
    v_lshlrev_b32 v89, 28, v96
    v_bitop3_b32 v90, v89, v45, v97 bitop3:0x6a
    ds_write_b32 v98, v90 offset:0
    v_mov_b32_dpp v91, v64 quad_perm:[0,0,0,0] row_mask:0xf bank_mask:0xf
    v_and_b32 v89, 3, v91
    v_and_b32 v97, 0xfffc, v91
    v_sub_u16_dpp v88, v64, v91 quad_perm:[2,2,2,2] row_mask:0xf bank_mask:0xf
    v_mad_u32_u24 v97, v97, 5, v4
    v_add_u32 v99, v88, v89
    v_bfm_b32 v96, v88, v89
    v_cmp_lt_u32 s[58:59], 16, v99
    v_lshlrev_b32 v89, v1, v96
    v_and_b32 v89, v45, v89
    v_cmp_ne_u32 vcc, 0, v89
    v_xor_b32 v90, v97, v89
    s_add_u32 s3, s37, s38
    v_mbcnt_lo_u32_b32 v98, vcc_lo, 0
    v_mbcnt_hi_u32_b32 v98, vcc_hi, v98
    s_bcnt1_i32_b64 s41, vcc
    v_lshl_add_u32 v98, v98, 2, s3
    s_mov_b64 exec, vcc
    ds_write_b32 v98, v90
    s_mov_b64 exec, -1
    s_lshl2_add_u32 s37, s41, s37
    s_cmp_lg_u64 s[58:59], 0
    s_cbranch_scc1 L2_xe61
L2_xr61:
    v_add_u32 v98, s37, v0
    v_mov_b32 v90, -1
    ds_write_b32 v98, v90
    ds_read2st64_b32 v[40:41], v0 offset0:0 offset1:1
    ds_read2st64_b32 v[42:43], v0 offset0:2 offset1:3
    s_sub_u32 s3, s37, 768
    s_cmp_gt_u32 s3, 256
    s_cbranch_scc1 L2_xf61
L2_xg61:
    s_setprio 2
    ds_write_addtid_b32 v124 offset:34816
    ds_write_addtid_b32 v125 offset:35072
    ds_write_addtid_b32 v126 offset:35328
    ds_write_addtid_b32 v127 offset:35584
    s_add_u32 s3, s40, 4096
    buffer_load_dwordx4 v[124:127], v3, s[16:19], s3 offen
    s_waitcnt lgkmcnt(14)
    v_cmpx_ne_u64 vcc, v[74:75], v[70:71]
    s_and_b64 s[82:83], vcc, s[80:81]
    s_cbranch_scc1 L2_c62
L2_d62:
    v_mov_b64 v[84:85], v[70:71]
    v_mov_b32 v7, v95
    v_mov_b64 v[86:87], v[74:75]
    s_mov_b64 exec, -1
    s_or_b64 s[80:81], s[80:81], vcc
    v_cmpx_ne_u64 vcc, v[72:73], v[68:69]
    s_and_b64 s[82:83], vcc, s[80:81]
    s_cbranch_scc1 L2_c63
L2_d63:
    v_mov_b64 v[84:85], v[68:69]
    v_mov_b32 v7, v94
    v_mov_b64 v[86:87], v[72:73]
    s_mov_b64 exec, -1
    s_or_b64 s[80:81], s[80:81], vcc
    ds_read_b64 v[70:71], v93 offset:65408
    s_and_b64 exec, s[84:85], s[80:81]
    v_mfma_f32_4x4x4_16b_bf16 v[76:79], v[12:13], v[84:85], 0
    v_mov_b32 v92, v7
    s_andn2_b64 s[80:81], s[80:81], s[84:85]
    v_mfma_f32_4x4x4_16b_bf16 v[76:79], v[10:11], v[86:87], v[76:79]
    s_mov_b64 exec, -1
    ds_read_b64 v[68:69], v92 offset:65408
    s_setprio 1
    s_waitcnt vmcnt(10)
    s_mov_b32 m0, s38
    s_nop 0
    ds_write_addtid_b32 v108 offset:0
    ds_write_addtid_b32 v109 offset:256
    ds_write_addtid_b32 v110 offset:512
    ds_write_addtid_b32 v111 offset:768
    s_waitcnt lgkmcnt(4)
    v_mfma_f32_4x4x4_16b_bf16 v[80:83], v[10:11], v[70:71], v[80:83]
    v_mfma_f32_4x4x4_16b_bf16 v[76:79], v[10:11], v[68:69], v[76:79]
    v_and_b32 v46, 0x40000000, v39
    v_bitop3_b32 v94, v36, v5, v46 bitop3:0xea
    v_and_b32 v46, 0x80000000, v39
    v_bitop3_b32 v95, v37, v5, v46 bitop3:0xea
    v_perm_b32 v15, v37, v38, s47
    v_bitop3_b32 v46, v37, 0.5, -0.5 bitop3:0xa8
    v_perm_b32 v14, v36, v38, s46
    v_bitop3_b32 v47, v36, 0.5, -0.5 bitop3:0xa8
    v_cvt_pk_bf16_f32 v80, v80, v81
    v_cvt_pk_bf16_f32 v81, v82, v83
    ds_wrxchg_rtn_b64 v[74:75], v93, v[80:81] offset:65408
    v_cvt_pk_bf16_f32 v76, v76, v77
    v_cvt_pk_bf16_f32 v77, v78, v79
    ds_wrxchg_rtn_b64 v[72:73], v92, v[76:77] offset:65408
    s_setprio 0
    s_waitcnt vmcnt(7)
    ds_write_addtid_b32 v112 offset:1024
    ds_write_addtid_b32 v113 offset:1280
    ds_write_addtid_b32 v114 offset:1536
    ds_write_addtid_b32 v115 offset:1792
    v_mfma_f32_4x4x4_16b_bf16 v[80:83], v[8:9], v[106:107], 0
    v_mfma_f32_4x4x4_16b_bf16 v[76:79], v[8:9], v[104:105], 0
    v_bitop3_b32 v15, v6, v15, v46 bitop3:0xca
    v_bitop3_b32 v14, v6, v14, v47 bitop3:0xca
    s_nop 1
    v_pk_mul_f32 v[80:81], v[80:81], v[14:15] op_sel:[0,1] op_sel_hi:[1,1]
    v_pk_mul_f32 v[82:83], v[82:83], v[14:15] op_sel:[0,1] op_sel_hi:[1,1]
    v_pk_mul_f32 v[76:77], v[76:77], v[14:15] op_sel:[0,0] op_sel_hi:[1,0]
    v_pk_mul_f32 v[78:79], v[78:79], v[14:15] op_sel:[0,0] op_sel_hi:[1,0]
    s_add_u32 s42, s42, 1
    s_waitcnt lgkmcnt(0)
    s_barrier
    s_bitcmp1_b32 s36, s42
    s_cbranch_scc1 L2_slow
L2_ret3:
    s_setprio 3
    v_and_b32 v47, 0x0fffffff, v44
    v_mov_b32 v39, v44
    buffer_load_dwordx2 v[34:35], v47, s[8:11], 0 offen
    buffer_load_dwordx3 v[36:38], v47, s[8:11], 0 offen offset:8
    v_cmpx_ne_u64 vcc, v[74:75], v[70:71]
    s_and_b64 s[82:83], vcc, s[80:81]
    s_cbranch_scc1 L2_c64
L2_d64:
    v_mov_b64 v[84:85], v[70:71]
    v_mov_b32 v7, v93
    v_mov_b64 v[86:87], v[74:75]
    s_mov_b64 exec, -1
    s_or_b64 s[80:81], s[80:81], vcc
    v_cmpx_ne_u64 vcc, v[72:73], v[68:69]
    s_and_b64 s[82:83], vcc, s[80:81]
    s_cbranch_scc1 L2_c65
L2_d65:
    v_mov_b64 v[84:85], v[68:69]
    v_mov_b32 v7, v92
    v_mov_b64 v[86:87], v[72:73]
    s_mov_b64 exec, -1
    s_or_b64 s[80:81], s[80:81], vcc
    ds_read_b64 v[70:71], v95 offset:65408
    ds_read_b64 v[68:69], v94 offset:65408
    v_and_b32 v46, 0x20000000, v21
    v_lshrrev_b32 v47, 14, v17
    v_bitop3_b32 v47, v47, v5, v46 bitop3:0xea
    ds_read_b64 v[102:103], v47
    v_bitop3_b32 v93, v17, v5, v46 bitop3:0xea
    v_and_b32 v46, 0x10000000, v21
    v_lshrrev_b32 v47, 14, v16
    v_bitop3_b32 v47, v47, v5, v46 bitop3:0xea
    ds_read_b64 v[100:101], v47
    v_bitop3_b32 v92, v16, v5, v46 bitop3:0xea
    s_waitcnt lgkmcnt(2)
    v_mfma_f32_4x4x4_16b_bf16 v[80:83], v[10:11], v[70:71], v[80:83]
    v_mfma_f32_4x4x4_16b_bf16 v[76:79], v[10:11], v[68:69], v[76:79]
    v_perm_b32 v15, v17, v20, s45
    v_bitop3_b32 v46, v17, 0.5, -0.5 bitop3:0xa8
    v_perm_b32 v14, v16, v20, s44
    v_bitop3_b32 v47, v16, 0.5, -0.5 bitop3:0xa8
    v_cvt_pk_bf16_f32 v80, v80, v81
    v_cvt_pk_bf16_f32 v81, v82, v83
    ds_wrxchg_rtn_b64 v[74:75], v95, v[80:81] offset:65408
    v_cvt_pk_bf16_f32 v76, v76, v77
    v_cvt_pk_bf16_f32 v77, v78, v79
    ds_wrxchg_rtn_b64 v[72:73], v94, v[76:77] offset:65408
    s_waitcnt lgkmcnt(2)
    v_mfma_f32_4x4x4_16b_bf16 v[80:83], v[8:9], v[102:103], 0
    v_mfma_f32_4x4x4_16b_bf16 v[76:79], v[8:9], v[100:101], 0
    v_bitop3_b32 v15, v6, v15, v46 bitop3:0xca
    v_bitop3_b32 v14, v6, v14, v47 bitop3:0xca
    v_cmp_lt_u32 s[84:85], v5, v92
    s_nop 0
    v_pk_mul_f32 v[80:81], v[80:81], v[14:15] op_sel:[0,1] op_sel_hi:[1,1]
    v_pk_mul_f32 v[82:83], v[82:83], v[14:15] op_sel:[0,1] op_sel_hi:[1,1]
    v_pk_mul_f32 v[76:77], v[76:77], v[14:15] op_sel:[0,0] op_sel_hi:[1,0]
    v_pk_mul_f32 v[78:79], v[78:79], v[14:15] op_sel:[0,0] op_sel_hi:[1,0]
    buffer_load_dwordx4 v[108:111], v3, s[16:19], s40 offen offset:0
    s_waitcnt lgkmcnt(0)
    v_cmpx_ne_u64 vcc, v[74:75], v[70:71]
    s_and_b64 s[82:83], vcc, s[80:81]
    s_cbranch_scc1 L2_c66
L2_d66:
    v_mov_b64 v[84:85], v[70:71]
    v_mov_b32 v7, v95
    v_mov_b64 v[86:87], v[74:75]
    s_mov_b64 exec, -1
    s_or_b64 s[80:81], s[80:81], vcc
    v_cmpx_ne_u64 vcc, v[72:73], v[68:69]
    s_and_b64 s[82:83], vcc, s[80:81]
    s_cbranch_scc1 L2_c67
L2_d67:
    v_mov_b64 v[84:85], v[68:69]
    v_mov_b32 v7, v94
    v_mov_b64 v[86:87], v[72:73]
    s_mov_b64 exec, -1
    s_or_b64 s[80:81], s[80:81], vcc
    ds_read_b64 v[70:71], v93 offset:65408
    s_and_b64 exec, s[84:85], s[80:81]
    v_mfma_f32_4x4x4_16b_bf16 v[76:79], v[12:13], v[84:85], 0
    v_mov_b32 v92, v7
    s_andn2_b64 s[80:81], s[80:81], s[84:85]
    v_mfma_f32_4x4x4_16b_bf16 v[76:79], v[10:11], v[86:87], v[76:79]
    s_mov_b64 exec, -1
    ds_read_b64 v[68:69], v92 offset:65408
    v_and_b32 v46, 0x80000000, v21
    v_lshrrev_b32 v47, 14, v19
    v_bitop3_b32 v47, v47, v5, v46 bitop3:0xea
    ds_read_b64 v[106:107], v47
    v_bitop3_b32 v95, v19, v5, v46 bitop3:0xea
    v_and_b32 v46, 0x40000000, v21
    v_lshrrev_b32 v47, 14, v18
    v_bitop3_b32 v47, v47, v5, v46 bitop3:0xea
    ds_read_b64 v[104:105], v47
    v_bitop3_b32 v94, v18, v5, v46 bitop3:0xea
    s_waitcnt lgkmcnt(2)
    v_mfma_f32_4x4x4_16b_bf16 v[80:83], v[10:11], v[70:71], v[80:83]
    v_mfma_f32_4x4x4_16b_bf16 v[76:79], v[10:11], v[68:69], v[76:79]
    v_perm_b32 v15, v19, v20, s47
    v_bitop3_b32 v46, v19, 0.5, -0.5 bitop3:0xa8
    v_perm_b32 v14, v18, v20, s46
    v_bitop3_b32 v47, v18, 0.5, -0.5 bitop3:0xa8
    v_cvt_pk_bf16_f32 v80, v80, v81
    v_cvt_pk_bf16_f32 v81, v82, v83
    ds_wrxchg_rtn_b64 v[74:75], v93, v[80:81] offset:65408
    v_cvt_pk_bf16_f32 v76, v76, v77
    v_cvt_pk_bf16_f32 v77, v78, v79
    ds_wrxchg_rtn_b64 v[72:73], v92, v[76:77] offset:65408
    s_setprio 2
    s_waitcnt lgkmcnt(2)
    v_mfma_f32_4x4x4_16b_bf16 v[80:83], v[8:9], v[106:107], 0
    v_mfma_f32_4x4x4_16b_bf16 v[76:79], v[8:9], v[104:105], 0
    v_bitop3_b32 v15, v6, v15, v46 bitop3:0xca
    v_bitop3_b32 v14, v6, v14, v47 bitop3:0xca
    s_nop 1
    v_pk_mul_f32 v[80:81], v[80:81], v[14:15] op_sel:[0,1] op_sel_hi:[1,1]
    v_pk_mul_f32 v[82:83], v[82:83], v[14:15] op_sel:[0,1] op_sel_hi:[1,1]
    v_pk_mul_f32 v[76:77], v[76:77], v[14:15] op_sel:[0,0] op_sel_hi:[1,0]
    v_pk_mul_f32 v[78:79], v[78:79], v[14:15] op_sel:[0,0] op_sel_hi:[1,0]
    v_and_b32 v47, 0x0fffffff, v40
    v_mov_b32 v21, v40
    buffer_load_dwordx2 v[16:17], v47, s[8:11], 0 offen
    buffer_load_dwordx3 v[18:20], v47, s[8:11], 0 offen offset:8
    s_waitcnt lgkmcnt(0)
    v_cmpx_ne_u64 vcc, v[74:75], v[70:71]
    s_and_b64 s[82:83], vcc, s[80:81]
    s_cbranch_scc1 L2_c68
L2_d68:
    v_mov_b64 v[84:85], v[70:71]
    v_mov_b32 v7, v93
    v_mov_b64 v[86:87], v[74:75]
    s_mov_b64 exec, -1
    s_or_b64 s[80:81], s[80:81], vcc
    v_cmpx_ne_u64 vcc, v[72:73], v[68:69]
    s_and_b64 s[82:83], vcc, s[80:81]
    s_cbranch_scc1 L2_c69
L2_d69:
    v_mov_b64 v[84:85], v[68:69]
    v_mov_b32 v7, v92
    v_mov_b64 v[86:87], v[72:73]
    s_mov_b64 exec, -1
    s_or_b64 s[80:81], s[80:81], vcc
    ds_read_b64 v[70:71], v95 offset:65408
    ds_read_b64 v[68:69], v94 offset:65408
    s_waitcnt vmcnt(10)
    v_and_b32 v46, 0x20000000, v27
    v_lshrrev_b32 v47, 14, v23
    v_bitop3_b32 v47, v47, v5, v46 bitop3:0xea
    ds_read_b64 v[102:103], v47
    v_bitop3_b32 v93, v23, v5, v46 bitop3:0xea
    v_and_b32 v46, 0x10000000, v27
    v_lshrrev_b32 v47, 14, v22
    v_bitop3_b32 v47, v47, v5, v46 bitop3:0xea
    ds_read_b64 v[100:101], v47
    v_bitop3_b32 v92, v22, v5, v46 bitop3:0xea
    s_waitcnt lgkmcnt(2)
    v_mfma_f32_4x4x4_16b_bf16 v[80:83], v[10:11], v[70:71], v[80:83]
    v_mfma_f32_4x4x4_16b_bf16 v[76:79], v[10:11], v[68:69], v[76:79]
    v_perm_b32 v15, v23, v26, s45
    v_bitop3_b32 v46, v23, 0.5, -0.5 bitop3:0xa8
    v_perm_b32 v14, v22, v26, s44
    v_bitop3_b32 v47, v22, 0.5, -0.5 bitop3:0xa8
    v_cvt_pk_bf16_f32 v80, v80, v81
    v_cvt_pk_bf16_f32 v81, v82, v83
    ds_wrxchg_rtn_b64 v[74:75], v95, v[80:81] offset:65408
    v_cvt_pk_bf16_f32 v76, v76, v77
    v_cvt_pk_bf16_f32 v77, v78, v79
    ds_wrxchg_rtn_b64 v[72:73], v94, v[76:77] offset:65408
    s_waitcnt lgkmcnt(2)
    v_mfma_f32_4x4x4_16b_bf16 v[80:83], v[8:9], v[102:103], 0
    v_mfma_f32_4x4x4_16b_bf16 v[76:79], v[8:9], v[100:101], 0
    v_bitop3_b32 v15, v6, v15, v46 bitop3:0xca
    v_bitop3_b32 v14, v6, v14, v47 bitop3:0xca
    v_cmp_lt_u32 s[84:85], v5, v92
    s_nop 0
    v_pk_mul_f32 v[80:81], v[80:81], v[14:15] op_sel:[0,1] op_sel_hi:[1,1]
    v_pk_mul_f32 v[82:83], v[82:83], v[14:15] op_sel:[0,1] op_sel_hi:[1,1]
    v_pk_mul_f32 v[76:77], v[76:77], v[14:15] op_sel:[0,0] op_sel_hi:[1,0]
    v_pk_mul_f32 v[78:79], v[78:79], v[14:15] op_sel:[0,0] op_sel_hi:[1,0]
    v_sub_u16 v88, v58, v50
    v_and_b32 v89, 3, v50
    v_add3_u32 v99, v88, v89, 3
    v_and_b32 v99, -4, v99
    v_max_u32 v99, 4, v99
    v_and_b32 v97, 0xfffc, v50
    v_bfm_b32 v96, v88, v89
    v_add_u32_dpp v91, v99, v99 row_shr:1 row_mask:0xf bank_mask:0xf bound_ctrl:1
    v_mad_u32_u24 v97, v97, 5, v2
    v_cmp_lt_u32 vcc, 16, v99
    v_add_u32_dpp v91, v91, v91 row_shr:2 row_mask:0xf bank_mask:0xf bound_ctrl:1
    v_sub_u32 v98, s38, v99
    v_lshrrev_b64 v[50:51], 16, v[50:51]
    v_add_u32_dpp v91, v91, v91 row_shr:4 row_mask:0xf bank_mask:0xf bound_ctrl:1
    v_lshrrev_b64 v[58:59], 16, v[58:59]
    s_mov_b32 s101, 0
    v_add_u32_dpp v91, v91, v91 row_shr:8 row_mask:0xf bank_mask:0xf bound_ctrl:1
    s_nop 1
    v_add_u32_dpp v91, v91, v91 row_bcast:15 row_mask:0xa bank_mask:0xf
    s_nop 1
    v_add_u32_dpp v91, v91, v91 row_bcast:31 row_mask:0xc bank_mask:0xf
    v_add_u32 v98, v98, v91
    v_readlane_b32 s37, v91, 63
    s_cbranch_vccnz L2_xo70
L2_xp70:
    buffer_load_dwordx4 v[112:115], v3, s[16:19], s40 offen offset:1024
    s_waitcnt lgkmcnt(0)
    v_cmpx_ne_u64 vcc, v[74:75], v[70:71]
    s_and_b64 s[82:83], vcc, s[80:81]
    s_cbranch_scc1 L2_c71
L2_d71:
    v_mov_b64 v[84:85], v[70:71]
    v_mov_b32 v7, v95
    v_mov_b64 v[86:87], v[74:75]
    s_mov_b64 exec, -1
    s_or_b64 s[80:81], s[80:81], vcc
    v_cmpx_ne_u64 vcc, v[72:73], v[68:69]
    s_and_b64 s[82:83], vcc, s[80:81]
    s_cbranch_scc1 L2_c72
L2_d72:
    v_mov_b64 v[84:85], v[68:69]
    v_mov_b32 v7, v94
    v_mov_b64 v[86:87], v[72:73]
    s_mov_b64 exec, -1
    s_or_b64 s[80:81], s[80:81], vcc
    ds_read_b64 v[70:71], v93 offset:65408
    s_and_b64 exec, s[84:85], s[80:81]
    v_mfma_f32_4x4x4_16b_bf16 v[76:79], v[12:13], v[84:85], 0
    v_mov_b32 v92, v7
    s_andn2_b64 s[80:81], s[80:81], s[84:85]
    v_mfma_f32_4x4x4_16b_bf16 v[76:79], v[10:11], v[86:87], v[76:79]
    s_mov_b64 exec, -1
    ds_read_b64 v[68:69], v92 offset:65408
    v_and_b32 v46, 0x80000000, v27
    v_lshrrev_b32 v47, 14, v25
    v_bitop3_b32 v47, v47, v5, v46 bitop3:0xea
    ds_read_b64 v[106:107], v47
    v_bitop3_b32 v95, v25, v5, v46 bitop3:0xea
    v_and_b32 v46, 0x40000000, v27
    v_lshrrev_b32 v47, 14, v24
    v_bitop3_b32 v47, v47, v5, v46 bitop3:0xea
    ds_read_b64 v[104:105], v47
    v_bitop3_b32 v94, v24, v5, v46 bitop3:0xea
    s_waitcnt lgkmcnt(2)
    v_mfma_f32_4x4x4_16b_bf16 v[80:83], v[10:11], v[70:71], v[80:83]
    v_mfma_f32_4x4x4_16b_bf16 v[76:79], v[10:11], v[68:69], v[76:79]
    v_perm_b32 v15, v25, v26, s47
    v_bitop3_b32 v46, v25, 0.5, -0.5 bitop3:0xa8
    v_perm_b32 v14, v24, v26, s46
    v_bitop3_b32 v47, v24, 0.5, -0.5 bitop3:0xa8
    v_cvt_pk_bf16_f32 v80, v80, v81
    v_cvt_pk_bf16_f32 v81, v82, v83
    ds_wrxchg_rtn_b64 v[74:75], v93, v[80:81] offset:65408
    v_cvt_pk_bf16_f32 v76, v76, v77
    v_cvt_pk_bf16_f32 v77, v78, v79
    ds_wrxchg_rtn_b64 v[72:73], v92, v[76:77] offset:65408
    s_setprio 1
    s_waitcnt lgkmcnt(2)
    v_mfma_f32_4x4x4_16b_bf16 v[80:83], v[8:9], v[106:107], 0
    v_mfma_f32_4x4x4_16b_bf16 v[76:79], v[8:9], v[104:105], 0
    v_bitop3_b32 v15, v6, v15, v46 bitop3:0xca
    v_bitop3_b32 v14, v6, v14, v47 bitop3:0xca
    s_nop 1
    v_pk_mul_f32 v[80:81], v[80:81], v[14:15] op_sel:[0,1] op_sel_hi:[1,1]
    v_pk_mul_f32 v[82:83], v[82:83], v[14:15] op_sel:[0,1] op_sel_hi:[1,1]
    v_pk_mul_f32 v[76:77], v[76:77], v[14:15] op_sel:[0,0] op_sel_hi:[1,0]
    v_pk_mul_f32 v[78:79], v[78:79], v[14:15] op_sel:[0,0] op_sel_hi:[1,0]
    v_and_b32 v47, 0x0fffffff, v41
    v_mov_b32 v27, v41
    buffer_load_dwordx2 v[22:23], v47, s[8:11], 0 offen
    buffer_load_dwordx3 v[24:26], v47, s[8:11], 0 offen offset:8
    s_waitcnt lgkmcnt(0)
    v_cmpx_ne_u64 vcc, v[74:75], v[70:71]
    s_and_b64 s[82:83], vcc, s[80:81]
    s_cbranch_scc1 L2_c73
L2_d73:
    v_mov_b64 v[84:85], v[70:71]
    v_mov_b32 v7, v93
    v_mov_b64 v[86:87], v[74:75]
    s_mov_b64 exec, -1
    s_or_b64 s[80:81], s[80:81], vcc
    v_cmpx_ne_u64 vcc, v[72:73], v[68:69]
    s_and_b64 s[82:83], vcc, s[80:81]
    s_cbranch_scc1 L2_c74
L2_d74:
    v_mov_b64 v[84:85], v[68:69]
    v_mov_b32 v7, v92
    v_mov_b64 v[86:87], v[72:73]
    s_mov_b64 exec, -1
    s_or_b64 s[80:81], s[80:81], vcc
    ds_read_b64 v[70:71], v95 offset:65408
    ds_read_b64 v[68:69], v94 offset:65408
    s_waitcnt vmcnt(11)
    v_and_b32 v46, 0x20000000, v33
    v_lshrrev_b32 v47, 14, v29
    v_bitop3_b32 v47, v47, v5, v46 bitop3:0xea
    ds_read_b64 v[102:103], v47
    v_bitop3_b32 v93, v29, v5, v46 bitop3:0xea
    v_and_b32 v46, 0x10000000, v33
    v_lshrrev_b32 v47, 14, v28
    v_bitop3_b32 v47, v47, v5, v46 bitop3:0xea
    ds_read_b64 v[100:101], v47
    v_bitop3_b32 v92, v28, v5, v46 bitop3:0xea
    s_waitcnt lgkmcnt(2)
    v_mfma_f32_4x4x4_16b_bf16 v[80:83], v[10:11], v[70:71], v[80:83]
    v_mfma_f32_4x4x4_16b_bf16 v[76:79], v[10:11], v[68:69], v[76:79]
    v_perm_b32 v15, v29, v32, s45
    v_bitop3_b32 v46, v29, 0.5, -0.5 bitop3:0xa8
    v_perm_b32 v14, v28, v32, s44
    v_bitop3_b32 v47, v28, 0.5, -0.5 bitop3:0xa8
    v_cvt_pk_bf16_f32 v80, v80, v81
    v_cvt_pk_bf16_f32 v81, v82, v83
    ds_wrxchg_rtn_b64 v[74:75], v95, v[80:81] offset:65408
    v_cvt_pk_bf16_f32 v76, v76, v77
    v_cvt_pk_bf16_f32 v77, v78, v79
    ds_wrxchg_rtn_b64 v[72:73], v94, v[76:77] offset:65408
    s_waitcnt lgkmcnt(2)
    v_mfma_f32_4x4x4_16b_bf16 v[80:83], v[8:9], v[102:103], 0
    v_mfma_f32_4x4x4_16b_bf16 v[76:79], v[8:9], v[100:101], 0
    v_bitop3_b32 v15, v6, v15, v46 bitop3:0xca
    v_bitop3_b32 v14, v6, v14, v47 bitop3:0xca
    v_cmp_lt_u32 s[84:85], v5, v92
    s_nop 0
    v_pk_mul_f32 v[80:81], v[80:81], v[14:15] op_sel:[0,1] op_sel_hi:[1,1]
    v_pk_mul_f32 v[82:83], v[82:83], v[14:15] op_sel:[0,1] op_sel_hi:[1,1]
    v_pk_mul_f32 v[76:77], v[76:77], v[14:15] op_sel:[0,0] op_sel_hi:[1,0]
    v_pk_mul_f32 v[78:79], v[78:79], v[14:15] op_sel:[0,0] op_sel_hi:[1,0]
    s_waitcnt lgkmcnt(0)
    v_cmpx_ne_u64 vcc, v[74:75], v[70:71]
    s_and_b64 s[82:83], vcc, s[80:81]
    s_cbranch_scc1 L2_c75
L2_d75:
    v_mov_b64 v[84:85], v[70:71]
    v_mov_b32 v7, v95
    v_mov_b64 v[86:87], v[74:75]
    s_mov_b64 exec, -1
    s_or_b64 s[80:81], s[80:81], vcc
    v_cmpx_ne_u64 vcc, v[72:73], v[68:69]
    s_and_b64 s[82:83], vcc, s[80:81]
    s_cbranch_scc1 L2_c76
L2_d76:
    v_mov_b64 v[84:85], v[68:69]
    v_mov_b32 v7, v94
    v_mov_b64 v[86:87], v[72:73]
    s_mov_b64 exec, -1
    s_or_b64 s[80:81], s[80:81], vcc
    ds_read_b64 v[70:71], v93 offset:65408
    s_and_b64 exec, s[84:85], s[80:81]
    v_mfma_f32_4x4x4_16b_bf16 v[76:79], v[12:13], v[84:85], 0
    v_mov_b32 v92, v7
    s_andn2_b64 s[80:81], s[80:81], s[84:85]
    v_mfma_f32_4x4x4_16b_bf16 v[76:79], v[10:11], v[86:87], v[76:79]
    s_mov_b64 exec, -1
    ds_read_b64 v[68:69], v92 offset:65408
    v_and_b32 v46, 0x80000000, v33
    v_lshrrev_b32 v47, 14, v31
    v_bitop3_b32 v47, v47, v5, v46 bitop3:0xea
    ds_read_b64 v[106:107], v47
    v_bitop3_b32 v95, v31, v5, v46 bitop3:0xea
    v_and_b32 v46, 0x40000000, v33
    v_lshrrev_b32 v47, 14, v30
    v_bitop3_b32 v47, v47, v5, v46 bitop3:0xea
    ds_read_b64 v[104:105], v47
    v_bitop3_b32 v94, v30, v5, v46 bitop3:0xea
    s_waitcnt lgkmcnt(2)
    v_mfma_f32_4x4x4_16b_bf16 v[80:83], v[10:11], v[70:71], v[80:83]
    v_mfma_f32_4x4x4_16b_bf16 v[76:79], v[10:11], v[68:69], v[76:79]
    v_perm_b32 v15, v31, v32, s47
    v_bitop3_b32 v46, v31, 0.5, -0.5 bitop3:0xa8
    v_perm_b32 v14, v30, v32, s46
    v_bitop3_b32 v47, v30, 0.5, -0.5 bitop3:0xa8
    v_cvt_pk_bf16_f32 v80, v80, v81
    v_cvt_pk_bf16_f32 v81, v82, v83
    ds_wrxchg_rtn_b64 v[74:75], v93, v[80:81] offset:65408
    v_cvt_pk_bf16_f32 v76, v76, v77
    v_cvt_pk_bf16_f32 v77, v78, v79
    ds_wrxchg_rtn_b64 v[72:73], v92, v[76:77] offset:65408
    s_setprio 0
    s_waitcnt lgkmcnt(2)
    v_mfma_f32_4x4x4_16b_bf16 v[80:83], v[8:9], v[106:107], 0
    v_mfma_f32_4x4x4_16b_bf16 v[76:79], v[8:9], v[104:105], 0
    v_bitop3_b32 v15, v6, v15, v46 bitop3:0xca
    v_bitop3_b32 v14, v6, v14, v47 bitop3:0xca
    s_nop 1
    v_pk_mul_f32 v[80:81], v[80:81], v[14:15] op_sel:[0,1] op_sel_hi:[1,1]
    v_pk_mul_f32 v[82:83], v[82:83], v[14:15] op_sel:[0,1] op_sel_hi:[1,1]
    v_pk_mul_f32 v[76:77], v[76:77], v[14:15] op_sel:[0,0] op_sel_hi:[1,0]
    v_pk_mul_f32 v[78:79], v[78:79], v[14:15] op_sel:[0,0] op_sel_hi:[1,0]
    s_add_u32 s40, s40, 0x50000
    v_and_b32 v47, 0x0fffffff, v42
    v_mov_b32 v33, v42
    buffer_load_dwordx2 v[28:29], v47, s[8:11], 0 offen
    buffer_load_dwordx3 v[30:32], v47, s[8:11], 0 offen offset:8
    s_waitcnt lgkmcnt(0)
    v_cmpx_ne_u64 vcc, v[74:75], v[70:71]
    s_and_b64 s[82:83], vcc, s[80:81]
    s_cbranch_scc1 L2_c77
L2_d77:
    v_mov_b64 v[84:85], v[70:71]
    v_mov_b32 v7, v93
    v_mov_b64 v[86:87], v[74:75]
    s_mov_b64 exec, -1
    s_or_b64 s[80:81], s[80:81], vcc
    v_cmpx_ne_u64 vcc, v[72:73], v[68:69]
    s_and_b64 s[82:83], vcc, s[80:81]
    s_cbranch_scc1 L2_c78
L2_d78:
    v_mov_b64 v[84:85], v[68:69]
    v_mov_b32 v7, v92
    v_mov_b64 v[86:87], v[72:73]
    s_mov_b64 exec, -1
    s_or_b64 s[80:81], s[80:81], vcc
    ds_read_b64 v[70:71], v95 offset:65408
    ds_read_b64 v[68:69], v94 offset:65408
    s_waitcnt vmcnt(8)
    v_and_b32 v46, 0x20000000, v39
    v_lshrrev_b32 v47, 14, v35
    v_bitop3_b32 v47, v47, v5, v46 bitop3:0xea
    ds_read_b64 v[102:103], v47
    v_bitop3_b32 v93, v35, v5, v46 bitop3:0xea
    v_and_b32 v46, 0x10000000, v39
    v_lshrrev_b32 v47, 14, v34
    v_bitop3_b32 v47, v47, v5, v46 bitop3:0xea
    ds_read_b64 v[100:101], v47
    v_bitop3_b32 v92, v34, v5, v46 bitop3:0xea
    v_and_b32 v46, 0x80000000, v39
    v_lshrrev_b32 v47, 14, v37
    v_bitop3_b32 v47, v47, v5, v46 bitop3:0xea
    ds_read_b64 v[106:107], v47
    v_and_b32 v46, 0x40000000, v39
    v_lshrrev_b32 v47, 14, v36
    v_bitop3_b32 v47, v47, v5, v46 bitop3:0xea
    ds_read_b64 v[104:105], v47
    s_waitcnt lgkmcnt(4)
    v_mfma_f32_4x4x4_16b_bf16 v[80:83], v[10:11], v[70:71], v[80:83]
    v_mfma_f32_4x4x4_16b_bf16 v[76:79], v[10:11], v[68:69], v[76:79]
    v_perm_b32 v15, v35, v38, s45
    v_bitop3_b32 v46, v35, 0.5, -0.5 bitop3:0xa8
    v_perm_b32 v14, v34, v38, s44
    v_bitop3_b32 v47, v34, 0.5, -0.5 bitop3:0xa8
    v_cvt_pk_bf16_f32 v80, v80, v81
    v_cvt_pk_bf16_f32 v81, v82, v83
    ds_wrxchg_rtn_b64 v[74:75], v95, v[80:81] offset:65408
    v_cvt_pk_bf16_f32 v76, v76, v77
    v_cvt_pk_bf16_f32 v77, v78, v79
    ds_wrxchg_rtn_b64 v[72:73], v94, v[76:77] offset:65408
    s_waitcnt lgkmcnt(2)
    s_barrier
    s_setprio 3
    s_mov_b32 m0, s100
    s_nop 0
    ds_write_addtid_b32 v116 offset:32768
    ds_write_addtid_b32 v117 offset:33024
    ds_write_addtid_b32 v118 offset:33280
    ds_write_addtid_b32 v119 offset:33536
    buffer_load_dwordx4 v[116:119], v3, s[16:19], s40 offen offset:2048
    ds_write_addtid_b32 v120 offset:33792
    ds_write_addtid_b32 v121 offset:34048
    ds_write_addtid_b32 v122 offset:34304
    ds_write_addtid_b32 v123 offset:34560
    buffer_load_dwordx4 v[120:123], v3, s[16:19], s40 offen offset:3072
    v_mfma_f32_4x4x4_16b_bf16 v[80:83], v[8:9], v[102:103], 0
    v_mfma_f32_4x4x4_16b_bf16 v[76:79], v[8:9], v[100:101], 0
    v_bitop3_b32 v15, v6, v15, v46 bitop3:0xca
    v_bitop3_b32 v14, v6, v14, v47 bitop3:0xca
    v_cmp_lt_u32 s[84:85], v5, v92
    s_nop 0
    v_pk_mul_f32 v[80:81], v[80:81], v[14:15] op_sel:[0,1] op_sel_hi:[1,1]
    v_pk_mul_f32 v[82:83], v[82:83], v[14:15] op_sel:[0,1] op_sel_hi:[1,1]
    v_pk_mul_f32 v[76:77], v[76:77], v[14:15] op_sel:[0,0] op_sel_hi:[1,0]
    v_pk_mul_f32 v[78:79], v[78:79], v[14:15] op_sel:[0,0] op_sel_hi:[1,0]
    v_mov_b32 v44, v43
    s_cmp_gt_u32 s37, 1024
    s_cbranch_scc1 L2_xs79
    s_cmp_lg_u32 s101, 0
    s_cbranch_scc1 L2_xa79
L2_xb79:
    v_lshlrev_b32 v89, 16, v96
    v_add_u32 v90, 60, v97
    v_bitop3_b32 v90, v89, v45, v90 bitop3:0x6a
    ds_write_b32 v98, v90 offset:12
    v_lshlrev_b32 v89, 20, v96
    v_add_u32 v90, 40, v97
    v_bitop3_b32 v90, v89, v45, v90 bitop3:0x6a
    ds_write_b32 v98, v90 offset:8
    v_lshlrev_b32 v89, 24, v96
    v_add_u32 v90, 20, v97
    v_bitop3_b32 v90, v89, v45, v90 bitop3:0x6a
    ds_write_b32 v98, v90 offset:4
    v_lshlrev_b32 v89, 28, v96
    v_bitop3_b32 v90, v89, v45, v97 bitop3:0x6a
    ds_write_b32 v98, v90 offset:0
    v_mov_b32_dpp v91, v66 quad_perm:[0,0,0,0] row_mask:0xf bank_mask:0xf
    v_and_b32 v89, 3, v91
    v_and_b32 v97, 0xfffc, v91
    v_sub_u16_dpp v88, v66, v91 quad_perm:[2,2,2,2] row_mask:0xf bank_mask:0xf
    v_mad_u32_u24 v97, v97, 5, v4
    v_add_u32 v99, v88, v89
    v_bfm_b32 v96, v88, v89
    v_cmp_lt_u32 s[58:59], 16, v99
    v_lshlrev_b32 v89, v1, v96
    v_and_b32 v89, v45, v89
    v_cmp_ne_u32 vcc, 0, v89
    v_xor_b32 v90, v97, v89
    s_add_u32 s3, s37, s38
    v_mbcnt_lo_u32_b32 v98, vcc_lo, 0
    v_mbcnt_hi_u32_b32 v98, vcc_hi, v98
    s_bcnt1_i32_b64 s41, vcc
    v_lshl_add_u32 v98, v98, 2, s3
    s_mov_b64 exec, vcc
    ds_write_b32 v98, v90
    s_mov_b64 exec, -1
    s_lshl2_add_u32 s37, s41, s37
    s_cmp_lg_u64 s[58:59], 0
    s_cbranch_scc1 L2_xe79
L2_xr79:
    v_add_u32 v98, s37, v0
    v_mov_b32 v90, -1
    ds_write_b32 v98, v90
    ds_read2st64_b32 v[40:41], v0 offset0:0 offset1:1
    ds_read2st64_b32 v[42:43], v0 offset0:2 offset1:3
    s_sub_u32 s3, s37, 768
    s_cmp_gt_u32 s3, 256
    s_cbranch_scc1 L2_xf79
L2_xg79:
    s_setprio 2
    ds_write_addtid_b32 v124 offset:34816
    ds_write_addtid_b32 v125 offset:35072
    ds_write_addtid_b32 v126 offset:35328
    ds_write_addtid_b32 v127 offset:35584
    s_add_u32 s3, s40, 4096
    buffer_load_dwordx4 v[124:127], v3, s[16:19], s3 offen
    s_waitcnt lgkmcnt(14)
    v_cmpx_ne_u64 vcc, v[74:75], v[70:71]
    s_and_b64 s[82:83], vcc, s[80:81]
    s_cbranch_scc1 L2_c80
L2_d80:
    v_mov_b64 v[84:85], v[70:71]
    v_mov_b32 v7, v95
    v_mov_b64 v[86:87], v[74:75]
    s_mov_b64 exec, -1
    s_or_b64 s[80:81], s[80:81], vcc
    v_cmpx_ne_u64 vcc, v[72:73], v[68:69]
    s_and_b64 s[82:83], vcc, s[80:81]
    s_cbranch_scc1 L2_c81
L2_d81:
    v_mov_b64 v[84:85], v[68:69]
    v_mov_b32 v7, v94
    v_mov_b64 v[86:87], v[72:73]
    s_mov_b64 exec, -1
    s_or_b64 s[80:81], s[80:81], vcc
    ds_read_b64 v[70:71], v93 offset:65408
    s_and_b64 exec, s[84:85], s[80:81]
    v_mfma_f32_4x4x4_16b_bf16 v[76:79], v[12:13], v[84:85], 0
    v_mov_b32 v92, v7
    s_andn2_b64 s[80:81], s[80:81], s[84:85]
    v_mfma_f32_4x4x4_16b_bf16 v[76:79], v[10:11], v[86:87], v[76:79]
    s_mov_b64 exec, -1
    ds_read_b64 v[68:69], v92 offset:65408
    s_setprio 1
    s_waitcnt vmcnt(10)
    s_mov_b32 m0, s38
    s_nop 0
    ds_write_addtid_b32 v108 offset:0
    ds_write_addtid_b32 v109 offset:256
    ds_write_addtid_b32 v110 offset:512
    ds_write_addtid_b32 v111 offset:768
    s_waitcnt lgkmcnt(4)
    v_mfma_f32_4x4x4_16b_bf16 v[80:83], v[10:11], v[70:71], v[80:83]
    v_mfma_f32_4x4x4_16b_bf16 v[76:79], v[10:11], v[68:69], v[76:79]
    v_and_b32 v46, 0x40000000, v39
    v_bitop3_b32 v94, v36, v5, v46 bitop3:0xea
    v_and_b32 v46, 0x80000000, v39
    v_bitop3_b32 v95, v37, v5, v46 bitop3:0xea
    v_perm_b32 v15, v37, v38, s47
    v_bitop3_b32 v46, v37, 0.5, -0.5 bitop3:0xa8
    v_perm_b32 v14, v36, v38, s46
    v_bitop3_b32 v47, v36, 0.5, -0.5 bitop3:0xa8
    v_cvt_pk_bf16_f32 v80, v80, v81
    v_cvt_pk_bf16_f32 v81, v82, v83
    ds_wrxchg_rtn_b64 v[74:75], v93, v[80:81] offset:65408
    v_cvt_pk_bf16_f32 v76, v76, v77
    v_cvt_pk_bf16_f32 v77, v78, v79
    ds_wrxchg_rtn_b64 v[72:73], v92, v[76:77] offset:65408
    s_setprio 0
    s_waitcnt vmcnt(7)
    ds_write_addtid_b32 v112 offset:1024
    ds_write_addtid_b32 v113 offset:1280
    ds_write_addtid_b32 v114 offset:1536
    ds_write_addtid_b32 v115 offset:1792
    v_mfma_f32_4x4x4_16b_bf16 v[80:83], v[8:9], v[106:107], 0
    v_mfma_f32_4x4x4_16b_bf16 v[76:79], v[8:9], v[104:105], 0
    v_bitop3_b32 v15, v6, v15, v46 bitop3:0xca
    v_bitop3_b32 v14, v6, v14, v47 bitop3:0xca
    s_nop 1
    v_pk_mul_f32 v[80:81], v[80:81], v[14:15] op_sel:[0,1] op_sel_hi:[1,1]
    v_pk_mul_f32 v[82:83], v[82:83], v[14:15] op_sel:[0,1] op_sel_hi:[1,1]
    v_pk_mul_f32 v[76:77], v[76:77], v[14:15] op_sel:[0,0] op_sel_hi:[1,0]
    v_pk_mul_f32 v[78:79], v[78:79], v[14:15] op_sel:[0,0] op_sel_hi:[1,0]
    s_add_u32 s42, s42, 1
    s_waitcnt lgkmcnt(0)
    s_barrier
    s_bitcmp1_b32 s36, s42
    s_cbranch_scc1 L2_slow
L2_ret4:
    s_setprio 3
    v_and_b32 v47, 0x0fffffff, v44
    v_mov_b32 v39, v44
    buffer_load_dwordx2 v[34:35], v47, s[8:11], 0 offen
    buffer_load_dwordx3 v[36:38], v47, s[8:11], 0 offen offset:8
    v_cmpx_ne_u64 vcc, v[74:75], v[70:71]
    s_and_b64 s[82:83], vcc, s[80:81]
    s_cbranch_scc1 L2_c82
L2_d82:
    v_mov_b64 v[84:85], v[70:71]
    v_mov_b32 v7, v93
    v_mov_b64 v[86:87], v[74:75]
    s_mov_b64 exec, -1
    s_or_b64 s[80:81], s[80:81], vcc
    v_cmpx_ne_u64 vcc, v[72:73], v[68:69]
    s_and_b64 s[82:83], vcc, s[80:81]
    s_cbranch_scc1 L2_c83
L2_d83:
    v_mov_b64 v[84:85], v[68:69]
    v_mov_b32 v7, v92
    v_mov_b64 v[86:87], v[72:73]
    s_mov_b64 exec, -1
    s_or_b64 s[80:81], s[80:81], vcc
    ds_read_b64 v[70:71], v95 offset:65408
    ds_read_b64 v[68:69], v94 offset:65408
    v_and_b32 v46, 0x20000000, v21
    v_lshrrev_b32 v47, 14, v17
    v_bitop3_b32 v47, v47, v5, v46 bitop3:0xea
    ds_read_b64 v[102:103], v47
    v_bitop3_b32 v93, v17, v5, v46 bitop3:0xea
    v_and_b32 v46, 0x10000000, v21
    v_lshrrev_b32 v47, 14, v16
    v_bitop3_b32 v47, v47, v5, v46 bitop3:0xea
    ds_read_b64 v[100:101], v47
    v_bitop3_b32 v92, v16, v5, v46 bitop3:0xea
    s_waitcnt lgkmcnt(2)
    v_mfma_f32_4x4x4_16b_bf16 v[80:83], v[10:11], v[70:71], v[80:83]
    v_mfma_f32_4x4x4_16b_bf16 v[76:79], v[10:11], v[68:69], v[76:79]
    v_perm_b32 v15, v17, v20, s45
    v_bitop3_b32 v46, v17, 0.5, -0.5 bitop3:0xa8
    v_perm_b32 v14, v16, v20, s44
    v_bitop3_b32 v47, v16, 0.5, -0.5 bitop3:0xa8
    v_cvt_pk_bf16_f32 v80, v80, v81
    v_cvt_pk_bf16_f32 v81, v82, v83
    ds_wrxchg_rtn_b64 v[74:75], v95, v[80:81] offset:65408
    v_cvt_pk_bf16_f32 v76, v76, v77
    v_cvt_pk_bf16_f32 v77, v78, v79
    ds_wrxchg_rtn_b64 v[72:73], v94, v[76:77] offset:65408
    s_waitcnt lgkmcnt(2)
    v_mfma_f32_4x4x4_16b_bf16 v[80:83], v[8:9], v[102:103], 0
    v_mfma_f32_4x4x4_16b_bf16 v[76:79], v[8:9], v[100:101], 0
    v_bitop3_b32 v15, v6, v15, v46 bitop3:0xca
    v_bitop3_b32 v14, v6, v14, v47 bitop3:0xca
    v_cmp_lt_u32 s[84:85], v5, v92
    s_nop 0
    v_pk_mul_f32 v[80:81], v[80:81], v[14:15] op_sel:[0,1] op_sel_hi:[1,1]
    v_pk_mul_f32 v[82:83], v[82:83], v[14:15] op_sel:[0,1] op_sel_hi:[1,1]
    v_pk_mul_f32 v[76:77], v[76:77], v[14:15] op_sel:[0,0] op_sel_hi:[1,0]
    v_pk_mul_f32 v[78:79], v[78:79], v[14:15] op_sel:[0,0] op_sel_hi:[1,0]
    buffer_load_dwordx4 v[108:111], v3, s[16:19], s40 offen offset:0
    s_waitcnt lgkmcnt(0)
    v_cmpx_ne_u64 vcc, v[74:75], v[70:71]
    s_and_b64 s[82:83], vcc, s[80:81]
    s_cbranch_scc1 L2_c84
L2_d84:
    v_mov_b64 v[84:85], v[70:71]
    v_mov_b32 v7, v95
    v_mov_b64 v[86:87], v[74:75]
    s_mov_b64 exec, -1
    s_or_b64 s[80:81], s[80:81], vcc
    v_cmpx_ne_u64 vcc, v[72:73], v[68:69]
    s_and_b64 s[82:83], vcc, s[80:81]
    s_cbranch_scc1 L2_c85
L2_d85:
    v_mov_b64 v[84:85], v[68:69]
    v_mov_b32 v7, v94
    v_mov_b64 v[86:87], v[72:73]
    s_mov_b64 exec, -1
    s_or_b64 s[80:81], s[80:81], vcc
    ds_read_b64 v[70:71], v93 offset:65408
    s_and_b64 exec, s[84:85], s[80:81]
    v_mfma_f32_4x4x4_16b_bf16 v[76:79], v[12:13], v[84:85], 0
    v_mov_b32 v92, v7
    s_andn2_b64 s[80:81], s[80:81], s[84:85]
    v_mfma_f32_4x4x4_16b_bf16 v[76:79], v[10:11], v[86:87], v[76:79]
    s_mov_b64 exec, -1
    ds_read_b64 v[68:69], v92 offset:65408
    v_and_b32 v46, 0x80000000, v21
    v_lshrrev_b32 v47, 14, v19
    v_bitop3_b32 v47, v47, v5, v46 bitop3:0xea
    ds_read_b64 v[106:107], v47
    v_bitop3_b32 v95, v19, v5, v46 bitop3:0xea
    v_and_b32 v46, 0x40000000, v21
    v_lshrrev_b32 v47, 14, v18
    v_bitop3_b32 v47, v47, v5, v46 bitop3:0xea
    ds_read_b64 v[104:105], v47
    v_bitop3_b32 v94, v18, v5, v46 bitop3:0xea
    s_waitcnt lgkmcnt(2)
    v_mfma_f32_4x4x4_16b_bf16 v[80:83], v[10:11], v[70:71], v[80:83]
    v_mfma_f32_4x4x4_16b_bf16 v[76:79], v[10:11], v[68:69], v[76:79]
    v_perm_b32 v15, v19, v20, s47
    v_bitop3_b32 v46, v19, 0.5, -0.5 bitop3:0xa8
    v_perm_b32 v14, v18, v20, s46
    v_bitop3_b32 v47, v18, 0.5, -0.5 bitop3:0xa8
    v_cvt_pk_bf16_f32 v80, v80, v81
    v_cvt_pk_bf16_f32 v81, v82, v83
    ds_wrxchg_rtn_b64 v[74:75], v93, v[80:81] offset:65408
    v_cvt_pk_bf16_f32 v76, v76, v77
    v_cvt_pk_bf16_f32 v77, v78, v79
    ds_wrxchg_rtn_b64 v[72:73], v92, v[76:77] offset:65408
    s_setprio 2
    s_waitcnt lgkmcnt(2)
    v_mfma_f32_4x4x4_16b_bf16 v[80:83], v[8:9], v[106:107], 0
    v_mfma_f32_4x4x4_16b_bf16 v[76:79], v[8:9], v[104:105], 0
    v_bitop3_b32 v15, v6, v15, v46 bitop3:0xca
    v_bitop3_b32 v14, v6, v14, v47 bitop3:0xca
    s_nop 1
    v_pk_mul_f32 v[80:81], v[80:81], v[14:15] op_sel:[0,1] op_sel_hi:[1,1]
    v_pk_mul_f32 v[82:83], v[82:83], v[14:15] op_sel:[0,1] op_sel_hi:[1,1]
    v_pk_mul_f32 v[76:77], v[76:77], v[14:15] op_sel:[0,0] op_sel_hi:[1,0]
    v_pk_mul_f32 v[78:79], v[78:79], v[14:15] op_sel:[0,0] op_sel_hi:[1,0]
    v_and_b32 v47, 0x0fffffff, v40
    v_mov_b32 v21, v40
    buffer_load_dwordx2 v[16:17], v47, s[8:11], 0 offen
    buffer_load_dwordx3 v[18:20], v47, s[8:11], 0 offen offset:8
    s_waitcnt lgkmcnt(0)
    v_cmpx_ne_u64 vcc, v[74:75], v[70:71]
    s_and_b64 s[82:83], vcc, s[80:81]
    s_cbranch_scc1 L2_c86
L2_d86:
    v_mov_b64 v[84:85], v[70:71]
    v_mov_b32 v7, v93
    v_mov_b64 v[86:87], v[74:75]
    s_mov_b64 exec, -1
    s_or_b64 s[80:81], s[80:81], vcc
    v_cmpx_ne_u64 vcc, v[72:73], v[68:69]
    s_and_b64 s[82:83], vcc, s[80:81]
    s_cbranch_scc1 L2_c87
L2_d87:
    v_mov_b64 v[84:85], v[68:69]
    v_mov_b32 v7, v92
    v_mov_b64 v[86:87], v[72:73]
    s_mov_b64 exec, -1
    s_or_b64 s[80:81], s[80:81], vcc
    ds_read_b64 v[70:71], v95 offset:65408
    ds_read_b64 v[68:69], v94 offset:65408
    s_waitcnt vmcnt(10)
    v_and_b32 v46, 0x20000000, v27
    v_lshrrev_b32 v47, 14, v23
    v_bitop3_b32 v47, v47, v5, v46 bitop3:0xea
    ds_read_b64 v[102:103], v47
    v_bitop3_b32 v93, v23, v5, v46 bitop3:0xea
    v_and_b32 v46, 0x10000000, v27
    v_lshrrev_b32 v47, 14, v22
    v_bitop3_b32 v47, v47, v5, v46 bitop3:0xea
    ds_read_b64 v[100:101], v47
    v_bitop3_b32 v92, v22, v5, v46 bitop3:0xea
    s_waitcnt lgkmcnt(2)
    v_mfma_f32_4x4x4_16b_bf16 v[80:83], v[10:11], v[70:71], v[80:83]
    v_mfma_f32_4x4x4_16b_bf16 v[76:79], v[10:11], v[68:69], v[76:79]
    v_perm_b32 v15, v23, v26, s45
    v_bitop3_b32 v46, v23, 0.5, -0.5 bitop3:0xa8
    v_perm_b32 v14, v22, v26, s44
    v_bitop3_b32 v47, v22, 0.5, -0.5 bitop3:0xa8
    v_cvt_pk_bf16_f32 v80, v80, v81
    v_cvt_pk_bf16_f32 v81, v82, v83
    ds_wrxchg_rtn_b64 v[74:75], v95, v[80:81] offset:65408
    v_cvt_pk_bf16_f32 v76, v76, v77
    v_cvt_pk_bf16_f32 v77, v78, v79
    ds_wrxchg_rtn_b64 v[72:73], v94, v[76:77] offset:65408
    s_waitcnt lgkmcnt(2)
    v_mfma_f32_4x4x4_16b_bf16 v[80:83], v[8:9], v[102:103], 0
    v_mfma_f32_4x4x4_16b_bf16 v[76:79], v[8:9], v[100:101], 0
    v_bitop3_b32 v15, v6, v15, v46 bitop3:0xca
    v_bitop3_b32 v14, v6, v14, v47 bitop3:0xca
    v_cmp_lt_u32 s[84:85], v5, v92
    s_nop 0
    v_pk_mul_f32 v[80:81], v[80:81], v[14:15] op_sel:[0,1] op_sel_hi:[1,1]
    v_pk_mul_f32 v[82:83], v[82:83], v[14:15] op_sel:[0,1] op_sel_hi:[1,1]
    v_pk_mul_f32 v[76:77], v[76:77], v[14:15] op_sel:[0,0] op_sel_hi:[1,0]
    v_pk_mul_f32 v[78:79], v[78:79], v[14:15] op_sel:[0,0] op_sel_hi:[1,0]
    v_sub_u16 v88, v60, v52
    v_and_b32 v89, 3, v52
    v_add3_u32 v99, v88, v89, 3
    v_and_b32 v99, -4, v99
    v_max_u32 v99, 4, v99
    v_and_b32 v97, 0xfffc, v52
    v_bfm_b32 v96, v88, v89
    v_add_u32_dpp v91, v99, v99 row_shr:1 row_mask:0xf bank_mask:0xf bound_ctrl:1
    v_mad_u32_u24 v97, v97, 5, v2
    v_cmp_lt_u32 vcc, 16, v99
    v_add_u32_dpp v91, v91, v91 row_shr:2 row_mask:0xf bank_mask:0xf bound_ctrl:1
    v_sub_u32 v98, s38, v99
    v_lshrrev_b64 v[52:53], 16, v[52:53]
    v_add_u32_dpp v91, v91, v91 row_shr:4 row_mask:0xf bank_mask:0xf bound_ctrl:1
    v_lshrrev_b64 v[60:61], 16, v[60:61]
    s_mov_b32 s101, 0
    v_add_u32_dpp v91, v91, v91 row_shr:8 row_mask:0xf bank_mask:0xf bound_ctrl:1
    s_nop 1
    v_add_u32_dpp v91, v91, v91 row_bcast:15 row_mask:0xa bank_mask:0xf
    s_nop 1
    v_add_u32_dpp v91, v91, v91 row_bcast:31 row_mask:0xc bank_mask:0xf
    v_add_u32 v98, v98, v91
    v_readlane_b32 s37, v91, 63
    s_cbranch_vccnz L2_xo88
L2_xp88:
    buffer_load_dwordx4 v[112:115], v3, s[16:19], s40 offen offset:1024
    s_waitcnt lgkmcnt(0)
    v_cmpx_ne_u64 vcc, v[74:75], v[70:71]
    s_and_b64 s[82:83], vcc, s[80:81]
    s_cbranch_scc1 L2_c89
L2_d89:
    v_mov_b64 v[84:85], v[70:71]
    v_mov_b32 v7, v95
    v_mov_b64 v[86:87], v[74:75]
    s_mov_b64 exec, -1
    s_or_b64 s[80:81], s[80:81], vcc
    v_cmpx_ne_u64 vcc, v[72:73], v[68:69]
    s_and_b64 s[82:83], vcc, s[80:81]
    s_cbranch_scc1 L2_c90
L2_d90:
    v_mov_b64 v[84:85], v[68:69]
    v_mov_b32 v7, v94
    v_mov_b64 v[86:87], v[72:73]
    s_mov_b64 exec, -1
    s_or_b64 s[80:81], s[80:81], vcc
    ds_read_b64 v[70:71], v93 offset:65408
    s_and_b64 exec, s[84:85], s[80:81]
    v_mfma_f32_4x4x4_16b_bf16 v[76:79], v[12:13], v[84:85], 0
    v_mov_b32 v92, v7
    s_andn2_b64 s[80:81], s[80:81], s[84:85]
    v_mfma_f32_4x4x4_16b_bf16 v[76:79], v[10:11], v[86:87], v[76:79]
    s_mov_b64 exec, -1
    ds_read_b64 v[68:69], v92 offset:65408
    v_and_b32 v46, 0x80000000, v27
    v_lshrrev_b32 v47, 14, v25
    v_bitop3_b32 v47, v47, v5, v46 bitop3:0xea
    ds_read_b64 v[106:107], v47
    v_bitop3_b32 v95, v25, v5, v46 bitop3:0xea
    v_and_b32 v46, 0x40000000, v27
    v_lshrrev_b32 v47, 14, v24
    v_bitop3_b32 v47, v47, v5, v46 bitop3:0xea
    ds_read_b64 v[104:105], v47
    v_bitop3_b32 v94, v24, v5, v46 bitop3:0xea
    s_waitcnt lgkmcnt(2)
    v_mfma_f32_4x4x4_16b_bf16 v[80:83], v[10:11], v[70:71], v[80:83]
    v_mfma_f32_4x4x4_16b_bf16 v[76:79], v[10:11], v[68:69], v[76:79]
    v_perm_b32 v15, v25, v26, s47
    v_bitop3_b32 v46, v25, 0.5, -0.5 bitop3:0xa8
    v_perm_b32 v14, v24, v26, s46
    v_bitop3_b32 v47, v24, 0.5, -0.5 bitop3:0xa8
    v_cvt_pk_bf16_f32 v80, v80, v81
    v_cvt_pk_bf16_f32 v81, v82, v83
    ds_wrxchg_rtn_b64 v[74:75], v93, v[80:81] offset:65408
    v_cvt_pk_bf16_f32 v76, v76, v77
    v_cvt_pk_bf16_f32 v77, v78, v79
    ds_wrxchg_rtn_b64 v[72:73], v92, v[76:77] offset:65408
    s_setprio 1
    s_waitcnt lgkmcnt(2)
    v_mfma_f32_4x4x4_16b_bf16 v[80:83], v[8:9], v[106:107], 0
    v_mfma_f32_4x4x4_16b_bf16 v[76:79], v[8:9], v[104:105], 0
    v_bitop3_b32 v15, v6, v15, v46 bitop3:0xca
    v_bitop3_b32 v14, v6, v14, v47 bitop3:0xca
    s_nop 1
    v_pk_mul_f32 v[80:81], v[80:81], v[14:15] op_sel:[0,1] op_sel_hi:[1,1]
    v_pk_mul_f32 v[82:83], v[82:83], v[14:15] op_sel:[0,1] op_sel_hi:[1,1]
    v_pk_mul_f32 v[76:77], v[76:77], v[14:15] op_sel:[0,0] op_sel_hi:[1,0]
    v_pk_mul_f32 v[78:79], v[78:79], v[14:15] op_sel:[0,0] op_sel_hi:[1,0]
    v_and_b32 v47, 0x0fffffff, v41
    v_mov_b32 v27, v41
    buffer_load_dwordx2 v[22:23], v47, s[8:11], 0 offen
    buffer_load_dwordx3 v[24:26], v47, s[8:11], 0 offen offset:8
    s_waitcnt lgkmcnt(0)
    v_cmpx_ne_u64 vcc, v[74:75], v[70:71]
    s_and_b64 s[82:83], vcc, s[80:81]
    s_cbranch_scc1 L2_c91
L2_d91:
    v_mov_b64 v[84:85], v[70:71]
    v_mov_b32 v7, v93
    v_mov_b64 v[86:87], v[74:75]
    s_mov_b64 exec, -1
    s_or_b64 s[80:81], s[80:81], vcc
    v_cmpx_ne_u64 vcc, v[72:73], v[68:69]
    s_and_b64 s[82:83], vcc, s[80:81]
    s_cbranch_scc1 L2_c92
L2_d92:
    v_mov_b64 v[84:85], v[68:69]
    v_mov_b32 v7, v92
    v_mov_b64 v[86:87], v[72:73]
    s_mov_b64 exec, -1
    s_or_b64 s[80:81], s[80:81], vcc
    ds_read_b64 v[70:71], v95 offset:65408
    ds_read_b64 v[68:69], v94 offset:65408
    s_waitcnt vmcnt(11)
    v_and_b32 v46, 0x20000000, v33
    v_lshrrev_b32 v47, 14, v29
    v_bitop3_b32 v47, v47, v5, v46 bitop3:0xea
    ds_read_b64 v[102:103], v47
    v_bitop3_b32 v93, v29, v5, v46 bitop3:0xea
    v_and_b32 v46, 0x10000000, v33
    v_lshrrev_b32 v47, 14, v28
    v_bitop3_b32 v47, v47, v5, v46 bitop3:0xea
    ds_read_b64 v[100:101], v47
    v_bitop3_b32 v92, v28, v5, v46 bitop3:0xea
    s_waitcnt lgkmcnt(2)
    v_mfma_f32_4x4x4_16b_bf16 v[80:83], v[10:11], v[70:71], v[80:83]
    v_mfma_f32_4x4x4_16b_bf16 v[76:79], v[10:11], v[68:69], v[76:79]
    v_perm_b32 v15, v29, v32, s45
    v_bitop3_b32 v46, v29, 0.5, -0.5 bitop3:0xa8
    v_perm_b32 v14, v28, v32, s44
    v_bitop3_b32 v47, v28, 0.5, -0.5 bitop3:0xa8
    v_cvt_pk_bf16_f32 v80, v80, v81
    v_cvt_pk_bf16_f32 v81, v82, v83
    ds_wrxchg_rtn_b64 v[74:75], v95, v[80:81] offset:65408
    v_cvt_pk_bf16_f32 v76, v76, v77
    v_cvt_pk_bf16_f32 v77, v78, v79
    ds_wrxchg_rtn_b64 v[72:73], v94, v[76:77] offset:65408
    s_waitcnt lgkmcnt(2)
    v_mfma_f32_4x4x4_16b_bf16 v[80:83], v[8:9], v[102:103], 0
    v_mfma_f32_4x4x4_16b_bf16 v[76:79], v[8:9], v[100:101], 0
    v_bitop3_b32 v15, v6, v15, v46 bitop3:0xca
    v_bitop3_b32 v14, v6, v14, v47 bitop3:0xca
    v_cmp_lt_u32 s[84:85], v5, v92
    s_nop 0
    v_pk_mul_f32 v[80:81], v[80:81], v[14:15] op_sel:[0,1] op_sel_hi:[1,1]
    v_pk_mul_f32 v[82:83], v[82:83], v[14:15] op_sel:[0,1] op_sel_hi:[1,1]
    v_pk_mul_f32 v[76:77], v[76:77], v[14:15] op_sel:[0,0] op_sel_hi:[1,0]
    v_pk_mul_f32 v[78:79], v[78:79], v[14:15] op_sel:[0,0] op_sel_hi:[1,0]
    s_waitcnt lgkmcnt(0)
    v_cmpx_ne_u64 vcc, v[74:75], v[70:71]
    s_and_b64 s[82:83], vcc, s[80:81]
    s_cbranch_scc1 L2_c93
L2_d93:
    v_mov_b64 v[84:85], v[70:71]
    v_mov_b32 v7, v95
    v_mov_b64 v[86:87], v[74:75]
    s_mov_b64 exec, -1
    s_or_b64 s[80:81], s[80:81], vcc
    v_cmpx_ne_u64 vcc, v[72:73], v[68:69]
    s_and_b64 s[82:83], vcc, s[80:81]
    s_cbranch_scc1 L2_c94
L2_d94:
    v_mov_b64 v[84:85], v[68:69]
    v_mov_b32 v7, v94
    v_mov_b64 v[86:87], v[72:73]
    s_mov_b64 exec, -1
    s_or_b64 s[80:81], s[80:81], vcc
    ds_read_b64 v[70:71], v93 offset:65408
    s_and_b64 exec, s[84:85], s[80:81]
    v_mfma_f32_4x4x4_16b_bf16 v[76:79], v[12:13], v[84:85], 0
    v_mov_b32 v92, v7
    s_andn2_b64 s[80:81], s[80:81], s[84:85]
    v_mfma_f32_4x4x4_16b_bf16 v[76:79], v[10:11], v[86:87], v[76:79]
    s_mov_b64 exec, -1
    ds_read_b64 v[68:69], v92 offset:65408
    v_and_b32 v46, 0x80000000, v33
    v_lshrrev_b32 v47, 14, v31
    v_bitop3_b32 v47, v47, v5, v46 bitop3:0xea
    ds_read_b64 v[106:107], v47
    v_bitop3_b32 v95, v31, v5, v46 bitop3:0xea
    v_and_b32 v46, 0x40000000, v33
    v_lshrrev_b32 v47, 14, v30
    v_bitop3_b32 v47, v47, v5, v46 bitop3:0xea
    ds_read_b64 v[104:105], v47
    v_bitop3_b32 v94, v30, v5, v46 bitop3:0xea
    s_waitcnt lgkmcnt(2)
    v_mfma_f32_4x4x4_16b_bf16 v[80:83], v[10:11], v[70:71], v[80:83]
    v_mfma_f32_4x4x4_16b_bf16 v[76:79], v[10:11], v[68:69], v[76:79]
    v_perm_b32 v15, v31, v32, s47
    v_bitop3_b32 v46, v31, 0.5, -0.5 bitop3:0xa8
    v_perm_b32 v14, v30, v32, s46
    v_bitop3_b32 v47, v30, 0.5, -0.5 bitop3:0xa8
    v_cvt_pk_bf16_f32 v80, v80, v81
    v_cvt_pk_bf16_f32 v81, v82, v83
    ds_wrxchg_rtn_b64 v[74:75], v93, v[80:81] offset:65408
    v_cvt_pk_bf16_f32 v76, v76, v77
    v_cvt_pk_bf16_f32 v77, v78, v79
    ds_wrxchg_rtn_b64 v[72:73], v92, v[76:77] offset:65408
    s_setprio 0
    s_waitcnt lgkmcnt(2)
    v_mfma_f32_4x4x4_16b_bf16 v[80:83], v[8:9], v[106:107], 0
    v_mfma_f32_4x4x4_16b_bf16 v[76:79], v[8:9], v[104:105], 0
    v_bitop3_b32 v15, v6, v15, v46 bitop3:0xca
    v_bitop3_b32 v14, v6, v14, v47 bitop3:0xca
    s_nop 1
    v_pk_mul_f32 v[80:81], v[80:81], v[14:15] op_sel:[0,1] op_sel_hi:[1,1]
    v_pk_mul_f32 v[82:83], v[82:83], v[14:15] op_sel:[0,1] op_sel_hi:[1,1]
    v_pk_mul_f32 v[76:77], v[76:77], v[14:15] op_sel:[0,0] op_sel_hi:[1,0]
    v_pk_mul_f32 v[78:79], v[78:79], v[14:15] op_sel:[0,0] op_sel_hi:[1,0]
    s_add_u32 s40, s40, 0x50000
    v_and_b32 v47, 0x0fffffff, v42
    v_mov_b32 v33, v42
    buffer_load_dwordx2 v[28:29], v47, s[8:11], 0 offen
    buffer_load_dwordx3 v[30:32], v47, s[8:11], 0 offen offset:8
    s_waitcnt lgkmcnt(0)
    v_cmpx_ne_u64 vcc, v[74:75], v[70:71]
    s_and_b64 s[82:83], vcc, s[80:81]
    s_cbranch_scc1 L2_c95
L2_d95:
    v_mov_b64 v[84:85], v[70:71]
    v_mov_b32 v7, v93
    v_mov_b64 v[86:87], v[74:75]
    s_mov_b64 exec, -1
    s_or_b64 s[80:81], s[80:81], vcc
    v_cmpx_ne_u64 vcc, v[72:73], v[68:69]
    s_and_b64 s[82:83], vcc, s[80:81]
    s_cbranch_scc1 L2_c96
L2_d96:
    v_mov_b64 v[84:85], v[68:69]
    v_mov_b32 v7, v92
    v_mov_b64 v[86:87], v[72:73]
    s_mov_b64 exec, -1
    s_or_b64 s[80:81], s[80:81], vcc
    ds_read_b64 v[70:71], v95 offset:65408
    ds_read_b64 v[68:69], v94 offset:65408
    s_waitcnt vmcnt(8)
    v_and_b32 v46, 0x20000000, v39
    v_lshrrev_b32 v47, 14, v35
    v_bitop3_b32 v47, v47, v5, v46 bitop3:0xea
    ds_read_b64 v[102:103], v47
    v_bitop3_b32 v93, v35, v5, v46 bitop3:0xea
    v_and_b32 v46, 0x10000000, v39
    v_lshrrev_b32 v47, 14, v34
    v_bitop3_b32 v47, v47, v5, v46 bitop3:0xea
    ds_read_b64 v[100:101], v47
    v_bitop3_b32 v92, v34, v5, v46 bitop3:0xea
    v_and_b32 v46, 0x80000000, v39
    v_lshrrev_b32 v47, 14, v37
    v_bitop3_b32 v47, v47, v5, v46 bitop3:0xea
    ds_read_b64 v[106:107], v47
    v_and_b32 v46, 0x40000000, v39
    v_lshrrev_b32 v47, 14, v36
    v_bitop3_b32 v47, v47, v5, v46 bitop3:0xea
    ds_read_b64 v[104:105], v47
    s_waitcnt lgkmcnt(4)
    v_mfma_f32_4x4x4_16b_bf16 v[80:83], v[10:11], v[70:71], v[80:83]
    v_mfma_f32_4x4x4_16b_bf16 v[76:79], v[10:11], v[68:69], v[76:79]
    v_perm_b32 v15, v35, v38, s45
    v_bitop3_b32 v46, v35, 0.5, -0.5 bitop3:0xa8
    v_perm_b32 v14, v34, v38, s44
    v_bitop3_b32 v47, v34, 0.5, -0.5 bitop3:0xa8
    v_cvt_pk_bf16_f32 v80, v80, v81
    v_cvt_pk_bf16_f32 v81, v82, v83
    ds_wrxchg_rtn_b64 v[74:75], v95, v[80:81] offset:65408
    v_cvt_pk_bf16_f32 v76, v76, v77
    v_cvt_pk_bf16_f32 v77, v78, v79
    ds_wrxchg_rtn_b64 v[72:73], v94, v[76:77] offset:65408
    s_waitcnt lgkmcnt(2)
    s_barrier
    s_setprio 3
    s_mov_b32 m0, s100
    s_nop 0
    ds_write_addtid_b32 v116 offset:32768
    ds_write_addtid_b32 v117 offset:33024
    ds_write_addtid_b32 v118 offset:33280
    ds_write_addtid_b32 v119 offset:33536
    buffer_load_dwordx4 v[116:119], v3, s[16:19], s40 offen offset:2048
    ds_write_addtid_b32 v120 offset:33792
    ds_write_addtid_b32 v121 offset:34048
    ds_write_addtid_b32 v122 offset:34304
    ds_write_addtid_b32 v123 offset:34560
    buffer_load_dwordx4 v[120:123], v3, s[16:19], s40 offen offset:3072
    v_mfma_f32_4x4x4_16b_bf16 v[80:83], v[8:9], v[102:103], 0
    v_mfma_f32_4x4x4_16b_bf16 v[76:79], v[8:9], v[100:101], 0
    v_bitop3_b32 v15, v6, v15, v46 bitop3:0xca
    v_bitop3_b32 v14, v6, v14, v47 bitop3:0xca
    v_cmp_lt_u32 s[84:85], v5, v92
    s_nop 0
    v_pk_mul_f32 v[80:81], v[80:81], v[14:15] op_sel:[0,1] op_sel_hi:[1,1]
    v_pk_mul_f32 v[82:83], v[82:83], v[14:15] op_sel:[0,1] op_sel_hi:[1,1]
    v_pk_mul_f32 v[76:77], v[76:77], v[14:15] op_sel:[0,0] op_sel_hi:[1,0]
    v_pk_mul_f32 v[78:79], v[78:79], v[14:15] op_sel:[0,0] op_sel_hi:[1,0]
    v_mov_b32 v44, v43
    s_cmp_gt_u32 s37, 1024
    s_cbranch_scc1 L2_xs97
    s_cmp_lg_u32 s101, 0
    s_cbranch_scc1 L2_xa97
L2_xb97:
    v_lshlrev_b32 v89, 16, v96
    v_add_u32 v90, 60, v97
    v_bitop3_b32 v90, v89, v45, v90 bitop3:0x6a
    ds_write_b32 v98, v90 offset:12
    v_lshlrev_b32 v89, 20, v96
    v_add_u32 v90, 40, v97
    v_bitop3_b32 v90, v89, v45, v90 bitop3:0x6a
    ds_write_b32 v98, v90 offset:8
    v_lshlrev_b32 v89, 24, v96
    v_add_u32 v90, 20, v97
    v_bitop3_b32 v90, v89, v45, v90 bitop3:0x6a
    ds_write_b32 v98, v90 offset:4
    v_lshlrev_b32 v89, 28, v96
    v_bitop3_b32 v90, v89, v45, v97 bitop3:0x6a
    ds_write_b32 v98, v90 offset:0
    v_mov_b32_dpp v91, v64 quad_perm:[1,1,1,1] row_mask:0xf bank_mask:0xf
    v_and_b32 v89, 3, v91
    v_and_b32 v97, 0xfffc, v91
    v_sub_u16_dpp v88, v64, v91 quad_perm:[3,3,3,3] row_mask:0xf bank_mask:0xf
    v_mad_u32_u24 v97, v97, 5, v4
    v_add_u32 v99, v88, v89
    v_bfm_b32 v96, v88, v89
    v_cmp_lt_u32 s[58:59], 16, v99
    v_lshlrev_b32 v89, v1, v96
    v_and_b32 v89, v45, v89
    v_cmp_ne_u32 vcc, 0, v89
    v_xor_b32 v90, v97, v89
    s_add_u32 s3, s37, s38
    v_mbcnt_lo_u32_b32 v98, vcc_lo, 0
    v_mbcnt_hi_u32_b32 v98, vcc_hi, v98
    s_bcnt1_i32_b64 s41, vcc
    v_lshl_add_u32 v98, v98, 2, s3
    s_mov_b64 exec, vcc
    ds_write_b32 v98, v90
    s_mov_b64 exec, -1
    s_lshl2_add_u32 s37, s41, s37
    s_cmp_lg_u64 s[58:59], 0
    s_cbranch_scc1 L2_xe97
L2_xr97:
    v_add_u32 v98, s37, v0
    v_mov_b32 v90, -1
    ds_write_b32 v98, v90
    ds_read2st64_b32 v[40:41], v0 offset0:0 offset1:1
    ds_read2st64_b32 v[42:43], v0 offset0:2 offset1:3
    s_sub_u32 s3, s37, 768
    s_cmp_gt_u32 s3, 256
    s_cbranch_scc1 L2_xf97
L2_xg97:
    s_setprio 2
    ds_write_addtid_b32 v124 offset:34816
    ds_write_addtid_b32 v125 offset:35072
    ds_write_addtid_b32 v126 offset:35328
    ds_write_addtid_b32 v127 offset:35584
    s_add_u32 s3, s40, 4096
    buffer_load_dwordx4 v[124:127], v3, s[16:19], s3 offen
    s_waitcnt lgkmcnt(14)
    v_cmpx_ne_u64 vcc, v[74:75], v[70:71]
    s_and_b64 s[82:83], vcc, s[80:81]
    s_cbranch_scc1 L2_c98
L2_d98:
    v_mov_b64 v[84:85], v[70:71]
    v_mov_b32 v7, v95
    v_mov_b64 v[86:87], v[74:75]
    s_mov_b64 exec, -1
    s_or_b64 s[80:81], s[80:81], vcc
    v_cmpx_ne_u64 vcc, v[72:73], v[68:69]
    s_and_b64 s[82:83], vcc, s[80:81]
    s_cbranch_scc1 L2_c99
L2_d99:
    v_mov_b64 v[84:85], v[68:69]
    v_mov_b32 v7, v94
    v_mov_b64 v[86:87], v[72:73]
    s_mov_b64 exec, -1
    s_or_b64 s[80:81], s[80:81], vcc
    ds_read_b64 v[70:71], v93 offset:65408
    s_and_b64 exec, s[84:85], s[80:81]
    v_mfma_f32_4x4x4_16b_bf16 v[76:79], v[12:13], v[84:85], 0
    v_mov_b32 v92, v7
    s_andn2_b64 s[80:81], s[80:81], s[84:85]
    v_mfma_f32_4x4x4_16b_bf16 v[76:79], v[10:11], v[86:87], v[76:79]
    s_mov_b64 exec, -1
    ds_read_b64 v[68:69], v92 offset:65408
    s_setprio 1
    s_waitcnt vmcnt(10)
    s_mov_b32 m0, s38
    s_nop 0
    ds_write_addtid_b32 v108 offset:0
    ds_write_addtid_b32 v109 offset:256
    ds_write_addtid_b32 v110 offset:512
    ds_write_addtid_b32 v111 offset:768
    s_waitcnt lgkmcnt(4)
    v_mfma_f32_4x4x4_16b_bf16 v[80:83], v[10:11], v[70:71], v[80:83]
    v_mfma_f32_4x4x4_16b_bf16 v[76:79], v[10:11], v[68:69], v[76:79]
    v_and_b32 v46, 0x40000000, v39
    v_bitop3_b32 v94, v36, v5, v46 bitop3:0xea
    v_and_b32 v46, 0x80000000, v39
    v_bitop3_b32 v95, v37, v5, v46 bitop3:0xea
    v_perm_b32 v15, v37, v38, s47
    v_bitop3_b32 v46, v37, 0.5, -0.5 bitop3:0xa8
    v_perm_b32 v14, v36, v38, s46
    v_bitop3_b32 v47, v36, 0.5, -0.5 bitop3:0xa8
    v_cvt_pk_bf16_f32 v80, v80, v81
    v_cvt_pk_bf16_f32 v81, v82, v83
    ds_wrxchg_rtn_b64 v[74:75], v93, v[80:81] offset:65408
    v_cvt_pk_bf16_f32 v76, v76, v77
    v_cvt_pk_bf16_f32 v77, v78, v79
    ds_wrxchg_rtn_b64 v[72:73], v92, v[76:77] offset:65408
    s_setprio 0
    s_waitcnt vmcnt(7)
    ds_write_addtid_b32 v112 offset:1024
    ds_write_addtid_b32 v113 offset:1280
    ds_write_addtid_b32 v114 offset:1536
    ds_write_addtid_b32 v115 offset:1792
    v_mfma_f32_4x4x4_16b_bf16 v[80:83], v[8:9], v[106:107], 0
    v_mfma_f32_4x4x4_16b_bf16 v[76:79], v[8:9], v[104:105], 0
    v_bitop3_b32 v15, v6, v15, v46 bitop3:0xca
    v_bitop3_b32 v14, v6, v14, v47 bitop3:0xca
    s_nop 1
    v_pk_mul_f32 v[80:81], v[80:81], v[14:15] op_sel:[0,1] op_sel_hi:[1,1]
    v_pk_mul_f32 v[82:83], v[82:83], v[14:15] op_sel:[0,1] op_sel_hi:[1,1]
    v_pk_mul_f32 v[76:77], v[76:77], v[14:15] op_sel:[0,0] op_sel_hi:[1,0]
    v_pk_mul_f32 v[78:79], v[78:79], v[14:15] op_sel:[0,0] op_sel_hi:[1,0]
    s_add_u32 s42, s42, 1
    s_waitcnt lgkmcnt(0)
    s_barrier
    s_bitcmp1_b32 s36, s42
    s_cbranch_scc1 L2_slow
L2_ret5:
    s_setprio 3
    v_and_b32 v47, 0x0fffffff, v44
    v_mov_b32 v39, v44
    buffer_load_dwordx2 v[34:35], v47, s[8:11], 0 offen
    buffer_load_dwordx3 v[36:38], v47, s[8:11], 0 offen offset:8
    v_cmpx_ne_u64 vcc, v[74:75], v[70:71]
    s_and_b64 s[82:83], vcc, s[80:81]
    s_cbranch_scc1 L2_c100
L2_d100:
    v_mov_b64 v[84:85], v[70:71]
    v_mov_b32 v7, v93
    v_mov_b64 v[86:87], v[74:75]
    s_mov_b64 exec, -1
    s_or_b64 s[80:81], s[80:81], vcc
    v_cmpx_ne_u64 vcc, v[72:73], v[68:69]
    s_and_b64 s[82:83], vcc, s[80:81]
    s_cbranch_scc1 L2_c101
L2_d101:
    v_mov_b64 v[84:85], v[68:69]
    v_mov_b32 v7, v92
    v_mov_b64 v[86:87], v[72:73]
    s_mov_b64 exec, -1
    s_or_b64 s[80:81], s[80:81], vcc
    ds_read_b64 v[70:71], v95 offset:65408
    ds_read_b64 v[68:69], v94 offset:65408
    v_and_b32 v46, 0x20000000, v21
    v_lshrrev_b32 v47, 14, v17
    v_bitop3_b32 v47, v47, v5, v46 bitop3:0xea
    ds_read_b64 v[102:103], v47
    v_bitop3_b32 v93, v17, v5, v46 bitop3:0xea
    v_and_b32 v46, 0x10000000, v21
    v_lshrrev_b32 v47, 14, v16
    v_bitop3_b32 v47, v47, v5, v46 bitop3:0xea
    ds_read_b64 v[100:101], v47
    v_bitop3_b32 v92, v16, v5, v46 bitop3:0xea
    s_waitcnt lgkmcnt(2)
    v_mfma_f32_4x4x4_16b_bf16 v[80:83], v[10:11], v[70:71], v[80:83]
    v_mfma_f32_4x4x4_16b_bf16 v[76:79], v[10:11], v[68:69], v[76:79]
    v_perm_b32 v15, v17, v20, s45
    v_bitop3_b32 v46, v17, 0.5, -0.5 bitop3:0xa8
    v_perm_b32 v14, v16, v20, s44
    v_bitop3_b32 v47, v16, 0.5, -0.5 bitop3:0xa8
    v_cvt_pk_bf16_f32 v80, v80, v81
    v_cvt_pk_bf16_f32 v81, v82, v83
    ds_wrxchg_rtn_b64 v[74:75], v95, v[80:81] offset:65408
    v_cvt_pk_bf16_f32 v76, v76, v77
    v_cvt_pk_bf16_f32 v77, v78, v79
    ds_wrxchg_rtn_b64 v[72:73], v94, v[76:77] offset:65408
    s_waitcnt lgkmcnt(2)
    v_mfma_f32_4x4x4_16b_bf16 v[80:83], v[8:9], v[102:103], 0
    v_mfma_f32_4x4x4_16b_bf16 v[76:79], v[8:9], v[100:101], 0
    v_bitop3_b32 v15, v6, v15, v46 bitop3:0xca
    v_bitop3_b32 v14, v6, v14, v47 bitop3:0xca
    v_cmp_lt_u32 s[84:85], v5, v92
    s_nop 0
    v_pk_mul_f32 v[80:81], v[80:81], v[14:15] op_sel:[0,1] op_sel_hi:[1,1]
    v_pk_mul_f32 v[82:83], v[82:83], v[14:15] op_sel:[0,1] op_sel_hi:[1,1]
    v_pk_mul_f32 v[76:77], v[76:77], v[14:15] op_sel:[0,0] op_sel_hi:[1,0]
    v_pk_mul_f32 v[78:79], v[78:79], v[14:15] op_sel:[0,0] op_sel_hi:[1,0]
    buffer_load_dwordx4 v[108:111], v3, s[16:19], s40 offen offset:0
    s_waitcnt lgkmcnt(0)
    v_cmpx_ne_u64 vcc, v[74:75], v[70:71]
    s_and_b64 s[82:83], vcc, s[80:81]
    s_cbranch_scc1 L2_c102
L2_d102:
    v_mov_b64 v[84:85], v[70:71]
    v_mov_b32 v7, v95
    v_mov_b64 v[86:87], v[74:75]
    s_mov_b64 exec, -1
    s_or_b64 s[80:81], s[80:81], vcc
    v_cmpx_ne_u64 vcc, v[72:73], v[68:69]
    s_and_b64 s[82:83], vcc, s[80:81]
    s_cbranch_scc1 L2_c103
L2_d103:
    v_mov_b64 v[84:85], v[68:69]
    v_mov_b32 v7, v94
    v_mov_b64 v[86:87], v[72:73]
    s_mov_b64 exec, -1
    s_or_b64 s[80:81], s[80:81], vcc
    ds_read_b64 v[70:71], v93 offset:65408
    s_and_b64 exec, s[84:85], s[80:81]
    v_mfma_f32_4x4x4_16b_bf16 v[76:79], v[12:13], v[84:85], 0
    v_mov_b32 v92, v7
    s_andn2_b64 s[80:81], s[80:81], s[84:85]
    v_mfma_f32_4x4x4_16b_bf16 v[76:79], v[10:11], v[86:87], v[76:79]
    s_mov_b64 exec, -1
    ds_read_b64 v[68:69], v92 offset:65408
    v_and_b32 v46, 0x80000000, v21
    v_lshrrev_b32 v47, 14, v19
    v_bitop3_b32 v47, v47, v5, v46 bitop3:0xea
    ds_read_b64 v[106:107], v47
    v_bitop3_b32 v95, v19, v5, v46 bitop3:0xea
    v_and_b32 v46, 0x40000000, v21
    v_lshrrev_b32 v47, 14, v18
    v_bitop3_b32 v47, v47, v5, v46 bitop3:0xea
    ds_read_b64 v[104:105], v47
    v_bitop3_b32 v94, v18, v5, v46 bitop3:0xea
    s_waitcnt lgkmcnt(2)
    v_mfma_f32_4x4x4_16b_bf16 v[80:83], v[10:11], v[70:71], v[80:83]
    v_mfma_f32_4x4x4_16b_bf16 v[76:79], v[10:11], v[68:69], v[76:79]
    v_perm_b32 v15, v19, v20, s47
    v_bitop3_b32 v46, v19, 0.5, -0.5 bitop3:0xa8
    v_perm_b32 v14, v18, v20, s46
    v_bitop3_b32 v47, v18, 0.5, -0.5 bitop3:0xa8
    v_cvt_pk_bf16_f32 v80, v80, v81
    v_cvt_pk_bf16_f32 v81, v82, v83
    ds_wrxchg_rtn_b64 v[74:75], v93, v[80:81] offset:65408
    v_cvt_pk_bf16_f32 v76, v76, v77
    v_cvt_pk_bf16_f32 v77, v78, v79
    ds_wrxchg_rtn_b64 v[72:73], v92, v[76:77] offset:65408
    s_setprio 2
    s_waitcnt lgkmcnt(2)
    v_mfma_f32_4x4x4_16b_bf16 v[80:83], v[8:9], v[106:107], 0
    v_mfma_f32_4x4x4_16b_bf16 v[76:79], v[8:9], v[104:105], 0
    v_bitop3_b32 v15, v6, v15, v46 bitop3:0xca
    v_bitop3_b32 v14, v6, v14, v47 bitop3:0xca
    s_nop 1
    v_pk_mul_f32 v[80:81], v[80:81], v[14:15] op_sel:[0,1] op_sel_hi:[1,1]
    v_pk_mul_f32 v[82:83], v[82:83], v[14:15] op_sel:[0,1] op_sel_hi:[1,1]
    v_pk_mul_f32 v[76:77], v[76:77], v[14:15] op_sel:[0,0] op_sel_hi:[1,0]
    v_pk_mul_f32 v[78:79], v[78:79], v[14:15] op_sel:[0,0] op_sel_hi:[1,0]
    v_and_b32 v47, 0x0fffffff, v40
    v_mov_b32 v21, v40
    buffer_load_dwordx2 v[16:17], v47, s[8:11], 0 offen
    buffer_load_dwordx3 v[18:20], v47, s[8:11], 0 offen offset:8
    s_waitcnt lgkmcnt(0)
    v_cmpx_ne_u64 vcc, v[74:75], v[70:71]
    s_and_b64 s[82:83], vcc, s[80:81]
    s_cbranch_scc1 L2_c104
L2_d104:
    v_mov_b64 v[84:85], v[70:71]
    v_mov_b32 v7, v93
    v_mov_b64 v[86:87], v[74:75]
    s_mov_b64 exec, -1
    s_or_b64 s[80:81], s[80:81], vcc
    v_cmpx_ne_u64 vcc, v[72:73], v[68:69]
    s_and_b64 s[82:83], vcc, s[80:81]
    s_cbranch_scc1 L2_c105
L2_d105:
    v_mov_b64 v[84:85], v[68:69]
    v_mov_b32 v7, v92
    v_mov_b64 v[86:87], v[72:73]
    s_mov_b64 exec, -1
    s_or_b64 s[80:81], s[80:81], vcc
    ds_read_b64 v[70:71], v95 offset:65408
    ds_read_b64 v[68:69], v94 offset:65408
    s_waitcnt vmcnt(10)
    v_and_b32 v46, 0x20000000, v27
    v_lshrrev_b32 v47, 14, v23
    v_bitop3_b32 v47, v47, v5, v46 bitop3:0xea
    ds_read_b64 v[102:103], v47
    v_bitop3_b32 v93, v23, v5, v46 bitop3:0xea
    v_and_b32 v46, 0x10000000, v27
    v_lshrrev_b32 v47, 14, v22
    v_bitop3_b32 v47, v47, v5, v46 bitop3:0xea
    ds_read_b64 v[100:101], v47
    v_bitop3_b32 v92, v22, v5, v46 bitop3:0xea
    s_waitcnt lgkmcnt(2)
    v_mfma_f32_4x4x4_16b_bf16 v[80:83], v[10:11], v[70:71], v[80:83]
    v_mfma_f32_4x4x4_16b_bf16 v[76:79], v[10:11], v[68:69], v[76:79]
    v_perm_b32 v15, v23, v26, s45
    v_bitop3_b32 v46, v23, 0.5, -0.5 bitop3:0xa8
    v_perm_b32 v14, v22, v26, s44
    v_bitop3_b32 v47, v22, 0.5, -0.5 bitop3:0xa8
    v_cvt_pk_bf16_f32 v80, v80, v81
    v_cvt_pk_bf16_f32 v81, v82, v83
    ds_wrxchg_rtn_b64 v[74:75], v95, v[80:81] offset:65408
    v_cvt_pk_bf16_f32 v76, v76, v77
    v_cvt_pk_bf16_f32 v77, v78, v79
    ds_wrxchg_rtn_b64 v[72:73], v94, v[76:77] offset:65408
    s_waitcnt lgkmcnt(2)
    v_mfma_f32_4x4x4_16b_bf16 v[80:83], v[8:9], v[102:103], 0
    v_mfma_f32_4x4x4_16b_bf16 v[76:79], v[8:9], v[100:101], 0
    v_bitop3_b32 v15, v6, v15, v46 bitop3:0xca
    v_bitop3_b32 v14, v6, v14, v47 bitop3:0xca
    v_cmp_lt_u32 s[84:85], v5, v92
    s_nop 0
    v_pk_mul_f32 v[80:81], v[80:81], v[14:15] op_sel:[0,1] op_sel_hi:[1,1]
    v_pk_mul_f32 v[82:83], v[82:83], v[14:15] op_sel:[0,1] op_sel_hi:[1,1]
    v_pk_mul_f32 v[76:77], v[76:77], v[14:15] op_sel:[0,0] op_sel_hi:[1,0]
    v_pk_mul_f32 v[78:79], v[78:79], v[14:15] op_sel:[0,0] op_sel_hi:[1,0]
    v_sub_u16 v88, v62, v54
    v_and_b32 v89, 3, v54
    v_add3_u32 v99, v88, v89, 3
    v_and_b32 v99, -4, v99
    v_max_u32 v99, 4, v99
    v_and_b32 v97, 0xfffc, v54
    v_bfm_b32 v96, v88, v89
    v_add_u32_dpp v91, v99, v99 row_shr:1 row_mask:0xf bank_mask:0xf bound_ctrl:1
    v_mad_u32_u24 v97, v97, 5, v2
    v_cmp_lt_u32 vcc, 16, v99
    v_add_u32_dpp v91, v91, v91 row_shr:2 row_mask:0xf bank_mask:0xf bound_ctrl:1
    v_sub_u32 v98, s38, v99
    v_lshrrev_b64 v[54:55], 16, v[54:55]
    v_add_u32_dpp v91, v91, v91 row_shr:4 row_mask:0xf bank_mask:0xf bound_ctrl:1
    v_lshrrev_b64 v[62:63], 16, v[62:63]
    s_mov_b32 s101, 0
    v_add_u32_dpp v91, v91, v91 row_shr:8 row_mask:0xf bank_mask:0xf bound_ctrl:1
    s_nop 1
    v_add_u32_dpp v91, v91, v91 row_bcast:15 row_mask:0xa bank_mask:0xf
    s_nop 1
    v_add_u32_dpp v91, v91, v91 row_bcast:31 row_mask:0xc bank_mask:0xf
    v_add_u32 v98, v98, v91
    v_readlane_b32 s37, v91, 63
    s_cbranch_vccnz L2_xo106
L2_xp106:
    buffer_load_dwordx4 v[112:115], v3, s[16:19], s40 offen offset:1024
    s_waitcnt lgkmcnt(0)
    v_cmpx_ne_u64 vcc, v[74:75], v[70:71]
    s_and_b64 s[82:83], vcc, s[80:81]
    s_cbranch_scc1 L2_c107
L2_d107:
    v_mov_b64 v[84:85], v[70:71]
    v_mov_b32 v7, v95
    v_mov_b64 v[86:87], v[74:75]
    s_mov_b64 exec, -1
    s_or_b64 s[80:81], s[80:81], vcc
    v_cmpx_ne_u64 vcc, v[72:73], v[68:69]
    s_and_b64 s[82:83], vcc, s[80:81]
    s_cbranch_scc1 L2_c108
L2_d108:
    v_mov_b64 v[84:85], v[68:69]
    v_mov_b32 v7, v94
    v_mov_b64 v[86:87], v[72:73]
    s_mov_b64 exec, -1
    s_or_b64 s[80:81], s[80:81], vcc
    ds_read_b64 v[70:71], v93 offset:65408
    s_and_b64 exec, s[84:85], s[80:81]
    v_mfma_f32_4x4x4_16b_bf16 v[76:79], v[12:13], v[84:85], 0
    v_mov_b32 v92, v7
    s_andn2_b64 s[80:81], s[80:81], s[84:85]
    v_mfma_f32_4x4x4_16b_bf16 v[76:79], v[10:11], v[86:87], v[76:79]
    s_mov_b64 exec, -1
    ds_read_b64 v[68:69], v92 offset:65408
    v_and_b32 v46, 0x80000000, v27
    v_lshrrev_b32 v47, 14, v25
    v_bitop3_b32 v47, v47, v5, v46 bitop3:0xea
    ds_read_b64 v[106:107], v47
    v_bitop3_b32 v95, v25, v5, v46 bitop3:0xea
    v_and_b32 v46, 0x40000000, v27
    v_lshrrev_b32 v47, 14, v24
    v_bitop3_b32 v47, v47, v5, v46 bitop3:0xea
    ds_read_b64 v[104:105], v47
    v_bitop3_b32 v94, v24, v5, v46 bitop3:0xea
    s_waitcnt lgkmcnt(2)
    v_mfma_f32_4x4x4_16b_bf16 v[80:83], v[10:11], v[70:71], v[80:83]
    v_mfma_f32_4x4x4_16b_bf16 v[76:79], v[10:11], v[68:69], v[76:79]
    v_perm_b32 v15, v25, v26, s47
    v_bitop3_b32 v46, v25, 0.5, -0.5 bitop3:0xa8
    v_perm_b32 v14, v24, v26, s46
    v_bitop3_b32 v47, v24, 0.5, -0.5 bitop3:0xa8
    v_cvt_pk_bf16_f32 v80, v80, v81
    v_cvt_pk_bf16_f32 v81, v82, v83
    ds_wrxchg_rtn_b64 v[74:75], v93, v[80:81] offset:65408
    v_cvt_pk_bf16_f32 v76, v76, v77
    v_cvt_pk_bf16_f32 v77, v78, v79
    ds_wrxchg_rtn_b64 v[72:73], v92, v[76:77] offset:65408
    s_setprio 1
    s_waitcnt lgkmcnt(2)
    v_mfma_f32_4x4x4_16b_bf16 v[80:83], v[8:9], v[106:107], 0
    v_mfma_f32_4x4x4_16b_bf16 v[76:79], v[8:9], v[104:105], 0
    v_bitop3_b32 v15, v6, v15, v46 bitop3:0xca
    v_bitop3_b32 v14, v6, v14, v47 bitop3:0xca
    s_nop 1
    v_pk_mul_f32 v[80:81], v[80:81], v[14:15] op_sel:[0,1] op_sel_hi:[1,1]
    v_pk_mul_f32 v[82:83], v[82:83], v[14:15] op_sel:[0,1] op_sel_hi:[1,1]
    v_pk_mul_f32 v[76:77], v[76:77], v[14:15] op_sel:[0,0] op_sel_hi:[1,0]
    v_pk_mul_f32 v[78:79], v[78:79], v[14:15] op_sel:[0,0] op_sel_hi:[1,0]
    v_and_b32 v47, 0x0fffffff, v41
    v_mov_b32 v27, v41
    buffer_load_dwordx2 v[22:23], v47, s[8:11], 0 offen
    buffer_load_dwordx3 v[24:26], v47, s[8:11], 0 offen offset:8
    s_waitcnt lgkmcnt(0)
    v_cmpx_ne_u64 vcc, v[74:75], v[70:71]
    s_and_b64 s[82:83], vcc, s[80:81]
    s_cbranch_scc1 L2_c109
L2_d109:
    v_mov_b64 v[84:85], v[70:71]
    v_mov_b32 v7, v93
    v_mov_b64 v[86:87], v[74:75]
    s_mov_b64 exec, -1
    s_or_b64 s[80:81], s[80:81], vcc
    v_cmpx_ne_u64 vcc, v[72:73], v[68:69]
    s_and_b64 s[82:83], vcc, s[80:81]
    s_cbranch_scc1 L2_c110
L2_d110:
    v_mov_b64 v[84:85], v[68:69]
    v_mov_b32 v7, v92
    v_mov_b64 v[86:87], v[72:73]
    s_mov_b64 exec, -1
    s_or_b64 s[80:81], s[80:81], vcc
    ds_read_b64 v[70:71], v95 offset:65408
    ds_read_b64 v[68:69], v94 offset:65408
    s_waitcnt vmcnt(11)
    v_and_b32 v46, 0x20000000, v33
    v_lshrrev_b32 v47, 14, v29
    v_bitop3_b32 v47, v47, v5, v46 bitop3:0xea
    ds_read_b64 v[102:103], v47
    v_bitop3_b32 v93, v29, v5, v46 bitop3:0xea
    v_and_b32 v46, 0x10000000, v33
    v_lshrrev_b32 v47, 14, v28
    v_bitop3_b32 v47, v47, v5, v46 bitop3:0xea
    ds_read_b64 v[100:101], v47
    v_bitop3_b32 v92, v28, v5, v46 bitop3:0xea
    s_waitcnt lgkmcnt(2)
    v_mfma_f32_4x4x4_16b_bf16 v[80:83], v[10:11], v[70:71], v[80:83]
    v_mfma_f32_4x4x4_16b_bf16 v[76:79], v[10:11], v[68:69], v[76:79]
    v_perm_b32 v15, v29, v32, s45
    v_bitop3_b32 v46, v29, 0.5, -0.5 bitop3:0xa8
    v_perm_b32 v14, v28, v32, s44
    v_bitop3_b32 v47, v28, 0.5, -0.5 bitop3:0xa8
    v_cvt_pk_bf16_f32 v80, v80, v81
    v_cvt_pk_bf16_f32 v81, v82, v83
    ds_wrxchg_rtn_b64 v[74:75], v95, v[80:81] offset:65408
    v_cvt_pk_bf16_f32 v76, v76, v77
    v_cvt_pk_bf16_f32 v77, v78, v79
    ds_wrxchg_rtn_b64 v[72:73], v94, v[76:77] offset:65408
    s_waitcnt lgkmcnt(2)
    v_mfma_f32_4x4x4_16b_bf16 v[80:83], v[8:9], v[102:103], 0
    v_mfma_f32_4x4x4_16b_bf16 v[76:79], v[8:9], v[100:101], 0
    v_bitop3_b32 v15, v6, v15, v46 bitop3:0xca
    v_bitop3_b32 v14, v6, v14, v47 bitop3:0xca
    v_cmp_lt_u32 s[84:85], v5, v92
    s_nop 0
    v_pk_mul_f32 v[80:81], v[80:81], v[14:15] op_sel:[0,1] op_sel_hi:[1,1]
    v_pk_mul_f32 v[82:83], v[82:83], v[14:15] op_sel:[0,1] op_sel_hi:[1,1]
    v_pk_mul_f32 v[76:77], v[76:77], v[14:15] op_sel:[0,0] op_sel_hi:[1,0]
    v_pk_mul_f32 v[78:79], v[78:79], v[14:15] op_sel:[0,0] op_sel_hi:[1,0]
    s_waitcnt lgkmcnt(0)
    v_cmpx_ne_u64 vcc, v[74:75], v[70:71]
    s_and_b64 s[82:83], vcc, s[80:81]
    s_cbranch_scc1 L2_c111
L2_d111:
    v_mov_b64 v[84:85], v[70:71]
    v_mov_b32 v7, v95
    v_mov_b64 v[86:87], v[74:75]
    s_mov_b64 exec, -1
    s_or_b64 s[80:81], s[80:81], vcc
    v_cmpx_ne_u64 vcc, v[72:73], v[68:69]
    s_and_b64 s[82:83], vcc, s[80:81]
    s_cbranch_scc1 L2_c112
L2_d112:
    v_mov_b64 v[84:85], v[68:69]
    v_mov_b32 v7, v94
    v_mov_b64 v[86:87], v[72:73]
    s_mov_b64 exec, -1
    s_or_b64 s[80:81], s[80:81], vcc
    ds_read_b64 v[70:71], v93 offset:65408
    s_and_b64 exec, s[84:85], s[80:81]
    v_mfma_f32_4x4x4_16b_bf16 v[76:79], v[12:13], v[84:85], 0
    v_mov_b32 v92, v7
    s_andn2_b64 s[80:81], s[80:81], s[84:85]
    v_mfma_f32_4x4x4_16b_bf16 v[76:79], v[10:11], v[86:87], v[76:79]
    s_mov_b64 exec, -1
    ds_read_b64 v[68:69], v92 offset:65408
    v_and_b32 v46, 0x80000000, v33
    v_lshrrev_b32 v47, 14, v31
    v_bitop3_b32 v47, v47, v5, v46 bitop3:0xea
    ds_read_b64 v[106:107], v47
    v_bitop3_b32 v95, v31, v5, v46 bitop3:0xea
    v_and_b32 v46, 0x40000000, v33
    v_lshrrev_b32 v47, 14, v30
    v_bitop3_b32 v47, v47, v5, v46 bitop3:0xea
    ds_read_b64 v[104:105], v47
    v_bitop3_b32 v94, v30, v5, v46 bitop3:0xea
    s_waitcnt lgkmcnt(2)
    v_mfma_f32_4x4x4_16b_bf16 v[80:83], v[10:11], v[70:71], v[80:83]
    v_mfma_f32_4x4x4_16b_bf16 v[76:79], v[10:11], v[68:69], v[76:79]
    v_perm_b32 v15, v31, v32, s47
    v_bitop3_b32 v46, v31, 0.5, -0.5 bitop3:0xa8
    v_perm_b32 v14, v30, v32, s46
    v_bitop3_b32 v47, v30, 0.5, -0.5 bitop3:0xa8
    v_cvt_pk_bf16_f32 v80, v80, v81
    v_cvt_pk_bf16_f32 v81, v82, v83
    ds_wrxchg_rtn_b64 v[74:75], v93, v[80:81] offset:65408
    v_cvt_pk_bf16_f32 v76, v76, v77
    v_cvt_pk_bf16_f32 v77, v78, v79
    ds_wrxchg_rtn_b64 v[72:73], v92, v[76:77] offset:65408
    s_setprio 0
    s_waitcnt lgkmcnt(2)
    v_mfma_f32_4x4x4_16b_bf16 v[80:83], v[8:9], v[106:107], 0
    v_mfma_f32_4x4x4_16b_bf16 v[76:79], v[8:9], v[104:105], 0
    v_bitop3_b32 v15, v6, v15, v46 bitop3:0xca
    v_bitop3_b32 v14, v6, v14, v47 bitop3:0xca
    s_nop 1
    v_pk_mul_f32 v[80:81], v[80:81], v[14:15] op_sel:[0,1] op_sel_hi:[1,1]
    v_pk_mul_f32 v[82:83], v[82:83], v[14:15] op_sel:[0,1] op_sel_hi:[1,1]
    v_pk_mul_f32 v[76:77], v[76:77], v[14:15] op_sel:[0,0] op_sel_hi:[1,0]
    v_pk_mul_f32 v[78:79], v[78:79], v[14:15] op_sel:[0,0] op_sel_hi:[1,0]
    s_add_u32 s40, s40, 0x50000
    v_and_b32 v47, 0x0fffffff, v42
    v_mov_b32 v33, v42
    buffer_load_dwordx2 v[28:29], v47, s[8:11], 0 offen
    buffer_load_dwordx3 v[30:32], v47, s[8:11], 0 offen offset:8
    s_waitcnt lgkmcnt(0)
    v_cmpx_ne_u64 vcc, v[74:75], v[70:71]
    s_and_b64 s[82:83], vcc, s[80:81]
    s_cbranch_scc1 L2_c113
L2_d113:
    v_mov_b64 v[84:85], v[70:71]
    v_mov_b32 v7, v93
    v_mov_b64 v[86:87], v[74:75]
    s_mov_b64 exec, -1
    s_or_b64 s[80:81], s[80:81], vcc
    v_cmpx_ne_u64 vcc, v[72:73], v[68:69]
    s_and_b64 s[82:83], vcc, s[80:81]
    s_cbranch_scc1 L2_c114
L2_d114:
    v_mov_b64 v[84:85], v[68:69]
    v_mov_b32 v7, v92
    v_mov_b64 v[86:87], v[72:73]
    s_mov_b64 exec, -1
    s_or_b64 s[80:81], s[80:81], vcc
    ds_read_b64 v[70:71], v95 offset:65408
    ds_read_b64 v[68:69], v94 offset:65408
    s_waitcnt vmcnt(8)
    v_and_b32 v46, 0x20000000, v39
    v_lshrrev_b32 v47, 14, v35
    v_bitop3_b32 v47, v47, v5, v46 bitop3:0xea
    ds_read_b64 v[102:103], v47
    v_bitop3_b32 v93, v35, v5, v46 bitop3:0xea
    v_and_b32 v46, 0x10000000, v39
    v_lshrrev_b32 v47, 14, v34
    v_bitop3_b32 v47, v47, v5, v46 bitop3:0xea
    ds_read_b64 v[100:101], v47
    v_bitop3_b32 v92, v34, v5, v46 bitop3:0xea
    v_and_b32 v46, 0x80000000, v39
    v_lshrrev_b32 v47, 14, v37
    v_bitop3_b32 v47, v47, v5, v46 bitop3:0xea
    ds_read_b64 v[106:107], v47
    v_and_b32 v46, 0x40000000, v39
    v_lshrrev_b32 v47, 14, v36
    v_bitop3_b32 v47, v47, v5, v46 bitop3:0xea
    ds_read_b64 v[104:105], v47
    s_waitcnt lgkmcnt(4)
    v_mfma_f32_4x4x4_16b_bf16 v[80:83], v[10:11], v[70:71], v[80:83]
    v_mfma_f32_4x4x4_16b_bf16 v[76:79], v[10:11], v[68:69], v[76:79]
    v_perm_b32 v15, v35, v38, s45
    v_bitop3_b32 v46, v35, 0.5, -0.5 bitop3:0xa8
    v_perm_b32 v14, v34, v38, s44
    v_bitop3_b32 v47, v34, 0.5, -0.5 bitop3:0xa8
    v_cvt_pk_bf16_f32 v80, v80, v81
    v_cvt_pk_bf16_f32 v81, v82, v83
    ds_wrxchg_rtn_b64 v[74:75], v95, v[80:81] offset:65408
    v_cvt_pk_bf16_f32 v76, v76, v77
    v_cvt_pk_bf16_f32 v77, v78, v79
    ds_wrxchg_rtn_b64 v[72:73], v94, v[76:77] offset:65408
    s_waitcnt lgkmcnt(2)
    s_barrier
    s_setprio 3
    s_mov_b32 m0, s100
    s_nop 0
    ds_write_addtid_b32 v116 offset:32768
    ds_write_addtid_b32 v117 offset:33024
    ds_write_addtid_b32 v118 offset:33280
    ds_write_addtid_b32 v119 offset:33536
    buffer_load_dwordx4 v[116:119], v3, s[16:19], s40 offen offset:2048
    ds_write_addtid_b32 v120 offset:33792
    ds_write_addtid_b32 v121 offset:34048
    ds_write_addtid_b32 v122 offset:34304
    ds_write_addtid_b32 v123 offset:34560
    buffer_load_dwordx4 v[120:123], v3, s[16:19], s40 offen offset:3072
    v_mfma_f32_4x4x4_16b_bf16 v[80:83], v[8:9], v[102:103], 0
    v_mfma_f32_4x4x4_16b_bf16 v[76:79], v[8:9], v[100:101], 0
    v_bitop3_b32 v15, v6, v15, v46 bitop3:0xca
    v_bitop3_b32 v14, v6, v14, v47 bitop3:0xca
    v_cmp_lt_u32 s[84:85], v5, v92
    s_nop 0
    v_pk_mul_f32 v[80:81], v[80:81], v[14:15] op_sel:[0,1] op_sel_hi:[1,1]
    v_pk_mul_f32 v[82:83], v[82:83], v[14:15] op_sel:[0,1] op_sel_hi:[1,1]
    v_pk_mul_f32 v[76:77], v[76:77], v[14:15] op_sel:[0,0] op_sel_hi:[1,0]
    v_pk_mul_f32 v[78:79], v[78:79], v[14:15] op_sel:[0,0] op_sel_hi:[1,0]
    v_mov_b32 v44, v43
    s_cmp_gt_u32 s37, 1024
    s_cbranch_scc1 L2_xs115
    s_cmp_lg_u32 s101, 0
    s_cbranch_scc1 L2_xa115
L2_xb115:
    v_lshlrev_b32 v89, 16, v96
    v_add_u32 v90, 60, v97
    v_bitop3_b32 v90, v89, v45, v90 bitop3:0x6a
    ds_write_b32 v98, v90 offset:12
    v_lshlrev_b32 v89, 20, v96
    v_add_u32 v90, 40, v97
    v_bitop3_b32 v90, v89, v45, v90 bitop3:0x6a
    ds_write_b32 v98, v90 offset:8
    v_lshlrev_b32 v89, 24, v96
    v_add_u32 v90, 20, v97
    v_bitop3_b32 v90, v89, v45, v90 bitop3:0x6a
    ds_write_b32 v98, v90 offset:4
    v_lshlrev_b32 v89, 28, v96
    v_bitop3_b32 v90, v89, v45, v97 bitop3:0x6a
    ds_write_b32 v98, v90 offset:0
    v_mov_b32_dpp v91, v66 quad_perm:[1,1,1,1] row_mask:0xf bank_mask:0xf
    v_and_b32 v89, 3, v91
    v_and_b32 v97, 0xfffc, v91
    v_sub_u16_dpp v88, v66, v91 quad_perm:[3,3,3,3] row_mask:0xf bank_mask:0xf
    v_mad_u32_u24 v97, v97, 5, v4
    v_add_u32 v99, v88, v89
    v_bfm_b32 v96, v88, v89
    v_cmp_lt_u32 s[58:59], 16, v99
    v_lshlrev_b32 v89, v1, v96
    v_and_b32 v89, v45, v89
    v_cmp_ne_u32 vcc, 0, v89
    v_xor_b32 v90, v97, v89
    s_add_u32 s3, s37, s38
    v_mbcnt_lo_u32_b32 v98, vcc_lo, 0
    v_mbcnt_hi_u32_b32 v98, vcc_hi, v98
    s_bcnt1_i32_b64 s41, vcc
    v_lshl_add_u32 v98, v98, 2, s3
    s_mov_b64 exec, vcc
    ds_write_b32 v98, v90
    s_mov_b64 exec, -1
    s_lshl2_add_u32 s37, s41, s37
    s_cmp_lg_u64 s[58:59], 0
    s_cbranch_scc1 L2_xe115
L2_xr115:
    v_add_u32 v98, s37, v0
    v_mov_b32 v90, -1
    ds_write_b32 v98, v90
    ds_read2st64_b32 v[40:41], v0 offset0:0 offset1:1
    ds_read2st64_b32 v[42:43], v0 offset0:2 offset1:3
    s_sub_u32 s3, s37, 768
    s_cmp_gt_u32 s3, 256
    s_cbranch_scc1 L2_xf115
L2_xg115:
    v_lshrrev_b64 v[64:65], 16, v[64:65]
    v_lshrrev_b64 v[66:67], 16, v[66:67]
    s_setprio 2
    ds_write_addtid_b32 v124 offset:34816
    ds_write_addtid_b32 v125 offset:35072
    ds_write_addtid_b32 v126 offset:35328
    ds_write_addtid_b32 v127 offset:35584
    s_add_u32 s3, s40, 4096
    buffer_load_dwordx4 v[124:127], v3, s[16:19], s3 offen
    s_waitcnt lgkmcnt(14)
    v_cmpx_ne_u64 vcc, v[74:75], v[70:71]
    s_and_b64 s[82:83], vcc, s[80:81]
    s_cbranch_scc1 L2_c116
L2_d116:
    v_mov_b64 v[84:85], v[70:71]
    v_mov_b32 v7, v95
    v_mov_b64 v[86:87], v[74:75]
    s_mov_b64 exec, -1
    s_or_b64 s[80:81], s[80:81], vcc
    v_cmpx_ne_u64 vcc, v[72:73], v[68:69]
    s_and_b64 s[82:83], vcc, s[80:81]
    s_cbranch_scc1 L2_c117
L2_d117:
    v_mov_b64 v[84:85], v[68:69]
    v_mov_b32 v7, v94
    v_mov_b64 v[86:87], v[72:73]
    s_mov_b64 exec, -1
    s_or_b64 s[80:81], s[80:81], vcc
    ds_read_b64 v[70:71], v93 offset:65408
    s_and_b64 exec, s[84:85], s[80:81]
    v_mfma_f32_4x4x4_16b_bf16 v[76:79], v[12:13], v[84:85], 0
    v_mov_b32 v92, v7
    s_andn2_b64 s[80:81], s[80:81], s[84:85]
    v_mfma_f32_4x4x4_16b_bf16 v[76:79], v[10:11], v[86:87], v[76:79]
    s_mov_b64 exec, -1
    ds_read_b64 v[68:69], v92 offset:65408
    s_setprio 1
    s_waitcnt vmcnt(10)
    s_mov_b32 m0, s38
    s_nop 0
    ds_write_addtid_b32 v108 offset:0
    ds_write_addtid_b32 v109 offset:256
    ds_write_addtid_b32 v110 offset:512
    ds_write_addtid_b32 v111 offset:768
    s_waitcnt lgkmcnt(4)
    v_mfma_f32_4x4x4_16b_bf16 v[80:83], v[10:11], v[70:71], v[80:83]
    v_mfma_f32_4x4x4_16b_bf16 v[76:79], v[10:11], v[68:69], v[76:79]
    v_and_b32 v46, 0x40000000, v39
    v_bitop3_b32 v94, v36, v5, v46 bitop3:0xea
    v_and_b32 v46, 0x80000000, v39
    v_bitop3_b32 v95, v37, v5, v46 bitop3:0xea
    v_perm_b32 v15, v37, v38, s47
    v_bitop3_b32 v46, v37, 0.5, -0.5 bitop3:0xa8
    v_perm_b32 v14, v36, v38, s46
    v_bitop3_b32 v47, v36, 0.5, -0.5 bitop3:0xa8
    v_cvt_pk_bf16_f32 v80, v80, v81
    v_cvt_pk_bf16_f32 v81, v82, v83
    ds_wrxchg_rtn_b64 v[74:75], v93, v[80:81] offset:65408
    v_cvt_pk_bf16_f32 v76, v76, v77
    v_cvt_pk_bf16_f32 v77, v78, v79
    ds_wrxchg_rtn_b64 v[72:73], v92, v[76:77] offset:65408
    s_setprio 0
    s_waitcnt vmcnt(7)
    ds_write_addtid_b32 v112 offset:1024
    ds_write_addtid_b32 v113 offset:1280
    ds_write_addtid_b32 v114 offset:1536
    ds_write_addtid_b32 v115 offset:1792
    v_mfma_f32_4x4x4_16b_bf16 v[80:83], v[8:9], v[106:107], 0
    v_mfma_f32_4x4x4_16b_bf16 v[76:79], v[8:9], v[104:105], 0
    v_bitop3_b32 v15, v6, v15, v46 bitop3:0xca
    v_bitop3_b32 v14, v6, v14, v47 bitop3:0xca
    s_nop 1
    v_pk_mul_f32 v[80:81], v[80:81], v[14:15] op_sel:[0,1] op_sel_hi:[1,1]
    v_pk_mul_f32 v[82:83], v[82:83], v[14:15] op_sel:[0,1] op_sel_hi:[1,1]
    v_pk_mul_f32 v[76:77], v[76:77], v[14:15] op_sel:[0,0] op_sel_hi:[1,0]
    v_pk_mul_f32 v[78:79], v[78:79], v[14:15] op_sel:[0,0] op_sel_hi:[1,0]
    s_add_u32 s42, s42, 1
    s_waitcnt lgkmcnt(0)
    s_cmp_lg_u32 s42, 14
    s_cbranch_scc1 L2_loop
    s_barrier
    s_bitcmp1_b32 s36, s42
    s_cbranch_scc1 L2_slow
L2_ret6:
    s_setprio 3
    v_and_b32 v47, 0x0fffffff, v44
    v_mov_b32 v39, v44
    buffer_load_dwordx2 v[34:35], v47, s[8:11], 0 offen
    buffer_load_dwordx3 v[36:38], v47, s[8:11], 0 offen offset:8
    v_cmpx_ne_u64 vcc, v[74:75], v[70:71]
    s_and_b64 s[82:83], vcc, s[80:81]
    s_cbranch_scc1 L2_c118
L2_d118:
    v_mov_b64 v[84:85], v[70:71]
    v_mov_b32 v7, v93
    v_mov_b64 v[86:87], v[74:75]
    s_mov_b64 exec, -1
    s_or_b64 s[80:81], s[80:81], vcc
    v_cmpx_ne_u64 vcc, v[72:73], v[68:69]
    s_and_b64 s[82:83], vcc, s[80:81]
    s_cbranch_scc1 L2_c119
L2_d119:
    v_mov_b64 v[84:85], v[68:69]
    v_mov_b32 v7, v92
    v_mov_b64 v[86:87], v[72:73]
    s_mov_b64 exec, -1
    s_or_b64 s[80:81], s[80:81], vcc
    ds_read_b64 v[70:71], v95 offset:65408
    ds_read_b64 v[68:69], v94 offset:65408
    v_and_b32 v46, 0x20000000, v21
    v_lshrrev_b32 v47, 14, v17
    v_bitop3_b32 v47, v47, v5, v46 bitop3:0xea
    ds_read_b64 v[102:103], v47
    v_bitop3_b32 v93, v17, v5, v46 bitop3:0xea
    v_and_b32 v46, 0x10000000, v21
    v_lshrrev_b32 v47, 14, v16
    v_bitop3_b32 v47, v47, v5, v46 bitop3:0xea
    ds_read_b64 v[100:101], v47
    v_bitop3_b32 v92, v16, v5, v46 bitop3:0xea
    s_waitcnt lgkmcnt(2)
    v_mfma_f32_4x4x4_16b_bf16 v[80:83], v[10:11], v[70:71], v[80:83]
    v_mfma_f32_4x4x4_16b_bf16 v[76:79], v[10:11], v[68:69], v[76:79]
    v_perm_b32 v15, v17, v20, s45
    v_bitop3_b32 v46, v17, 0.5, -0.5 bitop3:0xa8
    v_perm_b32 v14, v16, v20, s44
    v_bitop3_b32 v47, v16, 0.5, -0.5 bitop3:0xa8
    v_cvt_pk_bf16_f32 v80, v80, v81
    v_cvt_pk_bf16_f32 v81, v82, v83
    ds_wrxchg_rtn_b64 v[74:75], v95, v[80:81] offset:65408
    v_cvt_pk_bf16_f32 v76, v76, v77
    v_cvt_pk_bf16_f32 v77, v78, v79
    ds_wrxchg_rtn_b64 v[72:73], v94, v[76:77] offset:65408
    s_waitcnt lgkmcnt(2)
    v_mfma_f32_4x4x4_16b_bf16 v[80:83], v[8:9], v[102:103], 0
    v_mfma_f32_4x4x4_16b_bf16 v[76:79], v[8:9], v[100:101], 0
    v_bitop3_b32 v15, v6, v15, v46 bitop3:0xca
    v_bitop3_b32 v14, v6, v14, v47 bitop3:0xca
    v_cmp_lt_u32 s[84:85], v5, v92
    s_nop 0
    v_pk_mul_f32 v[80:81], v[80:81], v[14:15] op_sel:[0,1] op_sel_hi:[1,1]
    v_pk_mul_f32 v[82:83], v[82:83], v[14:15] op_sel:[0,1] op_sel_hi:[1,1]
    v_pk_mul_f32 v[76:77], v[76:77], v[14:15] op_sel:[0,0] op_sel_hi:[1,0]
    v_pk_mul_f32 v[78:79], v[78:79], v[14:15] op_sel:[0,0] op_sel_hi:[1,0]
    buffer_load_dwordx4 v[108:111], v3, s[16:19], s40 offen offset:0
    s_waitcnt lgkmcnt(0)
    v_cmpx_ne_u64 vcc, v[74:75], v[70:71]
    s_and_b64 s[82:83], vcc, s[80:81]
    s_cbranch_scc1 L2_c120
L2_d120:
    v_mov_b64 v[84:85], v[70:71]
    v_mov_b32 v7, v95
    v_mov_b64 v[86:87], v[74:75]
    s_mov_b64 exec, -1
    s_or_b64 s[80:81], s[80:81], vcc
    v_cmpx_ne_u64 vcc, v[72:73], v[68:69]
    s_and_b64 s[82:83], vcc, s[80:81]
    s_cbranch_scc1 L2_c121
L2_d121:
    v_mov_b64 v[84:85], v[68:69]
    v_mov_b32 v7, v94
    v_mov_b64 v[86:87], v[72:73]
    s_mov_b64 exec, -1
    s_or_b64 s[80:81], s[80:81], vcc
    ds_read_b64 v[70:71], v93 offset:65408
    s_and_b64 exec, s[84:85], s[80:81]
    v_mfma_f32_4x4x4_16b_bf16 v[76:79], v[12:13], v[84:85], 0
    v_mov_b32 v92, v7
    s_andn2_b64 s[80:81], s[80:81], s[84:85]
    v_mfma_f32_4x4x4_16b_bf16 v[76:79], v[10:11], v[86:87], v[76:79]
    s_mov_b64 exec, -1
    ds_read_b64 v[68:69], v92 offset:65408
    v_and_b32 v46, 0x80000000, v21
    v_lshrrev_b32 v47, 14, v19
    v_bitop3_b32 v47, v47, v5, v46 bitop3:0xea
    ds_read_b64 v[106:107], v47
    v_bitop3_b32 v95, v19, v5, v46 bitop3:0xea
    v_and_b32 v46, 0x40000000, v21
    v_lshrrev_b32 v47, 14, v18
    v_bitop3_b32 v47, v47, v5, v46 bitop3:0xea
    ds_read_b64 v[104:105], v47
    v_bitop3_b32 v94, v18, v5, v46 bitop3:0xea
    s_waitcnt lgkmcnt(2)
    v_mfma_f32_4x4x4_16b_bf16 v[80:83], v[10:11], v[70:71], v[80:83]
    v_mfma_f32_4x4x4_16b_bf16 v[76:79], v[10:11], v[68:69], v[76:79]
    v_perm_b32 v15, v19, v20, s47
    v_bitop3_b32 v46, v19, 0.5, -0.5 bitop3:0xa8
    v_perm_b32 v14, v18, v20, s46
    v_bitop3_b32 v47, v18, 0.5, -0.5 bitop3:0xa8
    v_cvt_pk_bf16_f32 v80, v80, v81
    v_cvt_pk_bf16_f32 v81, v82, v83
    ds_wrxchg_rtn_b64 v[74:75], v93, v[80:81] offset:65408
    v_cvt_pk_bf16_f32 v76, v76, v77
    v_cvt_pk_bf16_f32 v77, v78, v79
    ds_wrxchg_rtn_b64 v[72:73], v92, v[76:77] offset:65408
    s_setprio 2
    s_waitcnt lgkmcnt(2)
    v_mfma_f32_4x4x4_16b_bf16 v[80:83], v[8:9], v[106:107], 0
    v_mfma_f32_4x4x4_16b_bf16 v[76:79], v[8:9], v[104:105], 0
    v_bitop3_b32 v15, v6, v15, v46 bitop3:0xca
    v_bitop3_b32 v14, v6, v14, v47 bitop3:0xca
    s_nop 1
    v_pk_mul_f32 v[80:81], v[80:81], v[14:15] op_sel:[0,1] op_sel_hi:[1,1]
    v_pk_mul_f32 v[82:83], v[82:83], v[14:15] op_sel:[0,1] op_sel_hi:[1,1]
    v_pk_mul_f32 v[76:77], v[76:77], v[14:15] op_sel:[0,0] op_sel_hi:[1,0]
    v_pk_mul_f32 v[78:79], v[78:79], v[14:15] op_sel:[0,0] op_sel_hi:[1,0]
    v_and_b32 v47, 0x0fffffff, v40
    v_mov_b32 v21, v40
    buffer_load_dwordx2 v[16:17], v47, s[8:11], 0 offen
    buffer_load_dwordx3 v[18:20], v47, s[8:11], 0 offen offset:8
    s_waitcnt lgkmcnt(0)
    v_cmpx_ne_u64 vcc, v[74:75], v[70:71]
    s_and_b64 s[82:83], vcc, s[80:81]
    s_cbranch_scc1 L2_c122
L2_d122:
    v_mov_b64 v[84:85], v[70:71]
    v_mov_b32 v7, v93
    v_mov_b64 v[86:87], v[74:75]
    s_mov_b64 exec, -1
    s_or_b64 s[80:81], s[80:81], vcc
    v_cmpx_ne_u64 vcc, v[72:73], v[68:69]
    s_and_b64 s[82:83], vcc, s[80:81]
    s_cbranch_scc1 L2_c123
L2_d123:
    v_mov_b64 v[84:85], v[68:69]
    v_mov_b32 v7, v92
    v_mov_b64 v[86:87], v[72:73]
    s_mov_b64 exec, -1
    s_or_b64 s[80:81], s[80:81], vcc
    ds_read_b64 v[70:71], v95 offset:65408
    ds_read_b64 v[68:69], v94 offset:65408
    s_waitcnt vmcnt(10)
    v_and_b32 v46, 0x20000000, v27
    v_lshrrev_b32 v47, 14, v23
    v_bitop3_b32 v47, v47, v5, v46 bitop3:0xea
    ds_read_b64 v[102:103], v47
    v_bitop3_b32 v93, v23, v5, v46 bitop3:0xea
    v_and_b32 v46, 0x10000000, v27
    v_lshrrev_b32 v47, 14, v22
    v_bitop3_b32 v47, v47, v5, v46 bitop3:0xea
    ds_read_b64 v[100:101], v47
    v_bitop3_b32 v92, v22, v5, v46 bitop3:0xea
    s_waitcnt lgkmcnt(2)
    v_mfma_f32_4x4x4_16b_bf16 v[80:83], v[10:11], v[70:71], v[80:83]
    v_mfma_f32_4x4x4_16b_bf16 v[76:79], v[10:11], v[68:69], v[76:79]
    v_perm_b32 v15, v23, v26, s45
    v_bitop3_b32 v46, v23, 0.5, -0.5 bitop3:0xa8
    v_perm_b32 v14, v22, v26, s44
    v_bitop3_b32 v47, v22, 0.5, -0.5 bitop3:0xa8
    v_cvt_pk_bf16_f32 v80, v80, v81
    v_cvt_pk_bf16_f32 v81, v82, v83
    ds_wrxchg_rtn_b64 v[74:75], v95, v[80:81] offset:65408
    v_cvt_pk_bf16_f32 v76, v76, v77
    v_cvt_pk_bf16_f32 v77, v78, v79
    ds_wrxchg_rtn_b64 v[72:73], v94, v[76:77] offset:65408
    s_waitcnt lgkmcnt(2)
    v_mfma_f32_4x4x4_16b_bf16 v[80:83], v[8:9], v[102:103], 0
    v_mfma_f32_4x4x4_16b_bf16 v[76:79], v[8:9], v[100:101], 0
    v_bitop3_b32 v15, v6, v15, v46 bitop3:0xca
    v_bitop3_b32 v14, v6, v14, v47 bitop3:0xca
    v_cmp_lt_u32 s[84:85], v5, v92
    s_nop 0
    v_pk_mul_f32 v[80:81], v[80:81], v[14:15] op_sel:[0,1] op_sel_hi:[1,1]
    v_pk_mul_f32 v[82:83], v[82:83], v[14:15] op_sel:[0,1] op_sel_hi:[1,1]
    v_pk_mul_f32 v[76:77], v[76:77], v[14:15] op_sel:[0,0] op_sel_hi:[1,0]
    v_pk_mul_f32 v[78:79], v[78:79], v[14:15] op_sel:[0,0] op_sel_hi:[1,0]
    buffer_load_dwordx4 v[112:115], v3, s[16:19], s40 offen offset:1024
    s_waitcnt lgkmcnt(0)
    v_cmpx_ne_u64 vcc, v[74:75], v[70:71]
    s_and_b64 s[82:83], vcc, s[80:81]
    s_cbranch_scc1 L2_c124
L2_d124:
    v_mov_b64 v[84:85], v[70:71]
    v_mov_b32 v7, v95
    v_mov_b64 v[86:87], v[74:75]
    s_mov_b64 exec, -1
    s_or_b64 s[80:81], s[80:81], vcc
    v_cmpx_ne_u64 vcc, v[72:73], v[68:69]
    s_and_b64 s[82:83], vcc, s[80:81]
    s_cbranch_scc1 L2_c125
L2_d125:
    v_mov_b64 v[84:85], v[68:69]
    v_mov_b32 v7, v94
    v_mov_b64 v[86:87], v[72:73]
    s_mov_b64 exec, -1
    s_or_b64 s[80:81], s[80:81], vcc
    ds_read_b64 v[70:71], v93 offset:65408
    s_and_b64 exec, s[84:85], s[80:81]
    v_mfma_f32_4x4x4_16b_bf16 v[76:79], v[12:13], v[84:85], 0
    v_mov_b32 v92, v7
    s_andn2_b64 s[80:81], s[80:81], s[84:85]
    v_mfma_f32_4x4x4_16b_bf16 v[76:79], v[10:11], v[86:87], v[76:79]
    s_mov_b64 exec, -1
    ds_read_b64 v[68:69], v92 offset:65408
    v_and_b32 v46, 0x80000000, v27
    v_lshrrev_b32 v47, 14, v25
    v_bitop3_b32 v47, v47, v5, v46 bitop3:0xea
    ds_read_b64 v[106:107], v47
    v_bitop3_b32 v95, v25, v5, v46 bitop3:0xea
    v_and_b32 v46, 0x40000000, v27
    v_lshrrev_b32 v47, 14, v24
    v_bitop3_b32 v47, v47, v5, v46 bitop3:0xea
    ds_read_b64 v[104:105], v47
    v_bitop3_b32 v94, v24, v5, v46 bitop3:0xea
    s_waitcnt lgkmcnt(2)
    v_mfma_f32_4x4x4_16b_bf16 v[80:83], v[10:11], v[70:71], v[80:83]
    v_mfma_f32_4x4x4_16b_bf16 v[76:79], v[10:11], v[68:69], v[76:79]
    v_perm_b32 v15, v25, v26, s47
    v_bitop3_b32 v46, v25, 0.5, -0.5 bitop3:0xa8
    v_perm_b32 v14, v24, v26, s46
    v_bitop3_b32 v47, v24, 0.5, -0.5 bitop3:0xa8
    v_cvt_pk_bf16_f32 v80, v80, v81
    v_cvt_pk_bf16_f32 v81, v82, v83
    ds_wrxchg_rtn_b64 v[74:75], v93, v[80:81] offset:65408
    v_cvt_pk_bf16_f32 v76, v76, v77
    v_cvt_pk_bf16_f32 v77, v78, v79
    ds_wrxchg_rtn_b64 v[72:73], v92, v[76:77] offset:65408
    s_setprio 1
    s_waitcnt lgkmcnt(2)
    v_mfma_f32_4x4x4_16b_bf16 v[80:83], v[8:9], v[106:107], 0
    v_mfma_f32_4x4x4_16b_bf16 v[76:79], v[8:9], v[104:105], 0
    v_bitop3_b32 v15, v6, v15, v46 bitop3:0xca
    v_bitop3_b32 v14, v6, v14, v47 bitop3:0xca
    s_nop 1
    v_pk_mul_f32 v[80:81], v[80:81], v[14:15] op_sel:[0,1] op_sel_hi:[1,1]
    v_pk_mul_f32 v[82:83], v[82:83], v[14:15] op_sel:[0,1] op_sel_hi:[1,1]
    v_pk_mul_f32 v[76:77], v[76:77], v[14:15] op_sel:[0,0] op_sel_hi:[1,0]
    v_pk_mul_f32 v[78:79], v[78:79], v[14:15] op_sel:[0,0] op_sel_hi:[1,0]
    v_and_b32 v47, 0x0fffffff, v41
    v_mov_b32 v27, v41
    buffer_load_dwordx2 v[22:23], v47, s[8:11], 0 offen
    buffer_load_dwordx3 v[24:26], v47, s[8:11], 0 offen offset:8
    s_waitcnt lgkmcnt(0)
    v_cmpx_ne_u64 vcc, v[74:75], v[70:71]
    s_and_b64 s[82:83], vcc, s[80:81]
    s_cbranch_scc1 L2_c126
L2_d126:
    v_mov_b64 v[84:85], v[70:71]
    v_mov_b32 v7, v93
    v_mov_b64 v[86:87], v[74:75]
    s_mov_b64 exec, -1
    s_or_b64 s[80:81], s[80:81], vcc
    v_cmpx_ne_u64 vcc, v[72:73], v[68:69]
    s_and_b64 s[82:83], vcc, s[80:81]
    s_cbranch_scc1 L2_c127
L2_d127:
    v_mov_b64 v[84:85], v[68:69]
    v_mov_b32 v7, v92
    v_mov_b64 v[86:87], v[72:73]
    s_mov_b64 exec, -1
    s_or_b64 s[80:81], s[80:81], vcc
    ds_read_b64 v[70:71], v95 offset:65408
    ds_read_b64 v[68:69], v94 offset:65408
    s_waitcnt vmcnt(11)
    v_and_b32 v46, 0x20000000, v33
    v_lshrrev_b32 v47, 14, v29
    v_bitop3_b32 v47, v47, v5, v46 bitop3:0xea
    ds_read_b64 v[102:103], v47
    v_bitop3_b32 v93, v29, v5, v46 bitop3:0xea
    v_and_b32 v46, 0x10000000, v33
    v_lshrrev_b32 v47, 14, v28
    v_bitop3_b32 v47, v47, v5, v46 bitop3:0xea
    ds_read_b64 v[100:101], v47
    v_bitop3_b32 v92, v28, v5, v46 bitop3:0xea
    s_waitcnt lgkmcnt(2)
    v_mfma_f32_4x4x4_16b_bf16 v[80:83], v[10:11], v[70:71], v[80:83]
    v_mfma_f32_4x4x4_16b_bf16 v[76:79], v[10:11], v[68:69], v[76:79]
    v_perm_b32 v15, v29, v32, s45
    v_bitop3_b32 v46, v29, 0.5, -0.5 bitop3:0xa8
    v_perm_b32 v14, v28, v32, s44
    v_bitop3_b32 v47, v28, 0.5, -0.5 bitop3:0xa8
    v_cvt_pk_bf16_f32 v80, v80, v81
    v_cvt_pk_bf16_f32 v81, v82, v83
    ds_wrxchg_rtn_b64 v[74:75], v95, v[80:81] offset:65408
    v_cvt_pk_bf16_f32 v76, v76, v77
    v_cvt_pk_bf16_f32 v77, v78, v79
    ds_wrxchg_rtn_b64 v[72:73], v94, v[76:77] offset:65408
    s_waitcnt lgkmcnt(2)
    v_mfma_f32_4x4x4_16b_bf16 v[80:83], v[8:9], v[102:103], 0
    v_mfma_f32_4x4x4_16b_bf16 v[76:79], v[8:9], v[100:101], 0
    v_bitop3_b32 v15, v6, v15, v46 bitop3:0xca
    v_bitop3_b32 v14, v6, v14, v47 bitop3:0xca
    v_cmp_lt_u32 s[84:85], v5, v92
    s_nop 0
    v_pk_mul_f32 v[80:81], v[80:81], v[14:15] op_sel:[0,1] op_sel_hi:[1,1]
    v_pk_mul_f32 v[82:83], v[82:83], v[14:15] op_sel:[0,1] op_sel_hi:[1,1]
    v_pk_mul_f32 v[76:77], v[76:77], v[14:15] op_sel:[0,0] op_sel_hi:[1,0]
    v_pk_mul_f32 v[78:79], v[78:79], v[14:15] op_sel:[0,0] op_sel_hi:[1,0]
    s_waitcnt lgkmcnt(0)
    v_cmpx_ne_u64 vcc, v[74:75], v[70:71]
    s_and_b64 s[82:83], vcc, s[80:81]
    s_cbranch_scc1 L2_c128
L2_d128:
    v_mov_b64 v[84:85], v[70:71]
    v_mov_b32 v7, v95
    v_mov_b64 v[86:87], v[74:75]
    s_mov_b64 exec, -1
    s_or_b64 s[80:81], s[80:81], vcc
    v_cmpx_ne_u64 vcc, v[72:73], v[68:69]
    s_and_b64 s[82:83], vcc, s[80:81]
    s_cbranch_scc1 L2_c129
L2_d129:
    v_mov_b64 v[84:85], v[68:69]
    v_mov_b32 v7, v94
    v_mov_b64 v[86:87], v[72:73]
    s_mov_b64 exec, -1
    s_or_b64 s[80:81], s[80:81], vcc
    ds_read_b64 v[70:71], v93 offset:65408
    s_and_b64 exec, s[84:85], s[80:81]
    v_mfma_f32_4x4x4_16b_bf16 v[76:79], v[12:13], v[84:85], 0
    v_mov_b32 v92, v7
    s_andn2_b64 s[80:81], s[80:81], s[84:85]
    v_mfma_f32_4x4x4_16b_bf16 v[76:79], v[10:11], v[86:87], v[76:79]
    s_mov_b64 exec, -1
    ds_read_b64 v[68:69], v92 offset:65408
    v_and_b32 v46, 0x80000000, v33
    v_lshrrev_b32 v47, 14, v31
    v_bitop3_b32 v47, v47, v5, v46 bitop3:0xea
    ds_read_b64 v[106:107], v47
    v_bitop3_b32 v95, v31, v5, v46 bitop3:0xea
    v_and_b32 v46, 0x40000000, v33
    v_lshrrev_b32 v47, 14, v30
    v_bitop3_b32 v47, v47, v5, v46 bitop3:0xea
    ds_read_b64 v[104:105], v47
    v_bitop3_b32 v94, v30, v5, v46 bitop3:0xea
    s_waitcnt lgkmcnt(2)
    v_mfma_f32_4x4x4_16b_bf16 v[80:83], v[10:11], v[70:71], v[80:83]
    v_mfma_f32_4x4x4_16b_bf16 v[76:79], v[10:11], v[68:69], v[76:79]
    v_perm_b32 v15, v31, v32, s47
    v_bitop3_b32 v46, v31, 0.5, -0.5 bitop3:0xa8
    v_perm_b32 v14, v30, v32, s46
    v_bitop3_b32 v47, v30, 0.5, -0.5 bitop3:0xa8
    v_cvt_pk_bf16_f32 v80, v80, v81
    v_cvt_pk_bf16_f32 v81, v82, v83
    ds_wrxchg_rtn_b64 v[74:75], v93, v[80:81] offset:65408
    v_cvt_pk_bf16_f32 v76, v76, v77
    v_cvt_pk_bf16_f32 v77, v78, v79
    ds_wrxchg_rtn_b64 v[72:73], v92, v[76:77] offset:65408
    s_setprio 0
    s_waitcnt lgkmcnt(2)
    v_mfma_f32_4x4x4_16b_bf16 v[80:83], v[8:9], v[106:107], 0
    v_mfma_f32_4x4x4_16b_bf16 v[76:79], v[8:9], v[104:105], 0
    v_bitop3_b32 v15, v6, v15, v46 bitop3:0xca
    v_bitop3_b32 v14, v6, v14, v47 bitop3:0xca
    s_nop 1
    v_pk_mul_f32 v[80:81], v[80:81], v[14:15] op_sel:[0,1] op_sel_hi:[1,1]
    v_pk_mul_f32 v[82:83], v[82:83], v[14:15] op_sel:[0,1] op_sel_hi:[1,1]
    v_pk_mul_f32 v[76:77], v[76:77], v[14:15] op_sel:[0,0] op_sel_hi:[1,0]
    v_pk_mul_f32 v[78:79], v[78:79], v[14:15] op_sel:[0,0] op_sel_hi:[1,0]
    s_add_u32 s40, s40, 0xfff24000
    v_and_b32 v47, 0x0fffffff, v42
    v_mov_b32 v33, v42
    buffer_load_dwordx2 v[28:29], v47, s[8:11], 0 offen
    buffer_load_dwordx3 v[30:32], v47, s[8:11], 0 offen offset:8
    s_waitcnt lgkmcnt(0)
    v_cmpx_ne_u64 vcc, v[74:75], v[70:71]
    s_and_b64 s[82:83], vcc, s[80:81]
    s_cbranch_scc1 L2_c130
L2_d130:
    v_mov_b64 v[84:85], v[70:71]
    v_mov_b32 v7, v93
    v_mov_b64 v[86:87], v[74:75]
    s_mov_b64 exec, -1
    s_or_b64 s[80:81], s[80:81], vcc
    v_cmpx_ne_u64 vcc, v[72:73], v[68:69]
    s_and_b64 s[82:83], vcc, s[80:81]
    s_cbranch_scc1 L2_c131
L2_d131:
    v_mov_b64 v[84:85], v[68:69]
    v_mov_b32 v7, v92
    v_mov_b64 v[86:87], v[72:73]
    s_mov_b64 exec, -1
    s_or_b64 s[80:81], s[80:81], vcc
    ds_read_b64 v[70:71], v95 offset:65408
    ds_read_b64 v[68:69], v94 offset:65408
    s_waitcnt vmcnt(8)
    v_and_b32 v46, 0x20000000, v39
    v_lshrrev_b32 v47, 14, v35
    v_bitop3_b32 v47, v47, v5, v46 bitop3:0xea
    ds_read_b64 v[102:103], v47
    v_bitop3_b32 v93, v35, v5, v46 bitop3:0xea
    v_and_b32 v46, 0x10000000, v39
    v_lshrrev_b32 v47, 14, v34
    v_bitop3_b32 v47, v47, v5, v46 bitop3:0xea
    ds_read_b64 v[100:101], v47
    v_bitop3_b32 v92, v34, v5, v46 bitop3:0xea
    v_and_b32 v46, 0x80000000, v39
    v_lshrrev_b32 v47, 14, v37
    v_bitop3_b32 v47, v47, v5, v46 bitop3:0xea
    ds_read_b64 v[106:107], v47
    v_and_b32 v46, 0x40000000, v39
    v_lshrrev_b32 v47, 14, v36
    v_bitop3_b32 v47, v47, v5, v46 bitop3:0xea
    ds_read_b64 v[104:105], v47
    s_waitcnt lgkmcnt(4)
    v_mfma_f32_4x4x4_16b_bf16 v[80:83], v[10:11], v[70:71], v[80:83]
    v_mfma_f32_4x4x4_16b_bf16 v[76:79], v[10:11], v[68:69], v[76:79]
    v_perm_b32 v15, v35, v38, s45
    v_bitop3_b32 v46, v35, 0.5, -0.5 bitop3:0xa8
    v_perm_b32 v14, v34, v38, s44
    v_bitop3_b32 v47, v34, 0.5, -0.5 bitop3:0xa8
    v_cvt_pk_bf16_f32 v80, v80, v81
    v_cvt_pk_bf16_f32 v81, v82, v83
    ds_wrxchg_rtn_b64 v[74:75], v95, v[80:81] offset:65408
    v_cvt_pk_bf16_f32 v76, v76, v77
    v_cvt_pk_bf16_f32 v77, v78, v79
    ds_wrxchg_rtn_b64 v[72:73], v94, v[76:77] offset:65408
    s_waitcnt lgkmcnt(2)
    s_barrier
    s_setprio 3
    s_mov_b32 m0, s100
    s_nop 0
    ds_write_addtid_b32 v116 offset:32768
    ds_write_addtid_b32 v117 offset:33024
    ds_write_addtid_b32 v118 offset:33280
    ds_write_addtid_b32 v119 offset:33536
    ds_write_addtid_b32 v120 offset:33792
    ds_write_addtid_b32 v121 offset:34048
    ds_write_addtid_b32 v122 offset:34304
    ds_write_addtid_b32 v123 offset:34560
    v_mfma_f32_4x4x4_16b_bf16 v[80:83], v[8:9], v[102:103], 0
    v_mfma_f32_4x4x4_16b_bf16 v[76:79], v[8:9], v[100:101], 0
    v_bitop3_b32 v15, v6, v15, v46 bitop3:0xca
    v_bitop3_b32 v14, v6, v14, v47 bitop3:0xca
    v_cmp_lt_u32 s[84:85], v5, v92
    s_nop 0
    v_pk_mul_f32 v[80:81], v[80:81], v[14:15] op_sel:[0,1] op_sel_hi:[1,1]
    v_pk_mul_f32 v[82:83], v[82:83], v[14:15] op_sel:[0,1] op_sel_hi:[1,1]
    v_pk_mul_f32 v[76:77], v[76:77], v[14:15] op_sel:[0,0] op_sel_hi:[1,0]
    v_pk_mul_f32 v[78:79], v[78:79], v[14:15] op_sel:[0,0] op_sel_hi:[1,0]
    v_mov_b32 v44, v43
    s_setprio 2
    ds_write_addtid_b32 v124 offset:34816
    ds_write_addtid_b32 v125 offset:35072
    ds_write_addtid_b32 v126 offset:35328
    ds_write_addtid_b32 v127 offset:35584
    s_waitcnt lgkmcnt(12)
    v_cmpx_ne_u64 vcc, v[74:75], v[70:71]
    s_and_b64 s[82:83], vcc, s[80:81]
    s_cbranch_scc1 L2_c132
L2_d132:
    v_mov_b64 v[84:85], v[70:71]
    v_mov_b32 v7, v95
    v_mov_b64 v[86:87], v[74:75]
    s_mov_b64 exec, -1
    s_or_b64 s[80:81], s[80:81], vcc
    v_cmpx_ne_u64 vcc, v[72:73], v[68:69]
    s_and_b64 s[82:83], vcc, s[80:81]
    s_cbranch_scc1 L2_c133
L2_d133:
    v_mov_b64 v[84:85], v[68:69]
    v_mov_b32 v7, v94
    v_mov_b64 v[86:87], v[72:73]
    s_mov_b64 exec, -1
    s_or_b64 s[80:81], s[80:81], vcc
    ds_read_b64 v[70:71], v93 offset:65408
    s_and_b64 exec, s[84:85], s[80:81]
    v_mfma_f32_4x4x4_16b_bf16 v[76:79], v[12:13], v[84:85], 0
    v_mov_b32 v92, v7
    s_andn2_b64 s[80:81], s[80:81], s[84:85]
    v_mfma_f32_4x4x4_16b_bf16 v[76:79], v[10:11], v[86:87], v[76:79]
    s_mov_b64 exec, -1
    ds_read_b64 v[68:69], v92 offset:65408
    s_setprio 1
    s_waitcnt vmcnt(7)
    s_mov_b32 m0, s38
    s_nop 0
    ds_write_addtid_b32 v108 offset:0
    ds_write_addtid_b32 v109 offset:256
    ds_write_addtid_b32 v110 offset:512
    ds_write_addtid_b32 v111 offset:768
    s_waitcnt lgkmcnt(4)
    v_mfma_f32_4x4x4_16b_bf16 v[80:83], v[10:11], v[70:71], v[80:83]
    v_mfma_f32_4x4x4_16b_bf16 v[76:79], v[10:11], v[68:69], v[76:79]
    v_and_b32 v46, 0x40000000, v39
    v_bitop3_b32 v94, v36, v5, v46 bitop3:0xea
    v_and_b32 v46, 0x80000000, v39
    v_bitop3_b32 v95, v37, v5, v46 bitop3:0xea
    v_perm_b32 v15, v37, v38, s47
    v_bitop3_b32 v46, v37, 0.5, -0.5 bitop3:0xa8
    v_perm_b32 v14, v36, v38, s46
    v_bitop3_b32 v47, v36, 0.5, -0.5 bitop3:0xa8
    v_cvt_pk_bf16_f32 v80, v80, v81
    v_cvt_pk_bf16_f32 v81, v82, v83
    ds_wrxchg_rtn_b64 v[74:75], v93, v[80:81] offset:65408
    v_cvt_pk_bf16_f32 v76, v76, v77
    v_cvt_pk_bf16_f32 v77, v78, v79
    ds_wrxchg_rtn_b64 v[72:73], v92, v[76:77] offset:65408
    s_setprio 0
    s_waitcnt vmcnt(4)
    ds_write_addtid_b32 v112 offset:1024
    ds_write_addtid_b32 v113 offset:1280
    ds_write_addtid_b32 v114 offset:1536
    ds_write_addtid_b32 v115 offset:1792
    v_mfma_f32_4x4x4_16b_bf16 v[80:83], v[8:9], v[106:107], 0
    v_mfma_f32_4x4x4_16b_bf16 v[76:79], v[8:9], v[104:105], 0
    v_bitop3_b32 v15, v6, v15, v46 bitop3:0xca
    v_bitop3_b32 v14, v6, v14, v47 bitop3:0xca
    s_nop 1
    v_pk_mul_f32 v[80:81], v[80:81], v[14:15] op_sel:[0,1] op_sel_hi:[1,1]
    v_pk_mul_f32 v[82:83], v[82:83], v[14:15] op_sel:[0,1] op_sel_hi:[1,1]
    v_pk_mul_f32 v[76:77], v[76:77], v[14:15] op_sel:[0,0] op_sel_hi:[1,0]
    v_pk_mul_f32 v[78:79], v[78:79], v[14:15] op_sel:[0,0] op_sel_hi:[1,0]
    s_add_u32 s42, s42, 1
    s_waitcnt lgkmcnt(0)
    s_barrier
    s_bitcmp1_b32 s36, s42
    s_cbranch_scc1 L2_slow
L2_ret7:
    s_setprio 3
    v_and_b32 v47, 0x0fffffff, v44
    v_mov_b32 v39, v44
    buffer_load_dwordx2 v[34:35], v47, s[8:11], 0 offen
    buffer_load_dwordx3 v[36:38], v47, s[8:11], 0 offen offset:8
    v_cmpx_ne_u64 vcc, v[74:75], v[70:71]
    s_and_b64 s[82:83], vcc, s[80:81]
    s_cbranch_scc1 L2_c134
L2_d134:
    v_mov_b64 v[84:85], v[70:71]
    v_mov_b32 v7, v93
    v_mov_b64 v[86:87], v[74:75]
    s_mov_b64 exec, -1
    s_or_b64 s[80:81], s[80:81], vcc
    v_cmpx_ne_u64 vcc, v[72:73], v[68:69]
    s_and_b64 s[82:83], vcc, s[80:81]
    s_cbranch_scc1 L2_c135
L2_d135:
    v_mov_b64 v[84:85], v[68:69]
    v_mov_b32 v7, v92
    v_mov_b64 v[86:87], v[72:73]
    s_mov_b64 exec, -1
    s_or_b64 s[80:81], s[80:81], vcc
    ds_read_b64 v[70:71], v95 offset:65408
    ds_read_b64 v[68:69], v94 offset:65408
    v_and_b32 v46, 0x20000000, v21
    v_lshrrev_b32 v47, 14, v17
    v_bitop3_b32 v47, v47, v5, v46 bitop3:0xea
    ds_read_b64 v[102:103], v47
    v_bitop3_b32 v93, v17, v5, v46 bitop3:0xea
    v_and_b32 v46, 0x10000000, v21
    v_lshrrev_b32 v47, 14, v16
    v_bitop3_b32 v47, v47, v5, v46 bitop3:0xea
    ds_read_b64 v[100:101], v47
    v_bitop3_b32 v92, v16, v5, v46 bitop3:0xea
    s_waitcnt lgkmcnt(2)
    v_mfma_f32_4x4x4_16b_bf16 v[80:83], v[10:11], v[70:71], v[80:83]
    v_mfma_f32_4x4x4_16b_bf16 v[76:79], v[10:11], v[68:69], v[76:79]
    v_perm_b32 v15, v17, v20, s45
    v_bitop3_b32 v46, v17, 0.5, -0.5 bitop3:0xa8
    v_perm_b32 v14, v16, v20, s44
    v_bitop3_b32 v47, v16, 0.5, -0.5 bitop3:0xa8
    v_cvt_pk_bf16_f32 v80, v80, v81
    v_cvt_pk_bf16_f32 v81, v82, v83
    ds_wrxchg_rtn_b64 v[74:75], v95, v[80:81] offset:65408
    v_cvt_pk_bf16_f32 v76, v76, v77
    v_cvt_pk_bf16_f32 v77, v78, v79
    ds_wrxchg_rtn_b64 v[72:73], v94, v[76:77] offset:65408
    s_waitcnt lgkmcnt(2)
    v_mfma_f32_4x4x4_16b_bf16 v[80:83], v[8:9], v[102:103], 0
    v_mfma_f32_4x4x4_16b_bf16 v[76:79], v[8:9], v[100:101], 0
    v_bitop3_b32 v15, v6, v15, v46 bitop3:0xca
    v_bitop3_b32 v14, v6, v14, v47 bitop3:0xca
    v_cmp_lt_u32 s[84:85], v5, v92
    s_nop 0
    v_pk_mul_f32 v[80:81], v[80:81], v[14:15] op_sel:[0,1] op_sel_hi:[1,1]
    v_pk_mul_f32 v[82:83], v[82:83], v[14:15] op_sel:[0,1] op_sel_hi:[1,1]
    v_pk_mul_f32 v[76:77], v[76:77], v[14:15] op_sel:[0,0] op_sel_hi:[1,0]
    v_pk_mul_f32 v[78:79], v[78:79], v[14:15] op_sel:[0,0] op_sel_hi:[1,0]
    s_waitcnt lgkmcnt(0)
    v_cmpx_ne_u64 vcc, v[74:75], v[70:71]
    s_and_b64 s[82:83], vcc, s[80:81]
    s_cbranch_scc1 L2_c136
L2_d136:
    v_mov_b64 v[84:85], v[70:71]
    v_mov_b32 v7, v95
    v_mov_b64 v[86:87], v[74:75]
    s_mov_b64 exec, -1
    s_or_b64 s[80:81], s[80:81], vcc
    v_cmpx_ne_u64 vcc, v[72:73], v[68:69]
    s_and_b64 s[82:83], vcc, s[80:81]
    s_cbranch_scc1 L2_c137
L2_d137:
    v_mov_b64 v[84:85], v[68:69]
    v_mov_b32 v7, v94
    v_mov_b64 v[86:87], v[72:73]
    s_mov_b64 exec, -1
    s_or_b64 s[80:81], s[80:81], vcc
    ds_read_b64 v[70:71], v93 offset:65408
    s_and_b64 exec, s[84:85], s[80:81]
    v_mfma_f32_4x4x4_16b_bf16 v[76:79], v[12:13], v[84:85], 0
    v_mov_b32 v92, v7
    s_andn2_b64 s[80:81], s[80:81], s[84:85]
    v_mfma_f32_4x4x4_16b_bf16 v[76:79], v[10:11], v[86:87], v[76:79]
    s_mov_b64 exec, -1
    ds_read_b64 v[68:69], v92 offset:65408
    v_and_b32 v46, 0x80000000, v21
    v_lshrrev_b32 v47, 14, v19
    v_bitop3_b32 v47, v47, v5, v46 bitop3:0xea
    ds_read_b64 v[106:107], v47
    v_bitop3_b32 v95, v19, v5, v46 bitop3:0xea
    v_and_b32 v46, 0x40000000, v21
    v_lshrrev_b32 v47, 14, v18
    v_bitop3_b32 v47, v47, v5, v46 bitop3:0xea
    ds_read_b64 v[104:105], v47
    v_bitop3_b32 v94, v18, v5, v46 bitop3:0xea
    s_waitcnt lgkmcnt(2)
    v_mfma_f32_4x4x4_16b_bf16 v[80:83], v[10:11], v[70:71], v[80:83]
    v_mfma_f32_4x4x4_16b_bf16 v[76:79], v[10:11], v[68:69], v[76:79]
    v_perm_b32 v15, v19, v20, s47
    v_bitop3_b32 v46, v19, 0.5, -0.5 bitop3:0xa8
    v_perm_b32 v14, v18, v20, s46
    v_bitop3_b32 v47, v18, 0.5, -0.5 bitop3:0xa8
    v_cvt_pk_bf16_f32 v80, v80, v81
    v_cvt_pk_bf16_f32 v81, v82, v83
    ds_wrxchg_rtn_b64 v[74:75], v93, v[80:81] offset:65408
    v_cvt_pk_bf16_f32 v76, v76, v77
    v_cvt_pk_bf16_f32 v77, v78, v79
    ds_wrxchg_rtn_b64 v[72:73], v92, v[76:77] offset:65408
    s_setprio 2
    s_waitcnt lgkmcnt(2)
    v_mfma_f32_4x4x4_16b_bf16 v[80:83], v[8:9], v[106:107], 0
    v_mfma_f32_4x4x4_16b_bf16 v[76:79], v[8:9], v[104:105], 0
    v_bitop3_b32 v15, v6, v15, v46 bitop3:0xca
    v_bitop3_b32 v14, v6, v14, v47 bitop3:0xca
    s_nop 1
    v_pk_mul_f32 v[80:81], v[80:81], v[14:15] op_sel:[0,1] op_sel_hi:[1,1]
    v_pk_mul_f32 v[82:83], v[82:83], v[14:15] op_sel:[0,1] op_sel_hi:[1,1]
    v_pk_mul_f32 v[76:77], v[76:77], v[14:15] op_sel:[0,0] op_sel_hi:[1,0]
    v_pk_mul_f32 v[78:79], v[78:79], v[14:15] op_sel:[0,0] op_sel_hi:[1,0]
    s_lshl_b32 s3, s32, 12
    v_subrev_u32 v122, s3, v3
    s_mul_i32 s3, s33, 20000
    v_add_u32 v118, s3, v122
    v_add_u32 v119, 0x4000, v118
    s_lshl_b32 s3, s34, 7
    v_lshrrev_b32 v123, 7, v118
    v_and_b32 v120, 0x70, v118
    v_lshl_add_u32 v120, v123, 13, v120
    v_add_u32 v120, s3, v120
    v_lshrrev_b32 v123, 7, v119
    v_and_b32 v121, 0x70, v119
    v_lshl_add_u32 v121, v123, 13, v121
    v_add_u32 v121, s3, v121
    v_cmp_le_u32 vcc, 3616, v122
    s_mov_b64 exec, vcc
    v_mov_b32 v119, 2.0
    v_mov_b32 v121, 2.0
    s_mov_b64 exec, -1
    v_and_b32 v123, 0x30, v122
    v_lshlrev_b32 v123, 2, v123
    buffer_load_dwordx4 v[48:51], v123, s[24:27], 0 offen
    buffer_load_dwordx4 v[52:55], v123, s[24:27], 0 offen offset:16
    buffer_load_dwordx2 v[56:57], v123, s[24:27], 0 offen offset:32
    s_mov_b32 s12, s4
    s_mov_b32 s13, s5
    s_mov_b32 s14, 0x138800
    s_mov_b32 s15, 0x20000
    s_mov_b32 s16, s28
    s_mov_b32 s17, s29
    s_mov_b32 s18, 0x4e2000
    s_mov_b32 s19, 0x20000
    v_lshrrev_b32 v123, 2, v120
    buffer_load_dword v116, v123, s[12:15], 0 offen
    buffer_load_dwordx4 v[108:111], v120, s[16:19], 0 offen
    v_lshrrev_b32 v123, 2, v121
    buffer_load_dword v117, v123, s[12:15], 0 offen
    buffer_load_dwordx4 v[112:115], v121, s[16:19], 0 offen
    s_waitcnt lgkmcnt(0)
    v_cmpx_ne_u64 vcc, v[74:75], v[70:71]
    s_and_b64 s[82:83], vcc, s[80:81]
    s_cbranch_scc1 L2_c138
L2_d138:
    v_mov_b64 v[84:85], v[70:71]
    v_mov_b32 v7, v93
    v_mov_b64 v[86:87], v[74:75]
    s_mov_b64 exec, -1
    s_or_b64 s[80:81], s[80:81], vcc
    v_cmpx_ne_u64 vcc, v[72:73], v[68:69]
    s_and_b64 s[82:83], vcc, s[80:81]
    s_cbranch_scc1 L2_c139
L2_d139:
    v_mov_b64 v[84:85], v[68:69]
    v_mov_b32 v7, v92
    v_mov_b64 v[86:87], v[72:73]
    s_mov_b64 exec, -1
    s_or_b64 s[80:81], s[80:81], vcc
    ds_read_b64 v[70:71], v95 offset:65408
    ds_read_b64 v[68:69], v94 offset:65408
    s_waitcnt vmcnt(11)
    v_and_b32 v46, 0x20000000, v27
    v_lshrrev_b32 v47, 14, v23
    v_bitop3_b32 v47, v47, v5, v46 bitop3:0xea
    ds_read_b64 v[102:103], v47
    v_bitop3_b32 v93, v23, v5, v46 bitop3:0xea
    v_and_b32 v46, 0x10000000, v27
    v_lshrrev_b32 v47, 14, v22
    v_bitop3_b32 v47, v47, v5, v46 bitop3:0xea
    ds_read_b64 v[100:101], v47
    v_bitop3_b32 v92, v22, v5, v46 bitop3:0xea
    s_waitcnt lgkmcnt(2)
    v_mfma_f32_4x4x4_16b_bf16 v[80:83], v[10:11], v[70:71], v[80:83]
    v_mfma_f32_4x4x4_16b_bf16 v[76:79], v[10:11], v[68:69], v[76:79]
    v_perm_b32 v15, v23, v26, s45
    v_bitop3_b32 v46, v23, 0.5, -0.5 bitop3:0xa8
    v_perm_b32 v14, v22, v26, s44
    v_bitop3_b32 v47, v22, 0.5, -0.5 bitop3:0xa8
    v_cvt_pk_bf16_f32 v80, v80, v81
    v_cvt_pk_bf16_f32 v81, v82, v83
    ds_wrxchg_rtn_b64 v[74:75], v95, v[80:81] offset:65408
    v_cvt_pk_bf16_f32 v76, v76, v77
    v_cvt_pk_bf16_f32 v77, v78, v79
    ds_wrxchg_rtn_b64 v[72:73], v94, v[76:77] offset:65408
    s_waitcnt lgkmcnt(2)
    v_mfma_f32_4x4x4_16b_bf16 v[80:83], v[8:9], v[102:103], 0
    v_mfma_f32_4x4x4_16b_bf16 v[76:79], v[8:9], v[100:101], 0
    v_bitop3_b32 v15, v6, v15, v46 bitop3:0xca
    v_bitop3_b32 v14, v6, v14, v47 bitop3:0xca
    v_cmp_lt_u32 s[84:85], v5, v92
    s_nop 0
    v_pk_mul_f32 v[80:81], v[80:81], v[14:15] op_sel:[0,1] op_sel_hi:[1,1]
    v_pk_mul_f32 v[82:83], v[82:83], v[14:15] op_sel:[0,1] op_sel_hi:[1,1]
    v_pk_mul_f32 v[76:77], v[76:77], v[14:15] op_sel:[0,0] op_sel_hi:[1,0]
    v_pk_mul_f32 v[78:79], v[78:79], v[14:15] op_sel:[0,0] op_sel_hi:[1,0]
    s_waitcnt lgkmcnt(0)
    v_cmpx_ne_u64 vcc, v[74:75], v[70:71]
    s_and_b64 s[82:83], vcc, s[80:81]
    s_cbranch_scc1 L2_c140
L2_d140:
    v_mov_b64 v[84:85], v[70:71]
    v_mov_b32 v7, v95
    v_mov_b64 v[86:87], v[74:75]
    s_mov_b64 exec, -1
    s_or_b64 s[80:81], s[80:81], vcc
    v_cmpx_ne_u64 vcc, v[72:73], v[68:69]
    s_and_b64 s[82:83], vcc, s[80:81]
    s_cbranch_scc1 L2_c141
L2_d141:
    v_mov_b64 v[84:85], v[68:69]
    v_mov_b32 v7, v94
    v_mov_b64 v[86:87], v[72:73]
    s_mov_b64 exec, -1
    s_or_b64 s[80:81], s[80:81], vcc
    ds_read_b64 v[70:71], v93 offset:65408
    s_and_b64 exec, s[84:85], s[80:81]
    v_mfma_f32_4x4x4_16b_bf16 v[76:79], v[12:13], v[84:85], 0
    v_mov_b32 v92, v7
    s_andn2_b64 s[80:81], s[80:81], s[84:85]
    v_mfma_f32_4x4x4_16b_bf16 v[76:79], v[10:11], v[86:87], v[76:79]
    s_mov_b64 exec, -1
    ds_read_b64 v[68:69], v92 offset:65408
    v_and_b32 v46, 0x80000000, v27
    v_lshrrev_b32 v47, 14, v25
    v_bitop3_b32 v47, v47, v5, v46 bitop3:0xea
    ds_read_b64 v[106:107], v47
    v_bitop3_b32 v95, v25, v5, v46 bitop3:0xea
    v_and_b32 v46, 0x40000000, v27
    v_lshrrev_b32 v47, 14, v24
    v_bitop3_b32 v47, v47, v5, v46 bitop3:0xea
    ds_read_b64 v[104:105], v47
    v_bitop3_b32 v94, v24, v5, v46 bitop3:0xea
    s_waitcnt lgkmcnt(2)
    v_mfma_f32_4x4x4_16b_bf16 v[80:83], v[10:11], v[70:71], v[80:83]
    v_mfma_f32_4x4x4_16b_bf16 v[76:79], v[10:11], v[68:69], v[76:79]
    v_perm_b32 v15, v25, v26, s47
    v_bitop3_b32 v46, v25, 0.5, -0.5 bitop3:0xa8
    v_perm_b32 v14, v24, v26, s46
    v_bitop3_b32 v47, v24, 0.5, -0.5 bitop3:0xa8
    v_cvt_pk_bf16_f32 v80, v80, v81
    v_cvt_pk_bf16_f32 v81, v82, v83
    ds_wrxchg_rtn_b64 v[74:75], v93, v[80:81] offset:65408
    v_cvt_pk_bf16_f32 v76, v76, v77
    v_cvt_pk_bf16_f32 v77, v78, v79
    ds_wrxchg_rtn_b64 v[72:73], v92, v[76:77] offset:65408
    s_setprio 1
    s_waitcnt lgkmcnt(2)
    v_mfma_f32_4x4x4_16b_bf16 v[80:83], v[8:9], v[106:107], 0
    v_mfma_f32_4x4x4_16b_bf16 v[76:79], v[8:9], v[104:105], 0
    v_bitop3_b32 v15, v6, v15, v46 bitop3:0xca
    v_bitop3_b32 v14, v6, v14, v47 bitop3:0xca
    s_nop 1
    v_pk_mul_f32 v[80:81], v[80:81], v[14:15] op_sel:[0,1] op_sel_hi:[1,1]
    v_pk_mul_f32 v[82:83], v[82:83], v[14:15] op_sel:[0,1] op_sel_hi:[1,1]
    v_pk_mul_f32 v[76:77], v[76:77], v[14:15] op_sel:[0,0] op_sel_hi:[1,0]
    v_pk_mul_f32 v[78:79], v[78:79], v[14:15] op_sel:[0,0] op_sel_hi:[1,0]
    s_waitcnt lgkmcnt(0)
    v_cmpx_ne_u64 vcc, v[74:75], v[70:71]
    s_and_b64 s[82:83], vcc, s[80:81]
    s_cbranch_scc1 L2_c142
L2_d142:
    v_mov_b64 v[84:85], v[70:71]
    v_mov_b32 v7, v93
    v_mov_b64 v[86:87], v[74:75]
    s_mov_b64 exec, -1
    s_or_b64 s[80:81], s[80:81], vcc
    v_cmpx_ne_u64 vcc, v[72:73], v[68:69]
    s_and_b64 s[82:83], vcc, s[80:81]
    s_cbranch_scc1 L2_c143
L2_d143:
    v_mov_b64 v[84:85], v[68:69]
    v_mov_b32 v7, v92
    v_mov_b64 v[86:87], v[72:73]
    s_mov_b64 exec, -1
    s_or_b64 s[80:81], s[80:81], vcc
    ds_read_b64 v[70:71], v95 offset:65408
    ds_read_b64 v[68:69], v94 offset:65408
    s_waitcnt vmcnt(9)
    v_and_b32 v46, 0x20000000, v33
    v_lshrrev_b32 v47, 14, v29
    v_bitop3_b32 v47, v47, v5, v46 bitop3:0xea
    ds_read_b64 v[102:103], v47
    v_bitop3_b32 v93, v29, v5, v46 bitop3:0xea
    v_and_b32 v46, 0x10000000, v33
    v_lshrrev_b32 v47, 14, v28
    v_bitop3_b32 v47, v47, v5, v46 bitop3:0xea
    ds_read_b64 v[100:101], v47
    v_bitop3_b32 v92, v28, v5, v46 bitop3:0xea
    s_waitcnt lgkmcnt(2)
    v_mfma_f32_4x4x4_16b_bf16 v[80:83], v[10:11], v[70:71], v[80:83]
    v_mfma_f32_4x4x4_16b_bf16 v[76:79], v[10:11], v[68:69], v[76:79]
    v_perm_b32 v15, v29, v32, s45
    v_bitop3_b32 v46, v29, 0.5, -0.5 bitop3:0xa8
    v_perm_b32 v14, v28, v32, s44
    v_bitop3_b32 v47, v28, 0.5, -0.5 bitop3:0xa8
    v_cvt_pk_bf16_f32 v80, v80, v81
    v_cvt_pk_bf16_f32 v81, v82, v83
    ds_wrxchg_rtn_b64 v[74:75], v95, v[80:81] offset:65408
    v_cvt_pk_bf16_f32 v76, v76, v77
    v_cvt_pk_bf16_f32 v77, v78, v79
    ds_wrxchg_rtn_b64 v[72:73], v94, v[76:77] offset:65408
    s_waitcnt lgkmcnt(2)
    v_mfma_f32_4x4x4_16b_bf16 v[80:83], v[8:9], v[102:103], 0
    v_mfma_f32_4x4x4_16b_bf16 v[76:79], v[8:9], v[100:101], 0
    v_bitop3_b32 v15, v6, v15, v46 bitop3:0xca
    v_bitop3_b32 v14, v6, v14, v47 bitop3:0xca
    v_cmp_lt_u32 s[84:85], v5, v92
    s_nop 0
    v_pk_mul_f32 v[80:81], v[80:81], v[14:15] op_sel:[0,1] op_sel_hi:[1,1]
    v_pk_mul_f32 v[82:83], v[82:83], v[14:15] op_sel:[0,1] op_sel_hi:[1,1]
    v_pk_mul_f32 v[76:77], v[76:77], v[14:15] op_sel:[0,0] op_sel_hi:[1,0]
    v_pk_mul_f32 v[78:79], v[78:79], v[14:15] op_sel:[0,0] op_sel_hi:[1,0]
    s_waitcnt lgkmcnt(0)
    v_cmpx_ne_u64 vcc, v[74:75], v[70:71]
    s_and_b64 s[82:83], vcc, s[80:81]
    s_cbranch_scc1 L2_c144
L2_d144:
    v_mov_b64 v[84:85], v[70:71]
    v_mov_b32 v7, v95
    v_mov_b64 v[86:87], v[74:75]
    s_mov_b64 exec, -1
    s_or_b64 s[80:81], s[80:81], vcc
    v_cmpx_ne_u64 vcc, v[72:73], v[68:69]
    s_and_b64 s[82:83], vcc, s[80:81]
    s_cbranch_scc1 L2_c145
L2_d145:
    v_mov_b64 v[84:85], v[68:69]
    v_mov_b32 v7, v94
    v_mov_b64 v[86:87], v[72:73]
    s_mov_b64 exec, -1
    s_or_b64 s[80:81], s[80:81], vcc
    ds_read_b64 v[70:71], v93 offset:65408
    s_and_b64 exec, s[84:85], s[80:81]
    v_mfma_f32_4x4x4_16b_bf16 v[76:79], v[12:13], v[84:85], 0
    v_mov_b32 v92, v7
    s_andn2_b64 s[80:81], s[80:81], s[84:85]
    v_mfma_f32_4x4x4_16b_bf16 v[76:79], v[10:11], v[86:87], v[76:79]
    s_mov_b64 exec, -1
    ds_read_b64 v[68:69], v92 offset:65408
    v_and_b32 v46, 0x80000000, v33
    v_lshrrev_b32 v47, 14, v31
    v_bitop3_b32 v47, v47, v5, v46 bitop3:0xea
    ds_read_b64 v[106:107], v47
    v_bitop3_b32 v95, v31, v5, v46 bitop3:0xea
    v_and_b32 v46, 0x40000000, v33
    v_lshrrev_b32 v47, 14, v30
    v_bitop3_b32 v47, v47, v5, v46 bitop3:0xea
    ds_read_b64 v[104:105], v47
    v_bitop3_b32 v94, v30, v5, v46 bitop3:0xea
    s_waitcnt lgkmcnt(2)
    v_mfma_f32_4x4x4_16b_bf16 v[80:83], v[10:11], v[70:71], v[80:83]
    v_mfma_f32_4x4x4_16b_bf16 v[76:79], v[10:11], v[68:69], v[76:79]
    v_perm_b32 v15, v31, v32, s47
    v_bitop3_b32 v46, v31, 0.5, -0.5 bitop3:0xa8
    v_perm_b32 v14, v30, v32, s46
    v_bitop3_b32 v47, v30, 0.5, -0.5 bitop3:0xa8
    v_cvt_pk_bf16_f32 v80, v80, v81
    v_cvt_pk_bf16_f32 v81, v82, v83
    ds_wrxchg_rtn_b64 v[74:75], v93, v[80:81] offset:65408
    v_cvt_pk_bf16_f32 v76, v76, v77
    v_cvt_pk_bf16_f32 v77, v78, v79
    ds_wrxchg_rtn_b64 v[72:73], v92, v[76:77] offset:65408
    s_setprio 0
    s_waitcnt lgkmcnt(2)
    v_mfma_f32_4x4x4_16b_bf16 v[80:83], v[8:9], v[106:107], 0
    v_mfma_f32_4x4x4_16b_bf16 v[76:79], v[8:9], v[104:105], 0
    v_bitop3_b32 v15, v6, v15, v46 bitop3:0xca
    v_bitop3_b32 v14, v6, v14, v47 bitop3:0xca
    s_nop 1
    v_pk_mul_f32 v[80:81], v[80:81], v[14:15] op_sel:[0,1] op_sel_hi:[1,1]
    v_pk_mul_f32 v[82:83], v[82:83], v[14:15] op_sel:[0,1] op_sel_hi:[1,1]
    v_pk_mul_f32 v[76:77], v[76:77], v[14:15] op_sel:[0,0] op_sel_hi:[1,0]
    v_pk_mul_f32 v[78:79], v[78:79], v[14:15] op_sel:[0,0] op_sel_hi:[1,0]
    s_waitcnt lgkmcnt(0)
    v_cmpx_ne_u64 vcc, v[74:75], v[70:71]
    s_and_b64 s[82:83], vcc, s[80:81]
    s_cbranch_scc1 L2_c146
L2_d146:
    v_mov_b64 v[84:85], v[70:71]
    v_mov_b32 v7, v93
    v_mov_b64 v[86:87], v[74:75]
    s_mov_b64 exec, -1
    s_or_b64 s[80:81], s[80:81], vcc
    v_cmpx_ne_u64 vcc, v[72:73], v[68:69]
    s_and_b64 s[82:83], vcc, s[80:81]
    s_cbranch_scc1 L2_c147
L2_d147:
    v_mov_b64 v[84:85], v[68:69]
    v_mov_b32 v7, v92
    v_mov_b64 v[86:87], v[72:73]
    s_mov_b64 exec, -1
    s_or_b64 s[80:81], s[80:81], vcc
    ds_read_b64 v[70:71], v95 offset:65408
    ds_read_b64 v[68:69], v94 offset:65408
    s_waitcnt vmcnt(7)
    v_and_b32 v46, 0x20000000, v39
    v_lshrrev_b32 v47, 14, v35
    v_bitop3_b32 v47, v47, v5, v46 bitop3:0xea
    ds_read_b64 v[102:103], v47
    v_bitop3_b32 v93, v35, v5, v46 bitop3:0xea
    v_and_b32 v46, 0x10000000, v39
    v_lshrrev_b32 v47, 14, v34
    v_bitop3_b32 v47, v47, v5, v46 bitop3:0xea
    ds_read_b64 v[100:101], v47
    v_bitop3_b32 v92, v34, v5, v46 bitop3:0xea
    v_and_b32 v46, 0x80000000, v39
    v_lshrrev_b32 v47, 14, v37
    v_bitop3_b32 v47, v47, v5, v46 bitop3:0xea
    ds_read_b64 v[106:107], v47
    v_and_b32 v46, 0x40000000, v39
    v_lshrrev_b32 v47, 14, v36
    v_bitop3_b32 v47, v47, v5, v46 bitop3:0xea
    ds_read_b64 v[104:105], v47
    s_waitcnt lgkmcnt(4)
    v_mfma_f32_4x4x4_16b_bf16 v[80:83], v[10:11], v[70:71], v[80:83]
    v_mfma_f32_4x4x4_16b_bf16 v[76:79], v[10:11], v[68:69], v[76:79]
    v_perm_b32 v15, v35, v38, s45
    v_bitop3_b32 v46, v35, 0.5, -0.5 bitop3:0xa8
    v_perm_b32 v14, v34, v38, s44
    v_bitop3_b32 v47, v34, 0.5, -0.5 bitop3:0xa8
    v_cvt_pk_bf16_f32 v80, v80, v81
    v_cvt_pk_bf16_f32 v81, v82, v83
    ds_wrxchg_rtn_b64 v[74:75], v95, v[80:81] offset:65408
    v_cvt_pk_bf16_f32 v76, v76, v77
    v_cvt_pk_bf16_f32 v77, v78, v79
    ds_wrxchg_rtn_b64 v[72:73], v94, v[76:77] offset:65408
    s_waitcnt lgkmcnt(4)
    v_mfma_f32_4x4x4_16b_bf16 v[80:83], v[8:9], v[102:103], 0
    v_mfma_f32_4x4x4_16b_bf16 v[76:79], v[8:9], v[100:101], 0
    v_bitop3_b32 v15, v6, v15, v46 bitop3:0xca
    v_bitop3_b32 v14, v6, v14, v47 bitop3:0xca
    v_cmp_lt_u32 s[84:85], v5, v92
    s_nop 0
    v_pk_mul_f32 v[80:81], v[80:81], v[14:15] op_sel:[0,1] op_sel_hi:[1,1]
    v_pk_mul_f32 v[82:83], v[82:83], v[14:15] op_sel:[0,1] op_sel_hi:[1,1]
    v_pk_mul_f32 v[76:77], v[76:77], v[14:15] op_sel:[0,0] op_sel_hi:[1,0]
    v_pk_mul_f32 v[78:79], v[78:79], v[14:15] op_sel:[0,0] op_sel_hi:[1,0]
    s_waitcnt lgkmcnt(0)
    v_cmpx_ne_u64 vcc, v[74:75], v[70:71]
    s_and_b64 s[82:83], vcc, s[80:81]
    s_cbranch_scc1 L2_c148
L2_d148:
    v_mov_b64 v[84:85], v[70:71]
    v_mov_b32 v7, v95
    v_mov_b64 v[86:87], v[74:75]
    s_mov_b64 exec, -1
    s_or_b64 s[80:81], s[80:81], vcc
    v_cmpx_ne_u64 vcc, v[72:73], v[68:69]
    s_and_b64 s[82:83], vcc, s[80:81]
    s_cbranch_scc1 L2_c149
L2_d149:
    v_mov_b64 v[84:85], v[68:69]
    v_mov_b32 v7, v94
    v_mov_b64 v[86:87], v[72:73]
    s_mov_b64 exec, -1
    s_or_b64 s[80:81], s[80:81], vcc
    ds_read_b64 v[70:71], v93 offset:65408
    s_and_b64 exec, s[84:85], s[80:81]
    v_mfma_f32_4x4x4_16b_bf16 v[76:79], v[12:13], v[84:85], 0
    v_mov_b32 v92, v7
    s_andn2_b64 s[80:81], s[80:81], s[84:85]
    v_mfma_f32_4x4x4_16b_bf16 v[76:79], v[10:11], v[86:87], v[76:79]
    s_mov_b64 exec, -1
    ds_read_b64 v[68:69], v92 offset:65408
    s_waitcnt lgkmcnt(0)
    v_mfma_f32_4x4x4_16b_bf16 v[80:83], v[10:11], v[70:71], v[80:83]
    v_mfma_f32_4x4x4_16b_bf16 v[76:79], v[10:11], v[68:69], v[76:79]
    v_and_b32 v46, 0x40000000, v39
    v_bitop3_b32 v94, v36, v5, v46 bitop3:0xea
    v_and_b32 v46, 0x80000000, v39
    v_bitop3_b32 v95, v37, v5, v46 bitop3:0xea
    v_perm_b32 v15, v37, v38, s47
    v_bitop3_b32 v46, v37, 0.5, -0.5 bitop3:0xa8
    v_perm_b32 v14, v36, v38, s46
    v_bitop3_b32 v47, v36, 0.5, -0.5 bitop3:0xa8
    v_cvt_pk_bf16_f32 v80, v80, v81
    v_cvt_pk_bf16_f32 v81, v82, v83
    ds_wrxchg_rtn_b64 v[74:75], v93, v[80:81] offset:65408
    v_cvt_pk_bf16_f32 v76, v76, v77
    v_cvt_pk_bf16_f32 v77, v78, v79
    ds_wrxchg_rtn_b64 v[72:73], v92, v[76:77] offset:65408
    v_mfma_f32_4x4x4_16b_bf16 v[80:83], v[8:9], v[106:107], 0
    v_mfma_f32_4x4x4_16b_bf16 v[76:79], v[8:9], v[104:105], 0
    v_bitop3_b32 v15, v6, v15, v46 bitop3:0xca
    v_bitop3_b32 v14, v6, v14, v47 bitop3:0xca
    s_nop 1
    v_pk_mul_f32 v[80:81], v[80:81], v[14:15] op_sel:[0,1] op_sel_hi:[1,1]
    v_pk_mul_f32 v[82:83], v[82:83], v[14:15] op_sel:[0,1] op_sel_hi:[1,1]
    v_pk_mul_f32 v[76:77], v[76:77], v[14:15] op_sel:[0,0] op_sel_hi:[1,0]
    v_pk_mul_f32 v[78:79], v[78:79], v[14:15] op_sel:[0,0] op_sel_hi:[1,0]
    s_waitcnt lgkmcnt(0)
    v_cmpx_ne_u64 vcc, v[74:75], v[70:71]
    s_and_b64 s[82:83], vcc, s[80:81]
    s_cbranch_scc1 L2_c150
L2_d150:
    v_mov_b64 v[84:85], v[70:71]
    v_mov_b32 v7, v93
    v_mov_b64 v[86:87], v[74:75]
    s_mov_b64 exec, -1
    s_or_b64 s[80:81], s[80:81], vcc
    v_cmpx_ne_u64 vcc, v[72:73], v[68:69]
    s_and_b64 s[82:83], vcc, s[80:81]
    s_cbranch_scc1 L2_c151
L2_d151:
    v_mov_b64 v[84:85], v[68:69]
    v_mov_b32 v7, v92
    v_mov_b64 v[86:87], v[72:73]
    s_mov_b64 exec, -1
    s_or_b64 s[80:81], s[80:81], vcc
    ds_read_b64 v[70:71], v95 offset:65408
    ds_read_b64 v[68:69], v94 offset:65408
    s_waitcnt lgkmcnt(0)
    v_mfma_f32_4x4x4_16b_bf16 v[80:83], v[10:11], v[70:71], v[80:83]
    v_mfma_f32_4x4x4_16b_bf16 v[76:79], v[10:11], v[68:69], v[76:79]
    s_nop 3
    v_cvt_pk_bf16_f32 v80, v80, v81
    v_cvt_pk_bf16_f32 v81, v82, v83
    ds_wrxchg_rtn_b64 v[74:75], v95, v[80:81] offset:65408
    v_cvt_pk_bf16_f32 v76, v76, v77
    v_cvt_pk_bf16_f32 v77, v78, v79
    ds_wrxchg_rtn_b64 v[72:73], v94, v[76:77] offset:65408
    s_waitcnt lgkmcnt(0)
    v_cmpx_ne_u64 vcc, v[74:75], v[70:71]
    s_and_b64 s[82:83], vcc, s[80:81]
    s_cbranch_scc1 L2_c152
L2_d152:
    v_mov_b64 v[84:85], v[70:71]
    v_mov_b32 v7, v95
    v_mov_b64 v[86:87], v[74:75]
    s_mov_b64 exec, -1
    s_or_b64 s[80:81], s[80:81], vcc
    v_cmpx_ne_u64 vcc, v[72:73], v[68:69]
    s_and_b64 s[82:83], vcc, s[80:81]
    s_cbranch_scc1 L2_c153
L2_d153:
    v_mov_b64 v[84:85], v[68:69]
    v_mov_b32 v7, v94
    v_mov_b64 v[86:87], v[72:73]
    s_mov_b64 exec, -1
    s_or_b64 s[80:81], s[80:81], vcc
    s_mov_b64 exec, s[80:81]
    s_nop 1
    v_mfma_f32_4x4x4_16b_bf16 v[88:91], v[12:13], v[84:85], 0
    s_nop 1
    v_mfma_f32_4x4x4_16b_bf16 v[88:91], v[10:11], v[86:87], v[88:91]
    s_nop 4
    v_cvt_pk_bf16_f32 v88, v88, v89
    v_cvt_pk_bf16_f32 v89, v90, v91
    ds_pk_add_bf16 v7, v88 offset:65408
    ds_pk_add_bf16 v7, v89 offset:65412
    s_mov_b64 exec, -1
    s_load_dwordx2 s[4:5], s[0:1], 88
    v_add_u32 v123, 16384, v122
    v_add_u32 v124, 32768, v122
    v_add_u32 v125, 49152, v122
    v_add_u32 v126, 65536, v122
    s_lshl_b32 s50, s96, 16
    s_and_b32 s51, s96, 0xffff0000
    s_lshl_b32 s52, s97, 16
    s_and_b32 s53, s97, 0xffff0000
    s_lshl_b32 s54, s98, 16
    s_and_b32 s55, s98, 0xffff0000
    s_lshl_b32 s56, s99, 16
    s_and_b32 s57, s99, 0xffff0000
    s_waitcnt vmcnt(0) lgkmcnt(0)
    s_barrier
    v_add_u32 v36, 0x8000, v126
    ds_read_b128 v[16:19], v126 offset:16384
    ds_read_b128 v[20:23], v126 offset:32768
    ds_read_b128 v[24:27], v126 offset:49152
    ds_read_b128 v[28:31], v36 offset:32768
    ds_read_b128 v[32:35], v36 offset:49152
    s_add_u32 s8, s30, 0xebca000
    s_addc_u32 s9, s31, 0
    s_mov_b32 s10, 0x8000
    s_mov_b32 s11, 0x20000
    s_mov_b32 s12, s4
    s_mov_b32 s13, s5
    s_mov_b32 s14, 0x4e2000
    s_mov_b32 s15, 0x20000
    s_mul_i32 s3, s33, 20000
    v_subrev_u32 v36, s3, v122
    v_cmp_le_u32 vcc, 20000, v36
    s_waitcnt lgkmcnt(4)
    s_mov_b64 exec, vcc
    buffer_store_dwordx4 v[16:19], v122, s[20:23], 0 offen sc1
    s_mov_b64 exec, -1
    v_subrev_u32 v36, s3, v123
    v_cmp_le_u32 vcc, 20000, v36
    s_waitcnt lgkmcnt(3)
    s_mov_b64 exec, vcc
    buffer_store_dwordx4 v[20:23], v123, s[20:23], 0 offen sc1
    s_mov_b64 exec, -1
    v_subrev_u32 v36, s3, v124
    v_cmp_le_u32 vcc, 20000, v36
    s_waitcnt lgkmcnt(2)
    s_mov_b64 exec, vcc
    buffer_store_dwordx4 v[24:27], v124, s[20:23], 0 offen sc1
    s_mov_b64 exec, -1
    v_subrev_u32 v36, s3, v125
    v_cmp_le_u32 vcc, 20000, v36
    s_waitcnt lgkmcnt(1)
    s_mov_b64 exec, vcc
    buffer_store_dwordx4 v[28:31], v125, s[20:23], 0 offen sc1
    s_mov_b64 exec, -1
    v_subrev_u32 v36, s3, v126
    v_cmp_le_u32 vcc, 20000, v36
    s_waitcnt lgkmcnt(0)
    s_mov_b64 exec, vcc
    buffer_store_dwordx4 v[32:35], v126, s[20:23], 0 offen sc1
    s_mov_b64 exec, -1
    v_lshlrev_b32 v80, 16, v116
    v_subrev_f32 v60, s50, v80
    v_subrev_f32 v61, s51, v80
    v_subrev_f32 v62, s52, v80
    v_subrev_f32 v63, s53, v80
    v_subrev_f32 v64, s54, v80
    v_subrev_f32 v65, s55, v80
    v_subrev_f32 v66, s56, v80
    v_subrev_f32 v67, s57, v80
    v_cvt_pk_bf16_f32 v68, v60, v61
    v_cvt_pk_bf16_f32 v69, v62, v63
    v_cvt_pk_bf16_f32 v70, v64, v65
    v_cvt_pk_bf16_f32 v71, v66, v67
    v_lshlrev_b32 v60, 16, v68
    v_and_b32 v61, 0xffff0000, v68
    v_lshlrev_b32 v62, 16, v69
    v_and_b32 v63, 0xffff0000, v69
    v_lshlrev_b32 v64, 16, v70
    v_and_b32 v65, 0xffff0000, v70
    v_lshlrev_b32 v66, 16, v71
    v_and_b32 v67, 0xffff0000, v71
    v_mul_f32 v60, v60, v60
    v_mul_f32 v61, v61, v61
    v_mul_f32 v62, v62, v62
    v_mul_f32 v63, v63, v63
    v_mul_f32 v64, v64, v64
    v_mul_f32 v65, v65, v65
    v_mul_f32 v66, v66, v66
    v_mul_f32 v67, v67, v67
    v_cvt_pk_bf16_f32 v68, v60, v61
    v_cvt_pk_bf16_f32 v69, v62, v63
    v_cvt_pk_bf16_f32 v70, v64, v65
    v_cvt_pk_bf16_f32 v71, v66, v67
    v_lshlrev_b32 v60, 16, v68
    v_and_b32 v61, 0xffff0000, v68
    v_lshlrev_b32 v62, 16, v69
    v_and_b32 v63, 0xffff0000, v69
    v_lshlrev_b32 v64, 16, v70
    v_and_b32 v65, 0xffff0000, v70
    v_lshlrev_b32 v66, 16, v71
    v_and_b32 v67, 0xffff0000, v71
    v_mul_f32 v60, 0xc1200000, v60
    v_mul_f32 v61, 0xc1200000, v61
    v_mul_f32 v62, 0xc1200000, v62
    v_mul_f32 v63, 0xc1200000, v63
    v_mul_f32 v64, 0xc1200000, v64
    v_mul_f32 v65, 0xc1200000, v65
    v_mul_f32 v66, 0xc1200000, v66
    v_mul_f32 v67, 0xc1200000, v67
    v_cvt_pk_bf16_f32 v68, v60, v61
    v_cvt_pk_bf16_f32 v69, v62, v63
    v_cvt_pk_bf16_f32 v70, v64, v65
    v_cvt_pk_bf16_f32 v71, v66, v67
    v_lshlrev_b32 v60, 16, v68
    v_and_b32 v61, 0xffff0000, v68
    v_lshlrev_b32 v62, 16, v69
    v_and_b32 v63, 0xffff0000, v69
    v_lshlrev_b32 v64, 16, v70
    v_and_b32 v65, 0xffff0000, v70
    v_lshlrev_b32 v66, 16, v71
    v_and_b32 v67, 0xffff0000, v71
    v_mul_f32 v60, 0x3fb8aa3b, v60
    v_mul_f32 v61, 0x3fb8aa3b, v61
    v_mul_f32 v62, 0x3fb8aa3b, v62
    v_mul_f32 v63, 0x3fb8aa3b, v63
    v_mul_f32 v64, 0x3fb8aa3b, v64
    v_mul_f32 v65, 0x3fb8aa3b, v65
    v_mul_f32 v66, 0x3fb8aa3b, v66
    v_mul_f32 v67, 0x3fb8aa3b, v67
    v_exp_f32 v60, v60
    v_exp_f32 v61, v61
    v_exp_f32 v62, v62
    v_exp_f32 v63, v63
    v_exp_f32 v64, v64
    v_exp_f32 v65, v65
    v_exp_f32 v66, v66
    v_exp_f32 v67, v67
    v_cvt_pk_bf16_f32 v72, v60, v61
    v_cvt_pk_bf16_f32 v73, v62, v63
    v_cvt_pk_bf16_f32 v74, v64, v65
    v_cvt_pk_bf16_f32 v75, v66, v67
    v_and_b32 v80, 0xffff0000, v116
    v_subrev_f32 v60, s50, v80
    v_subrev_f32 v61, s51, v80
    v_subrev_f32 v62, s52, v80
    v_subrev_f32 v63, s53, v80
    v_subrev_f32 v64, s54, v80
    v_subrev_f32 v65, s55, v80
    v_subrev_f32 v66, s56, v80
    v_subrev_f32 v67, s57, v80
    v_cvt_pk_bf16_f32 v68, v60, v61
    v_cvt_pk_bf16_f32 v69, v62, v63
    v_cvt_pk_bf16_f32 v70, v64, v65
    v_cvt_pk_bf16_f32 v71, v66, v67
    v_lshlrev_b32 v60, 16, v68
    v_and_b32 v61, 0xffff0000, v68
    v_lshlrev_b32 v62, 16, v69
    v_and_b32 v63, 0xffff0000, v69
    v_lshlrev_b32 v64, 16, v70
    v_and_b32 v65, 0xffff0000, v70
    v_lshlrev_b32 v66, 16, v71
    v_and_b32 v67, 0xffff0000, v71
    v_mul_f32 v60, v60, v60
    v_mul_f32 v61, v61, v61
    v_mul_f32 v62, v62, v62
    v_mul_f32 v63, v63, v63
    v_mul_f32 v64, v64, v64
    v_mul_f32 v65, v65, v65
    v_mul_f32 v66, v66, v66
    v_mul_f32 v67, v67, v67
    v_cvt_pk_bf16_f32 v68, v60, v61
    v_cvt_pk_bf16_f32 v69, v62, v63
    v_cvt_pk_bf16_f32 v70, v64, v65
    v_cvt_pk_bf16_f32 v71, v66, v67
    v_lshlrev_b32 v60, 16, v68
    v_and_b32 v61, 0xffff0000, v68
    v_lshlrev_b32 v62, 16, v69
    v_and_b32 v63, 0xffff0000, v69
    v_lshlrev_b32 v64, 16, v70
    v_and_b32 v65, 0xffff0000, v70
    v_lshlrev_b32 v66, 16, v71
    v_and_b32 v67, 0xffff0000, v71
    v_mul_f32 v60, 0xc1200000, v60
    v_mul_f32 v61, 0xc1200000, v61
    v_mul_f32 v62, 0xc1200000, v62
    v_mul_f32 v63, 0xc1200000, v63
    v_mul_f32 v64, 0xc1200000, v64
    v_mul_f32 v65, 0xc1200000, v65
    v_mul_f32 v66, 0xc1200000, v66
    v_mul_f32 v67, 0xc1200000, v67
    v_cvt_pk_bf16_f32 v68, v60, v61
    v_cvt_pk_bf16_f32 v69, v62, v63
    v_cvt_pk_bf16_f32 v70, v64, v65
    v_cvt_pk_bf16_f32 v71, v66, v67
    v_lshlrev_b32 v60, 16, v68
    v_and_b32 v61, 0xffff0000, v68
    v_lshlrev_b32 v62, 16, v69
    v_and_b32 v63, 0xffff0000, v69
    v_lshlrev_b32 v64, 16, v70
    v_and_b32 v65, 0xffff0000, v70
    v_lshlrev_b32 v66, 16, v71
    v_and_b32 v67, 0xffff0000, v71
    v_mul_f32 v60, 0x3fb8aa3b, v60
    v_mul_f32 v61, 0x3fb8aa3b, v61
    v_mul_f32 v62, 0x3fb8aa3b, v62
    v_mul_f32 v63, 0x3fb8aa3b, v63
    v_mul_f32 v64, 0x3fb8aa3b, v64
    v_mul_f32 v65, 0x3fb8aa3b, v65
    v_mul_f32 v66, 0x3fb8aa3b, v66
    v_mul_f32 v67, 0x3fb8aa3b, v67
    v_exp_f32 v60, v60
    v_exp_f32 v61, v61
    v_exp_f32 v62, v62
    v_exp_f32 v63, v63
    v_exp_f32 v64, v64
    v_exp_f32 v65, v65
    v_exp_f32 v66, v66
    v_exp_f32 v67, v67
    v_cvt_pk_bf16_f32 v76, v60, v61
    v_cvt_pk_bf16_f32 v77, v62, v63
    v_cvt_pk_bf16_f32 v78, v64, v65
    v_cvt_pk_bf16_f32 v79, v66, v67
    v_mfma_f32_4x4x4_16b_bf16 v[80:83], v[48:49], v[72:73], 0
    v_mfma_f32_4x4x4_16b_bf16 v[88:91], v[52:53], v[72:73], 0
    v_mfma_f32_4x4x4_16b_bf16 v[84:87], v[48:49], v[76:77], 0
    v_mfma_f32_4x4x4_16b_bf16 v[92:95], v[52:53], v[76:77], 0
    v_mfma_f32_4x4x4_16b_bf16 v[80:83], v[50:51], v[74:75], v[80:83]
    v_mfma_f32_4x4x4_16b_bf16 v[88:91], v[54:55], v[74:75], v[88:91]
    v_mfma_f32_4x4x4_16b_bf16 v[84:87], v[50:51], v[78:79], v[84:87]
    v_mfma_f32_4x4x4_16b_bf16 v[92:95], v[54:55], v[78:79], v[92:95]
    v_add_u32 v104, 81920, v118
    ds_read_b128 v[32:35], v104
    v_add_u32 v104, 81920, v119
    ds_read_b128 v[60:63], v104
    s_add_u32 s20, s30, 0xd841000
    s_addc_u32 s21, s31, 0
    s_mov_b32 s22, 0x1388000
    s_mov_b32 s23, 0x20000
    s_add_u32 s3, s33, 1
    s_and_b32 s3, s3, 3
    s_lshl_b32 s3, s3, 6
    s_add_u32 s3, s3, s34
    s_mul_i32 s44, s3, 80000
    s_add_u32 s3, s33, 2
    s_and_b32 s3, s3, 3
    s_lshl_b32 s3, s3, 6
    s_add_u32 s3, s3, s34
    s_mul_i32 s45, s3, 80000
    s_add_u32 s3, s33, 3
    s_and_b32 s3, s3, 3
    s_lshl_b32 s3, s3, 6
    s_add_u32 s3, s3, s34
    s_mul_i32 s46, s3, 80000
    s_lshl_b32 s3, s34, 9
    s_lshl_b32 s4, s33, 7
    s_add_u32 s4, s4, s3
    v_mov_b32 v104, 1
    v_lshlrev_b32 v105, 3, v122
    s_waitcnt vmcnt(0)
    s_barrier
    s_cmp_lg_u32 s32, 0
    s_cbranch_scc1 L2_f2
    s_mov_b64 exec, 1
    buffer_store_dword v104, off, s[8:11], s4 sc1
    s_mov_b64 exec, 15
    s_bitset0_b64 exec, s33
L2_f3:
    buffer_load_dword v104, v105, s[8:11], s3 offen sc1
    s_waitcnt vmcnt(0)
    v_cmp_ne_u32 vcc, 1, v104
    s_cbranch_vccnz L2_f3
L2_f4:
    s_mov_b64 exec, -1
L2_f2:
    s_barrier
    buffer_load_dwordx4 v[36:39], v118, s[20:23], s44 offen sc1
    buffer_load_dwordx4 v[40:43], v118, s[20:23], s45 offen sc1
    buffer_load_dwordx4 v[44:47], v118, s[20:23], s46 offen sc1
    s_cmp_ge_u32 s32, 4
    s_cbranch_scc1 L2_f5
    buffer_load_dwordx4 v[64:67], v119, s[20:23], s44 offen sc1
    buffer_load_dwordx4 v[68:71], v119, s[20:23], s45 offen sc1
    buffer_load_dwordx4 v[72:75], v119, s[20:23], s46 offen sc1
    v_lshlrev_b32 v16, 16, v117
    v_subrev_f32 v96, s50, v16
    v_subrev_f32 v97, s51, v16
    v_subrev_f32 v98, s52, v16
    v_subrev_f32 v99, s53, v16
    v_subrev_f32 v100, s54, v16
    v_subrev_f32 v101, s55, v16
    v_subrev_f32 v102, s56, v16
    v_subrev_f32 v103, s57, v16
    v_cvt_pk_bf16_f32 v0, v96, v97
    v_cvt_pk_bf16_f32 v1, v98, v99
    v_cvt_pk_bf16_f32 v2, v100, v101
    v_cvt_pk_bf16_f32 v3, v102, v103
    v_lshlrev_b32 v96, 16, v0
    v_and_b32 v97, 0xffff0000, v0
    v_lshlrev_b32 v98, 16, v1
    v_and_b32 v99, 0xffff0000, v1
    v_lshlrev_b32 v100, 16, v2
    v_and_b32 v101, 0xffff0000, v2
    v_lshlrev_b32 v102, 16, v3
    v_and_b32 v103, 0xffff0000, v3
    v_mul_f32 v96, v96, v96
    v_mul_f32 v97, v97, v97
    v_mul_f32 v98, v98, v98
    v_mul_f32 v99, v99, v99
    v_mul_f32 v100, v100, v100
    v_mul_f32 v101, v101, v101
    v_mul_f32 v102, v102, v102
    v_mul_f32 v103, v103, v103
    v_cvt_pk_bf16_f32 v0, v96, v97
    v_cvt_pk_bf16_f32 v1, v98, v99
    v_cvt_pk_bf16_f32 v2, v100, v101
    v_cvt_pk_bf16_f32 v3, v102, v103
    v_lshlrev_b32 v96, 16, v0
    v_and_b32 v97, 0xffff0000, v0
    v_lshlrev_b32 v98, 16, v1
    v_and_b32 v99, 0xffff0000, v1
    v_lshlrev_b32 v100, 16, v2
    v_and_b32 v101, 0xffff0000, v2
    v_lshlrev_b32 v102, 16, v3
    v_and_b32 v103, 0xffff0000, v3
    v_mul_f32 v96, 0xc1200000, v96
    v_mul_f32 v97, 0xc1200000, v97
    v_mul_f32 v98, 0xc1200000, v98
    v_mul_f32 v99, 0xc1200000, v99
    v_mul_f32 v100, 0xc1200000, v100
    v_mul_f32 v101, 0xc1200000, v101
    v_mul_f32 v102, 0xc1200000, v102
    v_mul_f32 v103, 0xc1200000, v103
    v_cvt_pk_bf16_f32 v0, v96, v97
    v_cvt_pk_bf16_f32 v1, v98, v99
    v_cvt_pk_bf16_f32 v2, v100, v101
    v_cvt_pk_bf16_f32 v3, v102, v103
    v_lshlrev_b32 v96, 16, v0
    v_and_b32 v97, 0xffff0000, v0
    v_lshlrev_b32 v98, 16, v1
    v_and_b32 v99, 0xffff0000, v1
    v_lshlrev_b32 v100, 16, v2
    v_and_b32 v101, 0xffff0000, v2
    v_lshlrev_b32 v102, 16, v3
    v_and_b32 v103, 0xffff0000, v3
    v_mul_f32 v96, 0x3fb8aa3b, v96
    v_mul_f32 v97, 0x3fb8aa3b, v97
    v_mul_f32 v98, 0x3fb8aa3b, v98
    v_mul_f32 v99, 0x3fb8aa3b, v99
    v_mul_f32 v100, 0x3fb8aa3b, v100
    v_mul_f32 v101, 0x3fb8aa3b, v101
    v_mul_f32 v102, 0x3fb8aa3b, v102
    v_mul_f32 v103, 0x3fb8aa3b, v103
    v_exp_f32 v96, v96
    v_exp_f32 v97, v97
    v_exp_f32 v98, v98
    v_exp_f32 v99, v99
    v_exp_f32 v100, v100
    v_exp_f32 v101, v101
    v_exp_f32 v102, v102
    v_exp_f32 v103, v103
    v_cvt_pk_bf16_f32 v104, v96, v97
    v_cvt_pk_bf16_f32 v105, v98, v99
    v_cvt_pk_bf16_f32 v106, v100, v101
    v_cvt_pk_bf16_f32 v107, v102, v103
    v_and_b32 v16, 0xffff0000, v117
    v_subrev_f32 v96, s50, v16
    v_subrev_f32 v97, s51, v16
    v_subrev_f32 v98, s52, v16
    v_subrev_f32 v99, s53, v16
    v_subrev_f32 v100, s54, v16
    v_subrev_f32 v101, s55, v16
    v_subrev_f32 v102, s56, v16
    v_subrev_f32 v103, s57, v16
    v_cvt_pk_bf16_f32 v0, v96, v97
    v_cvt_pk_bf16_f32 v1, v98, v99
    v_cvt_pk_bf16_f32 v2, v100, v101
    v_cvt_pk_bf16_f32 v3, v102, v103
    v_lshlrev_b32 v96, 16, v0
    v_and_b32 v97, 0xffff0000, v0
    v_lshlrev_b32 v98, 16, v1
    v_and_b32 v99, 0xffff0000, v1
    v_lshlrev_b32 v100, 16, v2
    v_and_b32 v101, 0xffff0000, v2
    v_lshlrev_b32 v102, 16, v3
    v_and_b32 v103, 0xffff0000, v3
    v_mul_f32 v96, v96, v96
    v_mul_f32 v97, v97, v97
    v_mul_f32 v98, v98, v98
    v_mul_f32 v99, v99, v99
    v_mul_f32 v100, v100, v100
    v_mul_f32 v101, v101, v101
    v_mul_f32 v102, v102, v102
    v_mul_f32 v103, v103, v103
    v_cvt_pk_bf16_f32 v0, v96, v97
    v_cvt_pk_bf16_f32 v1, v98, v99
    v_cvt_pk_bf16_f32 v2, v100, v101
    v_cvt_pk_bf16_f32 v3, v102, v103
    v_lshlrev_b32 v96, 16, v0
    v_and_b32 v97, 0xffff0000, v0
    v_lshlrev_b32 v98, 16, v1
    v_and_b32 v99, 0xffff0000, v1
    v_lshlrev_b32 v100, 16, v2
    v_and_b32 v101, 0xffff0000, v2
    v_lshlrev_b32 v102, 16, v3
    v_and_b32 v103, 0xffff0000, v3
    v_mul_f32 v96, 0xc1200000, v96
    v_mul_f32 v97, 0xc1200000, v97
    v_mul_f32 v98, 0xc1200000, v98
    v_mul_f32 v99, 0xc1200000, v99
    v_mul_f32 v100, 0xc1200000, v100
    v_mul_f32 v101, 0xc1200000, v101
    v_mul_f32 v102, 0xc1200000, v102
    v_mul_f32 v103, 0xc1200000, v103
    v_cvt_pk_bf16_f32 v0, v96, v97
    v_cvt_pk_bf16_f32 v1, v98, v99
    v_cvt_pk_bf16_f32 v2, v100, v101
    v_cvt_pk_bf16_f32 v3, v102, v103
    v_lshlrev_b32 v96, 16, v0
    v_and_b32 v97, 0xffff0000, v0
    v_lshlrev_b32 v98, 16, v1
    v_and_b32 v99, 0xffff0000, v1
    v_lshlrev_b32 v100, 16, v2
    v_and_b32 v101, 0xffff0000, v2
    v_lshlrev_b32 v102, 16, v3
    v_and_b32 v103, 0xffff0000, v3
    v_mul_f32 v96, 0x3fb8aa3b, v96
    v_mul_f32 v97, 0x3fb8aa3b, v97
    v_mul_f32 v98, 0x3fb8aa3b, v98
    v_mul_f32 v99, 0x3fb8aa3b, v99
    v_mul_f32 v100, 0x3fb8aa3b, v100
    v_mul_f32 v101, 0x3fb8aa3b, v101
    v_mul_f32 v102, 0x3fb8aa3b, v102
    v_mul_f32 v103, 0x3fb8aa3b, v103
    v_exp_f32 v96, v96
    v_exp_f32 v97, v97
    v_exp_f32 v98, v98
    v_exp_f32 v99, v99
    v_exp_f32 v100, v100
    v_exp_f32 v101, v101
    v_exp_f32 v102, v102
    v_exp_f32 v103, v103
    v_cvt_pk_bf16_f32 v76, v96, v97
    v_cvt_pk_bf16_f32 v77, v98, v99
    v_cvt_pk_bf16_f32 v78, v100, v101
    v_cvt_pk_bf16_f32 v79, v102, v103
    v_mfma_f32_4x4x4_16b_bf16 v[16:19], v[48:49], v[104:105], 0
    v_mfma_f32_4x4x4_16b_bf16 v[24:27], v[52:53], v[104:105], 0
    v_mfma_f32_4x4x4_16b_bf16 v[20:23], v[48:49], v[76:77], 0
    v_mfma_f32_4x4x4_16b_bf16 v[28:31], v[52:53], v[76:77], 0
    v_mfma_f32_4x4x4_16b_bf16 v[16:19], v[50:51], v[106:107], v[16:19]
    v_mfma_f32_4x4x4_16b_bf16 v[24:27], v[54:55], v[106:107], v[24:27]
    v_mfma_f32_4x4x4_16b_bf16 v[20:23], v[50:51], v[78:79], v[20:23]
    v_mfma_f32_4x4x4_16b_bf16 v[28:31], v[54:55], v[78:79], v[28:31]
L2_f5:
    s_waitcnt vmcnt(0) lgkmcnt(0)
    v_mfma_f32_4x4x4_16b_bf16 v[96:99], v[10:11], v[32:33], 0
    v_mfma_f32_4x4x4_16b_bf16 v[100:103], v[10:11], v[34:35], 0
    s_nop 0
    v_mfma_f32_4x4x4_16b_bf16 v[96:99], v[10:11], v[36:37], v[96:99]
    v_mfma_f32_4x4x4_16b_bf16 v[100:103], v[10:11], v[38:39], v[100:103]
    s_nop 0
    v_mfma_f32_4x4x4_16b_bf16 v[96:99], v[10:11], v[40:41], v[96:99]
    v_mfma_f32_4x4x4_16b_bf16 v[100:103], v[10:11], v[42:43], v[100:103]
    s_nop 0
    v_mfma_f32_4x4x4_16b_bf16 v[96:99], v[10:11], v[44:45], v[96:99]
    v_mfma_f32_4x4x4_16b_bf16 v[100:103], v[10:11], v[46:47], v[100:103]
    s_nop 3
    v_mul_f32 v96, v96, v80
    v_mul_f32 v97, v97, v81
    v_mul_f32 v98, v98, v82
    v_mul_f32 v99, v99, v83
    v_cvt_pk_bf16_f32 v32, v96, v97
    v_cvt_pk_bf16_f32 v33, v98, v99
    v_mul_f32 v100, v100, v84
    v_mul_f32 v101, v101, v85
    v_mul_f32 v102, v102, v86
    v_mul_f32 v103, v103, v87
    v_cvt_pk_bf16_f32 v34, v100, v101
    v_cvt_pk_bf16_f32 v35, v102, v103
    v_mfma_f32_4x4x4_16b_bf16 v[80:83], v[56:57], v[32:33], 0
    s_nop 0
    v_mfma_f32_4x4x4_16b_bf16 v[84:87], v[56:57], v[34:35], 0
    s_nop 2
    v_mul_f32 v80, v80, v88
    v_mul_f32 v81, v81, v89
    v_mul_f32 v82, v82, v90
    v_mul_f32 v83, v83, v91
    v_mul_f32 v84, v84, v92
    v_mul_f32 v85, v85, v93
    v_mul_f32 v86, v86, v94
    v_mul_f32 v87, v87, v95
    v_mfma_f32_4x4x4_16b_bf16 v[96:99], v[10:11], v[108:109], v[80:83]
    s_nop 0
    v_mfma_f32_4x4x4_16b_bf16 v[100:103], v[10:11], v[110:111], v[84:87]
    s_nop 2
    v_cvt_pk_bf16_f32 v36, v96, v97
    v_cvt_pk_bf16_f32 v37, v98, v99
    v_cvt_pk_bf16_f32 v38, v100, v101
    v_cvt_pk_bf16_f32 v39, v102, v103
    buffer_store_dwordx4 v[36:39], v120, s[12:15], 0 offen
    s_cmp_ge_u32 s32, 4
    s_cbranch_scc1 L2_f6
    v_mfma_f32_4x4x4_16b_bf16 v[96:99], v[10:11], v[60:61], 0
    v_mfma_f32_4x4x4_16b_bf16 v[100:103], v[10:11], v[62:63], 0
    s_nop 0
    v_mfma_f32_4x4x4_16b_bf16 v[96:99], v[10:11], v[64:65], v[96:99]
    v_mfma_f32_4x4x4_16b_bf16 v[100:103], v[10:11], v[66:67], v[100:103]
    s_nop 0
    v_mfma_f32_4x4x4_16b_bf16 v[96:99], v[10:11], v[68:69], v[96:99]
    v_mfma_f32_4x4x4_16b_bf16 v[100:103], v[10:11], v[70:71], v[100:103]
    s_nop 0
    v_mfma_f32_4x4x4_16b_bf16 v[96:99], v[10:11], v[72:73], v[96:99]
    v_mfma_f32_4x4x4_16b_bf16 v[100:103], v[10:11], v[74:75], v[100:103]
    s_nop 3
    v_mul_f32 v96, v96, v16
    v_mul_f32 v97, v97, v17
    v_mul_f32 v98, v98, v18
    v_mul_f32 v99, v99, v19
    v_cvt_pk_bf16_f32 v60, v96, v97
    v_cvt_pk_bf16_f32 v61, v98, v99
    v_mul_f32 v100, v100, v20
    v_mul_f32 v101, v101, v21
    v_mul_f32 v102, v102, v22
    v_mul_f32 v103, v103, v23
    v_cvt_pk_bf16_f32 v62, v100, v101
    v_cvt_pk_bf16_f32 v63, v102, v103
    v_mfma_f32_4x4x4_16b_bf16 v[16:19], v[56:57], v[60:61], 0
    s_nop 0
    v_mfma_f32_4x4x4_16b_bf16 v[20:23], v[56:57], v[62:63], 0
    s_nop 2
    v_mul_f32 v16, v16, v24
    v_mul_f32 v17, v17, v25
    v_mul_f32 v18, v18, v26
    v_mul_f32 v19, v19, v27
    v_mul_f32 v20, v20, v28
    v_mul_f32 v21, v21, v29
    v_mul_f32 v22, v22, v30
    v_mul_f32 v23, v23, v31
    v_mfma_f32_4x4x4_16b_bf16 v[96:99], v[10:11], v[112:113], v[16:19]
    s_nop 0
    v_mfma_f32_4x4x4_16b_bf16 v[100:103], v[10:11], v[114:115], v[20:23]
    s_nop 2
    v_cvt_pk_bf16_f32 v64, v96, v97
    v_cvt_pk_bf16_f32 v65, v98, v99
    v_cvt_pk_bf16_f32 v66, v100, v101
    v_cvt_pk_bf16_f32 v67, v102, v103
    buffer_store_dwordx4 v[64:67], v121, s[12:15], 0 offen
L2_f6:
L2_end:
    s_endpgm
L2_slow:
    s_lshr_b32 s35, s42, 2
    s_lshl_b32 s50, s32, 4
    s_and_b32 s3, s42, 3
    s_lshl_b32 s53, s3, 3
    s_add_u32 s53, s53, s39
    s_and_b32 s3, s35, 2
    s_lshl_b32 s3, s3, 1
    s_add_u32 s53, s53, s3
    s_and_b32 s54, s35, 1
    s_lshl_b32 s54, s54, 4
L2_sl_seg:
    s_mul_i32 s55, s50, 173056
    s_and_b32 s3, s50, 3
    s_lshl_b32 s3, s3, 5
    s_add_u32 s3, s3, s55
    s_add_u32 s3, s3, s53
    buffer_load_dword v104, off, s[12:15], s3 sc1
    buffer_load_dword v105, off, s[12:15], s3 offset:32 sc1
    s_waitcnt vmcnt(0)
    v_readfirstlane_b32 s51, v104
    v_readfirstlane_b32 s52, v105
    s_lshr_b32 s51, s51, s54
    s_and_b32 s51, s51, 0xffff
    s_lshr_b32 s52, s52, s54
    s_and_b32 s52, s52, 0xffff
L2_sl_rec:
    s_cmp_ge_u32 s51, s52
    s_cbranch_scc1 L2_sl_next
    v_mbcnt_lo_u32_b32 v102, -1, 0
    v_mbcnt_hi_u32_b32 v102, -1, v102
    v_add_u32 v102, s51, v102
    v_and_b32 v103, -4, v102
    v_lshl_add_u32 v104, v102, 2, v103
    v_lshl_add_u32 v105, v103, 2, v102
    v_cmp_gt_u32 vcc, s52, v102
    s_mov_b64 exec, vcc
    buffer_load_dword v106, v104, s[8:11], s55 offen
    buffer_load_ubyte v107, v105, s[8:11], s55 offen offset:16
    s_waitcnt vmcnt(0)
    v_lshrrev_b32 v98, 14, v106
    v_and_b32 v98, v5, v98
    ds_read_b64 v[100:101], v98
    v_perm_b32 v97, v106, v107, s44
    v_and_b32 v96, v5, v106
    v_bitop3_b32 v103, v106, 0.5, -0.5 bitop3:0xa8
    v_bitop3_b32 v97, v6, v97, v103 bitop3:0xca
    s_waitcnt lgkmcnt(0)
    v_mfma_f32_4x4x4_16b_bf16 v[88:91], v[8:9], v[100:101], 0
    s_nop 4
    v_mul_f32 v88, v97, v88
    v_mul_f32 v89, v97, v89
    v_mul_f32 v90, v97, v90
    v_mul_f32 v91, v97, v91
    v_cvt_pk_bf16_f32 v88, v88, v89
    v_cvt_pk_bf16_f32 v89, v90, v91
    ds_pk_add_bf16 v96, v88 offset:65408
    ds_pk_add_bf16 v96, v89 offset:65412
    s_mov_b64 exec, -1
    s_add_u32 s51, s51, 64
    s_branch L2_sl_rec
L2_sl_next:
    s_add_u32 s50, s50, 1
    s_and_b32 s3, s50, 15
    s_cbranch_scc1 L2_sl_seg
    s_add_u32 s50, s50, 240
    s_cmp_lt_u32 s50, 1280
    s_cbranch_scc1 L2_sl_seg
    s_waitcnt lgkmcnt(0)
    s_cmp_eq_u32 s42, 0
    s_cbranch_scc1 L2_ret0
    s_cmp_eq_u32 s42, 1
    s_cbranch_scc1 L2_ret1
    s_cmp_eq_u32 s42, 14
    s_cbranch_scc1 L2_ret6
    s_cmp_eq_u32 s42, 15
    s_cbranch_scc1 L2_ret7
    s_and_b32 s3, s42, 3
    s_cmp_eq_u32 s3, 2
    s_cbranch_scc1 L2_ret2
    s_cmp_eq_u32 s3, 3
    s_cbranch_scc1 L2_ret3
    s_cmp_eq_u32 s3, 0
    s_cbranch_scc1 L2_ret4
    s_branch L2_ret5
L2_p1s:
    s_sleep 32
    s_branch L2_p1
L2_xo3:
    v_cmp_lt_u32 vcc, 20, v99
    s_mov_b32 s101, 1
    s_cbranch_vccz L2_xp3
    v_cmp_lt_u32 vcc, 32, v99
    v_cmp_lt_u32 s[58:59], 31, v88
    s_mov_b32 s101, 2
    s_or_b64 vcc, vcc, s[58:59]
    s_cbranch_scc0 L2_xp3
    s_mov_b32 s37, 0x10000
    s_branch L2_xp3
L2_xa4:
    s_cmp_eq_u32 s101, 1
    s_cbranch_scc1 L2_xc4
    v_lshlrev_b32 v89, 0, v96
    v_add_u32 v90, 140, v97
    v_bitop3_b32 v90, v89, v45, v90 bitop3:0x6a
    ds_write_b32 v98, v90 offset:28
    v_lshlrev_b32 v89, 4, v96
    v_add_u32 v90, 120, v97
    v_bitop3_b32 v90, v89, v45, v90 bitop3:0x6a
    ds_write_b32 v98, v90 offset:24
    v_lshlrev_b32 v89, 8, v96
    v_add_u32 v90, 100, v97
    v_bitop3_b32 v90, v89, v45, v90 bitop3:0x6a
    ds_write_b32 v98, v90 offset:20
L2_xc4:
    v_lshlrev_b32 v89, 12, v96
    v_add_u32 v90, 80, v97
    v_bitop3_b32 v90, v89, v45, v90 bitop3:0x6a
    ds_write_b32 v98, v90 offset:16
    s_branch L2_xb4
L2_xe4:
    v_cmp_lt_u32 vcc, 32, v99
    v_cmp_lt_u32 s[58:59], 31, v88
    v_lshrrev_b32 v89, 16, v96
    v_add_u32 v97, 80, v97
    s_or_b64 vcc, vcc, s[58:59]
    s_cbranch_scc1 L2_xs4
    v_lshlrev_b32 v89, v1, v89
    v_and_b32 v89, v45, v89
    v_cmp_ne_u32 vcc, 0, v89
    v_xor_b32 v90, v97, v89
    s_add_u32 s3, s37, s38
    v_mbcnt_lo_u32_b32 v98, vcc_lo, 0
    v_mbcnt_hi_u32_b32 v98, vcc_hi, v98
    s_bcnt1_i32_b64 s41, vcc
    v_lshl_add_u32 v98, v98, 2, s3
    s_mov_b64 exec, vcc
    ds_write_b32 v98, v90
    s_mov_b64 exec, -1
    s_lshl2_add_u32 s37, s41, s37
    s_branch L2_xr4
L2_xf4:
    s_waitcnt lgkmcnt(0)
    s_cmp_gt_u32 s37, 1024
    s_cbranch_scc1 L2_xs4
    v_mov_b32 v43, -1
    s_cmp_ge_u32 s37, 512
    s_cbranch_scc1 L2_xg4
    v_mov_b32 v42, -1
    s_cmp_ge_u32 s37, 256
    s_cbranch_scc1 L2_xg4
    v_mov_b32 v41, -1
    s_branch L2_xg4
L2_xs4:
    s_waitcnt lgkmcnt(0)
    v_mov_b32 v40, -1
    v_mov_b32 v41, -1
    v_mov_b32 v42, -1
    v_mov_b32 v43, -1
    s_add_u32 s3, s42, 0
    s_bitset1_b32 s36, s3
    s_branch L2_xg4
L2_xo5:
    v_cmp_lt_u32 vcc, 20, v99
    s_mov_b32 s101, 1
    s_cbranch_vccz L2_xp5
    v_cmp_lt_u32 vcc, 32, v99
    v_cmp_lt_u32 s[58:59], 31, v88
    s_mov_b32 s101, 2
    s_or_b64 vcc, vcc, s[58:59]
    s_cbranch_scc0 L2_xp5
    s_mov_b32 s37, 0x10000
    s_branch L2_xp5
L2_xa6:
    s_cmp_eq_u32 s101, 1
    s_cbranch_scc1 L2_xc6
    v_lshlrev_b32 v89, 0, v96
    v_add_u32 v90, 140, v97
    v_bitop3_b32 v90, v89, v45, v90 bitop3:0x6a
    ds_write_b32 v98, v90 offset:28
    v_lshlrev_b32 v89, 4, v96
    v_add_u32 v90, 120, v97
    v_bitop3_b32 v90, v89, v45, v90 bitop3:0x6a
    ds_write_b32 v98, v90 offset:24
    v_lshlrev_b32 v89, 8, v96
    v_add_u32 v90, 100, v97
    v_bitop3_b32 v90, v89, v45, v90 bitop3:0x6a
    ds_write_b32 v98, v90 offset:20
L2_xc6:
    v_lshlrev_b32 v89, 12, v96
    v_add_u32 v90, 80, v97
    v_bitop3_b32 v90, v89, v45, v90 bitop3:0x6a
    ds_write_b32 v98, v90 offset:16
    s_branch L2_xb6
L2_xe6:
    v_cmp_lt_u32 vcc, 32, v99
    v_cmp_lt_u32 s[58:59], 31, v88
    v_lshrrev_b32 v89, 16, v96
    v_add_u32 v97, 80, v97
    s_or_b64 vcc, vcc, s[58:59]
    s_cbranch_scc1 L2_xs6
    v_lshlrev_b32 v89, v1, v89
    v_and_b32 v89, v45, v89
    v_cmp_ne_u32 vcc, 0, v89
    v_xor_b32 v90, v97, v89
    s_add_u32 s3, s37, s38
    v_mbcnt_lo_u32_b32 v98, vcc_lo, 0
    v_mbcnt_hi_u32_b32 v98, vcc_hi, v98
    s_bcnt1_i32_b64 s41, vcc
    v_lshl_add_u32 v98, v98, 2, s3
    s_mov_b64 exec, vcc
    ds_write_b32 v98, v90
    s_mov_b64 exec, -1
    s_lshl2_add_u32 s37, s41, s37
    s_branch L2_xr6
L2_xf6:
    s_waitcnt lgkmcnt(0)
    s_cmp_gt_u32 s37, 1024
    s_cbranch_scc1 L2_xs6
    v_mov_b32 v43, -1
    s_cmp_ge_u32 s37, 512
    s_cbranch_scc1 L2_xg6
    v_mov_b32 v42, -1
    s_cmp_ge_u32 s37, 256
    s_cbranch_scc1 L2_xg6
    v_mov_b32 v41, -1
    s_branch L2_xg6
L2_xs6:
    s_waitcnt lgkmcnt(0)
    v_mov_b32 v40, -1
    v_mov_b32 v41, -1
    v_mov_b32 v42, -1
    v_mov_b32 v43, -1
    s_add_u32 s3, s42, 1
    s_bitset1_b32 s36, s3
    s_branch L2_xg6
L2_p2s:
    s_sleep 8
    s_branch L2_p2
L2_c7:
    s_mov_b64 s[50:51], vcc
    s_lshl_b64 s[52:53], s[82:83], 1
    s_andn2_b64 s[52:53], s[52:53], s[80:81]
    s_andn2_b64 s[52:53], s[52:53], s[50:51]
    s_or_b64 s[80:81], s[80:81], s[52:53]
    s_not_b64 vcc, s[52:53]
    s_mov_b64 exec, -1
    v_cndmask_b32_dpp v84, v84, v84, vcc wave_shr:1 row_mask:0xf bank_mask:0xf
    v_cndmask_b32_dpp v85, v85, v85, vcc wave_shr:1 row_mask:0xf bank_mask:0xf
    s_lshr_b64 s[52:53], s[52:53], 1
    v_cndmask_b32_dpp v86, v86, v86, vcc wave_shr:1 row_mask:0xf bank_mask:0xf
    v_cndmask_b32_dpp v87, v87, v87, vcc wave_shr:1 row_mask:0xf bank_mask:0xf
    s_andn2_b64 s[82:83], s[82:83], s[52:53]
    v_cndmask_b32_dpp v7, v7, v7, vcc wave_shr:1 row_mask:0xf bank_mask:0xf
    s_mov_b64 vcc, s[50:51]
    s_mov_b64 exec, s[50:51]
    s_cbranch_scc0 L2_d7
    s_mov_b64 exec, s[82:83]
    s_nop 1
    v_mfma_f32_4x4x4_16b_bf16 v[88:91], v[12:13], v[84:85], 0
    s_nop 1
    v_mfma_f32_4x4x4_16b_bf16 v[88:91], v[10:11], v[86:87], v[88:91]
    s_nop 4
    v_cvt_pk_bf16_f32 v88, v88, v89
    v_cvt_pk_bf16_f32 v89, v90, v91
    ds_pk_add_bf16 v7, v88 offset:65408
    ds_pk_add_bf16 v7, v89 offset:65412
    s_mov_b64 exec, vcc
    s_branch L2_d7
L2_c8:
    s_mov_b64 s[50:51], vcc
    s_lshl_b64 s[52:53], s[82:83], 1
    s_andn2_b64 s[52:53], s[52:53], s[80:81]
    s_andn2_b64 s[52:53], s[52:53], s[50:51]
    s_or_b64 s[80:81], s[80:81], s[52:53]
    s_not_b64 vcc, s[52:53]
    s_mov_b64 exec, -1
    v_cndmask_b32_dpp v84, v84, v84, vcc wave_shr:1 row_mask:0xf bank_mask:0xf
    v_cndmask_b32_dpp v85, v85, v85, vcc wave_shr:1 row_mask:0xf bank_mask:0xf
    s_lshr_b64 s[52:53], s[52:53], 1
    v_cndmask_b32_dpp v86, v86, v86, vcc wave_shr:1 row_mask:0xf bank_mask:0xf
    v_cndmask_b32_dpp v87, v87, v87, vcc wave_shr:1 row_mask:0xf bank_mask:0xf
    s_andn2_b64 s[82:83], s[82:83], s[52:53]
    v_cndmask_b32_dpp v7, v7, v7, vcc wave_shr:1 row_mask:0xf bank_mask:0xf
    s_mov_b64 vcc, s[50:51]
    s_mov_b64 exec, s[50:51]
    s_cbranch_scc0 L2_d8
    s_mov_b64 exec, s[82:83]
    s_nop 1
    v_mfma_f32_4x4x4_16b_bf16 v[88:91], v[12:13], v[84:85], 0
    s_nop 1
    v_mfma_f32_4x4x4_16b_bf16 v[88:91], v[10:11], v[86:87], v[88:91]
    s_nop 4
    v_cvt_pk_bf16_f32 v88, v88, v89
    v_cvt_pk_bf16_f32 v89, v90, v91
    ds_pk_add_bf16 v7, v88 offset:65408
    ds_pk_add_bf16 v7, v89 offset:65412
    s_mov_b64 exec, vcc
    s_branch L2_d8
L2_c11:
    s_mov_b64 s[50:51], vcc
    s_lshl_b64 s[52:53], s[82:83], 1
    s_andn2_b64 s[52:53], s[52:53], s[80:81]
    s_andn2_b64 s[52:53], s[52:53], s[50:51]
    s_or_b64 s[80:81], s[80:81], s[52:53]
    s_not_b64 vcc, s[52:53]
    s_mov_b64 exec, -1
    v_cndmask_b32_dpp v84, v84, v84, vcc wave_shr:1 row_mask:0xf bank_mask:0xf
    v_cndmask_b32_dpp v85, v85, v85, vcc wave_shr:1 row_mask:0xf bank_mask:0xf
    s_lshr_b64 s[52:53], s[52:53], 1
    v_cndmask_b32_dpp v86, v86, v86, vcc wave_shr:1 row_mask:0xf bank_mask:0xf
    v_cndmask_b32_dpp v87, v87, v87, vcc wave_shr:1 row_mask:0xf bank_mask:0xf
    s_andn2_b64 s[82:83], s[82:83], s[52:53]
    v_cndmask_b32_dpp v7, v7, v7, vcc wave_shr:1 row_mask:0xf bank_mask:0xf
    s_mov_b64 vcc, s[50:51]
    s_mov_b64 exec, s[50:51]
    s_cbranch_scc0 L2_d11
    s_mov_b64 exec, s[82:83]
    s_nop 1
    v_mfma_f32_4x4x4_16b_bf16 v[88:91], v[12:13], v[84:85], 0
    s_nop 1
    v_mfma_f32_4x4x4_16b_bf16 v[88:91], v[10:11], v[86:87], v[88:91]
    s_nop 4
    v_cvt_pk_bf16_f32 v88, v88, v89
    v_cvt_pk_bf16_f32 v89, v90, v91
    ds_pk_add_bf16 v7, v88 offset:65408
    ds_pk_add_bf16 v7, v89 offset:65412
    s_mov_b64 exec, vcc
    s_branch L2_d11
L2_c12:
    s_mov_b64 s[50:51], vcc
    s_lshl_b64 s[52:53], s[82:83], 1
    s_andn2_b64 s[52:53], s[52:53], s[80:81]
    s_andn2_b64 s[52:53], s[52:53], s[50:51]
    s_or_b64 s[80:81], s[80:81], s[52:53]
    s_not_b64 vcc, s[52:53]
    s_mov_b64 exec, -1
    v_cndmask_b32_dpp v84, v84, v84, vcc wave_shr:1 row_mask:0xf bank_mask:0xf
    v_cndmask_b32_dpp v85, v85, v85, vcc wave_shr:1 row_mask:0xf bank_mask:0xf
    s_lshr_b64 s[52:53], s[52:53], 1
    v_cndmask_b32_dpp v86, v86, v86, vcc wave_shr:1 row_mask:0xf bank_mask:0xf
    v_cndmask_b32_dpp v87, v87, v87, vcc wave_shr:1 row_mask:0xf bank_mask:0xf
    s_andn2_b64 s[82:83], s[82:83], s[52:53]
    v_cndmask_b32_dpp v7, v7, v7, vcc wave_shr:1 row_mask:0xf bank_mask:0xf
    s_mov_b64 vcc, s[50:51]
    s_mov_b64 exec, s[50:51]
    s_cbranch_scc0 L2_d12
    s_mov_b64 exec, s[82:83]
    s_nop 1
    v_mfma_f32_4x4x4_16b_bf16 v[88:91], v[12:13], v[84:85], 0
    s_nop 1
    v_mfma_f32_4x4x4_16b_bf16 v[88:91], v[10:11], v[86:87], v[88:91]
    s_nop 4
    v_cvt_pk_bf16_f32 v88, v88, v89
    v_cvt_pk_bf16_f32 v89, v90, v91
    ds_pk_add_bf16 v7, v88 offset:65408
    ds_pk_add_bf16 v7, v89 offset:65412
    s_mov_b64 exec, vcc
    s_branch L2_d12
L2_xo13:
    v_cmp_lt_u32 vcc, 20, v99
    s_mov_b32 s101, 1
    s_cbranch_vccz L2_xp13
    v_cmp_lt_u32 vcc, 32, v99
    v_cmp_lt_u32 s[58:59], 31, v88
    s_mov_b32 s101, 2
    s_or_b64 vcc, vcc, s[58:59]
    s_cbranch_scc0 L2_xp13
    s_mov_b32 s37, 0x10000
    s_branch L2_xp13
L2_c15:
    s_mov_b64 s[50:51], vcc
    s_lshl_b64 s[52:53], s[82:83], 1
    s_andn2_b64 s[52:53], s[52:53], s[80:81]
    s_andn2_b64 s[52:53], s[52:53], s[50:51]
    s_or_b64 s[80:81], s[80:81], s[52:53]
    s_not_b64 vcc, s[52:53]
    s_mov_b64 exec, -1
    v_cndmask_b32_dpp v84, v84, v84, vcc wave_shr:1 row_mask:0xf bank_mask:0xf
    v_cndmask_b32_dpp v85, v85, v85, vcc wave_shr:1 row_mask:0xf bank_mask:0xf
    s_lshr_b64 s[52:53], s[52:53], 1
    v_cndmask_b32_dpp v86, v86, v86, vcc wave_shr:1 row_mask:0xf bank_mask:0xf
    v_cndmask_b32_dpp v87, v87, v87, vcc wave_shr:1 row_mask:0xf bank_mask:0xf
    s_andn2_b64 s[82:83], s[82:83], s[52:53]
    v_cndmask_b32_dpp v7, v7, v7, vcc wave_shr:1 row_mask:0xf bank_mask:0xf
    s_mov_b64 vcc, s[50:51]
    s_mov_b64 exec, s[50:51]
    s_cbranch_scc0 L2_d15
    s_mov_b64 exec, s[82:83]
    s_nop 1
    v_mfma_f32_4x4x4_16b_bf16 v[88:91], v[12:13], v[84:85], 0
    s_nop 1
    v_mfma_f32_4x4x4_16b_bf16 v[88:91], v[10:11], v[86:87], v[88:91]
    s_nop 4
    v_cvt_pk_bf16_f32 v88, v88, v89
    v_cvt_pk_bf16_f32 v89, v90, v91
    ds_pk_add_bf16 v7, v88 offset:65408
    ds_pk_add_bf16 v7, v89 offset:65412
    s_mov_b64 exec, vcc
    s_branch L2_d15
L2_c16:
    s_mov_b64 s[50:51], vcc
    s_lshl_b64 s[52:53], s[82:83], 1
    s_andn2_b64 s[52:53], s[52:53], s[80:81]
    s_andn2_b64 s[52:53], s[52:53], s[50:51]
    s_or_b64 s[80:81], s[80:81], s[52:53]
    s_not_b64 vcc, s[52:53]
    s_mov_b64 exec, -1
    v_cndmask_b32_dpp v84, v84, v84, vcc wave_shr:1 row_mask:0xf bank_mask:0xf
    v_cndmask_b32_dpp v85, v85, v85, vcc wave_shr:1 row_mask:0xf bank_mask:0xf
    s_lshr_b64 s[52:53], s[52:53], 1
    v_cndmask_b32_dpp v86, v86, v86, vcc wave_shr:1 row_mask:0xf bank_mask:0xf
    v_cndmask_b32_dpp v87, v87, v87, vcc wave_shr:1 row_mask:0xf bank_mask:0xf
    s_andn2_b64 s[82:83], s[82:83], s[52:53]
    v_cndmask_b32_dpp v7, v7, v7, vcc wave_shr:1 row_mask:0xf bank_mask:0xf
    s_mov_b64 vcc, s[50:51]
    s_mov_b64 exec, s[50:51]
    s_cbranch_scc0 L2_d16
    s_mov_b64 exec, s[82:83]
    s_nop 1
    v_mfma_f32_4x4x4_16b_bf16 v[88:91], v[12:13], v[84:85], 0
    s_nop 1
    v_mfma_f32_4x4x4_16b_bf16 v[88:91], v[10:11], v[86:87], v[88:91]
    s_nop 4
    v_cvt_pk_bf16_f32 v88, v88, v89
    v_cvt_pk_bf16_f32 v89, v90, v91
    ds_pk_add_bf16 v7, v88 offset:65408
    ds_pk_add_bf16 v7, v89 offset:65412
    s_mov_b64 exec, vcc
    s_branch L2_d16
L2_c19:
    s_mov_b64 s[50:51], vcc
    s_lshl_b64 s[52:53], s[82:83], 1
    s_andn2_b64 s[52:53], s[52:53], s[80:81]
    s_andn2_b64 s[52:53], s[52:53], s[50:51]
    s_or_b64 s[80:81], s[80:81], s[52:53]
    s_not_b64 vcc, s[52:53]
    s_mov_b64 exec, -1
    v_cndmask_b32_dpp v84, v84, v84, vcc wave_shr:1 row_mask:0xf bank_mask:0xf
    v_cndmask_b32_dpp v85, v85, v85, vcc wave_shr:1 row_mask:0xf bank_mask:0xf
    s_lshr_b64 s[52:53], s[52:53], 1
    v_cndmask_b32_dpp v86, v86, v86, vcc wave_shr:1 row_mask:0xf bank_mask:0xf
    v_cndmask_b32_dpp v87, v87, v87, vcc wave_shr:1 row_mask:0xf bank_mask:0xf
    s_andn2_b64 s[82:83], s[82:83], s[52:53]
    v_cndmask_b32_dpp v7, v7, v7, vcc wave_shr:1 row_mask:0xf bank_mask:0xf
    s_mov_b64 vcc, s[50:51]
    s_mov_b64 exec, s[50:51]
    s_cbranch_scc0 L2_d19
    s_mov_b64 exec, s[82:83]
    s_nop 1
    v_mfma_f32_4x4x4_16b_bf16 v[88:91], v[12:13], v[84:85], 0
    s_nop 1
    v_mfma_f32_4x4x4_16b_bf16 v[88:91], v[10:11], v[86:87], v[88:91]
    s_nop 4
    v_cvt_pk_bf16_f32 v88, v88, v89
    v_cvt_pk_bf16_f32 v89, v90, v91
    ds_pk_add_bf16 v7, v88 offset:65408
    ds_pk_add_bf16 v7, v89 offset:65412
    s_mov_b64 exec, vcc
    s_branch L2_d19
L2_c20:
    s_mov_b64 s[50:51], vcc
    s_lshl_b64 s[52:53], s[82:83], 1
    s_andn2_b64 s[52:53], s[52:53], s[80:81]
    s_andn2_b64 s[52:53], s[52:53], s[50:51]
    s_or_b64 s[80:81], s[80:81], s[52:53]
    s_not_b64 vcc, s[52:53]
    s_mov_b64 exec, -1
    v_cndmask_b32_dpp v84, v84, v84, vcc wave_shr:1 row_mask:0xf bank_mask:0xf
    v_cndmask_b32_dpp v85, v85, v85, vcc wave_shr:1 row_mask:0xf bank_mask:0xf
    s_lshr_b64 s[52:53], s[52:53], 1
    v_cndmask_b32_dpp v86, v86, v86, vcc wave_shr:1 row_mask:0xf bank_mask:0xf
    v_cndmask_b32_dpp v87, v87, v87, vcc wave_shr:1 row_mask:0xf bank_mask:0xf
    s_andn2_b64 s[82:83], s[82:83], s[52:53]
    v_cndmask_b32_dpp v7, v7, v7, vcc wave_shr:1 row_mask:0xf bank_mask:0xf
    s_mov_b64 vcc, s[50:51]
    s_mov_b64 exec, s[50:51]
    s_cbranch_scc0 L2_d20
    s_mov_b64 exec, s[82:83]
    s_nop 1
    v_mfma_f32_4x4x4_16b_bf16 v[88:91], v[12:13], v[84:85], 0
    s_nop 1
    v_mfma_f32_4x4x4_16b_bf16 v[88:91], v[10:11], v[86:87], v[88:91]
    s_nop 4
    v_cvt_pk_bf16_f32 v88, v88, v89
    v_cvt_pk_bf16_f32 v89, v90, v91
    ds_pk_add_bf16 v7, v88 offset:65408
    ds_pk_add_bf16 v7, v89 offset:65412
    s_mov_b64 exec, vcc
    s_branch L2_d20
L2_c21:
    s_mov_b64 s[50:51], vcc
    s_lshl_b64 s[52:53], s[82:83], 1
    s_andn2_b64 s[52:53], s[52:53], s[80:81]
    s_andn2_b64 s[52:53], s[52:53], s[50:51]
    s_or_b64 s[80:81], s[80:81], s[52:53]
    s_not_b64 vcc, s[52:53]
    s_mov_b64 exec, -1
    v_cndmask_b32_dpp v84, v84, v84, vcc wave_shr:1 row_mask:0xf bank_mask:0xf
    v_cndmask_b32_dpp v85, v85, v85, vcc wave_shr:1 row_mask:0xf bank_mask:0xf
    s_lshr_b64 s[52:53], s[52:53], 1
    v_cndmask_b32_dpp v86, v86, v86, vcc wave_shr:1 row_mask:0xf bank_mask:0xf
    v_cndmask_b32_dpp v87, v87, v87, vcc wave_shr:1 row_mask:0xf bank_mask:0xf
    s_andn2_b64 s[82:83], s[82:83], s[52:53]
    v_cndmask_b32_dpp v7, v7, v7, vcc wave_shr:1 row_mask:0xf bank_mask:0xf
    s_mov_b64 vcc, s[50:51]
    s_mov_b64 exec, s[50:51]
    s_cbranch_scc0 L2_d21
    s_mov_b64 exec, s[82:83]
    s_nop 1
    v_mfma_f32_4x4x4_16b_bf16 v[88:91], v[12:13], v[84:85], 0
    s_nop 1
    v_mfma_f32_4x4x4_16b_bf16 v[88:91], v[10:11], v[86:87], v[88:91]
    s_nop 4
    v_cvt_pk_bf16_f32 v88, v88, v89
    v_cvt_pk_bf16_f32 v89, v90, v91
    ds_pk_add_bf16 v7, v88 offset:65408
    ds_pk_add_bf16 v7, v89 offset:65412
    s_mov_b64 exec, vcc
    s_branch L2_d21
L2_c22:
    s_mov_b64 s[50:51], vcc
    s_lshl_b64 s[52:53], s[82:83], 1
    s_andn2_b64 s[52:53], s[52:53], s[80:81]
    s_andn2_b64 s[52:53], s[52:53], s[50:51]
    s_or_b64 s[80:81], s[80:81], s[52:53]
    s_not_b64 vcc, s[52:53]
    s_mov_b64 exec, -1
    v_cndmask_b32_dpp v84, v84, v84, vcc wave_shr:1 row_mask:0xf bank_mask:0xf
    v_cndmask_b32_dpp v85, v85, v85, vcc wave_shr:1 row_mask:0xf bank_mask:0xf
    s_lshr_b64 s[52:53], s[52:53], 1
    v_cndmask_b32_dpp v86, v86, v86, vcc wave_shr:1 row_mask:0xf bank_mask:0xf
    v_cndmask_b32_dpp v87, v87, v87, vcc wave_shr:1 row_mask:0xf bank_mask:0xf
    s_andn2_b64 s[82:83], s[82:83], s[52:53]
    v_cndmask_b32_dpp v7, v7, v7, vcc wave_shr:1 row_mask:0xf bank_mask:0xf
    s_mov_b64 vcc, s[50:51]
    s_mov_b64 exec, s[50:51]
    s_cbranch_scc0 L2_d22
    s_mov_b64 exec, s[82:83]
    s_nop 1
    v_mfma_f32_4x4x4_16b_bf16 v[88:91], v[12:13], v[84:85], 0
    s_nop 1
    v_mfma_f32_4x4x4_16b_bf16 v[88:91], v[10:11], v[86:87], v[88:91]
    s_nop 4
    v_cvt_pk_bf16_f32 v88, v88, v89
    v_cvt_pk_bf16_f32 v89, v90, v91
    ds_pk_add_bf16 v7, v88 offset:65408
    ds_pk_add_bf16 v7, v89 offset:65412
    s_mov_b64 exec, vcc
    s_branch L2_d22
L2_c23:
    s_mov_b64 s[50:51], vcc
    s_lshl_b64 s[52:53], s[82:83], 1
    s_andn2_b64 s[52:53], s[52:53], s[80:81]
    s_andn2_b64 s[52:53], s[52:53], s[50:51]
    s_or_b64 s[80:81], s[80:81], s[52:53]
    s_not_b64 vcc, s[52:53]
    s_mov_b64 exec, -1
    v_cndmask_b32_dpp v84, v84, v84, vcc wave_shr:1 row_mask:0xf bank_mask:0xf
    v_cndmask_b32_dpp v85, v85, v85, vcc wave_shr:1 row_mask:0xf bank_mask:0xf
    s_lshr_b64 s[52:53], s[52:53], 1
    v_cndmask_b32_dpp v86, v86, v86, vcc wave_shr:1 row_mask:0xf bank_mask:0xf
    v_cndmask_b32_dpp v87, v87, v87, vcc wave_shr:1 row_mask:0xf bank_mask:0xf
    s_andn2_b64 s[82:83], s[82:83], s[52:53]
    v_cndmask_b32_dpp v7, v7, v7, vcc wave_shr:1 row_mask:0xf bank_mask:0xf
    s_mov_b64 vcc, s[50:51]
    s_mov_b64 exec, s[50:51]
    s_cbranch_scc0 L2_d23
    s_mov_b64 exec, s[82:83]
    s_nop 1
    v_mfma_f32_4x4x4_16b_bf16 v[88:91], v[12:13], v[84:85], 0
    s_nop 1
    v_mfma_f32_4x4x4_16b_bf16 v[88:91], v[10:11], v[86:87], v[88:91]
    s_nop 4
    v_cvt_pk_bf16_f32 v88, v88, v89
    v_cvt_pk_bf16_f32 v89, v90, v91
    ds_pk_add_bf16 v7, v88 offset:65408
    ds_pk_add_bf16 v7, v89 offset:65412
    s_mov_b64 exec, vcc
    s_branch L2_d23
L2_c24:
    s_mov_b64 s[50:51], vcc
    s_lshl_b64 s[52:53], s[82:83], 1
    s_andn2_b64 s[52:53], s[52:53], s[80:81]
    s_andn2_b64 s[52:53], s[52:53], s[50:51]
    s_or_b64 s[80:81], s[80:81], s[52:53]
    s_not_b64 vcc, s[52:53]
    s_mov_b64 exec, -1
    v_cndmask_b32_dpp v84, v84, v84, vcc wave_shr:1 row_mask:0xf bank_mask:0xf
    v_cndmask_b32_dpp v85, v85, v85, vcc wave_shr:1 row_mask:0xf bank_mask:0xf
    s_lshr_b64 s[52:53], s[52:53], 1
    v_cndmask_b32_dpp v86, v86, v86, vcc wave_shr:1 row_mask:0xf bank_mask:0xf
    v_cndmask_b32_dpp v87, v87, v87, vcc wave_shr:1 row_mask:0xf bank_mask:0xf
    s_andn2_b64 s[82:83], s[82:83], s[52:53]
    v_cndmask_b32_dpp v7, v7, v7, vcc wave_shr:1 row_mask:0xf bank_mask:0xf
    s_mov_b64 vcc, s[50:51]
    s_mov_b64 exec, s[50:51]
    s_cbranch_scc0 L2_d24
    s_mov_b64 exec, s[82:83]
    s_nop 1
    v_mfma_f32_4x4x4_16b_bf16 v[88:91], v[12:13], v[84:85], 0
    s_nop 1
    v_mfma_f32_4x4x4_16b_bf16 v[88:91], v[10:11], v[86:87], v[88:91]
    s_nop 4
    v_cvt_pk_bf16_f32 v88, v88, v89
    v_cvt_pk_bf16_f32 v89, v90, v91
    ds_pk_add_bf16 v7, v88 offset:65408
    ds_pk_add_bf16 v7, v89 offset:65412
    s_mov_b64 exec, vcc
    s_branch L2_d24
L2_xa25:
    s_cmp_eq_u32 s101, 1
    s_cbranch_scc1 L2_xc25
    v_lshlrev_b32 v89, 0, v96
    v_add_u32 v90, 140, v97
    v_bitop3_b32 v90, v89, v45, v90 bitop3:0x6a
    ds_write_b32 v98, v90 offset:28
    v_lshlrev_b32 v89, 4, v96
    v_add_u32 v90, 120, v97
    v_bitop3_b32 v90, v89, v45, v90 bitop3:0x6a
    ds_write_b32 v98, v90 offset:24
    v_lshlrev_b32 v89, 8, v96
    v_add_u32 v90, 100, v97
    v_bitop3_b32 v90, v89, v45, v90 bitop3:0x6a
    ds_write_b32 v98, v90 offset:20
L2_xc25:
    v_lshlrev_b32 v89, 12, v96
    v_add_u32 v90, 80, v97
    v_bitop3_b32 v90, v89, v45, v90 bitop3:0x6a
    ds_write_b32 v98, v90 offset:16
    s_branch L2_xb25
L2_xe25:
    v_cmp_lt_u32 vcc, 32, v99
    v_cmp_lt_u32 s[58:59], 31, v88
    v_lshrrev_b32 v89, 16, v96
    v_add_u32 v97, 80, v97
    s_or_b64 vcc, vcc, s[58:59]
    s_cbranch_scc1 L2_xs25
    v_lshlrev_b32 v89, v1, v89
    v_and_b32 v89, v45, v89
    v_cmp_ne_u32 vcc, 0, v89
    v_xor_b32 v90, v97, v89
    s_add_u32 s3, s37, s38
    v_mbcnt_lo_u32_b32 v98, vcc_lo, 0
    v_mbcnt_hi_u32_b32 v98, vcc_hi, v98
    s_bcnt1_i32_b64 s41, vcc
    v_lshl_add_u32 v98, v98, 2, s3
    s_mov_b64 exec, vcc
    ds_write_b32 v98, v90
    s_mov_b64 exec, -1
    s_lshl2_add_u32 s37, s41, s37
    s_branch L2_xr25
L2_xf25:
    s_waitcnt lgkmcnt(0)
    s_cmp_gt_u32 s37, 1024
    s_cbranch_scc1 L2_xs25
    v_mov_b32 v43, -1
    s_cmp_ge_u32 s37, 512
    s_cbranch_scc1 L2_xg25
    v_mov_b32 v42, -1
    s_cmp_ge_u32 s37, 256
    s_cbranch_scc1 L2_xg25
    v_mov_b32 v41, -1
    s_branch L2_xg25
L2_xs25:
    s_waitcnt lgkmcnt(0)
    v_mov_b32 v40, -1
    v_mov_b32 v41, -1
    v_mov_b32 v42, -1
    v_mov_b32 v43, -1
    s_add_u32 s3, s42, 2
    s_bitset1_b32 s36, s3
    s_branch L2_xg25
L2_c26:
    s_mov_b64 s[50:51], vcc
    s_lshl_b64 s[52:53], s[82:83], 1
    s_andn2_b64 s[52:53], s[52:53], s[80:81]
    s_andn2_b64 s[52:53], s[52:53], s[50:51]
    s_or_b64 s[80:81], s[80:81], s[52:53]
    s_not_b64 vcc, s[52:53]
    s_mov_b64 exec, -1
    v_cndmask_b32_dpp v84, v84, v84, vcc wave_shr:1 row_mask:0xf bank_mask:0xf
    v_cndmask_b32_dpp v85, v85, v85, vcc wave_shr:1 row_mask:0xf bank_mask:0xf
    s_lshr_b64 s[52:53], s[52:53], 1
    v_cndmask_b32_dpp v86, v86, v86, vcc wave_shr:1 row_mask:0xf bank_mask:0xf
    v_cndmask_b32_dpp v87, v87, v87, vcc wave_shr:1 row_mask:0xf bank_mask:0xf
    s_andn2_b64 s[82:83], s[82:83], s[52:53]
    v_cndmask_b32_dpp v7, v7, v7, vcc wave_shr:1 row_mask:0xf bank_mask:0xf
    s_mov_b64 vcc, s[50:51]
    s_mov_b64 exec, s[50:51]
    s_cbranch_scc0 L2_d26
    s_mov_b64 exec, s[82:83]
    s_nop 1
    v_mfma_f32_4x4x4_16b_bf16 v[88:91], v[12:13], v[84:85], 0
    s_nop 1
    v_mfma_f32_4x4x4_16b_bf16 v[88:91], v[10:11], v[86:87], v[88:91]
    s_nop 4
    v_cvt_pk_bf16_f32 v88, v88, v89
    v_cvt_pk_bf16_f32 v89, v90, v91
    ds_pk_add_bf16 v7, v88 offset:65408
    ds_pk_add_bf16 v7, v89 offset:65412
    s_mov_b64 exec, vcc
    s_branch L2_d26
L2_c27:
    s_mov_b64 s[50:51], vcc
    s_lshl_b64 s[52:53], s[82:83], 1
    s_andn2_b64 s[52:53], s[52:53], s[80:81]
    s_andn2_b64 s[52:53], s[52:53], s[50:51]
    s_or_b64 s[80:81], s[80:81], s[52:53]
    s_not_b64 vcc, s[52:53]
    s_mov_b64 exec, -1
    v_cndmask_b32_dpp v84, v84, v84, vcc wave_shr:1 row_mask:0xf bank_mask:0xf
    v_cndmask_b32_dpp v85, v85, v85, vcc wave_shr:1 row_mask:0xf bank_mask:0xf
    s_lshr_b64 s[52:53], s[52:53], 1
    v_cndmask_b32_dpp v86, v86, v86, vcc wave_shr:1 row_mask:0xf bank_mask:0xf
    v_cndmask_b32_dpp v87, v87, v87, vcc wave_shr:1 row_mask:0xf bank_mask:0xf
    s_andn2_b64 s[82:83], s[82:83], s[52:53]
    v_cndmask_b32_dpp v7, v7, v7, vcc wave_shr:1 row_mask:0xf bank_mask:0xf
    s_mov_b64 vcc, s[50:51]
    s_mov_b64 exec, s[50:51]
    s_cbranch_scc0 L2_d27
    s_mov_b64 exec, s[82:83]
    s_nop 1
    v_mfma_f32_4x4x4_16b_bf16 v[88:91], v[12:13], v[84:85], 0
    s_nop 1
    v_mfma_f32_4x4x4_16b_bf16 v[88:91], v[10:11], v[86:87], v[88:91]
    s_nop 4
    v_cvt_pk_bf16_f32 v88, v88, v89
    v_cvt_pk_bf16_f32 v89, v90, v91
    ds_pk_add_bf16 v7, v88 offset:65408
    ds_pk_add_bf16 v7, v89 offset:65412
    s_mov_b64 exec, vcc
    s_branch L2_d27
L2_c28:
    s_mov_b64 s[50:51], vcc
    s_lshl_b64 s[52:53], s[82:83], 1
    s_andn2_b64 s[52:53], s[52:53], s[80:81]
    s_andn2_b64 s[52:53], s[52:53], s[50:51]
    s_or_b64 s[80:81], s[80:81], s[52:53]
    s_not_b64 vcc, s[52:53]
    s_mov_b64 exec, -1
    v_cndmask_b32_dpp v84, v84, v84, vcc wave_shr:1 row_mask:0xf bank_mask:0xf
    v_cndmask_b32_dpp v85, v85, v85, vcc wave_shr:1 row_mask:0xf bank_mask:0xf
    s_lshr_b64 s[52:53], s[52:53], 1
    v_cndmask_b32_dpp v86, v86, v86, vcc wave_shr:1 row_mask:0xf bank_mask:0xf
    v_cndmask_b32_dpp v87, v87, v87, vcc wave_shr:1 row_mask:0xf bank_mask:0xf
    s_andn2_b64 s[82:83], s[82:83], s[52:53]
    v_cndmask_b32_dpp v7, v7, v7, vcc wave_shr:1 row_mask:0xf bank_mask:0xf
    s_mov_b64 vcc, s[50:51]
    s_mov_b64 exec, s[50:51]
    s_cbranch_scc0 L2_d28
    s_mov_b64 exec, s[82:83]
    s_nop 1
    v_mfma_f32_4x4x4_16b_bf16 v[88:91], v[12:13], v[84:85], 0
    s_nop 1
    v_mfma_f32_4x4x4_16b_bf16 v[88:91], v[10:11], v[86:87], v[88:91]
    s_nop 4
    v_cvt_pk_bf16_f32 v88, v88, v89
    v_cvt_pk_bf16_f32 v89, v90, v91
    ds_pk_add_bf16 v7, v88 offset:65408
    ds_pk_add_bf16 v7, v89 offset:65412
    s_mov_b64 exec, vcc
    s_branch L2_d28
L2_c29:
    s_mov_b64 s[50:51], vcc
    s_lshl_b64 s[52:53], s[82:83], 1
    s_andn2_b64 s[52:53], s[52:53], s[80:81]
    s_andn2_b64 s[52:53], s[52:53], s[50:51]
    s_or_b64 s[80:81], s[80:81], s[52:53]
    s_not_b64 vcc, s[52:53]
    s_mov_b64 exec, -1
    v_cndmask_b32_dpp v84, v84, v84, vcc wave_shr:1 row_mask:0xf bank_mask:0xf
    v_cndmask_b32_dpp v85, v85, v85, vcc wave_shr:1 row_mask:0xf bank_mask:0xf
    s_lshr_b64 s[52:53], s[52:53], 1
    v_cndmask_b32_dpp v86, v86, v86, vcc wave_shr:1 row_mask:0xf bank_mask:0xf
    v_cndmask_b32_dpp v87, v87, v87, vcc wave_shr:1 row_mask:0xf bank_mask:0xf
    s_andn2_b64 s[82:83], s[82:83], s[52:53]
    v_cndmask_b32_dpp v7, v7, v7, vcc wave_shr:1 row_mask:0xf bank_mask:0xf
    s_mov_b64 vcc, s[50:51]
    s_mov_b64 exec, s[50:51]
    s_cbranch_scc0 L2_d29
    s_mov_b64 exec, s[82:83]
    s_nop 1
    v_mfma_f32_4x4x4_16b_bf16 v[88:91], v[12:13], v[84:85], 0
    s_nop 1
    v_mfma_f32_4x4x4_16b_bf16 v[88:91], v[10:11], v[86:87], v[88:91]
    s_nop 4
    v_cvt_pk_bf16_f32 v88, v88, v89
    v_cvt_pk_bf16_f32 v89, v90, v91
    ds_pk_add_bf16 v7, v88 offset:65408
    ds_pk_add_bf16 v7, v89 offset:65412
    s_mov_b64 exec, vcc
    s_branch L2_d29
L2_c30:
    s_mov_b64 s[50:51], vcc
    s_lshl_b64 s[52:53], s[82:83], 1
    s_andn2_b64 s[52:53], s[52:53], s[80:81]
    s_andn2_b64 s[52:53], s[52:53], s[50:51]
    s_or_b64 s[80:81], s[80:81], s[52:53]
    s_not_b64 vcc, s[52:53]
    s_mov_b64 exec, -1
    v_cndmask_b32_dpp v84, v84, v84, vcc wave_shr:1 row_mask:0xf bank_mask:0xf
    v_cndmask_b32_dpp v85, v85, v85, vcc wave_shr:1 row_mask:0xf bank_mask:0xf
    s_lshr_b64 s[52:53], s[52:53], 1
    v_cndmask_b32_dpp v86, v86, v86, vcc wave_shr:1 row_mask:0xf bank_mask:0xf
    v_cndmask_b32_dpp v87, v87, v87, vcc wave_shr:1 row_mask:0xf bank_mask:0xf
    s_andn2_b64 s[82:83], s[82:83], s[52:53]
    v_cndmask_b32_dpp v7, v7, v7, vcc wave_shr:1 row_mask:0xf bank_mask:0xf
    s_mov_b64 vcc, s[50:51]
    s_mov_b64 exec, s[50:51]
    s_cbranch_scc0 L2_d30
    s_mov_b64 exec, s[82:83]
    s_nop 1
    v_mfma_f32_4x4x4_16b_bf16 v[88:91], v[12:13], v[84:85], 0
    s_nop 1
    v_mfma_f32_4x4x4_16b_bf16 v[88:91], v[10:11], v[86:87], v[88:91]
    s_nop 4
    v_cvt_pk_bf16_f32 v88, v88, v89
    v_cvt_pk_bf16_f32 v89, v90, v91
    ds_pk_add_bf16 v7, v88 offset:65408
    ds_pk_add_bf16 v7, v89 offset:65412
    s_mov_b64 exec, vcc
    s_branch L2_d30
L2_c31:
    s_mov_b64 s[50:51], vcc
    s_lshl_b64 s[52:53], s[82:83], 1
    s_andn2_b64 s[52:53], s[52:53], s[80:81]
    s_andn2_b64 s[52:53], s[52:53], s[50:51]
    s_or_b64 s[80:81], s[80:81], s[52:53]
    s_not_b64 vcc, s[52:53]
    s_mov_b64 exec, -1
    v_cndmask_b32_dpp v84, v84, v84, vcc wave_shr:1 row_mask:0xf bank_mask:0xf
    v_cndmask_b32_dpp v85, v85, v85, vcc wave_shr:1 row_mask:0xf bank_mask:0xf
    s_lshr_b64 s[52:53], s[52:53], 1
    v_cndmask_b32_dpp v86, v86, v86, vcc wave_shr:1 row_mask:0xf bank_mask:0xf
    v_cndmask_b32_dpp v87, v87, v87, vcc wave_shr:1 row_mask:0xf bank_mask:0xf
    s_andn2_b64 s[82:83], s[82:83], s[52:53]
    v_cndmask_b32_dpp v7, v7, v7, vcc wave_shr:1 row_mask:0xf bank_mask:0xf
    s_mov_b64 vcc, s[50:51]
    s_mov_b64 exec, s[50:51]
    s_cbranch_scc0 L2_d31
    s_mov_b64 exec, s[82:83]
    s_nop 1
    v_mfma_f32_4x4x4_16b_bf16 v[88:91], v[12:13], v[84:85], 0
    s_nop 1
    v_mfma_f32_4x4x4_16b_bf16 v[88:91], v[10:11], v[86:87], v[88:91]
    s_nop 4
    v_cvt_pk_bf16_f32 v88, v88, v89
    v_cvt_pk_bf16_f32 v89, v90, v91
    ds_pk_add_bf16 v7, v88 offset:65408
    ds_pk_add_bf16 v7, v89 offset:65412
    s_mov_b64 exec, vcc
    s_branch L2_d31
L2_c32:
    s_mov_b64 s[50:51], vcc
    s_lshl_b64 s[52:53], s[82:83], 1
    s_andn2_b64 s[52:53], s[52:53], s[80:81]
    s_andn2_b64 s[52:53], s[52:53], s[50:51]
    s_or_b64 s[80:81], s[80:81], s[52:53]
    s_not_b64 vcc, s[52:53]
    s_mov_b64 exec, -1
    v_cndmask_b32_dpp v84, v84, v84, vcc wave_shr:1 row_mask:0xf bank_mask:0xf
    v_cndmask_b32_dpp v85, v85, v85, vcc wave_shr:1 row_mask:0xf bank_mask:0xf
    s_lshr_b64 s[52:53], s[52:53], 1
    v_cndmask_b32_dpp v86, v86, v86, vcc wave_shr:1 row_mask:0xf bank_mask:0xf
    v_cndmask_b32_dpp v87, v87, v87, vcc wave_shr:1 row_mask:0xf bank_mask:0xf
    s_andn2_b64 s[82:83], s[82:83], s[52:53]
    v_cndmask_b32_dpp v7, v7, v7, vcc wave_shr:1 row_mask:0xf bank_mask:0xf
    s_mov_b64 vcc, s[50:51]
    s_mov_b64 exec, s[50:51]
    s_cbranch_scc0 L2_d32
    s_mov_b64 exec, s[82:83]
    s_nop 1
    v_mfma_f32_4x4x4_16b_bf16 v[88:91], v[12:13], v[84:85], 0
    s_nop 1
    v_mfma_f32_4x4x4_16b_bf16 v[88:91], v[10:11], v[86:87], v[88:91]
    s_nop 4
    v_cvt_pk_bf16_f32 v88, v88, v89
    v_cvt_pk_bf16_f32 v89, v90, v91
    ds_pk_add_bf16 v7, v88 offset:65408
    ds_pk_add_bf16 v7, v89 offset:65412
    s_mov_b64 exec, vcc
    s_branch L2_d32
L2_c33:
    s_mov_b64 s[50:51], vcc
    s_lshl_b64 s[52:53], s[82:83], 1
    s_andn2_b64 s[52:53], s[52:53], s[80:81]
    s_andn2_b64 s[52:53], s[52:53], s[50:51]
    s_or_b64 s[80:81], s[80:81], s[52:53]
    s_not_b64 vcc, s[52:53]
    s_mov_b64 exec, -1
    v_cndmask_b32_dpp v84, v84, v84, vcc wave_shr:1 row_mask:0xf bank_mask:0xf
    v_cndmask_b32_dpp v85, v85, v85, vcc wave_shr:1 row_mask:0xf bank_mask:0xf
    s_lshr_b64 s[52:53], s[52:53], 1
    v_cndmask_b32_dpp v86, v86, v86, vcc wave_shr:1 row_mask:0xf bank_mask:0xf
    v_cndmask_b32_dpp v87, v87, v87, vcc wave_shr:1 row_mask:0xf bank_mask:0xf
    s_andn2_b64 s[82:83], s[82:83], s[52:53]
    v_cndmask_b32_dpp v7, v7, v7, vcc wave_shr:1 row_mask:0xf bank_mask:0xf
    s_mov_b64 vcc, s[50:51]
    s_mov_b64 exec, s[50:51]
    s_cbranch_scc0 L2_d33
    s_mov_b64 exec, s[82:83]
    s_nop 1
    v_mfma_f32_4x4x4_16b_bf16 v[88:91], v[12:13], v[84:85], 0
    s_nop 1
    v_mfma_f32_4x4x4_16b_bf16 v[88:91], v[10:11], v[86:87], v[88:91]
    s_nop 4
    v_cvt_pk_bf16_f32 v88, v88, v89
    v_cvt_pk_bf16_f32 v89, v90, v91
    ds_pk_add_bf16 v7, v88 offset:65408
    ds_pk_add_bf16 v7, v89 offset:65412
    s_mov_b64 exec, vcc
    s_branch L2_d33
L2_xo34:
    v_cmp_lt_u32 vcc, 20, v99
    s_mov_b32 s101, 1
    s_cbranch_vccz L2_xp34
    v_cmp_lt_u32 vcc, 32, v99
    v_cmp_lt_u32 s[58:59], 31, v88
    s_mov_b32 s101, 2
    s_or_b64 vcc, vcc, s[58:59]
    s_cbranch_scc0 L2_xp34
    s_mov_b32 s37, 0x10000
    s_branch L2_xp34
L2_c35:
    s_mov_b64 s[50:51], vcc
    s_lshl_b64 s[52:53], s[82:83], 1
    s_andn2_b64 s[52:53], s[52:53], s[80:81]
    s_andn2_b64 s[52:53], s[52:53], s[50:51]
    s_or_b64 s[80:81], s[80:81], s[52:53]
    s_not_b64 vcc, s[52:53]
    s_mov_b64 exec, -1
    v_cndmask_b32_dpp v84, v84, v84, vcc wave_shr:1 row_mask:0xf bank_mask:0xf
    v_cndmask_b32_dpp v85, v85, v85, vcc wave_shr:1 row_mask:0xf bank_mask:0xf
    s_lshr_b64 s[52:53], s[52:53], 1
    v_cndmask_b32_dpp v86, v86, v86, vcc wave_shr:1 row_mask:0xf bank_mask:0xf
    v_cndmask_b32_dpp v87, v87, v87, vcc wave_shr:1 row_mask:0xf bank_mask:0xf
    s_andn2_b64 s[82:83], s[82:83], s[52:53]
    v_cndmask_b32_dpp v7, v7, v7, vcc wave_shr:1 row_mask:0xf bank_mask:0xf
    s_mov_b64 vcc, s[50:51]
    s_mov_b64 exec, s[50:51]
    s_cbranch_scc0 L2_d35
    s_mov_b64 exec, s[82:83]
    s_nop 1
    v_mfma_f32_4x4x4_16b_bf16 v[88:91], v[12:13], v[84:85], 0
    s_nop 1
    v_mfma_f32_4x4x4_16b_bf16 v[88:91], v[10:11], v[86:87], v[88:91]
    s_nop 4
    v_cvt_pk_bf16_f32 v88, v88, v89
    v_cvt_pk_bf16_f32 v89, v90, v91
    ds_pk_add_bf16 v7, v88 offset:65408
    ds_pk_add_bf16 v7, v89 offset:65412
    s_mov_b64 exec, vcc
    s_branch L2_d35
L2_c36:
    s_mov_b64 s[50:51], vcc
    s_lshl_b64 s[52:53], s[82:83], 1
    s_andn2_b64 s[52:53], s[52:53], s[80:81]
    s_andn2_b64 s[52:53], s[52:53], s[50:51]
    s_or_b64 s[80:81], s[80:81], s[52:53]
    s_not_b64 vcc, s[52:53]
    s_mov_b64 exec, -1
    v_cndmask_b32_dpp v84, v84, v84, vcc wave_shr:1 row_mask:0xf bank_mask:0xf
    v_cndmask_b32_dpp v85, v85, v85, vcc wave_shr:1 row_mask:0xf bank_mask:0xf
    s_lshr_b64 s[52:53], s[52:53], 1
    v_cndmask_b32_dpp v86, v86, v86, vcc wave_shr:1 row_mask:0xf bank_mask:0xf
    v_cndmask_b32_dpp v87, v87, v87, vcc wave_shr:1 row_mask:0xf bank_mask:0xf
    s_andn2_b64 s[82:83], s[82:83], s[52:53]
    v_cndmask_b32_dpp v7, v7, v7, vcc wave_shr:1 row_mask:0xf bank_mask:0xf
    s_mov_b64 vcc, s[50:51]
    s_mov_b64 exec, s[50:51]
    s_cbranch_scc0 L2_d36
    s_mov_b64 exec, s[82:83]
    s_nop 1
    v_mfma_f32_4x4x4_16b_bf16 v[88:91], v[12:13], v[84:85], 0
    s_nop 1
    v_mfma_f32_4x4x4_16b_bf16 v[88:91], v[10:11], v[86:87], v[88:91]
    s_nop 4
    v_cvt_pk_bf16_f32 v88, v88, v89
    v_cvt_pk_bf16_f32 v89, v90, v91
    ds_pk_add_bf16 v7, v88 offset:65408
    ds_pk_add_bf16 v7, v89 offset:65412
    s_mov_b64 exec, vcc
    s_branch L2_d36
L2_c37:
    s_mov_b64 s[50:51], vcc
    s_lshl_b64 s[52:53], s[82:83], 1
    s_andn2_b64 s[52:53], s[52:53], s[80:81]
    s_andn2_b64 s[52:53], s[52:53], s[50:51]
    s_or_b64 s[80:81], s[80:81], s[52:53]
    s_not_b64 vcc, s[52:53]
    s_mov_b64 exec, -1
    v_cndmask_b32_dpp v84, v84, v84, vcc wave_shr:1 row_mask:0xf bank_mask:0xf
    v_cndmask_b32_dpp v85, v85, v85, vcc wave_shr:1 row_mask:0xf bank_mask:0xf
    s_lshr_b64 s[52:53], s[52:53], 1
    v_cndmask_b32_dpp v86, v86, v86, vcc wave_shr:1 row_mask:0xf bank_mask:0xf
    v_cndmask_b32_dpp v87, v87, v87, vcc wave_shr:1 row_mask:0xf bank_mask:0xf
    s_andn2_b64 s[82:83], s[82:83], s[52:53]
    v_cndmask_b32_dpp v7, v7, v7, vcc wave_shr:1 row_mask:0xf bank_mask:0xf
    s_mov_b64 vcc, s[50:51]
    s_mov_b64 exec, s[50:51]
    s_cbranch_scc0 L2_d37
    s_mov_b64 exec, s[82:83]
    s_nop 1
    v_mfma_f32_4x4x4_16b_bf16 v[88:91], v[12:13], v[84:85], 0
    s_nop 1
    v_mfma_f32_4x4x4_16b_bf16 v[88:91], v[10:11], v[86:87], v[88:91]
    s_nop 4
    v_cvt_pk_bf16_f32 v88, v88, v89
    v_cvt_pk_bf16_f32 v89, v90, v91
    ds_pk_add_bf16 v7, v88 offset:65408
    ds_pk_add_bf16 v7, v89 offset:65412
    s_mov_b64 exec, vcc
    s_branch L2_d37
L2_c38:
    s_mov_b64 s[50:51], vcc
    s_lshl_b64 s[52:53], s[82:83], 1
    s_andn2_b64 s[52:53], s[52:53], s[80:81]
    s_andn2_b64 s[52:53], s[52:53], s[50:51]
    s_or_b64 s[80:81], s[80:81], s[52:53]
    s_not_b64 vcc, s[52:53]
    s_mov_b64 exec, -1
    v_cndmask_b32_dpp v84, v84, v84, vcc wave_shr:1 row_mask:0xf bank_mask:0xf
    v_cndmask_b32_dpp v85, v85, v85, vcc wave_shr:1 row_mask:0xf bank_mask:0xf
    s_lshr_b64 s[52:53], s[52:53], 1
    v_cndmask_b32_dpp v86, v86, v86, vcc wave_shr:1 row_mask:0xf bank_mask:0xf
    v_cndmask_b32_dpp v87, v87, v87, vcc wave_shr:1 row_mask:0xf bank_mask:0xf
    s_andn2_b64 s[82:83], s[82:83], s[52:53]
    v_cndmask_b32_dpp v7, v7, v7, vcc wave_shr:1 row_mask:0xf bank_mask:0xf
    s_mov_b64 vcc, s[50:51]
    s_mov_b64 exec, s[50:51]
    s_cbranch_scc0 L2_d38
    s_mov_b64 exec, s[82:83]
    s_nop 1
    v_mfma_f32_4x4x4_16b_bf16 v[88:91], v[12:13], v[84:85], 0
    s_nop 1
    v_mfma_f32_4x4x4_16b_bf16 v[88:91], v[10:11], v[86:87], v[88:91]
    s_nop 4
    v_cvt_pk_bf16_f32 v88, v88, v89
    v_cvt_pk_bf16_f32 v89, v90, v91
    ds_pk_add_bf16 v7, v88 offset:65408
    ds_pk_add_bf16 v7, v89 offset:65412
    s_mov_b64 exec, vcc
    s_branch L2_d38
L2_c39:
    s_mov_b64 s[50:51], vcc
    s_lshl_b64 s[52:53], s[82:83], 1
    s_andn2_b64 s[52:53], s[52:53], s[80:81]
    s_andn2_b64 s[52:53], s[52:53], s[50:51]
    s_or_b64 s[80:81], s[80:81], s[52:53]
    s_not_b64 vcc, s[52:53]
    s_mov_b64 exec, -1
    v_cndmask_b32_dpp v84, v84, v84, vcc wave_shr:1 row_mask:0xf bank_mask:0xf
    v_cndmask_b32_dpp v85, v85, v85, vcc wave_shr:1 row_mask:0xf bank_mask:0xf
    s_lshr_b64 s[52:53], s[52:53], 1
    v_cndmask_b32_dpp v86, v86, v86, vcc wave_shr:1 row_mask:0xf bank_mask:0xf
    v_cndmask_b32_dpp v87, v87, v87, vcc wave_shr:1 row_mask:0xf bank_mask:0xf
    s_andn2_b64 s[82:83], s[82:83], s[52:53]
    v_cndmask_b32_dpp v7, v7, v7, vcc wave_shr:1 row_mask:0xf bank_mask:0xf
    s_mov_b64 vcc, s[50:51]
    s_mov_b64 exec, s[50:51]
    s_cbranch_scc0 L2_d39
    s_mov_b64 exec, s[82:83]
    s_nop 1
    v_mfma_f32_4x4x4_16b_bf16 v[88:91], v[12:13], v[84:85], 0
    s_nop 1
    v_mfma_f32_4x4x4_16b_bf16 v[88:91], v[10:11], v[86:87], v[88:91]
    s_nop 4
    v_cvt_pk_bf16_f32 v88, v88, v89
    v_cvt_pk_bf16_f32 v89, v90, v91
    ds_pk_add_bf16 v7, v88 offset:65408
    ds_pk_add_bf16 v7, v89 offset:65412
    s_mov_b64 exec, vcc
    s_branch L2_d39
L2_c40:
    s_mov_b64 s[50:51], vcc
    s_lshl_b64 s[52:53], s[82:83], 1
    s_andn2_b64 s[52:53], s[52:53], s[80:81]
    s_andn2_b64 s[52:53], s[52:53], s[50:51]
    s_or_b64 s[80:81], s[80:81], s[52:53]
    s_not_b64 vcc, s[52:53]
    s_mov_b64 exec, -1
    v_cndmask_b32_dpp v84, v84, v84, vcc wave_shr:1 row_mask:0xf bank_mask:0xf
    v_cndmask_b32_dpp v85, v85, v85, vcc wave_shr:1 row_mask:0xf bank_mask:0xf
    s_lshr_b64 s[52:53], s[52:53], 1
    v_cndmask_b32_dpp v86, v86, v86, vcc wave_shr:1 row_mask:0xf bank_mask:0xf
    v_cndmask_b32_dpp v87, v87, v87, vcc wave_shr:1 row_mask:0xf bank_mask:0xf
    s_andn2_b64 s[82:83], s[82:83], s[52:53]
    v_cndmask_b32_dpp v7, v7, v7, vcc wave_shr:1 row_mask:0xf bank_mask:0xf
    s_mov_b64 vcc, s[50:51]
    s_mov_b64 exec, s[50:51]
    s_cbranch_scc0 L2_d40
    s_mov_b64 exec, s[82:83]
    s_nop 1
    v_mfma_f32_4x4x4_16b_bf16 v[88:91], v[12:13], v[84:85], 0
    s_nop 1
    v_mfma_f32_4x4x4_16b_bf16 v[88:91], v[10:11], v[86:87], v[88:91]
    s_nop 4
    v_cvt_pk_bf16_f32 v88, v88, v89
    v_cvt_pk_bf16_f32 v89, v90, v91
    ds_pk_add_bf16 v7, v88 offset:65408
    ds_pk_add_bf16 v7, v89 offset:65412
    s_mov_b64 exec, vcc
    s_branch L2_d40
L2_c41:
    s_mov_b64 s[50:51], vcc
    s_lshl_b64 s[52:53], s[82:83], 1
    s_andn2_b64 s[52:53], s[52:53], s[80:81]
    s_andn2_b64 s[52:53], s[52:53], s[50:51]
    s_or_b64 s[80:81], s[80:81], s[52:53]
    s_not_b64 vcc, s[52:53]
    s_mov_b64 exec, -1
    v_cndmask_b32_dpp v84, v84, v84, vcc wave_shr:1 row_mask:0xf bank_mask:0xf
    v_cndmask_b32_dpp v85, v85, v85, vcc wave_shr:1 row_mask:0xf bank_mask:0xf
    s_lshr_b64 s[52:53], s[52:53], 1
    v_cndmask_b32_dpp v86, v86, v86, vcc wave_shr:1 row_mask:0xf bank_mask:0xf
    v_cndmask_b32_dpp v87, v87, v87, vcc wave_shr:1 row_mask:0xf bank_mask:0xf
    s_andn2_b64 s[82:83], s[82:83], s[52:53]
    v_cndmask_b32_dpp v7, v7, v7, vcc wave_shr:1 row_mask:0xf bank_mask:0xf
    s_mov_b64 vcc, s[50:51]
    s_mov_b64 exec, s[50:51]
    s_cbranch_scc0 L2_d41
    s_mov_b64 exec, s[82:83]
    s_nop 1
    v_mfma_f32_4x4x4_16b_bf16 v[88:91], v[12:13], v[84:85], 0
    s_nop 1
    v_mfma_f32_4x4x4_16b_bf16 v[88:91], v[10:11], v[86:87], v[88:91]
    s_nop 4
    v_cvt_pk_bf16_f32 v88, v88, v89
    v_cvt_pk_bf16_f32 v89, v90, v91
    ds_pk_add_bf16 v7, v88 offset:65408
    ds_pk_add_bf16 v7, v89 offset:65412
    s_mov_b64 exec, vcc
    s_branch L2_d41
L2_c42:
    s_mov_b64 s[50:51], vcc
    s_lshl_b64 s[52:53], s[82:83], 1
    s_andn2_b64 s[52:53], s[52:53], s[80:81]
    s_andn2_b64 s[52:53], s[52:53], s[50:51]
    s_or_b64 s[80:81], s[80:81], s[52:53]
    s_not_b64 vcc, s[52:53]
    s_mov_b64 exec, -1
    v_cndmask_b32_dpp v84, v84, v84, vcc wave_shr:1 row_mask:0xf bank_mask:0xf
    v_cndmask_b32_dpp v85, v85, v85, vcc wave_shr:1 row_mask:0xf bank_mask:0xf
    s_lshr_b64 s[52:53], s[52:53], 1
    v_cndmask_b32_dpp v86, v86, v86, vcc wave_shr:1 row_mask:0xf bank_mask:0xf
    v_cndmask_b32_dpp v87, v87, v87, vcc wave_shr:1 row_mask:0xf bank_mask:0xf
    s_andn2_b64 s[82:83], s[82:83], s[52:53]
    v_cndmask_b32_dpp v7, v7, v7, vcc wave_shr:1 row_mask:0xf bank_mask:0xf
    s_mov_b64 vcc, s[50:51]
    s_mov_b64 exec, s[50:51]
    s_cbranch_scc0 L2_d42
    s_mov_b64 exec, s[82:83]
    s_nop 1
    v_mfma_f32_4x4x4_16b_bf16 v[88:91], v[12:13], v[84:85], 0
    s_nop 1
    v_mfma_f32_4x4x4_16b_bf16 v[88:91], v[10:11], v[86:87], v[88:91]
    s_nop 4
    v_cvt_pk_bf16_f32 v88, v88, v89
    v_cvt_pk_bf16_f32 v89, v90, v91
    ds_pk_add_bf16 v7, v88 offset:65408
    ds_pk_add_bf16 v7, v89 offset:65412
    s_mov_b64 exec, vcc
    s_branch L2_d42
L2_xa43:
    s_cmp_eq_u32 s101, 1
    s_cbranch_scc1 L2_xc43
    v_lshlrev_b32 v89, 0, v96
    v_add_u32 v90, 140, v97
    v_bitop3_b32 v90, v89, v45, v90 bitop3:0x6a
    ds_write_b32 v98, v90 offset:28
    v_lshlrev_b32 v89, 4, v96
    v_add_u32 v90, 120, v97
    v_bitop3_b32 v90, v89, v45, v90 bitop3:0x6a
    ds_write_b32 v98, v90 offset:24
    v_lshlrev_b32 v89, 8, v96
    v_add_u32 v90, 100, v97
    v_bitop3_b32 v90, v89, v45, v90 bitop3:0x6a
    ds_write_b32 v98, v90 offset:20
L2_xc43:
    v_lshlrev_b32 v89, 12, v96
    v_add_u32 v90, 80, v97
    v_bitop3_b32 v90, v89, v45, v90 bitop3:0x6a
    ds_write_b32 v98, v90 offset:16
    s_branch L2_xb43
L2_xe43:
    v_cmp_lt_u32 vcc, 32, v99
    v_cmp_lt_u32 s[58:59], 31, v88
    v_lshrrev_b32 v89, 16, v96
    v_add_u32 v97, 80, v97
    s_or_b64 vcc, vcc, s[58:59]
    s_cbranch_scc1 L2_xs43
    v_lshlrev_b32 v89, v1, v89
    v_and_b32 v89, v45, v89
    v_cmp_ne_u32 vcc, 0, v89
    v_xor_b32 v90, v97, v89
    s_add_u32 s3, s37, s38
    v_mbcnt_lo_u32_b32 v98, vcc_lo, 0
    v_mbcnt_hi_u32_b32 v98, vcc_hi, v98
    s_bcnt1_i32_b64 s41, vcc
    v_lshl_add_u32 v98, v98, 2, s3
    s_mov_b64 exec, vcc
    ds_write_b32 v98, v90
    s_mov_b64 exec, -1
    s_lshl2_add_u32 s37, s41, s37
    s_branch L2_xr43
L2_xf43:
    s_waitcnt lgkmcnt(0)
    s_cmp_gt_u32 s37, 1024
    s_cbranch_scc1 L2_xs43
    v_mov_b32 v43, -1
    s_cmp_ge_u32 s37, 512
    s_cbranch_scc1 L2_xg43
    v_mov_b32 v42, -1
    s_cmp_ge_u32 s37, 256
    s_cbranch_scc1 L2_xg43
    v_mov_b32 v41, -1
    s_branch L2_xg43
L2_xs43:
    s_waitcnt lgkmcnt(0)
    v_mov_b32 v40, -1
    v_mov_b32 v41, -1
    v_mov_b32 v42, -1
    v_mov_b32 v43, -1
    s_add_u32 s3, s42, 2
    s_bitset1_b32 s36, s3
    s_branch L2_xg43
L2_c44:
    s_mov_b64 s[50:51], vcc
    s_lshl_b64 s[52:53], s[82:83], 1
    s_andn2_b64 s[52:53], s[52:53], s[80:81]
    s_andn2_b64 s[52:53], s[52:53], s[50:51]
    s_or_b64 s[80:81], s[80:81], s[52:53]
    s_not_b64 vcc, s[52:53]
    s_mov_b64 exec, -1
    v_cndmask_b32_dpp v84, v84, v84, vcc wave_shr:1 row_mask:0xf bank_mask:0xf
    v_cndmask_b32_dpp v85, v85, v85, vcc wave_shr:1 row_mask:0xf bank_mask:0xf
    s_lshr_b64 s[52:53], s[52:53], 1
    v_cndmask_b32_dpp v86, v86, v86, vcc wave_shr:1 row_mask:0xf bank_mask:0xf
    v_cndmask_b32_dpp v87, v87, v87, vcc wave_shr:1 row_mask:0xf bank_mask:0xf
    s_andn2_b64 s[82:83], s[82:83], s[52:53]
    v_cndmask_b32_dpp v7, v7, v7, vcc wave_shr:1 row_mask:0xf bank_mask:0xf
    s_mov_b64 vcc, s[50:51]
    s_mov_b64 exec, s[50:51]
    s_cbranch_scc0 L2_d44
    s_mov_b64 exec, s[82:83]
    s_nop 1
    v_mfma_f32_4x4x4_16b_bf16 v[88:91], v[12:13], v[84:85], 0
    s_nop 1
    v_mfma_f32_4x4x4_16b_bf16 v[88:91], v[10:11], v[86:87], v[88:91]
    s_nop 4
    v_cvt_pk_bf16_f32 v88, v88, v89
    v_cvt_pk_bf16_f32 v89, v90, v91
    ds_pk_add_bf16 v7, v88 offset:65408
    ds_pk_add_bf16 v7, v89 offset:65412
    s_mov_b64 exec, vcc
    s_branch L2_d44
L2_c45:
    s_mov_b64 s[50:51], vcc
    s_lshl_b64 s[52:53], s[82:83], 1
    s_andn2_b64 s[52:53], s[52:53], s[80:81]
    s_andn2_b64 s[52:53], s[52:53], s[50:51]
    s_or_b64 s[80:81], s[80:81], s[52:53]
    s_not_b64 vcc, s[52:53]
    s_mov_b64 exec, -1
    v_cndmask_b32_dpp v84, v84, v84, vcc wave_shr:1 row_mask:0xf bank_mask:0xf
    v_cndmask_b32_dpp v85, v85, v85, vcc wave_shr:1 row_mask:0xf bank_mask:0xf
    s_lshr_b64 s[52:53], s[52:53], 1
    v_cndmask_b32_dpp v86, v86, v86, vcc wave_shr:1 row_mask:0xf bank_mask:0xf
    v_cndmask_b32_dpp v87, v87, v87, vcc wave_shr:1 row_mask:0xf bank_mask:0xf
    s_andn2_b64 s[82:83], s[82:83], s[52:53]
    v_cndmask_b32_dpp v7, v7, v7, vcc wave_shr:1 row_mask:0xf bank_mask:0xf
    s_mov_b64 vcc, s[50:51]
    s_mov_b64 exec, s[50:51]
    s_cbranch_scc0 L2_d45
    s_mov_b64 exec, s[82:83]
    s_nop 1
    v_mfma_f32_4x4x4_16b_bf16 v[88:91], v[12:13], v[84:85], 0
    s_nop 1
    v_mfma_f32_4x4x4_16b_bf16 v[88:91], v[10:11], v[86:87], v[88:91]
    s_nop 4
    v_cvt_pk_bf16_f32 v88, v88, v89
    v_cvt_pk_bf16_f32 v89, v90, v91
    ds_pk_add_bf16 v7, v88 offset:65408
    ds_pk_add_bf16 v7, v89 offset:65412
    s_mov_b64 exec, vcc
    s_branch L2_d45
L2_c46:
    s_mov_b64 s[50:51], vcc
    s_lshl_b64 s[52:53], s[82:83], 1
    s_andn2_b64 s[52:53], s[52:53], s[80:81]
    s_andn2_b64 s[52:53], s[52:53], s[50:51]
    s_or_b64 s[80:81], s[80:81], s[52:53]
    s_not_b64 vcc, s[52:53]
    s_mov_b64 exec, -1
    v_cndmask_b32_dpp v84, v84, v84, vcc wave_shr:1 row_mask:0xf bank_mask:0xf
    v_cndmask_b32_dpp v85, v85, v85, vcc wave_shr:1 row_mask:0xf bank_mask:0xf
    s_lshr_b64 s[52:53], s[52:53], 1
    v_cndmask_b32_dpp v86, v86, v86, vcc wave_shr:1 row_mask:0xf bank_mask:0xf
    v_cndmask_b32_dpp v87, v87, v87, vcc wave_shr:1 row_mask:0xf bank_mask:0xf
    s_andn2_b64 s[82:83], s[82:83], s[52:53]
    v_cndmask_b32_dpp v7, v7, v7, vcc wave_shr:1 row_mask:0xf bank_mask:0xf
    s_mov_b64 vcc, s[50:51]
    s_mov_b64 exec, s[50:51]
    s_cbranch_scc0 L2_d46
    s_mov_b64 exec, s[82:83]
    s_nop 1
    v_mfma_f32_4x4x4_16b_bf16 v[88:91], v[12:13], v[84:85], 0
    s_nop 1
    v_mfma_f32_4x4x4_16b_bf16 v[88:91], v[10:11], v[86:87], v[88:91]
    s_nop 4
    v_cvt_pk_bf16_f32 v88, v88, v89
    v_cvt_pk_bf16_f32 v89, v90, v91
    ds_pk_add_bf16 v7, v88 offset:65408
    ds_pk_add_bf16 v7, v89 offset:65412
    s_mov_b64 exec, vcc
    s_branch L2_d46
L2_c47:
    s_mov_b64 s[50:51], vcc
    s_lshl_b64 s[52:53], s[82:83], 1
    s_andn2_b64 s[52:53], s[52:53], s[80:81]
    s_andn2_b64 s[52:53], s[52:53], s[50:51]
    s_or_b64 s[80:81], s[80:81], s[52:53]
    s_not_b64 vcc, s[52:53]
    s_mov_b64 exec, -1
    v_cndmask_b32_dpp v84, v84, v84, vcc wave_shr:1 row_mask:0xf bank_mask:0xf
    v_cndmask_b32_dpp v85, v85, v85, vcc wave_shr:1 row_mask:0xf bank_mask:0xf
    s_lshr_b64 s[52:53], s[52:53], 1
    v_cndmask_b32_dpp v86, v86, v86, vcc wave_shr:1 row_mask:0xf bank_mask:0xf
    v_cndmask_b32_dpp v87, v87, v87, vcc wave_shr:1 row_mask:0xf bank_mask:0xf
    s_andn2_b64 s[82:83], s[82:83], s[52:53]
    v_cndmask_b32_dpp v7, v7, v7, vcc wave_shr:1 row_mask:0xf bank_mask:0xf
    s_mov_b64 vcc, s[50:51]
    s_mov_b64 exec, s[50:51]
    s_cbranch_scc0 L2_d47
    s_mov_b64 exec, s[82:83]
    s_nop 1
    v_mfma_f32_4x4x4_16b_bf16 v[88:91], v[12:13], v[84:85], 0
    s_nop 1
    v_mfma_f32_4x4x4_16b_bf16 v[88:91], v[10:11], v[86:87], v[88:91]
    s_nop 4
    v_cvt_pk_bf16_f32 v88, v88, v89
    v_cvt_pk_bf16_f32 v89, v90, v91
    ds_pk_add_bf16 v7, v88 offset:65408
    ds_pk_add_bf16 v7, v89 offset:65412
    s_mov_b64 exec, vcc
    s_branch L2_d47
L2_c48:
    s_mov_b64 s[50:51], vcc
    s_lshl_b64 s[52:53], s[82:83], 1
    s_andn2_b64 s[52:53], s[52:53], s[80:81]
    s_andn2_b64 s[52:53], s[52:53], s[50:51]
    s_or_b64 s[80:81], s[80:81], s[52:53]
    s_not_b64 vcc, s[52:53]
    s_mov_b64 exec, -1
    v_cndmask_b32_dpp v84, v84, v84, vcc wave_shr:1 row_mask:0xf bank_mask:0xf
    v_cndmask_b32_dpp v85, v85, v85, vcc wave_shr:1 row_mask:0xf bank_mask:0xf
    s_lshr_b64 s[52:53], s[52:53], 1
    v_cndmask_b32_dpp v86, v86, v86, vcc wave_shr:1 row_mask:0xf bank_mask:0xf
    v_cndmask_b32_dpp v87, v87, v87, vcc wave_shr:1 row_mask:0xf bank_mask:0xf
    s_andn2_b64 s[82:83], s[82:83], s[52:53]
    v_cndmask_b32_dpp v7, v7, v7, vcc wave_shr:1 row_mask:0xf bank_mask:0xf
    s_mov_b64 vcc, s[50:51]
    s_mov_b64 exec, s[50:51]
    s_cbranch_scc0 L2_d48
    s_mov_b64 exec, s[82:83]
    s_nop 1
    v_mfma_f32_4x4x4_16b_bf16 v[88:91], v[12:13], v[84:85], 0
    s_nop 1
    v_mfma_f32_4x4x4_16b_bf16 v[88:91], v[10:11], v[86:87], v[88:91]
    s_nop 4
    v_cvt_pk_bf16_f32 v88, v88, v89
    v_cvt_pk_bf16_f32 v89, v90, v91
    ds_pk_add_bf16 v7, v88 offset:65408
    ds_pk_add_bf16 v7, v89 offset:65412
    s_mov_b64 exec, vcc
    s_branch L2_d48
L2_c49:
    s_mov_b64 s[50:51], vcc
    s_lshl_b64 s[52:53], s[82:83], 1
    s_andn2_b64 s[52:53], s[52:53], s[80:81]
    s_andn2_b64 s[52:53], s[52:53], s[50:51]
    s_or_b64 s[80:81], s[80:81], s[52:53]
    s_not_b64 vcc, s[52:53]
    s_mov_b64 exec, -1
    v_cndmask_b32_dpp v84, v84, v84, vcc wave_shr:1 row_mask:0xf bank_mask:0xf
    v_cndmask_b32_dpp v85, v85, v85, vcc wave_shr:1 row_mask:0xf bank_mask:0xf
    s_lshr_b64 s[52:53], s[52:53], 1
    v_cndmask_b32_dpp v86, v86, v86, vcc wave_shr:1 row_mask:0xf bank_mask:0xf
    v_cndmask_b32_dpp v87, v87, v87, vcc wave_shr:1 row_mask:0xf bank_mask:0xf
    s_andn2_b64 s[82:83], s[82:83], s[52:53]
    v_cndmask_b32_dpp v7, v7, v7, vcc wave_shr:1 row_mask:0xf bank_mask:0xf
    s_mov_b64 vcc, s[50:51]
    s_mov_b64 exec, s[50:51]
    s_cbranch_scc0 L2_d49
    s_mov_b64 exec, s[82:83]
    s_nop 1
    v_mfma_f32_4x4x4_16b_bf16 v[88:91], v[12:13], v[84:85], 0
    s_nop 1
    v_mfma_f32_4x4x4_16b_bf16 v[88:91], v[10:11], v[86:87], v[88:91]
    s_nop 4
    v_cvt_pk_bf16_f32 v88, v88, v89
    v_cvt_pk_bf16_f32 v89, v90, v91
    ds_pk_add_bf16 v7, v88 offset:65408
    ds_pk_add_bf16 v7, v89 offset:65412
    s_mov_b64 exec, vcc
    s_branch L2_d49
L2_c50:
    s_mov_b64 s[50:51], vcc
    s_lshl_b64 s[52:53], s[82:83], 1
    s_andn2_b64 s[52:53], s[52:53], s[80:81]
    s_andn2_b64 s[52:53], s[52:53], s[50:51]
    s_or_b64 s[80:81], s[80:81], s[52:53]
    s_not_b64 vcc, s[52:53]
    s_mov_b64 exec, -1
    v_cndmask_b32_dpp v84, v84, v84, vcc wave_shr:1 row_mask:0xf bank_mask:0xf
    v_cndmask_b32_dpp v85, v85, v85, vcc wave_shr:1 row_mask:0xf bank_mask:0xf
    s_lshr_b64 s[52:53], s[52:53], 1
    v_cndmask_b32_dpp v86, v86, v86, vcc wave_shr:1 row_mask:0xf bank_mask:0xf
    v_cndmask_b32_dpp v87, v87, v87, vcc wave_shr:1 row_mask:0xf bank_mask:0xf
    s_andn2_b64 s[82:83], s[82:83], s[52:53]
    v_cndmask_b32_dpp v7, v7, v7, vcc wave_shr:1 row_mask:0xf bank_mask:0xf
    s_mov_b64 vcc, s[50:51]
    s_mov_b64 exec, s[50:51]
    s_cbranch_scc0 L2_d50
    s_mov_b64 exec, s[82:83]
    s_nop 1
    v_mfma_f32_4x4x4_16b_bf16 v[88:91], v[12:13], v[84:85], 0
    s_nop 1
    v_mfma_f32_4x4x4_16b_bf16 v[88:91], v[10:11], v[86:87], v[88:91]
    s_nop 4
    v_cvt_pk_bf16_f32 v88, v88, v89
    v_cvt_pk_bf16_f32 v89, v90, v91
    ds_pk_add_bf16 v7, v88 offset:65408
    ds_pk_add_bf16 v7, v89 offset:65412
    s_mov_b64 exec, vcc
    s_branch L2_d50
L2_c51:
    s_mov_b64 s[50:51], vcc
    s_lshl_b64 s[52:53], s[82:83], 1
    s_andn2_b64 s[52:53], s[52:53], s[80:81]
    s_andn2_b64 s[52:53], s[52:53], s[50:51]
    s_or_b64 s[80:81], s[80:81], s[52:53]
    s_not_b64 vcc, s[52:53]
    s_mov_b64 exec, -1
    v_cndmask_b32_dpp v84, v84, v84, vcc wave_shr:1 row_mask:0xf bank_mask:0xf
    v_cndmask_b32_dpp v85, v85, v85, vcc wave_shr:1 row_mask:0xf bank_mask:0xf
    s_lshr_b64 s[52:53], s[52:53], 1
    v_cndmask_b32_dpp v86, v86, v86, vcc wave_shr:1 row_mask:0xf bank_mask:0xf
    v_cndmask_b32_dpp v87, v87, v87, vcc wave_shr:1 row_mask:0xf bank_mask:0xf
    s_andn2_b64 s[82:83], s[82:83], s[52:53]
    v_cndmask_b32_dpp v7, v7, v7, vcc wave_shr:1 row_mask:0xf bank_mask:0xf
    s_mov_b64 vcc, s[50:51]
    s_mov_b64 exec, s[50:51]
    s_cbranch_scc0 L2_d51
    s_mov_b64 exec, s[82:83]
    s_nop 1
    v_mfma_f32_4x4x4_16b_bf16 v[88:91], v[12:13], v[84:85], 0
    s_nop 1
    v_mfma_f32_4x4x4_16b_bf16 v[88:91], v[10:11], v[86:87], v[88:91]
    s_nop 4
    v_cvt_pk_bf16_f32 v88, v88, v89
    v_cvt_pk_bf16_f32 v89, v90, v91
    ds_pk_add_bf16 v7, v88 offset:65408
    ds_pk_add_bf16 v7, v89 offset:65412
    s_mov_b64 exec, vcc
    s_branch L2_d51
L2_xo52:
    v_cmp_lt_u32 vcc, 20, v99
    s_mov_b32 s101, 1
    s_cbranch_vccz L2_xp52
    v_cmp_lt_u32 vcc, 32, v99
    v_cmp_lt_u32 s[58:59], 31, v88
    s_mov_b32 s101, 2
    s_or_b64 vcc, vcc, s[58:59]
    s_cbranch_scc0 L2_xp52
    s_mov_b32 s37, 0x10000
    s_branch L2_xp52
L2_c53:
    s_mov_b64 s[50:51], vcc
    s_lshl_b64 s[52:53], s[82:83], 1
    s_andn2_b64 s[52:53], s[52:53], s[80:81]
    s_andn2_b64 s[52:53], s[52:53], s[50:51]
    s_or_b64 s[80:81], s[80:81], s[52:53]
    s_not_b64 vcc, s[52:53]
    s_mov_b64 exec, -1
    v_cndmask_b32_dpp v84, v84, v84, vcc wave_shr:1 row_mask:0xf bank_mask:0xf
    v_cndmask_b32_dpp v85, v85, v85, vcc wave_shr:1 row_mask:0xf bank_mask:0xf
    s_lshr_b64 s[52:53], s[52:53], 1
    v_cndmask_b32_dpp v86, v86, v86, vcc wave_shr:1 row_mask:0xf bank_mask:0xf
    v_cndmask_b32_dpp v87, v87, v87, vcc wave_shr:1 row_mask:0xf bank_mask:0xf
    s_andn2_b64 s[82:83], s[82:83], s[52:53]
    v_cndmask_b32_dpp v7, v7, v7, vcc wave_shr:1 row_mask:0xf bank_mask:0xf
    s_mov_b64 vcc, s[50:51]
    s_mov_b64 exec, s[50:51]
    s_cbranch_scc0 L2_d53
    s_mov_b64 exec, s[82:83]
    s_nop 1
    v_mfma_f32_4x4x4_16b_bf16 v[88:91], v[12:13], v[84:85], 0
    s_nop 1
    v_mfma_f32_4x4x4_16b_bf16 v[88:91], v[10:11], v[86:87], v[88:91]
    s_nop 4
    v_cvt_pk_bf16_f32 v88, v88, v89
    v_cvt_pk_bf16_f32 v89, v90, v91
    ds_pk_add_bf16 v7, v88 offset:65408
    ds_pk_add_bf16 v7, v89 offset:65412
    s_mov_b64 exec, vcc
    s_branch L2_d53
L2_c54:
    s_mov_b64 s[50:51], vcc
    s_lshl_b64 s[52:53], s[82:83], 1
    s_andn2_b64 s[52:53], s[52:53], s[80:81]
    s_andn2_b64 s[52:53], s[52:53], s[50:51]
    s_or_b64 s[80:81], s[80:81], s[52:53]
    s_not_b64 vcc, s[52:53]
    s_mov_b64 exec, -1
    v_cndmask_b32_dpp v84, v84, v84, vcc wave_shr:1 row_mask:0xf bank_mask:0xf
    v_cndmask_b32_dpp v85, v85, v85, vcc wave_shr:1 row_mask:0xf bank_mask:0xf
    s_lshr_b64 s[52:53], s[52:53], 1
    v_cndmask_b32_dpp v86, v86, v86, vcc wave_shr:1 row_mask:0xf bank_mask:0xf
    v_cndmask_b32_dpp v87, v87, v87, vcc wave_shr:1 row_mask:0xf bank_mask:0xf
    s_andn2_b64 s[82:83], s[82:83], s[52:53]
    v_cndmask_b32_dpp v7, v7, v7, vcc wave_shr:1 row_mask:0xf bank_mask:0xf
    s_mov_b64 vcc, s[50:51]
    s_mov_b64 exec, s[50:51]
    s_cbranch_scc0 L2_d54
    s_mov_b64 exec, s[82:83]
    s_nop 1
    v_mfma_f32_4x4x4_16b_bf16 v[88:91], v[12:13], v[84:85], 0
    s_nop 1
    v_mfma_f32_4x4x4_16b_bf16 v[88:91], v[10:11], v[86:87], v[88:91]
    s_nop 4
    v_cvt_pk_bf16_f32 v88, v88, v89
    v_cvt_pk_bf16_f32 v89, v90, v91
    ds_pk_add_bf16 v7, v88 offset:65408
    ds_pk_add_bf16 v7, v89 offset:65412
    s_mov_b64 exec, vcc
    s_branch L2_d54
L2_c55:
    s_mov_b64 s[50:51], vcc
    s_lshl_b64 s[52:53], s[82:83], 1
    s_andn2_b64 s[52:53], s[52:53], s[80:81]
    s_andn2_b64 s[52:53], s[52:53], s[50:51]
    s_or_b64 s[80:81], s[80:81], s[52:53]
    s_not_b64 vcc, s[52:53]
    s_mov_b64 exec, -1
    v_cndmask_b32_dpp v84, v84, v84, vcc wave_shr:1 row_mask:0xf bank_mask:0xf
    v_cndmask_b32_dpp v85, v85, v85, vcc wave_shr:1 row_mask:0xf bank_mask:0xf
    s_lshr_b64 s[52:53], s[52:53], 1
    v_cndmask_b32_dpp v86, v86, v86, vcc wave_shr:1 row_mask:0xf bank_mask:0xf
    v_cndmask_b32_dpp v87, v87, v87, vcc wave_shr:1 row_mask:0xf bank_mask:0xf
    s_andn2_b64 s[82:83], s[82:83], s[52:53]
    v_cndmask_b32_dpp v7, v7, v7, vcc wave_shr:1 row_mask:0xf bank_mask:0xf
    s_mov_b64 vcc, s[50:51]
    s_mov_b64 exec, s[50:51]
    s_cbranch_scc0 L2_d55
    s_mov_b64 exec, s[82:83]
    s_nop 1
    v_mfma_f32_4x4x4_16b_bf16 v[88:91], v[12:13], v[84:85], 0
    s_nop 1
    v_mfma_f32_4x4x4_16b_bf16 v[88:91], v[10:11], v[86:87], v[88:91]
    s_nop 4
    v_cvt_pk_bf16_f32 v88, v88, v89
    v_cvt_pk_bf16_f32 v89, v90, v91
    ds_pk_add_bf16 v7, v88 offset:65408
    ds_pk_add_bf16 v7, v89 offset:65412
    s_mov_b64 exec, vcc
    s_branch L2_d55
L2_c56:
    s_mov_b64 s[50:51], vcc
    s_lshl_b64 s[52:53], s[82:83], 1
    s_andn2_b64 s[52:53], s[52:53], s[80:81]
    s_andn2_b64 s[52:53], s[52:53], s[50:51]
    s_or_b64 s[80:81], s[80:81], s[52:53]
    s_not_b64 vcc, s[52:53]
    s_mov_b64 exec, -1
    v_cndmask_b32_dpp v84, v84, v84, vcc wave_shr:1 row_mask:0xf bank_mask:0xf
    v_cndmask_b32_dpp v85, v85, v85, vcc wave_shr:1 row_mask:0xf bank_mask:0xf
    s_lshr_b64 s[52:53], s[52:53], 1
    v_cndmask_b32_dpp v86, v86, v86, vcc wave_shr:1 row_mask:0xf bank_mask:0xf
    v_cndmask_b32_dpp v87, v87, v87, vcc wave_shr:1 row_mask:0xf bank_mask:0xf
    s_andn2_b64 s[82:83], s[82:83], s[52:53]
    v_cndmask_b32_dpp v7, v7, v7, vcc wave_shr:1 row_mask:0xf bank_mask:0xf
    s_mov_b64 vcc, s[50:51]
    s_mov_b64 exec, s[50:51]
    s_cbranch_scc0 L2_d56
    s_mov_b64 exec, s[82:83]
    s_nop 1
    v_mfma_f32_4x4x4_16b_bf16 v[88:91], v[12:13], v[84:85], 0
    s_nop 1
    v_mfma_f32_4x4x4_16b_bf16 v[88:91], v[10:11], v[86:87], v[88:91]
    s_nop 4
    v_cvt_pk_bf16_f32 v88, v88, v89
    v_cvt_pk_bf16_f32 v89, v90, v91
    ds_pk_add_bf16 v7, v88 offset:65408
    ds_pk_add_bf16 v7, v89 offset:65412
    s_mov_b64 exec, vcc
    s_branch L2_d56
L2_c57:
    s_mov_b64 s[50:51], vcc
    s_lshl_b64 s[52:53], s[82:83], 1
    s_andn2_b64 s[52:53], s[52:53], s[80:81]
    s_andn2_b64 s[52:53], s[52:53], s[50:51]
    s_or_b64 s[80:81], s[80:81], s[52:53]
    s_not_b64 vcc, s[52:53]
    s_mov_b64 exec, -1
    v_cndmask_b32_dpp v84, v84, v84, vcc wave_shr:1 row_mask:0xf bank_mask:0xf
    v_cndmask_b32_dpp v85, v85, v85, vcc wave_shr:1 row_mask:0xf bank_mask:0xf
    s_lshr_b64 s[52:53], s[52:53], 1
    v_cndmask_b32_dpp v86, v86, v86, vcc wave_shr:1 row_mask:0xf bank_mask:0xf
    v_cndmask_b32_dpp v87, v87, v87, vcc wave_shr:1 row_mask:0xf bank_mask:0xf
    s_andn2_b64 s[82:83], s[82:83], s[52:53]
    v_cndmask_b32_dpp v7, v7, v7, vcc wave_shr:1 row_mask:0xf bank_mask:0xf
    s_mov_b64 vcc, s[50:51]
    s_mov_b64 exec, s[50:51]
    s_cbranch_scc0 L2_d57
    s_mov_b64 exec, s[82:83]
    s_nop 1
    v_mfma_f32_4x4x4_16b_bf16 v[88:91], v[12:13], v[84:85], 0
    s_nop 1
    v_mfma_f32_4x4x4_16b_bf16 v[88:91], v[10:11], v[86:87], v[88:91]
    s_nop 4
    v_cvt_pk_bf16_f32 v88, v88, v89
    v_cvt_pk_bf16_f32 v89, v90, v91
    ds_pk_add_bf16 v7, v88 offset:65408
    ds_pk_add_bf16 v7, v89 offset:65412
    s_mov_b64 exec, vcc
    s_branch L2_d57
L2_c58:
    s_mov_b64 s[50:51], vcc
    s_lshl_b64 s[52:53], s[82:83], 1
    s_andn2_b64 s[52:53], s[52:53], s[80:81]
    s_andn2_b64 s[52:53], s[52:53], s[50:51]
    s_or_b64 s[80:81], s[80:81], s[52:53]
    s_not_b64 vcc, s[52:53]
    s_mov_b64 exec, -1
    v_cndmask_b32_dpp v84, v84, v84, vcc wave_shr:1 row_mask:0xf bank_mask:0xf
    v_cndmask_b32_dpp v85, v85, v85, vcc wave_shr:1 row_mask:0xf bank_mask:0xf
    s_lshr_b64 s[52:53], s[52:53], 1
    v_cndmask_b32_dpp v86, v86, v86, vcc wave_shr:1 row_mask:0xf bank_mask:0xf
    v_cndmask_b32_dpp v87, v87, v87, vcc wave_shr:1 row_mask:0xf bank_mask:0xf
    s_andn2_b64 s[82:83], s[82:83], s[52:53]
    v_cndmask_b32_dpp v7, v7, v7, vcc wave_shr:1 row_mask:0xf bank_mask:0xf
    s_mov_b64 vcc, s[50:51]
    s_mov_b64 exec, s[50:51]
    s_cbranch_scc0 L2_d58
    s_mov_b64 exec, s[82:83]
    s_nop 1
    v_mfma_f32_4x4x4_16b_bf16 v[88:91], v[12:13], v[84:85], 0
    s_nop 1
    v_mfma_f32_4x4x4_16b_bf16 v[88:91], v[10:11], v[86:87], v[88:91]
    s_nop 4
    v_cvt_pk_bf16_f32 v88, v88, v89
    v_cvt_pk_bf16_f32 v89, v90, v91
    ds_pk_add_bf16 v7, v88 offset:65408
    ds_pk_add_bf16 v7, v89 offset:65412
    s_mov_b64 exec, vcc
    s_branch L2_d58
L2_c59:
    s_mov_b64 s[50:51], vcc
    s_lshl_b64 s[52:53], s[82:83], 1
    s_andn2_b64 s[52:53], s[52:53], s[80:81]
    s_andn2_b64 s[52:53], s[52:53], s[50:51]
    s_or_b64 s[80:81], s[80:81], s[52:53]
    s_not_b64 vcc, s[52:53]
    s_mov_b64 exec, -1
    v_cndmask_b32_dpp v84, v84, v84, vcc wave_shr:1 row_mask:0xf bank_mask:0xf
    v_cndmask_b32_dpp v85, v85, v85, vcc wave_shr:1 row_mask:0xf bank_mask:0xf
    s_lshr_b64 s[52:53], s[52:53], 1
    v_cndmask_b32_dpp v86, v86, v86, vcc wave_shr:1 row_mask:0xf bank_mask:0xf
    v_cndmask_b32_dpp v87, v87, v87, vcc wave_shr:1 row_mask:0xf bank_mask:0xf
    s_andn2_b64 s[82:83], s[82:83], s[52:53]
    v_cndmask_b32_dpp v7, v7, v7, vcc wave_shr:1 row_mask:0xf bank_mask:0xf
    s_mov_b64 vcc, s[50:51]
    s_mov_b64 exec, s[50:51]
    s_cbranch_scc0 L2_d59
    s_mov_b64 exec, s[82:83]
    s_nop 1
    v_mfma_f32_4x4x4_16b_bf16 v[88:91], v[12:13], v[84:85], 0
    s_nop 1
    v_mfma_f32_4x4x4_16b_bf16 v[88:91], v[10:11], v[86:87], v[88:91]
    s_nop 4
    v_cvt_pk_bf16_f32 v88, v88, v89
    v_cvt_pk_bf16_f32 v89, v90, v91
    ds_pk_add_bf16 v7, v88 offset:65408
    ds_pk_add_bf16 v7, v89 offset:65412
    s_mov_b64 exec, vcc
    s_branch L2_d59
L2_c60:
    s_mov_b64 s[50:51], vcc
    s_lshl_b64 s[52:53], s[82:83], 1
    s_andn2_b64 s[52:53], s[52:53], s[80:81]
    s_andn2_b64 s[52:53], s[52:53], s[50:51]
    s_or_b64 s[80:81], s[80:81], s[52:53]
    s_not_b64 vcc, s[52:53]
    s_mov_b64 exec, -1
    v_cndmask_b32_dpp v84, v84, v84, vcc wave_shr:1 row_mask:0xf bank_mask:0xf
    v_cndmask_b32_dpp v85, v85, v85, vcc wave_shr:1 row_mask:0xf bank_mask:0xf
    s_lshr_b64 s[52:53], s[52:53], 1
    v_cndmask_b32_dpp v86, v86, v86, vcc wave_shr:1 row_mask:0xf bank_mask:0xf
    v_cndmask_b32_dpp v87, v87, v87, vcc wave_shr:1 row_mask:0xf bank_mask:0xf
    s_andn2_b64 s[82:83], s[82:83], s[52:53]
    v_cndmask_b32_dpp v7, v7, v7, vcc wave_shr:1 row_mask:0xf bank_mask:0xf
    s_mov_b64 vcc, s[50:51]
    s_mov_b64 exec, s[50:51]
    s_cbranch_scc0 L2_d60
    s_mov_b64 exec, s[82:83]
    s_nop 1
    v_mfma_f32_4x4x4_16b_bf16 v[88:91], v[12:13], v[84:85], 0
    s_nop 1
    v_mfma_f32_4x4x4_16b_bf16 v[88:91], v[10:11], v[86:87], v[88:91]
    s_nop 4
    v_cvt_pk_bf16_f32 v88, v88, v89
    v_cvt_pk_bf16_f32 v89, v90, v91
    ds_pk_add_bf16 v7, v88 offset:65408
    ds_pk_add_bf16 v7, v89 offset:65412
    s_mov_b64 exec, vcc
    s_branch L2_d60
L2_xa61:
    s_cmp_eq_u32 s101, 1
    s_cbranch_scc1 L2_xc61
    v_lshlrev_b32 v89, 0, v96
    v_add_u32 v90, 140, v97
    v_bitop3_b32 v90, v89, v45, v90 bitop3:0x6a
    ds_write_b32 v98, v90 offset:28
    v_lshlrev_b32 v89, 4, v96
    v_add_u32 v90, 120, v97
    v_bitop3_b32 v90, v89, v45, v90 bitop3:0x6a
    ds_write_b32 v98, v90 offset:24
    v_lshlrev_b32 v89, 8, v96
    v_add_u32 v90, 100, v97
    v_bitop3_b32 v90, v89, v45, v90 bitop3:0x6a
    ds_write_b32 v98, v90 offset:20
L2_xc61:
    v_lshlrev_b32 v89, 12, v96
    v_add_u32 v90, 80, v97
    v_bitop3_b32 v90, v89, v45, v90 bitop3:0x6a
    ds_write_b32 v98, v90 offset:16
    s_branch L2_xb61
L2_xe61:
    v_cmp_lt_u32 vcc, 32, v99
    v_cmp_lt_u32 s[58:59], 31, v88
    v_lshrrev_b32 v89, 16, v96
    v_add_u32 v97, 80, v97
    s_or_b64 vcc, vcc, s[58:59]
    s_cbranch_scc1 L2_xs61
    v_lshlrev_b32 v89, v1, v89
    v_and_b32 v89, v45, v89
    v_cmp_ne_u32 vcc, 0, v89
    v_xor_b32 v90, v97, v89
    s_add_u32 s3, s37, s38
    v_mbcnt_lo_u32_b32 v98, vcc_lo, 0
    v_mbcnt_hi_u32_b32 v98, vcc_hi, v98
    s_bcnt1_i32_b64 s41, vcc
    v_lshl_add_u32 v98, v98, 2, s3
    s_mov_b64 exec, vcc
    ds_write_b32 v98, v90
    s_mov_b64 exec, -1
    s_lshl2_add_u32 s37, s41, s37
    s_branch L2_xr61
L2_xf61:
    s_waitcnt lgkmcnt(0)
    s_cmp_gt_u32 s37, 1024
    s_cbranch_scc1 L2_xs61
    v_mov_b32 v43, -1
    s_cmp_ge_u32 s37, 512
    s_cbranch_scc1 L2_xg61
    v_mov_b32 v42, -1
    s_cmp_ge_u32 s37, 256
    s_cbranch_scc1 L2_xg61
    v_mov_b32 v41, -1
    s_branch L2_xg61
L2_xs61:
    s_waitcnt lgkmcnt(0)
    v_mov_b32 v40, -1
    v_mov_b32 v41, -1
    v_mov_b32 v42, -1
    v_mov_b32 v43, -1
    s_add_u32 s3, s42, 2
    s_bitset1_b32 s36, s3
    s_branch L2_xg61
L2_c62:
    s_mov_b64 s[50:51], vcc
    s_lshl_b64 s[52:53], s[82:83], 1
    s_andn2_b64 s[52:53], s[52:53], s[80:81]
    s_andn2_b64 s[52:53], s[52:53], s[50:51]
    s_or_b64 s[80:81], s[80:81], s[52:53]
    s_not_b64 vcc, s[52:53]
    s_mov_b64 exec, -1
    v_cndmask_b32_dpp v84, v84, v84, vcc wave_shr:1 row_mask:0xf bank_mask:0xf
    v_cndmask_b32_dpp v85, v85, v85, vcc wave_shr:1 row_mask:0xf bank_mask:0xf
    s_lshr_b64 s[52:53], s[52:53], 1
    v_cndmask_b32_dpp v86, v86, v86, vcc wave_shr:1 row_mask:0xf bank_mask:0xf
    v_cndmask_b32_dpp v87, v87, v87, vcc wave_shr:1 row_mask:0xf bank_mask:0xf
    s_andn2_b64 s[82:83], s[82:83], s[52:53]
    v_cndmask_b32_dpp v7, v7, v7, vcc wave_shr:1 row_mask:0xf bank_mask:0xf
    s_mov_b64 vcc, s[50:51]
    s_mov_b64 exec, s[50:51]
    s_cbranch_scc0 L2_d62
    s_mov_b64 exec, s[82:83]
    s_nop 1
    v_mfma_f32_4x4x4_16b_bf16 v[88:91], v[12:13], v[84:85], 0
    s_nop 1
    v_mfma_f32_4x4x4_16b_bf16 v[88:91], v[10:11], v[86:87], v[88:91]
    s_nop 4
    v_cvt_pk_bf16_f32 v88, v88, v89
    v_cvt_pk_bf16_f32 v89, v90, v91
    ds_pk_add_bf16 v7, v88 offset:65408
    ds_pk_add_bf16 v7, v89 offset:65412
    s_mov_b64 exec, vcc
    s_branch L2_d62
L2_c63:
    s_mov_b64 s[50:51], vcc
    s_lshl_b64 s[52:53], s[82:83], 1
    s_andn2_b64 s[52:53], s[52:53], s[80:81]
    s_andn2_b64 s[52:53], s[52:53], s[50:51]
    s_or_b64 s[80:81], s[80:81], s[52:53]
    s_not_b64 vcc, s[52:53]
    s_mov_b64 exec, -1
    v_cndmask_b32_dpp v84, v84, v84, vcc wave_shr:1 row_mask:0xf bank_mask:0xf
    v_cndmask_b32_dpp v85, v85, v85, vcc wave_shr:1 row_mask:0xf bank_mask:0xf
    s_lshr_b64 s[52:53], s[52:53], 1
    v_cndmask_b32_dpp v86, v86, v86, vcc wave_shr:1 row_mask:0xf bank_mask:0xf
    v_cndmask_b32_dpp v87, v87, v87, vcc wave_shr:1 row_mask:0xf bank_mask:0xf
    s_andn2_b64 s[82:83], s[82:83], s[52:53]
    v_cndmask_b32_dpp v7, v7, v7, vcc wave_shr:1 row_mask:0xf bank_mask:0xf
    s_mov_b64 vcc, s[50:51]
    s_mov_b64 exec, s[50:51]
    s_cbranch_scc0 L2_d63
    s_mov_b64 exec, s[82:83]
    s_nop 1
    v_mfma_f32_4x4x4_16b_bf16 v[88:91], v[12:13], v[84:85], 0
    s_nop 1
    v_mfma_f32_4x4x4_16b_bf16 v[88:91], v[10:11], v[86:87], v[88:91]
    s_nop 4
    v_cvt_pk_bf16_f32 v88, v88, v89
    v_cvt_pk_bf16_f32 v89, v90, v91
    ds_pk_add_bf16 v7, v88 offset:65408
    ds_pk_add_bf16 v7, v89 offset:65412
    s_mov_b64 exec, vcc
    s_branch L2_d63
L2_c64:
    s_mov_b64 s[50:51], vcc
    s_lshl_b64 s[52:53], s[82:83], 1
    s_andn2_b64 s[52:53], s[52:53], s[80:81]
    s_andn2_b64 s[52:53], s[52:53], s[50:51]
    s_or_b64 s[80:81], s[80:81], s[52:53]
    s_not_b64 vcc, s[52:53]
    s_mov_b64 exec, -1
    v_cndmask_b32_dpp v84, v84, v84, vcc wave_shr:1 row_mask:0xf bank_mask:0xf
    v_cndmask_b32_dpp v85, v85, v85, vcc wave_shr:1 row_mask:0xf bank_mask:0xf
    s_lshr_b64 s[52:53], s[52:53], 1
    v_cndmask_b32_dpp v86, v86, v86, vcc wave_shr:1 row_mask:0xf bank_mask:0xf
    v_cndmask_b32_dpp v87, v87, v87, vcc wave_shr:1 row_mask:0xf bank_mask:0xf
    s_andn2_b64 s[82:83], s[82:83], s[52:53]
    v_cndmask_b32_dpp v7, v7, v7, vcc wave_shr:1 row_mask:0xf bank_mask:0xf
    s_mov_b64 vcc, s[50:51]
    s_mov_b64 exec, s[50:51]
    s_cbranch_scc0 L2_d64
    s_mov_b64 exec, s[82:83]
    s_nop 1
    v_mfma_f32_4x4x4_16b_bf16 v[88:91], v[12:13], v[84:85], 0
    s_nop 1
    v_mfma_f32_4x4x4_16b_bf16 v[88:91], v[10:11], v[86:87], v[88:91]
    s_nop 4
    v_cvt_pk_bf16_f32 v88, v88, v89
    v_cvt_pk_bf16_f32 v89, v90, v91
    ds_pk_add_bf16 v7, v88 offset:65408
    ds_pk_add_bf16 v7, v89 offset:65412
    s_mov_b64 exec, vcc
    s_branch L2_d64
L2_c65:
    s_mov_b64 s[50:51], vcc
    s_lshl_b64 s[52:53], s[82:83], 1
    s_andn2_b64 s[52:53], s[52:53], s[80:81]
    s_andn2_b64 s[52:53], s[52:53], s[50:51]
    s_or_b64 s[80:81], s[80:81], s[52:53]
    s_not_b64 vcc, s[52:53]
    s_mov_b64 exec, -1
    v_cndmask_b32_dpp v84, v84, v84, vcc wave_shr:1 row_mask:0xf bank_mask:0xf
    v_cndmask_b32_dpp v85, v85, v85, vcc wave_shr:1 row_mask:0xf bank_mask:0xf
    s_lshr_b64 s[52:53], s[52:53], 1
    v_cndmask_b32_dpp v86, v86, v86, vcc wave_shr:1 row_mask:0xf bank_mask:0xf
    v_cndmask_b32_dpp v87, v87, v87, vcc wave_shr:1 row_mask:0xf bank_mask:0xf
    s_andn2_b64 s[82:83], s[82:83], s[52:53]
    v_cndmask_b32_dpp v7, v7, v7, vcc wave_shr:1 row_mask:0xf bank_mask:0xf
    s_mov_b64 vcc, s[50:51]
    s_mov_b64 exec, s[50:51]
    s_cbranch_scc0 L2_d65
    s_mov_b64 exec, s[82:83]
    s_nop 1
    v_mfma_f32_4x4x4_16b_bf16 v[88:91], v[12:13], v[84:85], 0
    s_nop 1
    v_mfma_f32_4x4x4_16b_bf16 v[88:91], v[10:11], v[86:87], v[88:91]
    s_nop 4
    v_cvt_pk_bf16_f32 v88, v88, v89
    v_cvt_pk_bf16_f32 v89, v90, v91
    ds_pk_add_bf16 v7, v88 offset:65408
    ds_pk_add_bf16 v7, v89 offset:65412
    s_mov_b64 exec, vcc
    s_branch L2_d65
L2_c66:
    s_mov_b64 s[50:51], vcc
    s_lshl_b64 s[52:53], s[82:83], 1
    s_andn2_b64 s[52:53], s[52:53], s[80:81]
    s_andn2_b64 s[52:53], s[52:53], s[50:51]
    s_or_b64 s[80:81], s[80:81], s[52:53]
    s_not_b64 vcc, s[52:53]
    s_mov_b64 exec, -1
    v_cndmask_b32_dpp v84, v84, v84, vcc wave_shr:1 row_mask:0xf bank_mask:0xf
    v_cndmask_b32_dpp v85, v85, v85, vcc wave_shr:1 row_mask:0xf bank_mask:0xf
    s_lshr_b64 s[52:53], s[52:53], 1
    v_cndmask_b32_dpp v86, v86, v86, vcc wave_shr:1 row_mask:0xf bank_mask:0xf
    v_cndmask_b32_dpp v87, v87, v87, vcc wave_shr:1 row_mask:0xf bank_mask:0xf
    s_andn2_b64 s[82:83], s[82:83], s[52:53]
    v_cndmask_b32_dpp v7, v7, v7, vcc wave_shr:1 row_mask:0xf bank_mask:0xf
    s_mov_b64 vcc, s[50:51]
    s_mov_b64 exec, s[50:51]
    s_cbranch_scc0 L2_d66
    s_mov_b64 exec, s[82:83]
    s_nop 1
    v_mfma_f32_4x4x4_16b_bf16 v[88:91], v[12:13], v[84:85], 0
    s_nop 1
    v_mfma_f32_4x4x4_16b_bf16 v[88:91], v[10:11], v[86:87], v[88:91]
    s_nop 4
    v_cvt_pk_bf16_f32 v88, v88, v89
    v_cvt_pk_bf16_f32 v89, v90, v91
    ds_pk_add_bf16 v7, v88 offset:65408
    ds_pk_add_bf16 v7, v89 offset:65412
    s_mov_b64 exec, vcc
    s_branch L2_d66
L2_c67:
    s_mov_b64 s[50:51], vcc
    s_lshl_b64 s[52:53], s[82:83], 1
    s_andn2_b64 s[52:53], s[52:53], s[80:81]
    s_andn2_b64 s[52:53], s[52:53], s[50:51]
    s_or_b64 s[80:81], s[80:81], s[52:53]
    s_not_b64 vcc, s[52:53]
    s_mov_b64 exec, -1
    v_cndmask_b32_dpp v84, v84, v84, vcc wave_shr:1 row_mask:0xf bank_mask:0xf
    v_cndmask_b32_dpp v85, v85, v85, vcc wave_shr:1 row_mask:0xf bank_mask:0xf
    s_lshr_b64 s[52:53], s[52:53], 1
    v_cndmask_b32_dpp v86, v86, v86, vcc wave_shr:1 row_mask:0xf bank_mask:0xf
    v_cndmask_b32_dpp v87, v87, v87, vcc wave_shr:1 row_mask:0xf bank_mask:0xf
    s_andn2_b64 s[82:83], s[82:83], s[52:53]
    v_cndmask_b32_dpp v7, v7, v7, vcc wave_shr:1 row_mask:0xf bank_mask:0xf
    s_mov_b64 vcc, s[50:51]
    s_mov_b64 exec, s[50:51]
    s_cbranch_scc0 L2_d67
    s_mov_b64 exec, s[82:83]
    s_nop 1
    v_mfma_f32_4x4x4_16b_bf16 v[88:91], v[12:13], v[84:85], 0
    s_nop 1
    v_mfma_f32_4x4x4_16b_bf16 v[88:91], v[10:11], v[86:87], v[88:91]
    s_nop 4
    v_cvt_pk_bf16_f32 v88, v88, v89
    v_cvt_pk_bf16_f32 v89, v90, v91
    ds_pk_add_bf16 v7, v88 offset:65408
    ds_pk_add_bf16 v7, v89 offset:65412
    s_mov_b64 exec, vcc
    s_branch L2_d67
L2_c68:
    s_mov_b64 s[50:51], vcc
    s_lshl_b64 s[52:53], s[82:83], 1
    s_andn2_b64 s[52:53], s[52:53], s[80:81]
    s_andn2_b64 s[52:53], s[52:53], s[50:51]
    s_or_b64 s[80:81], s[80:81], s[52:53]
    s_not_b64 vcc, s[52:53]
    s_mov_b64 exec, -1
    v_cndmask_b32_dpp v84, v84, v84, vcc wave_shr:1 row_mask:0xf bank_mask:0xf
    v_cndmask_b32_dpp v85, v85, v85, vcc wave_shr:1 row_mask:0xf bank_mask:0xf
    s_lshr_b64 s[52:53], s[52:53], 1
    v_cndmask_b32_dpp v86, v86, v86, vcc wave_shr:1 row_mask:0xf bank_mask:0xf
    v_cndmask_b32_dpp v87, v87, v87, vcc wave_shr:1 row_mask:0xf bank_mask:0xf
    s_andn2_b64 s[82:83], s[82:83], s[52:53]
    v_cndmask_b32_dpp v7, v7, v7, vcc wave_shr:1 row_mask:0xf bank_mask:0xf
    s_mov_b64 vcc, s[50:51]
    s_mov_b64 exec, s[50:51]
    s_cbranch_scc0 L2_d68
    s_mov_b64 exec, s[82:83]
    s_nop 1
    v_mfma_f32_4x4x4_16b_bf16 v[88:91], v[12:13], v[84:85], 0
    s_nop 1
    v_mfma_f32_4x4x4_16b_bf16 v[88:91], v[10:11], v[86:87], v[88:91]
    s_nop 4
    v_cvt_pk_bf16_f32 v88, v88, v89
    v_cvt_pk_bf16_f32 v89, v90, v91
    ds_pk_add_bf16 v7, v88 offset:65408
    ds_pk_add_bf16 v7, v89 offset:65412
    s_mov_b64 exec, vcc
    s_branch L2_d68
L2_c69:
    s_mov_b64 s[50:51], vcc
    s_lshl_b64 s[52:53], s[82:83], 1
    s_andn2_b64 s[52:53], s[52:53], s[80:81]
    s_andn2_b64 s[52:53], s[52:53], s[50:51]
    s_or_b64 s[80:81], s[80:81], s[52:53]
    s_not_b64 vcc, s[52:53]
    s_mov_b64 exec, -1
    v_cndmask_b32_dpp v84, v84, v84, vcc wave_shr:1 row_mask:0xf bank_mask:0xf
    v_cndmask_b32_dpp v85, v85, v85, vcc wave_shr:1 row_mask:0xf bank_mask:0xf
    s_lshr_b64 s[52:53], s[52:53], 1
    v_cndmask_b32_dpp v86, v86, v86, vcc wave_shr:1 row_mask:0xf bank_mask:0xf
    v_cndmask_b32_dpp v87, v87, v87, vcc wave_shr:1 row_mask:0xf bank_mask:0xf
    s_andn2_b64 s[82:83], s[82:83], s[52:53]
    v_cndmask_b32_dpp v7, v7, v7, vcc wave_shr:1 row_mask:0xf bank_mask:0xf
    s_mov_b64 vcc, s[50:51]
    s_mov_b64 exec, s[50:51]
    s_cbranch_scc0 L2_d69
    s_mov_b64 exec, s[82:83]
    s_nop 1
    v_mfma_f32_4x4x4_16b_bf16 v[88:91], v[12:13], v[84:85], 0
    s_nop 1
    v_mfma_f32_4x4x4_16b_bf16 v[88:91], v[10:11], v[86:87], v[88:91]
    s_nop 4
    v_cvt_pk_bf16_f32 v88, v88, v89
    v_cvt_pk_bf16_f32 v89, v90, v91
    ds_pk_add_bf16 v7, v88 offset:65408
    ds_pk_add_bf16 v7, v89 offset:65412
    s_mov_b64 exec, vcc
    s_branch L2_d69
L2_xo70:
    v_cmp_lt_u32 vcc, 20, v99
    s_mov_b32 s101, 1
    s_cbranch_vccz L2_xp70
    v_cmp_lt_u32 vcc, 32, v99
    v_cmp_lt_u32 s[58:59], 31, v88
    s_mov_b32 s101, 2
    s_or_b64 vcc, vcc, s[58:59]
    s_cbranch_scc0 L2_xp70
    s_mov_b32 s37, 0x10000
    s_branch L2_xp70
L2_c71:
    s_mov_b64 s[50:51], vcc
    s_lshl_b64 s[52:53], s[82:83], 1
    s_andn2_b64 s[52:53], s[52:53], s[80:81]
    s_andn2_b64 s[52:53], s[52:53], s[50:51]
    s_or_b64 s[80:81], s[80:81], s[52:53]
    s_not_b64 vcc, s[52:53]
    s_mov_b64 exec, -1
    v_cndmask_b32_dpp v84, v84, v84, vcc wave_shr:1 row_mask:0xf bank_mask:0xf
    v_cndmask_b32_dpp v85, v85, v85, vcc wave_shr:1 row_mask:0xf bank_mask:0xf
    s_lshr_b64 s[52:53], s[52:53], 1
    v_cndmask_b32_dpp v86, v86, v86, vcc wave_shr:1 row_mask:0xf bank_mask:0xf
    v_cndmask_b32_dpp v87, v87, v87, vcc wave_shr:1 row_mask:0xf bank_mask:0xf
    s_andn2_b64 s[82:83], s[82:83], s[52:53]
    v_cndmask_b32_dpp v7, v7, v7, vcc wave_shr:1 row_mask:0xf bank_mask:0xf
    s_mov_b64 vcc, s[50:51]
    s_mov_b64 exec, s[50:51]
    s_cbranch_scc0 L2_d71
    s_mov_b64 exec, s[82:83]
    s_nop 1
    v_mfma_f32_4x4x4_16b_bf16 v[88:91], v[12:13], v[84:85], 0
    s_nop 1
    v_mfma_f32_4x4x4_16b_bf16 v[88:91], v[10:11], v[86:87], v[88:91]
    s_nop 4
    v_cvt_pk_bf16_f32 v88, v88, v89
    v_cvt_pk_bf16_f32 v89, v90, v91
    ds_pk_add_bf16 v7, v88 offset:65408
    ds_pk_add_bf16 v7, v89 offset:65412
    s_mov_b64 exec, vcc
    s_branch L2_d71
L2_c72:
    s_mov_b64 s[50:51], vcc
    s_lshl_b64 s[52:53], s[82:83], 1
    s_andn2_b64 s[52:53], s[52:53], s[80:81]
    s_andn2_b64 s[52:53], s[52:53], s[50:51]
    s_or_b64 s[80:81], s[80:81], s[52:53]
    s_not_b64 vcc, s[52:53]
    s_mov_b64 exec, -1
    v_cndmask_b32_dpp v84, v84, v84, vcc wave_shr:1 row_mask:0xf bank_mask:0xf
    v_cndmask_b32_dpp v85, v85, v85, vcc wave_shr:1 row_mask:0xf bank_mask:0xf
    s_lshr_b64 s[52:53], s[52:53], 1
    v_cndmask_b32_dpp v86, v86, v86, vcc wave_shr:1 row_mask:0xf bank_mask:0xf
    v_cndmask_b32_dpp v87, v87, v87, vcc wave_shr:1 row_mask:0xf bank_mask:0xf
    s_andn2_b64 s[82:83], s[82:83], s[52:53]
    v_cndmask_b32_dpp v7, v7, v7, vcc wave_shr:1 row_mask:0xf bank_mask:0xf
    s_mov_b64 vcc, s[50:51]
    s_mov_b64 exec, s[50:51]
    s_cbranch_scc0 L2_d72
    s_mov_b64 exec, s[82:83]
    s_nop 1
    v_mfma_f32_4x4x4_16b_bf16 v[88:91], v[12:13], v[84:85], 0
    s_nop 1
    v_mfma_f32_4x4x4_16b_bf16 v[88:91], v[10:11], v[86:87], v[88:91]
    s_nop 4
    v_cvt_pk_bf16_f32 v88, v88, v89
    v_cvt_pk_bf16_f32 v89, v90, v91
    ds_pk_add_bf16 v7, v88 offset:65408
    ds_pk_add_bf16 v7, v89 offset:65412
    s_mov_b64 exec, vcc
    s_branch L2_d72
L2_c73:
    s_mov_b64 s[50:51], vcc
    s_lshl_b64 s[52:53], s[82:83], 1
    s_andn2_b64 s[52:53], s[52:53], s[80:81]
    s_andn2_b64 s[52:53], s[52:53], s[50:51]
    s_or_b64 s[80:81], s[80:81], s[52:53]
    s_not_b64 vcc, s[52:53]
    s_mov_b64 exec, -1
    v_cndmask_b32_dpp v84, v84, v84, vcc wave_shr:1 row_mask:0xf bank_mask:0xf
    v_cndmask_b32_dpp v85, v85, v85, vcc wave_shr:1 row_mask:0xf bank_mask:0xf
    s_lshr_b64 s[52:53], s[52:53], 1
    v_cndmask_b32_dpp v86, v86, v86, vcc wave_shr:1 row_mask:0xf bank_mask:0xf
    v_cndmask_b32_dpp v87, v87, v87, vcc wave_shr:1 row_mask:0xf bank_mask:0xf
    s_andn2_b64 s[82:83], s[82:83], s[52:53]
    v_cndmask_b32_dpp v7, v7, v7, vcc wave_shr:1 row_mask:0xf bank_mask:0xf
    s_mov_b64 vcc, s[50:51]
    s_mov_b64 exec, s[50:51]
    s_cbranch_scc0 L2_d73
    s_mov_b64 exec, s[82:83]
    s_nop 1
    v_mfma_f32_4x4x4_16b_bf16 v[88:91], v[12:13], v[84:85], 0
    s_nop 1
    v_mfma_f32_4x4x4_16b_bf16 v[88:91], v[10:11], v[86:87], v[88:91]
    s_nop 4
    v_cvt_pk_bf16_f32 v88, v88, v89
    v_cvt_pk_bf16_f32 v89, v90, v91
    ds_pk_add_bf16 v7, v88 offset:65408
    ds_pk_add_bf16 v7, v89 offset:65412
    s_mov_b64 exec, vcc
    s_branch L2_d73
L2_c74:
    s_mov_b64 s[50:51], vcc
    s_lshl_b64 s[52:53], s[82:83], 1
    s_andn2_b64 s[52:53], s[52:53], s[80:81]
    s_andn2_b64 s[52:53], s[52:53], s[50:51]
    s_or_b64 s[80:81], s[80:81], s[52:53]
    s_not_b64 vcc, s[52:53]
    s_mov_b64 exec, -1
    v_cndmask_b32_dpp v84, v84, v84, vcc wave_shr:1 row_mask:0xf bank_mask:0xf
    v_cndmask_b32_dpp v85, v85, v85, vcc wave_shr:1 row_mask:0xf bank_mask:0xf
    s_lshr_b64 s[52:53], s[52:53], 1
    v_cndmask_b32_dpp v86, v86, v86, vcc wave_shr:1 row_mask:0xf bank_mask:0xf
    v_cndmask_b32_dpp v87, v87, v87, vcc wave_shr:1 row_mask:0xf bank_mask:0xf
    s_andn2_b64 s[82:83], s[82:83], s[52:53]
    v_cndmask_b32_dpp v7, v7, v7, vcc wave_shr:1 row_mask:0xf bank_mask:0xf
    s_mov_b64 vcc, s[50:51]
    s_mov_b64 exec, s[50:51]
    s_cbranch_scc0 L2_d74
    s_mov_b64 exec, s[82:83]
    s_nop 1
    v_mfma_f32_4x4x4_16b_bf16 v[88:91], v[12:13], v[84:85], 0
    s_nop 1
    v_mfma_f32_4x4x4_16b_bf16 v[88:91], v[10:11], v[86:87], v[88:91]
    s_nop 4
    v_cvt_pk_bf16_f32 v88, v88, v89
    v_cvt_pk_bf16_f32 v89, v90, v91
    ds_pk_add_bf16 v7, v88 offset:65408
    ds_pk_add_bf16 v7, v89 offset:65412
    s_mov_b64 exec, vcc
    s_branch L2_d74
L2_c75:
    s_mov_b64 s[50:51], vcc
    s_lshl_b64 s[52:53], s[82:83], 1
    s_andn2_b64 s[52:53], s[52:53], s[80:81]
    s_andn2_b64 s[52:53], s[52:53], s[50:51]
    s_or_b64 s[80:81], s[80:81], s[52:53]
    s_not_b64 vcc, s[52:53]
    s_mov_b64 exec, -1
    v_cndmask_b32_dpp v84, v84, v84, vcc wave_shr:1 row_mask:0xf bank_mask:0xf
    v_cndmask_b32_dpp v85, v85, v85, vcc wave_shr:1 row_mask:0xf bank_mask:0xf
    s_lshr_b64 s[52:53], s[52:53], 1
    v_cndmask_b32_dpp v86, v86, v86, vcc wave_shr:1 row_mask:0xf bank_mask:0xf
    v_cndmask_b32_dpp v87, v87, v87, vcc wave_shr:1 row_mask:0xf bank_mask:0xf
    s_andn2_b64 s[82:83], s[82:83], s[52:53]
    v_cndmask_b32_dpp v7, v7, v7, vcc wave_shr:1 row_mask:0xf bank_mask:0xf
    s_mov_b64 vcc, s[50:51]
    s_mov_b64 exec, s[50:51]
    s_cbranch_scc0 L2_d75
    s_mov_b64 exec, s[82:83]
    s_nop 1
    v_mfma_f32_4x4x4_16b_bf16 v[88:91], v[12:13], v[84:85], 0
    s_nop 1
    v_mfma_f32_4x4x4_16b_bf16 v[88:91], v[10:11], v[86:87], v[88:91]
    s_nop 4
    v_cvt_pk_bf16_f32 v88, v88, v89
    v_cvt_pk_bf16_f32 v89, v90, v91
    ds_pk_add_bf16 v7, v88 offset:65408
    ds_pk_add_bf16 v7, v89 offset:65412
    s_mov_b64 exec, vcc
    s_branch L2_d75
L2_c76:
    s_mov_b64 s[50:51], vcc
    s_lshl_b64 s[52:53], s[82:83], 1
    s_andn2_b64 s[52:53], s[52:53], s[80:81]
    s_andn2_b64 s[52:53], s[52:53], s[50:51]
    s_or_b64 s[80:81], s[80:81], s[52:53]
    s_not_b64 vcc, s[52:53]
    s_mov_b64 exec, -1
    v_cndmask_b32_dpp v84, v84, v84, vcc wave_shr:1 row_mask:0xf bank_mask:0xf
    v_cndmask_b32_dpp v85, v85, v85, vcc wave_shr:1 row_mask:0xf bank_mask:0xf
    s_lshr_b64 s[52:53], s[52:53], 1
    v_cndmask_b32_dpp v86, v86, v86, vcc wave_shr:1 row_mask:0xf bank_mask:0xf
    v_cndmask_b32_dpp v87, v87, v87, vcc wave_shr:1 row_mask:0xf bank_mask:0xf
    s_andn2_b64 s[82:83], s[82:83], s[52:53]
    v_cndmask_b32_dpp v7, v7, v7, vcc wave_shr:1 row_mask:0xf bank_mask:0xf
    s_mov_b64 vcc, s[50:51]
    s_mov_b64 exec, s[50:51]
    s_cbranch_scc0 L2_d76
    s_mov_b64 exec, s[82:83]
    s_nop 1
    v_mfma_f32_4x4x4_16b_bf16 v[88:91], v[12:13], v[84:85], 0
    s_nop 1
    v_mfma_f32_4x4x4_16b_bf16 v[88:91], v[10:11], v[86:87], v[88:91]
    s_nop 4
    v_cvt_pk_bf16_f32 v88, v88, v89
    v_cvt_pk_bf16_f32 v89, v90, v91
    ds_pk_add_bf16 v7, v88 offset:65408
    ds_pk_add_bf16 v7, v89 offset:65412
    s_mov_b64 exec, vcc
    s_branch L2_d76
L2_c77:
    s_mov_b64 s[50:51], vcc
    s_lshl_b64 s[52:53], s[82:83], 1
    s_andn2_b64 s[52:53], s[52:53], s[80:81]
    s_andn2_b64 s[52:53], s[52:53], s[50:51]
    s_or_b64 s[80:81], s[80:81], s[52:53]
    s_not_b64 vcc, s[52:53]
    s_mov_b64 exec, -1
    v_cndmask_b32_dpp v84, v84, v84, vcc wave_shr:1 row_mask:0xf bank_mask:0xf
    v_cndmask_b32_dpp v85, v85, v85, vcc wave_shr:1 row_mask:0xf bank_mask:0xf
    s_lshr_b64 s[52:53], s[52:53], 1
    v_cndmask_b32_dpp v86, v86, v86, vcc wave_shr:1 row_mask:0xf bank_mask:0xf
    v_cndmask_b32_dpp v87, v87, v87, vcc wave_shr:1 row_mask:0xf bank_mask:0xf
    s_andn2_b64 s[82:83], s[82:83], s[52:53]
    v_cndmask_b32_dpp v7, v7, v7, vcc wave_shr:1 row_mask:0xf bank_mask:0xf
    s_mov_b64 vcc, s[50:51]
    s_mov_b64 exec, s[50:51]
    s_cbranch_scc0 L2_d77
    s_mov_b64 exec, s[82:83]
    s_nop 1
    v_mfma_f32_4x4x4_16b_bf16 v[88:91], v[12:13], v[84:85], 0
    s_nop 1
    v_mfma_f32_4x4x4_16b_bf16 v[88:91], v[10:11], v[86:87], v[88:91]
    s_nop 4
    v_cvt_pk_bf16_f32 v88, v88, v89
    v_cvt_pk_bf16_f32 v89, v90, v91
    ds_pk_add_bf16 v7, v88 offset:65408
    ds_pk_add_bf16 v7, v89 offset:65412
    s_mov_b64 exec, vcc
    s_branch L2_d77
L2_c78:
    s_mov_b64 s[50:51], vcc
    s_lshl_b64 s[52:53], s[82:83], 1
    s_andn2_b64 s[52:53], s[52:53], s[80:81]
    s_andn2_b64 s[52:53], s[52:53], s[50:51]
    s_or_b64 s[80:81], s[80:81], s[52:53]
    s_not_b64 vcc, s[52:53]
    s_mov_b64 exec, -1
    v_cndmask_b32_dpp v84, v84, v84, vcc wave_shr:1 row_mask:0xf bank_mask:0xf
    v_cndmask_b32_dpp v85, v85, v85, vcc wave_shr:1 row_mask:0xf bank_mask:0xf
    s_lshr_b64 s[52:53], s[52:53], 1
    v_cndmask_b32_dpp v86, v86, v86, vcc wave_shr:1 row_mask:0xf bank_mask:0xf
    v_cndmask_b32_dpp v87, v87, v87, vcc wave_shr:1 row_mask:0xf bank_mask:0xf
    s_andn2_b64 s[82:83], s[82:83], s[52:53]
    v_cndmask_b32_dpp v7, v7, v7, vcc wave_shr:1 row_mask:0xf bank_mask:0xf
    s_mov_b64 vcc, s[50:51]
    s_mov_b64 exec, s[50:51]
    s_cbranch_scc0 L2_d78
    s_mov_b64 exec, s[82:83]
    s_nop 1
    v_mfma_f32_4x4x4_16b_bf16 v[88:91], v[12:13], v[84:85], 0
    s_nop 1
    v_mfma_f32_4x4x4_16b_bf16 v[88:91], v[10:11], v[86:87], v[88:91]
    s_nop 4
    v_cvt_pk_bf16_f32 v88, v88, v89
    v_cvt_pk_bf16_f32 v89, v90, v91
    ds_pk_add_bf16 v7, v88 offset:65408
    ds_pk_add_bf16 v7, v89 offset:65412
    s_mov_b64 exec, vcc
    s_branch L2_d78
L2_xa79:
    s_cmp_eq_u32 s101, 1
    s_cbranch_scc1 L2_xc79
    v_lshlrev_b32 v89, 0, v96
    v_add_u32 v90, 140, v97
    v_bitop3_b32 v90, v89, v45, v90 bitop3:0x6a
    ds_write_b32 v98, v90 offset:28
    v_lshlrev_b32 v89, 4, v96
    v_add_u32 v90, 120, v97
    v_bitop3_b32 v90, v89, v45, v90 bitop3:0x6a
    ds_write_b32 v98, v90 offset:24
    v_lshlrev_b32 v89, 8, v96
    v_add_u32 v90, 100, v97
    v_bitop3_b32 v90, v89, v45, v90 bitop3:0x6a
    ds_write_b32 v98, v90 offset:20
L2_xc79:
    v_lshlrev_b32 v89, 12, v96
    v_add_u32 v90, 80, v97
    v_bitop3_b32 v90, v89, v45, v90 bitop3:0x6a
    ds_write_b32 v98, v90 offset:16
    s_branch L2_xb79
L2_xe79:
    v_cmp_lt_u32 vcc, 32, v99
    v_cmp_lt_u32 s[58:59], 31, v88
    v_lshrrev_b32 v89, 16, v96
    v_add_u32 v97, 80, v97
    s_or_b64 vcc, vcc, s[58:59]
    s_cbranch_scc1 L2_xs79
    v_lshlrev_b32 v89, v1, v89
    v_and_b32 v89, v45, v89
    v_cmp_ne_u32 vcc, 0, v89
    v_xor_b32 v90, v97, v89
    s_add_u32 s3, s37, s38
    v_mbcnt_lo_u32_b32 v98, vcc_lo, 0
    v_mbcnt_hi_u32_b32 v98, vcc_hi, v98
    s_bcnt1_i32_b64 s41, vcc
    v_lshl_add_u32 v98, v98, 2, s3
    s_mov_b64 exec, vcc
    ds_write_b32 v98, v90
    s_mov_b64 exec, -1
    s_lshl2_add_u32 s37, s41, s37
    s_branch L2_xr79
L2_xf79:
    s_waitcnt lgkmcnt(0)
    s_cmp_gt_u32 s37, 1024
    s_cbranch_scc1 L2_xs79
    v_mov_b32 v43, -1
    s_cmp_ge_u32 s37, 512
    s_cbranch_scc1 L2_xg79
    v_mov_b32 v42, -1
    s_cmp_ge_u32 s37, 256
    s_cbranch_scc1 L2_xg79
    v_mov_b32 v41, -1
    s_branch L2_xg79
L2_xs79:
    s_waitcnt lgkmcnt(0)
    v_mov_b32 v40, -1
    v_mov_b32 v41, -1
    v_mov_b32 v42, -1
    v_mov_b32 v43, -1
    s_add_u32 s3, s42, 2
    s_bitset1_b32 s36, s3
    s_branch L2_xg79
L2_c80:
    s_mov_b64 s[50:51], vcc
    s_lshl_b64 s[52:53], s[82:83], 1
    s_andn2_b64 s[52:53], s[52:53], s[80:81]
    s_andn2_b64 s[52:53], s[52:53], s[50:51]
    s_or_b64 s[80:81], s[80:81], s[52:53]
    s_not_b64 vcc, s[52:53]
    s_mov_b64 exec, -1
    v_cndmask_b32_dpp v84, v84, v84, vcc wave_shr:1 row_mask:0xf bank_mask:0xf
    v_cndmask_b32_dpp v85, v85, v85, vcc wave_shr:1 row_mask:0xf bank_mask:0xf
    s_lshr_b64 s[52:53], s[52:53], 1
    v_cndmask_b32_dpp v86, v86, v86, vcc wave_shr:1 row_mask:0xf bank_mask:0xf
    v_cndmask_b32_dpp v87, v87, v87, vcc wave_shr:1 row_mask:0xf bank_mask:0xf
    s_andn2_b64 s[82:83], s[82:83], s[52:53]
    v_cndmask_b32_dpp v7, v7, v7, vcc wave_shr:1 row_mask:0xf bank_mask:0xf
    s_mov_b64 vcc, s[50:51]
    s_mov_b64 exec, s[50:51]
    s_cbranch_scc0 L2_d80
    s_mov_b64 exec, s[82:83]
    s_nop 1
    v_mfma_f32_4x4x4_16b_bf16 v[88:91], v[12:13], v[84:85], 0
    s_nop 1
    v_mfma_f32_4x4x4_16b_bf16 v[88:91], v[10:11], v[86:87], v[88:91]
    s_nop 4
    v_cvt_pk_bf16_f32 v88, v88, v89
    v_cvt_pk_bf16_f32 v89, v90, v91
    ds_pk_add_bf16 v7, v88 offset:65408
    ds_pk_add_bf16 v7, v89 offset:65412
    s_mov_b64 exec, vcc
    s_branch L2_d80
L2_c81:
    s_mov_b64 s[50:51], vcc
    s_lshl_b64 s[52:53], s[82:83], 1
    s_andn2_b64 s[52:53], s[52:53], s[80:81]
    s_andn2_b64 s[52:53], s[52:53], s[50:51]
    s_or_b64 s[80:81], s[80:81], s[52:53]
    s_not_b64 vcc, s[52:53]
    s_mov_b64 exec, -1
    v_cndmask_b32_dpp v84, v84, v84, vcc wave_shr:1 row_mask:0xf bank_mask:0xf
    v_cndmask_b32_dpp v85, v85, v85, vcc wave_shr:1 row_mask:0xf bank_mask:0xf
    s_lshr_b64 s[52:53], s[52:53], 1
    v_cndmask_b32_dpp v86, v86, v86, vcc wave_shr:1 row_mask:0xf bank_mask:0xf
    v_cndmask_b32_dpp v87, v87, v87, vcc wave_shr:1 row_mask:0xf bank_mask:0xf
    s_andn2_b64 s[82:83], s[82:83], s[52:53]
    v_cndmask_b32_dpp v7, v7, v7, vcc wave_shr:1 row_mask:0xf bank_mask:0xf
    s_mov_b64 vcc, s[50:51]
    s_mov_b64 exec, s[50:51]
    s_cbranch_scc0 L2_d81
    s_mov_b64 exec, s[82:83]
    s_nop 1
    v_mfma_f32_4x4x4_16b_bf16 v[88:91], v[12:13], v[84:85], 0
    s_nop 1
    v_mfma_f32_4x4x4_16b_bf16 v[88:91], v[10:11], v[86:87], v[88:91]
    s_nop 4
    v_cvt_pk_bf16_f32 v88, v88, v89
    v_cvt_pk_bf16_f32 v89, v90, v91
    ds_pk_add_bf16 v7, v88 offset:65408
    ds_pk_add_bf16 v7, v89 offset:65412
    s_mov_b64 exec, vcc
    s_branch L2_d81
L2_c82:
    s_mov_b64 s[50:51], vcc
    s_lshl_b64 s[52:53], s[82:83], 1
    s_andn2_b64 s[52:53], s[52:53], s[80:81]
    s_andn2_b64 s[52:53], s[52:53], s[50:51]
    s_or_b64 s[80:81], s[80:81], s[52:53]
    s_not_b64 vcc, s[52:53]
    s_mov_b64 exec, -1
    v_cndmask_b32_dpp v84, v84, v84, vcc wave_shr:1 row_mask:0xf bank_mask:0xf
    v_cndmask_b32_dpp v85, v85, v85, vcc wave_shr:1 row_mask:0xf bank_mask:0xf
    s_lshr_b64 s[52:53], s[52:53], 1
    v_cndmask_b32_dpp v86, v86, v86, vcc wave_shr:1 row_mask:0xf bank_mask:0xf
    v_cndmask_b32_dpp v87, v87, v87, vcc wave_shr:1 row_mask:0xf bank_mask:0xf
    s_andn2_b64 s[82:83], s[82:83], s[52:53]
    v_cndmask_b32_dpp v7, v7, v7, vcc wave_shr:1 row_mask:0xf bank_mask:0xf
    s_mov_b64 vcc, s[50:51]
    s_mov_b64 exec, s[50:51]
    s_cbranch_scc0 L2_d82
    s_mov_b64 exec, s[82:83]
    s_nop 1
    v_mfma_f32_4x4x4_16b_bf16 v[88:91], v[12:13], v[84:85], 0
    s_nop 1
    v_mfma_f32_4x4x4_16b_bf16 v[88:91], v[10:11], v[86:87], v[88:91]
    s_nop 4
    v_cvt_pk_bf16_f32 v88, v88, v89
    v_cvt_pk_bf16_f32 v89, v90, v91
    ds_pk_add_bf16 v7, v88 offset:65408
    ds_pk_add_bf16 v7, v89 offset:65412
    s_mov_b64 exec, vcc
    s_branch L2_d82
L2_c83:
    s_mov_b64 s[50:51], vcc
    s_lshl_b64 s[52:53], s[82:83], 1
    s_andn2_b64 s[52:53], s[52:53], s[80:81]
    s_andn2_b64 s[52:53], s[52:53], s[50:51]
    s_or_b64 s[80:81], s[80:81], s[52:53]
    s_not_b64 vcc, s[52:53]
    s_mov_b64 exec, -1
    v_cndmask_b32_dpp v84, v84, v84, vcc wave_shr:1 row_mask:0xf bank_mask:0xf
    v_cndmask_b32_dpp v85, v85, v85, vcc wave_shr:1 row_mask:0xf bank_mask:0xf
    s_lshr_b64 s[52:53], s[52:53], 1
    v_cndmask_b32_dpp v86, v86, v86, vcc wave_shr:1 row_mask:0xf bank_mask:0xf
    v_cndmask_b32_dpp v87, v87, v87, vcc wave_shr:1 row_mask:0xf bank_mask:0xf
    s_andn2_b64 s[82:83], s[82:83], s[52:53]
    v_cndmask_b32_dpp v7, v7, v7, vcc wave_shr:1 row_mask:0xf bank_mask:0xf
    s_mov_b64 vcc, s[50:51]
    s_mov_b64 exec, s[50:51]
    s_cbranch_scc0 L2_d83
    s_mov_b64 exec, s[82:83]
    s_nop 1
    v_mfma_f32_4x4x4_16b_bf16 v[88:91], v[12:13], v[84:85], 0
    s_nop 1
    v_mfma_f32_4x4x4_16b_bf16 v[88:91], v[10:11], v[86:87], v[88:91]
    s_nop 4
    v_cvt_pk_bf16_f32 v88, v88, v89
    v_cvt_pk_bf16_f32 v89, v90, v91
    ds_pk_add_bf16 v7, v88 offset:65408
    ds_pk_add_bf16 v7, v89 offset:65412
    s_mov_b64 exec, vcc
    s_branch L2_d83
L2_c84:
    s_mov_b64 s[50:51], vcc
    s_lshl_b64 s[52:53], s[82:83], 1
    s_andn2_b64 s[52:53], s[52:53], s[80:81]
    s_andn2_b64 s[52:53], s[52:53], s[50:51]
    s_or_b64 s[80:81], s[80:81], s[52:53]
    s_not_b64 vcc, s[52:53]
    s_mov_b64 exec, -1
    v_cndmask_b32_dpp v84, v84, v84, vcc wave_shr:1 row_mask:0xf bank_mask:0xf
    v_cndmask_b32_dpp v85, v85, v85, vcc wave_shr:1 row_mask:0xf bank_mask:0xf
    s_lshr_b64 s[52:53], s[52:53], 1
    v_cndmask_b32_dpp v86, v86, v86, vcc wave_shr:1 row_mask:0xf bank_mask:0xf
    v_cndmask_b32_dpp v87, v87, v87, vcc wave_shr:1 row_mask:0xf bank_mask:0xf
    s_andn2_b64 s[82:83], s[82:83], s[52:53]
    v_cndmask_b32_dpp v7, v7, v7, vcc wave_shr:1 row_mask:0xf bank_mask:0xf
    s_mov_b64 vcc, s[50:51]
    s_mov_b64 exec, s[50:51]
    s_cbranch_scc0 L2_d84
    s_mov_b64 exec, s[82:83]
    s_nop 1
    v_mfma_f32_4x4x4_16b_bf16 v[88:91], v[12:13], v[84:85], 0
    s_nop 1
    v_mfma_f32_4x4x4_16b_bf16 v[88:91], v[10:11], v[86:87], v[88:91]
    s_nop 4
    v_cvt_pk_bf16_f32 v88, v88, v89
    v_cvt_pk_bf16_f32 v89, v90, v91
    ds_pk_add_bf16 v7, v88 offset:65408
    ds_pk_add_bf16 v7, v89 offset:65412
    s_mov_b64 exec, vcc
    s_branch L2_d84
L2_c85:
    s_mov_b64 s[50:51], vcc
    s_lshl_b64 s[52:53], s[82:83], 1
    s_andn2_b64 s[52:53], s[52:53], s[80:81]
    s_andn2_b64 s[52:53], s[52:53], s[50:51]
    s_or_b64 s[80:81], s[80:81], s[52:53]
    s_not_b64 vcc, s[52:53]
    s_mov_b64 exec, -1
    v_cndmask_b32_dpp v84, v84, v84, vcc wave_shr:1 row_mask:0xf bank_mask:0xf
    v_cndmask_b32_dpp v85, v85, v85, vcc wave_shr:1 row_mask:0xf bank_mask:0xf
    s_lshr_b64 s[52:53], s[52:53], 1
    v_cndmask_b32_dpp v86, v86, v86, vcc wave_shr:1 row_mask:0xf bank_mask:0xf
    v_cndmask_b32_dpp v87, v87, v87, vcc wave_shr:1 row_mask:0xf bank_mask:0xf
    s_andn2_b64 s[82:83], s[82:83], s[52:53]
    v_cndmask_b32_dpp v7, v7, v7, vcc wave_shr:1 row_mask:0xf bank_mask:0xf
    s_mov_b64 vcc, s[50:51]
    s_mov_b64 exec, s[50:51]
    s_cbranch_scc0 L2_d85
    s_mov_b64 exec, s[82:83]
    s_nop 1
    v_mfma_f32_4x4x4_16b_bf16 v[88:91], v[12:13], v[84:85], 0
    s_nop 1
    v_mfma_f32_4x4x4_16b_bf16 v[88:91], v[10:11], v[86:87], v[88:91]
    s_nop 4
    v_cvt_pk_bf16_f32 v88, v88, v89
    v_cvt_pk_bf16_f32 v89, v90, v91
    ds_pk_add_bf16 v7, v88 offset:65408
    ds_pk_add_bf16 v7, v89 offset:65412
    s_mov_b64 exec, vcc
    s_branch L2_d85
L2_c86:
    s_mov_b64 s[50:51], vcc
    s_lshl_b64 s[52:53], s[82:83], 1
    s_andn2_b64 s[52:53], s[52:53], s[80:81]
    s_andn2_b64 s[52:53], s[52:53], s[50:51]
    s_or_b64 s[80:81], s[80:81], s[52:53]
    s_not_b64 vcc, s[52:53]
    s_mov_b64 exec, -1
    v_cndmask_b32_dpp v84, v84, v84, vcc wave_shr:1 row_mask:0xf bank_mask:0xf
    v_cndmask_b32_dpp v85, v85, v85, vcc wave_shr:1 row_mask:0xf bank_mask:0xf
    s_lshr_b64 s[52:53], s[52:53], 1
    v_cndmask_b32_dpp v86, v86, v86, vcc wave_shr:1 row_mask:0xf bank_mask:0xf
    v_cndmask_b32_dpp v87, v87, v87, vcc wave_shr:1 row_mask:0xf bank_mask:0xf
    s_andn2_b64 s[82:83], s[82:83], s[52:53]
    v_cndmask_b32_dpp v7, v7, v7, vcc wave_shr:1 row_mask:0xf bank_mask:0xf
    s_mov_b64 vcc, s[50:51]
    s_mov_b64 exec, s[50:51]
    s_cbranch_scc0 L2_d86
    s_mov_b64 exec, s[82:83]
    s_nop 1
    v_mfma_f32_4x4x4_16b_bf16 v[88:91], v[12:13], v[84:85], 0
    s_nop 1
    v_mfma_f32_4x4x4_16b_bf16 v[88:91], v[10:11], v[86:87], v[88:91]
    s_nop 4
    v_cvt_pk_bf16_f32 v88, v88, v89
    v_cvt_pk_bf16_f32 v89, v90, v91
    ds_pk_add_bf16 v7, v88 offset:65408
    ds_pk_add_bf16 v7, v89 offset:65412
    s_mov_b64 exec, vcc
    s_branch L2_d86
L2_c87:
    s_mov_b64 s[50:51], vcc
    s_lshl_b64 s[52:53], s[82:83], 1
    s_andn2_b64 s[52:53], s[52:53], s[80:81]
    s_andn2_b64 s[52:53], s[52:53], s[50:51]
    s_or_b64 s[80:81], s[80:81], s[52:53]
    s_not_b64 vcc, s[52:53]
    s_mov_b64 exec, -1
    v_cndmask_b32_dpp v84, v84, v84, vcc wave_shr:1 row_mask:0xf bank_mask:0xf
    v_cndmask_b32_dpp v85, v85, v85, vcc wave_shr:1 row_mask:0xf bank_mask:0xf
    s_lshr_b64 s[52:53], s[52:53], 1
    v_cndmask_b32_dpp v86, v86, v86, vcc wave_shr:1 row_mask:0xf bank_mask:0xf
    v_cndmask_b32_dpp v87, v87, v87, vcc wave_shr:1 row_mask:0xf bank_mask:0xf
    s_andn2_b64 s[82:83], s[82:83], s[52:53]
    v_cndmask_b32_dpp v7, v7, v7, vcc wave_shr:1 row_mask:0xf bank_mask:0xf
    s_mov_b64 vcc, s[50:51]
    s_mov_b64 exec, s[50:51]
    s_cbranch_scc0 L2_d87
    s_mov_b64 exec, s[82:83]
    s_nop 1
    v_mfma_f32_4x4x4_16b_bf16 v[88:91], v[12:13], v[84:85], 0
    s_nop 1
    v_mfma_f32_4x4x4_16b_bf16 v[88:91], v[10:11], v[86:87], v[88:91]
    s_nop 4
    v_cvt_pk_bf16_f32 v88, v88, v89
    v_cvt_pk_bf16_f32 v89, v90, v91
    ds_pk_add_bf16 v7, v88 offset:65408
    ds_pk_add_bf16 v7, v89 offset:65412
    s_mov_b64 exec, vcc
    s_branch L2_d87
L2_xo88:
    v_cmp_lt_u32 vcc, 20, v99
    s_mov_b32 s101, 1
    s_cbranch_vccz L2_xp88
    v_cmp_lt_u32 vcc, 32, v99
    v_cmp_lt_u32 s[58:59], 31, v88
    s_mov_b32 s101, 2
    s_or_b64 vcc, vcc, s[58:59]
    s_cbranch_scc0 L2_xp88
    s_mov_b32 s37, 0x10000
    s_branch L2_xp88
L2_c89:
    s_mov_b64 s[50:51], vcc
    s_lshl_b64 s[52:53], s[82:83], 1
    s_andn2_b64 s[52:53], s[52:53], s[80:81]
    s_andn2_b64 s[52:53], s[52:53], s[50:51]
    s_or_b64 s[80:81], s[80:81], s[52:53]
    s_not_b64 vcc, s[52:53]
    s_mov_b64 exec, -1
    v_cndmask_b32_dpp v84, v84, v84, vcc wave_shr:1 row_mask:0xf bank_mask:0xf
    v_cndmask_b32_dpp v85, v85, v85, vcc wave_shr:1 row_mask:0xf bank_mask:0xf
    s_lshr_b64 s[52:53], s[52:53], 1
    v_cndmask_b32_dpp v86, v86, v86, vcc wave_shr:1 row_mask:0xf bank_mask:0xf
    v_cndmask_b32_dpp v87, v87, v87, vcc wave_shr:1 row_mask:0xf bank_mask:0xf
    s_andn2_b64 s[82:83], s[82:83], s[52:53]
    v_cndmask_b32_dpp v7, v7, v7, vcc wave_shr:1 row_mask:0xf bank_mask:0xf
    s_mov_b64 vcc, s[50:51]
    s_mov_b64 exec, s[50:51]
    s_cbranch_scc0 L2_d89
    s_mov_b64 exec, s[82:83]
    s_nop 1
    v_mfma_f32_4x4x4_16b_bf16 v[88:91], v[12:13], v[84:85], 0
    s_nop 1
    v_mfma_f32_4x4x4_16b_bf16 v[88:91], v[10:11], v[86:87], v[88:91]
    s_nop 4
    v_cvt_pk_bf16_f32 v88, v88, v89
    v_cvt_pk_bf16_f32 v89, v90, v91
    ds_pk_add_bf16 v7, v88 offset:65408
    ds_pk_add_bf16 v7, v89 offset:65412
    s_mov_b64 exec, vcc
    s_branch L2_d89
L2_c90:
    s_mov_b64 s[50:51], vcc
    s_lshl_b64 s[52:53], s[82:83], 1
    s_andn2_b64 s[52:53], s[52:53], s[80:81]
    s_andn2_b64 s[52:53], s[52:53], s[50:51]
    s_or_b64 s[80:81], s[80:81], s[52:53]
    s_not_b64 vcc, s[52:53]
    s_mov_b64 exec, -1
    v_cndmask_b32_dpp v84, v84, v84, vcc wave_shr:1 row_mask:0xf bank_mask:0xf
    v_cndmask_b32_dpp v85, v85, v85, vcc wave_shr:1 row_mask:0xf bank_mask:0xf
    s_lshr_b64 s[52:53], s[52:53], 1
    v_cndmask_b32_dpp v86, v86, v86, vcc wave_shr:1 row_mask:0xf bank_mask:0xf
    v_cndmask_b32_dpp v87, v87, v87, vcc wave_shr:1 row_mask:0xf bank_mask:0xf
    s_andn2_b64 s[82:83], s[82:83], s[52:53]
    v_cndmask_b32_dpp v7, v7, v7, vcc wave_shr:1 row_mask:0xf bank_mask:0xf
    s_mov_b64 vcc, s[50:51]
    s_mov_b64 exec, s[50:51]
    s_cbranch_scc0 L2_d90
    s_mov_b64 exec, s[82:83]
    s_nop 1
    v_mfma_f32_4x4x4_16b_bf16 v[88:91], v[12:13], v[84:85], 0
    s_nop 1
    v_mfma_f32_4x4x4_16b_bf16 v[88:91], v[10:11], v[86:87], v[88:91]
    s_nop 4
    v_cvt_pk_bf16_f32 v88, v88, v89
    v_cvt_pk_bf16_f32 v89, v90, v91
    ds_pk_add_bf16 v7, v88 offset:65408
    ds_pk_add_bf16 v7, v89 offset:65412
    s_mov_b64 exec, vcc
    s_branch L2_d90
L2_c91:
    s_mov_b64 s[50:51], vcc
    s_lshl_b64 s[52:53], s[82:83], 1
    s_andn2_b64 s[52:53], s[52:53], s[80:81]
    s_andn2_b64 s[52:53], s[52:53], s[50:51]
    s_or_b64 s[80:81], s[80:81], s[52:53]
    s_not_b64 vcc, s[52:53]
    s_mov_b64 exec, -1
    v_cndmask_b32_dpp v84, v84, v84, vcc wave_shr:1 row_mask:0xf bank_mask:0xf
    v_cndmask_b32_dpp v85, v85, v85, vcc wave_shr:1 row_mask:0xf bank_mask:0xf
    s_lshr_b64 s[52:53], s[52:53], 1
    v_cndmask_b32_dpp v86, v86, v86, vcc wave_shr:1 row_mask:0xf bank_mask:0xf
    v_cndmask_b32_dpp v87, v87, v87, vcc wave_shr:1 row_mask:0xf bank_mask:0xf
    s_andn2_b64 s[82:83], s[82:83], s[52:53]
    v_cndmask_b32_dpp v7, v7, v7, vcc wave_shr:1 row_mask:0xf bank_mask:0xf
    s_mov_b64 vcc, s[50:51]
    s_mov_b64 exec, s[50:51]
    s_cbranch_scc0 L2_d91
    s_mov_b64 exec, s[82:83]
    s_nop 1
    v_mfma_f32_4x4x4_16b_bf16 v[88:91], v[12:13], v[84:85], 0
    s_nop 1
    v_mfma_f32_4x4x4_16b_bf16 v[88:91], v[10:11], v[86:87], v[88:91]
    s_nop 4
    v_cvt_pk_bf16_f32 v88, v88, v89
    v_cvt_pk_bf16_f32 v89, v90, v91
    ds_pk_add_bf16 v7, v88 offset:65408
    ds_pk_add_bf16 v7, v89 offset:65412
    s_mov_b64 exec, vcc
    s_branch L2_d91
L2_c92:
    s_mov_b64 s[50:51], vcc
    s_lshl_b64 s[52:53], s[82:83], 1
    s_andn2_b64 s[52:53], s[52:53], s[80:81]
    s_andn2_b64 s[52:53], s[52:53], s[50:51]
    s_or_b64 s[80:81], s[80:81], s[52:53]
    s_not_b64 vcc, s[52:53]
    s_mov_b64 exec, -1
    v_cndmask_b32_dpp v84, v84, v84, vcc wave_shr:1 row_mask:0xf bank_mask:0xf
    v_cndmask_b32_dpp v85, v85, v85, vcc wave_shr:1 row_mask:0xf bank_mask:0xf
    s_lshr_b64 s[52:53], s[52:53], 1
    v_cndmask_b32_dpp v86, v86, v86, vcc wave_shr:1 row_mask:0xf bank_mask:0xf
    v_cndmask_b32_dpp v87, v87, v87, vcc wave_shr:1 row_mask:0xf bank_mask:0xf
    s_andn2_b64 s[82:83], s[82:83], s[52:53]
    v_cndmask_b32_dpp v7, v7, v7, vcc wave_shr:1 row_mask:0xf bank_mask:0xf
    s_mov_b64 vcc, s[50:51]
    s_mov_b64 exec, s[50:51]
    s_cbranch_scc0 L2_d92
    s_mov_b64 exec, s[82:83]
    s_nop 1
    v_mfma_f32_4x4x4_16b_bf16 v[88:91], v[12:13], v[84:85], 0
    s_nop 1
    v_mfma_f32_4x4x4_16b_bf16 v[88:91], v[10:11], v[86:87], v[88:91]
    s_nop 4
    v_cvt_pk_bf16_f32 v88, v88, v89
    v_cvt_pk_bf16_f32 v89, v90, v91
    ds_pk_add_bf16 v7, v88 offset:65408
    ds_pk_add_bf16 v7, v89 offset:65412
    s_mov_b64 exec, vcc
    s_branch L2_d92
L2_c93:
    s_mov_b64 s[50:51], vcc
    s_lshl_b64 s[52:53], s[82:83], 1
    s_andn2_b64 s[52:53], s[52:53], s[80:81]
    s_andn2_b64 s[52:53], s[52:53], s[50:51]
    s_or_b64 s[80:81], s[80:81], s[52:53]
    s_not_b64 vcc, s[52:53]
    s_mov_b64 exec, -1
    v_cndmask_b32_dpp v84, v84, v84, vcc wave_shr:1 row_mask:0xf bank_mask:0xf
    v_cndmask_b32_dpp v85, v85, v85, vcc wave_shr:1 row_mask:0xf bank_mask:0xf
    s_lshr_b64 s[52:53], s[52:53], 1
    v_cndmask_b32_dpp v86, v86, v86, vcc wave_shr:1 row_mask:0xf bank_mask:0xf
    v_cndmask_b32_dpp v87, v87, v87, vcc wave_shr:1 row_mask:0xf bank_mask:0xf
    s_andn2_b64 s[82:83], s[82:83], s[52:53]
    v_cndmask_b32_dpp v7, v7, v7, vcc wave_shr:1 row_mask:0xf bank_mask:0xf
    s_mov_b64 vcc, s[50:51]
    s_mov_b64 exec, s[50:51]
    s_cbranch_scc0 L2_d93
    s_mov_b64 exec, s[82:83]
    s_nop 1
    v_mfma_f32_4x4x4_16b_bf16 v[88:91], v[12:13], v[84:85], 0
    s_nop 1
    v_mfma_f32_4x4x4_16b_bf16 v[88:91], v[10:11], v[86:87], v[88:91]
    s_nop 4
    v_cvt_pk_bf16_f32 v88, v88, v89
    v_cvt_pk_bf16_f32 v89, v90, v91
    ds_pk_add_bf16 v7, v88 offset:65408
    ds_pk_add_bf16 v7, v89 offset:65412
    s_mov_b64 exec, vcc
    s_branch L2_d93
L2_c94:
    s_mov_b64 s[50:51], vcc
    s_lshl_b64 s[52:53], s[82:83], 1
    s_andn2_b64 s[52:53], s[52:53], s[80:81]
    s_andn2_b64 s[52:53], s[52:53], s[50:51]
    s_or_b64 s[80:81], s[80:81], s[52:53]
    s_not_b64 vcc, s[52:53]
    s_mov_b64 exec, -1
    v_cndmask_b32_dpp v84, v84, v84, vcc wave_shr:1 row_mask:0xf bank_mask:0xf
    v_cndmask_b32_dpp v85, v85, v85, vcc wave_shr:1 row_mask:0xf bank_mask:0xf
    s_lshr_b64 s[52:53], s[52:53], 1
    v_cndmask_b32_dpp v86, v86, v86, vcc wave_shr:1 row_mask:0xf bank_mask:0xf
    v_cndmask_b32_dpp v87, v87, v87, vcc wave_shr:1 row_mask:0xf bank_mask:0xf
    s_andn2_b64 s[82:83], s[82:83], s[52:53]
    v_cndmask_b32_dpp v7, v7, v7, vcc wave_shr:1 row_mask:0xf bank_mask:0xf
    s_mov_b64 vcc, s[50:51]
    s_mov_b64 exec, s[50:51]
    s_cbranch_scc0 L2_d94
    s_mov_b64 exec, s[82:83]
    s_nop 1
    v_mfma_f32_4x4x4_16b_bf16 v[88:91], v[12:13], v[84:85], 0
    s_nop 1
    v_mfma_f32_4x4x4_16b_bf16 v[88:91], v[10:11], v[86:87], v[88:91]
    s_nop 4
    v_cvt_pk_bf16_f32 v88, v88, v89
    v_cvt_pk_bf16_f32 v89, v90, v91
    ds_pk_add_bf16 v7, v88 offset:65408
    ds_pk_add_bf16 v7, v89 offset:65412
    s_mov_b64 exec, vcc
    s_branch L2_d94
L2_c95:
    s_mov_b64 s[50:51], vcc
    s_lshl_b64 s[52:53], s[82:83], 1
    s_andn2_b64 s[52:53], s[52:53], s[80:81]
    s_andn2_b64 s[52:53], s[52:53], s[50:51]
    s_or_b64 s[80:81], s[80:81], s[52:53]
    s_not_b64 vcc, s[52:53]
    s_mov_b64 exec, -1
    v_cndmask_b32_dpp v84, v84, v84, vcc wave_shr:1 row_mask:0xf bank_mask:0xf
    v_cndmask_b32_dpp v85, v85, v85, vcc wave_shr:1 row_mask:0xf bank_mask:0xf
    s_lshr_b64 s[52:53], s[52:53], 1
    v_cndmask_b32_dpp v86, v86, v86, vcc wave_shr:1 row_mask:0xf bank_mask:0xf
    v_cndmask_b32_dpp v87, v87, v87, vcc wave_shr:1 row_mask:0xf bank_mask:0xf
    s_andn2_b64 s[82:83], s[82:83], s[52:53]
    v_cndmask_b32_dpp v7, v7, v7, vcc wave_shr:1 row_mask:0xf bank_mask:0xf
    s_mov_b64 vcc, s[50:51]
    s_mov_b64 exec, s[50:51]
    s_cbranch_scc0 L2_d95
    s_mov_b64 exec, s[82:83]
    s_nop 1
    v_mfma_f32_4x4x4_16b_bf16 v[88:91], v[12:13], v[84:85], 0
    s_nop 1
    v_mfma_f32_4x4x4_16b_bf16 v[88:91], v[10:11], v[86:87], v[88:91]
    s_nop 4
    v_cvt_pk_bf16_f32 v88, v88, v89
    v_cvt_pk_bf16_f32 v89, v90, v91
    ds_pk_add_bf16 v7, v88 offset:65408
    ds_pk_add_bf16 v7, v89 offset:65412
    s_mov_b64 exec, vcc
    s_branch L2_d95
L2_c96:
    s_mov_b64 s[50:51], vcc
    s_lshl_b64 s[52:53], s[82:83], 1
    s_andn2_b64 s[52:53], s[52:53], s[80:81]
    s_andn2_b64 s[52:53], s[52:53], s[50:51]
    s_or_b64 s[80:81], s[80:81], s[52:53]
    s_not_b64 vcc, s[52:53]
    s_mov_b64 exec, -1
    v_cndmask_b32_dpp v84, v84, v84, vcc wave_shr:1 row_mask:0xf bank_mask:0xf
    v_cndmask_b32_dpp v85, v85, v85, vcc wave_shr:1 row_mask:0xf bank_mask:0xf
    s_lshr_b64 s[52:53], s[52:53], 1
    v_cndmask_b32_dpp v86, v86, v86, vcc wave_shr:1 row_mask:0xf bank_mask:0xf
    v_cndmask_b32_dpp v87, v87, v87, vcc wave_shr:1 row_mask:0xf bank_mask:0xf
    s_andn2_b64 s[82:83], s[82:83], s[52:53]
    v_cndmask_b32_dpp v7, v7, v7, vcc wave_shr:1 row_mask:0xf bank_mask:0xf
    s_mov_b64 vcc, s[50:51]
    s_mov_b64 exec, s[50:51]
    s_cbranch_scc0 L2_d96
    s_mov_b64 exec, s[82:83]
    s_nop 1
    v_mfma_f32_4x4x4_16b_bf16 v[88:91], v[12:13], v[84:85], 0
    s_nop 1
    v_mfma_f32_4x4x4_16b_bf16 v[88:91], v[10:11], v[86:87], v[88:91]
    s_nop 4
    v_cvt_pk_bf16_f32 v88, v88, v89
    v_cvt_pk_bf16_f32 v89, v90, v91
    ds_pk_add_bf16 v7, v88 offset:65408
    ds_pk_add_bf16 v7, v89 offset:65412
    s_mov_b64 exec, vcc
    s_branch L2_d96
L2_xa97:
    s_cmp_eq_u32 s101, 1
    s_cbranch_scc1 L2_xc97
    v_lshlrev_b32 v89, 0, v96
    v_add_u32 v90, 140, v97
    v_bitop3_b32 v90, v89, v45, v90 bitop3:0x6a
    ds_write_b32 v98, v90 offset:28
    v_lshlrev_b32 v89, 4, v96
    v_add_u32 v90, 120, v97
    v_bitop3_b32 v90, v89, v45, v90 bitop3:0x6a
    ds_write_b32 v98, v90 offset:24
    v_lshlrev_b32 v89, 8, v96
    v_add_u32 v90, 100, v97
    v_bitop3_b32 v90, v89, v45, v90 bitop3:0x6a
    ds_write_b32 v98, v90 offset:20
L2_xc97:
    v_lshlrev_b32 v89, 12, v96
    v_add_u32 v90, 80, v97
    v_bitop3_b32 v90, v89, v45, v90 bitop3:0x6a
    ds_write_b32 v98, v90 offset:16
    s_branch L2_xb97
L2_xe97:
    v_cmp_lt_u32 vcc, 32, v99
    v_cmp_lt_u32 s[58:59], 31, v88
    v_lshrrev_b32 v89, 16, v96
    v_add_u32 v97, 80, v97
    s_or_b64 vcc, vcc, s[58:59]
    s_cbranch_scc1 L2_xs97
    v_lshlrev_b32 v89, v1, v89
    v_and_b32 v89, v45, v89
    v_cmp_ne_u32 vcc, 0, v89
    v_xor_b32 v90, v97, v89
    s_add_u32 s3, s37, s38
    v_mbcnt_lo_u32_b32 v98, vcc_lo, 0
    v_mbcnt_hi_u32_b32 v98, vcc_hi, v98
    s_bcnt1_i32_b64 s41, vcc
    v_lshl_add_u32 v98, v98, 2, s3
    s_mov_b64 exec, vcc
    ds_write_b32 v98, v90
    s_mov_b64 exec, -1
    s_lshl2_add_u32 s37, s41, s37
    s_branch L2_xr97
L2_xf97:
    s_waitcnt lgkmcnt(0)
    s_cmp_gt_u32 s37, 1024
    s_cbranch_scc1 L2_xs97
    v_mov_b32 v43, -1
    s_cmp_ge_u32 s37, 512
    s_cbranch_scc1 L2_xg97
    v_mov_b32 v42, -1
    s_cmp_ge_u32 s37, 256
    s_cbranch_scc1 L2_xg97
    v_mov_b32 v41, -1
    s_branch L2_xg97
L2_xs97:
    s_waitcnt lgkmcnt(0)
    v_mov_b32 v40, -1
    v_mov_b32 v41, -1
    v_mov_b32 v42, -1
    v_mov_b32 v43, -1
    s_add_u32 s3, s42, 2
    s_bitset1_b32 s36, s3
    s_branch L2_xg97
L2_c98:
    s_mov_b64 s[50:51], vcc
    s_lshl_b64 s[52:53], s[82:83], 1
    s_andn2_b64 s[52:53], s[52:53], s[80:81]
    s_andn2_b64 s[52:53], s[52:53], s[50:51]
    s_or_b64 s[80:81], s[80:81], s[52:53]
    s_not_b64 vcc, s[52:53]
    s_mov_b64 exec, -1
    v_cndmask_b32_dpp v84, v84, v84, vcc wave_shr:1 row_mask:0xf bank_mask:0xf
    v_cndmask_b32_dpp v85, v85, v85, vcc wave_shr:1 row_mask:0xf bank_mask:0xf
    s_lshr_b64 s[52:53], s[52:53], 1
    v_cndmask_b32_dpp v86, v86, v86, vcc wave_shr:1 row_mask:0xf bank_mask:0xf
    v_cndmask_b32_dpp v87, v87, v87, vcc wave_shr:1 row_mask:0xf bank_mask:0xf
    s_andn2_b64 s[82:83], s[82:83], s[52:53]
    v_cndmask_b32_dpp v7, v7, v7, vcc wave_shr:1 row_mask:0xf bank_mask:0xf
    s_mov_b64 vcc, s[50:51]
    s_mov_b64 exec, s[50:51]
    s_cbranch_scc0 L2_d98
    s_mov_b64 exec, s[82:83]
    s_nop 1
    v_mfma_f32_4x4x4_16b_bf16 v[88:91], v[12:13], v[84:85], 0
    s_nop 1
    v_mfma_f32_4x4x4_16b_bf16 v[88:91], v[10:11], v[86:87], v[88:91]
    s_nop 4
    v_cvt_pk_bf16_f32 v88, v88, v89
    v_cvt_pk_bf16_f32 v89, v90, v91
    ds_pk_add_bf16 v7, v88 offset:65408
    ds_pk_add_bf16 v7, v89 offset:65412
    s_mov_b64 exec, vcc
    s_branch L2_d98
L2_c99:
    s_mov_b64 s[50:51], vcc
    s_lshl_b64 s[52:53], s[82:83], 1
    s_andn2_b64 s[52:53], s[52:53], s[80:81]
    s_andn2_b64 s[52:53], s[52:53], s[50:51]
    s_or_b64 s[80:81], s[80:81], s[52:53]
    s_not_b64 vcc, s[52:53]
    s_mov_b64 exec, -1
    v_cndmask_b32_dpp v84, v84, v84, vcc wave_shr:1 row_mask:0xf bank_mask:0xf
    v_cndmask_b32_dpp v85, v85, v85, vcc wave_shr:1 row_mask:0xf bank_mask:0xf
    s_lshr_b64 s[52:53], s[52:53], 1
    v_cndmask_b32_dpp v86, v86, v86, vcc wave_shr:1 row_mask:0xf bank_mask:0xf
    v_cndmask_b32_dpp v87, v87, v87, vcc wave_shr:1 row_mask:0xf bank_mask:0xf
    s_andn2_b64 s[82:83], s[82:83], s[52:53]
    v_cndmask_b32_dpp v7, v7, v7, vcc wave_shr:1 row_mask:0xf bank_mask:0xf
    s_mov_b64 vcc, s[50:51]
    s_mov_b64 exec, s[50:51]
    s_cbranch_scc0 L2_d99
    s_mov_b64 exec, s[82:83]
    s_nop 1
    v_mfma_f32_4x4x4_16b_bf16 v[88:91], v[12:13], v[84:85], 0
    s_nop 1
    v_mfma_f32_4x4x4_16b_bf16 v[88:91], v[10:11], v[86:87], v[88:91]
    s_nop 4
    v_cvt_pk_bf16_f32 v88, v88, v89
    v_cvt_pk_bf16_f32 v89, v90, v91
    ds_pk_add_bf16 v7, v88 offset:65408
    ds_pk_add_bf16 v7, v89 offset:65412
    s_mov_b64 exec, vcc
    s_branch L2_d99
L2_c100:
    s_mov_b64 s[50:51], vcc
    s_lshl_b64 s[52:53], s[82:83], 1
    s_andn2_b64 s[52:53], s[52:53], s[80:81]
    s_andn2_b64 s[52:53], s[52:53], s[50:51]
    s_or_b64 s[80:81], s[80:81], s[52:53]
    s_not_b64 vcc, s[52:53]
    s_mov_b64 exec, -1
    v_cndmask_b32_dpp v84, v84, v84, vcc wave_shr:1 row_mask:0xf bank_mask:0xf
    v_cndmask_b32_dpp v85, v85, v85, vcc wave_shr:1 row_mask:0xf bank_mask:0xf
    s_lshr_b64 s[52:53], s[52:53], 1
    v_cndmask_b32_dpp v86, v86, v86, vcc wave_shr:1 row_mask:0xf bank_mask:0xf
    v_cndmask_b32_dpp v87, v87, v87, vcc wave_shr:1 row_mask:0xf bank_mask:0xf
    s_andn2_b64 s[82:83], s[82:83], s[52:53]
    v_cndmask_b32_dpp v7, v7, v7, vcc wave_shr:1 row_mask:0xf bank_mask:0xf
    s_mov_b64 vcc, s[50:51]
    s_mov_b64 exec, s[50:51]
    s_cbranch_scc0 L2_d100
    s_mov_b64 exec, s[82:83]
    s_nop 1
    v_mfma_f32_4x4x4_16b_bf16 v[88:91], v[12:13], v[84:85], 0
    s_nop 1
    v_mfma_f32_4x4x4_16b_bf16 v[88:91], v[10:11], v[86:87], v[88:91]
    s_nop 4
    v_cvt_pk_bf16_f32 v88, v88, v89
    v_cvt_pk_bf16_f32 v89, v90, v91
    ds_pk_add_bf16 v7, v88 offset:65408
    ds_pk_add_bf16 v7, v89 offset:65412
    s_mov_b64 exec, vcc
    s_branch L2_d100
L2_c101:
    s_mov_b64 s[50:51], vcc
    s_lshl_b64 s[52:53], s[82:83], 1
    s_andn2_b64 s[52:53], s[52:53], s[80:81]
    s_andn2_b64 s[52:53], s[52:53], s[50:51]
    s_or_b64 s[80:81], s[80:81], s[52:53]
    s_not_b64 vcc, s[52:53]
    s_mov_b64 exec, -1
    v_cndmask_b32_dpp v84, v84, v84, vcc wave_shr:1 row_mask:0xf bank_mask:0xf
    v_cndmask_b32_dpp v85, v85, v85, vcc wave_shr:1 row_mask:0xf bank_mask:0xf
    s_lshr_b64 s[52:53], s[52:53], 1
    v_cndmask_b32_dpp v86, v86, v86, vcc wave_shr:1 row_mask:0xf bank_mask:0xf
    v_cndmask_b32_dpp v87, v87, v87, vcc wave_shr:1 row_mask:0xf bank_mask:0xf
    s_andn2_b64 s[82:83], s[82:83], s[52:53]
    v_cndmask_b32_dpp v7, v7, v7, vcc wave_shr:1 row_mask:0xf bank_mask:0xf
    s_mov_b64 vcc, s[50:51]
    s_mov_b64 exec, s[50:51]
    s_cbranch_scc0 L2_d101
    s_mov_b64 exec, s[82:83]
    s_nop 1
    v_mfma_f32_4x4x4_16b_bf16 v[88:91], v[12:13], v[84:85], 0
    s_nop 1
    v_mfma_f32_4x4x4_16b_bf16 v[88:91], v[10:11], v[86:87], v[88:91]
    s_nop 4
    v_cvt_pk_bf16_f32 v88, v88, v89
    v_cvt_pk_bf16_f32 v89, v90, v91
    ds_pk_add_bf16 v7, v88 offset:65408
    ds_pk_add_bf16 v7, v89 offset:65412
    s_mov_b64 exec, vcc
    s_branch L2_d101
L2_c102:
    s_mov_b64 s[50:51], vcc
    s_lshl_b64 s[52:53], s[82:83], 1
    s_andn2_b64 s[52:53], s[52:53], s[80:81]
    s_andn2_b64 s[52:53], s[52:53], s[50:51]
    s_or_b64 s[80:81], s[80:81], s[52:53]
    s_not_b64 vcc, s[52:53]
    s_mov_b64 exec, -1
    v_cndmask_b32_dpp v84, v84, v84, vcc wave_shr:1 row_mask:0xf bank_mask:0xf
    v_cndmask_b32_dpp v85, v85, v85, vcc wave_shr:1 row_mask:0xf bank_mask:0xf
    s_lshr_b64 s[52:53], s[52:53], 1
    v_cndmask_b32_dpp v86, v86, v86, vcc wave_shr:1 row_mask:0xf bank_mask:0xf
    v_cndmask_b32_dpp v87, v87, v87, vcc wave_shr:1 row_mask:0xf bank_mask:0xf
    s_andn2_b64 s[82:83], s[82:83], s[52:53]
    v_cndmask_b32_dpp v7, v7, v7, vcc wave_shr:1 row_mask:0xf bank_mask:0xf
    s_mov_b64 vcc, s[50:51]
    s_mov_b64 exec, s[50:51]
    s_cbranch_scc0 L2_d102
    s_mov_b64 exec, s[82:83]
    s_nop 1
    v_mfma_f32_4x4x4_16b_bf16 v[88:91], v[12:13], v[84:85], 0
    s_nop 1
    v_mfma_f32_4x4x4_16b_bf16 v[88:91], v[10:11], v[86:87], v[88:91]
    s_nop 4
    v_cvt_pk_bf16_f32 v88, v88, v89
    v_cvt_pk_bf16_f32 v89, v90, v91
    ds_pk_add_bf16 v7, v88 offset:65408
    ds_pk_add_bf16 v7, v89 offset:65412
    s_mov_b64 exec, vcc
    s_branch L2_d102
L2_c103:
    s_mov_b64 s[50:51], vcc
    s_lshl_b64 s[52:53], s[82:83], 1
    s_andn2_b64 s[52:53], s[52:53], s[80:81]
    s_andn2_b64 s[52:53], s[52:53], s[50:51]
    s_or_b64 s[80:81], s[80:81], s[52:53]
    s_not_b64 vcc, s[52:53]
    s_mov_b64 exec, -1
    v_cndmask_b32_dpp v84, v84, v84, vcc wave_shr:1 row_mask:0xf bank_mask:0xf
    v_cndmask_b32_dpp v85, v85, v85, vcc wave_shr:1 row_mask:0xf bank_mask:0xf
    s_lshr_b64 s[52:53], s[52:53], 1
    v_cndmask_b32_dpp v86, v86, v86, vcc wave_shr:1 row_mask:0xf bank_mask:0xf
    v_cndmask_b32_dpp v87, v87, v87, vcc wave_shr:1 row_mask:0xf bank_mask:0xf
    s_andn2_b64 s[82:83], s[82:83], s[52:53]
    v_cndmask_b32_dpp v7, v7, v7, vcc wave_shr:1 row_mask:0xf bank_mask:0xf
    s_mov_b64 vcc, s[50:51]
    s_mov_b64 exec, s[50:51]
    s_cbranch_scc0 L2_d103
    s_mov_b64 exec, s[82:83]
    s_nop 1
    v_mfma_f32_4x4x4_16b_bf16 v[88:91], v[12:13], v[84:85], 0
    s_nop 1
    v_mfma_f32_4x4x4_16b_bf16 v[88:91], v[10:11], v[86:87], v[88:91]
    s_nop 4
    v_cvt_pk_bf16_f32 v88, v88, v89
    v_cvt_pk_bf16_f32 v89, v90, v91
    ds_pk_add_bf16 v7, v88 offset:65408
    ds_pk_add_bf16 v7, v89 offset:65412
    s_mov_b64 exec, vcc
    s_branch L2_d103
L2_c104:
    s_mov_b64 s[50:51], vcc
    s_lshl_b64 s[52:53], s[82:83], 1
    s_andn2_b64 s[52:53], s[52:53], s[80:81]
    s_andn2_b64 s[52:53], s[52:53], s[50:51]
    s_or_b64 s[80:81], s[80:81], s[52:53]
    s_not_b64 vcc, s[52:53]
    s_mov_b64 exec, -1
    v_cndmask_b32_dpp v84, v84, v84, vcc wave_shr:1 row_mask:0xf bank_mask:0xf
    v_cndmask_b32_dpp v85, v85, v85, vcc wave_shr:1 row_mask:0xf bank_mask:0xf
    s_lshr_b64 s[52:53], s[52:53], 1
    v_cndmask_b32_dpp v86, v86, v86, vcc wave_shr:1 row_mask:0xf bank_mask:0xf
    v_cndmask_b32_dpp v87, v87, v87, vcc wave_shr:1 row_mask:0xf bank_mask:0xf
    s_andn2_b64 s[82:83], s[82:83], s[52:53]
    v_cndmask_b32_dpp v7, v7, v7, vcc wave_shr:1 row_mask:0xf bank_mask:0xf
    s_mov_b64 vcc, s[50:51]
    s_mov_b64 exec, s[50:51]
    s_cbranch_scc0 L2_d104
    s_mov_b64 exec, s[82:83]
    s_nop 1
    v_mfma_f32_4x4x4_16b_bf16 v[88:91], v[12:13], v[84:85], 0
    s_nop 1
    v_mfma_f32_4x4x4_16b_bf16 v[88:91], v[10:11], v[86:87], v[88:91]
    s_nop 4
    v_cvt_pk_bf16_f32 v88, v88, v89
    v_cvt_pk_bf16_f32 v89, v90, v91
    ds_pk_add_bf16 v7, v88 offset:65408
    ds_pk_add_bf16 v7, v89 offset:65412
    s_mov_b64 exec, vcc
    s_branch L2_d104
L2_c105:
    s_mov_b64 s[50:51], vcc
    s_lshl_b64 s[52:53], s[82:83], 1
    s_andn2_b64 s[52:53], s[52:53], s[80:81]
    s_andn2_b64 s[52:53], s[52:53], s[50:51]
    s_or_b64 s[80:81], s[80:81], s[52:53]
    s_not_b64 vcc, s[52:53]
    s_mov_b64 exec, -1
    v_cndmask_b32_dpp v84, v84, v84, vcc wave_shr:1 row_mask:0xf bank_mask:0xf
    v_cndmask_b32_dpp v85, v85, v85, vcc wave_shr:1 row_mask:0xf bank_mask:0xf
    s_lshr_b64 s[52:53], s[52:53], 1
    v_cndmask_b32_dpp v86, v86, v86, vcc wave_shr:1 row_mask:0xf bank_mask:0xf
    v_cndmask_b32_dpp v87, v87, v87, vcc wave_shr:1 row_mask:0xf bank_mask:0xf
    s_andn2_b64 s[82:83], s[82:83], s[52:53]
    v_cndmask_b32_dpp v7, v7, v7, vcc wave_shr:1 row_mask:0xf bank_mask:0xf
    s_mov_b64 vcc, s[50:51]
    s_mov_b64 exec, s[50:51]
    s_cbranch_scc0 L2_d105
    s_mov_b64 exec, s[82:83]
    s_nop 1
    v_mfma_f32_4x4x4_16b_bf16 v[88:91], v[12:13], v[84:85], 0
    s_nop 1
    v_mfma_f32_4x4x4_16b_bf16 v[88:91], v[10:11], v[86:87], v[88:91]
    s_nop 4
    v_cvt_pk_bf16_f32 v88, v88, v89
    v_cvt_pk_bf16_f32 v89, v90, v91
    ds_pk_add_bf16 v7, v88 offset:65408
    ds_pk_add_bf16 v7, v89 offset:65412
    s_mov_b64 exec, vcc
    s_branch L2_d105
L2_xo106:
    v_cmp_lt_u32 vcc, 20, v99
    s_mov_b32 s101, 1
    s_cbranch_vccz L2_xp106
    v_cmp_lt_u32 vcc, 32, v99
    v_cmp_lt_u32 s[58:59], 31, v88
    s_mov_b32 s101, 2
    s_or_b64 vcc, vcc, s[58:59]
    s_cbranch_scc0 L2_xp106
    s_mov_b32 s37, 0x10000
    s_branch L2_xp106
L2_c107:
    s_mov_b64 s[50:51], vcc
    s_lshl_b64 s[52:53], s[82:83], 1
    s_andn2_b64 s[52:53], s[52:53], s[80:81]
    s_andn2_b64 s[52:53], s[52:53], s[50:51]
    s_or_b64 s[80:81], s[80:81], s[52:53]
    s_not_b64 vcc, s[52:53]
    s_mov_b64 exec, -1
    v_cndmask_b32_dpp v84, v84, v84, vcc wave_shr:1 row_mask:0xf bank_mask:0xf
    v_cndmask_b32_dpp v85, v85, v85, vcc wave_shr:1 row_mask:0xf bank_mask:0xf
    s_lshr_b64 s[52:53], s[52:53], 1
    v_cndmask_b32_dpp v86, v86, v86, vcc wave_shr:1 row_mask:0xf bank_mask:0xf
    v_cndmask_b32_dpp v87, v87, v87, vcc wave_shr:1 row_mask:0xf bank_mask:0xf
    s_andn2_b64 s[82:83], s[82:83], s[52:53]
    v_cndmask_b32_dpp v7, v7, v7, vcc wave_shr:1 row_mask:0xf bank_mask:0xf
    s_mov_b64 vcc, s[50:51]
    s_mov_b64 exec, s[50:51]
    s_cbranch_scc0 L2_d107
    s_mov_b64 exec, s[82:83]
    s_nop 1
    v_mfma_f32_4x4x4_16b_bf16 v[88:91], v[12:13], v[84:85], 0
    s_nop 1
    v_mfma_f32_4x4x4_16b_bf16 v[88:91], v[10:11], v[86:87], v[88:91]
    s_nop 4
    v_cvt_pk_bf16_f32 v88, v88, v89
    v_cvt_pk_bf16_f32 v89, v90, v91
    ds_pk_add_bf16 v7, v88 offset:65408
    ds_pk_add_bf16 v7, v89 offset:65412
    s_mov_b64 exec, vcc
    s_branch L2_d107
L2_c108:
    s_mov_b64 s[50:51], vcc
    s_lshl_b64 s[52:53], s[82:83], 1
    s_andn2_b64 s[52:53], s[52:53], s[80:81]
    s_andn2_b64 s[52:53], s[52:53], s[50:51]
    s_or_b64 s[80:81], s[80:81], s[52:53]
    s_not_b64 vcc, s[52:53]
    s_mov_b64 exec, -1
    v_cndmask_b32_dpp v84, v84, v84, vcc wave_shr:1 row_mask:0xf bank_mask:0xf
    v_cndmask_b32_dpp v85, v85, v85, vcc wave_shr:1 row_mask:0xf bank_mask:0xf
    s_lshr_b64 s[52:53], s[52:53], 1
    v_cndmask_b32_dpp v86, v86, v86, vcc wave_shr:1 row_mask:0xf bank_mask:0xf
    v_cndmask_b32_dpp v87, v87, v87, vcc wave_shr:1 row_mask:0xf bank_mask:0xf
    s_andn2_b64 s[82:83], s[82:83], s[52:53]
    v_cndmask_b32_dpp v7, v7, v7, vcc wave_shr:1 row_mask:0xf bank_mask:0xf
    s_mov_b64 vcc, s[50:51]
    s_mov_b64 exec, s[50:51]
    s_cbranch_scc0 L2_d108
    s_mov_b64 exec, s[82:83]
    s_nop 1
    v_mfma_f32_4x4x4_16b_bf16 v[88:91], v[12:13], v[84:85], 0
    s_nop 1
    v_mfma_f32_4x4x4_16b_bf16 v[88:91], v[10:11], v[86:87], v[88:91]
    s_nop 4
    v_cvt_pk_bf16_f32 v88, v88, v89
    v_cvt_pk_bf16_f32 v89, v90, v91
    ds_pk_add_bf16 v7, v88 offset:65408
    ds_pk_add_bf16 v7, v89 offset:65412
    s_mov_b64 exec, vcc
    s_branch L2_d108
L2_c109:
    s_mov_b64 s[50:51], vcc
    s_lshl_b64 s[52:53], s[82:83], 1
    s_andn2_b64 s[52:53], s[52:53], s[80:81]
    s_andn2_b64 s[52:53], s[52:53], s[50:51]
    s_or_b64 s[80:81], s[80:81], s[52:53]
    s_not_b64 vcc, s[52:53]
    s_mov_b64 exec, -1
    v_cndmask_b32_dpp v84, v84, v84, vcc wave_shr:1 row_mask:0xf bank_mask:0xf
    v_cndmask_b32_dpp v85, v85, v85, vcc wave_shr:1 row_mask:0xf bank_mask:0xf
    s_lshr_b64 s[52:53], s[52:53], 1
    v_cndmask_b32_dpp v86, v86, v86, vcc wave_shr:1 row_mask:0xf bank_mask:0xf
    v_cndmask_b32_dpp v87, v87, v87, vcc wave_shr:1 row_mask:0xf bank_mask:0xf
    s_andn2_b64 s[82:83], s[82:83], s[52:53]
    v_cndmask_b32_dpp v7, v7, v7, vcc wave_shr:1 row_mask:0xf bank_mask:0xf
    s_mov_b64 vcc, s[50:51]
    s_mov_b64 exec, s[50:51]
    s_cbranch_scc0 L2_d109
    s_mov_b64 exec, s[82:83]
    s_nop 1
    v_mfma_f32_4x4x4_16b_bf16 v[88:91], v[12:13], v[84:85], 0
    s_nop 1
    v_mfma_f32_4x4x4_16b_bf16 v[88:91], v[10:11], v[86:87], v[88:91]
    s_nop 4
    v_cvt_pk_bf16_f32 v88, v88, v89
    v_cvt_pk_bf16_f32 v89, v90, v91
    ds_pk_add_bf16 v7, v88 offset:65408
    ds_pk_add_bf16 v7, v89 offset:65412
    s_mov_b64 exec, vcc
    s_branch L2_d109
L2_c110:
    s_mov_b64 s[50:51], vcc
    s_lshl_b64 s[52:53], s[82:83], 1
    s_andn2_b64 s[52:53], s[52:53], s[80:81]
    s_andn2_b64 s[52:53], s[52:53], s[50:51]
    s_or_b64 s[80:81], s[80:81], s[52:53]
    s_not_b64 vcc, s[52:53]
    s_mov_b64 exec, -1
    v_cndmask_b32_dpp v84, v84, v84, vcc wave_shr:1 row_mask:0xf bank_mask:0xf
    v_cndmask_b32_dpp v85, v85, v85, vcc wave_shr:1 row_mask:0xf bank_mask:0xf
    s_lshr_b64 s[52:53], s[52:53], 1
    v_cndmask_b32_dpp v86, v86, v86, vcc wave_shr:1 row_mask:0xf bank_mask:0xf
    v_cndmask_b32_dpp v87, v87, v87, vcc wave_shr:1 row_mask:0xf bank_mask:0xf
    s_andn2_b64 s[82:83], s[82:83], s[52:53]
    v_cndmask_b32_dpp v7, v7, v7, vcc wave_shr:1 row_mask:0xf bank_mask:0xf
    s_mov_b64 vcc, s[50:51]
    s_mov_b64 exec, s[50:51]
    s_cbranch_scc0 L2_d110
    s_mov_b64 exec, s[82:83]
    s_nop 1
    v_mfma_f32_4x4x4_16b_bf16 v[88:91], v[12:13], v[84:85], 0
    s_nop 1
    v_mfma_f32_4x4x4_16b_bf16 v[88:91], v[10:11], v[86:87], v[88:91]
    s_nop 4
    v_cvt_pk_bf16_f32 v88, v88, v89
    v_cvt_pk_bf16_f32 v89, v90, v91
    ds_pk_add_bf16 v7, v88 offset:65408
    ds_pk_add_bf16 v7, v89 offset:65412
    s_mov_b64 exec, vcc
    s_branch L2_d110
L2_c111:
    s_mov_b64 s[50:51], vcc
    s_lshl_b64 s[52:53], s[82:83], 1
    s_andn2_b64 s[52:53], s[52:53], s[80:81]
    s_andn2_b64 s[52:53], s[52:53], s[50:51]
    s_or_b64 s[80:81], s[80:81], s[52:53]
    s_not_b64 vcc, s[52:53]
    s_mov_b64 exec, -1
    v_cndmask_b32_dpp v84, v84, v84, vcc wave_shr:1 row_mask:0xf bank_mask:0xf
    v_cndmask_b32_dpp v85, v85, v85, vcc wave_shr:1 row_mask:0xf bank_mask:0xf
    s_lshr_b64 s[52:53], s[52:53], 1
    v_cndmask_b32_dpp v86, v86, v86, vcc wave_shr:1 row_mask:0xf bank_mask:0xf
    v_cndmask_b32_dpp v87, v87, v87, vcc wave_shr:1 row_mask:0xf bank_mask:0xf
    s_andn2_b64 s[82:83], s[82:83], s[52:53]
    v_cndmask_b32_dpp v7, v7, v7, vcc wave_shr:1 row_mask:0xf bank_mask:0xf
    s_mov_b64 vcc, s[50:51]
    s_mov_b64 exec, s[50:51]
    s_cbranch_scc0 L2_d111
    s_mov_b64 exec, s[82:83]
    s_nop 1
    v_mfma_f32_4x4x4_16b_bf16 v[88:91], v[12:13], v[84:85], 0
    s_nop 1
    v_mfma_f32_4x4x4_16b_bf16 v[88:91], v[10:11], v[86:87], v[88:91]
    s_nop 4
    v_cvt_pk_bf16_f32 v88, v88, v89
    v_cvt_pk_bf16_f32 v89, v90, v91
    ds_pk_add_bf16 v7, v88 offset:65408
    ds_pk_add_bf16 v7, v89 offset:65412
    s_mov_b64 exec, vcc
    s_branch L2_d111
L2_c112:
    s_mov_b64 s[50:51], vcc
    s_lshl_b64 s[52:53], s[82:83], 1
    s_andn2_b64 s[52:53], s[52:53], s[80:81]
    s_andn2_b64 s[52:53], s[52:53], s[50:51]
    s_or_b64 s[80:81], s[80:81], s[52:53]
    s_not_b64 vcc, s[52:53]
    s_mov_b64 exec, -1
    v_cndmask_b32_dpp v84, v84, v84, vcc wave_shr:1 row_mask:0xf bank_mask:0xf
    v_cndmask_b32_dpp v85, v85, v85, vcc wave_shr:1 row_mask:0xf bank_mask:0xf
    s_lshr_b64 s[52:53], s[52:53], 1
    v_cndmask_b32_dpp v86, v86, v86, vcc wave_shr:1 row_mask:0xf bank_mask:0xf
    v_cndmask_b32_dpp v87, v87, v87, vcc wave_shr:1 row_mask:0xf bank_mask:0xf
    s_andn2_b64 s[82:83], s[82:83], s[52:53]
    v_cndmask_b32_dpp v7, v7, v7, vcc wave_shr:1 row_mask:0xf bank_mask:0xf
    s_mov_b64 vcc, s[50:51]
    s_mov_b64 exec, s[50:51]
    s_cbranch_scc0 L2_d112
    s_mov_b64 exec, s[82:83]
    s_nop 1
    v_mfma_f32_4x4x4_16b_bf16 v[88:91], v[12:13], v[84:85], 0
    s_nop 1
    v_mfma_f32_4x4x4_16b_bf16 v[88:91], v[10:11], v[86:87], v[88:91]
    s_nop 4
    v_cvt_pk_bf16_f32 v88, v88, v89
    v_cvt_pk_bf16_f32 v89, v90, v91
    ds_pk_add_bf16 v7, v88 offset:65408
    ds_pk_add_bf16 v7, v89 offset:65412
    s_mov_b64 exec, vcc
    s_branch L2_d112
L2_c113:
    s_mov_b64 s[50:51], vcc
    s_lshl_b64 s[52:53], s[82:83], 1
    s_andn2_b64 s[52:53], s[52:53], s[80:81]
    s_andn2_b64 s[52:53], s[52:53], s[50:51]
    s_or_b64 s[80:81], s[80:81], s[52:53]
    s_not_b64 vcc, s[52:53]
    s_mov_b64 exec, -1
    v_cndmask_b32_dpp v84, v84, v84, vcc wave_shr:1 row_mask:0xf bank_mask:0xf
    v_cndmask_b32_dpp v85, v85, v85, vcc wave_shr:1 row_mask:0xf bank_mask:0xf
    s_lshr_b64 s[52:53], s[52:53], 1
    v_cndmask_b32_dpp v86, v86, v86, vcc wave_shr:1 row_mask:0xf bank_mask:0xf
    v_cndmask_b32_dpp v87, v87, v87, vcc wave_shr:1 row_mask:0xf bank_mask:0xf
    s_andn2_b64 s[82:83], s[82:83], s[52:53]
    v_cndmask_b32_dpp v7, v7, v7, vcc wave_shr:1 row_mask:0xf bank_mask:0xf
    s_mov_b64 vcc, s[50:51]
    s_mov_b64 exec, s[50:51]
    s_cbranch_scc0 L2_d113
    s_mov_b64 exec, s[82:83]
    s_nop 1
    v_mfma_f32_4x4x4_16b_bf16 v[88:91], v[12:13], v[84:85], 0
    s_nop 1
    v_mfma_f32_4x4x4_16b_bf16 v[88:91], v[10:11], v[86:87], v[88:91]
    s_nop 4
    v_cvt_pk_bf16_f32 v88, v88, v89
    v_cvt_pk_bf16_f32 v89, v90, v91
    ds_pk_add_bf16 v7, v88 offset:65408
    ds_pk_add_bf16 v7, v89 offset:65412
    s_mov_b64 exec, vcc
    s_branch L2_d113
L2_c114:
    s_mov_b64 s[50:51], vcc
    s_lshl_b64 s[52:53], s[82:83], 1
    s_andn2_b64 s[52:53], s[52:53], s[80:81]
    s_andn2_b64 s[52:53], s[52:53], s[50:51]
    s_or_b64 s[80:81], s[80:81], s[52:53]
    s_not_b64 vcc, s[52:53]
    s_mov_b64 exec, -1
    v_cndmask_b32_dpp v84, v84, v84, vcc wave_shr:1 row_mask:0xf bank_mask:0xf
    v_cndmask_b32_dpp v85, v85, v85, vcc wave_shr:1 row_mask:0xf bank_mask:0xf
    s_lshr_b64 s[52:53], s[52:53], 1
    v_cndmask_b32_dpp v86, v86, v86, vcc wave_shr:1 row_mask:0xf bank_mask:0xf
    v_cndmask_b32_dpp v87, v87, v87, vcc wave_shr:1 row_mask:0xf bank_mask:0xf
    s_andn2_b64 s[82:83], s[82:83], s[52:53]
    v_cndmask_b32_dpp v7, v7, v7, vcc wave_shr:1 row_mask:0xf bank_mask:0xf
    s_mov_b64 vcc, s[50:51]
    s_mov_b64 exec, s[50:51]
    s_cbranch_scc0 L2_d114
    s_mov_b64 exec, s[82:83]
    s_nop 1
    v_mfma_f32_4x4x4_16b_bf16 v[88:91], v[12:13], v[84:85], 0
    s_nop 1
    v_mfma_f32_4x4x4_16b_bf16 v[88:91], v[10:11], v[86:87], v[88:91]
    s_nop 4
    v_cvt_pk_bf16_f32 v88, v88, v89
    v_cvt_pk_bf16_f32 v89, v90, v91
    ds_pk_add_bf16 v7, v88 offset:65408
    ds_pk_add_bf16 v7, v89 offset:65412
    s_mov_b64 exec, vcc
    s_branch L2_d114
L2_xa115:
    s_cmp_eq_u32 s101, 1
    s_cbranch_scc1 L2_xc115
    v_lshlrev_b32 v89, 0, v96
    v_add_u32 v90, 140, v97
    v_bitop3_b32 v90, v89, v45, v90 bitop3:0x6a
    ds_write_b32 v98, v90 offset:28
    v_lshlrev_b32 v89, 4, v96
    v_add_u32 v90, 120, v97
    v_bitop3_b32 v90, v89, v45, v90 bitop3:0x6a
    ds_write_b32 v98, v90 offset:24
    v_lshlrev_b32 v89, 8, v96
    v_add_u32 v90, 100, v97
    v_bitop3_b32 v90, v89, v45, v90 bitop3:0x6a
    ds_write_b32 v98, v90 offset:20
L2_xc115:
    v_lshlrev_b32 v89, 12, v96
    v_add_u32 v90, 80, v97
    v_bitop3_b32 v90, v89, v45, v90 bitop3:0x6a
    ds_write_b32 v98, v90 offset:16
    s_branch L2_xb115
L2_xe115:
    v_cmp_lt_u32 vcc, 32, v99
    v_cmp_lt_u32 s[58:59], 31, v88
    v_lshrrev_b32 v89, 16, v96
    v_add_u32 v97, 80, v97
    s_or_b64 vcc, vcc, s[58:59]
    s_cbranch_scc1 L2_xs115
    v_lshlrev_b32 v89, v1, v89
    v_and_b32 v89, v45, v89
    v_cmp_ne_u32 vcc, 0, v89
    v_xor_b32 v90, v97, v89
    s_add_u32 s3, s37, s38
    v_mbcnt_lo_u32_b32 v98, vcc_lo, 0
    v_mbcnt_hi_u32_b32 v98, vcc_hi, v98
    s_bcnt1_i32_b64 s41, vcc
    v_lshl_add_u32 v98, v98, 2, s3
    s_mov_b64 exec, vcc
    ds_write_b32 v98, v90
    s_mov_b64 exec, -1
    s_lshl2_add_u32 s37, s41, s37
    s_branch L2_xr115
L2_xf115:
    s_waitcnt lgkmcnt(0)
    s_cmp_gt_u32 s37, 1024
    s_cbranch_scc1 L2_xs115
    v_mov_b32 v43, -1
    s_cmp_ge_u32 s37, 512
    s_cbranch_scc1 L2_xg115
    v_mov_b32 v42, -1
    s_cmp_ge_u32 s37, 256
    s_cbranch_scc1 L2_xg115
    v_mov_b32 v41, -1
    s_branch L2_xg115
L2_xs115:
    s_waitcnt lgkmcnt(0)
    v_mov_b32 v40, -1
    v_mov_b32 v41, -1
    v_mov_b32 v42, -1
    v_mov_b32 v43, -1
    s_add_u32 s3, s42, 2
    s_bitset1_b32 s36, s3
    s_branch L2_xg115
L2_c116:
    s_mov_b64 s[50:51], vcc
    s_lshl_b64 s[52:53], s[82:83], 1
    s_andn2_b64 s[52:53], s[52:53], s[80:81]
    s_andn2_b64 s[52:53], s[52:53], s[50:51]
    s_or_b64 s[80:81], s[80:81], s[52:53]
    s_not_b64 vcc, s[52:53]
    s_mov_b64 exec, -1
    v_cndmask_b32_dpp v84, v84, v84, vcc wave_shr:1 row_mask:0xf bank_mask:0xf
    v_cndmask_b32_dpp v85, v85, v85, vcc wave_shr:1 row_mask:0xf bank_mask:0xf
    s_lshr_b64 s[52:53], s[52:53], 1
    v_cndmask_b32_dpp v86, v86, v86, vcc wave_shr:1 row_mask:0xf bank_mask:0xf
    v_cndmask_b32_dpp v87, v87, v87, vcc wave_shr:1 row_mask:0xf bank_mask:0xf
    s_andn2_b64 s[82:83], s[82:83], s[52:53]
    v_cndmask_b32_dpp v7, v7, v7, vcc wave_shr:1 row_mask:0xf bank_mask:0xf
    s_mov_b64 vcc, s[50:51]
    s_mov_b64 exec, s[50:51]
    s_cbranch_scc0 L2_d116
    s_mov_b64 exec, s[82:83]
    s_nop 1
    v_mfma_f32_4x4x4_16b_bf16 v[88:91], v[12:13], v[84:85], 0
    s_nop 1
    v_mfma_f32_4x4x4_16b_bf16 v[88:91], v[10:11], v[86:87], v[88:91]
    s_nop 4
    v_cvt_pk_bf16_f32 v88, v88, v89
    v_cvt_pk_bf16_f32 v89, v90, v91
    ds_pk_add_bf16 v7, v88 offset:65408
    ds_pk_add_bf16 v7, v89 offset:65412
    s_mov_b64 exec, vcc
    s_branch L2_d116
L2_c117:
    s_mov_b64 s[50:51], vcc
    s_lshl_b64 s[52:53], s[82:83], 1
    s_andn2_b64 s[52:53], s[52:53], s[80:81]
    s_andn2_b64 s[52:53], s[52:53], s[50:51]
    s_or_b64 s[80:81], s[80:81], s[52:53]
    s_not_b64 vcc, s[52:53]
    s_mov_b64 exec, -1
    v_cndmask_b32_dpp v84, v84, v84, vcc wave_shr:1 row_mask:0xf bank_mask:0xf
    v_cndmask_b32_dpp v85, v85, v85, vcc wave_shr:1 row_mask:0xf bank_mask:0xf
    s_lshr_b64 s[52:53], s[52:53], 1
    v_cndmask_b32_dpp v86, v86, v86, vcc wave_shr:1 row_mask:0xf bank_mask:0xf
    v_cndmask_b32_dpp v87, v87, v87, vcc wave_shr:1 row_mask:0xf bank_mask:0xf
    s_andn2_b64 s[82:83], s[82:83], s[52:53]
    v_cndmask_b32_dpp v7, v7, v7, vcc wave_shr:1 row_mask:0xf bank_mask:0xf
    s_mov_b64 vcc, s[50:51]
    s_mov_b64 exec, s[50:51]
    s_cbranch_scc0 L2_d117
    s_mov_b64 exec, s[82:83]
    s_nop 1
    v_mfma_f32_4x4x4_16b_bf16 v[88:91], v[12:13], v[84:85], 0
    s_nop 1
    v_mfma_f32_4x4x4_16b_bf16 v[88:91], v[10:11], v[86:87], v[88:91]
    s_nop 4
    v_cvt_pk_bf16_f32 v88, v88, v89
    v_cvt_pk_bf16_f32 v89, v90, v91
    ds_pk_add_bf16 v7, v88 offset:65408
    ds_pk_add_bf16 v7, v89 offset:65412
    s_mov_b64 exec, vcc
    s_branch L2_d117
L2_c118:
    s_mov_b64 s[50:51], vcc
    s_lshl_b64 s[52:53], s[82:83], 1
    s_andn2_b64 s[52:53], s[52:53], s[80:81]
    s_andn2_b64 s[52:53], s[52:53], s[50:51]
    s_or_b64 s[80:81], s[80:81], s[52:53]
    s_not_b64 vcc, s[52:53]
    s_mov_b64 exec, -1
    v_cndmask_b32_dpp v84, v84, v84, vcc wave_shr:1 row_mask:0xf bank_mask:0xf
    v_cndmask_b32_dpp v85, v85, v85, vcc wave_shr:1 row_mask:0xf bank_mask:0xf
    s_lshr_b64 s[52:53], s[52:53], 1
    v_cndmask_b32_dpp v86, v86, v86, vcc wave_shr:1 row_mask:0xf bank_mask:0xf
    v_cndmask_b32_dpp v87, v87, v87, vcc wave_shr:1 row_mask:0xf bank_mask:0xf
    s_andn2_b64 s[82:83], s[82:83], s[52:53]
    v_cndmask_b32_dpp v7, v7, v7, vcc wave_shr:1 row_mask:0xf bank_mask:0xf
    s_mov_b64 vcc, s[50:51]
    s_mov_b64 exec, s[50:51]
    s_cbranch_scc0 L2_d118
    s_mov_b64 exec, s[82:83]
    s_nop 1
    v_mfma_f32_4x4x4_16b_bf16 v[88:91], v[12:13], v[84:85], 0
    s_nop 1
    v_mfma_f32_4x4x4_16b_bf16 v[88:91], v[10:11], v[86:87], v[88:91]
    s_nop 4
    v_cvt_pk_bf16_f32 v88, v88, v89
    v_cvt_pk_bf16_f32 v89, v90, v91
    ds_pk_add_bf16 v7, v88 offset:65408
    ds_pk_add_bf16 v7, v89 offset:65412
    s_mov_b64 exec, vcc
    s_branch L2_d118
L2_c119:
    s_mov_b64 s[50:51], vcc
    s_lshl_b64 s[52:53], s[82:83], 1
    s_andn2_b64 s[52:53], s[52:53], s[80:81]
    s_andn2_b64 s[52:53], s[52:53], s[50:51]
    s_or_b64 s[80:81], s[80:81], s[52:53]
    s_not_b64 vcc, s[52:53]
    s_mov_b64 exec, -1
    v_cndmask_b32_dpp v84, v84, v84, vcc wave_shr:1 row_mask:0xf bank_mask:0xf
    v_cndmask_b32_dpp v85, v85, v85, vcc wave_shr:1 row_mask:0xf bank_mask:0xf
    s_lshr_b64 s[52:53], s[52:53], 1
    v_cndmask_b32_dpp v86, v86, v86, vcc wave_shr:1 row_mask:0xf bank_mask:0xf
    v_cndmask_b32_dpp v87, v87, v87, vcc wave_shr:1 row_mask:0xf bank_mask:0xf
    s_andn2_b64 s[82:83], s[82:83], s[52:53]
    v_cndmask_b32_dpp v7, v7, v7, vcc wave_shr:1 row_mask:0xf bank_mask:0xf
    s_mov_b64 vcc, s[50:51]
    s_mov_b64 exec, s[50:51]
    s_cbranch_scc0 L2_d119
    s_mov_b64 exec, s[82:83]
    s_nop 1
    v_mfma_f32_4x4x4_16b_bf16 v[88:91], v[12:13], v[84:85], 0
    s_nop 1
    v_mfma_f32_4x4x4_16b_bf16 v[88:91], v[10:11], v[86:87], v[88:91]
    s_nop 4
    v_cvt_pk_bf16_f32 v88, v88, v89
    v_cvt_pk_bf16_f32 v89, v90, v91
    ds_pk_add_bf16 v7, v88 offset:65408
    ds_pk_add_bf16 v7, v89 offset:65412
    s_mov_b64 exec, vcc
    s_branch L2_d119
L2_c120:
    s_mov_b64 s[50:51], vcc
    s_lshl_b64 s[52:53], s[82:83], 1
    s_andn2_b64 s[52:53], s[52:53], s[80:81]
    s_andn2_b64 s[52:53], s[52:53], s[50:51]
    s_or_b64 s[80:81], s[80:81], s[52:53]
    s_not_b64 vcc, s[52:53]
    s_mov_b64 exec, -1
    v_cndmask_b32_dpp v84, v84, v84, vcc wave_shr:1 row_mask:0xf bank_mask:0xf
    v_cndmask_b32_dpp v85, v85, v85, vcc wave_shr:1 row_mask:0xf bank_mask:0xf
    s_lshr_b64 s[52:53], s[52:53], 1
    v_cndmask_b32_dpp v86, v86, v86, vcc wave_shr:1 row_mask:0xf bank_mask:0xf
    v_cndmask_b32_dpp v87, v87, v87, vcc wave_shr:1 row_mask:0xf bank_mask:0xf
    s_andn2_b64 s[82:83], s[82:83], s[52:53]
    v_cndmask_b32_dpp v7, v7, v7, vcc wave_shr:1 row_mask:0xf bank_mask:0xf
    s_mov_b64 vcc, s[50:51]
    s_mov_b64 exec, s[50:51]
    s_cbranch_scc0 L2_d120
    s_mov_b64 exec, s[82:83]
    s_nop 1
    v_mfma_f32_4x4x4_16b_bf16 v[88:91], v[12:13], v[84:85], 0
    s_nop 1
    v_mfma_f32_4x4x4_16b_bf16 v[88:91], v[10:11], v[86:87], v[88:91]
    s_nop 4
    v_cvt_pk_bf16_f32 v88, v88, v89
    v_cvt_pk_bf16_f32 v89, v90, v91
    ds_pk_add_bf16 v7, v88 offset:65408
    ds_pk_add_bf16 v7, v89 offset:65412
    s_mov_b64 exec, vcc
    s_branch L2_d120
L2_c121:
    s_mov_b64 s[50:51], vcc
    s_lshl_b64 s[52:53], s[82:83], 1
    s_andn2_b64 s[52:53], s[52:53], s[80:81]
    s_andn2_b64 s[52:53], s[52:53], s[50:51]
    s_or_b64 s[80:81], s[80:81], s[52:53]
    s_not_b64 vcc, s[52:53]
    s_mov_b64 exec, -1
    v_cndmask_b32_dpp v84, v84, v84, vcc wave_shr:1 row_mask:0xf bank_mask:0xf
    v_cndmask_b32_dpp v85, v85, v85, vcc wave_shr:1 row_mask:0xf bank_mask:0xf
    s_lshr_b64 s[52:53], s[52:53], 1
    v_cndmask_b32_dpp v86, v86, v86, vcc wave_shr:1 row_mask:0xf bank_mask:0xf
    v_cndmask_b32_dpp v87, v87, v87, vcc wave_shr:1 row_mask:0xf bank_mask:0xf
    s_andn2_b64 s[82:83], s[82:83], s[52:53]
    v_cndmask_b32_dpp v7, v7, v7, vcc wave_shr:1 row_mask:0xf bank_mask:0xf
    s_mov_b64 vcc, s[50:51]
    s_mov_b64 exec, s[50:51]
    s_cbranch_scc0 L2_d121
    s_mov_b64 exec, s[82:83]
    s_nop 1
    v_mfma_f32_4x4x4_16b_bf16 v[88:91], v[12:13], v[84:85], 0
    s_nop 1
    v_mfma_f32_4x4x4_16b_bf16 v[88:91], v[10:11], v[86:87], v[88:91]
    s_nop 4
    v_cvt_pk_bf16_f32 v88, v88, v89
    v_cvt_pk_bf16_f32 v89, v90, v91
    ds_pk_add_bf16 v7, v88 offset:65408
    ds_pk_add_bf16 v7, v89 offset:65412
    s_mov_b64 exec, vcc
    s_branch L2_d121
L2_c122:
    s_mov_b64 s[50:51], vcc
    s_lshl_b64 s[52:53], s[82:83], 1
    s_andn2_b64 s[52:53], s[52:53], s[80:81]
    s_andn2_b64 s[52:53], s[52:53], s[50:51]
    s_or_b64 s[80:81], s[80:81], s[52:53]
    s_not_b64 vcc, s[52:53]
    s_mov_b64 exec, -1
    v_cndmask_b32_dpp v84, v84, v84, vcc wave_shr:1 row_mask:0xf bank_mask:0xf
    v_cndmask_b32_dpp v85, v85, v85, vcc wave_shr:1 row_mask:0xf bank_mask:0xf
    s_lshr_b64 s[52:53], s[52:53], 1
    v_cndmask_b32_dpp v86, v86, v86, vcc wave_shr:1 row_mask:0xf bank_mask:0xf
    v_cndmask_b32_dpp v87, v87, v87, vcc wave_shr:1 row_mask:0xf bank_mask:0xf
    s_andn2_b64 s[82:83], s[82:83], s[52:53]
    v_cndmask_b32_dpp v7, v7, v7, vcc wave_shr:1 row_mask:0xf bank_mask:0xf
    s_mov_b64 vcc, s[50:51]
    s_mov_b64 exec, s[50:51]
    s_cbranch_scc0 L2_d122
    s_mov_b64 exec, s[82:83]
    s_nop 1
    v_mfma_f32_4x4x4_16b_bf16 v[88:91], v[12:13], v[84:85], 0
    s_nop 1
    v_mfma_f32_4x4x4_16b_bf16 v[88:91], v[10:11], v[86:87], v[88:91]
    s_nop 4
    v_cvt_pk_bf16_f32 v88, v88, v89
    v_cvt_pk_bf16_f32 v89, v90, v91
    ds_pk_add_bf16 v7, v88 offset:65408
    ds_pk_add_bf16 v7, v89 offset:65412
    s_mov_b64 exec, vcc
    s_branch L2_d122
L2_c123:
    s_mov_b64 s[50:51], vcc
    s_lshl_b64 s[52:53], s[82:83], 1
    s_andn2_b64 s[52:53], s[52:53], s[80:81]
    s_andn2_b64 s[52:53], s[52:53], s[50:51]
    s_or_b64 s[80:81], s[80:81], s[52:53]
    s_not_b64 vcc, s[52:53]
    s_mov_b64 exec, -1
    v_cndmask_b32_dpp v84, v84, v84, vcc wave_shr:1 row_mask:0xf bank_mask:0xf
    v_cndmask_b32_dpp v85, v85, v85, vcc wave_shr:1 row_mask:0xf bank_mask:0xf
    s_lshr_b64 s[52:53], s[52:53], 1
    v_cndmask_b32_dpp v86, v86, v86, vcc wave_shr:1 row_mask:0xf bank_mask:0xf
    v_cndmask_b32_dpp v87, v87, v87, vcc wave_shr:1 row_mask:0xf bank_mask:0xf
    s_andn2_b64 s[82:83], s[82:83], s[52:53]
    v_cndmask_b32_dpp v7, v7, v7, vcc wave_shr:1 row_mask:0xf bank_mask:0xf
    s_mov_b64 vcc, s[50:51]
    s_mov_b64 exec, s[50:51]
    s_cbranch_scc0 L2_d123
    s_mov_b64 exec, s[82:83]
    s_nop 1
    v_mfma_f32_4x4x4_16b_bf16 v[88:91], v[12:13], v[84:85], 0
    s_nop 1
    v_mfma_f32_4x4x4_16b_bf16 v[88:91], v[10:11], v[86:87], v[88:91]
    s_nop 4
    v_cvt_pk_bf16_f32 v88, v88, v89
    v_cvt_pk_bf16_f32 v89, v90, v91
    ds_pk_add_bf16 v7, v88 offset:65408
    ds_pk_add_bf16 v7, v89 offset:65412
    s_mov_b64 exec, vcc
    s_branch L2_d123
L2_c124:
    s_mov_b64 s[50:51], vcc
    s_lshl_b64 s[52:53], s[82:83], 1
    s_andn2_b64 s[52:53], s[52:53], s[80:81]
    s_andn2_b64 s[52:53], s[52:53], s[50:51]
    s_or_b64 s[80:81], s[80:81], s[52:53]
    s_not_b64 vcc, s[52:53]
    s_mov_b64 exec, -1
    v_cndmask_b32_dpp v84, v84, v84, vcc wave_shr:1 row_mask:0xf bank_mask:0xf
    v_cndmask_b32_dpp v85, v85, v85, vcc wave_shr:1 row_mask:0xf bank_mask:0xf
    s_lshr_b64 s[52:53], s[52:53], 1
    v_cndmask_b32_dpp v86, v86, v86, vcc wave_shr:1 row_mask:0xf bank_mask:0xf
    v_cndmask_b32_dpp v87, v87, v87, vcc wave_shr:1 row_mask:0xf bank_mask:0xf
    s_andn2_b64 s[82:83], s[82:83], s[52:53]
    v_cndmask_b32_dpp v7, v7, v7, vcc wave_shr:1 row_mask:0xf bank_mask:0xf
    s_mov_b64 vcc, s[50:51]
    s_mov_b64 exec, s[50:51]
    s_cbranch_scc0 L2_d124
    s_mov_b64 exec, s[82:83]
    s_nop 1
    v_mfma_f32_4x4x4_16b_bf16 v[88:91], v[12:13], v[84:85], 0
    s_nop 1
    v_mfma_f32_4x4x4_16b_bf16 v[88:91], v[10:11], v[86:87], v[88:91]
    s_nop 4
    v_cvt_pk_bf16_f32 v88, v88, v89
    v_cvt_pk_bf16_f32 v89, v90, v91
    ds_pk_add_bf16 v7, v88 offset:65408
    ds_pk_add_bf16 v7, v89 offset:65412
    s_mov_b64 exec, vcc
    s_branch L2_d124
L2_c125:
    s_mov_b64 s[50:51], vcc
    s_lshl_b64 s[52:53], s[82:83], 1
    s_andn2_b64 s[52:53], s[52:53], s[80:81]
    s_andn2_b64 s[52:53], s[52:53], s[50:51]
    s_or_b64 s[80:81], s[80:81], s[52:53]
    s_not_b64 vcc, s[52:53]
    s_mov_b64 exec, -1
    v_cndmask_b32_dpp v84, v84, v84, vcc wave_shr:1 row_mask:0xf bank_mask:0xf
    v_cndmask_b32_dpp v85, v85, v85, vcc wave_shr:1 row_mask:0xf bank_mask:0xf
    s_lshr_b64 s[52:53], s[52:53], 1
    v_cndmask_b32_dpp v86, v86, v86, vcc wave_shr:1 row_mask:0xf bank_mask:0xf
    v_cndmask_b32_dpp v87, v87, v87, vcc wave_shr:1 row_mask:0xf bank_mask:0xf
    s_andn2_b64 s[82:83], s[82:83], s[52:53]
    v_cndmask_b32_dpp v7, v7, v7, vcc wave_shr:1 row_mask:0xf bank_mask:0xf
    s_mov_b64 vcc, s[50:51]
    s_mov_b64 exec, s[50:51]
    s_cbranch_scc0 L2_d125
    s_mov_b64 exec, s[82:83]
    s_nop 1
    v_mfma_f32_4x4x4_16b_bf16 v[88:91], v[12:13], v[84:85], 0
    s_nop 1
    v_mfma_f32_4x4x4_16b_bf16 v[88:91], v[10:11], v[86:87], v[88:91]
    s_nop 4
    v_cvt_pk_bf16_f32 v88, v88, v89
    v_cvt_pk_bf16_f32 v89, v90, v91
    ds_pk_add_bf16 v7, v88 offset:65408
    ds_pk_add_bf16 v7, v89 offset:65412
    s_mov_b64 exec, vcc
    s_branch L2_d125
L2_c126:
    s_mov_b64 s[50:51], vcc
    s_lshl_b64 s[52:53], s[82:83], 1
    s_andn2_b64 s[52:53], s[52:53], s[80:81]
    s_andn2_b64 s[52:53], s[52:53], s[50:51]
    s_or_b64 s[80:81], s[80:81], s[52:53]
    s_not_b64 vcc, s[52:53]
    s_mov_b64 exec, -1
    v_cndmask_b32_dpp v84, v84, v84, vcc wave_shr:1 row_mask:0xf bank_mask:0xf
    v_cndmask_b32_dpp v85, v85, v85, vcc wave_shr:1 row_mask:0xf bank_mask:0xf
    s_lshr_b64 s[52:53], s[52:53], 1
    v_cndmask_b32_dpp v86, v86, v86, vcc wave_shr:1 row_mask:0xf bank_mask:0xf
    v_cndmask_b32_dpp v87, v87, v87, vcc wave_shr:1 row_mask:0xf bank_mask:0xf
    s_andn2_b64 s[82:83], s[82:83], s[52:53]
    v_cndmask_b32_dpp v7, v7, v7, vcc wave_shr:1 row_mask:0xf bank_mask:0xf
    s_mov_b64 vcc, s[50:51]
    s_mov_b64 exec, s[50:51]
    s_cbranch_scc0 L2_d126
    s_mov_b64 exec, s[82:83]
    s_nop 1
    v_mfma_f32_4x4x4_16b_bf16 v[88:91], v[12:13], v[84:85], 0
    s_nop 1
    v_mfma_f32_4x4x4_16b_bf16 v[88:91], v[10:11], v[86:87], v[88:91]
    s_nop 4
    v_cvt_pk_bf16_f32 v88, v88, v89
    v_cvt_pk_bf16_f32 v89, v90, v91
    ds_pk_add_bf16 v7, v88 offset:65408
    ds_pk_add_bf16 v7, v89 offset:65412
    s_mov_b64 exec, vcc
    s_branch L2_d126
L2_c127:
    s_mov_b64 s[50:51], vcc
    s_lshl_b64 s[52:53], s[82:83], 1
    s_andn2_b64 s[52:53], s[52:53], s[80:81]
    s_andn2_b64 s[52:53], s[52:53], s[50:51]
    s_or_b64 s[80:81], s[80:81], s[52:53]
    s_not_b64 vcc, s[52:53]
    s_mov_b64 exec, -1
    v_cndmask_b32_dpp v84, v84, v84, vcc wave_shr:1 row_mask:0xf bank_mask:0xf
    v_cndmask_b32_dpp v85, v85, v85, vcc wave_shr:1 row_mask:0xf bank_mask:0xf
    s_lshr_b64 s[52:53], s[52:53], 1
    v_cndmask_b32_dpp v86, v86, v86, vcc wave_shr:1 row_mask:0xf bank_mask:0xf
    v_cndmask_b32_dpp v87, v87, v87, vcc wave_shr:1 row_mask:0xf bank_mask:0xf
    s_andn2_b64 s[82:83], s[82:83], s[52:53]
    v_cndmask_b32_dpp v7, v7, v7, vcc wave_shr:1 row_mask:0xf bank_mask:0xf
    s_mov_b64 vcc, s[50:51]
    s_mov_b64 exec, s[50:51]
    s_cbranch_scc0 L2_d127
    s_mov_b64 exec, s[82:83]
    s_nop 1
    v_mfma_f32_4x4x4_16b_bf16 v[88:91], v[12:13], v[84:85], 0
    s_nop 1
    v_mfma_f32_4x4x4_16b_bf16 v[88:91], v[10:11], v[86:87], v[88:91]
    s_nop 4
    v_cvt_pk_bf16_f32 v88, v88, v89
    v_cvt_pk_bf16_f32 v89, v90, v91
    ds_pk_add_bf16 v7, v88 offset:65408
    ds_pk_add_bf16 v7, v89 offset:65412
    s_mov_b64 exec, vcc
    s_branch L2_d127
L2_c128:
    s_mov_b64 s[50:51], vcc
    s_lshl_b64 s[52:53], s[82:83], 1
    s_andn2_b64 s[52:53], s[52:53], s[80:81]
    s_andn2_b64 s[52:53], s[52:53], s[50:51]
    s_or_b64 s[80:81], s[80:81], s[52:53]
    s_not_b64 vcc, s[52:53]
    s_mov_b64 exec, -1
    v_cndmask_b32_dpp v84, v84, v84, vcc wave_shr:1 row_mask:0xf bank_mask:0xf
    v_cndmask_b32_dpp v85, v85, v85, vcc wave_shr:1 row_mask:0xf bank_mask:0xf
    s_lshr_b64 s[52:53], s[52:53], 1
    v_cndmask_b32_dpp v86, v86, v86, vcc wave_shr:1 row_mask:0xf bank_mask:0xf
    v_cndmask_b32_dpp v87, v87, v87, vcc wave_shr:1 row_mask:0xf bank_mask:0xf
    s_andn2_b64 s[82:83], s[82:83], s[52:53]
    v_cndmask_b32_dpp v7, v7, v7, vcc wave_shr:1 row_mask:0xf bank_mask:0xf
    s_mov_b64 vcc, s[50:51]
    s_mov_b64 exec, s[50:51]
    s_cbranch_scc0 L2_d128
    s_mov_b64 exec, s[82:83]
    s_nop 1
    v_mfma_f32_4x4x4_16b_bf16 v[88:91], v[12:13], v[84:85], 0
    s_nop 1
    v_mfma_f32_4x4x4_16b_bf16 v[88:91], v[10:11], v[86:87], v[88:91]
    s_nop 4
    v_cvt_pk_bf16_f32 v88, v88, v89
    v_cvt_pk_bf16_f32 v89, v90, v91
    ds_pk_add_bf16 v7, v88 offset:65408
    ds_pk_add_bf16 v7, v89 offset:65412
    s_mov_b64 exec, vcc
    s_branch L2_d128
L2_c129:
    s_mov_b64 s[50:51], vcc
    s_lshl_b64 s[52:53], s[82:83], 1
    s_andn2_b64 s[52:53], s[52:53], s[80:81]
    s_andn2_b64 s[52:53], s[52:53], s[50:51]
    s_or_b64 s[80:81], s[80:81], s[52:53]
    s_not_b64 vcc, s[52:53]
    s_mov_b64 exec, -1
    v_cndmask_b32_dpp v84, v84, v84, vcc wave_shr:1 row_mask:0xf bank_mask:0xf
    v_cndmask_b32_dpp v85, v85, v85, vcc wave_shr:1 row_mask:0xf bank_mask:0xf
    s_lshr_b64 s[52:53], s[52:53], 1
    v_cndmask_b32_dpp v86, v86, v86, vcc wave_shr:1 row_mask:0xf bank_mask:0xf
    v_cndmask_b32_dpp v87, v87, v87, vcc wave_shr:1 row_mask:0xf bank_mask:0xf
    s_andn2_b64 s[82:83], s[82:83], s[52:53]
    v_cndmask_b32_dpp v7, v7, v7, vcc wave_shr:1 row_mask:0xf bank_mask:0xf
    s_mov_b64 vcc, s[50:51]
    s_mov_b64 exec, s[50:51]
    s_cbranch_scc0 L2_d129
    s_mov_b64 exec, s[82:83]
    s_nop 1
    v_mfma_f32_4x4x4_16b_bf16 v[88:91], v[12:13], v[84:85], 0
    s_nop 1
    v_mfma_f32_4x4x4_16b_bf16 v[88:91], v[10:11], v[86:87], v[88:91]
    s_nop 4
    v_cvt_pk_bf16_f32 v88, v88, v89
    v_cvt_pk_bf16_f32 v89, v90, v91
    ds_pk_add_bf16 v7, v88 offset:65408
    ds_pk_add_bf16 v7, v89 offset:65412
    s_mov_b64 exec, vcc
    s_branch L2_d129
L2_c130:
    s_mov_b64 s[50:51], vcc
    s_lshl_b64 s[52:53], s[82:83], 1
    s_andn2_b64 s[52:53], s[52:53], s[80:81]
    s_andn2_b64 s[52:53], s[52:53], s[50:51]
    s_or_b64 s[80:81], s[80:81], s[52:53]
    s_not_b64 vcc, s[52:53]
    s_mov_b64 exec, -1
    v_cndmask_b32_dpp v84, v84, v84, vcc wave_shr:1 row_mask:0xf bank_mask:0xf
    v_cndmask_b32_dpp v85, v85, v85, vcc wave_shr:1 row_mask:0xf bank_mask:0xf
    s_lshr_b64 s[52:53], s[52:53], 1
    v_cndmask_b32_dpp v86, v86, v86, vcc wave_shr:1 row_mask:0xf bank_mask:0xf
    v_cndmask_b32_dpp v87, v87, v87, vcc wave_shr:1 row_mask:0xf bank_mask:0xf
    s_andn2_b64 s[82:83], s[82:83], s[52:53]
    v_cndmask_b32_dpp v7, v7, v7, vcc wave_shr:1 row_mask:0xf bank_mask:0xf
    s_mov_b64 vcc, s[50:51]
    s_mov_b64 exec, s[50:51]
    s_cbranch_scc0 L2_d130
    s_mov_b64 exec, s[82:83]
    s_nop 1
    v_mfma_f32_4x4x4_16b_bf16 v[88:91], v[12:13], v[84:85], 0
    s_nop 1
    v_mfma_f32_4x4x4_16b_bf16 v[88:91], v[10:11], v[86:87], v[88:91]
    s_nop 4
    v_cvt_pk_bf16_f32 v88, v88, v89
    v_cvt_pk_bf16_f32 v89, v90, v91
    ds_pk_add_bf16 v7, v88 offset:65408
    ds_pk_add_bf16 v7, v89 offset:65412
    s_mov_b64 exec, vcc
    s_branch L2_d130
L2_c131:
    s_mov_b64 s[50:51], vcc
    s_lshl_b64 s[52:53], s[82:83], 1
    s_andn2_b64 s[52:53], s[52:53], s[80:81]
    s_andn2_b64 s[52:53], s[52:53], s[50:51]
    s_or_b64 s[80:81], s[80:81], s[52:53]
    s_not_b64 vcc, s[52:53]
    s_mov_b64 exec, -1
    v_cndmask_b32_dpp v84, v84, v84, vcc wave_shr:1 row_mask:0xf bank_mask:0xf
    v_cndmask_b32_dpp v85, v85, v85, vcc wave_shr:1 row_mask:0xf bank_mask:0xf
    s_lshr_b64 s[52:53], s[52:53], 1
    v_cndmask_b32_dpp v86, v86, v86, vcc wave_shr:1 row_mask:0xf bank_mask:0xf
    v_cndmask_b32_dpp v87, v87, v87, vcc wave_shr:1 row_mask:0xf bank_mask:0xf
    s_andn2_b64 s[82:83], s[82:83], s[52:53]
    v_cndmask_b32_dpp v7, v7, v7, vcc wave_shr:1 row_mask:0xf bank_mask:0xf
    s_mov_b64 vcc, s[50:51]
    s_mov_b64 exec, s[50:51]
    s_cbranch_scc0 L2_d131
    s_mov_b64 exec, s[82:83]
    s_nop 1
    v_mfma_f32_4x4x4_16b_bf16 v[88:91], v[12:13], v[84:85], 0
    s_nop 1
    v_mfma_f32_4x4x4_16b_bf16 v[88:91], v[10:11], v[86:87], v[88:91]
    s_nop 4
    v_cvt_pk_bf16_f32 v88, v88, v89
    v_cvt_pk_bf16_f32 v89, v90, v91
    ds_pk_add_bf16 v7, v88 offset:65408
    ds_pk_add_bf16 v7, v89 offset:65412
    s_mov_b64 exec, vcc
    s_branch L2_d131
L2_c132:
    s_mov_b64 s[50:51], vcc
    s_lshl_b64 s[52:53], s[82:83], 1
    s_andn2_b64 s[52:53], s[52:53], s[80:81]
    s_andn2_b64 s[52:53], s[52:53], s[50:51]
    s_or_b64 s[80:81], s[80:81], s[52:53]
    s_not_b64 vcc, s[52:53]
    s_mov_b64 exec, -1
    v_cndmask_b32_dpp v84, v84, v84, vcc wave_shr:1 row_mask:0xf bank_mask:0xf
    v_cndmask_b32_dpp v85, v85, v85, vcc wave_shr:1 row_mask:0xf bank_mask:0xf
    s_lshr_b64 s[52:53], s[52:53], 1
    v_cndmask_b32_dpp v86, v86, v86, vcc wave_shr:1 row_mask:0xf bank_mask:0xf
    v_cndmask_b32_dpp v87, v87, v87, vcc wave_shr:1 row_mask:0xf bank_mask:0xf
    s_andn2_b64 s[82:83], s[82:83], s[52:53]
    v_cndmask_b32_dpp v7, v7, v7, vcc wave_shr:1 row_mask:0xf bank_mask:0xf
    s_mov_b64 vcc, s[50:51]
    s_mov_b64 exec, s[50:51]
    s_cbranch_scc0 L2_d132
    s_mov_b64 exec, s[82:83]
    s_nop 1
    v_mfma_f32_4x4x4_16b_bf16 v[88:91], v[12:13], v[84:85], 0
    s_nop 1
    v_mfma_f32_4x4x4_16b_bf16 v[88:91], v[10:11], v[86:87], v[88:91]
    s_nop 4
    v_cvt_pk_bf16_f32 v88, v88, v89
    v_cvt_pk_bf16_f32 v89, v90, v91
    ds_pk_add_bf16 v7, v88 offset:65408
    ds_pk_add_bf16 v7, v89 offset:65412
    s_mov_b64 exec, vcc
    s_branch L2_d132
L2_c133:
    s_mov_b64 s[50:51], vcc
    s_lshl_b64 s[52:53], s[82:83], 1
    s_andn2_b64 s[52:53], s[52:53], s[80:81]
    s_andn2_b64 s[52:53], s[52:53], s[50:51]
    s_or_b64 s[80:81], s[80:81], s[52:53]
    s_not_b64 vcc, s[52:53]
    s_mov_b64 exec, -1
    v_cndmask_b32_dpp v84, v84, v84, vcc wave_shr:1 row_mask:0xf bank_mask:0xf
    v_cndmask_b32_dpp v85, v85, v85, vcc wave_shr:1 row_mask:0xf bank_mask:0xf
    s_lshr_b64 s[52:53], s[52:53], 1
    v_cndmask_b32_dpp v86, v86, v86, vcc wave_shr:1 row_mask:0xf bank_mask:0xf
    v_cndmask_b32_dpp v87, v87, v87, vcc wave_shr:1 row_mask:0xf bank_mask:0xf
    s_andn2_b64 s[82:83], s[82:83], s[52:53]
    v_cndmask_b32_dpp v7, v7, v7, vcc wave_shr:1 row_mask:0xf bank_mask:0xf
    s_mov_b64 vcc, s[50:51]
    s_mov_b64 exec, s[50:51]
    s_cbranch_scc0 L2_d133
    s_mov_b64 exec, s[82:83]
    s_nop 1
    v_mfma_f32_4x4x4_16b_bf16 v[88:91], v[12:13], v[84:85], 0
    s_nop 1
    v_mfma_f32_4x4x4_16b_bf16 v[88:91], v[10:11], v[86:87], v[88:91]
    s_nop 4
    v_cvt_pk_bf16_f32 v88, v88, v89
    v_cvt_pk_bf16_f32 v89, v90, v91
    ds_pk_add_bf16 v7, v88 offset:65408
    ds_pk_add_bf16 v7, v89 offset:65412
    s_mov_b64 exec, vcc
    s_branch L2_d133
L2_c134:
    s_mov_b64 s[50:51], vcc
    s_lshl_b64 s[52:53], s[82:83], 1
    s_andn2_b64 s[52:53], s[52:53], s[80:81]
    s_andn2_b64 s[52:53], s[52:53], s[50:51]
    s_or_b64 s[80:81], s[80:81], s[52:53]
    s_not_b64 vcc, s[52:53]
    s_mov_b64 exec, -1
    v_cndmask_b32_dpp v84, v84, v84, vcc wave_shr:1 row_mask:0xf bank_mask:0xf
    v_cndmask_b32_dpp v85, v85, v85, vcc wave_shr:1 row_mask:0xf bank_mask:0xf
    s_lshr_b64 s[52:53], s[52:53], 1
    v_cndmask_b32_dpp v86, v86, v86, vcc wave_shr:1 row_mask:0xf bank_mask:0xf
    v_cndmask_b32_dpp v87, v87, v87, vcc wave_shr:1 row_mask:0xf bank_mask:0xf
    s_andn2_b64 s[82:83], s[82:83], s[52:53]
    v_cndmask_b32_dpp v7, v7, v7, vcc wave_shr:1 row_mask:0xf bank_mask:0xf
    s_mov_b64 vcc, s[50:51]
    s_mov_b64 exec, s[50:51]
    s_cbranch_scc0 L2_d134
    s_mov_b64 exec, s[82:83]
    s_nop 1
    v_mfma_f32_4x4x4_16b_bf16 v[88:91], v[12:13], v[84:85], 0
    s_nop 1
    v_mfma_f32_4x4x4_16b_bf16 v[88:91], v[10:11], v[86:87], v[88:91]
    s_nop 4
    v_cvt_pk_bf16_f32 v88, v88, v89
    v_cvt_pk_bf16_f32 v89, v90, v91
    ds_pk_add_bf16 v7, v88 offset:65408
    ds_pk_add_bf16 v7, v89 offset:65412
    s_mov_b64 exec, vcc
    s_branch L2_d134
L2_c135:
    s_mov_b64 s[50:51], vcc
    s_lshl_b64 s[52:53], s[82:83], 1
    s_andn2_b64 s[52:53], s[52:53], s[80:81]
    s_andn2_b64 s[52:53], s[52:53], s[50:51]
    s_or_b64 s[80:81], s[80:81], s[52:53]
    s_not_b64 vcc, s[52:53]
    s_mov_b64 exec, -1
    v_cndmask_b32_dpp v84, v84, v84, vcc wave_shr:1 row_mask:0xf bank_mask:0xf
    v_cndmask_b32_dpp v85, v85, v85, vcc wave_shr:1 row_mask:0xf bank_mask:0xf
    s_lshr_b64 s[52:53], s[52:53], 1
    v_cndmask_b32_dpp v86, v86, v86, vcc wave_shr:1 row_mask:0xf bank_mask:0xf
    v_cndmask_b32_dpp v87, v87, v87, vcc wave_shr:1 row_mask:0xf bank_mask:0xf
    s_andn2_b64 s[82:83], s[82:83], s[52:53]
    v_cndmask_b32_dpp v7, v7, v7, vcc wave_shr:1 row_mask:0xf bank_mask:0xf
    s_mov_b64 vcc, s[50:51]
    s_mov_b64 exec, s[50:51]
    s_cbranch_scc0 L2_d135
    s_mov_b64 exec, s[82:83]
    s_nop 1
    v_mfma_f32_4x4x4_16b_bf16 v[88:91], v[12:13], v[84:85], 0
    s_nop 1
    v_mfma_f32_4x4x4_16b_bf16 v[88:91], v[10:11], v[86:87], v[88:91]
    s_nop 4
    v_cvt_pk_bf16_f32 v88, v88, v89
    v_cvt_pk_bf16_f32 v89, v90, v91
    ds_pk_add_bf16 v7, v88 offset:65408
    ds_pk_add_bf16 v7, v89 offset:65412
    s_mov_b64 exec, vcc
    s_branch L2_d135
L2_c136:
    s_mov_b64 s[50:51], vcc
    s_lshl_b64 s[52:53], s[82:83], 1
    s_andn2_b64 s[52:53], s[52:53], s[80:81]
    s_andn2_b64 s[52:53], s[52:53], s[50:51]
    s_or_b64 s[80:81], s[80:81], s[52:53]
    s_not_b64 vcc, s[52:53]
    s_mov_b64 exec, -1
    v_cndmask_b32_dpp v84, v84, v84, vcc wave_shr:1 row_mask:0xf bank_mask:0xf
    v_cndmask_b32_dpp v85, v85, v85, vcc wave_shr:1 row_mask:0xf bank_mask:0xf
    s_lshr_b64 s[52:53], s[52:53], 1
    v_cndmask_b32_dpp v86, v86, v86, vcc wave_shr:1 row_mask:0xf bank_mask:0xf
    v_cndmask_b32_dpp v87, v87, v87, vcc wave_shr:1 row_mask:0xf bank_mask:0xf
    s_andn2_b64 s[82:83], s[82:83], s[52:53]
    v_cndmask_b32_dpp v7, v7, v7, vcc wave_shr:1 row_mask:0xf bank_mask:0xf
    s_mov_b64 vcc, s[50:51]
    s_mov_b64 exec, s[50:51]
    s_cbranch_scc0 L2_d136
    s_mov_b64 exec, s[82:83]
    s_nop 1
    v_mfma_f32_4x4x4_16b_bf16 v[88:91], v[12:13], v[84:85], 0
    s_nop 1
    v_mfma_f32_4x4x4_16b_bf16 v[88:91], v[10:11], v[86:87], v[88:91]
    s_nop 4
    v_cvt_pk_bf16_f32 v88, v88, v89
    v_cvt_pk_bf16_f32 v89, v90, v91
    ds_pk_add_bf16 v7, v88 offset:65408
    ds_pk_add_bf16 v7, v89 offset:65412
    s_mov_b64 exec, vcc
    s_branch L2_d136
L2_c137:
    s_mov_b64 s[50:51], vcc
    s_lshl_b64 s[52:53], s[82:83], 1
    s_andn2_b64 s[52:53], s[52:53], s[80:81]
    s_andn2_b64 s[52:53], s[52:53], s[50:51]
    s_or_b64 s[80:81], s[80:81], s[52:53]
    s_not_b64 vcc, s[52:53]
    s_mov_b64 exec, -1
    v_cndmask_b32_dpp v84, v84, v84, vcc wave_shr:1 row_mask:0xf bank_mask:0xf
    v_cndmask_b32_dpp v85, v85, v85, vcc wave_shr:1 row_mask:0xf bank_mask:0xf
    s_lshr_b64 s[52:53], s[52:53], 1
    v_cndmask_b32_dpp v86, v86, v86, vcc wave_shr:1 row_mask:0xf bank_mask:0xf
    v_cndmask_b32_dpp v87, v87, v87, vcc wave_shr:1 row_mask:0xf bank_mask:0xf
    s_andn2_b64 s[82:83], s[82:83], s[52:53]
    v_cndmask_b32_dpp v7, v7, v7, vcc wave_shr:1 row_mask:0xf bank_mask:0xf
    s_mov_b64 vcc, s[50:51]
    s_mov_b64 exec, s[50:51]
    s_cbranch_scc0 L2_d137
    s_mov_b64 exec, s[82:83]
    s_nop 1
    v_mfma_f32_4x4x4_16b_bf16 v[88:91], v[12:13], v[84:85], 0
    s_nop 1
    v_mfma_f32_4x4x4_16b_bf16 v[88:91], v[10:11], v[86:87], v[88:91]
    s_nop 4
    v_cvt_pk_bf16_f32 v88, v88, v89
    v_cvt_pk_bf16_f32 v89, v90, v91
    ds_pk_add_bf16 v7, v88 offset:65408
    ds_pk_add_bf16 v7, v89 offset:65412
    s_mov_b64 exec, vcc
    s_branch L2_d137
L2_c138:
    s_mov_b64 s[50:51], vcc
    s_lshl_b64 s[52:53], s[82:83], 1
    s_andn2_b64 s[52:53], s[52:53], s[80:81]
    s_andn2_b64 s[52:53], s[52:53], s[50:51]
    s_or_b64 s[80:81], s[80:81], s[52:53]
    s_not_b64 vcc, s[52:53]
    s_mov_b64 exec, -1
    v_cndmask_b32_dpp v84, v84, v84, vcc wave_shr:1 row_mask:0xf bank_mask:0xf
    v_cndmask_b32_dpp v85, v85, v85, vcc wave_shr:1 row_mask:0xf bank_mask:0xf
    s_lshr_b64 s[52:53], s[52:53], 1
    v_cndmask_b32_dpp v86, v86, v86, vcc wave_shr:1 row_mask:0xf bank_mask:0xf
    v_cndmask_b32_dpp v87, v87, v87, vcc wave_shr:1 row_mask:0xf bank_mask:0xf
    s_andn2_b64 s[82:83], s[82:83], s[52:53]
    v_cndmask_b32_dpp v7, v7, v7, vcc wave_shr:1 row_mask:0xf bank_mask:0xf
    s_mov_b64 vcc, s[50:51]
    s_mov_b64 exec, s[50:51]
    s_cbranch_scc0 L2_d138
    s_mov_b64 exec, s[82:83]
    s_nop 1
    v_mfma_f32_4x4x4_16b_bf16 v[88:91], v[12:13], v[84:85], 0
    s_nop 1
    v_mfma_f32_4x4x4_16b_bf16 v[88:91], v[10:11], v[86:87], v[88:91]
    s_nop 4
    v_cvt_pk_bf16_f32 v88, v88, v89
    v_cvt_pk_bf16_f32 v89, v90, v91
    ds_pk_add_bf16 v7, v88 offset:65408
    ds_pk_add_bf16 v7, v89 offset:65412
    s_mov_b64 exec, vcc
    s_branch L2_d138
L2_c139:
    s_mov_b64 s[50:51], vcc
    s_lshl_b64 s[52:53], s[82:83], 1
    s_andn2_b64 s[52:53], s[52:53], s[80:81]
    s_andn2_b64 s[52:53], s[52:53], s[50:51]
    s_or_b64 s[80:81], s[80:81], s[52:53]
    s_not_b64 vcc, s[52:53]
    s_mov_b64 exec, -1
    v_cndmask_b32_dpp v84, v84, v84, vcc wave_shr:1 row_mask:0xf bank_mask:0xf
    v_cndmask_b32_dpp v85, v85, v85, vcc wave_shr:1 row_mask:0xf bank_mask:0xf
    s_lshr_b64 s[52:53], s[52:53], 1
    v_cndmask_b32_dpp v86, v86, v86, vcc wave_shr:1 row_mask:0xf bank_mask:0xf
    v_cndmask_b32_dpp v87, v87, v87, vcc wave_shr:1 row_mask:0xf bank_mask:0xf
    s_andn2_b64 s[82:83], s[82:83], s[52:53]
    v_cndmask_b32_dpp v7, v7, v7, vcc wave_shr:1 row_mask:0xf bank_mask:0xf
    s_mov_b64 vcc, s[50:51]
    s_mov_b64 exec, s[50:51]
    s_cbranch_scc0 L2_d139
    s_mov_b64 exec, s[82:83]
    s_nop 1
    v_mfma_f32_4x4x4_16b_bf16 v[88:91], v[12:13], v[84:85], 0
    s_nop 1
    v_mfma_f32_4x4x4_16b_bf16 v[88:91], v[10:11], v[86:87], v[88:91]
    s_nop 4
    v_cvt_pk_bf16_f32 v88, v88, v89
    v_cvt_pk_bf16_f32 v89, v90, v91
    ds_pk_add_bf16 v7, v88 offset:65408
    ds_pk_add_bf16 v7, v89 offset:65412
    s_mov_b64 exec, vcc
    s_branch L2_d139
L2_c140:
    s_mov_b64 s[50:51], vcc
    s_lshl_b64 s[52:53], s[82:83], 1
    s_andn2_b64 s[52:53], s[52:53], s[80:81]
    s_andn2_b64 s[52:53], s[52:53], s[50:51]
    s_or_b64 s[80:81], s[80:81], s[52:53]
    s_not_b64 vcc, s[52:53]
    s_mov_b64 exec, -1
    v_cndmask_b32_dpp v84, v84, v84, vcc wave_shr:1 row_mask:0xf bank_mask:0xf
    v_cndmask_b32_dpp v85, v85, v85, vcc wave_shr:1 row_mask:0xf bank_mask:0xf
    s_lshr_b64 s[52:53], s[52:53], 1
    v_cndmask_b32_dpp v86, v86, v86, vcc wave_shr:1 row_mask:0xf bank_mask:0xf
    v_cndmask_b32_dpp v87, v87, v87, vcc wave_shr:1 row_mask:0xf bank_mask:0xf
    s_andn2_b64 s[82:83], s[82:83], s[52:53]
    v_cndmask_b32_dpp v7, v7, v7, vcc wave_shr:1 row_mask:0xf bank_mask:0xf
    s_mov_b64 vcc, s[50:51]
    s_mov_b64 exec, s[50:51]
    s_cbranch_scc0 L2_d140
    s_mov_b64 exec, s[82:83]
    s_nop 1
    v_mfma_f32_4x4x4_16b_bf16 v[88:91], v[12:13], v[84:85], 0
    s_nop 1
    v_mfma_f32_4x4x4_16b_bf16 v[88:91], v[10:11], v[86:87], v[88:91]
    s_nop 4
    v_cvt_pk_bf16_f32 v88, v88, v89
    v_cvt_pk_bf16_f32 v89, v90, v91
    ds_pk_add_bf16 v7, v88 offset:65408
    ds_pk_add_bf16 v7, v89 offset:65412
    s_mov_b64 exec, vcc
    s_branch L2_d140
L2_c141:
    s_mov_b64 s[50:51], vcc
    s_lshl_b64 s[52:53], s[82:83], 1
    s_andn2_b64 s[52:53], s[52:53], s[80:81]
    s_andn2_b64 s[52:53], s[52:53], s[50:51]
    s_or_b64 s[80:81], s[80:81], s[52:53]
    s_not_b64 vcc, s[52:53]
    s_mov_b64 exec, -1
    v_cndmask_b32_dpp v84, v84, v84, vcc wave_shr:1 row_mask:0xf bank_mask:0xf
    v_cndmask_b32_dpp v85, v85, v85, vcc wave_shr:1 row_mask:0xf bank_mask:0xf
    s_lshr_b64 s[52:53], s[52:53], 1
    v_cndmask_b32_dpp v86, v86, v86, vcc wave_shr:1 row_mask:0xf bank_mask:0xf
    v_cndmask_b32_dpp v87, v87, v87, vcc wave_shr:1 row_mask:0xf bank_mask:0xf
    s_andn2_b64 s[82:83], s[82:83], s[52:53]
    v_cndmask_b32_dpp v7, v7, v7, vcc wave_shr:1 row_mask:0xf bank_mask:0xf
    s_mov_b64 vcc, s[50:51]
    s_mov_b64 exec, s[50:51]
    s_cbranch_scc0 L2_d141
    s_mov_b64 exec, s[82:83]
    s_nop 1
    v_mfma_f32_4x4x4_16b_bf16 v[88:91], v[12:13], v[84:85], 0
    s_nop 1
    v_mfma_f32_4x4x4_16b_bf16 v[88:91], v[10:11], v[86:87], v[88:91]
    s_nop 4
    v_cvt_pk_bf16_f32 v88, v88, v89
    v_cvt_pk_bf16_f32 v89, v90, v91
    ds_pk_add_bf16 v7, v88 offset:65408
    ds_pk_add_bf16 v7, v89 offset:65412
    s_mov_b64 exec, vcc
    s_branch L2_d141
L2_c142:
    s_mov_b64 s[50:51], vcc
    s_lshl_b64 s[52:53], s[82:83], 1
    s_andn2_b64 s[52:53], s[52:53], s[80:81]
    s_andn2_b64 s[52:53], s[52:53], s[50:51]
    s_or_b64 s[80:81], s[80:81], s[52:53]
    s_not_b64 vcc, s[52:53]
    s_mov_b64 exec, -1
    v_cndmask_b32_dpp v84, v84, v84, vcc wave_shr:1 row_mask:0xf bank_mask:0xf
    v_cndmask_b32_dpp v85, v85, v85, vcc wave_shr:1 row_mask:0xf bank_mask:0xf
    s_lshr_b64 s[52:53], s[52:53], 1
    v_cndmask_b32_dpp v86, v86, v86, vcc wave_shr:1 row_mask:0xf bank_mask:0xf
    v_cndmask_b32_dpp v87, v87, v87, vcc wave_shr:1 row_mask:0xf bank_mask:0xf
    s_andn2_b64 s[82:83], s[82:83], s[52:53]
    v_cndmask_b32_dpp v7, v7, v7, vcc wave_shr:1 row_mask:0xf bank_mask:0xf
    s_mov_b64 vcc, s[50:51]
    s_mov_b64 exec, s[50:51]
    s_cbranch_scc0 L2_d142
    s_mov_b64 exec, s[82:83]
    s_nop 1
    v_mfma_f32_4x4x4_16b_bf16 v[88:91], v[12:13], v[84:85], 0
    s_nop 1
    v_mfma_f32_4x4x4_16b_bf16 v[88:91], v[10:11], v[86:87], v[88:91]
    s_nop 4
    v_cvt_pk_bf16_f32 v88, v88, v89
    v_cvt_pk_bf16_f32 v89, v90, v91
    ds_pk_add_bf16 v7, v88 offset:65408
    ds_pk_add_bf16 v7, v89 offset:65412
    s_mov_b64 exec, vcc
    s_branch L2_d142
L2_c143:
    s_mov_b64 s[50:51], vcc
    s_lshl_b64 s[52:53], s[82:83], 1
    s_andn2_b64 s[52:53], s[52:53], s[80:81]
    s_andn2_b64 s[52:53], s[52:53], s[50:51]
    s_or_b64 s[80:81], s[80:81], s[52:53]
    s_not_b64 vcc, s[52:53]
    s_mov_b64 exec, -1
    v_cndmask_b32_dpp v84, v84, v84, vcc wave_shr:1 row_mask:0xf bank_mask:0xf
    v_cndmask_b32_dpp v85, v85, v85, vcc wave_shr:1 row_mask:0xf bank_mask:0xf
    s_lshr_b64 s[52:53], s[52:53], 1
    v_cndmask_b32_dpp v86, v86, v86, vcc wave_shr:1 row_mask:0xf bank_mask:0xf
    v_cndmask_b32_dpp v87, v87, v87, vcc wave_shr:1 row_mask:0xf bank_mask:0xf
    s_andn2_b64 s[82:83], s[82:83], s[52:53]
    v_cndmask_b32_dpp v7, v7, v7, vcc wave_shr:1 row_mask:0xf bank_mask:0xf
    s_mov_b64 vcc, s[50:51]
    s_mov_b64 exec, s[50:51]
    s_cbranch_scc0 L2_d143
    s_mov_b64 exec, s[82:83]
    s_nop 1
    v_mfma_f32_4x4x4_16b_bf16 v[88:91], v[12:13], v[84:85], 0
    s_nop 1
    v_mfma_f32_4x4x4_16b_bf16 v[88:91], v[10:11], v[86:87], v[88:91]
    s_nop 4
    v_cvt_pk_bf16_f32 v88, v88, v89
    v_cvt_pk_bf16_f32 v89, v90, v91
    ds_pk_add_bf16 v7, v88 offset:65408
    ds_pk_add_bf16 v7, v89 offset:65412
    s_mov_b64 exec, vcc
    s_branch L2_d143
L2_c144:
    s_mov_b64 s[50:51], vcc
    s_lshl_b64 s[52:53], s[82:83], 1
    s_andn2_b64 s[52:53], s[52:53], s[80:81]
    s_andn2_b64 s[52:53], s[52:53], s[50:51]
    s_or_b64 s[80:81], s[80:81], s[52:53]
    s_not_b64 vcc, s[52:53]
    s_mov_b64 exec, -1
    v_cndmask_b32_dpp v84, v84, v84, vcc wave_shr:1 row_mask:0xf bank_mask:0xf
    v_cndmask_b32_dpp v85, v85, v85, vcc wave_shr:1 row_mask:0xf bank_mask:0xf
    s_lshr_b64 s[52:53], s[52:53], 1
    v_cndmask_b32_dpp v86, v86, v86, vcc wave_shr:1 row_mask:0xf bank_mask:0xf
    v_cndmask_b32_dpp v87, v87, v87, vcc wave_shr:1 row_mask:0xf bank_mask:0xf
    s_andn2_b64 s[82:83], s[82:83], s[52:53]
    v_cndmask_b32_dpp v7, v7, v7, vcc wave_shr:1 row_mask:0xf bank_mask:0xf
    s_mov_b64 vcc, s[50:51]
    s_mov_b64 exec, s[50:51]
    s_cbranch_scc0 L2_d144
    s_mov_b64 exec, s[82:83]
    s_nop 1
    v_mfma_f32_4x4x4_16b_bf16 v[88:91], v[12:13], v[84:85], 0
    s_nop 1
    v_mfma_f32_4x4x4_16b_bf16 v[88:91], v[10:11], v[86:87], v[88:91]
    s_nop 4
    v_cvt_pk_bf16_f32 v88, v88, v89
    v_cvt_pk_bf16_f32 v89, v90, v91
    ds_pk_add_bf16 v7, v88 offset:65408
    ds_pk_add_bf16 v7, v89 offset:65412
    s_mov_b64 exec, vcc
    s_branch L2_d144
L2_c145:
    s_mov_b64 s[50:51], vcc
    s_lshl_b64 s[52:53], s[82:83], 1
    s_andn2_b64 s[52:53], s[52:53], s[80:81]
    s_andn2_b64 s[52:53], s[52:53], s[50:51]
    s_or_b64 s[80:81], s[80:81], s[52:53]
    s_not_b64 vcc, s[52:53]
    s_mov_b64 exec, -1
    v_cndmask_b32_dpp v84, v84, v84, vcc wave_shr:1 row_mask:0xf bank_mask:0xf
    v_cndmask_b32_dpp v85, v85, v85, vcc wave_shr:1 row_mask:0xf bank_mask:0xf
    s_lshr_b64 s[52:53], s[52:53], 1
    v_cndmask_b32_dpp v86, v86, v86, vcc wave_shr:1 row_mask:0xf bank_mask:0xf
    v_cndmask_b32_dpp v87, v87, v87, vcc wave_shr:1 row_mask:0xf bank_mask:0xf
    s_andn2_b64 s[82:83], s[82:83], s[52:53]
    v_cndmask_b32_dpp v7, v7, v7, vcc wave_shr:1 row_mask:0xf bank_mask:0xf
    s_mov_b64 vcc, s[50:51]
    s_mov_b64 exec, s[50:51]
    s_cbranch_scc0 L2_d145
    s_mov_b64 exec, s[82:83]
    s_nop 1
    v_mfma_f32_4x4x4_16b_bf16 v[88:91], v[12:13], v[84:85], 0
    s_nop 1
    v_mfma_f32_4x4x4_16b_bf16 v[88:91], v[10:11], v[86:87], v[88:91]
    s_nop 4
    v_cvt_pk_bf16_f32 v88, v88, v89
    v_cvt_pk_bf16_f32 v89, v90, v91
    ds_pk_add_bf16 v7, v88 offset:65408
    ds_pk_add_bf16 v7, v89 offset:65412
    s_mov_b64 exec, vcc
    s_branch L2_d145
L2_c146:
    s_mov_b64 s[50:51], vcc
    s_lshl_b64 s[52:53], s[82:83], 1
    s_andn2_b64 s[52:53], s[52:53], s[80:81]
    s_andn2_b64 s[52:53], s[52:53], s[50:51]
    s_or_b64 s[80:81], s[80:81], s[52:53]
    s_not_b64 vcc, s[52:53]
    s_mov_b64 exec, -1
    v_cndmask_b32_dpp v84, v84, v84, vcc wave_shr:1 row_mask:0xf bank_mask:0xf
    v_cndmask_b32_dpp v85, v85, v85, vcc wave_shr:1 row_mask:0xf bank_mask:0xf
    s_lshr_b64 s[52:53], s[52:53], 1
    v_cndmask_b32_dpp v86, v86, v86, vcc wave_shr:1 row_mask:0xf bank_mask:0xf
    v_cndmask_b32_dpp v87, v87, v87, vcc wave_shr:1 row_mask:0xf bank_mask:0xf
    s_andn2_b64 s[82:83], s[82:83], s[52:53]
    v_cndmask_b32_dpp v7, v7, v7, vcc wave_shr:1 row_mask:0xf bank_mask:0xf
    s_mov_b64 vcc, s[50:51]
    s_mov_b64 exec, s[50:51]
    s_cbranch_scc0 L2_d146
    s_mov_b64 exec, s[82:83]
    s_nop 1
    v_mfma_f32_4x4x4_16b_bf16 v[88:91], v[12:13], v[84:85], 0
    s_nop 1
    v_mfma_f32_4x4x4_16b_bf16 v[88:91], v[10:11], v[86:87], v[88:91]
    s_nop 4
    v_cvt_pk_bf16_f32 v88, v88, v89
    v_cvt_pk_bf16_f32 v89, v90, v91
    ds_pk_add_bf16 v7, v88 offset:65408
    ds_pk_add_bf16 v7, v89 offset:65412
    s_mov_b64 exec, vcc
    s_branch L2_d146
L2_c147:
    s_mov_b64 s[50:51], vcc
    s_lshl_b64 s[52:53], s[82:83], 1
    s_andn2_b64 s[52:53], s[52:53], s[80:81]
    s_andn2_b64 s[52:53], s[52:53], s[50:51]
    s_or_b64 s[80:81], s[80:81], s[52:53]
    s_not_b64 vcc, s[52:53]
    s_mov_b64 exec, -1
    v_cndmask_b32_dpp v84, v84, v84, vcc wave_shr:1 row_mask:0xf bank_mask:0xf
    v_cndmask_b32_dpp v85, v85, v85, vcc wave_shr:1 row_mask:0xf bank_mask:0xf
    s_lshr_b64 s[52:53], s[52:53], 1
    v_cndmask_b32_dpp v86, v86, v86, vcc wave_shr:1 row_mask:0xf bank_mask:0xf
    v_cndmask_b32_dpp v87, v87, v87, vcc wave_shr:1 row_mask:0xf bank_mask:0xf
    s_andn2_b64 s[82:83], s[82:83], s[52:53]
    v_cndmask_b32_dpp v7, v7, v7, vcc wave_shr:1 row_mask:0xf bank_mask:0xf
    s_mov_b64 vcc, s[50:51]
    s_mov_b64 exec, s[50:51]
    s_cbranch_scc0 L2_d147
    s_mov_b64 exec, s[82:83]
    s_nop 1
    v_mfma_f32_4x4x4_16b_bf16 v[88:91], v[12:13], v[84:85], 0
    s_nop 1
    v_mfma_f32_4x4x4_16b_bf16 v[88:91], v[10:11], v[86:87], v[88:91]
    s_nop 4
    v_cvt_pk_bf16_f32 v88, v88, v89
    v_cvt_pk_bf16_f32 v89, v90, v91
    ds_pk_add_bf16 v7, v88 offset:65408
    ds_pk_add_bf16 v7, v89 offset:65412
    s_mov_b64 exec, vcc
    s_branch L2_d147
L2_c148:
    s_mov_b64 s[50:51], vcc
    s_lshl_b64 s[52:53], s[82:83], 1
    s_andn2_b64 s[52:53], s[52:53], s[80:81]
    s_andn2_b64 s[52:53], s[52:53], s[50:51]
    s_or_b64 s[80:81], s[80:81], s[52:53]
    s_not_b64 vcc, s[52:53]
    s_mov_b64 exec, -1
    v_cndmask_b32_dpp v84, v84, v84, vcc wave_shr:1 row_mask:0xf bank_mask:0xf
    v_cndmask_b32_dpp v85, v85, v85, vcc wave_shr:1 row_mask:0xf bank_mask:0xf
    s_lshr_b64 s[52:53], s[52:53], 1
    v_cndmask_b32_dpp v86, v86, v86, vcc wave_shr:1 row_mask:0xf bank_mask:0xf
    v_cndmask_b32_dpp v87, v87, v87, vcc wave_shr:1 row_mask:0xf bank_mask:0xf
    s_andn2_b64 s[82:83], s[82:83], s[52:53]
    v_cndmask_b32_dpp v7, v7, v7, vcc wave_shr:1 row_mask:0xf bank_mask:0xf
    s_mov_b64 vcc, s[50:51]
    s_mov_b64 exec, s[50:51]
    s_cbranch_scc0 L2_d148
    s_mov_b64 exec, s[82:83]
    s_nop 1
    v_mfma_f32_4x4x4_16b_bf16 v[88:91], v[12:13], v[84:85], 0
    s_nop 1
    v_mfma_f32_4x4x4_16b_bf16 v[88:91], v[10:11], v[86:87], v[88:91]
    s_nop 4
    v_cvt_pk_bf16_f32 v88, v88, v89
    v_cvt_pk_bf16_f32 v89, v90, v91
    ds_pk_add_bf16 v7, v88 offset:65408
    ds_pk_add_bf16 v7, v89 offset:65412
    s_mov_b64 exec, vcc
    s_branch L2_d148
L2_c149:
    s_mov_b64 s[50:51], vcc
    s_lshl_b64 s[52:53], s[82:83], 1
    s_andn2_b64 s[52:53], s[52:53], s[80:81]
    s_andn2_b64 s[52:53], s[52:53], s[50:51]
    s_or_b64 s[80:81], s[80:81], s[52:53]
    s_not_b64 vcc, s[52:53]
    s_mov_b64 exec, -1
    v_cndmask_b32_dpp v84, v84, v84, vcc wave_shr:1 row_mask:0xf bank_mask:0xf
    v_cndmask_b32_dpp v85, v85, v85, vcc wave_shr:1 row_mask:0xf bank_mask:0xf
    s_lshr_b64 s[52:53], s[52:53], 1
    v_cndmask_b32_dpp v86, v86, v86, vcc wave_shr:1 row_mask:0xf bank_mask:0xf
    v_cndmask_b32_dpp v87, v87, v87, vcc wave_shr:1 row_mask:0xf bank_mask:0xf
    s_andn2_b64 s[82:83], s[82:83], s[52:53]
    v_cndmask_b32_dpp v7, v7, v7, vcc wave_shr:1 row_mask:0xf bank_mask:0xf
    s_mov_b64 vcc, s[50:51]
    s_mov_b64 exec, s[50:51]
    s_cbranch_scc0 L2_d149
    s_mov_b64 exec, s[82:83]
    s_nop 1
    v_mfma_f32_4x4x4_16b_bf16 v[88:91], v[12:13], v[84:85], 0
    s_nop 1
    v_mfma_f32_4x4x4_16b_bf16 v[88:91], v[10:11], v[86:87], v[88:91]
    s_nop 4
    v_cvt_pk_bf16_f32 v88, v88, v89
    v_cvt_pk_bf16_f32 v89, v90, v91
    ds_pk_add_bf16 v7, v88 offset:65408
    ds_pk_add_bf16 v7, v89 offset:65412
    s_mov_b64 exec, vcc
    s_branch L2_d149
L2_c150:
    s_mov_b64 s[50:51], vcc
    s_lshl_b64 s[52:53], s[82:83], 1
    s_andn2_b64 s[52:53], s[52:53], s[80:81]
    s_andn2_b64 s[52:53], s[52:53], s[50:51]
    s_or_b64 s[80:81], s[80:81], s[52:53]
    s_not_b64 vcc, s[52:53]
    s_mov_b64 exec, -1
    v_cndmask_b32_dpp v84, v84, v84, vcc wave_shr:1 row_mask:0xf bank_mask:0xf
    v_cndmask_b32_dpp v85, v85, v85, vcc wave_shr:1 row_mask:0xf bank_mask:0xf
    s_lshr_b64 s[52:53], s[52:53], 1
    v_cndmask_b32_dpp v86, v86, v86, vcc wave_shr:1 row_mask:0xf bank_mask:0xf
    v_cndmask_b32_dpp v87, v87, v87, vcc wave_shr:1 row_mask:0xf bank_mask:0xf
    s_andn2_b64 s[82:83], s[82:83], s[52:53]
    v_cndmask_b32_dpp v7, v7, v7, vcc wave_shr:1 row_mask:0xf bank_mask:0xf
    s_mov_b64 vcc, s[50:51]
    s_mov_b64 exec, s[50:51]
    s_cbranch_scc0 L2_d150
    s_mov_b64 exec, s[82:83]
    s_nop 1
    v_mfma_f32_4x4x4_16b_bf16 v[88:91], v[12:13], v[84:85], 0
    s_nop 1
    v_mfma_f32_4x4x4_16b_bf16 v[88:91], v[10:11], v[86:87], v[88:91]
    s_nop 4
    v_cvt_pk_bf16_f32 v88, v88, v89
    v_cvt_pk_bf16_f32 v89, v90, v91
    ds_pk_add_bf16 v7, v88 offset:65408
    ds_pk_add_bf16 v7, v89 offset:65412
    s_mov_b64 exec, vcc
    s_branch L2_d150
L2_c151:
    s_mov_b64 s[50:51], vcc
    s_lshl_b64 s[52:53], s[82:83], 1
    s_andn2_b64 s[52:53], s[52:53], s[80:81]
    s_andn2_b64 s[52:53], s[52:53], s[50:51]
    s_or_b64 s[80:81], s[80:81], s[52:53]
    s_not_b64 vcc, s[52:53]
    s_mov_b64 exec, -1
    v_cndmask_b32_dpp v84, v84, v84, vcc wave_shr:1 row_mask:0xf bank_mask:0xf
    v_cndmask_b32_dpp v85, v85, v85, vcc wave_shr:1 row_mask:0xf bank_mask:0xf
    s_lshr_b64 s[52:53], s[52:53], 1
    v_cndmask_b32_dpp v86, v86, v86, vcc wave_shr:1 row_mask:0xf bank_mask:0xf
    v_cndmask_b32_dpp v87, v87, v87, vcc wave_shr:1 row_mask:0xf bank_mask:0xf
    s_andn2_b64 s[82:83], s[82:83], s[52:53]
    v_cndmask_b32_dpp v7, v7, v7, vcc wave_shr:1 row_mask:0xf bank_mask:0xf
    s_mov_b64 vcc, s[50:51]
    s_mov_b64 exec, s[50:51]
    s_cbranch_scc0 L2_d151
    s_mov_b64 exec, s[82:83]
    s_nop 1
    v_mfma_f32_4x4x4_16b_bf16 v[88:91], v[12:13], v[84:85], 0
    s_nop 1
    v_mfma_f32_4x4x4_16b_bf16 v[88:91], v[10:11], v[86:87], v[88:91]
    s_nop 4
    v_cvt_pk_bf16_f32 v88, v88, v89
    v_cvt_pk_bf16_f32 v89, v90, v91
    ds_pk_add_bf16 v7, v88 offset:65408
    ds_pk_add_bf16 v7, v89 offset:65412
    s_mov_b64 exec, vcc
    s_branch L2_d151
L2_c152:
    s_mov_b64 s[50:51], vcc
    s_lshl_b64 s[52:53], s[82:83], 1
    s_andn2_b64 s[52:53], s[52:53], s[80:81]
    s_andn2_b64 s[52:53], s[52:53], s[50:51]
    s_or_b64 s[80:81], s[80:81], s[52:53]
    s_not_b64 vcc, s[52:53]
    s_mov_b64 exec, -1
    v_cndmask_b32_dpp v84, v84, v84, vcc wave_shr:1 row_mask:0xf bank_mask:0xf
    v_cndmask_b32_dpp v85, v85, v85, vcc wave_shr:1 row_mask:0xf bank_mask:0xf
    s_lshr_b64 s[52:53], s[52:53], 1
    v_cndmask_b32_dpp v86, v86, v86, vcc wave_shr:1 row_mask:0xf bank_mask:0xf
    v_cndmask_b32_dpp v87, v87, v87, vcc wave_shr:1 row_mask:0xf bank_mask:0xf
    s_andn2_b64 s[82:83], s[82:83], s[52:53]
    v_cndmask_b32_dpp v7, v7, v7, vcc wave_shr:1 row_mask:0xf bank_mask:0xf
    s_mov_b64 vcc, s[50:51]
    s_mov_b64 exec, s[50:51]
    s_cbranch_scc0 L2_d152
    s_mov_b64 exec, s[82:83]
    s_nop 1
    v_mfma_f32_4x4x4_16b_bf16 v[88:91], v[12:13], v[84:85], 0
    s_nop 1
    v_mfma_f32_4x4x4_16b_bf16 v[88:91], v[10:11], v[86:87], v[88:91]
    s_nop 4
    v_cvt_pk_bf16_f32 v88, v88, v89
    v_cvt_pk_bf16_f32 v89, v90, v91
    ds_pk_add_bf16 v7, v88 offset:65408
    ds_pk_add_bf16 v7, v89 offset:65412
    s_mov_b64 exec, vcc
    s_branch L2_d152
L2_c153:
    s_mov_b64 s[50:51], vcc
    s_lshl_b64 s[52:53], s[82:83], 1
    s_andn2_b64 s[52:53], s[52:53], s[80:81]
    s_andn2_b64 s[52:53], s[52:53], s[50:51]
    s_or_b64 s[80:81], s[80:81], s[52:53]
    s_not_b64 vcc, s[52:53]
    s_mov_b64 exec, -1
    v_cndmask_b32_dpp v84, v84, v84, vcc wave_shr:1 row_mask:0xf bank_mask:0xf
    v_cndmask_b32_dpp v85, v85, v85, vcc wave_shr:1 row_mask:0xf bank_mask:0xf
    s_lshr_b64 s[52:53], s[52:53], 1
    v_cndmask_b32_dpp v86, v86, v86, vcc wave_shr:1 row_mask:0xf bank_mask:0xf
    v_cndmask_b32_dpp v87, v87, v87, vcc wave_shr:1 row_mask:0xf bank_mask:0xf
    s_andn2_b64 s[82:83], s[82:83], s[52:53]
    v_cndmask_b32_dpp v7, v7, v7, vcc wave_shr:1 row_mask:0xf bank_mask:0xf
    s_mov_b64 vcc, s[50:51]
    s_mov_b64 exec, s[50:51]
    s_cbranch_scc0 L2_d153
    s_mov_b64 exec, s[82:83]
    s_nop 1
    v_mfma_f32_4x4x4_16b_bf16 v[88:91], v[12:13], v[84:85], 0
    s_nop 1
    v_mfma_f32_4x4x4_16b_bf16 v[88:91], v[10:11], v[86:87], v[88:91]
    s_nop 4
    v_cvt_pk_bf16_f32 v88, v88, v89
    v_cvt_pk_bf16_f32 v89, v90, v91
    ds_pk_add_bf16 v7, v88 offset:65408
    ds_pk_add_bf16 v7, v89 offset:65412
    s_mov_b64 exec, vcc
    s_branch L2_d153
.section .rodata,"a"
.p2align 6
.amdhsa_kernel gather_scatter__molecular_angular_gemnet__graph_kernel
  .amdhsa_next_free_vgpr 128
  .amdhsa_next_free_sgpr 102
  .amdhsa_accum_offset 128
  .amdhsa_group_segment_fixed_size 0
  .amdhsa_kernarg_size 112
  .amdhsa_user_sgpr_count 2
  .amdhsa_user_sgpr_kernarg_segment_ptr 1
  .amdhsa_system_sgpr_workgroup_id_x 1
  .amdhsa_float_denorm_mode_32 3
.end_amdhsa_kernel
```

```asm
; @launch grid=(256,1,1) block=(1024,1,1) lds=163840
.amdgcn_target "amdgcn-amd-amdhsa--gfx950"
.text
.globl gather_scatter__molecular_angular_gemnet__graph_kernel
.p2align 8
.type gather_scatter__molecular_angular_gemnet__graph_kernel,@function
gather_scatter__molecular_angular_gemnet__graph_kernel:
    s_cmp_ge_u32 s2, 256
    s_cbranch_scc0 L1_go
    s_endpgm
L1_go:
    s_load_dwordx4 s[4:7], s[0:1], 8
    s_load_dwordx2 s[28:29], s[0:1], 32
    s_load_dwordx2 s[30:31], s[0:1], 104
    s_load_dwordx2 s[56:57], s[0:1], 96
    s_load_dwordx2 s[86:87], s[0:1], 0
    s_load_dwordx4 s[60:63], s[0:1], 56
    s_load_dwordx4 s[64:67], s[0:1], 72
    v_lshrrev_b32 v7, 6, v0
    v_lshlrev_b32 v1, 3, v0
    v_readfirstlane_b32 s32, v7
    v_lshlrev_b32 v0, 4, v0
    s_mul_i32 s33, s2, 16384
    s_mul_i32 s34, s2, 8192
    s_waitcnt lgkmcnt(0)
    s_mov_b32 s8, s4
    s_mov_b32 s9, s5
    s_mov_b32 s10, 0x9c40000
    s_mov_b32 s11, 0x20000
    s_mov_b32 s12, s6
    s_mov_b32 s13, s7
    s_mov_b32 s14, 0x9c40000
    s_mov_b32 s15, 0x20000
    s_mov_b32 s16, s28
    s_mov_b32 s17, s29
    s_mov_b32 s18, 0x4e20000
    s_mov_b32 s19, 0x20000
    s_mov_b32 s68, s62
    s_mov_b32 s69, s63
    s_mov_b32 s70, 0x40
    s_mov_b32 s71, 0x20000
    s_mov_b32 s72, s60
    s_mov_b32 s73, s61
    s_mov_b32 s74, 0x40
    s_mov_b32 s75, 0x20000
    s_mov_b32 s20, s66
    s_mov_b32 s21, s67
    s_mov_b32 s22, 0x20
    s_mov_b32 s23, 0x20000
    s_mov_b32 s80, s64
    s_mov_b32 s81, s65
    s_mov_b32 s82, 0x20
    s_mov_b32 s83, 0x20000
    s_add_u32 s24, s30, 0xebc9000
    s_addc_u32 s25, s31, 0
    s_mov_b32 s26, 0x100
    s_mov_b32 s27, 0x20000
    v_lshrrev_b32 v2, 3, v0
    v_and_b32 v2, 6, v2
    v_lshlrev_b32 v3, 2, v0
    s_lshl_b32 s3, s32, 8
    s_add_u32 s3, s3, s2
    s_cmp_lg_u32 s3, 254
    s_cbranch_scc1 L1_wt
    buffer_load_ushort v96, v2, s[68:71], 0 offen offset:0
    buffer_load_ushort v108, v2, s[68:71], 0 offen offset:8
    buffer_load_ushort v97, v2, s[68:71], 0 offen offset:16
    buffer_load_ushort v109, v2, s[68:71], 0 offen offset:24
    buffer_load_ushort v98, v2, s[68:71], 0 offen offset:32
    buffer_load_ushort v110, v2, s[68:71], 0 offen offset:40
    buffer_load_ushort v99, v2, s[68:71], 0 offen offset:48
    buffer_load_ushort v111, v2, s[68:71], 0 offen offset:56
    buffer_load_ushort v100, v2, s[72:75], 0 offen offset:0
    buffer_load_ushort v112, v2, s[72:75], 0 offen offset:8
    buffer_load_ushort v101, v2, s[72:75], 0 offen offset:16
    buffer_load_ushort v113, v2, s[72:75], 0 offen offset:24
    buffer_load_ushort v102, v2, s[72:75], 0 offen offset:32
    buffer_load_ushort v114, v2, s[72:75], 0 offen offset:40
    buffer_load_ushort v103, v2, s[72:75], 0 offen offset:48
    buffer_load_ushort v115, v2, s[72:75], 0 offen offset:56
    buffer_load_ushort v104, v2, s[20:23], 0 offen offset:0
    buffer_load_ushort v116, v2, s[20:23], 0 offen offset:8
    buffer_load_ushort v105, v2, s[20:23], 0 offen offset:16
    buffer_load_ushort v117, v2, s[20:23], 0 offen offset:24
    buffer_load_ushort v106, v2, s[80:83], 0 offen offset:0
    buffer_load_ushort v118, v2, s[80:83], 0 offen offset:8
    buffer_load_ushort v107, v2, s[80:83], 0 offen offset:16
    buffer_load_ushort v119, v2, s[80:83], 0 offen offset:24
    s_waitcnt vmcnt(0)
    v_lshl_or_b32 v96, v108, 16, v96
    v_lshl_or_b32 v97, v109, 16, v97
    v_lshl_or_b32 v98, v110, 16, v98
    v_lshl_or_b32 v99, v111, 16, v99
    v_lshl_or_b32 v100, v112, 16, v100
    v_lshl_or_b32 v101, v113, 16, v101
    v_lshl_or_b32 v102, v114, 16, v102
    v_lshl_or_b32 v103, v115, 16, v103
    v_lshl_or_b32 v104, v116, 16, v104
    v_lshl_or_b32 v105, v117, 16, v105
    v_lshl_or_b32 v106, v118, 16, v106
    v_lshl_or_b32 v107, v119, 16, v107
    buffer_store_dwordx4 v[96:99], v3, s[24:27], 0 offen offset:0 sc1
    buffer_store_dwordx4 v[100:103], v3, s[24:27], 0 offen offset:16 sc1
    buffer_store_dwordx4 v[104:107], v3, s[24:27], 0 offen offset:32 sc1
L1_wt:
    s_nop 1
    s_add_u32 s44, s33, 0x0
    buffer_load_dwordx4 v[16:19], v0, s[8:11], s44 offen nt
    s_add_u32 s45, s33, 0x0
    buffer_load_dwordx4 v[20:23], v0, s[12:15], s45 offen nt
    s_add_u32 s46, s34, 0x0
    buffer_load_dwordx2 v[24:25], v1, s[16:19], s46 offen nt
    s_add_u32 s47, s34, 0x200000
    buffer_load_dwordx2 v[26:27], v1, s[16:19], s47 offen nt
    s_add_u32 s44, s33, 0x400000
    buffer_load_dwordx4 v[28:31], v0, s[8:11], s44 offen nt
    s_add_u32 s45, s33, 0x400000
    buffer_load_dwordx4 v[32:35], v0, s[12:15], s45 offen nt
    s_add_u32 s46, s33, 0x800000
    buffer_load_dwordx4 v[36:39], v0, s[8:11], s46 offen nt
    s_add_u32 s47, s33, 0x800000
    buffer_load_dwordx4 v[40:43], v0, s[12:15], s47 offen nt
    s_add_u32 s44, s34, 0x400000
    buffer_load_dwordx2 v[44:45], v1, s[16:19], s44 offen nt
    s_add_u32 s45, s34, 0x600000
    buffer_load_dwordx2 v[46:47], v1, s[16:19], s45 offen nt
    s_mov_b32 s20, s30
    s_mov_b32 s21, s31
    s_mov_b32 s22, 0xd340000
    s_mov_b32 s23, 0x20000
    s_add_u32 s24, s30, 0x28000
    s_addc_u32 s25, s31, 0
    s_mov_b32 s26, 0xd318000
    s_mov_b32 s27, 0x20000
    s_mov_b32 s80, s86
    s_mov_b32 s81, s87
    s_mov_b32 s82, 0x4e2000
    s_mov_b32 s83, 0x20000
    s_mul_i32 s35, s2, 173056
    s_and_b32 s37, s32, 3
    s_lshl_b32 s37, s37, 3
    s_mov_b32 s36, s37
    s_lshr_b32 s37, s32, 2
    s_mul_i32 s37, s37, 2080
    s_add_u32 s36, s36, s37
    s_and_b32 s37, s2, 3
    s_lshl_b32 s37, s37, 5
    s_add_u32 s36, s36, s37
    s_mul_i32 s4, s2, 5
    s_add_u32 s4, s4, 8192
    s_lshl_b32 s38, s4, 14
    s_lshl_b32 s39, s4, 13
    v_mov_b32 v2, 1
    v_mov_b32 v4, 0x80000007
    v_mov_b32 v5, 0xfc
    v_mov_b32 v6, 0x78
    s_mov_b32 s40, 16512
    s_mov_b32 s55, -10000
    s_mov_b32 s41, 0x010c0c01
    s_mov_b32 s42, 0x030c0c03
    v_mov_b32 v8, 0
    v_mov_b32 v9, 0
    v_mov_b32 v10, 0
    v_mov_b32 v11, 0
    ds_write_b128 v0, v[8:11]
    s_add_u32 s60, s30, 0xebd2000
    s_addc_u32 s61, s31, 0
    s_mov_b32 s62, 0x8000
    s_mov_b32 s63, 0x20000
    s_mov_b64 s[66:67], s[56:57]
    s_lshl_b32 s57, s2, 7
    s_add_u32 s68, s30, 0xebca000
    s_addc_u32 s69, s31, 0
    s_mov_b32 s70, 0x80
    s_mov_b32 s71, 0x20000
    s_lshl_b32 s3, s2, 7
    s_add_u32 s68, s68, s3
    s_addc_u32 s69, s69, 0
    s_cmp_lg_u32 s32, 0
    s_cbranch_scc1 L1_fl
    buffer_store_dwordx4 v[8:11], v0, s[68:71], 0 offen sc1
    s_mov_b64 exec, 0xff
    buffer_store_dwordx4 v[8:11], v0, s[60:63], s57 offen sc1
    s_mov_b64 exec, -1
    buffer_inv sc1
L1_fl:
    s_waitcnt lgkmcnt(0)
    s_barrier
    s_setprio 3
    s_add_u32 s46, s33, 0xc00000
    buffer_load_dwordx4 v[48:51], v0, s[8:11], s46 offen nt
    s_add_u32 s47, s33, 0xc00000
    buffer_load_dwordx4 v[52:55], v0, s[12:15], s47 offen nt
    s_waitcnt vmcnt(8)
    v_lshlrev_b32 v7, 16, v24
    v_and_b32 v8, 0xffff0000, v24
    v_lshlrev_b32 v9, 16, v25
    v_and_b32 v10, 0xffff0000, v25
    v_mul_f32 v7, 0.15915494, v7
    v_mul_f32 v8, 0.15915494, v8
    v_mul_f32 v9, 0.15915494, v9
    v_mul_f32 v10, 0.15915494, v10
    v_mul_hi_u32_u24 v14, 429497, v16
    v_lshrrev_b32 v12, 3, v20
    v_cos_f32 v7, v7
    v_lshlrev_b16 v13, 3, v20
    v_mad_i32_i24 v11, v14, s55, v16
    v_bitop3_b32 v12, v6, v13, v12 bitop3:0xca
    v_lshl_add_u32 v11, v11, 17, s40
    v_lshlrev_b16 v14, 8, v14
    v_lshrrev_b32 v13, 2, v20
    v_add_u32 v16, v12, v11
    v_bitop3_b32 v20, v5, v13, v14 bitop3:0xea
    ds_add_u32 v20, v2
    v_mul_hi_u32_u24 v14, 429497, v17
    v_lshrrev_b32 v12, 3, v21
    v_cos_f32 v8, v8
    v_lshlrev_b16 v13, 3, v21
    v_mad_i32_i24 v11, v14, s55, v17
    v_bitop3_b32 v12, v6, v13, v12 bitop3:0xca
    v_lshl_add_u32 v11, v11, 17, s40
    v_lshlrev_b16 v14, 8, v14
    v_lshrrev_b32 v13, 2, v21
    v_add_u32 v17, v12, v11
    v_bitop3_b32 v21, v5, v13, v14 bitop3:0xea
    ds_add_u32 v21, v2
    v_cvt_pk_bf16_f32 v24, v7, v8
    v_perm_b32 v12, v24, v24, s41
    v_bitop3_b32 v16, v4, v12, v16 bitop3:0xca
    v_perm_b32 v13, v24, v24, s42
    v_bitop3_b32 v17, v4, v13, v17 bitop3:0xca
    v_mul_hi_u32_u24 v14, 429497, v18
    v_lshrrev_b32 v12, 3, v22
    v_cos_f32 v9, v9
    v_lshlrev_b16 v13, 3, v22
    v_mad_i32_i24 v11, v14, s55, v18
    v_bitop3_b32 v12, v6, v13, v12 bitop3:0xca
    v_lshl_add_u32 v11, v11, 17, s40
    v_lshlrev_b16 v14, 8, v14
    v_lshrrev_b32 v13, 2, v22
    v_add_u32 v18, v12, v11
    v_bitop3_b32 v22, v5, v13, v14 bitop3:0xea
    ds_add_u32 v22, v2
    v_mul_hi_u32_u24 v14, 429497, v19
    v_lshrrev_b32 v12, 3, v23
    v_cos_f32 v10, v10
    v_lshlrev_b16 v13, 3, v23
    v_mad_i32_i24 v11, v14, s55, v19
    v_bitop3_b32 v12, v6, v13, v12 bitop3:0xca
    v_lshl_add_u32 v11, v11, 17, s40
    v_lshlrev_b16 v14, 8, v14
    v_lshrrev_b32 v13, 2, v23
    v_add_u32 v19, v12, v11
    v_bitop3_b32 v23, v5, v13, v14 bitop3:0xea
    ds_add_u32 v23, v2
    v_cvt_pk_bf16_f32 v25, v9, v10
    v_perm_b32 v12, v25, v25, s41
    v_bitop3_b32 v18, v4, v12, v18 bitop3:0xca
    v_perm_b32 v13, v25, v25, s42
    v_bitop3_b32 v19, v4, v13, v19 bitop3:0xca
    s_add_u32 s44, s33, 0x1000000
    buffer_load_dwordx4 v[56:59], v0, s[8:11], s44 offen nt
    s_add_u32 s45, s33, 0x1000000
    buffer_load_dwordx4 v[60:63], v0, s[12:15], s45 offen nt
    s_add_u32 s46, s34, 0x800000
    buffer_load_dwordx2 v[64:65], v1, s[16:19], s46 offen nt
    s_add_u32 s47, s34, 0xa00000
    buffer_load_dwordx2 v[66:67], v1, s[16:19], s47 offen nt
    s_waitcnt vmcnt(10)
    v_lshlrev_b32 v7, 16, v26
    v_and_b32 v8, 0xffff0000, v26
    v_lshlrev_b32 v9, 16, v27
    v_and_b32 v10, 0xffff0000, v27
    v_mul_f32 v7, 0.15915494, v7
    v_mul_f32 v8, 0.15915494, v8
    v_mul_f32 v9, 0.15915494, v9
    v_mul_f32 v10, 0.15915494, v10
    v_mul_hi_u32_u24 v14, 429497, v28
    v_lshrrev_b32 v12, 3, v32
    v_cos_f32 v7, v7
    v_lshlrev_b16 v13, 3, v32
    v_mad_i32_i24 v11, v14, s55, v28
    v_bitop3_b32 v12, v6, v13, v12 bitop3:0xca
    v_lshl_add_u32 v11, v11, 17, s40
    v_lshlrev_b16 v14, 8, v14
    v_lshrrev_b32 v13, 2, v32
    v_add_u32 v28, v12, v11
    v_bitop3_b32 v32, v5, v13, v14 bitop3:0xea
    ds_add_u32 v32, v2
    v_mul_hi_u32_u24 v14, 429497, v29
    v_lshrrev_b32 v12, 3, v33
    v_cos_f32 v8, v8
    v_lshlrev_b16 v13, 3, v33
    v_mad_i32_i24 v11, v14, s55, v29
    v_bitop3_b32 v12, v6, v13, v12 bitop3:0xca
    v_lshl_add_u32 v11, v11, 17, s40
    v_lshlrev_b16 v14, 8, v14
    v_lshrrev_b32 v13, 2, v33
    v_add_u32 v29, v12, v11
    v_bitop3_b32 v33, v5, v13, v14 bitop3:0xea
    ds_add_u32 v33, v2
    v_cvt_pk_bf16_f32 v26, v7, v8
    v_perm_b32 v12, v26, v26, s41
    v_bitop3_b32 v28, v4, v12, v28 bitop3:0xca
    v_perm_b32 v13, v26, v26, s42
    v_bitop3_b32 v29, v4, v13, v29 bitop3:0xca
    v_mul_hi_u32_u24 v14, 429497, v30
    v_lshrrev_b32 v12, 3, v34
    v_cos_f32 v9, v9
    v_lshlrev_b16 v13, 3, v34
    v_mad_i32_i24 v11, v14, s55, v30
    v_bitop3_b32 v12, v6, v13, v12 bitop3:0xca
    v_lshl_add_u32 v11, v11, 17, s40
    v_lshlrev_b16 v14, 8, v14
    v_lshrrev_b32 v13, 2, v34
    v_add_u32 v30, v12, v11
    v_bitop3_b32 v34, v5, v13, v14 bitop3:0xea
    ds_add_u32 v34, v2
    v_mul_hi_u32_u24 v14, 429497, v31
    v_lshrrev_b32 v12, 3, v35
    v_cos_f32 v10, v10
    v_lshlrev_b16 v13, 3, v35
    v_mad_i32_i24 v11, v14, s55, v31
    v_bitop3_b32 v12, v6, v13, v12 bitop3:0xca
    v_lshl_add_u32 v11, v11, 17, s40
    v_lshlrev_b16 v14, 8, v14
    v_lshrrev_b32 v13, 2, v35
    v_add_u32 v31, v12, v11
    v_bitop3_b32 v35, v5, v13, v14 bitop3:0xea
    ds_add_u32 v35, v2
    v_cvt_pk_bf16_f32 v27, v9, v10
    v_perm_b32 v12, v27, v27, s41
    v_bitop3_b32 v30, v4, v12, v30 bitop3:0xca
    v_perm_b32 v13, v27, v27, s42
    v_bitop3_b32 v31, v4, v13, v31 bitop3:0xca
    s_setprio 2
    s_add_u32 s44, s33, 0x1400000
    buffer_load_dwordx4 v[68:71], v0, s[8:11], s44 offen nt
    s_add_u32 s45, s33, 0x1400000
    buffer_load_dwordx4 v[72:75], v0, s[12:15], s45 offen nt
    s_waitcnt vmcnt(8)
    v_lshlrev_b32 v7, 16, v44
    v_and_b32 v8, 0xffff0000, v44
    v_lshlrev_b32 v9, 16, v45
    v_and_b32 v10, 0xffff0000, v45
    v_mul_f32 v7, 0.15915494, v7
    v_mul_f32 v8, 0.15915494, v8
    v_mul_f32 v9, 0.15915494, v9
    v_mul_f32 v10, 0.15915494, v10
    v_mul_hi_u32_u24 v14, 429497, v36
    v_lshrrev_b32 v12, 3, v40
    v_cos_f32 v7, v7
    v_lshlrev_b16 v13, 3, v40
    v_mad_i32_i24 v11, v14, s55, v36
    v_bitop3_b32 v12, v6, v13, v12 bitop3:0xca
    v_lshl_add_u32 v11, v11, 17, s40
    v_lshlrev_b16 v14, 8, v14
    v_lshrrev_b32 v13, 2, v40
    v_add_u32 v36, v12, v11
    v_bitop3_b32 v40, v5, v13, v14 bitop3:0xea
    ds_add_u32 v40, v2
    v_mul_hi_u32_u24 v14, 429497, v37
    v_lshrrev_b32 v12, 3, v41
    v_cos_f32 v8, v8
    v_lshlrev_b16 v13, 3, v41
    v_mad_i32_i24 v11, v14, s55, v37
    v_bitop3_b32 v12, v6, v13, v12 bitop3:0xca
    v_lshl_add_u32 v11, v11, 17, s40
    v_lshlrev_b16 v14, 8, v14
    v_lshrrev_b32 v13, 2, v41
    v_add_u32 v37, v12, v11
    v_bitop3_b32 v41, v5, v13, v14 bitop3:0xea
    ds_add_u32 v41, v2
    v_cvt_pk_bf16_f32 v44, v7, v8
    v_perm_b32 v12, v44, v44, s41
    v_bitop3_b32 v36, v4, v12, v36 bitop3:0xca
    v_perm_b32 v13, v44, v44, s42
    v_bitop3_b32 v37, v4, v13, v37 bitop3:0xca
    v_mul_hi_u32_u24 v14, 429497, v38
    v_lshrrev_b32 v12, 3, v42
    v_cos_f32 v9, v9
    v_lshlrev_b16 v13, 3, v42
    v_mad_i32_i24 v11, v14, s55, v38
    v_bitop3_b32 v12, v6, v13, v12 bitop3:0xca
    v_lshl_add_u32 v11, v11, 17, s40
    v_lshlrev_b16 v14, 8, v14
    v_lshrrev_b32 v13, 2, v42
    v_add_u32 v38, v12, v11
    v_bitop3_b32 v42, v5, v13, v14 bitop3:0xea
    ds_add_u32 v42, v2
    v_mul_hi_u32_u24 v14, 429497, v39
    v_lshrrev_b32 v12, 3, v43
    v_cos_f32 v10, v10
    v_lshlrev_b16 v13, 3, v43
    v_mad_i32_i24 v11, v14, s55, v39
    v_bitop3_b32 v12, v6, v13, v12 bitop3:0xca
    v_lshl_add_u32 v11, v11, 17, s40
    v_lshlrev_b16 v14, 8, v14
    v_lshrrev_b32 v13, 2, v43
    v_add_u32 v39, v12, v11
    v_bitop3_b32 v43, v5, v13, v14 bitop3:0xea
    ds_add_u32 v43, v2
    v_cvt_pk_bf16_f32 v45, v9, v10
    v_perm_b32 v12, v45, v45, s41
    v_bitop3_b32 v38, v4, v12, v38 bitop3:0xca
    v_perm_b32 v13, v45, v45, s42
    v_bitop3_b32 v39, v4, v13, v39 bitop3:0xca
    s_add_u32 s46, s33, 0x1800000
    buffer_load_dwordx4 v[76:79], v0, s[8:11], s46 offen nt
    s_add_u32 s47, s33, 0x1800000
    buffer_load_dwordx4 v[80:83], v0, s[12:15], s47 offen nt
    s_add_u32 s44, s34, 0xc00000
    buffer_load_dwordx2 v[84:85], v1, s[16:19], s44 offen nt
    s_add_u32 s45, s34, 0xe00000
    buffer_load_dwordx2 v[86:87], v1, s[16:19], s45 offen nt
    s_waitcnt vmcnt(10)
    v_lshlrev_b32 v7, 16, v46
    v_and_b32 v8, 0xffff0000, v46
    v_lshlrev_b32 v9, 16, v47
    v_and_b32 v10, 0xffff0000, v47
    v_mul_f32 v7, 0.15915494, v7
    v_mul_f32 v8, 0.15915494, v8
    v_mul_f32 v9, 0.15915494, v9
    v_mul_f32 v10, 0.15915494, v10
    v_mul_hi_u32_u24 v14, 429497, v48
    v_lshrrev_b32 v12, 3, v52
    v_cos_f32 v7, v7
    v_lshlrev_b16 v13, 3, v52
    v_mad_i32_i24 v11, v14, s55, v48
    v_bitop3_b32 v12, v6, v13, v12 bitop3:0xca
    v_lshl_add_u32 v11, v11, 17, s40
    v_lshlrev_b16 v14, 8, v14
    v_lshrrev_b32 v13, 2, v52
    v_add_u32 v48, v12, v11
    v_bitop3_b32 v52, v5, v13, v14 bitop3:0xea
    ds_add_u32 v52, v2
    v_mul_hi_u32_u24 v14, 429497, v49
    v_lshrrev_b32 v12, 3, v53
    v_cos_f32 v8, v8
    v_lshlrev_b16 v13, 3, v53
    v_mad_i32_i24 v11, v14, s55, v49
    v_bitop3_b32 v12, v6, v13, v12 bitop3:0xca
    v_lshl_add_u32 v11, v11, 17, s40
    v_lshlrev_b16 v14, 8, v14
    v_lshrrev_b32 v13, 2, v53
    v_add_u32 v49, v12, v11
    v_bitop3_b32 v53, v5, v13, v14 bitop3:0xea
    ds_add_u32 v53, v2
    v_cvt_pk_bf16_f32 v46, v7, v8
    v_perm_b32 v12, v46, v46, s41
    v_bitop3_b32 v48, v4, v12, v48 bitop3:0xca
    v_perm_b32 v13, v46, v46, s42
    v_bitop3_b32 v49, v4, v13, v49 bitop3:0xca
    v_mul_hi_u32_u24 v14, 429497, v50
    v_lshrrev_b32 v12, 3, v54
    v_cos_f32 v9, v9
    v_lshlrev_b16 v13, 3, v54
    v_mad_i32_i24 v11, v14, s55, v50
    v_bitop3_b32 v12, v6, v13, v12 bitop3:0xca
    v_lshl_add_u32 v11, v11, 17, s40
    v_lshlrev_b16 v14, 8, v14
    v_lshrrev_b32 v13, 2, v54
    v_add_u32 v50, v12, v11
    v_bitop3_b32 v54, v5, v13, v14 bitop3:0xea
    ds_add_u32 v54, v2
    v_mul_hi_u32_u24 v14, 429497, v51
    v_lshrrev_b32 v12, 3, v55
    v_cos_f32 v10, v10
    v_lshlrev_b16 v13, 3, v55
    v_mad_i32_i24 v11, v14, s55, v51
    v_bitop3_b32 v12, v6, v13, v12 bitop3:0xca
    v_lshl_add_u32 v11, v11, 17, s40
    v_lshlrev_b16 v14, 8, v14
    v_lshrrev_b32 v13, 2, v55
    v_add_u32 v51, v12, v11
    v_bitop3_b32 v55, v5, v13, v14 bitop3:0xea
    ds_add_u32 v55, v2
    v_cvt_pk_bf16_f32 v47, v9, v10
    v_perm_b32 v12, v47, v47, s41
    v_bitop3_b32 v50, v4, v12, v50 bitop3:0xca
    v_perm_b32 v13, v47, v47, s42
    v_bitop3_b32 v51, v4, v13, v51 bitop3:0xca
    s_setprio 1
    s_add_u32 s46, s33, 0x1c00000
    buffer_load_dwordx4 v[88:91], v0, s[8:11], s46 offen nt
    s_add_u32 s47, s33, 0x1c00000
    buffer_load_dwordx4 v[92:95], v0, s[12:15], s47 offen nt
    s_waitcnt vmcnt(8)
    v_lshlrev_b32 v7, 16, v64
    v_and_b32 v8, 0xffff0000, v64
    v_lshlrev_b32 v9, 16, v65
    v_and_b32 v10, 0xffff0000, v65
    v_mul_f32 v7, 0.15915494, v7
    v_mul_f32 v8, 0.15915494, v8
    v_mul_f32 v9, 0.15915494, v9
    v_mul_f32 v10, 0.15915494, v10
    v_mul_hi_u32_u24 v14, 429497, v56
    v_lshrrev_b32 v12, 3, v60
    v_cos_f32 v7, v7
    v_lshlrev_b16 v13, 3, v60
    v_mad_i32_i24 v11, v14, s55, v56
    v_bitop3_b32 v12, v6, v13, v12 bitop3:0xca
    v_lshl_add_u32 v11, v11, 17, s40
    v_lshlrev_b16 v14, 8, v14
    v_lshrrev_b32 v13, 2, v60
    v_add_u32 v56, v12, v11
    v_bitop3_b32 v60, v5, v13, v14 bitop3:0xea
    ds_add_u32 v60, v2
    v_mul_hi_u32_u24 v14, 429497, v57
    v_lshrrev_b32 v12, 3, v61
    v_cos_f32 v8, v8
    v_lshlrev_b16 v13, 3, v61
    v_mad_i32_i24 v11, v14, s55, v57
    v_bitop3_b32 v12, v6, v13, v12 bitop3:0xca
    v_lshl_add_u32 v11, v11, 17, s40
    v_lshlrev_b16 v14, 8, v14
    v_lshrrev_b32 v13, 2, v61
    v_add_u32 v57, v12, v11
    v_bitop3_b32 v61, v5, v13, v14 bitop3:0xea
    ds_add_u32 v61, v2
    v_cvt_pk_bf16_f32 v64, v7, v8
    v_perm_b32 v12, v64, v64, s41
    v_bitop3_b32 v56, v4, v12, v56 bitop3:0xca
    v_perm_b32 v13, v64, v64, s42
    v_bitop3_b32 v57, v4, v13, v57 bitop3:0xca
    v_mul_hi_u32_u24 v14, 429497, v58
    v_lshrrev_b32 v12, 3, v62
    v_cos_f32 v9, v9
    v_lshlrev_b16 v13, 3, v62
    v_mad_i32_i24 v11, v14, s55, v58
    v_bitop3_b32 v12, v6, v13, v12 bitop3:0xca
    v_lshl_add_u32 v11, v11, 17, s40
    v_lshlrev_b16 v14, 8, v14
    v_lshrrev_b32 v13, 2, v62
    v_add_u32 v58, v12, v11
    v_bitop3_b32 v62, v5, v13, v14 bitop3:0xea
    ds_add_u32 v62, v2
    v_mul_hi_u32_u24 v14, 429497, v59
    v_lshrrev_b32 v12, 3, v63
    v_cos_f32 v10, v10
    v_lshlrev_b16 v13, 3, v63
    v_mad_i32_i24 v11, v14, s55, v59
    v_bitop3_b32 v12, v6, v13, v12 bitop3:0xca
    v_lshl_add_u32 v11, v11, 17, s40
    v_lshlrev_b16 v14, 8, v14
    v_lshrrev_b32 v13, 2, v63
    v_add_u32 v59, v12, v11
    v_bitop3_b32 v63, v5, v13, v14 bitop3:0xea
    ds_add_u32 v63, v2
    v_cvt_pk_bf16_f32 v65, v9, v10
    v_perm_b32 v12, v65, v65, s41
    v_bitop3_b32 v58, v4, v12, v58 bitop3:0xca
    v_perm_b32 v13, v65, v65, s42
    v_bitop3_b32 v59, v4, v13, v59 bitop3:0xca
    s_add_u32 s44, s33, 0x2000000
    buffer_load_dwordx4 v[96:99], v0, s[8:11], s44 offen nt
    s_add_u32 s45, s33, 0x2000000
    buffer_load_dwordx4 v[104:107], v0, s[12:15], s45 offen nt
    s_add_u32 s46, s34, 0x1000000
    buffer_load_dwordx2 v[108:109], v1, s[16:19], s46 offen nt
    s_add_u32 s47, s34, 0x1200000
    buffer_load_dwordx2 v[110:111], v1, s[16:19], s47 offen nt
    s_waitcnt vmcnt(10)
    v_lshlrev_b32 v7, 16, v66
    v_and_b32 v8, 0xffff0000, v66
    v_lshlrev_b32 v9, 16, v67
    v_and_b32 v10, 0xffff0000, v67
    v_mul_f32 v7, 0.15915494, v7
    v_mul_f32 v8, 0.15915494, v8
    v_mul_f32 v9, 0.15915494, v9
    v_mul_f32 v10, 0.15915494, v10
    v_mul_hi_u32_u24 v14, 429497, v68
    v_lshrrev_b32 v12, 3, v72
    v_cos_f32 v7, v7
    v_lshlrev_b16 v13, 3, v72
    v_mad_i32_i24 v11, v14, s55, v68
    v_bitop3_b32 v12, v6, v13, v12 bitop3:0xca
    v_lshl_add_u32 v11, v11, 17, s40
    v_lshlrev_b16 v14, 8, v14
    v_lshrrev_b32 v13, 2, v72
    v_add_u32 v68, v12, v11
    v_bitop3_b32 v72, v5, v13, v14 bitop3:0xea
    ds_add_u32 v72, v2
    v_mul_hi_u32_u24 v14, 429497, v69
    v_lshrrev_b32 v12, 3, v73
    v_cos_f32 v8, v8
    v_lshlrev_b16 v13, 3, v73
    v_mad_i32_i24 v11, v14, s55, v69
    v_bitop3_b32 v12, v6, v13, v12 bitop3:0xca
    v_lshl_add_u32 v11, v11, 17, s40
    v_lshlrev_b16 v14, 8, v14
    v_lshrrev_b32 v13, 2, v73
    v_add_u32 v69, v12, v11
    v_bitop3_b32 v73, v5, v13, v14 bitop3:0xea
    ds_add_u32 v73, v2
    v_cvt_pk_bf16_f32 v66, v7, v8
    v_perm_b32 v12, v66, v66, s41
    v_bitop3_b32 v68, v4, v12, v68 bitop3:0xca
    v_perm_b32 v13, v66, v66, s42
    v_bitop3_b32 v69, v4, v13, v69 bitop3:0xca
    v_mul_hi_u32_u24 v14, 429497, v70
    v_lshrrev_b32 v12, 3, v74
    v_cos_f32 v9, v9
    v_lshlrev_b16 v13, 3, v74
    v_mad_i32_i24 v11, v14, s55, v70
    v_bitop3_b32 v12, v6, v13, v12 bitop3:0xca
    v_lshl_add_u32 v11, v11, 17, s40
    v_lshlrev_b16 v14, 8, v14
    v_lshrrev_b32 v13, 2, v74
    v_add_u32 v70, v12, v11
    v_bitop3_b32 v74, v5, v13, v14 bitop3:0xea
    ds_add_u32 v74, v2
    v_mul_hi_u32_u24 v14, 429497, v71
    v_lshrrev_b32 v12, 3, v75
    v_cos_f32 v10, v10
    v_lshlrev_b16 v13, 3, v75
    v_mad_i32_i24 v11, v14, s55, v71
    v_bitop3_b32 v12, v6, v13, v12 bitop3:0xca
    v_lshl_add_u32 v11, v11, 17, s40
    v_lshlrev_b16 v14, 8, v14
    v_lshrrev_b32 v13, 2, v75
    v_add_u32 v71, v12, v11
    v_bitop3_b32 v75, v5, v13, v14 bitop3:0xea
    ds_add_u32 v75, v2
    v_cvt_pk_bf16_f32 v67, v9, v10
    v_perm_b32 v12, v67, v67, s41
    v_bitop3_b32 v70, v4, v12, v70 bitop3:0xca
    v_perm_b32 v13, v67, v67, s42
    v_bitop3_b32 v71, v4, v13, v71 bitop3:0xca
    s_setprio 0
    s_add_u32 s44, s33, 0x2400000
    buffer_load_dwordx4 v[112:115], v0, s[8:11], s44 offen nt
    s_waitcnt vmcnt(7)
    v_lshlrev_b32 v7, 16, v84
    v_and_b32 v8, 0xffff0000, v84
    v_lshlrev_b32 v9, 16, v85
    v_and_b32 v10, 0xffff0000, v85
    v_mul_f32 v7, 0.15915494, v7
    v_mul_f32 v8, 0.15915494, v8
    v_mul_f32 v9, 0.15915494, v9
    v_mul_f32 v10, 0.15915494, v10
    v_mul_hi_u32_u24 v14, 429497, v76
    v_lshrrev_b32 v12, 3, v80
    v_cos_f32 v7, v7
    v_lshlrev_b16 v13, 3, v80
    v_mad_i32_i24 v11, v14, s55, v76
    v_bitop3_b32 v12, v6, v13, v12 bitop3:0xca
    v_lshl_add_u32 v11, v11, 17, s40
    v_lshlrev_b16 v14, 8, v14
    v_lshrrev_b32 v13, 2, v80
    v_add_u32 v76, v12, v11
    v_bitop3_b32 v80, v5, v13, v14 bitop3:0xea
    ds_add_u32 v80, v2
    v_mul_hi_u32_u24 v14, 429497, v77
    v_lshrrev_b32 v12, 3, v81
    v_cos_f32 v8, v8
    v_lshlrev_b16 v13, 3, v81
    v_mad_i32_i24 v11, v14, s55, v77
    v_bitop3_b32 v12, v6, v13, v12 bitop3:0xca
    v_lshl_add_u32 v11, v11, 17, s40
    v_lshlrev_b16 v14, 8, v14
    v_lshrrev_b32 v13, 2, v81
    v_add_u32 v77, v12, v11
    v_bitop3_b32 v81, v5, v13, v14 bitop3:0xea
    ds_add_u32 v81, v2
    v_cvt_pk_bf16_f32 v84, v7, v8
    v_perm_b32 v12, v84, v84, s41
    v_bitop3_b32 v76, v4, v12, v76 bitop3:0xca
    v_perm_b32 v13, v84, v84, s42
    v_bitop3_b32 v77, v4, v13, v77 bitop3:0xca
    v_mul_hi_u32_u24 v14, 429497, v78
    v_lshrrev_b32 v12, 3, v82
    v_cos_f32 v9, v9
    v_lshlrev_b16 v13, 3, v82
    v_mad_i32_i24 v11, v14, s55, v78
    v_bitop3_b32 v12, v6, v13, v12 bitop3:0xca
    v_lshl_add_u32 v11, v11, 17, s40
    v_lshlrev_b16 v14, 8, v14
    v_lshrrev_b32 v13, 2, v82
    v_add_u32 v78, v12, v11
    v_bitop3_b32 v82, v5, v13, v14 bitop3:0xea
    ds_add_u32 v82, v2
    v_mul_hi_u32_u24 v14, 429497, v79
    v_lshrrev_b32 v12, 3, v83
    v_cos_f32 v10, v10
    v_lshlrev_b16 v13, 3, v83
    v_mad_i32_i24 v11, v14, s55, v79
    v_bitop3_b32 v12, v6, v13, v12 bitop3:0xca
    v_lshl_add_u32 v11, v11, 17, s40
    v_lshlrev_b16 v14, 8, v14
    v_lshrrev_b32 v13, 2, v83
    v_add_u32 v79, v12, v11
    v_bitop3_b32 v83, v5, v13, v14 bitop3:0xea
    ds_add_u32 v83, v2
    v_cvt_pk_bf16_f32 v85, v9, v10
    v_perm_b32 v12, v85, v85, s41
    v_bitop3_b32 v78, v4, v12, v78 bitop3:0xca
    v_perm_b32 v13, v85, v85, s42
    v_bitop3_b32 v79, v4, v13, v79 bitop3:0xca
    s_waitcnt vmcnt(5)
    v_lshlrev_b32 v7, 16, v86
    v_and_b32 v8, 0xffff0000, v86
    v_lshlrev_b32 v9, 16, v87
    v_and_b32 v10, 0xffff0000, v87
    v_mul_f32 v7, 0.15915494, v7
    v_mul_f32 v8, 0.15915494, v8
    v_mul_f32 v9, 0.15915494, v9
    v_mul_f32 v10, 0.15915494, v10
    v_mul_hi_u32_u24 v14, 429497, v88
    v_lshrrev_b32 v12, 3, v92
    v_cos_f32 v7, v7
    v_lshlrev_b16 v13, 3, v92
    v_mad_i32_i24 v11, v14, s55, v88
    v_bitop3_b32 v12, v6, v13, v12 bitop3:0xca
    v_lshl_add_u32 v11, v11, 17, s40
    v_lshlrev_b16 v14, 8, v14
    v_lshrrev_b32 v13, 2, v92
    v_add_u32 v88, v12, v11
    v_bitop3_b32 v92, v5, v13, v14 bitop3:0xea
    ds_add_u32 v92, v2
    v_mul_hi_u32_u24 v14, 429497, v89
    v_lshrrev_b32 v12, 3, v93
    v_cos_f32 v8, v8
    v_lshlrev_b16 v13, 3, v93
    v_mad_i32_i24 v11, v14, s55, v89
    v_bitop3_b32 v12, v6, v13, v12 bitop3:0xca
    v_lshl_add_u32 v11, v11, 17, s40
    v_lshlrev_b16 v14, 8, v14
    v_lshrrev_b32 v13, 2, v93
    v_add_u32 v89, v12, v11
    v_bitop3_b32 v93, v5, v13, v14 bitop3:0xea
    ds_add_u32 v93, v2
    v_cvt_pk_bf16_f32 v86, v7, v8
    v_perm_b32 v12, v86, v86, s41
    v_bitop3_b32 v88, v4, v12, v88 bitop3:0xca
    v_perm_b32 v13, v86, v86, s42
    v_bitop3_b32 v89, v4, v13, v89 bitop3:0xca
    v_mul_hi_u32_u24 v14, 429497, v90
    v_lshrrev_b32 v12, 3, v94
    v_cos_f32 v9, v9
    v_lshlrev_b16 v13, 3, v94
    v_mad_i32_i24 v11, v14, s55, v90
    v_bitop3_b32 v12, v6, v13, v12 bitop3:0xca
    v_lshl_add_u32 v11, v11, 17, s40
    v_lshlrev_b16 v14, 8, v14
    v_lshrrev_b32 v13, 2, v94
    v_add_u32 v90, v12, v11
    v_bitop3_b32 v94, v5, v13, v14 bitop3:0xea
    ds_add_u32 v94, v2
    v_mul_hi_u32_u24 v14, 429497, v91
    v_lshrrev_b32 v12, 3, v95
    v_cos_f32 v10, v10
    v_lshlrev_b16 v13, 3, v95
    v_mad_i32_i24 v11, v14, s55, v91
    v_bitop3_b32 v12, v6, v13, v12 bitop3:0xca
    v_lshl_add_u32 v11, v11, 17, s40
    v_lshlrev_b16 v14, 8, v14
    v_lshrrev_b32 v13, 2, v95
    v_add_u32 v91, v12, v11
    v_bitop3_b32 v95, v5, v13, v14 bitop3:0xea
    ds_add_u32 v95, v2
    v_cvt_pk_bf16_f32 v87, v9, v10
    v_perm_b32 v12, v87, v87, s41
    v_bitop3_b32 v90, v4, v12, v90 bitop3:0xca
    v_perm_b32 v13, v87, v87, s42
    v_bitop3_b32 v91, v4, v13, v91 bitop3:0xca
    v_lshrrev_b32 v8, 2, v0
    v_and_b32 v7, 0x3c00, v0
    v_bitop3_b32 v7, v5, v8, v7 bitop3:0xea
    s_waitcnt lgkmcnt(0)
    s_barrier
    ds_read2st64_b32 v[8:9], v7 offset0:0 offset1:1
    ds_read2st64_b32 v[10:11], v7 offset0:2 offset1:3
    s_add_u32 s45, s33, 0x2400000
    buffer_load_dwordx4 v[100:103], v0, s[12:15], s45 offen nt
    s_waitcnt lgkmcnt(0)
    v_lshl_or_b32 v12, v9, 16, v8
    v_lshl_or_b32 v13, v11, 16, v10
    v_mov_b32 v14, v12
    v_mov_b32 v15, v13
    s_nop 0
    v_add_u32_dpp v14, v14, v14 row_shr:1 row_mask:0xf bank_mask:0xf bound_ctrl:1
    v_add_u32_dpp v15, v15, v15 row_shr:1 row_mask:0xf bank_mask:0xf bound_ctrl:1
    s_nop 0
    v_add_u32_dpp v14, v14, v14 row_shr:2 row_mask:0xf bank_mask:0xf bound_ctrl:1
    v_add_u32_dpp v15, v15, v15 row_shr:2 row_mask:0xf bank_mask:0xf bound_ctrl:1
    s_nop 0
    v_add_u32_dpp v14, v14, v14 row_shr:4 row_mask:0xf bank_mask:0xf bound_ctrl:1
    v_add_u32_dpp v15, v15, v15 row_shr:4 row_mask:0xf bank_mask:0xf bound_ctrl:1
    s_nop 0
    v_add_u32_dpp v14, v14, v14 row_shr:8 row_mask:0xf bank_mask:0xf bound_ctrl:1
    v_add_u32_dpp v15, v15, v15 row_shr:8 row_mask:0xf bank_mask:0xf bound_ctrl:1
    s_nop 0
    v_add_u32_dpp v14, v14, v14 row_bcast:15 row_mask:0xa bank_mask:0xf
    v_add_u32_dpp v15, v15, v15 row_bcast:15 row_mask:0xa bank_mask:0xf
    s_nop 0
    v_add_u32_dpp v14, v14, v14 row_bcast:31 row_mask:0xc bank_mask:0xf
    v_add_u32_dpp v15, v15, v15 row_bcast:31 row_mask:0xc bank_mask:0xf
    v_readlane_b32 s48, v14, 63
    v_readlane_b32 s49, v15, 63
    s_lshl_b32 s54, s32, 2
    v_mov_b32 v8, s54
    s_and_b32 s50, s48, 0xffff
    s_lshr_b32 s51, s48, 16
    s_and_b32 s52, s49, 0xffff
    s_lshr_b32 s53, s49, 16
    s_add_u32 s51, s51, s50
    s_add_u32 s52, s52, s51
    s_add_u32 s53, s53, s52
    v_mov_b32 v9, s53
    s_mov_b64 exec, 1
    ds_write_b32 v8, v9 offset:16384
    s_mov_b64 exec, -1
    v_and_b32 v8, 60, v7
    s_waitcnt lgkmcnt(0)
    s_barrier
    ds_read_b32 v9, v8 offset:16384
    s_waitcnt lgkmcnt(0)
    v_add_u32_dpp v9, v9, v9 row_shr:1 row_mask:0xf bank_mask:0xf bound_ctrl:1
    s_nop 1
    v_add_u32_dpp v9, v9, v9 row_shr:2 row_mask:0xf bank_mask:0xf bound_ctrl:1
    s_nop 1
    v_add_u32_dpp v9, v9, v9 row_shr:4 row_mask:0xf bank_mask:0xf bound_ctrl:1
    s_nop 1
    v_add_u32_dpp v9, v9, v9 row_shr:8 row_mask:0xf bank_mask:0xf bound_ctrl:1
    s_nop 0
    v_readlane_b32 s54, v9, s32
    s_sub_u32 s54, s54, s53
    s_add_u32 s50, s50, s54
    s_add_u32 s51, s51, s54
    s_add_u32 s52, s52, s54
    s_pack_ll_b32_b16 s48, s54, s50
    s_pack_ll_b32_b16 s49, s51, s52
    v_add_u32 v14, s48, v14
    v_add_u32 v15, s49, v15
    v_sub_u32 v12, v14, v12
    v_sub_u32 v13, v15, v13
    v_and_b32 v8, 0xffff, v12
    v_lshrrev_b32 v9, 16, v12
    v_and_b32 v10, 0xffff, v13
    v_lshrrev_b32 v11, 16, v13
    ds_write2st64_b32 v7, v8, v9 offset0:0 offset1:1
    ds_write2st64_b32 v7, v10, v11 offset0:2 offset1:3
    v_and_b32 v8, 0x3f0, v0
    v_lshl_add_u32 v8, v8, 1, s36
    ds_write_b64 v8, v[12:13] offset:20480
    s_bitset0_b64 exec, 63
    s_not_b64 exec, exec
    ds_write_b64 v8, v[14:15] offset:20512
    s_mov_b64 exec, -1
    s_waitcnt lgkmcnt(0)
    s_barrier
    s_setprio 3
    ds_add_rtn_u32 v20, v20, v2
    ds_add_rtn_u32 v21, v21, v2
    ds_add_rtn_u32 v22, v22, v2
    ds_add_rtn_u32 v23, v23, v2
    ds_read_b128 v[12:15], v0 offset:20480
    v_cmp_gt_u32 vcc, 8448, v0
    ds_add_rtn_u32 v32, v32, v2
    ds_add_rtn_u32 v33, v33, v2
    ds_add_rtn_u32 v34, v34, v2
    ds_add_rtn_u32 v35, v35, v2
    s_setprio 2
    ds_add_rtn_u32 v40, v40, v2
    ds_add_rtn_u32 v41, v41, v2
    ds_add_rtn_u32 v42, v42, v2
    ds_add_rtn_u32 v43, v43, v2
    s_waitcnt lgkmcnt(8)
    s_cbranch_vccz L1_p1
    s_add_u32 s46, s35, 0x0
    s_mov_b64 exec, vcc
    buffer_store_dwordx4 v[12:15], v0, s[24:27], s46 offen sc1
    s_mov_b64 exec, -1
L1_p1:
    s_add_u32 s47, s33, 0x2800000
    buffer_load_dwordx4 v[116:119], v0, s[8:11], s47 offen nt
    ds_add_rtn_u32 v52, v52, v2
    ds_add_rtn_u32 v53, v53, v2
    ds_add_rtn_u32 v54, v54, v2
    ds_add_rtn_u32 v55, v55, v2
    s_setprio 1
    ds_add_rtn_u32 v60, v60, v2
    ds_add_rtn_u32 v61, v61, v2
    ds_add_rtn_u32 v62, v62, v2
    ds_add_rtn_u32 v63, v63, v2
    ds_add_rtn_u32 v72, v72, v2
    ds_add_rtn_u32 v73, v73, v2
    ds_add_rtn_u32 v74, v74, v2
    ds_add_rtn_u32 v75, v75, v2
    s_add_u32 s44, s33, 0x2800000
    buffer_load_dwordx4 v[120:123], v0, s[12:15], s44 offen nt
    s_setprio 0
    ds_add_rtn_u32 v80, v80, v2
    ds_add_rtn_u32 v81, v81, v2
    ds_add_rtn_u32 v82, v82, v2
    ds_add_rtn_u32 v83, v83, v2
    ds_add_rtn_u32 v92, v92, v2
    ds_add_rtn_u32 v93, v93, v2
    ds_add_rtn_u32 v94, v94, v2
    ds_add_rtn_u32 v95, v95, v2
    s_waitcnt lgkmcnt(0)
    s_barrier
    s_setprio 3
    v_and_b32 v7, -4, v20
    v_lshl_add_u32 v8, v20, 2, v7
    ds_write_b32 v8, v16
    v_lshl_add_u32 v7, v7, 2, v20
    ds_write_b8 v7, v24 offset:16
    v_and_b32 v9, -4, v21
    v_lshl_add_u32 v10, v21, 2, v9
    ds_write_b32 v10, v17
    v_lshl_add_u32 v9, v9, 2, v21
    ds_write_b8_d16_hi v9, v24 offset:16
    v_and_b32 v7, -4, v22
    v_lshl_add_u32 v8, v22, 2, v7
    ds_write_b32 v8, v18
    v_lshl_add_u32 v7, v7, 2, v22
    ds_write_b8 v7, v25 offset:16
    v_and_b32 v9, -4, v23
    v_lshl_add_u32 v10, v23, 2, v9
    ds_write_b32 v10, v19
    v_lshl_add_u32 v9, v9, 2, v23
    ds_write_b8_d16_hi v9, v25 offset:16
    s_add_u32 s45, s34, 0x1400000
    buffer_load_dwordx2 v[124:125], v1, s[16:19], s45 offen nt
    s_add_u32 s46, s34, 0x1600000
    buffer_load_dwordx2 v[126:127], v1, s[16:19], s46 offen nt
    s_add_u32 s47, s33, 0x2c00000
    buffer_load_dwordx4 v[16:19], v0, s[8:11], s47 offen nt
    v_and_b32 v7, -4, v32
    v_lshl_add_u32 v8, v32, 2, v7
    ds_write_b32 v8, v28
    v_lshl_add_u32 v7, v7, 2, v32
    ds_write_b8 v7, v26 offset:16
    v_and_b32 v9, -4, v33
    v_lshl_add_u32 v10, v33, 2, v9
    ds_write_b32 v10, v29
    v_lshl_add_u32 v9, v9, 2, v33
    ds_write_b8_d16_hi v9, v26 offset:16
    v_and_b32 v7, -4, v34
    v_lshl_add_u32 v8, v34, 2, v7
    ds_write_b32 v8, v30
    v_lshl_add_u32 v7, v7, 2, v34
    ds_write_b8 v7, v27 offset:16
    v_and_b32 v9, -4, v35
    v_lshl_add_u32 v10, v35, 2, v9
    ds_write_b32 v10, v31
    v_lshl_add_u32 v9, v9, 2, v35
    ds_write_b8_d16_hi v9, v27 offset:16
    s_add_u32 s44, s33, 0x2c00000
    buffer_load_dwordx4 v[20:23], v0, s[12:15], s44 offen nt
    s_setprio 2
    v_and_b32 v7, -4, v40
    v_lshl_add_u32 v8, v40, 2, v7
    ds_write_b32 v8, v36
    v_lshl_add_u32 v7, v7, 2, v40
    ds_write_b8 v7, v44 offset:16
    v_and_b32 v9, -4, v41
    v_lshl_add_u32 v10, v41, 2, v9
    ds_write_b32 v10, v37
    v_lshl_add_u32 v9, v9, 2, v41
    ds_write_b8_d16_hi v9, v44 offset:16
    v_and_b32 v7, -4, v42
    v_lshl_add_u32 v8, v42, 2, v7
    ds_write_b32 v8, v38
    v_lshl_add_u32 v7, v7, 2, v42
    ds_write_b8 v7, v45 offset:16
    v_and_b32 v9, -4, v43
    v_lshl_add_u32 v10, v43, 2, v9
    ds_write_b32 v10, v39
    v_lshl_add_u32 v9, v9, 2, v43
    ds_write_b8_d16_hi v9, v45 offset:16
    s_add_u32 s45, s33, 0x3000000
    buffer_load_dwordx4 v[28:31], v0, s[8:11], s45 offen nt
    s_add_u32 s46, s33, 0x3000000
    buffer_load_dwordx4 v[32:35], v0, s[12:15], s46 offen nt
    v_and_b32 v7, -4, v52
    v_lshl_add_u32 v8, v52, 2, v7
    ds_write_b32 v8, v48
    v_lshl_add_u32 v7, v7, 2, v52
    ds_write_b8 v7, v46 offset:16
    v_and_b32 v9, -4, v53
    v_lshl_add_u32 v10, v53, 2, v9
    ds_write_b32 v10, v49
    v_lshl_add_u32 v9, v9, 2, v53
    ds_write_b8_d16_hi v9, v46 offset:16
    v_and_b32 v7, -4, v54
    v_lshl_add_u32 v8, v54, 2, v7
    ds_write_b32 v8, v50
    v_lshl_add_u32 v7, v7, 2, v54
    ds_write_b8 v7, v47 offset:16
    v_and_b32 v9, -4, v55
    v_lshl_add_u32 v10, v55, 2, v9
    ds_write_b32 v10, v51
    v_lshl_add_u32 v9, v9, 2, v55
    ds_write_b8_d16_hi v9, v47 offset:16
    s_add_u32 s47, s34, 0x1800000
    buffer_load_dwordx2 v[24:25], v1, s[16:19], s47 offen nt
    s_add_u32 s44, s34, 0x1a00000
    buffer_load_dwordx2 v[26:27], v1, s[16:19], s44 offen nt
    s_setprio 1
    v_and_b32 v7, -4, v60
    v_lshl_add_u32 v8, v60, 2, v7
    ds_write_b32 v8, v56
    v_lshl_add_u32 v7, v7, 2, v60
    ds_write_b8 v7, v64 offset:16
    v_and_b32 v9, -4, v61
    v_lshl_add_u32 v10, v61, 2, v9
    ds_write_b32 v10, v57
    v_lshl_add_u32 v9, v9, 2, v61
    ds_write_b8_d16_hi v9, v64 offset:16
    v_and_b32 v7, -4, v62
    v_lshl_add_u32 v8, v62, 2, v7
    ds_write_b32 v8, v58
    v_lshl_add_u32 v7, v7, 2, v62
    ds_write_b8 v7, v65 offset:16
    v_and_b32 v9, -4, v63
    v_lshl_add_u32 v10, v63, 2, v9
    ds_write_b32 v10, v59
    v_lshl_add_u32 v9, v9, 2, v63
    ds_write_b8_d16_hi v9, v65 offset:16
    s_add_u32 s45, s33, 0x3400000
    buffer_load_dwordx4 v[36:39], v0, s[8:11], s45 offen nt
    v_and_b32 v7, -4, v72
    v_lshl_add_u32 v8, v72, 2, v7
    ds_write_b32 v8, v68
    v_lshl_add_u32 v7, v7, 2, v72
    ds_write_b8 v7, v66 offset:16
    v_and_b32 v9, -4, v73
    v_lshl_add_u32 v10, v73, 2, v9
    ds_write_b32 v10, v69
    v_lshl_add_u32 v9, v9, 2, v73
    ds_write_b8_d16_hi v9, v66 offset:16
    v_and_b32 v7, -4, v74
    v_lshl_add_u32 v8, v74, 2, v7
    ds_write_b32 v8, v70
    v_lshl_add_u32 v7, v7, 2, v74
    ds_write_b8 v7, v67 offset:16
    v_and_b32 v9, -4, v75
    v_lshl_add_u32 v10, v75, 2, v9
    ds_write_b32 v10, v71
    v_lshl_add_u32 v9, v9, 2, v75
    ds_write_b8_d16_hi v9, v67 offset:16
    s_add_u32 s46, s33, 0x3400000
    buffer_load_dwordx4 v[40:43], v0, s[12:15], s46 offen nt
    s_add_u32 s47, s33, 0x3800000
    buffer_load_dwordx4 v[48:51], v0, s[8:11], s47 offen nt
    s_setprio 0
    v_and_b32 v7, -4, v80
    v_lshl_add_u32 v8, v80, 2, v7
    ds_write_b32 v8, v76
    v_lshl_add_u32 v7, v7, 2, v80
    ds_write_b8 v7, v84 offset:16
    v_and_b32 v9, -4, v81
    v_lshl_add_u32 v10, v81, 2, v9
    ds_write_b32 v10, v77
    v_lshl_add_u32 v9, v9, 2, v81
    ds_write_b8_d16_hi v9, v84 offset:16
    v_and_b32 v7, -4, v82
    v_lshl_add_u32 v8, v82, 2, v7
    ds_write_b32 v8, v78
    v_lshl_add_u32 v7, v7, 2, v82
    ds_write_b8 v7, v85 offset:16
    v_and_b32 v9, -4, v83
    v_lshl_add_u32 v10, v83, 2, v9
    ds_write_b32 v10, v79
    v_lshl_add_u32 v9, v9, 2, v83
    ds_write_b8_d16_hi v9, v85 offset:16
    s_add_u32 s44, s33, 0x3800000
    buffer_load_dwordx4 v[52:55], v0, s[12:15], s44 offen nt
    v_and_b32 v7, -4, v92
    v_lshl_add_u32 v8, v92, 2, v7
    ds_write_b32 v8, v88
    v_lshl_add_u32 v7, v7, 2, v92
    ds_write_b8 v7, v86 offset:16
    v_and_b32 v9, -4, v93
    v_lshl_add_u32 v10, v93, 2, v9
    ds_write_b32 v10, v89
    v_lshl_add_u32 v9, v9, 2, v93
    ds_write_b8_d16_hi v9, v86 offset:16
    v_and_b32 v7, -4, v94
    v_lshl_add_u32 v8, v94, 2, v7
    ds_write_b32 v8, v90
    v_lshl_add_u32 v7, v7, 2, v94
    ds_write_b8 v7, v87 offset:16
    v_and_b32 v9, -4, v95
    v_lshl_add_u32 v10, v95, 2, v9
    ds_write_b32 v10, v91
    v_lshl_add_u32 v9, v9, 2, v95
    ds_write_b8_d16_hi v9, v87 offset:16
    s_add_u32 s45, s34, 0x1c00000
    buffer_load_dwordx2 v[44:45], v1, s[16:19], s45 offen nt
    s_add_u32 s46, s34, 0x1e00000
    buffer_load_dwordx2 v[46:47], v1, s[16:19], s46 offen nt
    v_add_u32 v7, 0x10000, v0
    v_add_u32 v12, 0x20000, v0
    v_mov_b32 v8, 0
    v_mov_b32 v9, 0
    v_mov_b32 v10, 0
    v_mov_b32 v11, 0
    s_waitcnt lgkmcnt(0)
    s_barrier
    ds_read_b128 v[56:59], v0 offset:0
    ds_write_b128 v0, v[8:11]
    ds_read_b128 v[60:63], v0 offset:16384
    ds_read_b128 v[68:71], v0 offset:32768
    ds_read_b128 v[72:75], v0 offset:49152
    ds_read_b128 v[64:67], v7 offset:0
    ds_read_b128 v[76:79], v7 offset:16384
    ds_read_b128 v[80:83], v7 offset:32768
    ds_read_b128 v[88:91], v7 offset:49152
    ds_read_b128 v[92:95], v12 offset:0
    ds_read_b128 v[84:87], v12 offset:16384
    s_waitcnt lgkmcnt(0)
    s_barrier
    s_setprio 3
    s_add_u32 s47, s35, 0x0
    buffer_store_dwordx4 v[56:59], v0, s[20:23], s47 offen sc1
    s_add_u32 s44, s33, 0x3c00000
    s_nop 0
    buffer_load_dwordx4 v[56:59], v0, s[8:11], s44 offen nt
    s_add_u32 s45, s35, 0x4000
    buffer_store_dwordx4 v[60:63], v0, s[20:23], s45 offen sc1
    s_add_u32 s46, s33, 0x3c00000
    s_nop 0
    buffer_load_dwordx4 v[60:63], v0, s[12:15], s46 offen nt
    s_waitcnt vmcnt(22)
    v_lshlrev_b32 v7, 16, v108
    v_and_b32 v8, 0xffff0000, v108
    v_lshlrev_b32 v9, 16, v109
    v_and_b32 v10, 0xffff0000, v109
    v_mul_f32 v7, 0.15915494, v7
    v_mul_f32 v8, 0.15915494, v8
    v_mul_f32 v9, 0.15915494, v9
    v_mul_f32 v10, 0.15915494, v10
    v_mul_hi_u32_u24 v14, 429497, v96
    v_lshrrev_b32 v12, 3, v104
    v_cos_f32 v7, v7
    v_lshlrev_b16 v13, 3, v104
    v_mad_i32_i24 v11, v14, s55, v96
    v_bitop3_b32 v12, v6, v13, v12 bitop3:0xca
    v_lshl_add_u32 v11, v11, 17, s40
    v_lshlrev_b16 v14, 8, v14
    v_lshrrev_b32 v13, 2, v104
    v_add_u32 v96, v12, v11
    v_bitop3_b32 v104, v5, v13, v14 bitop3:0xea
    ds_add_u32 v104, v2
    v_mul_hi_u32_u24 v14, 429497, v97
    v_lshrrev_b32 v12, 3, v105
    v_cos_f32 v8, v8
    v_lshlrev_b16 v13, 3, v105
    v_mad_i32_i24 v11, v14, s55, v97
    v_bitop3_b32 v12, v6, v13, v12 bitop3:0xca
    v_lshl_add_u32 v11, v11, 17, s40
    v_lshlrev_b16 v14, 8, v14
    v_lshrrev_b32 v13, 2, v105
    v_add_u32 v97, v12, v11
    v_bitop3_b32 v105, v5, v13, v14 bitop3:0xea
    ds_add_u32 v105, v2
    v_cvt_pk_bf16_f32 v108, v7, v8
    v_perm_b32 v12, v108, v108, s41
    v_bitop3_b32 v96, v4, v12, v96 bitop3:0xca
    v_perm_b32 v13, v108, v108, s42
    v_bitop3_b32 v97, v4, v13, v97 bitop3:0xca
    v_mul_hi_u32_u24 v14, 429497, v98
    v_lshrrev_b32 v12, 3, v106
    v_cos_f32 v9, v9
    v_lshlrev_b16 v13, 3, v106
    v_mad_i32_i24 v11, v14, s55, v98
    v_bitop3_b32 v12, v6, v13, v12 bitop3:0xca
    v_lshl_add_u32 v11, v11, 17, s40
    v_lshlrev_b16 v14, 8, v14
    v_lshrrev_b32 v13, 2, v106
    v_add_u32 v98, v12, v11
    v_bitop3_b32 v106, v5, v13, v14 bitop3:0xea
    ds_add_u32 v106, v2
    v_mul_hi_u32_u24 v14, 429497, v99
    v_lshrrev_b32 v12, 3, v107
    v_cos_f32 v10, v10
    v_lshlrev_b16 v13, 3, v107
    v_mad_i32_i24 v11, v14, s55, v99
    v_bitop3_b32 v12, v6, v13, v12 bitop3:0xca
    v_lshl_add_u32 v11, v11, 17, s40
    v_lshlrev_b16 v14, 8, v14
    v_lshrrev_b32 v13, 2, v107
    v_add_u32 v99, v12, v11
    v_bitop3_b32 v107, v5, v13, v14 bitop3:0xea
    ds_add_u32 v107, v2
    v_cvt_pk_bf16_f32 v109, v9, v10
    v_perm_b32 v12, v109, v109, s41
    v_bitop3_b32 v98, v4, v12, v98 bitop3:0xca
    v_perm_b32 v13, v109, v109, s42
    v_bitop3_b32 v99, v4, v13, v99 bitop3:0xca
    s_waitcnt vmcnt(20)
    v_lshlrev_b32 v7, 16, v110
    v_and_b32 v8, 0xffff0000, v110
    v_lshlrev_b32 v9, 16, v111
    v_and_b32 v10, 0xffff0000, v111
    v_mul_f32 v7, 0.15915494, v7
    v_mul_f32 v8, 0.15915494, v8
    v_mul_f32 v9, 0.15915494, v9
    v_mul_f32 v10, 0.15915494, v10
    v_mul_hi_u32_u24 v14, 429497, v112
    v_lshrrev_b32 v12, 3, v100
    v_cos_f32 v7, v7
    v_lshlrev_b16 v13, 3, v100
    v_mad_i32_i24 v11, v14, s55, v112
    v_bitop3_b32 v12, v6, v13, v12 bitop3:0xca
    v_lshl_add_u32 v11, v11, 17, s40
    v_lshlrev_b16 v14, 8, v14
    v_lshrrev_b32 v13, 2, v100
    v_add_u32 v112, v12, v11
    v_bitop3_b32 v100, v5, v13, v14 bitop3:0xea
    ds_add_u32 v100, v2
    v_mul_hi_u32_u24 v14, 429497, v113
    v_lshrrev_b32 v12, 3, v101
    v_cos_f32 v8, v8
    v_lshlrev_b16 v13, 3, v101
    v_mad_i32_i24 v11, v14, s55, v113
    v_bitop3_b32 v12, v6, v13, v12 bitop3:0xca
    v_lshl_add_u32 v11, v11, 17, s40
    v_lshlrev_b16 v14, 8, v14
    v_lshrrev_b32 v13, 2, v101
    v_add_u32 v113, v12, v11
    v_bitop3_b32 v101, v5, v13, v14 bitop3:0xea
    ds_add_u32 v101, v2
    v_cvt_pk_bf16_f32 v110, v7, v8
    v_perm_b32 v12, v110, v110, s41
    v_bitop3_b32 v112, v4, v12, v112 bitop3:0xca
    v_perm_b32 v13, v110, v110, s42
    v_bitop3_b32 v113, v4, v13, v113 bitop3:0xca
    v_mul_hi_u32_u24 v14, 429497, v114
    v_lshrrev_b32 v12, 3, v102
    v_cos_f32 v9, v9
    v_lshlrev_b16 v13, 3, v102
    v_mad_i32_i24 v11, v14, s55, v114
    v_bitop3_b32 v12, v6, v13, v12 bitop3:0xca
    v_lshl_add_u32 v11, v11, 17, s40
    v_lshlrev_b16 v14, 8, v14
    v_lshrrev_b32 v13, 2, v102
    v_add_u32 v114, v12, v11
    v_bitop3_b32 v102, v5, v13, v14 bitop3:0xea
    ds_add_u32 v102, v2
    v_mul_hi_u32_u24 v14, 429497, v115
    v_lshrrev_b32 v12, 3, v103
    v_cos_f32 v10, v10
    v_lshlrev_b16 v13, 3, v103
    v_mad_i32_i24 v11, v14, s55, v115
    v_bitop3_b32 v12, v6, v13, v12 bitop3:0xca
    v_lshl_add_u32 v11, v11, 17, s40
    v_lshlrev_b16 v14, 8, v14
    v_lshrrev_b32 v13, 2, v103
    v_add_u32 v115, v12, v11
    v_bitop3_b32 v103, v5, v13, v14 bitop3:0xea
    ds_add_u32 v103, v2
    v_cvt_pk_bf16_f32 v111, v9, v10
    v_perm_b32 v12, v111, v111, s41
    v_bitop3_b32 v114, v4, v12, v114 bitop3:0xca
    v_perm_b32 v13, v111, v111, s42
    v_bitop3_b32 v115, v4, v13, v115 bitop3:0xca
    s_setprio 2
    s_waitcnt vmcnt(16)
    v_lshlrev_b32 v7, 16, v124
    v_and_b32 v8, 0xffff0000, v124
    v_lshlrev_b32 v9, 16, v125
    v_and_b32 v10, 0xffff0000, v125
    v_mul_f32 v7, 0.15915494, v7
    v_mul_f32 v8, 0.15915494, v8
    v_mul_f32 v9, 0.15915494, v9
    v_mul_f32 v10, 0.15915494, v10
    v_mul_hi_u32_u24 v14, 429497, v116
    v_lshrrev_b32 v12, 3, v120
    v_cos_f32 v7, v7
    v_lshlrev_b16 v13, 3, v120
    v_mad_i32_i24 v11, v14, s55, v116
    v_bitop3_b32 v12, v6, v13, v12 bitop3:0xca
    v_lshl_add_u32 v11, v11, 17, s40
    v_lshlrev_b16 v14, 8, v14
    v_lshrrev_b32 v13, 2, v120
    v_add_u32 v116, v12, v11
    v_bitop3_b32 v120, v5, v13, v14 bitop3:0xea
    ds_add_u32 v120, v2
    v_mul_hi_u32_u24 v14, 429497, v117
    v_lshrrev_b32 v12, 3, v121
    v_cos_f32 v8, v8
    v_lshlrev_b16 v13, 3, v121
    v_mad_i32_i24 v11, v14, s55, v117
    v_bitop3_b32 v12, v6, v13, v12 bitop3:0xca
    v_lshl_add_u32 v11, v11, 17, s40
    v_lshlrev_b16 v14, 8, v14
    v_lshrrev_b32 v13, 2, v121
    v_add_u32 v117, v12, v11
    v_bitop3_b32 v121, v5, v13, v14 bitop3:0xea
    ds_add_u32 v121, v2
    v_cvt_pk_bf16_f32 v124, v7, v8
    v_perm_b32 v12, v124, v124, s41
    v_bitop3_b32 v116, v4, v12, v116 bitop3:0xca
    v_perm_b32 v13, v124, v124, s42
    v_bitop3_b32 v117, v4, v13, v117 bitop3:0xca
    v_mul_hi_u32_u24 v14, 429497, v118
    v_lshrrev_b32 v12, 3, v122
    v_cos_f32 v9, v9
    v_lshlrev_b16 v13, 3, v122
    v_mad_i32_i24 v11, v14, s55, v118
    v_bitop3_b32 v12, v6, v13, v12 bitop3:0xca
    v_lshl_add_u32 v11, v11, 17, s40
    v_lshlrev_b16 v14, 8, v14
    v_lshrrev_b32 v13, 2, v122
    v_add_u32 v118, v12, v11
    v_bitop3_b32 v122, v5, v13, v14 bitop3:0xea
    ds_add_u32 v122, v2
    v_mul_hi_u32_u24 v14, 429497, v119
    v_lshrrev_b32 v12, 3, v123
    v_cos_f32 v10, v10
    v_lshlrev_b16 v13, 3, v123
    v_mad_i32_i24 v11, v14, s55, v119
    v_bitop3_b32 v12, v6, v13, v12 bitop3:0xca
    v_lshl_add_u32 v11, v11, 17, s40
    v_lshlrev_b16 v14, 8, v14
    v_lshrrev_b32 v13, 2, v123
    v_add_u32 v119, v12, v11
    v_bitop3_b32 v123, v5, v13, v14 bitop3:0xea
    ds_add_u32 v123, v2
    v_cvt_pk_bf16_f32 v125, v9, v10
    v_perm_b32 v12, v125, v125, s41
    v_bitop3_b32 v118, v4, v12, v118 bitop3:0xca
    v_perm_b32 v13, v125, v125, s42
    v_bitop3_b32 v119, v4, v13, v119 bitop3:0xca
    s_add_u32 s47, s35, 0x8000
    buffer_store_dwordx4 v[68:71], v0, s[20:23], s47 offen sc1
    s_add_u32 s44, s33, 0x4000000
    s_nop 0
    buffer_load_dwordx4 v[68:71], v0, s[8:11], s44 offen nt
    s_waitcnt vmcnt(16)
    v_lshlrev_b32 v7, 16, v126
    v_and_b32 v8, 0xffff0000, v126
    v_lshlrev_b32 v9, 16, v127
    v_and_b32 v10, 0xffff0000, v127
    v_mul_f32 v7, 0.15915494, v7
    v_mul_f32 v8, 0.15915494, v8
    v_mul_f32 v9, 0.15915494, v9
    v_mul_f32 v10, 0.15915494, v10
    v_mul_hi_u32_u24 v14, 429497, v16
    v_lshrrev_b32 v12, 3, v20
    v_cos_f32 v7, v7
    v_lshlrev_b16 v13, 3, v20
    v_mad_i32_i24 v11, v14, s55, v16
    v_bitop3_b32 v12, v6, v13, v12 bitop3:0xca
    v_lshl_add_u32 v11, v11, 17, s40
    v_lshlrev_b16 v14, 8, v14
    v_lshrrev_b32 v13, 2, v20
    v_add_u32 v16, v12, v11
    v_bitop3_b32 v20, v5, v13, v14 bitop3:0xea
    ds_add_u32 v20, v2
    v_mul_hi_u32_u24 v14, 429497, v17
    v_lshrrev_b32 v12, 3, v21
    v_cos_f32 v8, v8
    v_lshlrev_b16 v13, 3, v21
    v_mad_i32_i24 v11, v14, s55, v17
    v_bitop3_b32 v12, v6, v13, v12 bitop3:0xca
    v_lshl_add_u32 v11, v11, 17, s40
    v_lshlrev_b16 v14, 8, v14
    v_lshrrev_b32 v13, 2, v21
    v_add_u32 v17, v12, v11
    v_bitop3_b32 v21, v5, v13, v14 bitop3:0xea
    ds_add_u32 v21, v2
    v_cvt_pk_bf16_f32 v126, v7, v8
    v_perm_b32 v12, v126, v126, s41
    v_bitop3_b32 v16, v4, v12, v16 bitop3:0xca
    v_perm_b32 v13, v126, v126, s42
    v_bitop3_b32 v17, v4, v13, v17 bitop3:0xca
    v_mul_hi_u32_u24 v14, 429497, v18
    v_lshrrev_b32 v12, 3, v22
    v_cos_f32 v9, v9
    v_lshlrev_b16 v13, 3, v22
    v_mad_i32_i24 v11, v14, s55, v18
    v_bitop3_b32 v12, v6, v13, v12 bitop3:0xca
    v_lshl_add_u32 v11, v11, 17, s40
    v_lshlrev_b16 v14, 8, v14
    v_lshrrev_b32 v13, 2, v22
    v_add_u32 v18, v12, v11
    v_bitop3_b32 v22, v5, v13, v14 bitop3:0xea
    ds_add_u32 v22, v2
    v_mul_hi_u32_u24 v14, 429497, v19
    v_lshrrev_b32 v12, 3, v23
    v_cos_f32 v10, v10
    v_lshlrev_b16 v13, 3, v23
    v_mad_i32_i24 v11, v14, s55, v19
    v_bitop3_b32 v12, v6, v13, v12 bitop3:0xca
    v_lshl_add_u32 v11, v11, 17, s40
    v_lshlrev_b16 v14, 8, v14
    v_lshrrev_b32 v13, 2, v23
    v_add_u32 v19, v12, v11
    v_bitop3_b32 v23, v5, v13, v14 bitop3:0xea
    ds_add_u32 v23, v2
    v_cvt_pk_bf16_f32 v127, v9, v10
    v_perm_b32 v12, v127, v127, s41
    v_bitop3_b32 v18, v4, v12, v18 bitop3:0xca
    v_perm_b32 v13, v127, v127, s42
    v_bitop3_b32 v19, v4, v13, v19 bitop3:0xca
    s_setprio 1
    s_waitcnt vmcnt(12)
    v_lshlrev_b32 v7, 16, v24
    v_and_b32 v8, 0xffff0000, v24
    v_lshlrev_b32 v9, 16, v25
    v_and_b32 v10, 0xffff0000, v25
    v_mul_f32 v7, 0.15915494, v7
    v_mul_f32 v8, 0.15915494, v8
    v_mul_f32 v9, 0.15915494, v9
    v_mul_f32 v10, 0.15915494, v10
    v_mul_hi_u32_u24 v14, 429497, v28
    v_lshrrev_b32 v12, 3, v32
    v_cos_f32 v7, v7
    v_lshlrev_b16 v13, 3, v32
    v_mad_i32_i24 v11, v14, s55, v28
    v_bitop3_b32 v12, v6, v13, v12 bitop3:0xca
    v_lshl_add_u32 v11, v11, 17, s40
    v_lshlrev_b16 v14, 8, v14
    v_lshrrev_b32 v13, 2, v32
    v_add_u32 v28, v12, v11
    v_bitop3_b32 v32, v5, v13, v14 bitop3:0xea
    ds_add_u32 v32, v2
    v_mul_hi_u32_u24 v14, 429497, v29
    v_lshrrev_b32 v12, 3, v33
    v_cos_f32 v8, v8
    v_lshlrev_b16 v13, 3, v33
    v_mad_i32_i24 v11, v14, s55, v29
    v_bitop3_b32 v12, v6, v13, v12 bitop3:0xca
    v_lshl_add_u32 v11, v11, 17, s40
    v_lshlrev_b16 v14, 8, v14
    v_lshrrev_b32 v13, 2, v33
    v_add_u32 v29, v12, v11
    v_bitop3_b32 v33, v5, v13, v14 bitop3:0xea
    ds_add_u32 v33, v2
    v_cvt_pk_bf16_f32 v24, v7, v8
    v_perm_b32 v12, v24, v24, s41
    v_bitop3_b32 v28, v4, v12, v28 bitop3:0xca
    v_perm_b32 v13, v24, v24, s42
    v_bitop3_b32 v29, v4, v13, v29 bitop3:0xca
    v_mul_hi_u32_u24 v14, 429497, v30
    v_lshrrev_b32 v12, 3, v34
    v_cos_f32 v9, v9
    v_lshlrev_b16 v13, 3, v34
    v_mad_i32_i24 v11, v14, s55, v30
    v_bitop3_b32 v12, v6, v13, v12 bitop3:0xca
    v_lshl_add_u32 v11, v11, 17, s40
    v_lshlrev_b16 v14, 8, v14
    v_lshrrev_b32 v13, 2, v34
    v_add_u32 v30, v12, v11
    v_bitop3_b32 v34, v5, v13, v14 bitop3:0xea
    ds_add_u32 v34, v2
    v_mul_hi_u32_u24 v14, 429497, v31
    v_lshrrev_b32 v12, 3, v35
    v_cos_f32 v10, v10
    v_lshlrev_b16 v13, 3, v35
    v_mad_i32_i24 v11, v14, s55, v31
    v_bitop3_b32 v12, v6, v13, v12 bitop3:0xca
    v_lshl_add_u32 v11, v11, 17, s40
    v_lshlrev_b16 v14, 8, v14
    v_lshrrev_b32 v13, 2, v35
    v_add_u32 v31, v12, v11
    v_bitop3_b32 v35, v5, v13, v14 bitop3:0xea
    ds_add_u32 v35, v2
    v_cvt_pk_bf16_f32 v25, v9, v10
    v_perm_b32 v12, v25, v25, s41
    v_bitop3_b32 v30, v4, v12, v30 bitop3:0xca
    v_perm_b32 v13, v25, v25, s42
    v_bitop3_b32 v31, v4, v13, v31 bitop3:0xca
    s_waitcnt vmcnt(10)
    v_lshlrev_b32 v7, 16, v26
    v_and_b32 v8, 0xffff0000, v26
    v_lshlrev_b32 v9, 16, v27
    v_and_b32 v10, 0xffff0000, v27
    v_mul_f32 v7, 0.15915494, v7
    v_mul_f32 v8, 0.15915494, v8
    v_mul_f32 v9, 0.15915494, v9
    v_mul_f32 v10, 0.15915494, v10
    v_mul_hi_u32_u24 v14, 429497, v36
    v_lshrrev_b32 v12, 3, v40
    v_cos_f32 v7, v7
    v_lshlrev_b16 v13, 3, v40
    v_mad_i32_i24 v11, v14, s55, v36
    v_bitop3_b32 v12, v6, v13, v12 bitop3:0xca
    v_lshl_add_u32 v11, v11, 17, s40
    v_lshlrev_b16 v14, 8, v14
    v_lshrrev_b32 v13, 2, v40
    v_add_u32 v36, v12, v11
    v_bitop3_b32 v40, v5, v13, v14 bitop3:0xea
    ds_add_u32 v40, v2
    v_mul_hi_u32_u24 v14, 429497, v37
    v_lshrrev_b32 v12, 3, v41
    v_cos_f32 v8, v8
    v_lshlrev_b16 v13, 3, v41
    v_mad_i32_i24 v11, v14, s55, v37
    v_bitop3_b32 v12, v6, v13, v12 bitop3:0xca
    v_lshl_add_u32 v11, v11, 17, s40
    v_lshlrev_b16 v14, 8, v14
    v_lshrrev_b32 v13, 2, v41
    v_add_u32 v37, v12, v11
    v_bitop3_b32 v41, v5, v13, v14 bitop3:0xea
    ds_add_u32 v41, v2
    v_cvt_pk_bf16_f32 v26, v7, v8
    v_perm_b32 v12, v26, v26, s41
    v_bitop3_b32 v36, v4, v12, v36 bitop3:0xca
    v_perm_b32 v13, v26, v26, s42
    v_bitop3_b32 v37, v4, v13, v37 bitop3:0xca
    v_mul_hi_u32_u24 v14, 429497, v38
    v_lshrrev_b32 v12, 3, v42
    v_cos_f32 v9, v9
    v_lshlrev_b16 v13, 3, v42
    v_mad_i32_i24 v11, v14, s55, v38
    v_bitop3_b32 v12, v6, v13, v12 bitop3:0xca
    v_lshl_add_u32 v11, v11, 17, s40
    v_lshlrev_b16 v14, 8, v14
    v_lshrrev_b32 v13, 2, v42
    v_add_u32 v38, v12, v11
    v_bitop3_b32 v42, v5, v13, v14 bitop3:0xea
    ds_add_u32 v42, v2
    v_mul_hi_u32_u24 v14, 429497, v39
    v_lshrrev_b32 v12, 3, v43
    v_cos_f32 v10, v10
    v_lshlrev_b16 v13, 3, v43
    v_mad_i32_i24 v11, v14, s55, v39
    v_bitop3_b32 v12, v6, v13, v12 bitop3:0xca
    v_lshl_add_u32 v11, v11, 17, s40
    v_lshlrev_b16 v14, 8, v14
    v_lshrrev_b32 v13, 2, v43
    v_add_u32 v39, v12, v11
    v_bitop3_b32 v43, v5, v13, v14 bitop3:0xea
    ds_add_u32 v43, v2
    v_cvt_pk_bf16_f32 v27, v9, v10
    v_perm_b32 v12, v27, v27, s41
    v_bitop3_b32 v38, v4, v12, v38 bitop3:0xca
    v_perm_b32 v13, v27, v27, s42
    v_bitop3_b32 v39, v4, v13, v39 bitop3:0xca
    s_setprio 0
    s_add_u32 s45, s35, 0xc000
    buffer_store_dwordx4 v[72:75], v0, s[20:23], s45 offen sc1
    s_add_u32 s46, s33, 0x4000000
    s_nop 0
    buffer_load_dwordx4 v[72:75], v0, s[12:15], s46 offen nt
    s_waitcnt vmcnt(8)
    v_lshlrev_b32 v7, 16, v44
    v_and_b32 v8, 0xffff0000, v44
    v_lshlrev_b32 v9, 16, v45
    v_and_b32 v10, 0xffff0000, v45
    v_mul_f32 v7, 0.15915494, v7
    v_mul_f32 v8, 0.15915494, v8
    v_mul_f32 v9, 0.15915494, v9
    v_mul_f32 v10, 0.15915494, v10
    v_mul_hi_u32_u24 v14, 429497, v48
    v_lshrrev_b32 v12, 3, v52
    v_cos_f32 v7, v7
    v_lshlrev_b16 v13, 3, v52
    v_mad_i32_i24 v11, v14, s55, v48
    v_bitop3_b32 v12, v6, v13, v12 bitop3:0xca
    v_lshl_add_u32 v11, v11, 17, s40
    v_lshlrev_b16 v14, 8, v14
    v_lshrrev_b32 v13, 2, v52
    v_add_u32 v48, v12, v11
    v_bitop3_b32 v52, v5, v13, v14 bitop3:0xea
    ds_add_u32 v52, v2
    v_mul_hi_u32_u24 v14, 429497, v49
    v_lshrrev_b32 v12, 3, v53
    v_cos_f32 v8, v8
    v_lshlrev_b16 v13, 3, v53
    v_mad_i32_i24 v11, v14, s55, v49
    v_bitop3_b32 v12, v6, v13, v12 bitop3:0xca
    v_lshl_add_u32 v11, v11, 17, s40
    v_lshlrev_b16 v14, 8, v14
    v_lshrrev_b32 v13, 2, v53
    v_add_u32 v49, v12, v11
    v_bitop3_b32 v53, v5, v13, v14 bitop3:0xea
    ds_add_u32 v53, v2
    v_cvt_pk_bf16_f32 v44, v7, v8
    v_perm_b32 v12, v44, v44, s41
    v_bitop3_b32 v48, v4, v12, v48 bitop3:0xca
    v_perm_b32 v13, v44, v44, s42
    v_bitop3_b32 v49, v4, v13, v49 bitop3:0xca
    v_mul_hi_u32_u24 v14, 429497, v50
    v_lshrrev_b32 v12, 3, v54
    v_cos_f32 v9, v9
    v_lshlrev_b16 v13, 3, v54
    v_mad_i32_i24 v11, v14, s55, v50
    v_bitop3_b32 v12, v6, v13, v12 bitop3:0xca
    v_lshl_add_u32 v11, v11, 17, s40
    v_lshlrev_b16 v14, 8, v14
    v_lshrrev_b32 v13, 2, v54
    v_add_u32 v50, v12, v11
    v_bitop3_b32 v54, v5, v13, v14 bitop3:0xea
    ds_add_u32 v54, v2
    v_mul_hi_u32_u24 v14, 429497, v51
    v_lshrrev_b32 v12, 3, v55
    v_cos_f32 v10, v10
    v_lshlrev_b16 v13, 3, v55
    v_mad_i32_i24 v11, v14, s55, v51
    v_bitop3_b32 v12, v6, v13, v12 bitop3:0xca
    v_lshl_add_u32 v11, v11, 17, s40
    v_lshlrev_b16 v14, 8, v14
    v_lshrrev_b32 v13, 2, v55
    v_add_u32 v51, v12, v11
    v_bitop3_b32 v55, v5, v13, v14 bitop3:0xea
    ds_add_u32 v55, v2
    v_cvt_pk_bf16_f32 v45, v9, v10
    v_perm_b32 v12, v45, v45, s41
    v_bitop3_b32 v50, v4, v12, v50 bitop3:0xca
    v_perm_b32 v13, v45, v45, s42
    v_bitop3_b32 v51, v4, v13, v51 bitop3:0xca
    s_waitcnt vmcnt(4)
    v_lshlrev_b32 v7, 16, v46
    v_and_b32 v8, 0xffff0000, v46
    v_lshlrev_b32 v9, 16, v47
    v_and_b32 v10, 0xffff0000, v47
    v_mul_f32 v7, 0.15915494, v7
    v_mul_f32 v8, 0.15915494, v8
    v_mul_f32 v9, 0.15915494, v9
    v_mul_f32 v10, 0.15915494, v10
    v_mul_hi_u32_u24 v14, 429497, v56
    v_lshrrev_b32 v12, 3, v60
    v_cos_f32 v7, v7
    v_lshlrev_b16 v13, 3, v60
    v_mad_i32_i24 v11, v14, s55, v56
    v_bitop3_b32 v12, v6, v13, v12 bitop3:0xca
    v_lshl_add_u32 v11, v11, 17, s40
    v_lshlrev_b16 v14, 8, v14
    v_lshrrev_b32 v13, 2, v60
    v_add_u32 v56, v12, v11
    v_bitop3_b32 v60, v5, v13, v14 bitop3:0xea
    ds_add_u32 v60, v2
    v_mul_hi_u32_u24 v14, 429497, v57
    v_lshrrev_b32 v12, 3, v61
    v_cos_f32 v8, v8
    v_lshlrev_b16 v13, 3, v61
    v_mad_i32_i24 v11, v14, s55, v57
    v_bitop3_b32 v12, v6, v13, v12 bitop3:0xca
    v_lshl_add_u32 v11, v11, 17, s40
    v_lshlrev_b16 v14, 8, v14
    v_lshrrev_b32 v13, 2, v61
    v_add_u32 v57, v12, v11
    v_bitop3_b32 v61, v5, v13, v14 bitop3:0xea
    ds_add_u32 v61, v2
    v_cvt_pk_bf16_f32 v46, v7, v8
    v_perm_b32 v12, v46, v46, s41
    v_bitop3_b32 v56, v4, v12, v56 bitop3:0xca
    v_perm_b32 v13, v46, v46, s42
    v_bitop3_b32 v57, v4, v13, v57 bitop3:0xca
    v_mul_hi_u32_u24 v14, 429497, v58
    v_lshrrev_b32 v12, 3, v62
    v_cos_f32 v9, v9
    v_lshlrev_b16 v13, 3, v62
    v_mad_i32_i24 v11, v14, s55, v58
    v_bitop3_b32 v12, v6, v13, v12 bitop3:0xca
    v_lshl_add_u32 v11, v11, 17, s40
    v_lshlrev_b16 v14, 8, v14
    v_lshrrev_b32 v13, 2, v62
    v_add_u32 v58, v12, v11
    v_bitop3_b32 v62, v5, v13, v14 bitop3:0xea
    ds_add_u32 v62, v2
    v_mul_hi_u32_u24 v14, 429497, v59
    v_lshrrev_b32 v12, 3, v63
    v_cos_f32 v10, v10
    v_lshlrev_b16 v13, 3, v63
    v_mad_i32_i24 v11, v14, s55, v59
    v_bitop3_b32 v12, v6, v13, v12 bitop3:0xca
    v_lshl_add_u32 v11, v11, 17, s40
    v_lshlrev_b16 v14, 8, v14
    v_lshrrev_b32 v13, 2, v63
    v_add_u32 v59, v12, v11
    v_bitop3_b32 v63, v5, v13, v14 bitop3:0xea
    ds_add_u32 v63, v2
    v_cvt_pk_bf16_f32 v47, v9, v10
    v_perm_b32 v12, v47, v47, s41
    v_bitop3_b32 v58, v4, v12, v58 bitop3:0xca
    v_perm_b32 v13, v47, v47, s42
    v_bitop3_b32 v59, v4, v13, v59 bitop3:0xca
    v_lshrrev_b32 v8, 2, v0
    v_and_b32 v7, 0x3c00, v0
    v_bitop3_b32 v7, v5, v8, v7 bitop3:0xea
    s_waitcnt lgkmcnt(0)
    s_barrier
    ds_read2st64_b32 v[8:9], v7 offset0:0 offset1:1
    ds_read2st64_b32 v[10:11], v7 offset0:2 offset1:3
    s_add_u32 s47, s35, 0x10000
    buffer_store_dwordx4 v[64:67], v0, s[20:23], s47 offen sc1
    s_add_u32 s44, s34, 0x2000000
    s_nop 0
    buffer_load_dwordx2 v[64:65], v1, s[16:19], s44 offen nt
    s_add_u32 s45, s34, 0x2200000
    buffer_load_dwordx2 v[66:67], v1, s[16:19], s45 offen nt
    s_waitcnt lgkmcnt(0)
    v_lshl_or_b32 v12, v9, 16, v8
    v_lshl_or_b32 v13, v11, 16, v10
    v_mov_b32 v14, v12
    v_mov_b32 v15, v13
    s_nop 0
    v_add_u32_dpp v14, v14, v14 row_shr:1 row_mask:0xf bank_mask:0xf bound_ctrl:1
    v_add_u32_dpp v15, v15, v15 row_shr:1 row_mask:0xf bank_mask:0xf bound_ctrl:1
    s_nop 0
    v_add_u32_dpp v14, v14, v14 row_shr:2 row_mask:0xf bank_mask:0xf bound_ctrl:1
    v_add_u32_dpp v15, v15, v15 row_shr:2 row_mask:0xf bank_mask:0xf bound_ctrl:1
    s_nop 0
    v_add_u32_dpp v14, v14, v14 row_shr:4 row_mask:0xf bank_mask:0xf bound_ctrl:1
    v_add_u32_dpp v15, v15, v15 row_shr:4 row_mask:0xf bank_mask:0xf bound_ctrl:1
    s_nop 0
    v_add_u32_dpp v14, v14, v14 row_shr:8 row_mask:0xf bank_mask:0xf bound_ctrl:1
    v_add_u32_dpp v15, v15, v15 row_shr:8 row_mask:0xf bank_mask:0xf bound_ctrl:1
    s_nop 0
    v_add_u32_dpp v14, v14, v14 row_bcast:15 row_mask:0xa bank_mask:0xf
    v_add_u32_dpp v15, v15, v15 row_bcast:15 row_mask:0xa bank_mask:0xf
    s_nop 0
    v_add_u32_dpp v14, v14, v14 row_bcast:31 row_mask:0xc bank_mask:0xf
    v_add_u32_dpp v15, v15, v15 row_bcast:31 row_mask:0xc bank_mask:0xf
    v_readlane_b32 s48, v14, 63
    v_readlane_b32 s49, v15, 63
    s_lshl_b32 s54, s32, 2
    v_mov_b32 v8, s54
    s_and_b32 s50, s48, 0xffff
    s_lshr_b32 s51, s48, 16
    s_and_b32 s52, s49, 0xffff
    s_lshr_b32 s53, s49, 16
    s_add_u32 s51, s51, s50
    s_add_u32 s52, s52, s51
    s_add_u32 s53, s53, s52
    v_mov_b32 v9, s53
    s_mov_b64 exec, 1
    ds_write_b32 v8, v9 offset:16384
    s_mov_b64 exec, -1
    v_and_b32 v8, 60, v7
    s_waitcnt lgkmcnt(0)
    s_barrier
    ds_read_b32 v9, v8 offset:16384
    s_waitcnt lgkmcnt(0)
    v_add_u32_dpp v9, v9, v9 row_shr:1 row_mask:0xf bank_mask:0xf bound_ctrl:1
    s_nop 1
    v_add_u32_dpp v9, v9, v9 row_shr:2 row_mask:0xf bank_mask:0xf bound_ctrl:1
    s_nop 1
    v_add_u32_dpp v9, v9, v9 row_shr:4 row_mask:0xf bank_mask:0xf bound_ctrl:1
    s_nop 1
    v_add_u32_dpp v9, v9, v9 row_shr:8 row_mask:0xf bank_mask:0xf bound_ctrl:1
    s_nop 0
    v_readlane_b32 s54, v9, s32
    s_sub_u32 s54, s54, s53
    s_add_u32 s50, s50, s54
    s_add_u32 s51, s51, s54
    s_add_u32 s52, s52, s54
    s_pack_ll_b32_b16 s48, s54, s50
    s_pack_ll_b32_b16 s49, s51, s52
    v_add_u32 v14, s48, v14
    v_add_u32 v15, s49, v15
    v_sub_u32 v12, v14, v12
    v_sub_u32 v13, v15, v13
    v_and_b32 v8, 0xffff, v12
    v_lshrrev_b32 v9, 16, v12
    v_and_b32 v10, 0xffff, v13
    v_lshrrev_b32 v11, 16, v13
    ds_write2st64_b32 v7, v8, v9 offset0:0 offset1:1
    ds_write2st64_b32 v7, v10, v11 offset0:2 offset1:3
    v_and_b32 v8, 0x3f0, v0
    v_lshl_add_u32 v8, v8, 1, s36
    ds_write_b64 v8, v[12:13] offset:20480
    s_bitset0_b64 exec, 63
    s_not_b64 exec, exec
    ds_write_b64 v8, v[14:15] offset:20512
    s_mov_b64 exec, -1
    s_waitcnt lgkmcnt(0)
    s_barrier
    s_setprio 3
    ds_add_rtn_u32 v104, v104, v2
    ds_add_rtn_u32 v105, v105, v2
    ds_add_rtn_u32 v106, v106, v2
    ds_add_rtn_u32 v107, v107, v2
    ds_read_b128 v[12:15], v0 offset:20480
    v_cmp_gt_u32 vcc, 8448, v0
    ds_add_rtn_u32 v100, v100, v2
    ds_add_rtn_u32 v101, v101, v2
    ds_add_rtn_u32 v102, v102, v2
    ds_add_rtn_u32 v103, v103, v2
    s_setprio 2
    ds_add_rtn_u32 v120, v120, v2
    ds_add_rtn_u32 v121, v121, v2
    ds_add_rtn_u32 v122, v122, v2
    ds_add_rtn_u32 v123, v123, v2
    s_waitcnt lgkmcnt(8)
    s_cbranch_vccz L1_p2
    s_add_u32 s46, s35, 0x2a40000
    s_mov_b64 exec, vcc
    buffer_store_dwordx4 v[12:15], v0, s[24:27], s46 offen sc1
    s_mov_b64 exec, -1
L1_p2:
    s_add_u32 s47, s35, 0x14000
    buffer_store_dwordx4 v[76:79], v0, s[20:23], s47 offen sc1
    s_add_u32 s44, s33, 0x4400000
    s_nop 0
    buffer_load_dwordx4 v[76:79], v0, s[8:11], s44 offen nt
    ds_add_rtn_u32 v20, v20, v2
    ds_add_rtn_u32 v21, v21, v2
    ds_add_rtn_u32 v22, v22, v2
    ds_add_rtn_u32 v23, v23, v2
    s_setprio 1
    ds_add_rtn_u32 v32, v32, v2
    ds_add_rtn_u32 v33, v33, v2
    ds_add_rtn_u32 v34, v34, v2
    ds_add_rtn_u32 v35, v35, v2
    ds_add_rtn_u32 v40, v40, v2
    ds_add_rtn_u32 v41, v41, v2
    ds_add_rtn_u32 v42, v42, v2
    ds_add_rtn_u32 v43, v43, v2
    s_add_u32 s45, s35, 0x18000
    buffer_store_dwordx4 v[80:83], v0, s[20:23], s45 offen sc1
    s_add_u32 s46, s33, 0x4400000
    s_nop 0
    buffer_load_dwordx4 v[80:83], v0, s[12:15], s46 offen nt
    s_setprio 0
    ds_add_rtn_u32 v52, v52, v2
    ds_add_rtn_u32 v53, v53, v2
    ds_add_rtn_u32 v54, v54, v2
    ds_add_rtn_u32 v55, v55, v2
    ds_add_rtn_u32 v60, v60, v2
    ds_add_rtn_u32 v61, v61, v2
    ds_add_rtn_u32 v62, v62, v2
    ds_add_rtn_u32 v63, v63, v2
    s_waitcnt lgkmcnt(0)
    s_barrier
    s_setprio 3
    v_and_b32 v7, -4, v104
    v_lshl_add_u32 v8, v104, 2, v7
    ds_write_b32 v8, v96
    v_lshl_add_u32 v7, v7, 2, v104
    ds_write_b8 v7, v108 offset:16
    v_and_b32 v9, -4, v105
    v_lshl_add_u32 v10, v105, 2, v9
    ds_write_b32 v10, v97
    v_lshl_add_u32 v9, v9, 2, v105
    ds_write_b8_d16_hi v9, v108 offset:16
    v_and_b32 v7, -4, v106
    v_lshl_add_u32 v8, v106, 2, v7
    ds_write_b32 v8, v98
    v_lshl_add_u32 v7, v7, 2, v106
    ds_write_b8 v7, v109 offset:16
    v_and_b32 v9, -4, v107
    v_lshl_add_u32 v10, v107, 2, v9
    ds_write_b32 v10, v99
    v_lshl_add_u32 v9, v9, 2, v107
    ds_write_b8_d16_hi v9, v109 offset:16
    s_add_u32 s47, s35, 0x1c000
    buffer_store_dwordx4 v[88:91], v0, s[20:23], s47 offen sc1
    s_add_u32 s44, s33, 0x4800000
    buffer_load_dwordx4 v[96:99], v0, s[8:11], s44 offen nt
    s_add_u32 s45, s33, 0x4800000
    buffer_load_dwordx4 v[104:107], v0, s[12:15], s45 offen nt
    v_and_b32 v7, -4, v100
    v_lshl_add_u32 v8, v100, 2, v7
    ds_write_b32 v8, v112
    v_lshl_add_u32 v7, v7, 2, v100
    ds_write_b8 v7, v110 offset:16
    v_and_b32 v9, -4, v101
    v_lshl_add_u32 v10, v101, 2, v9
    ds_write_b32 v10, v113
    v_lshl_add_u32 v9, v9, 2, v101
    ds_write_b8_d16_hi v9, v110 offset:16
    v_and_b32 v7, -4, v102
    v_lshl_add_u32 v8, v102, 2, v7
    ds_write_b32 v8, v114
    v_lshl_add_u32 v7, v7, 2, v102
    ds_write_b8 v7, v111 offset:16
    v_and_b32 v9, -4, v103
    v_lshl_add_u32 v10, v103, 2, v9
    ds_write_b32 v10, v115
    v_lshl_add_u32 v9, v9, 2, v103
    ds_write_b8_d16_hi v9, v111 offset:16
    s_add_u32 s46, s34, 0x2400000
    buffer_load_dwordx2 v[88:89], v1, s[16:19], s46 offen nt
    s_add_u32 s47, s34, 0x2600000
    buffer_load_dwordx2 v[90:91], v1, s[16:19], s47 offen nt
    s_add_u32 s44, s33, 0x4c00000
    buffer_load_dwordx4 v[112:115], v0, s[8:11], s44 offen nt
    s_setprio 2
    v_and_b32 v7, -4, v120
    v_lshl_add_u32 v8, v120, 2, v7
    ds_write_b32 v8, v116
    v_lshl_add_u32 v7, v7, 2, v120
    ds_write_b8 v7, v124 offset:16
    v_and_b32 v9, -4, v121
    v_lshl_add_u32 v10, v121, 2, v9
    ds_write_b32 v10, v117
    v_lshl_add_u32 v9, v9, 2, v121
    ds_write_b8_d16_hi v9, v124 offset:16
    v_and_b32 v7, -4, v122
    v_lshl_add_u32 v8, v122, 2, v7
    ds_write_b32 v8, v118
    v_lshl_add_u32 v7, v7, 2, v122
    ds_write_b8 v7, v125 offset:16
    v_and_b32 v9, -4, v123
    v_lshl_add_u32 v10, v123, 2, v9
    ds_write_b32 v10, v119
    v_lshl_add_u32 v9, v9, 2, v123
    ds_write_b8_d16_hi v9, v125 offset:16
    s_add_u32 s45, s35, 0x20000
    buffer_store_dwordx4 v[92:95], v0, s[20:23], s45 offen sc1
    s_add_u32 s46, s33, 0x4c00000
    buffer_load_dwordx4 v[100:103], v0, s[12:15], s46 offen nt
    v_and_b32 v7, -4, v20
    v_lshl_add_u32 v8, v20, 2, v7
    ds_write_b32 v8, v16
    v_lshl_add_u32 v7, v7, 2, v20
    ds_write_b8 v7, v126 offset:16
    v_and_b32 v9, -4, v21
    v_lshl_add_u32 v10, v21, 2, v9
    ds_write_b32 v10, v17
    v_lshl_add_u32 v9, v9, 2, v21
    ds_write_b8_d16_hi v9, v126 offset:16
    v_and_b32 v7, -4, v22
    v_lshl_add_u32 v8, v22, 2, v7
    ds_write_b32 v8, v18
    v_lshl_add_u32 v7, v7, 2, v22
    ds_write_b8 v7, v127 offset:16
    v_and_b32 v9, -4, v23
    v_lshl_add_u32 v10, v23, 2, v9
    ds_write_b32 v10, v19
    v_lshl_add_u32 v9, v9, 2, v23
    ds_write_b8_d16_hi v9, v127 offset:16
    s_add_u32 s47, s33, 0x5000000
    buffer_load_dwordx4 v[108:111], v0, s[8:11], s47 offen nt
    s_add_u32 s44, s33, 0x5000000
    buffer_load_dwordx4 v[116:119], v0, s[12:15], s44 offen nt
    s_setprio 1
    v_and_b32 v7, -4, v32
    v_lshl_add_u32 v8, v32, 2, v7
    ds_write_b32 v8, v28
    v_lshl_add_u32 v7, v7, 2, v32
    ds_write_b8 v7, v24 offset:16
    v_and_b32 v9, -4, v33
    v_lshl_add_u32 v10, v33, 2, v9
    ds_write_b32 v10, v29
    v_lshl_add_u32 v9, v9, 2, v33
    ds_write_b8_d16_hi v9, v24 offset:16
    v_and_b32 v7, -4, v34
    v_lshl_add_u32 v8, v34, 2, v7
    ds_write_b32 v8, v30
    v_lshl_add_u32 v7, v7, 2, v34
    ds_write_b8 v7, v25 offset:16
    v_and_b32 v9, -4, v35
    v_lshl_add_u32 v10, v35, 2, v9
    ds_write_b32 v10, v31
    v_lshl_add_u32 v9, v9, 2, v35
    ds_write_b8_d16_hi v9, v25 offset:16
    s_add_u32 s45, s34, 0x2800000
    buffer_load_dwordx2 v[120:121], v1, s[16:19], s45 offen nt
    s_add_u32 s46, s34, 0x2a00000
    buffer_load_dwordx2 v[122:123], v1, s[16:19], s46 offen nt
    s_add_u32 s47, s33, 0x5400000
    buffer_load_dwordx4 v[92:95], v0, s[8:11], s47 offen nt
    v_and_b32 v7, -4, v40
    v_lshl_add_u32 v8, v40, 2, v7
    ds_write_b32 v8, v36
    v_lshl_add_u32 v7, v7, 2, v40
    ds_write_b8 v7, v26 offset:16
    v_and_b32 v9, -4, v41
    v_lshl_add_u32 v10, v41, 2, v9
    ds_write_b32 v10, v37
    v_lshl_add_u32 v9, v9, 2, v41
    ds_write_b8_d16_hi v9, v26 offset:16
    v_and_b32 v7, -4, v42
    v_lshl_add_u32 v8, v42, 2, v7
    ds_write_b32 v8, v38
    v_lshl_add_u32 v7, v7, 2, v42
    ds_write_b8 v7, v27 offset:16
    v_and_b32 v9, -4, v43
    v_lshl_add_u32 v10, v43, 2, v9
    ds_write_b32 v10, v39
    v_lshl_add_u32 v9, v9, 2, v43
    ds_write_b8_d16_hi v9, v27 offset:16
    s_add_u32 s44, s35, 0x24000
    buffer_store_dwordx4 v[84:87], v0, s[20:23], s44 offen sc1
    s_add_u32 s45, s33, 0x5400000
    buffer_load_dwordx4 v[16:19], v0, s[12:15], s45 offen nt
    s_setprio 0
    v_and_b32 v7, -4, v52
    v_lshl_add_u32 v8, v52, 2, v7
    ds_write_b32 v8, v48
    v_lshl_add_u32 v7, v7, 2, v52
    ds_write_b8 v7, v44 offset:16
    v_and_b32 v9, -4, v53
    v_lshl_add_u32 v10, v53, 2, v9
    ds_write_b32 v10, v49
    v_lshl_add_u32 v9, v9, 2, v53
    ds_write_b8_d16_hi v9, v44 offset:16
    v_and_b32 v7, -4, v54
    v_lshl_add_u32 v8, v54, 2, v7
    ds_write_b32 v8, v50
    v_lshl_add_u32 v7, v7, 2, v54
    ds_write_b8 v7, v45 offset:16
    v_and_b32 v9, -4, v55
    v_lshl_add_u32 v10, v55, 2, v9
    ds_write_b32 v10, v51
    v_lshl_add_u32 v9, v9, 2, v55
    ds_write_b8_d16_hi v9, v45 offset:16
    s_add_u32 s46, s33, 0x5800000
    buffer_load_dwordx4 v[20:23], v0, s[8:11], s46 offen nt
    s_add_u32 s47, s33, 0x5800000
    buffer_load_dwordx4 v[124:127], v0, s[12:15], s47 offen nt
    v_and_b32 v7, -4, v60
    v_lshl_add_u32 v8, v60, 2, v7
    ds_write_b32 v8, v56
    v_lshl_add_u32 v7, v7, 2, v60
    ds_write_b8 v7, v46 offset:16
    v_and_b32 v9, -4, v61
    v_lshl_add_u32 v10, v61, 2, v9
    ds_write_b32 v10, v57
    v_lshl_add_u32 v9, v9, 2, v61
    ds_write_b8_d16_hi v9, v46 offset:16
    v_and_b32 v7, -4, v62
    v_lshl_add_u32 v8, v62, 2, v7
    ds_write_b32 v8, v58
    v_lshl_add_u32 v7, v7, 2, v62
    ds_write_b8 v7, v47 offset:16
    v_and_b32 v9, -4, v63
    v_lshl_add_u32 v10, v63, 2, v9
    ds_write_b32 v10, v59
    v_lshl_add_u32 v9, v9, 2, v63
    ds_write_b8_d16_hi v9, v47 offset:16
    s_add_u32 s44, s34, 0x2c00000
    buffer_load_dwordx2 v[28:29], v1, s[16:19], s44 offen nt
    s_add_u32 s45, s34, 0x2e00000
    buffer_load_dwordx2 v[30:31], v1, s[16:19], s45 offen nt
    v_add_u32 v7, 0x10000, v0
    v_add_u32 v12, 0x20000, v0
    v_mov_b32 v8, 0
    v_mov_b32 v9, 0
    v_mov_b32 v10, 0
    v_mov_b32 v11, 0
    s_waitcnt lgkmcnt(0)
    s_barrier
    ds_read_b128 v[32:35], v0 offset:0
    ds_write_b128 v0, v[8:11]
    ds_read_b128 v[36:39], v0 offset:16384
    ds_read_b128 v[40:43], v0 offset:32768
    ds_read_b128 v[24:27], v0 offset:49152
    ds_read_b128 v[84:87], v7 offset:0
    ds_read_b128 v[48:51], v7 offset:16384
    ds_read_b128 v[52:55], v7 offset:32768
    ds_read_b128 v[56:59], v7 offset:49152
    ds_read_b128 v[60:63], v12 offset:0
    ds_read_b128 v[44:47], v12 offset:16384
    s_waitcnt lgkmcnt(0)
    s_barrier
    s_setprio 3
    s_add_u32 s46, s35, 0x2a40000
    buffer_store_dwordx4 v[32:35], v0, s[20:23], s46 offen sc1
    s_add_u32 s47, s33, 0x5c00000
    s_nop 0
    buffer_load_dwordx4 v[32:35], v0, s[8:11], s47 offen nt
    s_add_u32 s44, s35, 0x2a44000
    buffer_store_dwordx4 v[36:39], v0, s[20:23], s44 offen sc1
    s_add_u32 s45, s33, 0x5c00000
    s_nop 0
    buffer_load_dwordx4 v[36:39], v0, s[12:15], s45 offen nt
    s_waitcnt vmcnt(27)
    v_lshlrev_b32 v7, 16, v64
    v_and_b32 v8, 0xffff0000, v64
    v_lshlrev_b32 v9, 16, v65
    v_and_b32 v10, 0xffff0000, v65
    v_mul_f32 v7, 0.15915494, v7
    v_mul_f32 v8, 0.15915494, v8
    v_mul_f32 v9, 0.15915494, v9
    v_mul_f32 v10, 0.15915494, v10
    v_mul_hi_u32_u24 v14, 429497, v68
    v_lshrrev_b32 v12, 3, v72
    v_cos_f32 v7, v7
    v_lshlrev_b16 v13, 3, v72
    v_mad_i32_i24 v11, v14, s55, v68
    v_bitop3_b32 v12, v6, v13, v12 bitop3:0xca
    v_lshl_add_u32 v11, v11, 17, s40
    v_lshlrev_b16 v14, 8, v14
    v_lshrrev_b32 v13, 2, v72
    v_add_u32 v68, v12, v11
    v_bitop3_b32 v72, v5, v13, v14 bitop3:0xea
    ds_add_u32 v72, v2
    v_mul_hi_u32_u24 v14, 429497, v69
    v_lshrrev_b32 v12, 3, v73
    v_cos_f32 v8, v8
    v_lshlrev_b16 v13, 3, v73
    v_mad_i32_i24 v11, v14, s55, v69
    v_bitop3_b32 v12, v6, v13, v12 bitop3:0xca
    v_lshl_add_u32 v11, v11, 17, s40
    v_lshlrev_b16 v14, 8, v14
    v_lshrrev_b32 v13, 2, v73
    v_add_u32 v69, v12, v11
    v_bitop3_b32 v73, v5, v13, v14 bitop3:0xea
    ds_add_u32 v73, v2
    v_cvt_pk_bf16_f32 v64, v7, v8
    v_perm_b32 v12, v64, v64, s41
    v_bitop3_b32 v68, v4, v12, v68 bitop3:0xca
    v_perm_b32 v13, v64, v64, s42
    v_bitop3_b32 v69, v4, v13, v69 bitop3:0xca
    v_mul_hi_u32_u24 v14, 429497, v70
    v_lshrrev_b32 v12, 3, v74
    v_cos_f32 v9, v9
    v_lshlrev_b16 v13, 3, v74
    v_mad_i32_i24 v11, v14, s55, v70
    v_bitop3_b32 v12, v6, v13, v12 bitop3:0xca
    v_lshl_add_u32 v11, v11, 17, s40
    v_lshlrev_b16 v14, 8, v14
    v_lshrrev_b32 v13, 2, v74
    v_add_u32 v70, v12, v11
    v_bitop3_b32 v74, v5, v13, v14 bitop3:0xea
    ds_add_u32 v74, v2
    v_mul_hi_u32_u24 v14, 429497, v71
    v_lshrrev_b32 v12, 3, v75
    v_cos_f32 v10, v10
    v_lshlrev_b16 v13, 3, v75
    v_mad_i32_i24 v11, v14, s55, v71
    v_bitop3_b32 v12, v6, v13, v12 bitop3:0xca
    v_lshl_add_u32 v11, v11, 17, s40
    v_lshlrev_b16 v14, 8, v14
    v_lshrrev_b32 v13, 2, v75
    v_add_u32 v71, v12, v11
    v_bitop3_b32 v75, v5, v13, v14 bitop3:0xea
    ds_add_u32 v75, v2
    v_cvt_pk_bf16_f32 v65, v9, v10
    v_perm_b32 v12, v65, v65, s41
    v_bitop3_b32 v70, v4, v12, v70 bitop3:0xca
    v_perm_b32 v13, v65, v65, s42
    v_bitop3_b32 v71, v4, v13, v71 bitop3:0xca
    s_waitcnt vmcnt(23)
    v_lshlrev_b32 v7, 16, v66
    v_and_b32 v8, 0xffff0000, v66
    v_lshlrev_b32 v9, 16, v67
    v_and_b32 v10, 0xffff0000, v67
    v_mul_f32 v7, 0.15915494, v7
    v_mul_f32 v8, 0.15915494, v8
    v_mul_f32 v9, 0.15915494, v9
    v_mul_f32 v10, 0.15915494, v10
    v_mul_hi_u32_u24 v14, 429497, v76
    v_lshrrev_b32 v12, 3, v80
    v_cos_f32 v7, v7
    v_lshlrev_b16 v13, 3, v80
    v_mad_i32_i24 v11, v14, s55, v76
    v_bitop3_b32 v12, v6, v13, v12 bitop3:0xca
    v_lshl_add_u32 v11, v11, 17, s40
    v_lshlrev_b16 v14, 8, v14
    v_lshrrev_b32 v13, 2, v80
    v_add_u32 v76, v12, v11
    v_bitop3_b32 v80, v5, v13, v14 bitop3:0xea
    ds_add_u32 v80, v2
    v_mul_hi_u32_u24 v14, 429497, v77
    v_lshrrev_b32 v12, 3, v81
    v_cos_f32 v8, v8
    v_lshlrev_b16 v13, 3, v81
    v_mad_i32_i24 v11, v14, s55, v77
    v_bitop3_b32 v12, v6, v13, v12 bitop3:0xca
    v_lshl_add_u32 v11, v11, 17, s40
    v_lshlrev_b16 v14, 8, v14
    v_lshrrev_b32 v13, 2, v81
    v_add_u32 v77, v12, v11
    v_bitop3_b32 v81, v5, v13, v14 bitop3:0xea
    ds_add_u32 v81, v2
    v_cvt_pk_bf16_f32 v66, v7, v8
    v_perm_b32 v12, v66, v66, s41
    v_bitop3_b32 v76, v4, v12, v76 bitop3:0xca
    v_perm_b32 v13, v66, v66, s42
    v_bitop3_b32 v77, v4, v13, v77 bitop3:0xca
    v_mul_hi_u32_u24 v14, 429497, v78
    v_lshrrev_b32 v12, 3, v82
    v_cos_f32 v9, v9
    v_lshlrev_b16 v13, 3, v82
    v_mad_i32_i24 v11, v14, s55, v78
    v_bitop3_b32 v12, v6, v13, v12 bitop3:0xca
    v_lshl_add_u32 v11, v11, 17, s40
    v_lshlrev_b16 v14, 8, v14
    v_lshrrev_b32 v13, 2, v82
    v_add_u32 v78, v12, v11
    v_bitop3_b32 v82, v5, v13, v14 bitop3:0xea
    ds_add_u32 v82, v2
    v_mul_hi_u32_u24 v14, 429497, v79
    v_lshrrev_b32 v12, 3, v83
    v_cos_f32 v10, v10
    v_lshlrev_b16 v13, 3, v83
    v_mad_i32_i24 v11, v14, s55, v79
    v_bitop3_b32 v12, v6, v13, v12 bitop3:0xca
    v_lshl_add_u32 v11, v11, 17, s40
    v_lshlrev_b16 v14, 8, v14
    v_lshrrev_b32 v13, 2, v83
    v_add_u32 v79, v12, v11
    v_bitop3_b32 v83, v5, v13, v14 bitop3:0xea
    ds_add_u32 v83, v2
    v_cvt_pk_bf16_f32 v67, v9, v10
    v_perm_b32 v12, v67, v67, s41
    v_bitop3_b32 v78, v4, v12, v78 bitop3:0xca
    v_perm_b32 v13, v67, v67, s42
    v_bitop3_b32 v79, v4, v13, v79 bitop3:0xca
    s_setprio 2
    s_waitcnt vmcnt(18)
    v_lshlrev_b32 v7, 16, v88
    v_and_b32 v8, 0xffff0000, v88
    v_lshlrev_b32 v9, 16, v89
    v_and_b32 v10, 0xffff0000, v89
    v_mul_f32 v7, 0.15915494, v7
    v_mul_f32 v8, 0.15915494, v8
    v_mul_f32 v9, 0.15915494, v9
    v_mul_f32 v10, 0.15915494, v10
    v_mul_hi_u32_u24 v14, 429497, v96
    v_lshrrev_b32 v12, 3, v104
    v_cos_f32 v7, v7
    v_lshlrev_b16 v13, 3, v104
    v_mad_i32_i24 v11, v14, s55, v96
    v_bitop3_b32 v12, v6, v13, v12 bitop3:0xca
    v_lshl_add_u32 v11, v11, 17, s40
    v_lshlrev_b16 v14, 8, v14
    v_lshrrev_b32 v13, 2, v104
    v_add_u32 v96, v12, v11
    v_bitop3_b32 v104, v5, v13, v14 bitop3:0xea
    ds_add_u32 v104, v2
    v_mul_hi_u32_u24 v14, 429497, v97
    v_lshrrev_b32 v12, 3, v105
    v_cos_f32 v8, v8
    v_lshlrev_b16 v13, 3, v105
    v_mad_i32_i24 v11, v14, s55, v97
    v_bitop3_b32 v12, v6, v13, v12 bitop3:0xca
    v_lshl_add_u32 v11, v11, 17, s40
    v_lshlrev_b16 v14, 8, v14
    v_lshrrev_b32 v13, 2, v105
    v_add_u32 v97, v12, v11
    v_bitop3_b32 v105, v5, v13, v14 bitop3:0xea
    ds_add_u32 v105, v2
    v_cvt_pk_bf16_f32 v88, v7, v8
    v_perm_b32 v12, v88, v88, s41
    v_bitop3_b32 v96, v4, v12, v96 bitop3:0xca
    v_perm_b32 v13, v88, v88, s42
    v_bitop3_b32 v97, v4, v13, v97 bitop3:0xca
    v_mul_hi_u32_u24 v14, 429497, v98
    v_lshrrev_b32 v12, 3, v106
    v_cos_f32 v9, v9
    v_lshlrev_b16 v13, 3, v106
    v_mad_i32_i24 v11, v14, s55, v98
    v_bitop3_b32 v12, v6, v13, v12 bitop3:0xca
    v_lshl_add_u32 v11, v11, 17, s40
    v_lshlrev_b16 v14, 8, v14
    v_lshrrev_b32 v13, 2, v106
    v_add_u32 v98, v12, v11
    v_bitop3_b32 v106, v5, v13, v14 bitop3:0xea
    ds_add_u32 v106, v2
    v_mul_hi_u32_u24 v14, 429497, v99
    v_lshrrev_b32 v12, 3, v107
    v_cos_f32 v10, v10
    v_lshlrev_b16 v13, 3, v107
    v_mad_i32_i24 v11, v14, s55, v99
    v_bitop3_b32 v12, v6, v13, v12 bitop3:0xca
    v_lshl_add_u32 v11, v11, 17, s40
    v_lshlrev_b16 v14, 8, v14
    v_lshrrev_b32 v13, 2, v107
    v_add_u32 v99, v12, v11
    v_bitop3_b32 v107, v5, v13, v14 bitop3:0xea
    ds_add_u32 v107, v2
    v_cvt_pk_bf16_f32 v89, v9, v10
    v_perm_b32 v12, v89, v89, s41
    v_bitop3_b32 v98, v4, v12, v98 bitop3:0xca
    v_perm_b32 v13, v89, v89, s42
    v_bitop3_b32 v99, v4, v13, v99 bitop3:0xca
    s_add_u32 s46, s35, 0x2a48000
    buffer_store_dwordx4 v[40:43], v0, s[20:23], s46 offen sc1
    s_add_u32 s47, s33, 0x6000000
    s_nop 0
    buffer_load_dwordx4 v[40:43], v0, s[8:11], s47 offen nt
    s_waitcnt vmcnt(17)
    v_lshlrev_b32 v7, 16, v90
    v_and_b32 v8, 0xffff0000, v90
    v_lshlrev_b32 v9, 16, v91
    v_and_b32 v10, 0xffff0000, v91
    v_mul_f32 v7, 0.15915494, v7
    v_mul_f32 v8, 0.15915494, v8
    v_mul_f32 v9, 0.15915494, v9
    v_mul_f32 v10, 0.15915494, v10
    v_mul_hi_u32_u24 v14, 429497, v112
    v_lshrrev_b32 v12, 3, v100
    v_cos_f32 v7, v7
    v_lshlrev_b16 v13, 3, v100
    v_mad_i32_i24 v11, v14, s55, v112
    v_bitop3_b32 v12, v6, v13, v12 bitop3:0xca
    v_lshl_add_u32 v11, v11, 17, s40
    v_lshlrev_b16 v14, 8, v14
    v_lshrrev_b32 v13, 2, v100
    v_add_u32 v112, v12, v11
    v_bitop3_b32 v100, v5, v13, v14 bitop3:0xea
    ds_add_u32 v100, v2
    v_mul_hi_u32_u24 v14, 429497, v113
    v_lshrrev_b32 v12, 3, v101
    v_cos_f32 v8, v8
    v_lshlrev_b16 v13, 3, v101
    v_mad_i32_i24 v11, v14, s55, v113
    v_bitop3_b32 v12, v6, v13, v12 bitop3:0xca
    v_lshl_add_u32 v11, v11, 17, s40
    v_lshlrev_b16 v14, 8, v14
    v_lshrrev_b32 v13, 2, v101
    v_add_u32 v113, v12, v11
    v_bitop3_b32 v101, v5, v13, v14 bitop3:0xea
    ds_add_u32 v101, v2
    v_cvt_pk_bf16_f32 v90, v7, v8
    v_perm_b32 v12, v90, v90, s41
    v_bitop3_b32 v112, v4, v12, v112 bitop3:0xca
    v_perm_b32 v13, v90, v90, s42
    v_bitop3_b32 v113, v4, v13, v113 bitop3:0xca
    v_mul_hi_u32_u24 v14, 429497, v114
    v_lshrrev_b32 v12, 3, v102
    v_cos_f32 v9, v9
    v_lshlrev_b16 v13, 3, v102
    v_mad_i32_i24 v11, v14, s55, v114
    v_bitop3_b32 v12, v6, v13, v12 bitop3:0xca
    v_lshl_add_u32 v11, v11, 17, s40
    v_lshlrev_b16 v14, 8, v14
    v_lshrrev_b32 v13, 2, v102
    v_add_u32 v114, v12, v11
    v_bitop3_b32 v102, v5, v13, v14 bitop3:0xea
    ds_add_u32 v102, v2
    v_mul_hi_u32_u24 v14, 429497, v115
    v_lshrrev_b32 v12, 3, v103
    v_cos_f32 v10, v10
    v_lshlrev_b16 v13, 3, v103
    v_mad_i32_i24 v11, v14, s55, v115
    v_bitop3_b32 v12, v6, v13, v12 bitop3:0xca
    v_lshl_add_u32 v11, v11, 17, s40
    v_lshlrev_b16 v14, 8, v14
    v_lshrrev_b32 v13, 2, v103
    v_add_u32 v115, v12, v11
    v_bitop3_b32 v103, v5, v13, v14 bitop3:0xea
    ds_add_u32 v103, v2
    v_cvt_pk_bf16_f32 v91, v9, v10
    v_perm_b32 v12, v91, v91, s41
    v_bitop3_b32 v114, v4, v12, v114 bitop3:0xca
    v_perm_b32 v13, v91, v91, s42
    v_bitop3_b32 v115, v4, v13, v115 bitop3:0xca
    s_setprio 1
    s_waitcnt vmcnt(13)
    v_lshlrev_b32 v7, 16, v120
    v_and_b32 v8, 0xffff0000, v120
    v_lshlrev_b32 v9, 16, v121
    v_and_b32 v10, 0xffff0000, v121
    v_mul_f32 v7, 0.15915494, v7
    v_mul_f32 v8, 0.15915494, v8
    v_mul_f32 v9, 0.15915494, v9
    v_mul_f32 v10, 0.15915494, v10
    v_mul_hi_u32_u24 v14, 429497, v108
    v_lshrrev_b32 v12, 3, v116
    v_cos_f32 v7, v7
    v_lshlrev_b16 v13, 3, v116
    v_mad_i32_i24 v11, v14, s55, v108
    v_bitop3_b32 v12, v6, v13, v12 bitop3:0xca
    v_lshl_add_u32 v11, v11, 17, s40
    v_lshlrev_b16 v14, 8, v14
    v_lshrrev_b32 v13, 2, v116
    v_add_u32 v108, v12, v11
    v_bitop3_b32 v116, v5, v13, v14 bitop3:0xea
    ds_add_u32 v116, v2
    v_mul_hi_u32_u24 v14, 429497, v109
    v_lshrrev_b32 v12, 3, v117
    v_cos_f32 v8, v8
    v_lshlrev_b16 v13, 3, v117
    v_mad_i32_i24 v11, v14, s55, v109
    v_bitop3_b32 v12, v6, v13, v12 bitop3:0xca
    v_lshl_add_u32 v11, v11, 17, s40
    v_lshlrev_b16 v14, 8, v14
    v_lshrrev_b32 v13, 2, v117
    v_add_u32 v109, v12, v11
    v_bitop3_b32 v117, v5, v13, v14 bitop3:0xea
    ds_add_u32 v117, v2
    v_cvt_pk_bf16_f32 v120, v7, v8
    v_perm_b32 v12, v120, v120, s41
    v_bitop3_b32 v108, v4, v12, v108 bitop3:0xca
    v_perm_b32 v13, v120, v120, s42
    v_bitop3_b32 v109, v4, v13, v109 bitop3:0xca
    v_mul_hi_u32_u24 v14, 429497, v110
    v_lshrrev_b32 v12, 3, v118
    v_cos_f32 v9, v9
    v_lshlrev_b16 v13, 3, v118
    v_mad_i32_i24 v11, v14, s55, v110
    v_bitop3_b32 v12, v6, v13, v12 bitop3:0xca
    v_lshl_add_u32 v11, v11, 17, s40
    v_lshlrev_b16 v14, 8, v14
    v_lshrrev_b32 v13, 2, v118
    v_add_u32 v110, v12, v11
    v_bitop3_b32 v118, v5, v13, v14 bitop3:0xea
    ds_add_u32 v118, v2
    v_mul_hi_u32_u24 v14, 429497, v111
    v_lshrrev_b32 v12, 3, v119
    v_cos_f32 v10, v10
    v_lshlrev_b16 v13, 3, v119
    v_mad_i32_i24 v11, v14, s55, v111
    v_bitop3_b32 v12, v6, v13, v12 bitop3:0xca
    v_lshl_add_u32 v11, v11, 17, s40
    v_lshlrev_b16 v14, 8, v14
    v_lshrrev_b32 v13, 2, v119
    v_add_u32 v111, v12, v11
    v_bitop3_b32 v119, v5, v13, v14 bitop3:0xea
    ds_add_u32 v119, v2
    v_cvt_pk_bf16_f32 v121, v9, v10
    v_perm_b32 v12, v121, v121, s41
    v_bitop3_b32 v110, v4, v12, v110 bitop3:0xca
    v_perm_b32 v13, v121, v121, s42
    v_bitop3_b32 v111, v4, v13, v111 bitop3:0xca
    s_waitcnt vmcnt(10)
    v_lshlrev_b32 v7, 16, v122
    v_and_b32 v8, 0xffff0000, v122
    v_lshlrev_b32 v9, 16, v123
    v_and_b32 v10, 0xffff0000, v123
    v_mul_f32 v7, 0.15915494, v7
    v_mul_f32 v8, 0.15915494, v8
    v_mul_f32 v9, 0.15915494, v9
    v_mul_f32 v10, 0.15915494, v10
    v_mul_hi_u32_u24 v14, 429497, v92
    v_lshrrev_b32 v12, 3, v16
    v_cos_f32 v7, v7
    v_lshlrev_b16 v13, 3, v16
    v_mad_i32_i24 v11, v14, s55, v92
    v_bitop3_b32 v12, v6, v13, v12 bitop3:0xca
    v_lshl_add_u32 v11, v11, 17, s40
    v_lshlrev_b16 v14, 8, v14
    v_lshrrev_b32 v13, 2, v16
    v_add_u32 v92, v12, v11
    v_bitop3_b32 v16, v5, v13, v14 bitop3:0xea
    ds_add_u32 v16, v2
    v_mul_hi_u32_u24 v14, 429497, v93
    v_lshrrev_b32 v12, 3, v17
    v_cos_f32 v8, v8
    v_lshlrev_b16 v13, 3, v17
    v_mad_i32_i24 v11, v14, s55, v93
    v_bitop3_b32 v12, v6, v13, v12 bitop3:0xca
    v_lshl_add_u32 v11, v11, 17, s40
    v_lshlrev_b16 v14, 8, v14
    v_lshrrev_b32 v13, 2, v17
    v_add_u32 v93, v12, v11
    v_bitop3_b32 v17, v5, v13, v14 bitop3:0xea
    ds_add_u32 v17, v2
    v_cvt_pk_bf16_f32 v122, v7, v8
    v_perm_b32 v12, v122, v122, s41
    v_bitop3_b32 v92, v4, v12, v92 bitop3:0xca
    v_perm_b32 v13, v122, v122, s42
    v_bitop3_b32 v93, v4, v13, v93 bitop3:0xca
    v_mul_hi_u32_u24 v14, 429497, v94
    v_lshrrev_b32 v12, 3, v18
    v_cos_f32 v9, v9
    v_lshlrev_b16 v13, 3, v18
    v_mad_i32_i24 v11, v14, s55, v94
    v_bitop3_b32 v12, v6, v13, v12 bitop3:0xca
    v_lshl_add_u32 v11, v11, 17, s40
    v_lshlrev_b16 v14, 8, v14
    v_lshrrev_b32 v13, 2, v18
    v_add_u32 v94, v12, v11
    v_bitop3_b32 v18, v5, v13, v14 bitop3:0xea
    ds_add_u32 v18, v2
    v_mul_hi_u32_u24 v14, 429497, v95
    v_lshrrev_b32 v12, 3, v19
    v_cos_f32 v10, v10
    v_lshlrev_b16 v13, 3, v19
    v_mad_i32_i24 v11, v14, s55, v95
    v_bitop3_b32 v12, v6, v13, v12 bitop3:0xca
    v_lshl_add_u32 v11, v11, 17, s40
    v_lshlrev_b16 v14, 8, v14
    v_lshrrev_b32 v13, 2, v19
    v_add_u32 v95, v12, v11
    v_bitop3_b32 v19, v5, v13, v14 bitop3:0xea
    ds_add_u32 v19, v2
    v_cvt_pk_bf16_f32 v123, v9, v10
    v_perm_b32 v12, v123, v123, s41
    v_bitop3_b32 v94, v4, v12, v94 bitop3:0xca
    v_perm_b32 v13, v123, v123, s42
    v_bitop3_b32 v95, v4, v13, v95 bitop3:0xca
    s_setprio 0
    s_add_u32 s44, s35, 0x2a4c000
    buffer_store_dwordx4 v[24:27], v0, s[20:23], s44 offen sc1
    s_add_u32 s45, s33, 0x6000000
    s_nop 0
    buffer_load_dwordx4 v[24:27], v0, s[12:15], s45 offen nt
    s_waitcnt vmcnt(8)
    v_lshlrev_b32 v7, 16, v28
    v_and_b32 v8, 0xffff0000, v28
    v_lshlrev_b32 v9, 16, v29
    v_and_b32 v10, 0xffff0000, v29
    v_mul_f32 v7, 0.15915494, v7
    v_mul_f32 v8, 0.15915494, v8
    v_mul_f32 v9, 0.15915494, v9
    v_mul_f32 v10, 0.15915494, v10
    v_mul_hi_u32_u24 v14, 429497, v20
    v_lshrrev_b32 v12, 3, v124
    v_cos_f32 v7, v7
    v_lshlrev_b16 v13, 3, v124
    v_mad_i32_i24 v11, v14, s55, v20
    v_bitop3_b32 v12, v6, v13, v12 bitop3:0xca
    v_lshl_add_u32 v11, v11, 17, s40
    v_lshlrev_b16 v14, 8, v14
    v_lshrrev_b32 v13, 2, v124
    v_add_u32 v20, v12, v11
    v_bitop3_b32 v124, v5, v13, v14 bitop3:0xea
    ds_add_u32 v124, v2
    v_mul_hi_u32_u24 v14, 429497, v21
    v_lshrrev_b32 v12, 3, v125
    v_cos_f32 v8, v8
    v_lshlrev_b16 v13, 3, v125
    v_mad_i32_i24 v11, v14, s55, v21
    v_bitop3_b32 v12, v6, v13, v12 bitop3:0xca
    v_lshl_add_u32 v11, v11, 17, s40
    v_lshlrev_b16 v14, 8, v14
    v_lshrrev_b32 v13, 2, v125
    v_add_u32 v21, v12, v11
    v_bitop3_b32 v125, v5, v13, v14 bitop3:0xea
    ds_add_u32 v125, v2
    v_cvt_pk_bf16_f32 v28, v7, v8
    v_perm_b32 v12, v28, v28, s41
    v_bitop3_b32 v20, v4, v12, v20 bitop3:0xca
    v_perm_b32 v13, v28, v28, s42
    v_bitop3_b32 v21, v4, v13, v21 bitop3:0xca
    v_mul_hi_u32_u24 v14, 429497, v22
    v_lshrrev_b32 v12, 3, v126
    v_cos_f32 v9, v9
    v_lshlrev_b16 v13, 3, v126
    v_mad_i32_i24 v11, v14, s55, v22
    v_bitop3_b32 v12, v6, v13, v12 bitop3:0xca
    v_lshl_add_u32 v11, v11, 17, s40
    v_lshlrev_b16 v14, 8, v14
    v_lshrrev_b32 v13, 2, v126
    v_add_u32 v22, v12, v11
    v_bitop3_b32 v126, v5, v13, v14 bitop3:0xea
    ds_add_u32 v126, v2
    v_mul_hi_u32_u24 v14, 429497, v23
    v_lshrrev_b32 v12, 3, v127
    v_cos_f32 v10, v10
    v_lshlrev_b16 v13, 3, v127
    v_mad_i32_i24 v11, v14, s55, v23
    v_bitop3_b32 v12, v6, v13, v12 bitop3:0xca
    v_lshl_add_u32 v11, v11, 17, s40
    v_lshlrev_b16 v14, 8, v14
    v_lshrrev_b32 v13, 2, v127
    v_add_u32 v23, v12, v11
    v_bitop3_b32 v127, v5, v13, v14 bitop3:0xea
    ds_add_u32 v127, v2
    v_cvt_pk_bf16_f32 v29, v9, v10
    v_perm_b32 v12, v29, v29, s41
    v_bitop3_b32 v22, v4, v12, v22 bitop3:0xca
    v_perm_b32 v13, v29, v29, s42
    v_bitop3_b32 v23, v4, v13, v23 bitop3:0xca
    s_waitcnt vmcnt(4)
    v_lshlrev_b32 v7, 16, v30
    v_and_b32 v8, 0xffff0000, v30
    v_lshlrev_b32 v9, 16, v31
    v_and_b32 v10, 0xffff0000, v31
    v_mul_f32 v7, 0.15915494, v7
    v_mul_f32 v8, 0.15915494, v8
    v_mul_f32 v9, 0.15915494, v9
    v_mul_f32 v10, 0.15915494, v10
    v_mul_hi_u32_u24 v14, 429497, v32
    v_lshrrev_b32 v12, 3, v36
    v_cos_f32 v7, v7
    v_lshlrev_b16 v13, 3, v36
    v_mad_i32_i24 v11, v14, s55, v32
    v_bitop3_b32 v12, v6, v13, v12 bitop3:0xca
    v_lshl_add_u32 v11, v11, 17, s40
    v_lshlrev_b16 v14, 8, v14
    v_lshrrev_b32 v13, 2, v36
    v_add_u32 v32, v12, v11
    v_bitop3_b32 v36, v5, v13, v14 bitop3:0xea
    ds_add_u32 v36, v2
    v_mul_hi_u32_u24 v14, 429497, v33
    v_lshrrev_b32 v12, 3, v37
    v_cos_f32 v8, v8
    v_lshlrev_b16 v13, 3, v37
    v_mad_i32_i24 v11, v14, s55, v33
    v_bitop3_b32 v12, v6, v13, v12 bitop3:0xca
    v_lshl_add_u32 v11, v11, 17, s40
    v_lshlrev_b16 v14, 8, v14
    v_lshrrev_b32 v13, 2, v37
    v_add_u32 v33, v12, v11
    v_bitop3_b32 v37, v5, v13, v14 bitop3:0xea
    ds_add_u32 v37, v2
    v_cvt_pk_bf16_f32 v30, v7, v8
    v_perm_b32 v12, v30, v30, s41
    v_bitop3_b32 v32, v4, v12, v32 bitop3:0xca
    v_perm_b32 v13, v30, v30, s42
    v_bitop3_b32 v33, v4, v13, v33 bitop3:0xca
    v_mul_hi_u32_u24 v14, 429497, v34
    v_lshrrev_b32 v12, 3, v38
    v_cos_f32 v9, v9
    v_lshlrev_b16 v13, 3, v38
    v_mad_i32_i24 v11, v14, s55, v34
    v_bitop3_b32 v12, v6, v13, v12 bitop3:0xca
    v_lshl_add_u32 v11, v11, 17, s40
    v_lshlrev_b16 v14, 8, v14
    v_lshrrev_b32 v13, 2, v38
    v_add_u32 v34, v12, v11
    v_bitop3_b32 v38, v5, v13, v14 bitop3:0xea
    ds_add_u32 v38, v2
    v_mul_hi_u32_u24 v14, 429497, v35
    v_lshrrev_b32 v12, 3, v39
    v_cos_f32 v10, v10
    v_lshlrev_b16 v13, 3, v39
    v_mad_i32_i24 v11, v14, s55, v35
    v_bitop3_b32 v12, v6, v13, v12 bitop3:0xca
    v_lshl_add_u32 v11, v11, 17, s40
    v_lshlrev_b16 v14, 8, v14
    v_lshrrev_b32 v13, 2, v39
    v_add_u32 v35, v12, v11
    v_bitop3_b32 v39, v5, v13, v14 bitop3:0xea
    ds_add_u32 v39, v2
    v_cvt_pk_bf16_f32 v31, v9, v10
    v_perm_b32 v12, v31, v31, s41
    v_bitop3_b32 v34, v4, v12, v34 bitop3:0xca
    v_perm_b32 v13, v31, v31, s42
    v_bitop3_b32 v35, v4, v13, v35 bitop3:0xca
    v_lshrrev_b32 v8, 2, v0
    v_and_b32 v7, 0x3c00, v0
    v_bitop3_b32 v7, v5, v8, v7 bitop3:0xea
    s_waitcnt lgkmcnt(0)
    s_barrier
    ds_read2st64_b32 v[8:9], v7 offset0:0 offset1:1
    ds_read2st64_b32 v[10:11], v7 offset0:2 offset1:3
    s_add_u32 s46, s35, 0x2a50000
    buffer_store_dwordx4 v[84:87], v0, s[20:23], s46 offen sc1
    s_add_u32 s47, s34, 0x3000000
    s_nop 0
    buffer_load_dwordx2 v[84:85], v1, s[16:19], s47 offen nt
    s_add_u32 s44, s34, 0x3200000
    buffer_load_dwordx2 v[86:87], v1, s[16:19], s44 offen nt
    s_waitcnt lgkmcnt(0)
    v_lshl_or_b32 v12, v9, 16, v8
    v_lshl_or_b32 v13, v11, 16, v10
    v_mov_b32 v14, v12
    v_mov_b32 v15, v13
    s_nop 0
    v_add_u32_dpp v14, v14, v14 row_shr:1 row_mask:0xf bank_mask:0xf bound_ctrl:1
    v_add_u32_dpp v15, v15, v15 row_shr:1 row_mask:0xf bank_mask:0xf bound_ctrl:1
    s_nop 0
    v_add_u32_dpp v14, v14, v14 row_shr:2 row_mask:0xf bank_mask:0xf bound_ctrl:1
    v_add_u32_dpp v15, v15, v15 row_shr:2 row_mask:0xf bank_mask:0xf bound_ctrl:1
    s_nop 0
    v_add_u32_dpp v14, v14, v14 row_shr:4 row_mask:0xf bank_mask:0xf bound_ctrl:1
    v_add_u32_dpp v15, v15, v15 row_shr:4 row_mask:0xf bank_mask:0xf bound_ctrl:1
    s_nop 0
    v_add_u32_dpp v14, v14, v14 row_shr:8 row_mask:0xf bank_mask:0xf bound_ctrl:1
    v_add_u32_dpp v15, v15, v15 row_shr:8 row_mask:0xf bank_mask:0xf bound_ctrl:1
    s_nop 0
    v_add_u32_dpp v14, v14, v14 row_bcast:15 row_mask:0xa bank_mask:0xf
    v_add_u32_dpp v15, v15, v15 row_bcast:15 row_mask:0xa bank_mask:0xf
    s_nop 0
    v_add_u32_dpp v14, v14, v14 row_bcast:31 row_mask:0xc bank_mask:0xf
    v_add_u32_dpp v15, v15, v15 row_bcast:31 row_mask:0xc bank_mask:0xf
    v_readlane_b32 s48, v14, 63
    v_readlane_b32 s49, v15, 63
    s_lshl_b32 s54, s32, 2
    v_mov_b32 v8, s54
    s_and_b32 s50, s48, 0xffff
    s_lshr_b32 s51, s48, 16
    s_and_b32 s52, s49, 0xffff
    s_lshr_b32 s53, s49, 16
    s_add_u32 s51, s51, s50
    s_add_u32 s52, s52, s51
    s_add_u32 s53, s53, s52
    v_mov_b32 v9, s53
    s_mov_b64 exec, 1
    ds_write_b32 v8, v9 offset:16384
    s_mov_b64 exec, -1
    v_and_b32 v8, 60, v7
    s_waitcnt lgkmcnt(0)
    s_barrier
    ds_read_b32 v9, v8 offset:16384
    s_waitcnt lgkmcnt(0)
    v_add_u32_dpp v9, v9, v9 row_shr:1 row_mask:0xf bank_mask:0xf bound_ctrl:1
    s_nop 1
    v_add_u32_dpp v9, v9, v9 row_shr:2 row_mask:0xf bank_mask:0xf bound_ctrl:1
    s_nop 1
    v_add_u32_dpp v9, v9, v9 row_shr:4 row_mask:0xf bank_mask:0xf bound_ctrl:1
    s_nop 1
    v_add_u32_dpp v9, v9, v9 row_shr:8 row_mask:0xf bank_mask:0xf bound_ctrl:1
    s_nop 0
    v_readlane_b32 s54, v9, s32
    s_sub_u32 s54, s54, s53
    s_add_u32 s50, s50, s54
    s_add_u32 s51, s51, s54
    s_add_u32 s52, s52, s54
    s_pack_ll_b32_b16 s48, s54, s50
    s_pack_ll_b32_b16 s49, s51, s52
    v_add_u32 v14, s48, v14
    v_add_u32 v15, s49, v15
    v_sub_u32 v12, v14, v12
    v_sub_u32 v13, v15, v13
    v_and_b32 v8, 0xffff, v12
    v_lshrrev_b32 v9, 16, v12
    v_and_b32 v10, 0xffff, v13
    v_lshrrev_b32 v11, 16, v13
    ds_write2st64_b32 v7, v8, v9 offset0:0 offset1:1
    ds_write2st64_b32 v7, v10, v11 offset0:2 offset1:3
    v_and_b32 v8, 0x3f0, v0
    v_lshl_add_u32 v8, v8, 1, s36
    ds_write_b64 v8, v[12:13] offset:20480
    s_bitset0_b64 exec, 63
    s_not_b64 exec, exec
    ds_write_b64 v8, v[14:15] offset:20512
    s_mov_b64 exec, -1
    s_waitcnt lgkmcnt(0)
    s_barrier
    s_setprio 3
    ds_add_rtn_u32 v72, v72, v2
    ds_add_rtn_u32 v73, v73, v2
    ds_add_rtn_u32 v74, v74, v2
    ds_add_rtn_u32 v75, v75, v2
    ds_read_b128 v[12:15], v0 offset:20480
    v_cmp_gt_u32 vcc, 8448, v0
    ds_add_rtn_u32 v80, v80, v2
    ds_add_rtn_u32 v81, v81, v2
    ds_add_rtn_u32 v82, v82, v2
    ds_add_rtn_u32 v83, v83, v2
    s_setprio 2
    ds_add_rtn_u32 v104, v104, v2
    ds_add_rtn_u32 v105, v105, v2
    ds_add_rtn_u32 v106, v106, v2
    ds_add_rtn_u32 v107, v107, v2
    s_waitcnt lgkmcnt(8)
    s_cbranch_vccz L1_p3
    s_add_u32 s45, s35, 0x5480000
    s_mov_b64 exec, vcc
    buffer_store_dwordx4 v[12:15], v0, s[24:27], s45 offen sc1
    s_mov_b64 exec, -1
L1_p3:
    s_add_u32 s46, s35, 0x2a54000
    buffer_store_dwordx4 v[48:51], v0, s[20:23], s46 offen sc1
    s_add_u32 s47, s33, 0x6400000
    s_nop 0
    buffer_load_dwordx4 v[48:51], v0, s[8:11], s47 offen nt
    ds_add_rtn_u32 v100, v100, v2
    ds_add_rtn_u32 v101, v101, v2
    ds_add_rtn_u32 v102, v102, v2
    ds_add_rtn_u32 v103, v103, v2
    s_setprio 1
    ds_add_rtn_u32 v116, v116, v2
    ds_add_rtn_u32 v117, v117, v2
    ds_add_rtn_u32 v118, v118, v2
    ds_add_rtn_u32 v119, v119, v2
    ds_add_rtn_u32 v16, v16, v2
    ds_add_rtn_u32 v17, v17, v2
    ds_add_rtn_u32 v18, v18, v2
    ds_add_rtn_u32 v19, v19, v2
    s_add_u32 s44, s35, 0x2a58000
    buffer_store_dwordx4 v[52:55], v0, s[20:23], s44 offen sc1
    s_add_u32 s45, s33, 0x6400000
    s_nop 0
    buffer_load_dwordx4 v[52:55], v0, s[12:15], s45 offen nt
    s_setprio 0
    ds_add_rtn_u32 v124, v124, v2
    ds_add_rtn_u32 v125, v125, v2
    ds_add_rtn_u32 v126, v126, v2
    ds_add_rtn_u32 v127, v127, v2
    ds_add_rtn_u32 v36, v36, v2
    ds_add_rtn_u32 v37, v37, v2
    ds_add_rtn_u32 v38, v38, v2
    ds_add_rtn_u32 v39, v39, v2
    s_waitcnt lgkmcnt(0)
    s_barrier
    s_setprio 3
    v_and_b32 v7, -4, v72
    v_lshl_add_u32 v8, v72, 2, v7
    ds_write_b32 v8, v68
    v_lshl_add_u32 v7, v7, 2, v72
    ds_write_b8 v7, v64 offset:16
    v_and_b32 v9, -4, v73
    v_lshl_add_u32 v10, v73, 2, v9
    ds_write_b32 v10, v69
    v_lshl_add_u32 v9, v9, 2, v73
    ds_write_b8_d16_hi v9, v64 offset:16
    v_and_b32 v7, -4, v74
    v_lshl_add_u32 v8, v74, 2, v7
    ds_write_b32 v8, v70
    v_lshl_add_u32 v7, v7, 2, v74
    ds_write_b8 v7, v65 offset:16
    v_and_b32 v9, -4, v75
    v_lshl_add_u32 v10, v75, 2, v9
    ds_write_b32 v10, v71
    v_lshl_add_u32 v9, v9, 2, v75
    ds_write_b8_d16_hi v9, v65 offset:16
    s_add_u32 s46, s35, 0x2a5c000
    buffer_store_dwordx4 v[56:59], v0, s[20:23], s46 offen sc1
    s_add_u32 s47, s33, 0x6800000
    buffer_load_dwordx4 v[68:71], v0, s[8:11], s47 offen nt
    s_add_u32 s44, s33, 0x6800000
    buffer_load_dwordx4 v[72:75], v0, s[12:15], s44 offen nt
    v_and_b32 v7, -4, v80
    v_lshl_add_u32 v8, v80, 2, v7
    ds_write_b32 v8, v76
    v_lshl_add_u32 v7, v7, 2, v80
    ds_write_b8 v7, v66 offset:16
    v_and_b32 v9, -4, v81
    v_lshl_add_u32 v10, v81, 2, v9
    ds_write_b32 v10, v77
    v_lshl_add_u32 v9, v9, 2, v81
    ds_write_b8_d16_hi v9, v66 offset:16
    v_and_b32 v7, -4, v82
    v_lshl_add_u32 v8, v82, 2, v7
    ds_write_b32 v8, v78
    v_lshl_add_u32 v7, v7, 2, v82
    ds_write_b8 v7, v67 offset:16
    v_and_b32 v9, -4, v83
    v_lshl_add_u32 v10, v83, 2, v9
    ds_write_b32 v10, v79
    v_lshl_add_u32 v9, v9, 2, v83
    ds_write_b8_d16_hi v9, v67 offset:16
    s_add_u32 s45, s34, 0x3400000
    buffer_load_dwordx2 v[56:57], v1, s[16:19], s45 offen nt
    s_add_u32 s46, s34, 0x3600000
    buffer_load_dwordx2 v[58:59], v1, s[16:19], s46 offen nt
    s_add_u32 s47, s33, 0x6c00000
    buffer_load_dwordx4 v[76:79], v0, s[8:11], s47 offen nt
    s_setprio 2
    v_and_b32 v7, -4, v104
    v_lshl_add_u32 v8, v104, 2, v7
    ds_write_b32 v8, v96
    v_lshl_add_u32 v7, v7, 2, v104
    ds_write_b8 v7, v88 offset:16
    v_and_b32 v9, -4, v105
    v_lshl_add_u32 v10, v105, 2, v9
    ds_write_b32 v10, v97
    v_lshl_add_u32 v9, v9, 2, v105
    ds_write_b8_d16_hi v9, v88 offset:16
    v_and_b32 v7, -4, v106
    v_lshl_add_u32 v8, v106, 2, v7
    ds_write_b32 v8, v98
    v_lshl_add_u32 v7, v7, 2, v106
    ds_write_b8 v7, v89 offset:16
    v_and_b32 v9, -4, v107
    v_lshl_add_u32 v10, v107, 2, v9
    ds_write_b32 v10, v99
    v_lshl_add_u32 v9, v9, 2, v107
    ds_write_b8_d16_hi v9, v89 offset:16
    s_add_u32 s44, s35, 0x2a60000
    buffer_store_dwordx4 v[60:63], v0, s[20:23], s44 offen sc1
    s_add_u32 s45, s33, 0x6c00000
    buffer_load_dwordx4 v[80:83], v0, s[12:15], s45 offen nt
    v_and_b32 v7, -4, v100
    v_lshl_add_u32 v8, v100, 2, v7
    ds_write_b32 v8, v112
    v_lshl_add_u32 v7, v7, 2, v100
    ds_write_b8 v7, v90 offset:16
    v_and_b32 v9, -4, v101
    v_lshl_add_u32 v10, v101, 2, v9
    ds_write_b32 v10, v113
    v_lshl_add_u32 v9, v9, 2, v101
    ds_write_b8_d16_hi v9, v90 offset:16
    v_and_b32 v7, -4, v102
    v_lshl_add_u32 v8, v102, 2, v7
    ds_write_b32 v8, v114
    v_lshl_add_u32 v7, v7, 2, v102
    ds_write_b8 v7, v91 offset:16
    v_and_b32 v9, -4, v103
    v_lshl_add_u32 v10, v103, 2, v9
    ds_write_b32 v10, v115
    v_lshl_add_u32 v9, v9, 2, v103
    ds_write_b8_d16_hi v9, v91 offset:16
    s_add_u32 s46, s33, 0x7000000
    buffer_load_dwordx4 v[64:67], v0, s[8:11], s46 offen nt
    s_add_u32 s47, s33, 0x7000000
    buffer_load_dwordx4 v[96:99], v0, s[12:15], s47 offen nt
    s_setprio 1
    v_and_b32 v7, -4, v116
    v_lshl_add_u32 v8, v116, 2, v7
    ds_write_b32 v8, v108
    v_lshl_add_u32 v7, v7, 2, v116
    ds_write_b8 v7, v120 offset:16
    v_and_b32 v9, -4, v117
    v_lshl_add_u32 v10, v117, 2, v9
    ds_write_b32 v10, v109
    v_lshl_add_u32 v9, v9, 2, v117
    ds_write_b8_d16_hi v9, v120 offset:16
    v_and_b32 v7, -4, v118
    v_lshl_add_u32 v8, v118, 2, v7
    ds_write_b32 v8, v110
    v_lshl_add_u32 v7, v7, 2, v118
    ds_write_b8 v7, v121 offset:16
    v_and_b32 v9, -4, v119
    v_lshl_add_u32 v10, v119, 2, v9
    ds_write_b32 v10, v111
    v_lshl_add_u32 v9, v9, 2, v119
    ds_write_b8_d16_hi v9, v121 offset:16
    s_add_u32 s44, s34, 0x3800000
    buffer_load_dwordx2 v[104:105], v1, s[16:19], s44 offen nt
    s_add_u32 s45, s34, 0x3a00000
    buffer_load_dwordx2 v[106:107], v1, s[16:19], s45 offen nt
    s_add_u32 s46, s33, 0x7400000
    buffer_load_dwordx4 v[60:63], v0, s[8:11], s46 offen nt
    v_and_b32 v7, -4, v16
    v_lshl_add_u32 v8, v16, 2, v7
    ds_write_b32 v8, v92
    v_lshl_add_u32 v7, v7, 2, v16
    ds_write_b8 v7, v122 offset:16
    v_and_b32 v9, -4, v17
    v_lshl_add_u32 v10, v17, 2, v9
    ds_write_b32 v10, v93
    v_lshl_add_u32 v9, v9, 2, v17
    ds_write_b8_d16_hi v9, v122 offset:16
    v_and_b32 v7, -4, v18
    v_lshl_add_u32 v8, v18, 2, v7
    ds_write_b32 v8, v94
    v_lshl_add_u32 v7, v7, 2, v18
    ds_write_b8 v7, v123 offset:16
    v_and_b32 v9, -4, v19
    v_lshl_add_u32 v10, v19, 2, v9
    ds_write_b32 v10, v95
    v_lshl_add_u32 v9, v9, 2, v19
    ds_write_b8_d16_hi v9, v123 offset:16
    s_add_u32 s47, s35, 0x2a64000
    buffer_store_dwordx4 v[44:47], v0, s[20:23], s47 offen sc1
    s_add_u32 s44, s33, 0x7400000
    buffer_load_dwordx4 v[112:115], v0, s[12:15], s44 offen nt
    s_setprio 0
    v_and_b32 v7, -4, v124
    v_lshl_add_u32 v8, v124, 2, v7
    ds_write_b32 v8, v20
    v_lshl_add_u32 v7, v7, 2, v124
    ds_write_b8 v7, v28 offset:16
    v_and_b32 v9, -4, v125
    v_lshl_add_u32 v10, v125, 2, v9
    ds_write_b32 v10, v21
    v_lshl_add_u32 v9, v9, 2, v125
    ds_write_b8_d16_hi v9, v28 offset:16
    v_and_b32 v7, -4, v126
    v_lshl_add_u32 v8, v126, 2, v7
    ds_write_b32 v8, v22
    v_lshl_add_u32 v7, v7, 2, v126
    ds_write_b8 v7, v29 offset:16
    v_and_b32 v9, -4, v127
    v_lshl_add_u32 v10, v127, 2, v9
    ds_write_b32 v10, v23
    v_lshl_add_u32 v9, v9, 2, v127
    ds_write_b8_d16_hi v9, v29 offset:16
    s_add_u32 s45, s33, 0x7800000
    buffer_load_dwordx4 v[100:103], v0, s[8:11], s45 offen nt
    s_add_u32 s46, s33, 0x7800000
    buffer_load_dwordx4 v[88:91], v0, s[12:15], s46 offen nt
    v_and_b32 v7, -4, v36
    v_lshl_add_u32 v8, v36, 2, v7
    ds_write_b32 v8, v32
    v_lshl_add_u32 v7, v7, 2, v36
    ds_write_b8 v7, v30 offset:16
    v_and_b32 v9, -4, v37
    v_lshl_add_u32 v10, v37, 2, v9
    ds_write_b32 v10, v33
    v_lshl_add_u32 v9, v9, 2, v37
    ds_write_b8_d16_hi v9, v30 offset:16
    v_and_b32 v7, -4, v38
    v_lshl_add_u32 v8, v38, 2, v7
    ds_write_b32 v8, v34
    v_lshl_add_u32 v7, v7, 2, v38
    ds_write_b8 v7, v31 offset:16
    v_and_b32 v9, -4, v39
    v_lshl_add_u32 v10, v39, 2, v9
    ds_write_b32 v10, v35
    v_lshl_add_u32 v9, v9, 2, v39
    ds_write_b8_d16_hi v9, v31 offset:16
    s_add_u32 s47, s34, 0x3c00000
    buffer_load_dwordx2 v[108:109], v1, s[16:19], s47 offen nt
    s_add_u32 s44, s34, 0x3e00000
    buffer_load_dwordx2 v[110:111], v1, s[16:19], s44 offen nt
    v_add_u32 v7, 0x10000, v0
    v_add_u32 v12, 0x20000, v0
    v_mov_b32 v8, 0
    v_mov_b32 v9, 0
    v_mov_b32 v10, 0
    v_mov_b32 v11, 0
    s_waitcnt lgkmcnt(0)
    s_barrier
    ds_read_b128 v[116:119], v0 offset:0
    ds_write_b128 v0, v[8:11]
    ds_read_b128 v[92:95], v0 offset:16384
    ds_read_b128 v[16:19], v0 offset:32768
    ds_read_b128 v[120:123], v0 offset:49152
    ds_read_b128 v[44:47], v7 offset:0
    ds_read_b128 v[20:23], v7 offset:16384
    ds_read_b128 v[124:127], v7 offset:32768
    ds_read_b128 v[32:35], v7 offset:49152
    ds_read_b128 v[36:39], v12 offset:0
    ds_read_b128 v[28:31], v12 offset:16384
    s_waitcnt lgkmcnt(0)
    s_barrier
    s_setprio 3
    s_add_u32 s45, s35, 0x5480000
    buffer_store_dwordx4 v[116:119], v0, s[20:23], s45 offen sc1
    s_add_u32 s46, s33, 0x7c00000
    s_nop 0
    buffer_load_dwordx4 v[116:119], v0, s[8:11], s46 offen nt
    s_add_u32 s47, s35, 0x5484000
    buffer_store_dwordx4 v[92:95], v0, s[20:23], s47 offen sc1
    s_add_u32 s44, s33, 0x7c00000
    s_nop 0
    buffer_load_dwordx4 v[92:95], v0, s[12:15], s44 offen nt
    s_waitcnt vmcnt(27)
    v_lshlrev_b32 v7, 16, v84
    v_and_b32 v8, 0xffff0000, v84
    v_lshlrev_b32 v9, 16, v85
    v_and_b32 v10, 0xffff0000, v85
    v_mul_f32 v7, 0.15915494, v7
    v_mul_f32 v8, 0.15915494, v8
    v_mul_f32 v9, 0.15915494, v9
    v_mul_f32 v10, 0.15915494, v10
    v_mul_hi_u32_u24 v14, 429497, v40
    v_lshrrev_b32 v12, 3, v24
    v_cos_f32 v7, v7
    v_lshlrev_b16 v13, 3, v24
    v_mad_i32_i24 v11, v14, s55, v40
    v_bitop3_b32 v12, v6, v13, v12 bitop3:0xca
    v_lshl_add_u32 v11, v11, 17, s40
    v_lshlrev_b16 v14, 8, v14
    v_lshrrev_b32 v13, 2, v24
    v_add_u32 v40, v12, v11
    v_bitop3_b32 v24, v5, v13, v14 bitop3:0xea
    ds_add_u32 v24, v2
    v_mul_hi_u32_u24 v14, 429497, v41
    v_lshrrev_b32 v12, 3, v25
    v_cos_f32 v8, v8
    v_lshlrev_b16 v13, 3, v25
    v_mad_i32_i24 v11, v14, s55, v41
    v_bitop3_b32 v12, v6, v13, v12 bitop3:0xca
    v_lshl_add_u32 v11, v11, 17, s40
    v_lshlrev_b16 v14, 8, v14
    v_lshrrev_b32 v13, 2, v25
    v_add_u32 v41, v12, v11
    v_bitop3_b32 v25, v5, v13, v14 bitop3:0xea
    ds_add_u32 v25, v2
    v_cvt_pk_bf16_f32 v84, v7, v8
    v_perm_b32 v12, v84, v84, s41
    v_bitop3_b32 v40, v4, v12, v40 bitop3:0xca
    v_perm_b32 v13, v84, v84, s42
    v_bitop3_b32 v41, v4, v13, v41 bitop3:0xca
    v_mul_hi_u32_u24 v14, 429497, v42
    v_lshrrev_b32 v12, 3, v26
    v_cos_f32 v9, v9
    v_lshlrev_b16 v13, 3, v26
    v_mad_i32_i24 v11, v14, s55, v42
    v_bitop3_b32 v12, v6, v13, v12 bitop3:0xca
    v_lshl_add_u32 v11, v11, 17, s40
    v_lshlrev_b16 v14, 8, v14
    v_lshrrev_b32 v13, 2, v26
    v_add_u32 v42, v12, v11
    v_bitop3_b32 v26, v5, v13, v14 bitop3:0xea
    ds_add_u32 v26, v2
    v_mul_hi_u32_u24 v14, 429497, v43
    v_lshrrev_b32 v12, 3, v27
    v_cos_f32 v10, v10
    v_lshlrev_b16 v13, 3, v27
    v_mad_i32_i24 v11, v14, s55, v43
    v_bitop3_b32 v12, v6, v13, v12 bitop3:0xca
    v_lshl_add_u32 v11, v11, 17, s40
    v_lshlrev_b16 v14, 8, v14
    v_lshrrev_b32 v13, 2, v27
    v_add_u32 v43, v12, v11
    v_bitop3_b32 v27, v5, v13, v14 bitop3:0xea
    ds_add_u32 v27, v2
    v_cvt_pk_bf16_f32 v85, v9, v10
    v_perm_b32 v12, v85, v85, s41
    v_bitop3_b32 v42, v4, v12, v42 bitop3:0xca
    v_perm_b32 v13, v85, v85, s42
    v_bitop3_b32 v43, v4, v13, v43 bitop3:0xca
    s_waitcnt vmcnt(23)
    v_lshlrev_b32 v7, 16, v86
    v_and_b32 v8, 0xffff0000, v86
    v_lshlrev_b32 v9, 16, v87
    v_and_b32 v10, 0xffff0000, v87
    v_mul_f32 v7, 0.15915494, v7
    v_mul_f32 v8, 0.15915494, v8
    v_mul_f32 v9, 0.15915494, v9
    v_mul_f32 v10, 0.15915494, v10
    v_mul_hi_u32_u24 v14, 429497, v48
    v_lshrrev_b32 v12, 3, v52
    v_cos_f32 v7, v7
    v_lshlrev_b16 v13, 3, v52
    v_mad_i32_i24 v11, v14, s55, v48
    v_bitop3_b32 v12, v6, v13, v12 bitop3:0xca
    v_lshl_add_u32 v11, v11, 17, s40
    v_lshlrev_b16 v14, 8, v14
    v_lshrrev_b32 v13, 2, v52
    v_add_u32 v48, v12, v11
    v_bitop3_b32 v52, v5, v13, v14 bitop3:0xea
    ds_add_u32 v52, v2
    v_mul_hi_u32_u24 v14, 429497, v49
    v_lshrrev_b32 v12, 3, v53
    v_cos_f32 v8, v8
    v_lshlrev_b16 v13, 3, v53
    v_mad_i32_i24 v11, v14, s55, v49
    v_bitop3_b32 v12, v6, v13, v12 bitop3:0xca
    v_lshl_add_u32 v11, v11, 17, s40
    v_lshlrev_b16 v14, 8, v14
    v_lshrrev_b32 v13, 2, v53
    v_add_u32 v49, v12, v11
    v_bitop3_b32 v53, v5, v13, v14 bitop3:0xea
    ds_add_u32 v53, v2
    v_cvt_pk_bf16_f32 v86, v7, v8
    v_perm_b32 v12, v86, v86, s41
    v_bitop3_b32 v48, v4, v12, v48 bitop3:0xca
    v_perm_b32 v13, v86, v86, s42
    v_bitop3_b32 v49, v4, v13, v49 bitop3:0xca
    v_mul_hi_u32_u24 v14, 429497, v50
    v_lshrrev_b32 v12, 3, v54
    v_cos_f32 v9, v9
    v_lshlrev_b16 v13, 3, v54
    v_mad_i32_i24 v11, v14, s55, v50
    v_bitop3_b32 v12, v6, v13, v12 bitop3:0xca
    v_lshl_add_u32 v11, v11, 17, s40
    v_lshlrev_b16 v14, 8, v14
    v_lshrrev_b32 v13, 2, v54
    v_add_u32 v50, v12, v11
    v_bitop3_b32 v54, v5, v13, v14 bitop3:0xea
    ds_add_u32 v54, v2
    v_mul_hi_u32_u24 v14, 429497, v51
    v_lshrrev_b32 v12, 3, v55
    v_cos_f32 v10, v10
    v_lshlrev_b16 v13, 3, v55
    v_mad_i32_i24 v11, v14, s55, v51
    v_bitop3_b32 v12, v6, v13, v12 bitop3:0xca
    v_lshl_add_u32 v11, v11, 17, s40
    v_lshlrev_b16 v14, 8, v14
    v_lshrrev_b32 v13, 2, v55
    v_add_u32 v51, v12, v11
    v_bitop3_b32 v55, v5, v13, v14 bitop3:0xea
    ds_add_u32 v55, v2
    v_cvt_pk_bf16_f32 v87, v9, v10
    v_perm_b32 v12, v87, v87, s41
    v_bitop3_b32 v50, v4, v12, v50 bitop3:0xca
    v_perm_b32 v13, v87, v87, s42
    v_bitop3_b32 v51, v4, v13, v51 bitop3:0xca
    s_setprio 2
    s_waitcnt vmcnt(18)
    v_lshlrev_b32 v7, 16, v56
    v_and_b32 v8, 0xffff0000, v56
    v_lshlrev_b32 v9, 16, v57
    v_and_b32 v10, 0xffff0000, v57
    v_mul_f32 v7, 0.15915494, v7
    v_mul_f32 v8, 0.15915494, v8
    v_mul_f32 v9, 0.15915494, v9
    v_mul_f32 v10, 0.15915494, v10
    v_mul_hi_u32_u24 v14, 429497, v68
    v_lshrrev_b32 v12, 3, v72
    v_cos_f32 v7, v7
    v_lshlrev_b16 v13, 3, v72
    v_mad_i32_i24 v11, v14, s55, v68
    v_bitop3_b32 v12, v6, v13, v12 bitop3:0xca
    v_lshl_add_u32 v11, v11, 17, s40
    v_lshlrev_b16 v14, 8, v14
    v_lshrrev_b32 v13, 2, v72
    v_add_u32 v68, v12, v11
    v_bitop3_b32 v72, v5, v13, v14 bitop3:0xea
    ds_add_u32 v72, v2
    v_mul_hi_u32_u24 v14, 429497, v69
    v_lshrrev_b32 v12, 3, v73
    v_cos_f32 v8, v8
    v_lshlrev_b16 v13, 3, v73
    v_mad_i32_i24 v11, v14, s55, v69
    v_bitop3_b32 v12, v6, v13, v12 bitop3:0xca
    v_lshl_add_u32 v11, v11, 17, s40
    v_lshlrev_b16 v14, 8, v14
    v_lshrrev_b32 v13, 2, v73
    v_add_u32 v69, v12, v11
    v_bitop3_b32 v73, v5, v13, v14 bitop3:0xea
    ds_add_u32 v73, v2
    v_cvt_pk_bf16_f32 v56, v7, v8
    v_perm_b32 v12, v56, v56, s41
    v_bitop3_b32 v68, v4, v12, v68 bitop3:0xca
    v_perm_b32 v13, v56, v56, s42
    v_bitop3_b32 v69, v4, v13, v69 bitop3:0xca
    v_mul_hi_u32_u24 v14, 429497, v70
    v_lshrrev_b32 v12, 3, v74
    v_cos_f32 v9, v9
    v_lshlrev_b16 v13, 3, v74
    v_mad_i32_i24 v11, v14, s55, v70
    v_bitop3_b32 v12, v6, v13, v12 bitop3:0xca
    v_lshl_add_u32 v11, v11, 17, s40
    v_lshlrev_b16 v14, 8, v14
    v_lshrrev_b32 v13, 2, v74
    v_add_u32 v70, v12, v11
    v_bitop3_b32 v74, v5, v13, v14 bitop3:0xea
    ds_add_u32 v74, v2
    v_mul_hi_u32_u24 v14, 429497, v71
    v_lshrrev_b32 v12, 3, v75
    v_cos_f32 v10, v10
    v_lshlrev_b16 v13, 3, v75
    v_mad_i32_i24 v11, v14, s55, v71
    v_bitop3_b32 v12, v6, v13, v12 bitop3:0xca
    v_lshl_add_u32 v11, v11, 17, s40
    v_lshlrev_b16 v14, 8, v14
    v_lshrrev_b32 v13, 2, v75
    v_add_u32 v71, v12, v11
    v_bitop3_b32 v75, v5, v13, v14 bitop3:0xea
    ds_add_u32 v75, v2
    v_cvt_pk_bf16_f32 v57, v9, v10
    v_perm_b32 v12, v57, v57, s41
    v_bitop3_b32 v70, v4, v12, v70 bitop3:0xca
    v_perm_b32 v13, v57, v57, s42
    v_bitop3_b32 v71, v4, v13, v71 bitop3:0xca
    s_add_u32 s45, s35, 0x5488000
    buffer_store_dwordx4 v[16:19], v0, s[20:23], s45 offen sc1
    s_add_u32 s46, s33, 0x8000000
    s_nop 0
    buffer_load_dwordx4 v[16:19], v0, s[8:11], s46 offen nt
    s_waitcnt vmcnt(17)
    v_lshlrev_b32 v7, 16, v58
    v_and_b32 v8, 0xffff0000, v58
    v_lshlrev_b32 v9, 16, v59
    v_and_b32 v10, 0xffff0000, v59
    v_mul_f32 v7, 0.15915494, v7
    v_mul_f32 v8, 0.15915494, v8
    v_mul_f32 v9, 0.15915494, v9
    v_mul_f32 v10, 0.15915494, v10
    v_mul_hi_u32_u24 v14, 429497, v76
    v_lshrrev_b32 v12, 3, v80
    v_cos_f32 v7, v7
    v_lshlrev_b16 v13, 3, v80
    v_mad_i32_i24 v11, v14, s55, v76
    v_bitop3_b32 v12, v6, v13, v12 bitop3:0xca
    v_lshl_add_u32 v11, v11, 17, s40
    v_lshlrev_b16 v14, 8, v14
    v_lshrrev_b32 v13, 2, v80
    v_add_u32 v76, v12, v11
    v_bitop3_b32 v80, v5, v13, v14 bitop3:0xea
    ds_add_u32 v80, v2
    v_mul_hi_u32_u24 v14, 429497, v77
    v_lshrrev_b32 v12, 3, v81
    v_cos_f32 v8, v8
    v_lshlrev_b16 v13, 3, v81
    v_mad_i32_i24 v11, v14, s55, v77
    v_bitop3_b32 v12, v6, v13, v12 bitop3:0xca
    v_lshl_add_u32 v11, v11, 17, s40
    v_lshlrev_b16 v14, 8, v14
    v_lshrrev_b32 v13, 2, v81
    v_add_u32 v77, v12, v11
    v_bitop3_b32 v81, v5, v13, v14 bitop3:0xea
    ds_add_u32 v81, v2
    v_cvt_pk_bf16_f32 v58, v7, v8
    v_perm_b32 v12, v58, v58, s41
    v_bitop3_b32 v76, v4, v12, v76 bitop3:0xca
    v_perm_b32 v13, v58, v58, s42
    v_bitop3_b32 v77, v4, v13, v77 bitop3:0xca
    v_mul_hi_u32_u24 v14, 429497, v78
    v_lshrrev_b32 v12, 3, v82
    v_cos_f32 v9, v9
    v_lshlrev_b16 v13, 3, v82
    v_mad_i32_i24 v11, v14, s55, v78
    v_bitop3_b32 v12, v6, v13, v12 bitop3:0xca
    v_lshl_add_u32 v11, v11, 17, s40
    v_lshlrev_b16 v14, 8, v14
    v_lshrrev_b32 v13, 2, v82
    v_add_u32 v78, v12, v11
    v_bitop3_b32 v82, v5, v13, v14 bitop3:0xea
    ds_add_u32 v82, v2
    v_mul_hi_u32_u24 v14, 429497, v79
    v_lshrrev_b32 v12, 3, v83
    v_cos_f32 v10, v10
    v_lshlrev_b16 v13, 3, v83
    v_mad_i32_i24 v11, v14, s55, v79
    v_bitop3_b32 v12, v6, v13, v12 bitop3:0xca
    v_lshl_add_u32 v11, v11, 17, s40
    v_lshlrev_b16 v14, 8, v14
    v_lshrrev_b32 v13, 2, v83
    v_add_u32 v79, v12, v11
    v_bitop3_b32 v83, v5, v13, v14 bitop3:0xea
    ds_add_u32 v83, v2
    v_cvt_pk_bf16_f32 v59, v9, v10
    v_perm_b32 v12, v59, v59, s41
    v_bitop3_b32 v78, v4, v12, v78 bitop3:0xca
    v_perm_b32 v13, v59, v59, s42
    v_bitop3_b32 v79, v4, v13, v79 bitop3:0xca
    s_setprio 1
    s_waitcnt vmcnt(13)
    v_lshlrev_b32 v7, 16, v104
    v_and_b32 v8, 0xffff0000, v104
    v_lshlrev_b32 v9, 16, v105
    v_and_b32 v10, 0xffff0000, v105
    v_mul_f32 v7, 0.15915494, v7
    v_mul_f32 v8, 0.15915494, v8
    v_mul_f32 v9, 0.15915494, v9
    v_mul_f32 v10, 0.15915494, v10
    v_mul_hi_u32_u24 v14, 429497, v64
    v_lshrrev_b32 v12, 3, v96
    v_cos_f32 v7, v7
    v_lshlrev_b16 v13, 3, v96
    v_mad_i32_i24 v11, v14, s55, v64
    v_bitop3_b32 v12, v6, v13, v12 bitop3:0xca
    v_lshl_add_u32 v11, v11, 17, s40
    v_lshlrev_b16 v14, 8, v14
    v_lshrrev_b32 v13, 2, v96
    v_add_u32 v64, v12, v11
    v_bitop3_b32 v96, v5, v13, v14 bitop3:0xea
    ds_add_u32 v96, v2
    v_mul_hi_u32_u24 v14, 429497, v65
    v_lshrrev_b32 v12, 3, v97
    v_cos_f32 v8, v8
    v_lshlrev_b16 v13, 3, v97
    v_mad_i32_i24 v11, v14, s55, v65
    v_bitop3_b32 v12, v6, v13, v12 bitop3:0xca
    v_lshl_add_u32 v11, v11, 17, s40
    v_lshlrev_b16 v14, 8, v14
    v_lshrrev_b32 v13, 2, v97
    v_add_u32 v65, v12, v11
    v_bitop3_b32 v97, v5, v13, v14 bitop3:0xea
    ds_add_u32 v97, v2
    v_cvt_pk_bf16_f32 v104, v7, v8
    v_perm_b32 v12, v104, v104, s41
    v_bitop3_b32 v64, v4, v12, v64 bitop3:0xca
    v_perm_b32 v13, v104, v104, s42
    v_bitop3_b32 v65, v4, v13, v65 bitop3:0xca
    v_mul_hi_u32_u24 v14, 429497, v66
    v_lshrrev_b32 v12, 3, v98
    v_cos_f32 v9, v9
    v_lshlrev_b16 v13, 3, v98
    v_mad_i32_i24 v11, v14, s55, v66
    v_bitop3_b32 v12, v6, v13, v12 bitop3:0xca
    v_lshl_add_u32 v11, v11, 17, s40
    v_lshlrev_b16 v14, 8, v14
    v_lshrrev_b32 v13, 2, v98
    v_add_u32 v66, v12, v11
    v_bitop3_b32 v98, v5, v13, v14 bitop3:0xea
    ds_add_u32 v98, v2
    v_mul_hi_u32_u24 v14, 429497, v67
    v_lshrrev_b32 v12, 3, v99
    v_cos_f32 v10, v10
    v_lshlrev_b16 v13, 3, v99
    v_mad_i32_i24 v11, v14, s55, v67
    v_bitop3_b32 v12, v6, v13, v12 bitop3:0xca
    v_lshl_add_u32 v11, v11, 17, s40
    v_lshlrev_b16 v14, 8, v14
    v_lshrrev_b32 v13, 2, v99
    v_add_u32 v67, v12, v11
    v_bitop3_b32 v99, v5, v13, v14 bitop3:0xea
    ds_add_u32 v99, v2
    v_cvt_pk_bf16_f32 v105, v9, v10
    v_perm_b32 v12, v105, v105, s41
    v_bitop3_b32 v66, v4, v12, v66 bitop3:0xca
    v_perm_b32 v13, v105, v105, s42
    v_bitop3_b32 v67, v4, v13, v67 bitop3:0xca
    s_waitcnt vmcnt(10)
    v_lshlrev_b32 v7, 16, v106
    v_and_b32 v8, 0xffff0000, v106
    v_lshlrev_b32 v9, 16, v107
    v_and_b32 v10, 0xffff0000, v107
    v_mul_f32 v7, 0.15915494, v7
    v_mul_f32 v8, 0.15915494, v8
    v_mul_f32 v9, 0.15915494, v9
    v_mul_f32 v10, 0.15915494, v10
    v_mul_hi_u32_u24 v14, 429497, v60
    v_lshrrev_b32 v12, 3, v112
    v_cos_f32 v7, v7
    v_lshlrev_b16 v13, 3, v112
    v_mad_i32_i24 v11, v14, s55, v60
    v_bitop3_b32 v12, v6, v13, v12 bitop3:0xca
    v_lshl_add_u32 v11, v11, 17, s40
    v_lshlrev_b16 v14, 8, v14
    v_lshrrev_b32 v13, 2, v112
    v_add_u32 v60, v12, v11
    v_bitop3_b32 v112, v5, v13, v14 bitop3:0xea
    ds_add_u32 v112, v2
    v_mul_hi_u32_u24 v14, 429497, v61
    v_lshrrev_b32 v12, 3, v113
    v_cos_f32 v8, v8
    v_lshlrev_b16 v13, 3, v113
    v_mad_i32_i24 v11, v14, s55, v61
    v_bitop3_b32 v12, v6, v13, v12 bitop3:0xca
    v_lshl_add_u32 v11, v11, 17, s40
    v_lshlrev_b16 v14, 8, v14
    v_lshrrev_b32 v13, 2, v113
    v_add_u32 v61, v12, v11
    v_bitop3_b32 v113, v5, v13, v14 bitop3:0xea
    ds_add_u32 v113, v2
    v_cvt_pk_bf16_f32 v106, v7, v8
    v_perm_b32 v12, v106, v106, s41
    v_bitop3_b32 v60, v4, v12, v60 bitop3:0xca
    v_perm_b32 v13, v106, v106, s42
    v_bitop3_b32 v61, v4, v13, v61 bitop3:0xca
    v_mul_hi_u32_u24 v14, 429497, v62
    v_lshrrev_b32 v12, 3, v114
    v_cos_f32 v9, v9
    v_lshlrev_b16 v13, 3, v114
    v_mad_i32_i24 v11, v14, s55, v62
    v_bitop3_b32 v12, v6, v13, v12 bitop3:0xca
    v_lshl_add_u32 v11, v11, 17, s40
    v_lshlrev_b16 v14, 8, v14
    v_lshrrev_b32 v13, 2, v114
    v_add_u32 v62, v12, v11
    v_bitop3_b32 v114, v5, v13, v14 bitop3:0xea
    ds_add_u32 v114, v2
    v_mul_hi_u32_u24 v14, 429497, v63
    v_lshrrev_b32 v12, 3, v115
    v_cos_f32 v10, v10
    v_lshlrev_b16 v13, 3, v115
    v_mad_i32_i24 v11, v14, s55, v63
    v_bitop3_b32 v12, v6, v13, v12 bitop3:0xca
    v_lshl_add_u32 v11, v11, 17, s40
    v_lshlrev_b16 v14, 8, v14
    v_lshrrev_b32 v13, 2, v115
    v_add_u32 v63, v12, v11
    v_bitop3_b32 v115, v5, v13, v14 bitop3:0xea
    ds_add_u32 v115, v2
    v_cvt_pk_bf16_f32 v107, v9, v10
    v_perm_b32 v12, v107, v107, s41
    v_bitop3_b32 v62, v4, v12, v62 bitop3:0xca
    v_perm_b32 v13, v107, v107, s42
    v_bitop3_b32 v63, v4, v13, v63 bitop3:0xca
    s_setprio 0
    s_add_u32 s47, s35, 0x548c000
    buffer_store_dwordx4 v[120:123], v0, s[20:23], s47 offen sc1
    s_add_u32 s44, s33, 0x8000000
    s_nop 0
    buffer_load_dwordx4 v[120:123], v0, s[12:15], s44 offen nt
    s_waitcnt vmcnt(8)
    v_lshlrev_b32 v7, 16, v108
    v_and_b32 v8, 0xffff0000, v108
    v_lshlrev_b32 v9, 16, v109
    v_and_b32 v10, 0xffff0000, v109
    v_mul_f32 v7, 0.15915494, v7
    v_mul_f32 v8, 0.15915494, v8
    v_mul_f32 v9, 0.15915494, v9
    v_mul_f32 v10, 0.15915494, v10
    v_mul_hi_u32_u24 v14, 429497, v100
    v_lshrrev_b32 v12, 3, v88
    v_cos_f32 v7, v7
    v_lshlrev_b16 v13, 3, v88
    v_mad_i32_i24 v11, v14, s55, v100
    v_bitop3_b32 v12, v6, v13, v12 bitop3:0xca
    v_lshl_add_u32 v11, v11, 17, s40
    v_lshlrev_b16 v14, 8, v14
    v_lshrrev_b32 v13, 2, v88
    v_add_u32 v100, v12, v11
    v_bitop3_b32 v88, v5, v13, v14 bitop3:0xea
    ds_add_u32 v88, v2
    v_mul_hi_u32_u24 v14, 429497, v101
    v_lshrrev_b32 v12, 3, v89
    v_cos_f32 v8, v8
    v_lshlrev_b16 v13, 3, v89
    v_mad_i32_i24 v11, v14, s55, v101
    v_bitop3_b32 v12, v6, v13, v12 bitop3:0xca
    v_lshl_add_u32 v11, v11, 17, s40
    v_lshlrev_b16 v14, 8, v14
    v_lshrrev_b32 v13, 2, v89
    v_add_u32 v101, v12, v11
    v_bitop3_b32 v89, v5, v13, v14 bitop3:0xea
    ds_add_u32 v89, v2
    v_cvt_pk_bf16_f32 v108, v7, v8
    v_perm_b32 v12, v108, v108, s41
    v_bitop3_b32 v100, v4, v12, v100 bitop3:0xca
    v_perm_b32 v13, v108, v108, s42
    v_bitop3_b32 v101, v4, v13, v101 bitop3:0xca
    v_mul_hi_u32_u24 v14, 429497, v102
    v_lshrrev_b32 v12, 3, v90
    v_cos_f32 v9, v9
    v_lshlrev_b16 v13, 3, v90
    v_mad_i32_i24 v11, v14, s55, v102
    v_bitop3_b32 v12, v6, v13, v12 bitop3:0xca
    v_lshl_add_u32 v11, v11, 17, s40
    v_lshlrev_b16 v14, 8, v14
    v_lshrrev_b32 v13, 2, v90
    v_add_u32 v102, v12, v11
    v_bitop3_b32 v90, v5, v13, v14 bitop3:0xea
    ds_add_u32 v90, v2
    v_mul_hi_u32_u24 v14, 429497, v103
    v_lshrrev_b32 v12, 3, v91
    v_cos_f32 v10, v10
    v_lshlrev_b16 v13, 3, v91
    v_mad_i32_i24 v11, v14, s55, v103
    v_bitop3_b32 v12, v6, v13, v12 bitop3:0xca
    v_lshl_add_u32 v11, v11, 17, s40
    v_lshlrev_b16 v14, 8, v14
    v_lshrrev_b32 v13, 2, v91
    v_add_u32 v103, v12, v11
    v_bitop3_b32 v91, v5, v13, v14 bitop3:0xea
    ds_add_u32 v91, v2
    v_cvt_pk_bf16_f32 v109, v9, v10
    v_perm_b32 v12, v109, v109, s41
    v_bitop3_b32 v102, v4, v12, v102 bitop3:0xca
    v_perm_b32 v13, v109, v109, s42
    v_bitop3_b32 v103, v4, v13, v103 bitop3:0xca
    s_mov_b32 s68, s66
    s_mov_b32 s69, s67
    s_mov_b32 s70, 0x100
    s_mov_b32 s71, 0x20000
    v_mov_b32 v3, 1
    s_cmp_lg_u32 s32, 15
    s_cbranch_scc1 L1_tk
    s_mov_b64 exec, 1
    s_and_b32 s3, s2, 1
    s_lshl_b32 s3, s3, 7
    buffer_atomic_add v3, off, s[68:71], s3 sc0
    s_mov_b64 exec, -1
L1_tk:
    s_waitcnt vmcnt(4)
    v_lshlrev_b32 v7, 16, v110
    v_and_b32 v8, 0xffff0000, v110
    v_lshlrev_b32 v9, 16, v111
    v_and_b32 v10, 0xffff0000, v111
    v_mul_f32 v7, 0.15915494, v7
    v_mul_f32 v8, 0.15915494, v8
    v_mul_f32 v9, 0.15915494, v9
    v_mul_f32 v10, 0.15915494, v10
    v_mul_hi_u32_u24 v14, 429497, v116
    v_lshrrev_b32 v12, 3, v92
    v_cos_f32 v7, v7
    v_lshlrev_b16 v13, 3, v92
    v_mad_i32_i24 v11, v14, s55, v116
    v_bitop3_b32 v12, v6, v13, v12 bitop3:0xca
    v_lshl_add_u32 v11, v11, 17, s40
    v_lshlrev_b16 v14, 8, v14
    v_lshrrev_b32 v13, 2, v92
    v_add_u32 v116, v12, v11
    v_bitop3_b32 v92, v5, v13, v14 bitop3:0xea
    ds_add_u32 v92, v2
    v_mul_hi_u32_u24 v14, 429497, v117
    v_lshrrev_b32 v12, 3, v93
    v_cos_f32 v8, v8
    v_lshlrev_b16 v13, 3, v93
    v_mad_i32_i24 v11, v14, s55, v117
    v_bitop3_b32 v12, v6, v13, v12 bitop3:0xca
    v_lshl_add_u32 v11, v11, 17, s40
    v_lshlrev_b16 v14, 8, v14
    v_lshrrev_b32 v13, 2, v93
    v_add_u32 v117, v12, v11
    v_bitop3_b32 v93, v5, v13, v14 bitop3:0xea
    ds_add_u32 v93, v2
    v_cvt_pk_bf16_f32 v110, v7, v8
    v_perm_b32 v12, v110, v110, s41
    v_bitop3_b32 v116, v4, v12, v116 bitop3:0xca
    v_perm_b32 v13, v110, v110, s42
    v_bitop3_b32 v117, v4, v13, v117 bitop3:0xca
    v_mul_hi_u32_u24 v14, 429497, v118
    v_lshrrev_b32 v12, 3, v94
    v_cos_f32 v9, v9
    v_lshlrev_b16 v13, 3, v94
    v_mad_i32_i24 v11, v14, s55, v118
    v_bitop3_b32 v12, v6, v13, v12 bitop3:0xca
    v_lshl_add_u32 v11, v11, 17, s40
    v_lshlrev_b16 v14, 8, v14
    v_lshrrev_b32 v13, 2, v94
    v_add_u32 v118, v12, v11
    v_bitop3_b32 v94, v5, v13, v14 bitop3:0xea
    ds_add_u32 v94, v2
    v_mul_hi_u32_u24 v14, 429497, v119
    v_lshrrev_b32 v12, 3, v95
    v_cos_f32 v10, v10
    v_lshlrev_b16 v13, 3, v95
    v_mad_i32_i24 v11, v14, s55, v119
    v_bitop3_b32 v12, v6, v13, v12 bitop3:0xca
    v_lshl_add_u32 v11, v11, 17, s40
    v_lshlrev_b16 v14, 8, v14
    v_lshrrev_b32 v13, 2, v95
    v_add_u32 v119, v12, v11
    v_bitop3_b32 v95, v5, v13, v14 bitop3:0xea
    ds_add_u32 v95, v2
    v_cvt_pk_bf16_f32 v111, v9, v10
    v_perm_b32 v12, v111, v111, s41
    v_bitop3_b32 v118, v4, v12, v118 bitop3:0xca
    v_perm_b32 v13, v111, v111, s42
    v_bitop3_b32 v119, v4, v13, v119 bitop3:0xca
    v_lshrrev_b32 v8, 2, v0
    v_and_b32 v7, 0x3c00, v0
    v_bitop3_b32 v7, v5, v8, v7 bitop3:0xea
    s_waitcnt lgkmcnt(0)
    s_barrier
    ds_read2st64_b32 v[8:9], v7 offset0:0 offset1:1
    ds_read2st64_b32 v[10:11], v7 offset0:2 offset1:3
    s_add_u32 s45, s35, 0x5490000
    buffer_store_dwordx4 v[44:47], v0, s[20:23], s45 offen sc1
    s_add_u32 s46, s34, 0x4000000
    s_nop 0
    buffer_load_dwordx2 v[44:45], v1, s[16:19], s46 offen nt
    s_add_u32 s47, s34, 0x4200000
    buffer_load_dwordx2 v[46:47], v1, s[16:19], s47 offen nt
    s_waitcnt lgkmcnt(0)
    v_lshl_or_b32 v12, v9, 16, v8
    v_lshl_or_b32 v13, v11, 16, v10
    v_mov_b32 v14, v12
    v_mov_b32 v15, v13
    s_nop 0
    v_add_u32_dpp v14, v14, v14 row_shr:1 row_mask:0xf bank_mask:0xf bound_ctrl:1
    v_add_u32_dpp v15, v15, v15 row_shr:1 row_mask:0xf bank_mask:0xf bound_ctrl:1
    s_nop 0
    v_add_u32_dpp v14, v14, v14 row_shr:2 row_mask:0xf bank_mask:0xf bound_ctrl:1
    v_add_u32_dpp v15, v15, v15 row_shr:2 row_mask:0xf bank_mask:0xf bound_ctrl:1
    s_nop 0
    v_add_u32_dpp v14, v14, v14 row_shr:4 row_mask:0xf bank_mask:0xf bound_ctrl:1
    v_add_u32_dpp v15, v15, v15 row_shr:4 row_mask:0xf bank_mask:0xf bound_ctrl:1
    s_nop 0
    v_add_u32_dpp v14, v14, v14 row_shr:8 row_mask:0xf bank_mask:0xf bound_ctrl:1
    v_add_u32_dpp v15, v15, v15 row_shr:8 row_mask:0xf bank_mask:0xf bound_ctrl:1
    s_nop 0
    v_add_u32_dpp v14, v14, v14 row_bcast:15 row_mask:0xa bank_mask:0xf
    v_add_u32_dpp v15, v15, v15 row_bcast:15 row_mask:0xa bank_mask:0xf
    s_nop 0
    v_add_u32_dpp v14, v14, v14 row_bcast:31 row_mask:0xc bank_mask:0xf
    v_add_u32_dpp v15, v15, v15 row_bcast:31 row_mask:0xc bank_mask:0xf
    v_readlane_b32 s48, v14, 63
    v_readlane_b32 s49, v15, 63
    s_lshl_b32 s54, s32, 2
    v_mov_b32 v8, s54
    s_and_b32 s50, s48, 0xffff
    s_lshr_b32 s51, s48, 16
    s_and_b32 s52, s49, 0xffff
    s_lshr_b32 s53, s49, 16
    s_add_u32 s51, s51, s50
    s_add_u32 s52, s52, s51
    s_add_u32 s53, s53, s52
    v_mov_b32 v9, s53
    s_mov_b64 exec, 1
    ds_write_b32 v8, v9 offset:16384
    s_waitcnt vmcnt(3)
    ds_write_b32 v8, v3 offset:16448
    s_mov_b64 exec, -1
    v_and_b32 v8, 60, v7
    s_waitcnt lgkmcnt(0)
    s_barrier
    ds_read_b32 v9, v8 offset:16384
    ds_read_b32 v10, v8 offset:16448
    s_waitcnt lgkmcnt(0)
    v_readlane_b32 s84, v10, 15
    s_and_b32 s3, s2, 1
    s_lshl_b32 s3, s3, 7
    s_add_u32 s84, s84, s3
    s_min_u32 s4, s84, 96
    s_min_u32 s5, s84, 192
    s_min_u32 s6, s84, 240
    s_add_u32 s4, s4, s5
    s_add_u32 s4, s4, s6
    s_add_u32 s4, s4, 9467
    s_mov_b32 s4, s84
    s_lshl_b32 s58, s4, 14
    s_lshl_b32 s59, s4, 13
    s_mov_b32 s43, 5
    s_cmp_lt_u32 s84, 96
    s_addc_u32 s43, s43, 0
    s_cmp_lt_u32 s84, 192
    s_addc_u32 s43, s43, 0
    s_cmp_lt_u32 s84, 240
    s_addc_u32 s43, s43, 0
    v_add_u32_dpp v9, v9, v9 row_shr:1 row_mask:0xf bank_mask:0xf bound_ctrl:1
    s_nop 1
    v_add_u32_dpp v9, v9, v9 row_shr:2 row_mask:0xf bank_mask:0xf bound_ctrl:1
    s_nop 1
    v_add_u32_dpp v9, v9, v9 row_shr:4 row_mask:0xf bank_mask:0xf bound_ctrl:1
    s_nop 1
    v_add_u32_dpp v9, v9, v9 row_shr:8 row_mask:0xf bank_mask:0xf bound_ctrl:1
    s_nop 0
    v_readlane_b32 s54, v9, s32
    s_sub_u32 s54, s54, s53
    s_add_u32 s50, s50, s54
    s_add_u32 s51, s51, s54
    s_add_u32 s52, s52, s54
    s_pack_ll_b32_b16 s48, s54, s50
    s_pack_ll_b32_b16 s49, s51, s52
    v_add_u32 v14, s48, v14
    v_add_u32 v15, s49, v15
    v_sub_u32 v12, v14, v12
    v_sub_u32 v13, v15, v13
    v_and_b32 v8, 0xffff, v12
    v_lshrrev_b32 v9, 16, v12
    v_and_b32 v10, 0xffff, v13
    v_lshrrev_b32 v11, 16, v13
    ds_write2st64_b32 v7, v8, v9 offset0:0 offset1:1
    ds_write2st64_b32 v7, v10, v11 offset0:2 offset1:3
    v_and_b32 v8, 0x3f0, v0
    v_lshl_add_u32 v8, v8, 1, s36
    ds_write_b64 v8, v[12:13] offset:20480
    s_bitset0_b64 exec, 63
    s_not_b64 exec, exec
    ds_write_b64 v8, v[14:15] offset:20512
    s_mov_b64 exec, -1
    s_waitcnt lgkmcnt(0)
    s_barrier
    s_setprio 3
    ds_add_rtn_u32 v24, v24, v2
    ds_add_rtn_u32 v25, v25, v2
    ds_add_rtn_u32 v26, v26, v2
    ds_add_rtn_u32 v27, v27, v2
    ds_read_b128 v[12:15], v0 offset:20480
    v_cmp_gt_u32 vcc, 8448, v0
    ds_add_rtn_u32 v52, v52, v2
    ds_add_rtn_u32 v53, v53, v2
    ds_add_rtn_u32 v54, v54, v2
    ds_add_rtn_u32 v55, v55, v2
    s_setprio 2
    ds_add_rtn_u32 v72, v72, v2
    ds_add_rtn_u32 v73, v73, v2
    ds_add_rtn_u32 v74, v74, v2
    ds_add_rtn_u32 v75, v75, v2
    s_waitcnt lgkmcnt(8)
    s_cbranch_vccz L1_p4
    s_add_u32 s44, s35, 0x7ec0000
    s_mov_b64 exec, vcc
    buffer_store_dwordx4 v[12:15], v0, s[24:27], s44 offen sc1
    s_mov_b64 exec, -1
L1_p4:
    s_add_u32 s45, s35, 0x5494000
    buffer_store_dwordx4 v[20:23], v0, s[20:23], s45 offen sc1
    s_add_u32 s46, s33, 0x8400000
    s_nop 0
    buffer_load_dwordx4 v[20:23], v0, s[8:11], s46 offen nt
    ds_add_rtn_u32 v80, v80, v2
    ds_add_rtn_u32 v81, v81, v2
    ds_add_rtn_u32 v82, v82, v2
    ds_add_rtn_u32 v83, v83, v2
    s_setprio 1
    ds_add_rtn_u32 v96, v96, v2
    ds_add_rtn_u32 v97, v97, v2
    ds_add_rtn_u32 v98, v98, v2
    ds_add_rtn_u32 v99, v99, v2
    ds_add_rtn_u32 v112, v112, v2
    ds_add_rtn_u32 v113, v113, v2
    ds_add_rtn_u32 v114, v114, v2
    ds_add_rtn_u32 v115, v115, v2
    s_add_u32 s47, s35, 0x5498000
    buffer_store_dwordx4 v[124:127], v0, s[20:23], s47 offen sc1
    s_add_u32 s44, s33, 0x8400000
    s_nop 0
    buffer_load_dwordx4 v[124:127], v0, s[12:15], s44 offen nt
    s_setprio 0
    ds_add_rtn_u32 v88, v88, v2
    ds_add_rtn_u32 v89, v89, v2
    ds_add_rtn_u32 v90, v90, v2
    ds_add_rtn_u32 v91, v91, v2
    ds_add_rtn_u32 v92, v92, v2
    ds_add_rtn_u32 v93, v93, v2
    ds_add_rtn_u32 v94, v94, v2
    ds_add_rtn_u32 v95, v95, v2
    s_waitcnt lgkmcnt(0)
    s_barrier
    s_setprio 3
    v_and_b32 v7, -4, v24
    v_lshl_add_u32 v8, v24, 2, v7
    ds_write_b32 v8, v40
    v_lshl_add_u32 v7, v7, 2, v24
    ds_write_b8 v7, v84 offset:16
    v_and_b32 v9, -4, v25
    v_lshl_add_u32 v10, v25, 2, v9
    ds_write_b32 v10, v41
    v_lshl_add_u32 v9, v9, 2, v25
    ds_write_b8_d16_hi v9, v84 offset:16
    v_and_b32 v7, -4, v26
    v_lshl_add_u32 v8, v26, 2, v7
    ds_write_b32 v8, v42
    v_lshl_add_u32 v7, v7, 2, v26
    ds_write_b8 v7, v85 offset:16
    v_and_b32 v9, -4, v27
    v_lshl_add_u32 v10, v27, 2, v9
    ds_write_b32 v10, v43
    v_lshl_add_u32 v9, v9, 2, v27
    ds_write_b8_d16_hi v9, v85 offset:16
    s_add_u32 s45, s35, 0x549c000
    buffer_store_dwordx4 v[32:35], v0, s[20:23], s45 offen sc1
    s_add_u32 s46, s33, 0x8800000
    buffer_load_dwordx4 v[40:43], v0, s[8:11], s46 offen nt
    s_add_u32 s47, s33, 0x8800000
    buffer_load_dwordx4 v[24:27], v0, s[12:15], s47 offen nt
    v_and_b32 v7, -4, v52
    v_lshl_add_u32 v8, v52, 2, v7
    ds_write_b32 v8, v48
    v_lshl_add_u32 v7, v7, 2, v52
    ds_write_b8 v7, v86 offset:16
    v_and_b32 v9, -4, v53
    v_lshl_add_u32 v10, v53, 2, v9
    ds_write_b32 v10, v49
    v_lshl_add_u32 v9, v9, 2, v53
    ds_write_b8_d16_hi v9, v86 offset:16
    v_and_b32 v7, -4, v54
    v_lshl_add_u32 v8, v54, 2, v7
    ds_write_b32 v8, v50
    v_lshl_add_u32 v7, v7, 2, v54
    ds_write_b8 v7, v87 offset:16
    v_and_b32 v9, -4, v55
    v_lshl_add_u32 v10, v55, 2, v9
    ds_write_b32 v10, v51
    v_lshl_add_u32 v9, v9, 2, v55
    ds_write_b8_d16_hi v9, v87 offset:16
    s_add_u32 s44, s34, 0x4400000
    buffer_load_dwordx2 v[32:33], v1, s[16:19], s44 offen nt
    s_add_u32 s45, s34, 0x4600000
    buffer_load_dwordx2 v[34:35], v1, s[16:19], s45 offen nt
    s_add_u32 s46, s33, 0x8c00000
    buffer_load_dwordx4 v[48:51], v0, s[8:11], s46 offen nt
    s_setprio 2
    v_and_b32 v7, -4, v72
    v_lshl_add_u32 v8, v72, 2, v7
    ds_write_b32 v8, v68
    v_lshl_add_u32 v7, v7, 2, v72
    ds_write_b8 v7, v56 offset:16
    v_and_b32 v9, -4, v73
    v_lshl_add_u32 v10, v73, 2, v9
    ds_write_b32 v10, v69
    v_lshl_add_u32 v9, v9, 2, v73
    ds_write_b8_d16_hi v9, v56 offset:16
    v_and_b32 v7, -4, v74
    v_lshl_add_u32 v8, v74, 2, v7
    ds_write_b32 v8, v70
    v_lshl_add_u32 v7, v7, 2, v74
    ds_write_b8 v7, v57 offset:16
    v_and_b32 v9, -4, v75
    v_lshl_add_u32 v10, v75, 2, v9
    ds_write_b32 v10, v71
    v_lshl_add_u32 v9, v9, 2, v75
    ds_write_b8_d16_hi v9, v57 offset:16
    s_add_u32 s47, s35, 0x54a0000
    buffer_store_dwordx4 v[36:39], v0, s[20:23], s47 offen sc1
    s_add_u32 s44, s33, 0x8c00000
    buffer_load_dwordx4 v[52:55], v0, s[12:15], s44 offen nt
    v_and_b32 v7, -4, v80
    v_lshl_add_u32 v8, v80, 2, v7
    ds_write_b32 v8, v76
    v_lshl_add_u32 v7, v7, 2, v80
    ds_write_b8 v7, v58 offset:16
    v_and_b32 v9, -4, v81
    v_lshl_add_u32 v10, v81, 2, v9
    ds_write_b32 v10, v77
    v_lshl_add_u32 v9, v9, 2, v81
    ds_write_b8_d16_hi v9, v58 offset:16
    v_and_b32 v7, -4, v82
    v_lshl_add_u32 v8, v82, 2, v7
    ds_write_b32 v8, v78
    v_lshl_add_u32 v7, v7, 2, v82
    ds_write_b8 v7, v59 offset:16
    v_and_b32 v9, -4, v83
    v_lshl_add_u32 v10, v83, 2, v9
    ds_write_b32 v10, v79
    v_lshl_add_u32 v9, v9, 2, v83
    ds_write_b8_d16_hi v9, v59 offset:16
    s_add_u32 s45, s33, 0x9000000
    buffer_load_dwordx4 v[84:87], v0, s[8:11], s45 offen nt
    s_add_u32 s46, s33, 0x9000000
    buffer_load_dwordx4 v[68:71], v0, s[12:15], s46 offen nt
    s_setprio 1
    v_and_b32 v7, -4, v96
    v_lshl_add_u32 v8, v96, 2, v7
    ds_write_b32 v8, v64
    v_lshl_add_u32 v7, v7, 2, v96
    ds_write_b8 v7, v104 offset:16
    v_and_b32 v9, -4, v97
    v_lshl_add_u32 v10, v97, 2, v9
    ds_write_b32 v10, v65
    v_lshl_add_u32 v9, v9, 2, v97
    ds_write_b8_d16_hi v9, v104 offset:16
    v_and_b32 v7, -4, v98
    v_lshl_add_u32 v8, v98, 2, v7
    ds_write_b32 v8, v66
    v_lshl_add_u32 v7, v7, 2, v98
    ds_write_b8 v7, v105 offset:16
    v_and_b32 v9, -4, v99
    v_lshl_add_u32 v10, v99, 2, v9
    ds_write_b32 v10, v67
    v_lshl_add_u32 v9, v9, 2, v99
    ds_write_b8_d16_hi v9, v105 offset:16
    s_add_u32 s47, s34, 0x4800000
    buffer_load_dwordx2 v[72:73], v1, s[16:19], s47 offen nt
    s_cmp_le_u32 s43, 5
    s_cselect_b32 s18, 0, s18
    s_add_u32 s44, s59, 0x4a00000
    buffer_load_dwordx2 v[74:75], v1, s[16:19], s44 offen nt
    s_cmp_le_u32 s43, 5
    s_cselect_b32 s10, 0, s10
    s_add_u32 s45, s58, 0x9400000
    buffer_load_dwordx4 v[36:39], v0, s[8:11], s45 offen nt
    v_and_b32 v7, -4, v112
    v_lshl_add_u32 v8, v112, 2, v7
    ds_write_b32 v8, v60
    v_lshl_add_u32 v7, v7, 2, v112
    ds_write_b8 v7, v106 offset:16
    v_and_b32 v9, -4, v113
    v_lshl_add_u32 v10, v113, 2, v9
    ds_write_b32 v10, v61
    v_lshl_add_u32 v9, v9, 2, v113
    ds_write_b8_d16_hi v9, v106 offset:16
    v_and_b32 v7, -4, v114
    v_lshl_add_u32 v8, v114, 2, v7
    ds_write_b32 v8, v62
    v_lshl_add_u32 v7, v7, 2, v114
    ds_write_b8 v7, v107 offset:16
    v_and_b32 v9, -4, v115
    v_lshl_add_u32 v10, v115, 2, v9
    ds_write_b32 v10, v63
    v_lshl_add_u32 v9, v9, 2, v115
    ds_write_b8_d16_hi v9, v107 offset:16
    s_add_u32 s46, s35, 0x54a4000
    buffer_store_dwordx4 v[28:31], v0, s[20:23], s46 offen sc1
    s_cmp_le_u32 s43, 5
    s_cselect_b32 s14, 0, s14
    s_add_u32 s47, s58, 0x9400000
    buffer_load_dwordx4 v[76:79], v0, s[12:15], s47 offen nt
    s_setprio 0
    v_and_b32 v7, -4, v88
    v_lshl_add_u32 v8, v88, 2, v7
    ds_write_b32 v8, v100
    v_lshl_add_u32 v7, v7, 2, v88
    ds_write_b8 v7, v108 offset:16
    v_and_b32 v9, -4, v89
    v_lshl_add_u32 v10, v89, 2, v9
    ds_write_b32 v10, v101
    v_lshl_add_u32 v9, v9, 2, v89
    ds_write_b8_d16_hi v9, v108 offset:16
    v_and_b32 v7, -4, v90
    v_lshl_add_u32 v8, v90, 2, v7
    ds_write_b32 v8, v102
    v_lshl_add_u32 v7, v7, 2, v90
    ds_write_b8 v7, v109 offset:16
    v_and_b32 v9, -4, v91
    v_lshl_add_u32 v10, v91, 2, v9
    ds_write_b32 v10, v103
    v_lshl_add_u32 v9, v9, 2, v91
    ds_write_b8_d16_hi v9, v109 offset:16
    s_cmp_le_u32 s43, 6
    s_cselect_b32 s10, 0, s10
    s_add_u32 s44, s58, 0x97c0000
    buffer_load_dwordx4 v[80:83], v0, s[8:11], s44 offen nt
    s_cmp_le_u32 s43, 6
    s_cselect_b32 s14, 0, s14
    s_add_u32 s45, s58, 0x97c0000
    buffer_load_dwordx4 v[56:59], v0, s[12:15], s45 offen nt
    v_and_b32 v7, -4, v92
    v_lshl_add_u32 v8, v92, 2, v7
    ds_write_b32 v8, v116
    v_lshl_add_u32 v7, v7, 2, v92
    ds_write_b8 v7, v110 offset:16
    v_and_b32 v9, -4, v93
    v_lshl_add_u32 v10, v93, 2, v9
    ds_write_b32 v10, v117
    v_lshl_add_u32 v9, v9, 2, v93
    ds_write_b8_d16_hi v9, v110 offset:16
    v_and_b32 v7, -4, v94
    v_lshl_add_u32 v8, v94, 2, v7
    ds_write_b32 v8, v118
    v_lshl_add_u32 v7, v7, 2, v94
    ds_write_b8 v7, v111 offset:16
    v_and_b32 v9, -4, v95
    v_lshl_add_u32 v10, v95, 2, v9
    ds_write_b32 v10, v119
    v_lshl_add_u32 v9, v9, 2, v95
    ds_write_b8_d16_hi v9, v111 offset:16
    s_cmp_le_u32 s43, 6
    s_cselect_b32 s18, 0, s18
    s_add_u32 s46, s59, 0x4be0000
    buffer_load_dwordx2 v[64:65], v1, s[16:19], s46 offen nt
    s_cmp_le_u32 s43, 7
    s_cselect_b32 s18, 0, s18
    s_add_u32 s47, s59, 0x4d60000
    buffer_load_dwordx2 v[66:67], v1, s[16:19], s47 offen nt
    v_add_u32 v7, 0x10000, v0
    v_add_u32 v12, 0x20000, v0
    v_mov_b32 v8, 0
    v_mov_b32 v9, 0
    v_mov_b32 v10, 0
    v_mov_b32 v11, 0
    s_waitcnt lgkmcnt(0)
    s_barrier
    ds_read_b128 v[96:99], v0 offset:0
    ds_write_b128 v0, v[8:11]
    ds_read_b128 v[60:63], v0 offset:16384
    ds_read_b128 v[112:115], v0 offset:32768
    ds_read_b128 v[104:107], v0 offset:49152
    ds_read_b128 v[28:31], v7 offset:0
    ds_read_b128 v[100:103], v7 offset:16384
    ds_read_b128 v[88:91], v7 offset:32768
    ds_read_b128 v[116:119], v7 offset:49152
    ds_read_b128 v[92:95], v12 offset:0
    ds_read_b128 v[108:111], v12 offset:16384
    s_waitcnt lgkmcnt(0)
    s_barrier
    v_lshlrev_b32 v3, 3, v0
    v_and_b32 v3, 0x80, v3
    s_cmp_lg_u32 s32, 15
    s_cbranch_scc1 L2_k0
    s_mov_b64 exec, 3
    buffer_load_dword v3, v3, s[68:71], 0 offen sc1
    s_mov_b64 exec, -1
L2_k0:
    s_add_u32 s44, s35, 0x7ec0000
    buffer_store_dwordx4 v[96:99], v0, s[20:23], s44 offen sc1
    s_cmp_le_u32 s43, 7
    s_cselect_b32 s10, 0, s10
    s_add_u32 s45, s58, 0x9ac0000
    buffer_load_dwordx4 v[96:99], v0, s[8:11], s45 offen nt
    s_add_u32 s46, s35, 0x7ec4000
    buffer_store_dwordx4 v[60:63], v0, s[20:23], s46 offen sc1
    s_cmp_le_u32 s43, 7
    s_cselect_b32 s14, 0, s14
    s_add_u32 s47, s58, 0x9ac0000
    buffer_load_dwordx4 v[60:63], v0, s[12:15], s47 offen nt
    s_setprio 3
    s_waitcnt vmcnt(27)
    v_lshlrev_b32 v7, 16, v44
    v_and_b32 v8, 0xffff0000, v44
    v_lshlrev_b32 v9, 16, v45
    v_and_b32 v10, 0xffff0000, v45
    v_mul_f32 v7, 0.15915494, v7
    v_mul_f32 v8, 0.15915494, v8
    v_mul_f32 v9, 0.15915494, v9
    v_mul_f32 v10, 0.15915494, v10
    v_mul_hi_u32_u24 v14, 429497, v16
    v_lshrrev_b32 v12, 3, v120
    v_cos_f32 v7, v7
    v_lshlrev_b16 v13, 3, v120
    v_mad_i32_i24 v11, v14, s55, v16
    v_bitop3_b32 v12, v6, v13, v12 bitop3:0xca
    v_lshl_add_u32 v11, v11, 17, s40
    v_lshlrev_b16 v14, 8, v14
    v_lshrrev_b32 v13, 2, v120
    v_add_u32 v16, v12, v11
    v_bitop3_b32 v120, v5, v13, v14 bitop3:0xea
    ds_add_u32 v120, v2
    v_mul_hi_u32_u24 v14, 429497, v17
    v_lshrrev_b32 v12, 3, v121
    v_cos_f32 v8, v8
    v_lshlrev_b16 v13, 3, v121
    v_mad_i32_i24 v11, v14, s55, v17
    v_bitop3_b32 v12, v6, v13, v12 bitop3:0xca
    v_lshl_add_u32 v11, v11, 17, s40
    v_lshlrev_b16 v14, 8, v14
    v_lshrrev_b32 v13, 2, v121
    v_add_u32 v17, v12, v11
    v_bitop3_b32 v121, v5, v13, v14 bitop3:0xea
    ds_add_u32 v121, v2
    v_cvt_pk_bf16_f32 v44, v7, v8
    v_perm_b32 v12, v44, v44, s41
    v_bitop3_b32 v16, v4, v12, v16 bitop3:0xca
    v_perm_b32 v13, v44, v44, s42
    v_bitop3_b32 v17, v4, v13, v17 bitop3:0xca
    v_mul_hi_u32_u24 v14, 429497, v18
    v_lshrrev_b32 v12, 3, v122
    v_cos_f32 v9, v9
    v_lshlrev_b16 v13, 3, v122
    v_mad_i32_i24 v11, v14, s55, v18
    v_bitop3_b32 v12, v6, v13, v12 bitop3:0xca
    v_lshl_add_u32 v11, v11, 17, s40
    v_lshlrev_b16 v14, 8, v14
    v_lshrrev_b32 v13, 2, v122
    v_add_u32 v18, v12, v11
    v_bitop3_b32 v122, v5, v13, v14 bitop3:0xea
    ds_add_u32 v122, v2
    v_mul_hi_u32_u24 v14, 429497, v19
    v_lshrrev_b32 v12, 3, v123
    v_cos_f32 v10, v10
    v_lshlrev_b16 v13, 3, v123
    v_mad_i32_i24 v11, v14, s55, v19
    v_bitop3_b32 v12, v6, v13, v12 bitop3:0xca
    v_lshl_add_u32 v11, v11, 17, s40
    v_lshlrev_b16 v14, 8, v14
    v_lshrrev_b32 v13, 2, v123
    v_add_u32 v19, v12, v11
    v_bitop3_b32 v123, v5, v13, v14 bitop3:0xea
    ds_add_u32 v123, v2
    v_cvt_pk_bf16_f32 v45, v9, v10
    v_perm_b32 v12, v45, v45, s41
    v_bitop3_b32 v18, v4, v12, v18 bitop3:0xca
    v_perm_b32 v13, v45, v45, s42
    v_bitop3_b32 v19, v4, v13, v19 bitop3:0xca
    s_add_u32 s44, s35, 0x7ec8000
    buffer_store_dwordx4 v[112:115], v0, s[20:23], s44 offen sc1
    s_waitcnt vmcnt(24)
    v_lshlrev_b32 v7, 16, v46
    v_and_b32 v8, 0xffff0000, v46
    v_lshlrev_b32 v9, 16, v47
    v_and_b32 v10, 0xffff0000, v47
    v_mul_f32 v7, 0.15915494, v7
    v_mul_f32 v8, 0.15915494, v8
    v_mul_f32 v9, 0.15915494, v9
    v_mul_f32 v10, 0.15915494, v10
    v_mul_hi_u32_u24 v14, 429497, v20
    v_lshrrev_b32 v12, 3, v124
    v_cos_f32 v7, v7
    v_lshlrev_b16 v13, 3, v124
    v_mad_i32_i24 v11, v14, s55, v20
    v_bitop3_b32 v12, v6, v13, v12 bitop3:0xca
    v_lshl_add_u32 v11, v11, 17, s40
    v_lshlrev_b16 v14, 8, v14
    v_lshrrev_b32 v13, 2, v124
    v_add_u32 v20, v12, v11
    v_bitop3_b32 v124, v5, v13, v14 bitop3:0xea
    ds_add_u32 v124, v2
    v_mul_hi_u32_u24 v14, 429497, v21
    v_lshrrev_b32 v12, 3, v125
    v_cos_f32 v8, v8
    v_lshlrev_b16 v13, 3, v125
    v_mad_i32_i24 v11, v14, s55, v21
    v_bitop3_b32 v12, v6, v13, v12 bitop3:0xca
    v_lshl_add_u32 v11, v11, 17, s40
    v_lshlrev_b16 v14, 8, v14
    v_lshrrev_b32 v13, 2, v125
    v_add_u32 v21, v12, v11
    v_bitop3_b32 v125, v5, v13, v14 bitop3:0xea
    ds_add_u32 v125, v2
    v_cvt_pk_bf16_f32 v46, v7, v8
    v_perm_b32 v12, v46, v46, s41
    v_bitop3_b32 v20, v4, v12, v20 bitop3:0xca
    v_perm_b32 v13, v46, v46, s42
    v_bitop3_b32 v21, v4, v13, v21 bitop3:0xca
    v_mul_hi_u32_u24 v14, 429497, v22
    v_lshrrev_b32 v12, 3, v126
    v_cos_f32 v9, v9
    v_lshlrev_b16 v13, 3, v126
    v_mad_i32_i24 v11, v14, s55, v22
    v_bitop3_b32 v12, v6, v13, v12 bitop3:0xca
    v_lshl_add_u32 v11, v11, 17, s40
    v_lshlrev_b16 v14, 8, v14
    v_lshrrev_b32 v13, 2, v126
    v_add_u32 v22, v12, v11
    v_bitop3_b32 v126, v5, v13, v14 bitop3:0xea
    ds_add_u32 v126, v2
    v_mul_hi_u32_u24 v14, 429497, v23
    v_lshrrev_b32 v12, 3, v127
    v_cos_f32 v10, v10
    v_lshlrev_b16 v13, 3, v127
    v_mad_i32_i24 v11, v14, s55, v23
    v_bitop3_b32 v12, v6, v13, v12 bitop3:0xca
    v_lshl_add_u32 v11, v11, 17, s40
    v_lshlrev_b16 v14, 8, v14
    v_lshrrev_b32 v13, 2, v127
    v_add_u32 v23, v12, v11
    v_bitop3_b32 v127, v5, v13, v14 bitop3:0xea
    ds_add_u32 v127, v2
    v_cvt_pk_bf16_f32 v47, v9, v10
    v_perm_b32 v12, v47, v47, s41
    v_bitop3_b32 v22, v4, v12, v22 bitop3:0xca
    v_perm_b32 v13, v47, v47, s42
    v_bitop3_b32 v23, v4, v13, v23 bitop3:0xca
    s_setprio 2
    s_add_u32 s45, s35, 0x7ecc000
    buffer_store_dwordx4 v[104:107], v0, s[20:23], s45 offen sc1
    s_waitcnt vmcnt(20)
    v_lshlrev_b32 v7, 16, v32
    v_and_b32 v8, 0xffff0000, v32
    v_lshlrev_b32 v9, 16, v33
    v_and_b32 v10, 0xffff0000, v33
    v_mul_f32 v7, 0.15915494, v7
    v_mul_f32 v8, 0.15915494, v8
    v_mul_f32 v9, 0.15915494, v9
    v_mul_f32 v10, 0.15915494, v10
    v_mul_hi_u32_u24 v14, 429497, v40
    v_lshrrev_b32 v12, 3, v24
    v_cos_f32 v7, v7
    v_lshlrev_b16 v13, 3, v24
    v_mad_i32_i24 v11, v14, s55, v40
    v_bitop3_b32 v12, v6, v13, v12 bitop3:0xca
    v_lshl_add_u32 v11, v11, 17, s40
    v_lshlrev_b16 v14, 8, v14
    v_lshrrev_b32 v13, 2, v24
    v_add_u32 v40, v12, v11
    v_bitop3_b32 v24, v5, v13, v14 bitop3:0xea
    ds_add_u32 v24, v2
    v_mul_hi_u32_u24 v14, 429497, v41
    v_lshrrev_b32 v12, 3, v25
    v_cos_f32 v8, v8
    v_lshlrev_b16 v13, 3, v25
    v_mad_i32_i24 v11, v14, s55, v41
    v_bitop3_b32 v12, v6, v13, v12 bitop3:0xca
    v_lshl_add_u32 v11, v11, 17, s40
    v_lshlrev_b16 v14, 8, v14
    v_lshrrev_b32 v13, 2, v25
    v_add_u32 v41, v12, v11
    v_bitop3_b32 v25, v5, v13, v14 bitop3:0xea
    ds_add_u32 v25, v2
    v_cvt_pk_bf16_f32 v32, v7, v8
    v_perm_b32 v12, v32, v32, s41
    v_bitop3_b32 v40, v4, v12, v40 bitop3:0xca
    v_perm_b32 v13, v32, v32, s42
    v_bitop3_b32 v41, v4, v13, v41 bitop3:0xca
    v_mul_hi_u32_u24 v14, 429497, v42
    v_lshrrev_b32 v12, 3, v26
    v_cos_f32 v9, v9
    v_lshlrev_b16 v13, 3, v26
    v_mad_i32_i24 v11, v14, s55, v42
    v_bitop3_b32 v12, v6, v13, v12 bitop3:0xca
    v_lshl_add_u32 v11, v11, 17, s40
    v_lshlrev_b16 v14, 8, v14
    v_lshrrev_b32 v13, 2, v26
    v_add_u32 v42, v12, v11
    v_bitop3_b32 v26, v5, v13, v14 bitop3:0xea
    ds_add_u32 v26, v2
    v_mul_hi_u32_u24 v14, 429497, v43
    v_lshrrev_b32 v12, 3, v27
    v_cos_f32 v10, v10
    v_lshlrev_b16 v13, 3, v27
    v_mad_i32_i24 v11, v14, s55, v43
    v_bitop3_b32 v12, v6, v13, v12 bitop3:0xca
    v_lshl_add_u32 v11, v11, 17, s40
    v_lshlrev_b16 v14, 8, v14
    v_lshrrev_b32 v13, 2, v27
    v_add_u32 v43, v12, v11
    v_bitop3_b32 v27, v5, v13, v14 bitop3:0xea
    ds_add_u32 v27, v2
    v_cvt_pk_bf16_f32 v33, v9, v10
    v_perm_b32 v12, v33, v33, s41
    v_bitop3_b32 v42, v4, v12, v42 bitop3:0xca
    v_perm_b32 v13, v33, v33, s42
    v_bitop3_b32 v43, v4, v13, v43 bitop3:0xca
    s_waitcnt vmcnt(17)
    v_lshlrev_b32 v7, 16, v34
    v_and_b32 v8, 0xffff0000, v34
    v_lshlrev_b32 v9, 16, v35
    v_and_b32 v10, 0xffff0000, v35
    v_mul_f32 v7, 0.15915494, v7
    v_mul_f32 v8, 0.15915494, v8
    v_mul_f32 v9, 0.15915494, v9
    v_mul_f32 v10, 0.15915494, v10
    v_mul_hi_u32_u24 v14, 429497, v48
    v_lshrrev_b32 v12, 3, v52
    v_cos_f32 v7, v7
    v_lshlrev_b16 v13, 3, v52
    v_mad_i32_i24 v11, v14, s55, v48
    v_bitop3_b32 v12, v6, v13, v12 bitop3:0xca
    v_lshl_add_u32 v11, v11, 17, s40
    v_lshlrev_b16 v14, 8, v14
    v_lshrrev_b32 v13, 2, v52
    v_add_u32 v48, v12, v11
    v_bitop3_b32 v52, v5, v13, v14 bitop3:0xea
    ds_add_u32 v52, v2
    v_mul_hi_u32_u24 v14, 429497, v49
    v_lshrrev_b32 v12, 3, v53
    v_cos_f32 v8, v8
    v_lshlrev_b16 v13, 3, v53
    v_mad_i32_i24 v11, v14, s55, v49
    v_bitop3_b32 v12, v6, v13, v12 bitop3:0xca
    v_lshl_add_u32 v11, v11, 17, s40
    v_lshlrev_b16 v14, 8, v14
    v_lshrrev_b32 v13, 2, v53
    v_add_u32 v49, v12, v11
    v_bitop3_b32 v53, v5, v13, v14 bitop3:0xea
    ds_add_u32 v53, v2
    v_cvt_pk_bf16_f32 v34, v7, v8
    v_perm_b32 v12, v34, v34, s41
    v_bitop3_b32 v48, v4, v12, v48 bitop3:0xca
    v_perm_b32 v13, v34, v34, s42
    v_bitop3_b32 v49, v4, v13, v49 bitop3:0xca
    v_mul_hi_u32_u24 v14, 429497, v50
    v_lshrrev_b32 v12, 3, v54
    v_cos_f32 v9, v9
    v_lshlrev_b16 v13, 3, v54
    v_mad_i32_i24 v11, v14, s55, v50
    v_bitop3_b32 v12, v6, v13, v12 bitop3:0xca
    v_lshl_add_u32 v11, v11, 17, s40
    v_lshlrev_b16 v14, 8, v14
    v_lshrrev_b32 v13, 2, v54
    v_add_u32 v50, v12, v11
    v_bitop3_b32 v54, v5, v13, v14 bitop3:0xea
    ds_add_u32 v54, v2
    v_mul_hi_u32_u24 v14, 429497, v51
    v_lshrrev_b32 v12, 3, v55
    v_cos_f32 v10, v10
    v_lshlrev_b16 v13, 3, v55
    v_mad_i32_i24 v11, v14, s55, v51
    v_bitop3_b32 v12, v6, v13, v12 bitop3:0xca
    v_lshl_add_u32 v11, v11, 17, s40
    v_lshlrev_b16 v14, 8, v14
    v_lshrrev_b32 v13, 2, v55
    v_add_u32 v51, v12, v11
    v_bitop3_b32 v55, v5, v13, v14 bitop3:0xea
    ds_add_u32 v55, v2
    v_cvt_pk_bf16_f32 v35, v9, v10
    v_perm_b32 v12, v35, v35, s41
    v_bitop3_b32 v50, v4, v12, v50 bitop3:0xca
    v_perm_b32 v13, v35, v35, s42
    v_bitop3_b32 v51, v4, v13, v51 bitop3:0xca
    s_setprio 1
    s_add_u32 s46, s35, 0x7ed0000
    buffer_store_dwordx4 v[28:31], v0, s[20:23], s46 offen sc1
    v_lshrrev_b32 v15, 2, v0
    v_and_b32 v15, v5, v15
    s_cmp_ge_u32 s84, 128
    s_cselect_b32 s82, 0, s82
    s_and_b32 s3, s84, 1
    s_mul_i32 s3, s3, 40
    s_add_u32 s3, s3, s32
    s_mul_i32 s4, s3, 205
    s_lshr_b32 s4, s4, 10
    s_mul_i32 s5, s4, 5
    s_sub_u32 s5, s3, s5
    s_lshl_b32 s6, s4, 1
    s_add_u32 s6, s6, s5
    s_add_u32 s7, s6, s4
    s_add_u32 s7, s7, 30
    s_cmp_lt_u32 s5, 2
    s_cselect_b32 s6, s6, s7
    s_lshl_b32 s6, s6, 10
    s_lshr_b32 s7, s84, 1
    s_mul_i32 s7, s7, 80000
    s_add_u32 s6, s6, s7
    buffer_load_dword v112, v15, s[80:83], s6 offen offset:0
    buffer_load_dword v113, v15, s[80:83], s6 offen offset:256
    buffer_load_dword v114, v15, s[80:83], s6 offen offset:512
    buffer_load_dword v115, v15, s[80:83], s6 offen offset:768
    s_and_b32 s3, s84, 1
    s_mul_i32 s3, s3, 40
    s_add_u32 s3, s3, s32
    s_add_u32 s3, s3, 16
    s_mul_i32 s4, s3, 205
    s_lshr_b32 s4, s4, 10
    s_mul_i32 s5, s4, 5
    s_sub_u32 s5, s3, s5
    s_lshl_b32 s6, s4, 1
    s_add_u32 s6, s6, s5
    s_add_u32 s7, s6, s4
    s_add_u32 s7, s7, 30
    s_cmp_lt_u32 s5, 2
    s_cselect_b32 s6, s6, s7
    s_lshl_b32 s6, s6, 10
    s_lshr_b32 s7, s84, 1
    s_mul_i32 s7, s7, 80000
    s_add_u32 s6, s6, s7
    buffer_load_dword v104, v15, s[80:83], s6 offen offset:0
    buffer_load_dword v105, v15, s[80:83], s6 offen offset:256
    buffer_load_dword v106, v15, s[80:83], s6 offen offset:512
    buffer_load_dword v107, v15, s[80:83], s6 offen offset:768
    s_and_b32 s3, s84, 1
    s_mul_i32 s3, s3, 40
    s_add_u32 s3, s3, s32
    s_add_u32 s3, s3, 32
    s_cmp_ge_u32 s32, 8
    s_cselect_b32 s82, 0, s82
    s_mul_i32 s4, s3, 205
    s_lshr_b32 s4, s4, 10
    s_mul_i32 s5, s4, 5
    s_sub_u32 s5, s3, s5
    s_lshl_b32 s6, s4, 1
    s_add_u32 s6, s6, s5
    s_add_u32 s7, s6, s4
    s_add_u32 s7, s7, 30
    s_cmp_lt_u32 s5, 2
    s_cselect_b32 s6, s6, s7
    s_lshl_b32 s6, s6, 10
    s_lshr_b32 s7, s84, 1
    s_mul_i32 s7, s7, 80000
    s_add_u32 s6, s6, s7
    buffer_load_dword v28, v15, s[80:83], s6 offen offset:0
    buffer_load_dword v29, v15, s[80:83], s6 offen offset:256
    buffer_load_dword v30, v15, s[80:83], s6 offen offset:512
    buffer_load_dword v31, v15, s[80:83], s6 offen offset:768
    s_waitcnt vmcnt(26)
    v_lshlrev_b32 v7, 16, v72
    v_and_b32 v8, 0xffff0000, v72
    v_lshlrev_b32 v9, 16, v73
    v_and_b32 v10, 0xffff0000, v73
    v_mul_f32 v7, 0.15915494, v7
    v_mul_f32 v8, 0.15915494, v8
    v_mul_f32 v9, 0.15915494, v9
    v_mul_f32 v10, 0.15915494, v10
    v_mul_hi_u32_u24 v14, 429497, v84
    v_lshrrev_b32 v12, 3, v68
    v_cos_f32 v7, v7
    v_lshlrev_b16 v13, 3, v68
    v_mad_i32_i24 v11, v14, s55, v84
    v_bitop3_b32 v12, v6, v13, v12 bitop3:0xca
    v_lshl_add_u32 v11, v11, 17, s40
    v_lshlrev_b16 v14, 8, v14
    v_lshrrev_b32 v13, 2, v68
    v_add_u32 v84, v12, v11
    v_bitop3_b32 v68, v5, v13, v14 bitop3:0xea
    ds_add_u32 v68, v2
    v_mul_hi_u32_u24 v14, 429497, v85
    v_lshrrev_b32 v12, 3, v69
    v_cos_f32 v8, v8
    v_lshlrev_b16 v13, 3, v69
    v_mad_i32_i24 v11, v14, s55, v85
    v_bitop3_b32 v12, v6, v13, v12 bitop3:0xca
    v_lshl_add_u32 v11, v11, 17, s40
    v_lshlrev_b16 v14, 8, v14
    v_lshrrev_b32 v13, 2, v69
    v_add_u32 v85, v12, v11
    v_bitop3_b32 v69, v5, v13, v14 bitop3:0xea
    ds_add_u32 v69, v2
    v_cvt_pk_bf16_f32 v72, v7, v8
    v_perm_b32 v12, v72, v72, s41
    v_bitop3_b32 v84, v4, v12, v84 bitop3:0xca
    v_perm_b32 v13, v72, v72, s42
    v_bitop3_b32 v85, v4, v13, v85 bitop3:0xca
    v_mul_hi_u32_u24 v14, 429497, v86
    v_lshrrev_b32 v12, 3, v70
    v_cos_f32 v9, v9
    v_lshlrev_b16 v13, 3, v70
    v_mad_i32_i24 v11, v14, s55, v86
    v_bitop3_b32 v12, v6, v13, v12 bitop3:0xca
    v_lshl_add_u32 v11, v11, 17, s40
    v_lshlrev_b16 v14, 8, v14
    v_lshrrev_b32 v13, 2, v70
    v_add_u32 v86, v12, v11
    v_bitop3_b32 v70, v5, v13, v14 bitop3:0xea
    ds_add_u32 v70, v2
    v_mul_hi_u32_u24 v14, 429497, v87
    v_lshrrev_b32 v12, 3, v71
    v_cos_f32 v10, v10
    v_lshlrev_b16 v13, 3, v71
    v_mad_i32_i24 v11, v14, s55, v87
    v_bitop3_b32 v12, v6, v13, v12 bitop3:0xca
    v_lshl_add_u32 v11, v11, 17, s40
    v_lshlrev_b16 v14, 8, v14
    v_lshrrev_b32 v13, 2, v71
    v_add_u32 v87, v12, v11
    v_bitop3_b32 v71, v5, v13, v14 bitop3:0xea
    ds_add_u32 v71, v2
    v_cvt_pk_bf16_f32 v73, v9, v10
    v_perm_b32 v12, v73, v73, s41
    v_bitop3_b32 v86, v4, v12, v86 bitop3:0xca
    v_perm_b32 v13, v73, v73, s42
    v_bitop3_b32 v87, v4, v13, v87 bitop3:0xca
    s_waitcnt vmcnt(23)
    s_cmp_le_u32 s43, 5
    s_cbranch_scc1 L1_s5
    v_lshlrev_b32 v7, 16, v74
    v_and_b32 v8, 0xffff0000, v74
    v_lshlrev_b32 v9, 16, v75
    v_and_b32 v10, 0xffff0000, v75
    v_mul_f32 v7, 0.15915494, v7
    v_mul_f32 v8, 0.15915494, v8
    v_mul_f32 v9, 0.15915494, v9
    v_mul_f32 v10, 0.15915494, v10
    v_mul_hi_u32_u24 v14, 429497, v36
    v_lshrrev_b32 v12, 3, v76
    v_cos_f32 v7, v7
    v_lshlrev_b16 v13, 3, v76
    v_mad_i32_i24 v11, v14, s55, v36
    v_bitop3_b32 v12, v6, v13, v12 bitop3:0xca
    v_lshl_add_u32 v11, v11, 17, s40
    v_lshlrev_b16 v14, 8, v14
    v_lshrrev_b32 v13, 2, v76
    v_add_u32 v36, v12, v11
    v_bitop3_b32 v76, v5, v13, v14 bitop3:0xea
    ds_add_u32 v76, v2
    v_mul_hi_u32_u24 v14, 429497, v37
    v_lshrrev_b32 v12, 3, v77
    v_cos_f32 v8, v8
    v_lshlrev_b16 v13, 3, v77
    v_mad_i32_i24 v11, v14, s55, v37
    v_bitop3_b32 v12, v6, v13, v12 bitop3:0xca
    v_lshl_add_u32 v11, v11, 17, s40
    v_lshlrev_b16 v14, 8, v14
    v_lshrrev_b32 v13, 2, v77
    v_add_u32 v37, v12, v11
    v_bitop3_b32 v77, v5, v13, v14 bitop3:0xea
    ds_add_u32 v77, v2
    v_cvt_pk_bf16_f32 v74, v7, v8
    v_perm_b32 v12, v74, v74, s41
    v_bitop3_b32 v36, v4, v12, v36 bitop3:0xca
    v_perm_b32 v13, v74, v74, s42
    v_bitop3_b32 v37, v4, v13, v37 bitop3:0xca
    v_mul_hi_u32_u24 v14, 429497, v38
    v_lshrrev_b32 v12, 3, v78
    v_cos_f32 v9, v9
    v_lshlrev_b16 v13, 3, v78
    v_mad_i32_i24 v11, v14, s55, v38
    v_bitop3_b32 v12, v6, v13, v12 bitop3:0xca
    v_lshl_add_u32 v11, v11, 17, s40
    v_lshlrev_b16 v14, 8, v14
    v_lshrrev_b32 v13, 2, v78
    v_add_u32 v38, v12, v11
    v_bitop3_b32 v78, v5, v13, v14 bitop3:0xea
    ds_add_u32 v78, v2
    v_mul_hi_u32_u24 v14, 429497, v39
    v_lshrrev_b32 v12, 3, v79
    v_cos_f32 v10, v10
    v_lshlrev_b16 v13, 3, v79
    v_mad_i32_i24 v11, v14, s55, v39
    v_bitop3_b32 v12, v6, v13, v12 bitop3:0xca
    v_lshl_add_u32 v11, v11, 17, s40
    v_lshlrev_b16 v14, 8, v14
    v_lshrrev_b32 v13, 2, v79
    v_add_u32 v39, v12, v11
    v_bitop3_b32 v79, v5, v13, v14 bitop3:0xea
    ds_add_u32 v79, v2
    v_cvt_pk_bf16_f32 v75, v9, v10
    v_perm_b32 v12, v75, v75, s41
    v_bitop3_b32 v38, v4, v12, v38 bitop3:0xca
    v_perm_b32 v13, v75, v75, s42
    v_bitop3_b32 v39, v4, v13, v39 bitop3:0xca
L1_s5:
    s_setprio 0
    s_waitcnt vmcnt(19)
    s_cmp_le_u32 s43, 6
    s_cbranch_scc1 L1_s6
    v_lshlrev_b32 v7, 16, v64
    v_and_b32 v8, 0xffff0000, v64
    v_lshlrev_b32 v9, 16, v65
    v_and_b32 v10, 0xffff0000, v65
    v_mul_f32 v7, 0.15915494, v7
    v_mul_f32 v8, 0.15915494, v8
    v_mul_f32 v9, 0.15915494, v9
    v_mul_f32 v10, 0.15915494, v10
    v_mul_hi_u32_u24 v14, 429497, v80
    v_lshrrev_b32 v12, 3, v56
    v_cos_f32 v7, v7
    v_lshlrev_b16 v13, 3, v56
    v_mad_i32_i24 v11, v14, s55, v80
    v_bitop3_b32 v12, v6, v13, v12 bitop3:0xca
    v_lshl_add_u32 v11, v11, 17, s40
    v_lshlrev_b16 v14, 8, v14
    v_lshrrev_b32 v13, 2, v56
    v_add_u32 v80, v12, v11
    v_bitop3_b32 v56, v5, v13, v14 bitop3:0xea
    ds_add_u32 v56, v2
    v_mul_hi_u32_u24 v14, 429497, v81
    v_lshrrev_b32 v12, 3, v57
    v_cos_f32 v8, v8
    v_lshlrev_b16 v13, 3, v57
    v_mad_i32_i24 v11, v14, s55, v81
    v_bitop3_b32 v12, v6, v13, v12 bitop3:0xca
    v_lshl_add_u32 v11, v11, 17, s40
    v_lshlrev_b16 v14, 8, v14
    v_lshrrev_b32 v13, 2, v57
    v_add_u32 v81, v12, v11
    v_bitop3_b32 v57, v5, v13, v14 bitop3:0xea
    ds_add_u32 v57, v2
    v_cvt_pk_bf16_f32 v64, v7, v8
    v_perm_b32 v12, v64, v64, s41
    v_bitop3_b32 v80, v4, v12, v80 bitop3:0xca
    v_perm_b32 v13, v64, v64, s42
    v_bitop3_b32 v81, v4, v13, v81 bitop3:0xca
    v_mul_hi_u32_u24 v14, 429497, v82
    v_lshrrev_b32 v12, 3, v58
    v_cos_f32 v9, v9
    v_lshlrev_b16 v13, 3, v58
    v_mad_i32_i24 v11, v14, s55, v82
    v_bitop3_b32 v12, v6, v13, v12 bitop3:0xca
    v_lshl_add_u32 v11, v11, 17, s40
    v_lshlrev_b16 v14, 8, v14
    v_lshrrev_b32 v13, 2, v58
    v_add_u32 v82, v12, v11
    v_bitop3_b32 v58, v5, v13, v14 bitop3:0xea
    ds_add_u32 v58, v2
    v_mul_hi_u32_u24 v14, 429497, v83
    v_lshrrev_b32 v12, 3, v59
    v_cos_f32 v10, v10
    v_lshlrev_b16 v13, 3, v59
    v_mad_i32_i24 v11, v14, s55, v83
    v_bitop3_b32 v12, v6, v13, v12 bitop3:0xca
    v_lshl_add_u32 v11, v11, 17, s40
    v_lshlrev_b16 v14, 8, v14
    v_lshrrev_b32 v13, 2, v59
    v_add_u32 v83, v12, v11
    v_bitop3_b32 v59, v5, v13, v14 bitop3:0xea
    ds_add_u32 v59, v2
    v_cvt_pk_bf16_f32 v65, v9, v10
    v_perm_b32 v12, v65, v65, s41
    v_bitop3_b32 v82, v4, v12, v82 bitop3:0xca
    v_perm_b32 v13, v65, v65, s42
    v_bitop3_b32 v83, v4, v13, v83 bitop3:0xca
L1_s6:
    s_waitcnt vmcnt(15)
    s_cmp_le_u32 s43, 7
    s_cbranch_scc1 L1_s7
    v_lshlrev_b32 v7, 16, v66
    v_and_b32 v8, 0xffff0000, v66
    v_lshlrev_b32 v9, 16, v67
    v_and_b32 v10, 0xffff0000, v67
    v_mul_f32 v7, 0.15915494, v7
    v_mul_f32 v8, 0.15915494, v8
    v_mul_f32 v9, 0.15915494, v9
    v_mul_f32 v10, 0.15915494, v10
    v_mul_hi_u32_u24 v14, 429497, v96
    v_lshrrev_b32 v12, 3, v60
    v_cos_f32 v7, v7
    v_lshlrev_b16 v13, 3, v60
    v_mad_i32_i24 v11, v14, s55, v96
    v_bitop3_b32 v12, v6, v13, v12 bitop3:0xca
    v_lshl_add_u32 v11, v11, 17, s40
    v_lshlrev_b16 v14, 8, v14
    v_lshrrev_b32 v13, 2, v60
    v_add_u32 v96, v12, v11
    v_bitop3_b32 v60, v5, v13, v14 bitop3:0xea
    ds_add_u32 v60, v2
    v_mul_hi_u32_u24 v14, 429497, v97
    v_lshrrev_b32 v12, 3, v61
    v_cos_f32 v8, v8
    v_lshlrev_b16 v13, 3, v61
    v_mad_i32_i24 v11, v14, s55, v97
    v_bitop3_b32 v12, v6, v13, v12 bitop3:0xca
    v_lshl_add_u32 v11, v11, 17, s40
    v_lshlrev_b16 v14, 8, v14
    v_lshrrev_b32 v13, 2, v61
    v_add_u32 v97, v12, v11
    v_bitop3_b32 v61, v5, v13, v14 bitop3:0xea
    ds_add_u32 v61, v2
    v_cvt_pk_bf16_f32 v66, v7, v8
    v_perm_b32 v12, v66, v66, s41
    v_bitop3_b32 v96, v4, v12, v96 bitop3:0xca
    v_perm_b32 v13, v66, v66, s42
    v_bitop3_b32 v97, v4, v13, v97 bitop3:0xca
    v_mul_hi_u32_u24 v14, 429497, v98
    v_lshrrev_b32 v12, 3, v62
    v_cos_f32 v9, v9
    v_lshlrev_b16 v13, 3, v62
    v_mad_i32_i24 v11, v14, s55, v98
    v_bitop3_b32 v12, v6, v13, v12 bitop3:0xca
    v_lshl_add_u32 v11, v11, 17, s40
    v_lshlrev_b16 v14, 8, v14
    v_lshrrev_b32 v13, 2, v62
    v_add_u32 v98, v12, v11
    v_bitop3_b32 v62, v5, v13, v14 bitop3:0xea
    ds_add_u32 v62, v2
    v_mul_hi_u32_u24 v14, 429497, v99
    v_lshrrev_b32 v12, 3, v63
    v_cos_f32 v10, v10
    v_lshlrev_b16 v13, 3, v63
    v_mad_i32_i24 v11, v14, s55, v99
    v_bitop3_b32 v12, v6, v13, v12 bitop3:0xca
    v_lshl_add_u32 v11, v11, 17, s40
    v_lshlrev_b16 v14, 8, v14
    v_lshrrev_b32 v13, 2, v63
    v_add_u32 v99, v12, v11
    v_bitop3_b32 v63, v5, v13, v14 bitop3:0xea
    ds_add_u32 v63, v2
    v_cvt_pk_bf16_f32 v67, v9, v10
    v_perm_b32 v12, v67, v67, s41
    v_bitop3_b32 v98, v4, v12, v98 bitop3:0xca
    v_perm_b32 v13, v67, v67, s42
    v_bitop3_b32 v99, v4, v13, v99 bitop3:0xca
L1_s7:
    v_lshrrev_b32 v8, 2, v0
    v_and_b32 v7, 0x3c00, v0
    v_bitop3_b32 v7, v5, v8, v7 bitop3:0xea
    s_waitcnt lgkmcnt(0)
    s_barrier
    ds_read2st64_b32 v[8:9], v7 offset0:0 offset1:1
    ds_read2st64_b32 v[10:11], v7 offset0:2 offset1:3
    s_add_u32 s47, s35, 0x7ed4000
    buffer_store_dwordx4 v[100:103], v0, s[20:23], s47 offen sc1
    s_waitcnt lgkmcnt(0)
    v_lshl_or_b32 v12, v9, 16, v8
    v_lshl_or_b32 v13, v11, 16, v10
    v_mov_b32 v14, v12
    v_mov_b32 v15, v13
    s_nop 0
    v_add_u32_dpp v14, v14, v14 row_shr:1 row_mask:0xf bank_mask:0xf bound_ctrl:1
    v_add_u32_dpp v15, v15, v15 row_shr:1 row_mask:0xf bank_mask:0xf bound_ctrl:1
    s_nop 0
    v_add_u32_dpp v14, v14, v14 row_shr:2 row_mask:0xf bank_mask:0xf bound_ctrl:1
    v_add_u32_dpp v15, v15, v15 row_shr:2 row_mask:0xf bank_mask:0xf bound_ctrl:1
    s_nop 0
    v_add_u32_dpp v14, v14, v14 row_shr:4 row_mask:0xf bank_mask:0xf bound_ctrl:1
    v_add_u32_dpp v15, v15, v15 row_shr:4 row_mask:0xf bank_mask:0xf bound_ctrl:1
    s_nop 0
    v_add_u32_dpp v14, v14, v14 row_shr:8 row_mask:0xf bank_mask:0xf bound_ctrl:1
    v_add_u32_dpp v15, v15, v15 row_shr:8 row_mask:0xf bank_mask:0xf bound_ctrl:1
    s_nop 0
    v_add_u32_dpp v14, v14, v14 row_bcast:15 row_mask:0xa bank_mask:0xf
    v_add_u32_dpp v15, v15, v15 row_bcast:15 row_mask:0xa bank_mask:0xf
    s_nop 0
    v_add_u32_dpp v14, v14, v14 row_bcast:31 row_mask:0xc bank_mask:0xf
    v_add_u32_dpp v15, v15, v15 row_bcast:31 row_mask:0xc bank_mask:0xf
    v_readlane_b32 s48, v14, 63
    v_readlane_b32 s49, v15, 63
    s_lshl_b32 s54, s32, 2
    v_mov_b32 v8, s54
    s_and_b32 s50, s48, 0xffff
    s_lshr_b32 s51, s48, 16
    s_and_b32 s52, s49, 0xffff
    s_lshr_b32 s53, s49, 16
    s_add_u32 s51, s51, s50
    s_add_u32 s52, s52, s51
    s_add_u32 s53, s53, s52
    v_mov_b32 v9, s53
    v_and_b32_dpp v3, v3, v3 quad_perm:[1,0,3,2] row_mask:0xf bank_mask:0xf
    s_mov_b64 exec, 1
    ds_write_b32 v8, v9 offset:16384
    ds_write_b32 v8, v3 offset:16448
    s_mov_b64 exec, -1
    v_and_b32 v8, 60, v7
    s_waitcnt lgkmcnt(0)
    s_barrier
    ds_read_b32 v9, v8 offset:16384
    ds_read_b32 v10, v8 offset:16448
    s_waitcnt lgkmcnt(0)
    v_readlane_b32 s56, v10, 15
    s_xor_b32 s56, s56, 0x80
    v_add_u32_dpp v9, v9, v9 row_shr:1 row_mask:0xf bank_mask:0xf bound_ctrl:1
    s_nop 1
    v_add_u32_dpp v9, v9, v9 row_shr:2 row_mask:0xf bank_mask:0xf bound_ctrl:1
    s_nop 1
    v_add_u32_dpp v9, v9, v9 row_shr:4 row_mask:0xf bank_mask:0xf bound_ctrl:1
    s_nop 1
    v_add_u32_dpp v9, v9, v9 row_shr:8 row_mask:0xf bank_mask:0xf bound_ctrl:1
    s_nop 0
    v_readlane_b32 s54, v9, s32
    s_sub_u32 s54, s54, s53
    s_add_u32 s50, s50, s54
    s_add_u32 s51, s51, s54
    s_add_u32 s52, s52, s54
    s_pack_ll_b32_b16 s48, s54, s50
    s_pack_ll_b32_b16 s49, s51, s52
    v_add_u32 v14, s48, v14
    v_add_u32 v15, s49, v15
    v_sub_u32 v12, v14, v12
    v_sub_u32 v13, v15, v13
    v_and_b32 v8, 0xffff, v12
    v_lshrrev_b32 v9, 16, v12
    v_and_b32 v10, 0xffff, v13
    v_lshrrev_b32 v11, 16, v13
    ds_write2st64_b32 v7, v8, v9 offset0:0 offset1:1
    ds_write2st64_b32 v7, v10, v11 offset0:2 offset1:3
    v_and_b32 v8, 0x3f0, v0
    v_lshl_add_u32 v8, v8, 1, s36
    ds_write_b64 v8, v[12:13] offset:20480
    s_bitset0_b64 exec, 63
    s_not_b64 exec, exec
    ds_write_b64 v8, v[14:15] offset:20512
    s_mov_b64 exec, -1
    s_waitcnt lgkmcnt(0)
    s_barrier
    s_setprio 3
    ds_add_rtn_u32 v120, v120, v2
    ds_add_rtn_u32 v121, v121, v2
    ds_add_rtn_u32 v122, v122, v2
    ds_add_rtn_u32 v123, v123, v2
    ds_read_b128 v[12:15], v0 offset:20480
    v_cmp_gt_u32 vcc, 8448, v0
    ds_add_rtn_u32 v124, v124, v2
    ds_add_rtn_u32 v125, v125, v2
    ds_add_rtn_u32 v126, v126, v2
    ds_add_rtn_u32 v127, v127, v2
    s_setprio 2
    ds_add_rtn_u32 v24, v24, v2
    ds_add_rtn_u32 v25, v25, v2
    ds_add_rtn_u32 v26, v26, v2
    ds_add_rtn_u32 v27, v27, v2
    s_waitcnt lgkmcnt(8)
    s_cbranch_vccz L1_p8
    s_add_u32 s44, s35, 0xa900000
    s_mov_b64 exec, vcc
    buffer_store_dwordx4 v[12:15], v0, s[24:27], s44 offen sc1
    s_mov_b64 exec, -1
L1_p8:
    s_add_u32 s45, s35, 0x7ed8000
    buffer_store_dwordx4 v[88:91], v0, s[20:23], s45 offen sc1
    ds_add_rtn_u32 v52, v52, v2
    ds_add_rtn_u32 v53, v53, v2
    ds_add_rtn_u32 v54, v54, v2
    ds_add_rtn_u32 v55, v55, v2
    s_load_dwordx2 s[28:29], s[0:1], 0
    s_load_dwordx2 s[50:51], s[0:1], 40
    s_load_dwordx2 s[52:53], s[0:1], 24
    s_setprio 1
    ds_add_rtn_u32 v68, v68, v2
    ds_add_rtn_u32 v69, v69, v2
    ds_add_rtn_u32 v70, v70, v2
    ds_add_rtn_u32 v71, v71, v2
    s_add_u32 s80, s30, 0xd340000
    s_addc_u32 s81, s31, 0
    s_mov_b32 s82, 0xa000
    s_mov_b32 s83, 0x20000
    s_min_u32 s3, s84, 127
    s_mul_i32 s3, s3, 40960
    s_add_u32 s80, s80, s3
    s_addc_u32 s81, s81, 0
    s_cmp_ge_u32 s84, 128
    s_cselect_b32 s82, 0, s82
    s_waitcnt vmcnt(2)
    v_add_u32 v9, 0, v0
    buffer_store_dwordx4 v[112:115], v9, s[80:83], 0 offen sc1
    v_add_u32 v9, 16384, v0
    buffer_store_dwordx4 v[104:107], v9, s[80:83], 0 offen sc1
    v_add_u32 v9, 32768, v0
    buffer_store_dwordx4 v[28:31], v9, s[80:83], 0 offen sc1
    s_cmp_le_u32 s43, 5
    s_cbranch_scc1 L1_s9
    ds_add_rtn_u32 v76, v76, v2
    ds_add_rtn_u32 v77, v77, v2
    ds_add_rtn_u32 v78, v78, v2
    ds_add_rtn_u32 v79, v79, v2
L1_s9:
    s_setprio 0
    s_cmp_le_u32 s43, 6
    s_cbranch_scc1 L1_s10
    ds_add_rtn_u32 v56, v56, v2
    ds_add_rtn_u32 v57, v57, v2
    ds_add_rtn_u32 v58, v58, v2
    ds_add_rtn_u32 v59, v59, v2
L1_s10:
    s_cmp_le_u32 s43, 7
    s_cbranch_scc1 L1_s11
    ds_add_rtn_u32 v60, v60, v2
    ds_add_rtn_u32 v61, v61, v2
    ds_add_rtn_u32 v62, v62, v2
    ds_add_rtn_u32 v63, v63, v2
L1_s11:
    s_waitcnt lgkmcnt(0)
    s_barrier
    s_load_dwordx4 s[96:99], s[50:51], 0
    s_mov_b64 s[4:5], s[52:53]
    s_bfe_u32 s33, s2, 0x20001
    s_and_b32 s34, s2, 1
    s_lshl_b32 s34, s34, 5
    s_lshr_b32 s3, s2, 3
    s_add_u32 s34, s34, s3
    s_mul_i32 s39, s33, 2080
    s_lshl_b32 s3, s34, 5
    s_add_u32 s39, s39, s3
    s_mul_i32 s40, s33, 1310720
    s_add_u32 s40, s40, 0x50000
    s_lshl_b32 s38, s32, 11
    s_mul_i32 s100, s32, 3072
    s_mov_b32 s8, s30
    s_mov_b32 s9, s31
    s_mov_b32 s10, 0xd340000
    s_mov_b32 s11, 0x20000
    s_add_u32 s12, s30, 0x28000
    s_addc_u32 s13, s31, 0
    s_mov_b32 s14, 0xd318000
    s_mov_b32 s15, 0x20000
    s_mov_b32 s16, s64
    s_mov_b32 s17, s65
    s_mov_b32 s18, 0x20
    s_mov_b32 s19, 0x20000
    s_mov_b32 s24, s28
    s_mov_b32 s25, s29
    s_mov_b32 s26, 0x4e2000
    s_mov_b32 s27, 0x20000
    s_setprio 3
    v_and_b32 v7, -4, v120
    v_lshl_add_u32 v8, v120, 2, v7
    ds_write_b32 v8, v16
    v_lshl_add_u32 v7, v7, 2, v120
    ds_write_b8 v7, v44 offset:16
    v_and_b32 v9, -4, v121
    v_lshl_add_u32 v10, v121, 2, v9
    ds_write_b32 v10, v17
    v_lshl_add_u32 v9, v9, 2, v121
    ds_write_b8_d16_hi v9, v44 offset:16
    v_and_b32 v7, -4, v122
    v_lshl_add_u32 v8, v122, 2, v7
    ds_write_b32 v8, v18
    v_lshl_add_u32 v7, v7, 2, v122
    ds_write_b8 v7, v45 offset:16
    v_and_b32 v9, -4, v123
    v_lshl_add_u32 v10, v123, 2, v9
    ds_write_b32 v10, v19
    v_lshl_add_u32 v9, v9, 2, v123
    ds_write_b8_d16_hi v9, v45 offset:16
    s_add_u32 s46, s35, 0x7edc000
    buffer_store_dwordx4 v[116:119], v0, s[20:23], s46 offen sc1
    v_and_b32 v13, 0x3f0, v0
    v_and_b32 v14, 0x300, v13
    v_bfe_u32 v15, v13, 4, 4
    s_lshl_b32 s3, s32, 4
    v_add3_u32 v14, v14, v15, s3
    v_mul_u32_u24 v2, 173056, v14
    v_lshrrev_b32 v14, 6, v13
    s_add_u32 s3, s3, 0x400
    v_add_u32 v14, s3, v14
    v_mul_u32_u24 v4, 173056, v14
    v_and_b32 v14, 3, v14
    v_and_b32 v15, 0x30, v13
    v_lshl_add_u32 v14, v14, 5, v15
    v_add_u32 v6, v14, v4
    v_lshl_add_u32 v5, v15, 1, v2
    v_lshrrev_b32 v14, 3, v15
    buffer_load_ushort v100, v14, s[16:19], 0 offen offset:0
    buffer_load_ushort v101, v14, s[16:19], 0 offen offset:8
    buffer_load_ushort v102, v14, s[16:19], 0 offen offset:16
    buffer_load_ushort v103, v14, s[16:19], 0 offen offset:24
    s_mul_i32 s3, s32, 5120
    v_add_u32 v3, s3, v13
    v_lshrrev_b32 v14, 2, v13
    v_add_u32 v14, s38, v14
    v_and_b32 v7, -4, v124
    v_lshl_add_u32 v8, v124, 2, v7
    ds_write_b32 v8, v20
    v_lshl_add_u32 v7, v7, 2, v124
    ds_write_b8 v7, v46 offset:16
    v_and_b32 v9, -4, v125
    v_lshl_add_u32 v10, v125, 2, v9
    ds_write_b32 v10, v21
    v_lshl_add_u32 v9, v9, 2, v125
    ds_write_b8_d16_hi v9, v46 offset:16
    v_and_b32 v7, -4, v126
    v_lshl_add_u32 v8, v126, 2, v7
    ds_write_b32 v8, v22
    v_lshl_add_u32 v7, v7, 2, v126
    ds_write_b8 v7, v47 offset:16
    v_and_b32 v9, -4, v127
    v_lshl_add_u32 v10, v127, 2, v9
    ds_write_b32 v10, v23
    v_lshl_add_u32 v9, v9, 2, v127
    ds_write_b8_d16_hi v9, v47 offset:16
    s_setprio 2
    v_and_b32 v7, -4, v24
    v_lshl_add_u32 v8, v24, 2, v7
    ds_write_b32 v8, v40
    v_lshl_add_u32 v7, v7, 2, v24
    ds_write_b8 v7, v32 offset:16
    v_and_b32 v9, -4, v25
    v_lshl_add_u32 v10, v25, 2, v9
    ds_write_b32 v10, v41
    v_lshl_add_u32 v9, v9, 2, v25
    ds_write_b8_d16_hi v9, v32 offset:16
    v_and_b32 v7, -4, v26
    v_lshl_add_u32 v8, v26, 2, v7
    ds_write_b32 v8, v42
    v_lshl_add_u32 v7, v7, 2, v26
    ds_write_b8 v7, v33 offset:16
    v_and_b32 v9, -4, v27
    v_lshl_add_u32 v10, v27, 2, v9
    ds_write_b32 v10, v43
    v_lshl_add_u32 v9, v9, 2, v27
    ds_write_b8_d16_hi v9, v33 offset:16
    s_add_u32 s47, s35, 0x7ee0000
    buffer_store_dwordx4 v[92:95], v0, s[20:23], s47 offen sc1
    v_and_b32 v7, -4, v52
    v_lshl_add_u32 v8, v52, 2, v7
    ds_write_b32 v8, v48
    v_lshl_add_u32 v7, v7, 2, v52
    ds_write_b8 v7, v34 offset:16
    v_and_b32 v9, -4, v53
    v_lshl_add_u32 v10, v53, 2, v9
    ds_write_b32 v10, v49
    v_lshl_add_u32 v9, v9, 2, v53
    ds_write_b8_d16_hi v9, v34 offset:16
    v_and_b32 v7, -4, v54
    v_lshl_add_u32 v8, v54, 2, v7
    ds_write_b32 v8, v50
    v_lshl_add_u32 v7, v7, 2, v54
    ds_write_b8 v7, v35 offset:16
    v_and_b32 v9, -4, v55
    v_lshl_add_u32 v10, v55, 2, v9
    ds_write_b32 v10, v51
    v_lshl_add_u32 v9, v9, 2, v55
    ds_write_b8_d16_hi v9, v35 offset:16
    s_setprio 1
    v_and_b32 v7, -4, v68
    v_lshl_add_u32 v8, v68, 2, v7
    ds_write_b32 v8, v84
    v_lshl_add_u32 v7, v7, 2, v68
    ds_write_b8 v7, v72 offset:16
    v_and_b32 v9, -4, v69
    v_lshl_add_u32 v10, v69, 2, v9
    ds_write_b32 v10, v85
    v_lshl_add_u32 v9, v9, 2, v69
    ds_write_b8_d16_hi v9, v72 offset:16
    v_and_b32 v7, -4, v70
    v_lshl_add_u32 v8, v70, 2, v7
    ds_write_b32 v8, v86
    v_lshl_add_u32 v7, v7, 2, v70
    ds_write_b8 v7, v73 offset:16
    v_and_b32 v9, -4, v71
    v_lshl_add_u32 v10, v71, 2, v9
    ds_write_b32 v10, v87
    v_lshl_add_u32 v9, v9, 2, v71
    ds_write_b8_d16_hi v9, v73 offset:16
    s_cmp_le_u32 s43, 5
    s_cbranch_scc1 L1_s12
    v_and_b32 v7, -4, v76
    v_lshl_add_u32 v8, v76, 2, v7
    ds_write_b32 v8, v36
    v_lshl_add_u32 v7, v7, 2, v76
    ds_write_b8 v7, v74 offset:16
    v_and_b32 v9, -4, v77
    v_lshl_add_u32 v10, v77, 2, v9
    ds_write_b32 v10, v37
    v_lshl_add_u32 v9, v9, 2, v77
    ds_write_b8_d16_hi v9, v74 offset:16
    v_and_b32 v7, -4, v78
    v_lshl_add_u32 v8, v78, 2, v7
    ds_write_b32 v8, v38
    v_lshl_add_u32 v7, v7, 2, v78
    ds_write_b8 v7, v75 offset:16
    v_and_b32 v9, -4, v79
    v_lshl_add_u32 v10, v79, 2, v9
    ds_write_b32 v10, v39
    v_lshl_add_u32 v9, v9, 2, v79
    ds_write_b8_d16_hi v9, v75 offset:16
L1_s12:
    s_add_u32 s44, s35, 0x7ee4000
    buffer_store_dwordx4 v[108:111], v0, s[20:23], s44 offen sc1
    s_setprio 0
    s_cmp_le_u32 s43, 6
    s_cbranch_scc1 L1_s13
    v_and_b32 v7, -4, v56
    v_lshl_add_u32 v8, v56, 2, v7
    ds_write_b32 v8, v80
    v_lshl_add_u32 v7, v7, 2, v56
    ds_write_b8 v7, v64 offset:16
    v_and_b32 v9, -4, v57
    v_lshl_add_u32 v10, v57, 2, v9
    ds_write_b32 v10, v81
    v_lshl_add_u32 v9, v9, 2, v57
    ds_write_b8_d16_hi v9, v64 offset:16
    v_and_b32 v7, -4, v58
    v_lshl_add_u32 v8, v58, 2, v7
    ds_write_b32 v8, v82
    v_lshl_add_u32 v7, v7, 2, v58
    ds_write_b8 v7, v65 offset:16
    v_and_b32 v9, -4, v59
    v_lshl_add_u32 v10, v59, 2, v9
    ds_write_b32 v10, v83
    v_lshl_add_u32 v9, v9, 2, v59
    ds_write_b8_d16_hi v9, v65 offset:16
L1_s13:
    s_cmp_le_u32 s43, 7
    s_cbranch_scc1 L1_s14
    v_and_b32 v7, -4, v60
    v_lshl_add_u32 v8, v60, 2, v7
    ds_write_b32 v8, v96
    v_lshl_add_u32 v7, v7, 2, v60
    ds_write_b8 v7, v66 offset:16
    v_and_b32 v9, -4, v61
    v_lshl_add_u32 v10, v61, 2, v9
    ds_write_b32 v10, v97
    v_lshl_add_u32 v9, v9, 2, v61
    ds_write_b8_d16_hi v9, v66 offset:16
    v_and_b32 v7, -4, v62
    v_lshl_add_u32 v8, v62, 2, v7
    ds_write_b32 v8, v98
    v_lshl_add_u32 v7, v7, 2, v62
    ds_write_b8 v7, v67 offset:16
    v_and_b32 v9, -4, v63
    v_lshl_add_u32 v10, v63, 2, v9
    ds_write_b32 v10, v99
    v_lshl_add_u32 v9, v9, 2, v63
    ds_write_b8_d16_hi v9, v67 offset:16
L1_s14:
    s_waitcnt vmcnt(3)
    v_add_u32 v7, 0x10000, v0
    v_add_u32 v12, 0x20000, v0
    s_waitcnt lgkmcnt(0)
    s_barrier
    ds_read_b128 v[24:27], v0 offset:0
    ds_read_b128 v[28:31], v0 offset:16384
    ds_read_b128 v[32:35], v0 offset:32768
    ds_read_b128 v[36:39], v0 offset:49152
    ds_read_b128 v[76:79], v7 offset:0
    ds_read_b128 v[80:83], v7 offset:16384
    ds_read_b128 v[84:87], v7 offset:32768
    ds_read_b128 v[104:107], v7 offset:49152
    ds_read_b128 v[68:71], v12 offset:0
    ds_read_b128 v[72:75], v12 offset:16384
    s_cmp_lg_u32 s32, 0
    s_cbranch_scc1 L2_sg1
    s_mov_b32 exec_hi, 0
    v_mov_b32 v11, 1
    buffer_store_dword v11, v14, s[60:63], s57 offen sc1
    s_mov_b64 exec, -1
L2_sg1:
    s_waitcnt lgkmcnt(9)
    s_add_u32 s45, s35, 0xa900000
    buffer_store_dwordx4 v[24:27], v0, s[20:23], s45 offen sc1
    s_waitcnt lgkmcnt(8)
    s_add_u32 s46, s35, 0xa904000
    buffer_store_dwordx4 v[28:31], v0, s[20:23], s46 offen sc1
    s_waitcnt lgkmcnt(7)
    s_add_u32 s47, s35, 0xa908000
    buffer_store_dwordx4 v[32:35], v0, s[20:23], s47 offen sc1
    s_waitcnt lgkmcnt(6)
    s_add_u32 s44, s35, 0xa90c000
    buffer_store_dwordx4 v[36:39], v0, s[20:23], s44 offen sc1
    s_waitcnt lgkmcnt(5)
    s_add_u32 s45, s35, 0xa910000
    buffer_store_dwordx4 v[76:79], v0, s[20:23], s45 offen sc1
    s_waitcnt lgkmcnt(4)
    s_add_u32 s46, s35, 0xa914000
    buffer_store_dwordx4 v[80:83], v0, s[20:23], s46 offen sc1
    s_waitcnt lgkmcnt(3)
    s_add_u32 s47, s35, 0xa918000
    buffer_store_dwordx4 v[84:87], v0, s[20:23], s47 offen sc1
    s_waitcnt lgkmcnt(2)
    s_cmp_le_u32 s43, 5
    s_cbranch_scc1 L1_q15
    s_add_u32 s44, s35, 0xa91c000
    buffer_store_dwordx4 v[104:107], v0, s[20:23], s44 offen sc1
L1_q15:
    s_waitcnt lgkmcnt(1)
    s_cmp_le_u32 s43, 6
    s_cbranch_scc1 L1_q16
    s_add_u32 s45, s35, 0xa920000
    buffer_store_dwordx4 v[68:71], v0, s[20:23], s45 offen sc1
L1_q16:
    s_waitcnt lgkmcnt(0)
    s_cmp_le_u32 s43, 7
    s_cbranch_scc1 L1_q17
    s_add_u32 s46, s35, 0xa924000
    buffer_store_dwordx4 v[72:75], v0, s[20:23], s46 offen sc1
L1_q17:
    s_waitcnt lgkmcnt(0)
    s_barrier
    s_setprio 3
    v_mov_b32 v92, v0
    v_mov_b32 v93, v6
    v_mov_b32 v94, v13
    v_mov_b32 v95, v5
    v_mov_b32 v0, v14
    v_lshl_add_u32 v7, v13, 3, s38
    v_lshrrev_b32 v16, 2, v15
    v_mad_u32_u24 v4, v16, 5, v4
    v_or_b32 v4, 0xf0000000, v4
    v_or_b32 v2, 0xf0000000, v2
    v_sub_u32 v1, 28, v16
    v_lshrrev_b32 v17, 2, v16
    v_and_b32 v18, 3, v17
    v_lshlrev_b32 v18, 4, v18
    v_mov_b32 v10, 0x3f80
    v_mov_b32 v11, 0
    v_lshlrev_b64 v[10:11], v18, v[10:11]
    v_and_b32 v18, 3, v17
    v_lshlrev_b32 v18, 4, v18
    v_mov_b32 v12, 0xbf80
    v_mov_b32 v13, 0
    v_lshlrev_b64 v[12:13], v18, v[12:13]
    v_mov_b32 v45, 0xf0000000
    v_mov_b32 v5, 0x1fff8
    v_mov_b32 v6, 0x07ff0000
    v_mov_b32 v16, 0
    v_mov_b32 v17, 0
    v_mov_b32 v18, 0
    v_mov_b32 v19, 0
    v_add_u32 v20, 81920, v92
    v_add_u32 v21, 0x10000, v20
    ds_write_b128 v20, v[16:19] offset:0
    ds_write_b128 v20, v[16:19] offset:16384
    s_setprio 2
    ds_write_b128 v20, v[16:19] offset:32768
    ds_write_b128 v20, v[16:19] offset:49152
    ds_write_b128 v21, v[16:19]
    s_setprio 1
    s_setprio 0
    s_mov_b32 s44, 0x4000c0c
    s_mov_b32 s45, 0x4010c0c
    s_mov_b32 s46, 0x4020c0c
    s_mov_b32 s47, 0x4030c0c
    s_mov_b32 s36, 0
    s_mov_b32 s43, 0
    s_mov_b32 s42, 0
    s_mov_b64 s[80:81], 0
    s_mov_b64 s[84:85], 0
    s_mov_b64 s[48:49], 0
    s_add_u32 s16, s30, 0xd340000
    s_addc_u32 s17, s31, 0
    s_mov_b32 s18, 0x500000
    s_mov_b32 s19, 0x20000
    s_add_u32 s20, s30, 0xd841000
    s_addc_u32 s21, s31, 0
    s_mov_b32 s22, 0x13880
    s_mov_b32 s23, 0x20000
    s_lshl_b32 s3, s33, 6
    s_add_u32 s3, s3, s34
    s_mul_i32 s3, s3, 80000
    s_add_u32 s20, s20, s3
    s_addc_u32 s21, s21, 0
    v_mov_b32 v68, 0
    v_mov_b32 v69, 0
    v_mov_b32 v70, 0
    v_mov_b32 v71, 0
    v_mov_b32 v72, 0
    v_mov_b32 v73, 0
    v_mov_b32 v74, 0
    v_mov_b32 v75, 0
    s_waitcnt vmcnt(0)
    v_lshl_or_b32 v8, v101, 16, v100
    v_lshl_or_b32 v9, v103, 16, v102
    s_barrier
    s_cmp_lg_u32 s32, 0
    s_cbranch_scc1 L2_sg2
    s_mov_b32 exec_hi, 0
    v_mov_b32 v88, 2
    buffer_store_dword v88, v0, s[60:63], s57 offen sc1
    s_mov_b64 exec, -1
L2_sg2:
    s_mul_i32 s3, s33, 1280000
    s_add_u32 s3, s3, s100
    s_add_u32 s3, s3, 32768
    buffer_load_dwordx4 v[124:127], v94, s[24:27], s3 offen offset:2048
    s_mul_i32 s3, s33, 1280000
    s_add_u32 s3, s3, s100
    s_add_u32 s3, s3, 32768
    buffer_load_dwordx4 v[116:119], v94, s[24:27], s3 offen offset:0
    s_mul_i32 s3, s33, 1280000
    s_add_u32 s3, s3, s100
    s_add_u32 s3, s3, 32768
    buffer_load_dwordx4 v[120:123], v94, s[24:27], s3 offen offset:1024
    s_mul_i32 s3, s33, 1280000
    s_add_u32 s3, s3, s38
    s_add_u32 s3, s3, 0
    buffer_load_dwordx4 v[108:111], v94, s[24:27], s3 offen offset:0
    s_mul_i32 s3, s33, 1280000
    s_add_u32 s3, s3, s38
    s_add_u32 s3, s3, 0
    buffer_load_dwordx4 v[112:115], v94, s[24:27], s3 offen offset:1024
    s_cmp_eq_u32 s56, 0
    s_cbranch_scc1 L2_e3
    v_lshlrev_b32 v16, 3, v94
    v_and_b32 v16, 0x80, v16
L2_e4:
    buffer_load_dword v88, v16, s[68:71], 0 offen sc1
    s_waitcnt vmcnt(0)
    v_cmp_gt_u32 vcc, 0x80, v88
    s_cbranch_vccnz L2_e4
L2_e3:
    s_mov_b64 exec, 0xffff
L2_p1:
    buffer_load_dword v88, v7, s[60:63], 0 offen sc1
    s_waitcnt vmcnt(0)
    v_cmp_gt_u32 vcc, 1, v88
    s_cbranch_vccnz L2_p1s
    s_mov_b64 exec, -1
    v_cmp_gt_u32 vcc, 2, v88
    s_and_b32 s56, vcc_lo, 0xffff
    buffer_load_dwordx4 v[48:51], v95, s[12:15], s39 offen offset:0
    buffer_load_dwordx4 v[56:59], v95, s[12:15], s39 offen offset:32
    buffer_load_dwordx4 v[52:55], v95, s[12:15], s39 offen offset:16
    buffer_load_dwordx4 v[60:63], v95, s[12:15], s39 offen offset:48
    buffer_load_dwordx4 v[64:67], v93, s[12:15], s39 offen
    s_waitcnt vmcnt(0)
    v_sub_u16 v88, v56, v48
    v_and_b32 v89, 3, v48
    v_add3_u32 v99, v88, v89, 3
    v_and_b32 v99, -4, v99
    v_max_u32 v99, 4, v99
    v_and_b32 v97, 0xfffc, v48
    v_bfm_b32 v96, v88, v89
    v_add_u32_dpp v91, v99, v99 row_shr:1 row_mask:0xf bank_mask:0xf bound_ctrl:1
    v_mad_u32_u24 v97, v97, 5, v2
    v_cmp_lt_u32 vcc, 16, v99
    v_add_u32_dpp v91, v91, v91 row_shr:2 row_mask:0xf bank_mask:0xf bound_ctrl:1
    v_sub_u32 v98, s38, v99
    v_lshrrev_b64 v[48:49], 16, v[48:49]
    v_add_u32_dpp v91, v91, v91 row_shr:4 row_mask:0xf bank_mask:0xf bound_ctrl:1
    v_lshrrev_b64 v[56:57], 16, v[56:57]
    s_mov_b32 s101, 0
    v_add_u32_dpp v91, v91, v91 row_shr:8 row_mask:0xf bank_mask:0xf bound_ctrl:1
    s_nop 1
    v_add_u32_dpp v91, v91, v91 row_bcast:15 row_mask:0xa bank_mask:0xf
    s_nop 1
    v_add_u32_dpp v91, v91, v91 row_bcast:31 row_mask:0xc bank_mask:0xf
    v_add_u32 v98, v98, v91
    v_readlane_b32 s37, v91, 63
    s_cbranch_vccnz L2_xo3
L2_xp3:
    v_mov_b32 v44, v43
    s_cmp_gt_u32 s37, 1024
    s_cbranch_scc1 L2_xs4
    s_cmp_lg_u32 s101, 0
    s_cbranch_scc1 L2_xa4
L2_xb4:
    v_lshlrev_b32 v89, 16, v96
    v_add_u32 v90, 60, v97
    v_bitop3_b32 v90, v89, v45, v90 bitop3:0x6a
    ds_write_b32 v98, v90 offset:12
    v_lshlrev_b32 v89, 20, v96
    v_add_u32 v90, 40, v97
    v_bitop3_b32 v90, v89, v45, v90 bitop3:0x6a
    ds_write_b32 v98, v90 offset:8
    v_lshlrev_b32 v89, 24, v96
    v_add_u32 v90, 20, v97
    v_bitop3_b32 v90, v89, v45, v90 bitop3:0x6a
    ds_write_b32 v98, v90 offset:4
    v_lshlrev_b32 v89, 28, v96
    v_bitop3_b32 v90, v89, v45, v97 bitop3:0x6a
    ds_write_b32 v98, v90 offset:0
    v_mov_b32_dpp v91, v64 quad_perm:[0,0,0,0] row_mask:0xf bank_mask:0xf
    v_and_b32 v89, 3, v91
    v_and_b32 v97, 0xfffc, v91
    v_sub_u16_dpp v88, v64, v91 quad_perm:[2,2,2,2] row_mask:0xf bank_mask:0xf
    v_mad_u32_u24 v97, v97, 5, v4
    v_add_u32 v99, v88, v89
    v_bfm_b32 v96, v88, v89
    v_cmp_lt_u32 s[58:59], 16, v99
    v_lshlrev_b32 v89, v1, v96
    v_and_b32 v89, v45, v89
    v_cmp_ne_u32 vcc, 0, v89
    v_xor_b32 v90, v97, v89
    s_add_u32 s3, s37, s38
    v_mbcnt_lo_u32_b32 v98, vcc_lo, 0
    v_mbcnt_hi_u32_b32 v98, vcc_hi, v98
    s_bcnt1_i32_b64 s41, vcc
    v_lshl_add_u32 v98, v98, 2, s3
    s_mov_b64 exec, vcc
    ds_write_b32 v98, v90
    s_mov_b64 exec, -1
    s_lshl2_add_u32 s37, s41, s37
    s_cmp_lg_u64 s[58:59], 0
    s_cbranch_scc1 L2_xe4
L2_xr4:
    v_add_u32 v98, s37, v0
    v_mov_b32 v90, -1
    ds_write_b32 v98, v90
    ds_read2st64_b32 v[40:41], v0 offset0:0 offset1:1
    ds_read2st64_b32 v[42:43], v0 offset0:2 offset1:3
    s_sub_u32 s3, s37, 768
    s_cmp_gt_u32 s3, 256
    s_cbranch_scc1 L2_xf4
L2_xg4:
    v_sub_u16 v88, v58, v50
    v_and_b32 v89, 3, v50
    v_add3_u32 v99, v88, v89, 3
    v_and_b32 v99, -4, v99
    v_max_u32 v99, 4, v99
    v_and_b32 v97, 0xfffc, v50
    v_bfm_b32 v96, v88, v89
    v_add_u32_dpp v91, v99, v99 row_shr:1 row_mask:0xf bank_mask:0xf bound_ctrl:1
    v_mad_u32_u24 v97, v97, 5, v2
    v_cmp_lt_u32 vcc, 16, v99
    v_add_u32_dpp v91, v91, v91 row_shr:2 row_mask:0xf bank_mask:0xf bound_ctrl:1
    v_sub_u32 v98, s38, v99
    v_lshrrev_b64 v[50:51], 16, v[50:51]
    v_add_u32_dpp v91, v91, v91 row_shr:4 row_mask:0xf bank_mask:0xf bound_ctrl:1
    v_lshrrev_b64 v[58:59], 16, v[58:59]
    s_mov_b32 s101, 0
    v_add_u32_dpp v91, v91, v91 row_shr:8 row_mask:0xf bank_mask:0xf bound_ctrl:1
    s_nop 1
    v_add_u32_dpp v91, v91, v91 row_bcast:15 row_mask:0xa bank_mask:0xf
    s_nop 1
    v_add_u32_dpp v91, v91, v91 row_bcast:31 row_mask:0xc bank_mask:0xf
    v_add_u32 v98, v98, v91
    v_readlane_b32 s37, v91, 63
    s_cbranch_vccnz L2_xo5
L2_xp5:
    s_waitcnt lgkmcnt(0)
    v_mov_b32 v21, v40
    v_mov_b32 v27, v41
    v_mov_b32 v33, v42
    v_mov_b32 v39, v43
    v_mov_b32 v44, v43
    s_cmp_gt_u32 s37, 1024
    s_cbranch_scc1 L2_xs6
    s_cmp_lg_u32 s101, 0
    s_cbranch_scc1 L2_xa6
L2_xb6:
    v_lshlrev_b32 v89, 16, v96
    v_add_u32 v90, 60, v97
    v_bitop3_b32 v90, v89, v45, v90 bitop3:0x6a
    ds_write_b32 v98, v90 offset:12
    v_lshlrev_b32 v89, 20, v96
    v_add_u32 v90, 40, v97
    v_bitop3_b32 v90, v89, v45, v90 bitop3:0x6a
    ds_write_b32 v98, v90 offset:8
    v_lshlrev_b32 v89, 24, v96
    v_add_u32 v90, 20, v97
    v_bitop3_b32 v90, v89, v45, v90 bitop3:0x6a
    ds_write_b32 v98, v90 offset:4
    v_lshlrev_b32 v89, 28, v96
    v_bitop3_b32 v90, v89, v45, v97 bitop3:0x6a
    ds_write_b32 v98, v90 offset:0
    v_mov_b32_dpp v91, v66 quad_perm:[0,0,0,0] row_mask:0xf bank_mask:0xf
    v_and_b32 v89, 3, v91
    v_and_b32 v97, 0xfffc, v91
    v_sub_u16_dpp v88, v66, v91 quad_perm:[2,2,2,2] row_mask:0xf bank_mask:0xf
    v_mad_u32_u24 v97, v97, 5, v4
    v_add_u32 v99, v88, v89
    v_bfm_b32 v96, v88, v89
    v_cmp_lt_u32 s[58:59], 16, v99
    v_lshlrev_b32 v89, v1, v96
    v_and_b32 v89, v45, v89
    v_cmp_ne_u32 vcc, 0, v89
    v_xor_b32 v90, v97, v89
    s_add_u32 s3, s37, s38
    v_mbcnt_lo_u32_b32 v98, vcc_lo, 0
    v_mbcnt_hi_u32_b32 v98, vcc_hi, v98
    s_bcnt1_i32_b64 s41, vcc
    v_lshl_add_u32 v98, v98, 2, s3
    s_mov_b64 exec, vcc
    ds_write_b32 v98, v90
    s_mov_b64 exec, -1
    s_lshl2_add_u32 s37, s41, s37
    s_cmp_lg_u64 s[58:59], 0
    s_cbranch_scc1 L2_xe6
L2_xr6:
    v_add_u32 v98, s37, v0
    v_mov_b32 v90, -1
    ds_write_b32 v98, v90
    ds_read2st64_b32 v[40:41], v0 offset0:0 offset1:1
    ds_read2st64_b32 v[42:43], v0 offset0:2 offset1:3
    s_sub_u32 s3, s37, 768
    s_cmp_gt_u32 s3, 256
    s_cbranch_scc1 L2_xf6
L2_xg6:
    v_subrev_u32 v88, s38, v3
    ds_write_b128 v88, v[124:127] offset:34816
    v_subrev_u32 v88, s38, v3
    ds_write_b128 v88, v[116:119] offset:32768
    v_subrev_u32 v88, s38, v3
    ds_write_b128 v88, v[120:123] offset:33792
    v_subrev_u32 v88, s100, v3
    ds_write_b128 v88, v[108:111] offset:0
    v_subrev_u32 v88, s100, v3
    ds_write_b128 v88, v[112:115] offset:1024
    s_cmp_eq_u32 s56, 0
    s_cbranch_scc1 L2_e2
    s_mov_b64 exec, 0xffff
    buffer_load_dword v88, v7, s[60:63], 0 offen sc1
    s_mov_b64 exec, -1
    s_waitcnt vmcnt(0)
    v_cmp_gt_u32 vcc, 2, v88
    s_and_b32 s56, vcc_lo, 0xffff
    s_cbranch_scc0 L2_e2
    s_mul_i32 s3, s33, 1280000
    s_add_u32 s3, s3, s100
    s_add_u32 s3, s3, 352768
    buffer_load_dwordx4 v[124:127], v94, s[24:27], s3 offen offset:2048
    s_mul_i32 s3, s33, 1280000
    s_add_u32 s3, s3, s100
    s_add_u32 s3, s3, 352768
    buffer_load_dwordx4 v[116:119], v94, s[24:27], s3 offen offset:0
    s_mul_i32 s3, s33, 1280000
    s_add_u32 s3, s3, s100
    s_add_u32 s3, s3, 352768
    buffer_load_dwordx4 v[120:123], v94, s[24:27], s3 offen offset:1024
    s_mul_i32 s3, s33, 1280000
    s_add_u32 s3, s3, s38
    s_add_u32 s3, s3, 320000
    buffer_load_dwordx4 v[108:111], v94, s[24:27], s3 offen offset:0
    s_mul_i32 s3, s33, 1280000
    s_add_u32 s3, s3, s38
    s_add_u32 s3, s3, 320000
    buffer_load_dwordx4 v[112:115], v94, s[24:27], s3 offen offset:1024
    s_mov_b64 exec, 0xffff
L2_p2:
    buffer_load_dword v88, v7, s[60:63], 0 offen sc1
    s_waitcnt vmcnt(0)
    v_cmp_gt_u32 vcc, 2, v88
    s_cbranch_vccnz L2_p2s
    s_mov_b64 exec, -1
L2_e2:
    s_mov_b32 s6, 0xaaaaaaaa
    s_mov_b32 s7, 0xaaaaaaaa
    v_and_b32 v47, 0x0fffffff, v21
    buffer_load_dwordx2 v[16:17], v47, s[8:11], 0 offen
    buffer_load_dwordx3 v[18:20], v47, s[8:11], 0 offen offset:8
    s_waitcnt lgkmcnt(0)
    s_barrier
    s_bitcmp1_b32 s36, s42
    s_cbranch_scc1 L2_slow
L2_ret0:
    s_setprio 3
    v_and_b32 v47, 0x0fffffff, v27
    buffer_load_dwordx2 v[22:23], v47, s[8:11], 0 offen
    buffer_load_dwordx3 v[24:26], v47, s[8:11], 0 offen offset:8
    s_waitcnt vmcnt(2)
    v_and_b32 v46, 0x20000000, v21
    v_lshrrev_b32 v47, 14, v17
    v_bitop3_b32 v47, v47, v5, v46 bitop3:0xea
    ds_read_b64 v[102:103], v47
    v_bitop3_b32 v93, v17, v5, v46 bitop3:0xea
    v_and_b32 v46, 0x10000000, v21
    v_lshrrev_b32 v47, 14, v16
    v_bitop3_b32 v47, v47, v5, v46 bitop3:0xea
    ds_read_b64 v[100:101], v47
    v_bitop3_b32 v92, v16, v5, v46 bitop3:0xea
    v_perm_b32 v15, v17, v20, s45
    v_bitop3_b32 v46, v17, 0.5, -0.5 bitop3:0xa8
    v_perm_b32 v14, v16, v20, s44
    v_bitop3_b32 v47, v16, 0.5, -0.5 bitop3:0xa8
    s_waitcnt lgkmcnt(0)
    v_mfma_f32_4x4x4_16b_bf16 v[80:83], v[8:9], v[102:103], 0
    v_mfma_f32_4x4x4_16b_bf16 v[76:79], v[8:9], v[100:101], 0
    v_bitop3_b32 v15, v6, v15, v46 bitop3:0xca
    v_bitop3_b32 v14, v6, v14, v47 bitop3:0xca
    v_cmp_lt_u32 s[84:85], v5, v92
    s_nop 0
    v_pk_mul_f32 v[80:81], v[80:81], v[14:15] op_sel:[0,1] op_sel_hi:[1,1]
    v_pk_mul_f32 v[82:83], v[82:83], v[14:15] op_sel:[0,1] op_sel_hi:[1,1]
    v_pk_mul_f32 v[76:77], v[76:77], v[14:15] op_sel:[0,0] op_sel_hi:[1,0]
    v_pk_mul_f32 v[78:79], v[78:79], v[14:15] op_sel:[0,0] op_sel_hi:[1,0]
    v_and_b32 v47, 0x0fffffff, v33
    buffer_load_dwordx2 v[28:29], v47, s[8:11], 0 offen
    buffer_load_dwordx3 v[30:32], v47, s[8:11], 0 offen offset:8
    v_cmp_ne_u64 s[50:51], v[72:73], v[68:69]
    v_cmpx_ne_u64 s[54:55], v[74:75], v[70:71]
    s_and_b64 s[82:83], s[54:55], s[80:81]
    s_cbranch_scc1 L2_c7
L2_d7:
    v_mov_b64 v[84:85], v[70:71]
    v_mov_b32 v7, v95
    v_mov_b64 v[86:87], v[74:75]
    s_or_b64 s[80:81], s[80:81], s[54:55]
    s_mov_b64 exec, s[50:51]
    s_and_b64 s[82:83], s[50:51], s[80:81]
    s_cbranch_scc1 L2_c8
L2_d8:
    v_mov_b64 v[84:85], v[68:69]
    v_mov_b32 v7, v94
    v_mov_b64 v[86:87], v[72:73]
    s_mov_b64 exec, -1
    s_or_b64 s[80:81], s[80:81], s[50:51]
    ds_read_b64 v[70:71], v93 offset:65408
    s_and_b64 exec, s[84:85], s[80:81]
    v_mfma_f32_4x4x4_16b_bf16 v[76:79], v[12:13], v[84:85], 0
    v_mov_b32 v92, v7
    s_andn2_b64 s[80:81], s[80:81], s[84:85]
    v_mfma_f32_4x4x4_16b_bf16 v[76:79], v[10:11], v[86:87], v[76:79]
    s_mov_b64 exec, -1
    ds_read_b64 v[68:69], v92 offset:65408
    v_and_b32 v46, 0x80000000, v21
    v_lshrrev_b32 v47, 14, v19
    v_bitop3_b32 v47, v47, v5, v46 bitop3:0xea
    ds_read_b64 v[106:107], v47
    v_bitop3_b32 v95, v19, v5, v46 bitop3:0xea
    v_and_b32 v46, 0x40000000, v21
    v_lshrrev_b32 v47, 14, v18
    v_bitop3_b32 v47, v47, v5, v46 bitop3:0xea
    ds_read_b64 v[104:105], v47
    v_bitop3_b32 v94, v18, v5, v46 bitop3:0xea
    s_waitcnt lgkmcnt(2)
    v_mfma_f32_4x4x4_16b_bf16 v[80:83], v[10:11], v[70:71], v[80:83]
    v_mfma_f32_4x4x4_16b_bf16 v[76:79], v[10:11], v[68:69], v[76:79]
    v_perm_b32 v15, v19, v20, s47
    v_bitop3_b32 v46, v19, 0.5, -0.5 bitop3:0xa8
    v_perm_b32 v14, v18, v20, s46
    v_bitop3_b32 v47, v18, 0.5, -0.5 bitop3:0xa8
    v_cvt_pk_bf16_f32 v80, v80, v81
    v_cvt_pk_bf16_f32 v81, v82, v83
    ds_wrxchg_rtn_b64 v[74:75], v93, v[80:81] offset:65408
    v_cvt_pk_bf16_f32 v76, v76, v77
    v_cvt_pk_bf16_f32 v77, v78, v79
    ds_wrxchg_rtn_b64 v[72:73], v92, v[76:77] offset:65408
    s_setprio 2
    s_waitcnt lgkmcnt(2)
    v_mfma_f32_4x4x4_16b_bf16 v[80:83], v[8:9], v[106:107], 0
    v_mfma_f32_4x4x4_16b_bf16 v[76:79], v[8:9], v[104:105], 0
    v_bitop3_b32 v15, v6, v15, v46 bitop3:0xca
    v_bitop3_b32 v14, v6, v14, v47 bitop3:0xca
    s_nop 1
    v_pk_mul_f32 v[80:81], v[80:81], v[14:15] op_sel:[0,1] op_sel_hi:[1,1]
    v_pk_mul_f32 v[82:83], v[82:83], v[14:15] op_sel:[0,1] op_sel_hi:[1,1]
    v_pk_mul_f32 v[76:77], v[76:77], v[14:15] op_sel:[0,0] op_sel_hi:[1,0]
    v_pk_mul_f32 v[78:79], v[78:79], v[14:15] op_sel:[0,0] op_sel_hi:[1,0]
    v_sub_u16 v88, v60, v52
    v_and_b32 v89, 3, v52
    v_add3_u32 v99, v88, v89, 3
    v_and_b32 v99, -4, v99
    v_max_u32 v99, 4, v99
    v_and_b32 v97, 0xfffc, v52
    v_bfm_b32 v96, v88, v89
    v_add_u32_dpp v91, v99, v99 row_shr:1 row_mask:0xf bank_mask:0xf bound_ctrl:1
    v_mad_u32_u24 v97, v97, 5, v2
    v_cmp_lt_u32 vcc, 16, v99
    v_add_u32_dpp v91, v91, v91 row_shr:2 row_mask:0xf bank_mask:0xf bound_ctrl:1
    v_sub_u32 v98, s38, v99
    v_lshrrev_b64 v[52:53], 16, v[52:53]
    v_add_u32_dpp v91, v91, v91 row_shr:4 row_mask:0xf bank_mask:0xf bound_ctrl:1
    v_lshrrev_b64 v[60:61], 16, v[60:61]
    s_mov_b32 s101, 0
    v_add_u32_dpp v91, v91, v91 row_shr:8 row_mask:0xf bank_mask:0xf bound_ctrl:1
    s_nop 1
    v_add_u32_dpp v91, v91, v91 row_bcast:15 row_mask:0xa bank_mask:0xf
    s_nop 1
    v_add_u32_dpp v91, v91, v91 row_bcast:31 row_mask:0xc bank_mask:0xf
    v_add_u32 v98, v98, v91
    v_readlane_b32 s37, v91, 63
    s_cbranch_vccnz L2_xo9
L2_xp9:
    v_and_b32 v47, 0x3f0, v3
    s_cmp_lg_u32 s56, 0
    s_cbranch_scc1 L2_m10
    s_mul_i32 s3, s33, 1280000
    s_add_u32 s3, s3, s100
    s_add_u32 s3, s3, 352768
    buffer_load_dwordx4 v[124:127], v47, s[24:27], s3 offen offset:2048
L2_m10:
    v_and_b32 v47, 0x3f0, v3
    s_cmp_lg_u32 s56, 0
    s_cbranch_scc1 L2_m11
    s_mul_i32 s3, s33, 1280000
    s_add_u32 s3, s3, s100
    s_add_u32 s3, s3, 352768
    buffer_load_dwordx4 v[116:119], v47, s[24:27], s3 offen offset:0
L2_m11:
    s_waitcnt lgkmcnt(0)
    v_cmp_ne_u64 s[50:51], v[72:73], v[68:69]
    v_cmpx_ne_u64 s[54:55], v[74:75], v[70:71]
    s_and_b64 s[82:83], s[54:55], s[80:81]
    s_cbranch_scc1 L2_c12
L2_d12:
    v_mov_b64 v[84:85], v[70:71]
    v_mov_b32 v7, v93
    v_mov_b64 v[86:87], v[74:75]
    s_or_b64 s[80:81], s[80:81], s[54:55]
    s_mov_b64 exec, s[50:51]
    s_and_b64 s[82:83], s[50:51], s[80:81]
    s_cbranch_scc1 L2_c13
L2_d13:
    v_mov_b64 v[84:85], v[68:69]
    v_mov_b32 v7, v92
    v_mov_b64 v[86:87], v[72:73]
    s_mov_b64 exec, -1
    s_or_b64 s[80:81], s[80:81], s[50:51]
    ds_read_b64 v[70:71], v95 offset:65408
    ds_read_b64 v[68:69], v94 offset:65408
    s_waitcnt vmcnt(2)
    v_and_b32 v46, 0x20000000, v27
    v_lshrrev_b32 v47, 14, v23
    v_bitop3_b32 v47, v47, v5, v46 bitop3:0xea
    ds_read_b64 v[102:103], v47
    v_bitop3_b32 v93, v23, v5, v46 bitop3:0xea
    v_and_b32 v46, 0x10000000, v27
    v_lshrrev_b32 v47, 14, v22
    v_bitop3_b32 v47, v47, v5, v46 bitop3:0xea
    ds_read_b64 v[100:101], v47
    v_bitop3_b32 v92, v22, v5, v46 bitop3:0xea
    s_waitcnt lgkmcnt(2)
    v_mfma_f32_4x4x4_16b_bf16 v[80:83], v[10:11], v[70:71], v[80:83]
    v_mfma_f32_4x4x4_16b_bf16 v[76:79], v[10:11], v[68:69], v[76:79]
    v_perm_b32 v15, v23, v26, s45
    v_bitop3_b32 v46, v23, 0.5, -0.5 bitop3:0xa8
    v_perm_b32 v14, v22, v26, s44
    v_bitop3_b32 v47, v22, 0.5, -0.5 bitop3:0xa8
    v_cvt_pk_bf16_f32 v80, v80, v81
    v_cvt_pk_bf16_f32 v81, v82, v83
    ds_wrxchg_rtn_b64 v[74:75], v95, v[80:81] offset:65408
    v_cvt_pk_bf16_f32 v76, v76, v77
    v_cvt_pk_bf16_f32 v77, v78, v79
    ds_wrxchg_rtn_b64 v[72:73], v94, v[76:77] offset:65408
    s_waitcnt lgkmcnt(2)
    v_mfma_f32_4x4x4_16b_bf16 v[80:83], v[8:9], v[102:103], 0
    v_mfma_f32_4x4x4_16b_bf16 v[76:79], v[8:9], v[100:101], 0
    v_bitop3_b32 v15, v6, v15, v46 bitop3:0xca
    v_bitop3_b32 v14, v6, v14, v47 bitop3:0xca
    v_cmp_lt_u32 s[84:85], v5, v92
    s_nop 0
    v_pk_mul_f32 v[80:81], v[80:81], v[14:15] op_sel:[0,1] op_sel_hi:[1,1]
    v_pk_mul_f32 v[82:83], v[82:83], v[14:15] op_sel:[0,1] op_sel_hi:[1,1]
    v_pk_mul_f32 v[76:77], v[76:77], v[14:15] op_sel:[0,0] op_sel_hi:[1,0]
    v_pk_mul_f32 v[78:79], v[78:79], v[14:15] op_sel:[0,0] op_sel_hi:[1,0]
    v_and_b32 v47, 0x0fffffff, v39
    buffer_load_dwordx2 v[34:35], v47, s[8:11], 0 offen
    buffer_load_dwordx3 v[36:38], v47, s[8:11], 0 offen offset:8
    v_and_b32 v47, 0x3f0, v3
    s_cmp_lg_u32 s56, 0
    s_cbranch_scc1 L2_m14
    s_mul_i32 s3, s33, 1280000
    s_add_u32 s3, s3, s100
    s_add_u32 s3, s3, 352768
    buffer_load_dwordx4 v[120:123], v47, s[24:27], s3 offen offset:1024
L2_m14:
    s_waitcnt lgkmcnt(0)
    v_cmp_ne_u64 s[50:51], v[72:73], v[68:69]
    v_cmpx_ne_u64 s[54:55], v[74:75], v[70:71]
    s_and_b64 s[82:83], s[54:55], s[80:81]
    s_cbranch_scc1 L2_c15
L2_d15:
    v_mov_b64 v[84:85], v[70:71]
    v_mov_b32 v7, v95
    v_mov_b64 v[86:87], v[74:75]
    s_or_b64 s[80:81], s[80:81], s[54:55]
    s_mov_b64 exec, s[50:51]
    s_and_b64 s[82:83], s[50:51], s[80:81]
    s_cbranch_scc1 L2_c16
L2_d16:
    v_mov_b64 v[84:85], v[68:69]
    v_mov_b32 v7, v94
    v_mov_b64 v[86:87], v[72:73]
    s_mov_b64 exec, -1
    s_or_b64 s[80:81], s[80:81], s[50:51]
    ds_read_b64 v[70:71], v93 offset:65408
    s_and_b64 exec, s[84:85], s[80:81]
    v_mfma_f32_4x4x4_16b_bf16 v[76:79], v[12:13], v[84:85], 0
    v_mov_b32 v92, v7
    s_andn2_b64 s[80:81], s[80:81], s[84:85]
    v_mfma_f32_4x4x4_16b_bf16 v[76:79], v[10:11], v[86:87], v[76:79]
    s_mov_b64 exec, -1
    ds_read_b64 v[68:69], v92 offset:65408
    v_and_b32 v46, 0x80000000, v27
    v_lshrrev_b32 v47, 14, v25
    v_bitop3_b32 v47, v47, v5, v46 bitop3:0xea
    ds_read_b64 v[106:107], v47
    v_bitop3_b32 v95, v25, v5, v46 bitop3:0xea
    v_and_b32 v46, 0x40000000, v27
    v_lshrrev_b32 v47, 14, v24
    v_bitop3_b32 v47, v47, v5, v46 bitop3:0xea
    ds_read_b64 v[104:105], v47
    v_bitop3_b32 v94, v24, v5, v46 bitop3:0xea
    s_waitcnt lgkmcnt(2)
    v_mfma_f32_4x4x4_16b_bf16 v[80:83], v[10:11], v[70:71], v[80:83]
    v_mfma_f32_4x4x4_16b_bf16 v[76:79], v[10:11], v[68:69], v[76:79]
    v_perm_b32 v15, v25, v26, s47
    v_bitop3_b32 v46, v25, 0.5, -0.5 bitop3:0xa8
    v_perm_b32 v14, v24, v26, s46
    v_bitop3_b32 v47, v24, 0.5, -0.5 bitop3:0xa8
    v_cvt_pk_bf16_f32 v80, v80, v81
    v_cvt_pk_bf16_f32 v81, v82, v83
    ds_wrxchg_rtn_b64 v[74:75], v93, v[80:81] offset:65408
    v_cvt_pk_bf16_f32 v76, v76, v77
    v_cvt_pk_bf16_f32 v77, v78, v79
    ds_wrxchg_rtn_b64 v[72:73], v92, v[76:77] offset:65408
    s_setprio 1
    s_waitcnt lgkmcnt(2)
    v_mfma_f32_4x4x4_16b_bf16 v[80:83], v[8:9], v[106:107], 0
    v_mfma_f32_4x4x4_16b_bf16 v[76:79], v[8:9], v[104:105], 0
    v_bitop3_b32 v15, v6, v15, v46 bitop3:0xca
    v_bitop3_b32 v14, v6, v14, v47 bitop3:0xca
    s_nop 1
    v_pk_mul_f32 v[80:81], v[80:81], v[14:15] op_sel:[0,1] op_sel_hi:[1,1]
    v_pk_mul_f32 v[82:83], v[82:83], v[14:15] op_sel:[0,1] op_sel_hi:[1,1]
    v_pk_mul_f32 v[76:77], v[76:77], v[14:15] op_sel:[0,0] op_sel_hi:[1,0]
    v_pk_mul_f32 v[78:79], v[78:79], v[14:15] op_sel:[0,0] op_sel_hi:[1,0]
    v_and_b32 v47, 0x3f0, v3
    s_cmp_lg_u32 s56, 0
    s_cbranch_scc1 L2_m17
    s_mul_i32 s3, s33, 1280000
    s_add_u32 s3, s3, s38
    s_add_u32 s3, s3, 320000
    buffer_load_dwordx4 v[108:111], v47, s[24:27], s3 offen offset:0
L2_m17:
    v_and_b32 v47, 0x3f0, v3
    s_cmp_lg_u32 s56, 0
    s_cbranch_scc1 L2_m18
    s_mul_i32 s3, s33, 1280000
    s_add_u32 s3, s3, s38
    s_add_u32 s3, s3, 320000
    buffer_load_dwordx4 v[112:115], v47, s[24:27], s3 offen offset:1024
L2_m18:
    v_and_b32 v47, 0x0fffffff, v40
    v_mov_b32 v21, v40
    buffer_load_dwordx2 v[16:17], v47, s[8:11], 0 offen
    buffer_load_dwordx3 v[18:20], v47, s[8:11], 0 offen offset:8
    s_waitcnt lgkmcnt(0)
    v_cmp_ne_u64 s[50:51], v[72:73], v[68:69]
    v_cmpx_ne_u64 s[54:55], v[74:75], v[70:71]
    s_and_b64 s[82:83], s[54:55], s[80:81]
    s_cbranch_scc1 L2_c19
L2_d19:
    v_mov_b64 v[84:85], v[70:71]
    v_mov_b32 v7, v93
    v_mov_b64 v[86:87], v[74:75]
    s_or_b64 s[80:81], s[80:81], s[54:55]
    s_mov_b64 exec, s[50:51]
    s_and_b64 s[82:83], s[50:51], s[80:81]
    s_cbranch_scc1 L2_c20
L2_d20:
    v_mov_b64 v[84:85], v[68:69]
    v_mov_b32 v7, v92
    v_mov_b64 v[86:87], v[72:73]
    s_mov_b64 exec, -1
    s_or_b64 s[80:81], s[80:81], s[50:51]
    ds_read_b64 v[70:71], v95 offset:65408
    ds_read_b64 v[68:69], v94 offset:65408
    s_waitcnt vmcnt(4)
    v_and_b32 v46, 0x20000000, v33
    v_lshrrev_b32 v47, 14, v29
    v_bitop3_b32 v47, v47, v5, v46 bitop3:0xea
    ds_read_b64 v[102:103], v47
    v_bitop3_b32 v93, v29, v5, v46 bitop3:0xea
    v_and_b32 v46, 0x10000000, v33
    v_lshrrev_b32 v47, 14, v28
    v_bitop3_b32 v47, v47, v5, v46 bitop3:0xea
    ds_read_b64 v[100:101], v47
    v_bitop3_b32 v92, v28, v5, v46 bitop3:0xea
    s_waitcnt lgkmcnt(2)
    v_mfma_f32_4x4x4_16b_bf16 v[80:83], v[10:11], v[70:71], v[80:83]
    v_mfma_f32_4x4x4_16b_bf16 v[76:79], v[10:11], v[68:69], v[76:79]
    v_perm_b32 v15, v29, v32, s45
    v_bitop3_b32 v46, v29, 0.5, -0.5 bitop3:0xa8
    v_perm_b32 v14, v28, v32, s44
    v_bitop3_b32 v47, v28, 0.5, -0.5 bitop3:0xa8
    v_cvt_pk_bf16_f32 v80, v80, v81
    v_cvt_pk_bf16_f32 v81, v82, v83
    ds_wrxchg_rtn_b64 v[74:75], v95, v[80:81] offset:65408
    v_cvt_pk_bf16_f32 v76, v76, v77
    v_cvt_pk_bf16_f32 v77, v78, v79
    ds_wrxchg_rtn_b64 v[72:73], v94, v[76:77] offset:65408
    s_waitcnt lgkmcnt(2)
    v_mfma_f32_4x4x4_16b_bf16 v[80:83], v[8:9], v[102:103], 0
    v_mfma_f32_4x4x4_16b_bf16 v[76:79], v[8:9], v[100:101], 0
    v_bitop3_b32 v15, v6, v15, v46 bitop3:0xca
    v_bitop3_b32 v14, v6, v14, v47 bitop3:0xca
    v_cmp_lt_u32 s[84:85], v5, v92
    s_nop 0
    v_pk_mul_f32 v[80:81], v[80:81], v[14:15] op_sel:[0,1] op_sel_hi:[1,1]
    v_pk_mul_f32 v[82:83], v[82:83], v[14:15] op_sel:[0,1] op_sel_hi:[1,1]
    v_pk_mul_f32 v[76:77], v[76:77], v[14:15] op_sel:[0,0] op_sel_hi:[1,0]
    v_pk_mul_f32 v[78:79], v[78:79], v[14:15] op_sel:[0,0] op_sel_hi:[1,0]
    s_waitcnt lgkmcnt(0)
    v_cmp_ne_u64 s[50:51], v[72:73], v[68:69]
    v_cmpx_ne_u64 s[54:55], v[74:75], v[70:71]
    s_and_b64 s[82:83], s[54:55], s[80:81]
    s_cbranch_scc1 L2_c21
L2_d21:
    v_mov_b64 v[84:85], v[70:71]
    v_mov_b32 v7, v95
    v_mov_b64 v[86:87], v[74:75]
    s_or_b64 s[80:81], s[80:81], s[54:55]
    s_mov_b64 exec, s[50:51]
    s_and_b64 s[82:83], s[50:51], s[80:81]
    s_cbranch_scc1 L2_c22
L2_d22:
    v_mov_b64 v[84:85], v[68:69]
    v_mov_b32 v7, v94
    v_mov_b64 v[86:87], v[72:73]
    s_mov_b64 exec, -1
    s_or_b64 s[80:81], s[80:81], s[50:51]
    ds_read_b64 v[70:71], v93 offset:65408
    s_and_b64 exec, s[84:85], s[80:81]
    v_mfma_f32_4x4x4_16b_bf16 v[76:79], v[12:13], v[84:85], 0
    v_mov_b32 v92, v7
    s_andn2_b64 s[80:81], s[80:81], s[84:85]
    v_mfma_f32_4x4x4_16b_bf16 v[76:79], v[10:11], v[86:87], v[76:79]
    s_mov_b64 exec, -1
    ds_read_b64 v[68:69], v92 offset:65408
    v_and_b32 v46, 0x80000000, v33
    v_lshrrev_b32 v47, 14, v31
    v_bitop3_b32 v47, v47, v5, v46 bitop3:0xea
    ds_read_b64 v[106:107], v47
    v_bitop3_b32 v95, v31, v5, v46 bitop3:0xea
    v_and_b32 v46, 0x40000000, v33
    v_lshrrev_b32 v47, 14, v30
    v_bitop3_b32 v47, v47, v5, v46 bitop3:0xea
    ds_read_b64 v[104:105], v47
    v_bitop3_b32 v94, v30, v5, v46 bitop3:0xea
    s_waitcnt lgkmcnt(2)
    v_mfma_f32_4x4x4_16b_bf16 v[80:83], v[10:11], v[70:71], v[80:83]
    v_mfma_f32_4x4x4_16b_bf16 v[76:79], v[10:11], v[68:69], v[76:79]
    v_perm_b32 v15, v31, v32, s47
    v_bitop3_b32 v46, v31, 0.5, -0.5 bitop3:0xa8
    v_perm_b32 v14, v30, v32, s46
    v_bitop3_b32 v47, v30, 0.5, -0.5 bitop3:0xa8
    v_cvt_pk_bf16_f32 v80, v80, v81
    v_cvt_pk_bf16_f32 v81, v82, v83
    ds_wrxchg_rtn_b64 v[74:75], v93, v[80:81] offset:65408
    v_cvt_pk_bf16_f32 v76, v76, v77
    v_cvt_pk_bf16_f32 v77, v78, v79
    ds_wrxchg_rtn_b64 v[72:73], v92, v[76:77] offset:65408
    s_setprio 0
    s_waitcnt lgkmcnt(2)
    v_mfma_f32_4x4x4_16b_bf16 v[80:83], v[8:9], v[106:107], 0
    v_mfma_f32_4x4x4_16b_bf16 v[76:79], v[8:9], v[104:105], 0
    v_bitop3_b32 v15, v6, v15, v46 bitop3:0xca
    v_bitop3_b32 v14, v6, v14, v47 bitop3:0xca
    s_nop 1
    v_pk_mul_f32 v[80:81], v[80:81], v[14:15] op_sel:[0,1] op_sel_hi:[1,1]
    v_pk_mul_f32 v[82:83], v[82:83], v[14:15] op_sel:[0,1] op_sel_hi:[1,1]
    v_pk_mul_f32 v[76:77], v[76:77], v[14:15] op_sel:[0,0] op_sel_hi:[1,0]
    v_pk_mul_f32 v[78:79], v[78:79], v[14:15] op_sel:[0,0] op_sel_hi:[1,0]
    s_add_u32 s40, s40, 0x50000
    v_and_b32 v47, 0x0fffffff, v41
    v_mov_b32 v27, v41
    buffer_load_dwordx2 v[22:23], v47, s[8:11], 0 offen
    buffer_load_dwordx3 v[24:26], v47, s[8:11], 0 offen offset:8
    s_waitcnt lgkmcnt(0)
    v_cmp_ne_u64 s[50:51], v[72:73], v[68:69]
    v_cmpx_ne_u64 s[54:55], v[74:75], v[70:71]
    s_and_b64 s[82:83], s[54:55], s[80:81]
    s_cbranch_scc1 L2_c23
L2_d23:
    v_mov_b64 v[84:85], v[70:71]
    v_mov_b32 v7, v93
    v_mov_b64 v[86:87], v[74:75]
    s_or_b64 s[80:81], s[80:81], s[54:55]
    s_mov_b64 exec, s[50:51]
    s_and_b64 s[82:83], s[50:51], s[80:81]
    s_cbranch_scc1 L2_c24
L2_d24:
    v_mov_b64 v[84:85], v[68:69]
    v_mov_b32 v7, v92
    v_mov_b64 v[86:87], v[72:73]
    s_mov_b64 exec, -1
    s_or_b64 s[80:81], s[80:81], s[50:51]
    ds_read_b64 v[70:71], v95 offset:65408
    ds_read_b64 v[68:69], v94 offset:65408
    s_waitcnt vmcnt(4)
    v_and_b32 v46, 0x20000000, v39
    v_lshrrev_b32 v47, 14, v35
    v_bitop3_b32 v47, v47, v5, v46 bitop3:0xea
    ds_read_b64 v[102:103], v47
    v_bitop3_b32 v93, v35, v5, v46 bitop3:0xea
    v_and_b32 v46, 0x10000000, v39
    v_lshrrev_b32 v47, 14, v34
    v_bitop3_b32 v47, v47, v5, v46 bitop3:0xea
    ds_read_b64 v[100:101], v47
    v_bitop3_b32 v92, v34, v5, v46 bitop3:0xea
    v_and_b32 v46, 0x80000000, v39
    v_lshrrev_b32 v47, 14, v37
    v_bitop3_b32 v47, v47, v5, v46 bitop3:0xea
    ds_read_b64 v[106:107], v47
    v_and_b32 v46, 0x40000000, v39
    v_lshrrev_b32 v47, 14, v36
    v_bitop3_b32 v47, v47, v5, v46 bitop3:0xea
    ds_read_b64 v[104:105], v47
    s_waitcnt lgkmcnt(4)
    v_mfma_f32_4x4x4_16b_bf16 v[80:83], v[10:11], v[70:71], v[80:83]
    v_mfma_f32_4x4x4_16b_bf16 v[76:79], v[10:11], v[68:69], v[76:79]
    v_perm_b32 v15, v35, v38, s45
    v_bitop3_b32 v46, v35, 0.5, -0.5 bitop3:0xa8
    v_perm_b32 v14, v34, v38, s44
    v_bitop3_b32 v47, v34, 0.5, -0.5 bitop3:0xa8
    v_cvt_pk_bf16_f32 v80, v80, v81
    v_cvt_pk_bf16_f32 v81, v82, v83
    ds_wrxchg_rtn_b64 v[74:75], v95, v[80:81] offset:65408
    v_cvt_pk_bf16_f32 v76, v76, v77
    v_cvt_pk_bf16_f32 v77, v78, v79
    ds_wrxchg_rtn_b64 v[72:73], v94, v[76:77] offset:65408
    s_waitcnt lgkmcnt(2)
    s_barrier
    s_setprio 3
    s_waitcnt vmcnt(6)
    v_subrev_u32 v88, s38, v3
    ds_write_b128 v88, v[116:119] offset:32768
    buffer_load_dwordx4 v[116:119], v3, s[16:19], s40 offen offset:2048
    s_waitcnt vmcnt(5)
    v_subrev_u32 v88, s38, v3
    ds_write_b128 v88, v[120:123] offset:33792
    buffer_load_dwordx4 v[120:123], v3, s[16:19], s40 offen offset:3072
    v_mfma_f32_4x4x4_16b_bf16 v[80:83], v[8:9], v[102:103], 0
    v_mfma_f32_4x4x4_16b_bf16 v[76:79], v[8:9], v[100:101], 0
    v_bitop3_b32 v15, v6, v15, v46 bitop3:0xca
    v_bitop3_b32 v14, v6, v14, v47 bitop3:0xca
    v_cmp_lt_u32 s[84:85], v5, v92
    s_nop 0
    v_pk_mul_f32 v[80:81], v[80:81], v[14:15] op_sel:[0,1] op_sel_hi:[1,1]
    v_pk_mul_f32 v[82:83], v[82:83], v[14:15] op_sel:[0,1] op_sel_hi:[1,1]
    v_pk_mul_f32 v[76:77], v[76:77], v[14:15] op_sel:[0,0] op_sel_hi:[1,0]
    v_pk_mul_f32 v[78:79], v[78:79], v[14:15] op_sel:[0,0] op_sel_hi:[1,0]
    v_and_b32 v47, 0x0fffffff, v42
    v_mov_b32 v33, v42
    buffer_load_dwordx2 v[28:29], v47, s[8:11], 0 offen
    buffer_load_dwordx3 v[30:32], v47, s[8:11], 0 offen offset:8
    v_mov_b32 v44, v43
    s_cmp_gt_u32 s37, 1024
    s_cbranch_scc1 L2_xs25
    s_cmp_lg_u32 s101, 0
    s_cbranch_scc1 L2_xa25
L2_xb25:
    v_lshlrev_b32 v89, 16, v96
    v_add_u32 v90, 60, v97
    v_bitop3_b32 v90, v89, v45, v90 bitop3:0x6a
    ds_write_b32 v98, v90 offset:12
    v_lshlrev_b32 v89, 20, v96
    v_add_u32 v90, 40, v97
    v_bitop3_b32 v90, v89, v45, v90 bitop3:0x6a
    ds_write_b32 v98, v90 offset:8
    v_lshlrev_b32 v89, 24, v96
    v_add_u32 v90, 20, v97
    v_bitop3_b32 v90, v89, v45, v90 bitop3:0x6a
    ds_write_b32 v98, v90 offset:4
    v_lshlrev_b32 v89, 28, v96
    v_bitop3_b32 v90, v89, v45, v97 bitop3:0x6a
    ds_write_b32 v98, v90 offset:0
    v_mov_b32_dpp v91, v64 quad_perm:[1,1,1,1] row_mask:0xf bank_mask:0xf
    v_and_b32 v89, 3, v91
    v_and_b32 v97, 0xfffc, v91
    v_sub_u16_dpp v88, v64, v91 quad_perm:[3,3,3,3] row_mask:0xf bank_mask:0xf
    v_mad_u32_u24 v97, v97, 5, v4
    v_add_u32 v99, v88, v89
    v_bfm_b32 v96, v88, v89
    v_cmp_lt_u32 s[58:59], 16, v99
    v_lshlrev_b32 v89, v1, v96
    v_and_b32 v89, v45, v89
    v_cmp_ne_u32 vcc, 0, v89
    v_xor_b32 v90, v97, v89
    s_add_u32 s3, s37, s38
    v_mbcnt_lo_u32_b32 v98, vcc_lo, 0
    v_mbcnt_hi_u32_b32 v98, vcc_hi, v98
    s_bcnt1_i32_b64 s41, vcc
    v_lshl_add_u32 v98, v98, 2, s3
    s_mov_b64 exec, vcc
    ds_write_b32 v98, v90
    s_mov_b64 exec, -1
    s_lshl2_add_u32 s37, s41, s37
    s_cmp_lg_u64 s[58:59], 0
    s_cbranch_scc1 L2_xe25
L2_xr25:
    v_add_u32 v98, s37, v0
    v_mov_b32 v90, -1
    ds_write_b32 v98, v90
    ds_read2st64_b32 v[40:41], v0 offset0:0 offset1:1
    ds_read2st64_b32 v[42:43], v0 offset0:2 offset1:3
    s_sub_u32 s3, s37, 768
    s_cmp_gt_u32 s3, 256
    s_cbranch_scc1 L2_xf25
L2_xg25:
    s_setprio 2
    s_waitcnt vmcnt(10)
    v_subrev_u32 v88, s38, v3
    ds_write_b128 v88, v[124:127] offset:34816
    s_add_u32 s3, s40, 4096
    buffer_load_dwordx4 v[124:127], v3, s[16:19], s3 offen
    s_waitcnt lgkmcnt(11)
    v_cmp_ne_u64 s[50:51], v[72:73], v[68:69]
    v_cmpx_ne_u64 s[54:55], v[74:75], v[70:71]
    s_and_b64 s[82:83], s[54:55], s[80:81]
    s_cbranch_scc1 L2_c26
L2_d26:
    v_mov_b64 v[84:85], v[70:71]
    v_mov_b32 v7, v95
    v_mov_b64 v[86:87], v[74:75]
    s_or_b64 s[80:81], s[80:81], s[54:55]
    s_mov_b64 exec, s[50:51]
    s_and_b64 s[82:83], s[50:51], s[80:81]
    s_cbranch_scc1 L2_c27
L2_d27:
    v_mov_b64 v[84:85], v[68:69]
    v_mov_b32 v7, v94
    v_mov_b64 v[86:87], v[72:73]
    s_mov_b64 exec, -1
    s_or_b64 s[80:81], s[80:81], s[50:51]
    ds_read_b64 v[70:71], v93 offset:65408
    s_and_b64 exec, s[84:85], s[80:81]
    v_mfma_f32_4x4x4_16b_bf16 v[76:79], v[12:13], v[84:85], 0
    v_mov_b32 v92, v7
    s_andn2_b64 s[80:81], s[80:81], s[84:85]
    v_mfma_f32_4x4x4_16b_bf16 v[76:79], v[10:11], v[86:87], v[76:79]
    s_mov_b64 exec, -1
    ds_read_b64 v[68:69], v92 offset:65408
    s_setprio 1
    s_waitcnt vmcnt(9)
    v_subrev_u32 v88, s100, v3
    ds_write_b128 v88, v[108:111] offset:0
    s_waitcnt lgkmcnt(1)
    v_mfma_f32_4x4x4_16b_bf16 v[80:83], v[10:11], v[70:71], v[80:83]
    v_mfma_f32_4x4x4_16b_bf16 v[76:79], v[10:11], v[68:69], v[76:79]
    v_and_b32 v46, 0x40000000, v39
    v_bitop3_b32 v94, v36, v5, v46 bitop3:0xea
    v_and_b32 v46, 0x80000000, v39
    v_bitop3_b32 v95, v37, v5, v46 bitop3:0xea
    v_perm_b32 v15, v37, v38, s47
    v_bitop3_b32 v46, v37, 0.5, -0.5 bitop3:0xa8
    v_perm_b32 v14, v36, v38, s46
    v_bitop3_b32 v47, v36, 0.5, -0.5 bitop3:0xa8
    v_cvt_pk_bf16_f32 v80, v80, v81
    v_cvt_pk_bf16_f32 v81, v82, v83
    ds_wrxchg_rtn_b64 v[74:75], v93, v[80:81] offset:65408
    v_cvt_pk_bf16_f32 v76, v76, v77
    v_cvt_pk_bf16_f32 v77, v78, v79
    ds_wrxchg_rtn_b64 v[72:73], v92, v[76:77] offset:65408
    s_setprio 0
    s_waitcnt vmcnt(9)
    v_subrev_u32 v88, s100, v3
    ds_write_b128 v88, v[112:115] offset:1024
    v_mfma_f32_4x4x4_16b_bf16 v[80:83], v[8:9], v[106:107], 0
    v_mfma_f32_4x4x4_16b_bf16 v[76:79], v[8:9], v[104:105], 0
    v_bitop3_b32 v15, v6, v15, v46 bitop3:0xca
    v_bitop3_b32 v14, v6, v14, v47 bitop3:0xca
    s_nop 1
    v_pk_mul_f32 v[80:81], v[80:81], v[14:15] op_sel:[0,1] op_sel_hi:[1,1]
    v_pk_mul_f32 v[82:83], v[82:83], v[14:15] op_sel:[0,1] op_sel_hi:[1,1]
    v_pk_mul_f32 v[76:77], v[76:77], v[14:15] op_sel:[0,0] op_sel_hi:[1,0]
    v_pk_mul_f32 v[78:79], v[78:79], v[14:15] op_sel:[0,0] op_sel_hi:[1,0]
    s_add_u32 s42, s42, 1
    s_waitcnt lgkmcnt(0)
    s_add_u32 s24, s30, 0xebc9000
    s_addc_u32 s25, s31, 0
    s_mov_b32 s26, 0x100
    s_mov_b32 s27, 0x20000
    s_barrier
    s_bitcmp1_b32 s36, s42
    s_cbranch_scc1 L2_slow
L2_ret1:
    s_setprio 3
    v_and_b32 v47, 0x0fffffff, v44
    v_mov_b32 v39, v44
    buffer_load_dwordx2 v[34:35], v47, s[8:11], 0 offen
    buffer_load_dwordx3 v[36:38], v47, s[8:11], 0 offen offset:8
    buffer_load_dwordx4 v[108:111], v3, s[16:19], s40 offen offset:0
    v_cmp_ne_u64 s[50:51], v[72:73], v[68:69]
    v_cmpx_ne_u64 s[54:55], v[74:75], v[70:71]
    s_and_b64 s[82:83], s[54:55], s[80:81]
    s_cbranch_scc1 L2_c28
L2_d28:
    v_mov_b64 v[84:85], v[70:71]
    v_mov_b32 v7, v93
    v_mov_b64 v[86:87], v[74:75]
    s_or_b64 s[80:81], s[80:81], s[54:55]
    s_mov_b64 exec, s[50:51]
    s_and_b64 s[82:83], s[50:51], s[80:81]
    s_cbranch_scc1 L2_c29
L2_d29:
    v_mov_b64 v[84:85], v[68:69]
    v_mov_b32 v7, v92
    v_mov_b64 v[86:87], v[72:73]
    s_mov_b64 exec, -1
    s_or_b64 s[80:81], s[80:81], s[50:51]
    ds_read_b64 v[70:71], v95 offset:65408
    ds_read_b64 v[68:69], v94 offset:65408
    s_waitcnt vmcnt(10)
    v_and_b32 v46, 0x20000000, v21
    v_lshrrev_b32 v47, 14, v17
    v_bitop3_b32 v47, v47, v5, v46 bitop3:0xea
    ds_read_b64 v[102:103], v47
    v_bitop3_b32 v93, v17, v5, v46 bitop3:0xea
    v_and_b32 v46, 0x10000000, v21
    v_lshrrev_b32 v47, 14, v16
    v_bitop3_b32 v47, v47, v5, v46 bitop3:0xea
    ds_read_b64 v[100:101], v47
    v_bitop3_b32 v92, v16, v5, v46 bitop3:0xea
    s_waitcnt lgkmcnt(2)
    v_mfma_f32_4x4x4_16b_bf16 v[80:83], v[10:11], v[70:71], v[80:83]
    v_mfma_f32_4x4x4_16b_bf16 v[76:79], v[10:11], v[68:69], v[76:79]
    v_perm_b32 v15, v17, v20, s45
    v_bitop3_b32 v46, v17, 0.5, -0.5 bitop3:0xa8
    v_perm_b32 v14, v16, v20, s44
    v_bitop3_b32 v47, v16, 0.5, -0.5 bitop3:0xa8
    v_cvt_pk_bf16_f32 v80, v80, v81
    v_cvt_pk_bf16_f32 v81, v82, v83
    ds_wrxchg_rtn_b64 v[74:75], v95, v[80:81] offset:65408
    v_cvt_pk_bf16_f32 v76, v76, v77
    v_cvt_pk_bf16_f32 v77, v78, v79
    ds_wrxchg_rtn_b64 v[72:73], v94, v[76:77] offset:65408
    s_waitcnt lgkmcnt(2)
    v_mfma_f32_4x4x4_16b_bf16 v[80:83], v[8:9], v[102:103], 0
    v_mfma_f32_4x4x4_16b_bf16 v[76:79], v[8:9], v[100:101], 0
    v_bitop3_b32 v15, v6, v15, v46 bitop3:0xca
    v_bitop3_b32 v14, v6, v14, v47 bitop3:0xca
    v_cmp_lt_u32 s[84:85], v5, v92
    s_nop 0
    v_pk_mul_f32 v[80:81], v[80:81], v[14:15] op_sel:[0,1] op_sel_hi:[1,1]
    v_pk_mul_f32 v[82:83], v[82:83], v[14:15] op_sel:[0,1] op_sel_hi:[1,1]
    v_pk_mul_f32 v[76:77], v[76:77], v[14:15] op_sel:[0,0] op_sel_hi:[1,0]
    v_pk_mul_f32 v[78:79], v[78:79], v[14:15] op_sel:[0,0] op_sel_hi:[1,0]
    buffer_load_dwordx4 v[112:115], v3, s[16:19], s40 offen offset:1024
    s_waitcnt lgkmcnt(0)
    v_cmp_ne_u64 s[50:51], v[72:73], v[68:69]
    v_cmpx_ne_u64 s[54:55], v[74:75], v[70:71]
    s_and_b64 s[82:83], s[54:55], s[80:81]
    s_cbranch_scc1 L2_c30
L2_d30:
    v_mov_b64 v[84:85], v[70:71]
    v_mov_b32 v7, v95
    v_mov_b64 v[86:87], v[74:75]
    s_or_b64 s[80:81], s[80:81], s[54:55]
    s_mov_b64 exec, s[50:51]
    s_and_b64 s[82:83], s[50:51], s[80:81]
    s_cbranch_scc1 L2_c31
L2_d31:
    v_mov_b64 v[84:85], v[68:69]
    v_mov_b32 v7, v94
    v_mov_b64 v[86:87], v[72:73]
    s_mov_b64 exec, -1
    s_or_b64 s[80:81], s[80:81], s[50:51]
    ds_read_b64 v[70:71], v93 offset:65408
    s_and_b64 exec, s[84:85], s[80:81]
    v_mfma_f32_4x4x4_16b_bf16 v[76:79], v[12:13], v[84:85], 0
    v_mov_b32 v92, v7
    s_andn2_b64 s[80:81], s[80:81], s[84:85]
    v_mfma_f32_4x4x4_16b_bf16 v[76:79], v[10:11], v[86:87], v[76:79]
    s_mov_b64 exec, -1
    ds_read_b64 v[68:69], v92 offset:65408
    v_and_b32 v46, 0x80000000, v21
    v_lshrrev_b32 v47, 14, v19
    v_bitop3_b32 v47, v47, v5, v46 bitop3:0xea
    ds_read_b64 v[106:107], v47
    v_bitop3_b32 v95, v19, v5, v46 bitop3:0xea
    v_and_b32 v46, 0x40000000, v21
    v_lshrrev_b32 v47, 14, v18
    v_bitop3_b32 v47, v47, v5, v46 bitop3:0xea
    ds_read_b64 v[104:105], v47
    v_bitop3_b32 v94, v18, v5, v46 bitop3:0xea
    s_waitcnt lgkmcnt(2)
    v_mfma_f32_4x4x4_16b_bf16 v[80:83], v[10:11], v[70:71], v[80:83]
    v_mfma_f32_4x4x4_16b_bf16 v[76:79], v[10:11], v[68:69], v[76:79]
    v_perm_b32 v15, v19, v20, s47
    v_bitop3_b32 v46, v19, 0.5, -0.5 bitop3:0xa8
    v_perm_b32 v14, v18, v20, s46
    v_bitop3_b32 v47, v18, 0.5, -0.5 bitop3:0xa8
    v_cvt_pk_bf16_f32 v80, v80, v81
    v_cvt_pk_bf16_f32 v81, v82, v83
    ds_wrxchg_rtn_b64 v[74:75], v93, v[80:81] offset:65408
    v_cvt_pk_bf16_f32 v76, v76, v77
    v_cvt_pk_bf16_f32 v77, v78, v79
    ds_wrxchg_rtn_b64 v[72:73], v92, v[76:77] offset:65408
    s_setprio 2
    s_waitcnt lgkmcnt(2)
    v_mfma_f32_4x4x4_16b_bf16 v[80:83], v[8:9], v[106:107], 0
    v_mfma_f32_4x4x4_16b_bf16 v[76:79], v[8:9], v[104:105], 0
    v_bitop3_b32 v15, v6, v15, v46 bitop3:0xca
    v_bitop3_b32 v14, v6, v14, v47 bitop3:0xca
    s_nop 1
    v_pk_mul_f32 v[80:81], v[80:81], v[14:15] op_sel:[0,1] op_sel_hi:[1,1]
    v_pk_mul_f32 v[82:83], v[82:83], v[14:15] op_sel:[0,1] op_sel_hi:[1,1]
    v_pk_mul_f32 v[76:77], v[76:77], v[14:15] op_sel:[0,0] op_sel_hi:[1,0]
    v_pk_mul_f32 v[78:79], v[78:79], v[14:15] op_sel:[0,0] op_sel_hi:[1,0]
    v_sub_u16 v88, v62, v54
    v_and_b32 v89, 3, v54
    v_add3_u32 v99, v88, v89, 3
    v_and_b32 v99, -4, v99
    v_max_u32 v99, 4, v99
    v_and_b32 v97, 0xfffc, v54
    v_bfm_b32 v96, v88, v89
    v_add_u32_dpp v91, v99, v99 row_shr:1 row_mask:0xf bank_mask:0xf bound_ctrl:1
    v_mad_u32_u24 v97, v97, 5, v2
    v_cmp_lt_u32 vcc, 16, v99
    v_add_u32_dpp v91, v91, v91 row_shr:2 row_mask:0xf bank_mask:0xf bound_ctrl:1
    v_sub_u32 v98, s38, v99
    v_lshrrev_b64 v[54:55], 16, v[54:55]
    v_add_u32_dpp v91, v91, v91 row_shr:4 row_mask:0xf bank_mask:0xf bound_ctrl:1
    v_lshrrev_b64 v[62:63], 16, v[62:63]
    s_mov_b32 s101, 0
    v_add_u32_dpp v91, v91, v91 row_shr:8 row_mask:0xf bank_mask:0xf bound_ctrl:1
    s_nop 1
    v_add_u32_dpp v91, v91, v91 row_bcast:15 row_mask:0xa bank_mask:0xf
    s_nop 1
    v_add_u32_dpp v91, v91, v91 row_bcast:31 row_mask:0xc bank_mask:0xf
    v_add_u32 v98, v98, v91
    v_readlane_b32 s37, v91, 63
    s_cbranch_vccnz L2_xo32
L2_xp32:
    v_and_b32 v47, 0x0fffffff, v40
    v_mov_b32 v21, v40
    buffer_load_dwordx2 v[16:17], v47, s[8:11], 0 offen
    buffer_load_dwordx3 v[18:20], v47, s[8:11], 0 offen offset:8
    s_waitcnt lgkmcnt(0)
    v_cmp_ne_u64 s[50:51], v[72:73], v[68:69]
    v_cmpx_ne_u64 s[54:55], v[74:75], v[70:71]
    s_and_b64 s[82:83], s[54:55], s[80:81]
    s_cbranch_scc1 L2_c33
L2_d33:
    v_mov_b64 v[84:85], v[70:71]
    v_mov_b32 v7, v93
    v_mov_b64 v[86:87], v[74:75]
    s_or_b64 s[80:81], s[80:81], s[54:55]
    s_mov_b64 exec, s[50:51]
    s_and_b64 s[82:83], s[50:51], s[80:81]
    s_cbranch_scc1 L2_c34
L2_d34:
    v_mov_b64 v[84:85], v[68:69]
    v_mov_b32 v7, v92
    v_mov_b64 v[86:87], v[72:73]
    s_mov_b64 exec, -1
    s_or_b64 s[80:81], s[80:81], s[50:51]
    ds_read_b64 v[70:71], v95 offset:65408
    ds_read_b64 v[68:69], v94 offset:65408
    s_waitcnt vmcnt(11)
    v_and_b32 v46, 0x20000000, v27
    v_lshrrev_b32 v47, 14, v23
    v_bitop3_b32 v47, v47, v5, v46 bitop3:0xea
    ds_read_b64 v[102:103], v47
    v_bitop3_b32 v93, v23, v5, v46 bitop3:0xea
    v_and_b32 v46, 0x10000000, v27
    v_lshrrev_b32 v47, 14, v22
    v_bitop3_b32 v47, v47, v5, v46 bitop3:0xea
    ds_read_b64 v[100:101], v47
    v_bitop3_b32 v92, v22, v5, v46 bitop3:0xea
    s_waitcnt lgkmcnt(2)
    v_mfma_f32_4x4x4_16b_bf16 v[80:83], v[10:11], v[70:71], v[80:83]
    v_mfma_f32_4x4x4_16b_bf16 v[76:79], v[10:11], v[68:69], v[76:79]
    v_perm_b32 v15, v23, v26, s45
    v_bitop3_b32 v46, v23, 0.5, -0.5 bitop3:0xa8
    v_perm_b32 v14, v22, v26, s44
    v_bitop3_b32 v47, v22, 0.5, -0.5 bitop3:0xa8
    v_cvt_pk_bf16_f32 v80, v80, v81
    v_cvt_pk_bf16_f32 v81, v82, v83
    ds_wrxchg_rtn_b64 v[74:75], v95, v[80:81] offset:65408
    v_cvt_pk_bf16_f32 v76, v76, v77
    v_cvt_pk_bf16_f32 v77, v78, v79
    ds_wrxchg_rtn_b64 v[72:73], v94, v[76:77] offset:65408
    s_waitcnt lgkmcnt(2)
    v_mfma_f32_4x4x4_16b_bf16 v[80:83], v[8:9], v[102:103], 0
    v_mfma_f32_4x4x4_16b_bf16 v[76:79], v[8:9], v[100:101], 0
    v_bitop3_b32 v15, v6, v15, v46 bitop3:0xca
    v_bitop3_b32 v14, v6, v14, v47 bitop3:0xca
    v_cmp_lt_u32 s[84:85], v5, v92
    s_nop 0
    v_pk_mul_f32 v[80:81], v[80:81], v[14:15] op_sel:[0,1] op_sel_hi:[1,1]
    v_pk_mul_f32 v[82:83], v[82:83], v[14:15] op_sel:[0,1] op_sel_hi:[1,1]
    v_pk_mul_f32 v[76:77], v[76:77], v[14:15] op_sel:[0,0] op_sel_hi:[1,0]
    v_pk_mul_f32 v[78:79], v[78:79], v[14:15] op_sel:[0,0] op_sel_hi:[1,0]
    s_waitcnt lgkmcnt(0)
    v_cmp_ne_u64 s[50:51], v[72:73], v[68:69]
    v_cmpx_ne_u64 s[54:55], v[74:75], v[70:71]
    s_and_b64 s[82:83], s[54:55], s[80:81]
    s_cbranch_scc1 L2_c35
L2_d35:
    v_mov_b64 v[84:85], v[70:71]
    v_mov_b32 v7, v95
    v_mov_b64 v[86:87], v[74:75]
    s_or_b64 s[80:81], s[80:81], s[54:55]
    s_mov_b64 exec, s[50:51]
    s_and_b64 s[82:83], s[50:51], s[80:81]
    s_cbranch_scc1 L2_c36
L2_d36:
    v_mov_b64 v[84:85], v[68:69]
    v_mov_b32 v7, v94
    v_mov_b64 v[86:87], v[72:73]
    s_mov_b64 exec, -1
    s_or_b64 s[80:81], s[80:81], s[50:51]
    ds_read_b64 v[70:71], v93 offset:65408
    s_and_b64 exec, s[84:85], s[80:81]
    v_mfma_f32_4x4x4_16b_bf16 v[76:79], v[12:13], v[84:85], 0
    v_mov_b32 v92, v7
    s_andn2_b64 s[80:81], s[80:81], s[84:85]
    v_mfma_f32_4x4x4_16b_bf16 v[76:79], v[10:11], v[86:87], v[76:79]
    s_mov_b64 exec, -1
    ds_read_b64 v[68:69], v92 offset:65408
    v_and_b32 v46, 0x80000000, v27
    v_lshrrev_b32 v47, 14, v25
    v_bitop3_b32 v47, v47, v5, v46 bitop3:0xea
    ds_read_b64 v[106:107], v47
    v_bitop3_b32 v95, v25, v5, v46 bitop3:0xea
    v_and_b32 v46, 0x40000000, v27
    v_lshrrev_b32 v47, 14, v24
    v_bitop3_b32 v47, v47, v5, v46 bitop3:0xea
    ds_read_b64 v[104:105], v47
    v_bitop3_b32 v94, v24, v5, v46 bitop3:0xea
    s_waitcnt lgkmcnt(2)
    v_mfma_f32_4x4x4_16b_bf16 v[80:83], v[10:11], v[70:71], v[80:83]
    v_mfma_f32_4x4x4_16b_bf16 v[76:79], v[10:11], v[68:69], v[76:79]
    v_perm_b32 v15, v25, v26, s47
    v_bitop3_b32 v46, v25, 0.5, -0.5 bitop3:0xa8
    v_perm_b32 v14, v24, v26, s46
    v_bitop3_b32 v47, v24, 0.5, -0.5 bitop3:0xa8
    v_cvt_pk_bf16_f32 v80, v80, v81
    v_cvt_pk_bf16_f32 v81, v82, v83
    ds_wrxchg_rtn_b64 v[74:75], v93, v[80:81] offset:65408
    v_cvt_pk_bf16_f32 v76, v76, v77
    v_cvt_pk_bf16_f32 v77, v78, v79
    ds_wrxchg_rtn_b64 v[72:73], v92, v[76:77] offset:65408
    s_setprio 1
    s_waitcnt lgkmcnt(2)
    v_mfma_f32_4x4x4_16b_bf16 v[80:83], v[8:9], v[106:107], 0
    v_mfma_f32_4x4x4_16b_bf16 v[76:79], v[8:9], v[104:105], 0
    v_bitop3_b32 v15, v6, v15, v46 bitop3:0xca
    v_bitop3_b32 v14, v6, v14, v47 bitop3:0xca
    s_nop 1
    v_pk_mul_f32 v[80:81], v[80:81], v[14:15] op_sel:[0,1] op_sel_hi:[1,1]
    v_pk_mul_f32 v[82:83], v[82:83], v[14:15] op_sel:[0,1] op_sel_hi:[1,1]
    v_pk_mul_f32 v[76:77], v[76:77], v[14:15] op_sel:[0,0] op_sel_hi:[1,0]
    v_pk_mul_f32 v[78:79], v[78:79], v[14:15] op_sel:[0,0] op_sel_hi:[1,0]
    v_and_b32 v47, 0x0fffffff, v41
    v_mov_b32 v27, v41
    buffer_load_dwordx2 v[22:23], v47, s[8:11], 0 offen
    buffer_load_dwordx3 v[24:26], v47, s[8:11], 0 offen offset:8
    s_waitcnt lgkmcnt(0)
    v_cmp_ne_u64 s[50:51], v[72:73], v[68:69]
    v_cmpx_ne_u64 s[54:55], v[74:75], v[70:71]
    s_and_b64 s[82:83], s[54:55], s[80:81]
    s_cbranch_scc1 L2_c37
L2_d37:
    v_mov_b64 v[84:85], v[70:71]
    v_mov_b32 v7, v93
    v_mov_b64 v[86:87], v[74:75]
    s_or_b64 s[80:81], s[80:81], s[54:55]
    s_mov_b64 exec, s[50:51]
    s_and_b64 s[82:83], s[50:51], s[80:81]
    s_cbranch_scc1 L2_c38
L2_d38:
    v_mov_b64 v[84:85], v[68:69]
    v_mov_b32 v7, v92
    v_mov_b64 v[86:87], v[72:73]
    s_mov_b64 exec, -1
    s_or_b64 s[80:81], s[80:81], s[50:51]
    ds_read_b64 v[70:71], v95 offset:65408
    ds_read_b64 v[68:69], v94 offset:65408
    s_waitcnt vmcnt(9)
    v_and_b32 v46, 0x20000000, v33
    v_lshrrev_b32 v47, 14, v29
    v_bitop3_b32 v47, v47, v5, v46 bitop3:0xea
    ds_read_b64 v[102:103], v47
    v_bitop3_b32 v93, v29, v5, v46 bitop3:0xea
    v_and_b32 v46, 0x10000000, v33
    v_lshrrev_b32 v47, 14, v28
    v_bitop3_b32 v47, v47, v5, v46 bitop3:0xea
    ds_read_b64 v[100:101], v47
    v_bitop3_b32 v92, v28, v5, v46 bitop3:0xea
    s_waitcnt lgkmcnt(2)
    v_mfma_f32_4x4x4_16b_bf16 v[80:83], v[10:11], v[70:71], v[80:83]
    v_mfma_f32_4x4x4_16b_bf16 v[76:79], v[10:11], v[68:69], v[76:79]
    v_perm_b32 v15, v29, v32, s45
    v_bitop3_b32 v46, v29, 0.5, -0.5 bitop3:0xa8
    v_perm_b32 v14, v28, v32, s44
    v_bitop3_b32 v47, v28, 0.5, -0.5 bitop3:0xa8
    v_cvt_pk_bf16_f32 v80, v80, v81
    v_cvt_pk_bf16_f32 v81, v82, v83
    ds_wrxchg_rtn_b64 v[74:75], v95, v[80:81] offset:65408
    v_cvt_pk_bf16_f32 v76, v76, v77
    v_cvt_pk_bf16_f32 v77, v78, v79
    ds_wrxchg_rtn_b64 v[72:73], v94, v[76:77] offset:65408
    s_waitcnt lgkmcnt(2)
    v_mfma_f32_4x4x4_16b_bf16 v[80:83], v[8:9], v[102:103], 0
    v_mfma_f32_4x4x4_16b_bf16 v[76:79], v[8:9], v[100:101], 0
    v_bitop3_b32 v15, v6, v15, v46 bitop3:0xca
    v_bitop3_b32 v14, v6, v14, v47 bitop3:0xca
    v_cmp_lt_u32 s[84:85], v5, v92
    s_nop 0
    v_pk_mul_f32 v[80:81], v[80:81], v[14:15] op_sel:[0,1] op_sel_hi:[1,1]
    v_pk_mul_f32 v[82:83], v[82:83], v[14:15] op_sel:[0,1] op_sel_hi:[1,1]
    v_pk_mul_f32 v[76:77], v[76:77], v[14:15] op_sel:[0,0] op_sel_hi:[1,0]
    v_pk_mul_f32 v[78:79], v[78:79], v[14:15] op_sel:[0,0] op_sel_hi:[1,0]
    s_waitcnt lgkmcnt(0)
    v_cmp_ne_u64 s[50:51], v[72:73], v[68:69]
    v_cmpx_ne_u64 s[54:55], v[74:75], v[70:71]
    s_and_b64 s[82:83], s[54:55], s[80:81]
    s_cbranch_scc1 L2_c39
L2_d39:
    v_mov_b64 v[84:85], v[70:71]
    v_mov_b32 v7, v95
    v_mov_b64 v[86:87], v[74:75]
    s_or_b64 s[80:81], s[80:81], s[54:55]
    s_mov_b64 exec, s[50:51]
    s_and_b64 s[82:83], s[50:51], s[80:81]
    s_cbranch_scc1 L2_c40
L2_d40:
    v_mov_b64 v[84:85], v[68:69]
    v_mov_b32 v7, v94
    v_mov_b64 v[86:87], v[72:73]
    s_mov_b64 exec, -1
    s_or_b64 s[80:81], s[80:81], s[50:51]
    ds_read_b64 v[70:71], v93 offset:65408
    s_and_b64 exec, s[84:85], s[80:81]
    v_mfma_f32_4x4x4_16b_bf16 v[76:79], v[12:13], v[84:85], 0
    v_mov_b32 v92, v7
    s_andn2_b64 s[80:81], s[80:81], s[84:85]
    v_mfma_f32_4x4x4_16b_bf16 v[76:79], v[10:11], v[86:87], v[76:79]
    s_mov_b64 exec, -1
    ds_read_b64 v[68:69], v92 offset:65408
    v_and_b32 v46, 0x80000000, v33
    v_lshrrev_b32 v47, 14, v31
    v_bitop3_b32 v47, v47, v5, v46 bitop3:0xea
    ds_read_b64 v[106:107], v47
    v_bitop3_b32 v95, v31, v5, v46 bitop3:0xea
    v_and_b32 v46, 0x40000000, v33
    v_lshrrev_b32 v47, 14, v30
    v_bitop3_b32 v47, v47, v5, v46 bitop3:0xea
    ds_read_b64 v[104:105], v47
    v_bitop3_b32 v94, v30, v5, v46 bitop3:0xea
    s_waitcnt lgkmcnt(2)
    v_mfma_f32_4x4x4_16b_bf16 v[80:83], v[10:11], v[70:71], v[80:83]
    v_mfma_f32_4x4x4_16b_bf16 v[76:79], v[10:11], v[68:69], v[76:79]
    v_perm_b32 v15, v31, v32, s47
    v_bitop3_b32 v46, v31, 0.5, -0.5 bitop3:0xa8
    v_perm_b32 v14, v30, v32, s46
    v_bitop3_b32 v47, v30, 0.5, -0.5 bitop3:0xa8
    v_cvt_pk_bf16_f32 v80, v80, v81
    v_cvt_pk_bf16_f32 v81, v82, v83
    ds_wrxchg_rtn_b64 v[74:75], v93, v[80:81] offset:65408
    v_cvt_pk_bf16_f32 v76, v76, v77
    v_cvt_pk_bf16_f32 v77, v78, v79
    ds_wrxchg_rtn_b64 v[72:73], v92, v[76:77] offset:65408
    s_setprio 0
    s_waitcnt lgkmcnt(2)
    v_mfma_f32_4x4x4_16b_bf16 v[80:83], v[8:9], v[106:107], 0
    v_mfma_f32_4x4x4_16b_bf16 v[76:79], v[8:9], v[104:105], 0
    v_bitop3_b32 v15, v6, v15, v46 bitop3:0xca
    v_bitop3_b32 v14, v6, v14, v47 bitop3:0xca
    s_nop 1
    v_pk_mul_f32 v[80:81], v[80:81], v[14:15] op_sel:[0,1] op_sel_hi:[1,1]
    v_pk_mul_f32 v[82:83], v[82:83], v[14:15] op_sel:[0,1] op_sel_hi:[1,1]
    v_pk_mul_f32 v[76:77], v[76:77], v[14:15] op_sel:[0,0] op_sel_hi:[1,0]
    v_pk_mul_f32 v[78:79], v[78:79], v[14:15] op_sel:[0,0] op_sel_hi:[1,0]
    s_add_u32 s40, s40, 0x50000
    v_and_b32 v47, 0x0fffffff, v42
    v_mov_b32 v33, v42
    buffer_load_dwordx2 v[28:29], v47, s[8:11], 0 offen
    buffer_load_dwordx3 v[30:32], v47, s[8:11], 0 offen offset:8
    s_waitcnt lgkmcnt(0)
    v_cmp_ne_u64 s[50:51], v[72:73], v[68:69]
    v_cmpx_ne_u64 s[54:55], v[74:75], v[70:71]
    s_and_b64 s[82:83], s[54:55], s[80:81]
    s_cbranch_scc1 L2_c41
L2_d41:
    v_mov_b64 v[84:85], v[70:71]
    v_mov_b32 v7, v93
    v_mov_b64 v[86:87], v[74:75]
    s_or_b64 s[80:81], s[80:81], s[54:55]
    s_mov_b64 exec, s[50:51]
    s_and_b64 s[82:83], s[50:51], s[80:81]
    s_cbranch_scc1 L2_c42
L2_d42:
    v_mov_b64 v[84:85], v[68:69]
    v_mov_b32 v7, v92
    v_mov_b64 v[86:87], v[72:73]
    s_mov_b64 exec, -1
    s_or_b64 s[80:81], s[80:81], s[50:51]
    ds_read_b64 v[70:71], v95 offset:65408
    ds_read_b64 v[68:69], v94 offset:65408
    s_waitcnt vmcnt(8)
    v_and_b32 v46, 0x20000000, v39
    v_lshrrev_b32 v47, 14, v35
    v_bitop3_b32 v47, v47, v5, v46 bitop3:0xea
    ds_read_b64 v[102:103], v47
    v_bitop3_b32 v93, v35, v5, v46 bitop3:0xea
    v_and_b32 v46, 0x10000000, v39
    v_lshrrev_b32 v47, 14, v34
    v_bitop3_b32 v47, v47, v5, v46 bitop3:0xea
    ds_read_b64 v[100:101], v47
    v_bitop3_b32 v92, v34, v5, v46 bitop3:0xea
    v_and_b32 v46, 0x80000000, v39
    v_lshrrev_b32 v47, 14, v37
    v_bitop3_b32 v47, v47, v5, v46 bitop3:0xea
    ds_read_b64 v[106:107], v47
    v_and_b32 v46, 0x40000000, v39
    v_lshrrev_b32 v47, 14, v36
    v_bitop3_b32 v47, v47, v5, v46 bitop3:0xea
    ds_read_b64 v[104:105], v47
    s_waitcnt lgkmcnt(4)
    v_mfma_f32_4x4x4_16b_bf16 v[80:83], v[10:11], v[70:71], v[80:83]
    v_mfma_f32_4x4x4_16b_bf16 v[76:79], v[10:11], v[68:69], v[76:79]
    v_perm_b32 v15, v35, v38, s45
    v_bitop3_b32 v46, v35, 0.5, -0.5 bitop3:0xa8
    v_perm_b32 v14, v34, v38, s44
    v_bitop3_b32 v47, v34, 0.5, -0.5 bitop3:0xa8
    v_cvt_pk_bf16_f32 v80, v80, v81
    v_cvt_pk_bf16_f32 v81, v82, v83
    ds_wrxchg_rtn_b64 v[74:75], v95, v[80:81] offset:65408
    v_cvt_pk_bf16_f32 v76, v76, v77
    v_cvt_pk_bf16_f32 v77, v78, v79
    ds_wrxchg_rtn_b64 v[72:73], v94, v[76:77] offset:65408
    s_waitcnt lgkmcnt(2)
    s_barrier
    s_setprio 3
    s_mov_b32 m0, s100
    s_nop 0
    ds_write_addtid_b32 v116 offset:32768
    ds_write_addtid_b32 v117 offset:33024
    ds_write_addtid_b32 v118 offset:33280
    ds_write_addtid_b32 v119 offset:33536
    buffer_load_dwordx4 v[116:119], v3, s[16:19], s40 offen offset:2048
    ds_write_addtid_b32 v120 offset:33792
    ds_write_addtid_b32 v121 offset:34048
    ds_write_addtid_b32 v122 offset:34304
    ds_write_addtid_b32 v123 offset:34560
    buffer_load_dwordx4 v[120:123], v3, s[16:19], s40 offen offset:3072
    v_mfma_f32_4x4x4_16b_bf16 v[80:83], v[8:9], v[102:103], 0
    v_mfma_f32_4x4x4_16b_bf16 v[76:79], v[8:9], v[100:101], 0
    v_bitop3_b32 v15, v6, v15, v46 bitop3:0xca
    v_bitop3_b32 v14, v6, v14, v47 bitop3:0xca
    v_cmp_lt_u32 s[84:85], v5, v92
    s_nop 0
    v_pk_mul_f32 v[80:81], v[80:81], v[14:15] op_sel:[0,1] op_sel_hi:[1,1]
    v_pk_mul_f32 v[82:83], v[82:83], v[14:15] op_sel:[0,1] op_sel_hi:[1,1]
    v_pk_mul_f32 v[76:77], v[76:77], v[14:15] op_sel:[0,0] op_sel_hi:[1,0]
    v_pk_mul_f32 v[78:79], v[78:79], v[14:15] op_sel:[0,0] op_sel_hi:[1,0]
    v_mov_b32 v44, v43
    s_cmp_gt_u32 s37, 1024
    s_cbranch_scc1 L2_xs43
    s_cmp_lg_u32 s101, 0
    s_cbranch_scc1 L2_xa43
L2_xb43:
    v_lshlrev_b32 v89, 16, v96
    v_add_u32 v90, 60, v97
    v_bitop3_b32 v90, v89, v45, v90 bitop3:0x6a
    ds_write_b32 v98, v90 offset:12
    v_lshlrev_b32 v89, 20, v96
    v_add_u32 v90, 40, v97
    v_bitop3_b32 v90, v89, v45, v90 bitop3:0x6a
    ds_write_b32 v98, v90 offset:8
    v_lshlrev_b32 v89, 24, v96
    v_add_u32 v90, 20, v97
    v_bitop3_b32 v90, v89, v45, v90 bitop3:0x6a
    ds_write_b32 v98, v90 offset:4
    v_lshlrev_b32 v89, 28, v96
    v_bitop3_b32 v90, v89, v45, v97 bitop3:0x6a
    ds_write_b32 v98, v90 offset:0
    v_mov_b32_dpp v91, v66 quad_perm:[1,1,1,1] row_mask:0xf bank_mask:0xf
    v_and_b32 v89, 3, v91
    v_and_b32 v97, 0xfffc, v91
    v_sub_u16_dpp v88, v66, v91 quad_perm:[3,3,3,3] row_mask:0xf bank_mask:0xf
    v_mad_u32_u24 v97, v97, 5, v4
    v_add_u32 v99, v88, v89
    v_bfm_b32 v96, v88, v89
    v_cmp_lt_u32 s[58:59], 16, v99
    v_lshlrev_b32 v89, v1, v96
    v_and_b32 v89, v45, v89
    v_cmp_ne_u32 vcc, 0, v89
    v_xor_b32 v90, v97, v89
    s_add_u32 s3, s37, s38
    v_mbcnt_lo_u32_b32 v98, vcc_lo, 0
    v_mbcnt_hi_u32_b32 v98, vcc_hi, v98
    s_bcnt1_i32_b64 s41, vcc
    v_lshl_add_u32 v98, v98, 2, s3
    s_mov_b64 exec, vcc
    ds_write_b32 v98, v90
    s_mov_b64 exec, -1
    s_lshl2_add_u32 s37, s41, s37
    s_cmp_lg_u64 s[58:59], 0
    s_cbranch_scc1 L2_xe43
L2_xr43:
    v_add_u32 v98, s37, v0
    v_mov_b32 v90, -1
    ds_write_b32 v98, v90
    ds_read2st64_b32 v[40:41], v0 offset0:0 offset1:1
    ds_read2st64_b32 v[42:43], v0 offset0:2 offset1:3
    s_sub_u32 s3, s37, 768
    s_cmp_gt_u32 s3, 256
    s_cbranch_scc1 L2_xf43
L2_xg43:
    v_lshrrev_b64 v[64:65], 16, v[64:65]
    v_lshrrev_b64 v[66:67], 16, v[66:67]
    s_setprio 2
    ds_write_addtid_b32 v124 offset:34816
    ds_write_addtid_b32 v125 offset:35072
    ds_write_addtid_b32 v126 offset:35328
    ds_write_addtid_b32 v127 offset:35584
    s_add_u32 s3, s40, 4096
    buffer_load_dwordx4 v[124:127], v3, s[16:19], s3 offen
    s_waitcnt lgkmcnt(14)
    v_cmp_ne_u64 s[50:51], v[72:73], v[68:69]
    v_cmpx_ne_u64 s[54:55], v[74:75], v[70:71]
    s_and_b64 s[82:83], s[54:55], s[80:81]
    s_cbranch_scc1 L2_c44
L2_d44:
    v_mov_b64 v[84:85], v[70:71]
    v_mov_b32 v7, v95
    v_mov_b64 v[86:87], v[74:75]
    s_or_b64 s[80:81], s[80:81], s[54:55]
    s_mov_b64 exec, s[50:51]
    s_and_b64 s[82:83], s[50:51], s[80:81]
    s_cbranch_scc1 L2_c45
L2_d45:
    v_mov_b64 v[84:85], v[68:69]
    v_mov_b32 v7, v94
    v_mov_b64 v[86:87], v[72:73]
    s_mov_b64 exec, -1
    s_or_b64 s[80:81], s[80:81], s[50:51]
    ds_read_b64 v[70:71], v93 offset:65408
    s_and_b64 exec, s[84:85], s[80:81]
    v_mfma_f32_4x4x4_16b_bf16 v[76:79], v[12:13], v[84:85], 0
    v_mov_b32 v92, v7
    s_andn2_b64 s[80:81], s[80:81], s[84:85]
    v_mfma_f32_4x4x4_16b_bf16 v[76:79], v[10:11], v[86:87], v[76:79]
    s_mov_b64 exec, -1
    ds_read_b64 v[68:69], v92 offset:65408
    s_setprio 1
    s_waitcnt vmcnt(10)
    s_mov_b32 m0, s38
    s_nop 0
    ds_write_addtid_b32 v108 offset:0
    ds_write_addtid_b32 v109 offset:256
    ds_write_addtid_b32 v110 offset:512
    ds_write_addtid_b32 v111 offset:768
    s_waitcnt lgkmcnt(4)
    v_mfma_f32_4x4x4_16b_bf16 v[80:83], v[10:11], v[70:71], v[80:83]
    v_mfma_f32_4x4x4_16b_bf16 v[76:79], v[10:11], v[68:69], v[76:79]
    v_and_b32 v46, 0x40000000, v39
    v_bitop3_b32 v94, v36, v5, v46 bitop3:0xea
    v_and_b32 v46, 0x80000000, v39
    v_bitop3_b32 v95, v37, v5, v46 bitop3:0xea
    v_perm_b32 v15, v37, v38, s47
    v_bitop3_b32 v46, v37, 0.5, -0.5 bitop3:0xa8
    v_perm_b32 v14, v36, v38, s46
    v_bitop3_b32 v47, v36, 0.5, -0.5 bitop3:0xa8
    v_cvt_pk_bf16_f32 v80, v80, v81
    v_cvt_pk_bf16_f32 v81, v82, v83
    ds_wrxchg_rtn_b64 v[74:75], v93, v[80:81] offset:65408
    v_cvt_pk_bf16_f32 v76, v76, v77
    v_cvt_pk_bf16_f32 v77, v78, v79
    ds_wrxchg_rtn_b64 v[72:73], v92, v[76:77] offset:65408
    v_and_b32 v88, 0x0fffffff, v44
    v_mov_b32 v39, v44
    buffer_load_dwordx2 v[34:35], v88, s[8:11], 0 offen
    buffer_load_dwordx3 v[36:38], v88, s[8:11], 0 offen offset:8
    s_setprio 0
    s_waitcnt vmcnt(11)
    ds_write_addtid_b32 v112 offset:1024
    ds_write_addtid_b32 v113 offset:1280
    ds_write_addtid_b32 v114 offset:1536
    ds_write_addtid_b32 v115 offset:1792
    v_mfma_f32_4x4x4_16b_bf16 v[80:83], v[8:9], v[106:107], 0
    v_mfma_f32_4x4x4_16b_bf16 v[76:79], v[8:9], v[104:105], 0
    v_bitop3_b32 v15, v6, v15, v46 bitop3:0xca
    v_bitop3_b32 v14, v6, v14, v47 bitop3:0xca
    s_nop 1
    v_pk_mul_f32 v[80:81], v[80:81], v[14:15] op_sel:[0,1] op_sel_hi:[1,1]
    v_pk_mul_f32 v[82:83], v[82:83], v[14:15] op_sel:[0,1] op_sel_hi:[1,1]
    v_pk_mul_f32 v[76:77], v[76:77], v[14:15] op_sel:[0,0] op_sel_hi:[1,0]
    v_pk_mul_f32 v[78:79], v[78:79], v[14:15] op_sel:[0,0] op_sel_hi:[1,0]
    s_add_u32 s42, s42, 1
    s_waitcnt lgkmcnt(0)
L2_loop:
    s_barrier
    s_bitcmp1_b32 s36, s42
    s_cbranch_scc1 L2_slow
L2_ret2:
    s_setprio 3
    buffer_load_dwordx4 v[108:111], v3, s[16:19], s40 offen offset:0
    v_cmp_ne_u64 s[50:51], v[72:73], v[68:69]
    v_cmpx_ne_u64 s[54:55], v[74:75], v[70:71]
    s_and_b64 s[82:83], s[54:55], s[80:81]
    s_cbranch_scc1 L2_c46
L2_d46:
    v_mov_b64 v[84:85], v[70:71]
    v_mov_b32 v7, v93
    v_mov_b64 v[86:87], v[74:75]
    s_or_b64 s[80:81], s[80:81], s[54:55]
    s_mov_b64 exec, s[50:51]
    s_and_b64 s[82:83], s[50:51], s[80:81]
    s_cbranch_scc1 L2_c47
L2_d47:
    v_mov_b64 v[84:85], v[68:69]
    v_mov_b32 v7, v92
    v_mov_b64 v[86:87], v[72:73]
    s_mov_b64 exec, -1
    s_or_b64 s[80:81], s[80:81], s[50:51]
    ds_read_b64 v[70:71], v95 offset:65408
    ds_read_b64 v[68:69], v94 offset:65408
    s_waitcnt vmcnt(10)
    v_and_b32 v46, 0x20000000, v21
    v_lshrrev_b32 v47, 14, v17
    v_bitop3_b32 v47, v47, v5, v46 bitop3:0xea
    ds_read_b64 v[102:103], v47
    v_bitop3_b32 v93, v17, v5, v46 bitop3:0xea
    v_and_b32 v46, 0x10000000, v21
    v_lshrrev_b32 v47, 14, v16
    v_bitop3_b32 v47, v47, v5, v46 bitop3:0xea
    ds_read_b64 v[100:101], v47
    v_bitop3_b32 v92, v16, v5, v46 bitop3:0xea
    s_waitcnt lgkmcnt(2)
    v_mfma_f32_4x4x4_16b_bf16 v[80:83], v[10:11], v[70:71], v[80:83]
    v_mfma_f32_4x4x4_16b_bf16 v[76:79], v[10:11], v[68:69], v[76:79]
    v_perm_b32 v15, v17, v20, s45
    v_bitop3_b32 v46, v17, 0.5, -0.5 bitop3:0xa8
    v_perm_b32 v14, v16, v20, s44
    v_bitop3_b32 v47, v16, 0.5, -0.5 bitop3:0xa8
    v_cvt_pk_bf16_f32 v80, v80, v81
    v_cvt_pk_bf16_f32 v81, v82, v83
    ds_wrxchg_rtn_b64 v[74:75], v95, v[80:81] offset:65408
    v_cvt_pk_bf16_f32 v76, v76, v77
    v_cvt_pk_bf16_f32 v77, v78, v79
    ds_wrxchg_rtn_b64 v[72:73], v94, v[76:77] offset:65408
    s_waitcnt lgkmcnt(2)
    v_mfma_f32_4x4x4_16b_bf16 v[80:83], v[8:9], v[102:103], 0
    v_mfma_f32_4x4x4_16b_bf16 v[76:79], v[8:9], v[100:101], 0
    v_bitop3_b32 v15, v6, v15, v46 bitop3:0xca
    v_bitop3_b32 v14, v6, v14, v47 bitop3:0xca
    v_cmp_lt_u32 s[84:85], v5, v92
    s_nop 0
    v_pk_mul_f32 v[80:81], v[80:81], v[14:15] op_sel:[0,1] op_sel_hi:[1,1]
    v_pk_mul_f32 v[82:83], v[82:83], v[14:15] op_sel:[0,1] op_sel_hi:[1,1]
    v_pk_mul_f32 v[76:77], v[76:77], v[14:15] op_sel:[0,0] op_sel_hi:[1,0]
    v_pk_mul_f32 v[78:79], v[78:79], v[14:15] op_sel:[0,0] op_sel_hi:[1,0]
    buffer_load_dwordx4 v[112:115], v3, s[16:19], s40 offen offset:1024
    s_waitcnt lgkmcnt(0)
    v_cmp_ne_u64 s[50:51], v[72:73], v[68:69]
    v_cmpx_ne_u64 s[54:55], v[74:75], v[70:71]
    s_and_b64 s[82:83], s[54:55], s[80:81]
    s_cbranch_scc1 L2_c48
L2_d48:
    v_mov_b64 v[84:85], v[70:71]
    v_mov_b32 v7, v95
    v_mov_b64 v[86:87], v[74:75]
    s_or_b64 s[80:81], s[80:81], s[54:55]
    s_mov_b64 exec, s[50:51]
    s_and_b64 s[82:83], s[50:51], s[80:81]
    s_cbranch_scc1 L2_c49
L2_d49:
    v_mov_b64 v[84:85], v[68:69]
    v_mov_b32 v7, v94
    v_mov_b64 v[86:87], v[72:73]
    s_mov_b64 exec, -1
    s_or_b64 s[80:81], s[80:81], s[50:51]
    ds_read_b64 v[70:71], v93 offset:65408
    s_and_b64 exec, s[84:85], s[80:81]
    v_mfma_f32_4x4x4_16b_bf16 v[76:79], v[12:13], v[84:85], 0
    v_mov_b32 v92, v7
    s_andn2_b64 s[80:81], s[80:81], s[84:85]
    v_mfma_f32_4x4x4_16b_bf16 v[76:79], v[10:11], v[86:87], v[76:79]
    s_mov_b64 exec, -1
    ds_read_b64 v[68:69], v92 offset:65408
    v_and_b32 v46, 0x80000000, v21
    v_lshrrev_b32 v47, 14, v19
    v_bitop3_b32 v47, v47, v5, v46 bitop3:0xea
    ds_read_b64 v[106:107], v47
    v_bitop3_b32 v95, v19, v5, v46 bitop3:0xea
    v_and_b32 v46, 0x40000000, v21
    v_lshrrev_b32 v47, 14, v18
    v_bitop3_b32 v47, v47, v5, v46 bitop3:0xea
    ds_read_b64 v[104:105], v47
    v_bitop3_b32 v94, v18, v5, v46 bitop3:0xea
    s_waitcnt lgkmcnt(2)
    v_mfma_f32_4x4x4_16b_bf16 v[80:83], v[10:11], v[70:71], v[80:83]
    v_mfma_f32_4x4x4_16b_bf16 v[76:79], v[10:11], v[68:69], v[76:79]
    v_perm_b32 v15, v19, v20, s47
    v_bitop3_b32 v46, v19, 0.5, -0.5 bitop3:0xa8
    v_perm_b32 v14, v18, v20, s46
    v_bitop3_b32 v47, v18, 0.5, -0.5 bitop3:0xa8
    v_cvt_pk_bf16_f32 v80, v80, v81
    v_cvt_pk_bf16_f32 v81, v82, v83
    ds_wrxchg_rtn_b64 v[74:75], v93, v[80:81] offset:65408
    v_cvt_pk_bf16_f32 v76, v76, v77
    v_cvt_pk_bf16_f32 v77, v78, v79
    ds_wrxchg_rtn_b64 v[72:73], v92, v[76:77] offset:65408
    v_and_b32 v88, 0x0fffffff, v40
    v_mov_b32 v21, v40
    buffer_load_dwordx2 v[16:17], v88, s[8:11], 0 offen
    buffer_load_dwordx3 v[18:20], v88, s[8:11], 0 offen offset:8
    s_setprio 2
    s_waitcnt lgkmcnt(2)
    v_mfma_f32_4x4x4_16b_bf16 v[80:83], v[8:9], v[106:107], 0
    v_mfma_f32_4x4x4_16b_bf16 v[76:79], v[8:9], v[104:105], 0
    v_bitop3_b32 v15, v6, v15, v46 bitop3:0xca
    v_bitop3_b32 v14, v6, v14, v47 bitop3:0xca
    s_nop 1
    v_pk_mul_f32 v[80:81], v[80:81], v[14:15] op_sel:[0,1] op_sel_hi:[1,1]
    v_pk_mul_f32 v[82:83], v[82:83], v[14:15] op_sel:[0,1] op_sel_hi:[1,1]
    v_pk_mul_f32 v[76:77], v[76:77], v[14:15] op_sel:[0,0] op_sel_hi:[1,0]
    v_pk_mul_f32 v[78:79], v[78:79], v[14:15] op_sel:[0,0] op_sel_hi:[1,0]
    v_sub_u16 v88, v56, v48
    v_and_b32 v89, 3, v48
    v_add3_u32 v99, v88, v89, 3
    v_and_b32 v99, -4, v99
    v_max_u32 v99, 4, v99
    v_and_b32 v97, 0xfffc, v48
    v_bfm_b32 v96, v88, v89
    v_add_u32_dpp v91, v99, v99 row_shr:1 row_mask:0xf bank_mask:0xf bound_ctrl:1
    v_mad_u32_u24 v97, v97, 5, v2
    v_cmp_lt_u32 vcc, 16, v99
    v_add_u32_dpp v91, v91, v91 row_shr:2 row_mask:0xf bank_mask:0xf bound_ctrl:1
    v_sub_u32 v98, s38, v99
    v_lshrrev_b64 v[48:49], 16, v[48:49]
    v_add_u32_dpp v91, v91, v91 row_shr:4 row_mask:0xf bank_mask:0xf bound_ctrl:1
    v_lshrrev_b64 v[56:57], 16, v[56:57]
    s_mov_b32 s101, 0
    v_add_u32_dpp v91, v91, v91 row_shr:8 row_mask:0xf bank_mask:0xf bound_ctrl:1
    s_nop 1
    v_add_u32_dpp v91, v91, v91 row_bcast:15 row_mask:0xa bank_mask:0xf
    s_nop 1
    v_add_u32_dpp v91, v91, v91 row_bcast:31 row_mask:0xc bank_mask:0xf
    v_add_u32 v98, v98, v91
    v_readlane_b32 s37, v91, 63
    s_cbranch_vccnz L2_xo50
L2_xp50:
    s_waitcnt lgkmcnt(0)
    v_cmp_ne_u64 s[50:51], v[72:73], v[68:69]
    v_cmpx_ne_u64 s[54:55], v[74:75], v[70:71]
    s_and_b64 s[82:83], s[54:55], s[80:81]
    s_cbranch_scc1 L2_c51
L2_d51:
    v_mov_b64 v[84:85], v[70:71]
    v_mov_b32 v7, v93
    v_mov_b64 v[86:87], v[74:75]
    s_or_b64 s[80:81], s[80:81], s[54:55]
    s_mov_b64 exec, s[50:51]
    s_and_b64 s[82:83], s[50:51], s[80:81]
    s_cbranch_scc1 L2_c52
L2_d52:
    v_mov_b64 v[84:85], v[68:69]
    v_mov_b32 v7, v92
    v_mov_b64 v[86:87], v[72:73]
    s_mov_b64 exec, -1
    s_or_b64 s[80:81], s[80:81], s[50:51]
    ds_read_b64 v[70:71], v95 offset:65408
    ds_read_b64 v[68:69], v94 offset:65408
    s_waitcnt vmcnt(11)
    v_and_b32 v46, 0x20000000, v27
    v_lshrrev_b32 v47, 14, v23
    v_bitop3_b32 v47, v47, v5, v46 bitop3:0xea
    ds_read_b64 v[102:103], v47
    v_bitop3_b32 v93, v23, v5, v46 bitop3:0xea
    v_and_b32 v46, 0x10000000, v27
    v_lshrrev_b32 v47, 14, v22
    v_bitop3_b32 v47, v47, v5, v46 bitop3:0xea
    ds_read_b64 v[100:101], v47
    v_bitop3_b32 v92, v22, v5, v46 bitop3:0xea
    s_waitcnt lgkmcnt(2)
    v_mfma_f32_4x4x4_16b_bf16 v[80:83], v[10:11], v[70:71], v[80:83]
    v_mfma_f32_4x4x4_16b_bf16 v[76:79], v[10:11], v[68:69], v[76:79]
    v_perm_b32 v15, v23, v26, s45
    v_bitop3_b32 v46, v23, 0.5, -0.5 bitop3:0xa8
    v_perm_b32 v14, v22, v26, s44
    v_bitop3_b32 v47, v22, 0.5, -0.5 bitop3:0xa8
    v_cvt_pk_bf16_f32 v80, v80, v81
    v_cvt_pk_bf16_f32 v81, v82, v83
    ds_wrxchg_rtn_b64 v[74:75], v95, v[80:81] offset:65408
    v_cvt_pk_bf16_f32 v76, v76, v77
    v_cvt_pk_bf16_f32 v77, v78, v79
    ds_wrxchg_rtn_b64 v[72:73], v94, v[76:77] offset:65408
    s_waitcnt lgkmcnt(2)
    v_mfma_f32_4x4x4_16b_bf16 v[80:83], v[8:9], v[102:103], 0
    v_mfma_f32_4x4x4_16b_bf16 v[76:79], v[8:9], v[100:101], 0
    v_bitop3_b32 v15, v6, v15, v46 bitop3:0xca
    v_bitop3_b32 v14, v6, v14, v47 bitop3:0xca
    v_cmp_lt_u32 s[84:85], v5, v92
    s_nop 0
    v_pk_mul_f32 v[80:81], v[80:81], v[14:15] op_sel:[0,1] op_sel_hi:[1,1]
    v_pk_mul_f32 v[82:83], v[82:83], v[14:15] op_sel:[0,1] op_sel_hi:[1,1]
    v_pk_mul_f32 v[76:77], v[76:77], v[14:15] op_sel:[0,0] op_sel_hi:[1,0]
    v_pk_mul_f32 v[78:79], v[78:79], v[14:15] op_sel:[0,0] op_sel_hi:[1,0]
    s_waitcnt lgkmcnt(0)
    v_cmp_ne_u64 s[50:51], v[72:73], v[68:69]
    v_cmpx_ne_u64 s[54:55], v[74:75], v[70:71]
    s_and_b64 s[82:83], s[54:55], s[80:81]
    s_cbranch_scc1 L2_c53
L2_d53:
    v_mov_b64 v[84:85], v[70:71]
    v_mov_b32 v7, v95
    v_mov_b64 v[86:87], v[74:75]
    s_or_b64 s[80:81], s[80:81], s[54:55]
    s_mov_b64 exec, s[50:51]
    s_and_b64 s[82:83], s[50:51], s[80:81]
    s_cbranch_scc1 L2_c54
L2_d54:
    v_mov_b64 v[84:85], v[68:69]
    v_mov_b32 v7, v94
    v_mov_b64 v[86:87], v[72:73]
    s_mov_b64 exec, -1
    s_or_b64 s[80:81], s[80:81], s[50:51]
    ds_read_b64 v[70:71], v93 offset:65408
    s_and_b64 exec, s[84:85], s[80:81]
    v_mfma_f32_4x4x4_16b_bf16 v[76:79], v[12:13], v[84:85], 0
    v_mov_b32 v92, v7
    s_andn2_b64 s[80:81], s[80:81], s[84:85]
    v_mfma_f32_4x4x4_16b_bf16 v[76:79], v[10:11], v[86:87], v[76:79]
    s_mov_b64 exec, -1
    ds_read_b64 v[68:69], v92 offset:65408
    v_and_b32 v46, 0x80000000, v27
    v_lshrrev_b32 v47, 14, v25
    v_bitop3_b32 v47, v47, v5, v46 bitop3:0xea
    ds_read_b64 v[106:107], v47
    v_bitop3_b32 v95, v25, v5, v46 bitop3:0xea
    v_and_b32 v46, 0x40000000, v27
    v_lshrrev_b32 v47, 14, v24
    v_bitop3_b32 v47, v47, v5, v46 bitop3:0xea
    ds_read_b64 v[104:105], v47
    v_bitop3_b32 v94, v24, v5, v46 bitop3:0xea
    s_waitcnt lgkmcnt(2)
    v_mfma_f32_4x4x4_16b_bf16 v[80:83], v[10:11], v[70:71], v[80:83]
    v_mfma_f32_4x4x4_16b_bf16 v[76:79], v[10:11], v[68:69], v[76:79]
    v_perm_b32 v15, v25, v26, s47
    v_bitop3_b32 v46, v25, 0.5, -0.5 bitop3:0xa8
    v_perm_b32 v14, v24, v26, s46
    v_bitop3_b32 v47, v24, 0.5, -0.5 bitop3:0xa8
    v_cvt_pk_bf16_f32 v80, v80, v81
    v_cvt_pk_bf16_f32 v81, v82, v83
    ds_wrxchg_rtn_b64 v[74:75], v93, v[80:81] offset:65408
    v_cvt_pk_bf16_f32 v76, v76, v77
    v_cvt_pk_bf16_f32 v77, v78, v79
    ds_wrxchg_rtn_b64 v[72:73], v92, v[76:77] offset:65408
    v_and_b32 v88, 0x0fffffff, v41
    v_mov_b32 v27, v41
    buffer_load_dwordx2 v[22:23], v88, s[8:11], 0 offen
    buffer_load_dwordx3 v[24:26], v88, s[8:11], 0 offen offset:8
    s_setprio 1
    s_waitcnt lgkmcnt(2)
    v_mfma_f32_4x4x4_16b_bf16 v[80:83], v[8:9], v[106:107], 0
    v_mfma_f32_4x4x4_16b_bf16 v[76:79], v[8:9], v[104:105], 0
    v_bitop3_b32 v15, v6, v15, v46 bitop3:0xca
    v_bitop3_b32 v14, v6, v14, v47 bitop3:0xca
    s_nop 1
    v_pk_mul_f32 v[80:81], v[80:81], v[14:15] op_sel:[0,1] op_sel_hi:[1,1]
    v_pk_mul_f32 v[82:83], v[82:83], v[14:15] op_sel:[0,1] op_sel_hi:[1,1]
    v_pk_mul_f32 v[76:77], v[76:77], v[14:15] op_sel:[0,0] op_sel_hi:[1,0]
    v_pk_mul_f32 v[78:79], v[78:79], v[14:15] op_sel:[0,0] op_sel_hi:[1,0]
    s_waitcnt lgkmcnt(0)
    v_cmp_ne_u64 s[50:51], v[72:73], v[68:69]
    v_cmpx_ne_u64 s[54:55], v[74:75], v[70:71]
    s_and_b64 s[82:83], s[54:55], s[80:81]
    s_cbranch_scc1 L2_c55
L2_d55:
    v_mov_b64 v[84:85], v[70:71]
    v_mov_b32 v7, v93
    v_mov_b64 v[86:87], v[74:75]
    s_or_b64 s[80:81], s[80:81], s[54:55]
    s_mov_b64 exec, s[50:51]
    s_and_b64 s[82:83], s[50:51], s[80:81]
    s_cbranch_scc1 L2_c56
L2_d56:
    v_mov_b64 v[84:85], v[68:69]
    v_mov_b32 v7, v92
    v_mov_b64 v[86:87], v[72:73]
    s_mov_b64 exec, -1
    s_or_b64 s[80:81], s[80:81], s[50:51]
    ds_read_b64 v[70:71], v95 offset:65408
    ds_read_b64 v[68:69], v94 offset:65408
    s_waitcnt vmcnt(11)
    v_and_b32 v46, 0x20000000, v33
    v_lshrrev_b32 v47, 14, v29
    v_bitop3_b32 v47, v47, v5, v46 bitop3:0xea
    ds_read_b64 v[102:103], v47
    v_bitop3_b32 v93, v29, v5, v46 bitop3:0xea
    v_and_b32 v46, 0x10000000, v33
    v_lshrrev_b32 v47, 14, v28
    v_bitop3_b32 v47, v47, v5, v46 bitop3:0xea
    ds_read_b64 v[100:101], v47
    v_bitop3_b32 v92, v28, v5, v46 bitop3:0xea
    s_waitcnt lgkmcnt(2)
    v_mfma_f32_4x4x4_16b_bf16 v[80:83], v[10:11], v[70:71], v[80:83]
    v_mfma_f32_4x4x4_16b_bf16 v[76:79], v[10:11], v[68:69], v[76:79]
    v_perm_b32 v15, v29, v32, s45
    v_bitop3_b32 v46, v29, 0.5, -0.5 bitop3:0xa8
    v_perm_b32 v14, v28, v32, s44
    v_bitop3_b32 v47, v28, 0.5, -0.5 bitop3:0xa8
    v_cvt_pk_bf16_f32 v80, v80, v81
    v_cvt_pk_bf16_f32 v81, v82, v83
    ds_wrxchg_rtn_b64 v[74:75], v95, v[80:81] offset:65408
    v_cvt_pk_bf16_f32 v76, v76, v77
    v_cvt_pk_bf16_f32 v77, v78, v79
    ds_wrxchg_rtn_b64 v[72:73], v94, v[76:77] offset:65408
    s_waitcnt lgkmcnt(2)
    v_mfma_f32_4x4x4_16b_bf16 v[80:83], v[8:9], v[102:103], 0
    v_mfma_f32_4x4x4_16b_bf16 v[76:79], v[8:9], v[100:101], 0
    v_bitop3_b32 v15, v6, v15, v46 bitop3:0xca
    v_bitop3_b32 v14, v6, v14, v47 bitop3:0xca
    v_cmp_lt_u32 s[84:85], v5, v92
    s_nop 0
    v_pk_mul_f32 v[80:81], v[80:81], v[14:15] op_sel:[0,1] op_sel_hi:[1,1]
    v_pk_mul_f32 v[82:83], v[82:83], v[14:15] op_sel:[0,1] op_sel_hi:[1,1]
    v_pk_mul_f32 v[76:77], v[76:77], v[14:15] op_sel:[0,0] op_sel_hi:[1,0]
    v_pk_mul_f32 v[78:79], v[78:79], v[14:15] op_sel:[0,0] op_sel_hi:[1,0]
    s_waitcnt lgkmcnt(0)
    v_cmp_ne_u64 s[50:51], v[72:73], v[68:69]
    v_cmpx_ne_u64 s[54:55], v[74:75], v[70:71]
    s_and_b64 s[82:83], s[54:55], s[80:81]
    s_cbranch_scc1 L2_c57
L2_d57:
    v_mov_b64 v[84:85], v[70:71]
    v_mov_b32 v7, v95
    v_mov_b64 v[86:87], v[74:75]
    s_or_b64 s[80:81], s[80:81], s[54:55]
    s_mov_b64 exec, s[50:51]
    s_and_b64 s[82:83], s[50:51], s[80:81]
    s_cbranch_scc1 L2_c58
L2_d58:
    v_mov_b64 v[84:85], v[68:69]
    v_mov_b32 v7, v94
    v_mov_b64 v[86:87], v[72:73]
    s_mov_b64 exec, -1
    s_or_b64 s[80:81], s[80:81], s[50:51]
    ds_read_b64 v[70:71], v93 offset:65408
    s_and_b64 exec, s[84:85], s[80:81]
    v_mfma_f32_4x4x4_16b_bf16 v[76:79], v[12:13], v[84:85], 0
    v_mov_b32 v92, v7
    s_andn2_b64 s[80:81], s[80:81], s[84:85]
    v_mfma_f32_4x4x4_16b_bf16 v[76:79], v[10:11], v[86:87], v[76:79]
    s_mov_b64 exec, -1
    ds_read_b64 v[68:69], v92 offset:65408
    v_and_b32 v46, 0x80000000, v33
    v_lshrrev_b32 v47, 14, v31
    v_bitop3_b32 v47, v47, v5, v46 bitop3:0xea
    ds_read_b64 v[106:107], v47
    v_bitop3_b32 v95, v31, v5, v46 bitop3:0xea
    v_and_b32 v46, 0x40000000, v33
    v_lshrrev_b32 v47, 14, v30
    v_bitop3_b32 v47, v47, v5, v46 bitop3:0xea
    ds_read_b64 v[104:105], v47
    v_bitop3_b32 v94, v30, v5, v46 bitop3:0xea
    s_waitcnt lgkmcnt(2)
    v_mfma_f32_4x4x4_16b_bf16 v[80:83], v[10:11], v[70:71], v[80:83]
    v_mfma_f32_4x4x4_16b_bf16 v[76:79], v[10:11], v[68:69], v[76:79]
    v_perm_b32 v15, v31, v32, s47
    v_bitop3_b32 v46, v31, 0.5, -0.5 bitop3:0xa8
    v_perm_b32 v14, v30, v32, s46
    v_bitop3_b32 v47, v30, 0.5, -0.5 bitop3:0xa8
    v_cvt_pk_bf16_f32 v80, v80, v81
    v_cvt_pk_bf16_f32 v81, v82, v83
    ds_wrxchg_rtn_b64 v[74:75], v93, v[80:81] offset:65408
    v_cvt_pk_bf16_f32 v76, v76, v77
    v_cvt_pk_bf16_f32 v77, v78, v79
    ds_wrxchg_rtn_b64 v[72:73], v92, v[76:77] offset:65408
    v_and_b32 v88, 0x0fffffff, v42
    v_mov_b32 v33, v42
    buffer_load_dwordx2 v[28:29], v88, s[8:11], 0 offen
    buffer_load_dwordx3 v[30:32], v88, s[8:11], 0 offen offset:8
    s_setprio 0
    s_waitcnt lgkmcnt(2)
    v_mfma_f32_4x4x4_16b_bf16 v[80:83], v[8:9], v[106:107], 0
    v_mfma_f32_4x4x4_16b_bf16 v[76:79], v[8:9], v[104:105], 0
    v_bitop3_b32 v15, v6, v15, v46 bitop3:0xca
    v_bitop3_b32 v14, v6, v14, v47 bitop3:0xca
    s_nop 1
    v_pk_mul_f32 v[80:81], v[80:81], v[14:15] op_sel:[0,1] op_sel_hi:[1,1]
    v_pk_mul_f32 v[82:83], v[82:83], v[14:15] op_sel:[0,1] op_sel_hi:[1,1]
    v_pk_mul_f32 v[76:77], v[76:77], v[14:15] op_sel:[0,0] op_sel_hi:[1,0]
    v_pk_mul_f32 v[78:79], v[78:79], v[14:15] op_sel:[0,0] op_sel_hi:[1,0]
    s_add_u32 s40, s40, 0xfff24000
    s_waitcnt lgkmcnt(0)
    v_cmp_ne_u64 s[50:51], v[72:73], v[68:69]
    v_cmpx_ne_u64 s[54:55], v[74:75], v[70:71]
    s_and_b64 s[82:83], s[54:55], s[80:81]
    s_cbranch_scc1 L2_c59
L2_d59:
    v_mov_b64 v[84:85], v[70:71]
    v_mov_b32 v7, v93
    v_mov_b64 v[86:87], v[74:75]
    s_or_b64 s[80:81], s[80:81], s[54:55]
    s_mov_b64 exec, s[50:51]
    s_and_b64 s[82:83], s[50:51], s[80:81]
    s_cbranch_scc1 L2_c60
L2_d60:
    v_mov_b64 v[84:85], v[68:69]
    v_mov_b32 v7, v92
    v_mov_b64 v[86:87], v[72:73]
    s_mov_b64 exec, -1
    s_or_b64 s[80:81], s[80:81], s[50:51]
    ds_read_b64 v[70:71], v95 offset:65408
    ds_read_b64 v[68:69], v94 offset:65408
    s_waitcnt vmcnt(8)
    v_and_b32 v46, 0x20000000, v39
    v_lshrrev_b32 v47, 14, v35
    v_bitop3_b32 v47, v47, v5, v46 bitop3:0xea
    ds_read_b64 v[102:103], v47
    v_bitop3_b32 v93, v35, v5, v46 bitop3:0xea
    v_and_b32 v46, 0x10000000, v39
    v_lshrrev_b32 v47, 14, v34
    v_bitop3_b32 v47, v47, v5, v46 bitop3:0xea
    ds_read_b64 v[100:101], v47
    v_bitop3_b32 v92, v34, v5, v46 bitop3:0xea
    v_and_b32 v46, 0x80000000, v39
    v_lshrrev_b32 v47, 14, v37
    v_bitop3_b32 v47, v47, v5, v46 bitop3:0xea
    ds_read_b64 v[106:107], v47
    v_and_b32 v46, 0x40000000, v39
    v_lshrrev_b32 v47, 14, v36
    v_bitop3_b32 v47, v47, v5, v46 bitop3:0xea
    ds_read_b64 v[104:105], v47
    s_waitcnt lgkmcnt(4)
    v_mfma_f32_4x4x4_16b_bf16 v[80:83], v[10:11], v[70:71], v[80:83]
    v_mfma_f32_4x4x4_16b_bf16 v[76:79], v[10:11], v[68:69], v[76:79]
    v_perm_b32 v15, v35, v38, s45
    v_bitop3_b32 v46, v35, 0.5, -0.5 bitop3:0xa8
    v_perm_b32 v14, v34, v38, s44
    v_bitop3_b32 v47, v34, 0.5, -0.5 bitop3:0xa8
    v_cvt_pk_bf16_f32 v80, v80, v81
    v_cvt_pk_bf16_f32 v81, v82, v83
    ds_wrxchg_rtn_b64 v[74:75], v95, v[80:81] offset:65408
    v_cvt_pk_bf16_f32 v76, v76, v77
    v_cvt_pk_bf16_f32 v77, v78, v79
    ds_wrxchg_rtn_b64 v[72:73], v94, v[76:77] offset:65408
    s_waitcnt lgkmcnt(2)
    s_barrier
    s_setprio 3
    s_mov_b32 m0, s100
    s_nop 0
    ds_write_addtid_b32 v116 offset:32768
    ds_write_addtid_b32 v117 offset:33024
    ds_write_addtid_b32 v118 offset:33280
    ds_write_addtid_b32 v119 offset:33536
    buffer_load_dwordx4 v[116:119], v3, s[16:19], s40 offen offset:2048
    ds_write_addtid_b32 v120 offset:33792
    ds_write_addtid_b32 v121 offset:34048
    ds_write_addtid_b32 v122 offset:34304
    ds_write_addtid_b32 v123 offset:34560
    buffer_load_dwordx4 v[120:123], v3, s[16:19], s40 offen offset:3072
    v_mfma_f32_4x4x4_16b_bf16 v[80:83], v[8:9], v[102:103], 0
    v_mfma_f32_4x4x4_16b_bf16 v[76:79], v[8:9], v[100:101], 0
    v_bitop3_b32 v15, v6, v15, v46 bitop3:0xca
    v_bitop3_b32 v14, v6, v14, v47 bitop3:0xca
    v_cmp_lt_u32 s[84:85], v5, v92
    s_nop 0
    v_pk_mul_f32 v[80:81], v[80:81], v[14:15] op_sel:[0,1] op_sel_hi:[1,1]
    v_pk_mul_f32 v[82:83], v[82:83], v[14:15] op_sel:[0,1] op_sel_hi:[1,1]
    v_pk_mul_f32 v[76:77], v[76:77], v[14:15] op_sel:[0,0] op_sel_hi:[1,0]
    v_pk_mul_f32 v[78:79], v[78:79], v[14:15] op_sel:[0,0] op_sel_hi:[1,0]
    v_mov_b32 v44, v43
    s_cmp_gt_u32 s37, 1024
    s_cbranch_scc1 L2_xs61
    s_cmp_lg_u32 s101, 0
    s_cbranch_scc1 L2_xa61
L2_xb61:
    v_lshlrev_b32 v89, 16, v96
    v_add_u32 v90, 60, v97
    v_bitop3_b32 v90, v89, v45, v90 bitop3:0x6a
    ds_write_b32 v98, v90 offset:12
    v_lshlrev_b32 v89, 20, v96
    v_add_u32 v90, 40, v97
    v_bitop3_b32 v90, v89, v45, v90 bitop3:0x6a
    ds_write_b32 v98, v90 offset:8
    v_lshlrev_b32 v89, 24, v96
    v_add_u32 v90, 20, v97
    v_bitop3_b32 v90, v89, v45, v90 bitop3:0x6a
    ds_write_b32 v98, v90 offset:4
    v_lshlrev_b32 v89, 28, v96
    v_bitop3_b32 v90, v89, v45, v97 bitop3:0x6a
    ds_write_b32 v98, v90 offset:0
    v_mov_b32_dpp v91, v64 quad_perm:[0,0,0,0] row_mask:0xf bank_mask:0xf
    v_and_b32 v89, 3, v91
    v_and_b32 v97, 0xfffc, v91
    v_sub_u16_dpp v88, v64, v91 quad_perm:[2,2,2,2] row_mask:0xf bank_mask:0xf
    v_mad_u32_u24 v97, v97, 5, v4
    v_add_u32 v99, v88, v89
    v_bfm_b32 v96, v88, v89
    v_cmp_lt_u32 s[58:59], 16, v99
    v_lshlrev_b32 v89, v1, v96
    v_and_b32 v89, v45, v89
    v_cmp_ne_u32 vcc, 0, v89
    v_xor_b32 v90, v97, v89
    s_add_u32 s3, s37, s38
    v_mbcnt_lo_u32_b32 v98, vcc_lo, 0
    v_mbcnt_hi_u32_b32 v98, vcc_hi, v98
    s_bcnt1_i32_b64 s41, vcc
    v_lshl_add_u32 v98, v98, 2, s3
    s_mov_b64 exec, vcc
    ds_write_b32 v98, v90
    s_mov_b64 exec, -1
    s_lshl2_add_u32 s37, s41, s37
    s_cmp_lg_u64 s[58:59], 0
    s_cbranch_scc1 L2_xe61
L2_xr61:
    v_add_u32 v98, s37, v0
    v_mov_b32 v90, -1
    ds_write_b32 v98, v90
    ds_read2st64_b32 v[40:41], v0 offset0:0 offset1:1
    ds_read2st64_b32 v[42:43], v0 offset0:2 offset1:3
    s_sub_u32 s3, s37, 768
    s_cmp_gt_u32 s3, 256
    s_cbranch_scc1 L2_xf61
L2_xg61:
    s_setprio 2
    ds_write_addtid_b32 v124 offset:34816
    ds_write_addtid_b32 v125 offset:35072
    ds_write_addtid_b32 v126 offset:35328
    ds_write_addtid_b32 v127 offset:35584
    s_add_u32 s3, s40, 4096
    buffer_load_dwordx4 v[124:127], v3, s[16:19], s3 offen
    s_waitcnt lgkmcnt(14)
    v_cmp_ne_u64 s[50:51], v[72:73], v[68:69]
    v_cmpx_ne_u64 s[54:55], v[74:75], v[70:71]
    s_and_b64 s[82:83], s[54:55], s[80:81]
    s_cbranch_scc1 L2_c62
L2_d62:
    v_mov_b64 v[84:85], v[70:71]
    v_mov_b32 v7, v95
    v_mov_b64 v[86:87], v[74:75]
    s_or_b64 s[80:81], s[80:81], s[54:55]
    s_mov_b64 exec, s[50:51]
    s_and_b64 s[82:83], s[50:51], s[80:81]
    s_cbranch_scc1 L2_c63
L2_d63:
    v_mov_b64 v[84:85], v[68:69]
    v_mov_b32 v7, v94
    v_mov_b64 v[86:87], v[72:73]
    s_mov_b64 exec, -1
    s_or_b64 s[80:81], s[80:81], s[50:51]
    ds_read_b64 v[70:71], v93 offset:65408
    s_and_b64 exec, s[84:85], s[80:81]
    v_mfma_f32_4x4x4_16b_bf16 v[76:79], v[12:13], v[84:85], 0
    v_mov_b32 v92, v7
    s_andn2_b64 s[80:81], s[80:81], s[84:85]
    v_mfma_f32_4x4x4_16b_bf16 v[76:79], v[10:11], v[86:87], v[76:79]
    s_mov_b64 exec, -1
    ds_read_b64 v[68:69], v92 offset:65408
    s_setprio 1
    s_waitcnt vmcnt(10)
    s_mov_b32 m0, s38
    s_nop 0
    ds_write_addtid_b32 v108 offset:0
    ds_write_addtid_b32 v109 offset:256
    ds_write_addtid_b32 v110 offset:512
    ds_write_addtid_b32 v111 offset:768
    s_waitcnt lgkmcnt(4)
    v_mfma_f32_4x4x4_16b_bf16 v[80:83], v[10:11], v[70:71], v[80:83]
    v_mfma_f32_4x4x4_16b_bf16 v[76:79], v[10:11], v[68:69], v[76:79]
    v_and_b32 v46, 0x40000000, v39
    v_bitop3_b32 v94, v36, v5, v46 bitop3:0xea
    v_and_b32 v46, 0x80000000, v39
    v_bitop3_b32 v95, v37, v5, v46 bitop3:0xea
    v_perm_b32 v15, v37, v38, s47
    v_bitop3_b32 v46, v37, 0.5, -0.5 bitop3:0xa8
    v_perm_b32 v14, v36, v38, s46
    v_bitop3_b32 v47, v36, 0.5, -0.5 bitop3:0xa8
    v_cvt_pk_bf16_f32 v80, v80, v81
    v_cvt_pk_bf16_f32 v81, v82, v83
    ds_wrxchg_rtn_b64 v[74:75], v93, v[80:81] offset:65408
    v_cvt_pk_bf16_f32 v76, v76, v77
    v_cvt_pk_bf16_f32 v77, v78, v79
    ds_wrxchg_rtn_b64 v[72:73], v92, v[76:77] offset:65408
    v_and_b32 v88, 0x0fffffff, v44
    v_mov_b32 v39, v44
    buffer_load_dwordx2 v[34:35], v88, s[8:11], 0 offen
    buffer_load_dwordx3 v[36:38], v88, s[8:11], 0 offen offset:8
    s_setprio 0
    s_waitcnt vmcnt(11)
    ds_write_addtid_b32 v112 offset:1024
    ds_write_addtid_b32 v113 offset:1280
    ds_write_addtid_b32 v114 offset:1536
    ds_write_addtid_b32 v115 offset:1792
    v_mfma_f32_4x4x4_16b_bf16 v[80:83], v[8:9], v[106:107], 0
    v_mfma_f32_4x4x4_16b_bf16 v[76:79], v[8:9], v[104:105], 0
    v_bitop3_b32 v15, v6, v15, v46 bitop3:0xca
    v_bitop3_b32 v14, v6, v14, v47 bitop3:0xca
    s_nop 1
    v_pk_mul_f32 v[80:81], v[80:81], v[14:15] op_sel:[0,1] op_sel_hi:[1,1]
    v_pk_mul_f32 v[82:83], v[82:83], v[14:15] op_sel:[0,1] op_sel_hi:[1,1]
    v_pk_mul_f32 v[76:77], v[76:77], v[14:15] op_sel:[0,0] op_sel_hi:[1,0]
    v_pk_mul_f32 v[78:79], v[78:79], v[14:15] op_sel:[0,0] op_sel_hi:[1,0]
    s_add_u32 s42, s42, 1
    s_waitcnt lgkmcnt(0)
    s_barrier
    s_bitcmp1_b32 s36, s42
    s_cbranch_scc1 L2_slow
L2_ret3:
    s_setprio 3
    buffer_load_dwordx4 v[108:111], v3, s[16:19], s40 offen offset:0
    v_cmp_ne_u64 s[50:51], v[72:73], v[68:69]
    v_cmpx_ne_u64 s[54:55], v[74:75], v[70:71]
    s_and_b64 s[82:83], s[54:55], s[80:81]
    s_cbranch_scc1 L2_c64
L2_d64:
    v_mov_b64 v[84:85], v[70:71]
    v_mov_b32 v7, v93
    v_mov_b64 v[86:87], v[74:75]
    s_or_b64 s[80:81], s[80:81], s[54:55]
    s_mov_b64 exec, s[50:51]
    s_and_b64 s[82:83], s[50:51], s[80:81]
    s_cbranch_scc1 L2_c65
L2_d65:
    v_mov_b64 v[84:85], v[68:69]
    v_mov_b32 v7, v92
    v_mov_b64 v[86:87], v[72:73]
    s_mov_b64 exec, -1
    s_or_b64 s[80:81], s[80:81], s[50:51]
    ds_read_b64 v[70:71], v95 offset:65408
    ds_read_b64 v[68:69], v94 offset:65408
    s_waitcnt vmcnt(10)
    v_and_b32 v46, 0x20000000, v21
    v_lshrrev_b32 v47, 14, v17
    v_bitop3_b32 v47, v47, v5, v46 bitop3:0xea
    ds_read_b64 v[102:103], v47
    v_bitop3_b32 v93, v17, v5, v46 bitop3:0xea
    v_and_b32 v46, 0x10000000, v21
    v_lshrrev_b32 v47, 14, v16
    v_bitop3_b32 v47, v47, v5, v46 bitop3:0xea
    ds_read_b64 v[100:101], v47
    v_bitop3_b32 v92, v16, v5, v46 bitop3:0xea
    s_waitcnt lgkmcnt(2)
    v_mfma_f32_4x4x4_16b_bf16 v[80:83], v[10:11], v[70:71], v[80:83]
    v_mfma_f32_4x4x4_16b_bf16 v[76:79], v[10:11], v[68:69], v[76:79]
    v_perm_b32 v15, v17, v20, s45
    v_bitop3_b32 v46, v17, 0.5, -0.5 bitop3:0xa8
    v_perm_b32 v14, v16, v20, s44
    v_bitop3_b32 v47, v16, 0.5, -0.5 bitop3:0xa8
    v_cvt_pk_bf16_f32 v80, v80, v81
    v_cvt_pk_bf16_f32 v81, v82, v83
    ds_wrxchg_rtn_b64 v[74:75], v95, v[80:81] offset:65408
    v_cvt_pk_bf16_f32 v76, v76, v77
    v_cvt_pk_bf16_f32 v77, v78, v79
    ds_wrxchg_rtn_b64 v[72:73], v94, v[76:77] offset:65408
    s_waitcnt lgkmcnt(2)
    v_mfma_f32_4x4x4_16b_bf16 v[80:83], v[8:9], v[102:103], 0
    v_mfma_f32_4x4x4_16b_bf16 v[76:79], v[8:9], v[100:101], 0
    v_bitop3_b32 v15, v6, v15, v46 bitop3:0xca
    v_bitop3_b32 v14, v6, v14, v47 bitop3:0xca
    v_cmp_lt_u32 s[84:85], v5, v92
    s_nop 0
    v_pk_mul_f32 v[80:81], v[80:81], v[14:15] op_sel:[0,1] op_sel_hi:[1,1]
    v_pk_mul_f32 v[82:83], v[82:83], v[14:15] op_sel:[0,1] op_sel_hi:[1,1]
    v_pk_mul_f32 v[76:77], v[76:77], v[14:15] op_sel:[0,0] op_sel_hi:[1,0]
    v_pk_mul_f32 v[78:79], v[78:79], v[14:15] op_sel:[0,0] op_sel_hi:[1,0]
    buffer_load_dwordx4 v[112:115], v3, s[16:19], s40 offen offset:1024
    s_waitcnt lgkmcnt(0)
    v_cmp_ne_u64 s[50:51], v[72:73], v[68:69]
    v_cmpx_ne_u64 s[54:55], v[74:75], v[70:71]
    s_and_b64 s[82:83], s[54:55], s[80:81]
    s_cbranch_scc1 L2_c66
L2_d66:
    v_mov_b64 v[84:85], v[70:71]
    v_mov_b32 v7, v95
    v_mov_b64 v[86:87], v[74:75]
    s_or_b64 s[80:81], s[80:81], s[54:55]
    s_mov_b64 exec, s[50:51]
    s_and_b64 s[82:83], s[50:51], s[80:81]
    s_cbranch_scc1 L2_c67
L2_d67:
    v_mov_b64 v[84:85], v[68:69]
    v_mov_b32 v7, v94
    v_mov_b64 v[86:87], v[72:73]
    s_mov_b64 exec, -1
    s_or_b64 s[80:81], s[80:81], s[50:51]
    ds_read_b64 v[70:71], v93 offset:65408
    s_and_b64 exec, s[84:85], s[80:81]
    v_mfma_f32_4x4x4_16b_bf16 v[76:79], v[12:13], v[84:85], 0
    v_mov_b32 v92, v7
    s_andn2_b64 s[80:81], s[80:81], s[84:85]
    v_mfma_f32_4x4x4_16b_bf16 v[76:79], v[10:11], v[86:87], v[76:79]
    s_mov_b64 exec, -1
    ds_read_b64 v[68:69], v92 offset:65408
    v_and_b32 v46, 0x80000000, v21
    v_lshrrev_b32 v47, 14, v19
    v_bitop3_b32 v47, v47, v5, v46 bitop3:0xea
    ds_read_b64 v[106:107], v47
    v_bitop3_b32 v95, v19, v5, v46 bitop3:0xea
    v_and_b32 v46, 0x40000000, v21
    v_lshrrev_b32 v47, 14, v18
    v_bitop3_b32 v47, v47, v5, v46 bitop3:0xea
    ds_read_b64 v[104:105], v47
    v_bitop3_b32 v94, v18, v5, v46 bitop3:0xea
    s_waitcnt lgkmcnt(2)
    v_mfma_f32_4x4x4_16b_bf16 v[80:83], v[10:11], v[70:71], v[80:83]
    v_mfma_f32_4x4x4_16b_bf16 v[76:79], v[10:11], v[68:69], v[76:79]
    v_perm_b32 v15, v19, v20, s47
    v_bitop3_b32 v46, v19, 0.5, -0.5 bitop3:0xa8
    v_perm_b32 v14, v18, v20, s46
    v_bitop3_b32 v47, v18, 0.5, -0.5 bitop3:0xa8
    v_cvt_pk_bf16_f32 v80, v80, v81
    v_cvt_pk_bf16_f32 v81, v82, v83
    ds_wrxchg_rtn_b64 v[74:75], v93, v[80:81] offset:65408
    v_cvt_pk_bf16_f32 v76, v76, v77
    v_cvt_pk_bf16_f32 v77, v78, v79
    ds_wrxchg_rtn_b64 v[72:73], v92, v[76:77] offset:65408
    v_and_b32 v88, 0x0fffffff, v40
    v_mov_b32 v21, v40
    buffer_load_dwordx2 v[16:17], v88, s[8:11], 0 offen
    buffer_load_dwordx3 v[18:20], v88, s[8:11], 0 offen offset:8
    s_setprio 2
    s_waitcnt lgkmcnt(2)
    v_mfma_f32_4x4x4_16b_bf16 v[80:83], v[8:9], v[106:107], 0
    v_mfma_f32_4x4x4_16b_bf16 v[76:79], v[8:9], v[104:105], 0
    v_bitop3_b32 v15, v6, v15, v46 bitop3:0xca
    v_bitop3_b32 v14, v6, v14, v47 bitop3:0xca
    s_nop 1
    v_pk_mul_f32 v[80:81], v[80:81], v[14:15] op_sel:[0,1] op_sel_hi:[1,1]
    v_pk_mul_f32 v[82:83], v[82:83], v[14:15] op_sel:[0,1] op_sel_hi:[1,1]
    v_pk_mul_f32 v[76:77], v[76:77], v[14:15] op_sel:[0,0] op_sel_hi:[1,0]
    v_pk_mul_f32 v[78:79], v[78:79], v[14:15] op_sel:[0,0] op_sel_hi:[1,0]
    v_sub_u16 v88, v58, v50
    v_and_b32 v89, 3, v50
    v_add3_u32 v99, v88, v89, 3
    v_and_b32 v99, -4, v99
    v_max_u32 v99, 4, v99
    v_and_b32 v97, 0xfffc, v50
    v_bfm_b32 v96, v88, v89
    v_add_u32_dpp v91, v99, v99 row_shr:1 row_mask:0xf bank_mask:0xf bound_ctrl:1
    v_mad_u32_u24 v97, v97, 5, v2
    v_cmp_lt_u32 vcc, 16, v99
    v_add_u32_dpp v91, v91, v91 row_shr:2 row_mask:0xf bank_mask:0xf bound_ctrl:1
    v_sub_u32 v98, s38, v99
    v_lshrrev_b64 v[50:51], 16, v[50:51]
    v_add_u32_dpp v91, v91, v91 row_shr:4 row_mask:0xf bank_mask:0xf bound_ctrl:1
    v_lshrrev_b64 v[58:59], 16, v[58:59]
    s_mov_b32 s101, 0
    v_add_u32_dpp v91, v91, v91 row_shr:8 row_mask:0xf bank_mask:0xf bound_ctrl:1
    s_nop 1
    v_add_u32_dpp v91, v91, v91 row_bcast:15 row_mask:0xa bank_mask:0xf
    s_nop 1
    v_add_u32_dpp v91, v91, v91 row_bcast:31 row_mask:0xc bank_mask:0xf
    v_add_u32 v98, v98, v91
    v_readlane_b32 s37, v91, 63
    s_cbranch_vccnz L2_xo68
L2_xp68:
    s_waitcnt lgkmcnt(0)
    v_cmp_ne_u64 s[50:51], v[72:73], v[68:69]
    v_cmpx_ne_u64 s[54:55], v[74:75], v[70:71]
    s_and_b64 s[82:83], s[54:55], s[80:81]
    s_cbranch_scc1 L2_c69
L2_d69:
    v_mov_b64 v[84:85], v[70:71]
    v_mov_b32 v7, v93
    v_mov_b64 v[86:87], v[74:75]
    s_or_b64 s[80:81], s[80:81], s[54:55]
    s_mov_b64 exec, s[50:51]
    s_and_b64 s[82:83], s[50:51], s[80:81]
    s_cbranch_scc1 L2_c70
L2_d70:
    v_mov_b64 v[84:85], v[68:69]
    v_mov_b32 v7, v92
    v_mov_b64 v[86:87], v[72:73]
    s_mov_b64 exec, -1
    s_or_b64 s[80:81], s[80:81], s[50:51]
    ds_read_b64 v[70:71], v95 offset:65408
    ds_read_b64 v[68:69], v94 offset:65408
    s_waitcnt vmcnt(11)
    v_and_b32 v46, 0x20000000, v27
    v_lshrrev_b32 v47, 14, v23
    v_bitop3_b32 v47, v47, v5, v46 bitop3:0xea
    ds_read_b64 v[102:103], v47
    v_bitop3_b32 v93, v23, v5, v46 bitop3:0xea
    v_and_b32 v46, 0x10000000, v27
    v_lshrrev_b32 v47, 14, v22
    v_bitop3_b32 v47, v47, v5, v46 bitop3:0xea
    ds_read_b64 v[100:101], v47
    v_bitop3_b32 v92, v22, v5, v46 bitop3:0xea
    s_waitcnt lgkmcnt(2)
    v_mfma_f32_4x4x4_16b_bf16 v[80:83], v[10:11], v[70:71], v[80:83]
    v_mfma_f32_4x4x4_16b_bf16 v[76:79], v[10:11], v[68:69], v[76:79]
    v_perm_b32 v15, v23, v26, s45
    v_bitop3_b32 v46, v23, 0.5, -0.5 bitop3:0xa8
    v_perm_b32 v14, v22, v26, s44
    v_bitop3_b32 v47, v22, 0.5, -0.5 bitop3:0xa8
    v_cvt_pk_bf16_f32 v80, v80, v81
    v_cvt_pk_bf16_f32 v81, v82, v83
    ds_wrxchg_rtn_b64 v[74:75], v95, v[80:81] offset:65408
    v_cvt_pk_bf16_f32 v76, v76, v77
    v_cvt_pk_bf16_f32 v77, v78, v79
    ds_wrxchg_rtn_b64 v[72:73], v94, v[76:77] offset:65408
    s_waitcnt lgkmcnt(2)
    v_mfma_f32_4x4x4_16b_bf16 v[80:83], v[8:9], v[102:103], 0
    v_mfma_f32_4x4x4_16b_bf16 v[76:79], v[8:9], v[100:101], 0
    v_bitop3_b32 v15, v6, v15, v46 bitop3:0xca
    v_bitop3_b32 v14, v6, v14, v47 bitop3:0xca
    v_cmp_lt_u32 s[84:85], v5, v92
    s_nop 0
    v_pk_mul_f32 v[80:81], v[80:81], v[14:15] op_sel:[0,1] op_sel_hi:[1,1]
    v_pk_mul_f32 v[82:83], v[82:83], v[14:15] op_sel:[0,1] op_sel_hi:[1,1]
    v_pk_mul_f32 v[76:77], v[76:77], v[14:15] op_sel:[0,0] op_sel_hi:[1,0]
    v_pk_mul_f32 v[78:79], v[78:79], v[14:15] op_sel:[0,0] op_sel_hi:[1,0]
    s_waitcnt lgkmcnt(0)
    v_cmp_ne_u64 s[50:51], v[72:73], v[68:69]
    v_cmpx_ne_u64 s[54:55], v[74:75], v[70:71]
    s_and_b64 s[82:83], s[54:55], s[80:81]
    s_cbranch_scc1 L2_c71
L2_d71:
    v_mov_b64 v[84:85], v[70:71]
    v_mov_b32 v7, v95
    v_mov_b64 v[86:87], v[74:75]
    s_or_b64 s[80:81], s[80:81], s[54:55]
    s_mov_b64 exec, s[50:51]
    s_and_b64 s[82:83], s[50:51], s[80:81]
    s_cbranch_scc1 L2_c72
L2_d72:
    v_mov_b64 v[84:85], v[68:69]
    v_mov_b32 v7, v94
    v_mov_b64 v[86:87], v[72:73]
    s_mov_b64 exec, -1
    s_or_b64 s[80:81], s[80:81], s[50:51]
    ds_read_b64 v[70:71], v93 offset:65408
    s_and_b64 exec, s[84:85], s[80:81]
    v_mfma_f32_4x4x4_16b_bf16 v[76:79], v[12:13], v[84:85], 0
    v_mov_b32 v92, v7
    s_andn2_b64 s[80:81], s[80:81], s[84:85]
    v_mfma_f32_4x4x4_16b_bf16 v[76:79], v[10:11], v[86:87], v[76:79]
    s_mov_b64 exec, -1
    ds_read_b64 v[68:69], v92 offset:65408
    v_and_b32 v46, 0x80000000, v27
    v_lshrrev_b32 v47, 14, v25
    v_bitop3_b32 v47, v47, v5, v46 bitop3:0xea
    ds_read_b64 v[106:107], v47
    v_bitop3_b32 v95, v25, v5, v46 bitop3:0xea
    v_and_b32 v46, 0x40000000, v27
    v_lshrrev_b32 v47, 14, v24
    v_bitop3_b32 v47, v47, v5, v46 bitop3:0xea
    ds_read_b64 v[104:105], v47
    v_bitop3_b32 v94, v24, v5, v46 bitop3:0xea
    s_waitcnt lgkmcnt(2)
    v_mfma_f32_4x4x4_16b_bf16 v[80:83], v[10:11], v[70:71], v[80:83]
    v_mfma_f32_4x4x4_16b_bf16 v[76:79], v[10:11], v[68:69], v[76:79]
    v_perm_b32 v15, v25, v26, s47
    v_bitop3_b32 v46, v25, 0.5, -0.5 bitop3:0xa8
    v_perm_b32 v14, v24, v26, s46
    v_bitop3_b32 v47, v24, 0.5, -0.5 bitop3:0xa8
    v_cvt_pk_bf16_f32 v80, v80, v81
    v_cvt_pk_bf16_f32 v81, v82, v83
    ds_wrxchg_rtn_b64 v[74:75], v93, v[80:81] offset:65408
    v_cvt_pk_bf16_f32 v76, v76, v77
    v_cvt_pk_bf16_f32 v77, v78, v79
    ds_wrxchg_rtn_b64 v[72:73], v92, v[76:77] offset:65408
    v_and_b32 v88, 0x0fffffff, v41
    v_mov_b32 v27, v41
    buffer_load_dwordx2 v[22:23], v88, s[8:11], 0 offen
    buffer_load_dwordx3 v[24:26], v88, s[8:11], 0 offen offset:8
    s_setprio 1
    s_waitcnt lgkmcnt(2)
    v_mfma_f32_4x4x4_16b_bf16 v[80:83], v[8:9], v[106:107], 0
    v_mfma_f32_4x4x4_16b_bf16 v[76:79], v[8:9], v[104:105], 0
    v_bitop3_b32 v15, v6, v15, v46 bitop3:0xca
    v_bitop3_b32 v14, v6, v14, v47 bitop3:0xca
    s_nop 1
    v_pk_mul_f32 v[80:81], v[80:81], v[14:15] op_sel:[0,1] op_sel_hi:[1,1]
    v_pk_mul_f32 v[82:83], v[82:83], v[14:15] op_sel:[0,1] op_sel_hi:[1,1]
    v_pk_mul_f32 v[76:77], v[76:77], v[14:15] op_sel:[0,0] op_sel_hi:[1,0]
    v_pk_mul_f32 v[78:79], v[78:79], v[14:15] op_sel:[0,0] op_sel_hi:[1,0]
    s_waitcnt lgkmcnt(0)
    v_cmp_ne_u64 s[50:51], v[72:73], v[68:69]
    v_cmpx_ne_u64 s[54:55], v[74:75], v[70:71]
    s_and_b64 s[82:83], s[54:55], s[80:81]
    s_cbranch_scc1 L2_c73
L2_d73:
    v_mov_b64 v[84:85], v[70:71]
    v_mov_b32 v7, v93
    v_mov_b64 v[86:87], v[74:75]
    s_or_b64 s[80:81], s[80:81], s[54:55]
    s_mov_b64 exec, s[50:51]
    s_and_b64 s[82:83], s[50:51], s[80:81]
    s_cbranch_scc1 L2_c74
L2_d74:
    v_mov_b64 v[84:85], v[68:69]
    v_mov_b32 v7, v92
    v_mov_b64 v[86:87], v[72:73]
    s_mov_b64 exec, -1
    s_or_b64 s[80:81], s[80:81], s[50:51]
    ds_read_b64 v[70:71], v95 offset:65408
    ds_read_b64 v[68:69], v94 offset:65408
    s_waitcnt vmcnt(11)
    v_and_b32 v46, 0x20000000, v33
    v_lshrrev_b32 v47, 14, v29
    v_bitop3_b32 v47, v47, v5, v46 bitop3:0xea
    ds_read_b64 v[102:103], v47
    v_bitop3_b32 v93, v29, v5, v46 bitop3:0xea
    v_and_b32 v46, 0x10000000, v33
    v_lshrrev_b32 v47, 14, v28
    v_bitop3_b32 v47, v47, v5, v46 bitop3:0xea
    ds_read_b64 v[100:101], v47
    v_bitop3_b32 v92, v28, v5, v46 bitop3:0xea
    s_waitcnt lgkmcnt(2)
    v_mfma_f32_4x4x4_16b_bf16 v[80:83], v[10:11], v[70:71], v[80:83]
    v_mfma_f32_4x4x4_16b_bf16 v[76:79], v[10:11], v[68:69], v[76:79]
    v_perm_b32 v15, v29, v32, s45
    v_bitop3_b32 v46, v29, 0.5, -0.5 bitop3:0xa8
    v_perm_b32 v14, v28, v32, s44
    v_bitop3_b32 v47, v28, 0.5, -0.5 bitop3:0xa8
    v_cvt_pk_bf16_f32 v80, v80, v81
    v_cvt_pk_bf16_f32 v81, v82, v83
    ds_wrxchg_rtn_b64 v[74:75], v95, v[80:81] offset:65408
    v_cvt_pk_bf16_f32 v76, v76, v77
    v_cvt_pk_bf16_f32 v77, v78, v79
    ds_wrxchg_rtn_b64 v[72:73], v94, v[76:77] offset:65408
    s_waitcnt lgkmcnt(2)
    v_mfma_f32_4x4x4_16b_bf16 v[80:83], v[8:9], v[102:103], 0
    v_mfma_f32_4x4x4_16b_bf16 v[76:79], v[8:9], v[100:101], 0
    v_bitop3_b32 v15, v6, v15, v46 bitop3:0xca
    v_bitop3_b32 v14, v6, v14, v47 bitop3:0xca
    v_cmp_lt_u32 s[84:85], v5, v92
    s_nop 0
    v_pk_mul_f32 v[80:81], v[80:81], v[14:15] op_sel:[0,1] op_sel_hi:[1,1]
    v_pk_mul_f32 v[82:83], v[82:83], v[14:15] op_sel:[0,1] op_sel_hi:[1,1]
    v_pk_mul_f32 v[76:77], v[76:77], v[14:15] op_sel:[0,0] op_sel_hi:[1,0]
    v_pk_mul_f32 v[78:79], v[78:79], v[14:15] op_sel:[0,0] op_sel_hi:[1,0]
    s_waitcnt lgkmcnt(0)
    v_cmp_ne_u64 s[50:51], v[72:73], v[68:69]
    v_cmpx_ne_u64 s[54:55], v[74:75], v[70:71]
    s_and_b64 s[82:83], s[54:55], s[80:81]
    s_cbranch_scc1 L2_c75
L2_d75:
    v_mov_b64 v[84:85], v[70:71]
    v_mov_b32 v7, v95
    v_mov_b64 v[86:87], v[74:75]
    s_or_b64 s[80:81], s[80:81], s[54:55]
    s_mov_b64 exec, s[50:51]
    s_and_b64 s[82:83], s[50:51], s[80:81]
    s_cbranch_scc1 L2_c76
L2_d76:
    v_mov_b64 v[84:85], v[68:69]
    v_mov_b32 v7, v94
    v_mov_b64 v[86:87], v[72:73]
    s_mov_b64 exec, -1
    s_or_b64 s[80:81], s[80:81], s[50:51]
    ds_read_b64 v[70:71], v93 offset:65408
    s_and_b64 exec, s[84:85], s[80:81]
    v_mfma_f32_4x4x4_16b_bf16 v[76:79], v[12:13], v[84:85], 0
    v_mov_b32 v92, v7
    s_andn2_b64 s[80:81], s[80:81], s[84:85]
    v_mfma_f32_4x4x4_16b_bf16 v[76:79], v[10:11], v[86:87], v[76:79]
    s_mov_b64 exec, -1
    ds_read_b64 v[68:69], v92 offset:65408
    v_and_b32 v46, 0x80000000, v33
    v_lshrrev_b32 v47, 14, v31
    v_bitop3_b32 v47, v47, v5, v46 bitop3:0xea
    ds_read_b64 v[106:107], v47
    v_bitop3_b32 v95, v31, v5, v46 bitop3:0xea
    v_and_b32 v46, 0x40000000, v33
    v_lshrrev_b32 v47, 14, v30
    v_bitop3_b32 v47, v47, v5, v46 bitop3:0xea
    ds_read_b64 v[104:105], v47
    v_bitop3_b32 v94, v30, v5, v46 bitop3:0xea
    s_waitcnt lgkmcnt(2)
    v_mfma_f32_4x4x4_16b_bf16 v[80:83], v[10:11], v[70:71], v[80:83]
    v_mfma_f32_4x4x4_16b_bf16 v[76:79], v[10:11], v[68:69], v[76:79]
    v_perm_b32 v15, v31, v32, s47
    v_bitop3_b32 v46, v31, 0.5, -0.5 bitop3:0xa8
    v_perm_b32 v14, v30, v32, s46
    v_bitop3_b32 v47, v30, 0.5, -0.5 bitop3:0xa8
    v_cvt_pk_bf16_f32 v80, v80, v81
    v_cvt_pk_bf16_f32 v81, v82, v83
    ds_wrxchg_rtn_b64 v[74:75], v93, v[80:81] offset:65408
    v_cvt_pk_bf16_f32 v76, v76, v77
    v_cvt_pk_bf16_f32 v77, v78, v79
    ds_wrxchg_rtn_b64 v[72:73], v92, v[76:77] offset:65408
    v_and_b32 v88, 0x0fffffff, v42
    v_mov_b32 v33, v42
    buffer_load_dwordx2 v[28:29], v88, s[8:11], 0 offen
    buffer_load_dwordx3 v[30:32], v88, s[8:11], 0 offen offset:8
    s_setprio 0
    s_waitcnt lgkmcnt(2)
    v_mfma_f32_4x4x4_16b_bf16 v[80:83], v[8:9], v[106:107], 0
    v_mfma_f32_4x4x4_16b_bf16 v[76:79], v[8:9], v[104:105], 0
    v_bitop3_b32 v15, v6, v15, v46 bitop3:0xca
    v_bitop3_b32 v14, v6, v14, v47 bitop3:0xca
    s_nop 1
    v_pk_mul_f32 v[80:81], v[80:81], v[14:15] op_sel:[0,1] op_sel_hi:[1,1]
    v_pk_mul_f32 v[82:83], v[82:83], v[14:15] op_sel:[0,1] op_sel_hi:[1,1]
    v_pk_mul_f32 v[76:77], v[76:77], v[14:15] op_sel:[0,0] op_sel_hi:[1,0]
    v_pk_mul_f32 v[78:79], v[78:79], v[14:15] op_sel:[0,0] op_sel_hi:[1,0]
    s_add_u32 s40, s40, 0x50000
    s_waitcnt lgkmcnt(0)
    v_cmp_ne_u64 s[50:51], v[72:73], v[68:69]
    v_cmpx_ne_u64 s[54:55], v[74:75], v[70:71]
    s_and_b64 s[82:83], s[54:55], s[80:81]
    s_cbranch_scc1 L2_c77
L2_d77:
    v_mov_b64 v[84:85], v[70:71]
    v_mov_b32 v7, v93
    v_mov_b64 v[86:87], v[74:75]
    s_or_b64 s[80:81], s[80:81], s[54:55]
    s_mov_b64 exec, s[50:51]
    s_and_b64 s[82:83], s[50:51], s[80:81]
    s_cbranch_scc1 L2_c78
L2_d78:
    v_mov_b64 v[84:85], v[68:69]
    v_mov_b32 v7, v92
    v_mov_b64 v[86:87], v[72:73]
    s_mov_b64 exec, -1
    s_or_b64 s[80:81], s[80:81], s[50:51]
    ds_read_b64 v[70:71], v95 offset:65408
    ds_read_b64 v[68:69], v94 offset:65408
    s_waitcnt vmcnt(8)
    v_and_b32 v46, 0x20000000, v39
    v_lshrrev_b32 v47, 14, v35
    v_bitop3_b32 v47, v47, v5, v46 bitop3:0xea
    ds_read_b64 v[102:103], v47
    v_bitop3_b32 v93, v35, v5, v46 bitop3:0xea
    v_and_b32 v46, 0x10000000, v39
    v_lshrrev_b32 v47, 14, v34
    v_bitop3_b32 v47, v47, v5, v46 bitop3:0xea
    ds_read_b64 v[100:101], v47
    v_bitop3_b32 v92, v34, v5, v46 bitop3:0xea
    v_and_b32 v46, 0x80000000, v39
    v_lshrrev_b32 v47, 14, v37
    v_bitop3_b32 v47, v47, v5, v46 bitop3:0xea
    ds_read_b64 v[106:107], v47
    v_and_b32 v46, 0x40000000, v39
    v_lshrrev_b32 v47, 14, v36
    v_bitop3_b32 v47, v47, v5, v46 bitop3:0xea
    ds_read_b64 v[104:105], v47
    s_waitcnt lgkmcnt(4)
    v_mfma_f32_4x4x4_16b_bf16 v[80:83], v[10:11], v[70:71], v[80:83]
    v_mfma_f32_4x4x4_16b_bf16 v[76:79], v[10:11], v[68:69], v[76:79]
    v_perm_b32 v15, v35, v38, s45
    v_bitop3_b32 v46, v35, 0.5, -0.5 bitop3:0xa8
    v_perm_b32 v14, v34, v38, s44
    v_bitop3_b32 v47, v34, 0.5, -0.5 bitop3:0xa8
    v_cvt_pk_bf16_f32 v80, v80, v81
    v_cvt_pk_bf16_f32 v81, v82, v83
    ds_wrxchg_rtn_b64 v[74:75], v95, v[80:81] offset:65408
    v_cvt_pk_bf16_f32 v76, v76, v77
    v_cvt_pk_bf16_f32 v77, v78, v79
    ds_wrxchg_rtn_b64 v[72:73], v94, v[76:77] offset:65408
    s_waitcnt lgkmcnt(2)
    s_barrier
    s_setprio 3
    s_mov_b32 m0, s100
    s_nop 0
    ds_write_addtid_b32 v116 offset:32768
    ds_write_addtid_b32 v117 offset:33024
    ds_write_addtid_b32 v118 offset:33280
    ds_write_addtid_b32 v119 offset:33536
    buffer_load_dwordx4 v[116:119], v3, s[16:19], s40 offen offset:2048
    ds_write_addtid_b32 v120 offset:33792
    ds_write_addtid_b32 v121 offset:34048
    ds_write_addtid_b32 v122 offset:34304
    ds_write_addtid_b32 v123 offset:34560
    buffer_load_dwordx4 v[120:123], v3, s[16:19], s40 offen offset:3072
    v_mfma_f32_4x4x4_16b_bf16 v[80:83], v[8:9], v[102:103], 0
    v_mfma_f32_4x4x4_16b_bf16 v[76:79], v[8:9], v[100:101], 0
    v_bitop3_b32 v15, v6, v15, v46 bitop3:0xca
    v_bitop3_b32 v14, v6, v14, v47 bitop3:0xca
    v_cmp_lt_u32 s[84:85], v5, v92
    s_nop 0
    v_pk_mul_f32 v[80:81], v[80:81], v[14:15] op_sel:[0,1] op_sel_hi:[1,1]
    v_pk_mul_f32 v[82:83], v[82:83], v[14:15] op_sel:[0,1] op_sel_hi:[1,1]
    v_pk_mul_f32 v[76:77], v[76:77], v[14:15] op_sel:[0,0] op_sel_hi:[1,0]
    v_pk_mul_f32 v[78:79], v[78:79], v[14:15] op_sel:[0,0] op_sel_hi:[1,0]
    v_mov_b32 v44, v43
    s_cmp_gt_u32 s37, 1024
    s_cbranch_scc1 L2_xs79
    s_cmp_lg_u32 s101, 0
    s_cbranch_scc1 L2_xa79
L2_xb79:
    v_lshlrev_b32 v89, 16, v96
    v_add_u32 v90, 60, v97
    v_bitop3_b32 v90, v89, v45, v90 bitop3:0x6a
    ds_write_b32 v98, v90 offset:12
    v_lshlrev_b32 v89, 20, v96
    v_add_u32 v90, 40, v97
    v_bitop3_b32 v90, v89, v45, v90 bitop3:0x6a
    ds_write_b32 v98, v90 offset:8
    v_lshlrev_b32 v89, 24, v96
    v_add_u32 v90, 20, v97
    v_bitop3_b32 v90, v89, v45, v90 bitop3:0x6a
    ds_write_b32 v98, v90 offset:4
    v_lshlrev_b32 v89, 28, v96
    v_bitop3_b32 v90, v89, v45, v97 bitop3:0x6a
    ds_write_b32 v98, v90 offset:0
    v_mov_b32_dpp v91, v66 quad_perm:[0,0,0,0] row_mask:0xf bank_mask:0xf
    v_and_b32 v89, 3, v91
    v_and_b32 v97, 0xfffc, v91
    v_sub_u16_dpp v88, v66, v91 quad_perm:[2,2,2,2] row_mask:0xf bank_mask:0xf
    v_mad_u32_u24 v97, v97, 5, v4
    v_add_u32 v99, v88, v89
    v_bfm_b32 v96, v88, v89
    v_cmp_lt_u32 s[58:59], 16, v99
    v_lshlrev_b32 v89, v1, v96
    v_and_b32 v89, v45, v89
    v_cmp_ne_u32 vcc, 0, v89
    v_xor_b32 v90, v97, v89
    s_add_u32 s3, s37, s38
    v_mbcnt_lo_u32_b32 v98, vcc_lo, 0
    v_mbcnt_hi_u32_b32 v98, vcc_hi, v98
    s_bcnt1_i32_b64 s41, vcc
    v_lshl_add_u32 v98, v98, 2, s3
    s_mov_b64 exec, vcc
    ds_write_b32 v98, v90
    s_mov_b64 exec, -1
    s_lshl2_add_u32 s37, s41, s37
    s_cmp_lg_u64 s[58:59], 0
    s_cbranch_scc1 L2_xe79
L2_xr79:
    v_add_u32 v98, s37, v0
    v_mov_b32 v90, -1
    ds_write_b32 v98, v90
    ds_read2st64_b32 v[40:41], v0 offset0:0 offset1:1
    ds_read2st64_b32 v[42:43], v0 offset0:2 offset1:3
    s_sub_u32 s3, s37, 768
    s_cmp_gt_u32 s3, 256
    s_cbranch_scc1 L2_xf79
L2_xg79:
    s_setprio 2
    ds_write_addtid_b32 v124 offset:34816
    ds_write_addtid_b32 v125 offset:35072
    ds_write_addtid_b32 v126 offset:35328
    ds_write_addtid_b32 v127 offset:35584
    s_add_u32 s3, s40, 4096
    buffer_load_dwordx4 v[124:127], v3, s[16:19], s3 offen
    s_waitcnt lgkmcnt(14)
    v_cmp_ne_u64 s[50:51], v[72:73], v[68:69]
    v_cmpx_ne_u64 s[54:55], v[74:75], v[70:71]
    s_and_b64 s[82:83], s[54:55], s[80:81]
    s_cbranch_scc1 L2_c80
L2_d80:
    v_mov_b64 v[84:85], v[70:71]
    v_mov_b32 v7, v95
    v_mov_b64 v[86:87], v[74:75]
    s_or_b64 s[80:81], s[80:81], s[54:55]
    s_mov_b64 exec, s[50:51]
    s_and_b64 s[82:83], s[50:51], s[80:81]
    s_cbranch_scc1 L2_c81
L2_d81:
    v_mov_b64 v[84:85], v[68:69]
    v_mov_b32 v7, v94
    v_mov_b64 v[86:87], v[72:73]
    s_mov_b64 exec, -1
    s_or_b64 s[80:81], s[80:81], s[50:51]
    ds_read_b64 v[70:71], v93 offset:65408
    s_and_b64 exec, s[84:85], s[80:81]
    v_mfma_f32_4x4x4_16b_bf16 v[76:79], v[12:13], v[84:85], 0
    v_mov_b32 v92, v7
    s_andn2_b64 s[80:81], s[80:81], s[84:85]
    v_mfma_f32_4x4x4_16b_bf16 v[76:79], v[10:11], v[86:87], v[76:79]
    s_mov_b64 exec, -1
    ds_read_b64 v[68:69], v92 offset:65408
    s_setprio 1
    s_waitcnt vmcnt(10)
    s_mov_b32 m0, s38
    s_nop 0
    ds_write_addtid_b32 v108 offset:0
    ds_write_addtid_b32 v109 offset:256
    ds_write_addtid_b32 v110 offset:512
    ds_write_addtid_b32 v111 offset:768
    s_waitcnt lgkmcnt(4)
    v_mfma_f32_4x4x4_16b_bf16 v[80:83], v[10:11], v[70:71], v[80:83]
    v_mfma_f32_4x4x4_16b_bf16 v[76:79], v[10:11], v[68:69], v[76:79]
    v_and_b32 v46, 0x40000000, v39
    v_bitop3_b32 v94, v36, v5, v46 bitop3:0xea
    v_and_b32 v46, 0x80000000, v39
    v_bitop3_b32 v95, v37, v5, v46 bitop3:0xea
    v_perm_b32 v15, v37, v38, s47
    v_bitop3_b32 v46, v37, 0.5, -0.5 bitop3:0xa8
    v_perm_b32 v14, v36, v38, s46
    v_bitop3_b32 v47, v36, 0.5, -0.5 bitop3:0xa8
    v_cvt_pk_bf16_f32 v80, v80, v81
    v_cvt_pk_bf16_f32 v81, v82, v83
    ds_wrxchg_rtn_b64 v[74:75], v93, v[80:81] offset:65408
    v_cvt_pk_bf16_f32 v76, v76, v77
    v_cvt_pk_bf16_f32 v77, v78, v79
    ds_wrxchg_rtn_b64 v[72:73], v92, v[76:77] offset:65408
    v_and_b32 v88, 0x0fffffff, v44
    v_mov_b32 v39, v44
    buffer_load_dwordx2 v[34:35], v88, s[8:11], 0 offen
    buffer_load_dwordx3 v[36:38], v88, s[8:11], 0 offen offset:8
    s_setprio 0
    s_waitcnt vmcnt(11)
    ds_write_addtid_b32 v112 offset:1024
    ds_write_addtid_b32 v113 offset:1280
    ds_write_addtid_b32 v114 offset:1536
    ds_write_addtid_b32 v115 offset:1792
    v_mfma_f32_4x4x4_16b_bf16 v[80:83], v[8:9], v[106:107], 0
    v_mfma_f32_4x4x4_16b_bf16 v[76:79], v[8:9], v[104:105], 0
    v_bitop3_b32 v15, v6, v15, v46 bitop3:0xca
    v_bitop3_b32 v14, v6, v14, v47 bitop3:0xca
    s_nop 1
    v_pk_mul_f32 v[80:81], v[80:81], v[14:15] op_sel:[0,1] op_sel_hi:[1,1]
    v_pk_mul_f32 v[82:83], v[82:83], v[14:15] op_sel:[0,1] op_sel_hi:[1,1]
    v_pk_mul_f32 v[76:77], v[76:77], v[14:15] op_sel:[0,0] op_sel_hi:[1,0]
    v_pk_mul_f32 v[78:79], v[78:79], v[14:15] op_sel:[0,0] op_sel_hi:[1,0]
    s_add_u32 s42, s42, 1
    s_waitcnt lgkmcnt(0)
    s_barrier
    s_bitcmp1_b32 s36, s42
    s_cbranch_scc1 L2_slow
L2_ret4:
    s_setprio 3
    buffer_load_dwordx4 v[108:111], v3, s[16:19], s40 offen offset:0
    v_cmp_ne_u64 s[50:51], v[72:73], v[68:69]
    v_cmpx_ne_u64 s[54:55], v[74:75], v[70:71]
    s_and_b64 s[82:83], s[54:55], s[80:81]
    s_cbranch_scc1 L2_c82
L2_d82:
    v_mov_b64 v[84:85], v[70:71]
    v_mov_b32 v7, v93
    v_mov_b64 v[86:87], v[74:75]
    s_or_b64 s[80:81], s[80:81], s[54:55]
    s_mov_b64 exec, s[50:51]
    s_and_b64 s[82:83], s[50:51], s[80:81]
    s_cbranch_scc1 L2_c83
L2_d83:
    v_mov_b64 v[84:85], v[68:69]
    v_mov_b32 v7, v92
    v_mov_b64 v[86:87], v[72:73]
    s_mov_b64 exec, -1
    s_or_b64 s[80:81], s[80:81], s[50:51]
    ds_read_b64 v[70:71], v95 offset:65408
    ds_read_b64 v[68:69], v94 offset:65408
    s_waitcnt vmcnt(10)
    v_and_b32 v46, 0x20000000, v21
    v_lshrrev_b32 v47, 14, v17
    v_bitop3_b32 v47, v47, v5, v46 bitop3:0xea
    ds_read_b64 v[102:103], v47
    v_bitop3_b32 v93, v17, v5, v46 bitop3:0xea
    v_and_b32 v46, 0x10000000, v21
    v_lshrrev_b32 v47, 14, v16
    v_bitop3_b32 v47, v47, v5, v46 bitop3:0xea
    ds_read_b64 v[100:101], v47
    v_bitop3_b32 v92, v16, v5, v46 bitop3:0xea
    s_waitcnt lgkmcnt(2)
    v_mfma_f32_4x4x4_16b_bf16 v[80:83], v[10:11], v[70:71], v[80:83]
    v_mfma_f32_4x4x4_16b_bf16 v[76:79], v[10:11], v[68:69], v[76:79]
    v_perm_b32 v15, v17, v20, s45
    v_bitop3_b32 v46, v17, 0.5, -0.5 bitop3:0xa8
    v_perm_b32 v14, v16, v20, s44
    v_bitop3_b32 v47, v16, 0.5, -0.5 bitop3:0xa8
    v_cvt_pk_bf16_f32 v80, v80, v81
    v_cvt_pk_bf16_f32 v81, v82, v83
    ds_wrxchg_rtn_b64 v[74:75], v95, v[80:81] offset:65408
    v_cvt_pk_bf16_f32 v76, v76, v77
    v_cvt_pk_bf16_f32 v77, v78, v79
    ds_wrxchg_rtn_b64 v[72:73], v94, v[76:77] offset:65408
    s_waitcnt lgkmcnt(2)
    v_mfma_f32_4x4x4_16b_bf16 v[80:83], v[8:9], v[102:103], 0
    v_mfma_f32_4x4x4_16b_bf16 v[76:79], v[8:9], v[100:101], 0
    v_bitop3_b32 v15, v6, v15, v46 bitop3:0xca
    v_bitop3_b32 v14, v6, v14, v47 bitop3:0xca
    v_cmp_lt_u32 s[84:85], v5, v92
    s_nop 0
    v_pk_mul_f32 v[80:81], v[80:81], v[14:15] op_sel:[0,1] op_sel_hi:[1,1]
    v_pk_mul_f32 v[82:83], v[82:83], v[14:15] op_sel:[0,1] op_sel_hi:[1,1]
    v_pk_mul_f32 v[76:77], v[76:77], v[14:15] op_sel:[0,0] op_sel_hi:[1,0]
    v_pk_mul_f32 v[78:79], v[78:79], v[14:15] op_sel:[0,0] op_sel_hi:[1,0]
    buffer_load_dwordx4 v[112:115], v3, s[16:19], s40 offen offset:1024
    s_waitcnt lgkmcnt(0)
    v_cmp_ne_u64 s[50:51], v[72:73], v[68:69]
    v_cmpx_ne_u64 s[54:55], v[74:75], v[70:71]
    s_and_b64 s[82:83], s[54:55], s[80:81]
    s_cbranch_scc1 L2_c84
L2_d84:
    v_mov_b64 v[84:85], v[70:71]
    v_mov_b32 v7, v95
    v_mov_b64 v[86:87], v[74:75]
    s_or_b64 s[80:81], s[80:81], s[54:55]
    s_mov_b64 exec, s[50:51]
    s_and_b64 s[82:83], s[50:51], s[80:81]
    s_cbranch_scc1 L2_c85
L2_d85:
    v_mov_b64 v[84:85], v[68:69]
    v_mov_b32 v7, v94
    v_mov_b64 v[86:87], v[72:73]
    s_mov_b64 exec, -1
    s_or_b64 s[80:81], s[80:81], s[50:51]
    ds_read_b64 v[70:71], v93 offset:65408
    s_and_b64 exec, s[84:85], s[80:81]
    v_mfma_f32_4x4x4_16b_bf16 v[76:79], v[12:13], v[84:85], 0
    v_mov_b32 v92, v7
    s_andn2_b64 s[80:81], s[80:81], s[84:85]
    v_mfma_f32_4x4x4_16b_bf16 v[76:79], v[10:11], v[86:87], v[76:79]
    s_mov_b64 exec, -1
    ds_read_b64 v[68:69], v92 offset:65408
    v_and_b32 v46, 0x80000000, v21
    v_lshrrev_b32 v47, 14, v19
    v_bitop3_b32 v47, v47, v5, v46 bitop3:0xea
    ds_read_b64 v[106:107], v47
    v_bitop3_b32 v95, v19, v5, v46 bitop3:0xea
    v_and_b32 v46, 0x40000000, v21
    v_lshrrev_b32 v47, 14, v18
    v_bitop3_b32 v47, v47, v5, v46 bitop3:0xea
    ds_read_b64 v[104:105], v47
    v_bitop3_b32 v94, v18, v5, v46 bitop3:0xea
    s_waitcnt lgkmcnt(2)
    v_mfma_f32_4x4x4_16b_bf16 v[80:83], v[10:11], v[70:71], v[80:83]
    v_mfma_f32_4x4x4_16b_bf16 v[76:79], v[10:11], v[68:69], v[76:79]
    v_perm_b32 v15, v19, v20, s47
    v_bitop3_b32 v46, v19, 0.5, -0.5 bitop3:0xa8
    v_perm_b32 v14, v18, v20, s46
    v_bitop3_b32 v47, v18, 0.5, -0.5 bitop3:0xa8
    v_cvt_pk_bf16_f32 v80, v80, v81
    v_cvt_pk_bf16_f32 v81, v82, v83
    ds_wrxchg_rtn_b64 v[74:75], v93, v[80:81] offset:65408
    v_cvt_pk_bf16_f32 v76, v76, v77
    v_cvt_pk_bf16_f32 v77, v78, v79
    ds_wrxchg_rtn_b64 v[72:73], v92, v[76:77] offset:65408
    v_and_b32 v88, 0x0fffffff, v40
    v_mov_b32 v21, v40
    buffer_load_dwordx2 v[16:17], v88, s[8:11], 0 offen
    buffer_load_dwordx3 v[18:20], v88, s[8:11], 0 offen offset:8
    s_setprio 2
    s_waitcnt lgkmcnt(2)
    v_mfma_f32_4x4x4_16b_bf16 v[80:83], v[8:9], v[106:107], 0
    v_mfma_f32_4x4x4_16b_bf16 v[76:79], v[8:9], v[104:105], 0
    v_bitop3_b32 v15, v6, v15, v46 bitop3:0xca
    v_bitop3_b32 v14, v6, v14, v47 bitop3:0xca
    s_nop 1
    v_pk_mul_f32 v[80:81], v[80:81], v[14:15] op_sel:[0,1] op_sel_hi:[1,1]
    v_pk_mul_f32 v[82:83], v[82:83], v[14:15] op_sel:[0,1] op_sel_hi:[1,1]
    v_pk_mul_f32 v[76:77], v[76:77], v[14:15] op_sel:[0,0] op_sel_hi:[1,0]
    v_pk_mul_f32 v[78:79], v[78:79], v[14:15] op_sel:[0,0] op_sel_hi:[1,0]
    v_sub_u16 v88, v60, v52
    v_and_b32 v89, 3, v52
    v_add3_u32 v99, v88, v89, 3
    v_and_b32 v99, -4, v99
    v_max_u32 v99, 4, v99
    v_and_b32 v97, 0xfffc, v52
    v_bfm_b32 v96, v88, v89
    v_add_u32_dpp v91, v99, v99 row_shr:1 row_mask:0xf bank_mask:0xf bound_ctrl:1
    v_mad_u32_u24 v97, v97, 5, v2
    v_cmp_lt_u32 vcc, 16, v99
    v_add_u32_dpp v91, v91, v91 row_shr:2 row_mask:0xf bank_mask:0xf bound_ctrl:1
    v_sub_u32 v98, s38, v99
    v_lshrrev_b64 v[52:53], 16, v[52:53]
    v_add_u32_dpp v91, v91, v91 row_shr:4 row_mask:0xf bank_mask:0xf bound_ctrl:1
    v_lshrrev_b64 v[60:61], 16, v[60:61]
    s_mov_b32 s101, 0
    v_add_u32_dpp v91, v91, v91 row_shr:8 row_mask:0xf bank_mask:0xf bound_ctrl:1
    s_nop 1
    v_add_u32_dpp v91, v91, v91 row_bcast:15 row_mask:0xa bank_mask:0xf
    s_nop 1
    v_add_u32_dpp v91, v91, v91 row_bcast:31 row_mask:0xc bank_mask:0xf
    v_add_u32 v98, v98, v91
    v_readlane_b32 s37, v91, 63
    s_cbranch_vccnz L2_xo86
L2_xp86:
    s_waitcnt lgkmcnt(0)
    v_cmp_ne_u64 s[50:51], v[72:73], v[68:69]
    v_cmpx_ne_u64 s[54:55], v[74:75], v[70:71]
    s_and_b64 s[82:83], s[54:55], s[80:81]
    s_cbranch_scc1 L2_c87
L2_d87:
    v_mov_b64 v[84:85], v[70:71]
    v_mov_b32 v7, v93
    v_mov_b64 v[86:87], v[74:75]
    s_or_b64 s[80:81], s[80:81], s[54:55]
    s_mov_b64 exec, s[50:51]
    s_and_b64 s[82:83], s[50:51], s[80:81]
    s_cbranch_scc1 L2_c88
L2_d88:
    v_mov_b64 v[84:85], v[68:69]
    v_mov_b32 v7, v92
    v_mov_b64 v[86:87], v[72:73]
    s_mov_b64 exec, -1
    s_or_b64 s[80:81], s[80:81], s[50:51]
    ds_read_b64 v[70:71], v95 offset:65408
    ds_read_b64 v[68:69], v94 offset:65408
    s_waitcnt vmcnt(11)
    v_and_b32 v46, 0x20000000, v27
    v_lshrrev_b32 v47, 14, v23
    v_bitop3_b32 v47, v47, v5, v46 bitop3:0xea
    ds_read_b64 v[102:103], v47
    v_bitop3_b32 v93, v23, v5, v46 bitop3:0xea
    v_and_b32 v46, 0x10000000, v27
    v_lshrrev_b32 v47, 14, v22
    v_bitop3_b32 v47, v47, v5, v46 bitop3:0xea
    ds_read_b64 v[100:101], v47
    v_bitop3_b32 v92, v22, v5, v46 bitop3:0xea
    s_waitcnt lgkmcnt(2)
    v_mfma_f32_4x4x4_16b_bf16 v[80:83], v[10:11], v[70:71], v[80:83]
    v_mfma_f32_4x4x4_16b_bf16 v[76:79], v[10:11], v[68:69], v[76:79]
    v_perm_b32 v15, v23, v26, s45
    v_bitop3_b32 v46, v23, 0.5, -0.5 bitop3:0xa8
    v_perm_b32 v14, v22, v26, s44
    v_bitop3_b32 v47, v22, 0.5, -0.5 bitop3:0xa8
    v_cvt_pk_bf16_f32 v80, v80, v81
    v_cvt_pk_bf16_f32 v81, v82, v83
    ds_wrxchg_rtn_b64 v[74:75], v95, v[80:81] offset:65408
    v_cvt_pk_bf16_f32 v76, v76, v77
    v_cvt_pk_bf16_f32 v77, v78, v79
    ds_wrxchg_rtn_b64 v[72:73], v94, v[76:77] offset:65408
    s_waitcnt lgkmcnt(2)
    v_mfma_f32_4x4x4_16b_bf16 v[80:83], v[8:9], v[102:103], 0
    v_mfma_f32_4x4x4_16b_bf16 v[76:79], v[8:9], v[100:101], 0
    v_bitop3_b32 v15, v6, v15, v46 bitop3:0xca
    v_bitop3_b32 v14, v6, v14, v47 bitop3:0xca
    v_cmp_lt_u32 s[84:85], v5, v92
    s_nop 0
    v_pk_mul_f32 v[80:81], v[80:81], v[14:15] op_sel:[0,1] op_sel_hi:[1,1]
    v_pk_mul_f32 v[82:83], v[82:83], v[14:15] op_sel:[0,1] op_sel_hi:[1,1]
    v_pk_mul_f32 v[76:77], v[76:77], v[14:15] op_sel:[0,0] op_sel_hi:[1,0]
    v_pk_mul_f32 v[78:79], v[78:79], v[14:15] op_sel:[0,0] op_sel_hi:[1,0]
    s_waitcnt lgkmcnt(0)
    v_cmp_ne_u64 s[50:51], v[72:73], v[68:69]
    v_cmpx_ne_u64 s[54:55], v[74:75], v[70:71]
    s_and_b64 s[82:83], s[54:55], s[80:81]
    s_cbranch_scc1 L2_c89
L2_d89:
    v_mov_b64 v[84:85], v[70:71]
    v_mov_b32 v7, v95
    v_mov_b64 v[86:87], v[74:75]
    s_or_b64 s[80:81], s[80:81], s[54:55]
    s_mov_b64 exec, s[50:51]
    s_and_b64 s[82:83], s[50:51], s[80:81]
    s_cbranch_scc1 L2_c90
L2_d90:
    v_mov_b64 v[84:85], v[68:69]
    v_mov_b32 v7, v94
    v_mov_b64 v[86:87], v[72:73]
    s_mov_b64 exec, -1
    s_or_b64 s[80:81], s[80:81], s[50:51]
    ds_read_b64 v[70:71], v93 offset:65408
    s_and_b64 exec, s[84:85], s[80:81]
    v_mfma_f32_4x4x4_16b_bf16 v[76:79], v[12:13], v[84:85], 0
    v_mov_b32 v92, v7
    s_andn2_b64 s[80:81], s[80:81], s[84:85]
    v_mfma_f32_4x4x4_16b_bf16 v[76:79], v[10:11], v[86:87], v[76:79]
    s_mov_b64 exec, -1
    ds_read_b64 v[68:69], v92 offset:65408
    v_and_b32 v46, 0x80000000, v27
    v_lshrrev_b32 v47, 14, v25
    v_bitop3_b32 v47, v47, v5, v46 bitop3:0xea
    ds_read_b64 v[106:107], v47
    v_bitop3_b32 v95, v25, v5, v46 bitop3:0xea
    v_and_b32 v46, 0x40000000, v27
    v_lshrrev_b32 v47, 14, v24
    v_bitop3_b32 v47, v47, v5, v46 bitop3:0xea
    ds_read_b64 v[104:105], v47
    v_bitop3_b32 v94, v24, v5, v46 bitop3:0xea
    s_waitcnt lgkmcnt(2)
    v_mfma_f32_4x4x4_16b_bf16 v[80:83], v[10:11], v[70:71], v[80:83]
    v_mfma_f32_4x4x4_16b_bf16 v[76:79], v[10:11], v[68:69], v[76:79]
    v_perm_b32 v15, v25, v26, s47
    v_bitop3_b32 v46, v25, 0.5, -0.5 bitop3:0xa8
    v_perm_b32 v14, v24, v26, s46
    v_bitop3_b32 v47, v24, 0.5, -0.5 bitop3:0xa8
    v_cvt_pk_bf16_f32 v80, v80, v81
    v_cvt_pk_bf16_f32 v81, v82, v83
    ds_wrxchg_rtn_b64 v[74:75], v93, v[80:81] offset:65408
    v_cvt_pk_bf16_f32 v76, v76, v77
    v_cvt_pk_bf16_f32 v77, v78, v79
    ds_wrxchg_rtn_b64 v[72:73], v92, v[76:77] offset:65408
    v_and_b32 v88, 0x0fffffff, v41
    v_mov_b32 v27, v41
    buffer_load_dwordx2 v[22:23], v88, s[8:11], 0 offen
    buffer_load_dwordx3 v[24:26], v88, s[8:11], 0 offen offset:8
    s_setprio 1
    s_waitcnt lgkmcnt(2)
    v_mfma_f32_4x4x4_16b_bf16 v[80:83], v[8:9], v[106:107], 0
    v_mfma_f32_4x4x4_16b_bf16 v[76:79], v[8:9], v[104:105], 0
    v_bitop3_b32 v15, v6, v15, v46 bitop3:0xca
    v_bitop3_b32 v14, v6, v14, v47 bitop3:0xca
    s_nop 1
    v_pk_mul_f32 v[80:81], v[80:81], v[14:15] op_sel:[0,1] op_sel_hi:[1,1]
    v_pk_mul_f32 v[82:83], v[82:83], v[14:15] op_sel:[0,1] op_sel_hi:[1,1]
    v_pk_mul_f32 v[76:77], v[76:77], v[14:15] op_sel:[0,0] op_sel_hi:[1,0]
    v_pk_mul_f32 v[78:79], v[78:79], v[14:15] op_sel:[0,0] op_sel_hi:[1,0]
    s_waitcnt lgkmcnt(0)
    v_cmp_ne_u64 s[50:51], v[72:73], v[68:69]
    v_cmpx_ne_u64 s[54:55], v[74:75], v[70:71]
    s_and_b64 s[82:83], s[54:55], s[80:81]
    s_cbranch_scc1 L2_c91
L2_d91:
    v_mov_b64 v[84:85], v[70:71]
    v_mov_b32 v7, v93
    v_mov_b64 v[86:87], v[74:75]
    s_or_b64 s[80:81], s[80:81], s[54:55]
    s_mov_b64 exec, s[50:51]
    s_and_b64 s[82:83], s[50:51], s[80:81]
    s_cbranch_scc1 L2_c92
L2_d92:
    v_mov_b64 v[84:85], v[68:69]
    v_mov_b32 v7, v92
    v_mov_b64 v[86:87], v[72:73]
    s_mov_b64 exec, -1
    s_or_b64 s[80:81], s[80:81], s[50:51]
    ds_read_b64 v[70:71], v95 offset:65408
    ds_read_b64 v[68:69], v94 offset:65408
    s_waitcnt vmcnt(11)
    v_and_b32 v46, 0x20000000, v33
    v_lshrrev_b32 v47, 14, v29
    v_bitop3_b32 v47, v47, v5, v46 bitop3:0xea
    ds_read_b64 v[102:103], v47
    v_bitop3_b32 v93, v29, v5, v46 bitop3:0xea
    v_and_b32 v46, 0x10000000, v33
    v_lshrrev_b32 v47, 14, v28
    v_bitop3_b32 v47, v47, v5, v46 bitop3:0xea
    ds_read_b64 v[100:101], v47
    v_bitop3_b32 v92, v28, v5, v46 bitop3:0xea
    s_waitcnt lgkmcnt(2)
    v_mfma_f32_4x4x4_16b_bf16 v[80:83], v[10:11], v[70:71], v[80:83]
    v_mfma_f32_4x4x4_16b_bf16 v[76:79], v[10:11], v[68:69], v[76:79]
    v_perm_b32 v15, v29, v32, s45
    v_bitop3_b32 v46, v29, 0.5, -0.5 bitop3:0xa8
    v_perm_b32 v14, v28, v32, s44
    v_bitop3_b32 v47, v28, 0.5, -0.5 bitop3:0xa8
    v_cvt_pk_bf16_f32 v80, v80, v81
    v_cvt_pk_bf16_f32 v81, v82, v83
    ds_wrxchg_rtn_b64 v[74:75], v95, v[80:81] offset:65408
    v_cvt_pk_bf16_f32 v76, v76, v77
    v_cvt_pk_bf16_f32 v77, v78, v79
    ds_wrxchg_rtn_b64 v[72:73], v94, v[76:77] offset:65408
    s_waitcnt lgkmcnt(2)
    v_mfma_f32_4x4x4_16b_bf16 v[80:83], v[8:9], v[102:103], 0
    v_mfma_f32_4x4x4_16b_bf16 v[76:79], v[8:9], v[100:101], 0
    v_bitop3_b32 v15, v6, v15, v46 bitop3:0xca
    v_bitop3_b32 v14, v6, v14, v47 bitop3:0xca
    v_cmp_lt_u32 s[84:85], v5, v92
    s_nop 0
    v_pk_mul_f32 v[80:81], v[80:81], v[14:15] op_sel:[0,1] op_sel_hi:[1,1]
    v_pk_mul_f32 v[82:83], v[82:83], v[14:15] op_sel:[0,1] op_sel_hi:[1,1]
    v_pk_mul_f32 v[76:77], v[76:77], v[14:15] op_sel:[0,0] op_sel_hi:[1,0]
    v_pk_mul_f32 v[78:79], v[78:79], v[14:15] op_sel:[0,0] op_sel_hi:[1,0]
    s_waitcnt lgkmcnt(0)
    v_cmp_ne_u64 s[50:51], v[72:73], v[68:69]
    v_cmpx_ne_u64 s[54:55], v[74:75], v[70:71]
    s_and_b64 s[82:83], s[54:55], s[80:81]
    s_cbranch_scc1 L2_c93
L2_d93:
    v_mov_b64 v[84:85], v[70:71]
    v_mov_b32 v7, v95
    v_mov_b64 v[86:87], v[74:75]
    s_or_b64 s[80:81], s[80:81], s[54:55]
    s_mov_b64 exec, s[50:51]
    s_and_b64 s[82:83], s[50:51], s[80:81]
    s_cbranch_scc1 L2_c94
L2_d94:
    v_mov_b64 v[84:85], v[68:69]
    v_mov_b32 v7, v94
    v_mov_b64 v[86:87], v[72:73]
    s_mov_b64 exec, -1
    s_or_b64 s[80:81], s[80:81], s[50:51]
    ds_read_b64 v[70:71], v93 offset:65408
    s_and_b64 exec, s[84:85], s[80:81]
    v_mfma_f32_4x4x4_16b_bf16 v[76:79], v[12:13], v[84:85], 0
    v_mov_b32 v92, v7
    s_andn2_b64 s[80:81], s[80:81], s[84:85]
    v_mfma_f32_4x4x4_16b_bf16 v[76:79], v[10:11], v[86:87], v[76:79]
    s_mov_b64 exec, -1
    ds_read_b64 v[68:69], v92 offset:65408
    v_and_b32 v46, 0x80000000, v33
    v_lshrrev_b32 v47, 14, v31
    v_bitop3_b32 v47, v47, v5, v46 bitop3:0xea
    ds_read_b64 v[106:107], v47
    v_bitop3_b32 v95, v31, v5, v46 bitop3:0xea
    v_and_b32 v46, 0x40000000, v33
    v_lshrrev_b32 v47, 14, v30
    v_bitop3_b32 v47, v47, v5, v46 bitop3:0xea
    ds_read_b64 v[104:105], v47
    v_bitop3_b32 v94, v30, v5, v46 bitop3:0xea
    s_waitcnt lgkmcnt(2)
    v_mfma_f32_4x4x4_16b_bf16 v[80:83], v[10:11], v[70:71], v[80:83]
    v_mfma_f32_4x4x4_16b_bf16 v[76:79], v[10:11], v[68:69], v[76:79]
    v_perm_b32 v15, v31, v32, s47
    v_bitop3_b32 v46, v31, 0.5, -0.5 bitop3:0xa8
    v_perm_b32 v14, v30, v32, s46
    v_bitop3_b32 v47, v30, 0.5, -0.5 bitop3:0xa8
    v_cvt_pk_bf16_f32 v80, v80, v81
    v_cvt_pk_bf16_f32 v81, v82, v83
    ds_wrxchg_rtn_b64 v[74:75], v93, v[80:81] offset:65408
    v_cvt_pk_bf16_f32 v76, v76, v77
    v_cvt_pk_bf16_f32 v77, v78, v79
    ds_wrxchg_rtn_b64 v[72:73], v92, v[76:77] offset:65408
    v_and_b32 v88, 0x0fffffff, v42
    v_mov_b32 v33, v42
    buffer_load_dwordx2 v[28:29], v88, s[8:11], 0 offen
    buffer_load_dwordx3 v[30:32], v88, s[8:11], 0 offen offset:8
    s_setprio 0
    s_waitcnt lgkmcnt(2)
    v_mfma_f32_4x4x4_16b_bf16 v[80:83], v[8:9], v[106:107], 0
    v_mfma_f32_4x4x4_16b_bf16 v[76:79], v[8:9], v[104:105], 0
    v_bitop3_b32 v15, v6, v15, v46 bitop3:0xca
    v_bitop3_b32 v14, v6, v14, v47 bitop3:0xca
    s_nop 1
    v_pk_mul_f32 v[80:81], v[80:81], v[14:15] op_sel:[0,1] op_sel_hi:[1,1]
    v_pk_mul_f32 v[82:83], v[82:83], v[14:15] op_sel:[0,1] op_sel_hi:[1,1]
    v_pk_mul_f32 v[76:77], v[76:77], v[14:15] op_sel:[0,0] op_sel_hi:[1,0]
    v_pk_mul_f32 v[78:79], v[78:79], v[14:15] op_sel:[0,0] op_sel_hi:[1,0]
    s_add_u32 s40, s40, 0x50000
    s_waitcnt lgkmcnt(0)
    v_cmp_ne_u64 s[50:51], v[72:73], v[68:69]
    v_cmpx_ne_u64 s[54:55], v[74:75], v[70:71]
    s_and_b64 s[82:83], s[54:55], s[80:81]
    s_cbranch_scc1 L2_c95
L2_d95:
    v_mov_b64 v[84:85], v[70:71]
    v_mov_b32 v7, v93
    v_mov_b64 v[86:87], v[74:75]
    s_or_b64 s[80:81], s[80:81], s[54:55]
    s_mov_b64 exec, s[50:51]
    s_and_b64 s[82:83], s[50:51], s[80:81]
    s_cbranch_scc1 L2_c96
L2_d96:
    v_mov_b64 v[84:85], v[68:69]
    v_mov_b32 v7, v92
    v_mov_b64 v[86:87], v[72:73]
    s_mov_b64 exec, -1
    s_or_b64 s[80:81], s[80:81], s[50:51]
    ds_read_b64 v[70:71], v95 offset:65408
    ds_read_b64 v[68:69], v94 offset:65408
    s_waitcnt vmcnt(8)
    v_and_b32 v46, 0x20000000, v39
    v_lshrrev_b32 v47, 14, v35
    v_bitop3_b32 v47, v47, v5, v46 bitop3:0xea
    ds_read_b64 v[102:103], v47
    v_bitop3_b32 v93, v35, v5, v46 bitop3:0xea
    v_and_b32 v46, 0x10000000, v39
    v_lshrrev_b32 v47, 14, v34
    v_bitop3_b32 v47, v47, v5, v46 bitop3:0xea
    ds_read_b64 v[100:101], v47
    v_bitop3_b32 v92, v34, v5, v46 bitop3:0xea
    v_and_b32 v46, 0x80000000, v39
    v_lshrrev_b32 v47, 14, v37
    v_bitop3_b32 v47, v47, v5, v46 bitop3:0xea
    ds_read_b64 v[106:107], v47
    v_and_b32 v46, 0x40000000, v39
    v_lshrrev_b32 v47, 14, v36
    v_bitop3_b32 v47, v47, v5, v46 bitop3:0xea
    ds_read_b64 v[104:105], v47
    s_waitcnt lgkmcnt(4)
    v_mfma_f32_4x4x4_16b_bf16 v[80:83], v[10:11], v[70:71], v[80:83]
    v_mfma_f32_4x4x4_16b_bf16 v[76:79], v[10:11], v[68:69], v[76:79]
    v_perm_b32 v15, v35, v38, s45
    v_bitop3_b32 v46, v35, 0.5, -0.5 bitop3:0xa8
    v_perm_b32 v14, v34, v38, s44
    v_bitop3_b32 v47, v34, 0.5, -0.5 bitop3:0xa8
    v_cvt_pk_bf16_f32 v80, v80, v81
    v_cvt_pk_bf16_f32 v81, v82, v83
    ds_wrxchg_rtn_b64 v[74:75], v95, v[80:81] offset:65408
    v_cvt_pk_bf16_f32 v76, v76, v77
    v_cvt_pk_bf16_f32 v77, v78, v79
    ds_wrxchg_rtn_b64 v[72:73], v94, v[76:77] offset:65408
    s_waitcnt lgkmcnt(2)
    s_barrier
    s_setprio 3
    s_mov_b32 m0, s100
    s_nop 0
    ds_write_addtid_b32 v116 offset:32768
    ds_write_addtid_b32 v117 offset:33024
    ds_write_addtid_b32 v118 offset:33280
    ds_write_addtid_b32 v119 offset:33536
    buffer_load_dwordx4 v[116:119], v3, s[16:19], s40 offen offset:2048
    ds_write_addtid_b32 v120 offset:33792
    ds_write_addtid_b32 v121 offset:34048
    ds_write_addtid_b32 v122 offset:34304
    ds_write_addtid_b32 v123 offset:34560
    buffer_load_dwordx4 v[120:123], v3, s[16:19], s40 offen offset:3072
    v_mfma_f32_4x4x4_16b_bf16 v[80:83], v[8:9], v[102:103], 0
    v_mfma_f32_4x4x4_16b_bf16 v[76:79], v[8:9], v[100:101], 0
    v_bitop3_b32 v15, v6, v15, v46 bitop3:0xca
    v_bitop3_b32 v14, v6, v14, v47 bitop3:0xca
    v_cmp_lt_u32 s[84:85], v5, v92
    s_nop 0
    v_pk_mul_f32 v[80:81], v[80:81], v[14:15] op_sel:[0,1] op_sel_hi:[1,1]
    v_pk_mul_f32 v[82:83], v[82:83], v[14:15] op_sel:[0,1] op_sel_hi:[1,1]
    v_pk_mul_f32 v[76:77], v[76:77], v[14:15] op_sel:[0,0] op_sel_hi:[1,0]
    v_pk_mul_f32 v[78:79], v[78:79], v[14:15] op_sel:[0,0] op_sel_hi:[1,0]
    v_mov_b32 v44, v43
    s_cmp_gt_u32 s37, 1024
    s_cbranch_scc1 L2_xs97
    s_cmp_lg_u32 s101, 0
    s_cbranch_scc1 L2_xa97
L2_xb97:
    v_lshlrev_b32 v89, 16, v96
    v_add_u32 v90, 60, v97
    v_bitop3_b32 v90, v89, v45, v90 bitop3:0x6a
    ds_write_b32 v98, v90 offset:12
    v_lshlrev_b32 v89, 20, v96
    v_add_u32 v90, 40, v97
    v_bitop3_b32 v90, v89, v45, v90 bitop3:0x6a
    ds_write_b32 v98, v90 offset:8
    v_lshlrev_b32 v89, 24, v96
    v_add_u32 v90, 20, v97
    v_bitop3_b32 v90, v89, v45, v90 bitop3:0x6a
    ds_write_b32 v98, v90 offset:4
    v_lshlrev_b32 v89, 28, v96
    v_bitop3_b32 v90, v89, v45, v97 bitop3:0x6a
    ds_write_b32 v98, v90 offset:0
    v_mov_b32_dpp v91, v64 quad_perm:[1,1,1,1] row_mask:0xf bank_mask:0xf
    v_and_b32 v89, 3, v91
    v_and_b32 v97, 0xfffc, v91
    v_sub_u16_dpp v88, v64, v91 quad_perm:[3,3,3,3] row_mask:0xf bank_mask:0xf
    v_mad_u32_u24 v97, v97, 5, v4
    v_add_u32 v99, v88, v89
    v_bfm_b32 v96, v88, v89
    v_cmp_lt_u32 s[58:59], 16, v99
    v_lshlrev_b32 v89, v1, v96
    v_and_b32 v89, v45, v89
    v_cmp_ne_u32 vcc, 0, v89
    v_xor_b32 v90, v97, v89
    s_add_u32 s3, s37, s38
    v_mbcnt_lo_u32_b32 v98, vcc_lo, 0
    v_mbcnt_hi_u32_b32 v98, vcc_hi, v98
    s_bcnt1_i32_b64 s41, vcc
    v_lshl_add_u32 v98, v98, 2, s3
    s_mov_b64 exec, vcc
    ds_write_b32 v98, v90
    s_mov_b64 exec, -1
    s_lshl2_add_u32 s37, s41, s37
    s_cmp_lg_u64 s[58:59], 0
    s_cbranch_scc1 L2_xe97
L2_xr97:
    v_add_u32 v98, s37, v0
    v_mov_b32 v90, -1
    ds_write_b32 v98, v90
    ds_read2st64_b32 v[40:41], v0 offset0:0 offset1:1
    ds_read2st64_b32 v[42:43], v0 offset0:2 offset1:3
    s_sub_u32 s3, s37, 768
    s_cmp_gt_u32 s3, 256
    s_cbranch_scc1 L2_xf97
L2_xg97:
    s_setprio 2
    ds_write_addtid_b32 v124 offset:34816
    ds_write_addtid_b32 v125 offset:35072
    ds_write_addtid_b32 v126 offset:35328
    ds_write_addtid_b32 v127 offset:35584
    s_add_u32 s3, s40, 4096
    buffer_load_dwordx4 v[124:127], v3, s[16:19], s3 offen
    s_waitcnt lgkmcnt(14)
    v_cmp_ne_u64 s[50:51], v[72:73], v[68:69]
    v_cmpx_ne_u64 s[54:55], v[74:75], v[70:71]
    s_and_b64 s[82:83], s[54:55], s[80:81]
    s_cbranch_scc1 L2_c98
L2_d98:
    v_mov_b64 v[84:85], v[70:71]
    v_mov_b32 v7, v95
    v_mov_b64 v[86:87], v[74:75]
    s_or_b64 s[80:81], s[80:81], s[54:55]
    s_mov_b64 exec, s[50:51]
    s_and_b64 s[82:83], s[50:51], s[80:81]
    s_cbranch_scc1 L2_c99
L2_d99:
    v_mov_b64 v[84:85], v[68:69]
    v_mov_b32 v7, v94
    v_mov_b64 v[86:87], v[72:73]
    s_mov_b64 exec, -1
    s_or_b64 s[80:81], s[80:81], s[50:51]
    ds_read_b64 v[70:71], v93 offset:65408
    s_and_b64 exec, s[84:85], s[80:81]
    v_mfma_f32_4x4x4_16b_bf16 v[76:79], v[12:13], v[84:85], 0
    v_mov_b32 v92, v7
    s_andn2_b64 s[80:81], s[80:81], s[84:85]
    v_mfma_f32_4x4x4_16b_bf16 v[76:79], v[10:11], v[86:87], v[76:79]
    s_mov_b64 exec, -1
    ds_read_b64 v[68:69], v92 offset:65408
    s_setprio 1
    s_waitcnt vmcnt(10)
    s_mov_b32 m0, s38
    s_nop 0
    ds_write_addtid_b32 v108 offset:0
    ds_write_addtid_b32 v109 offset:256
    ds_write_addtid_b32 v110 offset:512
    ds_write_addtid_b32 v111 offset:768
    s_waitcnt lgkmcnt(4)
    v_mfma_f32_4x4x4_16b_bf16 v[80:83], v[10:11], v[70:71], v[80:83]
    v_mfma_f32_4x4x4_16b_bf16 v[76:79], v[10:11], v[68:69], v[76:79]
    v_and_b32 v46, 0x40000000, v39
    v_bitop3_b32 v94, v36, v5, v46 bitop3:0xea
    v_and_b32 v46, 0x80000000, v39
    v_bitop3_b32 v95, v37, v5, v46 bitop3:0xea
    v_perm_b32 v15, v37, v38, s47
    v_bitop3_b32 v46, v37, 0.5, -0.5 bitop3:0xa8
    v_perm_b32 v14, v36, v38, s46
    v_bitop3_b32 v47, v36, 0.5, -0.5 bitop3:0xa8
    v_cvt_pk_bf16_f32 v80, v80, v81
    v_cvt_pk_bf16_f32 v81, v82, v83
    ds_wrxchg_rtn_b64 v[74:75], v93, v[80:81] offset:65408
    v_cvt_pk_bf16_f32 v76, v76, v77
    v_cvt_pk_bf16_f32 v77, v78, v79
    ds_wrxchg_rtn_b64 v[72:73], v92, v[76:77] offset:65408
    v_and_b32 v88, 0x0fffffff, v44
    v_mov_b32 v39, v44
    buffer_load_dwordx2 v[34:35], v88, s[8:11], 0 offen
    buffer_load_dwordx3 v[36:38], v88, s[8:11], 0 offen offset:8
    s_setprio 0
    s_waitcnt vmcnt(11)
    ds_write_addtid_b32 v112 offset:1024
    ds_write_addtid_b32 v113 offset:1280
    ds_write_addtid_b32 v114 offset:1536
    ds_write_addtid_b32 v115 offset:1792
    v_mfma_f32_4x4x4_16b_bf16 v[80:83], v[8:9], v[106:107], 0
    v_mfma_f32_4x4x4_16b_bf16 v[76:79], v[8:9], v[104:105], 0
    v_bitop3_b32 v15, v6, v15, v46 bitop3:0xca
    v_bitop3_b32 v14, v6, v14, v47 bitop3:0xca
    s_nop 1
    v_pk_mul_f32 v[80:81], v[80:81], v[14:15] op_sel:[0,1] op_sel_hi:[1,1]
    v_pk_mul_f32 v[82:83], v[82:83], v[14:15] op_sel:[0,1] op_sel_hi:[1,1]
    v_pk_mul_f32 v[76:77], v[76:77], v[14:15] op_sel:[0,0] op_sel_hi:[1,0]
    v_pk_mul_f32 v[78:79], v[78:79], v[14:15] op_sel:[0,0] op_sel_hi:[1,0]
    s_add_u32 s42, s42, 1
    s_waitcnt lgkmcnt(0)
    s_barrier
    s_bitcmp1_b32 s36, s42
    s_cbranch_scc1 L2_slow
L2_ret5:
    s_setprio 3
    buffer_load_dwordx4 v[108:111], v3, s[16:19], s40 offen offset:0
    v_cmp_ne_u64 s[50:51], v[72:73], v[68:69]
    v_cmpx_ne_u64 s[54:55], v[74:75], v[70:71]
    s_and_b64 s[82:83], s[54:55], s[80:81]
    s_cbranch_scc1 L2_c100
L2_d100:
    v_mov_b64 v[84:85], v[70:71]
    v_mov_b32 v7, v93
    v_mov_b64 v[86:87], v[74:75]
    s_or_b64 s[80:81], s[80:81], s[54:55]
    s_mov_b64 exec, s[50:51]
    s_and_b64 s[82:83], s[50:51], s[80:81]
    s_cbranch_scc1 L2_c101
L2_d101:
    v_mov_b64 v[84:85], v[68:69]
    v_mov_b32 v7, v92
    v_mov_b64 v[86:87], v[72:73]
    s_mov_b64 exec, -1
    s_or_b64 s[80:81], s[80:81], s[50:51]
    ds_read_b64 v[70:71], v95 offset:65408
    ds_read_b64 v[68:69], v94 offset:65408
    s_waitcnt vmcnt(10)
    v_and_b32 v46, 0x20000000, v21
    v_lshrrev_b32 v47, 14, v17
    v_bitop3_b32 v47, v47, v5, v46 bitop3:0xea
    ds_read_b64 v[102:103], v47
    v_bitop3_b32 v93, v17, v5, v46 bitop3:0xea
    v_and_b32 v46, 0x10000000, v21
    v_lshrrev_b32 v47, 14, v16
    v_bitop3_b32 v47, v47, v5, v46 bitop3:0xea
    ds_read_b64 v[100:101], v47
    v_bitop3_b32 v92, v16, v5, v46 bitop3:0xea
    s_waitcnt lgkmcnt(2)
    v_mfma_f32_4x4x4_16b_bf16 v[80:83], v[10:11], v[70:71], v[80:83]
    v_mfma_f32_4x4x4_16b_bf16 v[76:79], v[10:11], v[68:69], v[76:79]
    v_perm_b32 v15, v17, v20, s45
    v_bitop3_b32 v46, v17, 0.5, -0.5 bitop3:0xa8
    v_perm_b32 v14, v16, v20, s44
    v_bitop3_b32 v47, v16, 0.5, -0.5 bitop3:0xa8
    v_cvt_pk_bf16_f32 v80, v80, v81
    v_cvt_pk_bf16_f32 v81, v82, v83
    ds_wrxchg_rtn_b64 v[74:75], v95, v[80:81] offset:65408
    v_cvt_pk_bf16_f32 v76, v76, v77
    v_cvt_pk_bf16_f32 v77, v78, v79
    ds_wrxchg_rtn_b64 v[72:73], v94, v[76:77] offset:65408
    s_waitcnt lgkmcnt(2)
    v_mfma_f32_4x4x4_16b_bf16 v[80:83], v[8:9], v[102:103], 0
    v_mfma_f32_4x4x4_16b_bf16 v[76:79], v[8:9], v[100:101], 0
    v_bitop3_b32 v15, v6, v15, v46 bitop3:0xca
    v_bitop3_b32 v14, v6, v14, v47 bitop3:0xca
    v_cmp_lt_u32 s[84:85], v5, v92
    s_nop 0
    v_pk_mul_f32 v[80:81], v[80:81], v[14:15] op_sel:[0,1] op_sel_hi:[1,1]
    v_pk_mul_f32 v[82:83], v[82:83], v[14:15] op_sel:[0,1] op_sel_hi:[1,1]
    v_pk_mul_f32 v[76:77], v[76:77], v[14:15] op_sel:[0,0] op_sel_hi:[1,0]
    v_pk_mul_f32 v[78:79], v[78:79], v[14:15] op_sel:[0,0] op_sel_hi:[1,0]
    buffer_load_dwordx4 v[112:115], v3, s[16:19], s40 offen offset:1024
    s_waitcnt lgkmcnt(0)
    v_cmp_ne_u64 s[50:51], v[72:73], v[68:69]
    v_cmpx_ne_u64 s[54:55], v[74:75], v[70:71]
    s_and_b64 s[82:83], s[54:55], s[80:81]
    s_cbranch_scc1 L2_c102
L2_d102:
    v_mov_b64 v[84:85], v[70:71]
    v_mov_b32 v7, v95
    v_mov_b64 v[86:87], v[74:75]
    s_or_b64 s[80:81], s[80:81], s[54:55]
    s_mov_b64 exec, s[50:51]
    s_and_b64 s[82:83], s[50:51], s[80:81]
    s_cbranch_scc1 L2_c103
L2_d103:
    v_mov_b64 v[84:85], v[68:69]
    v_mov_b32 v7, v94
    v_mov_b64 v[86:87], v[72:73]
    s_mov_b64 exec, -1
    s_or_b64 s[80:81], s[80:81], s[50:51]
    ds_read_b64 v[70:71], v93 offset:65408
    s_and_b64 exec, s[84:85], s[80:81]
    v_mfma_f32_4x4x4_16b_bf16 v[76:79], v[12:13], v[84:85], 0
    v_mov_b32 v92, v7
    s_andn2_b64 s[80:81], s[80:81], s[84:85]
    v_mfma_f32_4x4x4_16b_bf16 v[76:79], v[10:11], v[86:87], v[76:79]
    s_mov_b64 exec, -1
    ds_read_b64 v[68:69], v92 offset:65408
    v_and_b32 v46, 0x80000000, v21
    v_lshrrev_b32 v47, 14, v19
    v_bitop3_b32 v47, v47, v5, v46 bitop3:0xea
    ds_read_b64 v[106:107], v47
    v_bitop3_b32 v95, v19, v5, v46 bitop3:0xea
    v_and_b32 v46, 0x40000000, v21
    v_lshrrev_b32 v47, 14, v18
    v_bitop3_b32 v47, v47, v5, v46 bitop3:0xea
    ds_read_b64 v[104:105], v47
    v_bitop3_b32 v94, v18, v5, v46 bitop3:0xea
    s_waitcnt lgkmcnt(2)
    v_mfma_f32_4x4x4_16b_bf16 v[80:83], v[10:11], v[70:71], v[80:83]
    v_mfma_f32_4x4x4_16b_bf16 v[76:79], v[10:11], v[68:69], v[76:79]
    v_perm_b32 v15, v19, v20, s47
    v_bitop3_b32 v46, v19, 0.5, -0.5 bitop3:0xa8
    v_perm_b32 v14, v18, v20, s46
    v_bitop3_b32 v47, v18, 0.5, -0.5 bitop3:0xa8
    v_cvt_pk_bf16_f32 v80, v80, v81
    v_cvt_pk_bf16_f32 v81, v82, v83
    ds_wrxchg_rtn_b64 v[74:75], v93, v[80:81] offset:65408
    v_cvt_pk_bf16_f32 v76, v76, v77
    v_cvt_pk_bf16_f32 v77, v78, v79
    ds_wrxchg_rtn_b64 v[72:73], v92, v[76:77] offset:65408
    v_and_b32 v88, 0x0fffffff, v40
    v_mov_b32 v21, v40
    buffer_load_dwordx2 v[16:17], v88, s[8:11], 0 offen
    buffer_load_dwordx3 v[18:20], v88, s[8:11], 0 offen offset:8
    s_setprio 2
    s_waitcnt lgkmcnt(2)
    v_mfma_f32_4x4x4_16b_bf16 v[80:83], v[8:9], v[106:107], 0
    v_mfma_f32_4x4x4_16b_bf16 v[76:79], v[8:9], v[104:105], 0
    v_bitop3_b32 v15, v6, v15, v46 bitop3:0xca
    v_bitop3_b32 v14, v6, v14, v47 bitop3:0xca
    s_nop 1
    v_pk_mul_f32 v[80:81], v[80:81], v[14:15] op_sel:[0,1] op_sel_hi:[1,1]
    v_pk_mul_f32 v[82:83], v[82:83], v[14:15] op_sel:[0,1] op_sel_hi:[1,1]
    v_pk_mul_f32 v[76:77], v[76:77], v[14:15] op_sel:[0,0] op_sel_hi:[1,0]
    v_pk_mul_f32 v[78:79], v[78:79], v[14:15] op_sel:[0,0] op_sel_hi:[1,0]
    v_sub_u16 v88, v62, v54
    v_and_b32 v89, 3, v54
    v_add3_u32 v99, v88, v89, 3
    v_and_b32 v99, -4, v99
    v_max_u32 v99, 4, v99
    v_and_b32 v97, 0xfffc, v54
    v_bfm_b32 v96, v88, v89
    v_add_u32_dpp v91, v99, v99 row_shr:1 row_mask:0xf bank_mask:0xf bound_ctrl:1
    v_mad_u32_u24 v97, v97, 5, v2
    v_cmp_lt_u32 vcc, 16, v99
    v_add_u32_dpp v91, v91, v91 row_shr:2 row_mask:0xf bank_mask:0xf bound_ctrl:1
    v_sub_u32 v98, s38, v99
    v_lshrrev_b64 v[54:55], 16, v[54:55]
    v_add_u32_dpp v91, v91, v91 row_shr:4 row_mask:0xf bank_mask:0xf bound_ctrl:1
    v_lshrrev_b64 v[62:63], 16, v[62:63]
    s_mov_b32 s101, 0
    v_add_u32_dpp v91, v91, v91 row_shr:8 row_mask:0xf bank_mask:0xf bound_ctrl:1
    s_nop 1
    v_add_u32_dpp v91, v91, v91 row_bcast:15 row_mask:0xa bank_mask:0xf
    s_nop 1
    v_add_u32_dpp v91, v91, v91 row_bcast:31 row_mask:0xc bank_mask:0xf
    v_add_u32 v98, v98, v91
    v_readlane_b32 s37, v91, 63
    s_cbranch_vccnz L2_xo104
L2_xp104:
    s_waitcnt lgkmcnt(0)
    v_cmp_ne_u64 s[50:51], v[72:73], v[68:69]
    v_cmpx_ne_u64 s[54:55], v[74:75], v[70:71]
    s_and_b64 s[82:83], s[54:55], s[80:81]
    s_cbranch_scc1 L2_c105
L2_d105:
    v_mov_b64 v[84:85], v[70:71]
    v_mov_b32 v7, v93
    v_mov_b64 v[86:87], v[74:75]
    s_or_b64 s[80:81], s[80:81], s[54:55]
    s_mov_b64 exec, s[50:51]
    s_and_b64 s[82:83], s[50:51], s[80:81]
    s_cbranch_scc1 L2_c106
L2_d106:
    v_mov_b64 v[84:85], v[68:69]
    v_mov_b32 v7, v92
    v_mov_b64 v[86:87], v[72:73]
    s_mov_b64 exec, -1
    s_or_b64 s[80:81], s[80:81], s[50:51]
    ds_read_b64 v[70:71], v95 offset:65408
    ds_read_b64 v[68:69], v94 offset:65408
    s_waitcnt vmcnt(11)
    v_and_b32 v46, 0x20000000, v27
    v_lshrrev_b32 v47, 14, v23
    v_bitop3_b32 v47, v47, v5, v46 bitop3:0xea
    ds_read_b64 v[102:103], v47
    v_bitop3_b32 v93, v23, v5, v46 bitop3:0xea
    v_and_b32 v46, 0x10000000, v27
    v_lshrrev_b32 v47, 14, v22
    v_bitop3_b32 v47, v47, v5, v46 bitop3:0xea
    ds_read_b64 v[100:101], v47
    v_bitop3_b32 v92, v22, v5, v46 bitop3:0xea
    s_waitcnt lgkmcnt(2)
    v_mfma_f32_4x4x4_16b_bf16 v[80:83], v[10:11], v[70:71], v[80:83]
    v_mfma_f32_4x4x4_16b_bf16 v[76:79], v[10:11], v[68:69], v[76:79]
    v_perm_b32 v15, v23, v26, s45
    v_bitop3_b32 v46, v23, 0.5, -0.5 bitop3:0xa8
    v_perm_b32 v14, v22, v26, s44
    v_bitop3_b32 v47, v22, 0.5, -0.5 bitop3:0xa8
    v_cvt_pk_bf16_f32 v80, v80, v81
    v_cvt_pk_bf16_f32 v81, v82, v83
    ds_wrxchg_rtn_b64 v[74:75], v95, v[80:81] offset:65408
    v_cvt_pk_bf16_f32 v76, v76, v77
    v_cvt_pk_bf16_f32 v77, v78, v79
    ds_wrxchg_rtn_b64 v[72:73], v94, v[76:77] offset:65408
    s_waitcnt lgkmcnt(2)
    v_mfma_f32_4x4x4_16b_bf16 v[80:83], v[8:9], v[102:103], 0
    v_mfma_f32_4x4x4_16b_bf16 v[76:79], v[8:9], v[100:101], 0
    v_bitop3_b32 v15, v6, v15, v46 bitop3:0xca
    v_bitop3_b32 v14, v6, v14, v47 bitop3:0xca
    v_cmp_lt_u32 s[84:85], v5, v92
    s_nop 0
    v_pk_mul_f32 v[80:81], v[80:81], v[14:15] op_sel:[0,1] op_sel_hi:[1,1]
    v_pk_mul_f32 v[82:83], v[82:83], v[14:15] op_sel:[0,1] op_sel_hi:[1,1]
    v_pk_mul_f32 v[76:77], v[76:77], v[14:15] op_sel:[0,0] op_sel_hi:[1,0]
    v_pk_mul_f32 v[78:79], v[78:79], v[14:15] op_sel:[0,0] op_sel_hi:[1,0]
    s_waitcnt lgkmcnt(0)
    v_cmp_ne_u64 s[50:51], v[72:73], v[68:69]
    v_cmpx_ne_u64 s[54:55], v[74:75], v[70:71]
    s_and_b64 s[82:83], s[54:55], s[80:81]
    s_cbranch_scc1 L2_c107
L2_d107:
    v_mov_b64 v[84:85], v[70:71]
    v_mov_b32 v7, v95
    v_mov_b64 v[86:87], v[74:75]
    s_or_b64 s[80:81], s[80:81], s[54:55]
    s_mov_b64 exec, s[50:51]
    s_and_b64 s[82:83], s[50:51], s[80:81]
    s_cbranch_scc1 L2_c108
L2_d108:
    v_mov_b64 v[84:85], v[68:69]
    v_mov_b32 v7, v94
    v_mov_b64 v[86:87], v[72:73]
    s_mov_b64 exec, -1
    s_or_b64 s[80:81], s[80:81], s[50:51]
    ds_read_b64 v[70:71], v93 offset:65408
    s_and_b64 exec, s[84:85], s[80:81]
    v_mfma_f32_4x4x4_16b_bf16 v[76:79], v[12:13], v[84:85], 0
    v_mov_b32 v92, v7
    s_andn2_b64 s[80:81], s[80:81], s[84:85]
    v_mfma_f32_4x4x4_16b_bf16 v[76:79], v[10:11], v[86:87], v[76:79]
    s_mov_b64 exec, -1
    ds_read_b64 v[68:69], v92 offset:65408
    v_and_b32 v46, 0x80000000, v27
    v_lshrrev_b32 v47, 14, v25
    v_bitop3_b32 v47, v47, v5, v46 bitop3:0xea
    ds_read_b64 v[106:107], v47
    v_bitop3_b32 v95, v25, v5, v46 bitop3:0xea
    v_and_b32 v46, 0x40000000, v27
    v_lshrrev_b32 v47, 14, v24
    v_bitop3_b32 v47, v47, v5, v46 bitop3:0xea
    ds_read_b64 v[104:105], v47
    v_bitop3_b32 v94, v24, v5, v46 bitop3:0xea
    s_waitcnt lgkmcnt(2)
    v_mfma_f32_4x4x4_16b_bf16 v[80:83], v[10:11], v[70:71], v[80:83]
    v_mfma_f32_4x4x4_16b_bf16 v[76:79], v[10:11], v[68:69], v[76:79]
    v_perm_b32 v15, v25, v26, s47
    v_bitop3_b32 v46, v25, 0.5, -0.5 bitop3:0xa8
    v_perm_b32 v14, v24, v26, s46
    v_bitop3_b32 v47, v24, 0.5, -0.5 bitop3:0xa8
    v_cvt_pk_bf16_f32 v80, v80, v81
    v_cvt_pk_bf16_f32 v81, v82, v83
    ds_wrxchg_rtn_b64 v[74:75], v93, v[80:81] offset:65408
    v_cvt_pk_bf16_f32 v76, v76, v77
    v_cvt_pk_bf16_f32 v77, v78, v79
    ds_wrxchg_rtn_b64 v[72:73], v92, v[76:77] offset:65408
    v_and_b32 v88, 0x0fffffff, v41
    v_mov_b32 v27, v41
    buffer_load_dwordx2 v[22:23], v88, s[8:11], 0 offen
    buffer_load_dwordx3 v[24:26], v88, s[8:11], 0 offen offset:8
    s_setprio 1
    s_waitcnt lgkmcnt(2)
    v_mfma_f32_4x4x4_16b_bf16 v[80:83], v[8:9], v[106:107], 0
    v_mfma_f32_4x4x4_16b_bf16 v[76:79], v[8:9], v[104:105], 0
    v_bitop3_b32 v15, v6, v15, v46 bitop3:0xca
    v_bitop3_b32 v14, v6, v14, v47 bitop3:0xca
    s_nop 1
    v_pk_mul_f32 v[80:81], v[80:81], v[14:15] op_sel:[0,1] op_sel_hi:[1,1]
    v_pk_mul_f32 v[82:83], v[82:83], v[14:15] op_sel:[0,1] op_sel_hi:[1,1]
    v_pk_mul_f32 v[76:77], v[76:77], v[14:15] op_sel:[0,0] op_sel_hi:[1,0]
    v_pk_mul_f32 v[78:79], v[78:79], v[14:15] op_sel:[0,0] op_sel_hi:[1,0]
    s_waitcnt lgkmcnt(0)
    v_cmp_ne_u64 s[50:51], v[72:73], v[68:69]
    v_cmpx_ne_u64 s[54:55], v[74:75], v[70:71]
    s_and_b64 s[82:83], s[54:55], s[80:81]
    s_cbranch_scc1 L2_c109
L2_d109:
    v_mov_b64 v[84:85], v[70:71]
    v_mov_b32 v7, v93
    v_mov_b64 v[86:87], v[74:75]
    s_or_b64 s[80:81], s[80:81], s[54:55]
    s_mov_b64 exec, s[50:51]
    s_and_b64 s[82:83], s[50:51], s[80:81]
    s_cbranch_scc1 L2_c110
L2_d110:
    v_mov_b64 v[84:85], v[68:69]
    v_mov_b32 v7, v92
    v_mov_b64 v[86:87], v[72:73]
    s_mov_b64 exec, -1
    s_or_b64 s[80:81], s[80:81], s[50:51]
    ds_read_b64 v[70:71], v95 offset:65408
    ds_read_b64 v[68:69], v94 offset:65408
    s_waitcnt vmcnt(11)
    v_and_b32 v46, 0x20000000, v33
    v_lshrrev_b32 v47, 14, v29
    v_bitop3_b32 v47, v47, v5, v46 bitop3:0xea
    ds_read_b64 v[102:103], v47
    v_bitop3_b32 v93, v29, v5, v46 bitop3:0xea
    v_and_b32 v46, 0x10000000, v33
    v_lshrrev_b32 v47, 14, v28
    v_bitop3_b32 v47, v47, v5, v46 bitop3:0xea
    ds_read_b64 v[100:101], v47
    v_bitop3_b32 v92, v28, v5, v46 bitop3:0xea
    s_waitcnt lgkmcnt(2)
    v_mfma_f32_4x4x4_16b_bf16 v[80:83], v[10:11], v[70:71], v[80:83]
    v_mfma_f32_4x4x4_16b_bf16 v[76:79], v[10:11], v[68:69], v[76:79]
    v_perm_b32 v15, v29, v32, s45
    v_bitop3_b32 v46, v29, 0.5, -0.5 bitop3:0xa8
    v_perm_b32 v14, v28, v32, s44
    v_bitop3_b32 v47, v28, 0.5, -0.5 bitop3:0xa8
    v_cvt_pk_bf16_f32 v80, v80, v81
    v_cvt_pk_bf16_f32 v81, v82, v83
    ds_wrxchg_rtn_b64 v[74:75], v95, v[80:81] offset:65408
    v_cvt_pk_bf16_f32 v76, v76, v77
    v_cvt_pk_bf16_f32 v77, v78, v79
    ds_wrxchg_rtn_b64 v[72:73], v94, v[76:77] offset:65408
    s_waitcnt lgkmcnt(2)
    v_mfma_f32_4x4x4_16b_bf16 v[80:83], v[8:9], v[102:103], 0
    v_mfma_f32_4x4x4_16b_bf16 v[76:79], v[8:9], v[100:101], 0
    v_bitop3_b32 v15, v6, v15, v46 bitop3:0xca
    v_bitop3_b32 v14, v6, v14, v47 bitop3:0xca
    v_cmp_lt_u32 s[84:85], v5, v92
    s_nop 0
    v_pk_mul_f32 v[80:81], v[80:81], v[14:15] op_sel:[0,1] op_sel_hi:[1,1]
    v_pk_mul_f32 v[82:83], v[82:83], v[14:15] op_sel:[0,1] op_sel_hi:[1,1]
    v_pk_mul_f32 v[76:77], v[76:77], v[14:15] op_sel:[0,0] op_sel_hi:[1,0]
    v_pk_mul_f32 v[78:79], v[78:79], v[14:15] op_sel:[0,0] op_sel_hi:[1,0]
    s_waitcnt lgkmcnt(0)
    v_cmp_ne_u64 s[50:51], v[72:73], v[68:69]
    v_cmpx_ne_u64 s[54:55], v[74:75], v[70:71]
    s_and_b64 s[82:83], s[54:55], s[80:81]
    s_cbranch_scc1 L2_c111
L2_d111:
    v_mov_b64 v[84:85], v[70:71]
    v_mov_b32 v7, v95
    v_mov_b64 v[86:87], v[74:75]
    s_or_b64 s[80:81], s[80:81], s[54:55]
    s_mov_b64 exec, s[50:51]
    s_and_b64 s[82:83], s[50:51], s[80:81]
    s_cbranch_scc1 L2_c112
L2_d112:
    v_mov_b64 v[84:85], v[68:69]
    v_mov_b32 v7, v94
    v_mov_b64 v[86:87], v[72:73]
    s_mov_b64 exec, -1
    s_or_b64 s[80:81], s[80:81], s[50:51]
    ds_read_b64 v[70:71], v93 offset:65408
    s_and_b64 exec, s[84:85], s[80:81]
    v_mfma_f32_4x4x4_16b_bf16 v[76:79], v[12:13], v[84:85], 0
    v_mov_b32 v92, v7
    s_andn2_b64 s[80:81], s[80:81], s[84:85]
    v_mfma_f32_4x4x4_16b_bf16 v[76:79], v[10:11], v[86:87], v[76:79]
    s_mov_b64 exec, -1
    ds_read_b64 v[68:69], v92 offset:65408
    v_and_b32 v46, 0x80000000, v33
    v_lshrrev_b32 v47, 14, v31
    v_bitop3_b32 v47, v47, v5, v46 bitop3:0xea
    ds_read_b64 v[106:107], v47
    v_bitop3_b32 v95, v31, v5, v46 bitop3:0xea
    v_and_b32 v46, 0x40000000, v33
    v_lshrrev_b32 v47, 14, v30
    v_bitop3_b32 v47, v47, v5, v46 bitop3:0xea
    ds_read_b64 v[104:105], v47
    v_bitop3_b32 v94, v30, v5, v46 bitop3:0xea
    s_waitcnt lgkmcnt(2)
    v_mfma_f32_4x4x4_16b_bf16 v[80:83], v[10:11], v[70:71], v[80:83]
    v_mfma_f32_4x4x4_16b_bf16 v[76:79], v[10:11], v[68:69], v[76:79]
    v_perm_b32 v15, v31, v32, s47
    v_bitop3_b32 v46, v31, 0.5, -0.5 bitop3:0xa8
    v_perm_b32 v14, v30, v32, s46
    v_bitop3_b32 v47, v30, 0.5, -0.5 bitop3:0xa8
    v_cvt_pk_bf16_f32 v80, v80, v81
    v_cvt_pk_bf16_f32 v81, v82, v83
    ds_wrxchg_rtn_b64 v[74:75], v93, v[80:81] offset:65408
    v_cvt_pk_bf16_f32 v76, v76, v77
    v_cvt_pk_bf16_f32 v77, v78, v79
    ds_wrxchg_rtn_b64 v[72:73], v92, v[76:77] offset:65408
    v_and_b32 v88, 0x0fffffff, v42
    v_mov_b32 v33, v42
    buffer_load_dwordx2 v[28:29], v88, s[8:11], 0 offen
    buffer_load_dwordx3 v[30:32], v88, s[8:11], 0 offen offset:8
    s_setprio 0
    s_waitcnt lgkmcnt(2)
    v_mfma_f32_4x4x4_16b_bf16 v[80:83], v[8:9], v[106:107], 0
    v_mfma_f32_4x4x4_16b_bf16 v[76:79], v[8:9], v[104:105], 0
    v_bitop3_b32 v15, v6, v15, v46 bitop3:0xca
    v_bitop3_b32 v14, v6, v14, v47 bitop3:0xca
    s_nop 1
    v_pk_mul_f32 v[80:81], v[80:81], v[14:15] op_sel:[0,1] op_sel_hi:[1,1]
    v_pk_mul_f32 v[82:83], v[82:83], v[14:15] op_sel:[0,1] op_sel_hi:[1,1]
    v_pk_mul_f32 v[76:77], v[76:77], v[14:15] op_sel:[0,0] op_sel_hi:[1,0]
    v_pk_mul_f32 v[78:79], v[78:79], v[14:15] op_sel:[0,0] op_sel_hi:[1,0]
    s_add_u32 s40, s40, 0x50000
    s_waitcnt lgkmcnt(0)
    v_cmp_ne_u64 s[50:51], v[72:73], v[68:69]
    v_cmpx_ne_u64 s[54:55], v[74:75], v[70:71]
    s_and_b64 s[82:83], s[54:55], s[80:81]
    s_cbranch_scc1 L2_c113
L2_d113:
    v_mov_b64 v[84:85], v[70:71]
    v_mov_b32 v7, v93
    v_mov_b64 v[86:87], v[74:75]
    s_or_b64 s[80:81], s[80:81], s[54:55]
    s_mov_b64 exec, s[50:51]
    s_and_b64 s[82:83], s[50:51], s[80:81]
    s_cbranch_scc1 L2_c114
L2_d114:
    v_mov_b64 v[84:85], v[68:69]
    v_mov_b32 v7, v92
    v_mov_b64 v[86:87], v[72:73]
    s_mov_b64 exec, -1
    s_or_b64 s[80:81], s[80:81], s[50:51]
    ds_read_b64 v[70:71], v95 offset:65408
    ds_read_b64 v[68:69], v94 offset:65408
    s_waitcnt vmcnt(8)
    v_and_b32 v46, 0x20000000, v39
    v_lshrrev_b32 v47, 14, v35
    v_bitop3_b32 v47, v47, v5, v46 bitop3:0xea
    ds_read_b64 v[102:103], v47
    v_bitop3_b32 v93, v35, v5, v46 bitop3:0xea
    v_and_b32 v46, 0x10000000, v39
    v_lshrrev_b32 v47, 14, v34
    v_bitop3_b32 v47, v47, v5, v46 bitop3:0xea
    ds_read_b64 v[100:101], v47
    v_bitop3_b32 v92, v34, v5, v46 bitop3:0xea
    v_and_b32 v46, 0x80000000, v39
    v_lshrrev_b32 v47, 14, v37
    v_bitop3_b32 v47, v47, v5, v46 bitop3:0xea
    ds_read_b64 v[106:107], v47
    v_and_b32 v46, 0x40000000, v39
    v_lshrrev_b32 v47, 14, v36
    v_bitop3_b32 v47, v47, v5, v46 bitop3:0xea
    ds_read_b64 v[104:105], v47
    s_waitcnt lgkmcnt(4)
    v_mfma_f32_4x4x4_16b_bf16 v[80:83], v[10:11], v[70:71], v[80:83]
    v_mfma_f32_4x4x4_16b_bf16 v[76:79], v[10:11], v[68:69], v[76:79]
    v_perm_b32 v15, v35, v38, s45
    v_bitop3_b32 v46, v35, 0.5, -0.5 bitop3:0xa8
    v_perm_b32 v14, v34, v38, s44
    v_bitop3_b32 v47, v34, 0.5, -0.5 bitop3:0xa8
    v_cvt_pk_bf16_f32 v80, v80, v81
    v_cvt_pk_bf16_f32 v81, v82, v83
    ds_wrxchg_rtn_b64 v[74:75], v95, v[80:81] offset:65408
    v_cvt_pk_bf16_f32 v76, v76, v77
    v_cvt_pk_bf16_f32 v77, v78, v79
    ds_wrxchg_rtn_b64 v[72:73], v94, v[76:77] offset:65408
    s_waitcnt lgkmcnt(2)
    s_barrier
    s_setprio 3
    s_mov_b32 m0, s100
    s_nop 0
    ds_write_addtid_b32 v116 offset:32768
    ds_write_addtid_b32 v117 offset:33024
    ds_write_addtid_b32 v118 offset:33280
    ds_write_addtid_b32 v119 offset:33536
    buffer_load_dwordx4 v[116:119], v3, s[16:19], s40 offen offset:2048
    ds_write_addtid_b32 v120 offset:33792
    ds_write_addtid_b32 v121 offset:34048
    ds_write_addtid_b32 v122 offset:34304
    ds_write_addtid_b32 v123 offset:34560
    buffer_load_dwordx4 v[120:123], v3, s[16:19], s40 offen offset:3072
    v_mfma_f32_4x4x4_16b_bf16 v[80:83], v[8:9], v[102:103], 0
    v_mfma_f32_4x4x4_16b_bf16 v[76:79], v[8:9], v[100:101], 0
    v_bitop3_b32 v15, v6, v15, v46 bitop3:0xca
    v_bitop3_b32 v14, v6, v14, v47 bitop3:0xca
    v_cmp_lt_u32 s[84:85], v5, v92
    s_nop 0
    v_pk_mul_f32 v[80:81], v[80:81], v[14:15] op_sel:[0,1] op_sel_hi:[1,1]
    v_pk_mul_f32 v[82:83], v[82:83], v[14:15] op_sel:[0,1] op_sel_hi:[1,1]
    v_pk_mul_f32 v[76:77], v[76:77], v[14:15] op_sel:[0,0] op_sel_hi:[1,0]
    v_pk_mul_f32 v[78:79], v[78:79], v[14:15] op_sel:[0,0] op_sel_hi:[1,0]
    v_mov_b32 v44, v43
    s_cmp_gt_u32 s37, 1024
    s_cbranch_scc1 L2_xs115
    s_cmp_lg_u32 s101, 0
    s_cbranch_scc1 L2_xa115
L2_xb115:
    v_lshlrev_b32 v89, 16, v96
    v_add_u32 v90, 60, v97
    v_bitop3_b32 v90, v89, v45, v90 bitop3:0x6a
    ds_write_b32 v98, v90 offset:12
    v_lshlrev_b32 v89, 20, v96
    v_add_u32 v90, 40, v97
    v_bitop3_b32 v90, v89, v45, v90 bitop3:0x6a
    ds_write_b32 v98, v90 offset:8
    v_lshlrev_b32 v89, 24, v96
    v_add_u32 v90, 20, v97
    v_bitop3_b32 v90, v89, v45, v90 bitop3:0x6a
    ds_write_b32 v98, v90 offset:4
    v_lshlrev_b32 v89, 28, v96
    v_bitop3_b32 v90, v89, v45, v97 bitop3:0x6a
    ds_write_b32 v98, v90 offset:0
    v_mov_b32_dpp v91, v66 quad_perm:[1,1,1,1] row_mask:0xf bank_mask:0xf
    v_and_b32 v89, 3, v91
    v_and_b32 v97, 0xfffc, v91
    v_sub_u16_dpp v88, v66, v91 quad_perm:[3,3,3,3] row_mask:0xf bank_mask:0xf
    v_mad_u32_u24 v97, v97, 5, v4
    v_add_u32 v99, v88, v89
    v_bfm_b32 v96, v88, v89
    v_cmp_lt_u32 s[58:59], 16, v99
    v_lshlrev_b32 v89, v1, v96
    v_and_b32 v89, v45, v89
    v_cmp_ne_u32 vcc, 0, v89
    v_xor_b32 v90, v97, v89
    s_add_u32 s3, s37, s38
    v_mbcnt_lo_u32_b32 v98, vcc_lo, 0
    v_mbcnt_hi_u32_b32 v98, vcc_hi, v98
    s_bcnt1_i32_b64 s41, vcc
    v_lshl_add_u32 v98, v98, 2, s3
    s_mov_b64 exec, vcc
    ds_write_b32 v98, v90
    s_mov_b64 exec, -1
    s_lshl2_add_u32 s37, s41, s37
    s_cmp_lg_u64 s[58:59], 0
    s_cbranch_scc1 L2_xe115
L2_xr115:
    v_add_u32 v98, s37, v0
    v_mov_b32 v90, -1
    ds_write_b32 v98, v90
    ds_read2st64_b32 v[40:41], v0 offset0:0 offset1:1
    ds_read2st64_b32 v[42:43], v0 offset0:2 offset1:3
    s_sub_u32 s3, s37, 768
    s_cmp_gt_u32 s3, 256
    s_cbranch_scc1 L2_xf115
L2_xg115:
    v_lshrrev_b64 v[64:65], 16, v[64:65]
    v_lshrrev_b64 v[66:67], 16, v[66:67]
    s_setprio 2
    ds_write_addtid_b32 v124 offset:34816
    ds_write_addtid_b32 v125 offset:35072
    ds_write_addtid_b32 v126 offset:35328
    ds_write_addtid_b32 v127 offset:35584
    s_add_u32 s3, s40, 4096
    buffer_load_dwordx4 v[124:127], v3, s[16:19], s3 offen
    s_waitcnt lgkmcnt(14)
    v_cmp_ne_u64 s[50:51], v[72:73], v[68:69]
    v_cmpx_ne_u64 s[54:55], v[74:75], v[70:71]
    s_and_b64 s[82:83], s[54:55], s[80:81]
    s_cbranch_scc1 L2_c116
L2_d116:
    v_mov_b64 v[84:85], v[70:71]
    v_mov_b32 v7, v95
    v_mov_b64 v[86:87], v[74:75]
    s_or_b64 s[80:81], s[80:81], s[54:55]
    s_mov_b64 exec, s[50:51]
    s_and_b64 s[82:83], s[50:51], s[80:81]
    s_cbranch_scc1 L2_c117
L2_d117:
    v_mov_b64 v[84:85], v[68:69]
    v_mov_b32 v7, v94
    v_mov_b64 v[86:87], v[72:73]
    s_mov_b64 exec, -1
    s_or_b64 s[80:81], s[80:81], s[50:51]
    ds_read_b64 v[70:71], v93 offset:65408
    s_and_b64 exec, s[84:85], s[80:81]
    v_mfma_f32_4x4x4_16b_bf16 v[76:79], v[12:13], v[84:85], 0
    v_mov_b32 v92, v7
    s_andn2_b64 s[80:81], s[80:81], s[84:85]
    v_mfma_f32_4x4x4_16b_bf16 v[76:79], v[10:11], v[86:87], v[76:79]
    s_mov_b64 exec, -1
    ds_read_b64 v[68:69], v92 offset:65408
    s_setprio 1
    s_waitcnt vmcnt(10)
    s_mov_b32 m0, s38
    s_nop 0
    ds_write_addtid_b32 v108 offset:0
    ds_write_addtid_b32 v109 offset:256
    ds_write_addtid_b32 v110 offset:512
    ds_write_addtid_b32 v111 offset:768
    s_waitcnt lgkmcnt(4)
    v_mfma_f32_4x4x4_16b_bf16 v[80:83], v[10:11], v[70:71], v[80:83]
    v_mfma_f32_4x4x4_16b_bf16 v[76:79], v[10:11], v[68:69], v[76:79]
    v_and_b32 v46, 0x40000000, v39
    v_bitop3_b32 v94, v36, v5, v46 bitop3:0xea
    v_and_b32 v46, 0x80000000, v39
    v_bitop3_b32 v95, v37, v5, v46 bitop3:0xea
    v_perm_b32 v15, v37, v38, s47
    v_bitop3_b32 v46, v37, 0.5, -0.5 bitop3:0xa8
    v_perm_b32 v14, v36, v38, s46
    v_bitop3_b32 v47, v36, 0.5, -0.5 bitop3:0xa8
    v_cvt_pk_bf16_f32 v80, v80, v81
    v_cvt_pk_bf16_f32 v81, v82, v83
    ds_wrxchg_rtn_b64 v[74:75], v93, v[80:81] offset:65408
    v_cvt_pk_bf16_f32 v76, v76, v77
    v_cvt_pk_bf16_f32 v77, v78, v79
    ds_wrxchg_rtn_b64 v[72:73], v92, v[76:77] offset:65408
    v_and_b32 v88, 0x0fffffff, v44
    v_mov_b32 v39, v44
    buffer_load_dwordx2 v[34:35], v88, s[8:11], 0 offen
    buffer_load_dwordx3 v[36:38], v88, s[8:11], 0 offen offset:8
    s_setprio 0
    s_waitcnt vmcnt(11)
    ds_write_addtid_b32 v112 offset:1024
    ds_write_addtid_b32 v113 offset:1280
    ds_write_addtid_b32 v114 offset:1536
    ds_write_addtid_b32 v115 offset:1792
    v_mfma_f32_4x4x4_16b_bf16 v[80:83], v[8:9], v[106:107], 0
    v_mfma_f32_4x4x4_16b_bf16 v[76:79], v[8:9], v[104:105], 0
    v_bitop3_b32 v15, v6, v15, v46 bitop3:0xca
    v_bitop3_b32 v14, v6, v14, v47 bitop3:0xca
    s_nop 1
    v_pk_mul_f32 v[80:81], v[80:81], v[14:15] op_sel:[0,1] op_sel_hi:[1,1]
    v_pk_mul_f32 v[82:83], v[82:83], v[14:15] op_sel:[0,1] op_sel_hi:[1,1]
    v_pk_mul_f32 v[76:77], v[76:77], v[14:15] op_sel:[0,0] op_sel_hi:[1,0]
    v_pk_mul_f32 v[78:79], v[78:79], v[14:15] op_sel:[0,0] op_sel_hi:[1,0]
    s_add_u32 s42, s42, 1
    s_waitcnt lgkmcnt(0)
    s_cmp_lg_u32 s42, 14
    s_cbranch_scc1 L2_loop
    s_barrier
    s_bitcmp1_b32 s36, s42
    s_cbranch_scc1 L2_slow
L2_ret6:
    s_setprio 3
    buffer_load_dwordx4 v[108:111], v3, s[16:19], s40 offen offset:0
    v_cmp_ne_u64 s[50:51], v[72:73], v[68:69]
    v_cmpx_ne_u64 s[54:55], v[74:75], v[70:71]
    s_and_b64 s[82:83], s[54:55], s[80:81]
    s_cbranch_scc1 L2_c118
L2_d118:
    v_mov_b64 v[84:85], v[70:71]
    v_mov_b32 v7, v93
    v_mov_b64 v[86:87], v[74:75]
    s_or_b64 s[80:81], s[80:81], s[54:55]
    s_mov_b64 exec, s[50:51]
    s_and_b64 s[82:83], s[50:51], s[80:81]
    s_cbranch_scc1 L2_c119
L2_d119:
    v_mov_b64 v[84:85], v[68:69]
    v_mov_b32 v7, v92
    v_mov_b64 v[86:87], v[72:73]
    s_mov_b64 exec, -1
    s_or_b64 s[80:81], s[80:81], s[50:51]
    ds_read_b64 v[70:71], v95 offset:65408
    ds_read_b64 v[68:69], v94 offset:65408
    s_waitcnt vmcnt(10)
    v_and_b32 v46, 0x20000000, v21
    v_lshrrev_b32 v47, 14, v17
    v_bitop3_b32 v47, v47, v5, v46 bitop3:0xea
    ds_read_b64 v[102:103], v47
    v_bitop3_b32 v93, v17, v5, v46 bitop3:0xea
    v_and_b32 v46, 0x10000000, v21
    v_lshrrev_b32 v47, 14, v16
    v_bitop3_b32 v47, v47, v5, v46 bitop3:0xea
    ds_read_b64 v[100:101], v47
    v_bitop3_b32 v92, v16, v5, v46 bitop3:0xea
    s_waitcnt lgkmcnt(2)
    v_mfma_f32_4x4x4_16b_bf16 v[80:83], v[10:11], v[70:71], v[80:83]
    v_mfma_f32_4x4x4_16b_bf16 v[76:79], v[10:11], v[68:69], v[76:79]
    v_perm_b32 v15, v17, v20, s45
    v_bitop3_b32 v46, v17, 0.5, -0.5 bitop3:0xa8
    v_perm_b32 v14, v16, v20, s44
    v_bitop3_b32 v47, v16, 0.5, -0.5 bitop3:0xa8
    v_cvt_pk_bf16_f32 v80, v80, v81
    v_cvt_pk_bf16_f32 v81, v82, v83
    ds_wrxchg_rtn_b64 v[74:75], v95, v[80:81] offset:65408
    v_cvt_pk_bf16_f32 v76, v76, v77
    v_cvt_pk_bf16_f32 v77, v78, v79
    ds_wrxchg_rtn_b64 v[72:73], v94, v[76:77] offset:65408
    s_waitcnt lgkmcnt(2)
    v_mfma_f32_4x4x4_16b_bf16 v[80:83], v[8:9], v[102:103], 0
    v_mfma_f32_4x4x4_16b_bf16 v[76:79], v[8:9], v[100:101], 0
    v_bitop3_b32 v15, v6, v15, v46 bitop3:0xca
    v_bitop3_b32 v14, v6, v14, v47 bitop3:0xca
    v_cmp_lt_u32 s[84:85], v5, v92
    s_nop 0
    v_pk_mul_f32 v[80:81], v[80:81], v[14:15] op_sel:[0,1] op_sel_hi:[1,1]
    v_pk_mul_f32 v[82:83], v[82:83], v[14:15] op_sel:[0,1] op_sel_hi:[1,1]
    v_pk_mul_f32 v[76:77], v[76:77], v[14:15] op_sel:[0,0] op_sel_hi:[1,0]
    v_pk_mul_f32 v[78:79], v[78:79], v[14:15] op_sel:[0,0] op_sel_hi:[1,0]
    buffer_load_dwordx4 v[112:115], v3, s[16:19], s40 offen offset:1024
    s_waitcnt lgkmcnt(0)
    v_cmp_ne_u64 s[50:51], v[72:73], v[68:69]
    v_cmpx_ne_u64 s[54:55], v[74:75], v[70:71]
    s_and_b64 s[82:83], s[54:55], s[80:81]
    s_cbranch_scc1 L2_c120
L2_d120:
    v_mov_b64 v[84:85], v[70:71]
    v_mov_b32 v7, v95
    v_mov_b64 v[86:87], v[74:75]
    s_or_b64 s[80:81], s[80:81], s[54:55]
    s_mov_b64 exec, s[50:51]
    s_and_b64 s[82:83], s[50:51], s[80:81]
    s_cbranch_scc1 L2_c121
L2_d121:
    v_mov_b64 v[84:85], v[68:69]
    v_mov_b32 v7, v94
    v_mov_b64 v[86:87], v[72:73]
    s_mov_b64 exec, -1
    s_or_b64 s[80:81], s[80:81], s[50:51]
    ds_read_b64 v[70:71], v93 offset:65408
    s_and_b64 exec, s[84:85], s[80:81]
    v_mfma_f32_4x4x4_16b_bf16 v[76:79], v[12:13], v[84:85], 0
    v_mov_b32 v92, v7
    s_andn2_b64 s[80:81], s[80:81], s[84:85]
    v_mfma_f32_4x4x4_16b_bf16 v[76:79], v[10:11], v[86:87], v[76:79]
    s_mov_b64 exec, -1
    ds_read_b64 v[68:69], v92 offset:65408
    v_and_b32 v46, 0x80000000, v21
    v_lshrrev_b32 v47, 14, v19
    v_bitop3_b32 v47, v47, v5, v46 bitop3:0xea
    ds_read_b64 v[106:107], v47
    v_bitop3_b32 v95, v19, v5, v46 bitop3:0xea
    v_and_b32 v46, 0x40000000, v21
    v_lshrrev_b32 v47, 14, v18
    v_bitop3_b32 v47, v47, v5, v46 bitop3:0xea
    ds_read_b64 v[104:105], v47
    v_bitop3_b32 v94, v18, v5, v46 bitop3:0xea
    s_waitcnt lgkmcnt(2)
    v_mfma_f32_4x4x4_16b_bf16 v[80:83], v[10:11], v[70:71], v[80:83]
    v_mfma_f32_4x4x4_16b_bf16 v[76:79], v[10:11], v[68:69], v[76:79]
    v_perm_b32 v15, v19, v20, s47
    v_bitop3_b32 v46, v19, 0.5, -0.5 bitop3:0xa8
    v_perm_b32 v14, v18, v20, s46
    v_bitop3_b32 v47, v18, 0.5, -0.5 bitop3:0xa8
    v_cvt_pk_bf16_f32 v80, v80, v81
    v_cvt_pk_bf16_f32 v81, v82, v83
    ds_wrxchg_rtn_b64 v[74:75], v93, v[80:81] offset:65408
    v_cvt_pk_bf16_f32 v76, v76, v77
    v_cvt_pk_bf16_f32 v77, v78, v79
    ds_wrxchg_rtn_b64 v[72:73], v92, v[76:77] offset:65408
    v_and_b32 v88, 0x0fffffff, v40
    v_mov_b32 v21, v40
    buffer_load_dwordx2 v[16:17], v88, s[8:11], 0 offen
    buffer_load_dwordx3 v[18:20], v88, s[8:11], 0 offen offset:8
    s_setprio 2
    s_waitcnt lgkmcnt(2)
    v_mfma_f32_4x4x4_16b_bf16 v[80:83], v[8:9], v[106:107], 0
    v_mfma_f32_4x4x4_16b_bf16 v[76:79], v[8:9], v[104:105], 0
    v_bitop3_b32 v15, v6, v15, v46 bitop3:0xca
    v_bitop3_b32 v14, v6, v14, v47 bitop3:0xca
    s_nop 1
    v_pk_mul_f32 v[80:81], v[80:81], v[14:15] op_sel:[0,1] op_sel_hi:[1,1]
    v_pk_mul_f32 v[82:83], v[82:83], v[14:15] op_sel:[0,1] op_sel_hi:[1,1]
    v_pk_mul_f32 v[76:77], v[76:77], v[14:15] op_sel:[0,0] op_sel_hi:[1,0]
    v_pk_mul_f32 v[78:79], v[78:79], v[14:15] op_sel:[0,0] op_sel_hi:[1,0]
    s_waitcnt lgkmcnt(0)
    v_cmp_ne_u64 s[50:51], v[72:73], v[68:69]
    v_cmpx_ne_u64 s[54:55], v[74:75], v[70:71]
    s_and_b64 s[82:83], s[54:55], s[80:81]
    s_cbranch_scc1 L2_c122
L2_d122:
    v_mov_b64 v[84:85], v[70:71]
    v_mov_b32 v7, v93
    v_mov_b64 v[86:87], v[74:75]
    s_or_b64 s[80:81], s[80:81], s[54:55]
    s_mov_b64 exec, s[50:51]
    s_and_b64 s[82:83], s[50:51], s[80:81]
    s_cbranch_scc1 L2_c123
L2_d123:
    v_mov_b64 v[84:85], v[68:69]
    v_mov_b32 v7, v92
    v_mov_b64 v[86:87], v[72:73]
    s_mov_b64 exec, -1
    s_or_b64 s[80:81], s[80:81], s[50:51]
    ds_read_b64 v[70:71], v95 offset:65408
    ds_read_b64 v[68:69], v94 offset:65408
    s_waitcnt vmcnt(11)
    v_and_b32 v46, 0x20000000, v27
    v_lshrrev_b32 v47, 14, v23
    v_bitop3_b32 v47, v47, v5, v46 bitop3:0xea
    ds_read_b64 v[102:103], v47
    v_bitop3_b32 v93, v23, v5, v46 bitop3:0xea
    v_and_b32 v46, 0x10000000, v27
    v_lshrrev_b32 v47, 14, v22
    v_bitop3_b32 v47, v47, v5, v46 bitop3:0xea
    ds_read_b64 v[100:101], v47
    v_bitop3_b32 v92, v22, v5, v46 bitop3:0xea
    s_waitcnt lgkmcnt(2)
    v_mfma_f32_4x4x4_16b_bf16 v[80:83], v[10:11], v[70:71], v[80:83]
    v_mfma_f32_4x4x4_16b_bf16 v[76:79], v[10:11], v[68:69], v[76:79]
    v_perm_b32 v15, v23, v26, s45
    v_bitop3_b32 v46, v23, 0.5, -0.5 bitop3:0xa8
    v_perm_b32 v14, v22, v26, s44
    v_bitop3_b32 v47, v22, 0.5, -0.5 bitop3:0xa8
    v_cvt_pk_bf16_f32 v80, v80, v81
    v_cvt_pk_bf16_f32 v81, v82, v83
    ds_wrxchg_rtn_b64 v[74:75], v95, v[80:81] offset:65408
    v_cvt_pk_bf16_f32 v76, v76, v77
    v_cvt_pk_bf16_f32 v77, v78, v79
    ds_wrxchg_rtn_b64 v[72:73], v94, v[76:77] offset:65408
    s_waitcnt lgkmcnt(2)
    v_mfma_f32_4x4x4_16b_bf16 v[80:83], v[8:9], v[102:103], 0
    v_mfma_f32_4x4x4_16b_bf16 v[76:79], v[8:9], v[100:101], 0
    v_bitop3_b32 v15, v6, v15, v46 bitop3:0xca
    v_bitop3_b32 v14, v6, v14, v47 bitop3:0xca
    v_cmp_lt_u32 s[84:85], v5, v92
    s_nop 0
    v_pk_mul_f32 v[80:81], v[80:81], v[14:15] op_sel:[0,1] op_sel_hi:[1,1]
    v_pk_mul_f32 v[82:83], v[82:83], v[14:15] op_sel:[0,1] op_sel_hi:[1,1]
    v_pk_mul_f32 v[76:77], v[76:77], v[14:15] op_sel:[0,0] op_sel_hi:[1,0]
    v_pk_mul_f32 v[78:79], v[78:79], v[14:15] op_sel:[0,0] op_sel_hi:[1,0]
    s_waitcnt lgkmcnt(0)
    v_cmp_ne_u64 s[50:51], v[72:73], v[68:69]
    v_cmpx_ne_u64 s[54:55], v[74:75], v[70:71]
    s_and_b64 s[82:83], s[54:55], s[80:81]
    s_cbranch_scc1 L2_c124
L2_d124:
    v_mov_b64 v[84:85], v[70:71]
    v_mov_b32 v7, v95
    v_mov_b64 v[86:87], v[74:75]
    s_or_b64 s[80:81], s[80:81], s[54:55]
    s_mov_b64 exec, s[50:51]
    s_and_b64 s[82:83], s[50:51], s[80:81]
    s_cbranch_scc1 L2_c125
L2_d125:
    v_mov_b64 v[84:85], v[68:69]
    v_mov_b32 v7, v94
    v_mov_b64 v[86:87], v[72:73]
    s_mov_b64 exec, -1
    s_or_b64 s[80:81], s[80:81], s[50:51]
    ds_read_b64 v[70:71], v93 offset:65408
    s_and_b64 exec, s[84:85], s[80:81]
    v_mfma_f32_4x4x4_16b_bf16 v[76:79], v[12:13], v[84:85], 0
    v_mov_b32 v92, v7
    s_andn2_b64 s[80:81], s[80:81], s[84:85]
    v_mfma_f32_4x4x4_16b_bf16 v[76:79], v[10:11], v[86:87], v[76:79]
    s_mov_b64 exec, -1
    ds_read_b64 v[68:69], v92 offset:65408
    v_and_b32 v46, 0x80000000, v27
    v_lshrrev_b32 v47, 14, v25
    v_bitop3_b32 v47, v47, v5, v46 bitop3:0xea
    ds_read_b64 v[106:107], v47
    v_bitop3_b32 v95, v25, v5, v46 bitop3:0xea
    v_and_b32 v46, 0x40000000, v27
    v_lshrrev_b32 v47, 14, v24
    v_bitop3_b32 v47, v47, v5, v46 bitop3:0xea
    ds_read_b64 v[104:105], v47
    v_bitop3_b32 v94, v24, v5, v46 bitop3:0xea
    s_waitcnt lgkmcnt(2)
    v_mfma_f32_4x4x4_16b_bf16 v[80:83], v[10:11], v[70:71], v[80:83]
    v_mfma_f32_4x4x4_16b_bf16 v[76:79], v[10:11], v[68:69], v[76:79]
    v_perm_b32 v15, v25, v26, s47
    v_bitop3_b32 v46, v25, 0.5, -0.5 bitop3:0xa8
    v_perm_b32 v14, v24, v26, s46
    v_bitop3_b32 v47, v24, 0.5, -0.5 bitop3:0xa8
    v_cvt_pk_bf16_f32 v80, v80, v81
    v_cvt_pk_bf16_f32 v81, v82, v83
    ds_wrxchg_rtn_b64 v[74:75], v93, v[80:81] offset:65408
    v_cvt_pk_bf16_f32 v76, v76, v77
    v_cvt_pk_bf16_f32 v77, v78, v79
    ds_wrxchg_rtn_b64 v[72:73], v92, v[76:77] offset:65408
    v_and_b32 v88, 0x0fffffff, v41
    v_mov_b32 v27, v41
    buffer_load_dwordx2 v[22:23], v88, s[8:11], 0 offen
    buffer_load_dwordx3 v[24:26], v88, s[8:11], 0 offen offset:8
    s_setprio 1
    s_waitcnt lgkmcnt(2)
    v_mfma_f32_4x4x4_16b_bf16 v[80:83], v[8:9], v[106:107], 0
    v_mfma_f32_4x4x4_16b_bf16 v[76:79], v[8:9], v[104:105], 0
    v_bitop3_b32 v15, v6, v15, v46 bitop3:0xca
    v_bitop3_b32 v14, v6, v14, v47 bitop3:0xca
    s_nop 1
    v_pk_mul_f32 v[80:81], v[80:81], v[14:15] op_sel:[0,1] op_sel_hi:[1,1]
    v_pk_mul_f32 v[82:83], v[82:83], v[14:15] op_sel:[0,1] op_sel_hi:[1,1]
    v_pk_mul_f32 v[76:77], v[76:77], v[14:15] op_sel:[0,0] op_sel_hi:[1,0]
    v_pk_mul_f32 v[78:79], v[78:79], v[14:15] op_sel:[0,0] op_sel_hi:[1,0]
    s_waitcnt lgkmcnt(0)
    v_cmp_ne_u64 s[50:51], v[72:73], v[68:69]
    v_cmpx_ne_u64 s[54:55], v[74:75], v[70:71]
    s_and_b64 s[82:83], s[54:55], s[80:81]
    s_cbranch_scc1 L2_c126
L2_d126:
    v_mov_b64 v[84:85], v[70:71]
    v_mov_b32 v7, v93
    v_mov_b64 v[86:87], v[74:75]
    s_or_b64 s[80:81], s[80:81], s[54:55]
    s_mov_b64 exec, s[50:51]
    s_and_b64 s[82:83], s[50:51], s[80:81]
    s_cbranch_scc1 L2_c127
L2_d127:
    v_mov_b64 v[84:85], v[68:69]
    v_mov_b32 v7, v92
    v_mov_b64 v[86:87], v[72:73]
    s_mov_b64 exec, -1
    s_or_b64 s[80:81], s[80:81], s[50:51]
    ds_read_b64 v[70:71], v95 offset:65408
    ds_read_b64 v[68:69], v94 offset:65408
    s_waitcnt vmcnt(11)
    v_and_b32 v46, 0x20000000, v33
    v_lshrrev_b32 v47, 14, v29
    v_bitop3_b32 v47, v47, v5, v46 bitop3:0xea
    ds_read_b64 v[102:103], v47
    v_bitop3_b32 v93, v29, v5, v46 bitop3:0xea
    v_and_b32 v46, 0x10000000, v33
    v_lshrrev_b32 v47, 14, v28
    v_bitop3_b32 v47, v47, v5, v46 bitop3:0xea
    ds_read_b64 v[100:101], v47
    v_bitop3_b32 v92, v28, v5, v46 bitop3:0xea
    s_waitcnt lgkmcnt(2)
    v_mfma_f32_4x4x4_16b_bf16 v[80:83], v[10:11], v[70:71], v[80:83]
    v_mfma_f32_4x4x4_16b_bf16 v[76:79], v[10:11], v[68:69], v[76:79]
    v_perm_b32 v15, v29, v32, s45
    v_bitop3_b32 v46, v29, 0.5, -0.5 bitop3:0xa8
    v_perm_b32 v14, v28, v32, s44
    v_bitop3_b32 v47, v28, 0.5, -0.5 bitop3:0xa8
    v_cvt_pk_bf16_f32 v80, v80, v81
    v_cvt_pk_bf16_f32 v81, v82, v83
    ds_wrxchg_rtn_b64 v[74:75], v95, v[80:81] offset:65408
    v_cvt_pk_bf16_f32 v76, v76, v77
    v_cvt_pk_bf16_f32 v77, v78, v79
    ds_wrxchg_rtn_b64 v[72:73], v94, v[76:77] offset:65408
    s_waitcnt lgkmcnt(2)
    v_mfma_f32_4x4x4_16b_bf16 v[80:83], v[8:9], v[102:103], 0
    v_mfma_f32_4x4x4_16b_bf16 v[76:79], v[8:9], v[100:101], 0
    v_bitop3_b32 v15, v6, v15, v46 bitop3:0xca
    v_bitop3_b32 v14, v6, v14, v47 bitop3:0xca
    v_cmp_lt_u32 s[84:85], v5, v92
    s_nop 0
    v_pk_mul_f32 v[80:81], v[80:81], v[14:15] op_sel:[0,1] op_sel_hi:[1,1]
    v_pk_mul_f32 v[82:83], v[82:83], v[14:15] op_sel:[0,1] op_sel_hi:[1,1]
    v_pk_mul_f32 v[76:77], v[76:77], v[14:15] op_sel:[0,0] op_sel_hi:[1,0]
    v_pk_mul_f32 v[78:79], v[78:79], v[14:15] op_sel:[0,0] op_sel_hi:[1,0]
    s_waitcnt lgkmcnt(0)
    v_cmp_ne_u64 s[50:51], v[72:73], v[68:69]
    v_cmpx_ne_u64 s[54:55], v[74:75], v[70:71]
    s_and_b64 s[82:83], s[54:55], s[80:81]
    s_cbranch_scc1 L2_c128
L2_d128:
    v_mov_b64 v[84:85], v[70:71]
    v_mov_b32 v7, v95
    v_mov_b64 v[86:87], v[74:75]
    s_or_b64 s[80:81], s[80:81], s[54:55]
    s_mov_b64 exec, s[50:51]
    s_and_b64 s[82:83], s[50:51], s[80:81]
    s_cbranch_scc1 L2_c129
L2_d129:
    v_mov_b64 v[84:85], v[68:69]
    v_mov_b32 v7, v94
    v_mov_b64 v[86:87], v[72:73]
    s_mov_b64 exec, -1
    s_or_b64 s[80:81], s[80:81], s[50:51]
    ds_read_b64 v[70:71], v93 offset:65408
    s_and_b64 exec, s[84:85], s[80:81]
    v_mfma_f32_4x4x4_16b_bf16 v[76:79], v[12:13], v[84:85], 0
    v_mov_b32 v92, v7
    s_andn2_b64 s[80:81], s[80:81], s[84:85]
    v_mfma_f32_4x4x4_16b_bf16 v[76:79], v[10:11], v[86:87], v[76:79]
    s_mov_b64 exec, -1
    ds_read_b64 v[68:69], v92 offset:65408
    v_and_b32 v46, 0x80000000, v33
    v_lshrrev_b32 v47, 14, v31
    v_bitop3_b32 v47, v47, v5, v46 bitop3:0xea
    ds_read_b64 v[106:107], v47
    v_bitop3_b32 v95, v31, v5, v46 bitop3:0xea
    v_and_b32 v46, 0x40000000, v33
    v_lshrrev_b32 v47, 14, v30
    v_bitop3_b32 v47, v47, v5, v46 bitop3:0xea
    ds_read_b64 v[104:105], v47
    v_bitop3_b32 v94, v30, v5, v46 bitop3:0xea
    s_waitcnt lgkmcnt(2)
    v_mfma_f32_4x4x4_16b_bf16 v[80:83], v[10:11], v[70:71], v[80:83]
    v_mfma_f32_4x4x4_16b_bf16 v[76:79], v[10:11], v[68:69], v[76:79]
    v_perm_b32 v15, v31, v32, s47
    v_bitop3_b32 v46, v31, 0.5, -0.5 bitop3:0xa8
    v_perm_b32 v14, v30, v32, s46
    v_bitop3_b32 v47, v30, 0.5, -0.5 bitop3:0xa8
    v_cvt_pk_bf16_f32 v80, v80, v81
    v_cvt_pk_bf16_f32 v81, v82, v83
    ds_wrxchg_rtn_b64 v[74:75], v93, v[80:81] offset:65408
    v_cvt_pk_bf16_f32 v76, v76, v77
    v_cvt_pk_bf16_f32 v77, v78, v79
    ds_wrxchg_rtn_b64 v[72:73], v92, v[76:77] offset:65408
    v_and_b32 v88, 0x0fffffff, v42
    v_mov_b32 v33, v42
    buffer_load_dwordx2 v[28:29], v88, s[8:11], 0 offen
    buffer_load_dwordx3 v[30:32], v88, s[8:11], 0 offen offset:8
    s_setprio 0
    s_waitcnt lgkmcnt(2)
    v_mfma_f32_4x4x4_16b_bf16 v[80:83], v[8:9], v[106:107], 0
    v_mfma_f32_4x4x4_16b_bf16 v[76:79], v[8:9], v[104:105], 0
    v_bitop3_b32 v15, v6, v15, v46 bitop3:0xca
    v_bitop3_b32 v14, v6, v14, v47 bitop3:0xca
    s_nop 1
    v_pk_mul_f32 v[80:81], v[80:81], v[14:15] op_sel:[0,1] op_sel_hi:[1,1]
    v_pk_mul_f32 v[82:83], v[82:83], v[14:15] op_sel:[0,1] op_sel_hi:[1,1]
    v_pk_mul_f32 v[76:77], v[76:77], v[14:15] op_sel:[0,0] op_sel_hi:[1,0]
    v_pk_mul_f32 v[78:79], v[78:79], v[14:15] op_sel:[0,0] op_sel_hi:[1,0]
    s_add_u32 s40, s40, 0xfff24000
    s_waitcnt lgkmcnt(0)
    v_cmp_ne_u64 s[50:51], v[72:73], v[68:69]
    v_cmpx_ne_u64 s[54:55], v[74:75], v[70:71]
    s_and_b64 s[82:83], s[54:55], s[80:81]
    s_cbranch_scc1 L2_c130
L2_d130:
    v_mov_b64 v[84:85], v[70:71]
    v_mov_b32 v7, v93
    v_mov_b64 v[86:87], v[74:75]
    s_or_b64 s[80:81], s[80:81], s[54:55]
    s_mov_b64 exec, s[50:51]
    s_and_b64 s[82:83], s[50:51], s[80:81]
    s_cbranch_scc1 L2_c131
L2_d131:
    v_mov_b64 v[84:85], v[68:69]
    v_mov_b32 v7, v92
    v_mov_b64 v[86:87], v[72:73]
    s_mov_b64 exec, -1
    s_or_b64 s[80:81], s[80:81], s[50:51]
    ds_read_b64 v[70:71], v95 offset:65408
    ds_read_b64 v[68:69], v94 offset:65408
    s_waitcnt vmcnt(8)
    v_and_b32 v46, 0x20000000, v39
    v_lshrrev_b32 v47, 14, v35
    v_bitop3_b32 v47, v47, v5, v46 bitop3:0xea
    ds_read_b64 v[102:103], v47
    v_bitop3_b32 v93, v35, v5, v46 bitop3:0xea
    v_and_b32 v46, 0x10000000, v39
    v_lshrrev_b32 v47, 14, v34
    v_bitop3_b32 v47, v47, v5, v46 bitop3:0xea
    ds_read_b64 v[100:101], v47
    v_bitop3_b32 v92, v34, v5, v46 bitop3:0xea
    v_and_b32 v46, 0x80000000, v39
    v_lshrrev_b32 v47, 14, v37
    v_bitop3_b32 v47, v47, v5, v46 bitop3:0xea
    ds_read_b64 v[106:107], v47
    v_and_b32 v46, 0x40000000, v39
    v_lshrrev_b32 v47, 14, v36
    v_bitop3_b32 v47, v47, v5, v46 bitop3:0xea
    ds_read_b64 v[104:105], v47
    s_waitcnt lgkmcnt(4)
    v_mfma_f32_4x4x4_16b_bf16 v[80:83], v[10:11], v[70:71], v[80:83]
    v_mfma_f32_4x4x4_16b_bf16 v[76:79], v[10:11], v[68:69], v[76:79]
    v_perm_b32 v15, v35, v38, s45
    v_bitop3_b32 v46, v35, 0.5, -0.5 bitop3:0xa8
    v_perm_b32 v14, v34, v38, s44
    v_bitop3_b32 v47, v34, 0.5, -0.5 bitop3:0xa8
    v_cvt_pk_bf16_f32 v80, v80, v81
    v_cvt_pk_bf16_f32 v81, v82, v83
    ds_wrxchg_rtn_b64 v[74:75], v95, v[80:81] offset:65408
    v_cvt_pk_bf16_f32 v76, v76, v77
    v_cvt_pk_bf16_f32 v77, v78, v79
    ds_wrxchg_rtn_b64 v[72:73], v94, v[76:77] offset:65408
    s_waitcnt lgkmcnt(2)
    s_barrier
    s_setprio 3
    s_mov_b32 m0, s100
    s_nop 0
    ds_write_addtid_b32 v116 offset:32768
    ds_write_addtid_b32 v117 offset:33024
    ds_write_addtid_b32 v118 offset:33280
    ds_write_addtid_b32 v119 offset:33536
    ds_write_addtid_b32 v120 offset:33792
    ds_write_addtid_b32 v121 offset:34048
    ds_write_addtid_b32 v122 offset:34304
    ds_write_addtid_b32 v123 offset:34560
    v_mfma_f32_4x4x4_16b_bf16 v[80:83], v[8:9], v[102:103], 0
    v_mfma_f32_4x4x4_16b_bf16 v[76:79], v[8:9], v[100:101], 0
    v_bitop3_b32 v15, v6, v15, v46 bitop3:0xca
    v_bitop3_b32 v14, v6, v14, v47 bitop3:0xca
    v_cmp_lt_u32 s[84:85], v5, v92
    s_nop 0
    v_pk_mul_f32 v[80:81], v[80:81], v[14:15] op_sel:[0,1] op_sel_hi:[1,1]
    v_pk_mul_f32 v[82:83], v[82:83], v[14:15] op_sel:[0,1] op_sel_hi:[1,1]
    v_pk_mul_f32 v[76:77], v[76:77], v[14:15] op_sel:[0,0] op_sel_hi:[1,0]
    v_pk_mul_f32 v[78:79], v[78:79], v[14:15] op_sel:[0,0] op_sel_hi:[1,0]
    v_mov_b32 v44, v43
    s_setprio 2
    ds_write_addtid_b32 v124 offset:34816
    ds_write_addtid_b32 v125 offset:35072
    ds_write_addtid_b32 v126 offset:35328
    ds_write_addtid_b32 v127 offset:35584
    s_waitcnt lgkmcnt(12)
    v_cmp_ne_u64 s[50:51], v[72:73], v[68:69]
    v_cmpx_ne_u64 s[54:55], v[74:75], v[70:71]
    s_and_b64 s[82:83], s[54:55], s[80:81]
    s_cbranch_scc1 L2_c132
L2_d132:
    v_mov_b64 v[84:85], v[70:71]
    v_mov_b32 v7, v95
    v_mov_b64 v[86:87], v[74:75]
    s_or_b64 s[80:81], s[80:81], s[54:55]
    s_mov_b64 exec, s[50:51]
    s_and_b64 s[82:83], s[50:51], s[80:81]
    s_cbranch_scc1 L2_c133
L2_d133:
    v_mov_b64 v[84:85], v[68:69]
    v_mov_b32 v7, v94
    v_mov_b64 v[86:87], v[72:73]
    s_mov_b64 exec, -1
    s_or_b64 s[80:81], s[80:81], s[50:51]
    ds_read_b64 v[70:71], v93 offset:65408
    s_and_b64 exec, s[84:85], s[80:81]
    v_mfma_f32_4x4x4_16b_bf16 v[76:79], v[12:13], v[84:85], 0
    v_mov_b32 v92, v7
    s_andn2_b64 s[80:81], s[80:81], s[84:85]
    v_mfma_f32_4x4x4_16b_bf16 v[76:79], v[10:11], v[86:87], v[76:79]
    s_mov_b64 exec, -1
    ds_read_b64 v[68:69], v92 offset:65408
    s_setprio 1
    s_waitcnt vmcnt(7)
    s_mov_b32 m0, s38
    s_nop 0
    ds_write_addtid_b32 v108 offset:0
    ds_write_addtid_b32 v109 offset:256
    ds_write_addtid_b32 v110 offset:512
    ds_write_addtid_b32 v111 offset:768
    s_waitcnt lgkmcnt(4)
    v_mfma_f32_4x4x4_16b_bf16 v[80:83], v[10:11], v[70:71], v[80:83]
    v_mfma_f32_4x4x4_16b_bf16 v[76:79], v[10:11], v[68:69], v[76:79]
    v_and_b32 v46, 0x40000000, v39
    v_bitop3_b32 v94, v36, v5, v46 bitop3:0xea
    v_and_b32 v46, 0x80000000, v39
    v_bitop3_b32 v95, v37, v5, v46 bitop3:0xea
    v_perm_b32 v15, v37, v38, s47
    v_bitop3_b32 v46, v37, 0.5, -0.5 bitop3:0xa8
    v_perm_b32 v14, v36, v38, s46
    v_bitop3_b32 v47, v36, 0.5, -0.5 bitop3:0xa8
    v_cvt_pk_bf16_f32 v80, v80, v81
    v_cvt_pk_bf16_f32 v81, v82, v83
    ds_wrxchg_rtn_b64 v[74:75], v93, v[80:81] offset:65408
    v_cvt_pk_bf16_f32 v76, v76, v77
    v_cvt_pk_bf16_f32 v77, v78, v79
    ds_wrxchg_rtn_b64 v[72:73], v92, v[76:77] offset:65408
    v_and_b32 v88, 0x0fffffff, v44
    v_mov_b32 v39, v44
    buffer_load_dwordx2 v[34:35], v88, s[8:11], 0 offen
    buffer_load_dwordx3 v[36:38], v88, s[8:11], 0 offen offset:8
    s_setprio 0
    s_waitcnt vmcnt(8)
    ds_write_addtid_b32 v112 offset:1024
    ds_write_addtid_b32 v113 offset:1280
    ds_write_addtid_b32 v114 offset:1536
    ds_write_addtid_b32 v115 offset:1792
    v_mfma_f32_4x4x4_16b_bf16 v[80:83], v[8:9], v[106:107], 0
    v_mfma_f32_4x4x4_16b_bf16 v[76:79], v[8:9], v[104:105], 0
    v_bitop3_b32 v15, v6, v15, v46 bitop3:0xca
    v_bitop3_b32 v14, v6, v14, v47 bitop3:0xca
    s_nop 1
    v_pk_mul_f32 v[80:81], v[80:81], v[14:15] op_sel:[0,1] op_sel_hi:[1,1]
    v_pk_mul_f32 v[82:83], v[82:83], v[14:15] op_sel:[0,1] op_sel_hi:[1,1]
    v_pk_mul_f32 v[76:77], v[76:77], v[14:15] op_sel:[0,0] op_sel_hi:[1,0]
    v_pk_mul_f32 v[78:79], v[78:79], v[14:15] op_sel:[0,0] op_sel_hi:[1,0]
    s_add_u32 s42, s42, 1
    s_waitcnt lgkmcnt(0)
    s_barrier
    s_bitcmp1_b32 s36, s42
    s_cbranch_scc1 L2_slow
L2_ret7:
    s_setprio 3
    v_cmp_ne_u64 s[50:51], v[72:73], v[68:69]
    v_cmpx_ne_u64 s[54:55], v[74:75], v[70:71]
    s_and_b64 s[82:83], s[54:55], s[80:81]
    s_cbranch_scc1 L2_c134
L2_d134:
    v_mov_b64 v[84:85], v[70:71]
    v_mov_b32 v7, v93
    v_mov_b64 v[86:87], v[74:75]
    s_or_b64 s[80:81], s[80:81], s[54:55]
    s_mov_b64 exec, s[50:51]
    s_and_b64 s[82:83], s[50:51], s[80:81]
    s_cbranch_scc1 L2_c135
L2_d135:
    v_mov_b64 v[84:85], v[68:69]
    v_mov_b32 v7, v92
    v_mov_b64 v[86:87], v[72:73]
    s_mov_b64 exec, -1
    s_or_b64 s[80:81], s[80:81], s[50:51]
    ds_read_b64 v[70:71], v95 offset:65408
    ds_read_b64 v[68:69], v94 offset:65408
    s_waitcnt vmcnt(6)
    v_and_b32 v46, 0x20000000, v21
    v_lshrrev_b32 v47, 14, v17
    v_bitop3_b32 v47, v47, v5, v46 bitop3:0xea
    ds_read_b64 v[102:103], v47
    v_bitop3_b32 v93, v17, v5, v46 bitop3:0xea
    v_and_b32 v46, 0x10000000, v21
    v_lshrrev_b32 v47, 14, v16
    v_bitop3_b32 v47, v47, v5, v46 bitop3:0xea
    ds_read_b64 v[100:101], v47
    v_bitop3_b32 v92, v16, v5, v46 bitop3:0xea
    s_waitcnt lgkmcnt(2)
    v_mfma_f32_4x4x4_16b_bf16 v[80:83], v[10:11], v[70:71], v[80:83]
    v_mfma_f32_4x4x4_16b_bf16 v[76:79], v[10:11], v[68:69], v[76:79]
    v_perm_b32 v15, v17, v20, s45
    v_bitop3_b32 v46, v17, 0.5, -0.5 bitop3:0xa8
    v_perm_b32 v14, v16, v20, s44
    v_bitop3_b32 v47, v16, 0.5, -0.5 bitop3:0xa8
    v_cvt_pk_bf16_f32 v80, v80, v81
    v_cvt_pk_bf16_f32 v81, v82, v83
    ds_wrxchg_rtn_b64 v[74:75], v95, v[80:81] offset:65408
    v_cvt_pk_bf16_f32 v76, v76, v77
    v_cvt_pk_bf16_f32 v77, v78, v79
    ds_wrxchg_rtn_b64 v[72:73], v94, v[76:77] offset:65408
    s_waitcnt lgkmcnt(2)
    v_mfma_f32_4x4x4_16b_bf16 v[80:83], v[8:9], v[102:103], 0
    v_mfma_f32_4x4x4_16b_bf16 v[76:79], v[8:9], v[100:101], 0
    v_bitop3_b32 v15, v6, v15, v46 bitop3:0xca
    v_bitop3_b32 v14, v6, v14, v47 bitop3:0xca
    v_cmp_lt_u32 s[84:85], v5, v92
    s_nop 0
    v_pk_mul_f32 v[80:81], v[80:81], v[14:15] op_sel:[0,1] op_sel_hi:[1,1]
    v_pk_mul_f32 v[82:83], v[82:83], v[14:15] op_sel:[0,1] op_sel_hi:[1,1]
    v_pk_mul_f32 v[76:77], v[76:77], v[14:15] op_sel:[0,0] op_sel_hi:[1,0]
    v_pk_mul_f32 v[78:79], v[78:79], v[14:15] op_sel:[0,0] op_sel_hi:[1,0]
    s_waitcnt lgkmcnt(0)
    v_cmp_ne_u64 s[50:51], v[72:73], v[68:69]
    v_cmpx_ne_u64 s[54:55], v[74:75], v[70:71]
    s_and_b64 s[82:83], s[54:55], s[80:81]
    s_cbranch_scc1 L2_c136
L2_d136:
    v_mov_b64 v[84:85], v[70:71]
    v_mov_b32 v7, v95
    v_mov_b64 v[86:87], v[74:75]
    s_or_b64 s[80:81], s[80:81], s[54:55]
    s_mov_b64 exec, s[50:51]
    s_and_b64 s[82:83], s[50:51], s[80:81]
    s_cbranch_scc1 L2_c137
L2_d137:
    v_mov_b64 v[84:85], v[68:69]
    v_mov_b32 v7, v94
    v_mov_b64 v[86:87], v[72:73]
    s_mov_b64 exec, -1
    s_or_b64 s[80:81], s[80:81], s[50:51]
    ds_read_b64 v[70:71], v93 offset:65408
    s_and_b64 exec, s[84:85], s[80:81]
    v_mfma_f32_4x4x4_16b_bf16 v[76:79], v[12:13], v[84:85], 0
    v_mov_b32 v92, v7
    s_andn2_b64 s[80:81], s[80:81], s[84:85]
    v_mfma_f32_4x4x4_16b_bf16 v[76:79], v[10:11], v[86:87], v[76:79]
    s_mov_b64 exec, -1
    ds_read_b64 v[68:69], v92 offset:65408
    v_and_b32 v46, 0x80000000, v21
    v_lshrrev_b32 v47, 14, v19
    v_bitop3_b32 v47, v47, v5, v46 bitop3:0xea
    ds_read_b64 v[106:107], v47
    v_bitop3_b32 v95, v19, v5, v46 bitop3:0xea
    v_and_b32 v46, 0x40000000, v21
    v_lshrrev_b32 v47, 14, v18
    v_bitop3_b32 v47, v47, v5, v46 bitop3:0xea
    ds_read_b64 v[104:105], v47
    v_bitop3_b32 v94, v18, v5, v46 bitop3:0xea
    s_waitcnt lgkmcnt(2)
    v_mfma_f32_4x4x4_16b_bf16 v[80:83], v[10:11], v[70:71], v[80:83]
    v_mfma_f32_4x4x4_16b_bf16 v[76:79], v[10:11], v[68:69], v[76:79]
    v_perm_b32 v15, v19, v20, s47
    v_bitop3_b32 v46, v19, 0.5, -0.5 bitop3:0xa8
    v_perm_b32 v14, v18, v20, s46
    v_bitop3_b32 v47, v18, 0.5, -0.5 bitop3:0xa8
    v_cvt_pk_bf16_f32 v80, v80, v81
    v_cvt_pk_bf16_f32 v81, v82, v83
    ds_wrxchg_rtn_b64 v[74:75], v93, v[80:81] offset:65408
    v_cvt_pk_bf16_f32 v76, v76, v77
    v_cvt_pk_bf16_f32 v77, v78, v79
    ds_wrxchg_rtn_b64 v[72:73], v92, v[76:77] offset:65408
    s_setprio 2
    s_waitcnt lgkmcnt(2)
    v_mfma_f32_4x4x4_16b_bf16 v[80:83], v[8:9], v[106:107], 0
    v_mfma_f32_4x4x4_16b_bf16 v[76:79], v[8:9], v[104:105], 0
    v_bitop3_b32 v15, v6, v15, v46 bitop3:0xca
    v_bitop3_b32 v14, v6, v14, v47 bitop3:0xca
    s_nop 1
    v_pk_mul_f32 v[80:81], v[80:81], v[14:15] op_sel:[0,1] op_sel_hi:[1,1]
    v_pk_mul_f32 v[82:83], v[82:83], v[14:15] op_sel:[0,1] op_sel_hi:[1,1]
    v_pk_mul_f32 v[76:77], v[76:77], v[14:15] op_sel:[0,0] op_sel_hi:[1,0]
    v_pk_mul_f32 v[78:79], v[78:79], v[14:15] op_sel:[0,0] op_sel_hi:[1,0]
    s_waitcnt lgkmcnt(0)
    v_cmp_ne_u64 s[50:51], v[72:73], v[68:69]
    v_cmpx_ne_u64 s[54:55], v[74:75], v[70:71]
    s_and_b64 s[82:83], s[54:55], s[80:81]
    s_cbranch_scc1 L2_c138
L2_d138:
    v_mov_b64 v[84:85], v[70:71]
    v_mov_b32 v7, v93
    v_mov_b64 v[86:87], v[74:75]
    s_or_b64 s[80:81], s[80:81], s[54:55]
    s_mov_b64 exec, s[50:51]
    s_and_b64 s[82:83], s[50:51], s[80:81]
    s_cbranch_scc1 L2_c139
L2_d139:
    v_mov_b64 v[84:85], v[68:69]
    v_mov_b32 v7, v92
    v_mov_b64 v[86:87], v[72:73]
    s_mov_b64 exec, -1
    s_or_b64 s[80:81], s[80:81], s[50:51]
    ds_read_b64 v[70:71], v95 offset:65408
    ds_read_b64 v[68:69], v94 offset:65408
    s_waitcnt vmcnt(4)
    v_and_b32 v46, 0x20000000, v27
    v_lshrrev_b32 v47, 14, v23
    v_bitop3_b32 v47, v47, v5, v46 bitop3:0xea
    ds_read_b64 v[102:103], v47
    v_bitop3_b32 v93, v23, v5, v46 bitop3:0xea
    v_and_b32 v46, 0x10000000, v27
    v_lshrrev_b32 v47, 14, v22
    v_bitop3_b32 v47, v47, v5, v46 bitop3:0xea
    ds_read_b64 v[100:101], v47
    v_bitop3_b32 v92, v22, v5, v46 bitop3:0xea
    s_waitcnt lgkmcnt(2)
    v_mfma_f32_4x4x4_16b_bf16 v[80:83], v[10:11], v[70:71], v[80:83]
    v_mfma_f32_4x4x4_16b_bf16 v[76:79], v[10:11], v[68:69], v[76:79]
    v_perm_b32 v15, v23, v26, s45
    v_bitop3_b32 v46, v23, 0.5, -0.5 bitop3:0xa8
    v_perm_b32 v14, v22, v26, s44
    v_bitop3_b32 v47, v22, 0.5, -0.5 bitop3:0xa8
    v_cvt_pk_bf16_f32 v80, v80, v81
    v_cvt_pk_bf16_f32 v81, v82, v83
    ds_wrxchg_rtn_b64 v[74:75], v95, v[80:81] offset:65408
    v_cvt_pk_bf16_f32 v76, v76, v77
    v_cvt_pk_bf16_f32 v77, v78, v79
    ds_wrxchg_rtn_b64 v[72:73], v94, v[76:77] offset:65408
    s_waitcnt lgkmcnt(2)
    v_mfma_f32_4x4x4_16b_bf16 v[80:83], v[8:9], v[102:103], 0
    v_mfma_f32_4x4x4_16b_bf16 v[76:79], v[8:9], v[100:101], 0
    v_bitop3_b32 v15, v6, v15, v46 bitop3:0xca
    v_bitop3_b32 v14, v6, v14, v47 bitop3:0xca
    v_cmp_lt_u32 s[84:85], v5, v92
    s_nop 0
    v_pk_mul_f32 v[80:81], v[80:81], v[14:15] op_sel:[0,1] op_sel_hi:[1,1]
    v_pk_mul_f32 v[82:83], v[82:83], v[14:15] op_sel:[0,1] op_sel_hi:[1,1]
    v_pk_mul_f32 v[76:77], v[76:77], v[14:15] op_sel:[0,0] op_sel_hi:[1,0]
    v_pk_mul_f32 v[78:79], v[78:79], v[14:15] op_sel:[0,0] op_sel_hi:[1,0]
    s_waitcnt lgkmcnt(0)
    v_cmp_ne_u64 s[50:51], v[72:73], v[68:69]
    v_cmpx_ne_u64 s[54:55], v[74:75], v[70:71]
    s_and_b64 s[82:83], s[54:55], s[80:81]
    s_cbranch_scc1 L2_c140
L2_d140:
    v_mov_b64 v[84:85], v[70:71]
    v_mov_b32 v7, v95
    v_mov_b64 v[86:87], v[74:75]
    s_or_b64 s[80:81], s[80:81], s[54:55]
    s_mov_b64 exec, s[50:51]
    s_and_b64 s[82:83], s[50:51], s[80:81]
    s_cbranch_scc1 L2_c141
L2_d141:
    v_mov_b64 v[84:85], v[68:69]
    v_mov_b32 v7, v94
    v_mov_b64 v[86:87], v[72:73]
    s_mov_b64 exec, -1
    s_or_b64 s[80:81], s[80:81], s[50:51]
    ds_read_b64 v[70:71], v93 offset:65408
    s_and_b64 exec, s[84:85], s[80:81]
    v_mfma_f32_4x4x4_16b_bf16 v[76:79], v[12:13], v[84:85], 0
    v_mov_b32 v92, v7
    s_andn2_b64 s[80:81], s[80:81], s[84:85]
    v_mfma_f32_4x4x4_16b_bf16 v[76:79], v[10:11], v[86:87], v[76:79]
    s_mov_b64 exec, -1
    ds_read_b64 v[68:69], v92 offset:65408
    v_and_b32 v46, 0x80000000, v27
    v_lshrrev_b32 v47, 14, v25
    v_bitop3_b32 v47, v47, v5, v46 bitop3:0xea
    ds_read_b64 v[106:107], v47
    v_bitop3_b32 v95, v25, v5, v46 bitop3:0xea
    v_and_b32 v46, 0x40000000, v27
    v_lshrrev_b32 v47, 14, v24
    v_bitop3_b32 v47, v47, v5, v46 bitop3:0xea
    ds_read_b64 v[104:105], v47
    v_bitop3_b32 v94, v24, v5, v46 bitop3:0xea
    s_waitcnt lgkmcnt(2)
    v_mfma_f32_4x4x4_16b_bf16 v[80:83], v[10:11], v[70:71], v[80:83]
    v_mfma_f32_4x4x4_16b_bf16 v[76:79], v[10:11], v[68:69], v[76:79]
    v_perm_b32 v15, v25, v26, s47
    v_bitop3_b32 v46, v25, 0.5, -0.5 bitop3:0xa8
    v_perm_b32 v14, v24, v26, s46
    v_bitop3_b32 v47, v24, 0.5, -0.5 bitop3:0xa8
    v_cvt_pk_bf16_f32 v80, v80, v81
    v_cvt_pk_bf16_f32 v81, v82, v83
    ds_wrxchg_rtn_b64 v[74:75], v93, v[80:81] offset:65408
    v_cvt_pk_bf16_f32 v76, v76, v77
    v_cvt_pk_bf16_f32 v77, v78, v79
    ds_wrxchg_rtn_b64 v[72:73], v92, v[76:77] offset:65408
    s_setprio 1
    s_waitcnt lgkmcnt(2)
    v_mfma_f32_4x4x4_16b_bf16 v[80:83], v[8:9], v[106:107], 0
    v_mfma_f32_4x4x4_16b_bf16 v[76:79], v[8:9], v[104:105], 0
    v_bitop3_b32 v15, v6, v15, v46 bitop3:0xca
    v_bitop3_b32 v14, v6, v14, v47 bitop3:0xca
    s_nop 1
    v_pk_mul_f32 v[80:81], v[80:81], v[14:15] op_sel:[0,1] op_sel_hi:[1,1]
    v_pk_mul_f32 v[82:83], v[82:83], v[14:15] op_sel:[0,1] op_sel_hi:[1,1]
    v_pk_mul_f32 v[76:77], v[76:77], v[14:15] op_sel:[0,0] op_sel_hi:[1,0]
    v_pk_mul_f32 v[78:79], v[78:79], v[14:15] op_sel:[0,0] op_sel_hi:[1,0]
    s_lshl_b32 s3, s32, 12
    v_subrev_u32 v122, s3, v3
    s_mul_i32 s3, s33, 20000
    v_add_u32 v118, s3, v122
    v_add_u32 v119, 0x4000, v118
    s_lshl_b32 s3, s34, 7
    v_lshrrev_b32 v123, 7, v118
    v_and_b32 v120, 0x70, v118
    v_lshl_add_u32 v120, v123, 13, v120
    v_add_u32 v120, s3, v120
    v_lshrrev_b32 v123, 7, v119
    v_and_b32 v121, 0x70, v119
    v_lshl_add_u32 v121, v123, 13, v121
    v_add_u32 v121, s3, v121
    v_cmp_le_u32 vcc, 3616, v122
    s_mov_b64 exec, vcc
    v_mov_b32 v119, 2.0
    v_mov_b32 v121, 2.0
    s_mov_b64 exec, -1
    v_and_b32 v123, 0x30, v122
    v_lshlrev_b32 v123, 2, v123
    buffer_load_dwordx4 v[48:51], v123, s[24:27], 0 offen
    buffer_load_dwordx4 v[52:55], v123, s[24:27], 0 offen offset:16
    buffer_load_dwordx2 v[56:57], v123, s[24:27], 0 offen offset:32
    s_mov_b32 s12, s4
    s_mov_b32 s13, s5
    s_mov_b32 s14, 0x138800
    s_mov_b32 s15, 0x20000
    s_mov_b32 s16, s28
    s_mov_b32 s17, s29
    s_mov_b32 s18, 0x4e2000
    s_mov_b32 s19, 0x20000
    v_lshrrev_b32 v123, 2, v120
    buffer_load_dword v116, v123, s[12:15], 0 offen
    buffer_load_dwordx4 v[108:111], v120, s[16:19], 0 offen
    v_lshrrev_b32 v123, 2, v121
    buffer_load_dword v117, v123, s[12:15], 0 offen
    buffer_load_dwordx4 v[112:115], v121, s[16:19], 0 offen
    s_waitcnt lgkmcnt(0)
    v_cmp_ne_u64 s[50:51], v[72:73], v[68:69]
    v_cmpx_ne_u64 s[54:55], v[74:75], v[70:71]
    s_and_b64 s[82:83], s[54:55], s[80:81]
    s_cbranch_scc1 L2_c142
L2_d142:
    v_mov_b64 v[84:85], v[70:71]
    v_mov_b32 v7, v93
    v_mov_b64 v[86:87], v[74:75]
    s_or_b64 s[80:81], s[80:81], s[54:55]
    s_mov_b64 exec, s[50:51]
    s_and_b64 s[82:83], s[50:51], s[80:81]
    s_cbranch_scc1 L2_c143
L2_d143:
    v_mov_b64 v[84:85], v[68:69]
    v_mov_b32 v7, v92
    v_mov_b64 v[86:87], v[72:73]
    s_mov_b64 exec, -1
    s_or_b64 s[80:81], s[80:81], s[50:51]
    ds_read_b64 v[70:71], v95 offset:65408
    ds_read_b64 v[68:69], v94 offset:65408
    s_waitcnt vmcnt(9)
    v_and_b32 v46, 0x20000000, v33
    v_lshrrev_b32 v47, 14, v29
    v_bitop3_b32 v47, v47, v5, v46 bitop3:0xea
    ds_read_b64 v[102:103], v47
    v_bitop3_b32 v93, v29, v5, v46 bitop3:0xea
    v_and_b32 v46, 0x10000000, v33
    v_lshrrev_b32 v47, 14, v28
    v_bitop3_b32 v47, v47, v5, v46 bitop3:0xea
    ds_read_b64 v[100:101], v47
    v_bitop3_b32 v92, v28, v5, v46 bitop3:0xea
    s_waitcnt lgkmcnt(2)
    v_mfma_f32_4x4x4_16b_bf16 v[80:83], v[10:11], v[70:71], v[80:83]
    v_mfma_f32_4x4x4_16b_bf16 v[76:79], v[10:11], v[68:69], v[76:79]
    v_perm_b32 v15, v29, v32, s45
    v_bitop3_b32 v46, v29, 0.5, -0.5 bitop3:0xa8
    v_perm_b32 v14, v28, v32, s44
    v_bitop3_b32 v47, v28, 0.5, -0.5 bitop3:0xa8
    v_cvt_pk_bf16_f32 v80, v80, v81
    v_cvt_pk_bf16_f32 v81, v82, v83
    ds_wrxchg_rtn_b64 v[74:75], v95, v[80:81] offset:65408
    v_cvt_pk_bf16_f32 v76, v76, v77
    v_cvt_pk_bf16_f32 v77, v78, v79
    ds_wrxchg_rtn_b64 v[72:73], v94, v[76:77] offset:65408
    s_waitcnt lgkmcnt(2)
    v_mfma_f32_4x4x4_16b_bf16 v[80:83], v[8:9], v[102:103], 0
    v_mfma_f32_4x4x4_16b_bf16 v[76:79], v[8:9], v[100:101], 0
    v_bitop3_b32 v15, v6, v15, v46 bitop3:0xca
    v_bitop3_b32 v14, v6, v14, v47 bitop3:0xca
    v_cmp_lt_u32 s[84:85], v5, v92
    s_nop 0
    v_pk_mul_f32 v[80:81], v[80:81], v[14:15] op_sel:[0,1] op_sel_hi:[1,1]
    v_pk_mul_f32 v[82:83], v[82:83], v[14:15] op_sel:[0,1] op_sel_hi:[1,1]
    v_pk_mul_f32 v[76:77], v[76:77], v[14:15] op_sel:[0,0] op_sel_hi:[1,0]
    v_pk_mul_f32 v[78:79], v[78:79], v[14:15] op_sel:[0,0] op_sel_hi:[1,0]
    s_waitcnt lgkmcnt(0)
    v_cmp_ne_u64 s[50:51], v[72:73], v[68:69]
    v_cmpx_ne_u64 s[54:55], v[74:75], v[70:71]
    s_and_b64 s[82:83], s[54:55], s[80:81]
    s_cbranch_scc1 L2_c144
L2_d144:
    v_mov_b64 v[84:85], v[70:71]
    v_mov_b32 v7, v95
    v_mov_b64 v[86:87], v[74:75]
    s_or_b64 s[80:81], s[80:81], s[54:55]
    s_mov_b64 exec, s[50:51]
    s_and_b64 s[82:83], s[50:51], s[80:81]
    s_cbranch_scc1 L2_c145
L2_d145:
    v_mov_b64 v[84:85], v[68:69]
    v_mov_b32 v7, v94
    v_mov_b64 v[86:87], v[72:73]
    s_mov_b64 exec, -1
    s_or_b64 s[80:81], s[80:81], s[50:51]
    ds_read_b64 v[70:71], v93 offset:65408
    s_and_b64 exec, s[84:85], s[80:81]
    v_mfma_f32_4x4x4_16b_bf16 v[76:79], v[12:13], v[84:85], 0
    v_mov_b32 v92, v7
    s_andn2_b64 s[80:81], s[80:81], s[84:85]
    v_mfma_f32_4x4x4_16b_bf16 v[76:79], v[10:11], v[86:87], v[76:79]
    s_mov_b64 exec, -1
    ds_read_b64 v[68:69], v92 offset:65408
    v_and_b32 v46, 0x80000000, v33
    v_lshrrev_b32 v47, 14, v31
    v_bitop3_b32 v47, v47, v5, v46 bitop3:0xea
    ds_read_b64 v[106:107], v47
    v_bitop3_b32 v95, v31, v5, v46 bitop3:0xea
    v_and_b32 v46, 0x40000000, v33
    v_lshrrev_b32 v47, 14, v30
    v_bitop3_b32 v47, v47, v5, v46 bitop3:0xea
    ds_read_b64 v[104:105], v47
    v_bitop3_b32 v94, v30, v5, v46 bitop3:0xea
    s_waitcnt lgkmcnt(2)
    v_mfma_f32_4x4x4_16b_bf16 v[80:83], v[10:11], v[70:71], v[80:83]
    v_mfma_f32_4x4x4_16b_bf16 v[76:79], v[10:11], v[68:69], v[76:79]
    v_perm_b32 v15, v31, v32, s47
    v_bitop3_b32 v46, v31, 0.5, -0.5 bitop3:0xa8
    v_perm_b32 v14, v30, v32, s46
    v_bitop3_b32 v47, v30, 0.5, -0.5 bitop3:0xa8
    v_cvt_pk_bf16_f32 v80, v80, v81
    v_cvt_pk_bf16_f32 v81, v82, v83
    ds_wrxchg_rtn_b64 v[74:75], v93, v[80:81] offset:65408
    v_cvt_pk_bf16_f32 v76, v76, v77
    v_cvt_pk_bf16_f32 v77, v78, v79
    ds_wrxchg_rtn_b64 v[72:73], v92, v[76:77] offset:65408
    s_setprio 0
    s_waitcnt lgkmcnt(2)
    v_mfma_f32_4x4x4_16b_bf16 v[80:83], v[8:9], v[106:107], 0
    v_mfma_f32_4x4x4_16b_bf16 v[76:79], v[8:9], v[104:105], 0
    v_bitop3_b32 v15, v6, v15, v46 bitop3:0xca
    v_bitop3_b32 v14, v6, v14, v47 bitop3:0xca
    s_nop 1
    v_pk_mul_f32 v[80:81], v[80:81], v[14:15] op_sel:[0,1] op_sel_hi:[1,1]
    v_pk_mul_f32 v[82:83], v[82:83], v[14:15] op_sel:[0,1] op_sel_hi:[1,1]
    v_pk_mul_f32 v[76:77], v[76:77], v[14:15] op_sel:[0,0] op_sel_hi:[1,0]
    v_pk_mul_f32 v[78:79], v[78:79], v[14:15] op_sel:[0,0] op_sel_hi:[1,0]
    s_waitcnt lgkmcnt(0)
    v_cmp_ne_u64 s[50:51], v[72:73], v[68:69]
    v_cmpx_ne_u64 s[54:55], v[74:75], v[70:71]
    s_and_b64 s[82:83], s[54:55], s[80:81]
    s_cbranch_scc1 L2_c146
L2_d146:
    v_mov_b64 v[84:85], v[70:71]
    v_mov_b32 v7, v93
    v_mov_b64 v[86:87], v[74:75]
    s_or_b64 s[80:81], s[80:81], s[54:55]
    s_mov_b64 exec, s[50:51]
    s_and_b64 s[82:83], s[50:51], s[80:81]
    s_cbranch_scc1 L2_c147
L2_d147:
    v_mov_b64 v[84:85], v[68:69]
    v_mov_b32 v7, v92
    v_mov_b64 v[86:87], v[72:73]
    s_mov_b64 exec, -1
    s_or_b64 s[80:81], s[80:81], s[50:51]
    ds_read_b64 v[70:71], v95 offset:65408
    ds_read_b64 v[68:69], v94 offset:65408
    s_waitcnt vmcnt(7)
    v_and_b32 v46, 0x20000000, v39
    v_lshrrev_b32 v47, 14, v35
    v_bitop3_b32 v47, v47, v5, v46 bitop3:0xea
    ds_read_b64 v[102:103], v47
    v_bitop3_b32 v93, v35, v5, v46 bitop3:0xea
    v_and_b32 v46, 0x10000000, v39
    v_lshrrev_b32 v47, 14, v34
    v_bitop3_b32 v47, v47, v5, v46 bitop3:0xea
    ds_read_b64 v[100:101], v47
    v_bitop3_b32 v92, v34, v5, v46 bitop3:0xea
    v_and_b32 v46, 0x80000000, v39
    v_lshrrev_b32 v47, 14, v37
    v_bitop3_b32 v47, v47, v5, v46 bitop3:0xea
    ds_read_b64 v[106:107], v47
    v_and_b32 v46, 0x40000000, v39
    v_lshrrev_b32 v47, 14, v36
    v_bitop3_b32 v47, v47, v5, v46 bitop3:0xea
    ds_read_b64 v[104:105], v47
    s_waitcnt lgkmcnt(4)
    v_mfma_f32_4x4x4_16b_bf16 v[80:83], v[10:11], v[70:71], v[80:83]
    v_mfma_f32_4x4x4_16b_bf16 v[76:79], v[10:11], v[68:69], v[76:79]
    v_perm_b32 v15, v35, v38, s45
    v_bitop3_b32 v46, v35, 0.5, -0.5 bitop3:0xa8
    v_perm_b32 v14, v34, v38, s44
    v_bitop3_b32 v47, v34, 0.5, -0.5 bitop3:0xa8
    v_cvt_pk_bf16_f32 v80, v80, v81
    v_cvt_pk_bf16_f32 v81, v82, v83
    ds_wrxchg_rtn_b64 v[74:75], v95, v[80:81] offset:65408
    v_cvt_pk_bf16_f32 v76, v76, v77
    v_cvt_pk_bf16_f32 v77, v78, v79
    ds_wrxchg_rtn_b64 v[72:73], v94, v[76:77] offset:65408
    s_waitcnt lgkmcnt(4)
    v_mfma_f32_4x4x4_16b_bf16 v[80:83], v[8:9], v[102:103], 0
    v_mfma_f32_4x4x4_16b_bf16 v[76:79], v[8:9], v[100:101], 0
    v_bitop3_b32 v15, v6, v15, v46 bitop3:0xca
    v_bitop3_b32 v14, v6, v14, v47 bitop3:0xca
    v_cmp_lt_u32 s[84:85], v5, v92
    s_nop 0
    v_pk_mul_f32 v[80:81], v[80:81], v[14:15] op_sel:[0,1] op_sel_hi:[1,1]
    v_pk_mul_f32 v[82:83], v[82:83], v[14:15] op_sel:[0,1] op_sel_hi:[1,1]
    v_pk_mul_f32 v[76:77], v[76:77], v[14:15] op_sel:[0,0] op_sel_hi:[1,0]
    v_pk_mul_f32 v[78:79], v[78:79], v[14:15] op_sel:[0,0] op_sel_hi:[1,0]
    s_waitcnt lgkmcnt(0)
    v_cmp_ne_u64 s[50:51], v[72:73], v[68:69]
    v_cmpx_ne_u64 s[54:55], v[74:75], v[70:71]
    s_and_b64 s[82:83], s[54:55], s[80:81]
    s_cbranch_scc1 L2_c148
L2_d148:
    v_mov_b64 v[84:85], v[70:71]
    v_mov_b32 v7, v95
    v_mov_b64 v[86:87], v[74:75]
    s_or_b64 s[80:81], s[80:81], s[54:55]
    s_mov_b64 exec, s[50:51]
    s_and_b64 s[82:83], s[50:51], s[80:81]
    s_cbranch_scc1 L2_c149
L2_d149:
    v_mov_b64 v[84:85], v[68:69]
    v_mov_b32 v7, v94
    v_mov_b64 v[86:87], v[72:73]
    s_mov_b64 exec, -1
    s_or_b64 s[80:81], s[80:81], s[50:51]
    ds_read_b64 v[70:71], v93 offset:65408
    s_and_b64 exec, s[84:85], s[80:81]
    v_mfma_f32_4x4x4_16b_bf16 v[76:79], v[12:13], v[84:85], 0
    v_mov_b32 v92, v7
    s_andn2_b64 s[80:81], s[80:81], s[84:85]
    v_mfma_f32_4x4x4_16b_bf16 v[76:79], v[10:11], v[86:87], v[76:79]
    s_mov_b64 exec, -1
    ds_read_b64 v[68:69], v92 offset:65408
    s_waitcnt lgkmcnt(0)
    v_mfma_f32_4x4x4_16b_bf16 v[80:83], v[10:11], v[70:71], v[80:83]
    v_mfma_f32_4x4x4_16b_bf16 v[76:79], v[10:11], v[68:69], v[76:79]
    v_and_b32 v46, 0x40000000, v39
    v_bitop3_b32 v94, v36, v5, v46 bitop3:0xea
    v_and_b32 v46, 0x80000000, v39
    v_bitop3_b32 v95, v37, v5, v46 bitop3:0xea
    v_perm_b32 v15, v37, v38, s47
    v_bitop3_b32 v46, v37, 0.5, -0.5 bitop3:0xa8
    v_perm_b32 v14, v36, v38, s46
    v_bitop3_b32 v47, v36, 0.5, -0.5 bitop3:0xa8
    v_cvt_pk_bf16_f32 v80, v80, v81
    v_cvt_pk_bf16_f32 v81, v82, v83
    ds_wrxchg_rtn_b64 v[74:75], v93, v[80:81] offset:65408
    v_cvt_pk_bf16_f32 v76, v76, v77
    v_cvt_pk_bf16_f32 v77, v78, v79
    ds_wrxchg_rtn_b64 v[72:73], v92, v[76:77] offset:65408
    v_mfma_f32_4x4x4_16b_bf16 v[80:83], v[8:9], v[106:107], 0
    v_mfma_f32_4x4x4_16b_bf16 v[76:79], v[8:9], v[104:105], 0
    v_bitop3_b32 v15, v6, v15, v46 bitop3:0xca
    v_bitop3_b32 v14, v6, v14, v47 bitop3:0xca
    s_nop 1
    v_pk_mul_f32 v[80:81], v[80:81], v[14:15] op_sel:[0,1] op_sel_hi:[1,1]
    v_pk_mul_f32 v[82:83], v[82:83], v[14:15] op_sel:[0,1] op_sel_hi:[1,1]
    v_pk_mul_f32 v[76:77], v[76:77], v[14:15] op_sel:[0,0] op_sel_hi:[1,0]
    v_pk_mul_f32 v[78:79], v[78:79], v[14:15] op_sel:[0,0] op_sel_hi:[1,0]
    s_waitcnt lgkmcnt(0)
    v_cmp_ne_u64 s[50:51], v[72:73], v[68:69]
    v_cmpx_ne_u64 s[54:55], v[74:75], v[70:71]
    s_and_b64 s[82:83], s[54:55], s[80:81]
    s_cbranch_scc1 L2_c150
L2_d150:
    v_mov_b64 v[84:85], v[70:71]
    v_mov_b32 v7, v93
    v_mov_b64 v[86:87], v[74:75]
    s_or_b64 s[80:81], s[80:81], s[54:55]
    s_mov_b64 exec, s[50:51]
    s_and_b64 s[82:83], s[50:51], s[80:81]
    s_cbranch_scc1 L2_c151
L2_d151:
    v_mov_b64 v[84:85], v[68:69]
    v_mov_b32 v7, v92
    v_mov_b64 v[86:87], v[72:73]
    s_mov_b64 exec, -1
    s_or_b64 s[80:81], s[80:81], s[50:51]
    ds_read_b64 v[70:71], v95 offset:65408
    ds_read_b64 v[68:69], v94 offset:65408
    s_waitcnt lgkmcnt(0)
    v_mfma_f32_4x4x4_16b_bf16 v[80:83], v[10:11], v[70:71], v[80:83]
    v_mfma_f32_4x4x4_16b_bf16 v[76:79], v[10:11], v[68:69], v[76:79]
    s_nop 3
    v_cvt_pk_bf16_f32 v80, v80, v81
    v_cvt_pk_bf16_f32 v81, v82, v83
    ds_wrxchg_rtn_b64 v[74:75], v95, v[80:81] offset:65408
    v_cvt_pk_bf16_f32 v76, v76, v77
    v_cvt_pk_bf16_f32 v77, v78, v79
    ds_wrxchg_rtn_b64 v[72:73], v94, v[76:77] offset:65408
    s_waitcnt lgkmcnt(0)
    v_cmpx_ne_u64 vcc, v[74:75], v[70:71]
    s_and_b64 s[82:83], vcc, s[80:81]
    s_cbranch_scc1 L2_c152
L2_d152:
    v_mov_b64 v[84:85], v[70:71]
    v_mov_b32 v7, v95
    v_mov_b64 v[86:87], v[74:75]
    s_mov_b64 exec, -1
    s_or_b64 s[80:81], s[80:81], vcc
    v_cmpx_ne_u64 vcc, v[72:73], v[68:69]
    s_and_b64 s[82:83], vcc, s[80:81]
    s_cbranch_scc1 L2_c153
L2_d153:
    v_mov_b64 v[84:85], v[68:69]
    v_mov_b32 v7, v94
    v_mov_b64 v[86:87], v[72:73]
    s_mov_b64 exec, -1
    s_or_b64 s[80:81], s[80:81], vcc
    s_mov_b64 exec, s[80:81]
    s_nop 1
    v_mfma_f32_4x4x4_16b_bf16 v[88:91], v[12:13], v[84:85], 0
    s_nop 1
    v_mfma_f32_4x4x4_16b_bf16 v[88:91], v[10:11], v[86:87], v[88:91]
    s_nop 4
    v_cvt_pk_bf16_f32 v88, v88, v89
    v_cvt_pk_bf16_f32 v89, v90, v91
    ds_pk_add_bf16 v7, v88 offset:65408
    ds_pk_add_bf16 v7, v89 offset:65412
    s_mov_b64 exec, -1
    s_load_dwordx2 s[4:5], s[0:1], 88
    v_add_u32 v123, 16384, v122
    v_add_u32 v124, 32768, v122
    v_add_u32 v125, 49152, v122
    v_add_u32 v126, 65536, v122
    s_lshl_b32 s50, s96, 16
    s_and_b32 s51, s96, 0xffff0000
    s_lshl_b32 s52, s97, 16
    s_and_b32 s53, s97, 0xffff0000
    s_lshl_b32 s54, s98, 16
    s_and_b32 s55, s98, 0xffff0000
    s_lshl_b32 s56, s99, 16
    s_and_b32 s57, s99, 0xffff0000
    s_waitcnt vmcnt(0) lgkmcnt(0)
    s_barrier
    v_add_u32 v36, 0x8000, v126
    ds_read_b128 v[16:19], v126 offset:16384
    ds_read_b128 v[20:23], v126 offset:32768
    ds_read_b128 v[24:27], v126 offset:49152
    ds_read_b128 v[28:31], v36 offset:32768
    ds_read_b128 v[32:35], v36 offset:49152
    s_add_u32 s8, s30, 0xebca000
    s_addc_u32 s9, s31, 0
    s_mov_b32 s10, 0x8000
    s_mov_b32 s11, 0x20000
    s_mov_b32 s12, s4
    s_mov_b32 s13, s5
    s_mov_b32 s14, 0x4e2000
    s_mov_b32 s15, 0x20000
    s_mul_i32 s3, s33, 20000
    v_subrev_u32 v36, s3, v122
    v_cmp_le_u32 vcc, 20000, v36
    s_waitcnt lgkmcnt(4)
    s_mov_b64 exec, vcc
    buffer_store_dwordx4 v[16:19], v122, s[20:23], 0 offen sc1
    s_mov_b64 exec, -1
    v_subrev_u32 v36, s3, v123
    v_cmp_le_u32 vcc, 20000, v36
    s_waitcnt lgkmcnt(3)
    s_mov_b64 exec, vcc
    buffer_store_dwordx4 v[20:23], v123, s[20:23], 0 offen sc1
    s_mov_b64 exec, -1
    v_subrev_u32 v36, s3, v124
    v_cmp_le_u32 vcc, 20000, v36
    s_waitcnt lgkmcnt(2)
    s_mov_b64 exec, vcc
    buffer_store_dwordx4 v[24:27], v124, s[20:23], 0 offen sc1
    s_mov_b64 exec, -1
    v_subrev_u32 v36, s3, v125
    v_cmp_le_u32 vcc, 20000, v36
    s_waitcnt lgkmcnt(1)
    s_mov_b64 exec, vcc
    buffer_store_dwordx4 v[28:31], v125, s[20:23], 0 offen sc1
    s_mov_b64 exec, -1
    v_subrev_u32 v36, s3, v126
    v_cmp_le_u32 vcc, 20000, v36
    s_waitcnt lgkmcnt(0)
    s_mov_b64 exec, vcc
    buffer_store_dwordx4 v[32:35], v126, s[20:23], 0 offen sc1
    s_mov_b64 exec, -1
    v_lshlrev_b32 v80, 16, v116
    v_subrev_f32 v60, s50, v80
    v_subrev_f32 v61, s51, v80
    v_subrev_f32 v62, s52, v80
    v_subrev_f32 v63, s53, v80
    v_subrev_f32 v64, s54, v80
    v_subrev_f32 v65, s55, v80
    v_subrev_f32 v66, s56, v80
    v_subrev_f32 v67, s57, v80
    v_cvt_pk_bf16_f32 v68, v60, v61
    v_cvt_pk_bf16_f32 v69, v62, v63
    v_cvt_pk_bf16_f32 v70, v64, v65
    v_cvt_pk_bf16_f32 v71, v66, v67
    v_lshlrev_b32 v60, 16, v68
    v_and_b32 v61, 0xffff0000, v68
    v_lshlrev_b32 v62, 16, v69
    v_and_b32 v63, 0xffff0000, v69
    v_lshlrev_b32 v64, 16, v70
    v_and_b32 v65, 0xffff0000, v70
    v_lshlrev_b32 v66, 16, v71
    v_and_b32 v67, 0xffff0000, v71
    v_mul_f32 v60, v60, v60
    v_mul_f32 v61, v61, v61
    v_mul_f32 v62, v62, v62
    v_mul_f32 v63, v63, v63
    v_mul_f32 v64, v64, v64
    v_mul_f32 v65, v65, v65
    v_mul_f32 v66, v66, v66
    v_mul_f32 v67, v67, v67
    v_cvt_pk_bf16_f32 v68, v60, v61
    v_cvt_pk_bf16_f32 v69, v62, v63
    v_cvt_pk_bf16_f32 v70, v64, v65
    v_cvt_pk_bf16_f32 v71, v66, v67
    v_lshlrev_b32 v60, 16, v68
    v_and_b32 v61, 0xffff0000, v68
    v_lshlrev_b32 v62, 16, v69
    v_and_b32 v63, 0xffff0000, v69
    v_lshlrev_b32 v64, 16, v70
    v_and_b32 v65, 0xffff0000, v70
    v_lshlrev_b32 v66, 16, v71
    v_and_b32 v67, 0xffff0000, v71
    v_mul_f32 v60, 0xc1200000, v60
    v_mul_f32 v61, 0xc1200000, v61
    v_mul_f32 v62, 0xc1200000, v62
    v_mul_f32 v63, 0xc1200000, v63
    v_mul_f32 v64, 0xc1200000, v64
    v_mul_f32 v65, 0xc1200000, v65
    v_mul_f32 v66, 0xc1200000, v66
    v_mul_f32 v67, 0xc1200000, v67
    v_cvt_pk_bf16_f32 v68, v60, v61
    v_cvt_pk_bf16_f32 v69, v62, v63
    v_cvt_pk_bf16_f32 v70, v64, v65
    v_cvt_pk_bf16_f32 v71, v66, v67
    v_lshlrev_b32 v60, 16, v68
    v_and_b32 v61, 0xffff0000, v68
    v_lshlrev_b32 v62, 16, v69
    v_and_b32 v63, 0xffff0000, v69
    v_lshlrev_b32 v64, 16, v70
    v_and_b32 v65, 0xffff0000, v70
    v_lshlrev_b32 v66, 16, v71
    v_and_b32 v67, 0xffff0000, v71
    v_mul_f32 v60, 0x3fb8aa3b, v60
    v_mul_f32 v61, 0x3fb8aa3b, v61
    v_mul_f32 v62, 0x3fb8aa3b, v62
    v_mul_f32 v63, 0x3fb8aa3b, v63
    v_mul_f32 v64, 0x3fb8aa3b, v64
    v_mul_f32 v65, 0x3fb8aa3b, v65
    v_mul_f32 v66, 0x3fb8aa3b, v66
    v_mul_f32 v67, 0x3fb8aa3b, v67
    v_exp_f32 v60, v60
    v_exp_f32 v61, v61
    v_exp_f32 v62, v62
    v_exp_f32 v63, v63
    v_exp_f32 v64, v64
    v_exp_f32 v65, v65
    v_exp_f32 v66, v66
    v_exp_f32 v67, v67
    v_cvt_pk_bf16_f32 v72, v60, v61
    v_cvt_pk_bf16_f32 v73, v62, v63
    v_cvt_pk_bf16_f32 v74, v64, v65
    v_cvt_pk_bf16_f32 v75, v66, v67
    v_and_b32 v80, 0xffff0000, v116
    v_subrev_f32 v60, s50, v80
    v_subrev_f32 v61, s51, v80
    v_subrev_f32 v62, s52, v80
    v_subrev_f32 v63, s53, v80
    v_subrev_f32 v64, s54, v80
    v_subrev_f32 v65, s55, v80
    v_subrev_f32 v66, s56, v80
    v_subrev_f32 v67, s57, v80
    v_cvt_pk_bf16_f32 v68, v60, v61
    v_cvt_pk_bf16_f32 v69, v62, v63
    v_cvt_pk_bf16_f32 v70, v64, v65
    v_cvt_pk_bf16_f32 v71, v66, v67
    v_lshlrev_b32 v60, 16, v68
    v_and_b32 v61, 0xffff0000, v68
    v_lshlrev_b32 v62, 16, v69
    v_and_b32 v63, 0xffff0000, v69
    v_lshlrev_b32 v64, 16, v70
    v_and_b32 v65, 0xffff0000, v70
    v_lshlrev_b32 v66, 16, v71
    v_and_b32 v67, 0xffff0000, v71
    v_mul_f32 v60, v60, v60
    v_mul_f32 v61, v61, v61
    v_mul_f32 v62, v62, v62
    v_mul_f32 v63, v63, v63
    v_mul_f32 v64, v64, v64
    v_mul_f32 v65, v65, v65
    v_mul_f32 v66, v66, v66
    v_mul_f32 v67, v67, v67
    v_cvt_pk_bf16_f32 v68, v60, v61
    v_cvt_pk_bf16_f32 v69, v62, v63
    v_cvt_pk_bf16_f32 v70, v64, v65
    v_cvt_pk_bf16_f32 v71, v66, v67
    v_lshlrev_b32 v60, 16, v68
    v_and_b32 v61, 0xffff0000, v68
    v_lshlrev_b32 v62, 16, v69
    v_and_b32 v63, 0xffff0000, v69
    v_lshlrev_b32 v64, 16, v70
    v_and_b32 v65, 0xffff0000, v70
    v_lshlrev_b32 v66, 16, v71
    v_and_b32 v67, 0xffff0000, v71
    v_mul_f32 v60, 0xc1200000, v60
    v_mul_f32 v61, 0xc1200000, v61
    v_mul_f32 v62, 0xc1200000, v62
    v_mul_f32 v63, 0xc1200000, v63
    v_mul_f32 v64, 0xc1200000, v64
    v_mul_f32 v65, 0xc1200000, v65
    v_mul_f32 v66, 0xc1200000, v66
    v_mul_f32 v67, 0xc1200000, v67
    v_cvt_pk_bf16_f32 v68, v60, v61
    v_cvt_pk_bf16_f32 v69, v62, v63
    v_cvt_pk_bf16_f32 v70, v64, v65
    v_cvt_pk_bf16_f32 v71, v66, v67
    v_lshlrev_b32 v60, 16, v68
    v_and_b32 v61, 0xffff0000, v68
    v_lshlrev_b32 v62, 16, v69
    v_and_b32 v63, 0xffff0000, v69
    v_lshlrev_b32 v64, 16, v70
    v_and_b32 v65, 0xffff0000, v70
    v_lshlrev_b32 v66, 16, v71
    v_and_b32 v67, 0xffff0000, v71
    v_mul_f32 v60, 0x3fb8aa3b, v60
    v_mul_f32 v61, 0x3fb8aa3b, v61
    v_mul_f32 v62, 0x3fb8aa3b, v62
    v_mul_f32 v63, 0x3fb8aa3b, v63
    v_mul_f32 v64, 0x3fb8aa3b, v64
    v_mul_f32 v65, 0x3fb8aa3b, v65
    v_mul_f32 v66, 0x3fb8aa3b, v66
    v_mul_f32 v67, 0x3fb8aa3b, v67
    v_exp_f32 v60, v60
    v_exp_f32 v61, v61
    v_exp_f32 v62, v62
    v_exp_f32 v63, v63
    v_exp_f32 v64, v64
    v_exp_f32 v65, v65
    v_exp_f32 v66, v66
    v_exp_f32 v67, v67
    v_cvt_pk_bf16_f32 v76, v60, v61
    v_cvt_pk_bf16_f32 v77, v62, v63
    v_cvt_pk_bf16_f32 v78, v64, v65
    v_cvt_pk_bf16_f32 v79, v66, v67
    v_mfma_f32_4x4x4_16b_bf16 v[80:83], v[48:49], v[72:73], 0
    v_mfma_f32_4x4x4_16b_bf16 v[88:91], v[52:53], v[72:73], 0
    v_mfma_f32_4x4x4_16b_bf16 v[84:87], v[48:49], v[76:77], 0
    v_mfma_f32_4x4x4_16b_bf16 v[92:95], v[52:53], v[76:77], 0
    v_mfma_f32_4x4x4_16b_bf16 v[80:83], v[50:51], v[74:75], v[80:83]
    v_mfma_f32_4x4x4_16b_bf16 v[88:91], v[54:55], v[74:75], v[88:91]
    v_mfma_f32_4x4x4_16b_bf16 v[84:87], v[50:51], v[78:79], v[84:87]
    v_mfma_f32_4x4x4_16b_bf16 v[92:95], v[54:55], v[78:79], v[92:95]
    v_add_u32 v104, 81920, v118
    ds_read_b128 v[32:35], v104
    v_add_u32 v104, 81920, v119
    ds_read_b128 v[60:63], v104
    s_add_u32 s20, s30, 0xd841000
    s_addc_u32 s21, s31, 0
    s_mov_b32 s22, 0x1388000
    s_mov_b32 s23, 0x20000
    s_add_u32 s3, s33, 1
    s_and_b32 s3, s3, 3
    s_lshl_b32 s3, s3, 6
    s_add_u32 s3, s3, s34
    s_mul_i32 s44, s3, 80000
    s_add_u32 s3, s33, 2
    s_and_b32 s3, s3, 3
    s_lshl_b32 s3, s3, 6
    s_add_u32 s3, s3, s34
    s_mul_i32 s45, s3, 80000
    s_add_u32 s3, s33, 3
    s_and_b32 s3, s3, 3
    s_lshl_b32 s3, s3, 6
    s_add_u32 s3, s3, s34
    s_mul_i32 s46, s3, 80000
    s_lshl_b32 s3, s34, 9
    s_lshl_b32 s4, s33, 7
    s_add_u32 s4, s4, s3
    v_mov_b32 v104, 1
    v_lshlrev_b32 v105, 3, v122
    s_waitcnt vmcnt(0)
    s_barrier
    s_cmp_lg_u32 s32, 0
    s_cbranch_scc1 L2_f2
    s_mov_b64 exec, 1
    buffer_store_dword v104, off, s[8:11], s4 sc1
    s_mov_b64 exec, 15
    s_bitset0_b64 exec, s33
L2_f3:
    buffer_load_dword v104, v105, s[8:11], s3 offen sc1
    s_waitcnt vmcnt(0)
    v_cmp_ne_u32 vcc, 1, v104
    s_cbranch_vccnz L2_f3
L2_f4:
    s_mov_b64 exec, -1
L2_f2:
    s_barrier
    buffer_load_dwordx4 v[36:39], v118, s[20:23], s44 offen sc1
    buffer_load_dwordx4 v[40:43], v118, s[20:23], s45 offen sc1
    buffer_load_dwordx4 v[44:47], v118, s[20:23], s46 offen sc1
    s_cmp_ge_u32 s32, 4
    s_cbranch_scc1 L2_f5
    buffer_load_dwordx4 v[64:67], v119, s[20:23], s44 offen sc1
    buffer_load_dwordx4 v[68:71], v119, s[20:23], s45 offen sc1
    buffer_load_dwordx4 v[72:75], v119, s[20:23], s46 offen sc1
    v_lshlrev_b32 v16, 16, v117
    v_subrev_f32 v96, s50, v16
    v_subrev_f32 v97, s51, v16
    v_subrev_f32 v98, s52, v16
    v_subrev_f32 v99, s53, v16
    v_subrev_f32 v100, s54, v16
    v_subrev_f32 v101, s55, v16
    v_subrev_f32 v102, s56, v16
    v_subrev_f32 v103, s57, v16
    v_cvt_pk_bf16_f32 v0, v96, v97
    v_cvt_pk_bf16_f32 v1, v98, v99
    v_cvt_pk_bf16_f32 v2, v100, v101
    v_cvt_pk_bf16_f32 v3, v102, v103
    v_lshlrev_b32 v96, 16, v0
    v_and_b32 v97, 0xffff0000, v0
    v_lshlrev_b32 v98, 16, v1
    v_and_b32 v99, 0xffff0000, v1
    v_lshlrev_b32 v100, 16, v2
    v_and_b32 v101, 0xffff0000, v2
    v_lshlrev_b32 v102, 16, v3
    v_and_b32 v103, 0xffff0000, v3
    v_mul_f32 v96, v96, v96
    v_mul_f32 v97, v97, v97
    v_mul_f32 v98, v98, v98
    v_mul_f32 v99, v99, v99
    v_mul_f32 v100, v100, v100
    v_mul_f32 v101, v101, v101
    v_mul_f32 v102, v102, v102
    v_mul_f32 v103, v103, v103
    v_cvt_pk_bf16_f32 v0, v96, v97
    v_cvt_pk_bf16_f32 v1, v98, v99
    v_cvt_pk_bf16_f32 v2, v100, v101
    v_cvt_pk_bf16_f32 v3, v102, v103
    v_lshlrev_b32 v96, 16, v0
    v_and_b32 v97, 0xffff0000, v0
    v_lshlrev_b32 v98, 16, v1
    v_and_b32 v99, 0xffff0000, v1
    v_lshlrev_b32 v100, 16, v2
    v_and_b32 v101, 0xffff0000, v2
    v_lshlrev_b32 v102, 16, v3
    v_and_b32 v103, 0xffff0000, v3
    v_mul_f32 v96, 0xc1200000, v96
    v_mul_f32 v97, 0xc1200000, v97
    v_mul_f32 v98, 0xc1200000, v98
    v_mul_f32 v99, 0xc1200000, v99
    v_mul_f32 v100, 0xc1200000, v100
    v_mul_f32 v101, 0xc1200000, v101
    v_mul_f32 v102, 0xc1200000, v102
    v_mul_f32 v103, 0xc1200000, v103
    v_cvt_pk_bf16_f32 v0, v96, v97
    v_cvt_pk_bf16_f32 v1, v98, v99
    v_cvt_pk_bf16_f32 v2, v100, v101
    v_cvt_pk_bf16_f32 v3, v102, v103
    v_lshlrev_b32 v96, 16, v0
    v_and_b32 v97, 0xffff0000, v0
    v_lshlrev_b32 v98, 16, v1
    v_and_b32 v99, 0xffff0000, v1
    v_lshlrev_b32 v100, 16, v2
    v_and_b32 v101, 0xffff0000, v2
    v_lshlrev_b32 v102, 16, v3
    v_and_b32 v103, 0xffff0000, v3
    v_mul_f32 v96, 0x3fb8aa3b, v96
    v_mul_f32 v97, 0x3fb8aa3b, v97
    v_mul_f32 v98, 0x3fb8aa3b, v98
    v_mul_f32 v99, 0x3fb8aa3b, v99
    v_mul_f32 v100, 0x3fb8aa3b, v100
    v_mul_f32 v101, 0x3fb8aa3b, v101
    v_mul_f32 v102, 0x3fb8aa3b, v102
    v_mul_f32 v103, 0x3fb8aa3b, v103
    v_exp_f32 v96, v96
    v_exp_f32 v97, v97
    v_exp_f32 v98, v98
    v_exp_f32 v99, v99
    v_exp_f32 v100, v100
    v_exp_f32 v101, v101
    v_exp_f32 v102, v102
    v_exp_f32 v103, v103
    v_cvt_pk_bf16_f32 v104, v96, v97
    v_cvt_pk_bf16_f32 v105, v98, v99
    v_cvt_pk_bf16_f32 v106, v100, v101
    v_cvt_pk_bf16_f32 v107, v102, v103
    v_and_b32 v16, 0xffff0000, v117
    v_subrev_f32 v96, s50, v16
    v_subrev_f32 v97, s51, v16
    v_subrev_f32 v98, s52, v16
    v_subrev_f32 v99, s53, v16
    v_subrev_f32 v100, s54, v16
    v_subrev_f32 v101, s55, v16
    v_subrev_f32 v102, s56, v16
    v_subrev_f32 v103, s57, v16
    v_cvt_pk_bf16_f32 v0, v96, v97
    v_cvt_pk_bf16_f32 v1, v98, v99
    v_cvt_pk_bf16_f32 v2, v100, v101
    v_cvt_pk_bf16_f32 v3, v102, v103
    v_lshlrev_b32 v96, 16, v0
    v_and_b32 v97, 0xffff0000, v0
    v_lshlrev_b32 v98, 16, v1
    v_and_b32 v99, 0xffff0000, v1
    v_lshlrev_b32 v100, 16, v2
    v_and_b32 v101, 0xffff0000, v2
    v_lshlrev_b32 v102, 16, v3
    v_and_b32 v103, 0xffff0000, v3
    v_mul_f32 v96, v96, v96
    v_mul_f32 v97, v97, v97
    v_mul_f32 v98, v98, v98
    v_mul_f32 v99, v99, v99
    v_mul_f32 v100, v100, v100
    v_mul_f32 v101, v101, v101
    v_mul_f32 v102, v102, v102
    v_mul_f32 v103, v103, v103
    v_cvt_pk_bf16_f32 v0, v96, v97
    v_cvt_pk_bf16_f32 v1, v98, v99
    v_cvt_pk_bf16_f32 v2, v100, v101
    v_cvt_pk_bf16_f32 v3, v102, v103
    v_lshlrev_b32 v96, 16, v0
    v_and_b32 v97, 0xffff0000, v0
    v_lshlrev_b32 v98, 16, v1
    v_and_b32 v99, 0xffff0000, v1
    v_lshlrev_b32 v100, 16, v2
    v_and_b32 v101, 0xffff0000, v2
    v_lshlrev_b32 v102, 16, v3
    v_and_b32 v103, 0xffff0000, v3
    v_mul_f32 v96, 0xc1200000, v96
    v_mul_f32 v97, 0xc1200000, v97
    v_mul_f32 v98, 0xc1200000, v98
    v_mul_f32 v99, 0xc1200000, v99
    v_mul_f32 v100, 0xc1200000, v100
    v_mul_f32 v101, 0xc1200000, v101
    v_mul_f32 v102, 0xc1200000, v102
    v_mul_f32 v103, 0xc1200000, v103
    v_cvt_pk_bf16_f32 v0, v96, v97
    v_cvt_pk_bf16_f32 v1, v98, v99
    v_cvt_pk_bf16_f32 v2, v100, v101
    v_cvt_pk_bf16_f32 v3, v102, v103
    v_lshlrev_b32 v96, 16, v0
    v_and_b32 v97, 0xffff0000, v0
    v_lshlrev_b32 v98, 16, v1
    v_and_b32 v99, 0xffff0000, v1
    v_lshlrev_b32 v100, 16, v2
    v_and_b32 v101, 0xffff0000, v2
    v_lshlrev_b32 v102, 16, v3
    v_and_b32 v103, 0xffff0000, v3
    v_mul_f32 v96, 0x3fb8aa3b, v96
    v_mul_f32 v97, 0x3fb8aa3b, v97
    v_mul_f32 v98, 0x3fb8aa3b, v98
    v_mul_f32 v99, 0x3fb8aa3b, v99
    v_mul_f32 v100, 0x3fb8aa3b, v100
    v_mul_f32 v101, 0x3fb8aa3b, v101
    v_mul_f32 v102, 0x3fb8aa3b, v102
    v_mul_f32 v103, 0x3fb8aa3b, v103
    v_exp_f32 v96, v96
    v_exp_f32 v97, v97
    v_exp_f32 v98, v98
    v_exp_f32 v99, v99
    v_exp_f32 v100, v100
    v_exp_f32 v101, v101
    v_exp_f32 v102, v102
    v_exp_f32 v103, v103
    v_cvt_pk_bf16_f32 v76, v96, v97
    v_cvt_pk_bf16_f32 v77, v98, v99
    v_cvt_pk_bf16_f32 v78, v100, v101
    v_cvt_pk_bf16_f32 v79, v102, v103
    v_mfma_f32_4x4x4_16b_bf16 v[16:19], v[48:49], v[104:105], 0
    v_mfma_f32_4x4x4_16b_bf16 v[24:27], v[52:53], v[104:105], 0
    v_mfma_f32_4x4x4_16b_bf16 v[20:23], v[48:49], v[76:77], 0
    v_mfma_f32_4x4x4_16b_bf16 v[28:31], v[52:53], v[76:77], 0
    v_mfma_f32_4x4x4_16b_bf16 v[16:19], v[50:51], v[106:107], v[16:19]
    v_mfma_f32_4x4x4_16b_bf16 v[24:27], v[54:55], v[106:107], v[24:27]
    v_mfma_f32_4x4x4_16b_bf16 v[20:23], v[50:51], v[78:79], v[20:23]
    v_mfma_f32_4x4x4_16b_bf16 v[28:31], v[54:55], v[78:79], v[28:31]
L2_f5:
    s_waitcnt vmcnt(0) lgkmcnt(0)
    v_mfma_f32_4x4x4_16b_bf16 v[96:99], v[10:11], v[32:33], 0
    v_mfma_f32_4x4x4_16b_bf16 v[100:103], v[10:11], v[34:35], 0
    s_nop 0
    v_mfma_f32_4x4x4_16b_bf16 v[96:99], v[10:11], v[36:37], v[96:99]
    v_mfma_f32_4x4x4_16b_bf16 v[100:103], v[10:11], v[38:39], v[100:103]
    s_nop 0
    v_mfma_f32_4x4x4_16b_bf16 v[96:99], v[10:11], v[40:41], v[96:99]
    v_mfma_f32_4x4x4_16b_bf16 v[100:103], v[10:11], v[42:43], v[100:103]
    s_nop 0
    v_mfma_f32_4x4x4_16b_bf16 v[96:99], v[10:11], v[44:45], v[96:99]
    v_mfma_f32_4x4x4_16b_bf16 v[100:103], v[10:11], v[46:47], v[100:103]
    s_nop 3
    v_mul_f32 v96, v96, v80
    v_mul_f32 v97, v97, v81
    v_mul_f32 v98, v98, v82
    v_mul_f32 v99, v99, v83
    v_cvt_pk_bf16_f32 v32, v96, v97
    v_cvt_pk_bf16_f32 v33, v98, v99
    v_mul_f32 v100, v100, v84
    v_mul_f32 v101, v101, v85
    v_mul_f32 v102, v102, v86
    v_mul_f32 v103, v103, v87
    v_cvt_pk_bf16_f32 v34, v100, v101
    v_cvt_pk_bf16_f32 v35, v102, v103
    v_mfma_f32_4x4x4_16b_bf16 v[80:83], v[56:57], v[32:33], 0
    s_nop 0
    v_mfma_f32_4x4x4_16b_bf16 v[84:87], v[56:57], v[34:35], 0
    s_nop 2
    v_mul_f32 v80, v80, v88
    v_mul_f32 v81, v81, v89
    v_mul_f32 v82, v82, v90
    v_mul_f32 v83, v83, v91
    v_mul_f32 v84, v84, v92
    v_mul_f32 v85, v85, v93
    v_mul_f32 v86, v86, v94
    v_mul_f32 v87, v87, v95
    v_mfma_f32_4x4x4_16b_bf16 v[96:99], v[10:11], v[108:109], v[80:83]
    s_nop 0
    v_mfma_f32_4x4x4_16b_bf16 v[100:103], v[10:11], v[110:111], v[84:87]
    s_nop 2
    v_cvt_pk_bf16_f32 v36, v96, v97
    v_cvt_pk_bf16_f32 v37, v98, v99
    v_cvt_pk_bf16_f32 v38, v100, v101
    v_cvt_pk_bf16_f32 v39, v102, v103
    buffer_store_dwordx4 v[36:39], v120, s[12:15], 0 offen
    s_cmp_ge_u32 s32, 4
    s_cbranch_scc1 L2_f6
    v_mfma_f32_4x4x4_16b_bf16 v[96:99], v[10:11], v[60:61], 0
    v_mfma_f32_4x4x4_16b_bf16 v[100:103], v[10:11], v[62:63], 0
    s_nop 0
    v_mfma_f32_4x4x4_16b_bf16 v[96:99], v[10:11], v[64:65], v[96:99]
    v_mfma_f32_4x4x4_16b_bf16 v[100:103], v[10:11], v[66:67], v[100:103]
    s_nop 0
    v_mfma_f32_4x4x4_16b_bf16 v[96:99], v[10:11], v[68:69], v[96:99]
    v_mfma_f32_4x4x4_16b_bf16 v[100:103], v[10:11], v[70:71], v[100:103]
    s_nop 0
    v_mfma_f32_4x4x4_16b_bf16 v[96:99], v[10:11], v[72:73], v[96:99]
    v_mfma_f32_4x4x4_16b_bf16 v[100:103], v[10:11], v[74:75], v[100:103]
    s_nop 3
    v_mul_f32 v96, v96, v16
    v_mul_f32 v97, v97, v17
    v_mul_f32 v98, v98, v18
    v_mul_f32 v99, v99, v19
    v_cvt_pk_bf16_f32 v60, v96, v97
    v_cvt_pk_bf16_f32 v61, v98, v99
    v_mul_f32 v100, v100, v20
    v_mul_f32 v101, v101, v21
    v_mul_f32 v102, v102, v22
    v_mul_f32 v103, v103, v23
    v_cvt_pk_bf16_f32 v62, v100, v101
    v_cvt_pk_bf16_f32 v63, v102, v103
    v_mfma_f32_4x4x4_16b_bf16 v[16:19], v[56:57], v[60:61], 0
    s_nop 0
    v_mfma_f32_4x4x4_16b_bf16 v[20:23], v[56:57], v[62:63], 0
    s_nop 2
    v_mul_f32 v16, v16, v24
    v_mul_f32 v17, v17, v25
    v_mul_f32 v18, v18, v26
    v_mul_f32 v19, v19, v27
    v_mul_f32 v20, v20, v28
    v_mul_f32 v21, v21, v29
    v_mul_f32 v22, v22, v30
    v_mul_f32 v23, v23, v31
    v_mfma_f32_4x4x4_16b_bf16 v[96:99], v[10:11], v[112:113], v[16:19]
    s_nop 0
    v_mfma_f32_4x4x4_16b_bf16 v[100:103], v[10:11], v[114:115], v[20:23]
    s_nop 2
    v_cvt_pk_bf16_f32 v64, v96, v97
    v_cvt_pk_bf16_f32 v65, v98, v99
    v_cvt_pk_bf16_f32 v66, v100, v101
    v_cvt_pk_bf16_f32 v67, v102, v103
    buffer_store_dwordx4 v[64:67], v121, s[12:15], 0 offen
L2_f6:
L2_end:
    s_endpgm
L2_slow:
    s_lshr_b32 s35, s42, 2
    s_lshl_b32 s50, s32, 4
    s_and_b32 s3, s42, 3
    s_lshl_b32 s53, s3, 3
    s_add_u32 s53, s53, s39
    s_and_b32 s3, s35, 2
    s_lshl_b32 s3, s3, 1
    s_add_u32 s53, s53, s3
    s_and_b32 s54, s35, 1
    s_lshl_b32 s54, s54, 4
L2_sl_seg:
    s_mul_i32 s55, s50, 173056
    s_and_b32 s3, s50, 3
    s_lshl_b32 s3, s3, 5
    s_add_u32 s3, s3, s55
    s_add_u32 s3, s3, s53
    buffer_load_dword v104, off, s[12:15], s3 sc1
    buffer_load_dword v105, off, s[12:15], s3 offset:32 sc1
    s_waitcnt vmcnt(0)
    v_readfirstlane_b32 s51, v104
    v_readfirstlane_b32 s52, v105
    s_lshr_b32 s51, s51, s54
    s_and_b32 s51, s51, 0xffff
    s_lshr_b32 s52, s52, s54
    s_and_b32 s52, s52, 0xffff
L2_sl_rec:
    s_cmp_ge_u32 s51, s52
    s_cbranch_scc1 L2_sl_next
    v_mbcnt_lo_u32_b32 v102, -1, 0
    v_mbcnt_hi_u32_b32 v102, -1, v102
    v_add_u32 v102, s51, v102
    v_and_b32 v103, -4, v102
    v_lshl_add_u32 v104, v102, 2, v103
    v_lshl_add_u32 v105, v103, 2, v102
    v_cmp_gt_u32 vcc, s52, v102
    s_mov_b64 exec, vcc
    buffer_load_dword v106, v104, s[8:11], s55 offen
    buffer_load_ubyte v107, v105, s[8:11], s55 offen offset:16
    s_waitcnt vmcnt(0)
    v_lshrrev_b32 v98, 14, v106
    v_and_b32 v98, v5, v98
    ds_read_b64 v[100:101], v98
    v_perm_b32 v97, v106, v107, s44
    v_and_b32 v96, v5, v106
    v_bitop3_b32 v103, v106, 0.5, -0.5 bitop3:0xa8
    v_bitop3_b32 v97, v6, v97, v103 bitop3:0xca
    s_waitcnt lgkmcnt(0)
    v_mfma_f32_4x4x4_16b_bf16 v[88:91], v[8:9], v[100:101], 0
    s_nop 4
    v_mul_f32 v88, v97, v88
    v_mul_f32 v89, v97, v89
    v_mul_f32 v90, v97, v90
    v_mul_f32 v91, v97, v91
    v_cvt_pk_bf16_f32 v88, v88, v89
    v_cvt_pk_bf16_f32 v89, v90, v91
    ds_pk_add_bf16 v96, v88 offset:65408
    ds_pk_add_bf16 v96, v89 offset:65412
    s_mov_b64 exec, -1
    s_add_u32 s51, s51, 64
    s_branch L2_sl_rec
L2_sl_next:
    s_add_u32 s50, s50, 1
    s_and_b32 s3, s50, 15
    s_cbranch_scc1 L2_sl_seg
    s_add_u32 s50, s50, 240
    s_cmp_lt_u32 s50, 1280
    s_cbranch_scc1 L2_sl_seg
    s_waitcnt lgkmcnt(0)
    s_cmp_eq_u32 s42, 0
    s_cbranch_scc1 L2_ret0
    s_cmp_eq_u32 s42, 1
    s_cbranch_scc1 L2_ret1
    s_cmp_eq_u32 s42, 14
    s_cbranch_scc1 L2_ret6
    s_cmp_eq_u32 s42, 15
    s_cbranch_scc1 L2_ret7
    s_and_b32 s3, s42, 3
    s_cmp_eq_u32 s3, 2
    s_cbranch_scc1 L2_ret2
    s_cmp_eq_u32 s3, 3
    s_cbranch_scc1 L2_ret3
    s_cmp_eq_u32 s3, 0
    s_cbranch_scc1 L2_ret4
    s_branch L2_ret5
L2_p1s:
    s_sleep 32
    s_branch L2_p1
L2_xo3:
    v_cmp_lt_u32 vcc, 20, v99
    s_mov_b32 s101, 1
    s_cbranch_vccz L2_xp3
    v_cmp_lt_u32 vcc, 32, v99
    v_cmp_lt_u32 s[58:59], 31, v88
    s_mov_b32 s101, 2
    s_or_b64 vcc, vcc, s[58:59]
    s_cbranch_scc0 L2_xp3
    s_mov_b32 s37, 0x10000
    s_branch L2_xp3
L2_xa4:
    s_cmp_eq_u32 s101, 1
    s_cbranch_scc1 L2_xc4
    v_lshlrev_b32 v89, 0, v96
    v_add_u32 v90, 140, v97
    v_bitop3_b32 v90, v89, v45, v90 bitop3:0x6a
    ds_write_b32 v98, v90 offset:28
    v_lshlrev_b32 v89, 4, v96
    v_add_u32 v90, 120, v97
    v_bitop3_b32 v90, v89, v45, v90 bitop3:0x6a
    ds_write_b32 v98, v90 offset:24
    v_lshlrev_b32 v89, 8, v96
    v_add_u32 v90, 100, v97
    v_bitop3_b32 v90, v89, v45, v90 bitop3:0x6a
    ds_write_b32 v98, v90 offset:20
L2_xc4:
    v_lshlrev_b32 v89, 12, v96
    v_add_u32 v90, 80, v97
    v_bitop3_b32 v90, v89, v45, v90 bitop3:0x6a
    ds_write_b32 v98, v90 offset:16
    s_branch L2_xb4
L2_xe4:
    v_cmp_lt_u32 vcc, 32, v99
    v_cmp_lt_u32 s[58:59], 31, v88
    v_lshrrev_b32 v89, 16, v96
    v_add_u32 v97, 80, v97
    s_or_b64 vcc, vcc, s[58:59]
    s_cbranch_scc1 L2_xs4
    v_lshlrev_b32 v89, v1, v89
    v_and_b32 v89, v45, v89
    v_cmp_ne_u32 vcc, 0, v89
    v_xor_b32 v90, v97, v89
    s_add_u32 s3, s37, s38
    v_mbcnt_lo_u32_b32 v98, vcc_lo, 0
    v_mbcnt_hi_u32_b32 v98, vcc_hi, v98
    s_bcnt1_i32_b64 s41, vcc
    v_lshl_add_u32 v98, v98, 2, s3
    s_mov_b64 exec, vcc
    ds_write_b32 v98, v90
    s_mov_b64 exec, -1
    s_lshl2_add_u32 s37, s41, s37
    s_branch L2_xr4
L2_xf4:
    s_waitcnt lgkmcnt(0)
    s_cmp_gt_u32 s37, 1024
    s_cbranch_scc1 L2_xs4
    v_mov_b32 v43, -1
    s_cmp_ge_u32 s37, 512
    s_cbranch_scc1 L2_xg4
    v_mov_b32 v42, -1
    s_cmp_ge_u32 s37, 256
    s_cbranch_scc1 L2_xg4
    v_mov_b32 v41, -1
    s_branch L2_xg4
L2_xs4:
    s_waitcnt lgkmcnt(0)
    v_mov_b32 v40, -1
    v_mov_b32 v41, -1
    v_mov_b32 v42, -1
    v_mov_b32 v43, -1
    s_add_u32 s3, s42, 0
    s_bitset1_b32 s36, s3
    s_branch L2_xg4
L2_xo5:
    v_cmp_lt_u32 vcc, 20, v99
    s_mov_b32 s101, 1
    s_cbranch_vccz L2_xp5
    v_cmp_lt_u32 vcc, 32, v99
    v_cmp_lt_u32 s[58:59], 31, v88
    s_mov_b32 s101, 2
    s_or_b64 vcc, vcc, s[58:59]
    s_cbranch_scc0 L2_xp5
    s_mov_b32 s37, 0x10000
    s_branch L2_xp5
L2_xa6:
    s_cmp_eq_u32 s101, 1
    s_cbranch_scc1 L2_xc6
    v_lshlrev_b32 v89, 0, v96
    v_add_u32 v90, 140, v97
    v_bitop3_b32 v90, v89, v45, v90 bitop3:0x6a
    ds_write_b32 v98, v90 offset:28
    v_lshlrev_b32 v89, 4, v96
    v_add_u32 v90, 120, v97
    v_bitop3_b32 v90, v89, v45, v90 bitop3:0x6a
    ds_write_b32 v98, v90 offset:24
    v_lshlrev_b32 v89, 8, v96
    v_add_u32 v90, 100, v97
    v_bitop3_b32 v90, v89, v45, v90 bitop3:0x6a
    ds_write_b32 v98, v90 offset:20
L2_xc6:
    v_lshlrev_b32 v89, 12, v96
    v_add_u32 v90, 80, v97
    v_bitop3_b32 v90, v89, v45, v90 bitop3:0x6a
    ds_write_b32 v98, v90 offset:16
    s_branch L2_xb6
L2_xe6:
    v_cmp_lt_u32 vcc, 32, v99
    v_cmp_lt_u32 s[58:59], 31, v88
    v_lshrrev_b32 v89, 16, v96
    v_add_u32 v97, 80, v97
    s_or_b64 vcc, vcc, s[58:59]
    s_cbranch_scc1 L2_xs6
    v_lshlrev_b32 v89, v1, v89
    v_and_b32 v89, v45, v89
    v_cmp_ne_u32 vcc, 0, v89
    v_xor_b32 v90, v97, v89
    s_add_u32 s3, s37, s38
    v_mbcnt_lo_u32_b32 v98, vcc_lo, 0
    v_mbcnt_hi_u32_b32 v98, vcc_hi, v98
    s_bcnt1_i32_b64 s41, vcc
    v_lshl_add_u32 v98, v98, 2, s3
    s_mov_b64 exec, vcc
    ds_write_b32 v98, v90
    s_mov_b64 exec, -1
    s_lshl2_add_u32 s37, s41, s37
    s_branch L2_xr6
L2_xf6:
    s_waitcnt lgkmcnt(0)
    s_cmp_gt_u32 s37, 1024
    s_cbranch_scc1 L2_xs6
    v_mov_b32 v43, -1
    s_cmp_ge_u32 s37, 512
    s_cbranch_scc1 L2_xg6
    v_mov_b32 v42, -1
    s_cmp_ge_u32 s37, 256
    s_cbranch_scc1 L2_xg6
    v_mov_b32 v41, -1
    s_branch L2_xg6
L2_xs6:
    s_waitcnt lgkmcnt(0)
    v_mov_b32 v40, -1
    v_mov_b32 v41, -1
    v_mov_b32 v42, -1
    v_mov_b32 v43, -1
    s_add_u32 s3, s42, 1
    s_bitset1_b32 s36, s3
    s_branch L2_xg6
L2_p2s:
    s_sleep 8
    s_branch L2_p2
L2_c7:
    s_lshl_b64 s[52:53], s[82:83], 1
    s_andn2_b64 s[52:53], s[52:53], s[80:81]
    s_andn2_b64 s[52:53], s[52:53], s[54:55]
    s_or_b64 s[80:81], s[80:81], s[52:53]
    s_not_b64 vcc, s[52:53]
    s_mov_b64 exec, -1
    v_cndmask_b32_dpp v84, v84, v84, vcc wave_shr:1 row_mask:0xf bank_mask:0xf
    v_cndmask_b32_dpp v85, v85, v85, vcc wave_shr:1 row_mask:0xf bank_mask:0xf
    s_lshr_b64 s[52:53], s[52:53], 1
    v_cndmask_b32_dpp v86, v86, v86, vcc wave_shr:1 row_mask:0xf bank_mask:0xf
    v_cndmask_b32_dpp v87, v87, v87, vcc wave_shr:1 row_mask:0xf bank_mask:0xf
    s_andn2_b64 s[82:83], s[82:83], s[52:53]
    v_cndmask_b32_dpp v7, v7, v7, vcc wave_shr:1 row_mask:0xf bank_mask:0xf
    s_mov_b64 exec, s[54:55]
    s_cbranch_scc0 L2_d7
    s_mov_b64 exec, s[82:83]
    s_nop 1
    v_mfma_f32_4x4x4_16b_bf16 v[88:91], v[12:13], v[84:85], 0
    s_nop 1
    v_mfma_f32_4x4x4_16b_bf16 v[88:91], v[10:11], v[86:87], v[88:91]
    s_nop 4
    v_cvt_pk_bf16_f32 v88, v88, v89
    v_cvt_pk_bf16_f32 v89, v90, v91
    ds_pk_add_bf16 v7, v88 offset:65408
    ds_pk_add_bf16 v7, v89 offset:65412
    s_mov_b64 exec, s[54:55]
    s_branch L2_d7
L2_c8:
    s_lshl_b64 s[52:53], s[82:83], 1
    s_andn2_b64 s[52:53], s[52:53], s[80:81]
    s_andn2_b64 s[52:53], s[52:53], s[50:51]
    s_or_b64 s[80:81], s[80:81], s[52:53]
    s_not_b64 vcc, s[52:53]
    s_mov_b64 exec, -1
    v_cndmask_b32_dpp v84, v84, v84, vcc wave_shr:1 row_mask:0xf bank_mask:0xf
    v_cndmask_b32_dpp v85, v85, v85, vcc wave_shr:1 row_mask:0xf bank_mask:0xf
    s_lshr_b64 s[52:53], s[52:53], 1
    v_cndmask_b32_dpp v86, v86, v86, vcc wave_shr:1 row_mask:0xf bank_mask:0xf
    v_cndmask_b32_dpp v87, v87, v87, vcc wave_shr:1 row_mask:0xf bank_mask:0xf
    s_andn2_b64 s[82:83], s[82:83], s[52:53]
    v_cndmask_b32_dpp v7, v7, v7, vcc wave_shr:1 row_mask:0xf bank_mask:0xf
    s_mov_b64 exec, s[50:51]
    s_cbranch_scc0 L2_d8
    s_mov_b64 exec, s[82:83]
    s_nop 1
    v_mfma_f32_4x4x4_16b_bf16 v[88:91], v[12:13], v[84:85], 0
    s_nop 1
    v_mfma_f32_4x4x4_16b_bf16 v[88:91], v[10:11], v[86:87], v[88:91]
    s_nop 4
    v_cvt_pk_bf16_f32 v88, v88, v89
    v_cvt_pk_bf16_f32 v89, v90, v91
    ds_pk_add_bf16 v7, v88 offset:65408
    ds_pk_add_bf16 v7, v89 offset:65412
    s_mov_b64 exec, s[50:51]
    s_branch L2_d8
L2_xo9:
    v_cmp_lt_u32 vcc, 20, v99
    s_mov_b32 s101, 1
    s_cbranch_vccz L2_xp9
    v_cmp_lt_u32 vcc, 32, v99
    v_cmp_lt_u32 s[58:59], 31, v88
    s_mov_b32 s101, 2
    s_or_b64 vcc, vcc, s[58:59]
    s_cbranch_scc0 L2_xp9
    s_mov_b32 s37, 0x10000
    s_branch L2_xp9
L2_c12:
    s_lshl_b64 s[52:53], s[82:83], 1
    s_andn2_b64 s[52:53], s[52:53], s[80:81]
    s_andn2_b64 s[52:53], s[52:53], s[54:55]
    s_or_b64 s[80:81], s[80:81], s[52:53]
    s_not_b64 vcc, s[52:53]
    s_mov_b64 exec, -1
    v_cndmask_b32_dpp v84, v84, v84, vcc wave_shr:1 row_mask:0xf bank_mask:0xf
    v_cndmask_b32_dpp v85, v85, v85, vcc wave_shr:1 row_mask:0xf bank_mask:0xf
    s_lshr_b64 s[52:53], s[52:53], 1
    v_cndmask_b32_dpp v86, v86, v86, vcc wave_shr:1 row_mask:0xf bank_mask:0xf
    v_cndmask_b32_dpp v87, v87, v87, vcc wave_shr:1 row_mask:0xf bank_mask:0xf
    s_andn2_b64 s[82:83], s[82:83], s[52:53]
    v_cndmask_b32_dpp v7, v7, v7, vcc wave_shr:1 row_mask:0xf bank_mask:0xf
    s_mov_b64 exec, s[54:55]
    s_cbranch_scc0 L2_d12
    s_mov_b64 exec, s[82:83]
    s_nop 1
    v_mfma_f32_4x4x4_16b_bf16 v[88:91], v[12:13], v[84:85], 0
    s_nop 1
    v_mfma_f32_4x4x4_16b_bf16 v[88:91], v[10:11], v[86:87], v[88:91]
    s_nop 4
    v_cvt_pk_bf16_f32 v88, v88, v89
    v_cvt_pk_bf16_f32 v89, v90, v91
    ds_pk_add_bf16 v7, v88 offset:65408
    ds_pk_add_bf16 v7, v89 offset:65412
    s_mov_b64 exec, s[54:55]
    s_branch L2_d12
L2_c13:
    s_lshl_b64 s[52:53], s[82:83], 1
    s_andn2_b64 s[52:53], s[52:53], s[80:81]
    s_andn2_b64 s[52:53], s[52:53], s[50:51]
    s_or_b64 s[80:81], s[80:81], s[52:53]
    s_not_b64 vcc, s[52:53]
    s_mov_b64 exec, -1
    v_cndmask_b32_dpp v84, v84, v84, vcc wave_shr:1 row_mask:0xf bank_mask:0xf
    v_cndmask_b32_dpp v85, v85, v85, vcc wave_shr:1 row_mask:0xf bank_mask:0xf
    s_lshr_b64 s[52:53], s[52:53], 1
    v_cndmask_b32_dpp v86, v86, v86, vcc wave_shr:1 row_mask:0xf bank_mask:0xf
    v_cndmask_b32_dpp v87, v87, v87, vcc wave_shr:1 row_mask:0xf bank_mask:0xf
    s_andn2_b64 s[82:83], s[82:83], s[52:53]
    v_cndmask_b32_dpp v7, v7, v7, vcc wave_shr:1 row_mask:0xf bank_mask:0xf
    s_mov_b64 exec, s[50:51]
    s_cbranch_scc0 L2_d13
    s_mov_b64 exec, s[82:83]
    s_nop 1
    v_mfma_f32_4x4x4_16b_bf16 v[88:91], v[12:13], v[84:85], 0
    s_nop 1
    v_mfma_f32_4x4x4_16b_bf16 v[88:91], v[10:11], v[86:87], v[88:91]
    s_nop 4
    v_cvt_pk_bf16_f32 v88, v88, v89
    v_cvt_pk_bf16_f32 v89, v90, v91
    ds_pk_add_bf16 v7, v88 offset:65408
    ds_pk_add_bf16 v7, v89 offset:65412
    s_mov_b64 exec, s[50:51]
    s_branch L2_d13
L2_c15:
    s_lshl_b64 s[52:53], s[82:83], 1
    s_andn2_b64 s[52:53], s[52:53], s[80:81]
    s_andn2_b64 s[52:53], s[52:53], s[54:55]
    s_or_b64 s[80:81], s[80:81], s[52:53]
    s_not_b64 vcc, s[52:53]
    s_mov_b64 exec, -1
    v_cndmask_b32_dpp v84, v84, v84, vcc wave_shr:1 row_mask:0xf bank_mask:0xf
    v_cndmask_b32_dpp v85, v85, v85, vcc wave_shr:1 row_mask:0xf bank_mask:0xf
    s_lshr_b64 s[52:53], s[52:53], 1
    v_cndmask_b32_dpp v86, v86, v86, vcc wave_shr:1 row_mask:0xf bank_mask:0xf
    v_cndmask_b32_dpp v87, v87, v87, vcc wave_shr:1 row_mask:0xf bank_mask:0xf
    s_andn2_b64 s[82:83], s[82:83], s[52:53]
    v_cndmask_b32_dpp v7, v7, v7, vcc wave_shr:1 row_mask:0xf bank_mask:0xf
    s_mov_b64 exec, s[54:55]
    s_cbranch_scc0 L2_d15
    s_mov_b64 exec, s[82:83]
    s_nop 1
    v_mfma_f32_4x4x4_16b_bf16 v[88:91], v[12:13], v[84:85], 0
    s_nop 1
    v_mfma_f32_4x4x4_16b_bf16 v[88:91], v[10:11], v[86:87], v[88:91]
    s_nop 4
    v_cvt_pk_bf16_f32 v88, v88, v89
    v_cvt_pk_bf16_f32 v89, v90, v91
    ds_pk_add_bf16 v7, v88 offset:65408
    ds_pk_add_bf16 v7, v89 offset:65412
    s_mov_b64 exec, s[54:55]
    s_branch L2_d15
L2_c16:
    s_lshl_b64 s[52:53], s[82:83], 1
    s_andn2_b64 s[52:53], s[52:53], s[80:81]
    s_andn2_b64 s[52:53], s[52:53], s[50:51]
    s_or_b64 s[80:81], s[80:81], s[52:53]
    s_not_b64 vcc, s[52:53]
    s_mov_b64 exec, -1
    v_cndmask_b32_dpp v84, v84, v84, vcc wave_shr:1 row_mask:0xf bank_mask:0xf
    v_cndmask_b32_dpp v85, v85, v85, vcc wave_shr:1 row_mask:0xf bank_mask:0xf
    s_lshr_b64 s[52:53], s[52:53], 1
    v_cndmask_b32_dpp v86, v86, v86, vcc wave_shr:1 row_mask:0xf bank_mask:0xf
    v_cndmask_b32_dpp v87, v87, v87, vcc wave_shr:1 row_mask:0xf bank_mask:0xf
    s_andn2_b64 s[82:83], s[82:83], s[52:53]
    v_cndmask_b32_dpp v7, v7, v7, vcc wave_shr:1 row_mask:0xf bank_mask:0xf
    s_mov_b64 exec, s[50:51]
    s_cbranch_scc0 L2_d16
    s_mov_b64 exec, s[82:83]
    s_nop 1
    v_mfma_f32_4x4x4_16b_bf16 v[88:91], v[12:13], v[84:85], 0
    s_nop 1
    v_mfma_f32_4x4x4_16b_bf16 v[88:91], v[10:11], v[86:87], v[88:91]
    s_nop 4
    v_cvt_pk_bf16_f32 v88, v88, v89
    v_cvt_pk_bf16_f32 v89, v90, v91
    ds_pk_add_bf16 v7, v88 offset:65408
    ds_pk_add_bf16 v7, v89 offset:65412
    s_mov_b64 exec, s[50:51]
    s_branch L2_d16
L2_c19:
    s_lshl_b64 s[52:53], s[82:83], 1
    s_andn2_b64 s[52:53], s[52:53], s[80:81]
    s_andn2_b64 s[52:53], s[52:53], s[54:55]
    s_or_b64 s[80:81], s[80:81], s[52:53]
    s_not_b64 vcc, s[52:53]
    s_mov_b64 exec, -1
    v_cndmask_b32_dpp v84, v84, v84, vcc wave_shr:1 row_mask:0xf bank_mask:0xf
    v_cndmask_b32_dpp v85, v85, v85, vcc wave_shr:1 row_mask:0xf bank_mask:0xf
    s_lshr_b64 s[52:53], s[52:53], 1
    v_cndmask_b32_dpp v86, v86, v86, vcc wave_shr:1 row_mask:0xf bank_mask:0xf
    v_cndmask_b32_dpp v87, v87, v87, vcc wave_shr:1 row_mask:0xf bank_mask:0xf
    s_andn2_b64 s[82:83], s[82:83], s[52:53]
    v_cndmask_b32_dpp v7, v7, v7, vcc wave_shr:1 row_mask:0xf bank_mask:0xf
    s_mov_b64 exec, s[54:55]
    s_cbranch_scc0 L2_d19
    s_mov_b64 exec, s[82:83]
    s_nop 1
    v_mfma_f32_4x4x4_16b_bf16 v[88:91], v[12:13], v[84:85], 0
    s_nop 1
    v_mfma_f32_4x4x4_16b_bf16 v[88:91], v[10:11], v[86:87], v[88:91]
    s_nop 4
    v_cvt_pk_bf16_f32 v88, v88, v89
    v_cvt_pk_bf16_f32 v89, v90, v91
    ds_pk_add_bf16 v7, v88 offset:65408
    ds_pk_add_bf16 v7, v89 offset:65412
    s_mov_b64 exec, s[54:55]
    s_branch L2_d19
L2_c20:
    s_lshl_b64 s[52:53], s[82:83], 1
    s_andn2_b64 s[52:53], s[52:53], s[80:81]
    s_andn2_b64 s[52:53], s[52:53], s[50:51]
    s_or_b64 s[80:81], s[80:81], s[52:53]
    s_not_b64 vcc, s[52:53]
    s_mov_b64 exec, -1
    v_cndmask_b32_dpp v84, v84, v84, vcc wave_shr:1 row_mask:0xf bank_mask:0xf
    v_cndmask_b32_dpp v85, v85, v85, vcc wave_shr:1 row_mask:0xf bank_mask:0xf
    s_lshr_b64 s[52:53], s[52:53], 1
    v_cndmask_b32_dpp v86, v86, v86, vcc wave_shr:1 row_mask:0xf bank_mask:0xf
    v_cndmask_b32_dpp v87, v87, v87, vcc wave_shr:1 row_mask:0xf bank_mask:0xf
    s_andn2_b64 s[82:83], s[82:83], s[52:53]
    v_cndmask_b32_dpp v7, v7, v7, vcc wave_shr:1 row_mask:0xf bank_mask:0xf
    s_mov_b64 exec, s[50:51]
    s_cbranch_scc0 L2_d20
    s_mov_b64 exec, s[82:83]
    s_nop 1
    v_mfma_f32_4x4x4_16b_bf16 v[88:91], v[12:13], v[84:85], 0
    s_nop 1
    v_mfma_f32_4x4x4_16b_bf16 v[88:91], v[10:11], v[86:87], v[88:91]
    s_nop 4
    v_cvt_pk_bf16_f32 v88, v88, v89
    v_cvt_pk_bf16_f32 v89, v90, v91
    ds_pk_add_bf16 v7, v88 offset:65408
    ds_pk_add_bf16 v7, v89 offset:65412
    s_mov_b64 exec, s[50:51]
    s_branch L2_d20
L2_c21:
    s_lshl_b64 s[52:53], s[82:83], 1
    s_andn2_b64 s[52:53], s[52:53], s[80:81]
    s_andn2_b64 s[52:53], s[52:53], s[54:55]
    s_or_b64 s[80:81], s[80:81], s[52:53]
    s_not_b64 vcc, s[52:53]
    s_mov_b64 exec, -1
    v_cndmask_b32_dpp v84, v84, v84, vcc wave_shr:1 row_mask:0xf bank_mask:0xf
    v_cndmask_b32_dpp v85, v85, v85, vcc wave_shr:1 row_mask:0xf bank_mask:0xf
    s_lshr_b64 s[52:53], s[52:53], 1
    v_cndmask_b32_dpp v86, v86, v86, vcc wave_shr:1 row_mask:0xf bank_mask:0xf
    v_cndmask_b32_dpp v87, v87, v87, vcc wave_shr:1 row_mask:0xf bank_mask:0xf
    s_andn2_b64 s[82:83], s[82:83], s[52:53]
    v_cndmask_b32_dpp v7, v7, v7, vcc wave_shr:1 row_mask:0xf bank_mask:0xf
    s_mov_b64 exec, s[54:55]
    s_cbranch_scc0 L2_d21
    s_mov_b64 exec, s[82:83]
    s_nop 1
    v_mfma_f32_4x4x4_16b_bf16 v[88:91], v[12:13], v[84:85], 0
    s_nop 1
    v_mfma_f32_4x4x4_16b_bf16 v[88:91], v[10:11], v[86:87], v[88:91]
    s_nop 4
    v_cvt_pk_bf16_f32 v88, v88, v89
    v_cvt_pk_bf16_f32 v89, v90, v91
    ds_pk_add_bf16 v7, v88 offset:65408
    ds_pk_add_bf16 v7, v89 offset:65412
    s_mov_b64 exec, s[54:55]
    s_branch L2_d21
L2_c22:
    s_lshl_b64 s[52:53], s[82:83], 1
    s_andn2_b64 s[52:53], s[52:53], s[80:81]
    s_andn2_b64 s[52:53], s[52:53], s[50:51]
    s_or_b64 s[80:81], s[80:81], s[52:53]
    s_not_b64 vcc, s[52:53]
    s_mov_b64 exec, -1
    v_cndmask_b32_dpp v84, v84, v84, vcc wave_shr:1 row_mask:0xf bank_mask:0xf
    v_cndmask_b32_dpp v85, v85, v85, vcc wave_shr:1 row_mask:0xf bank_mask:0xf
    s_lshr_b64 s[52:53], s[52:53], 1
    v_cndmask_b32_dpp v86, v86, v86, vcc wave_shr:1 row_mask:0xf bank_mask:0xf
    v_cndmask_b32_dpp v87, v87, v87, vcc wave_shr:1 row_mask:0xf bank_mask:0xf
    s_andn2_b64 s[82:83], s[82:83], s[52:53]
    v_cndmask_b32_dpp v7, v7, v7, vcc wave_shr:1 row_mask:0xf bank_mask:0xf
    s_mov_b64 exec, s[50:51]
    s_cbranch_scc0 L2_d22
    s_mov_b64 exec, s[82:83]
    s_nop 1
    v_mfma_f32_4x4x4_16b_bf16 v[88:91], v[12:13], v[84:85], 0
    s_nop 1
    v_mfma_f32_4x4x4_16b_bf16 v[88:91], v[10:11], v[86:87], v[88:91]
    s_nop 4
    v_cvt_pk_bf16_f32 v88, v88, v89
    v_cvt_pk_bf16_f32 v89, v90, v91
    ds_pk_add_bf16 v7, v88 offset:65408
    ds_pk_add_bf16 v7, v89 offset:65412
    s_mov_b64 exec, s[50:51]
    s_branch L2_d22
L2_c23:
    s_lshl_b64 s[52:53], s[82:83], 1
    s_andn2_b64 s[52:53], s[52:53], s[80:81]
    s_andn2_b64 s[52:53], s[52:53], s[54:55]
    s_or_b64 s[80:81], s[80:81], s[52:53]
    s_not_b64 vcc, s[52:53]
    s_mov_b64 exec, -1
    v_cndmask_b32_dpp v84, v84, v84, vcc wave_shr:1 row_mask:0xf bank_mask:0xf
    v_cndmask_b32_dpp v85, v85, v85, vcc wave_shr:1 row_mask:0xf bank_mask:0xf
    s_lshr_b64 s[52:53], s[52:53], 1
    v_cndmask_b32_dpp v86, v86, v86, vcc wave_shr:1 row_mask:0xf bank_mask:0xf
    v_cndmask_b32_dpp v87, v87, v87, vcc wave_shr:1 row_mask:0xf bank_mask:0xf
    s_andn2_b64 s[82:83], s[82:83], s[52:53]
    v_cndmask_b32_dpp v7, v7, v7, vcc wave_shr:1 row_mask:0xf bank_mask:0xf
    s_mov_b64 exec, s[54:55]
    s_cbranch_scc0 L2_d23
    s_mov_b64 exec, s[82:83]
    s_nop 1
    v_mfma_f32_4x4x4_16b_bf16 v[88:91], v[12:13], v[84:85], 0
    s_nop 1
    v_mfma_f32_4x4x4_16b_bf16 v[88:91], v[10:11], v[86:87], v[88:91]
    s_nop 4
    v_cvt_pk_bf16_f32 v88, v88, v89
    v_cvt_pk_bf16_f32 v89, v90, v91
    ds_pk_add_bf16 v7, v88 offset:65408
    ds_pk_add_bf16 v7, v89 offset:65412
    s_mov_b64 exec, s[54:55]
    s_branch L2_d23
L2_c24:
    s_lshl_b64 s[52:53], s[82:83], 1
    s_andn2_b64 s[52:53], s[52:53], s[80:81]
    s_andn2_b64 s[52:53], s[52:53], s[50:51]
    s_or_b64 s[80:81], s[80:81], s[52:53]
    s_not_b64 vcc, s[52:53]
    s_mov_b64 exec, -1
    v_cndmask_b32_dpp v84, v84, v84, vcc wave_shr:1 row_mask:0xf bank_mask:0xf
    v_cndmask_b32_dpp v85, v85, v85, vcc wave_shr:1 row_mask:0xf bank_mask:0xf
    s_lshr_b64 s[52:53], s[52:53], 1
    v_cndmask_b32_dpp v86, v86, v86, vcc wave_shr:1 row_mask:0xf bank_mask:0xf
    v_cndmask_b32_dpp v87, v87, v87, vcc wave_shr:1 row_mask:0xf bank_mask:0xf
    s_andn2_b64 s[82:83], s[82:83], s[52:53]
    v_cndmask_b32_dpp v7, v7, v7, vcc wave_shr:1 row_mask:0xf bank_mask:0xf
    s_mov_b64 exec, s[50:51]
    s_cbranch_scc0 L2_d24
    s_mov_b64 exec, s[82:83]
    s_nop 1
    v_mfma_f32_4x4x4_16b_bf16 v[88:91], v[12:13], v[84:85], 0
    s_nop 1
    v_mfma_f32_4x4x4_16b_bf16 v[88:91], v[10:11], v[86:87], v[88:91]
    s_nop 4
    v_cvt_pk_bf16_f32 v88, v88, v89
    v_cvt_pk_bf16_f32 v89, v90, v91
    ds_pk_add_bf16 v7, v88 offset:65408
    ds_pk_add_bf16 v7, v89 offset:65412
    s_mov_b64 exec, s[50:51]
    s_branch L2_d24
L2_xa25:
    s_cmp_eq_u32 s101, 1
    s_cbranch_scc1 L2_xc25
    v_lshlrev_b32 v89, 0, v96
    v_add_u32 v90, 140, v97
    v_bitop3_b32 v90, v89, v45, v90 bitop3:0x6a
    ds_write_b32 v98, v90 offset:28
    v_lshlrev_b32 v89, 4, v96
    v_add_u32 v90, 120, v97
    v_bitop3_b32 v90, v89, v45, v90 bitop3:0x6a
    ds_write_b32 v98, v90 offset:24
    v_lshlrev_b32 v89, 8, v96
    v_add_u32 v90, 100, v97
    v_bitop3_b32 v90, v89, v45, v90 bitop3:0x6a
    ds_write_b32 v98, v90 offset:20
L2_xc25:
    v_lshlrev_b32 v89, 12, v96
    v_add_u32 v90, 80, v97
    v_bitop3_b32 v90, v89, v45, v90 bitop3:0x6a
    ds_write_b32 v98, v90 offset:16
    s_branch L2_xb25
L2_xe25:
    v_cmp_lt_u32 vcc, 32, v99
    v_cmp_lt_u32 s[58:59], 31, v88
    v_lshrrev_b32 v89, 16, v96
    v_add_u32 v97, 80, v97
    s_or_b64 vcc, vcc, s[58:59]
    s_cbranch_scc1 L2_xs25
    v_lshlrev_b32 v89, v1, v89
    v_and_b32 v89, v45, v89
    v_cmp_ne_u32 vcc, 0, v89
    v_xor_b32 v90, v97, v89
    s_add_u32 s3, s37, s38
    v_mbcnt_lo_u32_b32 v98, vcc_lo, 0
    v_mbcnt_hi_u32_b32 v98, vcc_hi, v98
    s_bcnt1_i32_b64 s41, vcc
    v_lshl_add_u32 v98, v98, 2, s3
    s_mov_b64 exec, vcc
    ds_write_b32 v98, v90
    s_mov_b64 exec, -1
    s_lshl2_add_u32 s37, s41, s37
    s_branch L2_xr25
L2_xf25:
    s_waitcnt lgkmcnt(0)
    s_cmp_gt_u32 s37, 1024
    s_cbranch_scc1 L2_xs25
    v_mov_b32 v43, -1
    s_cmp_ge_u32 s37, 512
    s_cbranch_scc1 L2_xg25
    v_mov_b32 v42, -1
    s_cmp_ge_u32 s37, 256
    s_cbranch_scc1 L2_xg25
    v_mov_b32 v41, -1
    s_branch L2_xg25
L2_xs25:
    s_waitcnt lgkmcnt(0)
    v_mov_b32 v40, -1
    v_mov_b32 v41, -1
    v_mov_b32 v42, -1
    v_mov_b32 v43, -1
    s_add_u32 s3, s42, 2
    s_bitset1_b32 s36, s3
    s_branch L2_xg25
L2_c26:
    s_lshl_b64 s[52:53], s[82:83], 1
    s_andn2_b64 s[52:53], s[52:53], s[80:81]
    s_andn2_b64 s[52:53], s[52:53], s[54:55]
    s_or_b64 s[80:81], s[80:81], s[52:53]
    s_not_b64 vcc, s[52:53]
    s_mov_b64 exec, -1
    v_cndmask_b32_dpp v84, v84, v84, vcc wave_shr:1 row_mask:0xf bank_mask:0xf
    v_cndmask_b32_dpp v85, v85, v85, vcc wave_shr:1 row_mask:0xf bank_mask:0xf
    s_lshr_b64 s[52:53], s[52:53], 1
    v_cndmask_b32_dpp v86, v86, v86, vcc wave_shr:1 row_mask:0xf bank_mask:0xf
    v_cndmask_b32_dpp v87, v87, v87, vcc wave_shr:1 row_mask:0xf bank_mask:0xf
    s_andn2_b64 s[82:83], s[82:83], s[52:53]
    v_cndmask_b32_dpp v7, v7, v7, vcc wave_shr:1 row_mask:0xf bank_mask:0xf
    s_mov_b64 exec, s[54:55]
    s_cbranch_scc0 L2_d26
    s_mov_b64 exec, s[82:83]
    s_nop 1
    v_mfma_f32_4x4x4_16b_bf16 v[88:91], v[12:13], v[84:85], 0
    s_nop 1
    v_mfma_f32_4x4x4_16b_bf16 v[88:91], v[10:11], v[86:87], v[88:91]
    s_nop 4
    v_cvt_pk_bf16_f32 v88, v88, v89
    v_cvt_pk_bf16_f32 v89, v90, v91
    ds_pk_add_bf16 v7, v88 offset:65408
    ds_pk_add_bf16 v7, v89 offset:65412
    s_mov_b64 exec, s[54:55]
    s_branch L2_d26
L2_c27:
    s_lshl_b64 s[52:53], s[82:83], 1
    s_andn2_b64 s[52:53], s[52:53], s[80:81]
    s_andn2_b64 s[52:53], s[52:53], s[50:51]
    s_or_b64 s[80:81], s[80:81], s[52:53]
    s_not_b64 vcc, s[52:53]
    s_mov_b64 exec, -1
    v_cndmask_b32_dpp v84, v84, v84, vcc wave_shr:1 row_mask:0xf bank_mask:0xf
    v_cndmask_b32_dpp v85, v85, v85, vcc wave_shr:1 row_mask:0xf bank_mask:0xf
    s_lshr_b64 s[52:53], s[52:53], 1
    v_cndmask_b32_dpp v86, v86, v86, vcc wave_shr:1 row_mask:0xf bank_mask:0xf
    v_cndmask_b32_dpp v87, v87, v87, vcc wave_shr:1 row_mask:0xf bank_mask:0xf
    s_andn2_b64 s[82:83], s[82:83], s[52:53]
    v_cndmask_b32_dpp v7, v7, v7, vcc wave_shr:1 row_mask:0xf bank_mask:0xf
    s_mov_b64 exec, s[50:51]
    s_cbranch_scc0 L2_d27
    s_mov_b64 exec, s[82:83]
    s_nop 1
    v_mfma_f32_4x4x4_16b_bf16 v[88:91], v[12:13], v[84:85], 0
    s_nop 1
    v_mfma_f32_4x4x4_16b_bf16 v[88:91], v[10:11], v[86:87], v[88:91]
    s_nop 4
    v_cvt_pk_bf16_f32 v88, v88, v89
    v_cvt_pk_bf16_f32 v89, v90, v91
    ds_pk_add_bf16 v7, v88 offset:65408
    ds_pk_add_bf16 v7, v89 offset:65412
    s_mov_b64 exec, s[50:51]
    s_branch L2_d27
L2_c28:
    s_lshl_b64 s[52:53], s[82:83], 1
    s_andn2_b64 s[52:53], s[52:53], s[80:81]
    s_andn2_b64 s[52:53], s[52:53], s[54:55]
    s_or_b64 s[80:81], s[80:81], s[52:53]
    s_not_b64 vcc, s[52:53]
    s_mov_b64 exec, -1
    v_cndmask_b32_dpp v84, v84, v84, vcc wave_shr:1 row_mask:0xf bank_mask:0xf
    v_cndmask_b32_dpp v85, v85, v85, vcc wave_shr:1 row_mask:0xf bank_mask:0xf
    s_lshr_b64 s[52:53], s[52:53], 1
    v_cndmask_b32_dpp v86, v86, v86, vcc wave_shr:1 row_mask:0xf bank_mask:0xf
    v_cndmask_b32_dpp v87, v87, v87, vcc wave_shr:1 row_mask:0xf bank_mask:0xf
    s_andn2_b64 s[82:83], s[82:83], s[52:53]
    v_cndmask_b32_dpp v7, v7, v7, vcc wave_shr:1 row_mask:0xf bank_mask:0xf
    s_mov_b64 exec, s[54:55]
    s_cbranch_scc0 L2_d28
    s_mov_b64 exec, s[82:83]
    s_nop 1
    v_mfma_f32_4x4x4_16b_bf16 v[88:91], v[12:13], v[84:85], 0
    s_nop 1
    v_mfma_f32_4x4x4_16b_bf16 v[88:91], v[10:11], v[86:87], v[88:91]
    s_nop 4
    v_cvt_pk_bf16_f32 v88, v88, v89
    v_cvt_pk_bf16_f32 v89, v90, v91
    ds_pk_add_bf16 v7, v88 offset:65408
    ds_pk_add_bf16 v7, v89 offset:65412
    s_mov_b64 exec, s[54:55]
    s_branch L2_d28
L2_c29:
    s_lshl_b64 s[52:53], s[82:83], 1
    s_andn2_b64 s[52:53], s[52:53], s[80:81]
    s_andn2_b64 s[52:53], s[52:53], s[50:51]
    s_or_b64 s[80:81], s[80:81], s[52:53]
    s_not_b64 vcc, s[52:53]
    s_mov_b64 exec, -1
    v_cndmask_b32_dpp v84, v84, v84, vcc wave_shr:1 row_mask:0xf bank_mask:0xf
    v_cndmask_b32_dpp v85, v85, v85, vcc wave_shr:1 row_mask:0xf bank_mask:0xf
    s_lshr_b64 s[52:53], s[52:53], 1
    v_cndmask_b32_dpp v86, v86, v86, vcc wave_shr:1 row_mask:0xf bank_mask:0xf
    v_cndmask_b32_dpp v87, v87, v87, vcc wave_shr:1 row_mask:0xf bank_mask:0xf
    s_andn2_b64 s[82:83], s[82:83], s[52:53]
    v_cndmask_b32_dpp v7, v7, v7, vcc wave_shr:1 row_mask:0xf bank_mask:0xf
    s_mov_b64 exec, s[50:51]
    s_cbranch_scc0 L2_d29
    s_mov_b64 exec, s[82:83]
    s_nop 1
    v_mfma_f32_4x4x4_16b_bf16 v[88:91], v[12:13], v[84:85], 0
    s_nop 1
    v_mfma_f32_4x4x4_16b_bf16 v[88:91], v[10:11], v[86:87], v[88:91]
    s_nop 4
    v_cvt_pk_bf16_f32 v88, v88, v89
    v_cvt_pk_bf16_f32 v89, v90, v91
    ds_pk_add_bf16 v7, v88 offset:65408
    ds_pk_add_bf16 v7, v89 offset:65412
    s_mov_b64 exec, s[50:51]
    s_branch L2_d29
L2_c30:
    s_lshl_b64 s[52:53], s[82:83], 1
    s_andn2_b64 s[52:53], s[52:53], s[80:81]
    s_andn2_b64 s[52:53], s[52:53], s[54:55]
    s_or_b64 s[80:81], s[80:81], s[52:53]
    s_not_b64 vcc, s[52:53]
    s_mov_b64 exec, -1
    v_cndmask_b32_dpp v84, v84, v84, vcc wave_shr:1 row_mask:0xf bank_mask:0xf
    v_cndmask_b32_dpp v85, v85, v85, vcc wave_shr:1 row_mask:0xf bank_mask:0xf
    s_lshr_b64 s[52:53], s[52:53], 1
    v_cndmask_b32_dpp v86, v86, v86, vcc wave_shr:1 row_mask:0xf bank_mask:0xf
    v_cndmask_b32_dpp v87, v87, v87, vcc wave_shr:1 row_mask:0xf bank_mask:0xf
    s_andn2_b64 s[82:83], s[82:83], s[52:53]
    v_cndmask_b32_dpp v7, v7, v7, vcc wave_shr:1 row_mask:0xf bank_mask:0xf
    s_mov_b64 exec, s[54:55]
    s_cbranch_scc0 L2_d30
    s_mov_b64 exec, s[82:83]
    s_nop 1
    v_mfma_f32_4x4x4_16b_bf16 v[88:91], v[12:13], v[84:85], 0
    s_nop 1
    v_mfma_f32_4x4x4_16b_bf16 v[88:91], v[10:11], v[86:87], v[88:91]
    s_nop 4
    v_cvt_pk_bf16_f32 v88, v88, v89
    v_cvt_pk_bf16_f32 v89, v90, v91
    ds_pk_add_bf16 v7, v88 offset:65408
    ds_pk_add_bf16 v7, v89 offset:65412
    s_mov_b64 exec, s[54:55]
    s_branch L2_d30
L2_c31:
    s_lshl_b64 s[52:53], s[82:83], 1
    s_andn2_b64 s[52:53], s[52:53], s[80:81]
    s_andn2_b64 s[52:53], s[52:53], s[50:51]
    s_or_b64 s[80:81], s[80:81], s[52:53]
    s_not_b64 vcc, s[52:53]
    s_mov_b64 exec, -1
    v_cndmask_b32_dpp v84, v84, v84, vcc wave_shr:1 row_mask:0xf bank_mask:0xf
    v_cndmask_b32_dpp v85, v85, v85, vcc wave_shr:1 row_mask:0xf bank_mask:0xf
    s_lshr_b64 s[52:53], s[52:53], 1
    v_cndmask_b32_dpp v86, v86, v86, vcc wave_shr:1 row_mask:0xf bank_mask:0xf
    v_cndmask_b32_dpp v87, v87, v87, vcc wave_shr:1 row_mask:0xf bank_mask:0xf
    s_andn2_b64 s[82:83], s[82:83], s[52:53]
    v_cndmask_b32_dpp v7, v7, v7, vcc wave_shr:1 row_mask:0xf bank_mask:0xf
    s_mov_b64 exec, s[50:51]
    s_cbranch_scc0 L2_d31
    s_mov_b64 exec, s[82:83]
    s_nop 1
    v_mfma_f32_4x4x4_16b_bf16 v[88:91], v[12:13], v[84:85], 0
    s_nop 1
    v_mfma_f32_4x4x4_16b_bf16 v[88:91], v[10:11], v[86:87], v[88:91]
    s_nop 4
    v_cvt_pk_bf16_f32 v88, v88, v89
    v_cvt_pk_bf16_f32 v89, v90, v91
    ds_pk_add_bf16 v7, v88 offset:65408
    ds_pk_add_bf16 v7, v89 offset:65412
    s_mov_b64 exec, s[50:51]
    s_branch L2_d31
L2_xo32:
    v_cmp_lt_u32 vcc, 20, v99
    s_mov_b32 s101, 1
    s_cbranch_vccz L2_xp32
    v_cmp_lt_u32 vcc, 32, v99
    v_cmp_lt_u32 s[58:59], 31, v88
    s_mov_b32 s101, 2
    s_or_b64 vcc, vcc, s[58:59]
    s_cbranch_scc0 L2_xp32
    s_mov_b32 s37, 0x10000
    s_branch L2_xp32
L2_c33:
    s_lshl_b64 s[52:53], s[82:83], 1
    s_andn2_b64 s[52:53], s[52:53], s[80:81]
    s_andn2_b64 s[52:53], s[52:53], s[54:55]
    s_or_b64 s[80:81], s[80:81], s[52:53]
    s_not_b64 vcc, s[52:53]
    s_mov_b64 exec, -1
    v_cndmask_b32_dpp v84, v84, v84, vcc wave_shr:1 row_mask:0xf bank_mask:0xf
    v_cndmask_b32_dpp v85, v85, v85, vcc wave_shr:1 row_mask:0xf bank_mask:0xf
    s_lshr_b64 s[52:53], s[52:53], 1
    v_cndmask_b32_dpp v86, v86, v86, vcc wave_shr:1 row_mask:0xf bank_mask:0xf
    v_cndmask_b32_dpp v87, v87, v87, vcc wave_shr:1 row_mask:0xf bank_mask:0xf
    s_andn2_b64 s[82:83], s[82:83], s[52:53]
    v_cndmask_b32_dpp v7, v7, v7, vcc wave_shr:1 row_mask:0xf bank_mask:0xf
    s_mov_b64 exec, s[54:55]
    s_cbranch_scc0 L2_d33
    s_mov_b64 exec, s[82:83]
    s_nop 1
    v_mfma_f32_4x4x4_16b_bf16 v[88:91], v[12:13], v[84:85], 0
    s_nop 1
    v_mfma_f32_4x4x4_16b_bf16 v[88:91], v[10:11], v[86:87], v[88:91]
    s_nop 4
    v_cvt_pk_bf16_f32 v88, v88, v89
    v_cvt_pk_bf16_f32 v89, v90, v91
    ds_pk_add_bf16 v7, v88 offset:65408
    ds_pk_add_bf16 v7, v89 offset:65412
    s_mov_b64 exec, s[54:55]
    s_branch L2_d33
L2_c34:
    s_lshl_b64 s[52:53], s[82:83], 1
    s_andn2_b64 s[52:53], s[52:53], s[80:81]
    s_andn2_b64 s[52:53], s[52:53], s[50:51]
    s_or_b64 s[80:81], s[80:81], s[52:53]
    s_not_b64 vcc, s[52:53]
    s_mov_b64 exec, -1
    v_cndmask_b32_dpp v84, v84, v84, vcc wave_shr:1 row_mask:0xf bank_mask:0xf
    v_cndmask_b32_dpp v85, v85, v85, vcc wave_shr:1 row_mask:0xf bank_mask:0xf
    s_lshr_b64 s[52:53], s[52:53], 1
    v_cndmask_b32_dpp v86, v86, v86, vcc wave_shr:1 row_mask:0xf bank_mask:0xf
    v_cndmask_b32_dpp v87, v87, v87, vcc wave_shr:1 row_mask:0xf bank_mask:0xf
    s_andn2_b64 s[82:83], s[82:83], s[52:53]
    v_cndmask_b32_dpp v7, v7, v7, vcc wave_shr:1 row_mask:0xf bank_mask:0xf
    s_mov_b64 exec, s[50:51]
    s_cbranch_scc0 L2_d34
    s_mov_b64 exec, s[82:83]
    s_nop 1
    v_mfma_f32_4x4x4_16b_bf16 v[88:91], v[12:13], v[84:85], 0
    s_nop 1
    v_mfma_f32_4x4x4_16b_bf16 v[88:91], v[10:11], v[86:87], v[88:91]
    s_nop 4
    v_cvt_pk_bf16_f32 v88, v88, v89
    v_cvt_pk_bf16_f32 v89, v90, v91
    ds_pk_add_bf16 v7, v88 offset:65408
    ds_pk_add_bf16 v7, v89 offset:65412
    s_mov_b64 exec, s[50:51]
    s_branch L2_d34
L2_c35:
    s_lshl_b64 s[52:53], s[82:83], 1
    s_andn2_b64 s[52:53], s[52:53], s[80:81]
    s_andn2_b64 s[52:53], s[52:53], s[54:55]
    s_or_b64 s[80:81], s[80:81], s[52:53]
    s_not_b64 vcc, s[52:53]
    s_mov_b64 exec, -1
    v_cndmask_b32_dpp v84, v84, v84, vcc wave_shr:1 row_mask:0xf bank_mask:0xf
    v_cndmask_b32_dpp v85, v85, v85, vcc wave_shr:1 row_mask:0xf bank_mask:0xf
    s_lshr_b64 s[52:53], s[52:53], 1
    v_cndmask_b32_dpp v86, v86, v86, vcc wave_shr:1 row_mask:0xf bank_mask:0xf
    v_cndmask_b32_dpp v87, v87, v87, vcc wave_shr:1 row_mask:0xf bank_mask:0xf
    s_andn2_b64 s[82:83], s[82:83], s[52:53]
    v_cndmask_b32_dpp v7, v7, v7, vcc wave_shr:1 row_mask:0xf bank_mask:0xf
    s_mov_b64 exec, s[54:55]
    s_cbranch_scc0 L2_d35
    s_mov_b64 exec, s[82:83]
    s_nop 1
    v_mfma_f32_4x4x4_16b_bf16 v[88:91], v[12:13], v[84:85], 0
    s_nop 1
    v_mfma_f32_4x4x4_16b_bf16 v[88:91], v[10:11], v[86:87], v[88:91]
    s_nop 4
    v_cvt_pk_bf16_f32 v88, v88, v89
    v_cvt_pk_bf16_f32 v89, v90, v91
    ds_pk_add_bf16 v7, v88 offset:65408
    ds_pk_add_bf16 v7, v89 offset:65412
    s_mov_b64 exec, s[54:55]
    s_branch L2_d35
L2_c36:
    s_lshl_b64 s[52:53], s[82:83], 1
    s_andn2_b64 s[52:53], s[52:53], s[80:81]
    s_andn2_b64 s[52:53], s[52:53], s[50:51]
    s_or_b64 s[80:81], s[80:81], s[52:53]
    s_not_b64 vcc, s[52:53]
    s_mov_b64 exec, -1
    v_cndmask_b32_dpp v84, v84, v84, vcc wave_shr:1 row_mask:0xf bank_mask:0xf
    v_cndmask_b32_dpp v85, v85, v85, vcc wave_shr:1 row_mask:0xf bank_mask:0xf
    s_lshr_b64 s[52:53], s[52:53], 1
    v_cndmask_b32_dpp v86, v86, v86, vcc wave_shr:1 row_mask:0xf bank_mask:0xf
    v_cndmask_b32_dpp v87, v87, v87, vcc wave_shr:1 row_mask:0xf bank_mask:0xf
    s_andn2_b64 s[82:83], s[82:83], s[52:53]
    v_cndmask_b32_dpp v7, v7, v7, vcc wave_shr:1 row_mask:0xf bank_mask:0xf
    s_mov_b64 exec, s[50:51]
    s_cbranch_scc0 L2_d36
    s_mov_b64 exec, s[82:83]
    s_nop 1
    v_mfma_f32_4x4x4_16b_bf16 v[88:91], v[12:13], v[84:85], 0
    s_nop 1
    v_mfma_f32_4x4x4_16b_bf16 v[88:91], v[10:11], v[86:87], v[88:91]
    s_nop 4
    v_cvt_pk_bf16_f32 v88, v88, v89
    v_cvt_pk_bf16_f32 v89, v90, v91
    ds_pk_add_bf16 v7, v88 offset:65408
    ds_pk_add_bf16 v7, v89 offset:65412
    s_mov_b64 exec, s[50:51]
    s_branch L2_d36
L2_c37:
    s_lshl_b64 s[52:53], s[82:83], 1
    s_andn2_b64 s[52:53], s[52:53], s[80:81]
    s_andn2_b64 s[52:53], s[52:53], s[54:55]
    s_or_b64 s[80:81], s[80:81], s[52:53]
    s_not_b64 vcc, s[52:53]
    s_mov_b64 exec, -1
    v_cndmask_b32_dpp v84, v84, v84, vcc wave_shr:1 row_mask:0xf bank_mask:0xf
    v_cndmask_b32_dpp v85, v85, v85, vcc wave_shr:1 row_mask:0xf bank_mask:0xf
    s_lshr_b64 s[52:53], s[52:53], 1
    v_cndmask_b32_dpp v86, v86, v86, vcc wave_shr:1 row_mask:0xf bank_mask:0xf
    v_cndmask_b32_dpp v87, v87, v87, vcc wave_shr:1 row_mask:0xf bank_mask:0xf
    s_andn2_b64 s[82:83], s[82:83], s[52:53]
    v_cndmask_b32_dpp v7, v7, v7, vcc wave_shr:1 row_mask:0xf bank_mask:0xf
    s_mov_b64 exec, s[54:55]
    s_cbranch_scc0 L2_d37
    s_mov_b64 exec, s[82:83]
    s_nop 1
    v_mfma_f32_4x4x4_16b_bf16 v[88:91], v[12:13], v[84:85], 0
    s_nop 1
    v_mfma_f32_4x4x4_16b_bf16 v[88:91], v[10:11], v[86:87], v[88:91]
    s_nop 4
    v_cvt_pk_bf16_f32 v88, v88, v89
    v_cvt_pk_bf16_f32 v89, v90, v91
    ds_pk_add_bf16 v7, v88 offset:65408
    ds_pk_add_bf16 v7, v89 offset:65412
    s_mov_b64 exec, s[54:55]
    s_branch L2_d37
L2_c38:
    s_lshl_b64 s[52:53], s[82:83], 1
    s_andn2_b64 s[52:53], s[52:53], s[80:81]
    s_andn2_b64 s[52:53], s[52:53], s[50:51]
    s_or_b64 s[80:81], s[80:81], s[52:53]
    s_not_b64 vcc, s[52:53]
    s_mov_b64 exec, -1
    v_cndmask_b32_dpp v84, v84, v84, vcc wave_shr:1 row_mask:0xf bank_mask:0xf
    v_cndmask_b32_dpp v85, v85, v85, vcc wave_shr:1 row_mask:0xf bank_mask:0xf
    s_lshr_b64 s[52:53], s[52:53], 1
    v_cndmask_b32_dpp v86, v86, v86, vcc wave_shr:1 row_mask:0xf bank_mask:0xf
    v_cndmask_b32_dpp v87, v87, v87, vcc wave_shr:1 row_mask:0xf bank_mask:0xf
    s_andn2_b64 s[82:83], s[82:83], s[52:53]
    v_cndmask_b32_dpp v7, v7, v7, vcc wave_shr:1 row_mask:0xf bank_mask:0xf
    s_mov_b64 exec, s[50:51]
    s_cbranch_scc0 L2_d38
    s_mov_b64 exec, s[82:83]
    s_nop 1
    v_mfma_f32_4x4x4_16b_bf16 v[88:91], v[12:13], v[84:85], 0
    s_nop 1
    v_mfma_f32_4x4x4_16b_bf16 v[88:91], v[10:11], v[86:87], v[88:91]
    s_nop 4
    v_cvt_pk_bf16_f32 v88, v88, v89
    v_cvt_pk_bf16_f32 v89, v90, v91
    ds_pk_add_bf16 v7, v88 offset:65408
    ds_pk_add_bf16 v7, v89 offset:65412
    s_mov_b64 exec, s[50:51]
    s_branch L2_d38
L2_c39:
    s_lshl_b64 s[52:53], s[82:83], 1
    s_andn2_b64 s[52:53], s[52:53], s[80:81]
    s_andn2_b64 s[52:53], s[52:53], s[54:55]
    s_or_b64 s[80:81], s[80:81], s[52:53]
    s_not_b64 vcc, s[52:53]
    s_mov_b64 exec, -1
    v_cndmask_b32_dpp v84, v84, v84, vcc wave_shr:1 row_mask:0xf bank_mask:0xf
    v_cndmask_b32_dpp v85, v85, v85, vcc wave_shr:1 row_mask:0xf bank_mask:0xf
    s_lshr_b64 s[52:53], s[52:53], 1
    v_cndmask_b32_dpp v86, v86, v86, vcc wave_shr:1 row_mask:0xf bank_mask:0xf
    v_cndmask_b32_dpp v87, v87, v87, vcc wave_shr:1 row_mask:0xf bank_mask:0xf
    s_andn2_b64 s[82:83], s[82:83], s[52:53]
    v_cndmask_b32_dpp v7, v7, v7, vcc wave_shr:1 row_mask:0xf bank_mask:0xf
    s_mov_b64 exec, s[54:55]
    s_cbranch_scc0 L2_d39
    s_mov_b64 exec, s[82:83]
    s_nop 1
    v_mfma_f32_4x4x4_16b_bf16 v[88:91], v[12:13], v[84:85], 0
    s_nop 1
    v_mfma_f32_4x4x4_16b_bf16 v[88:91], v[10:11], v[86:87], v[88:91]
    s_nop 4
    v_cvt_pk_bf16_f32 v88, v88, v89
    v_cvt_pk_bf16_f32 v89, v90, v91
    ds_pk_add_bf16 v7, v88 offset:65408
    ds_pk_add_bf16 v7, v89 offset:65412
    s_mov_b64 exec, s[54:55]
    s_branch L2_d39
L2_c40:
    s_lshl_b64 s[52:53], s[82:83], 1
    s_andn2_b64 s[52:53], s[52:53], s[80:81]
    s_andn2_b64 s[52:53], s[52:53], s[50:51]
    s_or_b64 s[80:81], s[80:81], s[52:53]
    s_not_b64 vcc, s[52:53]
    s_mov_b64 exec, -1
    v_cndmask_b32_dpp v84, v84, v84, vcc wave_shr:1 row_mask:0xf bank_mask:0xf
    v_cndmask_b32_dpp v85, v85, v85, vcc wave_shr:1 row_mask:0xf bank_mask:0xf
    s_lshr_b64 s[52:53], s[52:53], 1
    v_cndmask_b32_dpp v86, v86, v86, vcc wave_shr:1 row_mask:0xf bank_mask:0xf
    v_cndmask_b32_dpp v87, v87, v87, vcc wave_shr:1 row_mask:0xf bank_mask:0xf
    s_andn2_b64 s[82:83], s[82:83], s[52:53]
    v_cndmask_b32_dpp v7, v7, v7, vcc wave_shr:1 row_mask:0xf bank_mask:0xf
    s_mov_b64 exec, s[50:51]
    s_cbranch_scc0 L2_d40
    s_mov_b64 exec, s[82:83]
    s_nop 1
    v_mfma_f32_4x4x4_16b_bf16 v[88:91], v[12:13], v[84:85], 0
    s_nop 1
    v_mfma_f32_4x4x4_16b_bf16 v[88:91], v[10:11], v[86:87], v[88:91]
    s_nop 4
    v_cvt_pk_bf16_f32 v88, v88, v89
    v_cvt_pk_bf16_f32 v89, v90, v91
    ds_pk_add_bf16 v7, v88 offset:65408
    ds_pk_add_bf16 v7, v89 offset:65412
    s_mov_b64 exec, s[50:51]
    s_branch L2_d40
L2_c41:
    s_lshl_b64 s[52:53], s[82:83], 1
    s_andn2_b64 s[52:53], s[52:53], s[80:81]
    s_andn2_b64 s[52:53], s[52:53], s[54:55]
    s_or_b64 s[80:81], s[80:81], s[52:53]
    s_not_b64 vcc, s[52:53]
    s_mov_b64 exec, -1
    v_cndmask_b32_dpp v84, v84, v84, vcc wave_shr:1 row_mask:0xf bank_mask:0xf
    v_cndmask_b32_dpp v85, v85, v85, vcc wave_shr:1 row_mask:0xf bank_mask:0xf
    s_lshr_b64 s[52:53], s[52:53], 1
    v_cndmask_b32_dpp v86, v86, v86, vcc wave_shr:1 row_mask:0xf bank_mask:0xf
    v_cndmask_b32_dpp v87, v87, v87, vcc wave_shr:1 row_mask:0xf bank_mask:0xf
    s_andn2_b64 s[82:83], s[82:83], s[52:53]
    v_cndmask_b32_dpp v7, v7, v7, vcc wave_shr:1 row_mask:0xf bank_mask:0xf
    s_mov_b64 exec, s[54:55]
    s_cbranch_scc0 L2_d41
    s_mov_b64 exec, s[82:83]
    s_nop 1
    v_mfma_f32_4x4x4_16b_bf16 v[88:91], v[12:13], v[84:85], 0
    s_nop 1
    v_mfma_f32_4x4x4_16b_bf16 v[88:91], v[10:11], v[86:87], v[88:91]
    s_nop 4
    v_cvt_pk_bf16_f32 v88, v88, v89
    v_cvt_pk_bf16_f32 v89, v90, v91
    ds_pk_add_bf16 v7, v88 offset:65408
    ds_pk_add_bf16 v7, v89 offset:65412
    s_mov_b64 exec, s[54:55]
    s_branch L2_d41
L2_c42:
    s_lshl_b64 s[52:53], s[82:83], 1
    s_andn2_b64 s[52:53], s[52:53], s[80:81]
    s_andn2_b64 s[52:53], s[52:53], s[50:51]
    s_or_b64 s[80:81], s[80:81], s[52:53]
    s_not_b64 vcc, s[52:53]
    s_mov_b64 exec, -1
    v_cndmask_b32_dpp v84, v84, v84, vcc wave_shr:1 row_mask:0xf bank_mask:0xf
    v_cndmask_b32_dpp v85, v85, v85, vcc wave_shr:1 row_mask:0xf bank_mask:0xf
    s_lshr_b64 s[52:53], s[52:53], 1
    v_cndmask_b32_dpp v86, v86, v86, vcc wave_shr:1 row_mask:0xf bank_mask:0xf
    v_cndmask_b32_dpp v87, v87, v87, vcc wave_shr:1 row_mask:0xf bank_mask:0xf
    s_andn2_b64 s[82:83], s[82:83], s[52:53]
    v_cndmask_b32_dpp v7, v7, v7, vcc wave_shr:1 row_mask:0xf bank_mask:0xf
    s_mov_b64 exec, s[50:51]
    s_cbranch_scc0 L2_d42
    s_mov_b64 exec, s[82:83]
    s_nop 1
    v_mfma_f32_4x4x4_16b_bf16 v[88:91], v[12:13], v[84:85], 0
    s_nop 1
    v_mfma_f32_4x4x4_16b_bf16 v[88:91], v[10:11], v[86:87], v[88:91]
    s_nop 4
    v_cvt_pk_bf16_f32 v88, v88, v89
    v_cvt_pk_bf16_f32 v89, v90, v91
    ds_pk_add_bf16 v7, v88 offset:65408
    ds_pk_add_bf16 v7, v89 offset:65412
    s_mov_b64 exec, s[50:51]
    s_branch L2_d42
L2_xa43:
    s_cmp_eq_u32 s101, 1
    s_cbranch_scc1 L2_xc43
    v_lshlrev_b32 v89, 0, v96
    v_add_u32 v90, 140, v97
    v_bitop3_b32 v90, v89, v45, v90 bitop3:0x6a
    ds_write_b32 v98, v90 offset:28
    v_lshlrev_b32 v89, 4, v96
    v_add_u32 v90, 120, v97
    v_bitop3_b32 v90, v89, v45, v90 bitop3:0x6a
    ds_write_b32 v98, v90 offset:24
    v_lshlrev_b32 v89, 8, v96
    v_add_u32 v90, 100, v97
    v_bitop3_b32 v90, v89, v45, v90 bitop3:0x6a
    ds_write_b32 v98, v90 offset:20
L2_xc43:
    v_lshlrev_b32 v89, 12, v96
    v_add_u32 v90, 80, v97
    v_bitop3_b32 v90, v89, v45, v90 bitop3:0x6a
    ds_write_b32 v98, v90 offset:16
    s_branch L2_xb43
L2_xe43:
    v_cmp_lt_u32 vcc, 32, v99
    v_cmp_lt_u32 s[58:59], 31, v88
    v_lshrrev_b32 v89, 16, v96
    v_add_u32 v97, 80, v97
    s_or_b64 vcc, vcc, s[58:59]
    s_cbranch_scc1 L2_xs43
    v_lshlrev_b32 v89, v1, v89
    v_and_b32 v89, v45, v89
    v_cmp_ne_u32 vcc, 0, v89
    v_xor_b32 v90, v97, v89
    s_add_u32 s3, s37, s38
    v_mbcnt_lo_u32_b32 v98, vcc_lo, 0
    v_mbcnt_hi_u32_b32 v98, vcc_hi, v98
    s_bcnt1_i32_b64 s41, vcc
    v_lshl_add_u32 v98, v98, 2, s3
    s_mov_b64 exec, vcc
    ds_write_b32 v98, v90
    s_mov_b64 exec, -1
    s_lshl2_add_u32 s37, s41, s37
    s_branch L2_xr43
L2_xf43:
    s_waitcnt lgkmcnt(0)
    s_cmp_gt_u32 s37, 1024
    s_cbranch_scc1 L2_xs43
    v_mov_b32 v43, -1
    s_cmp_ge_u32 s37, 512
    s_cbranch_scc1 L2_xg43
    v_mov_b32 v42, -1
    s_cmp_ge_u32 s37, 256
    s_cbranch_scc1 L2_xg43
    v_mov_b32 v41, -1
    s_branch L2_xg43
L2_xs43:
    s_waitcnt lgkmcnt(0)
    v_mov_b32 v40, -1
    v_mov_b32 v41, -1
    v_mov_b32 v42, -1
    v_mov_b32 v43, -1
    s_add_u32 s3, s42, 2
    s_bitset1_b32 s36, s3
    s_branch L2_xg43
L2_c44:
    s_lshl_b64 s[52:53], s[82:83], 1
    s_andn2_b64 s[52:53], s[52:53], s[80:81]
    s_andn2_b64 s[52:53], s[52:53], s[54:55]
    s_or_b64 s[80:81], s[80:81], s[52:53]
    s_not_b64 vcc, s[52:53]
    s_mov_b64 exec, -1
    v_cndmask_b32_dpp v84, v84, v84, vcc wave_shr:1 row_mask:0xf bank_mask:0xf
    v_cndmask_b32_dpp v85, v85, v85, vcc wave_shr:1 row_mask:0xf bank_mask:0xf
    s_lshr_b64 s[52:53], s[52:53], 1
    v_cndmask_b32_dpp v86, v86, v86, vcc wave_shr:1 row_mask:0xf bank_mask:0xf
    v_cndmask_b32_dpp v87, v87, v87, vcc wave_shr:1 row_mask:0xf bank_mask:0xf
    s_andn2_b64 s[82:83], s[82:83], s[52:53]
    v_cndmask_b32_dpp v7, v7, v7, vcc wave_shr:1 row_mask:0xf bank_mask:0xf
    s_mov_b64 exec, s[54:55]
    s_cbranch_scc0 L2_d44
    s_mov_b64 exec, s[82:83]
    s_nop 1
    v_mfma_f32_4x4x4_16b_bf16 v[88:91], v[12:13], v[84:85], 0
    s_nop 1
    v_mfma_f32_4x4x4_16b_bf16 v[88:91], v[10:11], v[86:87], v[88:91]
    s_nop 4
    v_cvt_pk_bf16_f32 v88, v88, v89
    v_cvt_pk_bf16_f32 v89, v90, v91
    ds_pk_add_bf16 v7, v88 offset:65408
    ds_pk_add_bf16 v7, v89 offset:65412
    s_mov_b64 exec, s[54:55]
    s_branch L2_d44
L2_c45:
    s_lshl_b64 s[52:53], s[82:83], 1
    s_andn2_b64 s[52:53], s[52:53], s[80:81]
    s_andn2_b64 s[52:53], s[52:53], s[50:51]
    s_or_b64 s[80:81], s[80:81], s[52:53]
    s_not_b64 vcc, s[52:53]
    s_mov_b64 exec, -1
    v_cndmask_b32_dpp v84, v84, v84, vcc wave_shr:1 row_mask:0xf bank_mask:0xf
    v_cndmask_b32_dpp v85, v85, v85, vcc wave_shr:1 row_mask:0xf bank_mask:0xf
    s_lshr_b64 s[52:53], s[52:53], 1
    v_cndmask_b32_dpp v86, v86, v86, vcc wave_shr:1 row_mask:0xf bank_mask:0xf
    v_cndmask_b32_dpp v87, v87, v87, vcc wave_shr:1 row_mask:0xf bank_mask:0xf
    s_andn2_b64 s[82:83], s[82:83], s[52:53]
    v_cndmask_b32_dpp v7, v7, v7, vcc wave_shr:1 row_mask:0xf bank_mask:0xf
    s_mov_b64 exec, s[50:51]
    s_cbranch_scc0 L2_d45
    s_mov_b64 exec, s[82:83]
    s_nop 1
    v_mfma_f32_4x4x4_16b_bf16 v[88:91], v[12:13], v[84:85], 0
    s_nop 1
    v_mfma_f32_4x4x4_16b_bf16 v[88:91], v[10:11], v[86:87], v[88:91]
    s_nop 4
    v_cvt_pk_bf16_f32 v88, v88, v89
    v_cvt_pk_bf16_f32 v89, v90, v91
    ds_pk_add_bf16 v7, v88 offset:65408
    ds_pk_add_bf16 v7, v89 offset:65412
    s_mov_b64 exec, s[50:51]
    s_branch L2_d45
L2_c46:
    s_lshl_b64 s[52:53], s[82:83], 1
    s_andn2_b64 s[52:53], s[52:53], s[80:81]
    s_andn2_b64 s[52:53], s[52:53], s[54:55]
    s_or_b64 s[80:81], s[80:81], s[52:53]
    s_not_b64 vcc, s[52:53]
    s_mov_b64 exec, -1
    v_cndmask_b32_dpp v84, v84, v84, vcc wave_shr:1 row_mask:0xf bank_mask:0xf
    v_cndmask_b32_dpp v85, v85, v85, vcc wave_shr:1 row_mask:0xf bank_mask:0xf
    s_lshr_b64 s[52:53], s[52:53], 1
    v_cndmask_b32_dpp v86, v86, v86, vcc wave_shr:1 row_mask:0xf bank_mask:0xf
    v_cndmask_b32_dpp v87, v87, v87, vcc wave_shr:1 row_mask:0xf bank_mask:0xf
    s_andn2_b64 s[82:83], s[82:83], s[52:53]
    v_cndmask_b32_dpp v7, v7, v7, vcc wave_shr:1 row_mask:0xf bank_mask:0xf
    s_mov_b64 exec, s[54:55]
    s_cbranch_scc0 L2_d46
    s_mov_b64 exec, s[82:83]
    s_nop 1
    v_mfma_f32_4x4x4_16b_bf16 v[88:91], v[12:13], v[84:85], 0
    s_nop 1
    v_mfma_f32_4x4x4_16b_bf16 v[88:91], v[10:11], v[86:87], v[88:91]
    s_nop 4
    v_cvt_pk_bf16_f32 v88, v88, v89
    v_cvt_pk_bf16_f32 v89, v90, v91
    ds_pk_add_bf16 v7, v88 offset:65408
    ds_pk_add_bf16 v7, v89 offset:65412
    s_mov_b64 exec, s[54:55]
    s_branch L2_d46
L2_c47:
    s_lshl_b64 s[52:53], s[82:83], 1
    s_andn2_b64 s[52:53], s[52:53], s[80:81]
    s_andn2_b64 s[52:53], s[52:53], s[50:51]
    s_or_b64 s[80:81], s[80:81], s[52:53]
    s_not_b64 vcc, s[52:53]
    s_mov_b64 exec, -1
    v_cndmask_b32_dpp v84, v84, v84, vcc wave_shr:1 row_mask:0xf bank_mask:0xf
    v_cndmask_b32_dpp v85, v85, v85, vcc wave_shr:1 row_mask:0xf bank_mask:0xf
    s_lshr_b64 s[52:53], s[52:53], 1
    v_cndmask_b32_dpp v86, v86, v86, vcc wave_shr:1 row_mask:0xf bank_mask:0xf
    v_cndmask_b32_dpp v87, v87, v87, vcc wave_shr:1 row_mask:0xf bank_mask:0xf
    s_andn2_b64 s[82:83], s[82:83], s[52:53]
    v_cndmask_b32_dpp v7, v7, v7, vcc wave_shr:1 row_mask:0xf bank_mask:0xf
    s_mov_b64 exec, s[50:51]
    s_cbranch_scc0 L2_d47
    s_mov_b64 exec, s[82:83]
    s_nop 1
    v_mfma_f32_4x4x4_16b_bf16 v[88:91], v[12:13], v[84:85], 0
    s_nop 1
    v_mfma_f32_4x4x4_16b_bf16 v[88:91], v[10:11], v[86:87], v[88:91]
    s_nop 4
    v_cvt_pk_bf16_f32 v88, v88, v89
    v_cvt_pk_bf16_f32 v89, v90, v91
    ds_pk_add_bf16 v7, v88 offset:65408
    ds_pk_add_bf16 v7, v89 offset:65412
    s_mov_b64 exec, s[50:51]
    s_branch L2_d47
L2_c48:
    s_lshl_b64 s[52:53], s[82:83], 1
    s_andn2_b64 s[52:53], s[52:53], s[80:81]
    s_andn2_b64 s[52:53], s[52:53], s[54:55]
    s_or_b64 s[80:81], s[80:81], s[52:53]
    s_not_b64 vcc, s[52:53]
    s_mov_b64 exec, -1
    v_cndmask_b32_dpp v84, v84, v84, vcc wave_shr:1 row_mask:0xf bank_mask:0xf
    v_cndmask_b32_dpp v85, v85, v85, vcc wave_shr:1 row_mask:0xf bank_mask:0xf
    s_lshr_b64 s[52:53], s[52:53], 1
    v_cndmask_b32_dpp v86, v86, v86, vcc wave_shr:1 row_mask:0xf bank_mask:0xf
    v_cndmask_b32_dpp v87, v87, v87, vcc wave_shr:1 row_mask:0xf bank_mask:0xf
    s_andn2_b64 s[82:83], s[82:83], s[52:53]
    v_cndmask_b32_dpp v7, v7, v7, vcc wave_shr:1 row_mask:0xf bank_mask:0xf
    s_mov_b64 exec, s[54:55]
    s_cbranch_scc0 L2_d48
    s_mov_b64 exec, s[82:83]
    s_nop 1
    v_mfma_f32_4x4x4_16b_bf16 v[88:91], v[12:13], v[84:85], 0
    s_nop 1
    v_mfma_f32_4x4x4_16b_bf16 v[88:91], v[10:11], v[86:87], v[88:91]
    s_nop 4
    v_cvt_pk_bf16_f32 v88, v88, v89
    v_cvt_pk_bf16_f32 v89, v90, v91
    ds_pk_add_bf16 v7, v88 offset:65408
    ds_pk_add_bf16 v7, v89 offset:65412
    s_mov_b64 exec, s[54:55]
    s_branch L2_d48
L2_c49:
    s_lshl_b64 s[52:53], s[82:83], 1
    s_andn2_b64 s[52:53], s[52:53], s[80:81]
    s_andn2_b64 s[52:53], s[52:53], s[50:51]
    s_or_b64 s[80:81], s[80:81], s[52:53]
    s_not_b64 vcc, s[52:53]
    s_mov_b64 exec, -1
    v_cndmask_b32_dpp v84, v84, v84, vcc wave_shr:1 row_mask:0xf bank_mask:0xf
    v_cndmask_b32_dpp v85, v85, v85, vcc wave_shr:1 row_mask:0xf bank_mask:0xf
    s_lshr_b64 s[52:53], s[52:53], 1
    v_cndmask_b32_dpp v86, v86, v86, vcc wave_shr:1 row_mask:0xf bank_mask:0xf
    v_cndmask_b32_dpp v87, v87, v87, vcc wave_shr:1 row_mask:0xf bank_mask:0xf
    s_andn2_b64 s[82:83], s[82:83], s[52:53]
    v_cndmask_b32_dpp v7, v7, v7, vcc wave_shr:1 row_mask:0xf bank_mask:0xf
    s_mov_b64 exec, s[50:51]
    s_cbranch_scc0 L2_d49
    s_mov_b64 exec, s[82:83]
    s_nop 1
    v_mfma_f32_4x4x4_16b_bf16 v[88:91], v[12:13], v[84:85], 0
    s_nop 1
    v_mfma_f32_4x4x4_16b_bf16 v[88:91], v[10:11], v[86:87], v[88:91]
    s_nop 4
    v_cvt_pk_bf16_f32 v88, v88, v89
    v_cvt_pk_bf16_f32 v89, v90, v91
    ds_pk_add_bf16 v7, v88 offset:65408
    ds_pk_add_bf16 v7, v89 offset:65412
    s_mov_b64 exec, s[50:51]
    s_branch L2_d49
L2_xo50:
    v_cmp_lt_u32 vcc, 20, v99
    s_mov_b32 s101, 1
    s_cbranch_vccz L2_xp50
    v_cmp_lt_u32 vcc, 32, v99
    v_cmp_lt_u32 s[58:59], 31, v88
    s_mov_b32 s101, 2
    s_or_b64 vcc, vcc, s[58:59]
    s_cbranch_scc0 L2_xp50
    s_mov_b32 s37, 0x10000
    s_branch L2_xp50
L2_c51:
    s_lshl_b64 s[52:53], s[82:83], 1
    s_andn2_b64 s[52:53], s[52:53], s[80:81]
    s_andn2_b64 s[52:53], s[52:53], s[54:55]
    s_or_b64 s[80:81], s[80:81], s[52:53]
    s_not_b64 vcc, s[52:53]
    s_mov_b64 exec, -1
    v_cndmask_b32_dpp v84, v84, v84, vcc wave_shr:1 row_mask:0xf bank_mask:0xf
    v_cndmask_b32_dpp v85, v85, v85, vcc wave_shr:1 row_mask:0xf bank_mask:0xf
    s_lshr_b64 s[52:53], s[52:53], 1
    v_cndmask_b32_dpp v86, v86, v86, vcc wave_shr:1 row_mask:0xf bank_mask:0xf
    v_cndmask_b32_dpp v87, v87, v87, vcc wave_shr:1 row_mask:0xf bank_mask:0xf
    s_andn2_b64 s[82:83], s[82:83], s[52:53]
    v_cndmask_b32_dpp v7, v7, v7, vcc wave_shr:1 row_mask:0xf bank_mask:0xf
    s_mov_b64 exec, s[54:55]
    s_cbranch_scc0 L2_d51
    s_mov_b64 exec, s[82:83]
    s_nop 1
    v_mfma_f32_4x4x4_16b_bf16 v[88:91], v[12:13], v[84:85], 0
    s_nop 1
    v_mfma_f32_4x4x4_16b_bf16 v[88:91], v[10:11], v[86:87], v[88:91]
    s_nop 4
    v_cvt_pk_bf16_f32 v88, v88, v89
    v_cvt_pk_bf16_f32 v89, v90, v91
    ds_pk_add_bf16 v7, v88 offset:65408
    ds_pk_add_bf16 v7, v89 offset:65412
    s_mov_b64 exec, s[54:55]
    s_branch L2_d51
L2_c52:
    s_lshl_b64 s[52:53], s[82:83], 1
    s_andn2_b64 s[52:53], s[52:53], s[80:81]
    s_andn2_b64 s[52:53], s[52:53], s[50:51]
    s_or_b64 s[80:81], s[80:81], s[52:53]
    s_not_b64 vcc, s[52:53]
    s_mov_b64 exec, -1
    v_cndmask_b32_dpp v84, v84, v84, vcc wave_shr:1 row_mask:0xf bank_mask:0xf
    v_cndmask_b32_dpp v85, v85, v85, vcc wave_shr:1 row_mask:0xf bank_mask:0xf
    s_lshr_b64 s[52:53], s[52:53], 1
    v_cndmask_b32_dpp v86, v86, v86, vcc wave_shr:1 row_mask:0xf bank_mask:0xf
    v_cndmask_b32_dpp v87, v87, v87, vcc wave_shr:1 row_mask:0xf bank_mask:0xf
    s_andn2_b64 s[82:83], s[82:83], s[52:53]
    v_cndmask_b32_dpp v7, v7, v7, vcc wave_shr:1 row_mask:0xf bank_mask:0xf
    s_mov_b64 exec, s[50:51]
    s_cbranch_scc0 L2_d52
    s_mov_b64 exec, s[82:83]
    s_nop 1
    v_mfma_f32_4x4x4_16b_bf16 v[88:91], v[12:13], v[84:85], 0
    s_nop 1
    v_mfma_f32_4x4x4_16b_bf16 v[88:91], v[10:11], v[86:87], v[88:91]
    s_nop 4
    v_cvt_pk_bf16_f32 v88, v88, v89
    v_cvt_pk_bf16_f32 v89, v90, v91
    ds_pk_add_bf16 v7, v88 offset:65408
    ds_pk_add_bf16 v7, v89 offset:65412
    s_mov_b64 exec, s[50:51]
    s_branch L2_d52
L2_c53:
    s_lshl_b64 s[52:53], s[82:83], 1
    s_andn2_b64 s[52:53], s[52:53], s[80:81]
    s_andn2_b64 s[52:53], s[52:53], s[54:55]
    s_or_b64 s[80:81], s[80:81], s[52:53]
    s_not_b64 vcc, s[52:53]
    s_mov_b64 exec, -1
    v_cndmask_b32_dpp v84, v84, v84, vcc wave_shr:1 row_mask:0xf bank_mask:0xf
    v_cndmask_b32_dpp v85, v85, v85, vcc wave_shr:1 row_mask:0xf bank_mask:0xf
    s_lshr_b64 s[52:53], s[52:53], 1
    v_cndmask_b32_dpp v86, v86, v86, vcc wave_shr:1 row_mask:0xf bank_mask:0xf
    v_cndmask_b32_dpp v87, v87, v87, vcc wave_shr:1 row_mask:0xf bank_mask:0xf
    s_andn2_b64 s[82:83], s[82:83], s[52:53]
    v_cndmask_b32_dpp v7, v7, v7, vcc wave_shr:1 row_mask:0xf bank_mask:0xf
    s_mov_b64 exec, s[54:55]
    s_cbranch_scc0 L2_d53
    s_mov_b64 exec, s[82:83]
    s_nop 1
    v_mfma_f32_4x4x4_16b_bf16 v[88:91], v[12:13], v[84:85], 0
    s_nop 1
    v_mfma_f32_4x4x4_16b_bf16 v[88:91], v[10:11], v[86:87], v[88:91]
    s_nop 4
    v_cvt_pk_bf16_f32 v88, v88, v89
    v_cvt_pk_bf16_f32 v89, v90, v91
    ds_pk_add_bf16 v7, v88 offset:65408
    ds_pk_add_bf16 v7, v89 offset:65412
    s_mov_b64 exec, s[54:55]
    s_branch L2_d53
L2_c54:
    s_lshl_b64 s[52:53], s[82:83], 1
    s_andn2_b64 s[52:53], s[52:53], s[80:81]
    s_andn2_b64 s[52:53], s[52:53], s[50:51]
    s_or_b64 s[80:81], s[80:81], s[52:53]
    s_not_b64 vcc, s[52:53]
    s_mov_b64 exec, -1
    v_cndmask_b32_dpp v84, v84, v84, vcc wave_shr:1 row_mask:0xf bank_mask:0xf
    v_cndmask_b32_dpp v85, v85, v85, vcc wave_shr:1 row_mask:0xf bank_mask:0xf
    s_lshr_b64 s[52:53], s[52:53], 1
    v_cndmask_b32_dpp v86, v86, v86, vcc wave_shr:1 row_mask:0xf bank_mask:0xf
    v_cndmask_b32_dpp v87, v87, v87, vcc wave_shr:1 row_mask:0xf bank_mask:0xf
    s_andn2_b64 s[82:83], s[82:83], s[52:53]
    v_cndmask_b32_dpp v7, v7, v7, vcc wave_shr:1 row_mask:0xf bank_mask:0xf
    s_mov_b64 exec, s[50:51]
    s_cbranch_scc0 L2_d54
    s_mov_b64 exec, s[82:83]
    s_nop 1
    v_mfma_f32_4x4x4_16b_bf16 v[88:91], v[12:13], v[84:85], 0
    s_nop 1
    v_mfma_f32_4x4x4_16b_bf16 v[88:91], v[10:11], v[86:87], v[88:91]
    s_nop 4
    v_cvt_pk_bf16_f32 v88, v88, v89
    v_cvt_pk_bf16_f32 v89, v90, v91
    ds_pk_add_bf16 v7, v88 offset:65408
    ds_pk_add_bf16 v7, v89 offset:65412
    s_mov_b64 exec, s[50:51]
    s_branch L2_d54
L2_c55:
    s_lshl_b64 s[52:53], s[82:83], 1
    s_andn2_b64 s[52:53], s[52:53], s[80:81]
    s_andn2_b64 s[52:53], s[52:53], s[54:55]
    s_or_b64 s[80:81], s[80:81], s[52:53]
    s_not_b64 vcc, s[52:53]
    s_mov_b64 exec, -1
    v_cndmask_b32_dpp v84, v84, v84, vcc wave_shr:1 row_mask:0xf bank_mask:0xf
    v_cndmask_b32_dpp v85, v85, v85, vcc wave_shr:1 row_mask:0xf bank_mask:0xf
    s_lshr_b64 s[52:53], s[52:53], 1
    v_cndmask_b32_dpp v86, v86, v86, vcc wave_shr:1 row_mask:0xf bank_mask:0xf
    v_cndmask_b32_dpp v87, v87, v87, vcc wave_shr:1 row_mask:0xf bank_mask:0xf
    s_andn2_b64 s[82:83], s[82:83], s[52:53]
    v_cndmask_b32_dpp v7, v7, v7, vcc wave_shr:1 row_mask:0xf bank_mask:0xf
    s_mov_b64 exec, s[54:55]
    s_cbranch_scc0 L2_d55
    s_mov_b64 exec, s[82:83]
    s_nop 1
    v_mfma_f32_4x4x4_16b_bf16 v[88:91], v[12:13], v[84:85], 0
    s_nop 1
    v_mfma_f32_4x4x4_16b_bf16 v[88:91], v[10:11], v[86:87], v[88:91]
    s_nop 4
    v_cvt_pk_bf16_f32 v88, v88, v89
    v_cvt_pk_bf16_f32 v89, v90, v91
    ds_pk_add_bf16 v7, v88 offset:65408
    ds_pk_add_bf16 v7, v89 offset:65412
    s_mov_b64 exec, s[54:55]
    s_branch L2_d55
L2_c56:
    s_lshl_b64 s[52:53], s[82:83], 1
    s_andn2_b64 s[52:53], s[52:53], s[80:81]
    s_andn2_b64 s[52:53], s[52:53], s[50:51]
    s_or_b64 s[80:81], s[80:81], s[52:53]
    s_not_b64 vcc, s[52:53]
    s_mov_b64 exec, -1
    v_cndmask_b32_dpp v84, v84, v84, vcc wave_shr:1 row_mask:0xf bank_mask:0xf
    v_cndmask_b32_dpp v85, v85, v85, vcc wave_shr:1 row_mask:0xf bank_mask:0xf
    s_lshr_b64 s[52:53], s[52:53], 1
    v_cndmask_b32_dpp v86, v86, v86, vcc wave_shr:1 row_mask:0xf bank_mask:0xf
    v_cndmask_b32_dpp v87, v87, v87, vcc wave_shr:1 row_mask:0xf bank_mask:0xf
    s_andn2_b64 s[82:83], s[82:83], s[52:53]
    v_cndmask_b32_dpp v7, v7, v7, vcc wave_shr:1 row_mask:0xf bank_mask:0xf
    s_mov_b64 exec, s[50:51]
    s_cbranch_scc0 L2_d56
    s_mov_b64 exec, s[82:83]
    s_nop 1
    v_mfma_f32_4x4x4_16b_bf16 v[88:91], v[12:13], v[84:85], 0
    s_nop 1
    v_mfma_f32_4x4x4_16b_bf16 v[88:91], v[10:11], v[86:87], v[88:91]
    s_nop 4
    v_cvt_pk_bf16_f32 v88, v88, v89
    v_cvt_pk_bf16_f32 v89, v90, v91
    ds_pk_add_bf16 v7, v88 offset:65408
    ds_pk_add_bf16 v7, v89 offset:65412
    s_mov_b64 exec, s[50:51]
    s_branch L2_d56
L2_c57:
    s_lshl_b64 s[52:53], s[82:83], 1
    s_andn2_b64 s[52:53], s[52:53], s[80:81]
    s_andn2_b64 s[52:53], s[52:53], s[54:55]
    s_or_b64 s[80:81], s[80:81], s[52:53]
    s_not_b64 vcc, s[52:53]
    s_mov_b64 exec, -1
    v_cndmask_b32_dpp v84, v84, v84, vcc wave_shr:1 row_mask:0xf bank_mask:0xf
    v_cndmask_b32_dpp v85, v85, v85, vcc wave_shr:1 row_mask:0xf bank_mask:0xf
    s_lshr_b64 s[52:53], s[52:53], 1
    v_cndmask_b32_dpp v86, v86, v86, vcc wave_shr:1 row_mask:0xf bank_mask:0xf
    v_cndmask_b32_dpp v87, v87, v87, vcc wave_shr:1 row_mask:0xf bank_mask:0xf
    s_andn2_b64 s[82:83], s[82:83], s[52:53]
    v_cndmask_b32_dpp v7, v7, v7, vcc wave_shr:1 row_mask:0xf bank_mask:0xf
    s_mov_b64 exec, s[54:55]
    s_cbranch_scc0 L2_d57
    s_mov_b64 exec, s[82:83]
    s_nop 1
    v_mfma_f32_4x4x4_16b_bf16 v[88:91], v[12:13], v[84:85], 0
    s_nop 1
    v_mfma_f32_4x4x4_16b_bf16 v[88:91], v[10:11], v[86:87], v[88:91]
    s_nop 4
    v_cvt_pk_bf16_f32 v88, v88, v89
    v_cvt_pk_bf16_f32 v89, v90, v91
    ds_pk_add_bf16 v7, v88 offset:65408
    ds_pk_add_bf16 v7, v89 offset:65412
    s_mov_b64 exec, s[54:55]
    s_branch L2_d57
L2_c58:
    s_lshl_b64 s[52:53], s[82:83], 1
    s_andn2_b64 s[52:53], s[52:53], s[80:81]
    s_andn2_b64 s[52:53], s[52:53], s[50:51]
    s_or_b64 s[80:81], s[80:81], s[52:53]
    s_not_b64 vcc, s[52:53]
    s_mov_b64 exec, -1
    v_cndmask_b32_dpp v84, v84, v84, vcc wave_shr:1 row_mask:0xf bank_mask:0xf
    v_cndmask_b32_dpp v85, v85, v85, vcc wave_shr:1 row_mask:0xf bank_mask:0xf
    s_lshr_b64 s[52:53], s[52:53], 1
    v_cndmask_b32_dpp v86, v86, v86, vcc wave_shr:1 row_mask:0xf bank_mask:0xf
    v_cndmask_b32_dpp v87, v87, v87, vcc wave_shr:1 row_mask:0xf bank_mask:0xf
    s_andn2_b64 s[82:83], s[82:83], s[52:53]
    v_cndmask_b32_dpp v7, v7, v7, vcc wave_shr:1 row_mask:0xf bank_mask:0xf
    s_mov_b64 exec, s[50:51]
    s_cbranch_scc0 L2_d58
    s_mov_b64 exec, s[82:83]
    s_nop 1
    v_mfma_f32_4x4x4_16b_bf16 v[88:91], v[12:13], v[84:85], 0
    s_nop 1
    v_mfma_f32_4x4x4_16b_bf16 v[88:91], v[10:11], v[86:87], v[88:91]
    s_nop 4
    v_cvt_pk_bf16_f32 v88, v88, v89
    v_cvt_pk_bf16_f32 v89, v90, v91
    ds_pk_add_bf16 v7, v88 offset:65408
    ds_pk_add_bf16 v7, v89 offset:65412
    s_mov_b64 exec, s[50:51]
    s_branch L2_d58
L2_c59:
    s_lshl_b64 s[52:53], s[82:83], 1
    s_andn2_b64 s[52:53], s[52:53], s[80:81]
    s_andn2_b64 s[52:53], s[52:53], s[54:55]
    s_or_b64 s[80:81], s[80:81], s[52:53]
    s_not_b64 vcc, s[52:53]
    s_mov_b64 exec, -1
    v_cndmask_b32_dpp v84, v84, v84, vcc wave_shr:1 row_mask:0xf bank_mask:0xf
    v_cndmask_b32_dpp v85, v85, v85, vcc wave_shr:1 row_mask:0xf bank_mask:0xf
    s_lshr_b64 s[52:53], s[52:53], 1
    v_cndmask_b32_dpp v86, v86, v86, vcc wave_shr:1 row_mask:0xf bank_mask:0xf
    v_cndmask_b32_dpp v87, v87, v87, vcc wave_shr:1 row_mask:0xf bank_mask:0xf
    s_andn2_b64 s[82:83], s[82:83], s[52:53]
    v_cndmask_b32_dpp v7, v7, v7, vcc wave_shr:1 row_mask:0xf bank_mask:0xf
    s_mov_b64 exec, s[54:55]
    s_cbranch_scc0 L2_d59
    s_mov_b64 exec, s[82:83]
    s_nop 1
    v_mfma_f32_4x4x4_16b_bf16 v[88:91], v[12:13], v[84:85], 0
    s_nop 1
    v_mfma_f32_4x4x4_16b_bf16 v[88:91], v[10:11], v[86:87], v[88:91]
    s_nop 4
    v_cvt_pk_bf16_f32 v88, v88, v89
    v_cvt_pk_bf16_f32 v89, v90, v91
    ds_pk_add_bf16 v7, v88 offset:65408
    ds_pk_add_bf16 v7, v89 offset:65412
    s_mov_b64 exec, s[54:55]
    s_branch L2_d59
L2_c60:
    s_lshl_b64 s[52:53], s[82:83], 1
    s_andn2_b64 s[52:53], s[52:53], s[80:81]
    s_andn2_b64 s[52:53], s[52:53], s[50:51]
    s_or_b64 s[80:81], s[80:81], s[52:53]
    s_not_b64 vcc, s[52:53]
    s_mov_b64 exec, -1
    v_cndmask_b32_dpp v84, v84, v84, vcc wave_shr:1 row_mask:0xf bank_mask:0xf
    v_cndmask_b32_dpp v85, v85, v85, vcc wave_shr:1 row_mask:0xf bank_mask:0xf
    s_lshr_b64 s[52:53], s[52:53], 1
    v_cndmask_b32_dpp v86, v86, v86, vcc wave_shr:1 row_mask:0xf bank_mask:0xf
    v_cndmask_b32_dpp v87, v87, v87, vcc wave_shr:1 row_mask:0xf bank_mask:0xf
    s_andn2_b64 s[82:83], s[82:83], s[52:53]
    v_cndmask_b32_dpp v7, v7, v7, vcc wave_shr:1 row_mask:0xf bank_mask:0xf
    s_mov_b64 exec, s[50:51]
    s_cbranch_scc0 L2_d60
    s_mov_b64 exec, s[82:83]
    s_nop 1
    v_mfma_f32_4x4x4_16b_bf16 v[88:91], v[12:13], v[84:85], 0
    s_nop 1
    v_mfma_f32_4x4x4_16b_bf16 v[88:91], v[10:11], v[86:87], v[88:91]
    s_nop 4
    v_cvt_pk_bf16_f32 v88, v88, v89
    v_cvt_pk_bf16_f32 v89, v90, v91
    ds_pk_add_bf16 v7, v88 offset:65408
    ds_pk_add_bf16 v7, v89 offset:65412
    s_mov_b64 exec, s[50:51]
    s_branch L2_d60
L2_xa61:
    s_cmp_eq_u32 s101, 1
    s_cbranch_scc1 L2_xc61
    v_lshlrev_b32 v89, 0, v96
    v_add_u32 v90, 140, v97
    v_bitop3_b32 v90, v89, v45, v90 bitop3:0x6a
    ds_write_b32 v98, v90 offset:28
    v_lshlrev_b32 v89, 4, v96
    v_add_u32 v90, 120, v97
    v_bitop3_b32 v90, v89, v45, v90 bitop3:0x6a
    ds_write_b32 v98, v90 offset:24
    v_lshlrev_b32 v89, 8, v96
    v_add_u32 v90, 100, v97
    v_bitop3_b32 v90, v89, v45, v90 bitop3:0x6a
    ds_write_b32 v98, v90 offset:20
L2_xc61:
    v_lshlrev_b32 v89, 12, v96
    v_add_u32 v90, 80, v97
    v_bitop3_b32 v90, v89, v45, v90 bitop3:0x6a
    ds_write_b32 v98, v90 offset:16
    s_branch L2_xb61
L2_xe61:
    v_cmp_lt_u32 vcc, 32, v99
    v_cmp_lt_u32 s[58:59], 31, v88
    v_lshrrev_b32 v89, 16, v96
    v_add_u32 v97, 80, v97
    s_or_b64 vcc, vcc, s[58:59]
    s_cbranch_scc1 L2_xs61
    v_lshlrev_b32 v89, v1, v89
    v_and_b32 v89, v45, v89
    v_cmp_ne_u32 vcc, 0, v89
    v_xor_b32 v90, v97, v89
    s_add_u32 s3, s37, s38
    v_mbcnt_lo_u32_b32 v98, vcc_lo, 0
    v_mbcnt_hi_u32_b32 v98, vcc_hi, v98
    s_bcnt1_i32_b64 s41, vcc
    v_lshl_add_u32 v98, v98, 2, s3
    s_mov_b64 exec, vcc
    ds_write_b32 v98, v90
    s_mov_b64 exec, -1
    s_lshl2_add_u32 s37, s41, s37
    s_branch L2_xr61
L2_xf61:
    s_waitcnt lgkmcnt(0)
    s_cmp_gt_u32 s37, 1024
    s_cbranch_scc1 L2_xs61
    v_mov_b32 v43, -1
    s_cmp_ge_u32 s37, 512
    s_cbranch_scc1 L2_xg61
    v_mov_b32 v42, -1
    s_cmp_ge_u32 s37, 256
    s_cbranch_scc1 L2_xg61
    v_mov_b32 v41, -1
    s_branch L2_xg61
L2_xs61:
    s_waitcnt lgkmcnt(0)
    v_mov_b32 v40, -1
    v_mov_b32 v41, -1
    v_mov_b32 v42, -1
    v_mov_b32 v43, -1
    s_add_u32 s3, s42, 2
    s_bitset1_b32 s36, s3
    s_branch L2_xg61
L2_c62:
    s_lshl_b64 s[52:53], s[82:83], 1
    s_andn2_b64 s[52:53], s[52:53], s[80:81]
    s_andn2_b64 s[52:53], s[52:53], s[54:55]
    s_or_b64 s[80:81], s[80:81], s[52:53]
    s_not_b64 vcc, s[52:53]
    s_mov_b64 exec, -1
    v_cndmask_b32_dpp v84, v84, v84, vcc wave_shr:1 row_mask:0xf bank_mask:0xf
    v_cndmask_b32_dpp v85, v85, v85, vcc wave_shr:1 row_mask:0xf bank_mask:0xf
    s_lshr_b64 s[52:53], s[52:53], 1
    v_cndmask_b32_dpp v86, v86, v86, vcc wave_shr:1 row_mask:0xf bank_mask:0xf
    v_cndmask_b32_dpp v87, v87, v87, vcc wave_shr:1 row_mask:0xf bank_mask:0xf
    s_andn2_b64 s[82:83], s[82:83], s[52:53]
    v_cndmask_b32_dpp v7, v7, v7, vcc wave_shr:1 row_mask:0xf bank_mask:0xf
    s_mov_b64 exec, s[54:55]
    s_cbranch_scc0 L2_d62
    s_mov_b64 exec, s[82:83]
    s_nop 1
    v_mfma_f32_4x4x4_16b_bf16 v[88:91], v[12:13], v[84:85], 0
    s_nop 1
    v_mfma_f32_4x4x4_16b_bf16 v[88:91], v[10:11], v[86:87], v[88:91]
    s_nop 4
    v_cvt_pk_bf16_f32 v88, v88, v89
    v_cvt_pk_bf16_f32 v89, v90, v91
    ds_pk_add_bf16 v7, v88 offset:65408
    ds_pk_add_bf16 v7, v89 offset:65412
    s_mov_b64 exec, s[54:55]
    s_branch L2_d62
L2_c63:
    s_lshl_b64 s[52:53], s[82:83], 1
    s_andn2_b64 s[52:53], s[52:53], s[80:81]
    s_andn2_b64 s[52:53], s[52:53], s[50:51]
    s_or_b64 s[80:81], s[80:81], s[52:53]
    s_not_b64 vcc, s[52:53]
    s_mov_b64 exec, -1
    v_cndmask_b32_dpp v84, v84, v84, vcc wave_shr:1 row_mask:0xf bank_mask:0xf
    v_cndmask_b32_dpp v85, v85, v85, vcc wave_shr:1 row_mask:0xf bank_mask:0xf
    s_lshr_b64 s[52:53], s[52:53], 1
    v_cndmask_b32_dpp v86, v86, v86, vcc wave_shr:1 row_mask:0xf bank_mask:0xf
    v_cndmask_b32_dpp v87, v87, v87, vcc wave_shr:1 row_mask:0xf bank_mask:0xf
    s_andn2_b64 s[82:83], s[82:83], s[52:53]
    v_cndmask_b32_dpp v7, v7, v7, vcc wave_shr:1 row_mask:0xf bank_mask:0xf
    s_mov_b64 exec, s[50:51]
    s_cbranch_scc0 L2_d63
    s_mov_b64 exec, s[82:83]
    s_nop 1
    v_mfma_f32_4x4x4_16b_bf16 v[88:91], v[12:13], v[84:85], 0
    s_nop 1
    v_mfma_f32_4x4x4_16b_bf16 v[88:91], v[10:11], v[86:87], v[88:91]
    s_nop 4
    v_cvt_pk_bf16_f32 v88, v88, v89
    v_cvt_pk_bf16_f32 v89, v90, v91
    ds_pk_add_bf16 v7, v88 offset:65408
    ds_pk_add_bf16 v7, v89 offset:65412
    s_mov_b64 exec, s[50:51]
    s_branch L2_d63
L2_c64:
    s_lshl_b64 s[52:53], s[82:83], 1
    s_andn2_b64 s[52:53], s[52:53], s[80:81]
    s_andn2_b64 s[52:53], s[52:53], s[54:55]
    s_or_b64 s[80:81], s[80:81], s[52:53]
    s_not_b64 vcc, s[52:53]
    s_mov_b64 exec, -1
    v_cndmask_b32_dpp v84, v84, v84, vcc wave_shr:1 row_mask:0xf bank_mask:0xf
    v_cndmask_b32_dpp v85, v85, v85, vcc wave_shr:1 row_mask:0xf bank_mask:0xf
    s_lshr_b64 s[52:53], s[52:53], 1
    v_cndmask_b32_dpp v86, v86, v86, vcc wave_shr:1 row_mask:0xf bank_mask:0xf
    v_cndmask_b32_dpp v87, v87, v87, vcc wave_shr:1 row_mask:0xf bank_mask:0xf
    s_andn2_b64 s[82:83], s[82:83], s[52:53]
    v_cndmask_b32_dpp v7, v7, v7, vcc wave_shr:1 row_mask:0xf bank_mask:0xf
    s_mov_b64 exec, s[54:55]
    s_cbranch_scc0 L2_d64
    s_mov_b64 exec, s[82:83]
    s_nop 1
    v_mfma_f32_4x4x4_16b_bf16 v[88:91], v[12:13], v[84:85], 0
    s_nop 1
    v_mfma_f32_4x4x4_16b_bf16 v[88:91], v[10:11], v[86:87], v[88:91]
    s_nop 4
    v_cvt_pk_bf16_f32 v88, v88, v89
    v_cvt_pk_bf16_f32 v89, v90, v91
    ds_pk_add_bf16 v7, v88 offset:65408
    ds_pk_add_bf16 v7, v89 offset:65412
    s_mov_b64 exec, s[54:55]
    s_branch L2_d64
L2_c65:
    s_lshl_b64 s[52:53], s[82:83], 1
    s_andn2_b64 s[52:53], s[52:53], s[80:81]
    s_andn2_b64 s[52:53], s[52:53], s[50:51]
    s_or_b64 s[80:81], s[80:81], s[52:53]
    s_not_b64 vcc, s[52:53]
    s_mov_b64 exec, -1
    v_cndmask_b32_dpp v84, v84, v84, vcc wave_shr:1 row_mask:0xf bank_mask:0xf
    v_cndmask_b32_dpp v85, v85, v85, vcc wave_shr:1 row_mask:0xf bank_mask:0xf
    s_lshr_b64 s[52:53], s[52:53], 1
    v_cndmask_b32_dpp v86, v86, v86, vcc wave_shr:1 row_mask:0xf bank_mask:0xf
    v_cndmask_b32_dpp v87, v87, v87, vcc wave_shr:1 row_mask:0xf bank_mask:0xf
    s_andn2_b64 s[82:83], s[82:83], s[52:53]
    v_cndmask_b32_dpp v7, v7, v7, vcc wave_shr:1 row_mask:0xf bank_mask:0xf
    s_mov_b64 exec, s[50:51]
    s_cbranch_scc0 L2_d65
    s_mov_b64 exec, s[82:83]
    s_nop 1
    v_mfma_f32_4x4x4_16b_bf16 v[88:91], v[12:13], v[84:85], 0
    s_nop 1
    v_mfma_f32_4x4x4_16b_bf16 v[88:91], v[10:11], v[86:87], v[88:91]
    s_nop 4
    v_cvt_pk_bf16_f32 v88, v88, v89
    v_cvt_pk_bf16_f32 v89, v90, v91
    ds_pk_add_bf16 v7, v88 offset:65408
    ds_pk_add_bf16 v7, v89 offset:65412
    s_mov_b64 exec, s[50:51]
    s_branch L2_d65
L2_c66:
    s_lshl_b64 s[52:53], s[82:83], 1
    s_andn2_b64 s[52:53], s[52:53], s[80:81]
    s_andn2_b64 s[52:53], s[52:53], s[54:55]
    s_or_b64 s[80:81], s[80:81], s[52:53]
    s_not_b64 vcc, s[52:53]
    s_mov_b64 exec, -1
    v_cndmask_b32_dpp v84, v84, v84, vcc wave_shr:1 row_mask:0xf bank_mask:0xf
    v_cndmask_b32_dpp v85, v85, v85, vcc wave_shr:1 row_mask:0xf bank_mask:0xf
    s_lshr_b64 s[52:53], s[52:53], 1
    v_cndmask_b32_dpp v86, v86, v86, vcc wave_shr:1 row_mask:0xf bank_mask:0xf
    v_cndmask_b32_dpp v87, v87, v87, vcc wave_shr:1 row_mask:0xf bank_mask:0xf
    s_andn2_b64 s[82:83], s[82:83], s[52:53]
    v_cndmask_b32_dpp v7, v7, v7, vcc wave_shr:1 row_mask:0xf bank_mask:0xf
    s_mov_b64 exec, s[54:55]
    s_cbranch_scc0 L2_d66
    s_mov_b64 exec, s[82:83]
    s_nop 1
    v_mfma_f32_4x4x4_16b_bf16 v[88:91], v[12:13], v[84:85], 0
    s_nop 1
    v_mfma_f32_4x4x4_16b_bf16 v[88:91], v[10:11], v[86:87], v[88:91]
    s_nop 4
    v_cvt_pk_bf16_f32 v88, v88, v89
    v_cvt_pk_bf16_f32 v89, v90, v91
    ds_pk_add_bf16 v7, v88 offset:65408
    ds_pk_add_bf16 v7, v89 offset:65412
    s_mov_b64 exec, s[54:55]
    s_branch L2_d66
L2_c67:
    s_lshl_b64 s[52:53], s[82:83], 1
    s_andn2_b64 s[52:53], s[52:53], s[80:81]
    s_andn2_b64 s[52:53], s[52:53], s[50:51]
    s_or_b64 s[80:81], s[80:81], s[52:53]
    s_not_b64 vcc, s[52:53]
    s_mov_b64 exec, -1
    v_cndmask_b32_dpp v84, v84, v84, vcc wave_shr:1 row_mask:0xf bank_mask:0xf
    v_cndmask_b32_dpp v85, v85, v85, vcc wave_shr:1 row_mask:0xf bank_mask:0xf
    s_lshr_b64 s[52:53], s[52:53], 1
    v_cndmask_b32_dpp v86, v86, v86, vcc wave_shr:1 row_mask:0xf bank_mask:0xf
    v_cndmask_b32_dpp v87, v87, v87, vcc wave_shr:1 row_mask:0xf bank_mask:0xf
    s_andn2_b64 s[82:83], s[82:83], s[52:53]
    v_cndmask_b32_dpp v7, v7, v7, vcc wave_shr:1 row_mask:0xf bank_mask:0xf
    s_mov_b64 exec, s[50:51]
    s_cbranch_scc0 L2_d67
    s_mov_b64 exec, s[82:83]
    s_nop 1
    v_mfma_f32_4x4x4_16b_bf16 v[88:91], v[12:13], v[84:85], 0
    s_nop 1
    v_mfma_f32_4x4x4_16b_bf16 v[88:91], v[10:11], v[86:87], v[88:91]
    s_nop 4
    v_cvt_pk_bf16_f32 v88, v88, v89
    v_cvt_pk_bf16_f32 v89, v90, v91
    ds_pk_add_bf16 v7, v88 offset:65408
    ds_pk_add_bf16 v7, v89 offset:65412
    s_mov_b64 exec, s[50:51]
    s_branch L2_d67
L2_xo68:
    v_cmp_lt_u32 vcc, 20, v99
    s_mov_b32 s101, 1
    s_cbranch_vccz L2_xp68
    v_cmp_lt_u32 vcc, 32, v99
    v_cmp_lt_u32 s[58:59], 31, v88
    s_mov_b32 s101, 2
    s_or_b64 vcc, vcc, s[58:59]
    s_cbranch_scc0 L2_xp68
    s_mov_b32 s37, 0x10000
    s_branch L2_xp68
L2_c69:
    s_lshl_b64 s[52:53], s[82:83], 1
    s_andn2_b64 s[52:53], s[52:53], s[80:81]
    s_andn2_b64 s[52:53], s[52:53], s[54:55]
    s_or_b64 s[80:81], s[80:81], s[52:53]
    s_not_b64 vcc, s[52:53]
    s_mov_b64 exec, -1
    v_cndmask_b32_dpp v84, v84, v84, vcc wave_shr:1 row_mask:0xf bank_mask:0xf
    v_cndmask_b32_dpp v85, v85, v85, vcc wave_shr:1 row_mask:0xf bank_mask:0xf
    s_lshr_b64 s[52:53], s[52:53], 1
    v_cndmask_b32_dpp v86, v86, v86, vcc wave_shr:1 row_mask:0xf bank_mask:0xf
    v_cndmask_b32_dpp v87, v87, v87, vcc wave_shr:1 row_mask:0xf bank_mask:0xf
    s_andn2_b64 s[82:83], s[82:83], s[52:53]
    v_cndmask_b32_dpp v7, v7, v7, vcc wave_shr:1 row_mask:0xf bank_mask:0xf
    s_mov_b64 exec, s[54:55]
    s_cbranch_scc0 L2_d69
    s_mov_b64 exec, s[82:83]
    s_nop 1
    v_mfma_f32_4x4x4_16b_bf16 v[88:91], v[12:13], v[84:85], 0
    s_nop 1
    v_mfma_f32_4x4x4_16b_bf16 v[88:91], v[10:11], v[86:87], v[88:91]
    s_nop 4
    v_cvt_pk_bf16_f32 v88, v88, v89
    v_cvt_pk_bf16_f32 v89, v90, v91
    ds_pk_add_bf16 v7, v88 offset:65408
    ds_pk_add_bf16 v7, v89 offset:65412
    s_mov_b64 exec, s[54:55]
    s_branch L2_d69
L2_c70:
    s_lshl_b64 s[52:53], s[82:83], 1
    s_andn2_b64 s[52:53], s[52:53], s[80:81]
    s_andn2_b64 s[52:53], s[52:53], s[50:51]
    s_or_b64 s[80:81], s[80:81], s[52:53]
    s_not_b64 vcc, s[52:53]
    s_mov_b64 exec, -1
    v_cndmask_b32_dpp v84, v84, v84, vcc wave_shr:1 row_mask:0xf bank_mask:0xf
    v_cndmask_b32_dpp v85, v85, v85, vcc wave_shr:1 row_mask:0xf bank_mask:0xf
    s_lshr_b64 s[52:53], s[52:53], 1
    v_cndmask_b32_dpp v86, v86, v86, vcc wave_shr:1 row_mask:0xf bank_mask:0xf
    v_cndmask_b32_dpp v87, v87, v87, vcc wave_shr:1 row_mask:0xf bank_mask:0xf
    s_andn2_b64 s[82:83], s[82:83], s[52:53]
    v_cndmask_b32_dpp v7, v7, v7, vcc wave_shr:1 row_mask:0xf bank_mask:0xf
    s_mov_b64 exec, s[50:51]
    s_cbranch_scc0 L2_d70
    s_mov_b64 exec, s[82:83]
    s_nop 1
    v_mfma_f32_4x4x4_16b_bf16 v[88:91], v[12:13], v[84:85], 0
    s_nop 1
    v_mfma_f32_4x4x4_16b_bf16 v[88:91], v[10:11], v[86:87], v[88:91]
    s_nop 4
    v_cvt_pk_bf16_f32 v88, v88, v89
    v_cvt_pk_bf16_f32 v89, v90, v91
    ds_pk_add_bf16 v7, v88 offset:65408
    ds_pk_add_bf16 v7, v89 offset:65412
    s_mov_b64 exec, s[50:51]
    s_branch L2_d70
L2_c71:
    s_lshl_b64 s[52:53], s[82:83], 1
    s_andn2_b64 s[52:53], s[52:53], s[80:81]
    s_andn2_b64 s[52:53], s[52:53], s[54:55]
    s_or_b64 s[80:81], s[80:81], s[52:53]
    s_not_b64 vcc, s[52:53]
    s_mov_b64 exec, -1
    v_cndmask_b32_dpp v84, v84, v84, vcc wave_shr:1 row_mask:0xf bank_mask:0xf
    v_cndmask_b32_dpp v85, v85, v85, vcc wave_shr:1 row_mask:0xf bank_mask:0xf
    s_lshr_b64 s[52:53], s[52:53], 1
    v_cndmask_b32_dpp v86, v86, v86, vcc wave_shr:1 row_mask:0xf bank_mask:0xf
    v_cndmask_b32_dpp v87, v87, v87, vcc wave_shr:1 row_mask:0xf bank_mask:0xf
    s_andn2_b64 s[82:83], s[82:83], s[52:53]
    v_cndmask_b32_dpp v7, v7, v7, vcc wave_shr:1 row_mask:0xf bank_mask:0xf
    s_mov_b64 exec, s[54:55]
    s_cbranch_scc0 L2_d71
    s_mov_b64 exec, s[82:83]
    s_nop 1
    v_mfma_f32_4x4x4_16b_bf16 v[88:91], v[12:13], v[84:85], 0
    s_nop 1
    v_mfma_f32_4x4x4_16b_bf16 v[88:91], v[10:11], v[86:87], v[88:91]
    s_nop 4
    v_cvt_pk_bf16_f32 v88, v88, v89
    v_cvt_pk_bf16_f32 v89, v90, v91
    ds_pk_add_bf16 v7, v88 offset:65408
    ds_pk_add_bf16 v7, v89 offset:65412
    s_mov_b64 exec, s[54:55]
    s_branch L2_d71
L2_c72:
    s_lshl_b64 s[52:53], s[82:83], 1
    s_andn2_b64 s[52:53], s[52:53], s[80:81]
    s_andn2_b64 s[52:53], s[52:53], s[50:51]
    s_or_b64 s[80:81], s[80:81], s[52:53]
    s_not_b64 vcc, s[52:53]
    s_mov_b64 exec, -1
    v_cndmask_b32_dpp v84, v84, v84, vcc wave_shr:1 row_mask:0xf bank_mask:0xf
    v_cndmask_b32_dpp v85, v85, v85, vcc wave_shr:1 row_mask:0xf bank_mask:0xf
    s_lshr_b64 s[52:53], s[52:53], 1
    v_cndmask_b32_dpp v86, v86, v86, vcc wave_shr:1 row_mask:0xf bank_mask:0xf
    v_cndmask_b32_dpp v87, v87, v87, vcc wave_shr:1 row_mask:0xf bank_mask:0xf
    s_andn2_b64 s[82:83], s[82:83], s[52:53]
    v_cndmask_b32_dpp v7, v7, v7, vcc wave_shr:1 row_mask:0xf bank_mask:0xf
    s_mov_b64 exec, s[50:51]
    s_cbranch_scc0 L2_d72
    s_mov_b64 exec, s[82:83]
    s_nop 1
    v_mfma_f32_4x4x4_16b_bf16 v[88:91], v[12:13], v[84:85], 0
    s_nop 1
    v_mfma_f32_4x4x4_16b_bf16 v[88:91], v[10:11], v[86:87], v[88:91]
    s_nop 4
    v_cvt_pk_bf16_f32 v88, v88, v89
    v_cvt_pk_bf16_f32 v89, v90, v91
    ds_pk_add_bf16 v7, v88 offset:65408
    ds_pk_add_bf16 v7, v89 offset:65412
    s_mov_b64 exec, s[50:51]
    s_branch L2_d72
L2_c73:
    s_lshl_b64 s[52:53], s[82:83], 1
    s_andn2_b64 s[52:53], s[52:53], s[80:81]
    s_andn2_b64 s[52:53], s[52:53], s[54:55]
    s_or_b64 s[80:81], s[80:81], s[52:53]
    s_not_b64 vcc, s[52:53]
    s_mov_b64 exec, -1
    v_cndmask_b32_dpp v84, v84, v84, vcc wave_shr:1 row_mask:0xf bank_mask:0xf
    v_cndmask_b32_dpp v85, v85, v85, vcc wave_shr:1 row_mask:0xf bank_mask:0xf
    s_lshr_b64 s[52:53], s[52:53], 1
    v_cndmask_b32_dpp v86, v86, v86, vcc wave_shr:1 row_mask:0xf bank_mask:0xf
    v_cndmask_b32_dpp v87, v87, v87, vcc wave_shr:1 row_mask:0xf bank_mask:0xf
    s_andn2_b64 s[82:83], s[82:83], s[52:53]
    v_cndmask_b32_dpp v7, v7, v7, vcc wave_shr:1 row_mask:0xf bank_mask:0xf
    s_mov_b64 exec, s[54:55]
    s_cbranch_scc0 L2_d73
    s_mov_b64 exec, s[82:83]
    s_nop 1
    v_mfma_f32_4x4x4_16b_bf16 v[88:91], v[12:13], v[84:85], 0
    s_nop 1
    v_mfma_f32_4x4x4_16b_bf16 v[88:91], v[10:11], v[86:87], v[88:91]
    s_nop 4
    v_cvt_pk_bf16_f32 v88, v88, v89
    v_cvt_pk_bf16_f32 v89, v90, v91
    ds_pk_add_bf16 v7, v88 offset:65408
    ds_pk_add_bf16 v7, v89 offset:65412
    s_mov_b64 exec, s[54:55]
    s_branch L2_d73
L2_c74:
    s_lshl_b64 s[52:53], s[82:83], 1
    s_andn2_b64 s[52:53], s[52:53], s[80:81]
    s_andn2_b64 s[52:53], s[52:53], s[50:51]
    s_or_b64 s[80:81], s[80:81], s[52:53]
    s_not_b64 vcc, s[52:53]
    s_mov_b64 exec, -1
    v_cndmask_b32_dpp v84, v84, v84, vcc wave_shr:1 row_mask:0xf bank_mask:0xf
    v_cndmask_b32_dpp v85, v85, v85, vcc wave_shr:1 row_mask:0xf bank_mask:0xf
    s_lshr_b64 s[52:53], s[52:53], 1
    v_cndmask_b32_dpp v86, v86, v86, vcc wave_shr:1 row_mask:0xf bank_mask:0xf
    v_cndmask_b32_dpp v87, v87, v87, vcc wave_shr:1 row_mask:0xf bank_mask:0xf
    s_andn2_b64 s[82:83], s[82:83], s[52:53]
    v_cndmask_b32_dpp v7, v7, v7, vcc wave_shr:1 row_mask:0xf bank_mask:0xf
    s_mov_b64 exec, s[50:51]
    s_cbranch_scc0 L2_d74
    s_mov_b64 exec, s[82:83]
    s_nop 1
    v_mfma_f32_4x4x4_16b_bf16 v[88:91], v[12:13], v[84:85], 0
    s_nop 1
    v_mfma_f32_4x4x4_16b_bf16 v[88:91], v[10:11], v[86:87], v[88:91]
    s_nop 4
    v_cvt_pk_bf16_f32 v88, v88, v89
    v_cvt_pk_bf16_f32 v89, v90, v91
    ds_pk_add_bf16 v7, v88 offset:65408
    ds_pk_add_bf16 v7, v89 offset:65412
    s_mov_b64 exec, s[50:51]
    s_branch L2_d74
L2_c75:
    s_lshl_b64 s[52:53], s[82:83], 1
    s_andn2_b64 s[52:53], s[52:53], s[80:81]
    s_andn2_b64 s[52:53], s[52:53], s[54:55]
    s_or_b64 s[80:81], s[80:81], s[52:53]
    s_not_b64 vcc, s[52:53]
    s_mov_b64 exec, -1
    v_cndmask_b32_dpp v84, v84, v84, vcc wave_shr:1 row_mask:0xf bank_mask:0xf
    v_cndmask_b32_dpp v85, v85, v85, vcc wave_shr:1 row_mask:0xf bank_mask:0xf
    s_lshr_b64 s[52:53], s[52:53], 1
    v_cndmask_b32_dpp v86, v86, v86, vcc wave_shr:1 row_mask:0xf bank_mask:0xf
    v_cndmask_b32_dpp v87, v87, v87, vcc wave_shr:1 row_mask:0xf bank_mask:0xf
    s_andn2_b64 s[82:83], s[82:83], s[52:53]
    v_cndmask_b32_dpp v7, v7, v7, vcc wave_shr:1 row_mask:0xf bank_mask:0xf
    s_mov_b64 exec, s[54:55]
    s_cbranch_scc0 L2_d75
    s_mov_b64 exec, s[82:83]
    s_nop 1
    v_mfma_f32_4x4x4_16b_bf16 v[88:91], v[12:13], v[84:85], 0
    s_nop 1
    v_mfma_f32_4x4x4_16b_bf16 v[88:91], v[10:11], v[86:87], v[88:91]
    s_nop 4
    v_cvt_pk_bf16_f32 v88, v88, v89
    v_cvt_pk_bf16_f32 v89, v90, v91
    ds_pk_add_bf16 v7, v88 offset:65408
    ds_pk_add_bf16 v7, v89 offset:65412
    s_mov_b64 exec, s[54:55]
    s_branch L2_d75
L2_c76:
    s_lshl_b64 s[52:53], s[82:83], 1
    s_andn2_b64 s[52:53], s[52:53], s[80:81]
    s_andn2_b64 s[52:53], s[52:53], s[50:51]
    s_or_b64 s[80:81], s[80:81], s[52:53]
    s_not_b64 vcc, s[52:53]
    s_mov_b64 exec, -1
    v_cndmask_b32_dpp v84, v84, v84, vcc wave_shr:1 row_mask:0xf bank_mask:0xf
    v_cndmask_b32_dpp v85, v85, v85, vcc wave_shr:1 row_mask:0xf bank_mask:0xf
    s_lshr_b64 s[52:53], s[52:53], 1
    v_cndmask_b32_dpp v86, v86, v86, vcc wave_shr:1 row_mask:0xf bank_mask:0xf
    v_cndmask_b32_dpp v87, v87, v87, vcc wave_shr:1 row_mask:0xf bank_mask:0xf
    s_andn2_b64 s[82:83], s[82:83], s[52:53]
    v_cndmask_b32_dpp v7, v7, v7, vcc wave_shr:1 row_mask:0xf bank_mask:0xf
    s_mov_b64 exec, s[50:51]
    s_cbranch_scc0 L2_d76
    s_mov_b64 exec, s[82:83]
    s_nop 1
    v_mfma_f32_4x4x4_16b_bf16 v[88:91], v[12:13], v[84:85], 0
    s_nop 1
    v_mfma_f32_4x4x4_16b_bf16 v[88:91], v[10:11], v[86:87], v[88:91]
    s_nop 4
    v_cvt_pk_bf16_f32 v88, v88, v89
    v_cvt_pk_bf16_f32 v89, v90, v91
    ds_pk_add_bf16 v7, v88 offset:65408
    ds_pk_add_bf16 v7, v89 offset:65412
    s_mov_b64 exec, s[50:51]
    s_branch L2_d76
L2_c77:
    s_lshl_b64 s[52:53], s[82:83], 1
    s_andn2_b64 s[52:53], s[52:53], s[80:81]
    s_andn2_b64 s[52:53], s[52:53], s[54:55]
    s_or_b64 s[80:81], s[80:81], s[52:53]
    s_not_b64 vcc, s[52:53]
    s_mov_b64 exec, -1
    v_cndmask_b32_dpp v84, v84, v84, vcc wave_shr:1 row_mask:0xf bank_mask:0xf
    v_cndmask_b32_dpp v85, v85, v85, vcc wave_shr:1 row_mask:0xf bank_mask:0xf
    s_lshr_b64 s[52:53], s[52:53], 1
    v_cndmask_b32_dpp v86, v86, v86, vcc wave_shr:1 row_mask:0xf bank_mask:0xf
    v_cndmask_b32_dpp v87, v87, v87, vcc wave_shr:1 row_mask:0xf bank_mask:0xf
    s_andn2_b64 s[82:83], s[82:83], s[52:53]
    v_cndmask_b32_dpp v7, v7, v7, vcc wave_shr:1 row_mask:0xf bank_mask:0xf
    s_mov_b64 exec, s[54:55]
    s_cbranch_scc0 L2_d77
    s_mov_b64 exec, s[82:83]
    s_nop 1
    v_mfma_f32_4x4x4_16b_bf16 v[88:91], v[12:13], v[84:85], 0
    s_nop 1
    v_mfma_f32_4x4x4_16b_bf16 v[88:91], v[10:11], v[86:87], v[88:91]
    s_nop 4
    v_cvt_pk_bf16_f32 v88, v88, v89
    v_cvt_pk_bf16_f32 v89, v90, v91
    ds_pk_add_bf16 v7, v88 offset:65408
    ds_pk_add_bf16 v7, v89 offset:65412
    s_mov_b64 exec, s[54:55]
    s_branch L2_d77
L2_c78:
    s_lshl_b64 s[52:53], s[82:83], 1
    s_andn2_b64 s[52:53], s[52:53], s[80:81]
    s_andn2_b64 s[52:53], s[52:53], s[50:51]
    s_or_b64 s[80:81], s[80:81], s[52:53]
    s_not_b64 vcc, s[52:53]
    s_mov_b64 exec, -1
    v_cndmask_b32_dpp v84, v84, v84, vcc wave_shr:1 row_mask:0xf bank_mask:0xf
    v_cndmask_b32_dpp v85, v85, v85, vcc wave_shr:1 row_mask:0xf bank_mask:0xf
    s_lshr_b64 s[52:53], s[52:53], 1
    v_cndmask_b32_dpp v86, v86, v86, vcc wave_shr:1 row_mask:0xf bank_mask:0xf
    v_cndmask_b32_dpp v87, v87, v87, vcc wave_shr:1 row_mask:0xf bank_mask:0xf
    s_andn2_b64 s[82:83], s[82:83], s[52:53]
    v_cndmask_b32_dpp v7, v7, v7, vcc wave_shr:1 row_mask:0xf bank_mask:0xf
    s_mov_b64 exec, s[50:51]
    s_cbranch_scc0 L2_d78
    s_mov_b64 exec, s[82:83]
    s_nop 1
    v_mfma_f32_4x4x4_16b_bf16 v[88:91], v[12:13], v[84:85], 0
    s_nop 1
    v_mfma_f32_4x4x4_16b_bf16 v[88:91], v[10:11], v[86:87], v[88:91]
    s_nop 4
    v_cvt_pk_bf16_f32 v88, v88, v89
    v_cvt_pk_bf16_f32 v89, v90, v91
    ds_pk_add_bf16 v7, v88 offset:65408
    ds_pk_add_bf16 v7, v89 offset:65412
    s_mov_b64 exec, s[50:51]
    s_branch L2_d78
L2_xa79:
    s_cmp_eq_u32 s101, 1
    s_cbranch_scc1 L2_xc79
    v_lshlrev_b32 v89, 0, v96
    v_add_u32 v90, 140, v97
    v_bitop3_b32 v90, v89, v45, v90 bitop3:0x6a
    ds_write_b32 v98, v90 offset:28
    v_lshlrev_b32 v89, 4, v96
    v_add_u32 v90, 120, v97
    v_bitop3_b32 v90, v89, v45, v90 bitop3:0x6a
    ds_write_b32 v98, v90 offset:24
    v_lshlrev_b32 v89, 8, v96
    v_add_u32 v90, 100, v97
    v_bitop3_b32 v90, v89, v45, v90 bitop3:0x6a
    ds_write_b32 v98, v90 offset:20
L2_xc79:
    v_lshlrev_b32 v89, 12, v96
    v_add_u32 v90, 80, v97
    v_bitop3_b32 v90, v89, v45, v90 bitop3:0x6a
    ds_write_b32 v98, v90 offset:16
    s_branch L2_xb79
L2_xe79:
    v_cmp_lt_u32 vcc, 32, v99
    v_cmp_lt_u32 s[58:59], 31, v88
    v_lshrrev_b32 v89, 16, v96
    v_add_u32 v97, 80, v97
    s_or_b64 vcc, vcc, s[58:59]
    s_cbranch_scc1 L2_xs79
    v_lshlrev_b32 v89, v1, v89
    v_and_b32 v89, v45, v89
    v_cmp_ne_u32 vcc, 0, v89
    v_xor_b32 v90, v97, v89
    s_add_u32 s3, s37, s38
    v_mbcnt_lo_u32_b32 v98, vcc_lo, 0
    v_mbcnt_hi_u32_b32 v98, vcc_hi, v98
    s_bcnt1_i32_b64 s41, vcc
    v_lshl_add_u32 v98, v98, 2, s3
    s_mov_b64 exec, vcc
    ds_write_b32 v98, v90
    s_mov_b64 exec, -1
    s_lshl2_add_u32 s37, s41, s37
    s_branch L2_xr79
L2_xf79:
    s_waitcnt lgkmcnt(0)
    s_cmp_gt_u32 s37, 1024
    s_cbranch_scc1 L2_xs79
    v_mov_b32 v43, -1
    s_cmp_ge_u32 s37, 512
    s_cbranch_scc1 L2_xg79
    v_mov_b32 v42, -1
    s_cmp_ge_u32 s37, 256
    s_cbranch_scc1 L2_xg79
    v_mov_b32 v41, -1
    s_branch L2_xg79
L2_xs79:
    s_waitcnt lgkmcnt(0)
    v_mov_b32 v40, -1
    v_mov_b32 v41, -1
    v_mov_b32 v42, -1
    v_mov_b32 v43, -1
    s_add_u32 s3, s42, 2
    s_bitset1_b32 s36, s3
    s_branch L2_xg79
L2_c80:
    s_lshl_b64 s[52:53], s[82:83], 1
    s_andn2_b64 s[52:53], s[52:53], s[80:81]
    s_andn2_b64 s[52:53], s[52:53], s[54:55]
    s_or_b64 s[80:81], s[80:81], s[52:53]
    s_not_b64 vcc, s[52:53]
    s_mov_b64 exec, -1
    v_cndmask_b32_dpp v84, v84, v84, vcc wave_shr:1 row_mask:0xf bank_mask:0xf
    v_cndmask_b32_dpp v85, v85, v85, vcc wave_shr:1 row_mask:0xf bank_mask:0xf
    s_lshr_b64 s[52:53], s[52:53], 1
    v_cndmask_b32_dpp v86, v86, v86, vcc wave_shr:1 row_mask:0xf bank_mask:0xf
    v_cndmask_b32_dpp v87, v87, v87, vcc wave_shr:1 row_mask:0xf bank_mask:0xf
    s_andn2_b64 s[82:83], s[82:83], s[52:53]
    v_cndmask_b32_dpp v7, v7, v7, vcc wave_shr:1 row_mask:0xf bank_mask:0xf
    s_mov_b64 exec, s[54:55]
    s_cbranch_scc0 L2_d80
    s_mov_b64 exec, s[82:83]
    s_nop 1
    v_mfma_f32_4x4x4_16b_bf16 v[88:91], v[12:13], v[84:85], 0
    s_nop 1
    v_mfma_f32_4x4x4_16b_bf16 v[88:91], v[10:11], v[86:87], v[88:91]
    s_nop 4
    v_cvt_pk_bf16_f32 v88, v88, v89
    v_cvt_pk_bf16_f32 v89, v90, v91
    ds_pk_add_bf16 v7, v88 offset:65408
    ds_pk_add_bf16 v7, v89 offset:65412
    s_mov_b64 exec, s[54:55]
    s_branch L2_d80
L2_c81:
    s_lshl_b64 s[52:53], s[82:83], 1
    s_andn2_b64 s[52:53], s[52:53], s[80:81]
    s_andn2_b64 s[52:53], s[52:53], s[50:51]
    s_or_b64 s[80:81], s[80:81], s[52:53]
    s_not_b64 vcc, s[52:53]
    s_mov_b64 exec, -1
    v_cndmask_b32_dpp v84, v84, v84, vcc wave_shr:1 row_mask:0xf bank_mask:0xf
    v_cndmask_b32_dpp v85, v85, v85, vcc wave_shr:1 row_mask:0xf bank_mask:0xf
    s_lshr_b64 s[52:53], s[52:53], 1
    v_cndmask_b32_dpp v86, v86, v86, vcc wave_shr:1 row_mask:0xf bank_mask:0xf
    v_cndmask_b32_dpp v87, v87, v87, vcc wave_shr:1 row_mask:0xf bank_mask:0xf
    s_andn2_b64 s[82:83], s[82:83], s[52:53]
    v_cndmask_b32_dpp v7, v7, v7, vcc wave_shr:1 row_mask:0xf bank_mask:0xf
    s_mov_b64 exec, s[50:51]
    s_cbranch_scc0 L2_d81
    s_mov_b64 exec, s[82:83]
    s_nop 1
    v_mfma_f32_4x4x4_16b_bf16 v[88:91], v[12:13], v[84:85], 0
    s_nop 1
    v_mfma_f32_4x4x4_16b_bf16 v[88:91], v[10:11], v[86:87], v[88:91]
    s_nop 4
    v_cvt_pk_bf16_f32 v88, v88, v89
    v_cvt_pk_bf16_f32 v89, v90, v91
    ds_pk_add_bf16 v7, v88 offset:65408
    ds_pk_add_bf16 v7, v89 offset:65412
    s_mov_b64 exec, s[50:51]
    s_branch L2_d81
L2_c82:
    s_lshl_b64 s[52:53], s[82:83], 1
    s_andn2_b64 s[52:53], s[52:53], s[80:81]
    s_andn2_b64 s[52:53], s[52:53], s[54:55]
    s_or_b64 s[80:81], s[80:81], s[52:53]
    s_not_b64 vcc, s[52:53]
    s_mov_b64 exec, -1
    v_cndmask_b32_dpp v84, v84, v84, vcc wave_shr:1 row_mask:0xf bank_mask:0xf
    v_cndmask_b32_dpp v85, v85, v85, vcc wave_shr:1 row_mask:0xf bank_mask:0xf
    s_lshr_b64 s[52:53], s[52:53], 1
    v_cndmask_b32_dpp v86, v86, v86, vcc wave_shr:1 row_mask:0xf bank_mask:0xf
    v_cndmask_b32_dpp v87, v87, v87, vcc wave_shr:1 row_mask:0xf bank_mask:0xf
    s_andn2_b64 s[82:83], s[82:83], s[52:53]
    v_cndmask_b32_dpp v7, v7, v7, vcc wave_shr:1 row_mask:0xf bank_mask:0xf
    s_mov_b64 exec, s[54:55]
    s_cbranch_scc0 L2_d82
    s_mov_b64 exec, s[82:83]
    s_nop 1
    v_mfma_f32_4x4x4_16b_bf16 v[88:91], v[12:13], v[84:85], 0
    s_nop 1
    v_mfma_f32_4x4x4_16b_bf16 v[88:91], v[10:11], v[86:87], v[88:91]
    s_nop 4
    v_cvt_pk_bf16_f32 v88, v88, v89
    v_cvt_pk_bf16_f32 v89, v90, v91
    ds_pk_add_bf16 v7, v88 offset:65408
    ds_pk_add_bf16 v7, v89 offset:65412
    s_mov_b64 exec, s[54:55]
    s_branch L2_d82
L2_c83:
    s_lshl_b64 s[52:53], s[82:83], 1
    s_andn2_b64 s[52:53], s[52:53], s[80:81]
    s_andn2_b64 s[52:53], s[52:53], s[50:51]
    s_or_b64 s[80:81], s[80:81], s[52:53]
    s_not_b64 vcc, s[52:53]
    s_mov_b64 exec, -1
    v_cndmask_b32_dpp v84, v84, v84, vcc wave_shr:1 row_mask:0xf bank_mask:0xf
    v_cndmask_b32_dpp v85, v85, v85, vcc wave_shr:1 row_mask:0xf bank_mask:0xf
    s_lshr_b64 s[52:53], s[52:53], 1
    v_cndmask_b32_dpp v86, v86, v86, vcc wave_shr:1 row_mask:0xf bank_mask:0xf
    v_cndmask_b32_dpp v87, v87, v87, vcc wave_shr:1 row_mask:0xf bank_mask:0xf
    s_andn2_b64 s[82:83], s[82:83], s[52:53]
    v_cndmask_b32_dpp v7, v7, v7, vcc wave_shr:1 row_mask:0xf bank_mask:0xf
    s_mov_b64 exec, s[50:51]
    s_cbranch_scc0 L2_d83
    s_mov_b64 exec, s[82:83]
    s_nop 1
    v_mfma_f32_4x4x4_16b_bf16 v[88:91], v[12:13], v[84:85], 0
    s_nop 1
    v_mfma_f32_4x4x4_16b_bf16 v[88:91], v[10:11], v[86:87], v[88:91]
    s_nop 4
    v_cvt_pk_bf16_f32 v88, v88, v89
    v_cvt_pk_bf16_f32 v89, v90, v91
    ds_pk_add_bf16 v7, v88 offset:65408
    ds_pk_add_bf16 v7, v89 offset:65412
    s_mov_b64 exec, s[50:51]
    s_branch L2_d83
L2_c84:
    s_lshl_b64 s[52:53], s[82:83], 1
    s_andn2_b64 s[52:53], s[52:53], s[80:81]
    s_andn2_b64 s[52:53], s[52:53], s[54:55]
    s_or_b64 s[80:81], s[80:81], s[52:53]
    s_not_b64 vcc, s[52:53]
    s_mov_b64 exec, -1
    v_cndmask_b32_dpp v84, v84, v84, vcc wave_shr:1 row_mask:0xf bank_mask:0xf
    v_cndmask_b32_dpp v85, v85, v85, vcc wave_shr:1 row_mask:0xf bank_mask:0xf
    s_lshr_b64 s[52:53], s[52:53], 1
    v_cndmask_b32_dpp v86, v86, v86, vcc wave_shr:1 row_mask:0xf bank_mask:0xf
    v_cndmask_b32_dpp v87, v87, v87, vcc wave_shr:1 row_mask:0xf bank_mask:0xf
    s_andn2_b64 s[82:83], s[82:83], s[52:53]
    v_cndmask_b32_dpp v7, v7, v7, vcc wave_shr:1 row_mask:0xf bank_mask:0xf
    s_mov_b64 exec, s[54:55]
    s_cbranch_scc0 L2_d84
    s_mov_b64 exec, s[82:83]
    s_nop 1
    v_mfma_f32_4x4x4_16b_bf16 v[88:91], v[12:13], v[84:85], 0
    s_nop 1
    v_mfma_f32_4x4x4_16b_bf16 v[88:91], v[10:11], v[86:87], v[88:91]
    s_nop 4
    v_cvt_pk_bf16_f32 v88, v88, v89
    v_cvt_pk_bf16_f32 v89, v90, v91
    ds_pk_add_bf16 v7, v88 offset:65408
    ds_pk_add_bf16 v7, v89 offset:65412
    s_mov_b64 exec, s[54:55]
    s_branch L2_d84
L2_c85:
    s_lshl_b64 s[52:53], s[82:83], 1
    s_andn2_b64 s[52:53], s[52:53], s[80:81]
    s_andn2_b64 s[52:53], s[52:53], s[50:51]
    s_or_b64 s[80:81], s[80:81], s[52:53]
    s_not_b64 vcc, s[52:53]
    s_mov_b64 exec, -1
    v_cndmask_b32_dpp v84, v84, v84, vcc wave_shr:1 row_mask:0xf bank_mask:0xf
    v_cndmask_b32_dpp v85, v85, v85, vcc wave_shr:1 row_mask:0xf bank_mask:0xf
    s_lshr_b64 s[52:53], s[52:53], 1
    v_cndmask_b32_dpp v86, v86, v86, vcc wave_shr:1 row_mask:0xf bank_mask:0xf
    v_cndmask_b32_dpp v87, v87, v87, vcc wave_shr:1 row_mask:0xf bank_mask:0xf
    s_andn2_b64 s[82:83], s[82:83], s[52:53]
    v_cndmask_b32_dpp v7, v7, v7, vcc wave_shr:1 row_mask:0xf bank_mask:0xf
    s_mov_b64 exec, s[50:51]
    s_cbranch_scc0 L2_d85
    s_mov_b64 exec, s[82:83]
    s_nop 1
    v_mfma_f32_4x4x4_16b_bf16 v[88:91], v[12:13], v[84:85], 0
    s_nop 1
    v_mfma_f32_4x4x4_16b_bf16 v[88:91], v[10:11], v[86:87], v[88:91]
    s_nop 4
    v_cvt_pk_bf16_f32 v88, v88, v89
    v_cvt_pk_bf16_f32 v89, v90, v91
    ds_pk_add_bf16 v7, v88 offset:65408
    ds_pk_add_bf16 v7, v89 offset:65412
    s_mov_b64 exec, s[50:51]
    s_branch L2_d85
L2_xo86:
    v_cmp_lt_u32 vcc, 20, v99
    s_mov_b32 s101, 1
    s_cbranch_vccz L2_xp86
    v_cmp_lt_u32 vcc, 32, v99
    v_cmp_lt_u32 s[58:59], 31, v88
    s_mov_b32 s101, 2
    s_or_b64 vcc, vcc, s[58:59]
    s_cbranch_scc0 L2_xp86
    s_mov_b32 s37, 0x10000
    s_branch L2_xp86
L2_c87:
    s_lshl_b64 s[52:53], s[82:83], 1
    s_andn2_b64 s[52:53], s[52:53], s[80:81]
    s_andn2_b64 s[52:53], s[52:53], s[54:55]
    s_or_b64 s[80:81], s[80:81], s[52:53]
    s_not_b64 vcc, s[52:53]
    s_mov_b64 exec, -1
    v_cndmask_b32_dpp v84, v84, v84, vcc wave_shr:1 row_mask:0xf bank_mask:0xf
    v_cndmask_b32_dpp v85, v85, v85, vcc wave_shr:1 row_mask:0xf bank_mask:0xf
    s_lshr_b64 s[52:53], s[52:53], 1
    v_cndmask_b32_dpp v86, v86, v86, vcc wave_shr:1 row_mask:0xf bank_mask:0xf
    v_cndmask_b32_dpp v87, v87, v87, vcc wave_shr:1 row_mask:0xf bank_mask:0xf
    s_andn2_b64 s[82:83], s[82:83], s[52:53]
    v_cndmask_b32_dpp v7, v7, v7, vcc wave_shr:1 row_mask:0xf bank_mask:0xf
    s_mov_b64 exec, s[54:55]
    s_cbranch_scc0 L2_d87
    s_mov_b64 exec, s[82:83]
    s_nop 1
    v_mfma_f32_4x4x4_16b_bf16 v[88:91], v[12:13], v[84:85], 0
    s_nop 1
    v_mfma_f32_4x4x4_16b_bf16 v[88:91], v[10:11], v[86:87], v[88:91]
    s_nop 4
    v_cvt_pk_bf16_f32 v88, v88, v89
    v_cvt_pk_bf16_f32 v89, v90, v91
    ds_pk_add_bf16 v7, v88 offset:65408
    ds_pk_add_bf16 v7, v89 offset:65412
    s_mov_b64 exec, s[54:55]
    s_branch L2_d87
L2_c88:
    s_lshl_b64 s[52:53], s[82:83], 1
    s_andn2_b64 s[52:53], s[52:53], s[80:81]
    s_andn2_b64 s[52:53], s[52:53], s[50:51]
    s_or_b64 s[80:81], s[80:81], s[52:53]
    s_not_b64 vcc, s[52:53]
    s_mov_b64 exec, -1
    v_cndmask_b32_dpp v84, v84, v84, vcc wave_shr:1 row_mask:0xf bank_mask:0xf
    v_cndmask_b32_dpp v85, v85, v85, vcc wave_shr:1 row_mask:0xf bank_mask:0xf
    s_lshr_b64 s[52:53], s[52:53], 1
    v_cndmask_b32_dpp v86, v86, v86, vcc wave_shr:1 row_mask:0xf bank_mask:0xf
    v_cndmask_b32_dpp v87, v87, v87, vcc wave_shr:1 row_mask:0xf bank_mask:0xf
    s_andn2_b64 s[82:83], s[82:83], s[52:53]
    v_cndmask_b32_dpp v7, v7, v7, vcc wave_shr:1 row_mask:0xf bank_mask:0xf
    s_mov_b64 exec, s[50:51]
    s_cbranch_scc0 L2_d88
    s_mov_b64 exec, s[82:83]
    s_nop 1
    v_mfma_f32_4x4x4_16b_bf16 v[88:91], v[12:13], v[84:85], 0
    s_nop 1
    v_mfma_f32_4x4x4_16b_bf16 v[88:91], v[10:11], v[86:87], v[88:91]
    s_nop 4
    v_cvt_pk_bf16_f32 v88, v88, v89
    v_cvt_pk_bf16_f32 v89, v90, v91
    ds_pk_add_bf16 v7, v88 offset:65408
    ds_pk_add_bf16 v7, v89 offset:65412
    s_mov_b64 exec, s[50:51]
    s_branch L2_d88
L2_c89:
    s_lshl_b64 s[52:53], s[82:83], 1
    s_andn2_b64 s[52:53], s[52:53], s[80:81]
    s_andn2_b64 s[52:53], s[52:53], s[54:55]
    s_or_b64 s[80:81], s[80:81], s[52:53]
    s_not_b64 vcc, s[52:53]
    s_mov_b64 exec, -1
    v_cndmask_b32_dpp v84, v84, v84, vcc wave_shr:1 row_mask:0xf bank_mask:0xf
    v_cndmask_b32_dpp v85, v85, v85, vcc wave_shr:1 row_mask:0xf bank_mask:0xf
    s_lshr_b64 s[52:53], s[52:53], 1
    v_cndmask_b32_dpp v86, v86, v86, vcc wave_shr:1 row_mask:0xf bank_mask:0xf
    v_cndmask_b32_dpp v87, v87, v87, vcc wave_shr:1 row_mask:0xf bank_mask:0xf
    s_andn2_b64 s[82:83], s[82:83], s[52:53]
    v_cndmask_b32_dpp v7, v7, v7, vcc wave_shr:1 row_mask:0xf bank_mask:0xf
    s_mov_b64 exec, s[54:55]
    s_cbranch_scc0 L2_d89
    s_mov_b64 exec, s[82:83]
    s_nop 1
    v_mfma_f32_4x4x4_16b_bf16 v[88:91], v[12:13], v[84:85], 0
    s_nop 1
    v_mfma_f32_4x4x4_16b_bf16 v[88:91], v[10:11], v[86:87], v[88:91]
    s_nop 4
    v_cvt_pk_bf16_f32 v88, v88, v89
    v_cvt_pk_bf16_f32 v89, v90, v91
    ds_pk_add_bf16 v7, v88 offset:65408
    ds_pk_add_bf16 v7, v89 offset:65412
    s_mov_b64 exec, s[54:55]
    s_branch L2_d89
L2_c90:
    s_lshl_b64 s[52:53], s[82:83], 1
    s_andn2_b64 s[52:53], s[52:53], s[80:81]
    s_andn2_b64 s[52:53], s[52:53], s[50:51]
    s_or_b64 s[80:81], s[80:81], s[52:53]
    s_not_b64 vcc, s[52:53]
    s_mov_b64 exec, -1
    v_cndmask_b32_dpp v84, v84, v84, vcc wave_shr:1 row_mask:0xf bank_mask:0xf
    v_cndmask_b32_dpp v85, v85, v85, vcc wave_shr:1 row_mask:0xf bank_mask:0xf
    s_lshr_b64 s[52:53], s[52:53], 1
    v_cndmask_b32_dpp v86, v86, v86, vcc wave_shr:1 row_mask:0xf bank_mask:0xf
    v_cndmask_b32_dpp v87, v87, v87, vcc wave_shr:1 row_mask:0xf bank_mask:0xf
    s_andn2_b64 s[82:83], s[82:83], s[52:53]
    v_cndmask_b32_dpp v7, v7, v7, vcc wave_shr:1 row_mask:0xf bank_mask:0xf
    s_mov_b64 exec, s[50:51]
    s_cbranch_scc0 L2_d90
    s_mov_b64 exec, s[82:83]
    s_nop 1
    v_mfma_f32_4x4x4_16b_bf16 v[88:91], v[12:13], v[84:85], 0
    s_nop 1
    v_mfma_f32_4x4x4_16b_bf16 v[88:91], v[10:11], v[86:87], v[88:91]
    s_nop 4
    v_cvt_pk_bf16_f32 v88, v88, v89
    v_cvt_pk_bf16_f32 v89, v90, v91
    ds_pk_add_bf16 v7, v88 offset:65408
    ds_pk_add_bf16 v7, v89 offset:65412
    s_mov_b64 exec, s[50:51]
    s_branch L2_d90
L2_c91:
    s_lshl_b64 s[52:53], s[82:83], 1
    s_andn2_b64 s[52:53], s[52:53], s[80:81]
    s_andn2_b64 s[52:53], s[52:53], s[54:55]
    s_or_b64 s[80:81], s[80:81], s[52:53]
    s_not_b64 vcc, s[52:53]
    s_mov_b64 exec, -1
    v_cndmask_b32_dpp v84, v84, v84, vcc wave_shr:1 row_mask:0xf bank_mask:0xf
    v_cndmask_b32_dpp v85, v85, v85, vcc wave_shr:1 row_mask:0xf bank_mask:0xf
    s_lshr_b64 s[52:53], s[52:53], 1
    v_cndmask_b32_dpp v86, v86, v86, vcc wave_shr:1 row_mask:0xf bank_mask:0xf
    v_cndmask_b32_dpp v87, v87, v87, vcc wave_shr:1 row_mask:0xf bank_mask:0xf
    s_andn2_b64 s[82:83], s[82:83], s[52:53]
    v_cndmask_b32_dpp v7, v7, v7, vcc wave_shr:1 row_mask:0xf bank_mask:0xf
    s_mov_b64 exec, s[54:55]
    s_cbranch_scc0 L2_d91
    s_mov_b64 exec, s[82:83]
    s_nop 1
    v_mfma_f32_4x4x4_16b_bf16 v[88:91], v[12:13], v[84:85], 0
    s_nop 1
    v_mfma_f32_4x4x4_16b_bf16 v[88:91], v[10:11], v[86:87], v[88:91]
    s_nop 4
    v_cvt_pk_bf16_f32 v88, v88, v89
    v_cvt_pk_bf16_f32 v89, v90, v91
    ds_pk_add_bf16 v7, v88 offset:65408
    ds_pk_add_bf16 v7, v89 offset:65412
    s_mov_b64 exec, s[54:55]
    s_branch L2_d91
L2_c92:
    s_lshl_b64 s[52:53], s[82:83], 1
    s_andn2_b64 s[52:53], s[52:53], s[80:81]
    s_andn2_b64 s[52:53], s[52:53], s[50:51]
    s_or_b64 s[80:81], s[80:81], s[52:53]
    s_not_b64 vcc, s[52:53]
    s_mov_b64 exec, -1
    v_cndmask_b32_dpp v84, v84, v84, vcc wave_shr:1 row_mask:0xf bank_mask:0xf
    v_cndmask_b32_dpp v85, v85, v85, vcc wave_shr:1 row_mask:0xf bank_mask:0xf
    s_lshr_b64 s[52:53], s[52:53], 1
    v_cndmask_b32_dpp v86, v86, v86, vcc wave_shr:1 row_mask:0xf bank_mask:0xf
    v_cndmask_b32_dpp v87, v87, v87, vcc wave_shr:1 row_mask:0xf bank_mask:0xf
    s_andn2_b64 s[82:83], s[82:83], s[52:53]
    v_cndmask_b32_dpp v7, v7, v7, vcc wave_shr:1 row_mask:0xf bank_mask:0xf
    s_mov_b64 exec, s[50:51]
    s_cbranch_scc0 L2_d92
    s_mov_b64 exec, s[82:83]
    s_nop 1
    v_mfma_f32_4x4x4_16b_bf16 v[88:91], v[12:13], v[84:85], 0
    s_nop 1
    v_mfma_f32_4x4x4_16b_bf16 v[88:91], v[10:11], v[86:87], v[88:91]
    s_nop 4
    v_cvt_pk_bf16_f32 v88, v88, v89
    v_cvt_pk_bf16_f32 v89, v90, v91
    ds_pk_add_bf16 v7, v88 offset:65408
    ds_pk_add_bf16 v7, v89 offset:65412
    s_mov_b64 exec, s[50:51]
    s_branch L2_d92
L2_c93:
    s_lshl_b64 s[52:53], s[82:83], 1
    s_andn2_b64 s[52:53], s[52:53], s[80:81]
    s_andn2_b64 s[52:53], s[52:53], s[54:55]
    s_or_b64 s[80:81], s[80:81], s[52:53]
    s_not_b64 vcc, s[52:53]
    s_mov_b64 exec, -1
    v_cndmask_b32_dpp v84, v84, v84, vcc wave_shr:1 row_mask:0xf bank_mask:0xf
    v_cndmask_b32_dpp v85, v85, v85, vcc wave_shr:1 row_mask:0xf bank_mask:0xf
    s_lshr_b64 s[52:53], s[52:53], 1
    v_cndmask_b32_dpp v86, v86, v86, vcc wave_shr:1 row_mask:0xf bank_mask:0xf
    v_cndmask_b32_dpp v87, v87, v87, vcc wave_shr:1 row_mask:0xf bank_mask:0xf
    s_andn2_b64 s[82:83], s[82:83], s[52:53]
    v_cndmask_b32_dpp v7, v7, v7, vcc wave_shr:1 row_mask:0xf bank_mask:0xf
    s_mov_b64 exec, s[54:55]
    s_cbranch_scc0 L2_d93
    s_mov_b64 exec, s[82:83]
    s_nop 1
    v_mfma_f32_4x4x4_16b_bf16 v[88:91], v[12:13], v[84:85], 0
    s_nop 1
    v_mfma_f32_4x4x4_16b_bf16 v[88:91], v[10:11], v[86:87], v[88:91]
    s_nop 4
    v_cvt_pk_bf16_f32 v88, v88, v89
    v_cvt_pk_bf16_f32 v89, v90, v91
    ds_pk_add_bf16 v7, v88 offset:65408
    ds_pk_add_bf16 v7, v89 offset:65412
    s_mov_b64 exec, s[54:55]
    s_branch L2_d93
L2_c94:
    s_lshl_b64 s[52:53], s[82:83], 1
    s_andn2_b64 s[52:53], s[52:53], s[80:81]
    s_andn2_b64 s[52:53], s[52:53], s[50:51]
    s_or_b64 s[80:81], s[80:81], s[52:53]
    s_not_b64 vcc, s[52:53]
    s_mov_b64 exec, -1
    v_cndmask_b32_dpp v84, v84, v84, vcc wave_shr:1 row_mask:0xf bank_mask:0xf
    v_cndmask_b32_dpp v85, v85, v85, vcc wave_shr:1 row_mask:0xf bank_mask:0xf
    s_lshr_b64 s[52:53], s[52:53], 1
    v_cndmask_b32_dpp v86, v86, v86, vcc wave_shr:1 row_mask:0xf bank_mask:0xf
    v_cndmask_b32_dpp v87, v87, v87, vcc wave_shr:1 row_mask:0xf bank_mask:0xf
    s_andn2_b64 s[82:83], s[82:83], s[52:53]
    v_cndmask_b32_dpp v7, v7, v7, vcc wave_shr:1 row_mask:0xf bank_mask:0xf
    s_mov_b64 exec, s[50:51]
    s_cbranch_scc0 L2_d94
    s_mov_b64 exec, s[82:83]
    s_nop 1
    v_mfma_f32_4x4x4_16b_bf16 v[88:91], v[12:13], v[84:85], 0
    s_nop 1
    v_mfma_f32_4x4x4_16b_bf16 v[88:91], v[10:11], v[86:87], v[88:91]
    s_nop 4
    v_cvt_pk_bf16_f32 v88, v88, v89
    v_cvt_pk_bf16_f32 v89, v90, v91
    ds_pk_add_bf16 v7, v88 offset:65408
    ds_pk_add_bf16 v7, v89 offset:65412
    s_mov_b64 exec, s[50:51]
    s_branch L2_d94
L2_c95:
    s_lshl_b64 s[52:53], s[82:83], 1
    s_andn2_b64 s[52:53], s[52:53], s[80:81]
    s_andn2_b64 s[52:53], s[52:53], s[54:55]
    s_or_b64 s[80:81], s[80:81], s[52:53]
    s_not_b64 vcc, s[52:53]
    s_mov_b64 exec, -1
    v_cndmask_b32_dpp v84, v84, v84, vcc wave_shr:1 row_mask:0xf bank_mask:0xf
    v_cndmask_b32_dpp v85, v85, v85, vcc wave_shr:1 row_mask:0xf bank_mask:0xf
    s_lshr_b64 s[52:53], s[52:53], 1
    v_cndmask_b32_dpp v86, v86, v86, vcc wave_shr:1 row_mask:0xf bank_mask:0xf
    v_cndmask_b32_dpp v87, v87, v87, vcc wave_shr:1 row_mask:0xf bank_mask:0xf
    s_andn2_b64 s[82:83], s[82:83], s[52:53]
    v_cndmask_b32_dpp v7, v7, v7, vcc wave_shr:1 row_mask:0xf bank_mask:0xf
    s_mov_b64 exec, s[54:55]
    s_cbranch_scc0 L2_d95
    s_mov_b64 exec, s[82:83]
    s_nop 1
    v_mfma_f32_4x4x4_16b_bf16 v[88:91], v[12:13], v[84:85], 0
    s_nop 1
    v_mfma_f32_4x4x4_16b_bf16 v[88:91], v[10:11], v[86:87], v[88:91]
    s_nop 4
    v_cvt_pk_bf16_f32 v88, v88, v89
    v_cvt_pk_bf16_f32 v89, v90, v91
    ds_pk_add_bf16 v7, v88 offset:65408
    ds_pk_add_bf16 v7, v89 offset:65412
    s_mov_b64 exec, s[54:55]
    s_branch L2_d95
L2_c96:
    s_lshl_b64 s[52:53], s[82:83], 1
    s_andn2_b64 s[52:53], s[52:53], s[80:81]
    s_andn2_b64 s[52:53], s[52:53], s[50:51]
    s_or_b64 s[80:81], s[80:81], s[52:53]
    s_not_b64 vcc, s[52:53]
    s_mov_b64 exec, -1
    v_cndmask_b32_dpp v84, v84, v84, vcc wave_shr:1 row_mask:0xf bank_mask:0xf
    v_cndmask_b32_dpp v85, v85, v85, vcc wave_shr:1 row_mask:0xf bank_mask:0xf
    s_lshr_b64 s[52:53], s[52:53], 1
    v_cndmask_b32_dpp v86, v86, v86, vcc wave_shr:1 row_mask:0xf bank_mask:0xf
    v_cndmask_b32_dpp v87, v87, v87, vcc wave_shr:1 row_mask:0xf bank_mask:0xf
    s_andn2_b64 s[82:83], s[82:83], s[52:53]
    v_cndmask_b32_dpp v7, v7, v7, vcc wave_shr:1 row_mask:0xf bank_mask:0xf
    s_mov_b64 exec, s[50:51]
    s_cbranch_scc0 L2_d96
    s_mov_b64 exec, s[82:83]
    s_nop 1
    v_mfma_f32_4x4x4_16b_bf16 v[88:91], v[12:13], v[84:85], 0
    s_nop 1
    v_mfma_f32_4x4x4_16b_bf16 v[88:91], v[10:11], v[86:87], v[88:91]
    s_nop 4
    v_cvt_pk_bf16_f32 v88, v88, v89
    v_cvt_pk_bf16_f32 v89, v90, v91
    ds_pk_add_bf16 v7, v88 offset:65408
    ds_pk_add_bf16 v7, v89 offset:65412
    s_mov_b64 exec, s[50:51]
    s_branch L2_d96
L2_xa97:
    s_cmp_eq_u32 s101, 1
    s_cbranch_scc1 L2_xc97
    v_lshlrev_b32 v89, 0, v96
    v_add_u32 v90, 140, v97
    v_bitop3_b32 v90, v89, v45, v90 bitop3:0x6a
    ds_write_b32 v98, v90 offset:28
    v_lshlrev_b32 v89, 4, v96
    v_add_u32 v90, 120, v97
    v_bitop3_b32 v90, v89, v45, v90 bitop3:0x6a
    ds_write_b32 v98, v90 offset:24
    v_lshlrev_b32 v89, 8, v96
    v_add_u32 v90, 100, v97
    v_bitop3_b32 v90, v89, v45, v90 bitop3:0x6a
    ds_write_b32 v98, v90 offset:20
L2_xc97:
    v_lshlrev_b32 v89, 12, v96
    v_add_u32 v90, 80, v97
    v_bitop3_b32 v90, v89, v45, v90 bitop3:0x6a
    ds_write_b32 v98, v90 offset:16
    s_branch L2_xb97
L2_xe97:
    v_cmp_lt_u32 vcc, 32, v99
    v_cmp_lt_u32 s[58:59], 31, v88
    v_lshrrev_b32 v89, 16, v96
    v_add_u32 v97, 80, v97
    s_or_b64 vcc, vcc, s[58:59]
    s_cbranch_scc1 L2_xs97
    v_lshlrev_b32 v89, v1, v89
    v_and_b32 v89, v45, v89
    v_cmp_ne_u32 vcc, 0, v89
    v_xor_b32 v90, v97, v89
    s_add_u32 s3, s37, s38
    v_mbcnt_lo_u32_b32 v98, vcc_lo, 0
    v_mbcnt_hi_u32_b32 v98, vcc_hi, v98
    s_bcnt1_i32_b64 s41, vcc
    v_lshl_add_u32 v98, v98, 2, s3
    s_mov_b64 exec, vcc
    ds_write_b32 v98, v90
    s_mov_b64 exec, -1
    s_lshl2_add_u32 s37, s41, s37
    s_branch L2_xr97
L2_xf97:
    s_waitcnt lgkmcnt(0)
    s_cmp_gt_u32 s37, 1024
    s_cbranch_scc1 L2_xs97
    v_mov_b32 v43, -1
    s_cmp_ge_u32 s37, 512
    s_cbranch_scc1 L2_xg97
    v_mov_b32 v42, -1
    s_cmp_ge_u32 s37, 256
    s_cbranch_scc1 L2_xg97
    v_mov_b32 v41, -1
    s_branch L2_xg97
L2_xs97:
    s_waitcnt lgkmcnt(0)
    v_mov_b32 v40, -1
    v_mov_b32 v41, -1
    v_mov_b32 v42, -1
    v_mov_b32 v43, -1
    s_add_u32 s3, s42, 2
    s_bitset1_b32 s36, s3
    s_branch L2_xg97
L2_c98:
    s_lshl_b64 s[52:53], s[82:83], 1
    s_andn2_b64 s[52:53], s[52:53], s[80:81]
    s_andn2_b64 s[52:53], s[52:53], s[54:55]
    s_or_b64 s[80:81], s[80:81], s[52:53]
    s_not_b64 vcc, s[52:53]
    s_mov_b64 exec, -1
    v_cndmask_b32_dpp v84, v84, v84, vcc wave_shr:1 row_mask:0xf bank_mask:0xf
    v_cndmask_b32_dpp v85, v85, v85, vcc wave_shr:1 row_mask:0xf bank_mask:0xf
    s_lshr_b64 s[52:53], s[52:53], 1
    v_cndmask_b32_dpp v86, v86, v86, vcc wave_shr:1 row_mask:0xf bank_mask:0xf
    v_cndmask_b32_dpp v87, v87, v87, vcc wave_shr:1 row_mask:0xf bank_mask:0xf
    s_andn2_b64 s[82:83], s[82:83], s[52:53]
    v_cndmask_b32_dpp v7, v7, v7, vcc wave_shr:1 row_mask:0xf bank_mask:0xf
    s_mov_b64 exec, s[54:55]
    s_cbranch_scc0 L2_d98
    s_mov_b64 exec, s[82:83]
    s_nop 1
    v_mfma_f32_4x4x4_16b_bf16 v[88:91], v[12:13], v[84:85], 0
    s_nop 1
    v_mfma_f32_4x4x4_16b_bf16 v[88:91], v[10:11], v[86:87], v[88:91]
    s_nop 4
    v_cvt_pk_bf16_f32 v88, v88, v89
    v_cvt_pk_bf16_f32 v89, v90, v91
    ds_pk_add_bf16 v7, v88 offset:65408
    ds_pk_add_bf16 v7, v89 offset:65412
    s_mov_b64 exec, s[54:55]
    s_branch L2_d98
L2_c99:
    s_lshl_b64 s[52:53], s[82:83], 1
    s_andn2_b64 s[52:53], s[52:53], s[80:81]
    s_andn2_b64 s[52:53], s[52:53], s[50:51]
    s_or_b64 s[80:81], s[80:81], s[52:53]
    s_not_b64 vcc, s[52:53]
    s_mov_b64 exec, -1
    v_cndmask_b32_dpp v84, v84, v84, vcc wave_shr:1 row_mask:0xf bank_mask:0xf
    v_cndmask_b32_dpp v85, v85, v85, vcc wave_shr:1 row_mask:0xf bank_mask:0xf
    s_lshr_b64 s[52:53], s[52:53], 1
    v_cndmask_b32_dpp v86, v86, v86, vcc wave_shr:1 row_mask:0xf bank_mask:0xf
    v_cndmask_b32_dpp v87, v87, v87, vcc wave_shr:1 row_mask:0xf bank_mask:0xf
    s_andn2_b64 s[82:83], s[82:83], s[52:53]
    v_cndmask_b32_dpp v7, v7, v7, vcc wave_shr:1 row_mask:0xf bank_mask:0xf
    s_mov_b64 exec, s[50:51]
    s_cbranch_scc0 L2_d99
    s_mov_b64 exec, s[82:83]
    s_nop 1
    v_mfma_f32_4x4x4_16b_bf16 v[88:91], v[12:13], v[84:85], 0
    s_nop 1
    v_mfma_f32_4x4x4_16b_bf16 v[88:91], v[10:11], v[86:87], v[88:91]
    s_nop 4
    v_cvt_pk_bf16_f32 v88, v88, v89
    v_cvt_pk_bf16_f32 v89, v90, v91
    ds_pk_add_bf16 v7, v88 offset:65408
    ds_pk_add_bf16 v7, v89 offset:65412
    s_mov_b64 exec, s[50:51]
    s_branch L2_d99
L2_c100:
    s_lshl_b64 s[52:53], s[82:83], 1
    s_andn2_b64 s[52:53], s[52:53], s[80:81]
    s_andn2_b64 s[52:53], s[52:53], s[54:55]
    s_or_b64 s[80:81], s[80:81], s[52:53]
    s_not_b64 vcc, s[52:53]
    s_mov_b64 exec, -1
    v_cndmask_b32_dpp v84, v84, v84, vcc wave_shr:1 row_mask:0xf bank_mask:0xf
    v_cndmask_b32_dpp v85, v85, v85, vcc wave_shr:1 row_mask:0xf bank_mask:0xf
    s_lshr_b64 s[52:53], s[52:53], 1
    v_cndmask_b32_dpp v86, v86, v86, vcc wave_shr:1 row_mask:0xf bank_mask:0xf
    v_cndmask_b32_dpp v87, v87, v87, vcc wave_shr:1 row_mask:0xf bank_mask:0xf
    s_andn2_b64 s[82:83], s[82:83], s[52:53]
    v_cndmask_b32_dpp v7, v7, v7, vcc wave_shr:1 row_mask:0xf bank_mask:0xf
    s_mov_b64 exec, s[54:55]
    s_cbranch_scc0 L2_d100
    s_mov_b64 exec, s[82:83]
    s_nop 1
    v_mfma_f32_4x4x4_16b_bf16 v[88:91], v[12:13], v[84:85], 0
    s_nop 1
    v_mfma_f32_4x4x4_16b_bf16 v[88:91], v[10:11], v[86:87], v[88:91]
    s_nop 4
    v_cvt_pk_bf16_f32 v88, v88, v89
    v_cvt_pk_bf16_f32 v89, v90, v91
    ds_pk_add_bf16 v7, v88 offset:65408
    ds_pk_add_bf16 v7, v89 offset:65412
    s_mov_b64 exec, s[54:55]
    s_branch L2_d100
L2_c101:
    s_lshl_b64 s[52:53], s[82:83], 1
    s_andn2_b64 s[52:53], s[52:53], s[80:81]
    s_andn2_b64 s[52:53], s[52:53], s[50:51]
    s_or_b64 s[80:81], s[80:81], s[52:53]
    s_not_b64 vcc, s[52:53]
    s_mov_b64 exec, -1
    v_cndmask_b32_dpp v84, v84, v84, vcc wave_shr:1 row_mask:0xf bank_mask:0xf
    v_cndmask_b32_dpp v85, v85, v85, vcc wave_shr:1 row_mask:0xf bank_mask:0xf
    s_lshr_b64 s[52:53], s[52:53], 1
    v_cndmask_b32_dpp v86, v86, v86, vcc wave_shr:1 row_mask:0xf bank_mask:0xf
    v_cndmask_b32_dpp v87, v87, v87, vcc wave_shr:1 row_mask:0xf bank_mask:0xf
    s_andn2_b64 s[82:83], s[82:83], s[52:53]
    v_cndmask_b32_dpp v7, v7, v7, vcc wave_shr:1 row_mask:0xf bank_mask:0xf
    s_mov_b64 exec, s[50:51]
    s_cbranch_scc0 L2_d101
    s_mov_b64 exec, s[82:83]
    s_nop 1
    v_mfma_f32_4x4x4_16b_bf16 v[88:91], v[12:13], v[84:85], 0
    s_nop 1
    v_mfma_f32_4x4x4_16b_bf16 v[88:91], v[10:11], v[86:87], v[88:91]
    s_nop 4
    v_cvt_pk_bf16_f32 v88, v88, v89
    v_cvt_pk_bf16_f32 v89, v90, v91
    ds_pk_add_bf16 v7, v88 offset:65408
    ds_pk_add_bf16 v7, v89 offset:65412
    s_mov_b64 exec, s[50:51]
    s_branch L2_d101
L2_c102:
    s_lshl_b64 s[52:53], s[82:83], 1
    s_andn2_b64 s[52:53], s[52:53], s[80:81]
    s_andn2_b64 s[52:53], s[52:53], s[54:55]
    s_or_b64 s[80:81], s[80:81], s[52:53]
    s_not_b64 vcc, s[52:53]
    s_mov_b64 exec, -1
    v_cndmask_b32_dpp v84, v84, v84, vcc wave_shr:1 row_mask:0xf bank_mask:0xf
    v_cndmask_b32_dpp v85, v85, v85, vcc wave_shr:1 row_mask:0xf bank_mask:0xf
    s_lshr_b64 s[52:53], s[52:53], 1
    v_cndmask_b32_dpp v86, v86, v86, vcc wave_shr:1 row_mask:0xf bank_mask:0xf
    v_cndmask_b32_dpp v87, v87, v87, vcc wave_shr:1 row_mask:0xf bank_mask:0xf
    s_andn2_b64 s[82:83], s[82:83], s[52:53]
    v_cndmask_b32_dpp v7, v7, v7, vcc wave_shr:1 row_mask:0xf bank_mask:0xf
    s_mov_b64 exec, s[54:55]
    s_cbranch_scc0 L2_d102
    s_mov_b64 exec, s[82:83]
    s_nop 1
    v_mfma_f32_4x4x4_16b_bf16 v[88:91], v[12:13], v[84:85], 0
    s_nop 1
    v_mfma_f32_4x4x4_16b_bf16 v[88:91], v[10:11], v[86:87], v[88:91]
    s_nop 4
    v_cvt_pk_bf16_f32 v88, v88, v89
    v_cvt_pk_bf16_f32 v89, v90, v91
    ds_pk_add_bf16 v7, v88 offset:65408
    ds_pk_add_bf16 v7, v89 offset:65412
    s_mov_b64 exec, s[54:55]
    s_branch L2_d102
L2_c103:
    s_lshl_b64 s[52:53], s[82:83], 1
    s_andn2_b64 s[52:53], s[52:53], s[80:81]
    s_andn2_b64 s[52:53], s[52:53], s[50:51]
    s_or_b64 s[80:81], s[80:81], s[52:53]
    s_not_b64 vcc, s[52:53]
    s_mov_b64 exec, -1
    v_cndmask_b32_dpp v84, v84, v84, vcc wave_shr:1 row_mask:0xf bank_mask:0xf
    v_cndmask_b32_dpp v85, v85, v85, vcc wave_shr:1 row_mask:0xf bank_mask:0xf
    s_lshr_b64 s[52:53], s[52:53], 1
    v_cndmask_b32_dpp v86, v86, v86, vcc wave_shr:1 row_mask:0xf bank_mask:0xf
    v_cndmask_b32_dpp v87, v87, v87, vcc wave_shr:1 row_mask:0xf bank_mask:0xf
    s_andn2_b64 s[82:83], s[82:83], s[52:53]
    v_cndmask_b32_dpp v7, v7, v7, vcc wave_shr:1 row_mask:0xf bank_mask:0xf
    s_mov_b64 exec, s[50:51]
    s_cbranch_scc0 L2_d103
    s_mov_b64 exec, s[82:83]
    s_nop 1
    v_mfma_f32_4x4x4_16b_bf16 v[88:91], v[12:13], v[84:85], 0
    s_nop 1
    v_mfma_f32_4x4x4_16b_bf16 v[88:91], v[10:11], v[86:87], v[88:91]
    s_nop 4
    v_cvt_pk_bf16_f32 v88, v88, v89
    v_cvt_pk_bf16_f32 v89, v90, v91
    ds_pk_add_bf16 v7, v88 offset:65408
    ds_pk_add_bf16 v7, v89 offset:65412
    s_mov_b64 exec, s[50:51]
    s_branch L2_d103
L2_xo104:
    v_cmp_lt_u32 vcc, 20, v99
    s_mov_b32 s101, 1
    s_cbranch_vccz L2_xp104
    v_cmp_lt_u32 vcc, 32, v99
    v_cmp_lt_u32 s[58:59], 31, v88
    s_mov_b32 s101, 2
    s_or_b64 vcc, vcc, s[58:59]
    s_cbranch_scc0 L2_xp104
    s_mov_b32 s37, 0x10000
    s_branch L2_xp104
L2_c105:
    s_lshl_b64 s[52:53], s[82:83], 1
    s_andn2_b64 s[52:53], s[52:53], s[80:81]
    s_andn2_b64 s[52:53], s[52:53], s[54:55]
    s_or_b64 s[80:81], s[80:81], s[52:53]
    s_not_b64 vcc, s[52:53]
    s_mov_b64 exec, -1
    v_cndmask_b32_dpp v84, v84, v84, vcc wave_shr:1 row_mask:0xf bank_mask:0xf
    v_cndmask_b32_dpp v85, v85, v85, vcc wave_shr:1 row_mask:0xf bank_mask:0xf
    s_lshr_b64 s[52:53], s[52:53], 1
    v_cndmask_b32_dpp v86, v86, v86, vcc wave_shr:1 row_mask:0xf bank_mask:0xf
    v_cndmask_b32_dpp v87, v87, v87, vcc wave_shr:1 row_mask:0xf bank_mask:0xf
    s_andn2_b64 s[82:83], s[82:83], s[52:53]
    v_cndmask_b32_dpp v7, v7, v7, vcc wave_shr:1 row_mask:0xf bank_mask:0xf
    s_mov_b64 exec, s[54:55]
    s_cbranch_scc0 L2_d105
    s_mov_b64 exec, s[82:83]
    s_nop 1
    v_mfma_f32_4x4x4_16b_bf16 v[88:91], v[12:13], v[84:85], 0
    s_nop 1
    v_mfma_f32_4x4x4_16b_bf16 v[88:91], v[10:11], v[86:87], v[88:91]
    s_nop 4
    v_cvt_pk_bf16_f32 v88, v88, v89
    v_cvt_pk_bf16_f32 v89, v90, v91
    ds_pk_add_bf16 v7, v88 offset:65408
    ds_pk_add_bf16 v7, v89 offset:65412
    s_mov_b64 exec, s[54:55]
    s_branch L2_d105
L2_c106:
    s_lshl_b64 s[52:53], s[82:83], 1
    s_andn2_b64 s[52:53], s[52:53], s[80:81]
    s_andn2_b64 s[52:53], s[52:53], s[50:51]
    s_or_b64 s[80:81], s[80:81], s[52:53]
    s_not_b64 vcc, s[52:53]
    s_mov_b64 exec, -1
    v_cndmask_b32_dpp v84, v84, v84, vcc wave_shr:1 row_mask:0xf bank_mask:0xf
    v_cndmask_b32_dpp v85, v85, v85, vcc wave_shr:1 row_mask:0xf bank_mask:0xf
    s_lshr_b64 s[52:53], s[52:53], 1
    v_cndmask_b32_dpp v86, v86, v86, vcc wave_shr:1 row_mask:0xf bank_mask:0xf
    v_cndmask_b32_dpp v87, v87, v87, vcc wave_shr:1 row_mask:0xf bank_mask:0xf
    s_andn2_b64 s[82:83], s[82:83], s[52:53]
    v_cndmask_b32_dpp v7, v7, v7, vcc wave_shr:1 row_mask:0xf bank_mask:0xf
    s_mov_b64 exec, s[50:51]
    s_cbranch_scc0 L2_d106
    s_mov_b64 exec, s[82:83]
    s_nop 1
    v_mfma_f32_4x4x4_16b_bf16 v[88:91], v[12:13], v[84:85], 0
    s_nop 1
    v_mfma_f32_4x4x4_16b_bf16 v[88:91], v[10:11], v[86:87], v[88:91]
    s_nop 4
    v_cvt_pk_bf16_f32 v88, v88, v89
    v_cvt_pk_bf16_f32 v89, v90, v91
    ds_pk_add_bf16 v7, v88 offset:65408
    ds_pk_add_bf16 v7, v89 offset:65412
    s_mov_b64 exec, s[50:51]
    s_branch L2_d106
L2_c107:
    s_lshl_b64 s[52:53], s[82:83], 1
    s_andn2_b64 s[52:53], s[52:53], s[80:81]
    s_andn2_b64 s[52:53], s[52:53], s[54:55]
    s_or_b64 s[80:81], s[80:81], s[52:53]
    s_not_b64 vcc, s[52:53]
    s_mov_b64 exec, -1
    v_cndmask_b32_dpp v84, v84, v84, vcc wave_shr:1 row_mask:0xf bank_mask:0xf
    v_cndmask_b32_dpp v85, v85, v85, vcc wave_shr:1 row_mask:0xf bank_mask:0xf
    s_lshr_b64 s[52:53], s[52:53], 1
    v_cndmask_b32_dpp v86, v86, v86, vcc wave_shr:1 row_mask:0xf bank_mask:0xf
    v_cndmask_b32_dpp v87, v87, v87, vcc wave_shr:1 row_mask:0xf bank_mask:0xf
    s_andn2_b64 s[82:83], s[82:83], s[52:53]
    v_cndmask_b32_dpp v7, v7, v7, vcc wave_shr:1 row_mask:0xf bank_mask:0xf
    s_mov_b64 exec, s[54:55]
    s_cbranch_scc0 L2_d107
    s_mov_b64 exec, s[82:83]
    s_nop 1
    v_mfma_f32_4x4x4_16b_bf16 v[88:91], v[12:13], v[84:85], 0
    s_nop 1
    v_mfma_f32_4x4x4_16b_bf16 v[88:91], v[10:11], v[86:87], v[88:91]
    s_nop 4
    v_cvt_pk_bf16_f32 v88, v88, v89
    v_cvt_pk_bf16_f32 v89, v90, v91
    ds_pk_add_bf16 v7, v88 offset:65408
    ds_pk_add_bf16 v7, v89 offset:65412
    s_mov_b64 exec, s[54:55]
    s_branch L2_d107
L2_c108:
    s_lshl_b64 s[52:53], s[82:83], 1
    s_andn2_b64 s[52:53], s[52:53], s[80:81]
    s_andn2_b64 s[52:53], s[52:53], s[50:51]
    s_or_b64 s[80:81], s[80:81], s[52:53]
    s_not_b64 vcc, s[52:53]
    s_mov_b64 exec, -1
    v_cndmask_b32_dpp v84, v84, v84, vcc wave_shr:1 row_mask:0xf bank_mask:0xf
    v_cndmask_b32_dpp v85, v85, v85, vcc wave_shr:1 row_mask:0xf bank_mask:0xf
    s_lshr_b64 s[52:53], s[52:53], 1
    v_cndmask_b32_dpp v86, v86, v86, vcc wave_shr:1 row_mask:0xf bank_mask:0xf
    v_cndmask_b32_dpp v87, v87, v87, vcc wave_shr:1 row_mask:0xf bank_mask:0xf
    s_andn2_b64 s[82:83], s[82:83], s[52:53]
    v_cndmask_b32_dpp v7, v7, v7, vcc wave_shr:1 row_mask:0xf bank_mask:0xf
    s_mov_b64 exec, s[50:51]
    s_cbranch_scc0 L2_d108
    s_mov_b64 exec, s[82:83]
    s_nop 1
    v_mfma_f32_4x4x4_16b_bf16 v[88:91], v[12:13], v[84:85], 0
    s_nop 1
    v_mfma_f32_4x4x4_16b_bf16 v[88:91], v[10:11], v[86:87], v[88:91]
    s_nop 4
    v_cvt_pk_bf16_f32 v88, v88, v89
    v_cvt_pk_bf16_f32 v89, v90, v91
    ds_pk_add_bf16 v7, v88 offset:65408
    ds_pk_add_bf16 v7, v89 offset:65412
    s_mov_b64 exec, s[50:51]
    s_branch L2_d108
L2_c109:
    s_lshl_b64 s[52:53], s[82:83], 1
    s_andn2_b64 s[52:53], s[52:53], s[80:81]
    s_andn2_b64 s[52:53], s[52:53], s[54:55]
    s_or_b64 s[80:81], s[80:81], s[52:53]
    s_not_b64 vcc, s[52:53]
    s_mov_b64 exec, -1
    v_cndmask_b32_dpp v84, v84, v84, vcc wave_shr:1 row_mask:0xf bank_mask:0xf
    v_cndmask_b32_dpp v85, v85, v85, vcc wave_shr:1 row_mask:0xf bank_mask:0xf
    s_lshr_b64 s[52:53], s[52:53], 1
    v_cndmask_b32_dpp v86, v86, v86, vcc wave_shr:1 row_mask:0xf bank_mask:0xf
    v_cndmask_b32_dpp v87, v87, v87, vcc wave_shr:1 row_mask:0xf bank_mask:0xf
    s_andn2_b64 s[82:83], s[82:83], s[52:53]
    v_cndmask_b32_dpp v7, v7, v7, vcc wave_shr:1 row_mask:0xf bank_mask:0xf
    s_mov_b64 exec, s[54:55]
    s_cbranch_scc0 L2_d109
    s_mov_b64 exec, s[82:83]
    s_nop 1
    v_mfma_f32_4x4x4_16b_bf16 v[88:91], v[12:13], v[84:85], 0
    s_nop 1
    v_mfma_f32_4x4x4_16b_bf16 v[88:91], v[10:11], v[86:87], v[88:91]
    s_nop 4
    v_cvt_pk_bf16_f32 v88, v88, v89
    v_cvt_pk_bf16_f32 v89, v90, v91
    ds_pk_add_bf16 v7, v88 offset:65408
    ds_pk_add_bf16 v7, v89 offset:65412
    s_mov_b64 exec, s[54:55]
    s_branch L2_d109
L2_c110:
    s_lshl_b64 s[52:53], s[82:83], 1
    s_andn2_b64 s[52:53], s[52:53], s[80:81]
    s_andn2_b64 s[52:53], s[52:53], s[50:51]
    s_or_b64 s[80:81], s[80:81], s[52:53]
    s_not_b64 vcc, s[52:53]
    s_mov_b64 exec, -1
    v_cndmask_b32_dpp v84, v84, v84, vcc wave_shr:1 row_mask:0xf bank_mask:0xf
    v_cndmask_b32_dpp v85, v85, v85, vcc wave_shr:1 row_mask:0xf bank_mask:0xf
    s_lshr_b64 s[52:53], s[52:53], 1
    v_cndmask_b32_dpp v86, v86, v86, vcc wave_shr:1 row_mask:0xf bank_mask:0xf
    v_cndmask_b32_dpp v87, v87, v87, vcc wave_shr:1 row_mask:0xf bank_mask:0xf
    s_andn2_b64 s[82:83], s[82:83], s[52:53]
    v_cndmask_b32_dpp v7, v7, v7, vcc wave_shr:1 row_mask:0xf bank_mask:0xf
    s_mov_b64 exec, s[50:51]
    s_cbranch_scc0 L2_d110
    s_mov_b64 exec, s[82:83]
    s_nop 1
    v_mfma_f32_4x4x4_16b_bf16 v[88:91], v[12:13], v[84:85], 0
    s_nop 1
    v_mfma_f32_4x4x4_16b_bf16 v[88:91], v[10:11], v[86:87], v[88:91]
    s_nop 4
    v_cvt_pk_bf16_f32 v88, v88, v89
    v_cvt_pk_bf16_f32 v89, v90, v91
    ds_pk_add_bf16 v7, v88 offset:65408
    ds_pk_add_bf16 v7, v89 offset:65412
    s_mov_b64 exec, s[50:51]
    s_branch L2_d110
L2_c111:
    s_lshl_b64 s[52:53], s[82:83], 1
    s_andn2_b64 s[52:53], s[52:53], s[80:81]
    s_andn2_b64 s[52:53], s[52:53], s[54:55]
    s_or_b64 s[80:81], s[80:81], s[52:53]
    s_not_b64 vcc, s[52:53]
    s_mov_b64 exec, -1
    v_cndmask_b32_dpp v84, v84, v84, vcc wave_shr:1 row_mask:0xf bank_mask:0xf
    v_cndmask_b32_dpp v85, v85, v85, vcc wave_shr:1 row_mask:0xf bank_mask:0xf
    s_lshr_b64 s[52:53], s[52:53], 1
    v_cndmask_b32_dpp v86, v86, v86, vcc wave_shr:1 row_mask:0xf bank_mask:0xf
    v_cndmask_b32_dpp v87, v87, v87, vcc wave_shr:1 row_mask:0xf bank_mask:0xf
    s_andn2_b64 s[82:83], s[82:83], s[52:53]
    v_cndmask_b32_dpp v7, v7, v7, vcc wave_shr:1 row_mask:0xf bank_mask:0xf
    s_mov_b64 exec, s[54:55]
    s_cbranch_scc0 L2_d111
    s_mov_b64 exec, s[82:83]
    s_nop 1
    v_mfma_f32_4x4x4_16b_bf16 v[88:91], v[12:13], v[84:85], 0
    s_nop 1
    v_mfma_f32_4x4x4_16b_bf16 v[88:91], v[10:11], v[86:87], v[88:91]
    s_nop 4
    v_cvt_pk_bf16_f32 v88, v88, v89
    v_cvt_pk_bf16_f32 v89, v90, v91
    ds_pk_add_bf16 v7, v88 offset:65408
    ds_pk_add_bf16 v7, v89 offset:65412
    s_mov_b64 exec, s[54:55]
    s_branch L2_d111
L2_c112:
    s_lshl_b64 s[52:53], s[82:83], 1
    s_andn2_b64 s[52:53], s[52:53], s[80:81]
    s_andn2_b64 s[52:53], s[52:53], s[50:51]
    s_or_b64 s[80:81], s[80:81], s[52:53]
    s_not_b64 vcc, s[52:53]
    s_mov_b64 exec, -1
    v_cndmask_b32_dpp v84, v84, v84, vcc wave_shr:1 row_mask:0xf bank_mask:0xf
    v_cndmask_b32_dpp v85, v85, v85, vcc wave_shr:1 row_mask:0xf bank_mask:0xf
    s_lshr_b64 s[52:53], s[52:53], 1
    v_cndmask_b32_dpp v86, v86, v86, vcc wave_shr:1 row_mask:0xf bank_mask:0xf
    v_cndmask_b32_dpp v87, v87, v87, vcc wave_shr:1 row_mask:0xf bank_mask:0xf
    s_andn2_b64 s[82:83], s[82:83], s[52:53]
    v_cndmask_b32_dpp v7, v7, v7, vcc wave_shr:1 row_mask:0xf bank_mask:0xf
    s_mov_b64 exec, s[50:51]
    s_cbranch_scc0 L2_d112
    s_mov_b64 exec, s[82:83]
    s_nop 1
    v_mfma_f32_4x4x4_16b_bf16 v[88:91], v[12:13], v[84:85], 0
    s_nop 1
    v_mfma_f32_4x4x4_16b_bf16 v[88:91], v[10:11], v[86:87], v[88:91]
    s_nop 4
    v_cvt_pk_bf16_f32 v88, v88, v89
    v_cvt_pk_bf16_f32 v89, v90, v91
    ds_pk_add_bf16 v7, v88 offset:65408
    ds_pk_add_bf16 v7, v89 offset:65412
    s_mov_b64 exec, s[50:51]
    s_branch L2_d112
L2_c113:
    s_lshl_b64 s[52:53], s[82:83], 1
    s_andn2_b64 s[52:53], s[52:53], s[80:81]
    s_andn2_b64 s[52:53], s[52:53], s[54:55]
    s_or_b64 s[80:81], s[80:81], s[52:53]
    s_not_b64 vcc, s[52:53]
    s_mov_b64 exec, -1
    v_cndmask_b32_dpp v84, v84, v84, vcc wave_shr:1 row_mask:0xf bank_mask:0xf
    v_cndmask_b32_dpp v85, v85, v85, vcc wave_shr:1 row_mask:0xf bank_mask:0xf
    s_lshr_b64 s[52:53], s[52:53], 1
    v_cndmask_b32_dpp v86, v86, v86, vcc wave_shr:1 row_mask:0xf bank_mask:0xf
    v_cndmask_b32_dpp v87, v87, v87, vcc wave_shr:1 row_mask:0xf bank_mask:0xf
    s_andn2_b64 s[82:83], s[82:83], s[52:53]
    v_cndmask_b32_dpp v7, v7, v7, vcc wave_shr:1 row_mask:0xf bank_mask:0xf
    s_mov_b64 exec, s[54:55]
    s_cbranch_scc0 L2_d113
    s_mov_b64 exec, s[82:83]
    s_nop 1
    v_mfma_f32_4x4x4_16b_bf16 v[88:91], v[12:13], v[84:85], 0
    s_nop 1
    v_mfma_f32_4x4x4_16b_bf16 v[88:91], v[10:11], v[86:87], v[88:91]
    s_nop 4
    v_cvt_pk_bf16_f32 v88, v88, v89
    v_cvt_pk_bf16_f32 v89, v90, v91
    ds_pk_add_bf16 v7, v88 offset:65408
    ds_pk_add_bf16 v7, v89 offset:65412
    s_mov_b64 exec, s[54:55]
    s_branch L2_d113
L2_c114:
    s_lshl_b64 s[52:53], s[82:83], 1
    s_andn2_b64 s[52:53], s[52:53], s[80:81]
    s_andn2_b64 s[52:53], s[52:53], s[50:51]
    s_or_b64 s[80:81], s[80:81], s[52:53]
    s_not_b64 vcc, s[52:53]
    s_mov_b64 exec, -1
    v_cndmask_b32_dpp v84, v84, v84, vcc wave_shr:1 row_mask:0xf bank_mask:0xf
    v_cndmask_b32_dpp v85, v85, v85, vcc wave_shr:1 row_mask:0xf bank_mask:0xf
    s_lshr_b64 s[52:53], s[52:53], 1
    v_cndmask_b32_dpp v86, v86, v86, vcc wave_shr:1 row_mask:0xf bank_mask:0xf
    v_cndmask_b32_dpp v87, v87, v87, vcc wave_shr:1 row_mask:0xf bank_mask:0xf
    s_andn2_b64 s[82:83], s[82:83], s[52:53]
    v_cndmask_b32_dpp v7, v7, v7, vcc wave_shr:1 row_mask:0xf bank_mask:0xf
    s_mov_b64 exec, s[50:51]
    s_cbranch_scc0 L2_d114
    s_mov_b64 exec, s[82:83]
    s_nop 1
    v_mfma_f32_4x4x4_16b_bf16 v[88:91], v[12:13], v[84:85], 0
    s_nop 1
    v_mfma_f32_4x4x4_16b_bf16 v[88:91], v[10:11], v[86:87], v[88:91]
    s_nop 4
    v_cvt_pk_bf16_f32 v88, v88, v89
    v_cvt_pk_bf16_f32 v89, v90, v91
    ds_pk_add_bf16 v7, v88 offset:65408
    ds_pk_add_bf16 v7, v89 offset:65412
    s_mov_b64 exec, s[50:51]
    s_branch L2_d114
L2_xa115:
    s_cmp_eq_u32 s101, 1
    s_cbranch_scc1 L2_xc115
    v_lshlrev_b32 v89, 0, v96
    v_add_u32 v90, 140, v97
    v_bitop3_b32 v90, v89, v45, v90 bitop3:0x6a
    ds_write_b32 v98, v90 offset:28
    v_lshlrev_b32 v89, 4, v96
    v_add_u32 v90, 120, v97
    v_bitop3_b32 v90, v89, v45, v90 bitop3:0x6a
    ds_write_b32 v98, v90 offset:24
    v_lshlrev_b32 v89, 8, v96
    v_add_u32 v90, 100, v97
    v_bitop3_b32 v90, v89, v45, v90 bitop3:0x6a
    ds_write_b32 v98, v90 offset:20
L2_xc115:
    v_lshlrev_b32 v89, 12, v96
    v_add_u32 v90, 80, v97
    v_bitop3_b32 v90, v89, v45, v90 bitop3:0x6a
    ds_write_b32 v98, v90 offset:16
    s_branch L2_xb115
L2_xe115:
    v_cmp_lt_u32 vcc, 32, v99
    v_cmp_lt_u32 s[58:59], 31, v88
    v_lshrrev_b32 v89, 16, v96
    v_add_u32 v97, 80, v97
    s_or_b64 vcc, vcc, s[58:59]
    s_cbranch_scc1 L2_xs115
    v_lshlrev_b32 v89, v1, v89
    v_and_b32 v89, v45, v89
    v_cmp_ne_u32 vcc, 0, v89
    v_xor_b32 v90, v97, v89
    s_add_u32 s3, s37, s38
    v_mbcnt_lo_u32_b32 v98, vcc_lo, 0
    v_mbcnt_hi_u32_b32 v98, vcc_hi, v98
    s_bcnt1_i32_b64 s41, vcc
    v_lshl_add_u32 v98, v98, 2, s3
    s_mov_b64 exec, vcc
    ds_write_b32 v98, v90
    s_mov_b64 exec, -1
    s_lshl2_add_u32 s37, s41, s37
    s_branch L2_xr115
L2_xf115:
    s_waitcnt lgkmcnt(0)
    s_cmp_gt_u32 s37, 1024
    s_cbranch_scc1 L2_xs115
    v_mov_b32 v43, -1
    s_cmp_ge_u32 s37, 512
    s_cbranch_scc1 L2_xg115
    v_mov_b32 v42, -1
    s_cmp_ge_u32 s37, 256
    s_cbranch_scc1 L2_xg115
    v_mov_b32 v41, -1
    s_branch L2_xg115
L2_xs115:
    s_waitcnt lgkmcnt(0)
    v_mov_b32 v40, -1
    v_mov_b32 v41, -1
    v_mov_b32 v42, -1
    v_mov_b32 v43, -1
    s_add_u32 s3, s42, 2
    s_bitset1_b32 s36, s3
    s_branch L2_xg115
L2_c116:
    s_lshl_b64 s[52:53], s[82:83], 1
    s_andn2_b64 s[52:53], s[52:53], s[80:81]
    s_andn2_b64 s[52:53], s[52:53], s[54:55]
    s_or_b64 s[80:81], s[80:81], s[52:53]
    s_not_b64 vcc, s[52:53]
    s_mov_b64 exec, -1
    v_cndmask_b32_dpp v84, v84, v84, vcc wave_shr:1 row_mask:0xf bank_mask:0xf
    v_cndmask_b32_dpp v85, v85, v85, vcc wave_shr:1 row_mask:0xf bank_mask:0xf
    s_lshr_b64 s[52:53], s[52:53], 1
    v_cndmask_b32_dpp v86, v86, v86, vcc wave_shr:1 row_mask:0xf bank_mask:0xf
    v_cndmask_b32_dpp v87, v87, v87, vcc wave_shr:1 row_mask:0xf bank_mask:0xf
    s_andn2_b64 s[82:83], s[82:83], s[52:53]
    v_cndmask_b32_dpp v7, v7, v7, vcc wave_shr:1 row_mask:0xf bank_mask:0xf
    s_mov_b64 exec, s[54:55]
    s_cbranch_scc0 L2_d116
    s_mov_b64 exec, s[82:83]
    s_nop 1
    v_mfma_f32_4x4x4_16b_bf16 v[88:91], v[12:13], v[84:85], 0
    s_nop 1
    v_mfma_f32_4x4x4_16b_bf16 v[88:91], v[10:11], v[86:87], v[88:91]
    s_nop 4
    v_cvt_pk_bf16_f32 v88, v88, v89
    v_cvt_pk_bf16_f32 v89, v90, v91
    ds_pk_add_bf16 v7, v88 offset:65408
    ds_pk_add_bf16 v7, v89 offset:65412
    s_mov_b64 exec, s[54:55]
    s_branch L2_d116
L2_c117:
    s_lshl_b64 s[52:53], s[82:83], 1
    s_andn2_b64 s[52:53], s[52:53], s[80:81]
    s_andn2_b64 s[52:53], s[52:53], s[50:51]
    s_or_b64 s[80:81], s[80:81], s[52:53]
    s_not_b64 vcc, s[52:53]
    s_mov_b64 exec, -1
    v_cndmask_b32_dpp v84, v84, v84, vcc wave_shr:1 row_mask:0xf bank_mask:0xf
    v_cndmask_b32_dpp v85, v85, v85, vcc wave_shr:1 row_mask:0xf bank_mask:0xf
    s_lshr_b64 s[52:53], s[52:53], 1
    v_cndmask_b32_dpp v86, v86, v86, vcc wave_shr:1 row_mask:0xf bank_mask:0xf
    v_cndmask_b32_dpp v87, v87, v87, vcc wave_shr:1 row_mask:0xf bank_mask:0xf
    s_andn2_b64 s[82:83], s[82:83], s[52:53]
    v_cndmask_b32_dpp v7, v7, v7, vcc wave_shr:1 row_mask:0xf bank_mask:0xf
    s_mov_b64 exec, s[50:51]
    s_cbranch_scc0 L2_d117
    s_mov_b64 exec, s[82:83]
    s_nop 1
    v_mfma_f32_4x4x4_16b_bf16 v[88:91], v[12:13], v[84:85], 0
    s_nop 1
    v_mfma_f32_4x4x4_16b_bf16 v[88:91], v[10:11], v[86:87], v[88:91]
    s_nop 4
    v_cvt_pk_bf16_f32 v88, v88, v89
    v_cvt_pk_bf16_f32 v89, v90, v91
    ds_pk_add_bf16 v7, v88 offset:65408
    ds_pk_add_bf16 v7, v89 offset:65412
    s_mov_b64 exec, s[50:51]
    s_branch L2_d117
L2_c118:
    s_lshl_b64 s[52:53], s[82:83], 1
    s_andn2_b64 s[52:53], s[52:53], s[80:81]
    s_andn2_b64 s[52:53], s[52:53], s[54:55]
    s_or_b64 s[80:81], s[80:81], s[52:53]
    s_not_b64 vcc, s[52:53]
    s_mov_b64 exec, -1
    v_cndmask_b32_dpp v84, v84, v84, vcc wave_shr:1 row_mask:0xf bank_mask:0xf
    v_cndmask_b32_dpp v85, v85, v85, vcc wave_shr:1 row_mask:0xf bank_mask:0xf
    s_lshr_b64 s[52:53], s[52:53], 1
    v_cndmask_b32_dpp v86, v86, v86, vcc wave_shr:1 row_mask:0xf bank_mask:0xf
    v_cndmask_b32_dpp v87, v87, v87, vcc wave_shr:1 row_mask:0xf bank_mask:0xf
    s_andn2_b64 s[82:83], s[82:83], s[52:53]
    v_cndmask_b32_dpp v7, v7, v7, vcc wave_shr:1 row_mask:0xf bank_mask:0xf
    s_mov_b64 exec, s[54:55]
    s_cbranch_scc0 L2_d118
    s_mov_b64 exec, s[82:83]
    s_nop 1
    v_mfma_f32_4x4x4_16b_bf16 v[88:91], v[12:13], v[84:85], 0
    s_nop 1
    v_mfma_f32_4x4x4_16b_bf16 v[88:91], v[10:11], v[86:87], v[88:91]
    s_nop 4
    v_cvt_pk_bf16_f32 v88, v88, v89
    v_cvt_pk_bf16_f32 v89, v90, v91
    ds_pk_add_bf16 v7, v88 offset:65408
    ds_pk_add_bf16 v7, v89 offset:65412
    s_mov_b64 exec, s[54:55]
    s_branch L2_d118
L2_c119:
    s_lshl_b64 s[52:53], s[82:83], 1
    s_andn2_b64 s[52:53], s[52:53], s[80:81]
    s_andn2_b64 s[52:53], s[52:53], s[50:51]
    s_or_b64 s[80:81], s[80:81], s[52:53]
    s_not_b64 vcc, s[52:53]
    s_mov_b64 exec, -1
    v_cndmask_b32_dpp v84, v84, v84, vcc wave_shr:1 row_mask:0xf bank_mask:0xf
    v_cndmask_b32_dpp v85, v85, v85, vcc wave_shr:1 row_mask:0xf bank_mask:0xf
    s_lshr_b64 s[52:53], s[52:53], 1
    v_cndmask_b32_dpp v86, v86, v86, vcc wave_shr:1 row_mask:0xf bank_mask:0xf
    v_cndmask_b32_dpp v87, v87, v87, vcc wave_shr:1 row_mask:0xf bank_mask:0xf
    s_andn2_b64 s[82:83], s[82:83], s[52:53]
    v_cndmask_b32_dpp v7, v7, v7, vcc wave_shr:1 row_mask:0xf bank_mask:0xf
    s_mov_b64 exec, s[50:51]
    s_cbranch_scc0 L2_d119
    s_mov_b64 exec, s[82:83]
    s_nop 1
    v_mfma_f32_4x4x4_16b_bf16 v[88:91], v[12:13], v[84:85], 0
    s_nop 1
    v_mfma_f32_4x4x4_16b_bf16 v[88:91], v[10:11], v[86:87], v[88:91]
    s_nop 4
    v_cvt_pk_bf16_f32 v88, v88, v89
    v_cvt_pk_bf16_f32 v89, v90, v91
    ds_pk_add_bf16 v7, v88 offset:65408
    ds_pk_add_bf16 v7, v89 offset:65412
    s_mov_b64 exec, s[50:51]
    s_branch L2_d119
L2_c120:
    s_lshl_b64 s[52:53], s[82:83], 1
    s_andn2_b64 s[52:53], s[52:53], s[80:81]
    s_andn2_b64 s[52:53], s[52:53], s[54:55]
    s_or_b64 s[80:81], s[80:81], s[52:53]
    s_not_b64 vcc, s[52:53]
    s_mov_b64 exec, -1
    v_cndmask_b32_dpp v84, v84, v84, vcc wave_shr:1 row_mask:0xf bank_mask:0xf
    v_cndmask_b32_dpp v85, v85, v85, vcc wave_shr:1 row_mask:0xf bank_mask:0xf
    s_lshr_b64 s[52:53], s[52:53], 1
    v_cndmask_b32_dpp v86, v86, v86, vcc wave_shr:1 row_mask:0xf bank_mask:0xf
    v_cndmask_b32_dpp v87, v87, v87, vcc wave_shr:1 row_mask:0xf bank_mask:0xf
    s_andn2_b64 s[82:83], s[82:83], s[52:53]
    v_cndmask_b32_dpp v7, v7, v7, vcc wave_shr:1 row_mask:0xf bank_mask:0xf
    s_mov_b64 exec, s[54:55]
    s_cbranch_scc0 L2_d120
    s_mov_b64 exec, s[82:83]
    s_nop 1
    v_mfma_f32_4x4x4_16b_bf16 v[88:91], v[12:13], v[84:85], 0
    s_nop 1
    v_mfma_f32_4x4x4_16b_bf16 v[88:91], v[10:11], v[86:87], v[88:91]
    s_nop 4
    v_cvt_pk_bf16_f32 v88, v88, v89
    v_cvt_pk_bf16_f32 v89, v90, v91
    ds_pk_add_bf16 v7, v88 offset:65408
    ds_pk_add_bf16 v7, v89 offset:65412
    s_mov_b64 exec, s[54:55]
    s_branch L2_d120
L2_c121:
    s_lshl_b64 s[52:53], s[82:83], 1
    s_andn2_b64 s[52:53], s[52:53], s[80:81]
    s_andn2_b64 s[52:53], s[52:53], s[50:51]
    s_or_b64 s[80:81], s[80:81], s[52:53]
    s_not_b64 vcc, s[52:53]
    s_mov_b64 exec, -1
    v_cndmask_b32_dpp v84, v84, v84, vcc wave_shr:1 row_mask:0xf bank_mask:0xf
    v_cndmask_b32_dpp v85, v85, v85, vcc wave_shr:1 row_mask:0xf bank_mask:0xf
    s_lshr_b64 s[52:53], s[52:53], 1
    v_cndmask_b32_dpp v86, v86, v86, vcc wave_shr:1 row_mask:0xf bank_mask:0xf
    v_cndmask_b32_dpp v87, v87, v87, vcc wave_shr:1 row_mask:0xf bank_mask:0xf
    s_andn2_b64 s[82:83], s[82:83], s[52:53]
    v_cndmask_b32_dpp v7, v7, v7, vcc wave_shr:1 row_mask:0xf bank_mask:0xf
    s_mov_b64 exec, s[50:51]
    s_cbranch_scc0 L2_d121
    s_mov_b64 exec, s[82:83]
    s_nop 1
    v_mfma_f32_4x4x4_16b_bf16 v[88:91], v[12:13], v[84:85], 0
    s_nop 1
    v_mfma_f32_4x4x4_16b_bf16 v[88:91], v[10:11], v[86:87], v[88:91]
    s_nop 4
    v_cvt_pk_bf16_f32 v88, v88, v89
    v_cvt_pk_bf16_f32 v89, v90, v91
    ds_pk_add_bf16 v7, v88 offset:65408
    ds_pk_add_bf16 v7, v89 offset:65412
    s_mov_b64 exec, s[50:51]
    s_branch L2_d121
L2_c122:
    s_lshl_b64 s[52:53], s[82:83], 1
    s_andn2_b64 s[52:53], s[52:53], s[80:81]
    s_andn2_b64 s[52:53], s[52:53], s[54:55]
    s_or_b64 s[80:81], s[80:81], s[52:53]
    s_not_b64 vcc, s[52:53]
    s_mov_b64 exec, -1
    v_cndmask_b32_dpp v84, v84, v84, vcc wave_shr:1 row_mask:0xf bank_mask:0xf
    v_cndmask_b32_dpp v85, v85, v85, vcc wave_shr:1 row_mask:0xf bank_mask:0xf
    s_lshr_b64 s[52:53], s[52:53], 1
    v_cndmask_b32_dpp v86, v86, v86, vcc wave_shr:1 row_mask:0xf bank_mask:0xf
    v_cndmask_b32_dpp v87, v87, v87, vcc wave_shr:1 row_mask:0xf bank_mask:0xf
    s_andn2_b64 s[82:83], s[82:83], s[52:53]
    v_cndmask_b32_dpp v7, v7, v7, vcc wave_shr:1 row_mask:0xf bank_mask:0xf
    s_mov_b64 exec, s[54:55]
    s_cbranch_scc0 L2_d122
    s_mov_b64 exec, s[82:83]
    s_nop 1
    v_mfma_f32_4x4x4_16b_bf16 v[88:91], v[12:13], v[84:85], 0
    s_nop 1
    v_mfma_f32_4x4x4_16b_bf16 v[88:91], v[10:11], v[86:87], v[88:91]
    s_nop 4
    v_cvt_pk_bf16_f32 v88, v88, v89
    v_cvt_pk_bf16_f32 v89, v90, v91
    ds_pk_add_bf16 v7, v88 offset:65408
    ds_pk_add_bf16 v7, v89 offset:65412
    s_mov_b64 exec, s[54:55]
    s_branch L2_d122
L2_c123:
    s_lshl_b64 s[52:53], s[82:83], 1
    s_andn2_b64 s[52:53], s[52:53], s[80:81]
    s_andn2_b64 s[52:53], s[52:53], s[50:51]
    s_or_b64 s[80:81], s[80:81], s[52:53]
    s_not_b64 vcc, s[52:53]
    s_mov_b64 exec, -1
    v_cndmask_b32_dpp v84, v84, v84, vcc wave_shr:1 row_mask:0xf bank_mask:0xf
    v_cndmask_b32_dpp v85, v85, v85, vcc wave_shr:1 row_mask:0xf bank_mask:0xf
    s_lshr_b64 s[52:53], s[52:53], 1
    v_cndmask_b32_dpp v86, v86, v86, vcc wave_shr:1 row_mask:0xf bank_mask:0xf
    v_cndmask_b32_dpp v87, v87, v87, vcc wave_shr:1 row_mask:0xf bank_mask:0xf
    s_andn2_b64 s[82:83], s[82:83], s[52:53]
    v_cndmask_b32_dpp v7, v7, v7, vcc wave_shr:1 row_mask:0xf bank_mask:0xf
    s_mov_b64 exec, s[50:51]
    s_cbranch_scc0 L2_d123
    s_mov_b64 exec, s[82:83]
    s_nop 1
    v_mfma_f32_4x4x4_16b_bf16 v[88:91], v[12:13], v[84:85], 0
    s_nop 1
    v_mfma_f32_4x4x4_16b_bf16 v[88:91], v[10:11], v[86:87], v[88:91]
    s_nop 4
    v_cvt_pk_bf16_f32 v88, v88, v89
    v_cvt_pk_bf16_f32 v89, v90, v91
    ds_pk_add_bf16 v7, v88 offset:65408
    ds_pk_add_bf16 v7, v89 offset:65412
    s_mov_b64 exec, s[50:51]
    s_branch L2_d123
L2_c124:
    s_lshl_b64 s[52:53], s[82:83], 1
    s_andn2_b64 s[52:53], s[52:53], s[80:81]
    s_andn2_b64 s[52:53], s[52:53], s[54:55]
    s_or_b64 s[80:81], s[80:81], s[52:53]
    s_not_b64 vcc, s[52:53]
    s_mov_b64 exec, -1
    v_cndmask_b32_dpp v84, v84, v84, vcc wave_shr:1 row_mask:0xf bank_mask:0xf
    v_cndmask_b32_dpp v85, v85, v85, vcc wave_shr:1 row_mask:0xf bank_mask:0xf
    s_lshr_b64 s[52:53], s[52:53], 1
    v_cndmask_b32_dpp v86, v86, v86, vcc wave_shr:1 row_mask:0xf bank_mask:0xf
    v_cndmask_b32_dpp v87, v87, v87, vcc wave_shr:1 row_mask:0xf bank_mask:0xf
    s_andn2_b64 s[82:83], s[82:83], s[52:53]
    v_cndmask_b32_dpp v7, v7, v7, vcc wave_shr:1 row_mask:0xf bank_mask:0xf
    s_mov_b64 exec, s[54:55]
    s_cbranch_scc0 L2_d124
    s_mov_b64 exec, s[82:83]
    s_nop 1
    v_mfma_f32_4x4x4_16b_bf16 v[88:91], v[12:13], v[84:85], 0
    s_nop 1
    v_mfma_f32_4x4x4_16b_bf16 v[88:91], v[10:11], v[86:87], v[88:91]
    s_nop 4
    v_cvt_pk_bf16_f32 v88, v88, v89
    v_cvt_pk_bf16_f32 v89, v90, v91
    ds_pk_add_bf16 v7, v88 offset:65408
    ds_pk_add_bf16 v7, v89 offset:65412
    s_mov_b64 exec, s[54:55]
    s_branch L2_d124
L2_c125:
    s_lshl_b64 s[52:53], s[82:83], 1
    s_andn2_b64 s[52:53], s[52:53], s[80:81]
    s_andn2_b64 s[52:53], s[52:53], s[50:51]
    s_or_b64 s[80:81], s[80:81], s[52:53]
    s_not_b64 vcc, s[52:53]
    s_mov_b64 exec, -1
    v_cndmask_b32_dpp v84, v84, v84, vcc wave_shr:1 row_mask:0xf bank_mask:0xf
    v_cndmask_b32_dpp v85, v85, v85, vcc wave_shr:1 row_mask:0xf bank_mask:0xf
    s_lshr_b64 s[52:53], s[52:53], 1
    v_cndmask_b32_dpp v86, v86, v86, vcc wave_shr:1 row_mask:0xf bank_mask:0xf
    v_cndmask_b32_dpp v87, v87, v87, vcc wave_shr:1 row_mask:0xf bank_mask:0xf
    s_andn2_b64 s[82:83], s[82:83], s[52:53]
    v_cndmask_b32_dpp v7, v7, v7, vcc wave_shr:1 row_mask:0xf bank_mask:0xf
    s_mov_b64 exec, s[50:51]
    s_cbranch_scc0 L2_d125
    s_mov_b64 exec, s[82:83]
    s_nop 1
    v_mfma_f32_4x4x4_16b_bf16 v[88:91], v[12:13], v[84:85], 0
    s_nop 1
    v_mfma_f32_4x4x4_16b_bf16 v[88:91], v[10:11], v[86:87], v[88:91]
    s_nop 4
    v_cvt_pk_bf16_f32 v88, v88, v89
    v_cvt_pk_bf16_f32 v89, v90, v91
    ds_pk_add_bf16 v7, v88 offset:65408
    ds_pk_add_bf16 v7, v89 offset:65412
    s_mov_b64 exec, s[50:51]
    s_branch L2_d125
L2_c126:
    s_lshl_b64 s[52:53], s[82:83], 1
    s_andn2_b64 s[52:53], s[52:53], s[80:81]
    s_andn2_b64 s[52:53], s[52:53], s[54:55]
    s_or_b64 s[80:81], s[80:81], s[52:53]
    s_not_b64 vcc, s[52:53]
    s_mov_b64 exec, -1
    v_cndmask_b32_dpp v84, v84, v84, vcc wave_shr:1 row_mask:0xf bank_mask:0xf
    v_cndmask_b32_dpp v85, v85, v85, vcc wave_shr:1 row_mask:0xf bank_mask:0xf
    s_lshr_b64 s[52:53], s[52:53], 1
    v_cndmask_b32_dpp v86, v86, v86, vcc wave_shr:1 row_mask:0xf bank_mask:0xf
    v_cndmask_b32_dpp v87, v87, v87, vcc wave_shr:1 row_mask:0xf bank_mask:0xf
    s_andn2_b64 s[82:83], s[82:83], s[52:53]
    v_cndmask_b32_dpp v7, v7, v7, vcc wave_shr:1 row_mask:0xf bank_mask:0xf
    s_mov_b64 exec, s[54:55]
    s_cbranch_scc0 L2_d126
    s_mov_b64 exec, s[82:83]
    s_nop 1
    v_mfma_f32_4x4x4_16b_bf16 v[88:91], v[12:13], v[84:85], 0
    s_nop 1
    v_mfma_f32_4x4x4_16b_bf16 v[88:91], v[10:11], v[86:87], v[88:91]
    s_nop 4
    v_cvt_pk_bf16_f32 v88, v88, v89
    v_cvt_pk_bf16_f32 v89, v90, v91
    ds_pk_add_bf16 v7, v88 offset:65408
    ds_pk_add_bf16 v7, v89 offset:65412
    s_mov_b64 exec, s[54:55]
    s_branch L2_d126
L2_c127:
    s_lshl_b64 s[52:53], s[82:83], 1
    s_andn2_b64 s[52:53], s[52:53], s[80:81]
    s_andn2_b64 s[52:53], s[52:53], s[50:51]
    s_or_b64 s[80:81], s[80:81], s[52:53]
    s_not_b64 vcc, s[52:53]
    s_mov_b64 exec, -1
    v_cndmask_b32_dpp v84, v84, v84, vcc wave_shr:1 row_mask:0xf bank_mask:0xf
    v_cndmask_b32_dpp v85, v85, v85, vcc wave_shr:1 row_mask:0xf bank_mask:0xf
    s_lshr_b64 s[52:53], s[52:53], 1
    v_cndmask_b32_dpp v86, v86, v86, vcc wave_shr:1 row_mask:0xf bank_mask:0xf
    v_cndmask_b32_dpp v87, v87, v87, vcc wave_shr:1 row_mask:0xf bank_mask:0xf
    s_andn2_b64 s[82:83], s[82:83], s[52:53]
    v_cndmask_b32_dpp v7, v7, v7, vcc wave_shr:1 row_mask:0xf bank_mask:0xf
    s_mov_b64 exec, s[50:51]
    s_cbranch_scc0 L2_d127
    s_mov_b64 exec, s[82:83]
    s_nop 1
    v_mfma_f32_4x4x4_16b_bf16 v[88:91], v[12:13], v[84:85], 0
    s_nop 1
    v_mfma_f32_4x4x4_16b_bf16 v[88:91], v[10:11], v[86:87], v[88:91]
    s_nop 4
    v_cvt_pk_bf16_f32 v88, v88, v89
    v_cvt_pk_bf16_f32 v89, v90, v91
    ds_pk_add_bf16 v7, v88 offset:65408
    ds_pk_add_bf16 v7, v89 offset:65412
    s_mov_b64 exec, s[50:51]
    s_branch L2_d127
L2_c128:
    s_lshl_b64 s[52:53], s[82:83], 1
    s_andn2_b64 s[52:53], s[52:53], s[80:81]
    s_andn2_b64 s[52:53], s[52:53], s[54:55]
    s_or_b64 s[80:81], s[80:81], s[52:53]
    s_not_b64 vcc, s[52:53]
    s_mov_b64 exec, -1
    v_cndmask_b32_dpp v84, v84, v84, vcc wave_shr:1 row_mask:0xf bank_mask:0xf
    v_cndmask_b32_dpp v85, v85, v85, vcc wave_shr:1 row_mask:0xf bank_mask:0xf
    s_lshr_b64 s[52:53], s[52:53], 1
    v_cndmask_b32_dpp v86, v86, v86, vcc wave_shr:1 row_mask:0xf bank_mask:0xf
    v_cndmask_b32_dpp v87, v87, v87, vcc wave_shr:1 row_mask:0xf bank_mask:0xf
    s_andn2_b64 s[82:83], s[82:83], s[52:53]
    v_cndmask_b32_dpp v7, v7, v7, vcc wave_shr:1 row_mask:0xf bank_mask:0xf
    s_mov_b64 exec, s[54:55]
    s_cbranch_scc0 L2_d128
    s_mov_b64 exec, s[82:83]
    s_nop 1
    v_mfma_f32_4x4x4_16b_bf16 v[88:91], v[12:13], v[84:85], 0
    s_nop 1
    v_mfma_f32_4x4x4_16b_bf16 v[88:91], v[10:11], v[86:87], v[88:91]
    s_nop 4
    v_cvt_pk_bf16_f32 v88, v88, v89
    v_cvt_pk_bf16_f32 v89, v90, v91
    ds_pk_add_bf16 v7, v88 offset:65408
    ds_pk_add_bf16 v7, v89 offset:65412
    s_mov_b64 exec, s[54:55]
    s_branch L2_d128
L2_c129:
    s_lshl_b64 s[52:53], s[82:83], 1
    s_andn2_b64 s[52:53], s[52:53], s[80:81]
    s_andn2_b64 s[52:53], s[52:53], s[50:51]
    s_or_b64 s[80:81], s[80:81], s[52:53]
    s_not_b64 vcc, s[52:53]
    s_mov_b64 exec, -1
    v_cndmask_b32_dpp v84, v84, v84, vcc wave_shr:1 row_mask:0xf bank_mask:0xf
    v_cndmask_b32_dpp v85, v85, v85, vcc wave_shr:1 row_mask:0xf bank_mask:0xf
    s_lshr_b64 s[52:53], s[52:53], 1
    v_cndmask_b32_dpp v86, v86, v86, vcc wave_shr:1 row_mask:0xf bank_mask:0xf
    v_cndmask_b32_dpp v87, v87, v87, vcc wave_shr:1 row_mask:0xf bank_mask:0xf
    s_andn2_b64 s[82:83], s[82:83], s[52:53]
    v_cndmask_b32_dpp v7, v7, v7, vcc wave_shr:1 row_mask:0xf bank_mask:0xf
    s_mov_b64 exec, s[50:51]
    s_cbranch_scc0 L2_d129
    s_mov_b64 exec, s[82:83]
    s_nop 1
    v_mfma_f32_4x4x4_16b_bf16 v[88:91], v[12:13], v[84:85], 0
    s_nop 1
    v_mfma_f32_4x4x4_16b_bf16 v[88:91], v[10:11], v[86:87], v[88:91]
    s_nop 4
    v_cvt_pk_bf16_f32 v88, v88, v89
    v_cvt_pk_bf16_f32 v89, v90, v91
    ds_pk_add_bf16 v7, v88 offset:65408
    ds_pk_add_bf16 v7, v89 offset:65412
    s_mov_b64 exec, s[50:51]
    s_branch L2_d129
L2_c130:
    s_lshl_b64 s[52:53], s[82:83], 1
    s_andn2_b64 s[52:53], s[52:53], s[80:81]
    s_andn2_b64 s[52:53], s[52:53], s[54:55]
    s_or_b64 s[80:81], s[80:81], s[52:53]
    s_not_b64 vcc, s[52:53]
    s_mov_b64 exec, -1
    v_cndmask_b32_dpp v84, v84, v84, vcc wave_shr:1 row_mask:0xf bank_mask:0xf
    v_cndmask_b32_dpp v85, v85, v85, vcc wave_shr:1 row_mask:0xf bank_mask:0xf
    s_lshr_b64 s[52:53], s[52:53], 1
    v_cndmask_b32_dpp v86, v86, v86, vcc wave_shr:1 row_mask:0xf bank_mask:0xf
    v_cndmask_b32_dpp v87, v87, v87, vcc wave_shr:1 row_mask:0xf bank_mask:0xf
    s_andn2_b64 s[82:83], s[82:83], s[52:53]
    v_cndmask_b32_dpp v7, v7, v7, vcc wave_shr:1 row_mask:0xf bank_mask:0xf
    s_mov_b64 exec, s[54:55]
    s_cbranch_scc0 L2_d130
    s_mov_b64 exec, s[82:83]
    s_nop 1
    v_mfma_f32_4x4x4_16b_bf16 v[88:91], v[12:13], v[84:85], 0
    s_nop 1
    v_mfma_f32_4x4x4_16b_bf16 v[88:91], v[10:11], v[86:87], v[88:91]
    s_nop 4
    v_cvt_pk_bf16_f32 v88, v88, v89
    v_cvt_pk_bf16_f32 v89, v90, v91
    ds_pk_add_bf16 v7, v88 offset:65408
    ds_pk_add_bf16 v7, v89 offset:65412
    s_mov_b64 exec, s[54:55]
    s_branch L2_d130
L2_c131:
    s_lshl_b64 s[52:53], s[82:83], 1
    s_andn2_b64 s[52:53], s[52:53], s[80:81]
    s_andn2_b64 s[52:53], s[52:53], s[50:51]
    s_or_b64 s[80:81], s[80:81], s[52:53]
    s_not_b64 vcc, s[52:53]
    s_mov_b64 exec, -1
    v_cndmask_b32_dpp v84, v84, v84, vcc wave_shr:1 row_mask:0xf bank_mask:0xf
    v_cndmask_b32_dpp v85, v85, v85, vcc wave_shr:1 row_mask:0xf bank_mask:0xf
    s_lshr_b64 s[52:53], s[52:53], 1
    v_cndmask_b32_dpp v86, v86, v86, vcc wave_shr:1 row_mask:0xf bank_mask:0xf
    v_cndmask_b32_dpp v87, v87, v87, vcc wave_shr:1 row_mask:0xf bank_mask:0xf
    s_andn2_b64 s[82:83], s[82:83], s[52:53]
    v_cndmask_b32_dpp v7, v7, v7, vcc wave_shr:1 row_mask:0xf bank_mask:0xf
    s_mov_b64 exec, s[50:51]
    s_cbranch_scc0 L2_d131
    s_mov_b64 exec, s[82:83]
    s_nop 1
    v_mfma_f32_4x4x4_16b_bf16 v[88:91], v[12:13], v[84:85], 0
    s_nop 1
    v_mfma_f32_4x4x4_16b_bf16 v[88:91], v[10:11], v[86:87], v[88:91]
    s_nop 4
    v_cvt_pk_bf16_f32 v88, v88, v89
    v_cvt_pk_bf16_f32 v89, v90, v91
    ds_pk_add_bf16 v7, v88 offset:65408
    ds_pk_add_bf16 v7, v89 offset:65412
    s_mov_b64 exec, s[50:51]
    s_branch L2_d131
L2_c132:
    s_lshl_b64 s[52:53], s[82:83], 1
    s_andn2_b64 s[52:53], s[52:53], s[80:81]
    s_andn2_b64 s[52:53], s[52:53], s[54:55]
    s_or_b64 s[80:81], s[80:81], s[52:53]
    s_not_b64 vcc, s[52:53]
    s_mov_b64 exec, -1
    v_cndmask_b32_dpp v84, v84, v84, vcc wave_shr:1 row_mask:0xf bank_mask:0xf
    v_cndmask_b32_dpp v85, v85, v85, vcc wave_shr:1 row_mask:0xf bank_mask:0xf
    s_lshr_b64 s[52:53], s[52:53], 1
    v_cndmask_b32_dpp v86, v86, v86, vcc wave_shr:1 row_mask:0xf bank_mask:0xf
    v_cndmask_b32_dpp v87, v87, v87, vcc wave_shr:1 row_mask:0xf bank_mask:0xf
    s_andn2_b64 s[82:83], s[82:83], s[52:53]
    v_cndmask_b32_dpp v7, v7, v7, vcc wave_shr:1 row_mask:0xf bank_mask:0xf
    s_mov_b64 exec, s[54:55]
    s_cbranch_scc0 L2_d132
    s_mov_b64 exec, s[82:83]
    s_nop 1
    v_mfma_f32_4x4x4_16b_bf16 v[88:91], v[12:13], v[84:85], 0
    s_nop 1
    v_mfma_f32_4x4x4_16b_bf16 v[88:91], v[10:11], v[86:87], v[88:91]
    s_nop 4
    v_cvt_pk_bf16_f32 v88, v88, v89
    v_cvt_pk_bf16_f32 v89, v90, v91
    ds_pk_add_bf16 v7, v88 offset:65408
    ds_pk_add_bf16 v7, v89 offset:65412
    s_mov_b64 exec, s[54:55]
    s_branch L2_d132
L2_c133:
    s_lshl_b64 s[52:53], s[82:83], 1
    s_andn2_b64 s[52:53], s[52:53], s[80:81]
    s_andn2_b64 s[52:53], s[52:53], s[50:51]
    s_or_b64 s[80:81], s[80:81], s[52:53]
    s_not_b64 vcc, s[52:53]
    s_mov_b64 exec, -1
    v_cndmask_b32_dpp v84, v84, v84, vcc wave_shr:1 row_mask:0xf bank_mask:0xf
    v_cndmask_b32_dpp v85, v85, v85, vcc wave_shr:1 row_mask:0xf bank_mask:0xf
    s_lshr_b64 s[52:53], s[52:53], 1
    v_cndmask_b32_dpp v86, v86, v86, vcc wave_shr:1 row_mask:0xf bank_mask:0xf
    v_cndmask_b32_dpp v87, v87, v87, vcc wave_shr:1 row_mask:0xf bank_mask:0xf
    s_andn2_b64 s[82:83], s[82:83], s[52:53]
    v_cndmask_b32_dpp v7, v7, v7, vcc wave_shr:1 row_mask:0xf bank_mask:0xf
    s_mov_b64 exec, s[50:51]
    s_cbranch_scc0 L2_d133
    s_mov_b64 exec, s[82:83]
    s_nop 1
    v_mfma_f32_4x4x4_16b_bf16 v[88:91], v[12:13], v[84:85], 0
    s_nop 1
    v_mfma_f32_4x4x4_16b_bf16 v[88:91], v[10:11], v[86:87], v[88:91]
    s_nop 4
    v_cvt_pk_bf16_f32 v88, v88, v89
    v_cvt_pk_bf16_f32 v89, v90, v91
    ds_pk_add_bf16 v7, v88 offset:65408
    ds_pk_add_bf16 v7, v89 offset:65412
    s_mov_b64 exec, s[50:51]
    s_branch L2_d133
L2_c134:
    s_lshl_b64 s[52:53], s[82:83], 1
    s_andn2_b64 s[52:53], s[52:53], s[80:81]
    s_andn2_b64 s[52:53], s[52:53], s[54:55]
    s_or_b64 s[80:81], s[80:81], s[52:53]
    s_not_b64 vcc, s[52:53]
    s_mov_b64 exec, -1
    v_cndmask_b32_dpp v84, v84, v84, vcc wave_shr:1 row_mask:0xf bank_mask:0xf
    v_cndmask_b32_dpp v85, v85, v85, vcc wave_shr:1 row_mask:0xf bank_mask:0xf
    s_lshr_b64 s[52:53], s[52:53], 1
    v_cndmask_b32_dpp v86, v86, v86, vcc wave_shr:1 row_mask:0xf bank_mask:0xf
    v_cndmask_b32_dpp v87, v87, v87, vcc wave_shr:1 row_mask:0xf bank_mask:0xf
    s_andn2_b64 s[82:83], s[82:83], s[52:53]
    v_cndmask_b32_dpp v7, v7, v7, vcc wave_shr:1 row_mask:0xf bank_mask:0xf
    s_mov_b64 exec, s[54:55]
    s_cbranch_scc0 L2_d134
    s_mov_b64 exec, s[82:83]
    s_nop 1
    v_mfma_f32_4x4x4_16b_bf16 v[88:91], v[12:13], v[84:85], 0
    s_nop 1
    v_mfma_f32_4x4x4_16b_bf16 v[88:91], v[10:11], v[86:87], v[88:91]
    s_nop 4
    v_cvt_pk_bf16_f32 v88, v88, v89
    v_cvt_pk_bf16_f32 v89, v90, v91
    ds_pk_add_bf16 v7, v88 offset:65408
    ds_pk_add_bf16 v7, v89 offset:65412
    s_mov_b64 exec, s[54:55]
    s_branch L2_d134
L2_c135:
    s_lshl_b64 s[52:53], s[82:83], 1
    s_andn2_b64 s[52:53], s[52:53], s[80:81]
    s_andn2_b64 s[52:53], s[52:53], s[50:51]
    s_or_b64 s[80:81], s[80:81], s[52:53]
    s_not_b64 vcc, s[52:53]
    s_mov_b64 exec, -1
    v_cndmask_b32_dpp v84, v84, v84, vcc wave_shr:1 row_mask:0xf bank_mask:0xf
    v_cndmask_b32_dpp v85, v85, v85, vcc wave_shr:1 row_mask:0xf bank_mask:0xf
    s_lshr_b64 s[52:53], s[52:53], 1
    v_cndmask_b32_dpp v86, v86, v86, vcc wave_shr:1 row_mask:0xf bank_mask:0xf
    v_cndmask_b32_dpp v87, v87, v87, vcc wave_shr:1 row_mask:0xf bank_mask:0xf
    s_andn2_b64 s[82:83], s[82:83], s[52:53]
    v_cndmask_b32_dpp v7, v7, v7, vcc wave_shr:1 row_mask:0xf bank_mask:0xf
    s_mov_b64 exec, s[50:51]
    s_cbranch_scc0 L2_d135
    s_mov_b64 exec, s[82:83]
    s_nop 1
    v_mfma_f32_4x4x4_16b_bf16 v[88:91], v[12:13], v[84:85], 0
    s_nop 1
    v_mfma_f32_4x4x4_16b_bf16 v[88:91], v[10:11], v[86:87], v[88:91]
    s_nop 4
    v_cvt_pk_bf16_f32 v88, v88, v89
    v_cvt_pk_bf16_f32 v89, v90, v91
    ds_pk_add_bf16 v7, v88 offset:65408
    ds_pk_add_bf16 v7, v89 offset:65412
    s_mov_b64 exec, s[50:51]
    s_branch L2_d135
L2_c136:
    s_lshl_b64 s[52:53], s[82:83], 1
    s_andn2_b64 s[52:53], s[52:53], s[80:81]
    s_andn2_b64 s[52:53], s[52:53], s[54:55]
    s_or_b64 s[80:81], s[80:81], s[52:53]
    s_not_b64 vcc, s[52:53]
    s_mov_b64 exec, -1
    v_cndmask_b32_dpp v84, v84, v84, vcc wave_shr:1 row_mask:0xf bank_mask:0xf
    v_cndmask_b32_dpp v85, v85, v85, vcc wave_shr:1 row_mask:0xf bank_mask:0xf
    s_lshr_b64 s[52:53], s[52:53], 1
    v_cndmask_b32_dpp v86, v86, v86, vcc wave_shr:1 row_mask:0xf bank_mask:0xf
    v_cndmask_b32_dpp v87, v87, v87, vcc wave_shr:1 row_mask:0xf bank_mask:0xf
    s_andn2_b64 s[82:83], s[82:83], s[52:53]
    v_cndmask_b32_dpp v7, v7, v7, vcc wave_shr:1 row_mask:0xf bank_mask:0xf
    s_mov_b64 exec, s[54:55]
    s_cbranch_scc0 L2_d136
    s_mov_b64 exec, s[82:83]
    s_nop 1
    v_mfma_f32_4x4x4_16b_bf16 v[88:91], v[12:13], v[84:85], 0
    s_nop 1
    v_mfma_f32_4x4x4_16b_bf16 v[88:91], v[10:11], v[86:87], v[88:91]
    s_nop 4
    v_cvt_pk_bf16_f32 v88, v88, v89
    v_cvt_pk_bf16_f32 v89, v90, v91
    ds_pk_add_bf16 v7, v88 offset:65408
    ds_pk_add_bf16 v7, v89 offset:65412
    s_mov_b64 exec, s[54:55]
    s_branch L2_d136
L2_c137:
    s_lshl_b64 s[52:53], s[82:83], 1
    s_andn2_b64 s[52:53], s[52:53], s[80:81]
    s_andn2_b64 s[52:53], s[52:53], s[50:51]
    s_or_b64 s[80:81], s[80:81], s[52:53]
    s_not_b64 vcc, s[52:53]
    s_mov_b64 exec, -1
    v_cndmask_b32_dpp v84, v84, v84, vcc wave_shr:1 row_mask:0xf bank_mask:0xf
    v_cndmask_b32_dpp v85, v85, v85, vcc wave_shr:1 row_mask:0xf bank_mask:0xf
    s_lshr_b64 s[52:53], s[52:53], 1
    v_cndmask_b32_dpp v86, v86, v86, vcc wave_shr:1 row_mask:0xf bank_mask:0xf
    v_cndmask_b32_dpp v87, v87, v87, vcc wave_shr:1 row_mask:0xf bank_mask:0xf
    s_andn2_b64 s[82:83], s[82:83], s[52:53]
    v_cndmask_b32_dpp v7, v7, v7, vcc wave_shr:1 row_mask:0xf bank_mask:0xf
    s_mov_b64 exec, s[50:51]
    s_cbranch_scc0 L2_d137
    s_mov_b64 exec, s[82:83]
    s_nop 1
    v_mfma_f32_4x4x4_16b_bf16 v[88:91], v[12:13], v[84:85], 0
    s_nop 1
    v_mfma_f32_4x4x4_16b_bf16 v[88:91], v[10:11], v[86:87], v[88:91]
    s_nop 4
    v_cvt_pk_bf16_f32 v88, v88, v89
    v_cvt_pk_bf16_f32 v89, v90, v91
    ds_pk_add_bf16 v7, v88 offset:65408
    ds_pk_add_bf16 v7, v89 offset:65412
    s_mov_b64 exec, s[50:51]
    s_branch L2_d137
L2_c138:
    s_lshl_b64 s[52:53], s[82:83], 1
    s_andn2_b64 s[52:53], s[52:53], s[80:81]
    s_andn2_b64 s[52:53], s[52:53], s[54:55]
    s_or_b64 s[80:81], s[80:81], s[52:53]
    s_not_b64 vcc, s[52:53]
    s_mov_b64 exec, -1
    v_cndmask_b32_dpp v84, v84, v84, vcc wave_shr:1 row_mask:0xf bank_mask:0xf
    v_cndmask_b32_dpp v85, v85, v85, vcc wave_shr:1 row_mask:0xf bank_mask:0xf
    s_lshr_b64 s[52:53], s[52:53], 1
    v_cndmask_b32_dpp v86, v86, v86, vcc wave_shr:1 row_mask:0xf bank_mask:0xf
    v_cndmask_b32_dpp v87, v87, v87, vcc wave_shr:1 row_mask:0xf bank_mask:0xf
    s_andn2_b64 s[82:83], s[82:83], s[52:53]
    v_cndmask_b32_dpp v7, v7, v7, vcc wave_shr:1 row_mask:0xf bank_mask:0xf
    s_mov_b64 exec, s[54:55]
    s_cbranch_scc0 L2_d138
    s_mov_b64 exec, s[82:83]
    s_nop 1
    v_mfma_f32_4x4x4_16b_bf16 v[88:91], v[12:13], v[84:85], 0
    s_nop 1
    v_mfma_f32_4x4x4_16b_bf16 v[88:91], v[10:11], v[86:87], v[88:91]
    s_nop 4
    v_cvt_pk_bf16_f32 v88, v88, v89
    v_cvt_pk_bf16_f32 v89, v90, v91
    ds_pk_add_bf16 v7, v88 offset:65408
    ds_pk_add_bf16 v7, v89 offset:65412
    s_mov_b64 exec, s[54:55]
    s_branch L2_d138
L2_c139:
    s_lshl_b64 s[52:53], s[82:83], 1
    s_andn2_b64 s[52:53], s[52:53], s[80:81]
    s_andn2_b64 s[52:53], s[52:53], s[50:51]
    s_or_b64 s[80:81], s[80:81], s[52:53]
    s_not_b64 vcc, s[52:53]
    s_mov_b64 exec, -1
    v_cndmask_b32_dpp v84, v84, v84, vcc wave_shr:1 row_mask:0xf bank_mask:0xf
    v_cndmask_b32_dpp v85, v85, v85, vcc wave_shr:1 row_mask:0xf bank_mask:0xf
    s_lshr_b64 s[52:53], s[52:53], 1
    v_cndmask_b32_dpp v86, v86, v86, vcc wave_shr:1 row_mask:0xf bank_mask:0xf
    v_cndmask_b32_dpp v87, v87, v87, vcc wave_shr:1 row_mask:0xf bank_mask:0xf
    s_andn2_b64 s[82:83], s[82:83], s[52:53]
    v_cndmask_b32_dpp v7, v7, v7, vcc wave_shr:1 row_mask:0xf bank_mask:0xf
    s_mov_b64 exec, s[50:51]
    s_cbranch_scc0 L2_d139
    s_mov_b64 exec, s[82:83]
    s_nop 1
    v_mfma_f32_4x4x4_16b_bf16 v[88:91], v[12:13], v[84:85], 0
    s_nop 1
    v_mfma_f32_4x4x4_16b_bf16 v[88:91], v[10:11], v[86:87], v[88:91]
    s_nop 4
    v_cvt_pk_bf16_f32 v88, v88, v89
    v_cvt_pk_bf16_f32 v89, v90, v91
    ds_pk_add_bf16 v7, v88 offset:65408
    ds_pk_add_bf16 v7, v89 offset:65412
    s_mov_b64 exec, s[50:51]
    s_branch L2_d139
L2_c140:
    s_lshl_b64 s[52:53], s[82:83], 1
    s_andn2_b64 s[52:53], s[52:53], s[80:81]
    s_andn2_b64 s[52:53], s[52:53], s[54:55]
    s_or_b64 s[80:81], s[80:81], s[52:53]
    s_not_b64 vcc, s[52:53]
    s_mov_b64 exec, -1
    v_cndmask_b32_dpp v84, v84, v84, vcc wave_shr:1 row_mask:0xf bank_mask:0xf
    v_cndmask_b32_dpp v85, v85, v85, vcc wave_shr:1 row_mask:0xf bank_mask:0xf
    s_lshr_b64 s[52:53], s[52:53], 1
    v_cndmask_b32_dpp v86, v86, v86, vcc wave_shr:1 row_mask:0xf bank_mask:0xf
    v_cndmask_b32_dpp v87, v87, v87, vcc wave_shr:1 row_mask:0xf bank_mask:0xf
    s_andn2_b64 s[82:83], s[82:83], s[52:53]
    v_cndmask_b32_dpp v7, v7, v7, vcc wave_shr:1 row_mask:0xf bank_mask:0xf
    s_mov_b64 exec, s[54:55]
    s_cbranch_scc0 L2_d140
    s_mov_b64 exec, s[82:83]
    s_nop 1
    v_mfma_f32_4x4x4_16b_bf16 v[88:91], v[12:13], v[84:85], 0
    s_nop 1
    v_mfma_f32_4x4x4_16b_bf16 v[88:91], v[10:11], v[86:87], v[88:91]
    s_nop 4
    v_cvt_pk_bf16_f32 v88, v88, v89
    v_cvt_pk_bf16_f32 v89, v90, v91
    ds_pk_add_bf16 v7, v88 offset:65408
    ds_pk_add_bf16 v7, v89 offset:65412
    s_mov_b64 exec, s[54:55]
    s_branch L2_d140
L2_c141:
    s_lshl_b64 s[52:53], s[82:83], 1
    s_andn2_b64 s[52:53], s[52:53], s[80:81]
    s_andn2_b64 s[52:53], s[52:53], s[50:51]
    s_or_b64 s[80:81], s[80:81], s[52:53]
    s_not_b64 vcc, s[52:53]
    s_mov_b64 exec, -1
    v_cndmask_b32_dpp v84, v84, v84, vcc wave_shr:1 row_mask:0xf bank_mask:0xf
    v_cndmask_b32_dpp v85, v85, v85, vcc wave_shr:1 row_mask:0xf bank_mask:0xf
    s_lshr_b64 s[52:53], s[52:53], 1
    v_cndmask_b32_dpp v86, v86, v86, vcc wave_shr:1 row_mask:0xf bank_mask:0xf
    v_cndmask_b32_dpp v87, v87, v87, vcc wave_shr:1 row_mask:0xf bank_mask:0xf
    s_andn2_b64 s[82:83], s[82:83], s[52:53]
    v_cndmask_b32_dpp v7, v7, v7, vcc wave_shr:1 row_mask:0xf bank_mask:0xf
    s_mov_b64 exec, s[50:51]
    s_cbranch_scc0 L2_d141
    s_mov_b64 exec, s[82:83]
    s_nop 1
    v_mfma_f32_4x4x4_16b_bf16 v[88:91], v[12:13], v[84:85], 0
    s_nop 1
    v_mfma_f32_4x4x4_16b_bf16 v[88:91], v[10:11], v[86:87], v[88:91]
    s_nop 4
    v_cvt_pk_bf16_f32 v88, v88, v89
    v_cvt_pk_bf16_f32 v89, v90, v91
    ds_pk_add_bf16 v7, v88 offset:65408
    ds_pk_add_bf16 v7, v89 offset:65412
    s_mov_b64 exec, s[50:51]
    s_branch L2_d141
L2_c142:
    s_lshl_b64 s[52:53], s[82:83], 1
    s_andn2_b64 s[52:53], s[52:53], s[80:81]
    s_andn2_b64 s[52:53], s[52:53], s[54:55]
    s_or_b64 s[80:81], s[80:81], s[52:53]
    s_not_b64 vcc, s[52:53]
    s_mov_b64 exec, -1
    v_cndmask_b32_dpp v84, v84, v84, vcc wave_shr:1 row_mask:0xf bank_mask:0xf
    v_cndmask_b32_dpp v85, v85, v85, vcc wave_shr:1 row_mask:0xf bank_mask:0xf
    s_lshr_b64 s[52:53], s[52:53], 1
    v_cndmask_b32_dpp v86, v86, v86, vcc wave_shr:1 row_mask:0xf bank_mask:0xf
    v_cndmask_b32_dpp v87, v87, v87, vcc wave_shr:1 row_mask:0xf bank_mask:0xf
    s_andn2_b64 s[82:83], s[82:83], s[52:53]
    v_cndmask_b32_dpp v7, v7, v7, vcc wave_shr:1 row_mask:0xf bank_mask:0xf
    s_mov_b64 exec, s[54:55]
    s_cbranch_scc0 L2_d142
    s_mov_b64 exec, s[82:83]
    s_nop 1
    v_mfma_f32_4x4x4_16b_bf16 v[88:91], v[12:13], v[84:85], 0
    s_nop 1
    v_mfma_f32_4x4x4_16b_bf16 v[88:91], v[10:11], v[86:87], v[88:91]
    s_nop 4
    v_cvt_pk_bf16_f32 v88, v88, v89
    v_cvt_pk_bf16_f32 v89, v90, v91
    ds_pk_add_bf16 v7, v88 offset:65408
    ds_pk_add_bf16 v7, v89 offset:65412
    s_mov_b64 exec, s[54:55]
    s_branch L2_d142
L2_c143:
    s_lshl_b64 s[52:53], s[82:83], 1
    s_andn2_b64 s[52:53], s[52:53], s[80:81]
    s_andn2_b64 s[52:53], s[52:53], s[50:51]
    s_or_b64 s[80:81], s[80:81], s[52:53]
    s_not_b64 vcc, s[52:53]
    s_mov_b64 exec, -1
    v_cndmask_b32_dpp v84, v84, v84, vcc wave_shr:1 row_mask:0xf bank_mask:0xf
    v_cndmask_b32_dpp v85, v85, v85, vcc wave_shr:1 row_mask:0xf bank_mask:0xf
    s_lshr_b64 s[52:53], s[52:53], 1
    v_cndmask_b32_dpp v86, v86, v86, vcc wave_shr:1 row_mask:0xf bank_mask:0xf
    v_cndmask_b32_dpp v87, v87, v87, vcc wave_shr:1 row_mask:0xf bank_mask:0xf
    s_andn2_b64 s[82:83], s[82:83], s[52:53]
    v_cndmask_b32_dpp v7, v7, v7, vcc wave_shr:1 row_mask:0xf bank_mask:0xf
    s_mov_b64 exec, s[50:51]
    s_cbranch_scc0 L2_d143
    s_mov_b64 exec, s[82:83]
    s_nop 1
    v_mfma_f32_4x4x4_16b_bf16 v[88:91], v[12:13], v[84:85], 0
    s_nop 1
    v_mfma_f32_4x4x4_16b_bf16 v[88:91], v[10:11], v[86:87], v[88:91]
    s_nop 4
    v_cvt_pk_bf16_f32 v88, v88, v89
    v_cvt_pk_bf16_f32 v89, v90, v91
    ds_pk_add_bf16 v7, v88 offset:65408
    ds_pk_add_bf16 v7, v89 offset:65412
    s_mov_b64 exec, s[50:51]
    s_branch L2_d143
L2_c144:
    s_lshl_b64 s[52:53], s[82:83], 1
    s_andn2_b64 s[52:53], s[52:53], s[80:81]
    s_andn2_b64 s[52:53], s[52:53], s[54:55]
    s_or_b64 s[80:81], s[80:81], s[52:53]
    s_not_b64 vcc, s[52:53]
    s_mov_b64 exec, -1
    v_cndmask_b32_dpp v84, v84, v84, vcc wave_shr:1 row_mask:0xf bank_mask:0xf
    v_cndmask_b32_dpp v85, v85, v85, vcc wave_shr:1 row_mask:0xf bank_mask:0xf
    s_lshr_b64 s[52:53], s[52:53], 1
    v_cndmask_b32_dpp v86, v86, v86, vcc wave_shr:1 row_mask:0xf bank_mask:0xf
    v_cndmask_b32_dpp v87, v87, v87, vcc wave_shr:1 row_mask:0xf bank_mask:0xf
    s_andn2_b64 s[82:83], s[82:83], s[52:53]
    v_cndmask_b32_dpp v7, v7, v7, vcc wave_shr:1 row_mask:0xf bank_mask:0xf
    s_mov_b64 exec, s[54:55]
    s_cbranch_scc0 L2_d144
    s_mov_b64 exec, s[82:83]
    s_nop 1
    v_mfma_f32_4x4x4_16b_bf16 v[88:91], v[12:13], v[84:85], 0
    s_nop 1
    v_mfma_f32_4x4x4_16b_bf16 v[88:91], v[10:11], v[86:87], v[88:91]
    s_nop 4
    v_cvt_pk_bf16_f32 v88, v88, v89
    v_cvt_pk_bf16_f32 v89, v90, v91
    ds_pk_add_bf16 v7, v88 offset:65408
    ds_pk_add_bf16 v7, v89 offset:65412
    s_mov_b64 exec, s[54:55]
    s_branch L2_d144
L2_c145:
    s_lshl_b64 s[52:53], s[82:83], 1
    s_andn2_b64 s[52:53], s[52:53], s[80:81]
    s_andn2_b64 s[52:53], s[52:53], s[50:51]
    s_or_b64 s[80:81], s[80:81], s[52:53]
    s_not_b64 vcc, s[52:53]
    s_mov_b64 exec, -1
    v_cndmask_b32_dpp v84, v84, v84, vcc wave_shr:1 row_mask:0xf bank_mask:0xf
    v_cndmask_b32_dpp v85, v85, v85, vcc wave_shr:1 row_mask:0xf bank_mask:0xf
    s_lshr_b64 s[52:53], s[52:53], 1
    v_cndmask_b32_dpp v86, v86, v86, vcc wave_shr:1 row_mask:0xf bank_mask:0xf
    v_cndmask_b32_dpp v87, v87, v87, vcc wave_shr:1 row_mask:0xf bank_mask:0xf
    s_andn2_b64 s[82:83], s[82:83], s[52:53]
    v_cndmask_b32_dpp v7, v7, v7, vcc wave_shr:1 row_mask:0xf bank_mask:0xf
    s_mov_b64 exec, s[50:51]
    s_cbranch_scc0 L2_d145
    s_mov_b64 exec, s[82:83]
    s_nop 1
    v_mfma_f32_4x4x4_16b_bf16 v[88:91], v[12:13], v[84:85], 0
    s_nop 1
    v_mfma_f32_4x4x4_16b_bf16 v[88:91], v[10:11], v[86:87], v[88:91]
    s_nop 4
    v_cvt_pk_bf16_f32 v88, v88, v89
    v_cvt_pk_bf16_f32 v89, v90, v91
    ds_pk_add_bf16 v7, v88 offset:65408
    ds_pk_add_bf16 v7, v89 offset:65412
    s_mov_b64 exec, s[50:51]
    s_branch L2_d145
L2_c146:
    s_lshl_b64 s[52:53], s[82:83], 1
    s_andn2_b64 s[52:53], s[52:53], s[80:81]
    s_andn2_b64 s[52:53], s[52:53], s[54:55]
    s_or_b64 s[80:81], s[80:81], s[52:53]
    s_not_b64 vcc, s[52:53]
    s_mov_b64 exec, -1
    v_cndmask_b32_dpp v84, v84, v84, vcc wave_shr:1 row_mask:0xf bank_mask:0xf
    v_cndmask_b32_dpp v85, v85, v85, vcc wave_shr:1 row_mask:0xf bank_mask:0xf
    s_lshr_b64 s[52:53], s[52:53], 1
    v_cndmask_b32_dpp v86, v86, v86, vcc wave_shr:1 row_mask:0xf bank_mask:0xf
    v_cndmask_b32_dpp v87, v87, v87, vcc wave_shr:1 row_mask:0xf bank_mask:0xf
    s_andn2_b64 s[82:83], s[82:83], s[52:53]
    v_cndmask_b32_dpp v7, v7, v7, vcc wave_shr:1 row_mask:0xf bank_mask:0xf
    s_mov_b64 exec, s[54:55]
    s_cbranch_scc0 L2_d146
    s_mov_b64 exec, s[82:83]
    s_nop 1
    v_mfma_f32_4x4x4_16b_bf16 v[88:91], v[12:13], v[84:85], 0
    s_nop 1
    v_mfma_f32_4x4x4_16b_bf16 v[88:91], v[10:11], v[86:87], v[88:91]
    s_nop 4
    v_cvt_pk_bf16_f32 v88, v88, v89
    v_cvt_pk_bf16_f32 v89, v90, v91
    ds_pk_add_bf16 v7, v88 offset:65408
    ds_pk_add_bf16 v7, v89 offset:65412
    s_mov_b64 exec, s[54:55]
    s_branch L2_d146
L2_c147:
    s_lshl_b64 s[52:53], s[82:83], 1
    s_andn2_b64 s[52:53], s[52:53], s[80:81]
    s_andn2_b64 s[52:53], s[52:53], s[50:51]
    s_or_b64 s[80:81], s[80:81], s[52:53]
    s_not_b64 vcc, s[52:53]
    s_mov_b64 exec, -1
    v_cndmask_b32_dpp v84, v84, v84, vcc wave_shr:1 row_mask:0xf bank_mask:0xf
    v_cndmask_b32_dpp v85, v85, v85, vcc wave_shr:1 row_mask:0xf bank_mask:0xf
    s_lshr_b64 s[52:53], s[52:53], 1
    v_cndmask_b32_dpp v86, v86, v86, vcc wave_shr:1 row_mask:0xf bank_mask:0xf
    v_cndmask_b32_dpp v87, v87, v87, vcc wave_shr:1 row_mask:0xf bank_mask:0xf
    s_andn2_b64 s[82:83], s[82:83], s[52:53]
    v_cndmask_b32_dpp v7, v7, v7, vcc wave_shr:1 row_mask:0xf bank_mask:0xf
    s_mov_b64 exec, s[50:51]
    s_cbranch_scc0 L2_d147
    s_mov_b64 exec, s[82:83]
    s_nop 1
    v_mfma_f32_4x4x4_16b_bf16 v[88:91], v[12:13], v[84:85], 0
    s_nop 1
    v_mfma_f32_4x4x4_16b_bf16 v[88:91], v[10:11], v[86:87], v[88:91]
    s_nop 4
    v_cvt_pk_bf16_f32 v88, v88, v89
    v_cvt_pk_bf16_f32 v89, v90, v91
    ds_pk_add_bf16 v7, v88 offset:65408
    ds_pk_add_bf16 v7, v89 offset:65412
    s_mov_b64 exec, s[50:51]
    s_branch L2_d147
L2_c148:
    s_lshl_b64 s[52:53], s[82:83], 1
    s_andn2_b64 s[52:53], s[52:53], s[80:81]
    s_andn2_b64 s[52:53], s[52:53], s[54:55]
    s_or_b64 s[80:81], s[80:81], s[52:53]
    s_not_b64 vcc, s[52:53]
    s_mov_b64 exec, -1
    v_cndmask_b32_dpp v84, v84, v84, vcc wave_shr:1 row_mask:0xf bank_mask:0xf
    v_cndmask_b32_dpp v85, v85, v85, vcc wave_shr:1 row_mask:0xf bank_mask:0xf
    s_lshr_b64 s[52:53], s[52:53], 1
    v_cndmask_b32_dpp v86, v86, v86, vcc wave_shr:1 row_mask:0xf bank_mask:0xf
    v_cndmask_b32_dpp v87, v87, v87, vcc wave_shr:1 row_mask:0xf bank_mask:0xf
    s_andn2_b64 s[82:83], s[82:83], s[52:53]
    v_cndmask_b32_dpp v7, v7, v7, vcc wave_shr:1 row_mask:0xf bank_mask:0xf
    s_mov_b64 exec, s[54:55]
    s_cbranch_scc0 L2_d148
    s_mov_b64 exec, s[82:83]
    s_nop 1
    v_mfma_f32_4x4x4_16b_bf16 v[88:91], v[12:13], v[84:85], 0
    s_nop 1
    v_mfma_f32_4x4x4_16b_bf16 v[88:91], v[10:11], v[86:87], v[88:91]
    s_nop 4
    v_cvt_pk_bf16_f32 v88, v88, v89
    v_cvt_pk_bf16_f32 v89, v90, v91
    ds_pk_add_bf16 v7, v88 offset:65408
    ds_pk_add_bf16 v7, v89 offset:65412
    s_mov_b64 exec, s[54:55]
    s_branch L2_d148
L2_c149:
    s_lshl_b64 s[52:53], s[82:83], 1
    s_andn2_b64 s[52:53], s[52:53], s[80:81]
    s_andn2_b64 s[52:53], s[52:53], s[50:51]
    s_or_b64 s[80:81], s[80:81], s[52:53]
    s_not_b64 vcc, s[52:53]
    s_mov_b64 exec, -1
    v_cndmask_b32_dpp v84, v84, v84, vcc wave_shr:1 row_mask:0xf bank_mask:0xf
    v_cndmask_b32_dpp v85, v85, v85, vcc wave_shr:1 row_mask:0xf bank_mask:0xf
    s_lshr_b64 s[52:53], s[52:53], 1
    v_cndmask_b32_dpp v86, v86, v86, vcc wave_shr:1 row_mask:0xf bank_mask:0xf
    v_cndmask_b32_dpp v87, v87, v87, vcc wave_shr:1 row_mask:0xf bank_mask:0xf
    s_andn2_b64 s[82:83], s[82:83], s[52:53]
    v_cndmask_b32_dpp v7, v7, v7, vcc wave_shr:1 row_mask:0xf bank_mask:0xf
    s_mov_b64 exec, s[50:51]
    s_cbranch_scc0 L2_d149
    s_mov_b64 exec, s[82:83]
    s_nop 1
    v_mfma_f32_4x4x4_16b_bf16 v[88:91], v[12:13], v[84:85], 0
    s_nop 1
    v_mfma_f32_4x4x4_16b_bf16 v[88:91], v[10:11], v[86:87], v[88:91]
    s_nop 4
    v_cvt_pk_bf16_f32 v88, v88, v89
    v_cvt_pk_bf16_f32 v89, v90, v91
    ds_pk_add_bf16 v7, v88 offset:65408
    ds_pk_add_bf16 v7, v89 offset:65412
    s_mov_b64 exec, s[50:51]
    s_branch L2_d149
L2_c150:
    s_lshl_b64 s[52:53], s[82:83], 1
    s_andn2_b64 s[52:53], s[52:53], s[80:81]
    s_andn2_b64 s[52:53], s[52:53], s[54:55]
    s_or_b64 s[80:81], s[80:81], s[52:53]
    s_not_b64 vcc, s[52:53]
    s_mov_b64 exec, -1
    v_cndmask_b32_dpp v84, v84, v84, vcc wave_shr:1 row_mask:0xf bank_mask:0xf
    v_cndmask_b32_dpp v85, v85, v85, vcc wave_shr:1 row_mask:0xf bank_mask:0xf
    s_lshr_b64 s[52:53], s[52:53], 1
    v_cndmask_b32_dpp v86, v86, v86, vcc wave_shr:1 row_mask:0xf bank_mask:0xf
    v_cndmask_b32_dpp v87, v87, v87, vcc wave_shr:1 row_mask:0xf bank_mask:0xf
    s_andn2_b64 s[82:83], s[82:83], s[52:53]
    v_cndmask_b32_dpp v7, v7, v7, vcc wave_shr:1 row_mask:0xf bank_mask:0xf
    s_mov_b64 exec, s[54:55]
    s_cbranch_scc0 L2_d150
    s_mov_b64 exec, s[82:83]
    s_nop 1
    v_mfma_f32_4x4x4_16b_bf16 v[88:91], v[12:13], v[84:85], 0
    s_nop 1
    v_mfma_f32_4x4x4_16b_bf16 v[88:91], v[10:11], v[86:87], v[88:91]
    s_nop 4
    v_cvt_pk_bf16_f32 v88, v88, v89
    v_cvt_pk_bf16_f32 v89, v90, v91
    ds_pk_add_bf16 v7, v88 offset:65408
    ds_pk_add_bf16 v7, v89 offset:65412
    s_mov_b64 exec, s[54:55]
    s_branch L2_d150
L2_c151:
    s_lshl_b64 s[52:53], s[82:83], 1
    s_andn2_b64 s[52:53], s[52:53], s[80:81]
    s_andn2_b64 s[52:53], s[52:53], s[50:51]
    s_or_b64 s[80:81], s[80:81], s[52:53]
    s_not_b64 vcc, s[52:53]
    s_mov_b64 exec, -1
    v_cndmask_b32_dpp v84, v84, v84, vcc wave_shr:1 row_mask:0xf bank_mask:0xf
    v_cndmask_b32_dpp v85, v85, v85, vcc wave_shr:1 row_mask:0xf bank_mask:0xf
    s_lshr_b64 s[52:53], s[52:53], 1
    v_cndmask_b32_dpp v86, v86, v86, vcc wave_shr:1 row_mask:0xf bank_mask:0xf
    v_cndmask_b32_dpp v87, v87, v87, vcc wave_shr:1 row_mask:0xf bank_mask:0xf
    s_andn2_b64 s[82:83], s[82:83], s[52:53]
    v_cndmask_b32_dpp v7, v7, v7, vcc wave_shr:1 row_mask:0xf bank_mask:0xf
    s_mov_b64 exec, s[50:51]
    s_cbranch_scc0 L2_d151
    s_mov_b64 exec, s[82:83]
    s_nop 1
    v_mfma_f32_4x4x4_16b_bf16 v[88:91], v[12:13], v[84:85], 0
    s_nop 1
    v_mfma_f32_4x4x4_16b_bf16 v[88:91], v[10:11], v[86:87], v[88:91]
    s_nop 4
    v_cvt_pk_bf16_f32 v88, v88, v89
    v_cvt_pk_bf16_f32 v89, v90, v91
    ds_pk_add_bf16 v7, v88 offset:65408
    ds_pk_add_bf16 v7, v89 offset:65412
    s_mov_b64 exec, s[50:51]
    s_branch L2_d151
L2_c152:
    s_mov_b64 s[50:51], vcc
    s_lshl_b64 s[52:53], s[82:83], 1
    s_andn2_b64 s[52:53], s[52:53], s[80:81]
    s_andn2_b64 s[52:53], s[52:53], s[50:51]
    s_or_b64 s[80:81], s[80:81], s[52:53]
    s_not_b64 vcc, s[52:53]
    s_mov_b64 exec, -1
    v_cndmask_b32_dpp v84, v84, v84, vcc wave_shr:1 row_mask:0xf bank_mask:0xf
    v_cndmask_b32_dpp v85, v85, v85, vcc wave_shr:1 row_mask:0xf bank_mask:0xf
    s_lshr_b64 s[52:53], s[52:53], 1
    v_cndmask_b32_dpp v86, v86, v86, vcc wave_shr:1 row_mask:0xf bank_mask:0xf
    v_cndmask_b32_dpp v87, v87, v87, vcc wave_shr:1 row_mask:0xf bank_mask:0xf
    s_andn2_b64 s[82:83], s[82:83], s[52:53]
    v_cndmask_b32_dpp v7, v7, v7, vcc wave_shr:1 row_mask:0xf bank_mask:0xf
    s_mov_b64 vcc, s[50:51]
    s_mov_b64 exec, s[50:51]
    s_cbranch_scc0 L2_d152
    s_mov_b64 exec, s[82:83]
    s_nop 1
    v_mfma_f32_4x4x4_16b_bf16 v[88:91], v[12:13], v[84:85], 0
    s_nop 1
    v_mfma_f32_4x4x4_16b_bf16 v[88:91], v[10:11], v[86:87], v[88:91]
    s_nop 4
    v_cvt_pk_bf16_f32 v88, v88, v89
    v_cvt_pk_bf16_f32 v89, v90, v91
    ds_pk_add_bf16 v7, v88 offset:65408
    ds_pk_add_bf16 v7, v89 offset:65412
    s_mov_b64 exec, vcc
    s_branch L2_d152
L2_c153:
    s_mov_b64 s[50:51], vcc
    s_lshl_b64 s[52:53], s[82:83], 1
    s_andn2_b64 s[52:53], s[52:53], s[80:81]
    s_andn2_b64 s[52:53], s[52:53], s[50:51]
    s_or_b64 s[80:81], s[80:81], s[52:53]
    s_not_b64 vcc, s[52:53]
    s_mov_b64 exec, -1
    v_cndmask_b32_dpp v84, v84, v84, vcc wave_shr:1 row_mask:0xf bank_mask:0xf
    v_cndmask_b32_dpp v85, v85, v85, vcc wave_shr:1 row_mask:0xf bank_mask:0xf
    s_lshr_b64 s[52:53], s[52:53], 1
    v_cndmask_b32_dpp v86, v86, v86, vcc wave_shr:1 row_mask:0xf bank_mask:0xf
    v_cndmask_b32_dpp v87, v87, v87, vcc wave_shr:1 row_mask:0xf bank_mask:0xf
    s_andn2_b64 s[82:83], s[82:83], s[52:53]
    v_cndmask_b32_dpp v7, v7, v7, vcc wave_shr:1 row_mask:0xf bank_mask:0xf
    s_mov_b64 vcc, s[50:51]
    s_mov_b64 exec, s[50:51]
    s_cbranch_scc0 L2_d153
    s_mov_b64 exec, s[82:83]
    s_nop 1
    v_mfma_f32_4x4x4_16b_bf16 v[88:91], v[12:13], v[84:85], 0
    s_nop 1
    v_mfma_f32_4x4x4_16b_bf16 v[88:91], v[10:11], v[86:87], v[88:91]
    s_nop 4
    v_cvt_pk_bf16_f32 v88, v88, v89
    v_cvt_pk_bf16_f32 v89, v90, v91
    ds_pk_add_bf16 v7, v88 offset:65408
    ds_pk_add_bf16 v7, v89 offset:65412
    s_mov_b64 exec, vcc
    s_branch L2_d153
.section .rodata,"a"
.p2align 6
.amdhsa_kernel gather_scatter__molecular_angular_gemnet__graph_kernel
  .amdhsa_next_free_vgpr 128
  .amdhsa_next_free_sgpr 102
  .amdhsa_accum_offset 128
  .amdhsa_group_segment_fixed_size 0
  .amdhsa_kernarg_size 112
  .amdhsa_user_sgpr_count 2
  .amdhsa_user_sgpr_kernarg_segment_ptr 1
  .amdhsa_system_sgpr_workgroup_id_x 1
  .amdhsa_float_denorm_mode_32 3
.end_amdhsa_kernel
```

```asm
; @launch grid=(256,1,1) block=(1024,1,1) lds=163840
.amdgcn_target "amdgcn-amd-amdhsa--gfx950"
.text
.globl gather_scatter__molecular_angular_gemnet__graph_kernel
.p2align 8
.type gather_scatter__molecular_angular_gemnet__graph_kernel,@function
gather_scatter__molecular_angular_gemnet__graph_kernel:
    s_cmp_ge_u32 s2, 256
    s_cbranch_scc0 L1_go
    s_endpgm
L1_go:
    s_load_dwordx4 s[4:7], s[0:1], 8
    s_load_dwordx2 s[28:29], s[0:1], 32
    s_load_dwordx2 s[30:31], s[0:1], 104
    s_load_dwordx2 s[56:57], s[0:1], 96
    s_load_dwordx2 s[86:87], s[0:1], 0
    s_load_dwordx4 s[60:63], s[0:1], 56
    s_load_dwordx4 s[64:67], s[0:1], 72
    v_lshrrev_b32 v7, 6, v0
    v_lshlrev_b32 v1, 3, v0
    v_readfirstlane_b32 s32, v7
    v_lshlrev_b32 v0, 4, v0
    s_xor_b32 s44, s2, 0
    s_lshr_b32 s3, s44, 5
    s_lshl_b32 s96, s3, 19
    s_and_b32 s3, s44, 31
    s_lshl_b32 s3, s3, 10
    s_add_u32 s96, s96, s3
    s_mul_i32 s3, s32, 31744
    s_add_u32 s96, s96, s3
    s_xor_b32 s44, s2, 8
    s_lshr_b32 s3, s44, 5
    s_lshl_b32 s97, s3, 19
    s_and_b32 s3, s44, 31
    s_lshl_b32 s3, s3, 10
    s_add_u32 s97, s97, s3
    s_mul_i32 s3, s32, 31744
    s_add_u32 s97, s97, s3
    s_xor_b32 s44, s2, 16
    s_lshr_b32 s3, s44, 5
    s_lshl_b32 s98, s3, 19
    s_and_b32 s3, s44, 31
    s_lshl_b32 s3, s3, 10
    s_add_u32 s98, s98, s3
    s_mul_i32 s3, s32, 31744
    s_add_u32 s98, s98, s3
    s_xor_b32 s44, s2, 24
    s_lshr_b32 s3, s44, 5
    s_lshl_b32 s99, s3, 19
    s_and_b32 s3, s44, 31
    s_lshl_b32 s3, s3, 10
    s_add_u32 s99, s99, s3
    s_mul_i32 s3, s32, 31744
    s_add_u32 s99, s99, s3
    s_waitcnt lgkmcnt(0)
    s_mov_b32 s8, s4
    s_mov_b32 s9, s5
    s_mov_b32 s10, 0x9c40000
    s_mov_b32 s11, 0x20000
    s_mov_b32 s12, s6
    s_mov_b32 s13, s7
    s_mov_b32 s14, 0x9c40000
    s_mov_b32 s15, 0x20000
    s_mov_b32 s16, s28
    s_mov_b32 s17, s29
    s_mov_b32 s18, 0x4e20000
    s_mov_b32 s19, 0x20000
    s_mov_b32 s68, s62
    s_mov_b32 s69, s63
    s_mov_b32 s70, 0x40
    s_mov_b32 s71, 0x20000
    s_mov_b32 s72, s60
    s_mov_b32 s73, s61
    s_mov_b32 s74, 0x40
    s_mov_b32 s75, 0x20000
    s_mov_b32 s20, s66
    s_mov_b32 s21, s67
    s_mov_b32 s22, 0x20
    s_mov_b32 s23, 0x20000
    s_mov_b32 s80, s64
    s_mov_b32 s81, s65
    s_mov_b32 s82, 0x20
    s_mov_b32 s83, 0x20000
    s_add_u32 s24, s30, 0xebc9000
    s_addc_u32 s25, s31, 0
    s_mov_b32 s26, 0x100
    s_mov_b32 s27, 0x20000
    v_lshrrev_b32 v2, 3, v0
    v_and_b32 v2, 6, v2
    v_lshlrev_b32 v3, 2, v0
    s_lshl_b32 s3, s32, 8
    s_add_u32 s3, s3, s2
    s_cmp_lg_u32 s3, 254
    s_cbranch_scc1 L1_wt
    buffer_load_ushort v96, v2, s[68:71], 0 offen offset:0
    buffer_load_ushort v108, v2, s[68:71], 0 offen offset:8
    buffer_load_ushort v97, v2, s[68:71], 0 offen offset:16
    buffer_load_ushort v109, v2, s[68:71], 0 offen offset:24
    buffer_load_ushort v98, v2, s[68:71], 0 offen offset:32
    buffer_load_ushort v110, v2, s[68:71], 0 offen offset:40
    buffer_load_ushort v99, v2, s[68:71], 0 offen offset:48
    buffer_load_ushort v111, v2, s[68:71], 0 offen offset:56
    buffer_load_ushort v100, v2, s[72:75], 0 offen offset:0
    buffer_load_ushort v112, v2, s[72:75], 0 offen offset:8
    buffer_load_ushort v101, v2, s[72:75], 0 offen offset:16
    buffer_load_ushort v113, v2, s[72:75], 0 offen offset:24
    buffer_load_ushort v102, v2, s[72:75], 0 offen offset:32
    buffer_load_ushort v114, v2, s[72:75], 0 offen offset:40
    buffer_load_ushort v103, v2, s[72:75], 0 offen offset:48
    buffer_load_ushort v115, v2, s[72:75], 0 offen offset:56
    buffer_load_ushort v104, v2, s[20:23], 0 offen offset:0
    buffer_load_ushort v116, v2, s[20:23], 0 offen offset:8
    buffer_load_ushort v105, v2, s[20:23], 0 offen offset:16
    buffer_load_ushort v117, v2, s[20:23], 0 offen offset:24
    buffer_load_ushort v106, v2, s[80:83], 0 offen offset:0
    buffer_load_ushort v118, v2, s[80:83], 0 offen offset:8
    buffer_load_ushort v107, v2, s[80:83], 0 offen offset:16
    buffer_load_ushort v119, v2, s[80:83], 0 offen offset:24
    s_waitcnt vmcnt(0)
    v_lshl_or_b32 v96, v108, 16, v96
    v_lshl_or_b32 v97, v109, 16, v97
    v_lshl_or_b32 v98, v110, 16, v98
    v_lshl_or_b32 v99, v111, 16, v99
    v_lshl_or_b32 v100, v112, 16, v100
    v_lshl_or_b32 v101, v113, 16, v101
    v_lshl_or_b32 v102, v114, 16, v102
    v_lshl_or_b32 v103, v115, 16, v103
    v_lshl_or_b32 v104, v116, 16, v104
    v_lshl_or_b32 v105, v117, 16, v105
    v_lshl_or_b32 v106, v118, 16, v106
    v_lshl_or_b32 v107, v119, 16, v107
    buffer_store_dwordx4 v[96:99], v3, s[24:27], 0 offen offset:0 sc1
    buffer_store_dwordx4 v[100:103], v3, s[24:27], 0 offen offset:16 sc1
    buffer_store_dwordx4 v[104:107], v3, s[24:27], 0 offen offset:32 sc1
L1_wt:
    s_nop 1
    s_add_u32 s44, s96, 0x0
    buffer_load_dwordx4 v[16:19], v0, s[8:11], s44 offen nt
    s_add_u32 s45, s96, 0x0
    buffer_load_dwordx4 v[20:23], v0, s[12:15], s45 offen nt
    s_add_u32 s46, s96, 0x0
    s_lshr_b32 s46, s46, 1
    buffer_load_dwordx2 v[24:25], v1, s[16:19], s46 offen nt
    s_add_u32 s47, s97, 0x400000
    s_lshr_b32 s47, s47, 1
    buffer_load_dwordx2 v[26:27], v1, s[16:19], s47 offen nt
    s_add_u32 s44, s97, 0x400000
    buffer_load_dwordx4 v[28:31], v0, s[8:11], s44 offen nt
    s_add_u32 s45, s97, 0x400000
    buffer_load_dwordx4 v[32:35], v0, s[12:15], s45 offen nt
    s_add_u32 s46, s98, 0x800000
    buffer_load_dwordx4 v[36:39], v0, s[8:11], s46 offen nt
    s_add_u32 s47, s98, 0x800000
    buffer_load_dwordx4 v[40:43], v0, s[12:15], s47 offen nt
    s_add_u32 s44, s98, 0x800000
    s_lshr_b32 s44, s44, 1
    buffer_load_dwordx2 v[44:45], v1, s[16:19], s44 offen nt
    s_add_u32 s45, s99, 0xc00000
    s_lshr_b32 s45, s45, 1
    buffer_load_dwordx2 v[46:47], v1, s[16:19], s45 offen nt
    s_mov_b32 s20, s30
    s_mov_b32 s21, s31
    s_mov_b32 s22, 0xd340000
    s_mov_b32 s23, 0x20000
    s_add_u32 s24, s30, 0x28000
    s_addc_u32 s25, s31, 0
    s_mov_b32 s26, 0xd318000
    s_mov_b32 s27, 0x20000
    s_mov_b32 s80, s86
    s_mov_b32 s81, s87
    s_mov_b32 s82, 0x4e2000
    s_mov_b32 s83, 0x20000
    s_mul_i32 s35, s2, 173056
    s_and_b32 s37, s32, 3
    s_lshl_b32 s37, s37, 3
    s_mov_b32 s36, s37
    s_lshr_b32 s37, s32, 2
    s_mul_i32 s37, s37, 2080
    s_add_u32 s36, s36, s37
    s_and_b32 s37, s2, 3
    s_lshl_b32 s37, s37, 5
    s_add_u32 s36, s36, s37
    s_mul_i32 s4, s2, 5
    s_add_u32 s4, s4, 8192
    s_lshl_b32 s38, s4, 14
    s_lshl_b32 s39, s4, 13
    v_mov_b32 v2, 1
    v_mov_b32 v4, 0x80000007
    v_mov_b32 v5, 0xfc
    v_mov_b32 v6, 0x78
    s_mov_b32 s40, 16512
    s_mov_b32 s55, -10000
    s_mov_b32 s41, 0x010c0c01
    s_mov_b32 s42, 0x030c0c03
    v_mov_b32 v8, 0
    v_mov_b32 v9, 0
    v_mov_b32 v10, 0
    v_mov_b32 v11, 0
    ds_write_b128 v0, v[8:11]
    s_add_u32 s60, s30, 0xebd2000
    s_addc_u32 s61, s31, 0
    s_mov_b32 s62, 0x8000
    s_mov_b32 s63, 0x20000
    s_mov_b64 s[66:67], s[56:57]
    s_lshl_b32 s57, s2, 7
    s_add_u32 s68, s30, 0xebca000
    s_addc_u32 s69, s31, 0
    s_mov_b32 s70, 0x80
    s_mov_b32 s71, 0x20000
    s_lshl_b32 s3, s2, 7
    s_add_u32 s68, s68, s3
    s_addc_u32 s69, s69, 0
    s_cmp_lg_u32 s32, 0
    s_cbranch_scc1 L1_fl
    buffer_store_dwordx4 v[8:11], v0, s[68:71], 0 offen sc1
    s_mov_b64 exec, 0xff
    buffer_store_dwordx4 v[8:11], v0, s[60:63], s57 offen sc1
    s_mov_b64 exec, -1
    buffer_inv sc1
L1_fl:
    s_waitcnt lgkmcnt(0)
    s_barrier
    s_setprio 3
    s_add_u32 s46, s99, 0xc00000
    buffer_load_dwordx4 v[48:51], v0, s[8:11], s46 offen nt
    s_add_u32 s47, s99, 0xc00000
    buffer_load_dwordx4 v[52:55], v0, s[12:15], s47 offen nt
    s_waitcnt vmcnt(8)
    v_lshlrev_b32 v7, 16, v24
    v_and_b32 v8, 0xffff0000, v24
    v_lshlrev_b32 v9, 16, v25
    v_and_b32 v10, 0xffff0000, v25
    v_mul_f32 v7, 0.15915494, v7
    v_mul_f32 v8, 0.15915494, v8
    v_mul_f32 v9, 0.15915494, v9
    v_mul_f32 v10, 0.15915494, v10
    v_mul_hi_u32_u24 v14, 429497, v16
    v_lshrrev_b32 v12, 3, v20
    v_cos_f32 v7, v7
    v_lshlrev_b16 v13, 3, v20
    v_mad_i32_i24 v11, v14, s55, v16
    v_bitop3_b32 v12, v6, v13, v12 bitop3:0xca
    v_lshl_add_u32 v11, v11, 17, s40
    v_lshlrev_b16 v14, 8, v14
    v_lshrrev_b32 v13, 2, v20
    v_add_u32 v16, v12, v11
    v_bitop3_b32 v20, v5, v13, v14 bitop3:0xea
    ds_add_u32 v20, v2
    v_mul_hi_u32_u24 v14, 429497, v17
    v_lshrrev_b32 v12, 3, v21
    v_cos_f32 v8, v8
    v_lshlrev_b16 v13, 3, v21
    v_mad_i32_i24 v11, v14, s55, v17
    v_bitop3_b32 v12, v6, v13, v12 bitop3:0xca
    v_lshl_add_u32 v11, v11, 17, s40
    v_lshlrev_b16 v14, 8, v14
    v_lshrrev_b32 v13, 2, v21
    v_add_u32 v17, v12, v11
    v_bitop3_b32 v21, v5, v13, v14 bitop3:0xea
    ds_add_u32 v21, v2
    v_cvt_pk_bf16_f32 v24, v7, v8
    v_perm_b32 v12, v24, v24, s41
    v_bitop3_b32 v16, v4, v12, v16 bitop3:0xca
    v_perm_b32 v13, v24, v24, s42
    v_bitop3_b32 v17, v4, v13, v17 bitop3:0xca
    v_mul_hi_u32_u24 v14, 429497, v18
    v_lshrrev_b32 v12, 3, v22
    v_cos_f32 v9, v9
    v_lshlrev_b16 v13, 3, v22
    v_mad_i32_i24 v11, v14, s55, v18
    v_bitop3_b32 v12, v6, v13, v12 bitop3:0xca
    v_lshl_add_u32 v11, v11, 17, s40
    v_lshlrev_b16 v14, 8, v14
    v_lshrrev_b32 v13, 2, v22
    v_add_u32 v18, v12, v11
    v_bitop3_b32 v22, v5, v13, v14 bitop3:0xea
    ds_add_u32 v22, v2
    v_mul_hi_u32_u24 v14, 429497, v19
    v_lshrrev_b32 v12, 3, v23
    v_cos_f32 v10, v10
    v_lshlrev_b16 v13, 3, v23
    v_mad_i32_i24 v11, v14, s55, v19
    v_bitop3_b32 v12, v6, v13, v12 bitop3:0xca
    v_lshl_add_u32 v11, v11, 17, s40
    v_lshlrev_b16 v14, 8, v14
    v_lshrrev_b32 v13, 2, v23
    v_add_u32 v19, v12, v11
    v_bitop3_b32 v23, v5, v13, v14 bitop3:0xea
    ds_add_u32 v23, v2
    v_cvt_pk_bf16_f32 v25, v9, v10
    v_perm_b32 v12, v25, v25, s41
    v_bitop3_b32 v18, v4, v12, v18 bitop3:0xca
    v_perm_b32 v13, v25, v25, s42
    v_bitop3_b32 v19, v4, v13, v19 bitop3:0xca
    s_add_u32 s44, s96, 0x1000000
    buffer_load_dwordx4 v[56:59], v0, s[8:11], s44 offen nt
    s_add_u32 s45, s96, 0x1000000
    buffer_load_dwordx4 v[60:63], v0, s[12:15], s45 offen nt
    s_add_u32 s46, s96, 0x1000000
    s_lshr_b32 s46, s46, 1
    buffer_load_dwordx2 v[64:65], v1, s[16:19], s46 offen nt
    s_add_u32 s47, s97, 0x1400000
    s_lshr_b32 s47, s47, 1
    buffer_load_dwordx2 v[66:67], v1, s[16:19], s47 offen nt
    s_waitcnt vmcnt(10)
    v_lshlrev_b32 v7, 16, v26
    v_and_b32 v8, 0xffff0000, v26
    v_lshlrev_b32 v9, 16, v27
    v_and_b32 v10, 0xffff0000, v27
    v_mul_f32 v7, 0.15915494, v7
    v_mul_f32 v8, 0.15915494, v8
    v_mul_f32 v9, 0.15915494, v9
    v_mul_f32 v10, 0.15915494, v10
    v_mul_hi_u32_u24 v14, 429497, v28
    v_lshrrev_b32 v12, 3, v32
    v_cos_f32 v7, v7
    v_lshlrev_b16 v13, 3, v32
    v_mad_i32_i24 v11, v14, s55, v28
    v_bitop3_b32 v12, v6, v13, v12 bitop3:0xca
    v_lshl_add_u32 v11, v11, 17, s40
    v_lshlrev_b16 v14, 8, v14
    v_lshrrev_b32 v13, 2, v32
    v_add_u32 v28, v12, v11
    v_bitop3_b32 v32, v5, v13, v14 bitop3:0xea
    ds_add_u32 v32, v2
    v_mul_hi_u32_u24 v14, 429497, v29
    v_lshrrev_b32 v12, 3, v33
    v_cos_f32 v8, v8
    v_lshlrev_b16 v13, 3, v33
    v_mad_i32_i24 v11, v14, s55, v29
    v_bitop3_b32 v12, v6, v13, v12 bitop3:0xca
    v_lshl_add_u32 v11, v11, 17, s40
    v_lshlrev_b16 v14, 8, v14
    v_lshrrev_b32 v13, 2, v33
    v_add_u32 v29, v12, v11
    v_bitop3_b32 v33, v5, v13, v14 bitop3:0xea
    ds_add_u32 v33, v2
    v_cvt_pk_bf16_f32 v26, v7, v8
    v_perm_b32 v12, v26, v26, s41
    v_bitop3_b32 v28, v4, v12, v28 bitop3:0xca
    v_perm_b32 v13, v26, v26, s42
    v_bitop3_b32 v29, v4, v13, v29 bitop3:0xca
    v_mul_hi_u32_u24 v14, 429497, v30
    v_lshrrev_b32 v12, 3, v34
    v_cos_f32 v9, v9
    v_lshlrev_b16 v13, 3, v34
    v_mad_i32_i24 v11, v14, s55, v30
    v_bitop3_b32 v12, v6, v13, v12 bitop3:0xca
    v_lshl_add_u32 v11, v11, 17, s40
    v_lshlrev_b16 v14, 8, v14
    v_lshrrev_b32 v13, 2, v34
    v_add_u32 v30, v12, v11
    v_bitop3_b32 v34, v5, v13, v14 bitop3:0xea
    ds_add_u32 v34, v2
    v_mul_hi_u32_u24 v14, 429497, v31
    v_lshrrev_b32 v12, 3, v35
    v_cos_f32 v10, v10
    v_lshlrev_b16 v13, 3, v35
    v_mad_i32_i24 v11, v14, s55, v31
    v_bitop3_b32 v12, v6, v13, v12 bitop3:0xca
    v_lshl_add_u32 v11, v11, 17, s40
    v_lshlrev_b16 v14, 8, v14
    v_lshrrev_b32 v13, 2, v35
    v_add_u32 v31, v12, v11
    v_bitop3_b32 v35, v5, v13, v14 bitop3:0xea
    ds_add_u32 v35, v2
    v_cvt_pk_bf16_f32 v27, v9, v10
    v_perm_b32 v12, v27, v27, s41
    v_bitop3_b32 v30, v4, v12, v30 bitop3:0xca
    v_perm_b32 v13, v27, v27, s42
    v_bitop3_b32 v31, v4, v13, v31 bitop3:0xca
    s_setprio 2
    s_add_u32 s44, s97, 0x1400000
    buffer_load_dwordx4 v[68:71], v0, s[8:11], s44 offen nt
    s_add_u32 s45, s97, 0x1400000
    buffer_load_dwordx4 v[72:75], v0, s[12:15], s45 offen nt
    s_waitcnt vmcnt(8)
    v_lshlrev_b32 v7, 16, v44
    v_and_b32 v8, 0xffff0000, v44
    v_lshlrev_b32 v9, 16, v45
    v_and_b32 v10, 0xffff0000, v45
    v_mul_f32 v7, 0.15915494, v7
    v_mul_f32 v8, 0.15915494, v8
    v_mul_f32 v9, 0.15915494, v9
    v_mul_f32 v10, 0.15915494, v10
    v_mul_hi_u32_u24 v14, 429497, v36
    v_lshrrev_b32 v12, 3, v40
    v_cos_f32 v7, v7
    v_lshlrev_b16 v13, 3, v40
    v_mad_i32_i24 v11, v14, s55, v36
    v_bitop3_b32 v12, v6, v13, v12 bitop3:0xca
    v_lshl_add_u32 v11, v11, 17, s40
    v_lshlrev_b16 v14, 8, v14
    v_lshrrev_b32 v13, 2, v40
    v_add_u32 v36, v12, v11
    v_bitop3_b32 v40, v5, v13, v14 bitop3:0xea
    ds_add_u32 v40, v2
    v_mul_hi_u32_u24 v14, 429497, v37
    v_lshrrev_b32 v12, 3, v41
    v_cos_f32 v8, v8
    v_lshlrev_b16 v13, 3, v41
    v_mad_i32_i24 v11, v14, s55, v37
    v_bitop3_b32 v12, v6, v13, v12 bitop3:0xca
    v_lshl_add_u32 v11, v11, 17, s40
    v_lshlrev_b16 v14, 8, v14
    v_lshrrev_b32 v13, 2, v41
    v_add_u32 v37, v12, v11
    v_bitop3_b32 v41, v5, v13, v14 bitop3:0xea
    ds_add_u32 v41, v2
    v_cvt_pk_bf16_f32 v44, v7, v8
    v_perm_b32 v12, v44, v44, s41
    v_bitop3_b32 v36, v4, v12, v36 bitop3:0xca
    v_perm_b32 v13, v44, v44, s42
    v_bitop3_b32 v37, v4, v13, v37 bitop3:0xca
    v_mul_hi_u32_u24 v14, 429497, v38
    v_lshrrev_b32 v12, 3, v42
    v_cos_f32 v9, v9
    v_lshlrev_b16 v13, 3, v42
    v_mad_i32_i24 v11, v14, s55, v38
    v_bitop3_b32 v12, v6, v13, v12 bitop3:0xca
    v_lshl_add_u32 v11, v11, 17, s40
    v_lshlrev_b16 v14, 8, v14
    v_lshrrev_b32 v13, 2, v42
    v_add_u32 v38, v12, v11
    v_bitop3_b32 v42, v5, v13, v14 bitop3:0xea
    ds_add_u32 v42, v2
    v_mul_hi_u32_u24 v14, 429497, v39
    v_lshrrev_b32 v12, 3, v43
    v_cos_f32 v10, v10
    v_lshlrev_b16 v13, 3, v43
    v_mad_i32_i24 v11, v14, s55, v39
    v_bitop3_b32 v12, v6, v13, v12 bitop3:0xca
    v_lshl_add_u32 v11, v11, 17, s40
    v_lshlrev_b16 v14, 8, v14
    v_lshrrev_b32 v13, 2, v43
    v_add_u32 v39, v12, v11
    v_bitop3_b32 v43, v5, v13, v14 bitop3:0xea
    ds_add_u32 v43, v2
    v_cvt_pk_bf16_f32 v45, v9, v10
    v_perm_b32 v12, v45, v45, s41
    v_bitop3_b32 v38, v4, v12, v38 bitop3:0xca
    v_perm_b32 v13, v45, v45, s42
    v_bitop3_b32 v39, v4, v13, v39 bitop3:0xca
    s_add_u32 s46, s98, 0x1800000
    buffer_load_dwordx4 v[76:79], v0, s[8:11], s46 offen nt
    s_add_u32 s47, s98, 0x1800000
    buffer_load_dwordx4 v[80:83], v0, s[12:15], s47 offen nt
    s_add_u32 s44, s98, 0x1800000
    s_lshr_b32 s44, s44, 1
    buffer_load_dwordx2 v[84:85], v1, s[16:19], s44 offen nt
    s_add_u32 s45, s99, 0x1c00000
    s_lshr_b32 s45, s45, 1
    buffer_load_dwordx2 v[86:87], v1, s[16:19], s45 offen nt
    s_waitcnt vmcnt(10)
    v_lshlrev_b32 v7, 16, v46
    v_and_b32 v8, 0xffff0000, v46
    v_lshlrev_b32 v9, 16, v47
    v_and_b32 v10, 0xffff0000, v47
    v_mul_f32 v7, 0.15915494, v7
    v_mul_f32 v8, 0.15915494, v8
    v_mul_f32 v9, 0.15915494, v9
    v_mul_f32 v10, 0.15915494, v10
    v_mul_hi_u32_u24 v14, 429497, v48
    v_lshrrev_b32 v12, 3, v52
    v_cos_f32 v7, v7
    v_lshlrev_b16 v13, 3, v52
    v_mad_i32_i24 v11, v14, s55, v48
    v_bitop3_b32 v12, v6, v13, v12 bitop3:0xca
    v_lshl_add_u32 v11, v11, 17, s40
    v_lshlrev_b16 v14, 8, v14
    v_lshrrev_b32 v13, 2, v52
    v_add_u32 v48, v12, v11
    v_bitop3_b32 v52, v5, v13, v14 bitop3:0xea
    ds_add_u32 v52, v2
    v_mul_hi_u32_u24 v14, 429497, v49
    v_lshrrev_b32 v12, 3, v53
    v_cos_f32 v8, v8
    v_lshlrev_b16 v13, 3, v53
    v_mad_i32_i24 v11, v14, s55, v49
    v_bitop3_b32 v12, v6, v13, v12 bitop3:0xca
    v_lshl_add_u32 v11, v11, 17, s40
    v_lshlrev_b16 v14, 8, v14
    v_lshrrev_b32 v13, 2, v53
    v_add_u32 v49, v12, v11
    v_bitop3_b32 v53, v5, v13, v14 bitop3:0xea
    ds_add_u32 v53, v2
    v_cvt_pk_bf16_f32 v46, v7, v8
    v_perm_b32 v12, v46, v46, s41
    v_bitop3_b32 v48, v4, v12, v48 bitop3:0xca
    v_perm_b32 v13, v46, v46, s42
    v_bitop3_b32 v49, v4, v13, v49 bitop3:0xca
    v_mul_hi_u32_u24 v14, 429497, v50
    v_lshrrev_b32 v12, 3, v54
    v_cos_f32 v9, v9
    v_lshlrev_b16 v13, 3, v54
    v_mad_i32_i24 v11, v14, s55, v50
    v_bitop3_b32 v12, v6, v13, v12 bitop3:0xca
    v_lshl_add_u32 v11, v11, 17, s40
    v_lshlrev_b16 v14, 8, v14
    v_lshrrev_b32 v13, 2, v54
    v_add_u32 v50, v12, v11
    v_bitop3_b32 v54, v5, v13, v14 bitop3:0xea
    ds_add_u32 v54, v2
    v_mul_hi_u32_u24 v14, 429497, v51
    v_lshrrev_b32 v12, 3, v55
    v_cos_f32 v10, v10
    v_lshlrev_b16 v13, 3, v55
    v_mad_i32_i24 v11, v14, s55, v51
    v_bitop3_b32 v12, v6, v13, v12 bitop3:0xca
    v_lshl_add_u32 v11, v11, 17, s40
    v_lshlrev_b16 v14, 8, v14
    v_lshrrev_b32 v13, 2, v55
    v_add_u32 v51, v12, v11
    v_bitop3_b32 v55, v5, v13, v14 bitop3:0xea
    ds_add_u32 v55, v2
    v_cvt_pk_bf16_f32 v47, v9, v10
    v_perm_b32 v12, v47, v47, s41
    v_bitop3_b32 v50, v4, v12, v50 bitop3:0xca
    v_perm_b32 v13, v47, v47, s42
    v_bitop3_b32 v51, v4, v13, v51 bitop3:0xca
    s_setprio 1
    s_add_u32 s46, s99, 0x1c00000
    buffer_load_dwordx4 v[88:91], v0, s[8:11], s46 offen nt
    s_add_u32 s47, s99, 0x1c00000
    buffer_load_dwordx4 v[92:95], v0, s[12:15], s47 offen nt
    s_waitcnt vmcnt(8)
    v_lshlrev_b32 v7, 16, v64
    v_and_b32 v8, 0xffff0000, v64
    v_lshlrev_b32 v9, 16, v65
    v_and_b32 v10, 0xffff0000, v65
    v_mul_f32 v7, 0.15915494, v7
    v_mul_f32 v8, 0.15915494, v8
    v_mul_f32 v9, 0.15915494, v9
    v_mul_f32 v10, 0.15915494, v10
    v_mul_hi_u32_u24 v14, 429497, v56
    v_lshrrev_b32 v12, 3, v60
    v_cos_f32 v7, v7
    v_lshlrev_b16 v13, 3, v60
    v_mad_i32_i24 v11, v14, s55, v56
    v_bitop3_b32 v12, v6, v13, v12 bitop3:0xca
    v_lshl_add_u32 v11, v11, 17, s40
    v_lshlrev_b16 v14, 8, v14
    v_lshrrev_b32 v13, 2, v60
    v_add_u32 v56, v12, v11
    v_bitop3_b32 v60, v5, v13, v14 bitop3:0xea
    ds_add_u32 v60, v2
    v_mul_hi_u32_u24 v14, 429497, v57
    v_lshrrev_b32 v12, 3, v61
    v_cos_f32 v8, v8
    v_lshlrev_b16 v13, 3, v61
    v_mad_i32_i24 v11, v14, s55, v57
    v_bitop3_b32 v12, v6, v13, v12 bitop3:0xca
    v_lshl_add_u32 v11, v11, 17, s40
    v_lshlrev_b16 v14, 8, v14
    v_lshrrev_b32 v13, 2, v61
    v_add_u32 v57, v12, v11
    v_bitop3_b32 v61, v5, v13, v14 bitop3:0xea
    ds_add_u32 v61, v2
    v_cvt_pk_bf16_f32 v64, v7, v8
    v_perm_b32 v12, v64, v64, s41
    v_bitop3_b32 v56, v4, v12, v56 bitop3:0xca
    v_perm_b32 v13, v64, v64, s42
    v_bitop3_b32 v57, v4, v13, v57 bitop3:0xca
    v_mul_hi_u32_u24 v14, 429497, v58
    v_lshrrev_b32 v12, 3, v62
    v_cos_f32 v9, v9
    v_lshlrev_b16 v13, 3, v62
    v_mad_i32_i24 v11, v14, s55, v58
    v_bitop3_b32 v12, v6, v13, v12 bitop3:0xca
    v_lshl_add_u32 v11, v11, 17, s40
    v_lshlrev_b16 v14, 8, v14
    v_lshrrev_b32 v13, 2, v62
    v_add_u32 v58, v12, v11
    v_bitop3_b32 v62, v5, v13, v14 bitop3:0xea
    ds_add_u32 v62, v2
    v_mul_hi_u32_u24 v14, 429497, v59
    v_lshrrev_b32 v12, 3, v63
    v_cos_f32 v10, v10
    v_lshlrev_b16 v13, 3, v63
    v_mad_i32_i24 v11, v14, s55, v59
    v_bitop3_b32 v12, v6, v13, v12 bitop3:0xca
    v_lshl_add_u32 v11, v11, 17, s40
    v_lshlrev_b16 v14, 8, v14
    v_lshrrev_b32 v13, 2, v63
    v_add_u32 v59, v12, v11
    v_bitop3_b32 v63, v5, v13, v14 bitop3:0xea
    ds_add_u32 v63, v2
    v_cvt_pk_bf16_f32 v65, v9, v10
    v_perm_b32 v12, v65, v65, s41
    v_bitop3_b32 v58, v4, v12, v58 bitop3:0xca
    v_perm_b32 v13, v65, v65, s42
    v_bitop3_b32 v59, v4, v13, v59 bitop3:0xca
    s_add_u32 s44, s96, 0x2000000
    buffer_load_dwordx4 v[96:99], v0, s[8:11], s44 offen nt
    s_add_u32 s45, s96, 0x2000000
    buffer_load_dwordx4 v[104:107], v0, s[12:15], s45 offen nt
    s_add_u32 s46, s96, 0x2000000
    s_lshr_b32 s46, s46, 1
    buffer_load_dwordx2 v[108:109], v1, s[16:19], s46 offen nt
    s_add_u32 s47, s97, 0x2400000
    s_lshr_b32 s47, s47, 1
    buffer_load_dwordx2 v[110:111], v1, s[16:19], s47 offen nt
    s_waitcnt vmcnt(10)
    v_lshlrev_b32 v7, 16, v66
    v_and_b32 v8, 0xffff0000, v66
    v_lshlrev_b32 v9, 16, v67
    v_and_b32 v10, 0xffff0000, v67
    v_mul_f32 v7, 0.15915494, v7
    v_mul_f32 v8, 0.15915494, v8
    v_mul_f32 v9, 0.15915494, v9
    v_mul_f32 v10, 0.15915494, v10
    v_mul_hi_u32_u24 v14, 429497, v68
    v_lshrrev_b32 v12, 3, v72
    v_cos_f32 v7, v7
    v_lshlrev_b16 v13, 3, v72
    v_mad_i32_i24 v11, v14, s55, v68
    v_bitop3_b32 v12, v6, v13, v12 bitop3:0xca
    v_lshl_add_u32 v11, v11, 17, s40
    v_lshlrev_b16 v14, 8, v14
    v_lshrrev_b32 v13, 2, v72
    v_add_u32 v68, v12, v11
    v_bitop3_b32 v72, v5, v13, v14 bitop3:0xea
    ds_add_u32 v72, v2
    v_mul_hi_u32_u24 v14, 429497, v69
    v_lshrrev_b32 v12, 3, v73
    v_cos_f32 v8, v8
    v_lshlrev_b16 v13, 3, v73
    v_mad_i32_i24 v11, v14, s55, v69
    v_bitop3_b32 v12, v6, v13, v12 bitop3:0xca
    v_lshl_add_u32 v11, v11, 17, s40
    v_lshlrev_b16 v14, 8, v14
    v_lshrrev_b32 v13, 2, v73
    v_add_u32 v69, v12, v11
    v_bitop3_b32 v73, v5, v13, v14 bitop3:0xea
    ds_add_u32 v73, v2
    v_cvt_pk_bf16_f32 v66, v7, v8
    v_perm_b32 v12, v66, v66, s41
    v_bitop3_b32 v68, v4, v12, v68 bitop3:0xca
    v_perm_b32 v13, v66, v66, s42
    v_bitop3_b32 v69, v4, v13, v69 bitop3:0xca
    v_mul_hi_u32_u24 v14, 429497, v70
    v_lshrrev_b32 v12, 3, v74
    v_cos_f32 v9, v9
    v_lshlrev_b16 v13, 3, v74
    v_mad_i32_i24 v11, v14, s55, v70
    v_bitop3_b32 v12, v6, v13, v12 bitop3:0xca
    v_lshl_add_u32 v11, v11, 17, s40
    v_lshlrev_b16 v14, 8, v14
    v_lshrrev_b32 v13, 2, v74
    v_add_u32 v70, v12, v11
    v_bitop3_b32 v74, v5, v13, v14 bitop3:0xea
    ds_add_u32 v74, v2
    v_mul_hi_u32_u24 v14, 429497, v71
    v_lshrrev_b32 v12, 3, v75
    v_cos_f32 v10, v10
    v_lshlrev_b16 v13, 3, v75
    v_mad_i32_i24 v11, v14, s55, v71
    v_bitop3_b32 v12, v6, v13, v12 bitop3:0xca
    v_lshl_add_u32 v11, v11, 17, s40
    v_lshlrev_b16 v14, 8, v14
    v_lshrrev_b32 v13, 2, v75
    v_add_u32 v71, v12, v11
    v_bitop3_b32 v75, v5, v13, v14 bitop3:0xea
    ds_add_u32 v75, v2
    v_cvt_pk_bf16_f32 v67, v9, v10
    v_perm_b32 v12, v67, v67, s41
    v_bitop3_b32 v70, v4, v12, v70 bitop3:0xca
    v_perm_b32 v13, v67, v67, s42
    v_bitop3_b32 v71, v4, v13, v71 bitop3:0xca
    s_setprio 0
    s_add_u32 s44, s97, 0x2400000
    buffer_load_dwordx4 v[112:115], v0, s[8:11], s44 offen nt
    s_waitcnt vmcnt(7)
    v_lshlrev_b32 v7, 16, v84
    v_and_b32 v8, 0xffff0000, v84
    v_lshlrev_b32 v9, 16, v85
    v_and_b32 v10, 0xffff0000, v85
    v_mul_f32 v7, 0.15915494, v7
    v_mul_f32 v8, 0.15915494, v8
    v_mul_f32 v9, 0.15915494, v9
    v_mul_f32 v10, 0.15915494, v10
    v_mul_hi_u32_u24 v14, 429497, v76
    v_lshrrev_b32 v12, 3, v80
    v_cos_f32 v7, v7
    v_lshlrev_b16 v13, 3, v80
    v_mad_i32_i24 v11, v14, s55, v76
    v_bitop3_b32 v12, v6, v13, v12 bitop3:0xca
    v_lshl_add_u32 v11, v11, 17, s40
    v_lshlrev_b16 v14, 8, v14
    v_lshrrev_b32 v13, 2, v80
    v_add_u32 v76, v12, v11
    v_bitop3_b32 v80, v5, v13, v14 bitop3:0xea
    ds_add_u32 v80, v2
    v_mul_hi_u32_u24 v14, 429497, v77
    v_lshrrev_b32 v12, 3, v81
    v_cos_f32 v8, v8
    v_lshlrev_b16 v13, 3, v81
    v_mad_i32_i24 v11, v14, s55, v77
    v_bitop3_b32 v12, v6, v13, v12 bitop3:0xca
    v_lshl_add_u32 v11, v11, 17, s40
    v_lshlrev_b16 v14, 8, v14
    v_lshrrev_b32 v13, 2, v81
    v_add_u32 v77, v12, v11
    v_bitop3_b32 v81, v5, v13, v14 bitop3:0xea
    ds_add_u32 v81, v2
    v_cvt_pk_bf16_f32 v84, v7, v8
    v_perm_b32 v12, v84, v84, s41
    v_bitop3_b32 v76, v4, v12, v76 bitop3:0xca
    v_perm_b32 v13, v84, v84, s42
    v_bitop3_b32 v77, v4, v13, v77 bitop3:0xca
    v_mul_hi_u32_u24 v14, 429497, v78
    v_lshrrev_b32 v12, 3, v82
    v_cos_f32 v9, v9
    v_lshlrev_b16 v13, 3, v82
    v_mad_i32_i24 v11, v14, s55, v78
    v_bitop3_b32 v12, v6, v13, v12 bitop3:0xca
    v_lshl_add_u32 v11, v11, 17, s40
    v_lshlrev_b16 v14, 8, v14
    v_lshrrev_b32 v13, 2, v82
    v_add_u32 v78, v12, v11
    v_bitop3_b32 v82, v5, v13, v14 bitop3:0xea
    ds_add_u32 v82, v2
    v_mul_hi_u32_u24 v14, 429497, v79
    v_lshrrev_b32 v12, 3, v83
    v_cos_f32 v10, v10
    v_lshlrev_b16 v13, 3, v83
    v_mad_i32_i24 v11, v14, s55, v79
    v_bitop3_b32 v12, v6, v13, v12 bitop3:0xca
    v_lshl_add_u32 v11, v11, 17, s40
    v_lshlrev_b16 v14, 8, v14
    v_lshrrev_b32 v13, 2, v83
    v_add_u32 v79, v12, v11
    v_bitop3_b32 v83, v5, v13, v14 bitop3:0xea
    ds_add_u32 v83, v2
    v_cvt_pk_bf16_f32 v85, v9, v10
    v_perm_b32 v12, v85, v85, s41
    v_bitop3_b32 v78, v4, v12, v78 bitop3:0xca
    v_perm_b32 v13, v85, v85, s42
    v_bitop3_b32 v79, v4, v13, v79 bitop3:0xca
    s_waitcnt vmcnt(5)
    v_lshlrev_b32 v7, 16, v86
    v_and_b32 v8, 0xffff0000, v86
    v_lshlrev_b32 v9, 16, v87
    v_and_b32 v10, 0xffff0000, v87
    v_mul_f32 v7, 0.15915494, v7
    v_mul_f32 v8, 0.15915494, v8
    v_mul_f32 v9, 0.15915494, v9
    v_mul_f32 v10, 0.15915494, v10
    v_mul_hi_u32_u24 v14, 429497, v88
    v_lshrrev_b32 v12, 3, v92
    v_cos_f32 v7, v7
    v_lshlrev_b16 v13, 3, v92
    v_mad_i32_i24 v11, v14, s55, v88
    v_bitop3_b32 v12, v6, v13, v12 bitop3:0xca
    v_lshl_add_u32 v11, v11, 17, s40
    v_lshlrev_b16 v14, 8, v14
    v_lshrrev_b32 v13, 2, v92
    v_add_u32 v88, v12, v11
    v_bitop3_b32 v92, v5, v13, v14 bitop3:0xea
    ds_add_u32 v92, v2
    v_mul_hi_u32_u24 v14, 429497, v89
    v_lshrrev_b32 v12, 3, v93
    v_cos_f32 v8, v8
    v_lshlrev_b16 v13, 3, v93
    v_mad_i32_i24 v11, v14, s55, v89
    v_bitop3_b32 v12, v6, v13, v12 bitop3:0xca
    v_lshl_add_u32 v11, v11, 17, s40
    v_lshlrev_b16 v14, 8, v14
    v_lshrrev_b32 v13, 2, v93
    v_add_u32 v89, v12, v11
    v_bitop3_b32 v93, v5, v13, v14 bitop3:0xea
    ds_add_u32 v93, v2
    v_cvt_pk_bf16_f32 v86, v7, v8
    v_perm_b32 v12, v86, v86, s41
    v_bitop3_b32 v88, v4, v12, v88 bitop3:0xca
    v_perm_b32 v13, v86, v86, s42
    v_bitop3_b32 v89, v4, v13, v89 bitop3:0xca
    v_mul_hi_u32_u24 v14, 429497, v90
    v_lshrrev_b32 v12, 3, v94
    v_cos_f32 v9, v9
    v_lshlrev_b16 v13, 3, v94
    v_mad_i32_i24 v11, v14, s55, v90
    v_bitop3_b32 v12, v6, v13, v12 bitop3:0xca
    v_lshl_add_u32 v11, v11, 17, s40
    v_lshlrev_b16 v14, 8, v14
    v_lshrrev_b32 v13, 2, v94
    v_add_u32 v90, v12, v11
    v_bitop3_b32 v94, v5, v13, v14 bitop3:0xea
    ds_add_u32 v94, v2
    v_mul_hi_u32_u24 v14, 429497, v91
    v_lshrrev_b32 v12, 3, v95
    v_cos_f32 v10, v10
    v_lshlrev_b16 v13, 3, v95
    v_mad_i32_i24 v11, v14, s55, v91
    v_bitop3_b32 v12, v6, v13, v12 bitop3:0xca
    v_lshl_add_u32 v11, v11, 17, s40
    v_lshlrev_b16 v14, 8, v14
    v_lshrrev_b32 v13, 2, v95
    v_add_u32 v91, v12, v11
    v_bitop3_b32 v95, v5, v13, v14 bitop3:0xea
    ds_add_u32 v95, v2
    v_cvt_pk_bf16_f32 v87, v9, v10
    v_perm_b32 v12, v87, v87, s41
    v_bitop3_b32 v90, v4, v12, v90 bitop3:0xca
    v_perm_b32 v13, v87, v87, s42
    v_bitop3_b32 v91, v4, v13, v91 bitop3:0xca
    v_lshrrev_b32 v8, 2, v0
    v_and_b32 v7, 0x3c00, v0
    v_bitop3_b32 v7, v5, v8, v7 bitop3:0xea
    s_waitcnt lgkmcnt(0)
    s_barrier
    ds_read2st64_b32 v[8:9], v7 offset0:0 offset1:1
    ds_read2st64_b32 v[10:11], v7 offset0:2 offset1:3
    s_add_u32 s45, s97, 0x2400000
    buffer_load_dwordx4 v[100:103], v0, s[12:15], s45 offen nt
    s_waitcnt lgkmcnt(0)
    v_lshl_or_b32 v12, v9, 16, v8
    v_lshl_or_b32 v13, v11, 16, v10
    v_mov_b32 v14, v12
    v_mov_b32 v15, v13
    s_nop 0
    v_add_u32_dpp v14, v14, v14 row_shr:1 row_mask:0xf bank_mask:0xf bound_ctrl:1
    v_add_u32_dpp v15, v15, v15 row_shr:1 row_mask:0xf bank_mask:0xf bound_ctrl:1
    s_nop 0
    v_add_u32_dpp v14, v14, v14 row_shr:2 row_mask:0xf bank_mask:0xf bound_ctrl:1
    v_add_u32_dpp v15, v15, v15 row_shr:2 row_mask:0xf bank_mask:0xf bound_ctrl:1
    s_nop 0
    v_add_u32_dpp v14, v14, v14 row_shr:4 row_mask:0xf bank_mask:0xf bound_ctrl:1
    v_add_u32_dpp v15, v15, v15 row_shr:4 row_mask:0xf bank_mask:0xf bound_ctrl:1
    s_nop 0
    v_add_u32_dpp v14, v14, v14 row_shr:8 row_mask:0xf bank_mask:0xf bound_ctrl:1
    v_add_u32_dpp v15, v15, v15 row_shr:8 row_mask:0xf bank_mask:0xf bound_ctrl:1
    s_nop 0
    v_add_u32_dpp v14, v14, v14 row_bcast:15 row_mask:0xa bank_mask:0xf
    v_add_u32_dpp v15, v15, v15 row_bcast:15 row_mask:0xa bank_mask:0xf
    s_nop 0
    v_add_u32_dpp v14, v14, v14 row_bcast:31 row_mask:0xc bank_mask:0xf
    v_add_u32_dpp v15, v15, v15 row_bcast:31 row_mask:0xc bank_mask:0xf
    v_readlane_b32 s48, v14, 63
    v_readlane_b32 s49, v15, 63
    s_lshl_b32 s54, s32, 2
    v_mov_b32 v8, s54
    s_and_b32 s50, s48, 0xffff
    s_lshr_b32 s51, s48, 16
    s_and_b32 s52, s49, 0xffff
    s_lshr_b32 s53, s49, 16
    s_add_u32 s51, s51, s50
    s_add_u32 s52, s52, s51
    s_add_u32 s53, s53, s52
    v_mov_b32 v9, s53
    s_mov_b64 exec, 1
    ds_write_b32 v8, v9 offset:16384
    s_mov_b64 exec, -1
    v_and_b32 v8, 60, v7
    s_waitcnt lgkmcnt(0)
    s_barrier
    ds_read_b32 v9, v8 offset:16384
    s_waitcnt lgkmcnt(0)
    v_add_u32_dpp v9, v9, v9 row_shr:1 row_mask:0xf bank_mask:0xf bound_ctrl:1
    s_nop 1
    v_add_u32_dpp v9, v9, v9 row_shr:2 row_mask:0xf bank_mask:0xf bound_ctrl:1
    s_nop 1
    v_add_u32_dpp v9, v9, v9 row_shr:4 row_mask:0xf bank_mask:0xf bound_ctrl:1
    s_nop 1
    v_add_u32_dpp v9, v9, v9 row_shr:8 row_mask:0xf bank_mask:0xf bound_ctrl:1
    s_nop 0
    v_readlane_b32 s54, v9, s32
    s_sub_u32 s54, s54, s53
    s_add_u32 s50, s50, s54
    s_add_u32 s51, s51, s54
    s_add_u32 s52, s52, s54
    s_pack_ll_b32_b16 s48, s54, s50
    s_pack_ll_b32_b16 s49, s51, s52
    v_add_u32 v14, s48, v14
    v_add_u32 v15, s49, v15
    v_sub_u32 v12, v14, v12
    v_sub_u32 v13, v15, v13
    v_and_b32 v8, 0xffff, v12
    v_lshrrev_b32 v9, 16, v12
    v_and_b32 v10, 0xffff, v13
    v_lshrrev_b32 v11, 16, v13
    ds_write2st64_b32 v7, v8, v9 offset0:0 offset1:1
    ds_write2st64_b32 v7, v10, v11 offset0:2 offset1:3
    v_and_b32 v8, 0x3f0, v0
    v_lshl_add_u32 v8, v8, 1, s36
    ds_write_b64 v8, v[12:13] offset:20480
    s_bitset0_b64 exec, 63
    s_not_b64 exec, exec
    ds_write_b64 v8, v[14:15] offset:20512
    s_mov_b64 exec, -1
    s_waitcnt lgkmcnt(0)
    s_barrier
    s_setprio 3
    ds_add_rtn_u32 v20, v20, v2
    ds_add_rtn_u32 v21, v21, v2
    ds_add_rtn_u32 v22, v22, v2
    ds_add_rtn_u32 v23, v23, v2
    ds_read_b128 v[12:15], v0 offset:20480
    v_cmp_gt_u32 vcc, 8448, v0
    ds_add_rtn_u32 v32, v32, v2
    ds_add_rtn_u32 v33, v33, v2
    ds_add_rtn_u32 v34, v34, v2
    ds_add_rtn_u32 v35, v35, v2
    s_setprio 2
    ds_add_rtn_u32 v40, v40, v2
    ds_add_rtn_u32 v41, v41, v2
    ds_add_rtn_u32 v42, v42, v2
    ds_add_rtn_u32 v43, v43, v2
    s_waitcnt lgkmcnt(8)
    s_cbranch_vccz L1_p1
    s_add_u32 s46, s35, 0x0
    s_mov_b64 exec, vcc
    buffer_store_dwordx4 v[12:15], v0, s[24:27], s46 offen sc1
    s_mov_b64 exec, -1
L1_p1:
    s_add_u32 s47, s98, 0x2800000
    buffer_load_dwordx4 v[116:119], v0, s[8:11], s47 offen nt
    ds_add_rtn_u32 v52, v52, v2
    ds_add_rtn_u32 v53, v53, v2
    ds_add_rtn_u32 v54, v54, v2
    ds_add_rtn_u32 v55, v55, v2
    s_setprio 1
    ds_add_rtn_u32 v60, v60, v2
    ds_add_rtn_u32 v61, v61, v2
    ds_add_rtn_u32 v62, v62, v2
    ds_add_rtn_u32 v63, v63, v2
    ds_add_rtn_u32 v72, v72, v2
    ds_add_rtn_u32 v73, v73, v2
    ds_add_rtn_u32 v74, v74, v2
    ds_add_rtn_u32 v75, v75, v2
    s_add_u32 s44, s98, 0x2800000
    buffer_load_dwordx4 v[120:123], v0, s[12:15], s44 offen nt
    s_setprio 0
    ds_add_rtn_u32 v80, v80, v2
    ds_add_rtn_u32 v81, v81, v2
    ds_add_rtn_u32 v82, v82, v2
    ds_add_rtn_u32 v83, v83, v2
    ds_add_rtn_u32 v92, v92, v2
    ds_add_rtn_u32 v93, v93, v2
    ds_add_rtn_u32 v94, v94, v2
    ds_add_rtn_u32 v95, v95, v2
    s_waitcnt lgkmcnt(0)
    s_barrier
    s_setprio 3
    v_and_b32 v7, -4, v20
    v_lshl_add_u32 v8, v20, 2, v7
    ds_write_b32 v8, v16
    v_lshl_add_u32 v7, v7, 2, v20
    ds_write_b8 v7, v24 offset:16
    v_and_b32 v9, -4, v21
    v_lshl_add_u32 v10, v21, 2, v9
    ds_write_b32 v10, v17
    v_lshl_add_u32 v9, v9, 2, v21
    ds_write_b8_d16_hi v9, v24 offset:16
    v_and_b32 v7, -4, v22
    v_lshl_add_u32 v8, v22, 2, v7
    ds_write_b32 v8, v18
    v_lshl_add_u32 v7, v7, 2, v22
    ds_write_b8 v7, v25 offset:16
    v_and_b32 v9, -4, v23
    v_lshl_add_u32 v10, v23, 2, v9
    ds_write_b32 v10, v19
    v_lshl_add_u32 v9, v9, 2, v23
    ds_write_b8_d16_hi v9, v25 offset:16
    s_add_u32 s45, s98, 0x2800000
    s_lshr_b32 s45, s45, 1
    buffer_load_dwordx2 v[124:125], v1, s[16:19], s45 offen nt
    s_add_u32 s46, s99, 0x2c00000
    s_lshr_b32 s46, s46, 1
    buffer_load_dwordx2 v[126:127], v1, s[16:19], s46 offen nt
    s_add_u32 s47, s99, 0x2c00000
    buffer_load_dwordx4 v[16:19], v0, s[8:11], s47 offen nt
    v_and_b32 v7, -4, v32
    v_lshl_add_u32 v8, v32, 2, v7
    ds_write_b32 v8, v28
    v_lshl_add_u32 v7, v7, 2, v32
    ds_write_b8 v7, v26 offset:16
    v_and_b32 v9, -4, v33
    v_lshl_add_u32 v10, v33, 2, v9
    ds_write_b32 v10, v29
    v_lshl_add_u32 v9, v9, 2, v33
    ds_write_b8_d16_hi v9, v26 offset:16
    v_and_b32 v7, -4, v34
    v_lshl_add_u32 v8, v34, 2, v7
    ds_write_b32 v8, v30
    v_lshl_add_u32 v7, v7, 2, v34
    ds_write_b8 v7, v27 offset:16
    v_and_b32 v9, -4, v35
    v_lshl_add_u32 v10, v35, 2, v9
    ds_write_b32 v10, v31
    v_lshl_add_u32 v9, v9, 2, v35
    ds_write_b8_d16_hi v9, v27 offset:16
    s_add_u32 s44, s99, 0x2c00000
    buffer_load_dwordx4 v[20:23], v0, s[12:15], s44 offen nt
    s_setprio 2
    v_and_b32 v7, -4, v40
    v_lshl_add_u32 v8, v40, 2, v7
    ds_write_b32 v8, v36
    v_lshl_add_u32 v7, v7, 2, v40
    ds_write_b8 v7, v44 offset:16
    v_and_b32 v9, -4, v41
    v_lshl_add_u32 v10, v41, 2, v9
    ds_write_b32 v10, v37
    v_lshl_add_u32 v9, v9, 2, v41
    ds_write_b8_d16_hi v9, v44 offset:16
    v_and_b32 v7, -4, v42
    v_lshl_add_u32 v8, v42, 2, v7
    ds_write_b32 v8, v38
    v_lshl_add_u32 v7, v7, 2, v42
    ds_write_b8 v7, v45 offset:16
    v_and_b32 v9, -4, v43
    v_lshl_add_u32 v10, v43, 2, v9
    ds_write_b32 v10, v39
    v_lshl_add_u32 v9, v9, 2, v43
    ds_write_b8_d16_hi v9, v45 offset:16
    s_add_u32 s45, s96, 0x3000000
    buffer_load_dwordx4 v[28:31], v0, s[8:11], s45 offen nt
    s_add_u32 s46, s96, 0x3000000
    buffer_load_dwordx4 v[32:35], v0, s[12:15], s46 offen nt
    v_and_b32 v7, -4, v52
    v_lshl_add_u32 v8, v52, 2, v7
    ds_write_b32 v8, v48
    v_lshl_add_u32 v7, v7, 2, v52
    ds_write_b8 v7, v46 offset:16
    v_and_b32 v9, -4, v53
    v_lshl_add_u32 v10, v53, 2, v9
    ds_write_b32 v10, v49
    v_lshl_add_u32 v9, v9, 2, v53
    ds_write_b8_d16_hi v9, v46 offset:16
    v_and_b32 v7, -4, v54
    v_lshl_add_u32 v8, v54, 2, v7
    ds_write_b32 v8, v50
    v_lshl_add_u32 v7, v7, 2, v54
    ds_write_b8 v7, v47 offset:16
    v_and_b32 v9, -4, v55
    v_lshl_add_u32 v10, v55, 2, v9
    ds_write_b32 v10, v51
    v_lshl_add_u32 v9, v9, 2, v55
    ds_write_b8_d16_hi v9, v47 offset:16
    s_add_u32 s47, s96, 0x3000000
    s_lshr_b32 s47, s47, 1
    buffer_load_dwordx2 v[24:25], v1, s[16:19], s47 offen nt
    s_add_u32 s44, s97, 0x3400000
    s_lshr_b32 s44, s44, 1
    buffer_load_dwordx2 v[26:27], v1, s[16:19], s44 offen nt
    s_setprio 1
    v_and_b32 v7, -4, v60
    v_lshl_add_u32 v8, v60, 2, v7
    ds_write_b32 v8, v56
    v_lshl_add_u32 v7, v7, 2, v60
    ds_write_b8 v7, v64 offset:16
    v_and_b32 v9, -4, v61
    v_lshl_add_u32 v10, v61, 2, v9
    ds_write_b32 v10, v57
    v_lshl_add_u32 v9, v9, 2, v61
    ds_write_b8_d16_hi v9, v64 offset:16
    v_and_b32 v7, -4, v62
    v_lshl_add_u32 v8, v62, 2, v7
    ds_write_b32 v8, v58
    v_lshl_add_u32 v7, v7, 2, v62
    ds_write_b8 v7, v65 offset:16
    v_and_b32 v9, -4, v63
    v_lshl_add_u32 v10, v63, 2, v9
    ds_write_b32 v10, v59
    v_lshl_add_u32 v9, v9, 2, v63
    ds_write_b8_d16_hi v9, v65 offset:16
    s_add_u32 s45, s97, 0x3400000
    buffer_load_dwordx4 v[36:39], v0, s[8:11], s45 offen nt
    v_and_b32 v7, -4, v72
    v_lshl_add_u32 v8, v72, 2, v7
    ds_write_b32 v8, v68
    v_lshl_add_u32 v7, v7, 2, v72
    ds_write_b8 v7, v66 offset:16
    v_and_b32 v9, -4, v73
    v_lshl_add_u32 v10, v73, 2, v9
    ds_write_b32 v10, v69
    v_lshl_add_u32 v9, v9, 2, v73
    ds_write_b8_d16_hi v9, v66 offset:16
    v_and_b32 v7, -4, v74
    v_lshl_add_u32 v8, v74, 2, v7
    ds_write_b32 v8, v70
    v_lshl_add_u32 v7, v7, 2, v74
    ds_write_b8 v7, v67 offset:16
    v_and_b32 v9, -4, v75
    v_lshl_add_u32 v10, v75, 2, v9
    ds_write_b32 v10, v71
    v_lshl_add_u32 v9, v9, 2, v75
    ds_write_b8_d16_hi v9, v67 offset:16
    s_add_u32 s46, s97, 0x3400000
    buffer_load_dwordx4 v[40:43], v0, s[12:15], s46 offen nt
    s_add_u32 s47, s98, 0x3800000
    buffer_load_dwordx4 v[48:51], v0, s[8:11], s47 offen nt
    s_setprio 0
    v_and_b32 v7, -4, v80
    v_lshl_add_u32 v8, v80, 2, v7
    ds_write_b32 v8, v76
    v_lshl_add_u32 v7, v7, 2, v80
    ds_write_b8 v7, v84 offset:16
    v_and_b32 v9, -4, v81
    v_lshl_add_u32 v10, v81, 2, v9
    ds_write_b32 v10, v77
    v_lshl_add_u32 v9, v9, 2, v81
    ds_write_b8_d16_hi v9, v84 offset:16
    v_and_b32 v7, -4, v82
    v_lshl_add_u32 v8, v82, 2, v7
    ds_write_b32 v8, v78
    v_lshl_add_u32 v7, v7, 2, v82
    ds_write_b8 v7, v85 offset:16
    v_and_b32 v9, -4, v83
    v_lshl_add_u32 v10, v83, 2, v9
    ds_write_b32 v10, v79
    v_lshl_add_u32 v9, v9, 2, v83
    ds_write_b8_d16_hi v9, v85 offset:16
    s_add_u32 s44, s98, 0x3800000
    buffer_load_dwordx4 v[52:55], v0, s[12:15], s44 offen nt
    v_and_b32 v7, -4, v92
    v_lshl_add_u32 v8, v92, 2, v7
    ds_write_b32 v8, v88
    v_lshl_add_u32 v7, v7, 2, v92
    ds_write_b8 v7, v86 offset:16
    v_and_b32 v9, -4, v93
    v_lshl_add_u32 v10, v93, 2, v9
    ds_write_b32 v10, v89
    v_lshl_add_u32 v9, v9, 2, v93
    ds_write_b8_d16_hi v9, v86 offset:16
    v_and_b32 v7, -4, v94
    v_lshl_add_u32 v8, v94, 2, v7
    ds_write_b32 v8, v90
    v_lshl_add_u32 v7, v7, 2, v94
    ds_write_b8 v7, v87 offset:16
    v_and_b32 v9, -4, v95
    v_lshl_add_u32 v10, v95, 2, v9
    ds_write_b32 v10, v91
    v_lshl_add_u32 v9, v9, 2, v95
    ds_write_b8_d16_hi v9, v87 offset:16
    s_add_u32 s45, s98, 0x3800000
    s_lshr_b32 s45, s45, 1
    buffer_load_dwordx2 v[44:45], v1, s[16:19], s45 offen nt
    s_add_u32 s46, s99, 0x3c00000
    s_lshr_b32 s46, s46, 1
    buffer_load_dwordx2 v[46:47], v1, s[16:19], s46 offen nt
    v_add_u32 v7, 0x10000, v0
    v_add_u32 v12, 0x20000, v0
    v_mov_b32 v8, 0
    v_mov_b32 v9, 0
    v_mov_b32 v10, 0
    v_mov_b32 v11, 0
    s_waitcnt lgkmcnt(0)
    s_barrier
    ds_read_b128 v[56:59], v0 offset:0
    ds_write_b128 v0, v[8:11]
    ds_read_b128 v[60:63], v0 offset:16384
    ds_read_b128 v[68:71], v0 offset:32768
    ds_read_b128 v[72:75], v0 offset:49152
    ds_read_b128 v[64:67], v7 offset:0
    ds_read_b128 v[76:79], v7 offset:16384
    ds_read_b128 v[80:83], v7 offset:32768
    ds_read_b128 v[88:91], v7 offset:49152
    ds_read_b128 v[92:95], v12 offset:0
    ds_read_b128 v[84:87], v12 offset:16384
    s_waitcnt lgkmcnt(0)
    s_barrier
    s_setprio 3
    s_add_u32 s47, s35, 0x0
    buffer_store_dwordx4 v[56:59], v0, s[20:23], s47 offen sc1
    s_add_u32 s44, s99, 0x3c00000
    s_nop 0
    buffer_load_dwordx4 v[56:59], v0, s[8:11], s44 offen nt
    s_add_u32 s45, s35, 0x4000
    buffer_store_dwordx4 v[60:63], v0, s[20:23], s45 offen sc1
    s_add_u32 s46, s99, 0x3c00000
    s_nop 0
    buffer_load_dwordx4 v[60:63], v0, s[12:15], s46 offen nt
    s_waitcnt vmcnt(22)
    v_lshlrev_b32 v7, 16, v108
    v_and_b32 v8, 0xffff0000, v108
    v_lshlrev_b32 v9, 16, v109
    v_and_b32 v10, 0xffff0000, v109
    v_mul_f32 v7, 0.15915494, v7
    v_mul_f32 v8, 0.15915494, v8
    v_mul_f32 v9, 0.15915494, v9
    v_mul_f32 v10, 0.15915494, v10
    v_mul_hi_u32_u24 v14, 429497, v96
    v_lshrrev_b32 v12, 3, v104
    v_cos_f32 v7, v7
    v_lshlrev_b16 v13, 3, v104
    v_mad_i32_i24 v11, v14, s55, v96
    v_bitop3_b32 v12, v6, v13, v12 bitop3:0xca
    v_lshl_add_u32 v11, v11, 17, s40
    v_lshlrev_b16 v14, 8, v14
    v_lshrrev_b32 v13, 2, v104
    v_add_u32 v96, v12, v11
    v_bitop3_b32 v104, v5, v13, v14 bitop3:0xea
    ds_add_u32 v104, v2
    v_mul_hi_u32_u24 v14, 429497, v97
    v_lshrrev_b32 v12, 3, v105
    v_cos_f32 v8, v8
    v_lshlrev_b16 v13, 3, v105
    v_mad_i32_i24 v11, v14, s55, v97
    v_bitop3_b32 v12, v6, v13, v12 bitop3:0xca
    v_lshl_add_u32 v11, v11, 17, s40
    v_lshlrev_b16 v14, 8, v14
    v_lshrrev_b32 v13, 2, v105
    v_add_u32 v97, v12, v11
    v_bitop3_b32 v105, v5, v13, v14 bitop3:0xea
    ds_add_u32 v105, v2
    v_cvt_pk_bf16_f32 v108, v7, v8
    v_perm_b32 v12, v108, v108, s41
    v_bitop3_b32 v96, v4, v12, v96 bitop3:0xca
    v_perm_b32 v13, v108, v108, s42
    v_bitop3_b32 v97, v4, v13, v97 bitop3:0xca
    v_mul_hi_u32_u24 v14, 429497, v98
    v_lshrrev_b32 v12, 3, v106
    v_cos_f32 v9, v9
    v_lshlrev_b16 v13, 3, v106
    v_mad_i32_i24 v11, v14, s55, v98
    v_bitop3_b32 v12, v6, v13, v12 bitop3:0xca
    v_lshl_add_u32 v11, v11, 17, s40
    v_lshlrev_b16 v14, 8, v14
    v_lshrrev_b32 v13, 2, v106
    v_add_u32 v98, v12, v11
    v_bitop3_b32 v106, v5, v13, v14 bitop3:0xea
    ds_add_u32 v106, v2
    v_mul_hi_u32_u24 v14, 429497, v99
    v_lshrrev_b32 v12, 3, v107
    v_cos_f32 v10, v10
    v_lshlrev_b16 v13, 3, v107
    v_mad_i32_i24 v11, v14, s55, v99
    v_bitop3_b32 v12, v6, v13, v12 bitop3:0xca
    v_lshl_add_u32 v11, v11, 17, s40
    v_lshlrev_b16 v14, 8, v14
    v_lshrrev_b32 v13, 2, v107
    v_add_u32 v99, v12, v11
    v_bitop3_b32 v107, v5, v13, v14 bitop3:0xea
    ds_add_u32 v107, v2
    v_cvt_pk_bf16_f32 v109, v9, v10
    v_perm_b32 v12, v109, v109, s41
    v_bitop3_b32 v98, v4, v12, v98 bitop3:0xca
    v_perm_b32 v13, v109, v109, s42
    v_bitop3_b32 v99, v4, v13, v99 bitop3:0xca
    s_waitcnt vmcnt(20)
    v_lshlrev_b32 v7, 16, v110
    v_and_b32 v8, 0xffff0000, v110
    v_lshlrev_b32 v9, 16, v111
    v_and_b32 v10, 0xffff0000, v111
    v_mul_f32 v7, 0.15915494, v7
    v_mul_f32 v8, 0.15915494, v8
    v_mul_f32 v9, 0.15915494, v9
    v_mul_f32 v10, 0.15915494, v10
    v_mul_hi_u32_u24 v14, 429497, v112
    v_lshrrev_b32 v12, 3, v100
    v_cos_f32 v7, v7
    v_lshlrev_b16 v13, 3, v100
    v_mad_i32_i24 v11, v14, s55, v112
    v_bitop3_b32 v12, v6, v13, v12 bitop3:0xca
    v_lshl_add_u32 v11, v11, 17, s40
    v_lshlrev_b16 v14, 8, v14
    v_lshrrev_b32 v13, 2, v100
    v_add_u32 v112, v12, v11
    v_bitop3_b32 v100, v5, v13, v14 bitop3:0xea
    ds_add_u32 v100, v2
    v_mul_hi_u32_u24 v14, 429497, v113
    v_lshrrev_b32 v12, 3, v101
    v_cos_f32 v8, v8
    v_lshlrev_b16 v13, 3, v101
    v_mad_i32_i24 v11, v14, s55, v113
    v_bitop3_b32 v12, v6, v13, v12 bitop3:0xca
    v_lshl_add_u32 v11, v11, 17, s40
    v_lshlrev_b16 v14, 8, v14
    v_lshrrev_b32 v13, 2, v101
    v_add_u32 v113, v12, v11
    v_bitop3_b32 v101, v5, v13, v14 bitop3:0xea
    ds_add_u32 v101, v2
    v_cvt_pk_bf16_f32 v110, v7, v8
    v_perm_b32 v12, v110, v110, s41
    v_bitop3_b32 v112, v4, v12, v112 bitop3:0xca
    v_perm_b32 v13, v110, v110, s42
    v_bitop3_b32 v113, v4, v13, v113 bitop3:0xca
    v_mul_hi_u32_u24 v14, 429497, v114
    v_lshrrev_b32 v12, 3, v102
    v_cos_f32 v9, v9
    v_lshlrev_b16 v13, 3, v102
    v_mad_i32_i24 v11, v14, s55, v114
    v_bitop3_b32 v12, v6, v13, v12 bitop3:0xca
    v_lshl_add_u32 v11, v11, 17, s40
    v_lshlrev_b16 v14, 8, v14
    v_lshrrev_b32 v13, 2, v102
    v_add_u32 v114, v12, v11
    v_bitop3_b32 v102, v5, v13, v14 bitop3:0xea
    ds_add_u32 v102, v2
    v_mul_hi_u32_u24 v14, 429497, v115
    v_lshrrev_b32 v12, 3, v103
    v_cos_f32 v10, v10
    v_lshlrev_b16 v13, 3, v103
    v_mad_i32_i24 v11, v14, s55, v115
    v_bitop3_b32 v12, v6, v13, v12 bitop3:0xca
    v_lshl_add_u32 v11, v11, 17, s40
    v_lshlrev_b16 v14, 8, v14
    v_lshrrev_b32 v13, 2, v103
    v_add_u32 v115, v12, v11
    v_bitop3_b32 v103, v5, v13, v14 bitop3:0xea
    ds_add_u32 v103, v2
    v_cvt_pk_bf16_f32 v111, v9, v10
    v_perm_b32 v12, v111, v111, s41
    v_bitop3_b32 v114, v4, v12, v114 bitop3:0xca
    v_perm_b32 v13, v111, v111, s42
    v_bitop3_b32 v115, v4, v13, v115 bitop3:0xca
    s_setprio 2
    s_waitcnt vmcnt(16)
    v_lshlrev_b32 v7, 16, v124
    v_and_b32 v8, 0xffff0000, v124
    v_lshlrev_b32 v9, 16, v125
    v_and_b32 v10, 0xffff0000, v125
    v_mul_f32 v7, 0.15915494, v7
    v_mul_f32 v8, 0.15915494, v8
    v_mul_f32 v9, 0.15915494, v9
    v_mul_f32 v10, 0.15915494, v10
    v_mul_hi_u32_u24 v14, 429497, v116
    v_lshrrev_b32 v12, 3, v120
    v_cos_f32 v7, v7
    v_lshlrev_b16 v13, 3, v120
    v_mad_i32_i24 v11, v14, s55, v116
    v_bitop3_b32 v12, v6, v13, v12 bitop3:0xca
    v_lshl_add_u32 v11, v11, 17, s40
    v_lshlrev_b16 v14, 8, v14
    v_lshrrev_b32 v13, 2, v120
    v_add_u32 v116, v12, v11
    v_bitop3_b32 v120, v5, v13, v14 bitop3:0xea
    ds_add_u32 v120, v2
    v_mul_hi_u32_u24 v14, 429497, v117
    v_lshrrev_b32 v12, 3, v121
    v_cos_f32 v8, v8
    v_lshlrev_b16 v13, 3, v121
    v_mad_i32_i24 v11, v14, s55, v117
    v_bitop3_b32 v12, v6, v13, v12 bitop3:0xca
    v_lshl_add_u32 v11, v11, 17, s40
    v_lshlrev_b16 v14, 8, v14
    v_lshrrev_b32 v13, 2, v121
    v_add_u32 v117, v12, v11
    v_bitop3_b32 v121, v5, v13, v14 bitop3:0xea
    ds_add_u32 v121, v2
    v_cvt_pk_bf16_f32 v124, v7, v8
    v_perm_b32 v12, v124, v124, s41
    v_bitop3_b32 v116, v4, v12, v116 bitop3:0xca
    v_perm_b32 v13, v124, v124, s42
    v_bitop3_b32 v117, v4, v13, v117 bitop3:0xca
    v_mul_hi_u32_u24 v14, 429497, v118
    v_lshrrev_b32 v12, 3, v122
    v_cos_f32 v9, v9
    v_lshlrev_b16 v13, 3, v122
    v_mad_i32_i24 v11, v14, s55, v118
    v_bitop3_b32 v12, v6, v13, v12 bitop3:0xca
    v_lshl_add_u32 v11, v11, 17, s40
    v_lshlrev_b16 v14, 8, v14
    v_lshrrev_b32 v13, 2, v122
    v_add_u32 v118, v12, v11
    v_bitop3_b32 v122, v5, v13, v14 bitop3:0xea
    ds_add_u32 v122, v2
    v_mul_hi_u32_u24 v14, 429497, v119
    v_lshrrev_b32 v12, 3, v123
    v_cos_f32 v10, v10
    v_lshlrev_b16 v13, 3, v123
    v_mad_i32_i24 v11, v14, s55, v119
    v_bitop3_b32 v12, v6, v13, v12 bitop3:0xca
    v_lshl_add_u32 v11, v11, 17, s40
    v_lshlrev_b16 v14, 8, v14
    v_lshrrev_b32 v13, 2, v123
    v_add_u32 v119, v12, v11
    v_bitop3_b32 v123, v5, v13, v14 bitop3:0xea
    ds_add_u32 v123, v2
    v_cvt_pk_bf16_f32 v125, v9, v10
    v_perm_b32 v12, v125, v125, s41
    v_bitop3_b32 v118, v4, v12, v118 bitop3:0xca
    v_perm_b32 v13, v125, v125, s42
    v_bitop3_b32 v119, v4, v13, v119 bitop3:0xca
    s_add_u32 s47, s35, 0x8000
    buffer_store_dwordx4 v[68:71], v0, s[20:23], s47 offen sc1
    s_add_u32 s44, s96, 0x4000000
    s_nop 0
    buffer_load_dwordx4 v[68:71], v0, s[8:11], s44 offen nt
    s_waitcnt vmcnt(16)
    v_lshlrev_b32 v7, 16, v126
    v_and_b32 v8, 0xffff0000, v126
    v_lshlrev_b32 v9, 16, v127
    v_and_b32 v10, 0xffff0000, v127
    v_mul_f32 v7, 0.15915494, v7
    v_mul_f32 v8, 0.15915494, v8
    v_mul_f32 v9, 0.15915494, v9
    v_mul_f32 v10, 0.15915494, v10
    v_mul_hi_u32_u24 v14, 429497, v16
    v_lshrrev_b32 v12, 3, v20
    v_cos_f32 v7, v7
    v_lshlrev_b16 v13, 3, v20
    v_mad_i32_i24 v11, v14, s55, v16
    v_bitop3_b32 v12, v6, v13, v12 bitop3:0xca
    v_lshl_add_u32 v11, v11, 17, s40
    v_lshlrev_b16 v14, 8, v14
    v_lshrrev_b32 v13, 2, v20
    v_add_u32 v16, v12, v11
    v_bitop3_b32 v20, v5, v13, v14 bitop3:0xea
    ds_add_u32 v20, v2
    v_mul_hi_u32_u24 v14, 429497, v17
    v_lshrrev_b32 v12, 3, v21
    v_cos_f32 v8, v8
    v_lshlrev_b16 v13, 3, v21
    v_mad_i32_i24 v11, v14, s55, v17
    v_bitop3_b32 v12, v6, v13, v12 bitop3:0xca
    v_lshl_add_u32 v11, v11, 17, s40
    v_lshlrev_b16 v14, 8, v14
    v_lshrrev_b32 v13, 2, v21
    v_add_u32 v17, v12, v11
    v_bitop3_b32 v21, v5, v13, v14 bitop3:0xea
    ds_add_u32 v21, v2
    v_cvt_pk_bf16_f32 v126, v7, v8
    v_perm_b32 v12, v126, v126, s41
    v_bitop3_b32 v16, v4, v12, v16 bitop3:0xca
    v_perm_b32 v13, v126, v126, s42
    v_bitop3_b32 v17, v4, v13, v17 bitop3:0xca
    v_mul_hi_u32_u24 v14, 429497, v18
    v_lshrrev_b32 v12, 3, v22
    v_cos_f32 v9, v9
    v_lshlrev_b16 v13, 3, v22
    v_mad_i32_i24 v11, v14, s55, v18
    v_bitop3_b32 v12, v6, v13, v12 bitop3:0xca
    v_lshl_add_u32 v11, v11, 17, s40
    v_lshlrev_b16 v14, 8, v14
    v_lshrrev_b32 v13, 2, v22
    v_add_u32 v18, v12, v11
    v_bitop3_b32 v22, v5, v13, v14 bitop3:0xea
    ds_add_u32 v22, v2
    v_mul_hi_u32_u24 v14, 429497, v19
    v_lshrrev_b32 v12, 3, v23
    v_cos_f32 v10, v10
    v_lshlrev_b16 v13, 3, v23
    v_mad_i32_i24 v11, v14, s55, v19
    v_bitop3_b32 v12, v6, v13, v12 bitop3:0xca
    v_lshl_add_u32 v11, v11, 17, s40
    v_lshlrev_b16 v14, 8, v14
    v_lshrrev_b32 v13, 2, v23
    v_add_u32 v19, v12, v11
    v_bitop3_b32 v23, v5, v13, v14 bitop3:0xea
    ds_add_u32 v23, v2
    v_cvt_pk_bf16_f32 v127, v9, v10
    v_perm_b32 v12, v127, v127, s41
    v_bitop3_b32 v18, v4, v12, v18 bitop3:0xca
    v_perm_b32 v13, v127, v127, s42
    v_bitop3_b32 v19, v4, v13, v19 bitop3:0xca
    s_setprio 1
    s_waitcnt vmcnt(12)
    v_lshlrev_b32 v7, 16, v24
    v_and_b32 v8, 0xffff0000, v24
    v_lshlrev_b32 v9, 16, v25
    v_and_b32 v10, 0xffff0000, v25
    v_mul_f32 v7, 0.15915494, v7
    v_mul_f32 v8, 0.15915494, v8
    v_mul_f32 v9, 0.15915494, v9
    v_mul_f32 v10, 0.15915494, v10
    v_mul_hi_u32_u24 v14, 429497, v28
    v_lshrrev_b32 v12, 3, v32
    v_cos_f32 v7, v7
    v_lshlrev_b16 v13, 3, v32
    v_mad_i32_i24 v11, v14, s55, v28
    v_bitop3_b32 v12, v6, v13, v12 bitop3:0xca
    v_lshl_add_u32 v11, v11, 17, s40
    v_lshlrev_b16 v14, 8, v14
    v_lshrrev_b32 v13, 2, v32
    v_add_u32 v28, v12, v11
    v_bitop3_b32 v32, v5, v13, v14 bitop3:0xea
    ds_add_u32 v32, v2
    v_mul_hi_u32_u24 v14, 429497, v29
    v_lshrrev_b32 v12, 3, v33
    v_cos_f32 v8, v8
    v_lshlrev_b16 v13, 3, v33
    v_mad_i32_i24 v11, v14, s55, v29
    v_bitop3_b32 v12, v6, v13, v12 bitop3:0xca
    v_lshl_add_u32 v11, v11, 17, s40
    v_lshlrev_b16 v14, 8, v14
    v_lshrrev_b32 v13, 2, v33
    v_add_u32 v29, v12, v11
    v_bitop3_b32 v33, v5, v13, v14 bitop3:0xea
    ds_add_u32 v33, v2
    v_cvt_pk_bf16_f32 v24, v7, v8
    v_perm_b32 v12, v24, v24, s41
    v_bitop3_b32 v28, v4, v12, v28 bitop3:0xca
    v_perm_b32 v13, v24, v24, s42
    v_bitop3_b32 v29, v4, v13, v29 bitop3:0xca
    v_mul_hi_u32_u24 v14, 429497, v30
    v_lshrrev_b32 v12, 3, v34
    v_cos_f32 v9, v9
    v_lshlrev_b16 v13, 3, v34
    v_mad_i32_i24 v11, v14, s55, v30
    v_bitop3_b32 v12, v6, v13, v12 bitop3:0xca
    v_lshl_add_u32 v11, v11, 17, s40
    v_lshlrev_b16 v14, 8, v14
    v_lshrrev_b32 v13, 2, v34
    v_add_u32 v30, v12, v11
    v_bitop3_b32 v34, v5, v13, v14 bitop3:0xea
    ds_add_u32 v34, v2
    v_mul_hi_u32_u24 v14, 429497, v31
    v_lshrrev_b32 v12, 3, v35
    v_cos_f32 v10, v10
    v_lshlrev_b16 v13, 3, v35
    v_mad_i32_i24 v11, v14, s55, v31
    v_bitop3_b32 v12, v6, v13, v12 bitop3:0xca
    v_lshl_add_u32 v11, v11, 17, s40
    v_lshlrev_b16 v14, 8, v14
    v_lshrrev_b32 v13, 2, v35
    v_add_u32 v31, v12, v11
    v_bitop3_b32 v35, v5, v13, v14 bitop3:0xea
    ds_add_u32 v35, v2
    v_cvt_pk_bf16_f32 v25, v9, v10
    v_perm_b32 v12, v25, v25, s41
    v_bitop3_b32 v30, v4, v12, v30 bitop3:0xca
    v_perm_b32 v13, v25, v25, s42
    v_bitop3_b32 v31, v4, v13, v31 bitop3:0xca
    s_waitcnt vmcnt(10)
    v_lshlrev_b32 v7, 16, v26
    v_and_b32 v8, 0xffff0000, v26
    v_lshlrev_b32 v9, 16, v27
    v_and_b32 v10, 0xffff0000, v27
    v_mul_f32 v7, 0.15915494, v7
    v_mul_f32 v8, 0.15915494, v8
    v_mul_f32 v9, 0.15915494, v9
    v_mul_f32 v10, 0.15915494, v10
    v_mul_hi_u32_u24 v14, 429497, v36
    v_lshrrev_b32 v12, 3, v40
    v_cos_f32 v7, v7
    v_lshlrev_b16 v13, 3, v40
    v_mad_i32_i24 v11, v14, s55, v36
    v_bitop3_b32 v12, v6, v13, v12 bitop3:0xca
    v_lshl_add_u32 v11, v11, 17, s40
    v_lshlrev_b16 v14, 8, v14
    v_lshrrev_b32 v13, 2, v40
    v_add_u32 v36, v12, v11
    v_bitop3_b32 v40, v5, v13, v14 bitop3:0xea
    ds_add_u32 v40, v2
    v_mul_hi_u32_u24 v14, 429497, v37
    v_lshrrev_b32 v12, 3, v41
    v_cos_f32 v8, v8
    v_lshlrev_b16 v13, 3, v41
    v_mad_i32_i24 v11, v14, s55, v37
    v_bitop3_b32 v12, v6, v13, v12 bitop3:0xca
    v_lshl_add_u32 v11, v11, 17, s40
    v_lshlrev_b16 v14, 8, v14
    v_lshrrev_b32 v13, 2, v41
    v_add_u32 v37, v12, v11
    v_bitop3_b32 v41, v5, v13, v14 bitop3:0xea
    ds_add_u32 v41, v2
    v_cvt_pk_bf16_f32 v26, v7, v8
    v_perm_b32 v12, v26, v26, s41
    v_bitop3_b32 v36, v4, v12, v36 bitop3:0xca
    v_perm_b32 v13, v26, v26, s42
    v_bitop3_b32 v37, v4, v13, v37 bitop3:0xca
    v_mul_hi_u32_u24 v14, 429497, v38
    v_lshrrev_b32 v12, 3, v42
    v_cos_f32 v9, v9
    v_lshlrev_b16 v13, 3, v42
    v_mad_i32_i24 v11, v14, s55, v38
    v_bitop3_b32 v12, v6, v13, v12 bitop3:0xca
    v_lshl_add_u32 v11, v11, 17, s40
    v_lshlrev_b16 v14, 8, v14
    v_lshrrev_b32 v13, 2, v42
    v_add_u32 v38, v12, v11
    v_bitop3_b32 v42, v5, v13, v14 bitop3:0xea
    ds_add_u32 v42, v2
    v_mul_hi_u32_u24 v14, 429497, v39
    v_lshrrev_b32 v12, 3, v43
    v_cos_f32 v10, v10
    v_lshlrev_b16 v13, 3, v43
    v_mad_i32_i24 v11, v14, s55, v39
    v_bitop3_b32 v12, v6, v13, v12 bitop3:0xca
    v_lshl_add_u32 v11, v11, 17, s40
    v_lshlrev_b16 v14, 8, v14
    v_lshrrev_b32 v13, 2, v43
    v_add_u32 v39, v12, v11
    v_bitop3_b32 v43, v5, v13, v14 bitop3:0xea
    ds_add_u32 v43, v2
    v_cvt_pk_bf16_f32 v27, v9, v10
    v_perm_b32 v12, v27, v27, s41
    v_bitop3_b32 v38, v4, v12, v38 bitop3:0xca
    v_perm_b32 v13, v27, v27, s42
    v_bitop3_b32 v39, v4, v13, v39 bitop3:0xca
    s_setprio 0
    s_add_u32 s45, s35, 0xc000
    buffer_store_dwordx4 v[72:75], v0, s[20:23], s45 offen sc1
    s_add_u32 s46, s96, 0x4000000
    s_nop 0
    buffer_load_dwordx4 v[72:75], v0, s[12:15], s46 offen nt
    s_waitcnt vmcnt(8)
    v_lshlrev_b32 v7, 16, v44
    v_and_b32 v8, 0xffff0000, v44
    v_lshlrev_b32 v9, 16, v45
    v_and_b32 v10, 0xffff0000, v45
    v_mul_f32 v7, 0.15915494, v7
    v_mul_f32 v8, 0.15915494, v8
    v_mul_f32 v9, 0.15915494, v9
    v_mul_f32 v10, 0.15915494, v10
    v_mul_hi_u32_u24 v14, 429497, v48
    v_lshrrev_b32 v12, 3, v52
    v_cos_f32 v7, v7
    v_lshlrev_b16 v13, 3, v52
    v_mad_i32_i24 v11, v14, s55, v48
    v_bitop3_b32 v12, v6, v13, v12 bitop3:0xca
    v_lshl_add_u32 v11, v11, 17, s40
    v_lshlrev_b16 v14, 8, v14
    v_lshrrev_b32 v13, 2, v52
    v_add_u32 v48, v12, v11
    v_bitop3_b32 v52, v5, v13, v14 bitop3:0xea
    ds_add_u32 v52, v2
    v_mul_hi_u32_u24 v14, 429497, v49
    v_lshrrev_b32 v12, 3, v53
    v_cos_f32 v8, v8
    v_lshlrev_b16 v13, 3, v53
    v_mad_i32_i24 v11, v14, s55, v49
    v_bitop3_b32 v12, v6, v13, v12 bitop3:0xca
    v_lshl_add_u32 v11, v11, 17, s40
    v_lshlrev_b16 v14, 8, v14
    v_lshrrev_b32 v13, 2, v53
    v_add_u32 v49, v12, v11
    v_bitop3_b32 v53, v5, v13, v14 bitop3:0xea
    ds_add_u32 v53, v2
    v_cvt_pk_bf16_f32 v44, v7, v8
    v_perm_b32 v12, v44, v44, s41
    v_bitop3_b32 v48, v4, v12, v48 bitop3:0xca
    v_perm_b32 v13, v44, v44, s42
    v_bitop3_b32 v49, v4, v13, v49 bitop3:0xca
    v_mul_hi_u32_u24 v14, 429497, v50
    v_lshrrev_b32 v12, 3, v54
    v_cos_f32 v9, v9
    v_lshlrev_b16 v13, 3, v54
    v_mad_i32_i24 v11, v14, s55, v50
    v_bitop3_b32 v12, v6, v13, v12 bitop3:0xca
    v_lshl_add_u32 v11, v11, 17, s40
    v_lshlrev_b16 v14, 8, v14
    v_lshrrev_b32 v13, 2, v54
    v_add_u32 v50, v12, v11
    v_bitop3_b32 v54, v5, v13, v14 bitop3:0xea
    ds_add_u32 v54, v2
    v_mul_hi_u32_u24 v14, 429497, v51
    v_lshrrev_b32 v12, 3, v55
    v_cos_f32 v10, v10
    v_lshlrev_b16 v13, 3, v55
    v_mad_i32_i24 v11, v14, s55, v51
    v_bitop3_b32 v12, v6, v13, v12 bitop3:0xca
    v_lshl_add_u32 v11, v11, 17, s40
    v_lshlrev_b16 v14, 8, v14
    v_lshrrev_b32 v13, 2, v55
    v_add_u32 v51, v12, v11
    v_bitop3_b32 v55, v5, v13, v14 bitop3:0xea
    ds_add_u32 v55, v2
    v_cvt_pk_bf16_f32 v45, v9, v10
    v_perm_b32 v12, v45, v45, s41
    v_bitop3_b32 v50, v4, v12, v50 bitop3:0xca
    v_perm_b32 v13, v45, v45, s42
    v_bitop3_b32 v51, v4, v13, v51 bitop3:0xca
    s_waitcnt vmcnt(4)
    v_lshlrev_b32 v7, 16, v46
    v_and_b32 v8, 0xffff0000, v46
    v_lshlrev_b32 v9, 16, v47
    v_and_b32 v10, 0xffff0000, v47
    v_mul_f32 v7, 0.15915494, v7
    v_mul_f32 v8, 0.15915494, v8
    v_mul_f32 v9, 0.15915494, v9
    v_mul_f32 v10, 0.15915494, v10
    v_mul_hi_u32_u24 v14, 429497, v56
    v_lshrrev_b32 v12, 3, v60
    v_cos_f32 v7, v7
    v_lshlrev_b16 v13, 3, v60
    v_mad_i32_i24 v11, v14, s55, v56
    v_bitop3_b32 v12, v6, v13, v12 bitop3:0xca
    v_lshl_add_u32 v11, v11, 17, s40
    v_lshlrev_b16 v14, 8, v14
    v_lshrrev_b32 v13, 2, v60
    v_add_u32 v56, v12, v11
    v_bitop3_b32 v60, v5, v13, v14 bitop3:0xea
    ds_add_u32 v60, v2
    v_mul_hi_u32_u24 v14, 429497, v57
    v_lshrrev_b32 v12, 3, v61
    v_cos_f32 v8, v8
    v_lshlrev_b16 v13, 3, v61
    v_mad_i32_i24 v11, v14, s55, v57
    v_bitop3_b32 v12, v6, v13, v12 bitop3:0xca
    v_lshl_add_u32 v11, v11, 17, s40
    v_lshlrev_b16 v14, 8, v14
    v_lshrrev_b32 v13, 2, v61
    v_add_u32 v57, v12, v11
    v_bitop3_b32 v61, v5, v13, v14 bitop3:0xea
    ds_add_u32 v61, v2
    v_cvt_pk_bf16_f32 v46, v7, v8
    v_perm_b32 v12, v46, v46, s41
    v_bitop3_b32 v56, v4, v12, v56 bitop3:0xca
    v_perm_b32 v13, v46, v46, s42
    v_bitop3_b32 v57, v4, v13, v57 bitop3:0xca
    v_mul_hi_u32_u24 v14, 429497, v58
    v_lshrrev_b32 v12, 3, v62
    v_cos_f32 v9, v9
    v_lshlrev_b16 v13, 3, v62
    v_mad_i32_i24 v11, v14, s55, v58
    v_bitop3_b32 v12, v6, v13, v12 bitop3:0xca
    v_lshl_add_u32 v11, v11, 17, s40
    v_lshlrev_b16 v14, 8, v14
    v_lshrrev_b32 v13, 2, v62
    v_add_u32 v58, v12, v11
    v_bitop3_b32 v62, v5, v13, v14 bitop3:0xea
    ds_add_u32 v62, v2
    v_mul_hi_u32_u24 v14, 429497, v59
    v_lshrrev_b32 v12, 3, v63
    v_cos_f32 v10, v10
    v_lshlrev_b16 v13, 3, v63
    v_mad_i32_i24 v11, v14, s55, v59
    v_bitop3_b32 v12, v6, v13, v12 bitop3:0xca
    v_lshl_add_u32 v11, v11, 17, s40
    v_lshlrev_b16 v14, 8, v14
    v_lshrrev_b32 v13, 2, v63
    v_add_u32 v59, v12, v11
    v_bitop3_b32 v63, v5, v13, v14 bitop3:0xea
    ds_add_u32 v63, v2
    v_cvt_pk_bf16_f32 v47, v9, v10
    v_perm_b32 v12, v47, v47, s41
    v_bitop3_b32 v58, v4, v12, v58 bitop3:0xca
    v_perm_b32 v13, v47, v47, s42
    v_bitop3_b32 v59, v4, v13, v59 bitop3:0xca
    v_lshrrev_b32 v8, 2, v0
    v_and_b32 v7, 0x3c00, v0
    v_bitop3_b32 v7, v5, v8, v7 bitop3:0xea
    s_waitcnt lgkmcnt(0)
    s_barrier
    ds_read2st64_b32 v[8:9], v7 offset0:0 offset1:1
    ds_read2st64_b32 v[10:11], v7 offset0:2 offset1:3
    s_add_u32 s47, s35, 0x10000
    buffer_store_dwordx4 v[64:67], v0, s[20:23], s47 offen sc1
    s_add_u32 s44, s96, 0x4000000
    s_lshr_b32 s44, s44, 1
    buffer_load_dwordx2 v[64:65], v1, s[16:19], s44 offen nt
    s_add_u32 s45, s97, 0x4400000
    s_lshr_b32 s45, s45, 1
    buffer_load_dwordx2 v[66:67], v1, s[16:19], s45 offen nt
    s_waitcnt lgkmcnt(0)
    v_lshl_or_b32 v12, v9, 16, v8
    v_lshl_or_b32 v13, v11, 16, v10
    v_mov_b32 v14, v12
    v_mov_b32 v15, v13
    s_nop 0
    v_add_u32_dpp v14, v14, v14 row_shr:1 row_mask:0xf bank_mask:0xf bound_ctrl:1
    v_add_u32_dpp v15, v15, v15 row_shr:1 row_mask:0xf bank_mask:0xf bound_ctrl:1
    s_nop 0
    v_add_u32_dpp v14, v14, v14 row_shr:2 row_mask:0xf bank_mask:0xf bound_ctrl:1
    v_add_u32_dpp v15, v15, v15 row_shr:2 row_mask:0xf bank_mask:0xf bound_ctrl:1
    s_nop 0
    v_add_u32_dpp v14, v14, v14 row_shr:4 row_mask:0xf bank_mask:0xf bound_ctrl:1
    v_add_u32_dpp v15, v15, v15 row_shr:4 row_mask:0xf bank_mask:0xf bound_ctrl:1
    s_nop 0
    v_add_u32_dpp v14, v14, v14 row_shr:8 row_mask:0xf bank_mask:0xf bound_ctrl:1
    v_add_u32_dpp v15, v15, v15 row_shr:8 row_mask:0xf bank_mask:0xf bound_ctrl:1
    s_nop 0
    v_add_u32_dpp v14, v14, v14 row_bcast:15 row_mask:0xa bank_mask:0xf
    v_add_u32_dpp v15, v15, v15 row_bcast:15 row_mask:0xa bank_mask:0xf
    s_nop 0
    v_add_u32_dpp v14, v14, v14 row_bcast:31 row_mask:0xc bank_mask:0xf
    v_add_u32_dpp v15, v15, v15 row_bcast:31 row_mask:0xc bank_mask:0xf
    v_readlane_b32 s48, v14, 63
    v_readlane_b32 s49, v15, 63
    s_lshl_b32 s54, s32, 2
    v_mov_b32 v8, s54
    s_and_b32 s50, s48, 0xffff
    s_lshr_b32 s51, s48, 16
    s_and_b32 s52, s49, 0xffff
    s_lshr_b32 s53, s49, 16
    s_add_u32 s51, s51, s50
    s_add_u32 s52, s52, s51
    s_add_u32 s53, s53, s52
    v_mov_b32 v9, s53
    s_mov_b64 exec, 1
    ds_write_b32 v8, v9 offset:16384
    s_mov_b64 exec, -1
    v_and_b32 v8, 60, v7
    s_waitcnt lgkmcnt(0)
    s_barrier
    ds_read_b32 v9, v8 offset:16384
    s_waitcnt lgkmcnt(0)
    v_add_u32_dpp v9, v9, v9 row_shr:1 row_mask:0xf bank_mask:0xf bound_ctrl:1
    s_nop 1
    v_add_u32_dpp v9, v9, v9 row_shr:2 row_mask:0xf bank_mask:0xf bound_ctrl:1
    s_nop 1
    v_add_u32_dpp v9, v9, v9 row_shr:4 row_mask:0xf bank_mask:0xf bound_ctrl:1
    s_nop 1
    v_add_u32_dpp v9, v9, v9 row_shr:8 row_mask:0xf bank_mask:0xf bound_ctrl:1
    s_nop 0
    v_readlane_b32 s54, v9, s32
    s_sub_u32 s54, s54, s53
    s_add_u32 s50, s50, s54
    s_add_u32 s51, s51, s54
    s_add_u32 s52, s52, s54
    s_pack_ll_b32_b16 s48, s54, s50
    s_pack_ll_b32_b16 s49, s51, s52
    v_add_u32 v14, s48, v14
    v_add_u32 v15, s49, v15
    v_sub_u32 v12, v14, v12
    v_sub_u32 v13, v15, v13
    v_and_b32 v8, 0xffff, v12
    v_lshrrev_b32 v9, 16, v12
    v_and_b32 v10, 0xffff, v13
    v_lshrrev_b32 v11, 16, v13
    ds_write2st64_b32 v7, v8, v9 offset0:0 offset1:1
    ds_write2st64_b32 v7, v10, v11 offset0:2 offset1:3
    v_and_b32 v8, 0x3f0, v0
    v_lshl_add_u32 v8, v8, 1, s36
    ds_write_b64 v8, v[12:13] offset:20480
    s_bitset0_b64 exec, 63
    s_not_b64 exec, exec
    ds_write_b64 v8, v[14:15] offset:20512
    s_mov_b64 exec, -1
    s_waitcnt lgkmcnt(0)
    s_barrier
    s_setprio 3
    ds_add_rtn_u32 v104, v104, v2
    ds_add_rtn_u32 v105, v105, v2
    ds_add_rtn_u32 v106, v106, v2
    ds_add_rtn_u32 v107, v107, v2
    ds_read_b128 v[12:15], v0 offset:20480
    v_cmp_gt_u32 vcc, 8448, v0
    ds_add_rtn_u32 v100, v100, v2
    ds_add_rtn_u32 v101, v101, v2
    ds_add_rtn_u32 v102, v102, v2
    ds_add_rtn_u32 v103, v103, v2
    s_setprio 2
    ds_add_rtn_u32 v120, v120, v2
    ds_add_rtn_u32 v121, v121, v2
    ds_add_rtn_u32 v122, v122, v2
    ds_add_rtn_u32 v123, v123, v2
    s_waitcnt lgkmcnt(8)
    s_cbranch_vccz L1_p2
    s_add_u32 s46, s35, 0x2a40000
    s_mov_b64 exec, vcc
    buffer_store_dwordx4 v[12:15], v0, s[24:27], s46 offen sc1
    s_mov_b64 exec, -1
L1_p2:
    s_add_u32 s47, s35, 0x14000
    buffer_store_dwordx4 v[76:79], v0, s[20:23], s47 offen sc1
    s_add_u32 s44, s97, 0x4400000
    s_nop 0
    buffer_load_dwordx4 v[76:79], v0, s[8:11], s44 offen nt
    ds_add_rtn_u32 v20, v20, v2
    ds_add_rtn_u32 v21, v21, v2
    ds_add_rtn_u32 v22, v22, v2
    ds_add_rtn_u32 v23, v23, v2
    s_setprio 1
    ds_add_rtn_u32 v32, v32, v2
    ds_add_rtn_u32 v33, v33, v2
    ds_add_rtn_u32 v34, v34, v2
    ds_add_rtn_u32 v35, v35, v2
    ds_add_rtn_u32 v40, v40, v2
    ds_add_rtn_u32 v41, v41, v2
    ds_add_rtn_u32 v42, v42, v2
    ds_add_rtn_u32 v43, v43, v2
    s_add_u32 s45, s35, 0x18000
    buffer_store_dwordx4 v[80:83], v0, s[20:23], s45 offen sc1
    s_add_u32 s46, s97, 0x4400000
    s_nop 0
    buffer_load_dwordx4 v[80:83], v0, s[12:15], s46 offen nt
    s_setprio 0
    ds_add_rtn_u32 v52, v52, v2
    ds_add_rtn_u32 v53, v53, v2
    ds_add_rtn_u32 v54, v54, v2
    ds_add_rtn_u32 v55, v55, v2
    ds_add_rtn_u32 v60, v60, v2
    ds_add_rtn_u32 v61, v61, v2
    ds_add_rtn_u32 v62, v62, v2
    ds_add_rtn_u32 v63, v63, v2
    s_waitcnt lgkmcnt(0)
    s_barrier
    s_setprio 3
    v_and_b32 v7, -4, v104
    v_lshl_add_u32 v8, v104, 2, v7
    ds_write_b32 v8, v96
    v_lshl_add_u32 v7, v7, 2, v104
    ds_write_b8 v7, v108 offset:16
    v_and_b32 v9, -4, v105
    v_lshl_add_u32 v10, v105, 2, v9
    ds_write_b32 v10, v97
    v_lshl_add_u32 v9, v9, 2, v105
    ds_write_b8_d16_hi v9, v108 offset:16
    v_and_b32 v7, -4, v106
    v_lshl_add_u32 v8, v106, 2, v7
    ds_write_b32 v8, v98
    v_lshl_add_u32 v7, v7, 2, v106
    ds_write_b8 v7, v109 offset:16
    v_and_b32 v9, -4, v107
    v_lshl_add_u32 v10, v107, 2, v9
    ds_write_b32 v10, v99
    v_lshl_add_u32 v9, v9, 2, v107
    ds_write_b8_d16_hi v9, v109 offset:16
    s_add_u32 s47, s35, 0x1c000
    buffer_store_dwordx4 v[88:91], v0, s[20:23], s47 offen sc1
    s_add_u32 s44, s98, 0x4800000
    buffer_load_dwordx4 v[96:99], v0, s[8:11], s44 offen nt
    s_add_u32 s45, s98, 0x4800000
    buffer_load_dwordx4 v[104:107], v0, s[12:15], s45 offen nt
    v_and_b32 v7, -4, v100
    v_lshl_add_u32 v8, v100, 2, v7
    ds_write_b32 v8, v112
    v_lshl_add_u32 v7, v7, 2, v100
    ds_write_b8 v7, v110 offset:16
    v_and_b32 v9, -4, v101
    v_lshl_add_u32 v10, v101, 2, v9
    ds_write_b32 v10, v113
    v_lshl_add_u32 v9, v9, 2, v101
    ds_write_b8_d16_hi v9, v110 offset:16
    v_and_b32 v7, -4, v102
    v_lshl_add_u32 v8, v102, 2, v7
    ds_write_b32 v8, v114
    v_lshl_add_u32 v7, v7, 2, v102
    ds_write_b8 v7, v111 offset:16
    v_and_b32 v9, -4, v103
    v_lshl_add_u32 v10, v103, 2, v9
    ds_write_b32 v10, v115
    v_lshl_add_u32 v9, v9, 2, v103
    ds_write_b8_d16_hi v9, v111 offset:16
    s_add_u32 s46, s98, 0x4800000
    s_lshr_b32 s46, s46, 1
    buffer_load_dwordx2 v[88:89], v1, s[16:19], s46 offen nt
    s_add_u32 s47, s99, 0x4c00000
    s_lshr_b32 s47, s47, 1
    buffer_load_dwordx2 v[90:91], v1, s[16:19], s47 offen nt
    s_add_u32 s44, s99, 0x4c00000
    buffer_load_dwordx4 v[112:115], v0, s[8:11], s44 offen nt
    s_setprio 2
    v_and_b32 v7, -4, v120
    v_lshl_add_u32 v8, v120, 2, v7
    ds_write_b32 v8, v116
    v_lshl_add_u32 v7, v7, 2, v120
    ds_write_b8 v7, v124 offset:16
    v_and_b32 v9, -4, v121
    v_lshl_add_u32 v10, v121, 2, v9
    ds_write_b32 v10, v117
    v_lshl_add_u32 v9, v9, 2, v121
    ds_write_b8_d16_hi v9, v124 offset:16
    v_and_b32 v7, -4, v122
    v_lshl_add_u32 v8, v122, 2, v7
    ds_write_b32 v8, v118
    v_lshl_add_u32 v7, v7, 2, v122
    ds_write_b8 v7, v125 offset:16
    v_and_b32 v9, -4, v123
    v_lshl_add_u32 v10, v123, 2, v9
    ds_write_b32 v10, v119
    v_lshl_add_u32 v9, v9, 2, v123
    ds_write_b8_d16_hi v9, v125 offset:16
    s_add_u32 s45, s35, 0x20000
    buffer_store_dwordx4 v[92:95], v0, s[20:23], s45 offen sc1
    s_add_u32 s46, s99, 0x4c00000
    buffer_load_dwordx4 v[100:103], v0, s[12:15], s46 offen nt
    v_and_b32 v7, -4, v20
    v_lshl_add_u32 v8, v20, 2, v7
    ds_write_b32 v8, v16
    v_lshl_add_u32 v7, v7, 2, v20
    ds_write_b8 v7, v126 offset:16
    v_and_b32 v9, -4, v21
    v_lshl_add_u32 v10, v21, 2, v9
    ds_write_b32 v10, v17
    v_lshl_add_u32 v9, v9, 2, v21
    ds_write_b8_d16_hi v9, v126 offset:16
    v_and_b32 v7, -4, v22
    v_lshl_add_u32 v8, v22, 2, v7
    ds_write_b32 v8, v18
    v_lshl_add_u32 v7, v7, 2, v22
    ds_write_b8 v7, v127 offset:16
    v_and_b32 v9, -4, v23
    v_lshl_add_u32 v10, v23, 2, v9
    ds_write_b32 v10, v19
    v_lshl_add_u32 v9, v9, 2, v23
    ds_write_b8_d16_hi v9, v127 offset:16
    s_add_u32 s47, s96, 0x5000000
    buffer_load_dwordx4 v[108:111], v0, s[8:11], s47 offen nt
    s_add_u32 s44, s96, 0x5000000
    buffer_load_dwordx4 v[116:119], v0, s[12:15], s44 offen nt
    s_setprio 1
    v_and_b32 v7, -4, v32
    v_lshl_add_u32 v8, v32, 2, v7
    ds_write_b32 v8, v28
    v_lshl_add_u32 v7, v7, 2, v32
    ds_write_b8 v7, v24 offset:16
    v_and_b32 v9, -4, v33
    v_lshl_add_u32 v10, v33, 2, v9
    ds_write_b32 v10, v29
    v_lshl_add_u32 v9, v9, 2, v33
    ds_write_b8_d16_hi v9, v24 offset:16
    v_and_b32 v7, -4, v34
    v_lshl_add_u32 v8, v34, 2, v7
    ds_write_b32 v8, v30
    v_lshl_add_u32 v7, v7, 2, v34
    ds_write_b8 v7, v25 offset:16
    v_and_b32 v9, -4, v35
    v_lshl_add_u32 v10, v35, 2, v9
    ds_write_b32 v10, v31
    v_lshl_add_u32 v9, v9, 2, v35
    ds_write_b8_d16_hi v9, v25 offset:16
    s_add_u32 s45, s96, 0x5000000
    s_lshr_b32 s45, s45, 1
    buffer_load_dwordx2 v[120:121], v1, s[16:19], s45 offen nt
    s_add_u32 s46, s97, 0x5400000
    s_lshr_b32 s46, s46, 1
    buffer_load_dwordx2 v[122:123], v1, s[16:19], s46 offen nt
    s_add_u32 s47, s97, 0x5400000
    buffer_load_dwordx4 v[92:95], v0, s[8:11], s47 offen nt
    v_and_b32 v7, -4, v40
    v_lshl_add_u32 v8, v40, 2, v7
    ds_write_b32 v8, v36
    v_lshl_add_u32 v7, v7, 2, v40
    ds_write_b8 v7, v26 offset:16
    v_and_b32 v9, -4, v41
    v_lshl_add_u32 v10, v41, 2, v9
    ds_write_b32 v10, v37
    v_lshl_add_u32 v9, v9, 2, v41
    ds_write_b8_d16_hi v9, v26 offset:16
    v_and_b32 v7, -4, v42
    v_lshl_add_u32 v8, v42, 2, v7
    ds_write_b32 v8, v38
    v_lshl_add_u32 v7, v7, 2, v42
    ds_write_b8 v7, v27 offset:16
    v_and_b32 v9, -4, v43
    v_lshl_add_u32 v10, v43, 2, v9
    ds_write_b32 v10, v39
    v_lshl_add_u32 v9, v9, 2, v43
    ds_write_b8_d16_hi v9, v27 offset:16
    s_add_u32 s44, s35, 0x24000
    buffer_store_dwordx4 v[84:87], v0, s[20:23], s44 offen sc1
    s_add_u32 s45, s97, 0x5400000
    buffer_load_dwordx4 v[16:19], v0, s[12:15], s45 offen nt
    s_setprio 0
    v_and_b32 v7, -4, v52
    v_lshl_add_u32 v8, v52, 2, v7
    ds_write_b32 v8, v48
    v_lshl_add_u32 v7, v7, 2, v52
    ds_write_b8 v7, v44 offset:16
    v_and_b32 v9, -4, v53
    v_lshl_add_u32 v10, v53, 2, v9
    ds_write_b32 v10, v49
    v_lshl_add_u32 v9, v9, 2, v53
    ds_write_b8_d16_hi v9, v44 offset:16
    v_and_b32 v7, -4, v54
    v_lshl_add_u32 v8, v54, 2, v7
    ds_write_b32 v8, v50
    v_lshl_add_u32 v7, v7, 2, v54
    ds_write_b8 v7, v45 offset:16
    v_and_b32 v9, -4, v55
    v_lshl_add_u32 v10, v55, 2, v9
    ds_write_b32 v10, v51
    v_lshl_add_u32 v9, v9, 2, v55
    ds_write_b8_d16_hi v9, v45 offset:16
    s_add_u32 s46, s98, 0x5800000
    buffer_load_dwordx4 v[20:23], v0, s[8:11], s46 offen nt
    s_add_u32 s47, s98, 0x5800000
    buffer_load_dwordx4 v[124:127], v0, s[12:15], s47 offen nt
    v_and_b32 v7, -4, v60
    v_lshl_add_u32 v8, v60, 2, v7
    ds_write_b32 v8, v56
    v_lshl_add_u32 v7, v7, 2, v60
    ds_write_b8 v7, v46 offset:16
    v_and_b32 v9, -4, v61
    v_lshl_add_u32 v10, v61, 2, v9
    ds_write_b32 v10, v57
    v_lshl_add_u32 v9, v9, 2, v61
    ds_write_b8_d16_hi v9, v46 offset:16
    v_and_b32 v7, -4, v62
    v_lshl_add_u32 v8, v62, 2, v7
    ds_write_b32 v8, v58
    v_lshl_add_u32 v7, v7, 2, v62
    ds_write_b8 v7, v47 offset:16
    v_and_b32 v9, -4, v63
    v_lshl_add_u32 v10, v63, 2, v9
    ds_write_b32 v10, v59
    v_lshl_add_u32 v9, v9, 2, v63
    ds_write_b8_d16_hi v9, v47 offset:16
    s_add_u32 s44, s98, 0x5800000
    s_lshr_b32 s44, s44, 1
    buffer_load_dwordx2 v[28:29], v1, s[16:19], s44 offen nt
    s_add_u32 s45, s99, 0x5c00000
    s_lshr_b32 s45, s45, 1
    buffer_load_dwordx2 v[30:31], v1, s[16:19], s45 offen nt
    v_add_u32 v7, 0x10000, v0
    v_add_u32 v12, 0x20000, v0
    v_mov_b32 v8, 0
    v_mov_b32 v9, 0
    v_mov_b32 v10, 0
    v_mov_b32 v11, 0
    s_waitcnt lgkmcnt(0)
    s_barrier
    ds_read_b128 v[32:35], v0 offset:0
    ds_write_b128 v0, v[8:11]
    ds_read_b128 v[36:39], v0 offset:16384
    ds_read_b128 v[40:43], v0 offset:32768
    ds_read_b128 v[24:27], v0 offset:49152
    ds_read_b128 v[84:87], v7 offset:0
    ds_read_b128 v[48:51], v7 offset:16384
    ds_read_b128 v[52:55], v7 offset:32768
    ds_read_b128 v[56:59], v7 offset:49152
    ds_read_b128 v[60:63], v12 offset:0
    ds_read_b128 v[44:47], v12 offset:16384
    s_waitcnt lgkmcnt(0)
    s_barrier
    s_setprio 3
    s_add_u32 s46, s35, 0x2a40000
    buffer_store_dwordx4 v[32:35], v0, s[20:23], s46 offen sc1
    s_add_u32 s47, s99, 0x5c00000
    s_nop 0
    buffer_load_dwordx4 v[32:35], v0, s[8:11], s47 offen nt
    s_add_u32 s44, s35, 0x2a44000
    buffer_store_dwordx4 v[36:39], v0, s[20:23], s44 offen sc1
    s_add_u32 s45, s99, 0x5c00000
    s_nop 0
    buffer_load_dwordx4 v[36:39], v0, s[12:15], s45 offen nt
    s_waitcnt vmcnt(27)
    v_lshlrev_b32 v7, 16, v64
    v_and_b32 v8, 0xffff0000, v64
    v_lshlrev_b32 v9, 16, v65
    v_and_b32 v10, 0xffff0000, v65
    v_mul_f32 v7, 0.15915494, v7
    v_mul_f32 v8, 0.15915494, v8
    v_mul_f32 v9, 0.15915494, v9
    v_mul_f32 v10, 0.15915494, v10
    v_mul_hi_u32_u24 v14, 429497, v68
    v_lshrrev_b32 v12, 3, v72
    v_cos_f32 v7, v7
    v_lshlrev_b16 v13, 3, v72
    v_mad_i32_i24 v11, v14, s55, v68
    v_bitop3_b32 v12, v6, v13, v12 bitop3:0xca
    v_lshl_add_u32 v11, v11, 17, s40
    v_lshlrev_b16 v14, 8, v14
    v_lshrrev_b32 v13, 2, v72
    v_add_u32 v68, v12, v11
    v_bitop3_b32 v72, v5, v13, v14 bitop3:0xea
    ds_add_u32 v72, v2
    v_mul_hi_u32_u24 v14, 429497, v69
    v_lshrrev_b32 v12, 3, v73
    v_cos_f32 v8, v8
    v_lshlrev_b16 v13, 3, v73
    v_mad_i32_i24 v11, v14, s55, v69
    v_bitop3_b32 v12, v6, v13, v12 bitop3:0xca
    v_lshl_add_u32 v11, v11, 17, s40
    v_lshlrev_b16 v14, 8, v14
    v_lshrrev_b32 v13, 2, v73
    v_add_u32 v69, v12, v11
    v_bitop3_b32 v73, v5, v13, v14 bitop3:0xea
    ds_add_u32 v73, v2
    v_cvt_pk_bf16_f32 v64, v7, v8
    v_perm_b32 v12, v64, v64, s41
    v_bitop3_b32 v68, v4, v12, v68 bitop3:0xca
    v_perm_b32 v13, v64, v64, s42
    v_bitop3_b32 v69, v4, v13, v69 bitop3:0xca
    v_mul_hi_u32_u24 v14, 429497, v70
    v_lshrrev_b32 v12, 3, v74
    v_cos_f32 v9, v9
    v_lshlrev_b16 v13, 3, v74
    v_mad_i32_i24 v11, v14, s55, v70
    v_bitop3_b32 v12, v6, v13, v12 bitop3:0xca
    v_lshl_add_u32 v11, v11, 17, s40
    v_lshlrev_b16 v14, 8, v14
    v_lshrrev_b32 v13, 2, v74
    v_add_u32 v70, v12, v11
    v_bitop3_b32 v74, v5, v13, v14 bitop3:0xea
    ds_add_u32 v74, v2
    v_mul_hi_u32_u24 v14, 429497, v71
    v_lshrrev_b32 v12, 3, v75
    v_cos_f32 v10, v10
    v_lshlrev_b16 v13, 3, v75
    v_mad_i32_i24 v11, v14, s55, v71
    v_bitop3_b32 v12, v6, v13, v12 bitop3:0xca
    v_lshl_add_u32 v11, v11, 17, s40
    v_lshlrev_b16 v14, 8, v14
    v_lshrrev_b32 v13, 2, v75
    v_add_u32 v71, v12, v11
    v_bitop3_b32 v75, v5, v13, v14 bitop3:0xea
    ds_add_u32 v75, v2
    v_cvt_pk_bf16_f32 v65, v9, v10
    v_perm_b32 v12, v65, v65, s41
    v_bitop3_b32 v70, v4, v12, v70 bitop3:0xca
    v_perm_b32 v13, v65, v65, s42
    v_bitop3_b32 v71, v4, v13, v71 bitop3:0xca
    s_waitcnt vmcnt(23)
    v_lshlrev_b32 v7, 16, v66
    v_and_b32 v8, 0xffff0000, v66
    v_lshlrev_b32 v9, 16, v67
    v_and_b32 v10, 0xffff0000, v67
    v_mul_f32 v7, 0.15915494, v7
    v_mul_f32 v8, 0.15915494, v8
    v_mul_f32 v9, 0.15915494, v9
    v_mul_f32 v10, 0.15915494, v10
    v_mul_hi_u32_u24 v14, 429497, v76
    v_lshrrev_b32 v12, 3, v80
    v_cos_f32 v7, v7
    v_lshlrev_b16 v13, 3, v80
    v_mad_i32_i24 v11, v14, s55, v76
    v_bitop3_b32 v12, v6, v13, v12 bitop3:0xca
    v_lshl_add_u32 v11, v11, 17, s40
    v_lshlrev_b16 v14, 8, v14
    v_lshrrev_b32 v13, 2, v80
    v_add_u32 v76, v12, v11
    v_bitop3_b32 v80, v5, v13, v14 bitop3:0xea
    ds_add_u32 v80, v2
    v_mul_hi_u32_u24 v14, 429497, v77
    v_lshrrev_b32 v12, 3, v81
    v_cos_f32 v8, v8
    v_lshlrev_b16 v13, 3, v81
    v_mad_i32_i24 v11, v14, s55, v77
    v_bitop3_b32 v12, v6, v13, v12 bitop3:0xca
    v_lshl_add_u32 v11, v11, 17, s40
    v_lshlrev_b16 v14, 8, v14
    v_lshrrev_b32 v13, 2, v81
    v_add_u32 v77, v12, v11
    v_bitop3_b32 v81, v5, v13, v14 bitop3:0xea
    ds_add_u32 v81, v2
    v_cvt_pk_bf16_f32 v66, v7, v8
    v_perm_b32 v12, v66, v66, s41
    v_bitop3_b32 v76, v4, v12, v76 bitop3:0xca
    v_perm_b32 v13, v66, v66, s42
    v_bitop3_b32 v77, v4, v13, v77 bitop3:0xca
    v_mul_hi_u32_u24 v14, 429497, v78
    v_lshrrev_b32 v12, 3, v82
    v_cos_f32 v9, v9
    v_lshlrev_b16 v13, 3, v82
    v_mad_i32_i24 v11, v14, s55, v78
    v_bitop3_b32 v12, v6, v13, v12 bitop3:0xca
    v_lshl_add_u32 v11, v11, 17, s40
    v_lshlrev_b16 v14, 8, v14
    v_lshrrev_b32 v13, 2, v82
    v_add_u32 v78, v12, v11
    v_bitop3_b32 v82, v5, v13, v14 bitop3:0xea
    ds_add_u32 v82, v2
    v_mul_hi_u32_u24 v14, 429497, v79
    v_lshrrev_b32 v12, 3, v83
    v_cos_f32 v10, v10
    v_lshlrev_b16 v13, 3, v83
    v_mad_i32_i24 v11, v14, s55, v79
    v_bitop3_b32 v12, v6, v13, v12 bitop3:0xca
    v_lshl_add_u32 v11, v11, 17, s40
    v_lshlrev_b16 v14, 8, v14
    v_lshrrev_b32 v13, 2, v83
    v_add_u32 v79, v12, v11
    v_bitop3_b32 v83, v5, v13, v14 bitop3:0xea
    ds_add_u32 v83, v2
    v_cvt_pk_bf16_f32 v67, v9, v10
    v_perm_b32 v12, v67, v67, s41
    v_bitop3_b32 v78, v4, v12, v78 bitop3:0xca
    v_perm_b32 v13, v67, v67, s42
    v_bitop3_b32 v79, v4, v13, v79 bitop3:0xca
    s_setprio 2
    s_waitcnt vmcnt(18)
    v_lshlrev_b32 v7, 16, v88
    v_and_b32 v8, 0xffff0000, v88
    v_lshlrev_b32 v9, 16, v89
    v_and_b32 v10, 0xffff0000, v89
    v_mul_f32 v7, 0.15915494, v7
    v_mul_f32 v8, 0.15915494, v8
    v_mul_f32 v9, 0.15915494, v9
    v_mul_f32 v10, 0.15915494, v10
    v_mul_hi_u32_u24 v14, 429497, v96
    v_lshrrev_b32 v12, 3, v104
    v_cos_f32 v7, v7
    v_lshlrev_b16 v13, 3, v104
    v_mad_i32_i24 v11, v14, s55, v96
    v_bitop3_b32 v12, v6, v13, v12 bitop3:0xca
    v_lshl_add_u32 v11, v11, 17, s40
    v_lshlrev_b16 v14, 8, v14
    v_lshrrev_b32 v13, 2, v104
    v_add_u32 v96, v12, v11
    v_bitop3_b32 v104, v5, v13, v14 bitop3:0xea
    ds_add_u32 v104, v2
    v_mul_hi_u32_u24 v14, 429497, v97
    v_lshrrev_b32 v12, 3, v105
    v_cos_f32 v8, v8
    v_lshlrev_b16 v13, 3, v105
    v_mad_i32_i24 v11, v14, s55, v97
    v_bitop3_b32 v12, v6, v13, v12 bitop3:0xca
    v_lshl_add_u32 v11, v11, 17, s40
    v_lshlrev_b16 v14, 8, v14
    v_lshrrev_b32 v13, 2, v105
    v_add_u32 v97, v12, v11
    v_bitop3_b32 v105, v5, v13, v14 bitop3:0xea
    ds_add_u32 v105, v2
    v_cvt_pk_bf16_f32 v88, v7, v8
    v_perm_b32 v12, v88, v88, s41
    v_bitop3_b32 v96, v4, v12, v96 bitop3:0xca
    v_perm_b32 v13, v88, v88, s42
    v_bitop3_b32 v97, v4, v13, v97 bitop3:0xca
    v_mul_hi_u32_u24 v14, 429497, v98
    v_lshrrev_b32 v12, 3, v106
    v_cos_f32 v9, v9
    v_lshlrev_b16 v13, 3, v106
    v_mad_i32_i24 v11, v14, s55, v98
    v_bitop3_b32 v12, v6, v13, v12 bitop3:0xca
    v_lshl_add_u32 v11, v11, 17, s40
    v_lshlrev_b16 v14, 8, v14
    v_lshrrev_b32 v13, 2, v106
    v_add_u32 v98, v12, v11
    v_bitop3_b32 v106, v5, v13, v14 bitop3:0xea
    ds_add_u32 v106, v2
    v_mul_hi_u32_u24 v14, 429497, v99
    v_lshrrev_b32 v12, 3, v107
    v_cos_f32 v10, v10
    v_lshlrev_b16 v13, 3, v107
    v_mad_i32_i24 v11, v14, s55, v99
    v_bitop3_b32 v12, v6, v13, v12 bitop3:0xca
    v_lshl_add_u32 v11, v11, 17, s40
    v_lshlrev_b16 v14, 8, v14
    v_lshrrev_b32 v13, 2, v107
    v_add_u32 v99, v12, v11
    v_bitop3_b32 v107, v5, v13, v14 bitop3:0xea
    ds_add_u32 v107, v2
    v_cvt_pk_bf16_f32 v89, v9, v10
    v_perm_b32 v12, v89, v89, s41
    v_bitop3_b32 v98, v4, v12, v98 bitop3:0xca
    v_perm_b32 v13, v89, v89, s42
    v_bitop3_b32 v99, v4, v13, v99 bitop3:0xca
    s_add_u32 s46, s35, 0x2a48000
    buffer_store_dwordx4 v[40:43], v0, s[20:23], s46 offen sc1
    s_add_u32 s47, s96, 0x6000000
    s_nop 0
    buffer_load_dwordx4 v[40:43], v0, s[8:11], s47 offen nt
    s_waitcnt vmcnt(17)
    v_lshlrev_b32 v7, 16, v90
    v_and_b32 v8, 0xffff0000, v90
    v_lshlrev_b32 v9, 16, v91
    v_and_b32 v10, 0xffff0000, v91
    v_mul_f32 v7, 0.15915494, v7
    v_mul_f32 v8, 0.15915494, v8
    v_mul_f32 v9, 0.15915494, v9
    v_mul_f32 v10, 0.15915494, v10
    v_mul_hi_u32_u24 v14, 429497, v112
    v_lshrrev_b32 v12, 3, v100
    v_cos_f32 v7, v7
    v_lshlrev_b16 v13, 3, v100
    v_mad_i32_i24 v11, v14, s55, v112
    v_bitop3_b32 v12, v6, v13, v12 bitop3:0xca
    v_lshl_add_u32 v11, v11, 17, s40
    v_lshlrev_b16 v14, 8, v14
    v_lshrrev_b32 v13, 2, v100
    v_add_u32 v112, v12, v11
    v_bitop3_b32 v100, v5, v13, v14 bitop3:0xea
    ds_add_u32 v100, v2
    v_mul_hi_u32_u24 v14, 429497, v113
    v_lshrrev_b32 v12, 3, v101
    v_cos_f32 v8, v8
    v_lshlrev_b16 v13, 3, v101
    v_mad_i32_i24 v11, v14, s55, v113
    v_bitop3_b32 v12, v6, v13, v12 bitop3:0xca
    v_lshl_add_u32 v11, v11, 17, s40
    v_lshlrev_b16 v14, 8, v14
    v_lshrrev_b32 v13, 2, v101
    v_add_u32 v113, v12, v11
    v_bitop3_b32 v101, v5, v13, v14 bitop3:0xea
    ds_add_u32 v101, v2
    v_cvt_pk_bf16_f32 v90, v7, v8
    v_perm_b32 v12, v90, v90, s41
    v_bitop3_b32 v112, v4, v12, v112 bitop3:0xca
    v_perm_b32 v13, v90, v90, s42
    v_bitop3_b32 v113, v4, v13, v113 bitop3:0xca
    v_mul_hi_u32_u24 v14, 429497, v114
    v_lshrrev_b32 v12, 3, v102
    v_cos_f32 v9, v9
    v_lshlrev_b16 v13, 3, v102
    v_mad_i32_i24 v11, v14, s55, v114
    v_bitop3_b32 v12, v6, v13, v12 bitop3:0xca
    v_lshl_add_u32 v11, v11, 17, s40
    v_lshlrev_b16 v14, 8, v14
    v_lshrrev_b32 v13, 2, v102
    v_add_u32 v114, v12, v11
    v_bitop3_b32 v102, v5, v13, v14 bitop3:0xea
    ds_add_u32 v102, v2
    v_mul_hi_u32_u24 v14, 429497, v115
    v_lshrrev_b32 v12, 3, v103
    v_cos_f32 v10, v10
    v_lshlrev_b16 v13, 3, v103
    v_mad_i32_i24 v11, v14, s55, v115
    v_bitop3_b32 v12, v6, v13, v12 bitop3:0xca
    v_lshl_add_u32 v11, v11, 17, s40
    v_lshlrev_b16 v14, 8, v14
    v_lshrrev_b32 v13, 2, v103
    v_add_u32 v115, v12, v11
    v_bitop3_b32 v103, v5, v13, v14 bitop3:0xea
    ds_add_u32 v103, v2
    v_cvt_pk_bf16_f32 v91, v9, v10
    v_perm_b32 v12, v91, v91, s41
    v_bitop3_b32 v114, v4, v12, v114 bitop3:0xca
    v_perm_b32 v13, v91, v91, s42
    v_bitop3_b32 v115, v4, v13, v115 bitop3:0xca
    s_setprio 1
    s_waitcnt vmcnt(13)
    v_lshlrev_b32 v7, 16, v120
    v_and_b32 v8, 0xffff0000, v120
    v_lshlrev_b32 v9, 16, v121
    v_and_b32 v10, 0xffff0000, v121
    v_mul_f32 v7, 0.15915494, v7
    v_mul_f32 v8, 0.15915494, v8
    v_mul_f32 v9, 0.15915494, v9
    v_mul_f32 v10, 0.15915494, v10
    v_mul_hi_u32_u24 v14, 429497, v108
    v_lshrrev_b32 v12, 3, v116
    v_cos_f32 v7, v7
    v_lshlrev_b16 v13, 3, v116
    v_mad_i32_i24 v11, v14, s55, v108
    v_bitop3_b32 v12, v6, v13, v12 bitop3:0xca
    v_lshl_add_u32 v11, v11, 17, s40
    v_lshlrev_b16 v14, 8, v14
    v_lshrrev_b32 v13, 2, v116
    v_add_u32 v108, v12, v11
    v_bitop3_b32 v116, v5, v13, v14 bitop3:0xea
    ds_add_u32 v116, v2
    v_mul_hi_u32_u24 v14, 429497, v109
    v_lshrrev_b32 v12, 3, v117
    v_cos_f32 v8, v8
    v_lshlrev_b16 v13, 3, v117
    v_mad_i32_i24 v11, v14, s55, v109
    v_bitop3_b32 v12, v6, v13, v12 bitop3:0xca
    v_lshl_add_u32 v11, v11, 17, s40
    v_lshlrev_b16 v14, 8, v14
    v_lshrrev_b32 v13, 2, v117
    v_add_u32 v109, v12, v11
    v_bitop3_b32 v117, v5, v13, v14 bitop3:0xea
    ds_add_u32 v117, v2
    v_cvt_pk_bf16_f32 v120, v7, v8
    v_perm_b32 v12, v120, v120, s41
    v_bitop3_b32 v108, v4, v12, v108 bitop3:0xca
    v_perm_b32 v13, v120, v120, s42
    v_bitop3_b32 v109, v4, v13, v109 bitop3:0xca
    v_mul_hi_u32_u24 v14, 429497, v110
    v_lshrrev_b32 v12, 3, v118
    v_cos_f32 v9, v9
    v_lshlrev_b16 v13, 3, v118
    v_mad_i32_i24 v11, v14, s55, v110
    v_bitop3_b32 v12, v6, v13, v12 bitop3:0xca
    v_lshl_add_u32 v11, v11, 17, s40
    v_lshlrev_b16 v14, 8, v14
    v_lshrrev_b32 v13, 2, v118
    v_add_u32 v110, v12, v11
    v_bitop3_b32 v118, v5, v13, v14 bitop3:0xea
    ds_add_u32 v118, v2
    v_mul_hi_u32_u24 v14, 429497, v111
    v_lshrrev_b32 v12, 3, v119
    v_cos_f32 v10, v10
    v_lshlrev_b16 v13, 3, v119
    v_mad_i32_i24 v11, v14, s55, v111
    v_bitop3_b32 v12, v6, v13, v12 bitop3:0xca
    v_lshl_add_u32 v11, v11, 17, s40
    v_lshlrev_b16 v14, 8, v14
    v_lshrrev_b32 v13, 2, v119
    v_add_u32 v111, v12, v11
    v_bitop3_b32 v119, v5, v13, v14 bitop3:0xea
    ds_add_u32 v119, v2
    v_cvt_pk_bf16_f32 v121, v9, v10
    v_perm_b32 v12, v121, v121, s41
    v_bitop3_b32 v110, v4, v12, v110 bitop3:0xca
    v_perm_b32 v13, v121, v121, s42
    v_bitop3_b32 v111, v4, v13, v111 bitop3:0xca
    s_waitcnt vmcnt(10)
    v_lshlrev_b32 v7, 16, v122
    v_and_b32 v8, 0xffff0000, v122
    v_lshlrev_b32 v9, 16, v123
    v_and_b32 v10, 0xffff0000, v123
    v_mul_f32 v7, 0.15915494, v7
    v_mul_f32 v8, 0.15915494, v8
    v_mul_f32 v9, 0.15915494, v9
    v_mul_f32 v10, 0.15915494, v10
    v_mul_hi_u32_u24 v14, 429497, v92
    v_lshrrev_b32 v12, 3, v16
    v_cos_f32 v7, v7
    v_lshlrev_b16 v13, 3, v16
    v_mad_i32_i24 v11, v14, s55, v92
    v_bitop3_b32 v12, v6, v13, v12 bitop3:0xca
    v_lshl_add_u32 v11, v11, 17, s40
    v_lshlrev_b16 v14, 8, v14
    v_lshrrev_b32 v13, 2, v16
    v_add_u32 v92, v12, v11
    v_bitop3_b32 v16, v5, v13, v14 bitop3:0xea
    ds_add_u32 v16, v2
    v_mul_hi_u32_u24 v14, 429497, v93
    v_lshrrev_b32 v12, 3, v17
    v_cos_f32 v8, v8
    v_lshlrev_b16 v13, 3, v17
    v_mad_i32_i24 v11, v14, s55, v93
    v_bitop3_b32 v12, v6, v13, v12 bitop3:0xca
    v_lshl_add_u32 v11, v11, 17, s40
    v_lshlrev_b16 v14, 8, v14
    v_lshrrev_b32 v13, 2, v17
    v_add_u32 v93, v12, v11
    v_bitop3_b32 v17, v5, v13, v14 bitop3:0xea
    ds_add_u32 v17, v2
    v_cvt_pk_bf16_f32 v122, v7, v8
    v_perm_b32 v12, v122, v122, s41
    v_bitop3_b32 v92, v4, v12, v92 bitop3:0xca
    v_perm_b32 v13, v122, v122, s42
    v_bitop3_b32 v93, v4, v13, v93 bitop3:0xca
    v_mul_hi_u32_u24 v14, 429497, v94
    v_lshrrev_b32 v12, 3, v18
    v_cos_f32 v9, v9
    v_lshlrev_b16 v13, 3, v18
    v_mad_i32_i24 v11, v14, s55, v94
    v_bitop3_b32 v12, v6, v13, v12 bitop3:0xca
    v_lshl_add_u32 v11, v11, 17, s40
    v_lshlrev_b16 v14, 8, v14
    v_lshrrev_b32 v13, 2, v18
    v_add_u32 v94, v12, v11
    v_bitop3_b32 v18, v5, v13, v14 bitop3:0xea
    ds_add_u32 v18, v2
    v_mul_hi_u32_u24 v14, 429497, v95
    v_lshrrev_b32 v12, 3, v19
    v_cos_f32 v10, v10
    v_lshlrev_b16 v13, 3, v19
    v_mad_i32_i24 v11, v14, s55, v95
    v_bitop3_b32 v12, v6, v13, v12 bitop3:0xca
    v_lshl_add_u32 v11, v11, 17, s40
    v_lshlrev_b16 v14, 8, v14
    v_lshrrev_b32 v13, 2, v19
    v_add_u32 v95, v12, v11
    v_bitop3_b32 v19, v5, v13, v14 bitop3:0xea
    ds_add_u32 v19, v2
    v_cvt_pk_bf16_f32 v123, v9, v10
    v_perm_b32 v12, v123, v123, s41
    v_bitop3_b32 v94, v4, v12, v94 bitop3:0xca
    v_perm_b32 v13, v123, v123, s42
    v_bitop3_b32 v95, v4, v13, v95 bitop3:0xca
    s_setprio 0
    s_add_u32 s44, s35, 0x2a4c000
    buffer_store_dwordx4 v[24:27], v0, s[20:23], s44 offen sc1
    s_add_u32 s45, s96, 0x6000000
    s_nop 0
    buffer_load_dwordx4 v[24:27], v0, s[12:15], s45 offen nt
    s_waitcnt vmcnt(8)
    v_lshlrev_b32 v7, 16, v28
    v_and_b32 v8, 0xffff0000, v28
    v_lshlrev_b32 v9, 16, v29
    v_and_b32 v10, 0xffff0000, v29
    v_mul_f32 v7, 0.15915494, v7
    v_mul_f32 v8, 0.15915494, v8
    v_mul_f32 v9, 0.15915494, v9
    v_mul_f32 v10, 0.15915494, v10
    v_mul_hi_u32_u24 v14, 429497, v20
    v_lshrrev_b32 v12, 3, v124
    v_cos_f32 v7, v7
    v_lshlrev_b16 v13, 3, v124
    v_mad_i32_i24 v11, v14, s55, v20
    v_bitop3_b32 v12, v6, v13, v12 bitop3:0xca
    v_lshl_add_u32 v11, v11, 17, s40
    v_lshlrev_b16 v14, 8, v14
    v_lshrrev_b32 v13, 2, v124
    v_add_u32 v20, v12, v11
    v_bitop3_b32 v124, v5, v13, v14 bitop3:0xea
    ds_add_u32 v124, v2
    v_mul_hi_u32_u24 v14, 429497, v21
    v_lshrrev_b32 v12, 3, v125
    v_cos_f32 v8, v8
    v_lshlrev_b16 v13, 3, v125
    v_mad_i32_i24 v11, v14, s55, v21
    v_bitop3_b32 v12, v6, v13, v12 bitop3:0xca
    v_lshl_add_u32 v11, v11, 17, s40
    v_lshlrev_b16 v14, 8, v14
    v_lshrrev_b32 v13, 2, v125
    v_add_u32 v21, v12, v11
    v_bitop3_b32 v125, v5, v13, v14 bitop3:0xea
    ds_add_u32 v125, v2
    v_cvt_pk_bf16_f32 v28, v7, v8
    v_perm_b32 v12, v28, v28, s41
    v_bitop3_b32 v20, v4, v12, v20 bitop3:0xca
    v_perm_b32 v13, v28, v28, s42
    v_bitop3_b32 v21, v4, v13, v21 bitop3:0xca
    v_mul_hi_u32_u24 v14, 429497, v22
    v_lshrrev_b32 v12, 3, v126
    v_cos_f32 v9, v9
    v_lshlrev_b16 v13, 3, v126
    v_mad_i32_i24 v11, v14, s55, v22
    v_bitop3_b32 v12, v6, v13, v12 bitop3:0xca
    v_lshl_add_u32 v11, v11, 17, s40
    v_lshlrev_b16 v14, 8, v14
    v_lshrrev_b32 v13, 2, v126
    v_add_u32 v22, v12, v11
    v_bitop3_b32 v126, v5, v13, v14 bitop3:0xea
    ds_add_u32 v126, v2
    v_mul_hi_u32_u24 v14, 429497, v23
    v_lshrrev_b32 v12, 3, v127
    v_cos_f32 v10, v10
    v_lshlrev_b16 v13, 3, v127
    v_mad_i32_i24 v11, v14, s55, v23
    v_bitop3_b32 v12, v6, v13, v12 bitop3:0xca
    v_lshl_add_u32 v11, v11, 17, s40
    v_lshlrev_b16 v14, 8, v14
    v_lshrrev_b32 v13, 2, v127
    v_add_u32 v23, v12, v11
    v_bitop3_b32 v127, v5, v13, v14 bitop3:0xea
    ds_add_u32 v127, v2
    v_cvt_pk_bf16_f32 v29, v9, v10
    v_perm_b32 v12, v29, v29, s41
    v_bitop3_b32 v22, v4, v12, v22 bitop3:0xca
    v_perm_b32 v13, v29, v29, s42
    v_bitop3_b32 v23, v4, v13, v23 bitop3:0xca
    s_waitcnt vmcnt(4)
    v_lshlrev_b32 v7, 16, v30
    v_and_b32 v8, 0xffff0000, v30
    v_lshlrev_b32 v9, 16, v31
    v_and_b32 v10, 0xffff0000, v31
    v_mul_f32 v7, 0.15915494, v7
    v_mul_f32 v8, 0.15915494, v8
    v_mul_f32 v9, 0.15915494, v9
    v_mul_f32 v10, 0.15915494, v10
    v_mul_hi_u32_u24 v14, 429497, v32
    v_lshrrev_b32 v12, 3, v36
    v_cos_f32 v7, v7
    v_lshlrev_b16 v13, 3, v36
    v_mad_i32_i24 v11, v14, s55, v32
    v_bitop3_b32 v12, v6, v13, v12 bitop3:0xca
    v_lshl_add_u32 v11, v11, 17, s40
    v_lshlrev_b16 v14, 8, v14
    v_lshrrev_b32 v13, 2, v36
    v_add_u32 v32, v12, v11
    v_bitop3_b32 v36, v5, v13, v14 bitop3:0xea
    ds_add_u32 v36, v2
    v_mul_hi_u32_u24 v14, 429497, v33
    v_lshrrev_b32 v12, 3, v37
    v_cos_f32 v8, v8
    v_lshlrev_b16 v13, 3, v37
    v_mad_i32_i24 v11, v14, s55, v33
    v_bitop3_b32 v12, v6, v13, v12 bitop3:0xca
    v_lshl_add_u32 v11, v11, 17, s40
    v_lshlrev_b16 v14, 8, v14
    v_lshrrev_b32 v13, 2, v37
    v_add_u32 v33, v12, v11
    v_bitop3_b32 v37, v5, v13, v14 bitop3:0xea
    ds_add_u32 v37, v2
    v_cvt_pk_bf16_f32 v30, v7, v8
    v_perm_b32 v12, v30, v30, s41
    v_bitop3_b32 v32, v4, v12, v32 bitop3:0xca
    v_perm_b32 v13, v30, v30, s42
    v_bitop3_b32 v33, v4, v13, v33 bitop3:0xca
    v_mul_hi_u32_u24 v14, 429497, v34
    v_lshrrev_b32 v12, 3, v38
    v_cos_f32 v9, v9
    v_lshlrev_b16 v13, 3, v38
    v_mad_i32_i24 v11, v14, s55, v34
    v_bitop3_b32 v12, v6, v13, v12 bitop3:0xca
    v_lshl_add_u32 v11, v11, 17, s40
    v_lshlrev_b16 v14, 8, v14
    v_lshrrev_b32 v13, 2, v38
    v_add_u32 v34, v12, v11
    v_bitop3_b32 v38, v5, v13, v14 bitop3:0xea
    ds_add_u32 v38, v2
    v_mul_hi_u32_u24 v14, 429497, v35
    v_lshrrev_b32 v12, 3, v39
    v_cos_f32 v10, v10
    v_lshlrev_b16 v13, 3, v39
    v_mad_i32_i24 v11, v14, s55, v35
    v_bitop3_b32 v12, v6, v13, v12 bitop3:0xca
    v_lshl_add_u32 v11, v11, 17, s40
    v_lshlrev_b16 v14, 8, v14
    v_lshrrev_b32 v13, 2, v39
    v_add_u32 v35, v12, v11
    v_bitop3_b32 v39, v5, v13, v14 bitop3:0xea
    ds_add_u32 v39, v2
    v_cvt_pk_bf16_f32 v31, v9, v10
    v_perm_b32 v12, v31, v31, s41
    v_bitop3_b32 v34, v4, v12, v34 bitop3:0xca
    v_perm_b32 v13, v31, v31, s42
    v_bitop3_b32 v35, v4, v13, v35 bitop3:0xca
    v_lshrrev_b32 v8, 2, v0
    v_and_b32 v7, 0x3c00, v0
    v_bitop3_b32 v7, v5, v8, v7 bitop3:0xea
    s_waitcnt lgkmcnt(0)
    s_barrier
    ds_read2st64_b32 v[8:9], v7 offset0:0 offset1:1
    ds_read2st64_b32 v[10:11], v7 offset0:2 offset1:3
    s_add_u32 s46, s35, 0x2a50000
    buffer_store_dwordx4 v[84:87], v0, s[20:23], s46 offen sc1
    s_add_u32 s47, s96, 0x6000000
    s_lshr_b32 s47, s47, 1
    buffer_load_dwordx2 v[84:85], v1, s[16:19], s47 offen nt
    s_add_u32 s44, s97, 0x6400000
    s_lshr_b32 s44, s44, 1
    buffer_load_dwordx2 v[86:87], v1, s[16:19], s44 offen nt
    s_waitcnt lgkmcnt(0)
    v_lshl_or_b32 v12, v9, 16, v8
    v_lshl_or_b32 v13, v11, 16, v10
    v_mov_b32 v14, v12
    v_mov_b32 v15, v13
    s_nop 0
    v_add_u32_dpp v14, v14, v14 row_shr:1 row_mask:0xf bank_mask:0xf bound_ctrl:1
    v_add_u32_dpp v15, v15, v15 row_shr:1 row_mask:0xf bank_mask:0xf bound_ctrl:1
    s_nop 0
    v_add_u32_dpp v14, v14, v14 row_shr:2 row_mask:0xf bank_mask:0xf bound_ctrl:1
    v_add_u32_dpp v15, v15, v15 row_shr:2 row_mask:0xf bank_mask:0xf bound_ctrl:1
    s_nop 0
    v_add_u32_dpp v14, v14, v14 row_shr:4 row_mask:0xf bank_mask:0xf bound_ctrl:1
    v_add_u32_dpp v15, v15, v15 row_shr:4 row_mask:0xf bank_mask:0xf bound_ctrl:1
    s_nop 0
    v_add_u32_dpp v14, v14, v14 row_shr:8 row_mask:0xf bank_mask:0xf bound_ctrl:1
    v_add_u32_dpp v15, v15, v15 row_shr:8 row_mask:0xf bank_mask:0xf bound_ctrl:1
    s_nop 0
    v_add_u32_dpp v14, v14, v14 row_bcast:15 row_mask:0xa bank_mask:0xf
    v_add_u32_dpp v15, v15, v15 row_bcast:15 row_mask:0xa bank_mask:0xf
    s_nop 0
    v_add_u32_dpp v14, v14, v14 row_bcast:31 row_mask:0xc bank_mask:0xf
    v_add_u32_dpp v15, v15, v15 row_bcast:31 row_mask:0xc bank_mask:0xf
    v_readlane_b32 s48, v14, 63
    v_readlane_b32 s49, v15, 63
    s_lshl_b32 s54, s32, 2
    v_mov_b32 v8, s54
    s_and_b32 s50, s48, 0xffff
    s_lshr_b32 s51, s48, 16
    s_and_b32 s52, s49, 0xffff
    s_lshr_b32 s53, s49, 16
    s_add_u32 s51, s51, s50
    s_add_u32 s52, s52, s51
    s_add_u32 s53, s53, s52
    v_mov_b32 v9, s53
    s_mov_b64 exec, 1
    ds_write_b32 v8, v9 offset:16384
    s_mov_b64 exec, -1
    v_and_b32 v8, 60, v7
    s_waitcnt lgkmcnt(0)
    s_barrier
    ds_read_b32 v9, v8 offset:16384
    s_waitcnt lgkmcnt(0)
    v_add_u32_dpp v9, v9, v9 row_shr:1 row_mask:0xf bank_mask:0xf bound_ctrl:1
    s_nop 1
    v_add_u32_dpp v9, v9, v9 row_shr:2 row_mask:0xf bank_mask:0xf bound_ctrl:1
    s_nop 1
    v_add_u32_dpp v9, v9, v9 row_shr:4 row_mask:0xf bank_mask:0xf bound_ctrl:1
    s_nop 1
    v_add_u32_dpp v9, v9, v9 row_shr:8 row_mask:0xf bank_mask:0xf bound_ctrl:1
    s_nop 0
    v_readlane_b32 s54, v9, s32
    s_sub_u32 s54, s54, s53
    s_add_u32 s50, s50, s54
    s_add_u32 s51, s51, s54
    s_add_u32 s52, s52, s54
    s_pack_ll_b32_b16 s48, s54, s50
    s_pack_ll_b32_b16 s49, s51, s52
    v_add_u32 v14, s48, v14
    v_add_u32 v15, s49, v15
    v_sub_u32 v12, v14, v12
    v_sub_u32 v13, v15, v13
    v_and_b32 v8, 0xffff, v12
    v_lshrrev_b32 v9, 16, v12
    v_and_b32 v10, 0xffff, v13
    v_lshrrev_b32 v11, 16, v13
    ds_write2st64_b32 v7, v8, v9 offset0:0 offset1:1
    ds_write2st64_b32 v7, v10, v11 offset0:2 offset1:3
    v_and_b32 v8, 0x3f0, v0
    v_lshl_add_u32 v8, v8, 1, s36
    ds_write_b64 v8, v[12:13] offset:20480
    s_bitset0_b64 exec, 63
    s_not_b64 exec, exec
    ds_write_b64 v8, v[14:15] offset:20512
    s_mov_b64 exec, -1
    s_waitcnt lgkmcnt(0)
    s_barrier
    s_setprio 3
    ds_add_rtn_u32 v72, v72, v2
    ds_add_rtn_u32 v73, v73, v2
    ds_add_rtn_u32 v74, v74, v2
    ds_add_rtn_u32 v75, v75, v2
    ds_read_b128 v[12:15], v0 offset:20480
    v_cmp_gt_u32 vcc, 8448, v0
    ds_add_rtn_u32 v80, v80, v2
    ds_add_rtn_u32 v81, v81, v2
    ds_add_rtn_u32 v82, v82, v2
    ds_add_rtn_u32 v83, v83, v2
    s_setprio 2
    ds_add_rtn_u32 v104, v104, v2
    ds_add_rtn_u32 v105, v105, v2
    ds_add_rtn_u32 v106, v106, v2
    ds_add_rtn_u32 v107, v107, v2
    s_waitcnt lgkmcnt(8)
    s_cbranch_vccz L1_p3
    s_add_u32 s45, s35, 0x5480000
    s_mov_b64 exec, vcc
    buffer_store_dwordx4 v[12:15], v0, s[24:27], s45 offen sc1
    s_mov_b64 exec, -1
L1_p3:
    s_add_u32 s46, s35, 0x2a54000
    buffer_store_dwordx4 v[48:51], v0, s[20:23], s46 offen sc1
    s_add_u32 s47, s97, 0x6400000
    s_nop 0
    buffer_load_dwordx4 v[48:51], v0, s[8:11], s47 offen nt
    ds_add_rtn_u32 v100, v100, v2
    ds_add_rtn_u32 v101, v101, v2
    ds_add_rtn_u32 v102, v102, v2
    ds_add_rtn_u32 v103, v103, v2
    s_setprio 1
    ds_add_rtn_u32 v116, v116, v2
    ds_add_rtn_u32 v117, v117, v2
    ds_add_rtn_u32 v118, v118, v2
    ds_add_rtn_u32 v119, v119, v2
    ds_add_rtn_u32 v16, v16, v2
    ds_add_rtn_u32 v17, v17, v2
    ds_add_rtn_u32 v18, v18, v2
    ds_add_rtn_u32 v19, v19, v2
    s_add_u32 s44, s35, 0x2a58000
    buffer_store_dwordx4 v[52:55], v0, s[20:23], s44 offen sc1
    s_add_u32 s45, s97, 0x6400000
    s_nop 0
    buffer_load_dwordx4 v[52:55], v0, s[12:15], s45 offen nt
    s_setprio 0
    ds_add_rtn_u32 v124, v124, v2
    ds_add_rtn_u32 v125, v125, v2
    ds_add_rtn_u32 v126, v126, v2
    ds_add_rtn_u32 v127, v127, v2
    ds_add_rtn_u32 v36, v36, v2
    ds_add_rtn_u32 v37, v37, v2
    ds_add_rtn_u32 v38, v38, v2
    ds_add_rtn_u32 v39, v39, v2
    s_waitcnt lgkmcnt(0)
    s_barrier
    s_setprio 3
    v_and_b32 v7, -4, v72
    v_lshl_add_u32 v8, v72, 2, v7
    ds_write_b32 v8, v68
    v_lshl_add_u32 v7, v7, 2, v72
    ds_write_b8 v7, v64 offset:16
    v_and_b32 v9, -4, v73
    v_lshl_add_u32 v10, v73, 2, v9
    ds_write_b32 v10, v69
    v_lshl_add_u32 v9, v9, 2, v73
    ds_write_b8_d16_hi v9, v64 offset:16
    v_and_b32 v7, -4, v74
    v_lshl_add_u32 v8, v74, 2, v7
    ds_write_b32 v8, v70
    v_lshl_add_u32 v7, v7, 2, v74
    ds_write_b8 v7, v65 offset:16
    v_and_b32 v9, -4, v75
    v_lshl_add_u32 v10, v75, 2, v9
    ds_write_b32 v10, v71
    v_lshl_add_u32 v9, v9, 2, v75
    ds_write_b8_d16_hi v9, v65 offset:16
    s_add_u32 s46, s35, 0x2a5c000
    buffer_store_dwordx4 v[56:59], v0, s[20:23], s46 offen sc1
    s_add_u32 s47, s98, 0x6800000
    buffer_load_dwordx4 v[68:71], v0, s[8:11], s47 offen nt
    s_add_u32 s44, s98, 0x6800000
    buffer_load_dwordx4 v[72:75], v0, s[12:15], s44 offen nt
    v_and_b32 v7, -4, v80
    v_lshl_add_u32 v8, v80, 2, v7
    ds_write_b32 v8, v76
    v_lshl_add_u32 v7, v7, 2, v80
    ds_write_b8 v7, v66 offset:16
    v_and_b32 v9, -4, v81
    v_lshl_add_u32 v10, v81, 2, v9
    ds_write_b32 v10, v77
    v_lshl_add_u32 v9, v9, 2, v81
    ds_write_b8_d16_hi v9, v66 offset:16
    v_and_b32 v7, -4, v82
    v_lshl_add_u32 v8, v82, 2, v7
    ds_write_b32 v8, v78
    v_lshl_add_u32 v7, v7, 2, v82
    ds_write_b8 v7, v67 offset:16
    v_and_b32 v9, -4, v83
    v_lshl_add_u32 v10, v83, 2, v9
    ds_write_b32 v10, v79
    v_lshl_add_u32 v9, v9, 2, v83
    ds_write_b8_d16_hi v9, v67 offset:16
    s_add_u32 s45, s98, 0x6800000
    s_lshr_b32 s45, s45, 1
    buffer_load_dwordx2 v[56:57], v1, s[16:19], s45 offen nt
    s_add_u32 s46, s99, 0x6c00000
    s_lshr_b32 s46, s46, 1
    buffer_load_dwordx2 v[58:59], v1, s[16:19], s46 offen nt
    s_add_u32 s47, s99, 0x6c00000
    buffer_load_dwordx4 v[76:79], v0, s[8:11], s47 offen nt
    s_setprio 2
    v_and_b32 v7, -4, v104
    v_lshl_add_u32 v8, v104, 2, v7
    ds_write_b32 v8, v96
    v_lshl_add_u32 v7, v7, 2, v104
    ds_write_b8 v7, v88 offset:16
    v_and_b32 v9, -4, v105
    v_lshl_add_u32 v10, v105, 2, v9
    ds_write_b32 v10, v97
    v_lshl_add_u32 v9, v9, 2, v105
    ds_write_b8_d16_hi v9, v88 offset:16
    v_and_b32 v7, -4, v106
    v_lshl_add_u32 v8, v106, 2, v7
    ds_write_b32 v8, v98
    v_lshl_add_u32 v7, v7, 2, v106
    ds_write_b8 v7, v89 offset:16
    v_and_b32 v9, -4, v107
    v_lshl_add_u32 v10, v107, 2, v9
    ds_write_b32 v10, v99
    v_lshl_add_u32 v9, v9, 2, v107
    ds_write_b8_d16_hi v9, v89 offset:16
    s_add_u32 s44, s35, 0x2a60000
    buffer_store_dwordx4 v[60:63], v0, s[20:23], s44 offen sc1
    s_add_u32 s45, s99, 0x6c00000
    buffer_load_dwordx4 v[80:83], v0, s[12:15], s45 offen nt
    v_and_b32 v7, -4, v100
    v_lshl_add_u32 v8, v100, 2, v7
    ds_write_b32 v8, v112
    v_lshl_add_u32 v7, v7, 2, v100
    ds_write_b8 v7, v90 offset:16
    v_and_b32 v9, -4, v101
    v_lshl_add_u32 v10, v101, 2, v9
    ds_write_b32 v10, v113
    v_lshl_add_u32 v9, v9, 2, v101
    ds_write_b8_d16_hi v9, v90 offset:16
    v_and_b32 v7, -4, v102
    v_lshl_add_u32 v8, v102, 2, v7
    ds_write_b32 v8, v114
    v_lshl_add_u32 v7, v7, 2, v102
    ds_write_b8 v7, v91 offset:16
    v_and_b32 v9, -4, v103
    v_lshl_add_u32 v10, v103, 2, v9
    ds_write_b32 v10, v115
    v_lshl_add_u32 v9, v9, 2, v103
    ds_write_b8_d16_hi v9, v91 offset:16
    s_add_u32 s46, s96, 0x7000000
    buffer_load_dwordx4 v[64:67], v0, s[8:11], s46 offen nt
    s_add_u32 s47, s96, 0x7000000
    buffer_load_dwordx4 v[96:99], v0, s[12:15], s47 offen nt
    s_setprio 1
    v_and_b32 v7, -4, v116
    v_lshl_add_u32 v8, v116, 2, v7
    ds_write_b32 v8, v108
    v_lshl_add_u32 v7, v7, 2, v116
    ds_write_b8 v7, v120 offset:16
    v_and_b32 v9, -4, v117
    v_lshl_add_u32 v10, v117, 2, v9
    ds_write_b32 v10, v109
    v_lshl_add_u32 v9, v9, 2, v117
    ds_write_b8_d16_hi v9, v120 offset:16
    v_and_b32 v7, -4, v118
    v_lshl_add_u32 v8, v118, 2, v7
    ds_write_b32 v8, v110
    v_lshl_add_u32 v7, v7, 2, v118
    ds_write_b8 v7, v121 offset:16
    v_and_b32 v9, -4, v119
    v_lshl_add_u32 v10, v119, 2, v9
    ds_write_b32 v10, v111
    v_lshl_add_u32 v9, v9, 2, v119
    ds_write_b8_d16_hi v9, v121 offset:16
    s_add_u32 s44, s96, 0x7000000
    s_lshr_b32 s44, s44, 1
    buffer_load_dwordx2 v[104:105], v1, s[16:19], s44 offen nt
    s_add_u32 s45, s97, 0x7400000
    s_lshr_b32 s45, s45, 1
    buffer_load_dwordx2 v[106:107], v1, s[16:19], s45 offen nt
    s_add_u32 s46, s97, 0x7400000
    buffer_load_dwordx4 v[60:63], v0, s[8:11], s46 offen nt
    v_and_b32 v7, -4, v16
    v_lshl_add_u32 v8, v16, 2, v7
    ds_write_b32 v8, v92
    v_lshl_add_u32 v7, v7, 2, v16
    ds_write_b8 v7, v122 offset:16
    v_and_b32 v9, -4, v17
    v_lshl_add_u32 v10, v17, 2, v9
    ds_write_b32 v10, v93
    v_lshl_add_u32 v9, v9, 2, v17
    ds_write_b8_d16_hi v9, v122 offset:16
    v_and_b32 v7, -4, v18
    v_lshl_add_u32 v8, v18, 2, v7
    ds_write_b32 v8, v94
    v_lshl_add_u32 v7, v7, 2, v18
    ds_write_b8 v7, v123 offset:16
    v_and_b32 v9, -4, v19
    v_lshl_add_u32 v10, v19, 2, v9
    ds_write_b32 v10, v95
    v_lshl_add_u32 v9, v9, 2, v19
    ds_write_b8_d16_hi v9, v123 offset:16
    s_add_u32 s47, s35, 0x2a64000
    buffer_store_dwordx4 v[44:47], v0, s[20:23], s47 offen sc1
    s_add_u32 s44, s97, 0x7400000
    buffer_load_dwordx4 v[112:115], v0, s[12:15], s44 offen nt
    s_setprio 0
    v_and_b32 v7, -4, v124
    v_lshl_add_u32 v8, v124, 2, v7
    ds_write_b32 v8, v20
    v_lshl_add_u32 v7, v7, 2, v124
    ds_write_b8 v7, v28 offset:16
    v_and_b32 v9, -4, v125
    v_lshl_add_u32 v10, v125, 2, v9
    ds_write_b32 v10, v21
    v_lshl_add_u32 v9, v9, 2, v125
    ds_write_b8_d16_hi v9, v28 offset:16
    v_and_b32 v7, -4, v126
    v_lshl_add_u32 v8, v126, 2, v7
    ds_write_b32 v8, v22
    v_lshl_add_u32 v7, v7, 2, v126
    ds_write_b8 v7, v29 offset:16
    v_and_b32 v9, -4, v127
    v_lshl_add_u32 v10, v127, 2, v9
    ds_write_b32 v10, v23
    v_lshl_add_u32 v9, v9, 2, v127
    ds_write_b8_d16_hi v9, v29 offset:16
    s_add_u32 s45, s98, 0x7800000
    buffer_load_dwordx4 v[100:103], v0, s[8:11], s45 offen nt
    s_add_u32 s46, s98, 0x7800000
    buffer_load_dwordx4 v[88:91], v0, s[12:15], s46 offen nt
    v_and_b32 v7, -4, v36
    v_lshl_add_u32 v8, v36, 2, v7
    ds_write_b32 v8, v32
    v_lshl_add_u32 v7, v7, 2, v36
    ds_write_b8 v7, v30 offset:16
    v_and_b32 v9, -4, v37
    v_lshl_add_u32 v10, v37, 2, v9
    ds_write_b32 v10, v33
    v_lshl_add_u32 v9, v9, 2, v37
    ds_write_b8_d16_hi v9, v30 offset:16
    v_and_b32 v7, -4, v38
    v_lshl_add_u32 v8, v38, 2, v7
    ds_write_b32 v8, v34
    v_lshl_add_u32 v7, v7, 2, v38
    ds_write_b8 v7, v31 offset:16
    v_and_b32 v9, -4, v39
    v_lshl_add_u32 v10, v39, 2, v9
    ds_write_b32 v10, v35
    v_lshl_add_u32 v9, v9, 2, v39
    ds_write_b8_d16_hi v9, v31 offset:16
    s_add_u32 s47, s98, 0x7800000
    s_lshr_b32 s47, s47, 1
    buffer_load_dwordx2 v[108:109], v1, s[16:19], s47 offen nt
    s_add_u32 s44, s99, 0x7c00000
    s_lshr_b32 s44, s44, 1
    buffer_load_dwordx2 v[110:111], v1, s[16:19], s44 offen nt
    v_add_u32 v7, 0x10000, v0
    v_add_u32 v12, 0x20000, v0
    v_mov_b32 v8, 0
    v_mov_b32 v9, 0
    v_mov_b32 v10, 0
    v_mov_b32 v11, 0
    s_waitcnt lgkmcnt(0)
    s_barrier
    ds_read_b128 v[116:119], v0 offset:0
    ds_write_b128 v0, v[8:11]
    ds_read_b128 v[92:95], v0 offset:16384
    ds_read_b128 v[16:19], v0 offset:32768
    ds_read_b128 v[120:123], v0 offset:49152
    ds_read_b128 v[44:47], v7 offset:0
    ds_read_b128 v[20:23], v7 offset:16384
    ds_read_b128 v[124:127], v7 offset:32768
    ds_read_b128 v[32:35], v7 offset:49152
    ds_read_b128 v[36:39], v12 offset:0
    ds_read_b128 v[28:31], v12 offset:16384
    s_waitcnt lgkmcnt(0)
    s_barrier
    s_setprio 3
    s_add_u32 s45, s35, 0x5480000
    buffer_store_dwordx4 v[116:119], v0, s[20:23], s45 offen sc1
    s_add_u32 s46, s99, 0x7c00000
    s_nop 0
    buffer_load_dwordx4 v[116:119], v0, s[8:11], s46 offen nt
    s_add_u32 s47, s35, 0x5484000
    buffer_store_dwordx4 v[92:95], v0, s[20:23], s47 offen sc1
    s_add_u32 s44, s99, 0x7c00000
    s_nop 0
    buffer_load_dwordx4 v[92:95], v0, s[12:15], s44 offen nt
    s_waitcnt vmcnt(27)
    v_lshlrev_b32 v7, 16, v84
    v_and_b32 v8, 0xffff0000, v84
    v_lshlrev_b32 v9, 16, v85
    v_and_b32 v10, 0xffff0000, v85
    v_mul_f32 v7, 0.15915494, v7
    v_mul_f32 v8, 0.15915494, v8
    v_mul_f32 v9, 0.15915494, v9
    v_mul_f32 v10, 0.15915494, v10
    v_mul_hi_u32_u24 v14, 429497, v40
    v_lshrrev_b32 v12, 3, v24
    v_cos_f32 v7, v7
    v_lshlrev_b16 v13, 3, v24
    v_mad_i32_i24 v11, v14, s55, v40
    v_bitop3_b32 v12, v6, v13, v12 bitop3:0xca
    v_lshl_add_u32 v11, v11, 17, s40
    v_lshlrev_b16 v14, 8, v14
    v_lshrrev_b32 v13, 2, v24
    v_add_u32 v40, v12, v11
    v_bitop3_b32 v24, v5, v13, v14 bitop3:0xea
    ds_add_u32 v24, v2
    v_mul_hi_u32_u24 v14, 429497, v41
    v_lshrrev_b32 v12, 3, v25
    v_cos_f32 v8, v8
    v_lshlrev_b16 v13, 3, v25
    v_mad_i32_i24 v11, v14, s55, v41
    v_bitop3_b32 v12, v6, v13, v12 bitop3:0xca
    v_lshl_add_u32 v11, v11, 17, s40
    v_lshlrev_b16 v14, 8, v14
    v_lshrrev_b32 v13, 2, v25
    v_add_u32 v41, v12, v11
    v_bitop3_b32 v25, v5, v13, v14 bitop3:0xea
    ds_add_u32 v25, v2
    v_cvt_pk_bf16_f32 v84, v7, v8
    v_perm_b32 v12, v84, v84, s41
    v_bitop3_b32 v40, v4, v12, v40 bitop3:0xca
    v_perm_b32 v13, v84, v84, s42
    v_bitop3_b32 v41, v4, v13, v41 bitop3:0xca
    v_mul_hi_u32_u24 v14, 429497, v42
    v_lshrrev_b32 v12, 3, v26
    v_cos_f32 v9, v9
    v_lshlrev_b16 v13, 3, v26
    v_mad_i32_i24 v11, v14, s55, v42
    v_bitop3_b32 v12, v6, v13, v12 bitop3:0xca
    v_lshl_add_u32 v11, v11, 17, s40
    v_lshlrev_b16 v14, 8, v14
    v_lshrrev_b32 v13, 2, v26
    v_add_u32 v42, v12, v11
    v_bitop3_b32 v26, v5, v13, v14 bitop3:0xea
    ds_add_u32 v26, v2
    v_mul_hi_u32_u24 v14, 429497, v43
    v_lshrrev_b32 v12, 3, v27
    v_cos_f32 v10, v10
    v_lshlrev_b16 v13, 3, v27
    v_mad_i32_i24 v11, v14, s55, v43
    v_bitop3_b32 v12, v6, v13, v12 bitop3:0xca
    v_lshl_add_u32 v11, v11, 17, s40
    v_lshlrev_b16 v14, 8, v14
    v_lshrrev_b32 v13, 2, v27
    v_add_u32 v43, v12, v11
    v_bitop3_b32 v27, v5, v13, v14 bitop3:0xea
    ds_add_u32 v27, v2
    v_cvt_pk_bf16_f32 v85, v9, v10
    v_perm_b32 v12, v85, v85, s41
    v_bitop3_b32 v42, v4, v12, v42 bitop3:0xca
    v_perm_b32 v13, v85, v85, s42
    v_bitop3_b32 v43, v4, v13, v43 bitop3:0xca
    s_waitcnt vmcnt(23)
    v_lshlrev_b32 v7, 16, v86
    v_and_b32 v8, 0xffff0000, v86
    v_lshlrev_b32 v9, 16, v87
    v_and_b32 v10, 0xffff0000, v87
    v_mul_f32 v7, 0.15915494, v7
    v_mul_f32 v8, 0.15915494, v8
    v_mul_f32 v9, 0.15915494, v9
    v_mul_f32 v10, 0.15915494, v10
    v_mul_hi_u32_u24 v14, 429497, v48
    v_lshrrev_b32 v12, 3, v52
    v_cos_f32 v7, v7
    v_lshlrev_b16 v13, 3, v52
    v_mad_i32_i24 v11, v14, s55, v48
    v_bitop3_b32 v12, v6, v13, v12 bitop3:0xca
    v_lshl_add_u32 v11, v11, 17, s40
    v_lshlrev_b16 v14, 8, v14
    v_lshrrev_b32 v13, 2, v52
    v_add_u32 v48, v12, v11
    v_bitop3_b32 v52, v5, v13, v14 bitop3:0xea
    ds_add_u32 v52, v2
    v_mul_hi_u32_u24 v14, 429497, v49
    v_lshrrev_b32 v12, 3, v53
    v_cos_f32 v8, v8
    v_lshlrev_b16 v13, 3, v53
    v_mad_i32_i24 v11, v14, s55, v49
    v_bitop3_b32 v12, v6, v13, v12 bitop3:0xca
    v_lshl_add_u32 v11, v11, 17, s40
    v_lshlrev_b16 v14, 8, v14
    v_lshrrev_b32 v13, 2, v53
    v_add_u32 v49, v12, v11
    v_bitop3_b32 v53, v5, v13, v14 bitop3:0xea
    ds_add_u32 v53, v2
    v_cvt_pk_bf16_f32 v86, v7, v8
    v_perm_b32 v12, v86, v86, s41
    v_bitop3_b32 v48, v4, v12, v48 bitop3:0xca
    v_perm_b32 v13, v86, v86, s42
    v_bitop3_b32 v49, v4, v13, v49 bitop3:0xca
    v_mul_hi_u32_u24 v14, 429497, v50
    v_lshrrev_b32 v12, 3, v54
    v_cos_f32 v9, v9
    v_lshlrev_b16 v13, 3, v54
    v_mad_i32_i24 v11, v14, s55, v50
    v_bitop3_b32 v12, v6, v13, v12 bitop3:0xca
    v_lshl_add_u32 v11, v11, 17, s40
    v_lshlrev_b16 v14, 8, v14
    v_lshrrev_b32 v13, 2, v54
    v_add_u32 v50, v12, v11
    v_bitop3_b32 v54, v5, v13, v14 bitop3:0xea
    ds_add_u32 v54, v2
    v_mul_hi_u32_u24 v14, 429497, v51
    v_lshrrev_b32 v12, 3, v55
    v_cos_f32 v10, v10
    v_lshlrev_b16 v13, 3, v55
    v_mad_i32_i24 v11, v14, s55, v51
    v_bitop3_b32 v12, v6, v13, v12 bitop3:0xca
    v_lshl_add_u32 v11, v11, 17, s40
    v_lshlrev_b16 v14, 8, v14
    v_lshrrev_b32 v13, 2, v55
    v_add_u32 v51, v12, v11
    v_bitop3_b32 v55, v5, v13, v14 bitop3:0xea
    ds_add_u32 v55, v2
    v_cvt_pk_bf16_f32 v87, v9, v10
    v_perm_b32 v12, v87, v87, s41
    v_bitop3_b32 v50, v4, v12, v50 bitop3:0xca
    v_perm_b32 v13, v87, v87, s42
    v_bitop3_b32 v51, v4, v13, v51 bitop3:0xca
    s_setprio 2
    s_waitcnt vmcnt(18)
    v_lshlrev_b32 v7, 16, v56
    v_and_b32 v8, 0xffff0000, v56
    v_lshlrev_b32 v9, 16, v57
    v_and_b32 v10, 0xffff0000, v57
    v_mul_f32 v7, 0.15915494, v7
    v_mul_f32 v8, 0.15915494, v8
    v_mul_f32 v9, 0.15915494, v9
    v_mul_f32 v10, 0.15915494, v10
    v_mul_hi_u32_u24 v14, 429497, v68
    v_lshrrev_b32 v12, 3, v72
    v_cos_f32 v7, v7
    v_lshlrev_b16 v13, 3, v72
    v_mad_i32_i24 v11, v14, s55, v68
    v_bitop3_b32 v12, v6, v13, v12 bitop3:0xca
    v_lshl_add_u32 v11, v11, 17, s40
    v_lshlrev_b16 v14, 8, v14
    v_lshrrev_b32 v13, 2, v72
    v_add_u32 v68, v12, v11
    v_bitop3_b32 v72, v5, v13, v14 bitop3:0xea
    ds_add_u32 v72, v2
    v_mul_hi_u32_u24 v14, 429497, v69
    v_lshrrev_b32 v12, 3, v73
    v_cos_f32 v8, v8
    v_lshlrev_b16 v13, 3, v73
    v_mad_i32_i24 v11, v14, s55, v69
    v_bitop3_b32 v12, v6, v13, v12 bitop3:0xca
    v_lshl_add_u32 v11, v11, 17, s40
    v_lshlrev_b16 v14, 8, v14
    v_lshrrev_b32 v13, 2, v73
    v_add_u32 v69, v12, v11
    v_bitop3_b32 v73, v5, v13, v14 bitop3:0xea
    ds_add_u32 v73, v2
    v_cvt_pk_bf16_f32 v56, v7, v8
    v_perm_b32 v12, v56, v56, s41
    v_bitop3_b32 v68, v4, v12, v68 bitop3:0xca
    v_perm_b32 v13, v56, v56, s42
    v_bitop3_b32 v69, v4, v13, v69 bitop3:0xca
    v_mul_hi_u32_u24 v14, 429497, v70
    v_lshrrev_b32 v12, 3, v74
    v_cos_f32 v9, v9
    v_lshlrev_b16 v13, 3, v74
    v_mad_i32_i24 v11, v14, s55, v70
    v_bitop3_b32 v12, v6, v13, v12 bitop3:0xca
    v_lshl_add_u32 v11, v11, 17, s40
    v_lshlrev_b16 v14, 8, v14
    v_lshrrev_b32 v13, 2, v74
    v_add_u32 v70, v12, v11
    v_bitop3_b32 v74, v5, v13, v14 bitop3:0xea
    ds_add_u32 v74, v2
    v_mul_hi_u32_u24 v14, 429497, v71
    v_lshrrev_b32 v12, 3, v75
    v_cos_f32 v10, v10
    v_lshlrev_b16 v13, 3, v75
    v_mad_i32_i24 v11, v14, s55, v71
    v_bitop3_b32 v12, v6, v13, v12 bitop3:0xca
    v_lshl_add_u32 v11, v11, 17, s40
    v_lshlrev_b16 v14, 8, v14
    v_lshrrev_b32 v13, 2, v75
    v_add_u32 v71, v12, v11
    v_bitop3_b32 v75, v5, v13, v14 bitop3:0xea
    ds_add_u32 v75, v2
    v_cvt_pk_bf16_f32 v57, v9, v10
    v_perm_b32 v12, v57, v57, s41
    v_bitop3_b32 v70, v4, v12, v70 bitop3:0xca
    v_perm_b32 v13, v57, v57, s42
    v_bitop3_b32 v71, v4, v13, v71 bitop3:0xca
    s_add_u32 s45, s35, 0x5488000
    buffer_store_dwordx4 v[16:19], v0, s[20:23], s45 offen sc1
    s_add_u32 s46, s96, 0x8000000
    s_nop 0
    buffer_load_dwordx4 v[16:19], v0, s[8:11], s46 offen nt
    s_waitcnt vmcnt(17)
    v_lshlrev_b32 v7, 16, v58
    v_and_b32 v8, 0xffff0000, v58
    v_lshlrev_b32 v9, 16, v59
    v_and_b32 v10, 0xffff0000, v59
    v_mul_f32 v7, 0.15915494, v7
    v_mul_f32 v8, 0.15915494, v8
    v_mul_f32 v9, 0.15915494, v9
    v_mul_f32 v10, 0.15915494, v10
    v_mul_hi_u32_u24 v14, 429497, v76
    v_lshrrev_b32 v12, 3, v80
    v_cos_f32 v7, v7
    v_lshlrev_b16 v13, 3, v80
    v_mad_i32_i24 v11, v14, s55, v76
    v_bitop3_b32 v12, v6, v13, v12 bitop3:0xca
    v_lshl_add_u32 v11, v11, 17, s40
    v_lshlrev_b16 v14, 8, v14
    v_lshrrev_b32 v13, 2, v80
    v_add_u32 v76, v12, v11
    v_bitop3_b32 v80, v5, v13, v14 bitop3:0xea
    ds_add_u32 v80, v2
    v_mul_hi_u32_u24 v14, 429497, v77
    v_lshrrev_b32 v12, 3, v81
    v_cos_f32 v8, v8
    v_lshlrev_b16 v13, 3, v81
    v_mad_i32_i24 v11, v14, s55, v77
    v_bitop3_b32 v12, v6, v13, v12 bitop3:0xca
    v_lshl_add_u32 v11, v11, 17, s40
    v_lshlrev_b16 v14, 8, v14
    v_lshrrev_b32 v13, 2, v81
    v_add_u32 v77, v12, v11
    v_bitop3_b32 v81, v5, v13, v14 bitop3:0xea
    ds_add_u32 v81, v2
    v_cvt_pk_bf16_f32 v58, v7, v8
    v_perm_b32 v12, v58, v58, s41
    v_bitop3_b32 v76, v4, v12, v76 bitop3:0xca
    v_perm_b32 v13, v58, v58, s42
    v_bitop3_b32 v77, v4, v13, v77 bitop3:0xca
    v_mul_hi_u32_u24 v14, 429497, v78
    v_lshrrev_b32 v12, 3, v82
    v_cos_f32 v9, v9
    v_lshlrev_b16 v13, 3, v82
    v_mad_i32_i24 v11, v14, s55, v78
    v_bitop3_b32 v12, v6, v13, v12 bitop3:0xca
    v_lshl_add_u32 v11, v11, 17, s40
    v_lshlrev_b16 v14, 8, v14
    v_lshrrev_b32 v13, 2, v82
    v_add_u32 v78, v12, v11
    v_bitop3_b32 v82, v5, v13, v14 bitop3:0xea
    ds_add_u32 v82, v2
    v_mul_hi_u32_u24 v14, 429497, v79
    v_lshrrev_b32 v12, 3, v83
    v_cos_f32 v10, v10
    v_lshlrev_b16 v13, 3, v83
    v_mad_i32_i24 v11, v14, s55, v79
    v_bitop3_b32 v12, v6, v13, v12 bitop3:0xca
    v_lshl_add_u32 v11, v11, 17, s40
    v_lshlrev_b16 v14, 8, v14
    v_lshrrev_b32 v13, 2, v83
    v_add_u32 v79, v12, v11
    v_bitop3_b32 v83, v5, v13, v14 bitop3:0xea
    ds_add_u32 v83, v2
    v_cvt_pk_bf16_f32 v59, v9, v10
    v_perm_b32 v12, v59, v59, s41
    v_bitop3_b32 v78, v4, v12, v78 bitop3:0xca
    v_perm_b32 v13, v59, v59, s42
    v_bitop3_b32 v79, v4, v13, v79 bitop3:0xca
    s_setprio 1
    s_waitcnt vmcnt(13)
    v_lshlrev_b32 v7, 16, v104
    v_and_b32 v8, 0xffff0000, v104
    v_lshlrev_b32 v9, 16, v105
    v_and_b32 v10, 0xffff0000, v105
    v_mul_f32 v7, 0.15915494, v7
    v_mul_f32 v8, 0.15915494, v8
    v_mul_f32 v9, 0.15915494, v9
    v_mul_f32 v10, 0.15915494, v10
    v_mul_hi_u32_u24 v14, 429497, v64
    v_lshrrev_b32 v12, 3, v96
    v_cos_f32 v7, v7
    v_lshlrev_b16 v13, 3, v96
    v_mad_i32_i24 v11, v14, s55, v64
    v_bitop3_b32 v12, v6, v13, v12 bitop3:0xca
    v_lshl_add_u32 v11, v11, 17, s40
    v_lshlrev_b16 v14, 8, v14
    v_lshrrev_b32 v13, 2, v96
    v_add_u32 v64, v12, v11
    v_bitop3_b32 v96, v5, v13, v14 bitop3:0xea
    ds_add_u32 v96, v2
    v_mul_hi_u32_u24 v14, 429497, v65
    v_lshrrev_b32 v12, 3, v97
    v_cos_f32 v8, v8
    v_lshlrev_b16 v13, 3, v97
    v_mad_i32_i24 v11, v14, s55, v65
    v_bitop3_b32 v12, v6, v13, v12 bitop3:0xca
    v_lshl_add_u32 v11, v11, 17, s40
    v_lshlrev_b16 v14, 8, v14
    v_lshrrev_b32 v13, 2, v97
    v_add_u32 v65, v12, v11
    v_bitop3_b32 v97, v5, v13, v14 bitop3:0xea
    ds_add_u32 v97, v2
    v_cvt_pk_bf16_f32 v104, v7, v8
    v_perm_b32 v12, v104, v104, s41
    v_bitop3_b32 v64, v4, v12, v64 bitop3:0xca
    v_perm_b32 v13, v104, v104, s42
    v_bitop3_b32 v65, v4, v13, v65 bitop3:0xca
    v_mul_hi_u32_u24 v14, 429497, v66
    v_lshrrev_b32 v12, 3, v98
    v_cos_f32 v9, v9
    v_lshlrev_b16 v13, 3, v98
    v_mad_i32_i24 v11, v14, s55, v66
    v_bitop3_b32 v12, v6, v13, v12 bitop3:0xca
    v_lshl_add_u32 v11, v11, 17, s40
    v_lshlrev_b16 v14, 8, v14
    v_lshrrev_b32 v13, 2, v98
    v_add_u32 v66, v12, v11
    v_bitop3_b32 v98, v5, v13, v14 bitop3:0xea
    ds_add_u32 v98, v2
    v_mul_hi_u32_u24 v14, 429497, v67
    v_lshrrev_b32 v12, 3, v99
    v_cos_f32 v10, v10
    v_lshlrev_b16 v13, 3, v99
    v_mad_i32_i24 v11, v14, s55, v67
    v_bitop3_b32 v12, v6, v13, v12 bitop3:0xca
    v_lshl_add_u32 v11, v11, 17, s40
    v_lshlrev_b16 v14, 8, v14
    v_lshrrev_b32 v13, 2, v99
    v_add_u32 v67, v12, v11
    v_bitop3_b32 v99, v5, v13, v14 bitop3:0xea
    ds_add_u32 v99, v2
    v_cvt_pk_bf16_f32 v105, v9, v10
    v_perm_b32 v12, v105, v105, s41
    v_bitop3_b32 v66, v4, v12, v66 bitop3:0xca
    v_perm_b32 v13, v105, v105, s42
    v_bitop3_b32 v67, v4, v13, v67 bitop3:0xca
    s_waitcnt vmcnt(10)
    v_lshlrev_b32 v7, 16, v106
    v_and_b32 v8, 0xffff0000, v106
    v_lshlrev_b32 v9, 16, v107
    v_and_b32 v10, 0xffff0000, v107
    v_mul_f32 v7, 0.15915494, v7
    v_mul_f32 v8, 0.15915494, v8
    v_mul_f32 v9, 0.15915494, v9
    v_mul_f32 v10, 0.15915494, v10
    v_mul_hi_u32_u24 v14, 429497, v60
    v_lshrrev_b32 v12, 3, v112
    v_cos_f32 v7, v7
    v_lshlrev_b16 v13, 3, v112
    v_mad_i32_i24 v11, v14, s55, v60
    v_bitop3_b32 v12, v6, v13, v12 bitop3:0xca
    v_lshl_add_u32 v11, v11, 17, s40
    v_lshlrev_b16 v14, 8, v14
    v_lshrrev_b32 v13, 2, v112
    v_add_u32 v60, v12, v11
    v_bitop3_b32 v112, v5, v13, v14 bitop3:0xea
    ds_add_u32 v112, v2
    v_mul_hi_u32_u24 v14, 429497, v61
    v_lshrrev_b32 v12, 3, v113
    v_cos_f32 v8, v8
    v_lshlrev_b16 v13, 3, v113
    v_mad_i32_i24 v11, v14, s55, v61
    v_bitop3_b32 v12, v6, v13, v12 bitop3:0xca
    v_lshl_add_u32 v11, v11, 17, s40
    v_lshlrev_b16 v14, 8, v14
    v_lshrrev_b32 v13, 2, v113
    v_add_u32 v61, v12, v11
    v_bitop3_b32 v113, v5, v13, v14 bitop3:0xea
    ds_add_u32 v113, v2
    v_cvt_pk_bf16_f32 v106, v7, v8
    v_perm_b32 v12, v106, v106, s41
    v_bitop3_b32 v60, v4, v12, v60 bitop3:0xca
    v_perm_b32 v13, v106, v106, s42
    v_bitop3_b32 v61, v4, v13, v61 bitop3:0xca
    v_mul_hi_u32_u24 v14, 429497, v62
    v_lshrrev_b32 v12, 3, v114
    v_cos_f32 v9, v9
    v_lshlrev_b16 v13, 3, v114
    v_mad_i32_i24 v11, v14, s55, v62
    v_bitop3_b32 v12, v6, v13, v12 bitop3:0xca
    v_lshl_add_u32 v11, v11, 17, s40
    v_lshlrev_b16 v14, 8, v14
    v_lshrrev_b32 v13, 2, v114
    v_add_u32 v62, v12, v11
    v_bitop3_b32 v114, v5, v13, v14 bitop3:0xea
    ds_add_u32 v114, v2
    v_mul_hi_u32_u24 v14, 429497, v63
    v_lshrrev_b32 v12, 3, v115
    v_cos_f32 v10, v10
    v_lshlrev_b16 v13, 3, v115
    v_mad_i32_i24 v11, v14, s55, v63
    v_bitop3_b32 v12, v6, v13, v12 bitop3:0xca
    v_lshl_add_u32 v11, v11, 17, s40
    v_lshlrev_b16 v14, 8, v14
    v_lshrrev_b32 v13, 2, v115
    v_add_u32 v63, v12, v11
    v_bitop3_b32 v115, v5, v13, v14 bitop3:0xea
    ds_add_u32 v115, v2
    v_cvt_pk_bf16_f32 v107, v9, v10
    v_perm_b32 v12, v107, v107, s41
    v_bitop3_b32 v62, v4, v12, v62 bitop3:0xca
    v_perm_b32 v13, v107, v107, s42
    v_bitop3_b32 v63, v4, v13, v63 bitop3:0xca
    s_setprio 0
    s_add_u32 s47, s35, 0x548c000
    buffer_store_dwordx4 v[120:123], v0, s[20:23], s47 offen sc1
    s_add_u32 s44, s96, 0x8000000
    s_nop 0
    buffer_load_dwordx4 v[120:123], v0, s[12:15], s44 offen nt
    s_waitcnt vmcnt(8)
    v_lshlrev_b32 v7, 16, v108
    v_and_b32 v8, 0xffff0000, v108
    v_lshlrev_b32 v9, 16, v109
    v_and_b32 v10, 0xffff0000, v109
    v_mul_f32 v7, 0.15915494, v7
    v_mul_f32 v8, 0.15915494, v8
    v_mul_f32 v9, 0.15915494, v9
    v_mul_f32 v10, 0.15915494, v10
    v_mul_hi_u32_u24 v14, 429497, v100
    v_lshrrev_b32 v12, 3, v88
    v_cos_f32 v7, v7
    v_lshlrev_b16 v13, 3, v88
    v_mad_i32_i24 v11, v14, s55, v100
    v_bitop3_b32 v12, v6, v13, v12 bitop3:0xca
    v_lshl_add_u32 v11, v11, 17, s40
    v_lshlrev_b16 v14, 8, v14
    v_lshrrev_b32 v13, 2, v88
    v_add_u32 v100, v12, v11
    v_bitop3_b32 v88, v5, v13, v14 bitop3:0xea
    ds_add_u32 v88, v2
    v_mul_hi_u32_u24 v14, 429497, v101
    v_lshrrev_b32 v12, 3, v89
    v_cos_f32 v8, v8
    v_lshlrev_b16 v13, 3, v89
    v_mad_i32_i24 v11, v14, s55, v101
    v_bitop3_b32 v12, v6, v13, v12 bitop3:0xca
    v_lshl_add_u32 v11, v11, 17, s40
    v_lshlrev_b16 v14, 8, v14
    v_lshrrev_b32 v13, 2, v89
    v_add_u32 v101, v12, v11
    v_bitop3_b32 v89, v5, v13, v14 bitop3:0xea
    ds_add_u32 v89, v2
    v_cvt_pk_bf16_f32 v108, v7, v8
    v_perm_b32 v12, v108, v108, s41
    v_bitop3_b32 v100, v4, v12, v100 bitop3:0xca
    v_perm_b32 v13, v108, v108, s42
    v_bitop3_b32 v101, v4, v13, v101 bitop3:0xca
    v_mul_hi_u32_u24 v14, 429497, v102
    v_lshrrev_b32 v12, 3, v90
    v_cos_f32 v9, v9
    v_lshlrev_b16 v13, 3, v90
    v_mad_i32_i24 v11, v14, s55, v102
    v_bitop3_b32 v12, v6, v13, v12 bitop3:0xca
    v_lshl_add_u32 v11, v11, 17, s40
    v_lshlrev_b16 v14, 8, v14
    v_lshrrev_b32 v13, 2, v90
    v_add_u32 v102, v12, v11
    v_bitop3_b32 v90, v5, v13, v14 bitop3:0xea
    ds_add_u32 v90, v2
    v_mul_hi_u32_u24 v14, 429497, v103
    v_lshrrev_b32 v12, 3, v91
    v_cos_f32 v10, v10
    v_lshlrev_b16 v13, 3, v91
    v_mad_i32_i24 v11, v14, s55, v103
    v_bitop3_b32 v12, v6, v13, v12 bitop3:0xca
    v_lshl_add_u32 v11, v11, 17, s40
    v_lshlrev_b16 v14, 8, v14
    v_lshrrev_b32 v13, 2, v91
    v_add_u32 v103, v12, v11
    v_bitop3_b32 v91, v5, v13, v14 bitop3:0xea
    ds_add_u32 v91, v2
    v_cvt_pk_bf16_f32 v109, v9, v10
    v_perm_b32 v12, v109, v109, s41
    v_bitop3_b32 v102, v4, v12, v102 bitop3:0xca
    v_perm_b32 v13, v109, v109, s42
    v_bitop3_b32 v103, v4, v13, v103 bitop3:0xca
    s_mov_b32 s68, s66
    s_mov_b32 s69, s67
    s_mov_b32 s70, 0x100
    s_mov_b32 s71, 0x20000
    v_mov_b32 v3, 1
    s_cmp_lg_u32 s32, 15
    s_cbranch_scc1 L1_tk
    s_mov_b64 exec, 1
    s_and_b32 s3, s2, 1
    s_lshl_b32 s3, s3, 7
    buffer_atomic_add v3, off, s[68:71], s3 sc0
    s_mov_b64 exec, -1
L1_tk:
    s_waitcnt vmcnt(4)
    v_lshlrev_b32 v7, 16, v110
    v_and_b32 v8, 0xffff0000, v110
    v_lshlrev_b32 v9, 16, v111
    v_and_b32 v10, 0xffff0000, v111
    v_mul_f32 v7, 0.15915494, v7
    v_mul_f32 v8, 0.15915494, v8
    v_mul_f32 v9, 0.15915494, v9
    v_mul_f32 v10, 0.15915494, v10
    v_mul_hi_u32_u24 v14, 429497, v116
    v_lshrrev_b32 v12, 3, v92
    v_cos_f32 v7, v7
    v_lshlrev_b16 v13, 3, v92
    v_mad_i32_i24 v11, v14, s55, v116
    v_bitop3_b32 v12, v6, v13, v12 bitop3:0xca
    v_lshl_add_u32 v11, v11, 17, s40
    v_lshlrev_b16 v14, 8, v14
    v_lshrrev_b32 v13, 2, v92
    v_add_u32 v116, v12, v11
    v_bitop3_b32 v92, v5, v13, v14 bitop3:0xea
    ds_add_u32 v92, v2
    v_mul_hi_u32_u24 v14, 429497, v117
    v_lshrrev_b32 v12, 3, v93
    v_cos_f32 v8, v8
    v_lshlrev_b16 v13, 3, v93
    v_mad_i32_i24 v11, v14, s55, v117
    v_bitop3_b32 v12, v6, v13, v12 bitop3:0xca
    v_lshl_add_u32 v11, v11, 17, s40
    v_lshlrev_b16 v14, 8, v14
    v_lshrrev_b32 v13, 2, v93
    v_add_u32 v117, v12, v11
    v_bitop3_b32 v93, v5, v13, v14 bitop3:0xea
    ds_add_u32 v93, v2
    v_cvt_pk_bf16_f32 v110, v7, v8
    v_perm_b32 v12, v110, v110, s41
    v_bitop3_b32 v116, v4, v12, v116 bitop3:0xca
    v_perm_b32 v13, v110, v110, s42
    v_bitop3_b32 v117, v4, v13, v117 bitop3:0xca
    v_mul_hi_u32_u24 v14, 429497, v118
    v_lshrrev_b32 v12, 3, v94
    v_cos_f32 v9, v9
    v_lshlrev_b16 v13, 3, v94
    v_mad_i32_i24 v11, v14, s55, v118
    v_bitop3_b32 v12, v6, v13, v12 bitop3:0xca
    v_lshl_add_u32 v11, v11, 17, s40
    v_lshlrev_b16 v14, 8, v14
    v_lshrrev_b32 v13, 2, v94
    v_add_u32 v118, v12, v11
    v_bitop3_b32 v94, v5, v13, v14 bitop3:0xea
    ds_add_u32 v94, v2
    v_mul_hi_u32_u24 v14, 429497, v119
    v_lshrrev_b32 v12, 3, v95
    v_cos_f32 v10, v10
    v_lshlrev_b16 v13, 3, v95
    v_mad_i32_i24 v11, v14, s55, v119
    v_bitop3_b32 v12, v6, v13, v12 bitop3:0xca
    v_lshl_add_u32 v11, v11, 17, s40
    v_lshlrev_b16 v14, 8, v14
    v_lshrrev_b32 v13, 2, v95
    v_add_u32 v119, v12, v11
    v_bitop3_b32 v95, v5, v13, v14 bitop3:0xea
    ds_add_u32 v95, v2
    v_cvt_pk_bf16_f32 v111, v9, v10
    v_perm_b32 v12, v111, v111, s41
    v_bitop3_b32 v118, v4, v12, v118 bitop3:0xca
    v_perm_b32 v13, v111, v111, s42
    v_bitop3_b32 v119, v4, v13, v119 bitop3:0xca
    v_lshrrev_b32 v8, 2, v0
    v_and_b32 v7, 0x3c00, v0
    v_bitop3_b32 v7, v5, v8, v7 bitop3:0xea
    s_waitcnt lgkmcnt(0)
    s_barrier
    ds_read2st64_b32 v[8:9], v7 offset0:0 offset1:1
    ds_read2st64_b32 v[10:11], v7 offset0:2 offset1:3
    s_add_u32 s45, s35, 0x5490000
    buffer_store_dwordx4 v[44:47], v0, s[20:23], s45 offen sc1
    s_add_u32 s46, s96, 0x8000000
    s_lshr_b32 s46, s46, 1
    buffer_load_dwordx2 v[44:45], v1, s[16:19], s46 offen nt
    s_add_u32 s47, s97, 0x8400000
    s_lshr_b32 s47, s47, 1
    buffer_load_dwordx2 v[46:47], v1, s[16:19], s47 offen nt
    s_waitcnt lgkmcnt(0)
    v_lshl_or_b32 v12, v9, 16, v8
    v_lshl_or_b32 v13, v11, 16, v10
    v_mov_b32 v14, v12
    v_mov_b32 v15, v13
    s_nop 0
    v_add_u32_dpp v14, v14, v14 row_shr:1 row_mask:0xf bank_mask:0xf bound_ctrl:1
    v_add_u32_dpp v15, v15, v15 row_shr:1 row_mask:0xf bank_mask:0xf bound_ctrl:1
    s_nop 0
    v_add_u32_dpp v14, v14, v14 row_shr:2 row_mask:0xf bank_mask:0xf bound_ctrl:1
    v_add_u32_dpp v15, v15, v15 row_shr:2 row_mask:0xf bank_mask:0xf bound_ctrl:1
    s_nop 0
    v_add_u32_dpp v14, v14, v14 row_shr:4 row_mask:0xf bank_mask:0xf bound_ctrl:1
    v_add_u32_dpp v15, v15, v15 row_shr:4 row_mask:0xf bank_mask:0xf bound_ctrl:1
    s_nop 0
    v_add_u32_dpp v14, v14, v14 row_shr:8 row_mask:0xf bank_mask:0xf bound_ctrl:1
    v_add_u32_dpp v15, v15, v15 row_shr:8 row_mask:0xf bank_mask:0xf bound_ctrl:1
    s_nop 0
    v_add_u32_dpp v14, v14, v14 row_bcast:15 row_mask:0xa bank_mask:0xf
    v_add_u32_dpp v15, v15, v15 row_bcast:15 row_mask:0xa bank_mask:0xf
    s_nop 0
    v_add_u32_dpp v14, v14, v14 row_bcast:31 row_mask:0xc bank_mask:0xf
    v_add_u32_dpp v15, v15, v15 row_bcast:31 row_mask:0xc bank_mask:0xf
    v_readlane_b32 s48, v14, 63
    v_readlane_b32 s49, v15, 63
    s_lshl_b32 s54, s32, 2
    v_mov_b32 v8, s54
    s_and_b32 s50, s48, 0xffff
    s_lshr_b32 s51, s48, 16
    s_and_b32 s52, s49, 0xffff
    s_lshr_b32 s53, s49, 16
    s_add_u32 s51, s51, s50
    s_add_u32 s52, s52, s51
    s_add_u32 s53, s53, s52
    v_mov_b32 v9, s53
    s_mov_b64 exec, 1
    ds_write_b32 v8, v9 offset:16384
    s_waitcnt vmcnt(3)
    ds_write_b32 v8, v3 offset:16448
    s_mov_b64 exec, -1
    v_and_b32 v8, 60, v7
    s_waitcnt lgkmcnt(0)
    s_barrier
    ds_read_b32 v9, v8 offset:16384
    ds_read_b32 v10, v8 offset:16448
    s_waitcnt lgkmcnt(0)
    v_readlane_b32 s84, v10, 15
    s_and_b32 s3, s2, 1
    s_lshl_b32 s3, s3, 7
    s_add_u32 s84, s84, s3
    s_min_u32 s4, s84, 96
    s_min_u32 s5, s84, 192
    s_min_u32 s6, s84, 240
    s_add_u32 s4, s4, s5
    s_add_u32 s4, s4, s6
    s_add_u32 s4, s4, 9467
    s_mov_b32 s4, s84
    s_lshl_b32 s58, s4, 14
    s_lshl_b32 s59, s4, 13
    s_mov_b32 s43, 5
    s_cmp_lt_u32 s84, 96
    s_addc_u32 s43, s43, 0
    s_cmp_lt_u32 s84, 192
    s_addc_u32 s43, s43, 0
    s_cmp_lt_u32 s84, 240
    s_addc_u32 s43, s43, 0
    v_add_u32_dpp v9, v9, v9 row_shr:1 row_mask:0xf bank_mask:0xf bound_ctrl:1
    s_nop 1
    v_add_u32_dpp v9, v9, v9 row_shr:2 row_mask:0xf bank_mask:0xf bound_ctrl:1
    s_nop 1
    v_add_u32_dpp v9, v9, v9 row_shr:4 row_mask:0xf bank_mask:0xf bound_ctrl:1
    s_nop 1
    v_add_u32_dpp v9, v9, v9 row_shr:8 row_mask:0xf bank_mask:0xf bound_ctrl:1
    s_nop 0
    v_readlane_b32 s54, v9, s32
    s_sub_u32 s54, s54, s53
    s_add_u32 s50, s50, s54
    s_add_u32 s51, s51, s54
    s_add_u32 s52, s52, s54
    s_pack_ll_b32_b16 s48, s54, s50
    s_pack_ll_b32_b16 s49, s51, s52
    v_add_u32 v14, s48, v14
    v_add_u32 v15, s49, v15
    v_sub_u32 v12, v14, v12
    v_sub_u32 v13, v15, v13
    v_and_b32 v8, 0xffff, v12
    v_lshrrev_b32 v9, 16, v12
    v_and_b32 v10, 0xffff, v13
    v_lshrrev_b32 v11, 16, v13
    ds_write2st64_b32 v7, v8, v9 offset0:0 offset1:1
    ds_write2st64_b32 v7, v10, v11 offset0:2 offset1:3
    v_and_b32 v8, 0x3f0, v0
    v_lshl_add_u32 v8, v8, 1, s36
    ds_write_b64 v8, v[12:13] offset:20480
    s_bitset0_b64 exec, 63
    s_not_b64 exec, exec
    ds_write_b64 v8, v[14:15] offset:20512
    s_mov_b64 exec, -1
    s_waitcnt lgkmcnt(0)
    s_barrier
    s_setprio 3
    ds_add_rtn_u32 v24, v24, v2
    ds_add_rtn_u32 v25, v25, v2
    ds_add_rtn_u32 v26, v26, v2
    ds_add_rtn_u32 v27, v27, v2
    ds_read_b128 v[12:15], v0 offset:20480
    v_cmp_gt_u32 vcc, 8448, v0
    ds_add_rtn_u32 v52, v52, v2
    ds_add_rtn_u32 v53, v53, v2
    ds_add_rtn_u32 v54, v54, v2
    ds_add_rtn_u32 v55, v55, v2
    s_setprio 2
    ds_add_rtn_u32 v72, v72, v2
    ds_add_rtn_u32 v73, v73, v2
    ds_add_rtn_u32 v74, v74, v2
    ds_add_rtn_u32 v75, v75, v2
    s_waitcnt lgkmcnt(8)
    s_cbranch_vccz L1_p4
    s_add_u32 s44, s35, 0x7ec0000
    s_mov_b64 exec, vcc
    buffer_store_dwordx4 v[12:15], v0, s[24:27], s44 offen sc1
    s_mov_b64 exec, -1
L1_p4:
    s_add_u32 s45, s35, 0x5494000
    buffer_store_dwordx4 v[20:23], v0, s[20:23], s45 offen sc1
    s_add_u32 s46, s97, 0x8400000
    s_nop 0
    buffer_load_dwordx4 v[20:23], v0, s[8:11], s46 offen nt
    ds_add_rtn_u32 v80, v80, v2
    ds_add_rtn_u32 v81, v81, v2
    ds_add_rtn_u32 v82, v82, v2
    ds_add_rtn_u32 v83, v83, v2
    s_setprio 1
    ds_add_rtn_u32 v96, v96, v2
    ds_add_rtn_u32 v97, v97, v2
    ds_add_rtn_u32 v98, v98, v2
    ds_add_rtn_u32 v99, v99, v2
    ds_add_rtn_u32 v112, v112, v2
    ds_add_rtn_u32 v113, v113, v2
    ds_add_rtn_u32 v114, v114, v2
    ds_add_rtn_u32 v115, v115, v2
    s_add_u32 s47, s35, 0x5498000
    buffer_store_dwordx4 v[124:127], v0, s[20:23], s47 offen sc1
    s_add_u32 s44, s97, 0x8400000
    s_nop 0
    buffer_load_dwordx4 v[124:127], v0, s[12:15], s44 offen nt
    s_setprio 0
    ds_add_rtn_u32 v88, v88, v2
    ds_add_rtn_u32 v89, v89, v2
    ds_add_rtn_u32 v90, v90, v2
    ds_add_rtn_u32 v91, v91, v2
    ds_add_rtn_u32 v92, v92, v2
    ds_add_rtn_u32 v93, v93, v2
    ds_add_rtn_u32 v94, v94, v2
    ds_add_rtn_u32 v95, v95, v2
    s_waitcnt lgkmcnt(0)
    s_barrier
    s_setprio 3
    v_and_b32 v7, -4, v24
    v_lshl_add_u32 v8, v24, 2, v7
    ds_write_b32 v8, v40
    v_lshl_add_u32 v7, v7, 2, v24
    ds_write_b8 v7, v84 offset:16
    v_and_b32 v9, -4, v25
    v_lshl_add_u32 v10, v25, 2, v9
    ds_write_b32 v10, v41
    v_lshl_add_u32 v9, v9, 2, v25
    ds_write_b8_d16_hi v9, v84 offset:16
    v_and_b32 v7, -4, v26
    v_lshl_add_u32 v8, v26, 2, v7
    ds_write_b32 v8, v42
    v_lshl_add_u32 v7, v7, 2, v26
    ds_write_b8 v7, v85 offset:16
    v_and_b32 v9, -4, v27
    v_lshl_add_u32 v10, v27, 2, v9
    ds_write_b32 v10, v43
    v_lshl_add_u32 v9, v9, 2, v27
    ds_write_b8_d16_hi v9, v85 offset:16
    s_add_u32 s45, s35, 0x549c000
    buffer_store_dwordx4 v[32:35], v0, s[20:23], s45 offen sc1
    s_add_u32 s46, s98, 0x8800000
    buffer_load_dwordx4 v[40:43], v0, s[8:11], s46 offen nt
    s_add_u32 s47, s98, 0x8800000
    buffer_load_dwordx4 v[24:27], v0, s[12:15], s47 offen nt
    v_and_b32 v7, -4, v52
    v_lshl_add_u32 v8, v52, 2, v7
    ds_write_b32 v8, v48
    v_lshl_add_u32 v7, v7, 2, v52
    ds_write_b8 v7, v86 offset:16
    v_and_b32 v9, -4, v53
    v_lshl_add_u32 v10, v53, 2, v9
    ds_write_b32 v10, v49
    v_lshl_add_u32 v9, v9, 2, v53
    ds_write_b8_d16_hi v9, v86 offset:16
    v_and_b32 v7, -4, v54
    v_lshl_add_u32 v8, v54, 2, v7
    ds_write_b32 v8, v50
    v_lshl_add_u32 v7, v7, 2, v54
    ds_write_b8 v7, v87 offset:16
    v_and_b32 v9, -4, v55
    v_lshl_add_u32 v10, v55, 2, v9
    ds_write_b32 v10, v51
    v_lshl_add_u32 v9, v9, 2, v55
    ds_write_b8_d16_hi v9, v87 offset:16
    s_add_u32 s44, s98, 0x8800000
    s_lshr_b32 s44, s44, 1
    buffer_load_dwordx2 v[32:33], v1, s[16:19], s44 offen nt
    s_add_u32 s45, s99, 0x8c00000
    s_lshr_b32 s45, s45, 1
    buffer_load_dwordx2 v[34:35], v1, s[16:19], s45 offen nt
    s_add_u32 s46, s99, 0x8c00000
    buffer_load_dwordx4 v[48:51], v0, s[8:11], s46 offen nt
    s_setprio 2
    v_and_b32 v7, -4, v72
    v_lshl_add_u32 v8, v72, 2, v7
    ds_write_b32 v8, v68
    v_lshl_add_u32 v7, v7, 2, v72
    ds_write_b8 v7, v56 offset:16
    v_and_b32 v9, -4, v73
    v_lshl_add_u32 v10, v73, 2, v9
    ds_write_b32 v10, v69
    v_lshl_add_u32 v9, v9, 2, v73
    ds_write_b8_d16_hi v9, v56 offset:16
    v_and_b32 v7, -4, v74
    v_lshl_add_u32 v8, v74, 2, v7
    ds_write_b32 v8, v70
    v_lshl_add_u32 v7, v7, 2, v74
    ds_write_b8 v7, v57 offset:16
    v_and_b32 v9, -4, v75
    v_lshl_add_u32 v10, v75, 2, v9
    ds_write_b32 v10, v71
    v_lshl_add_u32 v9, v9, 2, v75
    ds_write_b8_d16_hi v9, v57 offset:16
    s_add_u32 s47, s35, 0x54a0000
    buffer_store_dwordx4 v[36:39], v0, s[20:23], s47 offen sc1
    s_add_u32 s44, s99, 0x8c00000
    buffer_load_dwordx4 v[52:55], v0, s[12:15], s44 offen nt
    v_and_b32 v7, -4, v80
    v_lshl_add_u32 v8, v80, 2, v7
    ds_write_b32 v8, v76
    v_lshl_add_u32 v7, v7, 2, v80
    ds_write_b8 v7, v58 offset:16
    v_and_b32 v9, -4, v81
    v_lshl_add_u32 v10, v81, 2, v9
    ds_write_b32 v10, v77
    v_lshl_add_u32 v9, v9, 2, v81
    ds_write_b8_d16_hi v9, v58 offset:16
    v_and_b32 v7, -4, v82
    v_lshl_add_u32 v8, v82, 2, v7
    ds_write_b32 v8, v78
    v_lshl_add_u32 v7, v7, 2, v82
    ds_write_b8 v7, v59 offset:16
    v_and_b32 v9, -4, v83
    v_lshl_add_u32 v10, v83, 2, v9
    ds_write_b32 v10, v79
    v_lshl_add_u32 v9, v9, 2, v83
    ds_write_b8_d16_hi v9, v59 offset:16
    s_add_u32 s45, s96, 0x9000000
    buffer_load_dwordx4 v[84:87], v0, s[8:11], s45 offen nt
    s_add_u32 s46, s96, 0x9000000
    buffer_load_dwordx4 v[68:71], v0, s[12:15], s46 offen nt
    s_setprio 1
    v_and_b32 v7, -4, v96
    v_lshl_add_u32 v8, v96, 2, v7
    ds_write_b32 v8, v64
    v_lshl_add_u32 v7, v7, 2, v96
    ds_write_b8 v7, v104 offset:16
    v_and_b32 v9, -4, v97
    v_lshl_add_u32 v10, v97, 2, v9
    ds_write_b32 v10, v65
    v_lshl_add_u32 v9, v9, 2, v97
    ds_write_b8_d16_hi v9, v104 offset:16
    v_and_b32 v7, -4, v98
    v_lshl_add_u32 v8, v98, 2, v7
    ds_write_b32 v8, v66
    v_lshl_add_u32 v7, v7, 2, v98
    ds_write_b8 v7, v105 offset:16
    v_and_b32 v9, -4, v99
    v_lshl_add_u32 v10, v99, 2, v9
    ds_write_b32 v10, v67
    v_lshl_add_u32 v9, v9, 2, v99
    ds_write_b8_d16_hi v9, v105 offset:16
    s_add_u32 s47, s96, 0x9000000
    s_lshr_b32 s47, s47, 1
    buffer_load_dwordx2 v[72:73], v1, s[16:19], s47 offen nt
    s_cmp_le_u32 s43, 5
    s_cselect_b32 s18, 0, s18
    s_add_u32 s44, s59, 0x4a00000
    buffer_load_dwordx2 v[74:75], v1, s[16:19], s44 offen nt
    s_cmp_le_u32 s43, 5
    s_cselect_b32 s10, 0, s10
    s_add_u32 s45, s58, 0x9400000
    buffer_load_dwordx4 v[36:39], v0, s[8:11], s45 offen nt
    v_and_b32 v7, -4, v112
    v_lshl_add_u32 v8, v112, 2, v7
    ds_write_b32 v8, v60
    v_lshl_add_u32 v7, v7, 2, v112
    ds_write_b8 v7, v106 offset:16
    v_and_b32 v9, -4, v113
    v_lshl_add_u32 v10, v113, 2, v9
    ds_write_b32 v10, v61
    v_lshl_add_u32 v9, v9, 2, v113
    ds_write_b8_d16_hi v9, v106 offset:16
    v_and_b32 v7, -4, v114
    v_lshl_add_u32 v8, v114, 2, v7
    ds_write_b32 v8, v62
    v_lshl_add_u32 v7, v7, 2, v114
    ds_write_b8 v7, v107 offset:16
    v_and_b32 v9, -4, v115
    v_lshl_add_u32 v10, v115, 2, v9
    ds_write_b32 v10, v63
    v_lshl_add_u32 v9, v9, 2, v115
    ds_write_b8_d16_hi v9, v107 offset:16
    s_add_u32 s46, s35, 0x54a4000
    buffer_store_dwordx4 v[28:31], v0, s[20:23], s46 offen sc1
    s_cmp_le_u32 s43, 5
    s_cselect_b32 s14, 0, s14
    s_add_u32 s47, s58, 0x9400000
    buffer_load_dwordx4 v[76:79], v0, s[12:15], s47 offen nt
    s_setprio 0
    v_and_b32 v7, -4, v88
    v_lshl_add_u32 v8, v88, 2, v7
    ds_write_b32 v8, v100
    v_lshl_add_u32 v7, v7, 2, v88
    ds_write_b8 v7, v108 offset:16
    v_and_b32 v9, -4, v89
    v_lshl_add_u32 v10, v89, 2, v9
    ds_write_b32 v10, v101
    v_lshl_add_u32 v9, v9, 2, v89
    ds_write_b8_d16_hi v9, v108 offset:16
    v_and_b32 v7, -4, v90
    v_lshl_add_u32 v8, v90, 2, v7
    ds_write_b32 v8, v102
    v_lshl_add_u32 v7, v7, 2, v90
    ds_write_b8 v7, v109 offset:16
    v_and_b32 v9, -4, v91
    v_lshl_add_u32 v10, v91, 2, v9
    ds_write_b32 v10, v103
    v_lshl_add_u32 v9, v9, 2, v91
    ds_write_b8_d16_hi v9, v109 offset:16
    s_cmp_le_u32 s43, 6
    s_cselect_b32 s10, 0, s10
    s_add_u32 s44, s58, 0x97c0000
    buffer_load_dwordx4 v[80:83], v0, s[8:11], s44 offen nt
    s_cmp_le_u32 s43, 6
    s_cselect_b32 s14, 0, s14
    s_add_u32 s45, s58, 0x97c0000
    buffer_load_dwordx4 v[56:59], v0, s[12:15], s45 offen nt
    v_and_b32 v7, -4, v92
    v_lshl_add_u32 v8, v92, 2, v7
    ds_write_b32 v8, v116
    v_lshl_add_u32 v7, v7, 2, v92
    ds_write_b8 v7, v110 offset:16
    v_and_b32 v9, -4, v93
    v_lshl_add_u32 v10, v93, 2, v9
    ds_write_b32 v10, v117
    v_lshl_add_u32 v9, v9, 2, v93
    ds_write_b8_d16_hi v9, v110 offset:16
    v_and_b32 v7, -4, v94
    v_lshl_add_u32 v8, v94, 2, v7
    ds_write_b32 v8, v118
    v_lshl_add_u32 v7, v7, 2, v94
    ds_write_b8 v7, v111 offset:16
    v_and_b32 v9, -4, v95
    v_lshl_add_u32 v10, v95, 2, v9
    ds_write_b32 v10, v119
    v_lshl_add_u32 v9, v9, 2, v95
    ds_write_b8_d16_hi v9, v111 offset:16
    s_cmp_le_u32 s43, 6
    s_cselect_b32 s18, 0, s18
    s_add_u32 s46, s59, 0x4be0000
    buffer_load_dwordx2 v[64:65], v1, s[16:19], s46 offen nt
    s_cmp_le_u32 s43, 7
    s_cselect_b32 s18, 0, s18
    s_add_u32 s47, s59, 0x4d60000
    buffer_load_dwordx2 v[66:67], v1, s[16:19], s47 offen nt
    v_add_u32 v7, 0x10000, v0
    v_add_u32 v12, 0x20000, v0
    v_mov_b32 v8, 0
    v_mov_b32 v9, 0
    v_mov_b32 v10, 0
    v_mov_b32 v11, 0
    s_waitcnt lgkmcnt(0)
    s_barrier
    ds_read_b128 v[96:99], v0 offset:0
    ds_write_b128 v0, v[8:11]
    ds_read_b128 v[60:63], v0 offset:16384
    ds_read_b128 v[112:115], v0 offset:32768
    ds_read_b128 v[104:107], v0 offset:49152
    ds_read_b128 v[28:31], v7 offset:0
    ds_read_b128 v[100:103], v7 offset:16384
    ds_read_b128 v[88:91], v7 offset:32768
    ds_read_b128 v[116:119], v7 offset:49152
    ds_read_b128 v[92:95], v12 offset:0
    ds_read_b128 v[108:111], v12 offset:16384
    s_waitcnt lgkmcnt(0)
    s_barrier
    v_lshlrev_b32 v3, 3, v0
    v_and_b32 v3, 0x80, v3
    s_cmp_lg_u32 s32, 15
    s_cbranch_scc1 L2_k0
    s_mov_b64 exec, 3
    buffer_load_dword v3, v3, s[68:71], 0 offen sc1
    s_mov_b64 exec, -1
L2_k0:
    s_add_u32 s44, s35, 0x7ec0000
    buffer_store_dwordx4 v[96:99], v0, s[20:23], s44 offen sc1
    s_cmp_le_u32 s43, 7
    s_cselect_b32 s10, 0, s10
    s_add_u32 s45, s58, 0x9ac0000
    buffer_load_dwordx4 v[96:99], v0, s[8:11], s45 offen nt
    s_add_u32 s46, s35, 0x7ec4000
    buffer_store_dwordx4 v[60:63], v0, s[20:23], s46 offen sc1
    s_cmp_le_u32 s43, 7
    s_cselect_b32 s14, 0, s14
    s_add_u32 s47, s58, 0x9ac0000
    buffer_load_dwordx4 v[60:63], v0, s[12:15], s47 offen nt
    s_setprio 3
    s_waitcnt vmcnt(27)
    v_lshlrev_b32 v7, 16, v44
    v_and_b32 v8, 0xffff0000, v44
    v_lshlrev_b32 v9, 16, v45
    v_and_b32 v10, 0xffff0000, v45
    v_mul_f32 v7, 0.15915494, v7
    v_mul_f32 v8, 0.15915494, v8
    v_mul_f32 v9, 0.15915494, v9
    v_mul_f32 v10, 0.15915494, v10
    v_mul_hi_u32_u24 v14, 429497, v16
    v_lshrrev_b32 v12, 3, v120
    v_cos_f32 v7, v7
    v_lshlrev_b16 v13, 3, v120
    v_mad_i32_i24 v11, v14, s55, v16
    v_bitop3_b32 v12, v6, v13, v12 bitop3:0xca
    v_lshl_add_u32 v11, v11, 17, s40
    v_lshlrev_b16 v14, 8, v14
    v_lshrrev_b32 v13, 2, v120
    v_add_u32 v16, v12, v11
    v_bitop3_b32 v120, v5, v13, v14 bitop3:0xea
    ds_add_u32 v120, v2
    v_mul_hi_u32_u24 v14, 429497, v17
    v_lshrrev_b32 v12, 3, v121
    v_cos_f32 v8, v8
    v_lshlrev_b16 v13, 3, v121
    v_mad_i32_i24 v11, v14, s55, v17
    v_bitop3_b32 v12, v6, v13, v12 bitop3:0xca
    v_lshl_add_u32 v11, v11, 17, s40
    v_lshlrev_b16 v14, 8, v14
    v_lshrrev_b32 v13, 2, v121
    v_add_u32 v17, v12, v11
    v_bitop3_b32 v121, v5, v13, v14 bitop3:0xea
    ds_add_u32 v121, v2
    v_cvt_pk_bf16_f32 v44, v7, v8
    v_perm_b32 v12, v44, v44, s41
    v_bitop3_b32 v16, v4, v12, v16 bitop3:0xca
    v_perm_b32 v13, v44, v44, s42
    v_bitop3_b32 v17, v4, v13, v17 bitop3:0xca
    v_mul_hi_u32_u24 v14, 429497, v18
    v_lshrrev_b32 v12, 3, v122
    v_cos_f32 v9, v9
    v_lshlrev_b16 v13, 3, v122
    v_mad_i32_i24 v11, v14, s55, v18
    v_bitop3_b32 v12, v6, v13, v12 bitop3:0xca
    v_lshl_add_u32 v11, v11, 17, s40
    v_lshlrev_b16 v14, 8, v14
    v_lshrrev_b32 v13, 2, v122
    v_add_u32 v18, v12, v11
    v_bitop3_b32 v122, v5, v13, v14 bitop3:0xea
    ds_add_u32 v122, v2
    v_mul_hi_u32_u24 v14, 429497, v19
    v_lshrrev_b32 v12, 3, v123
    v_cos_f32 v10, v10
    v_lshlrev_b16 v13, 3, v123
    v_mad_i32_i24 v11, v14, s55, v19
    v_bitop3_b32 v12, v6, v13, v12 bitop3:0xca
    v_lshl_add_u32 v11, v11, 17, s40
    v_lshlrev_b16 v14, 8, v14
    v_lshrrev_b32 v13, 2, v123
    v_add_u32 v19, v12, v11
    v_bitop3_b32 v123, v5, v13, v14 bitop3:0xea
    ds_add_u32 v123, v2
    v_cvt_pk_bf16_f32 v45, v9, v10
    v_perm_b32 v12, v45, v45, s41
    v_bitop3_b32 v18, v4, v12, v18 bitop3:0xca
    v_perm_b32 v13, v45, v45, s42
    v_bitop3_b32 v19, v4, v13, v19 bitop3:0xca
    s_add_u32 s44, s35, 0x7ec8000
    buffer_store_dwordx4 v[112:115], v0, s[20:23], s44 offen sc1
    s_waitcnt vmcnt(24)
    v_lshlrev_b32 v7, 16, v46
    v_and_b32 v8, 0xffff0000, v46
    v_lshlrev_b32 v9, 16, v47
    v_and_b32 v10, 0xffff0000, v47
    v_mul_f32 v7, 0.15915494, v7
    v_mul_f32 v8, 0.15915494, v8
    v_mul_f32 v9, 0.15915494, v9
    v_mul_f32 v10, 0.15915494, v10
    v_mul_hi_u32_u24 v14, 429497, v20
    v_lshrrev_b32 v12, 3, v124
    v_cos_f32 v7, v7
    v_lshlrev_b16 v13, 3, v124
    v_mad_i32_i24 v11, v14, s55, v20
    v_bitop3_b32 v12, v6, v13, v12 bitop3:0xca
    v_lshl_add_u32 v11, v11, 17, s40
    v_lshlrev_b16 v14, 8, v14
    v_lshrrev_b32 v13, 2, v124
    v_add_u32 v20, v12, v11
    v_bitop3_b32 v124, v5, v13, v14 bitop3:0xea
    ds_add_u32 v124, v2
    v_mul_hi_u32_u24 v14, 429497, v21
    v_lshrrev_b32 v12, 3, v125
    v_cos_f32 v8, v8
    v_lshlrev_b16 v13, 3, v125
    v_mad_i32_i24 v11, v14, s55, v21
    v_bitop3_b32 v12, v6, v13, v12 bitop3:0xca
    v_lshl_add_u32 v11, v11, 17, s40
    v_lshlrev_b16 v14, 8, v14
    v_lshrrev_b32 v13, 2, v125
    v_add_u32 v21, v12, v11
    v_bitop3_b32 v125, v5, v13, v14 bitop3:0xea
    ds_add_u32 v125, v2
    v_cvt_pk_bf16_f32 v46, v7, v8
    v_perm_b32 v12, v46, v46, s41
    v_bitop3_b32 v20, v4, v12, v20 bitop3:0xca
    v_perm_b32 v13, v46, v46, s42
    v_bitop3_b32 v21, v4, v13, v21 bitop3:0xca
    v_mul_hi_u32_u24 v14, 429497, v22
    v_lshrrev_b32 v12, 3, v126
    v_cos_f32 v9, v9
    v_lshlrev_b16 v13, 3, v126
    v_mad_i32_i24 v11, v14, s55, v22
    v_bitop3_b32 v12, v6, v13, v12 bitop3:0xca
    v_lshl_add_u32 v11, v11, 17, s40
    v_lshlrev_b16 v14, 8, v14
    v_lshrrev_b32 v13, 2, v126
    v_add_u32 v22, v12, v11
    v_bitop3_b32 v126, v5, v13, v14 bitop3:0xea
    ds_add_u32 v126, v2
    v_mul_hi_u32_u24 v14, 429497, v23
    v_lshrrev_b32 v12, 3, v127
    v_cos_f32 v10, v10
    v_lshlrev_b16 v13, 3, v127
    v_mad_i32_i24 v11, v14, s55, v23
    v_bitop3_b32 v12, v6, v13, v12 bitop3:0xca
    v_lshl_add_u32 v11, v11, 17, s40
    v_lshlrev_b16 v14, 8, v14
    v_lshrrev_b32 v13, 2, v127
    v_add_u32 v23, v12, v11
    v_bitop3_b32 v127, v5, v13, v14 bitop3:0xea
    ds_add_u32 v127, v2
    v_cvt_pk_bf16_f32 v47, v9, v10
    v_perm_b32 v12, v47, v47, s41
    v_bitop3_b32 v22, v4, v12, v22 bitop3:0xca
    v_perm_b32 v13, v47, v47, s42
    v_bitop3_b32 v23, v4, v13, v23 bitop3:0xca
    s_setprio 2
    s_add_u32 s45, s35, 0x7ecc000
    buffer_store_dwordx4 v[104:107], v0, s[20:23], s45 offen sc1
    s_waitcnt vmcnt(20)
    v_lshlrev_b32 v7, 16, v32
    v_and_b32 v8, 0xffff0000, v32
    v_lshlrev_b32 v9, 16, v33
    v_and_b32 v10, 0xffff0000, v33
    v_mul_f32 v7, 0.15915494, v7
    v_mul_f32 v8, 0.15915494, v8
    v_mul_f32 v9, 0.15915494, v9
    v_mul_f32 v10, 0.15915494, v10
    v_mul_hi_u32_u24 v14, 429497, v40
    v_lshrrev_b32 v12, 3, v24
    v_cos_f32 v7, v7
    v_lshlrev_b16 v13, 3, v24
    v_mad_i32_i24 v11, v14, s55, v40
    v_bitop3_b32 v12, v6, v13, v12 bitop3:0xca
    v_lshl_add_u32 v11, v11, 17, s40
    v_lshlrev_b16 v14, 8, v14
    v_lshrrev_b32 v13, 2, v24
    v_add_u32 v40, v12, v11
    v_bitop3_b32 v24, v5, v13, v14 bitop3:0xea
    ds_add_u32 v24, v2
    v_mul_hi_u32_u24 v14, 429497, v41
    v_lshrrev_b32 v12, 3, v25
    v_cos_f32 v8, v8
    v_lshlrev_b16 v13, 3, v25
    v_mad_i32_i24 v11, v14, s55, v41
    v_bitop3_b32 v12, v6, v13, v12 bitop3:0xca
    v_lshl_add_u32 v11, v11, 17, s40
    v_lshlrev_b16 v14, 8, v14
    v_lshrrev_b32 v13, 2, v25
    v_add_u32 v41, v12, v11
    v_bitop3_b32 v25, v5, v13, v14 bitop3:0xea
    ds_add_u32 v25, v2
    v_cvt_pk_bf16_f32 v32, v7, v8
    v_perm_b32 v12, v32, v32, s41
    v_bitop3_b32 v40, v4, v12, v40 bitop3:0xca
    v_perm_b32 v13, v32, v32, s42
    v_bitop3_b32 v41, v4, v13, v41 bitop3:0xca
    v_mul_hi_u32_u24 v14, 429497, v42
    v_lshrrev_b32 v12, 3, v26
    v_cos_f32 v9, v9
    v_lshlrev_b16 v13, 3, v26
    v_mad_i32_i24 v11, v14, s55, v42
    v_bitop3_b32 v12, v6, v13, v12 bitop3:0xca
    v_lshl_add_u32 v11, v11, 17, s40
    v_lshlrev_b16 v14, 8, v14
    v_lshrrev_b32 v13, 2, v26
    v_add_u32 v42, v12, v11
    v_bitop3_b32 v26, v5, v13, v14 bitop3:0xea
    ds_add_u32 v26, v2
    v_mul_hi_u32_u24 v14, 429497, v43
    v_lshrrev_b32 v12, 3, v27
    v_cos_f32 v10, v10
    v_lshlrev_b16 v13, 3, v27
    v_mad_i32_i24 v11, v14, s55, v43
    v_bitop3_b32 v12, v6, v13, v12 bitop3:0xca
    v_lshl_add_u32 v11, v11, 17, s40
    v_lshlrev_b16 v14, 8, v14
    v_lshrrev_b32 v13, 2, v27
    v_add_u32 v43, v12, v11
    v_bitop3_b32 v27, v5, v13, v14 bitop3:0xea
    ds_add_u32 v27, v2
    v_cvt_pk_bf16_f32 v33, v9, v10
    v_perm_b32 v12, v33, v33, s41
    v_bitop3_b32 v42, v4, v12, v42 bitop3:0xca
    v_perm_b32 v13, v33, v33, s42
    v_bitop3_b32 v43, v4, v13, v43 bitop3:0xca
    s_waitcnt vmcnt(17)
    v_lshlrev_b32 v7, 16, v34
    v_and_b32 v8, 0xffff0000, v34
    v_lshlrev_b32 v9, 16, v35
    v_and_b32 v10, 0xffff0000, v35
    v_mul_f32 v7, 0.15915494, v7
    v_mul_f32 v8, 0.15915494, v8
    v_mul_f32 v9, 0.15915494, v9
    v_mul_f32 v10, 0.15915494, v10
    v_mul_hi_u32_u24 v14, 429497, v48
    v_lshrrev_b32 v12, 3, v52
    v_cos_f32 v7, v7
    v_lshlrev_b16 v13, 3, v52
    v_mad_i32_i24 v11, v14, s55, v48
    v_bitop3_b32 v12, v6, v13, v12 bitop3:0xca
    v_lshl_add_u32 v11, v11, 17, s40
    v_lshlrev_b16 v14, 8, v14
    v_lshrrev_b32 v13, 2, v52
    v_add_u32 v48, v12, v11
    v_bitop3_b32 v52, v5, v13, v14 bitop3:0xea
    ds_add_u32 v52, v2
    v_mul_hi_u32_u24 v14, 429497, v49
    v_lshrrev_b32 v12, 3, v53
    v_cos_f32 v8, v8
    v_lshlrev_b16 v13, 3, v53
    v_mad_i32_i24 v11, v14, s55, v49
    v_bitop3_b32 v12, v6, v13, v12 bitop3:0xca
    v_lshl_add_u32 v11, v11, 17, s40
    v_lshlrev_b16 v14, 8, v14
    v_lshrrev_b32 v13, 2, v53
    v_add_u32 v49, v12, v11
    v_bitop3_b32 v53, v5, v13, v14 bitop3:0xea
    ds_add_u32 v53, v2
    v_cvt_pk_bf16_f32 v34, v7, v8
    v_perm_b32 v12, v34, v34, s41
    v_bitop3_b32 v48, v4, v12, v48 bitop3:0xca
    v_perm_b32 v13, v34, v34, s42
    v_bitop3_b32 v49, v4, v13, v49 bitop3:0xca
    v_mul_hi_u32_u24 v14, 429497, v50
    v_lshrrev_b32 v12, 3, v54
    v_cos_f32 v9, v9
    v_lshlrev_b16 v13, 3, v54
    v_mad_i32_i24 v11, v14, s55, v50
    v_bitop3_b32 v12, v6, v13, v12 bitop3:0xca
    v_lshl_add_u32 v11, v11, 17, s40
    v_lshlrev_b16 v14, 8, v14
    v_lshrrev_b32 v13, 2, v54
    v_add_u32 v50, v12, v11
    v_bitop3_b32 v54, v5, v13, v14 bitop3:0xea
    ds_add_u32 v54, v2
    v_mul_hi_u32_u24 v14, 429497, v51
    v_lshrrev_b32 v12, 3, v55
    v_cos_f32 v10, v10
    v_lshlrev_b16 v13, 3, v55
    v_mad_i32_i24 v11, v14, s55, v51
    v_bitop3_b32 v12, v6, v13, v12 bitop3:0xca
    v_lshl_add_u32 v11, v11, 17, s40
    v_lshlrev_b16 v14, 8, v14
    v_lshrrev_b32 v13, 2, v55
    v_add_u32 v51, v12, v11
    v_bitop3_b32 v55, v5, v13, v14 bitop3:0xea
    ds_add_u32 v55, v2
    v_cvt_pk_bf16_f32 v35, v9, v10
    v_perm_b32 v12, v35, v35, s41
    v_bitop3_b32 v50, v4, v12, v50 bitop3:0xca
    v_perm_b32 v13, v35, v35, s42
    v_bitop3_b32 v51, v4, v13, v51 bitop3:0xca
    s_setprio 1
    s_add_u32 s46, s35, 0x7ed0000
    buffer_store_dwordx4 v[28:31], v0, s[20:23], s46 offen sc1
    v_lshrrev_b32 v15, 2, v0
    v_and_b32 v15, v5, v15
    s_cmp_ge_u32 s84, 128
    s_cselect_b32 s82, 0, s82
    s_and_b32 s3, s84, 1
    s_mul_i32 s3, s3, 40
    s_add_u32 s3, s3, s32
    s_mul_i32 s4, s3, 205
    s_lshr_b32 s4, s4, 10
    s_mul_i32 s5, s4, 5
    s_sub_u32 s5, s3, s5
    s_lshl_b32 s6, s4, 1
    s_add_u32 s6, s6, s5
    s_add_u32 s7, s6, s4
    s_add_u32 s7, s7, 30
    s_cmp_lt_u32 s5, 2
    s_cselect_b32 s6, s6, s7
    s_lshl_b32 s6, s6, 10
    s_lshr_b32 s7, s84, 1
    s_mul_i32 s7, s7, 80000
    s_add_u32 s6, s6, s7
    buffer_load_dword v112, v15, s[80:83], s6 offen offset:0
    buffer_load_dword v113, v15, s[80:83], s6 offen offset:256
    buffer_load_dword v114, v15, s[80:83], s6 offen offset:512
    buffer_load_dword v115, v15, s[80:83], s6 offen offset:768
    s_and_b32 s3, s84, 1
    s_mul_i32 s3, s3, 40
    s_add_u32 s3, s3, s32
    s_add_u32 s3, s3, 16
    s_mul_i32 s4, s3, 205
    s_lshr_b32 s4, s4, 10
    s_mul_i32 s5, s4, 5
    s_sub_u32 s5, s3, s5
    s_lshl_b32 s6, s4, 1
    s_add_u32 s6, s6, s5
    s_add_u32 s7, s6, s4
    s_add_u32 s7, s7, 30
    s_cmp_lt_u32 s5, 2
    s_cselect_b32 s6, s6, s7
    s_lshl_b32 s6, s6, 10
    s_lshr_b32 s7, s84, 1
    s_mul_i32 s7, s7, 80000
    s_add_u32 s6, s6, s7
    buffer_load_dword v104, v15, s[80:83], s6 offen offset:0
    buffer_load_dword v105, v15, s[80:83], s6 offen offset:256
    buffer_load_dword v106, v15, s[80:83], s6 offen offset:512
    buffer_load_dword v107, v15, s[80:83], s6 offen offset:768
    s_and_b32 s3, s84, 1
    s_mul_i32 s3, s3, 40
    s_add_u32 s3, s3, s32
    s_add_u32 s3, s3, 32
    s_cmp_ge_u32 s32, 8
    s_cselect_b32 s82, 0, s82
    s_mul_i32 s4, s3, 205
    s_lshr_b32 s4, s4, 10
    s_mul_i32 s5, s4, 5
    s_sub_u32 s5, s3, s5
    s_lshl_b32 s6, s4, 1
    s_add_u32 s6, s6, s5
    s_add_u32 s7, s6, s4
    s_add_u32 s7, s7, 30
    s_cmp_lt_u32 s5, 2
    s_cselect_b32 s6, s6, s7
    s_lshl_b32 s6, s6, 10
    s_lshr_b32 s7, s84, 1
    s_mul_i32 s7, s7, 80000
    s_add_u32 s6, s6, s7
    buffer_load_dword v28, v15, s[80:83], s6 offen offset:0
    buffer_load_dword v29, v15, s[80:83], s6 offen offset:256
    buffer_load_dword v30, v15, s[80:83], s6 offen offset:512
    buffer_load_dword v31, v15, s[80:83], s6 offen offset:768
    s_waitcnt vmcnt(26)
    v_lshlrev_b32 v7, 16, v72
    v_and_b32 v8, 0xffff0000, v72
    v_lshlrev_b32 v9, 16, v73
    v_and_b32 v10, 0xffff0000, v73
    v_mul_f32 v7, 0.15915494, v7
    v_mul_f32 v8, 0.15915494, v8
    v_mul_f32 v9, 0.15915494, v9
    v_mul_f32 v10, 0.15915494, v10
    v_mul_hi_u32_u24 v14, 429497, v84
    v_lshrrev_b32 v12, 3, v68
    v_cos_f32 v7, v7
    v_lshlrev_b16 v13, 3, v68
    v_mad_i32_i24 v11, v14, s55, v84
    v_bitop3_b32 v12, v6, v13, v12 bitop3:0xca
    v_lshl_add_u32 v11, v11, 17, s40
    v_lshlrev_b16 v14, 8, v14
    v_lshrrev_b32 v13, 2, v68
    v_add_u32 v84, v12, v11
    v_bitop3_b32 v68, v5, v13, v14 bitop3:0xea
    ds_add_u32 v68, v2
    v_mul_hi_u32_u24 v14, 429497, v85
    v_lshrrev_b32 v12, 3, v69
    v_cos_f32 v8, v8
    v_lshlrev_b16 v13, 3, v69
    v_mad_i32_i24 v11, v14, s55, v85
    v_bitop3_b32 v12, v6, v13, v12 bitop3:0xca
    v_lshl_add_u32 v11, v11, 17, s40
    v_lshlrev_b16 v14, 8, v14
    v_lshrrev_b32 v13, 2, v69
    v_add_u32 v85, v12, v11
    v_bitop3_b32 v69, v5, v13, v14 bitop3:0xea
    ds_add_u32 v69, v2
    v_cvt_pk_bf16_f32 v72, v7, v8
    v_perm_b32 v12, v72, v72, s41
    v_bitop3_b32 v84, v4, v12, v84 bitop3:0xca
    v_perm_b32 v13, v72, v72, s42
    v_bitop3_b32 v85, v4, v13, v85 bitop3:0xca
    v_mul_hi_u32_u24 v14, 429497, v86
    v_lshrrev_b32 v12, 3, v70
    v_cos_f32 v9, v9
    v_lshlrev_b16 v13, 3, v70
    v_mad_i32_i24 v11, v14, s55, v86
    v_bitop3_b32 v12, v6, v13, v12 bitop3:0xca
    v_lshl_add_u32 v11, v11, 17, s40
    v_lshlrev_b16 v14, 8, v14
    v_lshrrev_b32 v13, 2, v70
    v_add_u32 v86, v12, v11
    v_bitop3_b32 v70, v5, v13, v14 bitop3:0xea
    ds_add_u32 v70, v2
    v_mul_hi_u32_u24 v14, 429497, v87
    v_lshrrev_b32 v12, 3, v71
    v_cos_f32 v10, v10
    v_lshlrev_b16 v13, 3, v71
    v_mad_i32_i24 v11, v14, s55, v87
    v_bitop3_b32 v12, v6, v13, v12 bitop3:0xca
    v_lshl_add_u32 v11, v11, 17, s40
    v_lshlrev_b16 v14, 8, v14
    v_lshrrev_b32 v13, 2, v71
    v_add_u32 v87, v12, v11
    v_bitop3_b32 v71, v5, v13, v14 bitop3:0xea
    ds_add_u32 v71, v2
    v_cvt_pk_bf16_f32 v73, v9, v10
    v_perm_b32 v12, v73, v73, s41
    v_bitop3_b32 v86, v4, v12, v86 bitop3:0xca
    v_perm_b32 v13, v73, v73, s42
    v_bitop3_b32 v87, v4, v13, v87 bitop3:0xca
    s_waitcnt vmcnt(23)
    s_cmp_le_u32 s43, 5
    s_cbranch_scc1 L1_s5
    v_lshlrev_b32 v7, 16, v74
    v_and_b32 v8, 0xffff0000, v74
    v_lshlrev_b32 v9, 16, v75
    v_and_b32 v10, 0xffff0000, v75
    v_mul_f32 v7, 0.15915494, v7
    v_mul_f32 v8, 0.15915494, v8
    v_mul_f32 v9, 0.15915494, v9
    v_mul_f32 v10, 0.15915494, v10
    v_mul_hi_u32_u24 v14, 429497, v36
    v_lshrrev_b32 v12, 3, v76
    v_cos_f32 v7, v7
    v_lshlrev_b16 v13, 3, v76
    v_mad_i32_i24 v11, v14, s55, v36
    v_bitop3_b32 v12, v6, v13, v12 bitop3:0xca
    v_lshl_add_u32 v11, v11, 17, s40
    v_lshlrev_b16 v14, 8, v14
    v_lshrrev_b32 v13, 2, v76
    v_add_u32 v36, v12, v11
    v_bitop3_b32 v76, v5, v13, v14 bitop3:0xea
    ds_add_u32 v76, v2
    v_mul_hi_u32_u24 v14, 429497, v37
    v_lshrrev_b32 v12, 3, v77
    v_cos_f32 v8, v8
    v_lshlrev_b16 v13, 3, v77
    v_mad_i32_i24 v11, v14, s55, v37
    v_bitop3_b32 v12, v6, v13, v12 bitop3:0xca
    v_lshl_add_u32 v11, v11, 17, s40
    v_lshlrev_b16 v14, 8, v14
    v_lshrrev_b32 v13, 2, v77
    v_add_u32 v37, v12, v11
    v_bitop3_b32 v77, v5, v13, v14 bitop3:0xea
    ds_add_u32 v77, v2
    v_cvt_pk_bf16_f32 v74, v7, v8
    v_perm_b32 v12, v74, v74, s41
    v_bitop3_b32 v36, v4, v12, v36 bitop3:0xca
    v_perm_b32 v13, v74, v74, s42
    v_bitop3_b32 v37, v4, v13, v37 bitop3:0xca
    v_mul_hi_u32_u24 v14, 429497, v38
    v_lshrrev_b32 v12, 3, v78
    v_cos_f32 v9, v9
    v_lshlrev_b16 v13, 3, v78
    v_mad_i32_i24 v11, v14, s55, v38
    v_bitop3_b32 v12, v6, v13, v12 bitop3:0xca
    v_lshl_add_u32 v11, v11, 17, s40
    v_lshlrev_b16 v14, 8, v14
    v_lshrrev_b32 v13, 2, v78
    v_add_u32 v38, v12, v11
    v_bitop3_b32 v78, v5, v13, v14 bitop3:0xea
    ds_add_u32 v78, v2
    v_mul_hi_u32_u24 v14, 429497, v39
    v_lshrrev_b32 v12, 3, v79
    v_cos_f32 v10, v10
    v_lshlrev_b16 v13, 3, v79
    v_mad_i32_i24 v11, v14, s55, v39
    v_bitop3_b32 v12, v6, v13, v12 bitop3:0xca
    v_lshl_add_u32 v11, v11, 17, s40
    v_lshlrev_b16 v14, 8, v14
    v_lshrrev_b32 v13, 2, v79
    v_add_u32 v39, v12, v11
    v_bitop3_b32 v79, v5, v13, v14 bitop3:0xea
    ds_add_u32 v79, v2
    v_cvt_pk_bf16_f32 v75, v9, v10
    v_perm_b32 v12, v75, v75, s41
    v_bitop3_b32 v38, v4, v12, v38 bitop3:0xca
    v_perm_b32 v13, v75, v75, s42
    v_bitop3_b32 v39, v4, v13, v39 bitop3:0xca
L1_s5:
    s_setprio 0
    s_waitcnt vmcnt(19)
    s_cmp_le_u32 s43, 6
    s_cbranch_scc1 L1_s6
    v_lshlrev_b32 v7, 16, v64
    v_and_b32 v8, 0xffff0000, v64
    v_lshlrev_b32 v9, 16, v65
    v_and_b32 v10, 0xffff0000, v65
    v_mul_f32 v7, 0.15915494, v7
    v_mul_f32 v8, 0.15915494, v8
    v_mul_f32 v9, 0.15915494, v9
    v_mul_f32 v10, 0.15915494, v10
    v_mul_hi_u32_u24 v14, 429497, v80
    v_lshrrev_b32 v12, 3, v56
    v_cos_f32 v7, v7
    v_lshlrev_b16 v13, 3, v56
    v_mad_i32_i24 v11, v14, s55, v80
    v_bitop3_b32 v12, v6, v13, v12 bitop3:0xca
    v_lshl_add_u32 v11, v11, 17, s40
    v_lshlrev_b16 v14, 8, v14
    v_lshrrev_b32 v13, 2, v56
    v_add_u32 v80, v12, v11
    v_bitop3_b32 v56, v5, v13, v14 bitop3:0xea
    ds_add_u32 v56, v2
    v_mul_hi_u32_u24 v14, 429497, v81
    v_lshrrev_b32 v12, 3, v57
    v_cos_f32 v8, v8
    v_lshlrev_b16 v13, 3, v57
    v_mad_i32_i24 v11, v14, s55, v81
    v_bitop3_b32 v12, v6, v13, v12 bitop3:0xca
    v_lshl_add_u32 v11, v11, 17, s40
    v_lshlrev_b16 v14, 8, v14
    v_lshrrev_b32 v13, 2, v57
    v_add_u32 v81, v12, v11
    v_bitop3_b32 v57, v5, v13, v14 bitop3:0xea
    ds_add_u32 v57, v2
    v_cvt_pk_bf16_f32 v64, v7, v8
    v_perm_b32 v12, v64, v64, s41
    v_bitop3_b32 v80, v4, v12, v80 bitop3:0xca
    v_perm_b32 v13, v64, v64, s42
    v_bitop3_b32 v81, v4, v13, v81 bitop3:0xca
    v_mul_hi_u32_u24 v14, 429497, v82
    v_lshrrev_b32 v12, 3, v58
    v_cos_f32 v9, v9
    v_lshlrev_b16 v13, 3, v58
    v_mad_i32_i24 v11, v14, s55, v82
    v_bitop3_b32 v12, v6, v13, v12 bitop3:0xca
    v_lshl_add_u32 v11, v11, 17, s40
    v_lshlrev_b16 v14, 8, v14
    v_lshrrev_b32 v13, 2, v58
    v_add_u32 v82, v12, v11
    v_bitop3_b32 v58, v5, v13, v14 bitop3:0xea
    ds_add_u32 v58, v2
    v_mul_hi_u32_u24 v14, 429497, v83
    v_lshrrev_b32 v12, 3, v59
    v_cos_f32 v10, v10
    v_lshlrev_b16 v13, 3, v59
    v_mad_i32_i24 v11, v14, s55, v83
    v_bitop3_b32 v12, v6, v13, v12 bitop3:0xca
    v_lshl_add_u32 v11, v11, 17, s40
    v_lshlrev_b16 v14, 8, v14
    v_lshrrev_b32 v13, 2, v59
    v_add_u32 v83, v12, v11
    v_bitop3_b32 v59, v5, v13, v14 bitop3:0xea
    ds_add_u32 v59, v2
    v_cvt_pk_bf16_f32 v65, v9, v10
    v_perm_b32 v12, v65, v65, s41
    v_bitop3_b32 v82, v4, v12, v82 bitop3:0xca
    v_perm_b32 v13, v65, v65, s42
    v_bitop3_b32 v83, v4, v13, v83 bitop3:0xca
L1_s6:
    s_waitcnt vmcnt(15)
    s_cmp_le_u32 s43, 7
    s_cbranch_scc1 L1_s7
    v_lshlrev_b32 v7, 16, v66
    v_and_b32 v8, 0xffff0000, v66
    v_lshlrev_b32 v9, 16, v67
    v_and_b32 v10, 0xffff0000, v67
    v_mul_f32 v7, 0.15915494, v7
    v_mul_f32 v8, 0.15915494, v8
    v_mul_f32 v9, 0.15915494, v9
    v_mul_f32 v10, 0.15915494, v10
    v_mul_hi_u32_u24 v14, 429497, v96
    v_lshrrev_b32 v12, 3, v60
    v_cos_f32 v7, v7
    v_lshlrev_b16 v13, 3, v60
    v_mad_i32_i24 v11, v14, s55, v96
    v_bitop3_b32 v12, v6, v13, v12 bitop3:0xca
    v_lshl_add_u32 v11, v11, 17, s40
    v_lshlrev_b16 v14, 8, v14
    v_lshrrev_b32 v13, 2, v60
    v_add_u32 v96, v12, v11
    v_bitop3_b32 v60, v5, v13, v14 bitop3:0xea
    ds_add_u32 v60, v2
    v_mul_hi_u32_u24 v14, 429497, v97
    v_lshrrev_b32 v12, 3, v61
    v_cos_f32 v8, v8
    v_lshlrev_b16 v13, 3, v61
    v_mad_i32_i24 v11, v14, s55, v97
    v_bitop3_b32 v12, v6, v13, v12 bitop3:0xca
    v_lshl_add_u32 v11, v11, 17, s40
    v_lshlrev_b16 v14, 8, v14
    v_lshrrev_b32 v13, 2, v61
    v_add_u32 v97, v12, v11
    v_bitop3_b32 v61, v5, v13, v14 bitop3:0xea
    ds_add_u32 v61, v2
    v_cvt_pk_bf16_f32 v66, v7, v8
    v_perm_b32 v12, v66, v66, s41
    v_bitop3_b32 v96, v4, v12, v96 bitop3:0xca
    v_perm_b32 v13, v66, v66, s42
    v_bitop3_b32 v97, v4, v13, v97 bitop3:0xca
    v_mul_hi_u32_u24 v14, 429497, v98
    v_lshrrev_b32 v12, 3, v62
    v_cos_f32 v9, v9
    v_lshlrev_b16 v13, 3, v62
    v_mad_i32_i24 v11, v14, s55, v98
    v_bitop3_b32 v12, v6, v13, v12 bitop3:0xca
    v_lshl_add_u32 v11, v11, 17, s40
    v_lshlrev_b16 v14, 8, v14
    v_lshrrev_b32 v13, 2, v62
    v_add_u32 v98, v12, v11
    v_bitop3_b32 v62, v5, v13, v14 bitop3:0xea
    ds_add_u32 v62, v2
    v_mul_hi_u32_u24 v14, 429497, v99
    v_lshrrev_b32 v12, 3, v63
    v_cos_f32 v10, v10
    v_lshlrev_b16 v13, 3, v63
    v_mad_i32_i24 v11, v14, s55, v99
    v_bitop3_b32 v12, v6, v13, v12 bitop3:0xca
    v_lshl_add_u32 v11, v11, 17, s40
    v_lshlrev_b16 v14, 8, v14
    v_lshrrev_b32 v13, 2, v63
    v_add_u32 v99, v12, v11
    v_bitop3_b32 v63, v5, v13, v14 bitop3:0xea
    ds_add_u32 v63, v2
    v_cvt_pk_bf16_f32 v67, v9, v10
    v_perm_b32 v12, v67, v67, s41
    v_bitop3_b32 v98, v4, v12, v98 bitop3:0xca
    v_perm_b32 v13, v67, v67, s42
    v_bitop3_b32 v99, v4, v13, v99 bitop3:0xca
L1_s7:
    v_lshrrev_b32 v8, 2, v0
    v_and_b32 v7, 0x3c00, v0
    v_bitop3_b32 v7, v5, v8, v7 bitop3:0xea
    s_waitcnt lgkmcnt(0)
    s_barrier
    ds_read2st64_b32 v[8:9], v7 offset0:0 offset1:1
    ds_read2st64_b32 v[10:11], v7 offset0:2 offset1:3
    s_add_u32 s47, s35, 0x7ed4000
    buffer_store_dwordx4 v[100:103], v0, s[20:23], s47 offen sc1
    s_waitcnt lgkmcnt(0)
    v_lshl_or_b32 v12, v9, 16, v8
    v_lshl_or_b32 v13, v11, 16, v10
    v_mov_b32 v14, v12
    v_mov_b32 v15, v13
    s_nop 0
    v_add_u32_dpp v14, v14, v14 row_shr:1 row_mask:0xf bank_mask:0xf bound_ctrl:1
    v_add_u32_dpp v15, v15, v15 row_shr:1 row_mask:0xf bank_mask:0xf bound_ctrl:1
    s_nop 0
    v_add_u32_dpp v14, v14, v14 row_shr:2 row_mask:0xf bank_mask:0xf bound_ctrl:1
    v_add_u32_dpp v15, v15, v15 row_shr:2 row_mask:0xf bank_mask:0xf bound_ctrl:1
    s_nop 0
    v_add_u32_dpp v14, v14, v14 row_shr:4 row_mask:0xf bank_mask:0xf bound_ctrl:1
    v_add_u32_dpp v15, v15, v15 row_shr:4 row_mask:0xf bank_mask:0xf bound_ctrl:1
    s_nop 0
    v_add_u32_dpp v14, v14, v14 row_shr:8 row_mask:0xf bank_mask:0xf bound_ctrl:1
    v_add_u32_dpp v15, v15, v15 row_shr:8 row_mask:0xf bank_mask:0xf bound_ctrl:1
    s_nop 0
    v_add_u32_dpp v14, v14, v14 row_bcast:15 row_mask:0xa bank_mask:0xf
    v_add_u32_dpp v15, v15, v15 row_bcast:15 row_mask:0xa bank_mask:0xf
    s_nop 0
    v_add_u32_dpp v14, v14, v14 row_bcast:31 row_mask:0xc bank_mask:0xf
    v_add_u32_dpp v15, v15, v15 row_bcast:31 row_mask:0xc bank_mask:0xf
    v_readlane_b32 s48, v14, 63
    v_readlane_b32 s49, v15, 63
    s_lshl_b32 s54, s32, 2
    v_mov_b32 v8, s54
    s_and_b32 s50, s48, 0xffff
    s_lshr_b32 s51, s48, 16
    s_and_b32 s52, s49, 0xffff
    s_lshr_b32 s53, s49, 16
    s_add_u32 s51, s51, s50
    s_add_u32 s52, s52, s51
    s_add_u32 s53, s53, s52
    v_mov_b32 v9, s53
    v_and_b32_dpp v3, v3, v3 quad_perm:[1,0,3,2] row_mask:0xf bank_mask:0xf
    s_mov_b64 exec, 1
    ds_write_b32 v8, v9 offset:16384
    ds_write_b32 v8, v3 offset:16448
    s_mov_b64 exec, -1
    v_and_b32 v8, 60, v7
    s_waitcnt lgkmcnt(0)
    s_barrier
    ds_read_b32 v9, v8 offset:16384
    ds_read_b32 v10, v8 offset:16448
    s_waitcnt lgkmcnt(0)
    v_readlane_b32 s56, v10, 15
    s_xor_b32 s56, s56, 0x80
    v_add_u32_dpp v9, v9, v9 row_shr:1 row_mask:0xf bank_mask:0xf bound_ctrl:1
    s_nop 1
    v_add_u32_dpp v9, v9, v9 row_shr:2 row_mask:0xf bank_mask:0xf bound_ctrl:1
    s_nop 1
    v_add_u32_dpp v9, v9, v9 row_shr:4 row_mask:0xf bank_mask:0xf bound_ctrl:1
    s_nop 1
    v_add_u32_dpp v9, v9, v9 row_shr:8 row_mask:0xf bank_mask:0xf bound_ctrl:1
    s_nop 0
    v_readlane_b32 s54, v9, s32
    s_sub_u32 s54, s54, s53
    s_add_u32 s50, s50, s54
    s_add_u32 s51, s51, s54
    s_add_u32 s52, s52, s54
    s_pack_ll_b32_b16 s48, s54, s50
    s_pack_ll_b32_b16 s49, s51, s52
    v_add_u32 v14, s48, v14
    v_add_u32 v15, s49, v15
    v_sub_u32 v12, v14, v12
    v_sub_u32 v13, v15, v13
    v_and_b32 v8, 0xffff, v12
    v_lshrrev_b32 v9, 16, v12
    v_and_b32 v10, 0xffff, v13
    v_lshrrev_b32 v11, 16, v13
    ds_write2st64_b32 v7, v8, v9 offset0:0 offset1:1
    ds_write2st64_b32 v7, v10, v11 offset0:2 offset1:3
    v_and_b32 v8, 0x3f0, v0
    v_lshl_add_u32 v8, v8, 1, s36
    ds_write_b64 v8, v[12:13] offset:20480
    s_bitset0_b64 exec, 63
    s_not_b64 exec, exec
    ds_write_b64 v8, v[14:15] offset:20512
    s_mov_b64 exec, -1
    s_waitcnt lgkmcnt(0)
    s_barrier
    s_setprio 3
    ds_add_rtn_u32 v120, v120, v2
    ds_add_rtn_u32 v121, v121, v2
    ds_add_rtn_u32 v122, v122, v2
    ds_add_rtn_u32 v123, v123, v2
    ds_read_b128 v[12:15], v0 offset:20480
    v_cmp_gt_u32 vcc, 8448, v0
    ds_add_rtn_u32 v124, v124, v2
    ds_add_rtn_u32 v125, v125, v2
    ds_add_rtn_u32 v126, v126, v2
    ds_add_rtn_u32 v127, v127, v2
    s_setprio 2
    ds_add_rtn_u32 v24, v24, v2
    ds_add_rtn_u32 v25, v25, v2
    ds_add_rtn_u32 v26, v26, v2
    ds_add_rtn_u32 v27, v27, v2
    s_waitcnt lgkmcnt(8)
    s_cbranch_vccz L1_p8
    s_add_u32 s44, s35, 0xa900000
    s_mov_b64 exec, vcc
    buffer_store_dwordx4 v[12:15], v0, s[24:27], s44 offen sc1
    s_mov_b64 exec, -1
L1_p8:
    s_add_u32 s45, s35, 0x7ed8000
    buffer_store_dwordx4 v[88:91], v0, s[20:23], s45 offen sc1
    ds_add_rtn_u32 v52, v52, v2
    ds_add_rtn_u32 v53, v53, v2
    ds_add_rtn_u32 v54, v54, v2
    ds_add_rtn_u32 v55, v55, v2
    s_load_dwordx2 s[28:29], s[0:1], 0
    s_load_dwordx2 s[50:51], s[0:1], 40
    s_load_dwordx2 s[52:53], s[0:1], 24
    s_setprio 1
    ds_add_rtn_u32 v68, v68, v2
    ds_add_rtn_u32 v69, v69, v2
    ds_add_rtn_u32 v70, v70, v2
    ds_add_rtn_u32 v71, v71, v2
    s_add_u32 s80, s30, 0xd340000
    s_addc_u32 s81, s31, 0
    s_mov_b32 s82, 0xa000
    s_mov_b32 s83, 0x20000
    s_min_u32 s3, s84, 127
    s_mul_i32 s3, s3, 40960
    s_add_u32 s80, s80, s3
    s_addc_u32 s81, s81, 0
    s_cmp_ge_u32 s84, 128
    s_cselect_b32 s82, 0, s82
    s_waitcnt vmcnt(2)
    v_add_u32 v9, 0, v0
    buffer_store_dwordx4 v[112:115], v9, s[80:83], 0 offen sc1
    v_add_u32 v9, 16384, v0
    buffer_store_dwordx4 v[104:107], v9, s[80:83], 0 offen sc1
    v_add_u32 v9, 32768, v0
    buffer_store_dwordx4 v[28:31], v9, s[80:83], 0 offen sc1
    s_cmp_le_u32 s43, 5
    s_cbranch_scc1 L1_s9
    ds_add_rtn_u32 v76, v76, v2
    ds_add_rtn_u32 v77, v77, v2
    ds_add_rtn_u32 v78, v78, v2
    ds_add_rtn_u32 v79, v79, v2
L1_s9:
    s_setprio 0
    s_cmp_le_u32 s43, 6
    s_cbranch_scc1 L1_s10
    ds_add_rtn_u32 v56, v56, v2
    ds_add_rtn_u32 v57, v57, v2
    ds_add_rtn_u32 v58, v58, v2
    ds_add_rtn_u32 v59, v59, v2
L1_s10:
    s_cmp_le_u32 s43, 7
    s_cbranch_scc1 L1_s11
    ds_add_rtn_u32 v60, v60, v2
    ds_add_rtn_u32 v61, v61, v2
    ds_add_rtn_u32 v62, v62, v2
    ds_add_rtn_u32 v63, v63, v2
L1_s11:
    s_waitcnt lgkmcnt(0)
    s_barrier
    s_load_dwordx4 s[96:99], s[50:51], 0
    s_mov_b64 s[4:5], s[52:53]
    s_bfe_u32 s33, s2, 0x20001
    s_and_b32 s34, s2, 1
    s_lshl_b32 s34, s34, 5
    s_lshr_b32 s3, s2, 3
    s_add_u32 s34, s34, s3
    s_mul_i32 s39, s33, 2080
    s_lshl_b32 s3, s34, 5
    s_add_u32 s39, s39, s3
    s_mul_i32 s40, s33, 1310720
    s_add_u32 s40, s40, 0x50000
    s_lshl_b32 s38, s32, 11
    s_mul_i32 s100, s32, 3072
    s_mov_b32 s8, s30
    s_mov_b32 s9, s31
    s_mov_b32 s10, 0xd340000
    s_mov_b32 s11, 0x20000
    s_add_u32 s12, s30, 0x28000
    s_addc_u32 s13, s31, 0
    s_mov_b32 s14, 0xd318000
    s_mov_b32 s15, 0x20000
    s_mov_b32 s16, s64
    s_mov_b32 s17, s65
    s_mov_b32 s18, 0x20
    s_mov_b32 s19, 0x20000
    s_mov_b32 s24, s28
    s_mov_b32 s25, s29
    s_mov_b32 s26, 0x4e2000
    s_mov_b32 s27, 0x20000
    s_setprio 3
    v_and_b32 v7, -4, v120
    v_lshl_add_u32 v8, v120, 2, v7
    ds_write_b32 v8, v16
    v_lshl_add_u32 v7, v7, 2, v120
    ds_write_b8 v7, v44 offset:16
    v_and_b32 v9, -4, v121
    v_lshl_add_u32 v10, v121, 2, v9
    ds_write_b32 v10, v17
    v_lshl_add_u32 v9, v9, 2, v121
    ds_write_b8_d16_hi v9, v44 offset:16
    v_and_b32 v7, -4, v122
    v_lshl_add_u32 v8, v122, 2, v7
    ds_write_b32 v8, v18
    v_lshl_add_u32 v7, v7, 2, v122
    ds_write_b8 v7, v45 offset:16
    v_and_b32 v9, -4, v123
    v_lshl_add_u32 v10, v123, 2, v9
    ds_write_b32 v10, v19
    v_lshl_add_u32 v9, v9, 2, v123
    ds_write_b8_d16_hi v9, v45 offset:16
    s_add_u32 s46, s35, 0x7edc000
    buffer_store_dwordx4 v[116:119], v0, s[20:23], s46 offen sc1
    v_and_b32 v13, 0x3f0, v0
    v_and_b32 v14, 0x300, v13
    v_bfe_u32 v15, v13, 4, 4
    s_lshl_b32 s3, s32, 4
    v_add3_u32 v14, v14, v15, s3
    v_mul_u32_u24 v2, 173056, v14
    v_lshrrev_b32 v14, 6, v13
    s_add_u32 s3, s3, 0x400
    v_add_u32 v14, s3, v14
    v_mul_u32_u24 v4, 173056, v14
    v_and_b32 v14, 3, v14
    v_and_b32 v15, 0x30, v13
    v_lshl_add_u32 v14, v14, 5, v15
    v_add_u32 v6, v14, v4
    v_lshl_add_u32 v5, v15, 1, v2
    v_lshrrev_b32 v14, 3, v15
    buffer_load_ushort v100, v14, s[16:19], 0 offen offset:0
    buffer_load_ushort v101, v14, s[16:19], 0 offen offset:8
    buffer_load_ushort v102, v14, s[16:19], 0 offen offset:16
    buffer_load_ushort v103, v14, s[16:19], 0 offen offset:24
    s_mul_i32 s3, s32, 5120
    v_add_u32 v3, s3, v13
    v_lshrrev_b32 v14, 2, v13
    v_add_u32 v14, s38, v14
    v_and_b32 v7, -4, v124
    v_lshl_add_u32 v8, v124, 2, v7
    ds_write_b32 v8, v20
    v_lshl_add_u32 v7, v7, 2, v124
    ds_write_b8 v7, v46 offset:16
    v_and_b32 v9, -4, v125
    v_lshl_add_u32 v10, v125, 2, v9
    ds_write_b32 v10, v21
    v_lshl_add_u32 v9, v9, 2, v125
    ds_write_b8_d16_hi v9, v46 offset:16
    v_and_b32 v7, -4, v126
    v_lshl_add_u32 v8, v126, 2, v7
    ds_write_b32 v8, v22
    v_lshl_add_u32 v7, v7, 2, v126
    ds_write_b8 v7, v47 offset:16
    v_and_b32 v9, -4, v127
    v_lshl_add_u32 v10, v127, 2, v9
    ds_write_b32 v10, v23
    v_lshl_add_u32 v9, v9, 2, v127
    ds_write_b8_d16_hi v9, v47 offset:16
    s_setprio 2
    v_and_b32 v7, -4, v24
    v_lshl_add_u32 v8, v24, 2, v7
    ds_write_b32 v8, v40
    v_lshl_add_u32 v7, v7, 2, v24
    ds_write_b8 v7, v32 offset:16
    v_and_b32 v9, -4, v25
    v_lshl_add_u32 v10, v25, 2, v9
    ds_write_b32 v10, v41
    v_lshl_add_u32 v9, v9, 2, v25
    ds_write_b8_d16_hi v9, v32 offset:16
    v_and_b32 v7, -4, v26
    v_lshl_add_u32 v8, v26, 2, v7
    ds_write_b32 v8, v42
    v_lshl_add_u32 v7, v7, 2, v26
    ds_write_b8 v7, v33 offset:16
    v_and_b32 v9, -4, v27
    v_lshl_add_u32 v10, v27, 2, v9
    ds_write_b32 v10, v43
    v_lshl_add_u32 v9, v9, 2, v27
    ds_write_b8_d16_hi v9, v33 offset:16
    s_add_u32 s47, s35, 0x7ee0000
    buffer_store_dwordx4 v[92:95], v0, s[20:23], s47 offen sc1
    v_and_b32 v7, -4, v52
    v_lshl_add_u32 v8, v52, 2, v7
    ds_write_b32 v8, v48
    v_lshl_add_u32 v7, v7, 2, v52
    ds_write_b8 v7, v34 offset:16
    v_and_b32 v9, -4, v53
    v_lshl_add_u32 v10, v53, 2, v9
    ds_write_b32 v10, v49
    v_lshl_add_u32 v9, v9, 2, v53
    ds_write_b8_d16_hi v9, v34 offset:16
    v_and_b32 v7, -4, v54
    v_lshl_add_u32 v8, v54, 2, v7
    ds_write_b32 v8, v50
    v_lshl_add_u32 v7, v7, 2, v54
    ds_write_b8 v7, v35 offset:16
    v_and_b32 v9, -4, v55
    v_lshl_add_u32 v10, v55, 2, v9
    ds_write_b32 v10, v51
    v_lshl_add_u32 v9, v9, 2, v55
    ds_write_b8_d16_hi v9, v35 offset:16
    s_setprio 1
    v_and_b32 v7, -4, v68
    v_lshl_add_u32 v8, v68, 2, v7
    ds_write_b32 v8, v84
    v_lshl_add_u32 v7, v7, 2, v68
    ds_write_b8 v7, v72 offset:16
    v_and_b32 v9, -4, v69
    v_lshl_add_u32 v10, v69, 2, v9
    ds_write_b32 v10, v85
    v_lshl_add_u32 v9, v9, 2, v69
    ds_write_b8_d16_hi v9, v72 offset:16
    v_and_b32 v7, -4, v70
    v_lshl_add_u32 v8, v70, 2, v7
    ds_write_b32 v8, v86
    v_lshl_add_u32 v7, v7, 2, v70
    ds_write_b8 v7, v73 offset:16
    v_and_b32 v9, -4, v71
    v_lshl_add_u32 v10, v71, 2, v9
    ds_write_b32 v10, v87
    v_lshl_add_u32 v9, v9, 2, v71
    ds_write_b8_d16_hi v9, v73 offset:16
    s_cmp_le_u32 s43, 5
    s_cbranch_scc1 L1_s12
    v_and_b32 v7, -4, v76
    v_lshl_add_u32 v8, v76, 2, v7
    ds_write_b32 v8, v36
    v_lshl_add_u32 v7, v7, 2, v76
    ds_write_b8 v7, v74 offset:16
    v_and_b32 v9, -4, v77
    v_lshl_add_u32 v10, v77, 2, v9
    ds_write_b32 v10, v37
    v_lshl_add_u32 v9, v9, 2, v77
    ds_write_b8_d16_hi v9, v74 offset:16
    v_and_b32 v7, -4, v78
    v_lshl_add_u32 v8, v78, 2, v7
    ds_write_b32 v8, v38
    v_lshl_add_u32 v7, v7, 2, v78
    ds_write_b8 v7, v75 offset:16
    v_and_b32 v9, -4, v79
    v_lshl_add_u32 v10, v79, 2, v9
    ds_write_b32 v10, v39
    v_lshl_add_u32 v9, v9, 2, v79
    ds_write_b8_d16_hi v9, v75 offset:16
L1_s12:
    s_add_u32 s44, s35, 0x7ee4000
    buffer_store_dwordx4 v[108:111], v0, s[20:23], s44 offen sc1
    s_setprio 0
    s_cmp_le_u32 s43, 6
    s_cbranch_scc1 L1_s13
    v_and_b32 v7, -4, v56
    v_lshl_add_u32 v8, v56, 2, v7
    ds_write_b32 v8, v80
    v_lshl_add_u32 v7, v7, 2, v56
    ds_write_b8 v7, v64 offset:16
    v_and_b32 v9, -4, v57
    v_lshl_add_u32 v10, v57, 2, v9
    ds_write_b32 v10, v81
    v_lshl_add_u32 v9, v9, 2, v57
    ds_write_b8_d16_hi v9, v64 offset:16
    v_and_b32 v7, -4, v58
    v_lshl_add_u32 v8, v58, 2, v7
    ds_write_b32 v8, v82
    v_lshl_add_u32 v7, v7, 2, v58
    ds_write_b8 v7, v65 offset:16
    v_and_b32 v9, -4, v59
    v_lshl_add_u32 v10, v59, 2, v9
    ds_write_b32 v10, v83
    v_lshl_add_u32 v9, v9, 2, v59
    ds_write_b8_d16_hi v9, v65 offset:16
L1_s13:
    s_cmp_le_u32 s43, 7
    s_cbranch_scc1 L1_s14
    v_and_b32 v7, -4, v60
    v_lshl_add_u32 v8, v60, 2, v7
    ds_write_b32 v8, v96
    v_lshl_add_u32 v7, v7, 2, v60
    ds_write_b8 v7, v66 offset:16
    v_and_b32 v9, -4, v61
    v_lshl_add_u32 v10, v61, 2, v9
    ds_write_b32 v10, v97
    v_lshl_add_u32 v9, v9, 2, v61
    ds_write_b8_d16_hi v9, v66 offset:16
    v_and_b32 v7, -4, v62
    v_lshl_add_u32 v8, v62, 2, v7
    ds_write_b32 v8, v98
    v_lshl_add_u32 v7, v7, 2, v62
    ds_write_b8 v7, v67 offset:16
    v_and_b32 v9, -4, v63
    v_lshl_add_u32 v10, v63, 2, v9
    ds_write_b32 v10, v99
    v_lshl_add_u32 v9, v9, 2, v63
    ds_write_b8_d16_hi v9, v67 offset:16
L1_s14:
    s_waitcnt vmcnt(3)
    v_add_u32 v7, 0x10000, v0
    v_add_u32 v12, 0x20000, v0
    s_waitcnt lgkmcnt(0)
    s_barrier
    ds_read_b128 v[24:27], v0 offset:0
    ds_read_b128 v[28:31], v0 offset:16384
    ds_read_b128 v[32:35], v0 offset:32768
    ds_read_b128 v[36:39], v0 offset:49152
    ds_read_b128 v[76:79], v7 offset:0
    ds_read_b128 v[80:83], v7 offset:16384
    ds_read_b128 v[84:87], v7 offset:32768
    ds_read_b128 v[104:107], v7 offset:49152
    ds_read_b128 v[68:71], v12 offset:0
    ds_read_b128 v[72:75], v12 offset:16384
    s_cmp_lg_u32 s32, 0
    s_cbranch_scc1 L2_sg1
    s_mov_b32 exec_hi, 0
    v_mov_b32 v11, 1
    buffer_store_dword v11, v14, s[60:63], s57 offen sc1
    s_mov_b64 exec, -1
L2_sg1:
    s_waitcnt lgkmcnt(9)
    s_add_u32 s45, s35, 0xa900000
    buffer_store_dwordx4 v[24:27], v0, s[20:23], s45 offen sc1
    s_waitcnt lgkmcnt(8)
    s_add_u32 s46, s35, 0xa904000
    buffer_store_dwordx4 v[28:31], v0, s[20:23], s46 offen sc1
    s_waitcnt lgkmcnt(7)
    s_add_u32 s47, s35, 0xa908000
    buffer_store_dwordx4 v[32:35], v0, s[20:23], s47 offen sc1
    s_waitcnt lgkmcnt(6)
    s_add_u32 s44, s35, 0xa90c000
    buffer_store_dwordx4 v[36:39], v0, s[20:23], s44 offen sc1
    s_waitcnt lgkmcnt(5)
    s_add_u32 s45, s35, 0xa910000
    buffer_store_dwordx4 v[76:79], v0, s[20:23], s45 offen sc1
    s_waitcnt lgkmcnt(4)
    s_add_u32 s46, s35, 0xa914000
    buffer_store_dwordx4 v[80:83], v0, s[20:23], s46 offen sc1
    s_waitcnt lgkmcnt(3)
    s_add_u32 s47, s35, 0xa918000
    buffer_store_dwordx4 v[84:87], v0, s[20:23], s47 offen sc1
    s_waitcnt lgkmcnt(2)
    s_cmp_le_u32 s43, 5
    s_cbranch_scc1 L1_q15
    s_add_u32 s44, s35, 0xa91c000
    buffer_store_dwordx4 v[104:107], v0, s[20:23], s44 offen sc1
L1_q15:
    s_waitcnt lgkmcnt(1)
    s_cmp_le_u32 s43, 6
    s_cbranch_scc1 L1_q16
    s_add_u32 s45, s35, 0xa920000
    buffer_store_dwordx4 v[68:71], v0, s[20:23], s45 offen sc1
L1_q16:
    s_waitcnt lgkmcnt(0)
    s_cmp_le_u32 s43, 7
    s_cbranch_scc1 L1_q17
    s_add_u32 s46, s35, 0xa924000
    buffer_store_dwordx4 v[72:75], v0, s[20:23], s46 offen sc1
L1_q17:
    s_waitcnt lgkmcnt(0)
    s_barrier
    s_setprio 3
    v_mov_b32 v92, v0
    v_mov_b32 v93, v6
    v_mov_b32 v94, v13
    v_mov_b32 v95, v5
    v_mov_b32 v0, v14
    v_lshl_add_u32 v7, v13, 3, s38
    v_lshrrev_b32 v16, 2, v15
    v_mad_u32_u24 v4, v16, 5, v4
    v_or_b32 v4, 0xf0000000, v4
    v_or_b32 v2, 0xf0000000, v2
    v_sub_u32 v1, 28, v16
    v_lshrrev_b32 v17, 2, v16
    v_and_b32 v18, 3, v17
    v_lshlrev_b32 v18, 4, v18
    v_mov_b32 v10, 0x3f80
    v_mov_b32 v11, 0
    v_lshlrev_b64 v[10:11], v18, v[10:11]
    v_and_b32 v18, 3, v17
    v_lshlrev_b32 v18, 4, v18
    v_mov_b32 v12, 0xbf80
    v_mov_b32 v13, 0
    v_lshlrev_b64 v[12:13], v18, v[12:13]
    v_mov_b32 v45, 0xf0000000
    v_mov_b32 v5, 0x1fff8
    v_mov_b32 v6, 0x07ff0000
    v_mov_b32 v16, 0
    v_mov_b32 v17, 0
    v_mov_b32 v18, 0
    v_mov_b32 v19, 0
    v_add_u32 v20, 81920, v92
    v_add_u32 v21, 0x10000, v20
    ds_write_b128 v20, v[16:19] offset:0
    ds_write_b128 v20, v[16:19] offset:16384
    s_setprio 2
    ds_write_b128 v20, v[16:19] offset:32768
    ds_write_b128 v20, v[16:19] offset:49152
    ds_write_b128 v21, v[16:19]
    s_setprio 1
    s_setprio 0
    s_mov_b32 s44, 0x4000c0c
    s_mov_b32 s45, 0x4010c0c
    s_mov_b32 s46, 0x4020c0c
    s_mov_b32 s47, 0x4030c0c
    s_mov_b32 s36, 0
    s_mov_b32 s43, 0
    s_mov_b32 s42, 0
    s_mov_b64 s[80:81], 0
    s_mov_b64 s[84:85], 0
    s_mov_b64 s[48:49], 0
    s_add_u32 s16, s30, 0xd340000
    s_addc_u32 s17, s31, 0
    s_mov_b32 s18, 0x500000
    s_mov_b32 s19, 0x20000
    s_add_u32 s20, s30, 0xd841000
    s_addc_u32 s21, s31, 0
    s_mov_b32 s22, 0x13880
    s_mov_b32 s23, 0x20000
    s_lshl_b32 s3, s33, 6
    s_add_u32 s3, s3, s34
    s_mul_i32 s3, s3, 80000
    s_add_u32 s20, s20, s3
    s_addc_u32 s21, s21, 0
    v_mov_b32 v68, 0
    v_mov_b32 v69, 0
    v_mov_b32 v70, 0
    v_mov_b32 v71, 0
    v_mov_b32 v72, 0
    v_mov_b32 v73, 0
    v_mov_b32 v74, 0
    v_mov_b32 v75, 0
    s_waitcnt vmcnt(0)
    v_lshl_or_b32 v8, v101, 16, v100
    v_lshl_or_b32 v9, v103, 16, v102
    s_barrier
    s_cmp_lg_u32 s32, 0
    s_cbranch_scc1 L2_sg2
    s_mov_b32 exec_hi, 0
    v_mov_b32 v88, 2
    buffer_store_dword v88, v0, s[60:63], s57 offen sc1
    s_mov_b64 exec, -1
L2_sg2:
    s_mul_i32 s3, s33, 1280000
    s_add_u32 s3, s3, s100
    s_add_u32 s3, s3, 32768
    buffer_load_dwordx4 v[124:127], v94, s[24:27], s3 offen offset:2048
    s_mul_i32 s3, s33, 1280000
    s_add_u32 s3, s3, s100
    s_add_u32 s3, s3, 32768
    buffer_load_dwordx4 v[116:119], v94, s[24:27], s3 offen offset:0
    s_mul_i32 s3, s33, 1280000
    s_add_u32 s3, s3, s100
    s_add_u32 s3, s3, 32768
    buffer_load_dwordx4 v[120:123], v94, s[24:27], s3 offen offset:1024
    s_mul_i32 s3, s33, 1280000
    s_add_u32 s3, s3, s38
    s_add_u32 s3, s3, 0
    buffer_load_dwordx4 v[108:111], v94, s[24:27], s3 offen offset:0
    s_mul_i32 s3, s33, 1280000
    s_add_u32 s3, s3, s38
    s_add_u32 s3, s3, 0
    buffer_load_dwordx4 v[112:115], v94, s[24:27], s3 offen offset:1024
    s_cmp_eq_u32 s56, 0
    s_cbranch_scc1 L2_e3
    v_lshlrev_b32 v16, 3, v94
    v_and_b32 v16, 0x80, v16
L2_e4:
    buffer_load_dword v88, v16, s[68:71], 0 offen sc1
    s_waitcnt vmcnt(0)
    v_cmp_gt_u32 vcc, 0x80, v88
    s_cbranch_vccnz L2_e4
L2_e3:
    s_mov_b64 exec, 0xffff
L2_p1:
    buffer_load_dword v88, v7, s[60:63], 0 offen sc1
    s_waitcnt vmcnt(0)
    v_cmp_gt_u32 vcc, 1, v88
    s_cbranch_vccnz L2_p1s
    s_mov_b64 exec, -1
    v_cmp_gt_u32 vcc, 2, v88
    s_and_b32 s56, vcc_lo, 0xffff
    buffer_load_dwordx4 v[48:51], v95, s[12:15], s39 offen offset:0
    buffer_load_dwordx4 v[56:59], v95, s[12:15], s39 offen offset:32
    buffer_load_dwordx4 v[52:55], v95, s[12:15], s39 offen offset:16
    buffer_load_dwordx4 v[60:63], v95, s[12:15], s39 offen offset:48
    buffer_load_dwordx4 v[64:67], v93, s[12:15], s39 offen
    s_waitcnt vmcnt(0)
    v_sub_u16 v88, v56, v48
    v_and_b32 v89, 3, v48
    v_add3_u32 v99, v88, v89, 3
    v_and_b32 v99, -4, v99
    v_max_u32 v99, 4, v99
    v_and_b32 v97, 0xfffc, v48
    v_bfm_b32 v96, v88, v89
    v_add_u32_dpp v91, v99, v99 row_shr:1 row_mask:0xf bank_mask:0xf bound_ctrl:1
    v_mad_u32_u24 v97, v97, 5, v2
    v_cmp_lt_u32 vcc, 16, v99
    v_add_u32_dpp v91, v91, v91 row_shr:2 row_mask:0xf bank_mask:0xf bound_ctrl:1
    v_sub_u32 v98, s38, v99
    v_lshrrev_b64 v[48:49], 16, v[48:49]
    v_add_u32_dpp v91, v91, v91 row_shr:4 row_mask:0xf bank_mask:0xf bound_ctrl:1
    v_lshrrev_b64 v[56:57], 16, v[56:57]
    s_mov_b32 s101, 0
    v_add_u32_dpp v91, v91, v91 row_shr:8 row_mask:0xf bank_mask:0xf bound_ctrl:1
    s_nop 1
    v_add_u32_dpp v91, v91, v91 row_bcast:15 row_mask:0xa bank_mask:0xf
    s_nop 1
    v_add_u32_dpp v91, v91, v91 row_bcast:31 row_mask:0xc bank_mask:0xf
    v_add_u32 v98, v98, v91
    v_readlane_b32 s37, v91, 63
    s_cbranch_vccnz L2_xo3
L2_xp3:
    v_mov_b32 v44, v43
    s_cmp_gt_u32 s37, 1024
    s_cbranch_scc1 L2_xs4
    s_cmp_lg_u32 s101, 0
    s_cbranch_scc1 L2_xa4
L2_xb4:
    v_lshlrev_b32 v89, 16, v96
    v_add_u32 v90, 60, v97
    v_bitop3_b32 v90, v89, v45, v90 bitop3:0x6a
    ds_write_b32 v98, v90 offset:12
    v_lshlrev_b32 v89, 20, v96
    v_add_u32 v90, 40, v97
    v_bitop3_b32 v90, v89, v45, v90 bitop3:0x6a
    ds_write_b32 v98, v90 offset:8
    v_lshlrev_b32 v89, 24, v96
    v_add_u32 v90, 20, v97
    v_bitop3_b32 v90, v89, v45, v90 bitop3:0x6a
    ds_write_b32 v98, v90 offset:4
    v_lshlrev_b32 v89, 28, v96
    v_bitop3_b32 v90, v89, v45, v97 bitop3:0x6a
    ds_write_b32 v98, v90 offset:0
    v_mov_b32_dpp v91, v64 quad_perm:[0,0,0,0] row_mask:0xf bank_mask:0xf
    v_and_b32 v89, 3, v91
    v_and_b32 v97, 0xfffc, v91
    v_sub_u16_dpp v88, v64, v91 quad_perm:[2,2,2,2] row_mask:0xf bank_mask:0xf
    v_mad_u32_u24 v97, v97, 5, v4
    v_add_u32 v99, v88, v89
    v_bfm_b32 v96, v88, v89
    v_cmp_lt_u32 s[58:59], 16, v99
    v_lshlrev_b32 v89, v1, v96
    v_and_b32 v89, v45, v89
    v_cmp_ne_u32 vcc, 0, v89
    v_xor_b32 v90, v97, v89
    s_add_u32 s3, s37, s38
    v_mbcnt_lo_u32_b32 v98, vcc_lo, 0
    v_mbcnt_hi_u32_b32 v98, vcc_hi, v98
    s_bcnt1_i32_b64 s41, vcc
    v_lshl_add_u32 v98, v98, 2, s3
    s_mov_b64 exec, vcc
    ds_write_b32 v98, v90
    s_mov_b64 exec, -1
    s_lshl2_add_u32 s37, s41, s37
    s_cmp_lg_u64 s[58:59], 0
    s_cbranch_scc1 L2_xe4
L2_xr4:
    v_add_u32 v98, s37, v0
    v_mov_b32 v90, -1
    ds_write_b32 v98, v90
    ds_read2st64_b32 v[40:41], v0 offset0:0 offset1:1
    ds_read2st64_b32 v[42:43], v0 offset0:2 offset1:3
    s_sub_u32 s3, s37, 768
    s_cmp_gt_u32 s3, 256
    s_cbranch_scc1 L2_xf4
L2_xg4:
    v_sub_u16 v88, v58, v50
    v_and_b32 v89, 3, v50
    v_add3_u32 v99, v88, v89, 3
    v_and_b32 v99, -4, v99
    v_max_u32 v99, 4, v99
    v_and_b32 v97, 0xfffc, v50
    v_bfm_b32 v96, v88, v89
    v_add_u32_dpp v91, v99, v99 row_shr:1 row_mask:0xf bank_mask:0xf bound_ctrl:1
    v_mad_u32_u24 v97, v97, 5, v2
    v_cmp_lt_u32 vcc, 16, v99
    v_add_u32_dpp v91, v91, v91 row_shr:2 row_mask:0xf bank_mask:0xf bound_ctrl:1
    v_sub_u32 v98, s38, v99
    v_lshrrev_b64 v[50:51], 16, v[50:51]
    v_add_u32_dpp v91, v91, v91 row_shr:4 row_mask:0xf bank_mask:0xf bound_ctrl:1
    v_lshrrev_b64 v[58:59], 16, v[58:59]
    s_mov_b32 s101, 0
    v_add_u32_dpp v91, v91, v91 row_shr:8 row_mask:0xf bank_mask:0xf bound_ctrl:1
    s_nop 1
    v_add_u32_dpp v91, v91, v91 row_bcast:15 row_mask:0xa bank_mask:0xf
    s_nop 1
    v_add_u32_dpp v91, v91, v91 row_bcast:31 row_mask:0xc bank_mask:0xf
    v_add_u32 v98, v98, v91
    v_readlane_b32 s37, v91, 63
    s_cbranch_vccnz L2_xo5
L2_xp5:
    s_waitcnt lgkmcnt(0)
    v_mov_b32 v21, v40
    v_mov_b32 v27, v41
    v_mov_b32 v33, v42
    v_mov_b32 v39, v43
    v_mov_b32 v44, v43
    s_cmp_gt_u32 s37, 1024
    s_cbranch_scc1 L2_xs6
    s_cmp_lg_u32 s101, 0
    s_cbranch_scc1 L2_xa6
L2_xb6:
    v_lshlrev_b32 v89, 16, v96
    v_add_u32 v90, 60, v97
    v_bitop3_b32 v90, v89, v45, v90 bitop3:0x6a
    ds_write_b32 v98, v90 offset:12
    v_lshlrev_b32 v89, 20, v96
    v_add_u32 v90, 40, v97
    v_bitop3_b32 v90, v89, v45, v90 bitop3:0x6a
    ds_write_b32 v98, v90 offset:8
    v_lshlrev_b32 v89, 24, v96
    v_add_u32 v90, 20, v97
    v_bitop3_b32 v90, v89, v45, v90 bitop3:0x6a
    ds_write_b32 v98, v90 offset:4
    v_lshlrev_b32 v89, 28, v96
    v_bitop3_b32 v90, v89, v45, v97 bitop3:0x6a
    ds_write_b32 v98, v90 offset:0
    v_mov_b32_dpp v91, v66 quad_perm:[0,0,0,0] row_mask:0xf bank_mask:0xf
    v_and_b32 v89, 3, v91
    v_and_b32 v97, 0xfffc, v91
    v_sub_u16_dpp v88, v66, v91 quad_perm:[2,2,2,2] row_mask:0xf bank_mask:0xf
    v_mad_u32_u24 v97, v97, 5, v4
    v_add_u32 v99, v88, v89
    v_bfm_b32 v96, v88, v89
    v_cmp_lt_u32 s[58:59], 16, v99
    v_lshlrev_b32 v89, v1, v96
    v_and_b32 v89, v45, v89
    v_cmp_ne_u32 vcc, 0, v89
    v_xor_b32 v90, v97, v89
    s_add_u32 s3, s37, s38
    v_mbcnt_lo_u32_b32 v98, vcc_lo, 0
    v_mbcnt_hi_u32_b32 v98, vcc_hi, v98
    s_bcnt1_i32_b64 s41, vcc
    v_lshl_add_u32 v98, v98, 2, s3
    s_mov_b64 exec, vcc
    ds_write_b32 v98, v90
    s_mov_b64 exec, -1
    s_lshl2_add_u32 s37, s41, s37
    s_cmp_lg_u64 s[58:59], 0
    s_cbranch_scc1 L2_xe6
L2_xr6:
    v_add_u32 v98, s37, v0
    v_mov_b32 v90, -1
    ds_write_b32 v98, v90
    ds_read2st64_b32 v[40:41], v0 offset0:0 offset1:1
    ds_read2st64_b32 v[42:43], v0 offset0:2 offset1:3
    s_sub_u32 s3, s37, 768
    s_cmp_gt_u32 s3, 256
    s_cbranch_scc1 L2_xf6
L2_xg6:
    v_subrev_u32 v88, s38, v3
    ds_write_b128 v88, v[124:127] offset:34816
    v_subrev_u32 v88, s38, v3
    ds_write_b128 v88, v[116:119] offset:32768
    v_subrev_u32 v88, s38, v3
    ds_write_b128 v88, v[120:123] offset:33792
    v_subrev_u32 v88, s100, v3
    ds_write_b128 v88, v[108:111] offset:0
    v_subrev_u32 v88, s100, v3
    ds_write_b128 v88, v[112:115] offset:1024
    s_cmp_eq_u32 s56, 0
    s_cbranch_scc1 L2_e2
    s_mov_b64 exec, 0xffff
    buffer_load_dword v88, v7, s[60:63], 0 offen sc1
    s_mov_b64 exec, -1
    s_waitcnt vmcnt(0)
    v_cmp_gt_u32 vcc, 2, v88
    s_and_b32 s56, vcc_lo, 0xffff
    s_cbranch_scc0 L2_e2
    s_mul_i32 s3, s33, 1280000
    s_add_u32 s3, s3, s100
    s_add_u32 s3, s3, 352768
    buffer_load_dwordx4 v[124:127], v94, s[24:27], s3 offen offset:2048
    s_mul_i32 s3, s33, 1280000
    s_add_u32 s3, s3, s100
    s_add_u32 s3, s3, 352768
    buffer_load_dwordx4 v[116:119], v94, s[24:27], s3 offen offset:0
    s_mul_i32 s3, s33, 1280000
    s_add_u32 s3, s3, s100
    s_add_u32 s3, s3, 352768
    buffer_load_dwordx4 v[120:123], v94, s[24:27], s3 offen offset:1024
    s_mul_i32 s3, s33, 1280000
    s_add_u32 s3, s3, s38
    s_add_u32 s3, s3, 320000
    buffer_load_dwordx4 v[108:111], v94, s[24:27], s3 offen offset:0
    s_mul_i32 s3, s33, 1280000
    s_add_u32 s3, s3, s38
    s_add_u32 s3, s3, 320000
    buffer_load_dwordx4 v[112:115], v94, s[24:27], s3 offen offset:1024
    s_mov_b64 exec, 0xffff
L2_p2:
    buffer_load_dword v88, v7, s[60:63], 0 offen sc1
    s_waitcnt vmcnt(0)
    v_cmp_gt_u32 vcc, 2, v88
    s_cbranch_vccnz L2_p2s
    s_mov_b64 exec, -1
L2_e2:
    s_mov_b32 s6, 0xaaaaaaaa
    s_mov_b32 s7, 0xaaaaaaaa
    v_and_b32 v47, 0x0fffffff, v21
    buffer_load_dwordx2 v[16:17], v47, s[8:11], 0 offen
    buffer_load_dwordx3 v[18:20], v47, s[8:11], 0 offen offset:8
    s_waitcnt lgkmcnt(0)
    s_barrier
    s_bitcmp1_b32 s36, s42
    s_cbranch_scc1 L2_slow
L2_ret0:
    s_setprio 3
    v_and_b32 v47, 0x0fffffff, v27
    buffer_load_dwordx2 v[22:23], v47, s[8:11], 0 offen
    buffer_load_dwordx3 v[24:26], v47, s[8:11], 0 offen offset:8
    s_waitcnt vmcnt(2)
    v_and_b32 v46, 0x20000000, v21
    v_lshrrev_b32 v47, 14, v17
    v_bitop3_b32 v47, v47, v5, v46 bitop3:0xea
    ds_read_b64 v[102:103], v47
    v_bitop3_b32 v93, v17, v5, v46 bitop3:0xea
    v_and_b32 v46, 0x10000000, v21
    v_lshrrev_b32 v47, 14, v16
    v_bitop3_b32 v47, v47, v5, v46 bitop3:0xea
    ds_read_b64 v[100:101], v47
    v_bitop3_b32 v92, v16, v5, v46 bitop3:0xea
    v_perm_b32 v15, v17, v20, s45
    v_bitop3_b32 v46, v17, 0.5, -0.5 bitop3:0xa8
    v_perm_b32 v14, v16, v20, s44
    v_bitop3_b32 v47, v16, 0.5, -0.5 bitop3:0xa8
    s_waitcnt lgkmcnt(0)
    v_mfma_f32_4x4x4_16b_bf16 v[80:83], v[8:9], v[102:103], 0
    v_mfma_f32_4x4x4_16b_bf16 v[76:79], v[8:9], v[100:101], 0
    v_bitop3_b32 v15, v6, v15, v46 bitop3:0xca
    v_bitop3_b32 v14, v6, v14, v47 bitop3:0xca
    v_cmp_lt_u32 s[84:85], v5, v92
    s_nop 0
    v_pk_mul_f32 v[80:81], v[80:81], v[14:15] op_sel:[0,1] op_sel_hi:[1,1]
    v_pk_mul_f32 v[82:83], v[82:83], v[14:15] op_sel:[0,1] op_sel_hi:[1,1]
    v_pk_mul_f32 v[76:77], v[76:77], v[14:15] op_sel:[0,0] op_sel_hi:[1,0]
    v_pk_mul_f32 v[78:79], v[78:79], v[14:15] op_sel:[0,0] op_sel_hi:[1,0]
    v_and_b32 v47, 0x0fffffff, v33
    buffer_load_dwordx2 v[28:29], v47, s[8:11], 0 offen
    buffer_load_dwordx3 v[30:32], v47, s[8:11], 0 offen offset:8
    v_cmp_ne_u64 s[50:51], v[72:73], v[68:69]
    v_cmpx_ne_u64 s[54:55], v[74:75], v[70:71]
    s_and_b64 s[82:83], s[54:55], s[80:81]
    s_cbranch_scc1 L2_c7
L2_d7:
    v_mov_b64 v[84:85], v[70:71]
    v_mov_b32 v7, v95
    v_mov_b64 v[86:87], v[74:75]
    s_or_b64 s[80:81], s[80:81], s[54:55]
    s_mov_b64 exec, s[50:51]
    s_and_b64 s[82:83], s[50:51], s[80:81]
    s_cbranch_scc1 L2_c8
L2_d8:
    v_mov_b64 v[84:85], v[68:69]
    v_mov_b32 v7, v94
    v_mov_b64 v[86:87], v[72:73]
    s_mov_b64 exec, -1
    s_or_b64 s[80:81], s[80:81], s[50:51]
    ds_read_b64 v[70:71], v93 offset:65408
    s_and_b64 exec, s[84:85], s[80:81]
    v_mfma_f32_4x4x4_16b_bf16 v[76:79], v[12:13], v[84:85], 0
    v_mov_b32 v92, v7
    s_andn2_b64 s[80:81], s[80:81], s[84:85]
    v_mfma_f32_4x4x4_16b_bf16 v[76:79], v[10:11], v[86:87], v[76:79]
    s_mov_b64 exec, -1
    ds_read_b64 v[68:69], v92 offset:65408
    v_and_b32 v46, 0x80000000, v21
    v_lshrrev_b32 v47, 14, v19
    v_bitop3_b32 v47, v47, v5, v46 bitop3:0xea
    ds_read_b64 v[106:107], v47
    v_bitop3_b32 v95, v19, v5, v46 bitop3:0xea
    v_and_b32 v46, 0x40000000, v21
    v_lshrrev_b32 v47, 14, v18
    v_bitop3_b32 v47, v47, v5, v46 bitop3:0xea
    ds_read_b64 v[104:105], v47
    v_bitop3_b32 v94, v18, v5, v46 bitop3:0xea
    s_waitcnt lgkmcnt(2)
    v_mfma_f32_4x4x4_16b_bf16 v[80:83], v[10:11], v[70:71], v[80:83]
    v_mfma_f32_4x4x4_16b_bf16 v[76:79], v[10:11], v[68:69], v[76:79]
    v_perm_b32 v15, v19, v20, s47
    v_bitop3_b32 v46, v19, 0.5, -0.5 bitop3:0xa8
    v_perm_b32 v14, v18, v20, s46
    v_bitop3_b32 v47, v18, 0.5, -0.5 bitop3:0xa8
    v_cvt_pk_bf16_f32 v80, v80, v81
    v_cvt_pk_bf16_f32 v81, v82, v83
    ds_wrxchg_rtn_b64 v[74:75], v93, v[80:81] offset:65408
    v_cvt_pk_bf16_f32 v76, v76, v77
    v_cvt_pk_bf16_f32 v77, v78, v79
    ds_wrxchg_rtn_b64 v[72:73], v92, v[76:77] offset:65408
    s_setprio 2
    s_waitcnt lgkmcnt(2)
    v_mfma_f32_4x4x4_16b_bf16 v[80:83], v[8:9], v[106:107], 0
    v_mfma_f32_4x4x4_16b_bf16 v[76:79], v[8:9], v[104:105], 0
    v_bitop3_b32 v15, v6, v15, v46 bitop3:0xca
    v_bitop3_b32 v14, v6, v14, v47 bitop3:0xca
    s_nop 1
    v_pk_mul_f32 v[80:81], v[80:81], v[14:15] op_sel:[0,1] op_sel_hi:[1,1]
    v_pk_mul_f32 v[82:83], v[82:83], v[14:15] op_sel:[0,1] op_sel_hi:[1,1]
    v_pk_mul_f32 v[76:77], v[76:77], v[14:15] op_sel:[0,0] op_sel_hi:[1,0]
    v_pk_mul_f32 v[78:79], v[78:79], v[14:15] op_sel:[0,0] op_sel_hi:[1,0]
    v_sub_u16 v88, v60, v52
    v_and_b32 v89, 3, v52
    v_add3_u32 v99, v88, v89, 3
    v_and_b32 v99, -4, v99
    v_max_u32 v99, 4, v99
    v_and_b32 v97, 0xfffc, v52
    v_bfm_b32 v96, v88, v89
    v_add_u32_dpp v91, v99, v99 row_shr:1 row_mask:0xf bank_mask:0xf bound_ctrl:1
    v_mad_u32_u24 v97, v97, 5, v2
    v_cmp_lt_u32 vcc, 16, v99
    v_add_u32_dpp v91, v91, v91 row_shr:2 row_mask:0xf bank_mask:0xf bound_ctrl:1
    v_sub_u32 v98, s38, v99
    v_lshrrev_b64 v[52:53], 16, v[52:53]
    v_add_u32_dpp v91, v91, v91 row_shr:4 row_mask:0xf bank_mask:0xf bound_ctrl:1
    v_lshrrev_b64 v[60:61], 16, v[60:61]
    s_mov_b32 s101, 0
    v_add_u32_dpp v91, v91, v91 row_shr:8 row_mask:0xf bank_mask:0xf bound_ctrl:1
    s_nop 1
    v_add_u32_dpp v91, v91, v91 row_bcast:15 row_mask:0xa bank_mask:0xf
    s_nop 1
    v_add_u32_dpp v91, v91, v91 row_bcast:31 row_mask:0xc bank_mask:0xf
    v_add_u32 v98, v98, v91
    v_readlane_b32 s37, v91, 63
    s_cbranch_vccnz L2_xo9
L2_xp9:
    v_and_b32 v47, 0x3f0, v3
    s_cmp_lg_u32 s56, 0
    s_cbranch_scc1 L2_m10
    s_mul_i32 s3, s33, 1280000
    s_add_u32 s3, s3, s100
    s_add_u32 s3, s3, 352768
    buffer_load_dwordx4 v[124:127], v47, s[24:27], s3 offen offset:2048
L2_m10:
    v_and_b32 v47, 0x3f0, v3
    s_cmp_lg_u32 s56, 0
    s_cbranch_scc1 L2_m11
    s_mul_i32 s3, s33, 1280000
    s_add_u32 s3, s3, s100
    s_add_u32 s3, s3, 352768
    buffer_load_dwordx4 v[116:119], v47, s[24:27], s3 offen offset:0
L2_m11:
    s_waitcnt lgkmcnt(0)
    v_cmp_ne_u64 s[50:51], v[72:73], v[68:69]
    v_cmpx_ne_u64 s[54:55], v[74:75], v[70:71]
    s_and_b64 s[82:83], s[54:55], s[80:81]
    s_cbranch_scc1 L2_c12
L2_d12:
    v_mov_b64 v[84:85], v[70:71]
    v_mov_b32 v7, v93
    v_mov_b64 v[86:87], v[74:75]
    s_or_b64 s[80:81], s[80:81], s[54:55]
    s_mov_b64 exec, s[50:51]
    s_and_b64 s[82:83], s[50:51], s[80:81]
    s_cbranch_scc1 L2_c13
L2_d13:
    v_mov_b64 v[84:85], v[68:69]
    v_mov_b32 v7, v92
    v_mov_b64 v[86:87], v[72:73]
    s_mov_b64 exec, -1
    s_or_b64 s[80:81], s[80:81], s[50:51]
    ds_read_b64 v[70:71], v95 offset:65408
    ds_read_b64 v[68:69], v94 offset:65408
    s_waitcnt vmcnt(2)
    v_and_b32 v46, 0x20000000, v27
    v_lshrrev_b32 v47, 14, v23
    v_bitop3_b32 v47, v47, v5, v46 bitop3:0xea
    ds_read_b64 v[102:103], v47
    v_bitop3_b32 v93, v23, v5, v46 bitop3:0xea
    v_and_b32 v46, 0x10000000, v27
    v_lshrrev_b32 v47, 14, v22
    v_bitop3_b32 v47, v47, v5, v46 bitop3:0xea
    ds_read_b64 v[100:101], v47
    v_bitop3_b32 v92, v22, v5, v46 bitop3:0xea
    s_waitcnt lgkmcnt(2)
    v_mfma_f32_4x4x4_16b_bf16 v[80:83], v[10:11], v[70:71], v[80:83]
    v_mfma_f32_4x4x4_16b_bf16 v[76:79], v[10:11], v[68:69], v[76:79]
    v_perm_b32 v15, v23, v26, s45
    v_bitop3_b32 v46, v23, 0.5, -0.5 bitop3:0xa8
    v_perm_b32 v14, v22, v26, s44
    v_bitop3_b32 v47, v22, 0.5, -0.5 bitop3:0xa8
    v_cvt_pk_bf16_f32 v80, v80, v81
    v_cvt_pk_bf16_f32 v81, v82, v83
    ds_wrxchg_rtn_b64 v[74:75], v95, v[80:81] offset:65408
    v_cvt_pk_bf16_f32 v76, v76, v77
    v_cvt_pk_bf16_f32 v77, v78, v79
    ds_wrxchg_rtn_b64 v[72:73], v94, v[76:77] offset:65408
    s_waitcnt lgkmcnt(2)
    v_mfma_f32_4x4x4_16b_bf16 v[80:83], v[8:9], v[102:103], 0
    v_mfma_f32_4x4x4_16b_bf16 v[76:79], v[8:9], v[100:101], 0
    v_bitop3_b32 v15, v6, v15, v46 bitop3:0xca
    v_bitop3_b32 v14, v6, v14, v47 bitop3:0xca
    v_cmp_lt_u32 s[84:85], v5, v92
    s_nop 0
    v_pk_mul_f32 v[80:81], v[80:81], v[14:15] op_sel:[0,1] op_sel_hi:[1,1]
    v_pk_mul_f32 v[82:83], v[82:83], v[14:15] op_sel:[0,1] op_sel_hi:[1,1]
    v_pk_mul_f32 v[76:77], v[76:77], v[14:15] op_sel:[0,0] op_sel_hi:[1,0]
    v_pk_mul_f32 v[78:79], v[78:79], v[14:15] op_sel:[0,0] op_sel_hi:[1,0]
    v_and_b32 v47, 0x0fffffff, v39
    buffer_load_dwordx2 v[34:35], v47, s[8:11], 0 offen
    buffer_load_dwordx3 v[36:38], v47, s[8:11], 0 offen offset:8
    v_and_b32 v47, 0x3f0, v3
    s_cmp_lg_u32 s56, 0
    s_cbranch_scc1 L2_m14
    s_mul_i32 s3, s33, 1280000
    s_add_u32 s3, s3, s100
    s_add_u32 s3, s3, 352768
    buffer_load_dwordx4 v[120:123], v47, s[24:27], s3 offen offset:1024
L2_m14:
    s_waitcnt lgkmcnt(0)
    v_cmp_ne_u64 s[50:51], v[72:73], v[68:69]
    v_cmpx_ne_u64 s[54:55], v[74:75], v[70:71]
    s_and_b64 s[82:83], s[54:55], s[80:81]
    s_cbranch_scc1 L2_c15
L2_d15:
    v_mov_b64 v[84:85], v[70:71]
    v_mov_b32 v7, v95
    v_mov_b64 v[86:87], v[74:75]
    s_or_b64 s[80:81], s[80:81], s[54:55]
    s_mov_b64 exec, s[50:51]
    s_and_b64 s[82:83], s[50:51], s[80:81]
    s_cbranch_scc1 L2_c16
L2_d16:
    v_mov_b64 v[84:85], v[68:69]
    v_mov_b32 v7, v94
    v_mov_b64 v[86:87], v[72:73]
    s_mov_b64 exec, -1
    s_or_b64 s[80:81], s[80:81], s[50:51]
    ds_read_b64 v[70:71], v93 offset:65408
    s_and_b64 exec, s[84:85], s[80:81]
    v_mfma_f32_4x4x4_16b_bf16 v[76:79], v[12:13], v[84:85], 0
    v_mov_b32 v92, v7
    s_andn2_b64 s[80:81], s[80:81], s[84:85]
    v_mfma_f32_4x4x4_16b_bf16 v[76:79], v[10:11], v[86:87], v[76:79]
    s_mov_b64 exec, -1
    ds_read_b64 v[68:69], v92 offset:65408
    v_and_b32 v46, 0x80000000, v27
    v_lshrrev_b32 v47, 14, v25
    v_bitop3_b32 v47, v47, v5, v46 bitop3:0xea
    ds_read_b64 v[106:107], v47
    v_bitop3_b32 v95, v25, v5, v46 bitop3:0xea
    v_and_b32 v46, 0x40000000, v27
    v_lshrrev_b32 v47, 14, v24
    v_bitop3_b32 v47, v47, v5, v46 bitop3:0xea
    ds_read_b64 v[104:105], v47
    v_bitop3_b32 v94, v24, v5, v46 bitop3:0xea
    s_waitcnt lgkmcnt(2)
    v_mfma_f32_4x4x4_16b_bf16 v[80:83], v[10:11], v[70:71], v[80:83]
    v_mfma_f32_4x4x4_16b_bf16 v[76:79], v[10:11], v[68:69], v[76:79]
    v_perm_b32 v15, v25, v26, s47
    v_bitop3_b32 v46, v25, 0.5, -0.5 bitop3:0xa8
    v_perm_b32 v14, v24, v26, s46
    v_bitop3_b32 v47, v24, 0.5, -0.5 bitop3:0xa8
    v_cvt_pk_bf16_f32 v80, v80, v81
    v_cvt_pk_bf16_f32 v81, v82, v83
    ds_wrxchg_rtn_b64 v[74:75], v93, v[80:81] offset:65408
    v_cvt_pk_bf16_f32 v76, v76, v77
    v_cvt_pk_bf16_f32 v77, v78, v79
    ds_wrxchg_rtn_b64 v[72:73], v92, v[76:77] offset:65408
    s_setprio 1
    s_waitcnt lgkmcnt(2)
    v_mfma_f32_4x4x4_16b_bf16 v[80:83], v[8:9], v[106:107], 0
    v_mfma_f32_4x4x4_16b_bf16 v[76:79], v[8:9], v[104:105], 0
    v_bitop3_b32 v15, v6, v15, v46 bitop3:0xca
    v_bitop3_b32 v14, v6, v14, v47 bitop3:0xca
    s_nop 1
    v_pk_mul_f32 v[80:81], v[80:81], v[14:15] op_sel:[0,1] op_sel_hi:[1,1]
    v_pk_mul_f32 v[82:83], v[82:83], v[14:15] op_sel:[0,1] op_sel_hi:[1,1]
    v_pk_mul_f32 v[76:77], v[76:77], v[14:15] op_sel:[0,0] op_sel_hi:[1,0]
    v_pk_mul_f32 v[78:79], v[78:79], v[14:15] op_sel:[0,0] op_sel_hi:[1,0]
    v_and_b32 v47, 0x3f0, v3
    s_cmp_lg_u32 s56, 0
    s_cbranch_scc1 L2_m17
    s_mul_i32 s3, s33, 1280000
    s_add_u32 s3, s3, s38
    s_add_u32 s3, s3, 320000
    buffer_load_dwordx4 v[108:111], v47, s[24:27], s3 offen offset:0
L2_m17:
    v_and_b32 v47, 0x3f0, v3
    s_cmp_lg_u32 s56, 0
    s_cbranch_scc1 L2_m18
    s_mul_i32 s3, s33, 1280000
    s_add_u32 s3, s3, s38
    s_add_u32 s3, s3, 320000
    buffer_load_dwordx4 v[112:115], v47, s[24:27], s3 offen offset:1024
L2_m18:
    v_and_b32 v47, 0x0fffffff, v40
    v_mov_b32 v21, v40
    buffer_load_dwordx2 v[16:17], v47, s[8:11], 0 offen
    buffer_load_dwordx3 v[18:20], v47, s[8:11], 0 offen offset:8
    s_waitcnt lgkmcnt(0)
    v_cmp_ne_u64 s[50:51], v[72:73], v[68:69]
    v_cmpx_ne_u64 s[54:55], v[74:75], v[70:71]
    s_and_b64 s[82:83], s[54:55], s[80:81]
    s_cbranch_scc1 L2_c19
L2_d19:
    v_mov_b64 v[84:85], v[70:71]
    v_mov_b32 v7, v93
    v_mov_b64 v[86:87], v[74:75]
    s_or_b64 s[80:81], s[80:81], s[54:55]
    s_mov_b64 exec, s[50:51]
    s_and_b64 s[82:83], s[50:51], s[80:81]
    s_cbranch_scc1 L2_c20
L2_d20:
    v_mov_b64 v[84:85], v[68:69]
    v_mov_b32 v7, v92
    v_mov_b64 v[86:87], v[72:73]
    s_mov_b64 exec, -1
    s_or_b64 s[80:81], s[80:81], s[50:51]
    ds_read_b64 v[70:71], v95 offset:65408
    ds_read_b64 v[68:69], v94 offset:65408
    s_waitcnt vmcnt(4)
    v_and_b32 v46, 0x20000000, v33
    v_lshrrev_b32 v47, 14, v29
    v_bitop3_b32 v47, v47, v5, v46 bitop3:0xea
    ds_read_b64 v[102:103], v47
    v_bitop3_b32 v93, v29, v5, v46 bitop3:0xea
    v_and_b32 v46, 0x10000000, v33
    v_lshrrev_b32 v47, 14, v28
    v_bitop3_b32 v47, v47, v5, v46 bitop3:0xea
    ds_read_b64 v[100:101], v47
    v_bitop3_b32 v92, v28, v5, v46 bitop3:0xea
    s_waitcnt lgkmcnt(2)
    v_mfma_f32_4x4x4_16b_bf16 v[80:83], v[10:11], v[70:71], v[80:83]
    v_mfma_f32_4x4x4_16b_bf16 v[76:79], v[10:11], v[68:69], v[76:79]
    v_perm_b32 v15, v29, v32, s45
    v_bitop3_b32 v46, v29, 0.5, -0.5 bitop3:0xa8
    v_perm_b32 v14, v28, v32, s44
    v_bitop3_b32 v47, v28, 0.5, -0.5 bitop3:0xa8
    v_cvt_pk_bf16_f32 v80, v80, v81
    v_cvt_pk_bf16_f32 v81, v82, v83
    ds_wrxchg_rtn_b64 v[74:75], v95, v[80:81] offset:65408
    v_cvt_pk_bf16_f32 v76, v76, v77
    v_cvt_pk_bf16_f32 v77, v78, v79
    ds_wrxchg_rtn_b64 v[72:73], v94, v[76:77] offset:65408
    s_waitcnt lgkmcnt(2)
    v_mfma_f32_4x4x4_16b_bf16 v[80:83], v[8:9], v[102:103], 0
    v_mfma_f32_4x4x4_16b_bf16 v[76:79], v[8:9], v[100:101], 0
    v_bitop3_b32 v15, v6, v15, v46 bitop3:0xca
    v_bitop3_b32 v14, v6, v14, v47 bitop3:0xca
    v_cmp_lt_u32 s[84:85], v5, v92
    s_nop 0
    v_pk_mul_f32 v[80:81], v[80:81], v[14:15] op_sel:[0,1] op_sel_hi:[1,1]
    v_pk_mul_f32 v[82:83], v[82:83], v[14:15] op_sel:[0,1] op_sel_hi:[1,1]
    v_pk_mul_f32 v[76:77], v[76:77], v[14:15] op_sel:[0,0] op_sel_hi:[1,0]
    v_pk_mul_f32 v[78:79], v[78:79], v[14:15] op_sel:[0,0] op_sel_hi:[1,0]
    s_waitcnt lgkmcnt(0)
    v_cmp_ne_u64 s[50:51], v[72:73], v[68:69]
    v_cmpx_ne_u64 s[54:55], v[74:75], v[70:71]
    s_and_b64 s[82:83], s[54:55], s[80:81]
    s_cbranch_scc1 L2_c21
L2_d21:
    v_mov_b64 v[84:85], v[70:71]
    v_mov_b32 v7, v95
    v_mov_b64 v[86:87], v[74:75]
    s_or_b64 s[80:81], s[80:81], s[54:55]
    s_mov_b64 exec, s[50:51]
    s_and_b64 s[82:83], s[50:51], s[80:81]
    s_cbranch_scc1 L2_c22
L2_d22:
    v_mov_b64 v[84:85], v[68:69]
    v_mov_b32 v7, v94
    v_mov_b64 v[86:87], v[72:73]
    s_mov_b64 exec, -1
    s_or_b64 s[80:81], s[80:81], s[50:51]
    ds_read_b64 v[70:71], v93 offset:65408
    s_and_b64 exec, s[84:85], s[80:81]
    v_mfma_f32_4x4x4_16b_bf16 v[76:79], v[12:13], v[84:85], 0
    v_mov_b32 v92, v7
    s_andn2_b64 s[80:81], s[80:81], s[84:85]
    v_mfma_f32_4x4x4_16b_bf16 v[76:79], v[10:11], v[86:87], v[76:79]
    s_mov_b64 exec, -1
    ds_read_b64 v[68:69], v92 offset:65408
    v_and_b32 v46, 0x80000000, v33
    v_lshrrev_b32 v47, 14, v31
    v_bitop3_b32 v47, v47, v5, v46 bitop3:0xea
    ds_read_b64 v[106:107], v47
    v_bitop3_b32 v95, v31, v5, v46 bitop3:0xea
    v_and_b32 v46, 0x40000000, v33
    v_lshrrev_b32 v47, 14, v30
    v_bitop3_b32 v47, v47, v5, v46 bitop3:0xea
    ds_read_b64 v[104:105], v47
    v_bitop3_b32 v94, v30, v5, v46 bitop3:0xea
    s_waitcnt lgkmcnt(2)
    v_mfma_f32_4x4x4_16b_bf16 v[80:83], v[10:11], v[70:71], v[80:83]
    v_mfma_f32_4x4x4_16b_bf16 v[76:79], v[10:11], v[68:69], v[76:79]
    v_perm_b32 v15, v31, v32, s47
    v_bitop3_b32 v46, v31, 0.5, -0.5 bitop3:0xa8
    v_perm_b32 v14, v30, v32, s46
    v_bitop3_b32 v47, v30, 0.5, -0.5 bitop3:0xa8
    v_cvt_pk_bf16_f32 v80, v80, v81
    v_cvt_pk_bf16_f32 v81, v82, v83
    ds_wrxchg_rtn_b64 v[74:75], v93, v[80:81] offset:65408
    v_cvt_pk_bf16_f32 v76, v76, v77
    v_cvt_pk_bf16_f32 v77, v78, v79
    ds_wrxchg_rtn_b64 v[72:73], v92, v[76:77] offset:65408
    s_setprio 0
    s_waitcnt lgkmcnt(2)
    v_mfma_f32_4x4x4_16b_bf16 v[80:83], v[8:9], v[106:107], 0
    v_mfma_f32_4x4x4_16b_bf16 v[76:79], v[8:9], v[104:105], 0
    v_bitop3_b32 v15, v6, v15, v46 bitop3:0xca
    v_bitop3_b32 v14, v6, v14, v47 bitop3:0xca
    s_nop 1
    v_pk_mul_f32 v[80:81], v[80:81], v[14:15] op_sel:[0,1] op_sel_hi:[1,1]
    v_pk_mul_f32 v[82:83], v[82:83], v[14:15] op_sel:[0,1] op_sel_hi:[1,1]
    v_pk_mul_f32 v[76:77], v[76:77], v[14:15] op_sel:[0,0] op_sel_hi:[1,0]
    v_pk_mul_f32 v[78:79], v[78:79], v[14:15] op_sel:[0,0] op_sel_hi:[1,0]
    s_add_u32 s40, s40, 0x50000
    v_and_b32 v47, 0x0fffffff, v41
    v_mov_b32 v27, v41
    buffer_load_dwordx2 v[22:23], v47, s[8:11], 0 offen
    buffer_load_dwordx3 v[24:26], v47, s[8:11], 0 offen offset:8
    s_waitcnt lgkmcnt(0)
    v_cmp_ne_u64 s[50:51], v[72:73], v[68:69]
    v_cmpx_ne_u64 s[54:55], v[74:75], v[70:71]
    s_and_b64 s[82:83], s[54:55], s[80:81]
    s_cbranch_scc1 L2_c23
L2_d23:
    v_mov_b64 v[84:85], v[70:71]
    v_mov_b32 v7, v93
    v_mov_b64 v[86:87], v[74:75]
    s_or_b64 s[80:81], s[80:81], s[54:55]
    s_mov_b64 exec, s[50:51]
    s_and_b64 s[82:83], s[50:51], s[80:81]
    s_cbranch_scc1 L2_c24
L2_d24:
    v_mov_b64 v[84:85], v[68:69]
    v_mov_b32 v7, v92
    v_mov_b64 v[86:87], v[72:73]
    s_mov_b64 exec, -1
    s_or_b64 s[80:81], s[80:81], s[50:51]
    ds_read_b64 v[70:71], v95 offset:65408
    ds_read_b64 v[68:69], v94 offset:65408
    s_waitcnt vmcnt(4)
    v_and_b32 v46, 0x20000000, v39
    v_lshrrev_b32 v47, 14, v35
    v_bitop3_b32 v47, v47, v5, v46 bitop3:0xea
    ds_read_b64 v[102:103], v47
    v_bitop3_b32 v93, v35, v5, v46 bitop3:0xea
    v_and_b32 v46, 0x10000000, v39
    v_lshrrev_b32 v47, 14, v34
    v_bitop3_b32 v47, v47, v5, v46 bitop3:0xea
    ds_read_b64 v[100:101], v47
    v_bitop3_b32 v92, v34, v5, v46 bitop3:0xea
    v_and_b32 v46, 0x80000000, v39
    v_lshrrev_b32 v47, 14, v37
    v_bitop3_b32 v47, v47, v5, v46 bitop3:0xea
    ds_read_b64 v[106:107], v47
    v_and_b32 v46, 0x40000000, v39
    v_lshrrev_b32 v47, 14, v36
    v_bitop3_b32 v47, v47, v5, v46 bitop3:0xea
    ds_read_b64 v[104:105], v47
    s_waitcnt lgkmcnt(4)
    v_mfma_f32_4x4x4_16b_bf16 v[80:83], v[10:11], v[70:71], v[80:83]
    v_mfma_f32_4x4x4_16b_bf16 v[76:79], v[10:11], v[68:69], v[76:79]
    v_perm_b32 v15, v35, v38, s45
    v_bitop3_b32 v46, v35, 0.5, -0.5 bitop3:0xa8
    v_perm_b32 v14, v34, v38, s44
    v_bitop3_b32 v47, v34, 0.5, -0.5 bitop3:0xa8
    v_cvt_pk_bf16_f32 v80, v80, v81
    v_cvt_pk_bf16_f32 v81, v82, v83
    ds_wrxchg_rtn_b64 v[74:75], v95, v[80:81] offset:65408
    v_cvt_pk_bf16_f32 v76, v76, v77
    v_cvt_pk_bf16_f32 v77, v78, v79
    ds_wrxchg_rtn_b64 v[72:73], v94, v[76:77] offset:65408
    s_waitcnt lgkmcnt(2)
    s_barrier
    s_setprio 3
    s_waitcnt vmcnt(6)
    v_subrev_u32 v88, s38, v3
    ds_write_b128 v88, v[116:119] offset:32768
    buffer_load_dwordx4 v[116:119], v3, s[16:19], s40 offen offset:2048
    s_waitcnt vmcnt(5)
    v_subrev_u32 v88, s38, v3
    ds_write_b128 v88, v[120:123] offset:33792
    buffer_load_dwordx4 v[120:123], v3, s[16:19], s40 offen offset:3072
    v_mfma_f32_4x4x4_16b_bf16 v[80:83], v[8:9], v[102:103], 0
    v_mfma_f32_4x4x4_16b_bf16 v[76:79], v[8:9], v[100:101], 0
    v_bitop3_b32 v15, v6, v15, v46 bitop3:0xca
    v_bitop3_b32 v14, v6, v14, v47 bitop3:0xca
    v_cmp_lt_u32 s[84:85], v5, v92
    s_nop 0
    v_pk_mul_f32 v[80:81], v[80:81], v[14:15] op_sel:[0,1] op_sel_hi:[1,1]
    v_pk_mul_f32 v[82:83], v[82:83], v[14:15] op_sel:[0,1] op_sel_hi:[1,1]
    v_pk_mul_f32 v[76:77], v[76:77], v[14:15] op_sel:[0,0] op_sel_hi:[1,0]
    v_pk_mul_f32 v[78:79], v[78:79], v[14:15] op_sel:[0,0] op_sel_hi:[1,0]
    v_and_b32 v47, 0x0fffffff, v42
    v_mov_b32 v33, v42
    buffer_load_dwordx2 v[28:29], v47, s[8:11], 0 offen
    buffer_load_dwordx3 v[30:32], v47, s[8:11], 0 offen offset:8
    v_mov_b32 v44, v43
    s_cmp_gt_u32 s37, 1024
    s_cbranch_scc1 L2_xs25
    s_cmp_lg_u32 s101, 0
    s_cbranch_scc1 L2_xa25
L2_xb25:
    v_lshlrev_b32 v89, 16, v96
    v_add_u32 v90, 60, v97
    v_bitop3_b32 v90, v89, v45, v90 bitop3:0x6a
    ds_write_b32 v98, v90 offset:12
    v_lshlrev_b32 v89, 20, v96
    v_add_u32 v90, 40, v97
    v_bitop3_b32 v90, v89, v45, v90 bitop3:0x6a
    ds_write_b32 v98, v90 offset:8
    v_lshlrev_b32 v89, 24, v96
    v_add_u32 v90, 20, v97
    v_bitop3_b32 v90, v89, v45, v90 bitop3:0x6a
    ds_write_b32 v98, v90 offset:4
    v_lshlrev_b32 v89, 28, v96
    v_bitop3_b32 v90, v89, v45, v97 bitop3:0x6a
    ds_write_b32 v98, v90 offset:0
    v_mov_b32_dpp v91, v64 quad_perm:[1,1,1,1] row_mask:0xf bank_mask:0xf
    v_and_b32 v89, 3, v91
    v_and_b32 v97, 0xfffc, v91
    v_sub_u16_dpp v88, v64, v91 quad_perm:[3,3,3,3] row_mask:0xf bank_mask:0xf
    v_mad_u32_u24 v97, v97, 5, v4
    v_add_u32 v99, v88, v89
    v_bfm_b32 v96, v88, v89
    v_cmp_lt_u32 s[58:59], 16, v99
    v_lshlrev_b32 v89, v1, v96
    v_and_b32 v89, v45, v89
    v_cmp_ne_u32 vcc, 0, v89
    v_xor_b32 v90, v97, v89
    s_add_u32 s3, s37, s38
    v_mbcnt_lo_u32_b32 v98, vcc_lo, 0
    v_mbcnt_hi_u32_b32 v98, vcc_hi, v98
    s_bcnt1_i32_b64 s41, vcc
    v_lshl_add_u32 v98, v98, 2, s3
    s_mov_b64 exec, vcc
    ds_write_b32 v98, v90
    s_mov_b64 exec, -1
    s_lshl2_add_u32 s37, s41, s37
    s_cmp_lg_u64 s[58:59], 0
    s_cbranch_scc1 L2_xe25
L2_xr25:
    v_add_u32 v98, s37, v0
    v_mov_b32 v90, -1
    ds_write_b32 v98, v90
    ds_read2st64_b32 v[40:41], v0 offset0:0 offset1:1
    ds_read2st64_b32 v[42:43], v0 offset0:2 offset1:3
    s_sub_u32 s3, s37, 768
    s_cmp_gt_u32 s3, 256
    s_cbranch_scc1 L2_xf25
L2_xg25:
    s_setprio 2
    s_waitcnt vmcnt(10)
    v_subrev_u32 v88, s38, v3
    ds_write_b128 v88, v[124:127] offset:34816
    s_add_u32 s3, s40, 4096
    buffer_load_dwordx4 v[124:127], v3, s[16:19], s3 offen
    s_waitcnt lgkmcnt(11)
    v_cmp_ne_u64 s[50:51], v[72:73], v[68:69]
    v_cmpx_ne_u64 s[54:55], v[74:75], v[70:71]
    s_and_b64 s[82:83], s[54:55], s[80:81]
    s_cbranch_scc1 L2_c26
L2_d26:
    v_mov_b64 v[84:85], v[70:71]
    v_mov_b32 v7, v95
    v_mov_b64 v[86:87], v[74:75]
    s_or_b64 s[80:81], s[80:81], s[54:55]
    s_mov_b64 exec, s[50:51]
    s_and_b64 s[82:83], s[50:51], s[80:81]
    s_cbranch_scc1 L2_c27
L2_d27:
    v_mov_b64 v[84:85], v[68:69]
    v_mov_b32 v7, v94
    v_mov_b64 v[86:87], v[72:73]
    s_mov_b64 exec, -1
    s_or_b64 s[80:81], s[80:81], s[50:51]
    ds_read_b64 v[70:71], v93 offset:65408
    s_and_b64 exec, s[84:85], s[80:81]
    v_mfma_f32_4x4x4_16b_bf16 v[76:79], v[12:13], v[84:85], 0
    v_mov_b32 v92, v7
    s_andn2_b64 s[80:81], s[80:81], s[84:85]
    v_mfma_f32_4x4x4_16b_bf16 v[76:79], v[10:11], v[86:87], v[76:79]
    s_mov_b64 exec, -1
    ds_read_b64 v[68:69], v92 offset:65408
    s_setprio 1
    s_waitcnt vmcnt(9)
    v_subrev_u32 v88, s100, v3
    ds_write_b128 v88, v[108:111] offset:0
    s_waitcnt lgkmcnt(1)
    v_mfma_f32_4x4x4_16b_bf16 v[80:83], v[10:11], v[70:71], v[80:83]
    v_mfma_f32_4x4x4_16b_bf16 v[76:79], v[10:11], v[68:69], v[76:79]
    v_and_b32 v46, 0x40000000, v39
    v_bitop3_b32 v94, v36, v5, v46 bitop3:0xea
    v_and_b32 v46, 0x80000000, v39
    v_bitop3_b32 v95, v37, v5, v46 bitop3:0xea
    v_perm_b32 v15, v37, v38, s47
    v_bitop3_b32 v46, v37, 0.5, -0.5 bitop3:0xa8
    v_perm_b32 v14, v36, v38, s46
    v_bitop3_b32 v47, v36, 0.5, -0.5 bitop3:0xa8
    v_cvt_pk_bf16_f32 v80, v80, v81
    v_cvt_pk_bf16_f32 v81, v82, v83
    ds_wrxchg_rtn_b64 v[74:75], v93, v[80:81] offset:65408
    v_cvt_pk_bf16_f32 v76, v76, v77
    v_cvt_pk_bf16_f32 v77, v78, v79
    ds_wrxchg_rtn_b64 v[72:73], v92, v[76:77] offset:65408
    s_setprio 0
    s_waitcnt vmcnt(9)
    v_subrev_u32 v88, s100, v3
    ds_write_b128 v88, v[112:115] offset:1024
    v_mfma_f32_4x4x4_16b_bf16 v[80:83], v[8:9], v[106:107], 0
    v_mfma_f32_4x4x4_16b_bf16 v[76:79], v[8:9], v[104:105], 0
    v_bitop3_b32 v15, v6, v15, v46 bitop3:0xca
    v_bitop3_b32 v14, v6, v14, v47 bitop3:0xca
    s_nop 1
    v_pk_mul_f32 v[80:81], v[80:81], v[14:15] op_sel:[0,1] op_sel_hi:[1,1]
    v_pk_mul_f32 v[82:83], v[82:83], v[14:15] op_sel:[0,1] op_sel_hi:[1,1]
    v_pk_mul_f32 v[76:77], v[76:77], v[14:15] op_sel:[0,0] op_sel_hi:[1,0]
    v_pk_mul_f32 v[78:79], v[78:79], v[14:15] op_sel:[0,0] op_sel_hi:[1,0]
    s_add_u32 s42, s42, 1
    s_waitcnt lgkmcnt(0)
    s_add_u32 s24, s30, 0xebc9000
    s_addc_u32 s25, s31, 0
    s_mov_b32 s26, 0x100
    s_mov_b32 s27, 0x20000
    s_barrier
    s_bitcmp1_b32 s36, s42
    s_cbranch_scc1 L2_slow
L2_ret1:
    s_setprio 3
    v_and_b32 v47, 0x0fffffff, v44
    v_mov_b32 v39, v44
    buffer_load_dwordx2 v[34:35], v47, s[8:11], 0 offen
    buffer_load_dwordx3 v[36:38], v47, s[8:11], 0 offen offset:8
    buffer_load_dwordx4 v[108:111], v3, s[16:19], s40 offen offset:0
    v_cmp_ne_u64 s[50:51], v[72:73], v[68:69]
    v_cmpx_ne_u64 s[54:55], v[74:75], v[70:71]
    s_and_b64 s[82:83], s[54:55], s[80:81]
    s_cbranch_scc1 L2_c28
L2_d28:
    v_mov_b64 v[84:85], v[70:71]
    v_mov_b32 v7, v93
    v_mov_b64 v[86:87], v[74:75]
    s_or_b64 s[80:81], s[80:81], s[54:55]
    s_mov_b64 exec, s[50:51]
    s_and_b64 s[82:83], s[50:51], s[80:81]
    s_cbranch_scc1 L2_c29
L2_d29:
    v_mov_b64 v[84:85], v[68:69]
    v_mov_b32 v7, v92
    v_mov_b64 v[86:87], v[72:73]
    s_mov_b64 exec, -1
    s_or_b64 s[80:81], s[80:81], s[50:51]
    ds_read_b64 v[70:71], v95 offset:65408
    ds_read_b64 v[68:69], v94 offset:65408
    s_waitcnt vmcnt(10)
    v_and_b32 v46, 0x20000000, v21
    v_lshrrev_b32 v47, 14, v17
    v_bitop3_b32 v47, v47, v5, v46 bitop3:0xea
    ds_read_b64 v[102:103], v47
    v_bitop3_b32 v93, v17, v5, v46 bitop3:0xea
    v_and_b32 v46, 0x10000000, v21
    v_lshrrev_b32 v47, 14, v16
    v_bitop3_b32 v47, v47, v5, v46 bitop3:0xea
    ds_read_b64 v[100:101], v47
    v_bitop3_b32 v92, v16, v5, v46 bitop3:0xea
    s_waitcnt lgkmcnt(2)
    v_mfma_f32_4x4x4_16b_bf16 v[80:83], v[10:11], v[70:71], v[80:83]
    v_mfma_f32_4x4x4_16b_bf16 v[76:79], v[10:11], v[68:69], v[76:79]
    v_perm_b32 v15, v17, v20, s45
    v_bitop3_b32 v46, v17, 0.5, -0.5 bitop3:0xa8
    v_perm_b32 v14, v16, v20, s44
    v_bitop3_b32 v47, v16, 0.5, -0.5 bitop3:0xa8
    v_cvt_pk_bf16_f32 v80, v80, v81
    v_cvt_pk_bf16_f32 v81, v82, v83
    ds_wrxchg_rtn_b64 v[74:75], v95, v[80:81] offset:65408
    v_cvt_pk_bf16_f32 v76, v76, v77
    v_cvt_pk_bf16_f32 v77, v78, v79
    ds_wrxchg_rtn_b64 v[72:73], v94, v[76:77] offset:65408
    s_waitcnt lgkmcnt(2)
    v_mfma_f32_4x4x4_16b_bf16 v[80:83], v[8:9], v[102:103], 0
    v_mfma_f32_4x4x4_16b_bf16 v[76:79], v[8:9], v[100:101], 0
    v_bitop3_b32 v15, v6, v15, v46 bitop3:0xca
    v_bitop3_b32 v14, v6, v14, v47 bitop3:0xca
    v_cmp_lt_u32 s[84:85], v5, v92
    s_nop 0
    v_pk_mul_f32 v[80:81], v[80:81], v[14:15] op_sel:[0,1] op_sel_hi:[1,1]
    v_pk_mul_f32 v[82:83], v[82:83], v[14:15] op_sel:[0,1] op_sel_hi:[1,1]
    v_pk_mul_f32 v[76:77], v[76:77], v[14:15] op_sel:[0,0] op_sel_hi:[1,0]
    v_pk_mul_f32 v[78:79], v[78:79], v[14:15] op_sel:[0,0] op_sel_hi:[1,0]
    buffer_load_dwordx4 v[112:115], v3, s[16:19], s40 offen offset:1024
    s_waitcnt lgkmcnt(0)
    v_cmp_ne_u64 s[50:51], v[72:73], v[68:69]
    v_cmpx_ne_u64 s[54:55], v[74:75], v[70:71]
    s_and_b64 s[82:83], s[54:55], s[80:81]
    s_cbranch_scc1 L2_c30
L2_d30:
    v_mov_b64 v[84:85], v[70:71]
    v_mov_b32 v7, v95
    v_mov_b64 v[86:87], v[74:75]
    s_or_b64 s[80:81], s[80:81], s[54:55]
    s_mov_b64 exec, s[50:51]
    s_and_b64 s[82:83], s[50:51], s[80:81]
    s_cbranch_scc1 L2_c31
L2_d31:
    v_mov_b64 v[84:85], v[68:69]
    v_mov_b32 v7, v94
    v_mov_b64 v[86:87], v[72:73]
    s_mov_b64 exec, -1
    s_or_b64 s[80:81], s[80:81], s[50:51]
    ds_read_b64 v[70:71], v93 offset:65408
    s_and_b64 exec, s[84:85], s[80:81]
    v_mfma_f32_4x4x4_16b_bf16 v[76:79], v[12:13], v[84:85], 0
    v_mov_b32 v92, v7
    s_andn2_b64 s[80:81], s[80:81], s[84:85]
    v_mfma_f32_4x4x4_16b_bf16 v[76:79], v[10:11], v[86:87], v[76:79]
    s_mov_b64 exec, -1
    ds_read_b64 v[68:69], v92 offset:65408
    v_and_b32 v46, 0x80000000, v21
    v_lshrrev_b32 v47, 14, v19
    v_bitop3_b32 v47, v47, v5, v46 bitop3:0xea
    ds_read_b64 v[106:107], v47
    v_bitop3_b32 v95, v19, v5, v46 bitop3:0xea
    v_and_b32 v46, 0x40000000, v21
    v_lshrrev_b32 v47, 14, v18
    v_bitop3_b32 v47, v47, v5, v46 bitop3:0xea
    ds_read_b64 v[104:105], v47
    v_bitop3_b32 v94, v18, v5, v46 bitop3:0xea
    s_waitcnt lgkmcnt(2)
    v_mfma_f32_4x4x4_16b_bf16 v[80:83], v[10:11], v[70:71], v[80:83]
    v_mfma_f32_4x4x4_16b_bf16 v[76:79], v[10:11], v[68:69], v[76:79]
    v_perm_b32 v15, v19, v20, s47
    v_bitop3_b32 v46, v19, 0.5, -0.5 bitop3:0xa8
    v_perm_b32 v14, v18, v20, s46
    v_bitop3_b32 v47, v18, 0.5, -0.5 bitop3:0xa8
    v_cvt_pk_bf16_f32 v80, v80, v81
    v_cvt_pk_bf16_f32 v81, v82, v83
    ds_wrxchg_rtn_b64 v[74:75], v93, v[80:81] offset:65408
    v_cvt_pk_bf16_f32 v76, v76, v77
    v_cvt_pk_bf16_f32 v77, v78, v79
    ds_wrxchg_rtn_b64 v[72:73], v92, v[76:77] offset:65408
    s_setprio 2
    s_waitcnt lgkmcnt(2)
    v_mfma_f32_4x4x4_16b_bf16 v[80:83], v[8:9], v[106:107], 0
    v_mfma_f32_4x4x4_16b_bf16 v[76:79], v[8:9], v[104:105], 0
    v_bitop3_b32 v15, v6, v15, v46 bitop3:0xca
    v_bitop3_b32 v14, v6, v14, v47 bitop3:0xca
    s_nop 1
    v_pk_mul_f32 v[80:81], v[80:81], v[14:15] op_sel:[0,1] op_sel_hi:[1,1]
    v_pk_mul_f32 v[82:83], v[82:83], v[14:15] op_sel:[0,1] op_sel_hi:[1,1]
    v_pk_mul_f32 v[76:77], v[76:77], v[14:15] op_sel:[0,0] op_sel_hi:[1,0]
    v_pk_mul_f32 v[78:79], v[78:79], v[14:15] op_sel:[0,0] op_sel_hi:[1,0]
    v_sub_u16 v88, v62, v54
    v_and_b32 v89, 3, v54
    v_add3_u32 v99, v88, v89, 3
    v_and_b32 v99, -4, v99
    v_max_u32 v99, 4, v99
    v_and_b32 v97, 0xfffc, v54
    v_bfm_b32 v96, v88, v89
    v_add_u32_dpp v91, v99, v99 row_shr:1 row_mask:0xf bank_mask:0xf bound_ctrl:1
    v_mad_u32_u24 v97, v97, 5, v2
    v_cmp_lt_u32 vcc, 16, v99
    v_add_u32_dpp v91, v91, v91 row_shr:2 row_mask:0xf bank_mask:0xf bound_ctrl:1
    v_sub_u32 v98, s38, v99
    v_lshrrev_b64 v[54:55], 16, v[54:55]
    v_add_u32_dpp v91, v91, v91 row_shr:4 row_mask:0xf bank_mask:0xf bound_ctrl:1
    v_lshrrev_b64 v[62:63], 16, v[62:63]
    s_mov_b32 s101, 0
    v_add_u32_dpp v91, v91, v91 row_shr:8 row_mask:0xf bank_mask:0xf bound_ctrl:1
    s_nop 1
    v_add_u32_dpp v91, v91, v91 row_bcast:15 row_mask:0xa bank_mask:0xf
    s_nop 1
    v_add_u32_dpp v91, v91, v91 row_bcast:31 row_mask:0xc bank_mask:0xf
    v_add_u32 v98, v98, v91
    v_readlane_b32 s37, v91, 63
    s_cbranch_vccnz L2_xo32
L2_xp32:
    v_and_b32 v47, 0x0fffffff, v40
    v_mov_b32 v21, v40
    buffer_load_dwordx2 v[16:17], v47, s[8:11], 0 offen
    buffer_load_dwordx3 v[18:20], v47, s[8:11], 0 offen offset:8
    s_waitcnt lgkmcnt(0)
    v_cmp_ne_u64 s[50:51], v[72:73], v[68:69]
    v_cmpx_ne_u64 s[54:55], v[74:75], v[70:71]
    s_and_b64 s[82:83], s[54:55], s[80:81]
    s_cbranch_scc1 L2_c33
L2_d33:
    v_mov_b64 v[84:85], v[70:71]
    v_mov_b32 v7, v93
    v_mov_b64 v[86:87], v[74:75]
    s_or_b64 s[80:81], s[80:81], s[54:55]
    s_mov_b64 exec, s[50:51]
    s_and_b64 s[82:83], s[50:51], s[80:81]
    s_cbranch_scc1 L2_c34
L2_d34:
    v_mov_b64 v[84:85], v[68:69]
    v_mov_b32 v7, v92
    v_mov_b64 v[86:87], v[72:73]
    s_mov_b64 exec, -1
    s_or_b64 s[80:81], s[80:81], s[50:51]
    ds_read_b64 v[70:71], v95 offset:65408
    ds_read_b64 v[68:69], v94 offset:65408
    s_waitcnt vmcnt(11)
    v_and_b32 v46, 0x20000000, v27
    v_lshrrev_b32 v47, 14, v23
    v_bitop3_b32 v47, v47, v5, v46 bitop3:0xea
    ds_read_b64 v[102:103], v47
    v_bitop3_b32 v93, v23, v5, v46 bitop3:0xea
    v_and_b32 v46, 0x10000000, v27
    v_lshrrev_b32 v47, 14, v22
    v_bitop3_b32 v47, v47, v5, v46 bitop3:0xea
    ds_read_b64 v[100:101], v47
    v_bitop3_b32 v92, v22, v5, v46 bitop3:0xea
    s_waitcnt lgkmcnt(2)
    v_mfma_f32_4x4x4_16b_bf16 v[80:83], v[10:11], v[70:71], v[80:83]
    v_mfma_f32_4x4x4_16b_bf16 v[76:79], v[10:11], v[68:69], v[76:79]
    v_perm_b32 v15, v23, v26, s45
    v_bitop3_b32 v46, v23, 0.5, -0.5 bitop3:0xa8
    v_perm_b32 v14, v22, v26, s44
    v_bitop3_b32 v47, v22, 0.5, -0.5 bitop3:0xa8
    v_cvt_pk_bf16_f32 v80, v80, v81
    v_cvt_pk_bf16_f32 v81, v82, v83
    ds_wrxchg_rtn_b64 v[74:75], v95, v[80:81] offset:65408
    v_cvt_pk_bf16_f32 v76, v76, v77
    v_cvt_pk_bf16_f32 v77, v78, v79
    ds_wrxchg_rtn_b64 v[72:73], v94, v[76:77] offset:65408
    s_waitcnt lgkmcnt(2)
    v_mfma_f32_4x4x4_16b_bf16 v[80:83], v[8:9], v[102:103], 0
    v_mfma_f32_4x4x4_16b_bf16 v[76:79], v[8:9], v[100:101], 0
    v_bitop3_b32 v15, v6, v15, v46 bitop3:0xca
    v_bitop3_b32 v14, v6, v14, v47 bitop3:0xca
    v_cmp_lt_u32 s[84:85], v5, v92
    s_nop 0
    v_pk_mul_f32 v[80:81], v[80:81], v[14:15] op_sel:[0,1] op_sel_hi:[1,1]
    v_pk_mul_f32 v[82:83], v[82:83], v[14:15] op_sel:[0,1] op_sel_hi:[1,1]
    v_pk_mul_f32 v[76:77], v[76:77], v[14:15] op_sel:[0,0] op_sel_hi:[1,0]
    v_pk_mul_f32 v[78:79], v[78:79], v[14:15] op_sel:[0,0] op_sel_hi:[1,0]
    s_waitcnt lgkmcnt(0)
    v_cmp_ne_u64 s[50:51], v[72:73], v[68:69]
    v_cmpx_ne_u64 s[54:55], v[74:75], v[70:71]
    s_and_b64 s[82:83], s[54:55], s[80:81]
    s_cbranch_scc1 L2_c35
L2_d35:
    v_mov_b64 v[84:85], v[70:71]
    v_mov_b32 v7, v95
    v_mov_b64 v[86:87], v[74:75]
    s_or_b64 s[80:81], s[80:81], s[54:55]
    s_mov_b64 exec, s[50:51]
    s_and_b64 s[82:83], s[50:51], s[80:81]
    s_cbranch_scc1 L2_c36
L2_d36:
    v_mov_b64 v[84:85], v[68:69]
    v_mov_b32 v7, v94
    v_mov_b64 v[86:87], v[72:73]
    s_mov_b64 exec, -1
    s_or_b64 s[80:81], s[80:81], s[50:51]
    ds_read_b64 v[70:71], v93 offset:65408
    s_and_b64 exec, s[84:85], s[80:81]
    v_mfma_f32_4x4x4_16b_bf16 v[76:79], v[12:13], v[84:85], 0
    v_mov_b32 v92, v7
    s_andn2_b64 s[80:81], s[80:81], s[84:85]
    v_mfma_f32_4x4x4_16b_bf16 v[76:79], v[10:11], v[86:87], v[76:79]
    s_mov_b64 exec, -1
    ds_read_b64 v[68:69], v92 offset:65408
    v_and_b32 v46, 0x80000000, v27
    v_lshrrev_b32 v47, 14, v25
    v_bitop3_b32 v47, v47, v5, v46 bitop3:0xea
    ds_read_b64 v[106:107], v47
    v_bitop3_b32 v95, v25, v5, v46 bitop3:0xea
    v_and_b32 v46, 0x40000000, v27
    v_lshrrev_b32 v47, 14, v24
    v_bitop3_b32 v47, v47, v5, v46 bitop3:0xea
    ds_read_b64 v[104:105], v47
    v_bitop3_b32 v94, v24, v5, v46 bitop3:0xea
    s_waitcnt lgkmcnt(2)
    v_mfma_f32_4x4x4_16b_bf16 v[80:83], v[10:11], v[70:71], v[80:83]
    v_mfma_f32_4x4x4_16b_bf16 v[76:79], v[10:11], v[68:69], v[76:79]
    v_perm_b32 v15, v25, v26, s47
    v_bitop3_b32 v46, v25, 0.5, -0.5 bitop3:0xa8
    v_perm_b32 v14, v24, v26, s46
    v_bitop3_b32 v47, v24, 0.5, -0.5 bitop3:0xa8
    v_cvt_pk_bf16_f32 v80, v80, v81
    v_cvt_pk_bf16_f32 v81, v82, v83
    ds_wrxchg_rtn_b64 v[74:75], v93, v[80:81] offset:65408
    v_cvt_pk_bf16_f32 v76, v76, v77
    v_cvt_pk_bf16_f32 v77, v78, v79
    ds_wrxchg_rtn_b64 v[72:73], v92, v[76:77] offset:65408
    s_setprio 1
    s_waitcnt lgkmcnt(2)
    v_mfma_f32_4x4x4_16b_bf16 v[80:83], v[8:9], v[106:107], 0
    v_mfma_f32_4x4x4_16b_bf16 v[76:79], v[8:9], v[104:105], 0
    v_bitop3_b32 v15, v6, v15, v46 bitop3:0xca
    v_bitop3_b32 v14, v6, v14, v47 bitop3:0xca
    s_nop 1
    v_pk_mul_f32 v[80:81], v[80:81], v[14:15] op_sel:[0,1] op_sel_hi:[1,1]
    v_pk_mul_f32 v[82:83], v[82:83], v[14:15] op_sel:[0,1] op_sel_hi:[1,1]
    v_pk_mul_f32 v[76:77], v[76:77], v[14:15] op_sel:[0,0] op_sel_hi:[1,0]
    v_pk_mul_f32 v[78:79], v[78:79], v[14:15] op_sel:[0,0] op_sel_hi:[1,0]
    v_and_b32 v47, 0x0fffffff, v41
    v_mov_b32 v27, v41
    buffer_load_dwordx2 v[22:23], v47, s[8:11], 0 offen
    buffer_load_dwordx3 v[24:26], v47, s[8:11], 0 offen offset:8
    s_waitcnt lgkmcnt(0)
    v_cmp_ne_u64 s[50:51], v[72:73], v[68:69]
    v_cmpx_ne_u64 s[54:55], v[74:75], v[70:71]
    s_and_b64 s[82:83], s[54:55], s[80:81]
    s_cbranch_scc1 L2_c37
L2_d37:
    v_mov_b64 v[84:85], v[70:71]
    v_mov_b32 v7, v93
    v_mov_b64 v[86:87], v[74:75]
    s_or_b64 s[80:81], s[80:81], s[54:55]
    s_mov_b64 exec, s[50:51]
    s_and_b64 s[82:83], s[50:51], s[80:81]
    s_cbranch_scc1 L2_c38
L2_d38:
    v_mov_b64 v[84:85], v[68:69]
    v_mov_b32 v7, v92
    v_mov_b64 v[86:87], v[72:73]
    s_mov_b64 exec, -1
    s_or_b64 s[80:81], s[80:81], s[50:51]
    ds_read_b64 v[70:71], v95 offset:65408
    ds_read_b64 v[68:69], v94 offset:65408
    s_waitcnt vmcnt(9)
    v_and_b32 v46, 0x20000000, v33
    v_lshrrev_b32 v47, 14, v29
    v_bitop3_b32 v47, v47, v5, v46 bitop3:0xea
    ds_read_b64 v[102:103], v47
    v_bitop3_b32 v93, v29, v5, v46 bitop3:0xea
    v_and_b32 v46, 0x10000000, v33
    v_lshrrev_b32 v47, 14, v28
    v_bitop3_b32 v47, v47, v5, v46 bitop3:0xea
    ds_read_b64 v[100:101], v47
    v_bitop3_b32 v92, v28, v5, v46 bitop3:0xea
    s_waitcnt lgkmcnt(2)
    v_mfma_f32_4x4x4_16b_bf16 v[80:83], v[10:11], v[70:71], v[80:83]
    v_mfma_f32_4x4x4_16b_bf16 v[76:79], v[10:11], v[68:69], v[76:79]
    v_perm_b32 v15, v29, v32, s45
    v_bitop3_b32 v46, v29, 0.5, -0.5 bitop3:0xa8
    v_perm_b32 v14, v28, v32, s44
    v_bitop3_b32 v47, v28, 0.5, -0.5 bitop3:0xa8
    v_cvt_pk_bf16_f32 v80, v80, v81
    v_cvt_pk_bf16_f32 v81, v82, v83
    ds_wrxchg_rtn_b64 v[74:75], v95, v[80:81] offset:65408
    v_cvt_pk_bf16_f32 v76, v76, v77
    v_cvt_pk_bf16_f32 v77, v78, v79
    ds_wrxchg_rtn_b64 v[72:73], v94, v[76:77] offset:65408
    s_waitcnt lgkmcnt(2)
    v_mfma_f32_4x4x4_16b_bf16 v[80:83], v[8:9], v[102:103], 0
    v_mfma_f32_4x4x4_16b_bf16 v[76:79], v[8:9], v[100:101], 0
    v_bitop3_b32 v15, v6, v15, v46 bitop3:0xca
    v_bitop3_b32 v14, v6, v14, v47 bitop3:0xca
    v_cmp_lt_u32 s[84:85], v5, v92
    s_nop 0
    v_pk_mul_f32 v[80:81], v[80:81], v[14:15] op_sel:[0,1] op_sel_hi:[1,1]
    v_pk_mul_f32 v[82:83], v[82:83], v[14:15] op_sel:[0,1] op_sel_hi:[1,1]
    v_pk_mul_f32 v[76:77], v[76:77], v[14:15] op_sel:[0,0] op_sel_hi:[1,0]
    v_pk_mul_f32 v[78:79], v[78:79], v[14:15] op_sel:[0,0] op_sel_hi:[1,0]
    s_waitcnt lgkmcnt(0)
    v_cmp_ne_u64 s[50:51], v[72:73], v[68:69]
    v_cmpx_ne_u64 s[54:55], v[74:75], v[70:71]
    s_and_b64 s[82:83], s[54:55], s[80:81]
    s_cbranch_scc1 L2_c39
L2_d39:
    v_mov_b64 v[84:85], v[70:71]
    v_mov_b32 v7, v95
    v_mov_b64 v[86:87], v[74:75]
    s_or_b64 s[80:81], s[80:81], s[54:55]
    s_mov_b64 exec, s[50:51]
    s_and_b64 s[82:83], s[50:51], s[80:81]
    s_cbranch_scc1 L2_c40
L2_d40:
    v_mov_b64 v[84:85], v[68:69]
    v_mov_b32 v7, v94
    v_mov_b64 v[86:87], v[72:73]
    s_mov_b64 exec, -1
    s_or_b64 s[80:81], s[80:81], s[50:51]
    ds_read_b64 v[70:71], v93 offset:65408
    s_and_b64 exec, s[84:85], s[80:81]
    v_mfma_f32_4x4x4_16b_bf16 v[76:79], v[12:13], v[84:85], 0
    v_mov_b32 v92, v7
    s_andn2_b64 s[80:81], s[80:81], s[84:85]
    v_mfma_f32_4x4x4_16b_bf16 v[76:79], v[10:11], v[86:87], v[76:79]
    s_mov_b64 exec, -1
    ds_read_b64 v[68:69], v92 offset:65408
    v_and_b32 v46, 0x80000000, v33
    v_lshrrev_b32 v47, 14, v31
    v_bitop3_b32 v47, v47, v5, v46 bitop3:0xea
    ds_read_b64 v[106:107], v47
    v_bitop3_b32 v95, v31, v5, v46 bitop3:0xea
    v_and_b32 v46, 0x40000000, v33
    v_lshrrev_b32 v47, 14, v30
    v_bitop3_b32 v47, v47, v5, v46 bitop3:0xea
    ds_read_b64 v[104:105], v47
    v_bitop3_b32 v94, v30, v5, v46 bitop3:0xea
    s_waitcnt lgkmcnt(2)
    v_mfma_f32_4x4x4_16b_bf16 v[80:83], v[10:11], v[70:71], v[80:83]
    v_mfma_f32_4x4x4_16b_bf16 v[76:79], v[10:11], v[68:69], v[76:79]
    v_perm_b32 v15, v31, v32, s47
    v_bitop3_b32 v46, v31, 0.5, -0.5 bitop3:0xa8
    v_perm_b32 v14, v30, v32, s46
    v_bitop3_b32 v47, v30, 0.5, -0.5 bitop3:0xa8
    v_cvt_pk_bf16_f32 v80, v80, v81
    v_cvt_pk_bf16_f32 v81, v82, v83
    ds_wrxchg_rtn_b64 v[74:75], v93, v[80:81] offset:65408
    v_cvt_pk_bf16_f32 v76, v76, v77
    v_cvt_pk_bf16_f32 v77, v78, v79
    ds_wrxchg_rtn_b64 v[72:73], v92, v[76:77] offset:65408
    s_setprio 0
    s_waitcnt lgkmcnt(2)
    v_mfma_f32_4x4x4_16b_bf16 v[80:83], v[8:9], v[106:107], 0
    v_mfma_f32_4x4x4_16b_bf16 v[76:79], v[8:9], v[104:105], 0
    v_bitop3_b32 v15, v6, v15, v46 bitop3:0xca
    v_bitop3_b32 v14, v6, v14, v47 bitop3:0xca
    s_nop 1
    v_pk_mul_f32 v[80:81], v[80:81], v[14:15] op_sel:[0,1] op_sel_hi:[1,1]
    v_pk_mul_f32 v[82:83], v[82:83], v[14:15] op_sel:[0,1] op_sel_hi:[1,1]
    v_pk_mul_f32 v[76:77], v[76:77], v[14:15] op_sel:[0,0] op_sel_hi:[1,0]
    v_pk_mul_f32 v[78:79], v[78:79], v[14:15] op_sel:[0,0] op_sel_hi:[1,0]
    s_add_u32 s40, s40, 0x50000
    v_and_b32 v47, 0x0fffffff, v42
    v_mov_b32 v33, v42
    buffer_load_dwordx2 v[28:29], v47, s[8:11], 0 offen
    buffer_load_dwordx3 v[30:32], v47, s[8:11], 0 offen offset:8
    s_waitcnt lgkmcnt(0)
    v_cmp_ne_u64 s[50:51], v[72:73], v[68:69]
    v_cmpx_ne_u64 s[54:55], v[74:75], v[70:71]
    s_and_b64 s[82:83], s[54:55], s[80:81]
    s_cbranch_scc1 L2_c41
L2_d41:
    v_mov_b64 v[84:85], v[70:71]
    v_mov_b32 v7, v93
    v_mov_b64 v[86:87], v[74:75]
    s_or_b64 s[80:81], s[80:81], s[54:55]
    s_mov_b64 exec, s[50:51]
    s_and_b64 s[82:83], s[50:51], s[80:81]
    s_cbranch_scc1 L2_c42
L2_d42:
    v_mov_b64 v[84:85], v[68:69]
    v_mov_b32 v7, v92
    v_mov_b64 v[86:87], v[72:73]
    s_mov_b64 exec, -1
    s_or_b64 s[80:81], s[80:81], s[50:51]
    ds_read_b64 v[70:71], v95 offset:65408
    ds_read_b64 v[68:69], v94 offset:65408
    s_waitcnt vmcnt(8)
    v_and_b32 v46, 0x20000000, v39
    v_lshrrev_b32 v47, 14, v35
    v_bitop3_b32 v47, v47, v5, v46 bitop3:0xea
    ds_read_b64 v[102:103], v47
    v_bitop3_b32 v93, v35, v5, v46 bitop3:0xea
    v_and_b32 v46, 0x10000000, v39
    v_lshrrev_b32 v47, 14, v34
    v_bitop3_b32 v47, v47, v5, v46 bitop3:0xea
    ds_read_b64 v[100:101], v47
    v_bitop3_b32 v92, v34, v5, v46 bitop3:0xea
    v_and_b32 v46, 0x80000000, v39
    v_lshrrev_b32 v47, 14, v37
    v_bitop3_b32 v47, v47, v5, v46 bitop3:0xea
    ds_read_b64 v[106:107], v47
    v_and_b32 v46, 0x40000000, v39
    v_lshrrev_b32 v47, 14, v36
    v_bitop3_b32 v47, v47, v5, v46 bitop3:0xea
    ds_read_b64 v[104:105], v47
    s_waitcnt lgkmcnt(4)
    v_mfma_f32_4x4x4_16b_bf16 v[80:83], v[10:11], v[70:71], v[80:83]
    v_mfma_f32_4x4x4_16b_bf16 v[76:79], v[10:11], v[68:69], v[76:79]
    v_perm_b32 v15, v35, v38, s45
    v_bitop3_b32 v46, v35, 0.5, -0.5 bitop3:0xa8
    v_perm_b32 v14, v34, v38, s44
    v_bitop3_b32 v47, v34, 0.5, -0.5 bitop3:0xa8
    v_cvt_pk_bf16_f32 v80, v80, v81
    v_cvt_pk_bf16_f32 v81, v82, v83
    ds_wrxchg_rtn_b64 v[74:75], v95, v[80:81] offset:65408
    v_cvt_pk_bf16_f32 v76, v76, v77
    v_cvt_pk_bf16_f32 v77, v78, v79
    ds_wrxchg_rtn_b64 v[72:73], v94, v[76:77] offset:65408
    s_waitcnt lgkmcnt(2)
    s_barrier
    s_setprio 3
    s_mov_b32 m0, s100
    s_nop 0
    ds_write_addtid_b32 v116 offset:32768
    ds_write_addtid_b32 v117 offset:33024
    ds_write_addtid_b32 v118 offset:33280
    ds_write_addtid_b32 v119 offset:33536
    buffer_load_dwordx4 v[116:119], v3, s[16:19], s40 offen offset:2048
    ds_write_addtid_b32 v120 offset:33792
    ds_write_addtid_b32 v121 offset:34048
    ds_write_addtid_b32 v122 offset:34304
    ds_write_addtid_b32 v123 offset:34560
    buffer_load_dwordx4 v[120:123], v3, s[16:19], s40 offen offset:3072
    v_mfma_f32_4x4x4_16b_bf16 v[80:83], v[8:9], v[102:103], 0
    v_mfma_f32_4x4x4_16b_bf16 v[76:79], v[8:9], v[100:101], 0
    v_bitop3_b32 v15, v6, v15, v46 bitop3:0xca
    v_bitop3_b32 v14, v6, v14, v47 bitop3:0xca
    v_cmp_lt_u32 s[84:85], v5, v92
    s_nop 0
    v_pk_mul_f32 v[80:81], v[80:81], v[14:15] op_sel:[0,1] op_sel_hi:[1,1]
    v_pk_mul_f32 v[82:83], v[82:83], v[14:15] op_sel:[0,1] op_sel_hi:[1,1]
    v_pk_mul_f32 v[76:77], v[76:77], v[14:15] op_sel:[0,0] op_sel_hi:[1,0]
    v_pk_mul_f32 v[78:79], v[78:79], v[14:15] op_sel:[0,0] op_sel_hi:[1,0]
    v_mov_b32 v44, v43
    s_cmp_gt_u32 s37, 1024
    s_cbranch_scc1 L2_xs43
    s_cmp_lg_u32 s101, 0
    s_cbranch_scc1 L2_xa43
L2_xb43:
    v_lshlrev_b32 v89, 16, v96
    v_add_u32 v90, 60, v97
    v_bitop3_b32 v90, v89, v45, v90 bitop3:0x6a
    ds_write_b32 v98, v90 offset:12
    v_lshlrev_b32 v89, 20, v96
    v_add_u32 v90, 40, v97
    v_bitop3_b32 v90, v89, v45, v90 bitop3:0x6a
    ds_write_b32 v98, v90 offset:8
    v_lshlrev_b32 v89, 24, v96
    v_add_u32 v90, 20, v97
    v_bitop3_b32 v90, v89, v45, v90 bitop3:0x6a
    ds_write_b32 v98, v90 offset:4
    v_lshlrev_b32 v89, 28, v96
    v_bitop3_b32 v90, v89, v45, v97 bitop3:0x6a
    ds_write_b32 v98, v90 offset:0
    v_mov_b32_dpp v91, v66 quad_perm:[1,1,1,1] row_mask:0xf bank_mask:0xf
    v_and_b32 v89, 3, v91
    v_and_b32 v97, 0xfffc, v91
    v_sub_u16_dpp v88, v66, v91 quad_perm:[3,3,3,3] row_mask:0xf bank_mask:0xf
    v_mad_u32_u24 v97, v97, 5, v4
    v_add_u32 v99, v88, v89
    v_bfm_b32 v96, v88, v89
    v_cmp_lt_u32 s[58:59], 16, v99
    v_lshlrev_b32 v89, v1, v96
    v_and_b32 v89, v45, v89
    v_cmp_ne_u32 vcc, 0, v89
    v_xor_b32 v90, v97, v89
    s_add_u32 s3, s37, s38
    v_mbcnt_lo_u32_b32 v98, vcc_lo, 0
    v_mbcnt_hi_u32_b32 v98, vcc_hi, v98
    s_bcnt1_i32_b64 s41, vcc
    v_lshl_add_u32 v98, v98, 2, s3
    s_mov_b64 exec, vcc
    ds_write_b32 v98, v90
    s_mov_b64 exec, -1
    s_lshl2_add_u32 s37, s41, s37
    s_cmp_lg_u64 s[58:59], 0
    s_cbranch_scc1 L2_xe43
L2_xr43:
    v_add_u32 v98, s37, v0
    v_mov_b32 v90, -1
    ds_write_b32 v98, v90
    ds_read2st64_b32 v[40:41], v0 offset0:0 offset1:1
    ds_read2st64_b32 v[42:43], v0 offset0:2 offset1:3
    s_sub_u32 s3, s37, 768
    s_cmp_gt_u32 s3, 256
    s_cbranch_scc1 L2_xf43
L2_xg43:
    v_lshrrev_b64 v[64:65], 16, v[64:65]
    v_lshrrev_b64 v[66:67], 16, v[66:67]
    s_setprio 2
    ds_write_addtid_b32 v124 offset:34816
    ds_write_addtid_b32 v125 offset:35072
    ds_write_addtid_b32 v126 offset:35328
    ds_write_addtid_b32 v127 offset:35584
    s_add_u32 s3, s40, 4096
    buffer_load_dwordx4 v[124:127], v3, s[16:19], s3 offen
    s_waitcnt lgkmcnt(14)
    v_cmp_ne_u64 s[50:51], v[72:73], v[68:69]
    v_cmpx_ne_u64 s[54:55], v[74:75], v[70:71]
    s_and_b64 s[82:83], s[54:55], s[80:81]
    s_cbranch_scc1 L2_c44
L2_d44:
    v_mov_b64 v[84:85], v[70:71]
    v_mov_b32 v7, v95
    v_mov_b64 v[86:87], v[74:75]
    s_or_b64 s[80:81], s[80:81], s[54:55]
    s_mov_b64 exec, s[50:51]
    s_and_b64 s[82:83], s[50:51], s[80:81]
    s_cbranch_scc1 L2_c45
L2_d45:
    v_mov_b64 v[84:85], v[68:69]
    v_mov_b32 v7, v94
    v_mov_b64 v[86:87], v[72:73]
    s_mov_b64 exec, -1
    s_or_b64 s[80:81], s[80:81], s[50:51]
    ds_read_b64 v[70:71], v93 offset:65408
    s_and_b64 exec, s[84:85], s[80:81]
    v_mfma_f32_4x4x4_16b_bf16 v[76:79], v[12:13], v[84:85], 0
    v_mov_b32 v92, v7
    s_andn2_b64 s[80:81], s[80:81], s[84:85]
    v_mfma_f32_4x4x4_16b_bf16 v[76:79], v[10:11], v[86:87], v[76:79]
    s_mov_b64 exec, -1
    ds_read_b64 v[68:69], v92 offset:65408
    s_setprio 1
    s_waitcnt vmcnt(10)
    s_mov_b32 m0, s38
    s_nop 0
    ds_write_addtid_b32 v108 offset:0
    ds_write_addtid_b32 v109 offset:256
    ds_write_addtid_b32 v110 offset:512
    ds_write_addtid_b32 v111 offset:768
    s_waitcnt lgkmcnt(4)
    v_mfma_f32_4x4x4_16b_bf16 v[80:83], v[10:11], v[70:71], v[80:83]
    v_mfma_f32_4x4x4_16b_bf16 v[76:79], v[10:11], v[68:69], v[76:79]
    v_and_b32 v46, 0x40000000, v39
    v_bitop3_b32 v94, v36, v5, v46 bitop3:0xea
    v_and_b32 v46, 0x80000000, v39
    v_bitop3_b32 v95, v37, v5, v46 bitop3:0xea
    v_perm_b32 v15, v37, v38, s47
    v_bitop3_b32 v46, v37, 0.5, -0.5 bitop3:0xa8
    v_perm_b32 v14, v36, v38, s46
    v_bitop3_b32 v47, v36, 0.5, -0.5 bitop3:0xa8
    v_cvt_pk_bf16_f32 v80, v80, v81
    v_cvt_pk_bf16_f32 v81, v82, v83
    ds_wrxchg_rtn_b64 v[74:75], v93, v[80:81] offset:65408
    v_cvt_pk_bf16_f32 v76, v76, v77
    v_cvt_pk_bf16_f32 v77, v78, v79
    ds_wrxchg_rtn_b64 v[72:73], v92, v[76:77] offset:65408
    v_and_b32 v88, 0x0fffffff, v44
    v_mov_b32 v39, v44
    buffer_load_dwordx2 v[34:35], v88, s[8:11], 0 offen
    buffer_load_dwordx3 v[36:38], v88, s[8:11], 0 offen offset:8
    s_setprio 0
    s_waitcnt vmcnt(11)
    ds_write_addtid_b32 v112 offset:1024
    ds_write_addtid_b32 v113 offset:1280
    ds_write_addtid_b32 v114 offset:1536
    ds_write_addtid_b32 v115 offset:1792
    v_mfma_f32_4x4x4_16b_bf16 v[80:83], v[8:9], v[106:107], 0
    v_mfma_f32_4x4x4_16b_bf16 v[76:79], v[8:9], v[104:105], 0
    v_bitop3_b32 v15, v6, v15, v46 bitop3:0xca
    v_bitop3_b32 v14, v6, v14, v47 bitop3:0xca
    s_nop 1
    v_pk_mul_f32 v[80:81], v[80:81], v[14:15] op_sel:[0,1] op_sel_hi:[1,1]
    v_pk_mul_f32 v[82:83], v[82:83], v[14:15] op_sel:[0,1] op_sel_hi:[1,1]
    v_pk_mul_f32 v[76:77], v[76:77], v[14:15] op_sel:[0,0] op_sel_hi:[1,0]
    v_pk_mul_f32 v[78:79], v[78:79], v[14:15] op_sel:[0,0] op_sel_hi:[1,0]
    s_add_u32 s42, s42, 1
    s_waitcnt lgkmcnt(0)
L2_loop:
    s_barrier
    s_bitcmp1_b32 s36, s42
    s_cbranch_scc1 L2_slow
L2_ret2:
    s_setprio 3
    buffer_load_dwordx4 v[108:111], v3, s[16:19], s40 offen offset:0
    v_cmp_ne_u64 s[50:51], v[72:73], v[68:69]
    v_cmpx_ne_u64 s[54:55], v[74:75], v[70:71]
    s_and_b64 s[82:83], s[54:55], s[80:81]
    s_cbranch_scc1 L2_c46
L2_d46:
    v_mov_b64 v[84:85], v[70:71]
    v_mov_b32 v7, v93
    v_mov_b64 v[86:87], v[74:75]
    s_or_b64 s[80:81], s[80:81], s[54:55]
    s_mov_b64 exec, s[50:51]
    s_and_b64 s[82:83], s[50:51], s[80:81]
    s_cbranch_scc1 L2_c47
L2_d47:
    v_mov_b64 v[84:85], v[68:69]
    v_mov_b32 v7, v92
    v_mov_b64 v[86:87], v[72:73]
    s_mov_b64 exec, -1
    s_or_b64 s[80:81], s[80:81], s[50:51]
    ds_read_b64 v[70:71], v95 offset:65408
    ds_read_b64 v[68:69], v94 offset:65408
    s_waitcnt vmcnt(10)
    v_and_b32 v46, 0x20000000, v21
    v_lshrrev_b32 v47, 14, v17
    v_bitop3_b32 v47, v47, v5, v46 bitop3:0xea
    ds_read_b64 v[102:103], v47
    v_bitop3_b32 v93, v17, v5, v46 bitop3:0xea
    v_and_b32 v46, 0x10000000, v21
    v_lshrrev_b32 v47, 14, v16
    v_bitop3_b32 v47, v47, v5, v46 bitop3:0xea
    ds_read_b64 v[100:101], v47
    v_bitop3_b32 v92, v16, v5, v46 bitop3:0xea
    s_waitcnt lgkmcnt(2)
    v_mfma_f32_4x4x4_16b_bf16 v[80:83], v[10:11], v[70:71], v[80:83]
    v_mfma_f32_4x4x4_16b_bf16 v[76:79], v[10:11], v[68:69], v[76:79]
    v_perm_b32 v15, v17, v20, s45
    v_bitop3_b32 v46, v17, 0.5, -0.5 bitop3:0xa8
    v_perm_b32 v14, v16, v20, s44
    v_bitop3_b32 v47, v16, 0.5, -0.5 bitop3:0xa8
    v_cvt_pk_bf16_f32 v80, v80, v81
    v_cvt_pk_bf16_f32 v81, v82, v83
    ds_wrxchg_rtn_b64 v[74:75], v95, v[80:81] offset:65408
    v_cvt_pk_bf16_f32 v76, v76, v77
    v_cvt_pk_bf16_f32 v77, v78, v79
    ds_wrxchg_rtn_b64 v[72:73], v94, v[76:77] offset:65408
    s_waitcnt lgkmcnt(2)
    v_mfma_f32_4x4x4_16b_bf16 v[80:83], v[8:9], v[102:103], 0
    v_mfma_f32_4x4x4_16b_bf16 v[76:79], v[8:9], v[100:101], 0
    v_bitop3_b32 v15, v6, v15, v46 bitop3:0xca
    v_bitop3_b32 v14, v6, v14, v47 bitop3:0xca
    v_cmp_lt_u32 s[84:85], v5, v92
    s_nop 0
    v_pk_mul_f32 v[80:81], v[80:81], v[14:15] op_sel:[0,1] op_sel_hi:[1,1]
    v_pk_mul_f32 v[82:83], v[82:83], v[14:15] op_sel:[0,1] op_sel_hi:[1,1]
    v_pk_mul_f32 v[76:77], v[76:77], v[14:15] op_sel:[0,0] op_sel_hi:[1,0]
    v_pk_mul_f32 v[78:79], v[78:79], v[14:15] op_sel:[0,0] op_sel_hi:[1,0]
    buffer_load_dwordx4 v[112:115], v3, s[16:19], s40 offen offset:1024
    s_waitcnt lgkmcnt(0)
    v_cmp_ne_u64 s[50:51], v[72:73], v[68:69]
    v_cmpx_ne_u64 s[54:55], v[74:75], v[70:71]
    s_and_b64 s[82:83], s[54:55], s[80:81]
    s_cbranch_scc1 L2_c48
L2_d48:
    v_mov_b64 v[84:85], v[70:71]
    v_mov_b32 v7, v95
    v_mov_b64 v[86:87], v[74:75]
    s_or_b64 s[80:81], s[80:81], s[54:55]
    s_mov_b64 exec, s[50:51]
    s_and_b64 s[82:83], s[50:51], s[80:81]
    s_cbranch_scc1 L2_c49
L2_d49:
    v_mov_b64 v[84:85], v[68:69]
    v_mov_b32 v7, v94
    v_mov_b64 v[86:87], v[72:73]
    s_mov_b64 exec, -1
    s_or_b64 s[80:81], s[80:81], s[50:51]
    ds_read_b64 v[70:71], v93 offset:65408
    s_and_b64 exec, s[84:85], s[80:81]
    v_mfma_f32_4x4x4_16b_bf16 v[76:79], v[12:13], v[84:85], 0
    v_mov_b32 v92, v7
    s_andn2_b64 s[80:81], s[80:81], s[84:85]
    v_mfma_f32_4x4x4_16b_bf16 v[76:79], v[10:11], v[86:87], v[76:79]
    s_mov_b64 exec, -1
    ds_read_b64 v[68:69], v92 offset:65408
    v_and_b32 v46, 0x80000000, v21
    v_lshrrev_b32 v47, 14, v19
    v_bitop3_b32 v47, v47, v5, v46 bitop3:0xea
    ds_read_b64 v[106:107], v47
    v_bitop3_b32 v95, v19, v5, v46 bitop3:0xea
    v_and_b32 v46, 0x40000000, v21
    v_lshrrev_b32 v47, 14, v18
    v_bitop3_b32 v47, v47, v5, v46 bitop3:0xea
    ds_read_b64 v[104:105], v47
    v_bitop3_b32 v94, v18, v5, v46 bitop3:0xea
    s_waitcnt lgkmcnt(2)
    v_mfma_f32_4x4x4_16b_bf16 v[80:83], v[10:11], v[70:71], v[80:83]
    v_mfma_f32_4x4x4_16b_bf16 v[76:79], v[10:11], v[68:69], v[76:79]
    v_perm_b32 v15, v19, v20, s47
    v_bitop3_b32 v46, v19, 0.5, -0.5 bitop3:0xa8
    v_perm_b32 v14, v18, v20, s46
    v_bitop3_b32 v47, v18, 0.5, -0.5 bitop3:0xa8
    v_cvt_pk_bf16_f32 v80, v80, v81
    v_cvt_pk_bf16_f32 v81, v82, v83
    ds_wrxchg_rtn_b64 v[74:75], v93, v[80:81] offset:65408
    v_cvt_pk_bf16_f32 v76, v76, v77
    v_cvt_pk_bf16_f32 v77, v78, v79
    ds_wrxchg_rtn_b64 v[72:73], v92, v[76:77] offset:65408
    v_and_b32 v88, 0x0fffffff, v40
    v_mov_b32 v21, v40
    buffer_load_dwordx2 v[16:17], v88, s[8:11], 0 offen
    buffer_load_dwordx3 v[18:20], v88, s[8:11], 0 offen offset:8
    s_setprio 2
    s_waitcnt lgkmcnt(2)
    v_mfma_f32_4x4x4_16b_bf16 v[80:83], v[8:9], v[106:107], 0
    v_mfma_f32_4x4x4_16b_bf16 v[76:79], v[8:9], v[104:105], 0
    v_bitop3_b32 v15, v6, v15, v46 bitop3:0xca
    v_bitop3_b32 v14, v6, v14, v47 bitop3:0xca
    s_nop 1
    v_pk_mul_f32 v[80:81], v[80:81], v[14:15] op_sel:[0,1] op_sel_hi:[1,1]
    v_pk_mul_f32 v[82:83], v[82:83], v[14:15] op_sel:[0,1] op_sel_hi:[1,1]
    v_pk_mul_f32 v[76:77], v[76:77], v[14:15] op_sel:[0,0] op_sel_hi:[1,0]
    v_pk_mul_f32 v[78:79], v[78:79], v[14:15] op_sel:[0,0] op_sel_hi:[1,0]
    v_sub_u16 v88, v56, v48
    v_and_b32 v89, 3, v48
    v_add3_u32 v99, v88, v89, 3
    v_and_b32 v99, -4, v99
    v_max_u32 v99, 4, v99
    v_and_b32 v97, 0xfffc, v48
    v_bfm_b32 v96, v88, v89
    v_add_u32_dpp v91, v99, v99 row_shr:1 row_mask:0xf bank_mask:0xf bound_ctrl:1
    v_mad_u32_u24 v97, v97, 5, v2
    v_cmp_lt_u32 vcc, 16, v99
    v_add_u32_dpp v91, v91, v91 row_shr:2 row_mask:0xf bank_mask:0xf bound_ctrl:1
    v_sub_u32 v98, s38, v99
    v_lshrrev_b64 v[48:49], 16, v[48:49]
    v_add_u32_dpp v91, v91, v91 row_shr:4 row_mask:0xf bank_mask:0xf bound_ctrl:1
    v_lshrrev_b64 v[56:57], 16, v[56:57]
    s_mov_b32 s101, 0
    v_add_u32_dpp v91, v91, v91 row_shr:8 row_mask:0xf bank_mask:0xf bound_ctrl:1
    s_nop 1
    v_add_u32_dpp v91, v91, v91 row_bcast:15 row_mask:0xa bank_mask:0xf
    s_nop 1
    v_add_u32_dpp v91, v91, v91 row_bcast:31 row_mask:0xc bank_mask:0xf
    v_add_u32 v98, v98, v91
    v_readlane_b32 s37, v91, 63
    s_cbranch_vccnz L2_xo50
L2_xp50:
    s_waitcnt lgkmcnt(0)
    v_cmp_ne_u64 s[50:51], v[72:73], v[68:69]
    v_cmpx_ne_u64 s[54:55], v[74:75], v[70:71]
    s_and_b64 s[82:83], s[54:55], s[80:81]
    s_cbranch_scc1 L2_c51
L2_d51:
    v_mov_b64 v[84:85], v[70:71]
    v_mov_b32 v7, v93
    v_mov_b64 v[86:87], v[74:75]
    s_or_b64 s[80:81], s[80:81], s[54:55]
    s_mov_b64 exec, s[50:51]
    s_and_b64 s[82:83], s[50:51], s[80:81]
    s_cbranch_scc1 L2_c52
L2_d52:
    v_mov_b64 v[84:85], v[68:69]
    v_mov_b32 v7, v92
    v_mov_b64 v[86:87], v[72:73]
    s_mov_b64 exec, -1
    s_or_b64 s[80:81], s[80:81], s[50:51]
    ds_read_b64 v[70:71], v95 offset:65408
    ds_read_b64 v[68:69], v94 offset:65408
    s_waitcnt vmcnt(11)
    v_and_b32 v46, 0x20000000, v27
    v_lshrrev_b32 v47, 14, v23
    v_bitop3_b32 v47, v47, v5, v46 bitop3:0xea
    ds_read_b64 v[102:103], v47
    v_bitop3_b32 v93, v23, v5, v46 bitop3:0xea
    v_and_b32 v46, 0x10000000, v27
    v_lshrrev_b32 v47, 14, v22
    v_bitop3_b32 v47, v47, v5, v46 bitop3:0xea
    ds_read_b64 v[100:101], v47
    v_bitop3_b32 v92, v22, v5, v46 bitop3:0xea
    s_waitcnt lgkmcnt(2)
    v_mfma_f32_4x4x4_16b_bf16 v[80:83], v[10:11], v[70:71], v[80:83]
    v_mfma_f32_4x4x4_16b_bf16 v[76:79], v[10:11], v[68:69], v[76:79]
    v_perm_b32 v15, v23, v26, s45
    v_bitop3_b32 v46, v23, 0.5, -0.5 bitop3:0xa8
    v_perm_b32 v14, v22, v26, s44
    v_bitop3_b32 v47, v22, 0.5, -0.5 bitop3:0xa8
    v_cvt_pk_bf16_f32 v80, v80, v81
    v_cvt_pk_bf16_f32 v81, v82, v83
    ds_wrxchg_rtn_b64 v[74:75], v95, v[80:81] offset:65408
    v_cvt_pk_bf16_f32 v76, v76, v77
    v_cvt_pk_bf16_f32 v77, v78, v79
    ds_wrxchg_rtn_b64 v[72:73], v94, v[76:77] offset:65408
    s_waitcnt lgkmcnt(2)
    v_mfma_f32_4x4x4_16b_bf16 v[80:83], v[8:9], v[102:103], 0
    v_mfma_f32_4x4x4_16b_bf16 v[76:79], v[8:9], v[100:101], 0
    v_bitop3_b32 v15, v6, v15, v46 bitop3:0xca
    v_bitop3_b32 v14, v6, v14, v47 bitop3:0xca
    v_cmp_lt_u32 s[84:85], v5, v92
    s_nop 0
    v_pk_mul_f32 v[80:81], v[80:81], v[14:15] op_sel:[0,1] op_sel_hi:[1,1]
    v_pk_mul_f32 v[82:83], v[82:83], v[14:15] op_sel:[0,1] op_sel_hi:[1,1]
    v_pk_mul_f32 v[76:77], v[76:77], v[14:15] op_sel:[0,0] op_sel_hi:[1,0]
    v_pk_mul_f32 v[78:79], v[78:79], v[14:15] op_sel:[0,0] op_sel_hi:[1,0]
    s_waitcnt lgkmcnt(0)
    v_cmp_ne_u64 s[50:51], v[72:73], v[68:69]
    v_cmpx_ne_u64 s[54:55], v[74:75], v[70:71]
    s_and_b64 s[82:83], s[54:55], s[80:81]
    s_cbranch_scc1 L2_c53
L2_d53:
    v_mov_b64 v[84:85], v[70:71]
    v_mov_b32 v7, v95
    v_mov_b64 v[86:87], v[74:75]
    s_or_b64 s[80:81], s[80:81], s[54:55]
    s_mov_b64 exec, s[50:51]
    s_and_b64 s[82:83], s[50:51], s[80:81]
    s_cbranch_scc1 L2_c54
L2_d54:
    v_mov_b64 v[84:85], v[68:69]
    v_mov_b32 v7, v94
    v_mov_b64 v[86:87], v[72:73]
    s_mov_b64 exec, -1
    s_or_b64 s[80:81], s[80:81], s[50:51]
    ds_read_b64 v[70:71], v93 offset:65408
    s_and_b64 exec, s[84:85], s[80:81]
    v_mfma_f32_4x4x4_16b_bf16 v[76:79], v[12:13], v[84:85], 0
    v_mov_b32 v92, v7
    s_andn2_b64 s[80:81], s[80:81], s[84:85]
    v_mfma_f32_4x4x4_16b_bf16 v[76:79], v[10:11], v[86:87], v[76:79]
    s_mov_b64 exec, -1
    ds_read_b64 v[68:69], v92 offset:65408
    v_and_b32 v46, 0x80000000, v27
    v_lshrrev_b32 v47, 14, v25
    v_bitop3_b32 v47, v47, v5, v46 bitop3:0xea
    ds_read_b64 v[106:107], v47
    v_bitop3_b32 v95, v25, v5, v46 bitop3:0xea
    v_and_b32 v46, 0x40000000, v27
    v_lshrrev_b32 v47, 14, v24
    v_bitop3_b32 v47, v47, v5, v46 bitop3:0xea
    ds_read_b64 v[104:105], v47
    v_bitop3_b32 v94, v24, v5, v46 bitop3:0xea
    s_waitcnt lgkmcnt(2)
    v_mfma_f32_4x4x4_16b_bf16 v[80:83], v[10:11], v[70:71], v[80:83]
    v_mfma_f32_4x4x4_16b_bf16 v[76:79], v[10:11], v[68:69], v[76:79]
    v_perm_b32 v15, v25, v26, s47
    v_bitop3_b32 v46, v25, 0.5, -0.5 bitop3:0xa8
    v_perm_b32 v14, v24, v26, s46
    v_bitop3_b32 v47, v24, 0.5, -0.5 bitop3:0xa8
    v_cvt_pk_bf16_f32 v80, v80, v81
    v_cvt_pk_bf16_f32 v81, v82, v83
    ds_wrxchg_rtn_b64 v[74:75], v93, v[80:81] offset:65408
    v_cvt_pk_bf16_f32 v76, v76, v77
    v_cvt_pk_bf16_f32 v77, v78, v79
    ds_wrxchg_rtn_b64 v[72:73], v92, v[76:77] offset:65408
    v_and_b32 v88, 0x0fffffff, v41
    v_mov_b32 v27, v41
    buffer_load_dwordx2 v[22:23], v88, s[8:11], 0 offen
    buffer_load_dwordx3 v[24:26], v88, s[8:11], 0 offen offset:8
    s_setprio 1
    s_waitcnt lgkmcnt(2)
    v_mfma_f32_4x4x4_16b_bf16 v[80:83], v[8:9], v[106:107], 0
    v_mfma_f32_4x4x4_16b_bf16 v[76:79], v[8:9], v[104:105], 0
    v_bitop3_b32 v15, v6, v15, v46 bitop3:0xca
    v_bitop3_b32 v14, v6, v14, v47 bitop3:0xca
    s_nop 1
    v_pk_mul_f32 v[80:81], v[80:81], v[14:15] op_sel:[0,1] op_sel_hi:[1,1]
    v_pk_mul_f32 v[82:83], v[82:83], v[14:15] op_sel:[0,1] op_sel_hi:[1,1]
    v_pk_mul_f32 v[76:77], v[76:77], v[14:15] op_sel:[0,0] op_sel_hi:[1,0]
    v_pk_mul_f32 v[78:79], v[78:79], v[14:15] op_sel:[0,0] op_sel_hi:[1,0]
    s_waitcnt lgkmcnt(0)
    v_cmp_ne_u64 s[50:51], v[72:73], v[68:69]
    v_cmpx_ne_u64 s[54:55], v[74:75], v[70:71]
    s_and_b64 s[82:83], s[54:55], s[80:81]
    s_cbranch_scc1 L2_c55
L2_d55:
    v_mov_b64 v[84:85], v[70:71]
    v_mov_b32 v7, v93
    v_mov_b64 v[86:87], v[74:75]
    s_or_b64 s[80:81], s[80:81], s[54:55]
    s_mov_b64 exec, s[50:51]
    s_and_b64 s[82:83], s[50:51], s[80:81]
    s_cbranch_scc1 L2_c56
L2_d56:
    v_mov_b64 v[84:85], v[68:69]
    v_mov_b32 v7, v92
    v_mov_b64 v[86:87], v[72:73]
    s_mov_b64 exec, -1
    s_or_b64 s[80:81], s[80:81], s[50:51]
    ds_read_b64 v[70:71], v95 offset:65408
    ds_read_b64 v[68:69], v94 offset:65408
    s_waitcnt vmcnt(11)
    v_and_b32 v46, 0x20000000, v33
    v_lshrrev_b32 v47, 14, v29
    v_bitop3_b32 v47, v47, v5, v46 bitop3:0xea
    ds_read_b64 v[102:103], v47
    v_bitop3_b32 v93, v29, v5, v46 bitop3:0xea
    v_and_b32 v46, 0x10000000, v33
    v_lshrrev_b32 v47, 14, v28
    v_bitop3_b32 v47, v47, v5, v46 bitop3:0xea
    ds_read_b64 v[100:101], v47
    v_bitop3_b32 v92, v28, v5, v46 bitop3:0xea
    s_waitcnt lgkmcnt(2)
    v_mfma_f32_4x4x4_16b_bf16 v[80:83], v[10:11], v[70:71], v[80:83]
    v_mfma_f32_4x4x4_16b_bf16 v[76:79], v[10:11], v[68:69], v[76:79]
    v_perm_b32 v15, v29, v32, s45
    v_bitop3_b32 v46, v29, 0.5, -0.5 bitop3:0xa8
    v_perm_b32 v14, v28, v32, s44
    v_bitop3_b32 v47, v28, 0.5, -0.5 bitop3:0xa8
    v_cvt_pk_bf16_f32 v80, v80, v81
    v_cvt_pk_bf16_f32 v81, v82, v83
    ds_wrxchg_rtn_b64 v[74:75], v95, v[80:81] offset:65408
    v_cvt_pk_bf16_f32 v76, v76, v77
    v_cvt_pk_bf16_f32 v77, v78, v79
    ds_wrxchg_rtn_b64 v[72:73], v94, v[76:77] offset:65408
    s_waitcnt lgkmcnt(2)
    v_mfma_f32_4x4x4_16b_bf16 v[80:83], v[8:9], v[102:103], 0
    v_mfma_f32_4x4x4_16b_bf16 v[76:79], v[8:9], v[100:101], 0
    v_bitop3_b32 v15, v6, v15, v46 bitop3:0xca
    v_bitop3_b32 v14, v6, v14, v47 bitop3:0xca
    v_cmp_lt_u32 s[84:85], v5, v92
    s_nop 0
    v_pk_mul_f32 v[80:81], v[80:81], v[14:15] op_sel:[0,1] op_sel_hi:[1,1]
    v_pk_mul_f32 v[82:83], v[82:83], v[14:15] op_sel:[0,1] op_sel_hi:[1,1]
    v_pk_mul_f32 v[76:77], v[76:77], v[14:15] op_sel:[0,0] op_sel_hi:[1,0]
    v_pk_mul_f32 v[78:79], v[78:79], v[14:15] op_sel:[0,0] op_sel_hi:[1,0]
    s_waitcnt lgkmcnt(0)
    v_cmp_ne_u64 s[50:51], v[72:73], v[68:69]
    v_cmpx_ne_u64 s[54:55], v[74:75], v[70:71]
    s_and_b64 s[82:83], s[54:55], s[80:81]
    s_cbranch_scc1 L2_c57
L2_d57:
    v_mov_b64 v[84:85], v[70:71]
    v_mov_b32 v7, v95
    v_mov_b64 v[86:87], v[74:75]
    s_or_b64 s[80:81], s[80:81], s[54:55]
    s_mov_b64 exec, s[50:51]
    s_and_b64 s[82:83], s[50:51], s[80:81]
    s_cbranch_scc1 L2_c58
L2_d58:
    v_mov_b64 v[84:85], v[68:69]
    v_mov_b32 v7, v94
    v_mov_b64 v[86:87], v[72:73]
    s_mov_b64 exec, -1
    s_or_b64 s[80:81], s[80:81], s[50:51]
    ds_read_b64 v[70:71], v93 offset:65408
    s_and_b64 exec, s[84:85], s[80:81]
    v_mfma_f32_4x4x4_16b_bf16 v[76:79], v[12:13], v[84:85], 0
    v_mov_b32 v92, v7
    s_andn2_b64 s[80:81], s[80:81], s[84:85]
    v_mfma_f32_4x4x4_16b_bf16 v[76:79], v[10:11], v[86:87], v[76:79]
    s_mov_b64 exec, -1
    ds_read_b64 v[68:69], v92 offset:65408
    v_and_b32 v46, 0x80000000, v33
    v_lshrrev_b32 v47, 14, v31
    v_bitop3_b32 v47, v47, v5, v46 bitop3:0xea
    ds_read_b64 v[106:107], v47
    v_bitop3_b32 v95, v31, v5, v46 bitop3:0xea
    v_and_b32 v46, 0x40000000, v33
    v_lshrrev_b32 v47, 14, v30
    v_bitop3_b32 v47, v47, v5, v46 bitop3:0xea
    ds_read_b64 v[104:105], v47
    v_bitop3_b32 v94, v30, v5, v46 bitop3:0xea
    s_waitcnt lgkmcnt(2)
    v_mfma_f32_4x4x4_16b_bf16 v[80:83], v[10:11], v[70:71], v[80:83]
    v_mfma_f32_4x4x4_16b_bf16 v[76:79], v[10:11], v[68:69], v[76:79]
    v_perm_b32 v15, v31, v32, s47
    v_bitop3_b32 v46, v31, 0.5, -0.5 bitop3:0xa8
    v_perm_b32 v14, v30, v32, s46
    v_bitop3_b32 v47, v30, 0.5, -0.5 bitop3:0xa8
    v_cvt_pk_bf16_f32 v80, v80, v81
    v_cvt_pk_bf16_f32 v81, v82, v83
    ds_wrxchg_rtn_b64 v[74:75], v93, v[80:81] offset:65408
    v_cvt_pk_bf16_f32 v76, v76, v77
    v_cvt_pk_bf16_f32 v77, v78, v79
    ds_wrxchg_rtn_b64 v[72:73], v92, v[76:77] offset:65408
    v_and_b32 v88, 0x0fffffff, v42
    v_mov_b32 v33, v42
    buffer_load_dwordx2 v[28:29], v88, s[8:11], 0 offen
    buffer_load_dwordx3 v[30:32], v88, s[8:11], 0 offen offset:8
    s_setprio 0
    s_waitcnt lgkmcnt(2)
    v_mfma_f32_4x4x4_16b_bf16 v[80:83], v[8:9], v[106:107], 0
    v_mfma_f32_4x4x4_16b_bf16 v[76:79], v[8:9], v[104:105], 0
    v_bitop3_b32 v15, v6, v15, v46 bitop3:0xca
    v_bitop3_b32 v14, v6, v14, v47 bitop3:0xca
    s_nop 1
    v_pk_mul_f32 v[80:81], v[80:81], v[14:15] op_sel:[0,1] op_sel_hi:[1,1]
    v_pk_mul_f32 v[82:83], v[82:83], v[14:15] op_sel:[0,1] op_sel_hi:[1,1]
    v_pk_mul_f32 v[76:77], v[76:77], v[14:15] op_sel:[0,0] op_sel_hi:[1,0]
    v_pk_mul_f32 v[78:79], v[78:79], v[14:15] op_sel:[0,0] op_sel_hi:[1,0]
    s_add_u32 s40, s40, 0xfff24000
    s_waitcnt lgkmcnt(0)
    v_cmp_ne_u64 s[50:51], v[72:73], v[68:69]
    v_cmpx_ne_u64 s[54:55], v[74:75], v[70:71]
    s_and_b64 s[82:83], s[54:55], s[80:81]
    s_cbranch_scc1 L2_c59
L2_d59:
    v_mov_b64 v[84:85], v[70:71]
    v_mov_b32 v7, v93
    v_mov_b64 v[86:87], v[74:75]
    s_or_b64 s[80:81], s[80:81], s[54:55]
    s_mov_b64 exec, s[50:51]
    s_and_b64 s[82:83], s[50:51], s[80:81]
    s_cbranch_scc1 L2_c60
L2_d60:
    v_mov_b64 v[84:85], v[68:69]
    v_mov_b32 v7, v92
    v_mov_b64 v[86:87], v[72:73]
    s_mov_b64 exec, -1
    s_or_b64 s[80:81], s[80:81], s[50:51]
    ds_read_b64 v[70:71], v95 offset:65408
    ds_read_b64 v[68:69], v94 offset:65408
    s_waitcnt vmcnt(8)
    v_and_b32 v46, 0x20000000, v39
    v_lshrrev_b32 v47, 14, v35
    v_bitop3_b32 v47, v47, v5, v46 bitop3:0xea
    ds_read_b64 v[102:103], v47
    v_bitop3_b32 v93, v35, v5, v46 bitop3:0xea
    v_and_b32 v46, 0x10000000, v39
    v_lshrrev_b32 v47, 14, v34
    v_bitop3_b32 v47, v47, v5, v46 bitop3:0xea
    ds_read_b64 v[100:101], v47
    v_bitop3_b32 v92, v34, v5, v46 bitop3:0xea
    v_and_b32 v46, 0x80000000, v39
    v_lshrrev_b32 v47, 14, v37
    v_bitop3_b32 v47, v47, v5, v46 bitop3:0xea
    ds_read_b64 v[106:107], v47
    v_and_b32 v46, 0x40000000, v39
    v_lshrrev_b32 v47, 14, v36
    v_bitop3_b32 v47, v47, v5, v46 bitop3:0xea
    ds_read_b64 v[104:105], v47
    s_waitcnt lgkmcnt(4)
    v_mfma_f32_4x4x4_16b_bf16 v[80:83], v[10:11], v[70:71], v[80:83]
    v_mfma_f32_4x4x4_16b_bf16 v[76:79], v[10:11], v[68:69], v[76:79]
    v_perm_b32 v15, v35, v38, s45
    v_bitop3_b32 v46, v35, 0.5, -0.5 bitop3:0xa8
    v_perm_b32 v14, v34, v38, s44
    v_bitop3_b32 v47, v34, 0.5, -0.5 bitop3:0xa8
    v_cvt_pk_bf16_f32 v80, v80, v81
    v_cvt_pk_bf16_f32 v81, v82, v83
    ds_wrxchg_rtn_b64 v[74:75], v95, v[80:81] offset:65408
    v_cvt_pk_bf16_f32 v76, v76, v77
    v_cvt_pk_bf16_f32 v77, v78, v79
    ds_wrxchg_rtn_b64 v[72:73], v94, v[76:77] offset:65408
    s_waitcnt lgkmcnt(2)
    s_barrier
    s_setprio 3
    s_mov_b32 m0, s100
    s_nop 0
    ds_write_addtid_b32 v116 offset:32768
    ds_write_addtid_b32 v117 offset:33024
    ds_write_addtid_b32 v118 offset:33280
    ds_write_addtid_b32 v119 offset:33536
    buffer_load_dwordx4 v[116:119], v3, s[16:19], s40 offen offset:2048
    ds_write_addtid_b32 v120 offset:33792
    ds_write_addtid_b32 v121 offset:34048
    ds_write_addtid_b32 v122 offset:34304
    ds_write_addtid_b32 v123 offset:34560
    buffer_load_dwordx4 v[120:123], v3, s[16:19], s40 offen offset:3072
    v_mfma_f32_4x4x4_16b_bf16 v[80:83], v[8:9], v[102:103], 0
    v_mfma_f32_4x4x4_16b_bf16 v[76:79], v[8:9], v[100:101], 0
    v_bitop3_b32 v15, v6, v15, v46 bitop3:0xca
    v_bitop3_b32 v14, v6, v14, v47 bitop3:0xca
    v_cmp_lt_u32 s[84:85], v5, v92
    s_nop 0
    v_pk_mul_f32 v[80:81], v[80:81], v[14:15] op_sel:[0,1] op_sel_hi:[1,1]
    v_pk_mul_f32 v[82:83], v[82:83], v[14:15] op_sel:[0,1] op_sel_hi:[1,1]
    v_pk_mul_f32 v[76:77], v[76:77], v[14:15] op_sel:[0,0] op_sel_hi:[1,0]
    v_pk_mul_f32 v[78:79], v[78:79], v[14:15] op_sel:[0,0] op_sel_hi:[1,0]
    v_mov_b32 v44, v43
    s_cmp_gt_u32 s37, 1024
    s_cbranch_scc1 L2_xs61
    s_cmp_lg_u32 s101, 0
    s_cbranch_scc1 L2_xa61
L2_xb61:
    v_lshlrev_b32 v89, 16, v96
    v_add_u32 v90, 60, v97
    v_bitop3_b32 v90, v89, v45, v90 bitop3:0x6a
    ds_write_b32 v98, v90 offset:12
    v_lshlrev_b32 v89, 20, v96
    v_add_u32 v90, 40, v97
    v_bitop3_b32 v90, v89, v45, v90 bitop3:0x6a
    ds_write_b32 v98, v90 offset:8
    v_lshlrev_b32 v89, 24, v96
    v_add_u32 v90, 20, v97
    v_bitop3_b32 v90, v89, v45, v90 bitop3:0x6a
    ds_write_b32 v98, v90 offset:4
    v_lshlrev_b32 v89, 28, v96
    v_bitop3_b32 v90, v89, v45, v97 bitop3:0x6a
    ds_write_b32 v98, v90 offset:0
    v_mov_b32_dpp v91, v64 quad_perm:[0,0,0,0] row_mask:0xf bank_mask:0xf
    v_and_b32 v89, 3, v91
    v_and_b32 v97, 0xfffc, v91
    v_sub_u16_dpp v88, v64, v91 quad_perm:[2,2,2,2] row_mask:0xf bank_mask:0xf
    v_mad_u32_u24 v97, v97, 5, v4
    v_add_u32 v99, v88, v89
    v_bfm_b32 v96, v88, v89
    v_cmp_lt_u32 s[58:59], 16, v99
    v_lshlrev_b32 v89, v1, v96
    v_and_b32 v89, v45, v89
    v_cmp_ne_u32 vcc, 0, v89
    v_xor_b32 v90, v97, v89
    s_add_u32 s3, s37, s38
    v_mbcnt_lo_u32_b32 v98, vcc_lo, 0
    v_mbcnt_hi_u32_b32 v98, vcc_hi, v98
    s_bcnt1_i32_b64 s41, vcc
    v_lshl_add_u32 v98, v98, 2, s3
    s_mov_b64 exec, vcc
    ds_write_b32 v98, v90
    s_mov_b64 exec, -1
    s_lshl2_add_u32 s37, s41, s37
    s_cmp_lg_u64 s[58:59], 0
    s_cbranch_scc1 L2_xe61
L2_xr61:
    v_add_u32 v98, s37, v0
    v_mov_b32 v90, -1
    ds_write_b32 v98, v90
    ds_read2st64_b32 v[40:41], v0 offset0:0 offset1:1
    ds_read2st64_b32 v[42:43], v0 offset0:2 offset1:3
    s_sub_u32 s3, s37, 768
    s_cmp_gt_u32 s3, 256
    s_cbranch_scc1 L2_xf61
L2_xg61:
    s_setprio 2
    ds_write_addtid_b32 v124 offset:34816
    ds_write_addtid_b32 v125 offset:35072
    ds_write_addtid_b32 v126 offset:35328
    ds_write_addtid_b32 v127 offset:35584
    s_add_u32 s3, s40, 4096
    buffer_load_dwordx4 v[124:127], v3, s[16:19], s3 offen
    s_waitcnt lgkmcnt(14)
    v_cmp_ne_u64 s[50:51], v[72:73], v[68:69]
    v_cmpx_ne_u64 s[54:55], v[74:75], v[70:71]
    s_and_b64 s[82:83], s[54:55], s[80:81]
    s_cbranch_scc1 L2_c62
L2_d62:
    v_mov_b64 v[84:85], v[70:71]
    v_mov_b32 v7, v95
    v_mov_b64 v[86:87], v[74:75]
    s_or_b64 s[80:81], s[80:81], s[54:55]
    s_mov_b64 exec, s[50:51]
    s_and_b64 s[82:83], s[50:51], s[80:81]
    s_cbranch_scc1 L2_c63
L2_d63:
    v_mov_b64 v[84:85], v[68:69]
    v_mov_b32 v7, v94
    v_mov_b64 v[86:87], v[72:73]
    s_mov_b64 exec, -1
    s_or_b64 s[80:81], s[80:81], s[50:51]
    ds_read_b64 v[70:71], v93 offset:65408
    s_and_b64 exec, s[84:85], s[80:81]
    v_mfma_f32_4x4x4_16b_bf16 v[76:79], v[12:13], v[84:85], 0
    v_mov_b32 v92, v7
    s_andn2_b64 s[80:81], s[80:81], s[84:85]
    v_mfma_f32_4x4x4_16b_bf16 v[76:79], v[10:11], v[86:87], v[76:79]
    s_mov_b64 exec, -1
    ds_read_b64 v[68:69], v92 offset:65408
    s_setprio 1
    s_waitcnt vmcnt(10)
    s_mov_b32 m0, s38
    s_nop 0
    ds_write_addtid_b32 v108 offset:0
    ds_write_addtid_b32 v109 offset:256
    ds_write_addtid_b32 v110 offset:512
    ds_write_addtid_b32 v111 offset:768
    s_waitcnt lgkmcnt(4)
    v_mfma_f32_4x4x4_16b_bf16 v[80:83], v[10:11], v[70:71], v[80:83]
    v_mfma_f32_4x4x4_16b_bf16 v[76:79], v[10:11], v[68:69], v[76:79]
    v_and_b32 v46, 0x40000000, v39
    v_bitop3_b32 v94, v36, v5, v46 bitop3:0xea
    v_and_b32 v46, 0x80000000, v39
    v_bitop3_b32 v95, v37, v5, v46 bitop3:0xea
    v_perm_b32 v15, v37, v38, s47
    v_bitop3_b32 v46, v37, 0.5, -0.5 bitop3:0xa8
    v_perm_b32 v14, v36, v38, s46
    v_bitop3_b32 v47, v36, 0.5, -0.5 bitop3:0xa8
    v_cvt_pk_bf16_f32 v80, v80, v81
    v_cvt_pk_bf16_f32 v81, v82, v83
    ds_wrxchg_rtn_b64 v[74:75], v93, v[80:81] offset:65408
    v_cvt_pk_bf16_f32 v76, v76, v77
    v_cvt_pk_bf16_f32 v77, v78, v79
    ds_wrxchg_rtn_b64 v[72:73], v92, v[76:77] offset:65408
    v_and_b32 v88, 0x0fffffff, v44
    v_mov_b32 v39, v44
    buffer_load_dwordx2 v[34:35], v88, s[8:11], 0 offen
    buffer_load_dwordx3 v[36:38], v88, s[8:11], 0 offen offset:8
    s_setprio 0
    s_waitcnt vmcnt(11)
    ds_write_addtid_b32 v112 offset:1024
    ds_write_addtid_b32 v113 offset:1280
    ds_write_addtid_b32 v114 offset:1536
    ds_write_addtid_b32 v115 offset:1792
    v_mfma_f32_4x4x4_16b_bf16 v[80:83], v[8:9], v[106:107], 0
    v_mfma_f32_4x4x4_16b_bf16 v[76:79], v[8:9], v[104:105], 0
    v_bitop3_b32 v15, v6, v15, v46 bitop3:0xca
    v_bitop3_b32 v14, v6, v14, v47 bitop3:0xca
    s_nop 1
    v_pk_mul_f32 v[80:81], v[80:81], v[14:15] op_sel:[0,1] op_sel_hi:[1,1]
    v_pk_mul_f32 v[82:83], v[82:83], v[14:15] op_sel:[0,1] op_sel_hi:[1,1]
    v_pk_mul_f32 v[76:77], v[76:77], v[14:15] op_sel:[0,0] op_sel_hi:[1,0]
    v_pk_mul_f32 v[78:79], v[78:79], v[14:15] op_sel:[0,0] op_sel_hi:[1,0]
    s_add_u32 s42, s42, 1
    s_waitcnt lgkmcnt(0)
    s_barrier
    s_bitcmp1_b32 s36, s42
    s_cbranch_scc1 L2_slow
L2_ret3:
    s_setprio 3
    buffer_load_dwordx4 v[108:111], v3, s[16:19], s40 offen offset:0
    v_cmp_ne_u64 s[50:51], v[72:73], v[68:69]
    v_cmpx_ne_u64 s[54:55], v[74:75], v[70:71]
    s_and_b64 s[82:83], s[54:55], s[80:81]
    s_cbranch_scc1 L2_c64
L2_d64:
    v_mov_b64 v[84:85], v[70:71]
    v_mov_b32 v7, v93
    v_mov_b64 v[86:87], v[74:75]
    s_or_b64 s[80:81], s[80:81], s[54:55]
    s_mov_b64 exec, s[50:51]
    s_and_b64 s[82:83], s[50:51], s[80:81]
    s_cbranch_scc1 L2_c65
L2_d65:
    v_mov_b64 v[84:85], v[68:69]
    v_mov_b32 v7, v92
    v_mov_b64 v[86:87], v[72:73]
    s_mov_b64 exec, -1
    s_or_b64 s[80:81], s[80:81], s[50:51]
    ds_read_b64 v[70:71], v95 offset:65408
    ds_read_b64 v[68:69], v94 offset:65408
    s_waitcnt vmcnt(10)
    v_and_b32 v46, 0x20000000, v21
    v_lshrrev_b32 v47, 14, v17
    v_bitop3_b32 v47, v47, v5, v46 bitop3:0xea
    ds_read_b64 v[102:103], v47
    v_bitop3_b32 v93, v17, v5, v46 bitop3:0xea
    v_and_b32 v46, 0x10000000, v21
    v_lshrrev_b32 v47, 14, v16
    v_bitop3_b32 v47, v47, v5, v46 bitop3:0xea
    ds_read_b64 v[100:101], v47
    v_bitop3_b32 v92, v16, v5, v46 bitop3:0xea
    s_waitcnt lgkmcnt(2)
    v_mfma_f32_4x4x4_16b_bf16 v[80:83], v[10:11], v[70:71], v[80:83]
    v_mfma_f32_4x4x4_16b_bf16 v[76:79], v[10:11], v[68:69], v[76:79]
    v_perm_b32 v15, v17, v20, s45
    v_bitop3_b32 v46, v17, 0.5, -0.5 bitop3:0xa8
    v_perm_b32 v14, v16, v20, s44
    v_bitop3_b32 v47, v16, 0.5, -0.5 bitop3:0xa8
    v_cvt_pk_bf16_f32 v80, v80, v81
    v_cvt_pk_bf16_f32 v81, v82, v83
    ds_wrxchg_rtn_b64 v[74:75], v95, v[80:81] offset:65408
    v_cvt_pk_bf16_f32 v76, v76, v77
    v_cvt_pk_bf16_f32 v77, v78, v79
    ds_wrxchg_rtn_b64 v[72:73], v94, v[76:77] offset:65408
    s_waitcnt lgkmcnt(2)
    v_mfma_f32_4x4x4_16b_bf16 v[80:83], v[8:9], v[102:103], 0
    v_mfma_f32_4x4x4_16b_bf16 v[76:79], v[8:9], v[100:101], 0
    v_bitop3_b32 v15, v6, v15, v46 bitop3:0xca
    v_bitop3_b32 v14, v6, v14, v47 bitop3:0xca
    v_cmp_lt_u32 s[84:85], v5, v92
    s_nop 0
    v_pk_mul_f32 v[80:81], v[80:81], v[14:15] op_sel:[0,1] op_sel_hi:[1,1]
    v_pk_mul_f32 v[82:83], v[82:83], v[14:15] op_sel:[0,1] op_sel_hi:[1,1]
    v_pk_mul_f32 v[76:77], v[76:77], v[14:15] op_sel:[0,0] op_sel_hi:[1,0]
    v_pk_mul_f32 v[78:79], v[78:79], v[14:15] op_sel:[0,0] op_sel_hi:[1,0]
    buffer_load_dwordx4 v[112:115], v3, s[16:19], s40 offen offset:1024
    s_waitcnt lgkmcnt(0)
    v_cmp_ne_u64 s[50:51], v[72:73], v[68:69]
    v_cmpx_ne_u64 s[54:55], v[74:75], v[70:71]
    s_and_b64 s[82:83], s[54:55], s[80:81]
    s_cbranch_scc1 L2_c66
L2_d66:
    v_mov_b64 v[84:85], v[70:71]
    v_mov_b32 v7, v95
    v_mov_b64 v[86:87], v[74:75]
    s_or_b64 s[80:81], s[80:81], s[54:55]
    s_mov_b64 exec, s[50:51]
    s_and_b64 s[82:83], s[50:51], s[80:81]
    s_cbranch_scc1 L2_c67
L2_d67:
    v_mov_b64 v[84:85], v[68:69]
    v_mov_b32 v7, v94
    v_mov_b64 v[86:87], v[72:73]
    s_mov_b64 exec, -1
    s_or_b64 s[80:81], s[80:81], s[50:51]
    ds_read_b64 v[70:71], v93 offset:65408
    s_and_b64 exec, s[84:85], s[80:81]
    v_mfma_f32_4x4x4_16b_bf16 v[76:79], v[12:13], v[84:85], 0
    v_mov_b32 v92, v7
    s_andn2_b64 s[80:81], s[80:81], s[84:85]
    v_mfma_f32_4x4x4_16b_bf16 v[76:79], v[10:11], v[86:87], v[76:79]
    s_mov_b64 exec, -1
    ds_read_b64 v[68:69], v92 offset:65408
    v_and_b32 v46, 0x80000000, v21
    v_lshrrev_b32 v47, 14, v19
    v_bitop3_b32 v47, v47, v5, v46 bitop3:0xea
    ds_read_b64 v[106:107], v47
    v_bitop3_b32 v95, v19, v5, v46 bitop3:0xea
    v_and_b32 v46, 0x40000000, v21
    v_lshrrev_b32 v47, 14, v18
    v_bitop3_b32 v47, v47, v5, v46 bitop3:0xea
    ds_read_b64 v[104:105], v47
    v_bitop3_b32 v94, v18, v5, v46 bitop3:0xea
    s_waitcnt lgkmcnt(2)
    v_mfma_f32_4x4x4_16b_bf16 v[80:83], v[10:11], v[70:71], v[80:83]
    v_mfma_f32_4x4x4_16b_bf16 v[76:79], v[10:11], v[68:69], v[76:79]
    v_perm_b32 v15, v19, v20, s47
    v_bitop3_b32 v46, v19, 0.5, -0.5 bitop3:0xa8
    v_perm_b32 v14, v18, v20, s46
    v_bitop3_b32 v47, v18, 0.5, -0.5 bitop3:0xa8
    v_cvt_pk_bf16_f32 v80, v80, v81
    v_cvt_pk_bf16_f32 v81, v82, v83
    ds_wrxchg_rtn_b64 v[74:75], v93, v[80:81] offset:65408
    v_cvt_pk_bf16_f32 v76, v76, v77
    v_cvt_pk_bf16_f32 v77, v78, v79
    ds_wrxchg_rtn_b64 v[72:73], v92, v[76:77] offset:65408
    v_and_b32 v88, 0x0fffffff, v40
    v_mov_b32 v21, v40
    buffer_load_dwordx2 v[16:17], v88, s[8:11], 0 offen
    buffer_load_dwordx3 v[18:20], v88, s[8:11], 0 offen offset:8
    s_setprio 2
    s_waitcnt lgkmcnt(2)
    v_mfma_f32_4x4x4_16b_bf16 v[80:83], v[8:9], v[106:107], 0
    v_mfma_f32_4x4x4_16b_bf16 v[76:79], v[8:9], v[104:105], 0
    v_bitop3_b32 v15, v6, v15, v46 bitop3:0xca
    v_bitop3_b32 v14, v6, v14, v47 bitop3:0xca
    s_nop 1
    v_pk_mul_f32 v[80:81], v[80:81], v[14:15] op_sel:[0,1] op_sel_hi:[1,1]
    v_pk_mul_f32 v[82:83], v[82:83], v[14:15] op_sel:[0,1] op_sel_hi:[1,1]
    v_pk_mul_f32 v[76:77], v[76:77], v[14:15] op_sel:[0,0] op_sel_hi:[1,0]
    v_pk_mul_f32 v[78:79], v[78:79], v[14:15] op_sel:[0,0] op_sel_hi:[1,0]
    v_sub_u16 v88, v58, v50
    v_and_b32 v89, 3, v50
    v_add3_u32 v99, v88, v89, 3
    v_and_b32 v99, -4, v99
    v_max_u32 v99, 4, v99
    v_and_b32 v97, 0xfffc, v50
    v_bfm_b32 v96, v88, v89
    v_add_u32_dpp v91, v99, v99 row_shr:1 row_mask:0xf bank_mask:0xf bound_ctrl:1
    v_mad_u32_u24 v97, v97, 5, v2
    v_cmp_lt_u32 vcc, 16, v99
    v_add_u32_dpp v91, v91, v91 row_shr:2 row_mask:0xf bank_mask:0xf bound_ctrl:1
    v_sub_u32 v98, s38, v99
    v_lshrrev_b64 v[50:51], 16, v[50:51]
    v_add_u32_dpp v91, v91, v91 row_shr:4 row_mask:0xf bank_mask:0xf bound_ctrl:1
    v_lshrrev_b64 v[58:59], 16, v[58:59]
    s_mov_b32 s101, 0
    v_add_u32_dpp v91, v91, v91 row_shr:8 row_mask:0xf bank_mask:0xf bound_ctrl:1
    s_nop 1
    v_add_u32_dpp v91, v91, v91 row_bcast:15 row_mask:0xa bank_mask:0xf
    s_nop 1
    v_add_u32_dpp v91, v91, v91 row_bcast:31 row_mask:0xc bank_mask:0xf
    v_add_u32 v98, v98, v91
    v_readlane_b32 s37, v91, 63
    s_cbranch_vccnz L2_xo68
L2_xp68:
    s_waitcnt lgkmcnt(0)
    v_cmp_ne_u64 s[50:51], v[72:73], v[68:69]
    v_cmpx_ne_u64 s[54:55], v[74:75], v[70:71]
    s_and_b64 s[82:83], s[54:55], s[80:81]
    s_cbranch_scc1 L2_c69
L2_d69:
    v_mov_b64 v[84:85], v[70:71]
    v_mov_b32 v7, v93
    v_mov_b64 v[86:87], v[74:75]
    s_or_b64 s[80:81], s[80:81], s[54:55]
    s_mov_b64 exec, s[50:51]
    s_and_b64 s[82:83], s[50:51], s[80:81]
    s_cbranch_scc1 L2_c70
L2_d70:
    v_mov_b64 v[84:85], v[68:69]
    v_mov_b32 v7, v92
    v_mov_b64 v[86:87], v[72:73]
    s_mov_b64 exec, -1
    s_or_b64 s[80:81], s[80:81], s[50:51]
    ds_read_b64 v[70:71], v95 offset:65408
    ds_read_b64 v[68:69], v94 offset:65408
    s_waitcnt vmcnt(11)
    v_and_b32 v46, 0x20000000, v27
    v_lshrrev_b32 v47, 14, v23
    v_bitop3_b32 v47, v47, v5, v46 bitop3:0xea
    ds_read_b64 v[102:103], v47
    v_bitop3_b32 v93, v23, v5, v46 bitop3:0xea
    v_and_b32 v46, 0x10000000, v27
    v_lshrrev_b32 v47, 14, v22
    v_bitop3_b32 v47, v47, v5, v46 bitop3:0xea
    ds_read_b64 v[100:101], v47
    v_bitop3_b32 v92, v22, v5, v46 bitop3:0xea
    s_waitcnt lgkmcnt(2)
    v_mfma_f32_4x4x4_16b_bf16 v[80:83], v[10:11], v[70:71], v[80:83]
    v_mfma_f32_4x4x4_16b_bf16 v[76:79], v[10:11], v[68:69], v[76:79]
    v_perm_b32 v15, v23, v26, s45
    v_bitop3_b32 v46, v23, 0.5, -0.5 bitop3:0xa8
    v_perm_b32 v14, v22, v26, s44
    v_bitop3_b32 v47, v22, 0.5, -0.5 bitop3:0xa8
    v_cvt_pk_bf16_f32 v80, v80, v81
    v_cvt_pk_bf16_f32 v81, v82, v83
    ds_wrxchg_rtn_b64 v[74:75], v95, v[80:81] offset:65408
    v_cvt_pk_bf16_f32 v76, v76, v77
    v_cvt_pk_bf16_f32 v77, v78, v79
    ds_wrxchg_rtn_b64 v[72:73], v94, v[76:77] offset:65408
    s_waitcnt lgkmcnt(2)
    v_mfma_f32_4x4x4_16b_bf16 v[80:83], v[8:9], v[102:103], 0
    v_mfma_f32_4x4x4_16b_bf16 v[76:79], v[8:9], v[100:101], 0
    v_bitop3_b32 v15, v6, v15, v46 bitop3:0xca
    v_bitop3_b32 v14, v6, v14, v47 bitop3:0xca
    v_cmp_lt_u32 s[84:85], v5, v92
    s_nop 0
    v_pk_mul_f32 v[80:81], v[80:81], v[14:15] op_sel:[0,1] op_sel_hi:[1,1]
    v_pk_mul_f32 v[82:83], v[82:83], v[14:15] op_sel:[0,1] op_sel_hi:[1,1]
    v_pk_mul_f32 v[76:77], v[76:77], v[14:15] op_sel:[0,0] op_sel_hi:[1,0]
    v_pk_mul_f32 v[78:79], v[78:79], v[14:15] op_sel:[0,0] op_sel_hi:[1,0]
    s_waitcnt lgkmcnt(0)
    v_cmp_ne_u64 s[50:51], v[72:73], v[68:69]
    v_cmpx_ne_u64 s[54:55], v[74:75], v[70:71]
    s_and_b64 s[82:83], s[54:55], s[80:81]
    s_cbranch_scc1 L2_c71
L2_d71:
    v_mov_b64 v[84:85], v[70:71]
    v_mov_b32 v7, v95
    v_mov_b64 v[86:87], v[74:75]
    s_or_b64 s[80:81], s[80:81], s[54:55]
    s_mov_b64 exec, s[50:51]
    s_and_b64 s[82:83], s[50:51], s[80:81]
    s_cbranch_scc1 L2_c72
L2_d72:
    v_mov_b64 v[84:85], v[68:69]
    v_mov_b32 v7, v94
    v_mov_b64 v[86:87], v[72:73]
    s_mov_b64 exec, -1
    s_or_b64 s[80:81], s[80:81], s[50:51]
    ds_read_b64 v[70:71], v93 offset:65408
    s_and_b64 exec, s[84:85], s[80:81]
    v_mfma_f32_4x4x4_16b_bf16 v[76:79], v[12:13], v[84:85], 0
    v_mov_b32 v92, v7
    s_andn2_b64 s[80:81], s[80:81], s[84:85]
    v_mfma_f32_4x4x4_16b_bf16 v[76:79], v[10:11], v[86:87], v[76:79]
    s_mov_b64 exec, -1
    ds_read_b64 v[68:69], v92 offset:65408
    v_and_b32 v46, 0x80000000, v27
    v_lshrrev_b32 v47, 14, v25
    v_bitop3_b32 v47, v47, v5, v46 bitop3:0xea
    ds_read_b64 v[106:107], v47
    v_bitop3_b32 v95, v25, v5, v46 bitop3:0xea
    v_and_b32 v46, 0x40000000, v27
    v_lshrrev_b32 v47, 14, v24
    v_bitop3_b32 v47, v47, v5, v46 bitop3:0xea
    ds_read_b64 v[104:105], v47
    v_bitop3_b32 v94, v24, v5, v46 bitop3:0xea
    s_waitcnt lgkmcnt(2)
    v_mfma_f32_4x4x4_16b_bf16 v[80:83], v[10:11], v[70:71], v[80:83]
    v_mfma_f32_4x4x4_16b_bf16 v[76:79], v[10:11], v[68:69], v[76:79]
    v_perm_b32 v15, v25, v26, s47
    v_bitop3_b32 v46, v25, 0.5, -0.5 bitop3:0xa8
    v_perm_b32 v14, v24, v26, s46
    v_bitop3_b32 v47, v24, 0.5, -0.5 bitop3:0xa8
    v_cvt_pk_bf16_f32 v80, v80, v81
    v_cvt_pk_bf16_f32 v81, v82, v83
    ds_wrxchg_rtn_b64 v[74:75], v93, v[80:81] offset:65408
    v_cvt_pk_bf16_f32 v76, v76, v77
    v_cvt_pk_bf16_f32 v77, v78, v79
    ds_wrxchg_rtn_b64 v[72:73], v92, v[76:77] offset:65408
    v_and_b32 v88, 0x0fffffff, v41
    v_mov_b32 v27, v41
    buffer_load_dwordx2 v[22:23], v88, s[8:11], 0 offen
    buffer_load_dwordx3 v[24:26], v88, s[8:11], 0 offen offset:8
    s_setprio 1
    s_waitcnt lgkmcnt(2)
    v_mfma_f32_4x4x4_16b_bf16 v[80:83], v[8:9], v[106:107], 0
    v_mfma_f32_4x4x4_16b_bf16 v[76:79], v[8:9], v[104:105], 0
    v_bitop3_b32 v15, v6, v15, v46 bitop3:0xca
    v_bitop3_b32 v14, v6, v14, v47 bitop3:0xca
    s_nop 1
    v_pk_mul_f32 v[80:81], v[80:81], v[14:15] op_sel:[0,1] op_sel_hi:[1,1]
    v_pk_mul_f32 v[82:83], v[82:83], v[14:15] op_sel:[0,1] op_sel_hi:[1,1]
    v_pk_mul_f32 v[76:77], v[76:77], v[14:15] op_sel:[0,0] op_sel_hi:[1,0]
    v_pk_mul_f32 v[78:79], v[78:79], v[14:15] op_sel:[0,0] op_sel_hi:[1,0]
    s_waitcnt lgkmcnt(0)
    v_cmp_ne_u64 s[50:51], v[72:73], v[68:69]
    v_cmpx_ne_u64 s[54:55], v[74:75], v[70:71]
    s_and_b64 s[82:83], s[54:55], s[80:81]
    s_cbranch_scc1 L2_c73
L2_d73:
    v_mov_b64 v[84:85], v[70:71]
    v_mov_b32 v7, v93
    v_mov_b64 v[86:87], v[74:75]
    s_or_b64 s[80:81], s[80:81], s[54:55]
    s_mov_b64 exec, s[50:51]
    s_and_b64 s[82:83], s[50:51], s[80:81]
    s_cbranch_scc1 L2_c74
L2_d74:
    v_mov_b64 v[84:85], v[68:69]
    v_mov_b32 v7, v92
    v_mov_b64 v[86:87], v[72:73]
    s_mov_b64 exec, -1
    s_or_b64 s[80:81], s[80:81], s[50:51]
    ds_read_b64 v[70:71], v95 offset:65408
    ds_read_b64 v[68:69], v94 offset:65408
    s_waitcnt vmcnt(11)
    v_and_b32 v46, 0x20000000, v33
    v_lshrrev_b32 v47, 14, v29
    v_bitop3_b32 v47, v47, v5, v46 bitop3:0xea
    ds_read_b64 v[102:103], v47
    v_bitop3_b32 v93, v29, v5, v46 bitop3:0xea
    v_and_b32 v46, 0x10000000, v33
    v_lshrrev_b32 v47, 14, v28
    v_bitop3_b32 v47, v47, v5, v46 bitop3:0xea
    ds_read_b64 v[100:101], v47
    v_bitop3_b32 v92, v28, v5, v46 bitop3:0xea
    s_waitcnt lgkmcnt(2)
    v_mfma_f32_4x4x4_16b_bf16 v[80:83], v[10:11], v[70:71], v[80:83]
    v_mfma_f32_4x4x4_16b_bf16 v[76:79], v[10:11], v[68:69], v[76:79]
    v_perm_b32 v15, v29, v32, s45
    v_bitop3_b32 v46, v29, 0.5, -0.5 bitop3:0xa8
    v_perm_b32 v14, v28, v32, s44
    v_bitop3_b32 v47, v28, 0.5, -0.5 bitop3:0xa8
    v_cvt_pk_bf16_f32 v80, v80, v81
    v_cvt_pk_bf16_f32 v81, v82, v83
    ds_wrxchg_rtn_b64 v[74:75], v95, v[80:81] offset:65408
    v_cvt_pk_bf16_f32 v76, v76, v77
    v_cvt_pk_bf16_f32 v77, v78, v79
    ds_wrxchg_rtn_b64 v[72:73], v94, v[76:77] offset:65408
    s_waitcnt lgkmcnt(2)
    v_mfma_f32_4x4x4_16b_bf16 v[80:83], v[8:9], v[102:103], 0
    v_mfma_f32_4x4x4_16b_bf16 v[76:79], v[8:9], v[100:101], 0
    v_bitop3_b32 v15, v6, v15, v46 bitop3:0xca
    v_bitop3_b32 v14, v6, v14, v47 bitop3:0xca
    v_cmp_lt_u32 s[84:85], v5, v92
    s_nop 0
    v_pk_mul_f32 v[80:81], v[80:81], v[14:15] op_sel:[0,1] op_sel_hi:[1,1]
    v_pk_mul_f32 v[82:83], v[82:83], v[14:15] op_sel:[0,1] op_sel_hi:[1,1]
    v_pk_mul_f32 v[76:77], v[76:77], v[14:15] op_sel:[0,0] op_sel_hi:[1,0]
    v_pk_mul_f32 v[78:79], v[78:79], v[14:15] op_sel:[0,0] op_sel_hi:[1,0]
    s_waitcnt lgkmcnt(0)
    v_cmp_ne_u64 s[50:51], v[72:73], v[68:69]
    v_cmpx_ne_u64 s[54:55], v[74:75], v[70:71]
    s_and_b64 s[82:83], s[54:55], s[80:81]
    s_cbranch_scc1 L2_c75
L2_d75:
    v_mov_b64 v[84:85], v[70:71]
    v_mov_b32 v7, v95
    v_mov_b64 v[86:87], v[74:75]
    s_or_b64 s[80:81], s[80:81], s[54:55]
    s_mov_b64 exec, s[50:51]
    s_and_b64 s[82:83], s[50:51], s[80:81]
    s_cbranch_scc1 L2_c76
L2_d76:
    v_mov_b64 v[84:85], v[68:69]
    v_mov_b32 v7, v94
    v_mov_b64 v[86:87], v[72:73]
    s_mov_b64 exec, -1
    s_or_b64 s[80:81], s[80:81], s[50:51]
    ds_read_b64 v[70:71], v93 offset:65408
    s_and_b64 exec, s[84:85], s[80:81]
    v_mfma_f32_4x4x4_16b_bf16 v[76:79], v[12:13], v[84:85], 0
    v_mov_b32 v92, v7
    s_andn2_b64 s[80:81], s[80:81], s[84:85]
    v_mfma_f32_4x4x4_16b_bf16 v[76:79], v[10:11], v[86:87], v[76:79]
    s_mov_b64 exec, -1
    ds_read_b64 v[68:69], v92 offset:65408
    v_and_b32 v46, 0x80000000, v33
    v_lshrrev_b32 v47, 14, v31
    v_bitop3_b32 v47, v47, v5, v46 bitop3:0xea
    ds_read_b64 v[106:107], v47
    v_bitop3_b32 v95, v31, v5, v46 bitop3:0xea
    v_and_b32 v46, 0x40000000, v33
    v_lshrrev_b32 v47, 14, v30
    v_bitop3_b32 v47, v47, v5, v46 bitop3:0xea
    ds_read_b64 v[104:105], v47
    v_bitop3_b32 v94, v30, v5, v46 bitop3:0xea
    s_waitcnt lgkmcnt(2)
    v_mfma_f32_4x4x4_16b_bf16 v[80:83], v[10:11], v[70:71], v[80:83]
    v_mfma_f32_4x4x4_16b_bf16 v[76:79], v[10:11], v[68:69], v[76:79]
    v_perm_b32 v15, v31, v32, s47
    v_bitop3_b32 v46, v31, 0.5, -0.5 bitop3:0xa8
    v_perm_b32 v14, v30, v32, s46
    v_bitop3_b32 v47, v30, 0.5, -0.5 bitop3:0xa8
    v_cvt_pk_bf16_f32 v80, v80, v81
    v_cvt_pk_bf16_f32 v81, v82, v83
    ds_wrxchg_rtn_b64 v[74:75], v93, v[80:81] offset:65408
    v_cvt_pk_bf16_f32 v76, v76, v77
    v_cvt_pk_bf16_f32 v77, v78, v79
    ds_wrxchg_rtn_b64 v[72:73], v92, v[76:77] offset:65408
    v_and_b32 v88, 0x0fffffff, v42
    v_mov_b32 v33, v42
    buffer_load_dwordx2 v[28:29], v88, s[8:11], 0 offen
    buffer_load_dwordx3 v[30:32], v88, s[8:11], 0 offen offset:8
    s_setprio 0
    s_waitcnt lgkmcnt(2)
    v_mfma_f32_4x4x4_16b_bf16 v[80:83], v[8:9], v[106:107], 0
    v_mfma_f32_4x4x4_16b_bf16 v[76:79], v[8:9], v[104:105], 0
    v_bitop3_b32 v15, v6, v15, v46 bitop3:0xca
    v_bitop3_b32 v14, v6, v14, v47 bitop3:0xca
    s_nop 1
    v_pk_mul_f32 v[80:81], v[80:81], v[14:15] op_sel:[0,1] op_sel_hi:[1,1]
    v_pk_mul_f32 v[82:83], v[82:83], v[14:15] op_sel:[0,1] op_sel_hi:[1,1]
    v_pk_mul_f32 v[76:77], v[76:77], v[14:15] op_sel:[0,0] op_sel_hi:[1,0]
    v_pk_mul_f32 v[78:79], v[78:79], v[14:15] op_sel:[0,0] op_sel_hi:[1,0]
    s_add_u32 s40, s40, 0x50000
    s_waitcnt lgkmcnt(0)
    v_cmp_ne_u64 s[50:51], v[72:73], v[68:69]
    v_cmpx_ne_u64 s[54:55], v[74:75], v[70:71]
    s_and_b64 s[82:83], s[54:55], s[80:81]
    s_cbranch_scc1 L2_c77
L2_d77:
    v_mov_b64 v[84:85], v[70:71]
    v_mov_b32 v7, v93
    v_mov_b64 v[86:87], v[74:75]
    s_or_b64 s[80:81], s[80:81], s[54:55]
    s_mov_b64 exec, s[50:51]
    s_and_b64 s[82:83], s[50:51], s[80:81]
    s_cbranch_scc1 L2_c78
L2_d78:
    v_mov_b64 v[84:85], v[68:69]
    v_mov_b32 v7, v92
    v_mov_b64 v[86:87], v[72:73]
    s_mov_b64 exec, -1
    s_or_b64 s[80:81], s[80:81], s[50:51]
    ds_read_b64 v[70:71], v95 offset:65408
    ds_read_b64 v[68:69], v94 offset:65408
    s_waitcnt vmcnt(8)
    v_and_b32 v46, 0x20000000, v39
    v_lshrrev_b32 v47, 14, v35
    v_bitop3_b32 v47, v47, v5, v46 bitop3:0xea
    ds_read_b64 v[102:103], v47
    v_bitop3_b32 v93, v35, v5, v46 bitop3:0xea
    v_and_b32 v46, 0x10000000, v39
    v_lshrrev_b32 v47, 14, v34
    v_bitop3_b32 v47, v47, v5, v46 bitop3:0xea
    ds_read_b64 v[100:101], v47
    v_bitop3_b32 v92, v34, v5, v46 bitop3:0xea
    v_and_b32 v46, 0x80000000, v39
    v_lshrrev_b32 v47, 14, v37
    v_bitop3_b32 v47, v47, v5, v46 bitop3:0xea
    ds_read_b64 v[106:107], v47
    v_and_b32 v46, 0x40000000, v39
    v_lshrrev_b32 v47, 14, v36
    v_bitop3_b32 v47, v47, v5, v46 bitop3:0xea
    ds_read_b64 v[104:105], v47
    s_waitcnt lgkmcnt(4)
    v_mfma_f32_4x4x4_16b_bf16 v[80:83], v[10:11], v[70:71], v[80:83]
    v_mfma_f32_4x4x4_16b_bf16 v[76:79], v[10:11], v[68:69], v[76:79]
    v_perm_b32 v15, v35, v38, s45
    v_bitop3_b32 v46, v35, 0.5, -0.5 bitop3:0xa8
    v_perm_b32 v14, v34, v38, s44
    v_bitop3_b32 v47, v34, 0.5, -0.5 bitop3:0xa8
    v_cvt_pk_bf16_f32 v80, v80, v81
    v_cvt_pk_bf16_f32 v81, v82, v83
    ds_wrxchg_rtn_b64 v[74:75], v95, v[80:81] offset:65408
    v_cvt_pk_bf16_f32 v76, v76, v77
    v_cvt_pk_bf16_f32 v77, v78, v79
    ds_wrxchg_rtn_b64 v[72:73], v94, v[76:77] offset:65408
    s_waitcnt lgkmcnt(2)
    s_barrier
    s_setprio 3
    s_mov_b32 m0, s100
    s_nop 0
    ds_write_addtid_b32 v116 offset:32768
    ds_write_addtid_b32 v117 offset:33024
    ds_write_addtid_b32 v118 offset:33280
    ds_write_addtid_b32 v119 offset:33536
    buffer_load_dwordx4 v[116:119], v3, s[16:19], s40 offen offset:2048
    ds_write_addtid_b32 v120 offset:33792
    ds_write_addtid_b32 v121 offset:34048
    ds_write_addtid_b32 v122 offset:34304
    ds_write_addtid_b32 v123 offset:34560
    buffer_load_dwordx4 v[120:123], v3, s[16:19], s40 offen offset:3072
    v_mfma_f32_4x4x4_16b_bf16 v[80:83], v[8:9], v[102:103], 0
    v_mfma_f32_4x4x4_16b_bf16 v[76:79], v[8:9], v[100:101], 0
    v_bitop3_b32 v15, v6, v15, v46 bitop3:0xca
    v_bitop3_b32 v14, v6, v14, v47 bitop3:0xca
    v_cmp_lt_u32 s[84:85], v5, v92
    s_nop 0
    v_pk_mul_f32 v[80:81], v[80:81], v[14:15] op_sel:[0,1] op_sel_hi:[1,1]
    v_pk_mul_f32 v[82:83], v[82:83], v[14:15] op_sel:[0,1] op_sel_hi:[1,1]
    v_pk_mul_f32 v[76:77], v[76:77], v[14:15] op_sel:[0,0] op_sel_hi:[1,0]
    v_pk_mul_f32 v[78:79], v[78:79], v[14:15] op_sel:[0,0] op_sel_hi:[1,0]
    v_mov_b32 v44, v43
    s_cmp_gt_u32 s37, 1024
    s_cbranch_scc1 L2_xs79
    s_cmp_lg_u32 s101, 0
    s_cbranch_scc1 L2_xa79
L2_xb79:
    v_lshlrev_b32 v89, 16, v96
    v_add_u32 v90, 60, v97
    v_bitop3_b32 v90, v89, v45, v90 bitop3:0x6a
    ds_write_b32 v98, v90 offset:12
    v_lshlrev_b32 v89, 20, v96
    v_add_u32 v90, 40, v97
    v_bitop3_b32 v90, v89, v45, v90 bitop3:0x6a
    ds_write_b32 v98, v90 offset:8
    v_lshlrev_b32 v89, 24, v96
    v_add_u32 v90, 20, v97
    v_bitop3_b32 v90, v89, v45, v90 bitop3:0x6a
    ds_write_b32 v98, v90 offset:4
    v_lshlrev_b32 v89, 28, v96
    v_bitop3_b32 v90, v89, v45, v97 bitop3:0x6a
    ds_write_b32 v98, v90 offset:0
    v_mov_b32_dpp v91, v66 quad_perm:[0,0,0,0] row_mask:0xf bank_mask:0xf
    v_and_b32 v89, 3, v91
    v_and_b32 v97, 0xfffc, v91
    v_sub_u16_dpp v88, v66, v91 quad_perm:[2,2,2,2] row_mask:0xf bank_mask:0xf
    v_mad_u32_u24 v97, v97, 5, v4
    v_add_u32 v99, v88, v89
    v_bfm_b32 v96, v88, v89
    v_cmp_lt_u32 s[58:59], 16, v99
    v_lshlrev_b32 v89, v1, v96
    v_and_b32 v89, v45, v89
    v_cmp_ne_u32 vcc, 0, v89
    v_xor_b32 v90, v97, v89
    s_add_u32 s3, s37, s38
    v_mbcnt_lo_u32_b32 v98, vcc_lo, 0
    v_mbcnt_hi_u32_b32 v98, vcc_hi, v98
    s_bcnt1_i32_b64 s41, vcc
    v_lshl_add_u32 v98, v98, 2, s3
    s_mov_b64 exec, vcc
    ds_write_b32 v98, v90
    s_mov_b64 exec, -1
    s_lshl2_add_u32 s37, s41, s37
    s_cmp_lg_u64 s[58:59], 0
    s_cbranch_scc1 L2_xe79
L2_xr79:
    v_add_u32 v98, s37, v0
    v_mov_b32 v90, -1
    ds_write_b32 v98, v90
    ds_read2st64_b32 v[40:41], v0 offset0:0 offset1:1
    ds_read2st64_b32 v[42:43], v0 offset0:2 offset1:3
    s_sub_u32 s3, s37, 768
    s_cmp_gt_u32 s3, 256
    s_cbranch_scc1 L2_xf79
L2_xg79:
    s_setprio 2
    ds_write_addtid_b32 v124 offset:34816
    ds_write_addtid_b32 v125 offset:35072
    ds_write_addtid_b32 v126 offset:35328
    ds_write_addtid_b32 v127 offset:35584
    s_add_u32 s3, s40, 4096
    buffer_load_dwordx4 v[124:127], v3, s[16:19], s3 offen
    s_waitcnt lgkmcnt(14)
    v_cmp_ne_u64 s[50:51], v[72:73], v[68:69]
    v_cmpx_ne_u64 s[54:55], v[74:75], v[70:71]
    s_and_b64 s[82:83], s[54:55], s[80:81]
    s_cbranch_scc1 L2_c80
L2_d80:
    v_mov_b64 v[84:85], v[70:71]
    v_mov_b32 v7, v95
    v_mov_b64 v[86:87], v[74:75]
    s_or_b64 s[80:81], s[80:81], s[54:55]
    s_mov_b64 exec, s[50:51]
    s_and_b64 s[82:83], s[50:51], s[80:81]
    s_cbranch_scc1 L2_c81
L2_d81:
    v_mov_b64 v[84:85], v[68:69]
    v_mov_b32 v7, v94
    v_mov_b64 v[86:87], v[72:73]
    s_mov_b64 exec, -1
    s_or_b64 s[80:81], s[80:81], s[50:51]
    ds_read_b64 v[70:71], v93 offset:65408
    s_and_b64 exec, s[84:85], s[80:81]
    v_mfma_f32_4x4x4_16b_bf16 v[76:79], v[12:13], v[84:85], 0
    v_mov_b32 v92, v7
    s_andn2_b64 s[80:81], s[80:81], s[84:85]
    v_mfma_f32_4x4x4_16b_bf16 v[76:79], v[10:11], v[86:87], v[76:79]
    s_mov_b64 exec, -1
    ds_read_b64 v[68:69], v92 offset:65408
    s_setprio 1
    s_waitcnt vmcnt(10)
    s_mov_b32 m0, s38
    s_nop 0
    ds_write_addtid_b32 v108 offset:0
    ds_write_addtid_b32 v109 offset:256
    ds_write_addtid_b32 v110 offset:512
    ds_write_addtid_b32 v111 offset:768
    s_waitcnt lgkmcnt(4)
    v_mfma_f32_4x4x4_16b_bf16 v[80:83], v[10:11], v[70:71], v[80:83]
    v_mfma_f32_4x4x4_16b_bf16 v[76:79], v[10:11], v[68:69], v[76:79]
    v_and_b32 v46, 0x40000000, v39
    v_bitop3_b32 v94, v36, v5, v46 bitop3:0xea
    v_and_b32 v46, 0x80000000, v39
    v_bitop3_b32 v95, v37, v5, v46 bitop3:0xea
    v_perm_b32 v15, v37, v38, s47
    v_bitop3_b32 v46, v37, 0.5, -0.5 bitop3:0xa8
    v_perm_b32 v14, v36, v38, s46
    v_bitop3_b32 v47, v36, 0.5, -0.5 bitop3:0xa8
    v_cvt_pk_bf16_f32 v80, v80, v81
    v_cvt_pk_bf16_f32 v81, v82, v83
    ds_wrxchg_rtn_b64 v[74:75], v93, v[80:81] offset:65408
    v_cvt_pk_bf16_f32 v76, v76, v77
    v_cvt_pk_bf16_f32 v77, v78, v79
    ds_wrxchg_rtn_b64 v[72:73], v92, v[76:77] offset:65408
    v_and_b32 v88, 0x0fffffff, v44
    v_mov_b32 v39, v44
    buffer_load_dwordx2 v[34:35], v88, s[8:11], 0 offen
    buffer_load_dwordx3 v[36:38], v88, s[8:11], 0 offen offset:8
    s_setprio 0
    s_waitcnt vmcnt(11)
    ds_write_addtid_b32 v112 offset:1024
    ds_write_addtid_b32 v113 offset:1280
    ds_write_addtid_b32 v114 offset:1536
    ds_write_addtid_b32 v115 offset:1792
    v_mfma_f32_4x4x4_16b_bf16 v[80:83], v[8:9], v[106:107], 0
    v_mfma_f32_4x4x4_16b_bf16 v[76:79], v[8:9], v[104:105], 0
    v_bitop3_b32 v15, v6, v15, v46 bitop3:0xca
    v_bitop3_b32 v14, v6, v14, v47 bitop3:0xca
    s_nop 1
    v_pk_mul_f32 v[80:81], v[80:81], v[14:15] op_sel:[0,1] op_sel_hi:[1,1]
    v_pk_mul_f32 v[82:83], v[82:83], v[14:15] op_sel:[0,1] op_sel_hi:[1,1]
    v_pk_mul_f32 v[76:77], v[76:77], v[14:15] op_sel:[0,0] op_sel_hi:[1,0]
    v_pk_mul_f32 v[78:79], v[78:79], v[14:15] op_sel:[0,0] op_sel_hi:[1,0]
    s_add_u32 s42, s42, 1
    s_waitcnt lgkmcnt(0)
    s_barrier
    s_bitcmp1_b32 s36, s42
    s_cbranch_scc1 L2_slow
L2_ret4:
    s_setprio 3
    buffer_load_dwordx4 v[108:111], v3, s[16:19], s40 offen offset:0
    v_cmp_ne_u64 s[50:51], v[72:73], v[68:69]
    v_cmpx_ne_u64 s[54:55], v[74:75], v[70:71]
    s_and_b64 s[82:83], s[54:55], s[80:81]
    s_cbranch_scc1 L2_c82
L2_d82:
    v_mov_b64 v[84:85], v[70:71]
    v_mov_b32 v7, v93
    v_mov_b64 v[86:87], v[74:75]
    s_or_b64 s[80:81], s[80:81], s[54:55]
    s_mov_b64 exec, s[50:51]
    s_and_b64 s[82:83], s[50:51], s[80:81]
    s_cbranch_scc1 L2_c83
L2_d83:
    v_mov_b64 v[84:85], v[68:69]
    v_mov_b32 v7, v92
    v_mov_b64 v[86:87], v[72:73]
    s_mov_b64 exec, -1
    s_or_b64 s[80:81], s[80:81], s[50:51]
    ds_read_b64 v[70:71], v95 offset:65408
    ds_read_b64 v[68:69], v94 offset:65408
    s_waitcnt vmcnt(10)
    v_and_b32 v46, 0x20000000, v21
    v_lshrrev_b32 v47, 14, v17
    v_bitop3_b32 v47, v47, v5, v46 bitop3:0xea
    ds_read_b64 v[102:103], v47
    v_bitop3_b32 v93, v17, v5, v46 bitop3:0xea
    v_and_b32 v46, 0x10000000, v21
    v_lshrrev_b32 v47, 14, v16
    v_bitop3_b32 v47, v47, v5, v46 bitop3:0xea
    ds_read_b64 v[100:101], v47
    v_bitop3_b32 v92, v16, v5, v46 bitop3:0xea
    s_waitcnt lgkmcnt(2)
    v_mfma_f32_4x4x4_16b_bf16 v[80:83], v[10:11], v[70:71], v[80:83]
    v_mfma_f32_4x4x4_16b_bf16 v[76:79], v[10:11], v[68:69], v[76:79]
    v_perm_b32 v15, v17, v20, s45
    v_bitop3_b32 v46, v17, 0.5, -0.5 bitop3:0xa8
    v_perm_b32 v14, v16, v20, s44
    v_bitop3_b32 v47, v16, 0.5, -0.5 bitop3:0xa8
    v_cvt_pk_bf16_f32 v80, v80, v81
    v_cvt_pk_bf16_f32 v81, v82, v83
    ds_wrxchg_rtn_b64 v[74:75], v95, v[80:81] offset:65408
    v_cvt_pk_bf16_f32 v76, v76, v77
    v_cvt_pk_bf16_f32 v77, v78, v79
    ds_wrxchg_rtn_b64 v[72:73], v94, v[76:77] offset:65408
    s_waitcnt lgkmcnt(2)
    v_mfma_f32_4x4x4_16b_bf16 v[80:83], v[8:9], v[102:103], 0
    v_mfma_f32_4x4x4_16b_bf16 v[76:79], v[8:9], v[100:101], 0
    v_bitop3_b32 v15, v6, v15, v46 bitop3:0xca
    v_bitop3_b32 v14, v6, v14, v47 bitop3:0xca
    v_cmp_lt_u32 s[84:85], v5, v92
    s_nop 0
    v_pk_mul_f32 v[80:81], v[80:81], v[14:15] op_sel:[0,1] op_sel_hi:[1,1]
    v_pk_mul_f32 v[82:83], v[82:83], v[14:15] op_sel:[0,1] op_sel_hi:[1,1]
    v_pk_mul_f32 v[76:77], v[76:77], v[14:15] op_sel:[0,0] op_sel_hi:[1,0]
    v_pk_mul_f32 v[78:79], v[78:79], v[14:15] op_sel:[0,0] op_sel_hi:[1,0]
    buffer_load_dwordx4 v[112:115], v3, s[16:19], s40 offen offset:1024
    s_waitcnt lgkmcnt(0)
    v_cmp_ne_u64 s[50:51], v[72:73], v[68:69]
    v_cmpx_ne_u64 s[54:55], v[74:75], v[70:71]
    s_and_b64 s[82:83], s[54:55], s[80:81]
    s_cbranch_scc1 L2_c84
L2_d84:
    v_mov_b64 v[84:85], v[70:71]
    v_mov_b32 v7, v95
    v_mov_b64 v[86:87], v[74:75]
    s_or_b64 s[80:81], s[80:81], s[54:55]
    s_mov_b64 exec, s[50:51]
    s_and_b64 s[82:83], s[50:51], s[80:81]
    s_cbranch_scc1 L2_c85
L2_d85:
    v_mov_b64 v[84:85], v[68:69]
    v_mov_b32 v7, v94
    v_mov_b64 v[86:87], v[72:73]
    s_mov_b64 exec, -1
    s_or_b64 s[80:81], s[80:81], s[50:51]
    ds_read_b64 v[70:71], v93 offset:65408
    s_and_b64 exec, s[84:85], s[80:81]
    v_mfma_f32_4x4x4_16b_bf16 v[76:79], v[12:13], v[84:85], 0
    v_mov_b32 v92, v7
    s_andn2_b64 s[80:81], s[80:81], s[84:85]
    v_mfma_f32_4x4x4_16b_bf16 v[76:79], v[10:11], v[86:87], v[76:79]
    s_mov_b64 exec, -1
    ds_read_b64 v[68:69], v92 offset:65408
    v_and_b32 v46, 0x80000000, v21
    v_lshrrev_b32 v47, 14, v19
    v_bitop3_b32 v47, v47, v5, v46 bitop3:0xea
    ds_read_b64 v[106:107], v47
    v_bitop3_b32 v95, v19, v5, v46 bitop3:0xea
    v_and_b32 v46, 0x40000000, v21
    v_lshrrev_b32 v47, 14, v18
    v_bitop3_b32 v47, v47, v5, v46 bitop3:0xea
    ds_read_b64 v[104:105], v47
    v_bitop3_b32 v94, v18, v5, v46 bitop3:0xea
    s_waitcnt lgkmcnt(2)
    v_mfma_f32_4x4x4_16b_bf16 v[80:83], v[10:11], v[70:71], v[80:83]
    v_mfma_f32_4x4x4_16b_bf16 v[76:79], v[10:11], v[68:69], v[76:79]
    v_perm_b32 v15, v19, v20, s47
    v_bitop3_b32 v46, v19, 0.5, -0.5 bitop3:0xa8
    v_perm_b32 v14, v18, v20, s46
    v_bitop3_b32 v47, v18, 0.5, -0.5 bitop3:0xa8
    v_cvt_pk_bf16_f32 v80, v80, v81
    v_cvt_pk_bf16_f32 v81, v82, v83
    ds_wrxchg_rtn_b64 v[74:75], v93, v[80:81] offset:65408
    v_cvt_pk_bf16_f32 v76, v76, v77
    v_cvt_pk_bf16_f32 v77, v78, v79
    ds_wrxchg_rtn_b64 v[72:73], v92, v[76:77] offset:65408
    v_and_b32 v88, 0x0fffffff, v40
    v_mov_b32 v21, v40
    buffer_load_dwordx2 v[16:17], v88, s[8:11], 0 offen
    buffer_load_dwordx3 v[18:20], v88, s[8:11], 0 offen offset:8
    s_setprio 2
    s_waitcnt lgkmcnt(2)
    v_mfma_f32_4x4x4_16b_bf16 v[80:83], v[8:9], v[106:107], 0
    v_mfma_f32_4x4x4_16b_bf16 v[76:79], v[8:9], v[104:105], 0
    v_bitop3_b32 v15, v6, v15, v46 bitop3:0xca
    v_bitop3_b32 v14, v6, v14, v47 bitop3:0xca
    s_nop 1
    v_pk_mul_f32 v[80:81], v[80:81], v[14:15] op_sel:[0,1] op_sel_hi:[1,1]
    v_pk_mul_f32 v[82:83], v[82:83], v[14:15] op_sel:[0,1] op_sel_hi:[1,1]
    v_pk_mul_f32 v[76:77], v[76:77], v[14:15] op_sel:[0,0] op_sel_hi:[1,0]
    v_pk_mul_f32 v[78:79], v[78:79], v[14:15] op_sel:[0,0] op_sel_hi:[1,0]
    v_sub_u16 v88, v60, v52
    v_and_b32 v89, 3, v52
    v_add3_u32 v99, v88, v89, 3
    v_and_b32 v99, -4, v99
    v_max_u32 v99, 4, v99
    v_and_b32 v97, 0xfffc, v52
    v_bfm_b32 v96, v88, v89
    v_add_u32_dpp v91, v99, v99 row_shr:1 row_mask:0xf bank_mask:0xf bound_ctrl:1
    v_mad_u32_u24 v97, v97, 5, v2
    v_cmp_lt_u32 vcc, 16, v99
    v_add_u32_dpp v91, v91, v91 row_shr:2 row_mask:0xf bank_mask:0xf bound_ctrl:1
    v_sub_u32 v98, s38, v99
    v_lshrrev_b64 v[52:53], 16, v[52:53]
    v_add_u32_dpp v91, v91, v91 row_shr:4 row_mask:0xf bank_mask:0xf bound_ctrl:1
    v_lshrrev_b64 v[60:61], 16, v[60:61]
    s_mov_b32 s101, 0
    v_add_u32_dpp v91, v91, v91 row_shr:8 row_mask:0xf bank_mask:0xf bound_ctrl:1
    s_nop 1
    v_add_u32_dpp v91, v91, v91 row_bcast:15 row_mask:0xa bank_mask:0xf
    s_nop 1
    v_add_u32_dpp v91, v91, v91 row_bcast:31 row_mask:0xc bank_mask:0xf
    v_add_u32 v98, v98, v91
    v_readlane_b32 s37, v91, 63
    s_cbranch_vccnz L2_xo86
L2_xp86:
    s_waitcnt lgkmcnt(0)
    v_cmp_ne_u64 s[50:51], v[72:73], v[68:69]
    v_cmpx_ne_u64 s[54:55], v[74:75], v[70:71]
    s_and_b64 s[82:83], s[54:55], s[80:81]
    s_cbranch_scc1 L2_c87
L2_d87:
    v_mov_b64 v[84:85], v[70:71]
    v_mov_b32 v7, v93
    v_mov_b64 v[86:87], v[74:75]
    s_or_b64 s[80:81], s[80:81], s[54:55]
    s_mov_b64 exec, s[50:51]
    s_and_b64 s[82:83], s[50:51], s[80:81]
    s_cbranch_scc1 L2_c88
L2_d88:
    v_mov_b64 v[84:85], v[68:69]
    v_mov_b32 v7, v92
    v_mov_b64 v[86:87], v[72:73]
    s_mov_b64 exec, -1
    s_or_b64 s[80:81], s[80:81], s[50:51]
    ds_read_b64 v[70:71], v95 offset:65408
    ds_read_b64 v[68:69], v94 offset:65408
    s_waitcnt vmcnt(11)
    v_and_b32 v46, 0x20000000, v27
    v_lshrrev_b32 v47, 14, v23
    v_bitop3_b32 v47, v47, v5, v46 bitop3:0xea
    ds_read_b64 v[102:103], v47
    v_bitop3_b32 v93, v23, v5, v46 bitop3:0xea
    v_and_b32 v46, 0x10000000, v27
    v_lshrrev_b32 v47, 14, v22
    v_bitop3_b32 v47, v47, v5, v46 bitop3:0xea
    ds_read_b64 v[100:101], v47
    v_bitop3_b32 v92, v22, v5, v46 bitop3:0xea
    s_waitcnt lgkmcnt(2)
    v_mfma_f32_4x4x4_16b_bf16 v[80:83], v[10:11], v[70:71], v[80:83]
    v_mfma_f32_4x4x4_16b_bf16 v[76:79], v[10:11], v[68:69], v[76:79]
    v_perm_b32 v15, v23, v26, s45
    v_bitop3_b32 v46, v23, 0.5, -0.5 bitop3:0xa8
    v_perm_b32 v14, v22, v26, s44
    v_bitop3_b32 v47, v22, 0.5, -0.5 bitop3:0xa8
    v_cvt_pk_bf16_f32 v80, v80, v81
    v_cvt_pk_bf16_f32 v81, v82, v83
    ds_wrxchg_rtn_b64 v[74:75], v95, v[80:81] offset:65408
    v_cvt_pk_bf16_f32 v76, v76, v77
    v_cvt_pk_bf16_f32 v77, v78, v79
    ds_wrxchg_rtn_b64 v[72:73], v94, v[76:77] offset:65408
    s_waitcnt lgkmcnt(2)
    v_mfma_f32_4x4x4_16b_bf16 v[80:83], v[8:9], v[102:103], 0
    v_mfma_f32_4x4x4_16b_bf16 v[76:79], v[8:9], v[100:101], 0
    v_bitop3_b32 v15, v6, v15, v46 bitop3:0xca
    v_bitop3_b32 v14, v6, v14, v47 bitop3:0xca
    v_cmp_lt_u32 s[84:85], v5, v92
    s_nop 0
    v_pk_mul_f32 v[80:81], v[80:81], v[14:15] op_sel:[0,1] op_sel_hi:[1,1]
    v_pk_mul_f32 v[82:83], v[82:83], v[14:15] op_sel:[0,1] op_sel_hi:[1,1]
    v_pk_mul_f32 v[76:77], v[76:77], v[14:15] op_sel:[0,0] op_sel_hi:[1,0]
    v_pk_mul_f32 v[78:79], v[78:79], v[14:15] op_sel:[0,0] op_sel_hi:[1,0]
    s_waitcnt lgkmcnt(0)
    v_cmp_ne_u64 s[50:51], v[72:73], v[68:69]
    v_cmpx_ne_u64 s[54:55], v[74:75], v[70:71]
    s_and_b64 s[82:83], s[54:55], s[80:81]
    s_cbranch_scc1 L2_c89
L2_d89:
    v_mov_b64 v[84:85], v[70:71]
    v_mov_b32 v7, v95
    v_mov_b64 v[86:87], v[74:75]
    s_or_b64 s[80:81], s[80:81], s[54:55]
    s_mov_b64 exec, s[50:51]
    s_and_b64 s[82:83], s[50:51], s[80:81]
    s_cbranch_scc1 L2_c90
L2_d90:
    v_mov_b64 v[84:85], v[68:69]
    v_mov_b32 v7, v94
    v_mov_b64 v[86:87], v[72:73]
    s_mov_b64 exec, -1
    s_or_b64 s[80:81], s[80:81], s[50:51]
    ds_read_b64 v[70:71], v93 offset:65408
    s_and_b64 exec, s[84:85], s[80:81]
    v_mfma_f32_4x4x4_16b_bf16 v[76:79], v[12:13], v[84:85], 0
    v_mov_b32 v92, v7
    s_andn2_b64 s[80:81], s[80:81], s[84:85]
    v_mfma_f32_4x4x4_16b_bf16 v[76:79], v[10:11], v[86:87], v[76:79]
    s_mov_b64 exec, -1
    ds_read_b64 v[68:69], v92 offset:65408
    v_and_b32 v46, 0x80000000, v27
    v_lshrrev_b32 v47, 14, v25
    v_bitop3_b32 v47, v47, v5, v46 bitop3:0xea
    ds_read_b64 v[106:107], v47
    v_bitop3_b32 v95, v25, v5, v46 bitop3:0xea
    v_and_b32 v46, 0x40000000, v27
    v_lshrrev_b32 v47, 14, v24
    v_bitop3_b32 v47, v47, v5, v46 bitop3:0xea
    ds_read_b64 v[104:105], v47
    v_bitop3_b32 v94, v24, v5, v46 bitop3:0xea
    s_waitcnt lgkmcnt(2)
    v_mfma_f32_4x4x4_16b_bf16 v[80:83], v[10:11], v[70:71], v[80:83]
    v_mfma_f32_4x4x4_16b_bf16 v[76:79], v[10:11], v[68:69], v[76:79]
    v_perm_b32 v15, v25, v26, s47
    v_bitop3_b32 v46, v25, 0.5, -0.5 bitop3:0xa8
    v_perm_b32 v14, v24, v26, s46
    v_bitop3_b32 v47, v24, 0.5, -0.5 bitop3:0xa8
    v_cvt_pk_bf16_f32 v80, v80, v81
    v_cvt_pk_bf16_f32 v81, v82, v83
    ds_wrxchg_rtn_b64 v[74:75], v93, v[80:81] offset:65408
    v_cvt_pk_bf16_f32 v76, v76, v77
    v_cvt_pk_bf16_f32 v77, v78, v79
    ds_wrxchg_rtn_b64 v[72:73], v92, v[76:77] offset:65408
    v_and_b32 v88, 0x0fffffff, v41
    v_mov_b32 v27, v41
    buffer_load_dwordx2 v[22:23], v88, s[8:11], 0 offen
    buffer_load_dwordx3 v[24:26], v88, s[8:11], 0 offen offset:8
    s_setprio 1
    s_waitcnt lgkmcnt(2)
    v_mfma_f32_4x4x4_16b_bf16 v[80:83], v[8:9], v[106:107], 0
    v_mfma_f32_4x4x4_16b_bf16 v[76:79], v[8:9], v[104:105], 0
    v_bitop3_b32 v15, v6, v15, v46 bitop3:0xca
    v_bitop3_b32 v14, v6, v14, v47 bitop3:0xca
    s_nop 1
    v_pk_mul_f32 v[80:81], v[80:81], v[14:15] op_sel:[0,1] op_sel_hi:[1,1]
    v_pk_mul_f32 v[82:83], v[82:83], v[14:15] op_sel:[0,1] op_sel_hi:[1,1]
    v_pk_mul_f32 v[76:77], v[76:77], v[14:15] op_sel:[0,0] op_sel_hi:[1,0]
    v_pk_mul_f32 v[78:79], v[78:79], v[14:15] op_sel:[0,0] op_sel_hi:[1,0]
    s_waitcnt lgkmcnt(0)
    v_cmp_ne_u64 s[50:51], v[72:73], v[68:69]
    v_cmpx_ne_u64 s[54:55], v[74:75], v[70:71]
    s_and_b64 s[82:83], s[54:55], s[80:81]
    s_cbranch_scc1 L2_c91
L2_d91:
    v_mov_b64 v[84:85], v[70:71]
    v_mov_b32 v7, v93
    v_mov_b64 v[86:87], v[74:75]
    s_or_b64 s[80:81], s[80:81], s[54:55]
    s_mov_b64 exec, s[50:51]
    s_and_b64 s[82:83], s[50:51], s[80:81]
    s_cbranch_scc1 L2_c92
L2_d92:
    v_mov_b64 v[84:85], v[68:69]
    v_mov_b32 v7, v92
    v_mov_b64 v[86:87], v[72:73]
    s_mov_b64 exec, -1
    s_or_b64 s[80:81], s[80:81], s[50:51]
    ds_read_b64 v[70:71], v95 offset:65408
    ds_read_b64 v[68:69], v94 offset:65408
    s_waitcnt vmcnt(11)
    v_and_b32 v46, 0x20000000, v33
    v_lshrrev_b32 v47, 14, v29
    v_bitop3_b32 v47, v47, v5, v46 bitop3:0xea
    ds_read_b64 v[102:103], v47
    v_bitop3_b32 v93, v29, v5, v46 bitop3:0xea
    v_and_b32 v46, 0x10000000, v33
    v_lshrrev_b32 v47, 14, v28
    v_bitop3_b32 v47, v47, v5, v46 bitop3:0xea
    ds_read_b64 v[100:101], v47
    v_bitop3_b32 v92, v28, v5, v46 bitop3:0xea
    s_waitcnt lgkmcnt(2)
    v_mfma_f32_4x4x4_16b_bf16 v[80:83], v[10:11], v[70:71], v[80:83]
    v_mfma_f32_4x4x4_16b_bf16 v[76:79], v[10:11], v[68:69], v[76:79]
    v_perm_b32 v15, v29, v32, s45
    v_bitop3_b32 v46, v29, 0.5, -0.5 bitop3:0xa8
    v_perm_b32 v14, v28, v32, s44
    v_bitop3_b32 v47, v28, 0.5, -0.5 bitop3:0xa8
    v_cvt_pk_bf16_f32 v80, v80, v81
    v_cvt_pk_bf16_f32 v81, v82, v83
    ds_wrxchg_rtn_b64 v[74:75], v95, v[80:81] offset:65408
    v_cvt_pk_bf16_f32 v76, v76, v77
    v_cvt_pk_bf16_f32 v77, v78, v79
    ds_wrxchg_rtn_b64 v[72:73], v94, v[76:77] offset:65408
    s_waitcnt lgkmcnt(2)
    v_mfma_f32_4x4x4_16b_bf16 v[80:83], v[8:9], v[102:103], 0
    v_mfma_f32_4x4x4_16b_bf16 v[76:79], v[8:9], v[100:101], 0
    v_bitop3_b32 v15, v6, v15, v46 bitop3:0xca
    v_bitop3_b32 v14, v6, v14, v47 bitop3:0xca
    v_cmp_lt_u32 s[84:85], v5, v92
    s_nop 0
    v_pk_mul_f32 v[80:81], v[80:81], v[14:15] op_sel:[0,1] op_sel_hi:[1,1]
    v_pk_mul_f32 v[82:83], v[82:83], v[14:15] op_sel:[0,1] op_sel_hi:[1,1]
    v_pk_mul_f32 v[76:77], v[76:77], v[14:15] op_sel:[0,0] op_sel_hi:[1,0]
    v_pk_mul_f32 v[78:79], v[78:79], v[14:15] op_sel:[0,0] op_sel_hi:[1,0]
    s_waitcnt lgkmcnt(0)
    v_cmp_ne_u64 s[50:51], v[72:73], v[68:69]
    v_cmpx_ne_u64 s[54:55], v[74:75], v[70:71]
    s_and_b64 s[82:83], s[54:55], s[80:81]
    s_cbranch_scc1 L2_c93
L2_d93:
    v_mov_b64 v[84:85], v[70:71]
    v_mov_b32 v7, v95
    v_mov_b64 v[86:87], v[74:75]
    s_or_b64 s[80:81], s[80:81], s[54:55]
    s_mov_b64 exec, s[50:51]
    s_and_b64 s[82:83], s[50:51], s[80:81]
    s_cbranch_scc1 L2_c94
L2_d94:
    v_mov_b64 v[84:85], v[68:69]
    v_mov_b32 v7, v94
    v_mov_b64 v[86:87], v[72:73]
    s_mov_b64 exec, -1
    s_or_b64 s[80:81], s[80:81], s[50:51]
    ds_read_b64 v[70:71], v93 offset:65408
    s_and_b64 exec, s[84:85], s[80:81]
    v_mfma_f32_4x4x4_16b_bf16 v[76:79], v[12:13], v[84:85], 0
    v_mov_b32 v92, v7
    s_andn2_b64 s[80:81], s[80:81], s[84:85]
    v_mfma_f32_4x4x4_16b_bf16 v[76:79], v[10:11], v[86:87], v[76:79]
    s_mov_b64 exec, -1
    ds_read_b64 v[68:69], v92 offset:65408
    v_and_b32 v46, 0x80000000, v33
    v_lshrrev_b32 v47, 14, v31
    v_bitop3_b32 v47, v47, v5, v46 bitop3:0xea
    ds_read_b64 v[106:107], v47
    v_bitop3_b32 v95, v31, v5, v46 bitop3:0xea
    v_and_b32 v46, 0x40000000, v33
    v_lshrrev_b32 v47, 14, v30
    v_bitop3_b32 v47, v47, v5, v46 bitop3:0xea
    ds_read_b64 v[104:105], v47
    v_bitop3_b32 v94, v30, v5, v46 bitop3:0xea
    s_waitcnt lgkmcnt(2)
    v_mfma_f32_4x4x4_16b_bf16 v[80:83], v[10:11], v[70:71], v[80:83]
    v_mfma_f32_4x4x4_16b_bf16 v[76:79], v[10:11], v[68:69], v[76:79]
    v_perm_b32 v15, v31, v32, s47
    v_bitop3_b32 v46, v31, 0.5, -0.5 bitop3:0xa8
    v_perm_b32 v14, v30, v32, s46
    v_bitop3_b32 v47, v30, 0.5, -0.5 bitop3:0xa8
    v_cvt_pk_bf16_f32 v80, v80, v81
    v_cvt_pk_bf16_f32 v81, v82, v83
    ds_wrxchg_rtn_b64 v[74:75], v93, v[80:81] offset:65408
    v_cvt_pk_bf16_f32 v76, v76, v77
    v_cvt_pk_bf16_f32 v77, v78, v79
    ds_wrxchg_rtn_b64 v[72:73], v92, v[76:77] offset:65408
    v_and_b32 v88, 0x0fffffff, v42
    v_mov_b32 v33, v42
    buffer_load_dwordx2 v[28:29], v88, s[8:11], 0 offen
    buffer_load_dwordx3 v[30:32], v88, s[8:11], 0 offen offset:8
    s_setprio 0
    s_waitcnt lgkmcnt(2)
    v_mfma_f32_4x4x4_16b_bf16 v[80:83], v[8:9], v[106:107], 0
    v_mfma_f32_4x4x4_16b_bf16 v[76:79], v[8:9], v[104:105], 0
    v_bitop3_b32 v15, v6, v15, v46 bitop3:0xca
    v_bitop3_b32 v14, v6, v14, v47 bitop3:0xca
    s_nop 1
    v_pk_mul_f32 v[80:81], v[80:81], v[14:15] op_sel:[0,1] op_sel_hi:[1,1]
    v_pk_mul_f32 v[82:83], v[82:83], v[14:15] op_sel:[0,1] op_sel_hi:[1,1]
    v_pk_mul_f32 v[76:77], v[76:77], v[14:15] op_sel:[0,0] op_sel_hi:[1,0]
    v_pk_mul_f32 v[78:79], v[78:79], v[14:15] op_sel:[0,0] op_sel_hi:[1,0]
    s_add_u32 s40, s40, 0x50000
    s_waitcnt lgkmcnt(0)
    v_cmp_ne_u64 s[50:51], v[72:73], v[68:69]
    v_cmpx_ne_u64 s[54:55], v[74:75], v[70:71]
    s_and_b64 s[82:83], s[54:55], s[80:81]
    s_cbranch_scc1 L2_c95
L2_d95:
    v_mov_b64 v[84:85], v[70:71]
    v_mov_b32 v7, v93
    v_mov_b64 v[86:87], v[74:75]
    s_or_b64 s[80:81], s[80:81], s[54:55]
    s_mov_b64 exec, s[50:51]
    s_and_b64 s[82:83], s[50:51], s[80:81]
    s_cbranch_scc1 L2_c96
L2_d96:
    v_mov_b64 v[84:85], v[68:69]
    v_mov_b32 v7, v92
    v_mov_b64 v[86:87], v[72:73]
    s_mov_b64 exec, -1
    s_or_b64 s[80:81], s[80:81], s[50:51]
    ds_read_b64 v[70:71], v95 offset:65408
    ds_read_b64 v[68:69], v94 offset:65408
    s_waitcnt vmcnt(8)
    v_and_b32 v46, 0x20000000, v39
    v_lshrrev_b32 v47, 14, v35
    v_bitop3_b32 v47, v47, v5, v46 bitop3:0xea
    ds_read_b64 v[102:103], v47
    v_bitop3_b32 v93, v35, v5, v46 bitop3:0xea
    v_and_b32 v46, 0x10000000, v39
    v_lshrrev_b32 v47, 14, v34
    v_bitop3_b32 v47, v47, v5, v46 bitop3:0xea
    ds_read_b64 v[100:101], v47
    v_bitop3_b32 v92, v34, v5, v46 bitop3:0xea
    v_and_b32 v46, 0x80000000, v39
    v_lshrrev_b32 v47, 14, v37
    v_bitop3_b32 v47, v47, v5, v46 bitop3:0xea
    ds_read_b64 v[106:107], v47
    v_and_b32 v46, 0x40000000, v39
    v_lshrrev_b32 v47, 14, v36
    v_bitop3_b32 v47, v47, v5, v46 bitop3:0xea
    ds_read_b64 v[104:105], v47
    s_waitcnt lgkmcnt(4)
    v_mfma_f32_4x4x4_16b_bf16 v[80:83], v[10:11], v[70:71], v[80:83]
    v_mfma_f32_4x4x4_16b_bf16 v[76:79], v[10:11], v[68:69], v[76:79]
    v_perm_b32 v15, v35, v38, s45
    v_bitop3_b32 v46, v35, 0.5, -0.5 bitop3:0xa8
    v_perm_b32 v14, v34, v38, s44
    v_bitop3_b32 v47, v34, 0.5, -0.5 bitop3:0xa8
    v_cvt_pk_bf16_f32 v80, v80, v81
    v_cvt_pk_bf16_f32 v81, v82, v83
    ds_wrxchg_rtn_b64 v[74:75], v95, v[80:81] offset:65408
    v_cvt_pk_bf16_f32 v76, v76, v77
    v_cvt_pk_bf16_f32 v77, v78, v79
    ds_wrxchg_rtn_b64 v[72:73], v94, v[76:77] offset:65408
    s_waitcnt lgkmcnt(2)
    s_barrier
    s_setprio 3
    s_mov_b32 m0, s100
    s_nop 0
    ds_write_addtid_b32 v116 offset:32768
    ds_write_addtid_b32 v117 offset:33024
    ds_write_addtid_b32 v118 offset:33280
    ds_write_addtid_b32 v119 offset:33536
    buffer_load_dwordx4 v[116:119], v3, s[16:19], s40 offen offset:2048
    ds_write_addtid_b32 v120 offset:33792
    ds_write_addtid_b32 v121 offset:34048
    ds_write_addtid_b32 v122 offset:34304
    ds_write_addtid_b32 v123 offset:34560
    buffer_load_dwordx4 v[120:123], v3, s[16:19], s40 offen offset:3072
    v_mfma_f32_4x4x4_16b_bf16 v[80:83], v[8:9], v[102:103], 0
    v_mfma_f32_4x4x4_16b_bf16 v[76:79], v[8:9], v[100:101], 0
    v_bitop3_b32 v15, v6, v15, v46 bitop3:0xca
    v_bitop3_b32 v14, v6, v14, v47 bitop3:0xca
    v_cmp_lt_u32 s[84:85], v5, v92
    s_nop 0
    v_pk_mul_f32 v[80:81], v[80:81], v[14:15] op_sel:[0,1] op_sel_hi:[1,1]
    v_pk_mul_f32 v[82:83], v[82:83], v[14:15] op_sel:[0,1] op_sel_hi:[1,1]
    v_pk_mul_f32 v[76:77], v[76:77], v[14:15] op_sel:[0,0] op_sel_hi:[1,0]
    v_pk_mul_f32 v[78:79], v[78:79], v[14:15] op_sel:[0,0] op_sel_hi:[1,0]
    v_mov_b32 v44, v43
    s_cmp_gt_u32 s37, 1024
    s_cbranch_scc1 L2_xs97
    s_cmp_lg_u32 s101, 0
    s_cbranch_scc1 L2_xa97
L2_xb97:
    v_lshlrev_b32 v89, 16, v96
    v_add_u32 v90, 60, v97
    v_bitop3_b32 v90, v89, v45, v90 bitop3:0x6a
    ds_write_b32 v98, v90 offset:12
    v_lshlrev_b32 v89, 20, v96
    v_add_u32 v90, 40, v97
    v_bitop3_b32 v90, v89, v45, v90 bitop3:0x6a
    ds_write_b32 v98, v90 offset:8
    v_lshlrev_b32 v89, 24, v96
    v_add_u32 v90, 20, v97
    v_bitop3_b32 v90, v89, v45, v90 bitop3:0x6a
    ds_write_b32 v98, v90 offset:4
    v_lshlrev_b32 v89, 28, v96
    v_bitop3_b32 v90, v89, v45, v97 bitop3:0x6a
    ds_write_b32 v98, v90 offset:0
    v_mov_b32_dpp v91, v64 quad_perm:[1,1,1,1] row_mask:0xf bank_mask:0xf
    v_and_b32 v89, 3, v91
    v_and_b32 v97, 0xfffc, v91
    v_sub_u16_dpp v88, v64, v91 quad_perm:[3,3,3,3] row_mask:0xf bank_mask:0xf
    v_mad_u32_u24 v97, v97, 5, v4
    v_add_u32 v99, v88, v89
    v_bfm_b32 v96, v88, v89
    v_cmp_lt_u32 s[58:59], 16, v99
    v_lshlrev_b32 v89, v1, v96
    v_and_b32 v89, v45, v89
    v_cmp_ne_u32 vcc, 0, v89
    v_xor_b32 v90, v97, v89
    s_add_u32 s3, s37, s38
    v_mbcnt_lo_u32_b32 v98, vcc_lo, 0
    v_mbcnt_hi_u32_b32 v98, vcc_hi, v98
    s_bcnt1_i32_b64 s41, vcc
    v_lshl_add_u32 v98, v98, 2, s3
    s_mov_b64 exec, vcc
    ds_write_b32 v98, v90
    s_mov_b64 exec, -1
    s_lshl2_add_u32 s37, s41, s37
    s_cmp_lg_u64 s[58:59], 0
    s_cbranch_scc1 L2_xe97
L2_xr97:
    v_add_u32 v98, s37, v0
    v_mov_b32 v90, -1
    ds_write_b32 v98, v90
    ds_read2st64_b32 v[40:41], v0 offset0:0 offset1:1
    ds_read2st64_b32 v[42:43], v0 offset0:2 offset1:3
    s_sub_u32 s3, s37, 768
    s_cmp_gt_u32 s3, 256
    s_cbranch_scc1 L2_xf97
L2_xg97:
    s_setprio 2
    ds_write_addtid_b32 v124 offset:34816
    ds_write_addtid_b32 v125 offset:35072
    ds_write_addtid_b32 v126 offset:35328
    ds_write_addtid_b32 v127 offset:35584
    s_add_u32 s3, s40, 4096
    buffer_load_dwordx4 v[124:127], v3, s[16:19], s3 offen
    s_waitcnt lgkmcnt(14)
    v_cmp_ne_u64 s[50:51], v[72:73], v[68:69]
    v_cmpx_ne_u64 s[54:55], v[74:75], v[70:71]
    s_and_b64 s[82:83], s[54:55], s[80:81]
    s_cbranch_scc1 L2_c98
L2_d98:
    v_mov_b64 v[84:85], v[70:71]
    v_mov_b32 v7, v95
    v_mov_b64 v[86:87], v[74:75]
    s_or_b64 s[80:81], s[80:81], s[54:55]
    s_mov_b64 exec, s[50:51]
    s_and_b64 s[82:83], s[50:51], s[80:81]
    s_cbranch_scc1 L2_c99
L2_d99:
    v_mov_b64 v[84:85], v[68:69]
    v_mov_b32 v7, v94
    v_mov_b64 v[86:87], v[72:73]
    s_mov_b64 exec, -1
    s_or_b64 s[80:81], s[80:81], s[50:51]
    ds_read_b64 v[70:71], v93 offset:65408
    s_and_b64 exec, s[84:85], s[80:81]
    v_mfma_f32_4x4x4_16b_bf16 v[76:79], v[12:13], v[84:85], 0
    v_mov_b32 v92, v7
    s_andn2_b64 s[80:81], s[80:81], s[84:85]
    v_mfma_f32_4x4x4_16b_bf16 v[76:79], v[10:11], v[86:87], v[76:79]
    s_mov_b64 exec, -1
    ds_read_b64 v[68:69], v92 offset:65408
    s_setprio 1
    s_waitcnt vmcnt(10)
    s_mov_b32 m0, s38
    s_nop 0
    ds_write_addtid_b32 v108 offset:0
    ds_write_addtid_b32 v109 offset:256
    ds_write_addtid_b32 v110 offset:512
    ds_write_addtid_b32 v111 offset:768
    s_waitcnt lgkmcnt(4)
    v_mfma_f32_4x4x4_16b_bf16 v[80:83], v[10:11], v[70:71], v[80:83]
    v_mfma_f32_4x4x4_16b_bf16 v[76:79], v[10:11], v[68:69], v[76:79]
    v_and_b32 v46, 0x40000000, v39
    v_bitop3_b32 v94, v36, v5, v46 bitop3:0xea
    v_and_b32 v46, 0x80000000, v39
    v_bitop3_b32 v95, v37, v5, v46 bitop3:0xea
    v_perm_b32 v15, v37, v38, s47
    v_bitop3_b32 v46, v37, 0.5, -0.5 bitop3:0xa8
    v_perm_b32 v14, v36, v38, s46
    v_bitop3_b32 v47, v36, 0.5, -0.5 bitop3:0xa8
    v_cvt_pk_bf16_f32 v80, v80, v81
    v_cvt_pk_bf16_f32 v81, v82, v83
    ds_wrxchg_rtn_b64 v[74:75], v93, v[80:81] offset:65408
    v_cvt_pk_bf16_f32 v76, v76, v77
    v_cvt_pk_bf16_f32 v77, v78, v79
    ds_wrxchg_rtn_b64 v[72:73], v92, v[76:77] offset:65408
    v_and_b32 v88, 0x0fffffff, v44
    v_mov_b32 v39, v44
    buffer_load_dwordx2 v[34:35], v88, s[8:11], 0 offen
    buffer_load_dwordx3 v[36:38], v88, s[8:11], 0 offen offset:8
    s_setprio 0
    s_waitcnt vmcnt(11)
    ds_write_addtid_b32 v112 offset:1024
    ds_write_addtid_b32 v113 offset:1280
    ds_write_addtid_b32 v114 offset:1536
    ds_write_addtid_b32 v115 offset:1792
    v_mfma_f32_4x4x4_16b_bf16 v[80:83], v[8:9], v[106:107], 0
    v_mfma_f32_4x4x4_16b_bf16 v[76:79], v[8:9], v[104:105], 0
    v_bitop3_b32 v15, v6, v15, v46 bitop3:0xca
    v_bitop3_b32 v14, v6, v14, v47 bitop3:0xca
    s_nop 1
    v_pk_mul_f32 v[80:81], v[80:81], v[14:15] op_sel:[0,1] op_sel_hi:[1,1]
    v_pk_mul_f32 v[82:83], v[82:83], v[14:15] op_sel:[0,1] op_sel_hi:[1,1]
    v_pk_mul_f32 v[76:77], v[76:77], v[14:15] op_sel:[0,0] op_sel_hi:[1,0]
    v_pk_mul_f32 v[78:79], v[78:79], v[14:15] op_sel:[0,0] op_sel_hi:[1,0]
    s_add_u32 s42, s42, 1
    s_waitcnt lgkmcnt(0)
    s_barrier
    s_bitcmp1_b32 s36, s42
    s_cbranch_scc1 L2_slow
L2_ret5:
    s_setprio 3
    buffer_load_dwordx4 v[108:111], v3, s[16:19], s40 offen offset:0
    v_cmp_ne_u64 s[50:51], v[72:73], v[68:69]
    v_cmpx_ne_u64 s[54:55], v[74:75], v[70:71]
    s_and_b64 s[82:83], s[54:55], s[80:81]
    s_cbranch_scc1 L2_c100
L2_d100:
    v_mov_b64 v[84:85], v[70:71]
    v_mov_b32 v7, v93
    v_mov_b64 v[86:87], v[74:75]
    s_or_b64 s[80:81], s[80:81], s[54:55]
    s_mov_b64 exec, s[50:51]
    s_and_b64 s[82:83], s[50:51], s[80:81]
    s_cbranch_scc1 L2_c101
L2_d101:
    v_mov_b64 v[84:85], v[68:69]
    v_mov_b32 v7, v92
    v_mov_b64 v[86:87], v[72:73]
    s_mov_b64 exec, -1
    s_or_b64 s[80:81], s[80:81], s[50:51]
    ds_read_b64 v[70:71], v95 offset:65408
    ds_read_b64 v[68:69], v94 offset:65408
    s_waitcnt vmcnt(10)
    v_and_b32 v46, 0x20000000, v21
    v_lshrrev_b32 v47, 14, v17
    v_bitop3_b32 v47, v47, v5, v46 bitop3:0xea
    ds_read_b64 v[102:103], v47
    v_bitop3_b32 v93, v17, v5, v46 bitop3:0xea
    v_and_b32 v46, 0x10000000, v21
    v_lshrrev_b32 v47, 14, v16
    v_bitop3_b32 v47, v47, v5, v46 bitop3:0xea
    ds_read_b64 v[100:101], v47
    v_bitop3_b32 v92, v16, v5, v46 bitop3:0xea
    s_waitcnt lgkmcnt(2)
    v_mfma_f32_4x4x4_16b_bf16 v[80:83], v[10:11], v[70:71], v[80:83]
    v_mfma_f32_4x4x4_16b_bf16 v[76:79], v[10:11], v[68:69], v[76:79]
    v_perm_b32 v15, v17, v20, s45
    v_bitop3_b32 v46, v17, 0.5, -0.5 bitop3:0xa8
    v_perm_b32 v14, v16, v20, s44
    v_bitop3_b32 v47, v16, 0.5, -0.5 bitop3:0xa8
    v_cvt_pk_bf16_f32 v80, v80, v81
    v_cvt_pk_bf16_f32 v81, v82, v83
    ds_wrxchg_rtn_b64 v[74:75], v95, v[80:81] offset:65408
    v_cvt_pk_bf16_f32 v76, v76, v77
    v_cvt_pk_bf16_f32 v77, v78, v79
    ds_wrxchg_rtn_b64 v[72:73], v94, v[76:77] offset:65408
    s_waitcnt lgkmcnt(2)
    v_mfma_f32_4x4x4_16b_bf16 v[80:83], v[8:9], v[102:103], 0
    v_mfma_f32_4x4x4_16b_bf16 v[76:79], v[8:9], v[100:101], 0
    v_bitop3_b32 v15, v6, v15, v46 bitop3:0xca
    v_bitop3_b32 v14, v6, v14, v47 bitop3:0xca
    v_cmp_lt_u32 s[84:85], v5, v92
    s_nop 0
    v_pk_mul_f32 v[80:81], v[80:81], v[14:15] op_sel:[0,1] op_sel_hi:[1,1]
    v_pk_mul_f32 v[82:83], v[82:83], v[14:15] op_sel:[0,1] op_sel_hi:[1,1]
    v_pk_mul_f32 v[76:77], v[76:77], v[14:15] op_sel:[0,0] op_sel_hi:[1,0]
    v_pk_mul_f32 v[78:79], v[78:79], v[14:15] op_sel:[0,0] op_sel_hi:[1,0]
    buffer_load_dwordx4 v[112:115], v3, s[16:19], s40 offen offset:1024
    s_waitcnt lgkmcnt(0)
    v_cmp_ne_u64 s[50:51], v[72:73], v[68:69]
    v_cmpx_ne_u64 s[54:55], v[74:75], v[70:71]
    s_and_b64 s[82:83], s[54:55], s[80:81]
    s_cbranch_scc1 L2_c102
L2_d102:
    v_mov_b64 v[84:85], v[70:71]
    v_mov_b32 v7, v95
    v_mov_b64 v[86:87], v[74:75]
    s_or_b64 s[80:81], s[80:81], s[54:55]
    s_mov_b64 exec, s[50:51]
    s_and_b64 s[82:83], s[50:51], s[80:81]
    s_cbranch_scc1 L2_c103
L2_d103:
    v_mov_b64 v[84:85], v[68:69]
    v_mov_b32 v7, v94
    v_mov_b64 v[86:87], v[72:73]
    s_mov_b64 exec, -1
    s_or_b64 s[80:81], s[80:81], s[50:51]
    ds_read_b64 v[70:71], v93 offset:65408
    s_and_b64 exec, s[84:85], s[80:81]
    v_mfma_f32_4x4x4_16b_bf16 v[76:79], v[12:13], v[84:85], 0
    v_mov_b32 v92, v7
    s_andn2_b64 s[80:81], s[80:81], s[84:85]
    v_mfma_f32_4x4x4_16b_bf16 v[76:79], v[10:11], v[86:87], v[76:79]
    s_mov_b64 exec, -1
    ds_read_b64 v[68:69], v92 offset:65408
    v_and_b32 v46, 0x80000000, v21
    v_lshrrev_b32 v47, 14, v19
    v_bitop3_b32 v47, v47, v5, v46 bitop3:0xea
    ds_read_b64 v[106:107], v47
    v_bitop3_b32 v95, v19, v5, v46 bitop3:0xea
    v_and_b32 v46, 0x40000000, v21
    v_lshrrev_b32 v47, 14, v18
    v_bitop3_b32 v47, v47, v5, v46 bitop3:0xea
    ds_read_b64 v[104:105], v47
    v_bitop3_b32 v94, v18, v5, v46 bitop3:0xea
    s_waitcnt lgkmcnt(2)
    v_mfma_f32_4x4x4_16b_bf16 v[80:83], v[10:11], v[70:71], v[80:83]
    v_mfma_f32_4x4x4_16b_bf16 v[76:79], v[10:11], v[68:69], v[76:79]
    v_perm_b32 v15, v19, v20, s47
    v_bitop3_b32 v46, v19, 0.5, -0.5 bitop3:0xa8
    v_perm_b32 v14, v18, v20, s46
    v_bitop3_b32 v47, v18, 0.5, -0.5 bitop3:0xa8
    v_cvt_pk_bf16_f32 v80, v80, v81
    v_cvt_pk_bf16_f32 v81, v82, v83
    ds_wrxchg_rtn_b64 v[74:75], v93, v[80:81] offset:65408
    v_cvt_pk_bf16_f32 v76, v76, v77
    v_cvt_pk_bf16_f32 v77, v78, v79
    ds_wrxchg_rtn_b64 v[72:73], v92, v[76:77] offset:65408
    v_and_b32 v88, 0x0fffffff, v40
    v_mov_b32 v21, v40
    buffer_load_dwordx2 v[16:17], v88, s[8:11], 0 offen
    buffer_load_dwordx3 v[18:20], v88, s[8:11], 0 offen offset:8
    s_setprio 2
    s_waitcnt lgkmcnt(2)
    v_mfma_f32_4x4x4_16b_bf16 v[80:83], v[8:9], v[106:107], 0
    v_mfma_f32_4x4x4_16b_bf16 v[76:79], v[8:9], v[104:105], 0
    v_bitop3_b32 v15, v6, v15, v46 bitop3:0xca
    v_bitop3_b32 v14, v6, v14, v47 bitop3:0xca
    s_nop 1
    v_pk_mul_f32 v[80:81], v[80:81], v[14:15] op_sel:[0,1] op_sel_hi:[1,1]
    v_pk_mul_f32 v[82:83], v[82:83], v[14:15] op_sel:[0,1] op_sel_hi:[1,1]
    v_pk_mul_f32 v[76:77], v[76:77], v[14:15] op_sel:[0,0] op_sel_hi:[1,0]
    v_pk_mul_f32 v[78:79], v[78:79], v[14:15] op_sel:[0,0] op_sel_hi:[1,0]
    v_sub_u16 v88, v62, v54
    v_and_b32 v89, 3, v54
    v_add3_u32 v99, v88, v89, 3
    v_and_b32 v99, -4, v99
    v_max_u32 v99, 4, v99
    v_and_b32 v97, 0xfffc, v54
    v_bfm_b32 v96, v88, v89
    v_add_u32_dpp v91, v99, v99 row_shr:1 row_mask:0xf bank_mask:0xf bound_ctrl:1
    v_mad_u32_u24 v97, v97, 5, v2
    v_cmp_lt_u32 vcc, 16, v99
    v_add_u32_dpp v91, v91, v91 row_shr:2 row_mask:0xf bank_mask:0xf bound_ctrl:1
    v_sub_u32 v98, s38, v99
    v_lshrrev_b64 v[54:55], 16, v[54:55]
    v_add_u32_dpp v91, v91, v91 row_shr:4 row_mask:0xf bank_mask:0xf bound_ctrl:1
    v_lshrrev_b64 v[62:63], 16, v[62:63]
    s_mov_b32 s101, 0
    v_add_u32_dpp v91, v91, v91 row_shr:8 row_mask:0xf bank_mask:0xf bound_ctrl:1
    s_nop 1
    v_add_u32_dpp v91, v91, v91 row_bcast:15 row_mask:0xa bank_mask:0xf
    s_nop 1
    v_add_u32_dpp v91, v91, v91 row_bcast:31 row_mask:0xc bank_mask:0xf
    v_add_u32 v98, v98, v91
    v_readlane_b32 s37, v91, 63
    s_cbranch_vccnz L2_xo104
L2_xp104:
    s_waitcnt lgkmcnt(0)
    v_cmp_ne_u64 s[50:51], v[72:73], v[68:69]
    v_cmpx_ne_u64 s[54:55], v[74:75], v[70:71]
    s_and_b64 s[82:83], s[54:55], s[80:81]
    s_cbranch_scc1 L2_c105
L2_d105:
    v_mov_b64 v[84:85], v[70:71]
    v_mov_b32 v7, v93
    v_mov_b64 v[86:87], v[74:75]
    s_or_b64 s[80:81], s[80:81], s[54:55]
    s_mov_b64 exec, s[50:51]
    s_and_b64 s[82:83], s[50:51], s[80:81]
    s_cbranch_scc1 L2_c106
L2_d106:
    v_mov_b64 v[84:85], v[68:69]
    v_mov_b32 v7, v92
    v_mov_b64 v[86:87], v[72:73]
    s_mov_b64 exec, -1
    s_or_b64 s[80:81], s[80:81], s[50:51]
    ds_read_b64 v[70:71], v95 offset:65408
    ds_read_b64 v[68:69], v94 offset:65408
    s_waitcnt vmcnt(11)
    v_and_b32 v46, 0x20000000, v27
    v_lshrrev_b32 v47, 14, v23
    v_bitop3_b32 v47, v47, v5, v46 bitop3:0xea
    ds_read_b64 v[102:103], v47
    v_bitop3_b32 v93, v23, v5, v46 bitop3:0xea
    v_and_b32 v46, 0x10000000, v27
    v_lshrrev_b32 v47, 14, v22
    v_bitop3_b32 v47, v47, v5, v46 bitop3:0xea
    ds_read_b64 v[100:101], v47
    v_bitop3_b32 v92, v22, v5, v46 bitop3:0xea
    s_waitcnt lgkmcnt(2)
    v_mfma_f32_4x4x4_16b_bf16 v[80:83], v[10:11], v[70:71], v[80:83]
    v_mfma_f32_4x4x4_16b_bf16 v[76:79], v[10:11], v[68:69], v[76:79]
    v_perm_b32 v15, v23, v26, s45
    v_bitop3_b32 v46, v23, 0.5, -0.5 bitop3:0xa8
    v_perm_b32 v14, v22, v26, s44
    v_bitop3_b32 v47, v22, 0.5, -0.5 bitop3:0xa8
    v_cvt_pk_bf16_f32 v80, v80, v81
    v_cvt_pk_bf16_f32 v81, v82, v83
    ds_wrxchg_rtn_b64 v[74:75], v95, v[80:81] offset:65408
    v_cvt_pk_bf16_f32 v76, v76, v77
    v_cvt_pk_bf16_f32 v77, v78, v79
    ds_wrxchg_rtn_b64 v[72:73], v94, v[76:77] offset:65408
    s_waitcnt lgkmcnt(2)
    v_mfma_f32_4x4x4_16b_bf16 v[80:83], v[8:9], v[102:103], 0
    v_mfma_f32_4x4x4_16b_bf16 v[76:79], v[8:9], v[100:101], 0
    v_bitop3_b32 v15, v6, v15, v46 bitop3:0xca
    v_bitop3_b32 v14, v6, v14, v47 bitop3:0xca
    v_cmp_lt_u32 s[84:85], v5, v92
    s_nop 0
    v_pk_mul_f32 v[80:81], v[80:81], v[14:15] op_sel:[0,1] op_sel_hi:[1,1]
    v_pk_mul_f32 v[82:83], v[82:83], v[14:15] op_sel:[0,1] op_sel_hi:[1,1]
    v_pk_mul_f32 v[76:77], v[76:77], v[14:15] op_sel:[0,0] op_sel_hi:[1,0]
    v_pk_mul_f32 v[78:79], v[78:79], v[14:15] op_sel:[0,0] op_sel_hi:[1,0]
    s_waitcnt lgkmcnt(0)
    v_cmp_ne_u64 s[50:51], v[72:73], v[68:69]
    v_cmpx_ne_u64 s[54:55], v[74:75], v[70:71]
    s_and_b64 s[82:83], s[54:55], s[80:81]
    s_cbranch_scc1 L2_c107
L2_d107:
    v_mov_b64 v[84:85], v[70:71]
    v_mov_b32 v7, v95
    v_mov_b64 v[86:87], v[74:75]
    s_or_b64 s[80:81], s[80:81], s[54:55]
    s_mov_b64 exec, s[50:51]
    s_and_b64 s[82:83], s[50:51], s[80:81]
    s_cbranch_scc1 L2_c108
L2_d108:
    v_mov_b64 v[84:85], v[68:69]
    v_mov_b32 v7, v94
    v_mov_b64 v[86:87], v[72:73]
    s_mov_b64 exec, -1
    s_or_b64 s[80:81], s[80:81], s[50:51]
    ds_read_b64 v[70:71], v93 offset:65408
    s_and_b64 exec, s[84:85], s[80:81]
    v_mfma_f32_4x4x4_16b_bf16 v[76:79], v[12:13], v[84:85], 0
    v_mov_b32 v92, v7
    s_andn2_b64 s[80:81], s[80:81], s[84:85]
    v_mfma_f32_4x4x4_16b_bf16 v[76:79], v[10:11], v[86:87], v[76:79]
    s_mov_b64 exec, -1
    ds_read_b64 v[68:69], v92 offset:65408
    v_and_b32 v46, 0x80000000, v27
    v_lshrrev_b32 v47, 14, v25
    v_bitop3_b32 v47, v47, v5, v46 bitop3:0xea
    ds_read_b64 v[106:107], v47
    v_bitop3_b32 v95, v25, v5, v46 bitop3:0xea
    v_and_b32 v46, 0x40000000, v27
    v_lshrrev_b32 v47, 14, v24
    v_bitop3_b32 v47, v47, v5, v46 bitop3:0xea
    ds_read_b64 v[104:105], v47
    v_bitop3_b32 v94, v24, v5, v46 bitop3:0xea
    s_waitcnt lgkmcnt(2)
    v_mfma_f32_4x4x4_16b_bf16 v[80:83], v[10:11], v[70:71], v[80:83]
    v_mfma_f32_4x4x4_16b_bf16 v[76:79], v[10:11], v[68:69], v[76:79]
    v_perm_b32 v15, v25, v26, s47
    v_bitop3_b32 v46, v25, 0.5, -0.5 bitop3:0xa8
    v_perm_b32 v14, v24, v26, s46
    v_bitop3_b32 v47, v24, 0.5, -0.5 bitop3:0xa8
    v_cvt_pk_bf16_f32 v80, v80, v81
    v_cvt_pk_bf16_f32 v81, v82, v83
    ds_wrxchg_rtn_b64 v[74:75], v93, v[80:81] offset:65408
    v_cvt_pk_bf16_f32 v76, v76, v77
    v_cvt_pk_bf16_f32 v77, v78, v79
    ds_wrxchg_rtn_b64 v[72:73], v92, v[76:77] offset:65408
    v_and_b32 v88, 0x0fffffff, v41
    v_mov_b32 v27, v41
    buffer_load_dwordx2 v[22:23], v88, s[8:11], 0 offen
    buffer_load_dwordx3 v[24:26], v88, s[8:11], 0 offen offset:8
    s_setprio 1
    s_waitcnt lgkmcnt(2)
    v_mfma_f32_4x4x4_16b_bf16 v[80:83], v[8:9], v[106:107], 0
    v_mfma_f32_4x4x4_16b_bf16 v[76:79], v[8:9], v[104:105], 0
    v_bitop3_b32 v15, v6, v15, v46 bitop3:0xca
    v_bitop3_b32 v14, v6, v14, v47 bitop3:0xca
    s_nop 1
    v_pk_mul_f32 v[80:81], v[80:81], v[14:15] op_sel:[0,1] op_sel_hi:[1,1]
    v_pk_mul_f32 v[82:83], v[82:83], v[14:15] op_sel:[0,1] op_sel_hi:[1,1]
    v_pk_mul_f32 v[76:77], v[76:77], v[14:15] op_sel:[0,0] op_sel_hi:[1,0]
    v_pk_mul_f32 v[78:79], v[78:79], v[14:15] op_sel:[0,0] op_sel_hi:[1,0]
    s_waitcnt lgkmcnt(0)
    v_cmp_ne_u64 s[50:51], v[72:73], v[68:69]
    v_cmpx_ne_u64 s[54:55], v[74:75], v[70:71]
    s_and_b64 s[82:83], s[54:55], s[80:81]
    s_cbranch_scc1 L2_c109
L2_d109:
    v_mov_b64 v[84:85], v[70:71]
    v_mov_b32 v7, v93
    v_mov_b64 v[86:87], v[74:75]
    s_or_b64 s[80:81], s[80:81], s[54:55]
    s_mov_b64 exec, s[50:51]
    s_and_b64 s[82:83], s[50:51], s[80:81]
    s_cbranch_scc1 L2_c110
L2_d110:
    v_mov_b64 v[84:85], v[68:69]
    v_mov_b32 v7, v92
    v_mov_b64 v[86:87], v[72:73]
    s_mov_b64 exec, -1
    s_or_b64 s[80:81], s[80:81], s[50:51]
    ds_read_b64 v[70:71], v95 offset:65408
    ds_read_b64 v[68:69], v94 offset:65408
    s_waitcnt vmcnt(11)
    v_and_b32 v46, 0x20000000, v33
    v_lshrrev_b32 v47, 14, v29
    v_bitop3_b32 v47, v47, v5, v46 bitop3:0xea
    ds_read_b64 v[102:103], v47
    v_bitop3_b32 v93, v29, v5, v46 bitop3:0xea
    v_and_b32 v46, 0x10000000, v33
    v_lshrrev_b32 v47, 14, v28
    v_bitop3_b32 v47, v47, v5, v46 bitop3:0xea
    ds_read_b64 v[100:101], v47
    v_bitop3_b32 v92, v28, v5, v46 bitop3:0xea
    s_waitcnt lgkmcnt(2)
    v_mfma_f32_4x4x4_16b_bf16 v[80:83], v[10:11], v[70:71], v[80:83]
    v_mfma_f32_4x4x4_16b_bf16 v[76:79], v[10:11], v[68:69], v[76:79]
    v_perm_b32 v15, v29, v32, s45
    v_bitop3_b32 v46, v29, 0.5, -0.5 bitop3:0xa8
    v_perm_b32 v14, v28, v32, s44
    v_bitop3_b32 v47, v28, 0.5, -0.5 bitop3:0xa8
    v_cvt_pk_bf16_f32 v80, v80, v81
    v_cvt_pk_bf16_f32 v81, v82, v83
    ds_wrxchg_rtn_b64 v[74:75], v95, v[80:81] offset:65408
    v_cvt_pk_bf16_f32 v76, v76, v77
    v_cvt_pk_bf16_f32 v77, v78, v79
    ds_wrxchg_rtn_b64 v[72:73], v94, v[76:77] offset:65408
    s_waitcnt lgkmcnt(2)
    v_mfma_f32_4x4x4_16b_bf16 v[80:83], v[8:9], v[102:103], 0
    v_mfma_f32_4x4x4_16b_bf16 v[76:79], v[8:9], v[100:101], 0
    v_bitop3_b32 v15, v6, v15, v46 bitop3:0xca
    v_bitop3_b32 v14, v6, v14, v47 bitop3:0xca
    v_cmp_lt_u32 s[84:85], v5, v92
    s_nop 0
    v_pk_mul_f32 v[80:81], v[80:81], v[14:15] op_sel:[0,1] op_sel_hi:[1,1]
    v_pk_mul_f32 v[82:83], v[82:83], v[14:15] op_sel:[0,1] op_sel_hi:[1,1]
    v_pk_mul_f32 v[76:77], v[76:77], v[14:15] op_sel:[0,0] op_sel_hi:[1,0]
    v_pk_mul_f32 v[78:79], v[78:79], v[14:15] op_sel:[0,0] op_sel_hi:[1,0]
    s_waitcnt lgkmcnt(0)
    v_cmp_ne_u64 s[50:51], v[72:73], v[68:69]
    v_cmpx_ne_u64 s[54:55], v[74:75], v[70:71]
    s_and_b64 s[82:83], s[54:55], s[80:81]
    s_cbranch_scc1 L2_c111
L2_d111:
    v_mov_b64 v[84:85], v[70:71]
    v_mov_b32 v7, v95
    v_mov_b64 v[86:87], v[74:75]
    s_or_b64 s[80:81], s[80:81], s[54:55]
    s_mov_b64 exec, s[50:51]
    s_and_b64 s[82:83], s[50:51], s[80:81]
    s_cbranch_scc1 L2_c112
L2_d112:
    v_mov_b64 v[84:85], v[68:69]
    v_mov_b32 v7, v94
    v_mov_b64 v[86:87], v[72:73]
    s_mov_b64 exec, -1
    s_or_b64 s[80:81], s[80:81], s[50:51]
    ds_read_b64 v[70:71], v93 offset:65408
    s_and_b64 exec, s[84:85], s[80:81]
    v_mfma_f32_4x4x4_16b_bf16 v[76:79], v[12:13], v[84:85], 0
    v_mov_b32 v92, v7
    s_andn2_b64 s[80:81], s[80:81], s[84:85]
    v_mfma_f32_4x4x4_16b_bf16 v[76:79], v[10:11], v[86:87], v[76:79]
    s_mov_b64 exec, -1
    ds_read_b64 v[68:69], v92 offset:65408
    v_and_b32 v46, 0x80000000, v33
    v_lshrrev_b32 v47, 14, v31
    v_bitop3_b32 v47, v47, v5, v46 bitop3:0xea
    ds_read_b64 v[106:107], v47
    v_bitop3_b32 v95, v31, v5, v46 bitop3:0xea
    v_and_b32 v46, 0x40000000, v33
    v_lshrrev_b32 v47, 14, v30
    v_bitop3_b32 v47, v47, v5, v46 bitop3:0xea
    ds_read_b64 v[104:105], v47
    v_bitop3_b32 v94, v30, v5, v46 bitop3:0xea
    s_waitcnt lgkmcnt(2)
    v_mfma_f32_4x4x4_16b_bf16 v[80:83], v[10:11], v[70:71], v[80:83]
    v_mfma_f32_4x4x4_16b_bf16 v[76:79], v[10:11], v[68:69], v[76:79]
    v_perm_b32 v15, v31, v32, s47
    v_bitop3_b32 v46, v31, 0.5, -0.5 bitop3:0xa8
    v_perm_b32 v14, v30, v32, s46
    v_bitop3_b32 v47, v30, 0.5, -0.5 bitop3:0xa8
    v_cvt_pk_bf16_f32 v80, v80, v81
    v_cvt_pk_bf16_f32 v81, v82, v83
    ds_wrxchg_rtn_b64 v[74:75], v93, v[80:81] offset:65408
    v_cvt_pk_bf16_f32 v76, v76, v77
    v_cvt_pk_bf16_f32 v77, v78, v79
    ds_wrxchg_rtn_b64 v[72:73], v92, v[76:77] offset:65408
    v_and_b32 v88, 0x0fffffff, v42
    v_mov_b32 v33, v42
    buffer_load_dwordx2 v[28:29], v88, s[8:11], 0 offen
    buffer_load_dwordx3 v[30:32], v88, s[8:11], 0 offen offset:8
    s_setprio 0
    s_waitcnt lgkmcnt(2)
    v_mfma_f32_4x4x4_16b_bf16 v[80:83], v[8:9], v[106:107], 0
    v_mfma_f32_4x4x4_16b_bf16 v[76:79], v[8:9], v[104:105], 0
    v_bitop3_b32 v15, v6, v15, v46 bitop3:0xca
    v_bitop3_b32 v14, v6, v14, v47 bitop3:0xca
    s_nop 1
    v_pk_mul_f32 v[80:81], v[80:81], v[14:15] op_sel:[0,1] op_sel_hi:[1,1]
    v_pk_mul_f32 v[82:83], v[82:83], v[14:15] op_sel:[0,1] op_sel_hi:[1,1]
    v_pk_mul_f32 v[76:77], v[76:77], v[14:15] op_sel:[0,0] op_sel_hi:[1,0]
    v_pk_mul_f32 v[78:79], v[78:79], v[14:15] op_sel:[0,0] op_sel_hi:[1,0]
    s_add_u32 s40, s40, 0x50000
    s_waitcnt lgkmcnt(0)
    v_cmp_ne_u64 s[50:51], v[72:73], v[68:69]
    v_cmpx_ne_u64 s[54:55], v[74:75], v[70:71]
    s_and_b64 s[82:83], s[54:55], s[80:81]
    s_cbranch_scc1 L2_c113
L2_d113:
    v_mov_b64 v[84:85], v[70:71]
    v_mov_b32 v7, v93
    v_mov_b64 v[86:87], v[74:75]
    s_or_b64 s[80:81], s[80:81], s[54:55]
    s_mov_b64 exec, s[50:51]
    s_and_b64 s[82:83], s[50:51], s[80:81]
    s_cbranch_scc1 L2_c114
L2_d114:
    v_mov_b64 v[84:85], v[68:69]
    v_mov_b32 v7, v92
    v_mov_b64 v[86:87], v[72:73]
    s_mov_b64 exec, -1
    s_or_b64 s[80:81], s[80:81], s[50:51]
    ds_read_b64 v[70:71], v95 offset:65408
    ds_read_b64 v[68:69], v94 offset:65408
    s_waitcnt vmcnt(8)
    v_and_b32 v46, 0x20000000, v39
    v_lshrrev_b32 v47, 14, v35
    v_bitop3_b32 v47, v47, v5, v46 bitop3:0xea
    ds_read_b64 v[102:103], v47
    v_bitop3_b32 v93, v35, v5, v46 bitop3:0xea
    v_and_b32 v46, 0x10000000, v39
    v_lshrrev_b32 v47, 14, v34
    v_bitop3_b32 v47, v47, v5, v46 bitop3:0xea
    ds_read_b64 v[100:101], v47
    v_bitop3_b32 v92, v34, v5, v46 bitop3:0xea
    v_and_b32 v46, 0x80000000, v39
    v_lshrrev_b32 v47, 14, v37
    v_bitop3_b32 v47, v47, v5, v46 bitop3:0xea
    ds_read_b64 v[106:107], v47
    v_and_b32 v46, 0x40000000, v39
    v_lshrrev_b32 v47, 14, v36
    v_bitop3_b32 v47, v47, v5, v46 bitop3:0xea
    ds_read_b64 v[104:105], v47
    s_waitcnt lgkmcnt(4)
    v_mfma_f32_4x4x4_16b_bf16 v[80:83], v[10:11], v[70:71], v[80:83]
    v_mfma_f32_4x4x4_16b_bf16 v[76:79], v[10:11], v[68:69], v[76:79]
    v_perm_b32 v15, v35, v38, s45
    v_bitop3_b32 v46, v35, 0.5, -0.5 bitop3:0xa8
    v_perm_b32 v14, v34, v38, s44
    v_bitop3_b32 v47, v34, 0.5, -0.5 bitop3:0xa8
    v_cvt_pk_bf16_f32 v80, v80, v81
    v_cvt_pk_bf16_f32 v81, v82, v83
    ds_wrxchg_rtn_b64 v[74:75], v95, v[80:81] offset:65408
    v_cvt_pk_bf16_f32 v76, v76, v77
    v_cvt_pk_bf16_f32 v77, v78, v79
    ds_wrxchg_rtn_b64 v[72:73], v94, v[76:77] offset:65408
    s_waitcnt lgkmcnt(2)
    s_barrier
    s_setprio 3
    s_mov_b32 m0, s100
    s_nop 0
    ds_write_addtid_b32 v116 offset:32768
    ds_write_addtid_b32 v117 offset:33024
    ds_write_addtid_b32 v118 offset:33280
    ds_write_addtid_b32 v119 offset:33536
    buffer_load_dwordx4 v[116:119], v3, s[16:19], s40 offen offset:2048
    ds_write_addtid_b32 v120 offset:33792
    ds_write_addtid_b32 v121 offset:34048
    ds_write_addtid_b32 v122 offset:34304
    ds_write_addtid_b32 v123 offset:34560
    buffer_load_dwordx4 v[120:123], v3, s[16:19], s40 offen offset:3072
    v_mfma_f32_4x4x4_16b_bf16 v[80:83], v[8:9], v[102:103], 0
    v_mfma_f32_4x4x4_16b_bf16 v[76:79], v[8:9], v[100:101], 0
    v_bitop3_b32 v15, v6, v15, v46 bitop3:0xca
    v_bitop3_b32 v14, v6, v14, v47 bitop3:0xca
    v_cmp_lt_u32 s[84:85], v5, v92
    s_nop 0
    v_pk_mul_f32 v[80:81], v[80:81], v[14:15] op_sel:[0,1] op_sel_hi:[1,1]
    v_pk_mul_f32 v[82:83], v[82:83], v[14:15] op_sel:[0,1] op_sel_hi:[1,1]
    v_pk_mul_f32 v[76:77], v[76:77], v[14:15] op_sel:[0,0] op_sel_hi:[1,0]
    v_pk_mul_f32 v[78:79], v[78:79], v[14:15] op_sel:[0,0] op_sel_hi:[1,0]
    v_mov_b32 v44, v43
    s_cmp_gt_u32 s37, 1024
    s_cbranch_scc1 L2_xs115
    s_cmp_lg_u32 s101, 0
    s_cbranch_scc1 L2_xa115
L2_xb115:
    v_lshlrev_b32 v89, 16, v96
    v_add_u32 v90, 60, v97
    v_bitop3_b32 v90, v89, v45, v90 bitop3:0x6a
    ds_write_b32 v98, v90 offset:12
    v_lshlrev_b32 v89, 20, v96
    v_add_u32 v90, 40, v97
    v_bitop3_b32 v90, v89, v45, v90 bitop3:0x6a
    ds_write_b32 v98, v90 offset:8
    v_lshlrev_b32 v89, 24, v96
    v_add_u32 v90, 20, v97
    v_bitop3_b32 v90, v89, v45, v90 bitop3:0x6a
    ds_write_b32 v98, v90 offset:4
    v_lshlrev_b32 v89, 28, v96
    v_bitop3_b32 v90, v89, v45, v97 bitop3:0x6a
    ds_write_b32 v98, v90 offset:0
    v_mov_b32_dpp v91, v66 quad_perm:[1,1,1,1] row_mask:0xf bank_mask:0xf
    v_and_b32 v89, 3, v91
    v_and_b32 v97, 0xfffc, v91
    v_sub_u16_dpp v88, v66, v91 quad_perm:[3,3,3,3] row_mask:0xf bank_mask:0xf
    v_mad_u32_u24 v97, v97, 5, v4
    v_add_u32 v99, v88, v89
    v_bfm_b32 v96, v88, v89
    v_cmp_lt_u32 s[58:59], 16, v99
    v_lshlrev_b32 v89, v1, v96
    v_and_b32 v89, v45, v89
    v_cmp_ne_u32 vcc, 0, v89
    v_xor_b32 v90, v97, v89
    s_add_u32 s3, s37, s38
    v_mbcnt_lo_u32_b32 v98, vcc_lo, 0
    v_mbcnt_hi_u32_b32 v98, vcc_hi, v98
    s_bcnt1_i32_b64 s41, vcc
    v_lshl_add_u32 v98, v98, 2, s3
    s_mov_b64 exec, vcc
    ds_write_b32 v98, v90
    s_mov_b64 exec, -1
    s_lshl2_add_u32 s37, s41, s37
    s_cmp_lg_u64 s[58:59], 0
    s_cbranch_scc1 L2_xe115
L2_xr115:
    v_add_u32 v98, s37, v0
    v_mov_b32 v90, -1
    ds_write_b32 v98, v90
    ds_read2st64_b32 v[40:41], v0 offset0:0 offset1:1
    ds_read2st64_b32 v[42:43], v0 offset0:2 offset1:3
    s_sub_u32 s3, s37, 768
    s_cmp_gt_u32 s3, 256
    s_cbranch_scc1 L2_xf115
L2_xg115:
    v_lshrrev_b64 v[64:65], 16, v[64:65]
    v_lshrrev_b64 v[66:67], 16, v[66:67]
    s_setprio 2
    ds_write_addtid_b32 v124 offset:34816
    ds_write_addtid_b32 v125 offset:35072
    ds_write_addtid_b32 v126 offset:35328
    ds_write_addtid_b32 v127 offset:35584
    s_add_u32 s3, s40, 4096
    buffer_load_dwordx4 v[124:127], v3, s[16:19], s3 offen
    s_waitcnt lgkmcnt(14)
    v_cmp_ne_u64 s[50:51], v[72:73], v[68:69]
    v_cmpx_ne_u64 s[54:55], v[74:75], v[70:71]
    s_and_b64 s[82:83], s[54:55], s[80:81]
    s_cbranch_scc1 L2_c116
L2_d116:
    v_mov_b64 v[84:85], v[70:71]
    v_mov_b32 v7, v95
    v_mov_b64 v[86:87], v[74:75]
    s_or_b64 s[80:81], s[80:81], s[54:55]
    s_mov_b64 exec, s[50:51]
    s_and_b64 s[82:83], s[50:51], s[80:81]
    s_cbranch_scc1 L2_c117
L2_d117:
    v_mov_b64 v[84:85], v[68:69]
    v_mov_b32 v7, v94
    v_mov_b64 v[86:87], v[72:73]
    s_mov_b64 exec, -1
    s_or_b64 s[80:81], s[80:81], s[50:51]
    ds_read_b64 v[70:71], v93 offset:65408
    s_and_b64 exec, s[84:85], s[80:81]
    v_mfma_f32_4x4x4_16b_bf16 v[76:79], v[12:13], v[84:85], 0
    v_mov_b32 v92, v7
    s_andn2_b64 s[80:81], s[80:81], s[84:85]
    v_mfma_f32_4x4x4_16b_bf16 v[76:79], v[10:11], v[86:87], v[76:79]
    s_mov_b64 exec, -1
    ds_read_b64 v[68:69], v92 offset:65408
    s_setprio 1
    s_waitcnt vmcnt(10)
    s_mov_b32 m0, s38
    s_nop 0
    ds_write_addtid_b32 v108 offset:0
    ds_write_addtid_b32 v109 offset:256
    ds_write_addtid_b32 v110 offset:512
    ds_write_addtid_b32 v111 offset:768
    s_waitcnt lgkmcnt(4)
    v_mfma_f32_4x4x4_16b_bf16 v[80:83], v[10:11], v[70:71], v[80:83]
    v_mfma_f32_4x4x4_16b_bf16 v[76:79], v[10:11], v[68:69], v[76:79]
    v_and_b32 v46, 0x40000000, v39
    v_bitop3_b32 v94, v36, v5, v46 bitop3:0xea
    v_and_b32 v46, 0x80000000, v39
    v_bitop3_b32 v95, v37, v5, v46 bitop3:0xea
    v_perm_b32 v15, v37, v38, s47
    v_bitop3_b32 v46, v37, 0.5, -0.5 bitop3:0xa8
    v_perm_b32 v14, v36, v38, s46
    v_bitop3_b32 v47, v36, 0.5, -0.5 bitop3:0xa8
    v_cvt_pk_bf16_f32 v80, v80, v81
    v_cvt_pk_bf16_f32 v81, v82, v83
    ds_wrxchg_rtn_b64 v[74:75], v93, v[80:81] offset:65408
    v_cvt_pk_bf16_f32 v76, v76, v77
    v_cvt_pk_bf16_f32 v77, v78, v79
    ds_wrxchg_rtn_b64 v[72:73], v92, v[76:77] offset:65408
    v_and_b32 v88, 0x0fffffff, v44
    v_mov_b32 v39, v44
    buffer_load_dwordx2 v[34:35], v88, s[8:11], 0 offen
    buffer_load_dwordx3 v[36:38], v88, s[8:11], 0 offen offset:8
    s_setprio 0
    s_waitcnt vmcnt(11)
    ds_write_addtid_b32 v112 offset:1024
    ds_write_addtid_b32 v113 offset:1280
    ds_write_addtid_b32 v114 offset:1536
    ds_write_addtid_b32 v115 offset:1792
    v_mfma_f32_4x4x4_16b_bf16 v[80:83], v[8:9], v[106:107], 0
    v_mfma_f32_4x4x4_16b_bf16 v[76:79], v[8:9], v[104:105], 0
    v_bitop3_b32 v15, v6, v15, v46 bitop3:0xca
    v_bitop3_b32 v14, v6, v14, v47 bitop3:0xca
    s_nop 1
    v_pk_mul_f32 v[80:81], v[80:81], v[14:15] op_sel:[0,1] op_sel_hi:[1,1]
    v_pk_mul_f32 v[82:83], v[82:83], v[14:15] op_sel:[0,1] op_sel_hi:[1,1]
    v_pk_mul_f32 v[76:77], v[76:77], v[14:15] op_sel:[0,0] op_sel_hi:[1,0]
    v_pk_mul_f32 v[78:79], v[78:79], v[14:15] op_sel:[0,0] op_sel_hi:[1,0]
    s_add_u32 s42, s42, 1
    s_waitcnt lgkmcnt(0)
    s_cmp_lg_u32 s42, 14
    s_cbranch_scc1 L2_loop
    s_barrier
    s_bitcmp1_b32 s36, s42
    s_cbranch_scc1 L2_slow
L2_ret6:
    s_setprio 3
    buffer_load_dwordx4 v[108:111], v3, s[16:19], s40 offen offset:0
    v_cmp_ne_u64 s[50:51], v[72:73], v[68:69]
    v_cmpx_ne_u64 s[54:55], v[74:75], v[70:71]
    s_and_b64 s[82:83], s[54:55], s[80:81]
    s_cbranch_scc1 L2_c118
L2_d118:
    v_mov_b64 v[84:85], v[70:71]
    v_mov_b32 v7, v93
    v_mov_b64 v[86:87], v[74:75]
    s_or_b64 s[80:81], s[80:81], s[54:55]
    s_mov_b64 exec, s[50:51]
    s_and_b64 s[82:83], s[50:51], s[80:81]
    s_cbranch_scc1 L2_c119
L2_d119:
    v_mov_b64 v[84:85], v[68:69]
    v_mov_b32 v7, v92
    v_mov_b64 v[86:87], v[72:73]
    s_mov_b64 exec, -1
    s_or_b64 s[80:81], s[80:81], s[50:51]
    ds_read_b64 v[70:71], v95 offset:65408
    ds_read_b64 v[68:69], v94 offset:65408
    s_waitcnt vmcnt(10)
    v_and_b32 v46, 0x20000000, v21
    v_lshrrev_b32 v47, 14, v17
    v_bitop3_b32 v47, v47, v5, v46 bitop3:0xea
    ds_read_b64 v[102:103], v47
    v_bitop3_b32 v93, v17, v5, v46 bitop3:0xea
    v_and_b32 v46, 0x10000000, v21
    v_lshrrev_b32 v47, 14, v16
    v_bitop3_b32 v47, v47, v5, v46 bitop3:0xea
    ds_read_b64 v[100:101], v47
    v_bitop3_b32 v92, v16, v5, v46 bitop3:0xea
    s_waitcnt lgkmcnt(2)
    v_mfma_f32_4x4x4_16b_bf16 v[80:83], v[10:11], v[70:71], v[80:83]
    v_mfma_f32_4x4x4_16b_bf16 v[76:79], v[10:11], v[68:69], v[76:79]
    v_perm_b32 v15, v17, v20, s45
    v_bitop3_b32 v46, v17, 0.5, -0.5 bitop3:0xa8
    v_perm_b32 v14, v16, v20, s44
    v_bitop3_b32 v47, v16, 0.5, -0.5 bitop3:0xa8
    v_cvt_pk_bf16_f32 v80, v80, v81
    v_cvt_pk_bf16_f32 v81, v82, v83
    ds_wrxchg_rtn_b64 v[74:75], v95, v[80:81] offset:65408
    v_cvt_pk_bf16_f32 v76, v76, v77
    v_cvt_pk_bf16_f32 v77, v78, v79
    ds_wrxchg_rtn_b64 v[72:73], v94, v[76:77] offset:65408
    s_waitcnt lgkmcnt(2)
    v_mfma_f32_4x4x4_16b_bf16 v[80:83], v[8:9], v[102:103], 0
    v_mfma_f32_4x4x4_16b_bf16 v[76:79], v[8:9], v[100:101], 0
    v_bitop3_b32 v15, v6, v15, v46 bitop3:0xca
    v_bitop3_b32 v14, v6, v14, v47 bitop3:0xca
    v_cmp_lt_u32 s[84:85], v5, v92
    s_nop 0
    v_pk_mul_f32 v[80:81], v[80:81], v[14:15] op_sel:[0,1] op_sel_hi:[1,1]
    v_pk_mul_f32 v[82:83], v[82:83], v[14:15] op_sel:[0,1] op_sel_hi:[1,1]
    v_pk_mul_f32 v[76:77], v[76:77], v[14:15] op_sel:[0,0] op_sel_hi:[1,0]
    v_pk_mul_f32 v[78:79], v[78:79], v[14:15] op_sel:[0,0] op_sel_hi:[1,0]
    buffer_load_dwordx4 v[112:115], v3, s[16:19], s40 offen offset:1024
    s_waitcnt lgkmcnt(0)
    v_cmp_ne_u64 s[50:51], v[72:73], v[68:69]
    v_cmpx_ne_u64 s[54:55], v[74:75], v[70:71]
    s_and_b64 s[82:83], s[54:55], s[80:81]
    s_cbranch_scc1 L2_c120
L2_d120:
    v_mov_b64 v[84:85], v[70:71]
    v_mov_b32 v7, v95
    v_mov_b64 v[86:87], v[74:75]
    s_or_b64 s[80:81], s[80:81], s[54:55]
    s_mov_b64 exec, s[50:51]
    s_and_b64 s[82:83], s[50:51], s[80:81]
    s_cbranch_scc1 L2_c121
L2_d121:
    v_mov_b64 v[84:85], v[68:69]
    v_mov_b32 v7, v94
    v_mov_b64 v[86:87], v[72:73]
    s_mov_b64 exec, -1
    s_or_b64 s[80:81], s[80:81], s[50:51]
    ds_read_b64 v[70:71], v93 offset:65408
    s_and_b64 exec, s[84:85], s[80:81]
    v_mfma_f32_4x4x4_16b_bf16 v[76:79], v[12:13], v[84:85], 0
    v_mov_b32 v92, v7
    s_andn2_b64 s[80:81], s[80:81], s[84:85]
    v_mfma_f32_4x4x4_16b_bf16 v[76:79], v[10:11], v[86:87], v[76:79]
    s_mov_b64 exec, -1
    ds_read_b64 v[68:69], v92 offset:65408
    v_and_b32 v46, 0x80000000, v21
    v_lshrrev_b32 v47, 14, v19
    v_bitop3_b32 v47, v47, v5, v46 bitop3:0xea
    ds_read_b64 v[106:107], v47
    v_bitop3_b32 v95, v19, v5, v46 bitop3:0xea
    v_and_b32 v46, 0x40000000, v21
    v_lshrrev_b32 v47, 14, v18
    v_bitop3_b32 v47, v47, v5, v46 bitop3:0xea
    ds_read_b64 v[104:105], v47
    v_bitop3_b32 v94, v18, v5, v46 bitop3:0xea
    s_waitcnt lgkmcnt(2)
    v_mfma_f32_4x4x4_16b_bf16 v[80:83], v[10:11], v[70:71], v[80:83]
    v_mfma_f32_4x4x4_16b_bf16 v[76:79], v[10:11], v[68:69], v[76:79]
    v_perm_b32 v15, v19, v20, s47
    v_bitop3_b32 v46, v19, 0.5, -0.5 bitop3:0xa8
    v_perm_b32 v14, v18, v20, s46
    v_bitop3_b32 v47, v18, 0.5, -0.5 bitop3:0xa8
    v_cvt_pk_bf16_f32 v80, v80, v81
    v_cvt_pk_bf16_f32 v81, v82, v83
    ds_wrxchg_rtn_b64 v[74:75], v93, v[80:81] offset:65408
    v_cvt_pk_bf16_f32 v76, v76, v77
    v_cvt_pk_bf16_f32 v77, v78, v79
    ds_wrxchg_rtn_b64 v[72:73], v92, v[76:77] offset:65408
    v_and_b32 v88, 0x0fffffff, v40
    v_mov_b32 v21, v40
    buffer_load_dwordx2 v[16:17], v88, s[8:11], 0 offen
    buffer_load_dwordx3 v[18:20], v88, s[8:11], 0 offen offset:8
    s_setprio 2
    s_waitcnt lgkmcnt(2)
    v_mfma_f32_4x4x4_16b_bf16 v[80:83], v[8:9], v[106:107], 0
    v_mfma_f32_4x4x4_16b_bf16 v[76:79], v[8:9], v[104:105], 0
    v_bitop3_b32 v15, v6, v15, v46 bitop3:0xca
    v_bitop3_b32 v14, v6, v14, v47 bitop3:0xca
    s_nop 1
    v_pk_mul_f32 v[80:81], v[80:81], v[14:15] op_sel:[0,1] op_sel_hi:[1,1]
    v_pk_mul_f32 v[82:83], v[82:83], v[14:15] op_sel:[0,1] op_sel_hi:[1,1]
    v_pk_mul_f32 v[76:77], v[76:77], v[14:15] op_sel:[0,0] op_sel_hi:[1,0]
    v_pk_mul_f32 v[78:79], v[78:79], v[14:15] op_sel:[0,0] op_sel_hi:[1,0]
    s_waitcnt lgkmcnt(0)
    v_cmp_ne_u64 s[50:51], v[72:73], v[68:69]
    v_cmpx_ne_u64 s[54:55], v[74:75], v[70:71]
    s_and_b64 s[82:83], s[54:55], s[80:81]
    s_cbranch_scc1 L2_c122
L2_d122:
    v_mov_b64 v[84:85], v[70:71]
    v_mov_b32 v7, v93
    v_mov_b64 v[86:87], v[74:75]
    s_or_b64 s[80:81], s[80:81], s[54:55]
    s_mov_b64 exec, s[50:51]
    s_and_b64 s[82:83], s[50:51], s[80:81]
    s_cbranch_scc1 L2_c123
L2_d123:
    v_mov_b64 v[84:85], v[68:69]
    v_mov_b32 v7, v92
    v_mov_b64 v[86:87], v[72:73]
    s_mov_b64 exec, -1
    s_or_b64 s[80:81], s[80:81], s[50:51]
    ds_read_b64 v[70:71], v95 offset:65408
    ds_read_b64 v[68:69], v94 offset:65408
    s_waitcnt vmcnt(11)
    v_and_b32 v46, 0x20000000, v27
    v_lshrrev_b32 v47, 14, v23
    v_bitop3_b32 v47, v47, v5, v46 bitop3:0xea
    ds_read_b64 v[102:103], v47
    v_bitop3_b32 v93, v23, v5, v46 bitop3:0xea
    v_and_b32 v46, 0x10000000, v27
    v_lshrrev_b32 v47, 14, v22
    v_bitop3_b32 v47, v47, v5, v46 bitop3:0xea
    ds_read_b64 v[100:101], v47
    v_bitop3_b32 v92, v22, v5, v46 bitop3:0xea
    s_waitcnt lgkmcnt(2)
    v_mfma_f32_4x4x4_16b_bf16 v[80:83], v[10:11], v[70:71], v[80:83]
    v_mfma_f32_4x4x4_16b_bf16 v[76:79], v[10:11], v[68:69], v[76:79]
    v_perm_b32 v15, v23, v26, s45
    v_bitop3_b32 v46, v23, 0.5, -0.5 bitop3:0xa8
    v_perm_b32 v14, v22, v26, s44
    v_bitop3_b32 v47, v22, 0.5, -0.5 bitop3:0xa8
    v_cvt_pk_bf16_f32 v80, v80, v81
    v_cvt_pk_bf16_f32 v81, v82, v83
    ds_wrxchg_rtn_b64 v[74:75], v95, v[80:81] offset:65408
    v_cvt_pk_bf16_f32 v76, v76, v77
    v_cvt_pk_bf16_f32 v77, v78, v79
    ds_wrxchg_rtn_b64 v[72:73], v94, v[76:77] offset:65408
    s_waitcnt lgkmcnt(2)
    v_mfma_f32_4x4x4_16b_bf16 v[80:83], v[8:9], v[102:103], 0
    v_mfma_f32_4x4x4_16b_bf16 v[76:79], v[8:9], v[100:101], 0
    v_bitop3_b32 v15, v6, v15, v46 bitop3:0xca
    v_bitop3_b32 v14, v6, v14, v47 bitop3:0xca
    v_cmp_lt_u32 s[84:85], v5, v92
    s_nop 0
    v_pk_mul_f32 v[80:81], v[80:81], v[14:15] op_sel:[0,1] op_sel_hi:[1,1]
    v_pk_mul_f32 v[82:83], v[82:83], v[14:15] op_sel:[0,1] op_sel_hi:[1,1]
    v_pk_mul_f32 v[76:77], v[76:77], v[14:15] op_sel:[0,0] op_sel_hi:[1,0]
    v_pk_mul_f32 v[78:79], v[78:79], v[14:15] op_sel:[0,0] op_sel_hi:[1,0]
    s_waitcnt lgkmcnt(0)
    v_cmp_ne_u64 s[50:51], v[72:73], v[68:69]
    v_cmpx_ne_u64 s[54:55], v[74:75], v[70:71]
    s_and_b64 s[82:83], s[54:55], s[80:81]
    s_cbranch_scc1 L2_c124
L2_d124:
    v_mov_b64 v[84:85], v[70:71]
    v_mov_b32 v7, v95
    v_mov_b64 v[86:87], v[74:75]
    s_or_b64 s[80:81], s[80:81], s[54:55]
    s_mov_b64 exec, s[50:51]
    s_and_b64 s[82:83], s[50:51], s[80:81]
    s_cbranch_scc1 L2_c125
L2_d125:
    v_mov_b64 v[84:85], v[68:69]
    v_mov_b32 v7, v94
    v_mov_b64 v[86:87], v[72:73]
    s_mov_b64 exec, -1
    s_or_b64 s[80:81], s[80:81], s[50:51]
    ds_read_b64 v[70:71], v93 offset:65408
    s_and_b64 exec, s[84:85], s[80:81]
    v_mfma_f32_4x4x4_16b_bf16 v[76:79], v[12:13], v[84:85], 0
    v_mov_b32 v92, v7
    s_andn2_b64 s[80:81], s[80:81], s[84:85]
    v_mfma_f32_4x4x4_16b_bf16 v[76:79], v[10:11], v[86:87], v[76:79]
    s_mov_b64 exec, -1
    ds_read_b64 v[68:69], v92 offset:65408
    v_and_b32 v46, 0x80000000, v27
    v_lshrrev_b32 v47, 14, v25
    v_bitop3_b32 v47, v47, v5, v46 bitop3:0xea
    ds_read_b64 v[106:107], v47
    v_bitop3_b32 v95, v25, v5, v46 bitop3:0xea
    v_and_b32 v46, 0x40000000, v27
    v_lshrrev_b32 v47, 14, v24
    v_bitop3_b32 v47, v47, v5, v46 bitop3:0xea
    ds_read_b64 v[104:105], v47
    v_bitop3_b32 v94, v24, v5, v46 bitop3:0xea
    s_waitcnt lgkmcnt(2)
    v_mfma_f32_4x4x4_16b_bf16 v[80:83], v[10:11], v[70:71], v[80:83]
    v_mfma_f32_4x4x4_16b_bf16 v[76:79], v[10:11], v[68:69], v[76:79]
    v_perm_b32 v15, v25, v26, s47
    v_bitop3_b32 v46, v25, 0.5, -0.5 bitop3:0xa8
    v_perm_b32 v14, v24, v26, s46
    v_bitop3_b32 v47, v24, 0.5, -0.5 bitop3:0xa8
    v_cvt_pk_bf16_f32 v80, v80, v81
    v_cvt_pk_bf16_f32 v81, v82, v83
    ds_wrxchg_rtn_b64 v[74:75], v93, v[80:81] offset:65408
    v_cvt_pk_bf16_f32 v76, v76, v77
    v_cvt_pk_bf16_f32 v77, v78, v79
    ds_wrxchg_rtn_b64 v[72:73], v92, v[76:77] offset:65408
    v_and_b32 v88, 0x0fffffff, v41
    v_mov_b32 v27, v41
    buffer_load_dwordx2 v[22:23], v88, s[8:11], 0 offen
    buffer_load_dwordx3 v[24:26], v88, s[8:11], 0 offen offset:8
    s_setprio 1
    s_waitcnt lgkmcnt(2)
    v_mfma_f32_4x4x4_16b_bf16 v[80:83], v[8:9], v[106:107], 0
    v_mfma_f32_4x4x4_16b_bf16 v[76:79], v[8:9], v[104:105], 0
    v_bitop3_b32 v15, v6, v15, v46 bitop3:0xca
    v_bitop3_b32 v14, v6, v14, v47 bitop3:0xca
    s_nop 1
    v_pk_mul_f32 v[80:81], v[80:81], v[14:15] op_sel:[0,1] op_sel_hi:[1,1]
    v_pk_mul_f32 v[82:83], v[82:83], v[14:15] op_sel:[0,1] op_sel_hi:[1,1]
    v_pk_mul_f32 v[76:77], v[76:77], v[14:15] op_sel:[0,0] op_sel_hi:[1,0]
    v_pk_mul_f32 v[78:79], v[78:79], v[14:15] op_sel:[0,0] op_sel_hi:[1,0]
    s_waitcnt lgkmcnt(0)
    v_cmp_ne_u64 s[50:51], v[72:73], v[68:69]
    v_cmpx_ne_u64 s[54:55], v[74:75], v[70:71]
    s_and_b64 s[82:83], s[54:55], s[80:81]
    s_cbranch_scc1 L2_c126
L2_d126:
    v_mov_b64 v[84:85], v[70:71]
    v_mov_b32 v7, v93
    v_mov_b64 v[86:87], v[74:75]
    s_or_b64 s[80:81], s[80:81], s[54:55]
    s_mov_b64 exec, s[50:51]
    s_and_b64 s[82:83], s[50:51], s[80:81]
    s_cbranch_scc1 L2_c127
L2_d127:
    v_mov_b64 v[84:85], v[68:69]
    v_mov_b32 v7, v92
    v_mov_b64 v[86:87], v[72:73]
    s_mov_b64 exec, -1
    s_or_b64 s[80:81], s[80:81], s[50:51]
    ds_read_b64 v[70:71], v95 offset:65408
    ds_read_b64 v[68:69], v94 offset:65408
    s_waitcnt vmcnt(11)
    v_and_b32 v46, 0x20000000, v33
    v_lshrrev_b32 v47, 14, v29
    v_bitop3_b32 v47, v47, v5, v46 bitop3:0xea
    ds_read_b64 v[102:103], v47
    v_bitop3_b32 v93, v29, v5, v46 bitop3:0xea
    v_and_b32 v46, 0x10000000, v33
    v_lshrrev_b32 v47, 14, v28
    v_bitop3_b32 v47, v47, v5, v46 bitop3:0xea
    ds_read_b64 v[100:101], v47
    v_bitop3_b32 v92, v28, v5, v46 bitop3:0xea
    s_waitcnt lgkmcnt(2)
    v_mfma_f32_4x4x4_16b_bf16 v[80:83], v[10:11], v[70:71], v[80:83]
    v_mfma_f32_4x4x4_16b_bf16 v[76:79], v[10:11], v[68:69], v[76:79]
    v_perm_b32 v15, v29, v32, s45
    v_bitop3_b32 v46, v29, 0.5, -0.5 bitop3:0xa8
    v_perm_b32 v14, v28, v32, s44
    v_bitop3_b32 v47, v28, 0.5, -0.5 bitop3:0xa8
    v_cvt_pk_bf16_f32 v80, v80, v81
    v_cvt_pk_bf16_f32 v81, v82, v83
    ds_wrxchg_rtn_b64 v[74:75], v95, v[80:81] offset:65408
    v_cvt_pk_bf16_f32 v76, v76, v77
    v_cvt_pk_bf16_f32 v77, v78, v79
    ds_wrxchg_rtn_b64 v[72:73], v94, v[76:77] offset:65408
    s_waitcnt lgkmcnt(2)
    v_mfma_f32_4x4x4_16b_bf16 v[80:83], v[8:9], v[102:103], 0
    v_mfma_f32_4x4x4_16b_bf16 v[76:79], v[8:9], v[100:101], 0
    v_bitop3_b32 v15, v6, v15, v46 bitop3:0xca
    v_bitop3_b32 v14, v6, v14, v47 bitop3:0xca
    v_cmp_lt_u32 s[84:85], v5, v92
    s_nop 0
    v_pk_mul_f32 v[80:81], v[80:81], v[14:15] op_sel:[0,1] op_sel_hi:[1,1]
    v_pk_mul_f32 v[82:83], v[82:83], v[14:15] op_sel:[0,1] op_sel_hi:[1,1]
    v_pk_mul_f32 v[76:77], v[76:77], v[14:15] op_sel:[0,0] op_sel_hi:[1,0]
    v_pk_mul_f32 v[78:79], v[78:79], v[14:15] op_sel:[0,0] op_sel_hi:[1,0]
    s_waitcnt lgkmcnt(0)
    v_cmp_ne_u64 s[50:51], v[72:73], v[68:69]
    v_cmpx_ne_u64 s[54:55], v[74:75], v[70:71]
    s_and_b64 s[82:83], s[54:55], s[80:81]
    s_cbranch_scc1 L2_c128
L2_d128:
    v_mov_b64 v[84:85], v[70:71]
    v_mov_b32 v7, v95
    v_mov_b64 v[86:87], v[74:75]
    s_or_b64 s[80:81], s[80:81], s[54:55]
    s_mov_b64 exec, s[50:51]
    s_and_b64 s[82:83], s[50:51], s[80:81]
    s_cbranch_scc1 L2_c129
L2_d129:
    v_mov_b64 v[84:85], v[68:69]
    v_mov_b32 v7, v94
    v_mov_b64 v[86:87], v[72:73]
    s_mov_b64 exec, -1
    s_or_b64 s[80:81], s[80:81], s[50:51]
    ds_read_b64 v[70:71], v93 offset:65408
    s_and_b64 exec, s[84:85], s[80:81]
    v_mfma_f32_4x4x4_16b_bf16 v[76:79], v[12:13], v[84:85], 0
    v_mov_b32 v92, v7
    s_andn2_b64 s[80:81], s[80:81], s[84:85]
    v_mfma_f32_4x4x4_16b_bf16 v[76:79], v[10:11], v[86:87], v[76:79]
    s_mov_b64 exec, -1
    ds_read_b64 v[68:69], v92 offset:65408
    v_and_b32 v46, 0x80000000, v33
    v_lshrrev_b32 v47, 14, v31
    v_bitop3_b32 v47, v47, v5, v46 bitop3:0xea
    ds_read_b64 v[106:107], v47
    v_bitop3_b32 v95, v31, v5, v46 bitop3:0xea
    v_and_b32 v46, 0x40000000, v33
    v_lshrrev_b32 v47, 14, v30
    v_bitop3_b32 v47, v47, v5, v46 bitop3:0xea
    ds_read_b64 v[104:105], v47
    v_bitop3_b32 v94, v30, v5, v46 bitop3:0xea
    s_waitcnt lgkmcnt(2)
    v_mfma_f32_4x4x4_16b_bf16 v[80:83], v[10:11], v[70:71], v[80:83]
    v_mfma_f32_4x4x4_16b_bf16 v[76:79], v[10:11], v[68:69], v[76:79]
    v_perm_b32 v15, v31, v32, s47
    v_bitop3_b32 v46, v31, 0.5, -0.5 bitop3:0xa8
    v_perm_b32 v14, v30, v32, s46
    v_bitop3_b32 v47, v30, 0.5, -0.5 bitop3:0xa8
    v_cvt_pk_bf16_f32 v80, v80, v81
    v_cvt_pk_bf16_f32 v81, v82, v83
    ds_wrxchg_rtn_b64 v[74:75], v93, v[80:81] offset:65408
    v_cvt_pk_bf16_f32 v76, v76, v77
    v_cvt_pk_bf16_f32 v77, v78, v79
    ds_wrxchg_rtn_b64 v[72:73], v92, v[76:77] offset:65408
    v_and_b32 v88, 0x0fffffff, v42
    v_mov_b32 v33, v42
    buffer_load_dwordx2 v[28:29], v88, s[8:11], 0 offen
    buffer_load_dwordx3 v[30:32], v88, s[8:11], 0 offen offset:8
    s_setprio 0
    s_waitcnt lgkmcnt(2)
    v_mfma_f32_4x4x4_16b_bf16 v[80:83], v[8:9], v[106:107], 0
    v_mfma_f32_4x4x4_16b_bf16 v[76:79], v[8:9], v[104:105], 0
    v_bitop3_b32 v15, v6, v15, v46 bitop3:0xca
    v_bitop3_b32 v14, v6, v14, v47 bitop3:0xca
    s_nop 1
    v_pk_mul_f32 v[80:81], v[80:81], v[14:15] op_sel:[0,1] op_sel_hi:[1,1]
    v_pk_mul_f32 v[82:83], v[82:83], v[14:15] op_sel:[0,1] op_sel_hi:[1,1]
    v_pk_mul_f32 v[76:77], v[76:77], v[14:15] op_sel:[0,0] op_sel_hi:[1,0]
    v_pk_mul_f32 v[78:79], v[78:79], v[14:15] op_sel:[0,0] op_sel_hi:[1,0]
    s_add_u32 s40, s40, 0xfff24000
    s_waitcnt lgkmcnt(0)
    v_cmp_ne_u64 s[50:51], v[72:73], v[68:69]
    v_cmpx_ne_u64 s[54:55], v[74:75], v[70:71]
    s_and_b64 s[82:83], s[54:55], s[80:81]
    s_cbranch_scc1 L2_c130
L2_d130:
    v_mov_b64 v[84:85], v[70:71]
    v_mov_b32 v7, v93
    v_mov_b64 v[86:87], v[74:75]
    s_or_b64 s[80:81], s[80:81], s[54:55]
    s_mov_b64 exec, s[50:51]
    s_and_b64 s[82:83], s[50:51], s[80:81]
    s_cbranch_scc1 L2_c131
L2_d131:
    v_mov_b64 v[84:85], v[68:69]
    v_mov_b32 v7, v92
    v_mov_b64 v[86:87], v[72:73]
    s_mov_b64 exec, -1
    s_or_b64 s[80:81], s[80:81], s[50:51]
    ds_read_b64 v[70:71], v95 offset:65408
    ds_read_b64 v[68:69], v94 offset:65408
    s_waitcnt vmcnt(8)
    v_and_b32 v46, 0x20000000, v39
    v_lshrrev_b32 v47, 14, v35
    v_bitop3_b32 v47, v47, v5, v46 bitop3:0xea
    ds_read_b64 v[102:103], v47
    v_bitop3_b32 v93, v35, v5, v46 bitop3:0xea
    v_and_b32 v46, 0x10000000, v39
    v_lshrrev_b32 v47, 14, v34
    v_bitop3_b32 v47, v47, v5, v46 bitop3:0xea
    ds_read_b64 v[100:101], v47
    v_bitop3_b32 v92, v34, v5, v46 bitop3:0xea
    v_and_b32 v46, 0x80000000, v39
    v_lshrrev_b32 v47, 14, v37
    v_bitop3_b32 v47, v47, v5, v46 bitop3:0xea
    ds_read_b64 v[106:107], v47
    v_and_b32 v46, 0x40000000, v39
    v_lshrrev_b32 v47, 14, v36
    v_bitop3_b32 v47, v47, v5, v46 bitop3:0xea
    ds_read_b64 v[104:105], v47
    s_waitcnt lgkmcnt(4)
    v_mfma_f32_4x4x4_16b_bf16 v[80:83], v[10:11], v[70:71], v[80:83]
    v_mfma_f32_4x4x4_16b_bf16 v[76:79], v[10:11], v[68:69], v[76:79]
    v_perm_b32 v15, v35, v38, s45
    v_bitop3_b32 v46, v35, 0.5, -0.5 bitop3:0xa8
    v_perm_b32 v14, v34, v38, s44
    v_bitop3_b32 v47, v34, 0.5, -0.5 bitop3:0xa8
    v_cvt_pk_bf16_f32 v80, v80, v81
    v_cvt_pk_bf16_f32 v81, v82, v83
    ds_wrxchg_rtn_b64 v[74:75], v95, v[80:81] offset:65408
    v_cvt_pk_bf16_f32 v76, v76, v77
    v_cvt_pk_bf16_f32 v77, v78, v79
    ds_wrxchg_rtn_b64 v[72:73], v94, v[76:77] offset:65408
    s_waitcnt lgkmcnt(2)
    s_barrier
    s_setprio 3
    s_mov_b32 m0, s100
    s_nop 0
    ds_write_addtid_b32 v116 offset:32768
    ds_write_addtid_b32 v117 offset:33024
    ds_write_addtid_b32 v118 offset:33280
    ds_write_addtid_b32 v119 offset:33536
    ds_write_addtid_b32 v120 offset:33792
    ds_write_addtid_b32 v121 offset:34048
    ds_write_addtid_b32 v122 offset:34304
    ds_write_addtid_b32 v123 offset:34560
    v_mfma_f32_4x4x4_16b_bf16 v[80:83], v[8:9], v[102:103], 0
    v_mfma_f32_4x4x4_16b_bf16 v[76:79], v[8:9], v[100:101], 0
    v_bitop3_b32 v15, v6, v15, v46 bitop3:0xca
    v_bitop3_b32 v14, v6, v14, v47 bitop3:0xca
    v_cmp_lt_u32 s[84:85], v5, v92
    s_nop 0
    v_pk_mul_f32 v[80:81], v[80:81], v[14:15] op_sel:[0,1] op_sel_hi:[1,1]
    v_pk_mul_f32 v[82:83], v[82:83], v[14:15] op_sel:[0,1] op_sel_hi:[1,1]
    v_pk_mul_f32 v[76:77], v[76:77], v[14:15] op_sel:[0,0] op_sel_hi:[1,0]
    v_pk_mul_f32 v[78:79], v[78:79], v[14:15] op_sel:[0,0] op_sel_hi:[1,0]
    v_mov_b32 v44, v43
    s_setprio 2
    ds_write_addtid_b32 v124 offset:34816
    ds_write_addtid_b32 v125 offset:35072
    ds_write_addtid_b32 v126 offset:35328
    ds_write_addtid_b32 v127 offset:35584
    s_waitcnt lgkmcnt(12)
    v_cmp_ne_u64 s[50:51], v[72:73], v[68:69]
    v_cmpx_ne_u64 s[54:55], v[74:75], v[70:71]
    s_and_b64 s[82:83], s[54:55], s[80:81]
    s_cbranch_scc1 L2_c132
L2_d132:
    v_mov_b64 v[84:85], v[70:71]
    v_mov_b32 v7, v95
    v_mov_b64 v[86:87], v[74:75]
    s_or_b64 s[80:81], s[80:81], s[54:55]
    s_mov_b64 exec, s[50:51]
    s_and_b64 s[82:83], s[50:51], s[80:81]
    s_cbranch_scc1 L2_c133
L2_d133:
    v_mov_b64 v[84:85], v[68:69]
    v_mov_b32 v7, v94
    v_mov_b64 v[86:87], v[72:73]
    s_mov_b64 exec, -1
    s_or_b64 s[80:81], s[80:81], s[50:51]
    ds_read_b64 v[70:71], v93 offset:65408
    s_and_b64 exec, s[84:85], s[80:81]
    v_mfma_f32_4x4x4_16b_bf16 v[76:79], v[12:13], v[84:85], 0
    v_mov_b32 v92, v7
    s_andn2_b64 s[80:81], s[80:81], s[84:85]
    v_mfma_f32_4x4x4_16b_bf16 v[76:79], v[10:11], v[86:87], v[76:79]
    s_mov_b64 exec, -1
    ds_read_b64 v[68:69], v92 offset:65408
    s_setprio 1
    s_waitcnt vmcnt(7)
    s_mov_b32 m0, s38
    s_nop 0
    ds_write_addtid_b32 v108 offset:0
    ds_write_addtid_b32 v109 offset:256
    ds_write_addtid_b32 v110 offset:512
    ds_write_addtid_b32 v111 offset:768
    s_waitcnt lgkmcnt(4)
    v_mfma_f32_4x4x4_16b_bf16 v[80:83], v[10:11], v[70:71], v[80:83]
    v_mfma_f32_4x4x4_16b_bf16 v[76:79], v[10:11], v[68:69], v[76:79]
    v_and_b32 v46, 0x40000000, v39
    v_bitop3_b32 v94, v36, v5, v46 bitop3:0xea
    v_and_b32 v46, 0x80000000, v39
    v_bitop3_b32 v95, v37, v5, v46 bitop3:0xea
    v_perm_b32 v15, v37, v38, s47
    v_bitop3_b32 v46, v37, 0.5, -0.5 bitop3:0xa8
    v_perm_b32 v14, v36, v38, s46
    v_bitop3_b32 v47, v36, 0.5, -0.5 bitop3:0xa8
    v_cvt_pk_bf16_f32 v80, v80, v81
    v_cvt_pk_bf16_f32 v81, v82, v83
    ds_wrxchg_rtn_b64 v[74:75], v93, v[80:81] offset:65408
    v_cvt_pk_bf16_f32 v76, v76, v77
    v_cvt_pk_bf16_f32 v77, v78, v79
    ds_wrxchg_rtn_b64 v[72:73], v92, v[76:77] offset:65408
    v_and_b32 v88, 0x0fffffff, v44
    v_mov_b32 v39, v44
    buffer_load_dwordx2 v[34:35], v88, s[8:11], 0 offen
    buffer_load_dwordx3 v[36:38], v88, s[8:11], 0 offen offset:8
    s_setprio 0
    s_waitcnt vmcnt(8)
    ds_write_addtid_b32 v112 offset:1024
    ds_write_addtid_b32 v113 offset:1280
    ds_write_addtid_b32 v114 offset:1536
    ds_write_addtid_b32 v115 offset:1792
    v_mfma_f32_4x4x4_16b_bf16 v[80:83], v[8:9], v[106:107], 0
    v_mfma_f32_4x4x4_16b_bf16 v[76:79], v[8:9], v[104:105], 0
    v_bitop3_b32 v15, v6, v15, v46 bitop3:0xca
    v_bitop3_b32 v14, v6, v14, v47 bitop3:0xca
    s_nop 1
    v_pk_mul_f32 v[80:81], v[80:81], v[14:15] op_sel:[0,1] op_sel_hi:[1,1]
    v_pk_mul_f32 v[82:83], v[82:83], v[14:15] op_sel:[0,1] op_sel_hi:[1,1]
    v_pk_mul_f32 v[76:77], v[76:77], v[14:15] op_sel:[0,0] op_sel_hi:[1,0]
    v_pk_mul_f32 v[78:79], v[78:79], v[14:15] op_sel:[0,0] op_sel_hi:[1,0]
    s_add_u32 s42, s42, 1
    s_waitcnt lgkmcnt(0)
    s_barrier
    s_bitcmp1_b32 s36, s42
    s_cbranch_scc1 L2_slow
L2_ret7:
    s_setprio 3
    v_cmp_ne_u64 s[50:51], v[72:73], v[68:69]
    v_cmpx_ne_u64 s[54:55], v[74:75], v[70:71]
    s_and_b64 s[82:83], s[54:55], s[80:81]
    s_cbranch_scc1 L2_c134
L2_d134:
    v_mov_b64 v[84:85], v[70:71]
    v_mov_b32 v7, v93
    v_mov_b64 v[86:87], v[74:75]
    s_or_b64 s[80:81], s[80:81], s[54:55]
    s_mov_b64 exec, s[50:51]
    s_and_b64 s[82:83], s[50:51], s[80:81]
    s_cbranch_scc1 L2_c135
L2_d135:
    v_mov_b64 v[84:85], v[68:69]
    v_mov_b32 v7, v92
    v_mov_b64 v[86:87], v[72:73]
    s_mov_b64 exec, -1
    s_or_b64 s[80:81], s[80:81], s[50:51]
    ds_read_b64 v[70:71], v95 offset:65408
    ds_read_b64 v[68:69], v94 offset:65408
    s_waitcnt vmcnt(6)
    v_and_b32 v46, 0x20000000, v21
    v_lshrrev_b32 v47, 14, v17
    v_bitop3_b32 v47, v47, v5, v46 bitop3:0xea
    ds_read_b64 v[102:103], v47
    v_bitop3_b32 v93, v17, v5, v46 bitop3:0xea
    v_and_b32 v46, 0x10000000, v21
    v_lshrrev_b32 v47, 14, v16
    v_bitop3_b32 v47, v47, v5, v46 bitop3:0xea
    ds_read_b64 v[100:101], v47
    v_bitop3_b32 v92, v16, v5, v46 bitop3:0xea
    s_waitcnt lgkmcnt(2)
    v_mfma_f32_4x4x4_16b_bf16 v[80:83], v[10:11], v[70:71], v[80:83]
    v_mfma_f32_4x4x4_16b_bf16 v[76:79], v[10:11], v[68:69], v[76:79]
    v_perm_b32 v15, v17, v20, s45
    v_bitop3_b32 v46, v17, 0.5, -0.5 bitop3:0xa8
    v_perm_b32 v14, v16, v20, s44
    v_bitop3_b32 v47, v16, 0.5, -0.5 bitop3:0xa8
    v_cvt_pk_bf16_f32 v80, v80, v81
    v_cvt_pk_bf16_f32 v81, v82, v83
    ds_wrxchg_rtn_b64 v[74:75], v95, v[80:81] offset:65408
    v_cvt_pk_bf16_f32 v76, v76, v77
    v_cvt_pk_bf16_f32 v77, v78, v79
    ds_wrxchg_rtn_b64 v[72:73], v94, v[76:77] offset:65408
    s_waitcnt lgkmcnt(2)
    v_mfma_f32_4x4x4_16b_bf16 v[80:83], v[8:9], v[102:103], 0
    v_mfma_f32_4x4x4_16b_bf16 v[76:79], v[8:9], v[100:101], 0
    v_bitop3_b32 v15, v6, v15, v46 bitop3:0xca
    v_bitop3_b32 v14, v6, v14, v47 bitop3:0xca
    v_cmp_lt_u32 s[84:85], v5, v92
    s_nop 0
    v_pk_mul_f32 v[80:81], v[80:81], v[14:15] op_sel:[0,1] op_sel_hi:[1,1]
    v_pk_mul_f32 v[82:83], v[82:83], v[14:15] op_sel:[0,1] op_sel_hi:[1,1]
    v_pk_mul_f32 v[76:77], v[76:77], v[14:15] op_sel:[0,0] op_sel_hi:[1,0]
    v_pk_mul_f32 v[78:79], v[78:79], v[14:15] op_sel:[0,0] op_sel_hi:[1,0]
    s_waitcnt lgkmcnt(0)
    v_cmp_ne_u64 s[50:51], v[72:73], v[68:69]
    v_cmpx_ne_u64 s[54:55], v[74:75], v[70:71]
    s_and_b64 s[82:83], s[54:55], s[80:81]
    s_cbranch_scc1 L2_c136
L2_d136:
    v_mov_b64 v[84:85], v[70:71]
    v_mov_b32 v7, v95
    v_mov_b64 v[86:87], v[74:75]
    s_or_b64 s[80:81], s[80:81], s[54:55]
    s_mov_b64 exec, s[50:51]
    s_and_b64 s[82:83], s[50:51], s[80:81]
    s_cbranch_scc1 L2_c137
L2_d137:
    v_mov_b64 v[84:85], v[68:69]
    v_mov_b32 v7, v94
    v_mov_b64 v[86:87], v[72:73]
    s_mov_b64 exec, -1
    s_or_b64 s[80:81], s[80:81], s[50:51]
    ds_read_b64 v[70:71], v93 offset:65408
    s_and_b64 exec, s[84:85], s[80:81]
    v_mfma_f32_4x4x4_16b_bf16 v[76:79], v[12:13], v[84:85], 0
    v_mov_b32 v92, v7
    s_andn2_b64 s[80:81], s[80:81], s[84:85]
    v_mfma_f32_4x4x4_16b_bf16 v[76:79], v[10:11], v[86:87], v[76:79]
    s_mov_b64 exec, -1
    ds_read_b64 v[68:69], v92 offset:65408
    v_and_b32 v46, 0x80000000, v21
    v_lshrrev_b32 v47, 14, v19
    v_bitop3_b32 v47, v47, v5, v46 bitop3:0xea
    ds_read_b64 v[106:107], v47
    v_bitop3_b32 v95, v19, v5, v46 bitop3:0xea
    v_and_b32 v46, 0x40000000, v21
    v_lshrrev_b32 v47, 14, v18
    v_bitop3_b32 v47, v47, v5, v46 bitop3:0xea
    ds_read_b64 v[104:105], v47
    v_bitop3_b32 v94, v18, v5, v46 bitop3:0xea
    s_waitcnt lgkmcnt(2)
    v_mfma_f32_4x4x4_16b_bf16 v[80:83], v[10:11], v[70:71], v[80:83]
    v_mfma_f32_4x4x4_16b_bf16 v[76:79], v[10:11], v[68:69], v[76:79]
    v_perm_b32 v15, v19, v20, s47
    v_bitop3_b32 v46, v19, 0.5, -0.5 bitop3:0xa8
    v_perm_b32 v14, v18, v20, s46
    v_bitop3_b32 v47, v18, 0.5, -0.5 bitop3:0xa8
    v_cvt_pk_bf16_f32 v80, v80, v81
    v_cvt_pk_bf16_f32 v81, v82, v83
    ds_wrxchg_rtn_b64 v[74:75], v93, v[80:81] offset:65408
    v_cvt_pk_bf16_f32 v76, v76, v77
    v_cvt_pk_bf16_f32 v77, v78, v79
    ds_wrxchg_rtn_b64 v[72:73], v92, v[76:77] offset:65408
    s_setprio 2
    s_waitcnt lgkmcnt(2)
    v_mfma_f32_4x4x4_16b_bf16 v[80:83], v[8:9], v[106:107], 0
    v_mfma_f32_4x4x4_16b_bf16 v[76:79], v[8:9], v[104:105], 0
    v_bitop3_b32 v15, v6, v15, v46 bitop3:0xca
    v_bitop3_b32 v14, v6, v14, v47 bitop3:0xca
    s_nop 1
    v_pk_mul_f32 v[80:81], v[80:81], v[14:15] op_sel:[0,1] op_sel_hi:[1,1]
    v_pk_mul_f32 v[82:83], v[82:83], v[14:15] op_sel:[0,1] op_sel_hi:[1,1]
    v_pk_mul_f32 v[76:77], v[76:77], v[14:15] op_sel:[0,0] op_sel_hi:[1,0]
    v_pk_mul_f32 v[78:79], v[78:79], v[14:15] op_sel:[0,0] op_sel_hi:[1,0]
    s_waitcnt lgkmcnt(0)
    v_cmp_ne_u64 s[50:51], v[72:73], v[68:69]
    v_cmpx_ne_u64 s[54:55], v[74:75], v[70:71]
    s_and_b64 s[82:83], s[54:55], s[80:81]
    s_cbranch_scc1 L2_c138
L2_d138:
    v_mov_b64 v[84:85], v[70:71]
    v_mov_b32 v7, v93
    v_mov_b64 v[86:87], v[74:75]
    s_or_b64 s[80:81], s[80:81], s[54:55]
    s_mov_b64 exec, s[50:51]
    s_and_b64 s[82:83], s[50:51], s[80:81]
    s_cbranch_scc1 L2_c139
L2_d139:
    v_mov_b64 v[84:85], v[68:69]
    v_mov_b32 v7, v92
    v_mov_b64 v[86:87], v[72:73]
    s_mov_b64 exec, -1
    s_or_b64 s[80:81], s[80:81], s[50:51]
    ds_read_b64 v[70:71], v95 offset:65408
    ds_read_b64 v[68:69], v94 offset:65408
    s_waitcnt vmcnt(4)
    v_and_b32 v46, 0x20000000, v27
    v_lshrrev_b32 v47, 14, v23
    v_bitop3_b32 v47, v47, v5, v46 bitop3:0xea
    ds_read_b64 v[102:103], v47
    v_bitop3_b32 v93, v23, v5, v46 bitop3:0xea
    v_and_b32 v46, 0x10000000, v27
    v_lshrrev_b32 v47, 14, v22
    v_bitop3_b32 v47, v47, v5, v46 bitop3:0xea
    ds_read_b64 v[100:101], v47
    v_bitop3_b32 v92, v22, v5, v46 bitop3:0xea
    s_waitcnt lgkmcnt(2)
    v_mfma_f32_4x4x4_16b_bf16 v[80:83], v[10:11], v[70:71], v[80:83]
    v_mfma_f32_4x4x4_16b_bf16 v[76:79], v[10:11], v[68:69], v[76:79]
    v_perm_b32 v15, v23, v26, s45
    v_bitop3_b32 v46, v23, 0.5, -0.5 bitop3:0xa8
    v_perm_b32 v14, v22, v26, s44
    v_bitop3_b32 v47, v22, 0.5, -0.5 bitop3:0xa8
    v_cvt_pk_bf16_f32 v80, v80, v81
    v_cvt_pk_bf16_f32 v81, v82, v83
    ds_wrxchg_rtn_b64 v[74:75], v95, v[80:81] offset:65408
    v_cvt_pk_bf16_f32 v76, v76, v77
    v_cvt_pk_bf16_f32 v77, v78, v79
    ds_wrxchg_rtn_b64 v[72:73], v94, v[76:77] offset:65408
    s_waitcnt lgkmcnt(2)
    v_mfma_f32_4x4x4_16b_bf16 v[80:83], v[8:9], v[102:103], 0
    v_mfma_f32_4x4x4_16b_bf16 v[76:79], v[8:9], v[100:101], 0
    v_bitop3_b32 v15, v6, v15, v46 bitop3:0xca
    v_bitop3_b32 v14, v6, v14, v47 bitop3:0xca
    v_cmp_lt_u32 s[84:85], v5, v92
    s_nop 0
    v_pk_mul_f32 v[80:81], v[80:81], v[14:15] op_sel:[0,1] op_sel_hi:[1,1]
    v_pk_mul_f32 v[82:83], v[82:83], v[14:15] op_sel:[0,1] op_sel_hi:[1,1]
    v_pk_mul_f32 v[76:77], v[76:77], v[14:15] op_sel:[0,0] op_sel_hi:[1,0]
    v_pk_mul_f32 v[78:79], v[78:79], v[14:15] op_sel:[0,0] op_sel_hi:[1,0]
    s_waitcnt lgkmcnt(0)
    v_cmp_ne_u64 s[50:51], v[72:73], v[68:69]
    v_cmpx_ne_u64 s[54:55], v[74:75], v[70:71]
    s_and_b64 s[82:83], s[54:55], s[80:81]
    s_cbranch_scc1 L2_c140
L2_d140:
    v_mov_b64 v[84:85], v[70:71]
    v_mov_b32 v7, v95
    v_mov_b64 v[86:87], v[74:75]
    s_or_b64 s[80:81], s[80:81], s[54:55]
    s_mov_b64 exec, s[50:51]
    s_and_b64 s[82:83], s[50:51], s[80:81]
    s_cbranch_scc1 L2_c141
L2_d141:
    v_mov_b64 v[84:85], v[68:69]
    v_mov_b32 v7, v94
    v_mov_b64 v[86:87], v[72:73]
    s_mov_b64 exec, -1
    s_or_b64 s[80:81], s[80:81], s[50:51]
    ds_read_b64 v[70:71], v93 offset:65408
    s_and_b64 exec, s[84:85], s[80:81]
    v_mfma_f32_4x4x4_16b_bf16 v[76:79], v[12:13], v[84:85], 0
    v_mov_b32 v92, v7
    s_andn2_b64 s[80:81], s[80:81], s[84:85]
    v_mfma_f32_4x4x4_16b_bf16 v[76:79], v[10:11], v[86:87], v[76:79]
    s_mov_b64 exec, -1
    ds_read_b64 v[68:69], v92 offset:65408
    v_and_b32 v46, 0x80000000, v27
    v_lshrrev_b32 v47, 14, v25
    v_bitop3_b32 v47, v47, v5, v46 bitop3:0xea
    ds_read_b64 v[106:107], v47
    v_bitop3_b32 v95, v25, v5, v46 bitop3:0xea
    v_and_b32 v46, 0x40000000, v27
    v_lshrrev_b32 v47, 14, v24
    v_bitop3_b32 v47, v47, v5, v46 bitop3:0xea
    ds_read_b64 v[104:105], v47
    v_bitop3_b32 v94, v24, v5, v46 bitop3:0xea
    s_waitcnt lgkmcnt(2)
    v_mfma_f32_4x4x4_16b_bf16 v[80:83], v[10:11], v[70:71], v[80:83]
    v_mfma_f32_4x4x4_16b_bf16 v[76:79], v[10:11], v[68:69], v[76:79]
    v_perm_b32 v15, v25, v26, s47
    v_bitop3_b32 v46, v25, 0.5, -0.5 bitop3:0xa8
    v_perm_b32 v14, v24, v26, s46
    v_bitop3_b32 v47, v24, 0.5, -0.5 bitop3:0xa8
    v_cvt_pk_bf16_f32 v80, v80, v81
    v_cvt_pk_bf16_f32 v81, v82, v83
    ds_wrxchg_rtn_b64 v[74:75], v93, v[80:81] offset:65408
    v_cvt_pk_bf16_f32 v76, v76, v77
    v_cvt_pk_bf16_f32 v77, v78, v79
    ds_wrxchg_rtn_b64 v[72:73], v92, v[76:77] offset:65408
    s_setprio 1
    s_waitcnt lgkmcnt(2)
    v_mfma_f32_4x4x4_16b_bf16 v[80:83], v[8:9], v[106:107], 0
    v_mfma_f32_4x4x4_16b_bf16 v[76:79], v[8:9], v[104:105], 0
    v_bitop3_b32 v15, v6, v15, v46 bitop3:0xca
    v_bitop3_b32 v14, v6, v14, v47 bitop3:0xca
    s_nop 1
    v_pk_mul_f32 v[80:81], v[80:81], v[14:15] op_sel:[0,1] op_sel_hi:[1,1]
    v_pk_mul_f32 v[82:83], v[82:83], v[14:15] op_sel:[0,1] op_sel_hi:[1,1]
    v_pk_mul_f32 v[76:77], v[76:77], v[14:15] op_sel:[0,0] op_sel_hi:[1,0]
    v_pk_mul_f32 v[78:79], v[78:79], v[14:15] op_sel:[0,0] op_sel_hi:[1,0]
    s_lshl_b32 s3, s32, 12
    v_subrev_u32 v122, s3, v3
    s_mul_i32 s3, s33, 20000
    v_add_u32 v118, s3, v122
    v_add_u32 v119, 0x4000, v118
    s_lshl_b32 s3, s34, 7
    v_lshrrev_b32 v123, 7, v118
    v_and_b32 v120, 0x70, v118
    v_lshl_add_u32 v120, v123, 13, v120
    v_add_u32 v120, s3, v120
    v_lshrrev_b32 v123, 7, v119
    v_and_b32 v121, 0x70, v119
    v_lshl_add_u32 v121, v123, 13, v121
    v_add_u32 v121, s3, v121
    v_cmp_le_u32 vcc, 3616, v122
    s_mov_b64 exec, vcc
    v_mov_b32 v119, 2.0
    v_mov_b32 v121, 2.0
    s_mov_b64 exec, -1
    v_and_b32 v123, 0x30, v122
    v_lshlrev_b32 v123, 2, v123
    buffer_load_dwordx4 v[48:51], v123, s[24:27], 0 offen
    buffer_load_dwordx4 v[52:55], v123, s[24:27], 0 offen offset:16
    buffer_load_dwordx2 v[56:57], v123, s[24:27], 0 offen offset:32
    s_mov_b32 s12, s4
    s_mov_b32 s13, s5
    s_mov_b32 s14, 0x138800
    s_mov_b32 s15, 0x20000
    s_mov_b32 s16, s28
    s_mov_b32 s17, s29
    s_mov_b32 s18, 0x4e2000
    s_mov_b32 s19, 0x20000
    v_lshrrev_b32 v123, 2, v120
    buffer_load_dword v116, v123, s[12:15], 0 offen
    buffer_load_dwordx4 v[108:111], v120, s[16:19], 0 offen
    v_lshrrev_b32 v123, 2, v121
    buffer_load_dword v117, v123, s[12:15], 0 offen
    buffer_load_dwordx4 v[112:115], v121, s[16:19], 0 offen
    s_waitcnt lgkmcnt(0)
    v_cmp_ne_u64 s[50:51], v[72:73], v[68:69]
    v_cmpx_ne_u64 s[54:55], v[74:75], v[70:71]
    s_and_b64 s[82:83], s[54:55], s[80:81]
    s_cbranch_scc1 L2_c142
L2_d142:
    v_mov_b64 v[84:85], v[70:71]
    v_mov_b32 v7, v93
    v_mov_b64 v[86:87], v[74:75]
    s_or_b64 s[80:81], s[80:81], s[54:55]
    s_mov_b64 exec, s[50:51]
    s_and_b64 s[82:83], s[50:51], s[80:81]
    s_cbranch_scc1 L2_c143
L2_d143:
    v_mov_b64 v[84:85], v[68:69]
    v_mov_b32 v7, v92
    v_mov_b64 v[86:87], v[72:73]
    s_mov_b64 exec, -1
    s_or_b64 s[80:81], s[80:81], s[50:51]
    ds_read_b64 v[70:71], v95 offset:65408
    ds_read_b64 v[68:69], v94 offset:65408
    s_waitcnt vmcnt(9)
    v_and_b32 v46, 0x20000000, v33
    v_lshrrev_b32 v47, 14, v29
    v_bitop3_b32 v47, v47, v5, v46 bitop3:0xea
    ds_read_b64 v[102:103], v47
    v_bitop3_b32 v93, v29, v5, v46 bitop3:0xea
    v_and_b32 v46, 0x10000000, v33
    v_lshrrev_b32 v47, 14, v28
    v_bitop3_b32 v47, v47, v5, v46 bitop3:0xea
    ds_read_b64 v[100:101], v47
    v_bitop3_b32 v92, v28, v5, v46 bitop3:0xea
    s_waitcnt lgkmcnt(2)
    v_mfma_f32_4x4x4_16b_bf16 v[80:83], v[10:11], v[70:71], v[80:83]
    v_mfma_f32_4x4x4_16b_bf16 v[76:79], v[10:11], v[68:69], v[76:79]
    v_perm_b32 v15, v29, v32, s45
    v_bitop3_b32 v46, v29, 0.5, -0.5 bitop3:0xa8
    v_perm_b32 v14, v28, v32, s44
    v_bitop3_b32 v47, v28, 0.5, -0.5 bitop3:0xa8
    v_cvt_pk_bf16_f32 v80, v80, v81
    v_cvt_pk_bf16_f32 v81, v82, v83
    ds_wrxchg_rtn_b64 v[74:75], v95, v[80:81] offset:65408
    v_cvt_pk_bf16_f32 v76, v76, v77
    v_cvt_pk_bf16_f32 v77, v78, v79
    ds_wrxchg_rtn_b64 v[72:73], v94, v[76:77] offset:65408
    s_waitcnt lgkmcnt(2)
    v_mfma_f32_4x4x4_16b_bf16 v[80:83], v[8:9], v[102:103], 0
    v_mfma_f32_4x4x4_16b_bf16 v[76:79], v[8:9], v[100:101], 0
    v_bitop3_b32 v15, v6, v15, v46 bitop3:0xca
    v_bitop3_b32 v14, v6, v14, v47 bitop3:0xca
    v_cmp_lt_u32 s[84:85], v5, v92
    s_nop 0
    v_pk_mul_f32 v[80:81], v[80:81], v[14:15] op_sel:[0,1] op_sel_hi:[1,1]
    v_pk_mul_f32 v[82:83], v[82:83], v[14:15] op_sel:[0,1] op_sel_hi:[1,1]
    v_pk_mul_f32 v[76:77], v[76:77], v[14:15] op_sel:[0,0] op_sel_hi:[1,0]
    v_pk_mul_f32 v[78:79], v[78:79], v[14:15] op_sel:[0,0] op_sel_hi:[1,0]
    s_waitcnt lgkmcnt(0)
    v_cmp_ne_u64 s[50:51], v[72:73], v[68:69]
    v_cmpx_ne_u64 s[54:55], v[74:75], v[70:71]
    s_and_b64 s[82:83], s[54:55], s[80:81]
    s_cbranch_scc1 L2_c144
L2_d144:
    v_mov_b64 v[84:85], v[70:71]
    v_mov_b32 v7, v95
    v_mov_b64 v[86:87], v[74:75]
    s_or_b64 s[80:81], s[80:81], s[54:55]
    s_mov_b64 exec, s[50:51]
    s_and_b64 s[82:83], s[50:51], s[80:81]
    s_cbranch_scc1 L2_c145
L2_d145:
    v_mov_b64 v[84:85], v[68:69]
    v_mov_b32 v7, v94
    v_mov_b64 v[86:87], v[72:73]
    s_mov_b64 exec, -1
    s_or_b64 s[80:81], s[80:81], s[50:51]
    ds_read_b64 v[70:71], v93 offset:65408
    s_and_b64 exec, s[84:85], s[80:81]
    v_mfma_f32_4x4x4_16b_bf16 v[76:79], v[12:13], v[84:85], 0
    v_mov_b32 v92, v7
    s_andn2_b64 s[80:81], s[80:81], s[84:85]
    v_mfma_f32_4x4x4_16b_bf16 v[76:79], v[10:11], v[86:87], v[76:79]
    s_mov_b64 exec, -1
    ds_read_b64 v[68:69], v92 offset:65408
    v_and_b32 v46, 0x80000000, v33
    v_lshrrev_b32 v47, 14, v31
    v_bitop3_b32 v47, v47, v5, v46 bitop3:0xea
    ds_read_b64 v[106:107], v47
    v_bitop3_b32 v95, v31, v5, v46 bitop3:0xea
    v_and_b32 v46, 0x40000000, v33
    v_lshrrev_b32 v47, 14, v30
    v_bitop3_b32 v47, v47, v5, v46 bitop3:0xea
    ds_read_b64 v[104:105], v47
    v_bitop3_b32 v94, v30, v5, v46 bitop3:0xea
    s_waitcnt lgkmcnt(2)
    v_mfma_f32_4x4x4_16b_bf16 v[80:83], v[10:11], v[70:71], v[80:83]
    v_mfma_f32_4x4x4_16b_bf16 v[76:79], v[10:11], v[68:69], v[76:79]
    v_perm_b32 v15, v31, v32, s47
    v_bitop3_b32 v46, v31, 0.5, -0.5 bitop3:0xa8
    v_perm_b32 v14, v30, v32, s46
    v_bitop3_b32 v47, v30, 0.5, -0.5 bitop3:0xa8
    v_cvt_pk_bf16_f32 v80, v80, v81
    v_cvt_pk_bf16_f32 v81, v82, v83
    ds_wrxchg_rtn_b64 v[74:75], v93, v[80:81] offset:65408
    v_cvt_pk_bf16_f32 v76, v76, v77
    v_cvt_pk_bf16_f32 v77, v78, v79
    ds_wrxchg_rtn_b64 v[72:73], v92, v[76:77] offset:65408
    s_setprio 0
    s_waitcnt lgkmcnt(2)
    v_mfma_f32_4x4x4_16b_bf16 v[80:83], v[8:9], v[106:107], 0
    v_mfma_f32_4x4x4_16b_bf16 v[76:79], v[8:9], v[104:105], 0
    v_bitop3_b32 v15, v6, v15, v46 bitop3:0xca
    v_bitop3_b32 v14, v6, v14, v47 bitop3:0xca
    s_nop 1
    v_pk_mul_f32 v[80:81], v[80:81], v[14:15] op_sel:[0,1] op_sel_hi:[1,1]
    v_pk_mul_f32 v[82:83], v[82:83], v[14:15] op_sel:[0,1] op_sel_hi:[1,1]
    v_pk_mul_f32 v[76:77], v[76:77], v[14:15] op_sel:[0,0] op_sel_hi:[1,0]
    v_pk_mul_f32 v[78:79], v[78:79], v[14:15] op_sel:[0,0] op_sel_hi:[1,0]
    s_waitcnt lgkmcnt(0)
    v_cmp_ne_u64 s[50:51], v[72:73], v[68:69]
    v_cmpx_ne_u64 s[54:55], v[74:75], v[70:71]
    s_and_b64 s[82:83], s[54:55], s[80:81]
    s_cbranch_scc1 L2_c146
L2_d146:
    v_mov_b64 v[84:85], v[70:71]
    v_mov_b32 v7, v93
    v_mov_b64 v[86:87], v[74:75]
    s_or_b64 s[80:81], s[80:81], s[54:55]
    s_mov_b64 exec, s[50:51]
    s_and_b64 s[82:83], s[50:51], s[80:81]
    s_cbranch_scc1 L2_c147
L2_d147:
    v_mov_b64 v[84:85], v[68:69]
    v_mov_b32 v7, v92
    v_mov_b64 v[86:87], v[72:73]
    s_mov_b64 exec, -1
    s_or_b64 s[80:81], s[80:81], s[50:51]
    ds_read_b64 v[70:71], v95 offset:65408
    ds_read_b64 v[68:69], v94 offset:65408
    s_waitcnt vmcnt(7)
    v_and_b32 v46, 0x20000000, v39
    v_lshrrev_b32 v47, 14, v35
    v_bitop3_b32 v47, v47, v5, v46 bitop3:0xea
    ds_read_b64 v[102:103], v47
    v_bitop3_b32 v93, v35, v5, v46 bitop3:0xea
    v_and_b32 v46, 0x10000000, v39
    v_lshrrev_b32 v47, 14, v34
    v_bitop3_b32 v47, v47, v5, v46 bitop3:0xea
    ds_read_b64 v[100:101], v47
    v_bitop3_b32 v92, v34, v5, v46 bitop3:0xea
    v_and_b32 v46, 0x80000000, v39
    v_lshrrev_b32 v47, 14, v37
    v_bitop3_b32 v47, v47, v5, v46 bitop3:0xea
    ds_read_b64 v[106:107], v47
    v_and_b32 v46, 0x40000000, v39
    v_lshrrev_b32 v47, 14, v36
    v_bitop3_b32 v47, v47, v5, v46 bitop3:0xea
    ds_read_b64 v[104:105], v47
    s_waitcnt lgkmcnt(4)
    v_mfma_f32_4x4x4_16b_bf16 v[80:83], v[10:11], v[70:71], v[80:83]
    v_mfma_f32_4x4x4_16b_bf16 v[76:79], v[10:11], v[68:69], v[76:79]
    v_perm_b32 v15, v35, v38, s45
    v_bitop3_b32 v46, v35, 0.5, -0.5 bitop3:0xa8
    v_perm_b32 v14, v34, v38, s44
    v_bitop3_b32 v47, v34, 0.5, -0.5 bitop3:0xa8
    v_cvt_pk_bf16_f32 v80, v80, v81
    v_cvt_pk_bf16_f32 v81, v82, v83
    ds_wrxchg_rtn_b64 v[74:75], v95, v[80:81] offset:65408
    v_cvt_pk_bf16_f32 v76, v76, v77
    v_cvt_pk_bf16_f32 v77, v78, v79
    ds_wrxchg_rtn_b64 v[72:73], v94, v[76:77] offset:65408
    s_waitcnt lgkmcnt(4)
    v_mfma_f32_4x4x4_16b_bf16 v[80:83], v[8:9], v[102:103], 0
    v_mfma_f32_4x4x4_16b_bf16 v[76:79], v[8:9], v[100:101], 0
    v_bitop3_b32 v15, v6, v15, v46 bitop3:0xca
    v_bitop3_b32 v14, v6, v14, v47 bitop3:0xca
    v_cmp_lt_u32 s[84:85], v5, v92
    s_nop 0
    v_pk_mul_f32 v[80:81], v[80:81], v[14:15] op_sel:[0,1] op_sel_hi:[1,1]
    v_pk_mul_f32 v[82:83], v[82:83], v[14:15] op_sel:[0,1] op_sel_hi:[1,1]
    v_pk_mul_f32 v[76:77], v[76:77], v[14:15] op_sel:[0,0] op_sel_hi:[1,0]
    v_pk_mul_f32 v[78:79], v[78:79], v[14:15] op_sel:[0,0] op_sel_hi:[1,0]
    s_waitcnt lgkmcnt(0)
    v_cmp_ne_u64 s[50:51], v[72:73], v[68:69]
    v_cmpx_ne_u64 s[54:55], v[74:75], v[70:71]
    s_and_b64 s[82:83], s[54:55], s[80:81]
    s_cbranch_scc1 L2_c148
L2_d148:
    v_mov_b64 v[84:85], v[70:71]
    v_mov_b32 v7, v95
    v_mov_b64 v[86:87], v[74:75]
    s_or_b64 s[80:81], s[80:81], s[54:55]
    s_mov_b64 exec, s[50:51]
    s_and_b64 s[82:83], s[50:51], s[80:81]
    s_cbranch_scc1 L2_c149
L2_d149:
    v_mov_b64 v[84:85], v[68:69]
    v_mov_b32 v7, v94
    v_mov_b64 v[86:87], v[72:73]
    s_mov_b64 exec, -1
    s_or_b64 s[80:81], s[80:81], s[50:51]
    ds_read_b64 v[70:71], v93 offset:65408
    s_and_b64 exec, s[84:85], s[80:81]
    v_mfma_f32_4x4x4_16b_bf16 v[76:79], v[12:13], v[84:85], 0
    v_mov_b32 v92, v7
    s_andn2_b64 s[80:81], s[80:81], s[84:85]
    v_mfma_f32_4x4x4_16b_bf16 v[76:79], v[10:11], v[86:87], v[76:79]
    s_mov_b64 exec, -1
    ds_read_b64 v[68:69], v92 offset:65408
    s_waitcnt lgkmcnt(0)
    v_mfma_f32_4x4x4_16b_bf16 v[80:83], v[10:11], v[70:71], v[80:83]
    v_mfma_f32_4x4x4_16b_bf16 v[76:79], v[10:11], v[68:69], v[76:79]
    v_and_b32 v46, 0x40000000, v39
    v_bitop3_b32 v94, v36, v5, v46 bitop3:0xea
    v_and_b32 v46, 0x80000000, v39
    v_bitop3_b32 v95, v37, v5, v46 bitop3:0xea
    v_perm_b32 v15, v37, v38, s47
    v_bitop3_b32 v46, v37, 0.5, -0.5 bitop3:0xa8
    v_perm_b32 v14, v36, v38, s46
    v_bitop3_b32 v47, v36, 0.5, -0.5 bitop3:0xa8
    v_cvt_pk_bf16_f32 v80, v80, v81
    v_cvt_pk_bf16_f32 v81, v82, v83
    ds_wrxchg_rtn_b64 v[74:75], v93, v[80:81] offset:65408
    v_cvt_pk_bf16_f32 v76, v76, v77
    v_cvt_pk_bf16_f32 v77, v78, v79
    ds_wrxchg_rtn_b64 v[72:73], v92, v[76:77] offset:65408
    v_mfma_f32_4x4x4_16b_bf16 v[80:83], v[8:9], v[106:107], 0
    v_mfma_f32_4x4x4_16b_bf16 v[76:79], v[8:9], v[104:105], 0
    v_bitop3_b32 v15, v6, v15, v46 bitop3:0xca
    v_bitop3_b32 v14, v6, v14, v47 bitop3:0xca
    s_nop 1
    v_pk_mul_f32 v[80:81], v[80:81], v[14:15] op_sel:[0,1] op_sel_hi:[1,1]
    v_pk_mul_f32 v[82:83], v[82:83], v[14:15] op_sel:[0,1] op_sel_hi:[1,1]
    v_pk_mul_f32 v[76:77], v[76:77], v[14:15] op_sel:[0,0] op_sel_hi:[1,0]
    v_pk_mul_f32 v[78:79], v[78:79], v[14:15] op_sel:[0,0] op_sel_hi:[1,0]
    s_waitcnt lgkmcnt(0)
    v_cmp_ne_u64 s[50:51], v[72:73], v[68:69]
    v_cmpx_ne_u64 s[54:55], v[74:75], v[70:71]
    s_and_b64 s[82:83], s[54:55], s[80:81]
    s_cbranch_scc1 L2_c150
L2_d150:
    v_mov_b64 v[84:85], v[70:71]
    v_mov_b32 v7, v93
    v_mov_b64 v[86:87], v[74:75]
    s_or_b64 s[80:81], s[80:81], s[54:55]
    s_mov_b64 exec, s[50:51]
    s_and_b64 s[82:83], s[50:51], s[80:81]
    s_cbranch_scc1 L2_c151
L2_d151:
    v_mov_b64 v[84:85], v[68:69]
    v_mov_b32 v7, v92
    v_mov_b64 v[86:87], v[72:73]
    s_mov_b64 exec, -1
    s_or_b64 s[80:81], s[80:81], s[50:51]
    ds_read_b64 v[70:71], v95 offset:65408
    ds_read_b64 v[68:69], v94 offset:65408
    s_waitcnt lgkmcnt(0)
    v_mfma_f32_4x4x4_16b_bf16 v[80:83], v[10:11], v[70:71], v[80:83]
    v_mfma_f32_4x4x4_16b_bf16 v[76:79], v[10:11], v[68:69], v[76:79]
    s_nop 3
    v_cvt_pk_bf16_f32 v80, v80, v81
    v_cvt_pk_bf16_f32 v81, v82, v83
    ds_wrxchg_rtn_b64 v[74:75], v95, v[80:81] offset:65408
    v_cvt_pk_bf16_f32 v76, v76, v77
    v_cvt_pk_bf16_f32 v77, v78, v79
    ds_wrxchg_rtn_b64 v[72:73], v94, v[76:77] offset:65408
    s_waitcnt lgkmcnt(0)
    v_cmpx_ne_u64 vcc, v[74:75], v[70:71]
    s_and_b64 s[82:83], vcc, s[80:81]
    s_cbranch_scc1 L2_c152
L2_d152:
    v_mov_b64 v[84:85], v[70:71]
    v_mov_b32 v7, v95
    v_mov_b64 v[86:87], v[74:75]
    s_mov_b64 exec, -1
    s_or_b64 s[80:81], s[80:81], vcc
    v_cmpx_ne_u64 vcc, v[72:73], v[68:69]
    s_and_b64 s[82:83], vcc, s[80:81]
    s_cbranch_scc1 L2_c153
L2_d153:
    v_mov_b64 v[84:85], v[68:69]
    v_mov_b32 v7, v94
    v_mov_b64 v[86:87], v[72:73]
    s_mov_b64 exec, -1
    s_or_b64 s[80:81], s[80:81], vcc
    s_mov_b64 exec, s[80:81]
    s_nop 1
    v_mfma_f32_4x4x4_16b_bf16 v[88:91], v[12:13], v[84:85], 0
    s_nop 1
    v_mfma_f32_4x4x4_16b_bf16 v[88:91], v[10:11], v[86:87], v[88:91]
    s_nop 4
    v_cvt_pk_bf16_f32 v88, v88, v89
    v_cvt_pk_bf16_f32 v89, v90, v91
    ds_pk_add_bf16 v7, v88 offset:65408
    ds_pk_add_bf16 v7, v89 offset:65412
    s_mov_b64 exec, -1
    s_load_dwordx2 s[4:5], s[0:1], 88
    v_add_u32 v123, 16384, v122
    v_add_u32 v124, 32768, v122
    v_add_u32 v125, 49152, v122
    v_add_u32 v126, 65536, v122
    s_lshl_b32 s50, s96, 16
    s_and_b32 s51, s96, 0xffff0000
    s_lshl_b32 s52, s97, 16
    s_and_b32 s53, s97, 0xffff0000
    s_lshl_b32 s54, s98, 16
    s_and_b32 s55, s98, 0xffff0000
    s_lshl_b32 s56, s99, 16
    s_and_b32 s57, s99, 0xffff0000
    s_waitcnt vmcnt(0) lgkmcnt(0)
    s_barrier
    v_add_u32 v36, 0x8000, v126
    ds_read_b128 v[16:19], v126 offset:16384
    ds_read_b128 v[20:23], v126 offset:32768
    ds_read_b128 v[24:27], v126 offset:49152
    ds_read_b128 v[28:31], v36 offset:32768
    ds_read_b128 v[32:35], v36 offset:49152
    s_add_u32 s8, s30, 0xebca000
    s_addc_u32 s9, s31, 0
    s_mov_b32 s10, 0x8000
    s_mov_b32 s11, 0x20000
    s_mov_b32 s12, s4
    s_mov_b32 s13, s5
    s_mov_b32 s14, 0x4e2000
    s_mov_b32 s15, 0x20000
    s_mul_i32 s3, s33, 20000
    v_subrev_u32 v36, s3, v122
    v_cmp_le_u32 vcc, 20000, v36
    s_waitcnt lgkmcnt(4)
    s_mov_b64 exec, vcc
    buffer_store_dwordx4 v[16:19], v122, s[20:23], 0 offen sc1
    s_mov_b64 exec, -1
    v_subrev_u32 v36, s3, v123
    v_cmp_le_u32 vcc, 20000, v36
    s_waitcnt lgkmcnt(3)
    s_mov_b64 exec, vcc
    buffer_store_dwordx4 v[20:23], v123, s[20:23], 0 offen sc1
    s_mov_b64 exec, -1
    v_subrev_u32 v36, s3, v124
    v_cmp_le_u32 vcc, 20000, v36
    s_waitcnt lgkmcnt(2)
    s_mov_b64 exec, vcc
    buffer_store_dwordx4 v[24:27], v124, s[20:23], 0 offen sc1
    s_mov_b64 exec, -1
    v_subrev_u32 v36, s3, v125
    v_cmp_le_u32 vcc, 20000, v36
    s_waitcnt lgkmcnt(1)
    s_mov_b64 exec, vcc
    buffer_store_dwordx4 v[28:31], v125, s[20:23], 0 offen sc1
    s_mov_b64 exec, -1
    v_subrev_u32 v36, s3, v126
    v_cmp_le_u32 vcc, 20000, v36
    s_waitcnt lgkmcnt(0)
    s_mov_b64 exec, vcc
    buffer_store_dwordx4 v[32:35], v126, s[20:23], 0 offen sc1
    s_mov_b64 exec, -1
    v_lshlrev_b32 v80, 16, v116
    v_subrev_f32 v60, s50, v80
    v_subrev_f32 v61, s51, v80
    v_subrev_f32 v62, s52, v80
    v_subrev_f32 v63, s53, v80
    v_subrev_f32 v64, s54, v80
    v_subrev_f32 v65, s55, v80
    v_subrev_f32 v66, s56, v80
    v_subrev_f32 v67, s57, v80
    v_cvt_pk_bf16_f32 v68, v60, v61
    v_cvt_pk_bf16_f32 v69, v62, v63
    v_cvt_pk_bf16_f32 v70, v64, v65
    v_cvt_pk_bf16_f32 v71, v66, v67
    v_lshlrev_b32 v60, 16, v68
    v_and_b32 v61, 0xffff0000, v68
    v_lshlrev_b32 v62, 16, v69
    v_and_b32 v63, 0xffff0000, v69
    v_lshlrev_b32 v64, 16, v70
    v_and_b32 v65, 0xffff0000, v70
    v_lshlrev_b32 v66, 16, v71
    v_and_b32 v67, 0xffff0000, v71
    v_mul_f32 v60, v60, v60
    v_mul_f32 v61, v61, v61
    v_mul_f32 v62, v62, v62
    v_mul_f32 v63, v63, v63
    v_mul_f32 v64, v64, v64
    v_mul_f32 v65, v65, v65
    v_mul_f32 v66, v66, v66
    v_mul_f32 v67, v67, v67
    v_cvt_pk_bf16_f32 v68, v60, v61
    v_cvt_pk_bf16_f32 v69, v62, v63
    v_cvt_pk_bf16_f32 v70, v64, v65
    v_cvt_pk_bf16_f32 v71, v66, v67
    v_lshlrev_b32 v60, 16, v68
    v_and_b32 v61, 0xffff0000, v68
    v_lshlrev_b32 v62, 16, v69
    v_and_b32 v63, 0xffff0000, v69
    v_lshlrev_b32 v64, 16, v70
    v_and_b32 v65, 0xffff0000, v70
    v_lshlrev_b32 v66, 16, v71
    v_and_b32 v67, 0xffff0000, v71
    v_mul_f32 v60, 0xc1200000, v60
    v_mul_f32 v61, 0xc1200000, v61
    v_mul_f32 v62, 0xc1200000, v62
    v_mul_f32 v63, 0xc1200000, v63
    v_mul_f32 v64, 0xc1200000, v64
    v_mul_f32 v65, 0xc1200000, v65
    v_mul_f32 v66, 0xc1200000, v66
    v_mul_f32 v67, 0xc1200000, v67
    v_cvt_pk_bf16_f32 v68, v60, v61
    v_cvt_pk_bf16_f32 v69, v62, v63
    v_cvt_pk_bf16_f32 v70, v64, v65
    v_cvt_pk_bf16_f32 v71, v66, v67
    v_lshlrev_b32 v60, 16, v68
    v_and_b32 v61, 0xffff0000, v68
    v_lshlrev_b32 v62, 16, v69
    v_and_b32 v63, 0xffff0000, v69
    v_lshlrev_b32 v64, 16, v70
    v_and_b32 v65, 0xffff0000, v70
    v_lshlrev_b32 v66, 16, v71
    v_and_b32 v67, 0xffff0000, v71
    v_mul_f32 v60, 0x3fb8aa3b, v60
    v_mul_f32 v61, 0x3fb8aa3b, v61
    v_mul_f32 v62, 0x3fb8aa3b, v62
    v_mul_f32 v63, 0x3fb8aa3b, v63
    v_mul_f32 v64, 0x3fb8aa3b, v64
    v_mul_f32 v65, 0x3fb8aa3b, v65
    v_mul_f32 v66, 0x3fb8aa3b, v66
    v_mul_f32 v67, 0x3fb8aa3b, v67
    v_exp_f32 v60, v60
    v_exp_f32 v61, v61
    v_exp_f32 v62, v62
    v_exp_f32 v63, v63
    v_exp_f32 v64, v64
    v_exp_f32 v65, v65
    v_exp_f32 v66, v66
    v_exp_f32 v67, v67
    v_cvt_pk_bf16_f32 v72, v60, v61
    v_cvt_pk_bf16_f32 v73, v62, v63
    v_cvt_pk_bf16_f32 v74, v64, v65
    v_cvt_pk_bf16_f32 v75, v66, v67
    v_and_b32 v80, 0xffff0000, v116
    v_subrev_f32 v60, s50, v80
    v_subrev_f32 v61, s51, v80
    v_subrev_f32 v62, s52, v80
    v_subrev_f32 v63, s53, v80
    v_subrev_f32 v64, s54, v80
    v_subrev_f32 v65, s55, v80
    v_subrev_f32 v66, s56, v80
    v_subrev_f32 v67, s57, v80
    v_cvt_pk_bf16_f32 v68, v60, v61
    v_cvt_pk_bf16_f32 v69, v62, v63
    v_cvt_pk_bf16_f32 v70, v64, v65
    v_cvt_pk_bf16_f32 v71, v66, v67
    v_lshlrev_b32 v60, 16, v68
    v_and_b32 v61, 0xffff0000, v68
    v_lshlrev_b32 v62, 16, v69
    v_and_b32 v63, 0xffff0000, v69
    v_lshlrev_b32 v64, 16, v70
    v_and_b32 v65, 0xffff0000, v70
    v_lshlrev_b32 v66, 16, v71
    v_and_b32 v67, 0xffff0000, v71
    v_mul_f32 v60, v60, v60
    v_mul_f32 v61, v61, v61
    v_mul_f32 v62, v62, v62
    v_mul_f32 v63, v63, v63
    v_mul_f32 v64, v64, v64
    v_mul_f32 v65, v65, v65
    v_mul_f32 v66, v66, v66
    v_mul_f32 v67, v67, v67
    v_cvt_pk_bf16_f32 v68, v60, v61
    v_cvt_pk_bf16_f32 v69, v62, v63
    v_cvt_pk_bf16_f32 v70, v64, v65
    v_cvt_pk_bf16_f32 v71, v66, v67
    v_lshlrev_b32 v60, 16, v68
    v_and_b32 v61, 0xffff0000, v68
    v_lshlrev_b32 v62, 16, v69
    v_and_b32 v63, 0xffff0000, v69
    v_lshlrev_b32 v64, 16, v70
    v_and_b32 v65, 0xffff0000, v70
    v_lshlrev_b32 v66, 16, v71
    v_and_b32 v67, 0xffff0000, v71
    v_mul_f32 v60, 0xc1200000, v60
    v_mul_f32 v61, 0xc1200000, v61
    v_mul_f32 v62, 0xc1200000, v62
    v_mul_f32 v63, 0xc1200000, v63
    v_mul_f32 v64, 0xc1200000, v64
    v_mul_f32 v65, 0xc1200000, v65
    v_mul_f32 v66, 0xc1200000, v66
    v_mul_f32 v67, 0xc1200000, v67
    v_cvt_pk_bf16_f32 v68, v60, v61
    v_cvt_pk_bf16_f32 v69, v62, v63
    v_cvt_pk_bf16_f32 v70, v64, v65
    v_cvt_pk_bf16_f32 v71, v66, v67
    v_lshlrev_b32 v60, 16, v68
    v_and_b32 v61, 0xffff0000, v68
    v_lshlrev_b32 v62, 16, v69
    v_and_b32 v63, 0xffff0000, v69
    v_lshlrev_b32 v64, 16, v70
    v_and_b32 v65, 0xffff0000, v70
    v_lshlrev_b32 v66, 16, v71
    v_and_b32 v67, 0xffff0000, v71
    v_mul_f32 v60, 0x3fb8aa3b, v60
    v_mul_f32 v61, 0x3fb8aa3b, v61
    v_mul_f32 v62, 0x3fb8aa3b, v62
    v_mul_f32 v63, 0x3fb8aa3b, v63
    v_mul_f32 v64, 0x3fb8aa3b, v64
    v_mul_f32 v65, 0x3fb8aa3b, v65
    v_mul_f32 v66, 0x3fb8aa3b, v66
    v_mul_f32 v67, 0x3fb8aa3b, v67
    v_exp_f32 v60, v60
    v_exp_f32 v61, v61
    v_exp_f32 v62, v62
    v_exp_f32 v63, v63
    v_exp_f32 v64, v64
    v_exp_f32 v65, v65
    v_exp_f32 v66, v66
    v_exp_f32 v67, v67
    v_cvt_pk_bf16_f32 v76, v60, v61
    v_cvt_pk_bf16_f32 v77, v62, v63
    v_cvt_pk_bf16_f32 v78, v64, v65
    v_cvt_pk_bf16_f32 v79, v66, v67
    v_mfma_f32_4x4x4_16b_bf16 v[80:83], v[48:49], v[72:73], 0
    v_mfma_f32_4x4x4_16b_bf16 v[88:91], v[52:53], v[72:73], 0
    v_mfma_f32_4x4x4_16b_bf16 v[84:87], v[48:49], v[76:77], 0
    v_mfma_f32_4x4x4_16b_bf16 v[92:95], v[52:53], v[76:77], 0
    v_mfma_f32_4x4x4_16b_bf16 v[80:83], v[50:51], v[74:75], v[80:83]
    v_mfma_f32_4x4x4_16b_bf16 v[88:91], v[54:55], v[74:75], v[88:91]
    v_mfma_f32_4x4x4_16b_bf16 v[84:87], v[50:51], v[78:79], v[84:87]
    v_mfma_f32_4x4x4_16b_bf16 v[92:95], v[54:55], v[78:79], v[92:95]
    v_add_u32 v104, 81920, v118
    ds_read_b128 v[32:35], v104
    v_add_u32 v104, 81920, v119
    ds_read_b128 v[60:63], v104
    s_add_u32 s20, s30, 0xd841000
    s_addc_u32 s21, s31, 0
    s_mov_b32 s22, 0x1388000
    s_mov_b32 s23, 0x20000
    s_add_u32 s3, s33, 1
    s_and_b32 s3, s3, 3
    s_lshl_b32 s3, s3, 6
    s_add_u32 s3, s3, s34
    s_mul_i32 s44, s3, 80000
    s_add_u32 s3, s33, 2
    s_and_b32 s3, s3, 3
    s_lshl_b32 s3, s3, 6
    s_add_u32 s3, s3, s34
    s_mul_i32 s45, s3, 80000
    s_add_u32 s3, s33, 3
    s_and_b32 s3, s3, 3
    s_lshl_b32 s3, s3, 6
    s_add_u32 s3, s3, s34
    s_mul_i32 s46, s3, 80000
    s_lshl_b32 s3, s34, 9
    s_lshl_b32 s4, s33, 7
    s_add_u32 s4, s4, s3
    v_mov_b32 v104, 1
    v_lshlrev_b32 v105, 3, v122
    s_waitcnt vmcnt(0)
    s_barrier
    s_cmp_lg_u32 s32, 0
    s_cbranch_scc1 L2_f2
    s_mov_b64 exec, 1
    buffer_store_dword v104, off, s[8:11], s4 sc1
    s_mov_b64 exec, 15
    s_bitset0_b64 exec, s33
L2_f3:
    buffer_load_dword v104, v105, s[8:11], s3 offen sc1
    s_waitcnt vmcnt(0)
    v_cmp_ne_u32 vcc, 1, v104
    s_cbranch_vccnz L2_f3
L2_f4:
    s_mov_b64 exec, -1
L2_f2:
    s_barrier
    buffer_load_dwordx4 v[36:39], v118, s[20:23], s44 offen sc1
    buffer_load_dwordx4 v[40:43], v118, s[20:23], s45 offen sc1
    buffer_load_dwordx4 v[44:47], v118, s[20:23], s46 offen sc1
    s_cmp_ge_u32 s32, 4
    s_cbranch_scc1 L2_f5
    buffer_load_dwordx4 v[64:67], v119, s[20:23], s44 offen sc1
    buffer_load_dwordx4 v[68:71], v119, s[20:23], s45 offen sc1
    buffer_load_dwordx4 v[72:75], v119, s[20:23], s46 offen sc1
    v_lshlrev_b32 v16, 16, v117
    v_subrev_f32 v96, s50, v16
    v_subrev_f32 v97, s51, v16
    v_subrev_f32 v98, s52, v16
    v_subrev_f32 v99, s53, v16
    v_subrev_f32 v100, s54, v16
    v_subrev_f32 v101, s55, v16
    v_subrev_f32 v102, s56, v16
    v_subrev_f32 v103, s57, v16
    v_cvt_pk_bf16_f32 v0, v96, v97
    v_cvt_pk_bf16_f32 v1, v98, v99
    v_cvt_pk_bf16_f32 v2, v100, v101
    v_cvt_pk_bf16_f32 v3, v102, v103
    v_lshlrev_b32 v96, 16, v0
    v_and_b32 v97, 0xffff0000, v0
    v_lshlrev_b32 v98, 16, v1
    v_and_b32 v99, 0xffff0000, v1
    v_lshlrev_b32 v100, 16, v2
    v_and_b32 v101, 0xffff0000, v2
    v_lshlrev_b32 v102, 16, v3
    v_and_b32 v103, 0xffff0000, v3
    v_mul_f32 v96, v96, v96
    v_mul_f32 v97, v97, v97
    v_mul_f32 v98, v98, v98
    v_mul_f32 v99, v99, v99
    v_mul_f32 v100, v100, v100
    v_mul_f32 v101, v101, v101
    v_mul_f32 v102, v102, v102
    v_mul_f32 v103, v103, v103
    v_cvt_pk_bf16_f32 v0, v96, v97
    v_cvt_pk_bf16_f32 v1, v98, v99
    v_cvt_pk_bf16_f32 v2, v100, v101
    v_cvt_pk_bf16_f32 v3, v102, v103
    v_lshlrev_b32 v96, 16, v0
    v_and_b32 v97, 0xffff0000, v0
    v_lshlrev_b32 v98, 16, v1
    v_and_b32 v99, 0xffff0000, v1
    v_lshlrev_b32 v100, 16, v2
    v_and_b32 v101, 0xffff0000, v2
    v_lshlrev_b32 v102, 16, v3
    v_and_b32 v103, 0xffff0000, v3
    v_mul_f32 v96, 0xc1200000, v96
    v_mul_f32 v97, 0xc1200000, v97
    v_mul_f32 v98, 0xc1200000, v98
    v_mul_f32 v99, 0xc1200000, v99
    v_mul_f32 v100, 0xc1200000, v100
    v_mul_f32 v101, 0xc1200000, v101
    v_mul_f32 v102, 0xc1200000, v102
    v_mul_f32 v103, 0xc1200000, v103
    v_cvt_pk_bf16_f32 v0, v96, v97
    v_cvt_pk_bf16_f32 v1, v98, v99
    v_cvt_pk_bf16_f32 v2, v100, v101
    v_cvt_pk_bf16_f32 v3, v102, v103
    v_lshlrev_b32 v96, 16, v0
    v_and_b32 v97, 0xffff0000, v0
    v_lshlrev_b32 v98, 16, v1
    v_and_b32 v99, 0xffff0000, v1
    v_lshlrev_b32 v100, 16, v2
    v_and_b32 v101, 0xffff0000, v2
    v_lshlrev_b32 v102, 16, v3
    v_and_b32 v103, 0xffff0000, v3
    v_mul_f32 v96, 0x3fb8aa3b, v96
    v_mul_f32 v97, 0x3fb8aa3b, v97
    v_mul_f32 v98, 0x3fb8aa3b, v98
    v_mul_f32 v99, 0x3fb8aa3b, v99
    v_mul_f32 v100, 0x3fb8aa3b, v100
    v_mul_f32 v101, 0x3fb8aa3b, v101
    v_mul_f32 v102, 0x3fb8aa3b, v102
    v_mul_f32 v103, 0x3fb8aa3b, v103
    v_exp_f32 v96, v96
    v_exp_f32 v97, v97
    v_exp_f32 v98, v98
    v_exp_f32 v99, v99
    v_exp_f32 v100, v100
    v_exp_f32 v101, v101
    v_exp_f32 v102, v102
    v_exp_f32 v103, v103
    v_cvt_pk_bf16_f32 v104, v96, v97
    v_cvt_pk_bf16_f32 v105, v98, v99
    v_cvt_pk_bf16_f32 v106, v100, v101
    v_cvt_pk_bf16_f32 v107, v102, v103
    v_and_b32 v16, 0xffff0000, v117
    v_subrev_f32 v96, s50, v16
    v_subrev_f32 v97, s51, v16
    v_subrev_f32 v98, s52, v16
    v_subrev_f32 v99, s53, v16
    v_subrev_f32 v100, s54, v16
    v_subrev_f32 v101, s55, v16
    v_subrev_f32 v102, s56, v16
    v_subrev_f32 v103, s57, v16
    v_cvt_pk_bf16_f32 v0, v96, v97
    v_cvt_pk_bf16_f32 v1, v98, v99
    v_cvt_pk_bf16_f32 v2, v100, v101
    v_cvt_pk_bf16_f32 v3, v102, v103
    v_lshlrev_b32 v96, 16, v0
    v_and_b32 v97, 0xffff0000, v0
    v_lshlrev_b32 v98, 16, v1
    v_and_b32 v99, 0xffff0000, v1
    v_lshlrev_b32 v100, 16, v2
    v_and_b32 v101, 0xffff0000, v2
    v_lshlrev_b32 v102, 16, v3
    v_and_b32 v103, 0xffff0000, v3
    v_mul_f32 v96, v96, v96
    v_mul_f32 v97, v97, v97
    v_mul_f32 v98, v98, v98
    v_mul_f32 v99, v99, v99
    v_mul_f32 v100, v100, v100
    v_mul_f32 v101, v101, v101
    v_mul_f32 v102, v102, v102
    v_mul_f32 v103, v103, v103
    v_cvt_pk_bf16_f32 v0, v96, v97
    v_cvt_pk_bf16_f32 v1, v98, v99
    v_cvt_pk_bf16_f32 v2, v100, v101
    v_cvt_pk_bf16_f32 v3, v102, v103
    v_lshlrev_b32 v96, 16, v0
    v_and_b32 v97, 0xffff0000, v0
    v_lshlrev_b32 v98, 16, v1
    v_and_b32 v99, 0xffff0000, v1
    v_lshlrev_b32 v100, 16, v2
    v_and_b32 v101, 0xffff0000, v2
    v_lshlrev_b32 v102, 16, v3
    v_and_b32 v103, 0xffff0000, v3
    v_mul_f32 v96, 0xc1200000, v96
    v_mul_f32 v97, 0xc1200000, v97
    v_mul_f32 v98, 0xc1200000, v98
    v_mul_f32 v99, 0xc1200000, v99
    v_mul_f32 v100, 0xc1200000, v100
    v_mul_f32 v101, 0xc1200000, v101
    v_mul_f32 v102, 0xc1200000, v102
    v_mul_f32 v103, 0xc1200000, v103
    v_cvt_pk_bf16_f32 v0, v96, v97
    v_cvt_pk_bf16_f32 v1, v98, v99
    v_cvt_pk_bf16_f32 v2, v100, v101
    v_cvt_pk_bf16_f32 v3, v102, v103
    v_lshlrev_b32 v96, 16, v0
    v_and_b32 v97, 0xffff0000, v0
    v_lshlrev_b32 v98, 16, v1
    v_and_b32 v99, 0xffff0000, v1
    v_lshlrev_b32 v100, 16, v2
    v_and_b32 v101, 0xffff0000, v2
    v_lshlrev_b32 v102, 16, v3
    v_and_b32 v103, 0xffff0000, v3
    v_mul_f32 v96, 0x3fb8aa3b, v96
    v_mul_f32 v97, 0x3fb8aa3b, v97
    v_mul_f32 v98, 0x3fb8aa3b, v98
    v_mul_f32 v99, 0x3fb8aa3b, v99
    v_mul_f32 v100, 0x3fb8aa3b, v100
    v_mul_f32 v101, 0x3fb8aa3b, v101
    v_mul_f32 v102, 0x3fb8aa3b, v102
    v_mul_f32 v103, 0x3fb8aa3b, v103
    v_exp_f32 v96, v96
    v_exp_f32 v97, v97
    v_exp_f32 v98, v98
    v_exp_f32 v99, v99
    v_exp_f32 v100, v100
    v_exp_f32 v101, v101
    v_exp_f32 v102, v102
    v_exp_f32 v103, v103
    v_cvt_pk_bf16_f32 v76, v96, v97
    v_cvt_pk_bf16_f32 v77, v98, v99
    v_cvt_pk_bf16_f32 v78, v100, v101
    v_cvt_pk_bf16_f32 v79, v102, v103
    v_mfma_f32_4x4x4_16b_bf16 v[16:19], v[48:49], v[104:105], 0
    v_mfma_f32_4x4x4_16b_bf16 v[24:27], v[52:53], v[104:105], 0
    v_mfma_f32_4x4x4_16b_bf16 v[20:23], v[48:49], v[76:77], 0
    v_mfma_f32_4x4x4_16b_bf16 v[28:31], v[52:53], v[76:77], 0
    v_mfma_f32_4x4x4_16b_bf16 v[16:19], v[50:51], v[106:107], v[16:19]
    v_mfma_f32_4x4x4_16b_bf16 v[24:27], v[54:55], v[106:107], v[24:27]
    v_mfma_f32_4x4x4_16b_bf16 v[20:23], v[50:51], v[78:79], v[20:23]
    v_mfma_f32_4x4x4_16b_bf16 v[28:31], v[54:55], v[78:79], v[28:31]
L2_f5:
    s_waitcnt vmcnt(0) lgkmcnt(0)
    v_mfma_f32_4x4x4_16b_bf16 v[96:99], v[10:11], v[32:33], 0
    v_mfma_f32_4x4x4_16b_bf16 v[100:103], v[10:11], v[34:35], 0
    s_nop 0
    v_mfma_f32_4x4x4_16b_bf16 v[96:99], v[10:11], v[36:37], v[96:99]
    v_mfma_f32_4x4x4_16b_bf16 v[100:103], v[10:11], v[38:39], v[100:103]
    s_nop 0
    v_mfma_f32_4x4x4_16b_bf16 v[96:99], v[10:11], v[40:41], v[96:99]
    v_mfma_f32_4x4x4_16b_bf16 v[100:103], v[10:11], v[42:43], v[100:103]
    s_nop 0
    v_mfma_f32_4x4x4_16b_bf16 v[96:99], v[10:11], v[44:45], v[96:99]
    v_mfma_f32_4x4x4_16b_bf16 v[100:103], v[10:11], v[46:47], v[100:103]
    s_nop 3
    v_mul_f32 v96, v96, v80
    v_mul_f32 v97, v97, v81
    v_mul_f32 v98, v98, v82
    v_mul_f32 v99, v99, v83
    v_cvt_pk_bf16_f32 v32, v96, v97
    v_cvt_pk_bf16_f32 v33, v98, v99
    v_mul_f32 v100, v100, v84
    v_mul_f32 v101, v101, v85
    v_mul_f32 v102, v102, v86
    v_mul_f32 v103, v103, v87
    v_cvt_pk_bf16_f32 v34, v100, v101
    v_cvt_pk_bf16_f32 v35, v102, v103
    v_mfma_f32_4x4x4_16b_bf16 v[80:83], v[56:57], v[32:33], 0
    s_nop 0
    v_mfma_f32_4x4x4_16b_bf16 v[84:87], v[56:57], v[34:35], 0
    s_nop 2
    v_mul_f32 v80, v80, v88
    v_mul_f32 v81, v81, v89
    v_mul_f32 v82, v82, v90
    v_mul_f32 v83, v83, v91
    v_mul_f32 v84, v84, v92
    v_mul_f32 v85, v85, v93
    v_mul_f32 v86, v86, v94
    v_mul_f32 v87, v87, v95
    v_mfma_f32_4x4x4_16b_bf16 v[96:99], v[10:11], v[108:109], v[80:83]
    s_nop 0
    v_mfma_f32_4x4x4_16b_bf16 v[100:103], v[10:11], v[110:111], v[84:87]
    s_nop 2
    v_cvt_pk_bf16_f32 v36, v96, v97
    v_cvt_pk_bf16_f32 v37, v98, v99
    v_cvt_pk_bf16_f32 v38, v100, v101
    v_cvt_pk_bf16_f32 v39, v102, v103
    buffer_store_dwordx4 v[36:39], v120, s[12:15], 0 offen
    s_cmp_ge_u32 s32, 4
    s_cbranch_scc1 L2_f6
    v_mfma_f32_4x4x4_16b_bf16 v[96:99], v[10:11], v[60:61], 0
    v_mfma_f32_4x4x4_16b_bf16 v[100:103], v[10:11], v[62:63], 0
    s_nop 0
    v_mfma_f32_4x4x4_16b_bf16 v[96:99], v[10:11], v[64:65], v[96:99]
    v_mfma_f32_4x4x4_16b_bf16 v[100:103], v[10:11], v[66:67], v[100:103]
    s_nop 0
    v_mfma_f32_4x4x4_16b_bf16 v[96:99], v[10:11], v[68:69], v[96:99]
    v_mfma_f32_4x4x4_16b_bf16 v[100:103], v[10:11], v[70:71], v[100:103]
    s_nop 0
    v_mfma_f32_4x4x4_16b_bf16 v[96:99], v[10:11], v[72:73], v[96:99]
    v_mfma_f32_4x4x4_16b_bf16 v[100:103], v[10:11], v[74:75], v[100:103]
    s_nop 3
    v_mul_f32 v96, v96, v16
    v_mul_f32 v97, v97, v17
    v_mul_f32 v98, v98, v18
    v_mul_f32 v99, v99, v19
    v_cvt_pk_bf16_f32 v60, v96, v97
    v_cvt_pk_bf16_f32 v61, v98, v99
    v_mul_f32 v100, v100, v20
    v_mul_f32 v101, v101, v21
    v_mul_f32 v102, v102, v22
    v_mul_f32 v103, v103, v23
    v_cvt_pk_bf16_f32 v62, v100, v101
    v_cvt_pk_bf16_f32 v63, v102, v103
    v_mfma_f32_4x4x4_16b_bf16 v[16:19], v[56:57], v[60:61], 0
    s_nop 0
    v_mfma_f32_4x4x4_16b_bf16 v[20:23], v[56:57], v[62:63], 0
    s_nop 2
    v_mul_f32 v16, v16, v24
    v_mul_f32 v17, v17, v25
    v_mul_f32 v18, v18, v26
    v_mul_f32 v19, v19, v27
    v_mul_f32 v20, v20, v28
    v_mul_f32 v21, v21, v29
    v_mul_f32 v22, v22, v30
    v_mul_f32 v23, v23, v31
    v_mfma_f32_4x4x4_16b_bf16 v[96:99], v[10:11], v[112:113], v[16:19]
    s_nop 0
    v_mfma_f32_4x4x4_16b_bf16 v[100:103], v[10:11], v[114:115], v[20:23]
    s_nop 2
    v_cvt_pk_bf16_f32 v64, v96, v97
    v_cvt_pk_bf16_f32 v65, v98, v99
    v_cvt_pk_bf16_f32 v66, v100, v101
    v_cvt_pk_bf16_f32 v67, v102, v103
    buffer_store_dwordx4 v[64:67], v121, s[12:15], 0 offen
L2_f6:
L2_end:
    s_endpgm
L2_slow:
    s_lshr_b32 s35, s42, 2
    s_lshl_b32 s50, s32, 4
    s_and_b32 s3, s42, 3
    s_lshl_b32 s53, s3, 3
    s_add_u32 s53, s53, s39
    s_and_b32 s3, s35, 2
    s_lshl_b32 s3, s3, 1
    s_add_u32 s53, s53, s3
    s_and_b32 s54, s35, 1
    s_lshl_b32 s54, s54, 4
L2_sl_seg:
    s_mul_i32 s55, s50, 173056
    s_and_b32 s3, s50, 3
    s_lshl_b32 s3, s3, 5
    s_add_u32 s3, s3, s55
    s_add_u32 s3, s3, s53
    buffer_load_dword v104, off, s[12:15], s3 sc1
    buffer_load_dword v105, off, s[12:15], s3 offset:32 sc1
    s_waitcnt vmcnt(0)
    v_readfirstlane_b32 s51, v104
    v_readfirstlane_b32 s52, v105
    s_lshr_b32 s51, s51, s54
    s_and_b32 s51, s51, 0xffff
    s_lshr_b32 s52, s52, s54
    s_and_b32 s52, s52, 0xffff
L2_sl_rec:
    s_cmp_ge_u32 s51, s52
    s_cbranch_scc1 L2_sl_next
    v_mbcnt_lo_u32_b32 v102, -1, 0
    v_mbcnt_hi_u32_b32 v102, -1, v102
    v_add_u32 v102, s51, v102
    v_and_b32 v103, -4, v102
    v_lshl_add_u32 v104, v102, 2, v103
    v_lshl_add_u32 v105, v103, 2, v102
    v_cmp_gt_u32 vcc, s52, v102
    s_mov_b64 exec, vcc
    buffer_load_dword v106, v104, s[8:11], s55 offen
    buffer_load_ubyte v107, v105, s[8:11], s55 offen offset:16
    s_waitcnt vmcnt(0)
    v_lshrrev_b32 v98, 14, v106
    v_and_b32 v98, v5, v98
    ds_read_b64 v[100:101], v98
    v_perm_b32 v97, v106, v107, s44
    v_and_b32 v96, v5, v106
    v_bitop3_b32 v103, v106, 0.5, -0.5 bitop3:0xa8
    v_bitop3_b32 v97, v6, v97, v103 bitop3:0xca
    s_waitcnt lgkmcnt(0)
    v_mfma_f32_4x4x4_16b_bf16 v[88:91], v[8:9], v[100:101], 0
    s_nop 4
    v_mul_f32 v88, v97, v88
    v_mul_f32 v89, v97, v89
    v_mul_f32 v90, v97, v90
    v_mul_f32 v91, v97, v91
    v_cvt_pk_bf16_f32 v88, v88, v89
    v_cvt_pk_bf16_f32 v89, v90, v91
    ds_pk_add_bf16 v96, v88 offset:65408
    ds_pk_add_bf16 v96, v89 offset:65412
    s_mov_b64 exec, -1
    s_add_u32 s51, s51, 64
    s_branch L2_sl_rec
L2_sl_next:
    s_add_u32 s50, s50, 1
    s_and_b32 s3, s50, 15
    s_cbranch_scc1 L2_sl_seg
    s_add_u32 s50, s50, 240
    s_cmp_lt_u32 s50, 1280
    s_cbranch_scc1 L2_sl_seg
    s_waitcnt lgkmcnt(0)
    s_cmp_eq_u32 s42, 0
    s_cbranch_scc1 L2_ret0
    s_cmp_eq_u32 s42, 1
    s_cbranch_scc1 L2_ret1
    s_cmp_eq_u32 s42, 14
    s_cbranch_scc1 L2_ret6
    s_cmp_eq_u32 s42, 15
    s_cbranch_scc1 L2_ret7
    s_and_b32 s3, s42, 3
    s_cmp_eq_u32 s3, 2
    s_cbranch_scc1 L2_ret2
    s_cmp_eq_u32 s3, 3
    s_cbranch_scc1 L2_ret3
    s_cmp_eq_u32 s3, 0
    s_cbranch_scc1 L2_ret4
    s_branch L2_ret5
L2_p1s:
    s_sleep 32
    s_branch L2_p1
L2_xo3:
    v_cmp_lt_u32 vcc, 20, v99
    s_mov_b32 s101, 1
    s_cbranch_vccz L2_xp3
    v_cmp_lt_u32 vcc, 32, v99
    v_cmp_lt_u32 s[58:59], 31, v88
    s_mov_b32 s101, 2
    s_or_b64 vcc, vcc, s[58:59]
    s_cbranch_scc0 L2_xp3
    s_mov_b32 s37, 0x10000
    s_branch L2_xp3
L2_xa4:
    s_cmp_eq_u32 s101, 1
    s_cbranch_scc1 L2_xc4
    v_lshlrev_b32 v89, 0, v96
    v_add_u32 v90, 140, v97
    v_bitop3_b32 v90, v89, v45, v90 bitop3:0x6a
    ds_write_b32 v98, v90 offset:28
    v_lshlrev_b32 v89, 4, v96
    v_add_u32 v90, 120, v97
    v_bitop3_b32 v90, v89, v45, v90 bitop3:0x6a
    ds_write_b32 v98, v90 offset:24
    v_lshlrev_b32 v89, 8, v96
    v_add_u32 v90, 100, v97
    v_bitop3_b32 v90, v89, v45, v90 bitop3:0x6a
    ds_write_b32 v98, v90 offset:20
L2_xc4:
    v_lshlrev_b32 v89, 12, v96
    v_add_u32 v90, 80, v97
    v_bitop3_b32 v90, v89, v45, v90 bitop3:0x6a
    ds_write_b32 v98, v90 offset:16
    s_branch L2_xb4
L2_xe4:
    v_cmp_lt_u32 vcc, 32, v99
    v_cmp_lt_u32 s[58:59], 31, v88
    v_lshrrev_b32 v89, 16, v96
    v_add_u32 v97, 80, v97
    s_or_b64 vcc, vcc, s[58:59]
    s_cbranch_scc1 L2_xs4
    v_lshlrev_b32 v89, v1, v89
    v_and_b32 v89, v45, v89
    v_cmp_ne_u32 vcc, 0, v89
    v_xor_b32 v90, v97, v89
    s_add_u32 s3, s37, s38
    v_mbcnt_lo_u32_b32 v98, vcc_lo, 0
    v_mbcnt_hi_u32_b32 v98, vcc_hi, v98
    s_bcnt1_i32_b64 s41, vcc
    v_lshl_add_u32 v98, v98, 2, s3
    s_mov_b64 exec, vcc
    ds_write_b32 v98, v90
    s_mov_b64 exec, -1
    s_lshl2_add_u32 s37, s41, s37
    s_branch L2_xr4
L2_xf4:
    s_waitcnt lgkmcnt(0)
    s_cmp_gt_u32 s37, 1024
    s_cbranch_scc1 L2_xs4
    v_mov_b32 v43, -1
    s_cmp_ge_u32 s37, 512
    s_cbranch_scc1 L2_xg4
    v_mov_b32 v42, -1
    s_cmp_ge_u32 s37, 256
    s_cbranch_scc1 L2_xg4
    v_mov_b32 v41, -1
    s_branch L2_xg4
L2_xs4:
    s_waitcnt lgkmcnt(0)
    v_mov_b32 v40, -1
    v_mov_b32 v41, -1
    v_mov_b32 v42, -1
    v_mov_b32 v43, -1
    s_add_u32 s3, s42, 0
    s_bitset1_b32 s36, s3
    s_branch L2_xg4
L2_xo5:
    v_cmp_lt_u32 vcc, 20, v99
    s_mov_b32 s101, 1
    s_cbranch_vccz L2_xp5
    v_cmp_lt_u32 vcc, 32, v99
    v_cmp_lt_u32 s[58:59], 31, v88
    s_mov_b32 s101, 2
    s_or_b64 vcc, vcc, s[58:59]
    s_cbranch_scc0 L2_xp5
    s_mov_b32 s37, 0x10000
    s_branch L2_xp5
L2_xa6:
    s_cmp_eq_u32 s101, 1
    s_cbranch_scc1 L2_xc6
    v_lshlrev_b32 v89, 0, v96
    v_add_u32 v90, 140, v97
    v_bitop3_b32 v90, v89, v45, v90 bitop3:0x6a
    ds_write_b32 v98, v90 offset:28
    v_lshlrev_b32 v89, 4, v96
    v_add_u32 v90, 120, v97
    v_bitop3_b32 v90, v89, v45, v90 bitop3:0x6a
    ds_write_b32 v98, v90 offset:24
    v_lshlrev_b32 v89, 8, v96
    v_add_u32 v90, 100, v97
    v_bitop3_b32 v90, v89, v45, v90 bitop3:0x6a
    ds_write_b32 v98, v90 offset:20
L2_xc6:
    v_lshlrev_b32 v89, 12, v96
    v_add_u32 v90, 80, v97
    v_bitop3_b32 v90, v89, v45, v90 bitop3:0x6a
    ds_write_b32 v98, v90 offset:16
    s_branch L2_xb6
L2_xe6:
    v_cmp_lt_u32 vcc, 32, v99
    v_cmp_lt_u32 s[58:59], 31, v88
    v_lshrrev_b32 v89, 16, v96
    v_add_u32 v97, 80, v97
    s_or_b64 vcc, vcc, s[58:59]
    s_cbranch_scc1 L2_xs6
    v_lshlrev_b32 v89, v1, v89
    v_and_b32 v89, v45, v89
    v_cmp_ne_u32 vcc, 0, v89
    v_xor_b32 v90, v97, v89
    s_add_u32 s3, s37, s38
    v_mbcnt_lo_u32_b32 v98, vcc_lo, 0
    v_mbcnt_hi_u32_b32 v98, vcc_hi, v98
    s_bcnt1_i32_b64 s41, vcc
    v_lshl_add_u32 v98, v98, 2, s3
    s_mov_b64 exec, vcc
    ds_write_b32 v98, v90
    s_mov_b64 exec, -1
    s_lshl2_add_u32 s37, s41, s37
    s_branch L2_xr6
L2_xf6:
    s_waitcnt lgkmcnt(0)
    s_cmp_gt_u32 s37, 1024
    s_cbranch_scc1 L2_xs6
    v_mov_b32 v43, -1
    s_cmp_ge_u32 s37, 512
    s_cbranch_scc1 L2_xg6
    v_mov_b32 v42, -1
    s_cmp_ge_u32 s37, 256
    s_cbranch_scc1 L2_xg6
    v_mov_b32 v41, -1
    s_branch L2_xg6
L2_xs6:
    s_waitcnt lgkmcnt(0)
    v_mov_b32 v40, -1
    v_mov_b32 v41, -1
    v_mov_b32 v42, -1
    v_mov_b32 v43, -1
    s_add_u32 s3, s42, 1
    s_bitset1_b32 s36, s3
    s_branch L2_xg6
L2_p2s:
    s_sleep 8
    s_branch L2_p2
L2_c7:
    s_lshl_b64 s[52:53], s[82:83], 1
    s_andn2_b64 s[52:53], s[52:53], s[80:81]
    s_andn2_b64 s[52:53], s[52:53], s[54:55]
    s_or_b64 s[80:81], s[80:81], s[52:53]
    s_not_b64 vcc, s[52:53]
    s_mov_b64 exec, -1
    v_cndmask_b32_dpp v84, v84, v84, vcc wave_shr:1 row_mask:0xf bank_mask:0xf
    v_cndmask_b32_dpp v85, v85, v85, vcc wave_shr:1 row_mask:0xf bank_mask:0xf
    s_lshr_b64 s[52:53], s[52:53], 1
    v_cndmask_b32_dpp v86, v86, v86, vcc wave_shr:1 row_mask:0xf bank_mask:0xf
    v_cndmask_b32_dpp v87, v87, v87, vcc wave_shr:1 row_mask:0xf bank_mask:0xf
    s_andn2_b64 s[82:83], s[82:83], s[52:53]
    v_cndmask_b32_dpp v7, v7, v7, vcc wave_shr:1 row_mask:0xf bank_mask:0xf
    s_mov_b64 exec, s[54:55]
    s_cbranch_scc0 L2_d7
    s_mov_b64 exec, s[82:83]
    s_nop 1
    v_mfma_f32_4x4x4_16b_bf16 v[88:91], v[12:13], v[84:85], 0
    s_nop 1
    v_mfma_f32_4x4x4_16b_bf16 v[88:91], v[10:11], v[86:87], v[88:91]
    s_nop 4
    v_cvt_pk_bf16_f32 v88, v88, v89
    v_cvt_pk_bf16_f32 v89, v90, v91
    ds_pk_add_bf16 v7, v88 offset:65408
    ds_pk_add_bf16 v7, v89 offset:65412
    s_mov_b64 exec, s[54:55]
    s_branch L2_d7
L2_c8:
    s_lshl_b64 s[52:53], s[82:83], 1
    s_andn2_b64 s[52:53], s[52:53], s[80:81]
    s_andn2_b64 s[52:53], s[52:53], s[50:51]
    s_or_b64 s[80:81], s[80:81], s[52:53]
    s_not_b64 vcc, s[52:53]
    s_mov_b64 exec, -1
    v_cndmask_b32_dpp v84, v84, v84, vcc wave_shr:1 row_mask:0xf bank_mask:0xf
    v_cndmask_b32_dpp v85, v85, v85, vcc wave_shr:1 row_mask:0xf bank_mask:0xf
    s_lshr_b64 s[52:53], s[52:53], 1
    v_cndmask_b32_dpp v86, v86, v86, vcc wave_shr:1 row_mask:0xf bank_mask:0xf
    v_cndmask_b32_dpp v87, v87, v87, vcc wave_shr:1 row_mask:0xf bank_mask:0xf
    s_andn2_b64 s[82:83], s[82:83], s[52:53]
    v_cndmask_b32_dpp v7, v7, v7, vcc wave_shr:1 row_mask:0xf bank_mask:0xf
    s_mov_b64 exec, s[50:51]
    s_cbranch_scc0 L2_d8
    s_mov_b64 exec, s[82:83]
    s_nop 1
    v_mfma_f32_4x4x4_16b_bf16 v[88:91], v[12:13], v[84:85], 0
    s_nop 1
    v_mfma_f32_4x4x4_16b_bf16 v[88:91], v[10:11], v[86:87], v[88:91]
    s_nop 4
    v_cvt_pk_bf16_f32 v88, v88, v89
    v_cvt_pk_bf16_f32 v89, v90, v91
    ds_pk_add_bf16 v7, v88 offset:65408
    ds_pk_add_bf16 v7, v89 offset:65412
    s_mov_b64 exec, s[50:51]
    s_branch L2_d8
L2_xo9:
    v_cmp_lt_u32 vcc, 20, v99
    s_mov_b32 s101, 1
    s_cbranch_vccz L2_xp9
    v_cmp_lt_u32 vcc, 32, v99
    v_cmp_lt_u32 s[58:59], 31, v88
    s_mov_b32 s101, 2
    s_or_b64 vcc, vcc, s[58:59]
    s_cbranch_scc0 L2_xp9
    s_mov_b32 s37, 0x10000
    s_branch L2_xp9
L2_c12:
    s_lshl_b64 s[52:53], s[82:83], 1
    s_andn2_b64 s[52:53], s[52:53], s[80:81]
    s_andn2_b64 s[52:53], s[52:53], s[54:55]
    s_or_b64 s[80:81], s[80:81], s[52:53]
    s_not_b64 vcc, s[52:53]
    s_mov_b64 exec, -1
    v_cndmask_b32_dpp v84, v84, v84, vcc wave_shr:1 row_mask:0xf bank_mask:0xf
    v_cndmask_b32_dpp v85, v85, v85, vcc wave_shr:1 row_mask:0xf bank_mask:0xf
    s_lshr_b64 s[52:53], s[52:53], 1
    v_cndmask_b32_dpp v86, v86, v86, vcc wave_shr:1 row_mask:0xf bank_mask:0xf
    v_cndmask_b32_dpp v87, v87, v87, vcc wave_shr:1 row_mask:0xf bank_mask:0xf
    s_andn2_b64 s[82:83], s[82:83], s[52:53]
    v_cndmask_b32_dpp v7, v7, v7, vcc wave_shr:1 row_mask:0xf bank_mask:0xf
    s_mov_b64 exec, s[54:55]
    s_cbranch_scc0 L2_d12
    s_mov_b64 exec, s[82:83]
    s_nop 1
    v_mfma_f32_4x4x4_16b_bf16 v[88:91], v[12:13], v[84:85], 0
    s_nop 1
    v_mfma_f32_4x4x4_16b_bf16 v[88:91], v[10:11], v[86:87], v[88:91]
    s_nop 4
    v_cvt_pk_bf16_f32 v88, v88, v89
    v_cvt_pk_bf16_f32 v89, v90, v91
    ds_pk_add_bf16 v7, v88 offset:65408
    ds_pk_add_bf16 v7, v89 offset:65412
    s_mov_b64 exec, s[54:55]
    s_branch L2_d12
L2_c13:
    s_lshl_b64 s[52:53], s[82:83], 1
    s_andn2_b64 s[52:53], s[52:53], s[80:81]
    s_andn2_b64 s[52:53], s[52:53], s[50:51]
    s_or_b64 s[80:81], s[80:81], s[52:53]
    s_not_b64 vcc, s[52:53]
    s_mov_b64 exec, -1
    v_cndmask_b32_dpp v84, v84, v84, vcc wave_shr:1 row_mask:0xf bank_mask:0xf
    v_cndmask_b32_dpp v85, v85, v85, vcc wave_shr:1 row_mask:0xf bank_mask:0xf
    s_lshr_b64 s[52:53], s[52:53], 1
    v_cndmask_b32_dpp v86, v86, v86, vcc wave_shr:1 row_mask:0xf bank_mask:0xf
    v_cndmask_b32_dpp v87, v87, v87, vcc wave_shr:1 row_mask:0xf bank_mask:0xf
    s_andn2_b64 s[82:83], s[82:83], s[52:53]
    v_cndmask_b32_dpp v7, v7, v7, vcc wave_shr:1 row_mask:0xf bank_mask:0xf
    s_mov_b64 exec, s[50:51]
    s_cbranch_scc0 L2_d13
    s_mov_b64 exec, s[82:83]
    s_nop 1
    v_mfma_f32_4x4x4_16b_bf16 v[88:91], v[12:13], v[84:85], 0
    s_nop 1
    v_mfma_f32_4x4x4_16b_bf16 v[88:91], v[10:11], v[86:87], v[88:91]
    s_nop 4
    v_cvt_pk_bf16_f32 v88, v88, v89
    v_cvt_pk_bf16_f32 v89, v90, v91
    ds_pk_add_bf16 v7, v88 offset:65408
    ds_pk_add_bf16 v7, v89 offset:65412
    s_mov_b64 exec, s[50:51]
    s_branch L2_d13
L2_c15:
    s_lshl_b64 s[52:53], s[82:83], 1
    s_andn2_b64 s[52:53], s[52:53], s[80:81]
    s_andn2_b64 s[52:53], s[52:53], s[54:55]
    s_or_b64 s[80:81], s[80:81], s[52:53]
    s_not_b64 vcc, s[52:53]
    s_mov_b64 exec, -1
    v_cndmask_b32_dpp v84, v84, v84, vcc wave_shr:1 row_mask:0xf bank_mask:0xf
    v_cndmask_b32_dpp v85, v85, v85, vcc wave_shr:1 row_mask:0xf bank_mask:0xf
    s_lshr_b64 s[52:53], s[52:53], 1
    v_cndmask_b32_dpp v86, v86, v86, vcc wave_shr:1 row_mask:0xf bank_mask:0xf
    v_cndmask_b32_dpp v87, v87, v87, vcc wave_shr:1 row_mask:0xf bank_mask:0xf
    s_andn2_b64 s[82:83], s[82:83], s[52:53]
    v_cndmask_b32_dpp v7, v7, v7, vcc wave_shr:1 row_mask:0xf bank_mask:0xf
    s_mov_b64 exec, s[54:55]
    s_cbranch_scc0 L2_d15
    s_mov_b64 exec, s[82:83]
    s_nop 1
    v_mfma_f32_4x4x4_16b_bf16 v[88:91], v[12:13], v[84:85], 0
    s_nop 1
    v_mfma_f32_4x4x4_16b_bf16 v[88:91], v[10:11], v[86:87], v[88:91]
    s_nop 4
    v_cvt_pk_bf16_f32 v88, v88, v89
    v_cvt_pk_bf16_f32 v89, v90, v91
    ds_pk_add_bf16 v7, v88 offset:65408
    ds_pk_add_bf16 v7, v89 offset:65412
    s_mov_b64 exec, s[54:55]
    s_branch L2_d15
L2_c16:
    s_lshl_b64 s[52:53], s[82:83], 1
    s_andn2_b64 s[52:53], s[52:53], s[80:81]
    s_andn2_b64 s[52:53], s[52:53], s[50:51]
    s_or_b64 s[80:81], s[80:81], s[52:53]
    s_not_b64 vcc, s[52:53]
    s_mov_b64 exec, -1
    v_cndmask_b32_dpp v84, v84, v84, vcc wave_shr:1 row_mask:0xf bank_mask:0xf
    v_cndmask_b32_dpp v85, v85, v85, vcc wave_shr:1 row_mask:0xf bank_mask:0xf
    s_lshr_b64 s[52:53], s[52:53], 1
    v_cndmask_b32_dpp v86, v86, v86, vcc wave_shr:1 row_mask:0xf bank_mask:0xf
    v_cndmask_b32_dpp v87, v87, v87, vcc wave_shr:1 row_mask:0xf bank_mask:0xf
    s_andn2_b64 s[82:83], s[82:83], s[52:53]
    v_cndmask_b32_dpp v7, v7, v7, vcc wave_shr:1 row_mask:0xf bank_mask:0xf
    s_mov_b64 exec, s[50:51]
    s_cbranch_scc0 L2_d16
    s_mov_b64 exec, s[82:83]
    s_nop 1
    v_mfma_f32_4x4x4_16b_bf16 v[88:91], v[12:13], v[84:85], 0
    s_nop 1
    v_mfma_f32_4x4x4_16b_bf16 v[88:91], v[10:11], v[86:87], v[88:91]
    s_nop 4
    v_cvt_pk_bf16_f32 v88, v88, v89
    v_cvt_pk_bf16_f32 v89, v90, v91
    ds_pk_add_bf16 v7, v88 offset:65408
    ds_pk_add_bf16 v7, v89 offset:65412
    s_mov_b64 exec, s[50:51]
    s_branch L2_d16
L2_c19:
    s_lshl_b64 s[52:53], s[82:83], 1
    s_andn2_b64 s[52:53], s[52:53], s[80:81]
    s_andn2_b64 s[52:53], s[52:53], s[54:55]
    s_or_b64 s[80:81], s[80:81], s[52:53]
    s_not_b64 vcc, s[52:53]
    s_mov_b64 exec, -1
    v_cndmask_b32_dpp v84, v84, v84, vcc wave_shr:1 row_mask:0xf bank_mask:0xf
    v_cndmask_b32_dpp v85, v85, v85, vcc wave_shr:1 row_mask:0xf bank_mask:0xf
    s_lshr_b64 s[52:53], s[52:53], 1
    v_cndmask_b32_dpp v86, v86, v86, vcc wave_shr:1 row_mask:0xf bank_mask:0xf
    v_cndmask_b32_dpp v87, v87, v87, vcc wave_shr:1 row_mask:0xf bank_mask:0xf
    s_andn2_b64 s[82:83], s[82:83], s[52:53]
    v_cndmask_b32_dpp v7, v7, v7, vcc wave_shr:1 row_mask:0xf bank_mask:0xf
    s_mov_b64 exec, s[54:55]
    s_cbranch_scc0 L2_d19
    s_mov_b64 exec, s[82:83]
    s_nop 1
    v_mfma_f32_4x4x4_16b_bf16 v[88:91], v[12:13], v[84:85], 0
    s_nop 1
    v_mfma_f32_4x4x4_16b_bf16 v[88:91], v[10:11], v[86:87], v[88:91]
    s_nop 4
    v_cvt_pk_bf16_f32 v88, v88, v89
    v_cvt_pk_bf16_f32 v89, v90, v91
    ds_pk_add_bf16 v7, v88 offset:65408
    ds_pk_add_bf16 v7, v89 offset:65412
    s_mov_b64 exec, s[54:55]
    s_branch L2_d19
L2_c20:
    s_lshl_b64 s[52:53], s[82:83], 1
    s_andn2_b64 s[52:53], s[52:53], s[80:81]
    s_andn2_b64 s[52:53], s[52:53], s[50:51]
    s_or_b64 s[80:81], s[80:81], s[52:53]
    s_not_b64 vcc, s[52:53]
    s_mov_b64 exec, -1
    v_cndmask_b32_dpp v84, v84, v84, vcc wave_shr:1 row_mask:0xf bank_mask:0xf
    v_cndmask_b32_dpp v85, v85, v85, vcc wave_shr:1 row_mask:0xf bank_mask:0xf
    s_lshr_b64 s[52:53], s[52:53], 1
    v_cndmask_b32_dpp v86, v86, v86, vcc wave_shr:1 row_mask:0xf bank_mask:0xf
    v_cndmask_b32_dpp v87, v87, v87, vcc wave_shr:1 row_mask:0xf bank_mask:0xf
    s_andn2_b64 s[82:83], s[82:83], s[52:53]
    v_cndmask_b32_dpp v7, v7, v7, vcc wave_shr:1 row_mask:0xf bank_mask:0xf
    s_mov_b64 exec, s[50:51]
    s_cbranch_scc0 L2_d20
    s_mov_b64 exec, s[82:83]
    s_nop 1
    v_mfma_f32_4x4x4_16b_bf16 v[88:91], v[12:13], v[84:85], 0
    s_nop 1
    v_mfma_f32_4x4x4_16b_bf16 v[88:91], v[10:11], v[86:87], v[88:91]
    s_nop 4
    v_cvt_pk_bf16_f32 v88, v88, v89
    v_cvt_pk_bf16_f32 v89, v90, v91
    ds_pk_add_bf16 v7, v88 offset:65408
    ds_pk_add_bf16 v7, v89 offset:65412
    s_mov_b64 exec, s[50:51]
    s_branch L2_d20
L2_c21:
    s_lshl_b64 s[52:53], s[82:83], 1
    s_andn2_b64 s[52:53], s[52:53], s[80:81]
    s_andn2_b64 s[52:53], s[52:53], s[54:55]
    s_or_b64 s[80:81], s[80:81], s[52:53]
    s_not_b64 vcc, s[52:53]
    s_mov_b64 exec, -1
    v_cndmask_b32_dpp v84, v84, v84, vcc wave_shr:1 row_mask:0xf bank_mask:0xf
    v_cndmask_b32_dpp v85, v85, v85, vcc wave_shr:1 row_mask:0xf bank_mask:0xf
    s_lshr_b64 s[52:53], s[52:53], 1
    v_cndmask_b32_dpp v86, v86, v86, vcc wave_shr:1 row_mask:0xf bank_mask:0xf
    v_cndmask_b32_dpp v87, v87, v87, vcc wave_shr:1 row_mask:0xf bank_mask:0xf
    s_andn2_b64 s[82:83], s[82:83], s[52:53]
    v_cndmask_b32_dpp v7, v7, v7, vcc wave_shr:1 row_mask:0xf bank_mask:0xf
    s_mov_b64 exec, s[54:55]
    s_cbranch_scc0 L2_d21
    s_mov_b64 exec, s[82:83]
    s_nop 1
    v_mfma_f32_4x4x4_16b_bf16 v[88:91], v[12:13], v[84:85], 0
    s_nop 1
    v_mfma_f32_4x4x4_16b_bf16 v[88:91], v[10:11], v[86:87], v[88:91]
    s_nop 4
    v_cvt_pk_bf16_f32 v88, v88, v89
    v_cvt_pk_bf16_f32 v89, v90, v91
    ds_pk_add_bf16 v7, v88 offset:65408
    ds_pk_add_bf16 v7, v89 offset:65412
    s_mov_b64 exec, s[54:55]
    s_branch L2_d21
L2_c22:
    s_lshl_b64 s[52:53], s[82:83], 1
    s_andn2_b64 s[52:53], s[52:53], s[80:81]
    s_andn2_b64 s[52:53], s[52:53], s[50:51]
    s_or_b64 s[80:81], s[80:81], s[52:53]
    s_not_b64 vcc, s[52:53]
    s_mov_b64 exec, -1
    v_cndmask_b32_dpp v84, v84, v84, vcc wave_shr:1 row_mask:0xf bank_mask:0xf
    v_cndmask_b32_dpp v85, v85, v85, vcc wave_shr:1 row_mask:0xf bank_mask:0xf
    s_lshr_b64 s[52:53], s[52:53], 1
    v_cndmask_b32_dpp v86, v86, v86, vcc wave_shr:1 row_mask:0xf bank_mask:0xf
    v_cndmask_b32_dpp v87, v87, v87, vcc wave_shr:1 row_mask:0xf bank_mask:0xf
    s_andn2_b64 s[82:83], s[82:83], s[52:53]
    v_cndmask_b32_dpp v7, v7, v7, vcc wave_shr:1 row_mask:0xf bank_mask:0xf
    s_mov_b64 exec, s[50:51]
    s_cbranch_scc0 L2_d22
    s_mov_b64 exec, s[82:83]
    s_nop 1
    v_mfma_f32_4x4x4_16b_bf16 v[88:91], v[12:13], v[84:85], 0
    s_nop 1
    v_mfma_f32_4x4x4_16b_bf16 v[88:91], v[10:11], v[86:87], v[88:91]
    s_nop 4
    v_cvt_pk_bf16_f32 v88, v88, v89
    v_cvt_pk_bf16_f32 v89, v90, v91
    ds_pk_add_bf16 v7, v88 offset:65408
    ds_pk_add_bf16 v7, v89 offset:65412
    s_mov_b64 exec, s[50:51]
    s_branch L2_d22
L2_c23:
    s_lshl_b64 s[52:53], s[82:83], 1
    s_andn2_b64 s[52:53], s[52:53], s[80:81]
    s_andn2_b64 s[52:53], s[52:53], s[54:55]
    s_or_b64 s[80:81], s[80:81], s[52:53]
    s_not_b64 vcc, s[52:53]
    s_mov_b64 exec, -1
    v_cndmask_b32_dpp v84, v84, v84, vcc wave_shr:1 row_mask:0xf bank_mask:0xf
    v_cndmask_b32_dpp v85, v85, v85, vcc wave_shr:1 row_mask:0xf bank_mask:0xf
    s_lshr_b64 s[52:53], s[52:53], 1
    v_cndmask_b32_dpp v86, v86, v86, vcc wave_shr:1 row_mask:0xf bank_mask:0xf
    v_cndmask_b32_dpp v87, v87, v87, vcc wave_shr:1 row_mask:0xf bank_mask:0xf
    s_andn2_b64 s[82:83], s[82:83], s[52:53]
    v_cndmask_b32_dpp v7, v7, v7, vcc wave_shr:1 row_mask:0xf bank_mask:0xf
    s_mov_b64 exec, s[54:55]
    s_cbranch_scc0 L2_d23
    s_mov_b64 exec, s[82:83]
    s_nop 1
    v_mfma_f32_4x4x4_16b_bf16 v[88:91], v[12:13], v[84:85], 0
    s_nop 1
    v_mfma_f32_4x4x4_16b_bf16 v[88:91], v[10:11], v[86:87], v[88:91]
    s_nop 4
    v_cvt_pk_bf16_f32 v88, v88, v89
    v_cvt_pk_bf16_f32 v89, v90, v91
    ds_pk_add_bf16 v7, v88 offset:65408
    ds_pk_add_bf16 v7, v89 offset:65412
    s_mov_b64 exec, s[54:55]
    s_branch L2_d23
L2_c24:
    s_lshl_b64 s[52:53], s[82:83], 1
    s_andn2_b64 s[52:53], s[52:53], s[80:81]
    s_andn2_b64 s[52:53], s[52:53], s[50:51]
    s_or_b64 s[80:81], s[80:81], s[52:53]
    s_not_b64 vcc, s[52:53]
    s_mov_b64 exec, -1
    v_cndmask_b32_dpp v84, v84, v84, vcc wave_shr:1 row_mask:0xf bank_mask:0xf
    v_cndmask_b32_dpp v85, v85, v85, vcc wave_shr:1 row_mask:0xf bank_mask:0xf
    s_lshr_b64 s[52:53], s[52:53], 1
    v_cndmask_b32_dpp v86, v86, v86, vcc wave_shr:1 row_mask:0xf bank_mask:0xf
    v_cndmask_b32_dpp v87, v87, v87, vcc wave_shr:1 row_mask:0xf bank_mask:0xf
    s_andn2_b64 s[82:83], s[82:83], s[52:53]
    v_cndmask_b32_dpp v7, v7, v7, vcc wave_shr:1 row_mask:0xf bank_mask:0xf
    s_mov_b64 exec, s[50:51]
    s_cbranch_scc0 L2_d24
    s_mov_b64 exec, s[82:83]
    s_nop 1
    v_mfma_f32_4x4x4_16b_bf16 v[88:91], v[12:13], v[84:85], 0
    s_nop 1
    v_mfma_f32_4x4x4_16b_bf16 v[88:91], v[10:11], v[86:87], v[88:91]
    s_nop 4
    v_cvt_pk_bf16_f32 v88, v88, v89
    v_cvt_pk_bf16_f32 v89, v90, v91
    ds_pk_add_bf16 v7, v88 offset:65408
    ds_pk_add_bf16 v7, v89 offset:65412
    s_mov_b64 exec, s[50:51]
    s_branch L2_d24
L2_xa25:
    s_cmp_eq_u32 s101, 1
    s_cbranch_scc1 L2_xc25
    v_lshlrev_b32 v89, 0, v96
    v_add_u32 v90, 140, v97
    v_bitop3_b32 v90, v89, v45, v90 bitop3:0x6a
    ds_write_b32 v98, v90 offset:28
    v_lshlrev_b32 v89, 4, v96
    v_add_u32 v90, 120, v97
    v_bitop3_b32 v90, v89, v45, v90 bitop3:0x6a
    ds_write_b32 v98, v90 offset:24
    v_lshlrev_b32 v89, 8, v96
    v_add_u32 v90, 100, v97
    v_bitop3_b32 v90, v89, v45, v90 bitop3:0x6a
    ds_write_b32 v98, v90 offset:20
L2_xc25:
    v_lshlrev_b32 v89, 12, v96
    v_add_u32 v90, 80, v97
    v_bitop3_b32 v90, v89, v45, v90 bitop3:0x6a
    ds_write_b32 v98, v90 offset:16
    s_branch L2_xb25
L2_xe25:
    v_cmp_lt_u32 vcc, 32, v99
    v_cmp_lt_u32 s[58:59], 31, v88
    v_lshrrev_b32 v89, 16, v96
    v_add_u32 v97, 80, v97
    s_or_b64 vcc, vcc, s[58:59]
    s_cbranch_scc1 L2_xs25
    v_lshlrev_b32 v89, v1, v89
    v_and_b32 v89, v45, v89
    v_cmp_ne_u32 vcc, 0, v89
    v_xor_b32 v90, v97, v89
    s_add_u32 s3, s37, s38
    v_mbcnt_lo_u32_b32 v98, vcc_lo, 0
    v_mbcnt_hi_u32_b32 v98, vcc_hi, v98
    s_bcnt1_i32_b64 s41, vcc
    v_lshl_add_u32 v98, v98, 2, s3
    s_mov_b64 exec, vcc
    ds_write_b32 v98, v90
    s_mov_b64 exec, -1
    s_lshl2_add_u32 s37, s41, s37
    s_branch L2_xr25
L2_xf25:
    s_waitcnt lgkmcnt(0)
    s_cmp_gt_u32 s37, 1024
    s_cbranch_scc1 L2_xs25
    v_mov_b32 v43, -1
    s_cmp_ge_u32 s37, 512
    s_cbranch_scc1 L2_xg25
    v_mov_b32 v42, -1
    s_cmp_ge_u32 s37, 256
    s_cbranch_scc1 L2_xg25
    v_mov_b32 v41, -1
    s_branch L2_xg25
L2_xs25:
    s_waitcnt lgkmcnt(0)
    v_mov_b32 v40, -1
    v_mov_b32 v41, -1
    v_mov_b32 v42, -1
    v_mov_b32 v43, -1
    s_add_u32 s3, s42, 2
    s_bitset1_b32 s36, s3
    s_branch L2_xg25
L2_c26:
    s_lshl_b64 s[52:53], s[82:83], 1
    s_andn2_b64 s[52:53], s[52:53], s[80:81]
    s_andn2_b64 s[52:53], s[52:53], s[54:55]
    s_or_b64 s[80:81], s[80:81], s[52:53]
    s_not_b64 vcc, s[52:53]
    s_mov_b64 exec, -1
    v_cndmask_b32_dpp v84, v84, v84, vcc wave_shr:1 row_mask:0xf bank_mask:0xf
    v_cndmask_b32_dpp v85, v85, v85, vcc wave_shr:1 row_mask:0xf bank_mask:0xf
    s_lshr_b64 s[52:53], s[52:53], 1
    v_cndmask_b32_dpp v86, v86, v86, vcc wave_shr:1 row_mask:0xf bank_mask:0xf
    v_cndmask_b32_dpp v87, v87, v87, vcc wave_shr:1 row_mask:0xf bank_mask:0xf
    s_andn2_b64 s[82:83], s[82:83], s[52:53]
    v_cndmask_b32_dpp v7, v7, v7, vcc wave_shr:1 row_mask:0xf bank_mask:0xf
    s_mov_b64 exec, s[54:55]
    s_cbranch_scc0 L2_d26
    s_mov_b64 exec, s[82:83]
    s_nop 1
    v_mfma_f32_4x4x4_16b_bf16 v[88:91], v[12:13], v[84:85], 0
    s_nop 1
    v_mfma_f32_4x4x4_16b_bf16 v[88:91], v[10:11], v[86:87], v[88:91]
    s_nop 4
    v_cvt_pk_bf16_f32 v88, v88, v89
    v_cvt_pk_bf16_f32 v89, v90, v91
    ds_pk_add_bf16 v7, v88 offset:65408
    ds_pk_add_bf16 v7, v89 offset:65412
    s_mov_b64 exec, s[54:55]
    s_branch L2_d26
L2_c27:
    s_lshl_b64 s[52:53], s[82:83], 1
    s_andn2_b64 s[52:53], s[52:53], s[80:81]
    s_andn2_b64 s[52:53], s[52:53], s[50:51]
    s_or_b64 s[80:81], s[80:81], s[52:53]
    s_not_b64 vcc, s[52:53]
    s_mov_b64 exec, -1
    v_cndmask_b32_dpp v84, v84, v84, vcc wave_shr:1 row_mask:0xf bank_mask:0xf
    v_cndmask_b32_dpp v85, v85, v85, vcc wave_shr:1 row_mask:0xf bank_mask:0xf
    s_lshr_b64 s[52:53], s[52:53], 1
    v_cndmask_b32_dpp v86, v86, v86, vcc wave_shr:1 row_mask:0xf bank_mask:0xf
    v_cndmask_b32_dpp v87, v87, v87, vcc wave_shr:1 row_mask:0xf bank_mask:0xf
    s_andn2_b64 s[82:83], s[82:83], s[52:53]
    v_cndmask_b32_dpp v7, v7, v7, vcc wave_shr:1 row_mask:0xf bank_mask:0xf
    s_mov_b64 exec, s[50:51]
    s_cbranch_scc0 L2_d27
    s_mov_b64 exec, s[82:83]
    s_nop 1
    v_mfma_f32_4x4x4_16b_bf16 v[88:91], v[12:13], v[84:85], 0
    s_nop 1
    v_mfma_f32_4x4x4_16b_bf16 v[88:91], v[10:11], v[86:87], v[88:91]
    s_nop 4
    v_cvt_pk_bf16_f32 v88, v88, v89
    v_cvt_pk_bf16_f32 v89, v90, v91
    ds_pk_add_bf16 v7, v88 offset:65408
    ds_pk_add_bf16 v7, v89 offset:65412
    s_mov_b64 exec, s[50:51]
    s_branch L2_d27
L2_c28:
    s_lshl_b64 s[52:53], s[82:83], 1
    s_andn2_b64 s[52:53], s[52:53], s[80:81]
    s_andn2_b64 s[52:53], s[52:53], s[54:55]
    s_or_b64 s[80:81], s[80:81], s[52:53]
    s_not_b64 vcc, s[52:53]
    s_mov_b64 exec, -1
    v_cndmask_b32_dpp v84, v84, v84, vcc wave_shr:1 row_mask:0xf bank_mask:0xf
    v_cndmask_b32_dpp v85, v85, v85, vcc wave_shr:1 row_mask:0xf bank_mask:0xf
    s_lshr_b64 s[52:53], s[52:53], 1
    v_cndmask_b32_dpp v86, v86, v86, vcc wave_shr:1 row_mask:0xf bank_mask:0xf
    v_cndmask_b32_dpp v87, v87, v87, vcc wave_shr:1 row_mask:0xf bank_mask:0xf
    s_andn2_b64 s[82:83], s[82:83], s[52:53]
    v_cndmask_b32_dpp v7, v7, v7, vcc wave_shr:1 row_mask:0xf bank_mask:0xf
    s_mov_b64 exec, s[54:55]
    s_cbranch_scc0 L2_d28
    s_mov_b64 exec, s[82:83]
    s_nop 1
    v_mfma_f32_4x4x4_16b_bf16 v[88:91], v[12:13], v[84:85], 0
    s_nop 1
    v_mfma_f32_4x4x4_16b_bf16 v[88:91], v[10:11], v[86:87], v[88:91]
    s_nop 4
    v_cvt_pk_bf16_f32 v88, v88, v89
    v_cvt_pk_bf16_f32 v89, v90, v91
    ds_pk_add_bf16 v7, v88 offset:65408
    ds_pk_add_bf16 v7, v89 offset:65412
    s_mov_b64 exec, s[54:55]
    s_branch L2_d28
L2_c29:
    s_lshl_b64 s[52:53], s[82:83], 1
    s_andn2_b64 s[52:53], s[52:53], s[80:81]
    s_andn2_b64 s[52:53], s[52:53], s[50:51]
    s_or_b64 s[80:81], s[80:81], s[52:53]
    s_not_b64 vcc, s[52:53]
    s_mov_b64 exec, -1
    v_cndmask_b32_dpp v84, v84, v84, vcc wave_shr:1 row_mask:0xf bank_mask:0xf
    v_cndmask_b32_dpp v85, v85, v85, vcc wave_shr:1 row_mask:0xf bank_mask:0xf
    s_lshr_b64 s[52:53], s[52:53], 1
    v_cndmask_b32_dpp v86, v86, v86, vcc wave_shr:1 row_mask:0xf bank_mask:0xf
    v_cndmask_b32_dpp v87, v87, v87, vcc wave_shr:1 row_mask:0xf bank_mask:0xf
    s_andn2_b64 s[82:83], s[82:83], s[52:53]
    v_cndmask_b32_dpp v7, v7, v7, vcc wave_shr:1 row_mask:0xf bank_mask:0xf
    s_mov_b64 exec, s[50:51]
    s_cbranch_scc0 L2_d29
    s_mov_b64 exec, s[82:83]
    s_nop 1
    v_mfma_f32_4x4x4_16b_bf16 v[88:91], v[12:13], v[84:85], 0
    s_nop 1
    v_mfma_f32_4x4x4_16b_bf16 v[88:91], v[10:11], v[86:87], v[88:91]
    s_nop 4
    v_cvt_pk_bf16_f32 v88, v88, v89
    v_cvt_pk_bf16_f32 v89, v90, v91
    ds_pk_add_bf16 v7, v88 offset:65408
    ds_pk_add_bf16 v7, v89 offset:65412
    s_mov_b64 exec, s[50:51]
    s_branch L2_d29
L2_c30:
    s_lshl_b64 s[52:53], s[82:83], 1
    s_andn2_b64 s[52:53], s[52:53], s[80:81]
    s_andn2_b64 s[52:53], s[52:53], s[54:55]
    s_or_b64 s[80:81], s[80:81], s[52:53]
    s_not_b64 vcc, s[52:53]
    s_mov_b64 exec, -1
    v_cndmask_b32_dpp v84, v84, v84, vcc wave_shr:1 row_mask:0xf bank_mask:0xf
    v_cndmask_b32_dpp v85, v85, v85, vcc wave_shr:1 row_mask:0xf bank_mask:0xf
    s_lshr_b64 s[52:53], s[52:53], 1
    v_cndmask_b32_dpp v86, v86, v86, vcc wave_shr:1 row_mask:0xf bank_mask:0xf
    v_cndmask_b32_dpp v87, v87, v87, vcc wave_shr:1 row_mask:0xf bank_mask:0xf
    s_andn2_b64 s[82:83], s[82:83], s[52:53]
    v_cndmask_b32_dpp v7, v7, v7, vcc wave_shr:1 row_mask:0xf bank_mask:0xf
    s_mov_b64 exec, s[54:55]
    s_cbranch_scc0 L2_d30
    s_mov_b64 exec, s[82:83]
    s_nop 1
    v_mfma_f32_4x4x4_16b_bf16 v[88:91], v[12:13], v[84:85], 0
    s_nop 1
    v_mfma_f32_4x4x4_16b_bf16 v[88:91], v[10:11], v[86:87], v[88:91]
    s_nop 4
    v_cvt_pk_bf16_f32 v88, v88, v89
    v_cvt_pk_bf16_f32 v89, v90, v91
    ds_pk_add_bf16 v7, v88 offset:65408
    ds_pk_add_bf16 v7, v89 offset:65412
    s_mov_b64 exec, s[54:55]
    s_branch L2_d30
L2_c31:
    s_lshl_b64 s[52:53], s[82:83], 1
    s_andn2_b64 s[52:53], s[52:53], s[80:81]
    s_andn2_b64 s[52:53], s[52:53], s[50:51]
    s_or_b64 s[80:81], s[80:81], s[52:53]
    s_not_b64 vcc, s[52:53]
    s_mov_b64 exec, -1
    v_cndmask_b32_dpp v84, v84, v84, vcc wave_shr:1 row_mask:0xf bank_mask:0xf
    v_cndmask_b32_dpp v85, v85, v85, vcc wave_shr:1 row_mask:0xf bank_mask:0xf
    s_lshr_b64 s[52:53], s[52:53], 1
    v_cndmask_b32_dpp v86, v86, v86, vcc wave_shr:1 row_mask:0xf bank_mask:0xf
    v_cndmask_b32_dpp v87, v87, v87, vcc wave_shr:1 row_mask:0xf bank_mask:0xf
    s_andn2_b64 s[82:83], s[82:83], s[52:53]
    v_cndmask_b32_dpp v7, v7, v7, vcc wave_shr:1 row_mask:0xf bank_mask:0xf
    s_mov_b64 exec, s[50:51]
    s_cbranch_scc0 L2_d31
    s_mov_b64 exec, s[82:83]
    s_nop 1
    v_mfma_f32_4x4x4_16b_bf16 v[88:91], v[12:13], v[84:85], 0
    s_nop 1
    v_mfma_f32_4x4x4_16b_bf16 v[88:91], v[10:11], v[86:87], v[88:91]
    s_nop 4
    v_cvt_pk_bf16_f32 v88, v88, v89
    v_cvt_pk_bf16_f32 v89, v90, v91
    ds_pk_add_bf16 v7, v88 offset:65408
    ds_pk_add_bf16 v7, v89 offset:65412
    s_mov_b64 exec, s[50:51]
    s_branch L2_d31
L2_xo32:
    v_cmp_lt_u32 vcc, 20, v99
    s_mov_b32 s101, 1
    s_cbranch_vccz L2_xp32
    v_cmp_lt_u32 vcc, 32, v99
    v_cmp_lt_u32 s[58:59], 31, v88
    s_mov_b32 s101, 2
    s_or_b64 vcc, vcc, s[58:59]
    s_cbranch_scc0 L2_xp32
    s_mov_b32 s37, 0x10000
    s_branch L2_xp32
L2_c33:
    s_lshl_b64 s[52:53], s[82:83], 1
    s_andn2_b64 s[52:53], s[52:53], s[80:81]
    s_andn2_b64 s[52:53], s[52:53], s[54:55]
    s_or_b64 s[80:81], s[80:81], s[52:53]
    s_not_b64 vcc, s[52:53]
    s_mov_b64 exec, -1
    v_cndmask_b32_dpp v84, v84, v84, vcc wave_shr:1 row_mask:0xf bank_mask:0xf
    v_cndmask_b32_dpp v85, v85, v85, vcc wave_shr:1 row_mask:0xf bank_mask:0xf
    s_lshr_b64 s[52:53], s[52:53], 1
    v_cndmask_b32_dpp v86, v86, v86, vcc wave_shr:1 row_mask:0xf bank_mask:0xf
    v_cndmask_b32_dpp v87, v87, v87, vcc wave_shr:1 row_mask:0xf bank_mask:0xf
    s_andn2_b64 s[82:83], s[82:83], s[52:53]
    v_cndmask_b32_dpp v7, v7, v7, vcc wave_shr:1 row_mask:0xf bank_mask:0xf
    s_mov_b64 exec, s[54:55]
    s_cbranch_scc0 L2_d33
    s_mov_b64 exec, s[82:83]
    s_nop 1
    v_mfma_f32_4x4x4_16b_bf16 v[88:91], v[12:13], v[84:85], 0
    s_nop 1
    v_mfma_f32_4x4x4_16b_bf16 v[88:91], v[10:11], v[86:87], v[88:91]
    s_nop 4
    v_cvt_pk_bf16_f32 v88, v88, v89
    v_cvt_pk_bf16_f32 v89, v90, v91
    ds_pk_add_bf16 v7, v88 offset:65408
    ds_pk_add_bf16 v7, v89 offset:65412
    s_mov_b64 exec, s[54:55]
    s_branch L2_d33
L2_c34:
    s_lshl_b64 s[52:53], s[82:83], 1
    s_andn2_b64 s[52:53], s[52:53], s[80:81]
    s_andn2_b64 s[52:53], s[52:53], s[50:51]
    s_or_b64 s[80:81], s[80:81], s[52:53]
    s_not_b64 vcc, s[52:53]
    s_mov_b64 exec, -1
    v_cndmask_b32_dpp v84, v84, v84, vcc wave_shr:1 row_mask:0xf bank_mask:0xf
    v_cndmask_b32_dpp v85, v85, v85, vcc wave_shr:1 row_mask:0xf bank_mask:0xf
    s_lshr_b64 s[52:53], s[52:53], 1
    v_cndmask_b32_dpp v86, v86, v86, vcc wave_shr:1 row_mask:0xf bank_mask:0xf
    v_cndmask_b32_dpp v87, v87, v87, vcc wave_shr:1 row_mask:0xf bank_mask:0xf
    s_andn2_b64 s[82:83], s[82:83], s[52:53]
    v_cndmask_b32_dpp v7, v7, v7, vcc wave_shr:1 row_mask:0xf bank_mask:0xf
    s_mov_b64 exec, s[50:51]
    s_cbranch_scc0 L2_d34
    s_mov_b64 exec, s[82:83]
    s_nop 1
    v_mfma_f32_4x4x4_16b_bf16 v[88:91], v[12:13], v[84:85], 0
    s_nop 1
    v_mfma_f32_4x4x4_16b_bf16 v[88:91], v[10:11], v[86:87], v[88:91]
    s_nop 4
    v_cvt_pk_bf16_f32 v88, v88, v89
    v_cvt_pk_bf16_f32 v89, v90, v91
    ds_pk_add_bf16 v7, v88 offset:65408
    ds_pk_add_bf16 v7, v89 offset:65412
    s_mov_b64 exec, s[50:51]
    s_branch L2_d34
L2_c35:
    s_lshl_b64 s[52:53], s[82:83], 1
    s_andn2_b64 s[52:53], s[52:53], s[80:81]
    s_andn2_b64 s[52:53], s[52:53], s[54:55]
    s_or_b64 s[80:81], s[80:81], s[52:53]
    s_not_b64 vcc, s[52:53]
    s_mov_b64 exec, -1
    v_cndmask_b32_dpp v84, v84, v84, vcc wave_shr:1 row_mask:0xf bank_mask:0xf
    v_cndmask_b32_dpp v85, v85, v85, vcc wave_shr:1 row_mask:0xf bank_mask:0xf
    s_lshr_b64 s[52:53], s[52:53], 1
    v_cndmask_b32_dpp v86, v86, v86, vcc wave_shr:1 row_mask:0xf bank_mask:0xf
    v_cndmask_b32_dpp v87, v87, v87, vcc wave_shr:1 row_mask:0xf bank_mask:0xf
    s_andn2_b64 s[82:83], s[82:83], s[52:53]
    v_cndmask_b32_dpp v7, v7, v7, vcc wave_shr:1 row_mask:0xf bank_mask:0xf
    s_mov_b64 exec, s[54:55]
    s_cbranch_scc0 L2_d35
    s_mov_b64 exec, s[82:83]
    s_nop 1
    v_mfma_f32_4x4x4_16b_bf16 v[88:91], v[12:13], v[84:85], 0
    s_nop 1
    v_mfma_f32_4x4x4_16b_bf16 v[88:91], v[10:11], v[86:87], v[88:91]
    s_nop 4
    v_cvt_pk_bf16_f32 v88, v88, v89
    v_cvt_pk_bf16_f32 v89, v90, v91
    ds_pk_add_bf16 v7, v88 offset:65408
    ds_pk_add_bf16 v7, v89 offset:65412
    s_mov_b64 exec, s[54:55]
    s_branch L2_d35
L2_c36:
    s_lshl_b64 s[52:53], s[82:83], 1
    s_andn2_b64 s[52:53], s[52:53], s[80:81]
    s_andn2_b64 s[52:53], s[52:53], s[50:51]
    s_or_b64 s[80:81], s[80:81], s[52:53]
    s_not_b64 vcc, s[52:53]
    s_mov_b64 exec, -1
    v_cndmask_b32_dpp v84, v84, v84, vcc wave_shr:1 row_mask:0xf bank_mask:0xf
    v_cndmask_b32_dpp v85, v85, v85, vcc wave_shr:1 row_mask:0xf bank_mask:0xf
    s_lshr_b64 s[52:53], s[52:53], 1
    v_cndmask_b32_dpp v86, v86, v86, vcc wave_shr:1 row_mask:0xf bank_mask:0xf
    v_cndmask_b32_dpp v87, v87, v87, vcc wave_shr:1 row_mask:0xf bank_mask:0xf
    s_andn2_b64 s[82:83], s[82:83], s[52:53]
    v_cndmask_b32_dpp v7, v7, v7, vcc wave_shr:1 row_mask:0xf bank_mask:0xf
    s_mov_b64 exec, s[50:51]
    s_cbranch_scc0 L2_d36
    s_mov_b64 exec, s[82:83]
    s_nop 1
    v_mfma_f32_4x4x4_16b_bf16 v[88:91], v[12:13], v[84:85], 0
    s_nop 1
    v_mfma_f32_4x4x4_16b_bf16 v[88:91], v[10:11], v[86:87], v[88:91]
    s_nop 4
    v_cvt_pk_bf16_f32 v88, v88, v89
    v_cvt_pk_bf16_f32 v89, v90, v91
    ds_pk_add_bf16 v7, v88 offset:65408
    ds_pk_add_bf16 v7, v89 offset:65412
    s_mov_b64 exec, s[50:51]
    s_branch L2_d36
L2_c37:
    s_lshl_b64 s[52:53], s[82:83], 1
    s_andn2_b64 s[52:53], s[52:53], s[80:81]
    s_andn2_b64 s[52:53], s[52:53], s[54:55]
    s_or_b64 s[80:81], s[80:81], s[52:53]
    s_not_b64 vcc, s[52:53]
    s_mov_b64 exec, -1
    v_cndmask_b32_dpp v84, v84, v84, vcc wave_shr:1 row_mask:0xf bank_mask:0xf
    v_cndmask_b32_dpp v85, v85, v85, vcc wave_shr:1 row_mask:0xf bank_mask:0xf
    s_lshr_b64 s[52:53], s[52:53], 1
    v_cndmask_b32_dpp v86, v86, v86, vcc wave_shr:1 row_mask:0xf bank_mask:0xf
    v_cndmask_b32_dpp v87, v87, v87, vcc wave_shr:1 row_mask:0xf bank_mask:0xf
    s_andn2_b64 s[82:83], s[82:83], s[52:53]
    v_cndmask_b32_dpp v7, v7, v7, vcc wave_shr:1 row_mask:0xf bank_mask:0xf
    s_mov_b64 exec, s[54:55]
    s_cbranch_scc0 L2_d37
    s_mov_b64 exec, s[82:83]
    s_nop 1
    v_mfma_f32_4x4x4_16b_bf16 v[88:91], v[12:13], v[84:85], 0
    s_nop 1
    v_mfma_f32_4x4x4_16b_bf16 v[88:91], v[10:11], v[86:87], v[88:91]
    s_nop 4
    v_cvt_pk_bf16_f32 v88, v88, v89
    v_cvt_pk_bf16_f32 v89, v90, v91
    ds_pk_add_bf16 v7, v88 offset:65408
    ds_pk_add_bf16 v7, v89 offset:65412
    s_mov_b64 exec, s[54:55]
    s_branch L2_d37
L2_c38:
    s_lshl_b64 s[52:53], s[82:83], 1
    s_andn2_b64 s[52:53], s[52:53], s[80:81]
    s_andn2_b64 s[52:53], s[52:53], s[50:51]
    s_or_b64 s[80:81], s[80:81], s[52:53]
    s_not_b64 vcc, s[52:53]
    s_mov_b64 exec, -1
    v_cndmask_b32_dpp v84, v84, v84, vcc wave_shr:1 row_mask:0xf bank_mask:0xf
    v_cndmask_b32_dpp v85, v85, v85, vcc wave_shr:1 row_mask:0xf bank_mask:0xf
    s_lshr_b64 s[52:53], s[52:53], 1
    v_cndmask_b32_dpp v86, v86, v86, vcc wave_shr:1 row_mask:0xf bank_mask:0xf
    v_cndmask_b32_dpp v87, v87, v87, vcc wave_shr:1 row_mask:0xf bank_mask:0xf
    s_andn2_b64 s[82:83], s[82:83], s[52:53]
    v_cndmask_b32_dpp v7, v7, v7, vcc wave_shr:1 row_mask:0xf bank_mask:0xf
    s_mov_b64 exec, s[50:51]
    s_cbranch_scc0 L2_d38
    s_mov_b64 exec, s[82:83]
    s_nop 1
    v_mfma_f32_4x4x4_16b_bf16 v[88:91], v[12:13], v[84:85], 0
    s_nop 1
    v_mfma_f32_4x4x4_16b_bf16 v[88:91], v[10:11], v[86:87], v[88:91]
    s_nop 4
    v_cvt_pk_bf16_f32 v88, v88, v89
    v_cvt_pk_bf16_f32 v89, v90, v91
    ds_pk_add_bf16 v7, v88 offset:65408
    ds_pk_add_bf16 v7, v89 offset:65412
    s_mov_b64 exec, s[50:51]
    s_branch L2_d38
L2_c39:
    s_lshl_b64 s[52:53], s[82:83], 1
    s_andn2_b64 s[52:53], s[52:53], s[80:81]
    s_andn2_b64 s[52:53], s[52:53], s[54:55]
    s_or_b64 s[80:81], s[80:81], s[52:53]
    s_not_b64 vcc, s[52:53]
    s_mov_b64 exec, -1
    v_cndmask_b32_dpp v84, v84, v84, vcc wave_shr:1 row_mask:0xf bank_mask:0xf
    v_cndmask_b32_dpp v85, v85, v85, vcc wave_shr:1 row_mask:0xf bank_mask:0xf
    s_lshr_b64 s[52:53], s[52:53], 1
    v_cndmask_b32_dpp v86, v86, v86, vcc wave_shr:1 row_mask:0xf bank_mask:0xf
    v_cndmask_b32_dpp v87, v87, v87, vcc wave_shr:1 row_mask:0xf bank_mask:0xf
    s_andn2_b64 s[82:83], s[82:83], s[52:53]
    v_cndmask_b32_dpp v7, v7, v7, vcc wave_shr:1 row_mask:0xf bank_mask:0xf
    s_mov_b64 exec, s[54:55]
    s_cbranch_scc0 L2_d39
    s_mov_b64 exec, s[82:83]
    s_nop 1
    v_mfma_f32_4x4x4_16b_bf16 v[88:91], v[12:13], v[84:85], 0
    s_nop 1
    v_mfma_f32_4x4x4_16b_bf16 v[88:91], v[10:11], v[86:87], v[88:91]
    s_nop 4
    v_cvt_pk_bf16_f32 v88, v88, v89
    v_cvt_pk_bf16_f32 v89, v90, v91
    ds_pk_add_bf16 v7, v88 offset:65408
    ds_pk_add_bf16 v7, v89 offset:65412
    s_mov_b64 exec, s[54:55]
    s_branch L2_d39
L2_c40:
    s_lshl_b64 s[52:53], s[82:83], 1
    s_andn2_b64 s[52:53], s[52:53], s[80:81]
    s_andn2_b64 s[52:53], s[52:53], s[50:51]
    s_or_b64 s[80:81], s[80:81], s[52:53]
    s_not_b64 vcc, s[52:53]
    s_mov_b64 exec, -1
    v_cndmask_b32_dpp v84, v84, v84, vcc wave_shr:1 row_mask:0xf bank_mask:0xf
    v_cndmask_b32_dpp v85, v85, v85, vcc wave_shr:1 row_mask:0xf bank_mask:0xf
    s_lshr_b64 s[52:53], s[52:53], 1
    v_cndmask_b32_dpp v86, v86, v86, vcc wave_shr:1 row_mask:0xf bank_mask:0xf
    v_cndmask_b32_dpp v87, v87, v87, vcc wave_shr:1 row_mask:0xf bank_mask:0xf
    s_andn2_b64 s[82:83], s[82:83], s[52:53]
    v_cndmask_b32_dpp v7, v7, v7, vcc wave_shr:1 row_mask:0xf bank_mask:0xf
    s_mov_b64 exec, s[50:51]
    s_cbranch_scc0 L2_d40
    s_mov_b64 exec, s[82:83]
    s_nop 1
    v_mfma_f32_4x4x4_16b_bf16 v[88:91], v[12:13], v[84:85], 0
    s_nop 1
    v_mfma_f32_4x4x4_16b_bf16 v[88:91], v[10:11], v[86:87], v[88:91]
    s_nop 4
    v_cvt_pk_bf16_f32 v88, v88, v89
    v_cvt_pk_bf16_f32 v89, v90, v91
    ds_pk_add_bf16 v7, v88 offset:65408
    ds_pk_add_bf16 v7, v89 offset:65412
    s_mov_b64 exec, s[50:51]
    s_branch L2_d40
L2_c41:
    s_lshl_b64 s[52:53], s[82:83], 1
    s_andn2_b64 s[52:53], s[52:53], s[80:81]
    s_andn2_b64 s[52:53], s[52:53], s[54:55]
    s_or_b64 s[80:81], s[80:81], s[52:53]
    s_not_b64 vcc, s[52:53]
    s_mov_b64 exec, -1
    v_cndmask_b32_dpp v84, v84, v84, vcc wave_shr:1 row_mask:0xf bank_mask:0xf
    v_cndmask_b32_dpp v85, v85, v85, vcc wave_shr:1 row_mask:0xf bank_mask:0xf
    s_lshr_b64 s[52:53], s[52:53], 1
    v_cndmask_b32_dpp v86, v86, v86, vcc wave_shr:1 row_mask:0xf bank_mask:0xf
    v_cndmask_b32_dpp v87, v87, v87, vcc wave_shr:1 row_mask:0xf bank_mask:0xf
    s_andn2_b64 s[82:83], s[82:83], s[52:53]
    v_cndmask_b32_dpp v7, v7, v7, vcc wave_shr:1 row_mask:0xf bank_mask:0xf
    s_mov_b64 exec, s[54:55]
    s_cbranch_scc0 L2_d41
    s_mov_b64 exec, s[82:83]
    s_nop 1
    v_mfma_f32_4x4x4_16b_bf16 v[88:91], v[12:13], v[84:85], 0
    s_nop 1
    v_mfma_f32_4x4x4_16b_bf16 v[88:91], v[10:11], v[86:87], v[88:91]
    s_nop 4
    v_cvt_pk_bf16_f32 v88, v88, v89
    v_cvt_pk_bf16_f32 v89, v90, v91
    ds_pk_add_bf16 v7, v88 offset:65408
    ds_pk_add_bf16 v7, v89 offset:65412
    s_mov_b64 exec, s[54:55]
    s_branch L2_d41
L2_c42:
    s_lshl_b64 s[52:53], s[82:83], 1
    s_andn2_b64 s[52:53], s[52:53], s[80:81]
    s_andn2_b64 s[52:53], s[52:53], s[50:51]
    s_or_b64 s[80:81], s[80:81], s[52:53]
    s_not_b64 vcc, s[52:53]
    s_mov_b64 exec, -1
    v_cndmask_b32_dpp v84, v84, v84, vcc wave_shr:1 row_mask:0xf bank_mask:0xf
    v_cndmask_b32_dpp v85, v85, v85, vcc wave_shr:1 row_mask:0xf bank_mask:0xf
    s_lshr_b64 s[52:53], s[52:53], 1
    v_cndmask_b32_dpp v86, v86, v86, vcc wave_shr:1 row_mask:0xf bank_mask:0xf
    v_cndmask_b32_dpp v87, v87, v87, vcc wave_shr:1 row_mask:0xf bank_mask:0xf
    s_andn2_b64 s[82:83], s[82:83], s[52:53]
    v_cndmask_b32_dpp v7, v7, v7, vcc wave_shr:1 row_mask:0xf bank_mask:0xf
    s_mov_b64 exec, s[50:51]
    s_cbranch_scc0 L2_d42
    s_mov_b64 exec, s[82:83]
    s_nop 1
    v_mfma_f32_4x4x4_16b_bf16 v[88:91], v[12:13], v[84:85], 0
    s_nop 1
    v_mfma_f32_4x4x4_16b_bf16 v[88:91], v[10:11], v[86:87], v[88:91]
    s_nop 4
    v_cvt_pk_bf16_f32 v88, v88, v89
    v_cvt_pk_bf16_f32 v89, v90, v91
    ds_pk_add_bf16 v7, v88 offset:65408
    ds_pk_add_bf16 v7, v89 offset:65412
    s_mov_b64 exec, s[50:51]
    s_branch L2_d42
L2_xa43:
    s_cmp_eq_u32 s101, 1
    s_cbranch_scc1 L2_xc43
    v_lshlrev_b32 v89, 0, v96
    v_add_u32 v90, 140, v97
    v_bitop3_b32 v90, v89, v45, v90 bitop3:0x6a
    ds_write_b32 v98, v90 offset:28
    v_lshlrev_b32 v89, 4, v96
    v_add_u32 v90, 120, v97
    v_bitop3_b32 v90, v89, v45, v90 bitop3:0x6a
    ds_write_b32 v98, v90 offset:24
    v_lshlrev_b32 v89, 8, v96
    v_add_u32 v90, 100, v97
    v_bitop3_b32 v90, v89, v45, v90 bitop3:0x6a
    ds_write_b32 v98, v90 offset:20
L2_xc43:
    v_lshlrev_b32 v89, 12, v96
    v_add_u32 v90, 80, v97
    v_bitop3_b32 v90, v89, v45, v90 bitop3:0x6a
    ds_write_b32 v98, v90 offset:16
    s_branch L2_xb43
L2_xe43:
    v_cmp_lt_u32 vcc, 32, v99
    v_cmp_lt_u32 s[58:59], 31, v88
    v_lshrrev_b32 v89, 16, v96
    v_add_u32 v97, 80, v97
    s_or_b64 vcc, vcc, s[58:59]
    s_cbranch_scc1 L2_xs43
    v_lshlrev_b32 v89, v1, v89
    v_and_b32 v89, v45, v89
    v_cmp_ne_u32 vcc, 0, v89
    v_xor_b32 v90, v97, v89
    s_add_u32 s3, s37, s38
    v_mbcnt_lo_u32_b32 v98, vcc_lo, 0
    v_mbcnt_hi_u32_b32 v98, vcc_hi, v98
    s_bcnt1_i32_b64 s41, vcc
    v_lshl_add_u32 v98, v98, 2, s3
    s_mov_b64 exec, vcc
    ds_write_b32 v98, v90
    s_mov_b64 exec, -1
    s_lshl2_add_u32 s37, s41, s37
    s_branch L2_xr43
L2_xf43:
    s_waitcnt lgkmcnt(0)
    s_cmp_gt_u32 s37, 1024
    s_cbranch_scc1 L2_xs43
    v_mov_b32 v43, -1
    s_cmp_ge_u32 s37, 512
    s_cbranch_scc1 L2_xg43
    v_mov_b32 v42, -1
    s_cmp_ge_u32 s37, 256
    s_cbranch_scc1 L2_xg43
    v_mov_b32 v41, -1
    s_branch L2_xg43
L2_xs43:
    s_waitcnt lgkmcnt(0)
    v_mov_b32 v40, -1
    v_mov_b32 v41, -1
    v_mov_b32 v42, -1
    v_mov_b32 v43, -1
    s_add_u32 s3, s42, 2
    s_bitset1_b32 s36, s3
    s_branch L2_xg43
L2_c44:
    s_lshl_b64 s[52:53], s[82:83], 1
    s_andn2_b64 s[52:53], s[52:53], s[80:81]
    s_andn2_b64 s[52:53], s[52:53], s[54:55]
    s_or_b64 s[80:81], s[80:81], s[52:53]
    s_not_b64 vcc, s[52:53]
    s_mov_b64 exec, -1
    v_cndmask_b32_dpp v84, v84, v84, vcc wave_shr:1 row_mask:0xf bank_mask:0xf
    v_cndmask_b32_dpp v85, v85, v85, vcc wave_shr:1 row_mask:0xf bank_mask:0xf
    s_lshr_b64 s[52:53], s[52:53], 1
    v_cndmask_b32_dpp v86, v86, v86, vcc wave_shr:1 row_mask:0xf bank_mask:0xf
    v_cndmask_b32_dpp v87, v87, v87, vcc wave_shr:1 row_mask:0xf bank_mask:0xf
    s_andn2_b64 s[82:83], s[82:83], s[52:53]
    v_cndmask_b32_dpp v7, v7, v7, vcc wave_shr:1 row_mask:0xf bank_mask:0xf
    s_mov_b64 exec, s[54:55]
    s_cbranch_scc0 L2_d44
    s_mov_b64 exec, s[82:83]
    s_nop 1
    v_mfma_f32_4x4x4_16b_bf16 v[88:91], v[12:13], v[84:85], 0
    s_nop 1
    v_mfma_f32_4x4x4_16b_bf16 v[88:91], v[10:11], v[86:87], v[88:91]
    s_nop 4
    v_cvt_pk_bf16_f32 v88, v88, v89
    v_cvt_pk_bf16_f32 v89, v90, v91
    ds_pk_add_bf16 v7, v88 offset:65408
    ds_pk_add_bf16 v7, v89 offset:65412
    s_mov_b64 exec, s[54:55]
    s_branch L2_d44
L2_c45:
    s_lshl_b64 s[52:53], s[82:83], 1
    s_andn2_b64 s[52:53], s[52:53], s[80:81]
    s_andn2_b64 s[52:53], s[52:53], s[50:51]
    s_or_b64 s[80:81], s[80:81], s[52:53]
    s_not_b64 vcc, s[52:53]
    s_mov_b64 exec, -1
    v_cndmask_b32_dpp v84, v84, v84, vcc wave_shr:1 row_mask:0xf bank_mask:0xf
    v_cndmask_b32_dpp v85, v85, v85, vcc wave_shr:1 row_mask:0xf bank_mask:0xf
    s_lshr_b64 s[52:53], s[52:53], 1
    v_cndmask_b32_dpp v86, v86, v86, vcc wave_shr:1 row_mask:0xf bank_mask:0xf
    v_cndmask_b32_dpp v87, v87, v87, vcc wave_shr:1 row_mask:0xf bank_mask:0xf
    s_andn2_b64 s[82:83], s[82:83], s[52:53]
    v_cndmask_b32_dpp v7, v7, v7, vcc wave_shr:1 row_mask:0xf bank_mask:0xf
    s_mov_b64 exec, s[50:51]
    s_cbranch_scc0 L2_d45
    s_mov_b64 exec, s[82:83]
    s_nop 1
    v_mfma_f32_4x4x4_16b_bf16 v[88:91], v[12:13], v[84:85], 0
    s_nop 1
    v_mfma_f32_4x4x4_16b_bf16 v[88:91], v[10:11], v[86:87], v[88:91]
    s_nop 4
    v_cvt_pk_bf16_f32 v88, v88, v89
    v_cvt_pk_bf16_f32 v89, v90, v91
    ds_pk_add_bf16 v7, v88 offset:65408
    ds_pk_add_bf16 v7, v89 offset:65412
    s_mov_b64 exec, s[50:51]
    s_branch L2_d45
L2_c46:
    s_lshl_b64 s[52:53], s[82:83], 1
    s_andn2_b64 s[52:53], s[52:53], s[80:81]
    s_andn2_b64 s[52:53], s[52:53], s[54:55]
    s_or_b64 s[80:81], s[80:81], s[52:53]
    s_not_b64 vcc, s[52:53]
    s_mov_b64 exec, -1
    v_cndmask_b32_dpp v84, v84, v84, vcc wave_shr:1 row_mask:0xf bank_mask:0xf
    v_cndmask_b32_dpp v85, v85, v85, vcc wave_shr:1 row_mask:0xf bank_mask:0xf
    s_lshr_b64 s[52:53], s[52:53], 1
    v_cndmask_b32_dpp v86, v86, v86, vcc wave_shr:1 row_mask:0xf bank_mask:0xf
    v_cndmask_b32_dpp v87, v87, v87, vcc wave_shr:1 row_mask:0xf bank_mask:0xf
    s_andn2_b64 s[82:83], s[82:83], s[52:53]
    v_cndmask_b32_dpp v7, v7, v7, vcc wave_shr:1 row_mask:0xf bank_mask:0xf
    s_mov_b64 exec, s[54:55]
    s_cbranch_scc0 L2_d46
    s_mov_b64 exec, s[82:83]
    s_nop 1
    v_mfma_f32_4x4x4_16b_bf16 v[88:91], v[12:13], v[84:85], 0
    s_nop 1
    v_mfma_f32_4x4x4_16b_bf16 v[88:91], v[10:11], v[86:87], v[88:91]
    s_nop 4
    v_cvt_pk_bf16_f32 v88, v88, v89
    v_cvt_pk_bf16_f32 v89, v90, v91
    ds_pk_add_bf16 v7, v88 offset:65408
    ds_pk_add_bf16 v7, v89 offset:65412
    s_mov_b64 exec, s[54:55]
    s_branch L2_d46
L2_c47:
    s_lshl_b64 s[52:53], s[82:83], 1
    s_andn2_b64 s[52:53], s[52:53], s[80:81]
    s_andn2_b64 s[52:53], s[52:53], s[50:51]
    s_or_b64 s[80:81], s[80:81], s[52:53]
    s_not_b64 vcc, s[52:53]
    s_mov_b64 exec, -1
    v_cndmask_b32_dpp v84, v84, v84, vcc wave_shr:1 row_mask:0xf bank_mask:0xf
    v_cndmask_b32_dpp v85, v85, v85, vcc wave_shr:1 row_mask:0xf bank_mask:0xf
    s_lshr_b64 s[52:53], s[52:53], 1
    v_cndmask_b32_dpp v86, v86, v86, vcc wave_shr:1 row_mask:0xf bank_mask:0xf
    v_cndmask_b32_dpp v87, v87, v87, vcc wave_shr:1 row_mask:0xf bank_mask:0xf
    s_andn2_b64 s[82:83], s[82:83], s[52:53]
    v_cndmask_b32_dpp v7, v7, v7, vcc wave_shr:1 row_mask:0xf bank_mask:0xf
    s_mov_b64 exec, s[50:51]
    s_cbranch_scc0 L2_d47
    s_mov_b64 exec, s[82:83]
    s_nop 1
    v_mfma_f32_4x4x4_16b_bf16 v[88:91], v[12:13], v[84:85], 0
    s_nop 1
    v_mfma_f32_4x4x4_16b_bf16 v[88:91], v[10:11], v[86:87], v[88:91]
    s_nop 4
    v_cvt_pk_bf16_f32 v88, v88, v89
    v_cvt_pk_bf16_f32 v89, v90, v91
    ds_pk_add_bf16 v7, v88 offset:65408
    ds_pk_add_bf16 v7, v89 offset:65412
    s_mov_b64 exec, s[50:51]
    s_branch L2_d47
L2_c48:
    s_lshl_b64 s[52:53], s[82:83], 1
    s_andn2_b64 s[52:53], s[52:53], s[80:81]
    s_andn2_b64 s[52:53], s[52:53], s[54:55]
    s_or_b64 s[80:81], s[80:81], s[52:53]
    s_not_b64 vcc, s[52:53]
    s_mov_b64 exec, -1
    v_cndmask_b32_dpp v84, v84, v84, vcc wave_shr:1 row_mask:0xf bank_mask:0xf
    v_cndmask_b32_dpp v85, v85, v85, vcc wave_shr:1 row_mask:0xf bank_mask:0xf
    s_lshr_b64 s[52:53], s[52:53], 1
    v_cndmask_b32_dpp v86, v86, v86, vcc wave_shr:1 row_mask:0xf bank_mask:0xf
    v_cndmask_b32_dpp v87, v87, v87, vcc wave_shr:1 row_mask:0xf bank_mask:0xf
    s_andn2_b64 s[82:83], s[82:83], s[52:53]
    v_cndmask_b32_dpp v7, v7, v7, vcc wave_shr:1 row_mask:0xf bank_mask:0xf
    s_mov_b64 exec, s[54:55]
    s_cbranch_scc0 L2_d48
    s_mov_b64 exec, s[82:83]
    s_nop 1
    v_mfma_f32_4x4x4_16b_bf16 v[88:91], v[12:13], v[84:85], 0
    s_nop 1
    v_mfma_f32_4x4x4_16b_bf16 v[88:91], v[10:11], v[86:87], v[88:91]
    s_nop 4
    v_cvt_pk_bf16_f32 v88, v88, v89
    v_cvt_pk_bf16_f32 v89, v90, v91
    ds_pk_add_bf16 v7, v88 offset:65408
    ds_pk_add_bf16 v7, v89 offset:65412
    s_mov_b64 exec, s[54:55]
    s_branch L2_d48
L2_c49:
    s_lshl_b64 s[52:53], s[82:83], 1
    s_andn2_b64 s[52:53], s[52:53], s[80:81]
    s_andn2_b64 s[52:53], s[52:53], s[50:51]
    s_or_b64 s[80:81], s[80:81], s[52:53]
    s_not_b64 vcc, s[52:53]
    s_mov_b64 exec, -1
    v_cndmask_b32_dpp v84, v84, v84, vcc wave_shr:1 row_mask:0xf bank_mask:0xf
    v_cndmask_b32_dpp v85, v85, v85, vcc wave_shr:1 row_mask:0xf bank_mask:0xf
    s_lshr_b64 s[52:53], s[52:53], 1
    v_cndmask_b32_dpp v86, v86, v86, vcc wave_shr:1 row_mask:0xf bank_mask:0xf
    v_cndmask_b32_dpp v87, v87, v87, vcc wave_shr:1 row_mask:0xf bank_mask:0xf
    s_andn2_b64 s[82:83], s[82:83], s[52:53]
    v_cndmask_b32_dpp v7, v7, v7, vcc wave_shr:1 row_mask:0xf bank_mask:0xf
    s_mov_b64 exec, s[50:51]
    s_cbranch_scc0 L2_d49
    s_mov_b64 exec, s[82:83]
    s_nop 1
    v_mfma_f32_4x4x4_16b_bf16 v[88:91], v[12:13], v[84:85], 0
    s_nop 1
    v_mfma_f32_4x4x4_16b_bf16 v[88:91], v[10:11], v[86:87], v[88:91]
    s_nop 4
    v_cvt_pk_bf16_f32 v88, v88, v89
    v_cvt_pk_bf16_f32 v89, v90, v91
    ds_pk_add_bf16 v7, v88 offset:65408
    ds_pk_add_bf16 v7, v89 offset:65412
    s_mov_b64 exec, s[50:51]
    s_branch L2_d49
L2_xo50:
    v_cmp_lt_u32 vcc, 20, v99
    s_mov_b32 s101, 1
    s_cbranch_vccz L2_xp50
    v_cmp_lt_u32 vcc, 32, v99
    v_cmp_lt_u32 s[58:59], 31, v88
    s_mov_b32 s101, 2
    s_or_b64 vcc, vcc, s[58:59]
    s_cbranch_scc0 L2_xp50
    s_mov_b32 s37, 0x10000
    s_branch L2_xp50
L2_c51:
    s_lshl_b64 s[52:53], s[82:83], 1
    s_andn2_b64 s[52:53], s[52:53], s[80:81]
    s_andn2_b64 s[52:53], s[52:53], s[54:55]
    s_or_b64 s[80:81], s[80:81], s[52:53]
    s_not_b64 vcc, s[52:53]
    s_mov_b64 exec, -1
    v_cndmask_b32_dpp v84, v84, v84, vcc wave_shr:1 row_mask:0xf bank_mask:0xf
    v_cndmask_b32_dpp v85, v85, v85, vcc wave_shr:1 row_mask:0xf bank_mask:0xf
    s_lshr_b64 s[52:53], s[52:53], 1
    v_cndmask_b32_dpp v86, v86, v86, vcc wave_shr:1 row_mask:0xf bank_mask:0xf
    v_cndmask_b32_dpp v87, v87, v87, vcc wave_shr:1 row_mask:0xf bank_mask:0xf
    s_andn2_b64 s[82:83], s[82:83], s[52:53]
    v_cndmask_b32_dpp v7, v7, v7, vcc wave_shr:1 row_mask:0xf bank_mask:0xf
    s_mov_b64 exec, s[54:55]
    s_cbranch_scc0 L2_d51
    s_mov_b64 exec, s[82:83]
    s_nop 1
    v_mfma_f32_4x4x4_16b_bf16 v[88:91], v[12:13], v[84:85], 0
    s_nop 1
    v_mfma_f32_4x4x4_16b_bf16 v[88:91], v[10:11], v[86:87], v[88:91]
    s_nop 4
    v_cvt_pk_bf16_f32 v88, v88, v89
    v_cvt_pk_bf16_f32 v89, v90, v91
    ds_pk_add_bf16 v7, v88 offset:65408
    ds_pk_add_bf16 v7, v89 offset:65412
    s_mov_b64 exec, s[54:55]
    s_branch L2_d51
L2_c52:
    s_lshl_b64 s[52:53], s[82:83], 1
    s_andn2_b64 s[52:53], s[52:53], s[80:81]
    s_andn2_b64 s[52:53], s[52:53], s[50:51]
    s_or_b64 s[80:81], s[80:81], s[52:53]
    s_not_b64 vcc, s[52:53]
    s_mov_b64 exec, -1
    v_cndmask_b32_dpp v84, v84, v84, vcc wave_shr:1 row_mask:0xf bank_mask:0xf
    v_cndmask_b32_dpp v85, v85, v85, vcc wave_shr:1 row_mask:0xf bank_mask:0xf
    s_lshr_b64 s[52:53], s[52:53], 1
    v_cndmask_b32_dpp v86, v86, v86, vcc wave_shr:1 row_mask:0xf bank_mask:0xf
    v_cndmask_b32_dpp v87, v87, v87, vcc wave_shr:1 row_mask:0xf bank_mask:0xf
    s_andn2_b64 s[82:83], s[82:83], s[52:53]
    v_cndmask_b32_dpp v7, v7, v7, vcc wave_shr:1 row_mask:0xf bank_mask:0xf
    s_mov_b64 exec, s[50:51]
    s_cbranch_scc0 L2_d52
    s_mov_b64 exec, s[82:83]
    s_nop 1
    v_mfma_f32_4x4x4_16b_bf16 v[88:91], v[12:13], v[84:85], 0
    s_nop 1
    v_mfma_f32_4x4x4_16b_bf16 v[88:91], v[10:11], v[86:87], v[88:91]
    s_nop 4
    v_cvt_pk_bf16_f32 v88, v88, v89
    v_cvt_pk_bf16_f32 v89, v90, v91
    ds_pk_add_bf16 v7, v88 offset:65408
    ds_pk_add_bf16 v7, v89 offset:65412
    s_mov_b64 exec, s[50:51]
    s_branch L2_d52
L2_c53:
    s_lshl_b64 s[52:53], s[82:83], 1
    s_andn2_b64 s[52:53], s[52:53], s[80:81]
    s_andn2_b64 s[52:53], s[52:53], s[54:55]
    s_or_b64 s[80:81], s[80:81], s[52:53]
    s_not_b64 vcc, s[52:53]
    s_mov_b64 exec, -1
    v_cndmask_b32_dpp v84, v84, v84, vcc wave_shr:1 row_mask:0xf bank_mask:0xf
    v_cndmask_b32_dpp v85, v85, v85, vcc wave_shr:1 row_mask:0xf bank_mask:0xf
    s_lshr_b64 s[52:53], s[52:53], 1
    v_cndmask_b32_dpp v86, v86, v86, vcc wave_shr:1 row_mask:0xf bank_mask:0xf
    v_cndmask_b32_dpp v87, v87, v87, vcc wave_shr:1 row_mask:0xf bank_mask:0xf
    s_andn2_b64 s[82:83], s[82:83], s[52:53]
    v_cndmask_b32_dpp v7, v7, v7, vcc wave_shr:1 row_mask:0xf bank_mask:0xf
    s_mov_b64 exec, s[54:55]
    s_cbranch_scc0 L2_d53
    s_mov_b64 exec, s[82:83]
    s_nop 1
    v_mfma_f32_4x4x4_16b_bf16 v[88:91], v[12:13], v[84:85], 0
    s_nop 1
    v_mfma_f32_4x4x4_16b_bf16 v[88:91], v[10:11], v[86:87], v[88:91]
    s_nop 4
    v_cvt_pk_bf16_f32 v88, v88, v89
    v_cvt_pk_bf16_f32 v89, v90, v91
    ds_pk_add_bf16 v7, v88 offset:65408
    ds_pk_add_bf16 v7, v89 offset:65412
    s_mov_b64 exec, s[54:55]
    s_branch L2_d53
L2_c54:
    s_lshl_b64 s[52:53], s[82:83], 1
    s_andn2_b64 s[52:53], s[52:53], s[80:81]
    s_andn2_b64 s[52:53], s[52:53], s[50:51]
    s_or_b64 s[80:81], s[80:81], s[52:53]
    s_not_b64 vcc, s[52:53]
    s_mov_b64 exec, -1
    v_cndmask_b32_dpp v84, v84, v84, vcc wave_shr:1 row_mask:0xf bank_mask:0xf
    v_cndmask_b32_dpp v85, v85, v85, vcc wave_shr:1 row_mask:0xf bank_mask:0xf
    s_lshr_b64 s[52:53], s[52:53], 1
    v_cndmask_b32_dpp v86, v86, v86, vcc wave_shr:1 row_mask:0xf bank_mask:0xf
    v_cndmask_b32_dpp v87, v87, v87, vcc wave_shr:1 row_mask:0xf bank_mask:0xf
    s_andn2_b64 s[82:83], s[82:83], s[52:53]
    v_cndmask_b32_dpp v7, v7, v7, vcc wave_shr:1 row_mask:0xf bank_mask:0xf
    s_mov_b64 exec, s[50:51]
    s_cbranch_scc0 L2_d54
    s_mov_b64 exec, s[82:83]
    s_nop 1
    v_mfma_f32_4x4x4_16b_bf16 v[88:91], v[12:13], v[84:85], 0
    s_nop 1
    v_mfma_f32_4x4x4_16b_bf16 v[88:91], v[10:11], v[86:87], v[88:91]
    s_nop 4
    v_cvt_pk_bf16_f32 v88, v88, v89
    v_cvt_pk_bf16_f32 v89, v90, v91
    ds_pk_add_bf16 v7, v88 offset:65408
    ds_pk_add_bf16 v7, v89 offset:65412
    s_mov_b64 exec, s[50:51]
    s_branch L2_d54
L2_c55:
    s_lshl_b64 s[52:53], s[82:83], 1
    s_andn2_b64 s[52:53], s[52:53], s[80:81]
    s_andn2_b64 s[52:53], s[52:53], s[54:55]
    s_or_b64 s[80:81], s[80:81], s[52:53]
    s_not_b64 vcc, s[52:53]
    s_mov_b64 exec, -1
    v_cndmask_b32_dpp v84, v84, v84, vcc wave_shr:1 row_mask:0xf bank_mask:0xf
    v_cndmask_b32_dpp v85, v85, v85, vcc wave_shr:1 row_mask:0xf bank_mask:0xf
    s_lshr_b64 s[52:53], s[52:53], 1
    v_cndmask_b32_dpp v86, v86, v86, vcc wave_shr:1 row_mask:0xf bank_mask:0xf
    v_cndmask_b32_dpp v87, v87, v87, vcc wave_shr:1 row_mask:0xf bank_mask:0xf
    s_andn2_b64 s[82:83], s[82:83], s[52:53]
    v_cndmask_b32_dpp v7, v7, v7, vcc wave_shr:1 row_mask:0xf bank_mask:0xf
    s_mov_b64 exec, s[54:55]
    s_cbranch_scc0 L2_d55
    s_mov_b64 exec, s[82:83]
    s_nop 1
    v_mfma_f32_4x4x4_16b_bf16 v[88:91], v[12:13], v[84:85], 0
    s_nop 1
    v_mfma_f32_4x4x4_16b_bf16 v[88:91], v[10:11], v[86:87], v[88:91]
    s_nop 4
    v_cvt_pk_bf16_f32 v88, v88, v89
    v_cvt_pk_bf16_f32 v89, v90, v91
    ds_pk_add_bf16 v7, v88 offset:65408
    ds_pk_add_bf16 v7, v89 offset:65412
    s_mov_b64 exec, s[54:55]
    s_branch L2_d55
L2_c56:
    s_lshl_b64 s[52:53], s[82:83], 1
    s_andn2_b64 s[52:53], s[52:53], s[80:81]
    s_andn2_b64 s[52:53], s[52:53], s[50:51]
    s_or_b64 s[80:81], s[80:81], s[52:53]
    s_not_b64 vcc, s[52:53]
    s_mov_b64 exec, -1
    v_cndmask_b32_dpp v84, v84, v84, vcc wave_shr:1 row_mask:0xf bank_mask:0xf
    v_cndmask_b32_dpp v85, v85, v85, vcc wave_shr:1 row_mask:0xf bank_mask:0xf
    s_lshr_b64 s[52:53], s[52:53], 1
    v_cndmask_b32_dpp v86, v86, v86, vcc wave_shr:1 row_mask:0xf bank_mask:0xf
    v_cndmask_b32_dpp v87, v87, v87, vcc wave_shr:1 row_mask:0xf bank_mask:0xf
    s_andn2_b64 s[82:83], s[82:83], s[52:53]
    v_cndmask_b32_dpp v7, v7, v7, vcc wave_shr:1 row_mask:0xf bank_mask:0xf
    s_mov_b64 exec, s[50:51]
    s_cbranch_scc0 L2_d56
    s_mov_b64 exec, s[82:83]
    s_nop 1
    v_mfma_f32_4x4x4_16b_bf16 v[88:91], v[12:13], v[84:85], 0
    s_nop 1
    v_mfma_f32_4x4x4_16b_bf16 v[88:91], v[10:11], v[86:87], v[88:91]
    s_nop 4
    v_cvt_pk_bf16_f32 v88, v88, v89
    v_cvt_pk_bf16_f32 v89, v90, v91
    ds_pk_add_bf16 v7, v88 offset:65408
    ds_pk_add_bf16 v7, v89 offset:65412
    s_mov_b64 exec, s[50:51]
    s_branch L2_d56
L2_c57:
    s_lshl_b64 s[52:53], s[82:83], 1
    s_andn2_b64 s[52:53], s[52:53], s[80:81]
    s_andn2_b64 s[52:53], s[52:53], s[54:55]
    s_or_b64 s[80:81], s[80:81], s[52:53]
    s_not_b64 vcc, s[52:53]
    s_mov_b64 exec, -1
    v_cndmask_b32_dpp v84, v84, v84, vcc wave_shr:1 row_mask:0xf bank_mask:0xf
    v_cndmask_b32_dpp v85, v85, v85, vcc wave_shr:1 row_mask:0xf bank_mask:0xf
    s_lshr_b64 s[52:53], s[52:53], 1
    v_cndmask_b32_dpp v86, v86, v86, vcc wave_shr:1 row_mask:0xf bank_mask:0xf
    v_cndmask_b32_dpp v87, v87, v87, vcc wave_shr:1 row_mask:0xf bank_mask:0xf
    s_andn2_b64 s[82:83], s[82:83], s[52:53]
    v_cndmask_b32_dpp v7, v7, v7, vcc wave_shr:1 row_mask:0xf bank_mask:0xf
    s_mov_b64 exec, s[54:55]
    s_cbranch_scc0 L2_d57
    s_mov_b64 exec, s[82:83]
    s_nop 1
    v_mfma_f32_4x4x4_16b_bf16 v[88:91], v[12:13], v[84:85], 0
    s_nop 1
    v_mfma_f32_4x4x4_16b_bf16 v[88:91], v[10:11], v[86:87], v[88:91]
    s_nop 4
    v_cvt_pk_bf16_f32 v88, v88, v89
    v_cvt_pk_bf16_f32 v89, v90, v91
    ds_pk_add_bf16 v7, v88 offset:65408
    ds_pk_add_bf16 v7, v89 offset:65412
    s_mov_b64 exec, s[54:55]
    s_branch L2_d57
L2_c58:
    s_lshl_b64 s[52:53], s[82:83], 1
    s_andn2_b64 s[52:53], s[52:53], s[80:81]
    s_andn2_b64 s[52:53], s[52:53], s[50:51]
    s_or_b64 s[80:81], s[80:81], s[52:53]
    s_not_b64 vcc, s[52:53]
    s_mov_b64 exec, -1
    v_cndmask_b32_dpp v84, v84, v84, vcc wave_shr:1 row_mask:0xf bank_mask:0xf
    v_cndmask_b32_dpp v85, v85, v85, vcc wave_shr:1 row_mask:0xf bank_mask:0xf
    s_lshr_b64 s[52:53], s[52:53], 1
    v_cndmask_b32_dpp v86, v86, v86, vcc wave_shr:1 row_mask:0xf bank_mask:0xf
    v_cndmask_b32_dpp v87, v87, v87, vcc wave_shr:1 row_mask:0xf bank_mask:0xf
    s_andn2_b64 s[82:83], s[82:83], s[52:53]
    v_cndmask_b32_dpp v7, v7, v7, vcc wave_shr:1 row_mask:0xf bank_mask:0xf
    s_mov_b64 exec, s[50:51]
    s_cbranch_scc0 L2_d58
    s_mov_b64 exec, s[82:83]
    s_nop 1
    v_mfma_f32_4x4x4_16b_bf16 v[88:91], v[12:13], v[84:85], 0
    s_nop 1
    v_mfma_f32_4x4x4_16b_bf16 v[88:91], v[10:11], v[86:87], v[88:91]
    s_nop 4
    v_cvt_pk_bf16_f32 v88, v88, v89
    v_cvt_pk_bf16_f32 v89, v90, v91
    ds_pk_add_bf16 v7, v88 offset:65408
    ds_pk_add_bf16 v7, v89 offset:65412
    s_mov_b64 exec, s[50:51]
    s_branch L2_d58
L2_c59:
    s_lshl_b64 s[52:53], s[82:83], 1
    s_andn2_b64 s[52:53], s[52:53], s[80:81]
    s_andn2_b64 s[52:53], s[52:53], s[54:55]
    s_or_b64 s[80:81], s[80:81], s[52:53]
    s_not_b64 vcc, s[52:53]
    s_mov_b64 exec, -1
    v_cndmask_b32_dpp v84, v84, v84, vcc wave_shr:1 row_mask:0xf bank_mask:0xf
    v_cndmask_b32_dpp v85, v85, v85, vcc wave_shr:1 row_mask:0xf bank_mask:0xf
    s_lshr_b64 s[52:53], s[52:53], 1
    v_cndmask_b32_dpp v86, v86, v86, vcc wave_shr:1 row_mask:0xf bank_mask:0xf
    v_cndmask_b32_dpp v87, v87, v87, vcc wave_shr:1 row_mask:0xf bank_mask:0xf
    s_andn2_b64 s[82:83], s[82:83], s[52:53]
    v_cndmask_b32_dpp v7, v7, v7, vcc wave_shr:1 row_mask:0xf bank_mask:0xf
    s_mov_b64 exec, s[54:55]
    s_cbranch_scc0 L2_d59
    s_mov_b64 exec, s[82:83]
    s_nop 1
    v_mfma_f32_4x4x4_16b_bf16 v[88:91], v[12:13], v[84:85], 0
    s_nop 1
    v_mfma_f32_4x4x4_16b_bf16 v[88:91], v[10:11], v[86:87], v[88:91]
    s_nop 4
    v_cvt_pk_bf16_f32 v88, v88, v89
    v_cvt_pk_bf16_f32 v89, v90, v91
    ds_pk_add_bf16 v7, v88 offset:65408
    ds_pk_add_bf16 v7, v89 offset:65412
    s_mov_b64 exec, s[54:55]
    s_branch L2_d59
L2_c60:
    s_lshl_b64 s[52:53], s[82:83], 1
    s_andn2_b64 s[52:53], s[52:53], s[80:81]
    s_andn2_b64 s[52:53], s[52:53], s[50:51]
    s_or_b64 s[80:81], s[80:81], s[52:53]
    s_not_b64 vcc, s[52:53]
    s_mov_b64 exec, -1
    v_cndmask_b32_dpp v84, v84, v84, vcc wave_shr:1 row_mask:0xf bank_mask:0xf
    v_cndmask_b32_dpp v85, v85, v85, vcc wave_shr:1 row_mask:0xf bank_mask:0xf
    s_lshr_b64 s[52:53], s[52:53], 1
    v_cndmask_b32_dpp v86, v86, v86, vcc wave_shr:1 row_mask:0xf bank_mask:0xf
    v_cndmask_b32_dpp v87, v87, v87, vcc wave_shr:1 row_mask:0xf bank_mask:0xf
    s_andn2_b64 s[82:83], s[82:83], s[52:53]
    v_cndmask_b32_dpp v7, v7, v7, vcc wave_shr:1 row_mask:0xf bank_mask:0xf
    s_mov_b64 exec, s[50:51]
    s_cbranch_scc0 L2_d60
    s_mov_b64 exec, s[82:83]
    s_nop 1
    v_mfma_f32_4x4x4_16b_bf16 v[88:91], v[12:13], v[84:85], 0
    s_nop 1
    v_mfma_f32_4x4x4_16b_bf16 v[88:91], v[10:11], v[86:87], v[88:91]
    s_nop 4
    v_cvt_pk_bf16_f32 v88, v88, v89
    v_cvt_pk_bf16_f32 v89, v90, v91
    ds_pk_add_bf16 v7, v88 offset:65408
    ds_pk_add_bf16 v7, v89 offset:65412
    s_mov_b64 exec, s[50:51]
    s_branch L2_d60
L2_xa61:
    s_cmp_eq_u32 s101, 1
    s_cbranch_scc1 L2_xc61
    v_lshlrev_b32 v89, 0, v96
    v_add_u32 v90, 140, v97
    v_bitop3_b32 v90, v89, v45, v90 bitop3:0x6a
    ds_write_b32 v98, v90 offset:28
    v_lshlrev_b32 v89, 4, v96
    v_add_u32 v90, 120, v97
    v_bitop3_b32 v90, v89, v45, v90 bitop3:0x6a
    ds_write_b32 v98, v90 offset:24
    v_lshlrev_b32 v89, 8, v96
    v_add_u32 v90, 100, v97
    v_bitop3_b32 v90, v89, v45, v90 bitop3:0x6a
    ds_write_b32 v98, v90 offset:20
L2_xc61:
    v_lshlrev_b32 v89, 12, v96
    v_add_u32 v90, 80, v97
    v_bitop3_b32 v90, v89, v45, v90 bitop3:0x6a
    ds_write_b32 v98, v90 offset:16
    s_branch L2_xb61
L2_xe61:
    v_cmp_lt_u32 vcc, 32, v99
    v_cmp_lt_u32 s[58:59], 31, v88
    v_lshrrev_b32 v89, 16, v96
    v_add_u32 v97, 80, v97
    s_or_b64 vcc, vcc, s[58:59]
    s_cbranch_scc1 L2_xs61
    v_lshlrev_b32 v89, v1, v89
    v_and_b32 v89, v45, v89
    v_cmp_ne_u32 vcc, 0, v89
    v_xor_b32 v90, v97, v89
    s_add_u32 s3, s37, s38
    v_mbcnt_lo_u32_b32 v98, vcc_lo, 0
    v_mbcnt_hi_u32_b32 v98, vcc_hi, v98
    s_bcnt1_i32_b64 s41, vcc
    v_lshl_add_u32 v98, v98, 2, s3
    s_mov_b64 exec, vcc
    ds_write_b32 v98, v90
    s_mov_b64 exec, -1
    s_lshl2_add_u32 s37, s41, s37
    s_branch L2_xr61
L2_xf61:
    s_waitcnt lgkmcnt(0)
    s_cmp_gt_u32 s37, 1024
    s_cbranch_scc1 L2_xs61
    v_mov_b32 v43, -1
    s_cmp_ge_u32 s37, 512
    s_cbranch_scc1 L2_xg61
    v_mov_b32 v42, -1
    s_cmp_ge_u32 s37, 256
    s_cbranch_scc1 L2_xg61
    v_mov_b32 v41, -1
    s_branch L2_xg61
L2_xs61:
    s_waitcnt lgkmcnt(0)
    v_mov_b32 v40, -1
    v_mov_b32 v41, -1
    v_mov_b32 v42, -1
    v_mov_b32 v43, -1
    s_add_u32 s3, s42, 2
    s_bitset1_b32 s36, s3
    s_branch L2_xg61
L2_c62:
    s_lshl_b64 s[52:53], s[82:83], 1
    s_andn2_b64 s[52:53], s[52:53], s[80:81]
    s_andn2_b64 s[52:53], s[52:53], s[54:55]
    s_or_b64 s[80:81], s[80:81], s[52:53]
    s_not_b64 vcc, s[52:53]
    s_mov_b64 exec, -1
    v_cndmask_b32_dpp v84, v84, v84, vcc wave_shr:1 row_mask:0xf bank_mask:0xf
    v_cndmask_b32_dpp v85, v85, v85, vcc wave_shr:1 row_mask:0xf bank_mask:0xf
    s_lshr_b64 s[52:53], s[52:53], 1
    v_cndmask_b32_dpp v86, v86, v86, vcc wave_shr:1 row_mask:0xf bank_mask:0xf
    v_cndmask_b32_dpp v87, v87, v87, vcc wave_shr:1 row_mask:0xf bank_mask:0xf
    s_andn2_b64 s[82:83], s[82:83], s[52:53]
    v_cndmask_b32_dpp v7, v7, v7, vcc wave_shr:1 row_mask:0xf bank_mask:0xf
    s_mov_b64 exec, s[54:55]
    s_cbranch_scc0 L2_d62
    s_mov_b64 exec, s[82:83]
    s_nop 1
    v_mfma_f32_4x4x4_16b_bf16 v[88:91], v[12:13], v[84:85], 0
    s_nop 1
    v_mfma_f32_4x4x4_16b_bf16 v[88:91], v[10:11], v[86:87], v[88:91]
    s_nop 4
    v_cvt_pk_bf16_f32 v88, v88, v89
    v_cvt_pk_bf16_f32 v89, v90, v91
    ds_pk_add_bf16 v7, v88 offset:65408
    ds_pk_add_bf16 v7, v89 offset:65412
    s_mov_b64 exec, s[54:55]
    s_branch L2_d62
L2_c63:
    s_lshl_b64 s[52:53], s[82:83], 1
    s_andn2_b64 s[52:53], s[52:53], s[80:81]
    s_andn2_b64 s[52:53], s[52:53], s[50:51]
    s_or_b64 s[80:81], s[80:81], s[52:53]
    s_not_b64 vcc, s[52:53]
    s_mov_b64 exec, -1
    v_cndmask_b32_dpp v84, v84, v84, vcc wave_shr:1 row_mask:0xf bank_mask:0xf
    v_cndmask_b32_dpp v85, v85, v85, vcc wave_shr:1 row_mask:0xf bank_mask:0xf
    s_lshr_b64 s[52:53], s[52:53], 1
    v_cndmask_b32_dpp v86, v86, v86, vcc wave_shr:1 row_mask:0xf bank_mask:0xf
    v_cndmask_b32_dpp v87, v87, v87, vcc wave_shr:1 row_mask:0xf bank_mask:0xf
    s_andn2_b64 s[82:83], s[82:83], s[52:53]
    v_cndmask_b32_dpp v7, v7, v7, vcc wave_shr:1 row_mask:0xf bank_mask:0xf
    s_mov_b64 exec, s[50:51]
    s_cbranch_scc0 L2_d63
    s_mov_b64 exec, s[82:83]
    s_nop 1
    v_mfma_f32_4x4x4_16b_bf16 v[88:91], v[12:13], v[84:85], 0
    s_nop 1
    v_mfma_f32_4x4x4_16b_bf16 v[88:91], v[10:11], v[86:87], v[88:91]
    s_nop 4
    v_cvt_pk_bf16_f32 v88, v88, v89
    v_cvt_pk_bf16_f32 v89, v90, v91
    ds_pk_add_bf16 v7, v88 offset:65408
    ds_pk_add_bf16 v7, v89 offset:65412
    s_mov_b64 exec, s[50:51]
    s_branch L2_d63
L2_c64:
    s_lshl_b64 s[52:53], s[82:83], 1
    s_andn2_b64 s[52:53], s[52:53], s[80:81]
    s_andn2_b64 s[52:53], s[52:53], s[54:55]
    s_or_b64 s[80:81], s[80:81], s[52:53]
    s_not_b64 vcc, s[52:53]
    s_mov_b64 exec, -1
    v_cndmask_b32_dpp v84, v84, v84, vcc wave_shr:1 row_mask:0xf bank_mask:0xf
    v_cndmask_b32_dpp v85, v85, v85, vcc wave_shr:1 row_mask:0xf bank_mask:0xf
    s_lshr_b64 s[52:53], s[52:53], 1
    v_cndmask_b32_dpp v86, v86, v86, vcc wave_shr:1 row_mask:0xf bank_mask:0xf
    v_cndmask_b32_dpp v87, v87, v87, vcc wave_shr:1 row_mask:0xf bank_mask:0xf
    s_andn2_b64 s[82:83], s[82:83], s[52:53]
    v_cndmask_b32_dpp v7, v7, v7, vcc wave_shr:1 row_mask:0xf bank_mask:0xf
    s_mov_b64 exec, s[54:55]
    s_cbranch_scc0 L2_d64
    s_mov_b64 exec, s[82:83]
    s_nop 1
    v_mfma_f32_4x4x4_16b_bf16 v[88:91], v[12:13], v[84:85], 0
    s_nop 1
    v_mfma_f32_4x4x4_16b_bf16 v[88:91], v[10:11], v[86:87], v[88:91]
    s_nop 4
    v_cvt_pk_bf16_f32 v88, v88, v89
    v_cvt_pk_bf16_f32 v89, v90, v91
    ds_pk_add_bf16 v7, v88 offset:65408
    ds_pk_add_bf16 v7, v89 offset:65412
    s_mov_b64 exec, s[54:55]
    s_branch L2_d64
L2_c65:
    s_lshl_b64 s[52:53], s[82:83], 1
    s_andn2_b64 s[52:53], s[52:53], s[80:81]
    s_andn2_b64 s[52:53], s[52:53], s[50:51]
    s_or_b64 s[80:81], s[80:81], s[52:53]
    s_not_b64 vcc, s[52:53]
    s_mov_b64 exec, -1
    v_cndmask_b32_dpp v84, v84, v84, vcc wave_shr:1 row_mask:0xf bank_mask:0xf
    v_cndmask_b32_dpp v85, v85, v85, vcc wave_shr:1 row_mask:0xf bank_mask:0xf
    s_lshr_b64 s[52:53], s[52:53], 1
    v_cndmask_b32_dpp v86, v86, v86, vcc wave_shr:1 row_mask:0xf bank_mask:0xf
    v_cndmask_b32_dpp v87, v87, v87, vcc wave_shr:1 row_mask:0xf bank_mask:0xf
    s_andn2_b64 s[82:83], s[82:83], s[52:53]
    v_cndmask_b32_dpp v7, v7, v7, vcc wave_shr:1 row_mask:0xf bank_mask:0xf
    s_mov_b64 exec, s[50:51]
    s_cbranch_scc0 L2_d65
    s_mov_b64 exec, s[82:83]
    s_nop 1
    v_mfma_f32_4x4x4_16b_bf16 v[88:91], v[12:13], v[84:85], 0
    s_nop 1
    v_mfma_f32_4x4x4_16b_bf16 v[88:91], v[10:11], v[86:87], v[88:91]
    s_nop 4
    v_cvt_pk_bf16_f32 v88, v88, v89
    v_cvt_pk_bf16_f32 v89, v90, v91
    ds_pk_add_bf16 v7, v88 offset:65408
    ds_pk_add_bf16 v7, v89 offset:65412
    s_mov_b64 exec, s[50:51]
    s_branch L2_d65
L2_c66:
    s_lshl_b64 s[52:53], s[82:83], 1
    s_andn2_b64 s[52:53], s[52:53], s[80:81]
    s_andn2_b64 s[52:53], s[52:53], s[54:55]
    s_or_b64 s[80:81], s[80:81], s[52:53]
    s_not_b64 vcc, s[52:53]
    s_mov_b64 exec, -1
    v_cndmask_b32_dpp v84, v84, v84, vcc wave_shr:1 row_mask:0xf bank_mask:0xf
    v_cndmask_b32_dpp v85, v85, v85, vcc wave_shr:1 row_mask:0xf bank_mask:0xf
    s_lshr_b64 s[52:53], s[52:53], 1
    v_cndmask_b32_dpp v86, v86, v86, vcc wave_shr:1 row_mask:0xf bank_mask:0xf
    v_cndmask_b32_dpp v87, v87, v87, vcc wave_shr:1 row_mask:0xf bank_mask:0xf
    s_andn2_b64 s[82:83], s[82:83], s[52:53]
    v_cndmask_b32_dpp v7, v7, v7, vcc wave_shr:1 row_mask:0xf bank_mask:0xf
    s_mov_b64 exec, s[54:55]
    s_cbranch_scc0 L2_d66
    s_mov_b64 exec, s[82:83]
    s_nop 1
    v_mfma_f32_4x4x4_16b_bf16 v[88:91], v[12:13], v[84:85], 0
    s_nop 1
    v_mfma_f32_4x4x4_16b_bf16 v[88:91], v[10:11], v[86:87], v[88:91]
    s_nop 4
    v_cvt_pk_bf16_f32 v88, v88, v89
    v_cvt_pk_bf16_f32 v89, v90, v91
    ds_pk_add_bf16 v7, v88 offset:65408
    ds_pk_add_bf16 v7, v89 offset:65412
    s_mov_b64 exec, s[54:55]
    s_branch L2_d66
L2_c67:
    s_lshl_b64 s[52:53], s[82:83], 1
    s_andn2_b64 s[52:53], s[52:53], s[80:81]
    s_andn2_b64 s[52:53], s[52:53], s[50:51]
    s_or_b64 s[80:81], s[80:81], s[52:53]
    s_not_b64 vcc, s[52:53]
    s_mov_b64 exec, -1
    v_cndmask_b32_dpp v84, v84, v84, vcc wave_shr:1 row_mask:0xf bank_mask:0xf
    v_cndmask_b32_dpp v85, v85, v85, vcc wave_shr:1 row_mask:0xf bank_mask:0xf
    s_lshr_b64 s[52:53], s[52:53], 1
    v_cndmask_b32_dpp v86, v86, v86, vcc wave_shr:1 row_mask:0xf bank_mask:0xf
    v_cndmask_b32_dpp v87, v87, v87, vcc wave_shr:1 row_mask:0xf bank_mask:0xf
    s_andn2_b64 s[82:83], s[82:83], s[52:53]
    v_cndmask_b32_dpp v7, v7, v7, vcc wave_shr:1 row_mask:0xf bank_mask:0xf
    s_mov_b64 exec, s[50:51]
    s_cbranch_scc0 L2_d67
    s_mov_b64 exec, s[82:83]
    s_nop 1
    v_mfma_f32_4x4x4_16b_bf16 v[88:91], v[12:13], v[84:85], 0
    s_nop 1
    v_mfma_f32_4x4x4_16b_bf16 v[88:91], v[10:11], v[86:87], v[88:91]
    s_nop 4
    v_cvt_pk_bf16_f32 v88, v88, v89
    v_cvt_pk_bf16_f32 v89, v90, v91
    ds_pk_add_bf16 v7, v88 offset:65408
    ds_pk_add_bf16 v7, v89 offset:65412
    s_mov_b64 exec, s[50:51]
    s_branch L2_d67
L2_xo68:
    v_cmp_lt_u32 vcc, 20, v99
    s_mov_b32 s101, 1
    s_cbranch_vccz L2_xp68
    v_cmp_lt_u32 vcc, 32, v99
    v_cmp_lt_u32 s[58:59], 31, v88
    s_mov_b32 s101, 2
    s_or_b64 vcc, vcc, s[58:59]
    s_cbranch_scc0 L2_xp68
    s_mov_b32 s37, 0x10000
    s_branch L2_xp68
L2_c69:
    s_lshl_b64 s[52:53], s[82:83], 1
    s_andn2_b64 s[52:53], s[52:53], s[80:81]
    s_andn2_b64 s[52:53], s[52:53], s[54:55]
    s_or_b64 s[80:81], s[80:81], s[52:53]
    s_not_b64 vcc, s[52:53]
    s_mov_b64 exec, -1
    v_cndmask_b32_dpp v84, v84, v84, vcc wave_shr:1 row_mask:0xf bank_mask:0xf
    v_cndmask_b32_dpp v85, v85, v85, vcc wave_shr:1 row_mask:0xf bank_mask:0xf
    s_lshr_b64 s[52:53], s[52:53], 1
    v_cndmask_b32_dpp v86, v86, v86, vcc wave_shr:1 row_mask:0xf bank_mask:0xf
    v_cndmask_b32_dpp v87, v87, v87, vcc wave_shr:1 row_mask:0xf bank_mask:0xf
    s_andn2_b64 s[82:83], s[82:83], s[52:53]
    v_cndmask_b32_dpp v7, v7, v7, vcc wave_shr:1 row_mask:0xf bank_mask:0xf
    s_mov_b64 exec, s[54:55]
    s_cbranch_scc0 L2_d69
    s_mov_b64 exec, s[82:83]
    s_nop 1
    v_mfma_f32_4x4x4_16b_bf16 v[88:91], v[12:13], v[84:85], 0
    s_nop 1
    v_mfma_f32_4x4x4_16b_bf16 v[88:91], v[10:11], v[86:87], v[88:91]
    s_nop 4
    v_cvt_pk_bf16_f32 v88, v88, v89
    v_cvt_pk_bf16_f32 v89, v90, v91
    ds_pk_add_bf16 v7, v88 offset:65408
    ds_pk_add_bf16 v7, v89 offset:65412
    s_mov_b64 exec, s[54:55]
    s_branch L2_d69
L2_c70:
    s_lshl_b64 s[52:53], s[82:83], 1
    s_andn2_b64 s[52:53], s[52:53], s[80:81]
    s_andn2_b64 s[52:53], s[52:53], s[50:51]
    s_or_b64 s[80:81], s[80:81], s[52:53]
    s_not_b64 vcc, s[52:53]
    s_mov_b64 exec, -1
    v_cndmask_b32_dpp v84, v84, v84, vcc wave_shr:1 row_mask:0xf bank_mask:0xf
    v_cndmask_b32_dpp v85, v85, v85, vcc wave_shr:1 row_mask:0xf bank_mask:0xf
    s_lshr_b64 s[52:53], s[52:53], 1
    v_cndmask_b32_dpp v86, v86, v86, vcc wave_shr:1 row_mask:0xf bank_mask:0xf
    v_cndmask_b32_dpp v87, v87, v87, vcc wave_shr:1 row_mask:0xf bank_mask:0xf
    s_andn2_b64 s[82:83], s[82:83], s[52:53]
    v_cndmask_b32_dpp v7, v7, v7, vcc wave_shr:1 row_mask:0xf bank_mask:0xf
    s_mov_b64 exec, s[50:51]
    s_cbranch_scc0 L2_d70
    s_mov_b64 exec, s[82:83]
    s_nop 1
    v_mfma_f32_4x4x4_16b_bf16 v[88:91], v[12:13], v[84:85], 0
    s_nop 1
    v_mfma_f32_4x4x4_16b_bf16 v[88:91], v[10:11], v[86:87], v[88:91]
    s_nop 4
    v_cvt_pk_bf16_f32 v88, v88, v89
    v_cvt_pk_bf16_f32 v89, v90, v91
    ds_pk_add_bf16 v7, v88 offset:65408
    ds_pk_add_bf16 v7, v89 offset:65412
    s_mov_b64 exec, s[50:51]
    s_branch L2_d70
L2_c71:
    s_lshl_b64 s[52:53], s[82:83], 1
    s_andn2_b64 s[52:53], s[52:53], s[80:81]
    s_andn2_b64 s[52:53], s[52:53], s[54:55]
    s_or_b64 s[80:81], s[80:81], s[52:53]
    s_not_b64 vcc, s[52:53]
    s_mov_b64 exec, -1
    v_cndmask_b32_dpp v84, v84, v84, vcc wave_shr:1 row_mask:0xf bank_mask:0xf
    v_cndmask_b32_dpp v85, v85, v85, vcc wave_shr:1 row_mask:0xf bank_mask:0xf
    s_lshr_b64 s[52:53], s[52:53], 1
    v_cndmask_b32_dpp v86, v86, v86, vcc wave_shr:1 row_mask:0xf bank_mask:0xf
    v_cndmask_b32_dpp v87, v87, v87, vcc wave_shr:1 row_mask:0xf bank_mask:0xf
    s_andn2_b64 s[82:83], s[82:83], s[52:53]
    v_cndmask_b32_dpp v7, v7, v7, vcc wave_shr:1 row_mask:0xf bank_mask:0xf
    s_mov_b64 exec, s[54:55]
    s_cbranch_scc0 L2_d71
    s_mov_b64 exec, s[82:83]
    s_nop 1
    v_mfma_f32_4x4x4_16b_bf16 v[88:91], v[12:13], v[84:85], 0
    s_nop 1
    v_mfma_f32_4x4x4_16b_bf16 v[88:91], v[10:11], v[86:87], v[88:91]
    s_nop 4
    v_cvt_pk_bf16_f32 v88, v88, v89
    v_cvt_pk_bf16_f32 v89, v90, v91
    ds_pk_add_bf16 v7, v88 offset:65408
    ds_pk_add_bf16 v7, v89 offset:65412
    s_mov_b64 exec, s[54:55]
    s_branch L2_d71
L2_c72:
    s_lshl_b64 s[52:53], s[82:83], 1
    s_andn2_b64 s[52:53], s[52:53], s[80:81]
    s_andn2_b64 s[52:53], s[52:53], s[50:51]
    s_or_b64 s[80:81], s[80:81], s[52:53]
    s_not_b64 vcc, s[52:53]
    s_mov_b64 exec, -1
    v_cndmask_b32_dpp v84, v84, v84, vcc wave_shr:1 row_mask:0xf bank_mask:0xf
    v_cndmask_b32_dpp v85, v85, v85, vcc wave_shr:1 row_mask:0xf bank_mask:0xf
    s_lshr_b64 s[52:53], s[52:53], 1
    v_cndmask_b32_dpp v86, v86, v86, vcc wave_shr:1 row_mask:0xf bank_mask:0xf
    v_cndmask_b32_dpp v87, v87, v87, vcc wave_shr:1 row_mask:0xf bank_mask:0xf
    s_andn2_b64 s[82:83], s[82:83], s[52:53]
    v_cndmask_b32_dpp v7, v7, v7, vcc wave_shr:1 row_mask:0xf bank_mask:0xf
    s_mov_b64 exec, s[50:51]
    s_cbranch_scc0 L2_d72
    s_mov_b64 exec, s[82:83]
    s_nop 1
    v_mfma_f32_4x4x4_16b_bf16 v[88:91], v[12:13], v[84:85], 0
    s_nop 1
    v_mfma_f32_4x4x4_16b_bf16 v[88:91], v[10:11], v[86:87], v[88:91]
    s_nop 4
    v_cvt_pk_bf16_f32 v88, v88, v89
    v_cvt_pk_bf16_f32 v89, v90, v91
    ds_pk_add_bf16 v7, v88 offset:65408
    ds_pk_add_bf16 v7, v89 offset:65412
    s_mov_b64 exec, s[50:51]
    s_branch L2_d72
L2_c73:
    s_lshl_b64 s[52:53], s[82:83], 1
    s_andn2_b64 s[52:53], s[52:53], s[80:81]
    s_andn2_b64 s[52:53], s[52:53], s[54:55]
    s_or_b64 s[80:81], s[80:81], s[52:53]
    s_not_b64 vcc, s[52:53]
    s_mov_b64 exec, -1
    v_cndmask_b32_dpp v84, v84, v84, vcc wave_shr:1 row_mask:0xf bank_mask:0xf
    v_cndmask_b32_dpp v85, v85, v85, vcc wave_shr:1 row_mask:0xf bank_mask:0xf
    s_lshr_b64 s[52:53], s[52:53], 1
    v_cndmask_b32_dpp v86, v86, v86, vcc wave_shr:1 row_mask:0xf bank_mask:0xf
    v_cndmask_b32_dpp v87, v87, v87, vcc wave_shr:1 row_mask:0xf bank_mask:0xf
    s_andn2_b64 s[82:83], s[82:83], s[52:53]
    v_cndmask_b32_dpp v7, v7, v7, vcc wave_shr:1 row_mask:0xf bank_mask:0xf
    s_mov_b64 exec, s[54:55]
    s_cbranch_scc0 L2_d73
    s_mov_b64 exec, s[82:83]
    s_nop 1
    v_mfma_f32_4x4x4_16b_bf16 v[88:91], v[12:13], v[84:85], 0
    s_nop 1
    v_mfma_f32_4x4x4_16b_bf16 v[88:91], v[10:11], v[86:87], v[88:91]
    s_nop 4
    v_cvt_pk_bf16_f32 v88, v88, v89
    v_cvt_pk_bf16_f32 v89, v90, v91
    ds_pk_add_bf16 v7, v88 offset:65408
    ds_pk_add_bf16 v7, v89 offset:65412
    s_mov_b64 exec, s[54:55]
    s_branch L2_d73
L2_c74:
    s_lshl_b64 s[52:53], s[82:83], 1
    s_andn2_b64 s[52:53], s[52:53], s[80:81]
    s_andn2_b64 s[52:53], s[52:53], s[50:51]
    s_or_b64 s[80:81], s[80:81], s[52:53]
    s_not_b64 vcc, s[52:53]
    s_mov_b64 exec, -1
    v_cndmask_b32_dpp v84, v84, v84, vcc wave_shr:1 row_mask:0xf bank_mask:0xf
    v_cndmask_b32_dpp v85, v85, v85, vcc wave_shr:1 row_mask:0xf bank_mask:0xf
    s_lshr_b64 s[52:53], s[52:53], 1
    v_cndmask_b32_dpp v86, v86, v86, vcc wave_shr:1 row_mask:0xf bank_mask:0xf
    v_cndmask_b32_dpp v87, v87, v87, vcc wave_shr:1 row_mask:0xf bank_mask:0xf
    s_andn2_b64 s[82:83], s[82:83], s[52:53]
    v_cndmask_b32_dpp v7, v7, v7, vcc wave_shr:1 row_mask:0xf bank_mask:0xf
    s_mov_b64 exec, s[50:51]
    s_cbranch_scc0 L2_d74
    s_mov_b64 exec, s[82:83]
    s_nop 1
    v_mfma_f32_4x4x4_16b_bf16 v[88:91], v[12:13], v[84:85], 0
    s_nop 1
    v_mfma_f32_4x4x4_16b_bf16 v[88:91], v[10:11], v[86:87], v[88:91]
    s_nop 4
    v_cvt_pk_bf16_f32 v88, v88, v89
    v_cvt_pk_bf16_f32 v89, v90, v91
    ds_pk_add_bf16 v7, v88 offset:65408
    ds_pk_add_bf16 v7, v89 offset:65412
    s_mov_b64 exec, s[50:51]
    s_branch L2_d74
L2_c75:
    s_lshl_b64 s[52:53], s[82:83], 1
    s_andn2_b64 s[52:53], s[52:53], s[80:81]
    s_andn2_b64 s[52:53], s[52:53], s[54:55]
    s_or_b64 s[80:81], s[80:81], s[52:53]
    s_not_b64 vcc, s[52:53]
    s_mov_b64 exec, -1
    v_cndmask_b32_dpp v84, v84, v84, vcc wave_shr:1 row_mask:0xf bank_mask:0xf
    v_cndmask_b32_dpp v85, v85, v85, vcc wave_shr:1 row_mask:0xf bank_mask:0xf
    s_lshr_b64 s[52:53], s[52:53], 1
    v_cndmask_b32_dpp v86, v86, v86, vcc wave_shr:1 row_mask:0xf bank_mask:0xf
    v_cndmask_b32_dpp v87, v87, v87, vcc wave_shr:1 row_mask:0xf bank_mask:0xf
    s_andn2_b64 s[82:83], s[82:83], s[52:53]
    v_cndmask_b32_dpp v7, v7, v7, vcc wave_shr:1 row_mask:0xf bank_mask:0xf
    s_mov_b64 exec, s[54:55]
    s_cbranch_scc0 L2_d75
    s_mov_b64 exec, s[82:83]
    s_nop 1
    v_mfma_f32_4x4x4_16b_bf16 v[88:91], v[12:13], v[84:85], 0
    s_nop 1
    v_mfma_f32_4x4x4_16b_bf16 v[88:91], v[10:11], v[86:87], v[88:91]
    s_nop 4
    v_cvt_pk_bf16_f32 v88, v88, v89
    v_cvt_pk_bf16_f32 v89, v90, v91
    ds_pk_add_bf16 v7, v88 offset:65408
    ds_pk_add_bf16 v7, v89 offset:65412
    s_mov_b64 exec, s[54:55]
    s_branch L2_d75
L2_c76:
    s_lshl_b64 s[52:53], s[82:83], 1
    s_andn2_b64 s[52:53], s[52:53], s[80:81]
    s_andn2_b64 s[52:53], s[52:53], s[50:51]
    s_or_b64 s[80:81], s[80:81], s[52:53]
    s_not_b64 vcc, s[52:53]
    s_mov_b64 exec, -1
    v_cndmask_b32_dpp v84, v84, v84, vcc wave_shr:1 row_mask:0xf bank_mask:0xf
    v_cndmask_b32_dpp v85, v85, v85, vcc wave_shr:1 row_mask:0xf bank_mask:0xf
    s_lshr_b64 s[52:53], s[52:53], 1
    v_cndmask_b32_dpp v86, v86, v86, vcc wave_shr:1 row_mask:0xf bank_mask:0xf
    v_cndmask_b32_dpp v87, v87, v87, vcc wave_shr:1 row_mask:0xf bank_mask:0xf
    s_andn2_b64 s[82:83], s[82:83], s[52:53]
    v_cndmask_b32_dpp v7, v7, v7, vcc wave_shr:1 row_mask:0xf bank_mask:0xf
    s_mov_b64 exec, s[50:51]
    s_cbranch_scc0 L2_d76
    s_mov_b64 exec, s[82:83]
    s_nop 1
    v_mfma_f32_4x4x4_16b_bf16 v[88:91], v[12:13], v[84:85], 0
    s_nop 1
    v_mfma_f32_4x4x4_16b_bf16 v[88:91], v[10:11], v[86:87], v[88:91]
    s_nop 4
    v_cvt_pk_bf16_f32 v88, v88, v89
    v_cvt_pk_bf16_f32 v89, v90, v91
    ds_pk_add_bf16 v7, v88 offset:65408
    ds_pk_add_bf16 v7, v89 offset:65412
    s_mov_b64 exec, s[50:51]
    s_branch L2_d76
L2_c77:
    s_lshl_b64 s[52:53], s[82:83], 1
    s_andn2_b64 s[52:53], s[52:53], s[80:81]
    s_andn2_b64 s[52:53], s[52:53], s[54:55]
    s_or_b64 s[80:81], s[80:81], s[52:53]
    s_not_b64 vcc, s[52:53]
    s_mov_b64 exec, -1
    v_cndmask_b32_dpp v84, v84, v84, vcc wave_shr:1 row_mask:0xf bank_mask:0xf
    v_cndmask_b32_dpp v85, v85, v85, vcc wave_shr:1 row_mask:0xf bank_mask:0xf
    s_lshr_b64 s[52:53], s[52:53], 1
    v_cndmask_b32_dpp v86, v86, v86, vcc wave_shr:1 row_mask:0xf bank_mask:0xf
    v_cndmask_b32_dpp v87, v87, v87, vcc wave_shr:1 row_mask:0xf bank_mask:0xf
    s_andn2_b64 s[82:83], s[82:83], s[52:53]
    v_cndmask_b32_dpp v7, v7, v7, vcc wave_shr:1 row_mask:0xf bank_mask:0xf
    s_mov_b64 exec, s[54:55]
    s_cbranch_scc0 L2_d77
    s_mov_b64 exec, s[82:83]
    s_nop 1
    v_mfma_f32_4x4x4_16b_bf16 v[88:91], v[12:13], v[84:85], 0
    s_nop 1
    v_mfma_f32_4x4x4_16b_bf16 v[88:91], v[10:11], v[86:87], v[88:91]
    s_nop 4
    v_cvt_pk_bf16_f32 v88, v88, v89
    v_cvt_pk_bf16_f32 v89, v90, v91
    ds_pk_add_bf16 v7, v88 offset:65408
    ds_pk_add_bf16 v7, v89 offset:65412
    s_mov_b64 exec, s[54:55]
    s_branch L2_d77
L2_c78:
    s_lshl_b64 s[52:53], s[82:83], 1
    s_andn2_b64 s[52:53], s[52:53], s[80:81]
    s_andn2_b64 s[52:53], s[52:53], s[50:51]
    s_or_b64 s[80:81], s[80:81], s[52:53]
    s_not_b64 vcc, s[52:53]
    s_mov_b64 exec, -1
    v_cndmask_b32_dpp v84, v84, v84, vcc wave_shr:1 row_mask:0xf bank_mask:0xf
    v_cndmask_b32_dpp v85, v85, v85, vcc wave_shr:1 row_mask:0xf bank_mask:0xf
    s_lshr_b64 s[52:53], s[52:53], 1
    v_cndmask_b32_dpp v86, v86, v86, vcc wave_shr:1 row_mask:0xf bank_mask:0xf
    v_cndmask_b32_dpp v87, v87, v87, vcc wave_shr:1 row_mask:0xf bank_mask:0xf
    s_andn2_b64 s[82:83], s[82:83], s[52:53]
    v_cndmask_b32_dpp v7, v7, v7, vcc wave_shr:1 row_mask:0xf bank_mask:0xf
    s_mov_b64 exec, s[50:51]
    s_cbranch_scc0 L2_d78
    s_mov_b64 exec, s[82:83]
    s_nop 1
    v_mfma_f32_4x4x4_16b_bf16 v[88:91], v[12:13], v[84:85], 0
    s_nop 1
    v_mfma_f32_4x4x4_16b_bf16 v[88:91], v[10:11], v[86:87], v[88:91]
    s_nop 4
    v_cvt_pk_bf16_f32 v88, v88, v89
    v_cvt_pk_bf16_f32 v89, v90, v91
    ds_pk_add_bf16 v7, v88 offset:65408
    ds_pk_add_bf16 v7, v89 offset:65412
    s_mov_b64 exec, s[50:51]
    s_branch L2_d78
L2_xa79:
    s_cmp_eq_u32 s101, 1
    s_cbranch_scc1 L2_xc79
    v_lshlrev_b32 v89, 0, v96
    v_add_u32 v90, 140, v97
    v_bitop3_b32 v90, v89, v45, v90 bitop3:0x6a
    ds_write_b32 v98, v90 offset:28
    v_lshlrev_b32 v89, 4, v96
    v_add_u32 v90, 120, v97
    v_bitop3_b32 v90, v89, v45, v90 bitop3:0x6a
    ds_write_b32 v98, v90 offset:24
    v_lshlrev_b32 v89, 8, v96
    v_add_u32 v90, 100, v97
    v_bitop3_b32 v90, v89, v45, v90 bitop3:0x6a
    ds_write_b32 v98, v90 offset:20
L2_xc79:
    v_lshlrev_b32 v89, 12, v96
    v_add_u32 v90, 80, v97
    v_bitop3_b32 v90, v89, v45, v90 bitop3:0x6a
    ds_write_b32 v98, v90 offset:16
    s_branch L2_xb79
L2_xe79:
    v_cmp_lt_u32 vcc, 32, v99
    v_cmp_lt_u32 s[58:59], 31, v88
    v_lshrrev_b32 v89, 16, v96
    v_add_u32 v97, 80, v97
    s_or_b64 vcc, vcc, s[58:59]
    s_cbranch_scc1 L2_xs79
    v_lshlrev_b32 v89, v1, v89
    v_and_b32 v89, v45, v89
    v_cmp_ne_u32 vcc, 0, v89
    v_xor_b32 v90, v97, v89
    s_add_u32 s3, s37, s38
    v_mbcnt_lo_u32_b32 v98, vcc_lo, 0
    v_mbcnt_hi_u32_b32 v98, vcc_hi, v98
    s_bcnt1_i32_b64 s41, vcc
    v_lshl_add_u32 v98, v98, 2, s3
    s_mov_b64 exec, vcc
    ds_write_b32 v98, v90
    s_mov_b64 exec, -1
    s_lshl2_add_u32 s37, s41, s37
    s_branch L2_xr79
L2_xf79:
    s_waitcnt lgkmcnt(0)
    s_cmp_gt_u32 s37, 1024
    s_cbranch_scc1 L2_xs79
    v_mov_b32 v43, -1
    s_cmp_ge_u32 s37, 512
    s_cbranch_scc1 L2_xg79
    v_mov_b32 v42, -1
    s_cmp_ge_u32 s37, 256
    s_cbranch_scc1 L2_xg79
    v_mov_b32 v41, -1
    s_branch L2_xg79
L2_xs79:
    s_waitcnt lgkmcnt(0)
    v_mov_b32 v40, -1
    v_mov_b32 v41, -1
    v_mov_b32 v42, -1
    v_mov_b32 v43, -1
    s_add_u32 s3, s42, 2
    s_bitset1_b32 s36, s3
    s_branch L2_xg79
L2_c80:
    s_lshl_b64 s[52:53], s[82:83], 1
    s_andn2_b64 s[52:53], s[52:53], s[80:81]
    s_andn2_b64 s[52:53], s[52:53], s[54:55]
    s_or_b64 s[80:81], s[80:81], s[52:53]
    s_not_b64 vcc, s[52:53]
    s_mov_b64 exec, -1
    v_cndmask_b32_dpp v84, v84, v84, vcc wave_shr:1 row_mask:0xf bank_mask:0xf
    v_cndmask_b32_dpp v85, v85, v85, vcc wave_shr:1 row_mask:0xf bank_mask:0xf
    s_lshr_b64 s[52:53], s[52:53], 1
    v_cndmask_b32_dpp v86, v86, v86, vcc wave_shr:1 row_mask:0xf bank_mask:0xf
    v_cndmask_b32_dpp v87, v87, v87, vcc wave_shr:1 row_mask:0xf bank_mask:0xf
    s_andn2_b64 s[82:83], s[82:83], s[52:53]
    v_cndmask_b32_dpp v7, v7, v7, vcc wave_shr:1 row_mask:0xf bank_mask:0xf
    s_mov_b64 exec, s[54:55]
    s_cbranch_scc0 L2_d80
    s_mov_b64 exec, s[82:83]
    s_nop 1
    v_mfma_f32_4x4x4_16b_bf16 v[88:91], v[12:13], v[84:85], 0
    s_nop 1
    v_mfma_f32_4x4x4_16b_bf16 v[88:91], v[10:11], v[86:87], v[88:91]
    s_nop 4
    v_cvt_pk_bf16_f32 v88, v88, v89
    v_cvt_pk_bf16_f32 v89, v90, v91
    ds_pk_add_bf16 v7, v88 offset:65408
    ds_pk_add_bf16 v7, v89 offset:65412
    s_mov_b64 exec, s[54:55]
    s_branch L2_d80
L2_c81:
    s_lshl_b64 s[52:53], s[82:83], 1
    s_andn2_b64 s[52:53], s[52:53], s[80:81]
    s_andn2_b64 s[52:53], s[52:53], s[50:51]
    s_or_b64 s[80:81], s[80:81], s[52:53]
    s_not_b64 vcc, s[52:53]
    s_mov_b64 exec, -1
    v_cndmask_b32_dpp v84, v84, v84, vcc wave_shr:1 row_mask:0xf bank_mask:0xf
    v_cndmask_b32_dpp v85, v85, v85, vcc wave_shr:1 row_mask:0xf bank_mask:0xf
    s_lshr_b64 s[52:53], s[52:53], 1
    v_cndmask_b32_dpp v86, v86, v86, vcc wave_shr:1 row_mask:0xf bank_mask:0xf
    v_cndmask_b32_dpp v87, v87, v87, vcc wave_shr:1 row_mask:0xf bank_mask:0xf
    s_andn2_b64 s[82:83], s[82:83], s[52:53]
    v_cndmask_b32_dpp v7, v7, v7, vcc wave_shr:1 row_mask:0xf bank_mask:0xf
    s_mov_b64 exec, s[50:51]
    s_cbranch_scc0 L2_d81
    s_mov_b64 exec, s[82:83]
    s_nop 1
    v_mfma_f32_4x4x4_16b_bf16 v[88:91], v[12:13], v[84:85], 0
    s_nop 1
    v_mfma_f32_4x4x4_16b_bf16 v[88:91], v[10:11], v[86:87], v[88:91]
    s_nop 4
    v_cvt_pk_bf16_f32 v88, v88, v89
    v_cvt_pk_bf16_f32 v89, v90, v91
    ds_pk_add_bf16 v7, v88 offset:65408
    ds_pk_add_bf16 v7, v89 offset:65412
    s_mov_b64 exec, s[50:51]
    s_branch L2_d81
L2_c82:
    s_lshl_b64 s[52:53], s[82:83], 1
    s_andn2_b64 s[52:53], s[52:53], s[80:81]
    s_andn2_b64 s[52:53], s[52:53], s[54:55]
    s_or_b64 s[80:81], s[80:81], s[52:53]
    s_not_b64 vcc, s[52:53]
    s_mov_b64 exec, -1
    v_cndmask_b32_dpp v84, v84, v84, vcc wave_shr:1 row_mask:0xf bank_mask:0xf
    v_cndmask_b32_dpp v85, v85, v85, vcc wave_shr:1 row_mask:0xf bank_mask:0xf
    s_lshr_b64 s[52:53], s[52:53], 1
    v_cndmask_b32_dpp v86, v86, v86, vcc wave_shr:1 row_mask:0xf bank_mask:0xf
    v_cndmask_b32_dpp v87, v87, v87, vcc wave_shr:1 row_mask:0xf bank_mask:0xf
    s_andn2_b64 s[82:83], s[82:83], s[52:53]
    v_cndmask_b32_dpp v7, v7, v7, vcc wave_shr:1 row_mask:0xf bank_mask:0xf
    s_mov_b64 exec, s[54:55]
    s_cbranch_scc0 L2_d82
    s_mov_b64 exec, s[82:83]
    s_nop 1
    v_mfma_f32_4x4x4_16b_bf16 v[88:91], v[12:13], v[84:85], 0
    s_nop 1
    v_mfma_f32_4x4x4_16b_bf16 v[88:91], v[10:11], v[86:87], v[88:91]
    s_nop 4
    v_cvt_pk_bf16_f32 v88, v88, v89
    v_cvt_pk_bf16_f32 v89, v90, v91
    ds_pk_add_bf16 v7, v88 offset:65408
    ds_pk_add_bf16 v7, v89 offset:65412
    s_mov_b64 exec, s[54:55]
    s_branch L2_d82
L2_c83:
    s_lshl_b64 s[52:53], s[82:83], 1
    s_andn2_b64 s[52:53], s[52:53], s[80:81]
    s_andn2_b64 s[52:53], s[52:53], s[50:51]
    s_or_b64 s[80:81], s[80:81], s[52:53]
    s_not_b64 vcc, s[52:53]
    s_mov_b64 exec, -1
    v_cndmask_b32_dpp v84, v84, v84, vcc wave_shr:1 row_mask:0xf bank_mask:0xf
    v_cndmask_b32_dpp v85, v85, v85, vcc wave_shr:1 row_mask:0xf bank_mask:0xf
    s_lshr_b64 s[52:53], s[52:53], 1
    v_cndmask_b32_dpp v86, v86, v86, vcc wave_shr:1 row_mask:0xf bank_mask:0xf
    v_cndmask_b32_dpp v87, v87, v87, vcc wave_shr:1 row_mask:0xf bank_mask:0xf
    s_andn2_b64 s[82:83], s[82:83], s[52:53]
    v_cndmask_b32_dpp v7, v7, v7, vcc wave_shr:1 row_mask:0xf bank_mask:0xf
    s_mov_b64 exec, s[50:51]
    s_cbranch_scc0 L2_d83
    s_mov_b64 exec, s[82:83]
    s_nop 1
    v_mfma_f32_4x4x4_16b_bf16 v[88:91], v[12:13], v[84:85], 0
    s_nop 1
    v_mfma_f32_4x4x4_16b_bf16 v[88:91], v[10:11], v[86:87], v[88:91]
    s_nop 4
    v_cvt_pk_bf16_f32 v88, v88, v89
    v_cvt_pk_bf16_f32 v89, v90, v91
    ds_pk_add_bf16 v7, v88 offset:65408
    ds_pk_add_bf16 v7, v89 offset:65412
    s_mov_b64 exec, s[50:51]
    s_branch L2_d83
L2_c84:
    s_lshl_b64 s[52:53], s[82:83], 1
    s_andn2_b64 s[52:53], s[52:53], s[80:81]
    s_andn2_b64 s[52:53], s[52:53], s[54:55]
    s_or_b64 s[80:81], s[80:81], s[52:53]
    s_not_b64 vcc, s[52:53]
    s_mov_b64 exec, -1
    v_cndmask_b32_dpp v84, v84, v84, vcc wave_shr:1 row_mask:0xf bank_mask:0xf
    v_cndmask_b32_dpp v85, v85, v85, vcc wave_shr:1 row_mask:0xf bank_mask:0xf
    s_lshr_b64 s[52:53], s[52:53], 1
    v_cndmask_b32_dpp v86, v86, v86, vcc wave_shr:1 row_mask:0xf bank_mask:0xf
    v_cndmask_b32_dpp v87, v87, v87, vcc wave_shr:1 row_mask:0xf bank_mask:0xf
    s_andn2_b64 s[82:83], s[82:83], s[52:53]
    v_cndmask_b32_dpp v7, v7, v7, vcc wave_shr:1 row_mask:0xf bank_mask:0xf
    s_mov_b64 exec, s[54:55]
    s_cbranch_scc0 L2_d84
    s_mov_b64 exec, s[82:83]
    s_nop 1
    v_mfma_f32_4x4x4_16b_bf16 v[88:91], v[12:13], v[84:85], 0
    s_nop 1
    v_mfma_f32_4x4x4_16b_bf16 v[88:91], v[10:11], v[86:87], v[88:91]
    s_nop 4
    v_cvt_pk_bf16_f32 v88, v88, v89
    v_cvt_pk_bf16_f32 v89, v90, v91
    ds_pk_add_bf16 v7, v88 offset:65408
    ds_pk_add_bf16 v7, v89 offset:65412
    s_mov_b64 exec, s[54:55]
    s_branch L2_d84
L2_c85:
    s_lshl_b64 s[52:53], s[82:83], 1
    s_andn2_b64 s[52:53], s[52:53], s[80:81]
    s_andn2_b64 s[52:53], s[52:53], s[50:51]
    s_or_b64 s[80:81], s[80:81], s[52:53]
    s_not_b64 vcc, s[52:53]
    s_mov_b64 exec, -1
    v_cndmask_b32_dpp v84, v84, v84, vcc wave_shr:1 row_mask:0xf bank_mask:0xf
    v_cndmask_b32_dpp v85, v85, v85, vcc wave_shr:1 row_mask:0xf bank_mask:0xf
    s_lshr_b64 s[52:53], s[52:53], 1
    v_cndmask_b32_dpp v86, v86, v86, vcc wave_shr:1 row_mask:0xf bank_mask:0xf
    v_cndmask_b32_dpp v87, v87, v87, vcc wave_shr:1 row_mask:0xf bank_mask:0xf
    s_andn2_b64 s[82:83], s[82:83], s[52:53]
    v_cndmask_b32_dpp v7, v7, v7, vcc wave_shr:1 row_mask:0xf bank_mask:0xf
    s_mov_b64 exec, s[50:51]
    s_cbranch_scc0 L2_d85
    s_mov_b64 exec, s[82:83]
    s_nop 1
    v_mfma_f32_4x4x4_16b_bf16 v[88:91], v[12:13], v[84:85], 0
    s_nop 1
    v_mfma_f32_4x4x4_16b_bf16 v[88:91], v[10:11], v[86:87], v[88:91]
    s_nop 4
    v_cvt_pk_bf16_f32 v88, v88, v89
    v_cvt_pk_bf16_f32 v89, v90, v91
    ds_pk_add_bf16 v7, v88 offset:65408
    ds_pk_add_bf16 v7, v89 offset:65412
    s_mov_b64 exec, s[50:51]
    s_branch L2_d85
L2_xo86:
    v_cmp_lt_u32 vcc, 20, v99
    s_mov_b32 s101, 1
    s_cbranch_vccz L2_xp86
    v_cmp_lt_u32 vcc, 32, v99
    v_cmp_lt_u32 s[58:59], 31, v88
    s_mov_b32 s101, 2
    s_or_b64 vcc, vcc, s[58:59]
    s_cbranch_scc0 L2_xp86
    s_mov_b32 s37, 0x10000
    s_branch L2_xp86
L2_c87:
    s_lshl_b64 s[52:53], s[82:83], 1
    s_andn2_b64 s[52:53], s[52:53], s[80:81]
    s_andn2_b64 s[52:53], s[52:53], s[54:55]
    s_or_b64 s[80:81], s[80:81], s[52:53]
    s_not_b64 vcc, s[52:53]
    s_mov_b64 exec, -1
    v_cndmask_b32_dpp v84, v84, v84, vcc wave_shr:1 row_mask:0xf bank_mask:0xf
    v_cndmask_b32_dpp v85, v85, v85, vcc wave_shr:1 row_mask:0xf bank_mask:0xf
    s_lshr_b64 s[52:53], s[52:53], 1
    v_cndmask_b32_dpp v86, v86, v86, vcc wave_shr:1 row_mask:0xf bank_mask:0xf
    v_cndmask_b32_dpp v87, v87, v87, vcc wave_shr:1 row_mask:0xf bank_mask:0xf
    s_andn2_b64 s[82:83], s[82:83], s[52:53]
    v_cndmask_b32_dpp v7, v7, v7, vcc wave_shr:1 row_mask:0xf bank_mask:0xf
    s_mov_b64 exec, s[54:55]
    s_cbranch_scc0 L2_d87
    s_mov_b64 exec, s[82:83]
    s_nop 1
    v_mfma_f32_4x4x4_16b_bf16 v[88:91], v[12:13], v[84:85], 0
    s_nop 1
    v_mfma_f32_4x4x4_16b_bf16 v[88:91], v[10:11], v[86:87], v[88:91]
    s_nop 4
    v_cvt_pk_bf16_f32 v88, v88, v89
    v_cvt_pk_bf16_f32 v89, v90, v91
    ds_pk_add_bf16 v7, v88 offset:65408
    ds_pk_add_bf16 v7, v89 offset:65412
    s_mov_b64 exec, s[54:55]
    s_branch L2_d87
L2_c88:
    s_lshl_b64 s[52:53], s[82:83], 1
    s_andn2_b64 s[52:53], s[52:53], s[80:81]
    s_andn2_b64 s[52:53], s[52:53], s[50:51]
    s_or_b64 s[80:81], s[80:81], s[52:53]
    s_not_b64 vcc, s[52:53]
    s_mov_b64 exec, -1
    v_cndmask_b32_dpp v84, v84, v84, vcc wave_shr:1 row_mask:0xf bank_mask:0xf
    v_cndmask_b32_dpp v85, v85, v85, vcc wave_shr:1 row_mask:0xf bank_mask:0xf
    s_lshr_b64 s[52:53], s[52:53], 1
    v_cndmask_b32_dpp v86, v86, v86, vcc wave_shr:1 row_mask:0xf bank_mask:0xf
    v_cndmask_b32_dpp v87, v87, v87, vcc wave_shr:1 row_mask:0xf bank_mask:0xf
    s_andn2_b64 s[82:83], s[82:83], s[52:53]
    v_cndmask_b32_dpp v7, v7, v7, vcc wave_shr:1 row_mask:0xf bank_mask:0xf
    s_mov_b64 exec, s[50:51]
    s_cbranch_scc0 L2_d88
    s_mov_b64 exec, s[82:83]
    s_nop 1
    v_mfma_f32_4x4x4_16b_bf16 v[88:91], v[12:13], v[84:85], 0
    s_nop 1
    v_mfma_f32_4x4x4_16b_bf16 v[88:91], v[10:11], v[86:87], v[88:91]
    s_nop 4
    v_cvt_pk_bf16_f32 v88, v88, v89
    v_cvt_pk_bf16_f32 v89, v90, v91
    ds_pk_add_bf16 v7, v88 offset:65408
    ds_pk_add_bf16 v7, v89 offset:65412
    s_mov_b64 exec, s[50:51]
    s_branch L2_d88
L2_c89:
    s_lshl_b64 s[52:53], s[82:83], 1
    s_andn2_b64 s[52:53], s[52:53], s[80:81]
    s_andn2_b64 s[52:53], s[52:53], s[54:55]
    s_or_b64 s[80:81], s[80:81], s[52:53]
    s_not_b64 vcc, s[52:53]
    s_mov_b64 exec, -1
    v_cndmask_b32_dpp v84, v84, v84, vcc wave_shr:1 row_mask:0xf bank_mask:0xf
    v_cndmask_b32_dpp v85, v85, v85, vcc wave_shr:1 row_mask:0xf bank_mask:0xf
    s_lshr_b64 s[52:53], s[52:53], 1
    v_cndmask_b32_dpp v86, v86, v86, vcc wave_shr:1 row_mask:0xf bank_mask:0xf
    v_cndmask_b32_dpp v87, v87, v87, vcc wave_shr:1 row_mask:0xf bank_mask:0xf
    s_andn2_b64 s[82:83], s[82:83], s[52:53]
    v_cndmask_b32_dpp v7, v7, v7, vcc wave_shr:1 row_mask:0xf bank_mask:0xf
    s_mov_b64 exec, s[54:55]
    s_cbranch_scc0 L2_d89
    s_mov_b64 exec, s[82:83]
    s_nop 1
    v_mfma_f32_4x4x4_16b_bf16 v[88:91], v[12:13], v[84:85], 0
    s_nop 1
    v_mfma_f32_4x4x4_16b_bf16 v[88:91], v[10:11], v[86:87], v[88:91]
    s_nop 4
    v_cvt_pk_bf16_f32 v88, v88, v89
    v_cvt_pk_bf16_f32 v89, v90, v91
    ds_pk_add_bf16 v7, v88 offset:65408
    ds_pk_add_bf16 v7, v89 offset:65412
    s_mov_b64 exec, s[54:55]
    s_branch L2_d89
L2_c90:
    s_lshl_b64 s[52:53], s[82:83], 1
    s_andn2_b64 s[52:53], s[52:53], s[80:81]
    s_andn2_b64 s[52:53], s[52:53], s[50:51]
    s_or_b64 s[80:81], s[80:81], s[52:53]
    s_not_b64 vcc, s[52:53]
    s_mov_b64 exec, -1
    v_cndmask_b32_dpp v84, v84, v84, vcc wave_shr:1 row_mask:0xf bank_mask:0xf
    v_cndmask_b32_dpp v85, v85, v85, vcc wave_shr:1 row_mask:0xf bank_mask:0xf
    s_lshr_b64 s[52:53], s[52:53], 1
    v_cndmask_b32_dpp v86, v86, v86, vcc wave_shr:1 row_mask:0xf bank_mask:0xf
    v_cndmask_b32_dpp v87, v87, v87, vcc wave_shr:1 row_mask:0xf bank_mask:0xf
    s_andn2_b64 s[82:83], s[82:83], s[52:53]
    v_cndmask_b32_dpp v7, v7, v7, vcc wave_shr:1 row_mask:0xf bank_mask:0xf
    s_mov_b64 exec, s[50:51]
    s_cbranch_scc0 L2_d90
    s_mov_b64 exec, s[82:83]
    s_nop 1
    v_mfma_f32_4x4x4_16b_bf16 v[88:91], v[12:13], v[84:85], 0
    s_nop 1
    v_mfma_f32_4x4x4_16b_bf16 v[88:91], v[10:11], v[86:87], v[88:91]
    s_nop 4
    v_cvt_pk_bf16_f32 v88, v88, v89
    v_cvt_pk_bf16_f32 v89, v90, v91
    ds_pk_add_bf16 v7, v88 offset:65408
    ds_pk_add_bf16 v7, v89 offset:65412
    s_mov_b64 exec, s[50:51]
    s_branch L2_d90
L2_c91:
    s_lshl_b64 s[52:53], s[82:83], 1
    s_andn2_b64 s[52:53], s[52:53], s[80:81]
    s_andn2_b64 s[52:53], s[52:53], s[54:55]
    s_or_b64 s[80:81], s[80:81], s[52:53]
    s_not_b64 vcc, s[52:53]
    s_mov_b64 exec, -1
    v_cndmask_b32_dpp v84, v84, v84, vcc wave_shr:1 row_mask:0xf bank_mask:0xf
    v_cndmask_b32_dpp v85, v85, v85, vcc wave_shr:1 row_mask:0xf bank_mask:0xf
    s_lshr_b64 s[52:53], s[52:53], 1
    v_cndmask_b32_dpp v86, v86, v86, vcc wave_shr:1 row_mask:0xf bank_mask:0xf
    v_cndmask_b32_dpp v87, v87, v87, vcc wave_shr:1 row_mask:0xf bank_mask:0xf
    s_andn2_b64 s[82:83], s[82:83], s[52:53]
    v_cndmask_b32_dpp v7, v7, v7, vcc wave_shr:1 row_mask:0xf bank_mask:0xf
    s_mov_b64 exec, s[54:55]
    s_cbranch_scc0 L2_d91
    s_mov_b64 exec, s[82:83]
    s_nop 1
    v_mfma_f32_4x4x4_16b_bf16 v[88:91], v[12:13], v[84:85], 0
    s_nop 1
    v_mfma_f32_4x4x4_16b_bf16 v[88:91], v[10:11], v[86:87], v[88:91]
    s_nop 4
    v_cvt_pk_bf16_f32 v88, v88, v89
    v_cvt_pk_bf16_f32 v89, v90, v91
    ds_pk_add_bf16 v7, v88 offset:65408
    ds_pk_add_bf16 v7, v89 offset:65412
    s_mov_b64 exec, s[54:55]
    s_branch L2_d91
L2_c92:
    s_lshl_b64 s[52:53], s[82:83], 1
    s_andn2_b64 s[52:53], s[52:53], s[80:81]
    s_andn2_b64 s[52:53], s[52:53], s[50:51]
    s_or_b64 s[80:81], s[80:81], s[52:53]
    s_not_b64 vcc, s[52:53]
    s_mov_b64 exec, -1
    v_cndmask_b32_dpp v84, v84, v84, vcc wave_shr:1 row_mask:0xf bank_mask:0xf
    v_cndmask_b32_dpp v85, v85, v85, vcc wave_shr:1 row_mask:0xf bank_mask:0xf
    s_lshr_b64 s[52:53], s[52:53], 1
    v_cndmask_b32_dpp v86, v86, v86, vcc wave_shr:1 row_mask:0xf bank_mask:0xf
    v_cndmask_b32_dpp v87, v87, v87, vcc wave_shr:1 row_mask:0xf bank_mask:0xf
    s_andn2_b64 s[82:83], s[82:83], s[52:53]
    v_cndmask_b32_dpp v7, v7, v7, vcc wave_shr:1 row_mask:0xf bank_mask:0xf
    s_mov_b64 exec, s[50:51]
    s_cbranch_scc0 L2_d92
    s_mov_b64 exec, s[82:83]
    s_nop 1
    v_mfma_f32_4x4x4_16b_bf16 v[88:91], v[12:13], v[84:85], 0
    s_nop 1
    v_mfma_f32_4x4x4_16b_bf16 v[88:91], v[10:11], v[86:87], v[88:91]
    s_nop 4
    v_cvt_pk_bf16_f32 v88, v88, v89
    v_cvt_pk_bf16_f32 v89, v90, v91
    ds_pk_add_bf16 v7, v88 offset:65408
    ds_pk_add_bf16 v7, v89 offset:65412
    s_mov_b64 exec, s[50:51]
    s_branch L2_d92
L2_c93:
    s_lshl_b64 s[52:53], s[82:83], 1
    s_andn2_b64 s[52:53], s[52:53], s[80:81]
    s_andn2_b64 s[52:53], s[52:53], s[54:55]
    s_or_b64 s[80:81], s[80:81], s[52:53]
    s_not_b64 vcc, s[52:53]
    s_mov_b64 exec, -1
    v_cndmask_b32_dpp v84, v84, v84, vcc wave_shr:1 row_mask:0xf bank_mask:0xf
    v_cndmask_b32_dpp v85, v85, v85, vcc wave_shr:1 row_mask:0xf bank_mask:0xf
    s_lshr_b64 s[52:53], s[52:53], 1
    v_cndmask_b32_dpp v86, v86, v86, vcc wave_shr:1 row_mask:0xf bank_mask:0xf
    v_cndmask_b32_dpp v87, v87, v87, vcc wave_shr:1 row_mask:0xf bank_mask:0xf
    s_andn2_b64 s[82:83], s[82:83], s[52:53]
    v_cndmask_b32_dpp v7, v7, v7, vcc wave_shr:1 row_mask:0xf bank_mask:0xf
    s_mov_b64 exec, s[54:55]
    s_cbranch_scc0 L2_d93
    s_mov_b64 exec, s[82:83]
    s_nop 1
    v_mfma_f32_4x4x4_16b_bf16 v[88:91], v[12:13], v[84:85], 0
    s_nop 1
    v_mfma_f32_4x4x4_16b_bf16 v[88:91], v[10:11], v[86:87], v[88:91]
    s_nop 4
    v_cvt_pk_bf16_f32 v88, v88, v89
    v_cvt_pk_bf16_f32 v89, v90, v91
    ds_pk_add_bf16 v7, v88 offset:65408
    ds_pk_add_bf16 v7, v89 offset:65412
    s_mov_b64 exec, s[54:55]
    s_branch L2_d93
L2_c94:
    s_lshl_b64 s[52:53], s[82:83], 1
    s_andn2_b64 s[52:53], s[52:53], s[80:81]
    s_andn2_b64 s[52:53], s[52:53], s[50:51]
    s_or_b64 s[80:81], s[80:81], s[52:53]
    s_not_b64 vcc, s[52:53]
    s_mov_b64 exec, -1
    v_cndmask_b32_dpp v84, v84, v84, vcc wave_shr:1 row_mask:0xf bank_mask:0xf
    v_cndmask_b32_dpp v85, v85, v85, vcc wave_shr:1 row_mask:0xf bank_mask:0xf
    s_lshr_b64 s[52:53], s[52:53], 1
    v_cndmask_b32_dpp v86, v86, v86, vcc wave_shr:1 row_mask:0xf bank_mask:0xf
    v_cndmask_b32_dpp v87, v87, v87, vcc wave_shr:1 row_mask:0xf bank_mask:0xf
    s_andn2_b64 s[82:83], s[82:83], s[52:53]
    v_cndmask_b32_dpp v7, v7, v7, vcc wave_shr:1 row_mask:0xf bank_mask:0xf
    s_mov_b64 exec, s[50:51]
    s_cbranch_scc0 L2_d94
    s_mov_b64 exec, s[82:83]
    s_nop 1
    v_mfma_f32_4x4x4_16b_bf16 v[88:91], v[12:13], v[84:85], 0
    s_nop 1
    v_mfma_f32_4x4x4_16b_bf16 v[88:91], v[10:11], v[86:87], v[88:91]
    s_nop 4
    v_cvt_pk_bf16_f32 v88, v88, v89
    v_cvt_pk_bf16_f32 v89, v90, v91
    ds_pk_add_bf16 v7, v88 offset:65408
    ds_pk_add_bf16 v7, v89 offset:65412
    s_mov_b64 exec, s[50:51]
    s_branch L2_d94
L2_c95:
    s_lshl_b64 s[52:53], s[82:83], 1
    s_andn2_b64 s[52:53], s[52:53], s[80:81]
    s_andn2_b64 s[52:53], s[52:53], s[54:55]
    s_or_b64 s[80:81], s[80:81], s[52:53]
    s_not_b64 vcc, s[52:53]
    s_mov_b64 exec, -1
    v_cndmask_b32_dpp v84, v84, v84, vcc wave_shr:1 row_mask:0xf bank_mask:0xf
    v_cndmask_b32_dpp v85, v85, v85, vcc wave_shr:1 row_mask:0xf bank_mask:0xf
    s_lshr_b64 s[52:53], s[52:53], 1
    v_cndmask_b32_dpp v86, v86, v86, vcc wave_shr:1 row_mask:0xf bank_mask:0xf
    v_cndmask_b32_dpp v87, v87, v87, vcc wave_shr:1 row_mask:0xf bank_mask:0xf
    s_andn2_b64 s[82:83], s[82:83], s[52:53]
    v_cndmask_b32_dpp v7, v7, v7, vcc wave_shr:1 row_mask:0xf bank_mask:0xf
    s_mov_b64 exec, s[54:55]
    s_cbranch_scc0 L2_d95
    s_mov_b64 exec, s[82:83]
    s_nop 1
    v_mfma_f32_4x4x4_16b_bf16 v[88:91], v[12:13], v[84:85], 0
    s_nop 1
    v_mfma_f32_4x4x4_16b_bf16 v[88:91], v[10:11], v[86:87], v[88:91]
    s_nop 4
    v_cvt_pk_bf16_f32 v88, v88, v89
    v_cvt_pk_bf16_f32 v89, v90, v91
    ds_pk_add_bf16 v7, v88 offset:65408
    ds_pk_add_bf16 v7, v89 offset:65412
    s_mov_b64 exec, s[54:55]
    s_branch L2_d95
L2_c96:
    s_lshl_b64 s[52:53], s[82:83], 1
    s_andn2_b64 s[52:53], s[52:53], s[80:81]
    s_andn2_b64 s[52:53], s[52:53], s[50:51]
    s_or_b64 s[80:81], s[80:81], s[52:53]
    s_not_b64 vcc, s[52:53]
    s_mov_b64 exec, -1
    v_cndmask_b32_dpp v84, v84, v84, vcc wave_shr:1 row_mask:0xf bank_mask:0xf
    v_cndmask_b32_dpp v85, v85, v85, vcc wave_shr:1 row_mask:0xf bank_mask:0xf
    s_lshr_b64 s[52:53], s[52:53], 1
    v_cndmask_b32_dpp v86, v86, v86, vcc wave_shr:1 row_mask:0xf bank_mask:0xf
    v_cndmask_b32_dpp v87, v87, v87, vcc wave_shr:1 row_mask:0xf bank_mask:0xf
    s_andn2_b64 s[82:83], s[82:83], s[52:53]
    v_cndmask_b32_dpp v7, v7, v7, vcc wave_shr:1 row_mask:0xf bank_mask:0xf
    s_mov_b64 exec, s[50:51]
    s_cbranch_scc0 L2_d96
    s_mov_b64 exec, s[82:83]
    s_nop 1
    v_mfma_f32_4x4x4_16b_bf16 v[88:91], v[12:13], v[84:85], 0
    s_nop 1
    v_mfma_f32_4x4x4_16b_bf16 v[88:91], v[10:11], v[86:87], v[88:91]
    s_nop 4
    v_cvt_pk_bf16_f32 v88, v88, v89
    v_cvt_pk_bf16_f32 v89, v90, v91
    ds_pk_add_bf16 v7, v88 offset:65408
    ds_pk_add_bf16 v7, v89 offset:65412
    s_mov_b64 exec, s[50:51]
    s_branch L2_d96
L2_xa97:
    s_cmp_eq_u32 s101, 1
    s_cbranch_scc1 L2_xc97
    v_lshlrev_b32 v89, 0, v96
    v_add_u32 v90, 140, v97
    v_bitop3_b32 v90, v89, v45, v90 bitop3:0x6a
    ds_write_b32 v98, v90 offset:28
    v_lshlrev_b32 v89, 4, v96
    v_add_u32 v90, 120, v97
    v_bitop3_b32 v90, v89, v45, v90 bitop3:0x6a
    ds_write_b32 v98, v90 offset:24
    v_lshlrev_b32 v89, 8, v96
    v_add_u32 v90, 100, v97
    v_bitop3_b32 v90, v89, v45, v90 bitop3:0x6a
    ds_write_b32 v98, v90 offset:20
L2_xc97:
    v_lshlrev_b32 v89, 12, v96
    v_add_u32 v90, 80, v97
    v_bitop3_b32 v90, v89, v45, v90 bitop3:0x6a
    ds_write_b32 v98, v90 offset:16
    s_branch L2_xb97
L2_xe97:
    v_cmp_lt_u32 vcc, 32, v99
    v_cmp_lt_u32 s[58:59], 31, v88
    v_lshrrev_b32 v89, 16, v96
    v_add_u32 v97, 80, v97
    s_or_b64 vcc, vcc, s[58:59]
    s_cbranch_scc1 L2_xs97
    v_lshlrev_b32 v89, v1, v89
    v_and_b32 v89, v45, v89
    v_cmp_ne_u32 vcc, 0, v89
    v_xor_b32 v90, v97, v89
    s_add_u32 s3, s37, s38
    v_mbcnt_lo_u32_b32 v98, vcc_lo, 0
    v_mbcnt_hi_u32_b32 v98, vcc_hi, v98
    s_bcnt1_i32_b64 s41, vcc
    v_lshl_add_u32 v98, v98, 2, s3
    s_mov_b64 exec, vcc
    ds_write_b32 v98, v90
    s_mov_b64 exec, -1
    s_lshl2_add_u32 s37, s41, s37
    s_branch L2_xr97
L2_xf97:
    s_waitcnt lgkmcnt(0)
    s_cmp_gt_u32 s37, 1024
    s_cbranch_scc1 L2_xs97
    v_mov_b32 v43, -1
    s_cmp_ge_u32 s37, 512
    s_cbranch_scc1 L2_xg97
    v_mov_b32 v42, -1
    s_cmp_ge_u32 s37, 256
    s_cbranch_scc1 L2_xg97
    v_mov_b32 v41, -1
    s_branch L2_xg97
L2_xs97:
    s_waitcnt lgkmcnt(0)
    v_mov_b32 v40, -1
    v_mov_b32 v41, -1
    v_mov_b32 v42, -1
    v_mov_b32 v43, -1
    s_add_u32 s3, s42, 2
    s_bitset1_b32 s36, s3
    s_branch L2_xg97
L2_c98:
    s_lshl_b64 s[52:53], s[82:83], 1
    s_andn2_b64 s[52:53], s[52:53], s[80:81]
    s_andn2_b64 s[52:53], s[52:53], s[54:55]
    s_or_b64 s[80:81], s[80:81], s[52:53]
    s_not_b64 vcc, s[52:53]
    s_mov_b64 exec, -1
    v_cndmask_b32_dpp v84, v84, v84, vcc wave_shr:1 row_mask:0xf bank_mask:0xf
    v_cndmask_b32_dpp v85, v85, v85, vcc wave_shr:1 row_mask:0xf bank_mask:0xf
    s_lshr_b64 s[52:53], s[52:53], 1
    v_cndmask_b32_dpp v86, v86, v86, vcc wave_shr:1 row_mask:0xf bank_mask:0xf
    v_cndmask_b32_dpp v87, v87, v87, vcc wave_shr:1 row_mask:0xf bank_mask:0xf
    s_andn2_b64 s[82:83], s[82:83], s[52:53]
    v_cndmask_b32_dpp v7, v7, v7, vcc wave_shr:1 row_mask:0xf bank_mask:0xf
    s_mov_b64 exec, s[54:55]
    s_cbranch_scc0 L2_d98
    s_mov_b64 exec, s[82:83]
    s_nop 1
    v_mfma_f32_4x4x4_16b_bf16 v[88:91], v[12:13], v[84:85], 0
    s_nop 1
    v_mfma_f32_4x4x4_16b_bf16 v[88:91], v[10:11], v[86:87], v[88:91]
    s_nop 4
    v_cvt_pk_bf16_f32 v88, v88, v89
    v_cvt_pk_bf16_f32 v89, v90, v91
    ds_pk_add_bf16 v7, v88 offset:65408
    ds_pk_add_bf16 v7, v89 offset:65412
    s_mov_b64 exec, s[54:55]
    s_branch L2_d98
L2_c99:
    s_lshl_b64 s[52:53], s[82:83], 1
    s_andn2_b64 s[52:53], s[52:53], s[80:81]
    s_andn2_b64 s[52:53], s[52:53], s[50:51]
    s_or_b64 s[80:81], s[80:81], s[52:53]
    s_not_b64 vcc, s[52:53]
    s_mov_b64 exec, -1
    v_cndmask_b32_dpp v84, v84, v84, vcc wave_shr:1 row_mask:0xf bank_mask:0xf
    v_cndmask_b32_dpp v85, v85, v85, vcc wave_shr:1 row_mask:0xf bank_mask:0xf
    s_lshr_b64 s[52:53], s[52:53], 1
    v_cndmask_b32_dpp v86, v86, v86, vcc wave_shr:1 row_mask:0xf bank_mask:0xf
    v_cndmask_b32_dpp v87, v87, v87, vcc wave_shr:1 row_mask:0xf bank_mask:0xf
    s_andn2_b64 s[82:83], s[82:83], s[52:53]
    v_cndmask_b32_dpp v7, v7, v7, vcc wave_shr:1 row_mask:0xf bank_mask:0xf
    s_mov_b64 exec, s[50:51]
    s_cbranch_scc0 L2_d99
    s_mov_b64 exec, s[82:83]
    s_nop 1
    v_mfma_f32_4x4x4_16b_bf16 v[88:91], v[12:13], v[84:85], 0
    s_nop 1
    v_mfma_f32_4x4x4_16b_bf16 v[88:91], v[10:11], v[86:87], v[88:91]
    s_nop 4
    v_cvt_pk_bf16_f32 v88, v88, v89
    v_cvt_pk_bf16_f32 v89, v90, v91
    ds_pk_add_bf16 v7, v88 offset:65408
    ds_pk_add_bf16 v7, v89 offset:65412
    s_mov_b64 exec, s[50:51]
    s_branch L2_d99
L2_c100:
    s_lshl_b64 s[52:53], s[82:83], 1
    s_andn2_b64 s[52:53], s[52:53], s[80:81]
    s_andn2_b64 s[52:53], s[52:53], s[54:55]
    s_or_b64 s[80:81], s[80:81], s[52:53]
    s_not_b64 vcc, s[52:53]
    s_mov_b64 exec, -1
    v_cndmask_b32_dpp v84, v84, v84, vcc wave_shr:1 row_mask:0xf bank_mask:0xf
    v_cndmask_b32_dpp v85, v85, v85, vcc wave_shr:1 row_mask:0xf bank_mask:0xf
    s_lshr_b64 s[52:53], s[52:53], 1
    v_cndmask_b32_dpp v86, v86, v86, vcc wave_shr:1 row_mask:0xf bank_mask:0xf
    v_cndmask_b32_dpp v87, v87, v87, vcc wave_shr:1 row_mask:0xf bank_mask:0xf
    s_andn2_b64 s[82:83], s[82:83], s[52:53]
    v_cndmask_b32_dpp v7, v7, v7, vcc wave_shr:1 row_mask:0xf bank_mask:0xf
    s_mov_b64 exec, s[54:55]
    s_cbranch_scc0 L2_d100
    s_mov_b64 exec, s[82:83]
    s_nop 1
    v_mfma_f32_4x4x4_16b_bf16 v[88:91], v[12:13], v[84:85], 0
    s_nop 1
    v_mfma_f32_4x4x4_16b_bf16 v[88:91], v[10:11], v[86:87], v[88:91]
    s_nop 4
    v_cvt_pk_bf16_f32 v88, v88, v89
    v_cvt_pk_bf16_f32 v89, v90, v91
    ds_pk_add_bf16 v7, v88 offset:65408
    ds_pk_add_bf16 v7, v89 offset:65412
    s_mov_b64 exec, s[54:55]
    s_branch L2_d100
L2_c101:
    s_lshl_b64 s[52:53], s[82:83], 1
    s_andn2_b64 s[52:53], s[52:53], s[80:81]
    s_andn2_b64 s[52:53], s[52:53], s[50:51]
    s_or_b64 s[80:81], s[80:81], s[52:53]
    s_not_b64 vcc, s[52:53]
    s_mov_b64 exec, -1
    v_cndmask_b32_dpp v84, v84, v84, vcc wave_shr:1 row_mask:0xf bank_mask:0xf
    v_cndmask_b32_dpp v85, v85, v85, vcc wave_shr:1 row_mask:0xf bank_mask:0xf
    s_lshr_b64 s[52:53], s[52:53], 1
    v_cndmask_b32_dpp v86, v86, v86, vcc wave_shr:1 row_mask:0xf bank_mask:0xf
    v_cndmask_b32_dpp v87, v87, v87, vcc wave_shr:1 row_mask:0xf bank_mask:0xf
    s_andn2_b64 s[82:83], s[82:83], s[52:53]
    v_cndmask_b32_dpp v7, v7, v7, vcc wave_shr:1 row_mask:0xf bank_mask:0xf
    s_mov_b64 exec, s[50:51]
    s_cbranch_scc0 L2_d101
    s_mov_b64 exec, s[82:83]
    s_nop 1
    v_mfma_f32_4x4x4_16b_bf16 v[88:91], v[12:13], v[84:85], 0
    s_nop 1
    v_mfma_f32_4x4x4_16b_bf16 v[88:91], v[10:11], v[86:87], v[88:91]
    s_nop 4
    v_cvt_pk_bf16_f32 v88, v88, v89
    v_cvt_pk_bf16_f32 v89, v90, v91
    ds_pk_add_bf16 v7, v88 offset:65408
    ds_pk_add_bf16 v7, v89 offset:65412
    s_mov_b64 exec, s[50:51]
    s_branch L2_d101
L2_c102:
    s_lshl_b64 s[52:53], s[82:83], 1
    s_andn2_b64 s[52:53], s[52:53], s[80:81]
    s_andn2_b64 s[52:53], s[52:53], s[54:55]
    s_or_b64 s[80:81], s[80:81], s[52:53]
    s_not_b64 vcc, s[52:53]
    s_mov_b64 exec, -1
    v_cndmask_b32_dpp v84, v84, v84, vcc wave_shr:1 row_mask:0xf bank_mask:0xf
    v_cndmask_b32_dpp v85, v85, v85, vcc wave_shr:1 row_mask:0xf bank_mask:0xf
    s_lshr_b64 s[52:53], s[52:53], 1
    v_cndmask_b32_dpp v86, v86, v86, vcc wave_shr:1 row_mask:0xf bank_mask:0xf
    v_cndmask_b32_dpp v87, v87, v87, vcc wave_shr:1 row_mask:0xf bank_mask:0xf
    s_andn2_b64 s[82:83], s[82:83], s[52:53]
    v_cndmask_b32_dpp v7, v7, v7, vcc wave_shr:1 row_mask:0xf bank_mask:0xf
    s_mov_b64 exec, s[54:55]
    s_cbranch_scc0 L2_d102
    s_mov_b64 exec, s[82:83]
    s_nop 1
    v_mfma_f32_4x4x4_16b_bf16 v[88:91], v[12:13], v[84:85], 0
    s_nop 1
    v_mfma_f32_4x4x4_16b_bf16 v[88:91], v[10:11], v[86:87], v[88:91]
    s_nop 4
    v_cvt_pk_bf16_f32 v88, v88, v89
    v_cvt_pk_bf16_f32 v89, v90, v91
    ds_pk_add_bf16 v7, v88 offset:65408
    ds_pk_add_bf16 v7, v89 offset:65412
    s_mov_b64 exec, s[54:55]
    s_branch L2_d102
L2_c103:
    s_lshl_b64 s[52:53], s[82:83], 1
    s_andn2_b64 s[52:53], s[52:53], s[80:81]
    s_andn2_b64 s[52:53], s[52:53], s[50:51]
    s_or_b64 s[80:81], s[80:81], s[52:53]
    s_not_b64 vcc, s[52:53]
    s_mov_b64 exec, -1
    v_cndmask_b32_dpp v84, v84, v84, vcc wave_shr:1 row_mask:0xf bank_mask:0xf
    v_cndmask_b32_dpp v85, v85, v85, vcc wave_shr:1 row_mask:0xf bank_mask:0xf
    s_lshr_b64 s[52:53], s[52:53], 1
    v_cndmask_b32_dpp v86, v86, v86, vcc wave_shr:1 row_mask:0xf bank_mask:0xf
    v_cndmask_b32_dpp v87, v87, v87, vcc wave_shr:1 row_mask:0xf bank_mask:0xf
    s_andn2_b64 s[82:83], s[82:83], s[52:53]
    v_cndmask_b32_dpp v7, v7, v7, vcc wave_shr:1 row_mask:0xf bank_mask:0xf
    s_mov_b64 exec, s[50:51]
    s_cbranch_scc0 L2_d103
    s_mov_b64 exec, s[82:83]
    s_nop 1
    v_mfma_f32_4x4x4_16b_bf16 v[88:91], v[12:13], v[84:85], 0
    s_nop 1
    v_mfma_f32_4x4x4_16b_bf16 v[88:91], v[10:11], v[86:87], v[88:91]
    s_nop 4
    v_cvt_pk_bf16_f32 v88, v88, v89
    v_cvt_pk_bf16_f32 v89, v90, v91
    ds_pk_add_bf16 v7, v88 offset:65408
    ds_pk_add_bf16 v7, v89 offset:65412
    s_mov_b64 exec, s[50:51]
    s_branch L2_d103
L2_xo104:
    v_cmp_lt_u32 vcc, 20, v99
    s_mov_b32 s101, 1
    s_cbranch_vccz L2_xp104
    v_cmp_lt_u32 vcc, 32, v99
    v_cmp_lt_u32 s[58:59], 31, v88
    s_mov_b32 s101, 2
    s_or_b64 vcc, vcc, s[58:59]
    s_cbranch_scc0 L2_xp104
    s_mov_b32 s37, 0x10000
    s_branch L2_xp104
L2_c105:
    s_lshl_b64 s[52:53], s[82:83], 1
    s_andn2_b64 s[52:53], s[52:53], s[80:81]
    s_andn2_b64 s[52:53], s[52:53], s[54:55]
    s_or_b64 s[80:81], s[80:81], s[52:53]
    s_not_b64 vcc, s[52:53]
    s_mov_b64 exec, -1
    v_cndmask_b32_dpp v84, v84, v84, vcc wave_shr:1 row_mask:0xf bank_mask:0xf
    v_cndmask_b32_dpp v85, v85, v85, vcc wave_shr:1 row_mask:0xf bank_mask:0xf
    s_lshr_b64 s[52:53], s[52:53], 1
    v_cndmask_b32_dpp v86, v86, v86, vcc wave_shr:1 row_mask:0xf bank_mask:0xf
    v_cndmask_b32_dpp v87, v87, v87, vcc wave_shr:1 row_mask:0xf bank_mask:0xf
    s_andn2_b64 s[82:83], s[82:83], s[52:53]
    v_cndmask_b32_dpp v7, v7, v7, vcc wave_shr:1 row_mask:0xf bank_mask:0xf
    s_mov_b64 exec, s[54:55]
    s_cbranch_scc0 L2_d105
    s_mov_b64 exec, s[82:83]
    s_nop 1
    v_mfma_f32_4x4x4_16b_bf16 v[88:91], v[12:13], v[84:85], 0
    s_nop 1
    v_mfma_f32_4x4x4_16b_bf16 v[88:91], v[10:11], v[86:87], v[88:91]
    s_nop 4
    v_cvt_pk_bf16_f32 v88, v88, v89
    v_cvt_pk_bf16_f32 v89, v90, v91
    ds_pk_add_bf16 v7, v88 offset:65408
    ds_pk_add_bf16 v7, v89 offset:65412
    s_mov_b64 exec, s[54:55]
    s_branch L2_d105
L2_c106:
    s_lshl_b64 s[52:53], s[82:83], 1
    s_andn2_b64 s[52:53], s[52:53], s[80:81]
    s_andn2_b64 s[52:53], s[52:53], s[50:51]
    s_or_b64 s[80:81], s[80:81], s[52:53]
    s_not_b64 vcc, s[52:53]
    s_mov_b64 exec, -1
    v_cndmask_b32_dpp v84, v84, v84, vcc wave_shr:1 row_mask:0xf bank_mask:0xf
    v_cndmask_b32_dpp v85, v85, v85, vcc wave_shr:1 row_mask:0xf bank_mask:0xf
    s_lshr_b64 s[52:53], s[52:53], 1
    v_cndmask_b32_dpp v86, v86, v86, vcc wave_shr:1 row_mask:0xf bank_mask:0xf
    v_cndmask_b32_dpp v87, v87, v87, vcc wave_shr:1 row_mask:0xf bank_mask:0xf
    s_andn2_b64 s[82:83], s[82:83], s[52:53]
    v_cndmask_b32_dpp v7, v7, v7, vcc wave_shr:1 row_mask:0xf bank_mask:0xf
    s_mov_b64 exec, s[50:51]
    s_cbranch_scc0 L2_d106
    s_mov_b64 exec, s[82:83]
    s_nop 1
    v_mfma_f32_4x4x4_16b_bf16 v[88:91], v[12:13], v[84:85], 0
    s_nop 1
    v_mfma_f32_4x4x4_16b_bf16 v[88:91], v[10:11], v[86:87], v[88:91]
    s_nop 4
    v_cvt_pk_bf16_f32 v88, v88, v89
    v_cvt_pk_bf16_f32 v89, v90, v91
    ds_pk_add_bf16 v7, v88 offset:65408
    ds_pk_add_bf16 v7, v89 offset:65412
    s_mov_b64 exec, s[50:51]
    s_branch L2_d106
L2_c107:
    s_lshl_b64 s[52:53], s[82:83], 1
    s_andn2_b64 s[52:53], s[52:53], s[80:81]
    s_andn2_b64 s[52:53], s[52:53], s[54:55]
    s_or_b64 s[80:81], s[80:81], s[52:53]
    s_not_b64 vcc, s[52:53]
    s_mov_b64 exec, -1
    v_cndmask_b32_dpp v84, v84, v84, vcc wave_shr:1 row_mask:0xf bank_mask:0xf
    v_cndmask_b32_dpp v85, v85, v85, vcc wave_shr:1 row_mask:0xf bank_mask:0xf
    s_lshr_b64 s[52:53], s[52:53], 1
    v_cndmask_b32_dpp v86, v86, v86, vcc wave_shr:1 row_mask:0xf bank_mask:0xf
    v_cndmask_b32_dpp v87, v87, v87, vcc wave_shr:1 row_mask:0xf bank_mask:0xf
    s_andn2_b64 s[82:83], s[82:83], s[52:53]
    v_cndmask_b32_dpp v7, v7, v7, vcc wave_shr:1 row_mask:0xf bank_mask:0xf
    s_mov_b64 exec, s[54:55]
    s_cbranch_scc0 L2_d107
    s_mov_b64 exec, s[82:83]
    s_nop 1
    v_mfma_f32_4x4x4_16b_bf16 v[88:91], v[12:13], v[84:85], 0
    s_nop 1
    v_mfma_f32_4x4x4_16b_bf16 v[88:91], v[10:11], v[86:87], v[88:91]
    s_nop 4
    v_cvt_pk_bf16_f32 v88, v88, v89
    v_cvt_pk_bf16_f32 v89, v90, v91
    ds_pk_add_bf16 v7, v88 offset:65408
    ds_pk_add_bf16 v7, v89 offset:65412
    s_mov_b64 exec, s[54:55]
    s_branch L2_d107
L2_c108:
    s_lshl_b64 s[52:53], s[82:83], 1
    s_andn2_b64 s[52:53], s[52:53], s[80:81]
    s_andn2_b64 s[52:53], s[52:53], s[50:51]
    s_or_b64 s[80:81], s[80:81], s[52:53]
    s_not_b64 vcc, s[52:53]
    s_mov_b64 exec, -1
    v_cndmask_b32_dpp v84, v84, v84, vcc wave_shr:1 row_mask:0xf bank_mask:0xf
    v_cndmask_b32_dpp v85, v85, v85, vcc wave_shr:1 row_mask:0xf bank_mask:0xf
    s_lshr_b64 s[52:53], s[52:53], 1
    v_cndmask_b32_dpp v86, v86, v86, vcc wave_shr:1 row_mask:0xf bank_mask:0xf
    v_cndmask_b32_dpp v87, v87, v87, vcc wave_shr:1 row_mask:0xf bank_mask:0xf
    s_andn2_b64 s[82:83], s[82:83], s[52:53]
    v_cndmask_b32_dpp v7, v7, v7, vcc wave_shr:1 row_mask:0xf bank_mask:0xf
    s_mov_b64 exec, s[50:51]
    s_cbranch_scc0 L2_d108
    s_mov_b64 exec, s[82:83]
    s_nop 1
    v_mfma_f32_4x4x4_16b_bf16 v[88:91], v[12:13], v[84:85], 0
    s_nop 1
    v_mfma_f32_4x4x4_16b_bf16 v[88:91], v[10:11], v[86:87], v[88:91]
    s_nop 4
    v_cvt_pk_bf16_f32 v88, v88, v89
    v_cvt_pk_bf16_f32 v89, v90, v91
    ds_pk_add_bf16 v7, v88 offset:65408
    ds_pk_add_bf16 v7, v89 offset:65412
    s_mov_b64 exec, s[50:51]
    s_branch L2_d108
L2_c109:
    s_lshl_b64 s[52:53], s[82:83], 1
    s_andn2_b64 s[52:53], s[52:53], s[80:81]
    s_andn2_b64 s[52:53], s[52:53], s[54:55]
    s_or_b64 s[80:81], s[80:81], s[52:53]
    s_not_b64 vcc, s[52:53]
    s_mov_b64 exec, -1
    v_cndmask_b32_dpp v84, v84, v84, vcc wave_shr:1 row_mask:0xf bank_mask:0xf
    v_cndmask_b32_dpp v85, v85, v85, vcc wave_shr:1 row_mask:0xf bank_mask:0xf
    s_lshr_b64 s[52:53], s[52:53], 1
    v_cndmask_b32_dpp v86, v86, v86, vcc wave_shr:1 row_mask:0xf bank_mask:0xf
    v_cndmask_b32_dpp v87, v87, v87, vcc wave_shr:1 row_mask:0xf bank_mask:0xf
    s_andn2_b64 s[82:83], s[82:83], s[52:53]
    v_cndmask_b32_dpp v7, v7, v7, vcc wave_shr:1 row_mask:0xf bank_mask:0xf
    s_mov_b64 exec, s[54:55]
    s_cbranch_scc0 L2_d109
    s_mov_b64 exec, s[82:83]
    s_nop 1
    v_mfma_f32_4x4x4_16b_bf16 v[88:91], v[12:13], v[84:85], 0
    s_nop 1
    v_mfma_f32_4x4x4_16b_bf16 v[88:91], v[10:11], v[86:87], v[88:91]
    s_nop 4
    v_cvt_pk_bf16_f32 v88, v88, v89
    v_cvt_pk_bf16_f32 v89, v90, v91
    ds_pk_add_bf16 v7, v88 offset:65408
    ds_pk_add_bf16 v7, v89 offset:65412
    s_mov_b64 exec, s[54:55]
    s_branch L2_d109
L2_c110:
    s_lshl_b64 s[52:53], s[82:83], 1
    s_andn2_b64 s[52:53], s[52:53], s[80:81]
    s_andn2_b64 s[52:53], s[52:53], s[50:51]
    s_or_b64 s[80:81], s[80:81], s[52:53]
    s_not_b64 vcc, s[52:53]
    s_mov_b64 exec, -1
    v_cndmask_b32_dpp v84, v84, v84, vcc wave_shr:1 row_mask:0xf bank_mask:0xf
    v_cndmask_b32_dpp v85, v85, v85, vcc wave_shr:1 row_mask:0xf bank_mask:0xf
    s_lshr_b64 s[52:53], s[52:53], 1
    v_cndmask_b32_dpp v86, v86, v86, vcc wave_shr:1 row_mask:0xf bank_mask:0xf
    v_cndmask_b32_dpp v87, v87, v87, vcc wave_shr:1 row_mask:0xf bank_mask:0xf
    s_andn2_b64 s[82:83], s[82:83], s[52:53]
    v_cndmask_b32_dpp v7, v7, v7, vcc wave_shr:1 row_mask:0xf bank_mask:0xf
    s_mov_b64 exec, s[50:51]
    s_cbranch_scc0 L2_d110
    s_mov_b64 exec, s[82:83]
    s_nop 1
    v_mfma_f32_4x4x4_16b_bf16 v[88:91], v[12:13], v[84:85], 0
    s_nop 1
    v_mfma_f32_4x4x4_16b_bf16 v[88:91], v[10:11], v[86:87], v[88:91]
    s_nop 4
    v_cvt_pk_bf16_f32 v88, v88, v89
    v_cvt_pk_bf16_f32 v89, v90, v91
    ds_pk_add_bf16 v7, v88 offset:65408
    ds_pk_add_bf16 v7, v89 offset:65412
    s_mov_b64 exec, s[50:51]
    s_branch L2_d110
L2_c111:
    s_lshl_b64 s[52:53], s[82:83], 1
    s_andn2_b64 s[52:53], s[52:53], s[80:81]
    s_andn2_b64 s[52:53], s[52:53], s[54:55]
    s_or_b64 s[80:81], s[80:81], s[52:53]
    s_not_b64 vcc, s[52:53]
    s_mov_b64 exec, -1
    v_cndmask_b32_dpp v84, v84, v84, vcc wave_shr:1 row_mask:0xf bank_mask:0xf
    v_cndmask_b32_dpp v85, v85, v85, vcc wave_shr:1 row_mask:0xf bank_mask:0xf
    s_lshr_b64 s[52:53], s[52:53], 1
    v_cndmask_b32_dpp v86, v86, v86, vcc wave_shr:1 row_mask:0xf bank_mask:0xf
    v_cndmask_b32_dpp v87, v87, v87, vcc wave_shr:1 row_mask:0xf bank_mask:0xf
    s_andn2_b64 s[82:83], s[82:83], s[52:53]
    v_cndmask_b32_dpp v7, v7, v7, vcc wave_shr:1 row_mask:0xf bank_mask:0xf
    s_mov_b64 exec, s[54:55]
    s_cbranch_scc0 L2_d111
    s_mov_b64 exec, s[82:83]
    s_nop 1
    v_mfma_f32_4x4x4_16b_bf16 v[88:91], v[12:13], v[84:85], 0
    s_nop 1
    v_mfma_f32_4x4x4_16b_bf16 v[88:91], v[10:11], v[86:87], v[88:91]
    s_nop 4
    v_cvt_pk_bf16_f32 v88, v88, v89
    v_cvt_pk_bf16_f32 v89, v90, v91
    ds_pk_add_bf16 v7, v88 offset:65408
    ds_pk_add_bf16 v7, v89 offset:65412
    s_mov_b64 exec, s[54:55]
    s_branch L2_d111
L2_c112:
    s_lshl_b64 s[52:53], s[82:83], 1
    s_andn2_b64 s[52:53], s[52:53], s[80:81]
    s_andn2_b64 s[52:53], s[52:53], s[50:51]
    s_or_b64 s[80:81], s[80:81], s[52:53]
    s_not_b64 vcc, s[52:53]
    s_mov_b64 exec, -1
    v_cndmask_b32_dpp v84, v84, v84, vcc wave_shr:1 row_mask:0xf bank_mask:0xf
    v_cndmask_b32_dpp v85, v85, v85, vcc wave_shr:1 row_mask:0xf bank_mask:0xf
    s_lshr_b64 s[52:53], s[52:53], 1
    v_cndmask_b32_dpp v86, v86, v86, vcc wave_shr:1 row_mask:0xf bank_mask:0xf
    v_cndmask_b32_dpp v87, v87, v87, vcc wave_shr:1 row_mask:0xf bank_mask:0xf
    s_andn2_b64 s[82:83], s[82:83], s[52:53]
    v_cndmask_b32_dpp v7, v7, v7, vcc wave_shr:1 row_mask:0xf bank_mask:0xf
    s_mov_b64 exec, s[50:51]
    s_cbranch_scc0 L2_d112
    s_mov_b64 exec, s[82:83]
    s_nop 1
    v_mfma_f32_4x4x4_16b_bf16 v[88:91], v[12:13], v[84:85], 0
    s_nop 1
    v_mfma_f32_4x4x4_16b_bf16 v[88:91], v[10:11], v[86:87], v[88:91]
    s_nop 4
    v_cvt_pk_bf16_f32 v88, v88, v89
    v_cvt_pk_bf16_f32 v89, v90, v91
    ds_pk_add_bf16 v7, v88 offset:65408
    ds_pk_add_bf16 v7, v89 offset:65412
    s_mov_b64 exec, s[50:51]
    s_branch L2_d112
L2_c113:
    s_lshl_b64 s[52:53], s[82:83], 1
    s_andn2_b64 s[52:53], s[52:53], s[80:81]
    s_andn2_b64 s[52:53], s[52:53], s[54:55]
    s_or_b64 s[80:81], s[80:81], s[52:53]
    s_not_b64 vcc, s[52:53]
    s_mov_b64 exec, -1
    v_cndmask_b32_dpp v84, v84, v84, vcc wave_shr:1 row_mask:0xf bank_mask:0xf
    v_cndmask_b32_dpp v85, v85, v85, vcc wave_shr:1 row_mask:0xf bank_mask:0xf
    s_lshr_b64 s[52:53], s[52:53], 1
    v_cndmask_b32_dpp v86, v86, v86, vcc wave_shr:1 row_mask:0xf bank_mask:0xf
    v_cndmask_b32_dpp v87, v87, v87, vcc wave_shr:1 row_mask:0xf bank_mask:0xf
    s_andn2_b64 s[82:83], s[82:83], s[52:53]
    v_cndmask_b32_dpp v7, v7, v7, vcc wave_shr:1 row_mask:0xf bank_mask:0xf
    s_mov_b64 exec, s[54:55]
    s_cbranch_scc0 L2_d113
    s_mov_b64 exec, s[82:83]
    s_nop 1
    v_mfma_f32_4x4x4_16b_bf16 v[88:91], v[12:13], v[84:85], 0
    s_nop 1
    v_mfma_f32_4x4x4_16b_bf16 v[88:91], v[10:11], v[86:87], v[88:91]
    s_nop 4
    v_cvt_pk_bf16_f32 v88, v88, v89
    v_cvt_pk_bf16_f32 v89, v90, v91
    ds_pk_add_bf16 v7, v88 offset:65408
    ds_pk_add_bf16 v7, v89 offset:65412
    s_mov_b64 exec, s[54:55]
    s_branch L2_d113
L2_c114:
    s_lshl_b64 s[52:53], s[82:83], 1
    s_andn2_b64 s[52:53], s[52:53], s[80:81]
    s_andn2_b64 s[52:53], s[52:53], s[50:51]
    s_or_b64 s[80:81], s[80:81], s[52:53]
    s_not_b64 vcc, s[52:53]
    s_mov_b64 exec, -1
    v_cndmask_b32_dpp v84, v84, v84, vcc wave_shr:1 row_mask:0xf bank_mask:0xf
    v_cndmask_b32_dpp v85, v85, v85, vcc wave_shr:1 row_mask:0xf bank_mask:0xf
    s_lshr_b64 s[52:53], s[52:53], 1
    v_cndmask_b32_dpp v86, v86, v86, vcc wave_shr:1 row_mask:0xf bank_mask:0xf
    v_cndmask_b32_dpp v87, v87, v87, vcc wave_shr:1 row_mask:0xf bank_mask:0xf
    s_andn2_b64 s[82:83], s[82:83], s[52:53]
    v_cndmask_b32_dpp v7, v7, v7, vcc wave_shr:1 row_mask:0xf bank_mask:0xf
    s_mov_b64 exec, s[50:51]
    s_cbranch_scc0 L2_d114
    s_mov_b64 exec, s[82:83]
    s_nop 1
    v_mfma_f32_4x4x4_16b_bf16 v[88:91], v[12:13], v[84:85], 0
    s_nop 1
    v_mfma_f32_4x4x4_16b_bf16 v[88:91], v[10:11], v[86:87], v[88:91]
    s_nop 4
    v_cvt_pk_bf16_f32 v88, v88, v89
    v_cvt_pk_bf16_f32 v89, v90, v91
    ds_pk_add_bf16 v7, v88 offset:65408
    ds_pk_add_bf16 v7, v89 offset:65412
    s_mov_b64 exec, s[50:51]
    s_branch L2_d114
L2_xa115:
    s_cmp_eq_u32 s101, 1
    s_cbranch_scc1 L2_xc115
    v_lshlrev_b32 v89, 0, v96
    v_add_u32 v90, 140, v97
    v_bitop3_b32 v90, v89, v45, v90 bitop3:0x6a
    ds_write_b32 v98, v90 offset:28
    v_lshlrev_b32 v89, 4, v96
    v_add_u32 v90, 120, v97
    v_bitop3_b32 v90, v89, v45, v90 bitop3:0x6a
    ds_write_b32 v98, v90 offset:24
    v_lshlrev_b32 v89, 8, v96
    v_add_u32 v90, 100, v97
    v_bitop3_b32 v90, v89, v45, v90 bitop3:0x6a
    ds_write_b32 v98, v90 offset:20
L2_xc115:
    v_lshlrev_b32 v89, 12, v96
    v_add_u32 v90, 80, v97
    v_bitop3_b32 v90, v89, v45, v90 bitop3:0x6a
    ds_write_b32 v98, v90 offset:16
    s_branch L2_xb115
L2_xe115:
    v_cmp_lt_u32 vcc, 32, v99
    v_cmp_lt_u32 s[58:59], 31, v88
    v_lshrrev_b32 v89, 16, v96
    v_add_u32 v97, 80, v97
    s_or_b64 vcc, vcc, s[58:59]
    s_cbranch_scc1 L2_xs115
    v_lshlrev_b32 v89, v1, v89
    v_and_b32 v89, v45, v89
    v_cmp_ne_u32 vcc, 0, v89
    v_xor_b32 v90, v97, v89
    s_add_u32 s3, s37, s38
    v_mbcnt_lo_u32_b32 v98, vcc_lo, 0
    v_mbcnt_hi_u32_b32 v98, vcc_hi, v98
    s_bcnt1_i32_b64 s41, vcc
    v_lshl_add_u32 v98, v98, 2, s3
    s_mov_b64 exec, vcc
    ds_write_b32 v98, v90
    s_mov_b64 exec, -1
    s_lshl2_add_u32 s37, s41, s37
    s_branch L2_xr115
L2_xf115:
    s_waitcnt lgkmcnt(0)
    s_cmp_gt_u32 s37, 1024
    s_cbranch_scc1 L2_xs115
    v_mov_b32 v43, -1
    s_cmp_ge_u32 s37, 512
    s_cbranch_scc1 L2_xg115
    v_mov_b32 v42, -1
    s_cmp_ge_u32 s37, 256
    s_cbranch_scc1 L2_xg115
    v_mov_b32 v41, -1
    s_branch L2_xg115
L2_xs115:
    s_waitcnt lgkmcnt(0)
    v_mov_b32 v40, -1
    v_mov_b32 v41, -1
    v_mov_b32 v42, -1
    v_mov_b32 v43, -1
    s_add_u32 s3, s42, 2
    s_bitset1_b32 s36, s3
    s_branch L2_xg115
L2_c116:
    s_lshl_b64 s[52:53], s[82:83], 1
    s_andn2_b64 s[52:53], s[52:53], s[80:81]
    s_andn2_b64 s[52:53], s[52:53], s[54:55]
    s_or_b64 s[80:81], s[80:81], s[52:53]
    s_not_b64 vcc, s[52:53]
    s_mov_b64 exec, -1
    v_cndmask_b32_dpp v84, v84, v84, vcc wave_shr:1 row_mask:0xf bank_mask:0xf
    v_cndmask_b32_dpp v85, v85, v85, vcc wave_shr:1 row_mask:0xf bank_mask:0xf
    s_lshr_b64 s[52:53], s[52:53], 1
    v_cndmask_b32_dpp v86, v86, v86, vcc wave_shr:1 row_mask:0xf bank_mask:0xf
    v_cndmask_b32_dpp v87, v87, v87, vcc wave_shr:1 row_mask:0xf bank_mask:0xf
    s_andn2_b64 s[82:83], s[82:83], s[52:53]
    v_cndmask_b32_dpp v7, v7, v7, vcc wave_shr:1 row_mask:0xf bank_mask:0xf
    s_mov_b64 exec, s[54:55]
    s_cbranch_scc0 L2_d116
    s_mov_b64 exec, s[82:83]
    s_nop 1
    v_mfma_f32_4x4x4_16b_bf16 v[88:91], v[12:13], v[84:85], 0
    s_nop 1
    v_mfma_f32_4x4x4_16b_bf16 v[88:91], v[10:11], v[86:87], v[88:91]
    s_nop 4
    v_cvt_pk_bf16_f32 v88, v88, v89
    v_cvt_pk_bf16_f32 v89, v90, v91
    ds_pk_add_bf16 v7, v88 offset:65408
    ds_pk_add_bf16 v7, v89 offset:65412
    s_mov_b64 exec, s[54:55]
    s_branch L2_d116
L2_c117:
    s_lshl_b64 s[52:53], s[82:83], 1
    s_andn2_b64 s[52:53], s[52:53], s[80:81]
    s_andn2_b64 s[52:53], s[52:53], s[50:51]
    s_or_b64 s[80:81], s[80:81], s[52:53]
    s_not_b64 vcc, s[52:53]
    s_mov_b64 exec, -1
    v_cndmask_b32_dpp v84, v84, v84, vcc wave_shr:1 row_mask:0xf bank_mask:0xf
    v_cndmask_b32_dpp v85, v85, v85, vcc wave_shr:1 row_mask:0xf bank_mask:0xf
    s_lshr_b64 s[52:53], s[52:53], 1
    v_cndmask_b32_dpp v86, v86, v86, vcc wave_shr:1 row_mask:0xf bank_mask:0xf
    v_cndmask_b32_dpp v87, v87, v87, vcc wave_shr:1 row_mask:0xf bank_mask:0xf
    s_andn2_b64 s[82:83], s[82:83], s[52:53]
    v_cndmask_b32_dpp v7, v7, v7, vcc wave_shr:1 row_mask:0xf bank_mask:0xf
    s_mov_b64 exec, s[50:51]
    s_cbranch_scc0 L2_d117
    s_mov_b64 exec, s[82:83]
    s_nop 1
    v_mfma_f32_4x4x4_16b_bf16 v[88:91], v[12:13], v[84:85], 0
    s_nop 1
    v_mfma_f32_4x4x4_16b_bf16 v[88:91], v[10:11], v[86:87], v[88:91]
    s_nop 4
    v_cvt_pk_bf16_f32 v88, v88, v89
    v_cvt_pk_bf16_f32 v89, v90, v91
    ds_pk_add_bf16 v7, v88 offset:65408
    ds_pk_add_bf16 v7, v89 offset:65412
    s_mov_b64 exec, s[50:51]
    s_branch L2_d117
L2_c118:
    s_lshl_b64 s[52:53], s[82:83], 1
    s_andn2_b64 s[52:53], s[52:53], s[80:81]
    s_andn2_b64 s[52:53], s[52:53], s[54:55]
    s_or_b64 s[80:81], s[80:81], s[52:53]
    s_not_b64 vcc, s[52:53]
    s_mov_b64 exec, -1
    v_cndmask_b32_dpp v84, v84, v84, vcc wave_shr:1 row_mask:0xf bank_mask:0xf
    v_cndmask_b32_dpp v85, v85, v85, vcc wave_shr:1 row_mask:0xf bank_mask:0xf
    s_lshr_b64 s[52:53], s[52:53], 1
    v_cndmask_b32_dpp v86, v86, v86, vcc wave_shr:1 row_mask:0xf bank_mask:0xf
    v_cndmask_b32_dpp v87, v87, v87, vcc wave_shr:1 row_mask:0xf bank_mask:0xf
    s_andn2_b64 s[82:83], s[82:83], s[52:53]
    v_cndmask_b32_dpp v7, v7, v7, vcc wave_shr:1 row_mask:0xf bank_mask:0xf
    s_mov_b64 exec, s[54:55]
    s_cbranch_scc0 L2_d118
    s_mov_b64 exec, s[82:83]
    s_nop 1
    v_mfma_f32_4x4x4_16b_bf16 v[88:91], v[12:13], v[84:85], 0
    s_nop 1
    v_mfma_f32_4x4x4_16b_bf16 v[88:91], v[10:11], v[86:87], v[88:91]
    s_nop 4
    v_cvt_pk_bf16_f32 v88, v88, v89
    v_cvt_pk_bf16_f32 v89, v90, v91
    ds_pk_add_bf16 v7, v88 offset:65408
    ds_pk_add_bf16 v7, v89 offset:65412
    s_mov_b64 exec, s[54:55]
    s_branch L2_d118
L2_c119:
    s_lshl_b64 s[52:53], s[82:83], 1
    s_andn2_b64 s[52:53], s[52:53], s[80:81]
    s_andn2_b64 s[52:53], s[52:53], s[50:51]
    s_or_b64 s[80:81], s[80:81], s[52:53]
    s_not_b64 vcc, s[52:53]
    s_mov_b64 exec, -1
    v_cndmask_b32_dpp v84, v84, v84, vcc wave_shr:1 row_mask:0xf bank_mask:0xf
    v_cndmask_b32_dpp v85, v85, v85, vcc wave_shr:1 row_mask:0xf bank_mask:0xf
    s_lshr_b64 s[52:53], s[52:53], 1
    v_cndmask_b32_dpp v86, v86, v86, vcc wave_shr:1 row_mask:0xf bank_mask:0xf
    v_cndmask_b32_dpp v87, v87, v87, vcc wave_shr:1 row_mask:0xf bank_mask:0xf
    s_andn2_b64 s[82:83], s[82:83], s[52:53]
    v_cndmask_b32_dpp v7, v7, v7, vcc wave_shr:1 row_mask:0xf bank_mask:0xf
    s_mov_b64 exec, s[50:51]
    s_cbranch_scc0 L2_d119
    s_mov_b64 exec, s[82:83]
    s_nop 1
    v_mfma_f32_4x4x4_16b_bf16 v[88:91], v[12:13], v[84:85], 0
    s_nop 1
    v_mfma_f32_4x4x4_16b_bf16 v[88:91], v[10:11], v[86:87], v[88:91]
    s_nop 4
    v_cvt_pk_bf16_f32 v88, v88, v89
    v_cvt_pk_bf16_f32 v89, v90, v91
    ds_pk_add_bf16 v7, v88 offset:65408
    ds_pk_add_bf16 v7, v89 offset:65412
    s_mov_b64 exec, s[50:51]
    s_branch L2_d119
L2_c120:
    s_lshl_b64 s[52:53], s[82:83], 1
    s_andn2_b64 s[52:53], s[52:53], s[80:81]
    s_andn2_b64 s[52:53], s[52:53], s[54:55]
    s_or_b64 s[80:81], s[80:81], s[52:53]
    s_not_b64 vcc, s[52:53]
    s_mov_b64 exec, -1
    v_cndmask_b32_dpp v84, v84, v84, vcc wave_shr:1 row_mask:0xf bank_mask:0xf
    v_cndmask_b32_dpp v85, v85, v85, vcc wave_shr:1 row_mask:0xf bank_mask:0xf
    s_lshr_b64 s[52:53], s[52:53], 1
    v_cndmask_b32_dpp v86, v86, v86, vcc wave_shr:1 row_mask:0xf bank_mask:0xf
    v_cndmask_b32_dpp v87, v87, v87, vcc wave_shr:1 row_mask:0xf bank_mask:0xf
    s_andn2_b64 s[82:83], s[82:83], s[52:53]
    v_cndmask_b32_dpp v7, v7, v7, vcc wave_shr:1 row_mask:0xf bank_mask:0xf
    s_mov_b64 exec, s[54:55]
    s_cbranch_scc0 L2_d120
    s_mov_b64 exec, s[82:83]
    s_nop 1
    v_mfma_f32_4x4x4_16b_bf16 v[88:91], v[12:13], v[84:85], 0
    s_nop 1
    v_mfma_f32_4x4x4_16b_bf16 v[88:91], v[10:11], v[86:87], v[88:91]
    s_nop 4
    v_cvt_pk_bf16_f32 v88, v88, v89
    v_cvt_pk_bf16_f32 v89, v90, v91
    ds_pk_add_bf16 v7, v88 offset:65408
    ds_pk_add_bf16 v7, v89 offset:65412
    s_mov_b64 exec, s[54:55]
    s_branch L2_d120
L2_c121:
    s_lshl_b64 s[52:53], s[82:83], 1
    s_andn2_b64 s[52:53], s[52:53], s[80:81]
    s_andn2_b64 s[52:53], s[52:53], s[50:51]
    s_or_b64 s[80:81], s[80:81], s[52:53]
    s_not_b64 vcc, s[52:53]
    s_mov_b64 exec, -1
    v_cndmask_b32_dpp v84, v84, v84, vcc wave_shr:1 row_mask:0xf bank_mask:0xf
    v_cndmask_b32_dpp v85, v85, v85, vcc wave_shr:1 row_mask:0xf bank_mask:0xf
    s_lshr_b64 s[52:53], s[52:53], 1
    v_cndmask_b32_dpp v86, v86, v86, vcc wave_shr:1 row_mask:0xf bank_mask:0xf
    v_cndmask_b32_dpp v87, v87, v87, vcc wave_shr:1 row_mask:0xf bank_mask:0xf
    s_andn2_b64 s[82:83], s[82:83], s[52:53]
    v_cndmask_b32_dpp v7, v7, v7, vcc wave_shr:1 row_mask:0xf bank_mask:0xf
    s_mov_b64 exec, s[50:51]
    s_cbranch_scc0 L2_d121
    s_mov_b64 exec, s[82:83]
    s_nop 1
    v_mfma_f32_4x4x4_16b_bf16 v[88:91], v[12:13], v[84:85], 0
    s_nop 1
    v_mfma_f32_4x4x4_16b_bf16 v[88:91], v[10:11], v[86:87], v[88:91]
    s_nop 4
    v_cvt_pk_bf16_f32 v88, v88, v89
    v_cvt_pk_bf16_f32 v89, v90, v91
    ds_pk_add_bf16 v7, v88 offset:65408
    ds_pk_add_bf16 v7, v89 offset:65412
    s_mov_b64 exec, s[50:51]
    s_branch L2_d121
L2_c122:
    s_lshl_b64 s[52:53], s[82:83], 1
    s_andn2_b64 s[52:53], s[52:53], s[80:81]
    s_andn2_b64 s[52:53], s[52:53], s[54:55]
    s_or_b64 s[80:81], s[80:81], s[52:53]
    s_not_b64 vcc, s[52:53]
    s_mov_b64 exec, -1
    v_cndmask_b32_dpp v84, v84, v84, vcc wave_shr:1 row_mask:0xf bank_mask:0xf
    v_cndmask_b32_dpp v85, v85, v85, vcc wave_shr:1 row_mask:0xf bank_mask:0xf
    s_lshr_b64 s[52:53], s[52:53], 1
    v_cndmask_b32_dpp v86, v86, v86, vcc wave_shr:1 row_mask:0xf bank_mask:0xf
    v_cndmask_b32_dpp v87, v87, v87, vcc wave_shr:1 row_mask:0xf bank_mask:0xf
    s_andn2_b64 s[82:83], s[82:83], s[52:53]
    v_cndmask_b32_dpp v7, v7, v7, vcc wave_shr:1 row_mask:0xf bank_mask:0xf
    s_mov_b64 exec, s[54:55]
    s_cbranch_scc0 L2_d122
    s_mov_b64 exec, s[82:83]
    s_nop 1
    v_mfma_f32_4x4x4_16b_bf16 v[88:91], v[12:13], v[84:85], 0
    s_nop 1
    v_mfma_f32_4x4x4_16b_bf16 v[88:91], v[10:11], v[86:87], v[88:91]
    s_nop 4
    v_cvt_pk_bf16_f32 v88, v88, v89
    v_cvt_pk_bf16_f32 v89, v90, v91
    ds_pk_add_bf16 v7, v88 offset:65408
    ds_pk_add_bf16 v7, v89 offset:65412
    s_mov_b64 exec, s[54:55]
    s_branch L2_d122
L2_c123:
    s_lshl_b64 s[52:53], s[82:83], 1
    s_andn2_b64 s[52:53], s[52:53], s[80:81]
    s_andn2_b64 s[52:53], s[52:53], s[50:51]
    s_or_b64 s[80:81], s[80:81], s[52:53]
    s_not_b64 vcc, s[52:53]
    s_mov_b64 exec, -1
    v_cndmask_b32_dpp v84, v84, v84, vcc wave_shr:1 row_mask:0xf bank_mask:0xf
    v_cndmask_b32_dpp v85, v85, v85, vcc wave_shr:1 row_mask:0xf bank_mask:0xf
    s_lshr_b64 s[52:53], s[52:53], 1
    v_cndmask_b32_dpp v86, v86, v86, vcc wave_shr:1 row_mask:0xf bank_mask:0xf
    v_cndmask_b32_dpp v87, v87, v87, vcc wave_shr:1 row_mask:0xf bank_mask:0xf
    s_andn2_b64 s[82:83], s[82:83], s[52:53]
    v_cndmask_b32_dpp v7, v7, v7, vcc wave_shr:1 row_mask:0xf bank_mask:0xf
    s_mov_b64 exec, s[50:51]
    s_cbranch_scc0 L2_d123
    s_mov_b64 exec, s[82:83]
    s_nop 1
    v_mfma_f32_4x4x4_16b_bf16 v[88:91], v[12:13], v[84:85], 0
    s_nop 1
    v_mfma_f32_4x4x4_16b_bf16 v[88:91], v[10:11], v[86:87], v[88:91]
    s_nop 4
    v_cvt_pk_bf16_f32 v88, v88, v89
    v_cvt_pk_bf16_f32 v89, v90, v91
    ds_pk_add_bf16 v7, v88 offset:65408
    ds_pk_add_bf16 v7, v89 offset:65412
    s_mov_b64 exec, s[50:51]
    s_branch L2_d123
L2_c124:
    s_lshl_b64 s[52:53], s[82:83], 1
    s_andn2_b64 s[52:53], s[52:53], s[80:81]
    s_andn2_b64 s[52:53], s[52:53], s[54:55]
    s_or_b64 s[80:81], s[80:81], s[52:53]
    s_not_b64 vcc, s[52:53]
    s_mov_b64 exec, -1
    v_cndmask_b32_dpp v84, v84, v84, vcc wave_shr:1 row_mask:0xf bank_mask:0xf
    v_cndmask_b32_dpp v85, v85, v85, vcc wave_shr:1 row_mask:0xf bank_mask:0xf
    s_lshr_b64 s[52:53], s[52:53], 1
    v_cndmask_b32_dpp v86, v86, v86, vcc wave_shr:1 row_mask:0xf bank_mask:0xf
    v_cndmask_b32_dpp v87, v87, v87, vcc wave_shr:1 row_mask:0xf bank_mask:0xf
    s_andn2_b64 s[82:83], s[82:83], s[52:53]
    v_cndmask_b32_dpp v7, v7, v7, vcc wave_shr:1 row_mask:0xf bank_mask:0xf
    s_mov_b64 exec, s[54:55]
    s_cbranch_scc0 L2_d124
    s_mov_b64 exec, s[82:83]
    s_nop 1
    v_mfma_f32_4x4x4_16b_bf16 v[88:91], v[12:13], v[84:85], 0
    s_nop 1
    v_mfma_f32_4x4x4_16b_bf16 v[88:91], v[10:11], v[86:87], v[88:91]
    s_nop 4
    v_cvt_pk_bf16_f32 v88, v88, v89
    v_cvt_pk_bf16_f32 v89, v90, v91
    ds_pk_add_bf16 v7, v88 offset:65408
    ds_pk_add_bf16 v7, v89 offset:65412
    s_mov_b64 exec, s[54:55]
    s_branch L2_d124
L2_c125:
    s_lshl_b64 s[52:53], s[82:83], 1
    s_andn2_b64 s[52:53], s[52:53], s[80:81]
    s_andn2_b64 s[52:53], s[52:53], s[50:51]
    s_or_b64 s[80:81], s[80:81], s[52:53]
    s_not_b64 vcc, s[52:53]
    s_mov_b64 exec, -1
    v_cndmask_b32_dpp v84, v84, v84, vcc wave_shr:1 row_mask:0xf bank_mask:0xf
    v_cndmask_b32_dpp v85, v85, v85, vcc wave_shr:1 row_mask:0xf bank_mask:0xf
    s_lshr_b64 s[52:53], s[52:53], 1
    v_cndmask_b32_dpp v86, v86, v86, vcc wave_shr:1 row_mask:0xf bank_mask:0xf
    v_cndmask_b32_dpp v87, v87, v87, vcc wave_shr:1 row_mask:0xf bank_mask:0xf
    s_andn2_b64 s[82:83], s[82:83], s[52:53]
    v_cndmask_b32_dpp v7, v7, v7, vcc wave_shr:1 row_mask:0xf bank_mask:0xf
    s_mov_b64 exec, s[50:51]
    s_cbranch_scc0 L2_d125
    s_mov_b64 exec, s[82:83]
    s_nop 1
    v_mfma_f32_4x4x4_16b_bf16 v[88:91], v[12:13], v[84:85], 0
    s_nop 1
    v_mfma_f32_4x4x4_16b_bf16 v[88:91], v[10:11], v[86:87], v[88:91]
    s_nop 4
    v_cvt_pk_bf16_f32 v88, v88, v89
    v_cvt_pk_bf16_f32 v89, v90, v91
    ds_pk_add_bf16 v7, v88 offset:65408
    ds_pk_add_bf16 v7, v89 offset:65412
    s_mov_b64 exec, s[50:51]
    s_branch L2_d125
L2_c126:
    s_lshl_b64 s[52:53], s[82:83], 1
    s_andn2_b64 s[52:53], s[52:53], s[80:81]
    s_andn2_b64 s[52:53], s[52:53], s[54:55]
    s_or_b64 s[80:81], s[80:81], s[52:53]
    s_not_b64 vcc, s[52:53]
    s_mov_b64 exec, -1
    v_cndmask_b32_dpp v84, v84, v84, vcc wave_shr:1 row_mask:0xf bank_mask:0xf
    v_cndmask_b32_dpp v85, v85, v85, vcc wave_shr:1 row_mask:0xf bank_mask:0xf
    s_lshr_b64 s[52:53], s[52:53], 1
    v_cndmask_b32_dpp v86, v86, v86, vcc wave_shr:1 row_mask:0xf bank_mask:0xf
    v_cndmask_b32_dpp v87, v87, v87, vcc wave_shr:1 row_mask:0xf bank_mask:0xf
    s_andn2_b64 s[82:83], s[82:83], s[52:53]
    v_cndmask_b32_dpp v7, v7, v7, vcc wave_shr:1 row_mask:0xf bank_mask:0xf
    s_mov_b64 exec, s[54:55]
    s_cbranch_scc0 L2_d126
    s_mov_b64 exec, s[82:83]
    s_nop 1
    v_mfma_f32_4x4x4_16b_bf16 v[88:91], v[12:13], v[84:85], 0
    s_nop 1
    v_mfma_f32_4x4x4_16b_bf16 v[88:91], v[10:11], v[86:87], v[88:91]
    s_nop 4
    v_cvt_pk_bf16_f32 v88, v88, v89
    v_cvt_pk_bf16_f32 v89, v90, v91
    ds_pk_add_bf16 v7, v88 offset:65408
    ds_pk_add_bf16 v7, v89 offset:65412
    s_mov_b64 exec, s[54:55]
    s_branch L2_d126
L2_c127:
    s_lshl_b64 s[52:53], s[82:83], 1
    s_andn2_b64 s[52:53], s[52:53], s[80:81]
    s_andn2_b64 s[52:53], s[52:53], s[50:51]
    s_or_b64 s[80:81], s[80:81], s[52:53]
    s_not_b64 vcc, s[52:53]
    s_mov_b64 exec, -1
    v_cndmask_b32_dpp v84, v84, v84, vcc wave_shr:1 row_mask:0xf bank_mask:0xf
    v_cndmask_b32_dpp v85, v85, v85, vcc wave_shr:1 row_mask:0xf bank_mask:0xf
    s_lshr_b64 s[52:53], s[52:53], 1
    v_cndmask_b32_dpp v86, v86, v86, vcc wave_shr:1 row_mask:0xf bank_mask:0xf
    v_cndmask_b32_dpp v87, v87, v87, vcc wave_shr:1 row_mask:0xf bank_mask:0xf
    s_andn2_b64 s[82:83], s[82:83], s[52:53]
    v_cndmask_b32_dpp v7, v7, v7, vcc wave_shr:1 row_mask:0xf bank_mask:0xf
    s_mov_b64 exec, s[50:51]
    s_cbranch_scc0 L2_d127
    s_mov_b64 exec, s[82:83]
    s_nop 1
    v_mfma_f32_4x4x4_16b_bf16 v[88:91], v[12:13], v[84:85], 0
    s_nop 1
    v_mfma_f32_4x4x4_16b_bf16 v[88:91], v[10:11], v[86:87], v[88:91]
    s_nop 4
    v_cvt_pk_bf16_f32 v88, v88, v89
    v_cvt_pk_bf16_f32 v89, v90, v91
    ds_pk_add_bf16 v7, v88 offset:65408
    ds_pk_add_bf16 v7, v89 offset:65412
    s_mov_b64 exec, s[50:51]
    s_branch L2_d127
L2_c128:
    s_lshl_b64 s[52:53], s[82:83], 1
    s_andn2_b64 s[52:53], s[52:53], s[80:81]
    s_andn2_b64 s[52:53], s[52:53], s[54:55]
    s_or_b64 s[80:81], s[80:81], s[52:53]
    s_not_b64 vcc, s[52:53]
    s_mov_b64 exec, -1
    v_cndmask_b32_dpp v84, v84, v84, vcc wave_shr:1 row_mask:0xf bank_mask:0xf
    v_cndmask_b32_dpp v85, v85, v85, vcc wave_shr:1 row_mask:0xf bank_mask:0xf
    s_lshr_b64 s[52:53], s[52:53], 1
    v_cndmask_b32_dpp v86, v86, v86, vcc wave_shr:1 row_mask:0xf bank_mask:0xf
    v_cndmask_b32_dpp v87, v87, v87, vcc wave_shr:1 row_mask:0xf bank_mask:0xf
    s_andn2_b64 s[82:83], s[82:83], s[52:53]
    v_cndmask_b32_dpp v7, v7, v7, vcc wave_shr:1 row_mask:0xf bank_mask:0xf
    s_mov_b64 exec, s[54:55]
    s_cbranch_scc0 L2_d128
    s_mov_b64 exec, s[82:83]
    s_nop 1
    v_mfma_f32_4x4x4_16b_bf16 v[88:91], v[12:13], v[84:85], 0
    s_nop 1
    v_mfma_f32_4x4x4_16b_bf16 v[88:91], v[10:11], v[86:87], v[88:91]
    s_nop 4
    v_cvt_pk_bf16_f32 v88, v88, v89
    v_cvt_pk_bf16_f32 v89, v90, v91
    ds_pk_add_bf16 v7, v88 offset:65408
    ds_pk_add_bf16 v7, v89 offset:65412
    s_mov_b64 exec, s[54:55]
    s_branch L2_d128
L2_c129:
    s_lshl_b64 s[52:53], s[82:83], 1
    s_andn2_b64 s[52:53], s[52:53], s[80:81]
    s_andn2_b64 s[52:53], s[52:53], s[50:51]
    s_or_b64 s[80:81], s[80:81], s[52:53]
    s_not_b64 vcc, s[52:53]
    s_mov_b64 exec, -1
    v_cndmask_b32_dpp v84, v84, v84, vcc wave_shr:1 row_mask:0xf bank_mask:0xf
    v_cndmask_b32_dpp v85, v85, v85, vcc wave_shr:1 row_mask:0xf bank_mask:0xf
    s_lshr_b64 s[52:53], s[52:53], 1
    v_cndmask_b32_dpp v86, v86, v86, vcc wave_shr:1 row_mask:0xf bank_mask:0xf
    v_cndmask_b32_dpp v87, v87, v87, vcc wave_shr:1 row_mask:0xf bank_mask:0xf
    s_andn2_b64 s[82:83], s[82:83], s[52:53]
    v_cndmask_b32_dpp v7, v7, v7, vcc wave_shr:1 row_mask:0xf bank_mask:0xf
    s_mov_b64 exec, s[50:51]
    s_cbranch_scc0 L2_d129
    s_mov_b64 exec, s[82:83]
    s_nop 1
    v_mfma_f32_4x4x4_16b_bf16 v[88:91], v[12:13], v[84:85], 0
    s_nop 1
    v_mfma_f32_4x4x4_16b_bf16 v[88:91], v[10:11], v[86:87], v[88:91]
    s_nop 4
    v_cvt_pk_bf16_f32 v88, v88, v89
    v_cvt_pk_bf16_f32 v89, v90, v91
    ds_pk_add_bf16 v7, v88 offset:65408
    ds_pk_add_bf16 v7, v89 offset:65412
    s_mov_b64 exec, s[50:51]
    s_branch L2_d129
L2_c130:
    s_lshl_b64 s[52:53], s[82:83], 1
    s_andn2_b64 s[52:53], s[52:53], s[80:81]
    s_andn2_b64 s[52:53], s[52:53], s[54:55]
    s_or_b64 s[80:81], s[80:81], s[52:53]
    s_not_b64 vcc, s[52:53]
    s_mov_b64 exec, -1
    v_cndmask_b32_dpp v84, v84, v84, vcc wave_shr:1 row_mask:0xf bank_mask:0xf
    v_cndmask_b32_dpp v85, v85, v85, vcc wave_shr:1 row_mask:0xf bank_mask:0xf
    s_lshr_b64 s[52:53], s[52:53], 1
    v_cndmask_b32_dpp v86, v86, v86, vcc wave_shr:1 row_mask:0xf bank_mask:0xf
    v_cndmask_b32_dpp v87, v87, v87, vcc wave_shr:1 row_mask:0xf bank_mask:0xf
    s_andn2_b64 s[82:83], s[82:83], s[52:53]
    v_cndmask_b32_dpp v7, v7, v7, vcc wave_shr:1 row_mask:0xf bank_mask:0xf
    s_mov_b64 exec, s[54:55]
    s_cbranch_scc0 L2_d130
    s_mov_b64 exec, s[82:83]
    s_nop 1
    v_mfma_f32_4x4x4_16b_bf16 v[88:91], v[12:13], v[84:85], 0
    s_nop 1
    v_mfma_f32_4x4x4_16b_bf16 v[88:91], v[10:11], v[86:87], v[88:91]
    s_nop 4
    v_cvt_pk_bf16_f32 v88, v88, v89
    v_cvt_pk_bf16_f32 v89, v90, v91
    ds_pk_add_bf16 v7, v88 offset:65408
    ds_pk_add_bf16 v7, v89 offset:65412
    s_mov_b64 exec, s[54:55]
    s_branch L2_d130
L2_c131:
    s_lshl_b64 s[52:53], s[82:83], 1
    s_andn2_b64 s[52:53], s[52:53], s[80:81]
    s_andn2_b64 s[52:53], s[52:53], s[50:51]
    s_or_b64 s[80:81], s[80:81], s[52:53]
    s_not_b64 vcc, s[52:53]
    s_mov_b64 exec, -1
    v_cndmask_b32_dpp v84, v84, v84, vcc wave_shr:1 row_mask:0xf bank_mask:0xf
    v_cndmask_b32_dpp v85, v85, v85, vcc wave_shr:1 row_mask:0xf bank_mask:0xf
    s_lshr_b64 s[52:53], s[52:53], 1
    v_cndmask_b32_dpp v86, v86, v86, vcc wave_shr:1 row_mask:0xf bank_mask:0xf
    v_cndmask_b32_dpp v87, v87, v87, vcc wave_shr:1 row_mask:0xf bank_mask:0xf
    s_andn2_b64 s[82:83], s[82:83], s[52:53]
    v_cndmask_b32_dpp v7, v7, v7, vcc wave_shr:1 row_mask:0xf bank_mask:0xf
    s_mov_b64 exec, s[50:51]
    s_cbranch_scc0 L2_d131
    s_mov_b64 exec, s[82:83]
    s_nop 1
    v_mfma_f32_4x4x4_16b_bf16 v[88:91], v[12:13], v[84:85], 0
    s_nop 1
    v_mfma_f32_4x4x4_16b_bf16 v[88:91], v[10:11], v[86:87], v[88:91]
    s_nop 4
    v_cvt_pk_bf16_f32 v88, v88, v89
    v_cvt_pk_bf16_f32 v89, v90, v91
    ds_pk_add_bf16 v7, v88 offset:65408
    ds_pk_add_bf16 v7, v89 offset:65412
    s_mov_b64 exec, s[50:51]
    s_branch L2_d131
L2_c132:
    s_lshl_b64 s[52:53], s[82:83], 1
    s_andn2_b64 s[52:53], s[52:53], s[80:81]
    s_andn2_b64 s[52:53], s[52:53], s[54:55]
    s_or_b64 s[80:81], s[80:81], s[52:53]
    s_not_b64 vcc, s[52:53]
    s_mov_b64 exec, -1
    v_cndmask_b32_dpp v84, v84, v84, vcc wave_shr:1 row_mask:0xf bank_mask:0xf
    v_cndmask_b32_dpp v85, v85, v85, vcc wave_shr:1 row_mask:0xf bank_mask:0xf
    s_lshr_b64 s[52:53], s[52:53], 1
    v_cndmask_b32_dpp v86, v86, v86, vcc wave_shr:1 row_mask:0xf bank_mask:0xf
    v_cndmask_b32_dpp v87, v87, v87, vcc wave_shr:1 row_mask:0xf bank_mask:0xf
    s_andn2_b64 s[82:83], s[82:83], s[52:53]
    v_cndmask_b32_dpp v7, v7, v7, vcc wave_shr:1 row_mask:0xf bank_mask:0xf
    s_mov_b64 exec, s[54:55]
    s_cbranch_scc0 L2_d132
    s_mov_b64 exec, s[82:83]
    s_nop 1
    v_mfma_f32_4x4x4_16b_bf16 v[88:91], v[12:13], v[84:85], 0
    s_nop 1
    v_mfma_f32_4x4x4_16b_bf16 v[88:91], v[10:11], v[86:87], v[88:91]
    s_nop 4
    v_cvt_pk_bf16_f32 v88, v88, v89
    v_cvt_pk_bf16_f32 v89, v90, v91
    ds_pk_add_bf16 v7, v88 offset:65408
    ds_pk_add_bf16 v7, v89 offset:65412
    s_mov_b64 exec, s[54:55]
    s_branch L2_d132
L2_c133:
    s_lshl_b64 s[52:53], s[82:83], 1
    s_andn2_b64 s[52:53], s[52:53], s[80:81]
    s_andn2_b64 s[52:53], s[52:53], s[50:51]
    s_or_b64 s[80:81], s[80:81], s[52:53]
    s_not_b64 vcc, s[52:53]
    s_mov_b64 exec, -1
    v_cndmask_b32_dpp v84, v84, v84, vcc wave_shr:1 row_mask:0xf bank_mask:0xf
    v_cndmask_b32_dpp v85, v85, v85, vcc wave_shr:1 row_mask:0xf bank_mask:0xf
    s_lshr_b64 s[52:53], s[52:53], 1
    v_cndmask_b32_dpp v86, v86, v86, vcc wave_shr:1 row_mask:0xf bank_mask:0xf
    v_cndmask_b32_dpp v87, v87, v87, vcc wave_shr:1 row_mask:0xf bank_mask:0xf
    s_andn2_b64 s[82:83], s[82:83], s[52:53]
    v_cndmask_b32_dpp v7, v7, v7, vcc wave_shr:1 row_mask:0xf bank_mask:0xf
    s_mov_b64 exec, s[50:51]
    s_cbranch_scc0 L2_d133
    s_mov_b64 exec, s[82:83]
    s_nop 1
    v_mfma_f32_4x4x4_16b_bf16 v[88:91], v[12:13], v[84:85], 0
    s_nop 1
    v_mfma_f32_4x4x4_16b_bf16 v[88:91], v[10:11], v[86:87], v[88:91]
    s_nop 4
    v_cvt_pk_bf16_f32 v88, v88, v89
    v_cvt_pk_bf16_f32 v89, v90, v91
    ds_pk_add_bf16 v7, v88 offset:65408
    ds_pk_add_bf16 v7, v89 offset:65412
    s_mov_b64 exec, s[50:51]
    s_branch L2_d133
L2_c134:
    s_lshl_b64 s[52:53], s[82:83], 1
    s_andn2_b64 s[52:53], s[52:53], s[80:81]
    s_andn2_b64 s[52:53], s[52:53], s[54:55]
    s_or_b64 s[80:81], s[80:81], s[52:53]
    s_not_b64 vcc, s[52:53]
    s_mov_b64 exec, -1
    v_cndmask_b32_dpp v84, v84, v84, vcc wave_shr:1 row_mask:0xf bank_mask:0xf
    v_cndmask_b32_dpp v85, v85, v85, vcc wave_shr:1 row_mask:0xf bank_mask:0xf
    s_lshr_b64 s[52:53], s[52:53], 1
    v_cndmask_b32_dpp v86, v86, v86, vcc wave_shr:1 row_mask:0xf bank_mask:0xf
    v_cndmask_b32_dpp v87, v87, v87, vcc wave_shr:1 row_mask:0xf bank_mask:0xf
    s_andn2_b64 s[82:83], s[82:83], s[52:53]
    v_cndmask_b32_dpp v7, v7, v7, vcc wave_shr:1 row_mask:0xf bank_mask:0xf
    s_mov_b64 exec, s[54:55]
    s_cbranch_scc0 L2_d134
    s_mov_b64 exec, s[82:83]
    s_nop 1
    v_mfma_f32_4x4x4_16b_bf16 v[88:91], v[12:13], v[84:85], 0
    s_nop 1
    v_mfma_f32_4x4x4_16b_bf16 v[88:91], v[10:11], v[86:87], v[88:91]
    s_nop 4
    v_cvt_pk_bf16_f32 v88, v88, v89
    v_cvt_pk_bf16_f32 v89, v90, v91
    ds_pk_add_bf16 v7, v88 offset:65408
    ds_pk_add_bf16 v7, v89 offset:65412
    s_mov_b64 exec, s[54:55]
    s_branch L2_d134
L2_c135:
    s_lshl_b64 s[52:53], s[82:83], 1
    s_andn2_b64 s[52:53], s[52:53], s[80:81]
    s_andn2_b64 s[52:53], s[52:53], s[50:51]
    s_or_b64 s[80:81], s[80:81], s[52:53]
    s_not_b64 vcc, s[52:53]
    s_mov_b64 exec, -1
    v_cndmask_b32_dpp v84, v84, v84, vcc wave_shr:1 row_mask:0xf bank_mask:0xf
    v_cndmask_b32_dpp v85, v85, v85, vcc wave_shr:1 row_mask:0xf bank_mask:0xf
    s_lshr_b64 s[52:53], s[52:53], 1
    v_cndmask_b32_dpp v86, v86, v86, vcc wave_shr:1 row_mask:0xf bank_mask:0xf
    v_cndmask_b32_dpp v87, v87, v87, vcc wave_shr:1 row_mask:0xf bank_mask:0xf
    s_andn2_b64 s[82:83], s[82:83], s[52:53]
    v_cndmask_b32_dpp v7, v7, v7, vcc wave_shr:1 row_mask:0xf bank_mask:0xf
    s_mov_b64 exec, s[50:51]
    s_cbranch_scc0 L2_d135
    s_mov_b64 exec, s[82:83]
    s_nop 1
    v_mfma_f32_4x4x4_16b_bf16 v[88:91], v[12:13], v[84:85], 0
    s_nop 1
    v_mfma_f32_4x4x4_16b_bf16 v[88:91], v[10:11], v[86:87], v[88:91]
    s_nop 4
    v_cvt_pk_bf16_f32 v88, v88, v89
    v_cvt_pk_bf16_f32 v89, v90, v91
    ds_pk_add_bf16 v7, v88 offset:65408
    ds_pk_add_bf16 v7, v89 offset:65412
    s_mov_b64 exec, s[50:51]
    s_branch L2_d135
L2_c136:
    s_lshl_b64 s[52:53], s[82:83], 1
    s_andn2_b64 s[52:53], s[52:53], s[80:81]
    s_andn2_b64 s[52:53], s[52:53], s[54:55]
    s_or_b64 s[80:81], s[80:81], s[52:53]
    s_not_b64 vcc, s[52:53]
    s_mov_b64 exec, -1
    v_cndmask_b32_dpp v84, v84, v84, vcc wave_shr:1 row_mask:0xf bank_mask:0xf
    v_cndmask_b32_dpp v85, v85, v85, vcc wave_shr:1 row_mask:0xf bank_mask:0xf
    s_lshr_b64 s[52:53], s[52:53], 1
    v_cndmask_b32_dpp v86, v86, v86, vcc wave_shr:1 row_mask:0xf bank_mask:0xf
    v_cndmask_b32_dpp v87, v87, v87, vcc wave_shr:1 row_mask:0xf bank_mask:0xf
    s_andn2_b64 s[82:83], s[82:83], s[52:53]
    v_cndmask_b32_dpp v7, v7, v7, vcc wave_shr:1 row_mask:0xf bank_mask:0xf
    s_mov_b64 exec, s[54:55]
    s_cbranch_scc0 L2_d136
    s_mov_b64 exec, s[82:83]
    s_nop 1
    v_mfma_f32_4x4x4_16b_bf16 v[88:91], v[12:13], v[84:85], 0
    s_nop 1
    v_mfma_f32_4x4x4_16b_bf16 v[88:91], v[10:11], v[86:87], v[88:91]
    s_nop 4
    v_cvt_pk_bf16_f32 v88, v88, v89
    v_cvt_pk_bf16_f32 v89, v90, v91
    ds_pk_add_bf16 v7, v88 offset:65408
    ds_pk_add_bf16 v7, v89 offset:65412
    s_mov_b64 exec, s[54:55]
    s_branch L2_d136
L2_c137:
    s_lshl_b64 s[52:53], s[82:83], 1
    s_andn2_b64 s[52:53], s[52:53], s[80:81]
    s_andn2_b64 s[52:53], s[52:53], s[50:51]
    s_or_b64 s[80:81], s[80:81], s[52:53]
    s_not_b64 vcc, s[52:53]
    s_mov_b64 exec, -1
    v_cndmask_b32_dpp v84, v84, v84, vcc wave_shr:1 row_mask:0xf bank_mask:0xf
    v_cndmask_b32_dpp v85, v85, v85, vcc wave_shr:1 row_mask:0xf bank_mask:0xf
    s_lshr_b64 s[52:53], s[52:53], 1
    v_cndmask_b32_dpp v86, v86, v86, vcc wave_shr:1 row_mask:0xf bank_mask:0xf
    v_cndmask_b32_dpp v87, v87, v87, vcc wave_shr:1 row_mask:0xf bank_mask:0xf
    s_andn2_b64 s[82:83], s[82:83], s[52:53]
    v_cndmask_b32_dpp v7, v7, v7, vcc wave_shr:1 row_mask:0xf bank_mask:0xf
    s_mov_b64 exec, s[50:51]
    s_cbranch_scc0 L2_d137
    s_mov_b64 exec, s[82:83]
    s_nop 1
    v_mfma_f32_4x4x4_16b_bf16 v[88:91], v[12:13], v[84:85], 0
    s_nop 1
    v_mfma_f32_4x4x4_16b_bf16 v[88:91], v[10:11], v[86:87], v[88:91]
    s_nop 4
    v_cvt_pk_bf16_f32 v88, v88, v89
    v_cvt_pk_bf16_f32 v89, v90, v91
    ds_pk_add_bf16 v7, v88 offset:65408
    ds_pk_add_bf16 v7, v89 offset:65412
    s_mov_b64 exec, s[50:51]
    s_branch L2_d137
L2_c138:
    s_lshl_b64 s[52:53], s[82:83], 1
    s_andn2_b64 s[52:53], s[52:53], s[80:81]
    s_andn2_b64 s[52:53], s[52:53], s[54:55]
    s_or_b64 s[80:81], s[80:81], s[52:53]
    s_not_b64 vcc, s[52:53]
    s_mov_b64 exec, -1
    v_cndmask_b32_dpp v84, v84, v84, vcc wave_shr:1 row_mask:0xf bank_mask:0xf
    v_cndmask_b32_dpp v85, v85, v85, vcc wave_shr:1 row_mask:0xf bank_mask:0xf
    s_lshr_b64 s[52:53], s[52:53], 1
    v_cndmask_b32_dpp v86, v86, v86, vcc wave_shr:1 row_mask:0xf bank_mask:0xf
    v_cndmask_b32_dpp v87, v87, v87, vcc wave_shr:1 row_mask:0xf bank_mask:0xf
    s_andn2_b64 s[82:83], s[82:83], s[52:53]
    v_cndmask_b32_dpp v7, v7, v7, vcc wave_shr:1 row_mask:0xf bank_mask:0xf
    s_mov_b64 exec, s[54:55]
    s_cbranch_scc0 L2_d138
    s_mov_b64 exec, s[82:83]
    s_nop 1
    v_mfma_f32_4x4x4_16b_bf16 v[88:91], v[12:13], v[84:85], 0
    s_nop 1
    v_mfma_f32_4x4x4_16b_bf16 v[88:91], v[10:11], v[86:87], v[88:91]
    s_nop 4
    v_cvt_pk_bf16_f32 v88, v88, v89
    v_cvt_pk_bf16_f32 v89, v90, v91
    ds_pk_add_bf16 v7, v88 offset:65408
    ds_pk_add_bf16 v7, v89 offset:65412
    s_mov_b64 exec, s[54:55]
    s_branch L2_d138
L2_c139:
    s_lshl_b64 s[52:53], s[82:83], 1
    s_andn2_b64 s[52:53], s[52:53], s[80:81]
    s_andn2_b64 s[52:53], s[52:53], s[50:51]
    s_or_b64 s[80:81], s[80:81], s[52:53]
    s_not_b64 vcc, s[52:53]
    s_mov_b64 exec, -1
    v_cndmask_b32_dpp v84, v84, v84, vcc wave_shr:1 row_mask:0xf bank_mask:0xf
    v_cndmask_b32_dpp v85, v85, v85, vcc wave_shr:1 row_mask:0xf bank_mask:0xf
    s_lshr_b64 s[52:53], s[52:53], 1
    v_cndmask_b32_dpp v86, v86, v86, vcc wave_shr:1 row_mask:0xf bank_mask:0xf
    v_cndmask_b32_dpp v87, v87, v87, vcc wave_shr:1 row_mask:0xf bank_mask:0xf
    s_andn2_b64 s[82:83], s[82:83], s[52:53]
    v_cndmask_b32_dpp v7, v7, v7, vcc wave_shr:1 row_mask:0xf bank_mask:0xf
    s_mov_b64 exec, s[50:51]
    s_cbranch_scc0 L2_d139
    s_mov_b64 exec, s[82:83]
    s_nop 1
    v_mfma_f32_4x4x4_16b_bf16 v[88:91], v[12:13], v[84:85], 0
    s_nop 1
    v_mfma_f32_4x4x4_16b_bf16 v[88:91], v[10:11], v[86:87], v[88:91]
    s_nop 4
    v_cvt_pk_bf16_f32 v88, v88, v89
    v_cvt_pk_bf16_f32 v89, v90, v91
    ds_pk_add_bf16 v7, v88 offset:65408
    ds_pk_add_bf16 v7, v89 offset:65412
    s_mov_b64 exec, s[50:51]
    s_branch L2_d139
L2_c140:
    s_lshl_b64 s[52:53], s[82:83], 1
    s_andn2_b64 s[52:53], s[52:53], s[80:81]
    s_andn2_b64 s[52:53], s[52:53], s[54:55]
    s_or_b64 s[80:81], s[80:81], s[52:53]
    s_not_b64 vcc, s[52:53]
    s_mov_b64 exec, -1
    v_cndmask_b32_dpp v84, v84, v84, vcc wave_shr:1 row_mask:0xf bank_mask:0xf
    v_cndmask_b32_dpp v85, v85, v85, vcc wave_shr:1 row_mask:0xf bank_mask:0xf
    s_lshr_b64 s[52:53], s[52:53], 1
    v_cndmask_b32_dpp v86, v86, v86, vcc wave_shr:1 row_mask:0xf bank_mask:0xf
    v_cndmask_b32_dpp v87, v87, v87, vcc wave_shr:1 row_mask:0xf bank_mask:0xf
    s_andn2_b64 s[82:83], s[82:83], s[52:53]
    v_cndmask_b32_dpp v7, v7, v7, vcc wave_shr:1 row_mask:0xf bank_mask:0xf
    s_mov_b64 exec, s[54:55]
    s_cbranch_scc0 L2_d140
    s_mov_b64 exec, s[82:83]
    s_nop 1
    v_mfma_f32_4x4x4_16b_bf16 v[88:91], v[12:13], v[84:85], 0
    s_nop 1
    v_mfma_f32_4x4x4_16b_bf16 v[88:91], v[10:11], v[86:87], v[88:91]
    s_nop 4
    v_cvt_pk_bf16_f32 v88, v88, v89
    v_cvt_pk_bf16_f32 v89, v90, v91
    ds_pk_add_bf16 v7, v88 offset:65408
    ds_pk_add_bf16 v7, v89 offset:65412
    s_mov_b64 exec, s[54:55]
    s_branch L2_d140
L2_c141:
    s_lshl_b64 s[52:53], s[82:83], 1
    s_andn2_b64 s[52:53], s[52:53], s[80:81]
    s_andn2_b64 s[52:53], s[52:53], s[50:51]
    s_or_b64 s[80:81], s[80:81], s[52:53]
    s_not_b64 vcc, s[52:53]
    s_mov_b64 exec, -1
    v_cndmask_b32_dpp v84, v84, v84, vcc wave_shr:1 row_mask:0xf bank_mask:0xf
    v_cndmask_b32_dpp v85, v85, v85, vcc wave_shr:1 row_mask:0xf bank_mask:0xf
    s_lshr_b64 s[52:53], s[52:53], 1
    v_cndmask_b32_dpp v86, v86, v86, vcc wave_shr:1 row_mask:0xf bank_mask:0xf
    v_cndmask_b32_dpp v87, v87, v87, vcc wave_shr:1 row_mask:0xf bank_mask:0xf
    s_andn2_b64 s[82:83], s[82:83], s[52:53]
    v_cndmask_b32_dpp v7, v7, v7, vcc wave_shr:1 row_mask:0xf bank_mask:0xf
    s_mov_b64 exec, s[50:51]
    s_cbranch_scc0 L2_d141
    s_mov_b64 exec, s[82:83]
    s_nop 1
    v_mfma_f32_4x4x4_16b_bf16 v[88:91], v[12:13], v[84:85], 0
    s_nop 1
    v_mfma_f32_4x4x4_16b_bf16 v[88:91], v[10:11], v[86:87], v[88:91]
    s_nop 4
    v_cvt_pk_bf16_f32 v88, v88, v89
    v_cvt_pk_bf16_f32 v89, v90, v91
    ds_pk_add_bf16 v7, v88 offset:65408
    ds_pk_add_bf16 v7, v89 offset:65412
    s_mov_b64 exec, s[50:51]
    s_branch L2_d141
L2_c142:
    s_lshl_b64 s[52:53], s[82:83], 1
    s_andn2_b64 s[52:53], s[52:53], s[80:81]
    s_andn2_b64 s[52:53], s[52:53], s[54:55]
    s_or_b64 s[80:81], s[80:81], s[52:53]
    s_not_b64 vcc, s[52:53]
    s_mov_b64 exec, -1
    v_cndmask_b32_dpp v84, v84, v84, vcc wave_shr:1 row_mask:0xf bank_mask:0xf
    v_cndmask_b32_dpp v85, v85, v85, vcc wave_shr:1 row_mask:0xf bank_mask:0xf
    s_lshr_b64 s[52:53], s[52:53], 1
    v_cndmask_b32_dpp v86, v86, v86, vcc wave_shr:1 row_mask:0xf bank_mask:0xf
    v_cndmask_b32_dpp v87, v87, v87, vcc wave_shr:1 row_mask:0xf bank_mask:0xf
    s_andn2_b64 s[82:83], s[82:83], s[52:53]
    v_cndmask_b32_dpp v7, v7, v7, vcc wave_shr:1 row_mask:0xf bank_mask:0xf
    s_mov_b64 exec, s[54:55]
    s_cbranch_scc0 L2_d142
    s_mov_b64 exec, s[82:83]
    s_nop 1
    v_mfma_f32_4x4x4_16b_bf16 v[88:91], v[12:13], v[84:85], 0
    s_nop 1
    v_mfma_f32_4x4x4_16b_bf16 v[88:91], v[10:11], v[86:87], v[88:91]
    s_nop 4
    v_cvt_pk_bf16_f32 v88, v88, v89
    v_cvt_pk_bf16_f32 v89, v90, v91
    ds_pk_add_bf16 v7, v88 offset:65408
    ds_pk_add_bf16 v7, v89 offset:65412
    s_mov_b64 exec, s[54:55]
    s_branch L2_d142
L2_c143:
    s_lshl_b64 s[52:53], s[82:83], 1
    s_andn2_b64 s[52:53], s[52:53], s[80:81]
    s_andn2_b64 s[52:53], s[52:53], s[50:51]
    s_or_b64 s[80:81], s[80:81], s[52:53]
    s_not_b64 vcc, s[52:53]
    s_mov_b64 exec, -1
    v_cndmask_b32_dpp v84, v84, v84, vcc wave_shr:1 row_mask:0xf bank_mask:0xf
    v_cndmask_b32_dpp v85, v85, v85, vcc wave_shr:1 row_mask:0xf bank_mask:0xf
    s_lshr_b64 s[52:53], s[52:53], 1
    v_cndmask_b32_dpp v86, v86, v86, vcc wave_shr:1 row_mask:0xf bank_mask:0xf
    v_cndmask_b32_dpp v87, v87, v87, vcc wave_shr:1 row_mask:0xf bank_mask:0xf
    s_andn2_b64 s[82:83], s[82:83], s[52:53]
    v_cndmask_b32_dpp v7, v7, v7, vcc wave_shr:1 row_mask:0xf bank_mask:0xf
    s_mov_b64 exec, s[50:51]
    s_cbranch_scc0 L2_d143
    s_mov_b64 exec, s[82:83]
    s_nop 1
    v_mfma_f32_4x4x4_16b_bf16 v[88:91], v[12:13], v[84:85], 0
    s_nop 1
    v_mfma_f32_4x4x4_16b_bf16 v[88:91], v[10:11], v[86:87], v[88:91]
    s_nop 4
    v_cvt_pk_bf16_f32 v88, v88, v89
    v_cvt_pk_bf16_f32 v89, v90, v91
    ds_pk_add_bf16 v7, v88 offset:65408
    ds_pk_add_bf16 v7, v89 offset:65412
    s_mov_b64 exec, s[50:51]
    s_branch L2_d143
L2_c144:
    s_lshl_b64 s[52:53], s[82:83], 1
    s_andn2_b64 s[52:53], s[52:53], s[80:81]
    s_andn2_b64 s[52:53], s[52:53], s[54:55]
    s_or_b64 s[80:81], s[80:81], s[52:53]
    s_not_b64 vcc, s[52:53]
    s_mov_b64 exec, -1
    v_cndmask_b32_dpp v84, v84, v84, vcc wave_shr:1 row_mask:0xf bank_mask:0xf
    v_cndmask_b32_dpp v85, v85, v85, vcc wave_shr:1 row_mask:0xf bank_mask:0xf
    s_lshr_b64 s[52:53], s[52:53], 1
    v_cndmask_b32_dpp v86, v86, v86, vcc wave_shr:1 row_mask:0xf bank_mask:0xf
    v_cndmask_b32_dpp v87, v87, v87, vcc wave_shr:1 row_mask:0xf bank_mask:0xf
    s_andn2_b64 s[82:83], s[82:83], s[52:53]
    v_cndmask_b32_dpp v7, v7, v7, vcc wave_shr:1 row_mask:0xf bank_mask:0xf
    s_mov_b64 exec, s[54:55]
    s_cbranch_scc0 L2_d144
    s_mov_b64 exec, s[82:83]
    s_nop 1
    v_mfma_f32_4x4x4_16b_bf16 v[88:91], v[12:13], v[84:85], 0
    s_nop 1
    v_mfma_f32_4x4x4_16b_bf16 v[88:91], v[10:11], v[86:87], v[88:91]
    s_nop 4
    v_cvt_pk_bf16_f32 v88, v88, v89
    v_cvt_pk_bf16_f32 v89, v90, v91
    ds_pk_add_bf16 v7, v88 offset:65408
    ds_pk_add_bf16 v7, v89 offset:65412
    s_mov_b64 exec, s[54:55]
    s_branch L2_d144
L2_c145:
    s_lshl_b64 s[52:53], s[82:83], 1
    s_andn2_b64 s[52:53], s[52:53], s[80:81]
    s_andn2_b64 s[52:53], s[52:53], s[50:51]
    s_or_b64 s[80:81], s[80:81], s[52:53]
    s_not_b64 vcc, s[52:53]
    s_mov_b64 exec, -1
    v_cndmask_b32_dpp v84, v84, v84, vcc wave_shr:1 row_mask:0xf bank_mask:0xf
    v_cndmask_b32_dpp v85, v85, v85, vcc wave_shr:1 row_mask:0xf bank_mask:0xf
    s_lshr_b64 s[52:53], s[52:53], 1
    v_cndmask_b32_dpp v86, v86, v86, vcc wave_shr:1 row_mask:0xf bank_mask:0xf
    v_cndmask_b32_dpp v87, v87, v87, vcc wave_shr:1 row_mask:0xf bank_mask:0xf
    s_andn2_b64 s[82:83], s[82:83], s[52:53]
    v_cndmask_b32_dpp v7, v7, v7, vcc wave_shr:1 row_mask:0xf bank_mask:0xf
    s_mov_b64 exec, s[50:51]
    s_cbranch_scc0 L2_d145
    s_mov_b64 exec, s[82:83]
    s_nop 1
    v_mfma_f32_4x4x4_16b_bf16 v[88:91], v[12:13], v[84:85], 0
    s_nop 1
    v_mfma_f32_4x4x4_16b_bf16 v[88:91], v[10:11], v[86:87], v[88:91]
    s_nop 4
    v_cvt_pk_bf16_f32 v88, v88, v89
    v_cvt_pk_bf16_f32 v89, v90, v91
    ds_pk_add_bf16 v7, v88 offset:65408
    ds_pk_add_bf16 v7, v89 offset:65412
    s_mov_b64 exec, s[50:51]
    s_branch L2_d145
L2_c146:
    s_lshl_b64 s[52:53], s[82:83], 1
    s_andn2_b64 s[52:53], s[52:53], s[80:81]
    s_andn2_b64 s[52:53], s[52:53], s[54:55]
    s_or_b64 s[80:81], s[80:81], s[52:53]
    s_not_b64 vcc, s[52:53]
    s_mov_b64 exec, -1
    v_cndmask_b32_dpp v84, v84, v84, vcc wave_shr:1 row_mask:0xf bank_mask:0xf
    v_cndmask_b32_dpp v85, v85, v85, vcc wave_shr:1 row_mask:0xf bank_mask:0xf
    s_lshr_b64 s[52:53], s[52:53], 1
    v_cndmask_b32_dpp v86, v86, v86, vcc wave_shr:1 row_mask:0xf bank_mask:0xf
    v_cndmask_b32_dpp v87, v87, v87, vcc wave_shr:1 row_mask:0xf bank_mask:0xf
    s_andn2_b64 s[82:83], s[82:83], s[52:53]
    v_cndmask_b32_dpp v7, v7, v7, vcc wave_shr:1 row_mask:0xf bank_mask:0xf
    s_mov_b64 exec, s[54:55]
    s_cbranch_scc0 L2_d146
    s_mov_b64 exec, s[82:83]
    s_nop 1
    v_mfma_f32_4x4x4_16b_bf16 v[88:91], v[12:13], v[84:85], 0
    s_nop 1
    v_mfma_f32_4x4x4_16b_bf16 v[88:91], v[10:11], v[86:87], v[88:91]
    s_nop 4
    v_cvt_pk_bf16_f32 v88, v88, v89
    v_cvt_pk_bf16_f32 v89, v90, v91
    ds_pk_add_bf16 v7, v88 offset:65408
    ds_pk_add_bf16 v7, v89 offset:65412
    s_mov_b64 exec, s[54:55]
    s_branch L2_d146
L2_c147:
    s_lshl_b64 s[52:53], s[82:83], 1
    s_andn2_b64 s[52:53], s[52:53], s[80:81]
    s_andn2_b64 s[52:53], s[52:53], s[50:51]
    s_or_b64 s[80:81], s[80:81], s[52:53]
    s_not_b64 vcc, s[52:53]
    s_mov_b64 exec, -1
    v_cndmask_b32_dpp v84, v84, v84, vcc wave_shr:1 row_mask:0xf bank_mask:0xf
    v_cndmask_b32_dpp v85, v85, v85, vcc wave_shr:1 row_mask:0xf bank_mask:0xf
    s_lshr_b64 s[52:53], s[52:53], 1
    v_cndmask_b32_dpp v86, v86, v86, vcc wave_shr:1 row_mask:0xf bank_mask:0xf
    v_cndmask_b32_dpp v87, v87, v87, vcc wave_shr:1 row_mask:0xf bank_mask:0xf
    s_andn2_b64 s[82:83], s[82:83], s[52:53]
    v_cndmask_b32_dpp v7, v7, v7, vcc wave_shr:1 row_mask:0xf bank_mask:0xf
    s_mov_b64 exec, s[50:51]
    s_cbranch_scc0 L2_d147
    s_mov_b64 exec, s[82:83]
    s_nop 1
    v_mfma_f32_4x4x4_16b_bf16 v[88:91], v[12:13], v[84:85], 0
    s_nop 1
    v_mfma_f32_4x4x4_16b_bf16 v[88:91], v[10:11], v[86:87], v[88:91]
    s_nop 4
    v_cvt_pk_bf16_f32 v88, v88, v89
    v_cvt_pk_bf16_f32 v89, v90, v91
    ds_pk_add_bf16 v7, v88 offset:65408
    ds_pk_add_bf16 v7, v89 offset:65412
    s_mov_b64 exec, s[50:51]
    s_branch L2_d147
L2_c148:
    s_lshl_b64 s[52:53], s[82:83], 1
    s_andn2_b64 s[52:53], s[52:53], s[80:81]
    s_andn2_b64 s[52:53], s[52:53], s[54:55]
    s_or_b64 s[80:81], s[80:81], s[52:53]
    s_not_b64 vcc, s[52:53]
    s_mov_b64 exec, -1
    v_cndmask_b32_dpp v84, v84, v84, vcc wave_shr:1 row_mask:0xf bank_mask:0xf
    v_cndmask_b32_dpp v85, v85, v85, vcc wave_shr:1 row_mask:0xf bank_mask:0xf
    s_lshr_b64 s[52:53], s[52:53], 1
    v_cndmask_b32_dpp v86, v86, v86, vcc wave_shr:1 row_mask:0xf bank_mask:0xf
    v_cndmask_b32_dpp v87, v87, v87, vcc wave_shr:1 row_mask:0xf bank_mask:0xf
    s_andn2_b64 s[82:83], s[82:83], s[52:53]
    v_cndmask_b32_dpp v7, v7, v7, vcc wave_shr:1 row_mask:0xf bank_mask:0xf
    s_mov_b64 exec, s[54:55]
    s_cbranch_scc0 L2_d148
    s_mov_b64 exec, s[82:83]
    s_nop 1
    v_mfma_f32_4x4x4_16b_bf16 v[88:91], v[12:13], v[84:85], 0
    s_nop 1
    v_mfma_f32_4x4x4_16b_bf16 v[88:91], v[10:11], v[86:87], v[88:91]
    s_nop 4
    v_cvt_pk_bf16_f32 v88, v88, v89
    v_cvt_pk_bf16_f32 v89, v90, v91
    ds_pk_add_bf16 v7, v88 offset:65408
    ds_pk_add_bf16 v7, v89 offset:65412
    s_mov_b64 exec, s[54:55]
    s_branch L2_d148
L2_c149:
    s_lshl_b64 s[52:53], s[82:83], 1
    s_andn2_b64 s[52:53], s[52:53], s[80:81]
    s_andn2_b64 s[52:53], s[52:53], s[50:51]
    s_or_b64 s[80:81], s[80:81], s[52:53]
    s_not_b64 vcc, s[52:53]
    s_mov_b64 exec, -1
    v_cndmask_b32_dpp v84, v84, v84, vcc wave_shr:1 row_mask:0xf bank_mask:0xf
    v_cndmask_b32_dpp v85, v85, v85, vcc wave_shr:1 row_mask:0xf bank_mask:0xf
    s_lshr_b64 s[52:53], s[52:53], 1
    v_cndmask_b32_dpp v86, v86, v86, vcc wave_shr:1 row_mask:0xf bank_mask:0xf
    v_cndmask_b32_dpp v87, v87, v87, vcc wave_shr:1 row_mask:0xf bank_mask:0xf
    s_andn2_b64 s[82:83], s[82:83], s[52:53]
    v_cndmask_b32_dpp v7, v7, v7, vcc wave_shr:1 row_mask:0xf bank_mask:0xf
    s_mov_b64 exec, s[50:51]
    s_cbranch_scc0 L2_d149
    s_mov_b64 exec, s[82:83]
    s_nop 1
    v_mfma_f32_4x4x4_16b_bf16 v[88:91], v[12:13], v[84:85], 0
    s_nop 1
    v_mfma_f32_4x4x4_16b_bf16 v[88:91], v[10:11], v[86:87], v[88:91]
    s_nop 4
    v_cvt_pk_bf16_f32 v88, v88, v89
    v_cvt_pk_bf16_f32 v89, v90, v91
    ds_pk_add_bf16 v7, v88 offset:65408
    ds_pk_add_bf16 v7, v89 offset:65412
    s_mov_b64 exec, s[50:51]
    s_branch L2_d149
L2_c150:
    s_lshl_b64 s[52:53], s[82:83], 1
    s_andn2_b64 s[52:53], s[52:53], s[80:81]
    s_andn2_b64 s[52:53], s[52:53], s[54:55]
    s_or_b64 s[80:81], s[80:81], s[52:53]
    s_not_b64 vcc, s[52:53]
    s_mov_b64 exec, -1
    v_cndmask_b32_dpp v84, v84, v84, vcc wave_shr:1 row_mask:0xf bank_mask:0xf
    v_cndmask_b32_dpp v85, v85, v85, vcc wave_shr:1 row_mask:0xf bank_mask:0xf
    s_lshr_b64 s[52:53], s[52:53], 1
    v_cndmask_b32_dpp v86, v86, v86, vcc wave_shr:1 row_mask:0xf bank_mask:0xf
    v_cndmask_b32_dpp v87, v87, v87, vcc wave_shr:1 row_mask:0xf bank_mask:0xf
    s_andn2_b64 s[82:83], s[82:83], s[52:53]
    v_cndmask_b32_dpp v7, v7, v7, vcc wave_shr:1 row_mask:0xf bank_mask:0xf
    s_mov_b64 exec, s[54:55]
    s_cbranch_scc0 L2_d150
    s_mov_b64 exec, s[82:83]
    s_nop 1
    v_mfma_f32_4x4x4_16b_bf16 v[88:91], v[12:13], v[84:85], 0
    s_nop 1
    v_mfma_f32_4x4x4_16b_bf16 v[88:91], v[10:11], v[86:87], v[88:91]
    s_nop 4
    v_cvt_pk_bf16_f32 v88, v88, v89
    v_cvt_pk_bf16_f32 v89, v90, v91
    ds_pk_add_bf16 v7, v88 offset:65408
    ds_pk_add_bf16 v7, v89 offset:65412
    s_mov_b64 exec, s[54:55]
    s_branch L2_d150
L2_c151:
    s_lshl_b64 s[52:53], s[82:83], 1
    s_andn2_b64 s[52:53], s[52:53], s[80:81]
    s_andn2_b64 s[52:53], s[52:53], s[50:51]
    s_or_b64 s[80:81], s[80:81], s[52:53]
    s_not_b64 vcc, s[52:53]
    s_mov_b64 exec, -1
    v_cndmask_b32_dpp v84, v84, v84, vcc wave_shr:1 row_mask:0xf bank_mask:0xf
    v_cndmask_b32_dpp v85, v85, v85, vcc wave_shr:1 row_mask:0xf bank_mask:0xf
    s_lshr_b64 s[52:53], s[52:53], 1
    v_cndmask_b32_dpp v86, v86, v86, vcc wave_shr:1 row_mask:0xf bank_mask:0xf
    v_cndmask_b32_dpp v87, v87, v87, vcc wave_shr:1 row_mask:0xf bank_mask:0xf
    s_andn2_b64 s[82:83], s[82:83], s[52:53]
    v_cndmask_b32_dpp v7, v7, v7, vcc wave_shr:1 row_mask:0xf bank_mask:0xf
    s_mov_b64 exec, s[50:51]
    s_cbranch_scc0 L2_d151
    s_mov_b64 exec, s[82:83]
    s_nop 1
    v_mfma_f32_4x4x4_16b_bf16 v[88:91], v[12:13], v[84:85], 0
    s_nop 1
    v_mfma_f32_4x4x4_16b_bf16 v[88:91], v[10:11], v[86:87], v[88:91]
    s_nop 4
    v_cvt_pk_bf16_f32 v88, v88, v89
    v_cvt_pk_bf16_f32 v89, v90, v91
    ds_pk_add_bf16 v7, v88 offset:65408
    ds_pk_add_bf16 v7, v89 offset:65412
    s_mov_b64 exec, s[50:51]
    s_branch L2_d151
L2_c152:
    s_mov_b64 s[50:51], vcc
    s_lshl_b64 s[52:53], s[82:83], 1
    s_andn2_b64 s[52:53], s[52:53], s[80:81]
    s_andn2_b64 s[52:53], s[52:53], s[50:51]
    s_or_b64 s[80:81], s[80:81], s[52:53]
    s_not_b64 vcc, s[52:53]
    s_mov_b64 exec, -1
    v_cndmask_b32_dpp v84, v84, v84, vcc wave_shr:1 row_mask:0xf bank_mask:0xf
    v_cndmask_b32_dpp v85, v85, v85, vcc wave_shr:1 row_mask:0xf bank_mask:0xf
    s_lshr_b64 s[52:53], s[52:53], 1
    v_cndmask_b32_dpp v86, v86, v86, vcc wave_shr:1 row_mask:0xf bank_mask:0xf
    v_cndmask_b32_dpp v87, v87, v87, vcc wave_shr:1 row_mask:0xf bank_mask:0xf
    s_andn2_b64 s[82:83], s[82:83], s[52:53]
    v_cndmask_b32_dpp v7, v7, v7, vcc wave_shr:1 row_mask:0xf bank_mask:0xf
    s_mov_b64 vcc, s[50:51]
    s_mov_b64 exec, s[50:51]
    s_cbranch_scc0 L2_d152
    s_mov_b64 exec, s[82:83]
    s_nop 1
    v_mfma_f32_4x4x4_16b_bf16 v[88:91], v[12:13], v[84:85], 0
    s_nop 1
    v_mfma_f32_4x4x4_16b_bf16 v[88:91], v[10:11], v[86:87], v[88:91]
    s_nop 4
    v_cvt_pk_bf16_f32 v88, v88, v89
    v_cvt_pk_bf16_f32 v89, v90, v91
    ds_pk_add_bf16 v7, v88 offset:65408
    ds_pk_add_bf16 v7, v89 offset:65412
    s_mov_b64 exec, vcc
    s_branch L2_d152
L2_c153:
    s_mov_b64 s[50:51], vcc
    s_lshl_b64 s[52:53], s[82:83], 1
    s_andn2_b64 s[52:53], s[52:53], s[80:81]
    s_andn2_b64 s[52:53], s[52:53], s[50:51]
    s_or_b64 s[80:81], s[80:81], s[52:53]
    s_not_b64 vcc, s[52:53]
    s_mov_b64 exec, -1
    v_cndmask_b32_dpp v84, v84, v84, vcc wave_shr:1 row_mask:0xf bank_mask:0xf
    v_cndmask_b32_dpp v85, v85, v85, vcc wave_shr:1 row_mask:0xf bank_mask:0xf
    s_lshr_b64 s[52:53], s[52:53], 1
    v_cndmask_b32_dpp v86, v86, v86, vcc wave_shr:1 row_mask:0xf bank_mask:0xf
    v_cndmask_b32_dpp v87, v87, v87, vcc wave_shr:1 row_mask:0xf bank_mask:0xf
    s_andn2_b64 s[82:83], s[82:83], s[52:53]
    v_cndmask_b32_dpp v7, v7, v7, vcc wave_shr:1 row_mask:0xf bank_mask:0xf
    s_mov_b64 vcc, s[50:51]
    s_mov_b64 exec, s[50:51]
    s_cbranch_scc0 L2_d153
    s_mov_b64 exec, s[82:83]
    s_nop 1
    v_mfma_f32_4x4x4_16b_bf16 v[88:91], v[12:13], v[84:85], 0
    s_nop 1
    v_mfma_f32_4x4x4_16b_bf16 v[88:91], v[10:11], v[86:87], v[88:91]
    s_nop 4
    v_cvt_pk_bf16_f32 v88, v88, v89
    v_cvt_pk_bf16_f32 v89, v90, v91
    ds_pk_add_bf16 v7, v88 offset:65408
    ds_pk_add_bf16 v7, v89 offset:65412
    s_mov_b64 exec, vcc
    s_branch L2_d153
.section .rodata,"a"
.p2align 6
.amdhsa_kernel gather_scatter__molecular_angular_gemnet__graph_kernel
  .amdhsa_next_free_vgpr 128
  .amdhsa_next_free_sgpr 102
  .amdhsa_accum_offset 128
  .amdhsa_group_segment_fixed_size 0
  .amdhsa_kernarg_size 112
  .amdhsa_user_sgpr_count 2
  .amdhsa_user_sgpr_kernarg_segment_ptr 1
  .amdhsa_system_sgpr_workgroup_id_x 1
  .amdhsa_float_denorm_mode_32 3
.end_amdhsa_kernel
```

```asm
; @launch grid=(256,1,1) block=(1024,1,1) lds=163840
.amdgcn_target "amdgcn-amd-amdhsa--gfx950"
.text
.globl gather_scatter__molecular_angular_gemnet__graph_kernel
.p2align 8
.type gather_scatter__molecular_angular_gemnet__graph_kernel,@function
gather_scatter__molecular_angular_gemnet__graph_kernel:
    s_cmp_ge_u32 s2, 256
    s_cbranch_scc0 L1_go
    s_endpgm
L1_go:
    s_load_dwordx4 s[4:7], s[0:1], 8
    s_load_dwordx2 s[28:29], s[0:1], 32
    s_load_dwordx2 s[30:31], s[0:1], 104
    s_load_dwordx2 s[56:57], s[0:1], 96
    s_load_dwordx2 s[86:87], s[0:1], 0
    s_load_dwordx4 s[60:63], s[0:1], 56
    s_load_dwordx4 s[64:67], s[0:1], 72
    v_lshrrev_b32 v7, 6, v0
    v_lshlrev_b32 v1, 3, v0
    v_readfirstlane_b32 s32, v7
    v_lshlrev_b32 v0, 4, v0
    s_xor_b32 s44, s2, 0
    s_lshr_b32 s3, s44, 5
    s_lshl_b32 s96, s3, 19
    s_and_b32 s3, s44, 31
    s_lshl_b32 s3, s3, 10
    s_add_u32 s96, s96, s3
    s_mul_i32 s3, s32, 31744
    s_add_u32 s96, s96, s3
    s_xor_b32 s44, s2, 8
    s_lshr_b32 s3, s44, 5
    s_lshl_b32 s97, s3, 19
    s_and_b32 s3, s44, 31
    s_lshl_b32 s3, s3, 10
    s_add_u32 s97, s97, s3
    s_mul_i32 s3, s32, 31744
    s_add_u32 s97, s97, s3
    s_xor_b32 s44, s2, 16
    s_lshr_b32 s3, s44, 5
    s_lshl_b32 s98, s3, 19
    s_and_b32 s3, s44, 31
    s_lshl_b32 s3, s3, 10
    s_add_u32 s98, s98, s3
    s_mul_i32 s3, s32, 31744
    s_add_u32 s98, s98, s3
    s_xor_b32 s44, s2, 24
    s_lshr_b32 s3, s44, 5
    s_lshl_b32 s99, s3, 19
    s_and_b32 s3, s44, 31
    s_lshl_b32 s3, s3, 10
    s_add_u32 s99, s99, s3
    s_mul_i32 s3, s32, 31744
    s_add_u32 s99, s99, s3
    s_waitcnt lgkmcnt(0)
    s_mov_b32 s8, s4
    s_mov_b32 s9, s5
    s_mov_b32 s10, 0x9c40000
    s_mov_b32 s11, 0x20000
    s_mov_b32 s12, s6
    s_mov_b32 s13, s7
    s_mov_b32 s14, 0x9c40000
    s_mov_b32 s15, 0x20000
    s_mov_b32 s16, s28
    s_mov_b32 s17, s29
    s_mov_b32 s18, 0x4e20000
    s_mov_b32 s19, 0x20000
    s_mov_b32 s68, s62
    s_mov_b32 s69, s63
    s_mov_b32 s70, 0x40
    s_mov_b32 s71, 0x20000
    s_mov_b32 s72, s60
    s_mov_b32 s73, s61
    s_mov_b32 s74, 0x40
    s_mov_b32 s75, 0x20000
    s_mov_b32 s20, s66
    s_mov_b32 s21, s67
    s_mov_b32 s22, 0x20
    s_mov_b32 s23, 0x20000
    s_mov_b32 s80, s64
    s_mov_b32 s81, s65
    s_mov_b32 s82, 0x20
    s_mov_b32 s83, 0x20000
    s_add_u32 s24, s30, 0xebcd000
    s_addc_u32 s25, s31, 0
    s_mov_b32 s26, 0x100
    s_mov_b32 s27, 0x20000
    v_lshrrev_b32 v2, 3, v0
    v_and_b32 v2, 6, v2
    v_lshlrev_b32 v3, 2, v0
    s_lshl_b32 s3, s32, 8
    s_add_u32 s3, s3, s2
    s_cmp_lg_u32 s3, 254
    s_cbranch_scc1 L1_wt
    buffer_load_ushort v96, v2, s[68:71], 0 offen offset:0
    buffer_load_ushort v108, v2, s[68:71], 0 offen offset:8
    buffer_load_ushort v97, v2, s[68:71], 0 offen offset:16
    buffer_load_ushort v109, v2, s[68:71], 0 offen offset:24
    buffer_load_ushort v98, v2, s[68:71], 0 offen offset:32
    buffer_load_ushort v110, v2, s[68:71], 0 offen offset:40
    buffer_load_ushort v99, v2, s[68:71], 0 offen offset:48
    buffer_load_ushort v111, v2, s[68:71], 0 offen offset:56
    buffer_load_ushort v100, v2, s[72:75], 0 offen offset:0
    buffer_load_ushort v112, v2, s[72:75], 0 offen offset:8
    buffer_load_ushort v101, v2, s[72:75], 0 offen offset:16
    buffer_load_ushort v113, v2, s[72:75], 0 offen offset:24
    buffer_load_ushort v102, v2, s[72:75], 0 offen offset:32
    buffer_load_ushort v114, v2, s[72:75], 0 offen offset:40
    buffer_load_ushort v103, v2, s[72:75], 0 offen offset:48
    buffer_load_ushort v115, v2, s[72:75], 0 offen offset:56
    buffer_load_ushort v104, v2, s[20:23], 0 offen offset:0
    buffer_load_ushort v116, v2, s[20:23], 0 offen offset:8
    buffer_load_ushort v105, v2, s[20:23], 0 offen offset:16
    buffer_load_ushort v117, v2, s[20:23], 0 offen offset:24
    buffer_load_ushort v106, v2, s[80:83], 0 offen offset:0
    buffer_load_ushort v118, v2, s[80:83], 0 offen offset:8
    buffer_load_ushort v107, v2, s[80:83], 0 offen offset:16
    buffer_load_ushort v119, v2, s[80:83], 0 offen offset:24
    s_waitcnt vmcnt(0)
    v_lshl_or_b32 v96, v108, 16, v96
    v_lshl_or_b32 v97, v109, 16, v97
    v_lshl_or_b32 v98, v110, 16, v98
    v_lshl_or_b32 v99, v111, 16, v99
    v_lshl_or_b32 v100, v112, 16, v100
    v_lshl_or_b32 v101, v113, 16, v101
    v_lshl_or_b32 v102, v114, 16, v102
    v_lshl_or_b32 v103, v115, 16, v103
    v_lshl_or_b32 v104, v116, 16, v104
    v_lshl_or_b32 v105, v117, 16, v105
    v_lshl_or_b32 v106, v118, 16, v106
    v_lshl_or_b32 v107, v119, 16, v107
    buffer_store_dwordx4 v[96:99], v3, s[24:27], 0 offen offset:0 sc1
    buffer_store_dwordx4 v[100:103], v3, s[24:27], 0 offen offset:16 sc1
    buffer_store_dwordx4 v[104:107], v3, s[24:27], 0 offen offset:32 sc1
L1_wt:
    s_nop 1
    s_add_u32 s44, s96, 0x0
    buffer_load_dwordx4 v[16:19], v0, s[8:11], s44 offen nt
    s_add_u32 s45, s96, 0x0
    buffer_load_dwordx4 v[20:23], v0, s[12:15], s45 offen nt
    s_add_u32 s46, s96, 0x0
    s_lshr_b32 s46, s46, 1
    buffer_load_dwordx2 v[24:25], v1, s[16:19], s46 offen nt
    s_add_u32 s47, s97, 0x400000
    s_lshr_b32 s47, s47, 1
    buffer_load_dwordx2 v[26:27], v1, s[16:19], s47 offen nt
    s_add_u32 s44, s97, 0x400000
    buffer_load_dwordx4 v[28:31], v0, s[8:11], s44 offen nt
    s_add_u32 s45, s97, 0x400000
    buffer_load_dwordx4 v[32:35], v0, s[12:15], s45 offen nt
    s_add_u32 s46, s98, 0x800000
    buffer_load_dwordx4 v[36:39], v0, s[8:11], s46 offen nt
    s_add_u32 s47, s98, 0x800000
    buffer_load_dwordx4 v[40:43], v0, s[12:15], s47 offen nt
    s_add_u32 s44, s98, 0x800000
    s_lshr_b32 s44, s44, 1
    buffer_load_dwordx2 v[44:45], v1, s[16:19], s44 offen nt
    s_add_u32 s45, s99, 0xc00000
    s_lshr_b32 s45, s45, 1
    buffer_load_dwordx2 v[46:47], v1, s[16:19], s45 offen nt
    s_mov_b32 s20, s30
    s_mov_b32 s21, s31
    s_mov_b32 s22, 0xd344000
    s_mov_b32 s23, 0x20000
    s_add_u32 s24, s30, 0x2c000
    s_addc_u32 s25, s31, 0
    s_mov_b32 s26, 0xd318000
    s_mov_b32 s27, 0x20000
    s_add_u32 s3, s32, 0
    s_mul_i32 s4, s3, 205
    s_lshr_b32 s4, s4, 10
    s_mul_i32 s5, s4, 5
    s_sub_u32 s5, s3, s5
    s_lshl_b32 s5, s5, 5
    s_add_u32 s4, s4, s5
    s_sub_u32 s4, s4, s32
    s_lshl_b32 s72, s4, 10
    s_add_u32 s3, s32, 16
    s_mul_i32 s4, s3, 205
    s_lshr_b32 s4, s4, 10
    s_mul_i32 s5, s4, 5
    s_sub_u32 s5, s3, s5
    s_lshl_b32 s5, s5, 5
    s_add_u32 s4, s4, s5
    s_sub_u32 s4, s4, s32
    s_lshl_b32 s73, s4, 10
    s_add_u32 s3, s32, 32
    s_mul_i32 s4, s3, 205
    s_lshr_b32 s4, s4, 10
    s_mul_i32 s5, s4, 5
    s_sub_u32 s5, s3, s5
    s_lshl_b32 s5, s5, 5
    s_add_u32 s4, s4, s5
    s_sub_u32 s4, s4, s32
    s_lshl_b32 s85, s4, 10
    s_add_u32 s3, s32, 48
    s_mul_i32 s4, s3, 205
    s_lshr_b32 s4, s4, 10
    s_mul_i32 s5, s4, 5
    s_sub_u32 s5, s3, s5
    s_lshl_b32 s5, s5, 5
    s_add_u32 s4, s4, s5
    s_sub_u32 s4, s4, s32
    s_lshl_b32 s91, s4, 10
    s_add_u32 s3, s32, 64
    s_mul_i32 s4, s3, 205
    s_lshr_b32 s4, s4, 10
    s_mul_i32 s5, s4, 5
    s_sub_u32 s5, s3, s5
    s_lshl_b32 s5, s5, 5
    s_add_u32 s4, s4, s5
    s_sub_u32 s4, s4, s32
    s_lshl_b32 s93, s4, 10
    s_mov_b32 s80, s86
    s_mov_b32 s81, s87
    s_mov_b32 s82, 0x4e2000
    s_mov_b32 s83, 0x20000
    s_mul_i32 s35, s2, 173056
    s_and_b32 s37, s32, 3
    s_lshl_b32 s37, s37, 3
    s_mov_b32 s36, s37
    s_lshr_b32 s37, s32, 2
    s_mul_i32 s37, s37, 2080
    s_add_u32 s36, s36, s37
    s_and_b32 s37, s2, 3
    s_lshl_b32 s37, s37, 5
    s_add_u32 s36, s36, s37
    s_mul_i32 s4, s2, 5
    s_add_u32 s4, s4, 8192
    s_lshl_b32 s38, s4, 14
    s_lshl_b32 s39, s4, 13
    v_mov_b32 v2, 1
    v_mov_b32 v4, 0x80000007
    v_mov_b32 v5, 0xfc
    v_mov_b32 v6, 0x78
    s_mov_b32 s40, 16512
    s_mov_b32 s55, -10000
    s_mov_b32 s41, 0x010c0c01
    s_mov_b32 s42, 0x030c0c03
    v_mov_b32 v8, 0
    v_mov_b32 v9, 0
    v_mov_b32 v10, 0
    v_mov_b32 v11, 0
    ds_write_b128 v0, v[8:11]
    s_add_u32 s60, s30, 0xebd6000
    s_addc_u32 s61, s31, 0
    s_mov_b32 s62, 0x8000
    s_mov_b32 s63, 0x20000
    s_mov_b64 s[66:67], s[56:57]
    s_lshl_b32 s57, s2, 7
    s_add_u32 s68, s30, 0xebce000
    s_addc_u32 s69, s31, 0
    s_mov_b32 s70, 0x80
    s_mov_b32 s71, 0x20000
    s_lshl_b32 s3, s2, 7
    s_add_u32 s68, s68, s3
    s_addc_u32 s69, s69, 0
    s_cmp_lg_u32 s32, 0
    s_cbranch_scc1 L1_fl
    buffer_store_dwordx4 v[8:11], v0, s[68:71], 0 offen sc1
    s_mov_b64 exec, 0xff
    buffer_store_dwordx4 v[8:11], v0, s[60:63], s57 offen sc1
    s_mov_b64 exec, -1
    buffer_inv sc1
L1_fl:
    s_waitcnt lgkmcnt(0)
    s_barrier
    s_setprio 3
    s_add_u32 s46, s99, 0xc00000
    buffer_load_dwordx4 v[48:51], v0, s[8:11], s46 offen nt
    s_add_u32 s47, s99, 0xc00000
    buffer_load_dwordx4 v[52:55], v0, s[12:15], s47 offen nt
    s_waitcnt vmcnt(8)
    v_lshlrev_b32 v7, 16, v24
    v_and_b32 v8, 0xffff0000, v24
    v_lshlrev_b32 v9, 16, v25
    v_and_b32 v10, 0xffff0000, v25
    v_mul_f32 v7, 0.15915494, v7
    v_mul_f32 v8, 0.15915494, v8
    v_mul_f32 v9, 0.15915494, v9
    v_mul_f32 v10, 0.15915494, v10
    v_mul_hi_u32_u24 v14, 429497, v16
    v_lshrrev_b32 v12, 3, v20
    v_cos_f32 v7, v7
    v_lshlrev_b16 v13, 3, v20
    v_mad_i32_i24 v11, v14, s55, v16
    v_bitop3_b32 v12, v6, v13, v12 bitop3:0xca
    v_lshl_add_u32 v11, v11, 17, s40
    v_lshlrev_b16 v14, 8, v14
    v_lshrrev_b32 v13, 2, v20
    v_add_u32 v16, v12, v11
    v_bitop3_b32 v20, v5, v13, v14 bitop3:0xea
    ds_add_u32 v20, v2
    v_mul_hi_u32_u24 v14, 429497, v17
    v_lshrrev_b32 v12, 3, v21
    v_cos_f32 v8, v8
    v_lshlrev_b16 v13, 3, v21
    v_mad_i32_i24 v11, v14, s55, v17
    v_bitop3_b32 v12, v6, v13, v12 bitop3:0xca
    v_lshl_add_u32 v11, v11, 17, s40
    v_lshlrev_b16 v14, 8, v14
    v_lshrrev_b32 v13, 2, v21
    v_add_u32 v17, v12, v11
    v_bitop3_b32 v21, v5, v13, v14 bitop3:0xea
    ds_add_u32 v21, v2
    v_cvt_pk_bf16_f32 v24, v7, v8
    v_perm_b32 v12, v24, v24, s41
    v_bitop3_b32 v16, v4, v12, v16 bitop3:0xca
    v_perm_b32 v13, v24, v24, s42
    v_bitop3_b32 v17, v4, v13, v17 bitop3:0xca
    v_mul_hi_u32_u24 v14, 429497, v18
    v_lshrrev_b32 v12, 3, v22
    v_cos_f32 v9, v9
    v_lshlrev_b16 v13, 3, v22
    v_mad_i32_i24 v11, v14, s55, v18
    v_bitop3_b32 v12, v6, v13, v12 bitop3:0xca
    v_lshl_add_u32 v11, v11, 17, s40
    v_lshlrev_b16 v14, 8, v14
    v_lshrrev_b32 v13, 2, v22
    v_add_u32 v18, v12, v11
    v_bitop3_b32 v22, v5, v13, v14 bitop3:0xea
    ds_add_u32 v22, v2
    v_mul_hi_u32_u24 v14, 429497, v19
    v_lshrrev_b32 v12, 3, v23
    v_cos_f32 v10, v10
    v_lshlrev_b16 v13, 3, v23
    v_mad_i32_i24 v11, v14, s55, v19
    v_bitop3_b32 v12, v6, v13, v12 bitop3:0xca
    v_lshl_add_u32 v11, v11, 17, s40
    v_lshlrev_b16 v14, 8, v14
    v_lshrrev_b32 v13, 2, v23
    v_add_u32 v19, v12, v11
    v_bitop3_b32 v23, v5, v13, v14 bitop3:0xea
    ds_add_u32 v23, v2
    v_cvt_pk_bf16_f32 v25, v9, v10
    v_perm_b32 v12, v25, v25, s41
    v_bitop3_b32 v18, v4, v12, v18 bitop3:0xca
    v_perm_b32 v13, v25, v25, s42
    v_bitop3_b32 v19, v4, v13, v19 bitop3:0xca
    s_add_u32 s44, s96, 0x1000000
    buffer_load_dwordx4 v[56:59], v0, s[8:11], s44 offen nt
    s_add_u32 s45, s96, 0x1000000
    buffer_load_dwordx4 v[60:63], v0, s[12:15], s45 offen nt
    s_add_u32 s46, s96, 0x1000000
    s_lshr_b32 s46, s46, 1
    buffer_load_dwordx2 v[64:65], v1, s[16:19], s46 offen nt
    s_add_u32 s47, s97, 0x1400000
    s_lshr_b32 s47, s47, 1
    buffer_load_dwordx2 v[66:67], v1, s[16:19], s47 offen nt
    s_waitcnt vmcnt(10)
    v_lshlrev_b32 v7, 16, v26
    v_and_b32 v8, 0xffff0000, v26
    v_lshlrev_b32 v9, 16, v27
    v_and_b32 v10, 0xffff0000, v27
    v_mul_f32 v7, 0.15915494, v7
    v_mul_f32 v8, 0.15915494, v8
    v_mul_f32 v9, 0.15915494, v9
    v_mul_f32 v10, 0.15915494, v10
    v_mul_hi_u32_u24 v14, 429497, v28
    v_lshrrev_b32 v12, 3, v32
    v_cos_f32 v7, v7
    v_lshlrev_b16 v13, 3, v32
    v_mad_i32_i24 v11, v14, s55, v28
    v_bitop3_b32 v12, v6, v13, v12 bitop3:0xca
    v_lshl_add_u32 v11, v11, 17, s40
    v_lshlrev_b16 v14, 8, v14
    v_lshrrev_b32 v13, 2, v32
    v_add_u32 v28, v12, v11
    v_bitop3_b32 v32, v5, v13, v14 bitop3:0xea
    ds_add_u32 v32, v2
    v_mul_hi_u32_u24 v14, 429497, v29
    v_lshrrev_b32 v12, 3, v33
    v_cos_f32 v8, v8
    v_lshlrev_b16 v13, 3, v33
    v_mad_i32_i24 v11, v14, s55, v29
    v_bitop3_b32 v12, v6, v13, v12 bitop3:0xca
    v_lshl_add_u32 v11, v11, 17, s40
    v_lshlrev_b16 v14, 8, v14
    v_lshrrev_b32 v13, 2, v33
    v_add_u32 v29, v12, v11
    v_bitop3_b32 v33, v5, v13, v14 bitop3:0xea
    ds_add_u32 v33, v2
    v_cvt_pk_bf16_f32 v26, v7, v8
    v_perm_b32 v12, v26, v26, s41
    v_bitop3_b32 v28, v4, v12, v28 bitop3:0xca
    v_perm_b32 v13, v26, v26, s42
    v_bitop3_b32 v29, v4, v13, v29 bitop3:0xca
    v_mul_hi_u32_u24 v14, 429497, v30
    v_lshrrev_b32 v12, 3, v34
    v_cos_f32 v9, v9
    v_lshlrev_b16 v13, 3, v34
    v_mad_i32_i24 v11, v14, s55, v30
    v_bitop3_b32 v12, v6, v13, v12 bitop3:0xca
    v_lshl_add_u32 v11, v11, 17, s40
    v_lshlrev_b16 v14, 8, v14
    v_lshrrev_b32 v13, 2, v34
    v_add_u32 v30, v12, v11
    v_bitop3_b32 v34, v5, v13, v14 bitop3:0xea
    ds_add_u32 v34, v2
    v_mul_hi_u32_u24 v14, 429497, v31
    v_lshrrev_b32 v12, 3, v35
    v_cos_f32 v10, v10
    v_lshlrev_b16 v13, 3, v35
    v_mad_i32_i24 v11, v14, s55, v31
    v_bitop3_b32 v12, v6, v13, v12 bitop3:0xca
    v_lshl_add_u32 v11, v11, 17, s40
    v_lshlrev_b16 v14, 8, v14
    v_lshrrev_b32 v13, 2, v35
    v_add_u32 v31, v12, v11
    v_bitop3_b32 v35, v5, v13, v14 bitop3:0xea
    ds_add_u32 v35, v2
    v_cvt_pk_bf16_f32 v27, v9, v10
    v_perm_b32 v12, v27, v27, s41
    v_bitop3_b32 v30, v4, v12, v30 bitop3:0xca
    v_perm_b32 v13, v27, v27, s42
    v_bitop3_b32 v31, v4, v13, v31 bitop3:0xca
    s_setprio 2
    s_add_u32 s44, s97, 0x1400000
    buffer_load_dwordx4 v[68:71], v0, s[8:11], s44 offen nt
    s_add_u32 s45, s97, 0x1400000
    buffer_load_dwordx4 v[72:75], v0, s[12:15], s45 offen nt
    s_waitcnt vmcnt(8)
    v_lshlrev_b32 v7, 16, v44
    v_and_b32 v8, 0xffff0000, v44
    v_lshlrev_b32 v9, 16, v45
    v_and_b32 v10, 0xffff0000, v45
    v_mul_f32 v7, 0.15915494, v7
    v_mul_f32 v8, 0.15915494, v8
    v_mul_f32 v9, 0.15915494, v9
    v_mul_f32 v10, 0.15915494, v10
    v_mul_hi_u32_u24 v14, 429497, v36
    v_lshrrev_b32 v12, 3, v40
    v_cos_f32 v7, v7
    v_lshlrev_b16 v13, 3, v40
    v_mad_i32_i24 v11, v14, s55, v36
    v_bitop3_b32 v12, v6, v13, v12 bitop3:0xca
    v_lshl_add_u32 v11, v11, 17, s40
    v_lshlrev_b16 v14, 8, v14
    v_lshrrev_b32 v13, 2, v40
    v_add_u32 v36, v12, v11
    v_bitop3_b32 v40, v5, v13, v14 bitop3:0xea
    ds_add_u32 v40, v2
    v_mul_hi_u32_u24 v14, 429497, v37
    v_lshrrev_b32 v12, 3, v41
    v_cos_f32 v8, v8
    v_lshlrev_b16 v13, 3, v41
    v_mad_i32_i24 v11, v14, s55, v37
    v_bitop3_b32 v12, v6, v13, v12 bitop3:0xca
    v_lshl_add_u32 v11, v11, 17, s40
    v_lshlrev_b16 v14, 8, v14
    v_lshrrev_b32 v13, 2, v41
    v_add_u32 v37, v12, v11
    v_bitop3_b32 v41, v5, v13, v14 bitop3:0xea
    ds_add_u32 v41, v2
    v_cvt_pk_bf16_f32 v44, v7, v8
    v_perm_b32 v12, v44, v44, s41
    v_bitop3_b32 v36, v4, v12, v36 bitop3:0xca
    v_perm_b32 v13, v44, v44, s42
    v_bitop3_b32 v37, v4, v13, v37 bitop3:0xca
    v_mul_hi_u32_u24 v14, 429497, v38
    v_lshrrev_b32 v12, 3, v42
    v_cos_f32 v9, v9
    v_lshlrev_b16 v13, 3, v42
    v_mad_i32_i24 v11, v14, s55, v38
    v_bitop3_b32 v12, v6, v13, v12 bitop3:0xca
    v_lshl_add_u32 v11, v11, 17, s40
    v_lshlrev_b16 v14, 8, v14
    v_lshrrev_b32 v13, 2, v42
    v_add_u32 v38, v12, v11
    v_bitop3_b32 v42, v5, v13, v14 bitop3:0xea
    ds_add_u32 v42, v2
    v_mul_hi_u32_u24 v14, 429497, v39
    v_lshrrev_b32 v12, 3, v43
    v_cos_f32 v10, v10
    v_lshlrev_b16 v13, 3, v43
    v_mad_i32_i24 v11, v14, s55, v39
    v_bitop3_b32 v12, v6, v13, v12 bitop3:0xca
    v_lshl_add_u32 v11, v11, 17, s40
    v_lshlrev_b16 v14, 8, v14
    v_lshrrev_b32 v13, 2, v43
    v_add_u32 v39, v12, v11
    v_bitop3_b32 v43, v5, v13, v14 bitop3:0xea
    ds_add_u32 v43, v2
    v_cvt_pk_bf16_f32 v45, v9, v10
    v_perm_b32 v12, v45, v45, s41
    v_bitop3_b32 v38, v4, v12, v38 bitop3:0xca
    v_perm_b32 v13, v45, v45, s42
    v_bitop3_b32 v39, v4, v13, v39 bitop3:0xca
    s_add_u32 s46, s98, 0x1800000
    buffer_load_dwordx4 v[76:79], v0, s[8:11], s46 offen nt
    s_add_u32 s47, s98, 0x1800000
    buffer_load_dwordx4 v[80:83], v0, s[12:15], s47 offen nt
    s_add_u32 s44, s98, 0x1800000
    s_lshr_b32 s44, s44, 1
    buffer_load_dwordx2 v[84:85], v1, s[16:19], s44 offen nt
    s_add_u32 s45, s99, 0x1c00000
    s_lshr_b32 s45, s45, 1
    buffer_load_dwordx2 v[86:87], v1, s[16:19], s45 offen nt
    s_waitcnt vmcnt(10)
    v_lshlrev_b32 v7, 16, v46
    v_and_b32 v8, 0xffff0000, v46
    v_lshlrev_b32 v9, 16, v47
    v_and_b32 v10, 0xffff0000, v47
    v_mul_f32 v7, 0.15915494, v7
    v_mul_f32 v8, 0.15915494, v8
    v_mul_f32 v9, 0.15915494, v9
    v_mul_f32 v10, 0.15915494, v10
    v_mul_hi_u32_u24 v14, 429497, v48
    v_lshrrev_b32 v12, 3, v52
    v_cos_f32 v7, v7
    v_lshlrev_b16 v13, 3, v52
    v_mad_i32_i24 v11, v14, s55, v48
    v_bitop3_b32 v12, v6, v13, v12 bitop3:0xca
    v_lshl_add_u32 v11, v11, 17, s40
    v_lshlrev_b16 v14, 8, v14
    v_lshrrev_b32 v13, 2, v52
    v_add_u32 v48, v12, v11
    v_bitop3_b32 v52, v5, v13, v14 bitop3:0xea
    ds_add_u32 v52, v2
    v_mul_hi_u32_u24 v14, 429497, v49
    v_lshrrev_b32 v12, 3, v53
    v_cos_f32 v8, v8
    v_lshlrev_b16 v13, 3, v53
    v_mad_i32_i24 v11, v14, s55, v49
    v_bitop3_b32 v12, v6, v13, v12 bitop3:0xca
    v_lshl_add_u32 v11, v11, 17, s40
    v_lshlrev_b16 v14, 8, v14
    v_lshrrev_b32 v13, 2, v53
    v_add_u32 v49, v12, v11
    v_bitop3_b32 v53, v5, v13, v14 bitop3:0xea
    ds_add_u32 v53, v2
    v_cvt_pk_bf16_f32 v46, v7, v8
    v_perm_b32 v12, v46, v46, s41
    v_bitop3_b32 v48, v4, v12, v48 bitop3:0xca
    v_perm_b32 v13, v46, v46, s42
    v_bitop3_b32 v49, v4, v13, v49 bitop3:0xca
    v_mul_hi_u32_u24 v14, 429497, v50
    v_lshrrev_b32 v12, 3, v54
    v_cos_f32 v9, v9
    v_lshlrev_b16 v13, 3, v54
    v_mad_i32_i24 v11, v14, s55, v50
    v_bitop3_b32 v12, v6, v13, v12 bitop3:0xca
    v_lshl_add_u32 v11, v11, 17, s40
    v_lshlrev_b16 v14, 8, v14
    v_lshrrev_b32 v13, 2, v54
    v_add_u32 v50, v12, v11
    v_bitop3_b32 v54, v5, v13, v14 bitop3:0xea
    ds_add_u32 v54, v2
    v_mul_hi_u32_u24 v14, 429497, v51
    v_lshrrev_b32 v12, 3, v55
    v_cos_f32 v10, v10
    v_lshlrev_b16 v13, 3, v55
    v_mad_i32_i24 v11, v14, s55, v51
    v_bitop3_b32 v12, v6, v13, v12 bitop3:0xca
    v_lshl_add_u32 v11, v11, 17, s40
    v_lshlrev_b16 v14, 8, v14
    v_lshrrev_b32 v13, 2, v55
    v_add_u32 v51, v12, v11
    v_bitop3_b32 v55, v5, v13, v14 bitop3:0xea
    ds_add_u32 v55, v2
    v_cvt_pk_bf16_f32 v47, v9, v10
    v_perm_b32 v12, v47, v47, s41
    v_bitop3_b32 v50, v4, v12, v50 bitop3:0xca
    v_perm_b32 v13, v47, v47, s42
    v_bitop3_b32 v51, v4, v13, v51 bitop3:0xca
    s_setprio 1
    s_add_u32 s46, s99, 0x1c00000
    buffer_load_dwordx4 v[88:91], v0, s[8:11], s46 offen nt
    s_add_u32 s47, s99, 0x1c00000
    buffer_load_dwordx4 v[92:95], v0, s[12:15], s47 offen nt
    s_waitcnt vmcnt(8)
    v_lshlrev_b32 v7, 16, v64
    v_and_b32 v8, 0xffff0000, v64
    v_lshlrev_b32 v9, 16, v65
    v_and_b32 v10, 0xffff0000, v65
    v_mul_f32 v7, 0.15915494, v7
    v_mul_f32 v8, 0.15915494, v8
    v_mul_f32 v9, 0.15915494, v9
    v_mul_f32 v10, 0.15915494, v10
    v_mul_hi_u32_u24 v14, 429497, v56
    v_lshrrev_b32 v12, 3, v60
    v_cos_f32 v7, v7
    v_lshlrev_b16 v13, 3, v60
    v_mad_i32_i24 v11, v14, s55, v56
    v_bitop3_b32 v12, v6, v13, v12 bitop3:0xca
    v_lshl_add_u32 v11, v11, 17, s40
    v_lshlrev_b16 v14, 8, v14
    v_lshrrev_b32 v13, 2, v60
    v_add_u32 v56, v12, v11
    v_bitop3_b32 v60, v5, v13, v14 bitop3:0xea
    ds_add_u32 v60, v2
    v_mul_hi_u32_u24 v14, 429497, v57
    v_lshrrev_b32 v12, 3, v61
    v_cos_f32 v8, v8
    v_lshlrev_b16 v13, 3, v61
    v_mad_i32_i24 v11, v14, s55, v57
    v_bitop3_b32 v12, v6, v13, v12 bitop3:0xca
    v_lshl_add_u32 v11, v11, 17, s40
    v_lshlrev_b16 v14, 8, v14
    v_lshrrev_b32 v13, 2, v61
    v_add_u32 v57, v12, v11
    v_bitop3_b32 v61, v5, v13, v14 bitop3:0xea
    ds_add_u32 v61, v2
    v_cvt_pk_bf16_f32 v64, v7, v8
    v_perm_b32 v12, v64, v64, s41
    v_bitop3_b32 v56, v4, v12, v56 bitop3:0xca
    v_perm_b32 v13, v64, v64, s42
    v_bitop3_b32 v57, v4, v13, v57 bitop3:0xca
    v_mul_hi_u32_u24 v14, 429497, v58
    v_lshrrev_b32 v12, 3, v62
    v_cos_f32 v9, v9
    v_lshlrev_b16 v13, 3, v62
    v_mad_i32_i24 v11, v14, s55, v58
    v_bitop3_b32 v12, v6, v13, v12 bitop3:0xca
    v_lshl_add_u32 v11, v11, 17, s40
    v_lshlrev_b16 v14, 8, v14
    v_lshrrev_b32 v13, 2, v62
    v_add_u32 v58, v12, v11
    v_bitop3_b32 v62, v5, v13, v14 bitop3:0xea
    ds_add_u32 v62, v2
    v_mul_hi_u32_u24 v14, 429497, v59
    v_lshrrev_b32 v12, 3, v63
    v_cos_f32 v10, v10
    v_lshlrev_b16 v13, 3, v63
    v_mad_i32_i24 v11, v14, s55, v59
    v_bitop3_b32 v12, v6, v13, v12 bitop3:0xca
    v_lshl_add_u32 v11, v11, 17, s40
    v_lshlrev_b16 v14, 8, v14
    v_lshrrev_b32 v13, 2, v63
    v_add_u32 v59, v12, v11
    v_bitop3_b32 v63, v5, v13, v14 bitop3:0xea
    ds_add_u32 v63, v2
    v_cvt_pk_bf16_f32 v65, v9, v10
    v_perm_b32 v12, v65, v65, s41
    v_bitop3_b32 v58, v4, v12, v58 bitop3:0xca
    v_perm_b32 v13, v65, v65, s42
    v_bitop3_b32 v59, v4, v13, v59 bitop3:0xca
    s_add_u32 s44, s96, 0x2000000
    buffer_load_dwordx4 v[96:99], v0, s[8:11], s44 offen nt
    s_add_u32 s45, s96, 0x2000000
    buffer_load_dwordx4 v[104:107], v0, s[12:15], s45 offen nt
    s_add_u32 s46, s96, 0x2000000
    s_lshr_b32 s46, s46, 1
    buffer_load_dwordx2 v[108:109], v1, s[16:19], s46 offen nt
    s_add_u32 s47, s97, 0x2400000
    s_lshr_b32 s47, s47, 1
    buffer_load_dwordx2 v[110:111], v1, s[16:19], s47 offen nt
    s_waitcnt vmcnt(10)
    v_lshlrev_b32 v7, 16, v66
    v_and_b32 v8, 0xffff0000, v66
    v_lshlrev_b32 v9, 16, v67
    v_and_b32 v10, 0xffff0000, v67
    v_mul_f32 v7, 0.15915494, v7
    v_mul_f32 v8, 0.15915494, v8
    v_mul_f32 v9, 0.15915494, v9
    v_mul_f32 v10, 0.15915494, v10
    v_mul_hi_u32_u24 v14, 429497, v68
    v_lshrrev_b32 v12, 3, v72
    v_cos_f32 v7, v7
    v_lshlrev_b16 v13, 3, v72
    v_mad_i32_i24 v11, v14, s55, v68
    v_bitop3_b32 v12, v6, v13, v12 bitop3:0xca
    v_lshl_add_u32 v11, v11, 17, s40
    v_lshlrev_b16 v14, 8, v14
    v_lshrrev_b32 v13, 2, v72
    v_add_u32 v68, v12, v11
    v_bitop3_b32 v72, v5, v13, v14 bitop3:0xea
    ds_add_u32 v72, v2
    v_mul_hi_u32_u24 v14, 429497, v69
    v_lshrrev_b32 v12, 3, v73
    v_cos_f32 v8, v8
    v_lshlrev_b16 v13, 3, v73
    v_mad_i32_i24 v11, v14, s55, v69
    v_bitop3_b32 v12, v6, v13, v12 bitop3:0xca
    v_lshl_add_u32 v11, v11, 17, s40
    v_lshlrev_b16 v14, 8, v14
    v_lshrrev_b32 v13, 2, v73
    v_add_u32 v69, v12, v11
    v_bitop3_b32 v73, v5, v13, v14 bitop3:0xea
    ds_add_u32 v73, v2
    v_cvt_pk_bf16_f32 v66, v7, v8
    v_perm_b32 v12, v66, v66, s41
    v_bitop3_b32 v68, v4, v12, v68 bitop3:0xca
    v_perm_b32 v13, v66, v66, s42
    v_bitop3_b32 v69, v4, v13, v69 bitop3:0xca
    v_mul_hi_u32_u24 v14, 429497, v70
    v_lshrrev_b32 v12, 3, v74
    v_cos_f32 v9, v9
    v_lshlrev_b16 v13, 3, v74
    v_mad_i32_i24 v11, v14, s55, v70
    v_bitop3_b32 v12, v6, v13, v12 bitop3:0xca
    v_lshl_add_u32 v11, v11, 17, s40
    v_lshlrev_b16 v14, 8, v14
    v_lshrrev_b32 v13, 2, v74
    v_add_u32 v70, v12, v11
    v_bitop3_b32 v74, v5, v13, v14 bitop3:0xea
    ds_add_u32 v74, v2
    v_mul_hi_u32_u24 v14, 429497, v71
    v_lshrrev_b32 v12, 3, v75
    v_cos_f32 v10, v10
    v_lshlrev_b16 v13, 3, v75
    v_mad_i32_i24 v11, v14, s55, v71
    v_bitop3_b32 v12, v6, v13, v12 bitop3:0xca
    v_lshl_add_u32 v11, v11, 17, s40
    v_lshlrev_b16 v14, 8, v14
    v_lshrrev_b32 v13, 2, v75
    v_add_u32 v71, v12, v11
    v_bitop3_b32 v75, v5, v13, v14 bitop3:0xea
    ds_add_u32 v75, v2
    v_cvt_pk_bf16_f32 v67, v9, v10
    v_perm_b32 v12, v67, v67, s41
    v_bitop3_b32 v70, v4, v12, v70 bitop3:0xca
    v_perm_b32 v13, v67, v67, s42
    v_bitop3_b32 v71, v4, v13, v71 bitop3:0xca
    s_setprio 0
    s_add_u32 s44, s97, 0x2400000
    buffer_load_dwordx4 v[112:115], v0, s[8:11], s44 offen nt
    s_waitcnt vmcnt(7)
    v_lshlrev_b32 v7, 16, v84
    v_and_b32 v8, 0xffff0000, v84
    v_lshlrev_b32 v9, 16, v85
    v_and_b32 v10, 0xffff0000, v85
    v_mul_f32 v7, 0.15915494, v7
    v_mul_f32 v8, 0.15915494, v8
    v_mul_f32 v9, 0.15915494, v9
    v_mul_f32 v10, 0.15915494, v10
    v_mul_hi_u32_u24 v14, 429497, v76
    v_lshrrev_b32 v12, 3, v80
    v_cos_f32 v7, v7
    v_lshlrev_b16 v13, 3, v80
    v_mad_i32_i24 v11, v14, s55, v76
    v_bitop3_b32 v12, v6, v13, v12 bitop3:0xca
    v_lshl_add_u32 v11, v11, 17, s40
    v_lshlrev_b16 v14, 8, v14
    v_lshrrev_b32 v13, 2, v80
    v_add_u32 v76, v12, v11
    v_bitop3_b32 v80, v5, v13, v14 bitop3:0xea
    ds_add_u32 v80, v2
    v_mul_hi_u32_u24 v14, 429497, v77
    v_lshrrev_b32 v12, 3, v81
    v_cos_f32 v8, v8
    v_lshlrev_b16 v13, 3, v81
    v_mad_i32_i24 v11, v14, s55, v77
    v_bitop3_b32 v12, v6, v13, v12 bitop3:0xca
    v_lshl_add_u32 v11, v11, 17, s40
    v_lshlrev_b16 v14, 8, v14
    v_lshrrev_b32 v13, 2, v81
    v_add_u32 v77, v12, v11
    v_bitop3_b32 v81, v5, v13, v14 bitop3:0xea
    ds_add_u32 v81, v2
    v_cvt_pk_bf16_f32 v84, v7, v8
    v_perm_b32 v12, v84, v84, s41
    v_bitop3_b32 v76, v4, v12, v76 bitop3:0xca
    v_perm_b32 v13, v84, v84, s42
    v_bitop3_b32 v77, v4, v13, v77 bitop3:0xca
    v_mul_hi_u32_u24 v14, 429497, v78
    v_lshrrev_b32 v12, 3, v82
    v_cos_f32 v9, v9
    v_lshlrev_b16 v13, 3, v82
    v_mad_i32_i24 v11, v14, s55, v78
    v_bitop3_b32 v12, v6, v13, v12 bitop3:0xca
    v_lshl_add_u32 v11, v11, 17, s40
    v_lshlrev_b16 v14, 8, v14
    v_lshrrev_b32 v13, 2, v82
    v_add_u32 v78, v12, v11
    v_bitop3_b32 v82, v5, v13, v14 bitop3:0xea
    ds_add_u32 v82, v2
    v_mul_hi_u32_u24 v14, 429497, v79
    v_lshrrev_b32 v12, 3, v83
    v_cos_f32 v10, v10
    v_lshlrev_b16 v13, 3, v83
    v_mad_i32_i24 v11, v14, s55, v79
    v_bitop3_b32 v12, v6, v13, v12 bitop3:0xca
    v_lshl_add_u32 v11, v11, 17, s40
    v_lshlrev_b16 v14, 8, v14
    v_lshrrev_b32 v13, 2, v83
    v_add_u32 v79, v12, v11
    v_bitop3_b32 v83, v5, v13, v14 bitop3:0xea
    ds_add_u32 v83, v2
    v_cvt_pk_bf16_f32 v85, v9, v10
    v_perm_b32 v12, v85, v85, s41
    v_bitop3_b32 v78, v4, v12, v78 bitop3:0xca
    v_perm_b32 v13, v85, v85, s42
    v_bitop3_b32 v79, v4, v13, v79 bitop3:0xca
    s_waitcnt vmcnt(5)
    v_lshlrev_b32 v7, 16, v86
    v_and_b32 v8, 0xffff0000, v86
    v_lshlrev_b32 v9, 16, v87
    v_and_b32 v10, 0xffff0000, v87
    v_mul_f32 v7, 0.15915494, v7
    v_mul_f32 v8, 0.15915494, v8
    v_mul_f32 v9, 0.15915494, v9
    v_mul_f32 v10, 0.15915494, v10
    v_mul_hi_u32_u24 v14, 429497, v88
    v_lshrrev_b32 v12, 3, v92
    v_cos_f32 v7, v7
    v_lshlrev_b16 v13, 3, v92
    v_mad_i32_i24 v11, v14, s55, v88
    v_bitop3_b32 v12, v6, v13, v12 bitop3:0xca
    v_lshl_add_u32 v11, v11, 17, s40
    v_lshlrev_b16 v14, 8, v14
    v_lshrrev_b32 v13, 2, v92
    v_add_u32 v88, v12, v11
    v_bitop3_b32 v92, v5, v13, v14 bitop3:0xea
    ds_add_u32 v92, v2
    v_mul_hi_u32_u24 v14, 429497, v89
    v_lshrrev_b32 v12, 3, v93
    v_cos_f32 v8, v8
    v_lshlrev_b16 v13, 3, v93
    v_mad_i32_i24 v11, v14, s55, v89
    v_bitop3_b32 v12, v6, v13, v12 bitop3:0xca
    v_lshl_add_u32 v11, v11, 17, s40
    v_lshlrev_b16 v14, 8, v14
    v_lshrrev_b32 v13, 2, v93
    v_add_u32 v89, v12, v11
    v_bitop3_b32 v93, v5, v13, v14 bitop3:0xea
    ds_add_u32 v93, v2
    v_cvt_pk_bf16_f32 v86, v7, v8
    v_perm_b32 v12, v86, v86, s41
    v_bitop3_b32 v88, v4, v12, v88 bitop3:0xca
    v_perm_b32 v13, v86, v86, s42
    v_bitop3_b32 v89, v4, v13, v89 bitop3:0xca
    v_mul_hi_u32_u24 v14, 429497, v90
    v_lshrrev_b32 v12, 3, v94
    v_cos_f32 v9, v9
    v_lshlrev_b16 v13, 3, v94
    v_mad_i32_i24 v11, v14, s55, v90
    v_bitop3_b32 v12, v6, v13, v12 bitop3:0xca
    v_lshl_add_u32 v11, v11, 17, s40
    v_lshlrev_b16 v14, 8, v14
    v_lshrrev_b32 v13, 2, v94
    v_add_u32 v90, v12, v11
    v_bitop3_b32 v94, v5, v13, v14 bitop3:0xea
    ds_add_u32 v94, v2
    v_mul_hi_u32_u24 v14, 429497, v91
    v_lshrrev_b32 v12, 3, v95
    v_cos_f32 v10, v10
    v_lshlrev_b16 v13, 3, v95
    v_mad_i32_i24 v11, v14, s55, v91
    v_bitop3_b32 v12, v6, v13, v12 bitop3:0xca
    v_lshl_add_u32 v11, v11, 17, s40
    v_lshlrev_b16 v14, 8, v14
    v_lshrrev_b32 v13, 2, v95
    v_add_u32 v91, v12, v11
    v_bitop3_b32 v95, v5, v13, v14 bitop3:0xea
    ds_add_u32 v95, v2
    v_cvt_pk_bf16_f32 v87, v9, v10
    v_perm_b32 v12, v87, v87, s41
    v_bitop3_b32 v90, v4, v12, v90 bitop3:0xca
    v_perm_b32 v13, v87, v87, s42
    v_bitop3_b32 v91, v4, v13, v91 bitop3:0xca
    v_lshrrev_b32 v8, 2, v0
    v_and_b32 v7, 0x3c00, v0
    v_bitop3_b32 v7, v5, v8, v7 bitop3:0xea
    s_waitcnt lgkmcnt(0)
    s_barrier
    ds_read2st64_b32 v[8:9], v7 offset0:0 offset1:1
    ds_read2st64_b32 v[10:11], v7 offset0:2 offset1:3
    s_add_u32 s45, s97, 0x2400000
    buffer_load_dwordx4 v[100:103], v0, s[12:15], s45 offen nt
    s_waitcnt lgkmcnt(0)
    v_lshl_or_b32 v12, v9, 16, v8
    v_lshl_or_b32 v13, v11, 16, v10
    v_mov_b32 v14, v12
    v_mov_b32 v15, v13
    s_nop 0
    v_add_u32_dpp v14, v14, v14 row_shr:1 row_mask:0xf bank_mask:0xf bound_ctrl:1
    v_add_u32_dpp v15, v15, v15 row_shr:1 row_mask:0xf bank_mask:0xf bound_ctrl:1
    s_nop 0
    v_add_u32_dpp v14, v14, v14 row_shr:2 row_mask:0xf bank_mask:0xf bound_ctrl:1
    v_add_u32_dpp v15, v15, v15 row_shr:2 row_mask:0xf bank_mask:0xf bound_ctrl:1
    s_nop 0
    v_add_u32_dpp v14, v14, v14 row_shr:4 row_mask:0xf bank_mask:0xf bound_ctrl:1
    v_add_u32_dpp v15, v15, v15 row_shr:4 row_mask:0xf bank_mask:0xf bound_ctrl:1
    s_nop 0
    v_add_u32_dpp v14, v14, v14 row_shr:8 row_mask:0xf bank_mask:0xf bound_ctrl:1
    v_add_u32_dpp v15, v15, v15 row_shr:8 row_mask:0xf bank_mask:0xf bound_ctrl:1
    s_nop 0
    v_add_u32_dpp v14, v14, v14 row_bcast:15 row_mask:0xa bank_mask:0xf
    v_add_u32_dpp v15, v15, v15 row_bcast:15 row_mask:0xa bank_mask:0xf
    s_nop 0
    v_add_u32_dpp v14, v14, v14 row_bcast:31 row_mask:0xc bank_mask:0xf
    v_add_u32_dpp v15, v15, v15 row_bcast:31 row_mask:0xc bank_mask:0xf
    v_readlane_b32 s48, v14, 63
    v_readlane_b32 s49, v15, 63
    s_lshl_b32 s54, s32, 2
    v_mov_b32 v8, s54
    s_and_b32 s50, s48, 0xffff
    s_lshr_b32 s51, s48, 16
    s_and_b32 s52, s49, 0xffff
    s_lshr_b32 s53, s49, 16
    s_add_u32 s51, s51, s50
    s_add_u32 s52, s52, s51
    s_add_u32 s53, s53, s52
    v_mov_b32 v9, s53
    s_mov_b64 exec, 1
    ds_write_b32 v8, v9 offset:16384
    s_mov_b64 exec, -1
    v_and_b32 v8, 60, v7
    s_waitcnt lgkmcnt(0)
    s_barrier
    ds_read_b32 v9, v8 offset:16384
    s_waitcnt lgkmcnt(0)
    v_add_u32_dpp v9, v9, v9 row_shr:1 row_mask:0xf bank_mask:0xf bound_ctrl:1
    s_nop 1
    v_add_u32_dpp v9, v9, v9 row_shr:2 row_mask:0xf bank_mask:0xf bound_ctrl:1
    s_nop 1
    v_add_u32_dpp v9, v9, v9 row_shr:4 row_mask:0xf bank_mask:0xf bound_ctrl:1
    s_nop 1
    v_add_u32_dpp v9, v9, v9 row_shr:8 row_mask:0xf bank_mask:0xf bound_ctrl:1
    s_nop 0
    v_readlane_b32 s54, v9, s32
    s_sub_u32 s54, s54, s53
    s_add_u32 s50, s50, s54
    s_add_u32 s51, s51, s54
    s_add_u32 s52, s52, s54
    s_pack_ll_b32_b16 s48, s54, s50
    s_pack_ll_b32_b16 s49, s51, s52
    v_add_u32 v14, s48, v14
    v_add_u32 v15, s49, v15
    v_sub_u32 v12, v14, v12
    v_sub_u32 v13, v15, v13
    v_and_b32 v8, 0xffff, v12
    v_lshrrev_b32 v9, 16, v12
    v_and_b32 v10, 0xffff, v13
    v_lshrrev_b32 v11, 16, v13
    ds_write2st64_b32 v7, v8, v9 offset0:0 offset1:1
    ds_write2st64_b32 v7, v10, v11 offset0:2 offset1:3
    v_and_b32 v8, 0x3f0, v0
    v_lshl_add_u32 v8, v8, 1, s36
    ds_write_b64 v8, v[12:13] offset:20480
    s_bitset0_b64 exec, 63
    s_not_b64 exec, exec
    ds_write_b64 v8, v[14:15] offset:20512
    s_mov_b64 exec, -1
    s_waitcnt lgkmcnt(0)
    s_barrier
    s_setprio 3
    ds_add_rtn_u32 v20, v20, v2
    ds_add_rtn_u32 v21, v21, v2
    ds_add_rtn_u32 v22, v22, v2
    ds_add_rtn_u32 v23, v23, v2
    ds_read_b128 v[12:15], v0 offset:20480
    v_cmp_gt_u32 vcc, 8448, v0
    ds_add_rtn_u32 v32, v32, v2
    ds_add_rtn_u32 v33, v33, v2
    ds_add_rtn_u32 v34, v34, v2
    ds_add_rtn_u32 v35, v35, v2
    s_setprio 2
    ds_add_rtn_u32 v40, v40, v2
    ds_add_rtn_u32 v41, v41, v2
    ds_add_rtn_u32 v42, v42, v2
    ds_add_rtn_u32 v43, v43, v2
    s_waitcnt lgkmcnt(8)
    s_cbranch_vccz L1_p1
    s_add_u32 s46, s35, 0x0
    s_mov_b64 exec, vcc
    buffer_store_dwordx4 v[12:15], v0, s[24:27], s46 offen sc1
    s_mov_b64 exec, -1
L1_p1:
    s_add_u32 s47, s98, 0x2800000
    buffer_load_dwordx4 v[116:119], v0, s[8:11], s47 offen nt
    ds_add_rtn_u32 v52, v52, v2
    ds_add_rtn_u32 v53, v53, v2
    ds_add_rtn_u32 v54, v54, v2
    ds_add_rtn_u32 v55, v55, v2
    s_setprio 1
    ds_add_rtn_u32 v60, v60, v2
    ds_add_rtn_u32 v61, v61, v2
    ds_add_rtn_u32 v62, v62, v2
    ds_add_rtn_u32 v63, v63, v2
    ds_add_rtn_u32 v72, v72, v2
    ds_add_rtn_u32 v73, v73, v2
    ds_add_rtn_u32 v74, v74, v2
    ds_add_rtn_u32 v75, v75, v2
    s_add_u32 s44, s98, 0x2800000
    buffer_load_dwordx4 v[120:123], v0, s[12:15], s44 offen nt
    s_setprio 0
    ds_add_rtn_u32 v80, v80, v2
    ds_add_rtn_u32 v81, v81, v2
    ds_add_rtn_u32 v82, v82, v2
    ds_add_rtn_u32 v83, v83, v2
    ds_add_rtn_u32 v92, v92, v2
    ds_add_rtn_u32 v93, v93, v2
    ds_add_rtn_u32 v94, v94, v2
    ds_add_rtn_u32 v95, v95, v2
    s_waitcnt lgkmcnt(0)
    s_barrier
    s_setprio 3
    v_and_b32 v7, -4, v20
    v_lshl_add_u32 v8, v20, 2, v7
    ds_write_b32 v8, v16
    v_lshl_add_u32 v7, v7, 2, v20
    ds_write_b8 v7, v24 offset:16
    v_and_b32 v9, -4, v21
    v_lshl_add_u32 v10, v21, 2, v9
    ds_write_b32 v10, v17
    v_lshl_add_u32 v9, v9, 2, v21
    ds_write_b8_d16_hi v9, v24 offset:16
    v_and_b32 v7, -4, v22
    v_lshl_add_u32 v8, v22, 2, v7
    ds_write_b32 v8, v18
    v_lshl_add_u32 v7, v7, 2, v22
    ds_write_b8 v7, v25 offset:16
    v_and_b32 v9, -4, v23
    v_lshl_add_u32 v10, v23, 2, v9
    ds_write_b32 v10, v19
    v_lshl_add_u32 v9, v9, 2, v23
    ds_write_b8_d16_hi v9, v25 offset:16
    s_add_u32 s45, s98, 0x2800000
    s_lshr_b32 s45, s45, 1
    buffer_load_dwordx2 v[124:125], v1, s[16:19], s45 offen nt
    s_add_u32 s46, s99, 0x2c00000
    s_lshr_b32 s46, s46, 1
    buffer_load_dwordx2 v[126:127], v1, s[16:19], s46 offen nt
    s_add_u32 s47, s99, 0x2c00000
    buffer_load_dwordx4 v[16:19], v0, s[8:11], s47 offen nt
    v_and_b32 v7, -4, v32
    v_lshl_add_u32 v8, v32, 2, v7
    ds_write_b32 v8, v28
    v_lshl_add_u32 v7, v7, 2, v32
    ds_write_b8 v7, v26 offset:16
    v_and_b32 v9, -4, v33
    v_lshl_add_u32 v10, v33, 2, v9
    ds_write_b32 v10, v29
    v_lshl_add_u32 v9, v9, 2, v33
    ds_write_b8_d16_hi v9, v26 offset:16
    v_and_b32 v7, -4, v34
    v_lshl_add_u32 v8, v34, 2, v7
    ds_write_b32 v8, v30
    v_lshl_add_u32 v7, v7, 2, v34
    ds_write_b8 v7, v27 offset:16
    v_and_b32 v9, -4, v35
    v_lshl_add_u32 v10, v35, 2, v9
    ds_write_b32 v10, v31
    v_lshl_add_u32 v9, v9, 2, v35
    ds_write_b8_d16_hi v9, v27 offset:16
    s_add_u32 s44, s99, 0x2c00000
    buffer_load_dwordx4 v[20:23], v0, s[12:15], s44 offen nt
    s_setprio 2
    v_and_b32 v7, -4, v40
    v_lshl_add_u32 v8, v40, 2, v7
    ds_write_b32 v8, v36
    v_lshl_add_u32 v7, v7, 2, v40
    ds_write_b8 v7, v44 offset:16
    v_and_b32 v9, -4, v41
    v_lshl_add_u32 v10, v41, 2, v9
    ds_write_b32 v10, v37
    v_lshl_add_u32 v9, v9, 2, v41
    ds_write_b8_d16_hi v9, v44 offset:16
    v_and_b32 v7, -4, v42
    v_lshl_add_u32 v8, v42, 2, v7
    ds_write_b32 v8, v38
    v_lshl_add_u32 v7, v7, 2, v42
    ds_write_b8 v7, v45 offset:16
    v_and_b32 v9, -4, v43
    v_lshl_add_u32 v10, v43, 2, v9
    ds_write_b32 v10, v39
    v_lshl_add_u32 v9, v9, 2, v43
    ds_write_b8_d16_hi v9, v45 offset:16
    s_add_u32 s45, s96, 0x3000000
    buffer_load_dwordx4 v[28:31], v0, s[8:11], s45 offen nt
    s_add_u32 s46, s96, 0x3000000
    buffer_load_dwordx4 v[32:35], v0, s[12:15], s46 offen nt
    v_and_b32 v7, -4, v52
    v_lshl_add_u32 v8, v52, 2, v7
    ds_write_b32 v8, v48
    v_lshl_add_u32 v7, v7, 2, v52
    ds_write_b8 v7, v46 offset:16
    v_and_b32 v9, -4, v53
    v_lshl_add_u32 v10, v53, 2, v9
    ds_write_b32 v10, v49
    v_lshl_add_u32 v9, v9, 2, v53
    ds_write_b8_d16_hi v9, v46 offset:16
    v_and_b32 v7, -4, v54
    v_lshl_add_u32 v8, v54, 2, v7
    ds_write_b32 v8, v50
    v_lshl_add_u32 v7, v7, 2, v54
    ds_write_b8 v7, v47 offset:16
    v_and_b32 v9, -4, v55
    v_lshl_add_u32 v10, v55, 2, v9
    ds_write_b32 v10, v51
    v_lshl_add_u32 v9, v9, 2, v55
    ds_write_b8_d16_hi v9, v47 offset:16
    s_add_u32 s47, s96, 0x3000000
    s_lshr_b32 s47, s47, 1
    buffer_load_dwordx2 v[24:25], v1, s[16:19], s47 offen nt
    s_add_u32 s44, s97, 0x3400000
    s_lshr_b32 s44, s44, 1
    buffer_load_dwordx2 v[26:27], v1, s[16:19], s44 offen nt
    s_setprio 1
    v_and_b32 v7, -4, v60
    v_lshl_add_u32 v8, v60, 2, v7
    ds_write_b32 v8, v56
    v_lshl_add_u32 v7, v7, 2, v60
    ds_write_b8 v7, v64 offset:16
    v_and_b32 v9, -4, v61
    v_lshl_add_u32 v10, v61, 2, v9
    ds_write_b32 v10, v57
    v_lshl_add_u32 v9, v9, 2, v61
    ds_write_b8_d16_hi v9, v64 offset:16
    v_and_b32 v7, -4, v62
    v_lshl_add_u32 v8, v62, 2, v7
    ds_write_b32 v8, v58
    v_lshl_add_u32 v7, v7, 2, v62
    ds_write_b8 v7, v65 offset:16
    v_and_b32 v9, -4, v63
    v_lshl_add_u32 v10, v63, 2, v9
    ds_write_b32 v10, v59
    v_lshl_add_u32 v9, v9, 2, v63
    ds_write_b8_d16_hi v9, v65 offset:16
    s_add_u32 s45, s97, 0x3400000
    buffer_load_dwordx4 v[36:39], v0, s[8:11], s45 offen nt
    v_and_b32 v7, -4, v72
    v_lshl_add_u32 v8, v72, 2, v7
    ds_write_b32 v8, v68
    v_lshl_add_u32 v7, v7, 2, v72
    ds_write_b8 v7, v66 offset:16
    v_and_b32 v9, -4, v73
    v_lshl_add_u32 v10, v73, 2, v9
    ds_write_b32 v10, v69
    v_lshl_add_u32 v9, v9, 2, v73
    ds_write_b8_d16_hi v9, v66 offset:16
    v_and_b32 v7, -4, v74
    v_lshl_add_u32 v8, v74, 2, v7
    ds_write_b32 v8, v70
    v_lshl_add_u32 v7, v7, 2, v74
    ds_write_b8 v7, v67 offset:16
    v_and_b32 v9, -4, v75
    v_lshl_add_u32 v10, v75, 2, v9
    ds_write_b32 v10, v71
    v_lshl_add_u32 v9, v9, 2, v75
    ds_write_b8_d16_hi v9, v67 offset:16
    s_add_u32 s46, s97, 0x3400000
    buffer_load_dwordx4 v[40:43], v0, s[12:15], s46 offen nt
    s_add_u32 s47, s98, 0x3800000
    buffer_load_dwordx4 v[48:51], v0, s[8:11], s47 offen nt
    s_setprio 0
    v_and_b32 v7, -4, v80
    v_lshl_add_u32 v8, v80, 2, v7
    ds_write_b32 v8, v76
    v_lshl_add_u32 v7, v7, 2, v80
    ds_write_b8 v7, v84 offset:16
    v_and_b32 v9, -4, v81
    v_lshl_add_u32 v10, v81, 2, v9
    ds_write_b32 v10, v77
    v_lshl_add_u32 v9, v9, 2, v81
    ds_write_b8_d16_hi v9, v84 offset:16
    v_and_b32 v7, -4, v82
    v_lshl_add_u32 v8, v82, 2, v7
    ds_write_b32 v8, v78
    v_lshl_add_u32 v7, v7, 2, v82
    ds_write_b8 v7, v85 offset:16
    v_and_b32 v9, -4, v83
    v_lshl_add_u32 v10, v83, 2, v9
    ds_write_b32 v10, v79
    v_lshl_add_u32 v9, v9, 2, v83
    ds_write_b8_d16_hi v9, v85 offset:16
    s_add_u32 s44, s98, 0x3800000
    buffer_load_dwordx4 v[52:55], v0, s[12:15], s44 offen nt
    v_and_b32 v7, -4, v92
    v_lshl_add_u32 v8, v92, 2, v7
    ds_write_b32 v8, v88
    v_lshl_add_u32 v7, v7, 2, v92
    ds_write_b8 v7, v86 offset:16
    v_and_b32 v9, -4, v93
    v_lshl_add_u32 v10, v93, 2, v9
    ds_write_b32 v10, v89
    v_lshl_add_u32 v9, v9, 2, v93
    ds_write_b8_d16_hi v9, v86 offset:16
    v_and_b32 v7, -4, v94
    v_lshl_add_u32 v8, v94, 2, v7
    ds_write_b32 v8, v90
    v_lshl_add_u32 v7, v7, 2, v94
    ds_write_b8 v7, v87 offset:16
    v_and_b32 v9, -4, v95
    v_lshl_add_u32 v10, v95, 2, v9
    ds_write_b32 v10, v91
    v_lshl_add_u32 v9, v9, 2, v95
    ds_write_b8_d16_hi v9, v87 offset:16
    s_add_u32 s45, s98, 0x3800000
    s_lshr_b32 s45, s45, 1
    buffer_load_dwordx2 v[44:45], v1, s[16:19], s45 offen nt
    s_add_u32 s46, s99, 0x3c00000
    s_lshr_b32 s46, s46, 1
    buffer_load_dwordx2 v[46:47], v1, s[16:19], s46 offen nt
    v_add_u32 v7, s72, v0
    v_add_u32 v12, s73, v0
    v_add_u32 v13, s85, v0
    v_add_u32 v14, s91, v0
    v_add_u32 v15, s93, v0
    s_min_i32 s3, s72, s73
    s_min_i32 s3, s3, s85
    s_min_i32 s3, s3, s91
    s_min_i32 s3, s3, s93
    v_add_u32 v3, s3, v0
    v_mov_b32 v8, 0
    v_mov_b32 v9, 0
    v_mov_b32 v10, 0
    v_mov_b32 v11, 0
    s_waitcnt lgkmcnt(0)
    s_barrier
    ds_read_b128 v[56:59], v7 offset:0
    ds_read_b128 v[60:63], v12 offset:0
    ds_read_b128 v[68:71], v13 offset:0
    ds_read_b128 v[72:75], v14 offset:0
    ds_read_b128 v[64:67], v15 offset:0
    ds_write_b128 v3, v[8:11]
    ds_read_b128 v[76:79], v7 offset:16384
    ds_read_b128 v[80:83], v12 offset:16384
    ds_read_b128 v[88:91], v13 offset:16384
    ds_read_b128 v[92:95], v14 offset:16384
    ds_read_b128 v[84:87], v15 offset:16384
    s_waitcnt lgkmcnt(0)
    s_barrier
    s_setprio 3
    s_add_u32 s47, s35, 0x4000
    s_add_u32 s47, s47, s72
    buffer_store_dwordx4 v[56:59], v0, s[20:23], s47 offen sc1
    s_add_u32 s44, s99, 0x3c00000
    s_nop 0
    buffer_load_dwordx4 v[56:59], v0, s[8:11], s44 offen nt
    s_add_u32 s45, s35, 0x4000
    s_add_u32 s45, s45, s73
    buffer_store_dwordx4 v[60:63], v0, s[20:23], s45 offen sc1
    s_add_u32 s46, s99, 0x3c00000
    s_nop 0
    buffer_load_dwordx4 v[60:63], v0, s[12:15], s46 offen nt
    s_waitcnt vmcnt(22)
    v_lshlrev_b32 v7, 16, v108
    v_and_b32 v8, 0xffff0000, v108
    v_lshlrev_b32 v9, 16, v109
    v_and_b32 v10, 0xffff0000, v109
    v_mul_f32 v7, 0.15915494, v7
    v_mul_f32 v8, 0.15915494, v8
    v_mul_f32 v9, 0.15915494, v9
    v_mul_f32 v10, 0.15915494, v10
    v_mul_hi_u32_u24 v14, 429497, v96
    v_lshrrev_b32 v12, 3, v104
    v_cos_f32 v7, v7
    v_lshlrev_b16 v13, 3, v104
    v_mad_i32_i24 v11, v14, s55, v96
    v_bitop3_b32 v12, v6, v13, v12 bitop3:0xca
    v_lshl_add_u32 v11, v11, 17, s40
    v_lshlrev_b16 v14, 8, v14
    v_lshrrev_b32 v13, 2, v104
    v_add_u32 v96, v12, v11
    v_bitop3_b32 v104, v5, v13, v14 bitop3:0xea
    ds_add_u32 v104, v2
    v_mul_hi_u32_u24 v14, 429497, v97
    v_lshrrev_b32 v12, 3, v105
    v_cos_f32 v8, v8
    v_lshlrev_b16 v13, 3, v105
    v_mad_i32_i24 v11, v14, s55, v97
    v_bitop3_b32 v12, v6, v13, v12 bitop3:0xca
    v_lshl_add_u32 v11, v11, 17, s40
    v_lshlrev_b16 v14, 8, v14
    v_lshrrev_b32 v13, 2, v105
    v_add_u32 v97, v12, v11
    v_bitop3_b32 v105, v5, v13, v14 bitop3:0xea
    ds_add_u32 v105, v2
    v_cvt_pk_bf16_f32 v108, v7, v8
    v_perm_b32 v12, v108, v108, s41
    v_bitop3_b32 v96, v4, v12, v96 bitop3:0xca
    v_perm_b32 v13, v108, v108, s42
    v_bitop3_b32 v97, v4, v13, v97 bitop3:0xca
    v_mul_hi_u32_u24 v14, 429497, v98
    v_lshrrev_b32 v12, 3, v106
    v_cos_f32 v9, v9
    v_lshlrev_b16 v13, 3, v106
    v_mad_i32_i24 v11, v14, s55, v98
    v_bitop3_b32 v12, v6, v13, v12 bitop3:0xca
    v_lshl_add_u32 v11, v11, 17, s40
    v_lshlrev_b16 v14, 8, v14
    v_lshrrev_b32 v13, 2, v106
    v_add_u32 v98, v12, v11
    v_bitop3_b32 v106, v5, v13, v14 bitop3:0xea
    ds_add_u32 v106, v2
    v_mul_hi_u32_u24 v14, 429497, v99
    v_lshrrev_b32 v12, 3, v107
    v_cos_f32 v10, v10
    v_lshlrev_b16 v13, 3, v107
    v_mad_i32_i24 v11, v14, s55, v99
    v_bitop3_b32 v12, v6, v13, v12 bitop3:0xca
    v_lshl_add_u32 v11, v11, 17, s40
    v_lshlrev_b16 v14, 8, v14
    v_lshrrev_b32 v13, 2, v107
    v_add_u32 v99, v12, v11
    v_bitop3_b32 v107, v5, v13, v14 bitop3:0xea
    ds_add_u32 v107, v2
    v_cvt_pk_bf16_f32 v109, v9, v10
    v_perm_b32 v12, v109, v109, s41
    v_bitop3_b32 v98, v4, v12, v98 bitop3:0xca
    v_perm_b32 v13, v109, v109, s42
    v_bitop3_b32 v99, v4, v13, v99 bitop3:0xca
    s_waitcnt vmcnt(20)
    v_lshlrev_b32 v7, 16, v110
    v_and_b32 v8, 0xffff0000, v110
    v_lshlrev_b32 v9, 16, v111
    v_and_b32 v10, 0xffff0000, v111
    v_mul_f32 v7, 0.15915494, v7
    v_mul_f32 v8, 0.15915494, v8
    v_mul_f32 v9, 0.15915494, v9
    v_mul_f32 v10, 0.15915494, v10
    v_mul_hi_u32_u24 v14, 429497, v112
    v_lshrrev_b32 v12, 3, v100
    v_cos_f32 v7, v7
    v_lshlrev_b16 v13, 3, v100
    v_mad_i32_i24 v11, v14, s55, v112
    v_bitop3_b32 v12, v6, v13, v12 bitop3:0xca
    v_lshl_add_u32 v11, v11, 17, s40
    v_lshlrev_b16 v14, 8, v14
    v_lshrrev_b32 v13, 2, v100
    v_add_u32 v112, v12, v11
    v_bitop3_b32 v100, v5, v13, v14 bitop3:0xea
    ds_add_u32 v100, v2
    v_mul_hi_u32_u24 v14, 429497, v113
    v_lshrrev_b32 v12, 3, v101
    v_cos_f32 v8, v8
    v_lshlrev_b16 v13, 3, v101
    v_mad_i32_i24 v11, v14, s55, v113
    v_bitop3_b32 v12, v6, v13, v12 bitop3:0xca
    v_lshl_add_u32 v11, v11, 17, s40
    v_lshlrev_b16 v14, 8, v14
    v_lshrrev_b32 v13, 2, v101
    v_add_u32 v113, v12, v11
    v_bitop3_b32 v101, v5, v13, v14 bitop3:0xea
    ds_add_u32 v101, v2
    v_cvt_pk_bf16_f32 v110, v7, v8
    v_perm_b32 v12, v110, v110, s41
    v_bitop3_b32 v112, v4, v12, v112 bitop3:0xca
    v_perm_b32 v13, v110, v110, s42
    v_bitop3_b32 v113, v4, v13, v113 bitop3:0xca
    v_mul_hi_u32_u24 v14, 429497, v114
    v_lshrrev_b32 v12, 3, v102
    v_cos_f32 v9, v9
    v_lshlrev_b16 v13, 3, v102
    v_mad_i32_i24 v11, v14, s55, v114
    v_bitop3_b32 v12, v6, v13, v12 bitop3:0xca
    v_lshl_add_u32 v11, v11, 17, s40
    v_lshlrev_b16 v14, 8, v14
    v_lshrrev_b32 v13, 2, v102
    v_add_u32 v114, v12, v11
    v_bitop3_b32 v102, v5, v13, v14 bitop3:0xea
    ds_add_u32 v102, v2
    v_mul_hi_u32_u24 v14, 429497, v115
    v_lshrrev_b32 v12, 3, v103
    v_cos_f32 v10, v10
    v_lshlrev_b16 v13, 3, v103
    v_mad_i32_i24 v11, v14, s55, v115
    v_bitop3_b32 v12, v6, v13, v12 bitop3:0xca
    v_lshl_add_u32 v11, v11, 17, s40
    v_lshlrev_b16 v14, 8, v14
    v_lshrrev_b32 v13, 2, v103
    v_add_u32 v115, v12, v11
    v_bitop3_b32 v103, v5, v13, v14 bitop3:0xea
    ds_add_u32 v103, v2
    v_cvt_pk_bf16_f32 v111, v9, v10
    v_perm_b32 v12, v111, v111, s41
    v_bitop3_b32 v114, v4, v12, v114 bitop3:0xca
    v_perm_b32 v13, v111, v111, s42
    v_bitop3_b32 v115, v4, v13, v115 bitop3:0xca
    s_setprio 2
    s_waitcnt vmcnt(16)
    v_lshlrev_b32 v7, 16, v124
    v_and_b32 v8, 0xffff0000, v124
    v_lshlrev_b32 v9, 16, v125
    v_and_b32 v10, 0xffff0000, v125
    v_mul_f32 v7, 0.15915494, v7
    v_mul_f32 v8, 0.15915494, v8
    v_mul_f32 v9, 0.15915494, v9
    v_mul_f32 v10, 0.15915494, v10
    v_mul_hi_u32_u24 v14, 429497, v116
    v_lshrrev_b32 v12, 3, v120
    v_cos_f32 v7, v7
    v_lshlrev_b16 v13, 3, v120
    v_mad_i32_i24 v11, v14, s55, v116
    v_bitop3_b32 v12, v6, v13, v12 bitop3:0xca
    v_lshl_add_u32 v11, v11, 17, s40
    v_lshlrev_b16 v14, 8, v14
    v_lshrrev_b32 v13, 2, v120
    v_add_u32 v116, v12, v11
    v_bitop3_b32 v120, v5, v13, v14 bitop3:0xea
    ds_add_u32 v120, v2
    v_mul_hi_u32_u24 v14, 429497, v117
    v_lshrrev_b32 v12, 3, v121
    v_cos_f32 v8, v8
    v_lshlrev_b16 v13, 3, v121
    v_mad_i32_i24 v11, v14, s55, v117
    v_bitop3_b32 v12, v6, v13, v12 bitop3:0xca
    v_lshl_add_u32 v11, v11, 17, s40
    v_lshlrev_b16 v14, 8, v14
    v_lshrrev_b32 v13, 2, v121
    v_add_u32 v117, v12, v11
    v_bitop3_b32 v121, v5, v13, v14 bitop3:0xea
    ds_add_u32 v121, v2
    v_cvt_pk_bf16_f32 v124, v7, v8
    v_perm_b32 v12, v124, v124, s41
    v_bitop3_b32 v116, v4, v12, v116 bitop3:0xca
    v_perm_b32 v13, v124, v124, s42
    v_bitop3_b32 v117, v4, v13, v117 bitop3:0xca
    v_mul_hi_u32_u24 v14, 429497, v118
    v_lshrrev_b32 v12, 3, v122
    v_cos_f32 v9, v9
    v_lshlrev_b16 v13, 3, v122
    v_mad_i32_i24 v11, v14, s55, v118
    v_bitop3_b32 v12, v6, v13, v12 bitop3:0xca
    v_lshl_add_u32 v11, v11, 17, s40
    v_lshlrev_b16 v14, 8, v14
    v_lshrrev_b32 v13, 2, v122
    v_add_u32 v118, v12, v11
    v_bitop3_b32 v122, v5, v13, v14 bitop3:0xea
    ds_add_u32 v122, v2
    v_mul_hi_u32_u24 v14, 429497, v119
    v_lshrrev_b32 v12, 3, v123
    v_cos_f32 v10, v10
    v_lshlrev_b16 v13, 3, v123
    v_mad_i32_i24 v11, v14, s55, v119
    v_bitop3_b32 v12, v6, v13, v12 bitop3:0xca
    v_lshl_add_u32 v11, v11, 17, s40
    v_lshlrev_b16 v14, 8, v14
    v_lshrrev_b32 v13, 2, v123
    v_add_u32 v119, v12, v11
    v_bitop3_b32 v123, v5, v13, v14 bitop3:0xea
    ds_add_u32 v123, v2
    v_cvt_pk_bf16_f32 v125, v9, v10
    v_perm_b32 v12, v125, v125, s41
    v_bitop3_b32 v118, v4, v12, v118 bitop3:0xca
    v_perm_b32 v13, v125, v125, s42
    v_bitop3_b32 v119, v4, v13, v119 bitop3:0xca
    s_add_u32 s47, s35, 0x4000
    s_add_u32 s47, s47, s85
    buffer_store_dwordx4 v[68:71], v0, s[20:23], s47 offen sc1
    s_add_u32 s44, s96, 0x4000000
    s_nop 0
    buffer_load_dwordx4 v[68:71], v0, s[8:11], s44 offen nt
    s_waitcnt vmcnt(16)
    v_lshlrev_b32 v7, 16, v126
    v_and_b32 v8, 0xffff0000, v126
    v_lshlrev_b32 v9, 16, v127
    v_and_b32 v10, 0xffff0000, v127
    v_mul_f32 v7, 0.15915494, v7
    v_mul_f32 v8, 0.15915494, v8
    v_mul_f32 v9, 0.15915494, v9
    v_mul_f32 v10, 0.15915494, v10
    v_mul_hi_u32_u24 v14, 429497, v16
    v_lshrrev_b32 v12, 3, v20
    v_cos_f32 v7, v7
    v_lshlrev_b16 v13, 3, v20
    v_mad_i32_i24 v11, v14, s55, v16
    v_bitop3_b32 v12, v6, v13, v12 bitop3:0xca
    v_lshl_add_u32 v11, v11, 17, s40
    v_lshlrev_b16 v14, 8, v14
    v_lshrrev_b32 v13, 2, v20
    v_add_u32 v16, v12, v11
    v_bitop3_b32 v20, v5, v13, v14 bitop3:0xea
    ds_add_u32 v20, v2
    v_mul_hi_u32_u24 v14, 429497, v17
    v_lshrrev_b32 v12, 3, v21
    v_cos_f32 v8, v8
    v_lshlrev_b16 v13, 3, v21
    v_mad_i32_i24 v11, v14, s55, v17
    v_bitop3_b32 v12, v6, v13, v12 bitop3:0xca
    v_lshl_add_u32 v11, v11, 17, s40
    v_lshlrev_b16 v14, 8, v14
    v_lshrrev_b32 v13, 2, v21
    v_add_u32 v17, v12, v11
    v_bitop3_b32 v21, v5, v13, v14 bitop3:0xea
    ds_add_u32 v21, v2
    v_cvt_pk_bf16_f32 v126, v7, v8
    v_perm_b32 v12, v126, v126, s41
    v_bitop3_b32 v16, v4, v12, v16 bitop3:0xca
    v_perm_b32 v13, v126, v126, s42
    v_bitop3_b32 v17, v4, v13, v17 bitop3:0xca
    v_mul_hi_u32_u24 v14, 429497, v18
    v_lshrrev_b32 v12, 3, v22
    v_cos_f32 v9, v9
    v_lshlrev_b16 v13, 3, v22
    v_mad_i32_i24 v11, v14, s55, v18
    v_bitop3_b32 v12, v6, v13, v12 bitop3:0xca
    v_lshl_add_u32 v11, v11, 17, s40
    v_lshlrev_b16 v14, 8, v14
    v_lshrrev_b32 v13, 2, v22
    v_add_u32 v18, v12, v11
    v_bitop3_b32 v22, v5, v13, v14 bitop3:0xea
    ds_add_u32 v22, v2
    v_mul_hi_u32_u24 v14, 429497, v19
    v_lshrrev_b32 v12, 3, v23
    v_cos_f32 v10, v10
    v_lshlrev_b16 v13, 3, v23
    v_mad_i32_i24 v11, v14, s55, v19
    v_bitop3_b32 v12, v6, v13, v12 bitop3:0xca
    v_lshl_add_u32 v11, v11, 17, s40
    v_lshlrev_b16 v14, 8, v14
    v_lshrrev_b32 v13, 2, v23
    v_add_u32 v19, v12, v11
    v_bitop3_b32 v23, v5, v13, v14 bitop3:0xea
    ds_add_u32 v23, v2
    v_cvt_pk_bf16_f32 v127, v9, v10
    v_perm_b32 v12, v127, v127, s41
    v_bitop3_b32 v18, v4, v12, v18 bitop3:0xca
    v_perm_b32 v13, v127, v127, s42
    v_bitop3_b32 v19, v4, v13, v19 bitop3:0xca
    s_setprio 1
    s_waitcnt vmcnt(12)
    v_lshlrev_b32 v7, 16, v24
    v_and_b32 v8, 0xffff0000, v24
    v_lshlrev_b32 v9, 16, v25
    v_and_b32 v10, 0xffff0000, v25
    v_mul_f32 v7, 0.15915494, v7
    v_mul_f32 v8, 0.15915494, v8
    v_mul_f32 v9, 0.15915494, v9
    v_mul_f32 v10, 0.15915494, v10
    v_mul_hi_u32_u24 v14, 429497, v28
    v_lshrrev_b32 v12, 3, v32
    v_cos_f32 v7, v7
    v_lshlrev_b16 v13, 3, v32
    v_mad_i32_i24 v11, v14, s55, v28
    v_bitop3_b32 v12, v6, v13, v12 bitop3:0xca
    v_lshl_add_u32 v11, v11, 17, s40
    v_lshlrev_b16 v14, 8, v14
    v_lshrrev_b32 v13, 2, v32
    v_add_u32 v28, v12, v11
    v_bitop3_b32 v32, v5, v13, v14 bitop3:0xea
    ds_add_u32 v32, v2
    v_mul_hi_u32_u24 v14, 429497, v29
    v_lshrrev_b32 v12, 3, v33
    v_cos_f32 v8, v8
    v_lshlrev_b16 v13, 3, v33
    v_mad_i32_i24 v11, v14, s55, v29
    v_bitop3_b32 v12, v6, v13, v12 bitop3:0xca
    v_lshl_add_u32 v11, v11, 17, s40
    v_lshlrev_b16 v14, 8, v14
    v_lshrrev_b32 v13, 2, v33
    v_add_u32 v29, v12, v11
    v_bitop3_b32 v33, v5, v13, v14 bitop3:0xea
    ds_add_u32 v33, v2
    v_cvt_pk_bf16_f32 v24, v7, v8
    v_perm_b32 v12, v24, v24, s41
    v_bitop3_b32 v28, v4, v12, v28 bitop3:0xca
    v_perm_b32 v13, v24, v24, s42
    v_bitop3_b32 v29, v4, v13, v29 bitop3:0xca
    v_mul_hi_u32_u24 v14, 429497, v30
    v_lshrrev_b32 v12, 3, v34
    v_cos_f32 v9, v9
    v_lshlrev_b16 v13, 3, v34
    v_mad_i32_i24 v11, v14, s55, v30
    v_bitop3_b32 v12, v6, v13, v12 bitop3:0xca
    v_lshl_add_u32 v11, v11, 17, s40
    v_lshlrev_b16 v14, 8, v14
    v_lshrrev_b32 v13, 2, v34
    v_add_u32 v30, v12, v11
    v_bitop3_b32 v34, v5, v13, v14 bitop3:0xea
    ds_add_u32 v34, v2
    v_mul_hi_u32_u24 v14, 429497, v31
    v_lshrrev_b32 v12, 3, v35
    v_cos_f32 v10, v10
    v_lshlrev_b16 v13, 3, v35
    v_mad_i32_i24 v11, v14, s55, v31
    v_bitop3_b32 v12, v6, v13, v12 bitop3:0xca
    v_lshl_add_u32 v11, v11, 17, s40
    v_lshlrev_b16 v14, 8, v14
    v_lshrrev_b32 v13, 2, v35
    v_add_u32 v31, v12, v11
    v_bitop3_b32 v35, v5, v13, v14 bitop3:0xea
    ds_add_u32 v35, v2
    v_cvt_pk_bf16_f32 v25, v9, v10
    v_perm_b32 v12, v25, v25, s41
    v_bitop3_b32 v30, v4, v12, v30 bitop3:0xca
    v_perm_b32 v13, v25, v25, s42
    v_bitop3_b32 v31, v4, v13, v31 bitop3:0xca
    s_waitcnt vmcnt(10)
    v_lshlrev_b32 v7, 16, v26
    v_and_b32 v8, 0xffff0000, v26
    v_lshlrev_b32 v9, 16, v27
    v_and_b32 v10, 0xffff0000, v27
    v_mul_f32 v7, 0.15915494, v7
    v_mul_f32 v8, 0.15915494, v8
    v_mul_f32 v9, 0.15915494, v9
    v_mul_f32 v10, 0.15915494, v10
    v_mul_hi_u32_u24 v14, 429497, v36
    v_lshrrev_b32 v12, 3, v40
    v_cos_f32 v7, v7
    v_lshlrev_b16 v13, 3, v40
    v_mad_i32_i24 v11, v14, s55, v36
    v_bitop3_b32 v12, v6, v13, v12 bitop3:0xca
    v_lshl_add_u32 v11, v11, 17, s40
    v_lshlrev_b16 v14, 8, v14
    v_lshrrev_b32 v13, 2, v40
    v_add_u32 v36, v12, v11
    v_bitop3_b32 v40, v5, v13, v14 bitop3:0xea
    ds_add_u32 v40, v2
    v_mul_hi_u32_u24 v14, 429497, v37
    v_lshrrev_b32 v12, 3, v41
    v_cos_f32 v8, v8
    v_lshlrev_b16 v13, 3, v41
    v_mad_i32_i24 v11, v14, s55, v37
    v_bitop3_b32 v12, v6, v13, v12 bitop3:0xca
    v_lshl_add_u32 v11, v11, 17, s40
    v_lshlrev_b16 v14, 8, v14
    v_lshrrev_b32 v13, 2, v41
    v_add_u32 v37, v12, v11
    v_bitop3_b32 v41, v5, v13, v14 bitop3:0xea
    ds_add_u32 v41, v2
    v_cvt_pk_bf16_f32 v26, v7, v8
    v_perm_b32 v12, v26, v26, s41
    v_bitop3_b32 v36, v4, v12, v36 bitop3:0xca
    v_perm_b32 v13, v26, v26, s42
    v_bitop3_b32 v37, v4, v13, v37 bitop3:0xca
    v_mul_hi_u32_u24 v14, 429497, v38
    v_lshrrev_b32 v12, 3, v42
    v_cos_f32 v9, v9
    v_lshlrev_b16 v13, 3, v42
    v_mad_i32_i24 v11, v14, s55, v38
    v_bitop3_b32 v12, v6, v13, v12 bitop3:0xca
    v_lshl_add_u32 v11, v11, 17, s40
    v_lshlrev_b16 v14, 8, v14
    v_lshrrev_b32 v13, 2, v42
    v_add_u32 v38, v12, v11
    v_bitop3_b32 v42, v5, v13, v14 bitop3:0xea
    ds_add_u32 v42, v2
    v_mul_hi_u32_u24 v14, 429497, v39
    v_lshrrev_b32 v12, 3, v43
    v_cos_f32 v10, v10
    v_lshlrev_b16 v13, 3, v43
    v_mad_i32_i24 v11, v14, s55, v39
    v_bitop3_b32 v12, v6, v13, v12 bitop3:0xca
    v_lshl_add_u32 v11, v11, 17, s40
    v_lshlrev_b16 v14, 8, v14
    v_lshrrev_b32 v13, 2, v43
    v_add_u32 v39, v12, v11
    v_bitop3_b32 v43, v5, v13, v14 bitop3:0xea
    ds_add_u32 v43, v2
    v_cvt_pk_bf16_f32 v27, v9, v10
    v_perm_b32 v12, v27, v27, s41
    v_bitop3_b32 v38, v4, v12, v38 bitop3:0xca
    v_perm_b32 v13, v27, v27, s42
    v_bitop3_b32 v39, v4, v13, v39 bitop3:0xca
    s_setprio 0
    s_add_u32 s45, s35, 0x4000
    s_add_u32 s45, s45, s91
    buffer_store_dwordx4 v[72:75], v0, s[20:23], s45 offen sc1
    s_add_u32 s46, s96, 0x4000000
    s_nop 0
    buffer_load_dwordx4 v[72:75], v0, s[12:15], s46 offen nt
    s_waitcnt vmcnt(8)
    v_lshlrev_b32 v7, 16, v44
    v_and_b32 v8, 0xffff0000, v44
    v_lshlrev_b32 v9, 16, v45
    v_and_b32 v10, 0xffff0000, v45
    v_mul_f32 v7, 0.15915494, v7
    v_mul_f32 v8, 0.15915494, v8
    v_mul_f32 v9, 0.15915494, v9
    v_mul_f32 v10, 0.15915494, v10
    v_mul_hi_u32_u24 v14, 429497, v48
    v_lshrrev_b32 v12, 3, v52
    v_cos_f32 v7, v7
    v_lshlrev_b16 v13, 3, v52
    v_mad_i32_i24 v11, v14, s55, v48
    v_bitop3_b32 v12, v6, v13, v12 bitop3:0xca
    v_lshl_add_u32 v11, v11, 17, s40
    v_lshlrev_b16 v14, 8, v14
    v_lshrrev_b32 v13, 2, v52
    v_add_u32 v48, v12, v11
    v_bitop3_b32 v52, v5, v13, v14 bitop3:0xea
    ds_add_u32 v52, v2
    v_mul_hi_u32_u24 v14, 429497, v49
    v_lshrrev_b32 v12, 3, v53
    v_cos_f32 v8, v8
    v_lshlrev_b16 v13, 3, v53
    v_mad_i32_i24 v11, v14, s55, v49
    v_bitop3_b32 v12, v6, v13, v12 bitop3:0xca
    v_lshl_add_u32 v11, v11, 17, s40
    v_lshlrev_b16 v14, 8, v14
    v_lshrrev_b32 v13, 2, v53
    v_add_u32 v49, v12, v11
    v_bitop3_b32 v53, v5, v13, v14 bitop3:0xea
    ds_add_u32 v53, v2
    v_cvt_pk_bf16_f32 v44, v7, v8
    v_perm_b32 v12, v44, v44, s41
    v_bitop3_b32 v48, v4, v12, v48 bitop3:0xca
    v_perm_b32 v13, v44, v44, s42
    v_bitop3_b32 v49, v4, v13, v49 bitop3:0xca
    v_mul_hi_u32_u24 v14, 429497, v50
    v_lshrrev_b32 v12, 3, v54
    v_cos_f32 v9, v9
    v_lshlrev_b16 v13, 3, v54
    v_mad_i32_i24 v11, v14, s55, v50
    v_bitop3_b32 v12, v6, v13, v12 bitop3:0xca
    v_lshl_add_u32 v11, v11, 17, s40
    v_lshlrev_b16 v14, 8, v14
    v_lshrrev_b32 v13, 2, v54
    v_add_u32 v50, v12, v11
    v_bitop3_b32 v54, v5, v13, v14 bitop3:0xea
    ds_add_u32 v54, v2
    v_mul_hi_u32_u24 v14, 429497, v51
    v_lshrrev_b32 v12, 3, v55
    v_cos_f32 v10, v10
    v_lshlrev_b16 v13, 3, v55
    v_mad_i32_i24 v11, v14, s55, v51
    v_bitop3_b32 v12, v6, v13, v12 bitop3:0xca
    v_lshl_add_u32 v11, v11, 17, s40
    v_lshlrev_b16 v14, 8, v14
    v_lshrrev_b32 v13, 2, v55
    v_add_u32 v51, v12, v11
    v_bitop3_b32 v55, v5, v13, v14 bitop3:0xea
    ds_add_u32 v55, v2
    v_cvt_pk_bf16_f32 v45, v9, v10
    v_perm_b32 v12, v45, v45, s41
    v_bitop3_b32 v50, v4, v12, v50 bitop3:0xca
    v_perm_b32 v13, v45, v45, s42
    v_bitop3_b32 v51, v4, v13, v51 bitop3:0xca
    s_waitcnt vmcnt(4)
    v_lshlrev_b32 v7, 16, v46
    v_and_b32 v8, 0xffff0000, v46
    v_lshlrev_b32 v9, 16, v47
    v_and_b32 v10, 0xffff0000, v47
    v_mul_f32 v7, 0.15915494, v7
    v_mul_f32 v8, 0.15915494, v8
    v_mul_f32 v9, 0.15915494, v9
    v_mul_f32 v10, 0.15915494, v10
    v_mul_hi_u32_u24 v14, 429497, v56
    v_lshrrev_b32 v12, 3, v60
    v_cos_f32 v7, v7
    v_lshlrev_b16 v13, 3, v60
    v_mad_i32_i24 v11, v14, s55, v56
    v_bitop3_b32 v12, v6, v13, v12 bitop3:0xca
    v_lshl_add_u32 v11, v11, 17, s40
    v_lshlrev_b16 v14, 8, v14
    v_lshrrev_b32 v13, 2, v60
    v_add_u32 v56, v12, v11
    v_bitop3_b32 v60, v5, v13, v14 bitop3:0xea
    ds_add_u32 v60, v2
    v_mul_hi_u32_u24 v14, 429497, v57
    v_lshrrev_b32 v12, 3, v61
    v_cos_f32 v8, v8
    v_lshlrev_b16 v13, 3, v61
    v_mad_i32_i24 v11, v14, s55, v57
    v_bitop3_b32 v12, v6, v13, v12 bitop3:0xca
    v_lshl_add_u32 v11, v11, 17, s40
    v_lshlrev_b16 v14, 8, v14
    v_lshrrev_b32 v13, 2, v61
    v_add_u32 v57, v12, v11
    v_bitop3_b32 v61, v5, v13, v14 bitop3:0xea
    ds_add_u32 v61, v2
    v_cvt_pk_bf16_f32 v46, v7, v8
    v_perm_b32 v12, v46, v46, s41
    v_bitop3_b32 v56, v4, v12, v56 bitop3:0xca
    v_perm_b32 v13, v46, v46, s42
    v_bitop3_b32 v57, v4, v13, v57 bitop3:0xca
    v_mul_hi_u32_u24 v14, 429497, v58
    v_lshrrev_b32 v12, 3, v62
    v_cos_f32 v9, v9
    v_lshlrev_b16 v13, 3, v62
    v_mad_i32_i24 v11, v14, s55, v58
    v_bitop3_b32 v12, v6, v13, v12 bitop3:0xca
    v_lshl_add_u32 v11, v11, 17, s40
    v_lshlrev_b16 v14, 8, v14
    v_lshrrev_b32 v13, 2, v62
    v_add_u32 v58, v12, v11
    v_bitop3_b32 v62, v5, v13, v14 bitop3:0xea
    ds_add_u32 v62, v2
    v_mul_hi_u32_u24 v14, 429497, v59
    v_lshrrev_b32 v12, 3, v63
    v_cos_f32 v10, v10
    v_lshlrev_b16 v13, 3, v63
    v_mad_i32_i24 v11, v14, s55, v59
    v_bitop3_b32 v12, v6, v13, v12 bitop3:0xca
    v_lshl_add_u32 v11, v11, 17, s40
    v_lshlrev_b16 v14, 8, v14
    v_lshrrev_b32 v13, 2, v63
    v_add_u32 v59, v12, v11
    v_bitop3_b32 v63, v5, v13, v14 bitop3:0xea
    ds_add_u32 v63, v2
    v_cvt_pk_bf16_f32 v47, v9, v10
    v_perm_b32 v12, v47, v47, s41
    v_bitop3_b32 v58, v4, v12, v58 bitop3:0xca
    v_perm_b32 v13, v47, v47, s42
    v_bitop3_b32 v59, v4, v13, v59 bitop3:0xca
    v_lshrrev_b32 v8, 2, v0
    v_and_b32 v7, 0x3c00, v0
    v_bitop3_b32 v7, v5, v8, v7 bitop3:0xea
    s_waitcnt lgkmcnt(0)
    s_barrier
    ds_read2st64_b32 v[8:9], v7 offset0:0 offset1:1
    ds_read2st64_b32 v[10:11], v7 offset0:2 offset1:3
    s_add_u32 s47, s35, 0x4000
    s_add_u32 s47, s47, s93
    buffer_store_dwordx4 v[64:67], v0, s[20:23], s47 offen sc1
    s_add_u32 s44, s96, 0x4000000
    s_lshr_b32 s44, s44, 1
    buffer_load_dwordx2 v[64:65], v1, s[16:19], s44 offen nt
    s_add_u32 s45, s97, 0x4400000
    s_lshr_b32 s45, s45, 1
    buffer_load_dwordx2 v[66:67], v1, s[16:19], s45 offen nt
    s_waitcnt lgkmcnt(0)
    v_lshl_or_b32 v12, v9, 16, v8
    v_lshl_or_b32 v13, v11, 16, v10
    v_mov_b32 v14, v12
    v_mov_b32 v15, v13
    s_nop 0
    v_add_u32_dpp v14, v14, v14 row_shr:1 row_mask:0xf bank_mask:0xf bound_ctrl:1
    v_add_u32_dpp v15, v15, v15 row_shr:1 row_mask:0xf bank_mask:0xf bound_ctrl:1
    s_nop 0
    v_add_u32_dpp v14, v14, v14 row_shr:2 row_mask:0xf bank_mask:0xf bound_ctrl:1
    v_add_u32_dpp v15, v15, v15 row_shr:2 row_mask:0xf bank_mask:0xf bound_ctrl:1
    s_nop 0
    v_add_u32_dpp v14, v14, v14 row_shr:4 row_mask:0xf bank_mask:0xf bound_ctrl:1
    v_add_u32_dpp v15, v15, v15 row_shr:4 row_mask:0xf bank_mask:0xf bound_ctrl:1
    s_nop 0
    v_add_u32_dpp v14, v14, v14 row_shr:8 row_mask:0xf bank_mask:0xf bound_ctrl:1
    v_add_u32_dpp v15, v15, v15 row_shr:8 row_mask:0xf bank_mask:0xf bound_ctrl:1
    s_nop 0
    v_add_u32_dpp v14, v14, v14 row_bcast:15 row_mask:0xa bank_mask:0xf
    v_add_u32_dpp v15, v15, v15 row_bcast:15 row_mask:0xa bank_mask:0xf
    s_nop 0
    v_add_u32_dpp v14, v14, v14 row_bcast:31 row_mask:0xc bank_mask:0xf
    v_add_u32_dpp v15, v15, v15 row_bcast:31 row_mask:0xc bank_mask:0xf
    v_readlane_b32 s48, v14, 63
    v_readlane_b32 s49, v15, 63
    s_lshl_b32 s54, s32, 2
    v_mov_b32 v8, s54
    s_and_b32 s50, s48, 0xffff
    s_lshr_b32 s51, s48, 16
    s_and_b32 s52, s49, 0xffff
    s_lshr_b32 s53, s49, 16
    s_add_u32 s51, s51, s50
    s_add_u32 s52, s52, s51
    s_add_u32 s53, s53, s52
    v_mov_b32 v9, s53
    s_mov_b64 exec, 1
    ds_write_b32 v8, v9 offset:16384
    s_mov_b64 exec, -1
    v_and_b32 v8, 60, v7
    s_waitcnt lgkmcnt(0)
    s_barrier
    ds_read_b32 v9, v8 offset:16384
    s_waitcnt lgkmcnt(0)
    v_add_u32_dpp v9, v9, v9 row_shr:1 row_mask:0xf bank_mask:0xf bound_ctrl:1
    s_nop 1
    v_add_u32_dpp v9, v9, v9 row_shr:2 row_mask:0xf bank_mask:0xf bound_ctrl:1
    s_nop 1
    v_add_u32_dpp v9, v9, v9 row_shr:4 row_mask:0xf bank_mask:0xf bound_ctrl:1
    s_nop 1
    v_add_u32_dpp v9, v9, v9 row_shr:8 row_mask:0xf bank_mask:0xf bound_ctrl:1
    s_nop 0
    v_readlane_b32 s54, v9, s32
    s_sub_u32 s54, s54, s53
    s_add_u32 s50, s50, s54
    s_add_u32 s51, s51, s54
    s_add_u32 s52, s52, s54
    s_pack_ll_b32_b16 s48, s54, s50
    s_pack_ll_b32_b16 s49, s51, s52
    v_add_u32 v14, s48, v14
    v_add_u32 v15, s49, v15
    v_sub_u32 v12, v14, v12
    v_sub_u32 v13, v15, v13
    v_and_b32 v8, 0xffff, v12
    v_lshrrev_b32 v9, 16, v12
    v_and_b32 v10, 0xffff, v13
    v_lshrrev_b32 v11, 16, v13
    ds_write2st64_b32 v7, v8, v9 offset0:0 offset1:1
    ds_write2st64_b32 v7, v10, v11 offset0:2 offset1:3
    v_and_b32 v8, 0x3f0, v0
    v_lshl_add_u32 v8, v8, 1, s36
    ds_write_b64 v8, v[12:13] offset:20480
    s_bitset0_b64 exec, 63
    s_not_b64 exec, exec
    ds_write_b64 v8, v[14:15] offset:20512
    s_mov_b64 exec, -1
    s_waitcnt lgkmcnt(0)
    s_barrier
    s_setprio 3
    ds_add_rtn_u32 v104, v104, v2
    ds_add_rtn_u32 v105, v105, v2
    ds_add_rtn_u32 v106, v106, v2
    ds_add_rtn_u32 v107, v107, v2
    ds_read_b128 v[12:15], v0 offset:20480
    v_cmp_gt_u32 vcc, 8448, v0
    ds_add_rtn_u32 v100, v100, v2
    ds_add_rtn_u32 v101, v101, v2
    ds_add_rtn_u32 v102, v102, v2
    ds_add_rtn_u32 v103, v103, v2
    s_setprio 2
    ds_add_rtn_u32 v120, v120, v2
    ds_add_rtn_u32 v121, v121, v2
    ds_add_rtn_u32 v122, v122, v2
    ds_add_rtn_u32 v123, v123, v2
    s_waitcnt lgkmcnt(8)
    s_cbranch_vccz L1_p2
    s_add_u32 s46, s35, 0x2a40000
    s_mov_b64 exec, vcc
    buffer_store_dwordx4 v[12:15], v0, s[24:27], s46 offen sc1
    s_mov_b64 exec, -1
L1_p2:
    s_add_u32 s47, s35, 0x8000
    s_add_u32 s47, s47, s72
    buffer_store_dwordx4 v[76:79], v0, s[20:23], s47 offen sc1
    s_add_u32 s44, s97, 0x4400000
    s_nop 0
    buffer_load_dwordx4 v[76:79], v0, s[8:11], s44 offen nt
    ds_add_rtn_u32 v20, v20, v2
    ds_add_rtn_u32 v21, v21, v2
    ds_add_rtn_u32 v22, v22, v2
    ds_add_rtn_u32 v23, v23, v2
    s_setprio 1
    ds_add_rtn_u32 v32, v32, v2
    ds_add_rtn_u32 v33, v33, v2
    ds_add_rtn_u32 v34, v34, v2
    ds_add_rtn_u32 v35, v35, v2
    ds_add_rtn_u32 v40, v40, v2
    ds_add_rtn_u32 v41, v41, v2
    ds_add_rtn_u32 v42, v42, v2
    ds_add_rtn_u32 v43, v43, v2
    s_add_u32 s45, s35, 0x8000
    s_add_u32 s45, s45, s73
    buffer_store_dwordx4 v[80:83], v0, s[20:23], s45 offen sc1
    s_add_u32 s46, s97, 0x4400000
    s_nop 0
    buffer_load_dwordx4 v[80:83], v0, s[12:15], s46 offen nt
    s_setprio 0
    ds_add_rtn_u32 v52, v52, v2
    ds_add_rtn_u32 v53, v53, v2
    ds_add_rtn_u32 v54, v54, v2
    ds_add_rtn_u32 v55, v55, v2
    ds_add_rtn_u32 v60, v60, v2
    ds_add_rtn_u32 v61, v61, v2
    ds_add_rtn_u32 v62, v62, v2
    ds_add_rtn_u32 v63, v63, v2
    s_waitcnt lgkmcnt(0)
    s_barrier
    s_setprio 3
    v_and_b32 v7, -4, v104
    v_lshl_add_u32 v8, v104, 2, v7
    ds_write_b32 v8, v96
    v_lshl_add_u32 v7, v7, 2, v104
    ds_write_b8 v7, v108 offset:16
    v_and_b32 v9, -4, v105
    v_lshl_add_u32 v10, v105, 2, v9
    ds_write_b32 v10, v97
    v_lshl_add_u32 v9, v9, 2, v105
    ds_write_b8_d16_hi v9, v108 offset:16
    v_and_b32 v7, -4, v106
    v_lshl_add_u32 v8, v106, 2, v7
    ds_write_b32 v8, v98
    v_lshl_add_u32 v7, v7, 2, v106
    ds_write_b8 v7, v109 offset:16
    v_and_b32 v9, -4, v107
    v_lshl_add_u32 v10, v107, 2, v9
    ds_write_b32 v10, v99
    v_lshl_add_u32 v9, v9, 2, v107
    ds_write_b8_d16_hi v9, v109 offset:16
    s_add_u32 s47, s35, 0x8000
    s_add_u32 s47, s47, s85
    buffer_store_dwordx4 v[88:91], v0, s[20:23], s47 offen sc1
    s_add_u32 s44, s98, 0x4800000
    buffer_load_dwordx4 v[96:99], v0, s[8:11], s44 offen nt
    s_add_u32 s45, s98, 0x4800000
    buffer_load_dwordx4 v[104:107], v0, s[12:15], s45 offen nt
    v_and_b32 v7, -4, v100
    v_lshl_add_u32 v8, v100, 2, v7
    ds_write_b32 v8, v112
    v_lshl_add_u32 v7, v7, 2, v100
    ds_write_b8 v7, v110 offset:16
    v_and_b32 v9, -4, v101
    v_lshl_add_u32 v10, v101, 2, v9
    ds_write_b32 v10, v113
    v_lshl_add_u32 v9, v9, 2, v101
    ds_write_b8_d16_hi v9, v110 offset:16
    v_and_b32 v7, -4, v102
    v_lshl_add_u32 v8, v102, 2, v7
    ds_write_b32 v8, v114
    v_lshl_add_u32 v7, v7, 2, v102
    ds_write_b8 v7, v111 offset:16
    v_and_b32 v9, -4, v103
    v_lshl_add_u32 v10, v103, 2, v9
    ds_write_b32 v10, v115
    v_lshl_add_u32 v9, v9, 2, v103
    ds_write_b8_d16_hi v9, v111 offset:16
    s_add_u32 s46, s98, 0x4800000
    s_lshr_b32 s46, s46, 1
    buffer_load_dwordx2 v[88:89], v1, s[16:19], s46 offen nt
    s_add_u32 s47, s99, 0x4c00000
    s_lshr_b32 s47, s47, 1
    buffer_load_dwordx2 v[90:91], v1, s[16:19], s47 offen nt
    s_add_u32 s44, s99, 0x4c00000
    buffer_load_dwordx4 v[112:115], v0, s[8:11], s44 offen nt
    s_setprio 2
    v_and_b32 v7, -4, v120
    v_lshl_add_u32 v8, v120, 2, v7
    ds_write_b32 v8, v116
    v_lshl_add_u32 v7, v7, 2, v120
    ds_write_b8 v7, v124 offset:16
    v_and_b32 v9, -4, v121
    v_lshl_add_u32 v10, v121, 2, v9
    ds_write_b32 v10, v117
    v_lshl_add_u32 v9, v9, 2, v121
    ds_write_b8_d16_hi v9, v124 offset:16
    v_and_b32 v7, -4, v122
    v_lshl_add_u32 v8, v122, 2, v7
    ds_write_b32 v8, v118
    v_lshl_add_u32 v7, v7, 2, v122
    ds_write_b8 v7, v125 offset:16
    v_and_b32 v9, -4, v123
    v_lshl_add_u32 v10, v123, 2, v9
    ds_write_b32 v10, v119
    v_lshl_add_u32 v9, v9, 2, v123
    ds_write_b8_d16_hi v9, v125 offset:16
    s_add_u32 s45, s35, 0x8000
    s_add_u32 s45, s45, s91
    buffer_store_dwordx4 v[92:95], v0, s[20:23], s45 offen sc1
    s_add_u32 s46, s99, 0x4c00000
    buffer_load_dwordx4 v[100:103], v0, s[12:15], s46 offen nt
    v_and_b32 v7, -4, v20
    v_lshl_add_u32 v8, v20, 2, v7
    ds_write_b32 v8, v16
    v_lshl_add_u32 v7, v7, 2, v20
    ds_write_b8 v7, v126 offset:16
    v_and_b32 v9, -4, v21
    v_lshl_add_u32 v10, v21, 2, v9
    ds_write_b32 v10, v17
    v_lshl_add_u32 v9, v9, 2, v21
    ds_write_b8_d16_hi v9, v126 offset:16
    v_and_b32 v7, -4, v22
    v_lshl_add_u32 v8, v22, 2, v7
    ds_write_b32 v8, v18
    v_lshl_add_u32 v7, v7, 2, v22
    ds_write_b8 v7, v127 offset:16
    v_and_b32 v9, -4, v23
    v_lshl_add_u32 v10, v23, 2, v9
    ds_write_b32 v10, v19
    v_lshl_add_u32 v9, v9, 2, v23
    ds_write_b8_d16_hi v9, v127 offset:16
    s_add_u32 s47, s96, 0x5000000
    buffer_load_dwordx4 v[108:111], v0, s[8:11], s47 offen nt
    s_add_u32 s44, s96, 0x5000000
    buffer_load_dwordx4 v[116:119], v0, s[12:15], s44 offen nt
    s_setprio 1
    v_and_b32 v7, -4, v32
    v_lshl_add_u32 v8, v32, 2, v7
    ds_write_b32 v8, v28
    v_lshl_add_u32 v7, v7, 2, v32
    ds_write_b8 v7, v24 offset:16
    v_and_b32 v9, -4, v33
    v_lshl_add_u32 v10, v33, 2, v9
    ds_write_b32 v10, v29
    v_lshl_add_u32 v9, v9, 2, v33
    ds_write_b8_d16_hi v9, v24 offset:16
    v_and_b32 v7, -4, v34
    v_lshl_add_u32 v8, v34, 2, v7
    ds_write_b32 v8, v30
    v_lshl_add_u32 v7, v7, 2, v34
    ds_write_b8 v7, v25 offset:16
    v_and_b32 v9, -4, v35
    v_lshl_add_u32 v10, v35, 2, v9
    ds_write_b32 v10, v31
    v_lshl_add_u32 v9, v9, 2, v35
    ds_write_b8_d16_hi v9, v25 offset:16
    s_add_u32 s45, s96, 0x5000000
    s_lshr_b32 s45, s45, 1
    buffer_load_dwordx2 v[120:121], v1, s[16:19], s45 offen nt
    s_add_u32 s46, s97, 0x5400000
    s_lshr_b32 s46, s46, 1
    buffer_load_dwordx2 v[122:123], v1, s[16:19], s46 offen nt
    s_add_u32 s47, s97, 0x5400000
    buffer_load_dwordx4 v[92:95], v0, s[8:11], s47 offen nt
    v_and_b32 v7, -4, v40
    v_lshl_add_u32 v8, v40, 2, v7
    ds_write_b32 v8, v36
    v_lshl_add_u32 v7, v7, 2, v40
    ds_write_b8 v7, v26 offset:16
    v_and_b32 v9, -4, v41
    v_lshl_add_u32 v10, v41, 2, v9
    ds_write_b32 v10, v37
    v_lshl_add_u32 v9, v9, 2, v41
    ds_write_b8_d16_hi v9, v26 offset:16
    v_and_b32 v7, -4, v42
    v_lshl_add_u32 v8, v42, 2, v7
    ds_write_b32 v8, v38
    v_lshl_add_u32 v7, v7, 2, v42
    ds_write_b8 v7, v27 offset:16
    v_and_b32 v9, -4, v43
    v_lshl_add_u32 v10, v43, 2, v9
    ds_write_b32 v10, v39
    v_lshl_add_u32 v9, v9, 2, v43
    ds_write_b8_d16_hi v9, v27 offset:16
    s_add_u32 s44, s35, 0x8000
    s_add_u32 s44, s44, s93
    buffer_store_dwordx4 v[84:87], v0, s[20:23], s44 offen sc1
    s_add_u32 s45, s97, 0x5400000
    buffer_load_dwordx4 v[16:19], v0, s[12:15], s45 offen nt
    s_setprio 0
    v_and_b32 v7, -4, v52
    v_lshl_add_u32 v8, v52, 2, v7
    ds_write_b32 v8, v48
    v_lshl_add_u32 v7, v7, 2, v52
    ds_write_b8 v7, v44 offset:16
    v_and_b32 v9, -4, v53
    v_lshl_add_u32 v10, v53, 2, v9
    ds_write_b32 v10, v49
    v_lshl_add_u32 v9, v9, 2, v53
    ds_write_b8_d16_hi v9, v44 offset:16
    v_and_b32 v7, -4, v54
    v_lshl_add_u32 v8, v54, 2, v7
    ds_write_b32 v8, v50
    v_lshl_add_u32 v7, v7, 2, v54
    ds_write_b8 v7, v45 offset:16
    v_and_b32 v9, -4, v55
    v_lshl_add_u32 v10, v55, 2, v9
    ds_write_b32 v10, v51
    v_lshl_add_u32 v9, v9, 2, v55
    ds_write_b8_d16_hi v9, v45 offset:16
    s_add_u32 s46, s98, 0x5800000
    buffer_load_dwordx4 v[20:23], v0, s[8:11], s46 offen nt
    s_add_u32 s47, s98, 0x5800000
    buffer_load_dwordx4 v[124:127], v0, s[12:15], s47 offen nt
    v_and_b32 v7, -4, v60
    v_lshl_add_u32 v8, v60, 2, v7
    ds_write_b32 v8, v56
    v_lshl_add_u32 v7, v7, 2, v60
    ds_write_b8 v7, v46 offset:16
    v_and_b32 v9, -4, v61
    v_lshl_add_u32 v10, v61, 2, v9
    ds_write_b32 v10, v57
    v_lshl_add_u32 v9, v9, 2, v61
    ds_write_b8_d16_hi v9, v46 offset:16
    v_and_b32 v7, -4, v62
    v_lshl_add_u32 v8, v62, 2, v7
    ds_write_b32 v8, v58
    v_lshl_add_u32 v7, v7, 2, v62
    ds_write_b8 v7, v47 offset:16
    v_and_b32 v9, -4, v63
    v_lshl_add_u32 v10, v63, 2, v9
    ds_write_b32 v10, v59
    v_lshl_add_u32 v9, v9, 2, v63
    ds_write_b8_d16_hi v9, v47 offset:16
    s_add_u32 s44, s98, 0x5800000
    s_lshr_b32 s44, s44, 1
    buffer_load_dwordx2 v[28:29], v1, s[16:19], s44 offen nt
    s_add_u32 s45, s99, 0x5c00000
    s_lshr_b32 s45, s45, 1
    buffer_load_dwordx2 v[30:31], v1, s[16:19], s45 offen nt
    v_add_u32 v7, s72, v0
    v_add_u32 v12, s73, v0
    v_add_u32 v13, s85, v0
    v_add_u32 v14, s91, v0
    v_add_u32 v15, s93, v0
    s_min_i32 s3, s72, s73
    s_min_i32 s3, s3, s85
    s_min_i32 s3, s3, s91
    s_min_i32 s3, s3, s93
    v_add_u32 v3, s3, v0
    v_mov_b32 v8, 0
    v_mov_b32 v9, 0
    v_mov_b32 v10, 0
    v_mov_b32 v11, 0
    s_waitcnt lgkmcnt(0)
    s_barrier
    ds_read_b128 v[32:35], v7 offset:0
    ds_read_b128 v[36:39], v12 offset:0
    ds_read_b128 v[40:43], v13 offset:0
    ds_read_b128 v[24:27], v14 offset:0
    ds_read_b128 v[84:87], v15 offset:0
    ds_write_b128 v3, v[8:11]
    ds_read_b128 v[48:51], v7 offset:16384
    ds_read_b128 v[52:55], v12 offset:16384
    ds_read_b128 v[56:59], v13 offset:16384
    ds_read_b128 v[60:63], v14 offset:16384
    ds_read_b128 v[44:47], v15 offset:16384
    s_waitcnt lgkmcnt(0)
    s_barrier
    s_setprio 3
    s_add_u32 s46, s35, 0x2a44000
    s_add_u32 s46, s46, s72
    buffer_store_dwordx4 v[32:35], v0, s[20:23], s46 offen sc1
    s_add_u32 s47, s99, 0x5c00000
    s_nop 0
    buffer_load_dwordx4 v[32:35], v0, s[8:11], s47 offen nt
    s_add_u32 s44, s35, 0x2a44000
    s_add_u32 s44, s44, s73
    buffer_store_dwordx4 v[36:39], v0, s[20:23], s44 offen sc1
    s_add_u32 s45, s99, 0x5c00000
    s_nop 0
    buffer_load_dwordx4 v[36:39], v0, s[12:15], s45 offen nt
    s_waitcnt vmcnt(27)
    v_lshlrev_b32 v7, 16, v64
    v_and_b32 v8, 0xffff0000, v64
    v_lshlrev_b32 v9, 16, v65
    v_and_b32 v10, 0xffff0000, v65
    v_mul_f32 v7, 0.15915494, v7
    v_mul_f32 v8, 0.15915494, v8
    v_mul_f32 v9, 0.15915494, v9
    v_mul_f32 v10, 0.15915494, v10
    v_mul_hi_u32_u24 v14, 429497, v68
    v_lshrrev_b32 v12, 3, v72
    v_cos_f32 v7, v7
    v_lshlrev_b16 v13, 3, v72
    v_mad_i32_i24 v11, v14, s55, v68
    v_bitop3_b32 v12, v6, v13, v12 bitop3:0xca
    v_lshl_add_u32 v11, v11, 17, s40
    v_lshlrev_b16 v14, 8, v14
    v_lshrrev_b32 v13, 2, v72
    v_add_u32 v68, v12, v11
    v_bitop3_b32 v72, v5, v13, v14 bitop3:0xea
    ds_add_u32 v72, v2
    v_mul_hi_u32_u24 v14, 429497, v69
    v_lshrrev_b32 v12, 3, v73
    v_cos_f32 v8, v8
    v_lshlrev_b16 v13, 3, v73
    v_mad_i32_i24 v11, v14, s55, v69
    v_bitop3_b32 v12, v6, v13, v12 bitop3:0xca
    v_lshl_add_u32 v11, v11, 17, s40
    v_lshlrev_b16 v14, 8, v14
    v_lshrrev_b32 v13, 2, v73
    v_add_u32 v69, v12, v11
    v_bitop3_b32 v73, v5, v13, v14 bitop3:0xea
    ds_add_u32 v73, v2
    v_cvt_pk_bf16_f32 v64, v7, v8
    v_perm_b32 v12, v64, v64, s41
    v_bitop3_b32 v68, v4, v12, v68 bitop3:0xca
    v_perm_b32 v13, v64, v64, s42
    v_bitop3_b32 v69, v4, v13, v69 bitop3:0xca
    v_mul_hi_u32_u24 v14, 429497, v70
    v_lshrrev_b32 v12, 3, v74
    v_cos_f32 v9, v9
    v_lshlrev_b16 v13, 3, v74
    v_mad_i32_i24 v11, v14, s55, v70
    v_bitop3_b32 v12, v6, v13, v12 bitop3:0xca
    v_lshl_add_u32 v11, v11, 17, s40
    v_lshlrev_b16 v14, 8, v14
    v_lshrrev_b32 v13, 2, v74
    v_add_u32 v70, v12, v11
    v_bitop3_b32 v74, v5, v13, v14 bitop3:0xea
    ds_add_u32 v74, v2
    v_mul_hi_u32_u24 v14, 429497, v71
    v_lshrrev_b32 v12, 3, v75
    v_cos_f32 v10, v10
    v_lshlrev_b16 v13, 3, v75
    v_mad_i32_i24 v11, v14, s55, v71
    v_bitop3_b32 v12, v6, v13, v12 bitop3:0xca
    v_lshl_add_u32 v11, v11, 17, s40
    v_lshlrev_b16 v14, 8, v14
    v_lshrrev_b32 v13, 2, v75
    v_add_u32 v71, v12, v11
    v_bitop3_b32 v75, v5, v13, v14 bitop3:0xea
    ds_add_u32 v75, v2
    v_cvt_pk_bf16_f32 v65, v9, v10
    v_perm_b32 v12, v65, v65, s41
    v_bitop3_b32 v70, v4, v12, v70 bitop3:0xca
    v_perm_b32 v13, v65, v65, s42
    v_bitop3_b32 v71, v4, v13, v71 bitop3:0xca
    s_waitcnt vmcnt(23)
    v_lshlrev_b32 v7, 16, v66
    v_and_b32 v8, 0xffff0000, v66
    v_lshlrev_b32 v9, 16, v67
    v_and_b32 v10, 0xffff0000, v67
    v_mul_f32 v7, 0.15915494, v7
    v_mul_f32 v8, 0.15915494, v8
    v_mul_f32 v9, 0.15915494, v9
    v_mul_f32 v10, 0.15915494, v10
    v_mul_hi_u32_u24 v14, 429497, v76
    v_lshrrev_b32 v12, 3, v80
    v_cos_f32 v7, v7
    v_lshlrev_b16 v13, 3, v80
    v_mad_i32_i24 v11, v14, s55, v76
    v_bitop3_b32 v12, v6, v13, v12 bitop3:0xca
    v_lshl_add_u32 v11, v11, 17, s40
    v_lshlrev_b16 v14, 8, v14
    v_lshrrev_b32 v13, 2, v80
    v_add_u32 v76, v12, v11
    v_bitop3_b32 v80, v5, v13, v14 bitop3:0xea
    ds_add_u32 v80, v2
    v_mul_hi_u32_u24 v14, 429497, v77
    v_lshrrev_b32 v12, 3, v81
    v_cos_f32 v8, v8
    v_lshlrev_b16 v13, 3, v81
    v_mad_i32_i24 v11, v14, s55, v77
    v_bitop3_b32 v12, v6, v13, v12 bitop3:0xca
    v_lshl_add_u32 v11, v11, 17, s40
    v_lshlrev_b16 v14, 8, v14
    v_lshrrev_b32 v13, 2, v81
    v_add_u32 v77, v12, v11
    v_bitop3_b32 v81, v5, v13, v14 bitop3:0xea
    ds_add_u32 v81, v2
    v_cvt_pk_bf16_f32 v66, v7, v8
    v_perm_b32 v12, v66, v66, s41
    v_bitop3_b32 v76, v4, v12, v76 bitop3:0xca
    v_perm_b32 v13, v66, v66, s42
    v_bitop3_b32 v77, v4, v13, v77 bitop3:0xca
    v_mul_hi_u32_u24 v14, 429497, v78
    v_lshrrev_b32 v12, 3, v82
    v_cos_f32 v9, v9
    v_lshlrev_b16 v13, 3, v82
    v_mad_i32_i24 v11, v14, s55, v78
    v_bitop3_b32 v12, v6, v13, v12 bitop3:0xca
    v_lshl_add_u32 v11, v11, 17, s40
    v_lshlrev_b16 v14, 8, v14
    v_lshrrev_b32 v13, 2, v82
    v_add_u32 v78, v12, v11
    v_bitop3_b32 v82, v5, v13, v14 bitop3:0xea
    ds_add_u32 v82, v2
    v_mul_hi_u32_u24 v14, 429497, v79
    v_lshrrev_b32 v12, 3, v83
    v_cos_f32 v10, v10
    v_lshlrev_b16 v13, 3, v83
    v_mad_i32_i24 v11, v14, s55, v79
    v_bitop3_b32 v12, v6, v13, v12 bitop3:0xca
    v_lshl_add_u32 v11, v11, 17, s40
    v_lshlrev_b16 v14, 8, v14
    v_lshrrev_b32 v13, 2, v83
    v_add_u32 v79, v12, v11
    v_bitop3_b32 v83, v5, v13, v14 bitop3:0xea
    ds_add_u32 v83, v2
    v_cvt_pk_bf16_f32 v67, v9, v10
    v_perm_b32 v12, v67, v67, s41
    v_bitop3_b32 v78, v4, v12, v78 bitop3:0xca
    v_perm_b32 v13, v67, v67, s42
    v_bitop3_b32 v79, v4, v13, v79 bitop3:0xca
    s_setprio 2
    s_waitcnt vmcnt(18)
    v_lshlrev_b32 v7, 16, v88
    v_and_b32 v8, 0xffff0000, v88
    v_lshlrev_b32 v9, 16, v89
    v_and_b32 v10, 0xffff0000, v89
    v_mul_f32 v7, 0.15915494, v7
    v_mul_f32 v8, 0.15915494, v8
    v_mul_f32 v9, 0.15915494, v9
    v_mul_f32 v10, 0.15915494, v10
    v_mul_hi_u32_u24 v14, 429497, v96
    v_lshrrev_b32 v12, 3, v104
    v_cos_f32 v7, v7
    v_lshlrev_b16 v13, 3, v104
    v_mad_i32_i24 v11, v14, s55, v96
    v_bitop3_b32 v12, v6, v13, v12 bitop3:0xca
    v_lshl_add_u32 v11, v11, 17, s40
    v_lshlrev_b16 v14, 8, v14
    v_lshrrev_b32 v13, 2, v104
    v_add_u32 v96, v12, v11
    v_bitop3_b32 v104, v5, v13, v14 bitop3:0xea
    ds_add_u32 v104, v2
    v_mul_hi_u32_u24 v14, 429497, v97
    v_lshrrev_b32 v12, 3, v105
    v_cos_f32 v8, v8
    v_lshlrev_b16 v13, 3, v105
    v_mad_i32_i24 v11, v14, s55, v97
    v_bitop3_b32 v12, v6, v13, v12 bitop3:0xca
    v_lshl_add_u32 v11, v11, 17, s40
    v_lshlrev_b16 v14, 8, v14
    v_lshrrev_b32 v13, 2, v105
    v_add_u32 v97, v12, v11
    v_bitop3_b32 v105, v5, v13, v14 bitop3:0xea
    ds_add_u32 v105, v2
    v_cvt_pk_bf16_f32 v88, v7, v8
    v_perm_b32 v12, v88, v88, s41
    v_bitop3_b32 v96, v4, v12, v96 bitop3:0xca
    v_perm_b32 v13, v88, v88, s42
    v_bitop3_b32 v97, v4, v13, v97 bitop3:0xca
    v_mul_hi_u32_u24 v14, 429497, v98
    v_lshrrev_b32 v12, 3, v106
    v_cos_f32 v9, v9
    v_lshlrev_b16 v13, 3, v106
    v_mad_i32_i24 v11, v14, s55, v98
    v_bitop3_b32 v12, v6, v13, v12 bitop3:0xca
    v_lshl_add_u32 v11, v11, 17, s40
    v_lshlrev_b16 v14, 8, v14
    v_lshrrev_b32 v13, 2, v106
    v_add_u32 v98, v12, v11
    v_bitop3_b32 v106, v5, v13, v14 bitop3:0xea
    ds_add_u32 v106, v2
    v_mul_hi_u32_u24 v14, 429497, v99
    v_lshrrev_b32 v12, 3, v107
    v_cos_f32 v10, v10
    v_lshlrev_b16 v13, 3, v107
    v_mad_i32_i24 v11, v14, s55, v99
    v_bitop3_b32 v12, v6, v13, v12 bitop3:0xca
    v_lshl_add_u32 v11, v11, 17, s40
    v_lshlrev_b16 v14, 8, v14
    v_lshrrev_b32 v13, 2, v107
    v_add_u32 v99, v12, v11
    v_bitop3_b32 v107, v5, v13, v14 bitop3:0xea
    ds_add_u32 v107, v2
    v_cvt_pk_bf16_f32 v89, v9, v10
    v_perm_b32 v12, v89, v89, s41
    v_bitop3_b32 v98, v4, v12, v98 bitop3:0xca
    v_perm_b32 v13, v89, v89, s42
    v_bitop3_b32 v99, v4, v13, v99 bitop3:0xca
    s_add_u32 s46, s35, 0x2a44000
    s_add_u32 s46, s46, s85
    buffer_store_dwordx4 v[40:43], v0, s[20:23], s46 offen sc1
    s_add_u32 s47, s96, 0x6000000
    s_nop 0
    buffer_load_dwordx4 v[40:43], v0, s[8:11], s47 offen nt
    s_waitcnt vmcnt(17)
    v_lshlrev_b32 v7, 16, v90
    v_and_b32 v8, 0xffff0000, v90
    v_lshlrev_b32 v9, 16, v91
    v_and_b32 v10, 0xffff0000, v91
    v_mul_f32 v7, 0.15915494, v7
    v_mul_f32 v8, 0.15915494, v8
    v_mul_f32 v9, 0.15915494, v9
    v_mul_f32 v10, 0.15915494, v10
    v_mul_hi_u32_u24 v14, 429497, v112
    v_lshrrev_b32 v12, 3, v100
    v_cos_f32 v7, v7
    v_lshlrev_b16 v13, 3, v100
    v_mad_i32_i24 v11, v14, s55, v112
    v_bitop3_b32 v12, v6, v13, v12 bitop3:0xca
    v_lshl_add_u32 v11, v11, 17, s40
    v_lshlrev_b16 v14, 8, v14
    v_lshrrev_b32 v13, 2, v100
    v_add_u32 v112, v12, v11
    v_bitop3_b32 v100, v5, v13, v14 bitop3:0xea
    ds_add_u32 v100, v2
    v_mul_hi_u32_u24 v14, 429497, v113
    v_lshrrev_b32 v12, 3, v101
    v_cos_f32 v8, v8
    v_lshlrev_b16 v13, 3, v101
    v_mad_i32_i24 v11, v14, s55, v113
    v_bitop3_b32 v12, v6, v13, v12 bitop3:0xca
    v_lshl_add_u32 v11, v11, 17, s40
    v_lshlrev_b16 v14, 8, v14
    v_lshrrev_b32 v13, 2, v101
    v_add_u32 v113, v12, v11
    v_bitop3_b32 v101, v5, v13, v14 bitop3:0xea
    ds_add_u32 v101, v2
    v_cvt_pk_bf16_f32 v90, v7, v8
    v_perm_b32 v12, v90, v90, s41
    v_bitop3_b32 v112, v4, v12, v112 bitop3:0xca
    v_perm_b32 v13, v90, v90, s42
    v_bitop3_b32 v113, v4, v13, v113 bitop3:0xca
    v_mul_hi_u32_u24 v14, 429497, v114
    v_lshrrev_b32 v12, 3, v102
    v_cos_f32 v9, v9
    v_lshlrev_b16 v13, 3, v102
    v_mad_i32_i24 v11, v14, s55, v114
    v_bitop3_b32 v12, v6, v13, v12 bitop3:0xca
    v_lshl_add_u32 v11, v11, 17, s40
    v_lshlrev_b16 v14, 8, v14
    v_lshrrev_b32 v13, 2, v102
    v_add_u32 v114, v12, v11
    v_bitop3_b32 v102, v5, v13, v14 bitop3:0xea
    ds_add_u32 v102, v2
    v_mul_hi_u32_u24 v14, 429497, v115
    v_lshrrev_b32 v12, 3, v103
    v_cos_f32 v10, v10
    v_lshlrev_b16 v13, 3, v103
    v_mad_i32_i24 v11, v14, s55, v115
    v_bitop3_b32 v12, v6, v13, v12 bitop3:0xca
    v_lshl_add_u32 v11, v11, 17, s40
    v_lshlrev_b16 v14, 8, v14
    v_lshrrev_b32 v13, 2, v103
    v_add_u32 v115, v12, v11
    v_bitop3_b32 v103, v5, v13, v14 bitop3:0xea
    ds_add_u32 v103, v2
    v_cvt_pk_bf16_f32 v91, v9, v10
    v_perm_b32 v12, v91, v91, s41
    v_bitop3_b32 v114, v4, v12, v114 bitop3:0xca
    v_perm_b32 v13, v91, v91, s42
    v_bitop3_b32 v115, v4, v13, v115 bitop3:0xca
    s_setprio 1
    s_waitcnt vmcnt(13)
    v_lshlrev_b32 v7, 16, v120
    v_and_b32 v8, 0xffff0000, v120
    v_lshlrev_b32 v9, 16, v121
    v_and_b32 v10, 0xffff0000, v121
    v_mul_f32 v7, 0.15915494, v7
    v_mul_f32 v8, 0.15915494, v8
    v_mul_f32 v9, 0.15915494, v9
    v_mul_f32 v10, 0.15915494, v10
    v_mul_hi_u32_u24 v14, 429497, v108
    v_lshrrev_b32 v12, 3, v116
    v_cos_f32 v7, v7
    v_lshlrev_b16 v13, 3, v116
    v_mad_i32_i24 v11, v14, s55, v108
    v_bitop3_b32 v12, v6, v13, v12 bitop3:0xca
    v_lshl_add_u32 v11, v11, 17, s40
    v_lshlrev_b16 v14, 8, v14
    v_lshrrev_b32 v13, 2, v116
    v_add_u32 v108, v12, v11
    v_bitop3_b32 v116, v5, v13, v14 bitop3:0xea
    ds_add_u32 v116, v2
    v_mul_hi_u32_u24 v14, 429497, v109
    v_lshrrev_b32 v12, 3, v117
    v_cos_f32 v8, v8
    v_lshlrev_b16 v13, 3, v117
    v_mad_i32_i24 v11, v14, s55, v109
    v_bitop3_b32 v12, v6, v13, v12 bitop3:0xca
    v_lshl_add_u32 v11, v11, 17, s40
    v_lshlrev_b16 v14, 8, v14
    v_lshrrev_b32 v13, 2, v117
    v_add_u32 v109, v12, v11
    v_bitop3_b32 v117, v5, v13, v14 bitop3:0xea
    ds_add_u32 v117, v2
    v_cvt_pk_bf16_f32 v120, v7, v8
    v_perm_b32 v12, v120, v120, s41
    v_bitop3_b32 v108, v4, v12, v108 bitop3:0xca
    v_perm_b32 v13, v120, v120, s42
    v_bitop3_b32 v109, v4, v13, v109 bitop3:0xca
    v_mul_hi_u32_u24 v14, 429497, v110
    v_lshrrev_b32 v12, 3, v118
    v_cos_f32 v9, v9
    v_lshlrev_b16 v13, 3, v118
    v_mad_i32_i24 v11, v14, s55, v110
    v_bitop3_b32 v12, v6, v13, v12 bitop3:0xca
    v_lshl_add_u32 v11, v11, 17, s40
    v_lshlrev_b16 v14, 8, v14
    v_lshrrev_b32 v13, 2, v118
    v_add_u32 v110, v12, v11
    v_bitop3_b32 v118, v5, v13, v14 bitop3:0xea
    ds_add_u32 v118, v2
    v_mul_hi_u32_u24 v14, 429497, v111
    v_lshrrev_b32 v12, 3, v119
    v_cos_f32 v10, v10
    v_lshlrev_b16 v13, 3, v119
    v_mad_i32_i24 v11, v14, s55, v111
    v_bitop3_b32 v12, v6, v13, v12 bitop3:0xca
    v_lshl_add_u32 v11, v11, 17, s40
    v_lshlrev_b16 v14, 8, v14
    v_lshrrev_b32 v13, 2, v119
    v_add_u32 v111, v12, v11
    v_bitop3_b32 v119, v5, v13, v14 bitop3:0xea
    ds_add_u32 v119, v2
    v_cvt_pk_bf16_f32 v121, v9, v10
    v_perm_b32 v12, v121, v121, s41
    v_bitop3_b32 v110, v4, v12, v110 bitop3:0xca
    v_perm_b32 v13, v121, v121, s42
    v_bitop3_b32 v111, v4, v13, v111 bitop3:0xca
    s_waitcnt vmcnt(10)
    v_lshlrev_b32 v7, 16, v122
    v_and_b32 v8, 0xffff0000, v122
    v_lshlrev_b32 v9, 16, v123
    v_and_b32 v10, 0xffff0000, v123
    v_mul_f32 v7, 0.15915494, v7
    v_mul_f32 v8, 0.15915494, v8
    v_mul_f32 v9, 0.15915494, v9
    v_mul_f32 v10, 0.15915494, v10
    v_mul_hi_u32_u24 v14, 429497, v92
    v_lshrrev_b32 v12, 3, v16
    v_cos_f32 v7, v7
    v_lshlrev_b16 v13, 3, v16
    v_mad_i32_i24 v11, v14, s55, v92
    v_bitop3_b32 v12, v6, v13, v12 bitop3:0xca
    v_lshl_add_u32 v11, v11, 17, s40
    v_lshlrev_b16 v14, 8, v14
    v_lshrrev_b32 v13, 2, v16
    v_add_u32 v92, v12, v11
    v_bitop3_b32 v16, v5, v13, v14 bitop3:0xea
    ds_add_u32 v16, v2
    v_mul_hi_u32_u24 v14, 429497, v93
    v_lshrrev_b32 v12, 3, v17
    v_cos_f32 v8, v8
    v_lshlrev_b16 v13, 3, v17
    v_mad_i32_i24 v11, v14, s55, v93
    v_bitop3_b32 v12, v6, v13, v12 bitop3:0xca
    v_lshl_add_u32 v11, v11, 17, s40
    v_lshlrev_b16 v14, 8, v14
    v_lshrrev_b32 v13, 2, v17
    v_add_u32 v93, v12, v11
    v_bitop3_b32 v17, v5, v13, v14 bitop3:0xea
    ds_add_u32 v17, v2
    v_cvt_pk_bf16_f32 v122, v7, v8
    v_perm_b32 v12, v122, v122, s41
    v_bitop3_b32 v92, v4, v12, v92 bitop3:0xca
    v_perm_b32 v13, v122, v122, s42
    v_bitop3_b32 v93, v4, v13, v93 bitop3:0xca
    v_mul_hi_u32_u24 v14, 429497, v94
    v_lshrrev_b32 v12, 3, v18
    v_cos_f32 v9, v9
    v_lshlrev_b16 v13, 3, v18
    v_mad_i32_i24 v11, v14, s55, v94
    v_bitop3_b32 v12, v6, v13, v12 bitop3:0xca
    v_lshl_add_u32 v11, v11, 17, s40
    v_lshlrev_b16 v14, 8, v14
    v_lshrrev_b32 v13, 2, v18
    v_add_u32 v94, v12, v11
    v_bitop3_b32 v18, v5, v13, v14 bitop3:0xea
    ds_add_u32 v18, v2
    v_mul_hi_u32_u24 v14, 429497, v95
    v_lshrrev_b32 v12, 3, v19
    v_cos_f32 v10, v10
    v_lshlrev_b16 v13, 3, v19
    v_mad_i32_i24 v11, v14, s55, v95
    v_bitop3_b32 v12, v6, v13, v12 bitop3:0xca
    v_lshl_add_u32 v11, v11, 17, s40
    v_lshlrev_b16 v14, 8, v14
    v_lshrrev_b32 v13, 2, v19
    v_add_u32 v95, v12, v11
    v_bitop3_b32 v19, v5, v13, v14 bitop3:0xea
    ds_add_u32 v19, v2
    v_cvt_pk_bf16_f32 v123, v9, v10
    v_perm_b32 v12, v123, v123, s41
    v_bitop3_b32 v94, v4, v12, v94 bitop3:0xca
    v_perm_b32 v13, v123, v123, s42
    v_bitop3_b32 v95, v4, v13, v95 bitop3:0xca
    s_setprio 0
    s_add_u32 s44, s35, 0x2a44000
    s_add_u32 s44, s44, s91
    buffer_store_dwordx4 v[24:27], v0, s[20:23], s44 offen sc1
    s_add_u32 s45, s96, 0x6000000
    s_nop 0
    buffer_load_dwordx4 v[24:27], v0, s[12:15], s45 offen nt
    s_waitcnt vmcnt(8)
    v_lshlrev_b32 v7, 16, v28
    v_and_b32 v8, 0xffff0000, v28
    v_lshlrev_b32 v9, 16, v29
    v_and_b32 v10, 0xffff0000, v29
    v_mul_f32 v7, 0.15915494, v7
    v_mul_f32 v8, 0.15915494, v8
    v_mul_f32 v9, 0.15915494, v9
    v_mul_f32 v10, 0.15915494, v10
    v_mul_hi_u32_u24 v14, 429497, v20
    v_lshrrev_b32 v12, 3, v124
    v_cos_f32 v7, v7
    v_lshlrev_b16 v13, 3, v124
    v_mad_i32_i24 v11, v14, s55, v20
    v_bitop3_b32 v12, v6, v13, v12 bitop3:0xca
    v_lshl_add_u32 v11, v11, 17, s40
    v_lshlrev_b16 v14, 8, v14
    v_lshrrev_b32 v13, 2, v124
    v_add_u32 v20, v12, v11
    v_bitop3_b32 v124, v5, v13, v14 bitop3:0xea
    ds_add_u32 v124, v2
    v_mul_hi_u32_u24 v14, 429497, v21
    v_lshrrev_b32 v12, 3, v125
    v_cos_f32 v8, v8
    v_lshlrev_b16 v13, 3, v125
    v_mad_i32_i24 v11, v14, s55, v21
    v_bitop3_b32 v12, v6, v13, v12 bitop3:0xca
    v_lshl_add_u32 v11, v11, 17, s40
    v_lshlrev_b16 v14, 8, v14
    v_lshrrev_b32 v13, 2, v125
    v_add_u32 v21, v12, v11
    v_bitop3_b32 v125, v5, v13, v14 bitop3:0xea
    ds_add_u32 v125, v2
    v_cvt_pk_bf16_f32 v28, v7, v8
    v_perm_b32 v12, v28, v28, s41
    v_bitop3_b32 v20, v4, v12, v20 bitop3:0xca
    v_perm_b32 v13, v28, v28, s42
    v_bitop3_b32 v21, v4, v13, v21 bitop3:0xca
    v_mul_hi_u32_u24 v14, 429497, v22
    v_lshrrev_b32 v12, 3, v126
    v_cos_f32 v9, v9
    v_lshlrev_b16 v13, 3, v126
    v_mad_i32_i24 v11, v14, s55, v22
    v_bitop3_b32 v12, v6, v13, v12 bitop3:0xca
    v_lshl_add_u32 v11, v11, 17, s40
    v_lshlrev_b16 v14, 8, v14
    v_lshrrev_b32 v13, 2, v126
    v_add_u32 v22, v12, v11
    v_bitop3_b32 v126, v5, v13, v14 bitop3:0xea
    ds_add_u32 v126, v2
    v_mul_hi_u32_u24 v14, 429497, v23
    v_lshrrev_b32 v12, 3, v127
    v_cos_f32 v10, v10
    v_lshlrev_b16 v13, 3, v127
    v_mad_i32_i24 v11, v14, s55, v23
    v_bitop3_b32 v12, v6, v13, v12 bitop3:0xca
    v_lshl_add_u32 v11, v11, 17, s40
    v_lshlrev_b16 v14, 8, v14
    v_lshrrev_b32 v13, 2, v127
    v_add_u32 v23, v12, v11
    v_bitop3_b32 v127, v5, v13, v14 bitop3:0xea
    ds_add_u32 v127, v2
    v_cvt_pk_bf16_f32 v29, v9, v10
    v_perm_b32 v12, v29, v29, s41
    v_bitop3_b32 v22, v4, v12, v22 bitop3:0xca
    v_perm_b32 v13, v29, v29, s42
    v_bitop3_b32 v23, v4, v13, v23 bitop3:0xca
    s_waitcnt vmcnt(4)
    v_lshlrev_b32 v7, 16, v30
    v_and_b32 v8, 0xffff0000, v30
    v_lshlrev_b32 v9, 16, v31
    v_and_b32 v10, 0xffff0000, v31
    v_mul_f32 v7, 0.15915494, v7
    v_mul_f32 v8, 0.15915494, v8
    v_mul_f32 v9, 0.15915494, v9
    v_mul_f32 v10, 0.15915494, v10
    v_mul_hi_u32_u24 v14, 429497, v32
    v_lshrrev_b32 v12, 3, v36
    v_cos_f32 v7, v7
    v_lshlrev_b16 v13, 3, v36
    v_mad_i32_i24 v11, v14, s55, v32
    v_bitop3_b32 v12, v6, v13, v12 bitop3:0xca
    v_lshl_add_u32 v11, v11, 17, s40
    v_lshlrev_b16 v14, 8, v14
    v_lshrrev_b32 v13, 2, v36
    v_add_u32 v32, v12, v11
    v_bitop3_b32 v36, v5, v13, v14 bitop3:0xea
    ds_add_u32 v36, v2
    v_mul_hi_u32_u24 v14, 429497, v33
    v_lshrrev_b32 v12, 3, v37
    v_cos_f32 v8, v8
    v_lshlrev_b16 v13, 3, v37
    v_mad_i32_i24 v11, v14, s55, v33
    v_bitop3_b32 v12, v6, v13, v12 bitop3:0xca
    v_lshl_add_u32 v11, v11, 17, s40
    v_lshlrev_b16 v14, 8, v14
    v_lshrrev_b32 v13, 2, v37
    v_add_u32 v33, v12, v11
    v_bitop3_b32 v37, v5, v13, v14 bitop3:0xea
    ds_add_u32 v37, v2
    v_cvt_pk_bf16_f32 v30, v7, v8
    v_perm_b32 v12, v30, v30, s41
    v_bitop3_b32 v32, v4, v12, v32 bitop3:0xca
    v_perm_b32 v13, v30, v30, s42
    v_bitop3_b32 v33, v4, v13, v33 bitop3:0xca
    v_mul_hi_u32_u24 v14, 429497, v34
    v_lshrrev_b32 v12, 3, v38
    v_cos_f32 v9, v9
    v_lshlrev_b16 v13, 3, v38
    v_mad_i32_i24 v11, v14, s55, v34
    v_bitop3_b32 v12, v6, v13, v12 bitop3:0xca
    v_lshl_add_u32 v11, v11, 17, s40
    v_lshlrev_b16 v14, 8, v14
    v_lshrrev_b32 v13, 2, v38
    v_add_u32 v34, v12, v11
    v_bitop3_b32 v38, v5, v13, v14 bitop3:0xea
    ds_add_u32 v38, v2
    v_mul_hi_u32_u24 v14, 429497, v35
    v_lshrrev_b32 v12, 3, v39
    v_cos_f32 v10, v10
    v_lshlrev_b16 v13, 3, v39
    v_mad_i32_i24 v11, v14, s55, v35
    v_bitop3_b32 v12, v6, v13, v12 bitop3:0xca
    v_lshl_add_u32 v11, v11, 17, s40
    v_lshlrev_b16 v14, 8, v14
    v_lshrrev_b32 v13, 2, v39
    v_add_u32 v35, v12, v11
    v_bitop3_b32 v39, v5, v13, v14 bitop3:0xea
    ds_add_u32 v39, v2
    v_cvt_pk_bf16_f32 v31, v9, v10
    v_perm_b32 v12, v31, v31, s41
    v_bitop3_b32 v34, v4, v12, v34 bitop3:0xca
    v_perm_b32 v13, v31, v31, s42
    v_bitop3_b32 v35, v4, v13, v35 bitop3:0xca
    v_lshrrev_b32 v8, 2, v0
    v_and_b32 v7, 0x3c00, v0
    v_bitop3_b32 v7, v5, v8, v7 bitop3:0xea
    s_waitcnt lgkmcnt(0)
    s_barrier
    ds_read2st64_b32 v[8:9], v7 offset0:0 offset1:1
    ds_read2st64_b32 v[10:11], v7 offset0:2 offset1:3
    s_add_u32 s46, s35, 0x2a44000
    s_add_u32 s46, s46, s93
    buffer_store_dwordx4 v[84:87], v0, s[20:23], s46 offen sc1
    s_add_u32 s47, s96, 0x6000000
    s_lshr_b32 s47, s47, 1
    buffer_load_dwordx2 v[84:85], v1, s[16:19], s47 offen nt
    s_add_u32 s44, s97, 0x6400000
    s_lshr_b32 s44, s44, 1
    buffer_load_dwordx2 v[86:87], v1, s[16:19], s44 offen nt
    s_waitcnt lgkmcnt(0)
    v_lshl_or_b32 v12, v9, 16, v8
    v_lshl_or_b32 v13, v11, 16, v10
    v_mov_b32 v14, v12
    v_mov_b32 v15, v13
    s_nop 0
    v_add_u32_dpp v14, v14, v14 row_shr:1 row_mask:0xf bank_mask:0xf bound_ctrl:1
    v_add_u32_dpp v15, v15, v15 row_shr:1 row_mask:0xf bank_mask:0xf bound_ctrl:1
    s_nop 0
    v_add_u32_dpp v14, v14, v14 row_shr:2 row_mask:0xf bank_mask:0xf bound_ctrl:1
    v_add_u32_dpp v15, v15, v15 row_shr:2 row_mask:0xf bank_mask:0xf bound_ctrl:1
    s_nop 0
    v_add_u32_dpp v14, v14, v14 row_shr:4 row_mask:0xf bank_mask:0xf bound_ctrl:1
    v_add_u32_dpp v15, v15, v15 row_shr:4 row_mask:0xf bank_mask:0xf bound_ctrl:1
    s_nop 0
    v_add_u32_dpp v14, v14, v14 row_shr:8 row_mask:0xf bank_mask:0xf bound_ctrl:1
    v_add_u32_dpp v15, v15, v15 row_shr:8 row_mask:0xf bank_mask:0xf bound_ctrl:1
    s_nop 0
    v_add_u32_dpp v14, v14, v14 row_bcast:15 row_mask:0xa bank_mask:0xf
    v_add_u32_dpp v15, v15, v15 row_bcast:15 row_mask:0xa bank_mask:0xf
    s_nop 0
    v_add_u32_dpp v14, v14, v14 row_bcast:31 row_mask:0xc bank_mask:0xf
    v_add_u32_dpp v15, v15, v15 row_bcast:31 row_mask:0xc bank_mask:0xf
    v_readlane_b32 s48, v14, 63
    v_readlane_b32 s49, v15, 63
    s_lshl_b32 s54, s32, 2
    v_mov_b32 v8, s54
    s_and_b32 s50, s48, 0xffff
    s_lshr_b32 s51, s48, 16
    s_and_b32 s52, s49, 0xffff
    s_lshr_b32 s53, s49, 16
    s_add_u32 s51, s51, s50
    s_add_u32 s52, s52, s51
    s_add_u32 s53, s53, s52
    v_mov_b32 v9, s53
    s_mov_b64 exec, 1
    ds_write_b32 v8, v9 offset:16384
    s_mov_b64 exec, -1
    v_and_b32 v8, 60, v7
    s_waitcnt lgkmcnt(0)
    s_barrier
    ds_read_b32 v9, v8 offset:16384
    s_waitcnt lgkmcnt(0)
    v_add_u32_dpp v9, v9, v9 row_shr:1 row_mask:0xf bank_mask:0xf bound_ctrl:1
    s_nop 1
    v_add_u32_dpp v9, v9, v9 row_shr:2 row_mask:0xf bank_mask:0xf bound_ctrl:1
    s_nop 1
    v_add_u32_dpp v9, v9, v9 row_shr:4 row_mask:0xf bank_mask:0xf bound_ctrl:1
    s_nop 1
    v_add_u32_dpp v9, v9, v9 row_shr:8 row_mask:0xf bank_mask:0xf bound_ctrl:1
    s_nop 0
    v_readlane_b32 s54, v9, s32
    s_sub_u32 s54, s54, s53
    s_add_u32 s50, s50, s54
    s_add_u32 s51, s51, s54
    s_add_u32 s52, s52, s54
    s_pack_ll_b32_b16 s48, s54, s50
    s_pack_ll_b32_b16 s49, s51, s52
    v_add_u32 v14, s48, v14
    v_add_u32 v15, s49, v15
    v_sub_u32 v12, v14, v12
    v_sub_u32 v13, v15, v13
    v_and_b32 v8, 0xffff, v12
    v_lshrrev_b32 v9, 16, v12
    v_and_b32 v10, 0xffff, v13
    v_lshrrev_b32 v11, 16, v13
    ds_write2st64_b32 v7, v8, v9 offset0:0 offset1:1
    ds_write2st64_b32 v7, v10, v11 offset0:2 offset1:3
    v_and_b32 v8, 0x3f0, v0
    v_lshl_add_u32 v8, v8, 1, s36
    ds_write_b64 v8, v[12:13] offset:20480
    s_bitset0_b64 exec, 63
    s_not_b64 exec, exec
    ds_write_b64 v8, v[14:15] offset:20512
    s_mov_b64 exec, -1
    s_waitcnt lgkmcnt(0)
    s_barrier
    s_setprio 3
    ds_add_rtn_u32 v72, v72, v2
    ds_add_rtn_u32 v73, v73, v2
    ds_add_rtn_u32 v74, v74, v2
    ds_add_rtn_u32 v75, v75, v2
    ds_read_b128 v[12:15], v0 offset:20480
    v_cmp_gt_u32 vcc, 8448, v0
    ds_add_rtn_u32 v80, v80, v2
    ds_add_rtn_u32 v81, v81, v2
    ds_add_rtn_u32 v82, v82, v2
    ds_add_rtn_u32 v83, v83, v2
    s_setprio 2
    ds_add_rtn_u32 v104, v104, v2
    ds_add_rtn_u32 v105, v105, v2
    ds_add_rtn_u32 v106, v106, v2
    ds_add_rtn_u32 v107, v107, v2
    s_waitcnt lgkmcnt(8)
    s_cbranch_vccz L1_p3
    s_add_u32 s45, s35, 0x5480000
    s_mov_b64 exec, vcc
    buffer_store_dwordx4 v[12:15], v0, s[24:27], s45 offen sc1
    s_mov_b64 exec, -1
L1_p3:
    s_add_u32 s46, s35, 0x2a48000
    s_add_u32 s46, s46, s72
    buffer_store_dwordx4 v[48:51], v0, s[20:23], s46 offen sc1
    s_add_u32 s47, s97, 0x6400000
    s_nop 0
    buffer_load_dwordx4 v[48:51], v0, s[8:11], s47 offen nt
    ds_add_rtn_u32 v100, v100, v2
    ds_add_rtn_u32 v101, v101, v2
    ds_add_rtn_u32 v102, v102, v2
    ds_add_rtn_u32 v103, v103, v2
    s_setprio 1
    ds_add_rtn_u32 v116, v116, v2
    ds_add_rtn_u32 v117, v117, v2
    ds_add_rtn_u32 v118, v118, v2
    ds_add_rtn_u32 v119, v119, v2
    ds_add_rtn_u32 v16, v16, v2
    ds_add_rtn_u32 v17, v17, v2
    ds_add_rtn_u32 v18, v18, v2
    ds_add_rtn_u32 v19, v19, v2
    s_add_u32 s44, s35, 0x2a48000
    s_add_u32 s44, s44, s73
    buffer_store_dwordx4 v[52:55], v0, s[20:23], s44 offen sc1
    s_add_u32 s45, s97, 0x6400000
    s_nop 0
    buffer_load_dwordx4 v[52:55], v0, s[12:15], s45 offen nt
    s_setprio 0
    ds_add_rtn_u32 v124, v124, v2
    ds_add_rtn_u32 v125, v125, v2
    ds_add_rtn_u32 v126, v126, v2
    ds_add_rtn_u32 v127, v127, v2
    ds_add_rtn_u32 v36, v36, v2
    ds_add_rtn_u32 v37, v37, v2
    ds_add_rtn_u32 v38, v38, v2
    ds_add_rtn_u32 v39, v39, v2
    s_waitcnt lgkmcnt(0)
    s_barrier
    s_setprio 3
    v_and_b32 v7, -4, v72
    v_lshl_add_u32 v8, v72, 2, v7
    ds_write_b32 v8, v68
    v_lshl_add_u32 v7, v7, 2, v72
    ds_write_b8 v7, v64 offset:16
    v_and_b32 v9, -4, v73
    v_lshl_add_u32 v10, v73, 2, v9
    ds_write_b32 v10, v69
    v_lshl_add_u32 v9, v9, 2, v73
    ds_write_b8_d16_hi v9, v64 offset:16
    v_and_b32 v7, -4, v74
    v_lshl_add_u32 v8, v74, 2, v7
    ds_write_b32 v8, v70
    v_lshl_add_u32 v7, v7, 2, v74
    ds_write_b8 v7, v65 offset:16
    v_and_b32 v9, -4, v75
    v_lshl_add_u32 v10, v75, 2, v9
    ds_write_b32 v10, v71
    v_lshl_add_u32 v9, v9, 2, v75
    ds_write_b8_d16_hi v9, v65 offset:16
    s_add_u32 s46, s35, 0x2a48000
    s_add_u32 s46, s46, s85
    buffer_store_dwordx4 v[56:59], v0, s[20:23], s46 offen sc1
    s_add_u32 s47, s98, 0x6800000
    buffer_load_dwordx4 v[68:71], v0, s[8:11], s47 offen nt
    s_add_u32 s44, s98, 0x6800000
    buffer_load_dwordx4 v[72:75], v0, s[12:15], s44 offen nt
    v_and_b32 v7, -4, v80
    v_lshl_add_u32 v8, v80, 2, v7
    ds_write_b32 v8, v76
    v_lshl_add_u32 v7, v7, 2, v80
    ds_write_b8 v7, v66 offset:16
    v_and_b32 v9, -4, v81
    v_lshl_add_u32 v10, v81, 2, v9
    ds_write_b32 v10, v77
    v_lshl_add_u32 v9, v9, 2, v81
    ds_write_b8_d16_hi v9, v66 offset:16
    v_and_b32 v7, -4, v82
    v_lshl_add_u32 v8, v82, 2, v7
    ds_write_b32 v8, v78
    v_lshl_add_u32 v7, v7, 2, v82
    ds_write_b8 v7, v67 offset:16
    v_and_b32 v9, -4, v83
    v_lshl_add_u32 v10, v83, 2, v9
    ds_write_b32 v10, v79
    v_lshl_add_u32 v9, v9, 2, v83
    ds_write_b8_d16_hi v9, v67 offset:16
    s_add_u32 s45, s98, 0x6800000
    s_lshr_b32 s45, s45, 1
    buffer_load_dwordx2 v[56:57], v1, s[16:19], s45 offen nt
    s_add_u32 s46, s99, 0x6c00000
    s_lshr_b32 s46, s46, 1
    buffer_load_dwordx2 v[58:59], v1, s[16:19], s46 offen nt
    s_add_u32 s47, s99, 0x6c00000
    buffer_load_dwordx4 v[76:79], v0, s[8:11], s47 offen nt
    s_setprio 2
    v_and_b32 v7, -4, v104
    v_lshl_add_u32 v8, v104, 2, v7
    ds_write_b32 v8, v96
    v_lshl_add_u32 v7, v7, 2, v104
    ds_write_b8 v7, v88 offset:16
    v_and_b32 v9, -4, v105
    v_lshl_add_u32 v10, v105, 2, v9
    ds_write_b32 v10, v97
    v_lshl_add_u32 v9, v9, 2, v105
    ds_write_b8_d16_hi v9, v88 offset:16
    v_and_b32 v7, -4, v106
    v_lshl_add_u32 v8, v106, 2, v7
    ds_write_b32 v8, v98
    v_lshl_add_u32 v7, v7, 2, v106
    ds_write_b8 v7, v89 offset:16
    v_and_b32 v9, -4, v107
    v_lshl_add_u32 v10, v107, 2, v9
    ds_write_b32 v10, v99
    v_lshl_add_u32 v9, v9, 2, v107
    ds_write_b8_d16_hi v9, v89 offset:16
    s_add_u32 s44, s35, 0x2a48000
    s_add_u32 s44, s44, s91
    buffer_store_dwordx4 v[60:63], v0, s[20:23], s44 offen sc1
    s_add_u32 s45, s99, 0x6c00000
    buffer_load_dwordx4 v[80:83], v0, s[12:15], s45 offen nt
    v_and_b32 v7, -4, v100
    v_lshl_add_u32 v8, v100, 2, v7
    ds_write_b32 v8, v112
    v_lshl_add_u32 v7, v7, 2, v100
    ds_write_b8 v7, v90 offset:16
    v_and_b32 v9, -4, v101
    v_lshl_add_u32 v10, v101, 2, v9
    ds_write_b32 v10, v113
    v_lshl_add_u32 v9, v9, 2, v101
    ds_write_b8_d16_hi v9, v90 offset:16
    v_and_b32 v7, -4, v102
    v_lshl_add_u32 v8, v102, 2, v7
    ds_write_b32 v8, v114
    v_lshl_add_u32 v7, v7, 2, v102
    ds_write_b8 v7, v91 offset:16
    v_and_b32 v9, -4, v103
    v_lshl_add_u32 v10, v103, 2, v9
    ds_write_b32 v10, v115
    v_lshl_add_u32 v9, v9, 2, v103
    ds_write_b8_d16_hi v9, v91 offset:16
    s_add_u32 s46, s96, 0x7000000
    buffer_load_dwordx4 v[64:67], v0, s[8:11], s46 offen nt
    s_add_u32 s47, s96, 0x7000000
    buffer_load_dwordx4 v[96:99], v0, s[12:15], s47 offen nt
    s_setprio 1
    v_and_b32 v7, -4, v116
    v_lshl_add_u32 v8, v116, 2, v7
    ds_write_b32 v8, v108
    v_lshl_add_u32 v7, v7, 2, v116
    ds_write_b8 v7, v120 offset:16
    v_and_b32 v9, -4, v117
    v_lshl_add_u32 v10, v117, 2, v9
    ds_write_b32 v10, v109
    v_lshl_add_u32 v9, v9, 2, v117
    ds_write_b8_d16_hi v9, v120 offset:16
    v_and_b32 v7, -4, v118
    v_lshl_add_u32 v8, v118, 2, v7
    ds_write_b32 v8, v110
    v_lshl_add_u32 v7, v7, 2, v118
    ds_write_b8 v7, v121 offset:16
    v_and_b32 v9, -4, v119
    v_lshl_add_u32 v10, v119, 2, v9
    ds_write_b32 v10, v111
    v_lshl_add_u32 v9, v9, 2, v119
    ds_write_b8_d16_hi v9, v121 offset:16
    s_add_u32 s44, s96, 0x7000000
    s_lshr_b32 s44, s44, 1
    buffer_load_dwordx2 v[104:105], v1, s[16:19], s44 offen nt
    s_add_u32 s45, s97, 0x7400000
    s_lshr_b32 s45, s45, 1
    buffer_load_dwordx2 v[106:107], v1, s[16:19], s45 offen nt
    s_add_u32 s46, s97, 0x7400000
    buffer_load_dwordx4 v[60:63], v0, s[8:11], s46 offen nt
    v_and_b32 v7, -4, v16
    v_lshl_add_u32 v8, v16, 2, v7
    ds_write_b32 v8, v92
    v_lshl_add_u32 v7, v7, 2, v16
    ds_write_b8 v7, v122 offset:16
    v_and_b32 v9, -4, v17
    v_lshl_add_u32 v10, v17, 2, v9
    ds_write_b32 v10, v93
    v_lshl_add_u32 v9, v9, 2, v17
    ds_write_b8_d16_hi v9, v122 offset:16
    v_and_b32 v7, -4, v18
    v_lshl_add_u32 v8, v18, 2, v7
    ds_write_b32 v8, v94
    v_lshl_add_u32 v7, v7, 2, v18
    ds_write_b8 v7, v123 offset:16
    v_and_b32 v9, -4, v19
    v_lshl_add_u32 v10, v19, 2, v9
    ds_write_b32 v10, v95
    v_lshl_add_u32 v9, v9, 2, v19
    ds_write_b8_d16_hi v9, v123 offset:16
    s_add_u32 s47, s35, 0x2a48000
    s_add_u32 s47, s47, s93
    buffer_store_dwordx4 v[44:47], v0, s[20:23], s47 offen sc1
    s_add_u32 s44, s97, 0x7400000
    buffer_load_dwordx4 v[112:115], v0, s[12:15], s44 offen nt
    s_setprio 0
    v_and_b32 v7, -4, v124
    v_lshl_add_u32 v8, v124, 2, v7
    ds_write_b32 v8, v20
    v_lshl_add_u32 v7, v7, 2, v124
    ds_write_b8 v7, v28 offset:16
    v_and_b32 v9, -4, v125
    v_lshl_add_u32 v10, v125, 2, v9
    ds_write_b32 v10, v21
    v_lshl_add_u32 v9, v9, 2, v125
    ds_write_b8_d16_hi v9, v28 offset:16
    v_and_b32 v7, -4, v126
    v_lshl_add_u32 v8, v126, 2, v7
    ds_write_b32 v8, v22
    v_lshl_add_u32 v7, v7, 2, v126
    ds_write_b8 v7, v29 offset:16
    v_and_b32 v9, -4, v127
    v_lshl_add_u32 v10, v127, 2, v9
    ds_write_b32 v10, v23
    v_lshl_add_u32 v9, v9, 2, v127
    ds_write_b8_d16_hi v9, v29 offset:16
    s_add_u32 s45, s98, 0x7800000
    buffer_load_dwordx4 v[100:103], v0, s[8:11], s45 offen nt
    s_add_u32 s46, s98, 0x7800000
    buffer_load_dwordx4 v[88:91], v0, s[12:15], s46 offen nt
    v_and_b32 v7, -4, v36
    v_lshl_add_u32 v8, v36, 2, v7
    ds_write_b32 v8, v32
    v_lshl_add_u32 v7, v7, 2, v36
    ds_write_b8 v7, v30 offset:16
    v_and_b32 v9, -4, v37
    v_lshl_add_u32 v10, v37, 2, v9
    ds_write_b32 v10, v33
    v_lshl_add_u32 v9, v9, 2, v37
    ds_write_b8_d16_hi v9, v30 offset:16
    v_and_b32 v7, -4, v38
    v_lshl_add_u32 v8, v38, 2, v7
    ds_write_b32 v8, v34
    v_lshl_add_u32 v7, v7, 2, v38
    ds_write_b8 v7, v31 offset:16
    v_and_b32 v9, -4, v39
    v_lshl_add_u32 v10, v39, 2, v9
    ds_write_b32 v10, v35
    v_lshl_add_u32 v9, v9, 2, v39
    ds_write_b8_d16_hi v9, v31 offset:16
    s_add_u32 s47, s98, 0x7800000
    s_lshr_b32 s47, s47, 1
    buffer_load_dwordx2 v[108:109], v1, s[16:19], s47 offen nt
    s_add_u32 s44, s99, 0x7c00000
    s_lshr_b32 s44, s44, 1
    buffer_load_dwordx2 v[110:111], v1, s[16:19], s44 offen nt
    v_add_u32 v7, s72, v0
    v_add_u32 v12, s73, v0
    v_add_u32 v13, s85, v0
    v_add_u32 v14, s91, v0
    v_add_u32 v15, s93, v0
    s_min_i32 s3, s72, s73
    s_min_i32 s3, s3, s85
    s_min_i32 s3, s3, s91
    s_min_i32 s3, s3, s93
    v_add_u32 v3, s3, v0
    v_mov_b32 v8, 0
    v_mov_b32 v9, 0
    v_mov_b32 v10, 0
    v_mov_b32 v11, 0
    s_waitcnt lgkmcnt(0)
    s_barrier
    ds_read_b128 v[116:119], v7 offset:0
    ds_read_b128 v[92:95], v12 offset:0
    ds_read_b128 v[16:19], v13 offset:0
    ds_read_b128 v[120:123], v14 offset:0
    ds_read_b128 v[44:47], v15 offset:0
    ds_write_b128 v3, v[8:11]
    ds_read_b128 v[20:23], v7 offset:16384
    ds_read_b128 v[124:127], v12 offset:16384
    ds_read_b128 v[32:35], v13 offset:16384
    ds_read_b128 v[36:39], v14 offset:16384
    ds_read_b128 v[28:31], v15 offset:16384
    s_waitcnt lgkmcnt(0)
    s_barrier
    s_setprio 3
    s_add_u32 s45, s35, 0x5484000
    s_add_u32 s45, s45, s72
    buffer_store_dwordx4 v[116:119], v0, s[20:23], s45 offen sc1
    s_add_u32 s46, s99, 0x7c00000
    s_nop 0
    buffer_load_dwordx4 v[116:119], v0, s[8:11], s46 offen nt
    s_add_u32 s47, s35, 0x5484000
    s_add_u32 s47, s47, s73
    buffer_store_dwordx4 v[92:95], v0, s[20:23], s47 offen sc1
    s_add_u32 s44, s99, 0x7c00000
    s_nop 0
    buffer_load_dwordx4 v[92:95], v0, s[12:15], s44 offen nt
    s_waitcnt vmcnt(27)
    v_lshlrev_b32 v7, 16, v84
    v_and_b32 v8, 0xffff0000, v84
    v_lshlrev_b32 v9, 16, v85
    v_and_b32 v10, 0xffff0000, v85
    v_mul_f32 v7, 0.15915494, v7
    v_mul_f32 v8, 0.15915494, v8
    v_mul_f32 v9, 0.15915494, v9
    v_mul_f32 v10, 0.15915494, v10
    v_mul_hi_u32_u24 v14, 429497, v40
    v_lshrrev_b32 v12, 3, v24
    v_cos_f32 v7, v7
    v_lshlrev_b16 v13, 3, v24
    v_mad_i32_i24 v11, v14, s55, v40
    v_bitop3_b32 v12, v6, v13, v12 bitop3:0xca
    v_lshl_add_u32 v11, v11, 17, s40
    v_lshlrev_b16 v14, 8, v14
    v_lshrrev_b32 v13, 2, v24
    v_add_u32 v40, v12, v11
    v_bitop3_b32 v24, v5, v13, v14 bitop3:0xea
    ds_add_u32 v24, v2
    v_mul_hi_u32_u24 v14, 429497, v41
    v_lshrrev_b32 v12, 3, v25
    v_cos_f32 v8, v8
    v_lshlrev_b16 v13, 3, v25
    v_mad_i32_i24 v11, v14, s55, v41
    v_bitop3_b32 v12, v6, v13, v12 bitop3:0xca
    v_lshl_add_u32 v11, v11, 17, s40
    v_lshlrev_b16 v14, 8, v14
    v_lshrrev_b32 v13, 2, v25
    v_add_u32 v41, v12, v11
    v_bitop3_b32 v25, v5, v13, v14 bitop3:0xea
    ds_add_u32 v25, v2
    v_cvt_pk_bf16_f32 v84, v7, v8
    v_perm_b32 v12, v84, v84, s41
    v_bitop3_b32 v40, v4, v12, v40 bitop3:0xca
    v_perm_b32 v13, v84, v84, s42
    v_bitop3_b32 v41, v4, v13, v41 bitop3:0xca
    v_mul_hi_u32_u24 v14, 429497, v42
    v_lshrrev_b32 v12, 3, v26
    v_cos_f32 v9, v9
    v_lshlrev_b16 v13, 3, v26
    v_mad_i32_i24 v11, v14, s55, v42
    v_bitop3_b32 v12, v6, v13, v12 bitop3:0xca
    v_lshl_add_u32 v11, v11, 17, s40
    v_lshlrev_b16 v14, 8, v14
    v_lshrrev_b32 v13, 2, v26
    v_add_u32 v42, v12, v11
    v_bitop3_b32 v26, v5, v13, v14 bitop3:0xea
    ds_add_u32 v26, v2
    v_mul_hi_u32_u24 v14, 429497, v43
    v_lshrrev_b32 v12, 3, v27
    v_cos_f32 v10, v10
    v_lshlrev_b16 v13, 3, v27
    v_mad_i32_i24 v11, v14, s55, v43
    v_bitop3_b32 v12, v6, v13, v12 bitop3:0xca
    v_lshl_add_u32 v11, v11, 17, s40
    v_lshlrev_b16 v14, 8, v14
    v_lshrrev_b32 v13, 2, v27
    v_add_u32 v43, v12, v11
    v_bitop3_b32 v27, v5, v13, v14 bitop3:0xea
    ds_add_u32 v27, v2
    v_cvt_pk_bf16_f32 v85, v9, v10
    v_perm_b32 v12, v85, v85, s41
    v_bitop3_b32 v42, v4, v12, v42 bitop3:0xca
    v_perm_b32 v13, v85, v85, s42
    v_bitop3_b32 v43, v4, v13, v43 bitop3:0xca
    s_waitcnt vmcnt(23)
    v_lshlrev_b32 v7, 16, v86
    v_and_b32 v8, 0xffff0000, v86
    v_lshlrev_b32 v9, 16, v87
    v_and_b32 v10, 0xffff0000, v87
    v_mul_f32 v7, 0.15915494, v7
    v_mul_f32 v8, 0.15915494, v8
    v_mul_f32 v9, 0.15915494, v9
    v_mul_f32 v10, 0.15915494, v10
    v_mul_hi_u32_u24 v14, 429497, v48
    v_lshrrev_b32 v12, 3, v52
    v_cos_f32 v7, v7
    v_lshlrev_b16 v13, 3, v52
    v_mad_i32_i24 v11, v14, s55, v48
    v_bitop3_b32 v12, v6, v13, v12 bitop3:0xca
    v_lshl_add_u32 v11, v11, 17, s40
    v_lshlrev_b16 v14, 8, v14
    v_lshrrev_b32 v13, 2, v52
    v_add_u32 v48, v12, v11
    v_bitop3_b32 v52, v5, v13, v14 bitop3:0xea
    ds_add_u32 v52, v2
    v_mul_hi_u32_u24 v14, 429497, v49
    v_lshrrev_b32 v12, 3, v53
    v_cos_f32 v8, v8
    v_lshlrev_b16 v13, 3, v53
    v_mad_i32_i24 v11, v14, s55, v49
    v_bitop3_b32 v12, v6, v13, v12 bitop3:0xca
    v_lshl_add_u32 v11, v11, 17, s40
    v_lshlrev_b16 v14, 8, v14
    v_lshrrev_b32 v13, 2, v53
    v_add_u32 v49, v12, v11
    v_bitop3_b32 v53, v5, v13, v14 bitop3:0xea
    ds_add_u32 v53, v2
    v_cvt_pk_bf16_f32 v86, v7, v8
    v_perm_b32 v12, v86, v86, s41
    v_bitop3_b32 v48, v4, v12, v48 bitop3:0xca
    v_perm_b32 v13, v86, v86, s42
    v_bitop3_b32 v49, v4, v13, v49 bitop3:0xca
    v_mul_hi_u32_u24 v14, 429497, v50
    v_lshrrev_b32 v12, 3, v54
    v_cos_f32 v9, v9
    v_lshlrev_b16 v13, 3, v54
    v_mad_i32_i24 v11, v14, s55, v50
    v_bitop3_b32 v12, v6, v13, v12 bitop3:0xca
    v_lshl_add_u32 v11, v11, 17, s40
    v_lshlrev_b16 v14, 8, v14
    v_lshrrev_b32 v13, 2, v54
    v_add_u32 v50, v12, v11
    v_bitop3_b32 v54, v5, v13, v14 bitop3:0xea
    ds_add_u32 v54, v2
    v_mul_hi_u32_u24 v14, 429497, v51
    v_lshrrev_b32 v12, 3, v55
    v_cos_f32 v10, v10
    v_lshlrev_b16 v13, 3, v55
    v_mad_i32_i24 v11, v14, s55, v51
    v_bitop3_b32 v12, v6, v13, v12 bitop3:0xca
    v_lshl_add_u32 v11, v11, 17, s40
    v_lshlrev_b16 v14, 8, v14
    v_lshrrev_b32 v13, 2, v55
    v_add_u32 v51, v12, v11
    v_bitop3_b32 v55, v5, v13, v14 bitop3:0xea
    ds_add_u32 v55, v2
    v_cvt_pk_bf16_f32 v87, v9, v10
    v_perm_b32 v12, v87, v87, s41
    v_bitop3_b32 v50, v4, v12, v50 bitop3:0xca
    v_perm_b32 v13, v87, v87, s42
    v_bitop3_b32 v51, v4, v13, v51 bitop3:0xca
    s_setprio 2
    s_waitcnt vmcnt(18)
    v_lshlrev_b32 v7, 16, v56
    v_and_b32 v8, 0xffff0000, v56
    v_lshlrev_b32 v9, 16, v57
    v_and_b32 v10, 0xffff0000, v57
    v_mul_f32 v7, 0.15915494, v7
    v_mul_f32 v8, 0.15915494, v8
    v_mul_f32 v9, 0.15915494, v9
    v_mul_f32 v10, 0.15915494, v10
    v_mul_hi_u32_u24 v14, 429497, v68
    v_lshrrev_b32 v12, 3, v72
    v_cos_f32 v7, v7
    v_lshlrev_b16 v13, 3, v72
    v_mad_i32_i24 v11, v14, s55, v68
    v_bitop3_b32 v12, v6, v13, v12 bitop3:0xca
    v_lshl_add_u32 v11, v11, 17, s40
    v_lshlrev_b16 v14, 8, v14
    v_lshrrev_b32 v13, 2, v72
    v_add_u32 v68, v12, v11
    v_bitop3_b32 v72, v5, v13, v14 bitop3:0xea
    ds_add_u32 v72, v2
    v_mul_hi_u32_u24 v14, 429497, v69
    v_lshrrev_b32 v12, 3, v73
    v_cos_f32 v8, v8
    v_lshlrev_b16 v13, 3, v73
    v_mad_i32_i24 v11, v14, s55, v69
    v_bitop3_b32 v12, v6, v13, v12 bitop3:0xca
    v_lshl_add_u32 v11, v11, 17, s40
    v_lshlrev_b16 v14, 8, v14
    v_lshrrev_b32 v13, 2, v73
    v_add_u32 v69, v12, v11
    v_bitop3_b32 v73, v5, v13, v14 bitop3:0xea
    ds_add_u32 v73, v2
    v_cvt_pk_bf16_f32 v56, v7, v8
    v_perm_b32 v12, v56, v56, s41
    v_bitop3_b32 v68, v4, v12, v68 bitop3:0xca
    v_perm_b32 v13, v56, v56, s42
    v_bitop3_b32 v69, v4, v13, v69 bitop3:0xca
    v_mul_hi_u32_u24 v14, 429497, v70
    v_lshrrev_b32 v12, 3, v74
    v_cos_f32 v9, v9
    v_lshlrev_b16 v13, 3, v74
    v_mad_i32_i24 v11, v14, s55, v70
    v_bitop3_b32 v12, v6, v13, v12 bitop3:0xca
    v_lshl_add_u32 v11, v11, 17, s40
    v_lshlrev_b16 v14, 8, v14
    v_lshrrev_b32 v13, 2, v74
    v_add_u32 v70, v12, v11
    v_bitop3_b32 v74, v5, v13, v14 bitop3:0xea
    ds_add_u32 v74, v2
    v_mul_hi_u32_u24 v14, 429497, v71
    v_lshrrev_b32 v12, 3, v75
    v_cos_f32 v10, v10
    v_lshlrev_b16 v13, 3, v75
    v_mad_i32_i24 v11, v14, s55, v71
    v_bitop3_b32 v12, v6, v13, v12 bitop3:0xca
    v_lshl_add_u32 v11, v11, 17, s40
    v_lshlrev_b16 v14, 8, v14
    v_lshrrev_b32 v13, 2, v75
    v_add_u32 v71, v12, v11
    v_bitop3_b32 v75, v5, v13, v14 bitop3:0xea
    ds_add_u32 v75, v2
    v_cvt_pk_bf16_f32 v57, v9, v10
    v_perm_b32 v12, v57, v57, s41
    v_bitop3_b32 v70, v4, v12, v70 bitop3:0xca
    v_perm_b32 v13, v57, v57, s42
    v_bitop3_b32 v71, v4, v13, v71 bitop3:0xca
    s_add_u32 s45, s35, 0x5484000
    s_add_u32 s45, s45, s85
    buffer_store_dwordx4 v[16:19], v0, s[20:23], s45 offen sc1
    s_add_u32 s46, s96, 0x8000000
    s_nop 0
    buffer_load_dwordx4 v[16:19], v0, s[8:11], s46 offen nt
    s_waitcnt vmcnt(17)
    v_lshlrev_b32 v7, 16, v58
    v_and_b32 v8, 0xffff0000, v58
    v_lshlrev_b32 v9, 16, v59
    v_and_b32 v10, 0xffff0000, v59
    v_mul_f32 v7, 0.15915494, v7
    v_mul_f32 v8, 0.15915494, v8
    v_mul_f32 v9, 0.15915494, v9
    v_mul_f32 v10, 0.15915494, v10
    v_mul_hi_u32_u24 v14, 429497, v76
    v_lshrrev_b32 v12, 3, v80
    v_cos_f32 v7, v7
    v_lshlrev_b16 v13, 3, v80
    v_mad_i32_i24 v11, v14, s55, v76
    v_bitop3_b32 v12, v6, v13, v12 bitop3:0xca
    v_lshl_add_u32 v11, v11, 17, s40
    v_lshlrev_b16 v14, 8, v14
    v_lshrrev_b32 v13, 2, v80
    v_add_u32 v76, v12, v11
    v_bitop3_b32 v80, v5, v13, v14 bitop3:0xea
    ds_add_u32 v80, v2
    v_mul_hi_u32_u24 v14, 429497, v77
    v_lshrrev_b32 v12, 3, v81
    v_cos_f32 v8, v8
    v_lshlrev_b16 v13, 3, v81
    v_mad_i32_i24 v11, v14, s55, v77
    v_bitop3_b32 v12, v6, v13, v12 bitop3:0xca
    v_lshl_add_u32 v11, v11, 17, s40
    v_lshlrev_b16 v14, 8, v14
    v_lshrrev_b32 v13, 2, v81
    v_add_u32 v77, v12, v11
    v_bitop3_b32 v81, v5, v13, v14 bitop3:0xea
    ds_add_u32 v81, v2
    v_cvt_pk_bf16_f32 v58, v7, v8
    v_perm_b32 v12, v58, v58, s41
    v_bitop3_b32 v76, v4, v12, v76 bitop3:0xca
    v_perm_b32 v13, v58, v58, s42
    v_bitop3_b32 v77, v4, v13, v77 bitop3:0xca
    v_mul_hi_u32_u24 v14, 429497, v78
    v_lshrrev_b32 v12, 3, v82
    v_cos_f32 v9, v9
    v_lshlrev_b16 v13, 3, v82
    v_mad_i32_i24 v11, v14, s55, v78
    v_bitop3_b32 v12, v6, v13, v12 bitop3:0xca
    v_lshl_add_u32 v11, v11, 17, s40
    v_lshlrev_b16 v14, 8, v14
    v_lshrrev_b32 v13, 2, v82
    v_add_u32 v78, v12, v11
    v_bitop3_b32 v82, v5, v13, v14 bitop3:0xea
    ds_add_u32 v82, v2
    v_mul_hi_u32_u24 v14, 429497, v79
    v_lshrrev_b32 v12, 3, v83
    v_cos_f32 v10, v10
    v_lshlrev_b16 v13, 3, v83
    v_mad_i32_i24 v11, v14, s55, v79
    v_bitop3_b32 v12, v6, v13, v12 bitop3:0xca
    v_lshl_add_u32 v11, v11, 17, s40
    v_lshlrev_b16 v14, 8, v14
    v_lshrrev_b32 v13, 2, v83
    v_add_u32 v79, v12, v11
    v_bitop3_b32 v83, v5, v13, v14 bitop3:0xea
    ds_add_u32 v83, v2
    v_cvt_pk_bf16_f32 v59, v9, v10
    v_perm_b32 v12, v59, v59, s41
    v_bitop3_b32 v78, v4, v12, v78 bitop3:0xca
    v_perm_b32 v13, v59, v59, s42
    v_bitop3_b32 v79, v4, v13, v79 bitop3:0xca
    s_setprio 1
    s_waitcnt vmcnt(13)
    v_lshlrev_b32 v7, 16, v104
    v_and_b32 v8, 0xffff0000, v104
    v_lshlrev_b32 v9, 16, v105
    v_and_b32 v10, 0xffff0000, v105
    v_mul_f32 v7, 0.15915494, v7
    v_mul_f32 v8, 0.15915494, v8
    v_mul_f32 v9, 0.15915494, v9
    v_mul_f32 v10, 0.15915494, v10
    v_mul_hi_u32_u24 v14, 429497, v64
    v_lshrrev_b32 v12, 3, v96
    v_cos_f32 v7, v7
    v_lshlrev_b16 v13, 3, v96
    v_mad_i32_i24 v11, v14, s55, v64
    v_bitop3_b32 v12, v6, v13, v12 bitop3:0xca
    v_lshl_add_u32 v11, v11, 17, s40
    v_lshlrev_b16 v14, 8, v14
    v_lshrrev_b32 v13, 2, v96
    v_add_u32 v64, v12, v11
    v_bitop3_b32 v96, v5, v13, v14 bitop3:0xea
    ds_add_u32 v96, v2
    v_mul_hi_u32_u24 v14, 429497, v65
    v_lshrrev_b32 v12, 3, v97
    v_cos_f32 v8, v8
    v_lshlrev_b16 v13, 3, v97
    v_mad_i32_i24 v11, v14, s55, v65
    v_bitop3_b32 v12, v6, v13, v12 bitop3:0xca
    v_lshl_add_u32 v11, v11, 17, s40
    v_lshlrev_b16 v14, 8, v14
    v_lshrrev_b32 v13, 2, v97
    v_add_u32 v65, v12, v11
    v_bitop3_b32 v97, v5, v13, v14 bitop3:0xea
    ds_add_u32 v97, v2
    v_cvt_pk_bf16_f32 v104, v7, v8
    v_perm_b32 v12, v104, v104, s41
    v_bitop3_b32 v64, v4, v12, v64 bitop3:0xca
    v_perm_b32 v13, v104, v104, s42
    v_bitop3_b32 v65, v4, v13, v65 bitop3:0xca
    v_mul_hi_u32_u24 v14, 429497, v66
    v_lshrrev_b32 v12, 3, v98
    v_cos_f32 v9, v9
    v_lshlrev_b16 v13, 3, v98
    v_mad_i32_i24 v11, v14, s55, v66
    v_bitop3_b32 v12, v6, v13, v12 bitop3:0xca
    v_lshl_add_u32 v11, v11, 17, s40
    v_lshlrev_b16 v14, 8, v14
    v_lshrrev_b32 v13, 2, v98
    v_add_u32 v66, v12, v11
    v_bitop3_b32 v98, v5, v13, v14 bitop3:0xea
    ds_add_u32 v98, v2
    v_mul_hi_u32_u24 v14, 429497, v67
    v_lshrrev_b32 v12, 3, v99
    v_cos_f32 v10, v10
    v_lshlrev_b16 v13, 3, v99
    v_mad_i32_i24 v11, v14, s55, v67
    v_bitop3_b32 v12, v6, v13, v12 bitop3:0xca
    v_lshl_add_u32 v11, v11, 17, s40
    v_lshlrev_b16 v14, 8, v14
    v_lshrrev_b32 v13, 2, v99
    v_add_u32 v67, v12, v11
    v_bitop3_b32 v99, v5, v13, v14 bitop3:0xea
    ds_add_u32 v99, v2
    v_cvt_pk_bf16_f32 v105, v9, v10
    v_perm_b32 v12, v105, v105, s41
    v_bitop3_b32 v66, v4, v12, v66 bitop3:0xca
    v_perm_b32 v13, v105, v105, s42
    v_bitop3_b32 v67, v4, v13, v67 bitop3:0xca
    s_waitcnt vmcnt(10)
    v_lshlrev_b32 v7, 16, v106
    v_and_b32 v8, 0xffff0000, v106
    v_lshlrev_b32 v9, 16, v107
    v_and_b32 v10, 0xffff0000, v107
    v_mul_f32 v7, 0.15915494, v7
    v_mul_f32 v8, 0.15915494, v8
    v_mul_f32 v9, 0.15915494, v9
    v_mul_f32 v10, 0.15915494, v10
    v_mul_hi_u32_u24 v14, 429497, v60
    v_lshrrev_b32 v12, 3, v112
    v_cos_f32 v7, v7
    v_lshlrev_b16 v13, 3, v112
    v_mad_i32_i24 v11, v14, s55, v60
    v_bitop3_b32 v12, v6, v13, v12 bitop3:0xca
    v_lshl_add_u32 v11, v11, 17, s40
    v_lshlrev_b16 v14, 8, v14
    v_lshrrev_b32 v13, 2, v112
    v_add_u32 v60, v12, v11
    v_bitop3_b32 v112, v5, v13, v14 bitop3:0xea
    ds_add_u32 v112, v2
    v_mul_hi_u32_u24 v14, 429497, v61
    v_lshrrev_b32 v12, 3, v113
    v_cos_f32 v8, v8
    v_lshlrev_b16 v13, 3, v113
    v_mad_i32_i24 v11, v14, s55, v61
    v_bitop3_b32 v12, v6, v13, v12 bitop3:0xca
    v_lshl_add_u32 v11, v11, 17, s40
    v_lshlrev_b16 v14, 8, v14
    v_lshrrev_b32 v13, 2, v113
    v_add_u32 v61, v12, v11
    v_bitop3_b32 v113, v5, v13, v14 bitop3:0xea
    ds_add_u32 v113, v2
    v_cvt_pk_bf16_f32 v106, v7, v8
    v_perm_b32 v12, v106, v106, s41
    v_bitop3_b32 v60, v4, v12, v60 bitop3:0xca
    v_perm_b32 v13, v106, v106, s42
    v_bitop3_b32 v61, v4, v13, v61 bitop3:0xca
    v_mul_hi_u32_u24 v14, 429497, v62
    v_lshrrev_b32 v12, 3, v114
    v_cos_f32 v9, v9
    v_lshlrev_b16 v13, 3, v114
    v_mad_i32_i24 v11, v14, s55, v62
    v_bitop3_b32 v12, v6, v13, v12 bitop3:0xca
    v_lshl_add_u32 v11, v11, 17, s40
    v_lshlrev_b16 v14, 8, v14
    v_lshrrev_b32 v13, 2, v114
    v_add_u32 v62, v12, v11
    v_bitop3_b32 v114, v5, v13, v14 bitop3:0xea
    ds_add_u32 v114, v2
    v_mul_hi_u32_u24 v14, 429497, v63
    v_lshrrev_b32 v12, 3, v115
    v_cos_f32 v10, v10
    v_lshlrev_b16 v13, 3, v115
    v_mad_i32_i24 v11, v14, s55, v63
    v_bitop3_b32 v12, v6, v13, v12 bitop3:0xca
    v_lshl_add_u32 v11, v11, 17, s40
    v_lshlrev_b16 v14, 8, v14
    v_lshrrev_b32 v13, 2, v115
    v_add_u32 v63, v12, v11
    v_bitop3_b32 v115, v5, v13, v14 bitop3:0xea
    ds_add_u32 v115, v2
    v_cvt_pk_bf16_f32 v107, v9, v10
    v_perm_b32 v12, v107, v107, s41
    v_bitop3_b32 v62, v4, v12, v62 bitop3:0xca
    v_perm_b32 v13, v107, v107, s42
    v_bitop3_b32 v63, v4, v13, v63 bitop3:0xca
    s_setprio 0
    s_add_u32 s47, s35, 0x5484000
    s_add_u32 s47, s47, s91
    buffer_store_dwordx4 v[120:123], v0, s[20:23], s47 offen sc1
    s_add_u32 s44, s96, 0x8000000
    s_nop 0
    buffer_load_dwordx4 v[120:123], v0, s[12:15], s44 offen nt
    s_waitcnt vmcnt(8)
    v_lshlrev_b32 v7, 16, v108
    v_and_b32 v8, 0xffff0000, v108
    v_lshlrev_b32 v9, 16, v109
    v_and_b32 v10, 0xffff0000, v109
    v_mul_f32 v7, 0.15915494, v7
    v_mul_f32 v8, 0.15915494, v8
    v_mul_f32 v9, 0.15915494, v9
    v_mul_f32 v10, 0.15915494, v10
    v_mul_hi_u32_u24 v14, 429497, v100
    v_lshrrev_b32 v12, 3, v88
    v_cos_f32 v7, v7
    v_lshlrev_b16 v13, 3, v88
    v_mad_i32_i24 v11, v14, s55, v100
    v_bitop3_b32 v12, v6, v13, v12 bitop3:0xca
    v_lshl_add_u32 v11, v11, 17, s40
    v_lshlrev_b16 v14, 8, v14
    v_lshrrev_b32 v13, 2, v88
    v_add_u32 v100, v12, v11
    v_bitop3_b32 v88, v5, v13, v14 bitop3:0xea
    ds_add_u32 v88, v2
    v_mul_hi_u32_u24 v14, 429497, v101
    v_lshrrev_b32 v12, 3, v89
    v_cos_f32 v8, v8
    v_lshlrev_b16 v13, 3, v89
    v_mad_i32_i24 v11, v14, s55, v101
    v_bitop3_b32 v12, v6, v13, v12 bitop3:0xca
    v_lshl_add_u32 v11, v11, 17, s40
    v_lshlrev_b16 v14, 8, v14
    v_lshrrev_b32 v13, 2, v89
    v_add_u32 v101, v12, v11
    v_bitop3_b32 v89, v5, v13, v14 bitop3:0xea
    ds_add_u32 v89, v2
    v_cvt_pk_bf16_f32 v108, v7, v8
    v_perm_b32 v12, v108, v108, s41
    v_bitop3_b32 v100, v4, v12, v100 bitop3:0xca
    v_perm_b32 v13, v108, v108, s42
    v_bitop3_b32 v101, v4, v13, v101 bitop3:0xca
    v_mul_hi_u32_u24 v14, 429497, v102
    v_lshrrev_b32 v12, 3, v90
    v_cos_f32 v9, v9
    v_lshlrev_b16 v13, 3, v90
    v_mad_i32_i24 v11, v14, s55, v102
    v_bitop3_b32 v12, v6, v13, v12 bitop3:0xca
    v_lshl_add_u32 v11, v11, 17, s40
    v_lshlrev_b16 v14, 8, v14
    v_lshrrev_b32 v13, 2, v90
    v_add_u32 v102, v12, v11
    v_bitop3_b32 v90, v5, v13, v14 bitop3:0xea
    ds_add_u32 v90, v2
    v_mul_hi_u32_u24 v14, 429497, v103
    v_lshrrev_b32 v12, 3, v91
    v_cos_f32 v10, v10
    v_lshlrev_b16 v13, 3, v91
    v_mad_i32_i24 v11, v14, s55, v103
    v_bitop3_b32 v12, v6, v13, v12 bitop3:0xca
    v_lshl_add_u32 v11, v11, 17, s40
    v_lshlrev_b16 v14, 8, v14
    v_lshrrev_b32 v13, 2, v91
    v_add_u32 v103, v12, v11
    v_bitop3_b32 v91, v5, v13, v14 bitop3:0xea
    ds_add_u32 v91, v2
    v_cvt_pk_bf16_f32 v109, v9, v10
    v_perm_b32 v12, v109, v109, s41
    v_bitop3_b32 v102, v4, v12, v102 bitop3:0xca
    v_perm_b32 v13, v109, v109, s42
    v_bitop3_b32 v103, v4, v13, v103 bitop3:0xca
    s_mov_b32 s68, s66
    s_mov_b32 s69, s67
    s_mov_b32 s70, 0x100
    s_mov_b32 s71, 0x20000
    v_mov_b32 v3, 1
    s_cmp_lg_u32 s32, 15
    s_cbranch_scc1 L1_tk
    s_mov_b64 exec, 1
    s_and_b32 s3, s2, 1
    s_lshl_b32 s3, s3, 7
    buffer_atomic_add v3, off, s[68:71], s3 sc0
    s_mov_b64 exec, -1
L1_tk:
    s_waitcnt vmcnt(4)
    v_lshlrev_b32 v7, 16, v110
    v_and_b32 v8, 0xffff0000, v110
    v_lshlrev_b32 v9, 16, v111
    v_and_b32 v10, 0xffff0000, v111
    v_mul_f32 v7, 0.15915494, v7
    v_mul_f32 v8, 0.15915494, v8
    v_mul_f32 v9, 0.15915494, v9
    v_mul_f32 v10, 0.15915494, v10
    v_mul_hi_u32_u24 v14, 429497, v116
    v_lshrrev_b32 v12, 3, v92
    v_cos_f32 v7, v7
    v_lshlrev_b16 v13, 3, v92
    v_mad_i32_i24 v11, v14, s55, v116
    v_bitop3_b32 v12, v6, v13, v12 bitop3:0xca
    v_lshl_add_u32 v11, v11, 17, s40
    v_lshlrev_b16 v14, 8, v14
    v_lshrrev_b32 v13, 2, v92
    v_add_u32 v116, v12, v11
    v_bitop3_b32 v92, v5, v13, v14 bitop3:0xea
    ds_add_u32 v92, v2
    v_mul_hi_u32_u24 v14, 429497, v117
    v_lshrrev_b32 v12, 3, v93
    v_cos_f32 v8, v8
    v_lshlrev_b16 v13, 3, v93
    v_mad_i32_i24 v11, v14, s55, v117
    v_bitop3_b32 v12, v6, v13, v12 bitop3:0xca
    v_lshl_add_u32 v11, v11, 17, s40
    v_lshlrev_b16 v14, 8, v14
    v_lshrrev_b32 v13, 2, v93
    v_add_u32 v117, v12, v11
    v_bitop3_b32 v93, v5, v13, v14 bitop3:0xea
    ds_add_u32 v93, v2
    v_cvt_pk_bf16_f32 v110, v7, v8
    v_perm_b32 v12, v110, v110, s41
    v_bitop3_b32 v116, v4, v12, v116 bitop3:0xca
    v_perm_b32 v13, v110, v110, s42
    v_bitop3_b32 v117, v4, v13, v117 bitop3:0xca
    v_mul_hi_u32_u24 v14, 429497, v118
    v_lshrrev_b32 v12, 3, v94
    v_cos_f32 v9, v9
    v_lshlrev_b16 v13, 3, v94
    v_mad_i32_i24 v11, v14, s55, v118
    v_bitop3_b32 v12, v6, v13, v12 bitop3:0xca
    v_lshl_add_u32 v11, v11, 17, s40
    v_lshlrev_b16 v14, 8, v14
    v_lshrrev_b32 v13, 2, v94
    v_add_u32 v118, v12, v11
    v_bitop3_b32 v94, v5, v13, v14 bitop3:0xea
    ds_add_u32 v94, v2
    v_mul_hi_u32_u24 v14, 429497, v119
    v_lshrrev_b32 v12, 3, v95
    v_cos_f32 v10, v10
    v_lshlrev_b16 v13, 3, v95
    v_mad_i32_i24 v11, v14, s55, v119
    v_bitop3_b32 v12, v6, v13, v12 bitop3:0xca
    v_lshl_add_u32 v11, v11, 17, s40
    v_lshlrev_b16 v14, 8, v14
    v_lshrrev_b32 v13, 2, v95
    v_add_u32 v119, v12, v11
    v_bitop3_b32 v95, v5, v13, v14 bitop3:0xea
    ds_add_u32 v95, v2
    v_cvt_pk_bf16_f32 v111, v9, v10
    v_perm_b32 v12, v111, v111, s41
    v_bitop3_b32 v118, v4, v12, v118 bitop3:0xca
    v_perm_b32 v13, v111, v111, s42
    v_bitop3_b32 v119, v4, v13, v119 bitop3:0xca
    v_lshrrev_b32 v8, 2, v0
    v_and_b32 v7, 0x3c00, v0
    v_bitop3_b32 v7, v5, v8, v7 bitop3:0xea
    s_waitcnt lgkmcnt(0)
    s_barrier
    ds_read2st64_b32 v[8:9], v7 offset0:0 offset1:1
    ds_read2st64_b32 v[10:11], v7 offset0:2 offset1:3
    s_add_u32 s45, s35, 0x5484000
    s_add_u32 s45, s45, s93
    buffer_store_dwordx4 v[44:47], v0, s[20:23], s45 offen sc1
    s_add_u32 s46, s96, 0x8000000
    s_lshr_b32 s46, s46, 1
    buffer_load_dwordx2 v[44:45], v1, s[16:19], s46 offen nt
    s_add_u32 s47, s97, 0x8400000
    s_lshr_b32 s47, s47, 1
    buffer_load_dwordx2 v[46:47], v1, s[16:19], s47 offen nt
    s_waitcnt lgkmcnt(0)
    v_lshl_or_b32 v12, v9, 16, v8
    v_lshl_or_b32 v13, v11, 16, v10
    v_mov_b32 v14, v12
    v_mov_b32 v15, v13
    s_nop 0
    v_add_u32_dpp v14, v14, v14 row_shr:1 row_mask:0xf bank_mask:0xf bound_ctrl:1
    v_add_u32_dpp v15, v15, v15 row_shr:1 row_mask:0xf bank_mask:0xf bound_ctrl:1
    s_nop 0
    v_add_u32_dpp v14, v14, v14 row_shr:2 row_mask:0xf bank_mask:0xf bound_ctrl:1
    v_add_u32_dpp v15, v15, v15 row_shr:2 row_mask:0xf bank_mask:0xf bound_ctrl:1
    s_nop 0
    v_add_u32_dpp v14, v14, v14 row_shr:4 row_mask:0xf bank_mask:0xf bound_ctrl:1
    v_add_u32_dpp v15, v15, v15 row_shr:4 row_mask:0xf bank_mask:0xf bound_ctrl:1
    s_nop 0
    v_add_u32_dpp v14, v14, v14 row_shr:8 row_mask:0xf bank_mask:0xf bound_ctrl:1
    v_add_u32_dpp v15, v15, v15 row_shr:8 row_mask:0xf bank_mask:0xf bound_ctrl:1
    s_nop 0
    v_add_u32_dpp v14, v14, v14 row_bcast:15 row_mask:0xa bank_mask:0xf
    v_add_u32_dpp v15, v15, v15 row_bcast:15 row_mask:0xa bank_mask:0xf
    s_nop 0
    v_add_u32_dpp v14, v14, v14 row_bcast:31 row_mask:0xc bank_mask:0xf
    v_add_u32_dpp v15, v15, v15 row_bcast:31 row_mask:0xc bank_mask:0xf
    v_readlane_b32 s48, v14, 63
    v_readlane_b32 s49, v15, 63
    s_lshl_b32 s54, s32, 2
    v_mov_b32 v8, s54
    s_and_b32 s50, s48, 0xffff
    s_lshr_b32 s51, s48, 16
    s_and_b32 s52, s49, 0xffff
    s_lshr_b32 s53, s49, 16
    s_add_u32 s51, s51, s50
    s_add_u32 s52, s52, s51
    s_add_u32 s53, s53, s52
    v_mov_b32 v9, s53
    s_mov_b64 exec, 1
    ds_write_b32 v8, v9 offset:16384
    s_waitcnt vmcnt(3)
    ds_write_b32 v8, v3 offset:16448
    s_mov_b64 exec, -1
    v_and_b32 v8, 60, v7
    s_waitcnt lgkmcnt(0)
    s_barrier
    ds_read_b32 v9, v8 offset:16384
    ds_read_b32 v10, v8 offset:16448
    s_waitcnt lgkmcnt(0)
    v_readlane_b32 s84, v10, 15
    s_and_b32 s3, s2, 1
    s_lshl_b32 s3, s3, 7
    s_add_u32 s84, s84, s3
    s_min_u32 s4, s84, 96
    s_min_u32 s5, s84, 192
    s_min_u32 s6, s84, 240
    s_add_u32 s4, s4, s5
    s_add_u32 s4, s4, s6
    s_add_u32 s4, s4, 9467
    s_mov_b32 s4, s84
    s_lshl_b32 s58, s4, 14
    s_lshl_b32 s59, s4, 13
    s_mov_b32 s43, 5
    s_cmp_lt_u32 s84, 96
    s_addc_u32 s43, s43, 0
    s_cmp_lt_u32 s84, 192
    s_addc_u32 s43, s43, 0
    s_cmp_lt_u32 s84, 240
    s_addc_u32 s43, s43, 0
    v_add_u32_dpp v9, v9, v9 row_shr:1 row_mask:0xf bank_mask:0xf bound_ctrl:1
    s_nop 1
    v_add_u32_dpp v9, v9, v9 row_shr:2 row_mask:0xf bank_mask:0xf bound_ctrl:1
    s_nop 1
    v_add_u32_dpp v9, v9, v9 row_shr:4 row_mask:0xf bank_mask:0xf bound_ctrl:1
    s_nop 1
    v_add_u32_dpp v9, v9, v9 row_shr:8 row_mask:0xf bank_mask:0xf bound_ctrl:1
    s_nop 0
    v_readlane_b32 s54, v9, s32
    s_sub_u32 s54, s54, s53
    s_add_u32 s50, s50, s54
    s_add_u32 s51, s51, s54
    s_add_u32 s52, s52, s54
    s_pack_ll_b32_b16 s48, s54, s50
    s_pack_ll_b32_b16 s49, s51, s52
    v_add_u32 v14, s48, v14
    v_add_u32 v15, s49, v15
    v_sub_u32 v12, v14, v12
    v_sub_u32 v13, v15, v13
    v_and_b32 v8, 0xffff, v12
    v_lshrrev_b32 v9, 16, v12
    v_and_b32 v10, 0xffff, v13
    v_lshrrev_b32 v11, 16, v13
    ds_write2st64_b32 v7, v8, v9 offset0:0 offset1:1
    ds_write2st64_b32 v7, v10, v11 offset0:2 offset1:3
    v_and_b32 v8, 0x3f0, v0
    v_lshl_add_u32 v8, v8, 1, s36
    ds_write_b64 v8, v[12:13] offset:20480
    s_bitset0_b64 exec, 63
    s_not_b64 exec, exec
    ds_write_b64 v8, v[14:15] offset:20512
    s_mov_b64 exec, -1
    s_waitcnt lgkmcnt(0)
    s_barrier
    s_setprio 3
    ds_add_rtn_u32 v24, v24, v2
    ds_add_rtn_u32 v25, v25, v2
    ds_add_rtn_u32 v26, v26, v2
    ds_add_rtn_u32 v27, v27, v2
    ds_read_b128 v[12:15], v0 offset:20480
    v_cmp_gt_u32 vcc, 8448, v0
    ds_add_rtn_u32 v52, v52, v2
    ds_add_rtn_u32 v53, v53, v2
    ds_add_rtn_u32 v54, v54, v2
    ds_add_rtn_u32 v55, v55, v2
    s_setprio 2
    ds_add_rtn_u32 v72, v72, v2
    ds_add_rtn_u32 v73, v73, v2
    ds_add_rtn_u32 v74, v74, v2
    ds_add_rtn_u32 v75, v75, v2
    s_waitcnt lgkmcnt(8)
    s_cbranch_vccz L1_p4
    s_add_u32 s44, s35, 0x7ec0000
    s_mov_b64 exec, vcc
    buffer_store_dwordx4 v[12:15], v0, s[24:27], s44 offen sc1
    s_mov_b64 exec, -1
L1_p4:
    s_add_u32 s45, s35, 0x5488000
    s_add_u32 s45, s45, s72
    buffer_store_dwordx4 v[20:23], v0, s[20:23], s45 offen sc1
    s_add_u32 s46, s97, 0x8400000
    s_nop 0
    buffer_load_dwordx4 v[20:23], v0, s[8:11], s46 offen nt
    ds_add_rtn_u32 v80, v80, v2
    ds_add_rtn_u32 v81, v81, v2
    ds_add_rtn_u32 v82, v82, v2
    ds_add_rtn_u32 v83, v83, v2
    s_setprio 1
    ds_add_rtn_u32 v96, v96, v2
    ds_add_rtn_u32 v97, v97, v2
    ds_add_rtn_u32 v98, v98, v2
    ds_add_rtn_u32 v99, v99, v2
    ds_add_rtn_u32 v112, v112, v2
    ds_add_rtn_u32 v113, v113, v2
    ds_add_rtn_u32 v114, v114, v2
    ds_add_rtn_u32 v115, v115, v2
    s_add_u32 s47, s35, 0x5488000
    s_add_u32 s47, s47, s73
    buffer_store_dwordx4 v[124:127], v0, s[20:23], s47 offen sc1
    s_add_u32 s44, s97, 0x8400000
    s_nop 0
    buffer_load_dwordx4 v[124:127], v0, s[12:15], s44 offen nt
    s_setprio 0
    ds_add_rtn_u32 v88, v88, v2
    ds_add_rtn_u32 v89, v89, v2
    ds_add_rtn_u32 v90, v90, v2
    ds_add_rtn_u32 v91, v91, v2
    ds_add_rtn_u32 v92, v92, v2
    ds_add_rtn_u32 v93, v93, v2
    ds_add_rtn_u32 v94, v94, v2
    ds_add_rtn_u32 v95, v95, v2
    s_waitcnt lgkmcnt(0)
    s_barrier
    s_setprio 3
    v_and_b32 v7, -4, v24
    v_lshl_add_u32 v8, v24, 2, v7
    ds_write_b32 v8, v40
    v_lshl_add_u32 v7, v7, 2, v24
    ds_write_b8 v7, v84 offset:16
    v_and_b32 v9, -4, v25
    v_lshl_add_u32 v10, v25, 2, v9
    ds_write_b32 v10, v41
    v_lshl_add_u32 v9, v9, 2, v25
    ds_write_b8_d16_hi v9, v84 offset:16
    v_and_b32 v7, -4, v26
    v_lshl_add_u32 v8, v26, 2, v7
    ds_write_b32 v8, v42
    v_lshl_add_u32 v7, v7, 2, v26
    ds_write_b8 v7, v85 offset:16
    v_and_b32 v9, -4, v27
    v_lshl_add_u32 v10, v27, 2, v9
    ds_write_b32 v10, v43
    v_lshl_add_u32 v9, v9, 2, v27
    ds_write_b8_d16_hi v9, v85 offset:16
    s_add_u32 s45, s35, 0x5488000
    s_add_u32 s45, s45, s85
    buffer_store_dwordx4 v[32:35], v0, s[20:23], s45 offen sc1
    s_add_u32 s46, s98, 0x8800000
    buffer_load_dwordx4 v[40:43], v0, s[8:11], s46 offen nt
    s_add_u32 s47, s98, 0x8800000
    buffer_load_dwordx4 v[24:27], v0, s[12:15], s47 offen nt
    v_and_b32 v7, -4, v52
    v_lshl_add_u32 v8, v52, 2, v7
    ds_write_b32 v8, v48
    v_lshl_add_u32 v7, v7, 2, v52
    ds_write_b8 v7, v86 offset:16
    v_and_b32 v9, -4, v53
    v_lshl_add_u32 v10, v53, 2, v9
    ds_write_b32 v10, v49
    v_lshl_add_u32 v9, v9, 2, v53
    ds_write_b8_d16_hi v9, v86 offset:16
    v_and_b32 v7, -4, v54
    v_lshl_add_u32 v8, v54, 2, v7
    ds_write_b32 v8, v50
    v_lshl_add_u32 v7, v7, 2, v54
    ds_write_b8 v7, v87 offset:16
    v_and_b32 v9, -4, v55
    v_lshl_add_u32 v10, v55, 2, v9
    ds_write_b32 v10, v51
    v_lshl_add_u32 v9, v9, 2, v55
    ds_write_b8_d16_hi v9, v87 offset:16
    s_add_u32 s44, s98, 0x8800000
    s_lshr_b32 s44, s44, 1
    buffer_load_dwordx2 v[32:33], v1, s[16:19], s44 offen nt
    s_add_u32 s45, s99, 0x8c00000
    s_lshr_b32 s45, s45, 1
    buffer_load_dwordx2 v[34:35], v1, s[16:19], s45 offen nt
    s_add_u32 s46, s99, 0x8c00000
    buffer_load_dwordx4 v[48:51], v0, s[8:11], s46 offen nt
    s_setprio 2
    v_and_b32 v7, -4, v72
    v_lshl_add_u32 v8, v72, 2, v7
    ds_write_b32 v8, v68
    v_lshl_add_u32 v7, v7, 2, v72
    ds_write_b8 v7, v56 offset:16
    v_and_b32 v9, -4, v73
    v_lshl_add_u32 v10, v73, 2, v9
    ds_write_b32 v10, v69
    v_lshl_add_u32 v9, v9, 2, v73
    ds_write_b8_d16_hi v9, v56 offset:16
    v_and_b32 v7, -4, v74
    v_lshl_add_u32 v8, v74, 2, v7
    ds_write_b32 v8, v70
    v_lshl_add_u32 v7, v7, 2, v74
    ds_write_b8 v7, v57 offset:16
    v_and_b32 v9, -4, v75
    v_lshl_add_u32 v10, v75, 2, v9
    ds_write_b32 v10, v71
    v_lshl_add_u32 v9, v9, 2, v75
    ds_write_b8_d16_hi v9, v57 offset:16
    s_add_u32 s47, s35, 0x5488000
    s_add_u32 s47, s47, s91
    buffer_store_dwordx4 v[36:39], v0, s[20:23], s47 offen sc1
    s_add_u32 s44, s99, 0x8c00000
    buffer_load_dwordx4 v[52:55], v0, s[12:15], s44 offen nt
    v_and_b32 v7, -4, v80
    v_lshl_add_u32 v8, v80, 2, v7
    ds_write_b32 v8, v76
    v_lshl_add_u32 v7, v7, 2, v80
    ds_write_b8 v7, v58 offset:16
    v_and_b32 v9, -4, v81
    v_lshl_add_u32 v10, v81, 2, v9
    ds_write_b32 v10, v77
    v_lshl_add_u32 v9, v9, 2, v81
    ds_write_b8_d16_hi v9, v58 offset:16
    v_and_b32 v7, -4, v82
    v_lshl_add_u32 v8, v82, 2, v7
    ds_write_b32 v8, v78
    v_lshl_add_u32 v7, v7, 2, v82
    ds_write_b8 v7, v59 offset:16
    v_and_b32 v9, -4, v83
    v_lshl_add_u32 v10, v83, 2, v9
    ds_write_b32 v10, v79
    v_lshl_add_u32 v9, v9, 2, v83
    ds_write_b8_d16_hi v9, v59 offset:16
    s_add_u32 s45, s96, 0x9000000
    buffer_load_dwordx4 v[84:87], v0, s[8:11], s45 offen nt
    s_add_u32 s46, s96, 0x9000000
    buffer_load_dwordx4 v[68:71], v0, s[12:15], s46 offen nt
    s_setprio 1
    v_and_b32 v7, -4, v96
    v_lshl_add_u32 v8, v96, 2, v7
    ds_write_b32 v8, v64
    v_lshl_add_u32 v7, v7, 2, v96
    ds_write_b8 v7, v104 offset:16
    v_and_b32 v9, -4, v97
    v_lshl_add_u32 v10, v97, 2, v9
    ds_write_b32 v10, v65
    v_lshl_add_u32 v9, v9, 2, v97
    ds_write_b8_d16_hi v9, v104 offset:16
    v_and_b32 v7, -4, v98
    v_lshl_add_u32 v8, v98, 2, v7
    ds_write_b32 v8, v66
    v_lshl_add_u32 v7, v7, 2, v98
    ds_write_b8 v7, v105 offset:16
    v_and_b32 v9, -4, v99
    v_lshl_add_u32 v10, v99, 2, v9
    ds_write_b32 v10, v67
    v_lshl_add_u32 v9, v9, 2, v99
    ds_write_b8_d16_hi v9, v105 offset:16
    s_add_u32 s47, s96, 0x9000000
    s_lshr_b32 s47, s47, 1
    buffer_load_dwordx2 v[72:73], v1, s[16:19], s47 offen nt
    s_cmp_le_u32 s43, 5
    s_cselect_b32 s18, 0, s18
    s_add_u32 s44, s59, 0x4a00000
    buffer_load_dwordx2 v[74:75], v1, s[16:19], s44 offen nt
    s_cmp_le_u32 s43, 5
    s_cselect_b32 s10, 0, s10
    s_add_u32 s45, s58, 0x9400000
    buffer_load_dwordx4 v[36:39], v0, s[8:11], s45 offen nt
    v_and_b32 v7, -4, v112
    v_lshl_add_u32 v8, v112, 2, v7
    ds_write_b32 v8, v60
    v_lshl_add_u32 v7, v7, 2, v112
    ds_write_b8 v7, v106 offset:16
    v_and_b32 v9, -4, v113
    v_lshl_add_u32 v10, v113, 2, v9
    ds_write_b32 v10, v61
    v_lshl_add_u32 v9, v9, 2, v113
    ds_write_b8_d16_hi v9, v106 offset:16
    v_and_b32 v7, -4, v114
    v_lshl_add_u32 v8, v114, 2, v7
    ds_write_b32 v8, v62
    v_lshl_add_u32 v7, v7, 2, v114
    ds_write_b8 v7, v107 offset:16
    v_and_b32 v9, -4, v115
    v_lshl_add_u32 v10, v115, 2, v9
    ds_write_b32 v10, v63
    v_lshl_add_u32 v9, v9, 2, v115
    ds_write_b8_d16_hi v9, v107 offset:16
    s_add_u32 s46, s35, 0x5488000
    s_add_u32 s46, s46, s93
    buffer_store_dwordx4 v[28:31], v0, s[20:23], s46 offen sc1
    s_cmp_le_u32 s43, 5
    s_cselect_b32 s14, 0, s14
    s_add_u32 s47, s58, 0x9400000
    buffer_load_dwordx4 v[76:79], v0, s[12:15], s47 offen nt
    s_setprio 0
    v_and_b32 v7, -4, v88
    v_lshl_add_u32 v8, v88, 2, v7
    ds_write_b32 v8, v100
    v_lshl_add_u32 v7, v7, 2, v88
    ds_write_b8 v7, v108 offset:16
    v_and_b32 v9, -4, v89
    v_lshl_add_u32 v10, v89, 2, v9
    ds_write_b32 v10, v101
    v_lshl_add_u32 v9, v9, 2, v89
    ds_write_b8_d16_hi v9, v108 offset:16
    v_and_b32 v7, -4, v90
    v_lshl_add_u32 v8, v90, 2, v7
    ds_write_b32 v8, v102
    v_lshl_add_u32 v7, v7, 2, v90
    ds_write_b8 v7, v109 offset:16
    v_and_b32 v9, -4, v91
    v_lshl_add_u32 v10, v91, 2, v9
    ds_write_b32 v10, v103
    v_lshl_add_u32 v9, v9, 2, v91
    ds_write_b8_d16_hi v9, v109 offset:16
    s_cmp_le_u32 s43, 6
    s_cselect_b32 s10, 0, s10
    s_add_u32 s44, s58, 0x97c0000
    buffer_load_dwordx4 v[80:83], v0, s[8:11], s44 offen nt
    s_cmp_le_u32 s43, 6
    s_cselect_b32 s14, 0, s14
    s_add_u32 s45, s58, 0x97c0000
    buffer_load_dwordx4 v[56:59], v0, s[12:15], s45 offen nt
    v_and_b32 v7, -4, v92
    v_lshl_add_u32 v8, v92, 2, v7
    ds_write_b32 v8, v116
    v_lshl_add_u32 v7, v7, 2, v92
    ds_write_b8 v7, v110 offset:16
    v_and_b32 v9, -4, v93
    v_lshl_add_u32 v10, v93, 2, v9
    ds_write_b32 v10, v117
    v_lshl_add_u32 v9, v9, 2, v93
    ds_write_b8_d16_hi v9, v110 offset:16
    v_and_b32 v7, -4, v94
    v_lshl_add_u32 v8, v94, 2, v7
    ds_write_b32 v8, v118
    v_lshl_add_u32 v7, v7, 2, v94
    ds_write_b8 v7, v111 offset:16
    v_and_b32 v9, -4, v95
    v_lshl_add_u32 v10, v95, 2, v9
    ds_write_b32 v10, v119
    v_lshl_add_u32 v9, v9, 2, v95
    ds_write_b8_d16_hi v9, v111 offset:16
    s_cmp_le_u32 s43, 6
    s_cselect_b32 s18, 0, s18
    s_add_u32 s46, s59, 0x4be0000
    buffer_load_dwordx2 v[64:65], v1, s[16:19], s46 offen nt
    s_cmp_le_u32 s43, 7
    s_cselect_b32 s18, 0, s18
    s_add_u32 s47, s59, 0x4d60000
    buffer_load_dwordx2 v[66:67], v1, s[16:19], s47 offen nt
    v_add_u32 v7, s72, v0
    v_add_u32 v12, s73, v0
    v_add_u32 v13, s85, v0
    v_add_u32 v14, s91, v0
    v_add_u32 v15, s93, v0
    s_min_i32 s3, s72, s73
    s_min_i32 s3, s3, s85
    s_min_i32 s3, s3, s91
    s_min_i32 s3, s3, s93
    v_add_u32 v3, s3, v0
    v_mov_b32 v8, 0
    v_mov_b32 v9, 0
    v_mov_b32 v10, 0
    v_mov_b32 v11, 0
    s_waitcnt lgkmcnt(0)
    s_barrier
    ds_read_b128 v[96:99], v7 offset:0
    ds_read_b128 v[60:63], v12 offset:0
    ds_read_b128 v[112:115], v13 offset:0
    ds_read_b128 v[104:107], v14 offset:0
    ds_read_b128 v[28:31], v15 offset:0
    ds_write_b128 v3, v[8:11]
    ds_read_b128 v[100:103], v7 offset:16384
    ds_read_b128 v[88:91], v12 offset:16384
    ds_read_b128 v[116:119], v13 offset:16384
    ds_read_b128 v[92:95], v14 offset:16384
    ds_read_b128 v[108:111], v15 offset:16384
    s_waitcnt lgkmcnt(0)
    s_barrier
    v_lshlrev_b32 v3, 3, v0
    v_and_b32 v3, 0x80, v3
    s_cmp_lg_u32 s32, 15
    s_cbranch_scc1 L2_k0
    s_mov_b64 exec, 3
    buffer_load_dword v3, v3, s[68:71], 0 offen sc1
    s_mov_b64 exec, -1
L2_k0:
    s_add_u32 s44, s35, 0x7ec4000
    s_add_u32 s44, s44, s72
    buffer_store_dwordx4 v[96:99], v0, s[20:23], s44 offen sc1
    s_cmp_le_u32 s43, 7
    s_cselect_b32 s10, 0, s10
    s_add_u32 s45, s58, 0x9ac0000
    buffer_load_dwordx4 v[96:99], v0, s[8:11], s45 offen nt
    s_add_u32 s46, s35, 0x7ec4000
    s_add_u32 s46, s46, s73
    buffer_store_dwordx4 v[60:63], v0, s[20:23], s46 offen sc1
    s_cmp_le_u32 s43, 7
    s_cselect_b32 s14, 0, s14
    s_add_u32 s47, s58, 0x9ac0000
    buffer_load_dwordx4 v[60:63], v0, s[12:15], s47 offen nt
    s_setprio 3
    s_waitcnt vmcnt(27)
    v_lshlrev_b32 v7, 16, v44
    v_and_b32 v8, 0xffff0000, v44
    v_lshlrev_b32 v9, 16, v45
    v_and_b32 v10, 0xffff0000, v45
    v_mul_f32 v7, 0.15915494, v7
    v_mul_f32 v8, 0.15915494, v8
    v_mul_f32 v9, 0.15915494, v9
    v_mul_f32 v10, 0.15915494, v10
    v_mul_hi_u32_u24 v14, 429497, v16
    v_lshrrev_b32 v12, 3, v120
    v_cos_f32 v7, v7
    v_lshlrev_b16 v13, 3, v120
    v_mad_i32_i24 v11, v14, s55, v16
    v_bitop3_b32 v12, v6, v13, v12 bitop3:0xca
    v_lshl_add_u32 v11, v11, 17, s40
    v_lshlrev_b16 v14, 8, v14
    v_lshrrev_b32 v13, 2, v120
    v_add_u32 v16, v12, v11
    v_bitop3_b32 v120, v5, v13, v14 bitop3:0xea
    ds_add_u32 v120, v2
    v_mul_hi_u32_u24 v14, 429497, v17
    v_lshrrev_b32 v12, 3, v121
    v_cos_f32 v8, v8
    v_lshlrev_b16 v13, 3, v121
    v_mad_i32_i24 v11, v14, s55, v17
    v_bitop3_b32 v12, v6, v13, v12 bitop3:0xca
    v_lshl_add_u32 v11, v11, 17, s40
    v_lshlrev_b16 v14, 8, v14
    v_lshrrev_b32 v13, 2, v121
    v_add_u32 v17, v12, v11
    v_bitop3_b32 v121, v5, v13, v14 bitop3:0xea
    ds_add_u32 v121, v2
    v_cvt_pk_bf16_f32 v44, v7, v8
    v_perm_b32 v12, v44, v44, s41
    v_bitop3_b32 v16, v4, v12, v16 bitop3:0xca
    v_perm_b32 v13, v44, v44, s42
    v_bitop3_b32 v17, v4, v13, v17 bitop3:0xca
    v_mul_hi_u32_u24 v14, 429497, v18
    v_lshrrev_b32 v12, 3, v122
    v_cos_f32 v9, v9
    v_lshlrev_b16 v13, 3, v122
    v_mad_i32_i24 v11, v14, s55, v18
    v_bitop3_b32 v12, v6, v13, v12 bitop3:0xca
    v_lshl_add_u32 v11, v11, 17, s40
    v_lshlrev_b16 v14, 8, v14
    v_lshrrev_b32 v13, 2, v122
    v_add_u32 v18, v12, v11
    v_bitop3_b32 v122, v5, v13, v14 bitop3:0xea
    ds_add_u32 v122, v2
    v_mul_hi_u32_u24 v14, 429497, v19
    v_lshrrev_b32 v12, 3, v123
    v_cos_f32 v10, v10
    v_lshlrev_b16 v13, 3, v123
    v_mad_i32_i24 v11, v14, s55, v19
    v_bitop3_b32 v12, v6, v13, v12 bitop3:0xca
    v_lshl_add_u32 v11, v11, 17, s40
    v_lshlrev_b16 v14, 8, v14
    v_lshrrev_b32 v13, 2, v123
    v_add_u32 v19, v12, v11
    v_bitop3_b32 v123, v5, v13, v14 bitop3:0xea
    ds_add_u32 v123, v2
    v_cvt_pk_bf16_f32 v45, v9, v10
    v_perm_b32 v12, v45, v45, s41
    v_bitop3_b32 v18, v4, v12, v18 bitop3:0xca
    v_perm_b32 v13, v45, v45, s42
    v_bitop3_b32 v19, v4, v13, v19 bitop3:0xca
    s_add_u32 s44, s35, 0x7ec4000
    s_add_u32 s44, s44, s85
    buffer_store_dwordx4 v[112:115], v0, s[20:23], s44 offen sc1
    s_waitcnt vmcnt(24)
    v_lshlrev_b32 v7, 16, v46
    v_and_b32 v8, 0xffff0000, v46
    v_lshlrev_b32 v9, 16, v47
    v_and_b32 v10, 0xffff0000, v47
    v_mul_f32 v7, 0.15915494, v7
    v_mul_f32 v8, 0.15915494, v8
    v_mul_f32 v9, 0.15915494, v9
    v_mul_f32 v10, 0.15915494, v10
    v_mul_hi_u32_u24 v14, 429497, v20
    v_lshrrev_b32 v12, 3, v124
    v_cos_f32 v7, v7
    v_lshlrev_b16 v13, 3, v124
    v_mad_i32_i24 v11, v14, s55, v20
    v_bitop3_b32 v12, v6, v13, v12 bitop3:0xca
    v_lshl_add_u32 v11, v11, 17, s40
    v_lshlrev_b16 v14, 8, v14
    v_lshrrev_b32 v13, 2, v124
    v_add_u32 v20, v12, v11
    v_bitop3_b32 v124, v5, v13, v14 bitop3:0xea
    ds_add_u32 v124, v2
    v_mul_hi_u32_u24 v14, 429497, v21
    v_lshrrev_b32 v12, 3, v125
    v_cos_f32 v8, v8
    v_lshlrev_b16 v13, 3, v125
    v_mad_i32_i24 v11, v14, s55, v21
    v_bitop3_b32 v12, v6, v13, v12 bitop3:0xca
    v_lshl_add_u32 v11, v11, 17, s40
    v_lshlrev_b16 v14, 8, v14
    v_lshrrev_b32 v13, 2, v125
    v_add_u32 v21, v12, v11
    v_bitop3_b32 v125, v5, v13, v14 bitop3:0xea
    ds_add_u32 v125, v2
    v_cvt_pk_bf16_f32 v46, v7, v8
    v_perm_b32 v12, v46, v46, s41
    v_bitop3_b32 v20, v4, v12, v20 bitop3:0xca
    v_perm_b32 v13, v46, v46, s42
    v_bitop3_b32 v21, v4, v13, v21 bitop3:0xca
    v_mul_hi_u32_u24 v14, 429497, v22
    v_lshrrev_b32 v12, 3, v126
    v_cos_f32 v9, v9
    v_lshlrev_b16 v13, 3, v126
    v_mad_i32_i24 v11, v14, s55, v22
    v_bitop3_b32 v12, v6, v13, v12 bitop3:0xca
    v_lshl_add_u32 v11, v11, 17, s40
    v_lshlrev_b16 v14, 8, v14
    v_lshrrev_b32 v13, 2, v126
    v_add_u32 v22, v12, v11
    v_bitop3_b32 v126, v5, v13, v14 bitop3:0xea
    ds_add_u32 v126, v2
    v_mul_hi_u32_u24 v14, 429497, v23
    v_lshrrev_b32 v12, 3, v127
    v_cos_f32 v10, v10
    v_lshlrev_b16 v13, 3, v127
    v_mad_i32_i24 v11, v14, s55, v23
    v_bitop3_b32 v12, v6, v13, v12 bitop3:0xca
    v_lshl_add_u32 v11, v11, 17, s40
    v_lshlrev_b16 v14, 8, v14
    v_lshrrev_b32 v13, 2, v127
    v_add_u32 v23, v12, v11
    v_bitop3_b32 v127, v5, v13, v14 bitop3:0xea
    ds_add_u32 v127, v2
    v_cvt_pk_bf16_f32 v47, v9, v10
    v_perm_b32 v12, v47, v47, s41
    v_bitop3_b32 v22, v4, v12, v22 bitop3:0xca
    v_perm_b32 v13, v47, v47, s42
    v_bitop3_b32 v23, v4, v13, v23 bitop3:0xca
    s_setprio 2
    s_add_u32 s45, s35, 0x7ec4000
    s_add_u32 s45, s45, s91
    buffer_store_dwordx4 v[104:107], v0, s[20:23], s45 offen sc1
    s_waitcnt vmcnt(20)
    v_lshlrev_b32 v7, 16, v32
    v_and_b32 v8, 0xffff0000, v32
    v_lshlrev_b32 v9, 16, v33
    v_and_b32 v10, 0xffff0000, v33
    v_mul_f32 v7, 0.15915494, v7
    v_mul_f32 v8, 0.15915494, v8
    v_mul_f32 v9, 0.15915494, v9
    v_mul_f32 v10, 0.15915494, v10
    v_mul_hi_u32_u24 v14, 429497, v40
    v_lshrrev_b32 v12, 3, v24
    v_cos_f32 v7, v7
    v_lshlrev_b16 v13, 3, v24
    v_mad_i32_i24 v11, v14, s55, v40
    v_bitop3_b32 v12, v6, v13, v12 bitop3:0xca
    v_lshl_add_u32 v11, v11, 17, s40
    v_lshlrev_b16 v14, 8, v14
    v_lshrrev_b32 v13, 2, v24
    v_add_u32 v40, v12, v11
    v_bitop3_b32 v24, v5, v13, v14 bitop3:0xea
    ds_add_u32 v24, v2
    v_mul_hi_u32_u24 v14, 429497, v41
    v_lshrrev_b32 v12, 3, v25
    v_cos_f32 v8, v8
    v_lshlrev_b16 v13, 3, v25
    v_mad_i32_i24 v11, v14, s55, v41
    v_bitop3_b32 v12, v6, v13, v12 bitop3:0xca
    v_lshl_add_u32 v11, v11, 17, s40
    v_lshlrev_b16 v14, 8, v14
    v_lshrrev_b32 v13, 2, v25
    v_add_u32 v41, v12, v11
    v_bitop3_b32 v25, v5, v13, v14 bitop3:0xea
    ds_add_u32 v25, v2
    v_cvt_pk_bf16_f32 v32, v7, v8
    v_perm_b32 v12, v32, v32, s41
    v_bitop3_b32 v40, v4, v12, v40 bitop3:0xca
    v_perm_b32 v13, v32, v32, s42
    v_bitop3_b32 v41, v4, v13, v41 bitop3:0xca
    v_mul_hi_u32_u24 v14, 429497, v42
    v_lshrrev_b32 v12, 3, v26
    v_cos_f32 v9, v9
    v_lshlrev_b16 v13, 3, v26
    v_mad_i32_i24 v11, v14, s55, v42
    v_bitop3_b32 v12, v6, v13, v12 bitop3:0xca
    v_lshl_add_u32 v11, v11, 17, s40
    v_lshlrev_b16 v14, 8, v14
    v_lshrrev_b32 v13, 2, v26
    v_add_u32 v42, v12, v11
    v_bitop3_b32 v26, v5, v13, v14 bitop3:0xea
    ds_add_u32 v26, v2
    v_mul_hi_u32_u24 v14, 429497, v43
    v_lshrrev_b32 v12, 3, v27
    v_cos_f32 v10, v10
    v_lshlrev_b16 v13, 3, v27
    v_mad_i32_i24 v11, v14, s55, v43
    v_bitop3_b32 v12, v6, v13, v12 bitop3:0xca
    v_lshl_add_u32 v11, v11, 17, s40
    v_lshlrev_b16 v14, 8, v14
    v_lshrrev_b32 v13, 2, v27
    v_add_u32 v43, v12, v11
    v_bitop3_b32 v27, v5, v13, v14 bitop3:0xea
    ds_add_u32 v27, v2
    v_cvt_pk_bf16_f32 v33, v9, v10
    v_perm_b32 v12, v33, v33, s41
    v_bitop3_b32 v42, v4, v12, v42 bitop3:0xca
    v_perm_b32 v13, v33, v33, s42
    v_bitop3_b32 v43, v4, v13, v43 bitop3:0xca
    s_waitcnt vmcnt(17)
    v_lshlrev_b32 v7, 16, v34
    v_and_b32 v8, 0xffff0000, v34
    v_lshlrev_b32 v9, 16, v35
    v_and_b32 v10, 0xffff0000, v35
    v_mul_f32 v7, 0.15915494, v7
    v_mul_f32 v8, 0.15915494, v8
    v_mul_f32 v9, 0.15915494, v9
    v_mul_f32 v10, 0.15915494, v10
    v_mul_hi_u32_u24 v14, 429497, v48
    v_lshrrev_b32 v12, 3, v52
    v_cos_f32 v7, v7
    v_lshlrev_b16 v13, 3, v52
    v_mad_i32_i24 v11, v14, s55, v48
    v_bitop3_b32 v12, v6, v13, v12 bitop3:0xca
    v_lshl_add_u32 v11, v11, 17, s40
    v_lshlrev_b16 v14, 8, v14
    v_lshrrev_b32 v13, 2, v52
    v_add_u32 v48, v12, v11
    v_bitop3_b32 v52, v5, v13, v14 bitop3:0xea
    ds_add_u32 v52, v2
    v_mul_hi_u32_u24 v14, 429497, v49
    v_lshrrev_b32 v12, 3, v53
    v_cos_f32 v8, v8
    v_lshlrev_b16 v13, 3, v53
    v_mad_i32_i24 v11, v14, s55, v49
    v_bitop3_b32 v12, v6, v13, v12 bitop3:0xca
    v_lshl_add_u32 v11, v11, 17, s40
    v_lshlrev_b16 v14, 8, v14
    v_lshrrev_b32 v13, 2, v53
    v_add_u32 v49, v12, v11
    v_bitop3_b32 v53, v5, v13, v14 bitop3:0xea
    ds_add_u32 v53, v2
    v_cvt_pk_bf16_f32 v34, v7, v8
    v_perm_b32 v12, v34, v34, s41
    v_bitop3_b32 v48, v4, v12, v48 bitop3:0xca
    v_perm_b32 v13, v34, v34, s42
    v_bitop3_b32 v49, v4, v13, v49 bitop3:0xca
    v_mul_hi_u32_u24 v14, 429497, v50
    v_lshrrev_b32 v12, 3, v54
    v_cos_f32 v9, v9
    v_lshlrev_b16 v13, 3, v54
    v_mad_i32_i24 v11, v14, s55, v50
    v_bitop3_b32 v12, v6, v13, v12 bitop3:0xca
    v_lshl_add_u32 v11, v11, 17, s40
    v_lshlrev_b16 v14, 8, v14
    v_lshrrev_b32 v13, 2, v54
    v_add_u32 v50, v12, v11
    v_bitop3_b32 v54, v5, v13, v14 bitop3:0xea
    ds_add_u32 v54, v2
    v_mul_hi_u32_u24 v14, 429497, v51
    v_lshrrev_b32 v12, 3, v55
    v_cos_f32 v10, v10
    v_lshlrev_b16 v13, 3, v55
    v_mad_i32_i24 v11, v14, s55, v51
    v_bitop3_b32 v12, v6, v13, v12 bitop3:0xca
    v_lshl_add_u32 v11, v11, 17, s40
    v_lshlrev_b16 v14, 8, v14
    v_lshrrev_b32 v13, 2, v55
    v_add_u32 v51, v12, v11
    v_bitop3_b32 v55, v5, v13, v14 bitop3:0xea
    ds_add_u32 v55, v2
    v_cvt_pk_bf16_f32 v35, v9, v10
    v_perm_b32 v12, v35, v35, s41
    v_bitop3_b32 v50, v4, v12, v50 bitop3:0xca
    v_perm_b32 v13, v35, v35, s42
    v_bitop3_b32 v51, v4, v13, v51 bitop3:0xca
    s_setprio 1
    s_add_u32 s46, s35, 0x7ec4000
    s_add_u32 s46, s46, s93
    buffer_store_dwordx4 v[28:31], v0, s[20:23], s46 offen sc1
    v_lshrrev_b32 v15, 2, v0
    v_and_b32 v15, v5, v15
    s_cmp_ge_u32 s84, 128
    s_cselect_b32 s82, 0, s82
    s_and_b32 s3, s84, 1
    s_mul_i32 s3, s3, 40
    s_add_u32 s3, s3, s32
    s_mul_i32 s4, s3, 205
    s_lshr_b32 s4, s4, 10
    s_mul_i32 s5, s4, 5
    s_sub_u32 s5, s3, s5
    s_lshl_b32 s6, s4, 1
    s_add_u32 s6, s6, s5
    s_add_u32 s7, s6, s4
    s_add_u32 s7, s7, 30
    s_cmp_lt_u32 s5, 2
    s_cselect_b32 s6, s6, s7
    s_lshl_b32 s6, s6, 10
    s_lshr_b32 s7, s84, 1
    s_mul_i32 s7, s7, 80000
    s_add_u32 s6, s6, s7
    buffer_load_dword v112, v15, s[80:83], s6 offen offset:0
    buffer_load_dword v113, v15, s[80:83], s6 offen offset:256
    buffer_load_dword v114, v15, s[80:83], s6 offen offset:512
    buffer_load_dword v115, v15, s[80:83], s6 offen offset:768
    s_and_b32 s3, s84, 1
    s_mul_i32 s3, s3, 40
    s_add_u32 s3, s3, s32
    s_add_u32 s3, s3, 16
    s_mul_i32 s4, s3, 205
    s_lshr_b32 s4, s4, 10
    s_mul_i32 s5, s4, 5
    s_sub_u32 s5, s3, s5
    s_lshl_b32 s6, s4, 1
    s_add_u32 s6, s6, s5
    s_add_u32 s7, s6, s4
    s_add_u32 s7, s7, 30
    s_cmp_lt_u32 s5, 2
    s_cselect_b32 s6, s6, s7
    s_lshl_b32 s6, s6, 10
    s_lshr_b32 s7, s84, 1
    s_mul_i32 s7, s7, 80000
    s_add_u32 s6, s6, s7
    buffer_load_dword v104, v15, s[80:83], s6 offen offset:0
    buffer_load_dword v105, v15, s[80:83], s6 offen offset:256
    buffer_load_dword v106, v15, s[80:83], s6 offen offset:512
    buffer_load_dword v107, v15, s[80:83], s6 offen offset:768
    s_and_b32 s3, s84, 1
    s_mul_i32 s3, s3, 40
    s_add_u32 s3, s3, s32
    s_add_u32 s3, s3, 32
    s_cmp_ge_u32 s32, 8
    s_cselect_b32 s82, 0, s82
    s_mul_i32 s4, s3, 205
    s_lshr_b32 s4, s4, 10
    s_mul_i32 s5, s4, 5
    s_sub_u32 s5, s3, s5
    s_lshl_b32 s6, s4, 1
    s_add_u32 s6, s6, s5
    s_add_u32 s7, s6, s4
    s_add_u32 s7, s7, 30
    s_cmp_lt_u32 s5, 2
    s_cselect_b32 s6, s6, s7
    s_lshl_b32 s6, s6, 10
    s_lshr_b32 s7, s84, 1
    s_mul_i32 s7, s7, 80000
    s_add_u32 s6, s6, s7
    buffer_load_dword v28, v15, s[80:83], s6 offen offset:0
    buffer_load_dword v29, v15, s[80:83], s6 offen offset:256
    buffer_load_dword v30, v15, s[80:83], s6 offen offset:512
    buffer_load_dword v31, v15, s[80:83], s6 offen offset:768
    s_waitcnt vmcnt(26)
    v_lshlrev_b32 v7, 16, v72
    v_and_b32 v8, 0xffff0000, v72
    v_lshlrev_b32 v9, 16, v73
    v_and_b32 v10, 0xffff0000, v73
    v_mul_f32 v7, 0.15915494, v7
    v_mul_f32 v8, 0.15915494, v8
    v_mul_f32 v9, 0.15915494, v9
    v_mul_f32 v10, 0.15915494, v10
    v_mul_hi_u32_u24 v14, 429497, v84
    v_lshrrev_b32 v12, 3, v68
    v_cos_f32 v7, v7
    v_lshlrev_b16 v13, 3, v68
    v_mad_i32_i24 v11, v14, s55, v84
    v_bitop3_b32 v12, v6, v13, v12 bitop3:0xca
    v_lshl_add_u32 v11, v11, 17, s40
    v_lshlrev_b16 v14, 8, v14
    v_lshrrev_b32 v13, 2, v68
    v_add_u32 v84, v12, v11
    v_bitop3_b32 v68, v5, v13, v14 bitop3:0xea
    ds_add_u32 v68, v2
    v_mul_hi_u32_u24 v14, 429497, v85
    v_lshrrev_b32 v12, 3, v69
    v_cos_f32 v8, v8
    v_lshlrev_b16 v13, 3, v69
    v_mad_i32_i24 v11, v14, s55, v85
    v_bitop3_b32 v12, v6, v13, v12 bitop3:0xca
    v_lshl_add_u32 v11, v11, 17, s40
    v_lshlrev_b16 v14, 8, v14
    v_lshrrev_b32 v13, 2, v69
    v_add_u32 v85, v12, v11
    v_bitop3_b32 v69, v5, v13, v14 bitop3:0xea
    ds_add_u32 v69, v2
    v_cvt_pk_bf16_f32 v72, v7, v8
    v_perm_b32 v12, v72, v72, s41
    v_bitop3_b32 v84, v4, v12, v84 bitop3:0xca
    v_perm_b32 v13, v72, v72, s42
    v_bitop3_b32 v85, v4, v13, v85 bitop3:0xca
    v_mul_hi_u32_u24 v14, 429497, v86
    v_lshrrev_b32 v12, 3, v70
    v_cos_f32 v9, v9
    v_lshlrev_b16 v13, 3, v70
    v_mad_i32_i24 v11, v14, s55, v86
    v_bitop3_b32 v12, v6, v13, v12 bitop3:0xca
    v_lshl_add_u32 v11, v11, 17, s40
    v_lshlrev_b16 v14, 8, v14
    v_lshrrev_b32 v13, 2, v70
    v_add_u32 v86, v12, v11
    v_bitop3_b32 v70, v5, v13, v14 bitop3:0xea
    ds_add_u32 v70, v2
    v_mul_hi_u32_u24 v14, 429497, v87
    v_lshrrev_b32 v12, 3, v71
    v_cos_f32 v10, v10
    v_lshlrev_b16 v13, 3, v71
    v_mad_i32_i24 v11, v14, s55, v87
    v_bitop3_b32 v12, v6, v13, v12 bitop3:0xca
    v_lshl_add_u32 v11, v11, 17, s40
    v_lshlrev_b16 v14, 8, v14
    v_lshrrev_b32 v13, 2, v71
    v_add_u32 v87, v12, v11
    v_bitop3_b32 v71, v5, v13, v14 bitop3:0xea
    ds_add_u32 v71, v2
    v_cvt_pk_bf16_f32 v73, v9, v10
    v_perm_b32 v12, v73, v73, s41
    v_bitop3_b32 v86, v4, v12, v86 bitop3:0xca
    v_perm_b32 v13, v73, v73, s42
    v_bitop3_b32 v87, v4, v13, v87 bitop3:0xca
    s_waitcnt vmcnt(23)
    s_cmp_le_u32 s43, 5
    s_cbranch_scc1 L1_s5
    v_lshlrev_b32 v7, 16, v74
    v_and_b32 v8, 0xffff0000, v74
    v_lshlrev_b32 v9, 16, v75
    v_and_b32 v10, 0xffff0000, v75
    v_mul_f32 v7, 0.15915494, v7
    v_mul_f32 v8, 0.15915494, v8
    v_mul_f32 v9, 0.15915494, v9
    v_mul_f32 v10, 0.15915494, v10
    v_mul_hi_u32_u24 v14, 429497, v36
    v_lshrrev_b32 v12, 3, v76
    v_cos_f32 v7, v7
    v_lshlrev_b16 v13, 3, v76
    v_mad_i32_i24 v11, v14, s55, v36
    v_bitop3_b32 v12, v6, v13, v12 bitop3:0xca
    v_lshl_add_u32 v11, v11, 17, s40
    v_lshlrev_b16 v14, 8, v14
    v_lshrrev_b32 v13, 2, v76
    v_add_u32 v36, v12, v11
    v_bitop3_b32 v76, v5, v13, v14 bitop3:0xea
    ds_add_u32 v76, v2
    v_mul_hi_u32_u24 v14, 429497, v37
    v_lshrrev_b32 v12, 3, v77
    v_cos_f32 v8, v8
    v_lshlrev_b16 v13, 3, v77
    v_mad_i32_i24 v11, v14, s55, v37
    v_bitop3_b32 v12, v6, v13, v12 bitop3:0xca
    v_lshl_add_u32 v11, v11, 17, s40
    v_lshlrev_b16 v14, 8, v14
    v_lshrrev_b32 v13, 2, v77
    v_add_u32 v37, v12, v11
    v_bitop3_b32 v77, v5, v13, v14 bitop3:0xea
    ds_add_u32 v77, v2
    v_cvt_pk_bf16_f32 v74, v7, v8
    v_perm_b32 v12, v74, v74, s41
    v_bitop3_b32 v36, v4, v12, v36 bitop3:0xca
    v_perm_b32 v13, v74, v74, s42
    v_bitop3_b32 v37, v4, v13, v37 bitop3:0xca
    v_mul_hi_u32_u24 v14, 429497, v38
    v_lshrrev_b32 v12, 3, v78
    v_cos_f32 v9, v9
    v_lshlrev_b16 v13, 3, v78
    v_mad_i32_i24 v11, v14, s55, v38
    v_bitop3_b32 v12, v6, v13, v12 bitop3:0xca
    v_lshl_add_u32 v11, v11, 17, s40
    v_lshlrev_b16 v14, 8, v14
    v_lshrrev_b32 v13, 2, v78
    v_add_u32 v38, v12, v11
    v_bitop3_b32 v78, v5, v13, v14 bitop3:0xea
    ds_add_u32 v78, v2
    v_mul_hi_u32_u24 v14, 429497, v39
    v_lshrrev_b32 v12, 3, v79
    v_cos_f32 v10, v10
    v_lshlrev_b16 v13, 3, v79
    v_mad_i32_i24 v11, v14, s55, v39
    v_bitop3_b32 v12, v6, v13, v12 bitop3:0xca
    v_lshl_add_u32 v11, v11, 17, s40
    v_lshlrev_b16 v14, 8, v14
    v_lshrrev_b32 v13, 2, v79
    v_add_u32 v39, v12, v11
    v_bitop3_b32 v79, v5, v13, v14 bitop3:0xea
    ds_add_u32 v79, v2
    v_cvt_pk_bf16_f32 v75, v9, v10
    v_perm_b32 v12, v75, v75, s41
    v_bitop3_b32 v38, v4, v12, v38 bitop3:0xca
    v_perm_b32 v13, v75, v75, s42
    v_bitop3_b32 v39, v4, v13, v39 bitop3:0xca
L1_s5:
    s_setprio 0
    s_waitcnt vmcnt(19)
    s_cmp_le_u32 s43, 6
    s_cbranch_scc1 L1_s6
    v_lshlrev_b32 v7, 16, v64
    v_and_b32 v8, 0xffff0000, v64
    v_lshlrev_b32 v9, 16, v65
    v_and_b32 v10, 0xffff0000, v65
    v_mul_f32 v7, 0.15915494, v7
    v_mul_f32 v8, 0.15915494, v8
    v_mul_f32 v9, 0.15915494, v9
    v_mul_f32 v10, 0.15915494, v10
    v_mul_hi_u32_u24 v14, 429497, v80
    v_lshrrev_b32 v12, 3, v56
    v_cos_f32 v7, v7
    v_lshlrev_b16 v13, 3, v56
    v_mad_i32_i24 v11, v14, s55, v80
    v_bitop3_b32 v12, v6, v13, v12 bitop3:0xca
    v_lshl_add_u32 v11, v11, 17, s40
    v_lshlrev_b16 v14, 8, v14
    v_lshrrev_b32 v13, 2, v56
    v_add_u32 v80, v12, v11
    v_bitop3_b32 v56, v5, v13, v14 bitop3:0xea
    ds_add_u32 v56, v2
    v_mul_hi_u32_u24 v14, 429497, v81
    v_lshrrev_b32 v12, 3, v57
    v_cos_f32 v8, v8
    v_lshlrev_b16 v13, 3, v57
    v_mad_i32_i24 v11, v14, s55, v81
    v_bitop3_b32 v12, v6, v13, v12 bitop3:0xca
    v_lshl_add_u32 v11, v11, 17, s40
    v_lshlrev_b16 v14, 8, v14
    v_lshrrev_b32 v13, 2, v57
    v_add_u32 v81, v12, v11
    v_bitop3_b32 v57, v5, v13, v14 bitop3:0xea
    ds_add_u32 v57, v2
    v_cvt_pk_bf16_f32 v64, v7, v8
    v_perm_b32 v12, v64, v64, s41
    v_bitop3_b32 v80, v4, v12, v80 bitop3:0xca
    v_perm_b32 v13, v64, v64, s42
    v_bitop3_b32 v81, v4, v13, v81 bitop3:0xca
    v_mul_hi_u32_u24 v14, 429497, v82
    v_lshrrev_b32 v12, 3, v58
    v_cos_f32 v9, v9
    v_lshlrev_b16 v13, 3, v58
    v_mad_i32_i24 v11, v14, s55, v82
    v_bitop3_b32 v12, v6, v13, v12 bitop3:0xca
    v_lshl_add_u32 v11, v11, 17, s40
    v_lshlrev_b16 v14, 8, v14
    v_lshrrev_b32 v13, 2, v58
    v_add_u32 v82, v12, v11
    v_bitop3_b32 v58, v5, v13, v14 bitop3:0xea
    ds_add_u32 v58, v2
    v_mul_hi_u32_u24 v14, 429497, v83
    v_lshrrev_b32 v12, 3, v59
    v_cos_f32 v10, v10
    v_lshlrev_b16 v13, 3, v59
    v_mad_i32_i24 v11, v14, s55, v83
    v_bitop3_b32 v12, v6, v13, v12 bitop3:0xca
    v_lshl_add_u32 v11, v11, 17, s40
    v_lshlrev_b16 v14, 8, v14
    v_lshrrev_b32 v13, 2, v59
    v_add_u32 v83, v12, v11
    v_bitop3_b32 v59, v5, v13, v14 bitop3:0xea
    ds_add_u32 v59, v2
    v_cvt_pk_bf16_f32 v65, v9, v10
    v_perm_b32 v12, v65, v65, s41
    v_bitop3_b32 v82, v4, v12, v82 bitop3:0xca
    v_perm_b32 v13, v65, v65, s42
    v_bitop3_b32 v83, v4, v13, v83 bitop3:0xca
L1_s6:
    s_waitcnt vmcnt(15)
    s_cmp_le_u32 s43, 7
    s_cbranch_scc1 L1_s7
    v_lshlrev_b32 v7, 16, v66
    v_and_b32 v8, 0xffff0000, v66
    v_lshlrev_b32 v9, 16, v67
    v_and_b32 v10, 0xffff0000, v67
    v_mul_f32 v7, 0.15915494, v7
    v_mul_f32 v8, 0.15915494, v8
    v_mul_f32 v9, 0.15915494, v9
    v_mul_f32 v10, 0.15915494, v10
    v_mul_hi_u32_u24 v14, 429497, v96
    v_lshrrev_b32 v12, 3, v60
    v_cos_f32 v7, v7
    v_lshlrev_b16 v13, 3, v60
    v_mad_i32_i24 v11, v14, s55, v96
    v_bitop3_b32 v12, v6, v13, v12 bitop3:0xca
    v_lshl_add_u32 v11, v11, 17, s40
    v_lshlrev_b16 v14, 8, v14
    v_lshrrev_b32 v13, 2, v60
    v_add_u32 v96, v12, v11
    v_bitop3_b32 v60, v5, v13, v14 bitop3:0xea
    ds_add_u32 v60, v2
    v_mul_hi_u32_u24 v14, 429497, v97
    v_lshrrev_b32 v12, 3, v61
    v_cos_f32 v8, v8
    v_lshlrev_b16 v13, 3, v61
    v_mad_i32_i24 v11, v14, s55, v97
    v_bitop3_b32 v12, v6, v13, v12 bitop3:0xca
    v_lshl_add_u32 v11, v11, 17, s40
    v_lshlrev_b16 v14, 8, v14
    v_lshrrev_b32 v13, 2, v61
    v_add_u32 v97, v12, v11
    v_bitop3_b32 v61, v5, v13, v14 bitop3:0xea
    ds_add_u32 v61, v2
    v_cvt_pk_bf16_f32 v66, v7, v8
    v_perm_b32 v12, v66, v66, s41
    v_bitop3_b32 v96, v4, v12, v96 bitop3:0xca
    v_perm_b32 v13, v66, v66, s42
    v_bitop3_b32 v97, v4, v13, v97 bitop3:0xca
    v_mul_hi_u32_u24 v14, 429497, v98
    v_lshrrev_b32 v12, 3, v62
    v_cos_f32 v9, v9
    v_lshlrev_b16 v13, 3, v62
    v_mad_i32_i24 v11, v14, s55, v98
    v_bitop3_b32 v12, v6, v13, v12 bitop3:0xca
    v_lshl_add_u32 v11, v11, 17, s40
    v_lshlrev_b16 v14, 8, v14
    v_lshrrev_b32 v13, 2, v62
    v_add_u32 v98, v12, v11
    v_bitop3_b32 v62, v5, v13, v14 bitop3:0xea
    ds_add_u32 v62, v2
    v_mul_hi_u32_u24 v14, 429497, v99
    v_lshrrev_b32 v12, 3, v63
    v_cos_f32 v10, v10
    v_lshlrev_b16 v13, 3, v63
    v_mad_i32_i24 v11, v14, s55, v99
    v_bitop3_b32 v12, v6, v13, v12 bitop3:0xca
    v_lshl_add_u32 v11, v11, 17, s40
    v_lshlrev_b16 v14, 8, v14
    v_lshrrev_b32 v13, 2, v63
    v_add_u32 v99, v12, v11
    v_bitop3_b32 v63, v5, v13, v14 bitop3:0xea
    ds_add_u32 v63, v2
    v_cvt_pk_bf16_f32 v67, v9, v10
    v_perm_b32 v12, v67, v67, s41
    v_bitop3_b32 v98, v4, v12, v98 bitop3:0xca
    v_perm_b32 v13, v67, v67, s42
    v_bitop3_b32 v99, v4, v13, v99 bitop3:0xca
L1_s7:
    v_lshrrev_b32 v8, 2, v0
    v_and_b32 v7, 0x3c00, v0
    v_bitop3_b32 v7, v5, v8, v7 bitop3:0xea
    s_waitcnt lgkmcnt(0)
    s_barrier
    ds_read2st64_b32 v[8:9], v7 offset0:0 offset1:1
    ds_read2st64_b32 v[10:11], v7 offset0:2 offset1:3
    s_add_u32 s47, s35, 0x7ec8000
    s_add_u32 s47, s47, s72
    buffer_store_dwordx4 v[100:103], v0, s[20:23], s47 offen sc1
    s_waitcnt lgkmcnt(0)
    v_lshl_or_b32 v12, v9, 16, v8
    v_lshl_or_b32 v13, v11, 16, v10
    v_mov_b32 v14, v12
    v_mov_b32 v15, v13
    s_nop 0
    v_add_u32_dpp v14, v14, v14 row_shr:1 row_mask:0xf bank_mask:0xf bound_ctrl:1
    v_add_u32_dpp v15, v15, v15 row_shr:1 row_mask:0xf bank_mask:0xf bound_ctrl:1
    s_nop 0
    v_add_u32_dpp v14, v14, v14 row_shr:2 row_mask:0xf bank_mask:0xf bound_ctrl:1
    v_add_u32_dpp v15, v15, v15 row_shr:2 row_mask:0xf bank_mask:0xf bound_ctrl:1
    s_nop 0
    v_add_u32_dpp v14, v14, v14 row_shr:4 row_mask:0xf bank_mask:0xf bound_ctrl:1
    v_add_u32_dpp v15, v15, v15 row_shr:4 row_mask:0xf bank_mask:0xf bound_ctrl:1
    s_nop 0
    v_add_u32_dpp v14, v14, v14 row_shr:8 row_mask:0xf bank_mask:0xf bound_ctrl:1
    v_add_u32_dpp v15, v15, v15 row_shr:8 row_mask:0xf bank_mask:0xf bound_ctrl:1
    s_nop 0
    v_add_u32_dpp v14, v14, v14 row_bcast:15 row_mask:0xa bank_mask:0xf
    v_add_u32_dpp v15, v15, v15 row_bcast:15 row_mask:0xa bank_mask:0xf
    s_nop 0
    v_add_u32_dpp v14, v14, v14 row_bcast:31 row_mask:0xc bank_mask:0xf
    v_add_u32_dpp v15, v15, v15 row_bcast:31 row_mask:0xc bank_mask:0xf
    v_readlane_b32 s48, v14, 63
    v_readlane_b32 s49, v15, 63
    s_lshl_b32 s54, s32, 2
    v_mov_b32 v8, s54
    s_and_b32 s50, s48, 0xffff
    s_lshr_b32 s51, s48, 16
    s_and_b32 s52, s49, 0xffff
    s_lshr_b32 s53, s49, 16
    s_add_u32 s51, s51, s50
    s_add_u32 s52, s52, s51
    s_add_u32 s53, s53, s52
    v_mov_b32 v9, s53
    v_and_b32_dpp v3, v3, v3 quad_perm:[1,0,3,2] row_mask:0xf bank_mask:0xf
    s_mov_b64 exec, 1
    ds_write_b32 v8, v9 offset:16384
    ds_write_b32 v8, v3 offset:16448
    s_mov_b64 exec, -1
    v_and_b32 v8, 60, v7
    s_waitcnt lgkmcnt(0)
    s_barrier
    ds_read_b32 v9, v8 offset:16384
    ds_read_b32 v10, v8 offset:16448
    s_waitcnt lgkmcnt(0)
    v_readlane_b32 s56, v10, 15
    s_xor_b32 s56, s56, 0x80
    v_add_u32_dpp v9, v9, v9 row_shr:1 row_mask:0xf bank_mask:0xf bound_ctrl:1
    s_nop 1
    v_add_u32_dpp v9, v9, v9 row_shr:2 row_mask:0xf bank_mask:0xf bound_ctrl:1
    s_nop 1
    v_add_u32_dpp v9, v9, v9 row_shr:4 row_mask:0xf bank_mask:0xf bound_ctrl:1
    s_nop 1
    v_add_u32_dpp v9, v9, v9 row_shr:8 row_mask:0xf bank_mask:0xf bound_ctrl:1
    s_nop 0
    v_readlane_b32 s54, v9, s32
    s_sub_u32 s54, s54, s53
    s_add_u32 s50, s50, s54
    s_add_u32 s51, s51, s54
    s_add_u32 s52, s52, s54
    s_pack_ll_b32_b16 s48, s54, s50
    s_pack_ll_b32_b16 s49, s51, s52
    v_add_u32 v14, s48, v14
    v_add_u32 v15, s49, v15
    v_sub_u32 v12, v14, v12
    v_sub_u32 v13, v15, v13
    v_and_b32 v8, 0xffff, v12
    v_lshrrev_b32 v9, 16, v12
    v_and_b32 v10, 0xffff, v13
    v_lshrrev_b32 v11, 16, v13
    ds_write2st64_b32 v7, v8, v9 offset0:0 offset1:1
    ds_write2st64_b32 v7, v10, v11 offset0:2 offset1:3
    v_and_b32 v8, 0x3f0, v0
    v_lshl_add_u32 v8, v8, 1, s36
    ds_write_b64 v8, v[12:13] offset:20480
    s_bitset0_b64 exec, 63
    s_not_b64 exec, exec
    ds_write_b64 v8, v[14:15] offset:20512
    s_mov_b64 exec, -1
    s_waitcnt lgkmcnt(0)
    s_barrier
    s_setprio 3
    ds_add_rtn_u32 v120, v120, v2
    ds_add_rtn_u32 v121, v121, v2
    ds_add_rtn_u32 v122, v122, v2
    ds_add_rtn_u32 v123, v123, v2
    ds_read_b128 v[12:15], v0 offset:20480
    v_cmp_gt_u32 vcc, 8448, v0
    ds_add_rtn_u32 v124, v124, v2
    ds_add_rtn_u32 v125, v125, v2
    ds_add_rtn_u32 v126, v126, v2
    ds_add_rtn_u32 v127, v127, v2
    s_setprio 2
    ds_add_rtn_u32 v24, v24, v2
    ds_add_rtn_u32 v25, v25, v2
    ds_add_rtn_u32 v26, v26, v2
    ds_add_rtn_u32 v27, v27, v2
    s_waitcnt lgkmcnt(8)
    s_cbranch_vccz L1_p8
    s_add_u32 s44, s35, 0xa900000
    s_mov_b64 exec, vcc
    buffer_store_dwordx4 v[12:15], v0, s[24:27], s44 offen sc1
    s_mov_b64 exec, -1
L1_p8:
    s_add_u32 s45, s35, 0x7ec8000
    s_add_u32 s45, s45, s73
    buffer_store_dwordx4 v[88:91], v0, s[20:23], s45 offen sc1
    ds_add_rtn_u32 v52, v52, v2
    ds_add_rtn_u32 v53, v53, v2
    ds_add_rtn_u32 v54, v54, v2
    ds_add_rtn_u32 v55, v55, v2
    s_load_dwordx2 s[28:29], s[0:1], 0
    s_load_dwordx2 s[50:51], s[0:1], 40
    s_load_dwordx2 s[52:53], s[0:1], 24
    s_setprio 1
    ds_add_rtn_u32 v68, v68, v2
    ds_add_rtn_u32 v69, v69, v2
    ds_add_rtn_u32 v70, v70, v2
    ds_add_rtn_u32 v71, v71, v2
    s_add_u32 s80, s30, 0xd344000
    s_addc_u32 s81, s31, 0
    s_mov_b32 s82, 0xa000
    s_mov_b32 s83, 0x20000
    s_min_u32 s3, s84, 127
    s_mul_i32 s3, s3, 40960
    s_add_u32 s80, s80, s3
    s_addc_u32 s81, s81, 0
    s_cmp_ge_u32 s84, 128
    s_cselect_b32 s82, 0, s82
    s_waitcnt vmcnt(2)
    v_add_u32 v9, 0, v0
    buffer_store_dwordx4 v[112:115], v9, s[80:83], 0 offen sc1
    v_add_u32 v9, 16384, v0
    buffer_store_dwordx4 v[104:107], v9, s[80:83], 0 offen sc1
    v_add_u32 v9, 32768, v0
    buffer_store_dwordx4 v[28:31], v9, s[80:83], 0 offen sc1
    s_cmp_le_u32 s43, 5
    s_cbranch_scc1 L1_s9
    ds_add_rtn_u32 v76, v76, v2
    ds_add_rtn_u32 v77, v77, v2
    ds_add_rtn_u32 v78, v78, v2
    ds_add_rtn_u32 v79, v79, v2
L1_s9:
    s_setprio 0
    s_cmp_le_u32 s43, 6
    s_cbranch_scc1 L1_s10
    ds_add_rtn_u32 v56, v56, v2
    ds_add_rtn_u32 v57, v57, v2
    ds_add_rtn_u32 v58, v58, v2
    ds_add_rtn_u32 v59, v59, v2
L1_s10:
    s_cmp_le_u32 s43, 7
    s_cbranch_scc1 L1_s11
    ds_add_rtn_u32 v60, v60, v2
    ds_add_rtn_u32 v61, v61, v2
    ds_add_rtn_u32 v62, v62, v2
    ds_add_rtn_u32 v63, v63, v2
L1_s11:
    s_waitcnt lgkmcnt(0)
    s_barrier
    s_load_dwordx4 s[96:99], s[50:51], 0
    s_mov_b64 s[4:5], s[52:53]
    s_bfe_u32 s33, s2, 0x20001
    s_and_b32 s34, s2, 1
    s_lshl_b32 s34, s34, 5
    s_lshr_b32 s3, s2, 3
    s_add_u32 s34, s34, s3
    s_mul_i32 s39, s33, 2080
    s_lshl_b32 s3, s34, 5
    s_add_u32 s39, s39, s3
    s_mul_i32 s40, s33, 1310720
    s_add_u32 s40, s40, 0x50000
    s_lshl_b32 s38, s32, 11
    s_mul_i32 s100, s32, 3072
    s_add_u32 s8, s30, 0x4000
    s_addc_u32 s9, s31, 0
    s_mov_b32 s10, 0xd340000
    s_mov_b32 s11, 0x20000
    s_add_u32 s12, s30, 0x2c000
    s_addc_u32 s13, s31, 0
    s_mov_b32 s14, 0xd318000
    s_mov_b32 s15, 0x20000
    s_mov_b32 s16, s64
    s_mov_b32 s17, s65
    s_mov_b32 s18, 0x20
    s_mov_b32 s19, 0x20000
    s_mov_b32 s24, s28
    s_mov_b32 s25, s29
    s_mov_b32 s26, 0x4e2000
    s_mov_b32 s27, 0x20000
    s_setprio 3
    v_and_b32 v7, -4, v120
    v_lshl_add_u32 v8, v120, 2, v7
    ds_write_b32 v8, v16
    v_lshl_add_u32 v7, v7, 2, v120
    ds_write_b8 v7, v44 offset:16
    v_and_b32 v9, -4, v121
    v_lshl_add_u32 v10, v121, 2, v9
    ds_write_b32 v10, v17
    v_lshl_add_u32 v9, v9, 2, v121
    ds_write_b8_d16_hi v9, v44 offset:16
    v_and_b32 v7, -4, v122
    v_lshl_add_u32 v8, v122, 2, v7
    ds_write_b32 v8, v18
    v_lshl_add_u32 v7, v7, 2, v122
    ds_write_b8 v7, v45 offset:16
    v_and_b32 v9, -4, v123
    v_lshl_add_u32 v10, v123, 2, v9
    ds_write_b32 v10, v19
    v_lshl_add_u32 v9, v9, 2, v123
    ds_write_b8_d16_hi v9, v45 offset:16
    s_add_u32 s46, s35, 0x7ec8000
    s_add_u32 s46, s46, s85
    buffer_store_dwordx4 v[116:119], v0, s[20:23], s46 offen sc1
    v_and_b32 v13, 0x3f0, v0
    v_and_b32 v14, 0x300, v13
    v_bfe_u32 v15, v13, 4, 4
    s_lshl_b32 s3, s32, 4
    v_add3_u32 v14, v14, v15, s3
    v_mul_u32_u24 v2, 173056, v14
    v_lshrrev_b32 v14, 6, v13
    s_add_u32 s3, s3, 0x400
    v_add_u32 v14, s3, v14
    v_mul_u32_u24 v4, 173056, v14
    v_and_b32 v14, 3, v14
    v_and_b32 v15, 0x30, v13
    v_lshl_add_u32 v14, v14, 5, v15
    v_add_u32 v6, v14, v4
    v_lshl_add_u32 v5, v15, 1, v2
    v_lshrrev_b32 v14, 3, v15
    buffer_load_ushort v100, v14, s[16:19], 0 offen offset:0
    buffer_load_ushort v101, v14, s[16:19], 0 offen offset:8
    buffer_load_ushort v102, v14, s[16:19], 0 offen offset:16
    buffer_load_ushort v103, v14, s[16:19], 0 offen offset:24
    s_mul_i32 s3, s32, 5120
    v_add_u32 v3, s3, v13
    v_lshrrev_b32 v14, 2, v13
    v_add_u32 v14, s38, v14
    v_and_b32 v7, -4, v124
    v_lshl_add_u32 v8, v124, 2, v7
    ds_write_b32 v8, v20
    v_lshl_add_u32 v7, v7, 2, v124
    ds_write_b8 v7, v46 offset:16
    v_and_b32 v9, -4, v125
    v_lshl_add_u32 v10, v125, 2, v9
    ds_write_b32 v10, v21
    v_lshl_add_u32 v9, v9, 2, v125
    ds_write_b8_d16_hi v9, v46 offset:16
    v_and_b32 v7, -4, v126
    v_lshl_add_u32 v8, v126, 2, v7
    ds_write_b32 v8, v22
    v_lshl_add_u32 v7, v7, 2, v126
    ds_write_b8 v7, v47 offset:16
    v_and_b32 v9, -4, v127
    v_lshl_add_u32 v10, v127, 2, v9
    ds_write_b32 v10, v23
    v_lshl_add_u32 v9, v9, 2, v127
    ds_write_b8_d16_hi v9, v47 offset:16
    s_setprio 2
    v_and_b32 v7, -4, v24
    v_lshl_add_u32 v8, v24, 2, v7
    ds_write_b32 v8, v40
    v_lshl_add_u32 v7, v7, 2, v24
    ds_write_b8 v7, v32 offset:16
    v_and_b32 v9, -4, v25
    v_lshl_add_u32 v10, v25, 2, v9
    ds_write_b32 v10, v41
    v_lshl_add_u32 v9, v9, 2, v25
    ds_write_b8_d16_hi v9, v32 offset:16
    v_and_b32 v7, -4, v26
    v_lshl_add_u32 v8, v26, 2, v7
    ds_write_b32 v8, v42
    v_lshl_add_u32 v7, v7, 2, v26
    ds_write_b8 v7, v33 offset:16
    v_and_b32 v9, -4, v27
    v_lshl_add_u32 v10, v27, 2, v9
    ds_write_b32 v10, v43
    v_lshl_add_u32 v9, v9, 2, v27
    ds_write_b8_d16_hi v9, v33 offset:16
    s_add_u32 s47, s35, 0x7ec8000
    s_add_u32 s47, s47, s91
    buffer_store_dwordx4 v[92:95], v0, s[20:23], s47 offen sc1
    v_and_b32 v7, -4, v52
    v_lshl_add_u32 v8, v52, 2, v7
    ds_write_b32 v8, v48
    v_lshl_add_u32 v7, v7, 2, v52
    ds_write_b8 v7, v34 offset:16
    v_and_b32 v9, -4, v53
    v_lshl_add_u32 v10, v53, 2, v9
    ds_write_b32 v10, v49
    v_lshl_add_u32 v9, v9, 2, v53
    ds_write_b8_d16_hi v9, v34 offset:16
    v_and_b32 v7, -4, v54
    v_lshl_add_u32 v8, v54, 2, v7
    ds_write_b32 v8, v50
    v_lshl_add_u32 v7, v7, 2, v54
    ds_write_b8 v7, v35 offset:16
    v_and_b32 v9, -4, v55
    v_lshl_add_u32 v10, v55, 2, v9
    ds_write_b32 v10, v51
    v_lshl_add_u32 v9, v9, 2, v55
    ds_write_b8_d16_hi v9, v35 offset:16
    s_setprio 1
    v_and_b32 v7, -4, v68
    v_lshl_add_u32 v8, v68, 2, v7
    ds_write_b32 v8, v84
    v_lshl_add_u32 v7, v7, 2, v68
    ds_write_b8 v7, v72 offset:16
    v_and_b32 v9, -4, v69
    v_lshl_add_u32 v10, v69, 2, v9
    ds_write_b32 v10, v85
    v_lshl_add_u32 v9, v9, 2, v69
    ds_write_b8_d16_hi v9, v72 offset:16
    v_and_b32 v7, -4, v70
    v_lshl_add_u32 v8, v70, 2, v7
    ds_write_b32 v8, v86
    v_lshl_add_u32 v7, v7, 2, v70
    ds_write_b8 v7, v73 offset:16
    v_and_b32 v9, -4, v71
    v_lshl_add_u32 v10, v71, 2, v9
    ds_write_b32 v10, v87
    v_lshl_add_u32 v9, v9, 2, v71
    ds_write_b8_d16_hi v9, v73 offset:16
    s_cmp_le_u32 s43, 5
    s_cbranch_scc1 L1_s12
    v_and_b32 v7, -4, v76
    v_lshl_add_u32 v8, v76, 2, v7
    ds_write_b32 v8, v36
    v_lshl_add_u32 v7, v7, 2, v76
    ds_write_b8 v7, v74 offset:16
    v_and_b32 v9, -4, v77
    v_lshl_add_u32 v10, v77, 2, v9
    ds_write_b32 v10, v37
    v_lshl_add_u32 v9, v9, 2, v77
    ds_write_b8_d16_hi v9, v74 offset:16
    v_and_b32 v7, -4, v78
    v_lshl_add_u32 v8, v78, 2, v7
    ds_write_b32 v8, v38
    v_lshl_add_u32 v7, v7, 2, v78
    ds_write_b8 v7, v75 offset:16
    v_and_b32 v9, -4, v79
    v_lshl_add_u32 v10, v79, 2, v9
    ds_write_b32 v10, v39
    v_lshl_add_u32 v9, v9, 2, v79
    ds_write_b8_d16_hi v9, v75 offset:16
L1_s12:
    s_add_u32 s44, s35, 0x7ec8000
    s_add_u32 s44, s44, s93
    buffer_store_dwordx4 v[108:111], v0, s[20:23], s44 offen sc1
    s_setprio 0
    s_cmp_le_u32 s43, 6
    s_cbranch_scc1 L1_s13
    v_and_b32 v7, -4, v56
    v_lshl_add_u32 v8, v56, 2, v7
    ds_write_b32 v8, v80
    v_lshl_add_u32 v7, v7, 2, v56
    ds_write_b8 v7, v64 offset:16
    v_and_b32 v9, -4, v57
    v_lshl_add_u32 v10, v57, 2, v9
    ds_write_b32 v10, v81
    v_lshl_add_u32 v9, v9, 2, v57
    ds_write_b8_d16_hi v9, v64 offset:16
    v_and_b32 v7, -4, v58
    v_lshl_add_u32 v8, v58, 2, v7
    ds_write_b32 v8, v82
    v_lshl_add_u32 v7, v7, 2, v58
    ds_write_b8 v7, v65 offset:16
    v_and_b32 v9, -4, v59
    v_lshl_add_u32 v10, v59, 2, v9
    ds_write_b32 v10, v83
    v_lshl_add_u32 v9, v9, 2, v59
    ds_write_b8_d16_hi v9, v65 offset:16
L1_s13:
    s_cmp_le_u32 s43, 7
    s_cbranch_scc1 L1_s14
    v_and_b32 v7, -4, v60
    v_lshl_add_u32 v8, v60, 2, v7
    ds_write_b32 v8, v96
    v_lshl_add_u32 v7, v7, 2, v60
    ds_write_b8 v7, v66 offset:16
    v_and_b32 v9, -4, v61
    v_lshl_add_u32 v10, v61, 2, v9
    ds_write_b32 v10, v97
    v_lshl_add_u32 v9, v9, 2, v61
    ds_write_b8_d16_hi v9, v66 offset:16
    v_and_b32 v7, -4, v62
    v_lshl_add_u32 v8, v62, 2, v7
    ds_write_b32 v8, v98
    v_lshl_add_u32 v7, v7, 2, v62
    ds_write_b8 v7, v67 offset:16
    v_and_b32 v9, -4, v63
    v_lshl_add_u32 v10, v63, 2, v9
    ds_write_b32 v10, v99
    v_lshl_add_u32 v9, v9, 2, v63
    ds_write_b8_d16_hi v9, v67 offset:16
L1_s14:
    s_waitcnt vmcnt(3)
    v_add_u32 v7, 0x10000, v0
    v_add_u32 v12, 0x20000, v0
    s_waitcnt lgkmcnt(0)
    s_barrier
    ds_read_b128 v[24:27], v0 offset:0
    ds_read_b128 v[28:31], v0 offset:16384
    ds_read_b128 v[32:35], v0 offset:32768
    ds_read_b128 v[36:39], v0 offset:49152
    ds_read_b128 v[76:79], v7 offset:0
    ds_read_b128 v[80:83], v7 offset:16384
    ds_read_b128 v[84:87], v7 offset:32768
    ds_read_b128 v[104:107], v7 offset:49152
    ds_read_b128 v[68:71], v12 offset:0
    ds_read_b128 v[72:75], v12 offset:16384
    s_cmp_lg_u32 s32, 0
    s_cbranch_scc1 L2_sg1
    s_mov_b32 exec_hi, 0
    v_mov_b32 v11, 1
    buffer_store_dword v11, v14, s[60:63], s57 offen sc1
    s_mov_b64 exec, -1
L2_sg1:
    s_waitcnt lgkmcnt(9)
    s_add_u32 s45, s35, 0xa904000
    buffer_store_dwordx4 v[24:27], v0, s[20:23], s45 offen sc1
    s_waitcnt lgkmcnt(8)
    s_add_u32 s46, s35, 0xa908000
    buffer_store_dwordx4 v[28:31], v0, s[20:23], s46 offen sc1
    s_waitcnt lgkmcnt(7)
    s_add_u32 s47, s35, 0xa90c000
    buffer_store_dwordx4 v[32:35], v0, s[20:23], s47 offen sc1
    s_waitcnt lgkmcnt(6)
    s_add_u32 s44, s35, 0xa910000
    buffer_store_dwordx4 v[36:39], v0, s[20:23], s44 offen sc1
    s_waitcnt lgkmcnt(5)
    s_add_u32 s45, s35, 0xa914000
    buffer_store_dwordx4 v[76:79], v0, s[20:23], s45 offen sc1
    s_waitcnt lgkmcnt(4)
    s_add_u32 s46, s35, 0xa918000
    buffer_store_dwordx4 v[80:83], v0, s[20:23], s46 offen sc1
    s_waitcnt lgkmcnt(3)
    s_add_u32 s47, s35, 0xa91c000
    buffer_store_dwordx4 v[84:87], v0, s[20:23], s47 offen sc1
    s_waitcnt lgkmcnt(2)
    s_cmp_le_u32 s43, 5
    s_cbranch_scc1 L1_q15
    s_add_u32 s44, s35, 0xa920000
    buffer_store_dwordx4 v[104:107], v0, s[20:23], s44 offen sc1
L1_q15:
    s_waitcnt lgkmcnt(1)
    s_cmp_le_u32 s43, 6
    s_cbranch_scc1 L1_q16
    s_add_u32 s45, s35, 0xa924000
    buffer_store_dwordx4 v[68:71], v0, s[20:23], s45 offen sc1
L1_q16:
    s_waitcnt lgkmcnt(0)
    s_cmp_le_u32 s43, 7
    s_cbranch_scc1 L1_q17
    s_add_u32 s46, s35, 0xa928000
    buffer_store_dwordx4 v[72:75], v0, s[20:23], s46 offen sc1
L1_q17:
    s_waitcnt lgkmcnt(0)
    s_barrier
    s_setprio 3
    v_mov_b32 v92, v0
    v_mov_b32 v93, v6
    v_mov_b32 v94, v13
    v_mov_b32 v95, v5
    v_mov_b32 v0, v14
    v_lshl_add_u32 v7, v13, 3, s38
    v_lshrrev_b32 v16, 2, v15
    v_mad_u32_u24 v4, v16, 5, v4
    v_or_b32 v4, 0xf0000000, v4
    v_or_b32 v2, 0xf0000000, v2
    v_sub_u32 v1, 28, v16
    v_lshrrev_b32 v17, 2, v16
    v_and_b32 v18, 3, v17
    v_lshlrev_b32 v18, 4, v18
    v_mov_b32 v10, 0x3f80
    v_mov_b32 v11, 0
    v_lshlrev_b64 v[10:11], v18, v[10:11]
    v_and_b32 v18, 3, v17
    v_lshlrev_b32 v18, 4, v18
    v_mov_b32 v12, 0xbf80
    v_mov_b32 v13, 0
    v_lshlrev_b64 v[12:13], v18, v[12:13]
    v_mov_b32 v45, 0xf0000000
    v_mov_b32 v5, 0x1fff8
    v_mov_b32 v6, 0x07ff0000
    v_mov_b32 v16, 0
    v_mov_b32 v17, 0
    v_mov_b32 v18, 0
    v_mov_b32 v19, 0
    v_add_u32 v20, 81920, v92
    v_add_u32 v21, 0x10000, v20
    ds_write_b128 v20, v[16:19] offset:0
    ds_write_b128 v20, v[16:19] offset:16384
    s_setprio 2
    ds_write_b128 v20, v[16:19] offset:32768
    ds_write_b128 v20, v[16:19] offset:49152
    ds_write_b128 v21, v[16:19]
    s_setprio 1
    s_setprio 0
    s_mov_b32 s44, 0x4000c0c
    s_mov_b32 s45, 0x4010c0c
    s_mov_b32 s46, 0x4020c0c
    s_mov_b32 s47, 0x4030c0c
    s_mov_b32 s36, 0
    s_mov_b32 s43, 0
    s_mov_b32 s42, 0
    s_mov_b64 s[80:81], 0
    s_mov_b64 s[84:85], 0
    s_mov_b64 s[48:49], 0
    s_add_u32 s16, s30, 0xd344000
    s_addc_u32 s17, s31, 0
    s_mov_b32 s18, 0x500000
    s_mov_b32 s19, 0x20000
    s_add_u32 s20, s30, 0xd845000
    s_addc_u32 s21, s31, 0
    s_mov_b32 s22, 0x13880
    s_mov_b32 s23, 0x20000
    s_lshl_b32 s3, s33, 6
    s_add_u32 s3, s3, s34
    s_mul_i32 s3, s3, 80000
    s_add_u32 s20, s20, s3
    s_addc_u32 s21, s21, 0
    v_mov_b32 v68, 0
    v_mov_b32 v69, 0
    v_mov_b32 v70, 0
    v_mov_b32 v71, 0
    v_mov_b32 v72, 0
    v_mov_b32 v73, 0
    v_mov_b32 v74, 0
    v_mov_b32 v75, 0
    s_waitcnt vmcnt(0)
    v_lshl_or_b32 v8, v101, 16, v100
    v_lshl_or_b32 v9, v103, 16, v102
    s_barrier
    s_cmp_lg_u32 s32, 0
    s_cbranch_scc1 L2_sg2
    s_mov_b32 exec_hi, 0
    v_mov_b32 v88, 2
    buffer_store_dword v88, v0, s[60:63], s57 offen sc1
    s_mov_b64 exec, -1
L2_sg2:
    s_mul_i32 s3, s33, 1280000
    s_add_u32 s3, s3, s100
    s_add_u32 s3, s3, 32768
    buffer_load_dwordx4 v[124:127], v94, s[24:27], s3 offen offset:2048
    s_mul_i32 s3, s33, 1280000
    s_add_u32 s3, s3, s100
    s_add_u32 s3, s3, 32768
    buffer_load_dwordx4 v[116:119], v94, s[24:27], s3 offen offset:0
    s_mul_i32 s3, s33, 1280000
    s_add_u32 s3, s3, s100
    s_add_u32 s3, s3, 32768
    buffer_load_dwordx4 v[120:123], v94, s[24:27], s3 offen offset:1024
    s_mul_i32 s3, s33, 1280000
    s_add_u32 s3, s3, s38
    s_add_u32 s3, s3, 0
    buffer_load_dwordx4 v[108:111], v94, s[24:27], s3 offen offset:0
    s_mul_i32 s3, s33, 1280000
    s_add_u32 s3, s3, s38
    s_add_u32 s3, s3, 0
    buffer_load_dwordx4 v[112:115], v94, s[24:27], s3 offen offset:1024
    s_cmp_eq_u32 s56, 0
    s_cbranch_scc1 L2_e3
    v_lshlrev_b32 v16, 3, v94
    v_and_b32 v16, 0x80, v16
L2_e4:
    buffer_load_dword v88, v16, s[68:71], 0 offen sc1
    s_waitcnt vmcnt(0)
    v_cmp_gt_u32 vcc, 0x80, v88
    s_cbranch_vccnz L2_e4
L2_e3:
    s_mov_b64 exec, 0xffff
L2_p1:
    buffer_load_dword v88, v7, s[60:63], 0 offen sc1
    s_waitcnt vmcnt(0)
    v_cmp_gt_u32 vcc, 1, v88
    s_cbranch_vccnz L2_p1s
    s_mov_b64 exec, -1
    v_cmp_gt_u32 vcc, 2, v88
    s_and_b32 s56, vcc_lo, 0xffff
    buffer_load_dwordx4 v[48:51], v95, s[12:15], s39 offen offset:0
    buffer_load_dwordx4 v[56:59], v95, s[12:15], s39 offen offset:32
    buffer_load_dwordx4 v[52:55], v95, s[12:15], s39 offen offset:16
    buffer_load_dwordx4 v[60:63], v95, s[12:15], s39 offen offset:48
    buffer_load_dwordx4 v[64:67], v93, s[12:15], s39 offen
    s_waitcnt vmcnt(0)
    v_sub_u16 v88, v56, v48
    v_and_b32 v89, 3, v48
    v_add3_u32 v99, v88, v89, 3
    v_and_b32 v99, -4, v99
    v_max_u32 v99, 4, v99
    v_and_b32 v97, 0xfffc, v48
    v_bfm_b32 v96, v88, v89
    v_add_u32_dpp v91, v99, v99 row_shr:1 row_mask:0xf bank_mask:0xf bound_ctrl:1
    v_mad_u32_u24 v97, v97, 5, v2
    v_cmp_lt_u32 vcc, 16, v99
    v_add_u32_dpp v91, v91, v91 row_shr:2 row_mask:0xf bank_mask:0xf bound_ctrl:1
    v_sub_u32 v98, s38, v99
    v_lshrrev_b64 v[48:49], 16, v[48:49]
    v_add_u32_dpp v91, v91, v91 row_shr:4 row_mask:0xf bank_mask:0xf bound_ctrl:1
    v_lshrrev_b64 v[56:57], 16, v[56:57]
    s_mov_b32 s101, 0
    v_add_u32_dpp v91, v91, v91 row_shr:8 row_mask:0xf bank_mask:0xf bound_ctrl:1
    s_nop 1
    v_add_u32_dpp v91, v91, v91 row_bcast:15 row_mask:0xa bank_mask:0xf
    s_nop 1
    v_add_u32_dpp v91, v91, v91 row_bcast:31 row_mask:0xc bank_mask:0xf
    v_add_u32 v98, v98, v91
    v_readlane_b32 s37, v91, 63
    s_cbranch_vccnz L2_xo3
L2_xp3:
    v_mov_b32 v44, v43
    s_cmp_gt_u32 s37, 1024
    s_cbranch_scc1 L2_xs4
    s_cmp_lg_u32 s101, 0
    s_cbranch_scc1 L2_xa4
L2_xb4:
    v_lshlrev_b32 v89, 16, v96
    v_add_u32 v90, 60, v97
    v_bitop3_b32 v90, v89, v45, v90 bitop3:0x6a
    ds_write_b32 v98, v90 offset:12
    v_lshlrev_b32 v89, 20, v96
    v_add_u32 v90, 40, v97
    v_bitop3_b32 v90, v89, v45, v90 bitop3:0x6a
    ds_write_b32 v98, v90 offset:8
    v_lshlrev_b32 v89, 24, v96
    v_add_u32 v90, 20, v97
    v_bitop3_b32 v90, v89, v45, v90 bitop3:0x6a
    ds_write_b32 v98, v90 offset:4
    v_lshlrev_b32 v89, 28, v96
    v_bitop3_b32 v90, v89, v45, v97 bitop3:0x6a
    ds_write_b32 v98, v90 offset:0
    v_mov_b32_dpp v91, v64 quad_perm:[0,0,0,0] row_mask:0xf bank_mask:0xf
    v_and_b32 v89, 3, v91
    v_and_b32 v97, 0xfffc, v91
    v_sub_u16_dpp v88, v64, v91 quad_perm:[2,2,2,2] row_mask:0xf bank_mask:0xf
    v_mad_u32_u24 v97, v97, 5, v4
    v_add_u32 v99, v88, v89
    v_bfm_b32 v96, v88, v89
    v_cmp_lt_u32 s[58:59], 16, v99
    v_lshlrev_b32 v89, v1, v96
    v_and_b32 v89, v45, v89
    v_cmp_ne_u32 vcc, 0, v89
    v_xor_b32 v90, v97, v89
    s_add_u32 s3, s37, s38
    v_mbcnt_lo_u32_b32 v98, vcc_lo, 0
    v_mbcnt_hi_u32_b32 v98, vcc_hi, v98
    s_bcnt1_i32_b64 s41, vcc
    v_lshl_add_u32 v98, v98, 2, s3
    s_mov_b64 exec, vcc
    ds_write_b32 v98, v90
    s_mov_b64 exec, -1
    s_lshl2_add_u32 s37, s41, s37
    s_cmp_lg_u64 s[58:59], 0
    s_cbranch_scc1 L2_xe4
L2_xr4:
    v_add_u32 v98, s37, v0
    v_mov_b32 v90, -1
    ds_write_b32 v98, v90
    ds_read2st64_b32 v[40:41], v0 offset0:0 offset1:1
    ds_read2st64_b32 v[42:43], v0 offset0:2 offset1:3
    s_sub_u32 s3, s37, 768
    s_cmp_gt_u32 s3, 256
    s_cbranch_scc1 L2_xf4
L2_xg4:
    v_sub_u16 v88, v58, v50
    v_and_b32 v89, 3, v50
    v_add3_u32 v99, v88, v89, 3
    v_and_b32 v99, -4, v99
    v_max_u32 v99, 4, v99
    v_and_b32 v97, 0xfffc, v50
    v_bfm_b32 v96, v88, v89
    v_add_u32_dpp v91, v99, v99 row_shr:1 row_mask:0xf bank_mask:0xf bound_ctrl:1
    v_mad_u32_u24 v97, v97, 5, v2
    v_cmp_lt_u32 vcc, 16, v99
    v_add_u32_dpp v91, v91, v91 row_shr:2 row_mask:0xf bank_mask:0xf bound_ctrl:1
    v_sub_u32 v98, s38, v99
    v_lshrrev_b64 v[50:51], 16, v[50:51]
    v_add_u32_dpp v91, v91, v91 row_shr:4 row_mask:0xf bank_mask:0xf bound_ctrl:1
    v_lshrrev_b64 v[58:59], 16, v[58:59]
    s_mov_b32 s101, 0
    v_add_u32_dpp v91, v91, v91 row_shr:8 row_mask:0xf bank_mask:0xf bound_ctrl:1
    s_nop 1
    v_add_u32_dpp v91, v91, v91 row_bcast:15 row_mask:0xa bank_mask:0xf
    s_nop 1
    v_add_u32_dpp v91, v91, v91 row_bcast:31 row_mask:0xc bank_mask:0xf
    v_add_u32 v98, v98, v91
    v_readlane_b32 s37, v91, 63
    s_cbranch_vccnz L2_xo5
L2_xp5:
    s_waitcnt lgkmcnt(0)
    v_mov_b32 v21, v40
    v_mov_b32 v27, v41
    v_mov_b32 v33, v42
    v_mov_b32 v39, v43
    v_mov_b32 v44, v43
    s_cmp_gt_u32 s37, 1024
    s_cbranch_scc1 L2_xs6
    s_cmp_lg_u32 s101, 0
    s_cbranch_scc1 L2_xa6
L2_xb6:
    v_lshlrev_b32 v89, 16, v96
    v_add_u32 v90, 60, v97
    v_bitop3_b32 v90, v89, v45, v90 bitop3:0x6a
    ds_write_b32 v98, v90 offset:12
    v_lshlrev_b32 v89, 20, v96
    v_add_u32 v90, 40, v97
    v_bitop3_b32 v90, v89, v45, v90 bitop3:0x6a
    ds_write_b32 v98, v90 offset:8
    v_lshlrev_b32 v89, 24, v96
    v_add_u32 v90, 20, v97
    v_bitop3_b32 v90, v89, v45, v90 bitop3:0x6a
    ds_write_b32 v98, v90 offset:4
    v_lshlrev_b32 v89, 28, v96
    v_bitop3_b32 v90, v89, v45, v97 bitop3:0x6a
    ds_write_b32 v98, v90 offset:0
    v_mov_b32_dpp v91, v66 quad_perm:[0,0,0,0] row_mask:0xf bank_mask:0xf
    v_and_b32 v89, 3, v91
    v_and_b32 v97, 0xfffc, v91
    v_sub_u16_dpp v88, v66, v91 quad_perm:[2,2,2,2] row_mask:0xf bank_mask:0xf
    v_mad_u32_u24 v97, v97, 5, v4
    v_add_u32 v99, v88, v89
    v_bfm_b32 v96, v88, v89
    v_cmp_lt_u32 s[58:59], 16, v99
    v_lshlrev_b32 v89, v1, v96
    v_and_b32 v89, v45, v89
    v_cmp_ne_u32 vcc, 0, v89
    v_xor_b32 v90, v97, v89
    s_add_u32 s3, s37, s38
    v_mbcnt_lo_u32_b32 v98, vcc_lo, 0
    v_mbcnt_hi_u32_b32 v98, vcc_hi, v98
    s_bcnt1_i32_b64 s41, vcc
    v_lshl_add_u32 v98, v98, 2, s3
    s_mov_b64 exec, vcc
    ds_write_b32 v98, v90
    s_mov_b64 exec, -1
    s_lshl2_add_u32 s37, s41, s37
    s_cmp_lg_u64 s[58:59], 0
    s_cbranch_scc1 L2_xe6
L2_xr6:
    v_add_u32 v98, s37, v0
    v_mov_b32 v90, -1
    ds_write_b32 v98, v90
    ds_read2st64_b32 v[40:41], v0 offset0:0 offset1:1
    ds_read2st64_b32 v[42:43], v0 offset0:2 offset1:3
    s_sub_u32 s3, s37, 768
    s_cmp_gt_u32 s3, 256
    s_cbranch_scc1 L2_xf6
L2_xg6:
    v_subrev_u32 v88, s38, v3
    ds_write_b128 v88, v[124:127] offset:34816
    v_subrev_u32 v88, s38, v3
    ds_write_b128 v88, v[116:119] offset:32768
    v_subrev_u32 v88, s38, v3
    ds_write_b128 v88, v[120:123] offset:33792
    v_subrev_u32 v88, s100, v3
    ds_write_b128 v88, v[108:111] offset:0
    v_subrev_u32 v88, s100, v3
    ds_write_b128 v88, v[112:115] offset:1024
    s_cmp_eq_u32 s56, 0
    s_cbranch_scc1 L2_e2
    s_mov_b64 exec, 0xffff
    buffer_load_dword v88, v7, s[60:63], 0 offen sc1
    s_mov_b64 exec, -1
    s_waitcnt vmcnt(0)
    v_cmp_gt_u32 vcc, 2, v88
    s_and_b32 s56, vcc_lo, 0xffff
    s_cbranch_scc0 L2_e2
    s_mul_i32 s3, s33, 1280000
    s_add_u32 s3, s3, s100
    s_add_u32 s3, s3, 352768
    buffer_load_dwordx4 v[124:127], v94, s[24:27], s3 offen offset:2048
    s_mul_i32 s3, s33, 1280000
    s_add_u32 s3, s3, s100
    s_add_u32 s3, s3, 352768
    buffer_load_dwordx4 v[116:119], v94, s[24:27], s3 offen offset:0
    s_mul_i32 s3, s33, 1280000
    s_add_u32 s3, s3, s100
    s_add_u32 s3, s3, 352768
    buffer_load_dwordx4 v[120:123], v94, s[24:27], s3 offen offset:1024
    s_mul_i32 s3, s33, 1280000
    s_add_u32 s3, s3, s38
    s_add_u32 s3, s3, 320000
    buffer_load_dwordx4 v[108:111], v94, s[24:27], s3 offen offset:0
    s_mul_i32 s3, s33, 1280000
    s_add_u32 s3, s3, s38
    s_add_u32 s3, s3, 320000
    buffer_load_dwordx4 v[112:115], v94, s[24:27], s3 offen offset:1024
    s_mov_b64 exec, 0xffff
L2_p2:
    buffer_load_dword v88, v7, s[60:63], 0 offen sc1
    s_waitcnt vmcnt(0)
    v_cmp_gt_u32 vcc, 2, v88
    s_cbranch_vccnz L2_p2s
    s_mov_b64 exec, -1
L2_e2:
    s_mov_b32 s6, 0xaaaaaaaa
    s_mov_b32 s7, 0xaaaaaaaa
    v_and_b32 v47, 0x0fffffff, v21
    buffer_load_dwordx2 v[16:17], v47, s[8:11], 0 offen
    buffer_load_dwordx3 v[18:20], v47, s[8:11], 0 offen offset:8
    s_waitcnt lgkmcnt(0)
    s_barrier
    s_bitcmp1_b32 s36, s42
    s_cbranch_scc1 L2_slow
L2_ret0:
    s_setprio 3
    v_and_b32 v47, 0x0fffffff, v27
    buffer_load_dwordx2 v[22:23], v47, s[8:11], 0 offen
    buffer_load_dwordx3 v[24:26], v47, s[8:11], 0 offen offset:8
    s_waitcnt vmcnt(2)
    v_and_b32 v46, 0x20000000, v21
    v_lshrrev_b32 v47, 14, v17
    v_bitop3_b32 v47, v47, v5, v46 bitop3:0xea
    ds_read_b64 v[102:103], v47
    v_bitop3_b32 v93, v17, v5, v46 bitop3:0xea
    v_and_b32 v46, 0x10000000, v21
    v_lshrrev_b32 v47, 14, v16
    v_bitop3_b32 v47, v47, v5, v46 bitop3:0xea
    ds_read_b64 v[100:101], v47
    v_bitop3_b32 v92, v16, v5, v46 bitop3:0xea
    v_perm_b32 v15, v17, v20, s45
    v_bitop3_b32 v46, v17, 0.5, -0.5 bitop3:0xa8
    v_perm_b32 v14, v16, v20, s44
    v_bitop3_b32 v47, v16, 0.5, -0.5 bitop3:0xa8
    s_waitcnt lgkmcnt(0)
    v_mfma_f32_4x4x4_16b_bf16 v[80:83], v[8:9], v[102:103], 0
    v_mfma_f32_4x4x4_16b_bf16 v[76:79], v[8:9], v[100:101], 0
    v_bitop3_b32 v15, v6, v15, v46 bitop3:0xca
    v_bitop3_b32 v14, v6, v14, v47 bitop3:0xca
    v_cmp_lt_u32 s[84:85], v5, v92
    s_nop 0
    v_pk_mul_f32 v[80:81], v[80:81], v[14:15] op_sel:[0,1] op_sel_hi:[1,1]
    v_pk_mul_f32 v[82:83], v[82:83], v[14:15] op_sel:[0,1] op_sel_hi:[1,1]
    v_pk_mul_f32 v[76:77], v[76:77], v[14:15] op_sel:[0,0] op_sel_hi:[1,0]
    v_pk_mul_f32 v[78:79], v[78:79], v[14:15] op_sel:[0,0] op_sel_hi:[1,0]
    v_and_b32 v47, 0x0fffffff, v33
    buffer_load_dwordx2 v[28:29], v47, s[8:11], 0 offen
    buffer_load_dwordx3 v[30:32], v47, s[8:11], 0 offen offset:8
    v_cmp_ne_u64 s[50:51], v[72:73], v[68:69]
    v_cmpx_ne_u64 s[54:55], v[74:75], v[70:71]
    s_and_b64 s[82:83], s[54:55], s[80:81]
    s_cbranch_scc1 L2_c7
L2_d7:
    v_mov_b64 v[84:85], v[70:71]
    v_mov_b32 v7, v95
    v_mov_b64 v[86:87], v[74:75]
    s_or_b64 s[80:81], s[80:81], s[54:55]
    s_mov_b64 exec, s[50:51]
    s_and_b64 s[82:83], s[50:51], s[80:81]
    s_cbranch_scc1 L2_c8
L2_d8:
    v_mov_b64 v[84:85], v[68:69]
    v_mov_b32 v7, v94
    v_mov_b64 v[86:87], v[72:73]
    s_mov_b64 exec, -1
    s_or_b64 s[80:81], s[80:81], s[50:51]
    ds_read_b64 v[70:71], v93 offset:65408
    s_and_b64 exec, s[84:85], s[80:81]
    v_mfma_f32_4x4x4_16b_bf16 v[76:79], v[12:13], v[84:85], 0
    v_mov_b32 v92, v7
    s_andn2_b64 s[80:81], s[80:81], s[84:85]
    v_mfma_f32_4x4x4_16b_bf16 v[76:79], v[10:11], v[86:87], v[76:79]
    s_mov_b64 exec, -1
    ds_read_b64 v[68:69], v92 offset:65408
    v_and_b32 v46, 0x80000000, v21
    v_lshrrev_b32 v47, 14, v19
    v_bitop3_b32 v47, v47, v5, v46 bitop3:0xea
    ds_read_b64 v[106:107], v47
    v_bitop3_b32 v95, v19, v5, v46 bitop3:0xea
    v_and_b32 v46, 0x40000000, v21
    v_lshrrev_b32 v47, 14, v18
    v_bitop3_b32 v47, v47, v5, v46 bitop3:0xea
    ds_read_b64 v[104:105], v47
    v_bitop3_b32 v94, v18, v5, v46 bitop3:0xea
    s_waitcnt lgkmcnt(2)
    v_mfma_f32_4x4x4_16b_bf16 v[80:83], v[10:11], v[70:71], v[80:83]
    v_mfma_f32_4x4x4_16b_bf16 v[76:79], v[10:11], v[68:69], v[76:79]
    v_perm_b32 v15, v19, v20, s47
    v_bitop3_b32 v46, v19, 0.5, -0.5 bitop3:0xa8
    v_perm_b32 v14, v18, v20, s46
    v_bitop3_b32 v47, v18, 0.5, -0.5 bitop3:0xa8
    v_cvt_pk_bf16_f32 v80, v80, v81
    v_cvt_pk_bf16_f32 v81, v82, v83
    ds_wrxchg_rtn_b64 v[74:75], v93, v[80:81] offset:65408
    v_cvt_pk_bf16_f32 v76, v76, v77
    v_cvt_pk_bf16_f32 v77, v78, v79
    ds_wrxchg_rtn_b64 v[72:73], v92, v[76:77] offset:65408
    s_setprio 2
    s_waitcnt lgkmcnt(2)
    v_mfma_f32_4x4x4_16b_bf16 v[80:83], v[8:9], v[106:107], 0
    v_mfma_f32_4x4x4_16b_bf16 v[76:79], v[8:9], v[104:105], 0
    v_bitop3_b32 v15, v6, v15, v46 bitop3:0xca
    v_bitop3_b32 v14, v6, v14, v47 bitop3:0xca
    s_nop 1
    v_pk_mul_f32 v[80:81], v[80:81], v[14:15] op_sel:[0,1] op_sel_hi:[1,1]
    v_pk_mul_f32 v[82:83], v[82:83], v[14:15] op_sel:[0,1] op_sel_hi:[1,1]
    v_pk_mul_f32 v[76:77], v[76:77], v[14:15] op_sel:[0,0] op_sel_hi:[1,0]
    v_pk_mul_f32 v[78:79], v[78:79], v[14:15] op_sel:[0,0] op_sel_hi:[1,0]
    v_sub_u16 v88, v60, v52
    v_and_b32 v89, 3, v52
    v_add3_u32 v99, v88, v89, 3
    v_and_b32 v99, -4, v99
    v_max_u32 v99, 4, v99
    v_and_b32 v97, 0xfffc, v52
    v_bfm_b32 v96, v88, v89
    v_add_u32_dpp v91, v99, v99 row_shr:1 row_mask:0xf bank_mask:0xf bound_ctrl:1
    v_mad_u32_u24 v97, v97, 5, v2
    v_cmp_lt_u32 vcc, 16, v99
    v_add_u32_dpp v91, v91, v91 row_shr:2 row_mask:0xf bank_mask:0xf bound_ctrl:1
    v_sub_u32 v98, s38, v99
    v_lshrrev_b64 v[52:53], 16, v[52:53]
    v_add_u32_dpp v91, v91, v91 row_shr:4 row_mask:0xf bank_mask:0xf bound_ctrl:1
    v_lshrrev_b64 v[60:61], 16, v[60:61]
    s_mov_b32 s101, 0
    v_add_u32_dpp v91, v91, v91 row_shr:8 row_mask:0xf bank_mask:0xf bound_ctrl:1
    s_nop 1
    v_add_u32_dpp v91, v91, v91 row_bcast:15 row_mask:0xa bank_mask:0xf
    s_nop 1
    v_add_u32_dpp v91, v91, v91 row_bcast:31 row_mask:0xc bank_mask:0xf
    v_add_u32 v98, v98, v91
    v_readlane_b32 s37, v91, 63
    s_cbranch_vccnz L2_xo9
L2_xp9:
    v_and_b32 v47, 0x3f0, v3
    s_cmp_lg_u32 s56, 0
    s_cbranch_scc1 L2_m10
    s_mul_i32 s3, s33, 1280000
    s_add_u32 s3, s3, s100
    s_add_u32 s3, s3, 352768
    buffer_load_dwordx4 v[124:127], v47, s[24:27], s3 offen offset:2048
L2_m10:
    v_and_b32 v47, 0x3f0, v3
    s_cmp_lg_u32 s56, 0
    s_cbranch_scc1 L2_m11
    s_mul_i32 s3, s33, 1280000
    s_add_u32 s3, s3, s100
    s_add_u32 s3, s3, 352768
    buffer_load_dwordx4 v[116:119], v47, s[24:27], s3 offen offset:0
L2_m11:
    s_waitcnt lgkmcnt(0)
    v_cmp_ne_u64 s[50:51], v[72:73], v[68:69]
    v_cmpx_ne_u64 s[54:55], v[74:75], v[70:71]
    s_and_b64 s[82:83], s[54:55], s[80:81]
    s_cbranch_scc1 L2_c12
L2_d12:
    v_mov_b64 v[84:85], v[70:71]
    v_mov_b32 v7, v93
    v_mov_b64 v[86:87], v[74:75]
    s_or_b64 s[80:81], s[80:81], s[54:55]
    s_mov_b64 exec, s[50:51]
    s_and_b64 s[82:83], s[50:51], s[80:81]
    s_cbranch_scc1 L2_c13
L2_d13:
    v_mov_b64 v[84:85], v[68:69]
    v_mov_b32 v7, v92
    v_mov_b64 v[86:87], v[72:73]
    s_mov_b64 exec, -1
    s_or_b64 s[80:81], s[80:81], s[50:51]
    ds_read_b64 v[70:71], v95 offset:65408
    ds_read_b64 v[68:69], v94 offset:65408
    s_waitcnt vmcnt(2)
    v_and_b32 v46, 0x20000000, v27
    v_lshrrev_b32 v47, 14, v23
    v_bitop3_b32 v47, v47, v5, v46 bitop3:0xea
    ds_read_b64 v[102:103], v47
    v_bitop3_b32 v93, v23, v5, v46 bitop3:0xea
    v_and_b32 v46, 0x10000000, v27
    v_lshrrev_b32 v47, 14, v22
    v_bitop3_b32 v47, v47, v5, v46 bitop3:0xea
    ds_read_b64 v[100:101], v47
    v_bitop3_b32 v92, v22, v5, v46 bitop3:0xea
    s_waitcnt lgkmcnt(2)
    v_mfma_f32_4x4x4_16b_bf16 v[80:83], v[10:11], v[70:71], v[80:83]
    v_mfma_f32_4x4x4_16b_bf16 v[76:79], v[10:11], v[68:69], v[76:79]
    v_perm_b32 v15, v23, v26, s45
    v_bitop3_b32 v46, v23, 0.5, -0.5 bitop3:0xa8
    v_perm_b32 v14, v22, v26, s44
    v_bitop3_b32 v47, v22, 0.5, -0.5 bitop3:0xa8
    v_cvt_pk_bf16_f32 v80, v80, v81
    v_cvt_pk_bf16_f32 v81, v82, v83
    ds_wrxchg_rtn_b64 v[74:75], v95, v[80:81] offset:65408
    v_cvt_pk_bf16_f32 v76, v76, v77
    v_cvt_pk_bf16_f32 v77, v78, v79
    ds_wrxchg_rtn_b64 v[72:73], v94, v[76:77] offset:65408
    s_waitcnt lgkmcnt(2)
    v_mfma_f32_4x4x4_16b_bf16 v[80:83], v[8:9], v[102:103], 0
    v_mfma_f32_4x4x4_16b_bf16 v[76:79], v[8:9], v[100:101], 0
    v_bitop3_b32 v15, v6, v15, v46 bitop3:0xca
    v_bitop3_b32 v14, v6, v14, v47 bitop3:0xca
    v_cmp_lt_u32 s[84:85], v5, v92
    s_nop 0
    v_pk_mul_f32 v[80:81], v[80:81], v[14:15] op_sel:[0,1] op_sel_hi:[1,1]
    v_pk_mul_f32 v[82:83], v[82:83], v[14:15] op_sel:[0,1] op_sel_hi:[1,1]
    v_pk_mul_f32 v[76:77], v[76:77], v[14:15] op_sel:[0,0] op_sel_hi:[1,0]
    v_pk_mul_f32 v[78:79], v[78:79], v[14:15] op_sel:[0,0] op_sel_hi:[1,0]
    v_and_b32 v47, 0x0fffffff, v39
    buffer_load_dwordx2 v[34:35], v47, s[8:11], 0 offen
    buffer_load_dwordx3 v[36:38], v47, s[8:11], 0 offen offset:8
    v_and_b32 v47, 0x3f0, v3
    s_cmp_lg_u32 s56, 0
    s_cbranch_scc1 L2_m14
    s_mul_i32 s3, s33, 1280000
    s_add_u32 s3, s3, s100
    s_add_u32 s3, s3, 352768
    buffer_load_dwordx4 v[120:123], v47, s[24:27], s3 offen offset:1024
L2_m14:
    s_waitcnt lgkmcnt(0)
    v_cmp_ne_u64 s[50:51], v[72:73], v[68:69]
    v_cmpx_ne_u64 s[54:55], v[74:75], v[70:71]
    s_and_b64 s[82:83], s[54:55], s[80:81]
    s_cbranch_scc1 L2_c15
L2_d15:
    v_mov_b64 v[84:85], v[70:71]
    v_mov_b32 v7, v95
    v_mov_b64 v[86:87], v[74:75]
    s_or_b64 s[80:81], s[80:81], s[54:55]
    s_mov_b64 exec, s[50:51]
    s_and_b64 s[82:83], s[50:51], s[80:81]
    s_cbranch_scc1 L2_c16
L2_d16:
    v_mov_b64 v[84:85], v[68:69]
    v_mov_b32 v7, v94
    v_mov_b64 v[86:87], v[72:73]
    s_mov_b64 exec, -1
    s_or_b64 s[80:81], s[80:81], s[50:51]
    ds_read_b64 v[70:71], v93 offset:65408
    s_and_b64 exec, s[84:85], s[80:81]
    v_mfma_f32_4x4x4_16b_bf16 v[76:79], v[12:13], v[84:85], 0
    v_mov_b32 v92, v7
    s_andn2_b64 s[80:81], s[80:81], s[84:85]
    v_mfma_f32_4x4x4_16b_bf16 v[76:79], v[10:11], v[86:87], v[76:79]
    s_mov_b64 exec, -1
    ds_read_b64 v[68:69], v92 offset:65408
    v_and_b32 v46, 0x80000000, v27
    v_lshrrev_b32 v47, 14, v25
    v_bitop3_b32 v47, v47, v5, v46 bitop3:0xea
    ds_read_b64 v[106:107], v47
    v_bitop3_b32 v95, v25, v5, v46 bitop3:0xea
    v_and_b32 v46, 0x40000000, v27
    v_lshrrev_b32 v47, 14, v24
    v_bitop3_b32 v47, v47, v5, v46 bitop3:0xea
    ds_read_b64 v[104:105], v47
    v_bitop3_b32 v94, v24, v5, v46 bitop3:0xea
    s_waitcnt lgkmcnt(2)
    v_mfma_f32_4x4x4_16b_bf16 v[80:83], v[10:11], v[70:71], v[80:83]
    v_mfma_f32_4x4x4_16b_bf16 v[76:79], v[10:11], v[68:69], v[76:79]
    v_perm_b32 v15, v25, v26, s47
    v_bitop3_b32 v46, v25, 0.5, -0.5 bitop3:0xa8
    v_perm_b32 v14, v24, v26, s46
    v_bitop3_b32 v47, v24, 0.5, -0.5 bitop3:0xa8
    v_cvt_pk_bf16_f32 v80, v80, v81
    v_cvt_pk_bf16_f32 v81, v82, v83
    ds_wrxchg_rtn_b64 v[74:75], v93, v[80:81] offset:65408
    v_cvt_pk_bf16_f32 v76, v76, v77
    v_cvt_pk_bf16_f32 v77, v78, v79
    ds_wrxchg_rtn_b64 v[72:73], v92, v[76:77] offset:65408
    s_setprio 1
    s_waitcnt lgkmcnt(2)
    v_mfma_f32_4x4x4_16b_bf16 v[80:83], v[8:9], v[106:107], 0
    v_mfma_f32_4x4x4_16b_bf16 v[76:79], v[8:9], v[104:105], 0
    v_bitop3_b32 v15, v6, v15, v46 bitop3:0xca
    v_bitop3_b32 v14, v6, v14, v47 bitop3:0xca
    s_nop 1
    v_pk_mul_f32 v[80:81], v[80:81], v[14:15] op_sel:[0,1] op_sel_hi:[1,1]
    v_pk_mul_f32 v[82:83], v[82:83], v[14:15] op_sel:[0,1] op_sel_hi:[1,1]
    v_pk_mul_f32 v[76:77], v[76:77], v[14:15] op_sel:[0,0] op_sel_hi:[1,0]
    v_pk_mul_f32 v[78:79], v[78:79], v[14:15] op_sel:[0,0] op_sel_hi:[1,0]
    v_and_b32 v47, 0x3f0, v3
    s_cmp_lg_u32 s56, 0
    s_cbranch_scc1 L2_m17
    s_mul_i32 s3, s33, 1280000
    s_add_u32 s3, s3, s38
    s_add_u32 s3, s3, 320000
    buffer_load_dwordx4 v[108:111], v47, s[24:27], s3 offen offset:0
L2_m17:
    v_and_b32 v47, 0x3f0, v3
    s_cmp_lg_u32 s56, 0
    s_cbranch_scc1 L2_m18
    s_mul_i32 s3, s33, 1280000
    s_add_u32 s3, s3, s38
    s_add_u32 s3, s3, 320000
    buffer_load_dwordx4 v[112:115], v47, s[24:27], s3 offen offset:1024
L2_m18:
    v_and_b32 v47, 0x0fffffff, v40
    v_mov_b32 v21, v40
    buffer_load_dwordx2 v[16:17], v47, s[8:11], 0 offen
    buffer_load_dwordx3 v[18:20], v47, s[8:11], 0 offen offset:8
    s_waitcnt lgkmcnt(0)
    v_cmp_ne_u64 s[50:51], v[72:73], v[68:69]
    v_cmpx_ne_u64 s[54:55], v[74:75], v[70:71]
    s_and_b64 s[82:83], s[54:55], s[80:81]
    s_cbranch_scc1 L2_c19
L2_d19:
    v_mov_b64 v[84:85], v[70:71]
    v_mov_b32 v7, v93
    v_mov_b64 v[86:87], v[74:75]
    s_or_b64 s[80:81], s[80:81], s[54:55]
    s_mov_b64 exec, s[50:51]
    s_and_b64 s[82:83], s[50:51], s[80:81]
    s_cbranch_scc1 L2_c20
L2_d20:
    v_mov_b64 v[84:85], v[68:69]
    v_mov_b32 v7, v92
    v_mov_b64 v[86:87], v[72:73]
    s_mov_b64 exec, -1
    s_or_b64 s[80:81], s[80:81], s[50:51]
    ds_read_b64 v[70:71], v95 offset:65408
    ds_read_b64 v[68:69], v94 offset:65408
    s_waitcnt vmcnt(4)
    v_and_b32 v46, 0x20000000, v33
    v_lshrrev_b32 v47, 14, v29
    v_bitop3_b32 v47, v47, v5, v46 bitop3:0xea
    ds_read_b64 v[102:103], v47
    v_bitop3_b32 v93, v29, v5, v46 bitop3:0xea
    v_and_b32 v46, 0x10000000, v33
    v_lshrrev_b32 v47, 14, v28
    v_bitop3_b32 v47, v47, v5, v46 bitop3:0xea
    ds_read_b64 v[100:101], v47
    v_bitop3_b32 v92, v28, v5, v46 bitop3:0xea
    s_waitcnt lgkmcnt(2)
    v_mfma_f32_4x4x4_16b_bf16 v[80:83], v[10:11], v[70:71], v[80:83]
    v_mfma_f32_4x4x4_16b_bf16 v[76:79], v[10:11], v[68:69], v[76:79]
    v_perm_b32 v15, v29, v32, s45
    v_bitop3_b32 v46, v29, 0.5, -0.5 bitop3:0xa8
    v_perm_b32 v14, v28, v32, s44
    v_bitop3_b32 v47, v28, 0.5, -0.5 bitop3:0xa8
    v_cvt_pk_bf16_f32 v80, v80, v81
    v_cvt_pk_bf16_f32 v81, v82, v83
    ds_wrxchg_rtn_b64 v[74:75], v95, v[80:81] offset:65408
    v_cvt_pk_bf16_f32 v76, v76, v77
    v_cvt_pk_bf16_f32 v77, v78, v79
    ds_wrxchg_rtn_b64 v[72:73], v94, v[76:77] offset:65408
    s_waitcnt lgkmcnt(2)
    v_mfma_f32_4x4x4_16b_bf16 v[80:83], v[8:9], v[102:103], 0
    v_mfma_f32_4x4x4_16b_bf16 v[76:79], v[8:9], v[100:101], 0
    v_bitop3_b32 v15, v6, v15, v46 bitop3:0xca
    v_bitop3_b32 v14, v6, v14, v47 bitop3:0xca
    v_cmp_lt_u32 s[84:85], v5, v92
    s_nop 0
    v_pk_mul_f32 v[80:81], v[80:81], v[14:15] op_sel:[0,1] op_sel_hi:[1,1]
    v_pk_mul_f32 v[82:83], v[82:83], v[14:15] op_sel:[0,1] op_sel_hi:[1,1]
    v_pk_mul_f32 v[76:77], v[76:77], v[14:15] op_sel:[0,0] op_sel_hi:[1,0]
    v_pk_mul_f32 v[78:79], v[78:79], v[14:15] op_sel:[0,0] op_sel_hi:[1,0]
    s_waitcnt lgkmcnt(0)
    v_cmp_ne_u64 s[50:51], v[72:73], v[68:69]
    v_cmpx_ne_u64 s[54:55], v[74:75], v[70:71]
    s_and_b64 s[82:83], s[54:55], s[80:81]
    s_cbranch_scc1 L2_c21
L2_d21:
    v_mov_b64 v[84:85], v[70:71]
    v_mov_b32 v7, v95
    v_mov_b64 v[86:87], v[74:75]
    s_or_b64 s[80:81], s[80:81], s[54:55]
    s_mov_b64 exec, s[50:51]
    s_and_b64 s[82:83], s[50:51], s[80:81]
    s_cbranch_scc1 L2_c22
L2_d22:
    v_mov_b64 v[84:85], v[68:69]
    v_mov_b32 v7, v94
    v_mov_b64 v[86:87], v[72:73]
    s_mov_b64 exec, -1
    s_or_b64 s[80:81], s[80:81], s[50:51]
    ds_read_b64 v[70:71], v93 offset:65408
    s_and_b64 exec, s[84:85], s[80:81]
    v_mfma_f32_4x4x4_16b_bf16 v[76:79], v[12:13], v[84:85], 0
    v_mov_b32 v92, v7
    s_andn2_b64 s[80:81], s[80:81], s[84:85]
    v_mfma_f32_4x4x4_16b_bf16 v[76:79], v[10:11], v[86:87], v[76:79]
    s_mov_b64 exec, -1
    ds_read_b64 v[68:69], v92 offset:65408
    v_and_b32 v46, 0x80000000, v33
    v_lshrrev_b32 v47, 14, v31
    v_bitop3_b32 v47, v47, v5, v46 bitop3:0xea
    ds_read_b64 v[106:107], v47
    v_bitop3_b32 v95, v31, v5, v46 bitop3:0xea
    v_and_b32 v46, 0x40000000, v33
    v_lshrrev_b32 v47, 14, v30
    v_bitop3_b32 v47, v47, v5, v46 bitop3:0xea
    ds_read_b64 v[104:105], v47
    v_bitop3_b32 v94, v30, v5, v46 bitop3:0xea
    s_waitcnt lgkmcnt(2)
    v_mfma_f32_4x4x4_16b_bf16 v[80:83], v[10:11], v[70:71], v[80:83]
    v_mfma_f32_4x4x4_16b_bf16 v[76:79], v[10:11], v[68:69], v[76:79]
    v_perm_b32 v15, v31, v32, s47
    v_bitop3_b32 v46, v31, 0.5, -0.5 bitop3:0xa8
    v_perm_b32 v14, v30, v32, s46
    v_bitop3_b32 v47, v30, 0.5, -0.5 bitop3:0xa8
    v_cvt_pk_bf16_f32 v80, v80, v81
    v_cvt_pk_bf16_f32 v81, v82, v83
    ds_wrxchg_rtn_b64 v[74:75], v93, v[80:81] offset:65408
    v_cvt_pk_bf16_f32 v76, v76, v77
    v_cvt_pk_bf16_f32 v77, v78, v79
    ds_wrxchg_rtn_b64 v[72:73], v92, v[76:77] offset:65408
    s_setprio 0
    s_waitcnt lgkmcnt(2)
    v_mfma_f32_4x4x4_16b_bf16 v[80:83], v[8:9], v[106:107], 0
    v_mfma_f32_4x4x4_16b_bf16 v[76:79], v[8:9], v[104:105], 0
    v_bitop3_b32 v15, v6, v15, v46 bitop3:0xca
    v_bitop3_b32 v14, v6, v14, v47 bitop3:0xca
    s_nop 1
    v_pk_mul_f32 v[80:81], v[80:81], v[14:15] op_sel:[0,1] op_sel_hi:[1,1]
    v_pk_mul_f32 v[82:83], v[82:83], v[14:15] op_sel:[0,1] op_sel_hi:[1,1]
    v_pk_mul_f32 v[76:77], v[76:77], v[14:15] op_sel:[0,0] op_sel_hi:[1,0]
    v_pk_mul_f32 v[78:79], v[78:79], v[14:15] op_sel:[0,0] op_sel_hi:[1,0]
    s_add_u32 s40, s40, 0x50000
    v_and_b32 v47, 0x0fffffff, v41
    v_mov_b32 v27, v41
    buffer_load_dwordx2 v[22:23], v47, s[8:11], 0 offen
    buffer_load_dwordx3 v[24:26], v47, s[8:11], 0 offen offset:8
    s_waitcnt lgkmcnt(0)
    v_cmp_ne_u64 s[50:51], v[72:73], v[68:69]
    v_cmpx_ne_u64 s[54:55], v[74:75], v[70:71]
    s_and_b64 s[82:83], s[54:55], s[80:81]
    s_cbranch_scc1 L2_c23
L2_d23:
    v_mov_b64 v[84:85], v[70:71]
    v_mov_b32 v7, v93
    v_mov_b64 v[86:87], v[74:75]
    s_or_b64 s[80:81], s[80:81], s[54:55]
    s_mov_b64 exec, s[50:51]
    s_and_b64 s[82:83], s[50:51], s[80:81]
    s_cbranch_scc1 L2_c24
L2_d24:
    v_mov_b64 v[84:85], v[68:69]
    v_mov_b32 v7, v92
    v_mov_b64 v[86:87], v[72:73]
    s_mov_b64 exec, -1
    s_or_b64 s[80:81], s[80:81], s[50:51]
    ds_read_b64 v[70:71], v95 offset:65408
    ds_read_b64 v[68:69], v94 offset:65408
    s_waitcnt vmcnt(4)
    v_and_b32 v46, 0x20000000, v39
    v_lshrrev_b32 v47, 14, v35
    v_bitop3_b32 v47, v47, v5, v46 bitop3:0xea
    ds_read_b64 v[102:103], v47
    v_bitop3_b32 v93, v35, v5, v46 bitop3:0xea
    v_and_b32 v46, 0x10000000, v39
    v_lshrrev_b32 v47, 14, v34
    v_bitop3_b32 v47, v47, v5, v46 bitop3:0xea
    ds_read_b64 v[100:101], v47
    v_bitop3_b32 v92, v34, v5, v46 bitop3:0xea
    v_and_b32 v46, 0x80000000, v39
    v_lshrrev_b32 v47, 14, v37
    v_bitop3_b32 v47, v47, v5, v46 bitop3:0xea
    ds_read_b64 v[106:107], v47
    v_and_b32 v46, 0x40000000, v39
    v_lshrrev_b32 v47, 14, v36
    v_bitop3_b32 v47, v47, v5, v46 bitop3:0xea
    ds_read_b64 v[104:105], v47
    s_waitcnt lgkmcnt(4)
    v_mfma_f32_4x4x4_16b_bf16 v[80:83], v[10:11], v[70:71], v[80:83]
    v_mfma_f32_4x4x4_16b_bf16 v[76:79], v[10:11], v[68:69], v[76:79]
    v_perm_b32 v15, v35, v38, s45
    v_bitop3_b32 v46, v35, 0.5, -0.5 bitop3:0xa8
    v_perm_b32 v14, v34, v38, s44
    v_bitop3_b32 v47, v34, 0.5, -0.5 bitop3:0xa8
    v_cvt_pk_bf16_f32 v80, v80, v81
    v_cvt_pk_bf16_f32 v81, v82, v83
    ds_wrxchg_rtn_b64 v[74:75], v95, v[80:81] offset:65408
    v_cvt_pk_bf16_f32 v76, v76, v77
    v_cvt_pk_bf16_f32 v77, v78, v79
    ds_wrxchg_rtn_b64 v[72:73], v94, v[76:77] offset:65408
    s_waitcnt lgkmcnt(2)
    s_barrier
    s_setprio 3
    s_waitcnt vmcnt(6)
    v_subrev_u32 v88, s38, v3
    ds_write_b128 v88, v[116:119] offset:32768
    buffer_load_dwordx4 v[116:119], v3, s[16:19], s40 offen offset:2048
    s_waitcnt vmcnt(5)
    v_subrev_u32 v88, s38, v3
    ds_write_b128 v88, v[120:123] offset:33792
    buffer_load_dwordx4 v[120:123], v3, s[16:19], s40 offen offset:3072
    v_mfma_f32_4x4x4_16b_bf16 v[80:83], v[8:9], v[102:103], 0
    v_mfma_f32_4x4x4_16b_bf16 v[76:79], v[8:9], v[100:101], 0
    v_bitop3_b32 v15, v6, v15, v46 bitop3:0xca
    v_bitop3_b32 v14, v6, v14, v47 bitop3:0xca
    v_cmp_lt_u32 s[84:85], v5, v92
    s_nop 0
    v_pk_mul_f32 v[80:81], v[80:81], v[14:15] op_sel:[0,1] op_sel_hi:[1,1]
    v_pk_mul_f32 v[82:83], v[82:83], v[14:15] op_sel:[0,1] op_sel_hi:[1,1]
    v_pk_mul_f32 v[76:77], v[76:77], v[14:15] op_sel:[0,0] op_sel_hi:[1,0]
    v_pk_mul_f32 v[78:79], v[78:79], v[14:15] op_sel:[0,0] op_sel_hi:[1,0]
    v_and_b32 v47, 0x0fffffff, v42
    v_mov_b32 v33, v42
    buffer_load_dwordx2 v[28:29], v47, s[8:11], 0 offen
    buffer_load_dwordx3 v[30:32], v47, s[8:11], 0 offen offset:8
    v_mov_b32 v44, v43
    s_cmp_gt_u32 s37, 1024
    s_cbranch_scc1 L2_xs25
    s_cmp_lg_u32 s101, 0
    s_cbranch_scc1 L2_xa25
L2_xb25:
    v_lshlrev_b32 v89, 16, v96
    v_add_u32 v90, 60, v97
    v_bitop3_b32 v90, v89, v45, v90 bitop3:0x6a
    ds_write_b32 v98, v90 offset:12
    v_lshlrev_b32 v89, 20, v96
    v_add_u32 v90, 40, v97
    v_bitop3_b32 v90, v89, v45, v90 bitop3:0x6a
    ds_write_b32 v98, v90 offset:8
    v_lshlrev_b32 v89, 24, v96
    v_add_u32 v90, 20, v97
    v_bitop3_b32 v90, v89, v45, v90 bitop3:0x6a
    ds_write_b32 v98, v90 offset:4
    v_lshlrev_b32 v89, 28, v96
    v_bitop3_b32 v90, v89, v45, v97 bitop3:0x6a
    ds_write_b32 v98, v90 offset:0
    v_mov_b32_dpp v91, v64 quad_perm:[1,1,1,1] row_mask:0xf bank_mask:0xf
    v_and_b32 v89, 3, v91
    v_and_b32 v97, 0xfffc, v91
    v_sub_u16_dpp v88, v64, v91 quad_perm:[3,3,3,3] row_mask:0xf bank_mask:0xf
    v_mad_u32_u24 v97, v97, 5, v4
    v_add_u32 v99, v88, v89
    v_bfm_b32 v96, v88, v89
    v_cmp_lt_u32 s[58:59], 16, v99
    v_lshlrev_b32 v89, v1, v96
    v_and_b32 v89, v45, v89
    v_cmp_ne_u32 vcc, 0, v89
    v_xor_b32 v90, v97, v89
    s_add_u32 s3, s37, s38
    v_mbcnt_lo_u32_b32 v98, vcc_lo, 0
    v_mbcnt_hi_u32_b32 v98, vcc_hi, v98
    s_bcnt1_i32_b64 s41, vcc
    v_lshl_add_u32 v98, v98, 2, s3
    s_mov_b64 exec, vcc
    ds_write_b32 v98, v90
    s_mov_b64 exec, -1
    s_lshl2_add_u32 s37, s41, s37
    s_cmp_lg_u64 s[58:59], 0
    s_cbranch_scc1 L2_xe25
L2_xr25:
    v_add_u32 v98, s37, v0
    v_mov_b32 v90, -1
    ds_write_b32 v98, v90
    ds_read2st64_b32 v[40:41], v0 offset0:0 offset1:1
    ds_read2st64_b32 v[42:43], v0 offset0:2 offset1:3
    s_sub_u32 s3, s37, 768
    s_cmp_gt_u32 s3, 256
    s_cbranch_scc1 L2_xf25
L2_xg25:
    s_setprio 2
    s_waitcnt vmcnt(10)
    v_subrev_u32 v88, s38, v3
    ds_write_b128 v88, v[124:127] offset:34816
    s_add_u32 s3, s40, 4096
    buffer_load_dwordx4 v[124:127], v3, s[16:19], s3 offen
    s_waitcnt lgkmcnt(11)
    v_cmp_ne_u64 s[50:51], v[72:73], v[68:69]
    v_cmpx_ne_u64 s[54:55], v[74:75], v[70:71]
    s_and_b64 s[82:83], s[54:55], s[80:81]
    s_cbranch_scc1 L2_c26
L2_d26:
    v_mov_b64 v[84:85], v[70:71]
    v_mov_b32 v7, v95
    v_mov_b64 v[86:87], v[74:75]
    s_or_b64 s[80:81], s[80:81], s[54:55]
    s_mov_b64 exec, s[50:51]
    s_and_b64 s[82:83], s[50:51], s[80:81]
    s_cbranch_scc1 L2_c27
L2_d27:
    v_mov_b64 v[84:85], v[68:69]
    v_mov_b32 v7, v94
    v_mov_b64 v[86:87], v[72:73]
    s_mov_b64 exec, -1
    s_or_b64 s[80:81], s[80:81], s[50:51]
    ds_read_b64 v[70:71], v93 offset:65408
    s_and_b64 exec, s[84:85], s[80:81]
    v_mfma_f32_4x4x4_16b_bf16 v[76:79], v[12:13], v[84:85], 0
    v_mov_b32 v92, v7
    s_andn2_b64 s[80:81], s[80:81], s[84:85]
    v_mfma_f32_4x4x4_16b_bf16 v[76:79], v[10:11], v[86:87], v[76:79]
    s_mov_b64 exec, -1
    ds_read_b64 v[68:69], v92 offset:65408
    s_setprio 1
    s_waitcnt vmcnt(9)
    v_subrev_u32 v88, s100, v3
    ds_write_b128 v88, v[108:111] offset:0
    s_waitcnt lgkmcnt(1)
    v_mfma_f32_4x4x4_16b_bf16 v[80:83], v[10:11], v[70:71], v[80:83]
    v_mfma_f32_4x4x4_16b_bf16 v[76:79], v[10:11], v[68:69], v[76:79]
    v_and_b32 v46, 0x40000000, v39
    v_bitop3_b32 v94, v36, v5, v46 bitop3:0xea
    v_and_b32 v46, 0x80000000, v39
    v_bitop3_b32 v95, v37, v5, v46 bitop3:0xea
    v_perm_b32 v15, v37, v38, s47
    v_bitop3_b32 v46, v37, 0.5, -0.5 bitop3:0xa8
    v_perm_b32 v14, v36, v38, s46
    v_bitop3_b32 v47, v36, 0.5, -0.5 bitop3:0xa8
    v_cvt_pk_bf16_f32 v80, v80, v81
    v_cvt_pk_bf16_f32 v81, v82, v83
    ds_wrxchg_rtn_b64 v[74:75], v93, v[80:81] offset:65408
    v_cvt_pk_bf16_f32 v76, v76, v77
    v_cvt_pk_bf16_f32 v77, v78, v79
    ds_wrxchg_rtn_b64 v[72:73], v92, v[76:77] offset:65408
    s_setprio 0
    s_waitcnt vmcnt(9)
    v_subrev_u32 v88, s100, v3
    ds_write_b128 v88, v[112:115] offset:1024
    v_mfma_f32_4x4x4_16b_bf16 v[80:83], v[8:9], v[106:107], 0
    v_mfma_f32_4x4x4_16b_bf16 v[76:79], v[8:9], v[104:105], 0
    v_bitop3_b32 v15, v6, v15, v46 bitop3:0xca
    v_bitop3_b32 v14, v6, v14, v47 bitop3:0xca
    s_nop 1
    v_pk_mul_f32 v[80:81], v[80:81], v[14:15] op_sel:[0,1] op_sel_hi:[1,1]
    v_pk_mul_f32 v[82:83], v[82:83], v[14:15] op_sel:[0,1] op_sel_hi:[1,1]
    v_pk_mul_f32 v[76:77], v[76:77], v[14:15] op_sel:[0,0] op_sel_hi:[1,0]
    v_pk_mul_f32 v[78:79], v[78:79], v[14:15] op_sel:[0,0] op_sel_hi:[1,0]
    s_add_u32 s42, s42, 1
    s_waitcnt lgkmcnt(0)
    s_add_u32 s24, s30, 0xebcd000
    s_addc_u32 s25, s31, 0
    s_mov_b32 s26, 0x100
    s_mov_b32 s27, 0x20000
    s_barrier
    s_bitcmp1_b32 s36, s42
    s_cbranch_scc1 L2_slow
L2_ret1:
    s_setprio 3
    v_and_b32 v47, 0x0fffffff, v44
    v_mov_b32 v39, v44
    buffer_load_dwordx2 v[34:35], v47, s[8:11], 0 offen
    buffer_load_dwordx3 v[36:38], v47, s[8:11], 0 offen offset:8
    buffer_load_dwordx4 v[108:111], v3, s[16:19], s40 offen offset:0
    v_cmp_ne_u64 s[50:51], v[72:73], v[68:69]
    v_cmpx_ne_u64 s[54:55], v[74:75], v[70:71]
    s_and_b64 s[82:83], s[54:55], s[80:81]
    s_cbranch_scc1 L2_c28
L2_d28:
    v_mov_b64 v[84:85], v[70:71]
    v_mov_b32 v7, v93
    v_mov_b64 v[86:87], v[74:75]
    s_or_b64 s[80:81], s[80:81], s[54:55]
    s_mov_b64 exec, s[50:51]
    s_and_b64 s[82:83], s[50:51], s[80:81]
    s_cbranch_scc1 L2_c29
L2_d29:
    v_mov_b64 v[84:85], v[68:69]
    v_mov_b32 v7, v92
    v_mov_b64 v[86:87], v[72:73]
    s_mov_b64 exec, -1
    s_or_b64 s[80:81], s[80:81], s[50:51]
    ds_read_b64 v[70:71], v95 offset:65408
    ds_read_b64 v[68:69], v94 offset:65408
    s_waitcnt vmcnt(10)
    v_and_b32 v46, 0x20000000, v21
    v_lshrrev_b32 v47, 14, v17
    v_bitop3_b32 v47, v47, v5, v46 bitop3:0xea
    ds_read_b64 v[102:103], v47
    v_bitop3_b32 v93, v17, v5, v46 bitop3:0xea
    v_and_b32 v46, 0x10000000, v21
    v_lshrrev_b32 v47, 14, v16
    v_bitop3_b32 v47, v47, v5, v46 bitop3:0xea
    ds_read_b64 v[100:101], v47
    v_bitop3_b32 v92, v16, v5, v46 bitop3:0xea
    s_waitcnt lgkmcnt(2)
    v_mfma_f32_4x4x4_16b_bf16 v[80:83], v[10:11], v[70:71], v[80:83]
    v_mfma_f32_4x4x4_16b_bf16 v[76:79], v[10:11], v[68:69], v[76:79]
    v_perm_b32 v15, v17, v20, s45
    v_bitop3_b32 v46, v17, 0.5, -0.5 bitop3:0xa8
    v_perm_b32 v14, v16, v20, s44
    v_bitop3_b32 v47, v16, 0.5, -0.5 bitop3:0xa8
    v_cvt_pk_bf16_f32 v80, v80, v81
    v_cvt_pk_bf16_f32 v81, v82, v83
    ds_wrxchg_rtn_b64 v[74:75], v95, v[80:81] offset:65408
    v_cvt_pk_bf16_f32 v76, v76, v77
    v_cvt_pk_bf16_f32 v77, v78, v79
    ds_wrxchg_rtn_b64 v[72:73], v94, v[76:77] offset:65408
    s_waitcnt lgkmcnt(2)
    v_mfma_f32_4x4x4_16b_bf16 v[80:83], v[8:9], v[102:103], 0
    v_mfma_f32_4x4x4_16b_bf16 v[76:79], v[8:9], v[100:101], 0
    v_bitop3_b32 v15, v6, v15, v46 bitop3:0xca
    v_bitop3_b32 v14, v6, v14, v47 bitop3:0xca
    v_cmp_lt_u32 s[84:85], v5, v92
    s_nop 0
    v_pk_mul_f32 v[80:81], v[80:81], v[14:15] op_sel:[0,1] op_sel_hi:[1,1]
    v_pk_mul_f32 v[82:83], v[82:83], v[14:15] op_sel:[0,1] op_sel_hi:[1,1]
    v_pk_mul_f32 v[76:77], v[76:77], v[14:15] op_sel:[0,0] op_sel_hi:[1,0]
    v_pk_mul_f32 v[78:79], v[78:79], v[14:15] op_sel:[0,0] op_sel_hi:[1,0]
    buffer_load_dwordx4 v[112:115], v3, s[16:19], s40 offen offset:1024
    s_waitcnt lgkmcnt(0)
    v_cmp_ne_u64 s[50:51], v[72:73], v[68:69]
    v_cmpx_ne_u64 s[54:55], v[74:75], v[70:71]
    s_and_b64 s[82:83], s[54:55], s[80:81]
    s_cbranch_scc1 L2_c30
L2_d30:
    v_mov_b64 v[84:85], v[70:71]
    v_mov_b32 v7, v95
    v_mov_b64 v[86:87], v[74:75]
    s_or_b64 s[80:81], s[80:81], s[54:55]
    s_mov_b64 exec, s[50:51]
    s_and_b64 s[82:83], s[50:51], s[80:81]
    s_cbranch_scc1 L2_c31
L2_d31:
    v_mov_b64 v[84:85], v[68:69]
    v_mov_b32 v7, v94
    v_mov_b64 v[86:87], v[72:73]
    s_mov_b64 exec, -1
    s_or_b64 s[80:81], s[80:81], s[50:51]
    ds_read_b64 v[70:71], v93 offset:65408
    s_and_b64 exec, s[84:85], s[80:81]
    v_mfma_f32_4x4x4_16b_bf16 v[76:79], v[12:13], v[84:85], 0
    v_mov_b32 v92, v7
    s_andn2_b64 s[80:81], s[80:81], s[84:85]
    v_mfma_f32_4x4x4_16b_bf16 v[76:79], v[10:11], v[86:87], v[76:79]
    s_mov_b64 exec, -1
    ds_read_b64 v[68:69], v92 offset:65408
    v_and_b32 v46, 0x80000000, v21
    v_lshrrev_b32 v47, 14, v19
    v_bitop3_b32 v47, v47, v5, v46 bitop3:0xea
    ds_read_b64 v[106:107], v47
    v_bitop3_b32 v95, v19, v5, v46 bitop3:0xea
    v_and_b32 v46, 0x40000000, v21
    v_lshrrev_b32 v47, 14, v18
    v_bitop3_b32 v47, v47, v5, v46 bitop3:0xea
    ds_read_b64 v[104:105], v47
    v_bitop3_b32 v94, v18, v5, v46 bitop3:0xea
    s_waitcnt lgkmcnt(2)
    v_mfma_f32_4x4x4_16b_bf16 v[80:83], v[10:11], v[70:71], v[80:83]
    v_mfma_f32_4x4x4_16b_bf16 v[76:79], v[10:11], v[68:69], v[76:79]
    v_perm_b32 v15, v19, v20, s47
    v_bitop3_b32 v46, v19, 0.5, -0.5 bitop3:0xa8
    v_perm_b32 v14, v18, v20, s46
    v_bitop3_b32 v47, v18, 0.5, -0.5 bitop3:0xa8
    v_cvt_pk_bf16_f32 v80, v80, v81
    v_cvt_pk_bf16_f32 v81, v82, v83
    ds_wrxchg_rtn_b64 v[74:75], v93, v[80:81] offset:65408
    v_cvt_pk_bf16_f32 v76, v76, v77
    v_cvt_pk_bf16_f32 v77, v78, v79
    ds_wrxchg_rtn_b64 v[72:73], v92, v[76:77] offset:65408
    s_setprio 2
    s_waitcnt lgkmcnt(2)
    v_mfma_f32_4x4x4_16b_bf16 v[80:83], v[8:9], v[106:107], 0
    v_mfma_f32_4x4x4_16b_bf16 v[76:79], v[8:9], v[104:105], 0
    v_bitop3_b32 v15, v6, v15, v46 bitop3:0xca
    v_bitop3_b32 v14, v6, v14, v47 bitop3:0xca
    s_nop 1
    v_pk_mul_f32 v[80:81], v[80:81], v[14:15] op_sel:[0,1] op_sel_hi:[1,1]
    v_pk_mul_f32 v[82:83], v[82:83], v[14:15] op_sel:[0,1] op_sel_hi:[1,1]
    v_pk_mul_f32 v[76:77], v[76:77], v[14:15] op_sel:[0,0] op_sel_hi:[1,0]
    v_pk_mul_f32 v[78:79], v[78:79], v[14:15] op_sel:[0,0] op_sel_hi:[1,0]
    v_sub_u16 v88, v62, v54
    v_and_b32 v89, 3, v54
    v_add3_u32 v99, v88, v89, 3
    v_and_b32 v99, -4, v99
    v_max_u32 v99, 4, v99
    v_and_b32 v97, 0xfffc, v54
    v_bfm_b32 v96, v88, v89
    v_add_u32_dpp v91, v99, v99 row_shr:1 row_mask:0xf bank_mask:0xf bound_ctrl:1
    v_mad_u32_u24 v97, v97, 5, v2
    v_cmp_lt_u32 vcc, 16, v99
    v_add_u32_dpp v91, v91, v91 row_shr:2 row_mask:0xf bank_mask:0xf bound_ctrl:1
    v_sub_u32 v98, s38, v99
    v_lshrrev_b64 v[54:55], 16, v[54:55]
    v_add_u32_dpp v91, v91, v91 row_shr:4 row_mask:0xf bank_mask:0xf bound_ctrl:1
    v_lshrrev_b64 v[62:63], 16, v[62:63]
    s_mov_b32 s101, 0
    v_add_u32_dpp v91, v91, v91 row_shr:8 row_mask:0xf bank_mask:0xf bound_ctrl:1
    s_nop 1
    v_add_u32_dpp v91, v91, v91 row_bcast:15 row_mask:0xa bank_mask:0xf
    s_nop 1
    v_add_u32_dpp v91, v91, v91 row_bcast:31 row_mask:0xc bank_mask:0xf
    v_add_u32 v98, v98, v91
    v_readlane_b32 s37, v91, 63
    s_cbranch_vccnz L2_xo32
L2_xp32:
    v_and_b32 v47, 0x0fffffff, v40
    v_mov_b32 v21, v40
    buffer_load_dwordx2 v[16:17], v47, s[8:11], 0 offen
    buffer_load_dwordx3 v[18:20], v47, s[8:11], 0 offen offset:8
    s_waitcnt lgkmcnt(0)
    v_cmp_ne_u64 s[50:51], v[72:73], v[68:69]
    v_cmpx_ne_u64 s[54:55], v[74:75], v[70:71]
    s_and_b64 s[82:83], s[54:55], s[80:81]
    s_cbranch_scc1 L2_c33
L2_d33:
    v_mov_b64 v[84:85], v[70:71]
    v_mov_b32 v7, v93
    v_mov_b64 v[86:87], v[74:75]
    s_or_b64 s[80:81], s[80:81], s[54:55]
    s_mov_b64 exec, s[50:51]
    s_and_b64 s[82:83], s[50:51], s[80:81]
    s_cbranch_scc1 L2_c34
L2_d34:
    v_mov_b64 v[84:85], v[68:69]
    v_mov_b32 v7, v92
    v_mov_b64 v[86:87], v[72:73]
    s_mov_b64 exec, -1
    s_or_b64 s[80:81], s[80:81], s[50:51]
    ds_read_b64 v[70:71], v95 offset:65408
    ds_read_b64 v[68:69], v94 offset:65408
    s_waitcnt vmcnt(11)
    v_and_b32 v46, 0x20000000, v27
    v_lshrrev_b32 v47, 14, v23
    v_bitop3_b32 v47, v47, v5, v46 bitop3:0xea
    ds_read_b64 v[102:103], v47
    v_bitop3_b32 v93, v23, v5, v46 bitop3:0xea
    v_and_b32 v46, 0x10000000, v27
    v_lshrrev_b32 v47, 14, v22
    v_bitop3_b32 v47, v47, v5, v46 bitop3:0xea
    ds_read_b64 v[100:101], v47
    v_bitop3_b32 v92, v22, v5, v46 bitop3:0xea
    s_waitcnt lgkmcnt(2)
    v_mfma_f32_4x4x4_16b_bf16 v[80:83], v[10:11], v[70:71], v[80:83]
    v_mfma_f32_4x4x4_16b_bf16 v[76:79], v[10:11], v[68:69], v[76:79]
    v_perm_b32 v15, v23, v26, s45
    v_bitop3_b32 v46, v23, 0.5, -0.5 bitop3:0xa8
    v_perm_b32 v14, v22, v26, s44
    v_bitop3_b32 v47, v22, 0.5, -0.5 bitop3:0xa8
    v_cvt_pk_bf16_f32 v80, v80, v81
    v_cvt_pk_bf16_f32 v81, v82, v83
    ds_wrxchg_rtn_b64 v[74:75], v95, v[80:81] offset:65408
    v_cvt_pk_bf16_f32 v76, v76, v77
    v_cvt_pk_bf16_f32 v77, v78, v79
    ds_wrxchg_rtn_b64 v[72:73], v94, v[76:77] offset:65408
    s_waitcnt lgkmcnt(2)
    v_mfma_f32_4x4x4_16b_bf16 v[80:83], v[8:9], v[102:103], 0
    v_mfma_f32_4x4x4_16b_bf16 v[76:79], v[8:9], v[100:101], 0
    v_bitop3_b32 v15, v6, v15, v46 bitop3:0xca
    v_bitop3_b32 v14, v6, v14, v47 bitop3:0xca
    v_cmp_lt_u32 s[84:85], v5, v92
    s_nop 0
    v_pk_mul_f32 v[80:81], v[80:81], v[14:15] op_sel:[0,1] op_sel_hi:[1,1]
    v_pk_mul_f32 v[82:83], v[82:83], v[14:15] op_sel:[0,1] op_sel_hi:[1,1]
    v_pk_mul_f32 v[76:77], v[76:77], v[14:15] op_sel:[0,0] op_sel_hi:[1,0]
    v_pk_mul_f32 v[78:79], v[78:79], v[14:15] op_sel:[0,0] op_sel_hi:[1,0]
    s_waitcnt lgkmcnt(0)
    v_cmp_ne_u64 s[50:51], v[72:73], v[68:69]
    v_cmpx_ne_u64 s[54:55], v[74:75], v[70:71]
    s_and_b64 s[82:83], s[54:55], s[80:81]
    s_cbranch_scc1 L2_c35
L2_d35:
    v_mov_b64 v[84:85], v[70:71]
    v_mov_b32 v7, v95
    v_mov_b64 v[86:87], v[74:75]
    s_or_b64 s[80:81], s[80:81], s[54:55]
    s_mov_b64 exec, s[50:51]
    s_and_b64 s[82:83], s[50:51], s[80:81]
    s_cbranch_scc1 L2_c36
L2_d36:
    v_mov_b64 v[84:85], v[68:69]
    v_mov_b32 v7, v94
    v_mov_b64 v[86:87], v[72:73]
    s_mov_b64 exec, -1
    s_or_b64 s[80:81], s[80:81], s[50:51]
    ds_read_b64 v[70:71], v93 offset:65408
    s_and_b64 exec, s[84:85], s[80:81]
    v_mfma_f32_4x4x4_16b_bf16 v[76:79], v[12:13], v[84:85], 0
    v_mov_b32 v92, v7
    s_andn2_b64 s[80:81], s[80:81], s[84:85]
    v_mfma_f32_4x4x4_16b_bf16 v[76:79], v[10:11], v[86:87], v[76:79]
    s_mov_b64 exec, -1
    ds_read_b64 v[68:69], v92 offset:65408
    v_and_b32 v46, 0x80000000, v27
    v_lshrrev_b32 v47, 14, v25
    v_bitop3_b32 v47, v47, v5, v46 bitop3:0xea
    ds_read_b64 v[106:107], v47
    v_bitop3_b32 v95, v25, v5, v46 bitop3:0xea
    v_and_b32 v46, 0x40000000, v27
    v_lshrrev_b32 v47, 14, v24
    v_bitop3_b32 v47, v47, v5, v46 bitop3:0xea
    ds_read_b64 v[104:105], v47
    v_bitop3_b32 v94, v24, v5, v46 bitop3:0xea
    s_waitcnt lgkmcnt(2)
    v_mfma_f32_4x4x4_16b_bf16 v[80:83], v[10:11], v[70:71], v[80:83]
    v_mfma_f32_4x4x4_16b_bf16 v[76:79], v[10:11], v[68:69], v[76:79]
    v_perm_b32 v15, v25, v26, s47
    v_bitop3_b32 v46, v25, 0.5, -0.5 bitop3:0xa8
    v_perm_b32 v14, v24, v26, s46
    v_bitop3_b32 v47, v24, 0.5, -0.5 bitop3:0xa8
    v_cvt_pk_bf16_f32 v80, v80, v81
    v_cvt_pk_bf16_f32 v81, v82, v83
    ds_wrxchg_rtn_b64 v[74:75], v93, v[80:81] offset:65408
    v_cvt_pk_bf16_f32 v76, v76, v77
    v_cvt_pk_bf16_f32 v77, v78, v79
    ds_wrxchg_rtn_b64 v[72:73], v92, v[76:77] offset:65408
    s_setprio 1
    s_waitcnt lgkmcnt(2)
    v_mfma_f32_4x4x4_16b_bf16 v[80:83], v[8:9], v[106:107], 0
    v_mfma_f32_4x4x4_16b_bf16 v[76:79], v[8:9], v[104:105], 0
    v_bitop3_b32 v15, v6, v15, v46 bitop3:0xca
    v_bitop3_b32 v14, v6, v14, v47 bitop3:0xca
    s_nop 1
    v_pk_mul_f32 v[80:81], v[80:81], v[14:15] op_sel:[0,1] op_sel_hi:[1,1]
    v_pk_mul_f32 v[82:83], v[82:83], v[14:15] op_sel:[0,1] op_sel_hi:[1,1]
    v_pk_mul_f32 v[76:77], v[76:77], v[14:15] op_sel:[0,0] op_sel_hi:[1,0]
    v_pk_mul_f32 v[78:79], v[78:79], v[14:15] op_sel:[0,0] op_sel_hi:[1,0]
    v_and_b32 v47, 0x0fffffff, v41
    v_mov_b32 v27, v41
    buffer_load_dwordx2 v[22:23], v47, s[8:11], 0 offen
    buffer_load_dwordx3 v[24:26], v47, s[8:11], 0 offen offset:8
    s_waitcnt lgkmcnt(0)
    v_cmp_ne_u64 s[50:51], v[72:73], v[68:69]
    v_cmpx_ne_u64 s[54:55], v[74:75], v[70:71]
    s_and_b64 s[82:83], s[54:55], s[80:81]
    s_cbranch_scc1 L2_c37
L2_d37:
    v_mov_b64 v[84:85], v[70:71]
    v_mov_b32 v7, v93
    v_mov_b64 v[86:87], v[74:75]
    s_or_b64 s[80:81], s[80:81], s[54:55]
    s_mov_b64 exec, s[50:51]
    s_and_b64 s[82:83], s[50:51], s[80:81]
    s_cbranch_scc1 L2_c38
L2_d38:
    v_mov_b64 v[84:85], v[68:69]
    v_mov_b32 v7, v92
    v_mov_b64 v[86:87], v[72:73]
    s_mov_b64 exec, -1
    s_or_b64 s[80:81], s[80:81], s[50:51]
    ds_read_b64 v[70:71], v95 offset:65408
    ds_read_b64 v[68:69], v94 offset:65408
    s_waitcnt vmcnt(9)
    v_and_b32 v46, 0x20000000, v33
    v_lshrrev_b32 v47, 14, v29
    v_bitop3_b32 v47, v47, v5, v46 bitop3:0xea
    ds_read_b64 v[102:103], v47
    v_bitop3_b32 v93, v29, v5, v46 bitop3:0xea
    v_and_b32 v46, 0x10000000, v33
    v_lshrrev_b32 v47, 14, v28
    v_bitop3_b32 v47, v47, v5, v46 bitop3:0xea
    ds_read_b64 v[100:101], v47
    v_bitop3_b32 v92, v28, v5, v46 bitop3:0xea
    s_waitcnt lgkmcnt(2)
    v_mfma_f32_4x4x4_16b_bf16 v[80:83], v[10:11], v[70:71], v[80:83]
    v_mfma_f32_4x4x4_16b_bf16 v[76:79], v[10:11], v[68:69], v[76:79]
    v_perm_b32 v15, v29, v32, s45
    v_bitop3_b32 v46, v29, 0.5, -0.5 bitop3:0xa8
    v_perm_b32 v14, v28, v32, s44
    v_bitop3_b32 v47, v28, 0.5, -0.5 bitop3:0xa8
    v_cvt_pk_bf16_f32 v80, v80, v81
    v_cvt_pk_bf16_f32 v81, v82, v83
    ds_wrxchg_rtn_b64 v[74:75], v95, v[80:81] offset:65408
    v_cvt_pk_bf16_f32 v76, v76, v77
    v_cvt_pk_bf16_f32 v77, v78, v79
    ds_wrxchg_rtn_b64 v[72:73], v94, v[76:77] offset:65408
    s_waitcnt lgkmcnt(2)
    v_mfma_f32_4x4x4_16b_bf16 v[80:83], v[8:9], v[102:103], 0
    v_mfma_f32_4x4x4_16b_bf16 v[76:79], v[8:9], v[100:101], 0
    v_bitop3_b32 v15, v6, v15, v46 bitop3:0xca
    v_bitop3_b32 v14, v6, v14, v47 bitop3:0xca
    v_cmp_lt_u32 s[84:85], v5, v92
    s_nop 0
    v_pk_mul_f32 v[80:81], v[80:81], v[14:15] op_sel:[0,1] op_sel_hi:[1,1]
    v_pk_mul_f32 v[82:83], v[82:83], v[14:15] op_sel:[0,1] op_sel_hi:[1,1]
    v_pk_mul_f32 v[76:77], v[76:77], v[14:15] op_sel:[0,0] op_sel_hi:[1,0]
    v_pk_mul_f32 v[78:79], v[78:79], v[14:15] op_sel:[0,0] op_sel_hi:[1,0]
    s_waitcnt lgkmcnt(0)
    v_cmp_ne_u64 s[50:51], v[72:73], v[68:69]
    v_cmpx_ne_u64 s[54:55], v[74:75], v[70:71]
    s_and_b64 s[82:83], s[54:55], s[80:81]
    s_cbranch_scc1 L2_c39
L2_d39:
    v_mov_b64 v[84:85], v[70:71]
    v_mov_b32 v7, v95
    v_mov_b64 v[86:87], v[74:75]
    s_or_b64 s[80:81], s[80:81], s[54:55]
    s_mov_b64 exec, s[50:51]
    s_and_b64 s[82:83], s[50:51], s[80:81]
    s_cbranch_scc1 L2_c40
L2_d40:
    v_mov_b64 v[84:85], v[68:69]
    v_mov_b32 v7, v94
    v_mov_b64 v[86:87], v[72:73]
    s_mov_b64 exec, -1
    s_or_b64 s[80:81], s[80:81], s[50:51]
    ds_read_b64 v[70:71], v93 offset:65408
    s_and_b64 exec, s[84:85], s[80:81]
    v_mfma_f32_4x4x4_16b_bf16 v[76:79], v[12:13], v[84:85], 0
    v_mov_b32 v92, v7
    s_andn2_b64 s[80:81], s[80:81], s[84:85]
    v_mfma_f32_4x4x4_16b_bf16 v[76:79], v[10:11], v[86:87], v[76:79]
    s_mov_b64 exec, -1
    ds_read_b64 v[68:69], v92 offset:65408
    v_and_b32 v46, 0x80000000, v33
    v_lshrrev_b32 v47, 14, v31
    v_bitop3_b32 v47, v47, v5, v46 bitop3:0xea
    ds_read_b64 v[106:107], v47
    v_bitop3_b32 v95, v31, v5, v46 bitop3:0xea
    v_and_b32 v46, 0x40000000, v33
    v_lshrrev_b32 v47, 14, v30
    v_bitop3_b32 v47, v47, v5, v46 bitop3:0xea
    ds_read_b64 v[104:105], v47
    v_bitop3_b32 v94, v30, v5, v46 bitop3:0xea
    s_waitcnt lgkmcnt(2)
    v_mfma_f32_4x4x4_16b_bf16 v[80:83], v[10:11], v[70:71], v[80:83]
    v_mfma_f32_4x4x4_16b_bf16 v[76:79], v[10:11], v[68:69], v[76:79]
    v_perm_b32 v15, v31, v32, s47
    v_bitop3_b32 v46, v31, 0.5, -0.5 bitop3:0xa8
    v_perm_b32 v14, v30, v32, s46
    v_bitop3_b32 v47, v30, 0.5, -0.5 bitop3:0xa8
    v_cvt_pk_bf16_f32 v80, v80, v81
    v_cvt_pk_bf16_f32 v81, v82, v83
    ds_wrxchg_rtn_b64 v[74:75], v93, v[80:81] offset:65408
    v_cvt_pk_bf16_f32 v76, v76, v77
    v_cvt_pk_bf16_f32 v77, v78, v79
    ds_wrxchg_rtn_b64 v[72:73], v92, v[76:77] offset:65408
    s_setprio 0
    s_waitcnt lgkmcnt(2)
    v_mfma_f32_4x4x4_16b_bf16 v[80:83], v[8:9], v[106:107], 0
    v_mfma_f32_4x4x4_16b_bf16 v[76:79], v[8:9], v[104:105], 0
    v_bitop3_b32 v15, v6, v15, v46 bitop3:0xca
    v_bitop3_b32 v14, v6, v14, v47 bitop3:0xca
    s_nop 1
    v_pk_mul_f32 v[80:81], v[80:81], v[14:15] op_sel:[0,1] op_sel_hi:[1,1]
    v_pk_mul_f32 v[82:83], v[82:83], v[14:15] op_sel:[0,1] op_sel_hi:[1,1]
    v_pk_mul_f32 v[76:77], v[76:77], v[14:15] op_sel:[0,0] op_sel_hi:[1,0]
    v_pk_mul_f32 v[78:79], v[78:79], v[14:15] op_sel:[0,0] op_sel_hi:[1,0]
    s_add_u32 s40, s40, 0x50000
    v_and_b32 v47, 0x0fffffff, v42
    v_mov_b32 v33, v42
    buffer_load_dwordx2 v[28:29], v47, s[8:11], 0 offen
    buffer_load_dwordx3 v[30:32], v47, s[8:11], 0 offen offset:8
    s_waitcnt lgkmcnt(0)
    v_cmp_ne_u64 s[50:51], v[72:73], v[68:69]
    v_cmpx_ne_u64 s[54:55], v[74:75], v[70:71]
    s_and_b64 s[82:83], s[54:55], s[80:81]
    s_cbranch_scc1 L2_c41
L2_d41:
    v_mov_b64 v[84:85], v[70:71]
    v_mov_b32 v7, v93
    v_mov_b64 v[86:87], v[74:75]
    s_or_b64 s[80:81], s[80:81], s[54:55]
    s_mov_b64 exec, s[50:51]
    s_and_b64 s[82:83], s[50:51], s[80:81]
    s_cbranch_scc1 L2_c42
L2_d42:
    v_mov_b64 v[84:85], v[68:69]
    v_mov_b32 v7, v92
    v_mov_b64 v[86:87], v[72:73]
    s_mov_b64 exec, -1
    s_or_b64 s[80:81], s[80:81], s[50:51]
    ds_read_b64 v[70:71], v95 offset:65408
    ds_read_b64 v[68:69], v94 offset:65408
    s_waitcnt vmcnt(8)
    v_and_b32 v46, 0x20000000, v39
    v_lshrrev_b32 v47, 14, v35
    v_bitop3_b32 v47, v47, v5, v46 bitop3:0xea
    ds_read_b64 v[102:103], v47
    v_bitop3_b32 v93, v35, v5, v46 bitop3:0xea
    v_and_b32 v46, 0x10000000, v39
    v_lshrrev_b32 v47, 14, v34
    v_bitop3_b32 v47, v47, v5, v46 bitop3:0xea
    ds_read_b64 v[100:101], v47
    v_bitop3_b32 v92, v34, v5, v46 bitop3:0xea
    v_and_b32 v46, 0x80000000, v39
    v_lshrrev_b32 v47, 14, v37
    v_bitop3_b32 v47, v47, v5, v46 bitop3:0xea
    ds_read_b64 v[106:107], v47
    v_and_b32 v46, 0x40000000, v39
    v_lshrrev_b32 v47, 14, v36
    v_bitop3_b32 v47, v47, v5, v46 bitop3:0xea
    ds_read_b64 v[104:105], v47
    s_waitcnt lgkmcnt(4)
    v_mfma_f32_4x4x4_16b_bf16 v[80:83], v[10:11], v[70:71], v[80:83]
    v_mfma_f32_4x4x4_16b_bf16 v[76:79], v[10:11], v[68:69], v[76:79]
    v_perm_b32 v15, v35, v38, s45
    v_bitop3_b32 v46, v35, 0.5, -0.5 bitop3:0xa8
    v_perm_b32 v14, v34, v38, s44
    v_bitop3_b32 v47, v34, 0.5, -0.5 bitop3:0xa8
    v_cvt_pk_bf16_f32 v80, v80, v81
    v_cvt_pk_bf16_f32 v81, v82, v83
    ds_wrxchg_rtn_b64 v[74:75], v95, v[80:81] offset:65408
    v_cvt_pk_bf16_f32 v76, v76, v77
    v_cvt_pk_bf16_f32 v77, v78, v79
    ds_wrxchg_rtn_b64 v[72:73], v94, v[76:77] offset:65408
    s_waitcnt lgkmcnt(2)
    s_barrier
    s_setprio 3
    s_mov_b32 m0, s100
    s_nop 0
    ds_write_addtid_b32 v116 offset:32768
    ds_write_addtid_b32 v117 offset:33024
    ds_write_addtid_b32 v118 offset:33280
    ds_write_addtid_b32 v119 offset:33536
    buffer_load_dwordx4 v[116:119], v3, s[16:19], s40 offen offset:2048
    ds_write_addtid_b32 v120 offset:33792
    ds_write_addtid_b32 v121 offset:34048
    ds_write_addtid_b32 v122 offset:34304
    ds_write_addtid_b32 v123 offset:34560
    buffer_load_dwordx4 v[120:123], v3, s[16:19], s40 offen offset:3072
    v_mfma_f32_4x4x4_16b_bf16 v[80:83], v[8:9], v[102:103], 0
    v_mfma_f32_4x4x4_16b_bf16 v[76:79], v[8:9], v[100:101], 0
    v_bitop3_b32 v15, v6, v15, v46 bitop3:0xca
    v_bitop3_b32 v14, v6, v14, v47 bitop3:0xca
    v_cmp_lt_u32 s[84:85], v5, v92
    s_nop 0
    v_pk_mul_f32 v[80:81], v[80:81], v[14:15] op_sel:[0,1] op_sel_hi:[1,1]
    v_pk_mul_f32 v[82:83], v[82:83], v[14:15] op_sel:[0,1] op_sel_hi:[1,1]
    v_pk_mul_f32 v[76:77], v[76:77], v[14:15] op_sel:[0,0] op_sel_hi:[1,0]
    v_pk_mul_f32 v[78:79], v[78:79], v[14:15] op_sel:[0,0] op_sel_hi:[1,0]
    v_mov_b32 v44, v43
    s_cmp_gt_u32 s37, 1024
    s_cbranch_scc1 L2_xs43
    s_cmp_lg_u32 s101, 0
    s_cbranch_scc1 L2_xa43
L2_xb43:
    v_lshlrev_b32 v89, 16, v96
    v_add_u32 v90, 60, v97
    v_bitop3_b32 v90, v89, v45, v90 bitop3:0x6a
    ds_write_b32 v98, v90 offset:12
    v_lshlrev_b32 v89, 20, v96
    v_add_u32 v90, 40, v97
    v_bitop3_b32 v90, v89, v45, v90 bitop3:0x6a
    ds_write_b32 v98, v90 offset:8
    v_lshlrev_b32 v89, 24, v96
    v_add_u32 v90, 20, v97
    v_bitop3_b32 v90, v89, v45, v90 bitop3:0x6a
    ds_write_b32 v98, v90 offset:4
    v_lshlrev_b32 v89, 28, v96
    v_bitop3_b32 v90, v89, v45, v97 bitop3:0x6a
    ds_write_b32 v98, v90 offset:0
    v_mov_b32_dpp v91, v66 quad_perm:[1,1,1,1] row_mask:0xf bank_mask:0xf
    v_and_b32 v89, 3, v91
    v_and_b32 v97, 0xfffc, v91
    v_sub_u16_dpp v88, v66, v91 quad_perm:[3,3,3,3] row_mask:0xf bank_mask:0xf
    v_mad_u32_u24 v97, v97, 5, v4
    v_add_u32 v99, v88, v89
    v_bfm_b32 v96, v88, v89
    v_cmp_lt_u32 s[58:59], 16, v99
    v_lshlrev_b32 v89, v1, v96
    v_and_b32 v89, v45, v89
    v_cmp_ne_u32 vcc, 0, v89
    v_xor_b32 v90, v97, v89
    s_add_u32 s3, s37, s38
    v_mbcnt_lo_u32_b32 v98, vcc_lo, 0
    v_mbcnt_hi_u32_b32 v98, vcc_hi, v98
    s_bcnt1_i32_b64 s41, vcc
    v_lshl_add_u32 v98, v98, 2, s3
    s_mov_b64 exec, vcc
    ds_write_b32 v98, v90
    s_mov_b64 exec, -1
    s_lshl2_add_u32 s37, s41, s37
    s_cmp_lg_u64 s[58:59], 0
    s_cbranch_scc1 L2_xe43
L2_xr43:
    v_add_u32 v98, s37, v0
    v_mov_b32 v90, -1
    ds_write_b32 v98, v90
    ds_read2st64_b32 v[40:41], v0 offset0:0 offset1:1
    ds_read2st64_b32 v[42:43], v0 offset0:2 offset1:3
    s_sub_u32 s3, s37, 768
    s_cmp_gt_u32 s3, 256
    s_cbranch_scc1 L2_xf43
L2_xg43:
    v_lshrrev_b64 v[64:65], 16, v[64:65]
    v_lshrrev_b64 v[66:67], 16, v[66:67]
    s_setprio 2
    ds_write_addtid_b32 v124 offset:34816
    ds_write_addtid_b32 v125 offset:35072
    ds_write_addtid_b32 v126 offset:35328
    ds_write_addtid_b32 v127 offset:35584
    s_add_u32 s3, s40, 4096
    buffer_load_dwordx4 v[124:127], v3, s[16:19], s3 offen
    s_waitcnt lgkmcnt(14)
    v_cmp_ne_u64 s[50:51], v[72:73], v[68:69]
    v_cmpx_ne_u64 s[54:55], v[74:75], v[70:71]
    s_and_b64 s[82:83], s[54:55], s[80:81]
    s_cbranch_scc1 L2_c44
L2_d44:
    v_mov_b64 v[84:85], v[70:71]
    v_mov_b32 v7, v95
    v_mov_b64 v[86:87], v[74:75]
    s_or_b64 s[80:81], s[80:81], s[54:55]
    s_mov_b64 exec, s[50:51]
    s_and_b64 s[82:83], s[50:51], s[80:81]
    s_cbranch_scc1 L2_c45
L2_d45:
    v_mov_b64 v[84:85], v[68:69]
    v_mov_b32 v7, v94
    v_mov_b64 v[86:87], v[72:73]
    s_mov_b64 exec, -1
    s_or_b64 s[80:81], s[80:81], s[50:51]
    ds_read_b64 v[70:71], v93 offset:65408
    s_and_b64 exec, s[84:85], s[80:81]
    v_mfma_f32_4x4x4_16b_bf16 v[76:79], v[12:13], v[84:85], 0
    v_mov_b32 v92, v7
    s_andn2_b64 s[80:81], s[80:81], s[84:85]
    v_mfma_f32_4x4x4_16b_bf16 v[76:79], v[10:11], v[86:87], v[76:79]
    s_mov_b64 exec, -1
    ds_read_b64 v[68:69], v92 offset:65408
    s_setprio 1
    s_waitcnt vmcnt(10)
    s_mov_b32 m0, s38
    s_nop 0
    ds_write_addtid_b32 v108 offset:0
    ds_write_addtid_b32 v109 offset:256
    ds_write_addtid_b32 v110 offset:512
    ds_write_addtid_b32 v111 offset:768
    s_waitcnt lgkmcnt(4)
    v_mfma_f32_4x4x4_16b_bf16 v[80:83], v[10:11], v[70:71], v[80:83]
    v_mfma_f32_4x4x4_16b_bf16 v[76:79], v[10:11], v[68:69], v[76:79]
    v_and_b32 v46, 0x40000000, v39
    v_bitop3_b32 v94, v36, v5, v46 bitop3:0xea
    v_and_b32 v46, 0x80000000, v39
    v_bitop3_b32 v95, v37, v5, v46 bitop3:0xea
    v_perm_b32 v15, v37, v38, s47
    v_bitop3_b32 v46, v37, 0.5, -0.5 bitop3:0xa8
    v_perm_b32 v14, v36, v38, s46
    v_bitop3_b32 v47, v36, 0.5, -0.5 bitop3:0xa8
    v_cvt_pk_bf16_f32 v80, v80, v81
    v_cvt_pk_bf16_f32 v81, v82, v83
    ds_wrxchg_rtn_b64 v[74:75], v93, v[80:81] offset:65408
    v_cvt_pk_bf16_f32 v76, v76, v77
    v_cvt_pk_bf16_f32 v77, v78, v79
    ds_wrxchg_rtn_b64 v[72:73], v92, v[76:77] offset:65408
    v_and_b32 v88, 0x0fffffff, v44
    v_mov_b32 v39, v44
    buffer_load_dwordx2 v[34:35], v88, s[8:11], 0 offen
    buffer_load_dwordx3 v[36:38], v88, s[8:11], 0 offen offset:8
    s_setprio 0
    s_waitcnt vmcnt(11)
    ds_write_addtid_b32 v112 offset:1024
    ds_write_addtid_b32 v113 offset:1280
    ds_write_addtid_b32 v114 offset:1536
    ds_write_addtid_b32 v115 offset:1792
    v_mfma_f32_4x4x4_16b_bf16 v[80:83], v[8:9], v[106:107], 0
    v_mfma_f32_4x4x4_16b_bf16 v[76:79], v[8:9], v[104:105], 0
    v_bitop3_b32 v15, v6, v15, v46 bitop3:0xca
    v_bitop3_b32 v14, v6, v14, v47 bitop3:0xca
    s_nop 1
    v_pk_mul_f32 v[80:81], v[80:81], v[14:15] op_sel:[0,1] op_sel_hi:[1,1]
    v_pk_mul_f32 v[82:83], v[82:83], v[14:15] op_sel:[0,1] op_sel_hi:[1,1]
    v_pk_mul_f32 v[76:77], v[76:77], v[14:15] op_sel:[0,0] op_sel_hi:[1,0]
    v_pk_mul_f32 v[78:79], v[78:79], v[14:15] op_sel:[0,0] op_sel_hi:[1,0]
    s_add_u32 s42, s42, 1
    s_waitcnt lgkmcnt(0)
L2_loop:
    s_barrier
    s_bitcmp1_b32 s36, s42
    s_cbranch_scc1 L2_slow
L2_ret2:
    s_setprio 3
    buffer_load_dwordx4 v[108:111], v3, s[16:19], s40 offen offset:0
    v_cmp_ne_u64 s[50:51], v[72:73], v[68:69]
    v_cmpx_ne_u64 s[54:55], v[74:75], v[70:71]
    s_and_b64 s[82:83], s[54:55], s[80:81]
    s_cbranch_scc1 L2_c46
L2_d46:
    v_mov_b64 v[84:85], v[70:71]
    v_mov_b32 v7, v93
    v_mov_b64 v[86:87], v[74:75]
    s_or_b64 s[80:81], s[80:81], s[54:55]
    s_mov_b64 exec, s[50:51]
    s_and_b64 s[82:83], s[50:51], s[80:81]
    s_cbranch_scc1 L2_c47
L2_d47:
    v_mov_b64 v[84:85], v[68:69]
    v_mov_b32 v7, v92
    v_mov_b64 v[86:87], v[72:73]
    s_mov_b64 exec, -1
    s_or_b64 s[80:81], s[80:81], s[50:51]
    ds_read_b64 v[70:71], v95 offset:65408
    ds_read_b64 v[68:69], v94 offset:65408
    s_waitcnt vmcnt(10)
    v_and_b32 v46, 0x20000000, v21
    v_lshrrev_b32 v47, 14, v17
    v_bitop3_b32 v47, v47, v5, v46 bitop3:0xea
    ds_read_b64 v[102:103], v47
    v_bitop3_b32 v93, v17, v5, v46 bitop3:0xea
    v_and_b32 v46, 0x10000000, v21
    v_lshrrev_b32 v47, 14, v16
    v_bitop3_b32 v47, v47, v5, v46 bitop3:0xea
    ds_read_b64 v[100:101], v47
    v_bitop3_b32 v92, v16, v5, v46 bitop3:0xea
    s_waitcnt lgkmcnt(2)
    v_mfma_f32_4x4x4_16b_bf16 v[80:83], v[10:11], v[70:71], v[80:83]
    v_mfma_f32_4x4x4_16b_bf16 v[76:79], v[10:11], v[68:69], v[76:79]
    v_perm_b32 v15, v17, v20, s45
    v_bitop3_b32 v46, v17, 0.5, -0.5 bitop3:0xa8
    v_perm_b32 v14, v16, v20, s44
    v_bitop3_b32 v47, v16, 0.5, -0.5 bitop3:0xa8
    v_cvt_pk_bf16_f32 v80, v80, v81
    v_cvt_pk_bf16_f32 v81, v82, v83
    ds_wrxchg_rtn_b64 v[74:75], v95, v[80:81] offset:65408
    v_cvt_pk_bf16_f32 v76, v76, v77
    v_cvt_pk_bf16_f32 v77, v78, v79
    ds_wrxchg_rtn_b64 v[72:73], v94, v[76:77] offset:65408
    s_waitcnt lgkmcnt(2)
    v_mfma_f32_4x4x4_16b_bf16 v[80:83], v[8:9], v[102:103], 0
    v_mfma_f32_4x4x4_16b_bf16 v[76:79], v[8:9], v[100:101], 0
    v_bitop3_b32 v15, v6, v15, v46 bitop3:0xca
    v_bitop3_b32 v14, v6, v14, v47 bitop3:0xca
    v_cmp_lt_u32 s[84:85], v5, v92
    s_nop 0
    v_pk_mul_f32 v[80:81], v[80:81], v[14:15] op_sel:[0,1] op_sel_hi:[1,1]
    v_pk_mul_f32 v[82:83], v[82:83], v[14:15] op_sel:[0,1] op_sel_hi:[1,1]
    v_pk_mul_f32 v[76:77], v[76:77], v[14:15] op_sel:[0,0] op_sel_hi:[1,0]
    v_pk_mul_f32 v[78:79], v[78:79], v[14:15] op_sel:[0,0] op_sel_hi:[1,0]
    buffer_load_dwordx4 v[112:115], v3, s[16:19], s40 offen offset:1024
    s_waitcnt lgkmcnt(0)
    v_cmp_ne_u64 s[50:51], v[72:73], v[68:69]
    v_cmpx_ne_u64 s[54:55], v[74:75], v[70:71]
    s_and_b64 s[82:83], s[54:55], s[80:81]
    s_cbranch_scc1 L2_c48
L2_d48:
    v_mov_b64 v[84:85], v[70:71]
    v_mov_b32 v7, v95
    v_mov_b64 v[86:87], v[74:75]
    s_or_b64 s[80:81], s[80:81], s[54:55]
    s_mov_b64 exec, s[50:51]
    s_and_b64 s[82:83], s[50:51], s[80:81]
    s_cbranch_scc1 L2_c49
L2_d49:
    v_mov_b64 v[84:85], v[68:69]
    v_mov_b32 v7, v94
    v_mov_b64 v[86:87], v[72:73]
    s_mov_b64 exec, -1
    s_or_b64 s[80:81], s[80:81], s[50:51]
    ds_read_b64 v[70:71], v93 offset:65408
    s_and_b64 exec, s[84:85], s[80:81]
    v_mfma_f32_4x4x4_16b_bf16 v[76:79], v[12:13], v[84:85], 0
    v_mov_b32 v92, v7
    s_andn2_b64 s[80:81], s[80:81], s[84:85]
    v_mfma_f32_4x4x4_16b_bf16 v[76:79], v[10:11], v[86:87], v[76:79]
    s_mov_b64 exec, -1
    ds_read_b64 v[68:69], v92 offset:65408
    v_and_b32 v46, 0x80000000, v21
    v_lshrrev_b32 v47, 14, v19
    v_bitop3_b32 v47, v47, v5, v46 bitop3:0xea
    ds_read_b64 v[106:107], v47
    v_bitop3_b32 v95, v19, v5, v46 bitop3:0xea
    v_and_b32 v46, 0x40000000, v21
    v_lshrrev_b32 v47, 14, v18
    v_bitop3_b32 v47, v47, v5, v46 bitop3:0xea
    ds_read_b64 v[104:105], v47
    v_bitop3_b32 v94, v18, v5, v46 bitop3:0xea
    s_waitcnt lgkmcnt(2)
    v_mfma_f32_4x4x4_16b_bf16 v[80:83], v[10:11], v[70:71], v[80:83]
    v_mfma_f32_4x4x4_16b_bf16 v[76:79], v[10:11], v[68:69], v[76:79]
    v_perm_b32 v15, v19, v20, s47
    v_bitop3_b32 v46, v19, 0.5, -0.5 bitop3:0xa8
    v_perm_b32 v14, v18, v20, s46
    v_bitop3_b32 v47, v18, 0.5, -0.5 bitop3:0xa8
    v_cvt_pk_bf16_f32 v80, v80, v81
    v_cvt_pk_bf16_f32 v81, v82, v83
    ds_wrxchg_rtn_b64 v[74:75], v93, v[80:81] offset:65408
    v_cvt_pk_bf16_f32 v76, v76, v77
    v_cvt_pk_bf16_f32 v77, v78, v79
    ds_wrxchg_rtn_b64 v[72:73], v92, v[76:77] offset:65408
    v_and_b32 v88, 0x0fffffff, v40
    v_mov_b32 v21, v40
    buffer_load_dwordx2 v[16:17], v88, s[8:11], 0 offen
    buffer_load_dwordx3 v[18:20], v88, s[8:11], 0 offen offset:8
    s_setprio 2
    s_waitcnt lgkmcnt(2)
    v_mfma_f32_4x4x4_16b_bf16 v[80:83], v[8:9], v[106:107], 0
    v_mfma_f32_4x4x4_16b_bf16 v[76:79], v[8:9], v[104:105], 0
    v_bitop3_b32 v15, v6, v15, v46 bitop3:0xca
    v_bitop3_b32 v14, v6, v14, v47 bitop3:0xca
    s_nop 1
    v_pk_mul_f32 v[80:81], v[80:81], v[14:15] op_sel:[0,1] op_sel_hi:[1,1]
    v_pk_mul_f32 v[82:83], v[82:83], v[14:15] op_sel:[0,1] op_sel_hi:[1,1]
    v_pk_mul_f32 v[76:77], v[76:77], v[14:15] op_sel:[0,0] op_sel_hi:[1,0]
    v_pk_mul_f32 v[78:79], v[78:79], v[14:15] op_sel:[0,0] op_sel_hi:[1,0]
    v_sub_u16 v88, v56, v48
    v_and_b32 v89, 3, v48
    v_add3_u32 v99, v88, v89, 3
    v_and_b32 v99, -4, v99
    v_max_u32 v99, 4, v99
    v_and_b32 v97, 0xfffc, v48
    v_bfm_b32 v96, v88, v89
    v_add_u32_dpp v91, v99, v99 row_shr:1 row_mask:0xf bank_mask:0xf bound_ctrl:1
    v_mad_u32_u24 v97, v97, 5, v2
    v_cmp_lt_u32 vcc, 16, v99
    v_add_u32_dpp v91, v91, v91 row_shr:2 row_mask:0xf bank_mask:0xf bound_ctrl:1
    v_sub_u32 v98, s38, v99
    v_lshrrev_b64 v[48:49], 16, v[48:49]
    v_add_u32_dpp v91, v91, v91 row_shr:4 row_mask:0xf bank_mask:0xf bound_ctrl:1
    v_lshrrev_b64 v[56:57], 16, v[56:57]
    s_mov_b32 s101, 0
    v_add_u32_dpp v91, v91, v91 row_shr:8 row_mask:0xf bank_mask:0xf bound_ctrl:1
    s_nop 1
    v_add_u32_dpp v91, v91, v91 row_bcast:15 row_mask:0xa bank_mask:0xf
    s_nop 1
    v_add_u32_dpp v91, v91, v91 row_bcast:31 row_mask:0xc bank_mask:0xf
    v_add_u32 v98, v98, v91
    v_readlane_b32 s37, v91, 63
    s_cbranch_vccnz L2_xo50
L2_xp50:
    s_waitcnt lgkmcnt(0)
    v_cmp_ne_u64 s[50:51], v[72:73], v[68:69]
    v_cmpx_ne_u64 s[54:55], v[74:75], v[70:71]
    s_and_b64 s[82:83], s[54:55], s[80:81]
    s_cbranch_scc1 L2_c51
L2_d51:
    v_mov_b64 v[84:85], v[70:71]
    v_mov_b32 v7, v93
    v_mov_b64 v[86:87], v[74:75]
    s_or_b64 s[80:81], s[80:81], s[54:55]
    s_mov_b64 exec, s[50:51]
    s_and_b64 s[82:83], s[50:51], s[80:81]
    s_cbranch_scc1 L2_c52
L2_d52:
    v_mov_b64 v[84:85], v[68:69]
    v_mov_b32 v7, v92
    v_mov_b64 v[86:87], v[72:73]
    s_mov_b64 exec, -1
    s_or_b64 s[80:81], s[80:81], s[50:51]
    ds_read_b64 v[70:71], v95 offset:65408
    ds_read_b64 v[68:69], v94 offset:65408
    s_waitcnt vmcnt(11)
    v_and_b32 v46, 0x20000000, v27
    v_lshrrev_b32 v47, 14, v23
    v_bitop3_b32 v47, v47, v5, v46 bitop3:0xea
    ds_read_b64 v[102:103], v47
    v_bitop3_b32 v93, v23, v5, v46 bitop3:0xea
    v_and_b32 v46, 0x10000000, v27
    v_lshrrev_b32 v47, 14, v22
    v_bitop3_b32 v47, v47, v5, v46 bitop3:0xea
    ds_read_b64 v[100:101], v47
    v_bitop3_b32 v92, v22, v5, v46 bitop3:0xea
    s_waitcnt lgkmcnt(2)
    v_mfma_f32_4x4x4_16b_bf16 v[80:83], v[10:11], v[70:71], v[80:83]
    v_mfma_f32_4x4x4_16b_bf16 v[76:79], v[10:11], v[68:69], v[76:79]
    v_perm_b32 v15, v23, v26, s45
    v_bitop3_b32 v46, v23, 0.5, -0.5 bitop3:0xa8
    v_perm_b32 v14, v22, v26, s44
    v_bitop3_b32 v47, v22, 0.5, -0.5 bitop3:0xa8
    v_cvt_pk_bf16_f32 v80, v80, v81
    v_cvt_pk_bf16_f32 v81, v82, v83
    ds_wrxchg_rtn_b64 v[74:75], v95, v[80:81] offset:65408
    v_cvt_pk_bf16_f32 v76, v76, v77
    v_cvt_pk_bf16_f32 v77, v78, v79
    ds_wrxchg_rtn_b64 v[72:73], v94, v[76:77] offset:65408
    s_waitcnt lgkmcnt(2)
    v_mfma_f32_4x4x4_16b_bf16 v[80:83], v[8:9], v[102:103], 0
    v_mfma_f32_4x4x4_16b_bf16 v[76:79], v[8:9], v[100:101], 0
    v_bitop3_b32 v15, v6, v15, v46 bitop3:0xca
    v_bitop3_b32 v14, v6, v14, v47 bitop3:0xca
    v_cmp_lt_u32 s[84:85], v5, v92
    s_nop 0
    v_pk_mul_f32 v[80:81], v[80:81], v[14:15] op_sel:[0,1] op_sel_hi:[1,1]
    v_pk_mul_f32 v[82:83], v[82:83], v[14:15] op_sel:[0,1] op_sel_hi:[1,1]
    v_pk_mul_f32 v[76:77], v[76:77], v[14:15] op_sel:[0,0] op_sel_hi:[1,0]
    v_pk_mul_f32 v[78:79], v[78:79], v[14:15] op_sel:[0,0] op_sel_hi:[1,0]
    s_waitcnt lgkmcnt(0)
    v_cmp_ne_u64 s[50:51], v[72:73], v[68:69]
    v_cmpx_ne_u64 s[54:55], v[74:75], v[70:71]
    s_and_b64 s[82:83], s[54:55], s[80:81]
    s_cbranch_scc1 L2_c53
L2_d53:
    v_mov_b64 v[84:85], v[70:71]
    v_mov_b32 v7, v95
    v_mov_b64 v[86:87], v[74:75]
    s_or_b64 s[80:81], s[80:81], s[54:55]
    s_mov_b64 exec, s[50:51]
    s_and_b64 s[82:83], s[50:51], s[80:81]
    s_cbranch_scc1 L2_c54
L2_d54:
    v_mov_b64 v[84:85], v[68:69]
    v_mov_b32 v7, v94
    v_mov_b64 v[86:87], v[72:73]
    s_mov_b64 exec, -1
    s_or_b64 s[80:81], s[80:81], s[50:51]
    ds_read_b64 v[70:71], v93 offset:65408
    s_and_b64 exec, s[84:85], s[80:81]
    v_mfma_f32_4x4x4_16b_bf16 v[76:79], v[12:13], v[84:85], 0
    v_mov_b32 v92, v7
    s_andn2_b64 s[80:81], s[80:81], s[84:85]
    v_mfma_f32_4x4x4_16b_bf16 v[76:79], v[10:11], v[86:87], v[76:79]
    s_mov_b64 exec, -1
    ds_read_b64 v[68:69], v92 offset:65408
    v_and_b32 v46, 0x80000000, v27
    v_lshrrev_b32 v47, 14, v25
    v_bitop3_b32 v47, v47, v5, v46 bitop3:0xea
    ds_read_b64 v[106:107], v47
    v_bitop3_b32 v95, v25, v5, v46 bitop3:0xea
    v_and_b32 v46, 0x40000000, v27
    v_lshrrev_b32 v47, 14, v24
    v_bitop3_b32 v47, v47, v5, v46 bitop3:0xea
    ds_read_b64 v[104:105], v47
    v_bitop3_b32 v94, v24, v5, v46 bitop3:0xea
    s_waitcnt lgkmcnt(2)
    v_mfma_f32_4x4x4_16b_bf16 v[80:83], v[10:11], v[70:71], v[80:83]
    v_mfma_f32_4x4x4_16b_bf16 v[76:79], v[10:11], v[68:69], v[76:79]
    v_perm_b32 v15, v25, v26, s47
    v_bitop3_b32 v46, v25, 0.5, -0.5 bitop3:0xa8
    v_perm_b32 v14, v24, v26, s46
    v_bitop3_b32 v47, v24, 0.5, -0.5 bitop3:0xa8
    v_cvt_pk_bf16_f32 v80, v80, v81
    v_cvt_pk_bf16_f32 v81, v82, v83
    ds_wrxchg_rtn_b64 v[74:75], v93, v[80:81] offset:65408
    v_cvt_pk_bf16_f32 v76, v76, v77
    v_cvt_pk_bf16_f32 v77, v78, v79
    ds_wrxchg_rtn_b64 v[72:73], v92, v[76:77] offset:65408
    v_and_b32 v88, 0x0fffffff, v41
    v_mov_b32 v27, v41
    buffer_load_dwordx2 v[22:23], v88, s[8:11], 0 offen
    buffer_load_dwordx3 v[24:26], v88, s[8:11], 0 offen offset:8
    s_setprio 1
    s_waitcnt lgkmcnt(2)
    v_mfma_f32_4x4x4_16b_bf16 v[80:83], v[8:9], v[106:107], 0
    v_mfma_f32_4x4x4_16b_bf16 v[76:79], v[8:9], v[104:105], 0
    v_bitop3_b32 v15, v6, v15, v46 bitop3:0xca
    v_bitop3_b32 v14, v6, v14, v47 bitop3:0xca
    s_nop 1
    v_pk_mul_f32 v[80:81], v[80:81], v[14:15] op_sel:[0,1] op_sel_hi:[1,1]
    v_pk_mul_f32 v[82:83], v[82:83], v[14:15] op_sel:[0,1] op_sel_hi:[1,1]
    v_pk_mul_f32 v[76:77], v[76:77], v[14:15] op_sel:[0,0] op_sel_hi:[1,0]
    v_pk_mul_f32 v[78:79], v[78:79], v[14:15] op_sel:[0,0] op_sel_hi:[1,0]
    s_waitcnt lgkmcnt(0)
    v_cmp_ne_u64 s[50:51], v[72:73], v[68:69]
    v_cmpx_ne_u64 s[54:55], v[74:75], v[70:71]
    s_and_b64 s[82:83], s[54:55], s[80:81]
    s_cbranch_scc1 L2_c55
L2_d55:
    v_mov_b64 v[84:85], v[70:71]
    v_mov_b32 v7, v93
    v_mov_b64 v[86:87], v[74:75]
    s_or_b64 s[80:81], s[80:81], s[54:55]
    s_mov_b64 exec, s[50:51]
    s_and_b64 s[82:83], s[50:51], s[80:81]
    s_cbranch_scc1 L2_c56
L2_d56:
    v_mov_b64 v[84:85], v[68:69]
    v_mov_b32 v7, v92
    v_mov_b64 v[86:87], v[72:73]
    s_mov_b64 exec, -1
    s_or_b64 s[80:81], s[80:81], s[50:51]
    ds_read_b64 v[70:71], v95 offset:65408
    ds_read_b64 v[68:69], v94 offset:65408
    s_waitcnt vmcnt(11)
    v_and_b32 v46, 0x20000000, v33
    v_lshrrev_b32 v47, 14, v29
    v_bitop3_b32 v47, v47, v5, v46 bitop3:0xea
    ds_read_b64 v[102:103], v47
    v_bitop3_b32 v93, v29, v5, v46 bitop3:0xea
    v_and_b32 v46, 0x10000000, v33
    v_lshrrev_b32 v47, 14, v28
    v_bitop3_b32 v47, v47, v5, v46 bitop3:0xea
    ds_read_b64 v[100:101], v47
    v_bitop3_b32 v92, v28, v5, v46 bitop3:0xea
    s_waitcnt lgkmcnt(2)
    v_mfma_f32_4x4x4_16b_bf16 v[80:83], v[10:11], v[70:71], v[80:83]
    v_mfma_f32_4x4x4_16b_bf16 v[76:79], v[10:11], v[68:69], v[76:79]
    v_perm_b32 v15, v29, v32, s45
    v_bitop3_b32 v46, v29, 0.5, -0.5 bitop3:0xa8
    v_perm_b32 v14, v28, v32, s44
    v_bitop3_b32 v47, v28, 0.5, -0.5 bitop3:0xa8
    v_cvt_pk_bf16_f32 v80, v80, v81
    v_cvt_pk_bf16_f32 v81, v82, v83
    ds_wrxchg_rtn_b64 v[74:75], v95, v[80:81] offset:65408
    v_cvt_pk_bf16_f32 v76, v76, v77
    v_cvt_pk_bf16_f32 v77, v78, v79
    ds_wrxchg_rtn_b64 v[72:73], v94, v[76:77] offset:65408
    s_waitcnt lgkmcnt(2)
    v_mfma_f32_4x4x4_16b_bf16 v[80:83], v[8:9], v[102:103], 0
    v_mfma_f32_4x4x4_16b_bf16 v[76:79], v[8:9], v[100:101], 0
    v_bitop3_b32 v15, v6, v15, v46 bitop3:0xca
    v_bitop3_b32 v14, v6, v14, v47 bitop3:0xca
    v_cmp_lt_u32 s[84:85], v5, v92
    s_nop 0
    v_pk_mul_f32 v[80:81], v[80:81], v[14:15] op_sel:[0,1] op_sel_hi:[1,1]
    v_pk_mul_f32 v[82:83], v[82:83], v[14:15] op_sel:[0,1] op_sel_hi:[1,1]
    v_pk_mul_f32 v[76:77], v[76:77], v[14:15] op_sel:[0,0] op_sel_hi:[1,0]
    v_pk_mul_f32 v[78:79], v[78:79], v[14:15] op_sel:[0,0] op_sel_hi:[1,0]
    s_waitcnt lgkmcnt(0)
    v_cmp_ne_u64 s[50:51], v[72:73], v[68:69]
    v_cmpx_ne_u64 s[54:55], v[74:75], v[70:71]
    s_and_b64 s[82:83], s[54:55], s[80:81]
    s_cbranch_scc1 L2_c57
L2_d57:
    v_mov_b64 v[84:85], v[70:71]
    v_mov_b32 v7, v95
    v_mov_b64 v[86:87], v[74:75]
    s_or_b64 s[80:81], s[80:81], s[54:55]
    s_mov_b64 exec, s[50:51]
    s_and_b64 s[82:83], s[50:51], s[80:81]
    s_cbranch_scc1 L2_c58
L2_d58:
    v_mov_b64 v[84:85], v[68:69]
    v_mov_b32 v7, v94
    v_mov_b64 v[86:87], v[72:73]
    s_mov_b64 exec, -1
    s_or_b64 s[80:81], s[80:81], s[50:51]
    ds_read_b64 v[70:71], v93 offset:65408
    s_and_b64 exec, s[84:85], s[80:81]
    v_mfma_f32_4x4x4_16b_bf16 v[76:79], v[12:13], v[84:85], 0
    v_mov_b32 v92, v7
    s_andn2_b64 s[80:81], s[80:81], s[84:85]
    v_mfma_f32_4x4x4_16b_bf16 v[76:79], v[10:11], v[86:87], v[76:79]
    s_mov_b64 exec, -1
    ds_read_b64 v[68:69], v92 offset:65408
    v_and_b32 v46, 0x80000000, v33
    v_lshrrev_b32 v47, 14, v31
    v_bitop3_b32 v47, v47, v5, v46 bitop3:0xea
    ds_read_b64 v[106:107], v47
    v_bitop3_b32 v95, v31, v5, v46 bitop3:0xea
    v_and_b32 v46, 0x40000000, v33
    v_lshrrev_b32 v47, 14, v30
    v_bitop3_b32 v47, v47, v5, v46 bitop3:0xea
    ds_read_b64 v[104:105], v47
    v_bitop3_b32 v94, v30, v5, v46 bitop3:0xea
    s_waitcnt lgkmcnt(2)
    v_mfma_f32_4x4x4_16b_bf16 v[80:83], v[10:11], v[70:71], v[80:83]
    v_mfma_f32_4x4x4_16b_bf16 v[76:79], v[10:11], v[68:69], v[76:79]
    v_perm_b32 v15, v31, v32, s47
    v_bitop3_b32 v46, v31, 0.5, -0.5 bitop3:0xa8
    v_perm_b32 v14, v30, v32, s46
    v_bitop3_b32 v47, v30, 0.5, -0.5 bitop3:0xa8
    v_cvt_pk_bf16_f32 v80, v80, v81
    v_cvt_pk_bf16_f32 v81, v82, v83
    ds_wrxchg_rtn_b64 v[74:75], v93, v[80:81] offset:65408
    v_cvt_pk_bf16_f32 v76, v76, v77
    v_cvt_pk_bf16_f32 v77, v78, v79
    ds_wrxchg_rtn_b64 v[72:73], v92, v[76:77] offset:65408
    v_and_b32 v88, 0x0fffffff, v42
    v_mov_b32 v33, v42
    buffer_load_dwordx2 v[28:29], v88, s[8:11], 0 offen
    buffer_load_dwordx3 v[30:32], v88, s[8:11], 0 offen offset:8
    s_setprio 0
    s_waitcnt lgkmcnt(2)
    v_mfma_f32_4x4x4_16b_bf16 v[80:83], v[8:9], v[106:107], 0
    v_mfma_f32_4x4x4_16b_bf16 v[76:79], v[8:9], v[104:105], 0
    v_bitop3_b32 v15, v6, v15, v46 bitop3:0xca
    v_bitop3_b32 v14, v6, v14, v47 bitop3:0xca
    s_nop 1
    v_pk_mul_f32 v[80:81], v[80:81], v[14:15] op_sel:[0,1] op_sel_hi:[1,1]
    v_pk_mul_f32 v[82:83], v[82:83], v[14:15] op_sel:[0,1] op_sel_hi:[1,1]
    v_pk_mul_f32 v[76:77], v[76:77], v[14:15] op_sel:[0,0] op_sel_hi:[1,0]
    v_pk_mul_f32 v[78:79], v[78:79], v[14:15] op_sel:[0,0] op_sel_hi:[1,0]
    s_add_u32 s40, s40, 0xfff24000
    s_waitcnt lgkmcnt(0)
    v_cmp_ne_u64 s[50:51], v[72:73], v[68:69]
    v_cmpx_ne_u64 s[54:55], v[74:75], v[70:71]
    s_and_b64 s[82:83], s[54:55], s[80:81]
    s_cbranch_scc1 L2_c59
L2_d59:
    v_mov_b64 v[84:85], v[70:71]
    v_mov_b32 v7, v93
    v_mov_b64 v[86:87], v[74:75]
    s_or_b64 s[80:81], s[80:81], s[54:55]
    s_mov_b64 exec, s[50:51]
    s_and_b64 s[82:83], s[50:51], s[80:81]
    s_cbranch_scc1 L2_c60
L2_d60:
    v_mov_b64 v[84:85], v[68:69]
    v_mov_b32 v7, v92
    v_mov_b64 v[86:87], v[72:73]
    s_mov_b64 exec, -1
    s_or_b64 s[80:81], s[80:81], s[50:51]
    ds_read_b64 v[70:71], v95 offset:65408
    ds_read_b64 v[68:69], v94 offset:65408
    s_waitcnt vmcnt(8)
    v_and_b32 v46, 0x20000000, v39
    v_lshrrev_b32 v47, 14, v35
    v_bitop3_b32 v47, v47, v5, v46 bitop3:0xea
    ds_read_b64 v[102:103], v47
    v_bitop3_b32 v93, v35, v5, v46 bitop3:0xea
    v_and_b32 v46, 0x10000000, v39
    v_lshrrev_b32 v47, 14, v34
    v_bitop3_b32 v47, v47, v5, v46 bitop3:0xea
    ds_read_b64 v[100:101], v47
    v_bitop3_b32 v92, v34, v5, v46 bitop3:0xea
    v_and_b32 v46, 0x80000000, v39
    v_lshrrev_b32 v47, 14, v37
    v_bitop3_b32 v47, v47, v5, v46 bitop3:0xea
    ds_read_b64 v[106:107], v47
    v_and_b32 v46, 0x40000000, v39
    v_lshrrev_b32 v47, 14, v36
    v_bitop3_b32 v47, v47, v5, v46 bitop3:0xea
    ds_read_b64 v[104:105], v47
    s_waitcnt lgkmcnt(4)
    v_mfma_f32_4x4x4_16b_bf16 v[80:83], v[10:11], v[70:71], v[80:83]
    v_mfma_f32_4x4x4_16b_bf16 v[76:79], v[10:11], v[68:69], v[76:79]
    v_perm_b32 v15, v35, v38, s45
    v_bitop3_b32 v46, v35, 0.5, -0.5 bitop3:0xa8
    v_perm_b32 v14, v34, v38, s44
    v_bitop3_b32 v47, v34, 0.5, -0.5 bitop3:0xa8
    v_cvt_pk_bf16_f32 v80, v80, v81
    v_cvt_pk_bf16_f32 v81, v82, v83
    ds_wrxchg_rtn_b64 v[74:75], v95, v[80:81] offset:65408
    v_cvt_pk_bf16_f32 v76, v76, v77
    v_cvt_pk_bf16_f32 v77, v78, v79
    ds_wrxchg_rtn_b64 v[72:73], v94, v[76:77] offset:65408
    s_waitcnt lgkmcnt(2)
    s_barrier
    s_setprio 3
    s_mov_b32 m0, s100
    s_nop 0
    ds_write_addtid_b32 v116 offset:32768
    ds_write_addtid_b32 v117 offset:33024
    ds_write_addtid_b32 v118 offset:33280
    ds_write_addtid_b32 v119 offset:33536
    buffer_load_dwordx4 v[116:119], v3, s[16:19], s40 offen offset:2048
    ds_write_addtid_b32 v120 offset:33792
    ds_write_addtid_b32 v121 offset:34048
    ds_write_addtid_b32 v122 offset:34304
    ds_write_addtid_b32 v123 offset:34560
    buffer_load_dwordx4 v[120:123], v3, s[16:19], s40 offen offset:3072
    v_mfma_f32_4x4x4_16b_bf16 v[80:83], v[8:9], v[102:103], 0
    v_mfma_f32_4x4x4_16b_bf16 v[76:79], v[8:9], v[100:101], 0
    v_bitop3_b32 v15, v6, v15, v46 bitop3:0xca
    v_bitop3_b32 v14, v6, v14, v47 bitop3:0xca
    v_cmp_lt_u32 s[84:85], v5, v92
    s_nop 0
    v_pk_mul_f32 v[80:81], v[80:81], v[14:15] op_sel:[0,1] op_sel_hi:[1,1]
    v_pk_mul_f32 v[82:83], v[82:83], v[14:15] op_sel:[0,1] op_sel_hi:[1,1]
    v_pk_mul_f32 v[76:77], v[76:77], v[14:15] op_sel:[0,0] op_sel_hi:[1,0]
    v_pk_mul_f32 v[78:79], v[78:79], v[14:15] op_sel:[0,0] op_sel_hi:[1,0]
    v_mov_b32 v44, v43
    s_cmp_gt_u32 s37, 1024
    s_cbranch_scc1 L2_xs61
    s_cmp_lg_u32 s101, 0
    s_cbranch_scc1 L2_xa61
L2_xb61:
    v_lshlrev_b32 v89, 16, v96
    v_add_u32 v90, 60, v97
    v_bitop3_b32 v90, v89, v45, v90 bitop3:0x6a
    ds_write_b32 v98, v90 offset:12
    v_lshlrev_b32 v89, 20, v96
    v_add_u32 v90, 40, v97
    v_bitop3_b32 v90, v89, v45, v90 bitop3:0x6a
    ds_write_b32 v98, v90 offset:8
    v_lshlrev_b32 v89, 24, v96
    v_add_u32 v90, 20, v97
    v_bitop3_b32 v90, v89, v45, v90 bitop3:0x6a
    ds_write_b32 v98, v90 offset:4
    v_lshlrev_b32 v89, 28, v96
    v_bitop3_b32 v90, v89, v45, v97 bitop3:0x6a
    ds_write_b32 v98, v90 offset:0
    v_mov_b32_dpp v91, v64 quad_perm:[0,0,0,0] row_mask:0xf bank_mask:0xf
    v_and_b32 v89, 3, v91
    v_and_b32 v97, 0xfffc, v91
    v_sub_u16_dpp v88, v64, v91 quad_perm:[2,2,2,2] row_mask:0xf bank_mask:0xf
    v_mad_u32_u24 v97, v97, 5, v4
    v_add_u32 v99, v88, v89
    v_bfm_b32 v96, v88, v89
    v_cmp_lt_u32 s[58:59], 16, v99
    v_lshlrev_b32 v89, v1, v96
    v_and_b32 v89, v45, v89
    v_cmp_ne_u32 vcc, 0, v89
    v_xor_b32 v90, v97, v89
    s_add_u32 s3, s37, s38
    v_mbcnt_lo_u32_b32 v98, vcc_lo, 0
    v_mbcnt_hi_u32_b32 v98, vcc_hi, v98
    s_bcnt1_i32_b64 s41, vcc
    v_lshl_add_u32 v98, v98, 2, s3
    s_mov_b64 exec, vcc
    ds_write_b32 v98, v90
    s_mov_b64 exec, -1
    s_lshl2_add_u32 s37, s41, s37
    s_cmp_lg_u64 s[58:59], 0
    s_cbranch_scc1 L2_xe61
L2_xr61:
    v_add_u32 v98, s37, v0
    v_mov_b32 v90, -1
    ds_write_b32 v98, v90
    ds_read2st64_b32 v[40:41], v0 offset0:0 offset1:1
    ds_read2st64_b32 v[42:43], v0 offset0:2 offset1:3
    s_sub_u32 s3, s37, 768
    s_cmp_gt_u32 s3, 256
    s_cbranch_scc1 L2_xf61
L2_xg61:
    s_setprio 2
    ds_write_addtid_b32 v124 offset:34816
    ds_write_addtid_b32 v125 offset:35072
    ds_write_addtid_b32 v126 offset:35328
    ds_write_addtid_b32 v127 offset:35584
    s_add_u32 s3, s40, 4096
    buffer_load_dwordx4 v[124:127], v3, s[16:19], s3 offen
    s_waitcnt lgkmcnt(14)
    v_cmp_ne_u64 s[50:51], v[72:73], v[68:69]
    v_cmpx_ne_u64 s[54:55], v[74:75], v[70:71]
    s_and_b64 s[82:83], s[54:55], s[80:81]
    s_cbranch_scc1 L2_c62
L2_d62:
    v_mov_b64 v[84:85], v[70:71]
    v_mov_b32 v7, v95
    v_mov_b64 v[86:87], v[74:75]
    s_or_b64 s[80:81], s[80:81], s[54:55]
    s_mov_b64 exec, s[50:51]
    s_and_b64 s[82:83], s[50:51], s[80:81]
    s_cbranch_scc1 L2_c63
L2_d63:
    v_mov_b64 v[84:85], v[68:69]
    v_mov_b32 v7, v94
    v_mov_b64 v[86:87], v[72:73]
    s_mov_b64 exec, -1
    s_or_b64 s[80:81], s[80:81], s[50:51]
    ds_read_b64 v[70:71], v93 offset:65408
    s_and_b64 exec, s[84:85], s[80:81]
    v_mfma_f32_4x4x4_16b_bf16 v[76:79], v[12:13], v[84:85], 0
    v_mov_b32 v92, v7
    s_andn2_b64 s[80:81], s[80:81], s[84:85]
    v_mfma_f32_4x4x4_16b_bf16 v[76:79], v[10:11], v[86:87], v[76:79]
    s_mov_b64 exec, -1
    ds_read_b64 v[68:69], v92 offset:65408
    s_setprio 1
    s_waitcnt vmcnt(10)
    s_mov_b32 m0, s38
    s_nop 0
    ds_write_addtid_b32 v108 offset:0
    ds_write_addtid_b32 v109 offset:256
    ds_write_addtid_b32 v110 offset:512
    ds_write_addtid_b32 v111 offset:768
    s_waitcnt lgkmcnt(4)
    v_mfma_f32_4x4x4_16b_bf16 v[80:83], v[10:11], v[70:71], v[80:83]
    v_mfma_f32_4x4x4_16b_bf16 v[76:79], v[10:11], v[68:69], v[76:79]
    v_and_b32 v46, 0x40000000, v39
    v_bitop3_b32 v94, v36, v5, v46 bitop3:0xea
    v_and_b32 v46, 0x80000000, v39
    v_bitop3_b32 v95, v37, v5, v46 bitop3:0xea
    v_perm_b32 v15, v37, v38, s47
    v_bitop3_b32 v46, v37, 0.5, -0.5 bitop3:0xa8
    v_perm_b32 v14, v36, v38, s46
    v_bitop3_b32 v47, v36, 0.5, -0.5 bitop3:0xa8
    v_cvt_pk_bf16_f32 v80, v80, v81
    v_cvt_pk_bf16_f32 v81, v82, v83
    ds_wrxchg_rtn_b64 v[74:75], v93, v[80:81] offset:65408
    v_cvt_pk_bf16_f32 v76, v76, v77
    v_cvt_pk_bf16_f32 v77, v78, v79
    ds_wrxchg_rtn_b64 v[72:73], v92, v[76:77] offset:65408
    v_and_b32 v88, 0x0fffffff, v44
    v_mov_b32 v39, v44
    buffer_load_dwordx2 v[34:35], v88, s[8:11], 0 offen
    buffer_load_dwordx3 v[36:38], v88, s[8:11], 0 offen offset:8
    s_setprio 0
    s_waitcnt vmcnt(11)
    ds_write_addtid_b32 v112 offset:1024
    ds_write_addtid_b32 v113 offset:1280
    ds_write_addtid_b32 v114 offset:1536
    ds_write_addtid_b32 v115 offset:1792
    v_mfma_f32_4x4x4_16b_bf16 v[80:83], v[8:9], v[106:107], 0
    v_mfma_f32_4x4x4_16b_bf16 v[76:79], v[8:9], v[104:105], 0
    v_bitop3_b32 v15, v6, v15, v46 bitop3:0xca
    v_bitop3_b32 v14, v6, v14, v47 bitop3:0xca
    s_nop 1
    v_pk_mul_f32 v[80:81], v[80:81], v[14:15] op_sel:[0,1] op_sel_hi:[1,1]
    v_pk_mul_f32 v[82:83], v[82:83], v[14:15] op_sel:[0,1] op_sel_hi:[1,1]
    v_pk_mul_f32 v[76:77], v[76:77], v[14:15] op_sel:[0,0] op_sel_hi:[1,0]
    v_pk_mul_f32 v[78:79], v[78:79], v[14:15] op_sel:[0,0] op_sel_hi:[1,0]
    s_add_u32 s42, s42, 1
    s_waitcnt lgkmcnt(0)
    s_barrier
    s_bitcmp1_b32 s36, s42
    s_cbranch_scc1 L2_slow
L2_ret3:
    s_setprio 3
    buffer_load_dwordx4 v[108:111], v3, s[16:19], s40 offen offset:0
    v_cmp_ne_u64 s[50:51], v[72:73], v[68:69]
    v_cmpx_ne_u64 s[54:55], v[74:75], v[70:71]
    s_and_b64 s[82:83], s[54:55], s[80:81]
    s_cbranch_scc1 L2_c64
L2_d64:
    v_mov_b64 v[84:85], v[70:71]
    v_mov_b32 v7, v93
    v_mov_b64 v[86:87], v[74:75]
    s_or_b64 s[80:81], s[80:81], s[54:55]
    s_mov_b64 exec, s[50:51]
    s_and_b64 s[82:83], s[50:51], s[80:81]
    s_cbranch_scc1 L2_c65
L2_d65:
    v_mov_b64 v[84:85], v[68:69]
    v_mov_b32 v7, v92
    v_mov_b64 v[86:87], v[72:73]
    s_mov_b64 exec, -1
    s_or_b64 s[80:81], s[80:81], s[50:51]
    ds_read_b64 v[70:71], v95 offset:65408
    ds_read_b64 v[68:69], v94 offset:65408
    s_waitcnt vmcnt(10)
    v_and_b32 v46, 0x20000000, v21
    v_lshrrev_b32 v47, 14, v17
    v_bitop3_b32 v47, v47, v5, v46 bitop3:0xea
    ds_read_b64 v[102:103], v47
    v_bitop3_b32 v93, v17, v5, v46 bitop3:0xea
    v_and_b32 v46, 0x10000000, v21
    v_lshrrev_b32 v47, 14, v16
    v_bitop3_b32 v47, v47, v5, v46 bitop3:0xea
    ds_read_b64 v[100:101], v47
    v_bitop3_b32 v92, v16, v5, v46 bitop3:0xea
    s_waitcnt lgkmcnt(2)
    v_mfma_f32_4x4x4_16b_bf16 v[80:83], v[10:11], v[70:71], v[80:83]
    v_mfma_f32_4x4x4_16b_bf16 v[76:79], v[10:11], v[68:69], v[76:79]
    v_perm_b32 v15, v17, v20, s45
    v_bitop3_b32 v46, v17, 0.5, -0.5 bitop3:0xa8
    v_perm_b32 v14, v16, v20, s44
    v_bitop3_b32 v47, v16, 0.5, -0.5 bitop3:0xa8
    v_cvt_pk_bf16_f32 v80, v80, v81
    v_cvt_pk_bf16_f32 v81, v82, v83
    ds_wrxchg_rtn_b64 v[74:75], v95, v[80:81] offset:65408
    v_cvt_pk_bf16_f32 v76, v76, v77
    v_cvt_pk_bf16_f32 v77, v78, v79
    ds_wrxchg_rtn_b64 v[72:73], v94, v[76:77] offset:65408
    s_waitcnt lgkmcnt(2)
    v_mfma_f32_4x4x4_16b_bf16 v[80:83], v[8:9], v[102:103], 0
    v_mfma_f32_4x4x4_16b_bf16 v[76:79], v[8:9], v[100:101], 0
    v_bitop3_b32 v15, v6, v15, v46 bitop3:0xca
    v_bitop3_b32 v14, v6, v14, v47 bitop3:0xca
    v_cmp_lt_u32 s[84:85], v5, v92
    s_nop 0
    v_pk_mul_f32 v[80:81], v[80:81], v[14:15] op_sel:[0,1] op_sel_hi:[1,1]
    v_pk_mul_f32 v[82:83], v[82:83], v[14:15] op_sel:[0,1] op_sel_hi:[1,1]
    v_pk_mul_f32 v[76:77], v[76:77], v[14:15] op_sel:[0,0] op_sel_hi:[1,0]
    v_pk_mul_f32 v[78:79], v[78:79], v[14:15] op_sel:[0,0] op_sel_hi:[1,0]
    buffer_load_dwordx4 v[112:115], v3, s[16:19], s40 offen offset:1024
    s_waitcnt lgkmcnt(0)
    v_cmp_ne_u64 s[50:51], v[72:73], v[68:69]
    v_cmpx_ne_u64 s[54:55], v[74:75], v[70:71]
    s_and_b64 s[82:83], s[54:55], s[80:81]
    s_cbranch_scc1 L2_c66
L2_d66:
    v_mov_b64 v[84:85], v[70:71]
    v_mov_b32 v7, v95
    v_mov_b64 v[86:87], v[74:75]
    s_or_b64 s[80:81], s[80:81], s[54:55]
    s_mov_b64 exec, s[50:51]
    s_and_b64 s[82:83], s[50:51], s[80:81]
    s_cbranch_scc1 L2_c67
L2_d67:
    v_mov_b64 v[84:85], v[68:69]
    v_mov_b32 v7, v94
    v_mov_b64 v[86:87], v[72:73]
    s_mov_b64 exec, -1
    s_or_b64 s[80:81], s[80:81], s[50:51]
    ds_read_b64 v[70:71], v93 offset:65408
    s_and_b64 exec, s[84:85], s[80:81]
    v_mfma_f32_4x4x4_16b_bf16 v[76:79], v[12:13], v[84:85], 0
    v_mov_b32 v92, v7
    s_andn2_b64 s[80:81], s[80:81], s[84:85]
    v_mfma_f32_4x4x4_16b_bf16 v[76:79], v[10:11], v[86:87], v[76:79]
    s_mov_b64 exec, -1
    ds_read_b64 v[68:69], v92 offset:65408
    v_and_b32 v46, 0x80000000, v21
    v_lshrrev_b32 v47, 14, v19
    v_bitop3_b32 v47, v47, v5, v46 bitop3:0xea
    ds_read_b64 v[106:107], v47
    v_bitop3_b32 v95, v19, v5, v46 bitop3:0xea
    v_and_b32 v46, 0x40000000, v21
    v_lshrrev_b32 v47, 14, v18
    v_bitop3_b32 v47, v47, v5, v46 bitop3:0xea
    ds_read_b64 v[104:105], v47
    v_bitop3_b32 v94, v18, v5, v46 bitop3:0xea
    s_waitcnt lgkmcnt(2)
    v_mfma_f32_4x4x4_16b_bf16 v[80:83], v[10:11], v[70:71], v[80:83]
    v_mfma_f32_4x4x4_16b_bf16 v[76:79], v[10:11], v[68:69], v[76:79]
    v_perm_b32 v15, v19, v20, s47
    v_bitop3_b32 v46, v19, 0.5, -0.5 bitop3:0xa8
    v_perm_b32 v14, v18, v20, s46
    v_bitop3_b32 v47, v18, 0.5, -0.5 bitop3:0xa8
    v_cvt_pk_bf16_f32 v80, v80, v81
    v_cvt_pk_bf16_f32 v81, v82, v83
    ds_wrxchg_rtn_b64 v[74:75], v93, v[80:81] offset:65408
    v_cvt_pk_bf16_f32 v76, v76, v77
    v_cvt_pk_bf16_f32 v77, v78, v79
    ds_wrxchg_rtn_b64 v[72:73], v92, v[76:77] offset:65408
    v_and_b32 v88, 0x0fffffff, v40
    v_mov_b32 v21, v40
    buffer_load_dwordx2 v[16:17], v88, s[8:11], 0 offen
    buffer_load_dwordx3 v[18:20], v88, s[8:11], 0 offen offset:8
    s_setprio 2
    s_waitcnt lgkmcnt(2)
    v_mfma_f32_4x4x4_16b_bf16 v[80:83], v[8:9], v[106:107], 0
    v_mfma_f32_4x4x4_16b_bf16 v[76:79], v[8:9], v[104:105], 0
    v_bitop3_b32 v15, v6, v15, v46 bitop3:0xca
    v_bitop3_b32 v14, v6, v14, v47 bitop3:0xca
    s_nop 1
    v_pk_mul_f32 v[80:81], v[80:81], v[14:15] op_sel:[0,1] op_sel_hi:[1,1]
    v_pk_mul_f32 v[82:83], v[82:83], v[14:15] op_sel:[0,1] op_sel_hi:[1,1]
    v_pk_mul_f32 v[76:77], v[76:77], v[14:15] op_sel:[0,0] op_sel_hi:[1,0]
    v_pk_mul_f32 v[78:79], v[78:79], v[14:15] op_sel:[0,0] op_sel_hi:[1,0]
    v_sub_u16 v88, v58, v50
    v_and_b32 v89, 3, v50
    v_add3_u32 v99, v88, v89, 3
    v_and_b32 v99, -4, v99
    v_max_u32 v99, 4, v99
    v_and_b32 v97, 0xfffc, v50
    v_bfm_b32 v96, v88, v89
    v_add_u32_dpp v91, v99, v99 row_shr:1 row_mask:0xf bank_mask:0xf bound_ctrl:1
    v_mad_u32_u24 v97, v97, 5, v2
    v_cmp_lt_u32 vcc, 16, v99
    v_add_u32_dpp v91, v91, v91 row_shr:2 row_mask:0xf bank_mask:0xf bound_ctrl:1
    v_sub_u32 v98, s38, v99
    v_lshrrev_b64 v[50:51], 16, v[50:51]
    v_add_u32_dpp v91, v91, v91 row_shr:4 row_mask:0xf bank_mask:0xf bound_ctrl:1
    v_lshrrev_b64 v[58:59], 16, v[58:59]
    s_mov_b32 s101, 0
    v_add_u32_dpp v91, v91, v91 row_shr:8 row_mask:0xf bank_mask:0xf bound_ctrl:1
    s_nop 1
    v_add_u32_dpp v91, v91, v91 row_bcast:15 row_mask:0xa bank_mask:0xf
    s_nop 1
    v_add_u32_dpp v91, v91, v91 row_bcast:31 row_mask:0xc bank_mask:0xf
    v_add_u32 v98, v98, v91
    v_readlane_b32 s37, v91, 63
    s_cbranch_vccnz L2_xo68
L2_xp68:
    s_waitcnt lgkmcnt(0)
    v_cmp_ne_u64 s[50:51], v[72:73], v[68:69]
    v_cmpx_ne_u64 s[54:55], v[74:75], v[70:71]
    s_and_b64 s[82:83], s[54:55], s[80:81]
    s_cbranch_scc1 L2_c69
L2_d69:
    v_mov_b64 v[84:85], v[70:71]
    v_mov_b32 v7, v93
    v_mov_b64 v[86:87], v[74:75]
    s_or_b64 s[80:81], s[80:81], s[54:55]
    s_mov_b64 exec, s[50:51]
    s_and_b64 s[82:83], s[50:51], s[80:81]
    s_cbranch_scc1 L2_c70
L2_d70:
    v_mov_b64 v[84:85], v[68:69]
    v_mov_b32 v7, v92
    v_mov_b64 v[86:87], v[72:73]
    s_mov_b64 exec, -1
    s_or_b64 s[80:81], s[80:81], s[50:51]
    ds_read_b64 v[70:71], v95 offset:65408
    ds_read_b64 v[68:69], v94 offset:65408
    s_waitcnt vmcnt(11)
    v_and_b32 v46, 0x20000000, v27
    v_lshrrev_b32 v47, 14, v23
    v_bitop3_b32 v47, v47, v5, v46 bitop3:0xea
    ds_read_b64 v[102:103], v47
    v_bitop3_b32 v93, v23, v5, v46 bitop3:0xea
    v_and_b32 v46, 0x10000000, v27
    v_lshrrev_b32 v47, 14, v22
    v_bitop3_b32 v47, v47, v5, v46 bitop3:0xea
    ds_read_b64 v[100:101], v47
    v_bitop3_b32 v92, v22, v5, v46 bitop3:0xea
    s_waitcnt lgkmcnt(2)
    v_mfma_f32_4x4x4_16b_bf16 v[80:83], v[10:11], v[70:71], v[80:83]
    v_mfma_f32_4x4x4_16b_bf16 v[76:79], v[10:11], v[68:69], v[76:79]
    v_perm_b32 v15, v23, v26, s45
    v_bitop3_b32 v46, v23, 0.5, -0.5 bitop3:0xa8
    v_perm_b32 v14, v22, v26, s44
    v_bitop3_b32 v47, v22, 0.5, -0.5 bitop3:0xa8
    v_cvt_pk_bf16_f32 v80, v80, v81
    v_cvt_pk_bf16_f32 v81, v82, v83
    ds_wrxchg_rtn_b64 v[74:75], v95, v[80:81] offset:65408
    v_cvt_pk_bf16_f32 v76, v76, v77
    v_cvt_pk_bf16_f32 v77, v78, v79
    ds_wrxchg_rtn_b64 v[72:73], v94, v[76:77] offset:65408
    s_waitcnt lgkmcnt(2)
    v_mfma_f32_4x4x4_16b_bf16 v[80:83], v[8:9], v[102:103], 0
    v_mfma_f32_4x4x4_16b_bf16 v[76:79], v[8:9], v[100:101], 0
    v_bitop3_b32 v15, v6, v15, v46 bitop3:0xca
    v_bitop3_b32 v14, v6, v14, v47 bitop3:0xca
    v_cmp_lt_u32 s[84:85], v5, v92
    s_nop 0
    v_pk_mul_f32 v[80:81], v[80:81], v[14:15] op_sel:[0,1] op_sel_hi:[1,1]
    v_pk_mul_f32 v[82:83], v[82:83], v[14:15] op_sel:[0,1] op_sel_hi:[1,1]
    v_pk_mul_f32 v[76:77], v[76:77], v[14:15] op_sel:[0,0] op_sel_hi:[1,0]
    v_pk_mul_f32 v[78:79], v[78:79], v[14:15] op_sel:[0,0] op_sel_hi:[1,0]
    s_waitcnt lgkmcnt(0)
    v_cmp_ne_u64 s[50:51], v[72:73], v[68:69]
    v_cmpx_ne_u64 s[54:55], v[74:75], v[70:71]
    s_and_b64 s[82:83], s[54:55], s[80:81]
    s_cbranch_scc1 L2_c71
L2_d71:
    v_mov_b64 v[84:85], v[70:71]
    v_mov_b32 v7, v95
    v_mov_b64 v[86:87], v[74:75]
    s_or_b64 s[80:81], s[80:81], s[54:55]
    s_mov_b64 exec, s[50:51]
    s_and_b64 s[82:83], s[50:51], s[80:81]
    s_cbranch_scc1 L2_c72
L2_d72:
    v_mov_b64 v[84:85], v[68:69]
    v_mov_b32 v7, v94
    v_mov_b64 v[86:87], v[72:73]
    s_mov_b64 exec, -1
    s_or_b64 s[80:81], s[80:81], s[50:51]
    ds_read_b64 v[70:71], v93 offset:65408
    s_and_b64 exec, s[84:85], s[80:81]
    v_mfma_f32_4x4x4_16b_bf16 v[76:79], v[12:13], v[84:85], 0
    v_mov_b32 v92, v7
    s_andn2_b64 s[80:81], s[80:81], s[84:85]
    v_mfma_f32_4x4x4_16b_bf16 v[76:79], v[10:11], v[86:87], v[76:79]
    s_mov_b64 exec, -1
    ds_read_b64 v[68:69], v92 offset:65408
    v_and_b32 v46, 0x80000000, v27
    v_lshrrev_b32 v47, 14, v25
    v_bitop3_b32 v47, v47, v5, v46 bitop3:0xea
    ds_read_b64 v[106:107], v47
    v_bitop3_b32 v95, v25, v5, v46 bitop3:0xea
    v_and_b32 v46, 0x40000000, v27
    v_lshrrev_b32 v47, 14, v24
    v_bitop3_b32 v47, v47, v5, v46 bitop3:0xea
    ds_read_b64 v[104:105], v47
    v_bitop3_b32 v94, v24, v5, v46 bitop3:0xea
    s_waitcnt lgkmcnt(2)
    v_mfma_f32_4x4x4_16b_bf16 v[80:83], v[10:11], v[70:71], v[80:83]
    v_mfma_f32_4x4x4_16b_bf16 v[76:79], v[10:11], v[68:69], v[76:79]
    v_perm_b32 v15, v25, v26, s47
    v_bitop3_b32 v46, v25, 0.5, -0.5 bitop3:0xa8
    v_perm_b32 v14, v24, v26, s46
    v_bitop3_b32 v47, v24, 0.5, -0.5 bitop3:0xa8
    v_cvt_pk_bf16_f32 v80, v80, v81
    v_cvt_pk_bf16_f32 v81, v82, v83
    ds_wrxchg_rtn_b64 v[74:75], v93, v[80:81] offset:65408
    v_cvt_pk_bf16_f32 v76, v76, v77
    v_cvt_pk_bf16_f32 v77, v78, v79
    ds_wrxchg_rtn_b64 v[72:73], v92, v[76:77] offset:65408
    v_and_b32 v88, 0x0fffffff, v41
    v_mov_b32 v27, v41
    buffer_load_dwordx2 v[22:23], v88, s[8:11], 0 offen
    buffer_load_dwordx3 v[24:26], v88, s[8:11], 0 offen offset:8
    s_setprio 1
    s_waitcnt lgkmcnt(2)
    v_mfma_f32_4x4x4_16b_bf16 v[80:83], v[8:9], v[106:107], 0
    v_mfma_f32_4x4x4_16b_bf16 v[76:79], v[8:9], v[104:105], 0
    v_bitop3_b32 v15, v6, v15, v46 bitop3:0xca
    v_bitop3_b32 v14, v6, v14, v47 bitop3:0xca
    s_nop 1
    v_pk_mul_f32 v[80:81], v[80:81], v[14:15] op_sel:[0,1] op_sel_hi:[1,1]
    v_pk_mul_f32 v[82:83], v[82:83], v[14:15] op_sel:[0,1] op_sel_hi:[1,1]
    v_pk_mul_f32 v[76:77], v[76:77], v[14:15] op_sel:[0,0] op_sel_hi:[1,0]
    v_pk_mul_f32 v[78:79], v[78:79], v[14:15] op_sel:[0,0] op_sel_hi:[1,0]
    s_waitcnt lgkmcnt(0)
    v_cmp_ne_u64 s[50:51], v[72:73], v[68:69]
    v_cmpx_ne_u64 s[54:55], v[74:75], v[70:71]
    s_and_b64 s[82:83], s[54:55], s[80:81]
    s_cbranch_scc1 L2_c73
L2_d73:
    v_mov_b64 v[84:85], v[70:71]
    v_mov_b32 v7, v93
    v_mov_b64 v[86:87], v[74:75]
    s_or_b64 s[80:81], s[80:81], s[54:55]
    s_mov_b64 exec, s[50:51]
    s_and_b64 s[82:83], s[50:51], s[80:81]
    s_cbranch_scc1 L2_c74
L2_d74:
    v_mov_b64 v[84:85], v[68:69]
    v_mov_b32 v7, v92
    v_mov_b64 v[86:87], v[72:73]
    s_mov_b64 exec, -1
    s_or_b64 s[80:81], s[80:81], s[50:51]
    ds_read_b64 v[70:71], v95 offset:65408
    ds_read_b64 v[68:69], v94 offset:65408
    s_waitcnt vmcnt(11)
    v_and_b32 v46, 0x20000000, v33
    v_lshrrev_b32 v47, 14, v29
    v_bitop3_b32 v47, v47, v5, v46 bitop3:0xea
    ds_read_b64 v[102:103], v47
    v_bitop3_b32 v93, v29, v5, v46 bitop3:0xea
    v_and_b32 v46, 0x10000000, v33
    v_lshrrev_b32 v47, 14, v28
    v_bitop3_b32 v47, v47, v5, v46 bitop3:0xea
    ds_read_b64 v[100:101], v47
    v_bitop3_b32 v92, v28, v5, v46 bitop3:0xea
    s_waitcnt lgkmcnt(2)
    v_mfma_f32_4x4x4_16b_bf16 v[80:83], v[10:11], v[70:71], v[80:83]
    v_mfma_f32_4x4x4_16b_bf16 v[76:79], v[10:11], v[68:69], v[76:79]
    v_perm_b32 v15, v29, v32, s45
    v_bitop3_b32 v46, v29, 0.5, -0.5 bitop3:0xa8
    v_perm_b32 v14, v28, v32, s44
    v_bitop3_b32 v47, v28, 0.5, -0.5 bitop3:0xa8
    v_cvt_pk_bf16_f32 v80, v80, v81
    v_cvt_pk_bf16_f32 v81, v82, v83
    ds_wrxchg_rtn_b64 v[74:75], v95, v[80:81] offset:65408
    v_cvt_pk_bf16_f32 v76, v76, v77
    v_cvt_pk_bf16_f32 v77, v78, v79
    ds_wrxchg_rtn_b64 v[72:73], v94, v[76:77] offset:65408
    s_waitcnt lgkmcnt(2)
    v_mfma_f32_4x4x4_16b_bf16 v[80:83], v[8:9], v[102:103], 0
    v_mfma_f32_4x4x4_16b_bf16 v[76:79], v[8:9], v[100:101], 0
    v_bitop3_b32 v15, v6, v15, v46 bitop3:0xca
    v_bitop3_b32 v14, v6, v14, v47 bitop3:0xca
    v_cmp_lt_u32 s[84:85], v5, v92
    s_nop 0
    v_pk_mul_f32 v[80:81], v[80:81], v[14:15] op_sel:[0,1] op_sel_hi:[1,1]
    v_pk_mul_f32 v[82:83], v[82:83], v[14:15] op_sel:[0,1] op_sel_hi:[1,1]
    v_pk_mul_f32 v[76:77], v[76:77], v[14:15] op_sel:[0,0] op_sel_hi:[1,0]
    v_pk_mul_f32 v[78:79], v[78:79], v[14:15] op_sel:[0,0] op_sel_hi:[1,0]
    s_waitcnt lgkmcnt(0)
    v_cmp_ne_u64 s[50:51], v[72:73], v[68:69]
    v_cmpx_ne_u64 s[54:55], v[74:75], v[70:71]
    s_and_b64 s[82:83], s[54:55], s[80:81]
    s_cbranch_scc1 L2_c75
L2_d75:
    v_mov_b64 v[84:85], v[70:71]
    v_mov_b32 v7, v95
    v_mov_b64 v[86:87], v[74:75]
    s_or_b64 s[80:81], s[80:81], s[54:55]
    s_mov_b64 exec, s[50:51]
    s_and_b64 s[82:83], s[50:51], s[80:81]
    s_cbranch_scc1 L2_c76
L2_d76:
    v_mov_b64 v[84:85], v[68:69]
    v_mov_b32 v7, v94
    v_mov_b64 v[86:87], v[72:73]
    s_mov_b64 exec, -1
    s_or_b64 s[80:81], s[80:81], s[50:51]
    ds_read_b64 v[70:71], v93 offset:65408
    s_and_b64 exec, s[84:85], s[80:81]
    v_mfma_f32_4x4x4_16b_bf16 v[76:79], v[12:13], v[84:85], 0
    v_mov_b32 v92, v7
    s_andn2_b64 s[80:81], s[80:81], s[84:85]
    v_mfma_f32_4x4x4_16b_bf16 v[76:79], v[10:11], v[86:87], v[76:79]
    s_mov_b64 exec, -1
    ds_read_b64 v[68:69], v92 offset:65408
    v_and_b32 v46, 0x80000000, v33
    v_lshrrev_b32 v47, 14, v31
    v_bitop3_b32 v47, v47, v5, v46 bitop3:0xea
    ds_read_b64 v[106:107], v47
    v_bitop3_b32 v95, v31, v5, v46 bitop3:0xea
    v_and_b32 v46, 0x40000000, v33
    v_lshrrev_b32 v47, 14, v30
    v_bitop3_b32 v47, v47, v5, v46 bitop3:0xea
    ds_read_b64 v[104:105], v47
    v_bitop3_b32 v94, v30, v5, v46 bitop3:0xea
    s_waitcnt lgkmcnt(2)
    v_mfma_f32_4x4x4_16b_bf16 v[80:83], v[10:11], v[70:71], v[80:83]
    v_mfma_f32_4x4x4_16b_bf16 v[76:79], v[10:11], v[68:69], v[76:79]
    v_perm_b32 v15, v31, v32, s47
    v_bitop3_b32 v46, v31, 0.5, -0.5 bitop3:0xa8
    v_perm_b32 v14, v30, v32, s46
    v_bitop3_b32 v47, v30, 0.5, -0.5 bitop3:0xa8
    v_cvt_pk_bf16_f32 v80, v80, v81
    v_cvt_pk_bf16_f32 v81, v82, v83
    ds_wrxchg_rtn_b64 v[74:75], v93, v[80:81] offset:65408
    v_cvt_pk_bf16_f32 v76, v76, v77
    v_cvt_pk_bf16_f32 v77, v78, v79
    ds_wrxchg_rtn_b64 v[72:73], v92, v[76:77] offset:65408
    v_and_b32 v88, 0x0fffffff, v42
    v_mov_b32 v33, v42
    buffer_load_dwordx2 v[28:29], v88, s[8:11], 0 offen
    buffer_load_dwordx3 v[30:32], v88, s[8:11], 0 offen offset:8
    s_setprio 0
    s_waitcnt lgkmcnt(2)
    v_mfma_f32_4x4x4_16b_bf16 v[80:83], v[8:9], v[106:107], 0
    v_mfma_f32_4x4x4_16b_bf16 v[76:79], v[8:9], v[104:105], 0
    v_bitop3_b32 v15, v6, v15, v46 bitop3:0xca
    v_bitop3_b32 v14, v6, v14, v47 bitop3:0xca
    s_nop 1
    v_pk_mul_f32 v[80:81], v[80:81], v[14:15] op_sel:[0,1] op_sel_hi:[1,1]
    v_pk_mul_f32 v[82:83], v[82:83], v[14:15] op_sel:[0,1] op_sel_hi:[1,1]
    v_pk_mul_f32 v[76:77], v[76:77], v[14:15] op_sel:[0,0] op_sel_hi:[1,0]
    v_pk_mul_f32 v[78:79], v[78:79], v[14:15] op_sel:[0,0] op_sel_hi:[1,0]
    s_add_u32 s40, s40, 0x50000
    s_waitcnt lgkmcnt(0)
    v_cmp_ne_u64 s[50:51], v[72:73], v[68:69]
    v_cmpx_ne_u64 s[54:55], v[74:75], v[70:71]
    s_and_b64 s[82:83], s[54:55], s[80:81]
    s_cbranch_scc1 L2_c77
L2_d77:
    v_mov_b64 v[84:85], v[70:71]
    v_mov_b32 v7, v93
    v_mov_b64 v[86:87], v[74:75]
    s_or_b64 s[80:81], s[80:81], s[54:55]
    s_mov_b64 exec, s[50:51]
    s_and_b64 s[82:83], s[50:51], s[80:81]
    s_cbranch_scc1 L2_c78
L2_d78:
    v_mov_b64 v[84:85], v[68:69]
    v_mov_b32 v7, v92
    v_mov_b64 v[86:87], v[72:73]
    s_mov_b64 exec, -1
    s_or_b64 s[80:81], s[80:81], s[50:51]
    ds_read_b64 v[70:71], v95 offset:65408
    ds_read_b64 v[68:69], v94 offset:65408
    s_waitcnt vmcnt(8)
    v_and_b32 v46, 0x20000000, v39
    v_lshrrev_b32 v47, 14, v35
    v_bitop3_b32 v47, v47, v5, v46 bitop3:0xea
    ds_read_b64 v[102:103], v47
    v_bitop3_b32 v93, v35, v5, v46 bitop3:0xea
    v_and_b32 v46, 0x10000000, v39
    v_lshrrev_b32 v47, 14, v34
    v_bitop3_b32 v47, v47, v5, v46 bitop3:0xea
    ds_read_b64 v[100:101], v47
    v_bitop3_b32 v92, v34, v5, v46 bitop3:0xea
    v_and_b32 v46, 0x80000000, v39
    v_lshrrev_b32 v47, 14, v37
    v_bitop3_b32 v47, v47, v5, v46 bitop3:0xea
    ds_read_b64 v[106:107], v47
    v_and_b32 v46, 0x40000000, v39
    v_lshrrev_b32 v47, 14, v36
    v_bitop3_b32 v47, v47, v5, v46 bitop3:0xea
    ds_read_b64 v[104:105], v47
    s_waitcnt lgkmcnt(4)
    v_mfma_f32_4x4x4_16b_bf16 v[80:83], v[10:11], v[70:71], v[80:83]
    v_mfma_f32_4x4x4_16b_bf16 v[76:79], v[10:11], v[68:69], v[76:79]
    v_perm_b32 v15, v35, v38, s45
    v_bitop3_b32 v46, v35, 0.5, -0.5 bitop3:0xa8
    v_perm_b32 v14, v34, v38, s44
    v_bitop3_b32 v47, v34, 0.5, -0.5 bitop3:0xa8
    v_cvt_pk_bf16_f32 v80, v80, v81
    v_cvt_pk_bf16_f32 v81, v82, v83
    ds_wrxchg_rtn_b64 v[74:75], v95, v[80:81] offset:65408
    v_cvt_pk_bf16_f32 v76, v76, v77
    v_cvt_pk_bf16_f32 v77, v78, v79
    ds_wrxchg_rtn_b64 v[72:73], v94, v[76:77] offset:65408
    s_waitcnt lgkmcnt(2)
    s_barrier
    s_setprio 3
    s_mov_b32 m0, s100
    s_nop 0
    ds_write_addtid_b32 v116 offset:32768
    ds_write_addtid_b32 v117 offset:33024
    ds_write_addtid_b32 v118 offset:33280
    ds_write_addtid_b32 v119 offset:33536
    buffer_load_dwordx4 v[116:119], v3, s[16:19], s40 offen offset:2048
    ds_write_addtid_b32 v120 offset:33792
    ds_write_addtid_b32 v121 offset:34048
    ds_write_addtid_b32 v122 offset:34304
    ds_write_addtid_b32 v123 offset:34560
    buffer_load_dwordx4 v[120:123], v3, s[16:19], s40 offen offset:3072
    v_mfma_f32_4x4x4_16b_bf16 v[80:83], v[8:9], v[102:103], 0
    v_mfma_f32_4x4x4_16b_bf16 v[76:79], v[8:9], v[100:101], 0
    v_bitop3_b32 v15, v6, v15, v46 bitop3:0xca
    v_bitop3_b32 v14, v6, v14, v47 bitop3:0xca
    v_cmp_lt_u32 s[84:85], v5, v92
    s_nop 0
    v_pk_mul_f32 v[80:81], v[80:81], v[14:15] op_sel:[0,1] op_sel_hi:[1,1]
    v_pk_mul_f32 v[82:83], v[82:83], v[14:15] op_sel:[0,1] op_sel_hi:[1,1]
    v_pk_mul_f32 v[76:77], v[76:77], v[14:15] op_sel:[0,0] op_sel_hi:[1,0]
    v_pk_mul_f32 v[78:79], v[78:79], v[14:15] op_sel:[0,0] op_sel_hi:[1,0]
    v_mov_b32 v44, v43
    s_cmp_gt_u32 s37, 1024
    s_cbranch_scc1 L2_xs79
    s_cmp_lg_u32 s101, 0
    s_cbranch_scc1 L2_xa79
L2_xb79:
    v_lshlrev_b32 v89, 16, v96
    v_add_u32 v90, 60, v97
    v_bitop3_b32 v90, v89, v45, v90 bitop3:0x6a
    ds_write_b32 v98, v90 offset:12
    v_lshlrev_b32 v89, 20, v96
    v_add_u32 v90, 40, v97
    v_bitop3_b32 v90, v89, v45, v90 bitop3:0x6a
    ds_write_b32 v98, v90 offset:8
    v_lshlrev_b32 v89, 24, v96
    v_add_u32 v90, 20, v97
    v_bitop3_b32 v90, v89, v45, v90 bitop3:0x6a
    ds_write_b32 v98, v90 offset:4
    v_lshlrev_b32 v89, 28, v96
    v_bitop3_b32 v90, v89, v45, v97 bitop3:0x6a
    ds_write_b32 v98, v90 offset:0
    v_mov_b32_dpp v91, v66 quad_perm:[0,0,0,0] row_mask:0xf bank_mask:0xf
    v_and_b32 v89, 3, v91
    v_and_b32 v97, 0xfffc, v91
    v_sub_u16_dpp v88, v66, v91 quad_perm:[2,2,2,2] row_mask:0xf bank_mask:0xf
    v_mad_u32_u24 v97, v97, 5, v4
    v_add_u32 v99, v88, v89
    v_bfm_b32 v96, v88, v89
    v_cmp_lt_u32 s[58:59], 16, v99
    v_lshlrev_b32 v89, v1, v96
    v_and_b32 v89, v45, v89
    v_cmp_ne_u32 vcc, 0, v89
    v_xor_b32 v90, v97, v89
    s_add_u32 s3, s37, s38
    v_mbcnt_lo_u32_b32 v98, vcc_lo, 0
    v_mbcnt_hi_u32_b32 v98, vcc_hi, v98
    s_bcnt1_i32_b64 s41, vcc
    v_lshl_add_u32 v98, v98, 2, s3
    s_mov_b64 exec, vcc
    ds_write_b32 v98, v90
    s_mov_b64 exec, -1
    s_lshl2_add_u32 s37, s41, s37
    s_cmp_lg_u64 s[58:59], 0
    s_cbranch_scc1 L2_xe79
L2_xr79:
    v_add_u32 v98, s37, v0
    v_mov_b32 v90, -1
    ds_write_b32 v98, v90
    ds_read2st64_b32 v[40:41], v0 offset0:0 offset1:1
    ds_read2st64_b32 v[42:43], v0 offset0:2 offset1:3
    s_sub_u32 s3, s37, 768
    s_cmp_gt_u32 s3, 256
    s_cbranch_scc1 L2_xf79
L2_xg79:
    s_setprio 2
    ds_write_addtid_b32 v124 offset:34816
    ds_write_addtid_b32 v125 offset:35072
    ds_write_addtid_b32 v126 offset:35328
    ds_write_addtid_b32 v127 offset:35584
    s_add_u32 s3, s40, 4096
    buffer_load_dwordx4 v[124:127], v3, s[16:19], s3 offen
    s_waitcnt lgkmcnt(14)
    v_cmp_ne_u64 s[50:51], v[72:73], v[68:69]
    v_cmpx_ne_u64 s[54:55], v[74:75], v[70:71]
    s_and_b64 s[82:83], s[54:55], s[80:81]
    s_cbranch_scc1 L2_c80
L2_d80:
    v_mov_b64 v[84:85], v[70:71]
    v_mov_b32 v7, v95
    v_mov_b64 v[86:87], v[74:75]
    s_or_b64 s[80:81], s[80:81], s[54:55]
    s_mov_b64 exec, s[50:51]
    s_and_b64 s[82:83], s[50:51], s[80:81]
    s_cbranch_scc1 L2_c81
L2_d81:
    v_mov_b64 v[84:85], v[68:69]
    v_mov_b32 v7, v94
    v_mov_b64 v[86:87], v[72:73]
    s_mov_b64 exec, -1
    s_or_b64 s[80:81], s[80:81], s[50:51]
    ds_read_b64 v[70:71], v93 offset:65408
    s_and_b64 exec, s[84:85], s[80:81]
    v_mfma_f32_4x4x4_16b_bf16 v[76:79], v[12:13], v[84:85], 0
    v_mov_b32 v92, v7
    s_andn2_b64 s[80:81], s[80:81], s[84:85]
    v_mfma_f32_4x4x4_16b_bf16 v[76:79], v[10:11], v[86:87], v[76:79]
    s_mov_b64 exec, -1
    ds_read_b64 v[68:69], v92 offset:65408
    s_setprio 1
    s_waitcnt vmcnt(10)
    s_mov_b32 m0, s38
    s_nop 0
    ds_write_addtid_b32 v108 offset:0
    ds_write_addtid_b32 v109 offset:256
    ds_write_addtid_b32 v110 offset:512
    ds_write_addtid_b32 v111 offset:768
    s_waitcnt lgkmcnt(4)
    v_mfma_f32_4x4x4_16b_bf16 v[80:83], v[10:11], v[70:71], v[80:83]
    v_mfma_f32_4x4x4_16b_bf16 v[76:79], v[10:11], v[68:69], v[76:79]
    v_and_b32 v46, 0x40000000, v39
    v_bitop3_b32 v94, v36, v5, v46 bitop3:0xea
    v_and_b32 v46, 0x80000000, v39
    v_bitop3_b32 v95, v37, v5, v46 bitop3:0xea
    v_perm_b32 v15, v37, v38, s47
    v_bitop3_b32 v46, v37, 0.5, -0.5 bitop3:0xa8
    v_perm_b32 v14, v36, v38, s46
    v_bitop3_b32 v47, v36, 0.5, -0.5 bitop3:0xa8
    v_cvt_pk_bf16_f32 v80, v80, v81
    v_cvt_pk_bf16_f32 v81, v82, v83
    ds_wrxchg_rtn_b64 v[74:75], v93, v[80:81] offset:65408
    v_cvt_pk_bf16_f32 v76, v76, v77
    v_cvt_pk_bf16_f32 v77, v78, v79
    ds_wrxchg_rtn_b64 v[72:73], v92, v[76:77] offset:65408
    v_and_b32 v88, 0x0fffffff, v44
    v_mov_b32 v39, v44
    buffer_load_dwordx2 v[34:35], v88, s[8:11], 0 offen
    buffer_load_dwordx3 v[36:38], v88, s[8:11], 0 offen offset:8
    s_setprio 0
    s_waitcnt vmcnt(11)
    ds_write_addtid_b32 v112 offset:1024
    ds_write_addtid_b32 v113 offset:1280
    ds_write_addtid_b32 v114 offset:1536
    ds_write_addtid_b32 v115 offset:1792
    v_mfma_f32_4x4x4_16b_bf16 v[80:83], v[8:9], v[106:107], 0
    v_mfma_f32_4x4x4_16b_bf16 v[76:79], v[8:9], v[104:105], 0
    v_bitop3_b32 v15, v6, v15, v46 bitop3:0xca
    v_bitop3_b32 v14, v6, v14, v47 bitop3:0xca
    s_nop 1
    v_pk_mul_f32 v[80:81], v[80:81], v[14:15] op_sel:[0,1] op_sel_hi:[1,1]
    v_pk_mul_f32 v[82:83], v[82:83], v[14:15] op_sel:[0,1] op_sel_hi:[1,1]
    v_pk_mul_f32 v[76:77], v[76:77], v[14:15] op_sel:[0,0] op_sel_hi:[1,0]
    v_pk_mul_f32 v[78:79], v[78:79], v[14:15] op_sel:[0,0] op_sel_hi:[1,0]
    s_add_u32 s42, s42, 1
    s_waitcnt lgkmcnt(0)
    s_barrier
    s_bitcmp1_b32 s36, s42
    s_cbranch_scc1 L2_slow
L2_ret4:
    s_setprio 3
    buffer_load_dwordx4 v[108:111], v3, s[16:19], s40 offen offset:0
    v_cmp_ne_u64 s[50:51], v[72:73], v[68:69]
    v_cmpx_ne_u64 s[54:55], v[74:75], v[70:71]
    s_and_b64 s[82:83], s[54:55], s[80:81]
    s_cbranch_scc1 L2_c82
L2_d82:
    v_mov_b64 v[84:85], v[70:71]
    v_mov_b32 v7, v93
    v_mov_b64 v[86:87], v[74:75]
    s_or_b64 s[80:81], s[80:81], s[54:55]
    s_mov_b64 exec, s[50:51]
    s_and_b64 s[82:83], s[50:51], s[80:81]
    s_cbranch_scc1 L2_c83
L2_d83:
    v_mov_b64 v[84:85], v[68:69]
    v_mov_b32 v7, v92
    v_mov_b64 v[86:87], v[72:73]
    s_mov_b64 exec, -1
    s_or_b64 s[80:81], s[80:81], s[50:51]
    ds_read_b64 v[70:71], v95 offset:65408
    ds_read_b64 v[68:69], v94 offset:65408
    s_waitcnt vmcnt(10)
    v_and_b32 v46, 0x20000000, v21
    v_lshrrev_b32 v47, 14, v17
    v_bitop3_b32 v47, v47, v5, v46 bitop3:0xea
    ds_read_b64 v[102:103], v47
    v_bitop3_b32 v93, v17, v5, v46 bitop3:0xea
    v_and_b32 v46, 0x10000000, v21
    v_lshrrev_b32 v47, 14, v16
    v_bitop3_b32 v47, v47, v5, v46 bitop3:0xea
    ds_read_b64 v[100:101], v47
    v_bitop3_b32 v92, v16, v5, v46 bitop3:0xea
    s_waitcnt lgkmcnt(2)
    v_mfma_f32_4x4x4_16b_bf16 v[80:83], v[10:11], v[70:71], v[80:83]
    v_mfma_f32_4x4x4_16b_bf16 v[76:79], v[10:11], v[68:69], v[76:79]
    v_perm_b32 v15, v17, v20, s45
    v_bitop3_b32 v46, v17, 0.5, -0.5 bitop3:0xa8
    v_perm_b32 v14, v16, v20, s44
    v_bitop3_b32 v47, v16, 0.5, -0.5 bitop3:0xa8
    v_cvt_pk_bf16_f32 v80, v80, v81
    v_cvt_pk_bf16_f32 v81, v82, v83
    ds_wrxchg_rtn_b64 v[74:75], v95, v[80:81] offset:65408
    v_cvt_pk_bf16_f32 v76, v76, v77
    v_cvt_pk_bf16_f32 v77, v78, v79
    ds_wrxchg_rtn_b64 v[72:73], v94, v[76:77] offset:65408
    s_waitcnt lgkmcnt(2)
    v_mfma_f32_4x4x4_16b_bf16 v[80:83], v[8:9], v[102:103], 0
    v_mfma_f32_4x4x4_16b_bf16 v[76:79], v[8:9], v[100:101], 0
    v_bitop3_b32 v15, v6, v15, v46 bitop3:0xca
    v_bitop3_b32 v14, v6, v14, v47 bitop3:0xca
    v_cmp_lt_u32 s[84:85], v5, v92
    s_nop 0
    v_pk_mul_f32 v[80:81], v[80:81], v[14:15] op_sel:[0,1] op_sel_hi:[1,1]
    v_pk_mul_f32 v[82:83], v[82:83], v[14:15] op_sel:[0,1] op_sel_hi:[1,1]
    v_pk_mul_f32 v[76:77], v[76:77], v[14:15] op_sel:[0,0] op_sel_hi:[1,0]
    v_pk_mul_f32 v[78:79], v[78:79], v[14:15] op_sel:[0,0] op_sel_hi:[1,0]
    buffer_load_dwordx4 v[112:115], v3, s[16:19], s40 offen offset:1024
    s_waitcnt lgkmcnt(0)
    v_cmp_ne_u64 s[50:51], v[72:73], v[68:69]
    v_cmpx_ne_u64 s[54:55], v[74:75], v[70:71]
    s_and_b64 s[82:83], s[54:55], s[80:81]
    s_cbranch_scc1 L2_c84
L2_d84:
    v_mov_b64 v[84:85], v[70:71]
    v_mov_b32 v7, v95
    v_mov_b64 v[86:87], v[74:75]
    s_or_b64 s[80:81], s[80:81], s[54:55]
    s_mov_b64 exec, s[50:51]
    s_and_b64 s[82:83], s[50:51], s[80:81]
    s_cbranch_scc1 L2_c85
L2_d85:
    v_mov_b64 v[84:85], v[68:69]
    v_mov_b32 v7, v94
    v_mov_b64 v[86:87], v[72:73]
    s_mov_b64 exec, -1
    s_or_b64 s[80:81], s[80:81], s[50:51]
    ds_read_b64 v[70:71], v93 offset:65408
    s_and_b64 exec, s[84:85], s[80:81]
    v_mfma_f32_4x4x4_16b_bf16 v[76:79], v[12:13], v[84:85], 0
    v_mov_b32 v92, v7
    s_andn2_b64 s[80:81], s[80:81], s[84:85]
    v_mfma_f32_4x4x4_16b_bf16 v[76:79], v[10:11], v[86:87], v[76:79]
    s_mov_b64 exec, -1
    ds_read_b64 v[68:69], v92 offset:65408
    v_and_b32 v46, 0x80000000, v21
    v_lshrrev_b32 v47, 14, v19
    v_bitop3_b32 v47, v47, v5, v46 bitop3:0xea
    ds_read_b64 v[106:107], v47
    v_bitop3_b32 v95, v19, v5, v46 bitop3:0xea
    v_and_b32 v46, 0x40000000, v21
    v_lshrrev_b32 v47, 14, v18
    v_bitop3_b32 v47, v47, v5, v46 bitop3:0xea
    ds_read_b64 v[104:105], v47
    v_bitop3_b32 v94, v18, v5, v46 bitop3:0xea
    s_waitcnt lgkmcnt(2)
    v_mfma_f32_4x4x4_16b_bf16 v[80:83], v[10:11], v[70:71], v[80:83]
    v_mfma_f32_4x4x4_16b_bf16 v[76:79], v[10:11], v[68:69], v[76:79]
    v_perm_b32 v15, v19, v20, s47
    v_bitop3_b32 v46, v19, 0.5, -0.5 bitop3:0xa8
    v_perm_b32 v14, v18, v20, s46
    v_bitop3_b32 v47, v18, 0.5, -0.5 bitop3:0xa8
    v_cvt_pk_bf16_f32 v80, v80, v81
    v_cvt_pk_bf16_f32 v81, v82, v83
    ds_wrxchg_rtn_b64 v[74:75], v93, v[80:81] offset:65408
    v_cvt_pk_bf16_f32 v76, v76, v77
    v_cvt_pk_bf16_f32 v77, v78, v79
    ds_wrxchg_rtn_b64 v[72:73], v92, v[76:77] offset:65408
    v_and_b32 v88, 0x0fffffff, v40
    v_mov_b32 v21, v40
    buffer_load_dwordx2 v[16:17], v88, s[8:11], 0 offen
    buffer_load_dwordx3 v[18:20], v88, s[8:11], 0 offen offset:8
    s_setprio 2
    s_waitcnt lgkmcnt(2)
    v_mfma_f32_4x4x4_16b_bf16 v[80:83], v[8:9], v[106:107], 0
    v_mfma_f32_4x4x4_16b_bf16 v[76:79], v[8:9], v[104:105], 0
    v_bitop3_b32 v15, v6, v15, v46 bitop3:0xca
    v_bitop3_b32 v14, v6, v14, v47 bitop3:0xca
    s_nop 1
    v_pk_mul_f32 v[80:81], v[80:81], v[14:15] op_sel:[0,1] op_sel_hi:[1,1]
    v_pk_mul_f32 v[82:83], v[82:83], v[14:15] op_sel:[0,1] op_sel_hi:[1,1]
    v_pk_mul_f32 v[76:77], v[76:77], v[14:15] op_sel:[0,0] op_sel_hi:[1,0]
    v_pk_mul_f32 v[78:79], v[78:79], v[14:15] op_sel:[0,0] op_sel_hi:[1,0]
    v_sub_u16 v88, v60, v52
    v_and_b32 v89, 3, v52
    v_add3_u32 v99, v88, v89, 3
    v_and_b32 v99, -4, v99
    v_max_u32 v99, 4, v99
    v_and_b32 v97, 0xfffc, v52
    v_bfm_b32 v96, v88, v89
    v_add_u32_dpp v91, v99, v99 row_shr:1 row_mask:0xf bank_mask:0xf bound_ctrl:1
    v_mad_u32_u24 v97, v97, 5, v2
    v_cmp_lt_u32 vcc, 16, v99
    v_add_u32_dpp v91, v91, v91 row_shr:2 row_mask:0xf bank_mask:0xf bound_ctrl:1
    v_sub_u32 v98, s38, v99
    v_lshrrev_b64 v[52:53], 16, v[52:53]
    v_add_u32_dpp v91, v91, v91 row_shr:4 row_mask:0xf bank_mask:0xf bound_ctrl:1
    v_lshrrev_b64 v[60:61], 16, v[60:61]
    s_mov_b32 s101, 0
    v_add_u32_dpp v91, v91, v91 row_shr:8 row_mask:0xf bank_mask:0xf bound_ctrl:1
    s_nop 1
    v_add_u32_dpp v91, v91, v91 row_bcast:15 row_mask:0xa bank_mask:0xf
    s_nop 1
    v_add_u32_dpp v91, v91, v91 row_bcast:31 row_mask:0xc bank_mask:0xf
    v_add_u32 v98, v98, v91
    v_readlane_b32 s37, v91, 63
    s_cbranch_vccnz L2_xo86
L2_xp86:
    s_waitcnt lgkmcnt(0)
    v_cmp_ne_u64 s[50:51], v[72:73], v[68:69]
    v_cmpx_ne_u64 s[54:55], v[74:75], v[70:71]
    s_and_b64 s[82:83], s[54:55], s[80:81]
    s_cbranch_scc1 L2_c87
L2_d87:
    v_mov_b64 v[84:85], v[70:71]
    v_mov_b32 v7, v93
    v_mov_b64 v[86:87], v[74:75]
    s_or_b64 s[80:81], s[80:81], s[54:55]
    s_mov_b64 exec, s[50:51]
    s_and_b64 s[82:83], s[50:51], s[80:81]
    s_cbranch_scc1 L2_c88
L2_d88:
    v_mov_b64 v[84:85], v[68:69]
    v_mov_b32 v7, v92
    v_mov_b64 v[86:87], v[72:73]
    s_mov_b64 exec, -1
    s_or_b64 s[80:81], s[80:81], s[50:51]
    ds_read_b64 v[70:71], v95 offset:65408
    ds_read_b64 v[68:69], v94 offset:65408
    s_waitcnt vmcnt(11)
    v_and_b32 v46, 0x20000000, v27
    v_lshrrev_b32 v47, 14, v23
    v_bitop3_b32 v47, v47, v5, v46 bitop3:0xea
    ds_read_b64 v[102:103], v47
    v_bitop3_b32 v93, v23, v5, v46 bitop3:0xea
    v_and_b32 v46, 0x10000000, v27
    v_lshrrev_b32 v47, 14, v22
    v_bitop3_b32 v47, v47, v5, v46 bitop3:0xea
    ds_read_b64 v[100:101], v47
    v_bitop3_b32 v92, v22, v5, v46 bitop3:0xea
    s_waitcnt lgkmcnt(2)
    v_mfma_f32_4x4x4_16b_bf16 v[80:83], v[10:11], v[70:71], v[80:83]
    v_mfma_f32_4x4x4_16b_bf16 v[76:79], v[10:11], v[68:69], v[76:79]
    v_perm_b32 v15, v23, v26, s45
    v_bitop3_b32 v46, v23, 0.5, -0.5 bitop3:0xa8
    v_perm_b32 v14, v22, v26, s44
    v_bitop3_b32 v47, v22, 0.5, -0.5 bitop3:0xa8
    v_cvt_pk_bf16_f32 v80, v80, v81
    v_cvt_pk_bf16_f32 v81, v82, v83
    ds_wrxchg_rtn_b64 v[74:75], v95, v[80:81] offset:65408
    v_cvt_pk_bf16_f32 v76, v76, v77
    v_cvt_pk_bf16_f32 v77, v78, v79
    ds_wrxchg_rtn_b64 v[72:73], v94, v[76:77] offset:65408
    s_waitcnt lgkmcnt(2)
    v_mfma_f32_4x4x4_16b_bf16 v[80:83], v[8:9], v[102:103], 0
    v_mfma_f32_4x4x4_16b_bf16 v[76:79], v[8:9], v[100:101], 0
    v_bitop3_b32 v15, v6, v15, v46 bitop3:0xca
    v_bitop3_b32 v14, v6, v14, v47 bitop3:0xca
    v_cmp_lt_u32 s[84:85], v5, v92
    s_nop 0
    v_pk_mul_f32 v[80:81], v[80:81], v[14:15] op_sel:[0,1] op_sel_hi:[1,1]
    v_pk_mul_f32 v[82:83], v[82:83], v[14:15] op_sel:[0,1] op_sel_hi:[1,1]
    v_pk_mul_f32 v[76:77], v[76:77], v[14:15] op_sel:[0,0] op_sel_hi:[1,0]
    v_pk_mul_f32 v[78:79], v[78:79], v[14:15] op_sel:[0,0] op_sel_hi:[1,0]
    s_waitcnt lgkmcnt(0)
    v_cmp_ne_u64 s[50:51], v[72:73], v[68:69]
    v_cmpx_ne_u64 s[54:55], v[74:75], v[70:71]
    s_and_b64 s[82:83], s[54:55], s[80:81]
    s_cbranch_scc1 L2_c89
L2_d89:
    v_mov_b64 v[84:85], v[70:71]
    v_mov_b32 v7, v95
    v_mov_b64 v[86:87], v[74:75]
    s_or_b64 s[80:81], s[80:81], s[54:55]
    s_mov_b64 exec, s[50:51]
    s_and_b64 s[82:83], s[50:51], s[80:81]
    s_cbranch_scc1 L2_c90
L2_d90:
    v_mov_b64 v[84:85], v[68:69]
    v_mov_b32 v7, v94
    v_mov_b64 v[86:87], v[72:73]
    s_mov_b64 exec, -1
    s_or_b64 s[80:81], s[80:81], s[50:51]
    ds_read_b64 v[70:71], v93 offset:65408
    s_and_b64 exec, s[84:85], s[80:81]
    v_mfma_f32_4x4x4_16b_bf16 v[76:79], v[12:13], v[84:85], 0
    v_mov_b32 v92, v7
    s_andn2_b64 s[80:81], s[80:81], s[84:85]
    v_mfma_f32_4x4x4_16b_bf16 v[76:79], v[10:11], v[86:87], v[76:79]
    s_mov_b64 exec, -1
    ds_read_b64 v[68:69], v92 offset:65408
    v_and_b32 v46, 0x80000000, v27
    v_lshrrev_b32 v47, 14, v25
    v_bitop3_b32 v47, v47, v5, v46 bitop3:0xea
    ds_read_b64 v[106:107], v47
    v_bitop3_b32 v95, v25, v5, v46 bitop3:0xea
    v_and_b32 v46, 0x40000000, v27
    v_lshrrev_b32 v47, 14, v24
    v_bitop3_b32 v47, v47, v5, v46 bitop3:0xea
    ds_read_b64 v[104:105], v47
    v_bitop3_b32 v94, v24, v5, v46 bitop3:0xea
    s_waitcnt lgkmcnt(2)
    v_mfma_f32_4x4x4_16b_bf16 v[80:83], v[10:11], v[70:71], v[80:83]
    v_mfma_f32_4x4x4_16b_bf16 v[76:79], v[10:11], v[68:69], v[76:79]
    v_perm_b32 v15, v25, v26, s47
    v_bitop3_b32 v46, v25, 0.5, -0.5 bitop3:0xa8
    v_perm_b32 v14, v24, v26, s46
    v_bitop3_b32 v47, v24, 0.5, -0.5 bitop3:0xa8
    v_cvt_pk_bf16_f32 v80, v80, v81
    v_cvt_pk_bf16_f32 v81, v82, v83
    ds_wrxchg_rtn_b64 v[74:75], v93, v[80:81] offset:65408
    v_cvt_pk_bf16_f32 v76, v76, v77
    v_cvt_pk_bf16_f32 v77, v78, v79
    ds_wrxchg_rtn_b64 v[72:73], v92, v[76:77] offset:65408
    v_and_b32 v88, 0x0fffffff, v41
    v_mov_b32 v27, v41
    buffer_load_dwordx2 v[22:23], v88, s[8:11], 0 offen
    buffer_load_dwordx3 v[24:26], v88, s[8:11], 0 offen offset:8
    s_setprio 1
    s_waitcnt lgkmcnt(2)
    v_mfma_f32_4x4x4_16b_bf16 v[80:83], v[8:9], v[106:107], 0
    v_mfma_f32_4x4x4_16b_bf16 v[76:79], v[8:9], v[104:105], 0
    v_bitop3_b32 v15, v6, v15, v46 bitop3:0xca
    v_bitop3_b32 v14, v6, v14, v47 bitop3:0xca
    s_nop 1
    v_pk_mul_f32 v[80:81], v[80:81], v[14:15] op_sel:[0,1] op_sel_hi:[1,1]
    v_pk_mul_f32 v[82:83], v[82:83], v[14:15] op_sel:[0,1] op_sel_hi:[1,1]
    v_pk_mul_f32 v[76:77], v[76:77], v[14:15] op_sel:[0,0] op_sel_hi:[1,0]
    v_pk_mul_f32 v[78:79], v[78:79], v[14:15] op_sel:[0,0] op_sel_hi:[1,0]
    s_waitcnt lgkmcnt(0)
    v_cmp_ne_u64 s[50:51], v[72:73], v[68:69]
    v_cmpx_ne_u64 s[54:55], v[74:75], v[70:71]
    s_and_b64 s[82:83], s[54:55], s[80:81]
    s_cbranch_scc1 L2_c91
L2_d91:
    v_mov_b64 v[84:85], v[70:71]
    v_mov_b32 v7, v93
    v_mov_b64 v[86:87], v[74:75]
    s_or_b64 s[80:81], s[80:81], s[54:55]
    s_mov_b64 exec, s[50:51]
    s_and_b64 s[82:83], s[50:51], s[80:81]
    s_cbranch_scc1 L2_c92
L2_d92:
    v_mov_b64 v[84:85], v[68:69]
    v_mov_b32 v7, v92
    v_mov_b64 v[86:87], v[72:73]
    s_mov_b64 exec, -1
    s_or_b64 s[80:81], s[80:81], s[50:51]
    ds_read_b64 v[70:71], v95 offset:65408
    ds_read_b64 v[68:69], v94 offset:65408
    s_waitcnt vmcnt(11)
    v_and_b32 v46, 0x20000000, v33
    v_lshrrev_b32 v47, 14, v29
    v_bitop3_b32 v47, v47, v5, v46 bitop3:0xea
    ds_read_b64 v[102:103], v47
    v_bitop3_b32 v93, v29, v5, v46 bitop3:0xea
    v_and_b32 v46, 0x10000000, v33
    v_lshrrev_b32 v47, 14, v28
    v_bitop3_b32 v47, v47, v5, v46 bitop3:0xea
    ds_read_b64 v[100:101], v47
    v_bitop3_b32 v92, v28, v5, v46 bitop3:0xea
    s_waitcnt lgkmcnt(2)
    v_mfma_f32_4x4x4_16b_bf16 v[80:83], v[10:11], v[70:71], v[80:83]
    v_mfma_f32_4x4x4_16b_bf16 v[76:79], v[10:11], v[68:69], v[76:79]
    v_perm_b32 v15, v29, v32, s45
    v_bitop3_b32 v46, v29, 0.5, -0.5 bitop3:0xa8
    v_perm_b32 v14, v28, v32, s44
    v_bitop3_b32 v47, v28, 0.5, -0.5 bitop3:0xa8
    v_cvt_pk_bf16_f32 v80, v80, v81
    v_cvt_pk_bf16_f32 v81, v82, v83
    ds_wrxchg_rtn_b64 v[74:75], v95, v[80:81] offset:65408
    v_cvt_pk_bf16_f32 v76, v76, v77
    v_cvt_pk_bf16_f32 v77, v78, v79
    ds_wrxchg_rtn_b64 v[72:73], v94, v[76:77] offset:65408
    s_waitcnt lgkmcnt(2)
    v_mfma_f32_4x4x4_16b_bf16 v[80:83], v[8:9], v[102:103], 0
    v_mfma_f32_4x4x4_16b_bf16 v[76:79], v[8:9], v[100:101], 0
    v_bitop3_b32 v15, v6, v15, v46 bitop3:0xca
    v_bitop3_b32 v14, v6, v14, v47 bitop3:0xca
    v_cmp_lt_u32 s[84:85], v5, v92
    s_nop 0
    v_pk_mul_f32 v[80:81], v[80:81], v[14:15] op_sel:[0,1] op_sel_hi:[1,1]
    v_pk_mul_f32 v[82:83], v[82:83], v[14:15] op_sel:[0,1] op_sel_hi:[1,1]
    v_pk_mul_f32 v[76:77], v[76:77], v[14:15] op_sel:[0,0] op_sel_hi:[1,0]
    v_pk_mul_f32 v[78:79], v[78:79], v[14:15] op_sel:[0,0] op_sel_hi:[1,0]
    s_waitcnt lgkmcnt(0)
    v_cmp_ne_u64 s[50:51], v[72:73], v[68:69]
    v_cmpx_ne_u64 s[54:55], v[74:75], v[70:71]
    s_and_b64 s[82:83], s[54:55], s[80:81]
    s_cbranch_scc1 L2_c93
L2_d93:
    v_mov_b64 v[84:85], v[70:71]
    v_mov_b32 v7, v95
    v_mov_b64 v[86:87], v[74:75]
    s_or_b64 s[80:81], s[80:81], s[54:55]
    s_mov_b64 exec, s[50:51]
    s_and_b64 s[82:83], s[50:51], s[80:81]
    s_cbranch_scc1 L2_c94
L2_d94:
    v_mov_b64 v[84:85], v[68:69]
    v_mov_b32 v7, v94
    v_mov_b64 v[86:87], v[72:73]
    s_mov_b64 exec, -1
    s_or_b64 s[80:81], s[80:81], s[50:51]
    ds_read_b64 v[70:71], v93 offset:65408
    s_and_b64 exec, s[84:85], s[80:81]
    v_mfma_f32_4x4x4_16b_bf16 v[76:79], v[12:13], v[84:85], 0
    v_mov_b32 v92, v7
    s_andn2_b64 s[80:81], s[80:81], s[84:85]
    v_mfma_f32_4x4x4_16b_bf16 v[76:79], v[10:11], v[86:87], v[76:79]
    s_mov_b64 exec, -1
    ds_read_b64 v[68:69], v92 offset:65408
    v_and_b32 v46, 0x80000000, v33
    v_lshrrev_b32 v47, 14, v31
    v_bitop3_b32 v47, v47, v5, v46 bitop3:0xea
    ds_read_b64 v[106:107], v47
    v_bitop3_b32 v95, v31, v5, v46 bitop3:0xea
    v_and_b32 v46, 0x40000000, v33
    v_lshrrev_b32 v47, 14, v30
    v_bitop3_b32 v47, v47, v5, v46 bitop3:0xea
    ds_read_b64 v[104:105], v47
    v_bitop3_b32 v94, v30, v5, v46 bitop3:0xea
    s_waitcnt lgkmcnt(2)
    v_mfma_f32_4x4x4_16b_bf16 v[80:83], v[10:11], v[70:71], v[80:83]
    v_mfma_f32_4x4x4_16b_bf16 v[76:79], v[10:11], v[68:69], v[76:79]
    v_perm_b32 v15, v31, v32, s47
    v_bitop3_b32 v46, v31, 0.5, -0.5 bitop3:0xa8
    v_perm_b32 v14, v30, v32, s46
    v_bitop3_b32 v47, v30, 0.5, -0.5 bitop3:0xa8
    v_cvt_pk_bf16_f32 v80, v80, v81
    v_cvt_pk_bf16_f32 v81, v82, v83
    ds_wrxchg_rtn_b64 v[74:75], v93, v[80:81] offset:65408
    v_cvt_pk_bf16_f32 v76, v76, v77
    v_cvt_pk_bf16_f32 v77, v78, v79
    ds_wrxchg_rtn_b64 v[72:73], v92, v[76:77] offset:65408
    v_and_b32 v88, 0x0fffffff, v42
    v_mov_b32 v33, v42
    buffer_load_dwordx2 v[28:29], v88, s[8:11], 0 offen
    buffer_load_dwordx3 v[30:32], v88, s[8:11], 0 offen offset:8
    s_setprio 0
    s_waitcnt lgkmcnt(2)
    v_mfma_f32_4x4x4_16b_bf16 v[80:83], v[8:9], v[106:107], 0
    v_mfma_f32_4x4x4_16b_bf16 v[76:79], v[8:9], v[104:105], 0
    v_bitop3_b32 v15, v6, v15, v46 bitop3:0xca
    v_bitop3_b32 v14, v6, v14, v47 bitop3:0xca
    s_nop 1
    v_pk_mul_f32 v[80:81], v[80:81], v[14:15] op_sel:[0,1] op_sel_hi:[1,1]
    v_pk_mul_f32 v[82:83], v[82:83], v[14:15] op_sel:[0,1] op_sel_hi:[1,1]
    v_pk_mul_f32 v[76:77], v[76:77], v[14:15] op_sel:[0,0] op_sel_hi:[1,0]
    v_pk_mul_f32 v[78:79], v[78:79], v[14:15] op_sel:[0,0] op_sel_hi:[1,0]
    s_add_u32 s40, s40, 0x50000
    s_waitcnt lgkmcnt(0)
    v_cmp_ne_u64 s[50:51], v[72:73], v[68:69]
    v_cmpx_ne_u64 s[54:55], v[74:75], v[70:71]
    s_and_b64 s[82:83], s[54:55], s[80:81]
    s_cbranch_scc1 L2_c95
L2_d95:
    v_mov_b64 v[84:85], v[70:71]
    v_mov_b32 v7, v93
    v_mov_b64 v[86:87], v[74:75]
    s_or_b64 s[80:81], s[80:81], s[54:55]
    s_mov_b64 exec, s[50:51]
    s_and_b64 s[82:83], s[50:51], s[80:81]
    s_cbranch_scc1 L2_c96
L2_d96:
    v_mov_b64 v[84:85], v[68:69]
    v_mov_b32 v7, v92
    v_mov_b64 v[86:87], v[72:73]
    s_mov_b64 exec, -1
    s_or_b64 s[80:81], s[80:81], s[50:51]
    ds_read_b64 v[70:71], v95 offset:65408
    ds_read_b64 v[68:69], v94 offset:65408
    s_waitcnt vmcnt(8)
    v_and_b32 v46, 0x20000000, v39
    v_lshrrev_b32 v47, 14, v35
    v_bitop3_b32 v47, v47, v5, v46 bitop3:0xea
    ds_read_b64 v[102:103], v47
    v_bitop3_b32 v93, v35, v5, v46 bitop3:0xea
    v_and_b32 v46, 0x10000000, v39
    v_lshrrev_b32 v47, 14, v34
    v_bitop3_b32 v47, v47, v5, v46 bitop3:0xea
    ds_read_b64 v[100:101], v47
    v_bitop3_b32 v92, v34, v5, v46 bitop3:0xea
    v_and_b32 v46, 0x80000000, v39
    v_lshrrev_b32 v47, 14, v37
    v_bitop3_b32 v47, v47, v5, v46 bitop3:0xea
    ds_read_b64 v[106:107], v47
    v_and_b32 v46, 0x40000000, v39
    v_lshrrev_b32 v47, 14, v36
    v_bitop3_b32 v47, v47, v5, v46 bitop3:0xea
    ds_read_b64 v[104:105], v47
    s_waitcnt lgkmcnt(4)
    v_mfma_f32_4x4x4_16b_bf16 v[80:83], v[10:11], v[70:71], v[80:83]
    v_mfma_f32_4x4x4_16b_bf16 v[76:79], v[10:11], v[68:69], v[76:79]
    v_perm_b32 v15, v35, v38, s45
    v_bitop3_b32 v46, v35, 0.5, -0.5 bitop3:0xa8
    v_perm_b32 v14, v34, v38, s44
    v_bitop3_b32 v47, v34, 0.5, -0.5 bitop3:0xa8
    v_cvt_pk_bf16_f32 v80, v80, v81
    v_cvt_pk_bf16_f32 v81, v82, v83
    ds_wrxchg_rtn_b64 v[74:75], v95, v[80:81] offset:65408
    v_cvt_pk_bf16_f32 v76, v76, v77
    v_cvt_pk_bf16_f32 v77, v78, v79
    ds_wrxchg_rtn_b64 v[72:73], v94, v[76:77] offset:65408
    s_waitcnt lgkmcnt(2)
    s_barrier
    s_setprio 3
    s_mov_b32 m0, s100
    s_nop 0
    ds_write_addtid_b32 v116 offset:32768
    ds_write_addtid_b32 v117 offset:33024
    ds_write_addtid_b32 v118 offset:33280
    ds_write_addtid_b32 v119 offset:33536
    buffer_load_dwordx4 v[116:119], v3, s[16:19], s40 offen offset:2048
    ds_write_addtid_b32 v120 offset:33792
    ds_write_addtid_b32 v121 offset:34048
    ds_write_addtid_b32 v122 offset:34304
    ds_write_addtid_b32 v123 offset:34560
    buffer_load_dwordx4 v[120:123], v3, s[16:19], s40 offen offset:3072
    v_mfma_f32_4x4x4_16b_bf16 v[80:83], v[8:9], v[102:103], 0
    v_mfma_f32_4x4x4_16b_bf16 v[76:79], v[8:9], v[100:101], 0
    v_bitop3_b32 v15, v6, v15, v46 bitop3:0xca
    v_bitop3_b32 v14, v6, v14, v47 bitop3:0xca
    v_cmp_lt_u32 s[84:85], v5, v92
    s_nop 0
    v_pk_mul_f32 v[80:81], v[80:81], v[14:15] op_sel:[0,1] op_sel_hi:[1,1]
    v_pk_mul_f32 v[82:83], v[82:83], v[14:15] op_sel:[0,1] op_sel_hi:[1,1]
    v_pk_mul_f32 v[76:77], v[76:77], v[14:15] op_sel:[0,0] op_sel_hi:[1,0]
    v_pk_mul_f32 v[78:79], v[78:79], v[14:15] op_sel:[0,0] op_sel_hi:[1,0]
    v_mov_b32 v44, v43
    s_cmp_gt_u32 s37, 1024
    s_cbranch_scc1 L2_xs97
    s_cmp_lg_u32 s101, 0
    s_cbranch_scc1 L2_xa97
L2_xb97:
    v_lshlrev_b32 v89, 16, v96
    v_add_u32 v90, 60, v97
    v_bitop3_b32 v90, v89, v45, v90 bitop3:0x6a
    ds_write_b32 v98, v90 offset:12
    v_lshlrev_b32 v89, 20, v96
    v_add_u32 v90, 40, v97
    v_bitop3_b32 v90, v89, v45, v90 bitop3:0x6a
    ds_write_b32 v98, v90 offset:8
    v_lshlrev_b32 v89, 24, v96
    v_add_u32 v90, 20, v97
    v_bitop3_b32 v90, v89, v45, v90 bitop3:0x6a
    ds_write_b32 v98, v90 offset:4
    v_lshlrev_b32 v89, 28, v96
    v_bitop3_b32 v90, v89, v45, v97 bitop3:0x6a
    ds_write_b32 v98, v90 offset:0
    v_mov_b32_dpp v91, v64 quad_perm:[1,1,1,1] row_mask:0xf bank_mask:0xf
    v_and_b32 v89, 3, v91
    v_and_b32 v97, 0xfffc, v91
    v_sub_u16_dpp v88, v64, v91 quad_perm:[3,3,3,3] row_mask:0xf bank_mask:0xf
    v_mad_u32_u24 v97, v97, 5, v4
    v_add_u32 v99, v88, v89
    v_bfm_b32 v96, v88, v89
    v_cmp_lt_u32 s[58:59], 16, v99
    v_lshlrev_b32 v89, v1, v96
    v_and_b32 v89, v45, v89
    v_cmp_ne_u32 vcc, 0, v89
    v_xor_b32 v90, v97, v89
    s_add_u32 s3, s37, s38
    v_mbcnt_lo_u32_b32 v98, vcc_lo, 0
    v_mbcnt_hi_u32_b32 v98, vcc_hi, v98
    s_bcnt1_i32_b64 s41, vcc
    v_lshl_add_u32 v98, v98, 2, s3
    s_mov_b64 exec, vcc
    ds_write_b32 v98, v90
    s_mov_b64 exec, -1
    s_lshl2_add_u32 s37, s41, s37
    s_cmp_lg_u64 s[58:59], 0
    s_cbranch_scc1 L2_xe97
L2_xr97:
    v_add_u32 v98, s37, v0
    v_mov_b32 v90, -1
    ds_write_b32 v98, v90
    ds_read2st64_b32 v[40:41], v0 offset0:0 offset1:1
    ds_read2st64_b32 v[42:43], v0 offset0:2 offset1:3
    s_sub_u32 s3, s37, 768
    s_cmp_gt_u32 s3, 256
    s_cbranch_scc1 L2_xf97
L2_xg97:
    s_setprio 2
    ds_write_addtid_b32 v124 offset:34816
    ds_write_addtid_b32 v125 offset:35072
    ds_write_addtid_b32 v126 offset:35328
    ds_write_addtid_b32 v127 offset:35584
    s_add_u32 s3, s40, 4096
    buffer_load_dwordx4 v[124:127], v3, s[16:19], s3 offen
    s_waitcnt lgkmcnt(14)
    v_cmp_ne_u64 s[50:51], v[72:73], v[68:69]
    v_cmpx_ne_u64 s[54:55], v[74:75], v[70:71]
    s_and_b64 s[82:83], s[54:55], s[80:81]
    s_cbranch_scc1 L2_c98
L2_d98:
    v_mov_b64 v[84:85], v[70:71]
    v_mov_b32 v7, v95
    v_mov_b64 v[86:87], v[74:75]
    s_or_b64 s[80:81], s[80:81], s[54:55]
    s_mov_b64 exec, s[50:51]
    s_and_b64 s[82:83], s[50:51], s[80:81]
    s_cbranch_scc1 L2_c99
L2_d99:
    v_mov_b64 v[84:85], v[68:69]
    v_mov_b32 v7, v94
    v_mov_b64 v[86:87], v[72:73]
    s_mov_b64 exec, -1
    s_or_b64 s[80:81], s[80:81], s[50:51]
    ds_read_b64 v[70:71], v93 offset:65408
    s_and_b64 exec, s[84:85], s[80:81]
    v_mfma_f32_4x4x4_16b_bf16 v[76:79], v[12:13], v[84:85], 0
    v_mov_b32 v92, v7
    s_andn2_b64 s[80:81], s[80:81], s[84:85]
    v_mfma_f32_4x4x4_16b_bf16 v[76:79], v[10:11], v[86:87], v[76:79]
    s_mov_b64 exec, -1
    ds_read_b64 v[68:69], v92 offset:65408
    s_setprio 1
    s_waitcnt vmcnt(10)
    s_mov_b32 m0, s38
    s_nop 0
    ds_write_addtid_b32 v108 offset:0
    ds_write_addtid_b32 v109 offset:256
    ds_write_addtid_b32 v110 offset:512
    ds_write_addtid_b32 v111 offset:768
    s_waitcnt lgkmcnt(4)
    v_mfma_f32_4x4x4_16b_bf16 v[80:83], v[10:11], v[70:71], v[80:83]
    v_mfma_f32_4x4x4_16b_bf16 v[76:79], v[10:11], v[68:69], v[76:79]
    v_and_b32 v46, 0x40000000, v39
    v_bitop3_b32 v94, v36, v5, v46 bitop3:0xea
    v_and_b32 v46, 0x80000000, v39
    v_bitop3_b32 v95, v37, v5, v46 bitop3:0xea
    v_perm_b32 v15, v37, v38, s47
    v_bitop3_b32 v46, v37, 0.5, -0.5 bitop3:0xa8
    v_perm_b32 v14, v36, v38, s46
    v_bitop3_b32 v47, v36, 0.5, -0.5 bitop3:0xa8
    v_cvt_pk_bf16_f32 v80, v80, v81
    v_cvt_pk_bf16_f32 v81, v82, v83
    ds_wrxchg_rtn_b64 v[74:75], v93, v[80:81] offset:65408
    v_cvt_pk_bf16_f32 v76, v76, v77
    v_cvt_pk_bf16_f32 v77, v78, v79
    ds_wrxchg_rtn_b64 v[72:73], v92, v[76:77] offset:65408
    v_and_b32 v88, 0x0fffffff, v44
    v_mov_b32 v39, v44
    buffer_load_dwordx2 v[34:35], v88, s[8:11], 0 offen
    buffer_load_dwordx3 v[36:38], v88, s[8:11], 0 offen offset:8
    s_setprio 0
    s_waitcnt vmcnt(11)
    ds_write_addtid_b32 v112 offset:1024
    ds_write_addtid_b32 v113 offset:1280
    ds_write_addtid_b32 v114 offset:1536
    ds_write_addtid_b32 v115 offset:1792
    v_mfma_f32_4x4x4_16b_bf16 v[80:83], v[8:9], v[106:107], 0
    v_mfma_f32_4x4x4_16b_bf16 v[76:79], v[8:9], v[104:105], 0
    v_bitop3_b32 v15, v6, v15, v46 bitop3:0xca
    v_bitop3_b32 v14, v6, v14, v47 bitop3:0xca
    s_nop 1
    v_pk_mul_f32 v[80:81], v[80:81], v[14:15] op_sel:[0,1] op_sel_hi:[1,1]
    v_pk_mul_f32 v[82:83], v[82:83], v[14:15] op_sel:[0,1] op_sel_hi:[1,1]
    v_pk_mul_f32 v[76:77], v[76:77], v[14:15] op_sel:[0,0] op_sel_hi:[1,0]
    v_pk_mul_f32 v[78:79], v[78:79], v[14:15] op_sel:[0,0] op_sel_hi:[1,0]
    s_add_u32 s42, s42, 1
    s_waitcnt lgkmcnt(0)
    s_barrier
    s_bitcmp1_b32 s36, s42
    s_cbranch_scc1 L2_slow
L2_ret5:
    s_setprio 3
    buffer_load_dwordx4 v[108:111], v3, s[16:19], s40 offen offset:0
    v_cmp_ne_u64 s[50:51], v[72:73], v[68:69]
    v_cmpx_ne_u64 s[54:55], v[74:75], v[70:71]
    s_and_b64 s[82:83], s[54:55], s[80:81]
    s_cbranch_scc1 L2_c100
L2_d100:
    v_mov_b64 v[84:85], v[70:71]
    v_mov_b32 v7, v93
    v_mov_b64 v[86:87], v[74:75]
    s_or_b64 s[80:81], s[80:81], s[54:55]
    s_mov_b64 exec, s[50:51]
    s_and_b64 s[82:83], s[50:51], s[80:81]
    s_cbranch_scc1 L2_c101
L2_d101:
    v_mov_b64 v[84:85], v[68:69]
    v_mov_b32 v7, v92
    v_mov_b64 v[86:87], v[72:73]
    s_mov_b64 exec, -1
    s_or_b64 s[80:81], s[80:81], s[50:51]
    ds_read_b64 v[70:71], v95 offset:65408
    ds_read_b64 v[68:69], v94 offset:65408
    s_waitcnt vmcnt(10)
    v_and_b32 v46, 0x20000000, v21
    v_lshrrev_b32 v47, 14, v17
    v_bitop3_b32 v47, v47, v5, v46 bitop3:0xea
    ds_read_b64 v[102:103], v47
    v_bitop3_b32 v93, v17, v5, v46 bitop3:0xea
    v_and_b32 v46, 0x10000000, v21
    v_lshrrev_b32 v47, 14, v16
    v_bitop3_b32 v47, v47, v5, v46 bitop3:0xea
    ds_read_b64 v[100:101], v47
    v_bitop3_b32 v92, v16, v5, v46 bitop3:0xea
    s_waitcnt lgkmcnt(2)
    v_mfma_f32_4x4x4_16b_bf16 v[80:83], v[10:11], v[70:71], v[80:83]
    v_mfma_f32_4x4x4_16b_bf16 v[76:79], v[10:11], v[68:69], v[76:79]
    v_perm_b32 v15, v17, v20, s45
    v_bitop3_b32 v46, v17, 0.5, -0.5 bitop3:0xa8
    v_perm_b32 v14, v16, v20, s44
    v_bitop3_b32 v47, v16, 0.5, -0.5 bitop3:0xa8
    v_cvt_pk_bf16_f32 v80, v80, v81
    v_cvt_pk_bf16_f32 v81, v82, v83
    ds_wrxchg_rtn_b64 v[74:75], v95, v[80:81] offset:65408
    v_cvt_pk_bf16_f32 v76, v76, v77
    v_cvt_pk_bf16_f32 v77, v78, v79
    ds_wrxchg_rtn_b64 v[72:73], v94, v[76:77] offset:65408
    s_waitcnt lgkmcnt(2)
    v_mfma_f32_4x4x4_16b_bf16 v[80:83], v[8:9], v[102:103], 0
    v_mfma_f32_4x4x4_16b_bf16 v[76:79], v[8:9], v[100:101], 0
    v_bitop3_b32 v15, v6, v15, v46 bitop3:0xca
    v_bitop3_b32 v14, v6, v14, v47 bitop3:0xca
    v_cmp_lt_u32 s[84:85], v5, v92
    s_nop 0
    v_pk_mul_f32 v[80:81], v[80:81], v[14:15] op_sel:[0,1] op_sel_hi:[1,1]
    v_pk_mul_f32 v[82:83], v[82:83], v[14:15] op_sel:[0,1] op_sel_hi:[1,1]
    v_pk_mul_f32 v[76:77], v[76:77], v[14:15] op_sel:[0,0] op_sel_hi:[1,0]
    v_pk_mul_f32 v[78:79], v[78:79], v[14:15] op_sel:[0,0] op_sel_hi:[1,0]
    buffer_load_dwordx4 v[112:115], v3, s[16:19], s40 offen offset:1024
    s_waitcnt lgkmcnt(0)
    v_cmp_ne_u64 s[50:51], v[72:73], v[68:69]
    v_cmpx_ne_u64 s[54:55], v[74:75], v[70:71]
    s_and_b64 s[82:83], s[54:55], s[80:81]
    s_cbranch_scc1 L2_c102
L2_d102:
    v_mov_b64 v[84:85], v[70:71]
    v_mov_b32 v7, v95
    v_mov_b64 v[86:87], v[74:75]
    s_or_b64 s[80:81], s[80:81], s[54:55]
    s_mov_b64 exec, s[50:51]
    s_and_b64 s[82:83], s[50:51], s[80:81]
    s_cbranch_scc1 L2_c103
L2_d103:
    v_mov_b64 v[84:85], v[68:69]
    v_mov_b32 v7, v94
    v_mov_b64 v[86:87], v[72:73]
    s_mov_b64 exec, -1
    s_or_b64 s[80:81], s[80:81], s[50:51]
    ds_read_b64 v[70:71], v93 offset:65408
    s_and_b64 exec, s[84:85], s[80:81]
    v_mfma_f32_4x4x4_16b_bf16 v[76:79], v[12:13], v[84:85], 0
    v_mov_b32 v92, v7
    s_andn2_b64 s[80:81], s[80:81], s[84:85]
    v_mfma_f32_4x4x4_16b_bf16 v[76:79], v[10:11], v[86:87], v[76:79]
    s_mov_b64 exec, -1
    ds_read_b64 v[68:69], v92 offset:65408
    v_and_b32 v46, 0x80000000, v21
    v_lshrrev_b32 v47, 14, v19
    v_bitop3_b32 v47, v47, v5, v46 bitop3:0xea
    ds_read_b64 v[106:107], v47
    v_bitop3_b32 v95, v19, v5, v46 bitop3:0xea
    v_and_b32 v46, 0x40000000, v21
    v_lshrrev_b32 v47, 14, v18
    v_bitop3_b32 v47, v47, v5, v46 bitop3:0xea
    ds_read_b64 v[104:105], v47
    v_bitop3_b32 v94, v18, v5, v46 bitop3:0xea
    s_waitcnt lgkmcnt(2)
    v_mfma_f32_4x4x4_16b_bf16 v[80:83], v[10:11], v[70:71], v[80:83]
    v_mfma_f32_4x4x4_16b_bf16 v[76:79], v[10:11], v[68:69], v[76:79]
    v_perm_b32 v15, v19, v20, s47
    v_bitop3_b32 v46, v19, 0.5, -0.5 bitop3:0xa8
    v_perm_b32 v14, v18, v20, s46
    v_bitop3_b32 v47, v18, 0.5, -0.5 bitop3:0xa8
    v_cvt_pk_bf16_f32 v80, v80, v81
    v_cvt_pk_bf16_f32 v81, v82, v83
    ds_wrxchg_rtn_b64 v[74:75], v93, v[80:81] offset:65408
    v_cvt_pk_bf16_f32 v76, v76, v77
    v_cvt_pk_bf16_f32 v77, v78, v79
    ds_wrxchg_rtn_b64 v[72:73], v92, v[76:77] offset:65408
    v_and_b32 v88, 0x0fffffff, v40
    v_mov_b32 v21, v40
    buffer_load_dwordx2 v[16:17], v88, s[8:11], 0 offen
    buffer_load_dwordx3 v[18:20], v88, s[8:11], 0 offen offset:8
    s_setprio 2
    s_waitcnt lgkmcnt(2)
    v_mfma_f32_4x4x4_16b_bf16 v[80:83], v[8:9], v[106:107], 0
    v_mfma_f32_4x4x4_16b_bf16 v[76:79], v[8:9], v[104:105], 0
    v_bitop3_b32 v15, v6, v15, v46 bitop3:0xca
    v_bitop3_b32 v14, v6, v14, v47 bitop3:0xca
    s_nop 1
    v_pk_mul_f32 v[80:81], v[80:81], v[14:15] op_sel:[0,1] op_sel_hi:[1,1]
    v_pk_mul_f32 v[82:83], v[82:83], v[14:15] op_sel:[0,1] op_sel_hi:[1,1]
    v_pk_mul_f32 v[76:77], v[76:77], v[14:15] op_sel:[0,0] op_sel_hi:[1,0]
    v_pk_mul_f32 v[78:79], v[78:79], v[14:15] op_sel:[0,0] op_sel_hi:[1,0]
    v_sub_u16 v88, v62, v54
    v_and_b32 v89, 3, v54
    v_add3_u32 v99, v88, v89, 3
    v_and_b32 v99, -4, v99
    v_max_u32 v99, 4, v99
    v_and_b32 v97, 0xfffc, v54
    v_bfm_b32 v96, v88, v89
    v_add_u32_dpp v91, v99, v99 row_shr:1 row_mask:0xf bank_mask:0xf bound_ctrl:1
    v_mad_u32_u24 v97, v97, 5, v2
    v_cmp_lt_u32 vcc, 16, v99
    v_add_u32_dpp v91, v91, v91 row_shr:2 row_mask:0xf bank_mask:0xf bound_ctrl:1
    v_sub_u32 v98, s38, v99
    v_lshrrev_b64 v[54:55], 16, v[54:55]
    v_add_u32_dpp v91, v91, v91 row_shr:4 row_mask:0xf bank_mask:0xf bound_ctrl:1
    v_lshrrev_b64 v[62:63], 16, v[62:63]
    s_mov_b32 s101, 0
    v_add_u32_dpp v91, v91, v91 row_shr:8 row_mask:0xf bank_mask:0xf bound_ctrl:1
    s_nop 1
    v_add_u32_dpp v91, v91, v91 row_bcast:15 row_mask:0xa bank_mask:0xf
    s_nop 1
    v_add_u32_dpp v91, v91, v91 row_bcast:31 row_mask:0xc bank_mask:0xf
    v_add_u32 v98, v98, v91
    v_readlane_b32 s37, v91, 63
    s_cbranch_vccnz L2_xo104
L2_xp104:
    s_waitcnt lgkmcnt(0)
    v_cmp_ne_u64 s[50:51], v[72:73], v[68:69]
    v_cmpx_ne_u64 s[54:55], v[74:75], v[70:71]
    s_and_b64 s[82:83], s[54:55], s[80:81]
    s_cbranch_scc1 L2_c105
L2_d105:
    v_mov_b64 v[84:85], v[70:71]
    v_mov_b32 v7, v93
    v_mov_b64 v[86:87], v[74:75]
    s_or_b64 s[80:81], s[80:81], s[54:55]
    s_mov_b64 exec, s[50:51]
    s_and_b64 s[82:83], s[50:51], s[80:81]
    s_cbranch_scc1 L2_c106
L2_d106:
    v_mov_b64 v[84:85], v[68:69]
    v_mov_b32 v7, v92
    v_mov_b64 v[86:87], v[72:73]
    s_mov_b64 exec, -1
    s_or_b64 s[80:81], s[80:81], s[50:51]
    ds_read_b64 v[70:71], v95 offset:65408
    ds_read_b64 v[68:69], v94 offset:65408
    s_waitcnt vmcnt(11)
    v_and_b32 v46, 0x20000000, v27
    v_lshrrev_b32 v47, 14, v23
    v_bitop3_b32 v47, v47, v5, v46 bitop3:0xea
    ds_read_b64 v[102:103], v47
    v_bitop3_b32 v93, v23, v5, v46 bitop3:0xea
    v_and_b32 v46, 0x10000000, v27
    v_lshrrev_b32 v47, 14, v22
    v_bitop3_b32 v47, v47, v5, v46 bitop3:0xea
    ds_read_b64 v[100:101], v47
    v_bitop3_b32 v92, v22, v5, v46 bitop3:0xea
    s_waitcnt lgkmcnt(2)
    v_mfma_f32_4x4x4_16b_bf16 v[80:83], v[10:11], v[70:71], v[80:83]
    v_mfma_f32_4x4x4_16b_bf16 v[76:79], v[10:11], v[68:69], v[76:79]
    v_perm_b32 v15, v23, v26, s45
    v_bitop3_b32 v46, v23, 0.5, -0.5 bitop3:0xa8
    v_perm_b32 v14, v22, v26, s44
    v_bitop3_b32 v47, v22, 0.5, -0.5 bitop3:0xa8
    v_cvt_pk_bf16_f32 v80, v80, v81
    v_cvt_pk_bf16_f32 v81, v82, v83
    ds_wrxchg_rtn_b64 v[74:75], v95, v[80:81] offset:65408
    v_cvt_pk_bf16_f32 v76, v76, v77
    v_cvt_pk_bf16_f32 v77, v78, v79
    ds_wrxchg_rtn_b64 v[72:73], v94, v[76:77] offset:65408
    s_waitcnt lgkmcnt(2)
    v_mfma_f32_4x4x4_16b_bf16 v[80:83], v[8:9], v[102:103], 0
    v_mfma_f32_4x4x4_16b_bf16 v[76:79], v[8:9], v[100:101], 0
    v_bitop3_b32 v15, v6, v15, v46 bitop3:0xca
    v_bitop3_b32 v14, v6, v14, v47 bitop3:0xca
    v_cmp_lt_u32 s[84:85], v5, v92
    s_nop 0
    v_pk_mul_f32 v[80:81], v[80:81], v[14:15] op_sel:[0,1] op_sel_hi:[1,1]
    v_pk_mul_f32 v[82:83], v[82:83], v[14:15] op_sel:[0,1] op_sel_hi:[1,1]
    v_pk_mul_f32 v[76:77], v[76:77], v[14:15] op_sel:[0,0] op_sel_hi:[1,0]
    v_pk_mul_f32 v[78:79], v[78:79], v[14:15] op_sel:[0,0] op_sel_hi:[1,0]
    s_waitcnt lgkmcnt(0)
    v_cmp_ne_u64 s[50:51], v[72:73], v[68:69]
    v_cmpx_ne_u64 s[54:55], v[74:75], v[70:71]
    s_and_b64 s[82:83], s[54:55], s[80:81]
    s_cbranch_scc1 L2_c107
L2_d107:
    v_mov_b64 v[84:85], v[70:71]
    v_mov_b32 v7, v95
    v_mov_b64 v[86:87], v[74:75]
    s_or_b64 s[80:81], s[80:81], s[54:55]
    s_mov_b64 exec, s[50:51]
    s_and_b64 s[82:83], s[50:51], s[80:81]
    s_cbranch_scc1 L2_c108
L2_d108:
    v_mov_b64 v[84:85], v[68:69]
    v_mov_b32 v7, v94
    v_mov_b64 v[86:87], v[72:73]
    s_mov_b64 exec, -1
    s_or_b64 s[80:81], s[80:81], s[50:51]
    ds_read_b64 v[70:71], v93 offset:65408
    s_and_b64 exec, s[84:85], s[80:81]
    v_mfma_f32_4x4x4_16b_bf16 v[76:79], v[12:13], v[84:85], 0
    v_mov_b32 v92, v7
    s_andn2_b64 s[80:81], s[80:81], s[84:85]
    v_mfma_f32_4x4x4_16b_bf16 v[76:79], v[10:11], v[86:87], v[76:79]
    s_mov_b64 exec, -1
    ds_read_b64 v[68:69], v92 offset:65408
    v_and_b32 v46, 0x80000000, v27
    v_lshrrev_b32 v47, 14, v25
    v_bitop3_b32 v47, v47, v5, v46 bitop3:0xea
    ds_read_b64 v[106:107], v47
    v_bitop3_b32 v95, v25, v5, v46 bitop3:0xea
    v_and_b32 v46, 0x40000000, v27
    v_lshrrev_b32 v47, 14, v24
    v_bitop3_b32 v47, v47, v5, v46 bitop3:0xea
    ds_read_b64 v[104:105], v47
    v_bitop3_b32 v94, v24, v5, v46 bitop3:0xea
    s_waitcnt lgkmcnt(2)
    v_mfma_f32_4x4x4_16b_bf16 v[80:83], v[10:11], v[70:71], v[80:83]
    v_mfma_f32_4x4x4_16b_bf16 v[76:79], v[10:11], v[68:69], v[76:79]
    v_perm_b32 v15, v25, v26, s47
    v_bitop3_b32 v46, v25, 0.5, -0.5 bitop3:0xa8
    v_perm_b32 v14, v24, v26, s46
    v_bitop3_b32 v47, v24, 0.5, -0.5 bitop3:0xa8
    v_cvt_pk_bf16_f32 v80, v80, v81
    v_cvt_pk_bf16_f32 v81, v82, v83
    ds_wrxchg_rtn_b64 v[74:75], v93, v[80:81] offset:65408
    v_cvt_pk_bf16_f32 v76, v76, v77
    v_cvt_pk_bf16_f32 v77, v78, v79
    ds_wrxchg_rtn_b64 v[72:73], v92, v[76:77] offset:65408
    v_and_b32 v88, 0x0fffffff, v41
    v_mov_b32 v27, v41
    buffer_load_dwordx2 v[22:23], v88, s[8:11], 0 offen
    buffer_load_dwordx3 v[24:26], v88, s[8:11], 0 offen offset:8
    s_setprio 1
    s_waitcnt lgkmcnt(2)
    v_mfma_f32_4x4x4_16b_bf16 v[80:83], v[8:9], v[106:107], 0
    v_mfma_f32_4x4x4_16b_bf16 v[76:79], v[8:9], v[104:105], 0
    v_bitop3_b32 v15, v6, v15, v46 bitop3:0xca
    v_bitop3_b32 v14, v6, v14, v47 bitop3:0xca
    s_nop 1
    v_pk_mul_f32 v[80:81], v[80:81], v[14:15] op_sel:[0,1] op_sel_hi:[1,1]
    v_pk_mul_f32 v[82:83], v[82:83], v[14:15] op_sel:[0,1] op_sel_hi:[1,1]
    v_pk_mul_f32 v[76:77], v[76:77], v[14:15] op_sel:[0,0] op_sel_hi:[1,0]
    v_pk_mul_f32 v[78:79], v[78:79], v[14:15] op_sel:[0,0] op_sel_hi:[1,0]
    s_waitcnt lgkmcnt(0)
    v_cmp_ne_u64 s[50:51], v[72:73], v[68:69]
    v_cmpx_ne_u64 s[54:55], v[74:75], v[70:71]
    s_and_b64 s[82:83], s[54:55], s[80:81]
    s_cbranch_scc1 L2_c109
L2_d109:
    v_mov_b64 v[84:85], v[70:71]
    v_mov_b32 v7, v93
    v_mov_b64 v[86:87], v[74:75]
    s_or_b64 s[80:81], s[80:81], s[54:55]
    s_mov_b64 exec, s[50:51]
    s_and_b64 s[82:83], s[50:51], s[80:81]
    s_cbranch_scc1 L2_c110
L2_d110:
    v_mov_b64 v[84:85], v[68:69]
    v_mov_b32 v7, v92
    v_mov_b64 v[86:87], v[72:73]
    s_mov_b64 exec, -1
    s_or_b64 s[80:81], s[80:81], s[50:51]
    ds_read_b64 v[70:71], v95 offset:65408
    ds_read_b64 v[68:69], v94 offset:65408
    s_waitcnt vmcnt(11)
    v_and_b32 v46, 0x20000000, v33
    v_lshrrev_b32 v47, 14, v29
    v_bitop3_b32 v47, v47, v5, v46 bitop3:0xea
    ds_read_b64 v[102:103], v47
    v_bitop3_b32 v93, v29, v5, v46 bitop3:0xea
    v_and_b32 v46, 0x10000000, v33
    v_lshrrev_b32 v47, 14, v28
    v_bitop3_b32 v47, v47, v5, v46 bitop3:0xea
    ds_read_b64 v[100:101], v47
    v_bitop3_b32 v92, v28, v5, v46 bitop3:0xea
    s_waitcnt lgkmcnt(2)
    v_mfma_f32_4x4x4_16b_bf16 v[80:83], v[10:11], v[70:71], v[80:83]
    v_mfma_f32_4x4x4_16b_bf16 v[76:79], v[10:11], v[68:69], v[76:79]
    v_perm_b32 v15, v29, v32, s45
    v_bitop3_b32 v46, v29, 0.5, -0.5 bitop3:0xa8
    v_perm_b32 v14, v28, v32, s44
    v_bitop3_b32 v47, v28, 0.5, -0.5 bitop3:0xa8
    v_cvt_pk_bf16_f32 v80, v80, v81
    v_cvt_pk_bf16_f32 v81, v82, v83
    ds_wrxchg_rtn_b64 v[74:75], v95, v[80:81] offset:65408
    v_cvt_pk_bf16_f32 v76, v76, v77
    v_cvt_pk_bf16_f32 v77, v78, v79
    ds_wrxchg_rtn_b64 v[72:73], v94, v[76:77] offset:65408
    s_waitcnt lgkmcnt(2)
    v_mfma_f32_4x4x4_16b_bf16 v[80:83], v[8:9], v[102:103], 0
    v_mfma_f32_4x4x4_16b_bf16 v[76:79], v[8:9], v[100:101], 0
    v_bitop3_b32 v15, v6, v15, v46 bitop3:0xca
    v_bitop3_b32 v14, v6, v14, v47 bitop3:0xca
    v_cmp_lt_u32 s[84:85], v5, v92
    s_nop 0
    v_pk_mul_f32 v[80:81], v[80:81], v[14:15] op_sel:[0,1] op_sel_hi:[1,1]
    v_pk_mul_f32 v[82:83], v[82:83], v[14:15] op_sel:[0,1] op_sel_hi:[1,1]
    v_pk_mul_f32 v[76:77], v[76:77], v[14:15] op_sel:[0,0] op_sel_hi:[1,0]
    v_pk_mul_f32 v[78:79], v[78:79], v[14:15] op_sel:[0,0] op_sel_hi:[1,0]
    s_waitcnt lgkmcnt(0)
    v_cmp_ne_u64 s[50:51], v[72:73], v[68:69]
    v_cmpx_ne_u64 s[54:55], v[74:75], v[70:71]
    s_and_b64 s[82:83], s[54:55], s[80:81]
    s_cbranch_scc1 L2_c111
L2_d111:
    v_mov_b64 v[84:85], v[70:71]
    v_mov_b32 v7, v95
    v_mov_b64 v[86:87], v[74:75]
    s_or_b64 s[80:81], s[80:81], s[54:55]
    s_mov_b64 exec, s[50:51]
    s_and_b64 s[82:83], s[50:51], s[80:81]
    s_cbranch_scc1 L2_c112
L2_d112:
    v_mov_b64 v[84:85], v[68:69]
    v_mov_b32 v7, v94
    v_mov_b64 v[86:87], v[72:73]
    s_mov_b64 exec, -1
    s_or_b64 s[80:81], s[80:81], s[50:51]
    ds_read_b64 v[70:71], v93 offset:65408
    s_and_b64 exec, s[84:85], s[80:81]
    v_mfma_f32_4x4x4_16b_bf16 v[76:79], v[12:13], v[84:85], 0
    v_mov_b32 v92, v7
    s_andn2_b64 s[80:81], s[80:81], s[84:85]
    v_mfma_f32_4x4x4_16b_bf16 v[76:79], v[10:11], v[86:87], v[76:79]
    s_mov_b64 exec, -1
    ds_read_b64 v[68:69], v92 offset:65408
    v_and_b32 v46, 0x80000000, v33
    v_lshrrev_b32 v47, 14, v31
    v_bitop3_b32 v47, v47, v5, v46 bitop3:0xea
    ds_read_b64 v[106:107], v47
    v_bitop3_b32 v95, v31, v5, v46 bitop3:0xea
    v_and_b32 v46, 0x40000000, v33
    v_lshrrev_b32 v47, 14, v30
    v_bitop3_b32 v47, v47, v5, v46 bitop3:0xea
    ds_read_b64 v[104:105], v47
    v_bitop3_b32 v94, v30, v5, v46 bitop3:0xea
    s_waitcnt lgkmcnt(2)
    v_mfma_f32_4x4x4_16b_bf16 v[80:83], v[10:11], v[70:71], v[80:83]
    v_mfma_f32_4x4x4_16b_bf16 v[76:79], v[10:11], v[68:69], v[76:79]
    v_perm_b32 v15, v31, v32, s47
    v_bitop3_b32 v46, v31, 0.5, -0.5 bitop3:0xa8
    v_perm_b32 v14, v30, v32, s46
    v_bitop3_b32 v47, v30, 0.5, -0.5 bitop3:0xa8
    v_cvt_pk_bf16_f32 v80, v80, v81
    v_cvt_pk_bf16_f32 v81, v82, v83
    ds_wrxchg_rtn_b64 v[74:75], v93, v[80:81] offset:65408
    v_cvt_pk_bf16_f32 v76, v76, v77
    v_cvt_pk_bf16_f32 v77, v78, v79
    ds_wrxchg_rtn_b64 v[72:73], v92, v[76:77] offset:65408
    v_and_b32 v88, 0x0fffffff, v42
    v_mov_b32 v33, v42
    buffer_load_dwordx2 v[28:29], v88, s[8:11], 0 offen
    buffer_load_dwordx3 v[30:32], v88, s[8:11], 0 offen offset:8
    s_setprio 0
    s_waitcnt lgkmcnt(2)
    v_mfma_f32_4x4x4_16b_bf16 v[80:83], v[8:9], v[106:107], 0
    v_mfma_f32_4x4x4_16b_bf16 v[76:79], v[8:9], v[104:105], 0
    v_bitop3_b32 v15, v6, v15, v46 bitop3:0xca
    v_bitop3_b32 v14, v6, v14, v47 bitop3:0xca
    s_nop 1
    v_pk_mul_f32 v[80:81], v[80:81], v[14:15] op_sel:[0,1] op_sel_hi:[1,1]
    v_pk_mul_f32 v[82:83], v[82:83], v[14:15] op_sel:[0,1] op_sel_hi:[1,1]
    v_pk_mul_f32 v[76:77], v[76:77], v[14:15] op_sel:[0,0] op_sel_hi:[1,0]
    v_pk_mul_f32 v[78:79], v[78:79], v[14:15] op_sel:[0,0] op_sel_hi:[1,0]
    s_add_u32 s40, s40, 0x50000
    s_waitcnt lgkmcnt(0)
    v_cmp_ne_u64 s[50:51], v[72:73], v[68:69]
    v_cmpx_ne_u64 s[54:55], v[74:75], v[70:71]
    s_and_b64 s[82:83], s[54:55], s[80:81]
    s_cbranch_scc1 L2_c113
L2_d113:
    v_mov_b64 v[84:85], v[70:71]
    v_mov_b32 v7, v93
    v_mov_b64 v[86:87], v[74:75]
    s_or_b64 s[80:81], s[80:81], s[54:55]
    s_mov_b64 exec, s[50:51]
    s_and_b64 s[82:83], s[50:51], s[80:81]
    s_cbranch_scc1 L2_c114
L2_d114:
    v_mov_b64 v[84:85], v[68:69]
    v_mov_b32 v7, v92
    v_mov_b64 v[86:87], v[72:73]
    s_mov_b64 exec, -1
    s_or_b64 s[80:81], s[80:81], s[50:51]
    ds_read_b64 v[70:71], v95 offset:65408
    ds_read_b64 v[68:69], v94 offset:65408
    s_waitcnt vmcnt(8)
    v_and_b32 v46, 0x20000000, v39
    v_lshrrev_b32 v47, 14, v35
    v_bitop3_b32 v47, v47, v5, v46 bitop3:0xea
    ds_read_b64 v[102:103], v47
    v_bitop3_b32 v93, v35, v5, v46 bitop3:0xea
    v_and_b32 v46, 0x10000000, v39
    v_lshrrev_b32 v47, 14, v34
    v_bitop3_b32 v47, v47, v5, v46 bitop3:0xea
    ds_read_b64 v[100:101], v47
    v_bitop3_b32 v92, v34, v5, v46 bitop3:0xea
    v_and_b32 v46, 0x80000000, v39
    v_lshrrev_b32 v47, 14, v37
    v_bitop3_b32 v47, v47, v5, v46 bitop3:0xea
    ds_read_b64 v[106:107], v47
    v_and_b32 v46, 0x40000000, v39
    v_lshrrev_b32 v47, 14, v36
    v_bitop3_b32 v47, v47, v5, v46 bitop3:0xea
    ds_read_b64 v[104:105], v47
    s_waitcnt lgkmcnt(4)
    v_mfma_f32_4x4x4_16b_bf16 v[80:83], v[10:11], v[70:71], v[80:83]
    v_mfma_f32_4x4x4_16b_bf16 v[76:79], v[10:11], v[68:69], v[76:79]
    v_perm_b32 v15, v35, v38, s45
    v_bitop3_b32 v46, v35, 0.5, -0.5 bitop3:0xa8
    v_perm_b32 v14, v34, v38, s44
    v_bitop3_b32 v47, v34, 0.5, -0.5 bitop3:0xa8
    v_cvt_pk_bf16_f32 v80, v80, v81
    v_cvt_pk_bf16_f32 v81, v82, v83
    ds_wrxchg_rtn_b64 v[74:75], v95, v[80:81] offset:65408
    v_cvt_pk_bf16_f32 v76, v76, v77
    v_cvt_pk_bf16_f32 v77, v78, v79
    ds_wrxchg_rtn_b64 v[72:73], v94, v[76:77] offset:65408
    s_waitcnt lgkmcnt(2)
    s_barrier
    s_setprio 3
    s_mov_b32 m0, s100
    s_nop 0
    ds_write_addtid_b32 v116 offset:32768
    ds_write_addtid_b32 v117 offset:33024
    ds_write_addtid_b32 v118 offset:33280
    ds_write_addtid_b32 v119 offset:33536
    buffer_load_dwordx4 v[116:119], v3, s[16:19], s40 offen offset:2048
    ds_write_addtid_b32 v120 offset:33792
    ds_write_addtid_b32 v121 offset:34048
    ds_write_addtid_b32 v122 offset:34304
    ds_write_addtid_b32 v123 offset:34560
    buffer_load_dwordx4 v[120:123], v3, s[16:19], s40 offen offset:3072
    v_mfma_f32_4x4x4_16b_bf16 v[80:83], v[8:9], v[102:103], 0
    v_mfma_f32_4x4x4_16b_bf16 v[76:79], v[8:9], v[100:101], 0
    v_bitop3_b32 v15, v6, v15, v46 bitop3:0xca
    v_bitop3_b32 v14, v6, v14, v47 bitop3:0xca
    v_cmp_lt_u32 s[84:85], v5, v92
    s_nop 0
    v_pk_mul_f32 v[80:81], v[80:81], v[14:15] op_sel:[0,1] op_sel_hi:[1,1]
    v_pk_mul_f32 v[82:83], v[82:83], v[14:15] op_sel:[0,1] op_sel_hi:[1,1]
    v_pk_mul_f32 v[76:77], v[76:77], v[14:15] op_sel:[0,0] op_sel_hi:[1,0]
    v_pk_mul_f32 v[78:79], v[78:79], v[14:15] op_sel:[0,0] op_sel_hi:[1,0]
    v_mov_b32 v44, v43
    s_cmp_gt_u32 s37, 1024
    s_cbranch_scc1 L2_xs115
    s_cmp_lg_u32 s101, 0
    s_cbranch_scc1 L2_xa115
L2_xb115:
    v_lshlrev_b32 v89, 16, v96
    v_add_u32 v90, 60, v97
    v_bitop3_b32 v90, v89, v45, v90 bitop3:0x6a
    ds_write_b32 v98, v90 offset:12
    v_lshlrev_b32 v89, 20, v96
    v_add_u32 v90, 40, v97
    v_bitop3_b32 v90, v89, v45, v90 bitop3:0x6a
    ds_write_b32 v98, v90 offset:8
    v_lshlrev_b32 v89, 24, v96
    v_add_u32 v90, 20, v97
    v_bitop3_b32 v90, v89, v45, v90 bitop3:0x6a
    ds_write_b32 v98, v90 offset:4
    v_lshlrev_b32 v89, 28, v96
    v_bitop3_b32 v90, v89, v45, v97 bitop3:0x6a
    ds_write_b32 v98, v90 offset:0
    v_mov_b32_dpp v91, v66 quad_perm:[1,1,1,1] row_mask:0xf bank_mask:0xf
    v_and_b32 v89, 3, v91
    v_and_b32 v97, 0xfffc, v91
    v_sub_u16_dpp v88, v66, v91 quad_perm:[3,3,3,3] row_mask:0xf bank_mask:0xf
    v_mad_u32_u24 v97, v97, 5, v4
    v_add_u32 v99, v88, v89
    v_bfm_b32 v96, v88, v89
    v_cmp_lt_u32 s[58:59], 16, v99
    v_lshlrev_b32 v89, v1, v96
    v_and_b32 v89, v45, v89
    v_cmp_ne_u32 vcc, 0, v89
    v_xor_b32 v90, v97, v89
    s_add_u32 s3, s37, s38
    v_mbcnt_lo_u32_b32 v98, vcc_lo, 0
    v_mbcnt_hi_u32_b32 v98, vcc_hi, v98
    s_bcnt1_i32_b64 s41, vcc
    v_lshl_add_u32 v98, v98, 2, s3
    s_mov_b64 exec, vcc
    ds_write_b32 v98, v90
    s_mov_b64 exec, -1
    s_lshl2_add_u32 s37, s41, s37
    s_cmp_lg_u64 s[58:59], 0
    s_cbranch_scc1 L2_xe115
L2_xr115:
    v_add_u32 v98, s37, v0
    v_mov_b32 v90, -1
    ds_write_b32 v98, v90
    ds_read2st64_b32 v[40:41], v0 offset0:0 offset1:1
    ds_read2st64_b32 v[42:43], v0 offset0:2 offset1:3
    s_sub_u32 s3, s37, 768
    s_cmp_gt_u32 s3, 256
    s_cbranch_scc1 L2_xf115
L2_xg115:
    v_lshrrev_b64 v[64:65], 16, v[64:65]
    v_lshrrev_b64 v[66:67], 16, v[66:67]
    s_setprio 2
    ds_write_addtid_b32 v124 offset:34816
    ds_write_addtid_b32 v125 offset:35072
    ds_write_addtid_b32 v126 offset:35328
    ds_write_addtid_b32 v127 offset:35584
    s_add_u32 s3, s40, 4096
    buffer_load_dwordx4 v[124:127], v3, s[16:19], s3 offen
    s_waitcnt lgkmcnt(14)
    v_cmp_ne_u64 s[50:51], v[72:73], v[68:69]
    v_cmpx_ne_u64 s[54:55], v[74:75], v[70:71]
    s_and_b64 s[82:83], s[54:55], s[80:81]
    s_cbranch_scc1 L2_c116
L2_d116:
    v_mov_b64 v[84:85], v[70:71]
    v_mov_b32 v7, v95
    v_mov_b64 v[86:87], v[74:75]
    s_or_b64 s[80:81], s[80:81], s[54:55]
    s_mov_b64 exec, s[50:51]
    s_and_b64 s[82:83], s[50:51], s[80:81]
    s_cbranch_scc1 L2_c117
L2_d117:
    v_mov_b64 v[84:85], v[68:69]
    v_mov_b32 v7, v94
    v_mov_b64 v[86:87], v[72:73]
    s_mov_b64 exec, -1
    s_or_b64 s[80:81], s[80:81], s[50:51]
    ds_read_b64 v[70:71], v93 offset:65408
    s_and_b64 exec, s[84:85], s[80:81]
    v_mfma_f32_4x4x4_16b_bf16 v[76:79], v[12:13], v[84:85], 0
    v_mov_b32 v92, v7
    s_andn2_b64 s[80:81], s[80:81], s[84:85]
    v_mfma_f32_4x4x4_16b_bf16 v[76:79], v[10:11], v[86:87], v[76:79]
    s_mov_b64 exec, -1
    ds_read_b64 v[68:69], v92 offset:65408
    s_setprio 1
    s_waitcnt vmcnt(10)
    s_mov_b32 m0, s38
    s_nop 0
    ds_write_addtid_b32 v108 offset:0
    ds_write_addtid_b32 v109 offset:256
    ds_write_addtid_b32 v110 offset:512
    ds_write_addtid_b32 v111 offset:768
    s_waitcnt lgkmcnt(4)
    v_mfma_f32_4x4x4_16b_bf16 v[80:83], v[10:11], v[70:71], v[80:83]
    v_mfma_f32_4x4x4_16b_bf16 v[76:79], v[10:11], v[68:69], v[76:79]
    v_and_b32 v46, 0x40000000, v39
    v_bitop3_b32 v94, v36, v5, v46 bitop3:0xea
    v_and_b32 v46, 0x80000000, v39
    v_bitop3_b32 v95, v37, v5, v46 bitop3:0xea
    v_perm_b32 v15, v37, v38, s47
    v_bitop3_b32 v46, v37, 0.5, -0.5 bitop3:0xa8
    v_perm_b32 v14, v36, v38, s46
    v_bitop3_b32 v47, v36, 0.5, -0.5 bitop3:0xa8
    v_cvt_pk_bf16_f32 v80, v80, v81
    v_cvt_pk_bf16_f32 v81, v82, v83
    ds_wrxchg_rtn_b64 v[74:75], v93, v[80:81] offset:65408
    v_cvt_pk_bf16_f32 v76, v76, v77
    v_cvt_pk_bf16_f32 v77, v78, v79
    ds_wrxchg_rtn_b64 v[72:73], v92, v[76:77] offset:65408
    v_and_b32 v88, 0x0fffffff, v44
    v_mov_b32 v39, v44
    buffer_load_dwordx2 v[34:35], v88, s[8:11], 0 offen
    buffer_load_dwordx3 v[36:38], v88, s[8:11], 0 offen offset:8
    s_setprio 0
    s_waitcnt vmcnt(11)
    ds_write_addtid_b32 v112 offset:1024
    ds_write_addtid_b32 v113 offset:1280
    ds_write_addtid_b32 v114 offset:1536
    ds_write_addtid_b32 v115 offset:1792
    v_mfma_f32_4x4x4_16b_bf16 v[80:83], v[8:9], v[106:107], 0
    v_mfma_f32_4x4x4_16b_bf16 v[76:79], v[8:9], v[104:105], 0
    v_bitop3_b32 v15, v6, v15, v46 bitop3:0xca
    v_bitop3_b32 v14, v6, v14, v47 bitop3:0xca
    s_nop 1
    v_pk_mul_f32 v[80:81], v[80:81], v[14:15] op_sel:[0,1] op_sel_hi:[1,1]
    v_pk_mul_f32 v[82:83], v[82:83], v[14:15] op_sel:[0,1] op_sel_hi:[1,1]
    v_pk_mul_f32 v[76:77], v[76:77], v[14:15] op_sel:[0,0] op_sel_hi:[1,0]
    v_pk_mul_f32 v[78:79], v[78:79], v[14:15] op_sel:[0,0] op_sel_hi:[1,0]
    s_add_u32 s42, s42, 1
    s_waitcnt lgkmcnt(0)
    s_cmp_lg_u32 s42, 14
    s_cbranch_scc1 L2_loop
    s_barrier
    s_bitcmp1_b32 s36, s42
    s_cbranch_scc1 L2_slow
L2_ret6:
    s_setprio 3
    buffer_load_dwordx4 v[108:111], v3, s[16:19], s40 offen offset:0
    v_cmp_ne_u64 s[50:51], v[72:73], v[68:69]
    v_cmpx_ne_u64 s[54:55], v[74:75], v[70:71]
    s_and_b64 s[82:83], s[54:55], s[80:81]
    s_cbranch_scc1 L2_c118
L2_d118:
    v_mov_b64 v[84:85], v[70:71]
    v_mov_b32 v7, v93
    v_mov_b64 v[86:87], v[74:75]
    s_or_b64 s[80:81], s[80:81], s[54:55]
    s_mov_b64 exec, s[50:51]
    s_and_b64 s[82:83], s[50:51], s[80:81]
    s_cbranch_scc1 L2_c119
L2_d119:
    v_mov_b64 v[84:85], v[68:69]
    v_mov_b32 v7, v92
    v_mov_b64 v[86:87], v[72:73]
    s_mov_b64 exec, -1
    s_or_b64 s[80:81], s[80:81], s[50:51]
    ds_read_b64 v[70:71], v95 offset:65408
    ds_read_b64 v[68:69], v94 offset:65408
    s_waitcnt vmcnt(10)
    v_and_b32 v46, 0x20000000, v21
    v_lshrrev_b32 v47, 14, v17
    v_bitop3_b32 v47, v47, v5, v46 bitop3:0xea
    ds_read_b64 v[102:103], v47
    v_bitop3_b32 v93, v17, v5, v46 bitop3:0xea
    v_and_b32 v46, 0x10000000, v21
    v_lshrrev_b32 v47, 14, v16
    v_bitop3_b32 v47, v47, v5, v46 bitop3:0xea
    ds_read_b64 v[100:101], v47
    v_bitop3_b32 v92, v16, v5, v46 bitop3:0xea
    s_waitcnt lgkmcnt(2)
    v_mfma_f32_4x4x4_16b_bf16 v[80:83], v[10:11], v[70:71], v[80:83]
    v_mfma_f32_4x4x4_16b_bf16 v[76:79], v[10:11], v[68:69], v[76:79]
    v_perm_b32 v15, v17, v20, s45
    v_bitop3_b32 v46, v17, 0.5, -0.5 bitop3:0xa8
    v_perm_b32 v14, v16, v20, s44
    v_bitop3_b32 v47, v16, 0.5, -0.5 bitop3:0xa8
    v_cvt_pk_bf16_f32 v80, v80, v81
    v_cvt_pk_bf16_f32 v81, v82, v83
    ds_wrxchg_rtn_b64 v[74:75], v95, v[80:81] offset:65408
    v_cvt_pk_bf16_f32 v76, v76, v77
    v_cvt_pk_bf16_f32 v77, v78, v79
    ds_wrxchg_rtn_b64 v[72:73], v94, v[76:77] offset:65408
    s_waitcnt lgkmcnt(2)
    v_mfma_f32_4x4x4_16b_bf16 v[80:83], v[8:9], v[102:103], 0
    v_mfma_f32_4x4x4_16b_bf16 v[76:79], v[8:9], v[100:101], 0
    v_bitop3_b32 v15, v6, v15, v46 bitop3:0xca
    v_bitop3_b32 v14, v6, v14, v47 bitop3:0xca
    v_cmp_lt_u32 s[84:85], v5, v92
    s_nop 0
    v_pk_mul_f32 v[80:81], v[80:81], v[14:15] op_sel:[0,1] op_sel_hi:[1,1]
    v_pk_mul_f32 v[82:83], v[82:83], v[14:15] op_sel:[0,1] op_sel_hi:[1,1]
    v_pk_mul_f32 v[76:77], v[76:77], v[14:15] op_sel:[0,0] op_sel_hi:[1,0]
    v_pk_mul_f32 v[78:79], v[78:79], v[14:15] op_sel:[0,0] op_sel_hi:[1,0]
    buffer_load_dwordx4 v[112:115], v3, s[16:19], s40 offen offset:1024
    s_waitcnt lgkmcnt(0)
    v_cmp_ne_u64 s[50:51], v[72:73], v[68:69]
    v_cmpx_ne_u64 s[54:55], v[74:75], v[70:71]
    s_and_b64 s[82:83], s[54:55], s[80:81]
    s_cbranch_scc1 L2_c120
L2_d120:
    v_mov_b64 v[84:85], v[70:71]
    v_mov_b32 v7, v95
    v_mov_b64 v[86:87], v[74:75]
    s_or_b64 s[80:81], s[80:81], s[54:55]
    s_mov_b64 exec, s[50:51]
    s_and_b64 s[82:83], s[50:51], s[80:81]
    s_cbranch_scc1 L2_c121
L2_d121:
    v_mov_b64 v[84:85], v[68:69]
    v_mov_b32 v7, v94
    v_mov_b64 v[86:87], v[72:73]
    s_mov_b64 exec, -1
    s_or_b64 s[80:81], s[80:81], s[50:51]
    ds_read_b64 v[70:71], v93 offset:65408
    s_and_b64 exec, s[84:85], s[80:81]
    v_mfma_f32_4x4x4_16b_bf16 v[76:79], v[12:13], v[84:85], 0
    v_mov_b32 v92, v7
    s_andn2_b64 s[80:81], s[80:81], s[84:85]
    v_mfma_f32_4x4x4_16b_bf16 v[76:79], v[10:11], v[86:87], v[76:79]
    s_mov_b64 exec, -1
    ds_read_b64 v[68:69], v92 offset:65408
    v_and_b32 v46, 0x80000000, v21
    v_lshrrev_b32 v47, 14, v19
    v_bitop3_b32 v47, v47, v5, v46 bitop3:0xea
    ds_read_b64 v[106:107], v47
    v_bitop3_b32 v95, v19, v5, v46 bitop3:0xea
    v_and_b32 v46, 0x40000000, v21
    v_lshrrev_b32 v47, 14, v18
    v_bitop3_b32 v47, v47, v5, v46 bitop3:0xea
    ds_read_b64 v[104:105], v47
    v_bitop3_b32 v94, v18, v5, v46 bitop3:0xea
    s_waitcnt lgkmcnt(2)
    v_mfma_f32_4x4x4_16b_bf16 v[80:83], v[10:11], v[70:71], v[80:83]
    v_mfma_f32_4x4x4_16b_bf16 v[76:79], v[10:11], v[68:69], v[76:79]
    v_perm_b32 v15, v19, v20, s47
    v_bitop3_b32 v46, v19, 0.5, -0.5 bitop3:0xa8
    v_perm_b32 v14, v18, v20, s46
    v_bitop3_b32 v47, v18, 0.5, -0.5 bitop3:0xa8
    v_cvt_pk_bf16_f32 v80, v80, v81
    v_cvt_pk_bf16_f32 v81, v82, v83
    ds_wrxchg_rtn_b64 v[74:75], v93, v[80:81] offset:65408
    v_cvt_pk_bf16_f32 v76, v76, v77
    v_cvt_pk_bf16_f32 v77, v78, v79
    ds_wrxchg_rtn_b64 v[72:73], v92, v[76:77] offset:65408
    v_and_b32 v88, 0x0fffffff, v40
    v_mov_b32 v21, v40
    buffer_load_dwordx2 v[16:17], v88, s[8:11], 0 offen
    buffer_load_dwordx3 v[18:20], v88, s[8:11], 0 offen offset:8
    s_setprio 2
    s_waitcnt lgkmcnt(2)
    v_mfma_f32_4x4x4_16b_bf16 v[80:83], v[8:9], v[106:107], 0
    v_mfma_f32_4x4x4_16b_bf16 v[76:79], v[8:9], v[104:105], 0
    v_bitop3_b32 v15, v6, v15, v46 bitop3:0xca
    v_bitop3_b32 v14, v6, v14, v47 bitop3:0xca
    s_nop 1
    v_pk_mul_f32 v[80:81], v[80:81], v[14:15] op_sel:[0,1] op_sel_hi:[1,1]
    v_pk_mul_f32 v[82:83], v[82:83], v[14:15] op_sel:[0,1] op_sel_hi:[1,1]
    v_pk_mul_f32 v[76:77], v[76:77], v[14:15] op_sel:[0,0] op_sel_hi:[1,0]
    v_pk_mul_f32 v[78:79], v[78:79], v[14:15] op_sel:[0,0] op_sel_hi:[1,0]
    s_waitcnt lgkmcnt(0)
    v_cmp_ne_u64 s[50:51], v[72:73], v[68:69]
    v_cmpx_ne_u64 s[54:55], v[74:75], v[70:71]
    s_and_b64 s[82:83], s[54:55], s[80:81]
    s_cbranch_scc1 L2_c122
L2_d122:
    v_mov_b64 v[84:85], v[70:71]
    v_mov_b32 v7, v93
    v_mov_b64 v[86:87], v[74:75]
    s_or_b64 s[80:81], s[80:81], s[54:55]
    s_mov_b64 exec, s[50:51]
    s_and_b64 s[82:83], s[50:51], s[80:81]
    s_cbranch_scc1 L2_c123
L2_d123:
    v_mov_b64 v[84:85], v[68:69]
    v_mov_b32 v7, v92
    v_mov_b64 v[86:87], v[72:73]
    s_mov_b64 exec, -1
    s_or_b64 s[80:81], s[80:81], s[50:51]
    ds_read_b64 v[70:71], v95 offset:65408
    ds_read_b64 v[68:69], v94 offset:65408
    s_waitcnt vmcnt(11)
    v_and_b32 v46, 0x20000000, v27
    v_lshrrev_b32 v47, 14, v23
    v_bitop3_b32 v47, v47, v5, v46 bitop3:0xea
    ds_read_b64 v[102:103], v47
    v_bitop3_b32 v93, v23, v5, v46 bitop3:0xea
    v_and_b32 v46, 0x10000000, v27
    v_lshrrev_b32 v47, 14, v22
    v_bitop3_b32 v47, v47, v5, v46 bitop3:0xea
    ds_read_b64 v[100:101], v47
    v_bitop3_b32 v92, v22, v5, v46 bitop3:0xea
    s_waitcnt lgkmcnt(2)
    v_mfma_f32_4x4x4_16b_bf16 v[80:83], v[10:11], v[70:71], v[80:83]
    v_mfma_f32_4x4x4_16b_bf16 v[76:79], v[10:11], v[68:69], v[76:79]
    v_perm_b32 v15, v23, v26, s45
    v_bitop3_b32 v46, v23, 0.5, -0.5 bitop3:0xa8
    v_perm_b32 v14, v22, v26, s44
    v_bitop3_b32 v47, v22, 0.5, -0.5 bitop3:0xa8
    v_cvt_pk_bf16_f32 v80, v80, v81
    v_cvt_pk_bf16_f32 v81, v82, v83
    ds_wrxchg_rtn_b64 v[74:75], v95, v[80:81] offset:65408
    v_cvt_pk_bf16_f32 v76, v76, v77
    v_cvt_pk_bf16_f32 v77, v78, v79
    ds_wrxchg_rtn_b64 v[72:73], v94, v[76:77] offset:65408
    s_waitcnt lgkmcnt(2)
    v_mfma_f32_4x4x4_16b_bf16 v[80:83], v[8:9], v[102:103], 0
    v_mfma_f32_4x4x4_16b_bf16 v[76:79], v[8:9], v[100:101], 0
    v_bitop3_b32 v15, v6, v15, v46 bitop3:0xca
    v_bitop3_b32 v14, v6, v14, v47 bitop3:0xca
    v_cmp_lt_u32 s[84:85], v5, v92
    s_nop 0
    v_pk_mul_f32 v[80:81], v[80:81], v[14:15] op_sel:[0,1] op_sel_hi:[1,1]
    v_pk_mul_f32 v[82:83], v[82:83], v[14:15] op_sel:[0,1] op_sel_hi:[1,1]
    v_pk_mul_f32 v[76:77], v[76:77], v[14:15] op_sel:[0,0] op_sel_hi:[1,0]
    v_pk_mul_f32 v[78:79], v[78:79], v[14:15] op_sel:[0,0] op_sel_hi:[1,0]
    s_waitcnt lgkmcnt(0)
    v_cmp_ne_u64 s[50:51], v[72:73], v[68:69]
    v_cmpx_ne_u64 s[54:55], v[74:75], v[70:71]
    s_and_b64 s[82:83], s[54:55], s[80:81]
    s_cbranch_scc1 L2_c124
L2_d124:
    v_mov_b64 v[84:85], v[70:71]
    v_mov_b32 v7, v95
    v_mov_b64 v[86:87], v[74:75]
    s_or_b64 s[80:81], s[80:81], s[54:55]
    s_mov_b64 exec, s[50:51]
    s_and_b64 s[82:83], s[50:51], s[80:81]
    s_cbranch_scc1 L2_c125
L2_d125:
    v_mov_b64 v[84:85], v[68:69]
    v_mov_b32 v7, v94
    v_mov_b64 v[86:87], v[72:73]
    s_mov_b64 exec, -1
    s_or_b64 s[80:81], s[80:81], s[50:51]
    ds_read_b64 v[70:71], v93 offset:65408
    s_and_b64 exec, s[84:85], s[80:81]
    v_mfma_f32_4x4x4_16b_bf16 v[76:79], v[12:13], v[84:85], 0
    v_mov_b32 v92, v7
    s_andn2_b64 s[80:81], s[80:81], s[84:85]
    v_mfma_f32_4x4x4_16b_bf16 v[76:79], v[10:11], v[86:87], v[76:79]
    s_mov_b64 exec, -1
    ds_read_b64 v[68:69], v92 offset:65408
    v_and_b32 v46, 0x80000000, v27
    v_lshrrev_b32 v47, 14, v25
    v_bitop3_b32 v47, v47, v5, v46 bitop3:0xea
    ds_read_b64 v[106:107], v47
    v_bitop3_b32 v95, v25, v5, v46 bitop3:0xea
    v_and_b32 v46, 0x40000000, v27
    v_lshrrev_b32 v47, 14, v24
    v_bitop3_b32 v47, v47, v5, v46 bitop3:0xea
    ds_read_b64 v[104:105], v47
    v_bitop3_b32 v94, v24, v5, v46 bitop3:0xea
    s_waitcnt lgkmcnt(2)
    v_mfma_f32_4x4x4_16b_bf16 v[80:83], v[10:11], v[70:71], v[80:83]
    v_mfma_f32_4x4x4_16b_bf16 v[76:79], v[10:11], v[68:69], v[76:79]
    v_perm_b32 v15, v25, v26, s47
    v_bitop3_b32 v46, v25, 0.5, -0.5 bitop3:0xa8
    v_perm_b32 v14, v24, v26, s46
    v_bitop3_b32 v47, v24, 0.5, -0.5 bitop3:0xa8
    v_cvt_pk_bf16_f32 v80, v80, v81
    v_cvt_pk_bf16_f32 v81, v82, v83
    ds_wrxchg_rtn_b64 v[74:75], v93, v[80:81] offset:65408
    v_cvt_pk_bf16_f32 v76, v76, v77
    v_cvt_pk_bf16_f32 v77, v78, v79
    ds_wrxchg_rtn_b64 v[72:73], v92, v[76:77] offset:65408
    v_and_b32 v88, 0x0fffffff, v41
    v_mov_b32 v27, v41
    buffer_load_dwordx2 v[22:23], v88, s[8:11], 0 offen
    buffer_load_dwordx3 v[24:26], v88, s[8:11], 0 offen offset:8
    s_setprio 1
    s_waitcnt lgkmcnt(2)
    v_mfma_f32_4x4x4_16b_bf16 v[80:83], v[8:9], v[106:107], 0
    v_mfma_f32_4x4x4_16b_bf16 v[76:79], v[8:9], v[104:105], 0
    v_bitop3_b32 v15, v6, v15, v46 bitop3:0xca
    v_bitop3_b32 v14, v6, v14, v47 bitop3:0xca
    s_nop 1
    v_pk_mul_f32 v[80:81], v[80:81], v[14:15] op_sel:[0,1] op_sel_hi:[1,1]
    v_pk_mul_f32 v[82:83], v[82:83], v[14:15] op_sel:[0,1] op_sel_hi:[1,1]
    v_pk_mul_f32 v[76:77], v[76:77], v[14:15] op_sel:[0,0] op_sel_hi:[1,0]
    v_pk_mul_f32 v[78:79], v[78:79], v[14:15] op_sel:[0,0] op_sel_hi:[1,0]
    s_waitcnt lgkmcnt(0)
    v_cmp_ne_u64 s[50:51], v[72:73], v[68:69]
    v_cmpx_ne_u64 s[54:55], v[74:75], v[70:71]
    s_and_b64 s[82:83], s[54:55], s[80:81]
    s_cbranch_scc1 L2_c126
L2_d126:
    v_mov_b64 v[84:85], v[70:71]
    v_mov_b32 v7, v93
    v_mov_b64 v[86:87], v[74:75]
    s_or_b64 s[80:81], s[80:81], s[54:55]
    s_mov_b64 exec, s[50:51]
    s_and_b64 s[82:83], s[50:51], s[80:81]
    s_cbranch_scc1 L2_c127
L2_d127:
    v_mov_b64 v[84:85], v[68:69]
    v_mov_b32 v7, v92
    v_mov_b64 v[86:87], v[72:73]
    s_mov_b64 exec, -1
    s_or_b64 s[80:81], s[80:81], s[50:51]
    ds_read_b64 v[70:71], v95 offset:65408
    ds_read_b64 v[68:69], v94 offset:65408
    s_waitcnt vmcnt(11)
    v_and_b32 v46, 0x20000000, v33
    v_lshrrev_b32 v47, 14, v29
    v_bitop3_b32 v47, v47, v5, v46 bitop3:0xea
    ds_read_b64 v[102:103], v47
    v_bitop3_b32 v93, v29, v5, v46 bitop3:0xea
    v_and_b32 v46, 0x10000000, v33
    v_lshrrev_b32 v47, 14, v28
    v_bitop3_b32 v47, v47, v5, v46 bitop3:0xea
    ds_read_b64 v[100:101], v47
    v_bitop3_b32 v92, v28, v5, v46 bitop3:0xea
    s_waitcnt lgkmcnt(2)
    v_mfma_f32_4x4x4_16b_bf16 v[80:83], v[10:11], v[70:71], v[80:83]
    v_mfma_f32_4x4x4_16b_bf16 v[76:79], v[10:11], v[68:69], v[76:79]
    v_perm_b32 v15, v29, v32, s45
    v_bitop3_b32 v46, v29, 0.5, -0.5 bitop3:0xa8
    v_perm_b32 v14, v28, v32, s44
    v_bitop3_b32 v47, v28, 0.5, -0.5 bitop3:0xa8
    v_cvt_pk_bf16_f32 v80, v80, v81
    v_cvt_pk_bf16_f32 v81, v82, v83
    ds_wrxchg_rtn_b64 v[74:75], v95, v[80:81] offset:65408
    v_cvt_pk_bf16_f32 v76, v76, v77
    v_cvt_pk_bf16_f32 v77, v78, v79
    ds_wrxchg_rtn_b64 v[72:73], v94, v[76:77] offset:65408
    s_waitcnt lgkmcnt(2)
    v_mfma_f32_4x4x4_16b_bf16 v[80:83], v[8:9], v[102:103], 0
    v_mfma_f32_4x4x4_16b_bf16 v[76:79], v[8:9], v[100:101], 0
    v_bitop3_b32 v15, v6, v15, v46 bitop3:0xca
    v_bitop3_b32 v14, v6, v14, v47 bitop3:0xca
    v_cmp_lt_u32 s[84:85], v5, v92
    s_nop 0
    v_pk_mul_f32 v[80:81], v[80:81], v[14:15] op_sel:[0,1] op_sel_hi:[1,1]
    v_pk_mul_f32 v[82:83], v[82:83], v[14:15] op_sel:[0,1] op_sel_hi:[1,1]
    v_pk_mul_f32 v[76:77], v[76:77], v[14:15] op_sel:[0,0] op_sel_hi:[1,0]
    v_pk_mul_f32 v[78:79], v[78:79], v[14:15] op_sel:[0,0] op_sel_hi:[1,0]
    s_waitcnt lgkmcnt(0)
    v_cmp_ne_u64 s[50:51], v[72:73], v[68:69]
    v_cmpx_ne_u64 s[54:55], v[74:75], v[70:71]
    s_and_b64 s[82:83], s[54:55], s[80:81]
    s_cbranch_scc1 L2_c128
L2_d128:
    v_mov_b64 v[84:85], v[70:71]
    v_mov_b32 v7, v95
    v_mov_b64 v[86:87], v[74:75]
    s_or_b64 s[80:81], s[80:81], s[54:55]
    s_mov_b64 exec, s[50:51]
    s_and_b64 s[82:83], s[50:51], s[80:81]
    s_cbranch_scc1 L2_c129
L2_d129:
    v_mov_b64 v[84:85], v[68:69]
    v_mov_b32 v7, v94
    v_mov_b64 v[86:87], v[72:73]
    s_mov_b64 exec, -1
    s_or_b64 s[80:81], s[80:81], s[50:51]
    ds_read_b64 v[70:71], v93 offset:65408
    s_and_b64 exec, s[84:85], s[80:81]
    v_mfma_f32_4x4x4_16b_bf16 v[76:79], v[12:13], v[84:85], 0
    v_mov_b32 v92, v7
    s_andn2_b64 s[80:81], s[80:81], s[84:85]
    v_mfma_f32_4x4x4_16b_bf16 v[76:79], v[10:11], v[86:87], v[76:79]
    s_mov_b64 exec, -1
    ds_read_b64 v[68:69], v92 offset:65408
    v_and_b32 v46, 0x80000000, v33
    v_lshrrev_b32 v47, 14, v31
    v_bitop3_b32 v47, v47, v5, v46 bitop3:0xea
    ds_read_b64 v[106:107], v47
    v_bitop3_b32 v95, v31, v5, v46 bitop3:0xea
    v_and_b32 v46, 0x40000000, v33
    v_lshrrev_b32 v47, 14, v30
    v_bitop3_b32 v47, v47, v5, v46 bitop3:0xea
    ds_read_b64 v[104:105], v47
    v_bitop3_b32 v94, v30, v5, v46 bitop3:0xea
    s_waitcnt lgkmcnt(2)
    v_mfma_f32_4x4x4_16b_bf16 v[80:83], v[10:11], v[70:71], v[80:83]
    v_mfma_f32_4x4x4_16b_bf16 v[76:79], v[10:11], v[68:69], v[76:79]
    v_perm_b32 v15, v31, v32, s47
    v_bitop3_b32 v46, v31, 0.5, -0.5 bitop3:0xa8
    v_perm_b32 v14, v30, v32, s46
    v_bitop3_b32 v47, v30, 0.5, -0.5 bitop3:0xa8
    v_cvt_pk_bf16_f32 v80, v80, v81
    v_cvt_pk_bf16_f32 v81, v82, v83
    ds_wrxchg_rtn_b64 v[74:75], v93, v[80:81] offset:65408
    v_cvt_pk_bf16_f32 v76, v76, v77
    v_cvt_pk_bf16_f32 v77, v78, v79
    ds_wrxchg_rtn_b64 v[72:73], v92, v[76:77] offset:65408
    v_and_b32 v88, 0x0fffffff, v42
    v_mov_b32 v33, v42
    buffer_load_dwordx2 v[28:29], v88, s[8:11], 0 offen
    buffer_load_dwordx3 v[30:32], v88, s[8:11], 0 offen offset:8
    s_setprio 0
    s_waitcnt lgkmcnt(2)
    v_mfma_f32_4x4x4_16b_bf16 v[80:83], v[8:9], v[106:107], 0
    v_mfma_f32_4x4x4_16b_bf16 v[76:79], v[8:9], v[104:105], 0
    v_bitop3_b32 v15, v6, v15, v46 bitop3:0xca
    v_bitop3_b32 v14, v6, v14, v47 bitop3:0xca
    s_nop 1
    v_pk_mul_f32 v[80:81], v[80:81], v[14:15] op_sel:[0,1] op_sel_hi:[1,1]
    v_pk_mul_f32 v[82:83], v[82:83], v[14:15] op_sel:[0,1] op_sel_hi:[1,1]
    v_pk_mul_f32 v[76:77], v[76:77], v[14:15] op_sel:[0,0] op_sel_hi:[1,0]
    v_pk_mul_f32 v[78:79], v[78:79], v[14:15] op_sel:[0,0] op_sel_hi:[1,0]
    s_add_u32 s40, s40, 0xfff24000
    s_waitcnt lgkmcnt(0)
    v_cmp_ne_u64 s[50:51], v[72:73], v[68:69]
    v_cmpx_ne_u64 s[54:55], v[74:75], v[70:71]
    s_and_b64 s[82:83], s[54:55], s[80:81]
    s_cbranch_scc1 L2_c130
L2_d130:
    v_mov_b64 v[84:85], v[70:71]
    v_mov_b32 v7, v93
    v_mov_b64 v[86:87], v[74:75]
    s_or_b64 s[80:81], s[80:81], s[54:55]
    s_mov_b64 exec, s[50:51]
    s_and_b64 s[82:83], s[50:51], s[80:81]
    s_cbranch_scc1 L2_c131
L2_d131:
    v_mov_b64 v[84:85], v[68:69]
    v_mov_b32 v7, v92
    v_mov_b64 v[86:87], v[72:73]
    s_mov_b64 exec, -1
    s_or_b64 s[80:81], s[80:81], s[50:51]
    ds_read_b64 v[70:71], v95 offset:65408
    ds_read_b64 v[68:69], v94 offset:65408
    s_waitcnt vmcnt(8)
    v_and_b32 v46, 0x20000000, v39
    v_lshrrev_b32 v47, 14, v35
    v_bitop3_b32 v47, v47, v5, v46 bitop3:0xea
    ds_read_b64 v[102:103], v47
    v_bitop3_b32 v93, v35, v5, v46 bitop3:0xea
    v_and_b32 v46, 0x10000000, v39
    v_lshrrev_b32 v47, 14, v34
    v_bitop3_b32 v47, v47, v5, v46 bitop3:0xea
    ds_read_b64 v[100:101], v47
    v_bitop3_b32 v92, v34, v5, v46 bitop3:0xea
    v_and_b32 v46, 0x80000000, v39
    v_lshrrev_b32 v47, 14, v37
    v_bitop3_b32 v47, v47, v5, v46 bitop3:0xea
    ds_read_b64 v[106:107], v47
    v_and_b32 v46, 0x40000000, v39
    v_lshrrev_b32 v47, 14, v36
    v_bitop3_b32 v47, v47, v5, v46 bitop3:0xea
    ds_read_b64 v[104:105], v47
    s_waitcnt lgkmcnt(4)
    v_mfma_f32_4x4x4_16b_bf16 v[80:83], v[10:11], v[70:71], v[80:83]
    v_mfma_f32_4x4x4_16b_bf16 v[76:79], v[10:11], v[68:69], v[76:79]
    v_perm_b32 v15, v35, v38, s45
    v_bitop3_b32 v46, v35, 0.5, -0.5 bitop3:0xa8
    v_perm_b32 v14, v34, v38, s44
    v_bitop3_b32 v47, v34, 0.5, -0.5 bitop3:0xa8
    v_cvt_pk_bf16_f32 v80, v80, v81
    v_cvt_pk_bf16_f32 v81, v82, v83
    ds_wrxchg_rtn_b64 v[74:75], v95, v[80:81] offset:65408
    v_cvt_pk_bf16_f32 v76, v76, v77
    v_cvt_pk_bf16_f32 v77, v78, v79
    ds_wrxchg_rtn_b64 v[72:73], v94, v[76:77] offset:65408
    s_waitcnt lgkmcnt(2)
    s_barrier
    s_setprio 3
    s_mov_b32 m0, s100
    s_nop 0
    ds_write_addtid_b32 v116 offset:32768
    ds_write_addtid_b32 v117 offset:33024
    ds_write_addtid_b32 v118 offset:33280
    ds_write_addtid_b32 v119 offset:33536
    ds_write_addtid_b32 v120 offset:33792
    ds_write_addtid_b32 v121 offset:34048
    ds_write_addtid_b32 v122 offset:34304
    ds_write_addtid_b32 v123 offset:34560
    v_mfma_f32_4x4x4_16b_bf16 v[80:83], v[8:9], v[102:103], 0
    v_mfma_f32_4x4x4_16b_bf16 v[76:79], v[8:9], v[100:101], 0
    v_bitop3_b32 v15, v6, v15, v46 bitop3:0xca
    v_bitop3_b32 v14, v6, v14, v47 bitop3:0xca
    v_cmp_lt_u32 s[84:85], v5, v92
    s_nop 0
    v_pk_mul_f32 v[80:81], v[80:81], v[14:15] op_sel:[0,1] op_sel_hi:[1,1]
    v_pk_mul_f32 v[82:83], v[82:83], v[14:15] op_sel:[0,1] op_sel_hi:[1,1]
    v_pk_mul_f32 v[76:77], v[76:77], v[14:15] op_sel:[0,0] op_sel_hi:[1,0]
    v_pk_mul_f32 v[78:79], v[78:79], v[14:15] op_sel:[0,0] op_sel_hi:[1,0]
    v_mov_b32 v44, v43
    s_setprio 2
    ds_write_addtid_b32 v124 offset:34816
    ds_write_addtid_b32 v125 offset:35072
    ds_write_addtid_b32 v126 offset:35328
    ds_write_addtid_b32 v127 offset:35584
    s_waitcnt lgkmcnt(12)
    v_cmp_ne_u64 s[50:51], v[72:73], v[68:69]
    v_cmpx_ne_u64 s[54:55], v[74:75], v[70:71]
    s_and_b64 s[82:83], s[54:55], s[80:81]
    s_cbranch_scc1 L2_c132
L2_d132:
    v_mov_b64 v[84:85], v[70:71]
    v_mov_b32 v7, v95
    v_mov_b64 v[86:87], v[74:75]
    s_or_b64 s[80:81], s[80:81], s[54:55]
    s_mov_b64 exec, s[50:51]
    s_and_b64 s[82:83], s[50:51], s[80:81]
    s_cbranch_scc1 L2_c133
L2_d133:
    v_mov_b64 v[84:85], v[68:69]
    v_mov_b32 v7, v94
    v_mov_b64 v[86:87], v[72:73]
    s_mov_b64 exec, -1
    s_or_b64 s[80:81], s[80:81], s[50:51]
    ds_read_b64 v[70:71], v93 offset:65408
    s_and_b64 exec, s[84:85], s[80:81]
    v_mfma_f32_4x4x4_16b_bf16 v[76:79], v[12:13], v[84:85], 0
    v_mov_b32 v92, v7
    s_andn2_b64 s[80:81], s[80:81], s[84:85]
    v_mfma_f32_4x4x4_16b_bf16 v[76:79], v[10:11], v[86:87], v[76:79]
    s_mov_b64 exec, -1
    ds_read_b64 v[68:69], v92 offset:65408
    s_setprio 1
    s_waitcnt vmcnt(7)
    s_mov_b32 m0, s38
    s_nop 0
    ds_write_addtid_b32 v108 offset:0
    ds_write_addtid_b32 v109 offset:256
    ds_write_addtid_b32 v110 offset:512
    ds_write_addtid_b32 v111 offset:768
    s_waitcnt lgkmcnt(4)
    v_mfma_f32_4x4x4_16b_bf16 v[80:83], v[10:11], v[70:71], v[80:83]
    v_mfma_f32_4x4x4_16b_bf16 v[76:79], v[10:11], v[68:69], v[76:79]
    v_and_b32 v46, 0x40000000, v39
    v_bitop3_b32 v94, v36, v5, v46 bitop3:0xea
    v_and_b32 v46, 0x80000000, v39
    v_bitop3_b32 v95, v37, v5, v46 bitop3:0xea
    v_perm_b32 v15, v37, v38, s47
    v_bitop3_b32 v46, v37, 0.5, -0.5 bitop3:0xa8
    v_perm_b32 v14, v36, v38, s46
    v_bitop3_b32 v47, v36, 0.5, -0.5 bitop3:0xa8
    v_cvt_pk_bf16_f32 v80, v80, v81
    v_cvt_pk_bf16_f32 v81, v82, v83
    ds_wrxchg_rtn_b64 v[74:75], v93, v[80:81] offset:65408
    v_cvt_pk_bf16_f32 v76, v76, v77
    v_cvt_pk_bf16_f32 v77, v78, v79
    ds_wrxchg_rtn_b64 v[72:73], v92, v[76:77] offset:65408
    v_and_b32 v88, 0x0fffffff, v44
    v_mov_b32 v39, v44
    buffer_load_dwordx2 v[34:35], v88, s[8:11], 0 offen
    buffer_load_dwordx3 v[36:38], v88, s[8:11], 0 offen offset:8
    s_setprio 0
    s_waitcnt vmcnt(8)
    ds_write_addtid_b32 v112 offset:1024
    ds_write_addtid_b32 v113 offset:1280
    ds_write_addtid_b32 v114 offset:1536
    ds_write_addtid_b32 v115 offset:1792
    v_mfma_f32_4x4x4_16b_bf16 v[80:83], v[8:9], v[106:107], 0
    v_mfma_f32_4x4x4_16b_bf16 v[76:79], v[8:9], v[104:105], 0
    v_bitop3_b32 v15, v6, v15, v46 bitop3:0xca
    v_bitop3_b32 v14, v6, v14, v47 bitop3:0xca
    s_nop 1
    v_pk_mul_f32 v[80:81], v[80:81], v[14:15] op_sel:[0,1] op_sel_hi:[1,1]
    v_pk_mul_f32 v[82:83], v[82:83], v[14:15] op_sel:[0,1] op_sel_hi:[1,1]
    v_pk_mul_f32 v[76:77], v[76:77], v[14:15] op_sel:[0,0] op_sel_hi:[1,0]
    v_pk_mul_f32 v[78:79], v[78:79], v[14:15] op_sel:[0,0] op_sel_hi:[1,0]
    s_add_u32 s42, s42, 1
    s_waitcnt lgkmcnt(0)
    s_barrier
    s_bitcmp1_b32 s36, s42
    s_cbranch_scc1 L2_slow
L2_ret7:
    s_setprio 3
    v_cmp_ne_u64 s[50:51], v[72:73], v[68:69]
    v_cmpx_ne_u64 s[54:55], v[74:75], v[70:71]
    s_and_b64 s[82:83], s[54:55], s[80:81]
    s_cbranch_scc1 L2_c134
L2_d134:
    v_mov_b64 v[84:85], v[70:71]
    v_mov_b32 v7, v93
    v_mov_b64 v[86:87], v[74:75]
    s_or_b64 s[80:81], s[80:81], s[54:55]
    s_mov_b64 exec, s[50:51]
    s_and_b64 s[82:83], s[50:51], s[80:81]
    s_cbranch_scc1 L2_c135
L2_d135:
    v_mov_b64 v[84:85], v[68:69]
    v_mov_b32 v7, v92
    v_mov_b64 v[86:87], v[72:73]
    s_mov_b64 exec, -1
    s_or_b64 s[80:81], s[80:81], s[50:51]
    ds_read_b64 v[70:71], v95 offset:65408
    ds_read_b64 v[68:69], v94 offset:65408
    s_waitcnt vmcnt(6)
    v_and_b32 v46, 0x20000000, v21
    v_lshrrev_b32 v47, 14, v17
    v_bitop3_b32 v47, v47, v5, v46 bitop3:0xea
    ds_read_b64 v[102:103], v47
    v_bitop3_b32 v93, v17, v5, v46 bitop3:0xea
    v_and_b32 v46, 0x10000000, v21
    v_lshrrev_b32 v47, 14, v16
    v_bitop3_b32 v47, v47, v5, v46 bitop3:0xea
    ds_read_b64 v[100:101], v47
    v_bitop3_b32 v92, v16, v5, v46 bitop3:0xea
    s_waitcnt lgkmcnt(2)
    v_mfma_f32_4x4x4_16b_bf16 v[80:83], v[10:11], v[70:71], v[80:83]
    v_mfma_f32_4x4x4_16b_bf16 v[76:79], v[10:11], v[68:69], v[76:79]
    v_perm_b32 v15, v17, v20, s45
    v_bitop3_b32 v46, v17, 0.5, -0.5 bitop3:0xa8
    v_perm_b32 v14, v16, v20, s44
    v_bitop3_b32 v47, v16, 0.5, -0.5 bitop3:0xa8
    v_cvt_pk_bf16_f32 v80, v80, v81
    v_cvt_pk_bf16_f32 v81, v82, v83
    ds_wrxchg_rtn_b64 v[74:75], v95, v[80:81] offset:65408
    v_cvt_pk_bf16_f32 v76, v76, v77
    v_cvt_pk_bf16_f32 v77, v78, v79
    ds_wrxchg_rtn_b64 v[72:73], v94, v[76:77] offset:65408
    s_waitcnt lgkmcnt(2)
    v_mfma_f32_4x4x4_16b_bf16 v[80:83], v[8:9], v[102:103], 0
    v_mfma_f32_4x4x4_16b_bf16 v[76:79], v[8:9], v[100:101], 0
    v_bitop3_b32 v15, v6, v15, v46 bitop3:0xca
    v_bitop3_b32 v14, v6, v14, v47 bitop3:0xca
    v_cmp_lt_u32 s[84:85], v5, v92
    s_nop 0
    v_pk_mul_f32 v[80:81], v[80:81], v[14:15] op_sel:[0,1] op_sel_hi:[1,1]
    v_pk_mul_f32 v[82:83], v[82:83], v[14:15] op_sel:[0,1] op_sel_hi:[1,1]
    v_pk_mul_f32 v[76:77], v[76:77], v[14:15] op_sel:[0,0] op_sel_hi:[1,0]
    v_pk_mul_f32 v[78:79], v[78:79], v[14:15] op_sel:[0,0] op_sel_hi:[1,0]
    s_waitcnt lgkmcnt(0)
    v_cmp_ne_u64 s[50:51], v[72:73], v[68:69]
    v_cmpx_ne_u64 s[54:55], v[74:75], v[70:71]
    s_and_b64 s[82:83], s[54:55], s[80:81]
    s_cbranch_scc1 L2_c136
L2_d136:
    v_mov_b64 v[84:85], v[70:71]
    v_mov_b32 v7, v95
    v_mov_b64 v[86:87], v[74:75]
    s_or_b64 s[80:81], s[80:81], s[54:55]
    s_mov_b64 exec, s[50:51]
    s_and_b64 s[82:83], s[50:51], s[80:81]
    s_cbranch_scc1 L2_c137
L2_d137:
    v_mov_b64 v[84:85], v[68:69]
    v_mov_b32 v7, v94
    v_mov_b64 v[86:87], v[72:73]
    s_mov_b64 exec, -1
    s_or_b64 s[80:81], s[80:81], s[50:51]
    ds_read_b64 v[70:71], v93 offset:65408
    s_and_b64 exec, s[84:85], s[80:81]
    v_mfma_f32_4x4x4_16b_bf16 v[76:79], v[12:13], v[84:85], 0
    v_mov_b32 v92, v7
    s_andn2_b64 s[80:81], s[80:81], s[84:85]
    v_mfma_f32_4x4x4_16b_bf16 v[76:79], v[10:11], v[86:87], v[76:79]
    s_mov_b64 exec, -1
    ds_read_b64 v[68:69], v92 offset:65408
    v_and_b32 v46, 0x80000000, v21
    v_lshrrev_b32 v47, 14, v19
    v_bitop3_b32 v47, v47, v5, v46 bitop3:0xea
    ds_read_b64 v[106:107], v47
    v_bitop3_b32 v95, v19, v5, v46 bitop3:0xea
    v_and_b32 v46, 0x40000000, v21
    v_lshrrev_b32 v47, 14, v18
    v_bitop3_b32 v47, v47, v5, v46 bitop3:0xea
    ds_read_b64 v[104:105], v47
    v_bitop3_b32 v94, v18, v5, v46 bitop3:0xea
    s_waitcnt lgkmcnt(2)
    v_mfma_f32_4x4x4_16b_bf16 v[80:83], v[10:11], v[70:71], v[80:83]
    v_mfma_f32_4x4x4_16b_bf16 v[76:79], v[10:11], v[68:69], v[76:79]
    v_perm_b32 v15, v19, v20, s47
    v_bitop3_b32 v46, v19, 0.5, -0.5 bitop3:0xa8
    v_perm_b32 v14, v18, v20, s46
    v_bitop3_b32 v47, v18, 0.5, -0.5 bitop3:0xa8
    v_cvt_pk_bf16_f32 v80, v80, v81
    v_cvt_pk_bf16_f32 v81, v82, v83
    ds_wrxchg_rtn_b64 v[74:75], v93, v[80:81] offset:65408
    v_cvt_pk_bf16_f32 v76, v76, v77
    v_cvt_pk_bf16_f32 v77, v78, v79
    ds_wrxchg_rtn_b64 v[72:73], v92, v[76:77] offset:65408
    s_setprio 2
    s_waitcnt lgkmcnt(2)
    v_mfma_f32_4x4x4_16b_bf16 v[80:83], v[8:9], v[106:107], 0
    v_mfma_f32_4x4x4_16b_bf16 v[76:79], v[8:9], v[104:105], 0
    v_bitop3_b32 v15, v6, v15, v46 bitop3:0xca
    v_bitop3_b32 v14, v6, v14, v47 bitop3:0xca
    s_nop 1
    v_pk_mul_f32 v[80:81], v[80:81], v[14:15] op_sel:[0,1] op_sel_hi:[1,1]
    v_pk_mul_f32 v[82:83], v[82:83], v[14:15] op_sel:[0,1] op_sel_hi:[1,1]
    v_pk_mul_f32 v[76:77], v[76:77], v[14:15] op_sel:[0,0] op_sel_hi:[1,0]
    v_pk_mul_f32 v[78:79], v[78:79], v[14:15] op_sel:[0,0] op_sel_hi:[1,0]
    s_waitcnt lgkmcnt(0)
    v_cmp_ne_u64 s[50:51], v[72:73], v[68:69]
    v_cmpx_ne_u64 s[54:55], v[74:75], v[70:71]
    s_and_b64 s[82:83], s[54:55], s[80:81]
    s_cbranch_scc1 L2_c138
L2_d138:
    v_mov_b64 v[84:85], v[70:71]
    v_mov_b32 v7, v93
    v_mov_b64 v[86:87], v[74:75]
    s_or_b64 s[80:81], s[80:81], s[54:55]
    s_mov_b64 exec, s[50:51]
    s_and_b64 s[82:83], s[50:51], s[80:81]
    s_cbranch_scc1 L2_c139
L2_d139:
    v_mov_b64 v[84:85], v[68:69]
    v_mov_b32 v7, v92
    v_mov_b64 v[86:87], v[72:73]
    s_mov_b64 exec, -1
    s_or_b64 s[80:81], s[80:81], s[50:51]
    ds_read_b64 v[70:71], v95 offset:65408
    ds_read_b64 v[68:69], v94 offset:65408
    s_waitcnt vmcnt(4)
    v_and_b32 v46, 0x20000000, v27
    v_lshrrev_b32 v47, 14, v23
    v_bitop3_b32 v47, v47, v5, v46 bitop3:0xea
    ds_read_b64 v[102:103], v47
    v_bitop3_b32 v93, v23, v5, v46 bitop3:0xea
    v_and_b32 v46, 0x10000000, v27
    v_lshrrev_b32 v47, 14, v22
    v_bitop3_b32 v47, v47, v5, v46 bitop3:0xea
    ds_read_b64 v[100:101], v47
    v_bitop3_b32 v92, v22, v5, v46 bitop3:0xea
    s_waitcnt lgkmcnt(2)
    v_mfma_f32_4x4x4_16b_bf16 v[80:83], v[10:11], v[70:71], v[80:83]
    v_mfma_f32_4x4x4_16b_bf16 v[76:79], v[10:11], v[68:69], v[76:79]
    v_perm_b32 v15, v23, v26, s45
    v_bitop3_b32 v46, v23, 0.5, -0.5 bitop3:0xa8
    v_perm_b32 v14, v22, v26, s44
    v_bitop3_b32 v47, v22, 0.5, -0.5 bitop3:0xa8
    v_cvt_pk_bf16_f32 v80, v80, v81
    v_cvt_pk_bf16_f32 v81, v82, v83
    ds_wrxchg_rtn_b64 v[74:75], v95, v[80:81] offset:65408
    v_cvt_pk_bf16_f32 v76, v76, v77
    v_cvt_pk_bf16_f32 v77, v78, v79
    ds_wrxchg_rtn_b64 v[72:73], v94, v[76:77] offset:65408
    s_waitcnt lgkmcnt(2)
    v_mfma_f32_4x4x4_16b_bf16 v[80:83], v[8:9], v[102:103], 0
    v_mfma_f32_4x4x4_16b_bf16 v[76:79], v[8:9], v[100:101], 0
    v_bitop3_b32 v15, v6, v15, v46 bitop3:0xca
    v_bitop3_b32 v14, v6, v14, v47 bitop3:0xca
    v_cmp_lt_u32 s[84:85], v5, v92
    s_nop 0
    v_pk_mul_f32 v[80:81], v[80:81], v[14:15] op_sel:[0,1] op_sel_hi:[1,1]
    v_pk_mul_f32 v[82:83], v[82:83], v[14:15] op_sel:[0,1] op_sel_hi:[1,1]
    v_pk_mul_f32 v[76:77], v[76:77], v[14:15] op_sel:[0,0] op_sel_hi:[1,0]
    v_pk_mul_f32 v[78:79], v[78:79], v[14:15] op_sel:[0,0] op_sel_hi:[1,0]
    s_waitcnt lgkmcnt(0)
    v_cmp_ne_u64 s[50:51], v[72:73], v[68:69]
    v_cmpx_ne_u64 s[54:55], v[74:75], v[70:71]
    s_and_b64 s[82:83], s[54:55], s[80:81]
    s_cbranch_scc1 L2_c140
L2_d140:
    v_mov_b64 v[84:85], v[70:71]
    v_mov_b32 v7, v95
    v_mov_b64 v[86:87], v[74:75]
    s_or_b64 s[80:81], s[80:81], s[54:55]
    s_mov_b64 exec, s[50:51]
    s_and_b64 s[82:83], s[50:51], s[80:81]
    s_cbranch_scc1 L2_c141
L2_d141:
    v_mov_b64 v[84:85], v[68:69]
    v_mov_b32 v7, v94
    v_mov_b64 v[86:87], v[72:73]
    s_mov_b64 exec, -1
    s_or_b64 s[80:81], s[80:81], s[50:51]
    ds_read_b64 v[70:71], v93 offset:65408
    s_and_b64 exec, s[84:85], s[80:81]
    v_mfma_f32_4x4x4_16b_bf16 v[76:79], v[12:13], v[84:85], 0
    v_mov_b32 v92, v7
    s_andn2_b64 s[80:81], s[80:81], s[84:85]
    v_mfma_f32_4x4x4_16b_bf16 v[76:79], v[10:11], v[86:87], v[76:79]
    s_mov_b64 exec, -1
    ds_read_b64 v[68:69], v92 offset:65408
    v_and_b32 v46, 0x80000000, v27
    v_lshrrev_b32 v47, 14, v25
    v_bitop3_b32 v47, v47, v5, v46 bitop3:0xea
    ds_read_b64 v[106:107], v47
    v_bitop3_b32 v95, v25, v5, v46 bitop3:0xea
    v_and_b32 v46, 0x40000000, v27
    v_lshrrev_b32 v47, 14, v24
    v_bitop3_b32 v47, v47, v5, v46 bitop3:0xea
    ds_read_b64 v[104:105], v47
    v_bitop3_b32 v94, v24, v5, v46 bitop3:0xea
    s_waitcnt lgkmcnt(2)
    v_mfma_f32_4x4x4_16b_bf16 v[80:83], v[10:11], v[70:71], v[80:83]
    v_mfma_f32_4x4x4_16b_bf16 v[76:79], v[10:11], v[68:69], v[76:79]
    v_perm_b32 v15, v25, v26, s47
    v_bitop3_b32 v46, v25, 0.5, -0.5 bitop3:0xa8
    v_perm_b32 v14, v24, v26, s46
    v_bitop3_b32 v47, v24, 0.5, -0.5 bitop3:0xa8
    v_cvt_pk_bf16_f32 v80, v80, v81
    v_cvt_pk_bf16_f32 v81, v82, v83
    ds_wrxchg_rtn_b64 v[74:75], v93, v[80:81] offset:65408
    v_cvt_pk_bf16_f32 v76, v76, v77
    v_cvt_pk_bf16_f32 v77, v78, v79
    ds_wrxchg_rtn_b64 v[72:73], v92, v[76:77] offset:65408
    s_setprio 1
    s_waitcnt lgkmcnt(2)
    v_mfma_f32_4x4x4_16b_bf16 v[80:83], v[8:9], v[106:107], 0
    v_mfma_f32_4x4x4_16b_bf16 v[76:79], v[8:9], v[104:105], 0
    v_bitop3_b32 v15, v6, v15, v46 bitop3:0xca
    v_bitop3_b32 v14, v6, v14, v47 bitop3:0xca
    s_nop 1
    v_pk_mul_f32 v[80:81], v[80:81], v[14:15] op_sel:[0,1] op_sel_hi:[1,1]
    v_pk_mul_f32 v[82:83], v[82:83], v[14:15] op_sel:[0,1] op_sel_hi:[1,1]
    v_pk_mul_f32 v[76:77], v[76:77], v[14:15] op_sel:[0,0] op_sel_hi:[1,0]
    v_pk_mul_f32 v[78:79], v[78:79], v[14:15] op_sel:[0,0] op_sel_hi:[1,0]
    s_lshl_b32 s3, s32, 12
    v_subrev_u32 v122, s3, v3
    s_mul_i32 s3, s33, 20000
    v_add_u32 v118, s3, v122
    v_add_u32 v119, 0x4000, v118
    s_lshl_b32 s3, s34, 7
    v_lshrrev_b32 v123, 7, v118
    v_and_b32 v120, 0x70, v118
    v_lshl_add_u32 v120, v123, 13, v120
    v_add_u32 v120, s3, v120
    v_lshrrev_b32 v123, 7, v119
    v_and_b32 v121, 0x70, v119
    v_lshl_add_u32 v121, v123, 13, v121
    v_add_u32 v121, s3, v121
    v_cmp_le_u32 vcc, 3616, v122
    s_mov_b64 exec, vcc
    v_mov_b32 v119, 2.0
    v_mov_b32 v121, 2.0
    s_mov_b64 exec, -1
    v_and_b32 v123, 0x30, v122
    v_lshlrev_b32 v123, 2, v123
    buffer_load_dwordx4 v[48:51], v123, s[24:27], 0 offen
    buffer_load_dwordx4 v[52:55], v123, s[24:27], 0 offen offset:16
    buffer_load_dwordx2 v[56:57], v123, s[24:27], 0 offen offset:32
    s_mov_b32 s12, s4
    s_mov_b32 s13, s5
    s_mov_b32 s14, 0x138800
    s_mov_b32 s15, 0x20000
    s_mov_b32 s16, s28
    s_mov_b32 s17, s29
    s_mov_b32 s18, 0x4e2000
    s_mov_b32 s19, 0x20000
    v_lshrrev_b32 v123, 2, v120
    buffer_load_dword v116, v123, s[12:15], 0 offen
    buffer_load_dwordx4 v[108:111], v120, s[16:19], 0 offen
    v_lshrrev_b32 v123, 2, v121
    buffer_load_dword v117, v123, s[12:15], 0 offen
    buffer_load_dwordx4 v[112:115], v121, s[16:19], 0 offen
    s_waitcnt lgkmcnt(0)
    v_cmp_ne_u64 s[50:51], v[72:73], v[68:69]
    v_cmpx_ne_u64 s[54:55], v[74:75], v[70:71]
    s_and_b64 s[82:83], s[54:55], s[80:81]
    s_cbranch_scc1 L2_c142
L2_d142:
    v_mov_b64 v[84:85], v[70:71]
    v_mov_b32 v7, v93
    v_mov_b64 v[86:87], v[74:75]
    s_or_b64 s[80:81], s[80:81], s[54:55]
    s_mov_b64 exec, s[50:51]
    s_and_b64 s[82:83], s[50:51], s[80:81]
    s_cbranch_scc1 L2_c143
L2_d143:
    v_mov_b64 v[84:85], v[68:69]
    v_mov_b32 v7, v92
    v_mov_b64 v[86:87], v[72:73]
    s_mov_b64 exec, -1
    s_or_b64 s[80:81], s[80:81], s[50:51]
    ds_read_b64 v[70:71], v95 offset:65408
    ds_read_b64 v[68:69], v94 offset:65408
    s_waitcnt vmcnt(9)
    v_and_b32 v46, 0x20000000, v33
    v_lshrrev_b32 v47, 14, v29
    v_bitop3_b32 v47, v47, v5, v46 bitop3:0xea
    ds_read_b64 v[102:103], v47
    v_bitop3_b32 v93, v29, v5, v46 bitop3:0xea
    v_and_b32 v46, 0x10000000, v33
    v_lshrrev_b32 v47, 14, v28
    v_bitop3_b32 v47, v47, v5, v46 bitop3:0xea
    ds_read_b64 v[100:101], v47
    v_bitop3_b32 v92, v28, v5, v46 bitop3:0xea
    s_waitcnt lgkmcnt(2)
    v_mfma_f32_4x4x4_16b_bf16 v[80:83], v[10:11], v[70:71], v[80:83]
    v_mfma_f32_4x4x4_16b_bf16 v[76:79], v[10:11], v[68:69], v[76:79]
    v_perm_b32 v15, v29, v32, s45
    v_bitop3_b32 v46, v29, 0.5, -0.5 bitop3:0xa8
    v_perm_b32 v14, v28, v32, s44
    v_bitop3_b32 v47, v28, 0.5, -0.5 bitop3:0xa8
    v_cvt_pk_bf16_f32 v80, v80, v81
    v_cvt_pk_bf16_f32 v81, v82, v83
    ds_wrxchg_rtn_b64 v[74:75], v95, v[80:81] offset:65408
    v_cvt_pk_bf16_f32 v76, v76, v77
    v_cvt_pk_bf16_f32 v77, v78, v79
    ds_wrxchg_rtn_b64 v[72:73], v94, v[76:77] offset:65408
    s_waitcnt lgkmcnt(2)
    v_mfma_f32_4x4x4_16b_bf16 v[80:83], v[8:9], v[102:103], 0
    v_mfma_f32_4x4x4_16b_bf16 v[76:79], v[8:9], v[100:101], 0
    v_bitop3_b32 v15, v6, v15, v46 bitop3:0xca
    v_bitop3_b32 v14, v6, v14, v47 bitop3:0xca
    v_cmp_lt_u32 s[84:85], v5, v92
    s_nop 0
    v_pk_mul_f32 v[80:81], v[80:81], v[14:15] op_sel:[0,1] op_sel_hi:[1,1]
    v_pk_mul_f32 v[82:83], v[82:83], v[14:15] op_sel:[0,1] op_sel_hi:[1,1]
    v_pk_mul_f32 v[76:77], v[76:77], v[14:15] op_sel:[0,0] op_sel_hi:[1,0]
    v_pk_mul_f32 v[78:79], v[78:79], v[14:15] op_sel:[0,0] op_sel_hi:[1,0]
    s_waitcnt lgkmcnt(0)
    v_cmp_ne_u64 s[50:51], v[72:73], v[68:69]
    v_cmpx_ne_u64 s[54:55], v[74:75], v[70:71]
    s_and_b64 s[82:83], s[54:55], s[80:81]
    s_cbranch_scc1 L2_c144
L2_d144:
    v_mov_b64 v[84:85], v[70:71]
    v_mov_b32 v7, v95
    v_mov_b64 v[86:87], v[74:75]
    s_or_b64 s[80:81], s[80:81], s[54:55]
    s_mov_b64 exec, s[50:51]
    s_and_b64 s[82:83], s[50:51], s[80:81]
    s_cbranch_scc1 L2_c145
L2_d145:
    v_mov_b64 v[84:85], v[68:69]
    v_mov_b32 v7, v94
    v_mov_b64 v[86:87], v[72:73]
    s_mov_b64 exec, -1
    s_or_b64 s[80:81], s[80:81], s[50:51]
    ds_read_b64 v[70:71], v93 offset:65408
    s_and_b64 exec, s[84:85], s[80:81]
    v_mfma_f32_4x4x4_16b_bf16 v[76:79], v[12:13], v[84:85], 0
    v_mov_b32 v92, v7
    s_andn2_b64 s[80:81], s[80:81], s[84:85]
    v_mfma_f32_4x4x4_16b_bf16 v[76:79], v[10:11], v[86:87], v[76:79]
    s_mov_b64 exec, -1
    ds_read_b64 v[68:69], v92 offset:65408
    v_and_b32 v46, 0x80000000, v33
    v_lshrrev_b32 v47, 14, v31
    v_bitop3_b32 v47, v47, v5, v46 bitop3:0xea
    ds_read_b64 v[106:107], v47
    v_bitop3_b32 v95, v31, v5, v46 bitop3:0xea
    v_and_b32 v46, 0x40000000, v33
    v_lshrrev_b32 v47, 14, v30
    v_bitop3_b32 v47, v47, v5, v46 bitop3:0xea
    ds_read_b64 v[104:105], v47
    v_bitop3_b32 v94, v30, v5, v46 bitop3:0xea
    s_waitcnt lgkmcnt(2)
    v_mfma_f32_4x4x4_16b_bf16 v[80:83], v[10:11], v[70:71], v[80:83]
    v_mfma_f32_4x4x4_16b_bf16 v[76:79], v[10:11], v[68:69], v[76:79]
    v_perm_b32 v15, v31, v32, s47
    v_bitop3_b32 v46, v31, 0.5, -0.5 bitop3:0xa8
    v_perm_b32 v14, v30, v32, s46
    v_bitop3_b32 v47, v30, 0.5, -0.5 bitop3:0xa8
    v_cvt_pk_bf16_f32 v80, v80, v81
    v_cvt_pk_bf16_f32 v81, v82, v83
    ds_wrxchg_rtn_b64 v[74:75], v93, v[80:81] offset:65408
    v_cvt_pk_bf16_f32 v76, v76, v77
    v_cvt_pk_bf16_f32 v77, v78, v79
    ds_wrxchg_rtn_b64 v[72:73], v92, v[76:77] offset:65408
    s_setprio 0
    s_waitcnt lgkmcnt(2)
    v_mfma_f32_4x4x4_16b_bf16 v[80:83], v[8:9], v[106:107], 0
    v_mfma_f32_4x4x4_16b_bf16 v[76:79], v[8:9], v[104:105], 0
    v_bitop3_b32 v15, v6, v15, v46 bitop3:0xca
    v_bitop3_b32 v14, v6, v14, v47 bitop3:0xca
    s_nop 1
    v_pk_mul_f32 v[80:81], v[80:81], v[14:15] op_sel:[0,1] op_sel_hi:[1,1]
    v_pk_mul_f32 v[82:83], v[82:83], v[14:15] op_sel:[0,1] op_sel_hi:[1,1]
    v_pk_mul_f32 v[76:77], v[76:77], v[14:15] op_sel:[0,0] op_sel_hi:[1,0]
    v_pk_mul_f32 v[78:79], v[78:79], v[14:15] op_sel:[0,0] op_sel_hi:[1,0]
    s_waitcnt lgkmcnt(0)
    v_cmp_ne_u64 s[50:51], v[72:73], v[68:69]
    v_cmpx_ne_u64 s[54:55], v[74:75], v[70:71]
    s_and_b64 s[82:83], s[54:55], s[80:81]
    s_cbranch_scc1 L2_c146
L2_d146:
    v_mov_b64 v[84:85], v[70:71]
    v_mov_b32 v7, v93
    v_mov_b64 v[86:87], v[74:75]
    s_or_b64 s[80:81], s[80:81], s[54:55]
    s_mov_b64 exec, s[50:51]
    s_and_b64 s[82:83], s[50:51], s[80:81]
    s_cbranch_scc1 L2_c147
L2_d147:
    v_mov_b64 v[84:85], v[68:69]
    v_mov_b32 v7, v92
    v_mov_b64 v[86:87], v[72:73]
    s_mov_b64 exec, -1
    s_or_b64 s[80:81], s[80:81], s[50:51]
    ds_read_b64 v[70:71], v95 offset:65408
    ds_read_b64 v[68:69], v94 offset:65408
    s_waitcnt vmcnt(7)
    v_and_b32 v46, 0x20000000, v39
    v_lshrrev_b32 v47, 14, v35
    v_bitop3_b32 v47, v47, v5, v46 bitop3:0xea
    ds_read_b64 v[102:103], v47
    v_bitop3_b32 v93, v35, v5, v46 bitop3:0xea
    v_and_b32 v46, 0x10000000, v39
    v_lshrrev_b32 v47, 14, v34
    v_bitop3_b32 v47, v47, v5, v46 bitop3:0xea
    ds_read_b64 v[100:101], v47
    v_bitop3_b32 v92, v34, v5, v46 bitop3:0xea
    v_and_b32 v46, 0x80000000, v39
    v_lshrrev_b32 v47, 14, v37
    v_bitop3_b32 v47, v47, v5, v46 bitop3:0xea
    ds_read_b64 v[106:107], v47
    v_and_b32 v46, 0x40000000, v39
    v_lshrrev_b32 v47, 14, v36
    v_bitop3_b32 v47, v47, v5, v46 bitop3:0xea
    ds_read_b64 v[104:105], v47
    s_waitcnt lgkmcnt(4)
    v_mfma_f32_4x4x4_16b_bf16 v[80:83], v[10:11], v[70:71], v[80:83]
    v_mfma_f32_4x4x4_16b_bf16 v[76:79], v[10:11], v[68:69], v[76:79]
    v_perm_b32 v15, v35, v38, s45
    v_bitop3_b32 v46, v35, 0.5, -0.5 bitop3:0xa8
    v_perm_b32 v14, v34, v38, s44
    v_bitop3_b32 v47, v34, 0.5, -0.5 bitop3:0xa8
    v_cvt_pk_bf16_f32 v80, v80, v81
    v_cvt_pk_bf16_f32 v81, v82, v83
    ds_wrxchg_rtn_b64 v[74:75], v95, v[80:81] offset:65408
    v_cvt_pk_bf16_f32 v76, v76, v77
    v_cvt_pk_bf16_f32 v77, v78, v79
    ds_wrxchg_rtn_b64 v[72:73], v94, v[76:77] offset:65408
    s_waitcnt lgkmcnt(4)
    v_mfma_f32_4x4x4_16b_bf16 v[80:83], v[8:9], v[102:103], 0
    v_mfma_f32_4x4x4_16b_bf16 v[76:79], v[8:9], v[100:101], 0
    v_bitop3_b32 v15, v6, v15, v46 bitop3:0xca
    v_bitop3_b32 v14, v6, v14, v47 bitop3:0xca
    v_cmp_lt_u32 s[84:85], v5, v92
    s_nop 0
    v_pk_mul_f32 v[80:81], v[80:81], v[14:15] op_sel:[0,1] op_sel_hi:[1,1]
    v_pk_mul_f32 v[82:83], v[82:83], v[14:15] op_sel:[0,1] op_sel_hi:[1,1]
    v_pk_mul_f32 v[76:77], v[76:77], v[14:15] op_sel:[0,0] op_sel_hi:[1,0]
    v_pk_mul_f32 v[78:79], v[78:79], v[14:15] op_sel:[0,0] op_sel_hi:[1,0]
    s_waitcnt lgkmcnt(0)
    v_cmp_ne_u64 s[50:51], v[72:73], v[68:69]
    v_cmpx_ne_u64 s[54:55], v[74:75], v[70:71]
    s_and_b64 s[82:83], s[54:55], s[80:81]
    s_cbranch_scc1 L2_c148
L2_d148:
    v_mov_b64 v[84:85], v[70:71]
    v_mov_b32 v7, v95
    v_mov_b64 v[86:87], v[74:75]
    s_or_b64 s[80:81], s[80:81], s[54:55]
    s_mov_b64 exec, s[50:51]
    s_and_b64 s[82:83], s[50:51], s[80:81]
    s_cbranch_scc1 L2_c149
L2_d149:
    v_mov_b64 v[84:85], v[68:69]
    v_mov_b32 v7, v94
    v_mov_b64 v[86:87], v[72:73]
    s_mov_b64 exec, -1
    s_or_b64 s[80:81], s[80:81], s[50:51]
    ds_read_b64 v[70:71], v93 offset:65408
    s_and_b64 exec, s[84:85], s[80:81]
    v_mfma_f32_4x4x4_16b_bf16 v[76:79], v[12:13], v[84:85], 0
    v_mov_b32 v92, v7
    s_andn2_b64 s[80:81], s[80:81], s[84:85]
    v_mfma_f32_4x4x4_16b_bf16 v[76:79], v[10:11], v[86:87], v[76:79]
    s_mov_b64 exec, -1
    ds_read_b64 v[68:69], v92 offset:65408
    s_waitcnt lgkmcnt(0)
    v_mfma_f32_4x4x4_16b_bf16 v[80:83], v[10:11], v[70:71], v[80:83]
    v_mfma_f32_4x4x4_16b_bf16 v[76:79], v[10:11], v[68:69], v[76:79]
    v_and_b32 v46, 0x40000000, v39
    v_bitop3_b32 v94, v36, v5, v46 bitop3:0xea
    v_and_b32 v46, 0x80000000, v39
    v_bitop3_b32 v95, v37, v5, v46 bitop3:0xea
    v_perm_b32 v15, v37, v38, s47
    v_bitop3_b32 v46, v37, 0.5, -0.5 bitop3:0xa8
    v_perm_b32 v14, v36, v38, s46
    v_bitop3_b32 v47, v36, 0.5, -0.5 bitop3:0xa8
    v_cvt_pk_bf16_f32 v80, v80, v81
    v_cvt_pk_bf16_f32 v81, v82, v83
    ds_wrxchg_rtn_b64 v[74:75], v93, v[80:81] offset:65408
    v_cvt_pk_bf16_f32 v76, v76, v77
    v_cvt_pk_bf16_f32 v77, v78, v79
    ds_wrxchg_rtn_b64 v[72:73], v92, v[76:77] offset:65408
    v_mfma_f32_4x4x4_16b_bf16 v[80:83], v[8:9], v[106:107], 0
    v_mfma_f32_4x4x4_16b_bf16 v[76:79], v[8:9], v[104:105], 0
    v_bitop3_b32 v15, v6, v15, v46 bitop3:0xca
    v_bitop3_b32 v14, v6, v14, v47 bitop3:0xca
    s_nop 1
    v_pk_mul_f32 v[80:81], v[80:81], v[14:15] op_sel:[0,1] op_sel_hi:[1,1]
    v_pk_mul_f32 v[82:83], v[82:83], v[14:15] op_sel:[0,1] op_sel_hi:[1,1]
    v_pk_mul_f32 v[76:77], v[76:77], v[14:15] op_sel:[0,0] op_sel_hi:[1,0]
    v_pk_mul_f32 v[78:79], v[78:79], v[14:15] op_sel:[0,0] op_sel_hi:[1,0]
    s_waitcnt lgkmcnt(0)
    v_cmp_ne_u64 s[50:51], v[72:73], v[68:69]
    v_cmpx_ne_u64 s[54:55], v[74:75], v[70:71]
    s_and_b64 s[82:83], s[54:55], s[80:81]
    s_cbranch_scc1 L2_c150
L2_d150:
    v_mov_b64 v[84:85], v[70:71]
    v_mov_b32 v7, v93
    v_mov_b64 v[86:87], v[74:75]
    s_or_b64 s[80:81], s[80:81], s[54:55]
    s_mov_b64 exec, s[50:51]
    s_and_b64 s[82:83], s[50:51], s[80:81]
    s_cbranch_scc1 L2_c151
L2_d151:
    v_mov_b64 v[84:85], v[68:69]
    v_mov_b32 v7, v92
    v_mov_b64 v[86:87], v[72:73]
    s_mov_b64 exec, -1
    s_or_b64 s[80:81], s[80:81], s[50:51]
    ds_read_b64 v[70:71], v95 offset:65408
    ds_read_b64 v[68:69], v94 offset:65408
    s_waitcnt lgkmcnt(0)
    v_mfma_f32_4x4x4_16b_bf16 v[80:83], v[10:11], v[70:71], v[80:83]
    v_mfma_f32_4x4x4_16b_bf16 v[76:79], v[10:11], v[68:69], v[76:79]
    s_nop 3
    v_cvt_pk_bf16_f32 v80, v80, v81
    v_cvt_pk_bf16_f32 v81, v82, v83
    ds_wrxchg_rtn_b64 v[74:75], v95, v[80:81] offset:65408
    v_cvt_pk_bf16_f32 v76, v76, v77
    v_cvt_pk_bf16_f32 v77, v78, v79
    ds_wrxchg_rtn_b64 v[72:73], v94, v[76:77] offset:65408
    s_waitcnt lgkmcnt(0)
    v_cmpx_ne_u64 vcc, v[74:75], v[70:71]
    s_and_b64 s[82:83], vcc, s[80:81]
    s_cbranch_scc1 L2_c152
L2_d152:
    v_mov_b64 v[84:85], v[70:71]
    v_mov_b32 v7, v95
    v_mov_b64 v[86:87], v[74:75]
    s_mov_b64 exec, -1
    s_or_b64 s[80:81], s[80:81], vcc
    v_cmpx_ne_u64 vcc, v[72:73], v[68:69]
    s_and_b64 s[82:83], vcc, s[80:81]
    s_cbranch_scc1 L2_c153
L2_d153:
    v_mov_b64 v[84:85], v[68:69]
    v_mov_b32 v7, v94
    v_mov_b64 v[86:87], v[72:73]
    s_mov_b64 exec, -1
    s_or_b64 s[80:81], s[80:81], vcc
    s_mov_b64 exec, s[80:81]
    s_nop 1
    v_mfma_f32_4x4x4_16b_bf16 v[88:91], v[12:13], v[84:85], 0
    s_nop 1
    v_mfma_f32_4x4x4_16b_bf16 v[88:91], v[10:11], v[86:87], v[88:91]
    s_nop 4
    v_cvt_pk_bf16_f32 v88, v88, v89
    v_cvt_pk_bf16_f32 v89, v90, v91
    ds_pk_add_bf16 v7, v88 offset:65408
    ds_pk_add_bf16 v7, v89 offset:65412
    s_mov_b64 exec, -1
    s_load_dwordx2 s[4:5], s[0:1], 88
    v_add_u32 v123, 16384, v122
    v_add_u32 v124, 32768, v122
    v_add_u32 v125, 49152, v122
    v_add_u32 v126, 65536, v122
    s_lshl_b32 s50, s96, 16
    s_and_b32 s51, s96, 0xffff0000
    s_lshl_b32 s52, s97, 16
    s_and_b32 s53, s97, 0xffff0000
    s_lshl_b32 s54, s98, 16
    s_and_b32 s55, s98, 0xffff0000
    s_lshl_b32 s56, s99, 16
    s_and_b32 s57, s99, 0xffff0000
    s_waitcnt vmcnt(0) lgkmcnt(0)
    s_barrier
    v_add_u32 v36, 0x8000, v126
    ds_read_b128 v[16:19], v126 offset:16384
    ds_read_b128 v[20:23], v126 offset:32768
    ds_read_b128 v[24:27], v126 offset:49152
    ds_read_b128 v[28:31], v36 offset:32768
    ds_read_b128 v[32:35], v36 offset:49152
    s_add_u32 s8, s30, 0xebce000
    s_addc_u32 s9, s31, 0
    s_mov_b32 s10, 0x8000
    s_mov_b32 s11, 0x20000
    s_mov_b32 s12, s4
    s_mov_b32 s13, s5
    s_mov_b32 s14, 0x4e2000
    s_mov_b32 s15, 0x20000
    s_mul_i32 s3, s33, 20000
    v_subrev_u32 v36, s3, v122
    v_cmp_le_u32 vcc, 20000, v36
    s_waitcnt lgkmcnt(4)
    s_mov_b64 exec, vcc
    buffer_store_dwordx4 v[16:19], v122, s[20:23], 0 offen sc1
    s_mov_b64 exec, -1
    v_subrev_u32 v36, s3, v123
    v_cmp_le_u32 vcc, 20000, v36
    s_waitcnt lgkmcnt(3)
    s_mov_b64 exec, vcc
    buffer_store_dwordx4 v[20:23], v123, s[20:23], 0 offen sc1
    s_mov_b64 exec, -1
    v_subrev_u32 v36, s3, v124
    v_cmp_le_u32 vcc, 20000, v36
    s_waitcnt lgkmcnt(2)
    s_mov_b64 exec, vcc
    buffer_store_dwordx4 v[24:27], v124, s[20:23], 0 offen sc1
    s_mov_b64 exec, -1
    v_subrev_u32 v36, s3, v125
    v_cmp_le_u32 vcc, 20000, v36
    s_waitcnt lgkmcnt(1)
    s_mov_b64 exec, vcc
    buffer_store_dwordx4 v[28:31], v125, s[20:23], 0 offen sc1
    s_mov_b64 exec, -1
    v_subrev_u32 v36, s3, v126
    v_cmp_le_u32 vcc, 20000, v36
    s_waitcnt lgkmcnt(0)
    s_mov_b64 exec, vcc
    buffer_store_dwordx4 v[32:35], v126, s[20:23], 0 offen sc1
    s_mov_b64 exec, -1
    v_lshlrev_b32 v80, 16, v116
    v_subrev_f32 v60, s50, v80
    v_subrev_f32 v61, s51, v80
    v_subrev_f32 v62, s52, v80
    v_subrev_f32 v63, s53, v80
    v_subrev_f32 v64, s54, v80
    v_subrev_f32 v65, s55, v80
    v_subrev_f32 v66, s56, v80
    v_subrev_f32 v67, s57, v80
    v_cvt_pk_bf16_f32 v68, v60, v61
    v_cvt_pk_bf16_f32 v69, v62, v63
    v_cvt_pk_bf16_f32 v70, v64, v65
    v_cvt_pk_bf16_f32 v71, v66, v67
    v_lshlrev_b32 v60, 16, v68
    v_and_b32 v61, 0xffff0000, v68
    v_lshlrev_b32 v62, 16, v69
    v_and_b32 v63, 0xffff0000, v69
    v_lshlrev_b32 v64, 16, v70
    v_and_b32 v65, 0xffff0000, v70
    v_lshlrev_b32 v66, 16, v71
    v_and_b32 v67, 0xffff0000, v71
    v_mul_f32 v60, v60, v60
    v_mul_f32 v61, v61, v61
    v_mul_f32 v62, v62, v62
    v_mul_f32 v63, v63, v63
    v_mul_f32 v64, v64, v64
    v_mul_f32 v65, v65, v65
    v_mul_f32 v66, v66, v66
    v_mul_f32 v67, v67, v67
    v_cvt_pk_bf16_f32 v68, v60, v61
    v_cvt_pk_bf16_f32 v69, v62, v63
    v_cvt_pk_bf16_f32 v70, v64, v65
    v_cvt_pk_bf16_f32 v71, v66, v67
    v_lshlrev_b32 v60, 16, v68
    v_and_b32 v61, 0xffff0000, v68
    v_lshlrev_b32 v62, 16, v69
    v_and_b32 v63, 0xffff0000, v69
    v_lshlrev_b32 v64, 16, v70
    v_and_b32 v65, 0xffff0000, v70
    v_lshlrev_b32 v66, 16, v71
    v_and_b32 v67, 0xffff0000, v71
    v_mul_f32 v60, 0xc1200000, v60
    v_mul_f32 v61, 0xc1200000, v61
    v_mul_f32 v62, 0xc1200000, v62
    v_mul_f32 v63, 0xc1200000, v63
    v_mul_f32 v64, 0xc1200000, v64
    v_mul_f32 v65, 0xc1200000, v65
    v_mul_f32 v66, 0xc1200000, v66
    v_mul_f32 v67, 0xc1200000, v67
    v_cvt_pk_bf16_f32 v68, v60, v61
    v_cvt_pk_bf16_f32 v69, v62, v63
    v_cvt_pk_bf16_f32 v70, v64, v65
    v_cvt_pk_bf16_f32 v71, v66, v67
    v_lshlrev_b32 v60, 16, v68
    v_and_b32 v61, 0xffff0000, v68
    v_lshlrev_b32 v62, 16, v69
    v_and_b32 v63, 0xffff0000, v69
    v_lshlrev_b32 v64, 16, v70
    v_and_b32 v65, 0xffff0000, v70
    v_lshlrev_b32 v66, 16, v71
    v_and_b32 v67, 0xffff0000, v71
    v_mul_f32 v60, 0x3fb8aa3b, v60
    v_mul_f32 v61, 0x3fb8aa3b, v61
    v_mul_f32 v62, 0x3fb8aa3b, v62
    v_mul_f32 v63, 0x3fb8aa3b, v63
    v_mul_f32 v64, 0x3fb8aa3b, v64
    v_mul_f32 v65, 0x3fb8aa3b, v65
    v_mul_f32 v66, 0x3fb8aa3b, v66
    v_mul_f32 v67, 0x3fb8aa3b, v67
    v_exp_f32 v60, v60
    v_exp_f32 v61, v61
    v_exp_f32 v62, v62
    v_exp_f32 v63, v63
    v_exp_f32 v64, v64
    v_exp_f32 v65, v65
    v_exp_f32 v66, v66
    v_exp_f32 v67, v67
    v_cvt_pk_bf16_f32 v72, v60, v61
    v_cvt_pk_bf16_f32 v73, v62, v63
    v_cvt_pk_bf16_f32 v74, v64, v65
    v_cvt_pk_bf16_f32 v75, v66, v67
    v_and_b32 v80, 0xffff0000, v116
    v_subrev_f32 v60, s50, v80
    v_subrev_f32 v61, s51, v80
    v_subrev_f32 v62, s52, v80
    v_subrev_f32 v63, s53, v80
    v_subrev_f32 v64, s54, v80
    v_subrev_f32 v65, s55, v80
    v_subrev_f32 v66, s56, v80
    v_subrev_f32 v67, s57, v80
    v_cvt_pk_bf16_f32 v68, v60, v61
    v_cvt_pk_bf16_f32 v69, v62, v63
    v_cvt_pk_bf16_f32 v70, v64, v65
    v_cvt_pk_bf16_f32 v71, v66, v67
    v_lshlrev_b32 v60, 16, v68
    v_and_b32 v61, 0xffff0000, v68
    v_lshlrev_b32 v62, 16, v69
    v_and_b32 v63, 0xffff0000, v69
    v_lshlrev_b32 v64, 16, v70
    v_and_b32 v65, 0xffff0000, v70
    v_lshlrev_b32 v66, 16, v71
    v_and_b32 v67, 0xffff0000, v71
    v_mul_f32 v60, v60, v60
    v_mul_f32 v61, v61, v61
    v_mul_f32 v62, v62, v62
    v_mul_f32 v63, v63, v63
    v_mul_f32 v64, v64, v64
    v_mul_f32 v65, v65, v65
    v_mul_f32 v66, v66, v66
    v_mul_f32 v67, v67, v67
    v_cvt_pk_bf16_f32 v68, v60, v61
    v_cvt_pk_bf16_f32 v69, v62, v63
    v_cvt_pk_bf16_f32 v70, v64, v65
    v_cvt_pk_bf16_f32 v71, v66, v67
    v_lshlrev_b32 v60, 16, v68
    v_and_b32 v61, 0xffff0000, v68
    v_lshlrev_b32 v62, 16, v69
    v_and_b32 v63, 0xffff0000, v69
    v_lshlrev_b32 v64, 16, v70
    v_and_b32 v65, 0xffff0000, v70
    v_lshlrev_b32 v66, 16, v71
    v_and_b32 v67, 0xffff0000, v71
    v_mul_f32 v60, 0xc1200000, v60
    v_mul_f32 v61, 0xc1200000, v61
    v_mul_f32 v62, 0xc1200000, v62
    v_mul_f32 v63, 0xc1200000, v63
    v_mul_f32 v64, 0xc1200000, v64
    v_mul_f32 v65, 0xc1200000, v65
    v_mul_f32 v66, 0xc1200000, v66
    v_mul_f32 v67, 0xc1200000, v67
    v_cvt_pk_bf16_f32 v68, v60, v61
    v_cvt_pk_bf16_f32 v69, v62, v63
    v_cvt_pk_bf16_f32 v70, v64, v65
    v_cvt_pk_bf16_f32 v71, v66, v67
    v_lshlrev_b32 v60, 16, v68
    v_and_b32 v61, 0xffff0000, v68
    v_lshlrev_b32 v62, 16, v69
    v_and_b32 v63, 0xffff0000, v69
    v_lshlrev_b32 v64, 16, v70
    v_and_b32 v65, 0xffff0000, v70
    v_lshlrev_b32 v66, 16, v71
    v_and_b32 v67, 0xffff0000, v71
    v_mul_f32 v60, 0x3fb8aa3b, v60
    v_mul_f32 v61, 0x3fb8aa3b, v61
    v_mul_f32 v62, 0x3fb8aa3b, v62
    v_mul_f32 v63, 0x3fb8aa3b, v63
    v_mul_f32 v64, 0x3fb8aa3b, v64
    v_mul_f32 v65, 0x3fb8aa3b, v65
    v_mul_f32 v66, 0x3fb8aa3b, v66
    v_mul_f32 v67, 0x3fb8aa3b, v67
    v_exp_f32 v60, v60
    v_exp_f32 v61, v61
    v_exp_f32 v62, v62
    v_exp_f32 v63, v63
    v_exp_f32 v64, v64
    v_exp_f32 v65, v65
    v_exp_f32 v66, v66
    v_exp_f32 v67, v67
    v_cvt_pk_bf16_f32 v76, v60, v61
    v_cvt_pk_bf16_f32 v77, v62, v63
    v_cvt_pk_bf16_f32 v78, v64, v65
    v_cvt_pk_bf16_f32 v79, v66, v67
    v_mfma_f32_4x4x4_16b_bf16 v[80:83], v[48:49], v[72:73], 0
    v_mfma_f32_4x4x4_16b_bf16 v[88:91], v[52:53], v[72:73], 0
    v_mfma_f32_4x4x4_16b_bf16 v[84:87], v[48:49], v[76:77], 0
    v_mfma_f32_4x4x4_16b_bf16 v[92:95], v[52:53], v[76:77], 0
    v_mfma_f32_4x4x4_16b_bf16 v[80:83], v[50:51], v[74:75], v[80:83]
    v_mfma_f32_4x4x4_16b_bf16 v[88:91], v[54:55], v[74:75], v[88:91]
    v_mfma_f32_4x4x4_16b_bf16 v[84:87], v[50:51], v[78:79], v[84:87]
    v_mfma_f32_4x4x4_16b_bf16 v[92:95], v[54:55], v[78:79], v[92:95]
    v_add_u32 v104, 81920, v118
    ds_read_b128 v[32:35], v104
    v_add_u32 v104, 81920, v119
    ds_read_b128 v[60:63], v104
    s_add_u32 s20, s30, 0xd845000
    s_addc_u32 s21, s31, 0
    s_mov_b32 s22, 0x1388000
    s_mov_b32 s23, 0x20000
    s_add_u32 s3, s33, 1
    s_and_b32 s3, s3, 3
    s_lshl_b32 s3, s3, 6
    s_add_u32 s3, s3, s34
    s_mul_i32 s44, s3, 80000
    s_add_u32 s3, s33, 2
    s_and_b32 s3, s3, 3
    s_lshl_b32 s3, s3, 6
    s_add_u32 s3, s3, s34
    s_mul_i32 s45, s3, 80000
    s_add_u32 s3, s33, 3
    s_and_b32 s3, s3, 3
    s_lshl_b32 s3, s3, 6
    s_add_u32 s3, s3, s34
    s_mul_i32 s46, s3, 80000
    s_lshl_b32 s3, s34, 9
    s_lshl_b32 s4, s33, 7
    s_add_u32 s4, s4, s3
    v_mov_b32 v104, 1
    v_lshlrev_b32 v105, 3, v122
    s_waitcnt vmcnt(0)
    s_barrier
    s_cmp_lg_u32 s32, 0
    s_cbranch_scc1 L2_f2
    s_mov_b64 exec, 1
    buffer_store_dword v104, off, s[8:11], s4 sc1
    s_mov_b64 exec, 15
    s_bitset0_b64 exec, s33
L2_f3:
    buffer_load_dword v104, v105, s[8:11], s3 offen sc1
    s_waitcnt vmcnt(0)
    v_cmp_ne_u32 vcc, 1, v104
    s_cbranch_vccnz L2_f3
L2_f4:
    s_mov_b64 exec, -1
L2_f2:
    s_barrier
    buffer_load_dwordx4 v[36:39], v118, s[20:23], s44 offen sc1
    buffer_load_dwordx4 v[40:43], v118, s[20:23], s45 offen sc1
    buffer_load_dwordx4 v[44:47], v118, s[20:23], s46 offen sc1
    s_cmp_ge_u32 s32, 4
    s_cbranch_scc1 L2_f5
    buffer_load_dwordx4 v[64:67], v119, s[20:23], s44 offen sc1
    buffer_load_dwordx4 v[68:71], v119, s[20:23], s45 offen sc1
    buffer_load_dwordx4 v[72:75], v119, s[20:23], s46 offen sc1
    v_lshlrev_b32 v16, 16, v117
    v_subrev_f32 v96, s50, v16
    v_subrev_f32 v97, s51, v16
    v_subrev_f32 v98, s52, v16
    v_subrev_f32 v99, s53, v16
    v_subrev_f32 v100, s54, v16
    v_subrev_f32 v101, s55, v16
    v_subrev_f32 v102, s56, v16
    v_subrev_f32 v103, s57, v16
    v_cvt_pk_bf16_f32 v0, v96, v97
    v_cvt_pk_bf16_f32 v1, v98, v99
    v_cvt_pk_bf16_f32 v2, v100, v101
    v_cvt_pk_bf16_f32 v3, v102, v103
    v_lshlrev_b32 v96, 16, v0
    v_and_b32 v97, 0xffff0000, v0
    v_lshlrev_b32 v98, 16, v1
    v_and_b32 v99, 0xffff0000, v1
    v_lshlrev_b32 v100, 16, v2
    v_and_b32 v101, 0xffff0000, v2
    v_lshlrev_b32 v102, 16, v3
    v_and_b32 v103, 0xffff0000, v3
    v_mul_f32 v96, v96, v96
    v_mul_f32 v97, v97, v97
    v_mul_f32 v98, v98, v98
    v_mul_f32 v99, v99, v99
    v_mul_f32 v100, v100, v100
    v_mul_f32 v101, v101, v101
    v_mul_f32 v102, v102, v102
    v_mul_f32 v103, v103, v103
    v_cvt_pk_bf16_f32 v0, v96, v97
    v_cvt_pk_bf16_f32 v1, v98, v99
    v_cvt_pk_bf16_f32 v2, v100, v101
    v_cvt_pk_bf16_f32 v3, v102, v103
    v_lshlrev_b32 v96, 16, v0
    v_and_b32 v97, 0xffff0000, v0
    v_lshlrev_b32 v98, 16, v1
    v_and_b32 v99, 0xffff0000, v1
    v_lshlrev_b32 v100, 16, v2
    v_and_b32 v101, 0xffff0000, v2
    v_lshlrev_b32 v102, 16, v3
    v_and_b32 v103, 0xffff0000, v3
    v_mul_f32 v96, 0xc1200000, v96
    v_mul_f32 v97, 0xc1200000, v97
    v_mul_f32 v98, 0xc1200000, v98
    v_mul_f32 v99, 0xc1200000, v99
    v_mul_f32 v100, 0xc1200000, v100
    v_mul_f32 v101, 0xc1200000, v101
    v_mul_f32 v102, 0xc1200000, v102
    v_mul_f32 v103, 0xc1200000, v103
    v_cvt_pk_bf16_f32 v0, v96, v97
    v_cvt_pk_bf16_f32 v1, v98, v99
    v_cvt_pk_bf16_f32 v2, v100, v101
    v_cvt_pk_bf16_f32 v3, v102, v103
    v_lshlrev_b32 v96, 16, v0
    v_and_b32 v97, 0xffff0000, v0
    v_lshlrev_b32 v98, 16, v1
    v_and_b32 v99, 0xffff0000, v1
    v_lshlrev_b32 v100, 16, v2
    v_and_b32 v101, 0xffff0000, v2
    v_lshlrev_b32 v102, 16, v3
    v_and_b32 v103, 0xffff0000, v3
    v_mul_f32 v96, 0x3fb8aa3b, v96
    v_mul_f32 v97, 0x3fb8aa3b, v97
    v_mul_f32 v98, 0x3fb8aa3b, v98
    v_mul_f32 v99, 0x3fb8aa3b, v99
    v_mul_f32 v100, 0x3fb8aa3b, v100
    v_mul_f32 v101, 0x3fb8aa3b, v101
    v_mul_f32 v102, 0x3fb8aa3b, v102
    v_mul_f32 v103, 0x3fb8aa3b, v103
    v_exp_f32 v96, v96
    v_exp_f32 v97, v97
    v_exp_f32 v98, v98
    v_exp_f32 v99, v99
    v_exp_f32 v100, v100
    v_exp_f32 v101, v101
    v_exp_f32 v102, v102
    v_exp_f32 v103, v103
    v_cvt_pk_bf16_f32 v104, v96, v97
    v_cvt_pk_bf16_f32 v105, v98, v99
    v_cvt_pk_bf16_f32 v106, v100, v101
    v_cvt_pk_bf16_f32 v107, v102, v103
    v_and_b32 v16, 0xffff0000, v117
    v_subrev_f32 v96, s50, v16
    v_subrev_f32 v97, s51, v16
    v_subrev_f32 v98, s52, v16
    v_subrev_f32 v99, s53, v16
    v_subrev_f32 v100, s54, v16
    v_subrev_f32 v101, s55, v16
    v_subrev_f32 v102, s56, v16
    v_subrev_f32 v103, s57, v16
    v_cvt_pk_bf16_f32 v0, v96, v97
    v_cvt_pk_bf16_f32 v1, v98, v99
    v_cvt_pk_bf16_f32 v2, v100, v101
    v_cvt_pk_bf16_f32 v3, v102, v103
    v_lshlrev_b32 v96, 16, v0
    v_and_b32 v97, 0xffff0000, v0
    v_lshlrev_b32 v98, 16, v1
    v_and_b32 v99, 0xffff0000, v1
    v_lshlrev_b32 v100, 16, v2
    v_and_b32 v101, 0xffff0000, v2
    v_lshlrev_b32 v102, 16, v3
    v_and_b32 v103, 0xffff0000, v3
    v_mul_f32 v96, v96, v96
    v_mul_f32 v97, v97, v97
    v_mul_f32 v98, v98, v98
    v_mul_f32 v99, v99, v99
    v_mul_f32 v100, v100, v100
    v_mul_f32 v101, v101, v101
    v_mul_f32 v102, v102, v102
    v_mul_f32 v103, v103, v103
    v_cvt_pk_bf16_f32 v0, v96, v97
    v_cvt_pk_bf16_f32 v1, v98, v99
    v_cvt_pk_bf16_f32 v2, v100, v101
    v_cvt_pk_bf16_f32 v3, v102, v103
    v_lshlrev_b32 v96, 16, v0
    v_and_b32 v97, 0xffff0000, v0
    v_lshlrev_b32 v98, 16, v1
    v_and_b32 v99, 0xffff0000, v1
    v_lshlrev_b32 v100, 16, v2
    v_and_b32 v101, 0xffff0000, v2
    v_lshlrev_b32 v102, 16, v3
    v_and_b32 v103, 0xffff0000, v3
    v_mul_f32 v96, 0xc1200000, v96
    v_mul_f32 v97, 0xc1200000, v97
    v_mul_f32 v98, 0xc1200000, v98
    v_mul_f32 v99, 0xc1200000, v99
    v_mul_f32 v100, 0xc1200000, v100
    v_mul_f32 v101, 0xc1200000, v101
    v_mul_f32 v102, 0xc1200000, v102
    v_mul_f32 v103, 0xc1200000, v103
    v_cvt_pk_bf16_f32 v0, v96, v97
    v_cvt_pk_bf16_f32 v1, v98, v99
    v_cvt_pk_bf16_f32 v2, v100, v101
    v_cvt_pk_bf16_f32 v3, v102, v103
    v_lshlrev_b32 v96, 16, v0
    v_and_b32 v97, 0xffff0000, v0
    v_lshlrev_b32 v98, 16, v1
    v_and_b32 v99, 0xffff0000, v1
    v_lshlrev_b32 v100, 16, v2
    v_and_b32 v101, 0xffff0000, v2
    v_lshlrev_b32 v102, 16, v3
    v_and_b32 v103, 0xffff0000, v3
    v_mul_f32 v96, 0x3fb8aa3b, v96
    v_mul_f32 v97, 0x3fb8aa3b, v97
    v_mul_f32 v98, 0x3fb8aa3b, v98
    v_mul_f32 v99, 0x3fb8aa3b, v99
    v_mul_f32 v100, 0x3fb8aa3b, v100
    v_mul_f32 v101, 0x3fb8aa3b, v101
    v_mul_f32 v102, 0x3fb8aa3b, v102
    v_mul_f32 v103, 0x3fb8aa3b, v103
    v_exp_f32 v96, v96
    v_exp_f32 v97, v97
    v_exp_f32 v98, v98
    v_exp_f32 v99, v99
    v_exp_f32 v100, v100
    v_exp_f32 v101, v101
    v_exp_f32 v102, v102
    v_exp_f32 v103, v103
    v_cvt_pk_bf16_f32 v76, v96, v97
    v_cvt_pk_bf16_f32 v77, v98, v99
    v_cvt_pk_bf16_f32 v78, v100, v101
    v_cvt_pk_bf16_f32 v79, v102, v103
    v_mfma_f32_4x4x4_16b_bf16 v[16:19], v[48:49], v[104:105], 0
    v_mfma_f32_4x4x4_16b_bf16 v[24:27], v[52:53], v[104:105], 0
    v_mfma_f32_4x4x4_16b_bf16 v[20:23], v[48:49], v[76:77], 0
    v_mfma_f32_4x4x4_16b_bf16 v[28:31], v[52:53], v[76:77], 0
    v_mfma_f32_4x4x4_16b_bf16 v[16:19], v[50:51], v[106:107], v[16:19]
    v_mfma_f32_4x4x4_16b_bf16 v[24:27], v[54:55], v[106:107], v[24:27]
    v_mfma_f32_4x4x4_16b_bf16 v[20:23], v[50:51], v[78:79], v[20:23]
    v_mfma_f32_4x4x4_16b_bf16 v[28:31], v[54:55], v[78:79], v[28:31]
L2_f5:
    s_waitcnt vmcnt(0) lgkmcnt(0)
    v_mfma_f32_4x4x4_16b_bf16 v[96:99], v[10:11], v[32:33], 0
    v_mfma_f32_4x4x4_16b_bf16 v[100:103], v[10:11], v[34:35], 0
    s_nop 0
    v_mfma_f32_4x4x4_16b_bf16 v[96:99], v[10:11], v[36:37], v[96:99]
    v_mfma_f32_4x4x4_16b_bf16 v[100:103], v[10:11], v[38:39], v[100:103]
    s_nop 0
    v_mfma_f32_4x4x4_16b_bf16 v[96:99], v[10:11], v[40:41], v[96:99]
    v_mfma_f32_4x4x4_16b_bf16 v[100:103], v[10:11], v[42:43], v[100:103]
    s_nop 0
    v_mfma_f32_4x4x4_16b_bf16 v[96:99], v[10:11], v[44:45], v[96:99]
    v_mfma_f32_4x4x4_16b_bf16 v[100:103], v[10:11], v[46:47], v[100:103]
    s_nop 3
    v_mul_f32 v96, v96, v80
    v_mul_f32 v97, v97, v81
    v_mul_f32 v98, v98, v82
    v_mul_f32 v99, v99, v83
    v_cvt_pk_bf16_f32 v32, v96, v97
    v_cvt_pk_bf16_f32 v33, v98, v99
    v_mul_f32 v100, v100, v84
    v_mul_f32 v101, v101, v85
    v_mul_f32 v102, v102, v86
    v_mul_f32 v103, v103, v87
    v_cvt_pk_bf16_f32 v34, v100, v101
    v_cvt_pk_bf16_f32 v35, v102, v103
    v_mfma_f32_4x4x4_16b_bf16 v[80:83], v[56:57], v[32:33], 0
    s_nop 0
    v_mfma_f32_4x4x4_16b_bf16 v[84:87], v[56:57], v[34:35], 0
    s_nop 2
    v_mul_f32 v80, v80, v88
    v_mul_f32 v81, v81, v89
    v_mul_f32 v82, v82, v90
    v_mul_f32 v83, v83, v91
    v_mul_f32 v84, v84, v92
    v_mul_f32 v85, v85, v93
    v_mul_f32 v86, v86, v94
    v_mul_f32 v87, v87, v95
    v_mfma_f32_4x4x4_16b_bf16 v[96:99], v[10:11], v[108:109], v[80:83]
    s_nop 0
    v_mfma_f32_4x4x4_16b_bf16 v[100:103], v[10:11], v[110:111], v[84:87]
    s_nop 2
    v_cvt_pk_bf16_f32 v36, v96, v97
    v_cvt_pk_bf16_f32 v37, v98, v99
    v_cvt_pk_bf16_f32 v38, v100, v101
    v_cvt_pk_bf16_f32 v39, v102, v103
    buffer_store_dwordx4 v[36:39], v120, s[12:15], 0 offen
    s_cmp_ge_u32 s32, 4
    s_cbranch_scc1 L2_f6
    v_mfma_f32_4x4x4_16b_bf16 v[96:99], v[10:11], v[60:61], 0
    v_mfma_f32_4x4x4_16b_bf16 v[100:103], v[10:11], v[62:63], 0
    s_nop 0
    v_mfma_f32_4x4x4_16b_bf16 v[96:99], v[10:11], v[64:65], v[96:99]
    v_mfma_f32_4x4x4_16b_bf16 v[100:103], v[10:11], v[66:67], v[100:103]
    s_nop 0
    v_mfma_f32_4x4x4_16b_bf16 v[96:99], v[10:11], v[68:69], v[96:99]
    v_mfma_f32_4x4x4_16b_bf16 v[100:103], v[10:11], v[70:71], v[100:103]
    s_nop 0
    v_mfma_f32_4x4x4_16b_bf16 v[96:99], v[10:11], v[72:73], v[96:99]
    v_mfma_f32_4x4x4_16b_bf16 v[100:103], v[10:11], v[74:75], v[100:103]
    s_nop 3
    v_mul_f32 v96, v96, v16
    v_mul_f32 v97, v97, v17
    v_mul_f32 v98, v98, v18
    v_mul_f32 v99, v99, v19
    v_cvt_pk_bf16_f32 v60, v96, v97
    v_cvt_pk_bf16_f32 v61, v98, v99
    v_mul_f32 v100, v100, v20
    v_mul_f32 v101, v101, v21
    v_mul_f32 v102, v102, v22
    v_mul_f32 v103, v103, v23
    v_cvt_pk_bf16_f32 v62, v100, v101
    v_cvt_pk_bf16_f32 v63, v102, v103
    v_mfma_f32_4x4x4_16b_bf16 v[16:19], v[56:57], v[60:61], 0
    s_nop 0
    v_mfma_f32_4x4x4_16b_bf16 v[20:23], v[56:57], v[62:63], 0
    s_nop 2
    v_mul_f32 v16, v16, v24
    v_mul_f32 v17, v17, v25
    v_mul_f32 v18, v18, v26
    v_mul_f32 v19, v19, v27
    v_mul_f32 v20, v20, v28
    v_mul_f32 v21, v21, v29
    v_mul_f32 v22, v22, v30
    v_mul_f32 v23, v23, v31
    v_mfma_f32_4x4x4_16b_bf16 v[96:99], v[10:11], v[112:113], v[16:19]
    s_nop 0
    v_mfma_f32_4x4x4_16b_bf16 v[100:103], v[10:11], v[114:115], v[20:23]
    s_nop 2
    v_cvt_pk_bf16_f32 v64, v96, v97
    v_cvt_pk_bf16_f32 v65, v98, v99
    v_cvt_pk_bf16_f32 v66, v100, v101
    v_cvt_pk_bf16_f32 v67, v102, v103
    buffer_store_dwordx4 v[64:67], v121, s[12:15], 0 offen
L2_f6:
L2_end:
    s_endpgm
L2_slow:
    s_lshr_b32 s35, s42, 2
    s_lshl_b32 s50, s32, 4
    s_and_b32 s3, s42, 3
    s_lshl_b32 s53, s3, 3
    s_add_u32 s53, s53, s39
    s_and_b32 s3, s35, 2
    s_lshl_b32 s3, s3, 1
    s_add_u32 s53, s53, s3
    s_and_b32 s54, s35, 1
    s_lshl_b32 s54, s54, 4
L2_sl_seg:
    s_mul_i32 s55, s50, 173056
    s_and_b32 s3, s50, 3
    s_lshl_b32 s3, s3, 5
    s_add_u32 s3, s3, s55
    s_add_u32 s3, s3, s53
    buffer_load_dword v104, off, s[12:15], s3 sc1
    buffer_load_dword v105, off, s[12:15], s3 offset:32 sc1
    s_waitcnt vmcnt(0)
    v_readfirstlane_b32 s51, v104
    v_readfirstlane_b32 s52, v105
    s_lshr_b32 s51, s51, s54
    s_and_b32 s51, s51, 0xffff
    s_lshr_b32 s52, s52, s54
    s_and_b32 s52, s52, 0xffff
L2_sl_rec:
    s_cmp_ge_u32 s51, s52
    s_cbranch_scc1 L2_sl_next
    v_mbcnt_lo_u32_b32 v102, -1, 0
    v_mbcnt_hi_u32_b32 v102, -1, v102
    v_add_u32 v102, s51, v102
    v_and_b32 v103, -4, v102
    v_lshl_add_u32 v104, v102, 2, v103
    v_lshl_add_u32 v105, v103, 2, v102
    v_cmp_gt_u32 vcc, s52, v102
    s_mov_b64 exec, vcc
    buffer_load_dword v106, v104, s[8:11], s55 offen
    buffer_load_ubyte v107, v105, s[8:11], s55 offen offset:16
    s_waitcnt vmcnt(0)
    v_lshrrev_b32 v98, 14, v106
    v_and_b32 v98, v5, v98
    ds_read_b64 v[100:101], v98
    v_perm_b32 v97, v106, v107, s44
    v_and_b32 v96, v5, v106
    v_bitop3_b32 v103, v106, 0.5, -0.5 bitop3:0xa8
    v_bitop3_b32 v97, v6, v97, v103 bitop3:0xca
    s_waitcnt lgkmcnt(0)
    v_mfma_f32_4x4x4_16b_bf16 v[88:91], v[8:9], v[100:101], 0
    s_nop 4
    v_mul_f32 v88, v97, v88
    v_mul_f32 v89, v97, v89
    v_mul_f32 v90, v97, v90
    v_mul_f32 v91, v97, v91
    v_cvt_pk_bf16_f32 v88, v88, v89
    v_cvt_pk_bf16_f32 v89, v90, v91
    ds_pk_add_bf16 v96, v88 offset:65408
    ds_pk_add_bf16 v96, v89 offset:65412
    s_mov_b64 exec, -1
    s_add_u32 s51, s51, 64
    s_branch L2_sl_rec
L2_sl_next:
    s_add_u32 s50, s50, 1
    s_and_b32 s3, s50, 15
    s_cbranch_scc1 L2_sl_seg
    s_add_u32 s50, s50, 240
    s_cmp_lt_u32 s50, 1280
    s_cbranch_scc1 L2_sl_seg
    s_waitcnt lgkmcnt(0)
    s_cmp_eq_u32 s42, 0
    s_cbranch_scc1 L2_ret0
    s_cmp_eq_u32 s42, 1
    s_cbranch_scc1 L2_ret1
    s_cmp_eq_u32 s42, 14
    s_cbranch_scc1 L2_ret6
    s_cmp_eq_u32 s42, 15
    s_cbranch_scc1 L2_ret7
    s_and_b32 s3, s42, 3
    s_cmp_eq_u32 s3, 2
    s_cbranch_scc1 L2_ret2
    s_cmp_eq_u32 s3, 3
    s_cbranch_scc1 L2_ret3
    s_cmp_eq_u32 s3, 0
    s_cbranch_scc1 L2_ret4
    s_branch L2_ret5
L2_p1s:
    s_sleep 32
    s_branch L2_p1
L2_xo3:
    v_cmp_lt_u32 vcc, 20, v99
    s_mov_b32 s101, 1
    s_cbranch_vccz L2_xp3
    v_cmp_lt_u32 vcc, 32, v99
    v_cmp_lt_u32 s[58:59], 31, v88
    s_mov_b32 s101, 2
    s_or_b64 vcc, vcc, s[58:59]
    s_cbranch_scc0 L2_xp3
    s_mov_b32 s37, 0x10000
    s_branch L2_xp3
L2_xa4:
    s_cmp_eq_u32 s101, 1
    s_cbranch_scc1 L2_xc4
    v_lshlrev_b32 v89, 0, v96
    v_add_u32 v90, 140, v97
    v_bitop3_b32 v90, v89, v45, v90 bitop3:0x6a
    ds_write_b32 v98, v90 offset:28
    v_lshlrev_b32 v89, 4, v96
    v_add_u32 v90, 120, v97
    v_bitop3_b32 v90, v89, v45, v90 bitop3:0x6a
    ds_write_b32 v98, v90 offset:24
    v_lshlrev_b32 v89, 8, v96
    v_add_u32 v90, 100, v97
    v_bitop3_b32 v90, v89, v45, v90 bitop3:0x6a
    ds_write_b32 v98, v90 offset:20
L2_xc4:
    v_lshlrev_b32 v89, 12, v96
    v_add_u32 v90, 80, v97
    v_bitop3_b32 v90, v89, v45, v90 bitop3:0x6a
    ds_write_b32 v98, v90 offset:16
    s_branch L2_xb4
L2_xe4:
    v_cmp_lt_u32 vcc, 32, v99
    v_cmp_lt_u32 s[58:59], 31, v88
    v_lshrrev_b32 v89, 16, v96
    v_add_u32 v97, 80, v97
    s_or_b64 vcc, vcc, s[58:59]
    s_cbranch_scc1 L2_xs4
    v_lshlrev_b32 v89, v1, v89
    v_and_b32 v89, v45, v89
    v_cmp_ne_u32 vcc, 0, v89
    v_xor_b32 v90, v97, v89
    s_add_u32 s3, s37, s38
    v_mbcnt_lo_u32_b32 v98, vcc_lo, 0
    v_mbcnt_hi_u32_b32 v98, vcc_hi, v98
    s_bcnt1_i32_b64 s41, vcc
    v_lshl_add_u32 v98, v98, 2, s3
    s_mov_b64 exec, vcc
    ds_write_b32 v98, v90
    s_mov_b64 exec, -1
    s_lshl2_add_u32 s37, s41, s37
    s_branch L2_xr4
L2_xf4:
    s_waitcnt lgkmcnt(0)
    s_cmp_gt_u32 s37, 1024
    s_cbranch_scc1 L2_xs4
    v_mov_b32 v43, -1
    s_cmp_ge_u32 s37, 512
    s_cbranch_scc1 L2_xg4
    v_mov_b32 v42, -1
    s_cmp_ge_u32 s37, 256
    s_cbranch_scc1 L2_xg4
    v_mov_b32 v41, -1
    s_branch L2_xg4
L2_xs4:
    s_waitcnt lgkmcnt(0)
    v_mov_b32 v40, -1
    v_mov_b32 v41, -1
    v_mov_b32 v42, -1
    v_mov_b32 v43, -1
    s_add_u32 s3, s42, 0
    s_bitset1_b32 s36, s3
    s_branch L2_xg4
L2_xo5:
    v_cmp_lt_u32 vcc, 20, v99
    s_mov_b32 s101, 1
    s_cbranch_vccz L2_xp5
    v_cmp_lt_u32 vcc, 32, v99
    v_cmp_lt_u32 s[58:59], 31, v88
    s_mov_b32 s101, 2
    s_or_b64 vcc, vcc, s[58:59]
    s_cbranch_scc0 L2_xp5
    s_mov_b32 s37, 0x10000
    s_branch L2_xp5
L2_xa6:
    s_cmp_eq_u32 s101, 1
    s_cbranch_scc1 L2_xc6
    v_lshlrev_b32 v89, 0, v96
    v_add_u32 v90, 140, v97
    v_bitop3_b32 v90, v89, v45, v90 bitop3:0x6a
    ds_write_b32 v98, v90 offset:28
    v_lshlrev_b32 v89, 4, v96
    v_add_u32 v90, 120, v97
    v_bitop3_b32 v90, v89, v45, v90 bitop3:0x6a
    ds_write_b32 v98, v90 offset:24
    v_lshlrev_b32 v89, 8, v96
    v_add_u32 v90, 100, v97
    v_bitop3_b32 v90, v89, v45, v90 bitop3:0x6a
    ds_write_b32 v98, v90 offset:20
L2_xc6:
    v_lshlrev_b32 v89, 12, v96
    v_add_u32 v90, 80, v97
    v_bitop3_b32 v90, v89, v45, v90 bitop3:0x6a
    ds_write_b32 v98, v90 offset:16
    s_branch L2_xb6
L2_xe6:
    v_cmp_lt_u32 vcc, 32, v99
    v_cmp_lt_u32 s[58:59], 31, v88
    v_lshrrev_b32 v89, 16, v96
    v_add_u32 v97, 80, v97
    s_or_b64 vcc, vcc, s[58:59]
    s_cbranch_scc1 L2_xs6
    v_lshlrev_b32 v89, v1, v89
    v_and_b32 v89, v45, v89
    v_cmp_ne_u32 vcc, 0, v89
    v_xor_b32 v90, v97, v89
    s_add_u32 s3, s37, s38
    v_mbcnt_lo_u32_b32 v98, vcc_lo, 0
    v_mbcnt_hi_u32_b32 v98, vcc_hi, v98
    s_bcnt1_i32_b64 s41, vcc
    v_lshl_add_u32 v98, v98, 2, s3
    s_mov_b64 exec, vcc
    ds_write_b32 v98, v90
    s_mov_b64 exec, -1
    s_lshl2_add_u32 s37, s41, s37
    s_branch L2_xr6
L2_xf6:
    s_waitcnt lgkmcnt(0)
    s_cmp_gt_u32 s37, 1024
    s_cbranch_scc1 L2_xs6
    v_mov_b32 v43, -1
    s_cmp_ge_u32 s37, 512
    s_cbranch_scc1 L2_xg6
    v_mov_b32 v42, -1
    s_cmp_ge_u32 s37, 256
    s_cbranch_scc1 L2_xg6
    v_mov_b32 v41, -1
    s_branch L2_xg6
L2_xs6:
    s_waitcnt lgkmcnt(0)
    v_mov_b32 v40, -1
    v_mov_b32 v41, -1
    v_mov_b32 v42, -1
    v_mov_b32 v43, -1
    s_add_u32 s3, s42, 1
    s_bitset1_b32 s36, s3
    s_branch L2_xg6
L2_p2s:
    s_sleep 8
    s_branch L2_p2
L2_c7:
    s_lshl_b64 s[52:53], s[82:83], 1
    s_andn2_b64 s[52:53], s[52:53], s[80:81]
    s_andn2_b64 s[52:53], s[52:53], s[54:55]
    s_or_b64 s[80:81], s[80:81], s[52:53]
    s_not_b64 vcc, s[52:53]
    s_mov_b64 exec, -1
    v_cndmask_b32_dpp v84, v84, v84, vcc wave_shr:1 row_mask:0xf bank_mask:0xf
    v_cndmask_b32_dpp v85, v85, v85, vcc wave_shr:1 row_mask:0xf bank_mask:0xf
    s_lshr_b64 s[52:53], s[52:53], 1
    v_cndmask_b32_dpp v86, v86, v86, vcc wave_shr:1 row_mask:0xf bank_mask:0xf
    v_cndmask_b32_dpp v87, v87, v87, vcc wave_shr:1 row_mask:0xf bank_mask:0xf
    s_andn2_b64 s[82:83], s[82:83], s[52:53]
    v_cndmask_b32_dpp v7, v7, v7, vcc wave_shr:1 row_mask:0xf bank_mask:0xf
    s_mov_b64 exec, s[54:55]
    s_cbranch_scc0 L2_d7
    s_mov_b64 exec, s[82:83]
    s_nop 1
    v_mfma_f32_4x4x4_16b_bf16 v[88:91], v[12:13], v[84:85], 0
    s_nop 1
    v_mfma_f32_4x4x4_16b_bf16 v[88:91], v[10:11], v[86:87], v[88:91]
    s_nop 4
    v_cvt_pk_bf16_f32 v88, v88, v89
    v_cvt_pk_bf16_f32 v89, v90, v91
    ds_pk_add_bf16 v7, v88 offset:65408
    ds_pk_add_bf16 v7, v89 offset:65412
    s_mov_b64 exec, s[54:55]
    s_branch L2_d7
L2_c8:
    s_lshl_b64 s[52:53], s[82:83], 1
    s_andn2_b64 s[52:53], s[52:53], s[80:81]
    s_andn2_b64 s[52:53], s[52:53], s[50:51]
    s_or_b64 s[80:81], s[80:81], s[52:53]
    s_not_b64 vcc, s[52:53]
    s_mov_b64 exec, -1
    v_cndmask_b32_dpp v84, v84, v84, vcc wave_shr:1 row_mask:0xf bank_mask:0xf
    v_cndmask_b32_dpp v85, v85, v85, vcc wave_shr:1 row_mask:0xf bank_mask:0xf
    s_lshr_b64 s[52:53], s[52:53], 1
    v_cndmask_b32_dpp v86, v86, v86, vcc wave_shr:1 row_mask:0xf bank_mask:0xf
    v_cndmask_b32_dpp v87, v87, v87, vcc wave_shr:1 row_mask:0xf bank_mask:0xf
    s_andn2_b64 s[82:83], s[82:83], s[52:53]
    v_cndmask_b32_dpp v7, v7, v7, vcc wave_shr:1 row_mask:0xf bank_mask:0xf
    s_mov_b64 exec, s[50:51]
    s_cbranch_scc0 L2_d8
    s_mov_b64 exec, s[82:83]
    s_nop 1
    v_mfma_f32_4x4x4_16b_bf16 v[88:91], v[12:13], v[84:85], 0
    s_nop 1
    v_mfma_f32_4x4x4_16b_bf16 v[88:91], v[10:11], v[86:87], v[88:91]
    s_nop 4
    v_cvt_pk_bf16_f32 v88, v88, v89
    v_cvt_pk_bf16_f32 v89, v90, v91
    ds_pk_add_bf16 v7, v88 offset:65408
    ds_pk_add_bf16 v7, v89 offset:65412
    s_mov_b64 exec, s[50:51]
    s_branch L2_d8
L2_xo9:
    v_cmp_lt_u32 vcc, 20, v99
    s_mov_b32 s101, 1
    s_cbranch_vccz L2_xp9
    v_cmp_lt_u32 vcc, 32, v99
    v_cmp_lt_u32 s[58:59], 31, v88
    s_mov_b32 s101, 2
    s_or_b64 vcc, vcc, s[58:59]
    s_cbranch_scc0 L2_xp9
    s_mov_b32 s37, 0x10000
    s_branch L2_xp9
L2_c12:
    s_lshl_b64 s[52:53], s[82:83], 1
    s_andn2_b64 s[52:53], s[52:53], s[80:81]
    s_andn2_b64 s[52:53], s[52:53], s[54:55]
    s_or_b64 s[80:81], s[80:81], s[52:53]
    s_not_b64 vcc, s[52:53]
    s_mov_b64 exec, -1
    v_cndmask_b32_dpp v84, v84, v84, vcc wave_shr:1 row_mask:0xf bank_mask:0xf
    v_cndmask_b32_dpp v85, v85, v85, vcc wave_shr:1 row_mask:0xf bank_mask:0xf
    s_lshr_b64 s[52:53], s[52:53], 1
    v_cndmask_b32_dpp v86, v86, v86, vcc wave_shr:1 row_mask:0xf bank_mask:0xf
    v_cndmask_b32_dpp v87, v87, v87, vcc wave_shr:1 row_mask:0xf bank_mask:0xf
    s_andn2_b64 s[82:83], s[82:83], s[52:53]
    v_cndmask_b32_dpp v7, v7, v7, vcc wave_shr:1 row_mask:0xf bank_mask:0xf
    s_mov_b64 exec, s[54:55]
    s_cbranch_scc0 L2_d12
    s_mov_b64 exec, s[82:83]
    s_nop 1
    v_mfma_f32_4x4x4_16b_bf16 v[88:91], v[12:13], v[84:85], 0
    s_nop 1
    v_mfma_f32_4x4x4_16b_bf16 v[88:91], v[10:11], v[86:87], v[88:91]
    s_nop 4
    v_cvt_pk_bf16_f32 v88, v88, v89
    v_cvt_pk_bf16_f32 v89, v90, v91
    ds_pk_add_bf16 v7, v88 offset:65408
    ds_pk_add_bf16 v7, v89 offset:65412
    s_mov_b64 exec, s[54:55]
    s_branch L2_d12
L2_c13:
    s_lshl_b64 s[52:53], s[82:83], 1
    s_andn2_b64 s[52:53], s[52:53], s[80:81]
    s_andn2_b64 s[52:53], s[52:53], s[50:51]
    s_or_b64 s[80:81], s[80:81], s[52:53]
    s_not_b64 vcc, s[52:53]
    s_mov_b64 exec, -1
    v_cndmask_b32_dpp v84, v84, v84, vcc wave_shr:1 row_mask:0xf bank_mask:0xf
    v_cndmask_b32_dpp v85, v85, v85, vcc wave_shr:1 row_mask:0xf bank_mask:0xf
    s_lshr_b64 s[52:53], s[52:53], 1
    v_cndmask_b32_dpp v86, v86, v86, vcc wave_shr:1 row_mask:0xf bank_mask:0xf
    v_cndmask_b32_dpp v87, v87, v87, vcc wave_shr:1 row_mask:0xf bank_mask:0xf
    s_andn2_b64 s[82:83], s[82:83], s[52:53]
    v_cndmask_b32_dpp v7, v7, v7, vcc wave_shr:1 row_mask:0xf bank_mask:0xf
    s_mov_b64 exec, s[50:51]
    s_cbranch_scc0 L2_d13
    s_mov_b64 exec, s[82:83]
    s_nop 1
    v_mfma_f32_4x4x4_16b_bf16 v[88:91], v[12:13], v[84:85], 0
    s_nop 1
    v_mfma_f32_4x4x4_16b_bf16 v[88:91], v[10:11], v[86:87], v[88:91]
    s_nop 4
    v_cvt_pk_bf16_f32 v88, v88, v89
    v_cvt_pk_bf16_f32 v89, v90, v91
    ds_pk_add_bf16 v7, v88 offset:65408
    ds_pk_add_bf16 v7, v89 offset:65412
    s_mov_b64 exec, s[50:51]
    s_branch L2_d13
L2_c15:
    s_lshl_b64 s[52:53], s[82:83], 1
    s_andn2_b64 s[52:53], s[52:53], s[80:81]
    s_andn2_b64 s[52:53], s[52:53], s[54:55]
    s_or_b64 s[80:81], s[80:81], s[52:53]
    s_not_b64 vcc, s[52:53]
    s_mov_b64 exec, -1
    v_cndmask_b32_dpp v84, v84, v84, vcc wave_shr:1 row_mask:0xf bank_mask:0xf
    v_cndmask_b32_dpp v85, v85, v85, vcc wave_shr:1 row_mask:0xf bank_mask:0xf
    s_lshr_b64 s[52:53], s[52:53], 1
    v_cndmask_b32_dpp v86, v86, v86, vcc wave_shr:1 row_mask:0xf bank_mask:0xf
    v_cndmask_b32_dpp v87, v87, v87, vcc wave_shr:1 row_mask:0xf bank_mask:0xf
    s_andn2_b64 s[82:83], s[82:83], s[52:53]
    v_cndmask_b32_dpp v7, v7, v7, vcc wave_shr:1 row_mask:0xf bank_mask:0xf
    s_mov_b64 exec, s[54:55]
    s_cbranch_scc0 L2_d15
    s_mov_b64 exec, s[82:83]
    s_nop 1
    v_mfma_f32_4x4x4_16b_bf16 v[88:91], v[12:13], v[84:85], 0
    s_nop 1
    v_mfma_f32_4x4x4_16b_bf16 v[88:91], v[10:11], v[86:87], v[88:91]
    s_nop 4
    v_cvt_pk_bf16_f32 v88, v88, v89
    v_cvt_pk_bf16_f32 v89, v90, v91
    ds_pk_add_bf16 v7, v88 offset:65408
    ds_pk_add_bf16 v7, v89 offset:65412
    s_mov_b64 exec, s[54:55]
    s_branch L2_d15
L2_c16:
    s_lshl_b64 s[52:53], s[82:83], 1
    s_andn2_b64 s[52:53], s[52:53], s[80:81]
    s_andn2_b64 s[52:53], s[52:53], s[50:51]
    s_or_b64 s[80:81], s[80:81], s[52:53]
    s_not_b64 vcc, s[52:53]
    s_mov_b64 exec, -1
    v_cndmask_b32_dpp v84, v84, v84, vcc wave_shr:1 row_mask:0xf bank_mask:0xf
    v_cndmask_b32_dpp v85, v85, v85, vcc wave_shr:1 row_mask:0xf bank_mask:0xf
    s_lshr_b64 s[52:53], s[52:53], 1
    v_cndmask_b32_dpp v86, v86, v86, vcc wave_shr:1 row_mask:0xf bank_mask:0xf
    v_cndmask_b32_dpp v87, v87, v87, vcc wave_shr:1 row_mask:0xf bank_mask:0xf
    s_andn2_b64 s[82:83], s[82:83], s[52:53]
    v_cndmask_b32_dpp v7, v7, v7, vcc wave_shr:1 row_mask:0xf bank_mask:0xf
    s_mov_b64 exec, s[50:51]
    s_cbranch_scc0 L2_d16
    s_mov_b64 exec, s[82:83]
    s_nop 1
    v_mfma_f32_4x4x4_16b_bf16 v[88:91], v[12:13], v[84:85], 0
    s_nop 1
    v_mfma_f32_4x4x4_16b_bf16 v[88:91], v[10:11], v[86:87], v[88:91]
    s_nop 4
    v_cvt_pk_bf16_f32 v88, v88, v89
    v_cvt_pk_bf16_f32 v89, v90, v91
    ds_pk_add_bf16 v7, v88 offset:65408
    ds_pk_add_bf16 v7, v89 offset:65412
    s_mov_b64 exec, s[50:51]
    s_branch L2_d16
L2_c19:
    s_lshl_b64 s[52:53], s[82:83], 1
    s_andn2_b64 s[52:53], s[52:53], s[80:81]
    s_andn2_b64 s[52:53], s[52:53], s[54:55]
    s_or_b64 s[80:81], s[80:81], s[52:53]
    s_not_b64 vcc, s[52:53]
    s_mov_b64 exec, -1
    v_cndmask_b32_dpp v84, v84, v84, vcc wave_shr:1 row_mask:0xf bank_mask:0xf
    v_cndmask_b32_dpp v85, v85, v85, vcc wave_shr:1 row_mask:0xf bank_mask:0xf
    s_lshr_b64 s[52:53], s[52:53], 1
    v_cndmask_b32_dpp v86, v86, v86, vcc wave_shr:1 row_mask:0xf bank_mask:0xf
    v_cndmask_b32_dpp v87, v87, v87, vcc wave_shr:1 row_mask:0xf bank_mask:0xf
    s_andn2_b64 s[82:83], s[82:83], s[52:53]
    v_cndmask_b32_dpp v7, v7, v7, vcc wave_shr:1 row_mask:0xf bank_mask:0xf
    s_mov_b64 exec, s[54:55]
    s_cbranch_scc0 L2_d19
    s_mov_b64 exec, s[82:83]
    s_nop 1
    v_mfma_f32_4x4x4_16b_bf16 v[88:91], v[12:13], v[84:85], 0
    s_nop 1
    v_mfma_f32_4x4x4_16b_bf16 v[88:91], v[10:11], v[86:87], v[88:91]
    s_nop 4
    v_cvt_pk_bf16_f32 v88, v88, v89
    v_cvt_pk_bf16_f32 v89, v90, v91
    ds_pk_add_bf16 v7, v88 offset:65408
    ds_pk_add_bf16 v7, v89 offset:65412
    s_mov_b64 exec, s[54:55]
    s_branch L2_d19
L2_c20:
    s_lshl_b64 s[52:53], s[82:83], 1
    s_andn2_b64 s[52:53], s[52:53], s[80:81]
    s_andn2_b64 s[52:53], s[52:53], s[50:51]
    s_or_b64 s[80:81], s[80:81], s[52:53]
    s_not_b64 vcc, s[52:53]
    s_mov_b64 exec, -1
    v_cndmask_b32_dpp v84, v84, v84, vcc wave_shr:1 row_mask:0xf bank_mask:0xf
    v_cndmask_b32_dpp v85, v85, v85, vcc wave_shr:1 row_mask:0xf bank_mask:0xf
    s_lshr_b64 s[52:53], s[52:53], 1
    v_cndmask_b32_dpp v86, v86, v86, vcc wave_shr:1 row_mask:0xf bank_mask:0xf
    v_cndmask_b32_dpp v87, v87, v87, vcc wave_shr:1 row_mask:0xf bank_mask:0xf
    s_andn2_b64 s[82:83], s[82:83], s[52:53]
    v_cndmask_b32_dpp v7, v7, v7, vcc wave_shr:1 row_mask:0xf bank_mask:0xf
    s_mov_b64 exec, s[50:51]
    s_cbranch_scc0 L2_d20
    s_mov_b64 exec, s[82:83]
    s_nop 1
    v_mfma_f32_4x4x4_16b_bf16 v[88:91], v[12:13], v[84:85], 0
    s_nop 1
    v_mfma_f32_4x4x4_16b_bf16 v[88:91], v[10:11], v[86:87], v[88:91]
    s_nop 4
    v_cvt_pk_bf16_f32 v88, v88, v89
    v_cvt_pk_bf16_f32 v89, v90, v91
    ds_pk_add_bf16 v7, v88 offset:65408
    ds_pk_add_bf16 v7, v89 offset:65412
    s_mov_b64 exec, s[50:51]
    s_branch L2_d20
L2_c21:
    s_lshl_b64 s[52:53], s[82:83], 1
    s_andn2_b64 s[52:53], s[52:53], s[80:81]
    s_andn2_b64 s[52:53], s[52:53], s[54:55]
    s_or_b64 s[80:81], s[80:81], s[52:53]
    s_not_b64 vcc, s[52:53]
    s_mov_b64 exec, -1
    v_cndmask_b32_dpp v84, v84, v84, vcc wave_shr:1 row_mask:0xf bank_mask:0xf
    v_cndmask_b32_dpp v85, v85, v85, vcc wave_shr:1 row_mask:0xf bank_mask:0xf
    s_lshr_b64 s[52:53], s[52:53], 1
    v_cndmask_b32_dpp v86, v86, v86, vcc wave_shr:1 row_mask:0xf bank_mask:0xf
    v_cndmask_b32_dpp v87, v87, v87, vcc wave_shr:1 row_mask:0xf bank_mask:0xf
    s_andn2_b64 s[82:83], s[82:83], s[52:53]
    v_cndmask_b32_dpp v7, v7, v7, vcc wave_shr:1 row_mask:0xf bank_mask:0xf
    s_mov_b64 exec, s[54:55]
    s_cbranch_scc0 L2_d21
    s_mov_b64 exec, s[82:83]
    s_nop 1
    v_mfma_f32_4x4x4_16b_bf16 v[88:91], v[12:13], v[84:85], 0
    s_nop 1
    v_mfma_f32_4x4x4_16b_bf16 v[88:91], v[10:11], v[86:87], v[88:91]
    s_nop 4
    v_cvt_pk_bf16_f32 v88, v88, v89
    v_cvt_pk_bf16_f32 v89, v90, v91
    ds_pk_add_bf16 v7, v88 offset:65408
    ds_pk_add_bf16 v7, v89 offset:65412
    s_mov_b64 exec, s[54:55]
    s_branch L2_d21
L2_c22:
    s_lshl_b64 s[52:53], s[82:83], 1
    s_andn2_b64 s[52:53], s[52:53], s[80:81]
    s_andn2_b64 s[52:53], s[52:53], s[50:51]
    s_or_b64 s[80:81], s[80:81], s[52:53]
    s_not_b64 vcc, s[52:53]
    s_mov_b64 exec, -1
    v_cndmask_b32_dpp v84, v84, v84, vcc wave_shr:1 row_mask:0xf bank_mask:0xf
    v_cndmask_b32_dpp v85, v85, v85, vcc wave_shr:1 row_mask:0xf bank_mask:0xf
    s_lshr_b64 s[52:53], s[52:53], 1
    v_cndmask_b32_dpp v86, v86, v86, vcc wave_shr:1 row_mask:0xf bank_mask:0xf
    v_cndmask_b32_dpp v87, v87, v87, vcc wave_shr:1 row_mask:0xf bank_mask:0xf
    s_andn2_b64 s[82:83], s[82:83], s[52:53]
    v_cndmask_b32_dpp v7, v7, v7, vcc wave_shr:1 row_mask:0xf bank_mask:0xf
    s_mov_b64 exec, s[50:51]
    s_cbranch_scc0 L2_d22
    s_mov_b64 exec, s[82:83]
    s_nop 1
    v_mfma_f32_4x4x4_16b_bf16 v[88:91], v[12:13], v[84:85], 0
    s_nop 1
    v_mfma_f32_4x4x4_16b_bf16 v[88:91], v[10:11], v[86:87], v[88:91]
    s_nop 4
    v_cvt_pk_bf16_f32 v88, v88, v89
    v_cvt_pk_bf16_f32 v89, v90, v91
    ds_pk_add_bf16 v7, v88 offset:65408
    ds_pk_add_bf16 v7, v89 offset:65412
    s_mov_b64 exec, s[50:51]
    s_branch L2_d22
L2_c23:
    s_lshl_b64 s[52:53], s[82:83], 1
    s_andn2_b64 s[52:53], s[52:53], s[80:81]
    s_andn2_b64 s[52:53], s[52:53], s[54:55]
    s_or_b64 s[80:81], s[80:81], s[52:53]
    s_not_b64 vcc, s[52:53]
    s_mov_b64 exec, -1
    v_cndmask_b32_dpp v84, v84, v84, vcc wave_shr:1 row_mask:0xf bank_mask:0xf
    v_cndmask_b32_dpp v85, v85, v85, vcc wave_shr:1 row_mask:0xf bank_mask:0xf
    s_lshr_b64 s[52:53], s[52:53], 1
    v_cndmask_b32_dpp v86, v86, v86, vcc wave_shr:1 row_mask:0xf bank_mask:0xf
    v_cndmask_b32_dpp v87, v87, v87, vcc wave_shr:1 row_mask:0xf bank_mask:0xf
    s_andn2_b64 s[82:83], s[82:83], s[52:53]
    v_cndmask_b32_dpp v7, v7, v7, vcc wave_shr:1 row_mask:0xf bank_mask:0xf
    s_mov_b64 exec, s[54:55]
    s_cbranch_scc0 L2_d23
    s_mov_b64 exec, s[82:83]
    s_nop 1
    v_mfma_f32_4x4x4_16b_bf16 v[88:91], v[12:13], v[84:85], 0
    s_nop 1
    v_mfma_f32_4x4x4_16b_bf16 v[88:91], v[10:11], v[86:87], v[88:91]
    s_nop 4
    v_cvt_pk_bf16_f32 v88, v88, v89
    v_cvt_pk_bf16_f32 v89, v90, v91
    ds_pk_add_bf16 v7, v88 offset:65408
    ds_pk_add_bf16 v7, v89 offset:65412
    s_mov_b64 exec, s[54:55]
    s_branch L2_d23
L2_c24:
    s_lshl_b64 s[52:53], s[82:83], 1
    s_andn2_b64 s[52:53], s[52:53], s[80:81]
    s_andn2_b64 s[52:53], s[52:53], s[50:51]
    s_or_b64 s[80:81], s[80:81], s[52:53]
    s_not_b64 vcc, s[52:53]
    s_mov_b64 exec, -1
    v_cndmask_b32_dpp v84, v84, v84, vcc wave_shr:1 row_mask:0xf bank_mask:0xf
    v_cndmask_b32_dpp v85, v85, v85, vcc wave_shr:1 row_mask:0xf bank_mask:0xf
    s_lshr_b64 s[52:53], s[52:53], 1
    v_cndmask_b32_dpp v86, v86, v86, vcc wave_shr:1 row_mask:0xf bank_mask:0xf
    v_cndmask_b32_dpp v87, v87, v87, vcc wave_shr:1 row_mask:0xf bank_mask:0xf
    s_andn2_b64 s[82:83], s[82:83], s[52:53]
    v_cndmask_b32_dpp v7, v7, v7, vcc wave_shr:1 row_mask:0xf bank_mask:0xf
    s_mov_b64 exec, s[50:51]
    s_cbranch_scc0 L2_d24
    s_mov_b64 exec, s[82:83]
    s_nop 1
    v_mfma_f32_4x4x4_16b_bf16 v[88:91], v[12:13], v[84:85], 0
    s_nop 1
    v_mfma_f32_4x4x4_16b_bf16 v[88:91], v[10:11], v[86:87], v[88:91]
    s_nop 4
    v_cvt_pk_bf16_f32 v88, v88, v89
    v_cvt_pk_bf16_f32 v89, v90, v91
    ds_pk_add_bf16 v7, v88 offset:65408
    ds_pk_add_bf16 v7, v89 offset:65412
    s_mov_b64 exec, s[50:51]
    s_branch L2_d24
L2_xa25:
    s_cmp_eq_u32 s101, 1
    s_cbranch_scc1 L2_xc25
    v_lshlrev_b32 v89, 0, v96
    v_add_u32 v90, 140, v97
    v_bitop3_b32 v90, v89, v45, v90 bitop3:0x6a
    ds_write_b32 v98, v90 offset:28
    v_lshlrev_b32 v89, 4, v96
    v_add_u32 v90, 120, v97
    v_bitop3_b32 v90, v89, v45, v90 bitop3:0x6a
    ds_write_b32 v98, v90 offset:24
    v_lshlrev_b32 v89, 8, v96
    v_add_u32 v90, 100, v97
    v_bitop3_b32 v90, v89, v45, v90 bitop3:0x6a
    ds_write_b32 v98, v90 offset:20
L2_xc25:
    v_lshlrev_b32 v89, 12, v96
    v_add_u32 v90, 80, v97
    v_bitop3_b32 v90, v89, v45, v90 bitop3:0x6a
    ds_write_b32 v98, v90 offset:16
    s_branch L2_xb25
L2_xe25:
    v_cmp_lt_u32 vcc, 32, v99
    v_cmp_lt_u32 s[58:59], 31, v88
    v_lshrrev_b32 v89, 16, v96
    v_add_u32 v97, 80, v97
    s_or_b64 vcc, vcc, s[58:59]
    s_cbranch_scc1 L2_xs25
    v_lshlrev_b32 v89, v1, v89
    v_and_b32 v89, v45, v89
    v_cmp_ne_u32 vcc, 0, v89
    v_xor_b32 v90, v97, v89
    s_add_u32 s3, s37, s38
    v_mbcnt_lo_u32_b32 v98, vcc_lo, 0
    v_mbcnt_hi_u32_b32 v98, vcc_hi, v98
    s_bcnt1_i32_b64 s41, vcc
    v_lshl_add_u32 v98, v98, 2, s3
    s_mov_b64 exec, vcc
    ds_write_b32 v98, v90
    s_mov_b64 exec, -1
    s_lshl2_add_u32 s37, s41, s37
    s_branch L2_xr25
L2_xf25:
    s_waitcnt lgkmcnt(0)
    s_cmp_gt_u32 s37, 1024
    s_cbranch_scc1 L2_xs25
    v_mov_b32 v43, -1
    s_cmp_ge_u32 s37, 512
    s_cbranch_scc1 L2_xg25
    v_mov_b32 v42, -1
    s_cmp_ge_u32 s37, 256
    s_cbranch_scc1 L2_xg25
    v_mov_b32 v41, -1
    s_branch L2_xg25
L2_xs25:
    s_waitcnt lgkmcnt(0)
    v_mov_b32 v40, -1
    v_mov_b32 v41, -1
    v_mov_b32 v42, -1
    v_mov_b32 v43, -1
    s_add_u32 s3, s42, 2
    s_bitset1_b32 s36, s3
    s_branch L2_xg25
L2_c26:
    s_lshl_b64 s[52:53], s[82:83], 1
    s_andn2_b64 s[52:53], s[52:53], s[80:81]
    s_andn2_b64 s[52:53], s[52:53], s[54:55]
    s_or_b64 s[80:81], s[80:81], s[52:53]
    s_not_b64 vcc, s[52:53]
    s_mov_b64 exec, -1
    v_cndmask_b32_dpp v84, v84, v84, vcc wave_shr:1 row_mask:0xf bank_mask:0xf
    v_cndmask_b32_dpp v85, v85, v85, vcc wave_shr:1 row_mask:0xf bank_mask:0xf
    s_lshr_b64 s[52:53], s[52:53], 1
    v_cndmask_b32_dpp v86, v86, v86, vcc wave_shr:1 row_mask:0xf bank_mask:0xf
    v_cndmask_b32_dpp v87, v87, v87, vcc wave_shr:1 row_mask:0xf bank_mask:0xf
    s_andn2_b64 s[82:83], s[82:83], s[52:53]
    v_cndmask_b32_dpp v7, v7, v7, vcc wave_shr:1 row_mask:0xf bank_mask:0xf
    s_mov_b64 exec, s[54:55]
    s_cbranch_scc0 L2_d26
    s_mov_b64 exec, s[82:83]
    s_nop 1
    v_mfma_f32_4x4x4_16b_bf16 v[88:91], v[12:13], v[84:85], 0
    s_nop 1
    v_mfma_f32_4x4x4_16b_bf16 v[88:91], v[10:11], v[86:87], v[88:91]
    s_nop 4
    v_cvt_pk_bf16_f32 v88, v88, v89
    v_cvt_pk_bf16_f32 v89, v90, v91
    ds_pk_add_bf16 v7, v88 offset:65408
    ds_pk_add_bf16 v7, v89 offset:65412
    s_mov_b64 exec, s[54:55]
    s_branch L2_d26
L2_c27:
    s_lshl_b64 s[52:53], s[82:83], 1
    s_andn2_b64 s[52:53], s[52:53], s[80:81]
    s_andn2_b64 s[52:53], s[52:53], s[50:51]
    s_or_b64 s[80:81], s[80:81], s[52:53]
    s_not_b64 vcc, s[52:53]
    s_mov_b64 exec, -1
    v_cndmask_b32_dpp v84, v84, v84, vcc wave_shr:1 row_mask:0xf bank_mask:0xf
    v_cndmask_b32_dpp v85, v85, v85, vcc wave_shr:1 row_mask:0xf bank_mask:0xf
    s_lshr_b64 s[52:53], s[52:53], 1
    v_cndmask_b32_dpp v86, v86, v86, vcc wave_shr:1 row_mask:0xf bank_mask:0xf
    v_cndmask_b32_dpp v87, v87, v87, vcc wave_shr:1 row_mask:0xf bank_mask:0xf
    s_andn2_b64 s[82:83], s[82:83], s[52:53]
    v_cndmask_b32_dpp v7, v7, v7, vcc wave_shr:1 row_mask:0xf bank_mask:0xf
    s_mov_b64 exec, s[50:51]
    s_cbranch_scc0 L2_d27
    s_mov_b64 exec, s[82:83]
    s_nop 1
    v_mfma_f32_4x4x4_16b_bf16 v[88:91], v[12:13], v[84:85], 0
    s_nop 1
    v_mfma_f32_4x4x4_16b_bf16 v[88:91], v[10:11], v[86:87], v[88:91]
    s_nop 4
    v_cvt_pk_bf16_f32 v88, v88, v89
    v_cvt_pk_bf16_f32 v89, v90, v91
    ds_pk_add_bf16 v7, v88 offset:65408
    ds_pk_add_bf16 v7, v89 offset:65412
    s_mov_b64 exec, s[50:51]
    s_branch L2_d27
L2_c28:
    s_lshl_b64 s[52:53], s[82:83], 1
    s_andn2_b64 s[52:53], s[52:53], s[80:81]
    s_andn2_b64 s[52:53], s[52:53], s[54:55]
    s_or_b64 s[80:81], s[80:81], s[52:53]
    s_not_b64 vcc, s[52:53]
    s_mov_b64 exec, -1
    v_cndmask_b32_dpp v84, v84, v84, vcc wave_shr:1 row_mask:0xf bank_mask:0xf
    v_cndmask_b32_dpp v85, v85, v85, vcc wave_shr:1 row_mask:0xf bank_mask:0xf
    s_lshr_b64 s[52:53], s[52:53], 1
    v_cndmask_b32_dpp v86, v86, v86, vcc wave_shr:1 row_mask:0xf bank_mask:0xf
    v_cndmask_b32_dpp v87, v87, v87, vcc wave_shr:1 row_mask:0xf bank_mask:0xf
    s_andn2_b64 s[82:83], s[82:83], s[52:53]
    v_cndmask_b32_dpp v7, v7, v7, vcc wave_shr:1 row_mask:0xf bank_mask:0xf
    s_mov_b64 exec, s[54:55]
    s_cbranch_scc0 L2_d28
    s_mov_b64 exec, s[82:83]
    s_nop 1
    v_mfma_f32_4x4x4_16b_bf16 v[88:91], v[12:13], v[84:85], 0
    s_nop 1
    v_mfma_f32_4x4x4_16b_bf16 v[88:91], v[10:11], v[86:87], v[88:91]
    s_nop 4
    v_cvt_pk_bf16_f32 v88, v88, v89
    v_cvt_pk_bf16_f32 v89, v90, v91
    ds_pk_add_bf16 v7, v88 offset:65408
    ds_pk_add_bf16 v7, v89 offset:65412
    s_mov_b64 exec, s[54:55]
    s_branch L2_d28
L2_c29:
    s_lshl_b64 s[52:53], s[82:83], 1
    s_andn2_b64 s[52:53], s[52:53], s[80:81]
    s_andn2_b64 s[52:53], s[52:53], s[50:51]
    s_or_b64 s[80:81], s[80:81], s[52:53]
    s_not_b64 vcc, s[52:53]
    s_mov_b64 exec, -1
    v_cndmask_b32_dpp v84, v84, v84, vcc wave_shr:1 row_mask:0xf bank_mask:0xf
    v_cndmask_b32_dpp v85, v85, v85, vcc wave_shr:1 row_mask:0xf bank_mask:0xf
    s_lshr_b64 s[52:53], s[52:53], 1
    v_cndmask_b32_dpp v86, v86, v86, vcc wave_shr:1 row_mask:0xf bank_mask:0xf
    v_cndmask_b32_dpp v87, v87, v87, vcc wave_shr:1 row_mask:0xf bank_mask:0xf
    s_andn2_b64 s[82:83], s[82:83], s[52:53]
    v_cndmask_b32_dpp v7, v7, v7, vcc wave_shr:1 row_mask:0xf bank_mask:0xf
    s_mov_b64 exec, s[50:51]
    s_cbranch_scc0 L2_d29
    s_mov_b64 exec, s[82:83]
    s_nop 1
    v_mfma_f32_4x4x4_16b_bf16 v[88:91], v[12:13], v[84:85], 0
    s_nop 1
    v_mfma_f32_4x4x4_16b_bf16 v[88:91], v[10:11], v[86:87], v[88:91]
    s_nop 4
    v_cvt_pk_bf16_f32 v88, v88, v89
    v_cvt_pk_bf16_f32 v89, v90, v91
    ds_pk_add_bf16 v7, v88 offset:65408
    ds_pk_add_bf16 v7, v89 offset:65412
    s_mov_b64 exec, s[50:51]
    s_branch L2_d29
L2_c30:
    s_lshl_b64 s[52:53], s[82:83], 1
    s_andn2_b64 s[52:53], s[52:53], s[80:81]
    s_andn2_b64 s[52:53], s[52:53], s[54:55]
    s_or_b64 s[80:81], s[80:81], s[52:53]
    s_not_b64 vcc, s[52:53]
    s_mov_b64 exec, -1
    v_cndmask_b32_dpp v84, v84, v84, vcc wave_shr:1 row_mask:0xf bank_mask:0xf
    v_cndmask_b32_dpp v85, v85, v85, vcc wave_shr:1 row_mask:0xf bank_mask:0xf
    s_lshr_b64 s[52:53], s[52:53], 1
    v_cndmask_b32_dpp v86, v86, v86, vcc wave_shr:1 row_mask:0xf bank_mask:0xf
    v_cndmask_b32_dpp v87, v87, v87, vcc wave_shr:1 row_mask:0xf bank_mask:0xf
    s_andn2_b64 s[82:83], s[82:83], s[52:53]
    v_cndmask_b32_dpp v7, v7, v7, vcc wave_shr:1 row_mask:0xf bank_mask:0xf
    s_mov_b64 exec, s[54:55]
    s_cbranch_scc0 L2_d30
    s_mov_b64 exec, s[82:83]
    s_nop 1
    v_mfma_f32_4x4x4_16b_bf16 v[88:91], v[12:13], v[84:85], 0
    s_nop 1
    v_mfma_f32_4x4x4_16b_bf16 v[88:91], v[10:11], v[86:87], v[88:91]
    s_nop 4
    v_cvt_pk_bf16_f32 v88, v88, v89
    v_cvt_pk_bf16_f32 v89, v90, v91
    ds_pk_add_bf16 v7, v88 offset:65408
    ds_pk_add_bf16 v7, v89 offset:65412
    s_mov_b64 exec, s[54:55]
    s_branch L2_d30
L2_c31:
    s_lshl_b64 s[52:53], s[82:83], 1
    s_andn2_b64 s[52:53], s[52:53], s[80:81]
    s_andn2_b64 s[52:53], s[52:53], s[50:51]
    s_or_b64 s[80:81], s[80:81], s[52:53]
    s_not_b64 vcc, s[52:53]
    s_mov_b64 exec, -1
    v_cndmask_b32_dpp v84, v84, v84, vcc wave_shr:1 row_mask:0xf bank_mask:0xf
    v_cndmask_b32_dpp v85, v85, v85, vcc wave_shr:1 row_mask:0xf bank_mask:0xf
    s_lshr_b64 s[52:53], s[52:53], 1
    v_cndmask_b32_dpp v86, v86, v86, vcc wave_shr:1 row_mask:0xf bank_mask:0xf
    v_cndmask_b32_dpp v87, v87, v87, vcc wave_shr:1 row_mask:0xf bank_mask:0xf
    s_andn2_b64 s[82:83], s[82:83], s[52:53]
    v_cndmask_b32_dpp v7, v7, v7, vcc wave_shr:1 row_mask:0xf bank_mask:0xf
    s_mov_b64 exec, s[50:51]
    s_cbranch_scc0 L2_d31
    s_mov_b64 exec, s[82:83]
    s_nop 1
    v_mfma_f32_4x4x4_16b_bf16 v[88:91], v[12:13], v[84:85], 0
    s_nop 1
    v_mfma_f32_4x4x4_16b_bf16 v[88:91], v[10:11], v[86:87], v[88:91]
    s_nop 4
    v_cvt_pk_bf16_f32 v88, v88, v89
    v_cvt_pk_bf16_f32 v89, v90, v91
    ds_pk_add_bf16 v7, v88 offset:65408
    ds_pk_add_bf16 v7, v89 offset:65412
    s_mov_b64 exec, s[50:51]
    s_branch L2_d31
L2_xo32:
    v_cmp_lt_u32 vcc, 20, v99
    s_mov_b32 s101, 1
    s_cbranch_vccz L2_xp32
    v_cmp_lt_u32 vcc, 32, v99
    v_cmp_lt_u32 s[58:59], 31, v88
    s_mov_b32 s101, 2
    s_or_b64 vcc, vcc, s[58:59]
    s_cbranch_scc0 L2_xp32
    s_mov_b32 s37, 0x10000
    s_branch L2_xp32
L2_c33:
    s_lshl_b64 s[52:53], s[82:83], 1
    s_andn2_b64 s[52:53], s[52:53], s[80:81]
    s_andn2_b64 s[52:53], s[52:53], s[54:55]
    s_or_b64 s[80:81], s[80:81], s[52:53]
    s_not_b64 vcc, s[52:53]
    s_mov_b64 exec, -1
    v_cndmask_b32_dpp v84, v84, v84, vcc wave_shr:1 row_mask:0xf bank_mask:0xf
    v_cndmask_b32_dpp v85, v85, v85, vcc wave_shr:1 row_mask:0xf bank_mask:0xf
    s_lshr_b64 s[52:53], s[52:53], 1
    v_cndmask_b32_dpp v86, v86, v86, vcc wave_shr:1 row_mask:0xf bank_mask:0xf
    v_cndmask_b32_dpp v87, v87, v87, vcc wave_shr:1 row_mask:0xf bank_mask:0xf
    s_andn2_b64 s[82:83], s[82:83], s[52:53]
    v_cndmask_b32_dpp v7, v7, v7, vcc wave_shr:1 row_mask:0xf bank_mask:0xf
    s_mov_b64 exec, s[54:55]
    s_cbranch_scc0 L2_d33
    s_mov_b64 exec, s[82:83]
    s_nop 1
    v_mfma_f32_4x4x4_16b_bf16 v[88:91], v[12:13], v[84:85], 0
    s_nop 1
    v_mfma_f32_4x4x4_16b_bf16 v[88:91], v[10:11], v[86:87], v[88:91]
    s_nop 4
    v_cvt_pk_bf16_f32 v88, v88, v89
    v_cvt_pk_bf16_f32 v89, v90, v91
    ds_pk_add_bf16 v7, v88 offset:65408
    ds_pk_add_bf16 v7, v89 offset:65412
    s_mov_b64 exec, s[54:55]
    s_branch L2_d33
L2_c34:
    s_lshl_b64 s[52:53], s[82:83], 1
    s_andn2_b64 s[52:53], s[52:53], s[80:81]
    s_andn2_b64 s[52:53], s[52:53], s[50:51]
    s_or_b64 s[80:81], s[80:81], s[52:53]
    s_not_b64 vcc, s[52:53]
    s_mov_b64 exec, -1
    v_cndmask_b32_dpp v84, v84, v84, vcc wave_shr:1 row_mask:0xf bank_mask:0xf
    v_cndmask_b32_dpp v85, v85, v85, vcc wave_shr:1 row_mask:0xf bank_mask:0xf
    s_lshr_b64 s[52:53], s[52:53], 1
    v_cndmask_b32_dpp v86, v86, v86, vcc wave_shr:1 row_mask:0xf bank_mask:0xf
    v_cndmask_b32_dpp v87, v87, v87, vcc wave_shr:1 row_mask:0xf bank_mask:0xf
    s_andn2_b64 s[82:83], s[82:83], s[52:53]
    v_cndmask_b32_dpp v7, v7, v7, vcc wave_shr:1 row_mask:0xf bank_mask:0xf
    s_mov_b64 exec, s[50:51]
    s_cbranch_scc0 L2_d34
    s_mov_b64 exec, s[82:83]
    s_nop 1
    v_mfma_f32_4x4x4_16b_bf16 v[88:91], v[12:13], v[84:85], 0
    s_nop 1
    v_mfma_f32_4x4x4_16b_bf16 v[88:91], v[10:11], v[86:87], v[88:91]
    s_nop 4
    v_cvt_pk_bf16_f32 v88, v88, v89
    v_cvt_pk_bf16_f32 v89, v90, v91
    ds_pk_add_bf16 v7, v88 offset:65408
    ds_pk_add_bf16 v7, v89 offset:65412
    s_mov_b64 exec, s[50:51]
    s_branch L2_d34
L2_c35:
    s_lshl_b64 s[52:53], s[82:83], 1
    s_andn2_b64 s[52:53], s[52:53], s[80:81]
    s_andn2_b64 s[52:53], s[52:53], s[54:55]
    s_or_b64 s[80:81], s[80:81], s[52:53]
    s_not_b64 vcc, s[52:53]
    s_mov_b64 exec, -1
    v_cndmask_b32_dpp v84, v84, v84, vcc wave_shr:1 row_mask:0xf bank_mask:0xf
    v_cndmask_b32_dpp v85, v85, v85, vcc wave_shr:1 row_mask:0xf bank_mask:0xf
    s_lshr_b64 s[52:53], s[52:53], 1
    v_cndmask_b32_dpp v86, v86, v86, vcc wave_shr:1 row_mask:0xf bank_mask:0xf
    v_cndmask_b32_dpp v87, v87, v87, vcc wave_shr:1 row_mask:0xf bank_mask:0xf
    s_andn2_b64 s[82:83], s[82:83], s[52:53]
    v_cndmask_b32_dpp v7, v7, v7, vcc wave_shr:1 row_mask:0xf bank_mask:0xf
    s_mov_b64 exec, s[54:55]
    s_cbranch_scc0 L2_d35
    s_mov_b64 exec, s[82:83]
    s_nop 1
    v_mfma_f32_4x4x4_16b_bf16 v[88:91], v[12:13], v[84:85], 0
    s_nop 1
    v_mfma_f32_4x4x4_16b_bf16 v[88:91], v[10:11], v[86:87], v[88:91]
    s_nop 4
    v_cvt_pk_bf16_f32 v88, v88, v89
    v_cvt_pk_bf16_f32 v89, v90, v91
    ds_pk_add_bf16 v7, v88 offset:65408
    ds_pk_add_bf16 v7, v89 offset:65412
    s_mov_b64 exec, s[54:55]
    s_branch L2_d35
L2_c36:
    s_lshl_b64 s[52:53], s[82:83], 1
    s_andn2_b64 s[52:53], s[52:53], s[80:81]
    s_andn2_b64 s[52:53], s[52:53], s[50:51]
    s_or_b64 s[80:81], s[80:81], s[52:53]
    s_not_b64 vcc, s[52:53]
    s_mov_b64 exec, -1
    v_cndmask_b32_dpp v84, v84, v84, vcc wave_shr:1 row_mask:0xf bank_mask:0xf
    v_cndmask_b32_dpp v85, v85, v85, vcc wave_shr:1 row_mask:0xf bank_mask:0xf
    s_lshr_b64 s[52:53], s[52:53], 1
    v_cndmask_b32_dpp v86, v86, v86, vcc wave_shr:1 row_mask:0xf bank_mask:0xf
    v_cndmask_b32_dpp v87, v87, v87, vcc wave_shr:1 row_mask:0xf bank_mask:0xf
    s_andn2_b64 s[82:83], s[82:83], s[52:53]
    v_cndmask_b32_dpp v7, v7, v7, vcc wave_shr:1 row_mask:0xf bank_mask:0xf
    s_mov_b64 exec, s[50:51]
    s_cbranch_scc0 L2_d36
    s_mov_b64 exec, s[82:83]
    s_nop 1
    v_mfma_f32_4x4x4_16b_bf16 v[88:91], v[12:13], v[84:85], 0
    s_nop 1
    v_mfma_f32_4x4x4_16b_bf16 v[88:91], v[10:11], v[86:87], v[88:91]
    s_nop 4
    v_cvt_pk_bf16_f32 v88, v88, v89
    v_cvt_pk_bf16_f32 v89, v90, v91
    ds_pk_add_bf16 v7, v88 offset:65408
    ds_pk_add_bf16 v7, v89 offset:65412
    s_mov_b64 exec, s[50:51]
    s_branch L2_d36
L2_c37:
    s_lshl_b64 s[52:53], s[82:83], 1
    s_andn2_b64 s[52:53], s[52:53], s[80:81]
    s_andn2_b64 s[52:53], s[52:53], s[54:55]
    s_or_b64 s[80:81], s[80:81], s[52:53]
    s_not_b64 vcc, s[52:53]
    s_mov_b64 exec, -1
    v_cndmask_b32_dpp v84, v84, v84, vcc wave_shr:1 row_mask:0xf bank_mask:0xf
    v_cndmask_b32_dpp v85, v85, v85, vcc wave_shr:1 row_mask:0xf bank_mask:0xf
    s_lshr_b64 s[52:53], s[52:53], 1
    v_cndmask_b32_dpp v86, v86, v86, vcc wave_shr:1 row_mask:0xf bank_mask:0xf
    v_cndmask_b32_dpp v87, v87, v87, vcc wave_shr:1 row_mask:0xf bank_mask:0xf
    s_andn2_b64 s[82:83], s[82:83], s[52:53]
    v_cndmask_b32_dpp v7, v7, v7, vcc wave_shr:1 row_mask:0xf bank_mask:0xf
    s_mov_b64 exec, s[54:55]
    s_cbranch_scc0 L2_d37
    s_mov_b64 exec, s[82:83]
    s_nop 1
    v_mfma_f32_4x4x4_16b_bf16 v[88:91], v[12:13], v[84:85], 0
    s_nop 1
    v_mfma_f32_4x4x4_16b_bf16 v[88:91], v[10:11], v[86:87], v[88:91]
    s_nop 4
    v_cvt_pk_bf16_f32 v88, v88, v89
    v_cvt_pk_bf16_f32 v89, v90, v91
    ds_pk_add_bf16 v7, v88 offset:65408
    ds_pk_add_bf16 v7, v89 offset:65412
    s_mov_b64 exec, s[54:55]
    s_branch L2_d37
L2_c38:
    s_lshl_b64 s[52:53], s[82:83], 1
    s_andn2_b64 s[52:53], s[52:53], s[80:81]
    s_andn2_b64 s[52:53], s[52:53], s[50:51]
    s_or_b64 s[80:81], s[80:81], s[52:53]
    s_not_b64 vcc, s[52:53]
    s_mov_b64 exec, -1
    v_cndmask_b32_dpp v84, v84, v84, vcc wave_shr:1 row_mask:0xf bank_mask:0xf
    v_cndmask_b32_dpp v85, v85, v85, vcc wave_shr:1 row_mask:0xf bank_mask:0xf
    s_lshr_b64 s[52:53], s[52:53], 1
    v_cndmask_b32_dpp v86, v86, v86, vcc wave_shr:1 row_mask:0xf bank_mask:0xf
    v_cndmask_b32_dpp v87, v87, v87, vcc wave_shr:1 row_mask:0xf bank_mask:0xf
    s_andn2_b64 s[82:83], s[82:83], s[52:53]
    v_cndmask_b32_dpp v7, v7, v7, vcc wave_shr:1 row_mask:0xf bank_mask:0xf
    s_mov_b64 exec, s[50:51]
    s_cbranch_scc0 L2_d38
    s_mov_b64 exec, s[82:83]
    s_nop 1
    v_mfma_f32_4x4x4_16b_bf16 v[88:91], v[12:13], v[84:85], 0
    s_nop 1
    v_mfma_f32_4x4x4_16b_bf16 v[88:91], v[10:11], v[86:87], v[88:91]
    s_nop 4
    v_cvt_pk_bf16_f32 v88, v88, v89
    v_cvt_pk_bf16_f32 v89, v90, v91
    ds_pk_add_bf16 v7, v88 offset:65408
    ds_pk_add_bf16 v7, v89 offset:65412
    s_mov_b64 exec, s[50:51]
    s_branch L2_d38
L2_c39:
    s_lshl_b64 s[52:53], s[82:83], 1
    s_andn2_b64 s[52:53], s[52:53], s[80:81]
    s_andn2_b64 s[52:53], s[52:53], s[54:55]
    s_or_b64 s[80:81], s[80:81], s[52:53]
    s_not_b64 vcc, s[52:53]
    s_mov_b64 exec, -1
    v_cndmask_b32_dpp v84, v84, v84, vcc wave_shr:1 row_mask:0xf bank_mask:0xf
    v_cndmask_b32_dpp v85, v85, v85, vcc wave_shr:1 row_mask:0xf bank_mask:0xf
    s_lshr_b64 s[52:53], s[52:53], 1
    v_cndmask_b32_dpp v86, v86, v86, vcc wave_shr:1 row_mask:0xf bank_mask:0xf
    v_cndmask_b32_dpp v87, v87, v87, vcc wave_shr:1 row_mask:0xf bank_mask:0xf
    s_andn2_b64 s[82:83], s[82:83], s[52:53]
    v_cndmask_b32_dpp v7, v7, v7, vcc wave_shr:1 row_mask:0xf bank_mask:0xf
    s_mov_b64 exec, s[54:55]
    s_cbranch_scc0 L2_d39
    s_mov_b64 exec, s[82:83]
    s_nop 1
    v_mfma_f32_4x4x4_16b_bf16 v[88:91], v[12:13], v[84:85], 0
    s_nop 1
    v_mfma_f32_4x4x4_16b_bf16 v[88:91], v[10:11], v[86:87], v[88:91]
    s_nop 4
    v_cvt_pk_bf16_f32 v88, v88, v89
    v_cvt_pk_bf16_f32 v89, v90, v91
    ds_pk_add_bf16 v7, v88 offset:65408
    ds_pk_add_bf16 v7, v89 offset:65412
    s_mov_b64 exec, s[54:55]
    s_branch L2_d39
L2_c40:
    s_lshl_b64 s[52:53], s[82:83], 1
    s_andn2_b64 s[52:53], s[52:53], s[80:81]
    s_andn2_b64 s[52:53], s[52:53], s[50:51]
    s_or_b64 s[80:81], s[80:81], s[52:53]
    s_not_b64 vcc, s[52:53]
    s_mov_b64 exec, -1
    v_cndmask_b32_dpp v84, v84, v84, vcc wave_shr:1 row_mask:0xf bank_mask:0xf
    v_cndmask_b32_dpp v85, v85, v85, vcc wave_shr:1 row_mask:0xf bank_mask:0xf
    s_lshr_b64 s[52:53], s[52:53], 1
    v_cndmask_b32_dpp v86, v86, v86, vcc wave_shr:1 row_mask:0xf bank_mask:0xf
    v_cndmask_b32_dpp v87, v87, v87, vcc wave_shr:1 row_mask:0xf bank_mask:0xf
    s_andn2_b64 s[82:83], s[82:83], s[52:53]
    v_cndmask_b32_dpp v7, v7, v7, vcc wave_shr:1 row_mask:0xf bank_mask:0xf
    s_mov_b64 exec, s[50:51]
    s_cbranch_scc0 L2_d40
    s_mov_b64 exec, s[82:83]
    s_nop 1
    v_mfma_f32_4x4x4_16b_bf16 v[88:91], v[12:13], v[84:85], 0
    s_nop 1
    v_mfma_f32_4x4x4_16b_bf16 v[88:91], v[10:11], v[86:87], v[88:91]
    s_nop 4
    v_cvt_pk_bf16_f32 v88, v88, v89
    v_cvt_pk_bf16_f32 v89, v90, v91
    ds_pk_add_bf16 v7, v88 offset:65408
    ds_pk_add_bf16 v7, v89 offset:65412
    s_mov_b64 exec, s[50:51]
    s_branch L2_d40
L2_c41:
    s_lshl_b64 s[52:53], s[82:83], 1
    s_andn2_b64 s[52:53], s[52:53], s[80:81]
    s_andn2_b64 s[52:53], s[52:53], s[54:55]
    s_or_b64 s[80:81], s[80:81], s[52:53]
    s_not_b64 vcc, s[52:53]
    s_mov_b64 exec, -1
    v_cndmask_b32_dpp v84, v84, v84, vcc wave_shr:1 row_mask:0xf bank_mask:0xf
    v_cndmask_b32_dpp v85, v85, v85, vcc wave_shr:1 row_mask:0xf bank_mask:0xf
    s_lshr_b64 s[52:53], s[52:53], 1
    v_cndmask_b32_dpp v86, v86, v86, vcc wave_shr:1 row_mask:0xf bank_mask:0xf
    v_cndmask_b32_dpp v87, v87, v87, vcc wave_shr:1 row_mask:0xf bank_mask:0xf
    s_andn2_b64 s[82:83], s[82:83], s[52:53]
    v_cndmask_b32_dpp v7, v7, v7, vcc wave_shr:1 row_mask:0xf bank_mask:0xf
    s_mov_b64 exec, s[54:55]
    s_cbranch_scc0 L2_d41
    s_mov_b64 exec, s[82:83]
    s_nop 1
    v_mfma_f32_4x4x4_16b_bf16 v[88:91], v[12:13], v[84:85], 0
    s_nop 1
    v_mfma_f32_4x4x4_16b_bf16 v[88:91], v[10:11], v[86:87], v[88:91]
    s_nop 4
    v_cvt_pk_bf16_f32 v88, v88, v89
    v_cvt_pk_bf16_f32 v89, v90, v91
    ds_pk_add_bf16 v7, v88 offset:65408
    ds_pk_add_bf16 v7, v89 offset:65412
    s_mov_b64 exec, s[54:55]
    s_branch L2_d41
L2_c42:
    s_lshl_b64 s[52:53], s[82:83], 1
    s_andn2_b64 s[52:53], s[52:53], s[80:81]
    s_andn2_b64 s[52:53], s[52:53], s[50:51]
    s_or_b64 s[80:81], s[80:81], s[52:53]
    s_not_b64 vcc, s[52:53]
    s_mov_b64 exec, -1
    v_cndmask_b32_dpp v84, v84, v84, vcc wave_shr:1 row_mask:0xf bank_mask:0xf
    v_cndmask_b32_dpp v85, v85, v85, vcc wave_shr:1 row_mask:0xf bank_mask:0xf
    s_lshr_b64 s[52:53], s[52:53], 1
    v_cndmask_b32_dpp v86, v86, v86, vcc wave_shr:1 row_mask:0xf bank_mask:0xf
    v_cndmask_b32_dpp v87, v87, v87, vcc wave_shr:1 row_mask:0xf bank_mask:0xf
    s_andn2_b64 s[82:83], s[82:83], s[52:53]
    v_cndmask_b32_dpp v7, v7, v7, vcc wave_shr:1 row_mask:0xf bank_mask:0xf
    s_mov_b64 exec, s[50:51]
    s_cbranch_scc0 L2_d42
    s_mov_b64 exec, s[82:83]
    s_nop 1
    v_mfma_f32_4x4x4_16b_bf16 v[88:91], v[12:13], v[84:85], 0
    s_nop 1
    v_mfma_f32_4x4x4_16b_bf16 v[88:91], v[10:11], v[86:87], v[88:91]
    s_nop 4
    v_cvt_pk_bf16_f32 v88, v88, v89
    v_cvt_pk_bf16_f32 v89, v90, v91
    ds_pk_add_bf16 v7, v88 offset:65408
    ds_pk_add_bf16 v7, v89 offset:65412
    s_mov_b64 exec, s[50:51]
    s_branch L2_d42
L2_xa43:
    s_cmp_eq_u32 s101, 1
    s_cbranch_scc1 L2_xc43
    v_lshlrev_b32 v89, 0, v96
    v_add_u32 v90, 140, v97
    v_bitop3_b32 v90, v89, v45, v90 bitop3:0x6a
    ds_write_b32 v98, v90 offset:28
    v_lshlrev_b32 v89, 4, v96
    v_add_u32 v90, 120, v97
    v_bitop3_b32 v90, v89, v45, v90 bitop3:0x6a
    ds_write_b32 v98, v90 offset:24
    v_lshlrev_b32 v89, 8, v96
    v_add_u32 v90, 100, v97
    v_bitop3_b32 v90, v89, v45, v90 bitop3:0x6a
    ds_write_b32 v98, v90 offset:20
L2_xc43:
    v_lshlrev_b32 v89, 12, v96
    v_add_u32 v90, 80, v97
    v_bitop3_b32 v90, v89, v45, v90 bitop3:0x6a
    ds_write_b32 v98, v90 offset:16
    s_branch L2_xb43
L2_xe43:
    v_cmp_lt_u32 vcc, 32, v99
    v_cmp_lt_u32 s[58:59], 31, v88
    v_lshrrev_b32 v89, 16, v96
    v_add_u32 v97, 80, v97
    s_or_b64 vcc, vcc, s[58:59]
    s_cbranch_scc1 L2_xs43
    v_lshlrev_b32 v89, v1, v89
    v_and_b32 v89, v45, v89
    v_cmp_ne_u32 vcc, 0, v89
    v_xor_b32 v90, v97, v89
    s_add_u32 s3, s37, s38
    v_mbcnt_lo_u32_b32 v98, vcc_lo, 0
    v_mbcnt_hi_u32_b32 v98, vcc_hi, v98
    s_bcnt1_i32_b64 s41, vcc
    v_lshl_add_u32 v98, v98, 2, s3
    s_mov_b64 exec, vcc
    ds_write_b32 v98, v90
    s_mov_b64 exec, -1
    s_lshl2_add_u32 s37, s41, s37
    s_branch L2_xr43
L2_xf43:
    s_waitcnt lgkmcnt(0)
    s_cmp_gt_u32 s37, 1024
    s_cbranch_scc1 L2_xs43
    v_mov_b32 v43, -1
    s_cmp_ge_u32 s37, 512
    s_cbranch_scc1 L2_xg43
    v_mov_b32 v42, -1
    s_cmp_ge_u32 s37, 256
    s_cbranch_scc1 L2_xg43
    v_mov_b32 v41, -1
    s_branch L2_xg43
L2_xs43:
    s_waitcnt lgkmcnt(0)
    v_mov_b32 v40, -1
    v_mov_b32 v41, -1
    v_mov_b32 v42, -1
    v_mov_b32 v43, -1
    s_add_u32 s3, s42, 2
    s_bitset1_b32 s36, s3
    s_branch L2_xg43
L2_c44:
    s_lshl_b64 s[52:53], s[82:83], 1
    s_andn2_b64 s[52:53], s[52:53], s[80:81]
    s_andn2_b64 s[52:53], s[52:53], s[54:55]
    s_or_b64 s[80:81], s[80:81], s[52:53]
    s_not_b64 vcc, s[52:53]
    s_mov_b64 exec, -1
    v_cndmask_b32_dpp v84, v84, v84, vcc wave_shr:1 row_mask:0xf bank_mask:0xf
    v_cndmask_b32_dpp v85, v85, v85, vcc wave_shr:1 row_mask:0xf bank_mask:0xf
    s_lshr_b64 s[52:53], s[52:53], 1
    v_cndmask_b32_dpp v86, v86, v86, vcc wave_shr:1 row_mask:0xf bank_mask:0xf
    v_cndmask_b32_dpp v87, v87, v87, vcc wave_shr:1 row_mask:0xf bank_mask:0xf
    s_andn2_b64 s[82:83], s[82:83], s[52:53]
    v_cndmask_b32_dpp v7, v7, v7, vcc wave_shr:1 row_mask:0xf bank_mask:0xf
    s_mov_b64 exec, s[54:55]
    s_cbranch_scc0 L2_d44
    s_mov_b64 exec, s[82:83]
    s_nop 1
    v_mfma_f32_4x4x4_16b_bf16 v[88:91], v[12:13], v[84:85], 0
    s_nop 1
    v_mfma_f32_4x4x4_16b_bf16 v[88:91], v[10:11], v[86:87], v[88:91]
    s_nop 4
    v_cvt_pk_bf16_f32 v88, v88, v89
    v_cvt_pk_bf16_f32 v89, v90, v91
    ds_pk_add_bf16 v7, v88 offset:65408
    ds_pk_add_bf16 v7, v89 offset:65412
    s_mov_b64 exec, s[54:55]
    s_branch L2_d44
L2_c45:
    s_lshl_b64 s[52:53], s[82:83], 1
    s_andn2_b64 s[52:53], s[52:53], s[80:81]
    s_andn2_b64 s[52:53], s[52:53], s[50:51]
    s_or_b64 s[80:81], s[80:81], s[52:53]
    s_not_b64 vcc, s[52:53]
    s_mov_b64 exec, -1
    v_cndmask_b32_dpp v84, v84, v84, vcc wave_shr:1 row_mask:0xf bank_mask:0xf
    v_cndmask_b32_dpp v85, v85, v85, vcc wave_shr:1 row_mask:0xf bank_mask:0xf
    s_lshr_b64 s[52:53], s[52:53], 1
    v_cndmask_b32_dpp v86, v86, v86, vcc wave_shr:1 row_mask:0xf bank_mask:0xf
    v_cndmask_b32_dpp v87, v87, v87, vcc wave_shr:1 row_mask:0xf bank_mask:0xf
    s_andn2_b64 s[82:83], s[82:83], s[52:53]
    v_cndmask_b32_dpp v7, v7, v7, vcc wave_shr:1 row_mask:0xf bank_mask:0xf
    s_mov_b64 exec, s[50:51]
    s_cbranch_scc0 L2_d45
    s_mov_b64 exec, s[82:83]
    s_nop 1
    v_mfma_f32_4x4x4_16b_bf16 v[88:91], v[12:13], v[84:85], 0
    s_nop 1
    v_mfma_f32_4x4x4_16b_bf16 v[88:91], v[10:11], v[86:87], v[88:91]
    s_nop 4
    v_cvt_pk_bf16_f32 v88, v88, v89
    v_cvt_pk_bf16_f32 v89, v90, v91
    ds_pk_add_bf16 v7, v88 offset:65408
    ds_pk_add_bf16 v7, v89 offset:65412
    s_mov_b64 exec, s[50:51]
    s_branch L2_d45
L2_c46:
    s_lshl_b64 s[52:53], s[82:83], 1
    s_andn2_b64 s[52:53], s[52:53], s[80:81]
    s_andn2_b64 s[52:53], s[52:53], s[54:55]
    s_or_b64 s[80:81], s[80:81], s[52:53]
    s_not_b64 vcc, s[52:53]
    s_mov_b64 exec, -1
    v_cndmask_b32_dpp v84, v84, v84, vcc wave_shr:1 row_mask:0xf bank_mask:0xf
    v_cndmask_b32_dpp v85, v85, v85, vcc wave_shr:1 row_mask:0xf bank_mask:0xf
    s_lshr_b64 s[52:53], s[52:53], 1
    v_cndmask_b32_dpp v86, v86, v86, vcc wave_shr:1 row_mask:0xf bank_mask:0xf
    v_cndmask_b32_dpp v87, v87, v87, vcc wave_shr:1 row_mask:0xf bank_mask:0xf
    s_andn2_b64 s[82:83], s[82:83], s[52:53]
    v_cndmask_b32_dpp v7, v7, v7, vcc wave_shr:1 row_mask:0xf bank_mask:0xf
    s_mov_b64 exec, s[54:55]
    s_cbranch_scc0 L2_d46
    s_mov_b64 exec, s[82:83]
    s_nop 1
    v_mfma_f32_4x4x4_16b_bf16 v[88:91], v[12:13], v[84:85], 0
    s_nop 1
    v_mfma_f32_4x4x4_16b_bf16 v[88:91], v[10:11], v[86:87], v[88:91]
    s_nop 4
    v_cvt_pk_bf16_f32 v88, v88, v89
    v_cvt_pk_bf16_f32 v89, v90, v91
    ds_pk_add_bf16 v7, v88 offset:65408
    ds_pk_add_bf16 v7, v89 offset:65412
    s_mov_b64 exec, s[54:55]
    s_branch L2_d46
L2_c47:
    s_lshl_b64 s[52:53], s[82:83], 1
    s_andn2_b64 s[52:53], s[52:53], s[80:81]
    s_andn2_b64 s[52:53], s[52:53], s[50:51]
    s_or_b64 s[80:81], s[80:81], s[52:53]
    s_not_b64 vcc, s[52:53]
    s_mov_b64 exec, -1
    v_cndmask_b32_dpp v84, v84, v84, vcc wave_shr:1 row_mask:0xf bank_mask:0xf
    v_cndmask_b32_dpp v85, v85, v85, vcc wave_shr:1 row_mask:0xf bank_mask:0xf
    s_lshr_b64 s[52:53], s[52:53], 1
    v_cndmask_b32_dpp v86, v86, v86, vcc wave_shr:1 row_mask:0xf bank_mask:0xf
    v_cndmask_b32_dpp v87, v87, v87, vcc wave_shr:1 row_mask:0xf bank_mask:0xf
    s_andn2_b64 s[82:83], s[82:83], s[52:53]
    v_cndmask_b32_dpp v7, v7, v7, vcc wave_shr:1 row_mask:0xf bank_mask:0xf
    s_mov_b64 exec, s[50:51]
    s_cbranch_scc0 L2_d47
    s_mov_b64 exec, s[82:83]
    s_nop 1
    v_mfma_f32_4x4x4_16b_bf16 v[88:91], v[12:13], v[84:85], 0
    s_nop 1
    v_mfma_f32_4x4x4_16b_bf16 v[88:91], v[10:11], v[86:87], v[88:91]
    s_nop 4
    v_cvt_pk_bf16_f32 v88, v88, v89
    v_cvt_pk_bf16_f32 v89, v90, v91
    ds_pk_add_bf16 v7, v88 offset:65408
    ds_pk_add_bf16 v7, v89 offset:65412
    s_mov_b64 exec, s[50:51]
    s_branch L2_d47
L2_c48:
    s_lshl_b64 s[52:53], s[82:83], 1
    s_andn2_b64 s[52:53], s[52:53], s[80:81]
    s_andn2_b64 s[52:53], s[52:53], s[54:55]
    s_or_b64 s[80:81], s[80:81], s[52:53]
    s_not_b64 vcc, s[52:53]
    s_mov_b64 exec, -1
    v_cndmask_b32_dpp v84, v84, v84, vcc wave_shr:1 row_mask:0xf bank_mask:0xf
    v_cndmask_b32_dpp v85, v85, v85, vcc wave_shr:1 row_mask:0xf bank_mask:0xf
    s_lshr_b64 s[52:53], s[52:53], 1
    v_cndmask_b32_dpp v86, v86, v86, vcc wave_shr:1 row_mask:0xf bank_mask:0xf
    v_cndmask_b32_dpp v87, v87, v87, vcc wave_shr:1 row_mask:0xf bank_mask:0xf
    s_andn2_b64 s[82:83], s[82:83], s[52:53]
    v_cndmask_b32_dpp v7, v7, v7, vcc wave_shr:1 row_mask:0xf bank_mask:0xf
    s_mov_b64 exec, s[54:55]
    s_cbranch_scc0 L2_d48
    s_mov_b64 exec, s[82:83]
    s_nop 1
    v_mfma_f32_4x4x4_16b_bf16 v[88:91], v[12:13], v[84:85], 0
    s_nop 1
    v_mfma_f32_4x4x4_16b_bf16 v[88:91], v[10:11], v[86:87], v[88:91]
    s_nop 4
    v_cvt_pk_bf16_f32 v88, v88, v89
    v_cvt_pk_bf16_f32 v89, v90, v91
    ds_pk_add_bf16 v7, v88 offset:65408
    ds_pk_add_bf16 v7, v89 offset:65412
    s_mov_b64 exec, s[54:55]
    s_branch L2_d48
L2_c49:
    s_lshl_b64 s[52:53], s[82:83], 1
    s_andn2_b64 s[52:53], s[52:53], s[80:81]
    s_andn2_b64 s[52:53], s[52:53], s[50:51]
    s_or_b64 s[80:81], s[80:81], s[52:53]
    s_not_b64 vcc, s[52:53]
    s_mov_b64 exec, -1
    v_cndmask_b32_dpp v84, v84, v84, vcc wave_shr:1 row_mask:0xf bank_mask:0xf
    v_cndmask_b32_dpp v85, v85, v85, vcc wave_shr:1 row_mask:0xf bank_mask:0xf
    s_lshr_b64 s[52:53], s[52:53], 1
    v_cndmask_b32_dpp v86, v86, v86, vcc wave_shr:1 row_mask:0xf bank_mask:0xf
    v_cndmask_b32_dpp v87, v87, v87, vcc wave_shr:1 row_mask:0xf bank_mask:0xf
    s_andn2_b64 s[82:83], s[82:83], s[52:53]
    v_cndmask_b32_dpp v7, v7, v7, vcc wave_shr:1 row_mask:0xf bank_mask:0xf
    s_mov_b64 exec, s[50:51]
    s_cbranch_scc0 L2_d49
    s_mov_b64 exec, s[82:83]
    s_nop 1
    v_mfma_f32_4x4x4_16b_bf16 v[88:91], v[12:13], v[84:85], 0
    s_nop 1
    v_mfma_f32_4x4x4_16b_bf16 v[88:91], v[10:11], v[86:87], v[88:91]
    s_nop 4
    v_cvt_pk_bf16_f32 v88, v88, v89
    v_cvt_pk_bf16_f32 v89, v90, v91
    ds_pk_add_bf16 v7, v88 offset:65408
    ds_pk_add_bf16 v7, v89 offset:65412
    s_mov_b64 exec, s[50:51]
    s_branch L2_d49
L2_xo50:
    v_cmp_lt_u32 vcc, 20, v99
    s_mov_b32 s101, 1
    s_cbranch_vccz L2_xp50
    v_cmp_lt_u32 vcc, 32, v99
    v_cmp_lt_u32 s[58:59], 31, v88
    s_mov_b32 s101, 2
    s_or_b64 vcc, vcc, s[58:59]
    s_cbranch_scc0 L2_xp50
    s_mov_b32 s37, 0x10000
    s_branch L2_xp50
L2_c51:
    s_lshl_b64 s[52:53], s[82:83], 1
    s_andn2_b64 s[52:53], s[52:53], s[80:81]
    s_andn2_b64 s[52:53], s[52:53], s[54:55]
    s_or_b64 s[80:81], s[80:81], s[52:53]
    s_not_b64 vcc, s[52:53]
    s_mov_b64 exec, -1
    v_cndmask_b32_dpp v84, v84, v84, vcc wave_shr:1 row_mask:0xf bank_mask:0xf
    v_cndmask_b32_dpp v85, v85, v85, vcc wave_shr:1 row_mask:0xf bank_mask:0xf
    s_lshr_b64 s[52:53], s[52:53], 1
    v_cndmask_b32_dpp v86, v86, v86, vcc wave_shr:1 row_mask:0xf bank_mask:0xf
    v_cndmask_b32_dpp v87, v87, v87, vcc wave_shr:1 row_mask:0xf bank_mask:0xf
    s_andn2_b64 s[82:83], s[82:83], s[52:53]
    v_cndmask_b32_dpp v7, v7, v7, vcc wave_shr:1 row_mask:0xf bank_mask:0xf
    s_mov_b64 exec, s[54:55]
    s_cbranch_scc0 L2_d51
    s_mov_b64 exec, s[82:83]
    s_nop 1
    v_mfma_f32_4x4x4_16b_bf16 v[88:91], v[12:13], v[84:85], 0
    s_nop 1
    v_mfma_f32_4x4x4_16b_bf16 v[88:91], v[10:11], v[86:87], v[88:91]
    s_nop 4
    v_cvt_pk_bf16_f32 v88, v88, v89
    v_cvt_pk_bf16_f32 v89, v90, v91
    ds_pk_add_bf16 v7, v88 offset:65408
    ds_pk_add_bf16 v7, v89 offset:65412
    s_mov_b64 exec, s[54:55]
    s_branch L2_d51
L2_c52:
    s_lshl_b64 s[52:53], s[82:83], 1
    s_andn2_b64 s[52:53], s[52:53], s[80:81]
    s_andn2_b64 s[52:53], s[52:53], s[50:51]
    s_or_b64 s[80:81], s[80:81], s[52:53]
    s_not_b64 vcc, s[52:53]
    s_mov_b64 exec, -1
    v_cndmask_b32_dpp v84, v84, v84, vcc wave_shr:1 row_mask:0xf bank_mask:0xf
    v_cndmask_b32_dpp v85, v85, v85, vcc wave_shr:1 row_mask:0xf bank_mask:0xf
    s_lshr_b64 s[52:53], s[52:53], 1
    v_cndmask_b32_dpp v86, v86, v86, vcc wave_shr:1 row_mask:0xf bank_mask:0xf
    v_cndmask_b32_dpp v87, v87, v87, vcc wave_shr:1 row_mask:0xf bank_mask:0xf
    s_andn2_b64 s[82:83], s[82:83], s[52:53]
    v_cndmask_b32_dpp v7, v7, v7, vcc wave_shr:1 row_mask:0xf bank_mask:0xf
    s_mov_b64 exec, s[50:51]
    s_cbranch_scc0 L2_d52
    s_mov_b64 exec, s[82:83]
    s_nop 1
    v_mfma_f32_4x4x4_16b_bf16 v[88:91], v[12:13], v[84:85], 0
    s_nop 1
    v_mfma_f32_4x4x4_16b_bf16 v[88:91], v[10:11], v[86:87], v[88:91]
    s_nop 4
    v_cvt_pk_bf16_f32 v88, v88, v89
    v_cvt_pk_bf16_f32 v89, v90, v91
    ds_pk_add_bf16 v7, v88 offset:65408
    ds_pk_add_bf16 v7, v89 offset:65412
    s_mov_b64 exec, s[50:51]
    s_branch L2_d52
L2_c53:
    s_lshl_b64 s[52:53], s[82:83], 1
    s_andn2_b64 s[52:53], s[52:53], s[80:81]
    s_andn2_b64 s[52:53], s[52:53], s[54:55]
    s_or_b64 s[80:81], s[80:81], s[52:53]
    s_not_b64 vcc, s[52:53]
    s_mov_b64 exec, -1
    v_cndmask_b32_dpp v84, v84, v84, vcc wave_shr:1 row_mask:0xf bank_mask:0xf
    v_cndmask_b32_dpp v85, v85, v85, vcc wave_shr:1 row_mask:0xf bank_mask:0xf
    s_lshr_b64 s[52:53], s[52:53], 1
    v_cndmask_b32_dpp v86, v86, v86, vcc wave_shr:1 row_mask:0xf bank_mask:0xf
    v_cndmask_b32_dpp v87, v87, v87, vcc wave_shr:1 row_mask:0xf bank_mask:0xf
    s_andn2_b64 s[82:83], s[82:83], s[52:53]
    v_cndmask_b32_dpp v7, v7, v7, vcc wave_shr:1 row_mask:0xf bank_mask:0xf
    s_mov_b64 exec, s[54:55]
    s_cbranch_scc0 L2_d53
    s_mov_b64 exec, s[82:83]
    s_nop 1
    v_mfma_f32_4x4x4_16b_bf16 v[88:91], v[12:13], v[84:85], 0
    s_nop 1
    v_mfma_f32_4x4x4_16b_bf16 v[88:91], v[10:11], v[86:87], v[88:91]
    s_nop 4
    v_cvt_pk_bf16_f32 v88, v88, v89
    v_cvt_pk_bf16_f32 v89, v90, v91
    ds_pk_add_bf16 v7, v88 offset:65408
    ds_pk_add_bf16 v7, v89 offset:65412
    s_mov_b64 exec, s[54:55]
    s_branch L2_d53
L2_c54:
    s_lshl_b64 s[52:53], s[82:83], 1
    s_andn2_b64 s[52:53], s[52:53], s[80:81]
    s_andn2_b64 s[52:53], s[52:53], s[50:51]
    s_or_b64 s[80:81], s[80:81], s[52:53]
    s_not_b64 vcc, s[52:53]
    s_mov_b64 exec, -1
    v_cndmask_b32_dpp v84, v84, v84, vcc wave_shr:1 row_mask:0xf bank_mask:0xf
    v_cndmask_b32_dpp v85, v85, v85, vcc wave_shr:1 row_mask:0xf bank_mask:0xf
    s_lshr_b64 s[52:53], s[52:53], 1
    v_cndmask_b32_dpp v86, v86, v86, vcc wave_shr:1 row_mask:0xf bank_mask:0xf
    v_cndmask_b32_dpp v87, v87, v87, vcc wave_shr:1 row_mask:0xf bank_mask:0xf
    s_andn2_b64 s[82:83], s[82:83], s[52:53]
    v_cndmask_b32_dpp v7, v7, v7, vcc wave_shr:1 row_mask:0xf bank_mask:0xf
    s_mov_b64 exec, s[50:51]
    s_cbranch_scc0 L2_d54
    s_mov_b64 exec, s[82:83]
    s_nop 1
    v_mfma_f32_4x4x4_16b_bf16 v[88:91], v[12:13], v[84:85], 0
    s_nop 1
    v_mfma_f32_4x4x4_16b_bf16 v[88:91], v[10:11], v[86:87], v[88:91]
    s_nop 4
    v_cvt_pk_bf16_f32 v88, v88, v89
    v_cvt_pk_bf16_f32 v89, v90, v91
    ds_pk_add_bf16 v7, v88 offset:65408
    ds_pk_add_bf16 v7, v89 offset:65412
    s_mov_b64 exec, s[50:51]
    s_branch L2_d54
L2_c55:
    s_lshl_b64 s[52:53], s[82:83], 1
    s_andn2_b64 s[52:53], s[52:53], s[80:81]
    s_andn2_b64 s[52:53], s[52:53], s[54:55]
    s_or_b64 s[80:81], s[80:81], s[52:53]
    s_not_b64 vcc, s[52:53]
    s_mov_b64 exec, -1
    v_cndmask_b32_dpp v84, v84, v84, vcc wave_shr:1 row_mask:0xf bank_mask:0xf
    v_cndmask_b32_dpp v85, v85, v85, vcc wave_shr:1 row_mask:0xf bank_mask:0xf
    s_lshr_b64 s[52:53], s[52:53], 1
    v_cndmask_b32_dpp v86, v86, v86, vcc wave_shr:1 row_mask:0xf bank_mask:0xf
    v_cndmask_b32_dpp v87, v87, v87, vcc wave_shr:1 row_mask:0xf bank_mask:0xf
    s_andn2_b64 s[82:83], s[82:83], s[52:53]
    v_cndmask_b32_dpp v7, v7, v7, vcc wave_shr:1 row_mask:0xf bank_mask:0xf
    s_mov_b64 exec, s[54:55]
    s_cbranch_scc0 L2_d55
    s_mov_b64 exec, s[82:83]
    s_nop 1
    v_mfma_f32_4x4x4_16b_bf16 v[88:91], v[12:13], v[84:85], 0
    s_nop 1
    v_mfma_f32_4x4x4_16b_bf16 v[88:91], v[10:11], v[86:87], v[88:91]
    s_nop 4
    v_cvt_pk_bf16_f32 v88, v88, v89
    v_cvt_pk_bf16_f32 v89, v90, v91
    ds_pk_add_bf16 v7, v88 offset:65408
    ds_pk_add_bf16 v7, v89 offset:65412
    s_mov_b64 exec, s[54:55]
    s_branch L2_d55
L2_c56:
    s_lshl_b64 s[52:53], s[82:83], 1
    s_andn2_b64 s[52:53], s[52:53], s[80:81]
    s_andn2_b64 s[52:53], s[52:53], s[50:51]
    s_or_b64 s[80:81], s[80:81], s[52:53]
    s_not_b64 vcc, s[52:53]
    s_mov_b64 exec, -1
    v_cndmask_b32_dpp v84, v84, v84, vcc wave_shr:1 row_mask:0xf bank_mask:0xf
    v_cndmask_b32_dpp v85, v85, v85, vcc wave_shr:1 row_mask:0xf bank_mask:0xf
    s_lshr_b64 s[52:53], s[52:53], 1
    v_cndmask_b32_dpp v86, v86, v86, vcc wave_shr:1 row_mask:0xf bank_mask:0xf
    v_cndmask_b32_dpp v87, v87, v87, vcc wave_shr:1 row_mask:0xf bank_mask:0xf
    s_andn2_b64 s[82:83], s[82:83], s[52:53]
    v_cndmask_b32_dpp v7, v7, v7, vcc wave_shr:1 row_mask:0xf bank_mask:0xf
    s_mov_b64 exec, s[50:51]
    s_cbranch_scc0 L2_d56
    s_mov_b64 exec, s[82:83]
    s_nop 1
    v_mfma_f32_4x4x4_16b_bf16 v[88:91], v[12:13], v[84:85], 0
    s_nop 1
    v_mfma_f32_4x4x4_16b_bf16 v[88:91], v[10:11], v[86:87], v[88:91]
    s_nop 4
    v_cvt_pk_bf16_f32 v88, v88, v89
    v_cvt_pk_bf16_f32 v89, v90, v91
    ds_pk_add_bf16 v7, v88 offset:65408
    ds_pk_add_bf16 v7, v89 offset:65412
    s_mov_b64 exec, s[50:51]
    s_branch L2_d56
L2_c57:
    s_lshl_b64 s[52:53], s[82:83], 1
    s_andn2_b64 s[52:53], s[52:53], s[80:81]
    s_andn2_b64 s[52:53], s[52:53], s[54:55]
    s_or_b64 s[80:81], s[80:81], s[52:53]
    s_not_b64 vcc, s[52:53]
    s_mov_b64 exec, -1
    v_cndmask_b32_dpp v84, v84, v84, vcc wave_shr:1 row_mask:0xf bank_mask:0xf
    v_cndmask_b32_dpp v85, v85, v85, vcc wave_shr:1 row_mask:0xf bank_mask:0xf
    s_lshr_b64 s[52:53], s[52:53], 1
    v_cndmask_b32_dpp v86, v86, v86, vcc wave_shr:1 row_mask:0xf bank_mask:0xf
    v_cndmask_b32_dpp v87, v87, v87, vcc wave_shr:1 row_mask:0xf bank_mask:0xf
    s_andn2_b64 s[82:83], s[82:83], s[52:53]
    v_cndmask_b32_dpp v7, v7, v7, vcc wave_shr:1 row_mask:0xf bank_mask:0xf
    s_mov_b64 exec, s[54:55]
    s_cbranch_scc0 L2_d57
    s_mov_b64 exec, s[82:83]
    s_nop 1
    v_mfma_f32_4x4x4_16b_bf16 v[88:91], v[12:13], v[84:85], 0
    s_nop 1
    v_mfma_f32_4x4x4_16b_bf16 v[88:91], v[10:11], v[86:87], v[88:91]
    s_nop 4
    v_cvt_pk_bf16_f32 v88, v88, v89
    v_cvt_pk_bf16_f32 v89, v90, v91
    ds_pk_add_bf16 v7, v88 offset:65408
    ds_pk_add_bf16 v7, v89 offset:65412
    s_mov_b64 exec, s[54:55]
    s_branch L2_d57
L2_c58:
    s_lshl_b64 s[52:53], s[82:83], 1
    s_andn2_b64 s[52:53], s[52:53], s[80:81]
    s_andn2_b64 s[52:53], s[52:53], s[50:51]
    s_or_b64 s[80:81], s[80:81], s[52:53]
    s_not_b64 vcc, s[52:53]
    s_mov_b64 exec, -1
    v_cndmask_b32_dpp v84, v84, v84, vcc wave_shr:1 row_mask:0xf bank_mask:0xf
    v_cndmask_b32_dpp v85, v85, v85, vcc wave_shr:1 row_mask:0xf bank_mask:0xf
    s_lshr_b64 s[52:53], s[52:53], 1
    v_cndmask_b32_dpp v86, v86, v86, vcc wave_shr:1 row_mask:0xf bank_mask:0xf
    v_cndmask_b32_dpp v87, v87, v87, vcc wave_shr:1 row_mask:0xf bank_mask:0xf
    s_andn2_b64 s[82:83], s[82:83], s[52:53]
    v_cndmask_b32_dpp v7, v7, v7, vcc wave_shr:1 row_mask:0xf bank_mask:0xf
    s_mov_b64 exec, s[50:51]
    s_cbranch_scc0 L2_d58
    s_mov_b64 exec, s[82:83]
    s_nop 1
    v_mfma_f32_4x4x4_16b_bf16 v[88:91], v[12:13], v[84:85], 0
    s_nop 1
    v_mfma_f32_4x4x4_16b_bf16 v[88:91], v[10:11], v[86:87], v[88:91]
    s_nop 4
    v_cvt_pk_bf16_f32 v88, v88, v89
    v_cvt_pk_bf16_f32 v89, v90, v91
    ds_pk_add_bf16 v7, v88 offset:65408
    ds_pk_add_bf16 v7, v89 offset:65412
    s_mov_b64 exec, s[50:51]
    s_branch L2_d58
L2_c59:
    s_lshl_b64 s[52:53], s[82:83], 1
    s_andn2_b64 s[52:53], s[52:53], s[80:81]
    s_andn2_b64 s[52:53], s[52:53], s[54:55]
    s_or_b64 s[80:81], s[80:81], s[52:53]
    s_not_b64 vcc, s[52:53]
    s_mov_b64 exec, -1
    v_cndmask_b32_dpp v84, v84, v84, vcc wave_shr:1 row_mask:0xf bank_mask:0xf
    v_cndmask_b32_dpp v85, v85, v85, vcc wave_shr:1 row_mask:0xf bank_mask:0xf
    s_lshr_b64 s[52:53], s[52:53], 1
    v_cndmask_b32_dpp v86, v86, v86, vcc wave_shr:1 row_mask:0xf bank_mask:0xf
    v_cndmask_b32_dpp v87, v87, v87, vcc wave_shr:1 row_mask:0xf bank_mask:0xf
    s_andn2_b64 s[82:83], s[82:83], s[52:53]
    v_cndmask_b32_dpp v7, v7, v7, vcc wave_shr:1 row_mask:0xf bank_mask:0xf
    s_mov_b64 exec, s[54:55]
    s_cbranch_scc0 L2_d59
    s_mov_b64 exec, s[82:83]
    s_nop 1
    v_mfma_f32_4x4x4_16b_bf16 v[88:91], v[12:13], v[84:85], 0
    s_nop 1
    v_mfma_f32_4x4x4_16b_bf16 v[88:91], v[10:11], v[86:87], v[88:91]
    s_nop 4
    v_cvt_pk_bf16_f32 v88, v88, v89
    v_cvt_pk_bf16_f32 v89, v90, v91
    ds_pk_add_bf16 v7, v88 offset:65408
    ds_pk_add_bf16 v7, v89 offset:65412
    s_mov_b64 exec, s[54:55]
    s_branch L2_d59
L2_c60:
    s_lshl_b64 s[52:53], s[82:83], 1
    s_andn2_b64 s[52:53], s[52:53], s[80:81]
    s_andn2_b64 s[52:53], s[52:53], s[50:51]
    s_or_b64 s[80:81], s[80:81], s[52:53]
    s_not_b64 vcc, s[52:53]
    s_mov_b64 exec, -1
    v_cndmask_b32_dpp v84, v84, v84, vcc wave_shr:1 row_mask:0xf bank_mask:0xf
    v_cndmask_b32_dpp v85, v85, v85, vcc wave_shr:1 row_mask:0xf bank_mask:0xf
    s_lshr_b64 s[52:53], s[52:53], 1
    v_cndmask_b32_dpp v86, v86, v86, vcc wave_shr:1 row_mask:0xf bank_mask:0xf
    v_cndmask_b32_dpp v87, v87, v87, vcc wave_shr:1 row_mask:0xf bank_mask:0xf
    s_andn2_b64 s[82:83], s[82:83], s[52:53]
    v_cndmask_b32_dpp v7, v7, v7, vcc wave_shr:1 row_mask:0xf bank_mask:0xf
    s_mov_b64 exec, s[50:51]
    s_cbranch_scc0 L2_d60
    s_mov_b64 exec, s[82:83]
    s_nop 1
    v_mfma_f32_4x4x4_16b_bf16 v[88:91], v[12:13], v[84:85], 0
    s_nop 1
    v_mfma_f32_4x4x4_16b_bf16 v[88:91], v[10:11], v[86:87], v[88:91]
    s_nop 4
    v_cvt_pk_bf16_f32 v88, v88, v89
    v_cvt_pk_bf16_f32 v89, v90, v91
    ds_pk_add_bf16 v7, v88 offset:65408
    ds_pk_add_bf16 v7, v89 offset:65412
    s_mov_b64 exec, s[50:51]
    s_branch L2_d60
L2_xa61:
    s_cmp_eq_u32 s101, 1
    s_cbranch_scc1 L2_xc61
    v_lshlrev_b32 v89, 0, v96
    v_add_u32 v90, 140, v97
    v_bitop3_b32 v90, v89, v45, v90 bitop3:0x6a
    ds_write_b32 v98, v90 offset:28
    v_lshlrev_b32 v89, 4, v96
    v_add_u32 v90, 120, v97
    v_bitop3_b32 v90, v89, v45, v90 bitop3:0x6a
    ds_write_b32 v98, v90 offset:24
    v_lshlrev_b32 v89, 8, v96
    v_add_u32 v90, 100, v97
    v_bitop3_b32 v90, v89, v45, v90 bitop3:0x6a
    ds_write_b32 v98, v90 offset:20
L2_xc61:
    v_lshlrev_b32 v89, 12, v96
    v_add_u32 v90, 80, v97
    v_bitop3_b32 v90, v89, v45, v90 bitop3:0x6a
    ds_write_b32 v98, v90 offset:16
    s_branch L2_xb61
L2_xe61:
    v_cmp_lt_u32 vcc, 32, v99
    v_cmp_lt_u32 s[58:59], 31, v88
    v_lshrrev_b32 v89, 16, v96
    v_add_u32 v97, 80, v97
    s_or_b64 vcc, vcc, s[58:59]
    s_cbranch_scc1 L2_xs61
    v_lshlrev_b32 v89, v1, v89
    v_and_b32 v89, v45, v89
    v_cmp_ne_u32 vcc, 0, v89
    v_xor_b32 v90, v97, v89
    s_add_u32 s3, s37, s38
    v_mbcnt_lo_u32_b32 v98, vcc_lo, 0
    v_mbcnt_hi_u32_b32 v98, vcc_hi, v98
    s_bcnt1_i32_b64 s41, vcc
    v_lshl_add_u32 v98, v98, 2, s3
    s_mov_b64 exec, vcc
    ds_write_b32 v98, v90
    s_mov_b64 exec, -1
    s_lshl2_add_u32 s37, s41, s37
    s_branch L2_xr61
L2_xf61:
    s_waitcnt lgkmcnt(0)
    s_cmp_gt_u32 s37, 1024
    s_cbranch_scc1 L2_xs61
    v_mov_b32 v43, -1
    s_cmp_ge_u32 s37, 512
    s_cbranch_scc1 L2_xg61
    v_mov_b32 v42, -1
    s_cmp_ge_u32 s37, 256
    s_cbranch_scc1 L2_xg61
    v_mov_b32 v41, -1
    s_branch L2_xg61
L2_xs61:
    s_waitcnt lgkmcnt(0)
    v_mov_b32 v40, -1
    v_mov_b32 v41, -1
    v_mov_b32 v42, -1
    v_mov_b32 v43, -1
    s_add_u32 s3, s42, 2
    s_bitset1_b32 s36, s3
    s_branch L2_xg61
L2_c62:
    s_lshl_b64 s[52:53], s[82:83], 1
    s_andn2_b64 s[52:53], s[52:53], s[80:81]
    s_andn2_b64 s[52:53], s[52:53], s[54:55]
    s_or_b64 s[80:81], s[80:81], s[52:53]
    s_not_b64 vcc, s[52:53]
    s_mov_b64 exec, -1
    v_cndmask_b32_dpp v84, v84, v84, vcc wave_shr:1 row_mask:0xf bank_mask:0xf
    v_cndmask_b32_dpp v85, v85, v85, vcc wave_shr:1 row_mask:0xf bank_mask:0xf
    s_lshr_b64 s[52:53], s[52:53], 1
    v_cndmask_b32_dpp v86, v86, v86, vcc wave_shr:1 row_mask:0xf bank_mask:0xf
    v_cndmask_b32_dpp v87, v87, v87, vcc wave_shr:1 row_mask:0xf bank_mask:0xf
    s_andn2_b64 s[82:83], s[82:83], s[52:53]
    v_cndmask_b32_dpp v7, v7, v7, vcc wave_shr:1 row_mask:0xf bank_mask:0xf
    s_mov_b64 exec, s[54:55]
    s_cbranch_scc0 L2_d62
    s_mov_b64 exec, s[82:83]
    s_nop 1
    v_mfma_f32_4x4x4_16b_bf16 v[88:91], v[12:13], v[84:85], 0
    s_nop 1
    v_mfma_f32_4x4x4_16b_bf16 v[88:91], v[10:11], v[86:87], v[88:91]
    s_nop 4
    v_cvt_pk_bf16_f32 v88, v88, v89
    v_cvt_pk_bf16_f32 v89, v90, v91
    ds_pk_add_bf16 v7, v88 offset:65408
    ds_pk_add_bf16 v7, v89 offset:65412
    s_mov_b64 exec, s[54:55]
    s_branch L2_d62
L2_c63:
    s_lshl_b64 s[52:53], s[82:83], 1
    s_andn2_b64 s[52:53], s[52:53], s[80:81]
    s_andn2_b64 s[52:53], s[52:53], s[50:51]
    s_or_b64 s[80:81], s[80:81], s[52:53]
    s_not_b64 vcc, s[52:53]
    s_mov_b64 exec, -1
    v_cndmask_b32_dpp v84, v84, v84, vcc wave_shr:1 row_mask:0xf bank_mask:0xf
    v_cndmask_b32_dpp v85, v85, v85, vcc wave_shr:1 row_mask:0xf bank_mask:0xf
    s_lshr_b64 s[52:53], s[52:53], 1
    v_cndmask_b32_dpp v86, v86, v86, vcc wave_shr:1 row_mask:0xf bank_mask:0xf
    v_cndmask_b32_dpp v87, v87, v87, vcc wave_shr:1 row_mask:0xf bank_mask:0xf
    s_andn2_b64 s[82:83], s[82:83], s[52:53]
    v_cndmask_b32_dpp v7, v7, v7, vcc wave_shr:1 row_mask:0xf bank_mask:0xf
    s_mov_b64 exec, s[50:51]
    s_cbranch_scc0 L2_d63
    s_mov_b64 exec, s[82:83]
    s_nop 1
    v_mfma_f32_4x4x4_16b_bf16 v[88:91], v[12:13], v[84:85], 0
    s_nop 1
    v_mfma_f32_4x4x4_16b_bf16 v[88:91], v[10:11], v[86:87], v[88:91]
    s_nop 4
    v_cvt_pk_bf16_f32 v88, v88, v89
    v_cvt_pk_bf16_f32 v89, v90, v91
    ds_pk_add_bf16 v7, v88 offset:65408
    ds_pk_add_bf16 v7, v89 offset:65412
    s_mov_b64 exec, s[50:51]
    s_branch L2_d63
L2_c64:
    s_lshl_b64 s[52:53], s[82:83], 1
    s_andn2_b64 s[52:53], s[52:53], s[80:81]
    s_andn2_b64 s[52:53], s[52:53], s[54:55]
    s_or_b64 s[80:81], s[80:81], s[52:53]
    s_not_b64 vcc, s[52:53]
    s_mov_b64 exec, -1
    v_cndmask_b32_dpp v84, v84, v84, vcc wave_shr:1 row_mask:0xf bank_mask:0xf
    v_cndmask_b32_dpp v85, v85, v85, vcc wave_shr:1 row_mask:0xf bank_mask:0xf
    s_lshr_b64 s[52:53], s[52:53], 1
    v_cndmask_b32_dpp v86, v86, v86, vcc wave_shr:1 row_mask:0xf bank_mask:0xf
    v_cndmask_b32_dpp v87, v87, v87, vcc wave_shr:1 row_mask:0xf bank_mask:0xf
    s_andn2_b64 s[82:83], s[82:83], s[52:53]
    v_cndmask_b32_dpp v7, v7, v7, vcc wave_shr:1 row_mask:0xf bank_mask:0xf
    s_mov_b64 exec, s[54:55]
    s_cbranch_scc0 L2_d64
    s_mov_b64 exec, s[82:83]
    s_nop 1
    v_mfma_f32_4x4x4_16b_bf16 v[88:91], v[12:13], v[84:85], 0
    s_nop 1
    v_mfma_f32_4x4x4_16b_bf16 v[88:91], v[10:11], v[86:87], v[88:91]
    s_nop 4
    v_cvt_pk_bf16_f32 v88, v88, v89
    v_cvt_pk_bf16_f32 v89, v90, v91
    ds_pk_add_bf16 v7, v88 offset:65408
    ds_pk_add_bf16 v7, v89 offset:65412
    s_mov_b64 exec, s[54:55]
    s_branch L2_d64
L2_c65:
    s_lshl_b64 s[52:53], s[82:83], 1
    s_andn2_b64 s[52:53], s[52:53], s[80:81]
    s_andn2_b64 s[52:53], s[52:53], s[50:51]
    s_or_b64 s[80:81], s[80:81], s[52:53]
    s_not_b64 vcc, s[52:53]
    s_mov_b64 exec, -1
    v_cndmask_b32_dpp v84, v84, v84, vcc wave_shr:1 row_mask:0xf bank_mask:0xf
    v_cndmask_b32_dpp v85, v85, v85, vcc wave_shr:1 row_mask:0xf bank_mask:0xf
    s_lshr_b64 s[52:53], s[52:53], 1
    v_cndmask_b32_dpp v86, v86, v86, vcc wave_shr:1 row_mask:0xf bank_mask:0xf
    v_cndmask_b32_dpp v87, v87, v87, vcc wave_shr:1 row_mask:0xf bank_mask:0xf
    s_andn2_b64 s[82:83], s[82:83], s[52:53]
    v_cndmask_b32_dpp v7, v7, v7, vcc wave_shr:1 row_mask:0xf bank_mask:0xf
    s_mov_b64 exec, s[50:51]
    s_cbranch_scc0 L2_d65
    s_mov_b64 exec, s[82:83]
    s_nop 1
    v_mfma_f32_4x4x4_16b_bf16 v[88:91], v[12:13], v[84:85], 0
    s_nop 1
    v_mfma_f32_4x4x4_16b_bf16 v[88:91], v[10:11], v[86:87], v[88:91]
    s_nop 4
    v_cvt_pk_bf16_f32 v88, v88, v89
    v_cvt_pk_bf16_f32 v89, v90, v91
    ds_pk_add_bf16 v7, v88 offset:65408
    ds_pk_add_bf16 v7, v89 offset:65412
    s_mov_b64 exec, s[50:51]
    s_branch L2_d65
L2_c66:
    s_lshl_b64 s[52:53], s[82:83], 1
    s_andn2_b64 s[52:53], s[52:53], s[80:81]
    s_andn2_b64 s[52:53], s[52:53], s[54:55]
    s_or_b64 s[80:81], s[80:81], s[52:53]
    s_not_b64 vcc, s[52:53]
    s_mov_b64 exec, -1
    v_cndmask_b32_dpp v84, v84, v84, vcc wave_shr:1 row_mask:0xf bank_mask:0xf
    v_cndmask_b32_dpp v85, v85, v85, vcc wave_shr:1 row_mask:0xf bank_mask:0xf
    s_lshr_b64 s[52:53], s[52:53], 1
    v_cndmask_b32_dpp v86, v86, v86, vcc wave_shr:1 row_mask:0xf bank_mask:0xf
    v_cndmask_b32_dpp v87, v87, v87, vcc wave_shr:1 row_mask:0xf bank_mask:0xf
    s_andn2_b64 s[82:83], s[82:83], s[52:53]
    v_cndmask_b32_dpp v7, v7, v7, vcc wave_shr:1 row_mask:0xf bank_mask:0xf
    s_mov_b64 exec, s[54:55]
    s_cbranch_scc0 L2_d66
    s_mov_b64 exec, s[82:83]
    s_nop 1
    v_mfma_f32_4x4x4_16b_bf16 v[88:91], v[12:13], v[84:85], 0
    s_nop 1
    v_mfma_f32_4x4x4_16b_bf16 v[88:91], v[10:11], v[86:87], v[88:91]
    s_nop 4
    v_cvt_pk_bf16_f32 v88, v88, v89
    v_cvt_pk_bf16_f32 v89, v90, v91
    ds_pk_add_bf16 v7, v88 offset:65408
    ds_pk_add_bf16 v7, v89 offset:65412
    s_mov_b64 exec, s[54:55]
    s_branch L2_d66
L2_c67:
    s_lshl_b64 s[52:53], s[82:83], 1
    s_andn2_b64 s[52:53], s[52:53], s[80:81]
    s_andn2_b64 s[52:53], s[52:53], s[50:51]
    s_or_b64 s[80:81], s[80:81], s[52:53]
    s_not_b64 vcc, s[52:53]
    s_mov_b64 exec, -1
    v_cndmask_b32_dpp v84, v84, v84, vcc wave_shr:1 row_mask:0xf bank_mask:0xf
    v_cndmask_b32_dpp v85, v85, v85, vcc wave_shr:1 row_mask:0xf bank_mask:0xf
    s_lshr_b64 s[52:53], s[52:53], 1
    v_cndmask_b32_dpp v86, v86, v86, vcc wave_shr:1 row_mask:0xf bank_mask:0xf
    v_cndmask_b32_dpp v87, v87, v87, vcc wave_shr:1 row_mask:0xf bank_mask:0xf
    s_andn2_b64 s[82:83], s[82:83], s[52:53]
    v_cndmask_b32_dpp v7, v7, v7, vcc wave_shr:1 row_mask:0xf bank_mask:0xf
    s_mov_b64 exec, s[50:51]
    s_cbranch_scc0 L2_d67
    s_mov_b64 exec, s[82:83]
    s_nop 1
    v_mfma_f32_4x4x4_16b_bf16 v[88:91], v[12:13], v[84:85], 0
    s_nop 1
    v_mfma_f32_4x4x4_16b_bf16 v[88:91], v[10:11], v[86:87], v[88:91]
    s_nop 4
    v_cvt_pk_bf16_f32 v88, v88, v89
    v_cvt_pk_bf16_f32 v89, v90, v91
    ds_pk_add_bf16 v7, v88 offset:65408
    ds_pk_add_bf16 v7, v89 offset:65412
    s_mov_b64 exec, s[50:51]
    s_branch L2_d67
L2_xo68:
    v_cmp_lt_u32 vcc, 20, v99
    s_mov_b32 s101, 1
    s_cbranch_vccz L2_xp68
    v_cmp_lt_u32 vcc, 32, v99
    v_cmp_lt_u32 s[58:59], 31, v88
    s_mov_b32 s101, 2
    s_or_b64 vcc, vcc, s[58:59]
    s_cbranch_scc0 L2_xp68
    s_mov_b32 s37, 0x10000
    s_branch L2_xp68
L2_c69:
    s_lshl_b64 s[52:53], s[82:83], 1
    s_andn2_b64 s[52:53], s[52:53], s[80:81]
    s_andn2_b64 s[52:53], s[52:53], s[54:55]
    s_or_b64 s[80:81], s[80:81], s[52:53]
    s_not_b64 vcc, s[52:53]
    s_mov_b64 exec, -1
    v_cndmask_b32_dpp v84, v84, v84, vcc wave_shr:1 row_mask:0xf bank_mask:0xf
    v_cndmask_b32_dpp v85, v85, v85, vcc wave_shr:1 row_mask:0xf bank_mask:0xf
    s_lshr_b64 s[52:53], s[52:53], 1
    v_cndmask_b32_dpp v86, v86, v86, vcc wave_shr:1 row_mask:0xf bank_mask:0xf
    v_cndmask_b32_dpp v87, v87, v87, vcc wave_shr:1 row_mask:0xf bank_mask:0xf
    s_andn2_b64 s[82:83], s[82:83], s[52:53]
    v_cndmask_b32_dpp v7, v7, v7, vcc wave_shr:1 row_mask:0xf bank_mask:0xf
    s_mov_b64 exec, s[54:55]
    s_cbranch_scc0 L2_d69
    s_mov_b64 exec, s[82:83]
    s_nop 1
    v_mfma_f32_4x4x4_16b_bf16 v[88:91], v[12:13], v[84:85], 0
    s_nop 1
    v_mfma_f32_4x4x4_16b_bf16 v[88:91], v[10:11], v[86:87], v[88:91]
    s_nop 4
    v_cvt_pk_bf16_f32 v88, v88, v89
    v_cvt_pk_bf16_f32 v89, v90, v91
    ds_pk_add_bf16 v7, v88 offset:65408
    ds_pk_add_bf16 v7, v89 offset:65412
    s_mov_b64 exec, s[54:55]
    s_branch L2_d69
L2_c70:
    s_lshl_b64 s[52:53], s[82:83], 1
    s_andn2_b64 s[52:53], s[52:53], s[80:81]
    s_andn2_b64 s[52:53], s[52:53], s[50:51]
    s_or_b64 s[80:81], s[80:81], s[52:53]
    s_not_b64 vcc, s[52:53]
    s_mov_b64 exec, -1
    v_cndmask_b32_dpp v84, v84, v84, vcc wave_shr:1 row_mask:0xf bank_mask:0xf
    v_cndmask_b32_dpp v85, v85, v85, vcc wave_shr:1 row_mask:0xf bank_mask:0xf
    s_lshr_b64 s[52:53], s[52:53], 1
    v_cndmask_b32_dpp v86, v86, v86, vcc wave_shr:1 row_mask:0xf bank_mask:0xf
    v_cndmask_b32_dpp v87, v87, v87, vcc wave_shr:1 row_mask:0xf bank_mask:0xf
    s_andn2_b64 s[82:83], s[82:83], s[52:53]
    v_cndmask_b32_dpp v7, v7, v7, vcc wave_shr:1 row_mask:0xf bank_mask:0xf
    s_mov_b64 exec, s[50:51]
    s_cbranch_scc0 L2_d70
    s_mov_b64 exec, s[82:83]
    s_nop 1
    v_mfma_f32_4x4x4_16b_bf16 v[88:91], v[12:13], v[84:85], 0
    s_nop 1
    v_mfma_f32_4x4x4_16b_bf16 v[88:91], v[10:11], v[86:87], v[88:91]
    s_nop 4
    v_cvt_pk_bf16_f32 v88, v88, v89
    v_cvt_pk_bf16_f32 v89, v90, v91
    ds_pk_add_bf16 v7, v88 offset:65408
    ds_pk_add_bf16 v7, v89 offset:65412
    s_mov_b64 exec, s[50:51]
    s_branch L2_d70
L2_c71:
    s_lshl_b64 s[52:53], s[82:83], 1
    s_andn2_b64 s[52:53], s[52:53], s[80:81]
    s_andn2_b64 s[52:53], s[52:53], s[54:55]
    s_or_b64 s[80:81], s[80:81], s[52:53]
    s_not_b64 vcc, s[52:53]
    s_mov_b64 exec, -1
    v_cndmask_b32_dpp v84, v84, v84, vcc wave_shr:1 row_mask:0xf bank_mask:0xf
    v_cndmask_b32_dpp v85, v85, v85, vcc wave_shr:1 row_mask:0xf bank_mask:0xf
    s_lshr_b64 s[52:53], s[52:53], 1
    v_cndmask_b32_dpp v86, v86, v86, vcc wave_shr:1 row_mask:0xf bank_mask:0xf
    v_cndmask_b32_dpp v87, v87, v87, vcc wave_shr:1 row_mask:0xf bank_mask:0xf
    s_andn2_b64 s[82:83], s[82:83], s[52:53]
    v_cndmask_b32_dpp v7, v7, v7, vcc wave_shr:1 row_mask:0xf bank_mask:0xf
    s_mov_b64 exec, s[54:55]
    s_cbranch_scc0 L2_d71
    s_mov_b64 exec, s[82:83]
    s_nop 1
    v_mfma_f32_4x4x4_16b_bf16 v[88:91], v[12:13], v[84:85], 0
    s_nop 1
    v_mfma_f32_4x4x4_16b_bf16 v[88:91], v[10:11], v[86:87], v[88:91]
    s_nop 4
    v_cvt_pk_bf16_f32 v88, v88, v89
    v_cvt_pk_bf16_f32 v89, v90, v91
    ds_pk_add_bf16 v7, v88 offset:65408
    ds_pk_add_bf16 v7, v89 offset:65412
    s_mov_b64 exec, s[54:55]
    s_branch L2_d71
L2_c72:
    s_lshl_b64 s[52:53], s[82:83], 1
    s_andn2_b64 s[52:53], s[52:53], s[80:81]
    s_andn2_b64 s[52:53], s[52:53], s[50:51]
    s_or_b64 s[80:81], s[80:81], s[52:53]
    s_not_b64 vcc, s[52:53]
    s_mov_b64 exec, -1
    v_cndmask_b32_dpp v84, v84, v84, vcc wave_shr:1 row_mask:0xf bank_mask:0xf
    v_cndmask_b32_dpp v85, v85, v85, vcc wave_shr:1 row_mask:0xf bank_mask:0xf
    s_lshr_b64 s[52:53], s[52:53], 1
    v_cndmask_b32_dpp v86, v86, v86, vcc wave_shr:1 row_mask:0xf bank_mask:0xf
    v_cndmask_b32_dpp v87, v87, v87, vcc wave_shr:1 row_mask:0xf bank_mask:0xf
    s_andn2_b64 s[82:83], s[82:83], s[52:53]
    v_cndmask_b32_dpp v7, v7, v7, vcc wave_shr:1 row_mask:0xf bank_mask:0xf
    s_mov_b64 exec, s[50:51]
    s_cbranch_scc0 L2_d72
    s_mov_b64 exec, s[82:83]
    s_nop 1
    v_mfma_f32_4x4x4_16b_bf16 v[88:91], v[12:13], v[84:85], 0
    s_nop 1
    v_mfma_f32_4x4x4_16b_bf16 v[88:91], v[10:11], v[86:87], v[88:91]
    s_nop 4
    v_cvt_pk_bf16_f32 v88, v88, v89
    v_cvt_pk_bf16_f32 v89, v90, v91
    ds_pk_add_bf16 v7, v88 offset:65408
    ds_pk_add_bf16 v7, v89 offset:65412
    s_mov_b64 exec, s[50:51]
    s_branch L2_d72
L2_c73:
    s_lshl_b64 s[52:53], s[82:83], 1
    s_andn2_b64 s[52:53], s[52:53], s[80:81]
    s_andn2_b64 s[52:53], s[52:53], s[54:55]
    s_or_b64 s[80:81], s[80:81], s[52:53]
    s_not_b64 vcc, s[52:53]
    s_mov_b64 exec, -1
    v_cndmask_b32_dpp v84, v84, v84, vcc wave_shr:1 row_mask:0xf bank_mask:0xf
    v_cndmask_b32_dpp v85, v85, v85, vcc wave_shr:1 row_mask:0xf bank_mask:0xf
    s_lshr_b64 s[52:53], s[52:53], 1
    v_cndmask_b32_dpp v86, v86, v86, vcc wave_shr:1 row_mask:0xf bank_mask:0xf
    v_cndmask_b32_dpp v87, v87, v87, vcc wave_shr:1 row_mask:0xf bank_mask:0xf
    s_andn2_b64 s[82:83], s[82:83], s[52:53]
    v_cndmask_b32_dpp v7, v7, v7, vcc wave_shr:1 row_mask:0xf bank_mask:0xf
    s_mov_b64 exec, s[54:55]
    s_cbranch_scc0 L2_d73
    s_mov_b64 exec, s[82:83]
    s_nop 1
    v_mfma_f32_4x4x4_16b_bf16 v[88:91], v[12:13], v[84:85], 0
    s_nop 1
    v_mfma_f32_4x4x4_16b_bf16 v[88:91], v[10:11], v[86:87], v[88:91]
    s_nop 4
    v_cvt_pk_bf16_f32 v88, v88, v89
    v_cvt_pk_bf16_f32 v89, v90, v91
    ds_pk_add_bf16 v7, v88 offset:65408
    ds_pk_add_bf16 v7, v89 offset:65412
    s_mov_b64 exec, s[54:55]
    s_branch L2_d73
L2_c74:
    s_lshl_b64 s[52:53], s[82:83], 1
    s_andn2_b64 s[52:53], s[52:53], s[80:81]
    s_andn2_b64 s[52:53], s[52:53], s[50:51]
    s_or_b64 s[80:81], s[80:81], s[52:53]
    s_not_b64 vcc, s[52:53]
    s_mov_b64 exec, -1
    v_cndmask_b32_dpp v84, v84, v84, vcc wave_shr:1 row_mask:0xf bank_mask:0xf
    v_cndmask_b32_dpp v85, v85, v85, vcc wave_shr:1 row_mask:0xf bank_mask:0xf
    s_lshr_b64 s[52:53], s[52:53], 1
    v_cndmask_b32_dpp v86, v86, v86, vcc wave_shr:1 row_mask:0xf bank_mask:0xf
    v_cndmask_b32_dpp v87, v87, v87, vcc wave_shr:1 row_mask:0xf bank_mask:0xf
    s_andn2_b64 s[82:83], s[82:83], s[52:53]
    v_cndmask_b32_dpp v7, v7, v7, vcc wave_shr:1 row_mask:0xf bank_mask:0xf
    s_mov_b64 exec, s[50:51]
    s_cbranch_scc0 L2_d74
    s_mov_b64 exec, s[82:83]
    s_nop 1
    v_mfma_f32_4x4x4_16b_bf16 v[88:91], v[12:13], v[84:85], 0
    s_nop 1
    v_mfma_f32_4x4x4_16b_bf16 v[88:91], v[10:11], v[86:87], v[88:91]
    s_nop 4
    v_cvt_pk_bf16_f32 v88, v88, v89
    v_cvt_pk_bf16_f32 v89, v90, v91
    ds_pk_add_bf16 v7, v88 offset:65408
    ds_pk_add_bf16 v7, v89 offset:65412
    s_mov_b64 exec, s[50:51]
    s_branch L2_d74
L2_c75:
    s_lshl_b64 s[52:53], s[82:83], 1
    s_andn2_b64 s[52:53], s[52:53], s[80:81]
    s_andn2_b64 s[52:53], s[52:53], s[54:55]
    s_or_b64 s[80:81], s[80:81], s[52:53]
    s_not_b64 vcc, s[52:53]
    s_mov_b64 exec, -1
    v_cndmask_b32_dpp v84, v84, v84, vcc wave_shr:1 row_mask:0xf bank_mask:0xf
    v_cndmask_b32_dpp v85, v85, v85, vcc wave_shr:1 row_mask:0xf bank_mask:0xf
    s_lshr_b64 s[52:53], s[52:53], 1
    v_cndmask_b32_dpp v86, v86, v86, vcc wave_shr:1 row_mask:0xf bank_mask:0xf
    v_cndmask_b32_dpp v87, v87, v87, vcc wave_shr:1 row_mask:0xf bank_mask:0xf
    s_andn2_b64 s[82:83], s[82:83], s[52:53]
    v_cndmask_b32_dpp v7, v7, v7, vcc wave_shr:1 row_mask:0xf bank_mask:0xf
    s_mov_b64 exec, s[54:55]
    s_cbranch_scc0 L2_d75
    s_mov_b64 exec, s[82:83]
    s_nop 1
    v_mfma_f32_4x4x4_16b_bf16 v[88:91], v[12:13], v[84:85], 0
    s_nop 1
    v_mfma_f32_4x4x4_16b_bf16 v[88:91], v[10:11], v[86:87], v[88:91]
    s_nop 4
    v_cvt_pk_bf16_f32 v88, v88, v89
    v_cvt_pk_bf16_f32 v89, v90, v91
    ds_pk_add_bf16 v7, v88 offset:65408
    ds_pk_add_bf16 v7, v89 offset:65412
    s_mov_b64 exec, s[54:55]
    s_branch L2_d75
L2_c76:
    s_lshl_b64 s[52:53], s[82:83], 1
    s_andn2_b64 s[52:53], s[52:53], s[80:81]
    s_andn2_b64 s[52:53], s[52:53], s[50:51]
    s_or_b64 s[80:81], s[80:81], s[52:53]
    s_not_b64 vcc, s[52:53]
    s_mov_b64 exec, -1
    v_cndmask_b32_dpp v84, v84, v84, vcc wave_shr:1 row_mask:0xf bank_mask:0xf
    v_cndmask_b32_dpp v85, v85, v85, vcc wave_shr:1 row_mask:0xf bank_mask:0xf
    s_lshr_b64 s[52:53], s[52:53], 1
    v_cndmask_b32_dpp v86, v86, v86, vcc wave_shr:1 row_mask:0xf bank_mask:0xf
    v_cndmask_b32_dpp v87, v87, v87, vcc wave_shr:1 row_mask:0xf bank_mask:0xf
    s_andn2_b64 s[82:83], s[82:83], s[52:53]
    v_cndmask_b32_dpp v7, v7, v7, vcc wave_shr:1 row_mask:0xf bank_mask:0xf
    s_mov_b64 exec, s[50:51]
    s_cbranch_scc0 L2_d76
    s_mov_b64 exec, s[82:83]
    s_nop 1
    v_mfma_f32_4x4x4_16b_bf16 v[88:91], v[12:13], v[84:85], 0
    s_nop 1
    v_mfma_f32_4x4x4_16b_bf16 v[88:91], v[10:11], v[86:87], v[88:91]
    s_nop 4
    v_cvt_pk_bf16_f32 v88, v88, v89
    v_cvt_pk_bf16_f32 v89, v90, v91
    ds_pk_add_bf16 v7, v88 offset:65408
    ds_pk_add_bf16 v7, v89 offset:65412
    s_mov_b64 exec, s[50:51]
    s_branch L2_d76
L2_c77:
    s_lshl_b64 s[52:53], s[82:83], 1
    s_andn2_b64 s[52:53], s[52:53], s[80:81]
    s_andn2_b64 s[52:53], s[52:53], s[54:55]
    s_or_b64 s[80:81], s[80:81], s[52:53]
    s_not_b64 vcc, s[52:53]
    s_mov_b64 exec, -1
    v_cndmask_b32_dpp v84, v84, v84, vcc wave_shr:1 row_mask:0xf bank_mask:0xf
    v_cndmask_b32_dpp v85, v85, v85, vcc wave_shr:1 row_mask:0xf bank_mask:0xf
    s_lshr_b64 s[52:53], s[52:53], 1
    v_cndmask_b32_dpp v86, v86, v86, vcc wave_shr:1 row_mask:0xf bank_mask:0xf
    v_cndmask_b32_dpp v87, v87, v87, vcc wave_shr:1 row_mask:0xf bank_mask:0xf
    s_andn2_b64 s[82:83], s[82:83], s[52:53]
    v_cndmask_b32_dpp v7, v7, v7, vcc wave_shr:1 row_mask:0xf bank_mask:0xf
    s_mov_b64 exec, s[54:55]
    s_cbranch_scc0 L2_d77
    s_mov_b64 exec, s[82:83]
    s_nop 1
    v_mfma_f32_4x4x4_16b_bf16 v[88:91], v[12:13], v[84:85], 0
    s_nop 1
    v_mfma_f32_4x4x4_16b_bf16 v[88:91], v[10:11], v[86:87], v[88:91]
    s_nop 4
    v_cvt_pk_bf16_f32 v88, v88, v89
    v_cvt_pk_bf16_f32 v89, v90, v91
    ds_pk_add_bf16 v7, v88 offset:65408
    ds_pk_add_bf16 v7, v89 offset:65412
    s_mov_b64 exec, s[54:55]
    s_branch L2_d77
L2_c78:
    s_lshl_b64 s[52:53], s[82:83], 1
    s_andn2_b64 s[52:53], s[52:53], s[80:81]
    s_andn2_b64 s[52:53], s[52:53], s[50:51]
    s_or_b64 s[80:81], s[80:81], s[52:53]
    s_not_b64 vcc, s[52:53]
    s_mov_b64 exec, -1
    v_cndmask_b32_dpp v84, v84, v84, vcc wave_shr:1 row_mask:0xf bank_mask:0xf
    v_cndmask_b32_dpp v85, v85, v85, vcc wave_shr:1 row_mask:0xf bank_mask:0xf
    s_lshr_b64 s[52:53], s[52:53], 1
    v_cndmask_b32_dpp v86, v86, v86, vcc wave_shr:1 row_mask:0xf bank_mask:0xf
    v_cndmask_b32_dpp v87, v87, v87, vcc wave_shr:1 row_mask:0xf bank_mask:0xf
    s_andn2_b64 s[82:83], s[82:83], s[52:53]
    v_cndmask_b32_dpp v7, v7, v7, vcc wave_shr:1 row_mask:0xf bank_mask:0xf
    s_mov_b64 exec, s[50:51]
    s_cbranch_scc0 L2_d78
    s_mov_b64 exec, s[82:83]
    s_nop 1
    v_mfma_f32_4x4x4_16b_bf16 v[88:91], v[12:13], v[84:85], 0
    s_nop 1
    v_mfma_f32_4x4x4_16b_bf16 v[88:91], v[10:11], v[86:87], v[88:91]
    s_nop 4
    v_cvt_pk_bf16_f32 v88, v88, v89
    v_cvt_pk_bf16_f32 v89, v90, v91
    ds_pk_add_bf16 v7, v88 offset:65408
    ds_pk_add_bf16 v7, v89 offset:65412
    s_mov_b64 exec, s[50:51]
    s_branch L2_d78
L2_xa79:
    s_cmp_eq_u32 s101, 1
    s_cbranch_scc1 L2_xc79
    v_lshlrev_b32 v89, 0, v96
    v_add_u32 v90, 140, v97
    v_bitop3_b32 v90, v89, v45, v90 bitop3:0x6a
    ds_write_b32 v98, v90 offset:28
    v_lshlrev_b32 v89, 4, v96
    v_add_u32 v90, 120, v97
    v_bitop3_b32 v90, v89, v45, v90 bitop3:0x6a
    ds_write_b32 v98, v90 offset:24
    v_lshlrev_b32 v89, 8, v96
    v_add_u32 v90, 100, v97
    v_bitop3_b32 v90, v89, v45, v90 bitop3:0x6a
    ds_write_b32 v98, v90 offset:20
L2_xc79:
    v_lshlrev_b32 v89, 12, v96
    v_add_u32 v90, 80, v97
    v_bitop3_b32 v90, v89, v45, v90 bitop3:0x6a
    ds_write_b32 v98, v90 offset:16
    s_branch L2_xb79
L2_xe79:
    v_cmp_lt_u32 vcc, 32, v99
    v_cmp_lt_u32 s[58:59], 31, v88
    v_lshrrev_b32 v89, 16, v96
    v_add_u32 v97, 80, v97
    s_or_b64 vcc, vcc, s[58:59]
    s_cbranch_scc1 L2_xs79
    v_lshlrev_b32 v89, v1, v89
    v_and_b32 v89, v45, v89
    v_cmp_ne_u32 vcc, 0, v89
    v_xor_b32 v90, v97, v89
    s_add_u32 s3, s37, s38
    v_mbcnt_lo_u32_b32 v98, vcc_lo, 0
    v_mbcnt_hi_u32_b32 v98, vcc_hi, v98
    s_bcnt1_i32_b64 s41, vcc
    v_lshl_add_u32 v98, v98, 2, s3
    s_mov_b64 exec, vcc
    ds_write_b32 v98, v90
    s_mov_b64 exec, -1
    s_lshl2_add_u32 s37, s41, s37
    s_branch L2_xr79
L2_xf79:
    s_waitcnt lgkmcnt(0)
    s_cmp_gt_u32 s37, 1024
    s_cbranch_scc1 L2_xs79
    v_mov_b32 v43, -1
    s_cmp_ge_u32 s37, 512
    s_cbranch_scc1 L2_xg79
    v_mov_b32 v42, -1
    s_cmp_ge_u32 s37, 256
    s_cbranch_scc1 L2_xg79
    v_mov_b32 v41, -1
    s_branch L2_xg79
L2_xs79:
    s_waitcnt lgkmcnt(0)
    v_mov_b32 v40, -1
    v_mov_b32 v41, -1
    v_mov_b32 v42, -1
    v_mov_b32 v43, -1
    s_add_u32 s3, s42, 2
    s_bitset1_b32 s36, s3
    s_branch L2_xg79
L2_c80:
    s_lshl_b64 s[52:53], s[82:83], 1
    s_andn2_b64 s[52:53], s[52:53], s[80:81]
    s_andn2_b64 s[52:53], s[52:53], s[54:55]
    s_or_b64 s[80:81], s[80:81], s[52:53]
    s_not_b64 vcc, s[52:53]
    s_mov_b64 exec, -1
    v_cndmask_b32_dpp v84, v84, v84, vcc wave_shr:1 row_mask:0xf bank_mask:0xf
    v_cndmask_b32_dpp v85, v85, v85, vcc wave_shr:1 row_mask:0xf bank_mask:0xf
    s_lshr_b64 s[52:53], s[52:53], 1
    v_cndmask_b32_dpp v86, v86, v86, vcc wave_shr:1 row_mask:0xf bank_mask:0xf
    v_cndmask_b32_dpp v87, v87, v87, vcc wave_shr:1 row_mask:0xf bank_mask:0xf
    s_andn2_b64 s[82:83], s[82:83], s[52:53]
    v_cndmask_b32_dpp v7, v7, v7, vcc wave_shr:1 row_mask:0xf bank_mask:0xf
    s_mov_b64 exec, s[54:55]
    s_cbranch_scc0 L2_d80
    s_mov_b64 exec, s[82:83]
    s_nop 1
    v_mfma_f32_4x4x4_16b_bf16 v[88:91], v[12:13], v[84:85], 0
    s_nop 1
    v_mfma_f32_4x4x4_16b_bf16 v[88:91], v[10:11], v[86:87], v[88:91]
    s_nop 4
    v_cvt_pk_bf16_f32 v88, v88, v89
    v_cvt_pk_bf16_f32 v89, v90, v91
    ds_pk_add_bf16 v7, v88 offset:65408
    ds_pk_add_bf16 v7, v89 offset:65412
    s_mov_b64 exec, s[54:55]
    s_branch L2_d80
L2_c81:
    s_lshl_b64 s[52:53], s[82:83], 1
    s_andn2_b64 s[52:53], s[52:53], s[80:81]
    s_andn2_b64 s[52:53], s[52:53], s[50:51]
    s_or_b64 s[80:81], s[80:81], s[52:53]
    s_not_b64 vcc, s[52:53]
    s_mov_b64 exec, -1
    v_cndmask_b32_dpp v84, v84, v84, vcc wave_shr:1 row_mask:0xf bank_mask:0xf
    v_cndmask_b32_dpp v85, v85, v85, vcc wave_shr:1 row_mask:0xf bank_mask:0xf
    s_lshr_b64 s[52:53], s[52:53], 1
    v_cndmask_b32_dpp v86, v86, v86, vcc wave_shr:1 row_mask:0xf bank_mask:0xf
    v_cndmask_b32_dpp v87, v87, v87, vcc wave_shr:1 row_mask:0xf bank_mask:0xf
    s_andn2_b64 s[82:83], s[82:83], s[52:53]
    v_cndmask_b32_dpp v7, v7, v7, vcc wave_shr:1 row_mask:0xf bank_mask:0xf
    s_mov_b64 exec, s[50:51]
    s_cbranch_scc0 L2_d81
    s_mov_b64 exec, s[82:83]
    s_nop 1
    v_mfma_f32_4x4x4_16b_bf16 v[88:91], v[12:13], v[84:85], 0
    s_nop 1
    v_mfma_f32_4x4x4_16b_bf16 v[88:91], v[10:11], v[86:87], v[88:91]
    s_nop 4
    v_cvt_pk_bf16_f32 v88, v88, v89
    v_cvt_pk_bf16_f32 v89, v90, v91
    ds_pk_add_bf16 v7, v88 offset:65408
    ds_pk_add_bf16 v7, v89 offset:65412
    s_mov_b64 exec, s[50:51]
    s_branch L2_d81
L2_c82:
    s_lshl_b64 s[52:53], s[82:83], 1
    s_andn2_b64 s[52:53], s[52:53], s[80:81]
    s_andn2_b64 s[52:53], s[52:53], s[54:55]
    s_or_b64 s[80:81], s[80:81], s[52:53]
    s_not_b64 vcc, s[52:53]
    s_mov_b64 exec, -1
    v_cndmask_b32_dpp v84, v84, v84, vcc wave_shr:1 row_mask:0xf bank_mask:0xf
    v_cndmask_b32_dpp v85, v85, v85, vcc wave_shr:1 row_mask:0xf bank_mask:0xf
    s_lshr_b64 s[52:53], s[52:53], 1
    v_cndmask_b32_dpp v86, v86, v86, vcc wave_shr:1 row_mask:0xf bank_mask:0xf
    v_cndmask_b32_dpp v87, v87, v87, vcc wave_shr:1 row_mask:0xf bank_mask:0xf
    s_andn2_b64 s[82:83], s[82:83], s[52:53]
    v_cndmask_b32_dpp v7, v7, v7, vcc wave_shr:1 row_mask:0xf bank_mask:0xf
    s_mov_b64 exec, s[54:55]
    s_cbranch_scc0 L2_d82
    s_mov_b64 exec, s[82:83]
    s_nop 1
    v_mfma_f32_4x4x4_16b_bf16 v[88:91], v[12:13], v[84:85], 0
    s_nop 1
    v_mfma_f32_4x4x4_16b_bf16 v[88:91], v[10:11], v[86:87], v[88:91]
    s_nop 4
    v_cvt_pk_bf16_f32 v88, v88, v89
    v_cvt_pk_bf16_f32 v89, v90, v91
    ds_pk_add_bf16 v7, v88 offset:65408
    ds_pk_add_bf16 v7, v89 offset:65412
    s_mov_b64 exec, s[54:55]
    s_branch L2_d82
L2_c83:
    s_lshl_b64 s[52:53], s[82:83], 1
    s_andn2_b64 s[52:53], s[52:53], s[80:81]
    s_andn2_b64 s[52:53], s[52:53], s[50:51]
    s_or_b64 s[80:81], s[80:81], s[52:53]
    s_not_b64 vcc, s[52:53]
    s_mov_b64 exec, -1
    v_cndmask_b32_dpp v84, v84, v84, vcc wave_shr:1 row_mask:0xf bank_mask:0xf
    v_cndmask_b32_dpp v85, v85, v85, vcc wave_shr:1 row_mask:0xf bank_mask:0xf
    s_lshr_b64 s[52:53], s[52:53], 1
    v_cndmask_b32_dpp v86, v86, v86, vcc wave_shr:1 row_mask:0xf bank_mask:0xf
    v_cndmask_b32_dpp v87, v87, v87, vcc wave_shr:1 row_mask:0xf bank_mask:0xf
    s_andn2_b64 s[82:83], s[82:83], s[52:53]
    v_cndmask_b32_dpp v7, v7, v7, vcc wave_shr:1 row_mask:0xf bank_mask:0xf
    s_mov_b64 exec, s[50:51]
    s_cbranch_scc0 L2_d83
    s_mov_b64 exec, s[82:83]
    s_nop 1
    v_mfma_f32_4x4x4_16b_bf16 v[88:91], v[12:13], v[84:85], 0
    s_nop 1
    v_mfma_f32_4x4x4_16b_bf16 v[88:91], v[10:11], v[86:87], v[88:91]
    s_nop 4
    v_cvt_pk_bf16_f32 v88, v88, v89
    v_cvt_pk_bf16_f32 v89, v90, v91
    ds_pk_add_bf16 v7, v88 offset:65408
    ds_pk_add_bf16 v7, v89 offset:65412
    s_mov_b64 exec, s[50:51]
    s_branch L2_d83
L2_c84:
    s_lshl_b64 s[52:53], s[82:83], 1
    s_andn2_b64 s[52:53], s[52:53], s[80:81]
    s_andn2_b64 s[52:53], s[52:53], s[54:55]
    s_or_b64 s[80:81], s[80:81], s[52:53]
    s_not_b64 vcc, s[52:53]
    s_mov_b64 exec, -1
    v_cndmask_b32_dpp v84, v84, v84, vcc wave_shr:1 row_mask:0xf bank_mask:0xf
    v_cndmask_b32_dpp v85, v85, v85, vcc wave_shr:1 row_mask:0xf bank_mask:0xf
    s_lshr_b64 s[52:53], s[52:53], 1
    v_cndmask_b32_dpp v86, v86, v86, vcc wave_shr:1 row_mask:0xf bank_mask:0xf
    v_cndmask_b32_dpp v87, v87, v87, vcc wave_shr:1 row_mask:0xf bank_mask:0xf
    s_andn2_b64 s[82:83], s[82:83], s[52:53]
    v_cndmask_b32_dpp v7, v7, v7, vcc wave_shr:1 row_mask:0xf bank_mask:0xf
    s_mov_b64 exec, s[54:55]
    s_cbranch_scc0 L2_d84
    s_mov_b64 exec, s[82:83]
    s_nop 1
    v_mfma_f32_4x4x4_16b_bf16 v[88:91], v[12:13], v[84:85], 0
    s_nop 1
    v_mfma_f32_4x4x4_16b_bf16 v[88:91], v[10:11], v[86:87], v[88:91]
    s_nop 4
    v_cvt_pk_bf16_f32 v88, v88, v89
    v_cvt_pk_bf16_f32 v89, v90, v91
    ds_pk_add_bf16 v7, v88 offset:65408
    ds_pk_add_bf16 v7, v89 offset:65412
    s_mov_b64 exec, s[54:55]
    s_branch L2_d84
L2_c85:
    s_lshl_b64 s[52:53], s[82:83], 1
    s_andn2_b64 s[52:53], s[52:53], s[80:81]
    s_andn2_b64 s[52:53], s[52:53], s[50:51]
    s_or_b64 s[80:81], s[80:81], s[52:53]
    s_not_b64 vcc, s[52:53]
    s_mov_b64 exec, -1
    v_cndmask_b32_dpp v84, v84, v84, vcc wave_shr:1 row_mask:0xf bank_mask:0xf
    v_cndmask_b32_dpp v85, v85, v85, vcc wave_shr:1 row_mask:0xf bank_mask:0xf
    s_lshr_b64 s[52:53], s[52:53], 1
    v_cndmask_b32_dpp v86, v86, v86, vcc wave_shr:1 row_mask:0xf bank_mask:0xf
    v_cndmask_b32_dpp v87, v87, v87, vcc wave_shr:1 row_mask:0xf bank_mask:0xf
    s_andn2_b64 s[82:83], s[82:83], s[52:53]
    v_cndmask_b32_dpp v7, v7, v7, vcc wave_shr:1 row_mask:0xf bank_mask:0xf
    s_mov_b64 exec, s[50:51]
    s_cbranch_scc0 L2_d85
    s_mov_b64 exec, s[82:83]
    s_nop 1
    v_mfma_f32_4x4x4_16b_bf16 v[88:91], v[12:13], v[84:85], 0
    s_nop 1
    v_mfma_f32_4x4x4_16b_bf16 v[88:91], v[10:11], v[86:87], v[88:91]
    s_nop 4
    v_cvt_pk_bf16_f32 v88, v88, v89
    v_cvt_pk_bf16_f32 v89, v90, v91
    ds_pk_add_bf16 v7, v88 offset:65408
    ds_pk_add_bf16 v7, v89 offset:65412
    s_mov_b64 exec, s[50:51]
    s_branch L2_d85
L2_xo86:
    v_cmp_lt_u32 vcc, 20, v99
    s_mov_b32 s101, 1
    s_cbranch_vccz L2_xp86
    v_cmp_lt_u32 vcc, 32, v99
    v_cmp_lt_u32 s[58:59], 31, v88
    s_mov_b32 s101, 2
    s_or_b64 vcc, vcc, s[58:59]
    s_cbranch_scc0 L2_xp86
    s_mov_b32 s37, 0x10000
    s_branch L2_xp86
L2_c87:
    s_lshl_b64 s[52:53], s[82:83], 1
    s_andn2_b64 s[52:53], s[52:53], s[80:81]
    s_andn2_b64 s[52:53], s[52:53], s[54:55]
    s_or_b64 s[80:81], s[80:81], s[52:53]
    s_not_b64 vcc, s[52:53]
    s_mov_b64 exec, -1
    v_cndmask_b32_dpp v84, v84, v84, vcc wave_shr:1 row_mask:0xf bank_mask:0xf
    v_cndmask_b32_dpp v85, v85, v85, vcc wave_shr:1 row_mask:0xf bank_mask:0xf
    s_lshr_b64 s[52:53], s[52:53], 1
    v_cndmask_b32_dpp v86, v86, v86, vcc wave_shr:1 row_mask:0xf bank_mask:0xf
    v_cndmask_b32_dpp v87, v87, v87, vcc wave_shr:1 row_mask:0xf bank_mask:0xf
    s_andn2_b64 s[82:83], s[82:83], s[52:53]
    v_cndmask_b32_dpp v7, v7, v7, vcc wave_shr:1 row_mask:0xf bank_mask:0xf
    s_mov_b64 exec, s[54:55]
    s_cbranch_scc0 L2_d87
    s_mov_b64 exec, s[82:83]
    s_nop 1
    v_mfma_f32_4x4x4_16b_bf16 v[88:91], v[12:13], v[84:85], 0
    s_nop 1
    v_mfma_f32_4x4x4_16b_bf16 v[88:91], v[10:11], v[86:87], v[88:91]
    s_nop 4
    v_cvt_pk_bf16_f32 v88, v88, v89
    v_cvt_pk_bf16_f32 v89, v90, v91
    ds_pk_add_bf16 v7, v88 offset:65408
    ds_pk_add_bf16 v7, v89 offset:65412
    s_mov_b64 exec, s[54:55]
    s_branch L2_d87
L2_c88:
    s_lshl_b64 s[52:53], s[82:83], 1
    s_andn2_b64 s[52:53], s[52:53], s[80:81]
    s_andn2_b64 s[52:53], s[52:53], s[50:51]
    s_or_b64 s[80:81], s[80:81], s[52:53]
    s_not_b64 vcc, s[52:53]
    s_mov_b64 exec, -1
    v_cndmask_b32_dpp v84, v84, v84, vcc wave_shr:1 row_mask:0xf bank_mask:0xf
    v_cndmask_b32_dpp v85, v85, v85, vcc wave_shr:1 row_mask:0xf bank_mask:0xf
    s_lshr_b64 s[52:53], s[52:53], 1
    v_cndmask_b32_dpp v86, v86, v86, vcc wave_shr:1 row_mask:0xf bank_mask:0xf
    v_cndmask_b32_dpp v87, v87, v87, vcc wave_shr:1 row_mask:0xf bank_mask:0xf
    s_andn2_b64 s[82:83], s[82:83], s[52:53]
    v_cndmask_b32_dpp v7, v7, v7, vcc wave_shr:1 row_mask:0xf bank_mask:0xf
    s_mov_b64 exec, s[50:51]
    s_cbranch_scc0 L2_d88
    s_mov_b64 exec, s[82:83]
    s_nop 1
    v_mfma_f32_4x4x4_16b_bf16 v[88:91], v[12:13], v[84:85], 0
    s_nop 1
    v_mfma_f32_4x4x4_16b_bf16 v[88:91], v[10:11], v[86:87], v[88:91]
    s_nop 4
    v_cvt_pk_bf16_f32 v88, v88, v89
    v_cvt_pk_bf16_f32 v89, v90, v91
    ds_pk_add_bf16 v7, v88 offset:65408
    ds_pk_add_bf16 v7, v89 offset:65412
    s_mov_b64 exec, s[50:51]
    s_branch L2_d88
L2_c89:
    s_lshl_b64 s[52:53], s[82:83], 1
    s_andn2_b64 s[52:53], s[52:53], s[80:81]
    s_andn2_b64 s[52:53], s[52:53], s[54:55]
    s_or_b64 s[80:81], s[80:81], s[52:53]
    s_not_b64 vcc, s[52:53]
    s_mov_b64 exec, -1
    v_cndmask_b32_dpp v84, v84, v84, vcc wave_shr:1 row_mask:0xf bank_mask:0xf
    v_cndmask_b32_dpp v85, v85, v85, vcc wave_shr:1 row_mask:0xf bank_mask:0xf
    s_lshr_b64 s[52:53], s[52:53], 1
    v_cndmask_b32_dpp v86, v86, v86, vcc wave_shr:1 row_mask:0xf bank_mask:0xf
    v_cndmask_b32_dpp v87, v87, v87, vcc wave_shr:1 row_mask:0xf bank_mask:0xf
    s_andn2_b64 s[82:83], s[82:83], s[52:53]
    v_cndmask_b32_dpp v7, v7, v7, vcc wave_shr:1 row_mask:0xf bank_mask:0xf
    s_mov_b64 exec, s[54:55]
    s_cbranch_scc0 L2_d89
    s_mov_b64 exec, s[82:83]
    s_nop 1
    v_mfma_f32_4x4x4_16b_bf16 v[88:91], v[12:13], v[84:85], 0
    s_nop 1
    v_mfma_f32_4x4x4_16b_bf16 v[88:91], v[10:11], v[86:87], v[88:91]
    s_nop 4
    v_cvt_pk_bf16_f32 v88, v88, v89
    v_cvt_pk_bf16_f32 v89, v90, v91
    ds_pk_add_bf16 v7, v88 offset:65408
    ds_pk_add_bf16 v7, v89 offset:65412
    s_mov_b64 exec, s[54:55]
    s_branch L2_d89
L2_c90:
    s_lshl_b64 s[52:53], s[82:83], 1
    s_andn2_b64 s[52:53], s[52:53], s[80:81]
    s_andn2_b64 s[52:53], s[52:53], s[50:51]
    s_or_b64 s[80:81], s[80:81], s[52:53]
    s_not_b64 vcc, s[52:53]
    s_mov_b64 exec, -1
    v_cndmask_b32_dpp v84, v84, v84, vcc wave_shr:1 row_mask:0xf bank_mask:0xf
    v_cndmask_b32_dpp v85, v85, v85, vcc wave_shr:1 row_mask:0xf bank_mask:0xf
    s_lshr_b64 s[52:53], s[52:53], 1
    v_cndmask_b32_dpp v86, v86, v86, vcc wave_shr:1 row_mask:0xf bank_mask:0xf
    v_cndmask_b32_dpp v87, v87, v87, vcc wave_shr:1 row_mask:0xf bank_mask:0xf
    s_andn2_b64 s[82:83], s[82:83], s[52:53]
    v_cndmask_b32_dpp v7, v7, v7, vcc wave_shr:1 row_mask:0xf bank_mask:0xf
    s_mov_b64 exec, s[50:51]
    s_cbranch_scc0 L2_d90
    s_mov_b64 exec, s[82:83]
    s_nop 1
    v_mfma_f32_4x4x4_16b_bf16 v[88:91], v[12:13], v[84:85], 0
    s_nop 1
    v_mfma_f32_4x4x4_16b_bf16 v[88:91], v[10:11], v[86:87], v[88:91]
    s_nop 4
    v_cvt_pk_bf16_f32 v88, v88, v89
    v_cvt_pk_bf16_f32 v89, v90, v91
    ds_pk_add_bf16 v7, v88 offset:65408
    ds_pk_add_bf16 v7, v89 offset:65412
    s_mov_b64 exec, s[50:51]
    s_branch L2_d90
L2_c91:
    s_lshl_b64 s[52:53], s[82:83], 1
    s_andn2_b64 s[52:53], s[52:53], s[80:81]
    s_andn2_b64 s[52:53], s[52:53], s[54:55]
    s_or_b64 s[80:81], s[80:81], s[52:53]
    s_not_b64 vcc, s[52:53]
    s_mov_b64 exec, -1
    v_cndmask_b32_dpp v84, v84, v84, vcc wave_shr:1 row_mask:0xf bank_mask:0xf
    v_cndmask_b32_dpp v85, v85, v85, vcc wave_shr:1 row_mask:0xf bank_mask:0xf
    s_lshr_b64 s[52:53], s[52:53], 1
    v_cndmask_b32_dpp v86, v86, v86, vcc wave_shr:1 row_mask:0xf bank_mask:0xf
    v_cndmask_b32_dpp v87, v87, v87, vcc wave_shr:1 row_mask:0xf bank_mask:0xf
    s_andn2_b64 s[82:83], s[82:83], s[52:53]
    v_cndmask_b32_dpp v7, v7, v7, vcc wave_shr:1 row_mask:0xf bank_mask:0xf
    s_mov_b64 exec, s[54:55]
    s_cbranch_scc0 L2_d91
    s_mov_b64 exec, s[82:83]
    s_nop 1
    v_mfma_f32_4x4x4_16b_bf16 v[88:91], v[12:13], v[84:85], 0
    s_nop 1
    v_mfma_f32_4x4x4_16b_bf16 v[88:91], v[10:11], v[86:87], v[88:91]
    s_nop 4
    v_cvt_pk_bf16_f32 v88, v88, v89
    v_cvt_pk_bf16_f32 v89, v90, v91
    ds_pk_add_bf16 v7, v88 offset:65408
    ds_pk_add_bf16 v7, v89 offset:65412
    s_mov_b64 exec, s[54:55]
    s_branch L2_d91
L2_c92:
    s_lshl_b64 s[52:53], s[82:83], 1
    s_andn2_b64 s[52:53], s[52:53], s[80:81]
    s_andn2_b64 s[52:53], s[52:53], s[50:51]
    s_or_b64 s[80:81], s[80:81], s[52:53]
    s_not_b64 vcc, s[52:53]
    s_mov_b64 exec, -1
    v_cndmask_b32_dpp v84, v84, v84, vcc wave_shr:1 row_mask:0xf bank_mask:0xf
    v_cndmask_b32_dpp v85, v85, v85, vcc wave_shr:1 row_mask:0xf bank_mask:0xf
    s_lshr_b64 s[52:53], s[52:53], 1
    v_cndmask_b32_dpp v86, v86, v86, vcc wave_shr:1 row_mask:0xf bank_mask:0xf
    v_cndmask_b32_dpp v87, v87, v87, vcc wave_shr:1 row_mask:0xf bank_mask:0xf
    s_andn2_b64 s[82:83], s[82:83], s[52:53]
    v_cndmask_b32_dpp v7, v7, v7, vcc wave_shr:1 row_mask:0xf bank_mask:0xf
    s_mov_b64 exec, s[50:51]
    s_cbranch_scc0 L2_d92
    s_mov_b64 exec, s[82:83]
    s_nop 1
    v_mfma_f32_4x4x4_16b_bf16 v[88:91], v[12:13], v[84:85], 0
    s_nop 1
    v_mfma_f32_4x4x4_16b_bf16 v[88:91], v[10:11], v[86:87], v[88:91]
    s_nop 4
    v_cvt_pk_bf16_f32 v88, v88, v89
    v_cvt_pk_bf16_f32 v89, v90, v91
    ds_pk_add_bf16 v7, v88 offset:65408
    ds_pk_add_bf16 v7, v89 offset:65412
    s_mov_b64 exec, s[50:51]
    s_branch L2_d92
L2_c93:
    s_lshl_b64 s[52:53], s[82:83], 1
    s_andn2_b64 s[52:53], s[52:53], s[80:81]
    s_andn2_b64 s[52:53], s[52:53], s[54:55]
    s_or_b64 s[80:81], s[80:81], s[52:53]
    s_not_b64 vcc, s[52:53]
    s_mov_b64 exec, -1
    v_cndmask_b32_dpp v84, v84, v84, vcc wave_shr:1 row_mask:0xf bank_mask:0xf
    v_cndmask_b32_dpp v85, v85, v85, vcc wave_shr:1 row_mask:0xf bank_mask:0xf
    s_lshr_b64 s[52:53], s[52:53], 1
    v_cndmask_b32_dpp v86, v86, v86, vcc wave_shr:1 row_mask:0xf bank_mask:0xf
    v_cndmask_b32_dpp v87, v87, v87, vcc wave_shr:1 row_mask:0xf bank_mask:0xf
    s_andn2_b64 s[82:83], s[82:83], s[52:53]
    v_cndmask_b32_dpp v7, v7, v7, vcc wave_shr:1 row_mask:0xf bank_mask:0xf
    s_mov_b64 exec, s[54:55]
    s_cbranch_scc0 L2_d93
    s_mov_b64 exec, s[82:83]
    s_nop 1
    v_mfma_f32_4x4x4_16b_bf16 v[88:91], v[12:13], v[84:85], 0
    s_nop 1
    v_mfma_f32_4x4x4_16b_bf16 v[88:91], v[10:11], v[86:87], v[88:91]
    s_nop 4
    v_cvt_pk_bf16_f32 v88, v88, v89
    v_cvt_pk_bf16_f32 v89, v90, v91
    ds_pk_add_bf16 v7, v88 offset:65408
    ds_pk_add_bf16 v7, v89 offset:65412
    s_mov_b64 exec, s[54:55]
    s_branch L2_d93
L2_c94:
    s_lshl_b64 s[52:53], s[82:83], 1
    s_andn2_b64 s[52:53], s[52:53], s[80:81]
    s_andn2_b64 s[52:53], s[52:53], s[50:51]
    s_or_b64 s[80:81], s[80:81], s[52:53]
    s_not_b64 vcc, s[52:53]
    s_mov_b64 exec, -1
    v_cndmask_b32_dpp v84, v84, v84, vcc wave_shr:1 row_mask:0xf bank_mask:0xf
    v_cndmask_b32_dpp v85, v85, v85, vcc wave_shr:1 row_mask:0xf bank_mask:0xf
    s_lshr_b64 s[52:53], s[52:53], 1
    v_cndmask_b32_dpp v86, v86, v86, vcc wave_shr:1 row_mask:0xf bank_mask:0xf
    v_cndmask_b32_dpp v87, v87, v87, vcc wave_shr:1 row_mask:0xf bank_mask:0xf
    s_andn2_b64 s[82:83], s[82:83], s[52:53]
    v_cndmask_b32_dpp v7, v7, v7, vcc wave_shr:1 row_mask:0xf bank_mask:0xf
    s_mov_b64 exec, s[50:51]
    s_cbranch_scc0 L2_d94
    s_mov_b64 exec, s[82:83]
    s_nop 1
    v_mfma_f32_4x4x4_16b_bf16 v[88:91], v[12:13], v[84:85], 0
    s_nop 1
    v_mfma_f32_4x4x4_16b_bf16 v[88:91], v[10:11], v[86:87], v[88:91]
    s_nop 4
    v_cvt_pk_bf16_f32 v88, v88, v89
    v_cvt_pk_bf16_f32 v89, v90, v91
    ds_pk_add_bf16 v7, v88 offset:65408
    ds_pk_add_bf16 v7, v89 offset:65412
    s_mov_b64 exec, s[50:51]
    s_branch L2_d94
L2_c95:
    s_lshl_b64 s[52:53], s[82:83], 1
    s_andn2_b64 s[52:53], s[52:53], s[80:81]
    s_andn2_b64 s[52:53], s[52:53], s[54:55]
    s_or_b64 s[80:81], s[80:81], s[52:53]
    s_not_b64 vcc, s[52:53]
    s_mov_b64 exec, -1
    v_cndmask_b32_dpp v84, v84, v84, vcc wave_shr:1 row_mask:0xf bank_mask:0xf
    v_cndmask_b32_dpp v85, v85, v85, vcc wave_shr:1 row_mask:0xf bank_mask:0xf
    s_lshr_b64 s[52:53], s[52:53], 1
    v_cndmask_b32_dpp v86, v86, v86, vcc wave_shr:1 row_mask:0xf bank_mask:0xf
    v_cndmask_b32_dpp v87, v87, v87, vcc wave_shr:1 row_mask:0xf bank_mask:0xf
    s_andn2_b64 s[82:83], s[82:83], s[52:53]
    v_cndmask_b32_dpp v7, v7, v7, vcc wave_shr:1 row_mask:0xf bank_mask:0xf
    s_mov_b64 exec, s[54:55]
    s_cbranch_scc0 L2_d95
    s_mov_b64 exec, s[82:83]
    s_nop 1
    v_mfma_f32_4x4x4_16b_bf16 v[88:91], v[12:13], v[84:85], 0
    s_nop 1
    v_mfma_f32_4x4x4_16b_bf16 v[88:91], v[10:11], v[86:87], v[88:91]
    s_nop 4
    v_cvt_pk_bf16_f32 v88, v88, v89
    v_cvt_pk_bf16_f32 v89, v90, v91
    ds_pk_add_bf16 v7, v88 offset:65408
    ds_pk_add_bf16 v7, v89 offset:65412
    s_mov_b64 exec, s[54:55]
    s_branch L2_d95
L2_c96:
    s_lshl_b64 s[52:53], s[82:83], 1
    s_andn2_b64 s[52:53], s[52:53], s[80:81]
    s_andn2_b64 s[52:53], s[52:53], s[50:51]
    s_or_b64 s[80:81], s[80:81], s[52:53]
    s_not_b64 vcc, s[52:53]
    s_mov_b64 exec, -1
    v_cndmask_b32_dpp v84, v84, v84, vcc wave_shr:1 row_mask:0xf bank_mask:0xf
    v_cndmask_b32_dpp v85, v85, v85, vcc wave_shr:1 row_mask:0xf bank_mask:0xf
    s_lshr_b64 s[52:53], s[52:53], 1
    v_cndmask_b32_dpp v86, v86, v86, vcc wave_shr:1 row_mask:0xf bank_mask:0xf
    v_cndmask_b32_dpp v87, v87, v87, vcc wave_shr:1 row_mask:0xf bank_mask:0xf
    s_andn2_b64 s[82:83], s[82:83], s[52:53]
    v_cndmask_b32_dpp v7, v7, v7, vcc wave_shr:1 row_mask:0xf bank_mask:0xf
    s_mov_b64 exec, s[50:51]
    s_cbranch_scc0 L2_d96
    s_mov_b64 exec, s[82:83]
    s_nop 1
    v_mfma_f32_4x4x4_16b_bf16 v[88:91], v[12:13], v[84:85], 0
    s_nop 1
    v_mfma_f32_4x4x4_16b_bf16 v[88:91], v[10:11], v[86:87], v[88:91]
    s_nop 4
    v_cvt_pk_bf16_f32 v88, v88, v89
    v_cvt_pk_bf16_f32 v89, v90, v91
    ds_pk_add_bf16 v7, v88 offset:65408
    ds_pk_add_bf16 v7, v89 offset:65412
    s_mov_b64 exec, s[50:51]
    s_branch L2_d96
L2_xa97:
    s_cmp_eq_u32 s101, 1
    s_cbranch_scc1 L2_xc97
    v_lshlrev_b32 v89, 0, v96
    v_add_u32 v90, 140, v97
    v_bitop3_b32 v90, v89, v45, v90 bitop3:0x6a
    ds_write_b32 v98, v90 offset:28
    v_lshlrev_b32 v89, 4, v96
    v_add_u32 v90, 120, v97
    v_bitop3_b32 v90, v89, v45, v90 bitop3:0x6a
    ds_write_b32 v98, v90 offset:24
    v_lshlrev_b32 v89, 8, v96
    v_add_u32 v90, 100, v97
    v_bitop3_b32 v90, v89, v45, v90 bitop3:0x6a
    ds_write_b32 v98, v90 offset:20
L2_xc97:
    v_lshlrev_b32 v89, 12, v96
    v_add_u32 v90, 80, v97
    v_bitop3_b32 v90, v89, v45, v90 bitop3:0x6a
    ds_write_b32 v98, v90 offset:16
    s_branch L2_xb97
L2_xe97:
    v_cmp_lt_u32 vcc, 32, v99
    v_cmp_lt_u32 s[58:59], 31, v88
    v_lshrrev_b32 v89, 16, v96
    v_add_u32 v97, 80, v97
    s_or_b64 vcc, vcc, s[58:59]
    s_cbranch_scc1 L2_xs97
    v_lshlrev_b32 v89, v1, v89
    v_and_b32 v89, v45, v89
    v_cmp_ne_u32 vcc, 0, v89
    v_xor_b32 v90, v97, v89
    s_add_u32 s3, s37, s38
    v_mbcnt_lo_u32_b32 v98, vcc_lo, 0
    v_mbcnt_hi_u32_b32 v98, vcc_hi, v98
    s_bcnt1_i32_b64 s41, vcc
    v_lshl_add_u32 v98, v98, 2, s3
    s_mov_b64 exec, vcc
    ds_write_b32 v98, v90
    s_mov_b64 exec, -1
    s_lshl2_add_u32 s37, s41, s37
    s_branch L2_xr97
L2_xf97:
    s_waitcnt lgkmcnt(0)
    s_cmp_gt_u32 s37, 1024
    s_cbranch_scc1 L2_xs97
    v_mov_b32 v43, -1
    s_cmp_ge_u32 s37, 512
    s_cbranch_scc1 L2_xg97
    v_mov_b32 v42, -1
    s_cmp_ge_u32 s37, 256
    s_cbranch_scc1 L2_xg97
    v_mov_b32 v41, -1
    s_branch L2_xg97
L2_xs97:
    s_waitcnt lgkmcnt(0)
    v_mov_b32 v40, -1
    v_mov_b32 v41, -1
    v_mov_b32 v42, -1
    v_mov_b32 v43, -1
    s_add_u32 s3, s42, 2
    s_bitset1_b32 s36, s3
    s_branch L2_xg97
L2_c98:
    s_lshl_b64 s[52:53], s[82:83], 1
    s_andn2_b64 s[52:53], s[52:53], s[80:81]
    s_andn2_b64 s[52:53], s[52:53], s[54:55]
    s_or_b64 s[80:81], s[80:81], s[52:53]
    s_not_b64 vcc, s[52:53]
    s_mov_b64 exec, -1
    v_cndmask_b32_dpp v84, v84, v84, vcc wave_shr:1 row_mask:0xf bank_mask:0xf
    v_cndmask_b32_dpp v85, v85, v85, vcc wave_shr:1 row_mask:0xf bank_mask:0xf
    s_lshr_b64 s[52:53], s[52:53], 1
    v_cndmask_b32_dpp v86, v86, v86, vcc wave_shr:1 row_mask:0xf bank_mask:0xf
    v_cndmask_b32_dpp v87, v87, v87, vcc wave_shr:1 row_mask:0xf bank_mask:0xf
    s_andn2_b64 s[82:83], s[82:83], s[52:53]
    v_cndmask_b32_dpp v7, v7, v7, vcc wave_shr:1 row_mask:0xf bank_mask:0xf
    s_mov_b64 exec, s[54:55]
    s_cbranch_scc0 L2_d98
    s_mov_b64 exec, s[82:83]
    s_nop 1
    v_mfma_f32_4x4x4_16b_bf16 v[88:91], v[12:13], v[84:85], 0
    s_nop 1
    v_mfma_f32_4x4x4_16b_bf16 v[88:91], v[10:11], v[86:87], v[88:91]
    s_nop 4
    v_cvt_pk_bf16_f32 v88, v88, v89
    v_cvt_pk_bf16_f32 v89, v90, v91
    ds_pk_add_bf16 v7, v88 offset:65408
    ds_pk_add_bf16 v7, v89 offset:65412
    s_mov_b64 exec, s[54:55]
    s_branch L2_d98
L2_c99:
    s_lshl_b64 s[52:53], s[82:83], 1
    s_andn2_b64 s[52:53], s[52:53], s[80:81]
    s_andn2_b64 s[52:53], s[52:53], s[50:51]
    s_or_b64 s[80:81], s[80:81], s[52:53]
    s_not_b64 vcc, s[52:53]
    s_mov_b64 exec, -1
    v_cndmask_b32_dpp v84, v84, v84, vcc wave_shr:1 row_mask:0xf bank_mask:0xf
    v_cndmask_b32_dpp v85, v85, v85, vcc wave_shr:1 row_mask:0xf bank_mask:0xf
    s_lshr_b64 s[52:53], s[52:53], 1
    v_cndmask_b32_dpp v86, v86, v86, vcc wave_shr:1 row_mask:0xf bank_mask:0xf
    v_cndmask_b32_dpp v87, v87, v87, vcc wave_shr:1 row_mask:0xf bank_mask:0xf
    s_andn2_b64 s[82:83], s[82:83], s[52:53]
    v_cndmask_b32_dpp v7, v7, v7, vcc wave_shr:1 row_mask:0xf bank_mask:0xf
    s_mov_b64 exec, s[50:51]
    s_cbranch_scc0 L2_d99
    s_mov_b64 exec, s[82:83]
    s_nop 1
    v_mfma_f32_4x4x4_16b_bf16 v[88:91], v[12:13], v[84:85], 0
    s_nop 1
    v_mfma_f32_4x4x4_16b_bf16 v[88:91], v[10:11], v[86:87], v[88:91]
    s_nop 4
    v_cvt_pk_bf16_f32 v88, v88, v89
    v_cvt_pk_bf16_f32 v89, v90, v91
    ds_pk_add_bf16 v7, v88 offset:65408
    ds_pk_add_bf16 v7, v89 offset:65412
    s_mov_b64 exec, s[50:51]
    s_branch L2_d99
L2_c100:
    s_lshl_b64 s[52:53], s[82:83], 1
    s_andn2_b64 s[52:53], s[52:53], s[80:81]
    s_andn2_b64 s[52:53], s[52:53], s[54:55]
    s_or_b64 s[80:81], s[80:81], s[52:53]
    s_not_b64 vcc, s[52:53]
    s_mov_b64 exec, -1
    v_cndmask_b32_dpp v84, v84, v84, vcc wave_shr:1 row_mask:0xf bank_mask:0xf
    v_cndmask_b32_dpp v85, v85, v85, vcc wave_shr:1 row_mask:0xf bank_mask:0xf
    s_lshr_b64 s[52:53], s[52:53], 1
    v_cndmask_b32_dpp v86, v86, v86, vcc wave_shr:1 row_mask:0xf bank_mask:0xf
    v_cndmask_b32_dpp v87, v87, v87, vcc wave_shr:1 row_mask:0xf bank_mask:0xf
    s_andn2_b64 s[82:83], s[82:83], s[52:53]
    v_cndmask_b32_dpp v7, v7, v7, vcc wave_shr:1 row_mask:0xf bank_mask:0xf
    s_mov_b64 exec, s[54:55]
    s_cbranch_scc0 L2_d100
    s_mov_b64 exec, s[82:83]
    s_nop 1
    v_mfma_f32_4x4x4_16b_bf16 v[88:91], v[12:13], v[84:85], 0
    s_nop 1
    v_mfma_f32_4x4x4_16b_bf16 v[88:91], v[10:11], v[86:87], v[88:91]
    s_nop 4
    v_cvt_pk_bf16_f32 v88, v88, v89
    v_cvt_pk_bf16_f32 v89, v90, v91
    ds_pk_add_bf16 v7, v88 offset:65408
    ds_pk_add_bf16 v7, v89 offset:65412
    s_mov_b64 exec, s[54:55]
    s_branch L2_d100
L2_c101:
    s_lshl_b64 s[52:53], s[82:83], 1
    s_andn2_b64 s[52:53], s[52:53], s[80:81]
    s_andn2_b64 s[52:53], s[52:53], s[50:51]
    s_or_b64 s[80:81], s[80:81], s[52:53]
    s_not_b64 vcc, s[52:53]
    s_mov_b64 exec, -1
    v_cndmask_b32_dpp v84, v84, v84, vcc wave_shr:1 row_mask:0xf bank_mask:0xf
    v_cndmask_b32_dpp v85, v85, v85, vcc wave_shr:1 row_mask:0xf bank_mask:0xf
    s_lshr_b64 s[52:53], s[52:53], 1
    v_cndmask_b32_dpp v86, v86, v86, vcc wave_shr:1 row_mask:0xf bank_mask:0xf
    v_cndmask_b32_dpp v87, v87, v87, vcc wave_shr:1 row_mask:0xf bank_mask:0xf
    s_andn2_b64 s[82:83], s[82:83], s[52:53]
    v_cndmask_b32_dpp v7, v7, v7, vcc wave_shr:1 row_mask:0xf bank_mask:0xf
    s_mov_b64 exec, s[50:51]
    s_cbranch_scc0 L2_d101
    s_mov_b64 exec, s[82:83]
    s_nop 1
    v_mfma_f32_4x4x4_16b_bf16 v[88:91], v[12:13], v[84:85], 0
    s_nop 1
    v_mfma_f32_4x4x4_16b_bf16 v[88:91], v[10:11], v[86:87], v[88:91]
    s_nop 4
    v_cvt_pk_bf16_f32 v88, v88, v89
    v_cvt_pk_bf16_f32 v89, v90, v91
    ds_pk_add_bf16 v7, v88 offset:65408
    ds_pk_add_bf16 v7, v89 offset:65412
    s_mov_b64 exec, s[50:51]
    s_branch L2_d101
L2_c102:
    s_lshl_b64 s[52:53], s[82:83], 1
    s_andn2_b64 s[52:53], s[52:53], s[80:81]
    s_andn2_b64 s[52:53], s[52:53], s[54:55]
    s_or_b64 s[80:81], s[80:81], s[52:53]
    s_not_b64 vcc, s[52:53]
    s_mov_b64 exec, -1
    v_cndmask_b32_dpp v84, v84, v84, vcc wave_shr:1 row_mask:0xf bank_mask:0xf
    v_cndmask_b32_dpp v85, v85, v85, vcc wave_shr:1 row_mask:0xf bank_mask:0xf
    s_lshr_b64 s[52:53], s[52:53], 1
    v_cndmask_b32_dpp v86, v86, v86, vcc wave_shr:1 row_mask:0xf bank_mask:0xf
    v_cndmask_b32_dpp v87, v87, v87, vcc wave_shr:1 row_mask:0xf bank_mask:0xf
    s_andn2_b64 s[82:83], s[82:83], s[52:53]
    v_cndmask_b32_dpp v7, v7, v7, vcc wave_shr:1 row_mask:0xf bank_mask:0xf
    s_mov_b64 exec, s[54:55]
    s_cbranch_scc0 L2_d102
    s_mov_b64 exec, s[82:83]
    s_nop 1
    v_mfma_f32_4x4x4_16b_bf16 v[88:91], v[12:13], v[84:85], 0
    s_nop 1
    v_mfma_f32_4x4x4_16b_bf16 v[88:91], v[10:11], v[86:87], v[88:91]
    s_nop 4
    v_cvt_pk_bf16_f32 v88, v88, v89
    v_cvt_pk_bf16_f32 v89, v90, v91
    ds_pk_add_bf16 v7, v88 offset:65408
    ds_pk_add_bf16 v7, v89 offset:65412
    s_mov_b64 exec, s[54:55]
    s_branch L2_d102
L2_c103:
    s_lshl_b64 s[52:53], s[82:83], 1
    s_andn2_b64 s[52:53], s[52:53], s[80:81]
    s_andn2_b64 s[52:53], s[52:53], s[50:51]
    s_or_b64 s[80:81], s[80:81], s[52:53]
    s_not_b64 vcc, s[52:53]
    s_mov_b64 exec, -1
    v_cndmask_b32_dpp v84, v84, v84, vcc wave_shr:1 row_mask:0xf bank_mask:0xf
    v_cndmask_b32_dpp v85, v85, v85, vcc wave_shr:1 row_mask:0xf bank_mask:0xf
    s_lshr_b64 s[52:53], s[52:53], 1
    v_cndmask_b32_dpp v86, v86, v86, vcc wave_shr:1 row_mask:0xf bank_mask:0xf
    v_cndmask_b32_dpp v87, v87, v87, vcc wave_shr:1 row_mask:0xf bank_mask:0xf
    s_andn2_b64 s[82:83], s[82:83], s[52:53]
    v_cndmask_b32_dpp v7, v7, v7, vcc wave_shr:1 row_mask:0xf bank_mask:0xf
    s_mov_b64 exec, s[50:51]
    s_cbranch_scc0 L2_d103
    s_mov_b64 exec, s[82:83]
    s_nop 1
    v_mfma_f32_4x4x4_16b_bf16 v[88:91], v[12:13], v[84:85], 0
    s_nop 1
    v_mfma_f32_4x4x4_16b_bf16 v[88:91], v[10:11], v[86:87], v[88:91]
    s_nop 4
    v_cvt_pk_bf16_f32 v88, v88, v89
    v_cvt_pk_bf16_f32 v89, v90, v91
    ds_pk_add_bf16 v7, v88 offset:65408
    ds_pk_add_bf16 v7, v89 offset:65412
    s_mov_b64 exec, s[50:51]
    s_branch L2_d103
L2_xo104:
    v_cmp_lt_u32 vcc, 20, v99
    s_mov_b32 s101, 1
    s_cbranch_vccz L2_xp104
    v_cmp_lt_u32 vcc, 32, v99
    v_cmp_lt_u32 s[58:59], 31, v88
    s_mov_b32 s101, 2
    s_or_b64 vcc, vcc, s[58:59]
    s_cbranch_scc0 L2_xp104
    s_mov_b32 s37, 0x10000
    s_branch L2_xp104
L2_c105:
    s_lshl_b64 s[52:53], s[82:83], 1
    s_andn2_b64 s[52:53], s[52:53], s[80:81]
    s_andn2_b64 s[52:53], s[52:53], s[54:55]
    s_or_b64 s[80:81], s[80:81], s[52:53]
    s_not_b64 vcc, s[52:53]
    s_mov_b64 exec, -1
    v_cndmask_b32_dpp v84, v84, v84, vcc wave_shr:1 row_mask:0xf bank_mask:0xf
    v_cndmask_b32_dpp v85, v85, v85, vcc wave_shr:1 row_mask:0xf bank_mask:0xf
    s_lshr_b64 s[52:53], s[52:53], 1
    v_cndmask_b32_dpp v86, v86, v86, vcc wave_shr:1 row_mask:0xf bank_mask:0xf
    v_cndmask_b32_dpp v87, v87, v87, vcc wave_shr:1 row_mask:0xf bank_mask:0xf
    s_andn2_b64 s[82:83], s[82:83], s[52:53]
    v_cndmask_b32_dpp v7, v7, v7, vcc wave_shr:1 row_mask:0xf bank_mask:0xf
    s_mov_b64 exec, s[54:55]
    s_cbranch_scc0 L2_d105
    s_mov_b64 exec, s[82:83]
    s_nop 1
    v_mfma_f32_4x4x4_16b_bf16 v[88:91], v[12:13], v[84:85], 0
    s_nop 1
    v_mfma_f32_4x4x4_16b_bf16 v[88:91], v[10:11], v[86:87], v[88:91]
    s_nop 4
    v_cvt_pk_bf16_f32 v88, v88, v89
    v_cvt_pk_bf16_f32 v89, v90, v91
    ds_pk_add_bf16 v7, v88 offset:65408
    ds_pk_add_bf16 v7, v89 offset:65412
    s_mov_b64 exec, s[54:55]
    s_branch L2_d105
L2_c106:
    s_lshl_b64 s[52:53], s[82:83], 1
    s_andn2_b64 s[52:53], s[52:53], s[80:81]
    s_andn2_b64 s[52:53], s[52:53], s[50:51]
    s_or_b64 s[80:81], s[80:81], s[52:53]
    s_not_b64 vcc, s[52:53]
    s_mov_b64 exec, -1
    v_cndmask_b32_dpp v84, v84, v84, vcc wave_shr:1 row_mask:0xf bank_mask:0xf
    v_cndmask_b32_dpp v85, v85, v85, vcc wave_shr:1 row_mask:0xf bank_mask:0xf
    s_lshr_b64 s[52:53], s[52:53], 1
    v_cndmask_b32_dpp v86, v86, v86, vcc wave_shr:1 row_mask:0xf bank_mask:0xf
    v_cndmask_b32_dpp v87, v87, v87, vcc wave_shr:1 row_mask:0xf bank_mask:0xf
    s_andn2_b64 s[82:83], s[82:83], s[52:53]
    v_cndmask_b32_dpp v7, v7, v7, vcc wave_shr:1 row_mask:0xf bank_mask:0xf
    s_mov_b64 exec, s[50:51]
    s_cbranch_scc0 L2_d106
    s_mov_b64 exec, s[82:83]
    s_nop 1
    v_mfma_f32_4x4x4_16b_bf16 v[88:91], v[12:13], v[84:85], 0
    s_nop 1
    v_mfma_f32_4x4x4_16b_bf16 v[88:91], v[10:11], v[86:87], v[88:91]
    s_nop 4
    v_cvt_pk_bf16_f32 v88, v88, v89
    v_cvt_pk_bf16_f32 v89, v90, v91
    ds_pk_add_bf16 v7, v88 offset:65408
    ds_pk_add_bf16 v7, v89 offset:65412
    s_mov_b64 exec, s[50:51]
    s_branch L2_d106
L2_c107:
    s_lshl_b64 s[52:53], s[82:83], 1
    s_andn2_b64 s[52:53], s[52:53], s[80:81]
    s_andn2_b64 s[52:53], s[52:53], s[54:55]
    s_or_b64 s[80:81], s[80:81], s[52:53]
    s_not_b64 vcc, s[52:53]
    s_mov_b64 exec, -1
    v_cndmask_b32_dpp v84, v84, v84, vcc wave_shr:1 row_mask:0xf bank_mask:0xf
    v_cndmask_b32_dpp v85, v85, v85, vcc wave_shr:1 row_mask:0xf bank_mask:0xf
    s_lshr_b64 s[52:53], s[52:53], 1
    v_cndmask_b32_dpp v86, v86, v86, vcc wave_shr:1 row_mask:0xf bank_mask:0xf
    v_cndmask_b32_dpp v87, v87, v87, vcc wave_shr:1 row_mask:0xf bank_mask:0xf
    s_andn2_b64 s[82:83], s[82:83], s[52:53]
    v_cndmask_b32_dpp v7, v7, v7, vcc wave_shr:1 row_mask:0xf bank_mask:0xf
    s_mov_b64 exec, s[54:55]
    s_cbranch_scc0 L2_d107
    s_mov_b64 exec, s[82:83]
    s_nop 1
    v_mfma_f32_4x4x4_16b_bf16 v[88:91], v[12:13], v[84:85], 0
    s_nop 1
    v_mfma_f32_4x4x4_16b_bf16 v[88:91], v[10:11], v[86:87], v[88:91]
    s_nop 4
    v_cvt_pk_bf16_f32 v88, v88, v89
    v_cvt_pk_bf16_f32 v89, v90, v91
    ds_pk_add_bf16 v7, v88 offset:65408
    ds_pk_add_bf16 v7, v89 offset:65412
    s_mov_b64 exec, s[54:55]
    s_branch L2_d107
L2_c108:
    s_lshl_b64 s[52:53], s[82:83], 1
    s_andn2_b64 s[52:53], s[52:53], s[80:81]
    s_andn2_b64 s[52:53], s[52:53], s[50:51]
    s_or_b64 s[80:81], s[80:81], s[52:53]
    s_not_b64 vcc, s[52:53]
    s_mov_b64 exec, -1
    v_cndmask_b32_dpp v84, v84, v84, vcc wave_shr:1 row_mask:0xf bank_mask:0xf
    v_cndmask_b32_dpp v85, v85, v85, vcc wave_shr:1 row_mask:0xf bank_mask:0xf
    s_lshr_b64 s[52:53], s[52:53], 1
    v_cndmask_b32_dpp v86, v86, v86, vcc wave_shr:1 row_mask:0xf bank_mask:0xf
    v_cndmask_b32_dpp v87, v87, v87, vcc wave_shr:1 row_mask:0xf bank_mask:0xf
    s_andn2_b64 s[82:83], s[82:83], s[52:53]
    v_cndmask_b32_dpp v7, v7, v7, vcc wave_shr:1 row_mask:0xf bank_mask:0xf
    s_mov_b64 exec, s[50:51]
    s_cbranch_scc0 L2_d108
    s_mov_b64 exec, s[82:83]
    s_nop 1
    v_mfma_f32_4x4x4_16b_bf16 v[88:91], v[12:13], v[84:85], 0
    s_nop 1
    v_mfma_f32_4x4x4_16b_bf16 v[88:91], v[10:11], v[86:87], v[88:91]
    s_nop 4
    v_cvt_pk_bf16_f32 v88, v88, v89
    v_cvt_pk_bf16_f32 v89, v90, v91
    ds_pk_add_bf16 v7, v88 offset:65408
    ds_pk_add_bf16 v7, v89 offset:65412
    s_mov_b64 exec, s[50:51]
    s_branch L2_d108
L2_c109:
    s_lshl_b64 s[52:53], s[82:83], 1
    s_andn2_b64 s[52:53], s[52:53], s[80:81]
    s_andn2_b64 s[52:53], s[52:53], s[54:55]
    s_or_b64 s[80:81], s[80:81], s[52:53]
    s_not_b64 vcc, s[52:53]
    s_mov_b64 exec, -1
    v_cndmask_b32_dpp v84, v84, v84, vcc wave_shr:1 row_mask:0xf bank_mask:0xf
    v_cndmask_b32_dpp v85, v85, v85, vcc wave_shr:1 row_mask:0xf bank_mask:0xf
    s_lshr_b64 s[52:53], s[52:53], 1
    v_cndmask_b32_dpp v86, v86, v86, vcc wave_shr:1 row_mask:0xf bank_mask:0xf
    v_cndmask_b32_dpp v87, v87, v87, vcc wave_shr:1 row_mask:0xf bank_mask:0xf
    s_andn2_b64 s[82:83], s[82:83], s[52:53]
    v_cndmask_b32_dpp v7, v7, v7, vcc wave_shr:1 row_mask:0xf bank_mask:0xf
    s_mov_b64 exec, s[54:55]
    s_cbranch_scc0 L2_d109
    s_mov_b64 exec, s[82:83]
    s_nop 1
    v_mfma_f32_4x4x4_16b_bf16 v[88:91], v[12:13], v[84:85], 0
    s_nop 1
    v_mfma_f32_4x4x4_16b_bf16 v[88:91], v[10:11], v[86:87], v[88:91]
    s_nop 4
    v_cvt_pk_bf16_f32 v88, v88, v89
    v_cvt_pk_bf16_f32 v89, v90, v91
    ds_pk_add_bf16 v7, v88 offset:65408
    ds_pk_add_bf16 v7, v89 offset:65412
    s_mov_b64 exec, s[54:55]
    s_branch L2_d109
L2_c110:
    s_lshl_b64 s[52:53], s[82:83], 1
    s_andn2_b64 s[52:53], s[52:53], s[80:81]
    s_andn2_b64 s[52:53], s[52:53], s[50:51]
    s_or_b64 s[80:81], s[80:81], s[52:53]
    s_not_b64 vcc, s[52:53]
    s_mov_b64 exec, -1
    v_cndmask_b32_dpp v84, v84, v84, vcc wave_shr:1 row_mask:0xf bank_mask:0xf
    v_cndmask_b32_dpp v85, v85, v85, vcc wave_shr:1 row_mask:0xf bank_mask:0xf
    s_lshr_b64 s[52:53], s[52:53], 1
    v_cndmask_b32_dpp v86, v86, v86, vcc wave_shr:1 row_mask:0xf bank_mask:0xf
    v_cndmask_b32_dpp v87, v87, v87, vcc wave_shr:1 row_mask:0xf bank_mask:0xf
    s_andn2_b64 s[82:83], s[82:83], s[52:53]
    v_cndmask_b32_dpp v7, v7, v7, vcc wave_shr:1 row_mask:0xf bank_mask:0xf
    s_mov_b64 exec, s[50:51]
    s_cbranch_scc0 L2_d110
    s_mov_b64 exec, s[82:83]
    s_nop 1
    v_mfma_f32_4x4x4_16b_bf16 v[88:91], v[12:13], v[84:85], 0
    s_nop 1
    v_mfma_f32_4x4x4_16b_bf16 v[88:91], v[10:11], v[86:87], v[88:91]
    s_nop 4
    v_cvt_pk_bf16_f32 v88, v88, v89
    v_cvt_pk_bf16_f32 v89, v90, v91
    ds_pk_add_bf16 v7, v88 offset:65408
    ds_pk_add_bf16 v7, v89 offset:65412
    s_mov_b64 exec, s[50:51]
    s_branch L2_d110
L2_c111:
    s_lshl_b64 s[52:53], s[82:83], 1
    s_andn2_b64 s[52:53], s[52:53], s[80:81]
    s_andn2_b64 s[52:53], s[52:53], s[54:55]
    s_or_b64 s[80:81], s[80:81], s[52:53]
    s_not_b64 vcc, s[52:53]
    s_mov_b64 exec, -1
    v_cndmask_b32_dpp v84, v84, v84, vcc wave_shr:1 row_mask:0xf bank_mask:0xf
    v_cndmask_b32_dpp v85, v85, v85, vcc wave_shr:1 row_mask:0xf bank_mask:0xf
    s_lshr_b64 s[52:53], s[52:53], 1
    v_cndmask_b32_dpp v86, v86, v86, vcc wave_shr:1 row_mask:0xf bank_mask:0xf
    v_cndmask_b32_dpp v87, v87, v87, vcc wave_shr:1 row_mask:0xf bank_mask:0xf
    s_andn2_b64 s[82:83], s[82:83], s[52:53]
    v_cndmask_b32_dpp v7, v7, v7, vcc wave_shr:1 row_mask:0xf bank_mask:0xf
    s_mov_b64 exec, s[54:55]
    s_cbranch_scc0 L2_d111
    s_mov_b64 exec, s[82:83]
    s_nop 1
    v_mfma_f32_4x4x4_16b_bf16 v[88:91], v[12:13], v[84:85], 0
    s_nop 1
    v_mfma_f32_4x4x4_16b_bf16 v[88:91], v[10:11], v[86:87], v[88:91]
    s_nop 4
    v_cvt_pk_bf16_f32 v88, v88, v89
    v_cvt_pk_bf16_f32 v89, v90, v91
    ds_pk_add_bf16 v7, v88 offset:65408
    ds_pk_add_bf16 v7, v89 offset:65412
    s_mov_b64 exec, s[54:55]
    s_branch L2_d111
L2_c112:
    s_lshl_b64 s[52:53], s[82:83], 1
    s_andn2_b64 s[52:53], s[52:53], s[80:81]
    s_andn2_b64 s[52:53], s[52:53], s[50:51]
    s_or_b64 s[80:81], s[80:81], s[52:53]
    s_not_b64 vcc, s[52:53]
    s_mov_b64 exec, -1
    v_cndmask_b32_dpp v84, v84, v84, vcc wave_shr:1 row_mask:0xf bank_mask:0xf
    v_cndmask_b32_dpp v85, v85, v85, vcc wave_shr:1 row_mask:0xf bank_mask:0xf
    s_lshr_b64 s[52:53], s[52:53], 1
    v_cndmask_b32_dpp v86, v86, v86, vcc wave_shr:1 row_mask:0xf bank_mask:0xf
    v_cndmask_b32_dpp v87, v87, v87, vcc wave_shr:1 row_mask:0xf bank_mask:0xf
    s_andn2_b64 s[82:83], s[82:83], s[52:53]
    v_cndmask_b32_dpp v7, v7, v7, vcc wave_shr:1 row_mask:0xf bank_mask:0xf
    s_mov_b64 exec, s[50:51]
    s_cbranch_scc0 L2_d112
    s_mov_b64 exec, s[82:83]
    s_nop 1
    v_mfma_f32_4x4x4_16b_bf16 v[88:91], v[12:13], v[84:85], 0
    s_nop 1
    v_mfma_f32_4x4x4_16b_bf16 v[88:91], v[10:11], v[86:87], v[88:91]
    s_nop 4
    v_cvt_pk_bf16_f32 v88, v88, v89
    v_cvt_pk_bf16_f32 v89, v90, v91
    ds_pk_add_bf16 v7, v88 offset:65408
    ds_pk_add_bf16 v7, v89 offset:65412
    s_mov_b64 exec, s[50:51]
    s_branch L2_d112
L2_c113:
    s_lshl_b64 s[52:53], s[82:83], 1
    s_andn2_b64 s[52:53], s[52:53], s[80:81]
    s_andn2_b64 s[52:53], s[52:53], s[54:55]
    s_or_b64 s[80:81], s[80:81], s[52:53]
    s_not_b64 vcc, s[52:53]
    s_mov_b64 exec, -1
    v_cndmask_b32_dpp v84, v84, v84, vcc wave_shr:1 row_mask:0xf bank_mask:0xf
    v_cndmask_b32_dpp v85, v85, v85, vcc wave_shr:1 row_mask:0xf bank_mask:0xf
    s_lshr_b64 s[52:53], s[52:53], 1
    v_cndmask_b32_dpp v86, v86, v86, vcc wave_shr:1 row_mask:0xf bank_mask:0xf
    v_cndmask_b32_dpp v87, v87, v87, vcc wave_shr:1 row_mask:0xf bank_mask:0xf
    s_andn2_b64 s[82:83], s[82:83], s[52:53]
    v_cndmask_b32_dpp v7, v7, v7, vcc wave_shr:1 row_mask:0xf bank_mask:0xf
    s_mov_b64 exec, s[54:55]
    s_cbranch_scc0 L2_d113
    s_mov_b64 exec, s[82:83]
    s_nop 1
    v_mfma_f32_4x4x4_16b_bf16 v[88:91], v[12:13], v[84:85], 0
    s_nop 1
    v_mfma_f32_4x4x4_16b_bf16 v[88:91], v[10:11], v[86:87], v[88:91]
    s_nop 4
    v_cvt_pk_bf16_f32 v88, v88, v89
    v_cvt_pk_bf16_f32 v89, v90, v91
    ds_pk_add_bf16 v7, v88 offset:65408
    ds_pk_add_bf16 v7, v89 offset:65412
    s_mov_b64 exec, s[54:55]
    s_branch L2_d113
L2_c114:
    s_lshl_b64 s[52:53], s[82:83], 1
    s_andn2_b64 s[52:53], s[52:53], s[80:81]
    s_andn2_b64 s[52:53], s[52:53], s[50:51]
    s_or_b64 s[80:81], s[80:81], s[52:53]
    s_not_b64 vcc, s[52:53]
    s_mov_b64 exec, -1
    v_cndmask_b32_dpp v84, v84, v84, vcc wave_shr:1 row_mask:0xf bank_mask:0xf
    v_cndmask_b32_dpp v85, v85, v85, vcc wave_shr:1 row_mask:0xf bank_mask:0xf
    s_lshr_b64 s[52:53], s[52:53], 1
    v_cndmask_b32_dpp v86, v86, v86, vcc wave_shr:1 row_mask:0xf bank_mask:0xf
    v_cndmask_b32_dpp v87, v87, v87, vcc wave_shr:1 row_mask:0xf bank_mask:0xf
    s_andn2_b64 s[82:83], s[82:83], s[52:53]
    v_cndmask_b32_dpp v7, v7, v7, vcc wave_shr:1 row_mask:0xf bank_mask:0xf
    s_mov_b64 exec, s[50:51]
    s_cbranch_scc0 L2_d114
    s_mov_b64 exec, s[82:83]
    s_nop 1
    v_mfma_f32_4x4x4_16b_bf16 v[88:91], v[12:13], v[84:85], 0
    s_nop 1
    v_mfma_f32_4x4x4_16b_bf16 v[88:91], v[10:11], v[86:87], v[88:91]
    s_nop 4
    v_cvt_pk_bf16_f32 v88, v88, v89
    v_cvt_pk_bf16_f32 v89, v90, v91
    ds_pk_add_bf16 v7, v88 offset:65408
    ds_pk_add_bf16 v7, v89 offset:65412
    s_mov_b64 exec, s[50:51]
    s_branch L2_d114
L2_xa115:
    s_cmp_eq_u32 s101, 1
    s_cbranch_scc1 L2_xc115
    v_lshlrev_b32 v89, 0, v96
    v_add_u32 v90, 140, v97
    v_bitop3_b32 v90, v89, v45, v90 bitop3:0x6a
    ds_write_b32 v98, v90 offset:28
    v_lshlrev_b32 v89, 4, v96
    v_add_u32 v90, 120, v97
    v_bitop3_b32 v90, v89, v45, v90 bitop3:0x6a
    ds_write_b32 v98, v90 offset:24
    v_lshlrev_b32 v89, 8, v96
    v_add_u32 v90, 100, v97
    v_bitop3_b32 v90, v89, v45, v90 bitop3:0x6a
    ds_write_b32 v98, v90 offset:20
L2_xc115:
    v_lshlrev_b32 v89, 12, v96
    v_add_u32 v90, 80, v97
    v_bitop3_b32 v90, v89, v45, v90 bitop3:0x6a
    ds_write_b32 v98, v90 offset:16
    s_branch L2_xb115
L2_xe115:
    v_cmp_lt_u32 vcc, 32, v99
    v_cmp_lt_u32 s[58:59], 31, v88
    v_lshrrev_b32 v89, 16, v96
    v_add_u32 v97, 80, v97
    s_or_b64 vcc, vcc, s[58:59]
    s_cbranch_scc1 L2_xs115
    v_lshlrev_b32 v89, v1, v89
    v_and_b32 v89, v45, v89
    v_cmp_ne_u32 vcc, 0, v89
    v_xor_b32 v90, v97, v89
    s_add_u32 s3, s37, s38
    v_mbcnt_lo_u32_b32 v98, vcc_lo, 0
    v_mbcnt_hi_u32_b32 v98, vcc_hi, v98
    s_bcnt1_i32_b64 s41, vcc
    v_lshl_add_u32 v98, v98, 2, s3
    s_mov_b64 exec, vcc
    ds_write_b32 v98, v90
    s_mov_b64 exec, -1
    s_lshl2_add_u32 s37, s41, s37
    s_branch L2_xr115
L2_xf115:
    s_waitcnt lgkmcnt(0)
    s_cmp_gt_u32 s37, 1024
    s_cbranch_scc1 L2_xs115
    v_mov_b32 v43, -1
    s_cmp_ge_u32 s37, 512
    s_cbranch_scc1 L2_xg115
    v_mov_b32 v42, -1
    s_cmp_ge_u32 s37, 256
    s_cbranch_scc1 L2_xg115
    v_mov_b32 v41, -1
    s_branch L2_xg115
L2_xs115:
    s_waitcnt lgkmcnt(0)
    v_mov_b32 v40, -1
    v_mov_b32 v41, -1
    v_mov_b32 v42, -1
    v_mov_b32 v43, -1
    s_add_u32 s3, s42, 2
    s_bitset1_b32 s36, s3
    s_branch L2_xg115
L2_c116:
    s_lshl_b64 s[52:53], s[82:83], 1
    s_andn2_b64 s[52:53], s[52:53], s[80:81]
    s_andn2_b64 s[52:53], s[52:53], s[54:55]
    s_or_b64 s[80:81], s[80:81], s[52:53]
    s_not_b64 vcc, s[52:53]
    s_mov_b64 exec, -1
    v_cndmask_b32_dpp v84, v84, v84, vcc wave_shr:1 row_mask:0xf bank_mask:0xf
    v_cndmask_b32_dpp v85, v85, v85, vcc wave_shr:1 row_mask:0xf bank_mask:0xf
    s_lshr_b64 s[52:53], s[52:53], 1
    v_cndmask_b32_dpp v86, v86, v86, vcc wave_shr:1 row_mask:0xf bank_mask:0xf
    v_cndmask_b32_dpp v87, v87, v87, vcc wave_shr:1 row_mask:0xf bank_mask:0xf
    s_andn2_b64 s[82:83], s[82:83], s[52:53]
    v_cndmask_b32_dpp v7, v7, v7, vcc wave_shr:1 row_mask:0xf bank_mask:0xf
    s_mov_b64 exec, s[54:55]
    s_cbranch_scc0 L2_d116
    s_mov_b64 exec, s[82:83]
    s_nop 1
    v_mfma_f32_4x4x4_16b_bf16 v[88:91], v[12:13], v[84:85], 0
    s_nop 1
    v_mfma_f32_4x4x4_16b_bf16 v[88:91], v[10:11], v[86:87], v[88:91]
    s_nop 4
    v_cvt_pk_bf16_f32 v88, v88, v89
    v_cvt_pk_bf16_f32 v89, v90, v91
    ds_pk_add_bf16 v7, v88 offset:65408
    ds_pk_add_bf16 v7, v89 offset:65412
    s_mov_b64 exec, s[54:55]
    s_branch L2_d116
L2_c117:
    s_lshl_b64 s[52:53], s[82:83], 1
    s_andn2_b64 s[52:53], s[52:53], s[80:81]
    s_andn2_b64 s[52:53], s[52:53], s[50:51]
    s_or_b64 s[80:81], s[80:81], s[52:53]
    s_not_b64 vcc, s[52:53]
    s_mov_b64 exec, -1
    v_cndmask_b32_dpp v84, v84, v84, vcc wave_shr:1 row_mask:0xf bank_mask:0xf
    v_cndmask_b32_dpp v85, v85, v85, vcc wave_shr:1 row_mask:0xf bank_mask:0xf
    s_lshr_b64 s[52:53], s[52:53], 1
    v_cndmask_b32_dpp v86, v86, v86, vcc wave_shr:1 row_mask:0xf bank_mask:0xf
    v_cndmask_b32_dpp v87, v87, v87, vcc wave_shr:1 row_mask:0xf bank_mask:0xf
    s_andn2_b64 s[82:83], s[82:83], s[52:53]
    v_cndmask_b32_dpp v7, v7, v7, vcc wave_shr:1 row_mask:0xf bank_mask:0xf
    s_mov_b64 exec, s[50:51]
    s_cbranch_scc0 L2_d117
    s_mov_b64 exec, s[82:83]
    s_nop 1
    v_mfma_f32_4x4x4_16b_bf16 v[88:91], v[12:13], v[84:85], 0
    s_nop 1
    v_mfma_f32_4x4x4_16b_bf16 v[88:91], v[10:11], v[86:87], v[88:91]
    s_nop 4
    v_cvt_pk_bf16_f32 v88, v88, v89
    v_cvt_pk_bf16_f32 v89, v90, v91
    ds_pk_add_bf16 v7, v88 offset:65408
    ds_pk_add_bf16 v7, v89 offset:65412
    s_mov_b64 exec, s[50:51]
    s_branch L2_d117
L2_c118:
    s_lshl_b64 s[52:53], s[82:83], 1
    s_andn2_b64 s[52:53], s[52:53], s[80:81]
    s_andn2_b64 s[52:53], s[52:53], s[54:55]
    s_or_b64 s[80:81], s[80:81], s[52:53]
    s_not_b64 vcc, s[52:53]
    s_mov_b64 exec, -1
    v_cndmask_b32_dpp v84, v84, v84, vcc wave_shr:1 row_mask:0xf bank_mask:0xf
    v_cndmask_b32_dpp v85, v85, v85, vcc wave_shr:1 row_mask:0xf bank_mask:0xf
    s_lshr_b64 s[52:53], s[52:53], 1
    v_cndmask_b32_dpp v86, v86, v86, vcc wave_shr:1 row_mask:0xf bank_mask:0xf
    v_cndmask_b32_dpp v87, v87, v87, vcc wave_shr:1 row_mask:0xf bank_mask:0xf
    s_andn2_b64 s[82:83], s[82:83], s[52:53]
    v_cndmask_b32_dpp v7, v7, v7, vcc wave_shr:1 row_mask:0xf bank_mask:0xf
    s_mov_b64 exec, s[54:55]
    s_cbranch_scc0 L2_d118
    s_mov_b64 exec, s[82:83]
    s_nop 1
    v_mfma_f32_4x4x4_16b_bf16 v[88:91], v[12:13], v[84:85], 0
    s_nop 1
    v_mfma_f32_4x4x4_16b_bf16 v[88:91], v[10:11], v[86:87], v[88:91]
    s_nop 4
    v_cvt_pk_bf16_f32 v88, v88, v89
    v_cvt_pk_bf16_f32 v89, v90, v91
    ds_pk_add_bf16 v7, v88 offset:65408
    ds_pk_add_bf16 v7, v89 offset:65412
    s_mov_b64 exec, s[54:55]
    s_branch L2_d118
L2_c119:
    s_lshl_b64 s[52:53], s[82:83], 1
    s_andn2_b64 s[52:53], s[52:53], s[80:81]
    s_andn2_b64 s[52:53], s[52:53], s[50:51]
    s_or_b64 s[80:81], s[80:81], s[52:53]
    s_not_b64 vcc, s[52:53]
    s_mov_b64 exec, -1
    v_cndmask_b32_dpp v84, v84, v84, vcc wave_shr:1 row_mask:0xf bank_mask:0xf
    v_cndmask_b32_dpp v85, v85, v85, vcc wave_shr:1 row_mask:0xf bank_mask:0xf
    s_lshr_b64 s[52:53], s[52:53], 1
    v_cndmask_b32_dpp v86, v86, v86, vcc wave_shr:1 row_mask:0xf bank_mask:0xf
    v_cndmask_b32_dpp v87, v87, v87, vcc wave_shr:1 row_mask:0xf bank_mask:0xf
    s_andn2_b64 s[82:83], s[82:83], s[52:53]
    v_cndmask_b32_dpp v7, v7, v7, vcc wave_shr:1 row_mask:0xf bank_mask:0xf
    s_mov_b64 exec, s[50:51]
    s_cbranch_scc0 L2_d119
    s_mov_b64 exec, s[82:83]
    s_nop 1
    v_mfma_f32_4x4x4_16b_bf16 v[88:91], v[12:13], v[84:85], 0
    s_nop 1
    v_mfma_f32_4x4x4_16b_bf16 v[88:91], v[10:11], v[86:87], v[88:91]
    s_nop 4
    v_cvt_pk_bf16_f32 v88, v88, v89
    v_cvt_pk_bf16_f32 v89, v90, v91
    ds_pk_add_bf16 v7, v88 offset:65408
    ds_pk_add_bf16 v7, v89 offset:65412
    s_mov_b64 exec, s[50:51]
    s_branch L2_d119
L2_c120:
    s_lshl_b64 s[52:53], s[82:83], 1
    s_andn2_b64 s[52:53], s[52:53], s[80:81]
    s_andn2_b64 s[52:53], s[52:53], s[54:55]
    s_or_b64 s[80:81], s[80:81], s[52:53]
    s_not_b64 vcc, s[52:53]
    s_mov_b64 exec, -1
    v_cndmask_b32_dpp v84, v84, v84, vcc wave_shr:1 row_mask:0xf bank_mask:0xf
    v_cndmask_b32_dpp v85, v85, v85, vcc wave_shr:1 row_mask:0xf bank_mask:0xf
    s_lshr_b64 s[52:53], s[52:53], 1
    v_cndmask_b32_dpp v86, v86, v86, vcc wave_shr:1 row_mask:0xf bank_mask:0xf
    v_cndmask_b32_dpp v87, v87, v87, vcc wave_shr:1 row_mask:0xf bank_mask:0xf
    s_andn2_b64 s[82:83], s[82:83], s[52:53]
    v_cndmask_b32_dpp v7, v7, v7, vcc wave_shr:1 row_mask:0xf bank_mask:0xf
    s_mov_b64 exec, s[54:55]
    s_cbranch_scc0 L2_d120
    s_mov_b64 exec, s[82:83]
    s_nop 1
    v_mfma_f32_4x4x4_16b_bf16 v[88:91], v[12:13], v[84:85], 0
    s_nop 1
    v_mfma_f32_4x4x4_16b_bf16 v[88:91], v[10:11], v[86:87], v[88:91]
    s_nop 4
    v_cvt_pk_bf16_f32 v88, v88, v89
    v_cvt_pk_bf16_f32 v89, v90, v91
    ds_pk_add_bf16 v7, v88 offset:65408
    ds_pk_add_bf16 v7, v89 offset:65412
    s_mov_b64 exec, s[54:55]
    s_branch L2_d120
L2_c121:
    s_lshl_b64 s[52:53], s[82:83], 1
    s_andn2_b64 s[52:53], s[52:53], s[80:81]
    s_andn2_b64 s[52:53], s[52:53], s[50:51]
    s_or_b64 s[80:81], s[80:81], s[52:53]
    s_not_b64 vcc, s[52:53]
    s_mov_b64 exec, -1
    v_cndmask_b32_dpp v84, v84, v84, vcc wave_shr:1 row_mask:0xf bank_mask:0xf
    v_cndmask_b32_dpp v85, v85, v85, vcc wave_shr:1 row_mask:0xf bank_mask:0xf
    s_lshr_b64 s[52:53], s[52:53], 1
    v_cndmask_b32_dpp v86, v86, v86, vcc wave_shr:1 row_mask:0xf bank_mask:0xf
    v_cndmask_b32_dpp v87, v87, v87, vcc wave_shr:1 row_mask:0xf bank_mask:0xf
    s_andn2_b64 s[82:83], s[82:83], s[52:53]
    v_cndmask_b32_dpp v7, v7, v7, vcc wave_shr:1 row_mask:0xf bank_mask:0xf
    s_mov_b64 exec, s[50:51]
    s_cbranch_scc0 L2_d121
    s_mov_b64 exec, s[82:83]
    s_nop 1
    v_mfma_f32_4x4x4_16b_bf16 v[88:91], v[12:13], v[84:85], 0
    s_nop 1
    v_mfma_f32_4x4x4_16b_bf16 v[88:91], v[10:11], v[86:87], v[88:91]
    s_nop 4
    v_cvt_pk_bf16_f32 v88, v88, v89
    v_cvt_pk_bf16_f32 v89, v90, v91
    ds_pk_add_bf16 v7, v88 offset:65408
    ds_pk_add_bf16 v7, v89 offset:65412
    s_mov_b64 exec, s[50:51]
    s_branch L2_d121
L2_c122:
    s_lshl_b64 s[52:53], s[82:83], 1
    s_andn2_b64 s[52:53], s[52:53], s[80:81]
    s_andn2_b64 s[52:53], s[52:53], s[54:55]
    s_or_b64 s[80:81], s[80:81], s[52:53]
    s_not_b64 vcc, s[52:53]
    s_mov_b64 exec, -1
    v_cndmask_b32_dpp v84, v84, v84, vcc wave_shr:1 row_mask:0xf bank_mask:0xf
    v_cndmask_b32_dpp v85, v85, v85, vcc wave_shr:1 row_mask:0xf bank_mask:0xf
    s_lshr_b64 s[52:53], s[52:53], 1
    v_cndmask_b32_dpp v86, v86, v86, vcc wave_shr:1 row_mask:0xf bank_mask:0xf
    v_cndmask_b32_dpp v87, v87, v87, vcc wave_shr:1 row_mask:0xf bank_mask:0xf
    s_andn2_b64 s[82:83], s[82:83], s[52:53]
    v_cndmask_b32_dpp v7, v7, v7, vcc wave_shr:1 row_mask:0xf bank_mask:0xf
    s_mov_b64 exec, s[54:55]
    s_cbranch_scc0 L2_d122
    s_mov_b64 exec, s[82:83]
    s_nop 1
    v_mfma_f32_4x4x4_16b_bf16 v[88:91], v[12:13], v[84:85], 0
    s_nop 1
    v_mfma_f32_4x4x4_16b_bf16 v[88:91], v[10:11], v[86:87], v[88:91]
    s_nop 4
    v_cvt_pk_bf16_f32 v88, v88, v89
    v_cvt_pk_bf16_f32 v89, v90, v91
    ds_pk_add_bf16 v7, v88 offset:65408
    ds_pk_add_bf16 v7, v89 offset:65412
    s_mov_b64 exec, s[54:55]
    s_branch L2_d122
L2_c123:
    s_lshl_b64 s[52:53], s[82:83], 1
    s_andn2_b64 s[52:53], s[52:53], s[80:81]
    s_andn2_b64 s[52:53], s[52:53], s[50:51]
    s_or_b64 s[80:81], s[80:81], s[52:53]
    s_not_b64 vcc, s[52:53]
    s_mov_b64 exec, -1
    v_cndmask_b32_dpp v84, v84, v84, vcc wave_shr:1 row_mask:0xf bank_mask:0xf
    v_cndmask_b32_dpp v85, v85, v85, vcc wave_shr:1 row_mask:0xf bank_mask:0xf
    s_lshr_b64 s[52:53], s[52:53], 1
    v_cndmask_b32_dpp v86, v86, v86, vcc wave_shr:1 row_mask:0xf bank_mask:0xf
    v_cndmask_b32_dpp v87, v87, v87, vcc wave_shr:1 row_mask:0xf bank_mask:0xf
    s_andn2_b64 s[82:83], s[82:83], s[52:53]
    v_cndmask_b32_dpp v7, v7, v7, vcc wave_shr:1 row_mask:0xf bank_mask:0xf
    s_mov_b64 exec, s[50:51]
    s_cbranch_scc0 L2_d123
    s_mov_b64 exec, s[82:83]
    s_nop 1
    v_mfma_f32_4x4x4_16b_bf16 v[88:91], v[12:13], v[84:85], 0
    s_nop 1
    v_mfma_f32_4x4x4_16b_bf16 v[88:91], v[10:11], v[86:87], v[88:91]
    s_nop 4
    v_cvt_pk_bf16_f32 v88, v88, v89
    v_cvt_pk_bf16_f32 v89, v90, v91
    ds_pk_add_bf16 v7, v88 offset:65408
    ds_pk_add_bf16 v7, v89 offset:65412
    s_mov_b64 exec, s[50:51]
    s_branch L2_d123
L2_c124:
    s_lshl_b64 s[52:53], s[82:83], 1
    s_andn2_b64 s[52:53], s[52:53], s[80:81]
    s_andn2_b64 s[52:53], s[52:53], s[54:55]
    s_or_b64 s[80:81], s[80:81], s[52:53]
    s_not_b64 vcc, s[52:53]
    s_mov_b64 exec, -1
    v_cndmask_b32_dpp v84, v84, v84, vcc wave_shr:1 row_mask:0xf bank_mask:0xf
    v_cndmask_b32_dpp v85, v85, v85, vcc wave_shr:1 row_mask:0xf bank_mask:0xf
    s_lshr_b64 s[52:53], s[52:53], 1
    v_cndmask_b32_dpp v86, v86, v86, vcc wave_shr:1 row_mask:0xf bank_mask:0xf
    v_cndmask_b32_dpp v87, v87, v87, vcc wave_shr:1 row_mask:0xf bank_mask:0xf
    s_andn2_b64 s[82:83], s[82:83], s[52:53]
    v_cndmask_b32_dpp v7, v7, v7, vcc wave_shr:1 row_mask:0xf bank_mask:0xf
    s_mov_b64 exec, s[54:55]
    s_cbranch_scc0 L2_d124
    s_mov_b64 exec, s[82:83]
    s_nop 1
    v_mfma_f32_4x4x4_16b_bf16 v[88:91], v[12:13], v[84:85], 0
    s_nop 1
    v_mfma_f32_4x4x4_16b_bf16 v[88:91], v[10:11], v[86:87], v[88:91]
    s_nop 4
    v_cvt_pk_bf16_f32 v88, v88, v89
    v_cvt_pk_bf16_f32 v89, v90, v91
    ds_pk_add_bf16 v7, v88 offset:65408
    ds_pk_add_bf16 v7, v89 offset:65412
    s_mov_b64 exec, s[54:55]
    s_branch L2_d124
L2_c125:
    s_lshl_b64 s[52:53], s[82:83], 1
    s_andn2_b64 s[52:53], s[52:53], s[80:81]
    s_andn2_b64 s[52:53], s[52:53], s[50:51]
    s_or_b64 s[80:81], s[80:81], s[52:53]
    s_not_b64 vcc, s[52:53]
    s_mov_b64 exec, -1
    v_cndmask_b32_dpp v84, v84, v84, vcc wave_shr:1 row_mask:0xf bank_mask:0xf
    v_cndmask_b32_dpp v85, v85, v85, vcc wave_shr:1 row_mask:0xf bank_mask:0xf
    s_lshr_b64 s[52:53], s[52:53], 1
    v_cndmask_b32_dpp v86, v86, v86, vcc wave_shr:1 row_mask:0xf bank_mask:0xf
    v_cndmask_b32_dpp v87, v87, v87, vcc wave_shr:1 row_mask:0xf bank_mask:0xf
    s_andn2_b64 s[82:83], s[82:83], s[52:53]
    v_cndmask_b32_dpp v7, v7, v7, vcc wave_shr:1 row_mask:0xf bank_mask:0xf
    s_mov_b64 exec, s[50:51]
    s_cbranch_scc0 L2_d125
    s_mov_b64 exec, s[82:83]
    s_nop 1
    v_mfma_f32_4x4x4_16b_bf16 v[88:91], v[12:13], v[84:85], 0
    s_nop 1
    v_mfma_f32_4x4x4_16b_bf16 v[88:91], v[10:11], v[86:87], v[88:91]
    s_nop 4
    v_cvt_pk_bf16_f32 v88, v88, v89
    v_cvt_pk_bf16_f32 v89, v90, v91
    ds_pk_add_bf16 v7, v88 offset:65408
    ds_pk_add_bf16 v7, v89 offset:65412
    s_mov_b64 exec, s[50:51]
    s_branch L2_d125
L2_c126:
    s_lshl_b64 s[52:53], s[82:83], 1
    s_andn2_b64 s[52:53], s[52:53], s[80:81]
    s_andn2_b64 s[52:53], s[52:53], s[54:55]
    s_or_b64 s[80:81], s[80:81], s[52:53]
    s_not_b64 vcc, s[52:53]
    s_mov_b64 exec, -1
    v_cndmask_b32_dpp v84, v84, v84, vcc wave_shr:1 row_mask:0xf bank_mask:0xf
    v_cndmask_b32_dpp v85, v85, v85, vcc wave_shr:1 row_mask:0xf bank_mask:0xf
    s_lshr_b64 s[52:53], s[52:53], 1
    v_cndmask_b32_dpp v86, v86, v86, vcc wave_shr:1 row_mask:0xf bank_mask:0xf
    v_cndmask_b32_dpp v87, v87, v87, vcc wave_shr:1 row_mask:0xf bank_mask:0xf
    s_andn2_b64 s[82:83], s[82:83], s[52:53]
    v_cndmask_b32_dpp v7, v7, v7, vcc wave_shr:1 row_mask:0xf bank_mask:0xf
    s_mov_b64 exec, s[54:55]
    s_cbranch_scc0 L2_d126
    s_mov_b64 exec, s[82:83]
    s_nop 1
    v_mfma_f32_4x4x4_16b_bf16 v[88:91], v[12:13], v[84:85], 0
    s_nop 1
    v_mfma_f32_4x4x4_16b_bf16 v[88:91], v[10:11], v[86:87], v[88:91]
    s_nop 4
    v_cvt_pk_bf16_f32 v88, v88, v89
    v_cvt_pk_bf16_f32 v89, v90, v91
    ds_pk_add_bf16 v7, v88 offset:65408
    ds_pk_add_bf16 v7, v89 offset:65412
    s_mov_b64 exec, s[54:55]
    s_branch L2_d126
L2_c127:
    s_lshl_b64 s[52:53], s[82:83], 1
    s_andn2_b64 s[52:53], s[52:53], s[80:81]
    s_andn2_b64 s[52:53], s[52:53], s[50:51]
    s_or_b64 s[80:81], s[80:81], s[52:53]
    s_not_b64 vcc, s[52:53]
    s_mov_b64 exec, -1
    v_cndmask_b32_dpp v84, v84, v84, vcc wave_shr:1 row_mask:0xf bank_mask:0xf
    v_cndmask_b32_dpp v85, v85, v85, vcc wave_shr:1 row_mask:0xf bank_mask:0xf
    s_lshr_b64 s[52:53], s[52:53], 1
    v_cndmask_b32_dpp v86, v86, v86, vcc wave_shr:1 row_mask:0xf bank_mask:0xf
    v_cndmask_b32_dpp v87, v87, v87, vcc wave_shr:1 row_mask:0xf bank_mask:0xf
    s_andn2_b64 s[82:83], s[82:83], s[52:53]
    v_cndmask_b32_dpp v7, v7, v7, vcc wave_shr:1 row_mask:0xf bank_mask:0xf
    s_mov_b64 exec, s[50:51]
    s_cbranch_scc0 L2_d127
    s_mov_b64 exec, s[82:83]
    s_nop 1
    v_mfma_f32_4x4x4_16b_bf16 v[88:91], v[12:13], v[84:85], 0
    s_nop 1
    v_mfma_f32_4x4x4_16b_bf16 v[88:91], v[10:11], v[86:87], v[88:91]
    s_nop 4
    v_cvt_pk_bf16_f32 v88, v88, v89
    v_cvt_pk_bf16_f32 v89, v90, v91
    ds_pk_add_bf16 v7, v88 offset:65408
    ds_pk_add_bf16 v7, v89 offset:65412
    s_mov_b64 exec, s[50:51]
    s_branch L2_d127
L2_c128:
    s_lshl_b64 s[52:53], s[82:83], 1
    s_andn2_b64 s[52:53], s[52:53], s[80:81]
    s_andn2_b64 s[52:53], s[52:53], s[54:55]
    s_or_b64 s[80:81], s[80:81], s[52:53]
    s_not_b64 vcc, s[52:53]
    s_mov_b64 exec, -1
    v_cndmask_b32_dpp v84, v84, v84, vcc wave_shr:1 row_mask:0xf bank_mask:0xf
    v_cndmask_b32_dpp v85, v85, v85, vcc wave_shr:1 row_mask:0xf bank_mask:0xf
    s_lshr_b64 s[52:53], s[52:53], 1
    v_cndmask_b32_dpp v86, v86, v86, vcc wave_shr:1 row_mask:0xf bank_mask:0xf
    v_cndmask_b32_dpp v87, v87, v87, vcc wave_shr:1 row_mask:0xf bank_mask:0xf
    s_andn2_b64 s[82:83], s[82:83], s[52:53]
    v_cndmask_b32_dpp v7, v7, v7, vcc wave_shr:1 row_mask:0xf bank_mask:0xf
    s_mov_b64 exec, s[54:55]
    s_cbranch_scc0 L2_d128
    s_mov_b64 exec, s[82:83]
    s_nop 1
    v_mfma_f32_4x4x4_16b_bf16 v[88:91], v[12:13], v[84:85], 0
    s_nop 1
    v_mfma_f32_4x4x4_16b_bf16 v[88:91], v[10:11], v[86:87], v[88:91]
    s_nop 4
    v_cvt_pk_bf16_f32 v88, v88, v89
    v_cvt_pk_bf16_f32 v89, v90, v91
    ds_pk_add_bf16 v7, v88 offset:65408
    ds_pk_add_bf16 v7, v89 offset:65412
    s_mov_b64 exec, s[54:55]
    s_branch L2_d128
L2_c129:
    s_lshl_b64 s[52:53], s[82:83], 1
    s_andn2_b64 s[52:53], s[52:53], s[80:81]
    s_andn2_b64 s[52:53], s[52:53], s[50:51]
    s_or_b64 s[80:81], s[80:81], s[52:53]
    s_not_b64 vcc, s[52:53]
    s_mov_b64 exec, -1
    v_cndmask_b32_dpp v84, v84, v84, vcc wave_shr:1 row_mask:0xf bank_mask:0xf
    v_cndmask_b32_dpp v85, v85, v85, vcc wave_shr:1 row_mask:0xf bank_mask:0xf
    s_lshr_b64 s[52:53], s[52:53], 1
    v_cndmask_b32_dpp v86, v86, v86, vcc wave_shr:1 row_mask:0xf bank_mask:0xf
    v_cndmask_b32_dpp v87, v87, v87, vcc wave_shr:1 row_mask:0xf bank_mask:0xf
    s_andn2_b64 s[82:83], s[82:83], s[52:53]
    v_cndmask_b32_dpp v7, v7, v7, vcc wave_shr:1 row_mask:0xf bank_mask:0xf
    s_mov_b64 exec, s[50:51]
    s_cbranch_scc0 L2_d129
    s_mov_b64 exec, s[82:83]
    s_nop 1
    v_mfma_f32_4x4x4_16b_bf16 v[88:91], v[12:13], v[84:85], 0
    s_nop 1
    v_mfma_f32_4x4x4_16b_bf16 v[88:91], v[10:11], v[86:87], v[88:91]
    s_nop 4
    v_cvt_pk_bf16_f32 v88, v88, v89
    v_cvt_pk_bf16_f32 v89, v90, v91
    ds_pk_add_bf16 v7, v88 offset:65408
    ds_pk_add_bf16 v7, v89 offset:65412
    s_mov_b64 exec, s[50:51]
    s_branch L2_d129
L2_c130:
    s_lshl_b64 s[52:53], s[82:83], 1
    s_andn2_b64 s[52:53], s[52:53], s[80:81]
    s_andn2_b64 s[52:53], s[52:53], s[54:55]
    s_or_b64 s[80:81], s[80:81], s[52:53]
    s_not_b64 vcc, s[52:53]
    s_mov_b64 exec, -1
    v_cndmask_b32_dpp v84, v84, v84, vcc wave_shr:1 row_mask:0xf bank_mask:0xf
    v_cndmask_b32_dpp v85, v85, v85, vcc wave_shr:1 row_mask:0xf bank_mask:0xf
    s_lshr_b64 s[52:53], s[52:53], 1
    v_cndmask_b32_dpp v86, v86, v86, vcc wave_shr:1 row_mask:0xf bank_mask:0xf
    v_cndmask_b32_dpp v87, v87, v87, vcc wave_shr:1 row_mask:0xf bank_mask:0xf
    s_andn2_b64 s[82:83], s[82:83], s[52:53]
    v_cndmask_b32_dpp v7, v7, v7, vcc wave_shr:1 row_mask:0xf bank_mask:0xf
    s_mov_b64 exec, s[54:55]
    s_cbranch_scc0 L2_d130
    s_mov_b64 exec, s[82:83]
    s_nop 1
    v_mfma_f32_4x4x4_16b_bf16 v[88:91], v[12:13], v[84:85], 0
    s_nop 1
    v_mfma_f32_4x4x4_16b_bf16 v[88:91], v[10:11], v[86:87], v[88:91]
    s_nop 4
    v_cvt_pk_bf16_f32 v88, v88, v89
    v_cvt_pk_bf16_f32 v89, v90, v91
    ds_pk_add_bf16 v7, v88 offset:65408
    ds_pk_add_bf16 v7, v89 offset:65412
    s_mov_b64 exec, s[54:55]
    s_branch L2_d130
L2_c131:
    s_lshl_b64 s[52:53], s[82:83], 1
    s_andn2_b64 s[52:53], s[52:53], s[80:81]
    s_andn2_b64 s[52:53], s[52:53], s[50:51]
    s_or_b64 s[80:81], s[80:81], s[52:53]
    s_not_b64 vcc, s[52:53]
    s_mov_b64 exec, -1
    v_cndmask_b32_dpp v84, v84, v84, vcc wave_shr:1 row_mask:0xf bank_mask:0xf
    v_cndmask_b32_dpp v85, v85, v85, vcc wave_shr:1 row_mask:0xf bank_mask:0xf
    s_lshr_b64 s[52:53], s[52:53], 1
    v_cndmask_b32_dpp v86, v86, v86, vcc wave_shr:1 row_mask:0xf bank_mask:0xf
    v_cndmask_b32_dpp v87, v87, v87, vcc wave_shr:1 row_mask:0xf bank_mask:0xf
    s_andn2_b64 s[82:83], s[82:83], s[52:53]
    v_cndmask_b32_dpp v7, v7, v7, vcc wave_shr:1 row_mask:0xf bank_mask:0xf
    s_mov_b64 exec, s[50:51]
    s_cbranch_scc0 L2_d131
    s_mov_b64 exec, s[82:83]
    s_nop 1
    v_mfma_f32_4x4x4_16b_bf16 v[88:91], v[12:13], v[84:85], 0
    s_nop 1
    v_mfma_f32_4x4x4_16b_bf16 v[88:91], v[10:11], v[86:87], v[88:91]
    s_nop 4
    v_cvt_pk_bf16_f32 v88, v88, v89
    v_cvt_pk_bf16_f32 v89, v90, v91
    ds_pk_add_bf16 v7, v88 offset:65408
    ds_pk_add_bf16 v7, v89 offset:65412
    s_mov_b64 exec, s[50:51]
    s_branch L2_d131
L2_c132:
    s_lshl_b64 s[52:53], s[82:83], 1
    s_andn2_b64 s[52:53], s[52:53], s[80:81]
    s_andn2_b64 s[52:53], s[52:53], s[54:55]
    s_or_b64 s[80:81], s[80:81], s[52:53]
    s_not_b64 vcc, s[52:53]
    s_mov_b64 exec, -1
    v_cndmask_b32_dpp v84, v84, v84, vcc wave_shr:1 row_mask:0xf bank_mask:0xf
    v_cndmask_b32_dpp v85, v85, v85, vcc wave_shr:1 row_mask:0xf bank_mask:0xf
    s_lshr_b64 s[52:53], s[52:53], 1
    v_cndmask_b32_dpp v86, v86, v86, vcc wave_shr:1 row_mask:0xf bank_mask:0xf
    v_cndmask_b32_dpp v87, v87, v87, vcc wave_shr:1 row_mask:0xf bank_mask:0xf
    s_andn2_b64 s[82:83], s[82:83], s[52:53]
    v_cndmask_b32_dpp v7, v7, v7, vcc wave_shr:1 row_mask:0xf bank_mask:0xf
    s_mov_b64 exec, s[54:55]
    s_cbranch_scc0 L2_d132
    s_mov_b64 exec, s[82:83]
    s_nop 1
    v_mfma_f32_4x4x4_16b_bf16 v[88:91], v[12:13], v[84:85], 0
    s_nop 1
    v_mfma_f32_4x4x4_16b_bf16 v[88:91], v[10:11], v[86:87], v[88:91]
    s_nop 4
    v_cvt_pk_bf16_f32 v88, v88, v89
    v_cvt_pk_bf16_f32 v89, v90, v91
    ds_pk_add_bf16 v7, v88 offset:65408
    ds_pk_add_bf16 v7, v89 offset:65412
    s_mov_b64 exec, s[54:55]
    s_branch L2_d132
L2_c133:
    s_lshl_b64 s[52:53], s[82:83], 1
    s_andn2_b64 s[52:53], s[52:53], s[80:81]
    s_andn2_b64 s[52:53], s[52:53], s[50:51]
    s_or_b64 s[80:81], s[80:81], s[52:53]
    s_not_b64 vcc, s[52:53]
    s_mov_b64 exec, -1
    v_cndmask_b32_dpp v84, v84, v84, vcc wave_shr:1 row_mask:0xf bank_mask:0xf
    v_cndmask_b32_dpp v85, v85, v85, vcc wave_shr:1 row_mask:0xf bank_mask:0xf
    s_lshr_b64 s[52:53], s[52:53], 1
    v_cndmask_b32_dpp v86, v86, v86, vcc wave_shr:1 row_mask:0xf bank_mask:0xf
    v_cndmask_b32_dpp v87, v87, v87, vcc wave_shr:1 row_mask:0xf bank_mask:0xf
    s_andn2_b64 s[82:83], s[82:83], s[52:53]
    v_cndmask_b32_dpp v7, v7, v7, vcc wave_shr:1 row_mask:0xf bank_mask:0xf
    s_mov_b64 exec, s[50:51]
    s_cbranch_scc0 L2_d133
    s_mov_b64 exec, s[82:83]
    s_nop 1
    v_mfma_f32_4x4x4_16b_bf16 v[88:91], v[12:13], v[84:85], 0
    s_nop 1
    v_mfma_f32_4x4x4_16b_bf16 v[88:91], v[10:11], v[86:87], v[88:91]
    s_nop 4
    v_cvt_pk_bf16_f32 v88, v88, v89
    v_cvt_pk_bf16_f32 v89, v90, v91
    ds_pk_add_bf16 v7, v88 offset:65408
    ds_pk_add_bf16 v7, v89 offset:65412
    s_mov_b64 exec, s[50:51]
    s_branch L2_d133
L2_c134:
    s_lshl_b64 s[52:53], s[82:83], 1
    s_andn2_b64 s[52:53], s[52:53], s[80:81]
    s_andn2_b64 s[52:53], s[52:53], s[54:55]
    s_or_b64 s[80:81], s[80:81], s[52:53]
    s_not_b64 vcc, s[52:53]
    s_mov_b64 exec, -1
    v_cndmask_b32_dpp v84, v84, v84, vcc wave_shr:1 row_mask:0xf bank_mask:0xf
    v_cndmask_b32_dpp v85, v85, v85, vcc wave_shr:1 row_mask:0xf bank_mask:0xf
    s_lshr_b64 s[52:53], s[52:53], 1
    v_cndmask_b32_dpp v86, v86, v86, vcc wave_shr:1 row_mask:0xf bank_mask:0xf
    v_cndmask_b32_dpp v87, v87, v87, vcc wave_shr:1 row_mask:0xf bank_mask:0xf
    s_andn2_b64 s[82:83], s[82:83], s[52:53]
    v_cndmask_b32_dpp v7, v7, v7, vcc wave_shr:1 row_mask:0xf bank_mask:0xf
    s_mov_b64 exec, s[54:55]
    s_cbranch_scc0 L2_d134
    s_mov_b64 exec, s[82:83]
    s_nop 1
    v_mfma_f32_4x4x4_16b_bf16 v[88:91], v[12:13], v[84:85], 0
    s_nop 1
    v_mfma_f32_4x4x4_16b_bf16 v[88:91], v[10:11], v[86:87], v[88:91]
    s_nop 4
    v_cvt_pk_bf16_f32 v88, v88, v89
    v_cvt_pk_bf16_f32 v89, v90, v91
    ds_pk_add_bf16 v7, v88 offset:65408
    ds_pk_add_bf16 v7, v89 offset:65412
    s_mov_b64 exec, s[54:55]
    s_branch L2_d134
L2_c135:
    s_lshl_b64 s[52:53], s[82:83], 1
    s_andn2_b64 s[52:53], s[52:53], s[80:81]
    s_andn2_b64 s[52:53], s[52:53], s[50:51]
    s_or_b64 s[80:81], s[80:81], s[52:53]
    s_not_b64 vcc, s[52:53]
    s_mov_b64 exec, -1
    v_cndmask_b32_dpp v84, v84, v84, vcc wave_shr:1 row_mask:0xf bank_mask:0xf
    v_cndmask_b32_dpp v85, v85, v85, vcc wave_shr:1 row_mask:0xf bank_mask:0xf
    s_lshr_b64 s[52:53], s[52:53], 1
    v_cndmask_b32_dpp v86, v86, v86, vcc wave_shr:1 row_mask:0xf bank_mask:0xf
    v_cndmask_b32_dpp v87, v87, v87, vcc wave_shr:1 row_mask:0xf bank_mask:0xf
    s_andn2_b64 s[82:83], s[82:83], s[52:53]
    v_cndmask_b32_dpp v7, v7, v7, vcc wave_shr:1 row_mask:0xf bank_mask:0xf
    s_mov_b64 exec, s[50:51]
    s_cbranch_scc0 L2_d135
    s_mov_b64 exec, s[82:83]
    s_nop 1
    v_mfma_f32_4x4x4_16b_bf16 v[88:91], v[12:13], v[84:85], 0
    s_nop 1
    v_mfma_f32_4x4x4_16b_bf16 v[88:91], v[10:11], v[86:87], v[88:91]
    s_nop 4
    v_cvt_pk_bf16_f32 v88, v88, v89
    v_cvt_pk_bf16_f32 v89, v90, v91
    ds_pk_add_bf16 v7, v88 offset:65408
    ds_pk_add_bf16 v7, v89 offset:65412
    s_mov_b64 exec, s[50:51]
    s_branch L2_d135
L2_c136:
    s_lshl_b64 s[52:53], s[82:83], 1
    s_andn2_b64 s[52:53], s[52:53], s[80:81]
    s_andn2_b64 s[52:53], s[52:53], s[54:55]
    s_or_b64 s[80:81], s[80:81], s[52:53]
    s_not_b64 vcc, s[52:53]
    s_mov_b64 exec, -1
    v_cndmask_b32_dpp v84, v84, v84, vcc wave_shr:1 row_mask:0xf bank_mask:0xf
    v_cndmask_b32_dpp v85, v85, v85, vcc wave_shr:1 row_mask:0xf bank_mask:0xf
    s_lshr_b64 s[52:53], s[52:53], 1
    v_cndmask_b32_dpp v86, v86, v86, vcc wave_shr:1 row_mask:0xf bank_mask:0xf
    v_cndmask_b32_dpp v87, v87, v87, vcc wave_shr:1 row_mask:0xf bank_mask:0xf
    s_andn2_b64 s[82:83], s[82:83], s[52:53]
    v_cndmask_b32_dpp v7, v7, v7, vcc wave_shr:1 row_mask:0xf bank_mask:0xf
    s_mov_b64 exec, s[54:55]
    s_cbranch_scc0 L2_d136
    s_mov_b64 exec, s[82:83]
    s_nop 1
    v_mfma_f32_4x4x4_16b_bf16 v[88:91], v[12:13], v[84:85], 0
    s_nop 1
    v_mfma_f32_4x4x4_16b_bf16 v[88:91], v[10:11], v[86:87], v[88:91]
    s_nop 4
    v_cvt_pk_bf16_f32 v88, v88, v89
    v_cvt_pk_bf16_f32 v89, v90, v91
    ds_pk_add_bf16 v7, v88 offset:65408
    ds_pk_add_bf16 v7, v89 offset:65412
    s_mov_b64 exec, s[54:55]
    s_branch L2_d136
L2_c137:
    s_lshl_b64 s[52:53], s[82:83], 1
    s_andn2_b64 s[52:53], s[52:53], s[80:81]
    s_andn2_b64 s[52:53], s[52:53], s[50:51]
    s_or_b64 s[80:81], s[80:81], s[52:53]
    s_not_b64 vcc, s[52:53]
    s_mov_b64 exec, -1
    v_cndmask_b32_dpp v84, v84, v84, vcc wave_shr:1 row_mask:0xf bank_mask:0xf
    v_cndmask_b32_dpp v85, v85, v85, vcc wave_shr:1 row_mask:0xf bank_mask:0xf
    s_lshr_b64 s[52:53], s[52:53], 1
    v_cndmask_b32_dpp v86, v86, v86, vcc wave_shr:1 row_mask:0xf bank_mask:0xf
    v_cndmask_b32_dpp v87, v87, v87, vcc wave_shr:1 row_mask:0xf bank_mask:0xf
    s_andn2_b64 s[82:83], s[82:83], s[52:53]
    v_cndmask_b32_dpp v7, v7, v7, vcc wave_shr:1 row_mask:0xf bank_mask:0xf
    s_mov_b64 exec, s[50:51]
    s_cbranch_scc0 L2_d137
    s_mov_b64 exec, s[82:83]
    s_nop 1
    v_mfma_f32_4x4x4_16b_bf16 v[88:91], v[12:13], v[84:85], 0
    s_nop 1
    v_mfma_f32_4x4x4_16b_bf16 v[88:91], v[10:11], v[86:87], v[88:91]
    s_nop 4
    v_cvt_pk_bf16_f32 v88, v88, v89
    v_cvt_pk_bf16_f32 v89, v90, v91
    ds_pk_add_bf16 v7, v88 offset:65408
    ds_pk_add_bf16 v7, v89 offset:65412
    s_mov_b64 exec, s[50:51]
    s_branch L2_d137
L2_c138:
    s_lshl_b64 s[52:53], s[82:83], 1
    s_andn2_b64 s[52:53], s[52:53], s[80:81]
    s_andn2_b64 s[52:53], s[52:53], s[54:55]
    s_or_b64 s[80:81], s[80:81], s[52:53]
    s_not_b64 vcc, s[52:53]
    s_mov_b64 exec, -1
    v_cndmask_b32_dpp v84, v84, v84, vcc wave_shr:1 row_mask:0xf bank_mask:0xf
    v_cndmask_b32_dpp v85, v85, v85, vcc wave_shr:1 row_mask:0xf bank_mask:0xf
    s_lshr_b64 s[52:53], s[52:53], 1
    v_cndmask_b32_dpp v86, v86, v86, vcc wave_shr:1 row_mask:0xf bank_mask:0xf
    v_cndmask_b32_dpp v87, v87, v87, vcc wave_shr:1 row_mask:0xf bank_mask:0xf
    s_andn2_b64 s[82:83], s[82:83], s[52:53]
    v_cndmask_b32_dpp v7, v7, v7, vcc wave_shr:1 row_mask:0xf bank_mask:0xf
    s_mov_b64 exec, s[54:55]
    s_cbranch_scc0 L2_d138
    s_mov_b64 exec, s[82:83]
    s_nop 1
    v_mfma_f32_4x4x4_16b_bf16 v[88:91], v[12:13], v[84:85], 0
    s_nop 1
    v_mfma_f32_4x4x4_16b_bf16 v[88:91], v[10:11], v[86:87], v[88:91]
    s_nop 4
    v_cvt_pk_bf16_f32 v88, v88, v89
    v_cvt_pk_bf16_f32 v89, v90, v91
    ds_pk_add_bf16 v7, v88 offset:65408
    ds_pk_add_bf16 v7, v89 offset:65412
    s_mov_b64 exec, s[54:55]
    s_branch L2_d138
L2_c139:
    s_lshl_b64 s[52:53], s[82:83], 1
    s_andn2_b64 s[52:53], s[52:53], s[80:81]
    s_andn2_b64 s[52:53], s[52:53], s[50:51]
    s_or_b64 s[80:81], s[80:81], s[52:53]
    s_not_b64 vcc, s[52:53]
    s_mov_b64 exec, -1
    v_cndmask_b32_dpp v84, v84, v84, vcc wave_shr:1 row_mask:0xf bank_mask:0xf
    v_cndmask_b32_dpp v85, v85, v85, vcc wave_shr:1 row_mask:0xf bank_mask:0xf
    s_lshr_b64 s[52:53], s[52:53], 1
    v_cndmask_b32_dpp v86, v86, v86, vcc wave_shr:1 row_mask:0xf bank_mask:0xf
    v_cndmask_b32_dpp v87, v87, v87, vcc wave_shr:1 row_mask:0xf bank_mask:0xf
    s_andn2_b64 s[82:83], s[82:83], s[52:53]
    v_cndmask_b32_dpp v7, v7, v7, vcc wave_shr:1 row_mask:0xf bank_mask:0xf
    s_mov_b64 exec, s[50:51]
    s_cbranch_scc0 L2_d139
    s_mov_b64 exec, s[82:83]
    s_nop 1
    v_mfma_f32_4x4x4_16b_bf16 v[88:91], v[12:13], v[84:85], 0
    s_nop 1
    v_mfma_f32_4x4x4_16b_bf16 v[88:91], v[10:11], v[86:87], v[88:91]
    s_nop 4
    v_cvt_pk_bf16_f32 v88, v88, v89
    v_cvt_pk_bf16_f32 v89, v90, v91
    ds_pk_add_bf16 v7, v88 offset:65408
    ds_pk_add_bf16 v7, v89 offset:65412
    s_mov_b64 exec, s[50:51]
    s_branch L2_d139
L2_c140:
    s_lshl_b64 s[52:53], s[82:83], 1
    s_andn2_b64 s[52:53], s[52:53], s[80:81]
    s_andn2_b64 s[52:53], s[52:53], s[54:55]
    s_or_b64 s[80:81], s[80:81], s[52:53]
    s_not_b64 vcc, s[52:53]
    s_mov_b64 exec, -1
    v_cndmask_b32_dpp v84, v84, v84, vcc wave_shr:1 row_mask:0xf bank_mask:0xf
    v_cndmask_b32_dpp v85, v85, v85, vcc wave_shr:1 row_mask:0xf bank_mask:0xf
    s_lshr_b64 s[52:53], s[52:53], 1
    v_cndmask_b32_dpp v86, v86, v86, vcc wave_shr:1 row_mask:0xf bank_mask:0xf
    v_cndmask_b32_dpp v87, v87, v87, vcc wave_shr:1 row_mask:0xf bank_mask:0xf
    s_andn2_b64 s[82:83], s[82:83], s[52:53]
    v_cndmask_b32_dpp v7, v7, v7, vcc wave_shr:1 row_mask:0xf bank_mask:0xf
    s_mov_b64 exec, s[54:55]
    s_cbranch_scc0 L2_d140
    s_mov_b64 exec, s[82:83]
    s_nop 1
    v_mfma_f32_4x4x4_16b_bf16 v[88:91], v[12:13], v[84:85], 0
    s_nop 1
    v_mfma_f32_4x4x4_16b_bf16 v[88:91], v[10:11], v[86:87], v[88:91]
    s_nop 4
    v_cvt_pk_bf16_f32 v88, v88, v89
    v_cvt_pk_bf16_f32 v89, v90, v91
    ds_pk_add_bf16 v7, v88 offset:65408
    ds_pk_add_bf16 v7, v89 offset:65412
    s_mov_b64 exec, s[54:55]
    s_branch L2_d140
L2_c141:
    s_lshl_b64 s[52:53], s[82:83], 1
    s_andn2_b64 s[52:53], s[52:53], s[80:81]
    s_andn2_b64 s[52:53], s[52:53], s[50:51]
    s_or_b64 s[80:81], s[80:81], s[52:53]
    s_not_b64 vcc, s[52:53]
    s_mov_b64 exec, -1
    v_cndmask_b32_dpp v84, v84, v84, vcc wave_shr:1 row_mask:0xf bank_mask:0xf
    v_cndmask_b32_dpp v85, v85, v85, vcc wave_shr:1 row_mask:0xf bank_mask:0xf
    s_lshr_b64 s[52:53], s[52:53], 1
    v_cndmask_b32_dpp v86, v86, v86, vcc wave_shr:1 row_mask:0xf bank_mask:0xf
    v_cndmask_b32_dpp v87, v87, v87, vcc wave_shr:1 row_mask:0xf bank_mask:0xf
    s_andn2_b64 s[82:83], s[82:83], s[52:53]
    v_cndmask_b32_dpp v7, v7, v7, vcc wave_shr:1 row_mask:0xf bank_mask:0xf
    s_mov_b64 exec, s[50:51]
    s_cbranch_scc0 L2_d141
    s_mov_b64 exec, s[82:83]
    s_nop 1
    v_mfma_f32_4x4x4_16b_bf16 v[88:91], v[12:13], v[84:85], 0
    s_nop 1
    v_mfma_f32_4x4x4_16b_bf16 v[88:91], v[10:11], v[86:87], v[88:91]
    s_nop 4
    v_cvt_pk_bf16_f32 v88, v88, v89
    v_cvt_pk_bf16_f32 v89, v90, v91
    ds_pk_add_bf16 v7, v88 offset:65408
    ds_pk_add_bf16 v7, v89 offset:65412
    s_mov_b64 exec, s[50:51]
    s_branch L2_d141
L2_c142:
    s_lshl_b64 s[52:53], s[82:83], 1
    s_andn2_b64 s[52:53], s[52:53], s[80:81]
    s_andn2_b64 s[52:53], s[52:53], s[54:55]
    s_or_b64 s[80:81], s[80:81], s[52:53]
    s_not_b64 vcc, s[52:53]
    s_mov_b64 exec, -1
    v_cndmask_b32_dpp v84, v84, v84, vcc wave_shr:1 row_mask:0xf bank_mask:0xf
    v_cndmask_b32_dpp v85, v85, v85, vcc wave_shr:1 row_mask:0xf bank_mask:0xf
    s_lshr_b64 s[52:53], s[52:53], 1
    v_cndmask_b32_dpp v86, v86, v86, vcc wave_shr:1 row_mask:0xf bank_mask:0xf
    v_cndmask_b32_dpp v87, v87, v87, vcc wave_shr:1 row_mask:0xf bank_mask:0xf
    s_andn2_b64 s[82:83], s[82:83], s[52:53]
    v_cndmask_b32_dpp v7, v7, v7, vcc wave_shr:1 row_mask:0xf bank_mask:0xf
    s_mov_b64 exec, s[54:55]
    s_cbranch_scc0 L2_d142
    s_mov_b64 exec, s[82:83]
    s_nop 1
    v_mfma_f32_4x4x4_16b_bf16 v[88:91], v[12:13], v[84:85], 0
    s_nop 1
    v_mfma_f32_4x4x4_16b_bf16 v[88:91], v[10:11], v[86:87], v[88:91]
    s_nop 4
    v_cvt_pk_bf16_f32 v88, v88, v89
    v_cvt_pk_bf16_f32 v89, v90, v91
    ds_pk_add_bf16 v7, v88 offset:65408
    ds_pk_add_bf16 v7, v89 offset:65412
    s_mov_b64 exec, s[54:55]
    s_branch L2_d142
L2_c143:
    s_lshl_b64 s[52:53], s[82:83], 1
    s_andn2_b64 s[52:53], s[52:53], s[80:81]
    s_andn2_b64 s[52:53], s[52:53], s[50:51]
    s_or_b64 s[80:81], s[80:81], s[52:53]
    s_not_b64 vcc, s[52:53]
    s_mov_b64 exec, -1
    v_cndmask_b32_dpp v84, v84, v84, vcc wave_shr:1 row_mask:0xf bank_mask:0xf
    v_cndmask_b32_dpp v85, v85, v85, vcc wave_shr:1 row_mask:0xf bank_mask:0xf
    s_lshr_b64 s[52:53], s[52:53], 1
    v_cndmask_b32_dpp v86, v86, v86, vcc wave_shr:1 row_mask:0xf bank_mask:0xf
    v_cndmask_b32_dpp v87, v87, v87, vcc wave_shr:1 row_mask:0xf bank_mask:0xf
    s_andn2_b64 s[82:83], s[82:83], s[52:53]
    v_cndmask_b32_dpp v7, v7, v7, vcc wave_shr:1 row_mask:0xf bank_mask:0xf
    s_mov_b64 exec, s[50:51]
    s_cbranch_scc0 L2_d143
    s_mov_b64 exec, s[82:83]
    s_nop 1
    v_mfma_f32_4x4x4_16b_bf16 v[88:91], v[12:13], v[84:85], 0
    s_nop 1
    v_mfma_f32_4x4x4_16b_bf16 v[88:91], v[10:11], v[86:87], v[88:91]
    s_nop 4
    v_cvt_pk_bf16_f32 v88, v88, v89
    v_cvt_pk_bf16_f32 v89, v90, v91
    ds_pk_add_bf16 v7, v88 offset:65408
    ds_pk_add_bf16 v7, v89 offset:65412
    s_mov_b64 exec, s[50:51]
    s_branch L2_d143
L2_c144:
    s_lshl_b64 s[52:53], s[82:83], 1
    s_andn2_b64 s[52:53], s[52:53], s[80:81]
    s_andn2_b64 s[52:53], s[52:53], s[54:55]
    s_or_b64 s[80:81], s[80:81], s[52:53]
    s_not_b64 vcc, s[52:53]
    s_mov_b64 exec, -1
    v_cndmask_b32_dpp v84, v84, v84, vcc wave_shr:1 row_mask:0xf bank_mask:0xf
    v_cndmask_b32_dpp v85, v85, v85, vcc wave_shr:1 row_mask:0xf bank_mask:0xf
    s_lshr_b64 s[52:53], s[52:53], 1
    v_cndmask_b32_dpp v86, v86, v86, vcc wave_shr:1 row_mask:0xf bank_mask:0xf
    v_cndmask_b32_dpp v87, v87, v87, vcc wave_shr:1 row_mask:0xf bank_mask:0xf
    s_andn2_b64 s[82:83], s[82:83], s[52:53]
    v_cndmask_b32_dpp v7, v7, v7, vcc wave_shr:1 row_mask:0xf bank_mask:0xf
    s_mov_b64 exec, s[54:55]
    s_cbranch_scc0 L2_d144
    s_mov_b64 exec, s[82:83]
    s_nop 1
    v_mfma_f32_4x4x4_16b_bf16 v[88:91], v[12:13], v[84:85], 0
    s_nop 1
    v_mfma_f32_4x4x4_16b_bf16 v[88:91], v[10:11], v[86:87], v[88:91]
    s_nop 4
    v_cvt_pk_bf16_f32 v88, v88, v89
    v_cvt_pk_bf16_f32 v89, v90, v91
    ds_pk_add_bf16 v7, v88 offset:65408
    ds_pk_add_bf16 v7, v89 offset:65412
    s_mov_b64 exec, s[54:55]
    s_branch L2_d144
L2_c145:
    s_lshl_b64 s[52:53], s[82:83], 1
    s_andn2_b64 s[52:53], s[52:53], s[80:81]
    s_andn2_b64 s[52:53], s[52:53], s[50:51]
    s_or_b64 s[80:81], s[80:81], s[52:53]
    s_not_b64 vcc, s[52:53]
    s_mov_b64 exec, -1
    v_cndmask_b32_dpp v84, v84, v84, vcc wave_shr:1 row_mask:0xf bank_mask:0xf
    v_cndmask_b32_dpp v85, v85, v85, vcc wave_shr:1 row_mask:0xf bank_mask:0xf
    s_lshr_b64 s[52:53], s[52:53], 1
    v_cndmask_b32_dpp v86, v86, v86, vcc wave_shr:1 row_mask:0xf bank_mask:0xf
    v_cndmask_b32_dpp v87, v87, v87, vcc wave_shr:1 row_mask:0xf bank_mask:0xf
    s_andn2_b64 s[82:83], s[82:83], s[52:53]
    v_cndmask_b32_dpp v7, v7, v7, vcc wave_shr:1 row_mask:0xf bank_mask:0xf
    s_mov_b64 exec, s[50:51]
    s_cbranch_scc0 L2_d145
    s_mov_b64 exec, s[82:83]
    s_nop 1
    v_mfma_f32_4x4x4_16b_bf16 v[88:91], v[12:13], v[84:85], 0
    s_nop 1
    v_mfma_f32_4x4x4_16b_bf16 v[88:91], v[10:11], v[86:87], v[88:91]
    s_nop 4
    v_cvt_pk_bf16_f32 v88, v88, v89
    v_cvt_pk_bf16_f32 v89, v90, v91
    ds_pk_add_bf16 v7, v88 offset:65408
    ds_pk_add_bf16 v7, v89 offset:65412
    s_mov_b64 exec, s[50:51]
    s_branch L2_d145
L2_c146:
    s_lshl_b64 s[52:53], s[82:83], 1
    s_andn2_b64 s[52:53], s[52:53], s[80:81]
    s_andn2_b64 s[52:53], s[52:53], s[54:55]
    s_or_b64 s[80:81], s[80:81], s[52:53]
    s_not_b64 vcc, s[52:53]
    s_mov_b64 exec, -1
    v_cndmask_b32_dpp v84, v84, v84, vcc wave_shr:1 row_mask:0xf bank_mask:0xf
    v_cndmask_b32_dpp v85, v85, v85, vcc wave_shr:1 row_mask:0xf bank_mask:0xf
    s_lshr_b64 s[52:53], s[52:53], 1
    v_cndmask_b32_dpp v86, v86, v86, vcc wave_shr:1 row_mask:0xf bank_mask:0xf
    v_cndmask_b32_dpp v87, v87, v87, vcc wave_shr:1 row_mask:0xf bank_mask:0xf
    s_andn2_b64 s[82:83], s[82:83], s[52:53]
    v_cndmask_b32_dpp v7, v7, v7, vcc wave_shr:1 row_mask:0xf bank_mask:0xf
    s_mov_b64 exec, s[54:55]
    s_cbranch_scc0 L2_d146
    s_mov_b64 exec, s[82:83]
    s_nop 1
    v_mfma_f32_4x4x4_16b_bf16 v[88:91], v[12:13], v[84:85], 0
    s_nop 1
    v_mfma_f32_4x4x4_16b_bf16 v[88:91], v[10:11], v[86:87], v[88:91]
    s_nop 4
    v_cvt_pk_bf16_f32 v88, v88, v89
    v_cvt_pk_bf16_f32 v89, v90, v91
    ds_pk_add_bf16 v7, v88 offset:65408
    ds_pk_add_bf16 v7, v89 offset:65412
    s_mov_b64 exec, s[54:55]
    s_branch L2_d146
L2_c147:
    s_lshl_b64 s[52:53], s[82:83], 1
    s_andn2_b64 s[52:53], s[52:53], s[80:81]
    s_andn2_b64 s[52:53], s[52:53], s[50:51]
    s_or_b64 s[80:81], s[80:81], s[52:53]
    s_not_b64 vcc, s[52:53]
    s_mov_b64 exec, -1
    v_cndmask_b32_dpp v84, v84, v84, vcc wave_shr:1 row_mask:0xf bank_mask:0xf
    v_cndmask_b32_dpp v85, v85, v85, vcc wave_shr:1 row_mask:0xf bank_mask:0xf
    s_lshr_b64 s[52:53], s[52:53], 1
    v_cndmask_b32_dpp v86, v86, v86, vcc wave_shr:1 row_mask:0xf bank_mask:0xf
    v_cndmask_b32_dpp v87, v87, v87, vcc wave_shr:1 row_mask:0xf bank_mask:0xf
    s_andn2_b64 s[82:83], s[82:83], s[52:53]
    v_cndmask_b32_dpp v7, v7, v7, vcc wave_shr:1 row_mask:0xf bank_mask:0xf
    s_mov_b64 exec, s[50:51]
    s_cbranch_scc0 L2_d147
    s_mov_b64 exec, s[82:83]
    s_nop 1
    v_mfma_f32_4x4x4_16b_bf16 v[88:91], v[12:13], v[84:85], 0
    s_nop 1
    v_mfma_f32_4x4x4_16b_bf16 v[88:91], v[10:11], v[86:87], v[88:91]
    s_nop 4
    v_cvt_pk_bf16_f32 v88, v88, v89
    v_cvt_pk_bf16_f32 v89, v90, v91
    ds_pk_add_bf16 v7, v88 offset:65408
    ds_pk_add_bf16 v7, v89 offset:65412
    s_mov_b64 exec, s[50:51]
    s_branch L2_d147
L2_c148:
    s_lshl_b64 s[52:53], s[82:83], 1
    s_andn2_b64 s[52:53], s[52:53], s[80:81]
    s_andn2_b64 s[52:53], s[52:53], s[54:55]
    s_or_b64 s[80:81], s[80:81], s[52:53]
    s_not_b64 vcc, s[52:53]
    s_mov_b64 exec, -1
    v_cndmask_b32_dpp v84, v84, v84, vcc wave_shr:1 row_mask:0xf bank_mask:0xf
    v_cndmask_b32_dpp v85, v85, v85, vcc wave_shr:1 row_mask:0xf bank_mask:0xf
    s_lshr_b64 s[52:53], s[52:53], 1
    v_cndmask_b32_dpp v86, v86, v86, vcc wave_shr:1 row_mask:0xf bank_mask:0xf
    v_cndmask_b32_dpp v87, v87, v87, vcc wave_shr:1 row_mask:0xf bank_mask:0xf
    s_andn2_b64 s[82:83], s[82:83], s[52:53]
    v_cndmask_b32_dpp v7, v7, v7, vcc wave_shr:1 row_mask:0xf bank_mask:0xf
    s_mov_b64 exec, s[54:55]
    s_cbranch_scc0 L2_d148
    s_mov_b64 exec, s[82:83]
    s_nop 1
    v_mfma_f32_4x4x4_16b_bf16 v[88:91], v[12:13], v[84:85], 0
    s_nop 1
    v_mfma_f32_4x4x4_16b_bf16 v[88:91], v[10:11], v[86:87], v[88:91]
    s_nop 4
    v_cvt_pk_bf16_f32 v88, v88, v89
    v_cvt_pk_bf16_f32 v89, v90, v91
    ds_pk_add_bf16 v7, v88 offset:65408
    ds_pk_add_bf16 v7, v89 offset:65412
    s_mov_b64 exec, s[54:55]
    s_branch L2_d148
L2_c149:
    s_lshl_b64 s[52:53], s[82:83], 1
    s_andn2_b64 s[52:53], s[52:53], s[80:81]
    s_andn2_b64 s[52:53], s[52:53], s[50:51]
    s_or_b64 s[80:81], s[80:81], s[52:53]
    s_not_b64 vcc, s[52:53]
    s_mov_b64 exec, -1
    v_cndmask_b32_dpp v84, v84, v84, vcc wave_shr:1 row_mask:0xf bank_mask:0xf
    v_cndmask_b32_dpp v85, v85, v85, vcc wave_shr:1 row_mask:0xf bank_mask:0xf
    s_lshr_b64 s[52:53], s[52:53], 1
    v_cndmask_b32_dpp v86, v86, v86, vcc wave_shr:1 row_mask:0xf bank_mask:0xf
    v_cndmask_b32_dpp v87, v87, v87, vcc wave_shr:1 row_mask:0xf bank_mask:0xf
    s_andn2_b64 s[82:83], s[82:83], s[52:53]
    v_cndmask_b32_dpp v7, v7, v7, vcc wave_shr:1 row_mask:0xf bank_mask:0xf
    s_mov_b64 exec, s[50:51]
    s_cbranch_scc0 L2_d149
    s_mov_b64 exec, s[82:83]
    s_nop 1
    v_mfma_f32_4x4x4_16b_bf16 v[88:91], v[12:13], v[84:85], 0
    s_nop 1
    v_mfma_f32_4x4x4_16b_bf16 v[88:91], v[10:11], v[86:87], v[88:91]
    s_nop 4
    v_cvt_pk_bf16_f32 v88, v88, v89
    v_cvt_pk_bf16_f32 v89, v90, v91
    ds_pk_add_bf16 v7, v88 offset:65408
    ds_pk_add_bf16 v7, v89 offset:65412
    s_mov_b64 exec, s[50:51]
    s_branch L2_d149
L2_c150:
    s_lshl_b64 s[52:53], s[82:83], 1
    s_andn2_b64 s[52:53], s[52:53], s[80:81]
    s_andn2_b64 s[52:53], s[52:53], s[54:55]
    s_or_b64 s[80:81], s[80:81], s[52:53]
    s_not_b64 vcc, s[52:53]
    s_mov_b64 exec, -1
    v_cndmask_b32_dpp v84, v84, v84, vcc wave_shr:1 row_mask:0xf bank_mask:0xf
    v_cndmask_b32_dpp v85, v85, v85, vcc wave_shr:1 row_mask:0xf bank_mask:0xf
    s_lshr_b64 s[52:53], s[52:53], 1
    v_cndmask_b32_dpp v86, v86, v86, vcc wave_shr:1 row_mask:0xf bank_mask:0xf
    v_cndmask_b32_dpp v87, v87, v87, vcc wave_shr:1 row_mask:0xf bank_mask:0xf
    s_andn2_b64 s[82:83], s[82:83], s[52:53]
    v_cndmask_b32_dpp v7, v7, v7, vcc wave_shr:1 row_mask:0xf bank_mask:0xf
    s_mov_b64 exec, s[54:55]
    s_cbranch_scc0 L2_d150
    s_mov_b64 exec, s[82:83]
    s_nop 1
    v_mfma_f32_4x4x4_16b_bf16 v[88:91], v[12:13], v[84:85], 0
    s_nop 1
    v_mfma_f32_4x4x4_16b_bf16 v[88:91], v[10:11], v[86:87], v[88:91]
    s_nop 4
    v_cvt_pk_bf16_f32 v88, v88, v89
    v_cvt_pk_bf16_f32 v89, v90, v91
    ds_pk_add_bf16 v7, v88 offset:65408
    ds_pk_add_bf16 v7, v89 offset:65412
    s_mov_b64 exec, s[54:55]
    s_branch L2_d150
L2_c151:
    s_lshl_b64 s[52:53], s[82:83], 1
    s_andn2_b64 s[52:53], s[52:53], s[80:81]
    s_andn2_b64 s[52:53], s[52:53], s[50:51]
    s_or_b64 s[80:81], s[80:81], s[52:53]
    s_not_b64 vcc, s[52:53]
    s_mov_b64 exec, -1
    v_cndmask_b32_dpp v84, v84, v84, vcc wave_shr:1 row_mask:0xf bank_mask:0xf
    v_cndmask_b32_dpp v85, v85, v85, vcc wave_shr:1 row_mask:0xf bank_mask:0xf
    s_lshr_b64 s[52:53], s[52:53], 1
    v_cndmask_b32_dpp v86, v86, v86, vcc wave_shr:1 row_mask:0xf bank_mask:0xf
    v_cndmask_b32_dpp v87, v87, v87, vcc wave_shr:1 row_mask:0xf bank_mask:0xf
    s_andn2_b64 s[82:83], s[82:83], s[52:53]
    v_cndmask_b32_dpp v7, v7, v7, vcc wave_shr:1 row_mask:0xf bank_mask:0xf
    s_mov_b64 exec, s[50:51]
    s_cbranch_scc0 L2_d151
    s_mov_b64 exec, s[82:83]
    s_nop 1
    v_mfma_f32_4x4x4_16b_bf16 v[88:91], v[12:13], v[84:85], 0
    s_nop 1
    v_mfma_f32_4x4x4_16b_bf16 v[88:91], v[10:11], v[86:87], v[88:91]
    s_nop 4
    v_cvt_pk_bf16_f32 v88, v88, v89
    v_cvt_pk_bf16_f32 v89, v90, v91
    ds_pk_add_bf16 v7, v88 offset:65408
    ds_pk_add_bf16 v7, v89 offset:65412
    s_mov_b64 exec, s[50:51]
    s_branch L2_d151
L2_c152:
    s_mov_b64 s[50:51], vcc
    s_lshl_b64 s[52:53], s[82:83], 1
    s_andn2_b64 s[52:53], s[52:53], s[80:81]
    s_andn2_b64 s[52:53], s[52:53], s[50:51]
    s_or_b64 s[80:81], s[80:81], s[52:53]
    s_not_b64 vcc, s[52:53]
    s_mov_b64 exec, -1
    v_cndmask_b32_dpp v84, v84, v84, vcc wave_shr:1 row_mask:0xf bank_mask:0xf
    v_cndmask_b32_dpp v85, v85, v85, vcc wave_shr:1 row_mask:0xf bank_mask:0xf
    s_lshr_b64 s[52:53], s[52:53], 1
    v_cndmask_b32_dpp v86, v86, v86, vcc wave_shr:1 row_mask:0xf bank_mask:0xf
    v_cndmask_b32_dpp v87, v87, v87, vcc wave_shr:1 row_mask:0xf bank_mask:0xf
    s_andn2_b64 s[82:83], s[82:83], s[52:53]
    v_cndmask_b32_dpp v7, v7, v7, vcc wave_shr:1 row_mask:0xf bank_mask:0xf
    s_mov_b64 vcc, s[50:51]
    s_mov_b64 exec, s[50:51]
    s_cbranch_scc0 L2_d152
    s_mov_b64 exec, s[82:83]
    s_nop 1
    v_mfma_f32_4x4x4_16b_bf16 v[88:91], v[12:13], v[84:85], 0
    s_nop 1
    v_mfma_f32_4x4x4_16b_bf16 v[88:91], v[10:11], v[86:87], v[88:91]
    s_nop 4
    v_cvt_pk_bf16_f32 v88, v88, v89
    v_cvt_pk_bf16_f32 v89, v90, v91
    ds_pk_add_bf16 v7, v88 offset:65408
    ds_pk_add_bf16 v7, v89 offset:65412
    s_mov_b64 exec, vcc
    s_branch L2_d152
L2_c153:
    s_mov_b64 s[50:51], vcc
    s_lshl_b64 s[52:53], s[82:83], 1
    s_andn2_b64 s[52:53], s[52:53], s[80:81]
    s_andn2_b64 s[52:53], s[52:53], s[50:51]
    s_or_b64 s[80:81], s[80:81], s[52:53]
    s_not_b64 vcc, s[52:53]
    s_mov_b64 exec, -1
    v_cndmask_b32_dpp v84, v84, v84, vcc wave_shr:1 row_mask:0xf bank_mask:0xf
    v_cndmask_b32_dpp v85, v85, v85, vcc wave_shr:1 row_mask:0xf bank_mask:0xf
    s_lshr_b64 s[52:53], s[52:53], 1
    v_cndmask_b32_dpp v86, v86, v86, vcc wave_shr:1 row_mask:0xf bank_mask:0xf
    v_cndmask_b32_dpp v87, v87, v87, vcc wave_shr:1 row_mask:0xf bank_mask:0xf
    s_andn2_b64 s[82:83], s[82:83], s[52:53]
    v_cndmask_b32_dpp v7, v7, v7, vcc wave_shr:1 row_mask:0xf bank_mask:0xf
    s_mov_b64 vcc, s[50:51]
    s_mov_b64 exec, s[50:51]
    s_cbranch_scc0 L2_d153
    s_mov_b64 exec, s[82:83]
    s_nop 1
    v_mfma_f32_4x4x4_16b_bf16 v[88:91], v[12:13], v[84:85], 0
    s_nop 1
    v_mfma_f32_4x4x4_16b_bf16 v[88:91], v[10:11], v[86:87], v[88:91]
    s_nop 4
    v_cvt_pk_bf16_f32 v88, v88, v89
    v_cvt_pk_bf16_f32 v89, v90, v91
    ds_pk_add_bf16 v7, v88 offset:65408
    ds_pk_add_bf16 v7, v89 offset:65412
    s_mov_b64 exec, vcc
    s_branch L2_d153
.section .rodata,"a"
.p2align 6
.amdhsa_kernel gather_scatter__molecular_angular_gemnet__graph_kernel
  .amdhsa_next_free_vgpr 128
  .amdhsa_next_free_sgpr 102
  .amdhsa_accum_offset 128
  .amdhsa_group_segment_fixed_size 0
  .amdhsa_kernarg_size 112
  .amdhsa_user_sgpr_count 2
  .amdhsa_user_sgpr_kernarg_segment_ptr 1
  .amdhsa_system_sgpr_workgroup_id_x 1
  .amdhsa_float_denorm_mode_32 3
.end_amdhsa_kernel
```

```asm
; @launch grid=(256,1,1) block=(1024,1,1) lds=163840
.amdgcn_target "amdgcn-amd-amdhsa--gfx950"
.text
.globl gather_scatter__molecular_angular_gemnet__graph_kernel
.p2align 8
.type gather_scatter__molecular_angular_gemnet__graph_kernel,@function
gather_scatter__molecular_angular_gemnet__graph_kernel:
    s_cmp_ge_u32 s2, 256
    s_cbranch_scc0 L1_go
    s_endpgm
L1_go:
    s_load_dwordx4 s[4:7], s[0:1], 8
    s_load_dwordx2 s[28:29], s[0:1], 32
    s_load_dwordx2 s[30:31], s[0:1], 104
    s_load_dwordx2 s[56:57], s[0:1], 96
    s_load_dwordx2 s[86:87], s[0:1], 0
    s_load_dwordx4 s[60:63], s[0:1], 56
    s_load_dwordx4 s[64:67], s[0:1], 72
    v_lshrrev_b32 v7, 6, v0
    v_lshlrev_b32 v1, 3, v0
    v_readfirstlane_b32 s32, v7
    v_lshlrev_b32 v0, 4, v0
    v_and_b32 v1, 0x1f8, v1
    v_lshlrev_b32 v15, 1, v1
    s_lshr_b32 s3, s32, 1
    s_and_b32 s44, s32, 1
    s_lshl_b32 s44, s44, 3
    s_or_b32 s3, s3, s44
    s_lshl_b32 s3, s3, 10
    s_lshl_b32 s96, s2, 14
    s_add_u32 s96, s96, s3
    s_lshr_b32 s3, s32, 1
    s_and_b32 s44, s32, 1
    s_lshl_b32 s44, s44, 3
    s_or_b32 s3, s3, s44
    s_lshl_b32 s3, s3, 10
    s_lshl_b32 s97, s2, 14
    s_add_u32 s97, s97, s3
    s_lshr_b32 s3, s32, 1
    s_and_b32 s44, s32, 1
    s_lshl_b32 s44, s44, 3
    s_or_b32 s3, s3, s44
    s_lshl_b32 s3, s3, 10
    s_lshl_b32 s98, s2, 14
    s_add_u32 s98, s98, s3
    s_lshr_b32 s3, s32, 1
    s_and_b32 s44, s32, 1
    s_lshl_b32 s44, s44, 3
    s_or_b32 s3, s3, s44
    s_lshl_b32 s3, s3, 10
    s_lshl_b32 s99, s2, 14
    s_add_u32 s99, s99, s3
    s_waitcnt lgkmcnt(0)
    s_mov_b32 s8, s4
    s_mov_b32 s9, s5
    s_mov_b32 s10, 0x9c40000
    s_mov_b32 s11, 0x20000
    s_mov_b32 s12, s6
    s_mov_b32 s13, s7
    s_mov_b32 s14, 0x9c40000
    s_mov_b32 s15, 0x20000
    s_mov_b32 s16, s28
    s_mov_b32 s17, s29
    s_mov_b32 s18, 0x4e20000
    s_mov_b32 s19, 0x20000
    s_mov_b32 s68, s62
    s_mov_b32 s69, s63
    s_mov_b32 s70, 0x40
    s_mov_b32 s71, 0x20000
    s_mov_b32 s72, s60
    s_mov_b32 s73, s61
    s_mov_b32 s74, 0x40
    s_mov_b32 s75, 0x20000
    s_mov_b32 s20, s66
    s_mov_b32 s21, s67
    s_mov_b32 s22, 0x20
    s_mov_b32 s23, 0x20000
    s_mov_b32 s80, s64
    s_mov_b32 s81, s65
    s_mov_b32 s82, 0x20
    s_mov_b32 s83, 0x20000
    s_add_u32 s24, s30, 0xebcd000
    s_addc_u32 s25, s31, 0
    s_mov_b32 s26, 0x100
    s_mov_b32 s27, 0x20000
    v_lshrrev_b32 v2, 3, v0
    v_and_b32 v2, 6, v2
    v_lshlrev_b32 v3, 2, v0
    s_lshl_b32 s3, s32, 8
    s_add_u32 s3, s3, s2
    s_cmp_lg_u32 s3, 254
    s_cbranch_scc1 L1_wt
    buffer_load_ushort v96, v2, s[68:71], 0 offen offset:0
    buffer_load_ushort v108, v2, s[68:71], 0 offen offset:8
    buffer_load_ushort v97, v2, s[68:71], 0 offen offset:16
    buffer_load_ushort v109, v2, s[68:71], 0 offen offset:24
    buffer_load_ushort v98, v2, s[68:71], 0 offen offset:32
    buffer_load_ushort v110, v2, s[68:71], 0 offen offset:40
    buffer_load_ushort v99, v2, s[68:71], 0 offen offset:48
    buffer_load_ushort v111, v2, s[68:71], 0 offen offset:56
    buffer_load_ushort v100, v2, s[72:75], 0 offen offset:0
    buffer_load_ushort v112, v2, s[72:75], 0 offen offset:8
    buffer_load_ushort v101, v2, s[72:75], 0 offen offset:16
    buffer_load_ushort v113, v2, s[72:75], 0 offen offset:24
    buffer_load_ushort v102, v2, s[72:75], 0 offen offset:32
    buffer_load_ushort v114, v2, s[72:75], 0 offen offset:40
    buffer_load_ushort v103, v2, s[72:75], 0 offen offset:48
    buffer_load_ushort v115, v2, s[72:75], 0 offen offset:56
    buffer_load_ushort v104, v2, s[20:23], 0 offen offset:0
    buffer_load_ushort v116, v2, s[20:23], 0 offen offset:8
    buffer_load_ushort v105, v2, s[20:23], 0 offen offset:16
    buffer_load_ushort v117, v2, s[20:23], 0 offen offset:24
    buffer_load_ushort v106, v2, s[80:83], 0 offen offset:0
    buffer_load_ushort v118, v2, s[80:83], 0 offen offset:8
    buffer_load_ushort v107, v2, s[80:83], 0 offen offset:16
    buffer_load_ushort v119, v2, s[80:83], 0 offen offset:24
    s_waitcnt vmcnt(0)
    v_lshl_or_b32 v96, v108, 16, v96
    v_lshl_or_b32 v97, v109, 16, v97
    v_lshl_or_b32 v98, v110, 16, v98
    v_lshl_or_b32 v99, v111, 16, v99
    v_lshl_or_b32 v100, v112, 16, v100
    v_lshl_or_b32 v101, v113, 16, v101
    v_lshl_or_b32 v102, v114, 16, v102
    v_lshl_or_b32 v103, v115, 16, v103
    v_lshl_or_b32 v104, v116, 16, v104
    v_lshl_or_b32 v105, v117, 16, v105
    v_lshl_or_b32 v106, v118, 16, v106
    v_lshl_or_b32 v107, v119, 16, v107
    buffer_store_dwordx4 v[96:99], v3, s[24:27], 0 offen offset:0 sc1
    buffer_store_dwordx4 v[100:103], v3, s[24:27], 0 offen offset:16 sc1
    buffer_store_dwordx4 v[104:107], v3, s[24:27], 0 offen offset:32 sc1
L1_wt:
    s_nop 1
    s_add_u32 s44, s96, 0x0
    v_lshlrev_b32 v16, 1, v1
    buffer_load_dwordx4 v[16:19], v16, s[8:11], s44 offen nt
    s_add_u32 s45, s96, 0x0
    v_lshlrev_b32 v20, 1, v1
    buffer_load_dwordx4 v[20:23], v20, s[12:15], s45 offen nt
    s_add_u32 s46, s96, 0x0
    s_lshr_b32 s46, s46, 1
    buffer_load_dwordx2 v[24:25], v1, s[16:19], s46 offen nt
    s_add_u32 s47, s97, 0x400000
    s_lshr_b32 s47, s47, 1
    buffer_load_dwordx2 v[26:27], v1, s[16:19], s47 offen nt
    s_add_u32 s44, s97, 0x400000
    v_lshlrev_b32 v28, 1, v1
    buffer_load_dwordx4 v[28:31], v28, s[8:11], s44 offen nt
    s_add_u32 s45, s97, 0x400000
    v_lshlrev_b32 v32, 1, v1
    buffer_load_dwordx4 v[32:35], v32, s[12:15], s45 offen nt
    s_add_u32 s46, s98, 0x800000
    v_lshlrev_b32 v36, 1, v1
    buffer_load_dwordx4 v[36:39], v36, s[8:11], s46 offen nt
    s_add_u32 s47, s98, 0x800000
    v_lshlrev_b32 v40, 1, v1
    buffer_load_dwordx4 v[40:43], v40, s[12:15], s47 offen nt
    s_add_u32 s44, s98, 0x800000
    s_lshr_b32 s44, s44, 1
    buffer_load_dwordx2 v[44:45], v1, s[16:19], s44 offen nt
    s_add_u32 s45, s99, 0xc00000
    s_lshr_b32 s45, s45, 1
    buffer_load_dwordx2 v[46:47], v1, s[16:19], s45 offen nt
    s_mov_b32 s20, s30
    s_mov_b32 s21, s31
    s_mov_b32 s22, 0xd344000
    s_mov_b32 s23, 0x20000
    s_add_u32 s24, s30, 0x2c000
    s_addc_u32 s25, s31, 0
    s_mov_b32 s26, 0xd318000
    s_mov_b32 s27, 0x20000
    s_add_u32 s3, s32, 0
    s_mul_i32 s4, s3, 205
    s_lshr_b32 s4, s4, 10
    s_mul_i32 s5, s4, 5
    s_sub_u32 s5, s3, s5
    s_lshl_b32 s5, s5, 5
    s_add_u32 s4, s4, s5
    s_sub_u32 s4, s4, s32
    s_lshl_b32 s72, s4, 10
    s_add_u32 s3, s32, 16
    s_mul_i32 s4, s3, 205
    s_lshr_b32 s4, s4, 10
    s_mul_i32 s5, s4, 5
    s_sub_u32 s5, s3, s5
    s_lshl_b32 s5, s5, 5
    s_add_u32 s4, s4, s5
    s_sub_u32 s4, s4, s32
    s_lshl_b32 s73, s4, 10
    s_add_u32 s3, s32, 32
    s_mul_i32 s4, s3, 205
    s_lshr_b32 s4, s4, 10
    s_mul_i32 s5, s4, 5
    s_sub_u32 s5, s3, s5
    s_lshl_b32 s5, s5, 5
    s_add_u32 s4, s4, s5
    s_sub_u32 s4, s4, s32
    s_lshl_b32 s85, s4, 10
    s_add_u32 s3, s32, 48
    s_mul_i32 s4, s3, 205
    s_lshr_b32 s4, s4, 10
    s_mul_i32 s5, s4, 5
    s_sub_u32 s5, s3, s5
    s_lshl_b32 s5, s5, 5
    s_add_u32 s4, s4, s5
    s_sub_u32 s4, s4, s32
    s_lshl_b32 s91, s4, 10
    s_add_u32 s3, s32, 64
    s_mul_i32 s4, s3, 205
    s_lshr_b32 s4, s4, 10
    s_mul_i32 s5, s4, 5
    s_sub_u32 s5, s3, s5
    s_lshl_b32 s5, s5, 5
    s_add_u32 s4, s4, s5
    s_sub_u32 s4, s4, s32
    s_lshl_b32 s93, s4, 10
    s_mov_b32 s80, s86
    s_mov_b32 s81, s87
    s_mov_b32 s82, 0x4e2000
    s_mov_b32 s83, 0x20000
    s_mul_i32 s35, s2, 173056
    s_and_b32 s37, s32, 3
    s_lshl_b32 s37, s37, 3
    s_mov_b32 s36, s37
    s_lshr_b32 s37, s32, 2
    s_mul_i32 s37, s37, 2080
    s_add_u32 s36, s36, s37
    s_and_b32 s37, s2, 3
    s_lshl_b32 s37, s37, 5
    s_add_u32 s36, s36, s37
    s_mul_i32 s4, s2, 5
    s_add_u32 s4, s4, 8192
    s_lshl_b32 s38, s4, 14
    s_lshl_b32 s39, s4, 13
    v_mov_b32 v2, 1
    v_mov_b32 v4, 0x80000007
    v_mov_b32 v5, 0xfc
    v_mov_b32 v6, 0x78
    s_mov_b32 s40, 16512
    s_mov_b32 s55, -10000
    s_mov_b32 s41, 0x010c0c01
    s_mov_b32 s42, 0x030c0c03
    v_mov_b32 v8, 0
    v_mov_b32 v9, 0
    v_mov_b32 v10, 0
    v_mov_b32 v11, 0
    ds_write_b128 v0, v[8:11]
    s_add_u32 s60, s30, 0xebd6000
    s_addc_u32 s61, s31, 0
    s_mov_b32 s62, 0x8000
    s_mov_b32 s63, 0x20000
    s_mov_b64 s[66:67], s[56:57]
    s_lshl_b32 s57, s2, 7
    s_add_u32 s68, s30, 0xebce000
    s_addc_u32 s69, s31, 0
    s_mov_b32 s70, 0x80
    s_mov_b32 s71, 0x20000
    s_lshl_b32 s3, s2, 7
    s_add_u32 s68, s68, s3
    s_addc_u32 s69, s69, 0
    s_cmp_lg_u32 s32, 0
    s_cbranch_scc1 L1_fl
    buffer_store_dwordx4 v[8:11], v0, s[68:71], 0 offen sc1
    s_mov_b64 exec, 0xff
    buffer_store_dwordx4 v[8:11], v0, s[60:63], s57 offen sc1
    s_mov_b64 exec, -1
    buffer_inv sc1
L1_fl:
    s_waitcnt lgkmcnt(0)
    s_barrier
    s_setprio 3
    s_add_u32 s46, s99, 0xc00000
    v_lshlrev_b32 v48, 1, v1
    buffer_load_dwordx4 v[48:51], v48, s[8:11], s46 offen nt
    s_add_u32 s47, s99, 0xc00000
    v_lshlrev_b32 v52, 1, v1
    buffer_load_dwordx4 v[52:55], v52, s[12:15], s47 offen nt
    s_waitcnt vmcnt(8)
    v_lshlrev_b32 v7, 16, v24
    v_and_b32 v8, 0xffff0000, v24
    v_lshlrev_b32 v9, 16, v25
    v_and_b32 v10, 0xffff0000, v25
    v_mul_f32 v7, 0.15915494, v7
    v_mul_f32 v8, 0.15915494, v8
    v_mul_f32 v9, 0.15915494, v9
    v_mul_f32 v10, 0.15915494, v10
    v_mul_hi_u32_u24 v14, 429497, v16
    v_lshrrev_b32 v12, 3, v20
    v_cos_f32 v7, v7
    v_lshlrev_b16 v13, 3, v20
    v_mad_i32_i24 v11, v14, s55, v16
    v_bitop3_b32 v12, v6, v13, v12 bitop3:0xca
    v_lshl_add_u32 v11, v11, 17, s40
    v_lshlrev_b16 v14, 8, v14
    v_lshrrev_b32 v13, 2, v20
    v_add_u32 v16, v12, v11
    v_bitop3_b32 v20, v5, v13, v14 bitop3:0xea
    ds_add_u32 v20, v2
    v_mul_hi_u32_u24 v14, 429497, v17
    v_lshrrev_b32 v12, 3, v21
    v_cos_f32 v8, v8
    v_lshlrev_b16 v13, 3, v21
    v_mad_i32_i24 v11, v14, s55, v17
    v_bitop3_b32 v12, v6, v13, v12 bitop3:0xca
    v_lshl_add_u32 v11, v11, 17, s40
    v_lshlrev_b16 v14, 8, v14
    v_lshrrev_b32 v13, 2, v21
    v_add_u32 v17, v12, v11
    v_bitop3_b32 v21, v5, v13, v14 bitop3:0xea
    ds_add_u32 v21, v2
    v_cvt_pk_bf16_f32 v24, v7, v8
    v_perm_b32 v12, v24, v24, s41
    v_bitop3_b32 v16, v4, v12, v16 bitop3:0xca
    v_perm_b32 v13, v24, v24, s42
    v_bitop3_b32 v17, v4, v13, v17 bitop3:0xca
    v_mul_hi_u32_u24 v14, 429497, v18
    v_lshrrev_b32 v12, 3, v22
    v_cos_f32 v9, v9
    v_lshlrev_b16 v13, 3, v22
    v_mad_i32_i24 v11, v14, s55, v18
    v_bitop3_b32 v12, v6, v13, v12 bitop3:0xca
    v_lshl_add_u32 v11, v11, 17, s40
    v_lshlrev_b16 v14, 8, v14
    v_lshrrev_b32 v13, 2, v22
    v_add_u32 v18, v12, v11
    v_bitop3_b32 v22, v5, v13, v14 bitop3:0xea
    ds_add_u32 v22, v2
    v_mul_hi_u32_u24 v14, 429497, v19
    v_lshrrev_b32 v12, 3, v23
    v_cos_f32 v10, v10
    v_lshlrev_b16 v13, 3, v23
    v_mad_i32_i24 v11, v14, s55, v19
    v_bitop3_b32 v12, v6, v13, v12 bitop3:0xca
    v_lshl_add_u32 v11, v11, 17, s40
    v_lshlrev_b16 v14, 8, v14
    v_lshrrev_b32 v13, 2, v23
    v_add_u32 v19, v12, v11
    v_bitop3_b32 v23, v5, v13, v14 bitop3:0xea
    ds_add_u32 v23, v2
    v_cvt_pk_bf16_f32 v25, v9, v10
    v_perm_b32 v12, v25, v25, s41
    v_bitop3_b32 v18, v4, v12, v18 bitop3:0xca
    v_perm_b32 v13, v25, v25, s42
    v_bitop3_b32 v19, v4, v13, v19 bitop3:0xca
    s_add_u32 s44, s96, 0x1000000
    v_lshlrev_b32 v56, 1, v1
    buffer_load_dwordx4 v[56:59], v56, s[8:11], s44 offen nt
    s_add_u32 s45, s96, 0x1000000
    v_lshlrev_b32 v60, 1, v1
    buffer_load_dwordx4 v[60:63], v60, s[12:15], s45 offen nt
    s_add_u32 s46, s96, 0x1000000
    s_lshr_b32 s46, s46, 1
    buffer_load_dwordx2 v[64:65], v1, s[16:19], s46 offen nt
    s_add_u32 s47, s97, 0x1400000
    s_lshr_b32 s47, s47, 1
    buffer_load_dwordx2 v[66:67], v1, s[16:19], s47 offen nt
    s_waitcnt vmcnt(10)
    v_lshlrev_b32 v7, 16, v26
    v_and_b32 v8, 0xffff0000, v26
    v_lshlrev_b32 v9, 16, v27
    v_and_b32 v10, 0xffff0000, v27
    v_mul_f32 v7, 0.15915494, v7
    v_mul_f32 v8, 0.15915494, v8
    v_mul_f32 v9, 0.15915494, v9
    v_mul_f32 v10, 0.15915494, v10
    v_mul_hi_u32_u24 v14, 429497, v28
    v_lshrrev_b32 v12, 3, v32
    v_cos_f32 v7, v7
    v_lshlrev_b16 v13, 3, v32
    v_mad_i32_i24 v11, v14, s55, v28
    v_bitop3_b32 v12, v6, v13, v12 bitop3:0xca
    v_lshl_add_u32 v11, v11, 17, s40
    v_lshlrev_b16 v14, 8, v14
    v_lshrrev_b32 v13, 2, v32
    v_add_u32 v28, v12, v11
    v_bitop3_b32 v32, v5, v13, v14 bitop3:0xea
    ds_add_u32 v32, v2
    v_mul_hi_u32_u24 v14, 429497, v29
    v_lshrrev_b32 v12, 3, v33
    v_cos_f32 v8, v8
    v_lshlrev_b16 v13, 3, v33
    v_mad_i32_i24 v11, v14, s55, v29
    v_bitop3_b32 v12, v6, v13, v12 bitop3:0xca
    v_lshl_add_u32 v11, v11, 17, s40
    v_lshlrev_b16 v14, 8, v14
    v_lshrrev_b32 v13, 2, v33
    v_add_u32 v29, v12, v11
    v_bitop3_b32 v33, v5, v13, v14 bitop3:0xea
    ds_add_u32 v33, v2
    v_cvt_pk_bf16_f32 v26, v7, v8
    v_perm_b32 v12, v26, v26, s41
    v_bitop3_b32 v28, v4, v12, v28 bitop3:0xca
    v_perm_b32 v13, v26, v26, s42
    v_bitop3_b32 v29, v4, v13, v29 bitop3:0xca
    v_mul_hi_u32_u24 v14, 429497, v30
    v_lshrrev_b32 v12, 3, v34
    v_cos_f32 v9, v9
    v_lshlrev_b16 v13, 3, v34
    v_mad_i32_i24 v11, v14, s55, v30
    v_bitop3_b32 v12, v6, v13, v12 bitop3:0xca
    v_lshl_add_u32 v11, v11, 17, s40
    v_lshlrev_b16 v14, 8, v14
    v_lshrrev_b32 v13, 2, v34
    v_add_u32 v30, v12, v11
    v_bitop3_b32 v34, v5, v13, v14 bitop3:0xea
    ds_add_u32 v34, v2
    v_mul_hi_u32_u24 v14, 429497, v31
    v_lshrrev_b32 v12, 3, v35
    v_cos_f32 v10, v10
    v_lshlrev_b16 v13, 3, v35
    v_mad_i32_i24 v11, v14, s55, v31
    v_bitop3_b32 v12, v6, v13, v12 bitop3:0xca
    v_lshl_add_u32 v11, v11, 17, s40
    v_lshlrev_b16 v14, 8, v14
    v_lshrrev_b32 v13, 2, v35
    v_add_u32 v31, v12, v11
    v_bitop3_b32 v35, v5, v13, v14 bitop3:0xea
    ds_add_u32 v35, v2
    v_cvt_pk_bf16_f32 v27, v9, v10
    v_perm_b32 v12, v27, v27, s41
    v_bitop3_b32 v30, v4, v12, v30 bitop3:0xca
    v_perm_b32 v13, v27, v27, s42
    v_bitop3_b32 v31, v4, v13, v31 bitop3:0xca
    s_setprio 2
    s_add_u32 s44, s97, 0x1400000
    v_lshlrev_b32 v68, 1, v1
    buffer_load_dwordx4 v[68:71], v68, s[8:11], s44 offen nt
    s_add_u32 s45, s97, 0x1400000
    v_lshlrev_b32 v72, 1, v1
    buffer_load_dwordx4 v[72:75], v72, s[12:15], s45 offen nt
    s_waitcnt vmcnt(8)
    v_lshlrev_b32 v7, 16, v44
    v_and_b32 v8, 0xffff0000, v44
    v_lshlrev_b32 v9, 16, v45
    v_and_b32 v10, 0xffff0000, v45
    v_mul_f32 v7, 0.15915494, v7
    v_mul_f32 v8, 0.15915494, v8
    v_mul_f32 v9, 0.15915494, v9
    v_mul_f32 v10, 0.15915494, v10
    v_mul_hi_u32_u24 v14, 429497, v36
    v_lshrrev_b32 v12, 3, v40
    v_cos_f32 v7, v7
    v_lshlrev_b16 v13, 3, v40
    v_mad_i32_i24 v11, v14, s55, v36
    v_bitop3_b32 v12, v6, v13, v12 bitop3:0xca
    v_lshl_add_u32 v11, v11, 17, s40
    v_lshlrev_b16 v14, 8, v14
    v_lshrrev_b32 v13, 2, v40
    v_add_u32 v36, v12, v11
    v_bitop3_b32 v40, v5, v13, v14 bitop3:0xea
    ds_add_u32 v40, v2
    v_mul_hi_u32_u24 v14, 429497, v37
    v_lshrrev_b32 v12, 3, v41
    v_cos_f32 v8, v8
    v_lshlrev_b16 v13, 3, v41
    v_mad_i32_i24 v11, v14, s55, v37
    v_bitop3_b32 v12, v6, v13, v12 bitop3:0xca
    v_lshl_add_u32 v11, v11, 17, s40
    v_lshlrev_b16 v14, 8, v14
    v_lshrrev_b32 v13, 2, v41
    v_add_u32 v37, v12, v11
    v_bitop3_b32 v41, v5, v13, v14 bitop3:0xea
    ds_add_u32 v41, v2
    v_cvt_pk_bf16_f32 v44, v7, v8
    v_perm_b32 v12, v44, v44, s41
    v_bitop3_b32 v36, v4, v12, v36 bitop3:0xca
    v_perm_b32 v13, v44, v44, s42
    v_bitop3_b32 v37, v4, v13, v37 bitop3:0xca
    v_mul_hi_u32_u24 v14, 429497, v38
    v_lshrrev_b32 v12, 3, v42
    v_cos_f32 v9, v9
    v_lshlrev_b16 v13, 3, v42
    v_mad_i32_i24 v11, v14, s55, v38
    v_bitop3_b32 v12, v6, v13, v12 bitop3:0xca
    v_lshl_add_u32 v11, v11, 17, s40
    v_lshlrev_b16 v14, 8, v14
    v_lshrrev_b32 v13, 2, v42
    v_add_u32 v38, v12, v11
    v_bitop3_b32 v42, v5, v13, v14 bitop3:0xea
    ds_add_u32 v42, v2
    v_mul_hi_u32_u24 v14, 429497, v39
    v_lshrrev_b32 v12, 3, v43
    v_cos_f32 v10, v10
    v_lshlrev_b16 v13, 3, v43
    v_mad_i32_i24 v11, v14, s55, v39
    v_bitop3_b32 v12, v6, v13, v12 bitop3:0xca
    v_lshl_add_u32 v11, v11, 17, s40
    v_lshlrev_b16 v14, 8, v14
    v_lshrrev_b32 v13, 2, v43
    v_add_u32 v39, v12, v11
    v_bitop3_b32 v43, v5, v13, v14 bitop3:0xea
    ds_add_u32 v43, v2
    v_cvt_pk_bf16_f32 v45, v9, v10
    v_perm_b32 v12, v45, v45, s41
    v_bitop3_b32 v38, v4, v12, v38 bitop3:0xca
    v_perm_b32 v13, v45, v45, s42
    v_bitop3_b32 v39, v4, v13, v39 bitop3:0xca
    s_add_u32 s46, s98, 0x1800000
    v_lshlrev_b32 v76, 1, v1
    buffer_load_dwordx4 v[76:79], v76, s[8:11], s46 offen nt
    s_add_u32 s47, s98, 0x1800000
    v_lshlrev_b32 v80, 1, v1
    buffer_load_dwordx4 v[80:83], v80, s[12:15], s47 offen nt
    s_add_u32 s44, s98, 0x1800000
    s_lshr_b32 s44, s44, 1
    buffer_load_dwordx2 v[84:85], v1, s[16:19], s44 offen nt
    s_add_u32 s45, s99, 0x1c00000
    s_lshr_b32 s45, s45, 1
    buffer_load_dwordx2 v[86:87], v1, s[16:19], s45 offen nt
    s_waitcnt vmcnt(10)
    v_lshlrev_b32 v7, 16, v46
    v_and_b32 v8, 0xffff0000, v46
    v_lshlrev_b32 v9, 16, v47
    v_and_b32 v10, 0xffff0000, v47
    v_mul_f32 v7, 0.15915494, v7
    v_mul_f32 v8, 0.15915494, v8
    v_mul_f32 v9, 0.15915494, v9
    v_mul_f32 v10, 0.15915494, v10
    v_mul_hi_u32_u24 v14, 429497, v48
    v_lshrrev_b32 v12, 3, v52
    v_cos_f32 v7, v7
    v_lshlrev_b16 v13, 3, v52
    v_mad_i32_i24 v11, v14, s55, v48
    v_bitop3_b32 v12, v6, v13, v12 bitop3:0xca
    v_lshl_add_u32 v11, v11, 17, s40
    v_lshlrev_b16 v14, 8, v14
    v_lshrrev_b32 v13, 2, v52
    v_add_u32 v48, v12, v11
    v_bitop3_b32 v52, v5, v13, v14 bitop3:0xea
    ds_add_u32 v52, v2
    v_mul_hi_u32_u24 v14, 429497, v49
    v_lshrrev_b32 v12, 3, v53
    v_cos_f32 v8, v8
    v_lshlrev_b16 v13, 3, v53
    v_mad_i32_i24 v11, v14, s55, v49
    v_bitop3_b32 v12, v6, v13, v12 bitop3:0xca
    v_lshl_add_u32 v11, v11, 17, s40
    v_lshlrev_b16 v14, 8, v14
    v_lshrrev_b32 v13, 2, v53
    v_add_u32 v49, v12, v11
    v_bitop3_b32 v53, v5, v13, v14 bitop3:0xea
    ds_add_u32 v53, v2
    v_cvt_pk_bf16_f32 v46, v7, v8
    v_perm_b32 v12, v46, v46, s41
    v_bitop3_b32 v48, v4, v12, v48 bitop3:0xca
    v_perm_b32 v13, v46, v46, s42
    v_bitop3_b32 v49, v4, v13, v49 bitop3:0xca
    v_mul_hi_u32_u24 v14, 429497, v50
    v_lshrrev_b32 v12, 3, v54
    v_cos_f32 v9, v9
    v_lshlrev_b16 v13, 3, v54
    v_mad_i32_i24 v11, v14, s55, v50
    v_bitop3_b32 v12, v6, v13, v12 bitop3:0xca
    v_lshl_add_u32 v11, v11, 17, s40
    v_lshlrev_b16 v14, 8, v14
    v_lshrrev_b32 v13, 2, v54
    v_add_u32 v50, v12, v11
    v_bitop3_b32 v54, v5, v13, v14 bitop3:0xea
    ds_add_u32 v54, v2
    v_mul_hi_u32_u24 v14, 429497, v51
    v_lshrrev_b32 v12, 3, v55
    v_cos_f32 v10, v10
    v_lshlrev_b16 v13, 3, v55
    v_mad_i32_i24 v11, v14, s55, v51
    v_bitop3_b32 v12, v6, v13, v12 bitop3:0xca
    v_lshl_add_u32 v11, v11, 17, s40
    v_lshlrev_b16 v14, 8, v14
    v_lshrrev_b32 v13, 2, v55
    v_add_u32 v51, v12, v11
    v_bitop3_b32 v55, v5, v13, v14 bitop3:0xea
    ds_add_u32 v55, v2
    v_cvt_pk_bf16_f32 v47, v9, v10
    v_perm_b32 v12, v47, v47, s41
    v_bitop3_b32 v50, v4, v12, v50 bitop3:0xca
    v_perm_b32 v13, v47, v47, s42
    v_bitop3_b32 v51, v4, v13, v51 bitop3:0xca
    s_setprio 1
    s_add_u32 s46, s99, 0x1c00000
    v_lshlrev_b32 v88, 1, v1
    buffer_load_dwordx4 v[88:91], v88, s[8:11], s46 offen nt
    s_add_u32 s47, s99, 0x1c00000
    v_lshlrev_b32 v92, 1, v1
    buffer_load_dwordx4 v[92:95], v92, s[12:15], s47 offen nt
    s_waitcnt vmcnt(8)
    v_lshlrev_b32 v7, 16, v64
    v_and_b32 v8, 0xffff0000, v64
    v_lshlrev_b32 v9, 16, v65
    v_and_b32 v10, 0xffff0000, v65
    v_mul_f32 v7, 0.15915494, v7
    v_mul_f32 v8, 0.15915494, v8
    v_mul_f32 v9, 0.15915494, v9
    v_mul_f32 v10, 0.15915494, v10
    v_mul_hi_u32_u24 v14, 429497, v56
    v_lshrrev_b32 v12, 3, v60
    v_cos_f32 v7, v7
    v_lshlrev_b16 v13, 3, v60
    v_mad_i32_i24 v11, v14, s55, v56
    v_bitop3_b32 v12, v6, v13, v12 bitop3:0xca
    v_lshl_add_u32 v11, v11, 17, s40
    v_lshlrev_b16 v14, 8, v14
    v_lshrrev_b32 v13, 2, v60
    v_add_u32 v56, v12, v11
    v_bitop3_b32 v60, v5, v13, v14 bitop3:0xea
    ds_add_u32 v60, v2
    v_mul_hi_u32_u24 v14, 429497, v57
    v_lshrrev_b32 v12, 3, v61
    v_cos_f32 v8, v8
    v_lshlrev_b16 v13, 3, v61
    v_mad_i32_i24 v11, v14, s55, v57
    v_bitop3_b32 v12, v6, v13, v12 bitop3:0xca
    v_lshl_add_u32 v11, v11, 17, s40
    v_lshlrev_b16 v14, 8, v14
    v_lshrrev_b32 v13, 2, v61
    v_add_u32 v57, v12, v11
    v_bitop3_b32 v61, v5, v13, v14 bitop3:0xea
    ds_add_u32 v61, v2
    v_cvt_pk_bf16_f32 v64, v7, v8
    v_perm_b32 v12, v64, v64, s41
    v_bitop3_b32 v56, v4, v12, v56 bitop3:0xca
    v_perm_b32 v13, v64, v64, s42
    v_bitop3_b32 v57, v4, v13, v57 bitop3:0xca
    v_mul_hi_u32_u24 v14, 429497, v58
    v_lshrrev_b32 v12, 3, v62
    v_cos_f32 v9, v9
    v_lshlrev_b16 v13, 3, v62
    v_mad_i32_i24 v11, v14, s55, v58
    v_bitop3_b32 v12, v6, v13, v12 bitop3:0xca
    v_lshl_add_u32 v11, v11, 17, s40
    v_lshlrev_b16 v14, 8, v14
    v_lshrrev_b32 v13, 2, v62
    v_add_u32 v58, v12, v11
    v_bitop3_b32 v62, v5, v13, v14 bitop3:0xea
    ds_add_u32 v62, v2
    v_mul_hi_u32_u24 v14, 429497, v59
    v_lshrrev_b32 v12, 3, v63
    v_cos_f32 v10, v10
    v_lshlrev_b16 v13, 3, v63
    v_mad_i32_i24 v11, v14, s55, v59
    v_bitop3_b32 v12, v6, v13, v12 bitop3:0xca
    v_lshl_add_u32 v11, v11, 17, s40
    v_lshlrev_b16 v14, 8, v14
    v_lshrrev_b32 v13, 2, v63
    v_add_u32 v59, v12, v11
    v_bitop3_b32 v63, v5, v13, v14 bitop3:0xea
    ds_add_u32 v63, v2
    v_cvt_pk_bf16_f32 v65, v9, v10
    v_perm_b32 v12, v65, v65, s41
    v_bitop3_b32 v58, v4, v12, v58 bitop3:0xca
    v_perm_b32 v13, v65, v65, s42
    v_bitop3_b32 v59, v4, v13, v59 bitop3:0xca
    s_add_u32 s44, s96, 0x2000000
    v_lshlrev_b32 v96, 1, v1
    buffer_load_dwordx4 v[96:99], v96, s[8:11], s44 offen nt
    s_add_u32 s45, s96, 0x2000000
    v_lshlrev_b32 v104, 1, v1
    buffer_load_dwordx4 v[104:107], v104, s[12:15], s45 offen nt
    s_add_u32 s46, s96, 0x2000000
    s_lshr_b32 s46, s46, 1
    buffer_load_dwordx2 v[108:109], v1, s[16:19], s46 offen nt
    s_add_u32 s47, s97, 0x2400000
    s_lshr_b32 s47, s47, 1
    buffer_load_dwordx2 v[110:111], v1, s[16:19], s47 offen nt
    s_waitcnt vmcnt(10)
    v_lshlrev_b32 v7, 16, v66
    v_and_b32 v8, 0xffff0000, v66
    v_lshlrev_b32 v9, 16, v67
    v_and_b32 v10, 0xffff0000, v67
    v_mul_f32 v7, 0.15915494, v7
    v_mul_f32 v8, 0.15915494, v8
    v_mul_f32 v9, 0.15915494, v9
    v_mul_f32 v10, 0.15915494, v10
    v_mul_hi_u32_u24 v14, 429497, v68
    v_lshrrev_b32 v12, 3, v72
    v_cos_f32 v7, v7
    v_lshlrev_b16 v13, 3, v72
    v_mad_i32_i24 v11, v14, s55, v68
    v_bitop3_b32 v12, v6, v13, v12 bitop3:0xca
    v_lshl_add_u32 v11, v11, 17, s40
    v_lshlrev_b16 v14, 8, v14
    v_lshrrev_b32 v13, 2, v72
    v_add_u32 v68, v12, v11
    v_bitop3_b32 v72, v5, v13, v14 bitop3:0xea
    ds_add_u32 v72, v2
    v_mul_hi_u32_u24 v14, 429497, v69
    v_lshrrev_b32 v12, 3, v73
    v_cos_f32 v8, v8
    v_lshlrev_b16 v13, 3, v73
    v_mad_i32_i24 v11, v14, s55, v69
    v_bitop3_b32 v12, v6, v13, v12 bitop3:0xca
    v_lshl_add_u32 v11, v11, 17, s40
    v_lshlrev_b16 v14, 8, v14
    v_lshrrev_b32 v13, 2, v73
    v_add_u32 v69, v12, v11
    v_bitop3_b32 v73, v5, v13, v14 bitop3:0xea
    ds_add_u32 v73, v2
    v_cvt_pk_bf16_f32 v66, v7, v8
    v_perm_b32 v12, v66, v66, s41
    v_bitop3_b32 v68, v4, v12, v68 bitop3:0xca
    v_perm_b32 v13, v66, v66, s42
    v_bitop3_b32 v69, v4, v13, v69 bitop3:0xca
    v_mul_hi_u32_u24 v14, 429497, v70
    v_lshrrev_b32 v12, 3, v74
    v_cos_f32 v9, v9
    v_lshlrev_b16 v13, 3, v74
    v_mad_i32_i24 v11, v14, s55, v70
    v_bitop3_b32 v12, v6, v13, v12 bitop3:0xca
    v_lshl_add_u32 v11, v11, 17, s40
    v_lshlrev_b16 v14, 8, v14
    v_lshrrev_b32 v13, 2, v74
    v_add_u32 v70, v12, v11
    v_bitop3_b32 v74, v5, v13, v14 bitop3:0xea
    ds_add_u32 v74, v2
    v_mul_hi_u32_u24 v14, 429497, v71
    v_lshrrev_b32 v12, 3, v75
    v_cos_f32 v10, v10
    v_lshlrev_b16 v13, 3, v75
    v_mad_i32_i24 v11, v14, s55, v71
    v_bitop3_b32 v12, v6, v13, v12 bitop3:0xca
    v_lshl_add_u32 v11, v11, 17, s40
    v_lshlrev_b16 v14, 8, v14
    v_lshrrev_b32 v13, 2, v75
    v_add_u32 v71, v12, v11
    v_bitop3_b32 v75, v5, v13, v14 bitop3:0xea
    ds_add_u32 v75, v2
    v_cvt_pk_bf16_f32 v67, v9, v10
    v_perm_b32 v12, v67, v67, s41
    v_bitop3_b32 v70, v4, v12, v70 bitop3:0xca
    v_perm_b32 v13, v67, v67, s42
    v_bitop3_b32 v71, v4, v13, v71 bitop3:0xca
    s_setprio 0
    s_add_u32 s44, s97, 0x2400000
    v_lshlrev_b32 v112, 1, v1
    buffer_load_dwordx4 v[112:115], v112, s[8:11], s44 offen nt
    s_waitcnt vmcnt(7)
    v_lshlrev_b32 v7, 16, v84
    v_and_b32 v8, 0xffff0000, v84
    v_lshlrev_b32 v9, 16, v85
    v_and_b32 v10, 0xffff0000, v85
    v_mul_f32 v7, 0.15915494, v7
    v_mul_f32 v8, 0.15915494, v8
    v_mul_f32 v9, 0.15915494, v9
    v_mul_f32 v10, 0.15915494, v10
    v_mul_hi_u32_u24 v14, 429497, v76
    v_lshrrev_b32 v12, 3, v80
    v_cos_f32 v7, v7
    v_lshlrev_b16 v13, 3, v80
    v_mad_i32_i24 v11, v14, s55, v76
    v_bitop3_b32 v12, v6, v13, v12 bitop3:0xca
    v_lshl_add_u32 v11, v11, 17, s40
    v_lshlrev_b16 v14, 8, v14
    v_lshrrev_b32 v13, 2, v80
    v_add_u32 v76, v12, v11
    v_bitop3_b32 v80, v5, v13, v14 bitop3:0xea
    ds_add_u32 v80, v2
    v_mul_hi_u32_u24 v14, 429497, v77
    v_lshrrev_b32 v12, 3, v81
    v_cos_f32 v8, v8
    v_lshlrev_b16 v13, 3, v81
    v_mad_i32_i24 v11, v14, s55, v77
    v_bitop3_b32 v12, v6, v13, v12 bitop3:0xca
    v_lshl_add_u32 v11, v11, 17, s40
    v_lshlrev_b16 v14, 8, v14
    v_lshrrev_b32 v13, 2, v81
    v_add_u32 v77, v12, v11
    v_bitop3_b32 v81, v5, v13, v14 bitop3:0xea
    ds_add_u32 v81, v2
    v_cvt_pk_bf16_f32 v84, v7, v8
    v_perm_b32 v12, v84, v84, s41
    v_bitop3_b32 v76, v4, v12, v76 bitop3:0xca
    v_perm_b32 v13, v84, v84, s42
    v_bitop3_b32 v77, v4, v13, v77 bitop3:0xca
    v_mul_hi_u32_u24 v14, 429497, v78
    v_lshrrev_b32 v12, 3, v82
    v_cos_f32 v9, v9
    v_lshlrev_b16 v13, 3, v82
    v_mad_i32_i24 v11, v14, s55, v78
    v_bitop3_b32 v12, v6, v13, v12 bitop3:0xca
    v_lshl_add_u32 v11, v11, 17, s40
    v_lshlrev_b16 v14, 8, v14
    v_lshrrev_b32 v13, 2, v82
    v_add_u32 v78, v12, v11
    v_bitop3_b32 v82, v5, v13, v14 bitop3:0xea
    ds_add_u32 v82, v2
    v_mul_hi_u32_u24 v14, 429497, v79
    v_lshrrev_b32 v12, 3, v83
    v_cos_f32 v10, v10
    v_lshlrev_b16 v13, 3, v83
    v_mad_i32_i24 v11, v14, s55, v79
    v_bitop3_b32 v12, v6, v13, v12 bitop3:0xca
    v_lshl_add_u32 v11, v11, 17, s40
    v_lshlrev_b16 v14, 8, v14
    v_lshrrev_b32 v13, 2, v83
    v_add_u32 v79, v12, v11
    v_bitop3_b32 v83, v5, v13, v14 bitop3:0xea
    ds_add_u32 v83, v2
    v_cvt_pk_bf16_f32 v85, v9, v10
    v_perm_b32 v12, v85, v85, s41
    v_bitop3_b32 v78, v4, v12, v78 bitop3:0xca
    v_perm_b32 v13, v85, v85, s42
    v_bitop3_b32 v79, v4, v13, v79 bitop3:0xca
    s_waitcnt vmcnt(5)
    v_lshlrev_b32 v7, 16, v86
    v_and_b32 v8, 0xffff0000, v86
    v_lshlrev_b32 v9, 16, v87
    v_and_b32 v10, 0xffff0000, v87
    v_mul_f32 v7, 0.15915494, v7
    v_mul_f32 v8, 0.15915494, v8
    v_mul_f32 v9, 0.15915494, v9
    v_mul_f32 v10, 0.15915494, v10
    v_mul_hi_u32_u24 v14, 429497, v88
    v_lshrrev_b32 v12, 3, v92
    v_cos_f32 v7, v7
    v_lshlrev_b16 v13, 3, v92
    v_mad_i32_i24 v11, v14, s55, v88
    v_bitop3_b32 v12, v6, v13, v12 bitop3:0xca
    v_lshl_add_u32 v11, v11, 17, s40
    v_lshlrev_b16 v14, 8, v14
    v_lshrrev_b32 v13, 2, v92
    v_add_u32 v88, v12, v11
    v_bitop3_b32 v92, v5, v13, v14 bitop3:0xea
    ds_add_u32 v92, v2
    v_mul_hi_u32_u24 v14, 429497, v89
    v_lshrrev_b32 v12, 3, v93
    v_cos_f32 v8, v8
    v_lshlrev_b16 v13, 3, v93
    v_mad_i32_i24 v11, v14, s55, v89
    v_bitop3_b32 v12, v6, v13, v12 bitop3:0xca
    v_lshl_add_u32 v11, v11, 17, s40
    v_lshlrev_b16 v14, 8, v14
    v_lshrrev_b32 v13, 2, v93
    v_add_u32 v89, v12, v11
    v_bitop3_b32 v93, v5, v13, v14 bitop3:0xea
    ds_add_u32 v93, v2
    v_cvt_pk_bf16_f32 v86, v7, v8
    v_perm_b32 v12, v86, v86, s41
    v_bitop3_b32 v88, v4, v12, v88 bitop3:0xca
    v_perm_b32 v13, v86, v86, s42
    v_bitop3_b32 v89, v4, v13, v89 bitop3:0xca
    v_mul_hi_u32_u24 v14, 429497, v90
    v_lshrrev_b32 v12, 3, v94
    v_cos_f32 v9, v9
    v_lshlrev_b16 v13, 3, v94
    v_mad_i32_i24 v11, v14, s55, v90
    v_bitop3_b32 v12, v6, v13, v12 bitop3:0xca
    v_lshl_add_u32 v11, v11, 17, s40
    v_lshlrev_b16 v14, 8, v14
    v_lshrrev_b32 v13, 2, v94
    v_add_u32 v90, v12, v11
    v_bitop3_b32 v94, v5, v13, v14 bitop3:0xea
    ds_add_u32 v94, v2
    v_mul_hi_u32_u24 v14, 429497, v91
    v_lshrrev_b32 v12, 3, v95
    v_cos_f32 v10, v10
    v_lshlrev_b16 v13, 3, v95
    v_mad_i32_i24 v11, v14, s55, v91
    v_bitop3_b32 v12, v6, v13, v12 bitop3:0xca
    v_lshl_add_u32 v11, v11, 17, s40
    v_lshlrev_b16 v14, 8, v14
    v_lshrrev_b32 v13, 2, v95
    v_add_u32 v91, v12, v11
    v_bitop3_b32 v95, v5, v13, v14 bitop3:0xea
    ds_add_u32 v95, v2
    v_cvt_pk_bf16_f32 v87, v9, v10
    v_perm_b32 v12, v87, v87, s41
    v_bitop3_b32 v90, v4, v12, v90 bitop3:0xca
    v_perm_b32 v13, v87, v87, s42
    v_bitop3_b32 v91, v4, v13, v91 bitop3:0xca
    v_lshrrev_b32 v8, 2, v0
    v_and_b32 v7, 0x3c00, v0
    v_bitop3_b32 v7, v5, v8, v7 bitop3:0xea
    s_waitcnt lgkmcnt(0)
    s_barrier
    ds_read2st64_b32 v[8:9], v7 offset0:0 offset1:1
    ds_read2st64_b32 v[10:11], v7 offset0:2 offset1:3
    s_add_u32 s45, s97, 0x2400000
    v_lshlrev_b32 v100, 1, v1
    buffer_load_dwordx4 v[100:103], v100, s[12:15], s45 offen nt
    s_waitcnt lgkmcnt(0)
    v_lshl_or_b32 v12, v9, 16, v8
    v_lshl_or_b32 v13, v11, 16, v10
    v_mov_b32 v14, v12
    v_mov_b32 v15, v13
    s_nop 0
    v_add_u32_dpp v14, v14, v14 row_shr:1 row_mask:0xf bank_mask:0xf bound_ctrl:1
    v_add_u32_dpp v15, v15, v15 row_shr:1 row_mask:0xf bank_mask:0xf bound_ctrl:1
    s_nop 0
    v_add_u32_dpp v14, v14, v14 row_shr:2 row_mask:0xf bank_mask:0xf bound_ctrl:1
    v_add_u32_dpp v15, v15, v15 row_shr:2 row_mask:0xf bank_mask:0xf bound_ctrl:1
    s_nop 0
    v_add_u32_dpp v14, v14, v14 row_shr:4 row_mask:0xf bank_mask:0xf bound_ctrl:1
    v_add_u32_dpp v15, v15, v15 row_shr:4 row_mask:0xf bank_mask:0xf bound_ctrl:1
    s_nop 0
    v_add_u32_dpp v14, v14, v14 row_shr:8 row_mask:0xf bank_mask:0xf bound_ctrl:1
    v_add_u32_dpp v15, v15, v15 row_shr:8 row_mask:0xf bank_mask:0xf bound_ctrl:1
    s_nop 0
    v_add_u32_dpp v14, v14, v14 row_bcast:15 row_mask:0xa bank_mask:0xf
    v_add_u32_dpp v15, v15, v15 row_bcast:15 row_mask:0xa bank_mask:0xf
    s_nop 0
    v_add_u32_dpp v14, v14, v14 row_bcast:31 row_mask:0xc bank_mask:0xf
    v_add_u32_dpp v15, v15, v15 row_bcast:31 row_mask:0xc bank_mask:0xf
    v_readlane_b32 s48, v14, 63
    v_readlane_b32 s49, v15, 63
    s_lshl_b32 s54, s32, 2
    v_mov_b32 v8, s54
    s_and_b32 s50, s48, 0xffff
    s_lshr_b32 s51, s48, 16
    s_and_b32 s52, s49, 0xffff
    s_lshr_b32 s53, s49, 16
    s_add_u32 s51, s51, s50
    s_add_u32 s52, s52, s51
    s_add_u32 s53, s53, s52
    v_mov_b32 v9, s53
    s_mov_b64 exec, 1
    ds_write_b32 v8, v9 offset:16384
    s_mov_b64 exec, -1
    v_and_b32 v8, 60, v7
    s_waitcnt lgkmcnt(0)
    s_barrier
    ds_read_b32 v9, v8 offset:16384
    s_waitcnt lgkmcnt(0)
    v_add_u32_dpp v9, v9, v9 row_shr:1 row_mask:0xf bank_mask:0xf bound_ctrl:1
    s_nop 1
    v_add_u32_dpp v9, v9, v9 row_shr:2 row_mask:0xf bank_mask:0xf bound_ctrl:1
    s_nop 1
    v_add_u32_dpp v9, v9, v9 row_shr:4 row_mask:0xf bank_mask:0xf bound_ctrl:1
    s_nop 1
    v_add_u32_dpp v9, v9, v9 row_shr:8 row_mask:0xf bank_mask:0xf bound_ctrl:1
    s_nop 0
    v_readlane_b32 s54, v9, s32
    s_sub_u32 s54, s54, s53
    s_add_u32 s50, s50, s54
    s_add_u32 s51, s51, s54
    s_add_u32 s52, s52, s54
    s_pack_ll_b32_b16 s48, s54, s50
    s_pack_ll_b32_b16 s49, s51, s52
    v_add_u32 v14, s48, v14
    v_add_u32 v15, s49, v15
    v_sub_u32 v12, v14, v12
    v_sub_u32 v13, v15, v13
    v_and_b32 v8, 0xffff, v12
    v_lshrrev_b32 v9, 16, v12
    v_and_b32 v10, 0xffff, v13
    v_lshrrev_b32 v11, 16, v13
    ds_write2st64_b32 v7, v8, v9 offset0:0 offset1:1
    ds_write2st64_b32 v7, v10, v11 offset0:2 offset1:3
    v_and_b32 v8, 0x3f0, v0
    v_lshl_add_u32 v8, v8, 1, s36
    ds_write_b64 v8, v[12:13] offset:20480
    s_bitset0_b64 exec, 63
    s_not_b64 exec, exec
    ds_write_b64 v8, v[14:15] offset:20512
    s_mov_b64 exec, -1
    s_waitcnt lgkmcnt(0)
    s_barrier
    s_setprio 3
    ds_add_rtn_u32 v20, v20, v2
    ds_add_rtn_u32 v21, v21, v2
    ds_add_rtn_u32 v22, v22, v2
    ds_add_rtn_u32 v23, v23, v2
    ds_read_b128 v[12:15], v0 offset:20480
    v_cmp_gt_u32 vcc, 8448, v0
    ds_add_rtn_u32 v32, v32, v2
    ds_add_rtn_u32 v33, v33, v2
    ds_add_rtn_u32 v34, v34, v2
    ds_add_rtn_u32 v35, v35, v2
    s_setprio 2
    ds_add_rtn_u32 v40, v40, v2
    ds_add_rtn_u32 v41, v41, v2
    ds_add_rtn_u32 v42, v42, v2
    ds_add_rtn_u32 v43, v43, v2
    s_waitcnt lgkmcnt(8)
    s_cbranch_vccz L1_p1
    s_add_u32 s46, s35, 0x0
    s_mov_b64 exec, vcc
    buffer_store_dwordx4 v[12:15], v0, s[24:27], s46 offen sc1
    s_mov_b64 exec, -1
L1_p1:
    s_add_u32 s47, s98, 0x2800000
    v_lshlrev_b32 v116, 1, v1
    buffer_load_dwordx4 v[116:119], v116, s[8:11], s47 offen nt
    ds_add_rtn_u32 v52, v52, v2
    ds_add_rtn_u32 v53, v53, v2
    ds_add_rtn_u32 v54, v54, v2
    ds_add_rtn_u32 v55, v55, v2
    s_setprio 1
    ds_add_rtn_u32 v60, v60, v2
    ds_add_rtn_u32 v61, v61, v2
    ds_add_rtn_u32 v62, v62, v2
    ds_add_rtn_u32 v63, v63, v2
    ds_add_rtn_u32 v72, v72, v2
    ds_add_rtn_u32 v73, v73, v2
    ds_add_rtn_u32 v74, v74, v2
    ds_add_rtn_u32 v75, v75, v2
    s_add_u32 s44, s98, 0x2800000
    v_lshlrev_b32 v120, 1, v1
    buffer_load_dwordx4 v[120:123], v120, s[12:15], s44 offen nt
    s_setprio 0
    ds_add_rtn_u32 v80, v80, v2
    ds_add_rtn_u32 v81, v81, v2
    ds_add_rtn_u32 v82, v82, v2
    ds_add_rtn_u32 v83, v83, v2
    ds_add_rtn_u32 v92, v92, v2
    ds_add_rtn_u32 v93, v93, v2
    ds_add_rtn_u32 v94, v94, v2
    ds_add_rtn_u32 v95, v95, v2
    s_waitcnt lgkmcnt(0)
    s_barrier
    s_setprio 3
    v_and_b32 v7, -4, v20
    v_lshl_add_u32 v8, v20, 2, v7
    ds_write_b32 v8, v16
    v_lshl_add_u32 v7, v7, 2, v20
    ds_write_b8 v7, v24 offset:16
    v_and_b32 v9, -4, v21
    v_lshl_add_u32 v10, v21, 2, v9
    ds_write_b32 v10, v17
    v_lshl_add_u32 v9, v9, 2, v21
    ds_write_b8_d16_hi v9, v24 offset:16
    v_and_b32 v7, -4, v22
    v_lshl_add_u32 v8, v22, 2, v7
    ds_write_b32 v8, v18
    v_lshl_add_u32 v7, v7, 2, v22
    ds_write_b8 v7, v25 offset:16
    v_and_b32 v9, -4, v23
    v_lshl_add_u32 v10, v23, 2, v9
    ds_write_b32 v10, v19
    v_lshl_add_u32 v9, v9, 2, v23
    ds_write_b8_d16_hi v9, v25 offset:16
    s_add_u32 s45, s98, 0x2800000
    s_lshr_b32 s45, s45, 1
    buffer_load_dwordx2 v[124:125], v1, s[16:19], s45 offen nt
    s_add_u32 s46, s99, 0x2c00000
    s_lshr_b32 s46, s46, 1
    buffer_load_dwordx2 v[126:127], v1, s[16:19], s46 offen nt
    s_add_u32 s47, s99, 0x2c00000
    v_lshlrev_b32 v16, 1, v1
    buffer_load_dwordx4 v[16:19], v16, s[8:11], s47 offen nt
    v_and_b32 v7, -4, v32
    v_lshl_add_u32 v8, v32, 2, v7
    ds_write_b32 v8, v28
    v_lshl_add_u32 v7, v7, 2, v32
    ds_write_b8 v7, v26 offset:16
    v_and_b32 v9, -4, v33
    v_lshl_add_u32 v10, v33, 2, v9
    ds_write_b32 v10, v29
    v_lshl_add_u32 v9, v9, 2, v33
    ds_write_b8_d16_hi v9, v26 offset:16
    v_and_b32 v7, -4, v34
    v_lshl_add_u32 v8, v34, 2, v7
    ds_write_b32 v8, v30
    v_lshl_add_u32 v7, v7, 2, v34
    ds_write_b8 v7, v27 offset:16
    v_and_b32 v9, -4, v35
    v_lshl_add_u32 v10, v35, 2, v9
    ds_write_b32 v10, v31
    v_lshl_add_u32 v9, v9, 2, v35
    ds_write_b8_d16_hi v9, v27 offset:16
    s_add_u32 s44, s99, 0x2c00000
    v_lshlrev_b32 v20, 1, v1
    buffer_load_dwordx4 v[20:23], v20, s[12:15], s44 offen nt
    s_setprio 2
    v_and_b32 v7, -4, v40
    v_lshl_add_u32 v8, v40, 2, v7
    ds_write_b32 v8, v36
    v_lshl_add_u32 v7, v7, 2, v40
    ds_write_b8 v7, v44 offset:16
    v_and_b32 v9, -4, v41
    v_lshl_add_u32 v10, v41, 2, v9
    ds_write_b32 v10, v37
    v_lshl_add_u32 v9, v9, 2, v41
    ds_write_b8_d16_hi v9, v44 offset:16
    v_and_b32 v7, -4, v42
    v_lshl_add_u32 v8, v42, 2, v7
    ds_write_b32 v8, v38
    v_lshl_add_u32 v7, v7, 2, v42
    ds_write_b8 v7, v45 offset:16
    v_and_b32 v9, -4, v43
    v_lshl_add_u32 v10, v43, 2, v9
    ds_write_b32 v10, v39
    v_lshl_add_u32 v9, v9, 2, v43
    ds_write_b8_d16_hi v9, v45 offset:16
    s_add_u32 s45, s96, 0x3000000
    v_lshlrev_b32 v28, 1, v1
    buffer_load_dwordx4 v[28:31], v28, s[8:11], s45 offen nt
    s_add_u32 s46, s96, 0x3000000
    v_lshlrev_b32 v32, 1, v1
    buffer_load_dwordx4 v[32:35], v32, s[12:15], s46 offen nt
    v_and_b32 v7, -4, v52
    v_lshl_add_u32 v8, v52, 2, v7
    ds_write_b32 v8, v48
    v_lshl_add_u32 v7, v7, 2, v52
    ds_write_b8 v7, v46 offset:16
    v_and_b32 v9, -4, v53
    v_lshl_add_u32 v10, v53, 2, v9
    ds_write_b32 v10, v49
    v_lshl_add_u32 v9, v9, 2, v53
    ds_write_b8_d16_hi v9, v46 offset:16
    v_and_b32 v7, -4, v54
    v_lshl_add_u32 v8, v54, 2, v7
    ds_write_b32 v8, v50
    v_lshl_add_u32 v7, v7, 2, v54
    ds_write_b8 v7, v47 offset:16
    v_and_b32 v9, -4, v55
    v_lshl_add_u32 v10, v55, 2, v9
    ds_write_b32 v10, v51
    v_lshl_add_u32 v9, v9, 2, v55
    ds_write_b8_d16_hi v9, v47 offset:16
    s_add_u32 s47, s96, 0x3000000
    s_lshr_b32 s47, s47, 1
    buffer_load_dwordx2 v[24:25], v1, s[16:19], s47 offen nt
    s_add_u32 s44, s97, 0x3400000
    s_lshr_b32 s44, s44, 1
    buffer_load_dwordx2 v[26:27], v1, s[16:19], s44 offen nt
    s_setprio 1
    v_and_b32 v7, -4, v60
    v_lshl_add_u32 v8, v60, 2, v7
    ds_write_b32 v8, v56
    v_lshl_add_u32 v7, v7, 2, v60
    ds_write_b8 v7, v64 offset:16
    v_and_b32 v9, -4, v61
    v_lshl_add_u32 v10, v61, 2, v9
    ds_write_b32 v10, v57
    v_lshl_add_u32 v9, v9, 2, v61
    ds_write_b8_d16_hi v9, v64 offset:16
    v_and_b32 v7, -4, v62
    v_lshl_add_u32 v8, v62, 2, v7
    ds_write_b32 v8, v58
    v_lshl_add_u32 v7, v7, 2, v62
    ds_write_b8 v7, v65 offset:16
    v_and_b32 v9, -4, v63
    v_lshl_add_u32 v10, v63, 2, v9
    ds_write_b32 v10, v59
    v_lshl_add_u32 v9, v9, 2, v63
    ds_write_b8_d16_hi v9, v65 offset:16
    s_add_u32 s45, s97, 0x3400000
    v_lshlrev_b32 v36, 1, v1
    buffer_load_dwordx4 v[36:39], v36, s[8:11], s45 offen nt
    v_and_b32 v7, -4, v72
    v_lshl_add_u32 v8, v72, 2, v7
    ds_write_b32 v8, v68
    v_lshl_add_u32 v7, v7, 2, v72
    ds_write_b8 v7, v66 offset:16
    v_and_b32 v9, -4, v73
    v_lshl_add_u32 v10, v73, 2, v9
    ds_write_b32 v10, v69
    v_lshl_add_u32 v9, v9, 2, v73
    ds_write_b8_d16_hi v9, v66 offset:16
    v_and_b32 v7, -4, v74
    v_lshl_add_u32 v8, v74, 2, v7
    ds_write_b32 v8, v70
    v_lshl_add_u32 v7, v7, 2, v74
    ds_write_b8 v7, v67 offset:16
    v_and_b32 v9, -4, v75
    v_lshl_add_u32 v10, v75, 2, v9
    ds_write_b32 v10, v71
    v_lshl_add_u32 v9, v9, 2, v75
    ds_write_b8_d16_hi v9, v67 offset:16
    s_add_u32 s46, s97, 0x3400000
    v_lshlrev_b32 v40, 1, v1
    buffer_load_dwordx4 v[40:43], v40, s[12:15], s46 offen nt
    s_add_u32 s47, s98, 0x3800000
    v_lshlrev_b32 v48, 1, v1
    buffer_load_dwordx4 v[48:51], v48, s[8:11], s47 offen nt
    s_setprio 0
    v_and_b32 v7, -4, v80
    v_lshl_add_u32 v8, v80, 2, v7
    ds_write_b32 v8, v76
    v_lshl_add_u32 v7, v7, 2, v80
    ds_write_b8 v7, v84 offset:16
    v_and_b32 v9, -4, v81
    v_lshl_add_u32 v10, v81, 2, v9
    ds_write_b32 v10, v77
    v_lshl_add_u32 v9, v9, 2, v81
    ds_write_b8_d16_hi v9, v84 offset:16
    v_and_b32 v7, -4, v82
    v_lshl_add_u32 v8, v82, 2, v7
    ds_write_b32 v8, v78
    v_lshl_add_u32 v7, v7, 2, v82
    ds_write_b8 v7, v85 offset:16
    v_and_b32 v9, -4, v83
    v_lshl_add_u32 v10, v83, 2, v9
    ds_write_b32 v10, v79
    v_lshl_add_u32 v9, v9, 2, v83
    ds_write_b8_d16_hi v9, v85 offset:16
    s_add_u32 s44, s98, 0x3800000
    v_lshlrev_b32 v52, 1, v1
    buffer_load_dwordx4 v[52:55], v52, s[12:15], s44 offen nt
    v_and_b32 v7, -4, v92
    v_lshl_add_u32 v8, v92, 2, v7
    ds_write_b32 v8, v88
    v_lshl_add_u32 v7, v7, 2, v92
    ds_write_b8 v7, v86 offset:16
    v_and_b32 v9, -4, v93
    v_lshl_add_u32 v10, v93, 2, v9
    ds_write_b32 v10, v89
    v_lshl_add_u32 v9, v9, 2, v93
    ds_write_b8_d16_hi v9, v86 offset:16
    v_and_b32 v7, -4, v94
    v_lshl_add_u32 v8, v94, 2, v7
    ds_write_b32 v8, v90
    v_lshl_add_u32 v7, v7, 2, v94
    ds_write_b8 v7, v87 offset:16
    v_and_b32 v9, -4, v95
    v_lshl_add_u32 v10, v95, 2, v9
    ds_write_b32 v10, v91
    v_lshl_add_u32 v9, v9, 2, v95
    ds_write_b8_d16_hi v9, v87 offset:16
    s_add_u32 s45, s98, 0x3800000
    s_lshr_b32 s45, s45, 1
    buffer_load_dwordx2 v[44:45], v1, s[16:19], s45 offen nt
    s_add_u32 s46, s99, 0x3c00000
    s_lshr_b32 s46, s46, 1
    buffer_load_dwordx2 v[46:47], v1, s[16:19], s46 offen nt
    v_add_u32 v7, s72, v0
    v_add_u32 v12, s73, v0
    v_add_u32 v13, s85, v0
    v_add_u32 v14, s91, v0
    v_add_u32 v15, s93, v0
    s_min_i32 s3, s72, s73
    s_min_i32 s3, s3, s85
    s_min_i32 s3, s3, s91
    s_min_i32 s3, s3, s93
    v_add_u32 v3, s3, v0
    v_mov_b32 v8, 0
    v_mov_b32 v9, 0
    v_mov_b32 v10, 0
    v_mov_b32 v11, 0
    s_waitcnt lgkmcnt(0)
    s_barrier
    ds_read_b128 v[56:59], v7 offset:0
    ds_read_b128 v[60:63], v12 offset:0
    ds_read_b128 v[68:71], v13 offset:0
    ds_read_b128 v[72:75], v14 offset:0
    ds_read_b128 v[64:67], v15 offset:0
    ds_write_b128 v3, v[8:11]
    ds_read_b128 v[76:79], v7 offset:16384
    ds_read_b128 v[80:83], v12 offset:16384
    ds_read_b128 v[88:91], v13 offset:16384
    ds_read_b128 v[92:95], v14 offset:16384
    ds_read_b128 v[84:87], v15 offset:16384
    s_waitcnt lgkmcnt(0)
    s_barrier
    s_setprio 3
    s_add_u32 s47, s35, 0x4000
    s_add_u32 s47, s47, s72
    buffer_store_dwordx4 v[56:59], v0, s[20:23], s47 offen sc1
    s_add_u32 s44, s99, 0x3c00000
    s_nop 0
    v_lshlrev_b32 v56, 1, v1
    buffer_load_dwordx4 v[56:59], v56, s[8:11], s44 offen nt
    s_add_u32 s45, s35, 0x4000
    s_add_u32 s45, s45, s73
    buffer_store_dwordx4 v[60:63], v0, s[20:23], s45 offen sc1
    s_add_u32 s46, s99, 0x3c00000
    s_nop 0
    v_lshlrev_b32 v60, 1, v1
    buffer_load_dwordx4 v[60:63], v60, s[12:15], s46 offen nt
    s_waitcnt vmcnt(22)
    v_lshlrev_b32 v7, 16, v108
    v_and_b32 v8, 0xffff0000, v108
    v_lshlrev_b32 v9, 16, v109
    v_and_b32 v10, 0xffff0000, v109
    v_mul_f32 v7, 0.15915494, v7
    v_mul_f32 v8, 0.15915494, v8
    v_mul_f32 v9, 0.15915494, v9
    v_mul_f32 v10, 0.15915494, v10
    v_mul_hi_u32_u24 v14, 429497, v96
    v_lshrrev_b32 v12, 3, v104
    v_cos_f32 v7, v7
    v_lshlrev_b16 v13, 3, v104
    v_mad_i32_i24 v11, v14, s55, v96
    v_bitop3_b32 v12, v6, v13, v12 bitop3:0xca
    v_lshl_add_u32 v11, v11, 17, s40
    v_lshlrev_b16 v14, 8, v14
    v_lshrrev_b32 v13, 2, v104
    v_add_u32 v96, v12, v11
    v_bitop3_b32 v104, v5, v13, v14 bitop3:0xea
    ds_add_u32 v104, v2
    v_mul_hi_u32_u24 v14, 429497, v97
    v_lshrrev_b32 v12, 3, v105
    v_cos_f32 v8, v8
    v_lshlrev_b16 v13, 3, v105
    v_mad_i32_i24 v11, v14, s55, v97
    v_bitop3_b32 v12, v6, v13, v12 bitop3:0xca
    v_lshl_add_u32 v11, v11, 17, s40
    v_lshlrev_b16 v14, 8, v14
    v_lshrrev_b32 v13, 2, v105
    v_add_u32 v97, v12, v11
    v_bitop3_b32 v105, v5, v13, v14 bitop3:0xea
    ds_add_u32 v105, v2
    v_cvt_pk_bf16_f32 v108, v7, v8
    v_perm_b32 v12, v108, v108, s41
    v_bitop3_b32 v96, v4, v12, v96 bitop3:0xca
    v_perm_b32 v13, v108, v108, s42
    v_bitop3_b32 v97, v4, v13, v97 bitop3:0xca
    v_mul_hi_u32_u24 v14, 429497, v98
    v_lshrrev_b32 v12, 3, v106
    v_cos_f32 v9, v9
    v_lshlrev_b16 v13, 3, v106
    v_mad_i32_i24 v11, v14, s55, v98
    v_bitop3_b32 v12, v6, v13, v12 bitop3:0xca
    v_lshl_add_u32 v11, v11, 17, s40
    v_lshlrev_b16 v14, 8, v14
    v_lshrrev_b32 v13, 2, v106
    v_add_u32 v98, v12, v11
    v_bitop3_b32 v106, v5, v13, v14 bitop3:0xea
    ds_add_u32 v106, v2
    v_mul_hi_u32_u24 v14, 429497, v99
    v_lshrrev_b32 v12, 3, v107
    v_cos_f32 v10, v10
    v_lshlrev_b16 v13, 3, v107
    v_mad_i32_i24 v11, v14, s55, v99
    v_bitop3_b32 v12, v6, v13, v12 bitop3:0xca
    v_lshl_add_u32 v11, v11, 17, s40
    v_lshlrev_b16 v14, 8, v14
    v_lshrrev_b32 v13, 2, v107
    v_add_u32 v99, v12, v11
    v_bitop3_b32 v107, v5, v13, v14 bitop3:0xea
    ds_add_u32 v107, v2
    v_cvt_pk_bf16_f32 v109, v9, v10
    v_perm_b32 v12, v109, v109, s41
    v_bitop3_b32 v98, v4, v12, v98 bitop3:0xca
    v_perm_b32 v13, v109, v109, s42
    v_bitop3_b32 v99, v4, v13, v99 bitop3:0xca
    s_waitcnt vmcnt(20)
    v_lshlrev_b32 v7, 16, v110
    v_and_b32 v8, 0xffff0000, v110
    v_lshlrev_b32 v9, 16, v111
    v_and_b32 v10, 0xffff0000, v111
    v_mul_f32 v7, 0.15915494, v7
    v_mul_f32 v8, 0.15915494, v8
    v_mul_f32 v9, 0.15915494, v9
    v_mul_f32 v10, 0.15915494, v10
    v_mul_hi_u32_u24 v14, 429497, v112
    v_lshrrev_b32 v12, 3, v100
    v_cos_f32 v7, v7
    v_lshlrev_b16 v13, 3, v100
    v_mad_i32_i24 v11, v14, s55, v112
    v_bitop3_b32 v12, v6, v13, v12 bitop3:0xca
    v_lshl_add_u32 v11, v11, 17, s40
    v_lshlrev_b16 v14, 8, v14
    v_lshrrev_b32 v13, 2, v100
    v_add_u32 v112, v12, v11
    v_bitop3_b32 v100, v5, v13, v14 bitop3:0xea
    ds_add_u32 v100, v2
    v_mul_hi_u32_u24 v14, 429497, v113
    v_lshrrev_b32 v12, 3, v101
    v_cos_f32 v8, v8
    v_lshlrev_b16 v13, 3, v101
    v_mad_i32_i24 v11, v14, s55, v113
    v_bitop3_b32 v12, v6, v13, v12 bitop3:0xca
    v_lshl_add_u32 v11, v11, 17, s40
    v_lshlrev_b16 v14, 8, v14
    v_lshrrev_b32 v13, 2, v101
    v_add_u32 v113, v12, v11
    v_bitop3_b32 v101, v5, v13, v14 bitop3:0xea
    ds_add_u32 v101, v2
    v_cvt_pk_bf16_f32 v110, v7, v8
    v_perm_b32 v12, v110, v110, s41
    v_bitop3_b32 v112, v4, v12, v112 bitop3:0xca
    v_perm_b32 v13, v110, v110, s42
    v_bitop3_b32 v113, v4, v13, v113 bitop3:0xca
    v_mul_hi_u32_u24 v14, 429497, v114
    v_lshrrev_b32 v12, 3, v102
    v_cos_f32 v9, v9
    v_lshlrev_b16 v13, 3, v102
    v_mad_i32_i24 v11, v14, s55, v114
    v_bitop3_b32 v12, v6, v13, v12 bitop3:0xca
    v_lshl_add_u32 v11, v11, 17, s40
    v_lshlrev_b16 v14, 8, v14
    v_lshrrev_b32 v13, 2, v102
    v_add_u32 v114, v12, v11
    v_bitop3_b32 v102, v5, v13, v14 bitop3:0xea
    ds_add_u32 v102, v2
    v_mul_hi_u32_u24 v14, 429497, v115
    v_lshrrev_b32 v12, 3, v103
    v_cos_f32 v10, v10
    v_lshlrev_b16 v13, 3, v103
    v_mad_i32_i24 v11, v14, s55, v115
    v_bitop3_b32 v12, v6, v13, v12 bitop3:0xca
    v_lshl_add_u32 v11, v11, 17, s40
    v_lshlrev_b16 v14, 8, v14
    v_lshrrev_b32 v13, 2, v103
    v_add_u32 v115, v12, v11
    v_bitop3_b32 v103, v5, v13, v14 bitop3:0xea
    ds_add_u32 v103, v2
    v_cvt_pk_bf16_f32 v111, v9, v10
    v_perm_b32 v12, v111, v111, s41
    v_bitop3_b32 v114, v4, v12, v114 bitop3:0xca
    v_perm_b32 v13, v111, v111, s42
    v_bitop3_b32 v115, v4, v13, v115 bitop3:0xca
    s_setprio 2
    s_waitcnt vmcnt(16)
    v_lshlrev_b32 v7, 16, v124
    v_and_b32 v8, 0xffff0000, v124
    v_lshlrev_b32 v9, 16, v125
    v_and_b32 v10, 0xffff0000, v125
    v_mul_f32 v7, 0.15915494, v7
    v_mul_f32 v8, 0.15915494, v8
    v_mul_f32 v9, 0.15915494, v9
    v_mul_f32 v10, 0.15915494, v10
    v_mul_hi_u32_u24 v14, 429497, v116
    v_lshrrev_b32 v12, 3, v120
    v_cos_f32 v7, v7
    v_lshlrev_b16 v13, 3, v120
    v_mad_i32_i24 v11, v14, s55, v116
    v_bitop3_b32 v12, v6, v13, v12 bitop3:0xca
    v_lshl_add_u32 v11, v11, 17, s40
    v_lshlrev_b16 v14, 8, v14
    v_lshrrev_b32 v13, 2, v120
    v_add_u32 v116, v12, v11
    v_bitop3_b32 v120, v5, v13, v14 bitop3:0xea
    ds_add_u32 v120, v2
    v_mul_hi_u32_u24 v14, 429497, v117
    v_lshrrev_b32 v12, 3, v121
    v_cos_f32 v8, v8
    v_lshlrev_b16 v13, 3, v121
    v_mad_i32_i24 v11, v14, s55, v117
    v_bitop3_b32 v12, v6, v13, v12 bitop3:0xca
    v_lshl_add_u32 v11, v11, 17, s40
    v_lshlrev_b16 v14, 8, v14
    v_lshrrev_b32 v13, 2, v121
    v_add_u32 v117, v12, v11
    v_bitop3_b32 v121, v5, v13, v14 bitop3:0xea
    ds_add_u32 v121, v2
    v_cvt_pk_bf16_f32 v124, v7, v8
    v_perm_b32 v12, v124, v124, s41
    v_bitop3_b32 v116, v4, v12, v116 bitop3:0xca
    v_perm_b32 v13, v124, v124, s42
    v_bitop3_b32 v117, v4, v13, v117 bitop3:0xca
    v_mul_hi_u32_u24 v14, 429497, v118
    v_lshrrev_b32 v12, 3, v122
    v_cos_f32 v9, v9
    v_lshlrev_b16 v13, 3, v122
    v_mad_i32_i24 v11, v14, s55, v118
    v_bitop3_b32 v12, v6, v13, v12 bitop3:0xca
    v_lshl_add_u32 v11, v11, 17, s40
    v_lshlrev_b16 v14, 8, v14
    v_lshrrev_b32 v13, 2, v122
    v_add_u32 v118, v12, v11
    v_bitop3_b32 v122, v5, v13, v14 bitop3:0xea
    ds_add_u32 v122, v2
    v_mul_hi_u32_u24 v14, 429497, v119
    v_lshrrev_b32 v12, 3, v123
    v_cos_f32 v10, v10
    v_lshlrev_b16 v13, 3, v123
    v_mad_i32_i24 v11, v14, s55, v119
    v_bitop3_b32 v12, v6, v13, v12 bitop3:0xca
    v_lshl_add_u32 v11, v11, 17, s40
    v_lshlrev_b16 v14, 8, v14
    v_lshrrev_b32 v13, 2, v123
    v_add_u32 v119, v12, v11
    v_bitop3_b32 v123, v5, v13, v14 bitop3:0xea
    ds_add_u32 v123, v2
    v_cvt_pk_bf16_f32 v125, v9, v10
    v_perm_b32 v12, v125, v125, s41
    v_bitop3_b32 v118, v4, v12, v118 bitop3:0xca
    v_perm_b32 v13, v125, v125, s42
    v_bitop3_b32 v119, v4, v13, v119 bitop3:0xca
    s_add_u32 s47, s35, 0x4000
    s_add_u32 s47, s47, s85
    buffer_store_dwordx4 v[68:71], v0, s[20:23], s47 offen sc1
    s_add_u32 s44, s96, 0x4000000
    s_nop 0
    v_lshlrev_b32 v68, 1, v1
    buffer_load_dwordx4 v[68:71], v68, s[8:11], s44 offen nt
    s_waitcnt vmcnt(16)
    v_lshlrev_b32 v7, 16, v126
    v_and_b32 v8, 0xffff0000, v126
    v_lshlrev_b32 v9, 16, v127
    v_and_b32 v10, 0xffff0000, v127
    v_mul_f32 v7, 0.15915494, v7
    v_mul_f32 v8, 0.15915494, v8
    v_mul_f32 v9, 0.15915494, v9
    v_mul_f32 v10, 0.15915494, v10
    v_mul_hi_u32_u24 v14, 429497, v16
    v_lshrrev_b32 v12, 3, v20
    v_cos_f32 v7, v7
    v_lshlrev_b16 v13, 3, v20
    v_mad_i32_i24 v11, v14, s55, v16
    v_bitop3_b32 v12, v6, v13, v12 bitop3:0xca
    v_lshl_add_u32 v11, v11, 17, s40
    v_lshlrev_b16 v14, 8, v14
    v_lshrrev_b32 v13, 2, v20
    v_add_u32 v16, v12, v11
    v_bitop3_b32 v20, v5, v13, v14 bitop3:0xea
    ds_add_u32 v20, v2
    v_mul_hi_u32_u24 v14, 429497, v17
    v_lshrrev_b32 v12, 3, v21
    v_cos_f32 v8, v8
    v_lshlrev_b16 v13, 3, v21
    v_mad_i32_i24 v11, v14, s55, v17
    v_bitop3_b32 v12, v6, v13, v12 bitop3:0xca
    v_lshl_add_u32 v11, v11, 17, s40
    v_lshlrev_b16 v14, 8, v14
    v_lshrrev_b32 v13, 2, v21
    v_add_u32 v17, v12, v11
    v_bitop3_b32 v21, v5, v13, v14 bitop3:0xea
    ds_add_u32 v21, v2
    v_cvt_pk_bf16_f32 v126, v7, v8
    v_perm_b32 v12, v126, v126, s41
    v_bitop3_b32 v16, v4, v12, v16 bitop3:0xca
    v_perm_b32 v13, v126, v126, s42
    v_bitop3_b32 v17, v4, v13, v17 bitop3:0xca
    v_mul_hi_u32_u24 v14, 429497, v18
    v_lshrrev_b32 v12, 3, v22
    v_cos_f32 v9, v9
    v_lshlrev_b16 v13, 3, v22
    v_mad_i32_i24 v11, v14, s55, v18
    v_bitop3_b32 v12, v6, v13, v12 bitop3:0xca
    v_lshl_add_u32 v11, v11, 17, s40
    v_lshlrev_b16 v14, 8, v14
    v_lshrrev_b32 v13, 2, v22
    v_add_u32 v18, v12, v11
    v_bitop3_b32 v22, v5, v13, v14 bitop3:0xea
    ds_add_u32 v22, v2
    v_mul_hi_u32_u24 v14, 429497, v19
    v_lshrrev_b32 v12, 3, v23
    v_cos_f32 v10, v10
    v_lshlrev_b16 v13, 3, v23
    v_mad_i32_i24 v11, v14, s55, v19
    v_bitop3_b32 v12, v6, v13, v12 bitop3:0xca
    v_lshl_add_u32 v11, v11, 17, s40
    v_lshlrev_b16 v14, 8, v14
    v_lshrrev_b32 v13, 2, v23
    v_add_u32 v19, v12, v11
    v_bitop3_b32 v23, v5, v13, v14 bitop3:0xea
    ds_add_u32 v23, v2
    v_cvt_pk_bf16_f32 v127, v9, v10
    v_perm_b32 v12, v127, v127, s41
    v_bitop3_b32 v18, v4, v12, v18 bitop3:0xca
    v_perm_b32 v13, v127, v127, s42
    v_bitop3_b32 v19, v4, v13, v19 bitop3:0xca
    s_setprio 1
    s_waitcnt vmcnt(12)
    v_lshlrev_b32 v7, 16, v24
    v_and_b32 v8, 0xffff0000, v24
    v_lshlrev_b32 v9, 16, v25
    v_and_b32 v10, 0xffff0000, v25
    v_mul_f32 v7, 0.15915494, v7
    v_mul_f32 v8, 0.15915494, v8
    v_mul_f32 v9, 0.15915494, v9
    v_mul_f32 v10, 0.15915494, v10
    v_mul_hi_u32_u24 v14, 429497, v28
    v_lshrrev_b32 v12, 3, v32
    v_cos_f32 v7, v7
    v_lshlrev_b16 v13, 3, v32
    v_mad_i32_i24 v11, v14, s55, v28
    v_bitop3_b32 v12, v6, v13, v12 bitop3:0xca
    v_lshl_add_u32 v11, v11, 17, s40
    v_lshlrev_b16 v14, 8, v14
    v_lshrrev_b32 v13, 2, v32
    v_add_u32 v28, v12, v11
    v_bitop3_b32 v32, v5, v13, v14 bitop3:0xea
    ds_add_u32 v32, v2
    v_mul_hi_u32_u24 v14, 429497, v29
    v_lshrrev_b32 v12, 3, v33
    v_cos_f32 v8, v8
    v_lshlrev_b16 v13, 3, v33
    v_mad_i32_i24 v11, v14, s55, v29
    v_bitop3_b32 v12, v6, v13, v12 bitop3:0xca
    v_lshl_add_u32 v11, v11, 17, s40
    v_lshlrev_b16 v14, 8, v14
    v_lshrrev_b32 v13, 2, v33
    v_add_u32 v29, v12, v11
    v_bitop3_b32 v33, v5, v13, v14 bitop3:0xea
    ds_add_u32 v33, v2
    v_cvt_pk_bf16_f32 v24, v7, v8
    v_perm_b32 v12, v24, v24, s41
    v_bitop3_b32 v28, v4, v12, v28 bitop3:0xca
    v_perm_b32 v13, v24, v24, s42
    v_bitop3_b32 v29, v4, v13, v29 bitop3:0xca
    v_mul_hi_u32_u24 v14, 429497, v30
    v_lshrrev_b32 v12, 3, v34
    v_cos_f32 v9, v9
    v_lshlrev_b16 v13, 3, v34
    v_mad_i32_i24 v11, v14, s55, v30
    v_bitop3_b32 v12, v6, v13, v12 bitop3:0xca
    v_lshl_add_u32 v11, v11, 17, s40
    v_lshlrev_b16 v14, 8, v14
    v_lshrrev_b32 v13, 2, v34
    v_add_u32 v30, v12, v11
    v_bitop3_b32 v34, v5, v13, v14 bitop3:0xea
    ds_add_u32 v34, v2
    v_mul_hi_u32_u24 v14, 429497, v31
    v_lshrrev_b32 v12, 3, v35
    v_cos_f32 v10, v10
    v_lshlrev_b16 v13, 3, v35
    v_mad_i32_i24 v11, v14, s55, v31
    v_bitop3_b32 v12, v6, v13, v12 bitop3:0xca
    v_lshl_add_u32 v11, v11, 17, s40
    v_lshlrev_b16 v14, 8, v14
    v_lshrrev_b32 v13, 2, v35
    v_add_u32 v31, v12, v11
    v_bitop3_b32 v35, v5, v13, v14 bitop3:0xea
    ds_add_u32 v35, v2
    v_cvt_pk_bf16_f32 v25, v9, v10
    v_perm_b32 v12, v25, v25, s41
    v_bitop3_b32 v30, v4, v12, v30 bitop3:0xca
    v_perm_b32 v13, v25, v25, s42
    v_bitop3_b32 v31, v4, v13, v31 bitop3:0xca
    s_waitcnt vmcnt(10)
    v_lshlrev_b32 v7, 16, v26
    v_and_b32 v8, 0xffff0000, v26
    v_lshlrev_b32 v9, 16, v27
    v_and_b32 v10, 0xffff0000, v27
    v_mul_f32 v7, 0.15915494, v7
    v_mul_f32 v8, 0.15915494, v8
    v_mul_f32 v9, 0.15915494, v9
    v_mul_f32 v10, 0.15915494, v10
    v_mul_hi_u32_u24 v14, 429497, v36
    v_lshrrev_b32 v12, 3, v40
    v_cos_f32 v7, v7
    v_lshlrev_b16 v13, 3, v40
    v_mad_i32_i24 v11, v14, s55, v36
    v_bitop3_b32 v12, v6, v13, v12 bitop3:0xca
    v_lshl_add_u32 v11, v11, 17, s40
    v_lshlrev_b16 v14, 8, v14
    v_lshrrev_b32 v13, 2, v40
    v_add_u32 v36, v12, v11
    v_bitop3_b32 v40, v5, v13, v14 bitop3:0xea
    ds_add_u32 v40, v2
    v_mul_hi_u32_u24 v14, 429497, v37
    v_lshrrev_b32 v12, 3, v41
    v_cos_f32 v8, v8
    v_lshlrev_b16 v13, 3, v41
    v_mad_i32_i24 v11, v14, s55, v37
    v_bitop3_b32 v12, v6, v13, v12 bitop3:0xca
    v_lshl_add_u32 v11, v11, 17, s40
    v_lshlrev_b16 v14, 8, v14
    v_lshrrev_b32 v13, 2, v41
    v_add_u32 v37, v12, v11
    v_bitop3_b32 v41, v5, v13, v14 bitop3:0xea
    ds_add_u32 v41, v2
    v_cvt_pk_bf16_f32 v26, v7, v8
    v_perm_b32 v12, v26, v26, s41
    v_bitop3_b32 v36, v4, v12, v36 bitop3:0xca
    v_perm_b32 v13, v26, v26, s42
    v_bitop3_b32 v37, v4, v13, v37 bitop3:0xca
    v_mul_hi_u32_u24 v14, 429497, v38
    v_lshrrev_b32 v12, 3, v42
    v_cos_f32 v9, v9
    v_lshlrev_b16 v13, 3, v42
    v_mad_i32_i24 v11, v14, s55, v38
    v_bitop3_b32 v12, v6, v13, v12 bitop3:0xca
    v_lshl_add_u32 v11, v11, 17, s40
    v_lshlrev_b16 v14, 8, v14
    v_lshrrev_b32 v13, 2, v42
    v_add_u32 v38, v12, v11
    v_bitop3_b32 v42, v5, v13, v14 bitop3:0xea
    ds_add_u32 v42, v2
    v_mul_hi_u32_u24 v14, 429497, v39
    v_lshrrev_b32 v12, 3, v43
    v_cos_f32 v10, v10
    v_lshlrev_b16 v13, 3, v43
    v_mad_i32_i24 v11, v14, s55, v39
    v_bitop3_b32 v12, v6, v13, v12 bitop3:0xca
    v_lshl_add_u32 v11, v11, 17, s40
    v_lshlrev_b16 v14, 8, v14
    v_lshrrev_b32 v13, 2, v43
    v_add_u32 v39, v12, v11
    v_bitop3_b32 v43, v5, v13, v14 bitop3:0xea
    ds_add_u32 v43, v2
    v_cvt_pk_bf16_f32 v27, v9, v10
    v_perm_b32 v12, v27, v27, s41
    v_bitop3_b32 v38, v4, v12, v38 bitop3:0xca
    v_perm_b32 v13, v27, v27, s42
    v_bitop3_b32 v39, v4, v13, v39 bitop3:0xca
    s_setprio 0
    s_add_u32 s45, s35, 0x4000
    s_add_u32 s45, s45, s91
    buffer_store_dwordx4 v[72:75], v0, s[20:23], s45 offen sc1
    s_add_u32 s46, s96, 0x4000000
    s_nop 0
    v_lshlrev_b32 v72, 1, v1
    buffer_load_dwordx4 v[72:75], v72, s[12:15], s46 offen nt
    s_waitcnt vmcnt(8)
    v_lshlrev_b32 v7, 16, v44
    v_and_b32 v8, 0xffff0000, v44
    v_lshlrev_b32 v9, 16, v45
    v_and_b32 v10, 0xffff0000, v45
    v_mul_f32 v7, 0.15915494, v7
    v_mul_f32 v8, 0.15915494, v8
    v_mul_f32 v9, 0.15915494, v9
    v_mul_f32 v10, 0.15915494, v10
    v_mul_hi_u32_u24 v14, 429497, v48
    v_lshrrev_b32 v12, 3, v52
    v_cos_f32 v7, v7
    v_lshlrev_b16 v13, 3, v52
    v_mad_i32_i24 v11, v14, s55, v48
    v_bitop3_b32 v12, v6, v13, v12 bitop3:0xca
    v_lshl_add_u32 v11, v11, 17, s40
    v_lshlrev_b16 v14, 8, v14
    v_lshrrev_b32 v13, 2, v52
    v_add_u32 v48, v12, v11
    v_bitop3_b32 v52, v5, v13, v14 bitop3:0xea
    ds_add_u32 v52, v2
    v_mul_hi_u32_u24 v14, 429497, v49
    v_lshrrev_b32 v12, 3, v53
    v_cos_f32 v8, v8
    v_lshlrev_b16 v13, 3, v53
    v_mad_i32_i24 v11, v14, s55, v49
    v_bitop3_b32 v12, v6, v13, v12 bitop3:0xca
    v_lshl_add_u32 v11, v11, 17, s40
    v_lshlrev_b16 v14, 8, v14
    v_lshrrev_b32 v13, 2, v53
    v_add_u32 v49, v12, v11
    v_bitop3_b32 v53, v5, v13, v14 bitop3:0xea
    ds_add_u32 v53, v2
    v_cvt_pk_bf16_f32 v44, v7, v8
    v_perm_b32 v12, v44, v44, s41
    v_bitop3_b32 v48, v4, v12, v48 bitop3:0xca
    v_perm_b32 v13, v44, v44, s42
    v_bitop3_b32 v49, v4, v13, v49 bitop3:0xca
    v_mul_hi_u32_u24 v14, 429497, v50
    v_lshrrev_b32 v12, 3, v54
    v_cos_f32 v9, v9
    v_lshlrev_b16 v13, 3, v54
    v_mad_i32_i24 v11, v14, s55, v50
    v_bitop3_b32 v12, v6, v13, v12 bitop3:0xca
    v_lshl_add_u32 v11, v11, 17, s40
    v_lshlrev_b16 v14, 8, v14
    v_lshrrev_b32 v13, 2, v54
    v_add_u32 v50, v12, v11
    v_bitop3_b32 v54, v5, v13, v14 bitop3:0xea
    ds_add_u32 v54, v2
    v_mul_hi_u32_u24 v14, 429497, v51
    v_lshrrev_b32 v12, 3, v55
    v_cos_f32 v10, v10
    v_lshlrev_b16 v13, 3, v55
    v_mad_i32_i24 v11, v14, s55, v51
    v_bitop3_b32 v12, v6, v13, v12 bitop3:0xca
    v_lshl_add_u32 v11, v11, 17, s40
    v_lshlrev_b16 v14, 8, v14
    v_lshrrev_b32 v13, 2, v55
    v_add_u32 v51, v12, v11
    v_bitop3_b32 v55, v5, v13, v14 bitop3:0xea
    ds_add_u32 v55, v2
    v_cvt_pk_bf16_f32 v45, v9, v10
    v_perm_b32 v12, v45, v45, s41
    v_bitop3_b32 v50, v4, v12, v50 bitop3:0xca
    v_perm_b32 v13, v45, v45, s42
    v_bitop3_b32 v51, v4, v13, v51 bitop3:0xca
    s_waitcnt vmcnt(4)
    v_lshlrev_b32 v7, 16, v46
    v_and_b32 v8, 0xffff0000, v46
    v_lshlrev_b32 v9, 16, v47
    v_and_b32 v10, 0xffff0000, v47
    v_mul_f32 v7, 0.15915494, v7
    v_mul_f32 v8, 0.15915494, v8
    v_mul_f32 v9, 0.15915494, v9
    v_mul_f32 v10, 0.15915494, v10
    v_mul_hi_u32_u24 v14, 429497, v56
    v_lshrrev_b32 v12, 3, v60
    v_cos_f32 v7, v7
    v_lshlrev_b16 v13, 3, v60
    v_mad_i32_i24 v11, v14, s55, v56
    v_bitop3_b32 v12, v6, v13, v12 bitop3:0xca
    v_lshl_add_u32 v11, v11, 17, s40
    v_lshlrev_b16 v14, 8, v14
    v_lshrrev_b32 v13, 2, v60
    v_add_u32 v56, v12, v11
    v_bitop3_b32 v60, v5, v13, v14 bitop3:0xea
    ds_add_u32 v60, v2
    v_mul_hi_u32_u24 v14, 429497, v57
    v_lshrrev_b32 v12, 3, v61
    v_cos_f32 v8, v8
    v_lshlrev_b16 v13, 3, v61
    v_mad_i32_i24 v11, v14, s55, v57
    v_bitop3_b32 v12, v6, v13, v12 bitop3:0xca
    v_lshl_add_u32 v11, v11, 17, s40
    v_lshlrev_b16 v14, 8, v14
    v_lshrrev_b32 v13, 2, v61
    v_add_u32 v57, v12, v11
    v_bitop3_b32 v61, v5, v13, v14 bitop3:0xea
    ds_add_u32 v61, v2
    v_cvt_pk_bf16_f32 v46, v7, v8
    v_perm_b32 v12, v46, v46, s41
    v_bitop3_b32 v56, v4, v12, v56 bitop3:0xca
    v_perm_b32 v13, v46, v46, s42
    v_bitop3_b32 v57, v4, v13, v57 bitop3:0xca
    v_mul_hi_u32_u24 v14, 429497, v58
    v_lshrrev_b32 v12, 3, v62
    v_cos_f32 v9, v9
    v_lshlrev_b16 v13, 3, v62
    v_mad_i32_i24 v11, v14, s55, v58
    v_bitop3_b32 v12, v6, v13, v12 bitop3:0xca
    v_lshl_add_u32 v11, v11, 17, s40
    v_lshlrev_b16 v14, 8, v14
    v_lshrrev_b32 v13, 2, v62
    v_add_u32 v58, v12, v11
    v_bitop3_b32 v62, v5, v13, v14 bitop3:0xea
    ds_add_u32 v62, v2
    v_mul_hi_u32_u24 v14, 429497, v59
    v_lshrrev_b32 v12, 3, v63
    v_cos_f32 v10, v10
    v_lshlrev_b16 v13, 3, v63
    v_mad_i32_i24 v11, v14, s55, v59
    v_bitop3_b32 v12, v6, v13, v12 bitop3:0xca
    v_lshl_add_u32 v11, v11, 17, s40
    v_lshlrev_b16 v14, 8, v14
    v_lshrrev_b32 v13, 2, v63
    v_add_u32 v59, v12, v11
    v_bitop3_b32 v63, v5, v13, v14 bitop3:0xea
    ds_add_u32 v63, v2
    v_cvt_pk_bf16_f32 v47, v9, v10
    v_perm_b32 v12, v47, v47, s41
    v_bitop3_b32 v58, v4, v12, v58 bitop3:0xca
    v_perm_b32 v13, v47, v47, s42
    v_bitop3_b32 v59, v4, v13, v59 bitop3:0xca
    v_lshrrev_b32 v8, 2, v0
    v_and_b32 v7, 0x3c00, v0
    v_bitop3_b32 v7, v5, v8, v7 bitop3:0xea
    s_waitcnt lgkmcnt(0)
    s_barrier
    ds_read2st64_b32 v[8:9], v7 offset0:0 offset1:1
    ds_read2st64_b32 v[10:11], v7 offset0:2 offset1:3
    s_add_u32 s47, s35, 0x4000
    s_add_u32 s47, s47, s93
    buffer_store_dwordx4 v[64:67], v0, s[20:23], s47 offen sc1
    s_add_u32 s44, s96, 0x4000000
    s_lshr_b32 s44, s44, 1
    buffer_load_dwordx2 v[64:65], v1, s[16:19], s44 offen nt
    s_add_u32 s45, s97, 0x4400000
    s_lshr_b32 s45, s45, 1
    buffer_load_dwordx2 v[66:67], v1, s[16:19], s45 offen nt
    s_waitcnt lgkmcnt(0)
    v_lshl_or_b32 v12, v9, 16, v8
    v_lshl_or_b32 v13, v11, 16, v10
    v_mov_b32 v14, v12
    v_mov_b32 v15, v13
    s_nop 0
    v_add_u32_dpp v14, v14, v14 row_shr:1 row_mask:0xf bank_mask:0xf bound_ctrl:1
    v_add_u32_dpp v15, v15, v15 row_shr:1 row_mask:0xf bank_mask:0xf bound_ctrl:1
    s_nop 0
    v_add_u32_dpp v14, v14, v14 row_shr:2 row_mask:0xf bank_mask:0xf bound_ctrl:1
    v_add_u32_dpp v15, v15, v15 row_shr:2 row_mask:0xf bank_mask:0xf bound_ctrl:1
    s_nop 0
    v_add_u32_dpp v14, v14, v14 row_shr:4 row_mask:0xf bank_mask:0xf bound_ctrl:1
    v_add_u32_dpp v15, v15, v15 row_shr:4 row_mask:0xf bank_mask:0xf bound_ctrl:1
    s_nop 0
    v_add_u32_dpp v14, v14, v14 row_shr:8 row_mask:0xf bank_mask:0xf bound_ctrl:1
    v_add_u32_dpp v15, v15, v15 row_shr:8 row_mask:0xf bank_mask:0xf bound_ctrl:1
    s_nop 0
    v_add_u32_dpp v14, v14, v14 row_bcast:15 row_mask:0xa bank_mask:0xf
    v_add_u32_dpp v15, v15, v15 row_bcast:15 row_mask:0xa bank_mask:0xf
    s_nop 0
    v_add_u32_dpp v14, v14, v14 row_bcast:31 row_mask:0xc bank_mask:0xf
    v_add_u32_dpp v15, v15, v15 row_bcast:31 row_mask:0xc bank_mask:0xf
    v_readlane_b32 s48, v14, 63
    v_readlane_b32 s49, v15, 63
    s_lshl_b32 s54, s32, 2
    v_mov_b32 v8, s54
    s_and_b32 s50, s48, 0xffff
    s_lshr_b32 s51, s48, 16
    s_and_b32 s52, s49, 0xffff
    s_lshr_b32 s53, s49, 16
    s_add_u32 s51, s51, s50
    s_add_u32 s52, s52, s51
    s_add_u32 s53, s53, s52
    v_mov_b32 v9, s53
    s_mov_b64 exec, 1
    ds_write_b32 v8, v9 offset:16384
    s_mov_b64 exec, -1
    v_and_b32 v8, 60, v7
    s_waitcnt lgkmcnt(0)
    s_barrier
    ds_read_b32 v9, v8 offset:16384
    s_waitcnt lgkmcnt(0)
    v_add_u32_dpp v9, v9, v9 row_shr:1 row_mask:0xf bank_mask:0xf bound_ctrl:1
    s_nop 1
    v_add_u32_dpp v9, v9, v9 row_shr:2 row_mask:0xf bank_mask:0xf bound_ctrl:1
    s_nop 1
    v_add_u32_dpp v9, v9, v9 row_shr:4 row_mask:0xf bank_mask:0xf bound_ctrl:1
    s_nop 1
    v_add_u32_dpp v9, v9, v9 row_shr:8 row_mask:0xf bank_mask:0xf bound_ctrl:1
    s_nop 0
    v_readlane_b32 s54, v9, s32
    s_sub_u32 s54, s54, s53
    s_add_u32 s50, s50, s54
    s_add_u32 s51, s51, s54
    s_add_u32 s52, s52, s54
    s_pack_ll_b32_b16 s48, s54, s50
    s_pack_ll_b32_b16 s49, s51, s52
    v_add_u32 v14, s48, v14
    v_add_u32 v15, s49, v15
    v_sub_u32 v12, v14, v12
    v_sub_u32 v13, v15, v13
    v_and_b32 v8, 0xffff, v12
    v_lshrrev_b32 v9, 16, v12
    v_and_b32 v10, 0xffff, v13
    v_lshrrev_b32 v11, 16, v13
    ds_write2st64_b32 v7, v8, v9 offset0:0 offset1:1
    ds_write2st64_b32 v7, v10, v11 offset0:2 offset1:3
    v_and_b32 v8, 0x3f0, v0
    v_lshl_add_u32 v8, v8, 1, s36
    ds_write_b64 v8, v[12:13] offset:20480
    s_bitset0_b64 exec, 63
    s_not_b64 exec, exec
    ds_write_b64 v8, v[14:15] offset:20512
    s_mov_b64 exec, -1
    s_waitcnt lgkmcnt(0)
    s_barrier
    s_setprio 3
    ds_add_rtn_u32 v104, v104, v2
    ds_add_rtn_u32 v105, v105, v2
    ds_add_rtn_u32 v106, v106, v2
    ds_add_rtn_u32 v107, v107, v2
    ds_read_b128 v[12:15], v0 offset:20480
    v_cmp_gt_u32 vcc, 8448, v0
    ds_add_rtn_u32 v100, v100, v2
    ds_add_rtn_u32 v101, v101, v2
    ds_add_rtn_u32 v102, v102, v2
    ds_add_rtn_u32 v103, v103, v2
    s_setprio 2
    ds_add_rtn_u32 v120, v120, v2
    ds_add_rtn_u32 v121, v121, v2
    ds_add_rtn_u32 v122, v122, v2
    ds_add_rtn_u32 v123, v123, v2
    s_waitcnt lgkmcnt(8)
    s_cbranch_vccz L1_p2
    s_add_u32 s46, s35, 0x2a40000
    s_mov_b64 exec, vcc
    buffer_store_dwordx4 v[12:15], v0, s[24:27], s46 offen sc1
    s_mov_b64 exec, -1
L1_p2:
    s_add_u32 s47, s35, 0x8000
    s_add_u32 s47, s47, s72
    buffer_store_dwordx4 v[76:79], v0, s[20:23], s47 offen sc1
    s_add_u32 s44, s97, 0x4400000
    s_nop 0
    v_lshlrev_b32 v76, 1, v1
    buffer_load_dwordx4 v[76:79], v76, s[8:11], s44 offen nt
    ds_add_rtn_u32 v20, v20, v2
    ds_add_rtn_u32 v21, v21, v2
    ds_add_rtn_u32 v22, v22, v2
    ds_add_rtn_u32 v23, v23, v2
    s_setprio 1
    ds_add_rtn_u32 v32, v32, v2
    ds_add_rtn_u32 v33, v33, v2
    ds_add_rtn_u32 v34, v34, v2
    ds_add_rtn_u32 v35, v35, v2
    ds_add_rtn_u32 v40, v40, v2
    ds_add_rtn_u32 v41, v41, v2
    ds_add_rtn_u32 v42, v42, v2
    ds_add_rtn_u32 v43, v43, v2
    s_add_u32 s45, s35, 0x8000
    s_add_u32 s45, s45, s73
    buffer_store_dwordx4 v[80:83], v0, s[20:23], s45 offen sc1
    s_add_u32 s46, s97, 0x4400000
    s_nop 0
    v_lshlrev_b32 v80, 1, v1
    buffer_load_dwordx4 v[80:83], v80, s[12:15], s46 offen nt
    s_setprio 0
    ds_add_rtn_u32 v52, v52, v2
    ds_add_rtn_u32 v53, v53, v2
    ds_add_rtn_u32 v54, v54, v2
    ds_add_rtn_u32 v55, v55, v2
    ds_add_rtn_u32 v60, v60, v2
    ds_add_rtn_u32 v61, v61, v2
    ds_add_rtn_u32 v62, v62, v2
    ds_add_rtn_u32 v63, v63, v2
    s_waitcnt lgkmcnt(0)
    s_barrier
    s_setprio 3
    v_and_b32 v7, -4, v104
    v_lshl_add_u32 v8, v104, 2, v7
    ds_write_b32 v8, v96
    v_lshl_add_u32 v7, v7, 2, v104
    ds_write_b8 v7, v108 offset:16
    v_and_b32 v9, -4, v105
    v_lshl_add_u32 v10, v105, 2, v9
    ds_write_b32 v10, v97
    v_lshl_add_u32 v9, v9, 2, v105
    ds_write_b8_d16_hi v9, v108 offset:16
    v_and_b32 v7, -4, v106
    v_lshl_add_u32 v8, v106, 2, v7
    ds_write_b32 v8, v98
    v_lshl_add_u32 v7, v7, 2, v106
    ds_write_b8 v7, v109 offset:16
    v_and_b32 v9, -4, v107
    v_lshl_add_u32 v10, v107, 2, v9
    ds_write_b32 v10, v99
    v_lshl_add_u32 v9, v9, 2, v107
    ds_write_b8_d16_hi v9, v109 offset:16
    s_add_u32 s47, s35, 0x8000
    s_add_u32 s47, s47, s85
    buffer_store_dwordx4 v[88:91], v0, s[20:23], s47 offen sc1
    s_add_u32 s44, s98, 0x4800000
    v_lshlrev_b32 v96, 1, v1
    buffer_load_dwordx4 v[96:99], v96, s[8:11], s44 offen nt
    s_add_u32 s45, s98, 0x4800000
    v_lshlrev_b32 v104, 1, v1
    buffer_load_dwordx4 v[104:107], v104, s[12:15], s45 offen nt
    v_and_b32 v7, -4, v100
    v_lshl_add_u32 v8, v100, 2, v7
    ds_write_b32 v8, v112
    v_lshl_add_u32 v7, v7, 2, v100
    ds_write_b8 v7, v110 offset:16
    v_and_b32 v9, -4, v101
    v_lshl_add_u32 v10, v101, 2, v9
    ds_write_b32 v10, v113
    v_lshl_add_u32 v9, v9, 2, v101
    ds_write_b8_d16_hi v9, v110 offset:16
    v_and_b32 v7, -4, v102
    v_lshl_add_u32 v8, v102, 2, v7
    ds_write_b32 v8, v114
    v_lshl_add_u32 v7, v7, 2, v102
    ds_write_b8 v7, v111 offset:16
    v_and_b32 v9, -4, v103
    v_lshl_add_u32 v10, v103, 2, v9
    ds_write_b32 v10, v115
    v_lshl_add_u32 v9, v9, 2, v103
    ds_write_b8_d16_hi v9, v111 offset:16
    s_add_u32 s46, s98, 0x4800000
    s_lshr_b32 s46, s46, 1
    buffer_load_dwordx2 v[88:89], v1, s[16:19], s46 offen nt
    s_add_u32 s47, s99, 0x4c00000
    s_lshr_b32 s47, s47, 1
    buffer_load_dwordx2 v[90:91], v1, s[16:19], s47 offen nt
    s_add_u32 s44, s99, 0x4c00000
    v_lshlrev_b32 v112, 1, v1
    buffer_load_dwordx4 v[112:115], v112, s[8:11], s44 offen nt
    s_setprio 2
    v_and_b32 v7, -4, v120
    v_lshl_add_u32 v8, v120, 2, v7
    ds_write_b32 v8, v116
    v_lshl_add_u32 v7, v7, 2, v120
    ds_write_b8 v7, v124 offset:16
    v_and_b32 v9, -4, v121
    v_lshl_add_u32 v10, v121, 2, v9
    ds_write_b32 v10, v117
    v_lshl_add_u32 v9, v9, 2, v121
    ds_write_b8_d16_hi v9, v124 offset:16
    v_and_b32 v7, -4, v122
    v_lshl_add_u32 v8, v122, 2, v7
    ds_write_b32 v8, v118
    v_lshl_add_u32 v7, v7, 2, v122
    ds_write_b8 v7, v125 offset:16
    v_and_b32 v9, -4, v123
    v_lshl_add_u32 v10, v123, 2, v9
    ds_write_b32 v10, v119
    v_lshl_add_u32 v9, v9, 2, v123
    ds_write_b8_d16_hi v9, v125 offset:16
    s_add_u32 s45, s35, 0x8000
    s_add_u32 s45, s45, s91
    buffer_store_dwordx4 v[92:95], v0, s[20:23], s45 offen sc1
    s_add_u32 s46, s99, 0x4c00000
    v_lshlrev_b32 v100, 1, v1
    buffer_load_dwordx4 v[100:103], v100, s[12:15], s46 offen nt
    v_and_b32 v7, -4, v20
    v_lshl_add_u32 v8, v20, 2, v7
    ds_write_b32 v8, v16
    v_lshl_add_u32 v7, v7, 2, v20
    ds_write_b8 v7, v126 offset:16
    v_and_b32 v9, -4, v21
    v_lshl_add_u32 v10, v21, 2, v9
    ds_write_b32 v10, v17
    v_lshl_add_u32 v9, v9, 2, v21
    ds_write_b8_d16_hi v9, v126 offset:16
    v_and_b32 v7, -4, v22
    v_lshl_add_u32 v8, v22, 2, v7
    ds_write_b32 v8, v18
    v_lshl_add_u32 v7, v7, 2, v22
    ds_write_b8 v7, v127 offset:16
    v_and_b32 v9, -4, v23
    v_lshl_add_u32 v10, v23, 2, v9
    ds_write_b32 v10, v19
    v_lshl_add_u32 v9, v9, 2, v23
    ds_write_b8_d16_hi v9, v127 offset:16
    s_add_u32 s47, s96, 0x5000000
    v_lshlrev_b32 v108, 1, v1
    buffer_load_dwordx4 v[108:111], v108, s[8:11], s47 offen nt
    s_add_u32 s44, s96, 0x5000000
    v_lshlrev_b32 v116, 1, v1
    buffer_load_dwordx4 v[116:119], v116, s[12:15], s44 offen nt
    s_setprio 1
    v_and_b32 v7, -4, v32
    v_lshl_add_u32 v8, v32, 2, v7
    ds_write_b32 v8, v28
    v_lshl_add_u32 v7, v7, 2, v32
    ds_write_b8 v7, v24 offset:16
    v_and_b32 v9, -4, v33
    v_lshl_add_u32 v10, v33, 2, v9
    ds_write_b32 v10, v29
    v_lshl_add_u32 v9, v9, 2, v33
    ds_write_b8_d16_hi v9, v24 offset:16
    v_and_b32 v7, -4, v34
    v_lshl_add_u32 v8, v34, 2, v7
    ds_write_b32 v8, v30
    v_lshl_add_u32 v7, v7, 2, v34
    ds_write_b8 v7, v25 offset:16
    v_and_b32 v9, -4, v35
    v_lshl_add_u32 v10, v35, 2, v9
    ds_write_b32 v10, v31
    v_lshl_add_u32 v9, v9, 2, v35
    ds_write_b8_d16_hi v9, v25 offset:16
    s_add_u32 s45, s96, 0x5000000
    s_lshr_b32 s45, s45, 1
    buffer_load_dwordx2 v[120:121], v1, s[16:19], s45 offen nt
    s_add_u32 s46, s97, 0x5400000
    s_lshr_b32 s46, s46, 1
    buffer_load_dwordx2 v[122:123], v1, s[16:19], s46 offen nt
    s_add_u32 s47, s97, 0x5400000
    v_lshlrev_b32 v92, 1, v1
    buffer_load_dwordx4 v[92:95], v92, s[8:11], s47 offen nt
    v_and_b32 v7, -4, v40
    v_lshl_add_u32 v8, v40, 2, v7
    ds_write_b32 v8, v36
    v_lshl_add_u32 v7, v7, 2, v40
    ds_write_b8 v7, v26 offset:16
    v_and_b32 v9, -4, v41
    v_lshl_add_u32 v10, v41, 2, v9
    ds_write_b32 v10, v37
    v_lshl_add_u32 v9, v9, 2, v41
    ds_write_b8_d16_hi v9, v26 offset:16
    v_and_b32 v7, -4, v42
    v_lshl_add_u32 v8, v42, 2, v7
    ds_write_b32 v8, v38
    v_lshl_add_u32 v7, v7, 2, v42
    ds_write_b8 v7, v27 offset:16
    v_and_b32 v9, -4, v43
    v_lshl_add_u32 v10, v43, 2, v9
    ds_write_b32 v10, v39
    v_lshl_add_u32 v9, v9, 2, v43
    ds_write_b8_d16_hi v9, v27 offset:16
    s_add_u32 s44, s35, 0x8000
    s_add_u32 s44, s44, s93
    buffer_store_dwordx4 v[84:87], v0, s[20:23], s44 offen sc1
    s_add_u32 s45, s97, 0x5400000
    v_lshlrev_b32 v16, 1, v1
    buffer_load_dwordx4 v[16:19], v16, s[12:15], s45 offen nt
    s_setprio 0
    v_and_b32 v7, -4, v52
    v_lshl_add_u32 v8, v52, 2, v7
    ds_write_b32 v8, v48
    v_lshl_add_u32 v7, v7, 2, v52
    ds_write_b8 v7, v44 offset:16
    v_and_b32 v9, -4, v53
    v_lshl_add_u32 v10, v53, 2, v9
    ds_write_b32 v10, v49
    v_lshl_add_u32 v9, v9, 2, v53
    ds_write_b8_d16_hi v9, v44 offset:16
    v_and_b32 v7, -4, v54
    v_lshl_add_u32 v8, v54, 2, v7
    ds_write_b32 v8, v50
    v_lshl_add_u32 v7, v7, 2, v54
    ds_write_b8 v7, v45 offset:16
    v_and_b32 v9, -4, v55
    v_lshl_add_u32 v10, v55, 2, v9
    ds_write_b32 v10, v51
    v_lshl_add_u32 v9, v9, 2, v55
    ds_write_b8_d16_hi v9, v45 offset:16
    s_add_u32 s46, s98, 0x5800000
    v_lshlrev_b32 v20, 1, v1
    buffer_load_dwordx4 v[20:23], v20, s[8:11], s46 offen nt
    s_add_u32 s47, s98, 0x5800000
    v_lshlrev_b32 v124, 1, v1
    buffer_load_dwordx4 v[124:127], v124, s[12:15], s47 offen nt
    v_and_b32 v7, -4, v60
    v_lshl_add_u32 v8, v60, 2, v7
    ds_write_b32 v8, v56
    v_lshl_add_u32 v7, v7, 2, v60
    ds_write_b8 v7, v46 offset:16
    v_and_b32 v9, -4, v61
    v_lshl_add_u32 v10, v61, 2, v9
    ds_write_b32 v10, v57
    v_lshl_add_u32 v9, v9, 2, v61
    ds_write_b8_d16_hi v9, v46 offset:16
    v_and_b32 v7, -4, v62
    v_lshl_add_u32 v8, v62, 2, v7
    ds_write_b32 v8, v58
    v_lshl_add_u32 v7, v7, 2, v62
    ds_write_b8 v7, v47 offset:16
    v_and_b32 v9, -4, v63
    v_lshl_add_u32 v10, v63, 2, v9
    ds_write_b32 v10, v59
    v_lshl_add_u32 v9, v9, 2, v63
    ds_write_b8_d16_hi v9, v47 offset:16
    s_add_u32 s44, s98, 0x5800000
    s_lshr_b32 s44, s44, 1
    buffer_load_dwordx2 v[28:29], v1, s[16:19], s44 offen nt
    s_add_u32 s45, s99, 0x5c00000
    s_lshr_b32 s45, s45, 1
    buffer_load_dwordx2 v[30:31], v1, s[16:19], s45 offen nt
    v_add_u32 v7, s72, v0
    v_add_u32 v12, s73, v0
    v_add_u32 v13, s85, v0
    v_add_u32 v14, s91, v0
    v_add_u32 v15, s93, v0
    s_min_i32 s3, s72, s73
    s_min_i32 s3, s3, s85
    s_min_i32 s3, s3, s91
    s_min_i32 s3, s3, s93
    v_add_u32 v3, s3, v0
    v_mov_b32 v8, 0
    v_mov_b32 v9, 0
    v_mov_b32 v10, 0
    v_mov_b32 v11, 0
    s_waitcnt lgkmcnt(0)
    s_barrier
    ds_read_b128 v[32:35], v7 offset:0
    ds_read_b128 v[36:39], v12 offset:0
    ds_read_b128 v[40:43], v13 offset:0
    ds_read_b128 v[24:27], v14 offset:0
    ds_read_b128 v[84:87], v15 offset:0
    ds_write_b128 v3, v[8:11]
    ds_read_b128 v[48:51], v7 offset:16384
    ds_read_b128 v[52:55], v12 offset:16384
    ds_read_b128 v[56:59], v13 offset:16384
    ds_read_b128 v[60:63], v14 offset:16384
    ds_read_b128 v[44:47], v15 offset:16384
    s_waitcnt lgkmcnt(0)
    s_barrier
    s_setprio 3
    s_add_u32 s46, s35, 0x2a44000
    s_add_u32 s46, s46, s72
    buffer_store_dwordx4 v[32:35], v0, s[20:23], s46 offen sc1
    s_add_u32 s47, s99, 0x5c00000
    s_nop 0
    v_lshlrev_b32 v32, 1, v1
    buffer_load_dwordx4 v[32:35], v32, s[8:11], s47 offen nt
    s_add_u32 s44, s35, 0x2a44000
    s_add_u32 s44, s44, s73
    buffer_store_dwordx4 v[36:39], v0, s[20:23], s44 offen sc1
    s_add_u32 s45, s99, 0x5c00000
    s_nop 0
    v_lshlrev_b32 v36, 1, v1
    buffer_load_dwordx4 v[36:39], v36, s[12:15], s45 offen nt
    s_waitcnt vmcnt(27)
    v_lshlrev_b32 v7, 16, v64
    v_and_b32 v8, 0xffff0000, v64
    v_lshlrev_b32 v9, 16, v65
    v_and_b32 v10, 0xffff0000, v65
    v_mul_f32 v7, 0.15915494, v7
    v_mul_f32 v8, 0.15915494, v8
    v_mul_f32 v9, 0.15915494, v9
    v_mul_f32 v10, 0.15915494, v10
    v_mul_hi_u32_u24 v14, 429497, v68
    v_lshrrev_b32 v12, 3, v72
    v_cos_f32 v7, v7
    v_lshlrev_b16 v13, 3, v72
    v_mad_i32_i24 v11, v14, s55, v68
    v_bitop3_b32 v12, v6, v13, v12 bitop3:0xca
    v_lshl_add_u32 v11, v11, 17, s40
    v_lshlrev_b16 v14, 8, v14
    v_lshrrev_b32 v13, 2, v72
    v_add_u32 v68, v12, v11
    v_bitop3_b32 v72, v5, v13, v14 bitop3:0xea
    ds_add_u32 v72, v2
    v_mul_hi_u32_u24 v14, 429497, v69
    v_lshrrev_b32 v12, 3, v73
    v_cos_f32 v8, v8
    v_lshlrev_b16 v13, 3, v73
    v_mad_i32_i24 v11, v14, s55, v69
    v_bitop3_b32 v12, v6, v13, v12 bitop3:0xca
    v_lshl_add_u32 v11, v11, 17, s40
    v_lshlrev_b16 v14, 8, v14
    v_lshrrev_b32 v13, 2, v73
    v_add_u32 v69, v12, v11
    v_bitop3_b32 v73, v5, v13, v14 bitop3:0xea
    ds_add_u32 v73, v2
    v_cvt_pk_bf16_f32 v64, v7, v8
    v_perm_b32 v12, v64, v64, s41
    v_bitop3_b32 v68, v4, v12, v68 bitop3:0xca
    v_perm_b32 v13, v64, v64, s42
    v_bitop3_b32 v69, v4, v13, v69 bitop3:0xca
    v_mul_hi_u32_u24 v14, 429497, v70
    v_lshrrev_b32 v12, 3, v74
    v_cos_f32 v9, v9
    v_lshlrev_b16 v13, 3, v74
    v_mad_i32_i24 v11, v14, s55, v70
    v_bitop3_b32 v12, v6, v13, v12 bitop3:0xca
    v_lshl_add_u32 v11, v11, 17, s40
    v_lshlrev_b16 v14, 8, v14
    v_lshrrev_b32 v13, 2, v74
    v_add_u32 v70, v12, v11
    v_bitop3_b32 v74, v5, v13, v14 bitop3:0xea
    ds_add_u32 v74, v2
    v_mul_hi_u32_u24 v14, 429497, v71
    v_lshrrev_b32 v12, 3, v75
    v_cos_f32 v10, v10
    v_lshlrev_b16 v13, 3, v75
    v_mad_i32_i24 v11, v14, s55, v71
    v_bitop3_b32 v12, v6, v13, v12 bitop3:0xca
    v_lshl_add_u32 v11, v11, 17, s40
    v_lshlrev_b16 v14, 8, v14
    v_lshrrev_b32 v13, 2, v75
    v_add_u32 v71, v12, v11
    v_bitop3_b32 v75, v5, v13, v14 bitop3:0xea
    ds_add_u32 v75, v2
    v_cvt_pk_bf16_f32 v65, v9, v10
    v_perm_b32 v12, v65, v65, s41
    v_bitop3_b32 v70, v4, v12, v70 bitop3:0xca
    v_perm_b32 v13, v65, v65, s42
    v_bitop3_b32 v71, v4, v13, v71 bitop3:0xca
    s_waitcnt vmcnt(23)
    v_lshlrev_b32 v7, 16, v66
    v_and_b32 v8, 0xffff0000, v66
    v_lshlrev_b32 v9, 16, v67
    v_and_b32 v10, 0xffff0000, v67
    v_mul_f32 v7, 0.15915494, v7
    v_mul_f32 v8, 0.15915494, v8
    v_mul_f32 v9, 0.15915494, v9
    v_mul_f32 v10, 0.15915494, v10
    v_mul_hi_u32_u24 v14, 429497, v76
    v_lshrrev_b32 v12, 3, v80
    v_cos_f32 v7, v7
    v_lshlrev_b16 v13, 3, v80
    v_mad_i32_i24 v11, v14, s55, v76
    v_bitop3_b32 v12, v6, v13, v12 bitop3:0xca
    v_lshl_add_u32 v11, v11, 17, s40
    v_lshlrev_b16 v14, 8, v14
    v_lshrrev_b32 v13, 2, v80
    v_add_u32 v76, v12, v11
    v_bitop3_b32 v80, v5, v13, v14 bitop3:0xea
    ds_add_u32 v80, v2
    v_mul_hi_u32_u24 v14, 429497, v77
    v_lshrrev_b32 v12, 3, v81
    v_cos_f32 v8, v8
    v_lshlrev_b16 v13, 3, v81
    v_mad_i32_i24 v11, v14, s55, v77
    v_bitop3_b32 v12, v6, v13, v12 bitop3:0xca
    v_lshl_add_u32 v11, v11, 17, s40
    v_lshlrev_b16 v14, 8, v14
    v_lshrrev_b32 v13, 2, v81
    v_add_u32 v77, v12, v11
    v_bitop3_b32 v81, v5, v13, v14 bitop3:0xea
    ds_add_u32 v81, v2
    v_cvt_pk_bf16_f32 v66, v7, v8
    v_perm_b32 v12, v66, v66, s41
    v_bitop3_b32 v76, v4, v12, v76 bitop3:0xca
    v_perm_b32 v13, v66, v66, s42
    v_bitop3_b32 v77, v4, v13, v77 bitop3:0xca
    v_mul_hi_u32_u24 v14, 429497, v78
    v_lshrrev_b32 v12, 3, v82
    v_cos_f32 v9, v9
    v_lshlrev_b16 v13, 3, v82
    v_mad_i32_i24 v11, v14, s55, v78
    v_bitop3_b32 v12, v6, v13, v12 bitop3:0xca
    v_lshl_add_u32 v11, v11, 17, s40
    v_lshlrev_b16 v14, 8, v14
    v_lshrrev_b32 v13, 2, v82
    v_add_u32 v78, v12, v11
    v_bitop3_b32 v82, v5, v13, v14 bitop3:0xea
    ds_add_u32 v82, v2
    v_mul_hi_u32_u24 v14, 429497, v79
    v_lshrrev_b32 v12, 3, v83
    v_cos_f32 v10, v10
    v_lshlrev_b16 v13, 3, v83
    v_mad_i32_i24 v11, v14, s55, v79
    v_bitop3_b32 v12, v6, v13, v12 bitop3:0xca
    v_lshl_add_u32 v11, v11, 17, s40
    v_lshlrev_b16 v14, 8, v14
    v_lshrrev_b32 v13, 2, v83
    v_add_u32 v79, v12, v11
    v_bitop3_b32 v83, v5, v13, v14 bitop3:0xea
    ds_add_u32 v83, v2
    v_cvt_pk_bf16_f32 v67, v9, v10
    v_perm_b32 v12, v67, v67, s41
    v_bitop3_b32 v78, v4, v12, v78 bitop3:0xca
    v_perm_b32 v13, v67, v67, s42
    v_bitop3_b32 v79, v4, v13, v79 bitop3:0xca
    s_setprio 2
    s_waitcnt vmcnt(18)
    v_lshlrev_b32 v7, 16, v88
    v_and_b32 v8, 0xffff0000, v88
    v_lshlrev_b32 v9, 16, v89
    v_and_b32 v10, 0xffff0000, v89
    v_mul_f32 v7, 0.15915494, v7
    v_mul_f32 v8, 0.15915494, v8
    v_mul_f32 v9, 0.15915494, v9
    v_mul_f32 v10, 0.15915494, v10
    v_mul_hi_u32_u24 v14, 429497, v96
    v_lshrrev_b32 v12, 3, v104
    v_cos_f32 v7, v7
    v_lshlrev_b16 v13, 3, v104
    v_mad_i32_i24 v11, v14, s55, v96
    v_bitop3_b32 v12, v6, v13, v12 bitop3:0xca
    v_lshl_add_u32 v11, v11, 17, s40
    v_lshlrev_b16 v14, 8, v14
    v_lshrrev_b32 v13, 2, v104
    v_add_u32 v96, v12, v11
    v_bitop3_b32 v104, v5, v13, v14 bitop3:0xea
    ds_add_u32 v104, v2
    v_mul_hi_u32_u24 v14, 429497, v97
    v_lshrrev_b32 v12, 3, v105
    v_cos_f32 v8, v8
    v_lshlrev_b16 v13, 3, v105
    v_mad_i32_i24 v11, v14, s55, v97
    v_bitop3_b32 v12, v6, v13, v12 bitop3:0xca
    v_lshl_add_u32 v11, v11, 17, s40
    v_lshlrev_b16 v14, 8, v14
    v_lshrrev_b32 v13, 2, v105
    v_add_u32 v97, v12, v11
    v_bitop3_b32 v105, v5, v13, v14 bitop3:0xea
    ds_add_u32 v105, v2
    v_cvt_pk_bf16_f32 v88, v7, v8
    v_perm_b32 v12, v88, v88, s41
    v_bitop3_b32 v96, v4, v12, v96 bitop3:0xca
    v_perm_b32 v13, v88, v88, s42
    v_bitop3_b32 v97, v4, v13, v97 bitop3:0xca
    v_mul_hi_u32_u24 v14, 429497, v98
    v_lshrrev_b32 v12, 3, v106
    v_cos_f32 v9, v9
    v_lshlrev_b16 v13, 3, v106
    v_mad_i32_i24 v11, v14, s55, v98
    v_bitop3_b32 v12, v6, v13, v12 bitop3:0xca
    v_lshl_add_u32 v11, v11, 17, s40
    v_lshlrev_b16 v14, 8, v14
    v_lshrrev_b32 v13, 2, v106
    v_add_u32 v98, v12, v11
    v_bitop3_b32 v106, v5, v13, v14 bitop3:0xea
    ds_add_u32 v106, v2
    v_mul_hi_u32_u24 v14, 429497, v99
    v_lshrrev_b32 v12, 3, v107
    v_cos_f32 v10, v10
    v_lshlrev_b16 v13, 3, v107
    v_mad_i32_i24 v11, v14, s55, v99
    v_bitop3_b32 v12, v6, v13, v12 bitop3:0xca
    v_lshl_add_u32 v11, v11, 17, s40
    v_lshlrev_b16 v14, 8, v14
    v_lshrrev_b32 v13, 2, v107
    v_add_u32 v99, v12, v11
    v_bitop3_b32 v107, v5, v13, v14 bitop3:0xea
    ds_add_u32 v107, v2
    v_cvt_pk_bf16_f32 v89, v9, v10
    v_perm_b32 v12, v89, v89, s41
    v_bitop3_b32 v98, v4, v12, v98 bitop3:0xca
    v_perm_b32 v13, v89, v89, s42
    v_bitop3_b32 v99, v4, v13, v99 bitop3:0xca
    s_add_u32 s46, s35, 0x2a44000
    s_add_u32 s46, s46, s85
    buffer_store_dwordx4 v[40:43], v0, s[20:23], s46 offen sc1
    s_add_u32 s47, s96, 0x6000000
    s_nop 0
    v_lshlrev_b32 v40, 1, v1
    buffer_load_dwordx4 v[40:43], v40, s[8:11], s47 offen nt
    s_waitcnt vmcnt(17)
    v_lshlrev_b32 v7, 16, v90
    v_and_b32 v8, 0xffff0000, v90
    v_lshlrev_b32 v9, 16, v91
    v_and_b32 v10, 0xffff0000, v91
    v_mul_f32 v7, 0.15915494, v7
    v_mul_f32 v8, 0.15915494, v8
    v_mul_f32 v9, 0.15915494, v9
    v_mul_f32 v10, 0.15915494, v10
    v_mul_hi_u32_u24 v14, 429497, v112
    v_lshrrev_b32 v12, 3, v100
    v_cos_f32 v7, v7
    v_lshlrev_b16 v13, 3, v100
    v_mad_i32_i24 v11, v14, s55, v112
    v_bitop3_b32 v12, v6, v13, v12 bitop3:0xca
    v_lshl_add_u32 v11, v11, 17, s40
    v_lshlrev_b16 v14, 8, v14
    v_lshrrev_b32 v13, 2, v100
    v_add_u32 v112, v12, v11
    v_bitop3_b32 v100, v5, v13, v14 bitop3:0xea
    ds_add_u32 v100, v2
    v_mul_hi_u32_u24 v14, 429497, v113
    v_lshrrev_b32 v12, 3, v101
    v_cos_f32 v8, v8
    v_lshlrev_b16 v13, 3, v101
    v_mad_i32_i24 v11, v14, s55, v113
    v_bitop3_b32 v12, v6, v13, v12 bitop3:0xca
    v_lshl_add_u32 v11, v11, 17, s40
    v_lshlrev_b16 v14, 8, v14
    v_lshrrev_b32 v13, 2, v101
    v_add_u32 v113, v12, v11
    v_bitop3_b32 v101, v5, v13, v14 bitop3:0xea
    ds_add_u32 v101, v2
    v_cvt_pk_bf16_f32 v90, v7, v8
    v_perm_b32 v12, v90, v90, s41
    v_bitop3_b32 v112, v4, v12, v112 bitop3:0xca
    v_perm_b32 v13, v90, v90, s42
    v_bitop3_b32 v113, v4, v13, v113 bitop3:0xca
    v_mul_hi_u32_u24 v14, 429497, v114
    v_lshrrev_b32 v12, 3, v102
    v_cos_f32 v9, v9
    v_lshlrev_b16 v13, 3, v102
    v_mad_i32_i24 v11, v14, s55, v114
    v_bitop3_b32 v12, v6, v13, v12 bitop3:0xca
    v_lshl_add_u32 v11, v11, 17, s40
    v_lshlrev_b16 v14, 8, v14
    v_lshrrev_b32 v13, 2, v102
    v_add_u32 v114, v12, v11
    v_bitop3_b32 v102, v5, v13, v14 bitop3:0xea
    ds_add_u32 v102, v2
    v_mul_hi_u32_u24 v14, 429497, v115
    v_lshrrev_b32 v12, 3, v103
    v_cos_f32 v10, v10
    v_lshlrev_b16 v13, 3, v103
    v_mad_i32_i24 v11, v14, s55, v115
    v_bitop3_b32 v12, v6, v13, v12 bitop3:0xca
    v_lshl_add_u32 v11, v11, 17, s40
    v_lshlrev_b16 v14, 8, v14
    v_lshrrev_b32 v13, 2, v103
    v_add_u32 v115, v12, v11
    v_bitop3_b32 v103, v5, v13, v14 bitop3:0xea
    ds_add_u32 v103, v2
    v_cvt_pk_bf16_f32 v91, v9, v10
    v_perm_b32 v12, v91, v91, s41
    v_bitop3_b32 v114, v4, v12, v114 bitop3:0xca
    v_perm_b32 v13, v91, v91, s42
    v_bitop3_b32 v115, v4, v13, v115 bitop3:0xca
    s_setprio 1
    s_waitcnt vmcnt(13)
    v_lshlrev_b32 v7, 16, v120
    v_and_b32 v8, 0xffff0000, v120
    v_lshlrev_b32 v9, 16, v121
    v_and_b32 v10, 0xffff0000, v121
    v_mul_f32 v7, 0.15915494, v7
    v_mul_f32 v8, 0.15915494, v8
    v_mul_f32 v9, 0.15915494, v9
    v_mul_f32 v10, 0.15915494, v10
    v_mul_hi_u32_u24 v14, 429497, v108
    v_lshrrev_b32 v12, 3, v116
    v_cos_f32 v7, v7
    v_lshlrev_b16 v13, 3, v116
    v_mad_i32_i24 v11, v14, s55, v108
    v_bitop3_b32 v12, v6, v13, v12 bitop3:0xca
    v_lshl_add_u32 v11, v11, 17, s40
    v_lshlrev_b16 v14, 8, v14
    v_lshrrev_b32 v13, 2, v116
    v_add_u32 v108, v12, v11
    v_bitop3_b32 v116, v5, v13, v14 bitop3:0xea
    ds_add_u32 v116, v2
    v_mul_hi_u32_u24 v14, 429497, v109
    v_lshrrev_b32 v12, 3, v117
    v_cos_f32 v8, v8
    v_lshlrev_b16 v13, 3, v117
    v_mad_i32_i24 v11, v14, s55, v109
    v_bitop3_b32 v12, v6, v13, v12 bitop3:0xca
    v_lshl_add_u32 v11, v11, 17, s40
    v_lshlrev_b16 v14, 8, v14
    v_lshrrev_b32 v13, 2, v117
    v_add_u32 v109, v12, v11
    v_bitop3_b32 v117, v5, v13, v14 bitop3:0xea
    ds_add_u32 v117, v2
    v_cvt_pk_bf16_f32 v120, v7, v8
    v_perm_b32 v12, v120, v120, s41
    v_bitop3_b32 v108, v4, v12, v108 bitop3:0xca
    v_perm_b32 v13, v120, v120, s42
    v_bitop3_b32 v109, v4, v13, v109 bitop3:0xca
    v_mul_hi_u32_u24 v14, 429497, v110
    v_lshrrev_b32 v12, 3, v118
    v_cos_f32 v9, v9
    v_lshlrev_b16 v13, 3, v118
    v_mad_i32_i24 v11, v14, s55, v110
    v_bitop3_b32 v12, v6, v13, v12 bitop3:0xca
    v_lshl_add_u32 v11, v11, 17, s40
    v_lshlrev_b16 v14, 8, v14
    v_lshrrev_b32 v13, 2, v118
    v_add_u32 v110, v12, v11
    v_bitop3_b32 v118, v5, v13, v14 bitop3:0xea
    ds_add_u32 v118, v2
    v_mul_hi_u32_u24 v14, 429497, v111
    v_lshrrev_b32 v12, 3, v119
    v_cos_f32 v10, v10
    v_lshlrev_b16 v13, 3, v119
    v_mad_i32_i24 v11, v14, s55, v111
    v_bitop3_b32 v12, v6, v13, v12 bitop3:0xca
    v_lshl_add_u32 v11, v11, 17, s40
    v_lshlrev_b16 v14, 8, v14
    v_lshrrev_b32 v13, 2, v119
    v_add_u32 v111, v12, v11
    v_bitop3_b32 v119, v5, v13, v14 bitop3:0xea
    ds_add_u32 v119, v2
    v_cvt_pk_bf16_f32 v121, v9, v10
    v_perm_b32 v12, v121, v121, s41
    v_bitop3_b32 v110, v4, v12, v110 bitop3:0xca
    v_perm_b32 v13, v121, v121, s42
    v_bitop3_b32 v111, v4, v13, v111 bitop3:0xca
    s_waitcnt vmcnt(10)
    v_lshlrev_b32 v7, 16, v122
    v_and_b32 v8, 0xffff0000, v122
    v_lshlrev_b32 v9, 16, v123
    v_and_b32 v10, 0xffff0000, v123
    v_mul_f32 v7, 0.15915494, v7
    v_mul_f32 v8, 0.15915494, v8
    v_mul_f32 v9, 0.15915494, v9
    v_mul_f32 v10, 0.15915494, v10
    v_mul_hi_u32_u24 v14, 429497, v92
    v_lshrrev_b32 v12, 3, v16
    v_cos_f32 v7, v7
    v_lshlrev_b16 v13, 3, v16
    v_mad_i32_i24 v11, v14, s55, v92
    v_bitop3_b32 v12, v6, v13, v12 bitop3:0xca
    v_lshl_add_u32 v11, v11, 17, s40
    v_lshlrev_b16 v14, 8, v14
    v_lshrrev_b32 v13, 2, v16
    v_add_u32 v92, v12, v11
    v_bitop3_b32 v16, v5, v13, v14 bitop3:0xea
    ds_add_u32 v16, v2
    v_mul_hi_u32_u24 v14, 429497, v93
    v_lshrrev_b32 v12, 3, v17
    v_cos_f32 v8, v8
    v_lshlrev_b16 v13, 3, v17
    v_mad_i32_i24 v11, v14, s55, v93
    v_bitop3_b32 v12, v6, v13, v12 bitop3:0xca
    v_lshl_add_u32 v11, v11, 17, s40
    v_lshlrev_b16 v14, 8, v14
    v_lshrrev_b32 v13, 2, v17
    v_add_u32 v93, v12, v11
    v_bitop3_b32 v17, v5, v13, v14 bitop3:0xea
    ds_add_u32 v17, v2
    v_cvt_pk_bf16_f32 v122, v7, v8
    v_perm_b32 v12, v122, v122, s41
    v_bitop3_b32 v92, v4, v12, v92 bitop3:0xca
    v_perm_b32 v13, v122, v122, s42
    v_bitop3_b32 v93, v4, v13, v93 bitop3:0xca
    v_mul_hi_u32_u24 v14, 429497, v94
    v_lshrrev_b32 v12, 3, v18
    v_cos_f32 v9, v9
    v_lshlrev_b16 v13, 3, v18
    v_mad_i32_i24 v11, v14, s55, v94
    v_bitop3_b32 v12, v6, v13, v12 bitop3:0xca
    v_lshl_add_u32 v11, v11, 17, s40
    v_lshlrev_b16 v14, 8, v14
    v_lshrrev_b32 v13, 2, v18
    v_add_u32 v94, v12, v11
    v_bitop3_b32 v18, v5, v13, v14 bitop3:0xea
    ds_add_u32 v18, v2
    v_mul_hi_u32_u24 v14, 429497, v95
    v_lshrrev_b32 v12, 3, v19
    v_cos_f32 v10, v10
    v_lshlrev_b16 v13, 3, v19
    v_mad_i32_i24 v11, v14, s55, v95
    v_bitop3_b32 v12, v6, v13, v12 bitop3:0xca
    v_lshl_add_u32 v11, v11, 17, s40
    v_lshlrev_b16 v14, 8, v14
    v_lshrrev_b32 v13, 2, v19
    v_add_u32 v95, v12, v11
    v_bitop3_b32 v19, v5, v13, v14 bitop3:0xea
    ds_add_u32 v19, v2
    v_cvt_pk_bf16_f32 v123, v9, v10
    v_perm_b32 v12, v123, v123, s41
    v_bitop3_b32 v94, v4, v12, v94 bitop3:0xca
    v_perm_b32 v13, v123, v123, s42
    v_bitop3_b32 v95, v4, v13, v95 bitop3:0xca
    s_setprio 0
    s_add_u32 s44, s35, 0x2a44000
    s_add_u32 s44, s44, s91
    buffer_store_dwordx4 v[24:27], v0, s[20:23], s44 offen sc1
    s_add_u32 s45, s96, 0x6000000
    s_nop 0
    v_lshlrev_b32 v24, 1, v1
    buffer_load_dwordx4 v[24:27], v24, s[12:15], s45 offen nt
    s_waitcnt vmcnt(8)
    v_lshlrev_b32 v7, 16, v28
    v_and_b32 v8, 0xffff0000, v28
    v_lshlrev_b32 v9, 16, v29
    v_and_b32 v10, 0xffff0000, v29
    v_mul_f32 v7, 0.15915494, v7
    v_mul_f32 v8, 0.15915494, v8
    v_mul_f32 v9, 0.15915494, v9
    v_mul_f32 v10, 0.15915494, v10
    v_mul_hi_u32_u24 v14, 429497, v20
    v_lshrrev_b32 v12, 3, v124
    v_cos_f32 v7, v7
    v_lshlrev_b16 v13, 3, v124
    v_mad_i32_i24 v11, v14, s55, v20
    v_bitop3_b32 v12, v6, v13, v12 bitop3:0xca
    v_lshl_add_u32 v11, v11, 17, s40
    v_lshlrev_b16 v14, 8, v14
    v_lshrrev_b32 v13, 2, v124
    v_add_u32 v20, v12, v11
    v_bitop3_b32 v124, v5, v13, v14 bitop3:0xea
    ds_add_u32 v124, v2
    v_mul_hi_u32_u24 v14, 429497, v21
    v_lshrrev_b32 v12, 3, v125
    v_cos_f32 v8, v8
    v_lshlrev_b16 v13, 3, v125
    v_mad_i32_i24 v11, v14, s55, v21
    v_bitop3_b32 v12, v6, v13, v12 bitop3:0xca
    v_lshl_add_u32 v11, v11, 17, s40
    v_lshlrev_b16 v14, 8, v14
    v_lshrrev_b32 v13, 2, v125
    v_add_u32 v21, v12, v11
    v_bitop3_b32 v125, v5, v13, v14 bitop3:0xea
    ds_add_u32 v125, v2
    v_cvt_pk_bf16_f32 v28, v7, v8
    v_perm_b32 v12, v28, v28, s41
    v_bitop3_b32 v20, v4, v12, v20 bitop3:0xca
    v_perm_b32 v13, v28, v28, s42
    v_bitop3_b32 v21, v4, v13, v21 bitop3:0xca
    v_mul_hi_u32_u24 v14, 429497, v22
    v_lshrrev_b32 v12, 3, v126
    v_cos_f32 v9, v9
    v_lshlrev_b16 v13, 3, v126
    v_mad_i32_i24 v11, v14, s55, v22
    v_bitop3_b32 v12, v6, v13, v12 bitop3:0xca
    v_lshl_add_u32 v11, v11, 17, s40
    v_lshlrev_b16 v14, 8, v14
    v_lshrrev_b32 v13, 2, v126
    v_add_u32 v22, v12, v11
    v_bitop3_b32 v126, v5, v13, v14 bitop3:0xea
    ds_add_u32 v126, v2
    v_mul_hi_u32_u24 v14, 429497, v23
    v_lshrrev_b32 v12, 3, v127
    v_cos_f32 v10, v10
    v_lshlrev_b16 v13, 3, v127
    v_mad_i32_i24 v11, v14, s55, v23
    v_bitop3_b32 v12, v6, v13, v12 bitop3:0xca
    v_lshl_add_u32 v11, v11, 17, s40
    v_lshlrev_b16 v14, 8, v14
    v_lshrrev_b32 v13, 2, v127
    v_add_u32 v23, v12, v11
    v_bitop3_b32 v127, v5, v13, v14 bitop3:0xea
    ds_add_u32 v127, v2
    v_cvt_pk_bf16_f32 v29, v9, v10
    v_perm_b32 v12, v29, v29, s41
    v_bitop3_b32 v22, v4, v12, v22 bitop3:0xca
    v_perm_b32 v13, v29, v29, s42
    v_bitop3_b32 v23, v4, v13, v23 bitop3:0xca
    s_waitcnt vmcnt(4)
    v_lshlrev_b32 v7, 16, v30
    v_and_b32 v8, 0xffff0000, v30
    v_lshlrev_b32 v9, 16, v31
    v_and_b32 v10, 0xffff0000, v31
    v_mul_f32 v7, 0.15915494, v7
    v_mul_f32 v8, 0.15915494, v8
    v_mul_f32 v9, 0.15915494, v9
    v_mul_f32 v10, 0.15915494, v10
    v_mul_hi_u32_u24 v14, 429497, v32
    v_lshrrev_b32 v12, 3, v36
    v_cos_f32 v7, v7
    v_lshlrev_b16 v13, 3, v36
    v_mad_i32_i24 v11, v14, s55, v32
    v_bitop3_b32 v12, v6, v13, v12 bitop3:0xca
    v_lshl_add_u32 v11, v11, 17, s40
    v_lshlrev_b16 v14, 8, v14
    v_lshrrev_b32 v13, 2, v36
    v_add_u32 v32, v12, v11
    v_bitop3_b32 v36, v5, v13, v14 bitop3:0xea
    ds_add_u32 v36, v2
    v_mul_hi_u32_u24 v14, 429497, v33
    v_lshrrev_b32 v12, 3, v37
    v_cos_f32 v8, v8
    v_lshlrev_b16 v13, 3, v37
    v_mad_i32_i24 v11, v14, s55, v33
    v_bitop3_b32 v12, v6, v13, v12 bitop3:0xca
    v_lshl_add_u32 v11, v11, 17, s40
    v_lshlrev_b16 v14, 8, v14
    v_lshrrev_b32 v13, 2, v37
    v_add_u32 v33, v12, v11
    v_bitop3_b32 v37, v5, v13, v14 bitop3:0xea
    ds_add_u32 v37, v2
    v_cvt_pk_bf16_f32 v30, v7, v8
    v_perm_b32 v12, v30, v30, s41
    v_bitop3_b32 v32, v4, v12, v32 bitop3:0xca
    v_perm_b32 v13, v30, v30, s42
    v_bitop3_b32 v33, v4, v13, v33 bitop3:0xca
    v_mul_hi_u32_u24 v14, 429497, v34
    v_lshrrev_b32 v12, 3, v38
    v_cos_f32 v9, v9
    v_lshlrev_b16 v13, 3, v38
    v_mad_i32_i24 v11, v14, s55, v34
    v_bitop3_b32 v12, v6, v13, v12 bitop3:0xca
    v_lshl_add_u32 v11, v11, 17, s40
    v_lshlrev_b16 v14, 8, v14
    v_lshrrev_b32 v13, 2, v38
    v_add_u32 v34, v12, v11
    v_bitop3_b32 v38, v5, v13, v14 bitop3:0xea
    ds_add_u32 v38, v2
    v_mul_hi_u32_u24 v14, 429497, v35
    v_lshrrev_b32 v12, 3, v39
    v_cos_f32 v10, v10
    v_lshlrev_b16 v13, 3, v39
    v_mad_i32_i24 v11, v14, s55, v35
    v_bitop3_b32 v12, v6, v13, v12 bitop3:0xca
    v_lshl_add_u32 v11, v11, 17, s40
    v_lshlrev_b16 v14, 8, v14
    v_lshrrev_b32 v13, 2, v39
    v_add_u32 v35, v12, v11
    v_bitop3_b32 v39, v5, v13, v14 bitop3:0xea
    ds_add_u32 v39, v2
    v_cvt_pk_bf16_f32 v31, v9, v10
    v_perm_b32 v12, v31, v31, s41
    v_bitop3_b32 v34, v4, v12, v34 bitop3:0xca
    v_perm_b32 v13, v31, v31, s42
    v_bitop3_b32 v35, v4, v13, v35 bitop3:0xca
    v_lshrrev_b32 v8, 2, v0
    v_and_b32 v7, 0x3c00, v0
    v_bitop3_b32 v7, v5, v8, v7 bitop3:0xea
    s_waitcnt lgkmcnt(0)
    s_barrier
    ds_read2st64_b32 v[8:9], v7 offset0:0 offset1:1
    ds_read2st64_b32 v[10:11], v7 offset0:2 offset1:3
    s_add_u32 s46, s35, 0x2a44000
    s_add_u32 s46, s46, s93
    buffer_store_dwordx4 v[84:87], v0, s[20:23], s46 offen sc1
    s_add_u32 s47, s96, 0x6000000
    s_lshr_b32 s47, s47, 1
    buffer_load_dwordx2 v[84:85], v1, s[16:19], s47 offen nt
    s_add_u32 s44, s97, 0x6400000
    s_lshr_b32 s44, s44, 1
    buffer_load_dwordx2 v[86:87], v1, s[16:19], s44 offen nt
    s_waitcnt lgkmcnt(0)
    v_lshl_or_b32 v12, v9, 16, v8
    v_lshl_or_b32 v13, v11, 16, v10
    v_mov_b32 v14, v12
    v_mov_b32 v15, v13
    s_nop 0
    v_add_u32_dpp v14, v14, v14 row_shr:1 row_mask:0xf bank_mask:0xf bound_ctrl:1
    v_add_u32_dpp v15, v15, v15 row_shr:1 row_mask:0xf bank_mask:0xf bound_ctrl:1
    s_nop 0
    v_add_u32_dpp v14, v14, v14 row_shr:2 row_mask:0xf bank_mask:0xf bound_ctrl:1
    v_add_u32_dpp v15, v15, v15 row_shr:2 row_mask:0xf bank_mask:0xf bound_ctrl:1
    s_nop 0
    v_add_u32_dpp v14, v14, v14 row_shr:4 row_mask:0xf bank_mask:0xf bound_ctrl:1
    v_add_u32_dpp v15, v15, v15 row_shr:4 row_mask:0xf bank_mask:0xf bound_ctrl:1
    s_nop 0
    v_add_u32_dpp v14, v14, v14 row_shr:8 row_mask:0xf bank_mask:0xf bound_ctrl:1
    v_add_u32_dpp v15, v15, v15 row_shr:8 row_mask:0xf bank_mask:0xf bound_ctrl:1
    s_nop 0
    v_add_u32_dpp v14, v14, v14 row_bcast:15 row_mask:0xa bank_mask:0xf
    v_add_u32_dpp v15, v15, v15 row_bcast:15 row_mask:0xa bank_mask:0xf
    s_nop 0
    v_add_u32_dpp v14, v14, v14 row_bcast:31 row_mask:0xc bank_mask:0xf
    v_add_u32_dpp v15, v15, v15 row_bcast:31 row_mask:0xc bank_mask:0xf
    v_readlane_b32 s48, v14, 63
    v_readlane_b32 s49, v15, 63
    s_lshl_b32 s54, s32, 2
    v_mov_b32 v8, s54
    s_and_b32 s50, s48, 0xffff
    s_lshr_b32 s51, s48, 16
    s_and_b32 s52, s49, 0xffff
    s_lshr_b32 s53, s49, 16
    s_add_u32 s51, s51, s50
    s_add_u32 s52, s52, s51
    s_add_u32 s53, s53, s52
    v_mov_b32 v9, s53
    s_mov_b64 exec, 1
    ds_write_b32 v8, v9 offset:16384
    s_mov_b64 exec, -1
    v_and_b32 v8, 60, v7
    s_waitcnt lgkmcnt(0)
    s_barrier
    ds_read_b32 v9, v8 offset:16384
    s_waitcnt lgkmcnt(0)
    v_add_u32_dpp v9, v9, v9 row_shr:1 row_mask:0xf bank_mask:0xf bound_ctrl:1
    s_nop 1
    v_add_u32_dpp v9, v9, v9 row_shr:2 row_mask:0xf bank_mask:0xf bound_ctrl:1
    s_nop 1
    v_add_u32_dpp v9, v9, v9 row_shr:4 row_mask:0xf bank_mask:0xf bound_ctrl:1
    s_nop 1
    v_add_u32_dpp v9, v9, v9 row_shr:8 row_mask:0xf bank_mask:0xf bound_ctrl:1
    s_nop 0
    v_readlane_b32 s54, v9, s32
    s_sub_u32 s54, s54, s53
    s_add_u32 s50, s50, s54
    s_add_u32 s51, s51, s54
    s_add_u32 s52, s52, s54
    s_pack_ll_b32_b16 s48, s54, s50
    s_pack_ll_b32_b16 s49, s51, s52
    v_add_u32 v14, s48, v14
    v_add_u32 v15, s49, v15
    v_sub_u32 v12, v14, v12
    v_sub_u32 v13, v15, v13
    v_and_b32 v8, 0xffff, v12
    v_lshrrev_b32 v9, 16, v12
    v_and_b32 v10, 0xffff, v13
    v_lshrrev_b32 v11, 16, v13
    ds_write2st64_b32 v7, v8, v9 offset0:0 offset1:1
    ds_write2st64_b32 v7, v10, v11 offset0:2 offset1:3
    v_and_b32 v8, 0x3f0, v0
    v_lshl_add_u32 v8, v8, 1, s36
    ds_write_b64 v8, v[12:13] offset:20480
    s_bitset0_b64 exec, 63
    s_not_b64 exec, exec
    ds_write_b64 v8, v[14:15] offset:20512
    s_mov_b64 exec, -1
    s_waitcnt lgkmcnt(0)
    s_barrier
    s_setprio 3
    ds_add_rtn_u32 v72, v72, v2
    ds_add_rtn_u32 v73, v73, v2
    ds_add_rtn_u32 v74, v74, v2
    ds_add_rtn_u32 v75, v75, v2
    ds_read_b128 v[12:15], v0 offset:20480
    v_cmp_gt_u32 vcc, 8448, v0
    ds_add_rtn_u32 v80, v80, v2
    ds_add_rtn_u32 v81, v81, v2
    ds_add_rtn_u32 v82, v82, v2
    ds_add_rtn_u32 v83, v83, v2
    s_setprio 2
    ds_add_rtn_u32 v104, v104, v2
    ds_add_rtn_u32 v105, v105, v2
    ds_add_rtn_u32 v106, v106, v2
    ds_add_rtn_u32 v107, v107, v2
    s_waitcnt lgkmcnt(8)
    s_cbranch_vccz L1_p3
    s_add_u32 s45, s35, 0x5480000
    s_mov_b64 exec, vcc
    buffer_store_dwordx4 v[12:15], v0, s[24:27], s45 offen sc1
    s_mov_b64 exec, -1
L1_p3:
    s_add_u32 s46, s35, 0x2a48000
    s_add_u32 s46, s46, s72
    buffer_store_dwordx4 v[48:51], v0, s[20:23], s46 offen sc1
    s_add_u32 s47, s97, 0x6400000
    s_nop 0
    v_lshlrev_b32 v48, 1, v1
    buffer_load_dwordx4 v[48:51], v48, s[8:11], s47 offen nt
    ds_add_rtn_u32 v100, v100, v2
    ds_add_rtn_u32 v101, v101, v2
    ds_add_rtn_u32 v102, v102, v2
    ds_add_rtn_u32 v103, v103, v2
    s_setprio 1
    ds_add_rtn_u32 v116, v116, v2
    ds_add_rtn_u32 v117, v117, v2
    ds_add_rtn_u32 v118, v118, v2
    ds_add_rtn_u32 v119, v119, v2
    ds_add_rtn_u32 v16, v16, v2
    ds_add_rtn_u32 v17, v17, v2
    ds_add_rtn_u32 v18, v18, v2
    ds_add_rtn_u32 v19, v19, v2
    s_add_u32 s44, s35, 0x2a48000
    s_add_u32 s44, s44, s73
    buffer_store_dwordx4 v[52:55], v0, s[20:23], s44 offen sc1
    s_add_u32 s45, s97, 0x6400000
    s_nop 0
    v_lshlrev_b32 v52, 1, v1
    buffer_load_dwordx4 v[52:55], v52, s[12:15], s45 offen nt
    s_setprio 0
    ds_add_rtn_u32 v124, v124, v2
    ds_add_rtn_u32 v125, v125, v2
    ds_add_rtn_u32 v126, v126, v2
    ds_add_rtn_u32 v127, v127, v2
    ds_add_rtn_u32 v36, v36, v2
    ds_add_rtn_u32 v37, v37, v2
    ds_add_rtn_u32 v38, v38, v2
    ds_add_rtn_u32 v39, v39, v2
    s_waitcnt lgkmcnt(0)
    s_barrier
    s_setprio 3
    v_and_b32 v7, -4, v72
    v_lshl_add_u32 v8, v72, 2, v7
    ds_write_b32 v8, v68
    v_lshl_add_u32 v7, v7, 2, v72
    ds_write_b8 v7, v64 offset:16
    v_and_b32 v9, -4, v73
    v_lshl_add_u32 v10, v73, 2, v9
    ds_write_b32 v10, v69
    v_lshl_add_u32 v9, v9, 2, v73
    ds_write_b8_d16_hi v9, v64 offset:16
    v_and_b32 v7, -4, v74
    v_lshl_add_u32 v8, v74, 2, v7
    ds_write_b32 v8, v70
    v_lshl_add_u32 v7, v7, 2, v74
    ds_write_b8 v7, v65 offset:16
    v_and_b32 v9, -4, v75
    v_lshl_add_u32 v10, v75, 2, v9
    ds_write_b32 v10, v71
    v_lshl_add_u32 v9, v9, 2, v75
    ds_write_b8_d16_hi v9, v65 offset:16
    s_add_u32 s46, s35, 0x2a48000
    s_add_u32 s46, s46, s85
    buffer_store_dwordx4 v[56:59], v0, s[20:23], s46 offen sc1
    s_add_u32 s47, s98, 0x6800000
    v_lshlrev_b32 v68, 1, v1
    buffer_load_dwordx4 v[68:71], v68, s[8:11], s47 offen nt
    s_add_u32 s44, s98, 0x6800000
    v_lshlrev_b32 v72, 1, v1
    buffer_load_dwordx4 v[72:75], v72, s[12:15], s44 offen nt
    v_and_b32 v7, -4, v80
    v_lshl_add_u32 v8, v80, 2, v7
    ds_write_b32 v8, v76
    v_lshl_add_u32 v7, v7, 2, v80
    ds_write_b8 v7, v66 offset:16
    v_and_b32 v9, -4, v81
    v_lshl_add_u32 v10, v81, 2, v9
    ds_write_b32 v10, v77
    v_lshl_add_u32 v9, v9, 2, v81
    ds_write_b8_d16_hi v9, v66 offset:16
    v_and_b32 v7, -4, v82
    v_lshl_add_u32 v8, v82, 2, v7
    ds_write_b32 v8, v78
    v_lshl_add_u32 v7, v7, 2, v82
    ds_write_b8 v7, v67 offset:16
    v_and_b32 v9, -4, v83
    v_lshl_add_u32 v10, v83, 2, v9
    ds_write_b32 v10, v79
    v_lshl_add_u32 v9, v9, 2, v83
    ds_write_b8_d16_hi v9, v67 offset:16
    s_add_u32 s45, s98, 0x6800000
    s_lshr_b32 s45, s45, 1
    buffer_load_dwordx2 v[56:57], v1, s[16:19], s45 offen nt
    s_add_u32 s46, s99, 0x6c00000
    s_lshr_b32 s46, s46, 1
    buffer_load_dwordx2 v[58:59], v1, s[16:19], s46 offen nt
    s_add_u32 s47, s99, 0x6c00000
    v_lshlrev_b32 v76, 1, v1
    buffer_load_dwordx4 v[76:79], v76, s[8:11], s47 offen nt
    s_setprio 2
    v_and_b32 v7, -4, v104
    v_lshl_add_u32 v8, v104, 2, v7
    ds_write_b32 v8, v96
    v_lshl_add_u32 v7, v7, 2, v104
    ds_write_b8 v7, v88 offset:16
    v_and_b32 v9, -4, v105
    v_lshl_add_u32 v10, v105, 2, v9
    ds_write_b32 v10, v97
    v_lshl_add_u32 v9, v9, 2, v105
    ds_write_b8_d16_hi v9, v88 offset:16
    v_and_b32 v7, -4, v106
    v_lshl_add_u32 v8, v106, 2, v7
    ds_write_b32 v8, v98
    v_lshl_add_u32 v7, v7, 2, v106
    ds_write_b8 v7, v89 offset:16
    v_and_b32 v9, -4, v107
    v_lshl_add_u32 v10, v107, 2, v9
    ds_write_b32 v10, v99
    v_lshl_add_u32 v9, v9, 2, v107
    ds_write_b8_d16_hi v9, v89 offset:16
    s_add_u32 s44, s35, 0x2a48000
    s_add_u32 s44, s44, s91
    buffer_store_dwordx4 v[60:63], v0, s[20:23], s44 offen sc1
    s_add_u32 s45, s99, 0x6c00000
    v_lshlrev_b32 v80, 1, v1
    buffer_load_dwordx4 v[80:83], v80, s[12:15], s45 offen nt
    v_and_b32 v7, -4, v100
    v_lshl_add_u32 v8, v100, 2, v7
    ds_write_b32 v8, v112
    v_lshl_add_u32 v7, v7, 2, v100
    ds_write_b8 v7, v90 offset:16
    v_and_b32 v9, -4, v101
    v_lshl_add_u32 v10, v101, 2, v9
    ds_write_b32 v10, v113
    v_lshl_add_u32 v9, v9, 2, v101
    ds_write_b8_d16_hi v9, v90 offset:16
    v_and_b32 v7, -4, v102
    v_lshl_add_u32 v8, v102, 2, v7
    ds_write_b32 v8, v114
    v_lshl_add_u32 v7, v7, 2, v102
    ds_write_b8 v7, v91 offset:16
    v_and_b32 v9, -4, v103
    v_lshl_add_u32 v10, v103, 2, v9
    ds_write_b32 v10, v115
    v_lshl_add_u32 v9, v9, 2, v103
    ds_write_b8_d16_hi v9, v91 offset:16
    s_add_u32 s46, s96, 0x7000000
    v_lshlrev_b32 v64, 1, v1
    buffer_load_dwordx4 v[64:67], v64, s[8:11], s46 offen nt
    s_add_u32 s47, s96, 0x7000000
    v_lshlrev_b32 v96, 1, v1
    buffer_load_dwordx4 v[96:99], v96, s[12:15], s47 offen nt
    s_setprio 1
    v_and_b32 v7, -4, v116
    v_lshl_add_u32 v8, v116, 2, v7
    ds_write_b32 v8, v108
    v_lshl_add_u32 v7, v7, 2, v116
    ds_write_b8 v7, v120 offset:16
    v_and_b32 v9, -4, v117
    v_lshl_add_u32 v10, v117, 2, v9
    ds_write_b32 v10, v109
    v_lshl_add_u32 v9, v9, 2, v117
    ds_write_b8_d16_hi v9, v120 offset:16
    v_and_b32 v7, -4, v118
    v_lshl_add_u32 v8, v118, 2, v7
    ds_write_b32 v8, v110
    v_lshl_add_u32 v7, v7, 2, v118
    ds_write_b8 v7, v121 offset:16
    v_and_b32 v9, -4, v119
    v_lshl_add_u32 v10, v119, 2, v9
    ds_write_b32 v10, v111
    v_lshl_add_u32 v9, v9, 2, v119
    ds_write_b8_d16_hi v9, v121 offset:16
    s_add_u32 s44, s96, 0x7000000
    s_lshr_b32 s44, s44, 1
    buffer_load_dwordx2 v[104:105], v1, s[16:19], s44 offen nt
    s_add_u32 s45, s97, 0x7400000
    s_lshr_b32 s45, s45, 1
    buffer_load_dwordx2 v[106:107], v1, s[16:19], s45 offen nt
    s_add_u32 s46, s97, 0x7400000
    v_lshlrev_b32 v60, 1, v1
    buffer_load_dwordx4 v[60:63], v60, s[8:11], s46 offen nt
    v_and_b32 v7, -4, v16
    v_lshl_add_u32 v8, v16, 2, v7
    ds_write_b32 v8, v92
    v_lshl_add_u32 v7, v7, 2, v16
    ds_write_b8 v7, v122 offset:16
    v_and_b32 v9, -4, v17
    v_lshl_add_u32 v10, v17, 2, v9
    ds_write_b32 v10, v93
    v_lshl_add_u32 v9, v9, 2, v17
    ds_write_b8_d16_hi v9, v122 offset:16
    v_and_b32 v7, -4, v18
    v_lshl_add_u32 v8, v18, 2, v7
    ds_write_b32 v8, v94
    v_lshl_add_u32 v7, v7, 2, v18
    ds_write_b8 v7, v123 offset:16
    v_and_b32 v9, -4, v19
    v_lshl_add_u32 v10, v19, 2, v9
    ds_write_b32 v10, v95
    v_lshl_add_u32 v9, v9, 2, v19
    ds_write_b8_d16_hi v9, v123 offset:16
    s_add_u32 s47, s35, 0x2a48000
    s_add_u32 s47, s47, s93
    buffer_store_dwordx4 v[44:47], v0, s[20:23], s47 offen sc1
    s_add_u32 s44, s97, 0x7400000
    v_lshlrev_b32 v112, 1, v1
    buffer_load_dwordx4 v[112:115], v112, s[12:15], s44 offen nt
    s_setprio 0
    v_and_b32 v7, -4, v124
    v_lshl_add_u32 v8, v124, 2, v7
    ds_write_b32 v8, v20
    v_lshl_add_u32 v7, v7, 2, v124
    ds_write_b8 v7, v28 offset:16
    v_and_b32 v9, -4, v125
    v_lshl_add_u32 v10, v125, 2, v9
    ds_write_b32 v10, v21
    v_lshl_add_u32 v9, v9, 2, v125
    ds_write_b8_d16_hi v9, v28 offset:16
    v_and_b32 v7, -4, v126
    v_lshl_add_u32 v8, v126, 2, v7
    ds_write_b32 v8, v22
    v_lshl_add_u32 v7, v7, 2, v126
    ds_write_b8 v7, v29 offset:16
    v_and_b32 v9, -4, v127
    v_lshl_add_u32 v10, v127, 2, v9
    ds_write_b32 v10, v23
    v_lshl_add_u32 v9, v9, 2, v127
    ds_write_b8_d16_hi v9, v29 offset:16
    s_add_u32 s45, s98, 0x7800000
    v_lshlrev_b32 v100, 1, v1
    buffer_load_dwordx4 v[100:103], v100, s[8:11], s45 offen nt
    s_add_u32 s46, s98, 0x7800000
    v_lshlrev_b32 v88, 1, v1
    buffer_load_dwordx4 v[88:91], v88, s[12:15], s46 offen nt
    v_and_b32 v7, -4, v36
    v_lshl_add_u32 v8, v36, 2, v7
    ds_write_b32 v8, v32
    v_lshl_add_u32 v7, v7, 2, v36
    ds_write_b8 v7, v30 offset:16
    v_and_b32 v9, -4, v37
    v_lshl_add_u32 v10, v37, 2, v9
    ds_write_b32 v10, v33
    v_lshl_add_u32 v9, v9, 2, v37
    ds_write_b8_d16_hi v9, v30 offset:16
    v_and_b32 v7, -4, v38
    v_lshl_add_u32 v8, v38, 2, v7
    ds_write_b32 v8, v34
    v_lshl_add_u32 v7, v7, 2, v38
    ds_write_b8 v7, v31 offset:16
    v_and_b32 v9, -4, v39
    v_lshl_add_u32 v10, v39, 2, v9
    ds_write_b32 v10, v35
    v_lshl_add_u32 v9, v9, 2, v39
    ds_write_b8_d16_hi v9, v31 offset:16
    s_add_u32 s47, s98, 0x7800000
    s_lshr_b32 s47, s47, 1
    buffer_load_dwordx2 v[108:109], v1, s[16:19], s47 offen nt
    s_add_u32 s44, s99, 0x7c00000
    s_lshr_b32 s44, s44, 1
    buffer_load_dwordx2 v[110:111], v1, s[16:19], s44 offen nt
    v_add_u32 v7, s72, v0
    v_add_u32 v12, s73, v0
    v_add_u32 v13, s85, v0
    v_add_u32 v14, s91, v0
    v_add_u32 v15, s93, v0
    s_min_i32 s3, s72, s73
    s_min_i32 s3, s3, s85
    s_min_i32 s3, s3, s91
    s_min_i32 s3, s3, s93
    v_add_u32 v3, s3, v0
    v_mov_b32 v8, 0
    v_mov_b32 v9, 0
    v_mov_b32 v10, 0
    v_mov_b32 v11, 0
    s_waitcnt lgkmcnt(0)
    s_barrier
    ds_read_b128 v[116:119], v7 offset:0
    ds_read_b128 v[92:95], v12 offset:0
    ds_read_b128 v[16:19], v13 offset:0
    ds_read_b128 v[120:123], v14 offset:0
    ds_read_b128 v[44:47], v15 offset:0
    ds_write_b128 v3, v[8:11]
    ds_read_b128 v[20:23], v7 offset:16384
    ds_read_b128 v[124:127], v12 offset:16384
    ds_read_b128 v[32:35], v13 offset:16384
    ds_read_b128 v[36:39], v14 offset:16384
    ds_read_b128 v[28:31], v15 offset:16384
    s_waitcnt lgkmcnt(0)
    s_barrier
    s_setprio 3
    s_add_u32 s45, s35, 0x5484000
    s_add_u32 s45, s45, s72
    buffer_store_dwordx4 v[116:119], v0, s[20:23], s45 offen sc1
    s_add_u32 s46, s99, 0x7c00000
    s_nop 0
    v_lshlrev_b32 v116, 1, v1
    buffer_load_dwordx4 v[116:119], v116, s[8:11], s46 offen nt
    s_add_u32 s47, s35, 0x5484000
    s_add_u32 s47, s47, s73
    buffer_store_dwordx4 v[92:95], v0, s[20:23], s47 offen sc1
    s_add_u32 s44, s99, 0x7c00000
    s_nop 0
    v_lshlrev_b32 v92, 1, v1
    buffer_load_dwordx4 v[92:95], v92, s[12:15], s44 offen nt
    s_waitcnt vmcnt(27)
    v_lshlrev_b32 v7, 16, v84
    v_and_b32 v8, 0xffff0000, v84
    v_lshlrev_b32 v9, 16, v85
    v_and_b32 v10, 0xffff0000, v85
    v_mul_f32 v7, 0.15915494, v7
    v_mul_f32 v8, 0.15915494, v8
    v_mul_f32 v9, 0.15915494, v9
    v_mul_f32 v10, 0.15915494, v10
    v_mul_hi_u32_u24 v14, 429497, v40
    v_lshrrev_b32 v12, 3, v24
    v_cos_f32 v7, v7
    v_lshlrev_b16 v13, 3, v24
    v_mad_i32_i24 v11, v14, s55, v40
    v_bitop3_b32 v12, v6, v13, v12 bitop3:0xca
    v_lshl_add_u32 v11, v11, 17, s40
    v_lshlrev_b16 v14, 8, v14
    v_lshrrev_b32 v13, 2, v24
    v_add_u32 v40, v12, v11
    v_bitop3_b32 v24, v5, v13, v14 bitop3:0xea
    ds_add_u32 v24, v2
    v_mul_hi_u32_u24 v14, 429497, v41
    v_lshrrev_b32 v12, 3, v25
    v_cos_f32 v8, v8
    v_lshlrev_b16 v13, 3, v25
    v_mad_i32_i24 v11, v14, s55, v41
    v_bitop3_b32 v12, v6, v13, v12 bitop3:0xca
    v_lshl_add_u32 v11, v11, 17, s40
    v_lshlrev_b16 v14, 8, v14
    v_lshrrev_b32 v13, 2, v25
    v_add_u32 v41, v12, v11
    v_bitop3_b32 v25, v5, v13, v14 bitop3:0xea
    ds_add_u32 v25, v2
    v_cvt_pk_bf16_f32 v84, v7, v8
    v_perm_b32 v12, v84, v84, s41
    v_bitop3_b32 v40, v4, v12, v40 bitop3:0xca
    v_perm_b32 v13, v84, v84, s42
    v_bitop3_b32 v41, v4, v13, v41 bitop3:0xca
    v_mul_hi_u32_u24 v14, 429497, v42
    v_lshrrev_b32 v12, 3, v26
    v_cos_f32 v9, v9
    v_lshlrev_b16 v13, 3, v26
    v_mad_i32_i24 v11, v14, s55, v42
    v_bitop3_b32 v12, v6, v13, v12 bitop3:0xca
    v_lshl_add_u32 v11, v11, 17, s40
    v_lshlrev_b16 v14, 8, v14
    v_lshrrev_b32 v13, 2, v26
    v_add_u32 v42, v12, v11
    v_bitop3_b32 v26, v5, v13, v14 bitop3:0xea
    ds_add_u32 v26, v2
    v_mul_hi_u32_u24 v14, 429497, v43
    v_lshrrev_b32 v12, 3, v27
    v_cos_f32 v10, v10
    v_lshlrev_b16 v13, 3, v27
    v_mad_i32_i24 v11, v14, s55, v43
    v_bitop3_b32 v12, v6, v13, v12 bitop3:0xca
    v_lshl_add_u32 v11, v11, 17, s40
    v_lshlrev_b16 v14, 8, v14
    v_lshrrev_b32 v13, 2, v27
    v_add_u32 v43, v12, v11
    v_bitop3_b32 v27, v5, v13, v14 bitop3:0xea
    ds_add_u32 v27, v2
    v_cvt_pk_bf16_f32 v85, v9, v10
    v_perm_b32 v12, v85, v85, s41
    v_bitop3_b32 v42, v4, v12, v42 bitop3:0xca
    v_perm_b32 v13, v85, v85, s42
    v_bitop3_b32 v43, v4, v13, v43 bitop3:0xca
    s_waitcnt vmcnt(23)
    v_lshlrev_b32 v7, 16, v86
    v_and_b32 v8, 0xffff0000, v86
    v_lshlrev_b32 v9, 16, v87
    v_and_b32 v10, 0xffff0000, v87
    v_mul_f32 v7, 0.15915494, v7
    v_mul_f32 v8, 0.15915494, v8
    v_mul_f32 v9, 0.15915494, v9
    v_mul_f32 v10, 0.15915494, v10
    v_mul_hi_u32_u24 v14, 429497, v48
    v_lshrrev_b32 v12, 3, v52
    v_cos_f32 v7, v7
    v_lshlrev_b16 v13, 3, v52
    v_mad_i32_i24 v11, v14, s55, v48
    v_bitop3_b32 v12, v6, v13, v12 bitop3:0xca
    v_lshl_add_u32 v11, v11, 17, s40
    v_lshlrev_b16 v14, 8, v14
    v_lshrrev_b32 v13, 2, v52
    v_add_u32 v48, v12, v11
    v_bitop3_b32 v52, v5, v13, v14 bitop3:0xea
    ds_add_u32 v52, v2
    v_mul_hi_u32_u24 v14, 429497, v49
    v_lshrrev_b32 v12, 3, v53
    v_cos_f32 v8, v8
    v_lshlrev_b16 v13, 3, v53
    v_mad_i32_i24 v11, v14, s55, v49
    v_bitop3_b32 v12, v6, v13, v12 bitop3:0xca
    v_lshl_add_u32 v11, v11, 17, s40
    v_lshlrev_b16 v14, 8, v14
    v_lshrrev_b32 v13, 2, v53
    v_add_u32 v49, v12, v11
    v_bitop3_b32 v53, v5, v13, v14 bitop3:0xea
    ds_add_u32 v53, v2
    v_cvt_pk_bf16_f32 v86, v7, v8
    v_perm_b32 v12, v86, v86, s41
    v_bitop3_b32 v48, v4, v12, v48 bitop3:0xca
    v_perm_b32 v13, v86, v86, s42
    v_bitop3_b32 v49, v4, v13, v49 bitop3:0xca
    v_mul_hi_u32_u24 v14, 429497, v50
    v_lshrrev_b32 v12, 3, v54
    v_cos_f32 v9, v9
    v_lshlrev_b16 v13, 3, v54
    v_mad_i32_i24 v11, v14, s55, v50
    v_bitop3_b32 v12, v6, v13, v12 bitop3:0xca
    v_lshl_add_u32 v11, v11, 17, s40
    v_lshlrev_b16 v14, 8, v14
    v_lshrrev_b32 v13, 2, v54
    v_add_u32 v50, v12, v11
    v_bitop3_b32 v54, v5, v13, v14 bitop3:0xea
    ds_add_u32 v54, v2
    v_mul_hi_u32_u24 v14, 429497, v51
    v_lshrrev_b32 v12, 3, v55
    v_cos_f32 v10, v10
    v_lshlrev_b16 v13, 3, v55
    v_mad_i32_i24 v11, v14, s55, v51
    v_bitop3_b32 v12, v6, v13, v12 bitop3:0xca
    v_lshl_add_u32 v11, v11, 17, s40
    v_lshlrev_b16 v14, 8, v14
    v_lshrrev_b32 v13, 2, v55
    v_add_u32 v51, v12, v11
    v_bitop3_b32 v55, v5, v13, v14 bitop3:0xea
    ds_add_u32 v55, v2
    v_cvt_pk_bf16_f32 v87, v9, v10
    v_perm_b32 v12, v87, v87, s41
    v_bitop3_b32 v50, v4, v12, v50 bitop3:0xca
    v_perm_b32 v13, v87, v87, s42
    v_bitop3_b32 v51, v4, v13, v51 bitop3:0xca
    s_setprio 2
    s_waitcnt vmcnt(18)
    v_lshlrev_b32 v7, 16, v56
    v_and_b32 v8, 0xffff0000, v56
    v_lshlrev_b32 v9, 16, v57
    v_and_b32 v10, 0xffff0000, v57
    v_mul_f32 v7, 0.15915494, v7
    v_mul_f32 v8, 0.15915494, v8
    v_mul_f32 v9, 0.15915494, v9
    v_mul_f32 v10, 0.15915494, v10
    v_mul_hi_u32_u24 v14, 429497, v68
    v_lshrrev_b32 v12, 3, v72
    v_cos_f32 v7, v7
    v_lshlrev_b16 v13, 3, v72
    v_mad_i32_i24 v11, v14, s55, v68
    v_bitop3_b32 v12, v6, v13, v12 bitop3:0xca
    v_lshl_add_u32 v11, v11, 17, s40
    v_lshlrev_b16 v14, 8, v14
    v_lshrrev_b32 v13, 2, v72
    v_add_u32 v68, v12, v11
    v_bitop3_b32 v72, v5, v13, v14 bitop3:0xea
    ds_add_u32 v72, v2
    v_mul_hi_u32_u24 v14, 429497, v69
    v_lshrrev_b32 v12, 3, v73
    v_cos_f32 v8, v8
    v_lshlrev_b16 v13, 3, v73
    v_mad_i32_i24 v11, v14, s55, v69
    v_bitop3_b32 v12, v6, v13, v12 bitop3:0xca
    v_lshl_add_u32 v11, v11, 17, s40
    v_lshlrev_b16 v14, 8, v14
    v_lshrrev_b32 v13, 2, v73
    v_add_u32 v69, v12, v11
    v_bitop3_b32 v73, v5, v13, v14 bitop3:0xea
    ds_add_u32 v73, v2
    v_cvt_pk_bf16_f32 v56, v7, v8
    v_perm_b32 v12, v56, v56, s41
    v_bitop3_b32 v68, v4, v12, v68 bitop3:0xca
    v_perm_b32 v13, v56, v56, s42
    v_bitop3_b32 v69, v4, v13, v69 bitop3:0xca
    v_mul_hi_u32_u24 v14, 429497, v70
    v_lshrrev_b32 v12, 3, v74
    v_cos_f32 v9, v9
    v_lshlrev_b16 v13, 3, v74
    v_mad_i32_i24 v11, v14, s55, v70
    v_bitop3_b32 v12, v6, v13, v12 bitop3:0xca
    v_lshl_add_u32 v11, v11, 17, s40
    v_lshlrev_b16 v14, 8, v14
    v_lshrrev_b32 v13, 2, v74
    v_add_u32 v70, v12, v11
    v_bitop3_b32 v74, v5, v13, v14 bitop3:0xea
    ds_add_u32 v74, v2
    v_mul_hi_u32_u24 v14, 429497, v71
    v_lshrrev_b32 v12, 3, v75
    v_cos_f32 v10, v10
    v_lshlrev_b16 v13, 3, v75
    v_mad_i32_i24 v11, v14, s55, v71
    v_bitop3_b32 v12, v6, v13, v12 bitop3:0xca
    v_lshl_add_u32 v11, v11, 17, s40
    v_lshlrev_b16 v14, 8, v14
    v_lshrrev_b32 v13, 2, v75
    v_add_u32 v71, v12, v11
    v_bitop3_b32 v75, v5, v13, v14 bitop3:0xea
    ds_add_u32 v75, v2
    v_cvt_pk_bf16_f32 v57, v9, v10
    v_perm_b32 v12, v57, v57, s41
    v_bitop3_b32 v70, v4, v12, v70 bitop3:0xca
    v_perm_b32 v13, v57, v57, s42
    v_bitop3_b32 v71, v4, v13, v71 bitop3:0xca
    s_add_u32 s45, s35, 0x5484000
    s_add_u32 s45, s45, s85
    buffer_store_dwordx4 v[16:19], v0, s[20:23], s45 offen sc1
    s_add_u32 s46, s96, 0x8000000
    s_nop 0
    v_lshlrev_b32 v16, 1, v1
    buffer_load_dwordx4 v[16:19], v16, s[8:11], s46 offen nt
    s_waitcnt vmcnt(17)
    v_lshlrev_b32 v7, 16, v58
    v_and_b32 v8, 0xffff0000, v58
    v_lshlrev_b32 v9, 16, v59
    v_and_b32 v10, 0xffff0000, v59
    v_mul_f32 v7, 0.15915494, v7
    v_mul_f32 v8, 0.15915494, v8
    v_mul_f32 v9, 0.15915494, v9
    v_mul_f32 v10, 0.15915494, v10
    v_mul_hi_u32_u24 v14, 429497, v76
    v_lshrrev_b32 v12, 3, v80
    v_cos_f32 v7, v7
    v_lshlrev_b16 v13, 3, v80
    v_mad_i32_i24 v11, v14, s55, v76
    v_bitop3_b32 v12, v6, v13, v12 bitop3:0xca
    v_lshl_add_u32 v11, v11, 17, s40
    v_lshlrev_b16 v14, 8, v14
    v_lshrrev_b32 v13, 2, v80
    v_add_u32 v76, v12, v11
    v_bitop3_b32 v80, v5, v13, v14 bitop3:0xea
    ds_add_u32 v80, v2
    v_mul_hi_u32_u24 v14, 429497, v77
    v_lshrrev_b32 v12, 3, v81
    v_cos_f32 v8, v8
    v_lshlrev_b16 v13, 3, v81
    v_mad_i32_i24 v11, v14, s55, v77
    v_bitop3_b32 v12, v6, v13, v12 bitop3:0xca
    v_lshl_add_u32 v11, v11, 17, s40
    v_lshlrev_b16 v14, 8, v14
    v_lshrrev_b32 v13, 2, v81
    v_add_u32 v77, v12, v11
    v_bitop3_b32 v81, v5, v13, v14 bitop3:0xea
    ds_add_u32 v81, v2
    v_cvt_pk_bf16_f32 v58, v7, v8
    v_perm_b32 v12, v58, v58, s41
    v_bitop3_b32 v76, v4, v12, v76 bitop3:0xca
    v_perm_b32 v13, v58, v58, s42
    v_bitop3_b32 v77, v4, v13, v77 bitop3:0xca
    v_mul_hi_u32_u24 v14, 429497, v78
    v_lshrrev_b32 v12, 3, v82
    v_cos_f32 v9, v9
    v_lshlrev_b16 v13, 3, v82
    v_mad_i32_i24 v11, v14, s55, v78
    v_bitop3_b32 v12, v6, v13, v12 bitop3:0xca
    v_lshl_add_u32 v11, v11, 17, s40
    v_lshlrev_b16 v14, 8, v14
    v_lshrrev_b32 v13, 2, v82
    v_add_u32 v78, v12, v11
    v_bitop3_b32 v82, v5, v13, v14 bitop3:0xea
    ds_add_u32 v82, v2
    v_mul_hi_u32_u24 v14, 429497, v79
    v_lshrrev_b32 v12, 3, v83
    v_cos_f32 v10, v10
    v_lshlrev_b16 v13, 3, v83
    v_mad_i32_i24 v11, v14, s55, v79
    v_bitop3_b32 v12, v6, v13, v12 bitop3:0xca
    v_lshl_add_u32 v11, v11, 17, s40
    v_lshlrev_b16 v14, 8, v14
    v_lshrrev_b32 v13, 2, v83
    v_add_u32 v79, v12, v11
    v_bitop3_b32 v83, v5, v13, v14 bitop3:0xea
    ds_add_u32 v83, v2
    v_cvt_pk_bf16_f32 v59, v9, v10
    v_perm_b32 v12, v59, v59, s41
    v_bitop3_b32 v78, v4, v12, v78 bitop3:0xca
    v_perm_b32 v13, v59, v59, s42
    v_bitop3_b32 v79, v4, v13, v79 bitop3:0xca
    s_setprio 1
    s_waitcnt vmcnt(13)
    v_lshlrev_b32 v7, 16, v104
    v_and_b32 v8, 0xffff0000, v104
    v_lshlrev_b32 v9, 16, v105
    v_and_b32 v10, 0xffff0000, v105
    v_mul_f32 v7, 0.15915494, v7
    v_mul_f32 v8, 0.15915494, v8
    v_mul_f32 v9, 0.15915494, v9
    v_mul_f32 v10, 0.15915494, v10
    v_mul_hi_u32_u24 v14, 429497, v64
    v_lshrrev_b32 v12, 3, v96
    v_cos_f32 v7, v7
    v_lshlrev_b16 v13, 3, v96
    v_mad_i32_i24 v11, v14, s55, v64
    v_bitop3_b32 v12, v6, v13, v12 bitop3:0xca
    v_lshl_add_u32 v11, v11, 17, s40
    v_lshlrev_b16 v14, 8, v14
    v_lshrrev_b32 v13, 2, v96
    v_add_u32 v64, v12, v11
    v_bitop3_b32 v96, v5, v13, v14 bitop3:0xea
    ds_add_u32 v96, v2
    v_mul_hi_u32_u24 v14, 429497, v65
    v_lshrrev_b32 v12, 3, v97
    v_cos_f32 v8, v8
    v_lshlrev_b16 v13, 3, v97
    v_mad_i32_i24 v11, v14, s55, v65
    v_bitop3_b32 v12, v6, v13, v12 bitop3:0xca
    v_lshl_add_u32 v11, v11, 17, s40
    v_lshlrev_b16 v14, 8, v14
    v_lshrrev_b32 v13, 2, v97
    v_add_u32 v65, v12, v11
    v_bitop3_b32 v97, v5, v13, v14 bitop3:0xea
    ds_add_u32 v97, v2
    v_cvt_pk_bf16_f32 v104, v7, v8
    v_perm_b32 v12, v104, v104, s41
    v_bitop3_b32 v64, v4, v12, v64 bitop3:0xca
    v_perm_b32 v13, v104, v104, s42
    v_bitop3_b32 v65, v4, v13, v65 bitop3:0xca
    v_mul_hi_u32_u24 v14, 429497, v66
    v_lshrrev_b32 v12, 3, v98
    v_cos_f32 v9, v9
    v_lshlrev_b16 v13, 3, v98
    v_mad_i32_i24 v11, v14, s55, v66
    v_bitop3_b32 v12, v6, v13, v12 bitop3:0xca
    v_lshl_add_u32 v11, v11, 17, s40
    v_lshlrev_b16 v14, 8, v14
    v_lshrrev_b32 v13, 2, v98
    v_add_u32 v66, v12, v11
    v_bitop3_b32 v98, v5, v13, v14 bitop3:0xea
    ds_add_u32 v98, v2
    v_mul_hi_u32_u24 v14, 429497, v67
    v_lshrrev_b32 v12, 3, v99
    v_cos_f32 v10, v10
    v_lshlrev_b16 v13, 3, v99
    v_mad_i32_i24 v11, v14, s55, v67
    v_bitop3_b32 v12, v6, v13, v12 bitop3:0xca
    v_lshl_add_u32 v11, v11, 17, s40
    v_lshlrev_b16 v14, 8, v14
    v_lshrrev_b32 v13, 2, v99
    v_add_u32 v67, v12, v11
    v_bitop3_b32 v99, v5, v13, v14 bitop3:0xea
    ds_add_u32 v99, v2
    v_cvt_pk_bf16_f32 v105, v9, v10
    v_perm_b32 v12, v105, v105, s41
    v_bitop3_b32 v66, v4, v12, v66 bitop3:0xca
    v_perm_b32 v13, v105, v105, s42
    v_bitop3_b32 v67, v4, v13, v67 bitop3:0xca
    s_waitcnt vmcnt(10)
    v_lshlrev_b32 v7, 16, v106
    v_and_b32 v8, 0xffff0000, v106
    v_lshlrev_b32 v9, 16, v107
    v_and_b32 v10, 0xffff0000, v107
    v_mul_f32 v7, 0.15915494, v7
    v_mul_f32 v8, 0.15915494, v8
    v_mul_f32 v9, 0.15915494, v9
    v_mul_f32 v10, 0.15915494, v10
    v_mul_hi_u32_u24 v14, 429497, v60
    v_lshrrev_b32 v12, 3, v112
    v_cos_f32 v7, v7
    v_lshlrev_b16 v13, 3, v112
    v_mad_i32_i24 v11, v14, s55, v60
    v_bitop3_b32 v12, v6, v13, v12 bitop3:0xca
    v_lshl_add_u32 v11, v11, 17, s40
    v_lshlrev_b16 v14, 8, v14
    v_lshrrev_b32 v13, 2, v112
    v_add_u32 v60, v12, v11
    v_bitop3_b32 v112, v5, v13, v14 bitop3:0xea
    ds_add_u32 v112, v2
    v_mul_hi_u32_u24 v14, 429497, v61
    v_lshrrev_b32 v12, 3, v113
    v_cos_f32 v8, v8
    v_lshlrev_b16 v13, 3, v113
    v_mad_i32_i24 v11, v14, s55, v61
    v_bitop3_b32 v12, v6, v13, v12 bitop3:0xca
    v_lshl_add_u32 v11, v11, 17, s40
    v_lshlrev_b16 v14, 8, v14
    v_lshrrev_b32 v13, 2, v113
    v_add_u32 v61, v12, v11
    v_bitop3_b32 v113, v5, v13, v14 bitop3:0xea
    ds_add_u32 v113, v2
    v_cvt_pk_bf16_f32 v106, v7, v8
    v_perm_b32 v12, v106, v106, s41
    v_bitop3_b32 v60, v4, v12, v60 bitop3:0xca
    v_perm_b32 v13, v106, v106, s42
    v_bitop3_b32 v61, v4, v13, v61 bitop3:0xca
    v_mul_hi_u32_u24 v14, 429497, v62
    v_lshrrev_b32 v12, 3, v114
    v_cos_f32 v9, v9
    v_lshlrev_b16 v13, 3, v114
    v_mad_i32_i24 v11, v14, s55, v62
    v_bitop3_b32 v12, v6, v13, v12 bitop3:0xca
    v_lshl_add_u32 v11, v11, 17, s40
    v_lshlrev_b16 v14, 8, v14
    v_lshrrev_b32 v13, 2, v114
    v_add_u32 v62, v12, v11
    v_bitop3_b32 v114, v5, v13, v14 bitop3:0xea
    ds_add_u32 v114, v2
    v_mul_hi_u32_u24 v14, 429497, v63
    v_lshrrev_b32 v12, 3, v115
    v_cos_f32 v10, v10
    v_lshlrev_b16 v13, 3, v115
    v_mad_i32_i24 v11, v14, s55, v63
    v_bitop3_b32 v12, v6, v13, v12 bitop3:0xca
    v_lshl_add_u32 v11, v11, 17, s40
    v_lshlrev_b16 v14, 8, v14
    v_lshrrev_b32 v13, 2, v115
    v_add_u32 v63, v12, v11
    v_bitop3_b32 v115, v5, v13, v14 bitop3:0xea
    ds_add_u32 v115, v2
    v_cvt_pk_bf16_f32 v107, v9, v10
    v_perm_b32 v12, v107, v107, s41
    v_bitop3_b32 v62, v4, v12, v62 bitop3:0xca
    v_perm_b32 v13, v107, v107, s42
    v_bitop3_b32 v63, v4, v13, v63 bitop3:0xca
    s_setprio 0
    s_add_u32 s47, s35, 0x5484000
    s_add_u32 s47, s47, s91
    buffer_store_dwordx4 v[120:123], v0, s[20:23], s47 offen sc1
    s_add_u32 s44, s96, 0x8000000
    s_nop 0
    v_lshlrev_b32 v120, 1, v1
    buffer_load_dwordx4 v[120:123], v120, s[12:15], s44 offen nt
    s_waitcnt vmcnt(8)
    v_lshlrev_b32 v7, 16, v108
    v_and_b32 v8, 0xffff0000, v108
    v_lshlrev_b32 v9, 16, v109
    v_and_b32 v10, 0xffff0000, v109
    v_mul_f32 v7, 0.15915494, v7
    v_mul_f32 v8, 0.15915494, v8
    v_mul_f32 v9, 0.15915494, v9
    v_mul_f32 v10, 0.15915494, v10
    v_mul_hi_u32_u24 v14, 429497, v100
    v_lshrrev_b32 v12, 3, v88
    v_cos_f32 v7, v7
    v_lshlrev_b16 v13, 3, v88
    v_mad_i32_i24 v11, v14, s55, v100
    v_bitop3_b32 v12, v6, v13, v12 bitop3:0xca
    v_lshl_add_u32 v11, v11, 17, s40
    v_lshlrev_b16 v14, 8, v14
    v_lshrrev_b32 v13, 2, v88
    v_add_u32 v100, v12, v11
    v_bitop3_b32 v88, v5, v13, v14 bitop3:0xea
    ds_add_u32 v88, v2
    v_mul_hi_u32_u24 v14, 429497, v101
    v_lshrrev_b32 v12, 3, v89
    v_cos_f32 v8, v8
    v_lshlrev_b16 v13, 3, v89
    v_mad_i32_i24 v11, v14, s55, v101
    v_bitop3_b32 v12, v6, v13, v12 bitop3:0xca
    v_lshl_add_u32 v11, v11, 17, s40
    v_lshlrev_b16 v14, 8, v14
    v_lshrrev_b32 v13, 2, v89
    v_add_u32 v101, v12, v11
    v_bitop3_b32 v89, v5, v13, v14 bitop3:0xea
    ds_add_u32 v89, v2
    v_cvt_pk_bf16_f32 v108, v7, v8
    v_perm_b32 v12, v108, v108, s41
    v_bitop3_b32 v100, v4, v12, v100 bitop3:0xca
    v_perm_b32 v13, v108, v108, s42
    v_bitop3_b32 v101, v4, v13, v101 bitop3:0xca
    v_mul_hi_u32_u24 v14, 429497, v102
    v_lshrrev_b32 v12, 3, v90
    v_cos_f32 v9, v9
    v_lshlrev_b16 v13, 3, v90
    v_mad_i32_i24 v11, v14, s55, v102
    v_bitop3_b32 v12, v6, v13, v12 bitop3:0xca
    v_lshl_add_u32 v11, v11, 17, s40
    v_lshlrev_b16 v14, 8, v14
    v_lshrrev_b32 v13, 2, v90
    v_add_u32 v102, v12, v11
    v_bitop3_b32 v90, v5, v13, v14 bitop3:0xea
    ds_add_u32 v90, v2
    v_mul_hi_u32_u24 v14, 429497, v103
    v_lshrrev_b32 v12, 3, v91
    v_cos_f32 v10, v10
    v_lshlrev_b16 v13, 3, v91
    v_mad_i32_i24 v11, v14, s55, v103
    v_bitop3_b32 v12, v6, v13, v12 bitop3:0xca
    v_lshl_add_u32 v11, v11, 17, s40
    v_lshlrev_b16 v14, 8, v14
    v_lshrrev_b32 v13, 2, v91
    v_add_u32 v103, v12, v11
    v_bitop3_b32 v91, v5, v13, v14 bitop3:0xea
    ds_add_u32 v91, v2
    v_cvt_pk_bf16_f32 v109, v9, v10
    v_perm_b32 v12, v109, v109, s41
    v_bitop3_b32 v102, v4, v12, v102 bitop3:0xca
    v_perm_b32 v13, v109, v109, s42
    v_bitop3_b32 v103, v4, v13, v103 bitop3:0xca
    s_mov_b32 s68, s66
    s_mov_b32 s69, s67
    s_mov_b32 s70, 0x100
    s_mov_b32 s71, 0x20000
    v_mov_b32 v3, 1
    s_cmp_lg_u32 s32, 15
    s_cbranch_scc1 L1_tk
    s_mov_b64 exec, 1
    s_and_b32 s3, s2, 1
    s_lshl_b32 s3, s3, 7
    buffer_atomic_add v3, off, s[68:71], s3 sc0
    s_mov_b64 exec, -1
L1_tk:
    s_waitcnt vmcnt(4)
    v_lshlrev_b32 v7, 16, v110
    v_and_b32 v8, 0xffff0000, v110
    v_lshlrev_b32 v9, 16, v111
    v_and_b32 v10, 0xffff0000, v111
    v_mul_f32 v7, 0.15915494, v7
    v_mul_f32 v8, 0.15915494, v8
    v_mul_f32 v9, 0.15915494, v9
    v_mul_f32 v10, 0.15915494, v10
    v_mul_hi_u32_u24 v14, 429497, v116
    v_lshrrev_b32 v12, 3, v92
    v_cos_f32 v7, v7
    v_lshlrev_b16 v13, 3, v92
    v_mad_i32_i24 v11, v14, s55, v116
    v_bitop3_b32 v12, v6, v13, v12 bitop3:0xca
    v_lshl_add_u32 v11, v11, 17, s40
    v_lshlrev_b16 v14, 8, v14
    v_lshrrev_b32 v13, 2, v92
    v_add_u32 v116, v12, v11
    v_bitop3_b32 v92, v5, v13, v14 bitop3:0xea
    ds_add_u32 v92, v2
    v_mul_hi_u32_u24 v14, 429497, v117
    v_lshrrev_b32 v12, 3, v93
    v_cos_f32 v8, v8
    v_lshlrev_b16 v13, 3, v93
    v_mad_i32_i24 v11, v14, s55, v117
    v_bitop3_b32 v12, v6, v13, v12 bitop3:0xca
    v_lshl_add_u32 v11, v11, 17, s40
    v_lshlrev_b16 v14, 8, v14
    v_lshrrev_b32 v13, 2, v93
    v_add_u32 v117, v12, v11
    v_bitop3_b32 v93, v5, v13, v14 bitop3:0xea
    ds_add_u32 v93, v2
    v_cvt_pk_bf16_f32 v110, v7, v8
    v_perm_b32 v12, v110, v110, s41
    v_bitop3_b32 v116, v4, v12, v116 bitop3:0xca
    v_perm_b32 v13, v110, v110, s42
    v_bitop3_b32 v117, v4, v13, v117 bitop3:0xca
    v_mul_hi_u32_u24 v14, 429497, v118
    v_lshrrev_b32 v12, 3, v94
    v_cos_f32 v9, v9
    v_lshlrev_b16 v13, 3, v94
    v_mad_i32_i24 v11, v14, s55, v118
    v_bitop3_b32 v12, v6, v13, v12 bitop3:0xca
    v_lshl_add_u32 v11, v11, 17, s40
    v_lshlrev_b16 v14, 8, v14
    v_lshrrev_b32 v13, 2, v94
    v_add_u32 v118, v12, v11
    v_bitop3_b32 v94, v5, v13, v14 bitop3:0xea
    ds_add_u32 v94, v2
    v_mul_hi_u32_u24 v14, 429497, v119
    v_lshrrev_b32 v12, 3, v95
    v_cos_f32 v10, v10
    v_lshlrev_b16 v13, 3, v95
    v_mad_i32_i24 v11, v14, s55, v119
    v_bitop3_b32 v12, v6, v13, v12 bitop3:0xca
    v_lshl_add_u32 v11, v11, 17, s40
    v_lshlrev_b16 v14, 8, v14
    v_lshrrev_b32 v13, 2, v95
    v_add_u32 v119, v12, v11
    v_bitop3_b32 v95, v5, v13, v14 bitop3:0xea
    ds_add_u32 v95, v2
    v_cvt_pk_bf16_f32 v111, v9, v10
    v_perm_b32 v12, v111, v111, s41
    v_bitop3_b32 v118, v4, v12, v118 bitop3:0xca
    v_perm_b32 v13, v111, v111, s42
    v_bitop3_b32 v119, v4, v13, v119 bitop3:0xca
    v_lshrrev_b32 v8, 2, v0
    v_and_b32 v7, 0x3c00, v0
    v_bitop3_b32 v7, v5, v8, v7 bitop3:0xea
    s_waitcnt lgkmcnt(0)
    s_barrier
    ds_read2st64_b32 v[8:9], v7 offset0:0 offset1:1
    ds_read2st64_b32 v[10:11], v7 offset0:2 offset1:3
    s_add_u32 s45, s35, 0x5484000
    s_add_u32 s45, s45, s93
    buffer_store_dwordx4 v[44:47], v0, s[20:23], s45 offen sc1
    s_add_u32 s46, s96, 0x8000000
    s_lshr_b32 s46, s46, 1
    buffer_load_dwordx2 v[44:45], v1, s[16:19], s46 offen nt
    s_add_u32 s47, s97, 0x8400000
    s_lshr_b32 s47, s47, 1
    buffer_load_dwordx2 v[46:47], v1, s[16:19], s47 offen nt
    s_waitcnt lgkmcnt(0)
    v_lshl_or_b32 v12, v9, 16, v8
    v_lshl_or_b32 v13, v11, 16, v10
    v_mov_b32 v14, v12
    v_mov_b32 v15, v13
    s_nop 0
    v_add_u32_dpp v14, v14, v14 row_shr:1 row_mask:0xf bank_mask:0xf bound_ctrl:1
    v_add_u32_dpp v15, v15, v15 row_shr:1 row_mask:0xf bank_mask:0xf bound_ctrl:1
    s_nop 0
    v_add_u32_dpp v14, v14, v14 row_shr:2 row_mask:0xf bank_mask:0xf bound_ctrl:1
    v_add_u32_dpp v15, v15, v15 row_shr:2 row_mask:0xf bank_mask:0xf bound_ctrl:1
    s_nop 0
    v_add_u32_dpp v14, v14, v14 row_shr:4 row_mask:0xf bank_mask:0xf bound_ctrl:1
    v_add_u32_dpp v15, v15, v15 row_shr:4 row_mask:0xf bank_mask:0xf bound_ctrl:1
    s_nop 0
    v_add_u32_dpp v14, v14, v14 row_shr:8 row_mask:0xf bank_mask:0xf bound_ctrl:1
    v_add_u32_dpp v15, v15, v15 row_shr:8 row_mask:0xf bank_mask:0xf bound_ctrl:1
    s_nop 0
    v_add_u32_dpp v14, v14, v14 row_bcast:15 row_mask:0xa bank_mask:0xf
    v_add_u32_dpp v15, v15, v15 row_bcast:15 row_mask:0xa bank_mask:0xf
    s_nop 0
    v_add_u32_dpp v14, v14, v14 row_bcast:31 row_mask:0xc bank_mask:0xf
    v_add_u32_dpp v15, v15, v15 row_bcast:31 row_mask:0xc bank_mask:0xf
    v_readlane_b32 s48, v14, 63
    v_readlane_b32 s49, v15, 63
    s_lshl_b32 s54, s32, 2
    v_mov_b32 v8, s54
    s_and_b32 s50, s48, 0xffff
    s_lshr_b32 s51, s48, 16
    s_and_b32 s52, s49, 0xffff
    s_lshr_b32 s53, s49, 16
    s_add_u32 s51, s51, s50
    s_add_u32 s52, s52, s51
    s_add_u32 s53, s53, s52
    v_mov_b32 v9, s53
    s_mov_b64 exec, 1
    ds_write_b32 v8, v9 offset:16384
    s_waitcnt vmcnt(3)
    ds_write_b32 v8, v3 offset:16448
    s_mov_b64 exec, -1
    v_and_b32 v8, 60, v7
    s_waitcnt lgkmcnt(0)
    s_barrier
    ds_read_b32 v9, v8 offset:16384
    ds_read_b32 v10, v8 offset:16448
    s_waitcnt lgkmcnt(0)
    v_readlane_b32 s84, v10, 15
    s_and_b32 s3, s2, 1
    s_lshl_b32 s3, s3, 7
    s_add_u32 s84, s84, s3
    s_min_u32 s4, s84, 96
    s_min_u32 s5, s84, 192
    s_min_u32 s6, s84, 240
    s_add_u32 s4, s4, s5
    s_add_u32 s4, s4, s6
    s_add_u32 s4, s4, 9467
    s_mov_b32 s4, s84
    s_lshl_b32 s58, s4, 14
    s_lshl_b32 s5, s32, 10
    s_add_u32 s58, s58, s5
    s_lshr_b32 s59, s58, 1
    s_mov_b32 s43, 5
    s_cmp_lt_u32 s84, 96
    s_addc_u32 s43, s43, 0
    s_cmp_lt_u32 s84, 192
    s_addc_u32 s43, s43, 0
    s_cmp_lt_u32 s84, 240
    s_addc_u32 s43, s43, 0
    v_add_u32_dpp v9, v9, v9 row_shr:1 row_mask:0xf bank_mask:0xf bound_ctrl:1
    s_nop 1
    v_add_u32_dpp v9, v9, v9 row_shr:2 row_mask:0xf bank_mask:0xf bound_ctrl:1
    s_nop 1
    v_add_u32_dpp v9, v9, v9 row_shr:4 row_mask:0xf bank_mask:0xf bound_ctrl:1
    s_nop 1
    v_add_u32_dpp v9, v9, v9 row_shr:8 row_mask:0xf bank_mask:0xf bound_ctrl:1
    s_nop 0
    v_readlane_b32 s54, v9, s32
    s_sub_u32 s54, s54, s53
    s_add_u32 s50, s50, s54
    s_add_u32 s51, s51, s54
    s_add_u32 s52, s52, s54
    s_pack_ll_b32_b16 s48, s54, s50
    s_pack_ll_b32_b16 s49, s51, s52
    v_add_u32 v14, s48, v14
    v_add_u32 v15, s49, v15
    v_sub_u32 v12, v14, v12
    v_sub_u32 v13, v15, v13
    v_and_b32 v8, 0xffff, v12
    v_lshrrev_b32 v9, 16, v12
    v_and_b32 v10, 0xffff, v13
    v_lshrrev_b32 v11, 16, v13
    ds_write2st64_b32 v7, v8, v9 offset0:0 offset1:1
    ds_write2st64_b32 v7, v10, v11 offset0:2 offset1:3
    v_and_b32 v8, 0x3f0, v0
    v_lshl_add_u32 v8, v8, 1, s36
    ds_write_b64 v8, v[12:13] offset:20480
    s_bitset0_b64 exec, 63
    s_not_b64 exec, exec
    ds_write_b64 v8, v[14:15] offset:20512
    s_mov_b64 exec, -1
    s_waitcnt lgkmcnt(0)
    s_barrier
    s_setprio 3
    ds_add_rtn_u32 v24, v24, v2
    ds_add_rtn_u32 v25, v25, v2
    ds_add_rtn_u32 v26, v26, v2
    ds_add_rtn_u32 v27, v27, v2
    ds_read_b128 v[12:15], v0 offset:20480
    v_cmp_gt_u32 vcc, 8448, v0
    ds_add_rtn_u32 v52, v52, v2
    ds_add_rtn_u32 v53, v53, v2
    ds_add_rtn_u32 v54, v54, v2
    ds_add_rtn_u32 v55, v55, v2
    s_setprio 2
    ds_add_rtn_u32 v72, v72, v2
    ds_add_rtn_u32 v73, v73, v2
    ds_add_rtn_u32 v74, v74, v2
    ds_add_rtn_u32 v75, v75, v2
    s_waitcnt lgkmcnt(8)
    s_cbranch_vccz L1_p4
    s_add_u32 s44, s35, 0x7ec0000
    s_mov_b64 exec, vcc
    buffer_store_dwordx4 v[12:15], v0, s[24:27], s44 offen sc1
    s_mov_b64 exec, -1
L1_p4:
    s_add_u32 s45, s35, 0x5488000
    s_add_u32 s45, s45, s72
    buffer_store_dwordx4 v[20:23], v0, s[20:23], s45 offen sc1
    s_add_u32 s46, s97, 0x8400000
    s_nop 0
    v_lshlrev_b32 v20, 1, v1
    buffer_load_dwordx4 v[20:23], v20, s[8:11], s46 offen nt
    ds_add_rtn_u32 v80, v80, v2
    ds_add_rtn_u32 v81, v81, v2
    ds_add_rtn_u32 v82, v82, v2
    ds_add_rtn_u32 v83, v83, v2
    s_setprio 1
    ds_add_rtn_u32 v96, v96, v2
    ds_add_rtn_u32 v97, v97, v2
    ds_add_rtn_u32 v98, v98, v2
    ds_add_rtn_u32 v99, v99, v2
    ds_add_rtn_u32 v112, v112, v2
    ds_add_rtn_u32 v113, v113, v2
    ds_add_rtn_u32 v114, v114, v2
    ds_add_rtn_u32 v115, v115, v2
    s_add_u32 s47, s35, 0x5488000
    s_add_u32 s47, s47, s73
    buffer_store_dwordx4 v[124:127], v0, s[20:23], s47 offen sc1
    s_add_u32 s44, s97, 0x8400000
    s_nop 0
    v_lshlrev_b32 v124, 1, v1
    buffer_load_dwordx4 v[124:127], v124, s[12:15], s44 offen nt
    s_setprio 0
    ds_add_rtn_u32 v88, v88, v2
    ds_add_rtn_u32 v89, v89, v2
    ds_add_rtn_u32 v90, v90, v2
    ds_add_rtn_u32 v91, v91, v2
    ds_add_rtn_u32 v92, v92, v2
    ds_add_rtn_u32 v93, v93, v2
    ds_add_rtn_u32 v94, v94, v2
    ds_add_rtn_u32 v95, v95, v2
    s_waitcnt lgkmcnt(0)
    s_barrier
    s_setprio 3
    v_and_b32 v7, -4, v24
    v_lshl_add_u32 v8, v24, 2, v7
    ds_write_b32 v8, v40
    v_lshl_add_u32 v7, v7, 2, v24
    ds_write_b8 v7, v84 offset:16
    v_and_b32 v9, -4, v25
    v_lshl_add_u32 v10, v25, 2, v9
    ds_write_b32 v10, v41
    v_lshl_add_u32 v9, v9, 2, v25
    ds_write_b8_d16_hi v9, v84 offset:16
    v_and_b32 v7, -4, v26
    v_lshl_add_u32 v8, v26, 2, v7
    ds_write_b32 v8, v42
    v_lshl_add_u32 v7, v7, 2, v26
    ds_write_b8 v7, v85 offset:16
    v_and_b32 v9, -4, v27
    v_lshl_add_u32 v10, v27, 2, v9
    ds_write_b32 v10, v43
    v_lshl_add_u32 v9, v9, 2, v27
    ds_write_b8_d16_hi v9, v85 offset:16
    s_add_u32 s45, s35, 0x5488000
    s_add_u32 s45, s45, s85
    buffer_store_dwordx4 v[32:35], v0, s[20:23], s45 offen sc1
    s_add_u32 s46, s98, 0x8800000
    v_lshlrev_b32 v40, 1, v1
    buffer_load_dwordx4 v[40:43], v40, s[8:11], s46 offen nt
    s_add_u32 s47, s98, 0x8800000
    v_lshlrev_b32 v24, 1, v1
    buffer_load_dwordx4 v[24:27], v24, s[12:15], s47 offen nt
    v_and_b32 v7, -4, v52
    v_lshl_add_u32 v8, v52, 2, v7
    ds_write_b32 v8, v48
    v_lshl_add_u32 v7, v7, 2, v52
    ds_write_b8 v7, v86 offset:16
    v_and_b32 v9, -4, v53
    v_lshl_add_u32 v10, v53, 2, v9
    ds_write_b32 v10, v49
    v_lshl_add_u32 v9, v9, 2, v53
    ds_write_b8_d16_hi v9, v86 offset:16
    v_and_b32 v7, -4, v54
    v_lshl_add_u32 v8, v54, 2, v7
    ds_write_b32 v8, v50
    v_lshl_add_u32 v7, v7, 2, v54
    ds_write_b8 v7, v87 offset:16
    v_and_b32 v9, -4, v55
    v_lshl_add_u32 v10, v55, 2, v9
    ds_write_b32 v10, v51
    v_lshl_add_u32 v9, v9, 2, v55
    ds_write_b8_d16_hi v9, v87 offset:16
    s_add_u32 s44, s98, 0x8800000
    s_lshr_b32 s44, s44, 1
    buffer_load_dwordx2 v[32:33], v1, s[16:19], s44 offen nt
    s_add_u32 s45, s99, 0x8c00000
    s_lshr_b32 s45, s45, 1
    buffer_load_dwordx2 v[34:35], v1, s[16:19], s45 offen nt
    s_add_u32 s46, s99, 0x8c00000
    v_lshlrev_b32 v48, 1, v1
    buffer_load_dwordx4 v[48:51], v48, s[8:11], s46 offen nt
    s_setprio 2
    v_and_b32 v7, -4, v72
    v_lshl_add_u32 v8, v72, 2, v7
    ds_write_b32 v8, v68
    v_lshl_add_u32 v7, v7, 2, v72
    ds_write_b8 v7, v56 offset:16
    v_and_b32 v9, -4, v73
    v_lshl_add_u32 v10, v73, 2, v9
    ds_write_b32 v10, v69
    v_lshl_add_u32 v9, v9, 2, v73
    ds_write_b8_d16_hi v9, v56 offset:16
    v_and_b32 v7, -4, v74
    v_lshl_add_u32 v8, v74, 2, v7
    ds_write_b32 v8, v70
    v_lshl_add_u32 v7, v7, 2, v74
    ds_write_b8 v7, v57 offset:16
    v_and_b32 v9, -4, v75
    v_lshl_add_u32 v10, v75, 2, v9
    ds_write_b32 v10, v71
    v_lshl_add_u32 v9, v9, 2, v75
    ds_write_b8_d16_hi v9, v57 offset:16
    s_add_u32 s47, s35, 0x5488000
    s_add_u32 s47, s47, s91
    buffer_store_dwordx4 v[36:39], v0, s[20:23], s47 offen sc1
    s_add_u32 s44, s99, 0x8c00000
    v_lshlrev_b32 v52, 1, v1
    buffer_load_dwordx4 v[52:55], v52, s[12:15], s44 offen nt
    v_and_b32 v7, -4, v80
    v_lshl_add_u32 v8, v80, 2, v7
    ds_write_b32 v8, v76
    v_lshl_add_u32 v7, v7, 2, v80
    ds_write_b8 v7, v58 offset:16
    v_and_b32 v9, -4, v81
    v_lshl_add_u32 v10, v81, 2, v9
    ds_write_b32 v10, v77
    v_lshl_add_u32 v9, v9, 2, v81
    ds_write_b8_d16_hi v9, v58 offset:16
    v_and_b32 v7, -4, v82
    v_lshl_add_u32 v8, v82, 2, v7
    ds_write_b32 v8, v78
    v_lshl_add_u32 v7, v7, 2, v82
    ds_write_b8 v7, v59 offset:16
    v_and_b32 v9, -4, v83
    v_lshl_add_u32 v10, v83, 2, v9
    ds_write_b32 v10, v79
    v_lshl_add_u32 v9, v9, 2, v83
    ds_write_b8_d16_hi v9, v59 offset:16
    s_add_u32 s45, s96, 0x9000000
    v_lshlrev_b32 v84, 1, v1
    buffer_load_dwordx4 v[84:87], v84, s[8:11], s45 offen nt
    s_add_u32 s46, s96, 0x9000000
    v_lshlrev_b32 v68, 1, v1
    buffer_load_dwordx4 v[68:71], v68, s[12:15], s46 offen nt
    s_setprio 1
    v_and_b32 v7, -4, v96
    v_lshl_add_u32 v8, v96, 2, v7
    ds_write_b32 v8, v64
    v_lshl_add_u32 v7, v7, 2, v96
    ds_write_b8 v7, v104 offset:16
    v_and_b32 v9, -4, v97
    v_lshl_add_u32 v10, v97, 2, v9
    ds_write_b32 v10, v65
    v_lshl_add_u32 v9, v9, 2, v97
    ds_write_b8_d16_hi v9, v104 offset:16
    v_and_b32 v7, -4, v98
    v_lshl_add_u32 v8, v98, 2, v7
    ds_write_b32 v8, v66
    v_lshl_add_u32 v7, v7, 2, v98
    ds_write_b8 v7, v105 offset:16
    v_and_b32 v9, -4, v99
    v_lshl_add_u32 v10, v99, 2, v9
    ds_write_b32 v10, v67
    v_lshl_add_u32 v9, v9, 2, v99
    ds_write_b8_d16_hi v9, v105 offset:16
    s_add_u32 s47, s96, 0x9000000
    s_lshr_b32 s47, s47, 1
    buffer_load_dwordx2 v[72:73], v1, s[16:19], s47 offen nt
    s_cmp_le_u32 s43, 5
    s_cselect_b32 s18, 0, s18
    s_add_u32 s44, s59, 0x4a00000
    buffer_load_dwordx2 v[74:75], v1, s[16:19], s44 offen nt
    s_cmp_le_u32 s43, 5
    s_cselect_b32 s10, 0, s10
    s_add_u32 s45, s58, 0x9400000
    v_lshlrev_b32 v36, 1, v1
    buffer_load_dwordx4 v[36:39], v36, s[8:11], s45 offen nt
    v_and_b32 v7, -4, v112
    v_lshl_add_u32 v8, v112, 2, v7
    ds_write_b32 v8, v60
    v_lshl_add_u32 v7, v7, 2, v112
    ds_write_b8 v7, v106 offset:16
    v_and_b32 v9, -4, v113
    v_lshl_add_u32 v10, v113, 2, v9
    ds_write_b32 v10, v61
    v_lshl_add_u32 v9, v9, 2, v113
    ds_write_b8_d16_hi v9, v106 offset:16
    v_and_b32 v7, -4, v114
    v_lshl_add_u32 v8, v114, 2, v7
    ds_write_b32 v8, v62
    v_lshl_add_u32 v7, v7, 2, v114
    ds_write_b8 v7, v107 offset:16
    v_and_b32 v9, -4, v115
    v_lshl_add_u32 v10, v115, 2, v9
    ds_write_b32 v10, v63
    v_lshl_add_u32 v9, v9, 2, v115
    ds_write_b8_d16_hi v9, v107 offset:16
    s_add_u32 s46, s35, 0x5488000
    s_add_u32 s46, s46, s93
    buffer_store_dwordx4 v[28:31], v0, s[20:23], s46 offen sc1
    s_cmp_le_u32 s43, 5
    s_cselect_b32 s14, 0, s14
    s_add_u32 s47, s58, 0x9400000
    v_lshlrev_b32 v76, 1, v1
    buffer_load_dwordx4 v[76:79], v76, s[12:15], s47 offen nt
    s_setprio 0
    v_and_b32 v7, -4, v88
    v_lshl_add_u32 v8, v88, 2, v7
    ds_write_b32 v8, v100
    v_lshl_add_u32 v7, v7, 2, v88
    ds_write_b8 v7, v108 offset:16
    v_and_b32 v9, -4, v89
    v_lshl_add_u32 v10, v89, 2, v9
    ds_write_b32 v10, v101
    v_lshl_add_u32 v9, v9, 2, v89
    ds_write_b8_d16_hi v9, v108 offset:16
    v_and_b32 v7, -4, v90
    v_lshl_add_u32 v8, v90, 2, v7
    ds_write_b32 v8, v102
    v_lshl_add_u32 v7, v7, 2, v90
    ds_write_b8 v7, v109 offset:16
    v_and_b32 v9, -4, v91
    v_lshl_add_u32 v10, v91, 2, v9
    ds_write_b32 v10, v103
    v_lshl_add_u32 v9, v9, 2, v91
    ds_write_b8_d16_hi v9, v109 offset:16
    s_cmp_le_u32 s43, 6
    s_cselect_b32 s10, 0, s10
    s_add_u32 s44, s58, 0x97c0000
    v_lshlrev_b32 v80, 1, v1
    buffer_load_dwordx4 v[80:83], v80, s[8:11], s44 offen nt
    s_cmp_le_u32 s43, 6
    s_cselect_b32 s14, 0, s14
    s_add_u32 s45, s58, 0x97c0000
    v_lshlrev_b32 v56, 1, v1
    buffer_load_dwordx4 v[56:59], v56, s[12:15], s45 offen nt
    v_and_b32 v7, -4, v92
    v_lshl_add_u32 v8, v92, 2, v7
    ds_write_b32 v8, v116
    v_lshl_add_u32 v7, v7, 2, v92
    ds_write_b8 v7, v110 offset:16
    v_and_b32 v9, -4, v93
    v_lshl_add_u32 v10, v93, 2, v9
    ds_write_b32 v10, v117
    v_lshl_add_u32 v9, v9, 2, v93
    ds_write_b8_d16_hi v9, v110 offset:16
    v_and_b32 v7, -4, v94
    v_lshl_add_u32 v8, v94, 2, v7
    ds_write_b32 v8, v118
    v_lshl_add_u32 v7, v7, 2, v94
    ds_write_b8 v7, v111 offset:16
    v_and_b32 v9, -4, v95
    v_lshl_add_u32 v10, v95, 2, v9
    ds_write_b32 v10, v119
    v_lshl_add_u32 v9, v9, 2, v95
    ds_write_b8_d16_hi v9, v111 offset:16
    s_cmp_le_u32 s43, 6
    s_cselect_b32 s18, 0, s18
    s_add_u32 s46, s59, 0x4be0000
    buffer_load_dwordx2 v[64:65], v1, s[16:19], s46 offen nt
    s_cmp_le_u32 s43, 7
    s_cselect_b32 s18, 0, s18
    s_add_u32 s47, s59, 0x4d60000
    buffer_load_dwordx2 v[66:67], v1, s[16:19], s47 offen nt
    v_add_u32 v7, s72, v0
    v_add_u32 v12, s73, v0
    v_add_u32 v13, s85, v0
    v_add_u32 v14, s91, v0
    v_add_u32 v15, s93, v0
    s_min_i32 s3, s72, s73
    s_min_i32 s3, s3, s85
    s_min_i32 s3, s3, s91
    s_min_i32 s3, s3, s93
    v_add_u32 v3, s3, v0
    v_mov_b32 v8, 0
    v_mov_b32 v9, 0
    v_mov_b32 v10, 0
    v_mov_b32 v11, 0
    s_waitcnt lgkmcnt(0)
    s_barrier
    ds_read_b128 v[96:99], v7 offset:0
    ds_read_b128 v[60:63], v12 offset:0
    ds_read_b128 v[112:115], v13 offset:0
    ds_read_b128 v[104:107], v14 offset:0
    ds_read_b128 v[28:31], v15 offset:0
    ds_write_b128 v3, v[8:11]
    ds_read_b128 v[100:103], v7 offset:16384
    ds_read_b128 v[88:91], v12 offset:16384
    ds_read_b128 v[116:119], v13 offset:16384
    ds_read_b128 v[92:95], v14 offset:16384
    ds_read_b128 v[108:111], v15 offset:16384
    s_waitcnt lgkmcnt(0)
    s_barrier
    v_lshlrev_b32 v3, 3, v0
    v_and_b32 v3, 0x80, v3
    s_cmp_lg_u32 s32, 15
    s_cbranch_scc1 L2_k0
    s_mov_b64 exec, 3
    buffer_load_dword v3, v3, s[68:71], 0 offen sc1
    s_mov_b64 exec, -1
L2_k0:
    s_add_u32 s44, s35, 0x7ec4000
    s_add_u32 s44, s44, s72
    buffer_store_dwordx4 v[96:99], v0, s[20:23], s44 offen sc1
    s_cmp_le_u32 s43, 7
    s_cselect_b32 s10, 0, s10
    s_add_u32 s45, s58, 0x9ac0000
    v_lshlrev_b32 v96, 1, v1
    buffer_load_dwordx4 v[96:99], v96, s[8:11], s45 offen nt
    s_add_u32 s46, s35, 0x7ec4000
    s_add_u32 s46, s46, s73
    buffer_store_dwordx4 v[60:63], v0, s[20:23], s46 offen sc1
    s_cmp_le_u32 s43, 7
    s_cselect_b32 s14, 0, s14
    s_add_u32 s47, s58, 0x9ac0000
    v_lshlrev_b32 v60, 1, v1
    buffer_load_dwordx4 v[60:63], v60, s[12:15], s47 offen nt
    s_setprio 3
    s_waitcnt vmcnt(27)
    v_lshlrev_b32 v7, 16, v44
    v_and_b32 v8, 0xffff0000, v44
    v_lshlrev_b32 v9, 16, v45
    v_and_b32 v10, 0xffff0000, v45
    v_mul_f32 v7, 0.15915494, v7
    v_mul_f32 v8, 0.15915494, v8
    v_mul_f32 v9, 0.15915494, v9
    v_mul_f32 v10, 0.15915494, v10
    v_mul_hi_u32_u24 v14, 429497, v16
    v_lshrrev_b32 v12, 3, v120
    v_cos_f32 v7, v7
    v_lshlrev_b16 v13, 3, v120
    v_mad_i32_i24 v11, v14, s55, v16
    v_bitop3_b32 v12, v6, v13, v12 bitop3:0xca
    v_lshl_add_u32 v11, v11, 17, s40
    v_lshlrev_b16 v14, 8, v14
    v_lshrrev_b32 v13, 2, v120
    v_add_u32 v16, v12, v11
    v_bitop3_b32 v120, v5, v13, v14 bitop3:0xea
    ds_add_u32 v120, v2
    v_mul_hi_u32_u24 v14, 429497, v17
    v_lshrrev_b32 v12, 3, v121
    v_cos_f32 v8, v8
    v_lshlrev_b16 v13, 3, v121
    v_mad_i32_i24 v11, v14, s55, v17
    v_bitop3_b32 v12, v6, v13, v12 bitop3:0xca
    v_lshl_add_u32 v11, v11, 17, s40
    v_lshlrev_b16 v14, 8, v14
    v_lshrrev_b32 v13, 2, v121
    v_add_u32 v17, v12, v11
    v_bitop3_b32 v121, v5, v13, v14 bitop3:0xea
    ds_add_u32 v121, v2
    v_cvt_pk_bf16_f32 v44, v7, v8
    v_perm_b32 v12, v44, v44, s41
    v_bitop3_b32 v16, v4, v12, v16 bitop3:0xca
    v_perm_b32 v13, v44, v44, s42
    v_bitop3_b32 v17, v4, v13, v17 bitop3:0xca
    v_mul_hi_u32_u24 v14, 429497, v18
    v_lshrrev_b32 v12, 3, v122
    v_cos_f32 v9, v9
    v_lshlrev_b16 v13, 3, v122
    v_mad_i32_i24 v11, v14, s55, v18
    v_bitop3_b32 v12, v6, v13, v12 bitop3:0xca
    v_lshl_add_u32 v11, v11, 17, s40
    v_lshlrev_b16 v14, 8, v14
    v_lshrrev_b32 v13, 2, v122
    v_add_u32 v18, v12, v11
    v_bitop3_b32 v122, v5, v13, v14 bitop3:0xea
    ds_add_u32 v122, v2
    v_mul_hi_u32_u24 v14, 429497, v19
    v_lshrrev_b32 v12, 3, v123
    v_cos_f32 v10, v10
    v_lshlrev_b16 v13, 3, v123
    v_mad_i32_i24 v11, v14, s55, v19
    v_bitop3_b32 v12, v6, v13, v12 bitop3:0xca
    v_lshl_add_u32 v11, v11, 17, s40
    v_lshlrev_b16 v14, 8, v14
    v_lshrrev_b32 v13, 2, v123
    v_add_u32 v19, v12, v11
    v_bitop3_b32 v123, v5, v13, v14 bitop3:0xea
    ds_add_u32 v123, v2
    v_cvt_pk_bf16_f32 v45, v9, v10
    v_perm_b32 v12, v45, v45, s41
    v_bitop3_b32 v18, v4, v12, v18 bitop3:0xca
    v_perm_b32 v13, v45, v45, s42
    v_bitop3_b32 v19, v4, v13, v19 bitop3:0xca
    s_add_u32 s44, s35, 0x7ec4000
    s_add_u32 s44, s44, s85
    buffer_store_dwordx4 v[112:115], v0, s[20:23], s44 offen sc1
    s_waitcnt vmcnt(24)
    v_lshlrev_b32 v7, 16, v46
    v_and_b32 v8, 0xffff0000, v46
    v_lshlrev_b32 v9, 16, v47
    v_and_b32 v10, 0xffff0000, v47
    v_mul_f32 v7, 0.15915494, v7
    v_mul_f32 v8, 0.15915494, v8
    v_mul_f32 v9, 0.15915494, v9
    v_mul_f32 v10, 0.15915494, v10
    v_mul_hi_u32_u24 v14, 429497, v20
    v_lshrrev_b32 v12, 3, v124
    v_cos_f32 v7, v7
    v_lshlrev_b16 v13, 3, v124
    v_mad_i32_i24 v11, v14, s55, v20
    v_bitop3_b32 v12, v6, v13, v12 bitop3:0xca
    v_lshl_add_u32 v11, v11, 17, s40
    v_lshlrev_b16 v14, 8, v14
    v_lshrrev_b32 v13, 2, v124
    v_add_u32 v20, v12, v11
    v_bitop3_b32 v124, v5, v13, v14 bitop3:0xea
    ds_add_u32 v124, v2
    v_mul_hi_u32_u24 v14, 429497, v21
    v_lshrrev_b32 v12, 3, v125
    v_cos_f32 v8, v8
    v_lshlrev_b16 v13, 3, v125
    v_mad_i32_i24 v11, v14, s55, v21
    v_bitop3_b32 v12, v6, v13, v12 bitop3:0xca
    v_lshl_add_u32 v11, v11, 17, s40
    v_lshlrev_b16 v14, 8, v14
    v_lshrrev_b32 v13, 2, v125
    v_add_u32 v21, v12, v11
    v_bitop3_b32 v125, v5, v13, v14 bitop3:0xea
    ds_add_u32 v125, v2
    v_cvt_pk_bf16_f32 v46, v7, v8
    v_perm_b32 v12, v46, v46, s41
    v_bitop3_b32 v20, v4, v12, v20 bitop3:0xca
    v_perm_b32 v13, v46, v46, s42
    v_bitop3_b32 v21, v4, v13, v21 bitop3:0xca
    v_mul_hi_u32_u24 v14, 429497, v22
    v_lshrrev_b32 v12, 3, v126
    v_cos_f32 v9, v9
    v_lshlrev_b16 v13, 3, v126
    v_mad_i32_i24 v11, v14, s55, v22
    v_bitop3_b32 v12, v6, v13, v12 bitop3:0xca
    v_lshl_add_u32 v11, v11, 17, s40
    v_lshlrev_b16 v14, 8, v14
    v_lshrrev_b32 v13, 2, v126
    v_add_u32 v22, v12, v11
    v_bitop3_b32 v126, v5, v13, v14 bitop3:0xea
    ds_add_u32 v126, v2
    v_mul_hi_u32_u24 v14, 429497, v23
    v_lshrrev_b32 v12, 3, v127
    v_cos_f32 v10, v10
    v_lshlrev_b16 v13, 3, v127
    v_mad_i32_i24 v11, v14, s55, v23
    v_bitop3_b32 v12, v6, v13, v12 bitop3:0xca
    v_lshl_add_u32 v11, v11, 17, s40
    v_lshlrev_b16 v14, 8, v14
    v_lshrrev_b32 v13, 2, v127
    v_add_u32 v23, v12, v11
    v_bitop3_b32 v127, v5, v13, v14 bitop3:0xea
    ds_add_u32 v127, v2
    v_cvt_pk_bf16_f32 v47, v9, v10
    v_perm_b32 v12, v47, v47, s41
    v_bitop3_b32 v22, v4, v12, v22 bitop3:0xca
    v_perm_b32 v13, v47, v47, s42
    v_bitop3_b32 v23, v4, v13, v23 bitop3:0xca
    s_setprio 2
    s_add_u32 s45, s35, 0x7ec4000
    s_add_u32 s45, s45, s91
    buffer_store_dwordx4 v[104:107], v0, s[20:23], s45 offen sc1
    s_waitcnt vmcnt(20)
    v_lshlrev_b32 v7, 16, v32
    v_and_b32 v8, 0xffff0000, v32
    v_lshlrev_b32 v9, 16, v33
    v_and_b32 v10, 0xffff0000, v33
    v_mul_f32 v7, 0.15915494, v7
    v_mul_f32 v8, 0.15915494, v8
    v_mul_f32 v9, 0.15915494, v9
    v_mul_f32 v10, 0.15915494, v10
    v_mul_hi_u32_u24 v14, 429497, v40
    v_lshrrev_b32 v12, 3, v24
    v_cos_f32 v7, v7
    v_lshlrev_b16 v13, 3, v24
    v_mad_i32_i24 v11, v14, s55, v40
    v_bitop3_b32 v12, v6, v13, v12 bitop3:0xca
    v_lshl_add_u32 v11, v11, 17, s40
    v_lshlrev_b16 v14, 8, v14
    v_lshrrev_b32 v13, 2, v24
    v_add_u32 v40, v12, v11
    v_bitop3_b32 v24, v5, v13, v14 bitop3:0xea
    ds_add_u32 v24, v2
    v_mul_hi_u32_u24 v14, 429497, v41
    v_lshrrev_b32 v12, 3, v25
    v_cos_f32 v8, v8
    v_lshlrev_b16 v13, 3, v25
    v_mad_i32_i24 v11, v14, s55, v41
    v_bitop3_b32 v12, v6, v13, v12 bitop3:0xca
    v_lshl_add_u32 v11, v11, 17, s40
    v_lshlrev_b16 v14, 8, v14
    v_lshrrev_b32 v13, 2, v25
    v_add_u32 v41, v12, v11
    v_bitop3_b32 v25, v5, v13, v14 bitop3:0xea
    ds_add_u32 v25, v2
    v_cvt_pk_bf16_f32 v32, v7, v8
    v_perm_b32 v12, v32, v32, s41
    v_bitop3_b32 v40, v4, v12, v40 bitop3:0xca
    v_perm_b32 v13, v32, v32, s42
    v_bitop3_b32 v41, v4, v13, v41 bitop3:0xca
    v_mul_hi_u32_u24 v14, 429497, v42
    v_lshrrev_b32 v12, 3, v26
    v_cos_f32 v9, v9
    v_lshlrev_b16 v13, 3, v26
    v_mad_i32_i24 v11, v14, s55, v42
    v_bitop3_b32 v12, v6, v13, v12 bitop3:0xca
    v_lshl_add_u32 v11, v11, 17, s40
    v_lshlrev_b16 v14, 8, v14
    v_lshrrev_b32 v13, 2, v26
    v_add_u32 v42, v12, v11
    v_bitop3_b32 v26, v5, v13, v14 bitop3:0xea
    ds_add_u32 v26, v2
    v_mul_hi_u32_u24 v14, 429497, v43
    v_lshrrev_b32 v12, 3, v27
    v_cos_f32 v10, v10
    v_lshlrev_b16 v13, 3, v27
    v_mad_i32_i24 v11, v14, s55, v43
    v_bitop3_b32 v12, v6, v13, v12 bitop3:0xca
    v_lshl_add_u32 v11, v11, 17, s40
    v_lshlrev_b16 v14, 8, v14
    v_lshrrev_b32 v13, 2, v27
    v_add_u32 v43, v12, v11
    v_bitop3_b32 v27, v5, v13, v14 bitop3:0xea
    ds_add_u32 v27, v2
    v_cvt_pk_bf16_f32 v33, v9, v10
    v_perm_b32 v12, v33, v33, s41
    v_bitop3_b32 v42, v4, v12, v42 bitop3:0xca
    v_perm_b32 v13, v33, v33, s42
    v_bitop3_b32 v43, v4, v13, v43 bitop3:0xca
    s_waitcnt vmcnt(17)
    v_lshlrev_b32 v7, 16, v34
    v_and_b32 v8, 0xffff0000, v34
    v_lshlrev_b32 v9, 16, v35
    v_and_b32 v10, 0xffff0000, v35
    v_mul_f32 v7, 0.15915494, v7
    v_mul_f32 v8, 0.15915494, v8
    v_mul_f32 v9, 0.15915494, v9
    v_mul_f32 v10, 0.15915494, v10
    v_mul_hi_u32_u24 v14, 429497, v48
    v_lshrrev_b32 v12, 3, v52
    v_cos_f32 v7, v7
    v_lshlrev_b16 v13, 3, v52
    v_mad_i32_i24 v11, v14, s55, v48
    v_bitop3_b32 v12, v6, v13, v12 bitop3:0xca
    v_lshl_add_u32 v11, v11, 17, s40
    v_lshlrev_b16 v14, 8, v14
    v_lshrrev_b32 v13, 2, v52
    v_add_u32 v48, v12, v11
    v_bitop3_b32 v52, v5, v13, v14 bitop3:0xea
    ds_add_u32 v52, v2
    v_mul_hi_u32_u24 v14, 429497, v49
    v_lshrrev_b32 v12, 3, v53
    v_cos_f32 v8, v8
    v_lshlrev_b16 v13, 3, v53
    v_mad_i32_i24 v11, v14, s55, v49
    v_bitop3_b32 v12, v6, v13, v12 bitop3:0xca
    v_lshl_add_u32 v11, v11, 17, s40
    v_lshlrev_b16 v14, 8, v14
    v_lshrrev_b32 v13, 2, v53
    v_add_u32 v49, v12, v11
    v_bitop3_b32 v53, v5, v13, v14 bitop3:0xea
    ds_add_u32 v53, v2
    v_cvt_pk_bf16_f32 v34, v7, v8
    v_perm_b32 v12, v34, v34, s41
    v_bitop3_b32 v48, v4, v12, v48 bitop3:0xca
    v_perm_b32 v13, v34, v34, s42
    v_bitop3_b32 v49, v4, v13, v49 bitop3:0xca
    v_mul_hi_u32_u24 v14, 429497, v50
    v_lshrrev_b32 v12, 3, v54
    v_cos_f32 v9, v9
    v_lshlrev_b16 v13, 3, v54
    v_mad_i32_i24 v11, v14, s55, v50
    v_bitop3_b32 v12, v6, v13, v12 bitop3:0xca
    v_lshl_add_u32 v11, v11, 17, s40
    v_lshlrev_b16 v14, 8, v14
    v_lshrrev_b32 v13, 2, v54
    v_add_u32 v50, v12, v11
    v_bitop3_b32 v54, v5, v13, v14 bitop3:0xea
    ds_add_u32 v54, v2
    v_mul_hi_u32_u24 v14, 429497, v51
    v_lshrrev_b32 v12, 3, v55
    v_cos_f32 v10, v10
    v_lshlrev_b16 v13, 3, v55
    v_mad_i32_i24 v11, v14, s55, v51
    v_bitop3_b32 v12, v6, v13, v12 bitop3:0xca
    v_lshl_add_u32 v11, v11, 17, s40
    v_lshlrev_b16 v14, 8, v14
    v_lshrrev_b32 v13, 2, v55
    v_add_u32 v51, v12, v11
    v_bitop3_b32 v55, v5, v13, v14 bitop3:0xea
    ds_add_u32 v55, v2
    v_cvt_pk_bf16_f32 v35, v9, v10
    v_perm_b32 v12, v35, v35, s41
    v_bitop3_b32 v50, v4, v12, v50 bitop3:0xca
    v_perm_b32 v13, v35, v35, s42
    v_bitop3_b32 v51, v4, v13, v51 bitop3:0xca
    s_setprio 1
    s_add_u32 s46, s35, 0x7ec4000
    s_add_u32 s46, s46, s93
    buffer_store_dwordx4 v[28:31], v0, s[20:23], s46 offen sc1
    v_lshrrev_b32 v15, 2, v0
    v_and_b32 v15, v5, v15
    s_cmp_ge_u32 s84, 128
    s_cselect_b32 s82, 0, s82
    s_and_b32 s3, s84, 1
    s_mul_i32 s3, s3, 40
    s_add_u32 s3, s3, s32
    s_mul_i32 s4, s3, 205
    s_lshr_b32 s4, s4, 10
    s_mul_i32 s5, s4, 5
    s_sub_u32 s5, s3, s5
    s_lshl_b32 s6, s4, 1
    s_add_u32 s6, s6, s5
    s_add_u32 s7, s6, s4
    s_add_u32 s7, s7, 30
    s_cmp_lt_u32 s5, 2
    s_cselect_b32 s6, s6, s7
    s_lshl_b32 s6, s6, 10
    s_lshr_b32 s7, s84, 1
    s_mul_i32 s7, s7, 80000
    s_add_u32 s6, s6, s7
    buffer_load_dword v112, v15, s[80:83], s6 offen offset:0
    buffer_load_dword v113, v15, s[80:83], s6 offen offset:256
    buffer_load_dword v114, v15, s[80:83], s6 offen offset:512
    buffer_load_dword v115, v15, s[80:83], s6 offen offset:768
    s_and_b32 s3, s84, 1
    s_mul_i32 s3, s3, 40
    s_add_u32 s3, s3, s32
    s_add_u32 s3, s3, 16
    s_mul_i32 s4, s3, 205
    s_lshr_b32 s4, s4, 10
    s_mul_i32 s5, s4, 5
    s_sub_u32 s5, s3, s5
    s_lshl_b32 s6, s4, 1
    s_add_u32 s6, s6, s5
    s_add_u32 s7, s6, s4
    s_add_u32 s7, s7, 30
    s_cmp_lt_u32 s5, 2
    s_cselect_b32 s6, s6, s7
    s_lshl_b32 s6, s6, 10
    s_lshr_b32 s7, s84, 1
    s_mul_i32 s7, s7, 80000
    s_add_u32 s6, s6, s7
    buffer_load_dword v104, v15, s[80:83], s6 offen offset:0
    buffer_load_dword v105, v15, s[80:83], s6 offen offset:256
    buffer_load_dword v106, v15, s[80:83], s6 offen offset:512
    buffer_load_dword v107, v15, s[80:83], s6 offen offset:768
    s_and_b32 s3, s84, 1
    s_mul_i32 s3, s3, 40
    s_add_u32 s3, s3, s32
    s_add_u32 s3, s3, 32
    s_cmp_ge_u32 s32, 8
    s_cselect_b32 s82, 0, s82
    s_mul_i32 s4, s3, 205
    s_lshr_b32 s4, s4, 10
    s_mul_i32 s5, s4, 5
    s_sub_u32 s5, s3, s5
    s_lshl_b32 s6, s4, 1
    s_add_u32 s6, s6, s5
    s_add_u32 s7, s6, s4
    s_add_u32 s7, s7, 30
    s_cmp_lt_u32 s5, 2
    s_cselect_b32 s6, s6, s7
    s_lshl_b32 s6, s6, 10
    s_lshr_b32 s7, s84, 1
    s_mul_i32 s7, s7, 80000
    s_add_u32 s6, s6, s7
    buffer_load_dword v28, v15, s[80:83], s6 offen offset:0
    buffer_load_dword v29, v15, s[80:83], s6 offen offset:256
    buffer_load_dword v30, v15, s[80:83], s6 offen offset:512
    buffer_load_dword v31, v15, s[80:83], s6 offen offset:768
    s_waitcnt vmcnt(26)
    v_lshlrev_b32 v7, 16, v72
    v_and_b32 v8, 0xffff0000, v72
    v_lshlrev_b32 v9, 16, v73
    v_and_b32 v10, 0xffff0000, v73
    v_mul_f32 v7, 0.15915494, v7
    v_mul_f32 v8, 0.15915494, v8
    v_mul_f32 v9, 0.15915494, v9
    v_mul_f32 v10, 0.15915494, v10
    v_mul_hi_u32_u24 v14, 429497, v84
    v_lshrrev_b32 v12, 3, v68
    v_cos_f32 v7, v7
    v_lshlrev_b16 v13, 3, v68
    v_mad_i32_i24 v11, v14, s55, v84
    v_bitop3_b32 v12, v6, v13, v12 bitop3:0xca
    v_lshl_add_u32 v11, v11, 17, s40
    v_lshlrev_b16 v14, 8, v14
    v_lshrrev_b32 v13, 2, v68
    v_add_u32 v84, v12, v11
    v_bitop3_b32 v68, v5, v13, v14 bitop3:0xea
    ds_add_u32 v68, v2
    v_mul_hi_u32_u24 v14, 429497, v85
    v_lshrrev_b32 v12, 3, v69
    v_cos_f32 v8, v8
    v_lshlrev_b16 v13, 3, v69
    v_mad_i32_i24 v11, v14, s55, v85
    v_bitop3_b32 v12, v6, v13, v12 bitop3:0xca
    v_lshl_add_u32 v11, v11, 17, s40
    v_lshlrev_b16 v14, 8, v14
    v_lshrrev_b32 v13, 2, v69
    v_add_u32 v85, v12, v11
    v_bitop3_b32 v69, v5, v13, v14 bitop3:0xea
    ds_add_u32 v69, v2
    v_cvt_pk_bf16_f32 v72, v7, v8
    v_perm_b32 v12, v72, v72, s41
    v_bitop3_b32 v84, v4, v12, v84 bitop3:0xca
    v_perm_b32 v13, v72, v72, s42
    v_bitop3_b32 v85, v4, v13, v85 bitop3:0xca
    v_mul_hi_u32_u24 v14, 429497, v86
    v_lshrrev_b32 v12, 3, v70
    v_cos_f32 v9, v9
    v_lshlrev_b16 v13, 3, v70
    v_mad_i32_i24 v11, v14, s55, v86
    v_bitop3_b32 v12, v6, v13, v12 bitop3:0xca
    v_lshl_add_u32 v11, v11, 17, s40
    v_lshlrev_b16 v14, 8, v14
    v_lshrrev_b32 v13, 2, v70
    v_add_u32 v86, v12, v11
    v_bitop3_b32 v70, v5, v13, v14 bitop3:0xea
    ds_add_u32 v70, v2
    v_mul_hi_u32_u24 v14, 429497, v87
    v_lshrrev_b32 v12, 3, v71
    v_cos_f32 v10, v10
    v_lshlrev_b16 v13, 3, v71
    v_mad_i32_i24 v11, v14, s55, v87
    v_bitop3_b32 v12, v6, v13, v12 bitop3:0xca
    v_lshl_add_u32 v11, v11, 17, s40
    v_lshlrev_b16 v14, 8, v14
    v_lshrrev_b32 v13, 2, v71
    v_add_u32 v87, v12, v11
    v_bitop3_b32 v71, v5, v13, v14 bitop3:0xea
    ds_add_u32 v71, v2
    v_cvt_pk_bf16_f32 v73, v9, v10
    v_perm_b32 v12, v73, v73, s41
    v_bitop3_b32 v86, v4, v12, v86 bitop3:0xca
    v_perm_b32 v13, v73, v73, s42
    v_bitop3_b32 v87, v4, v13, v87 bitop3:0xca
    s_waitcnt vmcnt(23)
    s_cmp_le_u32 s43, 5
    s_cbranch_scc1 L1_s5
    v_lshlrev_b32 v7, 16, v74
    v_and_b32 v8, 0xffff0000, v74
    v_lshlrev_b32 v9, 16, v75
    v_and_b32 v10, 0xffff0000, v75
    v_mul_f32 v7, 0.15915494, v7
    v_mul_f32 v8, 0.15915494, v8
    v_mul_f32 v9, 0.15915494, v9
    v_mul_f32 v10, 0.15915494, v10
    v_mul_hi_u32_u24 v14, 429497, v36
    v_lshrrev_b32 v12, 3, v76
    v_cos_f32 v7, v7
    v_lshlrev_b16 v13, 3, v76
    v_mad_i32_i24 v11, v14, s55, v36
    v_bitop3_b32 v12, v6, v13, v12 bitop3:0xca
    v_lshl_add_u32 v11, v11, 17, s40
    v_lshlrev_b16 v14, 8, v14
    v_lshrrev_b32 v13, 2, v76
    v_add_u32 v36, v12, v11
    v_bitop3_b32 v76, v5, v13, v14 bitop3:0xea
    ds_add_u32 v76, v2
    v_mul_hi_u32_u24 v14, 429497, v37
    v_lshrrev_b32 v12, 3, v77
    v_cos_f32 v8, v8
    v_lshlrev_b16 v13, 3, v77
    v_mad_i32_i24 v11, v14, s55, v37
    v_bitop3_b32 v12, v6, v13, v12 bitop3:0xca
    v_lshl_add_u32 v11, v11, 17, s40
    v_lshlrev_b16 v14, 8, v14
    v_lshrrev_b32 v13, 2, v77
    v_add_u32 v37, v12, v11
    v_bitop3_b32 v77, v5, v13, v14 bitop3:0xea
    ds_add_u32 v77, v2
    v_cvt_pk_bf16_f32 v74, v7, v8
    v_perm_b32 v12, v74, v74, s41
    v_bitop3_b32 v36, v4, v12, v36 bitop3:0xca
    v_perm_b32 v13, v74, v74, s42
    v_bitop3_b32 v37, v4, v13, v37 bitop3:0xca
    v_mul_hi_u32_u24 v14, 429497, v38
    v_lshrrev_b32 v12, 3, v78
    v_cos_f32 v9, v9
    v_lshlrev_b16 v13, 3, v78
    v_mad_i32_i24 v11, v14, s55, v38
    v_bitop3_b32 v12, v6, v13, v12 bitop3:0xca
    v_lshl_add_u32 v11, v11, 17, s40
    v_lshlrev_b16 v14, 8, v14
    v_lshrrev_b32 v13, 2, v78
    v_add_u32 v38, v12, v11
    v_bitop3_b32 v78, v5, v13, v14 bitop3:0xea
    ds_add_u32 v78, v2
    v_mul_hi_u32_u24 v14, 429497, v39
    v_lshrrev_b32 v12, 3, v79
    v_cos_f32 v10, v10
    v_lshlrev_b16 v13, 3, v79
    v_mad_i32_i24 v11, v14, s55, v39
    v_bitop3_b32 v12, v6, v13, v12 bitop3:0xca
    v_lshl_add_u32 v11, v11, 17, s40
    v_lshlrev_b16 v14, 8, v14
    v_lshrrev_b32 v13, 2, v79
    v_add_u32 v39, v12, v11
    v_bitop3_b32 v79, v5, v13, v14 bitop3:0xea
    ds_add_u32 v79, v2
    v_cvt_pk_bf16_f32 v75, v9, v10
    v_perm_b32 v12, v75, v75, s41
    v_bitop3_b32 v38, v4, v12, v38 bitop3:0xca
    v_perm_b32 v13, v75, v75, s42
    v_bitop3_b32 v39, v4, v13, v39 bitop3:0xca
L1_s5:
    s_setprio 0
    s_waitcnt vmcnt(19)
    s_cmp_le_u32 s43, 6
    s_cbranch_scc1 L1_s6
    v_lshlrev_b32 v7, 16, v64
    v_and_b32 v8, 0xffff0000, v64
    v_lshlrev_b32 v9, 16, v65
    v_and_b32 v10, 0xffff0000, v65
    v_mul_f32 v7, 0.15915494, v7
    v_mul_f32 v8, 0.15915494, v8
    v_mul_f32 v9, 0.15915494, v9
    v_mul_f32 v10, 0.15915494, v10
    v_mul_hi_u32_u24 v14, 429497, v80
    v_lshrrev_b32 v12, 3, v56
    v_cos_f32 v7, v7
    v_lshlrev_b16 v13, 3, v56
    v_mad_i32_i24 v11, v14, s55, v80
    v_bitop3_b32 v12, v6, v13, v12 bitop3:0xca
    v_lshl_add_u32 v11, v11, 17, s40
    v_lshlrev_b16 v14, 8, v14
    v_lshrrev_b32 v13, 2, v56
    v_add_u32 v80, v12, v11
    v_bitop3_b32 v56, v5, v13, v14 bitop3:0xea
    ds_add_u32 v56, v2
    v_mul_hi_u32_u24 v14, 429497, v81
    v_lshrrev_b32 v12, 3, v57
    v_cos_f32 v8, v8
    v_lshlrev_b16 v13, 3, v57
    v_mad_i32_i24 v11, v14, s55, v81
    v_bitop3_b32 v12, v6, v13, v12 bitop3:0xca
    v_lshl_add_u32 v11, v11, 17, s40
    v_lshlrev_b16 v14, 8, v14
    v_lshrrev_b32 v13, 2, v57
    v_add_u32 v81, v12, v11
    v_bitop3_b32 v57, v5, v13, v14 bitop3:0xea
    ds_add_u32 v57, v2
    v_cvt_pk_bf16_f32 v64, v7, v8
    v_perm_b32 v12, v64, v64, s41
    v_bitop3_b32 v80, v4, v12, v80 bitop3:0xca
    v_perm_b32 v13, v64, v64, s42
    v_bitop3_b32 v81, v4, v13, v81 bitop3:0xca
    v_mul_hi_u32_u24 v14, 429497, v82
    v_lshrrev_b32 v12, 3, v58
    v_cos_f32 v9, v9
    v_lshlrev_b16 v13, 3, v58
    v_mad_i32_i24 v11, v14, s55, v82
    v_bitop3_b32 v12, v6, v13, v12 bitop3:0xca
    v_lshl_add_u32 v11, v11, 17, s40
    v_lshlrev_b16 v14, 8, v14
    v_lshrrev_b32 v13, 2, v58
    v_add_u32 v82, v12, v11
    v_bitop3_b32 v58, v5, v13, v14 bitop3:0xea
    ds_add_u32 v58, v2
    v_mul_hi_u32_u24 v14, 429497, v83
    v_lshrrev_b32 v12, 3, v59
    v_cos_f32 v10, v10
    v_lshlrev_b16 v13, 3, v59
    v_mad_i32_i24 v11, v14, s55, v83
    v_bitop3_b32 v12, v6, v13, v12 bitop3:0xca
    v_lshl_add_u32 v11, v11, 17, s40
    v_lshlrev_b16 v14, 8, v14
    v_lshrrev_b32 v13, 2, v59
    v_add_u32 v83, v12, v11
    v_bitop3_b32 v59, v5, v13, v14 bitop3:0xea
    ds_add_u32 v59, v2
    v_cvt_pk_bf16_f32 v65, v9, v10
    v_perm_b32 v12, v65, v65, s41
    v_bitop3_b32 v82, v4, v12, v82 bitop3:0xca
    v_perm_b32 v13, v65, v65, s42
    v_bitop3_b32 v83, v4, v13, v83 bitop3:0xca
L1_s6:
    s_waitcnt vmcnt(15)
    s_cmp_le_u32 s43, 7
    s_cbranch_scc1 L1_s7
    v_lshlrev_b32 v7, 16, v66
    v_and_b32 v8, 0xffff0000, v66
    v_lshlrev_b32 v9, 16, v67
    v_and_b32 v10, 0xffff0000, v67
    v_mul_f32 v7, 0.15915494, v7
    v_mul_f32 v8, 0.15915494, v8
    v_mul_f32 v9, 0.15915494, v9
    v_mul_f32 v10, 0.15915494, v10
    v_mul_hi_u32_u24 v14, 429497, v96
    v_lshrrev_b32 v12, 3, v60
    v_cos_f32 v7, v7
    v_lshlrev_b16 v13, 3, v60
    v_mad_i32_i24 v11, v14, s55, v96
    v_bitop3_b32 v12, v6, v13, v12 bitop3:0xca
    v_lshl_add_u32 v11, v11, 17, s40
    v_lshlrev_b16 v14, 8, v14
    v_lshrrev_b32 v13, 2, v60
    v_add_u32 v96, v12, v11
    v_bitop3_b32 v60, v5, v13, v14 bitop3:0xea
    ds_add_u32 v60, v2
    v_mul_hi_u32_u24 v14, 429497, v97
    v_lshrrev_b32 v12, 3, v61
    v_cos_f32 v8, v8
    v_lshlrev_b16 v13, 3, v61
    v_mad_i32_i24 v11, v14, s55, v97
    v_bitop3_b32 v12, v6, v13, v12 bitop3:0xca
    v_lshl_add_u32 v11, v11, 17, s40
    v_lshlrev_b16 v14, 8, v14
    v_lshrrev_b32 v13, 2, v61
    v_add_u32 v97, v12, v11
    v_bitop3_b32 v61, v5, v13, v14 bitop3:0xea
    ds_add_u32 v61, v2
    v_cvt_pk_bf16_f32 v66, v7, v8
    v_perm_b32 v12, v66, v66, s41
    v_bitop3_b32 v96, v4, v12, v96 bitop3:0xca
    v_perm_b32 v13, v66, v66, s42
    v_bitop3_b32 v97, v4, v13, v97 bitop3:0xca
    v_mul_hi_u32_u24 v14, 429497, v98
    v_lshrrev_b32 v12, 3, v62
    v_cos_f32 v9, v9
    v_lshlrev_b16 v13, 3, v62
    v_mad_i32_i24 v11, v14, s55, v98
    v_bitop3_b32 v12, v6, v13, v12 bitop3:0xca
    v_lshl_add_u32 v11, v11, 17, s40
    v_lshlrev_b16 v14, 8, v14
    v_lshrrev_b32 v13, 2, v62
    v_add_u32 v98, v12, v11
    v_bitop3_b32 v62, v5, v13, v14 bitop3:0xea
    ds_add_u32 v62, v2
    v_mul_hi_u32_u24 v14, 429497, v99
    v_lshrrev_b32 v12, 3, v63
    v_cos_f32 v10, v10
    v_lshlrev_b16 v13, 3, v63
    v_mad_i32_i24 v11, v14, s55, v99
    v_bitop3_b32 v12, v6, v13, v12 bitop3:0xca
    v_lshl_add_u32 v11, v11, 17, s40
    v_lshlrev_b16 v14, 8, v14
    v_lshrrev_b32 v13, 2, v63
    v_add_u32 v99, v12, v11
    v_bitop3_b32 v63, v5, v13, v14 bitop3:0xea
    ds_add_u32 v63, v2
    v_cvt_pk_bf16_f32 v67, v9, v10
    v_perm_b32 v12, v67, v67, s41
    v_bitop3_b32 v98, v4, v12, v98 bitop3:0xca
    v_perm_b32 v13, v67, v67, s42
    v_bitop3_b32 v99, v4, v13, v99 bitop3:0xca
L1_s7:
    v_lshrrev_b32 v8, 2, v0
    v_and_b32 v7, 0x3c00, v0
    v_bitop3_b32 v7, v5, v8, v7 bitop3:0xea
    s_waitcnt lgkmcnt(0)
    s_barrier
    ds_read2st64_b32 v[8:9], v7 offset0:0 offset1:1
    ds_read2st64_b32 v[10:11], v7 offset0:2 offset1:3
    s_add_u32 s47, s35, 0x7ec8000
    s_add_u32 s47, s47, s72
    buffer_store_dwordx4 v[100:103], v0, s[20:23], s47 offen sc1
    s_waitcnt lgkmcnt(0)
    v_lshl_or_b32 v12, v9, 16, v8
    v_lshl_or_b32 v13, v11, 16, v10
    v_mov_b32 v14, v12
    v_mov_b32 v15, v13
    s_nop 0
    v_add_u32_dpp v14, v14, v14 row_shr:1 row_mask:0xf bank_mask:0xf bound_ctrl:1
    v_add_u32_dpp v15, v15, v15 row_shr:1 row_mask:0xf bank_mask:0xf bound_ctrl:1
    s_nop 0
    v_add_u32_dpp v14, v14, v14 row_shr:2 row_mask:0xf bank_mask:0xf bound_ctrl:1
    v_add_u32_dpp v15, v15, v15 row_shr:2 row_mask:0xf bank_mask:0xf bound_ctrl:1
    s_nop 0
    v_add_u32_dpp v14, v14, v14 row_shr:4 row_mask:0xf bank_mask:0xf bound_ctrl:1
    v_add_u32_dpp v15, v15, v15 row_shr:4 row_mask:0xf bank_mask:0xf bound_ctrl:1
    s_nop 0
    v_add_u32_dpp v14, v14, v14 row_shr:8 row_mask:0xf bank_mask:0xf bound_ctrl:1
    v_add_u32_dpp v15, v15, v15 row_shr:8 row_mask:0xf bank_mask:0xf bound_ctrl:1
    s_nop 0
    v_add_u32_dpp v14, v14, v14 row_bcast:15 row_mask:0xa bank_mask:0xf
    v_add_u32_dpp v15, v15, v15 row_bcast:15 row_mask:0xa bank_mask:0xf
    s_nop 0
    v_add_u32_dpp v14, v14, v14 row_bcast:31 row_mask:0xc bank_mask:0xf
    v_add_u32_dpp v15, v15, v15 row_bcast:31 row_mask:0xc bank_mask:0xf
    v_readlane_b32 s48, v14, 63
    v_readlane_b32 s49, v15, 63
    s_lshl_b32 s54, s32, 2
    v_mov_b32 v8, s54
    s_and_b32 s50, s48, 0xffff
    s_lshr_b32 s51, s48, 16
    s_and_b32 s52, s49, 0xffff
    s_lshr_b32 s53, s49, 16
    s_add_u32 s51, s51, s50
    s_add_u32 s52, s52, s51
    s_add_u32 s53, s53, s52
    v_mov_b32 v9, s53
    v_and_b32_dpp v3, v3, v3 quad_perm:[1,0,3,2] row_mask:0xf bank_mask:0xf
    s_mov_b64 exec, 1
    ds_write_b32 v8, v9 offset:16384
    ds_write_b32 v8, v3 offset:16448
    s_mov_b64 exec, -1
    v_and_b32 v8, 60, v7
    s_waitcnt lgkmcnt(0)
    s_barrier
    ds_read_b32 v9, v8 offset:16384
    ds_read_b32 v10, v8 offset:16448
    s_waitcnt lgkmcnt(0)
    v_readlane_b32 s56, v10, 15
    s_xor_b32 s56, s56, 0x80
    v_add_u32_dpp v9, v9, v9 row_shr:1 row_mask:0xf bank_mask:0xf bound_ctrl:1
    s_nop 1
    v_add_u32_dpp v9, v9, v9 row_shr:2 row_mask:0xf bank_mask:0xf bound_ctrl:1
    s_nop 1
    v_add_u32_dpp v9, v9, v9 row_shr:4 row_mask:0xf bank_mask:0xf bound_ctrl:1
    s_nop 1
    v_add_u32_dpp v9, v9, v9 row_shr:8 row_mask:0xf bank_mask:0xf bound_ctrl:1
    s_nop 0
    v_readlane_b32 s54, v9, s32
    s_sub_u32 s54, s54, s53
    s_add_u32 s50, s50, s54
    s_add_u32 s51, s51, s54
    s_add_u32 s52, s52, s54
    s_pack_ll_b32_b16 s48, s54, s50
    s_pack_ll_b32_b16 s49, s51, s52
    v_add_u32 v14, s48, v14
    v_add_u32 v15, s49, v15
    v_sub_u32 v12, v14, v12
    v_sub_u32 v13, v15, v13
    v_and_b32 v8, 0xffff, v12
    v_lshrrev_b32 v9, 16, v12
    v_and_b32 v10, 0xffff, v13
    v_lshrrev_b32 v11, 16, v13
    ds_write2st64_b32 v7, v8, v9 offset0:0 offset1:1
    ds_write2st64_b32 v7, v10, v11 offset0:2 offset1:3
    v_and_b32 v8, 0x3f0, v0
    v_lshl_add_u32 v8, v8, 1, s36
    ds_write_b64 v8, v[12:13] offset:20480
    s_bitset0_b64 exec, 63
    s_not_b64 exec, exec
    ds_write_b64 v8, v[14:15] offset:20512
    s_mov_b64 exec, -1
    s_waitcnt lgkmcnt(0)
    s_barrier
    s_setprio 3
    ds_add_rtn_u32 v120, v120, v2
    ds_add_rtn_u32 v121, v121, v2
    ds_add_rtn_u32 v122, v122, v2
    ds_add_rtn_u32 v123, v123, v2
    ds_read_b128 v[12:15], v0 offset:20480
    v_cmp_gt_u32 vcc, 8448, v0
    ds_add_rtn_u32 v124, v124, v2
    ds_add_rtn_u32 v125, v125, v2
    ds_add_rtn_u32 v126, v126, v2
    ds_add_rtn_u32 v127, v127, v2
    s_setprio 2
    ds_add_rtn_u32 v24, v24, v2
    ds_add_rtn_u32 v25, v25, v2
    ds_add_rtn_u32 v26, v26, v2
    ds_add_rtn_u32 v27, v27, v2
    s_waitcnt lgkmcnt(8)
    s_cbranch_vccz L1_p8
    s_add_u32 s44, s35, 0xa900000
    s_mov_b64 exec, vcc
    buffer_store_dwordx4 v[12:15], v0, s[24:27], s44 offen sc1
    s_mov_b64 exec, -1
L1_p8:
    s_add_u32 s45, s35, 0x7ec8000
    s_add_u32 s45, s45, s73
    buffer_store_dwordx4 v[88:91], v0, s[20:23], s45 offen sc1
    ds_add_rtn_u32 v52, v52, v2
    ds_add_rtn_u32 v53, v53, v2
    ds_add_rtn_u32 v54, v54, v2
    ds_add_rtn_u32 v55, v55, v2
    s_load_dwordx2 s[28:29], s[0:1], 0
    s_load_dwordx2 s[50:51], s[0:1], 40
    s_load_dwordx2 s[52:53], s[0:1], 24
    s_setprio 1
    ds_add_rtn_u32 v68, v68, v2
    ds_add_rtn_u32 v69, v69, v2
    ds_add_rtn_u32 v70, v70, v2
    ds_add_rtn_u32 v71, v71, v2
    s_add_u32 s80, s30, 0xd344000
    s_addc_u32 s81, s31, 0
    s_mov_b32 s82, 0xa000
    s_mov_b32 s83, 0x20000
    s_min_u32 s3, s84, 127
    s_mul_i32 s3, s3, 40960
    s_add_u32 s80, s80, s3
    s_addc_u32 s81, s81, 0
    s_cmp_ge_u32 s84, 128
    s_cselect_b32 s82, 0, s82
    s_waitcnt vmcnt(2)
    v_add_u32 v9, 0, v0
    buffer_store_dwordx4 v[112:115], v9, s[80:83], 0 offen sc1
    v_add_u32 v9, 16384, v0
    buffer_store_dwordx4 v[104:107], v9, s[80:83], 0 offen sc1
    v_add_u32 v9, 32768, v0
    buffer_store_dwordx4 v[28:31], v9, s[80:83], 0 offen sc1
    s_cmp_le_u32 s43, 5
    s_cbranch_scc1 L1_s9
    ds_add_rtn_u32 v76, v76, v2
    ds_add_rtn_u32 v77, v77, v2
    ds_add_rtn_u32 v78, v78, v2
    ds_add_rtn_u32 v79, v79, v2
L1_s9:
    s_setprio 0
    s_cmp_le_u32 s43, 6
    s_cbranch_scc1 L1_s10
    ds_add_rtn_u32 v56, v56, v2
    ds_add_rtn_u32 v57, v57, v2
    ds_add_rtn_u32 v58, v58, v2
    ds_add_rtn_u32 v59, v59, v2
L1_s10:
    s_cmp_le_u32 s43, 7
    s_cbranch_scc1 L1_s11
    ds_add_rtn_u32 v60, v60, v2
    ds_add_rtn_u32 v61, v61, v2
    ds_add_rtn_u32 v62, v62, v2
    ds_add_rtn_u32 v63, v63, v2
L1_s11:
    s_waitcnt lgkmcnt(0)
    s_barrier
    s_load_dwordx4 s[96:99], s[50:51], 0
    s_mov_b64 s[4:5], s[52:53]
    s_bfe_u32 s33, s2, 0x20001
    s_and_b32 s34, s2, 1
    s_lshl_b32 s34, s34, 5
    s_lshr_b32 s3, s2, 3
    s_add_u32 s34, s34, s3
    s_mul_i32 s39, s33, 2080
    s_lshl_b32 s3, s34, 5
    s_add_u32 s39, s39, s3
    s_mul_i32 s40, s33, 1310720
    s_add_u32 s40, s40, 0x50000
    s_lshl_b32 s38, s32, 11
    s_mul_i32 s100, s32, 3072
    s_add_u32 s8, s30, 0x4000
    s_addc_u32 s9, s31, 0
    s_mov_b32 s10, 0xd340000
    s_mov_b32 s11, 0x20000
    s_add_u32 s12, s30, 0x2c000
    s_addc_u32 s13, s31, 0
    s_mov_b32 s14, 0xd318000
    s_mov_b32 s15, 0x20000
    s_mov_b32 s16, s64
    s_mov_b32 s17, s65
    s_mov_b32 s18, 0x20
    s_mov_b32 s19, 0x20000
    s_mov_b32 s24, s28
    s_mov_b32 s25, s29
    s_mov_b32 s26, 0x4e2000
    s_mov_b32 s27, 0x20000
    s_setprio 3
    v_and_b32 v7, -4, v120
    v_lshl_add_u32 v8, v120, 2, v7
    ds_write_b32 v8, v16
    v_lshl_add_u32 v7, v7, 2, v120
    ds_write_b8 v7, v44 offset:16
    v_and_b32 v9, -4, v121
    v_lshl_add_u32 v10, v121, 2, v9
    ds_write_b32 v10, v17
    v_lshl_add_u32 v9, v9, 2, v121
    ds_write_b8_d16_hi v9, v44 offset:16
    v_and_b32 v7, -4, v122
    v_lshl_add_u32 v8, v122, 2, v7
    ds_write_b32 v8, v18
    v_lshl_add_u32 v7, v7, 2, v122
    ds_write_b8 v7, v45 offset:16
    v_and_b32 v9, -4, v123
    v_lshl_add_u32 v10, v123, 2, v9
    ds_write_b32 v10, v19
    v_lshl_add_u32 v9, v9, 2, v123
    ds_write_b8_d16_hi v9, v45 offset:16
    s_add_u32 s46, s35, 0x7ec8000
    s_add_u32 s46, s46, s85
    buffer_store_dwordx4 v[116:119], v0, s[20:23], s46 offen sc1
    v_and_b32 v13, 0x3f0, v0
    v_and_b32 v14, 0x300, v13
    v_bfe_u32 v15, v13, 4, 4
    s_lshl_b32 s3, s32, 4
    v_add3_u32 v14, v14, v15, s3
    v_mul_u32_u24 v2, 173056, v14
    v_lshrrev_b32 v14, 6, v13
    s_add_u32 s3, s3, 0x400
    v_add_u32 v14, s3, v14
    v_mul_u32_u24 v4, 173056, v14
    v_and_b32 v14, 3, v14
    v_and_b32 v15, 0x30, v13
    v_lshl_add_u32 v14, v14, 5, v15
    v_add_u32 v6, v14, v4
    v_lshl_add_u32 v5, v15, 1, v2
    v_lshrrev_b32 v14, 3, v15
    buffer_load_ushort v100, v14, s[16:19], 0 offen offset:0
    buffer_load_ushort v101, v14, s[16:19], 0 offen offset:8
    buffer_load_ushort v102, v14, s[16:19], 0 offen offset:16
    buffer_load_ushort v103, v14, s[16:19], 0 offen offset:24
    s_mul_i32 s3, s32, 5120
    v_add_u32 v3, s3, v13
    v_lshrrev_b32 v14, 2, v13
    v_add_u32 v14, s38, v14
    v_and_b32 v7, -4, v124
    v_lshl_add_u32 v8, v124, 2, v7
    ds_write_b32 v8, v20
    v_lshl_add_u32 v7, v7, 2, v124
    ds_write_b8 v7, v46 offset:16
    v_and_b32 v9, -4, v125
    v_lshl_add_u32 v10, v125, 2, v9
    ds_write_b32 v10, v21
    v_lshl_add_u32 v9, v9, 2, v125
    ds_write_b8_d16_hi v9, v46 offset:16
    v_and_b32 v7, -4, v126
    v_lshl_add_u32 v8, v126, 2, v7
    ds_write_b32 v8, v22
    v_lshl_add_u32 v7, v7, 2, v126
    ds_write_b8 v7, v47 offset:16
    v_and_b32 v9, -4, v127
    v_lshl_add_u32 v10, v127, 2, v9
    ds_write_b32 v10, v23
    v_lshl_add_u32 v9, v9, 2, v127
    ds_write_b8_d16_hi v9, v47 offset:16
    s_setprio 2
    v_and_b32 v7, -4, v24
    v_lshl_add_u32 v8, v24, 2, v7
    ds_write_b32 v8, v40
    v_lshl_add_u32 v7, v7, 2, v24
    ds_write_b8 v7, v32 offset:16
    v_and_b32 v9, -4, v25
    v_lshl_add_u32 v10, v25, 2, v9
    ds_write_b32 v10, v41
    v_lshl_add_u32 v9, v9, 2, v25
    ds_write_b8_d16_hi v9, v32 offset:16
    v_and_b32 v7, -4, v26
    v_lshl_add_u32 v8, v26, 2, v7
    ds_write_b32 v8, v42
    v_lshl_add_u32 v7, v7, 2, v26
    ds_write_b8 v7, v33 offset:16
    v_and_b32 v9, -4, v27
    v_lshl_add_u32 v10, v27, 2, v9
    ds_write_b32 v10, v43
    v_lshl_add_u32 v9, v9, 2, v27
    ds_write_b8_d16_hi v9, v33 offset:16
    s_add_u32 s47, s35, 0x7ec8000
    s_add_u32 s47, s47, s91
    buffer_store_dwordx4 v[92:95], v0, s[20:23], s47 offen sc1
    v_and_b32 v7, -4, v52
    v_lshl_add_u32 v8, v52, 2, v7
    ds_write_b32 v8, v48
    v_lshl_add_u32 v7, v7, 2, v52
    ds_write_b8 v7, v34 offset:16
    v_and_b32 v9, -4, v53
    v_lshl_add_u32 v10, v53, 2, v9
    ds_write_b32 v10, v49
    v_lshl_add_u32 v9, v9, 2, v53
    ds_write_b8_d16_hi v9, v34 offset:16
    v_and_b32 v7, -4, v54
    v_lshl_add_u32 v8, v54, 2, v7
    ds_write_b32 v8, v50
    v_lshl_add_u32 v7, v7, 2, v54
    ds_write_b8 v7, v35 offset:16
    v_and_b32 v9, -4, v55
    v_lshl_add_u32 v10, v55, 2, v9
    ds_write_b32 v10, v51
    v_lshl_add_u32 v9, v9, 2, v55
    ds_write_b8_d16_hi v9, v35 offset:16
    s_setprio 1
    v_and_b32 v7, -4, v68
    v_lshl_add_u32 v8, v68, 2, v7
    ds_write_b32 v8, v84
    v_lshl_add_u32 v7, v7, 2, v68
    ds_write_b8 v7, v72 offset:16
    v_and_b32 v9, -4, v69
    v_lshl_add_u32 v10, v69, 2, v9
    ds_write_b32 v10, v85
    v_lshl_add_u32 v9, v9, 2, v69
    ds_write_b8_d16_hi v9, v72 offset:16
    v_and_b32 v7, -4, v70
    v_lshl_add_u32 v8, v70, 2, v7
    ds_write_b32 v8, v86
    v_lshl_add_u32 v7, v7, 2, v70
    ds_write_b8 v7, v73 offset:16
    v_and_b32 v9, -4, v71
    v_lshl_add_u32 v10, v71, 2, v9
    ds_write_b32 v10, v87
    v_lshl_add_u32 v9, v9, 2, v71
    ds_write_b8_d16_hi v9, v73 offset:16
    s_cmp_le_u32 s43, 5
    s_cbranch_scc1 L1_s12
    v_and_b32 v7, -4, v76
    v_lshl_add_u32 v8, v76, 2, v7
    ds_write_b32 v8, v36
    v_lshl_add_u32 v7, v7, 2, v76
    ds_write_b8 v7, v74 offset:16
    v_and_b32 v9, -4, v77
    v_lshl_add_u32 v10, v77, 2, v9
    ds_write_b32 v10, v37
    v_lshl_add_u32 v9, v9, 2, v77
    ds_write_b8_d16_hi v9, v74 offset:16
    v_and_b32 v7, -4, v78
    v_lshl_add_u32 v8, v78, 2, v7
    ds_write_b32 v8, v38
    v_lshl_add_u32 v7, v7, 2, v78
    ds_write_b8 v7, v75 offset:16
    v_and_b32 v9, -4, v79
    v_lshl_add_u32 v10, v79, 2, v9
    ds_write_b32 v10, v39
    v_lshl_add_u32 v9, v9, 2, v79
    ds_write_b8_d16_hi v9, v75 offset:16
L1_s12:
    s_add_u32 s44, s35, 0x7ec8000
    s_add_u32 s44, s44, s93
    buffer_store_dwordx4 v[108:111], v0, s[20:23], s44 offen sc1
    s_setprio 0
    s_cmp_le_u32 s43, 6
    s_cbranch_scc1 L1_s13
    v_and_b32 v7, -4, v56
    v_lshl_add_u32 v8, v56, 2, v7
    ds_write_b32 v8, v80
    v_lshl_add_u32 v7, v7, 2, v56
    ds_write_b8 v7, v64 offset:16
    v_and_b32 v9, -4, v57
    v_lshl_add_u32 v10, v57, 2, v9
    ds_write_b32 v10, v81
    v_lshl_add_u32 v9, v9, 2, v57
    ds_write_b8_d16_hi v9, v64 offset:16
    v_and_b32 v7, -4, v58
    v_lshl_add_u32 v8, v58, 2, v7
    ds_write_b32 v8, v82
    v_lshl_add_u32 v7, v7, 2, v58
    ds_write_b8 v7, v65 offset:16
    v_and_b32 v9, -4, v59
    v_lshl_add_u32 v10, v59, 2, v9
    ds_write_b32 v10, v83
    v_lshl_add_u32 v9, v9, 2, v59
    ds_write_b8_d16_hi v9, v65 offset:16
L1_s13:
    s_cmp_le_u32 s43, 7
    s_cbranch_scc1 L1_s14
    v_and_b32 v7, -4, v60
    v_lshl_add_u32 v8, v60, 2, v7
    ds_write_b32 v8, v96
    v_lshl_add_u32 v7, v7, 2, v60
    ds_write_b8 v7, v66 offset:16
    v_and_b32 v9, -4, v61
    v_lshl_add_u32 v10, v61, 2, v9
    ds_write_b32 v10, v97
    v_lshl_add_u32 v9, v9, 2, v61
    ds_write_b8_d16_hi v9, v66 offset:16
    v_and_b32 v7, -4, v62
    v_lshl_add_u32 v8, v62, 2, v7
    ds_write_b32 v8, v98
    v_lshl_add_u32 v7, v7, 2, v62
    ds_write_b8 v7, v67 offset:16
    v_and_b32 v9, -4, v63
    v_lshl_add_u32 v10, v63, 2, v9
    ds_write_b32 v10, v99
    v_lshl_add_u32 v9, v9, 2, v63
    ds_write_b8_d16_hi v9, v67 offset:16
L1_s14:
    s_waitcnt vmcnt(3)
    v_add_u32 v7, 0x10000, v0
    v_add_u32 v12, 0x20000, v0
    s_waitcnt lgkmcnt(0)
    s_barrier
    ds_read_b128 v[24:27], v0 offset:0
    ds_read_b128 v[28:31], v0 offset:16384
    ds_read_b128 v[32:35], v0 offset:32768
    ds_read_b128 v[36:39], v0 offset:49152
    ds_read_b128 v[76:79], v7 offset:0
    ds_read_b128 v[80:83], v7 offset:16384
    ds_read_b128 v[84:87], v7 offset:32768
    ds_read_b128 v[104:107], v7 offset:49152
    ds_read_b128 v[68:71], v12 offset:0
    ds_read_b128 v[72:75], v12 offset:16384
    s_cmp_lg_u32 s32, 0
    s_cbranch_scc1 L2_sg1
    s_mov_b32 exec_hi, 0
    v_mov_b32 v11, 1
    buffer_store_dword v11, v14, s[60:63], s57 offen sc1
    s_mov_b64 exec, -1
L2_sg1:
    s_waitcnt lgkmcnt(9)
    s_add_u32 s45, s35, 0xa904000
    buffer_store_dwordx4 v[24:27], v0, s[20:23], s45 offen sc1
    s_waitcnt lgkmcnt(8)
    s_add_u32 s46, s35, 0xa908000
    buffer_store_dwordx4 v[28:31], v0, s[20:23], s46 offen sc1
    s_waitcnt lgkmcnt(7)
    s_add_u32 s47, s35, 0xa90c000
    buffer_store_dwordx4 v[32:35], v0, s[20:23], s47 offen sc1
    s_waitcnt lgkmcnt(6)
    s_add_u32 s44, s35, 0xa910000
    buffer_store_dwordx4 v[36:39], v0, s[20:23], s44 offen sc1
    s_waitcnt lgkmcnt(5)
    s_add_u32 s45, s35, 0xa914000
    buffer_store_dwordx4 v[76:79], v0, s[20:23], s45 offen sc1
    s_waitcnt lgkmcnt(4)
    s_add_u32 s46, s35, 0xa918000
    buffer_store_dwordx4 v[80:83], v0, s[20:23], s46 offen sc1
    s_waitcnt lgkmcnt(3)
    s_add_u32 s47, s35, 0xa91c000
    buffer_store_dwordx4 v[84:87], v0, s[20:23], s47 offen sc1
    s_waitcnt lgkmcnt(2)
    s_cmp_le_u32 s43, 5
    s_cbranch_scc1 L1_q15
    s_add_u32 s44, s35, 0xa920000
    buffer_store_dwordx4 v[104:107], v0, s[20:23], s44 offen sc1
L1_q15:
    s_waitcnt lgkmcnt(1)
    s_cmp_le_u32 s43, 6
    s_cbranch_scc1 L1_q16
    s_add_u32 s45, s35, 0xa924000
    buffer_store_dwordx4 v[68:71], v0, s[20:23], s45 offen sc1
L1_q16:
    s_waitcnt lgkmcnt(0)
    s_cmp_le_u32 s43, 7
    s_cbranch_scc1 L1_q17
    s_add_u32 s46, s35, 0xa928000
    buffer_store_dwordx4 v[72:75], v0, s[20:23], s46 offen sc1
L1_q17:
    s_waitcnt lgkmcnt(0)
    s_barrier
    s_setprio 3
    v_mov_b32 v92, v0
    v_mov_b32 v93, v6
    v_mov_b32 v94, v13
    v_mov_b32 v95, v5
    v_mov_b32 v0, v14
    v_lshl_add_u32 v7, v13, 3, s38
    v_lshrrev_b32 v16, 2, v15
    v_mad_u32_u24 v4, v16, 5, v4
    v_or_b32 v4, 0xf0000000, v4
    v_or_b32 v2, 0xf0000000, v2
    v_sub_u32 v1, 28, v16
    v_lshrrev_b32 v17, 2, v16
    v_and_b32 v18, 3, v17
    v_lshlrev_b32 v18, 4, v18
    v_mov_b32 v10, 0x3f80
    v_mov_b32 v11, 0
    v_lshlrev_b64 v[10:11], v18, v[10:11]
    v_and_b32 v18, 3, v17
    v_lshlrev_b32 v18, 4, v18
    v_mov_b32 v12, 0xbf80
    v_mov_b32 v13, 0
    v_lshlrev_b64 v[12:13], v18, v[12:13]
    v_mov_b32 v45, 0xf0000000
    v_mov_b32 v5, 0x1fff8
    v_mov_b32 v6, 0x07ff0000
    v_mov_b32 v16, 0
    v_mov_b32 v17, 0
    v_mov_b32 v18, 0
    v_mov_b32 v19, 0
    v_add_u32 v20, 81920, v92
    v_add_u32 v21, 0x10000, v20
    ds_write_b128 v20, v[16:19] offset:0
    ds_write_b128 v20, v[16:19] offset:16384
    s_setprio 2
    ds_write_b128 v20, v[16:19] offset:32768
    ds_write_b128 v20, v[16:19] offset:49152
    ds_write_b128 v21, v[16:19]
    s_setprio 1
    s_setprio 0
    s_mov_b32 s44, 0x4000c0c
    s_mov_b32 s45, 0x4010c0c
    s_mov_b32 s46, 0x4020c0c
    s_mov_b32 s47, 0x4030c0c
    s_mov_b32 s36, 0
    s_mov_b32 s43, 0
    s_mov_b32 s42, 0
    s_mov_b64 s[80:81], 0
    s_mov_b64 s[84:85], 0
    s_mov_b64 s[48:49], 0
    s_add_u32 s16, s30, 0xd344000
    s_addc_u32 s17, s31, 0
    s_mov_b32 s18, 0x500000
    s_mov_b32 s19, 0x20000
    s_add_u32 s20, s30, 0xd845000
    s_addc_u32 s21, s31, 0
    s_mov_b32 s22, 0x13880
    s_mov_b32 s23, 0x20000
    s_lshl_b32 s3, s33, 6
    s_add_u32 s3, s3, s34
    s_mul_i32 s3, s3, 80000
    s_add_u32 s20, s20, s3
    s_addc_u32 s21, s21, 0
    v_mov_b32 v68, 0
    v_mov_b32 v69, 0
    v_mov_b32 v70, 0
    v_mov_b32 v71, 0
    v_mov_b32 v72, 0
    v_mov_b32 v73, 0
    v_mov_b32 v74, 0
    v_mov_b32 v75, 0
    s_waitcnt vmcnt(0)
    v_lshl_or_b32 v8, v101, 16, v100
    v_lshl_or_b32 v9, v103, 16, v102
    s_barrier
    s_cmp_lg_u32 s32, 0
    s_cbranch_scc1 L2_sg2
    s_mov_b32 exec_hi, 0
    v_mov_b32 v88, 2
    buffer_store_dword v88, v0, s[60:63], s57 offen sc1
    s_mov_b64 exec, -1
L2_sg2:
    s_mul_i32 s3, s33, 1280000
    s_add_u32 s3, s3, s100
    s_add_u32 s3, s3, 32768
    buffer_load_dwordx4 v[124:127], v94, s[24:27], s3 offen offset:2048
    s_mul_i32 s3, s33, 1280000
    s_add_u32 s3, s3, s100
    s_add_u32 s3, s3, 32768
    buffer_load_dwordx4 v[116:119], v94, s[24:27], s3 offen offset:0
    s_mul_i32 s3, s33, 1280000
    s_add_u32 s3, s3, s100
    s_add_u32 s3, s3, 32768
    buffer_load_dwordx4 v[120:123], v94, s[24:27], s3 offen offset:1024
    s_mul_i32 s3, s33, 1280000
    s_add_u32 s3, s3, s38
    s_add_u32 s3, s3, 0
    buffer_load_dwordx4 v[108:111], v94, s[24:27], s3 offen offset:0
    s_mul_i32 s3, s33, 1280000
    s_add_u32 s3, s3, s38
    s_add_u32 s3, s3, 0
    buffer_load_dwordx4 v[112:115], v94, s[24:27], s3 offen offset:1024
    s_cmp_eq_u32 s56, 0
    s_cbranch_scc1 L2_e3
    v_lshlrev_b32 v16, 3, v94
    v_and_b32 v16, 0x80, v16
L2_e4:
    buffer_load_dword v88, v16, s[68:71], 0 offen sc1
    s_waitcnt vmcnt(0)
    v_cmp_gt_u32 vcc, 0x80, v88
    s_cbranch_vccnz L2_e4
L2_e3:
    s_mov_b64 exec, 0xffff
L2_p1:
    buffer_load_dword v88, v7, s[60:63], 0 offen sc1
    s_waitcnt vmcnt(0)
    v_cmp_gt_u32 vcc, 1, v88
    s_cbranch_vccnz L2_p1s
    s_mov_b64 exec, -1
    v_cmp_gt_u32 vcc, 2, v88
    s_and_b32 s56, vcc_lo, 0xffff
    buffer_load_dwordx4 v[48:51], v95, s[12:15], s39 offen offset:0
    buffer_load_dwordx4 v[56:59], v95, s[12:15], s39 offen offset:32
    buffer_load_dwordx4 v[52:55], v95, s[12:15], s39 offen offset:16
    buffer_load_dwordx4 v[60:63], v95, s[12:15], s39 offen offset:48
    buffer_load_dwordx4 v[64:67], v93, s[12:15], s39 offen
    s_waitcnt vmcnt(0)
    v_sub_u16 v88, v56, v48
    v_and_b32 v89, 3, v48
    v_add3_u32 v99, v88, v89, 3
    v_and_b32 v99, -4, v99
    v_max_u32 v99, 4, v99
    v_and_b32 v97, 0xfffc, v48
    v_bfm_b32 v96, v88, v89
    v_add_u32_dpp v91, v99, v99 row_shr:1 row_mask:0xf bank_mask:0xf bound_ctrl:1
    v_mad_u32_u24 v97, v97, 5, v2
    v_cmp_lt_u32 vcc, 16, v99
    v_add_u32_dpp v91, v91, v91 row_shr:2 row_mask:0xf bank_mask:0xf bound_ctrl:1
    v_sub_u32 v98, s38, v99
    v_lshrrev_b64 v[48:49], 16, v[48:49]
    v_add_u32_dpp v91, v91, v91 row_shr:4 row_mask:0xf bank_mask:0xf bound_ctrl:1
    v_lshrrev_b64 v[56:57], 16, v[56:57]
    s_mov_b32 s101, 0
    v_add_u32_dpp v91, v91, v91 row_shr:8 row_mask:0xf bank_mask:0xf bound_ctrl:1
    s_nop 1
    v_add_u32_dpp v91, v91, v91 row_bcast:15 row_mask:0xa bank_mask:0xf
    s_nop 1
    v_add_u32_dpp v91, v91, v91 row_bcast:31 row_mask:0xc bank_mask:0xf
    v_add_u32 v98, v98, v91
    v_readlane_b32 s37, v91, 63
    s_cbranch_vccnz L2_xo3
L2_xp3:
    v_mov_b32 v44, v43
    s_cmp_gt_u32 s37, 1024
    s_cbranch_scc1 L2_xs4
    s_cmp_lg_u32 s101, 0
    s_cbranch_scc1 L2_xa4
L2_xb4:
    v_lshlrev_b32 v89, 16, v96
    v_add_u32 v90, 60, v97
    v_bitop3_b32 v90, v89, v45, v90 bitop3:0x6a
    ds_write_b32 v98, v90 offset:12
    v_lshlrev_b32 v89, 20, v96
    v_add_u32 v90, 40, v97
    v_bitop3_b32 v90, v89, v45, v90 bitop3:0x6a
    ds_write_b32 v98, v90 offset:8
    v_lshlrev_b32 v89, 24, v96
    v_add_u32 v90, 20, v97
    v_bitop3_b32 v90, v89, v45, v90 bitop3:0x6a
    ds_write_b32 v98, v90 offset:4
    v_lshlrev_b32 v89, 28, v96
    v_bitop3_b32 v90, v89, v45, v97 bitop3:0x6a
    ds_write_b32 v98, v90 offset:0
    v_mov_b32_dpp v91, v64 quad_perm:[0,0,0,0] row_mask:0xf bank_mask:0xf
    v_and_b32 v89, 3, v91
    v_and_b32 v97, 0xfffc, v91
    v_sub_u16_dpp v88, v64, v91 quad_perm:[2,2,2,2] row_mask:0xf bank_mask:0xf
    v_mad_u32_u24 v97, v97, 5, v4
    v_add_u32 v99, v88, v89
    v_bfm_b32 v96, v88, v89
    v_cmp_lt_u32 s[58:59], 16, v99
    v_lshlrev_b32 v89, v1, v96
    v_and_b32 v89, v45, v89
    v_cmp_ne_u32 vcc, 0, v89
    v_xor_b32 v90, v97, v89
    s_add_u32 s3, s37, s38
    v_mbcnt_lo_u32_b32 v98, vcc_lo, 0
    v_mbcnt_hi_u32_b32 v98, vcc_hi, v98
    s_bcnt1_i32_b64 s41, vcc
    v_lshl_add_u32 v98, v98, 2, s3
    s_mov_b64 exec, vcc
    ds_write_b32 v98, v90
    s_mov_b64 exec, -1
    s_lshl2_add_u32 s37, s41, s37
    s_cmp_lg_u64 s[58:59], 0
    s_cbranch_scc1 L2_xe4
L2_xr4:
    v_add_u32 v98, s37, v0
    v_mov_b32 v90, -1
    ds_write_b32 v98, v90
    ds_read2st64_b32 v[40:41], v0 offset0:0 offset1:1
    ds_read2st64_b32 v[42:43], v0 offset0:2 offset1:3
    s_sub_u32 s3, s37, 768
    s_cmp_gt_u32 s3, 256
    s_cbranch_scc1 L2_xf4
L2_xg4:
    v_sub_u16 v88, v58, v50
    v_and_b32 v89, 3, v50
    v_add3_u32 v99, v88, v89, 3
    v_and_b32 v99, -4, v99
    v_max_u32 v99, 4, v99
    v_and_b32 v97, 0xfffc, v50
    v_bfm_b32 v96, v88, v89
    v_add_u32_dpp v91, v99, v99 row_shr:1 row_mask:0xf bank_mask:0xf bound_ctrl:1
    v_mad_u32_u24 v97, v97, 5, v2
    v_cmp_lt_u32 vcc, 16, v99
    v_add_u32_dpp v91, v91, v91 row_shr:2 row_mask:0xf bank_mask:0xf bound_ctrl:1
    v_sub_u32 v98, s38, v99
    v_lshrrev_b64 v[50:51], 16, v[50:51]
    v_add_u32_dpp v91, v91, v91 row_shr:4 row_mask:0xf bank_mask:0xf bound_ctrl:1
    v_lshrrev_b64 v[58:59], 16, v[58:59]
    s_mov_b32 s101, 0
    v_add_u32_dpp v91, v91, v91 row_shr:8 row_mask:0xf bank_mask:0xf bound_ctrl:1
    s_nop 1
    v_add_u32_dpp v91, v91, v91 row_bcast:15 row_mask:0xa bank_mask:0xf
    s_nop 1
    v_add_u32_dpp v91, v91, v91 row_bcast:31 row_mask:0xc bank_mask:0xf
    v_add_u32 v98, v98, v91
    v_readlane_b32 s37, v91, 63
    s_cbranch_vccnz L2_xo5
L2_xp5:
    s_waitcnt lgkmcnt(0)
    v_mov_b32 v21, v40
    v_mov_b32 v27, v41
    v_mov_b32 v33, v42
    v_mov_b32 v39, v43
    v_mov_b32 v44, v43
    s_cmp_gt_u32 s37, 1024
    s_cbranch_scc1 L2_xs6
    s_cmp_lg_u32 s101, 0
    s_cbranch_scc1 L2_xa6
L2_xb6:
    v_lshlrev_b32 v89, 16, v96
    v_add_u32 v90, 60, v97
    v_bitop3_b32 v90, v89, v45, v90 bitop3:0x6a
    ds_write_b32 v98, v90 offset:12
    v_lshlrev_b32 v89, 20, v96
    v_add_u32 v90, 40, v97
    v_bitop3_b32 v90, v89, v45, v90 bitop3:0x6a
    ds_write_b32 v98, v90 offset:8
    v_lshlrev_b32 v89, 24, v96
    v_add_u32 v90, 20, v97
    v_bitop3_b32 v90, v89, v45, v90 bitop3:0x6a
    ds_write_b32 v98, v90 offset:4
    v_lshlrev_b32 v89, 28, v96
    v_bitop3_b32 v90, v89, v45, v97 bitop3:0x6a
    ds_write_b32 v98, v90 offset:0
    v_mov_b32_dpp v91, v66 quad_perm:[0,0,0,0] row_mask:0xf bank_mask:0xf
    v_and_b32 v89, 3, v91
    v_and_b32 v97, 0xfffc, v91
    v_sub_u16_dpp v88, v66, v91 quad_perm:[2,2,2,2] row_mask:0xf bank_mask:0xf
    v_mad_u32_u24 v97, v97, 5, v4
    v_add_u32 v99, v88, v89
    v_bfm_b32 v96, v88, v89
    v_cmp_lt_u32 s[58:59], 16, v99
    v_lshlrev_b32 v89, v1, v96
    v_and_b32 v89, v45, v89
    v_cmp_ne_u32 vcc, 0, v89
    v_xor_b32 v90, v97, v89
    s_add_u32 s3, s37, s38
    v_mbcnt_lo_u32_b32 v98, vcc_lo, 0
    v_mbcnt_hi_u32_b32 v98, vcc_hi, v98
    s_bcnt1_i32_b64 s41, vcc
    v_lshl_add_u32 v98, v98, 2, s3
    s_mov_b64 exec, vcc
    ds_write_b32 v98, v90
    s_mov_b64 exec, -1
    s_lshl2_add_u32 s37, s41, s37
    s_cmp_lg_u64 s[58:59], 0
    s_cbranch_scc1 L2_xe6
L2_xr6:
    v_add_u32 v98, s37, v0
    v_mov_b32 v90, -1
    ds_write_b32 v98, v90
    ds_read2st64_b32 v[40:41], v0 offset0:0 offset1:1
    ds_read2st64_b32 v[42:43], v0 offset0:2 offset1:3
    s_sub_u32 s3, s37, 768
    s_cmp_gt_u32 s3, 256
    s_cbranch_scc1 L2_xf6
L2_xg6:
    v_subrev_u32 v88, s38, v3
    ds_write_b128 v88, v[124:127] offset:34816
    v_subrev_u32 v88, s38, v3
    ds_write_b128 v88, v[116:119] offset:32768
    v_subrev_u32 v88, s38, v3
    ds_write_b128 v88, v[120:123] offset:33792
    v_subrev_u32 v88, s100, v3
    ds_write_b128 v88, v[108:111] offset:0
    v_subrev_u32 v88, s100, v3
    ds_write_b128 v88, v[112:115] offset:1024
    s_cmp_eq_u32 s56, 0
    s_cbranch_scc1 L2_e2
    s_mov_b64 exec, 0xffff
    buffer_load_dword v88, v7, s[60:63], 0 offen sc1
    s_mov_b64 exec, -1
    s_waitcnt vmcnt(0)
    v_cmp_gt_u32 vcc, 2, v88
    s_and_b32 s56, vcc_lo, 0xffff
    s_cbranch_scc0 L2_e2
    s_mul_i32 s3, s33, 1280000
    s_add_u32 s3, s3, s100
    s_add_u32 s3, s3, 352768
    buffer_load_dwordx4 v[124:127], v94, s[24:27], s3 offen offset:2048
    s_mul_i32 s3, s33, 1280000
    s_add_u32 s3, s3, s100
    s_add_u32 s3, s3, 352768
    buffer_load_dwordx4 v[116:119], v94, s[24:27], s3 offen offset:0
    s_mul_i32 s3, s33, 1280000
    s_add_u32 s3, s3, s100
    s_add_u32 s3, s3, 352768
    buffer_load_dwordx4 v[120:123], v94, s[24:27], s3 offen offset:1024
    s_mul_i32 s3, s33, 1280000
    s_add_u32 s3, s3, s38
    s_add_u32 s3, s3, 320000
    buffer_load_dwordx4 v[108:111], v94, s[24:27], s3 offen offset:0
    s_mul_i32 s3, s33, 1280000
    s_add_u32 s3, s3, s38
    s_add_u32 s3, s3, 320000
    buffer_load_dwordx4 v[112:115], v94, s[24:27], s3 offen offset:1024
    s_mov_b64 exec, 0xffff
L2_p2:
    buffer_load_dword v88, v7, s[60:63], 0 offen sc1
    s_waitcnt vmcnt(0)
    v_cmp_gt_u32 vcc, 2, v88
    s_cbranch_vccnz L2_p2s
    s_mov_b64 exec, -1
L2_e2:
    s_mov_b32 s6, 0xaaaaaaaa
    s_mov_b32 s7, 0xaaaaaaaa
    v_and_b32 v47, 0x0fffffff, v21
    buffer_load_dwordx2 v[16:17], v47, s[8:11], 0 offen
    buffer_load_dwordx3 v[18:20], v47, s[8:11], 0 offen offset:8
    s_waitcnt lgkmcnt(0)
    s_barrier
    s_bitcmp1_b32 s36, s42
    s_cbranch_scc1 L2_slow
L2_ret0:
    s_setprio 3
    v_and_b32 v47, 0x0fffffff, v27
    buffer_load_dwordx2 v[22:23], v47, s[8:11], 0 offen
    buffer_load_dwordx3 v[24:26], v47, s[8:11], 0 offen offset:8
    s_waitcnt vmcnt(2)
    v_and_b32 v46, 0x20000000, v21
    v_lshrrev_b32 v47, 14, v17
    v_bitop3_b32 v47, v47, v5, v46 bitop3:0xea
    ds_read_b64 v[102:103], v47
    v_bitop3_b32 v93, v17, v5, v46 bitop3:0xea
    v_and_b32 v46, 0x10000000, v21
    v_lshrrev_b32 v47, 14, v16
    v_bitop3_b32 v47, v47, v5, v46 bitop3:0xea
    ds_read_b64 v[100:101], v47
    v_bitop3_b32 v92, v16, v5, v46 bitop3:0xea
    v_perm_b32 v15, v17, v20, s45
    v_bitop3_b32 v46, v17, 0.5, -0.5 bitop3:0xa8
    v_perm_b32 v14, v16, v20, s44
    v_bitop3_b32 v47, v16, 0.5, -0.5 bitop3:0xa8
    s_waitcnt lgkmcnt(0)
    v_mfma_f32_4x4x4_16b_bf16 v[80:83], v[8:9], v[102:103], 0
    v_mfma_f32_4x4x4_16b_bf16 v[76:79], v[8:9], v[100:101], 0
    v_bitop3_b32 v15, v6, v15, v46 bitop3:0xca
    v_bitop3_b32 v14, v6, v14, v47 bitop3:0xca
    v_cmp_lt_u32 s[84:85], v5, v92
    s_nop 0
    v_pk_mul_f32 v[80:81], v[80:81], v[14:15] op_sel:[0,1] op_sel_hi:[1,1]
    v_pk_mul_f32 v[82:83], v[82:83], v[14:15] op_sel:[0,1] op_sel_hi:[1,1]
    v_pk_mul_f32 v[76:77], v[76:77], v[14:15] op_sel:[0,0] op_sel_hi:[1,0]
    v_pk_mul_f32 v[78:79], v[78:79], v[14:15] op_sel:[0,0] op_sel_hi:[1,0]
    v_and_b32 v47, 0x0fffffff, v33
    buffer_load_dwordx2 v[28:29], v47, s[8:11], 0 offen
    buffer_load_dwordx3 v[30:32], v47, s[8:11], 0 offen offset:8
    v_cmp_ne_u64 s[50:51], v[72:73], v[68:69]
    v_cmpx_ne_u64 s[54:55], v[74:75], v[70:71]
    s_and_b64 s[82:83], s[54:55], s[80:81]
    s_cbranch_scc1 L2_c7
L2_d7:
    v_mov_b64 v[84:85], v[70:71]
    v_mov_b32 v7, v95
    v_mov_b64 v[86:87], v[74:75]
    s_or_b64 s[80:81], s[80:81], s[54:55]
    s_mov_b64 exec, s[50:51]
    s_and_b64 s[82:83], s[50:51], s[80:81]
    s_cbranch_scc1 L2_c8
L2_d8:
    v_mov_b64 v[84:85], v[68:69]
    v_mov_b32 v7, v94
    v_mov_b64 v[86:87], v[72:73]
    s_mov_b64 exec, -1
    s_or_b64 s[80:81], s[80:81], s[50:51]
    ds_read_b64 v[70:71], v93 offset:65408
    s_and_b64 exec, s[84:85], s[80:81]
    v_mfma_f32_4x4x4_16b_bf16 v[76:79], v[12:13], v[84:85], 0
    v_mov_b32 v92, v7
    s_andn2_b64 s[80:81], s[80:81], s[84:85]
    v_mfma_f32_4x4x4_16b_bf16 v[76:79], v[10:11], v[86:87], v[76:79]
    s_mov_b64 exec, -1
    ds_read_b64 v[68:69], v92 offset:65408
    v_and_b32 v46, 0x80000000, v21
    v_lshrrev_b32 v47, 14, v19
    v_bitop3_b32 v47, v47, v5, v46 bitop3:0xea
    ds_read_b64 v[106:107], v47
    v_bitop3_b32 v95, v19, v5, v46 bitop3:0xea
    v_and_b32 v46, 0x40000000, v21
    v_lshrrev_b32 v47, 14, v18
    v_bitop3_b32 v47, v47, v5, v46 bitop3:0xea
    ds_read_b64 v[104:105], v47
    v_bitop3_b32 v94, v18, v5, v46 bitop3:0xea
    s_waitcnt lgkmcnt(2)
    v_mfma_f32_4x4x4_16b_bf16 v[80:83], v[10:11], v[70:71], v[80:83]
    v_mfma_f32_4x4x4_16b_bf16 v[76:79], v[10:11], v[68:69], v[76:79]
    v_perm_b32 v15, v19, v20, s47
    v_bitop3_b32 v46, v19, 0.5, -0.5 bitop3:0xa8
    v_perm_b32 v14, v18, v20, s46
    v_bitop3_b32 v47, v18, 0.5, -0.5 bitop3:0xa8
    v_cvt_pk_bf16_f32 v80, v80, v81
    v_cvt_pk_bf16_f32 v81, v82, v83
    ds_wrxchg_rtn_b64 v[74:75], v93, v[80:81] offset:65408
    v_cvt_pk_bf16_f32 v76, v76, v77
    v_cvt_pk_bf16_f32 v77, v78, v79
    ds_wrxchg_rtn_b64 v[72:73], v92, v[76:77] offset:65408
    s_setprio 2
    s_waitcnt lgkmcnt(2)
    v_mfma_f32_4x4x4_16b_bf16 v[80:83], v[8:9], v[106:107], 0
    v_mfma_f32_4x4x4_16b_bf16 v[76:79], v[8:9], v[104:105], 0
    v_bitop3_b32 v15, v6, v15, v46 bitop3:0xca
    v_bitop3_b32 v14, v6, v14, v47 bitop3:0xca
    s_nop 1
    v_pk_mul_f32 v[80:81], v[80:81], v[14:15] op_sel:[0,1] op_sel_hi:[1,1]
    v_pk_mul_f32 v[82:83], v[82:83], v[14:15] op_sel:[0,1] op_sel_hi:[1,1]
    v_pk_mul_f32 v[76:77], v[76:77], v[14:15] op_sel:[0,0] op_sel_hi:[1,0]
    v_pk_mul_f32 v[78:79], v[78:79], v[14:15] op_sel:[0,0] op_sel_hi:[1,0]
    v_sub_u16 v88, v60, v52
    v_and_b32 v89, 3, v52
    v_add3_u32 v99, v88, v89, 3
    v_and_b32 v99, -4, v99
    v_max_u32 v99, 4, v99
    v_and_b32 v97, 0xfffc, v52
    v_bfm_b32 v96, v88, v89
    v_add_u32_dpp v91, v99, v99 row_shr:1 row_mask:0xf bank_mask:0xf bound_ctrl:1
    v_mad_u32_u24 v97, v97, 5, v2
    v_cmp_lt_u32 vcc, 16, v99
    v_add_u32_dpp v91, v91, v91 row_shr:2 row_mask:0xf bank_mask:0xf bound_ctrl:1
    v_sub_u32 v98, s38, v99
    v_lshrrev_b64 v[52:53], 16, v[52:53]
    v_add_u32_dpp v91, v91, v91 row_shr:4 row_mask:0xf bank_mask:0xf bound_ctrl:1
    v_lshrrev_b64 v[60:61], 16, v[60:61]
    s_mov_b32 s101, 0
    v_add_u32_dpp v91, v91, v91 row_shr:8 row_mask:0xf bank_mask:0xf bound_ctrl:1
    s_nop 1
    v_add_u32_dpp v91, v91, v91 row_bcast:15 row_mask:0xa bank_mask:0xf
    s_nop 1
    v_add_u32_dpp v91, v91, v91 row_bcast:31 row_mask:0xc bank_mask:0xf
    v_add_u32 v98, v98, v91
    v_readlane_b32 s37, v91, 63
    s_cbranch_vccnz L2_xo9
L2_xp9:
    v_and_b32 v47, 0x3f0, v3
    s_cmp_lg_u32 s56, 0
    s_cbranch_scc1 L2_m10
    s_mul_i32 s3, s33, 1280000
    s_add_u32 s3, s3, s100
    s_add_u32 s3, s3, 352768
    buffer_load_dwordx4 v[124:127], v47, s[24:27], s3 offen offset:2048
L2_m10:
    v_and_b32 v47, 0x3f0, v3
    s_cmp_lg_u32 s56, 0
    s_cbranch_scc1 L2_m11
    s_mul_i32 s3, s33, 1280000
    s_add_u32 s3, s3, s100
    s_add_u32 s3, s3, 352768
    buffer_load_dwordx4 v[116:119], v47, s[24:27], s3 offen offset:0
L2_m11:
    s_waitcnt lgkmcnt(0)
    v_cmp_ne_u64 s[50:51], v[72:73], v[68:69]
    v_cmpx_ne_u64 s[54:55], v[74:75], v[70:71]
    s_and_b64 s[82:83], s[54:55], s[80:81]
    s_cbranch_scc1 L2_c12
L2_d12:
    v_mov_b64 v[84:85], v[70:71]
    v_mov_b32 v7, v93
    v_mov_b64 v[86:87], v[74:75]
    s_or_b64 s[80:81], s[80:81], s[54:55]
    s_mov_b64 exec, s[50:51]
    s_and_b64 s[82:83], s[50:51], s[80:81]
    s_cbranch_scc1 L2_c13
L2_d13:
    v_mov_b64 v[84:85], v[68:69]
    v_mov_b32 v7, v92
    v_mov_b64 v[86:87], v[72:73]
    s_mov_b64 exec, -1
    s_or_b64 s[80:81], s[80:81], s[50:51]
    ds_read_b64 v[70:71], v95 offset:65408
    ds_read_b64 v[68:69], v94 offset:65408
    s_waitcnt vmcnt(2)
    v_and_b32 v46, 0x20000000, v27
    v_lshrrev_b32 v47, 14, v23
    v_bitop3_b32 v47, v47, v5, v46 bitop3:0xea
    ds_read_b64 v[102:103], v47
    v_bitop3_b32 v93, v23, v5, v46 bitop3:0xea
    v_and_b32 v46, 0x10000000, v27
    v_lshrrev_b32 v47, 14, v22
    v_bitop3_b32 v47, v47, v5, v46 bitop3:0xea
    ds_read_b64 v[100:101], v47
    v_bitop3_b32 v92, v22, v5, v46 bitop3:0xea
    s_waitcnt lgkmcnt(2)
    v_mfma_f32_4x4x4_16b_bf16 v[80:83], v[10:11], v[70:71], v[80:83]
    v_mfma_f32_4x4x4_16b_bf16 v[76:79], v[10:11], v[68:69], v[76:79]
    v_perm_b32 v15, v23, v26, s45
    v_bitop3_b32 v46, v23, 0.5, -0.5 bitop3:0xa8
    v_perm_b32 v14, v22, v26, s44
    v_bitop3_b32 v47, v22, 0.5, -0.5 bitop3:0xa8
    v_cvt_pk_bf16_f32 v80, v80, v81
    v_cvt_pk_bf16_f32 v81, v82, v83
    ds_wrxchg_rtn_b64 v[74:75], v95, v[80:81] offset:65408
    v_cvt_pk_bf16_f32 v76, v76, v77
    v_cvt_pk_bf16_f32 v77, v78, v79
    ds_wrxchg_rtn_b64 v[72:73], v94, v[76:77] offset:65408
    s_waitcnt lgkmcnt(2)
    v_mfma_f32_4x4x4_16b_bf16 v[80:83], v[8:9], v[102:103], 0
    v_mfma_f32_4x4x4_16b_bf16 v[76:79], v[8:9], v[100:101], 0
    v_bitop3_b32 v15, v6, v15, v46 bitop3:0xca
    v_bitop3_b32 v14, v6, v14, v47 bitop3:0xca
    v_cmp_lt_u32 s[84:85], v5, v92
    s_nop 0
    v_pk_mul_f32 v[80:81], v[80:81], v[14:15] op_sel:[0,1] op_sel_hi:[1,1]
    v_pk_mul_f32 v[82:83], v[82:83], v[14:15] op_sel:[0,1] op_sel_hi:[1,1]
    v_pk_mul_f32 v[76:77], v[76:77], v[14:15] op_sel:[0,0] op_sel_hi:[1,0]
    v_pk_mul_f32 v[78:79], v[78:79], v[14:15] op_sel:[0,0] op_sel_hi:[1,0]
    v_and_b32 v47, 0x0fffffff, v39
    buffer_load_dwordx2 v[34:35], v47, s[8:11], 0 offen
    buffer_load_dwordx3 v[36:38], v47, s[8:11], 0 offen offset:8
    v_and_b32 v47, 0x3f0, v3
    s_cmp_lg_u32 s56, 0
    s_cbranch_scc1 L2_m14
    s_mul_i32 s3, s33, 1280000
    s_add_u32 s3, s3, s100
    s_add_u32 s3, s3, 352768
    buffer_load_dwordx4 v[120:123], v47, s[24:27], s3 offen offset:1024
L2_m14:
    s_waitcnt lgkmcnt(0)
    v_cmp_ne_u64 s[50:51], v[72:73], v[68:69]
    v_cmpx_ne_u64 s[54:55], v[74:75], v[70:71]
    s_and_b64 s[82:83], s[54:55], s[80:81]
    s_cbranch_scc1 L2_c15
L2_d15:
    v_mov_b64 v[84:85], v[70:71]
    v_mov_b32 v7, v95
    v_mov_b64 v[86:87], v[74:75]
    s_or_b64 s[80:81], s[80:81], s[54:55]
    s_mov_b64 exec, s[50:51]
    s_and_b64 s[82:83], s[50:51], s[80:81]
    s_cbranch_scc1 L2_c16
L2_d16:
    v_mov_b64 v[84:85], v[68:69]
    v_mov_b32 v7, v94
    v_mov_b64 v[86:87], v[72:73]
    s_mov_b64 exec, -1
    s_or_b64 s[80:81], s[80:81], s[50:51]
    ds_read_b64 v[70:71], v93 offset:65408
    s_and_b64 exec, s[84:85], s[80:81]
    v_mfma_f32_4x4x4_16b_bf16 v[76:79], v[12:13], v[84:85], 0
    v_mov_b32 v92, v7
    s_andn2_b64 s[80:81], s[80:81], s[84:85]
    v_mfma_f32_4x4x4_16b_bf16 v[76:79], v[10:11], v[86:87], v[76:79]
    s_mov_b64 exec, -1
    ds_read_b64 v[68:69], v92 offset:65408
    v_and_b32 v46, 0x80000000, v27
    v_lshrrev_b32 v47, 14, v25
    v_bitop3_b32 v47, v47, v5, v46 bitop3:0xea
    ds_read_b64 v[106:107], v47
    v_bitop3_b32 v95, v25, v5, v46 bitop3:0xea
    v_and_b32 v46, 0x40000000, v27
    v_lshrrev_b32 v47, 14, v24
    v_bitop3_b32 v47, v47, v5, v46 bitop3:0xea
    ds_read_b64 v[104:105], v47
    v_bitop3_b32 v94, v24, v5, v46 bitop3:0xea
    s_waitcnt lgkmcnt(2)
    v_mfma_f32_4x4x4_16b_bf16 v[80:83], v[10:11], v[70:71], v[80:83]
    v_mfma_f32_4x4x4_16b_bf16 v[76:79], v[10:11], v[68:69], v[76:79]
    v_perm_b32 v15, v25, v26, s47
    v_bitop3_b32 v46, v25, 0.5, -0.5 bitop3:0xa8
    v_perm_b32 v14, v24, v26, s46
    v_bitop3_b32 v47, v24, 0.5, -0.5 bitop3:0xa8
    v_cvt_pk_bf16_f32 v80, v80, v81
    v_cvt_pk_bf16_f32 v81, v82, v83
    ds_wrxchg_rtn_b64 v[74:75], v93, v[80:81] offset:65408
    v_cvt_pk_bf16_f32 v76, v76, v77
    v_cvt_pk_bf16_f32 v77, v78, v79
    ds_wrxchg_rtn_b64 v[72:73], v92, v[76:77] offset:65408
    s_setprio 1
    s_waitcnt lgkmcnt(2)
    v_mfma_f32_4x4x4_16b_bf16 v[80:83], v[8:9], v[106:107], 0
    v_mfma_f32_4x4x4_16b_bf16 v[76:79], v[8:9], v[104:105], 0
    v_bitop3_b32 v15, v6, v15, v46 bitop3:0xca
    v_bitop3_b32 v14, v6, v14, v47 bitop3:0xca
    s_nop 1
    v_pk_mul_f32 v[80:81], v[80:81], v[14:15] op_sel:[0,1] op_sel_hi:[1,1]
    v_pk_mul_f32 v[82:83], v[82:83], v[14:15] op_sel:[0,1] op_sel_hi:[1,1]
    v_pk_mul_f32 v[76:77], v[76:77], v[14:15] op_sel:[0,0] op_sel_hi:[1,0]
    v_pk_mul_f32 v[78:79], v[78:79], v[14:15] op_sel:[0,0] op_sel_hi:[1,0]
    v_and_b32 v47, 0x3f0, v3
    s_cmp_lg_u32 s56, 0
    s_cbranch_scc1 L2_m17
    s_mul_i32 s3, s33, 1280000
    s_add_u32 s3, s3, s38
    s_add_u32 s3, s3, 320000
    buffer_load_dwordx4 v[108:111], v47, s[24:27], s3 offen offset:0
L2_m17:
    v_and_b32 v47, 0x3f0, v3
    s_cmp_lg_u32 s56, 0
    s_cbranch_scc1 L2_m18
    s_mul_i32 s3, s33, 1280000
    s_add_u32 s3, s3, s38
    s_add_u32 s3, s3, 320000
    buffer_load_dwordx4 v[112:115], v47, s[24:27], s3 offen offset:1024
L2_m18:
    v_and_b32 v47, 0x0fffffff, v40
    v_mov_b32 v21, v40
    buffer_load_dwordx2 v[16:17], v47, s[8:11], 0 offen
    buffer_load_dwordx3 v[18:20], v47, s[8:11], 0 offen offset:8
    s_waitcnt lgkmcnt(0)
    v_cmp_ne_u64 s[50:51], v[72:73], v[68:69]
    v_cmpx_ne_u64 s[54:55], v[74:75], v[70:71]
    s_and_b64 s[82:83], s[54:55], s[80:81]
    s_cbranch_scc1 L2_c19
L2_d19:
    v_mov_b64 v[84:85], v[70:71]
    v_mov_b32 v7, v93
    v_mov_b64 v[86:87], v[74:75]
    s_or_b64 s[80:81], s[80:81], s[54:55]
    s_mov_b64 exec, s[50:51]
    s_and_b64 s[82:83], s[50:51], s[80:81]
    s_cbranch_scc1 L2_c20
L2_d20:
    v_mov_b64 v[84:85], v[68:69]
    v_mov_b32 v7, v92
    v_mov_b64 v[86:87], v[72:73]
    s_mov_b64 exec, -1
    s_or_b64 s[80:81], s[80:81], s[50:51]
    ds_read_b64 v[70:71], v95 offset:65408
    ds_read_b64 v[68:69], v94 offset:65408
    s_waitcnt vmcnt(4)
    v_and_b32 v46, 0x20000000, v33
    v_lshrrev_b32 v47, 14, v29
    v_bitop3_b32 v47, v47, v5, v46 bitop3:0xea
    ds_read_b64 v[102:103], v47
    v_bitop3_b32 v93, v29, v5, v46 bitop3:0xea
    v_and_b32 v46, 0x10000000, v33
    v_lshrrev_b32 v47, 14, v28
    v_bitop3_b32 v47, v47, v5, v46 bitop3:0xea
    ds_read_b64 v[100:101], v47
    v_bitop3_b32 v92, v28, v5, v46 bitop3:0xea
    s_waitcnt lgkmcnt(2)
    v_mfma_f32_4x4x4_16b_bf16 v[80:83], v[10:11], v[70:71], v[80:83]
    v_mfma_f32_4x4x4_16b_bf16 v[76:79], v[10:11], v[68:69], v[76:79]
    v_perm_b32 v15, v29, v32, s45
    v_bitop3_b32 v46, v29, 0.5, -0.5 bitop3:0xa8
    v_perm_b32 v14, v28, v32, s44
    v_bitop3_b32 v47, v28, 0.5, -0.5 bitop3:0xa8
    v_cvt_pk_bf16_f32 v80, v80, v81
    v_cvt_pk_bf16_f32 v81, v82, v83
    ds_wrxchg_rtn_b64 v[74:75], v95, v[80:81] offset:65408
    v_cvt_pk_bf16_f32 v76, v76, v77
    v_cvt_pk_bf16_f32 v77, v78, v79
    ds_wrxchg_rtn_b64 v[72:73], v94, v[76:77] offset:65408
    s_waitcnt lgkmcnt(2)
    v_mfma_f32_4x4x4_16b_bf16 v[80:83], v[8:9], v[102:103], 0
    v_mfma_f32_4x4x4_16b_bf16 v[76:79], v[8:9], v[100:101], 0
    v_bitop3_b32 v15, v6, v15, v46 bitop3:0xca
    v_bitop3_b32 v14, v6, v14, v47 bitop3:0xca
    v_cmp_lt_u32 s[84:85], v5, v92
    s_nop 0
    v_pk_mul_f32 v[80:81], v[80:81], v[14:15] op_sel:[0,1] op_sel_hi:[1,1]
    v_pk_mul_f32 v[82:83], v[82:83], v[14:15] op_sel:[0,1] op_sel_hi:[1,1]
    v_pk_mul_f32 v[76:77], v[76:77], v[14:15] op_sel:[0,0] op_sel_hi:[1,0]
    v_pk_mul_f32 v[78:79], v[78:79], v[14:15] op_sel:[0,0] op_sel_hi:[1,0]
    s_waitcnt lgkmcnt(0)
    v_cmp_ne_u64 s[50:51], v[72:73], v[68:69]
    v_cmpx_ne_u64 s[54:55], v[74:75], v[70:71]
    s_and_b64 s[82:83], s[54:55], s[80:81]
    s_cbranch_scc1 L2_c21
L2_d21:
    v_mov_b64 v[84:85], v[70:71]
    v_mov_b32 v7, v95
    v_mov_b64 v[86:87], v[74:75]
    s_or_b64 s[80:81], s[80:81], s[54:55]
    s_mov_b64 exec, s[50:51]
    s_and_b64 s[82:83], s[50:51], s[80:81]
    s_cbranch_scc1 L2_c22
L2_d22:
    v_mov_b64 v[84:85], v[68:69]
    v_mov_b32 v7, v94
    v_mov_b64 v[86:87], v[72:73]
    s_mov_b64 exec, -1
    s_or_b64 s[80:81], s[80:81], s[50:51]
    ds_read_b64 v[70:71], v93 offset:65408
    s_and_b64 exec, s[84:85], s[80:81]
    v_mfma_f32_4x4x4_16b_bf16 v[76:79], v[12:13], v[84:85], 0
    v_mov_b32 v92, v7
    s_andn2_b64 s[80:81], s[80:81], s[84:85]
    v_mfma_f32_4x4x4_16b_bf16 v[76:79], v[10:11], v[86:87], v[76:79]
    s_mov_b64 exec, -1
    ds_read_b64 v[68:69], v92 offset:65408
    v_and_b32 v46, 0x80000000, v33
    v_lshrrev_b32 v47, 14, v31
    v_bitop3_b32 v47, v47, v5, v46 bitop3:0xea
    ds_read_b64 v[106:107], v47
    v_bitop3_b32 v95, v31, v5, v46 bitop3:0xea
    v_and_b32 v46, 0x40000000, v33
    v_lshrrev_b32 v47, 14, v30
    v_bitop3_b32 v47, v47, v5, v46 bitop3:0xea
    ds_read_b64 v[104:105], v47
    v_bitop3_b32 v94, v30, v5, v46 bitop3:0xea
    s_waitcnt lgkmcnt(2)
    v_mfma_f32_4x4x4_16b_bf16 v[80:83], v[10:11], v[70:71], v[80:83]
    v_mfma_f32_4x4x4_16b_bf16 v[76:79], v[10:11], v[68:69], v[76:79]
    v_perm_b32 v15, v31, v32, s47
    v_bitop3_b32 v46, v31, 0.5, -0.5 bitop3:0xa8
    v_perm_b32 v14, v30, v32, s46
    v_bitop3_b32 v47, v30, 0.5, -0.5 bitop3:0xa8
    v_cvt_pk_bf16_f32 v80, v80, v81
    v_cvt_pk_bf16_f32 v81, v82, v83
    ds_wrxchg_rtn_b64 v[74:75], v93, v[80:81] offset:65408
    v_cvt_pk_bf16_f32 v76, v76, v77
    v_cvt_pk_bf16_f32 v77, v78, v79
    ds_wrxchg_rtn_b64 v[72:73], v92, v[76:77] offset:65408
    s_setprio 0
    s_waitcnt lgkmcnt(2)
    v_mfma_f32_4x4x4_16b_bf16 v[80:83], v[8:9], v[106:107], 0
    v_mfma_f32_4x4x4_16b_bf16 v[76:79], v[8:9], v[104:105], 0
    v_bitop3_b32 v15, v6, v15, v46 bitop3:0xca
    v_bitop3_b32 v14, v6, v14, v47 bitop3:0xca
    s_nop 1
    v_pk_mul_f32 v[80:81], v[80:81], v[14:15] op_sel:[0,1] op_sel_hi:[1,1]
    v_pk_mul_f32 v[82:83], v[82:83], v[14:15] op_sel:[0,1] op_sel_hi:[1,1]
    v_pk_mul_f32 v[76:77], v[76:77], v[14:15] op_sel:[0,0] op_sel_hi:[1,0]
    v_pk_mul_f32 v[78:79], v[78:79], v[14:15] op_sel:[0,0] op_sel_hi:[1,0]
    s_add_u32 s40, s40, 0x50000
    v_and_b32 v47, 0x0fffffff, v41
    v_mov_b32 v27, v41
    buffer_load_dwordx2 v[22:23], v47, s[8:11], 0 offen
    buffer_load_dwordx3 v[24:26], v47, s[8:11], 0 offen offset:8
    s_waitcnt lgkmcnt(0)
    v_cmp_ne_u64 s[50:51], v[72:73], v[68:69]
    v_cmpx_ne_u64 s[54:55], v[74:75], v[70:71]
    s_and_b64 s[82:83], s[54:55], s[80:81]
    s_cbranch_scc1 L2_c23
L2_d23:
    v_mov_b64 v[84:85], v[70:71]
    v_mov_b32 v7, v93
    v_mov_b64 v[86:87], v[74:75]
    s_or_b64 s[80:81], s[80:81], s[54:55]
    s_mov_b64 exec, s[50:51]
    s_and_b64 s[82:83], s[50:51], s[80:81]
    s_cbranch_scc1 L2_c24
L2_d24:
    v_mov_b64 v[84:85], v[68:69]
    v_mov_b32 v7, v92
    v_mov_b64 v[86:87], v[72:73]
    s_mov_b64 exec, -1
    s_or_b64 s[80:81], s[80:81], s[50:51]
    ds_read_b64 v[70:71], v95 offset:65408
    ds_read_b64 v[68:69], v94 offset:65408
    s_waitcnt vmcnt(4)
    v_and_b32 v46, 0x20000000, v39
    v_lshrrev_b32 v47, 14, v35
    v_bitop3_b32 v47, v47, v5, v46 bitop3:0xea
    ds_read_b64 v[102:103], v47
    v_bitop3_b32 v93, v35, v5, v46 bitop3:0xea
    v_and_b32 v46, 0x10000000, v39
    v_lshrrev_b32 v47, 14, v34
    v_bitop3_b32 v47, v47, v5, v46 bitop3:0xea
    ds_read_b64 v[100:101], v47
    v_bitop3_b32 v92, v34, v5, v46 bitop3:0xea
    v_and_b32 v46, 0x80000000, v39
    v_lshrrev_b32 v47, 14, v37
    v_bitop3_b32 v47, v47, v5, v46 bitop3:0xea
    ds_read_b64 v[106:107], v47
    v_and_b32 v46, 0x40000000, v39
    v_lshrrev_b32 v47, 14, v36
    v_bitop3_b32 v47, v47, v5, v46 bitop3:0xea
    ds_read_b64 v[104:105], v47
    s_waitcnt lgkmcnt(4)
    v_mfma_f32_4x4x4_16b_bf16 v[80:83], v[10:11], v[70:71], v[80:83]
    v_mfma_f32_4x4x4_16b_bf16 v[76:79], v[10:11], v[68:69], v[76:79]
    v_perm_b32 v15, v35, v38, s45
    v_bitop3_b32 v46, v35, 0.5, -0.5 bitop3:0xa8
    v_perm_b32 v14, v34, v38, s44
    v_bitop3_b32 v47, v34, 0.5, -0.5 bitop3:0xa8
    v_cvt_pk_bf16_f32 v80, v80, v81
    v_cvt_pk_bf16_f32 v81, v82, v83
    ds_wrxchg_rtn_b64 v[74:75], v95, v[80:81] offset:65408
    v_cvt_pk_bf16_f32 v76, v76, v77
    v_cvt_pk_bf16_f32 v77, v78, v79
    ds_wrxchg_rtn_b64 v[72:73], v94, v[76:77] offset:65408
    s_waitcnt lgkmcnt(2)
    s_barrier
    s_setprio 3
    s_waitcnt vmcnt(6)
    v_subrev_u32 v88, s38, v3
    ds_write_b128 v88, v[116:119] offset:32768
    buffer_load_dwordx4 v[116:119], v3, s[16:19], s40 offen offset:2048
    s_waitcnt vmcnt(5)
    v_subrev_u32 v88, s38, v3
    ds_write_b128 v88, v[120:123] offset:33792
    buffer_load_dwordx4 v[120:123], v3, s[16:19], s40 offen offset:3072
    v_mfma_f32_4x4x4_16b_bf16 v[80:83], v[8:9], v[102:103], 0
    v_mfma_f32_4x4x4_16b_bf16 v[76:79], v[8:9], v[100:101], 0
    v_bitop3_b32 v15, v6, v15, v46 bitop3:0xca
    v_bitop3_b32 v14, v6, v14, v47 bitop3:0xca
    v_cmp_lt_u32 s[84:85], v5, v92
    s_nop 0
    v_pk_mul_f32 v[80:81], v[80:81], v[14:15] op_sel:[0,1] op_sel_hi:[1,1]
    v_pk_mul_f32 v[82:83], v[82:83], v[14:15] op_sel:[0,1] op_sel_hi:[1,1]
    v_pk_mul_f32 v[76:77], v[76:77], v[14:15] op_sel:[0,0] op_sel_hi:[1,0]
    v_pk_mul_f32 v[78:79], v[78:79], v[14:15] op_sel:[0,0] op_sel_hi:[1,0]
    v_and_b32 v47, 0x0fffffff, v42
    v_mov_b32 v33, v42
    buffer_load_dwordx2 v[28:29], v47, s[8:11], 0 offen
    buffer_load_dwordx3 v[30:32], v47, s[8:11], 0 offen offset:8
    v_mov_b32 v44, v43
    s_cmp_gt_u32 s37, 1024
    s_cbranch_scc1 L2_xs25
    s_cmp_lg_u32 s101, 0
    s_cbranch_scc1 L2_xa25
L2_xb25:
    v_lshlrev_b32 v89, 16, v96
    v_add_u32 v90, 60, v97
    v_bitop3_b32 v90, v89, v45, v90 bitop3:0x6a
    ds_write_b32 v98, v90 offset:12
    v_lshlrev_b32 v89, 20, v96
    v_add_u32 v90, 40, v97
    v_bitop3_b32 v90, v89, v45, v90 bitop3:0x6a
    ds_write_b32 v98, v90 offset:8
    v_lshlrev_b32 v89, 24, v96
    v_add_u32 v90, 20, v97
    v_bitop3_b32 v90, v89, v45, v90 bitop3:0x6a
    ds_write_b32 v98, v90 offset:4
    v_lshlrev_b32 v89, 28, v96
    v_bitop3_b32 v90, v89, v45, v97 bitop3:0x6a
    ds_write_b32 v98, v90 offset:0
    v_mov_b32_dpp v91, v64 quad_perm:[1,1,1,1] row_mask:0xf bank_mask:0xf
    v_and_b32 v89, 3, v91
    v_and_b32 v97, 0xfffc, v91
    v_sub_u16_dpp v88, v64, v91 quad_perm:[3,3,3,3] row_mask:0xf bank_mask:0xf
    v_mad_u32_u24 v97, v97, 5, v4
    v_add_u32 v99, v88, v89
    v_bfm_b32 v96, v88, v89
    v_cmp_lt_u32 s[58:59], 16, v99
    v_lshlrev_b32 v89, v1, v96
    v_and_b32 v89, v45, v89
    v_cmp_ne_u32 vcc, 0, v89
    v_xor_b32 v90, v97, v89
    s_add_u32 s3, s37, s38
    v_mbcnt_lo_u32_b32 v98, vcc_lo, 0
    v_mbcnt_hi_u32_b32 v98, vcc_hi, v98
    s_bcnt1_i32_b64 s41, vcc
    v_lshl_add_u32 v98, v98, 2, s3
    s_mov_b64 exec, vcc
    ds_write_b32 v98, v90
    s_mov_b64 exec, -1
    s_lshl2_add_u32 s37, s41, s37
    s_cmp_lg_u64 s[58:59], 0
    s_cbranch_scc1 L2_xe25
L2_xr25:
    v_add_u32 v98, s37, v0
    v_mov_b32 v90, -1
    ds_write_b32 v98, v90
    ds_read2st64_b32 v[40:41], v0 offset0:0 offset1:1
    ds_read2st64_b32 v[42:43], v0 offset0:2 offset1:3
    s_sub_u32 s3, s37, 768
    s_cmp_gt_u32 s3, 256
    s_cbranch_scc1 L2_xf25
L2_xg25:
    s_setprio 2
    s_waitcnt vmcnt(10)
    v_subrev_u32 v88, s38, v3
    ds_write_b128 v88, v[124:127] offset:34816
    s_add_u32 s3, s40, 4096
    buffer_load_dwordx4 v[124:127], v3, s[16:19], s3 offen
    s_waitcnt lgkmcnt(11)
    v_cmp_ne_u64 s[50:51], v[72:73], v[68:69]
    v_cmpx_ne_u64 s[54:55], v[74:75], v[70:71]
    s_and_b64 s[82:83], s[54:55], s[80:81]
    s_cbranch_scc1 L2_c26
L2_d26:
    v_mov_b64 v[84:85], v[70:71]
    v_mov_b32 v7, v95
    v_mov_b64 v[86:87], v[74:75]
    s_or_b64 s[80:81], s[80:81], s[54:55]
    s_mov_b64 exec, s[50:51]
    s_and_b64 s[82:83], s[50:51], s[80:81]
    s_cbranch_scc1 L2_c27
L2_d27:
    v_mov_b64 v[84:85], v[68:69]
    v_mov_b32 v7, v94
    v_mov_b64 v[86:87], v[72:73]
    s_mov_b64 exec, -1
    s_or_b64 s[80:81], s[80:81], s[50:51]
    ds_read_b64 v[70:71], v93 offset:65408
    s_and_b64 exec, s[84:85], s[80:81]
    v_mfma_f32_4x4x4_16b_bf16 v[76:79], v[12:13], v[84:85], 0
    v_mov_b32 v92, v7
    s_andn2_b64 s[80:81], s[80:81], s[84:85]
    v_mfma_f32_4x4x4_16b_bf16 v[76:79], v[10:11], v[86:87], v[76:79]
    s_mov_b64 exec, -1
    ds_read_b64 v[68:69], v92 offset:65408
    s_setprio 1
    s_waitcnt vmcnt(9)
    v_subrev_u32 v88, s100, v3
    ds_write_b128 v88, v[108:111] offset:0
    s_waitcnt lgkmcnt(1)
    v_mfma_f32_4x4x4_16b_bf16 v[80:83], v[10:11], v[70:71], v[80:83]
    v_mfma_f32_4x4x4_16b_bf16 v[76:79], v[10:11], v[68:69], v[76:79]
    v_and_b32 v46, 0x40000000, v39
    v_bitop3_b32 v94, v36, v5, v46 bitop3:0xea
    v_and_b32 v46, 0x80000000, v39
    v_bitop3_b32 v95, v37, v5, v46 bitop3:0xea
    v_perm_b32 v15, v37, v38, s47
    v_bitop3_b32 v46, v37, 0.5, -0.5 bitop3:0xa8
    v_perm_b32 v14, v36, v38, s46
    v_bitop3_b32 v47, v36, 0.5, -0.5 bitop3:0xa8
    v_cvt_pk_bf16_f32 v80, v80, v81
    v_cvt_pk_bf16_f32 v81, v82, v83
    ds_wrxchg_rtn_b64 v[74:75], v93, v[80:81] offset:65408
    v_cvt_pk_bf16_f32 v76, v76, v77
    v_cvt_pk_bf16_f32 v77, v78, v79
    ds_wrxchg_rtn_b64 v[72:73], v92, v[76:77] offset:65408
    s_setprio 0
    s_waitcnt vmcnt(9)
    v_subrev_u32 v88, s100, v3
    ds_write_b128 v88, v[112:115] offset:1024
    v_mfma_f32_4x4x4_16b_bf16 v[80:83], v[8:9], v[106:107], 0
    v_mfma_f32_4x4x4_16b_bf16 v[76:79], v[8:9], v[104:105], 0
    v_bitop3_b32 v15, v6, v15, v46 bitop3:0xca
    v_bitop3_b32 v14, v6, v14, v47 bitop3:0xca
    s_nop 1
    v_pk_mul_f32 v[80:81], v[80:81], v[14:15] op_sel:[0,1] op_sel_hi:[1,1]
    v_pk_mul_f32 v[82:83], v[82:83], v[14:15] op_sel:[0,1] op_sel_hi:[1,1]
    v_pk_mul_f32 v[76:77], v[76:77], v[14:15] op_sel:[0,0] op_sel_hi:[1,0]
    v_pk_mul_f32 v[78:79], v[78:79], v[14:15] op_sel:[0,0] op_sel_hi:[1,0]
    s_add_u32 s42, s42, 1
    s_waitcnt lgkmcnt(0)
    s_add_u32 s24, s30, 0xebcd000
    s_addc_u32 s25, s31, 0
    s_mov_b32 s26, 0x100
    s_mov_b32 s27, 0x20000
    s_barrier
    s_bitcmp1_b32 s36, s42
    s_cbranch_scc1 L2_slow
L2_ret1:
    s_setprio 3
    v_and_b32 v47, 0x0fffffff, v44
    v_mov_b32 v39, v44
    buffer_load_dwordx2 v[34:35], v47, s[8:11], 0 offen
    buffer_load_dwordx3 v[36:38], v47, s[8:11], 0 offen offset:8
    buffer_load_dwordx4 v[108:111], v3, s[16:19], s40 offen offset:0
    v_cmp_ne_u64 s[50:51], v[72:73], v[68:69]
    v_cmpx_ne_u64 s[54:55], v[74:75], v[70:71]
    s_and_b64 s[82:83], s[54:55], s[80:81]
    s_cbranch_scc1 L2_c28
L2_d28:
    v_mov_b64 v[84:85], v[70:71]
    v_mov_b32 v7, v93
    v_mov_b64 v[86:87], v[74:75]
    s_or_b64 s[80:81], s[80:81], s[54:55]
    s_mov_b64 exec, s[50:51]
    s_and_b64 s[82:83], s[50:51], s[80:81]
    s_cbranch_scc1 L2_c29
L2_d29:
    v_mov_b64 v[84:85], v[68:69]
    v_mov_b32 v7, v92
    v_mov_b64 v[86:87], v[72:73]
    s_mov_b64 exec, -1
    s_or_b64 s[80:81], s[80:81], s[50:51]
    ds_read_b64 v[70:71], v95 offset:65408
    ds_read_b64 v[68:69], v94 offset:65408
    s_waitcnt vmcnt(10)
    v_and_b32 v46, 0x20000000, v21
    v_lshrrev_b32 v47, 14, v17
    v_bitop3_b32 v47, v47, v5, v46 bitop3:0xea
    ds_read_b64 v[102:103], v47
    v_bitop3_b32 v93, v17, v5, v46 bitop3:0xea
    v_and_b32 v46, 0x10000000, v21
    v_lshrrev_b32 v47, 14, v16
    v_bitop3_b32 v47, v47, v5, v46 bitop3:0xea
    ds_read_b64 v[100:101], v47
    v_bitop3_b32 v92, v16, v5, v46 bitop3:0xea
    s_waitcnt lgkmcnt(2)
    v_mfma_f32_4x4x4_16b_bf16 v[80:83], v[10:11], v[70:71], v[80:83]
    v_mfma_f32_4x4x4_16b_bf16 v[76:79], v[10:11], v[68:69], v[76:79]
    v_perm_b32 v15, v17, v20, s45
    v_bitop3_b32 v46, v17, 0.5, -0.5 bitop3:0xa8
    v_perm_b32 v14, v16, v20, s44
    v_bitop3_b32 v47, v16, 0.5, -0.5 bitop3:0xa8
    v_cvt_pk_bf16_f32 v80, v80, v81
    v_cvt_pk_bf16_f32 v81, v82, v83
    ds_wrxchg_rtn_b64 v[74:75], v95, v[80:81] offset:65408
    v_cvt_pk_bf16_f32 v76, v76, v77
    v_cvt_pk_bf16_f32 v77, v78, v79
    ds_wrxchg_rtn_b64 v[72:73], v94, v[76:77] offset:65408
    s_waitcnt lgkmcnt(2)
    v_mfma_f32_4x4x4_16b_bf16 v[80:83], v[8:9], v[102:103], 0
    v_mfma_f32_4x4x4_16b_bf16 v[76:79], v[8:9], v[100:101], 0
    v_bitop3_b32 v15, v6, v15, v46 bitop3:0xca
    v_bitop3_b32 v14, v6, v14, v47 bitop3:0xca
    v_cmp_lt_u32 s[84:85], v5, v92
    s_nop 0
    v_pk_mul_f32 v[80:81], v[80:81], v[14:15] op_sel:[0,1] op_sel_hi:[1,1]
    v_pk_mul_f32 v[82:83], v[82:83], v[14:15] op_sel:[0,1] op_sel_hi:[1,1]
    v_pk_mul_f32 v[76:77], v[76:77], v[14:15] op_sel:[0,0] op_sel_hi:[1,0]
    v_pk_mul_f32 v[78:79], v[78:79], v[14:15] op_sel:[0,0] op_sel_hi:[1,0]
    buffer_load_dwordx4 v[112:115], v3, s[16:19], s40 offen offset:1024
    s_waitcnt lgkmcnt(0)
    v_cmp_ne_u64 s[50:51], v[72:73], v[68:69]
    v_cmpx_ne_u64 s[54:55], v[74:75], v[70:71]
    s_and_b64 s[82:83], s[54:55], s[80:81]
    s_cbranch_scc1 L2_c30
L2_d30:
    v_mov_b64 v[84:85], v[70:71]
    v_mov_b32 v7, v95
    v_mov_b64 v[86:87], v[74:75]
    s_or_b64 s[80:81], s[80:81], s[54:55]
    s_mov_b64 exec, s[50:51]
    s_and_b64 s[82:83], s[50:51], s[80:81]
    s_cbranch_scc1 L2_c31
L2_d31:
    v_mov_b64 v[84:85], v[68:69]
    v_mov_b32 v7, v94
    v_mov_b64 v[86:87], v[72:73]
    s_mov_b64 exec, -1
    s_or_b64 s[80:81], s[80:81], s[50:51]
    ds_read_b64 v[70:71], v93 offset:65408
    s_and_b64 exec, s[84:85], s[80:81]
    v_mfma_f32_4x4x4_16b_bf16 v[76:79], v[12:13], v[84:85], 0
    v_mov_b32 v92, v7
    s_andn2_b64 s[80:81], s[80:81], s[84:85]
    v_mfma_f32_4x4x4_16b_bf16 v[76:79], v[10:11], v[86:87], v[76:79]
    s_mov_b64 exec, -1
    ds_read_b64 v[68:69], v92 offset:65408
    v_and_b32 v46, 0x80000000, v21
    v_lshrrev_b32 v47, 14, v19
    v_bitop3_b32 v47, v47, v5, v46 bitop3:0xea
    ds_read_b64 v[106:107], v47
    v_bitop3_b32 v95, v19, v5, v46 bitop3:0xea
    v_and_b32 v46, 0x40000000, v21
    v_lshrrev_b32 v47, 14, v18
    v_bitop3_b32 v47, v47, v5, v46 bitop3:0xea
    ds_read_b64 v[104:105], v47
    v_bitop3_b32 v94, v18, v5, v46 bitop3:0xea
    s_waitcnt lgkmcnt(2)
    v_mfma_f32_4x4x4_16b_bf16 v[80:83], v[10:11], v[70:71], v[80:83]
    v_mfma_f32_4x4x4_16b_bf16 v[76:79], v[10:11], v[68:69], v[76:79]
    v_perm_b32 v15, v19, v20, s47
    v_bitop3_b32 v46, v19, 0.5, -0.5 bitop3:0xa8
    v_perm_b32 v14, v18, v20, s46
    v_bitop3_b32 v47, v18, 0.5, -0.5 bitop3:0xa8
    v_cvt_pk_bf16_f32 v80, v80, v81
    v_cvt_pk_bf16_f32 v81, v82, v83
    ds_wrxchg_rtn_b64 v[74:75], v93, v[80:81] offset:65408
    v_cvt_pk_bf16_f32 v76, v76, v77
    v_cvt_pk_bf16_f32 v77, v78, v79
    ds_wrxchg_rtn_b64 v[72:73], v92, v[76:77] offset:65408
    s_setprio 2
    s_waitcnt lgkmcnt(2)
    v_mfma_f32_4x4x4_16b_bf16 v[80:83], v[8:9], v[106:107], 0
    v_mfma_f32_4x4x4_16b_bf16 v[76:79], v[8:9], v[104:105], 0
    v_bitop3_b32 v15, v6, v15, v46 bitop3:0xca
    v_bitop3_b32 v14, v6, v14, v47 bitop3:0xca
    s_nop 1
    v_pk_mul_f32 v[80:81], v[80:81], v[14:15] op_sel:[0,1] op_sel_hi:[1,1]
    v_pk_mul_f32 v[82:83], v[82:83], v[14:15] op_sel:[0,1] op_sel_hi:[1,1]
    v_pk_mul_f32 v[76:77], v[76:77], v[14:15] op_sel:[0,0] op_sel_hi:[1,0]
    v_pk_mul_f32 v[78:79], v[78:79], v[14:15] op_sel:[0,0] op_sel_hi:[1,0]
    v_sub_u16 v88, v62, v54
    v_and_b32 v89, 3, v54
    v_add3_u32 v99, v88, v89, 3
    v_and_b32 v99, -4, v99
    v_max_u32 v99, 4, v99
    v_and_b32 v97, 0xfffc, v54
    v_bfm_b32 v96, v88, v89
    v_add_u32_dpp v91, v99, v99 row_shr:1 row_mask:0xf bank_mask:0xf bound_ctrl:1
    v_mad_u32_u24 v97, v97, 5, v2
    v_cmp_lt_u32 vcc, 16, v99
    v_add_u32_dpp v91, v91, v91 row_shr:2 row_mask:0xf bank_mask:0xf bound_ctrl:1
    v_sub_u32 v98, s38, v99
    v_lshrrev_b64 v[54:55], 16, v[54:55]
    v_add_u32_dpp v91, v91, v91 row_shr:4 row_mask:0xf bank_mask:0xf bound_ctrl:1
    v_lshrrev_b64 v[62:63], 16, v[62:63]
    s_mov_b32 s101, 0
    v_add_u32_dpp v91, v91, v91 row_shr:8 row_mask:0xf bank_mask:0xf bound_ctrl:1
    s_nop 1
    v_add_u32_dpp v91, v91, v91 row_bcast:15 row_mask:0xa bank_mask:0xf
    s_nop 1
    v_add_u32_dpp v91, v91, v91 row_bcast:31 row_mask:0xc bank_mask:0xf
    v_add_u32 v98, v98, v91
    v_readlane_b32 s37, v91, 63
    s_cbranch_vccnz L2_xo32
L2_xp32:
    v_and_b32 v47, 0x0fffffff, v40
    v_mov_b32 v21, v40
    buffer_load_dwordx2 v[16:17], v47, s[8:11], 0 offen
    buffer_load_dwordx3 v[18:20], v47, s[8:11], 0 offen offset:8
    s_waitcnt lgkmcnt(0)
    v_cmp_ne_u64 s[50:51], v[72:73], v[68:69]
    v_cmpx_ne_u64 s[54:55], v[74:75], v[70:71]
    s_and_b64 s[82:83], s[54:55], s[80:81]
    s_cbranch_scc1 L2_c33
L2_d33:
    v_mov_b64 v[84:85], v[70:71]
    v_mov_b32 v7, v93
    v_mov_b64 v[86:87], v[74:75]
    s_or_b64 s[80:81], s[80:81], s[54:55]
    s_mov_b64 exec, s[50:51]
    s_and_b64 s[82:83], s[50:51], s[80:81]
    s_cbranch_scc1 L2_c34
L2_d34:
    v_mov_b64 v[84:85], v[68:69]
    v_mov_b32 v7, v92
    v_mov_b64 v[86:87], v[72:73]
    s_mov_b64 exec, -1
    s_or_b64 s[80:81], s[80:81], s[50:51]
    ds_read_b64 v[70:71], v95 offset:65408
    ds_read_b64 v[68:69], v94 offset:65408
    s_waitcnt vmcnt(11)
    v_and_b32 v46, 0x20000000, v27
    v_lshrrev_b32 v47, 14, v23
    v_bitop3_b32 v47, v47, v5, v46 bitop3:0xea
    ds_read_b64 v[102:103], v47
    v_bitop3_b32 v93, v23, v5, v46 bitop3:0xea
    v_and_b32 v46, 0x10000000, v27
    v_lshrrev_b32 v47, 14, v22
    v_bitop3_b32 v47, v47, v5, v46 bitop3:0xea
    ds_read_b64 v[100:101], v47
    v_bitop3_b32 v92, v22, v5, v46 bitop3:0xea
    s_waitcnt lgkmcnt(2)
    v_mfma_f32_4x4x4_16b_bf16 v[80:83], v[10:11], v[70:71], v[80:83]
    v_mfma_f32_4x4x4_16b_bf16 v[76:79], v[10:11], v[68:69], v[76:79]
    v_perm_b32 v15, v23, v26, s45
    v_bitop3_b32 v46, v23, 0.5, -0.5 bitop3:0xa8
    v_perm_b32 v14, v22, v26, s44
    v_bitop3_b32 v47, v22, 0.5, -0.5 bitop3:0xa8
    v_cvt_pk_bf16_f32 v80, v80, v81
    v_cvt_pk_bf16_f32 v81, v82, v83
    ds_wrxchg_rtn_b64 v[74:75], v95, v[80:81] offset:65408
    v_cvt_pk_bf16_f32 v76, v76, v77
    v_cvt_pk_bf16_f32 v77, v78, v79
    ds_wrxchg_rtn_b64 v[72:73], v94, v[76:77] offset:65408
    s_waitcnt lgkmcnt(2)
    v_mfma_f32_4x4x4_16b_bf16 v[80:83], v[8:9], v[102:103], 0
    v_mfma_f32_4x4x4_16b_bf16 v[76:79], v[8:9], v[100:101], 0
    v_bitop3_b32 v15, v6, v15, v46 bitop3:0xca
    v_bitop3_b32 v14, v6, v14, v47 bitop3:0xca
    v_cmp_lt_u32 s[84:85], v5, v92
    s_nop 0
    v_pk_mul_f32 v[80:81], v[80:81], v[14:15] op_sel:[0,1] op_sel_hi:[1,1]
    v_pk_mul_f32 v[82:83], v[82:83], v[14:15] op_sel:[0,1] op_sel_hi:[1,1]
    v_pk_mul_f32 v[76:77], v[76:77], v[14:15] op_sel:[0,0] op_sel_hi:[1,0]
    v_pk_mul_f32 v[78:79], v[78:79], v[14:15] op_sel:[0,0] op_sel_hi:[1,0]
    s_waitcnt lgkmcnt(0)
    v_cmp_ne_u64 s[50:51], v[72:73], v[68:69]
    v_cmpx_ne_u64 s[54:55], v[74:75], v[70:71]
    s_and_b64 s[82:83], s[54:55], s[80:81]
    s_cbranch_scc1 L2_c35
L2_d35:
    v_mov_b64 v[84:85], v[70:71]
    v_mov_b32 v7, v95
    v_mov_b64 v[86:87], v[74:75]
    s_or_b64 s[80:81], s[80:81], s[54:55]
    s_mov_b64 exec, s[50:51]
    s_and_b64 s[82:83], s[50:51], s[80:81]
    s_cbranch_scc1 L2_c36
L2_d36:
    v_mov_b64 v[84:85], v[68:69]
    v_mov_b32 v7, v94
    v_mov_b64 v[86:87], v[72:73]
    s_mov_b64 exec, -1
    s_or_b64 s[80:81], s[80:81], s[50:51]
    ds_read_b64 v[70:71], v93 offset:65408
    s_and_b64 exec, s[84:85], s[80:81]
    v_mfma_f32_4x4x4_16b_bf16 v[76:79], v[12:13], v[84:85], 0
    v_mov_b32 v92, v7
    s_andn2_b64 s[80:81], s[80:81], s[84:85]
    v_mfma_f32_4x4x4_16b_bf16 v[76:79], v[10:11], v[86:87], v[76:79]
    s_mov_b64 exec, -1
    ds_read_b64 v[68:69], v92 offset:65408
    v_and_b32 v46, 0x80000000, v27
    v_lshrrev_b32 v47, 14, v25
    v_bitop3_b32 v47, v47, v5, v46 bitop3:0xea
    ds_read_b64 v[106:107], v47
    v_bitop3_b32 v95, v25, v5, v46 bitop3:0xea
    v_and_b32 v46, 0x40000000, v27
    v_lshrrev_b32 v47, 14, v24
    v_bitop3_b32 v47, v47, v5, v46 bitop3:0xea
    ds_read_b64 v[104:105], v47
    v_bitop3_b32 v94, v24, v5, v46 bitop3:0xea
    s_waitcnt lgkmcnt(2)
    v_mfma_f32_4x4x4_16b_bf16 v[80:83], v[10:11], v[70:71], v[80:83]
    v_mfma_f32_4x4x4_16b_bf16 v[76:79], v[10:11], v[68:69], v[76:79]
    v_perm_b32 v15, v25, v26, s47
    v_bitop3_b32 v46, v25, 0.5, -0.5 bitop3:0xa8
    v_perm_b32 v14, v24, v26, s46
    v_bitop3_b32 v47, v24, 0.5, -0.5 bitop3:0xa8
    v_cvt_pk_bf16_f32 v80, v80, v81
    v_cvt_pk_bf16_f32 v81, v82, v83
    ds_wrxchg_rtn_b64 v[74:75], v93, v[80:81] offset:65408
    v_cvt_pk_bf16_f32 v76, v76, v77
    v_cvt_pk_bf16_f32 v77, v78, v79
    ds_wrxchg_rtn_b64 v[72:73], v92, v[76:77] offset:65408
    s_setprio 1
    s_waitcnt lgkmcnt(2)
    v_mfma_f32_4x4x4_16b_bf16 v[80:83], v[8:9], v[106:107], 0
    v_mfma_f32_4x4x4_16b_bf16 v[76:79], v[8:9], v[104:105], 0
    v_bitop3_b32 v15, v6, v15, v46 bitop3:0xca
    v_bitop3_b32 v14, v6, v14, v47 bitop3:0xca
    s_nop 1
    v_pk_mul_f32 v[80:81], v[80:81], v[14:15] op_sel:[0,1] op_sel_hi:[1,1]
    v_pk_mul_f32 v[82:83], v[82:83], v[14:15] op_sel:[0,1] op_sel_hi:[1,1]
    v_pk_mul_f32 v[76:77], v[76:77], v[14:15] op_sel:[0,0] op_sel_hi:[1,0]
    v_pk_mul_f32 v[78:79], v[78:79], v[14:15] op_sel:[0,0] op_sel_hi:[1,0]
    v_and_b32 v47, 0x0fffffff, v41
    v_mov_b32 v27, v41
    buffer_load_dwordx2 v[22:23], v47, s[8:11], 0 offen
    buffer_load_dwordx3 v[24:26], v47, s[8:11], 0 offen offset:8
    s_waitcnt lgkmcnt(0)
    v_cmp_ne_u64 s[50:51], v[72:73], v[68:69]
    v_cmpx_ne_u64 s[54:55], v[74:75], v[70:71]
    s_and_b64 s[82:83], s[54:55], s[80:81]
    s_cbranch_scc1 L2_c37
L2_d37:
    v_mov_b64 v[84:85], v[70:71]
    v_mov_b32 v7, v93
    v_mov_b64 v[86:87], v[74:75]
    s_or_b64 s[80:81], s[80:81], s[54:55]
    s_mov_b64 exec, s[50:51]
    s_and_b64 s[82:83], s[50:51], s[80:81]
    s_cbranch_scc1 L2_c38
L2_d38:
    v_mov_b64 v[84:85], v[68:69]
    v_mov_b32 v7, v92
    v_mov_b64 v[86:87], v[72:73]
    s_mov_b64 exec, -1
    s_or_b64 s[80:81], s[80:81], s[50:51]
    ds_read_b64 v[70:71], v95 offset:65408
    ds_read_b64 v[68:69], v94 offset:65408
    s_waitcnt vmcnt(9)
    v_and_b32 v46, 0x20000000, v33
    v_lshrrev_b32 v47, 14, v29
    v_bitop3_b32 v47, v47, v5, v46 bitop3:0xea
    ds_read_b64 v[102:103], v47
    v_bitop3_b32 v93, v29, v5, v46 bitop3:0xea
    v_and_b32 v46, 0x10000000, v33
    v_lshrrev_b32 v47, 14, v28
    v_bitop3_b32 v47, v47, v5, v46 bitop3:0xea
    ds_read_b64 v[100:101], v47
    v_bitop3_b32 v92, v28, v5, v46 bitop3:0xea
    s_waitcnt lgkmcnt(2)
    v_mfma_f32_4x4x4_16b_bf16 v[80:83], v[10:11], v[70:71], v[80:83]
    v_mfma_f32_4x4x4_16b_bf16 v[76:79], v[10:11], v[68:69], v[76:79]
    v_perm_b32 v15, v29, v32, s45
    v_bitop3_b32 v46, v29, 0.5, -0.5 bitop3:0xa8
    v_perm_b32 v14, v28, v32, s44
    v_bitop3_b32 v47, v28, 0.5, -0.5 bitop3:0xa8
    v_cvt_pk_bf16_f32 v80, v80, v81
    v_cvt_pk_bf16_f32 v81, v82, v83
    ds_wrxchg_rtn_b64 v[74:75], v95, v[80:81] offset:65408
    v_cvt_pk_bf16_f32 v76, v76, v77
    v_cvt_pk_bf16_f32 v77, v78, v79
    ds_wrxchg_rtn_b64 v[72:73], v94, v[76:77] offset:65408
    s_waitcnt lgkmcnt(2)
    v_mfma_f32_4x4x4_16b_bf16 v[80:83], v[8:9], v[102:103], 0
    v_mfma_f32_4x4x4_16b_bf16 v[76:79], v[8:9], v[100:101], 0
    v_bitop3_b32 v15, v6, v15, v46 bitop3:0xca
    v_bitop3_b32 v14, v6, v14, v47 bitop3:0xca
    v_cmp_lt_u32 s[84:85], v5, v92
    s_nop 0
    v_pk_mul_f32 v[80:81], v[80:81], v[14:15] op_sel:[0,1] op_sel_hi:[1,1]
    v_pk_mul_f32 v[82:83], v[82:83], v[14:15] op_sel:[0,1] op_sel_hi:[1,1]
    v_pk_mul_f32 v[76:77], v[76:77], v[14:15] op_sel:[0,0] op_sel_hi:[1,0]
    v_pk_mul_f32 v[78:79], v[78:79], v[14:15] op_sel:[0,0] op_sel_hi:[1,0]
    s_waitcnt lgkmcnt(0)
    v_cmp_ne_u64 s[50:51], v[72:73], v[68:69]
    v_cmpx_ne_u64 s[54:55], v[74:75], v[70:71]
    s_and_b64 s[82:83], s[54:55], s[80:81]
    s_cbranch_scc1 L2_c39
L2_d39:
    v_mov_b64 v[84:85], v[70:71]
    v_mov_b32 v7, v95
    v_mov_b64 v[86:87], v[74:75]
    s_or_b64 s[80:81], s[80:81], s[54:55]
    s_mov_b64 exec, s[50:51]
    s_and_b64 s[82:83], s[50:51], s[80:81]
    s_cbranch_scc1 L2_c40
L2_d40:
    v_mov_b64 v[84:85], v[68:69]
    v_mov_b32 v7, v94
    v_mov_b64 v[86:87], v[72:73]
    s_mov_b64 exec, -1
    s_or_b64 s[80:81], s[80:81], s[50:51]
    ds_read_b64 v[70:71], v93 offset:65408
    s_and_b64 exec, s[84:85], s[80:81]
    v_mfma_f32_4x4x4_16b_bf16 v[76:79], v[12:13], v[84:85], 0
    v_mov_b32 v92, v7
    s_andn2_b64 s[80:81], s[80:81], s[84:85]
    v_mfma_f32_4x4x4_16b_bf16 v[76:79], v[10:11], v[86:87], v[76:79]
    s_mov_b64 exec, -1
    ds_read_b64 v[68:69], v92 offset:65408
    v_and_b32 v46, 0x80000000, v33
    v_lshrrev_b32 v47, 14, v31
    v_bitop3_b32 v47, v47, v5, v46 bitop3:0xea
    ds_read_b64 v[106:107], v47
    v_bitop3_b32 v95, v31, v5, v46 bitop3:0xea
    v_and_b32 v46, 0x40000000, v33
    v_lshrrev_b32 v47, 14, v30
    v_bitop3_b32 v47, v47, v5, v46 bitop3:0xea
    ds_read_b64 v[104:105], v47
    v_bitop3_b32 v94, v30, v5, v46 bitop3:0xea
    s_waitcnt lgkmcnt(2)
    v_mfma_f32_4x4x4_16b_bf16 v[80:83], v[10:11], v[70:71], v[80:83]
    v_mfma_f32_4x4x4_16b_bf16 v[76:79], v[10:11], v[68:69], v[76:79]
    v_perm_b32 v15, v31, v32, s47
    v_bitop3_b32 v46, v31, 0.5, -0.5 bitop3:0xa8
    v_perm_b32 v14, v30, v32, s46
    v_bitop3_b32 v47, v30, 0.5, -0.5 bitop3:0xa8
    v_cvt_pk_bf16_f32 v80, v80, v81
    v_cvt_pk_bf16_f32 v81, v82, v83
    ds_wrxchg_rtn_b64 v[74:75], v93, v[80:81] offset:65408
    v_cvt_pk_bf16_f32 v76, v76, v77
    v_cvt_pk_bf16_f32 v77, v78, v79
    ds_wrxchg_rtn_b64 v[72:73], v92, v[76:77] offset:65408
    s_setprio 0
    s_waitcnt lgkmcnt(2)
    v_mfma_f32_4x4x4_16b_bf16 v[80:83], v[8:9], v[106:107], 0
    v_mfma_f32_4x4x4_16b_bf16 v[76:79], v[8:9], v[104:105], 0
    v_bitop3_b32 v15, v6, v15, v46 bitop3:0xca
    v_bitop3_b32 v14, v6, v14, v47 bitop3:0xca
    s_nop 1
    v_pk_mul_f32 v[80:81], v[80:81], v[14:15] op_sel:[0,1] op_sel_hi:[1,1]
    v_pk_mul_f32 v[82:83], v[82:83], v[14:15] op_sel:[0,1] op_sel_hi:[1,1]
    v_pk_mul_f32 v[76:77], v[76:77], v[14:15] op_sel:[0,0] op_sel_hi:[1,0]
    v_pk_mul_f32 v[78:79], v[78:79], v[14:15] op_sel:[0,0] op_sel_hi:[1,0]
    s_add_u32 s40, s40, 0x50000
    v_and_b32 v47, 0x0fffffff, v42
    v_mov_b32 v33, v42
    buffer_load_dwordx2 v[28:29], v47, s[8:11], 0 offen
    buffer_load_dwordx3 v[30:32], v47, s[8:11], 0 offen offset:8
    s_waitcnt lgkmcnt(0)
    v_cmp_ne_u64 s[50:51], v[72:73], v[68:69]
    v_cmpx_ne_u64 s[54:55], v[74:75], v[70:71]
    s_and_b64 s[82:83], s[54:55], s[80:81]
    s_cbranch_scc1 L2_c41
L2_d41:
    v_mov_b64 v[84:85], v[70:71]
    v_mov_b32 v7, v93
    v_mov_b64 v[86:87], v[74:75]
    s_or_b64 s[80:81], s[80:81], s[54:55]
    s_mov_b64 exec, s[50:51]
    s_and_b64 s[82:83], s[50:51], s[80:81]
    s_cbranch_scc1 L2_c42
L2_d42:
    v_mov_b64 v[84:85], v[68:69]
    v_mov_b32 v7, v92
    v_mov_b64 v[86:87], v[72:73]
    s_mov_b64 exec, -1
    s_or_b64 s[80:81], s[80:81], s[50:51]
    ds_read_b64 v[70:71], v95 offset:65408
    ds_read_b64 v[68:69], v94 offset:65408
    s_waitcnt vmcnt(8)
    v_and_b32 v46, 0x20000000, v39
    v_lshrrev_b32 v47, 14, v35
    v_bitop3_b32 v47, v47, v5, v46 bitop3:0xea
    ds_read_b64 v[102:103], v47
    v_bitop3_b32 v93, v35, v5, v46 bitop3:0xea
    v_and_b32 v46, 0x10000000, v39
    v_lshrrev_b32 v47, 14, v34
    v_bitop3_b32 v47, v47, v5, v46 bitop3:0xea
    ds_read_b64 v[100:101], v47
    v_bitop3_b32 v92, v34, v5, v46 bitop3:0xea
    v_and_b32 v46, 0x80000000, v39
    v_lshrrev_b32 v47, 14, v37
    v_bitop3_b32 v47, v47, v5, v46 bitop3:0xea
    ds_read_b64 v[106:107], v47
    v_and_b32 v46, 0x40000000, v39
    v_lshrrev_b32 v47, 14, v36
    v_bitop3_b32 v47, v47, v5, v46 bitop3:0xea
    ds_read_b64 v[104:105], v47
    s_waitcnt lgkmcnt(4)
    v_mfma_f32_4x4x4_16b_bf16 v[80:83], v[10:11], v[70:71], v[80:83]
    v_mfma_f32_4x4x4_16b_bf16 v[76:79], v[10:11], v[68:69], v[76:79]
    v_perm_b32 v15, v35, v38, s45
    v_bitop3_b32 v46, v35, 0.5, -0.5 bitop3:0xa8
    v_perm_b32 v14, v34, v38, s44
    v_bitop3_b32 v47, v34, 0.5, -0.5 bitop3:0xa8
    v_cvt_pk_bf16_f32 v80, v80, v81
    v_cvt_pk_bf16_f32 v81, v82, v83
    ds_wrxchg_rtn_b64 v[74:75], v95, v[80:81] offset:65408
    v_cvt_pk_bf16_f32 v76, v76, v77
    v_cvt_pk_bf16_f32 v77, v78, v79
    ds_wrxchg_rtn_b64 v[72:73], v94, v[76:77] offset:65408
    s_waitcnt lgkmcnt(2)
    s_barrier
    s_setprio 3
    s_mov_b32 m0, s100
    s_nop 0
    ds_write_addtid_b32 v116 offset:32768
    ds_write_addtid_b32 v117 offset:33024
    ds_write_addtid_b32 v118 offset:33280
    ds_write_addtid_b32 v119 offset:33536
    buffer_load_dwordx4 v[116:119], v3, s[16:19], s40 offen offset:2048
    ds_write_addtid_b32 v120 offset:33792
    ds_write_addtid_b32 v121 offset:34048
    ds_write_addtid_b32 v122 offset:34304
    ds_write_addtid_b32 v123 offset:34560
    buffer_load_dwordx4 v[120:123], v3, s[16:19], s40 offen offset:3072
    v_mfma_f32_4x4x4_16b_bf16 v[80:83], v[8:9], v[102:103], 0
    v_mfma_f32_4x4x4_16b_bf16 v[76:79], v[8:9], v[100:101], 0
    v_bitop3_b32 v15, v6, v15, v46 bitop3:0xca
    v_bitop3_b32 v14, v6, v14, v47 bitop3:0xca
    v_cmp_lt_u32 s[84:85], v5, v92
    s_nop 0
    v_pk_mul_f32 v[80:81], v[80:81], v[14:15] op_sel:[0,1] op_sel_hi:[1,1]
    v_pk_mul_f32 v[82:83], v[82:83], v[14:15] op_sel:[0,1] op_sel_hi:[1,1]
    v_pk_mul_f32 v[76:77], v[76:77], v[14:15] op_sel:[0,0] op_sel_hi:[1,0]
    v_pk_mul_f32 v[78:79], v[78:79], v[14:15] op_sel:[0,0] op_sel_hi:[1,0]
    v_mov_b32 v44, v43
    s_cmp_gt_u32 s37, 1024
    s_cbranch_scc1 L2_xs43
    s_cmp_lg_u32 s101, 0
    s_cbranch_scc1 L2_xa43
L2_xb43:
    v_lshlrev_b32 v89, 16, v96
    v_add_u32 v90, 60, v97
    v_bitop3_b32 v90, v89, v45, v90 bitop3:0x6a
    ds_write_b32 v98, v90 offset:12
    v_lshlrev_b32 v89, 20, v96
    v_add_u32 v90, 40, v97
    v_bitop3_b32 v90, v89, v45, v90 bitop3:0x6a
    ds_write_b32 v98, v90 offset:8
    v_lshlrev_b32 v89, 24, v96
    v_add_u32 v90, 20, v97
    v_bitop3_b32 v90, v89, v45, v90 bitop3:0x6a
    ds_write_b32 v98, v90 offset:4
    v_lshlrev_b32 v89, 28, v96
    v_bitop3_b32 v90, v89, v45, v97 bitop3:0x6a
    ds_write_b32 v98, v90 offset:0
    v_mov_b32_dpp v91, v66 quad_perm:[1,1,1,1] row_mask:0xf bank_mask:0xf
    v_and_b32 v89, 3, v91
    v_and_b32 v97, 0xfffc, v91
    v_sub_u16_dpp v88, v66, v91 quad_perm:[3,3,3,3] row_mask:0xf bank_mask:0xf
    v_mad_u32_u24 v97, v97, 5, v4
    v_add_u32 v99, v88, v89
    v_bfm_b32 v96, v88, v89
    v_cmp_lt_u32 s[58:59], 16, v99
    v_lshlrev_b32 v89, v1, v96
    v_and_b32 v89, v45, v89
    v_cmp_ne_u32 vcc, 0, v89
    v_xor_b32 v90, v97, v89
    s_add_u32 s3, s37, s38
    v_mbcnt_lo_u32_b32 v98, vcc_lo, 0
    v_mbcnt_hi_u32_b32 v98, vcc_hi, v98
    s_bcnt1_i32_b64 s41, vcc
    v_lshl_add_u32 v98, v98, 2, s3
    s_mov_b64 exec, vcc
    ds_write_b32 v98, v90
    s_mov_b64 exec, -1
    s_lshl2_add_u32 s37, s41, s37
    s_cmp_lg_u64 s[58:59], 0
    s_cbranch_scc1 L2_xe43
L2_xr43:
    v_add_u32 v98, s37, v0
    v_mov_b32 v90, -1
    ds_write_b32 v98, v90
    ds_read2st64_b32 v[40:41], v0 offset0:0 offset1:1
    ds_read2st64_b32 v[42:43], v0 offset0:2 offset1:3
    s_sub_u32 s3, s37, 768
    s_cmp_gt_u32 s3, 256
    s_cbranch_scc1 L2_xf43
L2_xg43:
    v_lshrrev_b64 v[64:65], 16, v[64:65]
    v_lshrrev_b64 v[66:67], 16, v[66:67]
    s_setprio 2
    ds_write_addtid_b32 v124 offset:34816
    ds_write_addtid_b32 v125 offset:35072
    ds_write_addtid_b32 v126 offset:35328
    ds_write_addtid_b32 v127 offset:35584
    s_add_u32 s3, s40, 4096
    buffer_load_dwordx4 v[124:127], v3, s[16:19], s3 offen
    s_waitcnt lgkmcnt(14)
    v_cmp_ne_u64 s[50:51], v[72:73], v[68:69]
    v_cmpx_ne_u64 s[54:55], v[74:75], v[70:71]
    s_and_b64 s[82:83], s[54:55], s[80:81]
    s_cbranch_scc1 L2_c44
L2_d44:
    v_mov_b64 v[84:85], v[70:71]
    v_mov_b32 v7, v95
    v_mov_b64 v[86:87], v[74:75]
    s_or_b64 s[80:81], s[80:81], s[54:55]
    s_mov_b64 exec, s[50:51]
    s_and_b64 s[82:83], s[50:51], s[80:81]
    s_cbranch_scc1 L2_c45
L2_d45:
    v_mov_b64 v[84:85], v[68:69]
    v_mov_b32 v7, v94
    v_mov_b64 v[86:87], v[72:73]
    s_mov_b64 exec, -1
    s_or_b64 s[80:81], s[80:81], s[50:51]
    ds_read_b64 v[70:71], v93 offset:65408
    s_and_b64 exec, s[84:85], s[80:81]
    v_mfma_f32_4x4x4_16b_bf16 v[76:79], v[12:13], v[84:85], 0
    v_mov_b32 v92, v7
    s_andn2_b64 s[80:81], s[80:81], s[84:85]
    v_mfma_f32_4x4x4_16b_bf16 v[76:79], v[10:11], v[86:87], v[76:79]
    s_mov_b64 exec, -1
    ds_read_b64 v[68:69], v92 offset:65408
    s_setprio 1
    s_waitcnt vmcnt(10)
    s_mov_b32 m0, s38
    s_nop 0
    ds_write_addtid_b32 v108 offset:0
    ds_write_addtid_b32 v109 offset:256
    ds_write_addtid_b32 v110 offset:512
    ds_write_addtid_b32 v111 offset:768
    s_waitcnt lgkmcnt(4)
    v_mfma_f32_4x4x4_16b_bf16 v[80:83], v[10:11], v[70:71], v[80:83]
    v_mfma_f32_4x4x4_16b_bf16 v[76:79], v[10:11], v[68:69], v[76:79]
    v_and_b32 v46, 0x40000000, v39
    v_bitop3_b32 v94, v36, v5, v46 bitop3:0xea
    v_and_b32 v46, 0x80000000, v39
    v_bitop3_b32 v95, v37, v5, v46 bitop3:0xea
    v_perm_b32 v15, v37, v38, s47
    v_bitop3_b32 v46, v37, 0.5, -0.5 bitop3:0xa8
    v_perm_b32 v14, v36, v38, s46
    v_bitop3_b32 v47, v36, 0.5, -0.5 bitop3:0xa8
    v_cvt_pk_bf16_f32 v80, v80, v81
    v_cvt_pk_bf16_f32 v81, v82, v83
    ds_wrxchg_rtn_b64 v[74:75], v93, v[80:81] offset:65408
    v_cvt_pk_bf16_f32 v76, v76, v77
    v_cvt_pk_bf16_f32 v77, v78, v79
    ds_wrxchg_rtn_b64 v[72:73], v92, v[76:77] offset:65408
    v_and_b32 v88, 0x0fffffff, v44
    v_mov_b32 v39, v44
    buffer_load_dwordx2 v[34:35], v88, s[8:11], 0 offen
    buffer_load_dwordx3 v[36:38], v88, s[8:11], 0 offen offset:8
    s_setprio 0
    s_waitcnt vmcnt(11)
    ds_write_addtid_b32 v112 offset:1024
    ds_write_addtid_b32 v113 offset:1280
    ds_write_addtid_b32 v114 offset:1536
    ds_write_addtid_b32 v115 offset:1792
    v_mfma_f32_4x4x4_16b_bf16 v[80:83], v[8:9], v[106:107], 0
    v_mfma_f32_4x4x4_16b_bf16 v[76:79], v[8:9], v[104:105], 0
    v_bitop3_b32 v15, v6, v15, v46 bitop3:0xca
    v_bitop3_b32 v14, v6, v14, v47 bitop3:0xca
    s_nop 1
    v_pk_mul_f32 v[80:81], v[80:81], v[14:15] op_sel:[0,1] op_sel_hi:[1,1]
    v_pk_mul_f32 v[82:83], v[82:83], v[14:15] op_sel:[0,1] op_sel_hi:[1,1]
    v_pk_mul_f32 v[76:77], v[76:77], v[14:15] op_sel:[0,0] op_sel_hi:[1,0]
    v_pk_mul_f32 v[78:79], v[78:79], v[14:15] op_sel:[0,0] op_sel_hi:[1,0]
    s_add_u32 s42, s42, 1
    s_waitcnt lgkmcnt(0)
L2_loop:
    s_barrier
    s_bitcmp1_b32 s36, s42
    s_cbranch_scc1 L2_slow
L2_ret2:
    s_setprio 3
    buffer_load_dwordx4 v[108:111], v3, s[16:19], s40 offen offset:0
    v_cmp_ne_u64 s[50:51], v[72:73], v[68:69]
    v_cmpx_ne_u64 s[54:55], v[74:75], v[70:71]
    s_and_b64 s[82:83], s[54:55], s[80:81]
    s_cbranch_scc1 L2_c46
L2_d46:
    v_mov_b64 v[84:85], v[70:71]
    v_mov_b32 v7, v93
    v_mov_b64 v[86:87], v[74:75]
    s_or_b64 s[80:81], s[80:81], s[54:55]
    s_mov_b64 exec, s[50:51]
    s_and_b64 s[82:83], s[50:51], s[80:81]
    s_cbranch_scc1 L2_c47
L2_d47:
    v_mov_b64 v[84:85], v[68:69]
    v_mov_b32 v7, v92
    v_mov_b64 v[86:87], v[72:73]
    s_mov_b64 exec, -1
    s_or_b64 s[80:81], s[80:81], s[50:51]
    ds_read_b64 v[70:71], v95 offset:65408
    ds_read_b64 v[68:69], v94 offset:65408
    s_waitcnt vmcnt(10)
    v_and_b32 v46, 0x20000000, v21
    v_lshrrev_b32 v47, 14, v17
    v_bitop3_b32 v47, v47, v5, v46 bitop3:0xea
    ds_read_b64 v[102:103], v47
    v_bitop3_b32 v93, v17, v5, v46 bitop3:0xea
    v_and_b32 v46, 0x10000000, v21
    v_lshrrev_b32 v47, 14, v16
    v_bitop3_b32 v47, v47, v5, v46 bitop3:0xea
    ds_read_b64 v[100:101], v47
    v_bitop3_b32 v92, v16, v5, v46 bitop3:0xea
    s_waitcnt lgkmcnt(2)
    v_mfma_f32_4x4x4_16b_bf16 v[80:83], v[10:11], v[70:71], v[80:83]
    v_mfma_f32_4x4x4_16b_bf16 v[76:79], v[10:11], v[68:69], v[76:79]
    v_perm_b32 v15, v17, v20, s45
    v_bitop3_b32 v46, v17, 0.5, -0.5 bitop3:0xa8
    v_perm_b32 v14, v16, v20, s44
    v_bitop3_b32 v47, v16, 0.5, -0.5 bitop3:0xa8
    v_cvt_pk_bf16_f32 v80, v80, v81
    v_cvt_pk_bf16_f32 v81, v82, v83
    ds_wrxchg_rtn_b64 v[74:75], v95, v[80:81] offset:65408
    v_cvt_pk_bf16_f32 v76, v76, v77
    v_cvt_pk_bf16_f32 v77, v78, v79
    ds_wrxchg_rtn_b64 v[72:73], v94, v[76:77] offset:65408
    s_waitcnt lgkmcnt(2)
    v_mfma_f32_4x4x4_16b_bf16 v[80:83], v[8:9], v[102:103], 0
    v_mfma_f32_4x4x4_16b_bf16 v[76:79], v[8:9], v[100:101], 0
    v_bitop3_b32 v15, v6, v15, v46 bitop3:0xca
    v_bitop3_b32 v14, v6, v14, v47 bitop3:0xca
    v_cmp_lt_u32 s[84:85], v5, v92
    s_nop 0
    v_pk_mul_f32 v[80:81], v[80:81], v[14:15] op_sel:[0,1] op_sel_hi:[1,1]
    v_pk_mul_f32 v[82:83], v[82:83], v[14:15] op_sel:[0,1] op_sel_hi:[1,1]
    v_pk_mul_f32 v[76:77], v[76:77], v[14:15] op_sel:[0,0] op_sel_hi:[1,0]
    v_pk_mul_f32 v[78:79], v[78:79], v[14:15] op_sel:[0,0] op_sel_hi:[1,0]
    buffer_load_dwordx4 v[112:115], v3, s[16:19], s40 offen offset:1024
    s_waitcnt lgkmcnt(0)
    v_cmp_ne_u64 s[50:51], v[72:73], v[68:69]
    v_cmpx_ne_u64 s[54:55], v[74:75], v[70:71]
    s_and_b64 s[82:83], s[54:55], s[80:81]
    s_cbranch_scc1 L2_c48
L2_d48:
    v_mov_b64 v[84:85], v[70:71]
    v_mov_b32 v7, v95
    v_mov_b64 v[86:87], v[74:75]
    s_or_b64 s[80:81], s[80:81], s[54:55]
    s_mov_b64 exec, s[50:51]
    s_and_b64 s[82:83], s[50:51], s[80:81]
    s_cbranch_scc1 L2_c49
L2_d49:
    v_mov_b64 v[84:85], v[68:69]
    v_mov_b32 v7, v94
    v_mov_b64 v[86:87], v[72:73]
    s_mov_b64 exec, -1
    s_or_b64 s[80:81], s[80:81], s[50:51]
    ds_read_b64 v[70:71], v93 offset:65408
    s_and_b64 exec, s[84:85], s[80:81]
    v_mfma_f32_4x4x4_16b_bf16 v[76:79], v[12:13], v[84:85], 0
    v_mov_b32 v92, v7
    s_andn2_b64 s[80:81], s[80:81], s[84:85]
    v_mfma_f32_4x4x4_16b_bf16 v[76:79], v[10:11], v[86:87], v[76:79]
    s_mov_b64 exec, -1
    ds_read_b64 v[68:69], v92 offset:65408
    v_and_b32 v46, 0x80000000, v21
    v_lshrrev_b32 v47, 14, v19
    v_bitop3_b32 v47, v47, v5, v46 bitop3:0xea
    ds_read_b64 v[106:107], v47
    v_bitop3_b32 v95, v19, v5, v46 bitop3:0xea
    v_and_b32 v46, 0x40000000, v21
    v_lshrrev_b32 v47, 14, v18
    v_bitop3_b32 v47, v47, v5, v46 bitop3:0xea
    ds_read_b64 v[104:105], v47
    v_bitop3_b32 v94, v18, v5, v46 bitop3:0xea
    s_waitcnt lgkmcnt(2)
    v_mfma_f32_4x4x4_16b_bf16 v[80:83], v[10:11], v[70:71], v[80:83]
    v_mfma_f32_4x4x4_16b_bf16 v[76:79], v[10:11], v[68:69], v[76:79]
    v_perm_b32 v15, v19, v20, s47
    v_bitop3_b32 v46, v19, 0.5, -0.5 bitop3:0xa8
    v_perm_b32 v14, v18, v20, s46
    v_bitop3_b32 v47, v18, 0.5, -0.5 bitop3:0xa8
    v_cvt_pk_bf16_f32 v80, v80, v81
    v_cvt_pk_bf16_f32 v81, v82, v83
    ds_wrxchg_rtn_b64 v[74:75], v93, v[80:81] offset:65408
    v_cvt_pk_bf16_f32 v76, v76, v77
    v_cvt_pk_bf16_f32 v77, v78, v79
    ds_wrxchg_rtn_b64 v[72:73], v92, v[76:77] offset:65408
    v_and_b32 v88, 0x0fffffff, v40
    v_mov_b32 v21, v40
    buffer_load_dwordx2 v[16:17], v88, s[8:11], 0 offen
    buffer_load_dwordx3 v[18:20], v88, s[8:11], 0 offen offset:8
    s_setprio 2
    s_waitcnt lgkmcnt(2)
    v_mfma_f32_4x4x4_16b_bf16 v[80:83], v[8:9], v[106:107], 0
    v_mfma_f32_4x4x4_16b_bf16 v[76:79], v[8:9], v[104:105], 0
    v_bitop3_b32 v15, v6, v15, v46 bitop3:0xca
    v_bitop3_b32 v14, v6, v14, v47 bitop3:0xca
    s_nop 1
    v_pk_mul_f32 v[80:81], v[80:81], v[14:15] op_sel:[0,1] op_sel_hi:[1,1]
    v_pk_mul_f32 v[82:83], v[82:83], v[14:15] op_sel:[0,1] op_sel_hi:[1,1]
    v_pk_mul_f32 v[76:77], v[76:77], v[14:15] op_sel:[0,0] op_sel_hi:[1,0]
    v_pk_mul_f32 v[78:79], v[78:79], v[14:15] op_sel:[0,0] op_sel_hi:[1,0]
    v_sub_u16 v88, v56, v48
    v_and_b32 v89, 3, v48
    v_add3_u32 v99, v88, v89, 3
    v_and_b32 v99, -4, v99
    v_max_u32 v99, 4, v99
    v_and_b32 v97, 0xfffc, v48
    v_bfm_b32 v96, v88, v89
    v_add_u32_dpp v91, v99, v99 row_shr:1 row_mask:0xf bank_mask:0xf bound_ctrl:1
    v_mad_u32_u24 v97, v97, 5, v2
    v_cmp_lt_u32 vcc, 16, v99
    v_add_u32_dpp v91, v91, v91 row_shr:2 row_mask:0xf bank_mask:0xf bound_ctrl:1
    v_sub_u32 v98, s38, v99
    v_lshrrev_b64 v[48:49], 16, v[48:49]
    v_add_u32_dpp v91, v91, v91 row_shr:4 row_mask:0xf bank_mask:0xf bound_ctrl:1
    v_lshrrev_b64 v[56:57], 16, v[56:57]
    s_mov_b32 s101, 0
    v_add_u32_dpp v91, v91, v91 row_shr:8 row_mask:0xf bank_mask:0xf bound_ctrl:1
    s_nop 1
    v_add_u32_dpp v91, v91, v91 row_bcast:15 row_mask:0xa bank_mask:0xf
    s_nop 1
    v_add_u32_dpp v91, v91, v91 row_bcast:31 row_mask:0xc bank_mask:0xf
    v_add_u32 v98, v98, v91
    v_readlane_b32 s37, v91, 63
    s_cbranch_vccnz L2_xo50
L2_xp50:
    s_waitcnt lgkmcnt(0)
    v_cmp_ne_u64 s[50:51], v[72:73], v[68:69]
    v_cmpx_ne_u64 s[54:55], v[74:75], v[70:71]
    s_and_b64 s[82:83], s[54:55], s[80:81]
    s_cbranch_scc1 L2_c51
L2_d51:
    v_mov_b64 v[84:85], v[70:71]
    v_mov_b32 v7, v93
    v_mov_b64 v[86:87], v[74:75]
    s_or_b64 s[80:81], s[80:81], s[54:55]
    s_mov_b64 exec, s[50:51]
    s_and_b64 s[82:83], s[50:51], s[80:81]
    s_cbranch_scc1 L2_c52
L2_d52:
    v_mov_b64 v[84:85], v[68:69]
    v_mov_b32 v7, v92
    v_mov_b64 v[86:87], v[72:73]
    s_mov_b64 exec, -1
    s_or_b64 s[80:81], s[80:81], s[50:51]
    ds_read_b64 v[70:71], v95 offset:65408
    ds_read_b64 v[68:69], v94 offset:65408
    s_waitcnt vmcnt(11)
    v_and_b32 v46, 0x20000000, v27
    v_lshrrev_b32 v47, 14, v23
    v_bitop3_b32 v47, v47, v5, v46 bitop3:0xea
    ds_read_b64 v[102:103], v47
    v_bitop3_b32 v93, v23, v5, v46 bitop3:0xea
    v_and_b32 v46, 0x10000000, v27
    v_lshrrev_b32 v47, 14, v22
    v_bitop3_b32 v47, v47, v5, v46 bitop3:0xea
    ds_read_b64 v[100:101], v47
    v_bitop3_b32 v92, v22, v5, v46 bitop3:0xea
    s_waitcnt lgkmcnt(2)
    v_mfma_f32_4x4x4_16b_bf16 v[80:83], v[10:11], v[70:71], v[80:83]
    v_mfma_f32_4x4x4_16b_bf16 v[76:79], v[10:11], v[68:69], v[76:79]
    v_perm_b32 v15, v23, v26, s45
    v_bitop3_b32 v46, v23, 0.5, -0.5 bitop3:0xa8
    v_perm_b32 v14, v22, v26, s44
    v_bitop3_b32 v47, v22, 0.5, -0.5 bitop3:0xa8
    v_cvt_pk_bf16_f32 v80, v80, v81
    v_cvt_pk_bf16_f32 v81, v82, v83
    ds_wrxchg_rtn_b64 v[74:75], v95, v[80:81] offset:65408
    v_cvt_pk_bf16_f32 v76, v76, v77
    v_cvt_pk_bf16_f32 v77, v78, v79
    ds_wrxchg_rtn_b64 v[72:73], v94, v[76:77] offset:65408
    s_waitcnt lgkmcnt(2)
    v_mfma_f32_4x4x4_16b_bf16 v[80:83], v[8:9], v[102:103], 0
    v_mfma_f32_4x4x4_16b_bf16 v[76:79], v[8:9], v[100:101], 0
    v_bitop3_b32 v15, v6, v15, v46 bitop3:0xca
    v_bitop3_b32 v14, v6, v14, v47 bitop3:0xca
    v_cmp_lt_u32 s[84:85], v5, v92
    s_nop 0
    v_pk_mul_f32 v[80:81], v[80:81], v[14:15] op_sel:[0,1] op_sel_hi:[1,1]
    v_pk_mul_f32 v[82:83], v[82:83], v[14:15] op_sel:[0,1] op_sel_hi:[1,1]
    v_pk_mul_f32 v[76:77], v[76:77], v[14:15] op_sel:[0,0] op_sel_hi:[1,0]
    v_pk_mul_f32 v[78:79], v[78:79], v[14:15] op_sel:[0,0] op_sel_hi:[1,0]
    s_waitcnt lgkmcnt(0)
    v_cmp_ne_u64 s[50:51], v[72:73], v[68:69]
    v_cmpx_ne_u64 s[54:55], v[74:75], v[70:71]
    s_and_b64 s[82:83], s[54:55], s[80:81]
    s_cbranch_scc1 L2_c53
L2_d53:
    v_mov_b64 v[84:85], v[70:71]
    v_mov_b32 v7, v95
    v_mov_b64 v[86:87], v[74:75]
    s_or_b64 s[80:81], s[80:81], s[54:55]
    s_mov_b64 exec, s[50:51]
    s_and_b64 s[82:83], s[50:51], s[80:81]
    s_cbranch_scc1 L2_c54
L2_d54:
    v_mov_b64 v[84:85], v[68:69]
    v_mov_b32 v7, v94
    v_mov_b64 v[86:87], v[72:73]
    s_mov_b64 exec, -1
    s_or_b64 s[80:81], s[80:81], s[50:51]
    ds_read_b64 v[70:71], v93 offset:65408
    s_and_b64 exec, s[84:85], s[80:81]
    v_mfma_f32_4x4x4_16b_bf16 v[76:79], v[12:13], v[84:85], 0
    v_mov_b32 v92, v7
    s_andn2_b64 s[80:81], s[80:81], s[84:85]
    v_mfma_f32_4x4x4_16b_bf16 v[76:79], v[10:11], v[86:87], v[76:79]
    s_mov_b64 exec, -1
    ds_read_b64 v[68:69], v92 offset:65408
    v_and_b32 v46, 0x80000000, v27
    v_lshrrev_b32 v47, 14, v25
    v_bitop3_b32 v47, v47, v5, v46 bitop3:0xea
    ds_read_b64 v[106:107], v47
    v_bitop3_b32 v95, v25, v5, v46 bitop3:0xea
    v_and_b32 v46, 0x40000000, v27
    v_lshrrev_b32 v47, 14, v24
    v_bitop3_b32 v47, v47, v5, v46 bitop3:0xea
    ds_read_b64 v[104:105], v47
    v_bitop3_b32 v94, v24, v5, v46 bitop3:0xea
    s_waitcnt lgkmcnt(2)
    v_mfma_f32_4x4x4_16b_bf16 v[80:83], v[10:11], v[70:71], v[80:83]
    v_mfma_f32_4x4x4_16b_bf16 v[76:79], v[10:11], v[68:69], v[76:79]
    v_perm_b32 v15, v25, v26, s47
    v_bitop3_b32 v46, v25, 0.5, -0.5 bitop3:0xa8
    v_perm_b32 v14, v24, v26, s46
    v_bitop3_b32 v47, v24, 0.5, -0.5 bitop3:0xa8
    v_cvt_pk_bf16_f32 v80, v80, v81
    v_cvt_pk_bf16_f32 v81, v82, v83
    ds_wrxchg_rtn_b64 v[74:75], v93, v[80:81] offset:65408
    v_cvt_pk_bf16_f32 v76, v76, v77
    v_cvt_pk_bf16_f32 v77, v78, v79
    ds_wrxchg_rtn_b64 v[72:73], v92, v[76:77] offset:65408
    v_and_b32 v88, 0x0fffffff, v41
    v_mov_b32 v27, v41
    buffer_load_dwordx2 v[22:23], v88, s[8:11], 0 offen
    buffer_load_dwordx3 v[24:26], v88, s[8:11], 0 offen offset:8
    s_setprio 1
    s_waitcnt lgkmcnt(2)
    v_mfma_f32_4x4x4_16b_bf16 v[80:83], v[8:9], v[106:107], 0
    v_mfma_f32_4x4x4_16b_bf16 v[76:79], v[8:9], v[104:105], 0
    v_bitop3_b32 v15, v6, v15, v46 bitop3:0xca
    v_bitop3_b32 v14, v6, v14, v47 bitop3:0xca
    s_nop 1
    v_pk_mul_f32 v[80:81], v[80:81], v[14:15] op_sel:[0,1] op_sel_hi:[1,1]
    v_pk_mul_f32 v[82:83], v[82:83], v[14:15] op_sel:[0,1] op_sel_hi:[1,1]
    v_pk_mul_f32 v[76:77], v[76:77], v[14:15] op_sel:[0,0] op_sel_hi:[1,0]
    v_pk_mul_f32 v[78:79], v[78:79], v[14:15] op_sel:[0,0] op_sel_hi:[1,0]
    s_waitcnt lgkmcnt(0)
    v_cmp_ne_u64 s[50:51], v[72:73], v[68:69]
    v_cmpx_ne_u64 s[54:55], v[74:75], v[70:71]
    s_and_b64 s[82:83], s[54:55], s[80:81]
    s_cbranch_scc1 L2_c55
L2_d55:
    v_mov_b64 v[84:85], v[70:71]
    v_mov_b32 v7, v93
    v_mov_b64 v[86:87], v[74:75]
    s_or_b64 s[80:81], s[80:81], s[54:55]
    s_mov_b64 exec, s[50:51]
    s_and_b64 s[82:83], s[50:51], s[80:81]
    s_cbranch_scc1 L2_c56
L2_d56:
    v_mov_b64 v[84:85], v[68:69]
    v_mov_b32 v7, v92
    v_mov_b64 v[86:87], v[72:73]
    s_mov_b64 exec, -1
    s_or_b64 s[80:81], s[80:81], s[50:51]
    ds_read_b64 v[70:71], v95 offset:65408
    ds_read_b64 v[68:69], v94 offset:65408
    s_waitcnt vmcnt(11)
    v_and_b32 v46, 0x20000000, v33
    v_lshrrev_b32 v47, 14, v29
    v_bitop3_b32 v47, v47, v5, v46 bitop3:0xea
    ds_read_b64 v[102:103], v47
    v_bitop3_b32 v93, v29, v5, v46 bitop3:0xea
    v_and_b32 v46, 0x10000000, v33
    v_lshrrev_b32 v47, 14, v28
    v_bitop3_b32 v47, v47, v5, v46 bitop3:0xea
    ds_read_b64 v[100:101], v47
    v_bitop3_b32 v92, v28, v5, v46 bitop3:0xea
    s_waitcnt lgkmcnt(2)
    v_mfma_f32_4x4x4_16b_bf16 v[80:83], v[10:11], v[70:71], v[80:83]
    v_mfma_f32_4x4x4_16b_bf16 v[76:79], v[10:11], v[68:69], v[76:79]
    v_perm_b32 v15, v29, v32, s45
    v_bitop3_b32 v46, v29, 0.5, -0.5 bitop3:0xa8
    v_perm_b32 v14, v28, v32, s44
    v_bitop3_b32 v47, v28, 0.5, -0.5 bitop3:0xa8
    v_cvt_pk_bf16_f32 v80, v80, v81
    v_cvt_pk_bf16_f32 v81, v82, v83
    ds_wrxchg_rtn_b64 v[74:75], v95, v[80:81] offset:65408
    v_cvt_pk_bf16_f32 v76, v76, v77
    v_cvt_pk_bf16_f32 v77, v78, v79
    ds_wrxchg_rtn_b64 v[72:73], v94, v[76:77] offset:65408
    s_waitcnt lgkmcnt(2)
    v_mfma_f32_4x4x4_16b_bf16 v[80:83], v[8:9], v[102:103], 0
    v_mfma_f32_4x4x4_16b_bf16 v[76:79], v[8:9], v[100:101], 0
    v_bitop3_b32 v15, v6, v15, v46 bitop3:0xca
    v_bitop3_b32 v14, v6, v14, v47 bitop3:0xca
    v_cmp_lt_u32 s[84:85], v5, v92
    s_nop 0
    v_pk_mul_f32 v[80:81], v[80:81], v[14:15] op_sel:[0,1] op_sel_hi:[1,1]
    v_pk_mul_f32 v[82:83], v[82:83], v[14:15] op_sel:[0,1] op_sel_hi:[1,1]
    v_pk_mul_f32 v[76:77], v[76:77], v[14:15] op_sel:[0,0] op_sel_hi:[1,0]
    v_pk_mul_f32 v[78:79], v[78:79], v[14:15] op_sel:[0,0] op_sel_hi:[1,0]
    s_waitcnt lgkmcnt(0)
    v_cmp_ne_u64 s[50:51], v[72:73], v[68:69]
    v_cmpx_ne_u64 s[54:55], v[74:75], v[70:71]
    s_and_b64 s[82:83], s[54:55], s[80:81]
    s_cbranch_scc1 L2_c57
L2_d57:
    v_mov_b64 v[84:85], v[70:71]
    v_mov_b32 v7, v95
    v_mov_b64 v[86:87], v[74:75]
    s_or_b64 s[80:81], s[80:81], s[54:55]
    s_mov_b64 exec, s[50:51]
    s_and_b64 s[82:83], s[50:51], s[80:81]
    s_cbranch_scc1 L2_c58
L2_d58:
    v_mov_b64 v[84:85], v[68:69]
    v_mov_b32 v7, v94
    v_mov_b64 v[86:87], v[72:73]
    s_mov_b64 exec, -1
    s_or_b64 s[80:81], s[80:81], s[50:51]
    ds_read_b64 v[70:71], v93 offset:65408
    s_and_b64 exec, s[84:85], s[80:81]
    v_mfma_f32_4x4x4_16b_bf16 v[76:79], v[12:13], v[84:85], 0
    v_mov_b32 v92, v7
    s_andn2_b64 s[80:81], s[80:81], s[84:85]
    v_mfma_f32_4x4x4_16b_bf16 v[76:79], v[10:11], v[86:87], v[76:79]
    s_mov_b64 exec, -1
    ds_read_b64 v[68:69], v92 offset:65408
    v_and_b32 v46, 0x80000000, v33
    v_lshrrev_b32 v47, 14, v31
    v_bitop3_b32 v47, v47, v5, v46 bitop3:0xea
    ds_read_b64 v[106:107], v47
    v_bitop3_b32 v95, v31, v5, v46 bitop3:0xea
    v_and_b32 v46, 0x40000000, v33
    v_lshrrev_b32 v47, 14, v30
    v_bitop3_b32 v47, v47, v5, v46 bitop3:0xea
    ds_read_b64 v[104:105], v47
    v_bitop3_b32 v94, v30, v5, v46 bitop3:0xea
    s_waitcnt lgkmcnt(2)
    v_mfma_f32_4x4x4_16b_bf16 v[80:83], v[10:11], v[70:71], v[80:83]
    v_mfma_f32_4x4x4_16b_bf16 v[76:79], v[10:11], v[68:69], v[76:79]
    v_perm_b32 v15, v31, v32, s47
    v_bitop3_b32 v46, v31, 0.5, -0.5 bitop3:0xa8
    v_perm_b32 v14, v30, v32, s46
    v_bitop3_b32 v47, v30, 0.5, -0.5 bitop3:0xa8
    v_cvt_pk_bf16_f32 v80, v80, v81
    v_cvt_pk_bf16_f32 v81, v82, v83
    ds_wrxchg_rtn_b64 v[74:75], v93, v[80:81] offset:65408
    v_cvt_pk_bf16_f32 v76, v76, v77
    v_cvt_pk_bf16_f32 v77, v78, v79
    ds_wrxchg_rtn_b64 v[72:73], v92, v[76:77] offset:65408
    v_and_b32 v88, 0x0fffffff, v42
    v_mov_b32 v33, v42
    buffer_load_dwordx2 v[28:29], v88, s[8:11], 0 offen
    buffer_load_dwordx3 v[30:32], v88, s[8:11], 0 offen offset:8
    s_setprio 0
    s_waitcnt lgkmcnt(2)
    v_mfma_f32_4x4x4_16b_bf16 v[80:83], v[8:9], v[106:107], 0
    v_mfma_f32_4x4x4_16b_bf16 v[76:79], v[8:9], v[104:105], 0
    v_bitop3_b32 v15, v6, v15, v46 bitop3:0xca
    v_bitop3_b32 v14, v6, v14, v47 bitop3:0xca
    s_nop 1
    v_pk_mul_f32 v[80:81], v[80:81], v[14:15] op_sel:[0,1] op_sel_hi:[1,1]
    v_pk_mul_f32 v[82:83], v[82:83], v[14:15] op_sel:[0,1] op_sel_hi:[1,1]
    v_pk_mul_f32 v[76:77], v[76:77], v[14:15] op_sel:[0,0] op_sel_hi:[1,0]
    v_pk_mul_f32 v[78:79], v[78:79], v[14:15] op_sel:[0,0] op_sel_hi:[1,0]
    s_add_u32 s40, s40, 0xfff24000
    s_waitcnt lgkmcnt(0)
    v_cmp_ne_u64 s[50:51], v[72:73], v[68:69]
    v_cmpx_ne_u64 s[54:55], v[74:75], v[70:71]
    s_and_b64 s[82:83], s[54:55], s[80:81]
    s_cbranch_scc1 L2_c59
L2_d59:
    v_mov_b64 v[84:85], v[70:71]
    v_mov_b32 v7, v93
    v_mov_b64 v[86:87], v[74:75]
    s_or_b64 s[80:81], s[80:81], s[54:55]
    s_mov_b64 exec, s[50:51]
    s_and_b64 s[82:83], s[50:51], s[80:81]
    s_cbranch_scc1 L2_c60
L2_d60:
    v_mov_b64 v[84:85], v[68:69]
    v_mov_b32 v7, v92
    v_mov_b64 v[86:87], v[72:73]
    s_mov_b64 exec, -1
    s_or_b64 s[80:81], s[80:81], s[50:51]
    ds_read_b64 v[70:71], v95 offset:65408
    ds_read_b64 v[68:69], v94 offset:65408
    s_waitcnt vmcnt(8)
    v_and_b32 v46, 0x20000000, v39
    v_lshrrev_b32 v47, 14, v35
    v_bitop3_b32 v47, v47, v5, v46 bitop3:0xea
    ds_read_b64 v[102:103], v47
    v_bitop3_b32 v93, v35, v5, v46 bitop3:0xea
    v_and_b32 v46, 0x10000000, v39
    v_lshrrev_b32 v47, 14, v34
    v_bitop3_b32 v47, v47, v5, v46 bitop3:0xea
    ds_read_b64 v[100:101], v47
    v_bitop3_b32 v92, v34, v5, v46 bitop3:0xea
    v_and_b32 v46, 0x80000000, v39
    v_lshrrev_b32 v47, 14, v37
    v_bitop3_b32 v47, v47, v5, v46 bitop3:0xea
    ds_read_b64 v[106:107], v47
    v_and_b32 v46, 0x40000000, v39
    v_lshrrev_b32 v47, 14, v36
    v_bitop3_b32 v47, v47, v5, v46 bitop3:0xea
    ds_read_b64 v[104:105], v47
    s_waitcnt lgkmcnt(4)
    v_mfma_f32_4x4x4_16b_bf16 v[80:83], v[10:11], v[70:71], v[80:83]
    v_mfma_f32_4x4x4_16b_bf16 v[76:79], v[10:11], v[68:69], v[76:79]
    v_perm_b32 v15, v35, v38, s45
    v_bitop3_b32 v46, v35, 0.5, -0.5 bitop3:0xa8
    v_perm_b32 v14, v34, v38, s44
    v_bitop3_b32 v47, v34, 0.5, -0.5 bitop3:0xa8
    v_cvt_pk_bf16_f32 v80, v80, v81
    v_cvt_pk_bf16_f32 v81, v82, v83
    ds_wrxchg_rtn_b64 v[74:75], v95, v[80:81] offset:65408
    v_cvt_pk_bf16_f32 v76, v76, v77
    v_cvt_pk_bf16_f32 v77, v78, v79
    ds_wrxchg_rtn_b64 v[72:73], v94, v[76:77] offset:65408
    s_waitcnt lgkmcnt(2)
    s_barrier
    s_setprio 3
    s_mov_b32 m0, s100
    s_nop 0
    ds_write_addtid_b32 v116 offset:32768
    ds_write_addtid_b32 v117 offset:33024
    ds_write_addtid_b32 v118 offset:33280
    ds_write_addtid_b32 v119 offset:33536
    buffer_load_dwordx4 v[116:119], v3, s[16:19], s40 offen offset:2048
    ds_write_addtid_b32 v120 offset:33792
    ds_write_addtid_b32 v121 offset:34048
    ds_write_addtid_b32 v122 offset:34304
    ds_write_addtid_b32 v123 offset:34560
    buffer_load_dwordx4 v[120:123], v3, s[16:19], s40 offen offset:3072
    v_mfma_f32_4x4x4_16b_bf16 v[80:83], v[8:9], v[102:103], 0
    v_mfma_f32_4x4x4_16b_bf16 v[76:79], v[8:9], v[100:101], 0
    v_bitop3_b32 v15, v6, v15, v46 bitop3:0xca
    v_bitop3_b32 v14, v6, v14, v47 bitop3:0xca
    v_cmp_lt_u32 s[84:85], v5, v92
    s_nop 0
    v_pk_mul_f32 v[80:81], v[80:81], v[14:15] op_sel:[0,1] op_sel_hi:[1,1]
    v_pk_mul_f32 v[82:83], v[82:83], v[14:15] op_sel:[0,1] op_sel_hi:[1,1]
    v_pk_mul_f32 v[76:77], v[76:77], v[14:15] op_sel:[0,0] op_sel_hi:[1,0]
    v_pk_mul_f32 v[78:79], v[78:79], v[14:15] op_sel:[0,0] op_sel_hi:[1,0]
    v_mov_b32 v44, v43
    s_cmp_gt_u32 s37, 1024
    s_cbranch_scc1 L2_xs61
    s_cmp_lg_u32 s101, 0
    s_cbranch_scc1 L2_xa61
L2_xb61:
    v_lshlrev_b32 v89, 16, v96
    v_add_u32 v90, 60, v97
    v_bitop3_b32 v90, v89, v45, v90 bitop3:0x6a
    ds_write_b32 v98, v90 offset:12
    v_lshlrev_b32 v89, 20, v96
    v_add_u32 v90, 40, v97
    v_bitop3_b32 v90, v89, v45, v90 bitop3:0x6a
    ds_write_b32 v98, v90 offset:8
    v_lshlrev_b32 v89, 24, v96
    v_add_u32 v90, 20, v97
    v_bitop3_b32 v90, v89, v45, v90 bitop3:0x6a
    ds_write_b32 v98, v90 offset:4
    v_lshlrev_b32 v89, 28, v96
    v_bitop3_b32 v90, v89, v45, v97 bitop3:0x6a
    ds_write_b32 v98, v90 offset:0
    v_mov_b32_dpp v91, v64 quad_perm:[0,0,0,0] row_mask:0xf bank_mask:0xf
    v_and_b32 v89, 3, v91
    v_and_b32 v97, 0xfffc, v91
    v_sub_u16_dpp v88, v64, v91 quad_perm:[2,2,2,2] row_mask:0xf bank_mask:0xf
    v_mad_u32_u24 v97, v97, 5, v4
    v_add_u32 v99, v88, v89
    v_bfm_b32 v96, v88, v89
    v_cmp_lt_u32 s[58:59], 16, v99
    v_lshlrev_b32 v89, v1, v96
    v_and_b32 v89, v45, v89
    v_cmp_ne_u32 vcc, 0, v89
    v_xor_b32 v90, v97, v89
    s_add_u32 s3, s37, s38
    v_mbcnt_lo_u32_b32 v98, vcc_lo, 0
    v_mbcnt_hi_u32_b32 v98, vcc_hi, v98
    s_bcnt1_i32_b64 s41, vcc
    v_lshl_add_u32 v98, v98, 2, s3
    s_mov_b64 exec, vcc
    ds_write_b32 v98, v90
    s_mov_b64 exec, -1
    s_lshl2_add_u32 s37, s41, s37
    s_cmp_lg_u64 s[58:59], 0
    s_cbranch_scc1 L2_xe61
L2_xr61:
    v_add_u32 v98, s37, v0
    v_mov_b32 v90, -1
    ds_write_b32 v98, v90
    ds_read2st64_b32 v[40:41], v0 offset0:0 offset1:1
    ds_read2st64_b32 v[42:43], v0 offset0:2 offset1:3
    s_sub_u32 s3, s37, 768
    s_cmp_gt_u32 s3, 256
    s_cbranch_scc1 L2_xf61
L2_xg61:
    s_setprio 2
    ds_write_addtid_b32 v124 offset:34816
    ds_write_addtid_b32 v125 offset:35072
    ds_write_addtid_b32 v126 offset:35328
    ds_write_addtid_b32 v127 offset:35584
    s_add_u32 s3, s40, 4096
    buffer_load_dwordx4 v[124:127], v3, s[16:19], s3 offen
    s_waitcnt lgkmcnt(14)
    v_cmp_ne_u64 s[50:51], v[72:73], v[68:69]
    v_cmpx_ne_u64 s[54:55], v[74:75], v[70:71]
    s_and_b64 s[82:83], s[54:55], s[80:81]
    s_cbranch_scc1 L2_c62
L2_d62:
    v_mov_b64 v[84:85], v[70:71]
    v_mov_b32 v7, v95
    v_mov_b64 v[86:87], v[74:75]
    s_or_b64 s[80:81], s[80:81], s[54:55]
    s_mov_b64 exec, s[50:51]
    s_and_b64 s[82:83], s[50:51], s[80:81]
    s_cbranch_scc1 L2_c63
L2_d63:
    v_mov_b64 v[84:85], v[68:69]
    v_mov_b32 v7, v94
    v_mov_b64 v[86:87], v[72:73]
    s_mov_b64 exec, -1
    s_or_b64 s[80:81], s[80:81], s[50:51]
    ds_read_b64 v[70:71], v93 offset:65408
    s_and_b64 exec, s[84:85], s[80:81]
    v_mfma_f32_4x4x4_16b_bf16 v[76:79], v[12:13], v[84:85], 0
    v_mov_b32 v92, v7
    s_andn2_b64 s[80:81], s[80:81], s[84:85]
    v_mfma_f32_4x4x4_16b_bf16 v[76:79], v[10:11], v[86:87], v[76:79]
    s_mov_b64 exec, -1
    ds_read_b64 v[68:69], v92 offset:65408
    s_setprio 1
    s_waitcnt vmcnt(10)
    s_mov_b32 m0, s38
    s_nop 0
    ds_write_addtid_b32 v108 offset:0
    ds_write_addtid_b32 v109 offset:256
    ds_write_addtid_b32 v110 offset:512
    ds_write_addtid_b32 v111 offset:768
    s_waitcnt lgkmcnt(4)
    v_mfma_f32_4x4x4_16b_bf16 v[80:83], v[10:11], v[70:71], v[80:83]
    v_mfma_f32_4x4x4_16b_bf16 v[76:79], v[10:11], v[68:69], v[76:79]
    v_and_b32 v46, 0x40000000, v39
    v_bitop3_b32 v94, v36, v5, v46 bitop3:0xea
    v_and_b32 v46, 0x80000000, v39
    v_bitop3_b32 v95, v37, v5, v46 bitop3:0xea
    v_perm_b32 v15, v37, v38, s47
    v_bitop3_b32 v46, v37, 0.5, -0.5 bitop3:0xa8
    v_perm_b32 v14, v36, v38, s46
    v_bitop3_b32 v47, v36, 0.5, -0.5 bitop3:0xa8
    v_cvt_pk_bf16_f32 v80, v80, v81
    v_cvt_pk_bf16_f32 v81, v82, v83
    ds_wrxchg_rtn_b64 v[74:75], v93, v[80:81] offset:65408
    v_cvt_pk_bf16_f32 v76, v76, v77
    v_cvt_pk_bf16_f32 v77, v78, v79
    ds_wrxchg_rtn_b64 v[72:73], v92, v[76:77] offset:65408
    v_and_b32 v88, 0x0fffffff, v44
    v_mov_b32 v39, v44
    buffer_load_dwordx2 v[34:35], v88, s[8:11], 0 offen
    buffer_load_dwordx3 v[36:38], v88, s[8:11], 0 offen offset:8
    s_setprio 0
    s_waitcnt vmcnt(11)
    ds_write_addtid_b32 v112 offset:1024
    ds_write_addtid_b32 v113 offset:1280
    ds_write_addtid_b32 v114 offset:1536
    ds_write_addtid_b32 v115 offset:1792
    v_mfma_f32_4x4x4_16b_bf16 v[80:83], v[8:9], v[106:107], 0
    v_mfma_f32_4x4x4_16b_bf16 v[76:79], v[8:9], v[104:105], 0
    v_bitop3_b32 v15, v6, v15, v46 bitop3:0xca
    v_bitop3_b32 v14, v6, v14, v47 bitop3:0xca
    s_nop 1
    v_pk_mul_f32 v[80:81], v[80:81], v[14:15] op_sel:[0,1] op_sel_hi:[1,1]
    v_pk_mul_f32 v[82:83], v[82:83], v[14:15] op_sel:[0,1] op_sel_hi:[1,1]
    v_pk_mul_f32 v[76:77], v[76:77], v[14:15] op_sel:[0,0] op_sel_hi:[1,0]
    v_pk_mul_f32 v[78:79], v[78:79], v[14:15] op_sel:[0,0] op_sel_hi:[1,0]
    s_add_u32 s42, s42, 1
    s_waitcnt lgkmcnt(0)
    s_barrier
    s_bitcmp1_b32 s36, s42
    s_cbranch_scc1 L2_slow
L2_ret3:
    s_setprio 3
    buffer_load_dwordx4 v[108:111], v3, s[16:19], s40 offen offset:0
    v_cmp_ne_u64 s[50:51], v[72:73], v[68:69]
    v_cmpx_ne_u64 s[54:55], v[74:75], v[70:71]
    s_and_b64 s[82:83], s[54:55], s[80:81]
    s_cbranch_scc1 L2_c64
L2_d64:
    v_mov_b64 v[84:85], v[70:71]
    v_mov_b32 v7, v93
    v_mov_b64 v[86:87], v[74:75]
    s_or_b64 s[80:81], s[80:81], s[54:55]
    s_mov_b64 exec, s[50:51]
    s_and_b64 s[82:83], s[50:51], s[80:81]
    s_cbranch_scc1 L2_c65
L2_d65:
    v_mov_b64 v[84:85], v[68:69]
    v_mov_b32 v7, v92
    v_mov_b64 v[86:87], v[72:73]
    s_mov_b64 exec, -1
    s_or_b64 s[80:81], s[80:81], s[50:51]
    ds_read_b64 v[70:71], v95 offset:65408
    ds_read_b64 v[68:69], v94 offset:65408
    s_waitcnt vmcnt(10)
    v_and_b32 v46, 0x20000000, v21
    v_lshrrev_b32 v47, 14, v17
    v_bitop3_b32 v47, v47, v5, v46 bitop3:0xea
    ds_read_b64 v[102:103], v47
    v_bitop3_b32 v93, v17, v5, v46 bitop3:0xea
    v_and_b32 v46, 0x10000000, v21
    v_lshrrev_b32 v47, 14, v16
    v_bitop3_b32 v47, v47, v5, v46 bitop3:0xea
    ds_read_b64 v[100:101], v47
    v_bitop3_b32 v92, v16, v5, v46 bitop3:0xea
    s_waitcnt lgkmcnt(2)
    v_mfma_f32_4x4x4_16b_bf16 v[80:83], v[10:11], v[70:71], v[80:83]
    v_mfma_f32_4x4x4_16b_bf16 v[76:79], v[10:11], v[68:69], v[76:79]
    v_perm_b32 v15, v17, v20, s45
    v_bitop3_b32 v46, v17, 0.5, -0.5 bitop3:0xa8
    v_perm_b32 v14, v16, v20, s44
    v_bitop3_b32 v47, v16, 0.5, -0.5 bitop3:0xa8
    v_cvt_pk_bf16_f32 v80, v80, v81
    v_cvt_pk_bf16_f32 v81, v82, v83
    ds_wrxchg_rtn_b64 v[74:75], v95, v[80:81] offset:65408
    v_cvt_pk_bf16_f32 v76, v76, v77
    v_cvt_pk_bf16_f32 v77, v78, v79
    ds_wrxchg_rtn_b64 v[72:73], v94, v[76:77] offset:65408
    s_waitcnt lgkmcnt(2)
    v_mfma_f32_4x4x4_16b_bf16 v[80:83], v[8:9], v[102:103], 0
    v_mfma_f32_4x4x4_16b_bf16 v[76:79], v[8:9], v[100:101], 0
    v_bitop3_b32 v15, v6, v15, v46 bitop3:0xca
    v_bitop3_b32 v14, v6, v14, v47 bitop3:0xca
    v_cmp_lt_u32 s[84:85], v5, v92
    s_nop 0
    v_pk_mul_f32 v[80:81], v[80:81], v[14:15] op_sel:[0,1] op_sel_hi:[1,1]
    v_pk_mul_f32 v[82:83], v[82:83], v[14:15] op_sel:[0,1] op_sel_hi:[1,1]
    v_pk_mul_f32 v[76:77], v[76:77], v[14:15] op_sel:[0,0] op_sel_hi:[1,0]
    v_pk_mul_f32 v[78:79], v[78:79], v[14:15] op_sel:[0,0] op_sel_hi:[1,0]
    buffer_load_dwordx4 v[112:115], v3, s[16:19], s40 offen offset:1024
    s_waitcnt lgkmcnt(0)
    v_cmp_ne_u64 s[50:51], v[72:73], v[68:69]
    v_cmpx_ne_u64 s[54:55], v[74:75], v[70:71]
    s_and_b64 s[82:83], s[54:55], s[80:81]
    s_cbranch_scc1 L2_c66
L2_d66:
    v_mov_b64 v[84:85], v[70:71]
    v_mov_b32 v7, v95
    v_mov_b64 v[86:87], v[74:75]
    s_or_b64 s[80:81], s[80:81], s[54:55]
    s_mov_b64 exec, s[50:51]
    s_and_b64 s[82:83], s[50:51], s[80:81]
    s_cbranch_scc1 L2_c67
L2_d67:
    v_mov_b64 v[84:85], v[68:69]
    v_mov_b32 v7, v94
    v_mov_b64 v[86:87], v[72:73]
    s_mov_b64 exec, -1
    s_or_b64 s[80:81], s[80:81], s[50:51]
    ds_read_b64 v[70:71], v93 offset:65408
    s_and_b64 exec, s[84:85], s[80:81]
    v_mfma_f32_4x4x4_16b_bf16 v[76:79], v[12:13], v[84:85], 0
    v_mov_b32 v92, v7
    s_andn2_b64 s[80:81], s[80:81], s[84:85]
    v_mfma_f32_4x4x4_16b_bf16 v[76:79], v[10:11], v[86:87], v[76:79]
    s_mov_b64 exec, -1
    ds_read_b64 v[68:69], v92 offset:65408
    v_and_b32 v46, 0x80000000, v21
    v_lshrrev_b32 v47, 14, v19
    v_bitop3_b32 v47, v47, v5, v46 bitop3:0xea
    ds_read_b64 v[106:107], v47
    v_bitop3_b32 v95, v19, v5, v46 bitop3:0xea
    v_and_b32 v46, 0x40000000, v21
    v_lshrrev_b32 v47, 14, v18
    v_bitop3_b32 v47, v47, v5, v46 bitop3:0xea
    ds_read_b64 v[104:105], v47
    v_bitop3_b32 v94, v18, v5, v46 bitop3:0xea
    s_waitcnt lgkmcnt(2)
    v_mfma_f32_4x4x4_16b_bf16 v[80:83], v[10:11], v[70:71], v[80:83]
    v_mfma_f32_4x4x4_16b_bf16 v[76:79], v[10:11], v[68:69], v[76:79]
    v_perm_b32 v15, v19, v20, s47
    v_bitop3_b32 v46, v19, 0.5, -0.5 bitop3:0xa8
    v_perm_b32 v14, v18, v20, s46
    v_bitop3_b32 v47, v18, 0.5, -0.5 bitop3:0xa8
    v_cvt_pk_bf16_f32 v80, v80, v81
    v_cvt_pk_bf16_f32 v81, v82, v83
    ds_wrxchg_rtn_b64 v[74:75], v93, v[80:81] offset:65408
    v_cvt_pk_bf16_f32 v76, v76, v77
    v_cvt_pk_bf16_f32 v77, v78, v79
    ds_wrxchg_rtn_b64 v[72:73], v92, v[76:77] offset:65408
    v_and_b32 v88, 0x0fffffff, v40
    v_mov_b32 v21, v40
    buffer_load_dwordx2 v[16:17], v88, s[8:11], 0 offen
    buffer_load_dwordx3 v[18:20], v88, s[8:11], 0 offen offset:8
    s_setprio 2
    s_waitcnt lgkmcnt(2)
    v_mfma_f32_4x4x4_16b_bf16 v[80:83], v[8:9], v[106:107], 0
    v_mfma_f32_4x4x4_16b_bf16 v[76:79], v[8:9], v[104:105], 0
    v_bitop3_b32 v15, v6, v15, v46 bitop3:0xca
    v_bitop3_b32 v14, v6, v14, v47 bitop3:0xca
    s_nop 1
    v_pk_mul_f32 v[80:81], v[80:81], v[14:15] op_sel:[0,1] op_sel_hi:[1,1]
    v_pk_mul_f32 v[82:83], v[82:83], v[14:15] op_sel:[0,1] op_sel_hi:[1,1]
    v_pk_mul_f32 v[76:77], v[76:77], v[14:15] op_sel:[0,0] op_sel_hi:[1,0]
    v_pk_mul_f32 v[78:79], v[78:79], v[14:15] op_sel:[0,0] op_sel_hi:[1,0]
    v_sub_u16 v88, v58, v50
    v_and_b32 v89, 3, v50
    v_add3_u32 v99, v88, v89, 3
    v_and_b32 v99, -4, v99
    v_max_u32 v99, 4, v99
    v_and_b32 v97, 0xfffc, v50
    v_bfm_b32 v96, v88, v89
    v_add_u32_dpp v91, v99, v99 row_shr:1 row_mask:0xf bank_mask:0xf bound_ctrl:1
    v_mad_u32_u24 v97, v97, 5, v2
    v_cmp_lt_u32 vcc, 16, v99
    v_add_u32_dpp v91, v91, v91 row_shr:2 row_mask:0xf bank_mask:0xf bound_ctrl:1
    v_sub_u32 v98, s38, v99
    v_lshrrev_b64 v[50:51], 16, v[50:51]
    v_add_u32_dpp v91, v91, v91 row_shr:4 row_mask:0xf bank_mask:0xf bound_ctrl:1
    v_lshrrev_b64 v[58:59], 16, v[58:59]
    s_mov_b32 s101, 0
    v_add_u32_dpp v91, v91, v91 row_shr:8 row_mask:0xf bank_mask:0xf bound_ctrl:1
    s_nop 1
    v_add_u32_dpp v91, v91, v91 row_bcast:15 row_mask:0xa bank_mask:0xf
    s_nop 1
    v_add_u32_dpp v91, v91, v91 row_bcast:31 row_mask:0xc bank_mask:0xf
    v_add_u32 v98, v98, v91
    v_readlane_b32 s37, v91, 63
    s_cbranch_vccnz L2_xo68
L2_xp68:
    s_waitcnt lgkmcnt(0)
    v_cmp_ne_u64 s[50:51], v[72:73], v[68:69]
    v_cmpx_ne_u64 s[54:55], v[74:75], v[70:71]
    s_and_b64 s[82:83], s[54:55], s[80:81]
    s_cbranch_scc1 L2_c69
L2_d69:
    v_mov_b64 v[84:85], v[70:71]
    v_mov_b32 v7, v93
    v_mov_b64 v[86:87], v[74:75]
    s_or_b64 s[80:81], s[80:81], s[54:55]
    s_mov_b64 exec, s[50:51]
    s_and_b64 s[82:83], s[50:51], s[80:81]
    s_cbranch_scc1 L2_c70
L2_d70:
    v_mov_b64 v[84:85], v[68:69]
    v_mov_b32 v7, v92
    v_mov_b64 v[86:87], v[72:73]
    s_mov_b64 exec, -1
    s_or_b64 s[80:81], s[80:81], s[50:51]
    ds_read_b64 v[70:71], v95 offset:65408
    ds_read_b64 v[68:69], v94 offset:65408
    s_waitcnt vmcnt(11)
    v_and_b32 v46, 0x20000000, v27
    v_lshrrev_b32 v47, 14, v23
    v_bitop3_b32 v47, v47, v5, v46 bitop3:0xea
    ds_read_b64 v[102:103], v47
    v_bitop3_b32 v93, v23, v5, v46 bitop3:0xea
    v_and_b32 v46, 0x10000000, v27
    v_lshrrev_b32 v47, 14, v22
    v_bitop3_b32 v47, v47, v5, v46 bitop3:0xea
    ds_read_b64 v[100:101], v47
    v_bitop3_b32 v92, v22, v5, v46 bitop3:0xea
    s_waitcnt lgkmcnt(2)
    v_mfma_f32_4x4x4_16b_bf16 v[80:83], v[10:11], v[70:71], v[80:83]
    v_mfma_f32_4x4x4_16b_bf16 v[76:79], v[10:11], v[68:69], v[76:79]
    v_perm_b32 v15, v23, v26, s45
    v_bitop3_b32 v46, v23, 0.5, -0.5 bitop3:0xa8
    v_perm_b32 v14, v22, v26, s44
    v_bitop3_b32 v47, v22, 0.5, -0.5 bitop3:0xa8
    v_cvt_pk_bf16_f32 v80, v80, v81
    v_cvt_pk_bf16_f32 v81, v82, v83
    ds_wrxchg_rtn_b64 v[74:75], v95, v[80:81] offset:65408
    v_cvt_pk_bf16_f32 v76, v76, v77
    v_cvt_pk_bf16_f32 v77, v78, v79
    ds_wrxchg_rtn_b64 v[72:73], v94, v[76:77] offset:65408
    s_waitcnt lgkmcnt(2)
    v_mfma_f32_4x4x4_16b_bf16 v[80:83], v[8:9], v[102:103], 0
    v_mfma_f32_4x4x4_16b_bf16 v[76:79], v[8:9], v[100:101], 0
    v_bitop3_b32 v15, v6, v15, v46 bitop3:0xca
    v_bitop3_b32 v14, v6, v14, v47 bitop3:0xca
    v_cmp_lt_u32 s[84:85], v5, v92
    s_nop 0
    v_pk_mul_f32 v[80:81], v[80:81], v[14:15] op_sel:[0,1] op_sel_hi:[1,1]
    v_pk_mul_f32 v[82:83], v[82:83], v[14:15] op_sel:[0,1] op_sel_hi:[1,1]
    v_pk_mul_f32 v[76:77], v[76:77], v[14:15] op_sel:[0,0] op_sel_hi:[1,0]
    v_pk_mul_f32 v[78:79], v[78:79], v[14:15] op_sel:[0,0] op_sel_hi:[1,0]
    s_waitcnt lgkmcnt(0)
    v_cmp_ne_u64 s[50:51], v[72:73], v[68:69]
    v_cmpx_ne_u64 s[54:55], v[74:75], v[70:71]
    s_and_b64 s[82:83], s[54:55], s[80:81]
    s_cbranch_scc1 L2_c71
L2_d71:
    v_mov_b64 v[84:85], v[70:71]
    v_mov_b32 v7, v95
    v_mov_b64 v[86:87], v[74:75]
    s_or_b64 s[80:81], s[80:81], s[54:55]
    s_mov_b64 exec, s[50:51]
    s_and_b64 s[82:83], s[50:51], s[80:81]
    s_cbranch_scc1 L2_c72
L2_d72:
    v_mov_b64 v[84:85], v[68:69]
    v_mov_b32 v7, v94
    v_mov_b64 v[86:87], v[72:73]
    s_mov_b64 exec, -1
    s_or_b64 s[80:81], s[80:81], s[50:51]
    ds_read_b64 v[70:71], v93 offset:65408
    s_and_b64 exec, s[84:85], s[80:81]
    v_mfma_f32_4x4x4_16b_bf16 v[76:79], v[12:13], v[84:85], 0
    v_mov_b32 v92, v7
    s_andn2_b64 s[80:81], s[80:81], s[84:85]
    v_mfma_f32_4x4x4_16b_bf16 v[76:79], v[10:11], v[86:87], v[76:79]
    s_mov_b64 exec, -1
    ds_read_b64 v[68:69], v92 offset:65408
    v_and_b32 v46, 0x80000000, v27
    v_lshrrev_b32 v47, 14, v25
    v_bitop3_b32 v47, v47, v5, v46 bitop3:0xea
    ds_read_b64 v[106:107], v47
    v_bitop3_b32 v95, v25, v5, v46 bitop3:0xea
    v_and_b32 v46, 0x40000000, v27
    v_lshrrev_b32 v47, 14, v24
    v_bitop3_b32 v47, v47, v5, v46 bitop3:0xea
    ds_read_b64 v[104:105], v47
    v_bitop3_b32 v94, v24, v5, v46 bitop3:0xea
    s_waitcnt lgkmcnt(2)
    v_mfma_f32_4x4x4_16b_bf16 v[80:83], v[10:11], v[70:71], v[80:83]
    v_mfma_f32_4x4x4_16b_bf16 v[76:79], v[10:11], v[68:69], v[76:79]
    v_perm_b32 v15, v25, v26, s47
    v_bitop3_b32 v46, v25, 0.5, -0.5 bitop3:0xa8
    v_perm_b32 v14, v24, v26, s46
    v_bitop3_b32 v47, v24, 0.5, -0.5 bitop3:0xa8
    v_cvt_pk_bf16_f32 v80, v80, v81
    v_cvt_pk_bf16_f32 v81, v82, v83
    ds_wrxchg_rtn_b64 v[74:75], v93, v[80:81] offset:65408
    v_cvt_pk_bf16_f32 v76, v76, v77
    v_cvt_pk_bf16_f32 v77, v78, v79
    ds_wrxchg_rtn_b64 v[72:73], v92, v[76:77] offset:65408
    v_and_b32 v88, 0x0fffffff, v41
    v_mov_b32 v27, v41
    buffer_load_dwordx2 v[22:23], v88, s[8:11], 0 offen
    buffer_load_dwordx3 v[24:26], v88, s[8:11], 0 offen offset:8
    s_setprio 1
    s_waitcnt lgkmcnt(2)
    v_mfma_f32_4x4x4_16b_bf16 v[80:83], v[8:9], v[106:107], 0
    v_mfma_f32_4x4x4_16b_bf16 v[76:79], v[8:9], v[104:105], 0
    v_bitop3_b32 v15, v6, v15, v46 bitop3:0xca
    v_bitop3_b32 v14, v6, v14, v47 bitop3:0xca
    s_nop 1
    v_pk_mul_f32 v[80:81], v[80:81], v[14:15] op_sel:[0,1] op_sel_hi:[1,1]
    v_pk_mul_f32 v[82:83], v[82:83], v[14:15] op_sel:[0,1] op_sel_hi:[1,1]
    v_pk_mul_f32 v[76:77], v[76:77], v[14:15] op_sel:[0,0] op_sel_hi:[1,0]
    v_pk_mul_f32 v[78:79], v[78:79], v[14:15] op_sel:[0,0] op_sel_hi:[1,0]
    s_waitcnt lgkmcnt(0)
    v_cmp_ne_u64 s[50:51], v[72:73], v[68:69]
    v_cmpx_ne_u64 s[54:55], v[74:75], v[70:71]
    s_and_b64 s[82:83], s[54:55], s[80:81]
    s_cbranch_scc1 L2_c73
L2_d73:
    v_mov_b64 v[84:85], v[70:71]
    v_mov_b32 v7, v93
    v_mov_b64 v[86:87], v[74:75]
    s_or_b64 s[80:81], s[80:81], s[54:55]
    s_mov_b64 exec, s[50:51]
    s_and_b64 s[82:83], s[50:51], s[80:81]
    s_cbranch_scc1 L2_c74
L2_d74:
    v_mov_b64 v[84:85], v[68:69]
    v_mov_b32 v7, v92
    v_mov_b64 v[86:87], v[72:73]
    s_mov_b64 exec, -1
    s_or_b64 s[80:81], s[80:81], s[50:51]
    ds_read_b64 v[70:71], v95 offset:65408
    ds_read_b64 v[68:69], v94 offset:65408
    s_waitcnt vmcnt(11)
    v_and_b32 v46, 0x20000000, v33
    v_lshrrev_b32 v47, 14, v29
    v_bitop3_b32 v47, v47, v5, v46 bitop3:0xea
    ds_read_b64 v[102:103], v47
    v_bitop3_b32 v93, v29, v5, v46 bitop3:0xea
    v_and_b32 v46, 0x10000000, v33
    v_lshrrev_b32 v47, 14, v28
    v_bitop3_b32 v47, v47, v5, v46 bitop3:0xea
    ds_read_b64 v[100:101], v47
    v_bitop3_b32 v92, v28, v5, v46 bitop3:0xea
    s_waitcnt lgkmcnt(2)
    v_mfma_f32_4x4x4_16b_bf16 v[80:83], v[10:11], v[70:71], v[80:83]
    v_mfma_f32_4x4x4_16b_bf16 v[76:79], v[10:11], v[68:69], v[76:79]
    v_perm_b32 v15, v29, v32, s45
    v_bitop3_b32 v46, v29, 0.5, -0.5 bitop3:0xa8
    v_perm_b32 v14, v28, v32, s44
    v_bitop3_b32 v47, v28, 0.5, -0.5 bitop3:0xa8
    v_cvt_pk_bf16_f32 v80, v80, v81
    v_cvt_pk_bf16_f32 v81, v82, v83
    ds_wrxchg_rtn_b64 v[74:75], v95, v[80:81] offset:65408
    v_cvt_pk_bf16_f32 v76, v76, v77
    v_cvt_pk_bf16_f32 v77, v78, v79
    ds_wrxchg_rtn_b64 v[72:73], v94, v[76:77] offset:65408
    s_waitcnt lgkmcnt(2)
    v_mfma_f32_4x4x4_16b_bf16 v[80:83], v[8:9], v[102:103], 0
    v_mfma_f32_4x4x4_16b_bf16 v[76:79], v[8:9], v[100:101], 0
    v_bitop3_b32 v15, v6, v15, v46 bitop3:0xca
    v_bitop3_b32 v14, v6, v14, v47 bitop3:0xca
    v_cmp_lt_u32 s[84:85], v5, v92
    s_nop 0
    v_pk_mul_f32 v[80:81], v[80:81], v[14:15] op_sel:[0,1] op_sel_hi:[1,1]
    v_pk_mul_f32 v[82:83], v[82:83], v[14:15] op_sel:[0,1] op_sel_hi:[1,1]
    v_pk_mul_f32 v[76:77], v[76:77], v[14:15] op_sel:[0,0] op_sel_hi:[1,0]
    v_pk_mul_f32 v[78:79], v[78:79], v[14:15] op_sel:[0,0] op_sel_hi:[1,0]
    s_waitcnt lgkmcnt(0)
    v_cmp_ne_u64 s[50:51], v[72:73], v[68:69]
    v_cmpx_ne_u64 s[54:55], v[74:75], v[70:71]
    s_and_b64 s[82:83], s[54:55], s[80:81]
    s_cbranch_scc1 L2_c75
L2_d75:
    v_mov_b64 v[84:85], v[70:71]
    v_mov_b32 v7, v95
    v_mov_b64 v[86:87], v[74:75]
    s_or_b64 s[80:81], s[80:81], s[54:55]
    s_mov_b64 exec, s[50:51]
    s_and_b64 s[82:83], s[50:51], s[80:81]
    s_cbranch_scc1 L2_c76
L2_d76:
    v_mov_b64 v[84:85], v[68:69]
    v_mov_b32 v7, v94
    v_mov_b64 v[86:87], v[72:73]
    s_mov_b64 exec, -1
    s_or_b64 s[80:81], s[80:81], s[50:51]
    ds_read_b64 v[70:71], v93 offset:65408
    s_and_b64 exec, s[84:85], s[80:81]
    v_mfma_f32_4x4x4_16b_bf16 v[76:79], v[12:13], v[84:85], 0
    v_mov_b32 v92, v7
    s_andn2_b64 s[80:81], s[80:81], s[84:85]
    v_mfma_f32_4x4x4_16b_bf16 v[76:79], v[10:11], v[86:87], v[76:79]
    s_mov_b64 exec, -1
    ds_read_b64 v[68:69], v92 offset:65408
    v_and_b32 v46, 0x80000000, v33
    v_lshrrev_b32 v47, 14, v31
    v_bitop3_b32 v47, v47, v5, v46 bitop3:0xea
    ds_read_b64 v[106:107], v47
    v_bitop3_b32 v95, v31, v5, v46 bitop3:0xea
    v_and_b32 v46, 0x40000000, v33
    v_lshrrev_b32 v47, 14, v30
    v_bitop3_b32 v47, v47, v5, v46 bitop3:0xea
    ds_read_b64 v[104:105], v47
    v_bitop3_b32 v94, v30, v5, v46 bitop3:0xea
    s_waitcnt lgkmcnt(2)
    v_mfma_f32_4x4x4_16b_bf16 v[80:83], v[10:11], v[70:71], v[80:83]
    v_mfma_f32_4x4x4_16b_bf16 v[76:79], v[10:11], v[68:69], v[76:79]
    v_perm_b32 v15, v31, v32, s47
    v_bitop3_b32 v46, v31, 0.5, -0.5 bitop3:0xa8
    v_perm_b32 v14, v30, v32, s46
    v_bitop3_b32 v47, v30, 0.5, -0.5 bitop3:0xa8
    v_cvt_pk_bf16_f32 v80, v80, v81
    v_cvt_pk_bf16_f32 v81, v82, v83
    ds_wrxchg_rtn_b64 v[74:75], v93, v[80:81] offset:65408
    v_cvt_pk_bf16_f32 v76, v76, v77
    v_cvt_pk_bf16_f32 v77, v78, v79
    ds_wrxchg_rtn_b64 v[72:73], v92, v[76:77] offset:65408
    v_and_b32 v88, 0x0fffffff, v42
    v_mov_b32 v33, v42
    buffer_load_dwordx2 v[28:29], v88, s[8:11], 0 offen
    buffer_load_dwordx3 v[30:32], v88, s[8:11], 0 offen offset:8
    s_setprio 0
    s_waitcnt lgkmcnt(2)
    v_mfma_f32_4x4x4_16b_bf16 v[80:83], v[8:9], v[106:107], 0
    v_mfma_f32_4x4x4_16b_bf16 v[76:79], v[8:9], v[104:105], 0
    v_bitop3_b32 v15, v6, v15, v46 bitop3:0xca
    v_bitop3_b32 v14, v6, v14, v47 bitop3:0xca
    s_nop 1
    v_pk_mul_f32 v[80:81], v[80:81], v[14:15] op_sel:[0,1] op_sel_hi:[1,1]
    v_pk_mul_f32 v[82:83], v[82:83], v[14:15] op_sel:[0,1] op_sel_hi:[1,1]
    v_pk_mul_f32 v[76:77], v[76:77], v[14:15] op_sel:[0,0] op_sel_hi:[1,0]
    v_pk_mul_f32 v[78:79], v[78:79], v[14:15] op_sel:[0,0] op_sel_hi:[1,0]
    s_add_u32 s40, s40, 0x50000
    s_waitcnt lgkmcnt(0)
    v_cmp_ne_u64 s[50:51], v[72:73], v[68:69]
    v_cmpx_ne_u64 s[54:55], v[74:75], v[70:71]
    s_and_b64 s[82:83], s[54:55], s[80:81]
    s_cbranch_scc1 L2_c77
L2_d77:
    v_mov_b64 v[84:85], v[70:71]
    v_mov_b32 v7, v93
    v_mov_b64 v[86:87], v[74:75]
    s_or_b64 s[80:81], s[80:81], s[54:55]
    s_mov_b64 exec, s[50:51]
    s_and_b64 s[82:83], s[50:51], s[80:81]
    s_cbranch_scc1 L2_c78
L2_d78:
    v_mov_b64 v[84:85], v[68:69]
    v_mov_b32 v7, v92
    v_mov_b64 v[86:87], v[72:73]
    s_mov_b64 exec, -1
    s_or_b64 s[80:81], s[80:81], s[50:51]
    ds_read_b64 v[70:71], v95 offset:65408
    ds_read_b64 v[68:69], v94 offset:65408
    s_waitcnt vmcnt(8)
    v_and_b32 v46, 0x20000000, v39
    v_lshrrev_b32 v47, 14, v35
    v_bitop3_b32 v47, v47, v5, v46 bitop3:0xea
    ds_read_b64 v[102:103], v47
    v_bitop3_b32 v93, v35, v5, v46 bitop3:0xea
    v_and_b32 v46, 0x10000000, v39
    v_lshrrev_b32 v47, 14, v34
    v_bitop3_b32 v47, v47, v5, v46 bitop3:0xea
    ds_read_b64 v[100:101], v47
    v_bitop3_b32 v92, v34, v5, v46 bitop3:0xea
    v_and_b32 v46, 0x80000000, v39
    v_lshrrev_b32 v47, 14, v37
    v_bitop3_b32 v47, v47, v5, v46 bitop3:0xea
    ds_read_b64 v[106:107], v47
    v_and_b32 v46, 0x40000000, v39
    v_lshrrev_b32 v47, 14, v36
    v_bitop3_b32 v47, v47, v5, v46 bitop3:0xea
    ds_read_b64 v[104:105], v47
    s_waitcnt lgkmcnt(4)
    v_mfma_f32_4x4x4_16b_bf16 v[80:83], v[10:11], v[70:71], v[80:83]
    v_mfma_f32_4x4x4_16b_bf16 v[76:79], v[10:11], v[68:69], v[76:79]
    v_perm_b32 v15, v35, v38, s45
    v_bitop3_b32 v46, v35, 0.5, -0.5 bitop3:0xa8
    v_perm_b32 v14, v34, v38, s44
    v_bitop3_b32 v47, v34, 0.5, -0.5 bitop3:0xa8
    v_cvt_pk_bf16_f32 v80, v80, v81
    v_cvt_pk_bf16_f32 v81, v82, v83
    ds_wrxchg_rtn_b64 v[74:75], v95, v[80:81] offset:65408
    v_cvt_pk_bf16_f32 v76, v76, v77
    v_cvt_pk_bf16_f32 v77, v78, v79
    ds_wrxchg_rtn_b64 v[72:73], v94, v[76:77] offset:65408
    s_waitcnt lgkmcnt(2)
    s_barrier
    s_setprio 3
    s_mov_b32 m0, s100
    s_nop 0
    ds_write_addtid_b32 v116 offset:32768
    ds_write_addtid_b32 v117 offset:33024
    ds_write_addtid_b32 v118 offset:33280
    ds_write_addtid_b32 v119 offset:33536
    buffer_load_dwordx4 v[116:119], v3, s[16:19], s40 offen offset:2048
    ds_write_addtid_b32 v120 offset:33792
    ds_write_addtid_b32 v121 offset:34048
    ds_write_addtid_b32 v122 offset:34304
    ds_write_addtid_b32 v123 offset:34560
    buffer_load_dwordx4 v[120:123], v3, s[16:19], s40 offen offset:3072
    v_mfma_f32_4x4x4_16b_bf16 v[80:83], v[8:9], v[102:103], 0
    v_mfma_f32_4x4x4_16b_bf16 v[76:79], v[8:9], v[100:101], 0
    v_bitop3_b32 v15, v6, v15, v46 bitop3:0xca
    v_bitop3_b32 v14, v6, v14, v47 bitop3:0xca
    v_cmp_lt_u32 s[84:85], v5, v92
    s_nop 0
    v_pk_mul_f32 v[80:81], v[80:81], v[14:15] op_sel:[0,1] op_sel_hi:[1,1]
    v_pk_mul_f32 v[82:83], v[82:83], v[14:15] op_sel:[0,1] op_sel_hi:[1,1]
    v_pk_mul_f32 v[76:77], v[76:77], v[14:15] op_sel:[0,0] op_sel_hi:[1,0]
    v_pk_mul_f32 v[78:79], v[78:79], v[14:15] op_sel:[0,0] op_sel_hi:[1,0]
    v_mov_b32 v44, v43
    s_cmp_gt_u32 s37, 1024
    s_cbranch_scc1 L2_xs79
    s_cmp_lg_u32 s101, 0
    s_cbranch_scc1 L2_xa79
L2_xb79:
    v_lshlrev_b32 v89, 16, v96
    v_add_u32 v90, 60, v97
    v_bitop3_b32 v90, v89, v45, v90 bitop3:0x6a
    ds_write_b32 v98, v90 offset:12
    v_lshlrev_b32 v89, 20, v96
    v_add_u32 v90, 40, v97
    v_bitop3_b32 v90, v89, v45, v90 bitop3:0x6a
    ds_write_b32 v98, v90 offset:8
    v_lshlrev_b32 v89, 24, v96
    v_add_u32 v90, 20, v97
    v_bitop3_b32 v90, v89, v45, v90 bitop3:0x6a
    ds_write_b32 v98, v90 offset:4
    v_lshlrev_b32 v89, 28, v96
    v_bitop3_b32 v90, v89, v45, v97 bitop3:0x6a
    ds_write_b32 v98, v90 offset:0
    v_mov_b32_dpp v91, v66 quad_perm:[0,0,0,0] row_mask:0xf bank_mask:0xf
    v_and_b32 v89, 3, v91
    v_and_b32 v97, 0xfffc, v91
    v_sub_u16_dpp v88, v66, v91 quad_perm:[2,2,2,2] row_mask:0xf bank_mask:0xf
    v_mad_u32_u24 v97, v97, 5, v4
    v_add_u32 v99, v88, v89
    v_bfm_b32 v96, v88, v89
    v_cmp_lt_u32 s[58:59], 16, v99
    v_lshlrev_b32 v89, v1, v96
    v_and_b32 v89, v45, v89
    v_cmp_ne_u32 vcc, 0, v89
    v_xor_b32 v90, v97, v89
    s_add_u32 s3, s37, s38
    v_mbcnt_lo_u32_b32 v98, vcc_lo, 0
    v_mbcnt_hi_u32_b32 v98, vcc_hi, v98
    s_bcnt1_i32_b64 s41, vcc
    v_lshl_add_u32 v98, v98, 2, s3
    s_mov_b64 exec, vcc
    ds_write_b32 v98, v90
    s_mov_b64 exec, -1
    s_lshl2_add_u32 s37, s41, s37
    s_cmp_lg_u64 s[58:59], 0
    s_cbranch_scc1 L2_xe79
L2_xr79:
    v_add_u32 v98, s37, v0
    v_mov_b32 v90, -1
    ds_write_b32 v98, v90
    ds_read2st64_b32 v[40:41], v0 offset0:0 offset1:1
    ds_read2st64_b32 v[42:43], v0 offset0:2 offset1:3
    s_sub_u32 s3, s37, 768
    s_cmp_gt_u32 s3, 256
    s_cbranch_scc1 L2_xf79
L2_xg79:
    s_setprio 2
    ds_write_addtid_b32 v124 offset:34816
    ds_write_addtid_b32 v125 offset:35072
    ds_write_addtid_b32 v126 offset:35328
    ds_write_addtid_b32 v127 offset:35584
    s_add_u32 s3, s40, 4096
    buffer_load_dwordx4 v[124:127], v3, s[16:19], s3 offen
    s_waitcnt lgkmcnt(14)
    v_cmp_ne_u64 s[50:51], v[72:73], v[68:69]
    v_cmpx_ne_u64 s[54:55], v[74:75], v[70:71]
    s_and_b64 s[82:83], s[54:55], s[80:81]
    s_cbranch_scc1 L2_c80
L2_d80:
    v_mov_b64 v[84:85], v[70:71]
    v_mov_b32 v7, v95
    v_mov_b64 v[86:87], v[74:75]
    s_or_b64 s[80:81], s[80:81], s[54:55]
    s_mov_b64 exec, s[50:51]
    s_and_b64 s[82:83], s[50:51], s[80:81]
    s_cbranch_scc1 L2_c81
L2_d81:
    v_mov_b64 v[84:85], v[68:69]
    v_mov_b32 v7, v94
    v_mov_b64 v[86:87], v[72:73]
    s_mov_b64 exec, -1
    s_or_b64 s[80:81], s[80:81], s[50:51]
    ds_read_b64 v[70:71], v93 offset:65408
    s_and_b64 exec, s[84:85], s[80:81]
    v_mfma_f32_4x4x4_16b_bf16 v[76:79], v[12:13], v[84:85], 0
    v_mov_b32 v92, v7
    s_andn2_b64 s[80:81], s[80:81], s[84:85]
    v_mfma_f32_4x4x4_16b_bf16 v[76:79], v[10:11], v[86:87], v[76:79]
    s_mov_b64 exec, -1
    ds_read_b64 v[68:69], v92 offset:65408
    s_setprio 1
    s_waitcnt vmcnt(10)
    s_mov_b32 m0, s38
    s_nop 0
    ds_write_addtid_b32 v108 offset:0
    ds_write_addtid_b32 v109 offset:256
    ds_write_addtid_b32 v110 offset:512
    ds_write_addtid_b32 v111 offset:768
    s_waitcnt lgkmcnt(4)
    v_mfma_f32_4x4x4_16b_bf16 v[80:83], v[10:11], v[70:71], v[80:83]
    v_mfma_f32_4x4x4_16b_bf16 v[76:79], v[10:11], v[68:69], v[76:79]
    v_and_b32 v46, 0x40000000, v39
    v_bitop3_b32 v94, v36, v5, v46 bitop3:0xea
    v_and_b32 v46, 0x80000000, v39
    v_bitop3_b32 v95, v37, v5, v46 bitop3:0xea
    v_perm_b32 v15, v37, v38, s47
    v_bitop3_b32 v46, v37, 0.5, -0.5 bitop3:0xa8
    v_perm_b32 v14, v36, v38, s46
    v_bitop3_b32 v47, v36, 0.5, -0.5 bitop3:0xa8
    v_cvt_pk_bf16_f32 v80, v80, v81
    v_cvt_pk_bf16_f32 v81, v82, v83
    ds_wrxchg_rtn_b64 v[74:75], v93, v[80:81] offset:65408
    v_cvt_pk_bf16_f32 v76, v76, v77
    v_cvt_pk_bf16_f32 v77, v78, v79
    ds_wrxchg_rtn_b64 v[72:73], v92, v[76:77] offset:65408
    v_and_b32 v88, 0x0fffffff, v44
    v_mov_b32 v39, v44
    buffer_load_dwordx2 v[34:35], v88, s[8:11], 0 offen
    buffer_load_dwordx3 v[36:38], v88, s[8:11], 0 offen offset:8
    s_setprio 0
    s_waitcnt vmcnt(11)
    ds_write_addtid_b32 v112 offset:1024
    ds_write_addtid_b32 v113 offset:1280
    ds_write_addtid_b32 v114 offset:1536
    ds_write_addtid_b32 v115 offset:1792
    v_mfma_f32_4x4x4_16b_bf16 v[80:83], v[8:9], v[106:107], 0
    v_mfma_f32_4x4x4_16b_bf16 v[76:79], v[8:9], v[104:105], 0
    v_bitop3_b32 v15, v6, v15, v46 bitop3:0xca
    v_bitop3_b32 v14, v6, v14, v47 bitop3:0xca
    s_nop 1
    v_pk_mul_f32 v[80:81], v[80:81], v[14:15] op_sel:[0,1] op_sel_hi:[1,1]
    v_pk_mul_f32 v[82:83], v[82:83], v[14:15] op_sel:[0,1] op_sel_hi:[1,1]
    v_pk_mul_f32 v[76:77], v[76:77], v[14:15] op_sel:[0,0] op_sel_hi:[1,0]
    v_pk_mul_f32 v[78:79], v[78:79], v[14:15] op_sel:[0,0] op_sel_hi:[1,0]
    s_add_u32 s42, s42, 1
    s_waitcnt lgkmcnt(0)
    s_barrier
    s_bitcmp1_b32 s36, s42
    s_cbranch_scc1 L2_slow
L2_ret4:
    s_setprio 3
    buffer_load_dwordx4 v[108:111], v3, s[16:19], s40 offen offset:0
    v_cmp_ne_u64 s[50:51], v[72:73], v[68:69]
    v_cmpx_ne_u64 s[54:55], v[74:75], v[70:71]
    s_and_b64 s[82:83], s[54:55], s[80:81]
    s_cbranch_scc1 L2_c82
L2_d82:
    v_mov_b64 v[84:85], v[70:71]
    v_mov_b32 v7, v93
    v_mov_b64 v[86:87], v[74:75]
    s_or_b64 s[80:81], s[80:81], s[54:55]
    s_mov_b64 exec, s[50:51]
    s_and_b64 s[82:83], s[50:51], s[80:81]
    s_cbranch_scc1 L2_c83
L2_d83:
    v_mov_b64 v[84:85], v[68:69]
    v_mov_b32 v7, v92
    v_mov_b64 v[86:87], v[72:73]
    s_mov_b64 exec, -1
    s_or_b64 s[80:81], s[80:81], s[50:51]
    ds_read_b64 v[70:71], v95 offset:65408
    ds_read_b64 v[68:69], v94 offset:65408
    s_waitcnt vmcnt(10)
    v_and_b32 v46, 0x20000000, v21
    v_lshrrev_b32 v47, 14, v17
    v_bitop3_b32 v47, v47, v5, v46 bitop3:0xea
    ds_read_b64 v[102:103], v47
    v_bitop3_b32 v93, v17, v5, v46 bitop3:0xea
    v_and_b32 v46, 0x10000000, v21
    v_lshrrev_b32 v47, 14, v16
    v_bitop3_b32 v47, v47, v5, v46 bitop3:0xea
    ds_read_b64 v[100:101], v47
    v_bitop3_b32 v92, v16, v5, v46 bitop3:0xea
    s_waitcnt lgkmcnt(2)
    v_mfma_f32_4x4x4_16b_bf16 v[80:83], v[10:11], v[70:71], v[80:83]
    v_mfma_f32_4x4x4_16b_bf16 v[76:79], v[10:11], v[68:69], v[76:79]
    v_perm_b32 v15, v17, v20, s45
    v_bitop3_b32 v46, v17, 0.5, -0.5 bitop3:0xa8
    v_perm_b32 v14, v16, v20, s44
    v_bitop3_b32 v47, v16, 0.5, -0.5 bitop3:0xa8
    v_cvt_pk_bf16_f32 v80, v80, v81
    v_cvt_pk_bf16_f32 v81, v82, v83
    ds_wrxchg_rtn_b64 v[74:75], v95, v[80:81] offset:65408
    v_cvt_pk_bf16_f32 v76, v76, v77
    v_cvt_pk_bf16_f32 v77, v78, v79
    ds_wrxchg_rtn_b64 v[72:73], v94, v[76:77] offset:65408
    s_waitcnt lgkmcnt(2)
    v_mfma_f32_4x4x4_16b_bf16 v[80:83], v[8:9], v[102:103], 0
    v_mfma_f32_4x4x4_16b_bf16 v[76:79], v[8:9], v[100:101], 0
    v_bitop3_b32 v15, v6, v15, v46 bitop3:0xca
    v_bitop3_b32 v14, v6, v14, v47 bitop3:0xca
    v_cmp_lt_u32 s[84:85], v5, v92
    s_nop 0
    v_pk_mul_f32 v[80:81], v[80:81], v[14:15] op_sel:[0,1] op_sel_hi:[1,1]
    v_pk_mul_f32 v[82:83], v[82:83], v[14:15] op_sel:[0,1] op_sel_hi:[1,1]
    v_pk_mul_f32 v[76:77], v[76:77], v[14:15] op_sel:[0,0] op_sel_hi:[1,0]
    v_pk_mul_f32 v[78:79], v[78:79], v[14:15] op_sel:[0,0] op_sel_hi:[1,0]
    buffer_load_dwordx4 v[112:115], v3, s[16:19], s40 offen offset:1024
    s_waitcnt lgkmcnt(0)
    v_cmp_ne_u64 s[50:51], v[72:73], v[68:69]
    v_cmpx_ne_u64 s[54:55], v[74:75], v[70:71]
    s_and_b64 s[82:83], s[54:55], s[80:81]
    s_cbranch_scc1 L2_c84
L2_d84:
    v_mov_b64 v[84:85], v[70:71]
    v_mov_b32 v7, v95
    v_mov_b64 v[86:87], v[74:75]
    s_or_b64 s[80:81], s[80:81], s[54:55]
    s_mov_b64 exec, s[50:51]
    s_and_b64 s[82:83], s[50:51], s[80:81]
    s_cbranch_scc1 L2_c85
L2_d85:
    v_mov_b64 v[84:85], v[68:69]
    v_mov_b32 v7, v94
    v_mov_b64 v[86:87], v[72:73]
    s_mov_b64 exec, -1
    s_or_b64 s[80:81], s[80:81], s[50:51]
    ds_read_b64 v[70:71], v93 offset:65408
    s_and_b64 exec, s[84:85], s[80:81]
    v_mfma_f32_4x4x4_16b_bf16 v[76:79], v[12:13], v[84:85], 0
    v_mov_b32 v92, v7
    s_andn2_b64 s[80:81], s[80:81], s[84:85]
    v_mfma_f32_4x4x4_16b_bf16 v[76:79], v[10:11], v[86:87], v[76:79]
    s_mov_b64 exec, -1
    ds_read_b64 v[68:69], v92 offset:65408
    v_and_b32 v46, 0x80000000, v21
    v_lshrrev_b32 v47, 14, v19
    v_bitop3_b32 v47, v47, v5, v46 bitop3:0xea
    ds_read_b64 v[106:107], v47
    v_bitop3_b32 v95, v19, v5, v46 bitop3:0xea
    v_and_b32 v46, 0x40000000, v21
    v_lshrrev_b32 v47, 14, v18
    v_bitop3_b32 v47, v47, v5, v46 bitop3:0xea
    ds_read_b64 v[104:105], v47
    v_bitop3_b32 v94, v18, v5, v46 bitop3:0xea
    s_waitcnt lgkmcnt(2)
    v_mfma_f32_4x4x4_16b_bf16 v[80:83], v[10:11], v[70:71], v[80:83]
    v_mfma_f32_4x4x4_16b_bf16 v[76:79], v[10:11], v[68:69], v[76:79]
    v_perm_b32 v15, v19, v20, s47
    v_bitop3_b32 v46, v19, 0.5, -0.5 bitop3:0xa8
    v_perm_b32 v14, v18, v20, s46
    v_bitop3_b32 v47, v18, 0.5, -0.5 bitop3:0xa8
    v_cvt_pk_bf16_f32 v80, v80, v81
    v_cvt_pk_bf16_f32 v81, v82, v83
    ds_wrxchg_rtn_b64 v[74:75], v93, v[80:81] offset:65408
    v_cvt_pk_bf16_f32 v76, v76, v77
    v_cvt_pk_bf16_f32 v77, v78, v79
    ds_wrxchg_rtn_b64 v[72:73], v92, v[76:77] offset:65408
    v_and_b32 v88, 0x0fffffff, v40
    v_mov_b32 v21, v40
    buffer_load_dwordx2 v[16:17], v88, s[8:11], 0 offen
    buffer_load_dwordx3 v[18:20], v88, s[8:11], 0 offen offset:8
    s_setprio 2
    s_waitcnt lgkmcnt(2)
    v_mfma_f32_4x4x4_16b_bf16 v[80:83], v[8:9], v[106:107], 0
    v_mfma_f32_4x4x4_16b_bf16 v[76:79], v[8:9], v[104:105], 0
    v_bitop3_b32 v15, v6, v15, v46 bitop3:0xca
    v_bitop3_b32 v14, v6, v14, v47 bitop3:0xca
    s_nop 1
    v_pk_mul_f32 v[80:81], v[80:81], v[14:15] op_sel:[0,1] op_sel_hi:[1,1]
    v_pk_mul_f32 v[82:83], v[82:83], v[14:15] op_sel:[0,1] op_sel_hi:[1,1]
    v_pk_mul_f32 v[76:77], v[76:77], v[14:15] op_sel:[0,0] op_sel_hi:[1,0]
    v_pk_mul_f32 v[78:79], v[78:79], v[14:15] op_sel:[0,0] op_sel_hi:[1,0]
    v_sub_u16 v88, v60, v52
    v_and_b32 v89, 3, v52
    v_add3_u32 v99, v88, v89, 3
    v_and_b32 v99, -4, v99
    v_max_u32 v99, 4, v99
    v_and_b32 v97, 0xfffc, v52
    v_bfm_b32 v96, v88, v89
    v_add_u32_dpp v91, v99, v99 row_shr:1 row_mask:0xf bank_mask:0xf bound_ctrl:1
    v_mad_u32_u24 v97, v97, 5, v2
    v_cmp_lt_u32 vcc, 16, v99
    v_add_u32_dpp v91, v91, v91 row_shr:2 row_mask:0xf bank_mask:0xf bound_ctrl:1
    v_sub_u32 v98, s38, v99
    v_lshrrev_b64 v[52:53], 16, v[52:53]
    v_add_u32_dpp v91, v91, v91 row_shr:4 row_mask:0xf bank_mask:0xf bound_ctrl:1
    v_lshrrev_b64 v[60:61], 16, v[60:61]
    s_mov_b32 s101, 0
    v_add_u32_dpp v91, v91, v91 row_shr:8 row_mask:0xf bank_mask:0xf bound_ctrl:1
    s_nop 1
    v_add_u32_dpp v91, v91, v91 row_bcast:15 row_mask:0xa bank_mask:0xf
    s_nop 1
    v_add_u32_dpp v91, v91, v91 row_bcast:31 row_mask:0xc bank_mask:0xf
    v_add_u32 v98, v98, v91
    v_readlane_b32 s37, v91, 63
    s_cbranch_vccnz L2_xo86
L2_xp86:
    s_waitcnt lgkmcnt(0)
    v_cmp_ne_u64 s[50:51], v[72:73], v[68:69]
    v_cmpx_ne_u64 s[54:55], v[74:75], v[70:71]
    s_and_b64 s[82:83], s[54:55], s[80:81]
    s_cbranch_scc1 L2_c87
L2_d87:
    v_mov_b64 v[84:85], v[70:71]
    v_mov_b32 v7, v93
    v_mov_b64 v[86:87], v[74:75]
    s_or_b64 s[80:81], s[80:81], s[54:55]
    s_mov_b64 exec, s[50:51]
    s_and_b64 s[82:83], s[50:51], s[80:81]
    s_cbranch_scc1 L2_c88
L2_d88:
    v_mov_b64 v[84:85], v[68:69]
    v_mov_b32 v7, v92
    v_mov_b64 v[86:87], v[72:73]
    s_mov_b64 exec, -1
    s_or_b64 s[80:81], s[80:81], s[50:51]
    ds_read_b64 v[70:71], v95 offset:65408
    ds_read_b64 v[68:69], v94 offset:65408
    s_waitcnt vmcnt(11)
    v_and_b32 v46, 0x20000000, v27
    v_lshrrev_b32 v47, 14, v23
    v_bitop3_b32 v47, v47, v5, v46 bitop3:0xea
    ds_read_b64 v[102:103], v47
    v_bitop3_b32 v93, v23, v5, v46 bitop3:0xea
    v_and_b32 v46, 0x10000000, v27
    v_lshrrev_b32 v47, 14, v22
    v_bitop3_b32 v47, v47, v5, v46 bitop3:0xea
    ds_read_b64 v[100:101], v47
    v_bitop3_b32 v92, v22, v5, v46 bitop3:0xea
    s_waitcnt lgkmcnt(2)
    v_mfma_f32_4x4x4_16b_bf16 v[80:83], v[10:11], v[70:71], v[80:83]
    v_mfma_f32_4x4x4_16b_bf16 v[76:79], v[10:11], v[68:69], v[76:79]
    v_perm_b32 v15, v23, v26, s45
    v_bitop3_b32 v46, v23, 0.5, -0.5 bitop3:0xa8
    v_perm_b32 v14, v22, v26, s44
    v_bitop3_b32 v47, v22, 0.5, -0.5 bitop3:0xa8
    v_cvt_pk_bf16_f32 v80, v80, v81
    v_cvt_pk_bf16_f32 v81, v82, v83
    ds_wrxchg_rtn_b64 v[74:75], v95, v[80:81] offset:65408
    v_cvt_pk_bf16_f32 v76, v76, v77
    v_cvt_pk_bf16_f32 v77, v78, v79
    ds_wrxchg_rtn_b64 v[72:73], v94, v[76:77] offset:65408
    s_waitcnt lgkmcnt(2)
    v_mfma_f32_4x4x4_16b_bf16 v[80:83], v[8:9], v[102:103], 0
    v_mfma_f32_4x4x4_16b_bf16 v[76:79], v[8:9], v[100:101], 0
    v_bitop3_b32 v15, v6, v15, v46 bitop3:0xca
    v_bitop3_b32 v14, v6, v14, v47 bitop3:0xca
    v_cmp_lt_u32 s[84:85], v5, v92
    s_nop 0
    v_pk_mul_f32 v[80:81], v[80:81], v[14:15] op_sel:[0,1] op_sel_hi:[1,1]
    v_pk_mul_f32 v[82:83], v[82:83], v[14:15] op_sel:[0,1] op_sel_hi:[1,1]
    v_pk_mul_f32 v[76:77], v[76:77], v[14:15] op_sel:[0,0] op_sel_hi:[1,0]
    v_pk_mul_f32 v[78:79], v[78:79], v[14:15] op_sel:[0,0] op_sel_hi:[1,0]
    s_waitcnt lgkmcnt(0)
    v_cmp_ne_u64 s[50:51], v[72:73], v[68:69]
    v_cmpx_ne_u64 s[54:55], v[74:75], v[70:71]
    s_and_b64 s[82:83], s[54:55], s[80:81]
    s_cbranch_scc1 L2_c89
L2_d89:
    v_mov_b64 v[84:85], v[70:71]
    v_mov_b32 v7, v95
    v_mov_b64 v[86:87], v[74:75]
    s_or_b64 s[80:81], s[80:81], s[54:55]
    s_mov_b64 exec, s[50:51]
    s_and_b64 s[82:83], s[50:51], s[80:81]
    s_cbranch_scc1 L2_c90
L2_d90:
    v_mov_b64 v[84:85], v[68:69]
    v_mov_b32 v7, v94
    v_mov_b64 v[86:87], v[72:73]
    s_mov_b64 exec, -1
    s_or_b64 s[80:81], s[80:81], s[50:51]
    ds_read_b64 v[70:71], v93 offset:65408
    s_and_b64 exec, s[84:85], s[80:81]
    v_mfma_f32_4x4x4_16b_bf16 v[76:79], v[12:13], v[84:85], 0
    v_mov_b32 v92, v7
    s_andn2_b64 s[80:81], s[80:81], s[84:85]
    v_mfma_f32_4x4x4_16b_bf16 v[76:79], v[10:11], v[86:87], v[76:79]
    s_mov_b64 exec, -1
    ds_read_b64 v[68:69], v92 offset:65408
    v_and_b32 v46, 0x80000000, v27
    v_lshrrev_b32 v47, 14, v25
    v_bitop3_b32 v47, v47, v5, v46 bitop3:0xea
    ds_read_b64 v[106:107], v47
    v_bitop3_b32 v95, v25, v5, v46 bitop3:0xea
    v_and_b32 v46, 0x40000000, v27
    v_lshrrev_b32 v47, 14, v24
    v_bitop3_b32 v47, v47, v5, v46 bitop3:0xea
    ds_read_b64 v[104:105], v47
    v_bitop3_b32 v94, v24, v5, v46 bitop3:0xea
    s_waitcnt lgkmcnt(2)
    v_mfma_f32_4x4x4_16b_bf16 v[80:83], v[10:11], v[70:71], v[80:83]
    v_mfma_f32_4x4x4_16b_bf16 v[76:79], v[10:11], v[68:69], v[76:79]
    v_perm_b32 v15, v25, v26, s47
    v_bitop3_b32 v46, v25, 0.5, -0.5 bitop3:0xa8
    v_perm_b32 v14, v24, v26, s46
    v_bitop3_b32 v47, v24, 0.5, -0.5 bitop3:0xa8
    v_cvt_pk_bf16_f32 v80, v80, v81
    v_cvt_pk_bf16_f32 v81, v82, v83
    ds_wrxchg_rtn_b64 v[74:75], v93, v[80:81] offset:65408
    v_cvt_pk_bf16_f32 v76, v76, v77
    v_cvt_pk_bf16_f32 v77, v78, v79
    ds_wrxchg_rtn_b64 v[72:73], v92, v[76:77] offset:65408
    v_and_b32 v88, 0x0fffffff, v41
    v_mov_b32 v27, v41
    buffer_load_dwordx2 v[22:23], v88, s[8:11], 0 offen
    buffer_load_dwordx3 v[24:26], v88, s[8:11], 0 offen offset:8
    s_setprio 1
    s_waitcnt lgkmcnt(2)
    v_mfma_f32_4x4x4_16b_bf16 v[80:83], v[8:9], v[106:107], 0
    v_mfma_f32_4x4x4_16b_bf16 v[76:79], v[8:9], v[104:105], 0
    v_bitop3_b32 v15, v6, v15, v46 bitop3:0xca
    v_bitop3_b32 v14, v6, v14, v47 bitop3:0xca
    s_nop 1
    v_pk_mul_f32 v[80:81], v[80:81], v[14:15] op_sel:[0,1] op_sel_hi:[1,1]
    v_pk_mul_f32 v[82:83], v[82:83], v[14:15] op_sel:[0,1] op_sel_hi:[1,1]
    v_pk_mul_f32 v[76:77], v[76:77], v[14:15] op_sel:[0,0] op_sel_hi:[1,0]
    v_pk_mul_f32 v[78:79], v[78:79], v[14:15] op_sel:[0,0] op_sel_hi:[1,0]
    s_waitcnt lgkmcnt(0)
    v_cmp_ne_u64 s[50:51], v[72:73], v[68:69]
    v_cmpx_ne_u64 s[54:55], v[74:75], v[70:71]
    s_and_b64 s[82:83], s[54:55], s[80:81]
    s_cbranch_scc1 L2_c91
L2_d91:
    v_mov_b64 v[84:85], v[70:71]
    v_mov_b32 v7, v93
    v_mov_b64 v[86:87], v[74:75]
    s_or_b64 s[80:81], s[80:81], s[54:55]
    s_mov_b64 exec, s[50:51]
    s_and_b64 s[82:83], s[50:51], s[80:81]
    s_cbranch_scc1 L2_c92
L2_d92:
    v_mov_b64 v[84:85], v[68:69]
    v_mov_b32 v7, v92
    v_mov_b64 v[86:87], v[72:73]
    s_mov_b64 exec, -1
    s_or_b64 s[80:81], s[80:81], s[50:51]
    ds_read_b64 v[70:71], v95 offset:65408
    ds_read_b64 v[68:69], v94 offset:65408
    s_waitcnt vmcnt(11)
    v_and_b32 v46, 0x20000000, v33
    v_lshrrev_b32 v47, 14, v29
    v_bitop3_b32 v47, v47, v5, v46 bitop3:0xea
    ds_read_b64 v[102:103], v47
    v_bitop3_b32 v93, v29, v5, v46 bitop3:0xea
    v_and_b32 v46, 0x10000000, v33
    v_lshrrev_b32 v47, 14, v28
    v_bitop3_b32 v47, v47, v5, v46 bitop3:0xea
    ds_read_b64 v[100:101], v47
    v_bitop3_b32 v92, v28, v5, v46 bitop3:0xea
    s_waitcnt lgkmcnt(2)
    v_mfma_f32_4x4x4_16b_bf16 v[80:83], v[10:11], v[70:71], v[80:83]
    v_mfma_f32_4x4x4_16b_bf16 v[76:79], v[10:11], v[68:69], v[76:79]
    v_perm_b32 v15, v29, v32, s45
    v_bitop3_b32 v46, v29, 0.5, -0.5 bitop3:0xa8
    v_perm_b32 v14, v28, v32, s44
    v_bitop3_b32 v47, v28, 0.5, -0.5 bitop3:0xa8
    v_cvt_pk_bf16_f32 v80, v80, v81
    v_cvt_pk_bf16_f32 v81, v82, v83
    ds_wrxchg_rtn_b64 v[74:75], v95, v[80:81] offset:65408
    v_cvt_pk_bf16_f32 v76, v76, v77
    v_cvt_pk_bf16_f32 v77, v78, v79
    ds_wrxchg_rtn_b64 v[72:73], v94, v[76:77] offset:65408
    s_waitcnt lgkmcnt(2)
    v_mfma_f32_4x4x4_16b_bf16 v[80:83], v[8:9], v[102:103], 0
    v_mfma_f32_4x4x4_16b_bf16 v[76:79], v[8:9], v[100:101], 0
    v_bitop3_b32 v15, v6, v15, v46 bitop3:0xca
    v_bitop3_b32 v14, v6, v14, v47 bitop3:0xca
    v_cmp_lt_u32 s[84:85], v5, v92
    s_nop 0
    v_pk_mul_f32 v[80:81], v[80:81], v[14:15] op_sel:[0,1] op_sel_hi:[1,1]
    v_pk_mul_f32 v[82:83], v[82:83], v[14:15] op_sel:[0,1] op_sel_hi:[1,1]
    v_pk_mul_f32 v[76:77], v[76:77], v[14:15] op_sel:[0,0] op_sel_hi:[1,0]
    v_pk_mul_f32 v[78:79], v[78:79], v[14:15] op_sel:[0,0] op_sel_hi:[1,0]
    s_waitcnt lgkmcnt(0)
    v_cmp_ne_u64 s[50:51], v[72:73], v[68:69]
    v_cmpx_ne_u64 s[54:55], v[74:75], v[70:71]
    s_and_b64 s[82:83], s[54:55], s[80:81]
    s_cbranch_scc1 L2_c93
L2_d93:
    v_mov_b64 v[84:85], v[70:71]
    v_mov_b32 v7, v95
    v_mov_b64 v[86:87], v[74:75]
    s_or_b64 s[80:81], s[80:81], s[54:55]
    s_mov_b64 exec, s[50:51]
    s_and_b64 s[82:83], s[50:51], s[80:81]
    s_cbranch_scc1 L2_c94
L2_d94:
    v_mov_b64 v[84:85], v[68:69]
    v_mov_b32 v7, v94
    v_mov_b64 v[86:87], v[72:73]
    s_mov_b64 exec, -1
    s_or_b64 s[80:81], s[80:81], s[50:51]
    ds_read_b64 v[70:71], v93 offset:65408
    s_and_b64 exec, s[84:85], s[80:81]
    v_mfma_f32_4x4x4_16b_bf16 v[76:79], v[12:13], v[84:85], 0
    v_mov_b32 v92, v7
    s_andn2_b64 s[80:81], s[80:81], s[84:85]
    v_mfma_f32_4x4x4_16b_bf16 v[76:79], v[10:11], v[86:87], v[76:79]
    s_mov_b64 exec, -1
    ds_read_b64 v[68:69], v92 offset:65408
    v_and_b32 v46, 0x80000000, v33
    v_lshrrev_b32 v47, 14, v31
    v_bitop3_b32 v47, v47, v5, v46 bitop3:0xea
    ds_read_b64 v[106:107], v47
    v_bitop3_b32 v95, v31, v5, v46 bitop3:0xea
    v_and_b32 v46, 0x40000000, v33
    v_lshrrev_b32 v47, 14, v30
    v_bitop3_b32 v47, v47, v5, v46 bitop3:0xea
    ds_read_b64 v[104:105], v47
    v_bitop3_b32 v94, v30, v5, v46 bitop3:0xea
    s_waitcnt lgkmcnt(2)
    v_mfma_f32_4x4x4_16b_bf16 v[80:83], v[10:11], v[70:71], v[80:83]
    v_mfma_f32_4x4x4_16b_bf16 v[76:79], v[10:11], v[68:69], v[76:79]
    v_perm_b32 v15, v31, v32, s47
    v_bitop3_b32 v46, v31, 0.5, -0.5 bitop3:0xa8
    v_perm_b32 v14, v30, v32, s46
    v_bitop3_b32 v47, v30, 0.5, -0.5 bitop3:0xa8
    v_cvt_pk_bf16_f32 v80, v80, v81
    v_cvt_pk_bf16_f32 v81, v82, v83
    ds_wrxchg_rtn_b64 v[74:75], v93, v[80:81] offset:65408
    v_cvt_pk_bf16_f32 v76, v76, v77
    v_cvt_pk_bf16_f32 v77, v78, v79
    ds_wrxchg_rtn_b64 v[72:73], v92, v[76:77] offset:65408
    v_and_b32 v88, 0x0fffffff, v42
    v_mov_b32 v33, v42
    buffer_load_dwordx2 v[28:29], v88, s[8:11], 0 offen
    buffer_load_dwordx3 v[30:32], v88, s[8:11], 0 offen offset:8
    s_setprio 0
    s_waitcnt lgkmcnt(2)
    v_mfma_f32_4x4x4_16b_bf16 v[80:83], v[8:9], v[106:107], 0
    v_mfma_f32_4x4x4_16b_bf16 v[76:79], v[8:9], v[104:105], 0
    v_bitop3_b32 v15, v6, v15, v46 bitop3:0xca
    v_bitop3_b32 v14, v6, v14, v47 bitop3:0xca
    s_nop 1
    v_pk_mul_f32 v[80:81], v[80:81], v[14:15] op_sel:[0,1] op_sel_hi:[1,1]
    v_pk_mul_f32 v[82:83], v[82:83], v[14:15] op_sel:[0,1] op_sel_hi:[1,1]
    v_pk_mul_f32 v[76:77], v[76:77], v[14:15] op_sel:[0,0] op_sel_hi:[1,0]
    v_pk_mul_f32 v[78:79], v[78:79], v[14:15] op_sel:[0,0] op_sel_hi:[1,0]
    s_add_u32 s40, s40, 0x50000
    s_waitcnt lgkmcnt(0)
    v_cmp_ne_u64 s[50:51], v[72:73], v[68:69]
    v_cmpx_ne_u64 s[54:55], v[74:75], v[70:71]
    s_and_b64 s[82:83], s[54:55], s[80:81]
    s_cbranch_scc1 L2_c95
L2_d95:
    v_mov_b64 v[84:85], v[70:71]
    v_mov_b32 v7, v93
    v_mov_b64 v[86:87], v[74:75]
    s_or_b64 s[80:81], s[80:81], s[54:55]
    s_mov_b64 exec, s[50:51]
    s_and_b64 s[82:83], s[50:51], s[80:81]
    s_cbranch_scc1 L2_c96
L2_d96:
    v_mov_b64 v[84:85], v[68:69]
    v_mov_b32 v7, v92
    v_mov_b64 v[86:87], v[72:73]
    s_mov_b64 exec, -1
    s_or_b64 s[80:81], s[80:81], s[50:51]
    ds_read_b64 v[70:71], v95 offset:65408
    ds_read_b64 v[68:69], v94 offset:65408
    s_waitcnt vmcnt(8)
    v_and_b32 v46, 0x20000000, v39
    v_lshrrev_b32 v47, 14, v35
    v_bitop3_b32 v47, v47, v5, v46 bitop3:0xea
    ds_read_b64 v[102:103], v47
    v_bitop3_b32 v93, v35, v5, v46 bitop3:0xea
    v_and_b32 v46, 0x10000000, v39
    v_lshrrev_b32 v47, 14, v34
    v_bitop3_b32 v47, v47, v5, v46 bitop3:0xea
    ds_read_b64 v[100:101], v47
    v_bitop3_b32 v92, v34, v5, v46 bitop3:0xea
    v_and_b32 v46, 0x80000000, v39
    v_lshrrev_b32 v47, 14, v37
    v_bitop3_b32 v47, v47, v5, v46 bitop3:0xea
    ds_read_b64 v[106:107], v47
    v_and_b32 v46, 0x40000000, v39
    v_lshrrev_b32 v47, 14, v36
    v_bitop3_b32 v47, v47, v5, v46 bitop3:0xea
    ds_read_b64 v[104:105], v47
    s_waitcnt lgkmcnt(4)
    v_mfma_f32_4x4x4_16b_bf16 v[80:83], v[10:11], v[70:71], v[80:83]
    v_mfma_f32_4x4x4_16b_bf16 v[76:79], v[10:11], v[68:69], v[76:79]
    v_perm_b32 v15, v35, v38, s45
    v_bitop3_b32 v46, v35, 0.5, -0.5 bitop3:0xa8
    v_perm_b32 v14, v34, v38, s44
    v_bitop3_b32 v47, v34, 0.5, -0.5 bitop3:0xa8
    v_cvt_pk_bf16_f32 v80, v80, v81
    v_cvt_pk_bf16_f32 v81, v82, v83
    ds_wrxchg_rtn_b64 v[74:75], v95, v[80:81] offset:65408
    v_cvt_pk_bf16_f32 v76, v76, v77
    v_cvt_pk_bf16_f32 v77, v78, v79
    ds_wrxchg_rtn_b64 v[72:73], v94, v[76:77] offset:65408
    s_waitcnt lgkmcnt(2)
    s_barrier
    s_setprio 3
    s_mov_b32 m0, s100
    s_nop 0
    ds_write_addtid_b32 v116 offset:32768
    ds_write_addtid_b32 v117 offset:33024
    ds_write_addtid_b32 v118 offset:33280
    ds_write_addtid_b32 v119 offset:33536
    buffer_load_dwordx4 v[116:119], v3, s[16:19], s40 offen offset:2048
    ds_write_addtid_b32 v120 offset:33792
    ds_write_addtid_b32 v121 offset:34048
    ds_write_addtid_b32 v122 offset:34304
    ds_write_addtid_b32 v123 offset:34560
    buffer_load_dwordx4 v[120:123], v3, s[16:19], s40 offen offset:3072
    v_mfma_f32_4x4x4_16b_bf16 v[80:83], v[8:9], v[102:103], 0
    v_mfma_f32_4x4x4_16b_bf16 v[76:79], v[8:9], v[100:101], 0
    v_bitop3_b32 v15, v6, v15, v46 bitop3:0xca
    v_bitop3_b32 v14, v6, v14, v47 bitop3:0xca
    v_cmp_lt_u32 s[84:85], v5, v92
    s_nop 0
    v_pk_mul_f32 v[80:81], v[80:81], v[14:15] op_sel:[0,1] op_sel_hi:[1,1]
    v_pk_mul_f32 v[82:83], v[82:83], v[14:15] op_sel:[0,1] op_sel_hi:[1,1]
    v_pk_mul_f32 v[76:77], v[76:77], v[14:15] op_sel:[0,0] op_sel_hi:[1,0]
    v_pk_mul_f32 v[78:79], v[78:79], v[14:15] op_sel:[0,0] op_sel_hi:[1,0]
    v_mov_b32 v44, v43
    s_cmp_gt_u32 s37, 1024
    s_cbranch_scc1 L2_xs97
    s_cmp_lg_u32 s101, 0
    s_cbranch_scc1 L2_xa97
L2_xb97:
    v_lshlrev_b32 v89, 16, v96
    v_add_u32 v90, 60, v97
    v_bitop3_b32 v90, v89, v45, v90 bitop3:0x6a
    ds_write_b32 v98, v90 offset:12
    v_lshlrev_b32 v89, 20, v96
    v_add_u32 v90, 40, v97
    v_bitop3_b32 v90, v89, v45, v90 bitop3:0x6a
    ds_write_b32 v98, v90 offset:8
    v_lshlrev_b32 v89, 24, v96
    v_add_u32 v90, 20, v97
    v_bitop3_b32 v90, v89, v45, v90 bitop3:0x6a
    ds_write_b32 v98, v90 offset:4
    v_lshlrev_b32 v89, 28, v96
    v_bitop3_b32 v90, v89, v45, v97 bitop3:0x6a
    ds_write_b32 v98, v90 offset:0
    v_mov_b32_dpp v91, v64 quad_perm:[1,1,1,1] row_mask:0xf bank_mask:0xf
    v_and_b32 v89, 3, v91
    v_and_b32 v97, 0xfffc, v91
    v_sub_u16_dpp v88, v64, v91 quad_perm:[3,3,3,3] row_mask:0xf bank_mask:0xf
    v_mad_u32_u24 v97, v97, 5, v4
    v_add_u32 v99, v88, v89
    v_bfm_b32 v96, v88, v89
    v_cmp_lt_u32 s[58:59], 16, v99
    v_lshlrev_b32 v89, v1, v96
    v_and_b32 v89, v45, v89
    v_cmp_ne_u32 vcc, 0, v89
    v_xor_b32 v90, v97, v89
    s_add_u32 s3, s37, s38
    v_mbcnt_lo_u32_b32 v98, vcc_lo, 0
    v_mbcnt_hi_u32_b32 v98, vcc_hi, v98
    s_bcnt1_i32_b64 s41, vcc
    v_lshl_add_u32 v98, v98, 2, s3
    s_mov_b64 exec, vcc
    ds_write_b32 v98, v90
    s_mov_b64 exec, -1
    s_lshl2_add_u32 s37, s41, s37
    s_cmp_lg_u64 s[58:59], 0
    s_cbranch_scc1 L2_xe97
L2_xr97:
    v_add_u32 v98, s37, v0
    v_mov_b32 v90, -1
    ds_write_b32 v98, v90
    ds_read2st64_b32 v[40:41], v0 offset0:0 offset1:1
    ds_read2st64_b32 v[42:43], v0 offset0:2 offset1:3
    s_sub_u32 s3, s37, 768
    s_cmp_gt_u32 s3, 256
    s_cbranch_scc1 L2_xf97
L2_xg97:
    s_setprio 2
    ds_write_addtid_b32 v124 offset:34816
    ds_write_addtid_b32 v125 offset:35072
    ds_write_addtid_b32 v126 offset:35328
    ds_write_addtid_b32 v127 offset:35584
    s_add_u32 s3, s40, 4096
    buffer_load_dwordx4 v[124:127], v3, s[16:19], s3 offen
    s_waitcnt lgkmcnt(14)
    v_cmp_ne_u64 s[50:51], v[72:73], v[68:69]
    v_cmpx_ne_u64 s[54:55], v[74:75], v[70:71]
    s_and_b64 s[82:83], s[54:55], s[80:81]
    s_cbranch_scc1 L2_c98
L2_d98:
    v_mov_b64 v[84:85], v[70:71]
    v_mov_b32 v7, v95
    v_mov_b64 v[86:87], v[74:75]
    s_or_b64 s[80:81], s[80:81], s[54:55]
    s_mov_b64 exec, s[50:51]
    s_and_b64 s[82:83], s[50:51], s[80:81]
    s_cbranch_scc1 L2_c99
L2_d99:
    v_mov_b64 v[84:85], v[68:69]
    v_mov_b32 v7, v94
    v_mov_b64 v[86:87], v[72:73]
    s_mov_b64 exec, -1
    s_or_b64 s[80:81], s[80:81], s[50:51]
    ds_read_b64 v[70:71], v93 offset:65408
    s_and_b64 exec, s[84:85], s[80:81]
    v_mfma_f32_4x4x4_16b_bf16 v[76:79], v[12:13], v[84:85], 0
    v_mov_b32 v92, v7
    s_andn2_b64 s[80:81], s[80:81], s[84:85]
    v_mfma_f32_4x4x4_16b_bf16 v[76:79], v[10:11], v[86:87], v[76:79]
    s_mov_b64 exec, -1
    ds_read_b64 v[68:69], v92 offset:65408
    s_setprio 1
    s_waitcnt vmcnt(10)
    s_mov_b32 m0, s38
    s_nop 0
    ds_write_addtid_b32 v108 offset:0
    ds_write_addtid_b32 v109 offset:256
    ds_write_addtid_b32 v110 offset:512
    ds_write_addtid_b32 v111 offset:768
    s_waitcnt lgkmcnt(4)
    v_mfma_f32_4x4x4_16b_bf16 v[80:83], v[10:11], v[70:71], v[80:83]
    v_mfma_f32_4x4x4_16b_bf16 v[76:79], v[10:11], v[68:69], v[76:79]
    v_and_b32 v46, 0x40000000, v39
    v_bitop3_b32 v94, v36, v5, v46 bitop3:0xea
    v_and_b32 v46, 0x80000000, v39
    v_bitop3_b32 v95, v37, v5, v46 bitop3:0xea
    v_perm_b32 v15, v37, v38, s47
    v_bitop3_b32 v46, v37, 0.5, -0.5 bitop3:0xa8
    v_perm_b32 v14, v36, v38, s46
    v_bitop3_b32 v47, v36, 0.5, -0.5 bitop3:0xa8
    v_cvt_pk_bf16_f32 v80, v80, v81
    v_cvt_pk_bf16_f32 v81, v82, v83
    ds_wrxchg_rtn_b64 v[74:75], v93, v[80:81] offset:65408
    v_cvt_pk_bf16_f32 v76, v76, v77
    v_cvt_pk_bf16_f32 v77, v78, v79
    ds_wrxchg_rtn_b64 v[72:73], v92, v[76:77] offset:65408
    v_and_b32 v88, 0x0fffffff, v44
    v_mov_b32 v39, v44
    buffer_load_dwordx2 v[34:35], v88, s[8:11], 0 offen
    buffer_load_dwordx3 v[36:38], v88, s[8:11], 0 offen offset:8
    s_setprio 0
    s_waitcnt vmcnt(11)
    ds_write_addtid_b32 v112 offset:1024
    ds_write_addtid_b32 v113 offset:1280
    ds_write_addtid_b32 v114 offset:1536
    ds_write_addtid_b32 v115 offset:1792
    v_mfma_f32_4x4x4_16b_bf16 v[80:83], v[8:9], v[106:107], 0
    v_mfma_f32_4x4x4_16b_bf16 v[76:79], v[8:9], v[104:105], 0
    v_bitop3_b32 v15, v6, v15, v46 bitop3:0xca
    v_bitop3_b32 v14, v6, v14, v47 bitop3:0xca
    s_nop 1
    v_pk_mul_f32 v[80:81], v[80:81], v[14:15] op_sel:[0,1] op_sel_hi:[1,1]
    v_pk_mul_f32 v[82:83], v[82:83], v[14:15] op_sel:[0,1] op_sel_hi:[1,1]
    v_pk_mul_f32 v[76:77], v[76:77], v[14:15] op_sel:[0,0] op_sel_hi:[1,0]
    v_pk_mul_f32 v[78:79], v[78:79], v[14:15] op_sel:[0,0] op_sel_hi:[1,0]
    s_add_u32 s42, s42, 1
    s_waitcnt lgkmcnt(0)
    s_barrier
    s_bitcmp1_b32 s36, s42
    s_cbranch_scc1 L2_slow
L2_ret5:
    s_setprio 3
    buffer_load_dwordx4 v[108:111], v3, s[16:19], s40 offen offset:0
    v_cmp_ne_u64 s[50:51], v[72:73], v[68:69]
    v_cmpx_ne_u64 s[54:55], v[74:75], v[70:71]
    s_and_b64 s[82:83], s[54:55], s[80:81]
    s_cbranch_scc1 L2_c100
L2_d100:
    v_mov_b64 v[84:85], v[70:71]
    v_mov_b32 v7, v93
    v_mov_b64 v[86:87], v[74:75]
    s_or_b64 s[80:81], s[80:81], s[54:55]
    s_mov_b64 exec, s[50:51]
    s_and_b64 s[82:83], s[50:51], s[80:81]
    s_cbranch_scc1 L2_c101
L2_d101:
    v_mov_b64 v[84:85], v[68:69]
    v_mov_b32 v7, v92
    v_mov_b64 v[86:87], v[72:73]
    s_mov_b64 exec, -1
    s_or_b64 s[80:81], s[80:81], s[50:51]
    ds_read_b64 v[70:71], v95 offset:65408
    ds_read_b64 v[68:69], v94 offset:65408
    s_waitcnt vmcnt(10)
    v_and_b32 v46, 0x20000000, v21
    v_lshrrev_b32 v47, 14, v17
    v_bitop3_b32 v47, v47, v5, v46 bitop3:0xea
    ds_read_b64 v[102:103], v47
    v_bitop3_b32 v93, v17, v5, v46 bitop3:0xea
    v_and_b32 v46, 0x10000000, v21
    v_lshrrev_b32 v47, 14, v16
    v_bitop3_b32 v47, v47, v5, v46 bitop3:0xea
    ds_read_b64 v[100:101], v47
    v_bitop3_b32 v92, v16, v5, v46 bitop3:0xea
    s_waitcnt lgkmcnt(2)
    v_mfma_f32_4x4x4_16b_bf16 v[80:83], v[10:11], v[70:71], v[80:83]
    v_mfma_f32_4x4x4_16b_bf16 v[76:79], v[10:11], v[68:69], v[76:79]
    v_perm_b32 v15, v17, v20, s45
    v_bitop3_b32 v46, v17, 0.5, -0.5 bitop3:0xa8
    v_perm_b32 v14, v16, v20, s44
    v_bitop3_b32 v47, v16, 0.5, -0.5 bitop3:0xa8
    v_cvt_pk_bf16_f32 v80, v80, v81
    v_cvt_pk_bf16_f32 v81, v82, v83
    ds_wrxchg_rtn_b64 v[74:75], v95, v[80:81] offset:65408
    v_cvt_pk_bf16_f32 v76, v76, v77
    v_cvt_pk_bf16_f32 v77, v78, v79
    ds_wrxchg_rtn_b64 v[72:73], v94, v[76:77] offset:65408
    s_waitcnt lgkmcnt(2)
    v_mfma_f32_4x4x4_16b_bf16 v[80:83], v[8:9], v[102:103], 0
    v_mfma_f32_4x4x4_16b_bf16 v[76:79], v[8:9], v[100:101], 0
    v_bitop3_b32 v15, v6, v15, v46 bitop3:0xca
    v_bitop3_b32 v14, v6, v14, v47 bitop3:0xca
    v_cmp_lt_u32 s[84:85], v5, v92
    s_nop 0
    v_pk_mul_f32 v[80:81], v[80:81], v[14:15] op_sel:[0,1] op_sel_hi:[1,1]
    v_pk_mul_f32 v[82:83], v[82:83], v[14:15] op_sel:[0,1] op_sel_hi:[1,1]
    v_pk_mul_f32 v[76:77], v[76:77], v[14:15] op_sel:[0,0] op_sel_hi:[1,0]
    v_pk_mul_f32 v[78:79], v[78:79], v[14:15] op_sel:[0,0] op_sel_hi:[1,0]
    buffer_load_dwordx4 v[112:115], v3, s[16:19], s40 offen offset:1024
    s_waitcnt lgkmcnt(0)
    v_cmp_ne_u64 s[50:51], v[72:73], v[68:69]
    v_cmpx_ne_u64 s[54:55], v[74:75], v[70:71]
    s_and_b64 s[82:83], s[54:55], s[80:81]
    s_cbranch_scc1 L2_c102
L2_d102:
    v_mov_b64 v[84:85], v[70:71]
    v_mov_b32 v7, v95
    v_mov_b64 v[86:87], v[74:75]
    s_or_b64 s[80:81], s[80:81], s[54:55]
    s_mov_b64 exec, s[50:51]
    s_and_b64 s[82:83], s[50:51], s[80:81]
    s_cbranch_scc1 L2_c103
L2_d103:
    v_mov_b64 v[84:85], v[68:69]
    v_mov_b32 v7, v94
    v_mov_b64 v[86:87], v[72:73]
    s_mov_b64 exec, -1
    s_or_b64 s[80:81], s[80:81], s[50:51]
    ds_read_b64 v[70:71], v93 offset:65408
    s_and_b64 exec, s[84:85], s[80:81]
    v_mfma_f32_4x4x4_16b_bf16 v[76:79], v[12:13], v[84:85], 0
    v_mov_b32 v92, v7
    s_andn2_b64 s[80:81], s[80:81], s[84:85]
    v_mfma_f32_4x4x4_16b_bf16 v[76:79], v[10:11], v[86:87], v[76:79]
    s_mov_b64 exec, -1
    ds_read_b64 v[68:69], v92 offset:65408
    v_and_b32 v46, 0x80000000, v21
    v_lshrrev_b32 v47, 14, v19
    v_bitop3_b32 v47, v47, v5, v46 bitop3:0xea
    ds_read_b64 v[106:107], v47
    v_bitop3_b32 v95, v19, v5, v46 bitop3:0xea
    v_and_b32 v46, 0x40000000, v21
    v_lshrrev_b32 v47, 14, v18
    v_bitop3_b32 v47, v47, v5, v46 bitop3:0xea
    ds_read_b64 v[104:105], v47
    v_bitop3_b32 v94, v18, v5, v46 bitop3:0xea
    s_waitcnt lgkmcnt(2)
    v_mfma_f32_4x4x4_16b_bf16 v[80:83], v[10:11], v[70:71], v[80:83]
    v_mfma_f32_4x4x4_16b_bf16 v[76:79], v[10:11], v[68:69], v[76:79]
    v_perm_b32 v15, v19, v20, s47
    v_bitop3_b32 v46, v19, 0.5, -0.5 bitop3:0xa8
    v_perm_b32 v14, v18, v20, s46
    v_bitop3_b32 v47, v18, 0.5, -0.5 bitop3:0xa8
    v_cvt_pk_bf16_f32 v80, v80, v81
    v_cvt_pk_bf16_f32 v81, v82, v83
    ds_wrxchg_rtn_b64 v[74:75], v93, v[80:81] offset:65408
    v_cvt_pk_bf16_f32 v76, v76, v77
    v_cvt_pk_bf16_f32 v77, v78, v79
    ds_wrxchg_rtn_b64 v[72:73], v92, v[76:77] offset:65408
    v_and_b32 v88, 0x0fffffff, v40
    v_mov_b32 v21, v40
    buffer_load_dwordx2 v[16:17], v88, s[8:11], 0 offen
    buffer_load_dwordx3 v[18:20], v88, s[8:11], 0 offen offset:8
    s_setprio 2
    s_waitcnt lgkmcnt(2)
    v_mfma_f32_4x4x4_16b_bf16 v[80:83], v[8:9], v[106:107], 0
    v_mfma_f32_4x4x4_16b_bf16 v[76:79], v[8:9], v[104:105], 0
    v_bitop3_b32 v15, v6, v15, v46 bitop3:0xca
    v_bitop3_b32 v14, v6, v14, v47 bitop3:0xca
    s_nop 1
    v_pk_mul_f32 v[80:81], v[80:81], v[14:15] op_sel:[0,1] op_sel_hi:[1,1]
    v_pk_mul_f32 v[82:83], v[82:83], v[14:15] op_sel:[0,1] op_sel_hi:[1,1]
    v_pk_mul_f32 v[76:77], v[76:77], v[14:15] op_sel:[0,0] op_sel_hi:[1,0]
    v_pk_mul_f32 v[78:79], v[78:79], v[14:15] op_sel:[0,0] op_sel_hi:[1,0]
    v_sub_u16 v88, v62, v54
    v_and_b32 v89, 3, v54
    v_add3_u32 v99, v88, v89, 3
    v_and_b32 v99, -4, v99
    v_max_u32 v99, 4, v99
    v_and_b32 v97, 0xfffc, v54
    v_bfm_b32 v96, v88, v89
    v_add_u32_dpp v91, v99, v99 row_shr:1 row_mask:0xf bank_mask:0xf bound_ctrl:1
    v_mad_u32_u24 v97, v97, 5, v2
    v_cmp_lt_u32 vcc, 16, v99
    v_add_u32_dpp v91, v91, v91 row_shr:2 row_mask:0xf bank_mask:0xf bound_ctrl:1
    v_sub_u32 v98, s38, v99
    v_lshrrev_b64 v[54:55], 16, v[54:55]
    v_add_u32_dpp v91, v91, v91 row_shr:4 row_mask:0xf bank_mask:0xf bound_ctrl:1
    v_lshrrev_b64 v[62:63], 16, v[62:63]
    s_mov_b32 s101, 0
    v_add_u32_dpp v91, v91, v91 row_shr:8 row_mask:0xf bank_mask:0xf bound_ctrl:1
    s_nop 1
    v_add_u32_dpp v91, v91, v91 row_bcast:15 row_mask:0xa bank_mask:0xf
    s_nop 1
    v_add_u32_dpp v91, v91, v91 row_bcast:31 row_mask:0xc bank_mask:0xf
    v_add_u32 v98, v98, v91
    v_readlane_b32 s37, v91, 63
    s_cbranch_vccnz L2_xo104
L2_xp104:
    s_waitcnt lgkmcnt(0)
    v_cmp_ne_u64 s[50:51], v[72:73], v[68:69]
    v_cmpx_ne_u64 s[54:55], v[74:75], v[70:71]
    s_and_b64 s[82:83], s[54:55], s[80:81]
    s_cbranch_scc1 L2_c105
L2_d105:
    v_mov_b64 v[84:85], v[70:71]
    v_mov_b32 v7, v93
    v_mov_b64 v[86:87], v[74:75]
    s_or_b64 s[80:81], s[80:81], s[54:55]
    s_mov_b64 exec, s[50:51]
    s_and_b64 s[82:83], s[50:51], s[80:81]
    s_cbranch_scc1 L2_c106
L2_d106:
    v_mov_b64 v[84:85], v[68:69]
    v_mov_b32 v7, v92
    v_mov_b64 v[86:87], v[72:73]
    s_mov_b64 exec, -1
    s_or_b64 s[80:81], s[80:81], s[50:51]
    ds_read_b64 v[70:71], v95 offset:65408
    ds_read_b64 v[68:69], v94 offset:65408
    s_waitcnt vmcnt(11)
    v_and_b32 v46, 0x20000000, v27
    v_lshrrev_b32 v47, 14, v23
    v_bitop3_b32 v47, v47, v5, v46 bitop3:0xea
    ds_read_b64 v[102:103], v47
    v_bitop3_b32 v93, v23, v5, v46 bitop3:0xea
    v_and_b32 v46, 0x10000000, v27
    v_lshrrev_b32 v47, 14, v22
    v_bitop3_b32 v47, v47, v5, v46 bitop3:0xea
    ds_read_b64 v[100:101], v47
    v_bitop3_b32 v92, v22, v5, v46 bitop3:0xea
    s_waitcnt lgkmcnt(2)
    v_mfma_f32_4x4x4_16b_bf16 v[80:83], v[10:11], v[70:71], v[80:83]
    v_mfma_f32_4x4x4_16b_bf16 v[76:79], v[10:11], v[68:69], v[76:79]
    v_perm_b32 v15, v23, v26, s45
    v_bitop3_b32 v46, v23, 0.5, -0.5 bitop3:0xa8
    v_perm_b32 v14, v22, v26, s44
    v_bitop3_b32 v47, v22, 0.5, -0.5 bitop3:0xa8
    v_cvt_pk_bf16_f32 v80, v80, v81
    v_cvt_pk_bf16_f32 v81, v82, v83
    ds_wrxchg_rtn_b64 v[74:75], v95, v[80:81] offset:65408
    v_cvt_pk_bf16_f32 v76, v76, v77
    v_cvt_pk_bf16_f32 v77, v78, v79
    ds_wrxchg_rtn_b64 v[72:73], v94, v[76:77] offset:65408
    s_waitcnt lgkmcnt(2)
    v_mfma_f32_4x4x4_16b_bf16 v[80:83], v[8:9], v[102:103], 0
    v_mfma_f32_4x4x4_16b_bf16 v[76:79], v[8:9], v[100:101], 0
    v_bitop3_b32 v15, v6, v15, v46 bitop3:0xca
    v_bitop3_b32 v14, v6, v14, v47 bitop3:0xca
    v_cmp_lt_u32 s[84:85], v5, v92
    s_nop 0
    v_pk_mul_f32 v[80:81], v[80:81], v[14:15] op_sel:[0,1] op_sel_hi:[1,1]
    v_pk_mul_f32 v[82:83], v[82:83], v[14:15] op_sel:[0,1] op_sel_hi:[1,1]
    v_pk_mul_f32 v[76:77], v[76:77], v[14:15] op_sel:[0,0] op_sel_hi:[1,0]
    v_pk_mul_f32 v[78:79], v[78:79], v[14:15] op_sel:[0,0] op_sel_hi:[1,0]
    s_waitcnt lgkmcnt(0)
    v_cmp_ne_u64 s[50:51], v[72:73], v[68:69]
    v_cmpx_ne_u64 s[54:55], v[74:75], v[70:71]
    s_and_b64 s[82:83], s[54:55], s[80:81]
    s_cbranch_scc1 L2_c107
L2_d107:
    v_mov_b64 v[84:85], v[70:71]
    v_mov_b32 v7, v95
    v_mov_b64 v[86:87], v[74:75]
    s_or_b64 s[80:81], s[80:81], s[54:55]
    s_mov_b64 exec, s[50:51]
    s_and_b64 s[82:83], s[50:51], s[80:81]
    s_cbranch_scc1 L2_c108
L2_d108:
    v_mov_b64 v[84:85], v[68:69]
    v_mov_b32 v7, v94
    v_mov_b64 v[86:87], v[72:73]
    s_mov_b64 exec, -1
    s_or_b64 s[80:81], s[80:81], s[50:51]
    ds_read_b64 v[70:71], v93 offset:65408
    s_and_b64 exec, s[84:85], s[80:81]
    v_mfma_f32_4x4x4_16b_bf16 v[76:79], v[12:13], v[84:85], 0
    v_mov_b32 v92, v7
    s_andn2_b64 s[80:81], s[80:81], s[84:85]
    v_mfma_f32_4x4x4_16b_bf16 v[76:79], v[10:11], v[86:87], v[76:79]
    s_mov_b64 exec, -1
    ds_read_b64 v[68:69], v92 offset:65408
    v_and_b32 v46, 0x80000000, v27
    v_lshrrev_b32 v47, 14, v25
    v_bitop3_b32 v47, v47, v5, v46 bitop3:0xea
    ds_read_b64 v[106:107], v47
    v_bitop3_b32 v95, v25, v5, v46 bitop3:0xea
    v_and_b32 v46, 0x40000000, v27
    v_lshrrev_b32 v47, 14, v24
    v_bitop3_b32 v47, v47, v5, v46 bitop3:0xea
    ds_read_b64 v[104:105], v47
    v_bitop3_b32 v94, v24, v5, v46 bitop3:0xea
    s_waitcnt lgkmcnt(2)
    v_mfma_f32_4x4x4_16b_bf16 v[80:83], v[10:11], v[70:71], v[80:83]
    v_mfma_f32_4x4x4_16b_bf16 v[76:79], v[10:11], v[68:69], v[76:79]
    v_perm_b32 v15, v25, v26, s47
    v_bitop3_b32 v46, v25, 0.5, -0.5 bitop3:0xa8
    v_perm_b32 v14, v24, v26, s46
    v_bitop3_b32 v47, v24, 0.5, -0.5 bitop3:0xa8
    v_cvt_pk_bf16_f32 v80, v80, v81
    v_cvt_pk_bf16_f32 v81, v82, v83
    ds_wrxchg_rtn_b64 v[74:75], v93, v[80:81] offset:65408
    v_cvt_pk_bf16_f32 v76, v76, v77
    v_cvt_pk_bf16_f32 v77, v78, v79
    ds_wrxchg_rtn_b64 v[72:73], v92, v[76:77] offset:65408
    v_and_b32 v88, 0x0fffffff, v41
    v_mov_b32 v27, v41
    buffer_load_dwordx2 v[22:23], v88, s[8:11], 0 offen
    buffer_load_dwordx3 v[24:26], v88, s[8:11], 0 offen offset:8
    s_setprio 1
    s_waitcnt lgkmcnt(2)
    v_mfma_f32_4x4x4_16b_bf16 v[80:83], v[8:9], v[106:107], 0
    v_mfma_f32_4x4x4_16b_bf16 v[76:79], v[8:9], v[104:105], 0
    v_bitop3_b32 v15, v6, v15, v46 bitop3:0xca
    v_bitop3_b32 v14, v6, v14, v47 bitop3:0xca
    s_nop 1
    v_pk_mul_f32 v[80:81], v[80:81], v[14:15] op_sel:[0,1] op_sel_hi:[1,1]
    v_pk_mul_f32 v[82:83], v[82:83], v[14:15] op_sel:[0,1] op_sel_hi:[1,1]
    v_pk_mul_f32 v[76:77], v[76:77], v[14:15] op_sel:[0,0] op_sel_hi:[1,0]
    v_pk_mul_f32 v[78:79], v[78:79], v[14:15] op_sel:[0,0] op_sel_hi:[1,0]
    s_waitcnt lgkmcnt(0)
    v_cmp_ne_u64 s[50:51], v[72:73], v[68:69]
    v_cmpx_ne_u64 s[54:55], v[74:75], v[70:71]
    s_and_b64 s[82:83], s[54:55], s[80:81]
    s_cbranch_scc1 L2_c109
L2_d109:
    v_mov_b64 v[84:85], v[70:71]
    v_mov_b32 v7, v93
    v_mov_b64 v[86:87], v[74:75]
    s_or_b64 s[80:81], s[80:81], s[54:55]
    s_mov_b64 exec, s[50:51]
    s_and_b64 s[82:83], s[50:51], s[80:81]
    s_cbranch_scc1 L2_c110
L2_d110:
    v_mov_b64 v[84:85], v[68:69]
    v_mov_b32 v7, v92
    v_mov_b64 v[86:87], v[72:73]
    s_mov_b64 exec, -1
    s_or_b64 s[80:81], s[80:81], s[50:51]
    ds_read_b64 v[70:71], v95 offset:65408
    ds_read_b64 v[68:69], v94 offset:65408
    s_waitcnt vmcnt(11)
    v_and_b32 v46, 0x20000000, v33
    v_lshrrev_b32 v47, 14, v29
    v_bitop3_b32 v47, v47, v5, v46 bitop3:0xea
    ds_read_b64 v[102:103], v47
    v_bitop3_b32 v93, v29, v5, v46 bitop3:0xea
    v_and_b32 v46, 0x10000000, v33
    v_lshrrev_b32 v47, 14, v28
    v_bitop3_b32 v47, v47, v5, v46 bitop3:0xea
    ds_read_b64 v[100:101], v47
    v_bitop3_b32 v92, v28, v5, v46 bitop3:0xea
    s_waitcnt lgkmcnt(2)
    v_mfma_f32_4x4x4_16b_bf16 v[80:83], v[10:11], v[70:71], v[80:83]
    v_mfma_f32_4x4x4_16b_bf16 v[76:79], v[10:11], v[68:69], v[76:79]
    v_perm_b32 v15, v29, v32, s45
    v_bitop3_b32 v46, v29, 0.5, -0.5 bitop3:0xa8
    v_perm_b32 v14, v28, v32, s44
    v_bitop3_b32 v47, v28, 0.5, -0.5 bitop3:0xa8
    v_cvt_pk_bf16_f32 v80, v80, v81
    v_cvt_pk_bf16_f32 v81, v82, v83
    ds_wrxchg_rtn_b64 v[74:75], v95, v[80:81] offset:65408
    v_cvt_pk_bf16_f32 v76, v76, v77
    v_cvt_pk_bf16_f32 v77, v78, v79
    ds_wrxchg_rtn_b64 v[72:73], v94, v[76:77] offset:65408
    s_waitcnt lgkmcnt(2)
    v_mfma_f32_4x4x4_16b_bf16 v[80:83], v[8:9], v[102:103], 0
    v_mfma_f32_4x4x4_16b_bf16 v[76:79], v[8:9], v[100:101], 0
    v_bitop3_b32 v15, v6, v15, v46 bitop3:0xca
    v_bitop3_b32 v14, v6, v14, v47 bitop3:0xca
    v_cmp_lt_u32 s[84:85], v5, v92
    s_nop 0
    v_pk_mul_f32 v[80:81], v[80:81], v[14:15] op_sel:[0,1] op_sel_hi:[1,1]
    v_pk_mul_f32 v[82:83], v[82:83], v[14:15] op_sel:[0,1] op_sel_hi:[1,1]
    v_pk_mul_f32 v[76:77], v[76:77], v[14:15] op_sel:[0,0] op_sel_hi:[1,0]
    v_pk_mul_f32 v[78:79], v[78:79], v[14:15] op_sel:[0,0] op_sel_hi:[1,0]
    s_waitcnt lgkmcnt(0)
    v_cmp_ne_u64 s[50:51], v[72:73], v[68:69]
    v_cmpx_ne_u64 s[54:55], v[74:75], v[70:71]
    s_and_b64 s[82:83], s[54:55], s[80:81]
    s_cbranch_scc1 L2_c111
L2_d111:
    v_mov_b64 v[84:85], v[70:71]
    v_mov_b32 v7, v95
    v_mov_b64 v[86:87], v[74:75]
    s_or_b64 s[80:81], s[80:81], s[54:55]
    s_mov_b64 exec, s[50:51]
    s_and_b64 s[82:83], s[50:51], s[80:81]
    s_cbranch_scc1 L2_c112
L2_d112:
    v_mov_b64 v[84:85], v[68:69]
    v_mov_b32 v7, v94
    v_mov_b64 v[86:87], v[72:73]
    s_mov_b64 exec, -1
    s_or_b64 s[80:81], s[80:81], s[50:51]
    ds_read_b64 v[70:71], v93 offset:65408
    s_and_b64 exec, s[84:85], s[80:81]
    v_mfma_f32_4x4x4_16b_bf16 v[76:79], v[12:13], v[84:85], 0
    v_mov_b32 v92, v7
    s_andn2_b64 s[80:81], s[80:81], s[84:85]
    v_mfma_f32_4x4x4_16b_bf16 v[76:79], v[10:11], v[86:87], v[76:79]
    s_mov_b64 exec, -1
    ds_read_b64 v[68:69], v92 offset:65408
    v_and_b32 v46, 0x80000000, v33
    v_lshrrev_b32 v47, 14, v31
    v_bitop3_b32 v47, v47, v5, v46 bitop3:0xea
    ds_read_b64 v[106:107], v47
    v_bitop3_b32 v95, v31, v5, v46 bitop3:0xea
    v_and_b32 v46, 0x40000000, v33
    v_lshrrev_b32 v47, 14, v30
    v_bitop3_b32 v47, v47, v5, v46 bitop3:0xea
    ds_read_b64 v[104:105], v47
    v_bitop3_b32 v94, v30, v5, v46 bitop3:0xea
    s_waitcnt lgkmcnt(2)
    v_mfma_f32_4x4x4_16b_bf16 v[80:83], v[10:11], v[70:71], v[80:83]
    v_mfma_f32_4x4x4_16b_bf16 v[76:79], v[10:11], v[68:69], v[76:79]
    v_perm_b32 v15, v31, v32, s47
    v_bitop3_b32 v46, v31, 0.5, -0.5 bitop3:0xa8
    v_perm_b32 v14, v30, v32, s46
    v_bitop3_b32 v47, v30, 0.5, -0.5 bitop3:0xa8
    v_cvt_pk_bf16_f32 v80, v80, v81
    v_cvt_pk_bf16_f32 v81, v82, v83
    ds_wrxchg_rtn_b64 v[74:75], v93, v[80:81] offset:65408
    v_cvt_pk_bf16_f32 v76, v76, v77
    v_cvt_pk_bf16_f32 v77, v78, v79
    ds_wrxchg_rtn_b64 v[72:73], v92, v[76:77] offset:65408
    v_and_b32 v88, 0x0fffffff, v42
    v_mov_b32 v33, v42
    buffer_load_dwordx2 v[28:29], v88, s[8:11], 0 offen
    buffer_load_dwordx3 v[30:32], v88, s[8:11], 0 offen offset:8
    s_setprio 0
    s_waitcnt lgkmcnt(2)
    v_mfma_f32_4x4x4_16b_bf16 v[80:83], v[8:9], v[106:107], 0
    v_mfma_f32_4x4x4_16b_bf16 v[76:79], v[8:9], v[104:105], 0
    v_bitop3_b32 v15, v6, v15, v46 bitop3:0xca
    v_bitop3_b32 v14, v6, v14, v47 bitop3:0xca
    s_nop 1
    v_pk_mul_f32 v[80:81], v[80:81], v[14:15] op_sel:[0,1] op_sel_hi:[1,1]
    v_pk_mul_f32 v[82:83], v[82:83], v[14:15] op_sel:[0,1] op_sel_hi:[1,1]
    v_pk_mul_f32 v[76:77], v[76:77], v[14:15] op_sel:[0,0] op_sel_hi:[1,0]
    v_pk_mul_f32 v[78:79], v[78:79], v[14:15] op_sel:[0,0] op_sel_hi:[1,0]
    s_add_u32 s40, s40, 0x50000
    s_waitcnt lgkmcnt(0)
    v_cmp_ne_u64 s[50:51], v[72:73], v[68:69]
    v_cmpx_ne_u64 s[54:55], v[74:75], v[70:71]
    s_and_b64 s[82:83], s[54:55], s[80:81]
    s_cbranch_scc1 L2_c113
L2_d113:
    v_mov_b64 v[84:85], v[70:71]
    v_mov_b32 v7, v93
    v_mov_b64 v[86:87], v[74:75]
    s_or_b64 s[80:81], s[80:81], s[54:55]
    s_mov_b64 exec, s[50:51]
    s_and_b64 s[82:83], s[50:51], s[80:81]
    s_cbranch_scc1 L2_c114
L2_d114:
    v_mov_b64 v[84:85], v[68:69]
    v_mov_b32 v7, v92
    v_mov_b64 v[86:87], v[72:73]
    s_mov_b64 exec, -1
    s_or_b64 s[80:81], s[80:81], s[50:51]
    ds_read_b64 v[70:71], v95 offset:65408
    ds_read_b64 v[68:69], v94 offset:65408
    s_waitcnt vmcnt(8)
    v_and_b32 v46, 0x20000000, v39
    v_lshrrev_b32 v47, 14, v35
    v_bitop3_b32 v47, v47, v5, v46 bitop3:0xea
    ds_read_b64 v[102:103], v47
    v_bitop3_b32 v93, v35, v5, v46 bitop3:0xea
    v_and_b32 v46, 0x10000000, v39
    v_lshrrev_b32 v47, 14, v34
    v_bitop3_b32 v47, v47, v5, v46 bitop3:0xea
    ds_read_b64 v[100:101], v47
    v_bitop3_b32 v92, v34, v5, v46 bitop3:0xea
    v_and_b32 v46, 0x80000000, v39
    v_lshrrev_b32 v47, 14, v37
    v_bitop3_b32 v47, v47, v5, v46 bitop3:0xea
    ds_read_b64 v[106:107], v47
    v_and_b32 v46, 0x40000000, v39
    v_lshrrev_b32 v47, 14, v36
    v_bitop3_b32 v47, v47, v5, v46 bitop3:0xea
    ds_read_b64 v[104:105], v47
    s_waitcnt lgkmcnt(4)
    v_mfma_f32_4x4x4_16b_bf16 v[80:83], v[10:11], v[70:71], v[80:83]
    v_mfma_f32_4x4x4_16b_bf16 v[76:79], v[10:11], v[68:69], v[76:79]
    v_perm_b32 v15, v35, v38, s45
    v_bitop3_b32 v46, v35, 0.5, -0.5 bitop3:0xa8
    v_perm_b32 v14, v34, v38, s44
    v_bitop3_b32 v47, v34, 0.5, -0.5 bitop3:0xa8
    v_cvt_pk_bf16_f32 v80, v80, v81
    v_cvt_pk_bf16_f32 v81, v82, v83
    ds_wrxchg_rtn_b64 v[74:75], v95, v[80:81] offset:65408
    v_cvt_pk_bf16_f32 v76, v76, v77
    v_cvt_pk_bf16_f32 v77, v78, v79
    ds_wrxchg_rtn_b64 v[72:73], v94, v[76:77] offset:65408
    s_waitcnt lgkmcnt(2)
    s_barrier
    s_setprio 3
    s_mov_b32 m0, s100
    s_nop 0
    ds_write_addtid_b32 v116 offset:32768
    ds_write_addtid_b32 v117 offset:33024
    ds_write_addtid_b32 v118 offset:33280
    ds_write_addtid_b32 v119 offset:33536
    buffer_load_dwordx4 v[116:119], v3, s[16:19], s40 offen offset:2048
    ds_write_addtid_b32 v120 offset:33792
    ds_write_addtid_b32 v121 offset:34048
    ds_write_addtid_b32 v122 offset:34304
    ds_write_addtid_b32 v123 offset:34560
    buffer_load_dwordx4 v[120:123], v3, s[16:19], s40 offen offset:3072
    v_mfma_f32_4x4x4_16b_bf16 v[80:83], v[8:9], v[102:103], 0
    v_mfma_f32_4x4x4_16b_bf16 v[76:79], v[8:9], v[100:101], 0
    v_bitop3_b32 v15, v6, v15, v46 bitop3:0xca
    v_bitop3_b32 v14, v6, v14, v47 bitop3:0xca
    v_cmp_lt_u32 s[84:85], v5, v92
    s_nop 0
    v_pk_mul_f32 v[80:81], v[80:81], v[14:15] op_sel:[0,1] op_sel_hi:[1,1]
    v_pk_mul_f32 v[82:83], v[82:83], v[14:15] op_sel:[0,1] op_sel_hi:[1,1]
    v_pk_mul_f32 v[76:77], v[76:77], v[14:15] op_sel:[0,0] op_sel_hi:[1,0]
    v_pk_mul_f32 v[78:79], v[78:79], v[14:15] op_sel:[0,0] op_sel_hi:[1,0]
    v_mov_b32 v44, v43
    s_cmp_gt_u32 s37, 1024
    s_cbranch_scc1 L2_xs115
    s_cmp_lg_u32 s101, 0
    s_cbranch_scc1 L2_xa115
L2_xb115:
    v_lshlrev_b32 v89, 16, v96
    v_add_u32 v90, 60, v97
    v_bitop3_b32 v90, v89, v45, v90 bitop3:0x6a
    ds_write_b32 v98, v90 offset:12
    v_lshlrev_b32 v89, 20, v96
    v_add_u32 v90, 40, v97
    v_bitop3_b32 v90, v89, v45, v90 bitop3:0x6a
    ds_write_b32 v98, v90 offset:8
    v_lshlrev_b32 v89, 24, v96
    v_add_u32 v90, 20, v97
    v_bitop3_b32 v90, v89, v45, v90 bitop3:0x6a
    ds_write_b32 v98, v90 offset:4
    v_lshlrev_b32 v89, 28, v96
    v_bitop3_b32 v90, v89, v45, v97 bitop3:0x6a
    ds_write_b32 v98, v90 offset:0
    v_mov_b32_dpp v91, v66 quad_perm:[1,1,1,1] row_mask:0xf bank_mask:0xf
    v_and_b32 v89, 3, v91
    v_and_b32 v97, 0xfffc, v91
    v_sub_u16_dpp v88, v66, v91 quad_perm:[3,3,3,3] row_mask:0xf bank_mask:0xf
    v_mad_u32_u24 v97, v97, 5, v4
    v_add_u32 v99, v88, v89
    v_bfm_b32 v96, v88, v89
    v_cmp_lt_u32 s[58:59], 16, v99
    v_lshlrev_b32 v89, v1, v96
    v_and_b32 v89, v45, v89
    v_cmp_ne_u32 vcc, 0, v89
    v_xor_b32 v90, v97, v89
    s_add_u32 s3, s37, s38
    v_mbcnt_lo_u32_b32 v98, vcc_lo, 0
    v_mbcnt_hi_u32_b32 v98, vcc_hi, v98
    s_bcnt1_i32_b64 s41, vcc
    v_lshl_add_u32 v98, v98, 2, s3
    s_mov_b64 exec, vcc
    ds_write_b32 v98, v90
    s_mov_b64 exec, -1
    s_lshl2_add_u32 s37, s41, s37
    s_cmp_lg_u64 s[58:59], 0
    s_cbranch_scc1 L2_xe115
L2_xr115:
    v_add_u32 v98, s37, v0
    v_mov_b32 v90, -1
    ds_write_b32 v98, v90
    ds_read2st64_b32 v[40:41], v0 offset0:0 offset1:1
    ds_read2st64_b32 v[42:43], v0 offset0:2 offset1:3
    s_sub_u32 s3, s37, 768
    s_cmp_gt_u32 s3, 256
    s_cbranch_scc1 L2_xf115
L2_xg115:
    v_lshrrev_b64 v[64:65], 16, v[64:65]
    v_lshrrev_b64 v[66:67], 16, v[66:67]
    s_setprio 2
    ds_write_addtid_b32 v124 offset:34816
    ds_write_addtid_b32 v125 offset:35072
    ds_write_addtid_b32 v126 offset:35328
    ds_write_addtid_b32 v127 offset:35584
    s_add_u32 s3, s40, 4096
    buffer_load_dwordx4 v[124:127], v3, s[16:19], s3 offen
    s_waitcnt lgkmcnt(14)
    v_cmp_ne_u64 s[50:51], v[72:73], v[68:69]
    v_cmpx_ne_u64 s[54:55], v[74:75], v[70:71]
    s_and_b64 s[82:83], s[54:55], s[80:81]
    s_cbranch_scc1 L2_c116
L2_d116:
    v_mov_b64 v[84:85], v[70:71]
    v_mov_b32 v7, v95
    v_mov_b64 v[86:87], v[74:75]
    s_or_b64 s[80:81], s[80:81], s[54:55]
    s_mov_b64 exec, s[50:51]
    s_and_b64 s[82:83], s[50:51], s[80:81]
    s_cbranch_scc1 L2_c117
L2_d117:
    v_mov_b64 v[84:85], v[68:69]
    v_mov_b32 v7, v94
    v_mov_b64 v[86:87], v[72:73]
    s_mov_b64 exec, -1
    s_or_b64 s[80:81], s[80:81], s[50:51]
    ds_read_b64 v[70:71], v93 offset:65408
    s_and_b64 exec, s[84:85], s[80:81]
    v_mfma_f32_4x4x4_16b_bf16 v[76:79], v[12:13], v[84:85], 0
    v_mov_b32 v92, v7
    s_andn2_b64 s[80:81], s[80:81], s[84:85]
    v_mfma_f32_4x4x4_16b_bf16 v[76:79], v[10:11], v[86:87], v[76:79]
    s_mov_b64 exec, -1
    ds_read_b64 v[68:69], v92 offset:65408
    s_setprio 1
    s_waitcnt vmcnt(10)
    s_mov_b32 m0, s38
    s_nop 0
    ds_write_addtid_b32 v108 offset:0
    ds_write_addtid_b32 v109 offset:256
    ds_write_addtid_b32 v110 offset:512
    ds_write_addtid_b32 v111 offset:768
    s_waitcnt lgkmcnt(4)
    v_mfma_f32_4x4x4_16b_bf16 v[80:83], v[10:11], v[70:71], v[80:83]
    v_mfma_f32_4x4x4_16b_bf16 v[76:79], v[10:11], v[68:69], v[76:79]
    v_and_b32 v46, 0x40000000, v39
    v_bitop3_b32 v94, v36, v5, v46 bitop3:0xea
    v_and_b32 v46, 0x80000000, v39
    v_bitop3_b32 v95, v37, v5, v46 bitop3:0xea
    v_perm_b32 v15, v37, v38, s47
    v_bitop3_b32 v46, v37, 0.5, -0.5 bitop3:0xa8
    v_perm_b32 v14, v36, v38, s46
    v_bitop3_b32 v47, v36, 0.5, -0.5 bitop3:0xa8
    v_cvt_pk_bf16_f32 v80, v80, v81
    v_cvt_pk_bf16_f32 v81, v82, v83
    ds_wrxchg_rtn_b64 v[74:75], v93, v[80:81] offset:65408
    v_cvt_pk_bf16_f32 v76, v76, v77
    v_cvt_pk_bf16_f32 v77, v78, v79
    ds_wrxchg_rtn_b64 v[72:73], v92, v[76:77] offset:65408
    v_and_b32 v88, 0x0fffffff, v44
    v_mov_b32 v39, v44
    buffer_load_dwordx2 v[34:35], v88, s[8:11], 0 offen
    buffer_load_dwordx3 v[36:38], v88, s[8:11], 0 offen offset:8
    s_setprio 0
    s_waitcnt vmcnt(11)
    ds_write_addtid_b32 v112 offset:1024
    ds_write_addtid_b32 v113 offset:1280
    ds_write_addtid_b32 v114 offset:1536
    ds_write_addtid_b32 v115 offset:1792
    v_mfma_f32_4x4x4_16b_bf16 v[80:83], v[8:9], v[106:107], 0
    v_mfma_f32_4x4x4_16b_bf16 v[76:79], v[8:9], v[104:105], 0
    v_bitop3_b32 v15, v6, v15, v46 bitop3:0xca
    v_bitop3_b32 v14, v6, v14, v47 bitop3:0xca
    s_nop 1
    v_pk_mul_f32 v[80:81], v[80:81], v[14:15] op_sel:[0,1] op_sel_hi:[1,1]
    v_pk_mul_f32 v[82:83], v[82:83], v[14:15] op_sel:[0,1] op_sel_hi:[1,1]
    v_pk_mul_f32 v[76:77], v[76:77], v[14:15] op_sel:[0,0] op_sel_hi:[1,0]
    v_pk_mul_f32 v[78:79], v[78:79], v[14:15] op_sel:[0,0] op_sel_hi:[1,0]
    s_add_u32 s42, s42, 1
    s_waitcnt lgkmcnt(0)
    s_cmp_lg_u32 s42, 14
    s_cbranch_scc1 L2_loop
    s_barrier
    s_bitcmp1_b32 s36, s42
    s_cbranch_scc1 L2_slow
L2_ret6:
    s_setprio 3
    buffer_load_dwordx4 v[108:111], v3, s[16:19], s40 offen offset:0
    v_cmp_ne_u64 s[50:51], v[72:73], v[68:69]
    v_cmpx_ne_u64 s[54:55], v[74:75], v[70:71]
    s_and_b64 s[82:83], s[54:55], s[80:81]
    s_cbranch_scc1 L2_c118
L2_d118:
    v_mov_b64 v[84:85], v[70:71]
    v_mov_b32 v7, v93
    v_mov_b64 v[86:87], v[74:75]
    s_or_b64 s[80:81], s[80:81], s[54:55]
    s_mov_b64 exec, s[50:51]
    s_and_b64 s[82:83], s[50:51], s[80:81]
    s_cbranch_scc1 L2_c119
L2_d119:
    v_mov_b64 v[84:85], v[68:69]
    v_mov_b32 v7, v92
    v_mov_b64 v[86:87], v[72:73]
    s_mov_b64 exec, -1
    s_or_b64 s[80:81], s[80:81], s[50:51]
    ds_read_b64 v[70:71], v95 offset:65408
    ds_read_b64 v[68:69], v94 offset:65408
    s_waitcnt vmcnt(10)
    v_and_b32 v46, 0x20000000, v21
    v_lshrrev_b32 v47, 14, v17
    v_bitop3_b32 v47, v47, v5, v46 bitop3:0xea
    ds_read_b64 v[102:103], v47
    v_bitop3_b32 v93, v17, v5, v46 bitop3:0xea
    v_and_b32 v46, 0x10000000, v21
    v_lshrrev_b32 v47, 14, v16
    v_bitop3_b32 v47, v47, v5, v46 bitop3:0xea
    ds_read_b64 v[100:101], v47
    v_bitop3_b32 v92, v16, v5, v46 bitop3:0xea
    s_waitcnt lgkmcnt(2)
    v_mfma_f32_4x4x4_16b_bf16 v[80:83], v[10:11], v[70:71], v[80:83]
    v_mfma_f32_4x4x4_16b_bf16 v[76:79], v[10:11], v[68:69], v[76:79]
    v_perm_b32 v15, v17, v20, s45
    v_bitop3_b32 v46, v17, 0.5, -0.5 bitop3:0xa8
    v_perm_b32 v14, v16, v20, s44
    v_bitop3_b32 v47, v16, 0.5, -0.5 bitop3:0xa8
    v_cvt_pk_bf16_f32 v80, v80, v81
    v_cvt_pk_bf16_f32 v81, v82, v83
    ds_wrxchg_rtn_b64 v[74:75], v95, v[80:81] offset:65408
    v_cvt_pk_bf16_f32 v76, v76, v77
    v_cvt_pk_bf16_f32 v77, v78, v79
    ds_wrxchg_rtn_b64 v[72:73], v94, v[76:77] offset:65408
    s_waitcnt lgkmcnt(2)
    v_mfma_f32_4x4x4_16b_bf16 v[80:83], v[8:9], v[102:103], 0
    v_mfma_f32_4x4x4_16b_bf16 v[76:79], v[8:9], v[100:101], 0
    v_bitop3_b32 v15, v6, v15, v46 bitop3:0xca
    v_bitop3_b32 v14, v6, v14, v47 bitop3:0xca
    v_cmp_lt_u32 s[84:85], v5, v92
    s_nop 0
    v_pk_mul_f32 v[80:81], v[80:81], v[14:15] op_sel:[0,1] op_sel_hi:[1,1]
    v_pk_mul_f32 v[82:83], v[82:83], v[14:15] op_sel:[0,1] op_sel_hi:[1,1]
    v_pk_mul_f32 v[76:77], v[76:77], v[14:15] op_sel:[0,0] op_sel_hi:[1,0]
    v_pk_mul_f32 v[78:79], v[78:79], v[14:15] op_sel:[0,0] op_sel_hi:[1,0]
    buffer_load_dwordx4 v[112:115], v3, s[16:19], s40 offen offset:1024
    s_waitcnt lgkmcnt(0)
    v_cmp_ne_u64 s[50:51], v[72:73], v[68:69]
    v_cmpx_ne_u64 s[54:55], v[74:75], v[70:71]
    s_and_b64 s[82:83], s[54:55], s[80:81]
    s_cbranch_scc1 L2_c120
L2_d120:
    v_mov_b64 v[84:85], v[70:71]
    v_mov_b32 v7, v95
    v_mov_b64 v[86:87], v[74:75]
    s_or_b64 s[80:81], s[80:81], s[54:55]
    s_mov_b64 exec, s[50:51]
    s_and_b64 s[82:83], s[50:51], s[80:81]
    s_cbranch_scc1 L2_c121
L2_d121:
    v_mov_b64 v[84:85], v[68:69]
    v_mov_b32 v7, v94
    v_mov_b64 v[86:87], v[72:73]
    s_mov_b64 exec, -1
    s_or_b64 s[80:81], s[80:81], s[50:51]
    ds_read_b64 v[70:71], v93 offset:65408
    s_and_b64 exec, s[84:85], s[80:81]
    v_mfma_f32_4x4x4_16b_bf16 v[76:79], v[12:13], v[84:85], 0
    v_mov_b32 v92, v7
    s_andn2_b64 s[80:81], s[80:81], s[84:85]
    v_mfma_f32_4x4x4_16b_bf16 v[76:79], v[10:11], v[86:87], v[76:79]
    s_mov_b64 exec, -1
    ds_read_b64 v[68:69], v92 offset:65408
    v_and_b32 v46, 0x80000000, v21
    v_lshrrev_b32 v47, 14, v19
    v_bitop3_b32 v47, v47, v5, v46 bitop3:0xea
    ds_read_b64 v[106:107], v47
    v_bitop3_b32 v95, v19, v5, v46 bitop3:0xea
    v_and_b32 v46, 0x40000000, v21
    v_lshrrev_b32 v47, 14, v18
    v_bitop3_b32 v47, v47, v5, v46 bitop3:0xea
    ds_read_b64 v[104:105], v47
    v_bitop3_b32 v94, v18, v5, v46 bitop3:0xea
    s_waitcnt lgkmcnt(2)
    v_mfma_f32_4x4x4_16b_bf16 v[80:83], v[10:11], v[70:71], v[80:83]
    v_mfma_f32_4x4x4_16b_bf16 v[76:79], v[10:11], v[68:69], v[76:79]
    v_perm_b32 v15, v19, v20, s47
    v_bitop3_b32 v46, v19, 0.5, -0.5 bitop3:0xa8
    v_perm_b32 v14, v18, v20, s46
    v_bitop3_b32 v47, v18, 0.5, -0.5 bitop3:0xa8
    v_cvt_pk_bf16_f32 v80, v80, v81
    v_cvt_pk_bf16_f32 v81, v82, v83
    ds_wrxchg_rtn_b64 v[74:75], v93, v[80:81] offset:65408
    v_cvt_pk_bf16_f32 v76, v76, v77
    v_cvt_pk_bf16_f32 v77, v78, v79
    ds_wrxchg_rtn_b64 v[72:73], v92, v[76:77] offset:65408
    v_and_b32 v88, 0x0fffffff, v40
    v_mov_b32 v21, v40
    buffer_load_dwordx2 v[16:17], v88, s[8:11], 0 offen
    buffer_load_dwordx3 v[18:20], v88, s[8:11], 0 offen offset:8
    s_setprio 2
    s_waitcnt lgkmcnt(2)
    v_mfma_f32_4x4x4_16b_bf16 v[80:83], v[8:9], v[106:107], 0
    v_mfma_f32_4x4x4_16b_bf16 v[76:79], v[8:9], v[104:105], 0
    v_bitop3_b32 v15, v6, v15, v46 bitop3:0xca
    v_bitop3_b32 v14, v6, v14, v47 bitop3:0xca
    s_nop 1
    v_pk_mul_f32 v[80:81], v[80:81], v[14:15] op_sel:[0,1] op_sel_hi:[1,1]
    v_pk_mul_f32 v[82:83], v[82:83], v[14:15] op_sel:[0,1] op_sel_hi:[1,1]
    v_pk_mul_f32 v[76:77], v[76:77], v[14:15] op_sel:[0,0] op_sel_hi:[1,0]
    v_pk_mul_f32 v[78:79], v[78:79], v[14:15] op_sel:[0,0] op_sel_hi:[1,0]
    s_waitcnt lgkmcnt(0)
    v_cmp_ne_u64 s[50:51], v[72:73], v[68:69]
    v_cmpx_ne_u64 s[54:55], v[74:75], v[70:71]
    s_and_b64 s[82:83], s[54:55], s[80:81]
    s_cbranch_scc1 L2_c122
L2_d122:
    v_mov_b64 v[84:85], v[70:71]
    v_mov_b32 v7, v93
    v_mov_b64 v[86:87], v[74:75]
    s_or_b64 s[80:81], s[80:81], s[54:55]
    s_mov_b64 exec, s[50:51]
    s_and_b64 s[82:83], s[50:51], s[80:81]
    s_cbranch_scc1 L2_c123
L2_d123:
    v_mov_b64 v[84:85], v[68:69]
    v_mov_b32 v7, v92
    v_mov_b64 v[86:87], v[72:73]
    s_mov_b64 exec, -1
    s_or_b64 s[80:81], s[80:81], s[50:51]
    ds_read_b64 v[70:71], v95 offset:65408
    ds_read_b64 v[68:69], v94 offset:65408
    s_waitcnt vmcnt(11)
    v_and_b32 v46, 0x20000000, v27
    v_lshrrev_b32 v47, 14, v23
    v_bitop3_b32 v47, v47, v5, v46 bitop3:0xea
    ds_read_b64 v[102:103], v47
    v_bitop3_b32 v93, v23, v5, v46 bitop3:0xea
    v_and_b32 v46, 0x10000000, v27
    v_lshrrev_b32 v47, 14, v22
    v_bitop3_b32 v47, v47, v5, v46 bitop3:0xea
    ds_read_b64 v[100:101], v47
    v_bitop3_b32 v92, v22, v5, v46 bitop3:0xea
    s_waitcnt lgkmcnt(2)
    v_mfma_f32_4x4x4_16b_bf16 v[80:83], v[10:11], v[70:71], v[80:83]
    v_mfma_f32_4x4x4_16b_bf16 v[76:79], v[10:11], v[68:69], v[76:79]
    v_perm_b32 v15, v23, v26, s45
    v_bitop3_b32 v46, v23, 0.5, -0.5 bitop3:0xa8
    v_perm_b32 v14, v22, v26, s44
    v_bitop3_b32 v47, v22, 0.5, -0.5 bitop3:0xa8
    v_cvt_pk_bf16_f32 v80, v80, v81
    v_cvt_pk_bf16_f32 v81, v82, v83
    ds_wrxchg_rtn_b64 v[74:75], v95, v[80:81] offset:65408
    v_cvt_pk_bf16_f32 v76, v76, v77
    v_cvt_pk_bf16_f32 v77, v78, v79
    ds_wrxchg_rtn_b64 v[72:73], v94, v[76:77] offset:65408
    s_waitcnt lgkmcnt(2)
    v_mfma_f32_4x4x4_16b_bf16 v[80:83], v[8:9], v[102:103], 0
    v_mfma_f32_4x4x4_16b_bf16 v[76:79], v[8:9], v[100:101], 0
    v_bitop3_b32 v15, v6, v15, v46 bitop3:0xca
    v_bitop3_b32 v14, v6, v14, v47 bitop3:0xca
    v_cmp_lt_u32 s[84:85], v5, v92
    s_nop 0
    v_pk_mul_f32 v[80:81], v[80:81], v[14:15] op_sel:[0,1] op_sel_hi:[1,1]
    v_pk_mul_f32 v[82:83], v[82:83], v[14:15] op_sel:[0,1] op_sel_hi:[1,1]
    v_pk_mul_f32 v[76:77], v[76:77], v[14:15] op_sel:[0,0] op_sel_hi:[1,0]
    v_pk_mul_f32 v[78:79], v[78:79], v[14:15] op_sel:[0,0] op_sel_hi:[1,0]
    s_waitcnt lgkmcnt(0)
    v_cmp_ne_u64 s[50:51], v[72:73], v[68:69]
    v_cmpx_ne_u64 s[54:55], v[74:75], v[70:71]
    s_and_b64 s[82:83], s[54:55], s[80:81]
    s_cbranch_scc1 L2_c124
L2_d124:
    v_mov_b64 v[84:85], v[70:71]
    v_mov_b32 v7, v95
    v_mov_b64 v[86:87], v[74:75]
    s_or_b64 s[80:81], s[80:81], s[54:55]
    s_mov_b64 exec, s[50:51]
    s_and_b64 s[82:83], s[50:51], s[80:81]
    s_cbranch_scc1 L2_c125
L2_d125:
    v_mov_b64 v[84:85], v[68:69]
    v_mov_b32 v7, v94
    v_mov_b64 v[86:87], v[72:73]
    s_mov_b64 exec, -1
    s_or_b64 s[80:81], s[80:81], s[50:51]
    ds_read_b64 v[70:71], v93 offset:65408
    s_and_b64 exec, s[84:85], s[80:81]
    v_mfma_f32_4x4x4_16b_bf16 v[76:79], v[12:13], v[84:85], 0
    v_mov_b32 v92, v7
    s_andn2_b64 s[80:81], s[80:81], s[84:85]
    v_mfma_f32_4x4x4_16b_bf16 v[76:79], v[10:11], v[86:87], v[76:79]
    s_mov_b64 exec, -1
    ds_read_b64 v[68:69], v92 offset:65408
    v_and_b32 v46, 0x80000000, v27
    v_lshrrev_b32 v47, 14, v25
    v_bitop3_b32 v47, v47, v5, v46 bitop3:0xea
    ds_read_b64 v[106:107], v47
    v_bitop3_b32 v95, v25, v5, v46 bitop3:0xea
    v_and_b32 v46, 0x40000000, v27
    v_lshrrev_b32 v47, 14, v24
    v_bitop3_b32 v47, v47, v5, v46 bitop3:0xea
    ds_read_b64 v[104:105], v47
    v_bitop3_b32 v94, v24, v5, v46 bitop3:0xea
    s_waitcnt lgkmcnt(2)
    v_mfma_f32_4x4x4_16b_bf16 v[80:83], v[10:11], v[70:71], v[80:83]
    v_mfma_f32_4x4x4_16b_bf16 v[76:79], v[10:11], v[68:69], v[76:79]
    v_perm_b32 v15, v25, v26, s47
    v_bitop3_b32 v46, v25, 0.5, -0.5 bitop3:0xa8
    v_perm_b32 v14, v24, v26, s46
    v_bitop3_b32 v47, v24, 0.5, -0.5 bitop3:0xa8
    v_cvt_pk_bf16_f32 v80, v80, v81
    v_cvt_pk_bf16_f32 v81, v82, v83
    ds_wrxchg_rtn_b64 v[74:75], v93, v[80:81] offset:65408
    v_cvt_pk_bf16_f32 v76, v76, v77
    v_cvt_pk_bf16_f32 v77, v78, v79
    ds_wrxchg_rtn_b64 v[72:73], v92, v[76:77] offset:65408
    v_and_b32 v88, 0x0fffffff, v41
    v_mov_b32 v27, v41
    buffer_load_dwordx2 v[22:23], v88, s[8:11], 0 offen
    buffer_load_dwordx3 v[24:26], v88, s[8:11], 0 offen offset:8
    s_setprio 1
    s_waitcnt lgkmcnt(2)
    v_mfma_f32_4x4x4_16b_bf16 v[80:83], v[8:9], v[106:107], 0
    v_mfma_f32_4x4x4_16b_bf16 v[76:79], v[8:9], v[104:105], 0
    v_bitop3_b32 v15, v6, v15, v46 bitop3:0xca
    v_bitop3_b32 v14, v6, v14, v47 bitop3:0xca
    s_nop 1
    v_pk_mul_f32 v[80:81], v[80:81], v[14:15] op_sel:[0,1] op_sel_hi:[1,1]
    v_pk_mul_f32 v[82:83], v[82:83], v[14:15] op_sel:[0,1] op_sel_hi:[1,1]
    v_pk_mul_f32 v[76:77], v[76:77], v[14:15] op_sel:[0,0] op_sel_hi:[1,0]
    v_pk_mul_f32 v[78:79], v[78:79], v[14:15] op_sel:[0,0] op_sel_hi:[1,0]
    s_waitcnt lgkmcnt(0)
    v_cmp_ne_u64 s[50:51], v[72:73], v[68:69]
    v_cmpx_ne_u64 s[54:55], v[74:75], v[70:71]
    s_and_b64 s[82:83], s[54:55], s[80:81]
    s_cbranch_scc1 L2_c126
L2_d126:
    v_mov_b64 v[84:85], v[70:71]
    v_mov_b32 v7, v93
    v_mov_b64 v[86:87], v[74:75]
    s_or_b64 s[80:81], s[80:81], s[54:55]
    s_mov_b64 exec, s[50:51]
    s_and_b64 s[82:83], s[50:51], s[80:81]
    s_cbranch_scc1 L2_c127
L2_d127:
    v_mov_b64 v[84:85], v[68:69]
    v_mov_b32 v7, v92
    v_mov_b64 v[86:87], v[72:73]
    s_mov_b64 exec, -1
    s_or_b64 s[80:81], s[80:81], s[50:51]
    ds_read_b64 v[70:71], v95 offset:65408
    ds_read_b64 v[68:69], v94 offset:65408
    s_waitcnt vmcnt(11)
    v_and_b32 v46, 0x20000000, v33
    v_lshrrev_b32 v47, 14, v29
    v_bitop3_b32 v47, v47, v5, v46 bitop3:0xea
    ds_read_b64 v[102:103], v47
    v_bitop3_b32 v93, v29, v5, v46 bitop3:0xea
    v_and_b32 v46, 0x10000000, v33
    v_lshrrev_b32 v47, 14, v28
    v_bitop3_b32 v47, v47, v5, v46 bitop3:0xea
    ds_read_b64 v[100:101], v47
    v_bitop3_b32 v92, v28, v5, v46 bitop3:0xea
    s_waitcnt lgkmcnt(2)
    v_mfma_f32_4x4x4_16b_bf16 v[80:83], v[10:11], v[70:71], v[80:83]
    v_mfma_f32_4x4x4_16b_bf16 v[76:79], v[10:11], v[68:69], v[76:79]
    v_perm_b32 v15, v29, v32, s45
    v_bitop3_b32 v46, v29, 0.5, -0.5 bitop3:0xa8
    v_perm_b32 v14, v28, v32, s44
    v_bitop3_b32 v47, v28, 0.5, -0.5 bitop3:0xa8
    v_cvt_pk_bf16_f32 v80, v80, v81
    v_cvt_pk_bf16_f32 v81, v82, v83
    ds_wrxchg_rtn_b64 v[74:75], v95, v[80:81] offset:65408
    v_cvt_pk_bf16_f32 v76, v76, v77
    v_cvt_pk_bf16_f32 v77, v78, v79
    ds_wrxchg_rtn_b64 v[72:73], v94, v[76:77] offset:65408
    s_waitcnt lgkmcnt(2)
    v_mfma_f32_4x4x4_16b_bf16 v[80:83], v[8:9], v[102:103], 0
    v_mfma_f32_4x4x4_16b_bf16 v[76:79], v[8:9], v[100:101], 0
    v_bitop3_b32 v15, v6, v15, v46 bitop3:0xca
    v_bitop3_b32 v14, v6, v14, v47 bitop3:0xca
    v_cmp_lt_u32 s[84:85], v5, v92
    s_nop 0
    v_pk_mul_f32 v[80:81], v[80:81], v[14:15] op_sel:[0,1] op_sel_hi:[1,1]
    v_pk_mul_f32 v[82:83], v[82:83], v[14:15] op_sel:[0,1] op_sel_hi:[1,1]
    v_pk_mul_f32 v[76:77], v[76:77], v[14:15] op_sel:[0,0] op_sel_hi:[1,0]
    v_pk_mul_f32 v[78:79], v[78:79], v[14:15] op_sel:[0,0] op_sel_hi:[1,0]
    s_waitcnt lgkmcnt(0)
    v_cmp_ne_u64 s[50:51], v[72:73], v[68:69]
    v_cmpx_ne_u64 s[54:55], v[74:75], v[70:71]
    s_and_b64 s[82:83], s[54:55], s[80:81]
    s_cbranch_scc1 L2_c128
L2_d128:
    v_mov_b64 v[84:85], v[70:71]
    v_mov_b32 v7, v95
    v_mov_b64 v[86:87], v[74:75]
    s_or_b64 s[80:81], s[80:81], s[54:55]
    s_mov_b64 exec, s[50:51]
    s_and_b64 s[82:83], s[50:51], s[80:81]
    s_cbranch_scc1 L2_c129
L2_d129:
    v_mov_b64 v[84:85], v[68:69]
    v_mov_b32 v7, v94
    v_mov_b64 v[86:87], v[72:73]
    s_mov_b64 exec, -1
    s_or_b64 s[80:81], s[80:81], s[50:51]
    ds_read_b64 v[70:71], v93 offset:65408
    s_and_b64 exec, s[84:85], s[80:81]
    v_mfma_f32_4x4x4_16b_bf16 v[76:79], v[12:13], v[84:85], 0
    v_mov_b32 v92, v7
    s_andn2_b64 s[80:81], s[80:81], s[84:85]
    v_mfma_f32_4x4x4_16b_bf16 v[76:79], v[10:11], v[86:87], v[76:79]
    s_mov_b64 exec, -1
    ds_read_b64 v[68:69], v92 offset:65408
    v_and_b32 v46, 0x80000000, v33
    v_lshrrev_b32 v47, 14, v31
    v_bitop3_b32 v47, v47, v5, v46 bitop3:0xea
    ds_read_b64 v[106:107], v47
    v_bitop3_b32 v95, v31, v5, v46 bitop3:0xea
    v_and_b32 v46, 0x40000000, v33
    v_lshrrev_b32 v47, 14, v30
    v_bitop3_b32 v47, v47, v5, v46 bitop3:0xea
    ds_read_b64 v[104:105], v47
    v_bitop3_b32 v94, v30, v5, v46 bitop3:0xea
    s_waitcnt lgkmcnt(2)
    v_mfma_f32_4x4x4_16b_bf16 v[80:83], v[10:11], v[70:71], v[80:83]
    v_mfma_f32_4x4x4_16b_bf16 v[76:79], v[10:11], v[68:69], v[76:79]
    v_perm_b32 v15, v31, v32, s47
    v_bitop3_b32 v46, v31, 0.5, -0.5 bitop3:0xa8
    v_perm_b32 v14, v30, v32, s46
    v_bitop3_b32 v47, v30, 0.5, -0.5 bitop3:0xa8
    v_cvt_pk_bf16_f32 v80, v80, v81
    v_cvt_pk_bf16_f32 v81, v82, v83
    ds_wrxchg_rtn_b64 v[74:75], v93, v[80:81] offset:65408
    v_cvt_pk_bf16_f32 v76, v76, v77
    v_cvt_pk_bf16_f32 v77, v78, v79
    ds_wrxchg_rtn_b64 v[72:73], v92, v[76:77] offset:65408
    v_and_b32 v88, 0x0fffffff, v42
    v_mov_b32 v33, v42
    buffer_load_dwordx2 v[28:29], v88, s[8:11], 0 offen
    buffer_load_dwordx3 v[30:32], v88, s[8:11], 0 offen offset:8
    s_setprio 0
    s_waitcnt lgkmcnt(2)
    v_mfma_f32_4x4x4_16b_bf16 v[80:83], v[8:9], v[106:107], 0
    v_mfma_f32_4x4x4_16b_bf16 v[76:79], v[8:9], v[104:105], 0
    v_bitop3_b32 v15, v6, v15, v46 bitop3:0xca
    v_bitop3_b32 v14, v6, v14, v47 bitop3:0xca
    s_nop 1
    v_pk_mul_f32 v[80:81], v[80:81], v[14:15] op_sel:[0,1] op_sel_hi:[1,1]
    v_pk_mul_f32 v[82:83], v[82:83], v[14:15] op_sel:[0,1] op_sel_hi:[1,1]
    v_pk_mul_f32 v[76:77], v[76:77], v[14:15] op_sel:[0,0] op_sel_hi:[1,0]
    v_pk_mul_f32 v[78:79], v[78:79], v[14:15] op_sel:[0,0] op_sel_hi:[1,0]
    s_add_u32 s40, s40, 0xfff24000
    s_waitcnt lgkmcnt(0)
    v_cmp_ne_u64 s[50:51], v[72:73], v[68:69]
    v_cmpx_ne_u64 s[54:55], v[74:75], v[70:71]
    s_and_b64 s[82:83], s[54:55], s[80:81]
    s_cbranch_scc1 L2_c130
L2_d130:
    v_mov_b64 v[84:85], v[70:71]
    v_mov_b32 v7, v93
    v_mov_b64 v[86:87], v[74:75]
    s_or_b64 s[80:81], s[80:81], s[54:55]
    s_mov_b64 exec, s[50:51]
    s_and_b64 s[82:83], s[50:51], s[80:81]
    s_cbranch_scc1 L2_c131
L2_d131:
    v_mov_b64 v[84:85], v[68:69]
    v_mov_b32 v7, v92
    v_mov_b64 v[86:87], v[72:73]
    s_mov_b64 exec, -1
    s_or_b64 s[80:81], s[80:81], s[50:51]
    ds_read_b64 v[70:71], v95 offset:65408
    ds_read_b64 v[68:69], v94 offset:65408
    s_waitcnt vmcnt(8)
    v_and_b32 v46, 0x20000000, v39
    v_lshrrev_b32 v47, 14, v35
    v_bitop3_b32 v47, v47, v5, v46 bitop3:0xea
    ds_read_b64 v[102:103], v47
    v_bitop3_b32 v93, v35, v5, v46 bitop3:0xea
    v_and_b32 v46, 0x10000000, v39
    v_lshrrev_b32 v47, 14, v34
    v_bitop3_b32 v47, v47, v5, v46 bitop3:0xea
    ds_read_b64 v[100:101], v47
    v_bitop3_b32 v92, v34, v5, v46 bitop3:0xea
    v_and_b32 v46, 0x80000000, v39
    v_lshrrev_b32 v47, 14, v37
    v_bitop3_b32 v47, v47, v5, v46 bitop3:0xea
    ds_read_b64 v[106:107], v47
    v_and_b32 v46, 0x40000000, v39
    v_lshrrev_b32 v47, 14, v36
    v_bitop3_b32 v47, v47, v5, v46 bitop3:0xea
    ds_read_b64 v[104:105], v47
    s_waitcnt lgkmcnt(4)
    v_mfma_f32_4x4x4_16b_bf16 v[80:83], v[10:11], v[70:71], v[80:83]
    v_mfma_f32_4x4x4_16b_bf16 v[76:79], v[10:11], v[68:69], v[76:79]
    v_perm_b32 v15, v35, v38, s45
    v_bitop3_b32 v46, v35, 0.5, -0.5 bitop3:0xa8
    v_perm_b32 v14, v34, v38, s44
    v_bitop3_b32 v47, v34, 0.5, -0.5 bitop3:0xa8
    v_cvt_pk_bf16_f32 v80, v80, v81
    v_cvt_pk_bf16_f32 v81, v82, v83
    ds_wrxchg_rtn_b64 v[74:75], v95, v[80:81] offset:65408
    v_cvt_pk_bf16_f32 v76, v76, v77
    v_cvt_pk_bf16_f32 v77, v78, v79
    ds_wrxchg_rtn_b64 v[72:73], v94, v[76:77] offset:65408
    s_waitcnt lgkmcnt(2)
    s_barrier
    s_setprio 3
    s_mov_b32 m0, s100
    s_nop 0
    ds_write_addtid_b32 v116 offset:32768
    ds_write_addtid_b32 v117 offset:33024
    ds_write_addtid_b32 v118 offset:33280
    ds_write_addtid_b32 v119 offset:33536
    ds_write_addtid_b32 v120 offset:33792
    ds_write_addtid_b32 v121 offset:34048
    ds_write_addtid_b32 v122 offset:34304
    ds_write_addtid_b32 v123 offset:34560
    v_mfma_f32_4x4x4_16b_bf16 v[80:83], v[8:9], v[102:103], 0
    v_mfma_f32_4x4x4_16b_bf16 v[76:79], v[8:9], v[100:101], 0
    v_bitop3_b32 v15, v6, v15, v46 bitop3:0xca
    v_bitop3_b32 v14, v6, v14, v47 bitop3:0xca
    v_cmp_lt_u32 s[84:85], v5, v92
    s_nop 0
    v_pk_mul_f32 v[80:81], v[80:81], v[14:15] op_sel:[0,1] op_sel_hi:[1,1]
    v_pk_mul_f32 v[82:83], v[82:83], v[14:15] op_sel:[0,1] op_sel_hi:[1,1]
    v_pk_mul_f32 v[76:77], v[76:77], v[14:15] op_sel:[0,0] op_sel_hi:[1,0]
    v_pk_mul_f32 v[78:79], v[78:79], v[14:15] op_sel:[0,0] op_sel_hi:[1,0]
    v_mov_b32 v44, v43
    s_setprio 2
    ds_write_addtid_b32 v124 offset:34816
    ds_write_addtid_b32 v125 offset:35072
    ds_write_addtid_b32 v126 offset:35328
    ds_write_addtid_b32 v127 offset:35584
    s_waitcnt lgkmcnt(12)
    v_cmp_ne_u64 s[50:51], v[72:73], v[68:69]
    v_cmpx_ne_u64 s[54:55], v[74:75], v[70:71]
    s_and_b64 s[82:83], s[54:55], s[80:81]
    s_cbranch_scc1 L2_c132
L2_d132:
    v_mov_b64 v[84:85], v[70:71]
    v_mov_b32 v7, v95
    v_mov_b64 v[86:87], v[74:75]
    s_or_b64 s[80:81], s[80:81], s[54:55]
    s_mov_b64 exec, s[50:51]
    s_and_b64 s[82:83], s[50:51], s[80:81]
    s_cbranch_scc1 L2_c133
L2_d133:
    v_mov_b64 v[84:85], v[68:69]
    v_mov_b32 v7, v94
    v_mov_b64 v[86:87], v[72:73]
    s_mov_b64 exec, -1
    s_or_b64 s[80:81], s[80:81], s[50:51]
    ds_read_b64 v[70:71], v93 offset:65408
    s_and_b64 exec, s[84:85], s[80:81]
    v_mfma_f32_4x4x4_16b_bf16 v[76:79], v[12:13], v[84:85], 0
    v_mov_b32 v92, v7
    s_andn2_b64 s[80:81], s[80:81], s[84:85]
    v_mfma_f32_4x4x4_16b_bf16 v[76:79], v[10:11], v[86:87], v[76:79]
    s_mov_b64 exec, -1
    ds_read_b64 v[68:69], v92 offset:65408
    s_setprio 1
    s_waitcnt vmcnt(7)
    s_mov_b32 m0, s38
    s_nop 0
    ds_write_addtid_b32 v108 offset:0
    ds_write_addtid_b32 v109 offset:256
    ds_write_addtid_b32 v110 offset:512
    ds_write_addtid_b32 v111 offset:768
    s_waitcnt lgkmcnt(4)
    v_mfma_f32_4x4x4_16b_bf16 v[80:83], v[10:11], v[70:71], v[80:83]
    v_mfma_f32_4x4x4_16b_bf16 v[76:79], v[10:11], v[68:69], v[76:79]
    v_and_b32 v46, 0x40000000, v39
    v_bitop3_b32 v94, v36, v5, v46 bitop3:0xea
    v_and_b32 v46, 0x80000000, v39
    v_bitop3_b32 v95, v37, v5, v46 bitop3:0xea
    v_perm_b32 v15, v37, v38, s47
    v_bitop3_b32 v46, v37, 0.5, -0.5 bitop3:0xa8
    v_perm_b32 v14, v36, v38, s46
    v_bitop3_b32 v47, v36, 0.5, -0.5 bitop3:0xa8
    v_cvt_pk_bf16_f32 v80, v80, v81
    v_cvt_pk_bf16_f32 v81, v82, v83
    ds_wrxchg_rtn_b64 v[74:75], v93, v[80:81] offset:65408
    v_cvt_pk_bf16_f32 v76, v76, v77
    v_cvt_pk_bf16_f32 v77, v78, v79
    ds_wrxchg_rtn_b64 v[72:73], v92, v[76:77] offset:65408
    v_and_b32 v88, 0x0fffffff, v44
    v_mov_b32 v39, v44
    buffer_load_dwordx2 v[34:35], v88, s[8:11], 0 offen
    buffer_load_dwordx3 v[36:38], v88, s[8:11], 0 offen offset:8
    s_setprio 0
    s_waitcnt vmcnt(8)
    ds_write_addtid_b32 v112 offset:1024
    ds_write_addtid_b32 v113 offset:1280
    ds_write_addtid_b32 v114 offset:1536
    ds_write_addtid_b32 v115 offset:1792
    v_mfma_f32_4x4x4_16b_bf16 v[80:83], v[8:9], v[106:107], 0
    v_mfma_f32_4x4x4_16b_bf16 v[76:79], v[8:9], v[104:105], 0
    v_bitop3_b32 v15, v6, v15, v46 bitop3:0xca
    v_bitop3_b32 v14, v6, v14, v47 bitop3:0xca
    s_nop 1
    v_pk_mul_f32 v[80:81], v[80:81], v[14:15] op_sel:[0,1] op_sel_hi:[1,1]
    v_pk_mul_f32 v[82:83], v[82:83], v[14:15] op_sel:[0,1] op_sel_hi:[1,1]
    v_pk_mul_f32 v[76:77], v[76:77], v[14:15] op_sel:[0,0] op_sel_hi:[1,0]
    v_pk_mul_f32 v[78:79], v[78:79], v[14:15] op_sel:[0,0] op_sel_hi:[1,0]
    s_add_u32 s42, s42, 1
    s_waitcnt lgkmcnt(0)
    s_barrier
    s_bitcmp1_b32 s36, s42
    s_cbranch_scc1 L2_slow
L2_ret7:
    s_setprio 3
    v_cmp_ne_u64 s[50:51], v[72:73], v[68:69]
    v_cmpx_ne_u64 s[54:55], v[74:75], v[70:71]
    s_and_b64 s[82:83], s[54:55], s[80:81]
    s_cbranch_scc1 L2_c134
L2_d134:
    v_mov_b64 v[84:85], v[70:71]
    v_mov_b32 v7, v93
    v_mov_b64 v[86:87], v[74:75]
    s_or_b64 s[80:81], s[80:81], s[54:55]
    s_mov_b64 exec, s[50:51]
    s_and_b64 s[82:83], s[50:51], s[80:81]
    s_cbranch_scc1 L2_c135
L2_d135:
    v_mov_b64 v[84:85], v[68:69]
    v_mov_b32 v7, v92
    v_mov_b64 v[86:87], v[72:73]
    s_mov_b64 exec, -1
    s_or_b64 s[80:81], s[80:81], s[50:51]
    ds_read_b64 v[70:71], v95 offset:65408
    ds_read_b64 v[68:69], v94 offset:65408
    s_waitcnt vmcnt(6)
    v_and_b32 v46, 0x20000000, v21
    v_lshrrev_b32 v47, 14, v17
    v_bitop3_b32 v47, v47, v5, v46 bitop3:0xea
    ds_read_b64 v[102:103], v47
    v_bitop3_b32 v93, v17, v5, v46 bitop3:0xea
    v_and_b32 v46, 0x10000000, v21
    v_lshrrev_b32 v47, 14, v16
    v_bitop3_b32 v47, v47, v5, v46 bitop3:0xea
    ds_read_b64 v[100:101], v47
    v_bitop3_b32 v92, v16, v5, v46 bitop3:0xea
    s_waitcnt lgkmcnt(2)
    v_mfma_f32_4x4x4_16b_bf16 v[80:83], v[10:11], v[70:71], v[80:83]
    v_mfma_f32_4x4x4_16b_bf16 v[76:79], v[10:11], v[68:69], v[76:79]
    v_perm_b32 v15, v17, v20, s45
    v_bitop3_b32 v46, v17, 0.5, -0.5 bitop3:0xa8
    v_perm_b32 v14, v16, v20, s44
    v_bitop3_b32 v47, v16, 0.5, -0.5 bitop3:0xa8
    v_cvt_pk_bf16_f32 v80, v80, v81
    v_cvt_pk_bf16_f32 v81, v82, v83
    ds_wrxchg_rtn_b64 v[74:75], v95, v[80:81] offset:65408
    v_cvt_pk_bf16_f32 v76, v76, v77
    v_cvt_pk_bf16_f32 v77, v78, v79
    ds_wrxchg_rtn_b64 v[72:73], v94, v[76:77] offset:65408
    s_waitcnt lgkmcnt(2)
    v_mfma_f32_4x4x4_16b_bf16 v[80:83], v[8:9], v[102:103], 0
    v_mfma_f32_4x4x4_16b_bf16 v[76:79], v[8:9], v[100:101], 0
    v_bitop3_b32 v15, v6, v15, v46 bitop3:0xca
    v_bitop3_b32 v14, v6, v14, v47 bitop3:0xca
    v_cmp_lt_u32 s[84:85], v5, v92
    s_nop 0
    v_pk_mul_f32 v[80:81], v[80:81], v[14:15] op_sel:[0,1] op_sel_hi:[1,1]
    v_pk_mul_f32 v[82:83], v[82:83], v[14:15] op_sel:[0,1] op_sel_hi:[1,1]
    v_pk_mul_f32 v[76:77], v[76:77], v[14:15] op_sel:[0,0] op_sel_hi:[1,0]
    v_pk_mul_f32 v[78:79], v[78:79], v[14:15] op_sel:[0,0] op_sel_hi:[1,0]
    s_waitcnt lgkmcnt(0)
    v_cmp_ne_u64 s[50:51], v[72:73], v[68:69]
    v_cmpx_ne_u64 s[54:55], v[74:75], v[70:71]
    s_and_b64 s[82:83], s[54:55], s[80:81]
    s_cbranch_scc1 L2_c136
L2_d136:
    v_mov_b64 v[84:85], v[70:71]
    v_mov_b32 v7, v95
    v_mov_b64 v[86:87], v[74:75]
    s_or_b64 s[80:81], s[80:81], s[54:55]
    s_mov_b64 exec, s[50:51]
    s_and_b64 s[82:83], s[50:51], s[80:81]
    s_cbranch_scc1 L2_c137
L2_d137:
    v_mov_b64 v[84:85], v[68:69]
    v_mov_b32 v7, v94
    v_mov_b64 v[86:87], v[72:73]
    s_mov_b64 exec, -1
    s_or_b64 s[80:81], s[80:81], s[50:51]
    ds_read_b64 v[70:71], v93 offset:65408
    s_and_b64 exec, s[84:85], s[80:81]
    v_mfma_f32_4x4x4_16b_bf16 v[76:79], v[12:13], v[84:85], 0
    v_mov_b32 v92, v7
    s_andn2_b64 s[80:81], s[80:81], s[84:85]
    v_mfma_f32_4x4x4_16b_bf16 v[76:79], v[10:11], v[86:87], v[76:79]
    s_mov_b64 exec, -1
    ds_read_b64 v[68:69], v92 offset:65408
    v_and_b32 v46, 0x80000000, v21
    v_lshrrev_b32 v47, 14, v19
    v_bitop3_b32 v47, v47, v5, v46 bitop3:0xea
    ds_read_b64 v[106:107], v47
    v_bitop3_b32 v95, v19, v5, v46 bitop3:0xea
    v_and_b32 v46, 0x40000000, v21
    v_lshrrev_b32 v47, 14, v18
    v_bitop3_b32 v47, v47, v5, v46 bitop3:0xea
    ds_read_b64 v[104:105], v47
    v_bitop3_b32 v94, v18, v5, v46 bitop3:0xea
    s_waitcnt lgkmcnt(2)
    v_mfma_f32_4x4x4_16b_bf16 v[80:83], v[10:11], v[70:71], v[80:83]
    v_mfma_f32_4x4x4_16b_bf16 v[76:79], v[10:11], v[68:69], v[76:79]
    v_perm_b32 v15, v19, v20, s47
    v_bitop3_b32 v46, v19, 0.5, -0.5 bitop3:0xa8
    v_perm_b32 v14, v18, v20, s46
    v_bitop3_b32 v47, v18, 0.5, -0.5 bitop3:0xa8
    v_cvt_pk_bf16_f32 v80, v80, v81
    v_cvt_pk_bf16_f32 v81, v82, v83
    ds_wrxchg_rtn_b64 v[74:75], v93, v[80:81] offset:65408
    v_cvt_pk_bf16_f32 v76, v76, v77
    v_cvt_pk_bf16_f32 v77, v78, v79
    ds_wrxchg_rtn_b64 v[72:73], v92, v[76:77] offset:65408
    s_setprio 2
    s_waitcnt lgkmcnt(2)
    v_mfma_f32_4x4x4_16b_bf16 v[80:83], v[8:9], v[106:107], 0
    v_mfma_f32_4x4x4_16b_bf16 v[76:79], v[8:9], v[104:105], 0
    v_bitop3_b32 v15, v6, v15, v46 bitop3:0xca
    v_bitop3_b32 v14, v6, v14, v47 bitop3:0xca
    s_nop 1
    v_pk_mul_f32 v[80:81], v[80:81], v[14:15] op_sel:[0,1] op_sel_hi:[1,1]
    v_pk_mul_f32 v[82:83], v[82:83], v[14:15] op_sel:[0,1] op_sel_hi:[1,1]
    v_pk_mul_f32 v[76:77], v[76:77], v[14:15] op_sel:[0,0] op_sel_hi:[1,0]
    v_pk_mul_f32 v[78:79], v[78:79], v[14:15] op_sel:[0,0] op_sel_hi:[1,0]
    s_waitcnt lgkmcnt(0)
    v_cmp_ne_u64 s[50:51], v[72:73], v[68:69]
    v_cmpx_ne_u64 s[54:55], v[74:75], v[70:71]
    s_and_b64 s[82:83], s[54:55], s[80:81]
    s_cbranch_scc1 L2_c138
L2_d138:
    v_mov_b64 v[84:85], v[70:71]
    v_mov_b32 v7, v93
    v_mov_b64 v[86:87], v[74:75]
    s_or_b64 s[80:81], s[80:81], s[54:55]
    s_mov_b64 exec, s[50:51]
    s_and_b64 s[82:83], s[50:51], s[80:81]
    s_cbranch_scc1 L2_c139
L2_d139:
    v_mov_b64 v[84:85], v[68:69]
    v_mov_b32 v7, v92
    v_mov_b64 v[86:87], v[72:73]
    s_mov_b64 exec, -1
    s_or_b64 s[80:81], s[80:81], s[50:51]
    ds_read_b64 v[70:71], v95 offset:65408
    ds_read_b64 v[68:69], v94 offset:65408
    s_waitcnt vmcnt(4)
    v_and_b32 v46, 0x20000000, v27
    v_lshrrev_b32 v47, 14, v23
    v_bitop3_b32 v47, v47, v5, v46 bitop3:0xea
    ds_read_b64 v[102:103], v47
    v_bitop3_b32 v93, v23, v5, v46 bitop3:0xea
    v_and_b32 v46, 0x10000000, v27
    v_lshrrev_b32 v47, 14, v22
    v_bitop3_b32 v47, v47, v5, v46 bitop3:0xea
    ds_read_b64 v[100:101], v47
    v_bitop3_b32 v92, v22, v5, v46 bitop3:0xea
    s_waitcnt lgkmcnt(2)
    v_mfma_f32_4x4x4_16b_bf16 v[80:83], v[10:11], v[70:71], v[80:83]
    v_mfma_f32_4x4x4_16b_bf16 v[76:79], v[10:11], v[68:69], v[76:79]
    v_perm_b32 v15, v23, v26, s45
    v_bitop3_b32 v46, v23, 0.5, -0.5 bitop3:0xa8
    v_perm_b32 v14, v22, v26, s44
    v_bitop3_b32 v47, v22, 0.5, -0.5 bitop3:0xa8
    v_cvt_pk_bf16_f32 v80, v80, v81
    v_cvt_pk_bf16_f32 v81, v82, v83
    ds_wrxchg_rtn_b64 v[74:75], v95, v[80:81] offset:65408
    v_cvt_pk_bf16_f32 v76, v76, v77
    v_cvt_pk_bf16_f32 v77, v78, v79
    ds_wrxchg_rtn_b64 v[72:73], v94, v[76:77] offset:65408
    s_waitcnt lgkmcnt(2)
    v_mfma_f32_4x4x4_16b_bf16 v[80:83], v[8:9], v[102:103], 0
    v_mfma_f32_4x4x4_16b_bf16 v[76:79], v[8:9], v[100:101], 0
    v_bitop3_b32 v15, v6, v15, v46 bitop3:0xca
    v_bitop3_b32 v14, v6, v14, v47 bitop3:0xca
    v_cmp_lt_u32 s[84:85], v5, v92
    s_nop 0
    v_pk_mul_f32 v[80:81], v[80:81], v[14:15] op_sel:[0,1] op_sel_hi:[1,1]
    v_pk_mul_f32 v[82:83], v[82:83], v[14:15] op_sel:[0,1] op_sel_hi:[1,1]
    v_pk_mul_f32 v[76:77], v[76:77], v[14:15] op_sel:[0,0] op_sel_hi:[1,0]
    v_pk_mul_f32 v[78:79], v[78:79], v[14:15] op_sel:[0,0] op_sel_hi:[1,0]
    s_waitcnt lgkmcnt(0)
    v_cmp_ne_u64 s[50:51], v[72:73], v[68:69]
    v_cmpx_ne_u64 s[54:55], v[74:75], v[70:71]
    s_and_b64 s[82:83], s[54:55], s[80:81]
    s_cbranch_scc1 L2_c140
L2_d140:
    v_mov_b64 v[84:85], v[70:71]
    v_mov_b32 v7, v95
    v_mov_b64 v[86:87], v[74:75]
    s_or_b64 s[80:81], s[80:81], s[54:55]
    s_mov_b64 exec, s[50:51]
    s_and_b64 s[82:83], s[50:51], s[80:81]
    s_cbranch_scc1 L2_c141
L2_d141:
    v_mov_b64 v[84:85], v[68:69]
    v_mov_b32 v7, v94
    v_mov_b64 v[86:87], v[72:73]
    s_mov_b64 exec, -1
    s_or_b64 s[80:81], s[80:81], s[50:51]
    ds_read_b64 v[70:71], v93 offset:65408
    s_and_b64 exec, s[84:85], s[80:81]
    v_mfma_f32_4x4x4_16b_bf16 v[76:79], v[12:13], v[84:85], 0
    v_mov_b32 v92, v7
    s_andn2_b64 s[80:81], s[80:81], s[84:85]
    v_mfma_f32_4x4x4_16b_bf16 v[76:79], v[10:11], v[86:87], v[76:79]
    s_mov_b64 exec, -1
    ds_read_b64 v[68:69], v92 offset:65408
    v_and_b32 v46, 0x80000000, v27
    v_lshrrev_b32 v47, 14, v25
    v_bitop3_b32 v47, v47, v5, v46 bitop3:0xea
    ds_read_b64 v[106:107], v47
    v_bitop3_b32 v95, v25, v5, v46 bitop3:0xea
    v_and_b32 v46, 0x40000000, v27
    v_lshrrev_b32 v47, 14, v24
    v_bitop3_b32 v47, v47, v5, v46 bitop3:0xea
    ds_read_b64 v[104:105], v47
    v_bitop3_b32 v94, v24, v5, v46 bitop3:0xea
    s_waitcnt lgkmcnt(2)
    v_mfma_f32_4x4x4_16b_bf16 v[80:83], v[10:11], v[70:71], v[80:83]
    v_mfma_f32_4x4x4_16b_bf16 v[76:79], v[10:11], v[68:69], v[76:79]
    v_perm_b32 v15, v25, v26, s47
    v_bitop3_b32 v46, v25, 0.5, -0.5 bitop3:0xa8
    v_perm_b32 v14, v24, v26, s46
    v_bitop3_b32 v47, v24, 0.5, -0.5 bitop3:0xa8
    v_cvt_pk_bf16_f32 v80, v80, v81
    v_cvt_pk_bf16_f32 v81, v82, v83
    ds_wrxchg_rtn_b64 v[74:75], v93, v[80:81] offset:65408
    v_cvt_pk_bf16_f32 v76, v76, v77
    v_cvt_pk_bf16_f32 v77, v78, v79
    ds_wrxchg_rtn_b64 v[72:73], v92, v[76:77] offset:65408
    s_setprio 1
    s_waitcnt lgkmcnt(2)
    v_mfma_f32_4x4x4_16b_bf16 v[80:83], v[8:9], v[106:107], 0
    v_mfma_f32_4x4x4_16b_bf16 v[76:79], v[8:9], v[104:105], 0
    v_bitop3_b32 v15, v6, v15, v46 bitop3:0xca
    v_bitop3_b32 v14, v6, v14, v47 bitop3:0xca
    s_nop 1
    v_pk_mul_f32 v[80:81], v[80:81], v[14:15] op_sel:[0,1] op_sel_hi:[1,1]
    v_pk_mul_f32 v[82:83], v[82:83], v[14:15] op_sel:[0,1] op_sel_hi:[1,1]
    v_pk_mul_f32 v[76:77], v[76:77], v[14:15] op_sel:[0,0] op_sel_hi:[1,0]
    v_pk_mul_f32 v[78:79], v[78:79], v[14:15] op_sel:[0,0] op_sel_hi:[1,0]
    s_lshl_b32 s3, s32, 12
    v_subrev_u32 v122, s3, v3
    s_mul_i32 s3, s33, 20000
    v_add_u32 v118, s3, v122
    v_add_u32 v119, 0x4000, v118
    s_lshl_b32 s3, s34, 7
    v_lshrrev_b32 v123, 7, v118
    v_and_b32 v120, 0x70, v118
    v_lshl_add_u32 v120, v123, 13, v120
    v_add_u32 v120, s3, v120
    v_lshrrev_b32 v123, 7, v119
    v_and_b32 v121, 0x70, v119
    v_lshl_add_u32 v121, v123, 13, v121
    v_add_u32 v121, s3, v121
    v_cmp_le_u32 vcc, 3616, v122
    s_mov_b64 exec, vcc
    v_mov_b32 v119, 2.0
    v_mov_b32 v121, 2.0
    s_mov_b64 exec, -1
    v_and_b32 v123, 0x30, v122
    v_lshlrev_b32 v123, 2, v123
    buffer_load_dwordx4 v[48:51], v123, s[24:27], 0 offen
    buffer_load_dwordx4 v[52:55], v123, s[24:27], 0 offen offset:16
    buffer_load_dwordx2 v[56:57], v123, s[24:27], 0 offen offset:32
    s_mov_b32 s12, s4
    s_mov_b32 s13, s5
    s_mov_b32 s14, 0x138800
    s_mov_b32 s15, 0x20000
    s_mov_b32 s16, s28
    s_mov_b32 s17, s29
    s_mov_b32 s18, 0x4e2000
    s_mov_b32 s19, 0x20000
    v_lshrrev_b32 v123, 2, v120
    buffer_load_dword v116, v123, s[12:15], 0 offen
    buffer_load_dwordx4 v[108:111], v120, s[16:19], 0 offen
    v_lshrrev_b32 v123, 2, v121
    buffer_load_dword v117, v123, s[12:15], 0 offen
    buffer_load_dwordx4 v[112:115], v121, s[16:19], 0 offen
    s_waitcnt lgkmcnt(0)
    v_cmp_ne_u64 s[50:51], v[72:73], v[68:69]
    v_cmpx_ne_u64 s[54:55], v[74:75], v[70:71]
    s_and_b64 s[82:83], s[54:55], s[80:81]
    s_cbranch_scc1 L2_c142
L2_d142:
    v_mov_b64 v[84:85], v[70:71]
    v_mov_b32 v7, v93
    v_mov_b64 v[86:87], v[74:75]
    s_or_b64 s[80:81], s[80:81], s[54:55]
    s_mov_b64 exec, s[50:51]
    s_and_b64 s[82:83], s[50:51], s[80:81]
    s_cbranch_scc1 L2_c143
L2_d143:
    v_mov_b64 v[84:85], v[68:69]
    v_mov_b32 v7, v92
    v_mov_b64 v[86:87], v[72:73]
    s_mov_b64 exec, -1
    s_or_b64 s[80:81], s[80:81], s[50:51]
    ds_read_b64 v[70:71], v95 offset:65408
    ds_read_b64 v[68:69], v94 offset:65408
    s_waitcnt vmcnt(9)
    v_and_b32 v46, 0x20000000, v33
    v_lshrrev_b32 v47, 14, v29
    v_bitop3_b32 v47, v47, v5, v46 bitop3:0xea
    ds_read_b64 v[102:103], v47
    v_bitop3_b32 v93, v29, v5, v46 bitop3:0xea
    v_and_b32 v46, 0x10000000, v33
    v_lshrrev_b32 v47, 14, v28
    v_bitop3_b32 v47, v47, v5, v46 bitop3:0xea
    ds_read_b64 v[100:101], v47
    v_bitop3_b32 v92, v28, v5, v46 bitop3:0xea
    s_waitcnt lgkmcnt(2)
    v_mfma_f32_4x4x4_16b_bf16 v[80:83], v[10:11], v[70:71], v[80:83]
    v_mfma_f32_4x4x4_16b_bf16 v[76:79], v[10:11], v[68:69], v[76:79]
    v_perm_b32 v15, v29, v32, s45
    v_bitop3_b32 v46, v29, 0.5, -0.5 bitop3:0xa8
    v_perm_b32 v14, v28, v32, s44
    v_bitop3_b32 v47, v28, 0.5, -0.5 bitop3:0xa8
    v_cvt_pk_bf16_f32 v80, v80, v81
    v_cvt_pk_bf16_f32 v81, v82, v83
    ds_wrxchg_rtn_b64 v[74:75], v95, v[80:81] offset:65408
    v_cvt_pk_bf16_f32 v76, v76, v77
    v_cvt_pk_bf16_f32 v77, v78, v79
    ds_wrxchg_rtn_b64 v[72:73], v94, v[76:77] offset:65408
    s_waitcnt lgkmcnt(2)
    v_mfma_f32_4x4x4_16b_bf16 v[80:83], v[8:9], v[102:103], 0
    v_mfma_f32_4x4x4_16b_bf16 v[76:79], v[8:9], v[100:101], 0
    v_bitop3_b32 v15, v6, v15, v46 bitop3:0xca
    v_bitop3_b32 v14, v6, v14, v47 bitop3:0xca
    v_cmp_lt_u32 s[84:85], v5, v92
    s_nop 0
    v_pk_mul_f32 v[80:81], v[80:81], v[14:15] op_sel:[0,1] op_sel_hi:[1,1]
    v_pk_mul_f32 v[82:83], v[82:83], v[14:15] op_sel:[0,1] op_sel_hi:[1,1]
    v_pk_mul_f32 v[76:77], v[76:77], v[14:15] op_sel:[0,0] op_sel_hi:[1,0]
    v_pk_mul_f32 v[78:79], v[78:79], v[14:15] op_sel:[0,0] op_sel_hi:[1,0]
    s_waitcnt lgkmcnt(0)
    v_cmp_ne_u64 s[50:51], v[72:73], v[68:69]
    v_cmpx_ne_u64 s[54:55], v[74:75], v[70:71]
    s_and_b64 s[82:83], s[54:55], s[80:81]
    s_cbranch_scc1 L2_c144
L2_d144:
    v_mov_b64 v[84:85], v[70:71]
    v_mov_b32 v7, v95
    v_mov_b64 v[86:87], v[74:75]
    s_or_b64 s[80:81], s[80:81], s[54:55]
    s_mov_b64 exec, s[50:51]
    s_and_b64 s[82:83], s[50:51], s[80:81]
    s_cbranch_scc1 L2_c145
L2_d145:
    v_mov_b64 v[84:85], v[68:69]
    v_mov_b32 v7, v94
    v_mov_b64 v[86:87], v[72:73]
    s_mov_b64 exec, -1
    s_or_b64 s[80:81], s[80:81], s[50:51]
    ds_read_b64 v[70:71], v93 offset:65408
    s_and_b64 exec, s[84:85], s[80:81]
    v_mfma_f32_4x4x4_16b_bf16 v[76:79], v[12:13], v[84:85], 0
    v_mov_b32 v92, v7
    s_andn2_b64 s[80:81], s[80:81], s[84:85]
    v_mfma_f32_4x4x4_16b_bf16 v[76:79], v[10:11], v[86:87], v[76:79]
    s_mov_b64 exec, -1
    ds_read_b64 v[68:69], v92 offset:65408
    v_and_b32 v46, 0x80000000, v33
    v_lshrrev_b32 v47, 14, v31
    v_bitop3_b32 v47, v47, v5, v46 bitop3:0xea
    ds_read_b64 v[106:107], v47
    v_bitop3_b32 v95, v31, v5, v46 bitop3:0xea
    v_and_b32 v46, 0x40000000, v33
    v_lshrrev_b32 v47, 14, v30
    v_bitop3_b32 v47, v47, v5, v46 bitop3:0xea
    ds_read_b64 v[104:105], v47
    v_bitop3_b32 v94, v30, v5, v46 bitop3:0xea
    s_waitcnt lgkmcnt(2)
    v_mfma_f32_4x4x4_16b_bf16 v[80:83], v[10:11], v[70:71], v[80:83]
    v_mfma_f32_4x4x4_16b_bf16 v[76:79], v[10:11], v[68:69], v[76:79]
    v_perm_b32 v15, v31, v32, s47
    v_bitop3_b32 v46, v31, 0.5, -0.5 bitop3:0xa8
    v_perm_b32 v14, v30, v32, s46
    v_bitop3_b32 v47, v30, 0.5, -0.5 bitop3:0xa8
    v_cvt_pk_bf16_f32 v80, v80, v81
    v_cvt_pk_bf16_f32 v81, v82, v83
    ds_wrxchg_rtn_b64 v[74:75], v93, v[80:81] offset:65408
    v_cvt_pk_bf16_f32 v76, v76, v77
    v_cvt_pk_bf16_f32 v77, v78, v79
    ds_wrxchg_rtn_b64 v[72:73], v92, v[76:77] offset:65408
    s_setprio 0
    s_waitcnt lgkmcnt(2)
    v_mfma_f32_4x4x4_16b_bf16 v[80:83], v[8:9], v[106:107], 0
    v_mfma_f32_4x4x4_16b_bf16 v[76:79], v[8:9], v[104:105], 0
    v_bitop3_b32 v15, v6, v15, v46 bitop3:0xca
    v_bitop3_b32 v14, v6, v14, v47 bitop3:0xca
    s_nop 1
    v_pk_mul_f32 v[80:81], v[80:81], v[14:15] op_sel:[0,1] op_sel_hi:[1,1]
    v_pk_mul_f32 v[82:83], v[82:83], v[14:15] op_sel:[0,1] op_sel_hi:[1,1]
    v_pk_mul_f32 v[76:77], v[76:77], v[14:15] op_sel:[0,0] op_sel_hi:[1,0]
    v_pk_mul_f32 v[78:79], v[78:79], v[14:15] op_sel:[0,0] op_sel_hi:[1,0]
    s_waitcnt lgkmcnt(0)
    v_cmp_ne_u64 s[50:51], v[72:73], v[68:69]
    v_cmpx_ne_u64 s[54:55], v[74:75], v[70:71]
    s_and_b64 s[82:83], s[54:55], s[80:81]
    s_cbranch_scc1 L2_c146
L2_d146:
    v_mov_b64 v[84:85], v[70:71]
    v_mov_b32 v7, v93
    v_mov_b64 v[86:87], v[74:75]
    s_or_b64 s[80:81], s[80:81], s[54:55]
    s_mov_b64 exec, s[50:51]
    s_and_b64 s[82:83], s[50:51], s[80:81]
    s_cbranch_scc1 L2_c147
L2_d147:
    v_mov_b64 v[84:85], v[68:69]
    v_mov_b32 v7, v92
    v_mov_b64 v[86:87], v[72:73]
    s_mov_b64 exec, -1
    s_or_b64 s[80:81], s[80:81], s[50:51]
    ds_read_b64 v[70:71], v95 offset:65408
    ds_read_b64 v[68:69], v94 offset:65408
    s_waitcnt vmcnt(7)
    v_and_b32 v46, 0x20000000, v39
    v_lshrrev_b32 v47, 14, v35
    v_bitop3_b32 v47, v47, v5, v46 bitop3:0xea
    ds_read_b64 v[102:103], v47
    v_bitop3_b32 v93, v35, v5, v46 bitop3:0xea
    v_and_b32 v46, 0x10000000, v39
    v_lshrrev_b32 v47, 14, v34
    v_bitop3_b32 v47, v47, v5, v46 bitop3:0xea
    ds_read_b64 v[100:101], v47
    v_bitop3_b32 v92, v34, v5, v46 bitop3:0xea
    v_and_b32 v46, 0x80000000, v39
    v_lshrrev_b32 v47, 14, v37
    v_bitop3_b32 v47, v47, v5, v46 bitop3:0xea
    ds_read_b64 v[106:107], v47
    v_and_b32 v46, 0x40000000, v39
    v_lshrrev_b32 v47, 14, v36
    v_bitop3_b32 v47, v47, v5, v46 bitop3:0xea
    ds_read_b64 v[104:105], v47
    s_waitcnt lgkmcnt(4)
    v_mfma_f32_4x4x4_16b_bf16 v[80:83], v[10:11], v[70:71], v[80:83]
    v_mfma_f32_4x4x4_16b_bf16 v[76:79], v[10:11], v[68:69], v[76:79]
    v_perm_b32 v15, v35, v38, s45
    v_bitop3_b32 v46, v35, 0.5, -0.5 bitop3:0xa8
    v_perm_b32 v14, v34, v38, s44
    v_bitop3_b32 v47, v34, 0.5, -0.5 bitop3:0xa8
    v_cvt_pk_bf16_f32 v80, v80, v81
    v_cvt_pk_bf16_f32 v81, v82, v83
    ds_wrxchg_rtn_b64 v[74:75], v95, v[80:81] offset:65408
    v_cvt_pk_bf16_f32 v76, v76, v77
    v_cvt_pk_bf16_f32 v77, v78, v79
    ds_wrxchg_rtn_b64 v[72:73], v94, v[76:77] offset:65408
    s_waitcnt lgkmcnt(4)
    v_mfma_f32_4x4x4_16b_bf16 v[80:83], v[8:9], v[102:103], 0
    v_mfma_f32_4x4x4_16b_bf16 v[76:79], v[8:9], v[100:101], 0
    v_bitop3_b32 v15, v6, v15, v46 bitop3:0xca
    v_bitop3_b32 v14, v6, v14, v47 bitop3:0xca
    v_cmp_lt_u32 s[84:85], v5, v92
    s_nop 0
    v_pk_mul_f32 v[80:81], v[80:81], v[14:15] op_sel:[0,1] op_sel_hi:[1,1]
    v_pk_mul_f32 v[82:83], v[82:83], v[14:15] op_sel:[0,1] op_sel_hi:[1,1]
    v_pk_mul_f32 v[76:77], v[76:77], v[14:15] op_sel:[0,0] op_sel_hi:[1,0]
    v_pk_mul_f32 v[78:79], v[78:79], v[14:15] op_sel:[0,0] op_sel_hi:[1,0]
    s_waitcnt lgkmcnt(0)
    v_cmp_ne_u64 s[50:51], v[72:73], v[68:69]
    v_cmpx_ne_u64 s[54:55], v[74:75], v[70:71]
    s_and_b64 s[82:83], s[54:55], s[80:81]
    s_cbranch_scc1 L2_c148
L2_d148:
    v_mov_b64 v[84:85], v[70:71]
    v_mov_b32 v7, v95
    v_mov_b64 v[86:87], v[74:75]
    s_or_b64 s[80:81], s[80:81], s[54:55]
    s_mov_b64 exec, s[50:51]
    s_and_b64 s[82:83], s[50:51], s[80:81]
    s_cbranch_scc1 L2_c149
L2_d149:
    v_mov_b64 v[84:85], v[68:69]
    v_mov_b32 v7, v94
    v_mov_b64 v[86:87], v[72:73]
    s_mov_b64 exec, -1
    s_or_b64 s[80:81], s[80:81], s[50:51]
    ds_read_b64 v[70:71], v93 offset:65408
    s_and_b64 exec, s[84:85], s[80:81]
    v_mfma_f32_4x4x4_16b_bf16 v[76:79], v[12:13], v[84:85], 0
    v_mov_b32 v92, v7
    s_andn2_b64 s[80:81], s[80:81], s[84:85]
    v_mfma_f32_4x4x4_16b_bf16 v[76:79], v[10:11], v[86:87], v[76:79]
    s_mov_b64 exec, -1
    ds_read_b64 v[68:69], v92 offset:65408
    s_waitcnt lgkmcnt(0)
    v_mfma_f32_4x4x4_16b_bf16 v[80:83], v[10:11], v[70:71], v[80:83]
    v_mfma_f32_4x4x4_16b_bf16 v[76:79], v[10:11], v[68:69], v[76:79]
    v_and_b32 v46, 0x40000000, v39
    v_bitop3_b32 v94, v36, v5, v46 bitop3:0xea
    v_and_b32 v46, 0x80000000, v39
    v_bitop3_b32 v95, v37, v5, v46 bitop3:0xea
    v_perm_b32 v15, v37, v38, s47
    v_bitop3_b32 v46, v37, 0.5, -0.5 bitop3:0xa8
    v_perm_b32 v14, v36, v38, s46
    v_bitop3_b32 v47, v36, 0.5, -0.5 bitop3:0xa8
    v_cvt_pk_bf16_f32 v80, v80, v81
    v_cvt_pk_bf16_f32 v81, v82, v83
    ds_wrxchg_rtn_b64 v[74:75], v93, v[80:81] offset:65408
    v_cvt_pk_bf16_f32 v76, v76, v77
    v_cvt_pk_bf16_f32 v77, v78, v79
    ds_wrxchg_rtn_b64 v[72:73], v92, v[76:77] offset:65408
    v_mfma_f32_4x4x4_16b_bf16 v[80:83], v[8:9], v[106:107], 0
    v_mfma_f32_4x4x4_16b_bf16 v[76:79], v[8:9], v[104:105], 0
    v_bitop3_b32 v15, v6, v15, v46 bitop3:0xca
    v_bitop3_b32 v14, v6, v14, v47 bitop3:0xca
    s_nop 1
    v_pk_mul_f32 v[80:81], v[80:81], v[14:15] op_sel:[0,1] op_sel_hi:[1,1]
    v_pk_mul_f32 v[82:83], v[82:83], v[14:15] op_sel:[0,1] op_sel_hi:[1,1]
    v_pk_mul_f32 v[76:77], v[76:77], v[14:15] op_sel:[0,0] op_sel_hi:[1,0]
    v_pk_mul_f32 v[78:79], v[78:79], v[14:15] op_sel:[0,0] op_sel_hi:[1,0]
    s_waitcnt lgkmcnt(0)
    v_cmp_ne_u64 s[50:51], v[72:73], v[68:69]
    v_cmpx_ne_u64 s[54:55], v[74:75], v[70:71]
    s_and_b64 s[82:83], s[54:55], s[80:81]
    s_cbranch_scc1 L2_c150
L2_d150:
    v_mov_b64 v[84:85], v[70:71]
    v_mov_b32 v7, v93
    v_mov_b64 v[86:87], v[74:75]
    s_or_b64 s[80:81], s[80:81], s[54:55]
    s_mov_b64 exec, s[50:51]
    s_and_b64 s[82:83], s[50:51], s[80:81]
    s_cbranch_scc1 L2_c151
L2_d151:
    v_mov_b64 v[84:85], v[68:69]
    v_mov_b32 v7, v92
    v_mov_b64 v[86:87], v[72:73]
    s_mov_b64 exec, -1
    s_or_b64 s[80:81], s[80:81], s[50:51]
    ds_read_b64 v[70:71], v95 offset:65408
    ds_read_b64 v[68:69], v94 offset:65408
    s_waitcnt lgkmcnt(0)
    v_mfma_f32_4x4x4_16b_bf16 v[80:83], v[10:11], v[70:71], v[80:83]
    v_mfma_f32_4x4x4_16b_bf16 v[76:79], v[10:11], v[68:69], v[76:79]
    s_nop 3
    v_cvt_pk_bf16_f32 v80, v80, v81
    v_cvt_pk_bf16_f32 v81, v82, v83
    ds_wrxchg_rtn_b64 v[74:75], v95, v[80:81] offset:65408
    v_cvt_pk_bf16_f32 v76, v76, v77
    v_cvt_pk_bf16_f32 v77, v78, v79
    ds_wrxchg_rtn_b64 v[72:73], v94, v[76:77] offset:65408
    s_waitcnt lgkmcnt(0)
    v_cmpx_ne_u64 vcc, v[74:75], v[70:71]
    s_and_b64 s[82:83], vcc, s[80:81]
    s_cbranch_scc1 L2_c152
L2_d152:
    v_mov_b64 v[84:85], v[70:71]
    v_mov_b32 v7, v95
    v_mov_b64 v[86:87], v[74:75]
    s_mov_b64 exec, -1
    s_or_b64 s[80:81], s[80:81], vcc
    v_cmpx_ne_u64 vcc, v[72:73], v[68:69]
    s_and_b64 s[82:83], vcc, s[80:81]
    s_cbranch_scc1 L2_c153
L2_d153:
    v_mov_b64 v[84:85], v[68:69]
    v_mov_b32 v7, v94
    v_mov_b64 v[86:87], v[72:73]
    s_mov_b64 exec, -1
    s_or_b64 s[80:81], s[80:81], vcc
    s_mov_b64 exec, s[80:81]
    s_nop 1
    v_mfma_f32_4x4x4_16b_bf16 v[88:91], v[12:13], v[84:85], 0
    s_nop 1
    v_mfma_f32_4x4x4_16b_bf16 v[88:91], v[10:11], v[86:87], v[88:91]
    s_nop 4
    v_cvt_pk_bf16_f32 v88, v88, v89
    v_cvt_pk_bf16_f32 v89, v90, v91
    ds_pk_add_bf16 v7, v88 offset:65408
    ds_pk_add_bf16 v7, v89 offset:65412
    s_mov_b64 exec, -1
    s_load_dwordx2 s[4:5], s[0:1], 88
    v_add_u32 v123, 16384, v122
    v_add_u32 v124, 32768, v122
    v_add_u32 v125, 49152, v122
    v_add_u32 v126, 65536, v122
    s_lshl_b32 s50, s96, 16
    s_and_b32 s51, s96, 0xffff0000
    s_lshl_b32 s52, s97, 16
    s_and_b32 s53, s97, 0xffff0000
    s_lshl_b32 s54, s98, 16
    s_and_b32 s55, s98, 0xffff0000
    s_lshl_b32 s56, s99, 16
    s_and_b32 s57, s99, 0xffff0000
    s_waitcnt vmcnt(0) lgkmcnt(0)
    s_barrier
    v_add_u32 v36, 0x8000, v126
    ds_read_b128 v[16:19], v126 offset:16384
    ds_read_b128 v[20:23], v126 offset:32768
    ds_read_b128 v[24:27], v126 offset:49152
    ds_read_b128 v[28:31], v36 offset:32768
    ds_read_b128 v[32:35], v36 offset:49152
    s_add_u32 s8, s30, 0xebce000
    s_addc_u32 s9, s31, 0
    s_mov_b32 s10, 0x8000
    s_mov_b32 s11, 0x20000
    s_mov_b32 s12, s4
    s_mov_b32 s13, s5
    s_mov_b32 s14, 0x4e2000
    s_mov_b32 s15, 0x20000
    s_mul_i32 s3, s33, 20000
    v_subrev_u32 v36, s3, v122
    v_cmp_le_u32 vcc, 20000, v36
    s_waitcnt lgkmcnt(4)
    s_mov_b64 exec, vcc
    buffer_store_dwordx4 v[16:19], v122, s[20:23], 0 offen sc1
    s_mov_b64 exec, -1
    v_subrev_u32 v36, s3, v123
    v_cmp_le_u32 vcc, 20000, v36
    s_waitcnt lgkmcnt(3)
    s_mov_b64 exec, vcc
    buffer_store_dwordx4 v[20:23], v123, s[20:23], 0 offen sc1
    s_mov_b64 exec, -1
    v_subrev_u32 v36, s3, v124
    v_cmp_le_u32 vcc, 20000, v36
    s_waitcnt lgkmcnt(2)
    s_mov_b64 exec, vcc
    buffer_store_dwordx4 v[24:27], v124, s[20:23], 0 offen sc1
    s_mov_b64 exec, -1
    v_subrev_u32 v36, s3, v125
    v_cmp_le_u32 vcc, 20000, v36
    s_waitcnt lgkmcnt(1)
    s_mov_b64 exec, vcc
    buffer_store_dwordx4 v[28:31], v125, s[20:23], 0 offen sc1
    s_mov_b64 exec, -1
    v_subrev_u32 v36, s3, v126
    v_cmp_le_u32 vcc, 20000, v36
    s_waitcnt lgkmcnt(0)
    s_mov_b64 exec, vcc
    buffer_store_dwordx4 v[32:35], v126, s[20:23], 0 offen sc1
    s_mov_b64 exec, -1
    v_lshlrev_b32 v80, 16, v116
    v_subrev_f32 v60, s50, v80
    v_subrev_f32 v61, s51, v80
    v_subrev_f32 v62, s52, v80
    v_subrev_f32 v63, s53, v80
    v_subrev_f32 v64, s54, v80
    v_subrev_f32 v65, s55, v80
    v_subrev_f32 v66, s56, v80
    v_subrev_f32 v67, s57, v80
    v_cvt_pk_bf16_f32 v68, v60, v61
    v_cvt_pk_bf16_f32 v69, v62, v63
    v_cvt_pk_bf16_f32 v70, v64, v65
    v_cvt_pk_bf16_f32 v71, v66, v67
    v_lshlrev_b32 v60, 16, v68
    v_and_b32 v61, 0xffff0000, v68
    v_lshlrev_b32 v62, 16, v69
    v_and_b32 v63, 0xffff0000, v69
    v_lshlrev_b32 v64, 16, v70
    v_and_b32 v65, 0xffff0000, v70
    v_lshlrev_b32 v66, 16, v71
    v_and_b32 v67, 0xffff0000, v71
    v_mul_f32 v60, v60, v60
    v_mul_f32 v61, v61, v61
    v_mul_f32 v62, v62, v62
    v_mul_f32 v63, v63, v63
    v_mul_f32 v64, v64, v64
    v_mul_f32 v65, v65, v65
    v_mul_f32 v66, v66, v66
    v_mul_f32 v67, v67, v67
    v_cvt_pk_bf16_f32 v68, v60, v61
    v_cvt_pk_bf16_f32 v69, v62, v63
    v_cvt_pk_bf16_f32 v70, v64, v65
    v_cvt_pk_bf16_f32 v71, v66, v67
    v_lshlrev_b32 v60, 16, v68
    v_and_b32 v61, 0xffff0000, v68
    v_lshlrev_b32 v62, 16, v69
    v_and_b32 v63, 0xffff0000, v69
    v_lshlrev_b32 v64, 16, v70
    v_and_b32 v65, 0xffff0000, v70
    v_lshlrev_b32 v66, 16, v71
    v_and_b32 v67, 0xffff0000, v71
    v_mul_f32 v60, 0xc1200000, v60
    v_mul_f32 v61, 0xc1200000, v61
    v_mul_f32 v62, 0xc1200000, v62
    v_mul_f32 v63, 0xc1200000, v63
    v_mul_f32 v64, 0xc1200000, v64
    v_mul_f32 v65, 0xc1200000, v65
    v_mul_f32 v66, 0xc1200000, v66
    v_mul_f32 v67, 0xc1200000, v67
    v_cvt_pk_bf16_f32 v68, v60, v61
    v_cvt_pk_bf16_f32 v69, v62, v63
    v_cvt_pk_bf16_f32 v70, v64, v65
    v_cvt_pk_bf16_f32 v71, v66, v67
    v_lshlrev_b32 v60, 16, v68
    v_and_b32 v61, 0xffff0000, v68
    v_lshlrev_b32 v62, 16, v69
    v_and_b32 v63, 0xffff0000, v69
    v_lshlrev_b32 v64, 16, v70
    v_and_b32 v65, 0xffff0000, v70
    v_lshlrev_b32 v66, 16, v71
    v_and_b32 v67, 0xffff0000, v71
    v_mul_f32 v60, 0x3fb8aa3b, v60
    v_mul_f32 v61, 0x3fb8aa3b, v61
    v_mul_f32 v62, 0x3fb8aa3b, v62
    v_mul_f32 v63, 0x3fb8aa3b, v63
    v_mul_f32 v64, 0x3fb8aa3b, v64
    v_mul_f32 v65, 0x3fb8aa3b, v65
    v_mul_f32 v66, 0x3fb8aa3b, v66
    v_mul_f32 v67, 0x3fb8aa3b, v67
    v_exp_f32 v60, v60
    v_exp_f32 v61, v61
    v_exp_f32 v62, v62
    v_exp_f32 v63, v63
    v_exp_f32 v64, v64
    v_exp_f32 v65, v65
    v_exp_f32 v66, v66
    v_exp_f32 v67, v67
    v_cvt_pk_bf16_f32 v72, v60, v61
    v_cvt_pk_bf16_f32 v73, v62, v63
    v_cvt_pk_bf16_f32 v74, v64, v65
    v_cvt_pk_bf16_f32 v75, v66, v67
    v_and_b32 v80, 0xffff0000, v116
    v_subrev_f32 v60, s50, v80
    v_subrev_f32 v61, s51, v80
    v_subrev_f32 v62, s52, v80
    v_subrev_f32 v63, s53, v80
    v_subrev_f32 v64, s54, v80
    v_subrev_f32 v65, s55, v80
    v_subrev_f32 v66, s56, v80
    v_subrev_f32 v67, s57, v80
    v_cvt_pk_bf16_f32 v68, v60, v61
    v_cvt_pk_bf16_f32 v69, v62, v63
    v_cvt_pk_bf16_f32 v70, v64, v65
    v_cvt_pk_bf16_f32 v71, v66, v67
    v_lshlrev_b32 v60, 16, v68
    v_and_b32 v61, 0xffff0000, v68
    v_lshlrev_b32 v62, 16, v69
    v_and_b32 v63, 0xffff0000, v69
    v_lshlrev_b32 v64, 16, v70
    v_and_b32 v65, 0xffff0000, v70
    v_lshlrev_b32 v66, 16, v71
    v_and_b32 v67, 0xffff0000, v71
    v_mul_f32 v60, v60, v60
    v_mul_f32 v61, v61, v61
    v_mul_f32 v62, v62, v62
    v_mul_f32 v63, v63, v63
    v_mul_f32 v64, v64, v64
    v_mul_f32 v65, v65, v65
    v_mul_f32 v66, v66, v66
    v_mul_f32 v67, v67, v67
    v_cvt_pk_bf16_f32 v68, v60, v61
    v_cvt_pk_bf16_f32 v69, v62, v63
    v_cvt_pk_bf16_f32 v70, v64, v65
    v_cvt_pk_bf16_f32 v71, v66, v67
    v_lshlrev_b32 v60, 16, v68
    v_and_b32 v61, 0xffff0000, v68
    v_lshlrev_b32 v62, 16, v69
    v_and_b32 v63, 0xffff0000, v69
    v_lshlrev_b32 v64, 16, v70
    v_and_b32 v65, 0xffff0000, v70
    v_lshlrev_b32 v66, 16, v71
    v_and_b32 v67, 0xffff0000, v71
    v_mul_f32 v60, 0xc1200000, v60
    v_mul_f32 v61, 0xc1200000, v61
    v_mul_f32 v62, 0xc1200000, v62
    v_mul_f32 v63, 0xc1200000, v63
    v_mul_f32 v64, 0xc1200000, v64
    v_mul_f32 v65, 0xc1200000, v65
    v_mul_f32 v66, 0xc1200000, v66
    v_mul_f32 v67, 0xc1200000, v67
    v_cvt_pk_bf16_f32 v68, v60, v61
    v_cvt_pk_bf16_f32 v69, v62, v63
    v_cvt_pk_bf16_f32 v70, v64, v65
    v_cvt_pk_bf16_f32 v71, v66, v67
    v_lshlrev_b32 v60, 16, v68
    v_and_b32 v61, 0xffff0000, v68
    v_lshlrev_b32 v62, 16, v69
    v_and_b32 v63, 0xffff0000, v69
    v_lshlrev_b32 v64, 16, v70
    v_and_b32 v65, 0xffff0000, v70
    v_lshlrev_b32 v66, 16, v71
    v_and_b32 v67, 0xffff0000, v71
    v_mul_f32 v60, 0x3fb8aa3b, v60
    v_mul_f32 v61, 0x3fb8aa3b, v61
    v_mul_f32 v62, 0x3fb8aa3b, v62
    v_mul_f32 v63, 0x3fb8aa3b, v63
    v_mul_f32 v64, 0x3fb8aa3b, v64
    v_mul_f32 v65, 0x3fb8aa3b, v65
    v_mul_f32 v66, 0x3fb8aa3b, v66
    v_mul_f32 v67, 0x3fb8aa3b, v67
    v_exp_f32 v60, v60
    v_exp_f32 v61, v61
    v_exp_f32 v62, v62
    v_exp_f32 v63, v63
    v_exp_f32 v64, v64
    v_exp_f32 v65, v65
    v_exp_f32 v66, v66
    v_exp_f32 v67, v67
    v_cvt_pk_bf16_f32 v76, v60, v61
    v_cvt_pk_bf16_f32 v77, v62, v63
    v_cvt_pk_bf16_f32 v78, v64, v65
    v_cvt_pk_bf16_f32 v79, v66, v67
    v_mfma_f32_4x4x4_16b_bf16 v[80:83], v[48:49], v[72:73], 0
    v_mfma_f32_4x4x4_16b_bf16 v[88:91], v[52:53], v[72:73], 0
    v_mfma_f32_4x4x4_16b_bf16 v[84:87], v[48:49], v[76:77], 0
    v_mfma_f32_4x4x4_16b_bf16 v[92:95], v[52:53], v[76:77], 0
    v_mfma_f32_4x4x4_16b_bf16 v[80:83], v[50:51], v[74:75], v[80:83]
    v_mfma_f32_4x4x4_16b_bf16 v[88:91], v[54:55], v[74:75], v[88:91]
    v_mfma_f32_4x4x4_16b_bf16 v[84:87], v[50:51], v[78:79], v[84:87]
    v_mfma_f32_4x4x4_16b_bf16 v[92:95], v[54:55], v[78:79], v[92:95]
    v_add_u32 v104, 81920, v118
    ds_read_b128 v[32:35], v104
    v_add_u32 v104, 81920, v119
    ds_read_b128 v[60:63], v104
    s_add_u32 s20, s30, 0xd845000
    s_addc_u32 s21, s31, 0
    s_mov_b32 s22, 0x1388000
    s_mov_b32 s23, 0x20000
    s_add_u32 s3, s33, 1
    s_and_b32 s3, s3, 3
    s_lshl_b32 s3, s3, 6
    s_add_u32 s3, s3, s34
    s_mul_i32 s44, s3, 80000
    s_add_u32 s3, s33, 2
    s_and_b32 s3, s3, 3
    s_lshl_b32 s3, s3, 6
    s_add_u32 s3, s3, s34
    s_mul_i32 s45, s3, 80000
    s_add_u32 s3, s33, 3
    s_and_b32 s3, s3, 3
    s_lshl_b32 s3, s3, 6
    s_add_u32 s3, s3, s34
    s_mul_i32 s46, s3, 80000
    s_lshl_b32 s3, s34, 9
    s_lshl_b32 s4, s33, 7
    s_add_u32 s4, s4, s3
    v_mov_b32 v104, 1
    v_lshlrev_b32 v105, 3, v122
    s_waitcnt vmcnt(0)
    s_barrier
    s_cmp_lg_u32 s32, 0
    s_cbranch_scc1 L2_f2
    s_mov_b64 exec, 1
    buffer_store_dword v104, off, s[8:11], s4 sc1
    s_mov_b64 exec, 15
    s_bitset0_b64 exec, s33
L2_f3:
    buffer_load_dword v104, v105, s[8:11], s3 offen sc1
    s_waitcnt vmcnt(0)
    v_cmp_ne_u32 vcc, 1, v104
    s_cbranch_vccnz L2_f3
L2_f4:
    s_mov_b64 exec, -1
L2_f2:
    s_barrier
    buffer_load_dwordx4 v[36:39], v118, s[20:23], s44 offen sc1
    buffer_load_dwordx4 v[40:43], v118, s[20:23], s45 offen sc1
    buffer_load_dwordx4 v[44:47], v118, s[20:23], s46 offen sc1
    s_cmp_ge_u32 s32, 4
    s_cbranch_scc1 L2_f5
    buffer_load_dwordx4 v[64:67], v119, s[20:23], s44 offen sc1
    buffer_load_dwordx4 v[68:71], v119, s[20:23], s45 offen sc1
    buffer_load_dwordx4 v[72:75], v119, s[20:23], s46 offen sc1
    v_lshlrev_b32 v16, 16, v117
    v_subrev_f32 v96, s50, v16
    v_subrev_f32 v97, s51, v16
    v_subrev_f32 v98, s52, v16
    v_subrev_f32 v99, s53, v16
    v_subrev_f32 v100, s54, v16
    v_subrev_f32 v101, s55, v16
    v_subrev_f32 v102, s56, v16
    v_subrev_f32 v103, s57, v16
    v_cvt_pk_bf16_f32 v0, v96, v97
    v_cvt_pk_bf16_f32 v1, v98, v99
    v_cvt_pk_bf16_f32 v2, v100, v101
    v_cvt_pk_bf16_f32 v3, v102, v103
    v_lshlrev_b32 v96, 16, v0
    v_and_b32 v97, 0xffff0000, v0
    v_lshlrev_b32 v98, 16, v1
    v_and_b32 v99, 0xffff0000, v1
    v_lshlrev_b32 v100, 16, v2
    v_and_b32 v101, 0xffff0000, v2
    v_lshlrev_b32 v102, 16, v3
    v_and_b32 v103, 0xffff0000, v3
    v_mul_f32 v96, v96, v96
    v_mul_f32 v97, v97, v97
    v_mul_f32 v98, v98, v98
    v_mul_f32 v99, v99, v99
    v_mul_f32 v100, v100, v100
    v_mul_f32 v101, v101, v101
    v_mul_f32 v102, v102, v102
    v_mul_f32 v103, v103, v103
    v_cvt_pk_bf16_f32 v0, v96, v97
    v_cvt_pk_bf16_f32 v1, v98, v99
    v_cvt_pk_bf16_f32 v2, v100, v101
    v_cvt_pk_bf16_f32 v3, v102, v103
    v_lshlrev_b32 v96, 16, v0
    v_and_b32 v97, 0xffff0000, v0
    v_lshlrev_b32 v98, 16, v1
    v_and_b32 v99, 0xffff0000, v1
    v_lshlrev_b32 v100, 16, v2
    v_and_b32 v101, 0xffff0000, v2
    v_lshlrev_b32 v102, 16, v3
    v_and_b32 v103, 0xffff0000, v3
    v_mul_f32 v96, 0xc1200000, v96
    v_mul_f32 v97, 0xc1200000, v97
    v_mul_f32 v98, 0xc1200000, v98
    v_mul_f32 v99, 0xc1200000, v99
    v_mul_f32 v100, 0xc1200000, v100
    v_mul_f32 v101, 0xc1200000, v101
    v_mul_f32 v102, 0xc1200000, v102
    v_mul_f32 v103, 0xc1200000, v103
    v_cvt_pk_bf16_f32 v0, v96, v97
    v_cvt_pk_bf16_f32 v1, v98, v99
    v_cvt_pk_bf16_f32 v2, v100, v101
    v_cvt_pk_bf16_f32 v3, v102, v103
    v_lshlrev_b32 v96, 16, v0
    v_and_b32 v97, 0xffff0000, v0
    v_lshlrev_b32 v98, 16, v1
    v_and_b32 v99, 0xffff0000, v1
    v_lshlrev_b32 v100, 16, v2
    v_and_b32 v101, 0xffff0000, v2
    v_lshlrev_b32 v102, 16, v3
    v_and_b32 v103, 0xffff0000, v3
    v_mul_f32 v96, 0x3fb8aa3b, v96
    v_mul_f32 v97, 0x3fb8aa3b, v97
    v_mul_f32 v98, 0x3fb8aa3b, v98
    v_mul_f32 v99, 0x3fb8aa3b, v99
    v_mul_f32 v100, 0x3fb8aa3b, v100
    v_mul_f32 v101, 0x3fb8aa3b, v101
    v_mul_f32 v102, 0x3fb8aa3b, v102
    v_mul_f32 v103, 0x3fb8aa3b, v103
    v_exp_f32 v96, v96
    v_exp_f32 v97, v97
    v_exp_f32 v98, v98
    v_exp_f32 v99, v99
    v_exp_f32 v100, v100
    v_exp_f32 v101, v101
    v_exp_f32 v102, v102
    v_exp_f32 v103, v103
    v_cvt_pk_bf16_f32 v104, v96, v97
    v_cvt_pk_bf16_f32 v105, v98, v99
    v_cvt_pk_bf16_f32 v106, v100, v101
    v_cvt_pk_bf16_f32 v107, v102, v103
    v_and_b32 v16, 0xffff0000, v117
    v_subrev_f32 v96, s50, v16
    v_subrev_f32 v97, s51, v16
    v_subrev_f32 v98, s52, v16
    v_subrev_f32 v99, s53, v16
    v_subrev_f32 v100, s54, v16
    v_subrev_f32 v101, s55, v16
    v_subrev_f32 v102, s56, v16
    v_subrev_f32 v103, s57, v16
    v_cvt_pk_bf16_f32 v0, v96, v97
    v_cvt_pk_bf16_f32 v1, v98, v99
    v_cvt_pk_bf16_f32 v2, v100, v101
    v_cvt_pk_bf16_f32 v3, v102, v103
    v_lshlrev_b32 v96, 16, v0
    v_and_b32 v97, 0xffff0000, v0
    v_lshlrev_b32 v98, 16, v1
    v_and_b32 v99, 0xffff0000, v1
    v_lshlrev_b32 v100, 16, v2
    v_and_b32 v101, 0xffff0000, v2
    v_lshlrev_b32 v102, 16, v3
    v_and_b32 v103, 0xffff0000, v3
    v_mul_f32 v96, v96, v96
    v_mul_f32 v97, v97, v97
    v_mul_f32 v98, v98, v98
    v_mul_f32 v99, v99, v99
    v_mul_f32 v100, v100, v100
    v_mul_f32 v101, v101, v101
    v_mul_f32 v102, v102, v102
    v_mul_f32 v103, v103, v103
    v_cvt_pk_bf16_f32 v0, v96, v97
    v_cvt_pk_bf16_f32 v1, v98, v99
    v_cvt_pk_bf16_f32 v2, v100, v101
    v_cvt_pk_bf16_f32 v3, v102, v103
    v_lshlrev_b32 v96, 16, v0
    v_and_b32 v97, 0xffff0000, v0
    v_lshlrev_b32 v98, 16, v1
    v_and_b32 v99, 0xffff0000, v1
    v_lshlrev_b32 v100, 16, v2
    v_and_b32 v101, 0xffff0000, v2
    v_lshlrev_b32 v102, 16, v3
    v_and_b32 v103, 0xffff0000, v3
    v_mul_f32 v96, 0xc1200000, v96
    v_mul_f32 v97, 0xc1200000, v97
    v_mul_f32 v98, 0xc1200000, v98
    v_mul_f32 v99, 0xc1200000, v99
    v_mul_f32 v100, 0xc1200000, v100
    v_mul_f32 v101, 0xc1200000, v101
    v_mul_f32 v102, 0xc1200000, v102
    v_mul_f32 v103, 0xc1200000, v103
    v_cvt_pk_bf16_f32 v0, v96, v97
    v_cvt_pk_bf16_f32 v1, v98, v99
    v_cvt_pk_bf16_f32 v2, v100, v101
    v_cvt_pk_bf16_f32 v3, v102, v103
    v_lshlrev_b32 v96, 16, v0
    v_and_b32 v97, 0xffff0000, v0
    v_lshlrev_b32 v98, 16, v1
    v_and_b32 v99, 0xffff0000, v1
    v_lshlrev_b32 v100, 16, v2
    v_and_b32 v101, 0xffff0000, v2
    v_lshlrev_b32 v102, 16, v3
    v_and_b32 v103, 0xffff0000, v3
    v_mul_f32 v96, 0x3fb8aa3b, v96
    v_mul_f32 v97, 0x3fb8aa3b, v97
    v_mul_f32 v98, 0x3fb8aa3b, v98
    v_mul_f32 v99, 0x3fb8aa3b, v99
    v_mul_f32 v100, 0x3fb8aa3b, v100
    v_mul_f32 v101, 0x3fb8aa3b, v101
    v_mul_f32 v102, 0x3fb8aa3b, v102
    v_mul_f32 v103, 0x3fb8aa3b, v103
    v_exp_f32 v96, v96
    v_exp_f32 v97, v97
    v_exp_f32 v98, v98
    v_exp_f32 v99, v99
    v_exp_f32 v100, v100
    v_exp_f32 v101, v101
    v_exp_f32 v102, v102
    v_exp_f32 v103, v103
    v_cvt_pk_bf16_f32 v76, v96, v97
    v_cvt_pk_bf16_f32 v77, v98, v99
    v_cvt_pk_bf16_f32 v78, v100, v101
    v_cvt_pk_bf16_f32 v79, v102, v103
    v_mfma_f32_4x4x4_16b_bf16 v[16:19], v[48:49], v[104:105], 0
    v_mfma_f32_4x4x4_16b_bf16 v[24:27], v[52:53], v[104:105], 0
    v_mfma_f32_4x4x4_16b_bf16 v[20:23], v[48:49], v[76:77], 0
    v_mfma_f32_4x4x4_16b_bf16 v[28:31], v[52:53], v[76:77], 0
    v_mfma_f32_4x4x4_16b_bf16 v[16:19], v[50:51], v[106:107], v[16:19]
    v_mfma_f32_4x4x4_16b_bf16 v[24:27], v[54:55], v[106:107], v[24:27]
    v_mfma_f32_4x4x4_16b_bf16 v[20:23], v[50:51], v[78:79], v[20:23]
    v_mfma_f32_4x4x4_16b_bf16 v[28:31], v[54:55], v[78:79], v[28:31]
L2_f5:
    s_waitcnt vmcnt(0) lgkmcnt(0)
    v_mfma_f32_4x4x4_16b_bf16 v[96:99], v[10:11], v[32:33], 0
    v_mfma_f32_4x4x4_16b_bf16 v[100:103], v[10:11], v[34:35], 0
    s_nop 0
    v_mfma_f32_4x4x4_16b_bf16 v[96:99], v[10:11], v[36:37], v[96:99]
    v_mfma_f32_4x4x4_16b_bf16 v[100:103], v[10:11], v[38:39], v[100:103]
    s_nop 0
    v_mfma_f32_4x4x4_16b_bf16 v[96:99], v[10:11], v[40:41], v[96:99]
    v_mfma_f32_4x4x4_16b_bf16 v[100:103], v[10:11], v[42:43], v[100:103]
    s_nop 0
    v_mfma_f32_4x4x4_16b_bf16 v[96:99], v[10:11], v[44:45], v[96:99]
    v_mfma_f32_4x4x4_16b_bf16 v[100:103], v[10:11], v[46:47], v[100:103]
    s_nop 3
    v_mul_f32 v96, v96, v80
    v_mul_f32 v97, v97, v81
    v_mul_f32 v98, v98, v82
    v_mul_f32 v99, v99, v83
    v_cvt_pk_bf16_f32 v32, v96, v97
    v_cvt_pk_bf16_f32 v33, v98, v99
    v_mul_f32 v100, v100, v84
    v_mul_f32 v101, v101, v85
    v_mul_f32 v102, v102, v86
    v_mul_f32 v103, v103, v87
    v_cvt_pk_bf16_f32 v34, v100, v101
    v_cvt_pk_bf16_f32 v35, v102, v103
    v_mfma_f32_4x4x4_16b_bf16 v[80:83], v[56:57], v[32:33], 0
    s_nop 0
    v_mfma_f32_4x4x4_16b_bf16 v[84:87], v[56:57], v[34:35], 0
    s_nop 2
    v_mul_f32 v80, v80, v88
    v_mul_f32 v81, v81, v89
    v_mul_f32 v82, v82, v90
    v_mul_f32 v83, v83, v91
    v_mul_f32 v84, v84, v92
    v_mul_f32 v85, v85, v93
    v_mul_f32 v86, v86, v94
    v_mul_f32 v87, v87, v95
    v_mfma_f32_4x4x4_16b_bf16 v[96:99], v[10:11], v[108:109], v[80:83]
    s_nop 0
    v_mfma_f32_4x4x4_16b_bf16 v[100:103], v[10:11], v[110:111], v[84:87]
    s_nop 2
    v_cvt_pk_bf16_f32 v36, v96, v97
    v_cvt_pk_bf16_f32 v37, v98, v99
    v_cvt_pk_bf16_f32 v38, v100, v101
    v_cvt_pk_bf16_f32 v39, v102, v103
    buffer_store_dwordx4 v[36:39], v120, s[12:15], 0 offen nt
    s_cmp_ge_u32 s32, 4
    s_cbranch_scc1 L2_f6
    v_mfma_f32_4x4x4_16b_bf16 v[96:99], v[10:11], v[60:61], 0
    v_mfma_f32_4x4x4_16b_bf16 v[100:103], v[10:11], v[62:63], 0
    s_nop 0
    v_mfma_f32_4x4x4_16b_bf16 v[96:99], v[10:11], v[64:65], v[96:99]
    v_mfma_f32_4x4x4_16b_bf16 v[100:103], v[10:11], v[66:67], v[100:103]
    s_nop 0
    v_mfma_f32_4x4x4_16b_bf16 v[96:99], v[10:11], v[68:69], v[96:99]
    v_mfma_f32_4x4x4_16b_bf16 v[100:103], v[10:11], v[70:71], v[100:103]
    s_nop 0
    v_mfma_f32_4x4x4_16b_bf16 v[96:99], v[10:11], v[72:73], v[96:99]
    v_mfma_f32_4x4x4_16b_bf16 v[100:103], v[10:11], v[74:75], v[100:103]
    s_nop 3
    v_mul_f32 v96, v96, v16
    v_mul_f32 v97, v97, v17
    v_mul_f32 v98, v98, v18
    v_mul_f32 v99, v99, v19
    v_cvt_pk_bf16_f32 v60, v96, v97
    v_cvt_pk_bf16_f32 v61, v98, v99
    v_mul_f32 v100, v100, v20
    v_mul_f32 v101, v101, v21
    v_mul_f32 v102, v102, v22
    v_mul_f32 v103, v103, v23
    v_cvt_pk_bf16_f32 v62, v100, v101
    v_cvt_pk_bf16_f32 v63, v102, v103
    v_mfma_f32_4x4x4_16b_bf16 v[16:19], v[56:57], v[60:61], 0
    s_nop 0
    v_mfma_f32_4x4x4_16b_bf16 v[20:23], v[56:57], v[62:63], 0
    s_nop 2
    v_mul_f32 v16, v16, v24
    v_mul_f32 v17, v17, v25
    v_mul_f32 v18, v18, v26
    v_mul_f32 v19, v19, v27
    v_mul_f32 v20, v20, v28
    v_mul_f32 v21, v21, v29
    v_mul_f32 v22, v22, v30
    v_mul_f32 v23, v23, v31
    v_mfma_f32_4x4x4_16b_bf16 v[96:99], v[10:11], v[112:113], v[16:19]
    s_nop 0
    v_mfma_f32_4x4x4_16b_bf16 v[100:103], v[10:11], v[114:115], v[20:23]
    s_nop 2
    v_cvt_pk_bf16_f32 v64, v96, v97
    v_cvt_pk_bf16_f32 v65, v98, v99
    v_cvt_pk_bf16_f32 v66, v100, v101
    v_cvt_pk_bf16_f32 v67, v102, v103
    buffer_store_dwordx4 v[64:67], v121, s[12:15], 0 offen nt
L2_f6:
L2_end:
    s_endpgm
L2_slow:
    s_lshr_b32 s35, s42, 2
    s_lshl_b32 s50, s32, 4
    s_and_b32 s3, s42, 3
    s_lshl_b32 s53, s3, 3
    s_add_u32 s53, s53, s39
    s_and_b32 s3, s35, 2
    s_lshl_b32 s3, s3, 1
    s_add_u32 s53, s53, s3
    s_and_b32 s54, s35, 1
    s_lshl_b32 s54, s54, 4
L2_sl_seg:
    s_mul_i32 s55, s50, 173056
    s_and_b32 s3, s50, 3
    s_lshl_b32 s3, s3, 5
    s_add_u32 s3, s3, s55
    s_add_u32 s3, s3, s53
    buffer_load_dword v104, off, s[12:15], s3 sc1
    buffer_load_dword v105, off, s[12:15], s3 offset:32 sc1
    s_waitcnt vmcnt(0)
    v_readfirstlane_b32 s51, v104
    v_readfirstlane_b32 s52, v105
    s_lshr_b32 s51, s51, s54
    s_and_b32 s51, s51, 0xffff
    s_lshr_b32 s52, s52, s54
    s_and_b32 s52, s52, 0xffff
L2_sl_rec:
    s_cmp_ge_u32 s51, s52
    s_cbranch_scc1 L2_sl_next
    v_mbcnt_lo_u32_b32 v102, -1, 0
    v_mbcnt_hi_u32_b32 v102, -1, v102
    v_add_u32 v102, s51, v102
    v_and_b32 v103, -4, v102
    v_lshl_add_u32 v104, v102, 2, v103
    v_lshl_add_u32 v105, v103, 2, v102
    v_cmp_gt_u32 vcc, s52, v102
    s_mov_b64 exec, vcc
    buffer_load_dword v106, v104, s[8:11], s55 offen
    buffer_load_ubyte v107, v105, s[8:11], s55 offen offset:16
    s_waitcnt vmcnt(0)
    v_lshrrev_b32 v98, 14, v106
    v_and_b32 v98, v5, v98
    ds_read_b64 v[100:101], v98
    v_perm_b32 v97, v106, v107, s44
    v_and_b32 v96, v5, v106
    v_bitop3_b32 v103, v106, 0.5, -0.5 bitop3:0xa8
    v_bitop3_b32 v97, v6, v97, v103 bitop3:0xca
    s_waitcnt lgkmcnt(0)
    v_mfma_f32_4x4x4_16b_bf16 v[88:91], v[8:9], v[100:101], 0
    s_nop 4
    v_mul_f32 v88, v97, v88
    v_mul_f32 v89, v97, v89
    v_mul_f32 v90, v97, v90
    v_mul_f32 v91, v97, v91
    v_cvt_pk_bf16_f32 v88, v88, v89
    v_cvt_pk_bf16_f32 v89, v90, v91
    ds_pk_add_bf16 v96, v88 offset:65408
    ds_pk_add_bf16 v96, v89 offset:65412
    s_mov_b64 exec, -1
    s_add_u32 s51, s51, 64
    s_branch L2_sl_rec
L2_sl_next:
    s_add_u32 s50, s50, 1
    s_and_b32 s3, s50, 15
    s_cbranch_scc1 L2_sl_seg
    s_add_u32 s50, s50, 240
    s_cmp_lt_u32 s50, 1280
    s_cbranch_scc1 L2_sl_seg
    s_waitcnt lgkmcnt(0)
    s_cmp_eq_u32 s42, 0
    s_cbranch_scc1 L2_ret0
    s_cmp_eq_u32 s42, 1
    s_cbranch_scc1 L2_ret1
    s_cmp_eq_u32 s42, 14
    s_cbranch_scc1 L2_ret6
    s_cmp_eq_u32 s42, 15
    s_cbranch_scc1 L2_ret7
    s_and_b32 s3, s42, 3
    s_cmp_eq_u32 s3, 2
    s_cbranch_scc1 L2_ret2
    s_cmp_eq_u32 s3, 3
    s_cbranch_scc1 L2_ret3
    s_cmp_eq_u32 s3, 0
    s_cbranch_scc1 L2_ret4
    s_branch L2_ret5
L2_p1s:
    s_sleep 32
    s_branch L2_p1
L2_xo3:
    v_cmp_lt_u32 vcc, 20, v99
    s_mov_b32 s101, 1
    s_cbranch_vccz L2_xp3
    v_cmp_lt_u32 vcc, 32, v99
    v_cmp_lt_u32 s[58:59], 31, v88
    s_mov_b32 s101, 2
    s_or_b64 vcc, vcc, s[58:59]
    s_cbranch_scc0 L2_xp3
    s_mov_b32 s37, 0x10000
    s_branch L2_xp3
L2_xa4:
    s_cmp_eq_u32 s101, 1
    s_cbranch_scc1 L2_xc4
    v_lshlrev_b32 v89, 0, v96
    v_add_u32 v90, 140, v97
    v_bitop3_b32 v90, v89, v45, v90 bitop3:0x6a
    ds_write_b32 v98, v90 offset:28
    v_lshlrev_b32 v89, 4, v96
    v_add_u32 v90, 120, v97
    v_bitop3_b32 v90, v89, v45, v90 bitop3:0x6a
    ds_write_b32 v98, v90 offset:24
    v_lshlrev_b32 v89, 8, v96
    v_add_u32 v90, 100, v97
    v_bitop3_b32 v90, v89, v45, v90 bitop3:0x6a
    ds_write_b32 v98, v90 offset:20
L2_xc4:
    v_lshlrev_b32 v89, 12, v96
    v_add_u32 v90, 80, v97
    v_bitop3_b32 v90, v89, v45, v90 bitop3:0x6a
    ds_write_b32 v98, v90 offset:16
    s_branch L2_xb4
L2_xe4:
    v_cmp_lt_u32 vcc, 32, v99
    v_cmp_lt_u32 s[58:59], 31, v88
    v_lshrrev_b32 v89, 16, v96
    v_add_u32 v97, 80, v97
    s_or_b64 vcc, vcc, s[58:59]
    s_cbranch_scc1 L2_xs4
    v_lshlrev_b32 v89, v1, v89
    v_and_b32 v89, v45, v89
    v_cmp_ne_u32 vcc, 0, v89
    v_xor_b32 v90, v97, v89
    s_add_u32 s3, s37, s38
    v_mbcnt_lo_u32_b32 v98, vcc_lo, 0
    v_mbcnt_hi_u32_b32 v98, vcc_hi, v98
    s_bcnt1_i32_b64 s41, vcc
    v_lshl_add_u32 v98, v98, 2, s3
    s_mov_b64 exec, vcc
    ds_write_b32 v98, v90
    s_mov_b64 exec, -1
    s_lshl2_add_u32 s37, s41, s37
    s_branch L2_xr4
L2_xf4:
    s_waitcnt lgkmcnt(0)
    s_cmp_gt_u32 s37, 1024
    s_cbranch_scc1 L2_xs4
    v_mov_b32 v43, -1
    s_cmp_ge_u32 s37, 512
    s_cbranch_scc1 L2_xg4
    v_mov_b32 v42, -1
    s_cmp_ge_u32 s37, 256
    s_cbranch_scc1 L2_xg4
    v_mov_b32 v41, -1
    s_branch L2_xg4
L2_xs4:
    s_waitcnt lgkmcnt(0)
    v_mov_b32 v40, -1
    v_mov_b32 v41, -1
    v_mov_b32 v42, -1
    v_mov_b32 v43, -1
    s_add_u32 s3, s42, 0
    s_bitset1_b32 s36, s3
    s_branch L2_xg4
L2_xo5:
    v_cmp_lt_u32 vcc, 20, v99
    s_mov_b32 s101, 1
    s_cbranch_vccz L2_xp5
    v_cmp_lt_u32 vcc, 32, v99
    v_cmp_lt_u32 s[58:59], 31, v88
    s_mov_b32 s101, 2
    s_or_b64 vcc, vcc, s[58:59]
    s_cbranch_scc0 L2_xp5
    s_mov_b32 s37, 0x10000
    s_branch L2_xp5
L2_xa6:
    s_cmp_eq_u32 s101, 1
    s_cbranch_scc1 L2_xc6
    v_lshlrev_b32 v89, 0, v96
    v_add_u32 v90, 140, v97
    v_bitop3_b32 v90, v89, v45, v90 bitop3:0x6a
    ds_write_b32 v98, v90 offset:28
    v_lshlrev_b32 v89, 4, v96
    v_add_u32 v90, 120, v97
    v_bitop3_b32 v90, v89, v45, v90 bitop3:0x6a
    ds_write_b32 v98, v90 offset:24
    v_lshlrev_b32 v89, 8, v96
    v_add_u32 v90, 100, v97
    v_bitop3_b32 v90, v89, v45, v90 bitop3:0x6a
    ds_write_b32 v98, v90 offset:20
L2_xc6:
    v_lshlrev_b32 v89, 12, v96
    v_add_u32 v90, 80, v97
    v_bitop3_b32 v90, v89, v45, v90 bitop3:0x6a
    ds_write_b32 v98, v90 offset:16
    s_branch L2_xb6
L2_xe6:
    v_cmp_lt_u32 vcc, 32, v99
    v_cmp_lt_u32 s[58:59], 31, v88
    v_lshrrev_b32 v89, 16, v96
    v_add_u32 v97, 80, v97
    s_or_b64 vcc, vcc, s[58:59]
    s_cbranch_scc1 L2_xs6
    v_lshlrev_b32 v89, v1, v89
    v_and_b32 v89, v45, v89
    v_cmp_ne_u32 vcc, 0, v89
    v_xor_b32 v90, v97, v89
    s_add_u32 s3, s37, s38
    v_mbcnt_lo_u32_b32 v98, vcc_lo, 0
    v_mbcnt_hi_u32_b32 v98, vcc_hi, v98
    s_bcnt1_i32_b64 s41, vcc
    v_lshl_add_u32 v98, v98, 2, s3
    s_mov_b64 exec, vcc
    ds_write_b32 v98, v90
    s_mov_b64 exec, -1
    s_lshl2_add_u32 s37, s41, s37
    s_branch L2_xr6
L2_xf6:
    s_waitcnt lgkmcnt(0)
    s_cmp_gt_u32 s37, 1024
    s_cbranch_scc1 L2_xs6
    v_mov_b32 v43, -1
    s_cmp_ge_u32 s37, 512
    s_cbranch_scc1 L2_xg6
    v_mov_b32 v42, -1
    s_cmp_ge_u32 s37, 256
    s_cbranch_scc1 L2_xg6
    v_mov_b32 v41, -1
    s_branch L2_xg6
L2_xs6:
    s_waitcnt lgkmcnt(0)
    v_mov_b32 v40, -1
    v_mov_b32 v41, -1
    v_mov_b32 v42, -1
    v_mov_b32 v43, -1
    s_add_u32 s3, s42, 1
    s_bitset1_b32 s36, s3
    s_branch L2_xg6
L2_p2s:
    s_sleep 8
    s_branch L2_p2
L2_c7:
    s_lshl_b64 s[52:53], s[82:83], 1
    s_andn2_b64 s[52:53], s[52:53], s[80:81]
    s_andn2_b64 s[52:53], s[52:53], s[54:55]
    s_or_b64 s[80:81], s[80:81], s[52:53]
    s_not_b64 vcc, s[52:53]
    s_mov_b64 exec, -1
    v_cndmask_b32_dpp v84, v84, v84, vcc wave_shr:1 row_mask:0xf bank_mask:0xf
    v_cndmask_b32_dpp v85, v85, v85, vcc wave_shr:1 row_mask:0xf bank_mask:0xf
    s_lshr_b64 s[52:53], s[52:53], 1
    v_cndmask_b32_dpp v86, v86, v86, vcc wave_shr:1 row_mask:0xf bank_mask:0xf
    v_cndmask_b32_dpp v87, v87, v87, vcc wave_shr:1 row_mask:0xf bank_mask:0xf
    s_andn2_b64 s[82:83], s[82:83], s[52:53]
    v_cndmask_b32_dpp v7, v7, v7, vcc wave_shr:1 row_mask:0xf bank_mask:0xf
    s_mov_b64 exec, s[54:55]
    s_cbranch_scc0 L2_d7
    s_mov_b64 exec, s[82:83]
    s_nop 1
    v_mfma_f32_4x4x4_16b_bf16 v[88:91], v[12:13], v[84:85], 0
    s_nop 1
    v_mfma_f32_4x4x4_16b_bf16 v[88:91], v[10:11], v[86:87], v[88:91]
    s_nop 4
    v_cvt_pk_bf16_f32 v88, v88, v89
    v_cvt_pk_bf16_f32 v89, v90, v91
    ds_pk_add_bf16 v7, v88 offset:65408
    ds_pk_add_bf16 v7, v89 offset:65412
    s_mov_b64 exec, s[54:55]
    s_branch L2_d7
L2_c8:
    s_lshl_b64 s[52:53], s[82:83], 1
    s_andn2_b64 s[52:53], s[52:53], s[80:81]
    s_andn2_b64 s[52:53], s[52:53], s[50:51]
    s_or_b64 s[80:81], s[80:81], s[52:53]
    s_not_b64 vcc, s[52:53]
    s_mov_b64 exec, -1
    v_cndmask_b32_dpp v84, v84, v84, vcc wave_shr:1 row_mask:0xf bank_mask:0xf
    v_cndmask_b32_dpp v85, v85, v85, vcc wave_shr:1 row_mask:0xf bank_mask:0xf
    s_lshr_b64 s[52:53], s[52:53], 1
    v_cndmask_b32_dpp v86, v86, v86, vcc wave_shr:1 row_mask:0xf bank_mask:0xf
    v_cndmask_b32_dpp v87, v87, v87, vcc wave_shr:1 row_mask:0xf bank_mask:0xf
    s_andn2_b64 s[82:83], s[82:83], s[52:53]
    v_cndmask_b32_dpp v7, v7, v7, vcc wave_shr:1 row_mask:0xf bank_mask:0xf
    s_mov_b64 exec, s[50:51]
    s_cbranch_scc0 L2_d8
    s_mov_b64 exec, s[82:83]
    s_nop 1
    v_mfma_f32_4x4x4_16b_bf16 v[88:91], v[12:13], v[84:85], 0
    s_nop 1
    v_mfma_f32_4x4x4_16b_bf16 v[88:91], v[10:11], v[86:87], v[88:91]
    s_nop 4
    v_cvt_pk_bf16_f32 v88, v88, v89
    v_cvt_pk_bf16_f32 v89, v90, v91
    ds_pk_add_bf16 v7, v88 offset:65408
    ds_pk_add_bf16 v7, v89 offset:65412
    s_mov_b64 exec, s[50:51]
    s_branch L2_d8
L2_xo9:
    v_cmp_lt_u32 vcc, 20, v99
    s_mov_b32 s101, 1
    s_cbranch_vccz L2_xp9
    v_cmp_lt_u32 vcc, 32, v99
    v_cmp_lt_u32 s[58:59], 31, v88
    s_mov_b32 s101, 2
    s_or_b64 vcc, vcc, s[58:59]
    s_cbranch_scc0 L2_xp9
    s_mov_b32 s37, 0x10000
    s_branch L2_xp9
L2_c12:
    s_lshl_b64 s[52:53], s[82:83], 1
    s_andn2_b64 s[52:53], s[52:53], s[80:81]
    s_andn2_b64 s[52:53], s[52:53], s[54:55]
    s_or_b64 s[80:81], s[80:81], s[52:53]
    s_not_b64 vcc, s[52:53]
    s_mov_b64 exec, -1
    v_cndmask_b32_dpp v84, v84, v84, vcc wave_shr:1 row_mask:0xf bank_mask:0xf
    v_cndmask_b32_dpp v85, v85, v85, vcc wave_shr:1 row_mask:0xf bank_mask:0xf
    s_lshr_b64 s[52:53], s[52:53], 1
    v_cndmask_b32_dpp v86, v86, v86, vcc wave_shr:1 row_mask:0xf bank_mask:0xf
    v_cndmask_b32_dpp v87, v87, v87, vcc wave_shr:1 row_mask:0xf bank_mask:0xf
    s_andn2_b64 s[82:83], s[82:83], s[52:53]
    v_cndmask_b32_dpp v7, v7, v7, vcc wave_shr:1 row_mask:0xf bank_mask:0xf
    s_mov_b64 exec, s[54:55]
    s_cbranch_scc0 L2_d12
    s_mov_b64 exec, s[82:83]
    s_nop 1
    v_mfma_f32_4x4x4_16b_bf16 v[88:91], v[12:13], v[84:85], 0
    s_nop 1
    v_mfma_f32_4x4x4_16b_bf16 v[88:91], v[10:11], v[86:87], v[88:91]
    s_nop 4
    v_cvt_pk_bf16_f32 v88, v88, v89
    v_cvt_pk_bf16_f32 v89, v90, v91
    ds_pk_add_bf16 v7, v88 offset:65408
    ds_pk_add_bf16 v7, v89 offset:65412
    s_mov_b64 exec, s[54:55]
    s_branch L2_d12
L2_c13:
    s_lshl_b64 s[52:53], s[82:83], 1
    s_andn2_b64 s[52:53], s[52:53], s[80:81]
    s_andn2_b64 s[52:53], s[52:53], s[50:51]
    s_or_b64 s[80:81], s[80:81], s[52:53]
    s_not_b64 vcc, s[52:53]
    s_mov_b64 exec, -1
    v_cndmask_b32_dpp v84, v84, v84, vcc wave_shr:1 row_mask:0xf bank_mask:0xf
    v_cndmask_b32_dpp v85, v85, v85, vcc wave_shr:1 row_mask:0xf bank_mask:0xf
    s_lshr_b64 s[52:53], s[52:53], 1
    v_cndmask_b32_dpp v86, v86, v86, vcc wave_shr:1 row_mask:0xf bank_mask:0xf
    v_cndmask_b32_dpp v87, v87, v87, vcc wave_shr:1 row_mask:0xf bank_mask:0xf
    s_andn2_b64 s[82:83], s[82:83], s[52:53]
    v_cndmask_b32_dpp v7, v7, v7, vcc wave_shr:1 row_mask:0xf bank_mask:0xf
    s_mov_b64 exec, s[50:51]
    s_cbranch_scc0 L2_d13
    s_mov_b64 exec, s[82:83]
    s_nop 1
    v_mfma_f32_4x4x4_16b_bf16 v[88:91], v[12:13], v[84:85], 0
    s_nop 1
    v_mfma_f32_4x4x4_16b_bf16 v[88:91], v[10:11], v[86:87], v[88:91]
    s_nop 4
    v_cvt_pk_bf16_f32 v88, v88, v89
    v_cvt_pk_bf16_f32 v89, v90, v91
    ds_pk_add_bf16 v7, v88 offset:65408
    ds_pk_add_bf16 v7, v89 offset:65412
    s_mov_b64 exec, s[50:51]
    s_branch L2_d13
L2_c15:
    s_lshl_b64 s[52:53], s[82:83], 1
    s_andn2_b64 s[52:53], s[52:53], s[80:81]
    s_andn2_b64 s[52:53], s[52:53], s[54:55]
    s_or_b64 s[80:81], s[80:81], s[52:53]
    s_not_b64 vcc, s[52:53]
    s_mov_b64 exec, -1
    v_cndmask_b32_dpp v84, v84, v84, vcc wave_shr:1 row_mask:0xf bank_mask:0xf
    v_cndmask_b32_dpp v85, v85, v85, vcc wave_shr:1 row_mask:0xf bank_mask:0xf
    s_lshr_b64 s[52:53], s[52:53], 1
    v_cndmask_b32_dpp v86, v86, v86, vcc wave_shr:1 row_mask:0xf bank_mask:0xf
    v_cndmask_b32_dpp v87, v87, v87, vcc wave_shr:1 row_mask:0xf bank_mask:0xf
    s_andn2_b64 s[82:83], s[82:83], s[52:53]
    v_cndmask_b32_dpp v7, v7, v7, vcc wave_shr:1 row_mask:0xf bank_mask:0xf
    s_mov_b64 exec, s[54:55]
    s_cbranch_scc0 L2_d15
    s_mov_b64 exec, s[82:83]
    s_nop 1
    v_mfma_f32_4x4x4_16b_bf16 v[88:91], v[12:13], v[84:85], 0
    s_nop 1
    v_mfma_f32_4x4x4_16b_bf16 v[88:91], v[10:11], v[86:87], v[88:91]
    s_nop 4
    v_cvt_pk_bf16_f32 v88, v88, v89
    v_cvt_pk_bf16_f32 v89, v90, v91
    ds_pk_add_bf16 v7, v88 offset:65408
    ds_pk_add_bf16 v7, v89 offset:65412
    s_mov_b64 exec, s[54:55]
    s_branch L2_d15
L2_c16:
    s_lshl_b64 s[52:53], s[82:83], 1
    s_andn2_b64 s[52:53], s[52:53], s[80:81]
    s_andn2_b64 s[52:53], s[52:53], s[50:51]
    s_or_b64 s[80:81], s[80:81], s[52:53]
    s_not_b64 vcc, s[52:53]
    s_mov_b64 exec, -1
    v_cndmask_b32_dpp v84, v84, v84, vcc wave_shr:1 row_mask:0xf bank_mask:0xf
    v_cndmask_b32_dpp v85, v85, v85, vcc wave_shr:1 row_mask:0xf bank_mask:0xf
    s_lshr_b64 s[52:53], s[52:53], 1
    v_cndmask_b32_dpp v86, v86, v86, vcc wave_shr:1 row_mask:0xf bank_mask:0xf
    v_cndmask_b32_dpp v87, v87, v87, vcc wave_shr:1 row_mask:0xf bank_mask:0xf
    s_andn2_b64 s[82:83], s[82:83], s[52:53]
    v_cndmask_b32_dpp v7, v7, v7, vcc wave_shr:1 row_mask:0xf bank_mask:0xf
    s_mov_b64 exec, s[50:51]
    s_cbranch_scc0 L2_d16
    s_mov_b64 exec, s[82:83]
    s_nop 1
    v_mfma_f32_4x4x4_16b_bf16 v[88:91], v[12:13], v[84:85], 0
    s_nop 1
    v_mfma_f32_4x4x4_16b_bf16 v[88:91], v[10:11], v[86:87], v[88:91]
    s_nop 4
    v_cvt_pk_bf16_f32 v88, v88, v89
    v_cvt_pk_bf16_f32 v89, v90, v91
    ds_pk_add_bf16 v7, v88 offset:65408
    ds_pk_add_bf16 v7, v89 offset:65412
    s_mov_b64 exec, s[50:51]
    s_branch L2_d16
L2_c19:
    s_lshl_b64 s[52:53], s[82:83], 1
    s_andn2_b64 s[52:53], s[52:53], s[80:81]
    s_andn2_b64 s[52:53], s[52:53], s[54:55]
    s_or_b64 s[80:81], s[80:81], s[52:53]
    s_not_b64 vcc, s[52:53]
    s_mov_b64 exec, -1
    v_cndmask_b32_dpp v84, v84, v84, vcc wave_shr:1 row_mask:0xf bank_mask:0xf
    v_cndmask_b32_dpp v85, v85, v85, vcc wave_shr:1 row_mask:0xf bank_mask:0xf
    s_lshr_b64 s[52:53], s[52:53], 1
    v_cndmask_b32_dpp v86, v86, v86, vcc wave_shr:1 row_mask:0xf bank_mask:0xf
    v_cndmask_b32_dpp v87, v87, v87, vcc wave_shr:1 row_mask:0xf bank_mask:0xf
    s_andn2_b64 s[82:83], s[82:83], s[52:53]
    v_cndmask_b32_dpp v7, v7, v7, vcc wave_shr:1 row_mask:0xf bank_mask:0xf
    s_mov_b64 exec, s[54:55]
    s_cbranch_scc0 L2_d19
    s_mov_b64 exec, s[82:83]
    s_nop 1
    v_mfma_f32_4x4x4_16b_bf16 v[88:91], v[12:13], v[84:85], 0
    s_nop 1
    v_mfma_f32_4x4x4_16b_bf16 v[88:91], v[10:11], v[86:87], v[88:91]
    s_nop 4
    v_cvt_pk_bf16_f32 v88, v88, v89
    v_cvt_pk_bf16_f32 v89, v90, v91
    ds_pk_add_bf16 v7, v88 offset:65408
    ds_pk_add_bf16 v7, v89 offset:65412
    s_mov_b64 exec, s[54:55]
    s_branch L2_d19
L2_c20:
    s_lshl_b64 s[52:53], s[82:83], 1
    s_andn2_b64 s[52:53], s[52:53], s[80:81]
    s_andn2_b64 s[52:53], s[52:53], s[50:51]
    s_or_b64 s[80:81], s[80:81], s[52:53]
    s_not_b64 vcc, s[52:53]
    s_mov_b64 exec, -1
    v_cndmask_b32_dpp v84, v84, v84, vcc wave_shr:1 row_mask:0xf bank_mask:0xf
    v_cndmask_b32_dpp v85, v85, v85, vcc wave_shr:1 row_mask:0xf bank_mask:0xf
    s_lshr_b64 s[52:53], s[52:53], 1
    v_cndmask_b32_dpp v86, v86, v86, vcc wave_shr:1 row_mask:0xf bank_mask:0xf
    v_cndmask_b32_dpp v87, v87, v87, vcc wave_shr:1 row_mask:0xf bank_mask:0xf
    s_andn2_b64 s[82:83], s[82:83], s[52:53]
    v_cndmask_b32_dpp v7, v7, v7, vcc wave_shr:1 row_mask:0xf bank_mask:0xf
    s_mov_b64 exec, s[50:51]
    s_cbranch_scc0 L2_d20
    s_mov_b64 exec, s[82:83]
    s_nop 1
    v_mfma_f32_4x4x4_16b_bf16 v[88:91], v[12:13], v[84:85], 0
    s_nop 1
    v_mfma_f32_4x4x4_16b_bf16 v[88:91], v[10:11], v[86:87], v[88:91]
    s_nop 4
    v_cvt_pk_bf16_f32 v88, v88, v89
    v_cvt_pk_bf16_f32 v89, v90, v91
    ds_pk_add_bf16 v7, v88 offset:65408
    ds_pk_add_bf16 v7, v89 offset:65412
    s_mov_b64 exec, s[50:51]
    s_branch L2_d20
L2_c21:
    s_lshl_b64 s[52:53], s[82:83], 1
    s_andn2_b64 s[52:53], s[52:53], s[80:81]
    s_andn2_b64 s[52:53], s[52:53], s[54:55]
    s_or_b64 s[80:81], s[80:81], s[52:53]
    s_not_b64 vcc, s[52:53]
    s_mov_b64 exec, -1
    v_cndmask_b32_dpp v84, v84, v84, vcc wave_shr:1 row_mask:0xf bank_mask:0xf
    v_cndmask_b32_dpp v85, v85, v85, vcc wave_shr:1 row_mask:0xf bank_mask:0xf
    s_lshr_b64 s[52:53], s[52:53], 1
    v_cndmask_b32_dpp v86, v86, v86, vcc wave_shr:1 row_mask:0xf bank_mask:0xf
    v_cndmask_b32_dpp v87, v87, v87, vcc wave_shr:1 row_mask:0xf bank_mask:0xf
    s_andn2_b64 s[82:83], s[82:83], s[52:53]
    v_cndmask_b32_dpp v7, v7, v7, vcc wave_shr:1 row_mask:0xf bank_mask:0xf
    s_mov_b64 exec, s[54:55]
    s_cbranch_scc0 L2_d21
    s_mov_b64 exec, s[82:83]
    s_nop 1
    v_mfma_f32_4x4x4_16b_bf16 v[88:91], v[12:13], v[84:85], 0
    s_nop 1
    v_mfma_f32_4x4x4_16b_bf16 v[88:91], v[10:11], v[86:87], v[88:91]
    s_nop 4
    v_cvt_pk_bf16_f32 v88, v88, v89
    v_cvt_pk_bf16_f32 v89, v90, v91
    ds_pk_add_bf16 v7, v88 offset:65408
    ds_pk_add_bf16 v7, v89 offset:65412
    s_mov_b64 exec, s[54:55]
    s_branch L2_d21
L2_c22:
    s_lshl_b64 s[52:53], s[82:83], 1
    s_andn2_b64 s[52:53], s[52:53], s[80:81]
    s_andn2_b64 s[52:53], s[52:53], s[50:51]
    s_or_b64 s[80:81], s[80:81], s[52:53]
    s_not_b64 vcc, s[52:53]
    s_mov_b64 exec, -1
    v_cndmask_b32_dpp v84, v84, v84, vcc wave_shr:1 row_mask:0xf bank_mask:0xf
    v_cndmask_b32_dpp v85, v85, v85, vcc wave_shr:1 row_mask:0xf bank_mask:0xf
    s_lshr_b64 s[52:53], s[52:53], 1
    v_cndmask_b32_dpp v86, v86, v86, vcc wave_shr:1 row_mask:0xf bank_mask:0xf
    v_cndmask_b32_dpp v87, v87, v87, vcc wave_shr:1 row_mask:0xf bank_mask:0xf
    s_andn2_b64 s[82:83], s[82:83], s[52:53]
    v_cndmask_b32_dpp v7, v7, v7, vcc wave_shr:1 row_mask:0xf bank_mask:0xf
    s_mov_b64 exec, s[50:51]
    s_cbranch_scc0 L2_d22
    s_mov_b64 exec, s[82:83]
    s_nop 1
    v_mfma_f32_4x4x4_16b_bf16 v[88:91], v[12:13], v[84:85], 0
    s_nop 1
    v_mfma_f32_4x4x4_16b_bf16 v[88:91], v[10:11], v[86:87], v[88:91]
    s_nop 4
    v_cvt_pk_bf16_f32 v88, v88, v89
    v_cvt_pk_bf16_f32 v89, v90, v91
    ds_pk_add_bf16 v7, v88 offset:65408
    ds_pk_add_bf16 v7, v89 offset:65412
    s_mov_b64 exec, s[50:51]
    s_branch L2_d22
L2_c23:
    s_lshl_b64 s[52:53], s[82:83], 1
    s_andn2_b64 s[52:53], s[52:53], s[80:81]
    s_andn2_b64 s[52:53], s[52:53], s[54:55]
    s_or_b64 s[80:81], s[80:81], s[52:53]
    s_not_b64 vcc, s[52:53]
    s_mov_b64 exec, -1
    v_cndmask_b32_dpp v84, v84, v84, vcc wave_shr:1 row_mask:0xf bank_mask:0xf
    v_cndmask_b32_dpp v85, v85, v85, vcc wave_shr:1 row_mask:0xf bank_mask:0xf
    s_lshr_b64 s[52:53], s[52:53], 1
    v_cndmask_b32_dpp v86, v86, v86, vcc wave_shr:1 row_mask:0xf bank_mask:0xf
    v_cndmask_b32_dpp v87, v87, v87, vcc wave_shr:1 row_mask:0xf bank_mask:0xf
    s_andn2_b64 s[82:83], s[82:83], s[52:53]
    v_cndmask_b32_dpp v7, v7, v7, vcc wave_shr:1 row_mask:0xf bank_mask:0xf
    s_mov_b64 exec, s[54:55]
    s_cbranch_scc0 L2_d23
    s_mov_b64 exec, s[82:83]
    s_nop 1
    v_mfma_f32_4x4x4_16b_bf16 v[88:91], v[12:13], v[84:85], 0
    s_nop 1
    v_mfma_f32_4x4x4_16b_bf16 v[88:91], v[10:11], v[86:87], v[88:91]
    s_nop 4
    v_cvt_pk_bf16_f32 v88, v88, v89
    v_cvt_pk_bf16_f32 v89, v90, v91
    ds_pk_add_bf16 v7, v88 offset:65408
    ds_pk_add_bf16 v7, v89 offset:65412
    s_mov_b64 exec, s[54:55]
    s_branch L2_d23
L2_c24:
    s_lshl_b64 s[52:53], s[82:83], 1
    s_andn2_b64 s[52:53], s[52:53], s[80:81]
    s_andn2_b64 s[52:53], s[52:53], s[50:51]
    s_or_b64 s[80:81], s[80:81], s[52:53]
    s_not_b64 vcc, s[52:53]
    s_mov_b64 exec, -1
    v_cndmask_b32_dpp v84, v84, v84, vcc wave_shr:1 row_mask:0xf bank_mask:0xf
    v_cndmask_b32_dpp v85, v85, v85, vcc wave_shr:1 row_mask:0xf bank_mask:0xf
    s_lshr_b64 s[52:53], s[52:53], 1
    v_cndmask_b32_dpp v86, v86, v86, vcc wave_shr:1 row_mask:0xf bank_mask:0xf
    v_cndmask_b32_dpp v87, v87, v87, vcc wave_shr:1 row_mask:0xf bank_mask:0xf
    s_andn2_b64 s[82:83], s[82:83], s[52:53]
    v_cndmask_b32_dpp v7, v7, v7, vcc wave_shr:1 row_mask:0xf bank_mask:0xf
    s_mov_b64 exec, s[50:51]
    s_cbranch_scc0 L2_d24
    s_mov_b64 exec, s[82:83]
    s_nop 1
    v_mfma_f32_4x4x4_16b_bf16 v[88:91], v[12:13], v[84:85], 0
    s_nop 1
    v_mfma_f32_4x4x4_16b_bf16 v[88:91], v[10:11], v[86:87], v[88:91]
    s_nop 4
    v_cvt_pk_bf16_f32 v88, v88, v89
    v_cvt_pk_bf16_f32 v89, v90, v91
    ds_pk_add_bf16 v7, v88 offset:65408
    ds_pk_add_bf16 v7, v89 offset:65412
    s_mov_b64 exec, s[50:51]
    s_branch L2_d24
L2_xa25:
    s_cmp_eq_u32 s101, 1
    s_cbranch_scc1 L2_xc25
    v_lshlrev_b32 v89, 0, v96
    v_add_u32 v90, 140, v97
    v_bitop3_b32 v90, v89, v45, v90 bitop3:0x6a
    ds_write_b32 v98, v90 offset:28
    v_lshlrev_b32 v89, 4, v96
    v_add_u32 v90, 120, v97
    v_bitop3_b32 v90, v89, v45, v90 bitop3:0x6a
    ds_write_b32 v98, v90 offset:24
    v_lshlrev_b32 v89, 8, v96
    v_add_u32 v90, 100, v97
    v_bitop3_b32 v90, v89, v45, v90 bitop3:0x6a
    ds_write_b32 v98, v90 offset:20
L2_xc25:
    v_lshlrev_b32 v89, 12, v96
    v_add_u32 v90, 80, v97
    v_bitop3_b32 v90, v89, v45, v90 bitop3:0x6a
    ds_write_b32 v98, v90 offset:16
    s_branch L2_xb25
L2_xe25:
    v_cmp_lt_u32 vcc, 32, v99
    v_cmp_lt_u32 s[58:59], 31, v88
    v_lshrrev_b32 v89, 16, v96
    v_add_u32 v97, 80, v97
    s_or_b64 vcc, vcc, s[58:59]
    s_cbranch_scc1 L2_xs25
    v_lshlrev_b32 v89, v1, v89
    v_and_b32 v89, v45, v89
    v_cmp_ne_u32 vcc, 0, v89
    v_xor_b32 v90, v97, v89
    s_add_u32 s3, s37, s38
    v_mbcnt_lo_u32_b32 v98, vcc_lo, 0
    v_mbcnt_hi_u32_b32 v98, vcc_hi, v98
    s_bcnt1_i32_b64 s41, vcc
    v_lshl_add_u32 v98, v98, 2, s3
    s_mov_b64 exec, vcc
    ds_write_b32 v98, v90
    s_mov_b64 exec, -1
    s_lshl2_add_u32 s37, s41, s37
    s_branch L2_xr25
L2_xf25:
    s_waitcnt lgkmcnt(0)
    s_cmp_gt_u32 s37, 1024
    s_cbranch_scc1 L2_xs25
    v_mov_b32 v43, -1
    s_cmp_ge_u32 s37, 512
    s_cbranch_scc1 L2_xg25
    v_mov_b32 v42, -1
    s_cmp_ge_u32 s37, 256
    s_cbranch_scc1 L2_xg25
    v_mov_b32 v41, -1
    s_branch L2_xg25
L2_xs25:
    s_waitcnt lgkmcnt(0)
    v_mov_b32 v40, -1
    v_mov_b32 v41, -1
    v_mov_b32 v42, -1
    v_mov_b32 v43, -1
    s_add_u32 s3, s42, 2
    s_bitset1_b32 s36, s3
    s_branch L2_xg25
L2_c26:
    s_lshl_b64 s[52:53], s[82:83], 1
    s_andn2_b64 s[52:53], s[52:53], s[80:81]
    s_andn2_b64 s[52:53], s[52:53], s[54:55]
    s_or_b64 s[80:81], s[80:81], s[52:53]
    s_not_b64 vcc, s[52:53]
    s_mov_b64 exec, -1
    v_cndmask_b32_dpp v84, v84, v84, vcc wave_shr:1 row_mask:0xf bank_mask:0xf
    v_cndmask_b32_dpp v85, v85, v85, vcc wave_shr:1 row_mask:0xf bank_mask:0xf
    s_lshr_b64 s[52:53], s[52:53], 1
    v_cndmask_b32_dpp v86, v86, v86, vcc wave_shr:1 row_mask:0xf bank_mask:0xf
    v_cndmask_b32_dpp v87, v87, v87, vcc wave_shr:1 row_mask:0xf bank_mask:0xf
    s_andn2_b64 s[82:83], s[82:83], s[52:53]
    v_cndmask_b32_dpp v7, v7, v7, vcc wave_shr:1 row_mask:0xf bank_mask:0xf
    s_mov_b64 exec, s[54:55]
    s_cbranch_scc0 L2_d26
    s_mov_b64 exec, s[82:83]
    s_nop 1
    v_mfma_f32_4x4x4_16b_bf16 v[88:91], v[12:13], v[84:85], 0
    s_nop 1
    v_mfma_f32_4x4x4_16b_bf16 v[88:91], v[10:11], v[86:87], v[88:91]
    s_nop 4
    v_cvt_pk_bf16_f32 v88, v88, v89
    v_cvt_pk_bf16_f32 v89, v90, v91
    ds_pk_add_bf16 v7, v88 offset:65408
    ds_pk_add_bf16 v7, v89 offset:65412
    s_mov_b64 exec, s[54:55]
    s_branch L2_d26
L2_c27:
    s_lshl_b64 s[52:53], s[82:83], 1
    s_andn2_b64 s[52:53], s[52:53], s[80:81]
    s_andn2_b64 s[52:53], s[52:53], s[50:51]
    s_or_b64 s[80:81], s[80:81], s[52:53]
    s_not_b64 vcc, s[52:53]
    s_mov_b64 exec, -1
    v_cndmask_b32_dpp v84, v84, v84, vcc wave_shr:1 row_mask:0xf bank_mask:0xf
    v_cndmask_b32_dpp v85, v85, v85, vcc wave_shr:1 row_mask:0xf bank_mask:0xf
    s_lshr_b64 s[52:53], s[52:53], 1
    v_cndmask_b32_dpp v86, v86, v86, vcc wave_shr:1 row_mask:0xf bank_mask:0xf
    v_cndmask_b32_dpp v87, v87, v87, vcc wave_shr:1 row_mask:0xf bank_mask:0xf
    s_andn2_b64 s[82:83], s[82:83], s[52:53]
    v_cndmask_b32_dpp v7, v7, v7, vcc wave_shr:1 row_mask:0xf bank_mask:0xf
    s_mov_b64 exec, s[50:51]
    s_cbranch_scc0 L2_d27
    s_mov_b64 exec, s[82:83]
    s_nop 1
    v_mfma_f32_4x4x4_16b_bf16 v[88:91], v[12:13], v[84:85], 0
    s_nop 1
    v_mfma_f32_4x4x4_16b_bf16 v[88:91], v[10:11], v[86:87], v[88:91]
    s_nop 4
    v_cvt_pk_bf16_f32 v88, v88, v89
    v_cvt_pk_bf16_f32 v89, v90, v91
    ds_pk_add_bf16 v7, v88 offset:65408
    ds_pk_add_bf16 v7, v89 offset:65412
    s_mov_b64 exec, s[50:51]
    s_branch L2_d27
L2_c28:
    s_lshl_b64 s[52:53], s[82:83], 1
    s_andn2_b64 s[52:53], s[52:53], s[80:81]
    s_andn2_b64 s[52:53], s[52:53], s[54:55]
    s_or_b64 s[80:81], s[80:81], s[52:53]
    s_not_b64 vcc, s[52:53]
    s_mov_b64 exec, -1
    v_cndmask_b32_dpp v84, v84, v84, vcc wave_shr:1 row_mask:0xf bank_mask:0xf
    v_cndmask_b32_dpp v85, v85, v85, vcc wave_shr:1 row_mask:0xf bank_mask:0xf
    s_lshr_b64 s[52:53], s[52:53], 1
    v_cndmask_b32_dpp v86, v86, v86, vcc wave_shr:1 row_mask:0xf bank_mask:0xf
    v_cndmask_b32_dpp v87, v87, v87, vcc wave_shr:1 row_mask:0xf bank_mask:0xf
    s_andn2_b64 s[82:83], s[82:83], s[52:53]
    v_cndmask_b32_dpp v7, v7, v7, vcc wave_shr:1 row_mask:0xf bank_mask:0xf
    s_mov_b64 exec, s[54:55]
    s_cbranch_scc0 L2_d28
    s_mov_b64 exec, s[82:83]
    s_nop 1
    v_mfma_f32_4x4x4_16b_bf16 v[88:91], v[12:13], v[84:85], 0
    s_nop 1
    v_mfma_f32_4x4x4_16b_bf16 v[88:91], v[10:11], v[86:87], v[88:91]
    s_nop 4
    v_cvt_pk_bf16_f32 v88, v88, v89
    v_cvt_pk_bf16_f32 v89, v90, v91
    ds_pk_add_bf16 v7, v88 offset:65408
    ds_pk_add_bf16 v7, v89 offset:65412
    s_mov_b64 exec, s[54:55]
    s_branch L2_d28
L2_c29:
    s_lshl_b64 s[52:53], s[82:83], 1
    s_andn2_b64 s[52:53], s[52:53], s[80:81]
    s_andn2_b64 s[52:53], s[52:53], s[50:51]
    s_or_b64 s[80:81], s[80:81], s[52:53]
    s_not_b64 vcc, s[52:53]
    s_mov_b64 exec, -1
    v_cndmask_b32_dpp v84, v84, v84, vcc wave_shr:1 row_mask:0xf bank_mask:0xf
    v_cndmask_b32_dpp v85, v85, v85, vcc wave_shr:1 row_mask:0xf bank_mask:0xf
    s_lshr_b64 s[52:53], s[52:53], 1
    v_cndmask_b32_dpp v86, v86, v86, vcc wave_shr:1 row_mask:0xf bank_mask:0xf
    v_cndmask_b32_dpp v87, v87, v87, vcc wave_shr:1 row_mask:0xf bank_mask:0xf
    s_andn2_b64 s[82:83], s[82:83], s[52:53]
    v_cndmask_b32_dpp v7, v7, v7, vcc wave_shr:1 row_mask:0xf bank_mask:0xf
    s_mov_b64 exec, s[50:51]
    s_cbranch_scc0 L2_d29
    s_mov_b64 exec, s[82:83]
    s_nop 1
    v_mfma_f32_4x4x4_16b_bf16 v[88:91], v[12:13], v[84:85], 0
    s_nop 1
    v_mfma_f32_4x4x4_16b_bf16 v[88:91], v[10:11], v[86:87], v[88:91]
    s_nop 4
    v_cvt_pk_bf16_f32 v88, v88, v89
    v_cvt_pk_bf16_f32 v89, v90, v91
    ds_pk_add_bf16 v7, v88 offset:65408
    ds_pk_add_bf16 v7, v89 offset:65412
    s_mov_b64 exec, s[50:51]
    s_branch L2_d29
L2_c30:
    s_lshl_b64 s[52:53], s[82:83], 1
    s_andn2_b64 s[52:53], s[52:53], s[80:81]
    s_andn2_b64 s[52:53], s[52:53], s[54:55]
    s_or_b64 s[80:81], s[80:81], s[52:53]
    s_not_b64 vcc, s[52:53]
    s_mov_b64 exec, -1
    v_cndmask_b32_dpp v84, v84, v84, vcc wave_shr:1 row_mask:0xf bank_mask:0xf
    v_cndmask_b32_dpp v85, v85, v85, vcc wave_shr:1 row_mask:0xf bank_mask:0xf
    s_lshr_b64 s[52:53], s[52:53], 1
    v_cndmask_b32_dpp v86, v86, v86, vcc wave_shr:1 row_mask:0xf bank_mask:0xf
    v_cndmask_b32_dpp v87, v87, v87, vcc wave_shr:1 row_mask:0xf bank_mask:0xf
    s_andn2_b64 s[82:83], s[82:83], s[52:53]
    v_cndmask_b32_dpp v7, v7, v7, vcc wave_shr:1 row_mask:0xf bank_mask:0xf
    s_mov_b64 exec, s[54:55]
    s_cbranch_scc0 L2_d30
    s_mov_b64 exec, s[82:83]
    s_nop 1
    v_mfma_f32_4x4x4_16b_bf16 v[88:91], v[12:13], v[84:85], 0
    s_nop 1
    v_mfma_f32_4x4x4_16b_bf16 v[88:91], v[10:11], v[86:87], v[88:91]
    s_nop 4
    v_cvt_pk_bf16_f32 v88, v88, v89
    v_cvt_pk_bf16_f32 v89, v90, v91
    ds_pk_add_bf16 v7, v88 offset:65408
    ds_pk_add_bf16 v7, v89 offset:65412
    s_mov_b64 exec, s[54:55]
    s_branch L2_d30
L2_c31:
    s_lshl_b64 s[52:53], s[82:83], 1
    s_andn2_b64 s[52:53], s[52:53], s[80:81]
    s_andn2_b64 s[52:53], s[52:53], s[50:51]
    s_or_b64 s[80:81], s[80:81], s[52:53]
    s_not_b64 vcc, s[52:53]
    s_mov_b64 exec, -1
    v_cndmask_b32_dpp v84, v84, v84, vcc wave_shr:1 row_mask:0xf bank_mask:0xf
    v_cndmask_b32_dpp v85, v85, v85, vcc wave_shr:1 row_mask:0xf bank_mask:0xf
    s_lshr_b64 s[52:53], s[52:53], 1
    v_cndmask_b32_dpp v86, v86, v86, vcc wave_shr:1 row_mask:0xf bank_mask:0xf
    v_cndmask_b32_dpp v87, v87, v87, vcc wave_shr:1 row_mask:0xf bank_mask:0xf
    s_andn2_b64 s[82:83], s[82:83], s[52:53]
    v_cndmask_b32_dpp v7, v7, v7, vcc wave_shr:1 row_mask:0xf bank_mask:0xf
    s_mov_b64 exec, s[50:51]
    s_cbranch_scc0 L2_d31
    s_mov_b64 exec, s[82:83]
    s_nop 1
    v_mfma_f32_4x4x4_16b_bf16 v[88:91], v[12:13], v[84:85], 0
    s_nop 1
    v_mfma_f32_4x4x4_16b_bf16 v[88:91], v[10:11], v[86:87], v[88:91]
    s_nop 4
    v_cvt_pk_bf16_f32 v88, v88, v89
    v_cvt_pk_bf16_f32 v89, v90, v91
    ds_pk_add_bf16 v7, v88 offset:65408
    ds_pk_add_bf16 v7, v89 offset:65412
    s_mov_b64 exec, s[50:51]
    s_branch L2_d31
L2_xo32:
    v_cmp_lt_u32 vcc, 20, v99
    s_mov_b32 s101, 1
    s_cbranch_vccz L2_xp32
    v_cmp_lt_u32 vcc, 32, v99
    v_cmp_lt_u32 s[58:59], 31, v88
    s_mov_b32 s101, 2
    s_or_b64 vcc, vcc, s[58:59]
    s_cbranch_scc0 L2_xp32
    s_mov_b32 s37, 0x10000
    s_branch L2_xp32
L2_c33:
    s_lshl_b64 s[52:53], s[82:83], 1
    s_andn2_b64 s[52:53], s[52:53], s[80:81]
    s_andn2_b64 s[52:53], s[52:53], s[54:55]
    s_or_b64 s[80:81], s[80:81], s[52:53]
    s_not_b64 vcc, s[52:53]
    s_mov_b64 exec, -1
    v_cndmask_b32_dpp v84, v84, v84, vcc wave_shr:1 row_mask:0xf bank_mask:0xf
    v_cndmask_b32_dpp v85, v85, v85, vcc wave_shr:1 row_mask:0xf bank_mask:0xf
    s_lshr_b64 s[52:53], s[52:53], 1
    v_cndmask_b32_dpp v86, v86, v86, vcc wave_shr:1 row_mask:0xf bank_mask:0xf
    v_cndmask_b32_dpp v87, v87, v87, vcc wave_shr:1 row_mask:0xf bank_mask:0xf
    s_andn2_b64 s[82:83], s[82:83], s[52:53]
    v_cndmask_b32_dpp v7, v7, v7, vcc wave_shr:1 row_mask:0xf bank_mask:0xf
    s_mov_b64 exec, s[54:55]
    s_cbranch_scc0 L2_d33
    s_mov_b64 exec, s[82:83]
    s_nop 1
    v_mfma_f32_4x4x4_16b_bf16 v[88:91], v[12:13], v[84:85], 0
    s_nop 1
    v_mfma_f32_4x4x4_16b_bf16 v[88:91], v[10:11], v[86:87], v[88:91]
    s_nop 4
    v_cvt_pk_bf16_f32 v88, v88, v89
    v_cvt_pk_bf16_f32 v89, v90, v91
    ds_pk_add_bf16 v7, v88 offset:65408
    ds_pk_add_bf16 v7, v89 offset:65412
    s_mov_b64 exec, s[54:55]
    s_branch L2_d33
L2_c34:
    s_lshl_b64 s[52:53], s[82:83], 1
    s_andn2_b64 s[52:53], s[52:53], s[80:81]
    s_andn2_b64 s[52:53], s[52:53], s[50:51]
    s_or_b64 s[80:81], s[80:81], s[52:53]
    s_not_b64 vcc, s[52:53]
    s_mov_b64 exec, -1
    v_cndmask_b32_dpp v84, v84, v84, vcc wave_shr:1 row_mask:0xf bank_mask:0xf
    v_cndmask_b32_dpp v85, v85, v85, vcc wave_shr:1 row_mask:0xf bank_mask:0xf
    s_lshr_b64 s[52:53], s[52:53], 1
    v_cndmask_b32_dpp v86, v86, v86, vcc wave_shr:1 row_mask:0xf bank_mask:0xf
    v_cndmask_b32_dpp v87, v87, v87, vcc wave_shr:1 row_mask:0xf bank_mask:0xf
    s_andn2_b64 s[82:83], s[82:83], s[52:53]
    v_cndmask_b32_dpp v7, v7, v7, vcc wave_shr:1 row_mask:0xf bank_mask:0xf
    s_mov_b64 exec, s[50:51]
    s_cbranch_scc0 L2_d34
    s_mov_b64 exec, s[82:83]
    s_nop 1
    v_mfma_f32_4x4x4_16b_bf16 v[88:91], v[12:13], v[84:85], 0
    s_nop 1
    v_mfma_f32_4x4x4_16b_bf16 v[88:91], v[10:11], v[86:87], v[88:91]
    s_nop 4
    v_cvt_pk_bf16_f32 v88, v88, v89
    v_cvt_pk_bf16_f32 v89, v90, v91
    ds_pk_add_bf16 v7, v88 offset:65408
    ds_pk_add_bf16 v7, v89 offset:65412
    s_mov_b64 exec, s[50:51]
    s_branch L2_d34
L2_c35:
    s_lshl_b64 s[52:53], s[82:83], 1
    s_andn2_b64 s[52:53], s[52:53], s[80:81]
    s_andn2_b64 s[52:53], s[52:53], s[54:55]
    s_or_b64 s[80:81], s[80:81], s[52:53]
    s_not_b64 vcc, s[52:53]
    s_mov_b64 exec, -1
    v_cndmask_b32_dpp v84, v84, v84, vcc wave_shr:1 row_mask:0xf bank_mask:0xf
    v_cndmask_b32_dpp v85, v85, v85, vcc wave_shr:1 row_mask:0xf bank_mask:0xf
    s_lshr_b64 s[52:53], s[52:53], 1
    v_cndmask_b32_dpp v86, v86, v86, vcc wave_shr:1 row_mask:0xf bank_mask:0xf
    v_cndmask_b32_dpp v87, v87, v87, vcc wave_shr:1 row_mask:0xf bank_mask:0xf
    s_andn2_b64 s[82:83], s[82:83], s[52:53]
    v_cndmask_b32_dpp v7, v7, v7, vcc wave_shr:1 row_mask:0xf bank_mask:0xf
    s_mov_b64 exec, s[54:55]
    s_cbranch_scc0 L2_d35
    s_mov_b64 exec, s[82:83]
    s_nop 1
    v_mfma_f32_4x4x4_16b_bf16 v[88:91], v[12:13], v[84:85], 0
    s_nop 1
    v_mfma_f32_4x4x4_16b_bf16 v[88:91], v[10:11], v[86:87], v[88:91]
    s_nop 4
    v_cvt_pk_bf16_f32 v88, v88, v89
    v_cvt_pk_bf16_f32 v89, v90, v91
    ds_pk_add_bf16 v7, v88 offset:65408
    ds_pk_add_bf16 v7, v89 offset:65412
    s_mov_b64 exec, s[54:55]
    s_branch L2_d35
L2_c36:
    s_lshl_b64 s[52:53], s[82:83], 1
    s_andn2_b64 s[52:53], s[52:53], s[80:81]
    s_andn2_b64 s[52:53], s[52:53], s[50:51]
    s_or_b64 s[80:81], s[80:81], s[52:53]
    s_not_b64 vcc, s[52:53]
    s_mov_b64 exec, -1
    v_cndmask_b32_dpp v84, v84, v84, vcc wave_shr:1 row_mask:0xf bank_mask:0xf
    v_cndmask_b32_dpp v85, v85, v85, vcc wave_shr:1 row_mask:0xf bank_mask:0xf
    s_lshr_b64 s[52:53], s[52:53], 1
    v_cndmask_b32_dpp v86, v86, v86, vcc wave_shr:1 row_mask:0xf bank_mask:0xf
    v_cndmask_b32_dpp v87, v87, v87, vcc wave_shr:1 row_mask:0xf bank_mask:0xf
    s_andn2_b64 s[82:83], s[82:83], s[52:53]
    v_cndmask_b32_dpp v7, v7, v7, vcc wave_shr:1 row_mask:0xf bank_mask:0xf
    s_mov_b64 exec, s[50:51]
    s_cbranch_scc0 L2_d36
    s_mov_b64 exec, s[82:83]
    s_nop 1
    v_mfma_f32_4x4x4_16b_bf16 v[88:91], v[12:13], v[84:85], 0
    s_nop 1
    v_mfma_f32_4x4x4_16b_bf16 v[88:91], v[10:11], v[86:87], v[88:91]
    s_nop 4
    v_cvt_pk_bf16_f32 v88, v88, v89
    v_cvt_pk_bf16_f32 v89, v90, v91
    ds_pk_add_bf16 v7, v88 offset:65408
    ds_pk_add_bf16 v7, v89 offset:65412
    s_mov_b64 exec, s[50:51]
    s_branch L2_d36
L2_c37:
    s_lshl_b64 s[52:53], s[82:83], 1
    s_andn2_b64 s[52:53], s[52:53], s[80:81]
    s_andn2_b64 s[52:53], s[52:53], s[54:55]
    s_or_b64 s[80:81], s[80:81], s[52:53]
    s_not_b64 vcc, s[52:53]
    s_mov_b64 exec, -1
    v_cndmask_b32_dpp v84, v84, v84, vcc wave_shr:1 row_mask:0xf bank_mask:0xf
    v_cndmask_b32_dpp v85, v85, v85, vcc wave_shr:1 row_mask:0xf bank_mask:0xf
    s_lshr_b64 s[52:53], s[52:53], 1
    v_cndmask_b32_dpp v86, v86, v86, vcc wave_shr:1 row_mask:0xf bank_mask:0xf
    v_cndmask_b32_dpp v87, v87, v87, vcc wave_shr:1 row_mask:0xf bank_mask:0xf
    s_andn2_b64 s[82:83], s[82:83], s[52:53]
    v_cndmask_b32_dpp v7, v7, v7, vcc wave_shr:1 row_mask:0xf bank_mask:0xf
    s_mov_b64 exec, s[54:55]
    s_cbranch_scc0 L2_d37
    s_mov_b64 exec, s[82:83]
    s_nop 1
    v_mfma_f32_4x4x4_16b_bf16 v[88:91], v[12:13], v[84:85], 0
    s_nop 1
    v_mfma_f32_4x4x4_16b_bf16 v[88:91], v[10:11], v[86:87], v[88:91]
    s_nop 4
    v_cvt_pk_bf16_f32 v88, v88, v89
    v_cvt_pk_bf16_f32 v89, v90, v91
    ds_pk_add_bf16 v7, v88 offset:65408
    ds_pk_add_bf16 v7, v89 offset:65412
    s_mov_b64 exec, s[54:55]
    s_branch L2_d37
L2_c38:
    s_lshl_b64 s[52:53], s[82:83], 1
    s_andn2_b64 s[52:53], s[52:53], s[80:81]
    s_andn2_b64 s[52:53], s[52:53], s[50:51]
    s_or_b64 s[80:81], s[80:81], s[52:53]
    s_not_b64 vcc, s[52:53]
    s_mov_b64 exec, -1
    v_cndmask_b32_dpp v84, v84, v84, vcc wave_shr:1 row_mask:0xf bank_mask:0xf
    v_cndmask_b32_dpp v85, v85, v85, vcc wave_shr:1 row_mask:0xf bank_mask:0xf
    s_lshr_b64 s[52:53], s[52:53], 1
    v_cndmask_b32_dpp v86, v86, v86, vcc wave_shr:1 row_mask:0xf bank_mask:0xf
    v_cndmask_b32_dpp v87, v87, v87, vcc wave_shr:1 row_mask:0xf bank_mask:0xf
    s_andn2_b64 s[82:83], s[82:83], s[52:53]
    v_cndmask_b32_dpp v7, v7, v7, vcc wave_shr:1 row_mask:0xf bank_mask:0xf
    s_mov_b64 exec, s[50:51]
    s_cbranch_scc0 L2_d38
    s_mov_b64 exec, s[82:83]
    s_nop 1
    v_mfma_f32_4x4x4_16b_bf16 v[88:91], v[12:13], v[84:85], 0
    s_nop 1
    v_mfma_f32_4x4x4_16b_bf16 v[88:91], v[10:11], v[86:87], v[88:91]
    s_nop 4
    v_cvt_pk_bf16_f32 v88, v88, v89
    v_cvt_pk_bf16_f32 v89, v90, v91
    ds_pk_add_bf16 v7, v88 offset:65408
    ds_pk_add_bf16 v7, v89 offset:65412
    s_mov_b64 exec, s[50:51]
    s_branch L2_d38
L2_c39:
    s_lshl_b64 s[52:53], s[82:83], 1
    s_andn2_b64 s[52:53], s[52:53], s[80:81]
    s_andn2_b64 s[52:53], s[52:53], s[54:55]
    s_or_b64 s[80:81], s[80:81], s[52:53]
    s_not_b64 vcc, s[52:53]
    s_mov_b64 exec, -1
    v_cndmask_b32_dpp v84, v84, v84, vcc wave_shr:1 row_mask:0xf bank_mask:0xf
    v_cndmask_b32_dpp v85, v85, v85, vcc wave_shr:1 row_mask:0xf bank_mask:0xf
    s_lshr_b64 s[52:53], s[52:53], 1
    v_cndmask_b32_dpp v86, v86, v86, vcc wave_shr:1 row_mask:0xf bank_mask:0xf
    v_cndmask_b32_dpp v87, v87, v87, vcc wave_shr:1 row_mask:0xf bank_mask:0xf
    s_andn2_b64 s[82:83], s[82:83], s[52:53]
    v_cndmask_b32_dpp v7, v7, v7, vcc wave_shr:1 row_mask:0xf bank_mask:0xf
    s_mov_b64 exec, s[54:55]
    s_cbranch_scc0 L2_d39
    s_mov_b64 exec, s[82:83]
    s_nop 1
    v_mfma_f32_4x4x4_16b_bf16 v[88:91], v[12:13], v[84:85], 0
    s_nop 1
    v_mfma_f32_4x4x4_16b_bf16 v[88:91], v[10:11], v[86:87], v[88:91]
    s_nop 4
    v_cvt_pk_bf16_f32 v88, v88, v89
    v_cvt_pk_bf16_f32 v89, v90, v91
    ds_pk_add_bf16 v7, v88 offset:65408
    ds_pk_add_bf16 v7, v89 offset:65412
    s_mov_b64 exec, s[54:55]
    s_branch L2_d39
L2_c40:
    s_lshl_b64 s[52:53], s[82:83], 1
    s_andn2_b64 s[52:53], s[52:53], s[80:81]
    s_andn2_b64 s[52:53], s[52:53], s[50:51]
    s_or_b64 s[80:81], s[80:81], s[52:53]
    s_not_b64 vcc, s[52:53]
    s_mov_b64 exec, -1
    v_cndmask_b32_dpp v84, v84, v84, vcc wave_shr:1 row_mask:0xf bank_mask:0xf
    v_cndmask_b32_dpp v85, v85, v85, vcc wave_shr:1 row_mask:0xf bank_mask:0xf
    s_lshr_b64 s[52:53], s[52:53], 1
    v_cndmask_b32_dpp v86, v86, v86, vcc wave_shr:1 row_mask:0xf bank_mask:0xf
    v_cndmask_b32_dpp v87, v87, v87, vcc wave_shr:1 row_mask:0xf bank_mask:0xf
    s_andn2_b64 s[82:83], s[82:83], s[52:53]
    v_cndmask_b32_dpp v7, v7, v7, vcc wave_shr:1 row_mask:0xf bank_mask:0xf
    s_mov_b64 exec, s[50:51]
    s_cbranch_scc0 L2_d40
    s_mov_b64 exec, s[82:83]
    s_nop 1
    v_mfma_f32_4x4x4_16b_bf16 v[88:91], v[12:13], v[84:85], 0
    s_nop 1
    v_mfma_f32_4x4x4_16b_bf16 v[88:91], v[10:11], v[86:87], v[88:91]
    s_nop 4
    v_cvt_pk_bf16_f32 v88, v88, v89
    v_cvt_pk_bf16_f32 v89, v90, v91
    ds_pk_add_bf16 v7, v88 offset:65408
    ds_pk_add_bf16 v7, v89 offset:65412
    s_mov_b64 exec, s[50:51]
    s_branch L2_d40
L2_c41:
    s_lshl_b64 s[52:53], s[82:83], 1
    s_andn2_b64 s[52:53], s[52:53], s[80:81]
    s_andn2_b64 s[52:53], s[52:53], s[54:55]
    s_or_b64 s[80:81], s[80:81], s[52:53]
    s_not_b64 vcc, s[52:53]
    s_mov_b64 exec, -1
    v_cndmask_b32_dpp v84, v84, v84, vcc wave_shr:1 row_mask:0xf bank_mask:0xf
    v_cndmask_b32_dpp v85, v85, v85, vcc wave_shr:1 row_mask:0xf bank_mask:0xf
    s_lshr_b64 s[52:53], s[52:53], 1
    v_cndmask_b32_dpp v86, v86, v86, vcc wave_shr:1 row_mask:0xf bank_mask:0xf
    v_cndmask_b32_dpp v87, v87, v87, vcc wave_shr:1 row_mask:0xf bank_mask:0xf
    s_andn2_b64 s[82:83], s[82:83], s[52:53]
    v_cndmask_b32_dpp v7, v7, v7, vcc wave_shr:1 row_mask:0xf bank_mask:0xf
    s_mov_b64 exec, s[54:55]
    s_cbranch_scc0 L2_d41
    s_mov_b64 exec, s[82:83]
    s_nop 1
    v_mfma_f32_4x4x4_16b_bf16 v[88:91], v[12:13], v[84:85], 0
    s_nop 1
    v_mfma_f32_4x4x4_16b_bf16 v[88:91], v[10:11], v[86:87], v[88:91]
    s_nop 4
    v_cvt_pk_bf16_f32 v88, v88, v89
    v_cvt_pk_bf16_f32 v89, v90, v91
    ds_pk_add_bf16 v7, v88 offset:65408
    ds_pk_add_bf16 v7, v89 offset:65412
    s_mov_b64 exec, s[54:55]
    s_branch L2_d41
L2_c42:
    s_lshl_b64 s[52:53], s[82:83], 1
    s_andn2_b64 s[52:53], s[52:53], s[80:81]
    s_andn2_b64 s[52:53], s[52:53], s[50:51]
    s_or_b64 s[80:81], s[80:81], s[52:53]
    s_not_b64 vcc, s[52:53]
    s_mov_b64 exec, -1
    v_cndmask_b32_dpp v84, v84, v84, vcc wave_shr:1 row_mask:0xf bank_mask:0xf
    v_cndmask_b32_dpp v85, v85, v85, vcc wave_shr:1 row_mask:0xf bank_mask:0xf
    s_lshr_b64 s[52:53], s[52:53], 1
    v_cndmask_b32_dpp v86, v86, v86, vcc wave_shr:1 row_mask:0xf bank_mask:0xf
    v_cndmask_b32_dpp v87, v87, v87, vcc wave_shr:1 row_mask:0xf bank_mask:0xf
    s_andn2_b64 s[82:83], s[82:83], s[52:53]
    v_cndmask_b32_dpp v7, v7, v7, vcc wave_shr:1 row_mask:0xf bank_mask:0xf
    s_mov_b64 exec, s[50:51]
    s_cbranch_scc0 L2_d42
    s_mov_b64 exec, s[82:83]
    s_nop 1
    v_mfma_f32_4x4x4_16b_bf16 v[88:91], v[12:13], v[84:85], 0
    s_nop 1
    v_mfma_f32_4x4x4_16b_bf16 v[88:91], v[10:11], v[86:87], v[88:91]
    s_nop 4
    v_cvt_pk_bf16_f32 v88, v88, v89
    v_cvt_pk_bf16_f32 v89, v90, v91
    ds_pk_add_bf16 v7, v88 offset:65408
    ds_pk_add_bf16 v7, v89 offset:65412
    s_mov_b64 exec, s[50:51]
    s_branch L2_d42
L2_xa43:
    s_cmp_eq_u32 s101, 1
    s_cbranch_scc1 L2_xc43
    v_lshlrev_b32 v89, 0, v96
    v_add_u32 v90, 140, v97
    v_bitop3_b32 v90, v89, v45, v90 bitop3:0x6a
    ds_write_b32 v98, v90 offset:28
    v_lshlrev_b32 v89, 4, v96
    v_add_u32 v90, 120, v97
    v_bitop3_b32 v90, v89, v45, v90 bitop3:0x6a
    ds_write_b32 v98, v90 offset:24
    v_lshlrev_b32 v89, 8, v96
    v_add_u32 v90, 100, v97
    v_bitop3_b32 v90, v89, v45, v90 bitop3:0x6a
    ds_write_b32 v98, v90 offset:20
L2_xc43:
    v_lshlrev_b32 v89, 12, v96
    v_add_u32 v90, 80, v97
    v_bitop3_b32 v90, v89, v45, v90 bitop3:0x6a
    ds_write_b32 v98, v90 offset:16
    s_branch L2_xb43
L2_xe43:
    v_cmp_lt_u32 vcc, 32, v99
    v_cmp_lt_u32 s[58:59], 31, v88
    v_lshrrev_b32 v89, 16, v96
    v_add_u32 v97, 80, v97
    s_or_b64 vcc, vcc, s[58:59]
    s_cbranch_scc1 L2_xs43
    v_lshlrev_b32 v89, v1, v89
    v_and_b32 v89, v45, v89
    v_cmp_ne_u32 vcc, 0, v89
    v_xor_b32 v90, v97, v89
    s_add_u32 s3, s37, s38
    v_mbcnt_lo_u32_b32 v98, vcc_lo, 0
    v_mbcnt_hi_u32_b32 v98, vcc_hi, v98
    s_bcnt1_i32_b64 s41, vcc
    v_lshl_add_u32 v98, v98, 2, s3
    s_mov_b64 exec, vcc
    ds_write_b32 v98, v90
    s_mov_b64 exec, -1
    s_lshl2_add_u32 s37, s41, s37
    s_branch L2_xr43
L2_xf43:
    s_waitcnt lgkmcnt(0)
    s_cmp_gt_u32 s37, 1024
    s_cbranch_scc1 L2_xs43
    v_mov_b32 v43, -1
    s_cmp_ge_u32 s37, 512
    s_cbranch_scc1 L2_xg43
    v_mov_b32 v42, -1
    s_cmp_ge_u32 s37, 256
    s_cbranch_scc1 L2_xg43
    v_mov_b32 v41, -1
    s_branch L2_xg43
L2_xs43:
    s_waitcnt lgkmcnt(0)
    v_mov_b32 v40, -1
    v_mov_b32 v41, -1
    v_mov_b32 v42, -1
    v_mov_b32 v43, -1
    s_add_u32 s3, s42, 2
    s_bitset1_b32 s36, s3
    s_branch L2_xg43
L2_c44:
    s_lshl_b64 s[52:53], s[82:83], 1
    s_andn2_b64 s[52:53], s[52:53], s[80:81]
    s_andn2_b64 s[52:53], s[52:53], s[54:55]
    s_or_b64 s[80:81], s[80:81], s[52:53]
    s_not_b64 vcc, s[52:53]
    s_mov_b64 exec, -1
    v_cndmask_b32_dpp v84, v84, v84, vcc wave_shr:1 row_mask:0xf bank_mask:0xf
    v_cndmask_b32_dpp v85, v85, v85, vcc wave_shr:1 row_mask:0xf bank_mask:0xf
    s_lshr_b64 s[52:53], s[52:53], 1
    v_cndmask_b32_dpp v86, v86, v86, vcc wave_shr:1 row_mask:0xf bank_mask:0xf
    v_cndmask_b32_dpp v87, v87, v87, vcc wave_shr:1 row_mask:0xf bank_mask:0xf
    s_andn2_b64 s[82:83], s[82:83], s[52:53]
    v_cndmask_b32_dpp v7, v7, v7, vcc wave_shr:1 row_mask:0xf bank_mask:0xf
    s_mov_b64 exec, s[54:55]
    s_cbranch_scc0 L2_d44
    s_mov_b64 exec, s[82:83]
    s_nop 1
    v_mfma_f32_4x4x4_16b_bf16 v[88:91], v[12:13], v[84:85], 0
    s_nop 1
    v_mfma_f32_4x4x4_16b_bf16 v[88:91], v[10:11], v[86:87], v[88:91]
    s_nop 4
    v_cvt_pk_bf16_f32 v88, v88, v89
    v_cvt_pk_bf16_f32 v89, v90, v91
    ds_pk_add_bf16 v7, v88 offset:65408
    ds_pk_add_bf16 v7, v89 offset:65412
    s_mov_b64 exec, s[54:55]
    s_branch L2_d44
L2_c45:
    s_lshl_b64 s[52:53], s[82:83], 1
    s_andn2_b64 s[52:53], s[52:53], s[80:81]
    s_andn2_b64 s[52:53], s[52:53], s[50:51]
    s_or_b64 s[80:81], s[80:81], s[52:53]
    s_not_b64 vcc, s[52:53]
    s_mov_b64 exec, -1
    v_cndmask_b32_dpp v84, v84, v84, vcc wave_shr:1 row_mask:0xf bank_mask:0xf
    v_cndmask_b32_dpp v85, v85, v85, vcc wave_shr:1 row_mask:0xf bank_mask:0xf
    s_lshr_b64 s[52:53], s[52:53], 1
    v_cndmask_b32_dpp v86, v86, v86, vcc wave_shr:1 row_mask:0xf bank_mask:0xf
    v_cndmask_b32_dpp v87, v87, v87, vcc wave_shr:1 row_mask:0xf bank_mask:0xf
    s_andn2_b64 s[82:83], s[82:83], s[52:53]
    v_cndmask_b32_dpp v7, v7, v7, vcc wave_shr:1 row_mask:0xf bank_mask:0xf
    s_mov_b64 exec, s[50:51]
    s_cbranch_scc0 L2_d45
    s_mov_b64 exec, s[82:83]
    s_nop 1
    v_mfma_f32_4x4x4_16b_bf16 v[88:91], v[12:13], v[84:85], 0
    s_nop 1
    v_mfma_f32_4x4x4_16b_bf16 v[88:91], v[10:11], v[86:87], v[88:91]
    s_nop 4
    v_cvt_pk_bf16_f32 v88, v88, v89
    v_cvt_pk_bf16_f32 v89, v90, v91
    ds_pk_add_bf16 v7, v88 offset:65408
    ds_pk_add_bf16 v7, v89 offset:65412
    s_mov_b64 exec, s[50:51]
    s_branch L2_d45
L2_c46:
    s_lshl_b64 s[52:53], s[82:83], 1
    s_andn2_b64 s[52:53], s[52:53], s[80:81]
    s_andn2_b64 s[52:53], s[52:53], s[54:55]
    s_or_b64 s[80:81], s[80:81], s[52:53]
    s_not_b64 vcc, s[52:53]
    s_mov_b64 exec, -1
    v_cndmask_b32_dpp v84, v84, v84, vcc wave_shr:1 row_mask:0xf bank_mask:0xf
    v_cndmask_b32_dpp v85, v85, v85, vcc wave_shr:1 row_mask:0xf bank_mask:0xf
    s_lshr_b64 s[52:53], s[52:53], 1
    v_cndmask_b32_dpp v86, v86, v86, vcc wave_shr:1 row_mask:0xf bank_mask:0xf
    v_cndmask_b32_dpp v87, v87, v87, vcc wave_shr:1 row_mask:0xf bank_mask:0xf
    s_andn2_b64 s[82:83], s[82:83], s[52:53]
    v_cndmask_b32_dpp v7, v7, v7, vcc wave_shr:1 row_mask:0xf bank_mask:0xf
    s_mov_b64 exec, s[54:55]
    s_cbranch_scc0 L2_d46
    s_mov_b64 exec, s[82:83]
    s_nop 1
    v_mfma_f32_4x4x4_16b_bf16 v[88:91], v[12:13], v[84:85], 0
    s_nop 1
    v_mfma_f32_4x4x4_16b_bf16 v[88:91], v[10:11], v[86:87], v[88:91]
    s_nop 4
    v_cvt_pk_bf16_f32 v88, v88, v89
    v_cvt_pk_bf16_f32 v89, v90, v91
    ds_pk_add_bf16 v7, v88 offset:65408
    ds_pk_add_bf16 v7, v89 offset:65412
    s_mov_b64 exec, s[54:55]
    s_branch L2_d46
L2_c47:
    s_lshl_b64 s[52:53], s[82:83], 1
    s_andn2_b64 s[52:53], s[52:53], s[80:81]
    s_andn2_b64 s[52:53], s[52:53], s[50:51]
    s_or_b64 s[80:81], s[80:81], s[52:53]
    s_not_b64 vcc, s[52:53]
    s_mov_b64 exec, -1
    v_cndmask_b32_dpp v84, v84, v84, vcc wave_shr:1 row_mask:0xf bank_mask:0xf
    v_cndmask_b32_dpp v85, v85, v85, vcc wave_shr:1 row_mask:0xf bank_mask:0xf
    s_lshr_b64 s[52:53], s[52:53], 1
    v_cndmask_b32_dpp v86, v86, v86, vcc wave_shr:1 row_mask:0xf bank_mask:0xf
    v_cndmask_b32_dpp v87, v87, v87, vcc wave_shr:1 row_mask:0xf bank_mask:0xf
    s_andn2_b64 s[82:83], s[82:83], s[52:53]
    v_cndmask_b32_dpp v7, v7, v7, vcc wave_shr:1 row_mask:0xf bank_mask:0xf
    s_mov_b64 exec, s[50:51]
    s_cbranch_scc0 L2_d47
    s_mov_b64 exec, s[82:83]
    s_nop 1
    v_mfma_f32_4x4x4_16b_bf16 v[88:91], v[12:13], v[84:85], 0
    s_nop 1
    v_mfma_f32_4x4x4_16b_bf16 v[88:91], v[10:11], v[86:87], v[88:91]
    s_nop 4
    v_cvt_pk_bf16_f32 v88, v88, v89
    v_cvt_pk_bf16_f32 v89, v90, v91
    ds_pk_add_bf16 v7, v88 offset:65408
    ds_pk_add_bf16 v7, v89 offset:65412
    s_mov_b64 exec, s[50:51]
    s_branch L2_d47
L2_c48:
    s_lshl_b64 s[52:53], s[82:83], 1
    s_andn2_b64 s[52:53], s[52:53], s[80:81]
    s_andn2_b64 s[52:53], s[52:53], s[54:55]
    s_or_b64 s[80:81], s[80:81], s[52:53]
    s_not_b64 vcc, s[52:53]
    s_mov_b64 exec, -1
    v_cndmask_b32_dpp v84, v84, v84, vcc wave_shr:1 row_mask:0xf bank_mask:0xf
    v_cndmask_b32_dpp v85, v85, v85, vcc wave_shr:1 row_mask:0xf bank_mask:0xf
    s_lshr_b64 s[52:53], s[52:53], 1
    v_cndmask_b32_dpp v86, v86, v86, vcc wave_shr:1 row_mask:0xf bank_mask:0xf
    v_cndmask_b32_dpp v87, v87, v87, vcc wave_shr:1 row_mask:0xf bank_mask:0xf
    s_andn2_b64 s[82:83], s[82:83], s[52:53]
    v_cndmask_b32_dpp v7, v7, v7, vcc wave_shr:1 row_mask:0xf bank_mask:0xf
    s_mov_b64 exec, s[54:55]
    s_cbranch_scc0 L2_d48
    s_mov_b64 exec, s[82:83]
    s_nop 1
    v_mfma_f32_4x4x4_16b_bf16 v[88:91], v[12:13], v[84:85], 0
    s_nop 1
    v_mfma_f32_4x4x4_16b_bf16 v[88:91], v[10:11], v[86:87], v[88:91]
    s_nop 4
    v_cvt_pk_bf16_f32 v88, v88, v89
    v_cvt_pk_bf16_f32 v89, v90, v91
    ds_pk_add_bf16 v7, v88 offset:65408
    ds_pk_add_bf16 v7, v89 offset:65412
    s_mov_b64 exec, s[54:55]
    s_branch L2_d48
L2_c49:
    s_lshl_b64 s[52:53], s[82:83], 1
    s_andn2_b64 s[52:53], s[52:53], s[80:81]
    s_andn2_b64 s[52:53], s[52:53], s[50:51]
    s_or_b64 s[80:81], s[80:81], s[52:53]
    s_not_b64 vcc, s[52:53]
    s_mov_b64 exec, -1
    v_cndmask_b32_dpp v84, v84, v84, vcc wave_shr:1 row_mask:0xf bank_mask:0xf
    v_cndmask_b32_dpp v85, v85, v85, vcc wave_shr:1 row_mask:0xf bank_mask:0xf
    s_lshr_b64 s[52:53], s[52:53], 1
    v_cndmask_b32_dpp v86, v86, v86, vcc wave_shr:1 row_mask:0xf bank_mask:0xf
    v_cndmask_b32_dpp v87, v87, v87, vcc wave_shr:1 row_mask:0xf bank_mask:0xf
    s_andn2_b64 s[82:83], s[82:83], s[52:53]
    v_cndmask_b32_dpp v7, v7, v7, vcc wave_shr:1 row_mask:0xf bank_mask:0xf
    s_mov_b64 exec, s[50:51]
    s_cbranch_scc0 L2_d49
    s_mov_b64 exec, s[82:83]
    s_nop 1
    v_mfma_f32_4x4x4_16b_bf16 v[88:91], v[12:13], v[84:85], 0
    s_nop 1
    v_mfma_f32_4x4x4_16b_bf16 v[88:91], v[10:11], v[86:87], v[88:91]
    s_nop 4
    v_cvt_pk_bf16_f32 v88, v88, v89
    v_cvt_pk_bf16_f32 v89, v90, v91
    ds_pk_add_bf16 v7, v88 offset:65408
    ds_pk_add_bf16 v7, v89 offset:65412
    s_mov_b64 exec, s[50:51]
    s_branch L2_d49
L2_xo50:
    v_cmp_lt_u32 vcc, 20, v99
    s_mov_b32 s101, 1
    s_cbranch_vccz L2_xp50
    v_cmp_lt_u32 vcc, 32, v99
    v_cmp_lt_u32 s[58:59], 31, v88
    s_mov_b32 s101, 2
    s_or_b64 vcc, vcc, s[58:59]
    s_cbranch_scc0 L2_xp50
    s_mov_b32 s37, 0x10000
    s_branch L2_xp50
L2_c51:
    s_lshl_b64 s[52:53], s[82:83], 1
    s_andn2_b64 s[52:53], s[52:53], s[80:81]
    s_andn2_b64 s[52:53], s[52:53], s[54:55]
    s_or_b64 s[80:81], s[80:81], s[52:53]
    s_not_b64 vcc, s[52:53]
    s_mov_b64 exec, -1
    v_cndmask_b32_dpp v84, v84, v84, vcc wave_shr:1 row_mask:0xf bank_mask:0xf
    v_cndmask_b32_dpp v85, v85, v85, vcc wave_shr:1 row_mask:0xf bank_mask:0xf
    s_lshr_b64 s[52:53], s[52:53], 1
    v_cndmask_b32_dpp v86, v86, v86, vcc wave_shr:1 row_mask:0xf bank_mask:0xf
    v_cndmask_b32_dpp v87, v87, v87, vcc wave_shr:1 row_mask:0xf bank_mask:0xf
    s_andn2_b64 s[82:83], s[82:83], s[52:53]
    v_cndmask_b32_dpp v7, v7, v7, vcc wave_shr:1 row_mask:0xf bank_mask:0xf
    s_mov_b64 exec, s[54:55]
    s_cbranch_scc0 L2_d51
    s_mov_b64 exec, s[82:83]
    s_nop 1
    v_mfma_f32_4x4x4_16b_bf16 v[88:91], v[12:13], v[84:85], 0
    s_nop 1
    v_mfma_f32_4x4x4_16b_bf16 v[88:91], v[10:11], v[86:87], v[88:91]
    s_nop 4
    v_cvt_pk_bf16_f32 v88, v88, v89
    v_cvt_pk_bf16_f32 v89, v90, v91
    ds_pk_add_bf16 v7, v88 offset:65408
    ds_pk_add_bf16 v7, v89 offset:65412
    s_mov_b64 exec, s[54:55]
    s_branch L2_d51
L2_c52:
    s_lshl_b64 s[52:53], s[82:83], 1
    s_andn2_b64 s[52:53], s[52:53], s[80:81]
    s_andn2_b64 s[52:53], s[52:53], s[50:51]
    s_or_b64 s[80:81], s[80:81], s[52:53]
    s_not_b64 vcc, s[52:53]
    s_mov_b64 exec, -1
    v_cndmask_b32_dpp v84, v84, v84, vcc wave_shr:1 row_mask:0xf bank_mask:0xf
    v_cndmask_b32_dpp v85, v85, v85, vcc wave_shr:1 row_mask:0xf bank_mask:0xf
    s_lshr_b64 s[52:53], s[52:53], 1
    v_cndmask_b32_dpp v86, v86, v86, vcc wave_shr:1 row_mask:0xf bank_mask:0xf
    v_cndmask_b32_dpp v87, v87, v87, vcc wave_shr:1 row_mask:0xf bank_mask:0xf
    s_andn2_b64 s[82:83], s[82:83], s[52:53]
    v_cndmask_b32_dpp v7, v7, v7, vcc wave_shr:1 row_mask:0xf bank_mask:0xf
    s_mov_b64 exec, s[50:51]
    s_cbranch_scc0 L2_d52
    s_mov_b64 exec, s[82:83]
    s_nop 1
    v_mfma_f32_4x4x4_16b_bf16 v[88:91], v[12:13], v[84:85], 0
    s_nop 1
    v_mfma_f32_4x4x4_16b_bf16 v[88:91], v[10:11], v[86:87], v[88:91]
    s_nop 4
    v_cvt_pk_bf16_f32 v88, v88, v89
    v_cvt_pk_bf16_f32 v89, v90, v91
    ds_pk_add_bf16 v7, v88 offset:65408
    ds_pk_add_bf16 v7, v89 offset:65412
    s_mov_b64 exec, s[50:51]
    s_branch L2_d52
L2_c53:
    s_lshl_b64 s[52:53], s[82:83], 1
    s_andn2_b64 s[52:53], s[52:53], s[80:81]
    s_andn2_b64 s[52:53], s[52:53], s[54:55]
    s_or_b64 s[80:81], s[80:81], s[52:53]
    s_not_b64 vcc, s[52:53]
    s_mov_b64 exec, -1
    v_cndmask_b32_dpp v84, v84, v84, vcc wave_shr:1 row_mask:0xf bank_mask:0xf
    v_cndmask_b32_dpp v85, v85, v85, vcc wave_shr:1 row_mask:0xf bank_mask:0xf
    s_lshr_b64 s[52:53], s[52:53], 1
    v_cndmask_b32_dpp v86, v86, v86, vcc wave_shr:1 row_mask:0xf bank_mask:0xf
    v_cndmask_b32_dpp v87, v87, v87, vcc wave_shr:1 row_mask:0xf bank_mask:0xf
    s_andn2_b64 s[82:83], s[82:83], s[52:53]
    v_cndmask_b32_dpp v7, v7, v7, vcc wave_shr:1 row_mask:0xf bank_mask:0xf
    s_mov_b64 exec, s[54:55]
    s_cbranch_scc0 L2_d53
    s_mov_b64 exec, s[82:83]
    s_nop 1
    v_mfma_f32_4x4x4_16b_bf16 v[88:91], v[12:13], v[84:85], 0
    s_nop 1
    v_mfma_f32_4x4x4_16b_bf16 v[88:91], v[10:11], v[86:87], v[88:91]
    s_nop 4
    v_cvt_pk_bf16_f32 v88, v88, v89
    v_cvt_pk_bf16_f32 v89, v90, v91
    ds_pk_add_bf16 v7, v88 offset:65408
    ds_pk_add_bf16 v7, v89 offset:65412
    s_mov_b64 exec, s[54:55]
    s_branch L2_d53
L2_c54:
    s_lshl_b64 s[52:53], s[82:83], 1
    s_andn2_b64 s[52:53], s[52:53], s[80:81]
    s_andn2_b64 s[52:53], s[52:53], s[50:51]
    s_or_b64 s[80:81], s[80:81], s[52:53]
    s_not_b64 vcc, s[52:53]
    s_mov_b64 exec, -1
    v_cndmask_b32_dpp v84, v84, v84, vcc wave_shr:1 row_mask:0xf bank_mask:0xf
    v_cndmask_b32_dpp v85, v85, v85, vcc wave_shr:1 row_mask:0xf bank_mask:0xf
    s_lshr_b64 s[52:53], s[52:53], 1
    v_cndmask_b32_dpp v86, v86, v86, vcc wave_shr:1 row_mask:0xf bank_mask:0xf
    v_cndmask_b32_dpp v87, v87, v87, vcc wave_shr:1 row_mask:0xf bank_mask:0xf
    s_andn2_b64 s[82:83], s[82:83], s[52:53]
    v_cndmask_b32_dpp v7, v7, v7, vcc wave_shr:1 row_mask:0xf bank_mask:0xf
    s_mov_b64 exec, s[50:51]
    s_cbranch_scc0 L2_d54
    s_mov_b64 exec, s[82:83]
    s_nop 1
    v_mfma_f32_4x4x4_16b_bf16 v[88:91], v[12:13], v[84:85], 0
    s_nop 1
    v_mfma_f32_4x4x4_16b_bf16 v[88:91], v[10:11], v[86:87], v[88:91]
    s_nop 4
    v_cvt_pk_bf16_f32 v88, v88, v89
    v_cvt_pk_bf16_f32 v89, v90, v91
    ds_pk_add_bf16 v7, v88 offset:65408
    ds_pk_add_bf16 v7, v89 offset:65412
    s_mov_b64 exec, s[50:51]
    s_branch L2_d54
L2_c55:
    s_lshl_b64 s[52:53], s[82:83], 1
    s_andn2_b64 s[52:53], s[52:53], s[80:81]
    s_andn2_b64 s[52:53], s[52:53], s[54:55]
    s_or_b64 s[80:81], s[80:81], s[52:53]
    s_not_b64 vcc, s[52:53]
    s_mov_b64 exec, -1
    v_cndmask_b32_dpp v84, v84, v84, vcc wave_shr:1 row_mask:0xf bank_mask:0xf
    v_cndmask_b32_dpp v85, v85, v85, vcc wave_shr:1 row_mask:0xf bank_mask:0xf
    s_lshr_b64 s[52:53], s[52:53], 1
    v_cndmask_b32_dpp v86, v86, v86, vcc wave_shr:1 row_mask:0xf bank_mask:0xf
    v_cndmask_b32_dpp v87, v87, v87, vcc wave_shr:1 row_mask:0xf bank_mask:0xf
    s_andn2_b64 s[82:83], s[82:83], s[52:53]
    v_cndmask_b32_dpp v7, v7, v7, vcc wave_shr:1 row_mask:0xf bank_mask:0xf
    s_mov_b64 exec, s[54:55]
    s_cbranch_scc0 L2_d55
    s_mov_b64 exec, s[82:83]
    s_nop 1
    v_mfma_f32_4x4x4_16b_bf16 v[88:91], v[12:13], v[84:85], 0
    s_nop 1
    v_mfma_f32_4x4x4_16b_bf16 v[88:91], v[10:11], v[86:87], v[88:91]
    s_nop 4
    v_cvt_pk_bf16_f32 v88, v88, v89
    v_cvt_pk_bf16_f32 v89, v90, v91
    ds_pk_add_bf16 v7, v88 offset:65408
    ds_pk_add_bf16 v7, v89 offset:65412
    s_mov_b64 exec, s[54:55]
    s_branch L2_d55
L2_c56:
    s_lshl_b64 s[52:53], s[82:83], 1
    s_andn2_b64 s[52:53], s[52:53], s[80:81]
    s_andn2_b64 s[52:53], s[52:53], s[50:51]
    s_or_b64 s[80:81], s[80:81], s[52:53]
    s_not_b64 vcc, s[52:53]
    s_mov_b64 exec, -1
    v_cndmask_b32_dpp v84, v84, v84, vcc wave_shr:1 row_mask:0xf bank_mask:0xf
    v_cndmask_b32_dpp v85, v85, v85, vcc wave_shr:1 row_mask:0xf bank_mask:0xf
    s_lshr_b64 s[52:53], s[52:53], 1
    v_cndmask_b32_dpp v86, v86, v86, vcc wave_shr:1 row_mask:0xf bank_mask:0xf
    v_cndmask_b32_dpp v87, v87, v87, vcc wave_shr:1 row_mask:0xf bank_mask:0xf
    s_andn2_b64 s[82:83], s[82:83], s[52:53]
    v_cndmask_b32_dpp v7, v7, v7, vcc wave_shr:1 row_mask:0xf bank_mask:0xf
    s_mov_b64 exec, s[50:51]
    s_cbranch_scc0 L2_d56
    s_mov_b64 exec, s[82:83]
    s_nop 1
    v_mfma_f32_4x4x4_16b_bf16 v[88:91], v[12:13], v[84:85], 0
    s_nop 1
    v_mfma_f32_4x4x4_16b_bf16 v[88:91], v[10:11], v[86:87], v[88:91]
    s_nop 4
    v_cvt_pk_bf16_f32 v88, v88, v89
    v_cvt_pk_bf16_f32 v89, v90, v91
    ds_pk_add_bf16 v7, v88 offset:65408
    ds_pk_add_bf16 v7, v89 offset:65412
    s_mov_b64 exec, s[50:51]
    s_branch L2_d56
L2_c57:
    s_lshl_b64 s[52:53], s[82:83], 1
    s_andn2_b64 s[52:53], s[52:53], s[80:81]
    s_andn2_b64 s[52:53], s[52:53], s[54:55]
    s_or_b64 s[80:81], s[80:81], s[52:53]
    s_not_b64 vcc, s[52:53]
    s_mov_b64 exec, -1
    v_cndmask_b32_dpp v84, v84, v84, vcc wave_shr:1 row_mask:0xf bank_mask:0xf
    v_cndmask_b32_dpp v85, v85, v85, vcc wave_shr:1 row_mask:0xf bank_mask:0xf
    s_lshr_b64 s[52:53], s[52:53], 1
    v_cndmask_b32_dpp v86, v86, v86, vcc wave_shr:1 row_mask:0xf bank_mask:0xf
    v_cndmask_b32_dpp v87, v87, v87, vcc wave_shr:1 row_mask:0xf bank_mask:0xf
    s_andn2_b64 s[82:83], s[82:83], s[52:53]
    v_cndmask_b32_dpp v7, v7, v7, vcc wave_shr:1 row_mask:0xf bank_mask:0xf
    s_mov_b64 exec, s[54:55]
    s_cbranch_scc0 L2_d57
    s_mov_b64 exec, s[82:83]
    s_nop 1
    v_mfma_f32_4x4x4_16b_bf16 v[88:91], v[12:13], v[84:85], 0
    s_nop 1
    v_mfma_f32_4x4x4_16b_bf16 v[88:91], v[10:11], v[86:87], v[88:91]
    s_nop 4
    v_cvt_pk_bf16_f32 v88, v88, v89
    v_cvt_pk_bf16_f32 v89, v90, v91
    ds_pk_add_bf16 v7, v88 offset:65408
    ds_pk_add_bf16 v7, v89 offset:65412
    s_mov_b64 exec, s[54:55]
    s_branch L2_d57
L2_c58:
    s_lshl_b64 s[52:53], s[82:83], 1
    s_andn2_b64 s[52:53], s[52:53], s[80:81]
    s_andn2_b64 s[52:53], s[52:53], s[50:51]
    s_or_b64 s[80:81], s[80:81], s[52:53]
    s_not_b64 vcc, s[52:53]
    s_mov_b64 exec, -1
    v_cndmask_b32_dpp v84, v84, v84, vcc wave_shr:1 row_mask:0xf bank_mask:0xf
    v_cndmask_b32_dpp v85, v85, v85, vcc wave_shr:1 row_mask:0xf bank_mask:0xf
    s_lshr_b64 s[52:53], s[52:53], 1
    v_cndmask_b32_dpp v86, v86, v86, vcc wave_shr:1 row_mask:0xf bank_mask:0xf
    v_cndmask_b32_dpp v87, v87, v87, vcc wave_shr:1 row_mask:0xf bank_mask:0xf
    s_andn2_b64 s[82:83], s[82:83], s[52:53]
    v_cndmask_b32_dpp v7, v7, v7, vcc wave_shr:1 row_mask:0xf bank_mask:0xf
    s_mov_b64 exec, s[50:51]
    s_cbranch_scc0 L2_d58
    s_mov_b64 exec, s[82:83]
    s_nop 1
    v_mfma_f32_4x4x4_16b_bf16 v[88:91], v[12:13], v[84:85], 0
    s_nop 1
    v_mfma_f32_4x4x4_16b_bf16 v[88:91], v[10:11], v[86:87], v[88:91]
    s_nop 4
    v_cvt_pk_bf16_f32 v88, v88, v89
    v_cvt_pk_bf16_f32 v89, v90, v91
    ds_pk_add_bf16 v7, v88 offset:65408
    ds_pk_add_bf16 v7, v89 offset:65412
    s_mov_b64 exec, s[50:51]
    s_branch L2_d58
L2_c59:
    s_lshl_b64 s[52:53], s[82:83], 1
    s_andn2_b64 s[52:53], s[52:53], s[80:81]
    s_andn2_b64 s[52:53], s[52:53], s[54:55]
    s_or_b64 s[80:81], s[80:81], s[52:53]
    s_not_b64 vcc, s[52:53]
    s_mov_b64 exec, -1
    v_cndmask_b32_dpp v84, v84, v84, vcc wave_shr:1 row_mask:0xf bank_mask:0xf
    v_cndmask_b32_dpp v85, v85, v85, vcc wave_shr:1 row_mask:0xf bank_mask:0xf
    s_lshr_b64 s[52:53], s[52:53], 1
    v_cndmask_b32_dpp v86, v86, v86, vcc wave_shr:1 row_mask:0xf bank_mask:0xf
    v_cndmask_b32_dpp v87, v87, v87, vcc wave_shr:1 row_mask:0xf bank_mask:0xf
    s_andn2_b64 s[82:83], s[82:83], s[52:53]
    v_cndmask_b32_dpp v7, v7, v7, vcc wave_shr:1 row_mask:0xf bank_mask:0xf
    s_mov_b64 exec, s[54:55]
    s_cbranch_scc0 L2_d59
    s_mov_b64 exec, s[82:83]
    s_nop 1
    v_mfma_f32_4x4x4_16b_bf16 v[88:91], v[12:13], v[84:85], 0
    s_nop 1
    v_mfma_f32_4x4x4_16b_bf16 v[88:91], v[10:11], v[86:87], v[88:91]
    s_nop 4
    v_cvt_pk_bf16_f32 v88, v88, v89
    v_cvt_pk_bf16_f32 v89, v90, v91
    ds_pk_add_bf16 v7, v88 offset:65408
    ds_pk_add_bf16 v7, v89 offset:65412
    s_mov_b64 exec, s[54:55]
    s_branch L2_d59
L2_c60:
    s_lshl_b64 s[52:53], s[82:83], 1
    s_andn2_b64 s[52:53], s[52:53], s[80:81]
    s_andn2_b64 s[52:53], s[52:53], s[50:51]
    s_or_b64 s[80:81], s[80:81], s[52:53]
    s_not_b64 vcc, s[52:53]
    s_mov_b64 exec, -1
    v_cndmask_b32_dpp v84, v84, v84, vcc wave_shr:1 row_mask:0xf bank_mask:0xf
    v_cndmask_b32_dpp v85, v85, v85, vcc wave_shr:1 row_mask:0xf bank_mask:0xf
    s_lshr_b64 s[52:53], s[52:53], 1
    v_cndmask_b32_dpp v86, v86, v86, vcc wave_shr:1 row_mask:0xf bank_mask:0xf
    v_cndmask_b32_dpp v87, v87, v87, vcc wave_shr:1 row_mask:0xf bank_mask:0xf
    s_andn2_b64 s[82:83], s[82:83], s[52:53]
    v_cndmask_b32_dpp v7, v7, v7, vcc wave_shr:1 row_mask:0xf bank_mask:0xf
    s_mov_b64 exec, s[50:51]
    s_cbranch_scc0 L2_d60
    s_mov_b64 exec, s[82:83]
    s_nop 1
    v_mfma_f32_4x4x4_16b_bf16 v[88:91], v[12:13], v[84:85], 0
    s_nop 1
    v_mfma_f32_4x4x4_16b_bf16 v[88:91], v[10:11], v[86:87], v[88:91]
    s_nop 4
    v_cvt_pk_bf16_f32 v88, v88, v89
    v_cvt_pk_bf16_f32 v89, v90, v91
    ds_pk_add_bf16 v7, v88 offset:65408
    ds_pk_add_bf16 v7, v89 offset:65412
    s_mov_b64 exec, s[50:51]
    s_branch L2_d60
L2_xa61:
    s_cmp_eq_u32 s101, 1
    s_cbranch_scc1 L2_xc61
    v_lshlrev_b32 v89, 0, v96
    v_add_u32 v90, 140, v97
    v_bitop3_b32 v90, v89, v45, v90 bitop3:0x6a
    ds_write_b32 v98, v90 offset:28
    v_lshlrev_b32 v89, 4, v96
    v_add_u32 v90, 120, v97
    v_bitop3_b32 v90, v89, v45, v90 bitop3:0x6a
    ds_write_b32 v98, v90 offset:24
    v_lshlrev_b32 v89, 8, v96
    v_add_u32 v90, 100, v97
    v_bitop3_b32 v90, v89, v45, v90 bitop3:0x6a
    ds_write_b32 v98, v90 offset:20
L2_xc61:
    v_lshlrev_b32 v89, 12, v96
    v_add_u32 v90, 80, v97
    v_bitop3_b32 v90, v89, v45, v90 bitop3:0x6a
    ds_write_b32 v98, v90 offset:16
    s_branch L2_xb61
L2_xe61:
    v_cmp_lt_u32 vcc, 32, v99
    v_cmp_lt_u32 s[58:59], 31, v88
    v_lshrrev_b32 v89, 16, v96
    v_add_u32 v97, 80, v97
    s_or_b64 vcc, vcc, s[58:59]
    s_cbranch_scc1 L2_xs61
    v_lshlrev_b32 v89, v1, v89
    v_and_b32 v89, v45, v89
    v_cmp_ne_u32 vcc, 0, v89
    v_xor_b32 v90, v97, v89
    s_add_u32 s3, s37, s38
    v_mbcnt_lo_u32_b32 v98, vcc_lo, 0
    v_mbcnt_hi_u32_b32 v98, vcc_hi, v98
    s_bcnt1_i32_b64 s41, vcc
    v_lshl_add_u32 v98, v98, 2, s3
    s_mov_b64 exec, vcc
    ds_write_b32 v98, v90
    s_mov_b64 exec, -1
    s_lshl2_add_u32 s37, s41, s37
    s_branch L2_xr61
L2_xf61:
    s_waitcnt lgkmcnt(0)
    s_cmp_gt_u32 s37, 1024
    s_cbranch_scc1 L2_xs61
    v_mov_b32 v43, -1
    s_cmp_ge_u32 s37, 512
    s_cbranch_scc1 L2_xg61
    v_mov_b32 v42, -1
    s_cmp_ge_u32 s37, 256
    s_cbranch_scc1 L2_xg61
    v_mov_b32 v41, -1
    s_branch L2_xg61
L2_xs61:
    s_waitcnt lgkmcnt(0)
    v_mov_b32 v40, -1
    v_mov_b32 v41, -1
    v_mov_b32 v42, -1
    v_mov_b32 v43, -1
    s_add_u32 s3, s42, 2
    s_bitset1_b32 s36, s3
    s_branch L2_xg61
L2_c62:
    s_lshl_b64 s[52:53], s[82:83], 1
    s_andn2_b64 s[52:53], s[52:53], s[80:81]
    s_andn2_b64 s[52:53], s[52:53], s[54:55]
    s_or_b64 s[80:81], s[80:81], s[52:53]
    s_not_b64 vcc, s[52:53]
    s_mov_b64 exec, -1
    v_cndmask_b32_dpp v84, v84, v84, vcc wave_shr:1 row_mask:0xf bank_mask:0xf
    v_cndmask_b32_dpp v85, v85, v85, vcc wave_shr:1 row_mask:0xf bank_mask:0xf
    s_lshr_b64 s[52:53], s[52:53], 1
    v_cndmask_b32_dpp v86, v86, v86, vcc wave_shr:1 row_mask:0xf bank_mask:0xf
    v_cndmask_b32_dpp v87, v87, v87, vcc wave_shr:1 row_mask:0xf bank_mask:0xf
    s_andn2_b64 s[82:83], s[82:83], s[52:53]
    v_cndmask_b32_dpp v7, v7, v7, vcc wave_shr:1 row_mask:0xf bank_mask:0xf
    s_mov_b64 exec, s[54:55]
    s_cbranch_scc0 L2_d62
    s_mov_b64 exec, s[82:83]
    s_nop 1
    v_mfma_f32_4x4x4_16b_bf16 v[88:91], v[12:13], v[84:85], 0
    s_nop 1
    v_mfma_f32_4x4x4_16b_bf16 v[88:91], v[10:11], v[86:87], v[88:91]
    s_nop 4
    v_cvt_pk_bf16_f32 v88, v88, v89
    v_cvt_pk_bf16_f32 v89, v90, v91
    ds_pk_add_bf16 v7, v88 offset:65408
    ds_pk_add_bf16 v7, v89 offset:65412
    s_mov_b64 exec, s[54:55]
    s_branch L2_d62
L2_c63:
    s_lshl_b64 s[52:53], s[82:83], 1
    s_andn2_b64 s[52:53], s[52:53], s[80:81]
    s_andn2_b64 s[52:53], s[52:53], s[50:51]
    s_or_b64 s[80:81], s[80:81], s[52:53]
    s_not_b64 vcc, s[52:53]
    s_mov_b64 exec, -1
    v_cndmask_b32_dpp v84, v84, v84, vcc wave_shr:1 row_mask:0xf bank_mask:0xf
    v_cndmask_b32_dpp v85, v85, v85, vcc wave_shr:1 row_mask:0xf bank_mask:0xf
    s_lshr_b64 s[52:53], s[52:53], 1
    v_cndmask_b32_dpp v86, v86, v86, vcc wave_shr:1 row_mask:0xf bank_mask:0xf
    v_cndmask_b32_dpp v87, v87, v87, vcc wave_shr:1 row_mask:0xf bank_mask:0xf
    s_andn2_b64 s[82:83], s[82:83], s[52:53]
    v_cndmask_b32_dpp v7, v7, v7, vcc wave_shr:1 row_mask:0xf bank_mask:0xf
    s_mov_b64 exec, s[50:51]
    s_cbranch_scc0 L2_d63
    s_mov_b64 exec, s[82:83]
    s_nop 1
    v_mfma_f32_4x4x4_16b_bf16 v[88:91], v[12:13], v[84:85], 0
    s_nop 1
    v_mfma_f32_4x4x4_16b_bf16 v[88:91], v[10:11], v[86:87], v[88:91]
    s_nop 4
    v_cvt_pk_bf16_f32 v88, v88, v89
    v_cvt_pk_bf16_f32 v89, v90, v91
    ds_pk_add_bf16 v7, v88 offset:65408
    ds_pk_add_bf16 v7, v89 offset:65412
    s_mov_b64 exec, s[50:51]
    s_branch L2_d63
L2_c64:
    s_lshl_b64 s[52:53], s[82:83], 1
    s_andn2_b64 s[52:53], s[52:53], s[80:81]
    s_andn2_b64 s[52:53], s[52:53], s[54:55]
    s_or_b64 s[80:81], s[80:81], s[52:53]
    s_not_b64 vcc, s[52:53]
    s_mov_b64 exec, -1
    v_cndmask_b32_dpp v84, v84, v84, vcc wave_shr:1 row_mask:0xf bank_mask:0xf
    v_cndmask_b32_dpp v85, v85, v85, vcc wave_shr:1 row_mask:0xf bank_mask:0xf
    s_lshr_b64 s[52:53], s[52:53], 1
    v_cndmask_b32_dpp v86, v86, v86, vcc wave_shr:1 row_mask:0xf bank_mask:0xf
    v_cndmask_b32_dpp v87, v87, v87, vcc wave_shr:1 row_mask:0xf bank_mask:0xf
    s_andn2_b64 s[82:83], s[82:83], s[52:53]
    v_cndmask_b32_dpp v7, v7, v7, vcc wave_shr:1 row_mask:0xf bank_mask:0xf
    s_mov_b64 exec, s[54:55]
    s_cbranch_scc0 L2_d64
    s_mov_b64 exec, s[82:83]
    s_nop 1
    v_mfma_f32_4x4x4_16b_bf16 v[88:91], v[12:13], v[84:85], 0
    s_nop 1
    v_mfma_f32_4x4x4_16b_bf16 v[88:91], v[10:11], v[86:87], v[88:91]
    s_nop 4
    v_cvt_pk_bf16_f32 v88, v88, v89
    v_cvt_pk_bf16_f32 v89, v90, v91
    ds_pk_add_bf16 v7, v88 offset:65408
    ds_pk_add_bf16 v7, v89 offset:65412
    s_mov_b64 exec, s[54:55]
    s_branch L2_d64
L2_c65:
    s_lshl_b64 s[52:53], s[82:83], 1
    s_andn2_b64 s[52:53], s[52:53], s[80:81]
    s_andn2_b64 s[52:53], s[52:53], s[50:51]
    s_or_b64 s[80:81], s[80:81], s[52:53]
    s_not_b64 vcc, s[52:53]
    s_mov_b64 exec, -1
    v_cndmask_b32_dpp v84, v84, v84, vcc wave_shr:1 row_mask:0xf bank_mask:0xf
    v_cndmask_b32_dpp v85, v85, v85, vcc wave_shr:1 row_mask:0xf bank_mask:0xf
    s_lshr_b64 s[52:53], s[52:53], 1
    v_cndmask_b32_dpp v86, v86, v86, vcc wave_shr:1 row_mask:0xf bank_mask:0xf
    v_cndmask_b32_dpp v87, v87, v87, vcc wave_shr:1 row_mask:0xf bank_mask:0xf
    s_andn2_b64 s[82:83], s[82:83], s[52:53]
    v_cndmask_b32_dpp v7, v7, v7, vcc wave_shr:1 row_mask:0xf bank_mask:0xf
    s_mov_b64 exec, s[50:51]
    s_cbranch_scc0 L2_d65
    s_mov_b64 exec, s[82:83]
    s_nop 1
    v_mfma_f32_4x4x4_16b_bf16 v[88:91], v[12:13], v[84:85], 0
    s_nop 1
    v_mfma_f32_4x4x4_16b_bf16 v[88:91], v[10:11], v[86:87], v[88:91]
    s_nop 4
    v_cvt_pk_bf16_f32 v88, v88, v89
    v_cvt_pk_bf16_f32 v89, v90, v91
    ds_pk_add_bf16 v7, v88 offset:65408
    ds_pk_add_bf16 v7, v89 offset:65412
    s_mov_b64 exec, s[50:51]
    s_branch L2_d65
L2_c66:
    s_lshl_b64 s[52:53], s[82:83], 1
    s_andn2_b64 s[52:53], s[52:53], s[80:81]
    s_andn2_b64 s[52:53], s[52:53], s[54:55]
    s_or_b64 s[80:81], s[80:81], s[52:53]
    s_not_b64 vcc, s[52:53]
    s_mov_b64 exec, -1
    v_cndmask_b32_dpp v84, v84, v84, vcc wave_shr:1 row_mask:0xf bank_mask:0xf
    v_cndmask_b32_dpp v85, v85, v85, vcc wave_shr:1 row_mask:0xf bank_mask:0xf
    s_lshr_b64 s[52:53], s[52:53], 1
    v_cndmask_b32_dpp v86, v86, v86, vcc wave_shr:1 row_mask:0xf bank_mask:0xf
    v_cndmask_b32_dpp v87, v87, v87, vcc wave_shr:1 row_mask:0xf bank_mask:0xf
    s_andn2_b64 s[82:83], s[82:83], s[52:53]
    v_cndmask_b32_dpp v7, v7, v7, vcc wave_shr:1 row_mask:0xf bank_mask:0xf
    s_mov_b64 exec, s[54:55]
    s_cbranch_scc0 L2_d66
    s_mov_b64 exec, s[82:83]
    s_nop 1
    v_mfma_f32_4x4x4_16b_bf16 v[88:91], v[12:13], v[84:85], 0
    s_nop 1
    v_mfma_f32_4x4x4_16b_bf16 v[88:91], v[10:11], v[86:87], v[88:91]
    s_nop 4
    v_cvt_pk_bf16_f32 v88, v88, v89
    v_cvt_pk_bf16_f32 v89, v90, v91
    ds_pk_add_bf16 v7, v88 offset:65408
    ds_pk_add_bf16 v7, v89 offset:65412
    s_mov_b64 exec, s[54:55]
    s_branch L2_d66
L2_c67:
    s_lshl_b64 s[52:53], s[82:83], 1
    s_andn2_b64 s[52:53], s[52:53], s[80:81]
    s_andn2_b64 s[52:53], s[52:53], s[50:51]
    s_or_b64 s[80:81], s[80:81], s[52:53]
    s_not_b64 vcc, s[52:53]
    s_mov_b64 exec, -1
    v_cndmask_b32_dpp v84, v84, v84, vcc wave_shr:1 row_mask:0xf bank_mask:0xf
    v_cndmask_b32_dpp v85, v85, v85, vcc wave_shr:1 row_mask:0xf bank_mask:0xf
    s_lshr_b64 s[52:53], s[52:53], 1
    v_cndmask_b32_dpp v86, v86, v86, vcc wave_shr:1 row_mask:0xf bank_mask:0xf
    v_cndmask_b32_dpp v87, v87, v87, vcc wave_shr:1 row_mask:0xf bank_mask:0xf
    s_andn2_b64 s[82:83], s[82:83], s[52:53]
    v_cndmask_b32_dpp v7, v7, v7, vcc wave_shr:1 row_mask:0xf bank_mask:0xf
    s_mov_b64 exec, s[50:51]
    s_cbranch_scc0 L2_d67
    s_mov_b64 exec, s[82:83]
    s_nop 1
    v_mfma_f32_4x4x4_16b_bf16 v[88:91], v[12:13], v[84:85], 0
    s_nop 1
    v_mfma_f32_4x4x4_16b_bf16 v[88:91], v[10:11], v[86:87], v[88:91]
    s_nop 4
    v_cvt_pk_bf16_f32 v88, v88, v89
    v_cvt_pk_bf16_f32 v89, v90, v91
    ds_pk_add_bf16 v7, v88 offset:65408
    ds_pk_add_bf16 v7, v89 offset:65412
    s_mov_b64 exec, s[50:51]
    s_branch L2_d67
L2_xo68:
    v_cmp_lt_u32 vcc, 20, v99
    s_mov_b32 s101, 1
    s_cbranch_vccz L2_xp68
    v_cmp_lt_u32 vcc, 32, v99
    v_cmp_lt_u32 s[58:59], 31, v88
    s_mov_b32 s101, 2
    s_or_b64 vcc, vcc, s[58:59]
    s_cbranch_scc0 L2_xp68
    s_mov_b32 s37, 0x10000
    s_branch L2_xp68
L2_c69:
    s_lshl_b64 s[52:53], s[82:83], 1
    s_andn2_b64 s[52:53], s[52:53], s[80:81]
    s_andn2_b64 s[52:53], s[52:53], s[54:55]
    s_or_b64 s[80:81], s[80:81], s[52:53]
    s_not_b64 vcc, s[52:53]
    s_mov_b64 exec, -1
    v_cndmask_b32_dpp v84, v84, v84, vcc wave_shr:1 row_mask:0xf bank_mask:0xf
    v_cndmask_b32_dpp v85, v85, v85, vcc wave_shr:1 row_mask:0xf bank_mask:0xf
    s_lshr_b64 s[52:53], s[52:53], 1
    v_cndmask_b32_dpp v86, v86, v86, vcc wave_shr:1 row_mask:0xf bank_mask:0xf
    v_cndmask_b32_dpp v87, v87, v87, vcc wave_shr:1 row_mask:0xf bank_mask:0xf
    s_andn2_b64 s[82:83], s[82:83], s[52:53]
    v_cndmask_b32_dpp v7, v7, v7, vcc wave_shr:1 row_mask:0xf bank_mask:0xf
    s_mov_b64 exec, s[54:55]
    s_cbranch_scc0 L2_d69
    s_mov_b64 exec, s[82:83]
    s_nop 1
    v_mfma_f32_4x4x4_16b_bf16 v[88:91], v[12:13], v[84:85], 0
    s_nop 1
    v_mfma_f32_4x4x4_16b_bf16 v[88:91], v[10:11], v[86:87], v[88:91]
    s_nop 4
    v_cvt_pk_bf16_f32 v88, v88, v89
    v_cvt_pk_bf16_f32 v89, v90, v91
    ds_pk_add_bf16 v7, v88 offset:65408
    ds_pk_add_bf16 v7, v89 offset:65412
    s_mov_b64 exec, s[54:55]
    s_branch L2_d69
L2_c70:
    s_lshl_b64 s[52:53], s[82:83], 1
    s_andn2_b64 s[52:53], s[52:53], s[80:81]
    s_andn2_b64 s[52:53], s[52:53], s[50:51]
    s_or_b64 s[80:81], s[80:81], s[52:53]
    s_not_b64 vcc, s[52:53]
    s_mov_b64 exec, -1
    v_cndmask_b32_dpp v84, v84, v84, vcc wave_shr:1 row_mask:0xf bank_mask:0xf
    v_cndmask_b32_dpp v85, v85, v85, vcc wave_shr:1 row_mask:0xf bank_mask:0xf
    s_lshr_b64 s[52:53], s[52:53], 1
    v_cndmask_b32_dpp v86, v86, v86, vcc wave_shr:1 row_mask:0xf bank_mask:0xf
    v_cndmask_b32_dpp v87, v87, v87, vcc wave_shr:1 row_mask:0xf bank_mask:0xf
    s_andn2_b64 s[82:83], s[82:83], s[52:53]
    v_cndmask_b32_dpp v7, v7, v7, vcc wave_shr:1 row_mask:0xf bank_mask:0xf
    s_mov_b64 exec, s[50:51]
    s_cbranch_scc0 L2_d70
    s_mov_b64 exec, s[82:83]
    s_nop 1
    v_mfma_f32_4x4x4_16b_bf16 v[88:91], v[12:13], v[84:85], 0
    s_nop 1
    v_mfma_f32_4x4x4_16b_bf16 v[88:91], v[10:11], v[86:87], v[88:91]
    s_nop 4
    v_cvt_pk_bf16_f32 v88, v88, v89
    v_cvt_pk_bf16_f32 v89, v90, v91
    ds_pk_add_bf16 v7, v88 offset:65408
    ds_pk_add_bf16 v7, v89 offset:65412
    s_mov_b64 exec, s[50:51]
    s_branch L2_d70
L2_c71:
    s_lshl_b64 s[52:53], s[82:83], 1
    s_andn2_b64 s[52:53], s[52:53], s[80:81]
    s_andn2_b64 s[52:53], s[52:53], s[54:55]
    s_or_b64 s[80:81], s[80:81], s[52:53]
    s_not_b64 vcc, s[52:53]
    s_mov_b64 exec, -1
    v_cndmask_b32_dpp v84, v84, v84, vcc wave_shr:1 row_mask:0xf bank_mask:0xf
    v_cndmask_b32_dpp v85, v85, v85, vcc wave_shr:1 row_mask:0xf bank_mask:0xf
    s_lshr_b64 s[52:53], s[52:53], 1
    v_cndmask_b32_dpp v86, v86, v86, vcc wave_shr:1 row_mask:0xf bank_mask:0xf
    v_cndmask_b32_dpp v87, v87, v87, vcc wave_shr:1 row_mask:0xf bank_mask:0xf
    s_andn2_b64 s[82:83], s[82:83], s[52:53]
    v_cndmask_b32_dpp v7, v7, v7, vcc wave_shr:1 row_mask:0xf bank_mask:0xf
    s_mov_b64 exec, s[54:55]
    s_cbranch_scc0 L2_d71
    s_mov_b64 exec, s[82:83]
    s_nop 1
    v_mfma_f32_4x4x4_16b_bf16 v[88:91], v[12:13], v[84:85], 0
    s_nop 1
    v_mfma_f32_4x4x4_16b_bf16 v[88:91], v[10:11], v[86:87], v[88:91]
    s_nop 4
    v_cvt_pk_bf16_f32 v88, v88, v89
    v_cvt_pk_bf16_f32 v89, v90, v91
    ds_pk_add_bf16 v7, v88 offset:65408
    ds_pk_add_bf16 v7, v89 offset:65412
    s_mov_b64 exec, s[54:55]
    s_branch L2_d71
L2_c72:
    s_lshl_b64 s[52:53], s[82:83], 1
    s_andn2_b64 s[52:53], s[52:53], s[80:81]
    s_andn2_b64 s[52:53], s[52:53], s[50:51]
    s_or_b64 s[80:81], s[80:81], s[52:53]
    s_not_b64 vcc, s[52:53]
    s_mov_b64 exec, -1
    v_cndmask_b32_dpp v84, v84, v84, vcc wave_shr:1 row_mask:0xf bank_mask:0xf
    v_cndmask_b32_dpp v85, v85, v85, vcc wave_shr:1 row_mask:0xf bank_mask:0xf
    s_lshr_b64 s[52:53], s[52:53], 1
    v_cndmask_b32_dpp v86, v86, v86, vcc wave_shr:1 row_mask:0xf bank_mask:0xf
    v_cndmask_b32_dpp v87, v87, v87, vcc wave_shr:1 row_mask:0xf bank_mask:0xf
    s_andn2_b64 s[82:83], s[82:83], s[52:53]
    v_cndmask_b32_dpp v7, v7, v7, vcc wave_shr:1 row_mask:0xf bank_mask:0xf
    s_mov_b64 exec, s[50:51]
    s_cbranch_scc0 L2_d72
    s_mov_b64 exec, s[82:83]
    s_nop 1
    v_mfma_f32_4x4x4_16b_bf16 v[88:91], v[12:13], v[84:85], 0
    s_nop 1
    v_mfma_f32_4x4x4_16b_bf16 v[88:91], v[10:11], v[86:87], v[88:91]
    s_nop 4
    v_cvt_pk_bf16_f32 v88, v88, v89
    v_cvt_pk_bf16_f32 v89, v90, v91
    ds_pk_add_bf16 v7, v88 offset:65408
    ds_pk_add_bf16 v7, v89 offset:65412
    s_mov_b64 exec, s[50:51]
    s_branch L2_d72
L2_c73:
    s_lshl_b64 s[52:53], s[82:83], 1
    s_andn2_b64 s[52:53], s[52:53], s[80:81]
    s_andn2_b64 s[52:53], s[52:53], s[54:55]
    s_or_b64 s[80:81], s[80:81], s[52:53]
    s_not_b64 vcc, s[52:53]
    s_mov_b64 exec, -1
    v_cndmask_b32_dpp v84, v84, v84, vcc wave_shr:1 row_mask:0xf bank_mask:0xf
    v_cndmask_b32_dpp v85, v85, v85, vcc wave_shr:1 row_mask:0xf bank_mask:0xf
    s_lshr_b64 s[52:53], s[52:53], 1
    v_cndmask_b32_dpp v86, v86, v86, vcc wave_shr:1 row_mask:0xf bank_mask:0xf
    v_cndmask_b32_dpp v87, v87, v87, vcc wave_shr:1 row_mask:0xf bank_mask:0xf
    s_andn2_b64 s[82:83], s[82:83], s[52:53]
    v_cndmask_b32_dpp v7, v7, v7, vcc wave_shr:1 row_mask:0xf bank_mask:0xf
    s_mov_b64 exec, s[54:55]
    s_cbranch_scc0 L2_d73
    s_mov_b64 exec, s[82:83]
    s_nop 1
    v_mfma_f32_4x4x4_16b_bf16 v[88:91], v[12:13], v[84:85], 0
    s_nop 1
    v_mfma_f32_4x4x4_16b_bf16 v[88:91], v[10:11], v[86:87], v[88:91]
    s_nop 4
    v_cvt_pk_bf16_f32 v88, v88, v89
    v_cvt_pk_bf16_f32 v89, v90, v91
    ds_pk_add_bf16 v7, v88 offset:65408
    ds_pk_add_bf16 v7, v89 offset:65412
    s_mov_b64 exec, s[54:55]
    s_branch L2_d73
L2_c74:
    s_lshl_b64 s[52:53], s[82:83], 1
    s_andn2_b64 s[52:53], s[52:53], s[80:81]
    s_andn2_b64 s[52:53], s[52:53], s[50:51]
    s_or_b64 s[80:81], s[80:81], s[52:53]
    s_not_b64 vcc, s[52:53]
    s_mov_b64 exec, -1
    v_cndmask_b32_dpp v84, v84, v84, vcc wave_shr:1 row_mask:0xf bank_mask:0xf
    v_cndmask_b32_dpp v85, v85, v85, vcc wave_shr:1 row_mask:0xf bank_mask:0xf
    s_lshr_b64 s[52:53], s[52:53], 1
    v_cndmask_b32_dpp v86, v86, v86, vcc wave_shr:1 row_mask:0xf bank_mask:0xf
    v_cndmask_b32_dpp v87, v87, v87, vcc wave_shr:1 row_mask:0xf bank_mask:0xf
    s_andn2_b64 s[82:83], s[82:83], s[52:53]
    v_cndmask_b32_dpp v7, v7, v7, vcc wave_shr:1 row_mask:0xf bank_mask:0xf
    s_mov_b64 exec, s[50:51]
    s_cbranch_scc0 L2_d74
    s_mov_b64 exec, s[82:83]
    s_nop 1
    v_mfma_f32_4x4x4_16b_bf16 v[88:91], v[12:13], v[84:85], 0
    s_nop 1
    v_mfma_f32_4x4x4_16b_bf16 v[88:91], v[10:11], v[86:87], v[88:91]
    s_nop 4
    v_cvt_pk_bf16_f32 v88, v88, v89
    v_cvt_pk_bf16_f32 v89, v90, v91
    ds_pk_add_bf16 v7, v88 offset:65408
    ds_pk_add_bf16 v7, v89 offset:65412
    s_mov_b64 exec, s[50:51]
    s_branch L2_d74
L2_c75:
    s_lshl_b64 s[52:53], s[82:83], 1
    s_andn2_b64 s[52:53], s[52:53], s[80:81]
    s_andn2_b64 s[52:53], s[52:53], s[54:55]
    s_or_b64 s[80:81], s[80:81], s[52:53]
    s_not_b64 vcc, s[52:53]
    s_mov_b64 exec, -1
    v_cndmask_b32_dpp v84, v84, v84, vcc wave_shr:1 row_mask:0xf bank_mask:0xf
    v_cndmask_b32_dpp v85, v85, v85, vcc wave_shr:1 row_mask:0xf bank_mask:0xf
    s_lshr_b64 s[52:53], s[52:53], 1
    v_cndmask_b32_dpp v86, v86, v86, vcc wave_shr:1 row_mask:0xf bank_mask:0xf
    v_cndmask_b32_dpp v87, v87, v87, vcc wave_shr:1 row_mask:0xf bank_mask:0xf
    s_andn2_b64 s[82:83], s[82:83], s[52:53]
    v_cndmask_b32_dpp v7, v7, v7, vcc wave_shr:1 row_mask:0xf bank_mask:0xf
    s_mov_b64 exec, s[54:55]
    s_cbranch_scc0 L2_d75
    s_mov_b64 exec, s[82:83]
    s_nop 1
    v_mfma_f32_4x4x4_16b_bf16 v[88:91], v[12:13], v[84:85], 0
    s_nop 1
    v_mfma_f32_4x4x4_16b_bf16 v[88:91], v[10:11], v[86:87], v[88:91]
    s_nop 4
    v_cvt_pk_bf16_f32 v88, v88, v89
    v_cvt_pk_bf16_f32 v89, v90, v91
    ds_pk_add_bf16 v7, v88 offset:65408
    ds_pk_add_bf16 v7, v89 offset:65412
    s_mov_b64 exec, s[54:55]
    s_branch L2_d75
L2_c76:
    s_lshl_b64 s[52:53], s[82:83], 1
    s_andn2_b64 s[52:53], s[52:53], s[80:81]
    s_andn2_b64 s[52:53], s[52:53], s[50:51]
    s_or_b64 s[80:81], s[80:81], s[52:53]
    s_not_b64 vcc, s[52:53]
    s_mov_b64 exec, -1
    v_cndmask_b32_dpp v84, v84, v84, vcc wave_shr:1 row_mask:0xf bank_mask:0xf
    v_cndmask_b32_dpp v85, v85, v85, vcc wave_shr:1 row_mask:0xf bank_mask:0xf
    s_lshr_b64 s[52:53], s[52:53], 1
    v_cndmask_b32_dpp v86, v86, v86, vcc wave_shr:1 row_mask:0xf bank_mask:0xf
    v_cndmask_b32_dpp v87, v87, v87, vcc wave_shr:1 row_mask:0xf bank_mask:0xf
    s_andn2_b64 s[82:83], s[82:83], s[52:53]
    v_cndmask_b32_dpp v7, v7, v7, vcc wave_shr:1 row_mask:0xf bank_mask:0xf
    s_mov_b64 exec, s[50:51]
    s_cbranch_scc0 L2_d76
    s_mov_b64 exec, s[82:83]
    s_nop 1
    v_mfma_f32_4x4x4_16b_bf16 v[88:91], v[12:13], v[84:85], 0
    s_nop 1
    v_mfma_f32_4x4x4_16b_bf16 v[88:91], v[10:11], v[86:87], v[88:91]
    s_nop 4
    v_cvt_pk_bf16_f32 v88, v88, v89
    v_cvt_pk_bf16_f32 v89, v90, v91
    ds_pk_add_bf16 v7, v88 offset:65408
    ds_pk_add_bf16 v7, v89 offset:65412
    s_mov_b64 exec, s[50:51]
    s_branch L2_d76
L2_c77:
    s_lshl_b64 s[52:53], s[82:83], 1
    s_andn2_b64 s[52:53], s[52:53], s[80:81]
    s_andn2_b64 s[52:53], s[52:53], s[54:55]
    s_or_b64 s[80:81], s[80:81], s[52:53]
    s_not_b64 vcc, s[52:53]
    s_mov_b64 exec, -1
    v_cndmask_b32_dpp v84, v84, v84, vcc wave_shr:1 row_mask:0xf bank_mask:0xf
    v_cndmask_b32_dpp v85, v85, v85, vcc wave_shr:1 row_mask:0xf bank_mask:0xf
    s_lshr_b64 s[52:53], s[52:53], 1
    v_cndmask_b32_dpp v86, v86, v86, vcc wave_shr:1 row_mask:0xf bank_mask:0xf
    v_cndmask_b32_dpp v87, v87, v87, vcc wave_shr:1 row_mask:0xf bank_mask:0xf
    s_andn2_b64 s[82:83], s[82:83], s[52:53]
    v_cndmask_b32_dpp v7, v7, v7, vcc wave_shr:1 row_mask:0xf bank_mask:0xf
    s_mov_b64 exec, s[54:55]
    s_cbranch_scc0 L2_d77
    s_mov_b64 exec, s[82:83]
    s_nop 1
    v_mfma_f32_4x4x4_16b_bf16 v[88:91], v[12:13], v[84:85], 0
    s_nop 1
    v_mfma_f32_4x4x4_16b_bf16 v[88:91], v[10:11], v[86:87], v[88:91]
    s_nop 4
    v_cvt_pk_bf16_f32 v88, v88, v89
    v_cvt_pk_bf16_f32 v89, v90, v91
    ds_pk_add_bf16 v7, v88 offset:65408
    ds_pk_add_bf16 v7, v89 offset:65412
    s_mov_b64 exec, s[54:55]
    s_branch L2_d77
L2_c78:
    s_lshl_b64 s[52:53], s[82:83], 1
    s_andn2_b64 s[52:53], s[52:53], s[80:81]
    s_andn2_b64 s[52:53], s[52:53], s[50:51]
    s_or_b64 s[80:81], s[80:81], s[52:53]
    s_not_b64 vcc, s[52:53]
    s_mov_b64 exec, -1
    v_cndmask_b32_dpp v84, v84, v84, vcc wave_shr:1 row_mask:0xf bank_mask:0xf
    v_cndmask_b32_dpp v85, v85, v85, vcc wave_shr:1 row_mask:0xf bank_mask:0xf
    s_lshr_b64 s[52:53], s[52:53], 1
    v_cndmask_b32_dpp v86, v86, v86, vcc wave_shr:1 row_mask:0xf bank_mask:0xf
    v_cndmask_b32_dpp v87, v87, v87, vcc wave_shr:1 row_mask:0xf bank_mask:0xf
    s_andn2_b64 s[82:83], s[82:83], s[52:53]
    v_cndmask_b32_dpp v7, v7, v7, vcc wave_shr:1 row_mask:0xf bank_mask:0xf
    s_mov_b64 exec, s[50:51]
    s_cbranch_scc0 L2_d78
    s_mov_b64 exec, s[82:83]
    s_nop 1
    v_mfma_f32_4x4x4_16b_bf16 v[88:91], v[12:13], v[84:85], 0
    s_nop 1
    v_mfma_f32_4x4x4_16b_bf16 v[88:91], v[10:11], v[86:87], v[88:91]
    s_nop 4
    v_cvt_pk_bf16_f32 v88, v88, v89
    v_cvt_pk_bf16_f32 v89, v90, v91
    ds_pk_add_bf16 v7, v88 offset:65408
    ds_pk_add_bf16 v7, v89 offset:65412
    s_mov_b64 exec, s[50:51]
    s_branch L2_d78
L2_xa79:
    s_cmp_eq_u32 s101, 1
    s_cbranch_scc1 L2_xc79
    v_lshlrev_b32 v89, 0, v96
    v_add_u32 v90, 140, v97
    v_bitop3_b32 v90, v89, v45, v90 bitop3:0x6a
    ds_write_b32 v98, v90 offset:28
    v_lshlrev_b32 v89, 4, v96
    v_add_u32 v90, 120, v97
    v_bitop3_b32 v90, v89, v45, v90 bitop3:0x6a
    ds_write_b32 v98, v90 offset:24
    v_lshlrev_b32 v89, 8, v96
    v_add_u32 v90, 100, v97
    v_bitop3_b32 v90, v89, v45, v90 bitop3:0x6a
    ds_write_b32 v98, v90 offset:20
L2_xc79:
    v_lshlrev_b32 v89, 12, v96
    v_add_u32 v90, 80, v97
    v_bitop3_b32 v90, v89, v45, v90 bitop3:0x6a
    ds_write_b32 v98, v90 offset:16
    s_branch L2_xb79
L2_xe79:
    v_cmp_lt_u32 vcc, 32, v99
    v_cmp_lt_u32 s[58:59], 31, v88
    v_lshrrev_b32 v89, 16, v96
    v_add_u32 v97, 80, v97
    s_or_b64 vcc, vcc, s[58:59]
    s_cbranch_scc1 L2_xs79
    v_lshlrev_b32 v89, v1, v89
    v_and_b32 v89, v45, v89
    v_cmp_ne_u32 vcc, 0, v89
    v_xor_b32 v90, v97, v89
    s_add_u32 s3, s37, s38
    v_mbcnt_lo_u32_b32 v98, vcc_lo, 0
    v_mbcnt_hi_u32_b32 v98, vcc_hi, v98
    s_bcnt1_i32_b64 s41, vcc
    v_lshl_add_u32 v98, v98, 2, s3
    s_mov_b64 exec, vcc
    ds_write_b32 v98, v90
    s_mov_b64 exec, -1
    s_lshl2_add_u32 s37, s41, s37
    s_branch L2_xr79
L2_xf79:
    s_waitcnt lgkmcnt(0)
    s_cmp_gt_u32 s37, 1024
    s_cbranch_scc1 L2_xs79
    v_mov_b32 v43, -1
    s_cmp_ge_u32 s37, 512
    s_cbranch_scc1 L2_xg79
    v_mov_b32 v42, -1
    s_cmp_ge_u32 s37, 256
    s_cbranch_scc1 L2_xg79
    v_mov_b32 v41, -1
    s_branch L2_xg79
L2_xs79:
    s_waitcnt lgkmcnt(0)
    v_mov_b32 v40, -1
    v_mov_b32 v41, -1
    v_mov_b32 v42, -1
    v_mov_b32 v43, -1
    s_add_u32 s3, s42, 2
    s_bitset1_b32 s36, s3
    s_branch L2_xg79
L2_c80:
    s_lshl_b64 s[52:53], s[82:83], 1
    s_andn2_b64 s[52:53], s[52:53], s[80:81]
    s_andn2_b64 s[52:53], s[52:53], s[54:55]
    s_or_b64 s[80:81], s[80:81], s[52:53]
    s_not_b64 vcc, s[52:53]
    s_mov_b64 exec, -1
    v_cndmask_b32_dpp v84, v84, v84, vcc wave_shr:1 row_mask:0xf bank_mask:0xf
    v_cndmask_b32_dpp v85, v85, v85, vcc wave_shr:1 row_mask:0xf bank_mask:0xf
    s_lshr_b64 s[52:53], s[52:53], 1
    v_cndmask_b32_dpp v86, v86, v86, vcc wave_shr:1 row_mask:0xf bank_mask:0xf
    v_cndmask_b32_dpp v87, v87, v87, vcc wave_shr:1 row_mask:0xf bank_mask:0xf
    s_andn2_b64 s[82:83], s[82:83], s[52:53]
    v_cndmask_b32_dpp v7, v7, v7, vcc wave_shr:1 row_mask:0xf bank_mask:0xf
    s_mov_b64 exec, s[54:55]
    s_cbranch_scc0 L2_d80
    s_mov_b64 exec, s[82:83]
    s_nop 1
    v_mfma_f32_4x4x4_16b_bf16 v[88:91], v[12:13], v[84:85], 0
    s_nop 1
    v_mfma_f32_4x4x4_16b_bf16 v[88:91], v[10:11], v[86:87], v[88:91]
    s_nop 4
    v_cvt_pk_bf16_f32 v88, v88, v89
    v_cvt_pk_bf16_f32 v89, v90, v91
    ds_pk_add_bf16 v7, v88 offset:65408
    ds_pk_add_bf16 v7, v89 offset:65412
    s_mov_b64 exec, s[54:55]
    s_branch L2_d80
L2_c81:
    s_lshl_b64 s[52:53], s[82:83], 1
    s_andn2_b64 s[52:53], s[52:53], s[80:81]
    s_andn2_b64 s[52:53], s[52:53], s[50:51]
    s_or_b64 s[80:81], s[80:81], s[52:53]
    s_not_b64 vcc, s[52:53]
    s_mov_b64 exec, -1
    v_cndmask_b32_dpp v84, v84, v84, vcc wave_shr:1 row_mask:0xf bank_mask:0xf
    v_cndmask_b32_dpp v85, v85, v85, vcc wave_shr:1 row_mask:0xf bank_mask:0xf
    s_lshr_b64 s[52:53], s[52:53], 1
    v_cndmask_b32_dpp v86, v86, v86, vcc wave_shr:1 row_mask:0xf bank_mask:0xf
    v_cndmask_b32_dpp v87, v87, v87, vcc wave_shr:1 row_mask:0xf bank_mask:0xf
    s_andn2_b64 s[82:83], s[82:83], s[52:53]
    v_cndmask_b32_dpp v7, v7, v7, vcc wave_shr:1 row_mask:0xf bank_mask:0xf
    s_mov_b64 exec, s[50:51]
    s_cbranch_scc0 L2_d81
    s_mov_b64 exec, s[82:83]
    s_nop 1
    v_mfma_f32_4x4x4_16b_bf16 v[88:91], v[12:13], v[84:85], 0
    s_nop 1
    v_mfma_f32_4x4x4_16b_bf16 v[88:91], v[10:11], v[86:87], v[88:91]
    s_nop 4
    v_cvt_pk_bf16_f32 v88, v88, v89
    v_cvt_pk_bf16_f32 v89, v90, v91
    ds_pk_add_bf16 v7, v88 offset:65408
    ds_pk_add_bf16 v7, v89 offset:65412
    s_mov_b64 exec, s[50:51]
    s_branch L2_d81
L2_c82:
    s_lshl_b64 s[52:53], s[82:83], 1
    s_andn2_b64 s[52:53], s[52:53], s[80:81]
    s_andn2_b64 s[52:53], s[52:53], s[54:55]
    s_or_b64 s[80:81], s[80:81], s[52:53]
    s_not_b64 vcc, s[52:53]
    s_mov_b64 exec, -1
    v_cndmask_b32_dpp v84, v84, v84, vcc wave_shr:1 row_mask:0xf bank_mask:0xf
    v_cndmask_b32_dpp v85, v85, v85, vcc wave_shr:1 row_mask:0xf bank_mask:0xf
    s_lshr_b64 s[52:53], s[52:53], 1
    v_cndmask_b32_dpp v86, v86, v86, vcc wave_shr:1 row_mask:0xf bank_mask:0xf
    v_cndmask_b32_dpp v87, v87, v87, vcc wave_shr:1 row_mask:0xf bank_mask:0xf
    s_andn2_b64 s[82:83], s[82:83], s[52:53]
    v_cndmask_b32_dpp v7, v7, v7, vcc wave_shr:1 row_mask:0xf bank_mask:0xf
    s_mov_b64 exec, s[54:55]
    s_cbranch_scc0 L2_d82
    s_mov_b64 exec, s[82:83]
    s_nop 1
    v_mfma_f32_4x4x4_16b_bf16 v[88:91], v[12:13], v[84:85], 0
    s_nop 1
    v_mfma_f32_4x4x4_16b_bf16 v[88:91], v[10:11], v[86:87], v[88:91]
    s_nop 4
    v_cvt_pk_bf16_f32 v88, v88, v89
    v_cvt_pk_bf16_f32 v89, v90, v91
    ds_pk_add_bf16 v7, v88 offset:65408
    ds_pk_add_bf16 v7, v89 offset:65412
    s_mov_b64 exec, s[54:55]
    s_branch L2_d82
L2_c83:
    s_lshl_b64 s[52:53], s[82:83], 1
    s_andn2_b64 s[52:53], s[52:53], s[80:81]
    s_andn2_b64 s[52:53], s[52:53], s[50:51]
    s_or_b64 s[80:81], s[80:81], s[52:53]
    s_not_b64 vcc, s[52:53]
    s_mov_b64 exec, -1
    v_cndmask_b32_dpp v84, v84, v84, vcc wave_shr:1 row_mask:0xf bank_mask:0xf
    v_cndmask_b32_dpp v85, v85, v85, vcc wave_shr:1 row_mask:0xf bank_mask:0xf
    s_lshr_b64 s[52:53], s[52:53], 1
    v_cndmask_b32_dpp v86, v86, v86, vcc wave_shr:1 row_mask:0xf bank_mask:0xf
    v_cndmask_b32_dpp v87, v87, v87, vcc wave_shr:1 row_mask:0xf bank_mask:0xf
    s_andn2_b64 s[82:83], s[82:83], s[52:53]
    v_cndmask_b32_dpp v7, v7, v7, vcc wave_shr:1 row_mask:0xf bank_mask:0xf
    s_mov_b64 exec, s[50:51]
    s_cbranch_scc0 L2_d83
    s_mov_b64 exec, s[82:83]
    s_nop 1
    v_mfma_f32_4x4x4_16b_bf16 v[88:91], v[12:13], v[84:85], 0
    s_nop 1
    v_mfma_f32_4x4x4_16b_bf16 v[88:91], v[10:11], v[86:87], v[88:91]
    s_nop 4
    v_cvt_pk_bf16_f32 v88, v88, v89
    v_cvt_pk_bf16_f32 v89, v90, v91
    ds_pk_add_bf16 v7, v88 offset:65408
    ds_pk_add_bf16 v7, v89 offset:65412
    s_mov_b64 exec, s[50:51]
    s_branch L2_d83
L2_c84:
    s_lshl_b64 s[52:53], s[82:83], 1
    s_andn2_b64 s[52:53], s[52:53], s[80:81]
    s_andn2_b64 s[52:53], s[52:53], s[54:55]
    s_or_b64 s[80:81], s[80:81], s[52:53]
    s_not_b64 vcc, s[52:53]
    s_mov_b64 exec, -1
    v_cndmask_b32_dpp v84, v84, v84, vcc wave_shr:1 row_mask:0xf bank_mask:0xf
    v_cndmask_b32_dpp v85, v85, v85, vcc wave_shr:1 row_mask:0xf bank_mask:0xf
    s_lshr_b64 s[52:53], s[52:53], 1
    v_cndmask_b32_dpp v86, v86, v86, vcc wave_shr:1 row_mask:0xf bank_mask:0xf
    v_cndmask_b32_dpp v87, v87, v87, vcc wave_shr:1 row_mask:0xf bank_mask:0xf
    s_andn2_b64 s[82:83], s[82:83], s[52:53]
    v_cndmask_b32_dpp v7, v7, v7, vcc wave_shr:1 row_mask:0xf bank_mask:0xf
    s_mov_b64 exec, s[54:55]
    s_cbranch_scc0 L2_d84
    s_mov_b64 exec, s[82:83]
    s_nop 1
    v_mfma_f32_4x4x4_16b_bf16 v[88:91], v[12:13], v[84:85], 0
    s_nop 1
    v_mfma_f32_4x4x4_16b_bf16 v[88:91], v[10:11], v[86:87], v[88:91]
    s_nop 4
    v_cvt_pk_bf16_f32 v88, v88, v89
    v_cvt_pk_bf16_f32 v89, v90, v91
    ds_pk_add_bf16 v7, v88 offset:65408
    ds_pk_add_bf16 v7, v89 offset:65412
    s_mov_b64 exec, s[54:55]
    s_branch L2_d84
L2_c85:
    s_lshl_b64 s[52:53], s[82:83], 1
    s_andn2_b64 s[52:53], s[52:53], s[80:81]
    s_andn2_b64 s[52:53], s[52:53], s[50:51]
    s_or_b64 s[80:81], s[80:81], s[52:53]
    s_not_b64 vcc, s[52:53]
    s_mov_b64 exec, -1
    v_cndmask_b32_dpp v84, v84, v84, vcc wave_shr:1 row_mask:0xf bank_mask:0xf
    v_cndmask_b32_dpp v85, v85, v85, vcc wave_shr:1 row_mask:0xf bank_mask:0xf
    s_lshr_b64 s[52:53], s[52:53], 1
    v_cndmask_b32_dpp v86, v86, v86, vcc wave_shr:1 row_mask:0xf bank_mask:0xf
    v_cndmask_b32_dpp v87, v87, v87, vcc wave_shr:1 row_mask:0xf bank_mask:0xf
    s_andn2_b64 s[82:83], s[82:83], s[52:53]
    v_cndmask_b32_dpp v7, v7, v7, vcc wave_shr:1 row_mask:0xf bank_mask:0xf
    s_mov_b64 exec, s[50:51]
    s_cbranch_scc0 L2_d85
    s_mov_b64 exec, s[82:83]
    s_nop 1
    v_mfma_f32_4x4x4_16b_bf16 v[88:91], v[12:13], v[84:85], 0
    s_nop 1
    v_mfma_f32_4x4x4_16b_bf16 v[88:91], v[10:11], v[86:87], v[88:91]
    s_nop 4
    v_cvt_pk_bf16_f32 v88, v88, v89
    v_cvt_pk_bf16_f32 v89, v90, v91
    ds_pk_add_bf16 v7, v88 offset:65408
    ds_pk_add_bf16 v7, v89 offset:65412
    s_mov_b64 exec, s[50:51]
    s_branch L2_d85
L2_xo86:
    v_cmp_lt_u32 vcc, 20, v99
    s_mov_b32 s101, 1
    s_cbranch_vccz L2_xp86
    v_cmp_lt_u32 vcc, 32, v99
    v_cmp_lt_u32 s[58:59], 31, v88
    s_mov_b32 s101, 2
    s_or_b64 vcc, vcc, s[58:59]
    s_cbranch_scc0 L2_xp86
    s_mov_b32 s37, 0x10000
    s_branch L2_xp86
L2_c87:
    s_lshl_b64 s[52:53], s[82:83], 1
    s_andn2_b64 s[52:53], s[52:53], s[80:81]
    s_andn2_b64 s[52:53], s[52:53], s[54:55]
    s_or_b64 s[80:81], s[80:81], s[52:53]
    s_not_b64 vcc, s[52:53]
    s_mov_b64 exec, -1
    v_cndmask_b32_dpp v84, v84, v84, vcc wave_shr:1 row_mask:0xf bank_mask:0xf
    v_cndmask_b32_dpp v85, v85, v85, vcc wave_shr:1 row_mask:0xf bank_mask:0xf
    s_lshr_b64 s[52:53], s[52:53], 1
    v_cndmask_b32_dpp v86, v86, v86, vcc wave_shr:1 row_mask:0xf bank_mask:0xf
    v_cndmask_b32_dpp v87, v87, v87, vcc wave_shr:1 row_mask:0xf bank_mask:0xf
    s_andn2_b64 s[82:83], s[82:83], s[52:53]
    v_cndmask_b32_dpp v7, v7, v7, vcc wave_shr:1 row_mask:0xf bank_mask:0xf
    s_mov_b64 exec, s[54:55]
    s_cbranch_scc0 L2_d87
    s_mov_b64 exec, s[82:83]
    s_nop 1
    v_mfma_f32_4x4x4_16b_bf16 v[88:91], v[12:13], v[84:85], 0
    s_nop 1
    v_mfma_f32_4x4x4_16b_bf16 v[88:91], v[10:11], v[86:87], v[88:91]
    s_nop 4
    v_cvt_pk_bf16_f32 v88, v88, v89
    v_cvt_pk_bf16_f32 v89, v90, v91
    ds_pk_add_bf16 v7, v88 offset:65408
    ds_pk_add_bf16 v7, v89 offset:65412
    s_mov_b64 exec, s[54:55]
    s_branch L2_d87
L2_c88:
    s_lshl_b64 s[52:53], s[82:83], 1
    s_andn2_b64 s[52:53], s[52:53], s[80:81]
    s_andn2_b64 s[52:53], s[52:53], s[50:51]
    s_or_b64 s[80:81], s[80:81], s[52:53]
    s_not_b64 vcc, s[52:53]
    s_mov_b64 exec, -1
    v_cndmask_b32_dpp v84, v84, v84, vcc wave_shr:1 row_mask:0xf bank_mask:0xf
    v_cndmask_b32_dpp v85, v85, v85, vcc wave_shr:1 row_mask:0xf bank_mask:0xf
    s_lshr_b64 s[52:53], s[52:53], 1
    v_cndmask_b32_dpp v86, v86, v86, vcc wave_shr:1 row_mask:0xf bank_mask:0xf
    v_cndmask_b32_dpp v87, v87, v87, vcc wave_shr:1 row_mask:0xf bank_mask:0xf
    s_andn2_b64 s[82:83], s[82:83], s[52:53]
    v_cndmask_b32_dpp v7, v7, v7, vcc wave_shr:1 row_mask:0xf bank_mask:0xf
    s_mov_b64 exec, s[50:51]
    s_cbranch_scc0 L2_d88
    s_mov_b64 exec, s[82:83]
    s_nop 1
    v_mfma_f32_4x4x4_16b_bf16 v[88:91], v[12:13], v[84:85], 0
    s_nop 1
    v_mfma_f32_4x4x4_16b_bf16 v[88:91], v[10:11], v[86:87], v[88:91]
    s_nop 4
    v_cvt_pk_bf16_f32 v88, v88, v89
    v_cvt_pk_bf16_f32 v89, v90, v91
    ds_pk_add_bf16 v7, v88 offset:65408
    ds_pk_add_bf16 v7, v89 offset:65412
    s_mov_b64 exec, s[50:51]
    s_branch L2_d88
L2_c89:
    s_lshl_b64 s[52:53], s[82:83], 1
    s_andn2_b64 s[52:53], s[52:53], s[80:81]
    s_andn2_b64 s[52:53], s[52:53], s[54:55]
    s_or_b64 s[80:81], s[80:81], s[52:53]
    s_not_b64 vcc, s[52:53]
    s_mov_b64 exec, -1
    v_cndmask_b32_dpp v84, v84, v84, vcc wave_shr:1 row_mask:0xf bank_mask:0xf
    v_cndmask_b32_dpp v85, v85, v85, vcc wave_shr:1 row_mask:0xf bank_mask:0xf
    s_lshr_b64 s[52:53], s[52:53], 1
    v_cndmask_b32_dpp v86, v86, v86, vcc wave_shr:1 row_mask:0xf bank_mask:0xf
    v_cndmask_b32_dpp v87, v87, v87, vcc wave_shr:1 row_mask:0xf bank_mask:0xf
    s_andn2_b64 s[82:83], s[82:83], s[52:53]
    v_cndmask_b32_dpp v7, v7, v7, vcc wave_shr:1 row_mask:0xf bank_mask:0xf
    s_mov_b64 exec, s[54:55]
    s_cbranch_scc0 L2_d89
    s_mov_b64 exec, s[82:83]
    s_nop 1
    v_mfma_f32_4x4x4_16b_bf16 v[88:91], v[12:13], v[84:85], 0
    s_nop 1
    v_mfma_f32_4x4x4_16b_bf16 v[88:91], v[10:11], v[86:87], v[88:91]
    s_nop 4
    v_cvt_pk_bf16_f32 v88, v88, v89
    v_cvt_pk_bf16_f32 v89, v90, v91
    ds_pk_add_bf16 v7, v88 offset:65408
    ds_pk_add_bf16 v7, v89 offset:65412
    s_mov_b64 exec, s[54:55]
    s_branch L2_d89
L2_c90:
    s_lshl_b64 s[52:53], s[82:83], 1
    s_andn2_b64 s[52:53], s[52:53], s[80:81]
    s_andn2_b64 s[52:53], s[52:53], s[50:51]
    s_or_b64 s[80:81], s[80:81], s[52:53]
    s_not_b64 vcc, s[52:53]
    s_mov_b64 exec, -1
    v_cndmask_b32_dpp v84, v84, v84, vcc wave_shr:1 row_mask:0xf bank_mask:0xf
    v_cndmask_b32_dpp v85, v85, v85, vcc wave_shr:1 row_mask:0xf bank_mask:0xf
    s_lshr_b64 s[52:53], s[52:53], 1
    v_cndmask_b32_dpp v86, v86, v86, vcc wave_shr:1 row_mask:0xf bank_mask:0xf
    v_cndmask_b32_dpp v87, v87, v87, vcc wave_shr:1 row_mask:0xf bank_mask:0xf
    s_andn2_b64 s[82:83], s[82:83], s[52:53]
    v_cndmask_b32_dpp v7, v7, v7, vcc wave_shr:1 row_mask:0xf bank_mask:0xf
    s_mov_b64 exec, s[50:51]
    s_cbranch_scc0 L2_d90
    s_mov_b64 exec, s[82:83]
    s_nop 1
    v_mfma_f32_4x4x4_16b_bf16 v[88:91], v[12:13], v[84:85], 0
    s_nop 1
    v_mfma_f32_4x4x4_16b_bf16 v[88:91], v[10:11], v[86:87], v[88:91]
    s_nop 4
    v_cvt_pk_bf16_f32 v88, v88, v89
    v_cvt_pk_bf16_f32 v89, v90, v91
    ds_pk_add_bf16 v7, v88 offset:65408
    ds_pk_add_bf16 v7, v89 offset:65412
    s_mov_b64 exec, s[50:51]
    s_branch L2_d90
L2_c91:
    s_lshl_b64 s[52:53], s[82:83], 1
    s_andn2_b64 s[52:53], s[52:53], s[80:81]
    s_andn2_b64 s[52:53], s[52:53], s[54:55]
    s_or_b64 s[80:81], s[80:81], s[52:53]
    s_not_b64 vcc, s[52:53]
    s_mov_b64 exec, -1
    v_cndmask_b32_dpp v84, v84, v84, vcc wave_shr:1 row_mask:0xf bank_mask:0xf
    v_cndmask_b32_dpp v85, v85, v85, vcc wave_shr:1 row_mask:0xf bank_mask:0xf
    s_lshr_b64 s[52:53], s[52:53], 1
    v_cndmask_b32_dpp v86, v86, v86, vcc wave_shr:1 row_mask:0xf bank_mask:0xf
    v_cndmask_b32_dpp v87, v87, v87, vcc wave_shr:1 row_mask:0xf bank_mask:0xf
    s_andn2_b64 s[82:83], s[82:83], s[52:53]
    v_cndmask_b32_dpp v7, v7, v7, vcc wave_shr:1 row_mask:0xf bank_mask:0xf
    s_mov_b64 exec, s[54:55]
    s_cbranch_scc0 L2_d91
    s_mov_b64 exec, s[82:83]
    s_nop 1
    v_mfma_f32_4x4x4_16b_bf16 v[88:91], v[12:13], v[84:85], 0
    s_nop 1
    v_mfma_f32_4x4x4_16b_bf16 v[88:91], v[10:11], v[86:87], v[88:91]
    s_nop 4
    v_cvt_pk_bf16_f32 v88, v88, v89
    v_cvt_pk_bf16_f32 v89, v90, v91
    ds_pk_add_bf16 v7, v88 offset:65408
    ds_pk_add_bf16 v7, v89 offset:65412
    s_mov_b64 exec, s[54:55]
    s_branch L2_d91
L2_c92:
    s_lshl_b64 s[52:53], s[82:83], 1
    s_andn2_b64 s[52:53], s[52:53], s[80:81]
    s_andn2_b64 s[52:53], s[52:53], s[50:51]
    s_or_b64 s[80:81], s[80:81], s[52:53]
    s_not_b64 vcc, s[52:53]
    s_mov_b64 exec, -1
    v_cndmask_b32_dpp v84, v84, v84, vcc wave_shr:1 row_mask:0xf bank_mask:0xf
    v_cndmask_b32_dpp v85, v85, v85, vcc wave_shr:1 row_mask:0xf bank_mask:0xf
    s_lshr_b64 s[52:53], s[52:53], 1
    v_cndmask_b32_dpp v86, v86, v86, vcc wave_shr:1 row_mask:0xf bank_mask:0xf
    v_cndmask_b32_dpp v87, v87, v87, vcc wave_shr:1 row_mask:0xf bank_mask:0xf
    s_andn2_b64 s[82:83], s[82:83], s[52:53]
    v_cndmask_b32_dpp v7, v7, v7, vcc wave_shr:1 row_mask:0xf bank_mask:0xf
    s_mov_b64 exec, s[50:51]
    s_cbranch_scc0 L2_d92
    s_mov_b64 exec, s[82:83]
    s_nop 1
    v_mfma_f32_4x4x4_16b_bf16 v[88:91], v[12:13], v[84:85], 0
    s_nop 1
    v_mfma_f32_4x4x4_16b_bf16 v[88:91], v[10:11], v[86:87], v[88:91]
    s_nop 4
    v_cvt_pk_bf16_f32 v88, v88, v89
    v_cvt_pk_bf16_f32 v89, v90, v91
    ds_pk_add_bf16 v7, v88 offset:65408
    ds_pk_add_bf16 v7, v89 offset:65412
    s_mov_b64 exec, s[50:51]
    s_branch L2_d92
L2_c93:
    s_lshl_b64 s[52:53], s[82:83], 1
    s_andn2_b64 s[52:53], s[52:53], s[80:81]
    s_andn2_b64 s[52:53], s[52:53], s[54:55]
    s_or_b64 s[80:81], s[80:81], s[52:53]
    s_not_b64 vcc, s[52:53]
    s_mov_b64 exec, -1
    v_cndmask_b32_dpp v84, v84, v84, vcc wave_shr:1 row_mask:0xf bank_mask:0xf
    v_cndmask_b32_dpp v85, v85, v85, vcc wave_shr:1 row_mask:0xf bank_mask:0xf
    s_lshr_b64 s[52:53], s[52:53], 1
    v_cndmask_b32_dpp v86, v86, v86, vcc wave_shr:1 row_mask:0xf bank_mask:0xf
    v_cndmask_b32_dpp v87, v87, v87, vcc wave_shr:1 row_mask:0xf bank_mask:0xf
    s_andn2_b64 s[82:83], s[82:83], s[52:53]
    v_cndmask_b32_dpp v7, v7, v7, vcc wave_shr:1 row_mask:0xf bank_mask:0xf
    s_mov_b64 exec, s[54:55]
    s_cbranch_scc0 L2_d93
    s_mov_b64 exec, s[82:83]
    s_nop 1
    v_mfma_f32_4x4x4_16b_bf16 v[88:91], v[12:13], v[84:85], 0
    s_nop 1
    v_mfma_f32_4x4x4_16b_bf16 v[88:91], v[10:11], v[86:87], v[88:91]
    s_nop 4
    v_cvt_pk_bf16_f32 v88, v88, v89
    v_cvt_pk_bf16_f32 v89, v90, v91
    ds_pk_add_bf16 v7, v88 offset:65408
    ds_pk_add_bf16 v7, v89 offset:65412
    s_mov_b64 exec, s[54:55]
    s_branch L2_d93
L2_c94:
    s_lshl_b64 s[52:53], s[82:83], 1
    s_andn2_b64 s[52:53], s[52:53], s[80:81]
    s_andn2_b64 s[52:53], s[52:53], s[50:51]
    s_or_b64 s[80:81], s[80:81], s[52:53]
    s_not_b64 vcc, s[52:53]
    s_mov_b64 exec, -1
    v_cndmask_b32_dpp v84, v84, v84, vcc wave_shr:1 row_mask:0xf bank_mask:0xf
    v_cndmask_b32_dpp v85, v85, v85, vcc wave_shr:1 row_mask:0xf bank_mask:0xf
    s_lshr_b64 s[52:53], s[52:53], 1
    v_cndmask_b32_dpp v86, v86, v86, vcc wave_shr:1 row_mask:0xf bank_mask:0xf
    v_cndmask_b32_dpp v87, v87, v87, vcc wave_shr:1 row_mask:0xf bank_mask:0xf
    s_andn2_b64 s[82:83], s[82:83], s[52:53]
    v_cndmask_b32_dpp v7, v7, v7, vcc wave_shr:1 row_mask:0xf bank_mask:0xf
    s_mov_b64 exec, s[50:51]
    s_cbranch_scc0 L2_d94
    s_mov_b64 exec, s[82:83]
    s_nop 1
    v_mfma_f32_4x4x4_16b_bf16 v[88:91], v[12:13], v[84:85], 0
    s_nop 1
    v_mfma_f32_4x4x4_16b_bf16 v[88:91], v[10:11], v[86:87], v[88:91]
    s_nop 4
    v_cvt_pk_bf16_f32 v88, v88, v89
    v_cvt_pk_bf16_f32 v89, v90, v91
    ds_pk_add_bf16 v7, v88 offset:65408
    ds_pk_add_bf16 v7, v89 offset:65412
    s_mov_b64 exec, s[50:51]
    s_branch L2_d94
L2_c95:
    s_lshl_b64 s[52:53], s[82:83], 1
    s_andn2_b64 s[52:53], s[52:53], s[80:81]
    s_andn2_b64 s[52:53], s[52:53], s[54:55]
    s_or_b64 s[80:81], s[80:81], s[52:53]
    s_not_b64 vcc, s[52:53]
    s_mov_b64 exec, -1
    v_cndmask_b32_dpp v84, v84, v84, vcc wave_shr:1 row_mask:0xf bank_mask:0xf
    v_cndmask_b32_dpp v85, v85, v85, vcc wave_shr:1 row_mask:0xf bank_mask:0xf
    s_lshr_b64 s[52:53], s[52:53], 1
    v_cndmask_b32_dpp v86, v86, v86, vcc wave_shr:1 row_mask:0xf bank_mask:0xf
    v_cndmask_b32_dpp v87, v87, v87, vcc wave_shr:1 row_mask:0xf bank_mask:0xf
    s_andn2_b64 s[82:83], s[82:83], s[52:53]
    v_cndmask_b32_dpp v7, v7, v7, vcc wave_shr:1 row_mask:0xf bank_mask:0xf
    s_mov_b64 exec, s[54:55]
    s_cbranch_scc0 L2_d95
    s_mov_b64 exec, s[82:83]
    s_nop 1
    v_mfma_f32_4x4x4_16b_bf16 v[88:91], v[12:13], v[84:85], 0
    s_nop 1
    v_mfma_f32_4x4x4_16b_bf16 v[88:91], v[10:11], v[86:87], v[88:91]
    s_nop 4
    v_cvt_pk_bf16_f32 v88, v88, v89
    v_cvt_pk_bf16_f32 v89, v90, v91
    ds_pk_add_bf16 v7, v88 offset:65408
    ds_pk_add_bf16 v7, v89 offset:65412
    s_mov_b64 exec, s[54:55]
    s_branch L2_d95
L2_c96:
    s_lshl_b64 s[52:53], s[82:83], 1
    s_andn2_b64 s[52:53], s[52:53], s[80:81]
    s_andn2_b64 s[52:53], s[52:53], s[50:51]
    s_or_b64 s[80:81], s[80:81], s[52:53]
    s_not_b64 vcc, s[52:53]
    s_mov_b64 exec, -1
    v_cndmask_b32_dpp v84, v84, v84, vcc wave_shr:1 row_mask:0xf bank_mask:0xf
    v_cndmask_b32_dpp v85, v85, v85, vcc wave_shr:1 row_mask:0xf bank_mask:0xf
    s_lshr_b64 s[52:53], s[52:53], 1
    v_cndmask_b32_dpp v86, v86, v86, vcc wave_shr:1 row_mask:0xf bank_mask:0xf
    v_cndmask_b32_dpp v87, v87, v87, vcc wave_shr:1 row_mask:0xf bank_mask:0xf
    s_andn2_b64 s[82:83], s[82:83], s[52:53]
    v_cndmask_b32_dpp v7, v7, v7, vcc wave_shr:1 row_mask:0xf bank_mask:0xf
    s_mov_b64 exec, s[50:51]
    s_cbranch_scc0 L2_d96
    s_mov_b64 exec, s[82:83]
    s_nop 1
    v_mfma_f32_4x4x4_16b_bf16 v[88:91], v[12:13], v[84:85], 0
    s_nop 1
    v_mfma_f32_4x4x4_16b_bf16 v[88:91], v[10:11], v[86:87], v[88:91]
    s_nop 4
    v_cvt_pk_bf16_f32 v88, v88, v89
    v_cvt_pk_bf16_f32 v89, v90, v91
    ds_pk_add_bf16 v7, v88 offset:65408
    ds_pk_add_bf16 v7, v89 offset:65412
    s_mov_b64 exec, s[50:51]
    s_branch L2_d96
L2_xa97:
    s_cmp_eq_u32 s101, 1
    s_cbranch_scc1 L2_xc97
    v_lshlrev_b32 v89, 0, v96
    v_add_u32 v90, 140, v97
    v_bitop3_b32 v90, v89, v45, v90 bitop3:0x6a
    ds_write_b32 v98, v90 offset:28
    v_lshlrev_b32 v89, 4, v96
    v_add_u32 v90, 120, v97
    v_bitop3_b32 v90, v89, v45, v90 bitop3:0x6a
    ds_write_b32 v98, v90 offset:24
    v_lshlrev_b32 v89, 8, v96
    v_add_u32 v90, 100, v97
    v_bitop3_b32 v90, v89, v45, v90 bitop3:0x6a
    ds_write_b32 v98, v90 offset:20
L2_xc97:
    v_lshlrev_b32 v89, 12, v96
    v_add_u32 v90, 80, v97
    v_bitop3_b32 v90, v89, v45, v90 bitop3:0x6a
    ds_write_b32 v98, v90 offset:16
    s_branch L2_xb97
L2_xe97:
    v_cmp_lt_u32 vcc, 32, v99
    v_cmp_lt_u32 s[58:59], 31, v88
    v_lshrrev_b32 v89, 16, v96
    v_add_u32 v97, 80, v97
    s_or_b64 vcc, vcc, s[58:59]
    s_cbranch_scc1 L2_xs97
    v_lshlrev_b32 v89, v1, v89
    v_and_b32 v89, v45, v89
    v_cmp_ne_u32 vcc, 0, v89
    v_xor_b32 v90, v97, v89
    s_add_u32 s3, s37, s38
    v_mbcnt_lo_u32_b32 v98, vcc_lo, 0
    v_mbcnt_hi_u32_b32 v98, vcc_hi, v98
    s_bcnt1_i32_b64 s41, vcc
    v_lshl_add_u32 v98, v98, 2, s3
    s_mov_b64 exec, vcc
    ds_write_b32 v98, v90
    s_mov_b64 exec, -1
    s_lshl2_add_u32 s37, s41, s37
    s_branch L2_xr97
L2_xf97:
    s_waitcnt lgkmcnt(0)
    s_cmp_gt_u32 s37, 1024
    s_cbranch_scc1 L2_xs97
    v_mov_b32 v43, -1
    s_cmp_ge_u32 s37, 512
    s_cbranch_scc1 L2_xg97
    v_mov_b32 v42, -1
    s_cmp_ge_u32 s37, 256
    s_cbranch_scc1 L2_xg97
    v_mov_b32 v41, -1
    s_branch L2_xg97
L2_xs97:
    s_waitcnt lgkmcnt(0)
    v_mov_b32 v40, -1
    v_mov_b32 v41, -1
    v_mov_b32 v42, -1
    v_mov_b32 v43, -1
    s_add_u32 s3, s42, 2
    s_bitset1_b32 s36, s3
    s_branch L2_xg97
L2_c98:
    s_lshl_b64 s[52:53], s[82:83], 1
    s_andn2_b64 s[52:53], s[52:53], s[80:81]
    s_andn2_b64 s[52:53], s[52:53], s[54:55]
    s_or_b64 s[80:81], s[80:81], s[52:53]
    s_not_b64 vcc, s[52:53]
    s_mov_b64 exec, -1
    v_cndmask_b32_dpp v84, v84, v84, vcc wave_shr:1 row_mask:0xf bank_mask:0xf
    v_cndmask_b32_dpp v85, v85, v85, vcc wave_shr:1 row_mask:0xf bank_mask:0xf
    s_lshr_b64 s[52:53], s[52:53], 1
    v_cndmask_b32_dpp v86, v86, v86, vcc wave_shr:1 row_mask:0xf bank_mask:0xf
    v_cndmask_b32_dpp v87, v87, v87, vcc wave_shr:1 row_mask:0xf bank_mask:0xf
    s_andn2_b64 s[82:83], s[82:83], s[52:53]
    v_cndmask_b32_dpp v7, v7, v7, vcc wave_shr:1 row_mask:0xf bank_mask:0xf
    s_mov_b64 exec, s[54:55]
    s_cbranch_scc0 L2_d98
    s_mov_b64 exec, s[82:83]
    s_nop 1
    v_mfma_f32_4x4x4_16b_bf16 v[88:91], v[12:13], v[84:85], 0
    s_nop 1
    v_mfma_f32_4x4x4_16b_bf16 v[88:91], v[10:11], v[86:87], v[88:91]
    s_nop 4
    v_cvt_pk_bf16_f32 v88, v88, v89
    v_cvt_pk_bf16_f32 v89, v90, v91
    ds_pk_add_bf16 v7, v88 offset:65408
    ds_pk_add_bf16 v7, v89 offset:65412
    s_mov_b64 exec, s[54:55]
    s_branch L2_d98
L2_c99:
    s_lshl_b64 s[52:53], s[82:83], 1
    s_andn2_b64 s[52:53], s[52:53], s[80:81]
    s_andn2_b64 s[52:53], s[52:53], s[50:51]
    s_or_b64 s[80:81], s[80:81], s[52:53]
    s_not_b64 vcc, s[52:53]
    s_mov_b64 exec, -1
    v_cndmask_b32_dpp v84, v84, v84, vcc wave_shr:1 row_mask:0xf bank_mask:0xf
    v_cndmask_b32_dpp v85, v85, v85, vcc wave_shr:1 row_mask:0xf bank_mask:0xf
    s_lshr_b64 s[52:53], s[52:53], 1
    v_cndmask_b32_dpp v86, v86, v86, vcc wave_shr:1 row_mask:0xf bank_mask:0xf
    v_cndmask_b32_dpp v87, v87, v87, vcc wave_shr:1 row_mask:0xf bank_mask:0xf
    s_andn2_b64 s[82:83], s[82:83], s[52:53]
    v_cndmask_b32_dpp v7, v7, v7, vcc wave_shr:1 row_mask:0xf bank_mask:0xf
    s_mov_b64 exec, s[50:51]
    s_cbranch_scc0 L2_d99
    s_mov_b64 exec, s[82:83]
    s_nop 1
    v_mfma_f32_4x4x4_16b_bf16 v[88:91], v[12:13], v[84:85], 0
    s_nop 1
    v_mfma_f32_4x4x4_16b_bf16 v[88:91], v[10:11], v[86:87], v[88:91]
    s_nop 4
    v_cvt_pk_bf16_f32 v88, v88, v89
    v_cvt_pk_bf16_f32 v89, v90, v91
    ds_pk_add_bf16 v7, v88 offset:65408
    ds_pk_add_bf16 v7, v89 offset:65412
    s_mov_b64 exec, s[50:51]
    s_branch L2_d99
L2_c100:
    s_lshl_b64 s[52:53], s[82:83], 1
    s_andn2_b64 s[52:53], s[52:53], s[80:81]
    s_andn2_b64 s[52:53], s[52:53], s[54:55]
    s_or_b64 s[80:81], s[80:81], s[52:53]
    s_not_b64 vcc, s[52:53]
    s_mov_b64 exec, -1
    v_cndmask_b32_dpp v84, v84, v84, vcc wave_shr:1 row_mask:0xf bank_mask:0xf
    v_cndmask_b32_dpp v85, v85, v85, vcc wave_shr:1 row_mask:0xf bank_mask:0xf
    s_lshr_b64 s[52:53], s[52:53], 1
    v_cndmask_b32_dpp v86, v86, v86, vcc wave_shr:1 row_mask:0xf bank_mask:0xf
    v_cndmask_b32_dpp v87, v87, v87, vcc wave_shr:1 row_mask:0xf bank_mask:0xf
    s_andn2_b64 s[82:83], s[82:83], s[52:53]
    v_cndmask_b32_dpp v7, v7, v7, vcc wave_shr:1 row_mask:0xf bank_mask:0xf
    s_mov_b64 exec, s[54:55]
    s_cbranch_scc0 L2_d100
    s_mov_b64 exec, s[82:83]
    s_nop 1
    v_mfma_f32_4x4x4_16b_bf16 v[88:91], v[12:13], v[84:85], 0
    s_nop 1
    v_mfma_f32_4x4x4_16b_bf16 v[88:91], v[10:11], v[86:87], v[88:91]
    s_nop 4
    v_cvt_pk_bf16_f32 v88, v88, v89
    v_cvt_pk_bf16_f32 v89, v90, v91
    ds_pk_add_bf16 v7, v88 offset:65408
    ds_pk_add_bf16 v7, v89 offset:65412
    s_mov_b64 exec, s[54:55]
    s_branch L2_d100
L2_c101:
    s_lshl_b64 s[52:53], s[82:83], 1
    s_andn2_b64 s[52:53], s[52:53], s[80:81]
    s_andn2_b64 s[52:53], s[52:53], s[50:51]
    s_or_b64 s[80:81], s[80:81], s[52:53]
    s_not_b64 vcc, s[52:53]
    s_mov_b64 exec, -1
    v_cndmask_b32_dpp v84, v84, v84, vcc wave_shr:1 row_mask:0xf bank_mask:0xf
    v_cndmask_b32_dpp v85, v85, v85, vcc wave_shr:1 row_mask:0xf bank_mask:0xf
    s_lshr_b64 s[52:53], s[52:53], 1
    v_cndmask_b32_dpp v86, v86, v86, vcc wave_shr:1 row_mask:0xf bank_mask:0xf
    v_cndmask_b32_dpp v87, v87, v87, vcc wave_shr:1 row_mask:0xf bank_mask:0xf
    s_andn2_b64 s[82:83], s[82:83], s[52:53]
    v_cndmask_b32_dpp v7, v7, v7, vcc wave_shr:1 row_mask:0xf bank_mask:0xf
    s_mov_b64 exec, s[50:51]
    s_cbranch_scc0 L2_d101
    s_mov_b64 exec, s[82:83]
    s_nop 1
    v_mfma_f32_4x4x4_16b_bf16 v[88:91], v[12:13], v[84:85], 0
    s_nop 1
    v_mfma_f32_4x4x4_16b_bf16 v[88:91], v[10:11], v[86:87], v[88:91]
    s_nop 4
    v_cvt_pk_bf16_f32 v88, v88, v89
    v_cvt_pk_bf16_f32 v89, v90, v91
    ds_pk_add_bf16 v7, v88 offset:65408
    ds_pk_add_bf16 v7, v89 offset:65412
    s_mov_b64 exec, s[50:51]
    s_branch L2_d101
L2_c102:
    s_lshl_b64 s[52:53], s[82:83], 1
    s_andn2_b64 s[52:53], s[52:53], s[80:81]
    s_andn2_b64 s[52:53], s[52:53], s[54:55]
    s_or_b64 s[80:81], s[80:81], s[52:53]
    s_not_b64 vcc, s[52:53]
    s_mov_b64 exec, -1
    v_cndmask_b32_dpp v84, v84, v84, vcc wave_shr:1 row_mask:0xf bank_mask:0xf
    v_cndmask_b32_dpp v85, v85, v85, vcc wave_shr:1 row_mask:0xf bank_mask:0xf
    s_lshr_b64 s[52:53], s[52:53], 1
    v_cndmask_b32_dpp v86, v86, v86, vcc wave_shr:1 row_mask:0xf bank_mask:0xf
    v_cndmask_b32_dpp v87, v87, v87, vcc wave_shr:1 row_mask:0xf bank_mask:0xf
    s_andn2_b64 s[82:83], s[82:83], s[52:53]
    v_cndmask_b32_dpp v7, v7, v7, vcc wave_shr:1 row_mask:0xf bank_mask:0xf
    s_mov_b64 exec, s[54:55]
    s_cbranch_scc0 L2_d102
    s_mov_b64 exec, s[82:83]
    s_nop 1
    v_mfma_f32_4x4x4_16b_bf16 v[88:91], v[12:13], v[84:85], 0
    s_nop 1
    v_mfma_f32_4x4x4_16b_bf16 v[88:91], v[10:11], v[86:87], v[88:91]
    s_nop 4
    v_cvt_pk_bf16_f32 v88, v88, v89
    v_cvt_pk_bf16_f32 v89, v90, v91
    ds_pk_add_bf16 v7, v88 offset:65408
    ds_pk_add_bf16 v7, v89 offset:65412
    s_mov_b64 exec, s[54:55]
    s_branch L2_d102
L2_c103:
    s_lshl_b64 s[52:53], s[82:83], 1
    s_andn2_b64 s[52:53], s[52:53], s[80:81]
    s_andn2_b64 s[52:53], s[52:53], s[50:51]
    s_or_b64 s[80:81], s[80:81], s[52:53]
    s_not_b64 vcc, s[52:53]
    s_mov_b64 exec, -1
    v_cndmask_b32_dpp v84, v84, v84, vcc wave_shr:1 row_mask:0xf bank_mask:0xf
    v_cndmask_b32_dpp v85, v85, v85, vcc wave_shr:1 row_mask:0xf bank_mask:0xf
    s_lshr_b64 s[52:53], s[52:53], 1
    v_cndmask_b32_dpp v86, v86, v86, vcc wave_shr:1 row_mask:0xf bank_mask:0xf
    v_cndmask_b32_dpp v87, v87, v87, vcc wave_shr:1 row_mask:0xf bank_mask:0xf
    s_andn2_b64 s[82:83], s[82:83], s[52:53]
    v_cndmask_b32_dpp v7, v7, v7, vcc wave_shr:1 row_mask:0xf bank_mask:0xf
    s_mov_b64 exec, s[50:51]
    s_cbranch_scc0 L2_d103
    s_mov_b64 exec, s[82:83]
    s_nop 1
    v_mfma_f32_4x4x4_16b_bf16 v[88:91], v[12:13], v[84:85], 0
    s_nop 1
    v_mfma_f32_4x4x4_16b_bf16 v[88:91], v[10:11], v[86:87], v[88:91]
    s_nop 4
    v_cvt_pk_bf16_f32 v88, v88, v89
    v_cvt_pk_bf16_f32 v89, v90, v91
    ds_pk_add_bf16 v7, v88 offset:65408
    ds_pk_add_bf16 v7, v89 offset:65412
    s_mov_b64 exec, s[50:51]
    s_branch L2_d103
L2_xo104:
    v_cmp_lt_u32 vcc, 20, v99
    s_mov_b32 s101, 1
    s_cbranch_vccz L2_xp104
    v_cmp_lt_u32 vcc, 32, v99
    v_cmp_lt_u32 s[58:59], 31, v88
    s_mov_b32 s101, 2
    s_or_b64 vcc, vcc, s[58:59]
    s_cbranch_scc0 L2_xp104
    s_mov_b32 s37, 0x10000
    s_branch L2_xp104
L2_c105:
    s_lshl_b64 s[52:53], s[82:83], 1
    s_andn2_b64 s[52:53], s[52:53], s[80:81]
    s_andn2_b64 s[52:53], s[52:53], s[54:55]
    s_or_b64 s[80:81], s[80:81], s[52:53]
    s_not_b64 vcc, s[52:53]
    s_mov_b64 exec, -1
    v_cndmask_b32_dpp v84, v84, v84, vcc wave_shr:1 row_mask:0xf bank_mask:0xf
    v_cndmask_b32_dpp v85, v85, v85, vcc wave_shr:1 row_mask:0xf bank_mask:0xf
    s_lshr_b64 s[52:53], s[52:53], 1
    v_cndmask_b32_dpp v86, v86, v86, vcc wave_shr:1 row_mask:0xf bank_mask:0xf
    v_cndmask_b32_dpp v87, v87, v87, vcc wave_shr:1 row_mask:0xf bank_mask:0xf
    s_andn2_b64 s[82:83], s[82:83], s[52:53]
    v_cndmask_b32_dpp v7, v7, v7, vcc wave_shr:1 row_mask:0xf bank_mask:0xf
    s_mov_b64 exec, s[54:55]
    s_cbranch_scc0 L2_d105
    s_mov_b64 exec, s[82:83]
    s_nop 1
    v_mfma_f32_4x4x4_16b_bf16 v[88:91], v[12:13], v[84:85], 0
    s_nop 1
    v_mfma_f32_4x4x4_16b_bf16 v[88:91], v[10:11], v[86:87], v[88:91]
    s_nop 4
    v_cvt_pk_bf16_f32 v88, v88, v89
    v_cvt_pk_bf16_f32 v89, v90, v91
    ds_pk_add_bf16 v7, v88 offset:65408
    ds_pk_add_bf16 v7, v89 offset:65412
    s_mov_b64 exec, s[54:55]
    s_branch L2_d105
L2_c106:
    s_lshl_b64 s[52:53], s[82:83], 1
    s_andn2_b64 s[52:53], s[52:53], s[80:81]
    s_andn2_b64 s[52:53], s[52:53], s[50:51]
    s_or_b64 s[80:81], s[80:81], s[52:53]
    s_not_b64 vcc, s[52:53]
    s_mov_b64 exec, -1
    v_cndmask_b32_dpp v84, v84, v84, vcc wave_shr:1 row_mask:0xf bank_mask:0xf
    v_cndmask_b32_dpp v85, v85, v85, vcc wave_shr:1 row_mask:0xf bank_mask:0xf
    s_lshr_b64 s[52:53], s[52:53], 1
    v_cndmask_b32_dpp v86, v86, v86, vcc wave_shr:1 row_mask:0xf bank_mask:0xf
    v_cndmask_b32_dpp v87, v87, v87, vcc wave_shr:1 row_mask:0xf bank_mask:0xf
    s_andn2_b64 s[82:83], s[82:83], s[52:53]
    v_cndmask_b32_dpp v7, v7, v7, vcc wave_shr:1 row_mask:0xf bank_mask:0xf
    s_mov_b64 exec, s[50:51]
    s_cbranch_scc0 L2_d106
    s_mov_b64 exec, s[82:83]
    s_nop 1
    v_mfma_f32_4x4x4_16b_bf16 v[88:91], v[12:13], v[84:85], 0
    s_nop 1
    v_mfma_f32_4x4x4_16b_bf16 v[88:91], v[10:11], v[86:87], v[88:91]
    s_nop 4
    v_cvt_pk_bf16_f32 v88, v88, v89
    v_cvt_pk_bf16_f32 v89, v90, v91
    ds_pk_add_bf16 v7, v88 offset:65408
    ds_pk_add_bf16 v7, v89 offset:65412
    s_mov_b64 exec, s[50:51]
    s_branch L2_d106
L2_c107:
    s_lshl_b64 s[52:53], s[82:83], 1
    s_andn2_b64 s[52:53], s[52:53], s[80:81]
    s_andn2_b64 s[52:53], s[52:53], s[54:55]
    s_or_b64 s[80:81], s[80:81], s[52:53]
    s_not_b64 vcc, s[52:53]
    s_mov_b64 exec, -1
    v_cndmask_b32_dpp v84, v84, v84, vcc wave_shr:1 row_mask:0xf bank_mask:0xf
    v_cndmask_b32_dpp v85, v85, v85, vcc wave_shr:1 row_mask:0xf bank_mask:0xf
    s_lshr_b64 s[52:53], s[52:53], 1
    v_cndmask_b32_dpp v86, v86, v86, vcc wave_shr:1 row_mask:0xf bank_mask:0xf
    v_cndmask_b32_dpp v87, v87, v87, vcc wave_shr:1 row_mask:0xf bank_mask:0xf
    s_andn2_b64 s[82:83], s[82:83], s[52:53]
    v_cndmask_b32_dpp v7, v7, v7, vcc wave_shr:1 row_mask:0xf bank_mask:0xf
    s_mov_b64 exec, s[54:55]
    s_cbranch_scc0 L2_d107
    s_mov_b64 exec, s[82:83]
    s_nop 1
    v_mfma_f32_4x4x4_16b_bf16 v[88:91], v[12:13], v[84:85], 0
    s_nop 1
    v_mfma_f32_4x4x4_16b_bf16 v[88:91], v[10:11], v[86:87], v[88:91]
    s_nop 4
    v_cvt_pk_bf16_f32 v88, v88, v89
    v_cvt_pk_bf16_f32 v89, v90, v91
    ds_pk_add_bf16 v7, v88 offset:65408
    ds_pk_add_bf16 v7, v89 offset:65412
    s_mov_b64 exec, s[54:55]
    s_branch L2_d107
L2_c108:
    s_lshl_b64 s[52:53], s[82:83], 1
    s_andn2_b64 s[52:53], s[52:53], s[80:81]
    s_andn2_b64 s[52:53], s[52:53], s[50:51]
    s_or_b64 s[80:81], s[80:81], s[52:53]
    s_not_b64 vcc, s[52:53]
    s_mov_b64 exec, -1
    v_cndmask_b32_dpp v84, v84, v84, vcc wave_shr:1 row_mask:0xf bank_mask:0xf
    v_cndmask_b32_dpp v85, v85, v85, vcc wave_shr:1 row_mask:0xf bank_mask:0xf
    s_lshr_b64 s[52:53], s[52:53], 1
    v_cndmask_b32_dpp v86, v86, v86, vcc wave_shr:1 row_mask:0xf bank_mask:0xf
    v_cndmask_b32_dpp v87, v87, v87, vcc wave_shr:1 row_mask:0xf bank_mask:0xf
    s_andn2_b64 s[82:83], s[82:83], s[52:53]
    v_cndmask_b32_dpp v7, v7, v7, vcc wave_shr:1 row_mask:0xf bank_mask:0xf
    s_mov_b64 exec, s[50:51]
    s_cbranch_scc0 L2_d108
    s_mov_b64 exec, s[82:83]
    s_nop 1
    v_mfma_f32_4x4x4_16b_bf16 v[88:91], v[12:13], v[84:85], 0
    s_nop 1
    v_mfma_f32_4x4x4_16b_bf16 v[88:91], v[10:11], v[86:87], v[88:91]
    s_nop 4
    v_cvt_pk_bf16_f32 v88, v88, v89
    v_cvt_pk_bf16_f32 v89, v90, v91
    ds_pk_add_bf16 v7, v88 offset:65408
    ds_pk_add_bf16 v7, v89 offset:65412
    s_mov_b64 exec, s[50:51]
    s_branch L2_d108
L2_c109:
    s_lshl_b64 s[52:53], s[82:83], 1
    s_andn2_b64 s[52:53], s[52:53], s[80:81]
    s_andn2_b64 s[52:53], s[52:53], s[54:55]
    s_or_b64 s[80:81], s[80:81], s[52:53]
    s_not_b64 vcc, s[52:53]
    s_mov_b64 exec, -1
    v_cndmask_b32_dpp v84, v84, v84, vcc wave_shr:1 row_mask:0xf bank_mask:0xf
    v_cndmask_b32_dpp v85, v85, v85, vcc wave_shr:1 row_mask:0xf bank_mask:0xf
    s_lshr_b64 s[52:53], s[52:53], 1
    v_cndmask_b32_dpp v86, v86, v86, vcc wave_shr:1 row_mask:0xf bank_mask:0xf
    v_cndmask_b32_dpp v87, v87, v87, vcc wave_shr:1 row_mask:0xf bank_mask:0xf
    s_andn2_b64 s[82:83], s[82:83], s[52:53]
    v_cndmask_b32_dpp v7, v7, v7, vcc wave_shr:1 row_mask:0xf bank_mask:0xf
    s_mov_b64 exec, s[54:55]
    s_cbranch_scc0 L2_d109
    s_mov_b64 exec, s[82:83]
    s_nop 1
    v_mfma_f32_4x4x4_16b_bf16 v[88:91], v[12:13], v[84:85], 0
    s_nop 1
    v_mfma_f32_4x4x4_16b_bf16 v[88:91], v[10:11], v[86:87], v[88:91]
    s_nop 4
    v_cvt_pk_bf16_f32 v88, v88, v89
    v_cvt_pk_bf16_f32 v89, v90, v91
    ds_pk_add_bf16 v7, v88 offset:65408
    ds_pk_add_bf16 v7, v89 offset:65412
    s_mov_b64 exec, s[54:55]
    s_branch L2_d109
L2_c110:
    s_lshl_b64 s[52:53], s[82:83], 1
    s_andn2_b64 s[52:53], s[52:53], s[80:81]
    s_andn2_b64 s[52:53], s[52:53], s[50:51]
    s_or_b64 s[80:81], s[80:81], s[52:53]
    s_not_b64 vcc, s[52:53]
    s_mov_b64 exec, -1
    v_cndmask_b32_dpp v84, v84, v84, vcc wave_shr:1 row_mask:0xf bank_mask:0xf
    v_cndmask_b32_dpp v85, v85, v85, vcc wave_shr:1 row_mask:0xf bank_mask:0xf
    s_lshr_b64 s[52:53], s[52:53], 1
    v_cndmask_b32_dpp v86, v86, v86, vcc wave_shr:1 row_mask:0xf bank_mask:0xf
    v_cndmask_b32_dpp v87, v87, v87, vcc wave_shr:1 row_mask:0xf bank_mask:0xf
    s_andn2_b64 s[82:83], s[82:83], s[52:53]
    v_cndmask_b32_dpp v7, v7, v7, vcc wave_shr:1 row_mask:0xf bank_mask:0xf
    s_mov_b64 exec, s[50:51]
    s_cbranch_scc0 L2_d110
    s_mov_b64 exec, s[82:83]
    s_nop 1
    v_mfma_f32_4x4x4_16b_bf16 v[88:91], v[12:13], v[84:85], 0
    s_nop 1
    v_mfma_f32_4x4x4_16b_bf16 v[88:91], v[10:11], v[86:87], v[88:91]
    s_nop 4
    v_cvt_pk_bf16_f32 v88, v88, v89
    v_cvt_pk_bf16_f32 v89, v90, v91
    ds_pk_add_bf16 v7, v88 offset:65408
    ds_pk_add_bf16 v7, v89 offset:65412
    s_mov_b64 exec, s[50:51]
    s_branch L2_d110
L2_c111:
    s_lshl_b64 s[52:53], s[82:83], 1
    s_andn2_b64 s[52:53], s[52:53], s[80:81]
    s_andn2_b64 s[52:53], s[52:53], s[54:55]
    s_or_b64 s[80:81], s[80:81], s[52:53]
    s_not_b64 vcc, s[52:53]
    s_mov_b64 exec, -1
    v_cndmask_b32_dpp v84, v84, v84, vcc wave_shr:1 row_mask:0xf bank_mask:0xf
    v_cndmask_b32_dpp v85, v85, v85, vcc wave_shr:1 row_mask:0xf bank_mask:0xf
    s_lshr_b64 s[52:53], s[52:53], 1
    v_cndmask_b32_dpp v86, v86, v86, vcc wave_shr:1 row_mask:0xf bank_mask:0xf
    v_cndmask_b32_dpp v87, v87, v87, vcc wave_shr:1 row_mask:0xf bank_mask:0xf
    s_andn2_b64 s[82:83], s[82:83], s[52:53]
    v_cndmask_b32_dpp v7, v7, v7, vcc wave_shr:1 row_mask:0xf bank_mask:0xf
    s_mov_b64 exec, s[54:55]
    s_cbranch_scc0 L2_d111
    s_mov_b64 exec, s[82:83]
    s_nop 1
    v_mfma_f32_4x4x4_16b_bf16 v[88:91], v[12:13], v[84:85], 0
    s_nop 1
    v_mfma_f32_4x4x4_16b_bf16 v[88:91], v[10:11], v[86:87], v[88:91]
    s_nop 4
    v_cvt_pk_bf16_f32 v88, v88, v89
    v_cvt_pk_bf16_f32 v89, v90, v91
    ds_pk_add_bf16 v7, v88 offset:65408
    ds_pk_add_bf16 v7, v89 offset:65412
    s_mov_b64 exec, s[54:55]
    s_branch L2_d111
L2_c112:
    s_lshl_b64 s[52:53], s[82:83], 1
    s_andn2_b64 s[52:53], s[52:53], s[80:81]
    s_andn2_b64 s[52:53], s[52:53], s[50:51]
    s_or_b64 s[80:81], s[80:81], s[52:53]
    s_not_b64 vcc, s[52:53]
    s_mov_b64 exec, -1
    v_cndmask_b32_dpp v84, v84, v84, vcc wave_shr:1 row_mask:0xf bank_mask:0xf
    v_cndmask_b32_dpp v85, v85, v85, vcc wave_shr:1 row_mask:0xf bank_mask:0xf
    s_lshr_b64 s[52:53], s[52:53], 1
    v_cndmask_b32_dpp v86, v86, v86, vcc wave_shr:1 row_mask:0xf bank_mask:0xf
    v_cndmask_b32_dpp v87, v87, v87, vcc wave_shr:1 row_mask:0xf bank_mask:0xf
    s_andn2_b64 s[82:83], s[82:83], s[52:53]
    v_cndmask_b32_dpp v7, v7, v7, vcc wave_shr:1 row_mask:0xf bank_mask:0xf
    s_mov_b64 exec, s[50:51]
    s_cbranch_scc0 L2_d112
    s_mov_b64 exec, s[82:83]
    s_nop 1
    v_mfma_f32_4x4x4_16b_bf16 v[88:91], v[12:13], v[84:85], 0
    s_nop 1
    v_mfma_f32_4x4x4_16b_bf16 v[88:91], v[10:11], v[86:87], v[88:91]
    s_nop 4
    v_cvt_pk_bf16_f32 v88, v88, v89
    v_cvt_pk_bf16_f32 v89, v90, v91
    ds_pk_add_bf16 v7, v88 offset:65408
    ds_pk_add_bf16 v7, v89 offset:65412
    s_mov_b64 exec, s[50:51]
    s_branch L2_d112
L2_c113:
    s_lshl_b64 s[52:53], s[82:83], 1
    s_andn2_b64 s[52:53], s[52:53], s[80:81]
    s_andn2_b64 s[52:53], s[52:53], s[54:55]
    s_or_b64 s[80:81], s[80:81], s[52:53]
    s_not_b64 vcc, s[52:53]
    s_mov_b64 exec, -1
    v_cndmask_b32_dpp v84, v84, v84, vcc wave_shr:1 row_mask:0xf bank_mask:0xf
    v_cndmask_b32_dpp v85, v85, v85, vcc wave_shr:1 row_mask:0xf bank_mask:0xf
    s_lshr_b64 s[52:53], s[52:53], 1
    v_cndmask_b32_dpp v86, v86, v86, vcc wave_shr:1 row_mask:0xf bank_mask:0xf
    v_cndmask_b32_dpp v87, v87, v87, vcc wave_shr:1 row_mask:0xf bank_mask:0xf
    s_andn2_b64 s[82:83], s[82:83], s[52:53]
    v_cndmask_b32_dpp v7, v7, v7, vcc wave_shr:1 row_mask:0xf bank_mask:0xf
    s_mov_b64 exec, s[54:55]
    s_cbranch_scc0 L2_d113
    s_mov_b64 exec, s[82:83]
    s_nop 1
    v_mfma_f32_4x4x4_16b_bf16 v[88:91], v[12:13], v[84:85], 0
    s_nop 1
    v_mfma_f32_4x4x4_16b_bf16 v[88:91], v[10:11], v[86:87], v[88:91]
    s_nop 4
    v_cvt_pk_bf16_f32 v88, v88, v89
    v_cvt_pk_bf16_f32 v89, v90, v91
    ds_pk_add_bf16 v7, v88 offset:65408
    ds_pk_add_bf16 v7, v89 offset:65412
    s_mov_b64 exec, s[54:55]
    s_branch L2_d113
L2_c114:
    s_lshl_b64 s[52:53], s[82:83], 1
    s_andn2_b64 s[52:53], s[52:53], s[80:81]
    s_andn2_b64 s[52:53], s[52:53], s[50:51]
    s_or_b64 s[80:81], s[80:81], s[52:53]
    s_not_b64 vcc, s[52:53]
    s_mov_b64 exec, -1
    v_cndmask_b32_dpp v84, v84, v84, vcc wave_shr:1 row_mask:0xf bank_mask:0xf
    v_cndmask_b32_dpp v85, v85, v85, vcc wave_shr:1 row_mask:0xf bank_mask:0xf
    s_lshr_b64 s[52:53], s[52:53], 1
    v_cndmask_b32_dpp v86, v86, v86, vcc wave_shr:1 row_mask:0xf bank_mask:0xf
    v_cndmask_b32_dpp v87, v87, v87, vcc wave_shr:1 row_mask:0xf bank_mask:0xf
    s_andn2_b64 s[82:83], s[82:83], s[52:53]
    v_cndmask_b32_dpp v7, v7, v7, vcc wave_shr:1 row_mask:0xf bank_mask:0xf
    s_mov_b64 exec, s[50:51]
    s_cbranch_scc0 L2_d114
    s_mov_b64 exec, s[82:83]
    s_nop 1
    v_mfma_f32_4x4x4_16b_bf16 v[88:91], v[12:13], v[84:85], 0
    s_nop 1
    v_mfma_f32_4x4x4_16b_bf16 v[88:91], v[10:11], v[86:87], v[88:91]
    s_nop 4
    v_cvt_pk_bf16_f32 v88, v88, v89
    v_cvt_pk_bf16_f32 v89, v90, v91
    ds_pk_add_bf16 v7, v88 offset:65408
    ds_pk_add_bf16 v7, v89 offset:65412
    s_mov_b64 exec, s[50:51]
    s_branch L2_d114
L2_xa115:
    s_cmp_eq_u32 s101, 1
    s_cbranch_scc1 L2_xc115
    v_lshlrev_b32 v89, 0, v96
    v_add_u32 v90, 140, v97
    v_bitop3_b32 v90, v89, v45, v90 bitop3:0x6a
    ds_write_b32 v98, v90 offset:28
    v_lshlrev_b32 v89, 4, v96
    v_add_u32 v90, 120, v97
    v_bitop3_b32 v90, v89, v45, v90 bitop3:0x6a
    ds_write_b32 v98, v90 offset:24
    v_lshlrev_b32 v89, 8, v96
    v_add_u32 v90, 100, v97
    v_bitop3_b32 v90, v89, v45, v90 bitop3:0x6a
    ds_write_b32 v98, v90 offset:20
L2_xc115:
    v_lshlrev_b32 v89, 12, v96
    v_add_u32 v90, 80, v97
    v_bitop3_b32 v90, v89, v45, v90 bitop3:0x6a
    ds_write_b32 v98, v90 offset:16
    s_branch L2_xb115
L2_xe115:
    v_cmp_lt_u32 vcc, 32, v99
    v_cmp_lt_u32 s[58:59], 31, v88
    v_lshrrev_b32 v89, 16, v96
    v_add_u32 v97, 80, v97
    s_or_b64 vcc, vcc, s[58:59]
    s_cbranch_scc1 L2_xs115
    v_lshlrev_b32 v89, v1, v89
    v_and_b32 v89, v45, v89
    v_cmp_ne_u32 vcc, 0, v89
    v_xor_b32 v90, v97, v89
    s_add_u32 s3, s37, s38
    v_mbcnt_lo_u32_b32 v98, vcc_lo, 0
    v_mbcnt_hi_u32_b32 v98, vcc_hi, v98
    s_bcnt1_i32_b64 s41, vcc
    v_lshl_add_u32 v98, v98, 2, s3
    s_mov_b64 exec, vcc
    ds_write_b32 v98, v90
    s_mov_b64 exec, -1
    s_lshl2_add_u32 s37, s41, s37
    s_branch L2_xr115
L2_xf115:
    s_waitcnt lgkmcnt(0)
    s_cmp_gt_u32 s37, 1024
    s_cbranch_scc1 L2_xs115
    v_mov_b32 v43, -1
    s_cmp_ge_u32 s37, 512
    s_cbranch_scc1 L2_xg115
    v_mov_b32 v42, -1
    s_cmp_ge_u32 s37, 256
    s_cbranch_scc1 L2_xg115
    v_mov_b32 v41, -1
    s_branch L2_xg115
L2_xs115:
    s_waitcnt lgkmcnt(0)
    v_mov_b32 v40, -1
    v_mov_b32 v41, -1
    v_mov_b32 v42, -1
    v_mov_b32 v43, -1
    s_add_u32 s3, s42, 2
    s_bitset1_b32 s36, s3
    s_branch L2_xg115
L2_c116:
    s_lshl_b64 s[52:53], s[82:83], 1
    s_andn2_b64 s[52:53], s[52:53], s[80:81]
    s_andn2_b64 s[52:53], s[52:53], s[54:55]
    s_or_b64 s[80:81], s[80:81], s[52:53]
    s_not_b64 vcc, s[52:53]
    s_mov_b64 exec, -1
    v_cndmask_b32_dpp v84, v84, v84, vcc wave_shr:1 row_mask:0xf bank_mask:0xf
    v_cndmask_b32_dpp v85, v85, v85, vcc wave_shr:1 row_mask:0xf bank_mask:0xf
    s_lshr_b64 s[52:53], s[52:53], 1
    v_cndmask_b32_dpp v86, v86, v86, vcc wave_shr:1 row_mask:0xf bank_mask:0xf
    v_cndmask_b32_dpp v87, v87, v87, vcc wave_shr:1 row_mask:0xf bank_mask:0xf
    s_andn2_b64 s[82:83], s[82:83], s[52:53]
    v_cndmask_b32_dpp v7, v7, v7, vcc wave_shr:1 row_mask:0xf bank_mask:0xf
    s_mov_b64 exec, s[54:55]
    s_cbranch_scc0 L2_d116
    s_mov_b64 exec, s[82:83]
    s_nop 1
    v_mfma_f32_4x4x4_16b_bf16 v[88:91], v[12:13], v[84:85], 0
    s_nop 1
    v_mfma_f32_4x4x4_16b_bf16 v[88:91], v[10:11], v[86:87], v[88:91]
    s_nop 4
    v_cvt_pk_bf16_f32 v88, v88, v89
    v_cvt_pk_bf16_f32 v89, v90, v91
    ds_pk_add_bf16 v7, v88 offset:65408
    ds_pk_add_bf16 v7, v89 offset:65412
    s_mov_b64 exec, s[54:55]
    s_branch L2_d116
L2_c117:
    s_lshl_b64 s[52:53], s[82:83], 1
    s_andn2_b64 s[52:53], s[52:53], s[80:81]
    s_andn2_b64 s[52:53], s[52:53], s[50:51]
    s_or_b64 s[80:81], s[80:81], s[52:53]
    s_not_b64 vcc, s[52:53]
    s_mov_b64 exec, -1
    v_cndmask_b32_dpp v84, v84, v84, vcc wave_shr:1 row_mask:0xf bank_mask:0xf
    v_cndmask_b32_dpp v85, v85, v85, vcc wave_shr:1 row_mask:0xf bank_mask:0xf
    s_lshr_b64 s[52:53], s[52:53], 1
    v_cndmask_b32_dpp v86, v86, v86, vcc wave_shr:1 row_mask:0xf bank_mask:0xf
    v_cndmask_b32_dpp v87, v87, v87, vcc wave_shr:1 row_mask:0xf bank_mask:0xf
    s_andn2_b64 s[82:83], s[82:83], s[52:53]
    v_cndmask_b32_dpp v7, v7, v7, vcc wave_shr:1 row_mask:0xf bank_mask:0xf
    s_mov_b64 exec, s[50:51]
    s_cbranch_scc0 L2_d117
    s_mov_b64 exec, s[82:83]
    s_nop 1
    v_mfma_f32_4x4x4_16b_bf16 v[88:91], v[12:13], v[84:85], 0
    s_nop 1
    v_mfma_f32_4x4x4_16b_bf16 v[88:91], v[10:11], v[86:87], v[88:91]
    s_nop 4
    v_cvt_pk_bf16_f32 v88, v88, v89
    v_cvt_pk_bf16_f32 v89, v90, v91
    ds_pk_add_bf16 v7, v88 offset:65408
    ds_pk_add_bf16 v7, v89 offset:65412
    s_mov_b64 exec, s[50:51]
    s_branch L2_d117
L2_c118:
    s_lshl_b64 s[52:53], s[82:83], 1
    s_andn2_b64 s[52:53], s[52:53], s[80:81]
    s_andn2_b64 s[52:53], s[52:53], s[54:55]
    s_or_b64 s[80:81], s[80:81], s[52:53]
    s_not_b64 vcc, s[52:53]
    s_mov_b64 exec, -1
    v_cndmask_b32_dpp v84, v84, v84, vcc wave_shr:1 row_mask:0xf bank_mask:0xf
    v_cndmask_b32_dpp v85, v85, v85, vcc wave_shr:1 row_mask:0xf bank_mask:0xf
    s_lshr_b64 s[52:53], s[52:53], 1
    v_cndmask_b32_dpp v86, v86, v86, vcc wave_shr:1 row_mask:0xf bank_mask:0xf
    v_cndmask_b32_dpp v87, v87, v87, vcc wave_shr:1 row_mask:0xf bank_mask:0xf
    s_andn2_b64 s[82:83], s[82:83], s[52:53]
    v_cndmask_b32_dpp v7, v7, v7, vcc wave_shr:1 row_mask:0xf bank_mask:0xf
    s_mov_b64 exec, s[54:55]
    s_cbranch_scc0 L2_d118
    s_mov_b64 exec, s[82:83]
    s_nop 1
    v_mfma_f32_4x4x4_16b_bf16 v[88:91], v[12:13], v[84:85], 0
    s_nop 1
    v_mfma_f32_4x4x4_16b_bf16 v[88:91], v[10:11], v[86:87], v[88:91]
    s_nop 4
    v_cvt_pk_bf16_f32 v88, v88, v89
    v_cvt_pk_bf16_f32 v89, v90, v91
    ds_pk_add_bf16 v7, v88 offset:65408
    ds_pk_add_bf16 v7, v89 offset:65412
    s_mov_b64 exec, s[54:55]
    s_branch L2_d118
L2_c119:
    s_lshl_b64 s[52:53], s[82:83], 1
    s_andn2_b64 s[52:53], s[52:53], s[80:81]
    s_andn2_b64 s[52:53], s[52:53], s[50:51]
    s_or_b64 s[80:81], s[80:81], s[52:53]
    s_not_b64 vcc, s[52:53]
    s_mov_b64 exec, -1
    v_cndmask_b32_dpp v84, v84, v84, vcc wave_shr:1 row_mask:0xf bank_mask:0xf
    v_cndmask_b32_dpp v85, v85, v85, vcc wave_shr:1 row_mask:0xf bank_mask:0xf
    s_lshr_b64 s[52:53], s[52:53], 1
    v_cndmask_b32_dpp v86, v86, v86, vcc wave_shr:1 row_mask:0xf bank_mask:0xf
    v_cndmask_b32_dpp v87, v87, v87, vcc wave_shr:1 row_mask:0xf bank_mask:0xf
    s_andn2_b64 s[82:83], s[82:83], s[52:53]
    v_cndmask_b32_dpp v7, v7, v7, vcc wave_shr:1 row_mask:0xf bank_mask:0xf
    s_mov_b64 exec, s[50:51]
    s_cbranch_scc0 L2_d119
    s_mov_b64 exec, s[82:83]
    s_nop 1
    v_mfma_f32_4x4x4_16b_bf16 v[88:91], v[12:13], v[84:85], 0
    s_nop 1
    v_mfma_f32_4x4x4_16b_bf16 v[88:91], v[10:11], v[86:87], v[88:91]
    s_nop 4
    v_cvt_pk_bf16_f32 v88, v88, v89
    v_cvt_pk_bf16_f32 v89, v90, v91
    ds_pk_add_bf16 v7, v88 offset:65408
    ds_pk_add_bf16 v7, v89 offset:65412
    s_mov_b64 exec, s[50:51]
    s_branch L2_d119
L2_c120:
    s_lshl_b64 s[52:53], s[82:83], 1
    s_andn2_b64 s[52:53], s[52:53], s[80:81]
    s_andn2_b64 s[52:53], s[52:53], s[54:55]
    s_or_b64 s[80:81], s[80:81], s[52:53]
    s_not_b64 vcc, s[52:53]
    s_mov_b64 exec, -1
    v_cndmask_b32_dpp v84, v84, v84, vcc wave_shr:1 row_mask:0xf bank_mask:0xf
    v_cndmask_b32_dpp v85, v85, v85, vcc wave_shr:1 row_mask:0xf bank_mask:0xf
    s_lshr_b64 s[52:53], s[52:53], 1
    v_cndmask_b32_dpp v86, v86, v86, vcc wave_shr:1 row_mask:0xf bank_mask:0xf
    v_cndmask_b32_dpp v87, v87, v87, vcc wave_shr:1 row_mask:0xf bank_mask:0xf
    s_andn2_b64 s[82:83], s[82:83], s[52:53]
    v_cndmask_b32_dpp v7, v7, v7, vcc wave_shr:1 row_mask:0xf bank_mask:0xf
    s_mov_b64 exec, s[54:55]
    s_cbranch_scc0 L2_d120
    s_mov_b64 exec, s[82:83]
    s_nop 1
    v_mfma_f32_4x4x4_16b_bf16 v[88:91], v[12:13], v[84:85], 0
    s_nop 1
    v_mfma_f32_4x4x4_16b_bf16 v[88:91], v[10:11], v[86:87], v[88:91]
    s_nop 4
    v_cvt_pk_bf16_f32 v88, v88, v89
    v_cvt_pk_bf16_f32 v89, v90, v91
    ds_pk_add_bf16 v7, v88 offset:65408
    ds_pk_add_bf16 v7, v89 offset:65412
    s_mov_b64 exec, s[54:55]
    s_branch L2_d120
L2_c121:
    s_lshl_b64 s[52:53], s[82:83], 1
    s_andn2_b64 s[52:53], s[52:53], s[80:81]
    s_andn2_b64 s[52:53], s[52:53], s[50:51]
    s_or_b64 s[80:81], s[80:81], s[52:53]
    s_not_b64 vcc, s[52:53]
    s_mov_b64 exec, -1
    v_cndmask_b32_dpp v84, v84, v84, vcc wave_shr:1 row_mask:0xf bank_mask:0xf
    v_cndmask_b32_dpp v85, v85, v85, vcc wave_shr:1 row_mask:0xf bank_mask:0xf
    s_lshr_b64 s[52:53], s[52:53], 1
    v_cndmask_b32_dpp v86, v86, v86, vcc wave_shr:1 row_mask:0xf bank_mask:0xf
    v_cndmask_b32_dpp v87, v87, v87, vcc wave_shr:1 row_mask:0xf bank_mask:0xf
    s_andn2_b64 s[82:83], s[82:83], s[52:53]
    v_cndmask_b32_dpp v7, v7, v7, vcc wave_shr:1 row_mask:0xf bank_mask:0xf
    s_mov_b64 exec, s[50:51]
    s_cbranch_scc0 L2_d121
    s_mov_b64 exec, s[82:83]
    s_nop 1
    v_mfma_f32_4x4x4_16b_bf16 v[88:91], v[12:13], v[84:85], 0
    s_nop 1
    v_mfma_f32_4x4x4_16b_bf16 v[88:91], v[10:11], v[86:87], v[88:91]
    s_nop 4
    v_cvt_pk_bf16_f32 v88, v88, v89
    v_cvt_pk_bf16_f32 v89, v90, v91
    ds_pk_add_bf16 v7, v88 offset:65408
    ds_pk_add_bf16 v7, v89 offset:65412
    s_mov_b64 exec, s[50:51]
    s_branch L2_d121
L2_c122:
    s_lshl_b64 s[52:53], s[82:83], 1
    s_andn2_b64 s[52:53], s[52:53], s[80:81]
    s_andn2_b64 s[52:53], s[52:53], s[54:55]
    s_or_b64 s[80:81], s[80:81], s[52:53]
    s_not_b64 vcc, s[52:53]
    s_mov_b64 exec, -1
    v_cndmask_b32_dpp v84, v84, v84, vcc wave_shr:1 row_mask:0xf bank_mask:0xf
    v_cndmask_b32_dpp v85, v85, v85, vcc wave_shr:1 row_mask:0xf bank_mask:0xf
    s_lshr_b64 s[52:53], s[52:53], 1
    v_cndmask_b32_dpp v86, v86, v86, vcc wave_shr:1 row_mask:0xf bank_mask:0xf
    v_cndmask_b32_dpp v87, v87, v87, vcc wave_shr:1 row_mask:0xf bank_mask:0xf
    s_andn2_b64 s[82:83], s[82:83], s[52:53]
    v_cndmask_b32_dpp v7, v7, v7, vcc wave_shr:1 row_mask:0xf bank_mask:0xf
    s_mov_b64 exec, s[54:55]
    s_cbranch_scc0 L2_d122
    s_mov_b64 exec, s[82:83]
    s_nop 1
    v_mfma_f32_4x4x4_16b_bf16 v[88:91], v[12:13], v[84:85], 0
    s_nop 1
    v_mfma_f32_4x4x4_16b_bf16 v[88:91], v[10:11], v[86:87], v[88:91]
    s_nop 4
    v_cvt_pk_bf16_f32 v88, v88, v89
    v_cvt_pk_bf16_f32 v89, v90, v91
    ds_pk_add_bf16 v7, v88 offset:65408
    ds_pk_add_bf16 v7, v89 offset:65412
    s_mov_b64 exec, s[54:55]
    s_branch L2_d122
L2_c123:
    s_lshl_b64 s[52:53], s[82:83], 1
    s_andn2_b64 s[52:53], s[52:53], s[80:81]
    s_andn2_b64 s[52:53], s[52:53], s[50:51]
    s_or_b64 s[80:81], s[80:81], s[52:53]
    s_not_b64 vcc, s[52:53]
    s_mov_b64 exec, -1
    v_cndmask_b32_dpp v84, v84, v84, vcc wave_shr:1 row_mask:0xf bank_mask:0xf
    v_cndmask_b32_dpp v85, v85, v85, vcc wave_shr:1 row_mask:0xf bank_mask:0xf
    s_lshr_b64 s[52:53], s[52:53], 1
    v_cndmask_b32_dpp v86, v86, v86, vcc wave_shr:1 row_mask:0xf bank_mask:0xf
    v_cndmask_b32_dpp v87, v87, v87, vcc wave_shr:1 row_mask:0xf bank_mask:0xf
    s_andn2_b64 s[82:83], s[82:83], s[52:53]
    v_cndmask_b32_dpp v7, v7, v7, vcc wave_shr:1 row_mask:0xf bank_mask:0xf
    s_mov_b64 exec, s[50:51]
    s_cbranch_scc0 L2_d123
    s_mov_b64 exec, s[82:83]
    s_nop 1
    v_mfma_f32_4x4x4_16b_bf16 v[88:91], v[12:13], v[84:85], 0
    s_nop 1
    v_mfma_f32_4x4x4_16b_bf16 v[88:91], v[10:11], v[86:87], v[88:91]
    s_nop 4
    v_cvt_pk_bf16_f32 v88, v88, v89
    v_cvt_pk_bf16_f32 v89, v90, v91
    ds_pk_add_bf16 v7, v88 offset:65408
    ds_pk_add_bf16 v7, v89 offset:65412
    s_mov_b64 exec, s[50:51]
    s_branch L2_d123
L2_c124:
    s_lshl_b64 s[52:53], s[82:83], 1
    s_andn2_b64 s[52:53], s[52:53], s[80:81]
    s_andn2_b64 s[52:53], s[52:53], s[54:55]
    s_or_b64 s[80:81], s[80:81], s[52:53]
    s_not_b64 vcc, s[52:53]
    s_mov_b64 exec, -1
    v_cndmask_b32_dpp v84, v84, v84, vcc wave_shr:1 row_mask:0xf bank_mask:0xf
    v_cndmask_b32_dpp v85, v85, v85, vcc wave_shr:1 row_mask:0xf bank_mask:0xf
    s_lshr_b64 s[52:53], s[52:53], 1
    v_cndmask_b32_dpp v86, v86, v86, vcc wave_shr:1 row_mask:0xf bank_mask:0xf
    v_cndmask_b32_dpp v87, v87, v87, vcc wave_shr:1 row_mask:0xf bank_mask:0xf
    s_andn2_b64 s[82:83], s[82:83], s[52:53]
    v_cndmask_b32_dpp v7, v7, v7, vcc wave_shr:1 row_mask:0xf bank_mask:0xf
    s_mov_b64 exec, s[54:55]
    s_cbranch_scc0 L2_d124
    s_mov_b64 exec, s[82:83]
    s_nop 1
    v_mfma_f32_4x4x4_16b_bf16 v[88:91], v[12:13], v[84:85], 0
    s_nop 1
    v_mfma_f32_4x4x4_16b_bf16 v[88:91], v[10:11], v[86:87], v[88:91]
    s_nop 4
    v_cvt_pk_bf16_f32 v88, v88, v89
    v_cvt_pk_bf16_f32 v89, v90, v91
    ds_pk_add_bf16 v7, v88 offset:65408
    ds_pk_add_bf16 v7, v89 offset:65412
    s_mov_b64 exec, s[54:55]
    s_branch L2_d124
L2_c125:
    s_lshl_b64 s[52:53], s[82:83], 1
    s_andn2_b64 s[52:53], s[52:53], s[80:81]
    s_andn2_b64 s[52:53], s[52:53], s[50:51]
    s_or_b64 s[80:81], s[80:81], s[52:53]
    s_not_b64 vcc, s[52:53]
    s_mov_b64 exec, -1
    v_cndmask_b32_dpp v84, v84, v84, vcc wave_shr:1 row_mask:0xf bank_mask:0xf
    v_cndmask_b32_dpp v85, v85, v85, vcc wave_shr:1 row_mask:0xf bank_mask:0xf
    s_lshr_b64 s[52:53], s[52:53], 1
    v_cndmask_b32_dpp v86, v86, v86, vcc wave_shr:1 row_mask:0xf bank_mask:0xf
    v_cndmask_b32_dpp v87, v87, v87, vcc wave_shr:1 row_mask:0xf bank_mask:0xf
    s_andn2_b64 s[82:83], s[82:83], s[52:53]
    v_cndmask_b32_dpp v7, v7, v7, vcc wave_shr:1 row_mask:0xf bank_mask:0xf
    s_mov_b64 exec, s[50:51]
    s_cbranch_scc0 L2_d125
    s_mov_b64 exec, s[82:83]
    s_nop 1
    v_mfma_f32_4x4x4_16b_bf16 v[88:91], v[12:13], v[84:85], 0
    s_nop 1
    v_mfma_f32_4x4x4_16b_bf16 v[88:91], v[10:11], v[86:87], v[88:91]
    s_nop 4
    v_cvt_pk_bf16_f32 v88, v88, v89
    v_cvt_pk_bf16_f32 v89, v90, v91
    ds_pk_add_bf16 v7, v88 offset:65408
    ds_pk_add_bf16 v7, v89 offset:65412
    s_mov_b64 exec, s[50:51]
    s_branch L2_d125
L2_c126:
    s_lshl_b64 s[52:53], s[82:83], 1
    s_andn2_b64 s[52:53], s[52:53], s[80:81]
    s_andn2_b64 s[52:53], s[52:53], s[54:55]
    s_or_b64 s[80:81], s[80:81], s[52:53]
    s_not_b64 vcc, s[52:53]
    s_mov_b64 exec, -1
    v_cndmask_b32_dpp v84, v84, v84, vcc wave_shr:1 row_mask:0xf bank_mask:0xf
    v_cndmask_b32_dpp v85, v85, v85, vcc wave_shr:1 row_mask:0xf bank_mask:0xf
    s_lshr_b64 s[52:53], s[52:53], 1
    v_cndmask_b32_dpp v86, v86, v86, vcc wave_shr:1 row_mask:0xf bank_mask:0xf
    v_cndmask_b32_dpp v87, v87, v87, vcc wave_shr:1 row_mask:0xf bank_mask:0xf
    s_andn2_b64 s[82:83], s[82:83], s[52:53]
    v_cndmask_b32_dpp v7, v7, v7, vcc wave_shr:1 row_mask:0xf bank_mask:0xf
    s_mov_b64 exec, s[54:55]
    s_cbranch_scc0 L2_d126
    s_mov_b64 exec, s[82:83]
    s_nop 1
    v_mfma_f32_4x4x4_16b_bf16 v[88:91], v[12:13], v[84:85], 0
    s_nop 1
    v_mfma_f32_4x4x4_16b_bf16 v[88:91], v[10:11], v[86:87], v[88:91]
    s_nop 4
    v_cvt_pk_bf16_f32 v88, v88, v89
    v_cvt_pk_bf16_f32 v89, v90, v91
    ds_pk_add_bf16 v7, v88 offset:65408
    ds_pk_add_bf16 v7, v89 offset:65412
    s_mov_b64 exec, s[54:55]
    s_branch L2_d126
L2_c127:
    s_lshl_b64 s[52:53], s[82:83], 1
    s_andn2_b64 s[52:53], s[52:53], s[80:81]
    s_andn2_b64 s[52:53], s[52:53], s[50:51]
    s_or_b64 s[80:81], s[80:81], s[52:53]
    s_not_b64 vcc, s[52:53]
    s_mov_b64 exec, -1
    v_cndmask_b32_dpp v84, v84, v84, vcc wave_shr:1 row_mask:0xf bank_mask:0xf
    v_cndmask_b32_dpp v85, v85, v85, vcc wave_shr:1 row_mask:0xf bank_mask:0xf
    s_lshr_b64 s[52:53], s[52:53], 1
    v_cndmask_b32_dpp v86, v86, v86, vcc wave_shr:1 row_mask:0xf bank_mask:0xf
    v_cndmask_b32_dpp v87, v87, v87, vcc wave_shr:1 row_mask:0xf bank_mask:0xf
    s_andn2_b64 s[82:83], s[82:83], s[52:53]
    v_cndmask_b32_dpp v7, v7, v7, vcc wave_shr:1 row_mask:0xf bank_mask:0xf
    s_mov_b64 exec, s[50:51]
    s_cbranch_scc0 L2_d127
    s_mov_b64 exec, s[82:83]
    s_nop 1
    v_mfma_f32_4x4x4_16b_bf16 v[88:91], v[12:13], v[84:85], 0
    s_nop 1
    v_mfma_f32_4x4x4_16b_bf16 v[88:91], v[10:11], v[86:87], v[88:91]
    s_nop 4
    v_cvt_pk_bf16_f32 v88, v88, v89
    v_cvt_pk_bf16_f32 v89, v90, v91
    ds_pk_add_bf16 v7, v88 offset:65408
    ds_pk_add_bf16 v7, v89 offset:65412
    s_mov_b64 exec, s[50:51]
    s_branch L2_d127
L2_c128:
    s_lshl_b64 s[52:53], s[82:83], 1
    s_andn2_b64 s[52:53], s[52:53], s[80:81]
    s_andn2_b64 s[52:53], s[52:53], s[54:55]
    s_or_b64 s[80:81], s[80:81], s[52:53]
    s_not_b64 vcc, s[52:53]
    s_mov_b64 exec, -1
    v_cndmask_b32_dpp v84, v84, v84, vcc wave_shr:1 row_mask:0xf bank_mask:0xf
    v_cndmask_b32_dpp v85, v85, v85, vcc wave_shr:1 row_mask:0xf bank_mask:0xf
    s_lshr_b64 s[52:53], s[52:53], 1
    v_cndmask_b32_dpp v86, v86, v86, vcc wave_shr:1 row_mask:0xf bank_mask:0xf
    v_cndmask_b32_dpp v87, v87, v87, vcc wave_shr:1 row_mask:0xf bank_mask:0xf
    s_andn2_b64 s[82:83], s[82:83], s[52:53]
    v_cndmask_b32_dpp v7, v7, v7, vcc wave_shr:1 row_mask:0xf bank_mask:0xf
    s_mov_b64 exec, s[54:55]
    s_cbranch_scc0 L2_d128
    s_mov_b64 exec, s[82:83]
    s_nop 1
    v_mfma_f32_4x4x4_16b_bf16 v[88:91], v[12:13], v[84:85], 0
    s_nop 1
    v_mfma_f32_4x4x4_16b_bf16 v[88:91], v[10:11], v[86:87], v[88:91]
    s_nop 4
    v_cvt_pk_bf16_f32 v88, v88, v89
    v_cvt_pk_bf16_f32 v89, v90, v91
    ds_pk_add_bf16 v7, v88 offset:65408
    ds_pk_add_bf16 v7, v89 offset:65412
    s_mov_b64 exec, s[54:55]
    s_branch L2_d128
L2_c129:
    s_lshl_b64 s[52:53], s[82:83], 1
    s_andn2_b64 s[52:53], s[52:53], s[80:81]
    s_andn2_b64 s[52:53], s[52:53], s[50:51]
    s_or_b64 s[80:81], s[80:81], s[52:53]
    s_not_b64 vcc, s[52:53]
    s_mov_b64 exec, -1
    v_cndmask_b32_dpp v84, v84, v84, vcc wave_shr:1 row_mask:0xf bank_mask:0xf
    v_cndmask_b32_dpp v85, v85, v85, vcc wave_shr:1 row_mask:0xf bank_mask:0xf
    s_lshr_b64 s[52:53], s[52:53], 1
    v_cndmask_b32_dpp v86, v86, v86, vcc wave_shr:1 row_mask:0xf bank_mask:0xf
    v_cndmask_b32_dpp v87, v87, v87, vcc wave_shr:1 row_mask:0xf bank_mask:0xf
    s_andn2_b64 s[82:83], s[82:83], s[52:53]
    v_cndmask_b32_dpp v7, v7, v7, vcc wave_shr:1 row_mask:0xf bank_mask:0xf
    s_mov_b64 exec, s[50:51]
    s_cbranch_scc0 L2_d129
    s_mov_b64 exec, s[82:83]
    s_nop 1
    v_mfma_f32_4x4x4_16b_bf16 v[88:91], v[12:13], v[84:85], 0
    s_nop 1
    v_mfma_f32_4x4x4_16b_bf16 v[88:91], v[10:11], v[86:87], v[88:91]
    s_nop 4
    v_cvt_pk_bf16_f32 v88, v88, v89
    v_cvt_pk_bf16_f32 v89, v90, v91
    ds_pk_add_bf16 v7, v88 offset:65408
    ds_pk_add_bf16 v7, v89 offset:65412
    s_mov_b64 exec, s[50:51]
    s_branch L2_d129
L2_c130:
    s_lshl_b64 s[52:53], s[82:83], 1
    s_andn2_b64 s[52:53], s[52:53], s[80:81]
    s_andn2_b64 s[52:53], s[52:53], s[54:55]
    s_or_b64 s[80:81], s[80:81], s[52:53]
    s_not_b64 vcc, s[52:53]
    s_mov_b64 exec, -1
    v_cndmask_b32_dpp v84, v84, v84, vcc wave_shr:1 row_mask:0xf bank_mask:0xf
    v_cndmask_b32_dpp v85, v85, v85, vcc wave_shr:1 row_mask:0xf bank_mask:0xf
    s_lshr_b64 s[52:53], s[52:53], 1
    v_cndmask_b32_dpp v86, v86, v86, vcc wave_shr:1 row_mask:0xf bank_mask:0xf
    v_cndmask_b32_dpp v87, v87, v87, vcc wave_shr:1 row_mask:0xf bank_mask:0xf
    s_andn2_b64 s[82:83], s[82:83], s[52:53]
    v_cndmask_b32_dpp v7, v7, v7, vcc wave_shr:1 row_mask:0xf bank_mask:0xf
    s_mov_b64 exec, s[54:55]
    s_cbranch_scc0 L2_d130
    s_mov_b64 exec, s[82:83]
    s_nop 1
    v_mfma_f32_4x4x4_16b_bf16 v[88:91], v[12:13], v[84:85], 0
    s_nop 1
    v_mfma_f32_4x4x4_16b_bf16 v[88:91], v[10:11], v[86:87], v[88:91]
    s_nop 4
    v_cvt_pk_bf16_f32 v88, v88, v89
    v_cvt_pk_bf16_f32 v89, v90, v91
    ds_pk_add_bf16 v7, v88 offset:65408
    ds_pk_add_bf16 v7, v89 offset:65412
    s_mov_b64 exec, s[54:55]
    s_branch L2_d130
L2_c131:
    s_lshl_b64 s[52:53], s[82:83], 1
    s_andn2_b64 s[52:53], s[52:53], s[80:81]
    s_andn2_b64 s[52:53], s[52:53], s[50:51]
    s_or_b64 s[80:81], s[80:81], s[52:53]
    s_not_b64 vcc, s[52:53]
    s_mov_b64 exec, -1
    v_cndmask_b32_dpp v84, v84, v84, vcc wave_shr:1 row_mask:0xf bank_mask:0xf
    v_cndmask_b32_dpp v85, v85, v85, vcc wave_shr:1 row_mask:0xf bank_mask:0xf
    s_lshr_b64 s[52:53], s[52:53], 1
    v_cndmask_b32_dpp v86, v86, v86, vcc wave_shr:1 row_mask:0xf bank_mask:0xf
    v_cndmask_b32_dpp v87, v87, v87, vcc wave_shr:1 row_mask:0xf bank_mask:0xf
    s_andn2_b64 s[82:83], s[82:83], s[52:53]
    v_cndmask_b32_dpp v7, v7, v7, vcc wave_shr:1 row_mask:0xf bank_mask:0xf
    s_mov_b64 exec, s[50:51]
    s_cbranch_scc0 L2_d131
    s_mov_b64 exec, s[82:83]
    s_nop 1
    v_mfma_f32_4x4x4_16b_bf16 v[88:91], v[12:13], v[84:85], 0
    s_nop 1
    v_mfma_f32_4x4x4_16b_bf16 v[88:91], v[10:11], v[86:87], v[88:91]
    s_nop 4
    v_cvt_pk_bf16_f32 v88, v88, v89
    v_cvt_pk_bf16_f32 v89, v90, v91
    ds_pk_add_bf16 v7, v88 offset:65408
    ds_pk_add_bf16 v7, v89 offset:65412
    s_mov_b64 exec, s[50:51]
    s_branch L2_d131
L2_c132:
    s_lshl_b64 s[52:53], s[82:83], 1
    s_andn2_b64 s[52:53], s[52:53], s[80:81]
    s_andn2_b64 s[52:53], s[52:53], s[54:55]
    s_or_b64 s[80:81], s[80:81], s[52:53]
    s_not_b64 vcc, s[52:53]
    s_mov_b64 exec, -1
    v_cndmask_b32_dpp v84, v84, v84, vcc wave_shr:1 row_mask:0xf bank_mask:0xf
    v_cndmask_b32_dpp v85, v85, v85, vcc wave_shr:1 row_mask:0xf bank_mask:0xf
    s_lshr_b64 s[52:53], s[52:53], 1
    v_cndmask_b32_dpp v86, v86, v86, vcc wave_shr:1 row_mask:0xf bank_mask:0xf
    v_cndmask_b32_dpp v87, v87, v87, vcc wave_shr:1 row_mask:0xf bank_mask:0xf
    s_andn2_b64 s[82:83], s[82:83], s[52:53]
    v_cndmask_b32_dpp v7, v7, v7, vcc wave_shr:1 row_mask:0xf bank_mask:0xf
    s_mov_b64 exec, s[54:55]
    s_cbranch_scc0 L2_d132
    s_mov_b64 exec, s[82:83]
    s_nop 1
    v_mfma_f32_4x4x4_16b_bf16 v[88:91], v[12:13], v[84:85], 0
    s_nop 1
    v_mfma_f32_4x4x4_16b_bf16 v[88:91], v[10:11], v[86:87], v[88:91]
    s_nop 4
    v_cvt_pk_bf16_f32 v88, v88, v89
    v_cvt_pk_bf16_f32 v89, v90, v91
    ds_pk_add_bf16 v7, v88 offset:65408
    ds_pk_add_bf16 v7, v89 offset:65412
    s_mov_b64 exec, s[54:55]
    s_branch L2_d132
L2_c133:
    s_lshl_b64 s[52:53], s[82:83], 1
    s_andn2_b64 s[52:53], s[52:53], s[80:81]
    s_andn2_b64 s[52:53], s[52:53], s[50:51]
    s_or_b64 s[80:81], s[80:81], s[52:53]
    s_not_b64 vcc, s[52:53]
    s_mov_b64 exec, -1
    v_cndmask_b32_dpp v84, v84, v84, vcc wave_shr:1 row_mask:0xf bank_mask:0xf
    v_cndmask_b32_dpp v85, v85, v85, vcc wave_shr:1 row_mask:0xf bank_mask:0xf
    s_lshr_b64 s[52:53], s[52:53], 1
    v_cndmask_b32_dpp v86, v86, v86, vcc wave_shr:1 row_mask:0xf bank_mask:0xf
    v_cndmask_b32_dpp v87, v87, v87, vcc wave_shr:1 row_mask:0xf bank_mask:0xf
    s_andn2_b64 s[82:83], s[82:83], s[52:53]
    v_cndmask_b32_dpp v7, v7, v7, vcc wave_shr:1 row_mask:0xf bank_mask:0xf
    s_mov_b64 exec, s[50:51]
    s_cbranch_scc0 L2_d133
    s_mov_b64 exec, s[82:83]
    s_nop 1
    v_mfma_f32_4x4x4_16b_bf16 v[88:91], v[12:13], v[84:85], 0
    s_nop 1
    v_mfma_f32_4x4x4_16b_bf16 v[88:91], v[10:11], v[86:87], v[88:91]
    s_nop 4
    v_cvt_pk_bf16_f32 v88, v88, v89
    v_cvt_pk_bf16_f32 v89, v90, v91
    ds_pk_add_bf16 v7, v88 offset:65408
    ds_pk_add_bf16 v7, v89 offset:65412
    s_mov_b64 exec, s[50:51]
    s_branch L2_d133
L2_c134:
    s_lshl_b64 s[52:53], s[82:83], 1
    s_andn2_b64 s[52:53], s[52:53], s[80:81]
    s_andn2_b64 s[52:53], s[52:53], s[54:55]
    s_or_b64 s[80:81], s[80:81], s[52:53]
    s_not_b64 vcc, s[52:53]
    s_mov_b64 exec, -1
    v_cndmask_b32_dpp v84, v84, v84, vcc wave_shr:1 row_mask:0xf bank_mask:0xf
    v_cndmask_b32_dpp v85, v85, v85, vcc wave_shr:1 row_mask:0xf bank_mask:0xf
    s_lshr_b64 s[52:53], s[52:53], 1
    v_cndmask_b32_dpp v86, v86, v86, vcc wave_shr:1 row_mask:0xf bank_mask:0xf
    v_cndmask_b32_dpp v87, v87, v87, vcc wave_shr:1 row_mask:0xf bank_mask:0xf
    s_andn2_b64 s[82:83], s[82:83], s[52:53]
    v_cndmask_b32_dpp v7, v7, v7, vcc wave_shr:1 row_mask:0xf bank_mask:0xf
    s_mov_b64 exec, s[54:55]
    s_cbranch_scc0 L2_d134
    s_mov_b64 exec, s[82:83]
    s_nop 1
    v_mfma_f32_4x4x4_16b_bf16 v[88:91], v[12:13], v[84:85], 0
    s_nop 1
    v_mfma_f32_4x4x4_16b_bf16 v[88:91], v[10:11], v[86:87], v[88:91]
    s_nop 4
    v_cvt_pk_bf16_f32 v88, v88, v89
    v_cvt_pk_bf16_f32 v89, v90, v91
    ds_pk_add_bf16 v7, v88 offset:65408
    ds_pk_add_bf16 v7, v89 offset:65412
    s_mov_b64 exec, s[54:55]
    s_branch L2_d134
L2_c135:
    s_lshl_b64 s[52:53], s[82:83], 1
    s_andn2_b64 s[52:53], s[52:53], s[80:81]
    s_andn2_b64 s[52:53], s[52:53], s[50:51]
    s_or_b64 s[80:81], s[80:81], s[52:53]
    s_not_b64 vcc, s[52:53]
    s_mov_b64 exec, -1
    v_cndmask_b32_dpp v84, v84, v84, vcc wave_shr:1 row_mask:0xf bank_mask:0xf
    v_cndmask_b32_dpp v85, v85, v85, vcc wave_shr:1 row_mask:0xf bank_mask:0xf
    s_lshr_b64 s[52:53], s[52:53], 1
    v_cndmask_b32_dpp v86, v86, v86, vcc wave_shr:1 row_mask:0xf bank_mask:0xf
    v_cndmask_b32_dpp v87, v87, v87, vcc wave_shr:1 row_mask:0xf bank_mask:0xf
    s_andn2_b64 s[82:83], s[82:83], s[52:53]
    v_cndmask_b32_dpp v7, v7, v7, vcc wave_shr:1 row_mask:0xf bank_mask:0xf
    s_mov_b64 exec, s[50:51]
    s_cbranch_scc0 L2_d135
    s_mov_b64 exec, s[82:83]
    s_nop 1
    v_mfma_f32_4x4x4_16b_bf16 v[88:91], v[12:13], v[84:85], 0
    s_nop 1
    v_mfma_f32_4x4x4_16b_bf16 v[88:91], v[10:11], v[86:87], v[88:91]
    s_nop 4
    v_cvt_pk_bf16_f32 v88, v88, v89
    v_cvt_pk_bf16_f32 v89, v90, v91
    ds_pk_add_bf16 v7, v88 offset:65408
    ds_pk_add_bf16 v7, v89 offset:65412
    s_mov_b64 exec, s[50:51]
    s_branch L2_d135
L2_c136:
    s_lshl_b64 s[52:53], s[82:83], 1
    s_andn2_b64 s[52:53], s[52:53], s[80:81]
    s_andn2_b64 s[52:53], s[52:53], s[54:55]
    s_or_b64 s[80:81], s[80:81], s[52:53]
    s_not_b64 vcc, s[52:53]
    s_mov_b64 exec, -1
    v_cndmask_b32_dpp v84, v84, v84, vcc wave_shr:1 row_mask:0xf bank_mask:0xf
    v_cndmask_b32_dpp v85, v85, v85, vcc wave_shr:1 row_mask:0xf bank_mask:0xf
    s_lshr_b64 s[52:53], s[52:53], 1
    v_cndmask_b32_dpp v86, v86, v86, vcc wave_shr:1 row_mask:0xf bank_mask:0xf
    v_cndmask_b32_dpp v87, v87, v87, vcc wave_shr:1 row_mask:0xf bank_mask:0xf
    s_andn2_b64 s[82:83], s[82:83], s[52:53]
    v_cndmask_b32_dpp v7, v7, v7, vcc wave_shr:1 row_mask:0xf bank_mask:0xf
    s_mov_b64 exec, s[54:55]
    s_cbranch_scc0 L2_d136
    s_mov_b64 exec, s[82:83]
    s_nop 1
    v_mfma_f32_4x4x4_16b_bf16 v[88:91], v[12:13], v[84:85], 0
    s_nop 1
    v_mfma_f32_4x4x4_16b_bf16 v[88:91], v[10:11], v[86:87], v[88:91]
    s_nop 4
    v_cvt_pk_bf16_f32 v88, v88, v89
    v_cvt_pk_bf16_f32 v89, v90, v91
    ds_pk_add_bf16 v7, v88 offset:65408
    ds_pk_add_bf16 v7, v89 offset:65412
    s_mov_b64 exec, s[54:55]
    s_branch L2_d136
L2_c137:
    s_lshl_b64 s[52:53], s[82:83], 1
    s_andn2_b64 s[52:53], s[52:53], s[80:81]
    s_andn2_b64 s[52:53], s[52:53], s[50:51]
    s_or_b64 s[80:81], s[80:81], s[52:53]
    s_not_b64 vcc, s[52:53]
    s_mov_b64 exec, -1
    v_cndmask_b32_dpp v84, v84, v84, vcc wave_shr:1 row_mask:0xf bank_mask:0xf
    v_cndmask_b32_dpp v85, v85, v85, vcc wave_shr:1 row_mask:0xf bank_mask:0xf
    s_lshr_b64 s[52:53], s[52:53], 1
    v_cndmask_b32_dpp v86, v86, v86, vcc wave_shr:1 row_mask:0xf bank_mask:0xf
    v_cndmask_b32_dpp v87, v87, v87, vcc wave_shr:1 row_mask:0xf bank_mask:0xf
    s_andn2_b64 s[82:83], s[82:83], s[52:53]
    v_cndmask_b32_dpp v7, v7, v7, vcc wave_shr:1 row_mask:0xf bank_mask:0xf
    s_mov_b64 exec, s[50:51]
    s_cbranch_scc0 L2_d137
    s_mov_b64 exec, s[82:83]
    s_nop 1
    v_mfma_f32_4x4x4_16b_bf16 v[88:91], v[12:13], v[84:85], 0
    s_nop 1
    v_mfma_f32_4x4x4_16b_bf16 v[88:91], v[10:11], v[86:87], v[88:91]
    s_nop 4
    v_cvt_pk_bf16_f32 v88, v88, v89
    v_cvt_pk_bf16_f32 v89, v90, v91
    ds_pk_add_bf16 v7, v88 offset:65408
    ds_pk_add_bf16 v7, v89 offset:65412
    s_mov_b64 exec, s[50:51]
    s_branch L2_d137
L2_c138:
    s_lshl_b64 s[52:53], s[82:83], 1
    s_andn2_b64 s[52:53], s[52:53], s[80:81]
    s_andn2_b64 s[52:53], s[52:53], s[54:55]
    s_or_b64 s[80:81], s[80:81], s[52:53]
    s_not_b64 vcc, s[52:53]
    s_mov_b64 exec, -1
    v_cndmask_b32_dpp v84, v84, v84, vcc wave_shr:1 row_mask:0xf bank_mask:0xf
    v_cndmask_b32_dpp v85, v85, v85, vcc wave_shr:1 row_mask:0xf bank_mask:0xf
    s_lshr_b64 s[52:53], s[52:53], 1
    v_cndmask_b32_dpp v86, v86, v86, vcc wave_shr:1 row_mask:0xf bank_mask:0xf
    v_cndmask_b32_dpp v87, v87, v87, vcc wave_shr:1 row_mask:0xf bank_mask:0xf
    s_andn2_b64 s[82:83], s[82:83], s[52:53]
    v_cndmask_b32_dpp v7, v7, v7, vcc wave_shr:1 row_mask:0xf bank_mask:0xf
    s_mov_b64 exec, s[54:55]
    s_cbranch_scc0 L2_d138
    s_mov_b64 exec, s[82:83]
    s_nop 1
    v_mfma_f32_4x4x4_16b_bf16 v[88:91], v[12:13], v[84:85], 0
    s_nop 1
    v_mfma_f32_4x4x4_16b_bf16 v[88:91], v[10:11], v[86:87], v[88:91]
    s_nop 4
    v_cvt_pk_bf16_f32 v88, v88, v89
    v_cvt_pk_bf16_f32 v89, v90, v91
    ds_pk_add_bf16 v7, v88 offset:65408
    ds_pk_add_bf16 v7, v89 offset:65412
    s_mov_b64 exec, s[54:55]
    s_branch L2_d138
L2_c139:
    s_lshl_b64 s[52:53], s[82:83], 1
    s_andn2_b64 s[52:53], s[52:53], s[80:81]
    s_andn2_b64 s[52:53], s[52:53], s[50:51]
    s_or_b64 s[80:81], s[80:81], s[52:53]
    s_not_b64 vcc, s[52:53]
    s_mov_b64 exec, -1
    v_cndmask_b32_dpp v84, v84, v84, vcc wave_shr:1 row_mask:0xf bank_mask:0xf
    v_cndmask_b32_dpp v85, v85, v85, vcc wave_shr:1 row_mask:0xf bank_mask:0xf
    s_lshr_b64 s[52:53], s[52:53], 1
    v_cndmask_b32_dpp v86, v86, v86, vcc wave_shr:1 row_mask:0xf bank_mask:0xf
    v_cndmask_b32_dpp v87, v87, v87, vcc wave_shr:1 row_mask:0xf bank_mask:0xf
    s_andn2_b64 s[82:83], s[82:83], s[52:53]
    v_cndmask_b32_dpp v7, v7, v7, vcc wave_shr:1 row_mask:0xf bank_mask:0xf
    s_mov_b64 exec, s[50:51]
    s_cbranch_scc0 L2_d139
    s_mov_b64 exec, s[82:83]
    s_nop 1
    v_mfma_f32_4x4x4_16b_bf16 v[88:91], v[12:13], v[84:85], 0
    s_nop 1
    v_mfma_f32_4x4x4_16b_bf16 v[88:91], v[10:11], v[86:87], v[88:91]
    s_nop 4
    v_cvt_pk_bf16_f32 v88, v88, v89
    v_cvt_pk_bf16_f32 v89, v90, v91
    ds_pk_add_bf16 v7, v88 offset:65408
    ds_pk_add_bf16 v7, v89 offset:65412
    s_mov_b64 exec, s[50:51]
    s_branch L2_d139
L2_c140:
    s_lshl_b64 s[52:53], s[82:83], 1
    s_andn2_b64 s[52:53], s[52:53], s[80:81]
    s_andn2_b64 s[52:53], s[52:53], s[54:55]
    s_or_b64 s[80:81], s[80:81], s[52:53]
    s_not_b64 vcc, s[52:53]
    s_mov_b64 exec, -1
    v_cndmask_b32_dpp v84, v84, v84, vcc wave_shr:1 row_mask:0xf bank_mask:0xf
    v_cndmask_b32_dpp v85, v85, v85, vcc wave_shr:1 row_mask:0xf bank_mask:0xf
    s_lshr_b64 s[52:53], s[52:53], 1
    v_cndmask_b32_dpp v86, v86, v86, vcc wave_shr:1 row_mask:0xf bank_mask:0xf
    v_cndmask_b32_dpp v87, v87, v87, vcc wave_shr:1 row_mask:0xf bank_mask:0xf
    s_andn2_b64 s[82:83], s[82:83], s[52:53]
    v_cndmask_b32_dpp v7, v7, v7, vcc wave_shr:1 row_mask:0xf bank_mask:0xf
    s_mov_b64 exec, s[54:55]
    s_cbranch_scc0 L2_d140
    s_mov_b64 exec, s[82:83]
    s_nop 1
    v_mfma_f32_4x4x4_16b_bf16 v[88:91], v[12:13], v[84:85], 0
    s_nop 1
    v_mfma_f32_4x4x4_16b_bf16 v[88:91], v[10:11], v[86:87], v[88:91]
    s_nop 4
    v_cvt_pk_bf16_f32 v88, v88, v89
    v_cvt_pk_bf16_f32 v89, v90, v91
    ds_pk_add_bf16 v7, v88 offset:65408
    ds_pk_add_bf16 v7, v89 offset:65412
    s_mov_b64 exec, s[54:55]
    s_branch L2_d140
L2_c141:
    s_lshl_b64 s[52:53], s[82:83], 1
    s_andn2_b64 s[52:53], s[52:53], s[80:81]
    s_andn2_b64 s[52:53], s[52:53], s[50:51]
    s_or_b64 s[80:81], s[80:81], s[52:53]
    s_not_b64 vcc, s[52:53]
    s_mov_b64 exec, -1
    v_cndmask_b32_dpp v84, v84, v84, vcc wave_shr:1 row_mask:0xf bank_mask:0xf
    v_cndmask_b32_dpp v85, v85, v85, vcc wave_shr:1 row_mask:0xf bank_mask:0xf
    s_lshr_b64 s[52:53], s[52:53], 1
    v_cndmask_b32_dpp v86, v86, v86, vcc wave_shr:1 row_mask:0xf bank_mask:0xf
    v_cndmask_b32_dpp v87, v87, v87, vcc wave_shr:1 row_mask:0xf bank_mask:0xf
    s_andn2_b64 s[82:83], s[82:83], s[52:53]
    v_cndmask_b32_dpp v7, v7, v7, vcc wave_shr:1 row_mask:0xf bank_mask:0xf
    s_mov_b64 exec, s[50:51]
    s_cbranch_scc0 L2_d141
    s_mov_b64 exec, s[82:83]
    s_nop 1
    v_mfma_f32_4x4x4_16b_bf16 v[88:91], v[12:13], v[84:85], 0
    s_nop 1
    v_mfma_f32_4x4x4_16b_bf16 v[88:91], v[10:11], v[86:87], v[88:91]
    s_nop 4
    v_cvt_pk_bf16_f32 v88, v88, v89
    v_cvt_pk_bf16_f32 v89, v90, v91
    ds_pk_add_bf16 v7, v88 offset:65408
    ds_pk_add_bf16 v7, v89 offset:65412
    s_mov_b64 exec, s[50:51]
    s_branch L2_d141
L2_c142:
    s_lshl_b64 s[52:53], s[82:83], 1
    s_andn2_b64 s[52:53], s[52:53], s[80:81]
    s_andn2_b64 s[52:53], s[52:53], s[54:55]
    s_or_b64 s[80:81], s[80:81], s[52:53]
    s_not_b64 vcc, s[52:53]
    s_mov_b64 exec, -1
    v_cndmask_b32_dpp v84, v84, v84, vcc wave_shr:1 row_mask:0xf bank_mask:0xf
    v_cndmask_b32_dpp v85, v85, v85, vcc wave_shr:1 row_mask:0xf bank_mask:0xf
    s_lshr_b64 s[52:53], s[52:53], 1
    v_cndmask_b32_dpp v86, v86, v86, vcc wave_shr:1 row_mask:0xf bank_mask:0xf
    v_cndmask_b32_dpp v87, v87, v87, vcc wave_shr:1 row_mask:0xf bank_mask:0xf
    s_andn2_b64 s[82:83], s[82:83], s[52:53]
    v_cndmask_b32_dpp v7, v7, v7, vcc wave_shr:1 row_mask:0xf bank_mask:0xf
    s_mov_b64 exec, s[54:55]
    s_cbranch_scc0 L2_d142
    s_mov_b64 exec, s[82:83]
    s_nop 1
    v_mfma_f32_4x4x4_16b_bf16 v[88:91], v[12:13], v[84:85], 0
    s_nop 1
    v_mfma_f32_4x4x4_16b_bf16 v[88:91], v[10:11], v[86:87], v[88:91]
    s_nop 4
    v_cvt_pk_bf16_f32 v88, v88, v89
    v_cvt_pk_bf16_f32 v89, v90, v91
    ds_pk_add_bf16 v7, v88 offset:65408
    ds_pk_add_bf16 v7, v89 offset:65412
    s_mov_b64 exec, s[54:55]
    s_branch L2_d142
L2_c143:
    s_lshl_b64 s[52:53], s[82:83], 1
    s_andn2_b64 s[52:53], s[52:53], s[80:81]
    s_andn2_b64 s[52:53], s[52:53], s[50:51]
    s_or_b64 s[80:81], s[80:81], s[52:53]
    s_not_b64 vcc, s[52:53]
    s_mov_b64 exec, -1
    v_cndmask_b32_dpp v84, v84, v84, vcc wave_shr:1 row_mask:0xf bank_mask:0xf
    v_cndmask_b32_dpp v85, v85, v85, vcc wave_shr:1 row_mask:0xf bank_mask:0xf
    s_lshr_b64 s[52:53], s[52:53], 1
    v_cndmask_b32_dpp v86, v86, v86, vcc wave_shr:1 row_mask:0xf bank_mask:0xf
    v_cndmask_b32_dpp v87, v87, v87, vcc wave_shr:1 row_mask:0xf bank_mask:0xf
    s_andn2_b64 s[82:83], s[82:83], s[52:53]
    v_cndmask_b32_dpp v7, v7, v7, vcc wave_shr:1 row_mask:0xf bank_mask:0xf
    s_mov_b64 exec, s[50:51]
    s_cbranch_scc0 L2_d143
    s_mov_b64 exec, s[82:83]
    s_nop 1
    v_mfma_f32_4x4x4_16b_bf16 v[88:91], v[12:13], v[84:85], 0
    s_nop 1
    v_mfma_f32_4x4x4_16b_bf16 v[88:91], v[10:11], v[86:87], v[88:91]
    s_nop 4
    v_cvt_pk_bf16_f32 v88, v88, v89
    v_cvt_pk_bf16_f32 v89, v90, v91
    ds_pk_add_bf16 v7, v88 offset:65408
    ds_pk_add_bf16 v7, v89 offset:65412
    s_mov_b64 exec, s[50:51]
    s_branch L2_d143
L2_c144:
    s_lshl_b64 s[52:53], s[82:83], 1
    s_andn2_b64 s[52:53], s[52:53], s[80:81]
    s_andn2_b64 s[52:53], s[52:53], s[54:55]
    s_or_b64 s[80:81], s[80:81], s[52:53]
    s_not_b64 vcc, s[52:53]
    s_mov_b64 exec, -1
    v_cndmask_b32_dpp v84, v84, v84, vcc wave_shr:1 row_mask:0xf bank_mask:0xf
    v_cndmask_b32_dpp v85, v85, v85, vcc wave_shr:1 row_mask:0xf bank_mask:0xf
    s_lshr_b64 s[52:53], s[52:53], 1
    v_cndmask_b32_dpp v86, v86, v86, vcc wave_shr:1 row_mask:0xf bank_mask:0xf
    v_cndmask_b32_dpp v87, v87, v87, vcc wave_shr:1 row_mask:0xf bank_mask:0xf
    s_andn2_b64 s[82:83], s[82:83], s[52:53]
    v_cndmask_b32_dpp v7, v7, v7, vcc wave_shr:1 row_mask:0xf bank_mask:0xf
    s_mov_b64 exec, s[54:55]
    s_cbranch_scc0 L2_d144
    s_mov_b64 exec, s[82:83]
    s_nop 1
    v_mfma_f32_4x4x4_16b_bf16 v[88:91], v[12:13], v[84:85], 0
    s_nop 1
    v_mfma_f32_4x4x4_16b_bf16 v[88:91], v[10:11], v[86:87], v[88:91]
    s_nop 4
    v_cvt_pk_bf16_f32 v88, v88, v89
    v_cvt_pk_bf16_f32 v89, v90, v91
    ds_pk_add_bf16 v7, v88 offset:65408
    ds_pk_add_bf16 v7, v89 offset:65412
    s_mov_b64 exec, s[54:55]
    s_branch L2_d144
L2_c145:
    s_lshl_b64 s[52:53], s[82:83], 1
    s_andn2_b64 s[52:53], s[52:53], s[80:81]
    s_andn2_b64 s[52:53], s[52:53], s[50:51]
    s_or_b64 s[80:81], s[80:81], s[52:53]
    s_not_b64 vcc, s[52:53]
    s_mov_b64 exec, -1
    v_cndmask_b32_dpp v84, v84, v84, vcc wave_shr:1 row_mask:0xf bank_mask:0xf
    v_cndmask_b32_dpp v85, v85, v85, vcc wave_shr:1 row_mask:0xf bank_mask:0xf
    s_lshr_b64 s[52:53], s[52:53], 1
    v_cndmask_b32_dpp v86, v86, v86, vcc wave_shr:1 row_mask:0xf bank_mask:0xf
    v_cndmask_b32_dpp v87, v87, v87, vcc wave_shr:1 row_mask:0xf bank_mask:0xf
    s_andn2_b64 s[82:83], s[82:83], s[52:53]
    v_cndmask_b32_dpp v7, v7, v7, vcc wave_shr:1 row_mask:0xf bank_mask:0xf
    s_mov_b64 exec, s[50:51]
    s_cbranch_scc0 L2_d145
    s_mov_b64 exec, s[82:83]
    s_nop 1
    v_mfma_f32_4x4x4_16b_bf16 v[88:91], v[12:13], v[84:85], 0
    s_nop 1
    v_mfma_f32_4x4x4_16b_bf16 v[88:91], v[10:11], v[86:87], v[88:91]
    s_nop 4
    v_cvt_pk_bf16_f32 v88, v88, v89
    v_cvt_pk_bf16_f32 v89, v90, v91
    ds_pk_add_bf16 v7, v88 offset:65408
    ds_pk_add_bf16 v7, v89 offset:65412
    s_mov_b64 exec, s[50:51]
    s_branch L2_d145
L2_c146:
    s_lshl_b64 s[52:53], s[82:83], 1
    s_andn2_b64 s[52:53], s[52:53], s[80:81]
    s_andn2_b64 s[52:53], s[52:53], s[54:55]
    s_or_b64 s[80:81], s[80:81], s[52:53]
    s_not_b64 vcc, s[52:53]
    s_mov_b64 exec, -1
    v_cndmask_b32_dpp v84, v84, v84, vcc wave_shr:1 row_mask:0xf bank_mask:0xf
    v_cndmask_b32_dpp v85, v85, v85, vcc wave_shr:1 row_mask:0xf bank_mask:0xf
    s_lshr_b64 s[52:53], s[52:53], 1
    v_cndmask_b32_dpp v86, v86, v86, vcc wave_shr:1 row_mask:0xf bank_mask:0xf
    v_cndmask_b32_dpp v87, v87, v87, vcc wave_shr:1 row_mask:0xf bank_mask:0xf
    s_andn2_b64 s[82:83], s[82:83], s[52:53]
    v_cndmask_b32_dpp v7, v7, v7, vcc wave_shr:1 row_mask:0xf bank_mask:0xf
    s_mov_b64 exec, s[54:55]
    s_cbranch_scc0 L2_d146
    s_mov_b64 exec, s[82:83]
    s_nop 1
    v_mfma_f32_4x4x4_16b_bf16 v[88:91], v[12:13], v[84:85], 0
    s_nop 1
    v_mfma_f32_4x4x4_16b_bf16 v[88:91], v[10:11], v[86:87], v[88:91]
    s_nop 4
    v_cvt_pk_bf16_f32 v88, v88, v89
    v_cvt_pk_bf16_f32 v89, v90, v91
    ds_pk_add_bf16 v7, v88 offset:65408
    ds_pk_add_bf16 v7, v89 offset:65412
    s_mov_b64 exec, s[54:55]
    s_branch L2_d146
L2_c147:
    s_lshl_b64 s[52:53], s[82:83], 1
    s_andn2_b64 s[52:53], s[52:53], s[80:81]
    s_andn2_b64 s[52:53], s[52:53], s[50:51]
    s_or_b64 s[80:81], s[80:81], s[52:53]
    s_not_b64 vcc, s[52:53]
    s_mov_b64 exec, -1
    v_cndmask_b32_dpp v84, v84, v84, vcc wave_shr:1 row_mask:0xf bank_mask:0xf
    v_cndmask_b32_dpp v85, v85, v85, vcc wave_shr:1 row_mask:0xf bank_mask:0xf
    s_lshr_b64 s[52:53], s[52:53], 1
    v_cndmask_b32_dpp v86, v86, v86, vcc wave_shr:1 row_mask:0xf bank_mask:0xf
    v_cndmask_b32_dpp v87, v87, v87, vcc wave_shr:1 row_mask:0xf bank_mask:0xf
    s_andn2_b64 s[82:83], s[82:83], s[52:53]
    v_cndmask_b32_dpp v7, v7, v7, vcc wave_shr:1 row_mask:0xf bank_mask:0xf
    s_mov_b64 exec, s[50:51]
    s_cbranch_scc0 L2_d147
    s_mov_b64 exec, s[82:83]
    s_nop 1
    v_mfma_f32_4x4x4_16b_bf16 v[88:91], v[12:13], v[84:85], 0
    s_nop 1
    v_mfma_f32_4x4x4_16b_bf16 v[88:91], v[10:11], v[86:87], v[88:91]
    s_nop 4
    v_cvt_pk_bf16_f32 v88, v88, v89
    v_cvt_pk_bf16_f32 v89, v90, v91
    ds_pk_add_bf16 v7, v88 offset:65408
    ds_pk_add_bf16 v7, v89 offset:65412
    s_mov_b64 exec, s[50:51]
    s_branch L2_d147
L2_c148:
    s_lshl_b64 s[52:53], s[82:83], 1
    s_andn2_b64 s[52:53], s[52:53], s[80:81]
    s_andn2_b64 s[52:53], s[52:53], s[54:55]
    s_or_b64 s[80:81], s[80:81], s[52:53]
    s_not_b64 vcc, s[52:53]
    s_mov_b64 exec, -1
    v_cndmask_b32_dpp v84, v84, v84, vcc wave_shr:1 row_mask:0xf bank_mask:0xf
    v_cndmask_b32_dpp v85, v85, v85, vcc wave_shr:1 row_mask:0xf bank_mask:0xf
    s_lshr_b64 s[52:53], s[52:53], 1
    v_cndmask_b32_dpp v86, v86, v86, vcc wave_shr:1 row_mask:0xf bank_mask:0xf
    v_cndmask_b32_dpp v87, v87, v87, vcc wave_shr:1 row_mask:0xf bank_mask:0xf
    s_andn2_b64 s[82:83], s[82:83], s[52:53]
    v_cndmask_b32_dpp v7, v7, v7, vcc wave_shr:1 row_mask:0xf bank_mask:0xf
    s_mov_b64 exec, s[54:55]
    s_cbranch_scc0 L2_d148
    s_mov_b64 exec, s[82:83]
    s_nop 1
    v_mfma_f32_4x4x4_16b_bf16 v[88:91], v[12:13], v[84:85], 0
    s_nop 1
    v_mfma_f32_4x4x4_16b_bf16 v[88:91], v[10:11], v[86:87], v[88:91]
    s_nop 4
    v_cvt_pk_bf16_f32 v88, v88, v89
    v_cvt_pk_bf16_f32 v89, v90, v91
    ds_pk_add_bf16 v7, v88 offset:65408
    ds_pk_add_bf16 v7, v89 offset:65412
    s_mov_b64 exec, s[54:55]
    s_branch L2_d148
L2_c149:
    s_lshl_b64 s[52:53], s[82:83], 1
    s_andn2_b64 s[52:53], s[52:53], s[80:81]
    s_andn2_b64 s[52:53], s[52:53], s[50:51]
    s_or_b64 s[80:81], s[80:81], s[52:53]
    s_not_b64 vcc, s[52:53]
    s_mov_b64 exec, -1
    v_cndmask_b32_dpp v84, v84, v84, vcc wave_shr:1 row_mask:0xf bank_mask:0xf
    v_cndmask_b32_dpp v85, v85, v85, vcc wave_shr:1 row_mask:0xf bank_mask:0xf
    s_lshr_b64 s[52:53], s[52:53], 1
    v_cndmask_b32_dpp v86, v86, v86, vcc wave_shr:1 row_mask:0xf bank_mask:0xf
    v_cndmask_b32_dpp v87, v87, v87, vcc wave_shr:1 row_mask:0xf bank_mask:0xf
    s_andn2_b64 s[82:83], s[82:83], s[52:53]
    v_cndmask_b32_dpp v7, v7, v7, vcc wave_shr:1 row_mask:0xf bank_mask:0xf
    s_mov_b64 exec, s[50:51]
    s_cbranch_scc0 L2_d149
    s_mov_b64 exec, s[82:83]
    s_nop 1
    v_mfma_f32_4x4x4_16b_bf16 v[88:91], v[12:13], v[84:85], 0
    s_nop 1
    v_mfma_f32_4x4x4_16b_bf16 v[88:91], v[10:11], v[86:87], v[88:91]
    s_nop 4
    v_cvt_pk_bf16_f32 v88, v88, v89
    v_cvt_pk_bf16_f32 v89, v90, v91
    ds_pk_add_bf16 v7, v88 offset:65408
    ds_pk_add_bf16 v7, v89 offset:65412
    s_mov_b64 exec, s[50:51]
    s_branch L2_d149
L2_c150:
    s_lshl_b64 s[52:53], s[82:83], 1
    s_andn2_b64 s[52:53], s[52:53], s[80:81]
    s_andn2_b64 s[52:53], s[52:53], s[54:55]
    s_or_b64 s[80:81], s[80:81], s[52:53]
    s_not_b64 vcc, s[52:53]
    s_mov_b64 exec, -1
    v_cndmask_b32_dpp v84, v84, v84, vcc wave_shr:1 row_mask:0xf bank_mask:0xf
    v_cndmask_b32_dpp v85, v85, v85, vcc wave_shr:1 row_mask:0xf bank_mask:0xf
    s_lshr_b64 s[52:53], s[52:53], 1
    v_cndmask_b32_dpp v86, v86, v86, vcc wave_shr:1 row_mask:0xf bank_mask:0xf
    v_cndmask_b32_dpp v87, v87, v87, vcc wave_shr:1 row_mask:0xf bank_mask:0xf
    s_andn2_b64 s[82:83], s[82:83], s[52:53]
    v_cndmask_b32_dpp v7, v7, v7, vcc wave_shr:1 row_mask:0xf bank_mask:0xf
    s_mov_b64 exec, s[54:55]
    s_cbranch_scc0 L2_d150
    s_mov_b64 exec, s[82:83]
    s_nop 1
    v_mfma_f32_4x4x4_16b_bf16 v[88:91], v[12:13], v[84:85], 0
    s_nop 1
    v_mfma_f32_4x4x4_16b_bf16 v[88:91], v[10:11], v[86:87], v[88:91]
    s_nop 4
    v_cvt_pk_bf16_f32 v88, v88, v89
    v_cvt_pk_bf16_f32 v89, v90, v91
    ds_pk_add_bf16 v7, v88 offset:65408
    ds_pk_add_bf16 v7, v89 offset:65412
    s_mov_b64 exec, s[54:55]
    s_branch L2_d150
L2_c151:
    s_lshl_b64 s[52:53], s[82:83], 1
    s_andn2_b64 s[52:53], s[52:53], s[80:81]
    s_andn2_b64 s[52:53], s[52:53], s[50:51]
    s_or_b64 s[80:81], s[80:81], s[52:53]
    s_not_b64 vcc, s[52:53]
    s_mov_b64 exec, -1
    v_cndmask_b32_dpp v84, v84, v84, vcc wave_shr:1 row_mask:0xf bank_mask:0xf
    v_cndmask_b32_dpp v85, v85, v85, vcc wave_shr:1 row_mask:0xf bank_mask:0xf
    s_lshr_b64 s[52:53], s[52:53], 1
    v_cndmask_b32_dpp v86, v86, v86, vcc wave_shr:1 row_mask:0xf bank_mask:0xf
    v_cndmask_b32_dpp v87, v87, v87, vcc wave_shr:1 row_mask:0xf bank_mask:0xf
    s_andn2_b64 s[82:83], s[82:83], s[52:53]
    v_cndmask_b32_dpp v7, v7, v7, vcc wave_shr:1 row_mask:0xf bank_mask:0xf
    s_mov_b64 exec, s[50:51]
    s_cbranch_scc0 L2_d151
    s_mov_b64 exec, s[82:83]
    s_nop 1
    v_mfma_f32_4x4x4_16b_bf16 v[88:91], v[12:13], v[84:85], 0
    s_nop 1
    v_mfma_f32_4x4x4_16b_bf16 v[88:91], v[10:11], v[86:87], v[88:91]
    s_nop 4
    v_cvt_pk_bf16_f32 v88, v88, v89
    v_cvt_pk_bf16_f32 v89, v90, v91
    ds_pk_add_bf16 v7, v88 offset:65408
    ds_pk_add_bf16 v7, v89 offset:65412
    s_mov_b64 exec, s[50:51]
    s_branch L2_d151
L2_c152:
    s_mov_b64 s[50:51], vcc
    s_lshl_b64 s[52:53], s[82:83], 1
    s_andn2_b64 s[52:53], s[52:53], s[80:81]
    s_andn2_b64 s[52:53], s[52:53], s[50:51]
    s_or_b64 s[80:81], s[80:81], s[52:53]
    s_not_b64 vcc, s[52:53]
    s_mov_b64 exec, -1
    v_cndmask_b32_dpp v84, v84, v84, vcc wave_shr:1 row_mask:0xf bank_mask:0xf
    v_cndmask_b32_dpp v85, v85, v85, vcc wave_shr:1 row_mask:0xf bank_mask:0xf
    s_lshr_b64 s[52:53], s[52:53], 1
    v_cndmask_b32_dpp v86, v86, v86, vcc wave_shr:1 row_mask:0xf bank_mask:0xf
    v_cndmask_b32_dpp v87, v87, v87, vcc wave_shr:1 row_mask:0xf bank_mask:0xf
    s_andn2_b64 s[82:83], s[82:83], s[52:53]
    v_cndmask_b32_dpp v7, v7, v7, vcc wave_shr:1 row_mask:0xf bank_mask:0xf
    s_mov_b64 vcc, s[50:51]
    s_mov_b64 exec, s[50:51]
    s_cbranch_scc0 L2_d152
    s_mov_b64 exec, s[82:83]
    s_nop 1
    v_mfma_f32_4x4x4_16b_bf16 v[88:91], v[12:13], v[84:85], 0
    s_nop 1
    v_mfma_f32_4x4x4_16b_bf16 v[88:91], v[10:11], v[86:87], v[88:91]
    s_nop 4
    v_cvt_pk_bf16_f32 v88, v88, v89
    v_cvt_pk_bf16_f32 v89, v90, v91
    ds_pk_add_bf16 v7, v88 offset:65408
    ds_pk_add_bf16 v7, v89 offset:65412
    s_mov_b64 exec, vcc
    s_branch L2_d152
L2_c153:
    s_mov_b64 s[50:51], vcc
    s_lshl_b64 s[52:53], s[82:83], 1
    s_andn2_b64 s[52:53], s[52:53], s[80:81]
    s_andn2_b64 s[52:53], s[52:53], s[50:51]
    s_or_b64 s[80:81], s[80:81], s[52:53]
    s_not_b64 vcc, s[52:53]
    s_mov_b64 exec, -1
    v_cndmask_b32_dpp v84, v84, v84, vcc wave_shr:1 row_mask:0xf bank_mask:0xf
    v_cndmask_b32_dpp v85, v85, v85, vcc wave_shr:1 row_mask:0xf bank_mask:0xf
    s_lshr_b64 s[52:53], s[52:53], 1
    v_cndmask_b32_dpp v86, v86, v86, vcc wave_shr:1 row_mask:0xf bank_mask:0xf
    v_cndmask_b32_dpp v87, v87, v87, vcc wave_shr:1 row_mask:0xf bank_mask:0xf
    s_andn2_b64 s[82:83], s[82:83], s[52:53]
    v_cndmask_b32_dpp v7, v7, v7, vcc wave_shr:1 row_mask:0xf bank_mask:0xf
    s_mov_b64 vcc, s[50:51]
    s_mov_b64 exec, s[50:51]
    s_cbranch_scc0 L2_d153
    s_mov_b64 exec, s[82:83]
    s_nop 1
    v_mfma_f32_4x4x4_16b_bf16 v[88:91], v[12:13], v[84:85], 0
    s_nop 1
    v_mfma_f32_4x4x4_16b_bf16 v[88:91], v[10:11], v[86:87], v[88:91]
    s_nop 4
    v_cvt_pk_bf16_f32 v88, v88, v89
    v_cvt_pk_bf16_f32 v89, v90, v91
    ds_pk_add_bf16 v7, v88 offset:65408
    ds_pk_add_bf16 v7, v89 offset:65412
    s_mov_b64 exec, vcc
    s_branch L2_d153
.section .rodata,"a"
.p2align 6
.amdhsa_kernel gather_scatter__molecular_angular_gemnet__graph_kernel
  .amdhsa_next_free_vgpr 128
  .amdhsa_next_free_sgpr 102
  .amdhsa_accum_offset 128
  .amdhsa_group_segment_fixed_size 0
  .amdhsa_kernarg_size 112
  .amdhsa_user_sgpr_count 2
  .amdhsa_user_sgpr_kernarg_segment_ptr 1
  .amdhsa_system_sgpr_workgroup_id_x 1
  .amdhsa_float_denorm_mode_32 3
.end_amdhsa_kernel
```

```asm
; @launch grid=(256,1,1) block=(1024,1,1) lds=163840
.amdgcn_target "amdgcn-amd-amdhsa--gfx950"
.text
.globl gather_scatter__molecular_angular_gemnet__graph_kernel
.p2align 8
.type gather_scatter__molecular_angular_gemnet__graph_kernel,@function
gather_scatter__molecular_angular_gemnet__graph_kernel:
    s_cmp_ge_u32 s2, 256
    s_cbranch_scc0 L1_go
    s_endpgm
L1_go:
    s_load_dwordx4 s[4:7], s[0:1], 8
    s_load_dwordx2 s[28:29], s[0:1], 32
    s_load_dwordx2 s[30:31], s[0:1], 104
    s_load_dwordx2 s[56:57], s[0:1], 96
    s_load_dwordx2 s[86:87], s[0:1], 0
    s_load_dwordx4 s[60:63], s[0:1], 56
    s_load_dwordx4 s[64:67], s[0:1], 72
    v_lshrrev_b32 v7, 6, v0
    v_lshlrev_b32 v1, 3, v0
    v_readfirstlane_b32 s32, v7
    v_lshlrev_b32 v0, 4, v0
    v_and_b32 v1, 0x1f8, v1
    v_lshlrev_b32 v15, 1, v1
    s_lshr_b32 s3, s32, 1
    s_and_b32 s44, s32, 1
    s_lshl_b32 s44, s44, 3
    s_or_b32 s3, s3, s44
    s_lshl_b32 s3, s3, 10
    s_lshl_b32 s96, s2, 14
    s_add_u32 s96, s96, s3
    s_lshr_b32 s3, s32, 1
    s_and_b32 s44, s32, 1
    s_lshl_b32 s44, s44, 3
    s_or_b32 s3, s3, s44
    s_lshl_b32 s3, s3, 10
    s_lshl_b32 s97, s2, 14
    s_add_u32 s97, s97, s3
    s_lshr_b32 s3, s32, 1
    s_and_b32 s44, s32, 1
    s_lshl_b32 s44, s44, 3
    s_or_b32 s3, s3, s44
    s_lshl_b32 s3, s3, 10
    s_lshl_b32 s98, s2, 14
    s_add_u32 s98, s98, s3
    s_lshr_b32 s3, s32, 1
    s_and_b32 s44, s32, 1
    s_lshl_b32 s44, s44, 3
    s_or_b32 s3, s3, s44
    s_lshl_b32 s3, s3, 10
    s_lshl_b32 s99, s2, 14
    s_add_u32 s99, s99, s3
    s_waitcnt lgkmcnt(0)
    s_mov_b32 s8, s4
    s_mov_b32 s9, s5
    s_mov_b32 s10, 0x9c40000
    s_mov_b32 s11, 0x20000
    s_mov_b32 s12, s6
    s_mov_b32 s13, s7
    s_mov_b32 s14, 0x9c40000
    s_mov_b32 s15, 0x20000
    s_mov_b32 s16, s28
    s_mov_b32 s17, s29
    s_mov_b32 s18, 0x4e20000
    s_mov_b32 s19, 0x20000
    s_mov_b32 s68, s62
    s_mov_b32 s69, s63
    s_mov_b32 s70, 0x40
    s_mov_b32 s71, 0x20000
    s_mov_b32 s72, s60
    s_mov_b32 s73, s61
    s_mov_b32 s74, 0x40
    s_mov_b32 s75, 0x20000
    s_mov_b32 s20, s66
    s_mov_b32 s21, s67
    s_mov_b32 s22, 0x20
    s_mov_b32 s23, 0x20000
    s_mov_b32 s80, s64
    s_mov_b32 s81, s65
    s_mov_b32 s82, 0x20
    s_mov_b32 s83, 0x20000
    s_add_u32 s24, s30, 0xec45000
    s_addc_u32 s25, s31, 0
    s_mov_b32 s26, 0x100
    s_mov_b32 s27, 0x20000
    v_lshrrev_b32 v2, 3, v0
    v_and_b32 v2, 6, v2
    v_lshlrev_b32 v3, 2, v0
    s_lshl_b32 s3, s32, 8
    s_add_u32 s3, s3, s2
    s_cmp_lg_u32 s3, 254
    s_cbranch_scc1 L1_wt
    buffer_load_ushort v96, v2, s[68:71], 0 offen offset:0
    buffer_load_ushort v108, v2, s[68:71], 0 offen offset:8
    buffer_load_ushort v97, v2, s[68:71], 0 offen offset:16
    buffer_load_ushort v109, v2, s[68:71], 0 offen offset:24
    buffer_load_ushort v98, v2, s[68:71], 0 offen offset:32
    buffer_load_ushort v110, v2, s[68:71], 0 offen offset:40
    buffer_load_ushort v99, v2, s[68:71], 0 offen offset:48
    buffer_load_ushort v111, v2, s[68:71], 0 offen offset:56
    buffer_load_ushort v100, v2, s[72:75], 0 offen offset:0
    buffer_load_ushort v112, v2, s[72:75], 0 offen offset:8
    buffer_load_ushort v101, v2, s[72:75], 0 offen offset:16
    buffer_load_ushort v113, v2, s[72:75], 0 offen offset:24
    buffer_load_ushort v102, v2, s[72:75], 0 offen offset:32
    buffer_load_ushort v114, v2, s[72:75], 0 offen offset:40
    buffer_load_ushort v103, v2, s[72:75], 0 offen offset:48
    buffer_load_ushort v115, v2, s[72:75], 0 offen offset:56
    buffer_load_ushort v104, v2, s[20:23], 0 offen offset:0
    buffer_load_ushort v116, v2, s[20:23], 0 offen offset:8
    buffer_load_ushort v105, v2, s[20:23], 0 offen offset:16
    buffer_load_ushort v117, v2, s[20:23], 0 offen offset:24
    buffer_load_ushort v106, v2, s[80:83], 0 offen offset:0
    buffer_load_ushort v118, v2, s[80:83], 0 offen offset:8
    buffer_load_ushort v107, v2, s[80:83], 0 offen offset:16
    buffer_load_ushort v119, v2, s[80:83], 0 offen offset:24
    s_waitcnt vmcnt(0)
    v_lshl_or_b32 v96, v108, 16, v96
    v_lshl_or_b32 v97, v109, 16, v97
    v_lshl_or_b32 v98, v110, 16, v98
    v_lshl_or_b32 v99, v111, 16, v99
    v_lshl_or_b32 v100, v112, 16, v100
    v_lshl_or_b32 v101, v113, 16, v101
    v_lshl_or_b32 v102, v114, 16, v102
    v_lshl_or_b32 v103, v115, 16, v103
    v_lshl_or_b32 v104, v116, 16, v104
    v_lshl_or_b32 v105, v117, 16, v105
    v_lshl_or_b32 v106, v118, 16, v106
    v_lshl_or_b32 v107, v119, 16, v107
    buffer_store_dwordx4 v[96:99], v3, s[24:27], 0 offen offset:0 sc1
    buffer_store_dwordx4 v[100:103], v3, s[24:27], 0 offen offset:16 sc1
    buffer_store_dwordx4 v[104:107], v3, s[24:27], 0 offen offset:32 sc1
L1_wt:
    s_nop 1
    s_add_u32 s44, s96, 0x0
    v_lshlrev_b32 v16, 1, v1
    buffer_load_dwordx4 v[16:19], v16, s[8:11], s44 offen nt
    s_add_u32 s45, s96, 0x0
    v_lshlrev_b32 v20, 1, v1
    buffer_load_dwordx4 v[20:23], v20, s[12:15], s45 offen nt
    s_add_u32 s46, s96, 0x0
    s_lshr_b32 s46, s46, 1
    buffer_load_dwordx2 v[24:25], v1, s[16:19], s46 offen nt
    s_add_u32 s47, s97, 0x400000
    s_lshr_b32 s47, s47, 1
    buffer_load_dwordx2 v[26:27], v1, s[16:19], s47 offen nt
    s_add_u32 s44, s97, 0x400000
    v_lshlrev_b32 v28, 1, v1
    buffer_load_dwordx4 v[28:31], v28, s[8:11], s44 offen nt
    s_add_u32 s45, s97, 0x400000
    v_lshlrev_b32 v32, 1, v1
    buffer_load_dwordx4 v[32:35], v32, s[12:15], s45 offen nt
    s_add_u32 s46, s98, 0x800000
    v_lshlrev_b32 v36, 1, v1
    buffer_load_dwordx4 v[36:39], v36, s[8:11], s46 offen nt
    s_add_u32 s47, s98, 0x800000
    v_lshlrev_b32 v40, 1, v1
    buffer_load_dwordx4 v[40:43], v40, s[12:15], s47 offen nt
    s_add_u32 s44, s98, 0x800000
    s_lshr_b32 s44, s44, 1
    buffer_load_dwordx2 v[44:45], v1, s[16:19], s44 offen nt
    s_add_u32 s45, s99, 0xc00000
    s_lshr_b32 s45, s45, 1
    buffer_load_dwordx2 v[46:47], v1, s[16:19], s45 offen nt
    s_mov_b32 s20, s30
    s_mov_b32 s21, s31
    s_mov_b32 s22, 0xd344000
    s_mov_b32 s23, 0x20000
    s_add_u32 s24, s30, 0x2c000
    s_addc_u32 s25, s31, 0
    s_mov_b32 s26, 0xd318000
    s_mov_b32 s27, 0x20000
    s_add_u32 s3, s32, 0
    s_mul_i32 s4, s3, 205
    s_lshr_b32 s4, s4, 10
    s_mul_i32 s5, s4, 5
    s_sub_u32 s5, s3, s5
    s_lshl_b32 s5, s5, 5
    s_add_u32 s4, s4, s5
    s_sub_u32 s4, s4, s32
    s_lshl_b32 s72, s4, 10
    s_add_u32 s3, s32, 16
    s_mul_i32 s4, s3, 205
    s_lshr_b32 s4, s4, 10
    s_mul_i32 s5, s4, 5
    s_sub_u32 s5, s3, s5
    s_lshl_b32 s5, s5, 5
    s_add_u32 s4, s4, s5
    s_sub_u32 s4, s4, s32
    s_lshl_b32 s73, s4, 10
    s_add_u32 s3, s32, 32
    s_mul_i32 s4, s3, 205
    s_lshr_b32 s4, s4, 10
    s_mul_i32 s5, s4, 5
    s_sub_u32 s5, s3, s5
    s_lshl_b32 s5, s5, 5
    s_add_u32 s4, s4, s5
    s_sub_u32 s4, s4, s32
    s_lshl_b32 s85, s4, 10
    s_add_u32 s3, s32, 48
    s_mul_i32 s4, s3, 205
    s_lshr_b32 s4, s4, 10
    s_mul_i32 s5, s4, 5
    s_sub_u32 s5, s3, s5
    s_lshl_b32 s5, s5, 5
    s_add_u32 s4, s4, s5
    s_sub_u32 s4, s4, s32
    s_lshl_b32 s91, s4, 10
    s_add_u32 s3, s32, 64
    s_mul_i32 s4, s3, 205
    s_lshr_b32 s4, s4, 10
    s_mul_i32 s5, s4, 5
    s_sub_u32 s5, s3, s5
    s_lshl_b32 s5, s5, 5
    s_add_u32 s4, s4, s5
    s_sub_u32 s4, s4, s32
    s_lshl_b32 s93, s4, 10
    s_mov_b32 s80, s86
    s_mov_b32 s81, s87
    s_mov_b32 s82, 0x4e2000
    s_mov_b32 s83, 0x20000
    s_mul_i32 s35, s2, 173056
    s_and_b32 s37, s32, 3
    s_lshl_b32 s37, s37, 3
    s_mov_b32 s36, s37
    s_lshr_b32 s37, s32, 2
    s_mul_i32 s37, s37, 2080
    s_add_u32 s36, s36, s37
    s_and_b32 s37, s2, 3
    s_lshl_b32 s37, s37, 5
    s_add_u32 s36, s36, s37
    s_mul_i32 s4, s2, 5
    s_add_u32 s4, s4, 8192
    s_lshl_b32 s38, s4, 14
    s_lshl_b32 s39, s4, 13
    v_mov_b32 v2, 1
    v_mov_b32 v4, 0x80000007
    v_mov_b32 v5, 0xfc
    v_mov_b32 v6, 0x78
    s_mov_b32 s40, 16512
    s_mov_b32 s55, -10000
    s_mov_b32 s41, 0x010c0c01
    s_mov_b32 s42, 0x030c0c03
    v_mov_b32 v8, 0
    v_mov_b32 v9, 0
    v_mov_b32 v10, 0
    v_mov_b32 v11, 0
    ds_write_b128 v0, v[8:11]
    s_add_u32 s60, s30, 0xec4e000
    s_addc_u32 s61, s31, 0
    s_mov_b32 s62, 0x8000
    s_mov_b32 s63, 0x20000
    s_mov_b64 s[66:67], s[56:57]
    s_lshl_b32 s57, s2, 7
    s_add_u32 s68, s30, 0xec46000
    s_addc_u32 s69, s31, 0
    s_mov_b32 s70, 0x80
    s_mov_b32 s71, 0x20000
    s_lshl_b32 s3, s2, 7
    s_add_u32 s68, s68, s3
    s_addc_u32 s69, s69, 0
    s_cmp_lg_u32 s32, 0
    s_cbranch_scc1 L1_fl
    buffer_store_dwordx4 v[8:11], v0, s[68:71], 0 offen sc1
    s_mov_b64 exec, 0xff
    buffer_store_dwordx4 v[8:11], v0, s[60:63], s57 offen sc1
    s_mov_b64 exec, -1
    buffer_inv sc1
L1_fl:
    s_waitcnt lgkmcnt(0)
    s_barrier
    s_setprio 3
    s_add_u32 s46, s99, 0xc00000
    v_lshlrev_b32 v48, 1, v1
    buffer_load_dwordx4 v[48:51], v48, s[8:11], s46 offen nt
    s_add_u32 s47, s99, 0xc00000
    v_lshlrev_b32 v52, 1, v1
    buffer_load_dwordx4 v[52:55], v52, s[12:15], s47 offen nt
    s_waitcnt vmcnt(8)
    v_lshlrev_b32 v7, 16, v24
    v_and_b32 v8, 0xffff0000, v24
    v_lshlrev_b32 v9, 16, v25
    v_and_b32 v10, 0xffff0000, v25
    v_mul_f32 v7, 0.15915494, v7
    v_mul_f32 v8, 0.15915494, v8
    v_mul_f32 v9, 0.15915494, v9
    v_mul_f32 v10, 0.15915494, v10
    v_mul_hi_u32_u24 v14, 429497, v16
    v_lshrrev_b32 v12, 3, v20
    v_cos_f32 v7, v7
    v_lshlrev_b16 v13, 3, v20
    v_mad_i32_i24 v11, v14, s55, v16
    v_bitop3_b32 v12, v6, v13, v12 bitop3:0xca
    v_lshl_add_u32 v11, v11, 17, s40
    v_lshlrev_b16 v14, 8, v14
    v_lshrrev_b32 v13, 2, v20
    v_add_u32 v16, v12, v11
    v_bitop3_b32 v20, v5, v13, v14 bitop3:0xea
    ds_add_u32 v20, v2
    v_mul_hi_u32_u24 v14, 429497, v17
    v_lshrrev_b32 v12, 3, v21
    v_cos_f32 v8, v8
    v_lshlrev_b16 v13, 3, v21
    v_mad_i32_i24 v11, v14, s55, v17
    v_bitop3_b32 v12, v6, v13, v12 bitop3:0xca
    v_lshl_add_u32 v11, v11, 17, s40
    v_lshlrev_b16 v14, 8, v14
    v_lshrrev_b32 v13, 2, v21
    v_add_u32 v17, v12, v11
    v_bitop3_b32 v21, v5, v13, v14 bitop3:0xea
    ds_add_u32 v21, v2
    v_cvt_pk_bf16_f32 v24, v7, v8
    v_perm_b32 v12, v24, v24, s41
    v_bitop3_b32 v16, v4, v12, v16 bitop3:0xca
    v_perm_b32 v13, v24, v24, s42
    v_bitop3_b32 v17, v4, v13, v17 bitop3:0xca
    v_mul_hi_u32_u24 v14, 429497, v18
    v_lshrrev_b32 v12, 3, v22
    v_cos_f32 v9, v9
    v_lshlrev_b16 v13, 3, v22
    v_mad_i32_i24 v11, v14, s55, v18
    v_bitop3_b32 v12, v6, v13, v12 bitop3:0xca
    v_lshl_add_u32 v11, v11, 17, s40
    v_lshlrev_b16 v14, 8, v14
    v_lshrrev_b32 v13, 2, v22
    v_add_u32 v18, v12, v11
    v_bitop3_b32 v22, v5, v13, v14 bitop3:0xea
    ds_add_u32 v22, v2
    v_mul_hi_u32_u24 v14, 429497, v19
    v_lshrrev_b32 v12, 3, v23
    v_cos_f32 v10, v10
    v_lshlrev_b16 v13, 3, v23
    v_mad_i32_i24 v11, v14, s55, v19
    v_bitop3_b32 v12, v6, v13, v12 bitop3:0xca
    v_lshl_add_u32 v11, v11, 17, s40
    v_lshlrev_b16 v14, 8, v14
    v_lshrrev_b32 v13, 2, v23
    v_add_u32 v19, v12, v11
    v_bitop3_b32 v23, v5, v13, v14 bitop3:0xea
    ds_add_u32 v23, v2
    v_cvt_pk_bf16_f32 v25, v9, v10
    v_perm_b32 v12, v25, v25, s41
    v_bitop3_b32 v18, v4, v12, v18 bitop3:0xca
    v_perm_b32 v13, v25, v25, s42
    v_bitop3_b32 v19, v4, v13, v19 bitop3:0xca
    s_add_u32 s44, s96, 0x1000000
    v_lshlrev_b32 v56, 1, v1
    buffer_load_dwordx4 v[56:59], v56, s[8:11], s44 offen nt
    s_add_u32 s45, s96, 0x1000000
    v_lshlrev_b32 v60, 1, v1
    buffer_load_dwordx4 v[60:63], v60, s[12:15], s45 offen nt
    s_add_u32 s46, s96, 0x1000000
    s_lshr_b32 s46, s46, 1
    buffer_load_dwordx2 v[64:65], v1, s[16:19], s46 offen nt
    s_add_u32 s47, s97, 0x1400000
    s_lshr_b32 s47, s47, 1
    buffer_load_dwordx2 v[66:67], v1, s[16:19], s47 offen nt
    s_waitcnt vmcnt(10)
    v_lshlrev_b32 v7, 16, v26
    v_and_b32 v8, 0xffff0000, v26
    v_lshlrev_b32 v9, 16, v27
    v_and_b32 v10, 0xffff0000, v27
    v_mul_f32 v7, 0.15915494, v7
    v_mul_f32 v8, 0.15915494, v8
    v_mul_f32 v9, 0.15915494, v9
    v_mul_f32 v10, 0.15915494, v10
    v_mul_hi_u32_u24 v14, 429497, v28
    v_lshrrev_b32 v12, 3, v32
    v_cos_f32 v7, v7
    v_lshlrev_b16 v13, 3, v32
    v_mad_i32_i24 v11, v14, s55, v28
    v_bitop3_b32 v12, v6, v13, v12 bitop3:0xca
    v_lshl_add_u32 v11, v11, 17, s40
    v_lshlrev_b16 v14, 8, v14
    v_lshrrev_b32 v13, 2, v32
    v_add_u32 v28, v12, v11
    v_bitop3_b32 v32, v5, v13, v14 bitop3:0xea
    ds_add_u32 v32, v2
    v_mul_hi_u32_u24 v14, 429497, v29
    v_lshrrev_b32 v12, 3, v33
    v_cos_f32 v8, v8
    v_lshlrev_b16 v13, 3, v33
    v_mad_i32_i24 v11, v14, s55, v29
    v_bitop3_b32 v12, v6, v13, v12 bitop3:0xca
    v_lshl_add_u32 v11, v11, 17, s40
    v_lshlrev_b16 v14, 8, v14
    v_lshrrev_b32 v13, 2, v33
    v_add_u32 v29, v12, v11
    v_bitop3_b32 v33, v5, v13, v14 bitop3:0xea
    ds_add_u32 v33, v2
    v_cvt_pk_bf16_f32 v26, v7, v8
    v_perm_b32 v12, v26, v26, s41
    v_bitop3_b32 v28, v4, v12, v28 bitop3:0xca
    v_perm_b32 v13, v26, v26, s42
    v_bitop3_b32 v29, v4, v13, v29 bitop3:0xca
    v_mul_hi_u32_u24 v14, 429497, v30
    v_lshrrev_b32 v12, 3, v34
    v_cos_f32 v9, v9
    v_lshlrev_b16 v13, 3, v34
    v_mad_i32_i24 v11, v14, s55, v30
    v_bitop3_b32 v12, v6, v13, v12 bitop3:0xca
    v_lshl_add_u32 v11, v11, 17, s40
    v_lshlrev_b16 v14, 8, v14
    v_lshrrev_b32 v13, 2, v34
    v_add_u32 v30, v12, v11
    v_bitop3_b32 v34, v5, v13, v14 bitop3:0xea
    ds_add_u32 v34, v2
    v_mul_hi_u32_u24 v14, 429497, v31
    v_lshrrev_b32 v12, 3, v35
    v_cos_f32 v10, v10
    v_lshlrev_b16 v13, 3, v35
    v_mad_i32_i24 v11, v14, s55, v31
    v_bitop3_b32 v12, v6, v13, v12 bitop3:0xca
    v_lshl_add_u32 v11, v11, 17, s40
    v_lshlrev_b16 v14, 8, v14
    v_lshrrev_b32 v13, 2, v35
    v_add_u32 v31, v12, v11
    v_bitop3_b32 v35, v5, v13, v14 bitop3:0xea
    ds_add_u32 v35, v2
    v_cvt_pk_bf16_f32 v27, v9, v10
    v_perm_b32 v12, v27, v27, s41
    v_bitop3_b32 v30, v4, v12, v30 bitop3:0xca
    v_perm_b32 v13, v27, v27, s42
    v_bitop3_b32 v31, v4, v13, v31 bitop3:0xca
    s_setprio 2
    s_add_u32 s44, s97, 0x1400000
    v_lshlrev_b32 v68, 1, v1
    buffer_load_dwordx4 v[68:71], v68, s[8:11], s44 offen nt
    s_add_u32 s45, s97, 0x1400000
    v_lshlrev_b32 v72, 1, v1
    buffer_load_dwordx4 v[72:75], v72, s[12:15], s45 offen nt
    s_waitcnt vmcnt(8)
    v_lshlrev_b32 v7, 16, v44
    v_and_b32 v8, 0xffff0000, v44
    v_lshlrev_b32 v9, 16, v45
    v_and_b32 v10, 0xffff0000, v45
    v_mul_f32 v7, 0.15915494, v7
    v_mul_f32 v8, 0.15915494, v8
    v_mul_f32 v9, 0.15915494, v9
    v_mul_f32 v10, 0.15915494, v10
    v_mul_hi_u32_u24 v14, 429497, v36
    v_lshrrev_b32 v12, 3, v40
    v_cos_f32 v7, v7
    v_lshlrev_b16 v13, 3, v40
    v_mad_i32_i24 v11, v14, s55, v36
    v_bitop3_b32 v12, v6, v13, v12 bitop3:0xca
    v_lshl_add_u32 v11, v11, 17, s40
    v_lshlrev_b16 v14, 8, v14
    v_lshrrev_b32 v13, 2, v40
    v_add_u32 v36, v12, v11
    v_bitop3_b32 v40, v5, v13, v14 bitop3:0xea
    ds_add_u32 v40, v2
    v_mul_hi_u32_u24 v14, 429497, v37
    v_lshrrev_b32 v12, 3, v41
    v_cos_f32 v8, v8
    v_lshlrev_b16 v13, 3, v41
    v_mad_i32_i24 v11, v14, s55, v37
    v_bitop3_b32 v12, v6, v13, v12 bitop3:0xca
    v_lshl_add_u32 v11, v11, 17, s40
    v_lshlrev_b16 v14, 8, v14
    v_lshrrev_b32 v13, 2, v41
    v_add_u32 v37, v12, v11
    v_bitop3_b32 v41, v5, v13, v14 bitop3:0xea
    ds_add_u32 v41, v2
    v_cvt_pk_bf16_f32 v44, v7, v8
    v_perm_b32 v12, v44, v44, s41
    v_bitop3_b32 v36, v4, v12, v36 bitop3:0xca
    v_perm_b32 v13, v44, v44, s42
    v_bitop3_b32 v37, v4, v13, v37 bitop3:0xca
    v_mul_hi_u32_u24 v14, 429497, v38
    v_lshrrev_b32 v12, 3, v42
    v_cos_f32 v9, v9
    v_lshlrev_b16 v13, 3, v42
    v_mad_i32_i24 v11, v14, s55, v38
    v_bitop3_b32 v12, v6, v13, v12 bitop3:0xca
    v_lshl_add_u32 v11, v11, 17, s40
    v_lshlrev_b16 v14, 8, v14
    v_lshrrev_b32 v13, 2, v42
    v_add_u32 v38, v12, v11
    v_bitop3_b32 v42, v5, v13, v14 bitop3:0xea
    ds_add_u32 v42, v2
    v_mul_hi_u32_u24 v14, 429497, v39
    v_lshrrev_b32 v12, 3, v43
    v_cos_f32 v10, v10
    v_lshlrev_b16 v13, 3, v43
    v_mad_i32_i24 v11, v14, s55, v39
    v_bitop3_b32 v12, v6, v13, v12 bitop3:0xca
    v_lshl_add_u32 v11, v11, 17, s40
    v_lshlrev_b16 v14, 8, v14
    v_lshrrev_b32 v13, 2, v43
    v_add_u32 v39, v12, v11
    v_bitop3_b32 v43, v5, v13, v14 bitop3:0xea
    ds_add_u32 v43, v2
    v_cvt_pk_bf16_f32 v45, v9, v10
    v_perm_b32 v12, v45, v45, s41
    v_bitop3_b32 v38, v4, v12, v38 bitop3:0xca
    v_perm_b32 v13, v45, v45, s42
    v_bitop3_b32 v39, v4, v13, v39 bitop3:0xca
    s_add_u32 s46, s98, 0x1800000
    v_lshlrev_b32 v76, 1, v1
    buffer_load_dwordx4 v[76:79], v76, s[8:11], s46 offen nt
    s_add_u32 s47, s98, 0x1800000
    v_lshlrev_b32 v80, 1, v1
    buffer_load_dwordx4 v[80:83], v80, s[12:15], s47 offen nt
    s_add_u32 s44, s98, 0x1800000
    s_lshr_b32 s44, s44, 1
    buffer_load_dwordx2 v[84:85], v1, s[16:19], s44 offen nt
    s_add_u32 s45, s99, 0x1c00000
    s_lshr_b32 s45, s45, 1
    buffer_load_dwordx2 v[86:87], v1, s[16:19], s45 offen nt
    s_waitcnt vmcnt(10)
    v_lshlrev_b32 v7, 16, v46
    v_and_b32 v8, 0xffff0000, v46
    v_lshlrev_b32 v9, 16, v47
    v_and_b32 v10, 0xffff0000, v47
    v_mul_f32 v7, 0.15915494, v7
    v_mul_f32 v8, 0.15915494, v8
    v_mul_f32 v9, 0.15915494, v9
    v_mul_f32 v10, 0.15915494, v10
    v_mul_hi_u32_u24 v14, 429497, v48
    v_lshrrev_b32 v12, 3, v52
    v_cos_f32 v7, v7
    v_lshlrev_b16 v13, 3, v52
    v_mad_i32_i24 v11, v14, s55, v48
    v_bitop3_b32 v12, v6, v13, v12 bitop3:0xca
    v_lshl_add_u32 v11, v11, 17, s40
    v_lshlrev_b16 v14, 8, v14
    v_lshrrev_b32 v13, 2, v52
    v_add_u32 v48, v12, v11
    v_bitop3_b32 v52, v5, v13, v14 bitop3:0xea
    ds_add_u32 v52, v2
    v_mul_hi_u32_u24 v14, 429497, v49
    v_lshrrev_b32 v12, 3, v53
    v_cos_f32 v8, v8
    v_lshlrev_b16 v13, 3, v53
    v_mad_i32_i24 v11, v14, s55, v49
    v_bitop3_b32 v12, v6, v13, v12 bitop3:0xca
    v_lshl_add_u32 v11, v11, 17, s40
    v_lshlrev_b16 v14, 8, v14
    v_lshrrev_b32 v13, 2, v53
    v_add_u32 v49, v12, v11
    v_bitop3_b32 v53, v5, v13, v14 bitop3:0xea
    ds_add_u32 v53, v2
    v_cvt_pk_bf16_f32 v46, v7, v8
    v_perm_b32 v12, v46, v46, s41
    v_bitop3_b32 v48, v4, v12, v48 bitop3:0xca
    v_perm_b32 v13, v46, v46, s42
    v_bitop3_b32 v49, v4, v13, v49 bitop3:0xca
    v_mul_hi_u32_u24 v14, 429497, v50
    v_lshrrev_b32 v12, 3, v54
    v_cos_f32 v9, v9
    v_lshlrev_b16 v13, 3, v54
    v_mad_i32_i24 v11, v14, s55, v50
    v_bitop3_b32 v12, v6, v13, v12 bitop3:0xca
    v_lshl_add_u32 v11, v11, 17, s40
    v_lshlrev_b16 v14, 8, v14
    v_lshrrev_b32 v13, 2, v54
    v_add_u32 v50, v12, v11
    v_bitop3_b32 v54, v5, v13, v14 bitop3:0xea
    ds_add_u32 v54, v2
    v_mul_hi_u32_u24 v14, 429497, v51
    v_lshrrev_b32 v12, 3, v55
    v_cos_f32 v10, v10
    v_lshlrev_b16 v13, 3, v55
    v_mad_i32_i24 v11, v14, s55, v51
    v_bitop3_b32 v12, v6, v13, v12 bitop3:0xca
    v_lshl_add_u32 v11, v11, 17, s40
    v_lshlrev_b16 v14, 8, v14
    v_lshrrev_b32 v13, 2, v55
    v_add_u32 v51, v12, v11
    v_bitop3_b32 v55, v5, v13, v14 bitop3:0xea
    ds_add_u32 v55, v2
    v_cvt_pk_bf16_f32 v47, v9, v10
    v_perm_b32 v12, v47, v47, s41
    v_bitop3_b32 v50, v4, v12, v50 bitop3:0xca
    v_perm_b32 v13, v47, v47, s42
    v_bitop3_b32 v51, v4, v13, v51 bitop3:0xca
    s_setprio 1
    s_add_u32 s46, s99, 0x1c00000
    v_lshlrev_b32 v88, 1, v1
    buffer_load_dwordx4 v[88:91], v88, s[8:11], s46 offen nt
    s_add_u32 s47, s99, 0x1c00000
    v_lshlrev_b32 v92, 1, v1
    buffer_load_dwordx4 v[92:95], v92, s[12:15], s47 offen nt
    s_waitcnt vmcnt(8)
    v_lshlrev_b32 v7, 16, v64
    v_and_b32 v8, 0xffff0000, v64
    v_lshlrev_b32 v9, 16, v65
    v_and_b32 v10, 0xffff0000, v65
    v_mul_f32 v7, 0.15915494, v7
    v_mul_f32 v8, 0.15915494, v8
    v_mul_f32 v9, 0.15915494, v9
    v_mul_f32 v10, 0.15915494, v10
    v_mul_hi_u32_u24 v14, 429497, v56
    v_lshrrev_b32 v12, 3, v60
    v_cos_f32 v7, v7
    v_lshlrev_b16 v13, 3, v60
    v_mad_i32_i24 v11, v14, s55, v56
    v_bitop3_b32 v12, v6, v13, v12 bitop3:0xca
    v_lshl_add_u32 v11, v11, 17, s40
    v_lshlrev_b16 v14, 8, v14
    v_lshrrev_b32 v13, 2, v60
    v_add_u32 v56, v12, v11
    v_bitop3_b32 v60, v5, v13, v14 bitop3:0xea
    ds_add_u32 v60, v2
    v_mul_hi_u32_u24 v14, 429497, v57
    v_lshrrev_b32 v12, 3, v61
    v_cos_f32 v8, v8
    v_lshlrev_b16 v13, 3, v61
    v_mad_i32_i24 v11, v14, s55, v57
    v_bitop3_b32 v12, v6, v13, v12 bitop3:0xca
    v_lshl_add_u32 v11, v11, 17, s40
    v_lshlrev_b16 v14, 8, v14
    v_lshrrev_b32 v13, 2, v61
    v_add_u32 v57, v12, v11
    v_bitop3_b32 v61, v5, v13, v14 bitop3:0xea
    ds_add_u32 v61, v2
    v_cvt_pk_bf16_f32 v64, v7, v8
    v_perm_b32 v12, v64, v64, s41
    v_bitop3_b32 v56, v4, v12, v56 bitop3:0xca
    v_perm_b32 v13, v64, v64, s42
    v_bitop3_b32 v57, v4, v13, v57 bitop3:0xca
    v_mul_hi_u32_u24 v14, 429497, v58
    v_lshrrev_b32 v12, 3, v62
    v_cos_f32 v9, v9
    v_lshlrev_b16 v13, 3, v62
    v_mad_i32_i24 v11, v14, s55, v58
    v_bitop3_b32 v12, v6, v13, v12 bitop3:0xca
    v_lshl_add_u32 v11, v11, 17, s40
    v_lshlrev_b16 v14, 8, v14
    v_lshrrev_b32 v13, 2, v62
    v_add_u32 v58, v12, v11
    v_bitop3_b32 v62, v5, v13, v14 bitop3:0xea
    ds_add_u32 v62, v2
    v_mul_hi_u32_u24 v14, 429497, v59
    v_lshrrev_b32 v12, 3, v63
    v_cos_f32 v10, v10
    v_lshlrev_b16 v13, 3, v63
    v_mad_i32_i24 v11, v14, s55, v59
    v_bitop3_b32 v12, v6, v13, v12 bitop3:0xca
    v_lshl_add_u32 v11, v11, 17, s40
    v_lshlrev_b16 v14, 8, v14
    v_lshrrev_b32 v13, 2, v63
    v_add_u32 v59, v12, v11
    v_bitop3_b32 v63, v5, v13, v14 bitop3:0xea
    ds_add_u32 v63, v2
    v_cvt_pk_bf16_f32 v65, v9, v10
    v_perm_b32 v12, v65, v65, s41
    v_bitop3_b32 v58, v4, v12, v58 bitop3:0xca
    v_perm_b32 v13, v65, v65, s42
    v_bitop3_b32 v59, v4, v13, v59 bitop3:0xca
    s_add_u32 s44, s96, 0x2000000
    v_lshlrev_b32 v96, 1, v1
    buffer_load_dwordx4 v[96:99], v96, s[8:11], s44 offen nt
    s_add_u32 s45, s96, 0x2000000
    v_lshlrev_b32 v104, 1, v1
    buffer_load_dwordx4 v[104:107], v104, s[12:15], s45 offen nt
    s_add_u32 s46, s96, 0x2000000
    s_lshr_b32 s46, s46, 1
    buffer_load_dwordx2 v[108:109], v1, s[16:19], s46 offen nt
    s_add_u32 s47, s97, 0x2400000
    s_lshr_b32 s47, s47, 1
    buffer_load_dwordx2 v[110:111], v1, s[16:19], s47 offen nt
    s_waitcnt vmcnt(10)
    v_lshlrev_b32 v7, 16, v66
    v_and_b32 v8, 0xffff0000, v66
    v_lshlrev_b32 v9, 16, v67
    v_and_b32 v10, 0xffff0000, v67
    v_mul_f32 v7, 0.15915494, v7
    v_mul_f32 v8, 0.15915494, v8
    v_mul_f32 v9, 0.15915494, v9
    v_mul_f32 v10, 0.15915494, v10
    v_mul_hi_u32_u24 v14, 429497, v68
    v_lshrrev_b32 v12, 3, v72
    v_cos_f32 v7, v7
    v_lshlrev_b16 v13, 3, v72
    v_mad_i32_i24 v11, v14, s55, v68
    v_bitop3_b32 v12, v6, v13, v12 bitop3:0xca
    v_lshl_add_u32 v11, v11, 17, s40
    v_lshlrev_b16 v14, 8, v14
    v_lshrrev_b32 v13, 2, v72
    v_add_u32 v68, v12, v11
    v_bitop3_b32 v72, v5, v13, v14 bitop3:0xea
    ds_add_u32 v72, v2
    v_mul_hi_u32_u24 v14, 429497, v69
    v_lshrrev_b32 v12, 3, v73
    v_cos_f32 v8, v8
    v_lshlrev_b16 v13, 3, v73
    v_mad_i32_i24 v11, v14, s55, v69
    v_bitop3_b32 v12, v6, v13, v12 bitop3:0xca
    v_lshl_add_u32 v11, v11, 17, s40
    v_lshlrev_b16 v14, 8, v14
    v_lshrrev_b32 v13, 2, v73
    v_add_u32 v69, v12, v11
    v_bitop3_b32 v73, v5, v13, v14 bitop3:0xea
    ds_add_u32 v73, v2
    v_cvt_pk_bf16_f32 v66, v7, v8
    v_perm_b32 v12, v66, v66, s41
    v_bitop3_b32 v68, v4, v12, v68 bitop3:0xca
    v_perm_b32 v13, v66, v66, s42
    v_bitop3_b32 v69, v4, v13, v69 bitop3:0xca
    v_mul_hi_u32_u24 v14, 429497, v70
    v_lshrrev_b32 v12, 3, v74
    v_cos_f32 v9, v9
    v_lshlrev_b16 v13, 3, v74
    v_mad_i32_i24 v11, v14, s55, v70
    v_bitop3_b32 v12, v6, v13, v12 bitop3:0xca
    v_lshl_add_u32 v11, v11, 17, s40
    v_lshlrev_b16 v14, 8, v14
    v_lshrrev_b32 v13, 2, v74
    v_add_u32 v70, v12, v11
    v_bitop3_b32 v74, v5, v13, v14 bitop3:0xea
    ds_add_u32 v74, v2
    v_mul_hi_u32_u24 v14, 429497, v71
    v_lshrrev_b32 v12, 3, v75
    v_cos_f32 v10, v10
    v_lshlrev_b16 v13, 3, v75
    v_mad_i32_i24 v11, v14, s55, v71
    v_bitop3_b32 v12, v6, v13, v12 bitop3:0xca
    v_lshl_add_u32 v11, v11, 17, s40
    v_lshlrev_b16 v14, 8, v14
    v_lshrrev_b32 v13, 2, v75
    v_add_u32 v71, v12, v11
    v_bitop3_b32 v75, v5, v13, v14 bitop3:0xea
    ds_add_u32 v75, v2
    v_cvt_pk_bf16_f32 v67, v9, v10
    v_perm_b32 v12, v67, v67, s41
    v_bitop3_b32 v70, v4, v12, v70 bitop3:0xca
    v_perm_b32 v13, v67, v67, s42
    v_bitop3_b32 v71, v4, v13, v71 bitop3:0xca
    s_setprio 0
    s_add_u32 s44, s97, 0x2400000
    v_lshlrev_b32 v112, 1, v1
    buffer_load_dwordx4 v[112:115], v112, s[8:11], s44 offen nt
    s_waitcnt vmcnt(7)
    v_lshlrev_b32 v7, 16, v84
    v_and_b32 v8, 0xffff0000, v84
    v_lshlrev_b32 v9, 16, v85
    v_and_b32 v10, 0xffff0000, v85
    v_mul_f32 v7, 0.15915494, v7
    v_mul_f32 v8, 0.15915494, v8
    v_mul_f32 v9, 0.15915494, v9
    v_mul_f32 v10, 0.15915494, v10
    v_mul_hi_u32_u24 v14, 429497, v76
    v_lshrrev_b32 v12, 3, v80
    v_cos_f32 v7, v7
    v_lshlrev_b16 v13, 3, v80
    v_mad_i32_i24 v11, v14, s55, v76
    v_bitop3_b32 v12, v6, v13, v12 bitop3:0xca
    v_lshl_add_u32 v11, v11, 17, s40
    v_lshlrev_b16 v14, 8, v14
    v_lshrrev_b32 v13, 2, v80
    v_add_u32 v76, v12, v11
    v_bitop3_b32 v80, v5, v13, v14 bitop3:0xea
    ds_add_u32 v80, v2
    v_mul_hi_u32_u24 v14, 429497, v77
    v_lshrrev_b32 v12, 3, v81
    v_cos_f32 v8, v8
    v_lshlrev_b16 v13, 3, v81
    v_mad_i32_i24 v11, v14, s55, v77
    v_bitop3_b32 v12, v6, v13, v12 bitop3:0xca
    v_lshl_add_u32 v11, v11, 17, s40
    v_lshlrev_b16 v14, 8, v14
    v_lshrrev_b32 v13, 2, v81
    v_add_u32 v77, v12, v11
    v_bitop3_b32 v81, v5, v13, v14 bitop3:0xea
    ds_add_u32 v81, v2
    v_cvt_pk_bf16_f32 v84, v7, v8
    v_perm_b32 v12, v84, v84, s41
    v_bitop3_b32 v76, v4, v12, v76 bitop3:0xca
    v_perm_b32 v13, v84, v84, s42
    v_bitop3_b32 v77, v4, v13, v77 bitop3:0xca
    v_mul_hi_u32_u24 v14, 429497, v78
    v_lshrrev_b32 v12, 3, v82
    v_cos_f32 v9, v9
    v_lshlrev_b16 v13, 3, v82
    v_mad_i32_i24 v11, v14, s55, v78
    v_bitop3_b32 v12, v6, v13, v12 bitop3:0xca
    v_lshl_add_u32 v11, v11, 17, s40
    v_lshlrev_b16 v14, 8, v14
    v_lshrrev_b32 v13, 2, v82
    v_add_u32 v78, v12, v11
    v_bitop3_b32 v82, v5, v13, v14 bitop3:0xea
    ds_add_u32 v82, v2
    v_mul_hi_u32_u24 v14, 429497, v79
    v_lshrrev_b32 v12, 3, v83
    v_cos_f32 v10, v10
    v_lshlrev_b16 v13, 3, v83
    v_mad_i32_i24 v11, v14, s55, v79
    v_bitop3_b32 v12, v6, v13, v12 bitop3:0xca
    v_lshl_add_u32 v11, v11, 17, s40
    v_lshlrev_b16 v14, 8, v14
    v_lshrrev_b32 v13, 2, v83
    v_add_u32 v79, v12, v11
    v_bitop3_b32 v83, v5, v13, v14 bitop3:0xea
    ds_add_u32 v83, v2
    v_cvt_pk_bf16_f32 v85, v9, v10
    v_perm_b32 v12, v85, v85, s41
    v_bitop3_b32 v78, v4, v12, v78 bitop3:0xca
    v_perm_b32 v13, v85, v85, s42
    v_bitop3_b32 v79, v4, v13, v79 bitop3:0xca
    s_waitcnt vmcnt(5)
    v_lshlrev_b32 v7, 16, v86
    v_and_b32 v8, 0xffff0000, v86
    v_lshlrev_b32 v9, 16, v87
    v_and_b32 v10, 0xffff0000, v87
    v_mul_f32 v7, 0.15915494, v7
    v_mul_f32 v8, 0.15915494, v8
    v_mul_f32 v9, 0.15915494, v9
    v_mul_f32 v10, 0.15915494, v10
    v_mul_hi_u32_u24 v14, 429497, v88
    v_lshrrev_b32 v12, 3, v92
    v_cos_f32 v7, v7
    v_lshlrev_b16 v13, 3, v92
    v_mad_i32_i24 v11, v14, s55, v88
    v_bitop3_b32 v12, v6, v13, v12 bitop3:0xca
    v_lshl_add_u32 v11, v11, 17, s40
    v_lshlrev_b16 v14, 8, v14
    v_lshrrev_b32 v13, 2, v92
    v_add_u32 v88, v12, v11
    v_bitop3_b32 v92, v5, v13, v14 bitop3:0xea
    ds_add_u32 v92, v2
    v_mul_hi_u32_u24 v14, 429497, v89
    v_lshrrev_b32 v12, 3, v93
    v_cos_f32 v8, v8
    v_lshlrev_b16 v13, 3, v93
    v_mad_i32_i24 v11, v14, s55, v89
    v_bitop3_b32 v12, v6, v13, v12 bitop3:0xca
    v_lshl_add_u32 v11, v11, 17, s40
    v_lshlrev_b16 v14, 8, v14
    v_lshrrev_b32 v13, 2, v93
    v_add_u32 v89, v12, v11
    v_bitop3_b32 v93, v5, v13, v14 bitop3:0xea
    ds_add_u32 v93, v2
    v_cvt_pk_bf16_f32 v86, v7, v8
    v_perm_b32 v12, v86, v86, s41
    v_bitop3_b32 v88, v4, v12, v88 bitop3:0xca
    v_perm_b32 v13, v86, v86, s42
    v_bitop3_b32 v89, v4, v13, v89 bitop3:0xca
    v_mul_hi_u32_u24 v14, 429497, v90
    v_lshrrev_b32 v12, 3, v94
    v_cos_f32 v9, v9
    v_lshlrev_b16 v13, 3, v94
    v_mad_i32_i24 v11, v14, s55, v90
    v_bitop3_b32 v12, v6, v13, v12 bitop3:0xca
    v_lshl_add_u32 v11, v11, 17, s40
    v_lshlrev_b16 v14, 8, v14
    v_lshrrev_b32 v13, 2, v94
    v_add_u32 v90, v12, v11
    v_bitop3_b32 v94, v5, v13, v14 bitop3:0xea
    ds_add_u32 v94, v2
    v_mul_hi_u32_u24 v14, 429497, v91
    v_lshrrev_b32 v12, 3, v95
    v_cos_f32 v10, v10
    v_lshlrev_b16 v13, 3, v95
    v_mad_i32_i24 v11, v14, s55, v91
    v_bitop3_b32 v12, v6, v13, v12 bitop3:0xca
    v_lshl_add_u32 v11, v11, 17, s40
    v_lshlrev_b16 v14, 8, v14
    v_lshrrev_b32 v13, 2, v95
    v_add_u32 v91, v12, v11
    v_bitop3_b32 v95, v5, v13, v14 bitop3:0xea
    ds_add_u32 v95, v2
    v_cvt_pk_bf16_f32 v87, v9, v10
    v_perm_b32 v12, v87, v87, s41
    v_bitop3_b32 v90, v4, v12, v90 bitop3:0xca
    v_perm_b32 v13, v87, v87, s42
    v_bitop3_b32 v91, v4, v13, v91 bitop3:0xca
    v_lshrrev_b32 v8, 2, v0
    v_and_b32 v7, 0x3c00, v0
    v_bitop3_b32 v7, v5, v8, v7 bitop3:0xea
    s_waitcnt lgkmcnt(0)
    s_barrier
    ds_read2st64_b32 v[8:9], v7 offset0:0 offset1:1
    ds_read2st64_b32 v[10:11], v7 offset0:2 offset1:3
    s_add_u32 s45, s97, 0x2400000
    v_lshlrev_b32 v100, 1, v1
    buffer_load_dwordx4 v[100:103], v100, s[12:15], s45 offen nt
    s_waitcnt lgkmcnt(0)
    v_lshl_or_b32 v12, v9, 16, v8
    v_lshl_or_b32 v13, v11, 16, v10
    v_mov_b32 v14, v12
    v_mov_b32 v15, v13
    s_nop 0
    v_add_u32_dpp v14, v14, v14 row_shr:1 row_mask:0xf bank_mask:0xf bound_ctrl:1
    v_add_u32_dpp v15, v15, v15 row_shr:1 row_mask:0xf bank_mask:0xf bound_ctrl:1
    s_nop 0
    v_add_u32_dpp v14, v14, v14 row_shr:2 row_mask:0xf bank_mask:0xf bound_ctrl:1
    v_add_u32_dpp v15, v15, v15 row_shr:2 row_mask:0xf bank_mask:0xf bound_ctrl:1
    s_nop 0
    v_add_u32_dpp v14, v14, v14 row_shr:4 row_mask:0xf bank_mask:0xf bound_ctrl:1
    v_add_u32_dpp v15, v15, v15 row_shr:4 row_mask:0xf bank_mask:0xf bound_ctrl:1
    s_nop 0
    v_add_u32_dpp v14, v14, v14 row_shr:8 row_mask:0xf bank_mask:0xf bound_ctrl:1
    v_add_u32_dpp v15, v15, v15 row_shr:8 row_mask:0xf bank_mask:0xf bound_ctrl:1
    s_nop 0
    v_add_u32_dpp v14, v14, v14 row_bcast:15 row_mask:0xa bank_mask:0xf
    v_add_u32_dpp v15, v15, v15 row_bcast:15 row_mask:0xa bank_mask:0xf
    s_nop 0
    v_add_u32_dpp v14, v14, v14 row_bcast:31 row_mask:0xc bank_mask:0xf
    v_add_u32_dpp v15, v15, v15 row_bcast:31 row_mask:0xc bank_mask:0xf
    v_readlane_b32 s48, v14, 63
    v_readlane_b32 s49, v15, 63
    s_lshl_b32 s54, s32, 2
    v_mov_b32 v8, s54
    s_and_b32 s50, s48, 0xffff
    s_lshr_b32 s51, s48, 16
    s_and_b32 s52, s49, 0xffff
    s_lshr_b32 s53, s49, 16
    s_add_u32 s51, s51, s50
    s_add_u32 s52, s52, s51
    s_add_u32 s53, s53, s52
    v_mov_b32 v9, s53
    s_mov_b64 exec, 1
    ds_write_b32 v8, v9 offset:16384
    s_mov_b64 exec, -1
    v_and_b32 v8, 60, v7
    s_waitcnt lgkmcnt(0)
    s_barrier
    ds_read_b32 v9, v8 offset:16384
    s_waitcnt lgkmcnt(0)
    v_add_u32_dpp v9, v9, v9 row_shr:1 row_mask:0xf bank_mask:0xf bound_ctrl:1
    s_nop 1
    v_add_u32_dpp v9, v9, v9 row_shr:2 row_mask:0xf bank_mask:0xf bound_ctrl:1
    s_nop 1
    v_add_u32_dpp v9, v9, v9 row_shr:4 row_mask:0xf bank_mask:0xf bound_ctrl:1
    s_nop 1
    v_add_u32_dpp v9, v9, v9 row_shr:8 row_mask:0xf bank_mask:0xf bound_ctrl:1
    s_nop 0
    v_readlane_b32 s54, v9, s32
    s_sub_u32 s54, s54, s53
    s_add_u32 s50, s50, s54
    s_add_u32 s51, s51, s54
    s_add_u32 s52, s52, s54
    s_pack_ll_b32_b16 s48, s54, s50
    s_pack_ll_b32_b16 s49, s51, s52
    v_add_u32 v14, s48, v14
    v_add_u32 v15, s49, v15
    v_sub_u32 v12, v14, v12
    v_sub_u32 v13, v15, v13
    v_and_b32 v8, 0xffff, v12
    v_lshrrev_b32 v9, 16, v12
    v_and_b32 v10, 0xffff, v13
    v_lshrrev_b32 v11, 16, v13
    ds_write2st64_b32 v7, v8, v9 offset0:0 offset1:1
    ds_write2st64_b32 v7, v10, v11 offset0:2 offset1:3
    v_and_b32 v8, 0x3f0, v0
    v_lshl_add_u32 v8, v8, 1, s36
    ds_write_b64 v8, v[12:13] offset:20480
    s_bitset0_b64 exec, 63
    s_not_b64 exec, exec
    ds_write_b64 v8, v[14:15] offset:20512
    s_mov_b64 exec, -1
    s_waitcnt lgkmcnt(0)
    s_barrier
    s_setprio 3
    ds_add_rtn_u32 v20, v20, v2
    ds_add_rtn_u32 v21, v21, v2
    ds_add_rtn_u32 v22, v22, v2
    ds_add_rtn_u32 v23, v23, v2
    ds_read_b128 v[12:15], v0 offset:20480
    v_cmp_gt_u32 vcc, 8448, v0
    ds_add_rtn_u32 v32, v32, v2
    ds_add_rtn_u32 v33, v33, v2
    ds_add_rtn_u32 v34, v34, v2
    ds_add_rtn_u32 v35, v35, v2
    s_setprio 2
    ds_add_rtn_u32 v40, v40, v2
    ds_add_rtn_u32 v41, v41, v2
    ds_add_rtn_u32 v42, v42, v2
    ds_add_rtn_u32 v43, v43, v2
    s_waitcnt lgkmcnt(8)
    s_cbranch_vccz L1_p1
    s_add_u32 s46, s35, 0x0
    s_mov_b64 exec, vcc
    buffer_store_dwordx4 v[12:15], v0, s[24:27], s46 offen sc1
    s_mov_b64 exec, -1
L1_p1:
    s_add_u32 s47, s98, 0x2800000
    v_lshlrev_b32 v116, 1, v1
    buffer_load_dwordx4 v[116:119], v116, s[8:11], s47 offen nt
    ds_add_rtn_u32 v52, v52, v2
    ds_add_rtn_u32 v53, v53, v2
    ds_add_rtn_u32 v54, v54, v2
    ds_add_rtn_u32 v55, v55, v2
    s_setprio 1
    ds_add_rtn_u32 v60, v60, v2
    ds_add_rtn_u32 v61, v61, v2
    ds_add_rtn_u32 v62, v62, v2
    ds_add_rtn_u32 v63, v63, v2
    ds_add_rtn_u32 v72, v72, v2
    ds_add_rtn_u32 v73, v73, v2
    ds_add_rtn_u32 v74, v74, v2
    ds_add_rtn_u32 v75, v75, v2
    s_add_u32 s44, s98, 0x2800000
    v_lshlrev_b32 v120, 1, v1
    buffer_load_dwordx4 v[120:123], v120, s[12:15], s44 offen nt
    s_setprio 0
    ds_add_rtn_u32 v80, v80, v2
    ds_add_rtn_u32 v81, v81, v2
    ds_add_rtn_u32 v82, v82, v2
    ds_add_rtn_u32 v83, v83, v2
    ds_add_rtn_u32 v92, v92, v2
    ds_add_rtn_u32 v93, v93, v2
    ds_add_rtn_u32 v94, v94, v2
    ds_add_rtn_u32 v95, v95, v2
    s_waitcnt lgkmcnt(0)
    s_barrier
    s_setprio 3
    v_and_b32 v7, -4, v20
    v_lshl_add_u32 v8, v20, 2, v7
    ds_write_b32 v8, v16
    v_lshl_add_u32 v7, v7, 2, v20
    ds_write_b8 v7, v24 offset:16
    v_and_b32 v9, -4, v21
    v_lshl_add_u32 v10, v21, 2, v9
    ds_write_b32 v10, v17
    v_lshl_add_u32 v9, v9, 2, v21
    ds_write_b8_d16_hi v9, v24 offset:16
    v_and_b32 v7, -4, v22
    v_lshl_add_u32 v8, v22, 2, v7
    ds_write_b32 v8, v18
    v_lshl_add_u32 v7, v7, 2, v22
    ds_write_b8 v7, v25 offset:16
    v_and_b32 v9, -4, v23
    v_lshl_add_u32 v10, v23, 2, v9
    ds_write_b32 v10, v19
    v_lshl_add_u32 v9, v9, 2, v23
    ds_write_b8_d16_hi v9, v25 offset:16
    s_add_u32 s45, s98, 0x2800000
    s_lshr_b32 s45, s45, 1
    buffer_load_dwordx2 v[124:125], v1, s[16:19], s45 offen nt
    s_add_u32 s46, s99, 0x2c00000
    s_lshr_b32 s46, s46, 1
    buffer_load_dwordx2 v[126:127], v1, s[16:19], s46 offen nt
    s_add_u32 s47, s99, 0x2c00000
    v_lshlrev_b32 v16, 1, v1
    buffer_load_dwordx4 v[16:19], v16, s[8:11], s47 offen nt
    v_and_b32 v7, -4, v32
    v_lshl_add_u32 v8, v32, 2, v7
    ds_write_b32 v8, v28
    v_lshl_add_u32 v7, v7, 2, v32
    ds_write_b8 v7, v26 offset:16
    v_and_b32 v9, -4, v33
    v_lshl_add_u32 v10, v33, 2, v9
    ds_write_b32 v10, v29
    v_lshl_add_u32 v9, v9, 2, v33
    ds_write_b8_d16_hi v9, v26 offset:16
    v_and_b32 v7, -4, v34
    v_lshl_add_u32 v8, v34, 2, v7
    ds_write_b32 v8, v30
    v_lshl_add_u32 v7, v7, 2, v34
    ds_write_b8 v7, v27 offset:16
    v_and_b32 v9, -4, v35
    v_lshl_add_u32 v10, v35, 2, v9
    ds_write_b32 v10, v31
    v_lshl_add_u32 v9, v9, 2, v35
    ds_write_b8_d16_hi v9, v27 offset:16
    s_add_u32 s44, s99, 0x2c00000
    v_lshlrev_b32 v20, 1, v1
    buffer_load_dwordx4 v[20:23], v20, s[12:15], s44 offen nt
    s_setprio 2
    v_and_b32 v7, -4, v40
    v_lshl_add_u32 v8, v40, 2, v7
    ds_write_b32 v8, v36
    v_lshl_add_u32 v7, v7, 2, v40
    ds_write_b8 v7, v44 offset:16
    v_and_b32 v9, -4, v41
    v_lshl_add_u32 v10, v41, 2, v9
    ds_write_b32 v10, v37
    v_lshl_add_u32 v9, v9, 2, v41
    ds_write_b8_d16_hi v9, v44 offset:16
    v_and_b32 v7, -4, v42
    v_lshl_add_u32 v8, v42, 2, v7
    ds_write_b32 v8, v38
    v_lshl_add_u32 v7, v7, 2, v42
    ds_write_b8 v7, v45 offset:16
    v_and_b32 v9, -4, v43
    v_lshl_add_u32 v10, v43, 2, v9
    ds_write_b32 v10, v39
    v_lshl_add_u32 v9, v9, 2, v43
    ds_write_b8_d16_hi v9, v45 offset:16
    s_add_u32 s45, s96, 0x3000000
    v_lshlrev_b32 v28, 1, v1
    buffer_load_dwordx4 v[28:31], v28, s[8:11], s45 offen nt
    s_add_u32 s46, s96, 0x3000000
    v_lshlrev_b32 v32, 1, v1
    buffer_load_dwordx4 v[32:35], v32, s[12:15], s46 offen nt
    v_and_b32 v7, -4, v52
    v_lshl_add_u32 v8, v52, 2, v7
    ds_write_b32 v8, v48
    v_lshl_add_u32 v7, v7, 2, v52
    ds_write_b8 v7, v46 offset:16
    v_and_b32 v9, -4, v53
    v_lshl_add_u32 v10, v53, 2, v9
    ds_write_b32 v10, v49
    v_lshl_add_u32 v9, v9, 2, v53
    ds_write_b8_d16_hi v9, v46 offset:16
    v_and_b32 v7, -4, v54
    v_lshl_add_u32 v8, v54, 2, v7
    ds_write_b32 v8, v50
    v_lshl_add_u32 v7, v7, 2, v54
    ds_write_b8 v7, v47 offset:16
    v_and_b32 v9, -4, v55
    v_lshl_add_u32 v10, v55, 2, v9
    ds_write_b32 v10, v51
    v_lshl_add_u32 v9, v9, 2, v55
    ds_write_b8_d16_hi v9, v47 offset:16
    s_add_u32 s47, s96, 0x3000000
    s_lshr_b32 s47, s47, 1
    buffer_load_dwordx2 v[24:25], v1, s[16:19], s47 offen nt
    s_add_u32 s44, s97, 0x3400000
    s_lshr_b32 s44, s44, 1
    buffer_load_dwordx2 v[26:27], v1, s[16:19], s44 offen nt
    s_setprio 1
    v_and_b32 v7, -4, v60
    v_lshl_add_u32 v8, v60, 2, v7
    ds_write_b32 v8, v56
    v_lshl_add_u32 v7, v7, 2, v60
    ds_write_b8 v7, v64 offset:16
    v_and_b32 v9, -4, v61
    v_lshl_add_u32 v10, v61, 2, v9
    ds_write_b32 v10, v57
    v_lshl_add_u32 v9, v9, 2, v61
    ds_write_b8_d16_hi v9, v64 offset:16
    v_and_b32 v7, -4, v62
    v_lshl_add_u32 v8, v62, 2, v7
    ds_write_b32 v8, v58
    v_lshl_add_u32 v7, v7, 2, v62
    ds_write_b8 v7, v65 offset:16
    v_and_b32 v9, -4, v63
    v_lshl_add_u32 v10, v63, 2, v9
    ds_write_b32 v10, v59
    v_lshl_add_u32 v9, v9, 2, v63
    ds_write_b8_d16_hi v9, v65 offset:16
    s_add_u32 s45, s97, 0x3400000
    v_lshlrev_b32 v36, 1, v1
    buffer_load_dwordx4 v[36:39], v36, s[8:11], s45 offen nt
    v_and_b32 v7, -4, v72
    v_lshl_add_u32 v8, v72, 2, v7
    ds_write_b32 v8, v68
    v_lshl_add_u32 v7, v7, 2, v72
    ds_write_b8 v7, v66 offset:16
    v_and_b32 v9, -4, v73
    v_lshl_add_u32 v10, v73, 2, v9
    ds_write_b32 v10, v69
    v_lshl_add_u32 v9, v9, 2, v73
    ds_write_b8_d16_hi v9, v66 offset:16
    v_and_b32 v7, -4, v74
    v_lshl_add_u32 v8, v74, 2, v7
    ds_write_b32 v8, v70
    v_lshl_add_u32 v7, v7, 2, v74
    ds_write_b8 v7, v67 offset:16
    v_and_b32 v9, -4, v75
    v_lshl_add_u32 v10, v75, 2, v9
    ds_write_b32 v10, v71
    v_lshl_add_u32 v9, v9, 2, v75
    ds_write_b8_d16_hi v9, v67 offset:16
    s_add_u32 s46, s97, 0x3400000
    v_lshlrev_b32 v40, 1, v1
    buffer_load_dwordx4 v[40:43], v40, s[12:15], s46 offen nt
    s_add_u32 s47, s98, 0x3800000
    v_lshlrev_b32 v48, 1, v1
    buffer_load_dwordx4 v[48:51], v48, s[8:11], s47 offen nt
    s_setprio 0
    v_and_b32 v7, -4, v80
    v_lshl_add_u32 v8, v80, 2, v7
    ds_write_b32 v8, v76
    v_lshl_add_u32 v7, v7, 2, v80
    ds_write_b8 v7, v84 offset:16
    v_and_b32 v9, -4, v81
    v_lshl_add_u32 v10, v81, 2, v9
    ds_write_b32 v10, v77
    v_lshl_add_u32 v9, v9, 2, v81
    ds_write_b8_d16_hi v9, v84 offset:16
    v_and_b32 v7, -4, v82
    v_lshl_add_u32 v8, v82, 2, v7
    ds_write_b32 v8, v78
    v_lshl_add_u32 v7, v7, 2, v82
    ds_write_b8 v7, v85 offset:16
    v_and_b32 v9, -4, v83
    v_lshl_add_u32 v10, v83, 2, v9
    ds_write_b32 v10, v79
    v_lshl_add_u32 v9, v9, 2, v83
    ds_write_b8_d16_hi v9, v85 offset:16
    s_add_u32 s44, s98, 0x3800000
    v_lshlrev_b32 v52, 1, v1
    buffer_load_dwordx4 v[52:55], v52, s[12:15], s44 offen nt
    v_and_b32 v7, -4, v92
    v_lshl_add_u32 v8, v92, 2, v7
    ds_write_b32 v8, v88
    v_lshl_add_u32 v7, v7, 2, v92
    ds_write_b8 v7, v86 offset:16
    v_and_b32 v9, -4, v93
    v_lshl_add_u32 v10, v93, 2, v9
    ds_write_b32 v10, v89
    v_lshl_add_u32 v9, v9, 2, v93
    ds_write_b8_d16_hi v9, v86 offset:16
    v_and_b32 v7, -4, v94
    v_lshl_add_u32 v8, v94, 2, v7
    ds_write_b32 v8, v90
    v_lshl_add_u32 v7, v7, 2, v94
    ds_write_b8 v7, v87 offset:16
    v_and_b32 v9, -4, v95
    v_lshl_add_u32 v10, v95, 2, v9
    ds_write_b32 v10, v91
    v_lshl_add_u32 v9, v9, 2, v95
    ds_write_b8_d16_hi v9, v87 offset:16
    s_add_u32 s45, s98, 0x3800000
    s_lshr_b32 s45, s45, 1
    buffer_load_dwordx2 v[44:45], v1, s[16:19], s45 offen nt
    s_add_u32 s46, s99, 0x3c00000
    s_lshr_b32 s46, s46, 1
    buffer_load_dwordx2 v[46:47], v1, s[16:19], s46 offen nt
    v_add_u32 v7, s72, v0
    v_add_u32 v12, s73, v0
    v_add_u32 v13, s85, v0
    v_add_u32 v14, s91, v0
    v_add_u32 v15, s93, v0
    s_min_i32 s3, s72, s73
    s_min_i32 s3, s3, s85
    s_min_i32 s3, s3, s91
    s_min_i32 s3, s3, s93
    v_add_u32 v3, s3, v0
    v_mov_b32 v8, 0
    v_mov_b32 v9, 0
    v_mov_b32 v10, 0
    v_mov_b32 v11, 0
    s_waitcnt lgkmcnt(0)
    s_barrier
    ds_read_b128 v[56:59], v7 offset:0
    ds_read_b128 v[60:63], v12 offset:0
    ds_read_b128 v[68:71], v13 offset:0
    ds_read_b128 v[72:75], v14 offset:0
    ds_read_b128 v[64:67], v15 offset:0
    ds_write_b128 v3, v[8:11]
    ds_read_b128 v[76:79], v7 offset:16384
    ds_read_b128 v[80:83], v12 offset:16384
    ds_read_b128 v[88:91], v13 offset:16384
    ds_read_b128 v[92:95], v14 offset:16384
    ds_read_b128 v[84:87], v15 offset:16384
    s_waitcnt lgkmcnt(0)
    s_barrier
    s_setprio 3
    s_add_u32 s47, s35, 0x4000
    s_add_u32 s47, s47, s72
    buffer_store_dwordx4 v[56:59], v0, s[20:23], s47 offen sc1
    s_add_u32 s44, s99, 0x3c00000
    s_nop 0
    v_lshlrev_b32 v56, 1, v1
    buffer_load_dwordx4 v[56:59], v56, s[8:11], s44 offen nt
    s_add_u32 s45, s35, 0x4000
    s_add_u32 s45, s45, s73
    buffer_store_dwordx4 v[60:63], v0, s[20:23], s45 offen sc1
    s_add_u32 s46, s99, 0x3c00000
    s_nop 0
    v_lshlrev_b32 v60, 1, v1
    buffer_load_dwordx4 v[60:63], v60, s[12:15], s46 offen nt
    s_waitcnt vmcnt(22)
    v_lshlrev_b32 v7, 16, v108
    v_and_b32 v8, 0xffff0000, v108
    v_lshlrev_b32 v9, 16, v109
    v_and_b32 v10, 0xffff0000, v109
    v_mul_f32 v7, 0.15915494, v7
    v_mul_f32 v8, 0.15915494, v8
    v_mul_f32 v9, 0.15915494, v9
    v_mul_f32 v10, 0.15915494, v10
    v_mul_hi_u32_u24 v14, 429497, v96
    v_lshrrev_b32 v12, 3, v104
    v_cos_f32 v7, v7
    v_lshlrev_b16 v13, 3, v104
    v_mad_i32_i24 v11, v14, s55, v96
    v_bitop3_b32 v12, v6, v13, v12 bitop3:0xca
    v_lshl_add_u32 v11, v11, 17, s40
    v_lshlrev_b16 v14, 8, v14
    v_lshrrev_b32 v13, 2, v104
    v_add_u32 v96, v12, v11
    v_bitop3_b32 v104, v5, v13, v14 bitop3:0xea
    ds_add_u32 v104, v2
    v_mul_hi_u32_u24 v14, 429497, v97
    v_lshrrev_b32 v12, 3, v105
    v_cos_f32 v8, v8
    v_lshlrev_b16 v13, 3, v105
    v_mad_i32_i24 v11, v14, s55, v97
    v_bitop3_b32 v12, v6, v13, v12 bitop3:0xca
    v_lshl_add_u32 v11, v11, 17, s40
    v_lshlrev_b16 v14, 8, v14
    v_lshrrev_b32 v13, 2, v105
    v_add_u32 v97, v12, v11
    v_bitop3_b32 v105, v5, v13, v14 bitop3:0xea
    ds_add_u32 v105, v2
    v_cvt_pk_bf16_f32 v108, v7, v8
    v_perm_b32 v12, v108, v108, s41
    v_bitop3_b32 v96, v4, v12, v96 bitop3:0xca
    v_perm_b32 v13, v108, v108, s42
    v_bitop3_b32 v97, v4, v13, v97 bitop3:0xca
    v_mul_hi_u32_u24 v14, 429497, v98
    v_lshrrev_b32 v12, 3, v106
    v_cos_f32 v9, v9
    v_lshlrev_b16 v13, 3, v106
    v_mad_i32_i24 v11, v14, s55, v98
    v_bitop3_b32 v12, v6, v13, v12 bitop3:0xca
    v_lshl_add_u32 v11, v11, 17, s40
    v_lshlrev_b16 v14, 8, v14
    v_lshrrev_b32 v13, 2, v106
    v_add_u32 v98, v12, v11
    v_bitop3_b32 v106, v5, v13, v14 bitop3:0xea
    ds_add_u32 v106, v2
    v_mul_hi_u32_u24 v14, 429497, v99
    v_lshrrev_b32 v12, 3, v107
    v_cos_f32 v10, v10
    v_lshlrev_b16 v13, 3, v107
    v_mad_i32_i24 v11, v14, s55, v99
    v_bitop3_b32 v12, v6, v13, v12 bitop3:0xca
    v_lshl_add_u32 v11, v11, 17, s40
    v_lshlrev_b16 v14, 8, v14
    v_lshrrev_b32 v13, 2, v107
    v_add_u32 v99, v12, v11
    v_bitop3_b32 v107, v5, v13, v14 bitop3:0xea
    ds_add_u32 v107, v2
    v_cvt_pk_bf16_f32 v109, v9, v10
    v_perm_b32 v12, v109, v109, s41
    v_bitop3_b32 v98, v4, v12, v98 bitop3:0xca
    v_perm_b32 v13, v109, v109, s42
    v_bitop3_b32 v99, v4, v13, v99 bitop3:0xca
    s_waitcnt vmcnt(20)
    v_lshlrev_b32 v7, 16, v110
    v_and_b32 v8, 0xffff0000, v110
    v_lshlrev_b32 v9, 16, v111
    v_and_b32 v10, 0xffff0000, v111
    v_mul_f32 v7, 0.15915494, v7
    v_mul_f32 v8, 0.15915494, v8
    v_mul_f32 v9, 0.15915494, v9
    v_mul_f32 v10, 0.15915494, v10
    v_mul_hi_u32_u24 v14, 429497, v112
    v_lshrrev_b32 v12, 3, v100
    v_cos_f32 v7, v7
    v_lshlrev_b16 v13, 3, v100
    v_mad_i32_i24 v11, v14, s55, v112
    v_bitop3_b32 v12, v6, v13, v12 bitop3:0xca
    v_lshl_add_u32 v11, v11, 17, s40
    v_lshlrev_b16 v14, 8, v14
    v_lshrrev_b32 v13, 2, v100
    v_add_u32 v112, v12, v11
    v_bitop3_b32 v100, v5, v13, v14 bitop3:0xea
    ds_add_u32 v100, v2
    v_mul_hi_u32_u24 v14, 429497, v113
    v_lshrrev_b32 v12, 3, v101
    v_cos_f32 v8, v8
    v_lshlrev_b16 v13, 3, v101
    v_mad_i32_i24 v11, v14, s55, v113
    v_bitop3_b32 v12, v6, v13, v12 bitop3:0xca
    v_lshl_add_u32 v11, v11, 17, s40
    v_lshlrev_b16 v14, 8, v14
    v_lshrrev_b32 v13, 2, v101
    v_add_u32 v113, v12, v11
    v_bitop3_b32 v101, v5, v13, v14 bitop3:0xea
    ds_add_u32 v101, v2
    v_cvt_pk_bf16_f32 v110, v7, v8
    v_perm_b32 v12, v110, v110, s41
    v_bitop3_b32 v112, v4, v12, v112 bitop3:0xca
    v_perm_b32 v13, v110, v110, s42
    v_bitop3_b32 v113, v4, v13, v113 bitop3:0xca
    v_mul_hi_u32_u24 v14, 429497, v114
    v_lshrrev_b32 v12, 3, v102
    v_cos_f32 v9, v9
    v_lshlrev_b16 v13, 3, v102
    v_mad_i32_i24 v11, v14, s55, v114
    v_bitop3_b32 v12, v6, v13, v12 bitop3:0xca
    v_lshl_add_u32 v11, v11, 17, s40
    v_lshlrev_b16 v14, 8, v14
    v_lshrrev_b32 v13, 2, v102
    v_add_u32 v114, v12, v11
    v_bitop3_b32 v102, v5, v13, v14 bitop3:0xea
    ds_add_u32 v102, v2
    v_mul_hi_u32_u24 v14, 429497, v115
    v_lshrrev_b32 v12, 3, v103
    v_cos_f32 v10, v10
    v_lshlrev_b16 v13, 3, v103
    v_mad_i32_i24 v11, v14, s55, v115
    v_bitop3_b32 v12, v6, v13, v12 bitop3:0xca
    v_lshl_add_u32 v11, v11, 17, s40
    v_lshlrev_b16 v14, 8, v14
    v_lshrrev_b32 v13, 2, v103
    v_add_u32 v115, v12, v11
    v_bitop3_b32 v103, v5, v13, v14 bitop3:0xea
    ds_add_u32 v103, v2
    v_cvt_pk_bf16_f32 v111, v9, v10
    v_perm_b32 v12, v111, v111, s41
    v_bitop3_b32 v114, v4, v12, v114 bitop3:0xca
    v_perm_b32 v13, v111, v111, s42
    v_bitop3_b32 v115, v4, v13, v115 bitop3:0xca
    s_setprio 2
    s_waitcnt vmcnt(16)
    v_lshlrev_b32 v7, 16, v124
    v_and_b32 v8, 0xffff0000, v124
    v_lshlrev_b32 v9, 16, v125
    v_and_b32 v10, 0xffff0000, v125
    v_mul_f32 v7, 0.15915494, v7
    v_mul_f32 v8, 0.15915494, v8
    v_mul_f32 v9, 0.15915494, v9
    v_mul_f32 v10, 0.15915494, v10
    v_mul_hi_u32_u24 v14, 429497, v116
    v_lshrrev_b32 v12, 3, v120
    v_cos_f32 v7, v7
    v_lshlrev_b16 v13, 3, v120
    v_mad_i32_i24 v11, v14, s55, v116
    v_bitop3_b32 v12, v6, v13, v12 bitop3:0xca
    v_lshl_add_u32 v11, v11, 17, s40
    v_lshlrev_b16 v14, 8, v14
    v_lshrrev_b32 v13, 2, v120
    v_add_u32 v116, v12, v11
    v_bitop3_b32 v120, v5, v13, v14 bitop3:0xea
    ds_add_u32 v120, v2
    v_mul_hi_u32_u24 v14, 429497, v117
    v_lshrrev_b32 v12, 3, v121
    v_cos_f32 v8, v8
    v_lshlrev_b16 v13, 3, v121
    v_mad_i32_i24 v11, v14, s55, v117
    v_bitop3_b32 v12, v6, v13, v12 bitop3:0xca
    v_lshl_add_u32 v11, v11, 17, s40
    v_lshlrev_b16 v14, 8, v14
    v_lshrrev_b32 v13, 2, v121
    v_add_u32 v117, v12, v11
    v_bitop3_b32 v121, v5, v13, v14 bitop3:0xea
    ds_add_u32 v121, v2
    v_cvt_pk_bf16_f32 v124, v7, v8
    v_perm_b32 v12, v124, v124, s41
    v_bitop3_b32 v116, v4, v12, v116 bitop3:0xca
    v_perm_b32 v13, v124, v124, s42
    v_bitop3_b32 v117, v4, v13, v117 bitop3:0xca
    v_mul_hi_u32_u24 v14, 429497, v118
    v_lshrrev_b32 v12, 3, v122
    v_cos_f32 v9, v9
    v_lshlrev_b16 v13, 3, v122
    v_mad_i32_i24 v11, v14, s55, v118
    v_bitop3_b32 v12, v6, v13, v12 bitop3:0xca
    v_lshl_add_u32 v11, v11, 17, s40
    v_lshlrev_b16 v14, 8, v14
    v_lshrrev_b32 v13, 2, v122
    v_add_u32 v118, v12, v11
    v_bitop3_b32 v122, v5, v13, v14 bitop3:0xea
    ds_add_u32 v122, v2
    v_mul_hi_u32_u24 v14, 429497, v119
    v_lshrrev_b32 v12, 3, v123
    v_cos_f32 v10, v10
    v_lshlrev_b16 v13, 3, v123
    v_mad_i32_i24 v11, v14, s55, v119
    v_bitop3_b32 v12, v6, v13, v12 bitop3:0xca
    v_lshl_add_u32 v11, v11, 17, s40
    v_lshlrev_b16 v14, 8, v14
    v_lshrrev_b32 v13, 2, v123
    v_add_u32 v119, v12, v11
    v_bitop3_b32 v123, v5, v13, v14 bitop3:0xea
    ds_add_u32 v123, v2
    v_cvt_pk_bf16_f32 v125, v9, v10
    v_perm_b32 v12, v125, v125, s41
    v_bitop3_b32 v118, v4, v12, v118 bitop3:0xca
    v_perm_b32 v13, v125, v125, s42
    v_bitop3_b32 v119, v4, v13, v119 bitop3:0xca
    s_add_u32 s47, s35, 0x4000
    s_add_u32 s47, s47, s85
    buffer_store_dwordx4 v[68:71], v0, s[20:23], s47 offen sc1
    s_add_u32 s44, s96, 0x4000000
    s_nop 0
    v_lshlrev_b32 v68, 1, v1
    buffer_load_dwordx4 v[68:71], v68, s[8:11], s44 offen nt
    s_waitcnt vmcnt(16)
    v_lshlrev_b32 v7, 16, v126
    v_and_b32 v8, 0xffff0000, v126
    v_lshlrev_b32 v9, 16, v127
    v_and_b32 v10, 0xffff0000, v127
    v_mul_f32 v7, 0.15915494, v7
    v_mul_f32 v8, 0.15915494, v8
    v_mul_f32 v9, 0.15915494, v9
    v_mul_f32 v10, 0.15915494, v10
    v_mul_hi_u32_u24 v14, 429497, v16
    v_lshrrev_b32 v12, 3, v20
    v_cos_f32 v7, v7
    v_lshlrev_b16 v13, 3, v20
    v_mad_i32_i24 v11, v14, s55, v16
    v_bitop3_b32 v12, v6, v13, v12 bitop3:0xca
    v_lshl_add_u32 v11, v11, 17, s40
    v_lshlrev_b16 v14, 8, v14
    v_lshrrev_b32 v13, 2, v20
    v_add_u32 v16, v12, v11
    v_bitop3_b32 v20, v5, v13, v14 bitop3:0xea
    ds_add_u32 v20, v2
    v_mul_hi_u32_u24 v14, 429497, v17
    v_lshrrev_b32 v12, 3, v21
    v_cos_f32 v8, v8
    v_lshlrev_b16 v13, 3, v21
    v_mad_i32_i24 v11, v14, s55, v17
    v_bitop3_b32 v12, v6, v13, v12 bitop3:0xca
    v_lshl_add_u32 v11, v11, 17, s40
    v_lshlrev_b16 v14, 8, v14
    v_lshrrev_b32 v13, 2, v21
    v_add_u32 v17, v12, v11
    v_bitop3_b32 v21, v5, v13, v14 bitop3:0xea
    ds_add_u32 v21, v2
    v_cvt_pk_bf16_f32 v126, v7, v8
    v_perm_b32 v12, v126, v126, s41
    v_bitop3_b32 v16, v4, v12, v16 bitop3:0xca
    v_perm_b32 v13, v126, v126, s42
    v_bitop3_b32 v17, v4, v13, v17 bitop3:0xca
    v_mul_hi_u32_u24 v14, 429497, v18
    v_lshrrev_b32 v12, 3, v22
    v_cos_f32 v9, v9
    v_lshlrev_b16 v13, 3, v22
    v_mad_i32_i24 v11, v14, s55, v18
    v_bitop3_b32 v12, v6, v13, v12 bitop3:0xca
    v_lshl_add_u32 v11, v11, 17, s40
    v_lshlrev_b16 v14, 8, v14
    v_lshrrev_b32 v13, 2, v22
    v_add_u32 v18, v12, v11
    v_bitop3_b32 v22, v5, v13, v14 bitop3:0xea
    ds_add_u32 v22, v2
    v_mul_hi_u32_u24 v14, 429497, v19
    v_lshrrev_b32 v12, 3, v23
    v_cos_f32 v10, v10
    v_lshlrev_b16 v13, 3, v23
    v_mad_i32_i24 v11, v14, s55, v19
    v_bitop3_b32 v12, v6, v13, v12 bitop3:0xca
    v_lshl_add_u32 v11, v11, 17, s40
    v_lshlrev_b16 v14, 8, v14
    v_lshrrev_b32 v13, 2, v23
    v_add_u32 v19, v12, v11
    v_bitop3_b32 v23, v5, v13, v14 bitop3:0xea
    ds_add_u32 v23, v2
    v_cvt_pk_bf16_f32 v127, v9, v10
    v_perm_b32 v12, v127, v127, s41
    v_bitop3_b32 v18, v4, v12, v18 bitop3:0xca
    v_perm_b32 v13, v127, v127, s42
    v_bitop3_b32 v19, v4, v13, v19 bitop3:0xca
    s_setprio 1
    s_waitcnt vmcnt(12)
    v_lshlrev_b32 v7, 16, v24
    v_and_b32 v8, 0xffff0000, v24
    v_lshlrev_b32 v9, 16, v25
    v_and_b32 v10, 0xffff0000, v25
    v_mul_f32 v7, 0.15915494, v7
    v_mul_f32 v8, 0.15915494, v8
    v_mul_f32 v9, 0.15915494, v9
    v_mul_f32 v10, 0.15915494, v10
    v_mul_hi_u32_u24 v14, 429497, v28
    v_lshrrev_b32 v12, 3, v32
    v_cos_f32 v7, v7
    v_lshlrev_b16 v13, 3, v32
    v_mad_i32_i24 v11, v14, s55, v28
    v_bitop3_b32 v12, v6, v13, v12 bitop3:0xca
    v_lshl_add_u32 v11, v11, 17, s40
    v_lshlrev_b16 v14, 8, v14
    v_lshrrev_b32 v13, 2, v32
    v_add_u32 v28, v12, v11
    v_bitop3_b32 v32, v5, v13, v14 bitop3:0xea
    ds_add_u32 v32, v2
    v_mul_hi_u32_u24 v14, 429497, v29
    v_lshrrev_b32 v12, 3, v33
    v_cos_f32 v8, v8
    v_lshlrev_b16 v13, 3, v33
    v_mad_i32_i24 v11, v14, s55, v29
    v_bitop3_b32 v12, v6, v13, v12 bitop3:0xca
    v_lshl_add_u32 v11, v11, 17, s40
    v_lshlrev_b16 v14, 8, v14
    v_lshrrev_b32 v13, 2, v33
    v_add_u32 v29, v12, v11
    v_bitop3_b32 v33, v5, v13, v14 bitop3:0xea
    ds_add_u32 v33, v2
    v_cvt_pk_bf16_f32 v24, v7, v8
    v_perm_b32 v12, v24, v24, s41
    v_bitop3_b32 v28, v4, v12, v28 bitop3:0xca
    v_perm_b32 v13, v24, v24, s42
    v_bitop3_b32 v29, v4, v13, v29 bitop3:0xca
    v_mul_hi_u32_u24 v14, 429497, v30
    v_lshrrev_b32 v12, 3, v34
    v_cos_f32 v9, v9
    v_lshlrev_b16 v13, 3, v34
    v_mad_i32_i24 v11, v14, s55, v30
    v_bitop3_b32 v12, v6, v13, v12 bitop3:0xca
    v_lshl_add_u32 v11, v11, 17, s40
    v_lshlrev_b16 v14, 8, v14
    v_lshrrev_b32 v13, 2, v34
    v_add_u32 v30, v12, v11
    v_bitop3_b32 v34, v5, v13, v14 bitop3:0xea
    ds_add_u32 v34, v2
    v_mul_hi_u32_u24 v14, 429497, v31
    v_lshrrev_b32 v12, 3, v35
    v_cos_f32 v10, v10
    v_lshlrev_b16 v13, 3, v35
    v_mad_i32_i24 v11, v14, s55, v31
    v_bitop3_b32 v12, v6, v13, v12 bitop3:0xca
    v_lshl_add_u32 v11, v11, 17, s40
    v_lshlrev_b16 v14, 8, v14
    v_lshrrev_b32 v13, 2, v35
    v_add_u32 v31, v12, v11
    v_bitop3_b32 v35, v5, v13, v14 bitop3:0xea
    ds_add_u32 v35, v2
    v_cvt_pk_bf16_f32 v25, v9, v10
    v_perm_b32 v12, v25, v25, s41
    v_bitop3_b32 v30, v4, v12, v30 bitop3:0xca
    v_perm_b32 v13, v25, v25, s42
    v_bitop3_b32 v31, v4, v13, v31 bitop3:0xca
    s_waitcnt vmcnt(10)
    v_lshlrev_b32 v7, 16, v26
    v_and_b32 v8, 0xffff0000, v26
    v_lshlrev_b32 v9, 16, v27
    v_and_b32 v10, 0xffff0000, v27
    v_mul_f32 v7, 0.15915494, v7
    v_mul_f32 v8, 0.15915494, v8
    v_mul_f32 v9, 0.15915494, v9
    v_mul_f32 v10, 0.15915494, v10
    v_mul_hi_u32_u24 v14, 429497, v36
    v_lshrrev_b32 v12, 3, v40
    v_cos_f32 v7, v7
    v_lshlrev_b16 v13, 3, v40
    v_mad_i32_i24 v11, v14, s55, v36
    v_bitop3_b32 v12, v6, v13, v12 bitop3:0xca
    v_lshl_add_u32 v11, v11, 17, s40
    v_lshlrev_b16 v14, 8, v14
    v_lshrrev_b32 v13, 2, v40
    v_add_u32 v36, v12, v11
    v_bitop3_b32 v40, v5, v13, v14 bitop3:0xea
    ds_add_u32 v40, v2
    v_mul_hi_u32_u24 v14, 429497, v37
    v_lshrrev_b32 v12, 3, v41
    v_cos_f32 v8, v8
    v_lshlrev_b16 v13, 3, v41
    v_mad_i32_i24 v11, v14, s55, v37
    v_bitop3_b32 v12, v6, v13, v12 bitop3:0xca
    v_lshl_add_u32 v11, v11, 17, s40
    v_lshlrev_b16 v14, 8, v14
    v_lshrrev_b32 v13, 2, v41
    v_add_u32 v37, v12, v11
    v_bitop3_b32 v41, v5, v13, v14 bitop3:0xea
    ds_add_u32 v41, v2
    v_cvt_pk_bf16_f32 v26, v7, v8
    v_perm_b32 v12, v26, v26, s41
    v_bitop3_b32 v36, v4, v12, v36 bitop3:0xca
    v_perm_b32 v13, v26, v26, s42
    v_bitop3_b32 v37, v4, v13, v37 bitop3:0xca
    v_mul_hi_u32_u24 v14, 429497, v38
    v_lshrrev_b32 v12, 3, v42
    v_cos_f32 v9, v9
    v_lshlrev_b16 v13, 3, v42
    v_mad_i32_i24 v11, v14, s55, v38
    v_bitop3_b32 v12, v6, v13, v12 bitop3:0xca
    v_lshl_add_u32 v11, v11, 17, s40
    v_lshlrev_b16 v14, 8, v14
    v_lshrrev_b32 v13, 2, v42
    v_add_u32 v38, v12, v11
    v_bitop3_b32 v42, v5, v13, v14 bitop3:0xea
    ds_add_u32 v42, v2
    v_mul_hi_u32_u24 v14, 429497, v39
    v_lshrrev_b32 v12, 3, v43
    v_cos_f32 v10, v10
    v_lshlrev_b16 v13, 3, v43
    v_mad_i32_i24 v11, v14, s55, v39
    v_bitop3_b32 v12, v6, v13, v12 bitop3:0xca
    v_lshl_add_u32 v11, v11, 17, s40
    v_lshlrev_b16 v14, 8, v14
    v_lshrrev_b32 v13, 2, v43
    v_add_u32 v39, v12, v11
    v_bitop3_b32 v43, v5, v13, v14 bitop3:0xea
    ds_add_u32 v43, v2
    v_cvt_pk_bf16_f32 v27, v9, v10
    v_perm_b32 v12, v27, v27, s41
    v_bitop3_b32 v38, v4, v12, v38 bitop3:0xca
    v_perm_b32 v13, v27, v27, s42
    v_bitop3_b32 v39, v4, v13, v39 bitop3:0xca
    s_setprio 0
    s_add_u32 s45, s35, 0x4000
    s_add_u32 s45, s45, s91
    buffer_store_dwordx4 v[72:75], v0, s[20:23], s45 offen sc1
    s_add_u32 s46, s96, 0x4000000
    s_nop 0
    v_lshlrev_b32 v72, 1, v1
    buffer_load_dwordx4 v[72:75], v72, s[12:15], s46 offen nt
    s_waitcnt vmcnt(8)
    v_lshlrev_b32 v7, 16, v44
    v_and_b32 v8, 0xffff0000, v44
    v_lshlrev_b32 v9, 16, v45
    v_and_b32 v10, 0xffff0000, v45
    v_mul_f32 v7, 0.15915494, v7
    v_mul_f32 v8, 0.15915494, v8
    v_mul_f32 v9, 0.15915494, v9
    v_mul_f32 v10, 0.15915494, v10
    v_mul_hi_u32_u24 v14, 429497, v48
    v_lshrrev_b32 v12, 3, v52
    v_cos_f32 v7, v7
    v_lshlrev_b16 v13, 3, v52
    v_mad_i32_i24 v11, v14, s55, v48
    v_bitop3_b32 v12, v6, v13, v12 bitop3:0xca
    v_lshl_add_u32 v11, v11, 17, s40
    v_lshlrev_b16 v14, 8, v14
    v_lshrrev_b32 v13, 2, v52
    v_add_u32 v48, v12, v11
    v_bitop3_b32 v52, v5, v13, v14 bitop3:0xea
    ds_add_u32 v52, v2
    v_mul_hi_u32_u24 v14, 429497, v49
    v_lshrrev_b32 v12, 3, v53
    v_cos_f32 v8, v8
    v_lshlrev_b16 v13, 3, v53
    v_mad_i32_i24 v11, v14, s55, v49
    v_bitop3_b32 v12, v6, v13, v12 bitop3:0xca
    v_lshl_add_u32 v11, v11, 17, s40
    v_lshlrev_b16 v14, 8, v14
    v_lshrrev_b32 v13, 2, v53
    v_add_u32 v49, v12, v11
    v_bitop3_b32 v53, v5, v13, v14 bitop3:0xea
    ds_add_u32 v53, v2
    v_cvt_pk_bf16_f32 v44, v7, v8
    v_perm_b32 v12, v44, v44, s41
    v_bitop3_b32 v48, v4, v12, v48 bitop3:0xca
    v_perm_b32 v13, v44, v44, s42
    v_bitop3_b32 v49, v4, v13, v49 bitop3:0xca
    v_mul_hi_u32_u24 v14, 429497, v50
    v_lshrrev_b32 v12, 3, v54
    v_cos_f32 v9, v9
    v_lshlrev_b16 v13, 3, v54
    v_mad_i32_i24 v11, v14, s55, v50
    v_bitop3_b32 v12, v6, v13, v12 bitop3:0xca
    v_lshl_add_u32 v11, v11, 17, s40
    v_lshlrev_b16 v14, 8, v14
    v_lshrrev_b32 v13, 2, v54
    v_add_u32 v50, v12, v11
    v_bitop3_b32 v54, v5, v13, v14 bitop3:0xea
    ds_add_u32 v54, v2
    v_mul_hi_u32_u24 v14, 429497, v51
    v_lshrrev_b32 v12, 3, v55
    v_cos_f32 v10, v10
    v_lshlrev_b16 v13, 3, v55
    v_mad_i32_i24 v11, v14, s55, v51
    v_bitop3_b32 v12, v6, v13, v12 bitop3:0xca
    v_lshl_add_u32 v11, v11, 17, s40
    v_lshlrev_b16 v14, 8, v14
    v_lshrrev_b32 v13, 2, v55
    v_add_u32 v51, v12, v11
    v_bitop3_b32 v55, v5, v13, v14 bitop3:0xea
    ds_add_u32 v55, v2
    v_cvt_pk_bf16_f32 v45, v9, v10
    v_perm_b32 v12, v45, v45, s41
    v_bitop3_b32 v50, v4, v12, v50 bitop3:0xca
    v_perm_b32 v13, v45, v45, s42
    v_bitop3_b32 v51, v4, v13, v51 bitop3:0xca
    s_waitcnt vmcnt(4)
    v_lshlrev_b32 v7, 16, v46
    v_and_b32 v8, 0xffff0000, v46
    v_lshlrev_b32 v9, 16, v47
    v_and_b32 v10, 0xffff0000, v47
    v_mul_f32 v7, 0.15915494, v7
    v_mul_f32 v8, 0.15915494, v8
    v_mul_f32 v9, 0.15915494, v9
    v_mul_f32 v10, 0.15915494, v10
    v_mul_hi_u32_u24 v14, 429497, v56
    v_lshrrev_b32 v12, 3, v60
    v_cos_f32 v7, v7
    v_lshlrev_b16 v13, 3, v60
    v_mad_i32_i24 v11, v14, s55, v56
    v_bitop3_b32 v12, v6, v13, v12 bitop3:0xca
    v_lshl_add_u32 v11, v11, 17, s40
    v_lshlrev_b16 v14, 8, v14
    v_lshrrev_b32 v13, 2, v60
    v_add_u32 v56, v12, v11
    v_bitop3_b32 v60, v5, v13, v14 bitop3:0xea
    ds_add_u32 v60, v2
    v_mul_hi_u32_u24 v14, 429497, v57
    v_lshrrev_b32 v12, 3, v61
    v_cos_f32 v8, v8
    v_lshlrev_b16 v13, 3, v61
    v_mad_i32_i24 v11, v14, s55, v57
    v_bitop3_b32 v12, v6, v13, v12 bitop3:0xca
    v_lshl_add_u32 v11, v11, 17, s40
    v_lshlrev_b16 v14, 8, v14
    v_lshrrev_b32 v13, 2, v61
    v_add_u32 v57, v12, v11
    v_bitop3_b32 v61, v5, v13, v14 bitop3:0xea
    ds_add_u32 v61, v2
    v_cvt_pk_bf16_f32 v46, v7, v8
    v_perm_b32 v12, v46, v46, s41
    v_bitop3_b32 v56, v4, v12, v56 bitop3:0xca
    v_perm_b32 v13, v46, v46, s42
    v_bitop3_b32 v57, v4, v13, v57 bitop3:0xca
    v_mul_hi_u32_u24 v14, 429497, v58
    v_lshrrev_b32 v12, 3, v62
    v_cos_f32 v9, v9
    v_lshlrev_b16 v13, 3, v62
    v_mad_i32_i24 v11, v14, s55, v58
    v_bitop3_b32 v12, v6, v13, v12 bitop3:0xca
    v_lshl_add_u32 v11, v11, 17, s40
    v_lshlrev_b16 v14, 8, v14
    v_lshrrev_b32 v13, 2, v62
    v_add_u32 v58, v12, v11
    v_bitop3_b32 v62, v5, v13, v14 bitop3:0xea
    ds_add_u32 v62, v2
    v_mul_hi_u32_u24 v14, 429497, v59
    v_lshrrev_b32 v12, 3, v63
    v_cos_f32 v10, v10
    v_lshlrev_b16 v13, 3, v63
    v_mad_i32_i24 v11, v14, s55, v59
    v_bitop3_b32 v12, v6, v13, v12 bitop3:0xca
    v_lshl_add_u32 v11, v11, 17, s40
    v_lshlrev_b16 v14, 8, v14
    v_lshrrev_b32 v13, 2, v63
    v_add_u32 v59, v12, v11
    v_bitop3_b32 v63, v5, v13, v14 bitop3:0xea
    ds_add_u32 v63, v2
    v_cvt_pk_bf16_f32 v47, v9, v10
    v_perm_b32 v12, v47, v47, s41
    v_bitop3_b32 v58, v4, v12, v58 bitop3:0xca
    v_perm_b32 v13, v47, v47, s42
    v_bitop3_b32 v59, v4, v13, v59 bitop3:0xca
    v_lshrrev_b32 v8, 2, v0
    v_and_b32 v7, 0x3c00, v0
    v_bitop3_b32 v7, v5, v8, v7 bitop3:0xea
    s_waitcnt lgkmcnt(0)
    s_barrier
    ds_read2st64_b32 v[8:9], v7 offset0:0 offset1:1
    ds_read2st64_b32 v[10:11], v7 offset0:2 offset1:3
    s_add_u32 s47, s35, 0x4000
    s_add_u32 s47, s47, s93
    buffer_store_dwordx4 v[64:67], v0, s[20:23], s47 offen sc1
    s_add_u32 s44, s96, 0x4000000
    s_lshr_b32 s44, s44, 1
    buffer_load_dwordx2 v[64:65], v1, s[16:19], s44 offen nt
    s_add_u32 s45, s97, 0x4400000
    s_lshr_b32 s45, s45, 1
    buffer_load_dwordx2 v[66:67], v1, s[16:19], s45 offen nt
    s_waitcnt lgkmcnt(0)
    v_lshl_or_b32 v12, v9, 16, v8
    v_lshl_or_b32 v13, v11, 16, v10
    v_mov_b32 v14, v12
    v_mov_b32 v15, v13
    s_nop 0
    v_add_u32_dpp v14, v14, v14 row_shr:1 row_mask:0xf bank_mask:0xf bound_ctrl:1
    v_add_u32_dpp v15, v15, v15 row_shr:1 row_mask:0xf bank_mask:0xf bound_ctrl:1
    s_nop 0
    v_add_u32_dpp v14, v14, v14 row_shr:2 row_mask:0xf bank_mask:0xf bound_ctrl:1
    v_add_u32_dpp v15, v15, v15 row_shr:2 row_mask:0xf bank_mask:0xf bound_ctrl:1
    s_nop 0
    v_add_u32_dpp v14, v14, v14 row_shr:4 row_mask:0xf bank_mask:0xf bound_ctrl:1
    v_add_u32_dpp v15, v15, v15 row_shr:4 row_mask:0xf bank_mask:0xf bound_ctrl:1
    s_nop 0
    v_add_u32_dpp v14, v14, v14 row_shr:8 row_mask:0xf bank_mask:0xf bound_ctrl:1
    v_add_u32_dpp v15, v15, v15 row_shr:8 row_mask:0xf bank_mask:0xf bound_ctrl:1
    s_nop 0
    v_add_u32_dpp v14, v14, v14 row_bcast:15 row_mask:0xa bank_mask:0xf
    v_add_u32_dpp v15, v15, v15 row_bcast:15 row_mask:0xa bank_mask:0xf
    s_nop 0
    v_add_u32_dpp v14, v14, v14 row_bcast:31 row_mask:0xc bank_mask:0xf
    v_add_u32_dpp v15, v15, v15 row_bcast:31 row_mask:0xc bank_mask:0xf
    v_readlane_b32 s48, v14, 63
    v_readlane_b32 s49, v15, 63
    s_lshl_b32 s54, s32, 2
    v_mov_b32 v8, s54
    s_and_b32 s50, s48, 0xffff
    s_lshr_b32 s51, s48, 16
    s_and_b32 s52, s49, 0xffff
    s_lshr_b32 s53, s49, 16
    s_add_u32 s51, s51, s50
    s_add_u32 s52, s52, s51
    s_add_u32 s53, s53, s52
    v_mov_b32 v9, s53
    s_mov_b64 exec, 1
    ds_write_b32 v8, v9 offset:16384
    s_mov_b64 exec, -1
    v_and_b32 v8, 60, v7
    s_waitcnt lgkmcnt(0)
    s_barrier
    ds_read_b32 v9, v8 offset:16384
    s_waitcnt lgkmcnt(0)
    v_add_u32_dpp v9, v9, v9 row_shr:1 row_mask:0xf bank_mask:0xf bound_ctrl:1
    s_nop 1
    v_add_u32_dpp v9, v9, v9 row_shr:2 row_mask:0xf bank_mask:0xf bound_ctrl:1
    s_nop 1
    v_add_u32_dpp v9, v9, v9 row_shr:4 row_mask:0xf bank_mask:0xf bound_ctrl:1
    s_nop 1
    v_add_u32_dpp v9, v9, v9 row_shr:8 row_mask:0xf bank_mask:0xf bound_ctrl:1
    s_nop 0
    v_readlane_b32 s54, v9, s32
    s_sub_u32 s54, s54, s53
    s_add_u32 s50, s50, s54
    s_add_u32 s51, s51, s54
    s_add_u32 s52, s52, s54
    s_pack_ll_b32_b16 s48, s54, s50
    s_pack_ll_b32_b16 s49, s51, s52
    v_add_u32 v14, s48, v14
    v_add_u32 v15, s49, v15
    v_sub_u32 v12, v14, v12
    v_sub_u32 v13, v15, v13
    v_and_b32 v8, 0xffff, v12
    v_lshrrev_b32 v9, 16, v12
    v_and_b32 v10, 0xffff, v13
    v_lshrrev_b32 v11, 16, v13
    ds_write2st64_b32 v7, v8, v9 offset0:0 offset1:1
    ds_write2st64_b32 v7, v10, v11 offset0:2 offset1:3
    v_and_b32 v8, 0x3f0, v0
    v_lshl_add_u32 v8, v8, 1, s36
    ds_write_b64 v8, v[12:13] offset:20480
    s_bitset0_b64 exec, 63
    s_not_b64 exec, exec
    ds_write_b64 v8, v[14:15] offset:20512
    s_mov_b64 exec, -1
    s_waitcnt lgkmcnt(0)
    s_barrier
    s_setprio 3
    ds_add_rtn_u32 v104, v104, v2
    ds_add_rtn_u32 v105, v105, v2
    ds_add_rtn_u32 v106, v106, v2
    ds_add_rtn_u32 v107, v107, v2
    ds_read_b128 v[12:15], v0 offset:20480
    v_cmp_gt_u32 vcc, 8448, v0
    ds_add_rtn_u32 v100, v100, v2
    ds_add_rtn_u32 v101, v101, v2
    ds_add_rtn_u32 v102, v102, v2
    ds_add_rtn_u32 v103, v103, v2
    s_setprio 2
    ds_add_rtn_u32 v120, v120, v2
    ds_add_rtn_u32 v121, v121, v2
    ds_add_rtn_u32 v122, v122, v2
    ds_add_rtn_u32 v123, v123, v2
    s_waitcnt lgkmcnt(8)
    s_cbranch_vccz L1_p2
    s_add_u32 s46, s35, 0x2a40000
    s_mov_b64 exec, vcc
    buffer_store_dwordx4 v[12:15], v0, s[24:27], s46 offen sc1
    s_mov_b64 exec, -1
L1_p2:
    s_add_u32 s47, s35, 0x8000
    s_add_u32 s47, s47, s72
    buffer_store_dwordx4 v[76:79], v0, s[20:23], s47 offen sc1
    s_add_u32 s44, s97, 0x4400000
    s_nop 0
    v_lshlrev_b32 v76, 1, v1
    buffer_load_dwordx4 v[76:79], v76, s[8:11], s44 offen nt
    ds_add_rtn_u32 v20, v20, v2
    ds_add_rtn_u32 v21, v21, v2
    ds_add_rtn_u32 v22, v22, v2
    ds_add_rtn_u32 v23, v23, v2
    s_setprio 1
    ds_add_rtn_u32 v32, v32, v2
    ds_add_rtn_u32 v33, v33, v2
    ds_add_rtn_u32 v34, v34, v2
    ds_add_rtn_u32 v35, v35, v2
    ds_add_rtn_u32 v40, v40, v2
    ds_add_rtn_u32 v41, v41, v2
    ds_add_rtn_u32 v42, v42, v2
    ds_add_rtn_u32 v43, v43, v2
    s_add_u32 s45, s35, 0x8000
    s_add_u32 s45, s45, s73
    buffer_store_dwordx4 v[80:83], v0, s[20:23], s45 offen sc1
    s_add_u32 s46, s97, 0x4400000
    s_nop 0
    v_lshlrev_b32 v80, 1, v1
    buffer_load_dwordx4 v[80:83], v80, s[12:15], s46 offen nt
    s_setprio 0
    ds_add_rtn_u32 v52, v52, v2
    ds_add_rtn_u32 v53, v53, v2
    ds_add_rtn_u32 v54, v54, v2
    ds_add_rtn_u32 v55, v55, v2
    ds_add_rtn_u32 v60, v60, v2
    ds_add_rtn_u32 v61, v61, v2
    ds_add_rtn_u32 v62, v62, v2
    ds_add_rtn_u32 v63, v63, v2
    s_waitcnt lgkmcnt(0)
    s_barrier
    s_setprio 3
    v_and_b32 v7, -4, v104
    v_lshl_add_u32 v8, v104, 2, v7
    ds_write_b32 v8, v96
    v_lshl_add_u32 v7, v7, 2, v104
    ds_write_b8 v7, v108 offset:16
    v_and_b32 v9, -4, v105
    v_lshl_add_u32 v10, v105, 2, v9
    ds_write_b32 v10, v97
    v_lshl_add_u32 v9, v9, 2, v105
    ds_write_b8_d16_hi v9, v108 offset:16
    v_and_b32 v7, -4, v106
    v_lshl_add_u32 v8, v106, 2, v7
    ds_write_b32 v8, v98
    v_lshl_add_u32 v7, v7, 2, v106
    ds_write_b8 v7, v109 offset:16
    v_and_b32 v9, -4, v107
    v_lshl_add_u32 v10, v107, 2, v9
    ds_write_b32 v10, v99
    v_lshl_add_u32 v9, v9, 2, v107
    ds_write_b8_d16_hi v9, v109 offset:16
    s_add_u32 s47, s35, 0x8000
    s_add_u32 s47, s47, s85
    buffer_store_dwordx4 v[88:91], v0, s[20:23], s47 offen sc1
    s_add_u32 s44, s98, 0x4800000
    v_lshlrev_b32 v96, 1, v1
    buffer_load_dwordx4 v[96:99], v96, s[8:11], s44 offen nt
    s_add_u32 s45, s98, 0x4800000
    v_lshlrev_b32 v104, 1, v1
    buffer_load_dwordx4 v[104:107], v104, s[12:15], s45 offen nt
    v_and_b32 v7, -4, v100
    v_lshl_add_u32 v8, v100, 2, v7
    ds_write_b32 v8, v112
    v_lshl_add_u32 v7, v7, 2, v100
    ds_write_b8 v7, v110 offset:16
    v_and_b32 v9, -4, v101
    v_lshl_add_u32 v10, v101, 2, v9
    ds_write_b32 v10, v113
    v_lshl_add_u32 v9, v9, 2, v101
    ds_write_b8_d16_hi v9, v110 offset:16
    v_and_b32 v7, -4, v102
    v_lshl_add_u32 v8, v102, 2, v7
    ds_write_b32 v8, v114
    v_lshl_add_u32 v7, v7, 2, v102
    ds_write_b8 v7, v111 offset:16
    v_and_b32 v9, -4, v103
    v_lshl_add_u32 v10, v103, 2, v9
    ds_write_b32 v10, v115
    v_lshl_add_u32 v9, v9, 2, v103
    ds_write_b8_d16_hi v9, v111 offset:16
    s_add_u32 s46, s98, 0x4800000
    s_lshr_b32 s46, s46, 1
    buffer_load_dwordx2 v[88:89], v1, s[16:19], s46 offen nt
    s_add_u32 s47, s99, 0x4c00000
    s_lshr_b32 s47, s47, 1
    buffer_load_dwordx2 v[90:91], v1, s[16:19], s47 offen nt
    s_add_u32 s44, s99, 0x4c00000
    v_lshlrev_b32 v112, 1, v1
    buffer_load_dwordx4 v[112:115], v112, s[8:11], s44 offen nt
    s_setprio 2
    v_and_b32 v7, -4, v120
    v_lshl_add_u32 v8, v120, 2, v7
    ds_write_b32 v8, v116
    v_lshl_add_u32 v7, v7, 2, v120
    ds_write_b8 v7, v124 offset:16
    v_and_b32 v9, -4, v121
    v_lshl_add_u32 v10, v121, 2, v9
    ds_write_b32 v10, v117
    v_lshl_add_u32 v9, v9, 2, v121
    ds_write_b8_d16_hi v9, v124 offset:16
    v_and_b32 v7, -4, v122
    v_lshl_add_u32 v8, v122, 2, v7
    ds_write_b32 v8, v118
    v_lshl_add_u32 v7, v7, 2, v122
    ds_write_b8 v7, v125 offset:16
    v_and_b32 v9, -4, v123
    v_lshl_add_u32 v10, v123, 2, v9
    ds_write_b32 v10, v119
    v_lshl_add_u32 v9, v9, 2, v123
    ds_write_b8_d16_hi v9, v125 offset:16
    s_add_u32 s45, s35, 0x8000
    s_add_u32 s45, s45, s91
    buffer_store_dwordx4 v[92:95], v0, s[20:23], s45 offen sc1
    s_add_u32 s46, s99, 0x4c00000
    v_lshlrev_b32 v100, 1, v1
    buffer_load_dwordx4 v[100:103], v100, s[12:15], s46 offen nt
    v_and_b32 v7, -4, v20
    v_lshl_add_u32 v8, v20, 2, v7
    ds_write_b32 v8, v16
    v_lshl_add_u32 v7, v7, 2, v20
    ds_write_b8 v7, v126 offset:16
    v_and_b32 v9, -4, v21
    v_lshl_add_u32 v10, v21, 2, v9
    ds_write_b32 v10, v17
    v_lshl_add_u32 v9, v9, 2, v21
    ds_write_b8_d16_hi v9, v126 offset:16
    v_and_b32 v7, -4, v22
    v_lshl_add_u32 v8, v22, 2, v7
    ds_write_b32 v8, v18
    v_lshl_add_u32 v7, v7, 2, v22
    ds_write_b8 v7, v127 offset:16
    v_and_b32 v9, -4, v23
    v_lshl_add_u32 v10, v23, 2, v9
    ds_write_b32 v10, v19
    v_lshl_add_u32 v9, v9, 2, v23
    ds_write_b8_d16_hi v9, v127 offset:16
    s_add_u32 s47, s96, 0x5000000
    v_lshlrev_b32 v108, 1, v1
    buffer_load_dwordx4 v[108:111], v108, s[8:11], s47 offen nt
    s_add_u32 s44, s96, 0x5000000
    v_lshlrev_b32 v116, 1, v1
    buffer_load_dwordx4 v[116:119], v116, s[12:15], s44 offen nt
    s_setprio 1
    v_and_b32 v7, -4, v32
    v_lshl_add_u32 v8, v32, 2, v7
    ds_write_b32 v8, v28
    v_lshl_add_u32 v7, v7, 2, v32
    ds_write_b8 v7, v24 offset:16
    v_and_b32 v9, -4, v33
    v_lshl_add_u32 v10, v33, 2, v9
    ds_write_b32 v10, v29
    v_lshl_add_u32 v9, v9, 2, v33
    ds_write_b8_d16_hi v9, v24 offset:16
    v_and_b32 v7, -4, v34
    v_lshl_add_u32 v8, v34, 2, v7
    ds_write_b32 v8, v30
    v_lshl_add_u32 v7, v7, 2, v34
    ds_write_b8 v7, v25 offset:16
    v_and_b32 v9, -4, v35
    v_lshl_add_u32 v10, v35, 2, v9
    ds_write_b32 v10, v31
    v_lshl_add_u32 v9, v9, 2, v35
    ds_write_b8_d16_hi v9, v25 offset:16
    s_add_u32 s45, s96, 0x5000000
    s_lshr_b32 s45, s45, 1
    buffer_load_dwordx2 v[120:121], v1, s[16:19], s45 offen nt
    s_add_u32 s46, s97, 0x5400000
    s_lshr_b32 s46, s46, 1
    buffer_load_dwordx2 v[122:123], v1, s[16:19], s46 offen nt
    s_add_u32 s47, s97, 0x5400000
    v_lshlrev_b32 v92, 1, v1
    buffer_load_dwordx4 v[92:95], v92, s[8:11], s47 offen nt
    v_and_b32 v7, -4, v40
    v_lshl_add_u32 v8, v40, 2, v7
    ds_write_b32 v8, v36
    v_lshl_add_u32 v7, v7, 2, v40
    ds_write_b8 v7, v26 offset:16
    v_and_b32 v9, -4, v41
    v_lshl_add_u32 v10, v41, 2, v9
    ds_write_b32 v10, v37
    v_lshl_add_u32 v9, v9, 2, v41
    ds_write_b8_d16_hi v9, v26 offset:16
    v_and_b32 v7, -4, v42
    v_lshl_add_u32 v8, v42, 2, v7
    ds_write_b32 v8, v38
    v_lshl_add_u32 v7, v7, 2, v42
    ds_write_b8 v7, v27 offset:16
    v_and_b32 v9, -4, v43
    v_lshl_add_u32 v10, v43, 2, v9
    ds_write_b32 v10, v39
    v_lshl_add_u32 v9, v9, 2, v43
    ds_write_b8_d16_hi v9, v27 offset:16
    s_add_u32 s44, s35, 0x8000
    s_add_u32 s44, s44, s93
    buffer_store_dwordx4 v[84:87], v0, s[20:23], s44 offen sc1
    s_add_u32 s45, s97, 0x5400000
    v_lshlrev_b32 v16, 1, v1
    buffer_load_dwordx4 v[16:19], v16, s[12:15], s45 offen nt
    s_setprio 0
    v_and_b32 v7, -4, v52
    v_lshl_add_u32 v8, v52, 2, v7
    ds_write_b32 v8, v48
    v_lshl_add_u32 v7, v7, 2, v52
    ds_write_b8 v7, v44 offset:16
    v_and_b32 v9, -4, v53
    v_lshl_add_u32 v10, v53, 2, v9
    ds_write_b32 v10, v49
    v_lshl_add_u32 v9, v9, 2, v53
    ds_write_b8_d16_hi v9, v44 offset:16
    v_and_b32 v7, -4, v54
    v_lshl_add_u32 v8, v54, 2, v7
    ds_write_b32 v8, v50
    v_lshl_add_u32 v7, v7, 2, v54
    ds_write_b8 v7, v45 offset:16
    v_and_b32 v9, -4, v55
    v_lshl_add_u32 v10, v55, 2, v9
    ds_write_b32 v10, v51
    v_lshl_add_u32 v9, v9, 2, v55
    ds_write_b8_d16_hi v9, v45 offset:16
    s_add_u32 s46, s98, 0x5800000
    v_lshlrev_b32 v20, 1, v1
    buffer_load_dwordx4 v[20:23], v20, s[8:11], s46 offen nt
    s_add_u32 s47, s98, 0x5800000
    v_lshlrev_b32 v124, 1, v1
    buffer_load_dwordx4 v[124:127], v124, s[12:15], s47 offen nt
    v_and_b32 v7, -4, v60
    v_lshl_add_u32 v8, v60, 2, v7
    ds_write_b32 v8, v56
    v_lshl_add_u32 v7, v7, 2, v60
    ds_write_b8 v7, v46 offset:16
    v_and_b32 v9, -4, v61
    v_lshl_add_u32 v10, v61, 2, v9
    ds_write_b32 v10, v57
    v_lshl_add_u32 v9, v9, 2, v61
    ds_write_b8_d16_hi v9, v46 offset:16
    v_and_b32 v7, -4, v62
    v_lshl_add_u32 v8, v62, 2, v7
    ds_write_b32 v8, v58
    v_lshl_add_u32 v7, v7, 2, v62
    ds_write_b8 v7, v47 offset:16
    v_and_b32 v9, -4, v63
    v_lshl_add_u32 v10, v63, 2, v9
    ds_write_b32 v10, v59
    v_lshl_add_u32 v9, v9, 2, v63
    ds_write_b8_d16_hi v9, v47 offset:16
    s_add_u32 s44, s98, 0x5800000
    s_lshr_b32 s44, s44, 1
    buffer_load_dwordx2 v[28:29], v1, s[16:19], s44 offen nt
    s_add_u32 s45, s99, 0x5c00000
    s_lshr_b32 s45, s45, 1
    buffer_load_dwordx2 v[30:31], v1, s[16:19], s45 offen nt
    v_add_u32 v7, s72, v0
    v_add_u32 v12, s73, v0
    v_add_u32 v13, s85, v0
    v_add_u32 v14, s91, v0
    v_add_u32 v15, s93, v0
    s_min_i32 s3, s72, s73
    s_min_i32 s3, s3, s85
    s_min_i32 s3, s3, s91
    s_min_i32 s3, s3, s93
    v_add_u32 v3, s3, v0
    v_mov_b32 v8, 0
    v_mov_b32 v9, 0
    v_mov_b32 v10, 0
    v_mov_b32 v11, 0
    s_waitcnt lgkmcnt(0)
    s_barrier
    ds_read_b128 v[32:35], v7 offset:0
    ds_read_b128 v[36:39], v12 offset:0
    ds_read_b128 v[40:43], v13 offset:0
    ds_read_b128 v[24:27], v14 offset:0
    ds_read_b128 v[84:87], v15 offset:0
    ds_write_b128 v3, v[8:11]
    ds_read_b128 v[48:51], v7 offset:16384
    ds_read_b128 v[52:55], v12 offset:16384
    ds_read_b128 v[56:59], v13 offset:16384
    ds_read_b128 v[60:63], v14 offset:16384
    ds_read_b128 v[44:47], v15 offset:16384
    s_waitcnt lgkmcnt(0)
    s_barrier
    s_setprio 3
    s_add_u32 s46, s35, 0x2a44000
    s_add_u32 s46, s46, s72
    buffer_store_dwordx4 v[32:35], v0, s[20:23], s46 offen sc1
    s_add_u32 s47, s99, 0x5c00000
    s_nop 0
    v_lshlrev_b32 v32, 1, v1
    buffer_load_dwordx4 v[32:35], v32, s[8:11], s47 offen nt
    s_add_u32 s44, s35, 0x2a44000
    s_add_u32 s44, s44, s73
    buffer_store_dwordx4 v[36:39], v0, s[20:23], s44 offen sc1
    s_add_u32 s45, s99, 0x5c00000
    s_nop 0
    v_lshlrev_b32 v36, 1, v1
    buffer_load_dwordx4 v[36:39], v36, s[12:15], s45 offen nt
    s_waitcnt vmcnt(27)
    v_lshlrev_b32 v7, 16, v64
    v_and_b32 v8, 0xffff0000, v64
    v_lshlrev_b32 v9, 16, v65
    v_and_b32 v10, 0xffff0000, v65
    v_mul_f32 v7, 0.15915494, v7
    v_mul_f32 v8, 0.15915494, v8
    v_mul_f32 v9, 0.15915494, v9
    v_mul_f32 v10, 0.15915494, v10
    v_mul_hi_u32_u24 v14, 429497, v68
    v_lshrrev_b32 v12, 3, v72
    v_cos_f32 v7, v7
    v_lshlrev_b16 v13, 3, v72
    v_mad_i32_i24 v11, v14, s55, v68
    v_bitop3_b32 v12, v6, v13, v12 bitop3:0xca
    v_lshl_add_u32 v11, v11, 17, s40
    v_lshlrev_b16 v14, 8, v14
    v_lshrrev_b32 v13, 2, v72
    v_add_u32 v68, v12, v11
    v_bitop3_b32 v72, v5, v13, v14 bitop3:0xea
    ds_add_u32 v72, v2
    v_mul_hi_u32_u24 v14, 429497, v69
    v_lshrrev_b32 v12, 3, v73
    v_cos_f32 v8, v8
    v_lshlrev_b16 v13, 3, v73
    v_mad_i32_i24 v11, v14, s55, v69
    v_bitop3_b32 v12, v6, v13, v12 bitop3:0xca
    v_lshl_add_u32 v11, v11, 17, s40
    v_lshlrev_b16 v14, 8, v14
    v_lshrrev_b32 v13, 2, v73
    v_add_u32 v69, v12, v11
    v_bitop3_b32 v73, v5, v13, v14 bitop3:0xea
    ds_add_u32 v73, v2
    v_cvt_pk_bf16_f32 v64, v7, v8
    v_perm_b32 v12, v64, v64, s41
    v_bitop3_b32 v68, v4, v12, v68 bitop3:0xca
    v_perm_b32 v13, v64, v64, s42
    v_bitop3_b32 v69, v4, v13, v69 bitop3:0xca
    v_mul_hi_u32_u24 v14, 429497, v70
    v_lshrrev_b32 v12, 3, v74
    v_cos_f32 v9, v9
    v_lshlrev_b16 v13, 3, v74
    v_mad_i32_i24 v11, v14, s55, v70
    v_bitop3_b32 v12, v6, v13, v12 bitop3:0xca
    v_lshl_add_u32 v11, v11, 17, s40
    v_lshlrev_b16 v14, 8, v14
    v_lshrrev_b32 v13, 2, v74
    v_add_u32 v70, v12, v11
    v_bitop3_b32 v74, v5, v13, v14 bitop3:0xea
    ds_add_u32 v74, v2
    v_mul_hi_u32_u24 v14, 429497, v71
    v_lshrrev_b32 v12, 3, v75
    v_cos_f32 v10, v10
    v_lshlrev_b16 v13, 3, v75
    v_mad_i32_i24 v11, v14, s55, v71
    v_bitop3_b32 v12, v6, v13, v12 bitop3:0xca
    v_lshl_add_u32 v11, v11, 17, s40
    v_lshlrev_b16 v14, 8, v14
    v_lshrrev_b32 v13, 2, v75
    v_add_u32 v71, v12, v11
    v_bitop3_b32 v75, v5, v13, v14 bitop3:0xea
    ds_add_u32 v75, v2
    v_cvt_pk_bf16_f32 v65, v9, v10
    v_perm_b32 v12, v65, v65, s41
    v_bitop3_b32 v70, v4, v12, v70 bitop3:0xca
    v_perm_b32 v13, v65, v65, s42
    v_bitop3_b32 v71, v4, v13, v71 bitop3:0xca
    s_waitcnt vmcnt(23)
    v_lshlrev_b32 v7, 16, v66
    v_and_b32 v8, 0xffff0000, v66
    v_lshlrev_b32 v9, 16, v67
    v_and_b32 v10, 0xffff0000, v67
    v_mul_f32 v7, 0.15915494, v7
    v_mul_f32 v8, 0.15915494, v8
    v_mul_f32 v9, 0.15915494, v9
    v_mul_f32 v10, 0.15915494, v10
    v_mul_hi_u32_u24 v14, 429497, v76
    v_lshrrev_b32 v12, 3, v80
    v_cos_f32 v7, v7
    v_lshlrev_b16 v13, 3, v80
    v_mad_i32_i24 v11, v14, s55, v76
    v_bitop3_b32 v12, v6, v13, v12 bitop3:0xca
    v_lshl_add_u32 v11, v11, 17, s40
    v_lshlrev_b16 v14, 8, v14
    v_lshrrev_b32 v13, 2, v80
    v_add_u32 v76, v12, v11
    v_bitop3_b32 v80, v5, v13, v14 bitop3:0xea
    ds_add_u32 v80, v2
    v_mul_hi_u32_u24 v14, 429497, v77
    v_lshrrev_b32 v12, 3, v81
    v_cos_f32 v8, v8
    v_lshlrev_b16 v13, 3, v81
    v_mad_i32_i24 v11, v14, s55, v77
    v_bitop3_b32 v12, v6, v13, v12 bitop3:0xca
    v_lshl_add_u32 v11, v11, 17, s40
    v_lshlrev_b16 v14, 8, v14
    v_lshrrev_b32 v13, 2, v81
    v_add_u32 v77, v12, v11
    v_bitop3_b32 v81, v5, v13, v14 bitop3:0xea
    ds_add_u32 v81, v2
    v_cvt_pk_bf16_f32 v66, v7, v8
    v_perm_b32 v12, v66, v66, s41
    v_bitop3_b32 v76, v4, v12, v76 bitop3:0xca
    v_perm_b32 v13, v66, v66, s42
    v_bitop3_b32 v77, v4, v13, v77 bitop3:0xca
    v_mul_hi_u32_u24 v14, 429497, v78
    v_lshrrev_b32 v12, 3, v82
    v_cos_f32 v9, v9
    v_lshlrev_b16 v13, 3, v82
    v_mad_i32_i24 v11, v14, s55, v78
    v_bitop3_b32 v12, v6, v13, v12 bitop3:0xca
    v_lshl_add_u32 v11, v11, 17, s40
    v_lshlrev_b16 v14, 8, v14
    v_lshrrev_b32 v13, 2, v82
    v_add_u32 v78, v12, v11
    v_bitop3_b32 v82, v5, v13, v14 bitop3:0xea
    ds_add_u32 v82, v2
    v_mul_hi_u32_u24 v14, 429497, v79
    v_lshrrev_b32 v12, 3, v83
    v_cos_f32 v10, v10
    v_lshlrev_b16 v13, 3, v83
    v_mad_i32_i24 v11, v14, s55, v79
    v_bitop3_b32 v12, v6, v13, v12 bitop3:0xca
    v_lshl_add_u32 v11, v11, 17, s40
    v_lshlrev_b16 v14, 8, v14
    v_lshrrev_b32 v13, 2, v83
    v_add_u32 v79, v12, v11
    v_bitop3_b32 v83, v5, v13, v14 bitop3:0xea
    ds_add_u32 v83, v2
    v_cvt_pk_bf16_f32 v67, v9, v10
    v_perm_b32 v12, v67, v67, s41
    v_bitop3_b32 v78, v4, v12, v78 bitop3:0xca
    v_perm_b32 v13, v67, v67, s42
    v_bitop3_b32 v79, v4, v13, v79 bitop3:0xca
    s_setprio 2
    s_waitcnt vmcnt(18)
    v_lshlrev_b32 v7, 16, v88
    v_and_b32 v8, 0xffff0000, v88
    v_lshlrev_b32 v9, 16, v89
    v_and_b32 v10, 0xffff0000, v89
    v_mul_f32 v7, 0.15915494, v7
    v_mul_f32 v8, 0.15915494, v8
    v_mul_f32 v9, 0.15915494, v9
    v_mul_f32 v10, 0.15915494, v10
    v_mul_hi_u32_u24 v14, 429497, v96
    v_lshrrev_b32 v12, 3, v104
    v_cos_f32 v7, v7
    v_lshlrev_b16 v13, 3, v104
    v_mad_i32_i24 v11, v14, s55, v96
    v_bitop3_b32 v12, v6, v13, v12 bitop3:0xca
    v_lshl_add_u32 v11, v11, 17, s40
    v_lshlrev_b16 v14, 8, v14
    v_lshrrev_b32 v13, 2, v104
    v_add_u32 v96, v12, v11
    v_bitop3_b32 v104, v5, v13, v14 bitop3:0xea
    ds_add_u32 v104, v2
    v_mul_hi_u32_u24 v14, 429497, v97
    v_lshrrev_b32 v12, 3, v105
    v_cos_f32 v8, v8
    v_lshlrev_b16 v13, 3, v105
    v_mad_i32_i24 v11, v14, s55, v97
    v_bitop3_b32 v12, v6, v13, v12 bitop3:0xca
    v_lshl_add_u32 v11, v11, 17, s40
    v_lshlrev_b16 v14, 8, v14
    v_lshrrev_b32 v13, 2, v105
    v_add_u32 v97, v12, v11
    v_bitop3_b32 v105, v5, v13, v14 bitop3:0xea
    ds_add_u32 v105, v2
    v_cvt_pk_bf16_f32 v88, v7, v8
    v_perm_b32 v12, v88, v88, s41
    v_bitop3_b32 v96, v4, v12, v96 bitop3:0xca
    v_perm_b32 v13, v88, v88, s42
    v_bitop3_b32 v97, v4, v13, v97 bitop3:0xca
    v_mul_hi_u32_u24 v14, 429497, v98
    v_lshrrev_b32 v12, 3, v106
    v_cos_f32 v9, v9
    v_lshlrev_b16 v13, 3, v106
    v_mad_i32_i24 v11, v14, s55, v98
    v_bitop3_b32 v12, v6, v13, v12 bitop3:0xca
    v_lshl_add_u32 v11, v11, 17, s40
    v_lshlrev_b16 v14, 8, v14
    v_lshrrev_b32 v13, 2, v106
    v_add_u32 v98, v12, v11
    v_bitop3_b32 v106, v5, v13, v14 bitop3:0xea
    ds_add_u32 v106, v2
    v_mul_hi_u32_u24 v14, 429497, v99
    v_lshrrev_b32 v12, 3, v107
    v_cos_f32 v10, v10
    v_lshlrev_b16 v13, 3, v107
    v_mad_i32_i24 v11, v14, s55, v99
    v_bitop3_b32 v12, v6, v13, v12 bitop3:0xca
    v_lshl_add_u32 v11, v11, 17, s40
    v_lshlrev_b16 v14, 8, v14
    v_lshrrev_b32 v13, 2, v107
    v_add_u32 v99, v12, v11
    v_bitop3_b32 v107, v5, v13, v14 bitop3:0xea
    ds_add_u32 v107, v2
    v_cvt_pk_bf16_f32 v89, v9, v10
    v_perm_b32 v12, v89, v89, s41
    v_bitop3_b32 v98, v4, v12, v98 bitop3:0xca
    v_perm_b32 v13, v89, v89, s42
    v_bitop3_b32 v99, v4, v13, v99 bitop3:0xca
    s_add_u32 s46, s35, 0x2a44000
    s_add_u32 s46, s46, s85
    buffer_store_dwordx4 v[40:43], v0, s[20:23], s46 offen sc1
    s_add_u32 s47, s96, 0x6000000
    s_nop 0
    v_lshlrev_b32 v40, 1, v1
    buffer_load_dwordx4 v[40:43], v40, s[8:11], s47 offen nt
    s_waitcnt vmcnt(17)
    v_lshlrev_b32 v7, 16, v90
    v_and_b32 v8, 0xffff0000, v90
    v_lshlrev_b32 v9, 16, v91
    v_and_b32 v10, 0xffff0000, v91
    v_mul_f32 v7, 0.15915494, v7
    v_mul_f32 v8, 0.15915494, v8
    v_mul_f32 v9, 0.15915494, v9
    v_mul_f32 v10, 0.15915494, v10
    v_mul_hi_u32_u24 v14, 429497, v112
    v_lshrrev_b32 v12, 3, v100
    v_cos_f32 v7, v7
    v_lshlrev_b16 v13, 3, v100
    v_mad_i32_i24 v11, v14, s55, v112
    v_bitop3_b32 v12, v6, v13, v12 bitop3:0xca
    v_lshl_add_u32 v11, v11, 17, s40
    v_lshlrev_b16 v14, 8, v14
    v_lshrrev_b32 v13, 2, v100
    v_add_u32 v112, v12, v11
    v_bitop3_b32 v100, v5, v13, v14 bitop3:0xea
    ds_add_u32 v100, v2
    v_mul_hi_u32_u24 v14, 429497, v113
    v_lshrrev_b32 v12, 3, v101
    v_cos_f32 v8, v8
    v_lshlrev_b16 v13, 3, v101
    v_mad_i32_i24 v11, v14, s55, v113
    v_bitop3_b32 v12, v6, v13, v12 bitop3:0xca
    v_lshl_add_u32 v11, v11, 17, s40
    v_lshlrev_b16 v14, 8, v14
    v_lshrrev_b32 v13, 2, v101
    v_add_u32 v113, v12, v11
    v_bitop3_b32 v101, v5, v13, v14 bitop3:0xea
    ds_add_u32 v101, v2
    v_cvt_pk_bf16_f32 v90, v7, v8
    v_perm_b32 v12, v90, v90, s41
    v_bitop3_b32 v112, v4, v12, v112 bitop3:0xca
    v_perm_b32 v13, v90, v90, s42
    v_bitop3_b32 v113, v4, v13, v113 bitop3:0xca
    v_mul_hi_u32_u24 v14, 429497, v114
    v_lshrrev_b32 v12, 3, v102
    v_cos_f32 v9, v9
    v_lshlrev_b16 v13, 3, v102
    v_mad_i32_i24 v11, v14, s55, v114
    v_bitop3_b32 v12, v6, v13, v12 bitop3:0xca
    v_lshl_add_u32 v11, v11, 17, s40
    v_lshlrev_b16 v14, 8, v14
    v_lshrrev_b32 v13, 2, v102
    v_add_u32 v114, v12, v11
    v_bitop3_b32 v102, v5, v13, v14 bitop3:0xea
    ds_add_u32 v102, v2
    v_mul_hi_u32_u24 v14, 429497, v115
    v_lshrrev_b32 v12, 3, v103
    v_cos_f32 v10, v10
    v_lshlrev_b16 v13, 3, v103
    v_mad_i32_i24 v11, v14, s55, v115
    v_bitop3_b32 v12, v6, v13, v12 bitop3:0xca
    v_lshl_add_u32 v11, v11, 17, s40
    v_lshlrev_b16 v14, 8, v14
    v_lshrrev_b32 v13, 2, v103
    v_add_u32 v115, v12, v11
    v_bitop3_b32 v103, v5, v13, v14 bitop3:0xea
    ds_add_u32 v103, v2
    v_cvt_pk_bf16_f32 v91, v9, v10
    v_perm_b32 v12, v91, v91, s41
    v_bitop3_b32 v114, v4, v12, v114 bitop3:0xca
    v_perm_b32 v13, v91, v91, s42
    v_bitop3_b32 v115, v4, v13, v115 bitop3:0xca
    s_setprio 1
    s_waitcnt vmcnt(13)
    v_lshlrev_b32 v7, 16, v120
    v_and_b32 v8, 0xffff0000, v120
    v_lshlrev_b32 v9, 16, v121
    v_and_b32 v10, 0xffff0000, v121
    v_mul_f32 v7, 0.15915494, v7
    v_mul_f32 v8, 0.15915494, v8
    v_mul_f32 v9, 0.15915494, v9
    v_mul_f32 v10, 0.15915494, v10
    v_mul_hi_u32_u24 v14, 429497, v108
    v_lshrrev_b32 v12, 3, v116
    v_cos_f32 v7, v7
    v_lshlrev_b16 v13, 3, v116
    v_mad_i32_i24 v11, v14, s55, v108
    v_bitop3_b32 v12, v6, v13, v12 bitop3:0xca
    v_lshl_add_u32 v11, v11, 17, s40
    v_lshlrev_b16 v14, 8, v14
    v_lshrrev_b32 v13, 2, v116
    v_add_u32 v108, v12, v11
    v_bitop3_b32 v116, v5, v13, v14 bitop3:0xea
    ds_add_u32 v116, v2
    v_mul_hi_u32_u24 v14, 429497, v109
    v_lshrrev_b32 v12, 3, v117
    v_cos_f32 v8, v8
    v_lshlrev_b16 v13, 3, v117
    v_mad_i32_i24 v11, v14, s55, v109
    v_bitop3_b32 v12, v6, v13, v12 bitop3:0xca
    v_lshl_add_u32 v11, v11, 17, s40
    v_lshlrev_b16 v14, 8, v14
    v_lshrrev_b32 v13, 2, v117
    v_add_u32 v109, v12, v11
    v_bitop3_b32 v117, v5, v13, v14 bitop3:0xea
    ds_add_u32 v117, v2
    v_cvt_pk_bf16_f32 v120, v7, v8
    v_perm_b32 v12, v120, v120, s41
    v_bitop3_b32 v108, v4, v12, v108 bitop3:0xca
    v_perm_b32 v13, v120, v120, s42
    v_bitop3_b32 v109, v4, v13, v109 bitop3:0xca
    v_mul_hi_u32_u24 v14, 429497, v110
    v_lshrrev_b32 v12, 3, v118
    v_cos_f32 v9, v9
    v_lshlrev_b16 v13, 3, v118
    v_mad_i32_i24 v11, v14, s55, v110
    v_bitop3_b32 v12, v6, v13, v12 bitop3:0xca
    v_lshl_add_u32 v11, v11, 17, s40
    v_lshlrev_b16 v14, 8, v14
    v_lshrrev_b32 v13, 2, v118
    v_add_u32 v110, v12, v11
    v_bitop3_b32 v118, v5, v13, v14 bitop3:0xea
    ds_add_u32 v118, v2
    v_mul_hi_u32_u24 v14, 429497, v111
    v_lshrrev_b32 v12, 3, v119
    v_cos_f32 v10, v10
    v_lshlrev_b16 v13, 3, v119
    v_mad_i32_i24 v11, v14, s55, v111
    v_bitop3_b32 v12, v6, v13, v12 bitop3:0xca
    v_lshl_add_u32 v11, v11, 17, s40
    v_lshlrev_b16 v14, 8, v14
    v_lshrrev_b32 v13, 2, v119
    v_add_u32 v111, v12, v11
    v_bitop3_b32 v119, v5, v13, v14 bitop3:0xea
    ds_add_u32 v119, v2
    v_cvt_pk_bf16_f32 v121, v9, v10
    v_perm_b32 v12, v121, v121, s41
    v_bitop3_b32 v110, v4, v12, v110 bitop3:0xca
    v_perm_b32 v13, v121, v121, s42
    v_bitop3_b32 v111, v4, v13, v111 bitop3:0xca
    s_waitcnt vmcnt(10)
    v_lshlrev_b32 v7, 16, v122
    v_and_b32 v8, 0xffff0000, v122
    v_lshlrev_b32 v9, 16, v123
    v_and_b32 v10, 0xffff0000, v123
    v_mul_f32 v7, 0.15915494, v7
    v_mul_f32 v8, 0.15915494, v8
    v_mul_f32 v9, 0.15915494, v9
    v_mul_f32 v10, 0.15915494, v10
    v_mul_hi_u32_u24 v14, 429497, v92
    v_lshrrev_b32 v12, 3, v16
    v_cos_f32 v7, v7
    v_lshlrev_b16 v13, 3, v16
    v_mad_i32_i24 v11, v14, s55, v92
    v_bitop3_b32 v12, v6, v13, v12 bitop3:0xca
    v_lshl_add_u32 v11, v11, 17, s40
    v_lshlrev_b16 v14, 8, v14
    v_lshrrev_b32 v13, 2, v16
    v_add_u32 v92, v12, v11
    v_bitop3_b32 v16, v5, v13, v14 bitop3:0xea
    ds_add_u32 v16, v2
    v_mul_hi_u32_u24 v14, 429497, v93
    v_lshrrev_b32 v12, 3, v17
    v_cos_f32 v8, v8
    v_lshlrev_b16 v13, 3, v17
    v_mad_i32_i24 v11, v14, s55, v93
    v_bitop3_b32 v12, v6, v13, v12 bitop3:0xca
    v_lshl_add_u32 v11, v11, 17, s40
    v_lshlrev_b16 v14, 8, v14
    v_lshrrev_b32 v13, 2, v17
    v_add_u32 v93, v12, v11
    v_bitop3_b32 v17, v5, v13, v14 bitop3:0xea
    ds_add_u32 v17, v2
    v_cvt_pk_bf16_f32 v122, v7, v8
    v_perm_b32 v12, v122, v122, s41
    v_bitop3_b32 v92, v4, v12, v92 bitop3:0xca
    v_perm_b32 v13, v122, v122, s42
    v_bitop3_b32 v93, v4, v13, v93 bitop3:0xca
    v_mul_hi_u32_u24 v14, 429497, v94
    v_lshrrev_b32 v12, 3, v18
    v_cos_f32 v9, v9
    v_lshlrev_b16 v13, 3, v18
    v_mad_i32_i24 v11, v14, s55, v94
    v_bitop3_b32 v12, v6, v13, v12 bitop3:0xca
    v_lshl_add_u32 v11, v11, 17, s40
    v_lshlrev_b16 v14, 8, v14
    v_lshrrev_b32 v13, 2, v18
    v_add_u32 v94, v12, v11
    v_bitop3_b32 v18, v5, v13, v14 bitop3:0xea
    ds_add_u32 v18, v2
    v_mul_hi_u32_u24 v14, 429497, v95
    v_lshrrev_b32 v12, 3, v19
    v_cos_f32 v10, v10
    v_lshlrev_b16 v13, 3, v19
    v_mad_i32_i24 v11, v14, s55, v95
    v_bitop3_b32 v12, v6, v13, v12 bitop3:0xca
    v_lshl_add_u32 v11, v11, 17, s40
    v_lshlrev_b16 v14, 8, v14
    v_lshrrev_b32 v13, 2, v19
    v_add_u32 v95, v12, v11
    v_bitop3_b32 v19, v5, v13, v14 bitop3:0xea
    ds_add_u32 v19, v2
    v_cvt_pk_bf16_f32 v123, v9, v10
    v_perm_b32 v12, v123, v123, s41
    v_bitop3_b32 v94, v4, v12, v94 bitop3:0xca
    v_perm_b32 v13, v123, v123, s42
    v_bitop3_b32 v95, v4, v13, v95 bitop3:0xca
    s_setprio 0
    s_add_u32 s44, s35, 0x2a44000
    s_add_u32 s44, s44, s91
    buffer_store_dwordx4 v[24:27], v0, s[20:23], s44 offen sc1
    s_add_u32 s45, s96, 0x6000000
    s_nop 0
    v_lshlrev_b32 v24, 1, v1
    buffer_load_dwordx4 v[24:27], v24, s[12:15], s45 offen nt
    s_waitcnt vmcnt(8)
    v_lshlrev_b32 v7, 16, v28
    v_and_b32 v8, 0xffff0000, v28
    v_lshlrev_b32 v9, 16, v29
    v_and_b32 v10, 0xffff0000, v29
    v_mul_f32 v7, 0.15915494, v7
    v_mul_f32 v8, 0.15915494, v8
    v_mul_f32 v9, 0.15915494, v9
    v_mul_f32 v10, 0.15915494, v10
    v_mul_hi_u32_u24 v14, 429497, v20
    v_lshrrev_b32 v12, 3, v124
    v_cos_f32 v7, v7
    v_lshlrev_b16 v13, 3, v124
    v_mad_i32_i24 v11, v14, s55, v20
    v_bitop3_b32 v12, v6, v13, v12 bitop3:0xca
    v_lshl_add_u32 v11, v11, 17, s40
    v_lshlrev_b16 v14, 8, v14
    v_lshrrev_b32 v13, 2, v124
    v_add_u32 v20, v12, v11
    v_bitop3_b32 v124, v5, v13, v14 bitop3:0xea
    ds_add_u32 v124, v2
    v_mul_hi_u32_u24 v14, 429497, v21
    v_lshrrev_b32 v12, 3, v125
    v_cos_f32 v8, v8
    v_lshlrev_b16 v13, 3, v125
    v_mad_i32_i24 v11, v14, s55, v21
    v_bitop3_b32 v12, v6, v13, v12 bitop3:0xca
    v_lshl_add_u32 v11, v11, 17, s40
    v_lshlrev_b16 v14, 8, v14
    v_lshrrev_b32 v13, 2, v125
    v_add_u32 v21, v12, v11
    v_bitop3_b32 v125, v5, v13, v14 bitop3:0xea
    ds_add_u32 v125, v2
    v_cvt_pk_bf16_f32 v28, v7, v8
    v_perm_b32 v12, v28, v28, s41
    v_bitop3_b32 v20, v4, v12, v20 bitop3:0xca
    v_perm_b32 v13, v28, v28, s42
    v_bitop3_b32 v21, v4, v13, v21 bitop3:0xca
    v_mul_hi_u32_u24 v14, 429497, v22
    v_lshrrev_b32 v12, 3, v126
    v_cos_f32 v9, v9
    v_lshlrev_b16 v13, 3, v126
    v_mad_i32_i24 v11, v14, s55, v22
    v_bitop3_b32 v12, v6, v13, v12 bitop3:0xca
    v_lshl_add_u32 v11, v11, 17, s40
    v_lshlrev_b16 v14, 8, v14
    v_lshrrev_b32 v13, 2, v126
    v_add_u32 v22, v12, v11
    v_bitop3_b32 v126, v5, v13, v14 bitop3:0xea
    ds_add_u32 v126, v2
    v_mul_hi_u32_u24 v14, 429497, v23
    v_lshrrev_b32 v12, 3, v127
    v_cos_f32 v10, v10
    v_lshlrev_b16 v13, 3, v127
    v_mad_i32_i24 v11, v14, s55, v23
    v_bitop3_b32 v12, v6, v13, v12 bitop3:0xca
    v_lshl_add_u32 v11, v11, 17, s40
    v_lshlrev_b16 v14, 8, v14
    v_lshrrev_b32 v13, 2, v127
    v_add_u32 v23, v12, v11
    v_bitop3_b32 v127, v5, v13, v14 bitop3:0xea
    ds_add_u32 v127, v2
    v_cvt_pk_bf16_f32 v29, v9, v10
    v_perm_b32 v12, v29, v29, s41
    v_bitop3_b32 v22, v4, v12, v22 bitop3:0xca
    v_perm_b32 v13, v29, v29, s42
    v_bitop3_b32 v23, v4, v13, v23 bitop3:0xca
    s_waitcnt vmcnt(4)
    v_lshlrev_b32 v7, 16, v30
    v_and_b32 v8, 0xffff0000, v30
    v_lshlrev_b32 v9, 16, v31
    v_and_b32 v10, 0xffff0000, v31
    v_mul_f32 v7, 0.15915494, v7
    v_mul_f32 v8, 0.15915494, v8
    v_mul_f32 v9, 0.15915494, v9
    v_mul_f32 v10, 0.15915494, v10
    v_mul_hi_u32_u24 v14, 429497, v32
    v_lshrrev_b32 v12, 3, v36
    v_cos_f32 v7, v7
    v_lshlrev_b16 v13, 3, v36
    v_mad_i32_i24 v11, v14, s55, v32
    v_bitop3_b32 v12, v6, v13, v12 bitop3:0xca
    v_lshl_add_u32 v11, v11, 17, s40
    v_lshlrev_b16 v14, 8, v14
    v_lshrrev_b32 v13, 2, v36
    v_add_u32 v32, v12, v11
    v_bitop3_b32 v36, v5, v13, v14 bitop3:0xea
    ds_add_u32 v36, v2
    v_mul_hi_u32_u24 v14, 429497, v33
    v_lshrrev_b32 v12, 3, v37
    v_cos_f32 v8, v8
    v_lshlrev_b16 v13, 3, v37
    v_mad_i32_i24 v11, v14, s55, v33
    v_bitop3_b32 v12, v6, v13, v12 bitop3:0xca
    v_lshl_add_u32 v11, v11, 17, s40
    v_lshlrev_b16 v14, 8, v14
    v_lshrrev_b32 v13, 2, v37
    v_add_u32 v33, v12, v11
    v_bitop3_b32 v37, v5, v13, v14 bitop3:0xea
    ds_add_u32 v37, v2
    v_cvt_pk_bf16_f32 v30, v7, v8
    v_perm_b32 v12, v30, v30, s41
    v_bitop3_b32 v32, v4, v12, v32 bitop3:0xca
    v_perm_b32 v13, v30, v30, s42
    v_bitop3_b32 v33, v4, v13, v33 bitop3:0xca
    v_mul_hi_u32_u24 v14, 429497, v34
    v_lshrrev_b32 v12, 3, v38
    v_cos_f32 v9, v9
    v_lshlrev_b16 v13, 3, v38
    v_mad_i32_i24 v11, v14, s55, v34
    v_bitop3_b32 v12, v6, v13, v12 bitop3:0xca
    v_lshl_add_u32 v11, v11, 17, s40
    v_lshlrev_b16 v14, 8, v14
    v_lshrrev_b32 v13, 2, v38
    v_add_u32 v34, v12, v11
    v_bitop3_b32 v38, v5, v13, v14 bitop3:0xea
    ds_add_u32 v38, v2
    v_mul_hi_u32_u24 v14, 429497, v35
    v_lshrrev_b32 v12, 3, v39
    v_cos_f32 v10, v10
    v_lshlrev_b16 v13, 3, v39
    v_mad_i32_i24 v11, v14, s55, v35
    v_bitop3_b32 v12, v6, v13, v12 bitop3:0xca
    v_lshl_add_u32 v11, v11, 17, s40
    v_lshlrev_b16 v14, 8, v14
    v_lshrrev_b32 v13, 2, v39
    v_add_u32 v35, v12, v11
    v_bitop3_b32 v39, v5, v13, v14 bitop3:0xea
    ds_add_u32 v39, v2
    v_cvt_pk_bf16_f32 v31, v9, v10
    v_perm_b32 v12, v31, v31, s41
    v_bitop3_b32 v34, v4, v12, v34 bitop3:0xca
    v_perm_b32 v13, v31, v31, s42
    v_bitop3_b32 v35, v4, v13, v35 bitop3:0xca
    v_lshrrev_b32 v8, 2, v0
    v_and_b32 v7, 0x3c00, v0
    v_bitop3_b32 v7, v5, v8, v7 bitop3:0xea
    s_waitcnt lgkmcnt(0)
    s_barrier
    ds_read2st64_b32 v[8:9], v7 offset0:0 offset1:1
    ds_read2st64_b32 v[10:11], v7 offset0:2 offset1:3
    s_add_u32 s46, s35, 0x2a44000
    s_add_u32 s46, s46, s93
    buffer_store_dwordx4 v[84:87], v0, s[20:23], s46 offen sc1
    s_add_u32 s47, s96, 0x6000000
    s_lshr_b32 s47, s47, 1
    buffer_load_dwordx2 v[84:85], v1, s[16:19], s47 offen nt
    s_add_u32 s44, s97, 0x6400000
    s_lshr_b32 s44, s44, 1
    buffer_load_dwordx2 v[86:87], v1, s[16:19], s44 offen nt
    s_waitcnt lgkmcnt(0)
    v_lshl_or_b32 v12, v9, 16, v8
    v_lshl_or_b32 v13, v11, 16, v10
    v_mov_b32 v14, v12
    v_mov_b32 v15, v13
    s_nop 0
    v_add_u32_dpp v14, v14, v14 row_shr:1 row_mask:0xf bank_mask:0xf bound_ctrl:1
    v_add_u32_dpp v15, v15, v15 row_shr:1 row_mask:0xf bank_mask:0xf bound_ctrl:1
    s_nop 0
    v_add_u32_dpp v14, v14, v14 row_shr:2 row_mask:0xf bank_mask:0xf bound_ctrl:1
    v_add_u32_dpp v15, v15, v15 row_shr:2 row_mask:0xf bank_mask:0xf bound_ctrl:1
    s_nop 0
    v_add_u32_dpp v14, v14, v14 row_shr:4 row_mask:0xf bank_mask:0xf bound_ctrl:1
    v_add_u32_dpp v15, v15, v15 row_shr:4 row_mask:0xf bank_mask:0xf bound_ctrl:1
    s_nop 0
    v_add_u32_dpp v14, v14, v14 row_shr:8 row_mask:0xf bank_mask:0xf bound_ctrl:1
    v_add_u32_dpp v15, v15, v15 row_shr:8 row_mask:0xf bank_mask:0xf bound_ctrl:1
    s_nop 0
    v_add_u32_dpp v14, v14, v14 row_bcast:15 row_mask:0xa bank_mask:0xf
    v_add_u32_dpp v15, v15, v15 row_bcast:15 row_mask:0xa bank_mask:0xf
    s_nop 0
    v_add_u32_dpp v14, v14, v14 row_bcast:31 row_mask:0xc bank_mask:0xf
    v_add_u32_dpp v15, v15, v15 row_bcast:31 row_mask:0xc bank_mask:0xf
    v_readlane_b32 s48, v14, 63
    v_readlane_b32 s49, v15, 63
    s_lshl_b32 s54, s32, 2
    v_mov_b32 v8, s54
    s_and_b32 s50, s48, 0xffff
    s_lshr_b32 s51, s48, 16
    s_and_b32 s52, s49, 0xffff
    s_lshr_b32 s53, s49, 16
    s_add_u32 s51, s51, s50
    s_add_u32 s52, s52, s51
    s_add_u32 s53, s53, s52
    v_mov_b32 v9, s53
    s_mov_b64 exec, 1
    ds_write_b32 v8, v9 offset:16384
    s_mov_b64 exec, -1
    v_and_b32 v8, 60, v7
    s_waitcnt lgkmcnt(0)
    s_barrier
    ds_read_b32 v9, v8 offset:16384
    s_waitcnt lgkmcnt(0)
    v_add_u32_dpp v9, v9, v9 row_shr:1 row_mask:0xf bank_mask:0xf bound_ctrl:1
    s_nop 1
    v_add_u32_dpp v9, v9, v9 row_shr:2 row_mask:0xf bank_mask:0xf bound_ctrl:1
    s_nop 1
    v_add_u32_dpp v9, v9, v9 row_shr:4 row_mask:0xf bank_mask:0xf bound_ctrl:1
    s_nop 1
    v_add_u32_dpp v9, v9, v9 row_shr:8 row_mask:0xf bank_mask:0xf bound_ctrl:1
    s_nop 0
    v_readlane_b32 s54, v9, s32
    s_sub_u32 s54, s54, s53
    s_add_u32 s50, s50, s54
    s_add_u32 s51, s51, s54
    s_add_u32 s52, s52, s54
    s_pack_ll_b32_b16 s48, s54, s50
    s_pack_ll_b32_b16 s49, s51, s52
    v_add_u32 v14, s48, v14
    v_add_u32 v15, s49, v15
    v_sub_u32 v12, v14, v12
    v_sub_u32 v13, v15, v13
    v_and_b32 v8, 0xffff, v12
    v_lshrrev_b32 v9, 16, v12
    v_and_b32 v10, 0xffff, v13
    v_lshrrev_b32 v11, 16, v13
    ds_write2st64_b32 v7, v8, v9 offset0:0 offset1:1
    ds_write2st64_b32 v7, v10, v11 offset0:2 offset1:3
    v_and_b32 v8, 0x3f0, v0
    v_lshl_add_u32 v8, v8, 1, s36
    ds_write_b64 v8, v[12:13] offset:20480
    s_bitset0_b64 exec, 63
    s_not_b64 exec, exec
    ds_write_b64 v8, v[14:15] offset:20512
    s_mov_b64 exec, -1
    s_waitcnt lgkmcnt(0)
    s_barrier
    s_setprio 3
    ds_add_rtn_u32 v72, v72, v2
    ds_add_rtn_u32 v73, v73, v2
    ds_add_rtn_u32 v74, v74, v2
    ds_add_rtn_u32 v75, v75, v2
    ds_read_b128 v[12:15], v0 offset:20480
    v_cmp_gt_u32 vcc, 8448, v0
    ds_add_rtn_u32 v80, v80, v2
    ds_add_rtn_u32 v81, v81, v2
    ds_add_rtn_u32 v82, v82, v2
    ds_add_rtn_u32 v83, v83, v2
    s_setprio 2
    ds_add_rtn_u32 v104, v104, v2
    ds_add_rtn_u32 v105, v105, v2
    ds_add_rtn_u32 v106, v106, v2
    ds_add_rtn_u32 v107, v107, v2
    s_waitcnt lgkmcnt(8)
    s_cbranch_vccz L1_p3
    s_add_u32 s45, s35, 0x5480000
    s_mov_b64 exec, vcc
    buffer_store_dwordx4 v[12:15], v0, s[24:27], s45 offen sc1
    s_mov_b64 exec, -1
L1_p3:
    s_add_u32 s46, s35, 0x2a48000
    s_add_u32 s46, s46, s72
    buffer_store_dwordx4 v[48:51], v0, s[20:23], s46 offen sc1
    s_add_u32 s47, s97, 0x6400000
    s_nop 0
    v_lshlrev_b32 v48, 1, v1
    buffer_load_dwordx4 v[48:51], v48, s[8:11], s47 offen nt
    ds_add_rtn_u32 v100, v100, v2
    ds_add_rtn_u32 v101, v101, v2
    ds_add_rtn_u32 v102, v102, v2
    ds_add_rtn_u32 v103, v103, v2
    s_setprio 1
    ds_add_rtn_u32 v116, v116, v2
    ds_add_rtn_u32 v117, v117, v2
    ds_add_rtn_u32 v118, v118, v2
    ds_add_rtn_u32 v119, v119, v2
    ds_add_rtn_u32 v16, v16, v2
    ds_add_rtn_u32 v17, v17, v2
    ds_add_rtn_u32 v18, v18, v2
    ds_add_rtn_u32 v19, v19, v2
    s_add_u32 s44, s35, 0x2a48000
    s_add_u32 s44, s44, s73
    buffer_store_dwordx4 v[52:55], v0, s[20:23], s44 offen sc1
    s_add_u32 s45, s97, 0x6400000
    s_nop 0
    v_lshlrev_b32 v52, 1, v1
    buffer_load_dwordx4 v[52:55], v52, s[12:15], s45 offen nt
    s_setprio 0
    ds_add_rtn_u32 v124, v124, v2
    ds_add_rtn_u32 v125, v125, v2
    ds_add_rtn_u32 v126, v126, v2
    ds_add_rtn_u32 v127, v127, v2
    ds_add_rtn_u32 v36, v36, v2
    ds_add_rtn_u32 v37, v37, v2
    ds_add_rtn_u32 v38, v38, v2
    ds_add_rtn_u32 v39, v39, v2
    s_waitcnt lgkmcnt(0)
    s_barrier
    s_setprio 3
    v_and_b32 v7, -4, v72
    v_lshl_add_u32 v8, v72, 2, v7
    ds_write_b32 v8, v68
    v_lshl_add_u32 v7, v7, 2, v72
    ds_write_b8 v7, v64 offset:16
    v_and_b32 v9, -4, v73
    v_lshl_add_u32 v10, v73, 2, v9
    ds_write_b32 v10, v69
    v_lshl_add_u32 v9, v9, 2, v73
    ds_write_b8_d16_hi v9, v64 offset:16
    v_and_b32 v7, -4, v74
    v_lshl_add_u32 v8, v74, 2, v7
    ds_write_b32 v8, v70
    v_lshl_add_u32 v7, v7, 2, v74
    ds_write_b8 v7, v65 offset:16
    v_and_b32 v9, -4, v75
    v_lshl_add_u32 v10, v75, 2, v9
    ds_write_b32 v10, v71
    v_lshl_add_u32 v9, v9, 2, v75
    ds_write_b8_d16_hi v9, v65 offset:16
    s_add_u32 s46, s35, 0x2a48000
    s_add_u32 s46, s46, s85
    buffer_store_dwordx4 v[56:59], v0, s[20:23], s46 offen sc1
    s_add_u32 s47, s98, 0x6800000
    v_lshlrev_b32 v68, 1, v1
    buffer_load_dwordx4 v[68:71], v68, s[8:11], s47 offen nt
    s_add_u32 s44, s98, 0x6800000
    v_lshlrev_b32 v72, 1, v1
    buffer_load_dwordx4 v[72:75], v72, s[12:15], s44 offen nt
    v_and_b32 v7, -4, v80
    v_lshl_add_u32 v8, v80, 2, v7
    ds_write_b32 v8, v76
    v_lshl_add_u32 v7, v7, 2, v80
    ds_write_b8 v7, v66 offset:16
    v_and_b32 v9, -4, v81
    v_lshl_add_u32 v10, v81, 2, v9
    ds_write_b32 v10, v77
    v_lshl_add_u32 v9, v9, 2, v81
    ds_write_b8_d16_hi v9, v66 offset:16
    v_and_b32 v7, -4, v82
    v_lshl_add_u32 v8, v82, 2, v7
    ds_write_b32 v8, v78
    v_lshl_add_u32 v7, v7, 2, v82
    ds_write_b8 v7, v67 offset:16
    v_and_b32 v9, -4, v83
    v_lshl_add_u32 v10, v83, 2, v9
    ds_write_b32 v10, v79
    v_lshl_add_u32 v9, v9, 2, v83
    ds_write_b8_d16_hi v9, v67 offset:16
    s_add_u32 s45, s98, 0x6800000
    s_lshr_b32 s45, s45, 1
    buffer_load_dwordx2 v[56:57], v1, s[16:19], s45 offen nt
    s_add_u32 s46, s99, 0x6c00000
    s_lshr_b32 s46, s46, 1
    buffer_load_dwordx2 v[58:59], v1, s[16:19], s46 offen nt
    s_add_u32 s47, s99, 0x6c00000
    v_lshlrev_b32 v76, 1, v1
    buffer_load_dwordx4 v[76:79], v76, s[8:11], s47 offen nt
    s_setprio 2
    v_and_b32 v7, -4, v104
    v_lshl_add_u32 v8, v104, 2, v7
    ds_write_b32 v8, v96
    v_lshl_add_u32 v7, v7, 2, v104
    ds_write_b8 v7, v88 offset:16
    v_and_b32 v9, -4, v105
    v_lshl_add_u32 v10, v105, 2, v9
    ds_write_b32 v10, v97
    v_lshl_add_u32 v9, v9, 2, v105
    ds_write_b8_d16_hi v9, v88 offset:16
    v_and_b32 v7, -4, v106
    v_lshl_add_u32 v8, v106, 2, v7
    ds_write_b32 v8, v98
    v_lshl_add_u32 v7, v7, 2, v106
    ds_write_b8 v7, v89 offset:16
    v_and_b32 v9, -4, v107
    v_lshl_add_u32 v10, v107, 2, v9
    ds_write_b32 v10, v99
    v_lshl_add_u32 v9, v9, 2, v107
    ds_write_b8_d16_hi v9, v89 offset:16
    s_add_u32 s44, s35, 0x2a48000
    s_add_u32 s44, s44, s91
    buffer_store_dwordx4 v[60:63], v0, s[20:23], s44 offen sc1
    s_add_u32 s45, s99, 0x6c00000
    v_lshlrev_b32 v80, 1, v1
    buffer_load_dwordx4 v[80:83], v80, s[12:15], s45 offen nt
    v_and_b32 v7, -4, v100
    v_lshl_add_u32 v8, v100, 2, v7
    ds_write_b32 v8, v112
    v_lshl_add_u32 v7, v7, 2, v100
    ds_write_b8 v7, v90 offset:16
    v_and_b32 v9, -4, v101
    v_lshl_add_u32 v10, v101, 2, v9
    ds_write_b32 v10, v113
    v_lshl_add_u32 v9, v9, 2, v101
    ds_write_b8_d16_hi v9, v90 offset:16
    v_and_b32 v7, -4, v102
    v_lshl_add_u32 v8, v102, 2, v7
    ds_write_b32 v8, v114
    v_lshl_add_u32 v7, v7, 2, v102
    ds_write_b8 v7, v91 offset:16
    v_and_b32 v9, -4, v103
    v_lshl_add_u32 v10, v103, 2, v9
    ds_write_b32 v10, v115
    v_lshl_add_u32 v9, v9, 2, v103
    ds_write_b8_d16_hi v9, v91 offset:16
    s_add_u32 s46, s96, 0x7000000
    v_lshlrev_b32 v64, 1, v1
    buffer_load_dwordx4 v[64:67], v64, s[8:11], s46 offen nt
    s_add_u32 s47, s96, 0x7000000
    v_lshlrev_b32 v96, 1, v1
    buffer_load_dwordx4 v[96:99], v96, s[12:15], s47 offen nt
    s_setprio 1
    v_and_b32 v7, -4, v116
    v_lshl_add_u32 v8, v116, 2, v7
    ds_write_b32 v8, v108
    v_lshl_add_u32 v7, v7, 2, v116
    ds_write_b8 v7, v120 offset:16
    v_and_b32 v9, -4, v117
    v_lshl_add_u32 v10, v117, 2, v9
    ds_write_b32 v10, v109
    v_lshl_add_u32 v9, v9, 2, v117
    ds_write_b8_d16_hi v9, v120 offset:16
    v_and_b32 v7, -4, v118
    v_lshl_add_u32 v8, v118, 2, v7
    ds_write_b32 v8, v110
    v_lshl_add_u32 v7, v7, 2, v118
    ds_write_b8 v7, v121 offset:16
    v_and_b32 v9, -4, v119
    v_lshl_add_u32 v10, v119, 2, v9
    ds_write_b32 v10, v111
    v_lshl_add_u32 v9, v9, 2, v119
    ds_write_b8_d16_hi v9, v121 offset:16
    s_add_u32 s44, s96, 0x7000000
    s_lshr_b32 s44, s44, 1
    buffer_load_dwordx2 v[104:105], v1, s[16:19], s44 offen nt
    s_add_u32 s45, s97, 0x7400000
    s_lshr_b32 s45, s45, 1
    buffer_load_dwordx2 v[106:107], v1, s[16:19], s45 offen nt
    s_add_u32 s46, s97, 0x7400000
    v_lshlrev_b32 v60, 1, v1
    buffer_load_dwordx4 v[60:63], v60, s[8:11], s46 offen nt
    v_and_b32 v7, -4, v16
    v_lshl_add_u32 v8, v16, 2, v7
    ds_write_b32 v8, v92
    v_lshl_add_u32 v7, v7, 2, v16
    ds_write_b8 v7, v122 offset:16
    v_and_b32 v9, -4, v17
    v_lshl_add_u32 v10, v17, 2, v9
    ds_write_b32 v10, v93
    v_lshl_add_u32 v9, v9, 2, v17
    ds_write_b8_d16_hi v9, v122 offset:16
    v_and_b32 v7, -4, v18
    v_lshl_add_u32 v8, v18, 2, v7
    ds_write_b32 v8, v94
    v_lshl_add_u32 v7, v7, 2, v18
    ds_write_b8 v7, v123 offset:16
    v_and_b32 v9, -4, v19
    v_lshl_add_u32 v10, v19, 2, v9
    ds_write_b32 v10, v95
    v_lshl_add_u32 v9, v9, 2, v19
    ds_write_b8_d16_hi v9, v123 offset:16
    s_add_u32 s47, s35, 0x2a48000
    s_add_u32 s47, s47, s93
    buffer_store_dwordx4 v[44:47], v0, s[20:23], s47 offen sc1
    s_add_u32 s44, s97, 0x7400000
    v_lshlrev_b32 v112, 1, v1
    buffer_load_dwordx4 v[112:115], v112, s[12:15], s44 offen nt
    s_setprio 0
    v_and_b32 v7, -4, v124
    v_lshl_add_u32 v8, v124, 2, v7
    ds_write_b32 v8, v20
    v_lshl_add_u32 v7, v7, 2, v124
    ds_write_b8 v7, v28 offset:16
    v_and_b32 v9, -4, v125
    v_lshl_add_u32 v10, v125, 2, v9
    ds_write_b32 v10, v21
    v_lshl_add_u32 v9, v9, 2, v125
    ds_write_b8_d16_hi v9, v28 offset:16
    v_and_b32 v7, -4, v126
    v_lshl_add_u32 v8, v126, 2, v7
    ds_write_b32 v8, v22
    v_lshl_add_u32 v7, v7, 2, v126
    ds_write_b8 v7, v29 offset:16
    v_and_b32 v9, -4, v127
    v_lshl_add_u32 v10, v127, 2, v9
    ds_write_b32 v10, v23
    v_lshl_add_u32 v9, v9, 2, v127
    ds_write_b8_d16_hi v9, v29 offset:16
    s_add_u32 s45, s98, 0x7800000
    v_lshlrev_b32 v100, 1, v1
    buffer_load_dwordx4 v[100:103], v100, s[8:11], s45 offen nt
    s_add_u32 s46, s98, 0x7800000
    v_lshlrev_b32 v88, 1, v1
    buffer_load_dwordx4 v[88:91], v88, s[12:15], s46 offen nt
    v_and_b32 v7, -4, v36
    v_lshl_add_u32 v8, v36, 2, v7
    ds_write_b32 v8, v32
    v_lshl_add_u32 v7, v7, 2, v36
    ds_write_b8 v7, v30 offset:16
    v_and_b32 v9, -4, v37
    v_lshl_add_u32 v10, v37, 2, v9
    ds_write_b32 v10, v33
    v_lshl_add_u32 v9, v9, 2, v37
    ds_write_b8_d16_hi v9, v30 offset:16
    v_and_b32 v7, -4, v38
    v_lshl_add_u32 v8, v38, 2, v7
    ds_write_b32 v8, v34
    v_lshl_add_u32 v7, v7, 2, v38
    ds_write_b8 v7, v31 offset:16
    v_and_b32 v9, -4, v39
    v_lshl_add_u32 v10, v39, 2, v9
    ds_write_b32 v10, v35
    v_lshl_add_u32 v9, v9, 2, v39
    ds_write_b8_d16_hi v9, v31 offset:16
    s_add_u32 s47, s98, 0x7800000
    s_lshr_b32 s47, s47, 1
    buffer_load_dwordx2 v[108:109], v1, s[16:19], s47 offen nt
    s_add_u32 s44, s99, 0x7c00000
    s_lshr_b32 s44, s44, 1
    buffer_load_dwordx2 v[110:111], v1, s[16:19], s44 offen nt
    v_add_u32 v7, s72, v0
    v_add_u32 v12, s73, v0
    v_add_u32 v13, s85, v0
    v_add_u32 v14, s91, v0
    v_add_u32 v15, s93, v0
    s_min_i32 s3, s72, s73
    s_min_i32 s3, s3, s85
    s_min_i32 s3, s3, s91
    s_min_i32 s3, s3, s93
    v_add_u32 v3, s3, v0
    v_mov_b32 v8, 0
    v_mov_b32 v9, 0
    v_mov_b32 v10, 0
    v_mov_b32 v11, 0
    s_waitcnt lgkmcnt(0)
    s_barrier
    ds_read_b128 v[116:119], v7 offset:0
    ds_read_b128 v[92:95], v12 offset:0
    ds_read_b128 v[16:19], v13 offset:0
    ds_read_b128 v[120:123], v14 offset:0
    ds_read_b128 v[44:47], v15 offset:0
    ds_write_b128 v3, v[8:11]
    ds_read_b128 v[20:23], v7 offset:16384
    ds_read_b128 v[124:127], v12 offset:16384
    ds_read_b128 v[32:35], v13 offset:16384
    ds_read_b128 v[36:39], v14 offset:16384
    ds_read_b128 v[28:31], v15 offset:16384
    s_waitcnt lgkmcnt(0)
    s_barrier
    s_setprio 3
    s_add_u32 s45, s35, 0x5484000
    s_add_u32 s45, s45, s72
    buffer_store_dwordx4 v[116:119], v0, s[20:23], s45 offen sc1
    s_add_u32 s46, s99, 0x7c00000
    s_nop 0
    v_lshlrev_b32 v116, 1, v1
    buffer_load_dwordx4 v[116:119], v116, s[8:11], s46 offen nt
    s_add_u32 s47, s35, 0x5484000
    s_add_u32 s47, s47, s73
    buffer_store_dwordx4 v[92:95], v0, s[20:23], s47 offen sc1
    s_add_u32 s44, s99, 0x7c00000
    s_nop 0
    v_lshlrev_b32 v92, 1, v1
    buffer_load_dwordx4 v[92:95], v92, s[12:15], s44 offen nt
    s_waitcnt vmcnt(27)
    v_lshlrev_b32 v7, 16, v84
    v_and_b32 v8, 0xffff0000, v84
    v_lshlrev_b32 v9, 16, v85
    v_and_b32 v10, 0xffff0000, v85
    v_mul_f32 v7, 0.15915494, v7
    v_mul_f32 v8, 0.15915494, v8
    v_mul_f32 v9, 0.15915494, v9
    v_mul_f32 v10, 0.15915494, v10
    v_mul_hi_u32_u24 v14, 429497, v40
    v_lshrrev_b32 v12, 3, v24
    v_cos_f32 v7, v7
    v_lshlrev_b16 v13, 3, v24
    v_mad_i32_i24 v11, v14, s55, v40
    v_bitop3_b32 v12, v6, v13, v12 bitop3:0xca
    v_lshl_add_u32 v11, v11, 17, s40
    v_lshlrev_b16 v14, 8, v14
    v_lshrrev_b32 v13, 2, v24
    v_add_u32 v40, v12, v11
    v_bitop3_b32 v24, v5, v13, v14 bitop3:0xea
    ds_add_u32 v24, v2
    v_mul_hi_u32_u24 v14, 429497, v41
    v_lshrrev_b32 v12, 3, v25
    v_cos_f32 v8, v8
    v_lshlrev_b16 v13, 3, v25
    v_mad_i32_i24 v11, v14, s55, v41
    v_bitop3_b32 v12, v6, v13, v12 bitop3:0xca
    v_lshl_add_u32 v11, v11, 17, s40
    v_lshlrev_b16 v14, 8, v14
    v_lshrrev_b32 v13, 2, v25
    v_add_u32 v41, v12, v11
    v_bitop3_b32 v25, v5, v13, v14 bitop3:0xea
    ds_add_u32 v25, v2
    v_cvt_pk_bf16_f32 v84, v7, v8
    v_perm_b32 v12, v84, v84, s41
    v_bitop3_b32 v40, v4, v12, v40 bitop3:0xca
    v_perm_b32 v13, v84, v84, s42
    v_bitop3_b32 v41, v4, v13, v41 bitop3:0xca
    v_mul_hi_u32_u24 v14, 429497, v42
    v_lshrrev_b32 v12, 3, v26
    v_cos_f32 v9, v9
    v_lshlrev_b16 v13, 3, v26
    v_mad_i32_i24 v11, v14, s55, v42
    v_bitop3_b32 v12, v6, v13, v12 bitop3:0xca
    v_lshl_add_u32 v11, v11, 17, s40
    v_lshlrev_b16 v14, 8, v14
    v_lshrrev_b32 v13, 2, v26
    v_add_u32 v42, v12, v11
    v_bitop3_b32 v26, v5, v13, v14 bitop3:0xea
    ds_add_u32 v26, v2
    v_mul_hi_u32_u24 v14, 429497, v43
    v_lshrrev_b32 v12, 3, v27
    v_cos_f32 v10, v10
    v_lshlrev_b16 v13, 3, v27
    v_mad_i32_i24 v11, v14, s55, v43
    v_bitop3_b32 v12, v6, v13, v12 bitop3:0xca
    v_lshl_add_u32 v11, v11, 17, s40
    v_lshlrev_b16 v14, 8, v14
    v_lshrrev_b32 v13, 2, v27
    v_add_u32 v43, v12, v11
    v_bitop3_b32 v27, v5, v13, v14 bitop3:0xea
    ds_add_u32 v27, v2
    v_cvt_pk_bf16_f32 v85, v9, v10
    v_perm_b32 v12, v85, v85, s41
    v_bitop3_b32 v42, v4, v12, v42 bitop3:0xca
    v_perm_b32 v13, v85, v85, s42
    v_bitop3_b32 v43, v4, v13, v43 bitop3:0xca
    s_waitcnt vmcnt(23)
    v_lshlrev_b32 v7, 16, v86
    v_and_b32 v8, 0xffff0000, v86
    v_lshlrev_b32 v9, 16, v87
    v_and_b32 v10, 0xffff0000, v87
    v_mul_f32 v7, 0.15915494, v7
    v_mul_f32 v8, 0.15915494, v8
    v_mul_f32 v9, 0.15915494, v9
    v_mul_f32 v10, 0.15915494, v10
    v_mul_hi_u32_u24 v14, 429497, v48
    v_lshrrev_b32 v12, 3, v52
    v_cos_f32 v7, v7
    v_lshlrev_b16 v13, 3, v52
    v_mad_i32_i24 v11, v14, s55, v48
    v_bitop3_b32 v12, v6, v13, v12 bitop3:0xca
    v_lshl_add_u32 v11, v11, 17, s40
    v_lshlrev_b16 v14, 8, v14
    v_lshrrev_b32 v13, 2, v52
    v_add_u32 v48, v12, v11
    v_bitop3_b32 v52, v5, v13, v14 bitop3:0xea
    ds_add_u32 v52, v2
    v_mul_hi_u32_u24 v14, 429497, v49
    v_lshrrev_b32 v12, 3, v53
    v_cos_f32 v8, v8
    v_lshlrev_b16 v13, 3, v53
    v_mad_i32_i24 v11, v14, s55, v49
    v_bitop3_b32 v12, v6, v13, v12 bitop3:0xca
    v_lshl_add_u32 v11, v11, 17, s40
    v_lshlrev_b16 v14, 8, v14
    v_lshrrev_b32 v13, 2, v53
    v_add_u32 v49, v12, v11
    v_bitop3_b32 v53, v5, v13, v14 bitop3:0xea
    ds_add_u32 v53, v2
    v_cvt_pk_bf16_f32 v86, v7, v8
    v_perm_b32 v12, v86, v86, s41
    v_bitop3_b32 v48, v4, v12, v48 bitop3:0xca
    v_perm_b32 v13, v86, v86, s42
    v_bitop3_b32 v49, v4, v13, v49 bitop3:0xca
    v_mul_hi_u32_u24 v14, 429497, v50
    v_lshrrev_b32 v12, 3, v54
    v_cos_f32 v9, v9
    v_lshlrev_b16 v13, 3, v54
    v_mad_i32_i24 v11, v14, s55, v50
    v_bitop3_b32 v12, v6, v13, v12 bitop3:0xca
    v_lshl_add_u32 v11, v11, 17, s40
    v_lshlrev_b16 v14, 8, v14
    v_lshrrev_b32 v13, 2, v54
    v_add_u32 v50, v12, v11
    v_bitop3_b32 v54, v5, v13, v14 bitop3:0xea
    ds_add_u32 v54, v2
    v_mul_hi_u32_u24 v14, 429497, v51
    v_lshrrev_b32 v12, 3, v55
    v_cos_f32 v10, v10
    v_lshlrev_b16 v13, 3, v55
    v_mad_i32_i24 v11, v14, s55, v51
    v_bitop3_b32 v12, v6, v13, v12 bitop3:0xca
    v_lshl_add_u32 v11, v11, 17, s40
    v_lshlrev_b16 v14, 8, v14
    v_lshrrev_b32 v13, 2, v55
    v_add_u32 v51, v12, v11
    v_bitop3_b32 v55, v5, v13, v14 bitop3:0xea
    ds_add_u32 v55, v2
    v_cvt_pk_bf16_f32 v87, v9, v10
    v_perm_b32 v12, v87, v87, s41
    v_bitop3_b32 v50, v4, v12, v50 bitop3:0xca
    v_perm_b32 v13, v87, v87, s42
    v_bitop3_b32 v51, v4, v13, v51 bitop3:0xca
    s_setprio 2
    s_waitcnt vmcnt(18)
    v_lshlrev_b32 v7, 16, v56
    v_and_b32 v8, 0xffff0000, v56
    v_lshlrev_b32 v9, 16, v57
    v_and_b32 v10, 0xffff0000, v57
    v_mul_f32 v7, 0.15915494, v7
    v_mul_f32 v8, 0.15915494, v8
    v_mul_f32 v9, 0.15915494, v9
    v_mul_f32 v10, 0.15915494, v10
    v_mul_hi_u32_u24 v14, 429497, v68
    v_lshrrev_b32 v12, 3, v72
    v_cos_f32 v7, v7
    v_lshlrev_b16 v13, 3, v72
    v_mad_i32_i24 v11, v14, s55, v68
    v_bitop3_b32 v12, v6, v13, v12 bitop3:0xca
    v_lshl_add_u32 v11, v11, 17, s40
    v_lshlrev_b16 v14, 8, v14
    v_lshrrev_b32 v13, 2, v72
    v_add_u32 v68, v12, v11
    v_bitop3_b32 v72, v5, v13, v14 bitop3:0xea
    ds_add_u32 v72, v2
    v_mul_hi_u32_u24 v14, 429497, v69
    v_lshrrev_b32 v12, 3, v73
    v_cos_f32 v8, v8
    v_lshlrev_b16 v13, 3, v73
    v_mad_i32_i24 v11, v14, s55, v69
    v_bitop3_b32 v12, v6, v13, v12 bitop3:0xca
    v_lshl_add_u32 v11, v11, 17, s40
    v_lshlrev_b16 v14, 8, v14
    v_lshrrev_b32 v13, 2, v73
    v_add_u32 v69, v12, v11
    v_bitop3_b32 v73, v5, v13, v14 bitop3:0xea
    ds_add_u32 v73, v2
    v_cvt_pk_bf16_f32 v56, v7, v8
    v_perm_b32 v12, v56, v56, s41
    v_bitop3_b32 v68, v4, v12, v68 bitop3:0xca
    v_perm_b32 v13, v56, v56, s42
    v_bitop3_b32 v69, v4, v13, v69 bitop3:0xca
    v_mul_hi_u32_u24 v14, 429497, v70
    v_lshrrev_b32 v12, 3, v74
    v_cos_f32 v9, v9
    v_lshlrev_b16 v13, 3, v74
    v_mad_i32_i24 v11, v14, s55, v70
    v_bitop3_b32 v12, v6, v13, v12 bitop3:0xca
    v_lshl_add_u32 v11, v11, 17, s40
    v_lshlrev_b16 v14, 8, v14
    v_lshrrev_b32 v13, 2, v74
    v_add_u32 v70, v12, v11
    v_bitop3_b32 v74, v5, v13, v14 bitop3:0xea
    ds_add_u32 v74, v2
    v_mul_hi_u32_u24 v14, 429497, v71
    v_lshrrev_b32 v12, 3, v75
    v_cos_f32 v10, v10
    v_lshlrev_b16 v13, 3, v75
    v_mad_i32_i24 v11, v14, s55, v71
    v_bitop3_b32 v12, v6, v13, v12 bitop3:0xca
    v_lshl_add_u32 v11, v11, 17, s40
    v_lshlrev_b16 v14, 8, v14
    v_lshrrev_b32 v13, 2, v75
    v_add_u32 v71, v12, v11
    v_bitop3_b32 v75, v5, v13, v14 bitop3:0xea
    ds_add_u32 v75, v2
    v_cvt_pk_bf16_f32 v57, v9, v10
    v_perm_b32 v12, v57, v57, s41
    v_bitop3_b32 v70, v4, v12, v70 bitop3:0xca
    v_perm_b32 v13, v57, v57, s42
    v_bitop3_b32 v71, v4, v13, v71 bitop3:0xca
    s_add_u32 s45, s35, 0x5484000
    s_add_u32 s45, s45, s85
    buffer_store_dwordx4 v[16:19], v0, s[20:23], s45 offen sc1
    s_add_u32 s46, s96, 0x8000000
    s_nop 0
    v_lshlrev_b32 v16, 1, v1
    buffer_load_dwordx4 v[16:19], v16, s[8:11], s46 offen nt
    s_waitcnt vmcnt(17)
    v_lshlrev_b32 v7, 16, v58
    v_and_b32 v8, 0xffff0000, v58
    v_lshlrev_b32 v9, 16, v59
    v_and_b32 v10, 0xffff0000, v59
    v_mul_f32 v7, 0.15915494, v7
    v_mul_f32 v8, 0.15915494, v8
    v_mul_f32 v9, 0.15915494, v9
    v_mul_f32 v10, 0.15915494, v10
    v_mul_hi_u32_u24 v14, 429497, v76
    v_lshrrev_b32 v12, 3, v80
    v_cos_f32 v7, v7
    v_lshlrev_b16 v13, 3, v80
    v_mad_i32_i24 v11, v14, s55, v76
    v_bitop3_b32 v12, v6, v13, v12 bitop3:0xca
    v_lshl_add_u32 v11, v11, 17, s40
    v_lshlrev_b16 v14, 8, v14
    v_lshrrev_b32 v13, 2, v80
    v_add_u32 v76, v12, v11
    v_bitop3_b32 v80, v5, v13, v14 bitop3:0xea
    ds_add_u32 v80, v2
    v_mul_hi_u32_u24 v14, 429497, v77
    v_lshrrev_b32 v12, 3, v81
    v_cos_f32 v8, v8
    v_lshlrev_b16 v13, 3, v81
    v_mad_i32_i24 v11, v14, s55, v77
    v_bitop3_b32 v12, v6, v13, v12 bitop3:0xca
    v_lshl_add_u32 v11, v11, 17, s40
    v_lshlrev_b16 v14, 8, v14
    v_lshrrev_b32 v13, 2, v81
    v_add_u32 v77, v12, v11
    v_bitop3_b32 v81, v5, v13, v14 bitop3:0xea
    ds_add_u32 v81, v2
    v_cvt_pk_bf16_f32 v58, v7, v8
    v_perm_b32 v12, v58, v58, s41
    v_bitop3_b32 v76, v4, v12, v76 bitop3:0xca
    v_perm_b32 v13, v58, v58, s42
    v_bitop3_b32 v77, v4, v13, v77 bitop3:0xca
    v_mul_hi_u32_u24 v14, 429497, v78
    v_lshrrev_b32 v12, 3, v82
    v_cos_f32 v9, v9
    v_lshlrev_b16 v13, 3, v82
    v_mad_i32_i24 v11, v14, s55, v78
    v_bitop3_b32 v12, v6, v13, v12 bitop3:0xca
    v_lshl_add_u32 v11, v11, 17, s40
    v_lshlrev_b16 v14, 8, v14
    v_lshrrev_b32 v13, 2, v82
    v_add_u32 v78, v12, v11
    v_bitop3_b32 v82, v5, v13, v14 bitop3:0xea
    ds_add_u32 v82, v2
    v_mul_hi_u32_u24 v14, 429497, v79
    v_lshrrev_b32 v12, 3, v83
    v_cos_f32 v10, v10
    v_lshlrev_b16 v13, 3, v83
    v_mad_i32_i24 v11, v14, s55, v79
    v_bitop3_b32 v12, v6, v13, v12 bitop3:0xca
    v_lshl_add_u32 v11, v11, 17, s40
    v_lshlrev_b16 v14, 8, v14
    v_lshrrev_b32 v13, 2, v83
    v_add_u32 v79, v12, v11
    v_bitop3_b32 v83, v5, v13, v14 bitop3:0xea
    ds_add_u32 v83, v2
    v_cvt_pk_bf16_f32 v59, v9, v10
    v_perm_b32 v12, v59, v59, s41
    v_bitop3_b32 v78, v4, v12, v78 bitop3:0xca
    v_perm_b32 v13, v59, v59, s42
    v_bitop3_b32 v79, v4, v13, v79 bitop3:0xca
    s_setprio 1
    s_waitcnt vmcnt(13)
    v_lshlrev_b32 v7, 16, v104
    v_and_b32 v8, 0xffff0000, v104
    v_lshlrev_b32 v9, 16, v105
    v_and_b32 v10, 0xffff0000, v105
    v_mul_f32 v7, 0.15915494, v7
    v_mul_f32 v8, 0.15915494, v8
    v_mul_f32 v9, 0.15915494, v9
    v_mul_f32 v10, 0.15915494, v10
    v_mul_hi_u32_u24 v14, 429497, v64
    v_lshrrev_b32 v12, 3, v96
    v_cos_f32 v7, v7
    v_lshlrev_b16 v13, 3, v96
    v_mad_i32_i24 v11, v14, s55, v64
    v_bitop3_b32 v12, v6, v13, v12 bitop3:0xca
    v_lshl_add_u32 v11, v11, 17, s40
    v_lshlrev_b16 v14, 8, v14
    v_lshrrev_b32 v13, 2, v96
    v_add_u32 v64, v12, v11
    v_bitop3_b32 v96, v5, v13, v14 bitop3:0xea
    ds_add_u32 v96, v2
    v_mul_hi_u32_u24 v14, 429497, v65
    v_lshrrev_b32 v12, 3, v97
    v_cos_f32 v8, v8
    v_lshlrev_b16 v13, 3, v97
    v_mad_i32_i24 v11, v14, s55, v65
    v_bitop3_b32 v12, v6, v13, v12 bitop3:0xca
    v_lshl_add_u32 v11, v11, 17, s40
    v_lshlrev_b16 v14, 8, v14
    v_lshrrev_b32 v13, 2, v97
    v_add_u32 v65, v12, v11
    v_bitop3_b32 v97, v5, v13, v14 bitop3:0xea
    ds_add_u32 v97, v2
    v_cvt_pk_bf16_f32 v104, v7, v8
    v_perm_b32 v12, v104, v104, s41
    v_bitop3_b32 v64, v4, v12, v64 bitop3:0xca
    v_perm_b32 v13, v104, v104, s42
    v_bitop3_b32 v65, v4, v13, v65 bitop3:0xca
    v_mul_hi_u32_u24 v14, 429497, v66
    v_lshrrev_b32 v12, 3, v98
    v_cos_f32 v9, v9
    v_lshlrev_b16 v13, 3, v98
    v_mad_i32_i24 v11, v14, s55, v66
    v_bitop3_b32 v12, v6, v13, v12 bitop3:0xca
    v_lshl_add_u32 v11, v11, 17, s40
    v_lshlrev_b16 v14, 8, v14
    v_lshrrev_b32 v13, 2, v98
    v_add_u32 v66, v12, v11
    v_bitop3_b32 v98, v5, v13, v14 bitop3:0xea
    ds_add_u32 v98, v2
    v_mul_hi_u32_u24 v14, 429497, v67
    v_lshrrev_b32 v12, 3, v99
    v_cos_f32 v10, v10
    v_lshlrev_b16 v13, 3, v99
    v_mad_i32_i24 v11, v14, s55, v67
    v_bitop3_b32 v12, v6, v13, v12 bitop3:0xca
    v_lshl_add_u32 v11, v11, 17, s40
    v_lshlrev_b16 v14, 8, v14
    v_lshrrev_b32 v13, 2, v99
    v_add_u32 v67, v12, v11
    v_bitop3_b32 v99, v5, v13, v14 bitop3:0xea
    ds_add_u32 v99, v2
    v_cvt_pk_bf16_f32 v105, v9, v10
    v_perm_b32 v12, v105, v105, s41
    v_bitop3_b32 v66, v4, v12, v66 bitop3:0xca
    v_perm_b32 v13, v105, v105, s42
    v_bitop3_b32 v67, v4, v13, v67 bitop3:0xca
    s_waitcnt vmcnt(10)
    v_lshlrev_b32 v7, 16, v106
    v_and_b32 v8, 0xffff0000, v106
    v_lshlrev_b32 v9, 16, v107
    v_and_b32 v10, 0xffff0000, v107
    v_mul_f32 v7, 0.15915494, v7
    v_mul_f32 v8, 0.15915494, v8
    v_mul_f32 v9, 0.15915494, v9
    v_mul_f32 v10, 0.15915494, v10
    v_mul_hi_u32_u24 v14, 429497, v60
    v_lshrrev_b32 v12, 3, v112
    v_cos_f32 v7, v7
    v_lshlrev_b16 v13, 3, v112
    v_mad_i32_i24 v11, v14, s55, v60
    v_bitop3_b32 v12, v6, v13, v12 bitop3:0xca
    v_lshl_add_u32 v11, v11, 17, s40
    v_lshlrev_b16 v14, 8, v14
    v_lshrrev_b32 v13, 2, v112
    v_add_u32 v60, v12, v11
    v_bitop3_b32 v112, v5, v13, v14 bitop3:0xea
    ds_add_u32 v112, v2
    v_mul_hi_u32_u24 v14, 429497, v61
    v_lshrrev_b32 v12, 3, v113
    v_cos_f32 v8, v8
    v_lshlrev_b16 v13, 3, v113
    v_mad_i32_i24 v11, v14, s55, v61
    v_bitop3_b32 v12, v6, v13, v12 bitop3:0xca
    v_lshl_add_u32 v11, v11, 17, s40
    v_lshlrev_b16 v14, 8, v14
    v_lshrrev_b32 v13, 2, v113
    v_add_u32 v61, v12, v11
    v_bitop3_b32 v113, v5, v13, v14 bitop3:0xea
    ds_add_u32 v113, v2
    v_cvt_pk_bf16_f32 v106, v7, v8
    v_perm_b32 v12, v106, v106, s41
    v_bitop3_b32 v60, v4, v12, v60 bitop3:0xca
    v_perm_b32 v13, v106, v106, s42
    v_bitop3_b32 v61, v4, v13, v61 bitop3:0xca
    v_mul_hi_u32_u24 v14, 429497, v62
    v_lshrrev_b32 v12, 3, v114
    v_cos_f32 v9, v9
    v_lshlrev_b16 v13, 3, v114
    v_mad_i32_i24 v11, v14, s55, v62
    v_bitop3_b32 v12, v6, v13, v12 bitop3:0xca
    v_lshl_add_u32 v11, v11, 17, s40
    v_lshlrev_b16 v14, 8, v14
    v_lshrrev_b32 v13, 2, v114
    v_add_u32 v62, v12, v11
    v_bitop3_b32 v114, v5, v13, v14 bitop3:0xea
    ds_add_u32 v114, v2
    v_mul_hi_u32_u24 v14, 429497, v63
    v_lshrrev_b32 v12, 3, v115
    v_cos_f32 v10, v10
    v_lshlrev_b16 v13, 3, v115
    v_mad_i32_i24 v11, v14, s55, v63
    v_bitop3_b32 v12, v6, v13, v12 bitop3:0xca
    v_lshl_add_u32 v11, v11, 17, s40
    v_lshlrev_b16 v14, 8, v14
    v_lshrrev_b32 v13, 2, v115
    v_add_u32 v63, v12, v11
    v_bitop3_b32 v115, v5, v13, v14 bitop3:0xea
    ds_add_u32 v115, v2
    v_cvt_pk_bf16_f32 v107, v9, v10
    v_perm_b32 v12, v107, v107, s41
    v_bitop3_b32 v62, v4, v12, v62 bitop3:0xca
    v_perm_b32 v13, v107, v107, s42
    v_bitop3_b32 v63, v4, v13, v63 bitop3:0xca
    s_setprio 0
    s_add_u32 s47, s35, 0x5484000
    s_add_u32 s47, s47, s91
    buffer_store_dwordx4 v[120:123], v0, s[20:23], s47 offen sc1
    s_add_u32 s44, s96, 0x8000000
    s_nop 0
    v_lshlrev_b32 v120, 1, v1
    buffer_load_dwordx4 v[120:123], v120, s[12:15], s44 offen nt
    s_waitcnt vmcnt(8)
    v_lshlrev_b32 v7, 16, v108
    v_and_b32 v8, 0xffff0000, v108
    v_lshlrev_b32 v9, 16, v109
    v_and_b32 v10, 0xffff0000, v109
    v_mul_f32 v7, 0.15915494, v7
    v_mul_f32 v8, 0.15915494, v8
    v_mul_f32 v9, 0.15915494, v9
    v_mul_f32 v10, 0.15915494, v10
    v_mul_hi_u32_u24 v14, 429497, v100
    v_lshrrev_b32 v12, 3, v88
    v_cos_f32 v7, v7
    v_lshlrev_b16 v13, 3, v88
    v_mad_i32_i24 v11, v14, s55, v100
    v_bitop3_b32 v12, v6, v13, v12 bitop3:0xca
    v_lshl_add_u32 v11, v11, 17, s40
    v_lshlrev_b16 v14, 8, v14
    v_lshrrev_b32 v13, 2, v88
    v_add_u32 v100, v12, v11
    v_bitop3_b32 v88, v5, v13, v14 bitop3:0xea
    ds_add_u32 v88, v2
    v_mul_hi_u32_u24 v14, 429497, v101
    v_lshrrev_b32 v12, 3, v89
    v_cos_f32 v8, v8
    v_lshlrev_b16 v13, 3, v89
    v_mad_i32_i24 v11, v14, s55, v101
    v_bitop3_b32 v12, v6, v13, v12 bitop3:0xca
    v_lshl_add_u32 v11, v11, 17, s40
    v_lshlrev_b16 v14, 8, v14
    v_lshrrev_b32 v13, 2, v89
    v_add_u32 v101, v12, v11
    v_bitop3_b32 v89, v5, v13, v14 bitop3:0xea
    ds_add_u32 v89, v2
    v_cvt_pk_bf16_f32 v108, v7, v8
    v_perm_b32 v12, v108, v108, s41
    v_bitop3_b32 v100, v4, v12, v100 bitop3:0xca
    v_perm_b32 v13, v108, v108, s42
    v_bitop3_b32 v101, v4, v13, v101 bitop3:0xca
    v_mul_hi_u32_u24 v14, 429497, v102
    v_lshrrev_b32 v12, 3, v90
    v_cos_f32 v9, v9
    v_lshlrev_b16 v13, 3, v90
    v_mad_i32_i24 v11, v14, s55, v102
    v_bitop3_b32 v12, v6, v13, v12 bitop3:0xca
    v_lshl_add_u32 v11, v11, 17, s40
    v_lshlrev_b16 v14, 8, v14
    v_lshrrev_b32 v13, 2, v90
    v_add_u32 v102, v12, v11
    v_bitop3_b32 v90, v5, v13, v14 bitop3:0xea
    ds_add_u32 v90, v2
    v_mul_hi_u32_u24 v14, 429497, v103
    v_lshrrev_b32 v12, 3, v91
    v_cos_f32 v10, v10
    v_lshlrev_b16 v13, 3, v91
    v_mad_i32_i24 v11, v14, s55, v103
    v_bitop3_b32 v12, v6, v13, v12 bitop3:0xca
    v_lshl_add_u32 v11, v11, 17, s40
    v_lshlrev_b16 v14, 8, v14
    v_lshrrev_b32 v13, 2, v91
    v_add_u32 v103, v12, v11
    v_bitop3_b32 v91, v5, v13, v14 bitop3:0xea
    ds_add_u32 v91, v2
    v_cvt_pk_bf16_f32 v109, v9, v10
    v_perm_b32 v12, v109, v109, s41
    v_bitop3_b32 v102, v4, v12, v102 bitop3:0xca
    v_perm_b32 v13, v109, v109, s42
    v_bitop3_b32 v103, v4, v13, v103 bitop3:0xca
    s_mov_b32 s68, s66
    s_mov_b32 s69, s67
    s_mov_b32 s70, 0x100
    s_mov_b32 s71, 0x20000
    v_mov_b32 v3, 1
    s_cmp_lg_u32 s32, 15
    s_cbranch_scc1 L1_tk
    s_mov_b64 exec, 1
    s_and_b32 s3, s2, 1
    s_lshl_b32 s3, s3, 7
    buffer_atomic_add v3, off, s[68:71], s3 sc0
    s_mov_b64 exec, -1
L1_tk:
    s_waitcnt vmcnt(4)
    v_lshlrev_b32 v7, 16, v110
    v_and_b32 v8, 0xffff0000, v110
    v_lshlrev_b32 v9, 16, v111
    v_and_b32 v10, 0xffff0000, v111
    v_mul_f32 v7, 0.15915494, v7
    v_mul_f32 v8, 0.15915494, v8
    v_mul_f32 v9, 0.15915494, v9
    v_mul_f32 v10, 0.15915494, v10
    v_mul_hi_u32_u24 v14, 429497, v116
    v_lshrrev_b32 v12, 3, v92
    v_cos_f32 v7, v7
    v_lshlrev_b16 v13, 3, v92
    v_mad_i32_i24 v11, v14, s55, v116
    v_bitop3_b32 v12, v6, v13, v12 bitop3:0xca
    v_lshl_add_u32 v11, v11, 17, s40
    v_lshlrev_b16 v14, 8, v14
    v_lshrrev_b32 v13, 2, v92
    v_add_u32 v116, v12, v11
    v_bitop3_b32 v92, v5, v13, v14 bitop3:0xea
    ds_add_u32 v92, v2
    v_mul_hi_u32_u24 v14, 429497, v117
    v_lshrrev_b32 v12, 3, v93
    v_cos_f32 v8, v8
    v_lshlrev_b16 v13, 3, v93
    v_mad_i32_i24 v11, v14, s55, v117
    v_bitop3_b32 v12, v6, v13, v12 bitop3:0xca
    v_lshl_add_u32 v11, v11, 17, s40
    v_lshlrev_b16 v14, 8, v14
    v_lshrrev_b32 v13, 2, v93
    v_add_u32 v117, v12, v11
    v_bitop3_b32 v93, v5, v13, v14 bitop3:0xea
    ds_add_u32 v93, v2
    v_cvt_pk_bf16_f32 v110, v7, v8
    v_perm_b32 v12, v110, v110, s41
    v_bitop3_b32 v116, v4, v12, v116 bitop3:0xca
    v_perm_b32 v13, v110, v110, s42
    v_bitop3_b32 v117, v4, v13, v117 bitop3:0xca
    v_mul_hi_u32_u24 v14, 429497, v118
    v_lshrrev_b32 v12, 3, v94
    v_cos_f32 v9, v9
    v_lshlrev_b16 v13, 3, v94
    v_mad_i32_i24 v11, v14, s55, v118
    v_bitop3_b32 v12, v6, v13, v12 bitop3:0xca
    v_lshl_add_u32 v11, v11, 17, s40
    v_lshlrev_b16 v14, 8, v14
    v_lshrrev_b32 v13, 2, v94
    v_add_u32 v118, v12, v11
    v_bitop3_b32 v94, v5, v13, v14 bitop3:0xea
    ds_add_u32 v94, v2
    v_mul_hi_u32_u24 v14, 429497, v119
    v_lshrrev_b32 v12, 3, v95
    v_cos_f32 v10, v10
    v_lshlrev_b16 v13, 3, v95
    v_mad_i32_i24 v11, v14, s55, v119
    v_bitop3_b32 v12, v6, v13, v12 bitop3:0xca
    v_lshl_add_u32 v11, v11, 17, s40
    v_lshlrev_b16 v14, 8, v14
    v_lshrrev_b32 v13, 2, v95
    v_add_u32 v119, v12, v11
    v_bitop3_b32 v95, v5, v13, v14 bitop3:0xea
    ds_add_u32 v95, v2
    v_cvt_pk_bf16_f32 v111, v9, v10
    v_perm_b32 v12, v111, v111, s41
    v_bitop3_b32 v118, v4, v12, v118 bitop3:0xca
    v_perm_b32 v13, v111, v111, s42
    v_bitop3_b32 v119, v4, v13, v119 bitop3:0xca
    v_lshrrev_b32 v8, 2, v0
    v_and_b32 v7, 0x3c00, v0
    v_bitop3_b32 v7, v5, v8, v7 bitop3:0xea
    s_waitcnt lgkmcnt(0)
    s_barrier
    ds_read2st64_b32 v[8:9], v7 offset0:0 offset1:1
    ds_read2st64_b32 v[10:11], v7 offset0:2 offset1:3
    s_add_u32 s45, s35, 0x5484000
    s_add_u32 s45, s45, s93
    buffer_store_dwordx4 v[44:47], v0, s[20:23], s45 offen sc1
    s_add_u32 s46, s96, 0x8000000
    s_lshr_b32 s46, s46, 1
    buffer_load_dwordx2 v[44:45], v1, s[16:19], s46 offen nt
    s_add_u32 s47, s97, 0x8400000
    s_lshr_b32 s47, s47, 1
    buffer_load_dwordx2 v[46:47], v1, s[16:19], s47 offen nt
    s_waitcnt lgkmcnt(0)
    v_lshl_or_b32 v12, v9, 16, v8
    v_lshl_or_b32 v13, v11, 16, v10
    v_mov_b32 v14, v12
    v_mov_b32 v15, v13
    s_nop 0
    v_add_u32_dpp v14, v14, v14 row_shr:1 row_mask:0xf bank_mask:0xf bound_ctrl:1
    v_add_u32_dpp v15, v15, v15 row_shr:1 row_mask:0xf bank_mask:0xf bound_ctrl:1
    s_nop 0
    v_add_u32_dpp v14, v14, v14 row_shr:2 row_mask:0xf bank_mask:0xf bound_ctrl:1
    v_add_u32_dpp v15, v15, v15 row_shr:2 row_mask:0xf bank_mask:0xf bound_ctrl:1
    s_nop 0
    v_add_u32_dpp v14, v14, v14 row_shr:4 row_mask:0xf bank_mask:0xf bound_ctrl:1
    v_add_u32_dpp v15, v15, v15 row_shr:4 row_mask:0xf bank_mask:0xf bound_ctrl:1
    s_nop 0
    v_add_u32_dpp v14, v14, v14 row_shr:8 row_mask:0xf bank_mask:0xf bound_ctrl:1
    v_add_u32_dpp v15, v15, v15 row_shr:8 row_mask:0xf bank_mask:0xf bound_ctrl:1
    s_nop 0
    v_add_u32_dpp v14, v14, v14 row_bcast:15 row_mask:0xa bank_mask:0xf
    v_add_u32_dpp v15, v15, v15 row_bcast:15 row_mask:0xa bank_mask:0xf
    s_nop 0
    v_add_u32_dpp v14, v14, v14 row_bcast:31 row_mask:0xc bank_mask:0xf
    v_add_u32_dpp v15, v15, v15 row_bcast:31 row_mask:0xc bank_mask:0xf
    v_readlane_b32 s48, v14, 63
    v_readlane_b32 s49, v15, 63
    s_lshl_b32 s54, s32, 2
    v_mov_b32 v8, s54
    s_and_b32 s50, s48, 0xffff
    s_lshr_b32 s51, s48, 16
    s_and_b32 s52, s49, 0xffff
    s_lshr_b32 s53, s49, 16
    s_add_u32 s51, s51, s50
    s_add_u32 s52, s52, s51
    s_add_u32 s53, s53, s52
    v_mov_b32 v9, s53
    s_mov_b64 exec, 1
    ds_write_b32 v8, v9 offset:16384
    s_waitcnt vmcnt(3)
    ds_write_b32 v8, v3 offset:16448
    s_mov_b64 exec, -1
    v_and_b32 v8, 60, v7
    s_waitcnt lgkmcnt(0)
    s_barrier
    ds_read_b32 v9, v8 offset:16384
    ds_read_b32 v10, v8 offset:16448
    s_waitcnt lgkmcnt(0)
    v_readlane_b32 s84, v10, 15
    s_and_b32 s3, s2, 1
    s_lshl_b32 s3, s3, 7
    s_add_u32 s84, s84, s3
    s_min_u32 s4, s84, 96
    s_min_u32 s5, s84, 192
    s_min_u32 s6, s84, 240
    s_add_u32 s4, s4, s5
    s_add_u32 s4, s4, s6
    s_add_u32 s4, s4, 9467
    s_mov_b32 s4, s84
    s_lshl_b32 s58, s4, 14
    s_lshl_b32 s5, s32, 10
    s_add_u32 s58, s58, s5
    s_lshr_b32 s59, s58, 1
    s_mov_b32 s43, 5
    s_cmp_lt_u32 s84, 96
    s_addc_u32 s43, s43, 0
    s_cmp_lt_u32 s84, 192
    s_addc_u32 s43, s43, 0
    s_cmp_lt_u32 s84, 240
    s_addc_u32 s43, s43, 0
    v_add_u32_dpp v9, v9, v9 row_shr:1 row_mask:0xf bank_mask:0xf bound_ctrl:1
    s_nop 1
    v_add_u32_dpp v9, v9, v9 row_shr:2 row_mask:0xf bank_mask:0xf bound_ctrl:1
    s_nop 1
    v_add_u32_dpp v9, v9, v9 row_shr:4 row_mask:0xf bank_mask:0xf bound_ctrl:1
    s_nop 1
    v_add_u32_dpp v9, v9, v9 row_shr:8 row_mask:0xf bank_mask:0xf bound_ctrl:1
    s_nop 0
    v_readlane_b32 s54, v9, s32
    s_sub_u32 s54, s54, s53
    s_add_u32 s50, s50, s54
    s_add_u32 s51, s51, s54
    s_add_u32 s52, s52, s54
    s_pack_ll_b32_b16 s48, s54, s50
    s_pack_ll_b32_b16 s49, s51, s52
    v_add_u32 v14, s48, v14
    v_add_u32 v15, s49, v15
    v_sub_u32 v12, v14, v12
    v_sub_u32 v13, v15, v13
    v_and_b32 v8, 0xffff, v12
    v_lshrrev_b32 v9, 16, v12
    v_and_b32 v10, 0xffff, v13
    v_lshrrev_b32 v11, 16, v13
    ds_write2st64_b32 v7, v8, v9 offset0:0 offset1:1
    ds_write2st64_b32 v7, v10, v11 offset0:2 offset1:3
    v_and_b32 v8, 0x3f0, v0
    v_lshl_add_u32 v8, v8, 1, s36
    ds_write_b64 v8, v[12:13] offset:20480
    s_bitset0_b64 exec, 63
    s_not_b64 exec, exec
    ds_write_b64 v8, v[14:15] offset:20512
    s_mov_b64 exec, -1
    s_waitcnt lgkmcnt(0)
    s_barrier
    s_setprio 3
    ds_add_rtn_u32 v24, v24, v2
    ds_add_rtn_u32 v25, v25, v2
    ds_add_rtn_u32 v26, v26, v2
    ds_add_rtn_u32 v27, v27, v2
    ds_read_b128 v[12:15], v0 offset:20480
    v_cmp_gt_u32 vcc, 8448, v0
    ds_add_rtn_u32 v52, v52, v2
    ds_add_rtn_u32 v53, v53, v2
    ds_add_rtn_u32 v54, v54, v2
    ds_add_rtn_u32 v55, v55, v2
    s_setprio 2
    ds_add_rtn_u32 v72, v72, v2
    ds_add_rtn_u32 v73, v73, v2
    ds_add_rtn_u32 v74, v74, v2
    ds_add_rtn_u32 v75, v75, v2
    s_waitcnt lgkmcnt(8)
    s_cbranch_vccz L1_p4
    s_add_u32 s44, s35, 0x7ec0000
    s_mov_b64 exec, vcc
    buffer_store_dwordx4 v[12:15], v0, s[24:27], s44 offen sc1
    s_mov_b64 exec, -1
L1_p4:
    s_add_u32 s45, s35, 0x5488000
    s_add_u32 s45, s45, s72
    buffer_store_dwordx4 v[20:23], v0, s[20:23], s45 offen sc1
    s_add_u32 s46, s97, 0x8400000
    s_nop 0
    v_lshlrev_b32 v20, 1, v1
    buffer_load_dwordx4 v[20:23], v20, s[8:11], s46 offen nt
    ds_add_rtn_u32 v80, v80, v2
    ds_add_rtn_u32 v81, v81, v2
    ds_add_rtn_u32 v82, v82, v2
    ds_add_rtn_u32 v83, v83, v2
    s_setprio 1
    ds_add_rtn_u32 v96, v96, v2
    ds_add_rtn_u32 v97, v97, v2
    ds_add_rtn_u32 v98, v98, v2
    ds_add_rtn_u32 v99, v99, v2
    ds_add_rtn_u32 v112, v112, v2
    ds_add_rtn_u32 v113, v113, v2
    ds_add_rtn_u32 v114, v114, v2
    ds_add_rtn_u32 v115, v115, v2
    s_add_u32 s47, s35, 0x5488000
    s_add_u32 s47, s47, s73
    buffer_store_dwordx4 v[124:127], v0, s[20:23], s47 offen sc1
    s_add_u32 s44, s97, 0x8400000
    s_nop 0
    v_lshlrev_b32 v124, 1, v1
    buffer_load_dwordx4 v[124:127], v124, s[12:15], s44 offen nt
    s_setprio 0
    ds_add_rtn_u32 v88, v88, v2
    ds_add_rtn_u32 v89, v89, v2
    ds_add_rtn_u32 v90, v90, v2
    ds_add_rtn_u32 v91, v91, v2
    ds_add_rtn_u32 v92, v92, v2
    ds_add_rtn_u32 v93, v93, v2
    ds_add_rtn_u32 v94, v94, v2
    ds_add_rtn_u32 v95, v95, v2
    s_waitcnt lgkmcnt(0)
    s_barrier
    s_setprio 3
    v_and_b32 v7, -4, v24
    v_lshl_add_u32 v8, v24, 2, v7
    ds_write_b32 v8, v40
    v_lshl_add_u32 v7, v7, 2, v24
    ds_write_b8 v7, v84 offset:16
    v_and_b32 v9, -4, v25
    v_lshl_add_u32 v10, v25, 2, v9
    ds_write_b32 v10, v41
    v_lshl_add_u32 v9, v9, 2, v25
    ds_write_b8_d16_hi v9, v84 offset:16
    v_and_b32 v7, -4, v26
    v_lshl_add_u32 v8, v26, 2, v7
    ds_write_b32 v8, v42
    v_lshl_add_u32 v7, v7, 2, v26
    ds_write_b8 v7, v85 offset:16
    v_and_b32 v9, -4, v27
    v_lshl_add_u32 v10, v27, 2, v9
    ds_write_b32 v10, v43
    v_lshl_add_u32 v9, v9, 2, v27
    ds_write_b8_d16_hi v9, v85 offset:16
    s_add_u32 s45, s35, 0x5488000
    s_add_u32 s45, s45, s85
    buffer_store_dwordx4 v[32:35], v0, s[20:23], s45 offen sc1
    s_add_u32 s46, s98, 0x8800000
    v_lshlrev_b32 v40, 1, v1
    buffer_load_dwordx4 v[40:43], v40, s[8:11], s46 offen nt
    s_add_u32 s47, s98, 0x8800000
    v_lshlrev_b32 v24, 1, v1
    buffer_load_dwordx4 v[24:27], v24, s[12:15], s47 offen nt
    v_and_b32 v7, -4, v52
    v_lshl_add_u32 v8, v52, 2, v7
    ds_write_b32 v8, v48
    v_lshl_add_u32 v7, v7, 2, v52
    ds_write_b8 v7, v86 offset:16
    v_and_b32 v9, -4, v53
    v_lshl_add_u32 v10, v53, 2, v9
    ds_write_b32 v10, v49
    v_lshl_add_u32 v9, v9, 2, v53
    ds_write_b8_d16_hi v9, v86 offset:16
    v_and_b32 v7, -4, v54
    v_lshl_add_u32 v8, v54, 2, v7
    ds_write_b32 v8, v50
    v_lshl_add_u32 v7, v7, 2, v54
    ds_write_b8 v7, v87 offset:16
    v_and_b32 v9, -4, v55
    v_lshl_add_u32 v10, v55, 2, v9
    ds_write_b32 v10, v51
    v_lshl_add_u32 v9, v9, 2, v55
    ds_write_b8_d16_hi v9, v87 offset:16
    s_add_u32 s44, s98, 0x8800000
    s_lshr_b32 s44, s44, 1
    buffer_load_dwordx2 v[32:33], v1, s[16:19], s44 offen nt
    s_add_u32 s45, s99, 0x8c00000
    s_lshr_b32 s45, s45, 1
    buffer_load_dwordx2 v[34:35], v1, s[16:19], s45 offen nt
    s_add_u32 s46, s99, 0x8c00000
    v_lshlrev_b32 v48, 1, v1
    buffer_load_dwordx4 v[48:51], v48, s[8:11], s46 offen nt
    s_setprio 2
    v_and_b32 v7, -4, v72
    v_lshl_add_u32 v8, v72, 2, v7
    ds_write_b32 v8, v68
    v_lshl_add_u32 v7, v7, 2, v72
    ds_write_b8 v7, v56 offset:16
    v_and_b32 v9, -4, v73
    v_lshl_add_u32 v10, v73, 2, v9
    ds_write_b32 v10, v69
    v_lshl_add_u32 v9, v9, 2, v73
    ds_write_b8_d16_hi v9, v56 offset:16
    v_and_b32 v7, -4, v74
    v_lshl_add_u32 v8, v74, 2, v7
    ds_write_b32 v8, v70
    v_lshl_add_u32 v7, v7, 2, v74
    ds_write_b8 v7, v57 offset:16
    v_and_b32 v9, -4, v75
    v_lshl_add_u32 v10, v75, 2, v9
    ds_write_b32 v10, v71
    v_lshl_add_u32 v9, v9, 2, v75
    ds_write_b8_d16_hi v9, v57 offset:16
    s_add_u32 s47, s35, 0x5488000
    s_add_u32 s47, s47, s91
    buffer_store_dwordx4 v[36:39], v0, s[20:23], s47 offen sc1
    s_add_u32 s44, s99, 0x8c00000
    v_lshlrev_b32 v52, 1, v1
    buffer_load_dwordx4 v[52:55], v52, s[12:15], s44 offen nt
    v_and_b32 v7, -4, v80
    v_lshl_add_u32 v8, v80, 2, v7
    ds_write_b32 v8, v76
    v_lshl_add_u32 v7, v7, 2, v80
    ds_write_b8 v7, v58 offset:16
    v_and_b32 v9, -4, v81
    v_lshl_add_u32 v10, v81, 2, v9
    ds_write_b32 v10, v77
    v_lshl_add_u32 v9, v9, 2, v81
    ds_write_b8_d16_hi v9, v58 offset:16
    v_and_b32 v7, -4, v82
    v_lshl_add_u32 v8, v82, 2, v7
    ds_write_b32 v8, v78
    v_lshl_add_u32 v7, v7, 2, v82
    ds_write_b8 v7, v59 offset:16
    v_and_b32 v9, -4, v83
    v_lshl_add_u32 v10, v83, 2, v9
    ds_write_b32 v10, v79
    v_lshl_add_u32 v9, v9, 2, v83
    ds_write_b8_d16_hi v9, v59 offset:16
    s_add_u32 s45, s96, 0x9000000
    v_lshlrev_b32 v84, 1, v1
    buffer_load_dwordx4 v[84:87], v84, s[8:11], s45 offen nt
    s_add_u32 s46, s96, 0x9000000
    v_lshlrev_b32 v68, 1, v1
    buffer_load_dwordx4 v[68:71], v68, s[12:15], s46 offen nt
    s_setprio 1
    v_and_b32 v7, -4, v96
    v_lshl_add_u32 v8, v96, 2, v7
    ds_write_b32 v8, v64
    v_lshl_add_u32 v7, v7, 2, v96
    ds_write_b8 v7, v104 offset:16
    v_and_b32 v9, -4, v97
    v_lshl_add_u32 v10, v97, 2, v9
    ds_write_b32 v10, v65
    v_lshl_add_u32 v9, v9, 2, v97
    ds_write_b8_d16_hi v9, v104 offset:16
    v_and_b32 v7, -4, v98
    v_lshl_add_u32 v8, v98, 2, v7
    ds_write_b32 v8, v66
    v_lshl_add_u32 v7, v7, 2, v98
    ds_write_b8 v7, v105 offset:16
    v_and_b32 v9, -4, v99
    v_lshl_add_u32 v10, v99, 2, v9
    ds_write_b32 v10, v67
    v_lshl_add_u32 v9, v9, 2, v99
    ds_write_b8_d16_hi v9, v105 offset:16
    s_add_u32 s47, s96, 0x9000000
    s_lshr_b32 s47, s47, 1
    buffer_load_dwordx2 v[72:73], v1, s[16:19], s47 offen nt
    s_cmp_le_u32 s43, 5
    s_cselect_b32 s18, 0, s18
    s_add_u32 s44, s59, 0x4a00000
    buffer_load_dwordx2 v[74:75], v1, s[16:19], s44 offen nt
    s_cmp_le_u32 s43, 5
    s_cselect_b32 s10, 0, s10
    s_add_u32 s45, s58, 0x9400000
    v_lshlrev_b32 v36, 1, v1
    buffer_load_dwordx4 v[36:39], v36, s[8:11], s45 offen nt
    v_and_b32 v7, -4, v112
    v_lshl_add_u32 v8, v112, 2, v7
    ds_write_b32 v8, v60
    v_lshl_add_u32 v7, v7, 2, v112
    ds_write_b8 v7, v106 offset:16
    v_and_b32 v9, -4, v113
    v_lshl_add_u32 v10, v113, 2, v9
    ds_write_b32 v10, v61
    v_lshl_add_u32 v9, v9, 2, v113
    ds_write_b8_d16_hi v9, v106 offset:16
    v_and_b32 v7, -4, v114
    v_lshl_add_u32 v8, v114, 2, v7
    ds_write_b32 v8, v62
    v_lshl_add_u32 v7, v7, 2, v114
    ds_write_b8 v7, v107 offset:16
    v_and_b32 v9, -4, v115
    v_lshl_add_u32 v10, v115, 2, v9
    ds_write_b32 v10, v63
    v_lshl_add_u32 v9, v9, 2, v115
    ds_write_b8_d16_hi v9, v107 offset:16
    s_add_u32 s46, s35, 0x5488000
    s_add_u32 s46, s46, s93
    buffer_store_dwordx4 v[28:31], v0, s[20:23], s46 offen sc1
    s_cmp_le_u32 s43, 5
    s_cselect_b32 s14, 0, s14
    s_add_u32 s47, s58, 0x9400000
    v_lshlrev_b32 v76, 1, v1
    buffer_load_dwordx4 v[76:79], v76, s[12:15], s47 offen nt
    s_setprio 0
    v_and_b32 v7, -4, v88
    v_lshl_add_u32 v8, v88, 2, v7
    ds_write_b32 v8, v100
    v_lshl_add_u32 v7, v7, 2, v88
    ds_write_b8 v7, v108 offset:16
    v_and_b32 v9, -4, v89
    v_lshl_add_u32 v10, v89, 2, v9
    ds_write_b32 v10, v101
    v_lshl_add_u32 v9, v9, 2, v89
    ds_write_b8_d16_hi v9, v108 offset:16
    v_and_b32 v7, -4, v90
    v_lshl_add_u32 v8, v90, 2, v7
    ds_write_b32 v8, v102
    v_lshl_add_u32 v7, v7, 2, v90
    ds_write_b8 v7, v109 offset:16
    v_and_b32 v9, -4, v91
    v_lshl_add_u32 v10, v91, 2, v9
    ds_write_b32 v10, v103
    v_lshl_add_u32 v9, v9, 2, v91
    ds_write_b8_d16_hi v9, v109 offset:16
    s_cmp_le_u32 s43, 6
    s_cselect_b32 s10, 0, s10
    s_add_u32 s44, s58, 0x97c0000
    v_lshlrev_b32 v80, 1, v1
    buffer_load_dwordx4 v[80:83], v80, s[8:11], s44 offen nt
    s_cmp_le_u32 s43, 6
    s_cselect_b32 s14, 0, s14
    s_add_u32 s45, s58, 0x97c0000
    v_lshlrev_b32 v56, 1, v1
    buffer_load_dwordx4 v[56:59], v56, s[12:15], s45 offen nt
    v_and_b32 v7, -4, v92
    v_lshl_add_u32 v8, v92, 2, v7
    ds_write_b32 v8, v116
    v_lshl_add_u32 v7, v7, 2, v92
    ds_write_b8 v7, v110 offset:16
    v_and_b32 v9, -4, v93
    v_lshl_add_u32 v10, v93, 2, v9
    ds_write_b32 v10, v117
    v_lshl_add_u32 v9, v9, 2, v93
    ds_write_b8_d16_hi v9, v110 offset:16
    v_and_b32 v7, -4, v94
    v_lshl_add_u32 v8, v94, 2, v7
    ds_write_b32 v8, v118
    v_lshl_add_u32 v7, v7, 2, v94
    ds_write_b8 v7, v111 offset:16
    v_and_b32 v9, -4, v95
    v_lshl_add_u32 v10, v95, 2, v9
    ds_write_b32 v10, v119
    v_lshl_add_u32 v9, v9, 2, v95
    ds_write_b8_d16_hi v9, v111 offset:16
    s_cmp_le_u32 s43, 6
    s_cselect_b32 s18, 0, s18
    s_add_u32 s46, s59, 0x4be0000
    buffer_load_dwordx2 v[64:65], v1, s[16:19], s46 offen nt
    s_cmp_le_u32 s43, 7
    s_cselect_b32 s18, 0, s18
    s_add_u32 s47, s59, 0x4d60000
    buffer_load_dwordx2 v[66:67], v1, s[16:19], s47 offen nt
    v_add_u32 v7, s72, v0
    v_add_u32 v12, s73, v0
    v_add_u32 v13, s85, v0
    v_add_u32 v14, s91, v0
    v_add_u32 v15, s93, v0
    s_min_i32 s3, s72, s73
    s_min_i32 s3, s3, s85
    s_min_i32 s3, s3, s91
    s_min_i32 s3, s3, s93
    v_add_u32 v3, s3, v0
    v_mov_b32 v8, 0
    v_mov_b32 v9, 0
    v_mov_b32 v10, 0
    v_mov_b32 v11, 0
    s_waitcnt lgkmcnt(0)
    s_barrier
    ds_read_b128 v[96:99], v7 offset:0
    ds_read_b128 v[60:63], v12 offset:0
    ds_read_b128 v[112:115], v13 offset:0
    ds_read_b128 v[104:107], v14 offset:0
    ds_read_b128 v[28:31], v15 offset:0
    ds_write_b128 v3, v[8:11]
    ds_read_b128 v[100:103], v7 offset:16384
    ds_read_b128 v[88:91], v12 offset:16384
    ds_read_b128 v[116:119], v13 offset:16384
    ds_read_b128 v[92:95], v14 offset:16384
    ds_read_b128 v[108:111], v15 offset:16384
    s_waitcnt lgkmcnt(0)
    s_barrier
    v_lshlrev_b32 v3, 3, v0
    v_and_b32 v3, 0x80, v3
    s_cmp_lg_u32 s32, 15
    s_cbranch_scc1 L2_k0
    s_mov_b64 exec, 3
    buffer_load_dword v3, v3, s[68:71], 0 offen sc1
    s_mov_b64 exec, -1
L2_k0:
    s_add_u32 s44, s35, 0x7ec4000
    s_add_u32 s44, s44, s72
    buffer_store_dwordx4 v[96:99], v0, s[20:23], s44 offen sc1
    s_cmp_le_u32 s43, 7
    s_cselect_b32 s10, 0, s10
    s_add_u32 s45, s58, 0x9ac0000
    v_lshlrev_b32 v96, 1, v1
    buffer_load_dwordx4 v[96:99], v96, s[8:11], s45 offen nt
    s_add_u32 s46, s35, 0x7ec4000
    s_add_u32 s46, s46, s73
    buffer_store_dwordx4 v[60:63], v0, s[20:23], s46 offen sc1
    s_cmp_le_u32 s43, 7
    s_cselect_b32 s14, 0, s14
    s_add_u32 s47, s58, 0x9ac0000
    v_lshlrev_b32 v60, 1, v1
    buffer_load_dwordx4 v[60:63], v60, s[12:15], s47 offen nt
    s_setprio 3
    s_waitcnt vmcnt(27)
    v_lshlrev_b32 v7, 16, v44
    v_and_b32 v8, 0xffff0000, v44
    v_lshlrev_b32 v9, 16, v45
    v_and_b32 v10, 0xffff0000, v45
    v_mul_f32 v7, 0.15915494, v7
    v_mul_f32 v8, 0.15915494, v8
    v_mul_f32 v9, 0.15915494, v9
    v_mul_f32 v10, 0.15915494, v10
    v_mul_hi_u32_u24 v14, 429497, v16
    v_lshrrev_b32 v12, 3, v120
    v_cos_f32 v7, v7
    v_lshlrev_b16 v13, 3, v120
    v_mad_i32_i24 v11, v14, s55, v16
    v_bitop3_b32 v12, v6, v13, v12 bitop3:0xca
    v_lshl_add_u32 v11, v11, 17, s40
    v_lshlrev_b16 v14, 8, v14
    v_lshrrev_b32 v13, 2, v120
    v_add_u32 v16, v12, v11
    v_bitop3_b32 v120, v5, v13, v14 bitop3:0xea
    ds_add_u32 v120, v2
    v_mul_hi_u32_u24 v14, 429497, v17
    v_lshrrev_b32 v12, 3, v121
    v_cos_f32 v8, v8
    v_lshlrev_b16 v13, 3, v121
    v_mad_i32_i24 v11, v14, s55, v17
    v_bitop3_b32 v12, v6, v13, v12 bitop3:0xca
    v_lshl_add_u32 v11, v11, 17, s40
    v_lshlrev_b16 v14, 8, v14
    v_lshrrev_b32 v13, 2, v121
    v_add_u32 v17, v12, v11
    v_bitop3_b32 v121, v5, v13, v14 bitop3:0xea
    ds_add_u32 v121, v2
    v_cvt_pk_bf16_f32 v44, v7, v8
    v_perm_b32 v12, v44, v44, s41
    v_bitop3_b32 v16, v4, v12, v16 bitop3:0xca
    v_perm_b32 v13, v44, v44, s42
    v_bitop3_b32 v17, v4, v13, v17 bitop3:0xca
    v_mul_hi_u32_u24 v14, 429497, v18
    v_lshrrev_b32 v12, 3, v122
    v_cos_f32 v9, v9
    v_lshlrev_b16 v13, 3, v122
    v_mad_i32_i24 v11, v14, s55, v18
    v_bitop3_b32 v12, v6, v13, v12 bitop3:0xca
    v_lshl_add_u32 v11, v11, 17, s40
    v_lshlrev_b16 v14, 8, v14
    v_lshrrev_b32 v13, 2, v122
    v_add_u32 v18, v12, v11
    v_bitop3_b32 v122, v5, v13, v14 bitop3:0xea
    ds_add_u32 v122, v2
    v_mul_hi_u32_u24 v14, 429497, v19
    v_lshrrev_b32 v12, 3, v123
    v_cos_f32 v10, v10
    v_lshlrev_b16 v13, 3, v123
    v_mad_i32_i24 v11, v14, s55, v19
    v_bitop3_b32 v12, v6, v13, v12 bitop3:0xca
    v_lshl_add_u32 v11, v11, 17, s40
    v_lshlrev_b16 v14, 8, v14
    v_lshrrev_b32 v13, 2, v123
    v_add_u32 v19, v12, v11
    v_bitop3_b32 v123, v5, v13, v14 bitop3:0xea
    ds_add_u32 v123, v2
    v_cvt_pk_bf16_f32 v45, v9, v10
    v_perm_b32 v12, v45, v45, s41
    v_bitop3_b32 v18, v4, v12, v18 bitop3:0xca
    v_perm_b32 v13, v45, v45, s42
    v_bitop3_b32 v19, v4, v13, v19 bitop3:0xca
    s_add_u32 s44, s35, 0x7ec4000
    s_add_u32 s44, s44, s85
    buffer_store_dwordx4 v[112:115], v0, s[20:23], s44 offen sc1
    s_waitcnt vmcnt(24)
    v_lshlrev_b32 v7, 16, v46
    v_and_b32 v8, 0xffff0000, v46
    v_lshlrev_b32 v9, 16, v47
    v_and_b32 v10, 0xffff0000, v47
    v_mul_f32 v7, 0.15915494, v7
    v_mul_f32 v8, 0.15915494, v8
    v_mul_f32 v9, 0.15915494, v9
    v_mul_f32 v10, 0.15915494, v10
    v_mul_hi_u32_u24 v14, 429497, v20
    v_lshrrev_b32 v12, 3, v124
    v_cos_f32 v7, v7
    v_lshlrev_b16 v13, 3, v124
    v_mad_i32_i24 v11, v14, s55, v20
    v_bitop3_b32 v12, v6, v13, v12 bitop3:0xca
    v_lshl_add_u32 v11, v11, 17, s40
    v_lshlrev_b16 v14, 8, v14
    v_lshrrev_b32 v13, 2, v124
    v_add_u32 v20, v12, v11
    v_bitop3_b32 v124, v5, v13, v14 bitop3:0xea
    ds_add_u32 v124, v2
    v_mul_hi_u32_u24 v14, 429497, v21
    v_lshrrev_b32 v12, 3, v125
    v_cos_f32 v8, v8
    v_lshlrev_b16 v13, 3, v125
    v_mad_i32_i24 v11, v14, s55, v21
    v_bitop3_b32 v12, v6, v13, v12 bitop3:0xca
    v_lshl_add_u32 v11, v11, 17, s40
    v_lshlrev_b16 v14, 8, v14
    v_lshrrev_b32 v13, 2, v125
    v_add_u32 v21, v12, v11
    v_bitop3_b32 v125, v5, v13, v14 bitop3:0xea
    ds_add_u32 v125, v2
    v_cvt_pk_bf16_f32 v46, v7, v8
    v_perm_b32 v12, v46, v46, s41
    v_bitop3_b32 v20, v4, v12, v20 bitop3:0xca
    v_perm_b32 v13, v46, v46, s42
    v_bitop3_b32 v21, v4, v13, v21 bitop3:0xca
    v_mul_hi_u32_u24 v14, 429497, v22
    v_lshrrev_b32 v12, 3, v126
    v_cos_f32 v9, v9
    v_lshlrev_b16 v13, 3, v126
    v_mad_i32_i24 v11, v14, s55, v22
    v_bitop3_b32 v12, v6, v13, v12 bitop3:0xca
    v_lshl_add_u32 v11, v11, 17, s40
    v_lshlrev_b16 v14, 8, v14
    v_lshrrev_b32 v13, 2, v126
    v_add_u32 v22, v12, v11
    v_bitop3_b32 v126, v5, v13, v14 bitop3:0xea
    ds_add_u32 v126, v2
    v_mul_hi_u32_u24 v14, 429497, v23
    v_lshrrev_b32 v12, 3, v127
    v_cos_f32 v10, v10
    v_lshlrev_b16 v13, 3, v127
    v_mad_i32_i24 v11, v14, s55, v23
    v_bitop3_b32 v12, v6, v13, v12 bitop3:0xca
    v_lshl_add_u32 v11, v11, 17, s40
    v_lshlrev_b16 v14, 8, v14
    v_lshrrev_b32 v13, 2, v127
    v_add_u32 v23, v12, v11
    v_bitop3_b32 v127, v5, v13, v14 bitop3:0xea
    ds_add_u32 v127, v2
    v_cvt_pk_bf16_f32 v47, v9, v10
    v_perm_b32 v12, v47, v47, s41
    v_bitop3_b32 v22, v4, v12, v22 bitop3:0xca
    v_perm_b32 v13, v47, v47, s42
    v_bitop3_b32 v23, v4, v13, v23 bitop3:0xca
    s_setprio 2
    s_add_u32 s45, s35, 0x7ec4000
    s_add_u32 s45, s45, s91
    buffer_store_dwordx4 v[104:107], v0, s[20:23], s45 offen sc1
    s_waitcnt vmcnt(20)
    v_lshlrev_b32 v7, 16, v32
    v_and_b32 v8, 0xffff0000, v32
    v_lshlrev_b32 v9, 16, v33
    v_and_b32 v10, 0xffff0000, v33
    v_mul_f32 v7, 0.15915494, v7
    v_mul_f32 v8, 0.15915494, v8
    v_mul_f32 v9, 0.15915494, v9
    v_mul_f32 v10, 0.15915494, v10
    v_mul_hi_u32_u24 v14, 429497, v40
    v_lshrrev_b32 v12, 3, v24
    v_cos_f32 v7, v7
    v_lshlrev_b16 v13, 3, v24
    v_mad_i32_i24 v11, v14, s55, v40
    v_bitop3_b32 v12, v6, v13, v12 bitop3:0xca
    v_lshl_add_u32 v11, v11, 17, s40
    v_lshlrev_b16 v14, 8, v14
    v_lshrrev_b32 v13, 2, v24
    v_add_u32 v40, v12, v11
    v_bitop3_b32 v24, v5, v13, v14 bitop3:0xea
    ds_add_u32 v24, v2
    v_mul_hi_u32_u24 v14, 429497, v41
    v_lshrrev_b32 v12, 3, v25
    v_cos_f32 v8, v8
    v_lshlrev_b16 v13, 3, v25
    v_mad_i32_i24 v11, v14, s55, v41
    v_bitop3_b32 v12, v6, v13, v12 bitop3:0xca
    v_lshl_add_u32 v11, v11, 17, s40
    v_lshlrev_b16 v14, 8, v14
    v_lshrrev_b32 v13, 2, v25
    v_add_u32 v41, v12, v11
    v_bitop3_b32 v25, v5, v13, v14 bitop3:0xea
    ds_add_u32 v25, v2
    v_cvt_pk_bf16_f32 v32, v7, v8
    v_perm_b32 v12, v32, v32, s41
    v_bitop3_b32 v40, v4, v12, v40 bitop3:0xca
    v_perm_b32 v13, v32, v32, s42
    v_bitop3_b32 v41, v4, v13, v41 bitop3:0xca
    v_mul_hi_u32_u24 v14, 429497, v42
    v_lshrrev_b32 v12, 3, v26
    v_cos_f32 v9, v9
    v_lshlrev_b16 v13, 3, v26
    v_mad_i32_i24 v11, v14, s55, v42
    v_bitop3_b32 v12, v6, v13, v12 bitop3:0xca
    v_lshl_add_u32 v11, v11, 17, s40
    v_lshlrev_b16 v14, 8, v14
    v_lshrrev_b32 v13, 2, v26
    v_add_u32 v42, v12, v11
    v_bitop3_b32 v26, v5, v13, v14 bitop3:0xea
    ds_add_u32 v26, v2
    v_mul_hi_u32_u24 v14, 429497, v43
    v_lshrrev_b32 v12, 3, v27
    v_cos_f32 v10, v10
    v_lshlrev_b16 v13, 3, v27
    v_mad_i32_i24 v11, v14, s55, v43
    v_bitop3_b32 v12, v6, v13, v12 bitop3:0xca
    v_lshl_add_u32 v11, v11, 17, s40
    v_lshlrev_b16 v14, 8, v14
    v_lshrrev_b32 v13, 2, v27
    v_add_u32 v43, v12, v11
    v_bitop3_b32 v27, v5, v13, v14 bitop3:0xea
    ds_add_u32 v27, v2
    v_cvt_pk_bf16_f32 v33, v9, v10
    v_perm_b32 v12, v33, v33, s41
    v_bitop3_b32 v42, v4, v12, v42 bitop3:0xca
    v_perm_b32 v13, v33, v33, s42
    v_bitop3_b32 v43, v4, v13, v43 bitop3:0xca
    s_waitcnt vmcnt(17)
    v_lshlrev_b32 v7, 16, v34
    v_and_b32 v8, 0xffff0000, v34
    v_lshlrev_b32 v9, 16, v35
    v_and_b32 v10, 0xffff0000, v35
    v_mul_f32 v7, 0.15915494, v7
    v_mul_f32 v8, 0.15915494, v8
    v_mul_f32 v9, 0.15915494, v9
    v_mul_f32 v10, 0.15915494, v10
    v_mul_hi_u32_u24 v14, 429497, v48
    v_lshrrev_b32 v12, 3, v52
    v_cos_f32 v7, v7
    v_lshlrev_b16 v13, 3, v52
    v_mad_i32_i24 v11, v14, s55, v48
    v_bitop3_b32 v12, v6, v13, v12 bitop3:0xca
    v_lshl_add_u32 v11, v11, 17, s40
    v_lshlrev_b16 v14, 8, v14
    v_lshrrev_b32 v13, 2, v52
    v_add_u32 v48, v12, v11
    v_bitop3_b32 v52, v5, v13, v14 bitop3:0xea
    ds_add_u32 v52, v2
    v_mul_hi_u32_u24 v14, 429497, v49
    v_lshrrev_b32 v12, 3, v53
    v_cos_f32 v8, v8
    v_lshlrev_b16 v13, 3, v53
    v_mad_i32_i24 v11, v14, s55, v49
    v_bitop3_b32 v12, v6, v13, v12 bitop3:0xca
    v_lshl_add_u32 v11, v11, 17, s40
    v_lshlrev_b16 v14, 8, v14
    v_lshrrev_b32 v13, 2, v53
    v_add_u32 v49, v12, v11
    v_bitop3_b32 v53, v5, v13, v14 bitop3:0xea
    ds_add_u32 v53, v2
    v_cvt_pk_bf16_f32 v34, v7, v8
    v_perm_b32 v12, v34, v34, s41
    v_bitop3_b32 v48, v4, v12, v48 bitop3:0xca
    v_perm_b32 v13, v34, v34, s42
    v_bitop3_b32 v49, v4, v13, v49 bitop3:0xca
    v_mul_hi_u32_u24 v14, 429497, v50
    v_lshrrev_b32 v12, 3, v54
    v_cos_f32 v9, v9
    v_lshlrev_b16 v13, 3, v54
    v_mad_i32_i24 v11, v14, s55, v50
    v_bitop3_b32 v12, v6, v13, v12 bitop3:0xca
    v_lshl_add_u32 v11, v11, 17, s40
    v_lshlrev_b16 v14, 8, v14
    v_lshrrev_b32 v13, 2, v54
    v_add_u32 v50, v12, v11
    v_bitop3_b32 v54, v5, v13, v14 bitop3:0xea
    ds_add_u32 v54, v2
    v_mul_hi_u32_u24 v14, 429497, v51
    v_lshrrev_b32 v12, 3, v55
    v_cos_f32 v10, v10
    v_lshlrev_b16 v13, 3, v55
    v_mad_i32_i24 v11, v14, s55, v51
    v_bitop3_b32 v12, v6, v13, v12 bitop3:0xca
    v_lshl_add_u32 v11, v11, 17, s40
    v_lshlrev_b16 v14, 8, v14
    v_lshrrev_b32 v13, 2, v55
    v_add_u32 v51, v12, v11
    v_bitop3_b32 v55, v5, v13, v14 bitop3:0xea
    ds_add_u32 v55, v2
    v_cvt_pk_bf16_f32 v35, v9, v10
    v_perm_b32 v12, v35, v35, s41
    v_bitop3_b32 v50, v4, v12, v50 bitop3:0xca
    v_perm_b32 v13, v35, v35, s42
    v_bitop3_b32 v51, v4, v13, v51 bitop3:0xca
    s_setprio 1
    s_add_u32 s46, s35, 0x7ec4000
    s_add_u32 s46, s46, s93
    buffer_store_dwordx4 v[28:31], v0, s[20:23], s46 offen sc1
    v_lshrrev_b32 v15, 2, v0
    v_and_b32 v15, v5, v15
    s_cmp_ge_u32 s84, 128
    s_cselect_b32 s82, 0, s82
    s_and_b32 s3, s84, 1
    s_mul_i32 s3, s3, 40
    s_add_u32 s3, s3, s32
    s_mul_i32 s4, s3, 205
    s_lshr_b32 s4, s4, 10
    s_mul_i32 s5, s4, 5
    s_sub_u32 s5, s3, s5
    s_lshl_b32 s6, s4, 1
    s_add_u32 s6, s6, s5
    s_add_u32 s7, s6, s4
    s_add_u32 s7, s7, 30
    s_cmp_lt_u32 s5, 2
    s_cselect_b32 s6, s6, s7
    s_lshl_b32 s6, s6, 10
    s_lshr_b32 s7, s84, 1
    s_mul_i32 s7, s7, 80000
    s_add_u32 s6, s6, s7
    buffer_load_dword v112, v15, s[80:83], s6 offen offset:0
    buffer_load_dword v113, v15, s[80:83], s6 offen offset:256
    buffer_load_dword v114, v15, s[80:83], s6 offen offset:512
    buffer_load_dword v115, v15, s[80:83], s6 offen offset:768
    s_and_b32 s3, s84, 1
    s_mul_i32 s3, s3, 40
    s_add_u32 s3, s3, s32
    s_add_u32 s3, s3, 16
    s_mul_i32 s4, s3, 205
    s_lshr_b32 s4, s4, 10
    s_mul_i32 s5, s4, 5
    s_sub_u32 s5, s3, s5
    s_lshl_b32 s6, s4, 1
    s_add_u32 s6, s6, s5
    s_add_u32 s7, s6, s4
    s_add_u32 s7, s7, 30
    s_cmp_lt_u32 s5, 2
    s_cselect_b32 s6, s6, s7
    s_lshl_b32 s6, s6, 10
    s_lshr_b32 s7, s84, 1
    s_mul_i32 s7, s7, 80000
    s_add_u32 s6, s6, s7
    buffer_load_dword v104, v15, s[80:83], s6 offen offset:0
    buffer_load_dword v105, v15, s[80:83], s6 offen offset:256
    buffer_load_dword v106, v15, s[80:83], s6 offen offset:512
    buffer_load_dword v107, v15, s[80:83], s6 offen offset:768
    s_and_b32 s3, s84, 1
    s_mul_i32 s3, s3, 40
    s_add_u32 s3, s3, s32
    s_add_u32 s3, s3, 32
    s_cmp_ge_u32 s32, 8
    s_cselect_b32 s82, 0, s82
    s_mul_i32 s4, s3, 205
    s_lshr_b32 s4, s4, 10
    s_mul_i32 s5, s4, 5
    s_sub_u32 s5, s3, s5
    s_lshl_b32 s6, s4, 1
    s_add_u32 s6, s6, s5
    s_add_u32 s7, s6, s4
    s_add_u32 s7, s7, 30
    s_cmp_lt_u32 s5, 2
    s_cselect_b32 s6, s6, s7
    s_lshl_b32 s6, s6, 10
    s_lshr_b32 s7, s84, 1
    s_mul_i32 s7, s7, 80000
    s_add_u32 s6, s6, s7
    buffer_load_dword v28, v15, s[80:83], s6 offen offset:0
    buffer_load_dword v29, v15, s[80:83], s6 offen offset:256
    buffer_load_dword v30, v15, s[80:83], s6 offen offset:512
    buffer_load_dword v31, v15, s[80:83], s6 offen offset:768
    s_waitcnt vmcnt(26)
    v_lshlrev_b32 v7, 16, v72
    v_and_b32 v8, 0xffff0000, v72
    v_lshlrev_b32 v9, 16, v73
    v_and_b32 v10, 0xffff0000, v73
    v_mul_f32 v7, 0.15915494, v7
    v_mul_f32 v8, 0.15915494, v8
    v_mul_f32 v9, 0.15915494, v9
    v_mul_f32 v10, 0.15915494, v10
    v_mul_hi_u32_u24 v14, 429497, v84
    v_lshrrev_b32 v12, 3, v68
    v_cos_f32 v7, v7
    v_lshlrev_b16 v13, 3, v68
    v_mad_i32_i24 v11, v14, s55, v84
    v_bitop3_b32 v12, v6, v13, v12 bitop3:0xca
    v_lshl_add_u32 v11, v11, 17, s40
    v_lshlrev_b16 v14, 8, v14
    v_lshrrev_b32 v13, 2, v68
    v_add_u32 v84, v12, v11
    v_bitop3_b32 v68, v5, v13, v14 bitop3:0xea
    ds_add_u32 v68, v2
    v_mul_hi_u32_u24 v14, 429497, v85
    v_lshrrev_b32 v12, 3, v69
    v_cos_f32 v8, v8
    v_lshlrev_b16 v13, 3, v69
    v_mad_i32_i24 v11, v14, s55, v85
    v_bitop3_b32 v12, v6, v13, v12 bitop3:0xca
    v_lshl_add_u32 v11, v11, 17, s40
    v_lshlrev_b16 v14, 8, v14
    v_lshrrev_b32 v13, 2, v69
    v_add_u32 v85, v12, v11
    v_bitop3_b32 v69, v5, v13, v14 bitop3:0xea
    ds_add_u32 v69, v2
    v_cvt_pk_bf16_f32 v72, v7, v8
    v_perm_b32 v12, v72, v72, s41
    v_bitop3_b32 v84, v4, v12, v84 bitop3:0xca
    v_perm_b32 v13, v72, v72, s42
    v_bitop3_b32 v85, v4, v13, v85 bitop3:0xca
    v_mul_hi_u32_u24 v14, 429497, v86
    v_lshrrev_b32 v12, 3, v70
    v_cos_f32 v9, v9
    v_lshlrev_b16 v13, 3, v70
    v_mad_i32_i24 v11, v14, s55, v86
    v_bitop3_b32 v12, v6, v13, v12 bitop3:0xca
    v_lshl_add_u32 v11, v11, 17, s40
    v_lshlrev_b16 v14, 8, v14
    v_lshrrev_b32 v13, 2, v70
    v_add_u32 v86, v12, v11
    v_bitop3_b32 v70, v5, v13, v14 bitop3:0xea
    ds_add_u32 v70, v2
    v_mul_hi_u32_u24 v14, 429497, v87
    v_lshrrev_b32 v12, 3, v71
    v_cos_f32 v10, v10
    v_lshlrev_b16 v13, 3, v71
    v_mad_i32_i24 v11, v14, s55, v87
    v_bitop3_b32 v12, v6, v13, v12 bitop3:0xca
    v_lshl_add_u32 v11, v11, 17, s40
    v_lshlrev_b16 v14, 8, v14
    v_lshrrev_b32 v13, 2, v71
    v_add_u32 v87, v12, v11
    v_bitop3_b32 v71, v5, v13, v14 bitop3:0xea
    ds_add_u32 v71, v2
    v_cvt_pk_bf16_f32 v73, v9, v10
    v_perm_b32 v12, v73, v73, s41
    v_bitop3_b32 v86, v4, v12, v86 bitop3:0xca
    v_perm_b32 v13, v73, v73, s42
    v_bitop3_b32 v87, v4, v13, v87 bitop3:0xca
    s_waitcnt vmcnt(23)
    s_cmp_le_u32 s43, 5
    s_cbranch_scc1 L1_s5
    v_lshlrev_b32 v7, 16, v74
    v_and_b32 v8, 0xffff0000, v74
    v_lshlrev_b32 v9, 16, v75
    v_and_b32 v10, 0xffff0000, v75
    v_mul_f32 v7, 0.15915494, v7
    v_mul_f32 v8, 0.15915494, v8
    v_mul_f32 v9, 0.15915494, v9
    v_mul_f32 v10, 0.15915494, v10
    v_mul_hi_u32_u24 v14, 429497, v36
    v_lshrrev_b32 v12, 3, v76
    v_cos_f32 v7, v7
    v_lshlrev_b16 v13, 3, v76
    v_mad_i32_i24 v11, v14, s55, v36
    v_bitop3_b32 v12, v6, v13, v12 bitop3:0xca
    v_lshl_add_u32 v11, v11, 17, s40
    v_lshlrev_b16 v14, 8, v14
    v_lshrrev_b32 v13, 2, v76
    v_add_u32 v36, v12, v11
    v_bitop3_b32 v76, v5, v13, v14 bitop3:0xea
    ds_add_u32 v76, v2
    v_mul_hi_u32_u24 v14, 429497, v37
    v_lshrrev_b32 v12, 3, v77
    v_cos_f32 v8, v8
    v_lshlrev_b16 v13, 3, v77
    v_mad_i32_i24 v11, v14, s55, v37
    v_bitop3_b32 v12, v6, v13, v12 bitop3:0xca
    v_lshl_add_u32 v11, v11, 17, s40
    v_lshlrev_b16 v14, 8, v14
    v_lshrrev_b32 v13, 2, v77
    v_add_u32 v37, v12, v11
    v_bitop3_b32 v77, v5, v13, v14 bitop3:0xea
    ds_add_u32 v77, v2
    v_cvt_pk_bf16_f32 v74, v7, v8
    v_perm_b32 v12, v74, v74, s41
    v_bitop3_b32 v36, v4, v12, v36 bitop3:0xca
    v_perm_b32 v13, v74, v74, s42
    v_bitop3_b32 v37, v4, v13, v37 bitop3:0xca
    v_mul_hi_u32_u24 v14, 429497, v38
    v_lshrrev_b32 v12, 3, v78
    v_cos_f32 v9, v9
    v_lshlrev_b16 v13, 3, v78
    v_mad_i32_i24 v11, v14, s55, v38
    v_bitop3_b32 v12, v6, v13, v12 bitop3:0xca
    v_lshl_add_u32 v11, v11, 17, s40
    v_lshlrev_b16 v14, 8, v14
    v_lshrrev_b32 v13, 2, v78
    v_add_u32 v38, v12, v11
    v_bitop3_b32 v78, v5, v13, v14 bitop3:0xea
    ds_add_u32 v78, v2
    v_mul_hi_u32_u24 v14, 429497, v39
    v_lshrrev_b32 v12, 3, v79
    v_cos_f32 v10, v10
    v_lshlrev_b16 v13, 3, v79
    v_mad_i32_i24 v11, v14, s55, v39
    v_bitop3_b32 v12, v6, v13, v12 bitop3:0xca
    v_lshl_add_u32 v11, v11, 17, s40
    v_lshlrev_b16 v14, 8, v14
    v_lshrrev_b32 v13, 2, v79
    v_add_u32 v39, v12, v11
    v_bitop3_b32 v79, v5, v13, v14 bitop3:0xea
    ds_add_u32 v79, v2
    v_cvt_pk_bf16_f32 v75, v9, v10
    v_perm_b32 v12, v75, v75, s41
    v_bitop3_b32 v38, v4, v12, v38 bitop3:0xca
    v_perm_b32 v13, v75, v75, s42
    v_bitop3_b32 v39, v4, v13, v39 bitop3:0xca
L1_s5:
    s_setprio 0
    s_waitcnt vmcnt(19)
    s_cmp_le_u32 s43, 6
    s_cbranch_scc1 L1_s6
    v_lshlrev_b32 v7, 16, v64
    v_and_b32 v8, 0xffff0000, v64
    v_lshlrev_b32 v9, 16, v65
    v_and_b32 v10, 0xffff0000, v65
    v_mul_f32 v7, 0.15915494, v7
    v_mul_f32 v8, 0.15915494, v8
    v_mul_f32 v9, 0.15915494, v9
    v_mul_f32 v10, 0.15915494, v10
    v_mul_hi_u32_u24 v14, 429497, v80
    v_lshrrev_b32 v12, 3, v56
    v_cos_f32 v7, v7
    v_lshlrev_b16 v13, 3, v56
    v_mad_i32_i24 v11, v14, s55, v80
    v_bitop3_b32 v12, v6, v13, v12 bitop3:0xca
    v_lshl_add_u32 v11, v11, 17, s40
    v_lshlrev_b16 v14, 8, v14
    v_lshrrev_b32 v13, 2, v56
    v_add_u32 v80, v12, v11
    v_bitop3_b32 v56, v5, v13, v14 bitop3:0xea
    ds_add_u32 v56, v2
    v_mul_hi_u32_u24 v14, 429497, v81
    v_lshrrev_b32 v12, 3, v57
    v_cos_f32 v8, v8
    v_lshlrev_b16 v13, 3, v57
    v_mad_i32_i24 v11, v14, s55, v81
    v_bitop3_b32 v12, v6, v13, v12 bitop3:0xca
    v_lshl_add_u32 v11, v11, 17, s40
    v_lshlrev_b16 v14, 8, v14
    v_lshrrev_b32 v13, 2, v57
    v_add_u32 v81, v12, v11
    v_bitop3_b32 v57, v5, v13, v14 bitop3:0xea
    ds_add_u32 v57, v2
    v_cvt_pk_bf16_f32 v64, v7, v8
    v_perm_b32 v12, v64, v64, s41
    v_bitop3_b32 v80, v4, v12, v80 bitop3:0xca
    v_perm_b32 v13, v64, v64, s42
    v_bitop3_b32 v81, v4, v13, v81 bitop3:0xca
    v_mul_hi_u32_u24 v14, 429497, v82
    v_lshrrev_b32 v12, 3, v58
    v_cos_f32 v9, v9
    v_lshlrev_b16 v13, 3, v58
    v_mad_i32_i24 v11, v14, s55, v82
    v_bitop3_b32 v12, v6, v13, v12 bitop3:0xca
    v_lshl_add_u32 v11, v11, 17, s40
    v_lshlrev_b16 v14, 8, v14
    v_lshrrev_b32 v13, 2, v58
    v_add_u32 v82, v12, v11
    v_bitop3_b32 v58, v5, v13, v14 bitop3:0xea
    ds_add_u32 v58, v2
    v_mul_hi_u32_u24 v14, 429497, v83
    v_lshrrev_b32 v12, 3, v59
    v_cos_f32 v10, v10
    v_lshlrev_b16 v13, 3, v59
    v_mad_i32_i24 v11, v14, s55, v83
    v_bitop3_b32 v12, v6, v13, v12 bitop3:0xca
    v_lshl_add_u32 v11, v11, 17, s40
    v_lshlrev_b16 v14, 8, v14
    v_lshrrev_b32 v13, 2, v59
    v_add_u32 v83, v12, v11
    v_bitop3_b32 v59, v5, v13, v14 bitop3:0xea
    ds_add_u32 v59, v2
    v_cvt_pk_bf16_f32 v65, v9, v10
    v_perm_b32 v12, v65, v65, s41
    v_bitop3_b32 v82, v4, v12, v82 bitop3:0xca
    v_perm_b32 v13, v65, v65, s42
    v_bitop3_b32 v83, v4, v13, v83 bitop3:0xca
L1_s6:
    s_waitcnt vmcnt(15)
    s_cmp_le_u32 s43, 7
    s_cbranch_scc1 L1_s7
    v_lshlrev_b32 v7, 16, v66
    v_and_b32 v8, 0xffff0000, v66
    v_lshlrev_b32 v9, 16, v67
    v_and_b32 v10, 0xffff0000, v67
    v_mul_f32 v7, 0.15915494, v7
    v_mul_f32 v8, 0.15915494, v8
    v_mul_f32 v9, 0.15915494, v9
    v_mul_f32 v10, 0.15915494, v10
    v_mul_hi_u32_u24 v14, 429497, v96
    v_lshrrev_b32 v12, 3, v60
    v_cos_f32 v7, v7
    v_lshlrev_b16 v13, 3, v60
    v_mad_i32_i24 v11, v14, s55, v96
    v_bitop3_b32 v12, v6, v13, v12 bitop3:0xca
    v_lshl_add_u32 v11, v11, 17, s40
    v_lshlrev_b16 v14, 8, v14
    v_lshrrev_b32 v13, 2, v60
    v_add_u32 v96, v12, v11
    v_bitop3_b32 v60, v5, v13, v14 bitop3:0xea
    ds_add_u32 v60, v2
    v_mul_hi_u32_u24 v14, 429497, v97
    v_lshrrev_b32 v12, 3, v61
    v_cos_f32 v8, v8
    v_lshlrev_b16 v13, 3, v61
    v_mad_i32_i24 v11, v14, s55, v97
    v_bitop3_b32 v12, v6, v13, v12 bitop3:0xca
    v_lshl_add_u32 v11, v11, 17, s40
    v_lshlrev_b16 v14, 8, v14
    v_lshrrev_b32 v13, 2, v61
    v_add_u32 v97, v12, v11
    v_bitop3_b32 v61, v5, v13, v14 bitop3:0xea
    ds_add_u32 v61, v2
    v_cvt_pk_bf16_f32 v66, v7, v8
    v_perm_b32 v12, v66, v66, s41
    v_bitop3_b32 v96, v4, v12, v96 bitop3:0xca
    v_perm_b32 v13, v66, v66, s42
    v_bitop3_b32 v97, v4, v13, v97 bitop3:0xca
    v_mul_hi_u32_u24 v14, 429497, v98
    v_lshrrev_b32 v12, 3, v62
    v_cos_f32 v9, v9
    v_lshlrev_b16 v13, 3, v62
    v_mad_i32_i24 v11, v14, s55, v98
    v_bitop3_b32 v12, v6, v13, v12 bitop3:0xca
    v_lshl_add_u32 v11, v11, 17, s40
    v_lshlrev_b16 v14, 8, v14
    v_lshrrev_b32 v13, 2, v62
    v_add_u32 v98, v12, v11
    v_bitop3_b32 v62, v5, v13, v14 bitop3:0xea
    ds_add_u32 v62, v2
    v_mul_hi_u32_u24 v14, 429497, v99
    v_lshrrev_b32 v12, 3, v63
    v_cos_f32 v10, v10
    v_lshlrev_b16 v13, 3, v63
    v_mad_i32_i24 v11, v14, s55, v99
    v_bitop3_b32 v12, v6, v13, v12 bitop3:0xca
    v_lshl_add_u32 v11, v11, 17, s40
    v_lshlrev_b16 v14, 8, v14
    v_lshrrev_b32 v13, 2, v63
    v_add_u32 v99, v12, v11
    v_bitop3_b32 v63, v5, v13, v14 bitop3:0xea
    ds_add_u32 v63, v2
    v_cvt_pk_bf16_f32 v67, v9, v10
    v_perm_b32 v12, v67, v67, s41
    v_bitop3_b32 v98, v4, v12, v98 bitop3:0xca
    v_perm_b32 v13, v67, v67, s42
    v_bitop3_b32 v99, v4, v13, v99 bitop3:0xca
L1_s7:
    v_lshrrev_b32 v8, 2, v0
    v_and_b32 v7, 0x3c00, v0
    v_bitop3_b32 v7, v5, v8, v7 bitop3:0xea
    s_waitcnt lgkmcnt(0)
    s_barrier
    ds_read2st64_b32 v[8:9], v7 offset0:0 offset1:1
    ds_read2st64_b32 v[10:11], v7 offset0:2 offset1:3
    s_add_u32 s47, s35, 0x7ec8000
    s_add_u32 s47, s47, s72
    buffer_store_dwordx4 v[100:103], v0, s[20:23], s47 offen sc1
    s_waitcnt lgkmcnt(0)
    v_lshl_or_b32 v12, v9, 16, v8
    v_lshl_or_b32 v13, v11, 16, v10
    v_mov_b32 v14, v12
    v_mov_b32 v15, v13
    s_nop 0
    v_add_u32_dpp v14, v14, v14 row_shr:1 row_mask:0xf bank_mask:0xf bound_ctrl:1
    v_add_u32_dpp v15, v15, v15 row_shr:1 row_mask:0xf bank_mask:0xf bound_ctrl:1
    s_nop 0
    v_add_u32_dpp v14, v14, v14 row_shr:2 row_mask:0xf bank_mask:0xf bound_ctrl:1
    v_add_u32_dpp v15, v15, v15 row_shr:2 row_mask:0xf bank_mask:0xf bound_ctrl:1
    s_nop 0
    v_add_u32_dpp v14, v14, v14 row_shr:4 row_mask:0xf bank_mask:0xf bound_ctrl:1
    v_add_u32_dpp v15, v15, v15 row_shr:4 row_mask:0xf bank_mask:0xf bound_ctrl:1
    s_nop 0
    v_add_u32_dpp v14, v14, v14 row_shr:8 row_mask:0xf bank_mask:0xf bound_ctrl:1
    v_add_u32_dpp v15, v15, v15 row_shr:8 row_mask:0xf bank_mask:0xf bound_ctrl:1
    s_nop 0
    v_add_u32_dpp v14, v14, v14 row_bcast:15 row_mask:0xa bank_mask:0xf
    v_add_u32_dpp v15, v15, v15 row_bcast:15 row_mask:0xa bank_mask:0xf
    s_nop 0
    v_add_u32_dpp v14, v14, v14 row_bcast:31 row_mask:0xc bank_mask:0xf
    v_add_u32_dpp v15, v15, v15 row_bcast:31 row_mask:0xc bank_mask:0xf
    v_readlane_b32 s48, v14, 63
    v_readlane_b32 s49, v15, 63
    s_lshl_b32 s54, s32, 2
    v_mov_b32 v8, s54
    s_and_b32 s50, s48, 0xffff
    s_lshr_b32 s51, s48, 16
    s_and_b32 s52, s49, 0xffff
    s_lshr_b32 s53, s49, 16
    s_add_u32 s51, s51, s50
    s_add_u32 s52, s52, s51
    s_add_u32 s53, s53, s52
    v_mov_b32 v9, s53
    v_and_b32_dpp v3, v3, v3 quad_perm:[1,0,3,2] row_mask:0xf bank_mask:0xf
    s_mov_b64 exec, 1
    ds_write_b32 v8, v9 offset:16384
    ds_write_b32 v8, v3 offset:16448
    s_mov_b64 exec, -1
    v_and_b32 v8, 60, v7
    s_waitcnt lgkmcnt(0)
    s_barrier
    ds_read_b32 v9, v8 offset:16384
    ds_read_b32 v10, v8 offset:16448
    s_waitcnt lgkmcnt(0)
    v_readlane_b32 s56, v10, 15
    s_xor_b32 s56, s56, 0x80
    v_add_u32_dpp v9, v9, v9 row_shr:1 row_mask:0xf bank_mask:0xf bound_ctrl:1
    s_nop 1
    v_add_u32_dpp v9, v9, v9 row_shr:2 row_mask:0xf bank_mask:0xf bound_ctrl:1
    s_nop 1
    v_add_u32_dpp v9, v9, v9 row_shr:4 row_mask:0xf bank_mask:0xf bound_ctrl:1
    s_nop 1
    v_add_u32_dpp v9, v9, v9 row_shr:8 row_mask:0xf bank_mask:0xf bound_ctrl:1
    s_nop 0
    v_readlane_b32 s54, v9, s32
    s_sub_u32 s54, s54, s53
    s_add_u32 s50, s50, s54
    s_add_u32 s51, s51, s54
    s_add_u32 s52, s52, s54
    s_pack_ll_b32_b16 s48, s54, s50
    s_pack_ll_b32_b16 s49, s51, s52
    v_add_u32 v14, s48, v14
    v_add_u32 v15, s49, v15
    v_sub_u32 v12, v14, v12
    v_sub_u32 v13, v15, v13
    v_and_b32 v8, 0xffff, v12
    v_lshrrev_b32 v9, 16, v12
    v_and_b32 v10, 0xffff, v13
    v_lshrrev_b32 v11, 16, v13
    ds_write2st64_b32 v7, v8, v9 offset0:0 offset1:1
    ds_write2st64_b32 v7, v10, v11 offset0:2 offset1:3
    v_and_b32 v8, 0x3f0, v0
    v_lshl_add_u32 v8, v8, 1, s36
    ds_write_b64 v8, v[12:13] offset:20480
    s_bitset0_b64 exec, 63
    s_not_b64 exec, exec
    ds_write_b64 v8, v[14:15] offset:20512
    s_mov_b64 exec, -1
    s_waitcnt lgkmcnt(0)
    s_barrier
    s_setprio 3
    ds_add_rtn_u32 v120, v120, v2
    ds_add_rtn_u32 v121, v121, v2
    ds_add_rtn_u32 v122, v122, v2
    ds_add_rtn_u32 v123, v123, v2
    ds_read_b128 v[12:15], v0 offset:20480
    v_cmp_gt_u32 vcc, 8448, v0
    ds_add_rtn_u32 v124, v124, v2
    ds_add_rtn_u32 v125, v125, v2
    ds_add_rtn_u32 v126, v126, v2
    ds_add_rtn_u32 v127, v127, v2
    s_setprio 2
    ds_add_rtn_u32 v24, v24, v2
    ds_add_rtn_u32 v25, v25, v2
    ds_add_rtn_u32 v26, v26, v2
    ds_add_rtn_u32 v27, v27, v2
    s_waitcnt lgkmcnt(8)
    s_cbranch_vccz L1_p8
    s_add_u32 s44, s35, 0xa900000
    s_mov_b64 exec, vcc
    buffer_store_dwordx4 v[12:15], v0, s[24:27], s44 offen sc1
    s_mov_b64 exec, -1
L1_p8:
    s_add_u32 s45, s35, 0x7ec8000
    s_add_u32 s45, s45, s73
    buffer_store_dwordx4 v[88:91], v0, s[20:23], s45 offen sc1
    ds_add_rtn_u32 v52, v52, v2
    ds_add_rtn_u32 v53, v53, v2
    ds_add_rtn_u32 v54, v54, v2
    ds_add_rtn_u32 v55, v55, v2
    s_load_dwordx2 s[28:29], s[0:1], 0
    s_load_dwordx2 s[50:51], s[0:1], 40
    s_load_dwordx2 s[52:53], s[0:1], 24
    s_setprio 1
    ds_add_rtn_u32 v68, v68, v2
    ds_add_rtn_u32 v69, v69, v2
    ds_add_rtn_u32 v70, v70, v2
    ds_add_rtn_u32 v71, v71, v2
    s_add_u32 s80, s30, 0xd344000
    s_addc_u32 s81, s31, 0
    s_mov_b32 s82, 0xa000
    s_mov_b32 s83, 0x20000
    s_min_u32 s3, s84, 127
    s_mul_i32 s3, s3, 40960
    s_add_u32 s80, s80, s3
    s_addc_u32 s81, s81, 0
    s_cmp_ge_u32 s84, 128
    s_cselect_b32 s82, 0, s82
    s_waitcnt vmcnt(2)
    v_add_u32 v9, 0, v0
    buffer_store_dwordx4 v[112:115], v9, s[80:83], 0 offen sc1
    v_add_u32 v9, 16384, v0
    buffer_store_dwordx4 v[104:107], v9, s[80:83], 0 offen sc1
    v_add_u32 v9, 32768, v0
    buffer_store_dwordx4 v[28:31], v9, s[80:83], 0 offen sc1
    s_cmp_le_u32 s43, 5
    s_cbranch_scc1 L1_s9
    ds_add_rtn_u32 v76, v76, v2
    ds_add_rtn_u32 v77, v77, v2
    ds_add_rtn_u32 v78, v78, v2
    ds_add_rtn_u32 v79, v79, v2
L1_s9:
    s_setprio 0
    s_cmp_le_u32 s43, 6
    s_cbranch_scc1 L1_s10
    ds_add_rtn_u32 v56, v56, v2
    ds_add_rtn_u32 v57, v57, v2
    ds_add_rtn_u32 v58, v58, v2
    ds_add_rtn_u32 v59, v59, v2
L1_s10:
    s_cmp_le_u32 s43, 7
    s_cbranch_scc1 L1_s11
    ds_add_rtn_u32 v60, v60, v2
    ds_add_rtn_u32 v61, v61, v2
    ds_add_rtn_u32 v62, v62, v2
    ds_add_rtn_u32 v63, v63, v2
L1_s11:
    s_waitcnt lgkmcnt(0)
    s_barrier
    s_load_dwordx4 s[96:99], s[50:51], 0
    s_mov_b64 s[4:5], s[52:53]
    s_bfe_u32 s33, s2, 0x20001
    s_and_b32 s34, s2, 1
    s_lshl_b32 s34, s34, 5
    s_lshr_b32 s3, s2, 3
    s_add_u32 s34, s34, s3
    s_mul_i32 s39, s33, 2080
    s_lshl_b32 s3, s34, 5
    s_add_u32 s39, s39, s3
    s_mul_i32 s40, s33, 1310720
    s_add_u32 s40, s40, 0x50000
    s_lshl_b32 s38, s32, 11
    s_mul_i32 s100, s32, 3072
    s_add_u32 s8, s30, 0x4000
    s_addc_u32 s9, s31, 0
    s_mov_b32 s10, 0xd340000
    s_mov_b32 s11, 0x20000
    s_add_u32 s12, s30, 0x2c000
    s_addc_u32 s13, s31, 0
    s_mov_b32 s14, 0xd318000
    s_mov_b32 s15, 0x20000
    s_mov_b32 s16, s64
    s_mov_b32 s17, s65
    s_mov_b32 s18, 0x20
    s_mov_b32 s19, 0x20000
    s_mov_b32 s24, s28
    s_mov_b32 s25, s29
    s_mov_b32 s26, 0x4e2000
    s_mov_b32 s27, 0x20000
    s_setprio 3
    v_and_b32 v7, -4, v120
    v_lshl_add_u32 v8, v120, 2, v7
    ds_write_b32 v8, v16
    v_lshl_add_u32 v7, v7, 2, v120
    ds_write_b8 v7, v44 offset:16
    v_and_b32 v9, -4, v121
    v_lshl_add_u32 v10, v121, 2, v9
    ds_write_b32 v10, v17
    v_lshl_add_u32 v9, v9, 2, v121
    ds_write_b8_d16_hi v9, v44 offset:16
    v_and_b32 v7, -4, v122
    v_lshl_add_u32 v8, v122, 2, v7
    ds_write_b32 v8, v18
    v_lshl_add_u32 v7, v7, 2, v122
    ds_write_b8 v7, v45 offset:16
    v_and_b32 v9, -4, v123
    v_lshl_add_u32 v10, v123, 2, v9
    ds_write_b32 v10, v19
    v_lshl_add_u32 v9, v9, 2, v123
    ds_write_b8_d16_hi v9, v45 offset:16
    s_add_u32 s46, s35, 0x7ec8000
    s_add_u32 s46, s46, s85
    buffer_store_dwordx4 v[116:119], v0, s[20:23], s46 offen sc1
    v_and_b32 v13, 0x3f0, v0
    v_and_b32 v14, 0x300, v13
    v_bfe_u32 v15, v13, 4, 4
    s_lshl_b32 s3, s32, 4
    v_add3_u32 v14, v14, v15, s3
    v_mul_u32_u24 v2, 173056, v14
    v_lshrrev_b32 v14, 6, v13
    s_add_u32 s3, s3, 0x400
    v_add_u32 v14, s3, v14
    v_mul_u32_u24 v4, 173056, v14
    v_and_b32 v14, 3, v14
    v_and_b32 v15, 0x30, v13
    v_lshl_add_u32 v14, v14, 5, v15
    v_add_u32 v6, v14, v4
    v_lshl_add_u32 v5, v15, 1, v2
    v_lshrrev_b32 v14, 3, v15
    buffer_load_ushort v100, v14, s[16:19], 0 offen offset:0
    buffer_load_ushort v101, v14, s[16:19], 0 offen offset:8
    buffer_load_ushort v102, v14, s[16:19], 0 offen offset:16
    buffer_load_ushort v103, v14, s[16:19], 0 offen offset:24
    s_mul_i32 s3, s32, 5120
    v_add_u32 v3, s3, v13
    v_lshrrev_b32 v14, 2, v13
    v_add_u32 v14, s38, v14
    v_and_b32 v7, -4, v124
    v_lshl_add_u32 v8, v124, 2, v7
    ds_write_b32 v8, v20
    v_lshl_add_u32 v7, v7, 2, v124
    ds_write_b8 v7, v46 offset:16
    v_and_b32 v9, -4, v125
    v_lshl_add_u32 v10, v125, 2, v9
    ds_write_b32 v10, v21
    v_lshl_add_u32 v9, v9, 2, v125
    ds_write_b8_d16_hi v9, v46 offset:16
    v_and_b32 v7, -4, v126
    v_lshl_add_u32 v8, v126, 2, v7
    ds_write_b32 v8, v22
    v_lshl_add_u32 v7, v7, 2, v126
    ds_write_b8 v7, v47 offset:16
    v_and_b32 v9, -4, v127
    v_lshl_add_u32 v10, v127, 2, v9
    ds_write_b32 v10, v23
    v_lshl_add_u32 v9, v9, 2, v127
    ds_write_b8_d16_hi v9, v47 offset:16
    s_setprio 2
    v_and_b32 v7, -4, v24
    v_lshl_add_u32 v8, v24, 2, v7
    ds_write_b32 v8, v40
    v_lshl_add_u32 v7, v7, 2, v24
    ds_write_b8 v7, v32 offset:16
    v_and_b32 v9, -4, v25
    v_lshl_add_u32 v10, v25, 2, v9
    ds_write_b32 v10, v41
    v_lshl_add_u32 v9, v9, 2, v25
    ds_write_b8_d16_hi v9, v32 offset:16
    v_and_b32 v7, -4, v26
    v_lshl_add_u32 v8, v26, 2, v7
    ds_write_b32 v8, v42
    v_lshl_add_u32 v7, v7, 2, v26
    ds_write_b8 v7, v33 offset:16
    v_and_b32 v9, -4, v27
    v_lshl_add_u32 v10, v27, 2, v9
    ds_write_b32 v10, v43
    v_lshl_add_u32 v9, v9, 2, v27
    ds_write_b8_d16_hi v9, v33 offset:16
    s_add_u32 s47, s35, 0x7ec8000
    s_add_u32 s47, s47, s91
    buffer_store_dwordx4 v[92:95], v0, s[20:23], s47 offen sc1
    v_and_b32 v7, -4, v52
    v_lshl_add_u32 v8, v52, 2, v7
    ds_write_b32 v8, v48
    v_lshl_add_u32 v7, v7, 2, v52
    ds_write_b8 v7, v34 offset:16
    v_and_b32 v9, -4, v53
    v_lshl_add_u32 v10, v53, 2, v9
    ds_write_b32 v10, v49
    v_lshl_add_u32 v9, v9, 2, v53
    ds_write_b8_d16_hi v9, v34 offset:16
    v_and_b32 v7, -4, v54
    v_lshl_add_u32 v8, v54, 2, v7
    ds_write_b32 v8, v50
    v_lshl_add_u32 v7, v7, 2, v54
    ds_write_b8 v7, v35 offset:16
    v_and_b32 v9, -4, v55
    v_lshl_add_u32 v10, v55, 2, v9
    ds_write_b32 v10, v51
    v_lshl_add_u32 v9, v9, 2, v55
    ds_write_b8_d16_hi v9, v35 offset:16
    s_setprio 1
    v_and_b32 v7, -4, v68
    v_lshl_add_u32 v8, v68, 2, v7
    ds_write_b32 v8, v84
    v_lshl_add_u32 v7, v7, 2, v68
    ds_write_b8 v7, v72 offset:16
    v_and_b32 v9, -4, v69
    v_lshl_add_u32 v10, v69, 2, v9
    ds_write_b32 v10, v85
    v_lshl_add_u32 v9, v9, 2, v69
    ds_write_b8_d16_hi v9, v72 offset:16
    v_and_b32 v7, -4, v70
    v_lshl_add_u32 v8, v70, 2, v7
    ds_write_b32 v8, v86
    v_lshl_add_u32 v7, v7, 2, v70
    ds_write_b8 v7, v73 offset:16
    v_and_b32 v9, -4, v71
    v_lshl_add_u32 v10, v71, 2, v9
    ds_write_b32 v10, v87
    v_lshl_add_u32 v9, v9, 2, v71
    ds_write_b8_d16_hi v9, v73 offset:16
    s_cmp_le_u32 s43, 5
    s_cbranch_scc1 L1_s12
    v_and_b32 v7, -4, v76
    v_lshl_add_u32 v8, v76, 2, v7
    ds_write_b32 v8, v36
    v_lshl_add_u32 v7, v7, 2, v76
    ds_write_b8 v7, v74 offset:16
    v_and_b32 v9, -4, v77
    v_lshl_add_u32 v10, v77, 2, v9
    ds_write_b32 v10, v37
    v_lshl_add_u32 v9, v9, 2, v77
    ds_write_b8_d16_hi v9, v74 offset:16
    v_and_b32 v7, -4, v78
    v_lshl_add_u32 v8, v78, 2, v7
    ds_write_b32 v8, v38
    v_lshl_add_u32 v7, v7, 2, v78
    ds_write_b8 v7, v75 offset:16
    v_and_b32 v9, -4, v79
    v_lshl_add_u32 v10, v79, 2, v9
    ds_write_b32 v10, v39
    v_lshl_add_u32 v9, v9, 2, v79
    ds_write_b8_d16_hi v9, v75 offset:16
L1_s12:
    s_add_u32 s44, s35, 0x7ec8000
    s_add_u32 s44, s44, s93
    buffer_store_dwordx4 v[108:111], v0, s[20:23], s44 offen sc1
    s_setprio 0
    s_cmp_le_u32 s43, 6
    s_cbranch_scc1 L1_s13
    v_and_b32 v7, -4, v56
    v_lshl_add_u32 v8, v56, 2, v7
    ds_write_b32 v8, v80
    v_lshl_add_u32 v7, v7, 2, v56
    ds_write_b8 v7, v64 offset:16
    v_and_b32 v9, -4, v57
    v_lshl_add_u32 v10, v57, 2, v9
    ds_write_b32 v10, v81
    v_lshl_add_u32 v9, v9, 2, v57
    ds_write_b8_d16_hi v9, v64 offset:16
    v_and_b32 v7, -4, v58
    v_lshl_add_u32 v8, v58, 2, v7
    ds_write_b32 v8, v82
    v_lshl_add_u32 v7, v7, 2, v58
    ds_write_b8 v7, v65 offset:16
    v_and_b32 v9, -4, v59
    v_lshl_add_u32 v10, v59, 2, v9
    ds_write_b32 v10, v83
    v_lshl_add_u32 v9, v9, 2, v59
    ds_write_b8_d16_hi v9, v65 offset:16
L1_s13:
    s_cmp_le_u32 s43, 7
    s_cbranch_scc1 L1_s14
    v_and_b32 v7, -4, v60
    v_lshl_add_u32 v8, v60, 2, v7
    ds_write_b32 v8, v96
    v_lshl_add_u32 v7, v7, 2, v60
    ds_write_b8 v7, v66 offset:16
    v_and_b32 v9, -4, v61
    v_lshl_add_u32 v10, v61, 2, v9
    ds_write_b32 v10, v97
    v_lshl_add_u32 v9, v9, 2, v61
    ds_write_b8_d16_hi v9, v66 offset:16
    v_and_b32 v7, -4, v62
    v_lshl_add_u32 v8, v62, 2, v7
    ds_write_b32 v8, v98
    v_lshl_add_u32 v7, v7, 2, v62
    ds_write_b8 v7, v67 offset:16
    v_and_b32 v9, -4, v63
    v_lshl_add_u32 v10, v63, 2, v9
    ds_write_b32 v10, v99
    v_lshl_add_u32 v9, v9, 2, v63
    ds_write_b8_d16_hi v9, v67 offset:16
L1_s14:
    s_waitcnt vmcnt(3)
    v_add_u32 v7, 0x10000, v0
    v_add_u32 v12, 0x20000, v0
    s_waitcnt lgkmcnt(0)
    s_barrier
    ds_read_b128 v[24:27], v0 offset:0
    ds_read_b128 v[28:31], v0 offset:16384
    ds_read_b128 v[32:35], v0 offset:32768
    ds_read_b128 v[36:39], v0 offset:49152
    ds_read_b128 v[76:79], v7 offset:0
    ds_read_b128 v[80:83], v7 offset:16384
    ds_read_b128 v[84:87], v7 offset:32768
    ds_read_b128 v[104:107], v7 offset:49152
    ds_read_b128 v[68:71], v12 offset:0
    ds_read_b128 v[72:75], v12 offset:16384
    s_cmp_lg_u32 s32, 0
    s_cbranch_scc1 L2_sg1
    s_mov_b32 exec_hi, 0
    v_mov_b32 v11, 1
    buffer_store_dword v11, v14, s[60:63], s57 offen sc1
    s_mov_b64 exec, -1
L2_sg1:
    s_waitcnt lgkmcnt(9)
    s_add_u32 s45, s35, 0xa904000
    buffer_store_dwordx4 v[24:27], v0, s[20:23], s45 offen sc1
    s_waitcnt lgkmcnt(8)
    s_add_u32 s46, s35, 0xa908000
    buffer_store_dwordx4 v[28:31], v0, s[20:23], s46 offen sc1
    s_waitcnt lgkmcnt(7)
    s_add_u32 s47, s35, 0xa90c000
    buffer_store_dwordx4 v[32:35], v0, s[20:23], s47 offen sc1
    s_waitcnt lgkmcnt(6)
    s_add_u32 s44, s35, 0xa910000
    buffer_store_dwordx4 v[36:39], v0, s[20:23], s44 offen sc1
    s_waitcnt lgkmcnt(5)
    s_add_u32 s45, s35, 0xa914000
    buffer_store_dwordx4 v[76:79], v0, s[20:23], s45 offen sc1
    s_waitcnt lgkmcnt(4)
    s_add_u32 s46, s35, 0xa918000
    buffer_store_dwordx4 v[80:83], v0, s[20:23], s46 offen sc1
    s_waitcnt lgkmcnt(3)
    s_add_u32 s47, s35, 0xa91c000
    buffer_store_dwordx4 v[84:87], v0, s[20:23], s47 offen sc1
    s_waitcnt lgkmcnt(2)
    s_cmp_le_u32 s43, 5
    s_cbranch_scc1 L1_q15
    s_add_u32 s44, s35, 0xa920000
    buffer_store_dwordx4 v[104:107], v0, s[20:23], s44 offen sc1
L1_q15:
    s_waitcnt lgkmcnt(1)
    s_cmp_le_u32 s43, 6
    s_cbranch_scc1 L1_q16
    s_add_u32 s45, s35, 0xa924000
    buffer_store_dwordx4 v[68:71], v0, s[20:23], s45 offen sc1
L1_q16:
    s_waitcnt lgkmcnt(0)
    s_cmp_le_u32 s43, 7
    s_cbranch_scc1 L1_q17
    s_add_u32 s46, s35, 0xa928000
    buffer_store_dwordx4 v[72:75], v0, s[20:23], s46 offen sc1
L1_q17:
    s_waitcnt lgkmcnt(0)
    s_barrier
    s_setprio 3
    v_mov_b32 v92, v0
    v_mov_b32 v93, v6
    v_mov_b32 v94, v13
    v_mov_b32 v95, v5
    v_mov_b32 v0, v14
    v_lshl_add_u32 v7, v13, 3, s38
    v_lshrrev_b32 v16, 2, v15
    v_mad_u32_u24 v4, v16, 5, v4
    v_or_b32 v4, 0xf0000000, v4
    v_or_b32 v2, 0xf0000000, v2
    v_sub_u32 v1, 28, v16
    v_lshrrev_b32 v17, 2, v16
    v_and_b32 v18, 3, v17
    v_lshlrev_b32 v18, 4, v18
    v_mov_b32 v10, 0x3f80
    v_mov_b32 v11, 0
    v_lshlrev_b64 v[10:11], v18, v[10:11]
    v_and_b32 v18, 3, v17
    v_lshlrev_b32 v18, 4, v18
    v_mov_b32 v12, 0xbf80
    v_mov_b32 v13, 0
    v_lshlrev_b64 v[12:13], v18, v[12:13]
    v_mov_b32 v45, 0xf0000000
    v_mov_b32 v5, 0x1fff8
    v_mov_b32 v6, 0x07ff0000
    v_mov_b32 v16, 0
    v_mov_b32 v17, 0
    v_mov_b32 v18, 0
    v_mov_b32 v19, 0
    v_add_u32 v20, 81920, v92
    v_add_u32 v21, 0x10000, v20
    ds_write_b128 v20, v[16:19] offset:0
    ds_write_b128 v20, v[16:19] offset:16384
    s_setprio 2
    ds_write_b128 v20, v[16:19] offset:32768
    ds_write_b128 v20, v[16:19] offset:49152
    ds_write_b128 v21, v[16:19]
    s_setprio 1
    s_setprio 0
    s_mov_b32 s44, 0x4000c0c
    s_mov_b32 s45, 0x4010c0c
    s_mov_b32 s46, 0x4020c0c
    s_mov_b32 s47, 0x4030c0c
    s_mov_b32 s36, 0
    s_mov_b32 s43, 0
    s_mov_b32 s42, 0
    s_mov_b64 s[80:81], 0
    s_mov_b64 s[84:85], 0
    s_mov_b64 s[48:49], 0
    s_add_u32 s16, s30, 0xd344000
    s_addc_u32 s17, s31, 0
    s_mov_b32 s18, 0x500000
    s_mov_b32 s19, 0x20000
    v_mov_b32 v68, 0
    v_mov_b32 v69, 0
    v_mov_b32 v70, 0
    v_mov_b32 v71, 0
    v_mov_b32 v72, 0
    v_mov_b32 v73, 0
    v_mov_b32 v74, 0
    v_mov_b32 v75, 0
    s_waitcnt vmcnt(0)
    v_lshl_or_b32 v8, v101, 16, v100
    v_lshl_or_b32 v9, v103, 16, v102
    s_barrier
    s_cmp_lg_u32 s32, 0
    s_cbranch_scc1 L2_sg2
    s_mov_b32 exec_hi, 0
    v_mov_b32 v88, 2
    buffer_store_dword v88, v0, s[60:63], s57 offen sc1
    s_mov_b64 exec, -1
L2_sg2:
    s_mul_i32 s3, s33, 1280000
    s_add_u32 s3, s3, s100
    s_add_u32 s3, s3, 32768
    buffer_load_dwordx4 v[124:127], v94, s[24:27], s3 offen offset:2048
    s_mul_i32 s3, s33, 1280000
    s_add_u32 s3, s3, s100
    s_add_u32 s3, s3, 32768
    buffer_load_dwordx4 v[116:119], v94, s[24:27], s3 offen offset:0
    s_mul_i32 s3, s33, 1280000
    s_add_u32 s3, s3, s100
    s_add_u32 s3, s3, 32768
    buffer_load_dwordx4 v[120:123], v94, s[24:27], s3 offen offset:1024
    s_mul_i32 s3, s33, 1280000
    s_add_u32 s3, s3, s38
    s_add_u32 s3, s3, 0
    buffer_load_dwordx4 v[108:111], v94, s[24:27], s3 offen offset:0
    s_mul_i32 s3, s33, 1280000
    s_add_u32 s3, s3, s38
    s_add_u32 s3, s3, 0
    buffer_load_dwordx4 v[112:115], v94, s[24:27], s3 offen offset:1024
    s_cmp_eq_u32 s56, 0
    s_cbranch_scc1 L2_e3
    v_lshlrev_b32 v16, 3, v94
    v_and_b32 v16, 0x80, v16
L2_e4:
    buffer_load_dword v88, v16, s[68:71], 0 offen sc1
    s_waitcnt vmcnt(0)
    v_cmp_gt_u32 vcc, 0x80, v88
    s_cbranch_vccnz L2_e4
L2_e3:
    s_mov_b64 exec, 0xffff
L2_p1:
    buffer_load_dword v88, v7, s[60:63], 0 offen sc1
    s_waitcnt vmcnt(0)
    v_cmp_gt_u32 vcc, 1, v88
    s_cbranch_vccnz L2_p1s
    s_mov_b64 exec, -1
    v_cmp_gt_u32 vcc, 2, v88
    s_and_b32 s56, vcc_lo, 0xffff
    buffer_load_dwordx4 v[48:51], v95, s[12:15], s39 offen offset:0
    buffer_load_dwordx4 v[56:59], v95, s[12:15], s39 offen offset:32
    buffer_load_dwordx4 v[52:55], v95, s[12:15], s39 offen offset:16
    buffer_load_dwordx4 v[60:63], v95, s[12:15], s39 offen offset:48
    buffer_load_dwordx4 v[64:67], v93, s[12:15], s39 offen
    s_waitcnt vmcnt(0)
    v_sub_u16 v88, v56, v48
    v_and_b32 v89, 3, v48
    v_add3_u32 v99, v88, v89, 3
    v_and_b32 v99, -4, v99
    v_max_u32 v99, 4, v99
    v_and_b32 v97, 0xfffc, v48
    v_bfm_b32 v96, v88, v89
    v_add_u32_dpp v91, v99, v99 row_shr:1 row_mask:0xf bank_mask:0xf bound_ctrl:1
    v_mad_u32_u24 v97, v97, 5, v2
    v_cmp_lt_u32 vcc, 16, v99
    v_add_u32_dpp v91, v91, v91 row_shr:2 row_mask:0xf bank_mask:0xf bound_ctrl:1
    v_sub_u32 v98, s38, v99
    v_lshrrev_b64 v[48:49], 16, v[48:49]
    v_add_u32_dpp v91, v91, v91 row_shr:4 row_mask:0xf bank_mask:0xf bound_ctrl:1
    v_lshrrev_b64 v[56:57], 16, v[56:57]
    s_mov_b32 s101, 0
    v_add_u32_dpp v91, v91, v91 row_shr:8 row_mask:0xf bank_mask:0xf bound_ctrl:1
    s_nop 1
    v_add_u32_dpp v91, v91, v91 row_bcast:15 row_mask:0xa bank_mask:0xf
    s_nop 1
    v_add_u32_dpp v91, v91, v91 row_bcast:31 row_mask:0xc bank_mask:0xf
    v_add_u32 v98, v98, v91
    v_readlane_b32 s37, v91, 63
    s_cbranch_vccnz L2_xo3
L2_xp3:
    v_mov_b32 v44, v43
    s_cmp_gt_u32 s37, 1024
    s_cbranch_scc1 L2_xs4
    s_cmp_lg_u32 s101, 0
    s_cbranch_scc1 L2_xa4
L2_xb4:
    v_lshlrev_b32 v89, 16, v96
    v_add_u32 v90, 60, v97
    v_bitop3_b32 v90, v89, v45, v90 bitop3:0x6a
    ds_write_b32 v98, v90 offset:12
    v_lshlrev_b32 v89, 20, v96
    v_add_u32 v90, 40, v97
    v_bitop3_b32 v90, v89, v45, v90 bitop3:0x6a
    ds_write_b32 v98, v90 offset:8
    v_lshlrev_b32 v89, 24, v96
    v_add_u32 v90, 20, v97
    v_bitop3_b32 v90, v89, v45, v90 bitop3:0x6a
    ds_write_b32 v98, v90 offset:4
    v_lshlrev_b32 v89, 28, v96
    v_bitop3_b32 v90, v89, v45, v97 bitop3:0x6a
    ds_write_b32 v98, v90 offset:0
    v_mov_b32_dpp v91, v64 quad_perm:[0,0,0,0] row_mask:0xf bank_mask:0xf
    v_and_b32 v89, 3, v91
    v_and_b32 v97, 0xfffc, v91
    v_sub_u16_dpp v88, v64, v91 quad_perm:[2,2,2,2] row_mask:0xf bank_mask:0xf
    v_mad_u32_u24 v97, v97, 5, v4
    v_add_u32 v99, v88, v89
    v_bfm_b32 v96, v88, v89
    v_cmp_lt_u32 s[58:59], 16, v99
    v_lshlrev_b32 v89, v1, v96
    v_and_b32 v89, v45, v89
    v_cmp_ne_u32 vcc, 0, v89
    v_xor_b32 v90, v97, v89
    s_add_u32 s3, s37, s38
    v_mbcnt_lo_u32_b32 v98, vcc_lo, 0
    v_mbcnt_hi_u32_b32 v98, vcc_hi, v98
    s_bcnt1_i32_b64 s41, vcc
    v_lshl_add_u32 v98, v98, 2, s3
    s_mov_b64 exec, vcc
    ds_write_b32 v98, v90
    s_mov_b64 exec, -1
    s_lshl2_add_u32 s37, s41, s37
    s_cmp_lg_u64 s[58:59], 0
    s_cbranch_scc1 L2_xe4
L2_xr4:
    v_add_u32 v98, s37, v0
    v_mov_b32 v90, -1
    ds_write_b32 v98, v90
    ds_read2st64_b32 v[40:41], v0 offset0:0 offset1:1
    ds_read2st64_b32 v[42:43], v0 offset0:2 offset1:3
    s_sub_u32 s3, s37, 768
    s_cmp_gt_u32 s3, 256
    s_cbranch_scc1 L2_xf4
L2_xg4:
    v_sub_u16 v88, v58, v50
    v_and_b32 v89, 3, v50
    v_add3_u32 v99, v88, v89, 3
    v_and_b32 v99, -4, v99
    v_max_u32 v99, 4, v99
    v_and_b32 v97, 0xfffc, v50
    v_bfm_b32 v96, v88, v89
    v_add_u32_dpp v91, v99, v99 row_shr:1 row_mask:0xf bank_mask:0xf bound_ctrl:1
    v_mad_u32_u24 v97, v97, 5, v2
    v_cmp_lt_u32 vcc, 16, v99
    v_add_u32_dpp v91, v91, v91 row_shr:2 row_mask:0xf bank_mask:0xf bound_ctrl:1
    v_sub_u32 v98, s38, v99
    v_lshrrev_b64 v[50:51], 16, v[50:51]
    v_add_u32_dpp v91, v91, v91 row_shr:4 row_mask:0xf bank_mask:0xf bound_ctrl:1
    v_lshrrev_b64 v[58:59], 16, v[58:59]
    s_mov_b32 s101, 0
    v_add_u32_dpp v91, v91, v91 row_shr:8 row_mask:0xf bank_mask:0xf bound_ctrl:1
    s_nop 1
    v_add_u32_dpp v91, v91, v91 row_bcast:15 row_mask:0xa bank_mask:0xf
    s_nop 1
    v_add_u32_dpp v91, v91, v91 row_bcast:31 row_mask:0xc bank_mask:0xf
    v_add_u32 v98, v98, v91
    v_readlane_b32 s37, v91, 63
    s_cbranch_vccnz L2_xo5
L2_xp5:
    s_waitcnt lgkmcnt(0)
    v_mov_b32 v21, v40
    v_mov_b32 v27, v41
    v_mov_b32 v33, v42
    v_mov_b32 v39, v43
    v_mov_b32 v44, v43
    s_cmp_gt_u32 s37, 1024
    s_cbranch_scc1 L2_xs6
    s_cmp_lg_u32 s101, 0
    s_cbranch_scc1 L2_xa6
L2_xb6:
    v_lshlrev_b32 v89, 16, v96
    v_add_u32 v90, 60, v97
    v_bitop3_b32 v90, v89, v45, v90 bitop3:0x6a
    ds_write_b32 v98, v90 offset:12
    v_lshlrev_b32 v89, 20, v96
    v_add_u32 v90, 40, v97
    v_bitop3_b32 v90, v89, v45, v90 bitop3:0x6a
    ds_write_b32 v98, v90 offset:8
    v_lshlrev_b32 v89, 24, v96
    v_add_u32 v90, 20, v97
    v_bitop3_b32 v90, v89, v45, v90 bitop3:0x6a
    ds_write_b32 v98, v90 offset:4
    v_lshlrev_b32 v89, 28, v96
    v_bitop3_b32 v90, v89, v45, v97 bitop3:0x6a
    ds_write_b32 v98, v90 offset:0
    v_mov_b32_dpp v91, v66 quad_perm:[0,0,0,0] row_mask:0xf bank_mask:0xf
    v_and_b32 v89, 3, v91
    v_and_b32 v97, 0xfffc, v91
    v_sub_u16_dpp v88, v66, v91 quad_perm:[2,2,2,2] row_mask:0xf bank_mask:0xf
    v_mad_u32_u24 v97, v97, 5, v4
    v_add_u32 v99, v88, v89
    v_bfm_b32 v96, v88, v89
    v_cmp_lt_u32 s[58:59], 16, v99
    v_lshlrev_b32 v89, v1, v96
    v_and_b32 v89, v45, v89
    v_cmp_ne_u32 vcc, 0, v89
    v_xor_b32 v90, v97, v89
    s_add_u32 s3, s37, s38
    v_mbcnt_lo_u32_b32 v98, vcc_lo, 0
    v_mbcnt_hi_u32_b32 v98, vcc_hi, v98
    s_bcnt1_i32_b64 s41, vcc
    v_lshl_add_u32 v98, v98, 2, s3
    s_mov_b64 exec, vcc
    ds_write_b32 v98, v90
    s_mov_b64 exec, -1
    s_lshl2_add_u32 s37, s41, s37
    s_cmp_lg_u64 s[58:59], 0
    s_cbranch_scc1 L2_xe6
L2_xr6:
    v_add_u32 v98, s37, v0
    v_mov_b32 v90, -1
    ds_write_b32 v98, v90
    ds_read2st64_b32 v[40:41], v0 offset0:0 offset1:1
    ds_read2st64_b32 v[42:43], v0 offset0:2 offset1:3
    s_sub_u32 s3, s37, 768
    s_cmp_gt_u32 s3, 256
    s_cbranch_scc1 L2_xf6
L2_xg6:
    v_subrev_u32 v88, s38, v3
    ds_write_b128 v88, v[124:127] offset:34816
    v_subrev_u32 v88, s38, v3
    ds_write_b128 v88, v[116:119] offset:32768
    v_subrev_u32 v88, s38, v3
    ds_write_b128 v88, v[120:123] offset:33792
    v_subrev_u32 v88, s100, v3
    ds_write_b128 v88, v[108:111] offset:0
    v_subrev_u32 v88, s100, v3
    ds_write_b128 v88, v[112:115] offset:1024
    s_cmp_eq_u32 s56, 0
    s_cbranch_scc1 L2_e2
    s_mov_b64 exec, 0xffff
    buffer_load_dword v88, v7, s[60:63], 0 offen sc1
    s_mov_b64 exec, -1
    s_waitcnt vmcnt(0)
    v_cmp_gt_u32 vcc, 2, v88
    s_and_b32 s56, vcc_lo, 0xffff
    s_cbranch_scc0 L2_e2
    s_mul_i32 s3, s33, 1280000
    s_add_u32 s3, s3, s100
    s_add_u32 s3, s3, 352768
    buffer_load_dwordx4 v[124:127], v94, s[24:27], s3 offen offset:2048
    s_mul_i32 s3, s33, 1280000
    s_add_u32 s3, s3, s100
    s_add_u32 s3, s3, 352768
    buffer_load_dwordx4 v[116:119], v94, s[24:27], s3 offen offset:0
    s_mul_i32 s3, s33, 1280000
    s_add_u32 s3, s3, s100
    s_add_u32 s3, s3, 352768
    buffer_load_dwordx4 v[120:123], v94, s[24:27], s3 offen offset:1024
    s_mul_i32 s3, s33, 1280000
    s_add_u32 s3, s3, s38
    s_add_u32 s3, s3, 320000
    buffer_load_dwordx4 v[108:111], v94, s[24:27], s3 offen offset:0
    s_mul_i32 s3, s33, 1280000
    s_add_u32 s3, s3, s38
    s_add_u32 s3, s3, 320000
    buffer_load_dwordx4 v[112:115], v94, s[24:27], s3 offen offset:1024
    s_mov_b64 exec, 0xffff
L2_p2:
    buffer_load_dword v88, v7, s[60:63], 0 offen sc1
    s_waitcnt vmcnt(0)
    v_cmp_gt_u32 vcc, 2, v88
    s_cbranch_vccnz L2_p2s
    s_mov_b64 exec, -1
L2_e2:
    s_mov_b32 s6, 0xaaaaaaaa
    s_mov_b32 s7, 0xaaaaaaaa
    v_and_b32 v47, 0x0fffffff, v21
    buffer_load_dwordx2 v[16:17], v47, s[8:11], 0 offen
    buffer_load_dwordx3 v[18:20], v47, s[8:11], 0 offen offset:8
    s_waitcnt lgkmcnt(0)
    s_barrier
    s_bitcmp1_b32 s36, s42
    s_cbranch_scc1 L2_slow
L2_ret0:
    s_setprio 3
    v_and_b32 v47, 0x0fffffff, v27
    buffer_load_dwordx2 v[22:23], v47, s[8:11], 0 offen
    buffer_load_dwordx3 v[24:26], v47, s[8:11], 0 offen offset:8
    s_waitcnt vmcnt(2)
    v_and_b32 v46, 0x20000000, v21
    v_lshrrev_b32 v47, 14, v17
    v_bitop3_b32 v47, v47, v5, v46 bitop3:0xea
    ds_read_b64 v[102:103], v47
    v_bitop3_b32 v93, v17, v5, v46 bitop3:0xea
    v_and_b32 v46, 0x10000000, v21
    v_lshrrev_b32 v47, 14, v16
    v_bitop3_b32 v47, v47, v5, v46 bitop3:0xea
    ds_read_b64 v[100:101], v47
    v_bitop3_b32 v92, v16, v5, v46 bitop3:0xea
    v_perm_b32 v15, v17, v20, s45
    v_bitop3_b32 v46, v17, 0.5, -0.5 bitop3:0xa8
    v_perm_b32 v14, v16, v20, s44
    v_bitop3_b32 v47, v16, 0.5, -0.5 bitop3:0xa8
    s_waitcnt lgkmcnt(0)
    v_mfma_f32_4x4x4_16b_bf16 v[80:83], v[8:9], v[102:103], 0
    v_mfma_f32_4x4x4_16b_bf16 v[76:79], v[8:9], v[100:101], 0
    v_bitop3_b32 v15, v6, v15, v46 bitop3:0xca
    v_bitop3_b32 v14, v6, v14, v47 bitop3:0xca
    v_cmp_lt_u32 s[84:85], v5, v92
    s_nop 0
    v_pk_mul_f32 v[80:81], v[80:81], v[14:15] op_sel:[0,1] op_sel_hi:[1,1]
    v_pk_mul_f32 v[82:83], v[82:83], v[14:15] op_sel:[0,1] op_sel_hi:[1,1]
    v_pk_mul_f32 v[76:77], v[76:77], v[14:15] op_sel:[0,0] op_sel_hi:[1,0]
    v_pk_mul_f32 v[78:79], v[78:79], v[14:15] op_sel:[0,0] op_sel_hi:[1,0]
    v_and_b32 v47, 0x0fffffff, v33
    buffer_load_dwordx2 v[28:29], v47, s[8:11], 0 offen
    buffer_load_dwordx3 v[30:32], v47, s[8:11], 0 offen offset:8
    v_cmp_ne_u64 s[50:51], v[72:73], v[68:69]
    v_cmpx_ne_u64 s[54:55], v[74:75], v[70:71]
    s_and_b64 s[82:83], s[54:55], s[80:81]
    s_cbranch_scc1 L2_c7
L2_d7:
    v_mov_b64 v[84:85], v[70:71]
    v_mov_b32 v7, v95
    v_mov_b64 v[86:87], v[74:75]
    s_or_b64 s[80:81], s[80:81], s[54:55]
    s_mov_b64 exec, s[50:51]
    s_and_b64 s[82:83], s[50:51], s[80:81]
    s_cbranch_scc1 L2_c8
L2_d8:
    v_mov_b64 v[84:85], v[68:69]
    v_mov_b32 v7, v94
    v_mov_b64 v[86:87], v[72:73]
    s_mov_b64 exec, -1
    s_or_b64 s[80:81], s[80:81], s[50:51]
    ds_read_b64 v[70:71], v93 offset:65408
    s_and_b64 exec, s[84:85], s[80:81]
    v_mfma_f32_4x4x4_16b_bf16 v[76:79], v[12:13], v[84:85], 0
    v_mov_b32 v92, v7
    s_andn2_b64 s[80:81], s[80:81], s[84:85]
    v_mfma_f32_4x4x4_16b_bf16 v[76:79], v[10:11], v[86:87], v[76:79]
    s_mov_b64 exec, -1
    ds_read_b64 v[68:69], v92 offset:65408
    v_and_b32 v46, 0x80000000, v21
    v_lshrrev_b32 v47, 14, v19
    v_bitop3_b32 v47, v47, v5, v46 bitop3:0xea
    ds_read_b64 v[106:107], v47
    v_bitop3_b32 v95, v19, v5, v46 bitop3:0xea
    v_and_b32 v46, 0x40000000, v21
    v_lshrrev_b32 v47, 14, v18
    v_bitop3_b32 v47, v47, v5, v46 bitop3:0xea
    ds_read_b64 v[104:105], v47
    v_bitop3_b32 v94, v18, v5, v46 bitop3:0xea
    s_waitcnt lgkmcnt(2)
    v_mfma_f32_4x4x4_16b_bf16 v[80:83], v[10:11], v[70:71], v[80:83]
    v_mfma_f32_4x4x4_16b_bf16 v[76:79], v[10:11], v[68:69], v[76:79]
    v_perm_b32 v15, v19, v20, s47
    v_bitop3_b32 v46, v19, 0.5, -0.5 bitop3:0xa8
    v_perm_b32 v14, v18, v20, s46
    v_bitop3_b32 v47, v18, 0.5, -0.5 bitop3:0xa8
    v_cvt_pk_bf16_f32 v80, v80, v81
    v_cvt_pk_bf16_f32 v81, v82, v83
    ds_wrxchg_rtn_b64 v[74:75], v93, v[80:81] offset:65408
    v_cvt_pk_bf16_f32 v76, v76, v77
    v_cvt_pk_bf16_f32 v77, v78, v79
    ds_wrxchg_rtn_b64 v[72:73], v92, v[76:77] offset:65408
    s_setprio 2
    s_waitcnt lgkmcnt(2)
    v_mfma_f32_4x4x4_16b_bf16 v[80:83], v[8:9], v[106:107], 0
    v_mfma_f32_4x4x4_16b_bf16 v[76:79], v[8:9], v[104:105], 0
    v_bitop3_b32 v15, v6, v15, v46 bitop3:0xca
    v_bitop3_b32 v14, v6, v14, v47 bitop3:0xca
    s_nop 1
    v_pk_mul_f32 v[80:81], v[80:81], v[14:15] op_sel:[0,1] op_sel_hi:[1,1]
    v_pk_mul_f32 v[82:83], v[82:83], v[14:15] op_sel:[0,1] op_sel_hi:[1,1]
    v_pk_mul_f32 v[76:77], v[76:77], v[14:15] op_sel:[0,0] op_sel_hi:[1,0]
    v_pk_mul_f32 v[78:79], v[78:79], v[14:15] op_sel:[0,0] op_sel_hi:[1,0]
    v_sub_u16 v88, v60, v52
    v_and_b32 v89, 3, v52
    v_add3_u32 v99, v88, v89, 3
    v_and_b32 v99, -4, v99
    v_max_u32 v99, 4, v99
    v_and_b32 v97, 0xfffc, v52
    v_bfm_b32 v96, v88, v89
    v_add_u32_dpp v91, v99, v99 row_shr:1 row_mask:0xf bank_mask:0xf bound_ctrl:1
    v_mad_u32_u24 v97, v97, 5, v2
    v_cmp_lt_u32 vcc, 16, v99
    v_add_u32_dpp v91, v91, v91 row_shr:2 row_mask:0xf bank_mask:0xf bound_ctrl:1
    v_sub_u32 v98, s38, v99
    v_lshrrev_b64 v[52:53], 16, v[52:53]
    v_add_u32_dpp v91, v91, v91 row_shr:4 row_mask:0xf bank_mask:0xf bound_ctrl:1
    v_lshrrev_b64 v[60:61], 16, v[60:61]
    s_mov_b32 s101, 0
    v_add_u32_dpp v91, v91, v91 row_shr:8 row_mask:0xf bank_mask:0xf bound_ctrl:1
    s_nop 1
    v_add_u32_dpp v91, v91, v91 row_bcast:15 row_mask:0xa bank_mask:0xf
    s_nop 1
    v_add_u32_dpp v91, v91, v91 row_bcast:31 row_mask:0xc bank_mask:0xf
    v_add_u32 v98, v98, v91
    v_readlane_b32 s37, v91, 63
    s_cbranch_vccnz L2_xo9
L2_xp9:
    v_and_b32 v47, 0x3f0, v3
    s_cmp_lg_u32 s56, 0
    s_cbranch_scc1 L2_m10
    s_mul_i32 s3, s33, 1280000
    s_add_u32 s3, s3, s100
    s_add_u32 s3, s3, 352768
    buffer_load_dwordx4 v[124:127], v47, s[24:27], s3 offen offset:2048
L2_m10:
    v_and_b32 v47, 0x3f0, v3
    s_cmp_lg_u32 s56, 0
    s_cbranch_scc1 L2_m11
    s_mul_i32 s3, s33, 1280000
    s_add_u32 s3, s3, s100
    s_add_u32 s3, s3, 352768
    buffer_load_dwordx4 v[116:119], v47, s[24:27], s3 offen offset:0
L2_m11:
    s_waitcnt lgkmcnt(0)
    v_cmp_ne_u64 s[50:51], v[72:73], v[68:69]
    v_cmpx_ne_u64 s[54:55], v[74:75], v[70:71]
    s_and_b64 s[82:83], s[54:55], s[80:81]
    s_cbranch_scc1 L2_c12
L2_d12:
    v_mov_b64 v[84:85], v[70:71]
    v_mov_b32 v7, v93
    v_mov_b64 v[86:87], v[74:75]
    s_or_b64 s[80:81], s[80:81], s[54:55]
    s_mov_b64 exec, s[50:51]
    s_and_b64 s[82:83], s[50:51], s[80:81]
    s_cbranch_scc1 L2_c13
L2_d13:
    v_mov_b64 v[84:85], v[68:69]
    v_mov_b32 v7, v92
    v_mov_b64 v[86:87], v[72:73]
    s_mov_b64 exec, -1
    s_or_b64 s[80:81], s[80:81], s[50:51]
    ds_read_b64 v[70:71], v95 offset:65408
    ds_read_b64 v[68:69], v94 offset:65408
    s_waitcnt vmcnt(2)
    v_and_b32 v46, 0x20000000, v27
    v_lshrrev_b32 v47, 14, v23
    v_bitop3_b32 v47, v47, v5, v46 bitop3:0xea
    ds_read_b64 v[102:103], v47
    v_bitop3_b32 v93, v23, v5, v46 bitop3:0xea
    v_and_b32 v46, 0x10000000, v27
    v_lshrrev_b32 v47, 14, v22
    v_bitop3_b32 v47, v47, v5, v46 bitop3:0xea
    ds_read_b64 v[100:101], v47
    v_bitop3_b32 v92, v22, v5, v46 bitop3:0xea
    s_waitcnt lgkmcnt(2)
    v_mfma_f32_4x4x4_16b_bf16 v[80:83], v[10:11], v[70:71], v[80:83]
    v_mfma_f32_4x4x4_16b_bf16 v[76:79], v[10:11], v[68:69], v[76:79]
    v_perm_b32 v15, v23, v26, s45
    v_bitop3_b32 v46, v23, 0.5, -0.5 bitop3:0xa8
    v_perm_b32 v14, v22, v26, s44
    v_bitop3_b32 v47, v22, 0.5, -0.5 bitop3:0xa8
    v_cvt_pk_bf16_f32 v80, v80, v81
    v_cvt_pk_bf16_f32 v81, v82, v83
    ds_wrxchg_rtn_b64 v[74:75], v95, v[80:81] offset:65408
    v_cvt_pk_bf16_f32 v76, v76, v77
    v_cvt_pk_bf16_f32 v77, v78, v79
    ds_wrxchg_rtn_b64 v[72:73], v94, v[76:77] offset:65408
    s_waitcnt lgkmcnt(2)
    v_mfma_f32_4x4x4_16b_bf16 v[80:83], v[8:9], v[102:103], 0
    v_mfma_f32_4x4x4_16b_bf16 v[76:79], v[8:9], v[100:101], 0
    v_bitop3_b32 v15, v6, v15, v46 bitop3:0xca
    v_bitop3_b32 v14, v6, v14, v47 bitop3:0xca
    v_cmp_lt_u32 s[84:85], v5, v92
    s_nop 0
    v_pk_mul_f32 v[80:81], v[80:81], v[14:15] op_sel:[0,1] op_sel_hi:[1,1]
    v_pk_mul_f32 v[82:83], v[82:83], v[14:15] op_sel:[0,1] op_sel_hi:[1,1]
    v_pk_mul_f32 v[76:77], v[76:77], v[14:15] op_sel:[0,0] op_sel_hi:[1,0]
    v_pk_mul_f32 v[78:79], v[78:79], v[14:15] op_sel:[0,0] op_sel_hi:[1,0]
    v_and_b32 v47, 0x0fffffff, v39
    buffer_load_dwordx2 v[34:35], v47, s[8:11], 0 offen
    buffer_load_dwordx3 v[36:38], v47, s[8:11], 0 offen offset:8
    v_and_b32 v47, 0x3f0, v3
    s_cmp_lg_u32 s56, 0
    s_cbranch_scc1 L2_m14
    s_mul_i32 s3, s33, 1280000
    s_add_u32 s3, s3, s100
    s_add_u32 s3, s3, 352768
    buffer_load_dwordx4 v[120:123], v47, s[24:27], s3 offen offset:1024
L2_m14:
    s_waitcnt lgkmcnt(0)
    v_cmp_ne_u64 s[50:51], v[72:73], v[68:69]
    v_cmpx_ne_u64 s[54:55], v[74:75], v[70:71]
    s_and_b64 s[82:83], s[54:55], s[80:81]
    s_cbranch_scc1 L2_c15
L2_d15:
    v_mov_b64 v[84:85], v[70:71]
    v_mov_b32 v7, v95
    v_mov_b64 v[86:87], v[74:75]
    s_or_b64 s[80:81], s[80:81], s[54:55]
    s_mov_b64 exec, s[50:51]
    s_and_b64 s[82:83], s[50:51], s[80:81]
    s_cbranch_scc1 L2_c16
L2_d16:
    v_mov_b64 v[84:85], v[68:69]
    v_mov_b32 v7, v94
    v_mov_b64 v[86:87], v[72:73]
    s_mov_b64 exec, -1
    s_or_b64 s[80:81], s[80:81], s[50:51]
    ds_read_b64 v[70:71], v93 offset:65408
    s_and_b64 exec, s[84:85], s[80:81]
    v_mfma_f32_4x4x4_16b_bf16 v[76:79], v[12:13], v[84:85], 0
    v_mov_b32 v92, v7
    s_andn2_b64 s[80:81], s[80:81], s[84:85]
    v_mfma_f32_4x4x4_16b_bf16 v[76:79], v[10:11], v[86:87], v[76:79]
    s_mov_b64 exec, -1
    ds_read_b64 v[68:69], v92 offset:65408
    v_and_b32 v46, 0x80000000, v27
    v_lshrrev_b32 v47, 14, v25
    v_bitop3_b32 v47, v47, v5, v46 bitop3:0xea
    ds_read_b64 v[106:107], v47
    v_bitop3_b32 v95, v25, v5, v46 bitop3:0xea
    v_and_b32 v46, 0x40000000, v27
    v_lshrrev_b32 v47, 14, v24
    v_bitop3_b32 v47, v47, v5, v46 bitop3:0xea
    ds_read_b64 v[104:105], v47
    v_bitop3_b32 v94, v24, v5, v46 bitop3:0xea
    s_waitcnt lgkmcnt(2)
    v_mfma_f32_4x4x4_16b_bf16 v[80:83], v[10:11], v[70:71], v[80:83]
    v_mfma_f32_4x4x4_16b_bf16 v[76:79], v[10:11], v[68:69], v[76:79]
    v_perm_b32 v15, v25, v26, s47
    v_bitop3_b32 v46, v25, 0.5, -0.5 bitop3:0xa8
    v_perm_b32 v14, v24, v26, s46
    v_bitop3_b32 v47, v24, 0.5, -0.5 bitop3:0xa8
    v_cvt_pk_bf16_f32 v80, v80, v81
    v_cvt_pk_bf16_f32 v81, v82, v83
    ds_wrxchg_rtn_b64 v[74:75], v93, v[80:81] offset:65408
    v_cvt_pk_bf16_f32 v76, v76, v77
    v_cvt_pk_bf16_f32 v77, v78, v79
    ds_wrxchg_rtn_b64 v[72:73], v92, v[76:77] offset:65408
    s_setprio 1
    s_waitcnt lgkmcnt(2)
    v_mfma_f32_4x4x4_16b_bf16 v[80:83], v[8:9], v[106:107], 0
    v_mfma_f32_4x4x4_16b_bf16 v[76:79], v[8:9], v[104:105], 0
    v_bitop3_b32 v15, v6, v15, v46 bitop3:0xca
    v_bitop3_b32 v14, v6, v14, v47 bitop3:0xca
    s_nop 1
    v_pk_mul_f32 v[80:81], v[80:81], v[14:15] op_sel:[0,1] op_sel_hi:[1,1]
    v_pk_mul_f32 v[82:83], v[82:83], v[14:15] op_sel:[0,1] op_sel_hi:[1,1]
    v_pk_mul_f32 v[76:77], v[76:77], v[14:15] op_sel:[0,0] op_sel_hi:[1,0]
    v_pk_mul_f32 v[78:79], v[78:79], v[14:15] op_sel:[0,0] op_sel_hi:[1,0]
    v_and_b32 v47, 0x3f0, v3
    s_cmp_lg_u32 s56, 0
    s_cbranch_scc1 L2_m17
    s_mul_i32 s3, s33, 1280000
    s_add_u32 s3, s3, s38
    s_add_u32 s3, s3, 320000
    buffer_load_dwordx4 v[108:111], v47, s[24:27], s3 offen offset:0
L2_m17:
    v_and_b32 v47, 0x3f0, v3
    s_cmp_lg_u32 s56, 0
    s_cbranch_scc1 L2_m18
    s_mul_i32 s3, s33, 1280000
    s_add_u32 s3, s3, s38
    s_add_u32 s3, s3, 320000
    buffer_load_dwordx4 v[112:115], v47, s[24:27], s3 offen offset:1024
L2_m18:
    v_and_b32 v47, 0x0fffffff, v40
    v_mov_b32 v21, v40
    buffer_load_dwordx2 v[16:17], v47, s[8:11], 0 offen
    buffer_load_dwordx3 v[18:20], v47, s[8:11], 0 offen offset:8
    s_waitcnt lgkmcnt(0)
    v_cmp_ne_u64 s[50:51], v[72:73], v[68:69]
    v_cmpx_ne_u64 s[54:55], v[74:75], v[70:71]
    s_and_b64 s[82:83], s[54:55], s[80:81]
    s_cbranch_scc1 L2_c19
L2_d19:
    v_mov_b64 v[84:85], v[70:71]
    v_mov_b32 v7, v93
    v_mov_b64 v[86:87], v[74:75]
    s_or_b64 s[80:81], s[80:81], s[54:55]
    s_mov_b64 exec, s[50:51]
    s_and_b64 s[82:83], s[50:51], s[80:81]
    s_cbranch_scc1 L2_c20
L2_d20:
    v_mov_b64 v[84:85], v[68:69]
    v_mov_b32 v7, v92
    v_mov_b64 v[86:87], v[72:73]
    s_mov_b64 exec, -1
    s_or_b64 s[80:81], s[80:81], s[50:51]
    ds_read_b64 v[70:71], v95 offset:65408
    ds_read_b64 v[68:69], v94 offset:65408
    s_waitcnt vmcnt(4)
    v_and_b32 v46, 0x20000000, v33
    v_lshrrev_b32 v47, 14, v29
    v_bitop3_b32 v47, v47, v5, v46 bitop3:0xea
    ds_read_b64 v[102:103], v47
    v_bitop3_b32 v93, v29, v5, v46 bitop3:0xea
    v_and_b32 v46, 0x10000000, v33
    v_lshrrev_b32 v47, 14, v28
    v_bitop3_b32 v47, v47, v5, v46 bitop3:0xea
    ds_read_b64 v[100:101], v47
    v_bitop3_b32 v92, v28, v5, v46 bitop3:0xea
    s_waitcnt lgkmcnt(2)
    v_mfma_f32_4x4x4_16b_bf16 v[80:83], v[10:11], v[70:71], v[80:83]
    v_mfma_f32_4x4x4_16b_bf16 v[76:79], v[10:11], v[68:69], v[76:79]
    v_perm_b32 v15, v29, v32, s45
    v_bitop3_b32 v46, v29, 0.5, -0.5 bitop3:0xa8
    v_perm_b32 v14, v28, v32, s44
    v_bitop3_b32 v47, v28, 0.5, -0.5 bitop3:0xa8
    v_cvt_pk_bf16_f32 v80, v80, v81
    v_cvt_pk_bf16_f32 v81, v82, v83
    ds_wrxchg_rtn_b64 v[74:75], v95, v[80:81] offset:65408
    v_cvt_pk_bf16_f32 v76, v76, v77
    v_cvt_pk_bf16_f32 v77, v78, v79
    ds_wrxchg_rtn_b64 v[72:73], v94, v[76:77] offset:65408
    s_waitcnt lgkmcnt(2)
    v_mfma_f32_4x4x4_16b_bf16 v[80:83], v[8:9], v[102:103], 0
    v_mfma_f32_4x4x4_16b_bf16 v[76:79], v[8:9], v[100:101], 0
    v_bitop3_b32 v15, v6, v15, v46 bitop3:0xca
    v_bitop3_b32 v14, v6, v14, v47 bitop3:0xca
    v_cmp_lt_u32 s[84:85], v5, v92
    s_nop 0
    v_pk_mul_f32 v[80:81], v[80:81], v[14:15] op_sel:[0,1] op_sel_hi:[1,1]
    v_pk_mul_f32 v[82:83], v[82:83], v[14:15] op_sel:[0,1] op_sel_hi:[1,1]
    v_pk_mul_f32 v[76:77], v[76:77], v[14:15] op_sel:[0,0] op_sel_hi:[1,0]
    v_pk_mul_f32 v[78:79], v[78:79], v[14:15] op_sel:[0,0] op_sel_hi:[1,0]
    s_waitcnt lgkmcnt(0)
    v_cmp_ne_u64 s[50:51], v[72:73], v[68:69]
    v_cmpx_ne_u64 s[54:55], v[74:75], v[70:71]
    s_and_b64 s[82:83], s[54:55], s[80:81]
    s_cbranch_scc1 L2_c21
L2_d21:
    v_mov_b64 v[84:85], v[70:71]
    v_mov_b32 v7, v95
    v_mov_b64 v[86:87], v[74:75]
    s_or_b64 s[80:81], s[80:81], s[54:55]
    s_mov_b64 exec, s[50:51]
    s_and_b64 s[82:83], s[50:51], s[80:81]
    s_cbranch_scc1 L2_c22
L2_d22:
    v_mov_b64 v[84:85], v[68:69]
    v_mov_b32 v7, v94
    v_mov_b64 v[86:87], v[72:73]
    s_mov_b64 exec, -1
    s_or_b64 s[80:81], s[80:81], s[50:51]
    ds_read_b64 v[70:71], v93 offset:65408
    s_and_b64 exec, s[84:85], s[80:81]
    v_mfma_f32_4x4x4_16b_bf16 v[76:79], v[12:13], v[84:85], 0
    v_mov_b32 v92, v7
    s_andn2_b64 s[80:81], s[80:81], s[84:85]
    v_mfma_f32_4x4x4_16b_bf16 v[76:79], v[10:11], v[86:87], v[76:79]
    s_mov_b64 exec, -1
    ds_read_b64 v[68:69], v92 offset:65408
    v_and_b32 v46, 0x80000000, v33
    v_lshrrev_b32 v47, 14, v31
    v_bitop3_b32 v47, v47, v5, v46 bitop3:0xea
    ds_read_b64 v[106:107], v47
    v_bitop3_b32 v95, v31, v5, v46 bitop3:0xea
    v_and_b32 v46, 0x40000000, v33
    v_lshrrev_b32 v47, 14, v30
    v_bitop3_b32 v47, v47, v5, v46 bitop3:0xea
    ds_read_b64 v[104:105], v47
    v_bitop3_b32 v94, v30, v5, v46 bitop3:0xea
    s_waitcnt lgkmcnt(2)
    v_mfma_f32_4x4x4_16b_bf16 v[80:83], v[10:11], v[70:71], v[80:83]
    v_mfma_f32_4x4x4_16b_bf16 v[76:79], v[10:11], v[68:69], v[76:79]
    v_perm_b32 v15, v31, v32, s47
    v_bitop3_b32 v46, v31, 0.5, -0.5 bitop3:0xa8
    v_perm_b32 v14, v30, v32, s46
    v_bitop3_b32 v47, v30, 0.5, -0.5 bitop3:0xa8
    v_cvt_pk_bf16_f32 v80, v80, v81
    v_cvt_pk_bf16_f32 v81, v82, v83
    ds_wrxchg_rtn_b64 v[74:75], v93, v[80:81] offset:65408
    v_cvt_pk_bf16_f32 v76, v76, v77
    v_cvt_pk_bf16_f32 v77, v78, v79
    ds_wrxchg_rtn_b64 v[72:73], v92, v[76:77] offset:65408
    s_setprio 0
    s_waitcnt lgkmcnt(2)
    v_mfma_f32_4x4x4_16b_bf16 v[80:83], v[8:9], v[106:107], 0
    v_mfma_f32_4x4x4_16b_bf16 v[76:79], v[8:9], v[104:105], 0
    v_bitop3_b32 v15, v6, v15, v46 bitop3:0xca
    v_bitop3_b32 v14, v6, v14, v47 bitop3:0xca
    s_nop 1
    v_pk_mul_f32 v[80:81], v[80:81], v[14:15] op_sel:[0,1] op_sel_hi:[1,1]
    v_pk_mul_f32 v[82:83], v[82:83], v[14:15] op_sel:[0,1] op_sel_hi:[1,1]
    v_pk_mul_f32 v[76:77], v[76:77], v[14:15] op_sel:[0,0] op_sel_hi:[1,0]
    v_pk_mul_f32 v[78:79], v[78:79], v[14:15] op_sel:[0,0] op_sel_hi:[1,0]
    s_add_u32 s40, s40, 0x50000
    v_and_b32 v47, 0x0fffffff, v41
    v_mov_b32 v27, v41
    buffer_load_dwordx2 v[22:23], v47, s[8:11], 0 offen
    buffer_load_dwordx3 v[24:26], v47, s[8:11], 0 offen offset:8
    s_waitcnt lgkmcnt(0)
    v_cmp_ne_u64 s[50:51], v[72:73], v[68:69]
    v_cmpx_ne_u64 s[54:55], v[74:75], v[70:71]
    s_and_b64 s[82:83], s[54:55], s[80:81]
    s_cbranch_scc1 L2_c23
L2_d23:
    v_mov_b64 v[84:85], v[70:71]
    v_mov_b32 v7, v93
    v_mov_b64 v[86:87], v[74:75]
    s_or_b64 s[80:81], s[80:81], s[54:55]
    s_mov_b64 exec, s[50:51]
    s_and_b64 s[82:83], s[50:51], s[80:81]
    s_cbranch_scc1 L2_c24
L2_d24:
    v_mov_b64 v[84:85], v[68:69]
    v_mov_b32 v7, v92
    v_mov_b64 v[86:87], v[72:73]
    s_mov_b64 exec, -1
    s_or_b64 s[80:81], s[80:81], s[50:51]
    ds_read_b64 v[70:71], v95 offset:65408
    ds_read_b64 v[68:69], v94 offset:65408
    s_waitcnt vmcnt(4)
    v_and_b32 v46, 0x20000000, v39
    v_lshrrev_b32 v47, 14, v35
    v_bitop3_b32 v47, v47, v5, v46 bitop3:0xea
    ds_read_b64 v[102:103], v47
    v_bitop3_b32 v93, v35, v5, v46 bitop3:0xea
    v_and_b32 v46, 0x10000000, v39
    v_lshrrev_b32 v47, 14, v34
    v_bitop3_b32 v47, v47, v5, v46 bitop3:0xea
    ds_read_b64 v[100:101], v47
    v_bitop3_b32 v92, v34, v5, v46 bitop3:0xea
    v_and_b32 v46, 0x80000000, v39
    v_lshrrev_b32 v47, 14, v37
    v_bitop3_b32 v47, v47, v5, v46 bitop3:0xea
    ds_read_b64 v[106:107], v47
    v_and_b32 v46, 0x40000000, v39
    v_lshrrev_b32 v47, 14, v36
    v_bitop3_b32 v47, v47, v5, v46 bitop3:0xea
    ds_read_b64 v[104:105], v47
    s_waitcnt lgkmcnt(4)
    v_mfma_f32_4x4x4_16b_bf16 v[80:83], v[10:11], v[70:71], v[80:83]
    v_mfma_f32_4x4x4_16b_bf16 v[76:79], v[10:11], v[68:69], v[76:79]
    v_perm_b32 v15, v35, v38, s45
    v_bitop3_b32 v46, v35, 0.5, -0.5 bitop3:0xa8
    v_perm_b32 v14, v34, v38, s44
    v_bitop3_b32 v47, v34, 0.5, -0.5 bitop3:0xa8
    v_cvt_pk_bf16_f32 v80, v80, v81
    v_cvt_pk_bf16_f32 v81, v82, v83
    ds_wrxchg_rtn_b64 v[74:75], v95, v[80:81] offset:65408
    v_cvt_pk_bf16_f32 v76, v76, v77
    v_cvt_pk_bf16_f32 v77, v78, v79
    ds_wrxchg_rtn_b64 v[72:73], v94, v[76:77] offset:65408
    s_waitcnt lgkmcnt(2)
    s_barrier
    s_setprio 3
    s_waitcnt vmcnt(6)
    v_subrev_u32 v88, s38, v3
    ds_write_b128 v88, v[116:119] offset:32768
    buffer_load_dwordx4 v[116:119], v3, s[16:19], s40 offen offset:2048
    s_waitcnt vmcnt(5)
    v_subrev_u32 v88, s38, v3
    ds_write_b128 v88, v[120:123] offset:33792
    buffer_load_dwordx4 v[120:123], v3, s[16:19], s40 offen offset:3072
    v_mfma_f32_4x4x4_16b_bf16 v[80:83], v[8:9], v[102:103], 0
    v_mfma_f32_4x4x4_16b_bf16 v[76:79], v[8:9], v[100:101], 0
    v_bitop3_b32 v15, v6, v15, v46 bitop3:0xca
    v_bitop3_b32 v14, v6, v14, v47 bitop3:0xca
    v_cmp_lt_u32 s[84:85], v5, v92
    s_nop 0
    v_pk_mul_f32 v[80:81], v[80:81], v[14:15] op_sel:[0,1] op_sel_hi:[1,1]
    v_pk_mul_f32 v[82:83], v[82:83], v[14:15] op_sel:[0,1] op_sel_hi:[1,1]
    v_pk_mul_f32 v[76:77], v[76:77], v[14:15] op_sel:[0,0] op_sel_hi:[1,0]
    v_pk_mul_f32 v[78:79], v[78:79], v[14:15] op_sel:[0,0] op_sel_hi:[1,0]
    v_and_b32 v47, 0x0fffffff, v42
    v_mov_b32 v33, v42
    buffer_load_dwordx2 v[28:29], v47, s[8:11], 0 offen
    buffer_load_dwordx3 v[30:32], v47, s[8:11], 0 offen offset:8
    v_mov_b32 v44, v43
    s_cmp_gt_u32 s37, 1024
    s_cbranch_scc1 L2_xs25
    s_cmp_lg_u32 s101, 0
    s_cbranch_scc1 L2_xa25
L2_xb25:
    v_lshlrev_b32 v89, 16, v96
    v_add_u32 v90, 60, v97
    v_bitop3_b32 v90, v89, v45, v90 bitop3:0x6a
    ds_write_b32 v98, v90 offset:12
    v_lshlrev_b32 v89, 20, v96
    v_add_u32 v90, 40, v97
    v_bitop3_b32 v90, v89, v45, v90 bitop3:0x6a
    ds_write_b32 v98, v90 offset:8
    v_lshlrev_b32 v89, 24, v96
    v_add_u32 v90, 20, v97
    v_bitop3_b32 v90, v89, v45, v90 bitop3:0x6a
    ds_write_b32 v98, v90 offset:4
    v_lshlrev_b32 v89, 28, v96
    v_bitop3_b32 v90, v89, v45, v97 bitop3:0x6a
    ds_write_b32 v98, v90 offset:0
    v_mov_b32_dpp v91, v64 quad_perm:[1,1,1,1] row_mask:0xf bank_mask:0xf
    v_and_b32 v89, 3, v91
    v_and_b32 v97, 0xfffc, v91
    v_sub_u16_dpp v88, v64, v91 quad_perm:[3,3,3,3] row_mask:0xf bank_mask:0xf
    v_mad_u32_u24 v97, v97, 5, v4
    v_add_u32 v99, v88, v89
    v_bfm_b32 v96, v88, v89
    v_cmp_lt_u32 s[58:59], 16, v99
    v_lshlrev_b32 v89, v1, v96
    v_and_b32 v89, v45, v89
    v_cmp_ne_u32 vcc, 0, v89
    v_xor_b32 v90, v97, v89
    s_add_u32 s3, s37, s38
    v_mbcnt_lo_u32_b32 v98, vcc_lo, 0
    v_mbcnt_hi_u32_b32 v98, vcc_hi, v98
    s_bcnt1_i32_b64 s41, vcc
    v_lshl_add_u32 v98, v98, 2, s3
    s_mov_b64 exec, vcc
    ds_write_b32 v98, v90
    s_mov_b64 exec, -1
    s_lshl2_add_u32 s37, s41, s37
    s_cmp_lg_u64 s[58:59], 0
    s_cbranch_scc1 L2_xe25
L2_xr25:
    v_add_u32 v98, s37, v0
    v_mov_b32 v90, -1
    ds_write_b32 v98, v90
    ds_read2st64_b32 v[40:41], v0 offset0:0 offset1:1
    ds_read2st64_b32 v[42:43], v0 offset0:2 offset1:3
    s_sub_u32 s3, s37, 768
    s_cmp_gt_u32 s3, 256
    s_cbranch_scc1 L2_xf25
L2_xg25:
    s_setprio 2
    s_waitcnt vmcnt(10)
    v_subrev_u32 v88, s38, v3
    ds_write_b128 v88, v[124:127] offset:34816
    s_add_u32 s3, s40, 4096
    buffer_load_dwordx4 v[124:127], v3, s[16:19], s3 offen
    s_waitcnt lgkmcnt(11)
    v_cmp_ne_u64 s[50:51], v[72:73], v[68:69]
    v_cmpx_ne_u64 s[54:55], v[74:75], v[70:71]
    s_and_b64 s[82:83], s[54:55], s[80:81]
    s_cbranch_scc1 L2_c26
L2_d26:
    v_mov_b64 v[84:85], v[70:71]
    v_mov_b32 v7, v95
    v_mov_b64 v[86:87], v[74:75]
    s_or_b64 s[80:81], s[80:81], s[54:55]
    s_mov_b64 exec, s[50:51]
    s_and_b64 s[82:83], s[50:51], s[80:81]
    s_cbranch_scc1 L2_c27
L2_d27:
    v_mov_b64 v[84:85], v[68:69]
    v_mov_b32 v7, v94
    v_mov_b64 v[86:87], v[72:73]
    s_mov_b64 exec, -1
    s_or_b64 s[80:81], s[80:81], s[50:51]
    ds_read_b64 v[70:71], v93 offset:65408
    s_and_b64 exec, s[84:85], s[80:81]
    v_mfma_f32_4x4x4_16b_bf16 v[76:79], v[12:13], v[84:85], 0
    v_mov_b32 v92, v7
    s_andn2_b64 s[80:81], s[80:81], s[84:85]
    v_mfma_f32_4x4x4_16b_bf16 v[76:79], v[10:11], v[86:87], v[76:79]
    s_mov_b64 exec, -1
    ds_read_b64 v[68:69], v92 offset:65408
    s_setprio 1
    s_waitcnt vmcnt(9)
    v_subrev_u32 v88, s100, v3
    ds_write_b128 v88, v[108:111] offset:0
    s_waitcnt lgkmcnt(1)
    v_mfma_f32_4x4x4_16b_bf16 v[80:83], v[10:11], v[70:71], v[80:83]
    v_mfma_f32_4x4x4_16b_bf16 v[76:79], v[10:11], v[68:69], v[76:79]
    v_and_b32 v46, 0x40000000, v39
    v_bitop3_b32 v94, v36, v5, v46 bitop3:0xea
    v_and_b32 v46, 0x80000000, v39
    v_bitop3_b32 v95, v37, v5, v46 bitop3:0xea
    v_perm_b32 v15, v37, v38, s47
    v_bitop3_b32 v46, v37, 0.5, -0.5 bitop3:0xa8
    v_perm_b32 v14, v36, v38, s46
    v_bitop3_b32 v47, v36, 0.5, -0.5 bitop3:0xa8
    v_cvt_pk_bf16_f32 v80, v80, v81
    v_cvt_pk_bf16_f32 v81, v82, v83
    ds_wrxchg_rtn_b64 v[74:75], v93, v[80:81] offset:65408
    v_cvt_pk_bf16_f32 v76, v76, v77
    v_cvt_pk_bf16_f32 v77, v78, v79
    ds_wrxchg_rtn_b64 v[72:73], v92, v[76:77] offset:65408
    s_setprio 0
    s_waitcnt vmcnt(9)
    v_subrev_u32 v88, s100, v3
    ds_write_b128 v88, v[112:115] offset:1024
    v_mfma_f32_4x4x4_16b_bf16 v[80:83], v[8:9], v[106:107], 0
    v_mfma_f32_4x4x4_16b_bf16 v[76:79], v[8:9], v[104:105], 0
    v_bitop3_b32 v15, v6, v15, v46 bitop3:0xca
    v_bitop3_b32 v14, v6, v14, v47 bitop3:0xca
    s_nop 1
    v_pk_mul_f32 v[80:81], v[80:81], v[14:15] op_sel:[0,1] op_sel_hi:[1,1]
    v_pk_mul_f32 v[82:83], v[82:83], v[14:15] op_sel:[0,1] op_sel_hi:[1,1]
    v_pk_mul_f32 v[76:77], v[76:77], v[14:15] op_sel:[0,0] op_sel_hi:[1,0]
    v_pk_mul_f32 v[78:79], v[78:79], v[14:15] op_sel:[0,0] op_sel_hi:[1,0]
    s_add_u32 s42, s42, 1
    s_waitcnt lgkmcnt(0)
    s_add_u32 s24, s30, 0xec45000
    s_addc_u32 s25, s31, 0
    s_mov_b32 s26, 0x100
    s_mov_b32 s27, 0x20000
    s_barrier
    s_bitcmp1_b32 s36, s42
    s_cbranch_scc1 L2_slow
L2_ret1:
    s_setprio 3
    v_and_b32 v47, 0x0fffffff, v44
    v_mov_b32 v39, v44
    buffer_load_dwordx2 v[34:35], v47, s[8:11], 0 offen
    buffer_load_dwordx3 v[36:38], v47, s[8:11], 0 offen offset:8
    buffer_load_dwordx4 v[108:111], v3, s[16:19], s40 offen offset:0
    v_cmp_ne_u64 s[50:51], v[72:73], v[68:69]
    v_cmpx_ne_u64 s[54:55], v[74:75], v[70:71]
    s_and_b64 s[82:83], s[54:55], s[80:81]
    s_cbranch_scc1 L2_c28
L2_d28:
    v_mov_b64 v[84:85], v[70:71]
    v_mov_b32 v7, v93
    v_mov_b64 v[86:87], v[74:75]
    s_or_b64 s[80:81], s[80:81], s[54:55]
    s_mov_b64 exec, s[50:51]
    s_and_b64 s[82:83], s[50:51], s[80:81]
    s_cbranch_scc1 L2_c29
L2_d29:
    v_mov_b64 v[84:85], v[68:69]
    v_mov_b32 v7, v92
    v_mov_b64 v[86:87], v[72:73]
    s_mov_b64 exec, -1
    s_or_b64 s[80:81], s[80:81], s[50:51]
    ds_read_b64 v[70:71], v95 offset:65408
    ds_read_b64 v[68:69], v94 offset:65408
    s_waitcnt vmcnt(10)
    v_and_b32 v46, 0x20000000, v21
    v_lshrrev_b32 v47, 14, v17
    v_bitop3_b32 v47, v47, v5, v46 bitop3:0xea
    ds_read_b64 v[102:103], v47
    v_bitop3_b32 v93, v17, v5, v46 bitop3:0xea
    v_and_b32 v46, 0x10000000, v21
    v_lshrrev_b32 v47, 14, v16
    v_bitop3_b32 v47, v47, v5, v46 bitop3:0xea
    ds_read_b64 v[100:101], v47
    v_bitop3_b32 v92, v16, v5, v46 bitop3:0xea
    s_waitcnt lgkmcnt(2)
    v_mfma_f32_4x4x4_16b_bf16 v[80:83], v[10:11], v[70:71], v[80:83]
    v_mfma_f32_4x4x4_16b_bf16 v[76:79], v[10:11], v[68:69], v[76:79]
    v_perm_b32 v15, v17, v20, s45
    v_bitop3_b32 v46, v17, 0.5, -0.5 bitop3:0xa8
    v_perm_b32 v14, v16, v20, s44
    v_bitop3_b32 v47, v16, 0.5, -0.5 bitop3:0xa8
    v_cvt_pk_bf16_f32 v80, v80, v81
    v_cvt_pk_bf16_f32 v81, v82, v83
    ds_wrxchg_rtn_b64 v[74:75], v95, v[80:81] offset:65408
    v_cvt_pk_bf16_f32 v76, v76, v77
    v_cvt_pk_bf16_f32 v77, v78, v79
    ds_wrxchg_rtn_b64 v[72:73], v94, v[76:77] offset:65408
    s_waitcnt lgkmcnt(2)
    v_mfma_f32_4x4x4_16b_bf16 v[80:83], v[8:9], v[102:103], 0
    v_mfma_f32_4x4x4_16b_bf16 v[76:79], v[8:9], v[100:101], 0
    v_bitop3_b32 v15, v6, v15, v46 bitop3:0xca
    v_bitop3_b32 v14, v6, v14, v47 bitop3:0xca
    v_cmp_lt_u32 s[84:85], v5, v92
    s_nop 0
    v_pk_mul_f32 v[80:81], v[80:81], v[14:15] op_sel:[0,1] op_sel_hi:[1,1]
    v_pk_mul_f32 v[82:83], v[82:83], v[14:15] op_sel:[0,1] op_sel_hi:[1,1]
    v_pk_mul_f32 v[76:77], v[76:77], v[14:15] op_sel:[0,0] op_sel_hi:[1,0]
    v_pk_mul_f32 v[78:79], v[78:79], v[14:15] op_sel:[0,0] op_sel_hi:[1,0]
    buffer_load_dwordx4 v[112:115], v3, s[16:19], s40 offen offset:1024
    s_waitcnt lgkmcnt(0)
    v_cmp_ne_u64 s[50:51], v[72:73], v[68:69]
    v_cmpx_ne_u64 s[54:55], v[74:75], v[70:71]
    s_and_b64 s[82:83], s[54:55], s[80:81]
    s_cbranch_scc1 L2_c30
L2_d30:
    v_mov_b64 v[84:85], v[70:71]
    v_mov_b32 v7, v95
    v_mov_b64 v[86:87], v[74:75]
    s_or_b64 s[80:81], s[80:81], s[54:55]
    s_mov_b64 exec, s[50:51]
    s_and_b64 s[82:83], s[50:51], s[80:81]
    s_cbranch_scc1 L2_c31
L2_d31:
    v_mov_b64 v[84:85], v[68:69]
    v_mov_b32 v7, v94
    v_mov_b64 v[86:87], v[72:73]
    s_mov_b64 exec, -1
    s_or_b64 s[80:81], s[80:81], s[50:51]
    ds_read_b64 v[70:71], v93 offset:65408
    s_and_b64 exec, s[84:85], s[80:81]
    v_mfma_f32_4x4x4_16b_bf16 v[76:79], v[12:13], v[84:85], 0
    v_mov_b32 v92, v7
    s_andn2_b64 s[80:81], s[80:81], s[84:85]
    v_mfma_f32_4x4x4_16b_bf16 v[76:79], v[10:11], v[86:87], v[76:79]
    s_mov_b64 exec, -1
    ds_read_b64 v[68:69], v92 offset:65408
    v_and_b32 v46, 0x80000000, v21
    v_lshrrev_b32 v47, 14, v19
    v_bitop3_b32 v47, v47, v5, v46 bitop3:0xea
    ds_read_b64 v[106:107], v47
    v_bitop3_b32 v95, v19, v5, v46 bitop3:0xea
    v_and_b32 v46, 0x40000000, v21
    v_lshrrev_b32 v47, 14, v18
    v_bitop3_b32 v47, v47, v5, v46 bitop3:0xea
    ds_read_b64 v[104:105], v47
    v_bitop3_b32 v94, v18, v5, v46 bitop3:0xea
    s_waitcnt lgkmcnt(2)
    v_mfma_f32_4x4x4_16b_bf16 v[80:83], v[10:11], v[70:71], v[80:83]
    v_mfma_f32_4x4x4_16b_bf16 v[76:79], v[10:11], v[68:69], v[76:79]
    v_perm_b32 v15, v19, v20, s47
    v_bitop3_b32 v46, v19, 0.5, -0.5 bitop3:0xa8
    v_perm_b32 v14, v18, v20, s46
    v_bitop3_b32 v47, v18, 0.5, -0.5 bitop3:0xa8
    v_cvt_pk_bf16_f32 v80, v80, v81
    v_cvt_pk_bf16_f32 v81, v82, v83
    ds_wrxchg_rtn_b64 v[74:75], v93, v[80:81] offset:65408
    v_cvt_pk_bf16_f32 v76, v76, v77
    v_cvt_pk_bf16_f32 v77, v78, v79
    ds_wrxchg_rtn_b64 v[72:73], v92, v[76:77] offset:65408
    s_setprio 2
    s_waitcnt lgkmcnt(2)
    v_mfma_f32_4x4x4_16b_bf16 v[80:83], v[8:9], v[106:107], 0
    v_mfma_f32_4x4x4_16b_bf16 v[76:79], v[8:9], v[104:105], 0
    v_bitop3_b32 v15, v6, v15, v46 bitop3:0xca
    v_bitop3_b32 v14, v6, v14, v47 bitop3:0xca
    s_nop 1
    v_pk_mul_f32 v[80:81], v[80:81], v[14:15] op_sel:[0,1] op_sel_hi:[1,1]
    v_pk_mul_f32 v[82:83], v[82:83], v[14:15] op_sel:[0,1] op_sel_hi:[1,1]
    v_pk_mul_f32 v[76:77], v[76:77], v[14:15] op_sel:[0,0] op_sel_hi:[1,0]
    v_pk_mul_f32 v[78:79], v[78:79], v[14:15] op_sel:[0,0] op_sel_hi:[1,0]
    v_sub_u16 v88, v62, v54
    v_and_b32 v89, 3, v54
    v_add3_u32 v99, v88, v89, 3
    v_and_b32 v99, -4, v99
    v_max_u32 v99, 4, v99
    v_and_b32 v97, 0xfffc, v54
    v_bfm_b32 v96, v88, v89
    v_add_u32_dpp v91, v99, v99 row_shr:1 row_mask:0xf bank_mask:0xf bound_ctrl:1
    v_mad_u32_u24 v97, v97, 5, v2
    v_cmp_lt_u32 vcc, 16, v99
    v_add_u32_dpp v91, v91, v91 row_shr:2 row_mask:0xf bank_mask:0xf bound_ctrl:1
    v_sub_u32 v98, s38, v99
    v_lshrrev_b64 v[54:55], 16, v[54:55]
    v_add_u32_dpp v91, v91, v91 row_shr:4 row_mask:0xf bank_mask:0xf bound_ctrl:1
    v_lshrrev_b64 v[62:63], 16, v[62:63]
    s_mov_b32 s101, 0
    v_add_u32_dpp v91, v91, v91 row_shr:8 row_mask:0xf bank_mask:0xf bound_ctrl:1
    s_nop 1
    v_add_u32_dpp v91, v91, v91 row_bcast:15 row_mask:0xa bank_mask:0xf
    s_nop 1
    v_add_u32_dpp v91, v91, v91 row_bcast:31 row_mask:0xc bank_mask:0xf
    v_add_u32 v98, v98, v91
    v_readlane_b32 s37, v91, 63
    s_cbranch_vccnz L2_xo32
L2_xp32:
    v_and_b32 v47, 0x0fffffff, v40
    v_mov_b32 v21, v40
    buffer_load_dwordx2 v[16:17], v47, s[8:11], 0 offen
    buffer_load_dwordx3 v[18:20], v47, s[8:11], 0 offen offset:8
    s_waitcnt lgkmcnt(0)
    v_cmp_ne_u64 s[50:51], v[72:73], v[68:69]
    v_cmpx_ne_u64 s[54:55], v[74:75], v[70:71]
    s_and_b64 s[82:83], s[54:55], s[80:81]
    s_cbranch_scc1 L2_c33
L2_d33:
    v_mov_b64 v[84:85], v[70:71]
    v_mov_b32 v7, v93
    v_mov_b64 v[86:87], v[74:75]
    s_or_b64 s[80:81], s[80:81], s[54:55]
    s_mov_b64 exec, s[50:51]
    s_and_b64 s[82:83], s[50:51], s[80:81]
    s_cbranch_scc1 L2_c34
L2_d34:
    v_mov_b64 v[84:85], v[68:69]
    v_mov_b32 v7, v92
    v_mov_b64 v[86:87], v[72:73]
    s_mov_b64 exec, -1
    s_or_b64 s[80:81], s[80:81], s[50:51]
    ds_read_b64 v[70:71], v95 offset:65408
    ds_read_b64 v[68:69], v94 offset:65408
    s_waitcnt vmcnt(11)
    v_and_b32 v46, 0x20000000, v27
    v_lshrrev_b32 v47, 14, v23
    v_bitop3_b32 v47, v47, v5, v46 bitop3:0xea
    ds_read_b64 v[102:103], v47
    v_bitop3_b32 v93, v23, v5, v46 bitop3:0xea
    v_and_b32 v46, 0x10000000, v27
    v_lshrrev_b32 v47, 14, v22
    v_bitop3_b32 v47, v47, v5, v46 bitop3:0xea
    ds_read_b64 v[100:101], v47
    v_bitop3_b32 v92, v22, v5, v46 bitop3:0xea
    s_waitcnt lgkmcnt(2)
    v_mfma_f32_4x4x4_16b_bf16 v[80:83], v[10:11], v[70:71], v[80:83]
    v_mfma_f32_4x4x4_16b_bf16 v[76:79], v[10:11], v[68:69], v[76:79]
    v_perm_b32 v15, v23, v26, s45
    v_bitop3_b32 v46, v23, 0.5, -0.5 bitop3:0xa8
    v_perm_b32 v14, v22, v26, s44
    v_bitop3_b32 v47, v22, 0.5, -0.5 bitop3:0xa8
    v_cvt_pk_bf16_f32 v80, v80, v81
    v_cvt_pk_bf16_f32 v81, v82, v83
    ds_wrxchg_rtn_b64 v[74:75], v95, v[80:81] offset:65408
    v_cvt_pk_bf16_f32 v76, v76, v77
    v_cvt_pk_bf16_f32 v77, v78, v79
    ds_wrxchg_rtn_b64 v[72:73], v94, v[76:77] offset:65408
    s_waitcnt lgkmcnt(2)
    v_mfma_f32_4x4x4_16b_bf16 v[80:83], v[8:9], v[102:103], 0
    v_mfma_f32_4x4x4_16b_bf16 v[76:79], v[8:9], v[100:101], 0
    v_bitop3_b32 v15, v6, v15, v46 bitop3:0xca
    v_bitop3_b32 v14, v6, v14, v47 bitop3:0xca
    v_cmp_lt_u32 s[84:85], v5, v92
    s_nop 0
    v_pk_mul_f32 v[80:81], v[80:81], v[14:15] op_sel:[0,1] op_sel_hi:[1,1]
    v_pk_mul_f32 v[82:83], v[82:83], v[14:15] op_sel:[0,1] op_sel_hi:[1,1]
    v_pk_mul_f32 v[76:77], v[76:77], v[14:15] op_sel:[0,0] op_sel_hi:[1,0]
    v_pk_mul_f32 v[78:79], v[78:79], v[14:15] op_sel:[0,0] op_sel_hi:[1,0]
    s_waitcnt lgkmcnt(0)
    v_cmp_ne_u64 s[50:51], v[72:73], v[68:69]
    v_cmpx_ne_u64 s[54:55], v[74:75], v[70:71]
    s_and_b64 s[82:83], s[54:55], s[80:81]
    s_cbranch_scc1 L2_c35
L2_d35:
    v_mov_b64 v[84:85], v[70:71]
    v_mov_b32 v7, v95
    v_mov_b64 v[86:87], v[74:75]
    s_or_b64 s[80:81], s[80:81], s[54:55]
    s_mov_b64 exec, s[50:51]
    s_and_b64 s[82:83], s[50:51], s[80:81]
    s_cbranch_scc1 L2_c36
L2_d36:
    v_mov_b64 v[84:85], v[68:69]
    v_mov_b32 v7, v94
    v_mov_b64 v[86:87], v[72:73]
    s_mov_b64 exec, -1
    s_or_b64 s[80:81], s[80:81], s[50:51]
    ds_read_b64 v[70:71], v93 offset:65408
    s_and_b64 exec, s[84:85], s[80:81]
    v_mfma_f32_4x4x4_16b_bf16 v[76:79], v[12:13], v[84:85], 0
    v_mov_b32 v92, v7
    s_andn2_b64 s[80:81], s[80:81], s[84:85]
    v_mfma_f32_4x4x4_16b_bf16 v[76:79], v[10:11], v[86:87], v[76:79]
    s_mov_b64 exec, -1
    ds_read_b64 v[68:69], v92 offset:65408
    v_and_b32 v46, 0x80000000, v27
    v_lshrrev_b32 v47, 14, v25
    v_bitop3_b32 v47, v47, v5, v46 bitop3:0xea
    ds_read_b64 v[106:107], v47
    v_bitop3_b32 v95, v25, v5, v46 bitop3:0xea
    v_and_b32 v46, 0x40000000, v27
    v_lshrrev_b32 v47, 14, v24
    v_bitop3_b32 v47, v47, v5, v46 bitop3:0xea
    ds_read_b64 v[104:105], v47
    v_bitop3_b32 v94, v24, v5, v46 bitop3:0xea
    s_waitcnt lgkmcnt(2)
    v_mfma_f32_4x4x4_16b_bf16 v[80:83], v[10:11], v[70:71], v[80:83]
    v_mfma_f32_4x4x4_16b_bf16 v[76:79], v[10:11], v[68:69], v[76:79]
    v_perm_b32 v15, v25, v26, s47
    v_bitop3_b32 v46, v25, 0.5, -0.5 bitop3:0xa8
    v_perm_b32 v14, v24, v26, s46
    v_bitop3_b32 v47, v24, 0.5, -0.5 bitop3:0xa8
    v_cvt_pk_bf16_f32 v80, v80, v81
    v_cvt_pk_bf16_f32 v81, v82, v83
    ds_wrxchg_rtn_b64 v[74:75], v93, v[80:81] offset:65408
    v_cvt_pk_bf16_f32 v76, v76, v77
    v_cvt_pk_bf16_f32 v77, v78, v79
    ds_wrxchg_rtn_b64 v[72:73], v92, v[76:77] offset:65408
    s_setprio 1
    s_waitcnt lgkmcnt(2)
    v_mfma_f32_4x4x4_16b_bf16 v[80:83], v[8:9], v[106:107], 0
    v_mfma_f32_4x4x4_16b_bf16 v[76:79], v[8:9], v[104:105], 0
    v_bitop3_b32 v15, v6, v15, v46 bitop3:0xca
    v_bitop3_b32 v14, v6, v14, v47 bitop3:0xca
    s_nop 1
    v_pk_mul_f32 v[80:81], v[80:81], v[14:15] op_sel:[0,1] op_sel_hi:[1,1]
    v_pk_mul_f32 v[82:83], v[82:83], v[14:15] op_sel:[0,1] op_sel_hi:[1,1]
    v_pk_mul_f32 v[76:77], v[76:77], v[14:15] op_sel:[0,0] op_sel_hi:[1,0]
    v_pk_mul_f32 v[78:79], v[78:79], v[14:15] op_sel:[0,0] op_sel_hi:[1,0]
    v_and_b32 v47, 0x0fffffff, v41
    v_mov_b32 v27, v41
    buffer_load_dwordx2 v[22:23], v47, s[8:11], 0 offen
    buffer_load_dwordx3 v[24:26], v47, s[8:11], 0 offen offset:8
    s_waitcnt lgkmcnt(0)
    v_cmp_ne_u64 s[50:51], v[72:73], v[68:69]
    v_cmpx_ne_u64 s[54:55], v[74:75], v[70:71]
    s_and_b64 s[82:83], s[54:55], s[80:81]
    s_cbranch_scc1 L2_c37
L2_d37:
    v_mov_b64 v[84:85], v[70:71]
    v_mov_b32 v7, v93
    v_mov_b64 v[86:87], v[74:75]
    s_or_b64 s[80:81], s[80:81], s[54:55]
    s_mov_b64 exec, s[50:51]
    s_and_b64 s[82:83], s[50:51], s[80:81]
    s_cbranch_scc1 L2_c38
L2_d38:
    v_mov_b64 v[84:85], v[68:69]
    v_mov_b32 v7, v92
    v_mov_b64 v[86:87], v[72:73]
    s_mov_b64 exec, -1
    s_or_b64 s[80:81], s[80:81], s[50:51]
    ds_read_b64 v[70:71], v95 offset:65408
    ds_read_b64 v[68:69], v94 offset:65408
    s_waitcnt vmcnt(9)
    v_and_b32 v46, 0x20000000, v33
    v_lshrrev_b32 v47, 14, v29
    v_bitop3_b32 v47, v47, v5, v46 bitop3:0xea
    ds_read_b64 v[102:103], v47
    v_bitop3_b32 v93, v29, v5, v46 bitop3:0xea
    v_and_b32 v46, 0x10000000, v33
    v_lshrrev_b32 v47, 14, v28
    v_bitop3_b32 v47, v47, v5, v46 bitop3:0xea
    ds_read_b64 v[100:101], v47
    v_bitop3_b32 v92, v28, v5, v46 bitop3:0xea
    s_waitcnt lgkmcnt(2)
    v_mfma_f32_4x4x4_16b_bf16 v[80:83], v[10:11], v[70:71], v[80:83]
    v_mfma_f32_4x4x4_16b_bf16 v[76:79], v[10:11], v[68:69], v[76:79]
    v_perm_b32 v15, v29, v32, s45
    v_bitop3_b32 v46, v29, 0.5, -0.5 bitop3:0xa8
    v_perm_b32 v14, v28, v32, s44
    v_bitop3_b32 v47, v28, 0.5, -0.5 bitop3:0xa8
    v_cvt_pk_bf16_f32 v80, v80, v81
    v_cvt_pk_bf16_f32 v81, v82, v83
    ds_wrxchg_rtn_b64 v[74:75], v95, v[80:81] offset:65408
    v_cvt_pk_bf16_f32 v76, v76, v77
    v_cvt_pk_bf16_f32 v77, v78, v79
    ds_wrxchg_rtn_b64 v[72:73], v94, v[76:77] offset:65408
    s_waitcnt lgkmcnt(2)
    v_mfma_f32_4x4x4_16b_bf16 v[80:83], v[8:9], v[102:103], 0
    v_mfma_f32_4x4x4_16b_bf16 v[76:79], v[8:9], v[100:101], 0
    v_bitop3_b32 v15, v6, v15, v46 bitop3:0xca
    v_bitop3_b32 v14, v6, v14, v47 bitop3:0xca
    v_cmp_lt_u32 s[84:85], v5, v92
    s_nop 0
    v_pk_mul_f32 v[80:81], v[80:81], v[14:15] op_sel:[0,1] op_sel_hi:[1,1]
    v_pk_mul_f32 v[82:83], v[82:83], v[14:15] op_sel:[0,1] op_sel_hi:[1,1]
    v_pk_mul_f32 v[76:77], v[76:77], v[14:15] op_sel:[0,0] op_sel_hi:[1,0]
    v_pk_mul_f32 v[78:79], v[78:79], v[14:15] op_sel:[0,0] op_sel_hi:[1,0]
    s_waitcnt lgkmcnt(0)
    v_cmp_ne_u64 s[50:51], v[72:73], v[68:69]
    v_cmpx_ne_u64 s[54:55], v[74:75], v[70:71]
    s_and_b64 s[82:83], s[54:55], s[80:81]
    s_cbranch_scc1 L2_c39
L2_d39:
    v_mov_b64 v[84:85], v[70:71]
    v_mov_b32 v7, v95
    v_mov_b64 v[86:87], v[74:75]
    s_or_b64 s[80:81], s[80:81], s[54:55]
    s_mov_b64 exec, s[50:51]
    s_and_b64 s[82:83], s[50:51], s[80:81]
    s_cbranch_scc1 L2_c40
L2_d40:
    v_mov_b64 v[84:85], v[68:69]
    v_mov_b32 v7, v94
    v_mov_b64 v[86:87], v[72:73]
    s_mov_b64 exec, -1
    s_or_b64 s[80:81], s[80:81], s[50:51]
    ds_read_b64 v[70:71], v93 offset:65408
    s_and_b64 exec, s[84:85], s[80:81]
    v_mfma_f32_4x4x4_16b_bf16 v[76:79], v[12:13], v[84:85], 0
    v_mov_b32 v92, v7
    s_andn2_b64 s[80:81], s[80:81], s[84:85]
    v_mfma_f32_4x4x4_16b_bf16 v[76:79], v[10:11], v[86:87], v[76:79]
    s_mov_b64 exec, -1
    ds_read_b64 v[68:69], v92 offset:65408
    v_and_b32 v46, 0x80000000, v33
    v_lshrrev_b32 v47, 14, v31
    v_bitop3_b32 v47, v47, v5, v46 bitop3:0xea
    ds_read_b64 v[106:107], v47
    v_bitop3_b32 v95, v31, v5, v46 bitop3:0xea
    v_and_b32 v46, 0x40000000, v33
    v_lshrrev_b32 v47, 14, v30
    v_bitop3_b32 v47, v47, v5, v46 bitop3:0xea
    ds_read_b64 v[104:105], v47
    v_bitop3_b32 v94, v30, v5, v46 bitop3:0xea
    s_waitcnt lgkmcnt(2)
    v_mfma_f32_4x4x4_16b_bf16 v[80:83], v[10:11], v[70:71], v[80:83]
    v_mfma_f32_4x4x4_16b_bf16 v[76:79], v[10:11], v[68:69], v[76:79]
    v_perm_b32 v15, v31, v32, s47
    v_bitop3_b32 v46, v31, 0.5, -0.5 bitop3:0xa8
    v_perm_b32 v14, v30, v32, s46
    v_bitop3_b32 v47, v30, 0.5, -0.5 bitop3:0xa8
    v_cvt_pk_bf16_f32 v80, v80, v81
    v_cvt_pk_bf16_f32 v81, v82, v83
    ds_wrxchg_rtn_b64 v[74:75], v93, v[80:81] offset:65408
    v_cvt_pk_bf16_f32 v76, v76, v77
    v_cvt_pk_bf16_f32 v77, v78, v79
    ds_wrxchg_rtn_b64 v[72:73], v92, v[76:77] offset:65408
    s_setprio 0
    s_waitcnt lgkmcnt(2)
    v_mfma_f32_4x4x4_16b_bf16 v[80:83], v[8:9], v[106:107], 0
    v_mfma_f32_4x4x4_16b_bf16 v[76:79], v[8:9], v[104:105], 0
    v_bitop3_b32 v15, v6, v15, v46 bitop3:0xca
    v_bitop3_b32 v14, v6, v14, v47 bitop3:0xca
    s_nop 1
    v_pk_mul_f32 v[80:81], v[80:81], v[14:15] op_sel:[0,1] op_sel_hi:[1,1]
    v_pk_mul_f32 v[82:83], v[82:83], v[14:15] op_sel:[0,1] op_sel_hi:[1,1]
    v_pk_mul_f32 v[76:77], v[76:77], v[14:15] op_sel:[0,0] op_sel_hi:[1,0]
    v_pk_mul_f32 v[78:79], v[78:79], v[14:15] op_sel:[0,0] op_sel_hi:[1,0]
    s_add_u32 s40, s40, 0x50000
    v_and_b32 v47, 0x0fffffff, v42
    v_mov_b32 v33, v42
    buffer_load_dwordx2 v[28:29], v47, s[8:11], 0 offen
    buffer_load_dwordx3 v[30:32], v47, s[8:11], 0 offen offset:8
    s_waitcnt lgkmcnt(0)
    v_cmp_ne_u64 s[50:51], v[72:73], v[68:69]
    v_cmpx_ne_u64 s[54:55], v[74:75], v[70:71]
    s_and_b64 s[82:83], s[54:55], s[80:81]
    s_cbranch_scc1 L2_c41
L2_d41:
    v_mov_b64 v[84:85], v[70:71]
    v_mov_b32 v7, v93
    v_mov_b64 v[86:87], v[74:75]
    s_or_b64 s[80:81], s[80:81], s[54:55]
    s_mov_b64 exec, s[50:51]
    s_and_b64 s[82:83], s[50:51], s[80:81]
    s_cbranch_scc1 L2_c42
L2_d42:
    v_mov_b64 v[84:85], v[68:69]
    v_mov_b32 v7, v92
    v_mov_b64 v[86:87], v[72:73]
    s_mov_b64 exec, -1
    s_or_b64 s[80:81], s[80:81], s[50:51]
    ds_read_b64 v[70:71], v95 offset:65408
    ds_read_b64 v[68:69], v94 offset:65408
    s_waitcnt vmcnt(8)
    v_and_b32 v46, 0x20000000, v39
    v_lshrrev_b32 v47, 14, v35
    v_bitop3_b32 v47, v47, v5, v46 bitop3:0xea
    ds_read_b64 v[102:103], v47
    v_bitop3_b32 v93, v35, v5, v46 bitop3:0xea
    v_and_b32 v46, 0x10000000, v39
    v_lshrrev_b32 v47, 14, v34
    v_bitop3_b32 v47, v47, v5, v46 bitop3:0xea
    ds_read_b64 v[100:101], v47
    v_bitop3_b32 v92, v34, v5, v46 bitop3:0xea
    v_and_b32 v46, 0x80000000, v39
    v_lshrrev_b32 v47, 14, v37
    v_bitop3_b32 v47, v47, v5, v46 bitop3:0xea
    ds_read_b64 v[106:107], v47
    v_and_b32 v46, 0x40000000, v39
    v_lshrrev_b32 v47, 14, v36
    v_bitop3_b32 v47, v47, v5, v46 bitop3:0xea
    ds_read_b64 v[104:105], v47
    s_waitcnt lgkmcnt(4)
    v_mfma_f32_4x4x4_16b_bf16 v[80:83], v[10:11], v[70:71], v[80:83]
    v_mfma_f32_4x4x4_16b_bf16 v[76:79], v[10:11], v[68:69], v[76:79]
    v_perm_b32 v15, v35, v38, s45
    v_bitop3_b32 v46, v35, 0.5, -0.5 bitop3:0xa8
    v_perm_b32 v14, v34, v38, s44
    v_bitop3_b32 v47, v34, 0.5, -0.5 bitop3:0xa8
    v_cvt_pk_bf16_f32 v80, v80, v81
    v_cvt_pk_bf16_f32 v81, v82, v83
    ds_wrxchg_rtn_b64 v[74:75], v95, v[80:81] offset:65408
    v_cvt_pk_bf16_f32 v76, v76, v77
    v_cvt_pk_bf16_f32 v77, v78, v79
    ds_wrxchg_rtn_b64 v[72:73], v94, v[76:77] offset:65408
    s_waitcnt lgkmcnt(2)
    s_barrier
    s_setprio 3
    s_mov_b32 m0, s100
    s_nop 0
    ds_write_addtid_b32 v116 offset:32768
    ds_write_addtid_b32 v117 offset:33024
    ds_write_addtid_b32 v118 offset:33280
    ds_write_addtid_b32 v119 offset:33536
    buffer_load_dwordx4 v[116:119], v3, s[16:19], s40 offen offset:2048
    ds_write_addtid_b32 v120 offset:33792
    ds_write_addtid_b32 v121 offset:34048
    ds_write_addtid_b32 v122 offset:34304
    ds_write_addtid_b32 v123 offset:34560
    buffer_load_dwordx4 v[120:123], v3, s[16:19], s40 offen offset:3072
    v_mfma_f32_4x4x4_16b_bf16 v[80:83], v[8:9], v[102:103], 0
    v_mfma_f32_4x4x4_16b_bf16 v[76:79], v[8:9], v[100:101], 0
    v_bitop3_b32 v15, v6, v15, v46 bitop3:0xca
    v_bitop3_b32 v14, v6, v14, v47 bitop3:0xca
    v_cmp_lt_u32 s[84:85], v5, v92
    s_nop 0
    v_pk_mul_f32 v[80:81], v[80:81], v[14:15] op_sel:[0,1] op_sel_hi:[1,1]
    v_pk_mul_f32 v[82:83], v[82:83], v[14:15] op_sel:[0,1] op_sel_hi:[1,1]
    v_pk_mul_f32 v[76:77], v[76:77], v[14:15] op_sel:[0,0] op_sel_hi:[1,0]
    v_pk_mul_f32 v[78:79], v[78:79], v[14:15] op_sel:[0,0] op_sel_hi:[1,0]
    v_mov_b32 v44, v43
    s_cmp_gt_u32 s37, 1024
    s_cbranch_scc1 L2_xs43
    s_cmp_lg_u32 s101, 0
    s_cbranch_scc1 L2_xa43
L2_xb43:
    v_lshlrev_b32 v89, 16, v96
    v_add_u32 v90, 60, v97
    v_bitop3_b32 v90, v89, v45, v90 bitop3:0x6a
    ds_write_b32 v98, v90 offset:12
    v_lshlrev_b32 v89, 20, v96
    v_add_u32 v90, 40, v97
    v_bitop3_b32 v90, v89, v45, v90 bitop3:0x6a
    ds_write_b32 v98, v90 offset:8
    v_lshlrev_b32 v89, 24, v96
    v_add_u32 v90, 20, v97
    v_bitop3_b32 v90, v89, v45, v90 bitop3:0x6a
    ds_write_b32 v98, v90 offset:4
    v_lshlrev_b32 v89, 28, v96
    v_bitop3_b32 v90, v89, v45, v97 bitop3:0x6a
    ds_write_b32 v98, v90 offset:0
    v_mov_b32_dpp v91, v66 quad_perm:[1,1,1,1] row_mask:0xf bank_mask:0xf
    v_and_b32 v89, 3, v91
    v_and_b32 v97, 0xfffc, v91
    v_sub_u16_dpp v88, v66, v91 quad_perm:[3,3,3,3] row_mask:0xf bank_mask:0xf
    v_mad_u32_u24 v97, v97, 5, v4
    v_add_u32 v99, v88, v89
    v_bfm_b32 v96, v88, v89
    v_cmp_lt_u32 s[58:59], 16, v99
    v_lshlrev_b32 v89, v1, v96
    v_and_b32 v89, v45, v89
    v_cmp_ne_u32 vcc, 0, v89
    v_xor_b32 v90, v97, v89
    s_add_u32 s3, s37, s38
    v_mbcnt_lo_u32_b32 v98, vcc_lo, 0
    v_mbcnt_hi_u32_b32 v98, vcc_hi, v98
    s_bcnt1_i32_b64 s41, vcc
    v_lshl_add_u32 v98, v98, 2, s3
    s_mov_b64 exec, vcc
    ds_write_b32 v98, v90
    s_mov_b64 exec, -1
    s_lshl2_add_u32 s37, s41, s37
    s_cmp_lg_u64 s[58:59], 0
    s_cbranch_scc1 L2_xe43
L2_xr43:
    v_add_u32 v98, s37, v0
    v_mov_b32 v90, -1
    ds_write_b32 v98, v90
    ds_read2st64_b32 v[40:41], v0 offset0:0 offset1:1
    ds_read2st64_b32 v[42:43], v0 offset0:2 offset1:3
    s_sub_u32 s3, s37, 768
    s_cmp_gt_u32 s3, 256
    s_cbranch_scc1 L2_xf43
L2_xg43:
    v_lshrrev_b64 v[64:65], 16, v[64:65]
    v_lshrrev_b64 v[66:67], 16, v[66:67]
    s_setprio 2
    ds_write_addtid_b32 v124 offset:34816
    ds_write_addtid_b32 v125 offset:35072
    ds_write_addtid_b32 v126 offset:35328
    ds_write_addtid_b32 v127 offset:35584
    s_add_u32 s3, s40, 4096
    buffer_load_dwordx4 v[124:127], v3, s[16:19], s3 offen
    s_waitcnt lgkmcnt(14)
    v_cmp_ne_u64 s[50:51], v[72:73], v[68:69]
    v_cmpx_ne_u64 s[54:55], v[74:75], v[70:71]
    s_and_b64 s[82:83], s[54:55], s[80:81]
    s_cbranch_scc1 L2_c44
L2_d44:
    v_mov_b64 v[84:85], v[70:71]
    v_mov_b32 v7, v95
    v_mov_b64 v[86:87], v[74:75]
    s_or_b64 s[80:81], s[80:81], s[54:55]
    s_mov_b64 exec, s[50:51]
    s_and_b64 s[82:83], s[50:51], s[80:81]
    s_cbranch_scc1 L2_c45
L2_d45:
    v_mov_b64 v[84:85], v[68:69]
    v_mov_b32 v7, v94
    v_mov_b64 v[86:87], v[72:73]
    s_mov_b64 exec, -1
    s_or_b64 s[80:81], s[80:81], s[50:51]
    ds_read_b64 v[70:71], v93 offset:65408
    s_and_b64 exec, s[84:85], s[80:81]
    v_mfma_f32_4x4x4_16b_bf16 v[76:79], v[12:13], v[84:85], 0
    v_mov_b32 v92, v7
    s_andn2_b64 s[80:81], s[80:81], s[84:85]
    v_mfma_f32_4x4x4_16b_bf16 v[76:79], v[10:11], v[86:87], v[76:79]
    s_mov_b64 exec, -1
    ds_read_b64 v[68:69], v92 offset:65408
    s_setprio 1
    s_waitcnt vmcnt(10)
    s_mov_b32 m0, s38
    s_nop 0
    ds_write_addtid_b32 v108 offset:0
    ds_write_addtid_b32 v109 offset:256
    ds_write_addtid_b32 v110 offset:512
    ds_write_addtid_b32 v111 offset:768
    s_waitcnt lgkmcnt(4)
    v_mfma_f32_4x4x4_16b_bf16 v[80:83], v[10:11], v[70:71], v[80:83]
    v_mfma_f32_4x4x4_16b_bf16 v[76:79], v[10:11], v[68:69], v[76:79]
    v_and_b32 v46, 0x40000000, v39
    v_bitop3_b32 v94, v36, v5, v46 bitop3:0xea
    v_and_b32 v46, 0x80000000, v39
    v_bitop3_b32 v95, v37, v5, v46 bitop3:0xea
    v_perm_b32 v15, v37, v38, s47
    v_bitop3_b32 v46, v37, 0.5, -0.5 bitop3:0xa8
    v_perm_b32 v14, v36, v38, s46
    v_bitop3_b32 v47, v36, 0.5, -0.5 bitop3:0xa8
    v_cvt_pk_bf16_f32 v80, v80, v81
    v_cvt_pk_bf16_f32 v81, v82, v83
    ds_wrxchg_rtn_b64 v[74:75], v93, v[80:81] offset:65408
    v_cvt_pk_bf16_f32 v76, v76, v77
    v_cvt_pk_bf16_f32 v77, v78, v79
    ds_wrxchg_rtn_b64 v[72:73], v92, v[76:77] offset:65408
    v_and_b32 v88, 0x0fffffff, v44
    v_mov_b32 v39, v44
    buffer_load_dwordx2 v[34:35], v88, s[8:11], 0 offen
    buffer_load_dwordx3 v[36:38], v88, s[8:11], 0 offen offset:8
    s_setprio 0
    s_waitcnt vmcnt(11)
    ds_write_addtid_b32 v112 offset:1024
    ds_write_addtid_b32 v113 offset:1280
    ds_write_addtid_b32 v114 offset:1536
    ds_write_addtid_b32 v115 offset:1792
    v_mfma_f32_4x4x4_16b_bf16 v[80:83], v[8:9], v[106:107], 0
    v_mfma_f32_4x4x4_16b_bf16 v[76:79], v[8:9], v[104:105], 0
    v_bitop3_b32 v15, v6, v15, v46 bitop3:0xca
    v_bitop3_b32 v14, v6, v14, v47 bitop3:0xca
    s_nop 1
    v_pk_mul_f32 v[80:81], v[80:81], v[14:15] op_sel:[0,1] op_sel_hi:[1,1]
    v_pk_mul_f32 v[82:83], v[82:83], v[14:15] op_sel:[0,1] op_sel_hi:[1,1]
    v_pk_mul_f32 v[76:77], v[76:77], v[14:15] op_sel:[0,0] op_sel_hi:[1,0]
    v_pk_mul_f32 v[78:79], v[78:79], v[14:15] op_sel:[0,0] op_sel_hi:[1,0]
    s_add_u32 s42, s42, 1
    s_waitcnt lgkmcnt(0)
L2_loop:
    s_barrier
    s_bitcmp1_b32 s36, s42
    s_cbranch_scc1 L2_slow
L2_ret2:
    s_setprio 3
    buffer_load_dwordx4 v[108:111], v3, s[16:19], s40 offen offset:0
    v_cmp_ne_u64 s[50:51], v[72:73], v[68:69]
    v_cmpx_ne_u64 s[54:55], v[74:75], v[70:71]
    s_and_b64 s[82:83], s[54:55], s[80:81]
    s_cbranch_scc1 L2_c46
L2_d46:
    v_mov_b64 v[84:85], v[70:71]
    v_mov_b32 v7, v93
    v_mov_b64 v[86:87], v[74:75]
    s_or_b64 s[80:81], s[80:81], s[54:55]
    s_mov_b64 exec, s[50:51]
    s_and_b64 s[82:83], s[50:51], s[80:81]
    s_cbranch_scc1 L2_c47
L2_d47:
    v_mov_b64 v[84:85], v[68:69]
    v_mov_b32 v7, v92
    v_mov_b64 v[86:87], v[72:73]
    s_mov_b64 exec, -1
    s_or_b64 s[80:81], s[80:81], s[50:51]
    ds_read_b64 v[70:71], v95 offset:65408
    ds_read_b64 v[68:69], v94 offset:65408
    s_waitcnt vmcnt(10)
    v_and_b32 v46, 0x20000000, v21
    v_lshrrev_b32 v47, 14, v17
    v_bitop3_b32 v47, v47, v5, v46 bitop3:0xea
    ds_read_b64 v[102:103], v47
    v_bitop3_b32 v93, v17, v5, v46 bitop3:0xea
    v_and_b32 v46, 0x10000000, v21
    v_lshrrev_b32 v47, 14, v16
    v_bitop3_b32 v47, v47, v5, v46 bitop3:0xea
    ds_read_b64 v[100:101], v47
    v_bitop3_b32 v92, v16, v5, v46 bitop3:0xea
    s_waitcnt lgkmcnt(2)
    v_mfma_f32_4x4x4_16b_bf16 v[80:83], v[10:11], v[70:71], v[80:83]
    v_mfma_f32_4x4x4_16b_bf16 v[76:79], v[10:11], v[68:69], v[76:79]
    v_perm_b32 v15, v17, v20, s45
    v_bitop3_b32 v46, v17, 0.5, -0.5 bitop3:0xa8
    v_perm_b32 v14, v16, v20, s44
    v_bitop3_b32 v47, v16, 0.5, -0.5 bitop3:0xa8
    v_cvt_pk_bf16_f32 v80, v80, v81
    v_cvt_pk_bf16_f32 v81, v82, v83
    ds_wrxchg_rtn_b64 v[74:75], v95, v[80:81] offset:65408
    v_cvt_pk_bf16_f32 v76, v76, v77
    v_cvt_pk_bf16_f32 v77, v78, v79
    ds_wrxchg_rtn_b64 v[72:73], v94, v[76:77] offset:65408
    s_waitcnt lgkmcnt(2)
    v_mfma_f32_4x4x4_16b_bf16 v[80:83], v[8:9], v[102:103], 0
    v_mfma_f32_4x4x4_16b_bf16 v[76:79], v[8:9], v[100:101], 0
    v_bitop3_b32 v15, v6, v15, v46 bitop3:0xca
    v_bitop3_b32 v14, v6, v14, v47 bitop3:0xca
    v_cmp_lt_u32 s[84:85], v5, v92
    s_nop 0
    v_pk_mul_f32 v[80:81], v[80:81], v[14:15] op_sel:[0,1] op_sel_hi:[1,1]
    v_pk_mul_f32 v[82:83], v[82:83], v[14:15] op_sel:[0,1] op_sel_hi:[1,1]
    v_pk_mul_f32 v[76:77], v[76:77], v[14:15] op_sel:[0,0] op_sel_hi:[1,0]
    v_pk_mul_f32 v[78:79], v[78:79], v[14:15] op_sel:[0,0] op_sel_hi:[1,0]
    buffer_load_dwordx4 v[112:115], v3, s[16:19], s40 offen offset:1024
    s_waitcnt lgkmcnt(0)
    v_cmp_ne_u64 s[50:51], v[72:73], v[68:69]
    v_cmpx_ne_u64 s[54:55], v[74:75], v[70:71]
    s_and_b64 s[82:83], s[54:55], s[80:81]
    s_cbranch_scc1 L2_c48
L2_d48:
    v_mov_b64 v[84:85], v[70:71]
    v_mov_b32 v7, v95
    v_mov_b64 v[86:87], v[74:75]
    s_or_b64 s[80:81], s[80:81], s[54:55]
    s_mov_b64 exec, s[50:51]
    s_and_b64 s[82:83], s[50:51], s[80:81]
    s_cbranch_scc1 L2_c49
L2_d49:
    v_mov_b64 v[84:85], v[68:69]
    v_mov_b32 v7, v94
    v_mov_b64 v[86:87], v[72:73]
    s_mov_b64 exec, -1
    s_or_b64 s[80:81], s[80:81], s[50:51]
    ds_read_b64 v[70:71], v93 offset:65408
    s_and_b64 exec, s[84:85], s[80:81]
    v_mfma_f32_4x4x4_16b_bf16 v[76:79], v[12:13], v[84:85], 0
    v_mov_b32 v92, v7
    s_andn2_b64 s[80:81], s[80:81], s[84:85]
    v_mfma_f32_4x4x4_16b_bf16 v[76:79], v[10:11], v[86:87], v[76:79]
    s_mov_b64 exec, -1
    ds_read_b64 v[68:69], v92 offset:65408
    v_and_b32 v46, 0x80000000, v21
    v_lshrrev_b32 v47, 14, v19
    v_bitop3_b32 v47, v47, v5, v46 bitop3:0xea
    ds_read_b64 v[106:107], v47
    v_bitop3_b32 v95, v19, v5, v46 bitop3:0xea
    v_and_b32 v46, 0x40000000, v21
    v_lshrrev_b32 v47, 14, v18
    v_bitop3_b32 v47, v47, v5, v46 bitop3:0xea
    ds_read_b64 v[104:105], v47
    v_bitop3_b32 v94, v18, v5, v46 bitop3:0xea
    s_waitcnt lgkmcnt(2)
    v_mfma_f32_4x4x4_16b_bf16 v[80:83], v[10:11], v[70:71], v[80:83]
    v_mfma_f32_4x4x4_16b_bf16 v[76:79], v[10:11], v[68:69], v[76:79]
    v_perm_b32 v15, v19, v20, s47
    v_bitop3_b32 v46, v19, 0.5, -0.5 bitop3:0xa8
    v_perm_b32 v14, v18, v20, s46
    v_bitop3_b32 v47, v18, 0.5, -0.5 bitop3:0xa8
    v_cvt_pk_bf16_f32 v80, v80, v81
    v_cvt_pk_bf16_f32 v81, v82, v83
    ds_wrxchg_rtn_b64 v[74:75], v93, v[80:81] offset:65408
    v_cvt_pk_bf16_f32 v76, v76, v77
    v_cvt_pk_bf16_f32 v77, v78, v79
    ds_wrxchg_rtn_b64 v[72:73], v92, v[76:77] offset:65408
    v_and_b32 v88, 0x0fffffff, v40
    v_mov_b32 v21, v40
    buffer_load_dwordx2 v[16:17], v88, s[8:11], 0 offen
    buffer_load_dwordx3 v[18:20], v88, s[8:11], 0 offen offset:8
    s_setprio 2
    s_waitcnt lgkmcnt(2)
    v_mfma_f32_4x4x4_16b_bf16 v[80:83], v[8:9], v[106:107], 0
    v_mfma_f32_4x4x4_16b_bf16 v[76:79], v[8:9], v[104:105], 0
    v_bitop3_b32 v15, v6, v15, v46 bitop3:0xca
    v_bitop3_b32 v14, v6, v14, v47 bitop3:0xca
    s_nop 1
    v_pk_mul_f32 v[80:81], v[80:81], v[14:15] op_sel:[0,1] op_sel_hi:[1,1]
    v_pk_mul_f32 v[82:83], v[82:83], v[14:15] op_sel:[0,1] op_sel_hi:[1,1]
    v_pk_mul_f32 v[76:77], v[76:77], v[14:15] op_sel:[0,0] op_sel_hi:[1,0]
    v_pk_mul_f32 v[78:79], v[78:79], v[14:15] op_sel:[0,0] op_sel_hi:[1,0]
    v_sub_u16 v88, v56, v48
    v_and_b32 v89, 3, v48
    v_add3_u32 v99, v88, v89, 3
    v_and_b32 v99, -4, v99
    v_max_u32 v99, 4, v99
    v_and_b32 v97, 0xfffc, v48
    v_bfm_b32 v96, v88, v89
    v_add_u32_dpp v91, v99, v99 row_shr:1 row_mask:0xf bank_mask:0xf bound_ctrl:1
    v_mad_u32_u24 v97, v97, 5, v2
    v_cmp_lt_u32 vcc, 16, v99
    v_add_u32_dpp v91, v91, v91 row_shr:2 row_mask:0xf bank_mask:0xf bound_ctrl:1
    v_sub_u32 v98, s38, v99
    v_lshrrev_b64 v[48:49], 16, v[48:49]
    v_add_u32_dpp v91, v91, v91 row_shr:4 row_mask:0xf bank_mask:0xf bound_ctrl:1
    v_lshrrev_b64 v[56:57], 16, v[56:57]
    s_mov_b32 s101, 0
    v_add_u32_dpp v91, v91, v91 row_shr:8 row_mask:0xf bank_mask:0xf bound_ctrl:1
    s_nop 1
    v_add_u32_dpp v91, v91, v91 row_bcast:15 row_mask:0xa bank_mask:0xf
    s_nop 1
    v_add_u32_dpp v91, v91, v91 row_bcast:31 row_mask:0xc bank_mask:0xf
    v_add_u32 v98, v98, v91
    v_readlane_b32 s37, v91, 63
    s_cbranch_vccnz L2_xo50
L2_xp50:
    s_waitcnt lgkmcnt(0)
    v_cmp_ne_u64 s[50:51], v[72:73], v[68:69]
    v_cmpx_ne_u64 s[54:55], v[74:75], v[70:71]
    s_and_b64 s[82:83], s[54:55], s[80:81]
    s_cbranch_scc1 L2_c51
L2_d51:
    v_mov_b64 v[84:85], v[70:71]
    v_mov_b32 v7, v93
    v_mov_b64 v[86:87], v[74:75]
    s_or_b64 s[80:81], s[80:81], s[54:55]
    s_mov_b64 exec, s[50:51]
    s_and_b64 s[82:83], s[50:51], s[80:81]
    s_cbranch_scc1 L2_c52
L2_d52:
    v_mov_b64 v[84:85], v[68:69]
    v_mov_b32 v7, v92
    v_mov_b64 v[86:87], v[72:73]
    s_mov_b64 exec, -1
    s_or_b64 s[80:81], s[80:81], s[50:51]
    ds_read_b64 v[70:71], v95 offset:65408
    ds_read_b64 v[68:69], v94 offset:65408
    s_waitcnt vmcnt(11)
    v_and_b32 v46, 0x20000000, v27
    v_lshrrev_b32 v47, 14, v23
    v_bitop3_b32 v47, v47, v5, v46 bitop3:0xea
    ds_read_b64 v[102:103], v47
    v_bitop3_b32 v93, v23, v5, v46 bitop3:0xea
    v_and_b32 v46, 0x10000000, v27
    v_lshrrev_b32 v47, 14, v22
    v_bitop3_b32 v47, v47, v5, v46 bitop3:0xea
    ds_read_b64 v[100:101], v47
    v_bitop3_b32 v92, v22, v5, v46 bitop3:0xea
    s_waitcnt lgkmcnt(2)
    v_mfma_f32_4x4x4_16b_bf16 v[80:83], v[10:11], v[70:71], v[80:83]
    v_mfma_f32_4x4x4_16b_bf16 v[76:79], v[10:11], v[68:69], v[76:79]
    v_perm_b32 v15, v23, v26, s45
    v_bitop3_b32 v46, v23, 0.5, -0.5 bitop3:0xa8
    v_perm_b32 v14, v22, v26, s44
    v_bitop3_b32 v47, v22, 0.5, -0.5 bitop3:0xa8
    v_cvt_pk_bf16_f32 v80, v80, v81
    v_cvt_pk_bf16_f32 v81, v82, v83
    ds_wrxchg_rtn_b64 v[74:75], v95, v[80:81] offset:65408
    v_cvt_pk_bf16_f32 v76, v76, v77
    v_cvt_pk_bf16_f32 v77, v78, v79
    ds_wrxchg_rtn_b64 v[72:73], v94, v[76:77] offset:65408
    s_waitcnt lgkmcnt(2)
    v_mfma_f32_4x4x4_16b_bf16 v[80:83], v[8:9], v[102:103], 0
    v_mfma_f32_4x4x4_16b_bf16 v[76:79], v[8:9], v[100:101], 0
    v_bitop3_b32 v15, v6, v15, v46 bitop3:0xca
    v_bitop3_b32 v14, v6, v14, v47 bitop3:0xca
    v_cmp_lt_u32 s[84:85], v5, v92
    s_nop 0
    v_pk_mul_f32 v[80:81], v[80:81], v[14:15] op_sel:[0,1] op_sel_hi:[1,1]
    v_pk_mul_f32 v[82:83], v[82:83], v[14:15] op_sel:[0,1] op_sel_hi:[1,1]
    v_pk_mul_f32 v[76:77], v[76:77], v[14:15] op_sel:[0,0] op_sel_hi:[1,0]
    v_pk_mul_f32 v[78:79], v[78:79], v[14:15] op_sel:[0,0] op_sel_hi:[1,0]
    s_waitcnt lgkmcnt(0)
    v_cmp_ne_u64 s[50:51], v[72:73], v[68:69]
    v_cmpx_ne_u64 s[54:55], v[74:75], v[70:71]
    s_and_b64 s[82:83], s[54:55], s[80:81]
    s_cbranch_scc1 L2_c53
L2_d53:
    v_mov_b64 v[84:85], v[70:71]
    v_mov_b32 v7, v95
    v_mov_b64 v[86:87], v[74:75]
    s_or_b64 s[80:81], s[80:81], s[54:55]
    s_mov_b64 exec, s[50:51]
    s_and_b64 s[82:83], s[50:51], s[80:81]
    s_cbranch_scc1 L2_c54
L2_d54:
    v_mov_b64 v[84:85], v[68:69]
    v_mov_b32 v7, v94
    v_mov_b64 v[86:87], v[72:73]
    s_mov_b64 exec, -1
    s_or_b64 s[80:81], s[80:81], s[50:51]
    ds_read_b64 v[70:71], v93 offset:65408
    s_and_b64 exec, s[84:85], s[80:81]
    v_mfma_f32_4x4x4_16b_bf16 v[76:79], v[12:13], v[84:85], 0
    v_mov_b32 v92, v7
    s_andn2_b64 s[80:81], s[80:81], s[84:85]
    v_mfma_f32_4x4x4_16b_bf16 v[76:79], v[10:11], v[86:87], v[76:79]
    s_mov_b64 exec, -1
    ds_read_b64 v[68:69], v92 offset:65408
    v_and_b32 v46, 0x80000000, v27
    v_lshrrev_b32 v47, 14, v25
    v_bitop3_b32 v47, v47, v5, v46 bitop3:0xea
    ds_read_b64 v[106:107], v47
    v_bitop3_b32 v95, v25, v5, v46 bitop3:0xea
    v_and_b32 v46, 0x40000000, v27
    v_lshrrev_b32 v47, 14, v24
    v_bitop3_b32 v47, v47, v5, v46 bitop3:0xea
    ds_read_b64 v[104:105], v47
    v_bitop3_b32 v94, v24, v5, v46 bitop3:0xea
    s_waitcnt lgkmcnt(2)
    v_mfma_f32_4x4x4_16b_bf16 v[80:83], v[10:11], v[70:71], v[80:83]
    v_mfma_f32_4x4x4_16b_bf16 v[76:79], v[10:11], v[68:69], v[76:79]
    v_perm_b32 v15, v25, v26, s47
    v_bitop3_b32 v46, v25, 0.5, -0.5 bitop3:0xa8
    v_perm_b32 v14, v24, v26, s46
    v_bitop3_b32 v47, v24, 0.5, -0.5 bitop3:0xa8
    v_cvt_pk_bf16_f32 v80, v80, v81
    v_cvt_pk_bf16_f32 v81, v82, v83
    ds_wrxchg_rtn_b64 v[74:75], v93, v[80:81] offset:65408
    v_cvt_pk_bf16_f32 v76, v76, v77
    v_cvt_pk_bf16_f32 v77, v78, v79
    ds_wrxchg_rtn_b64 v[72:73], v92, v[76:77] offset:65408
    v_and_b32 v88, 0x0fffffff, v41
    v_mov_b32 v27, v41
    buffer_load_dwordx2 v[22:23], v88, s[8:11], 0 offen
    buffer_load_dwordx3 v[24:26], v88, s[8:11], 0 offen offset:8
    s_setprio 1
    s_waitcnt lgkmcnt(2)
    v_mfma_f32_4x4x4_16b_bf16 v[80:83], v[8:9], v[106:107], 0
    v_mfma_f32_4x4x4_16b_bf16 v[76:79], v[8:9], v[104:105], 0
    v_bitop3_b32 v15, v6, v15, v46 bitop3:0xca
    v_bitop3_b32 v14, v6, v14, v47 bitop3:0xca
    s_nop 1
    v_pk_mul_f32 v[80:81], v[80:81], v[14:15] op_sel:[0,1] op_sel_hi:[1,1]
    v_pk_mul_f32 v[82:83], v[82:83], v[14:15] op_sel:[0,1] op_sel_hi:[1,1]
    v_pk_mul_f32 v[76:77], v[76:77], v[14:15] op_sel:[0,0] op_sel_hi:[1,0]
    v_pk_mul_f32 v[78:79], v[78:79], v[14:15] op_sel:[0,0] op_sel_hi:[1,0]
    s_waitcnt lgkmcnt(0)
    v_cmp_ne_u64 s[50:51], v[72:73], v[68:69]
    v_cmpx_ne_u64 s[54:55], v[74:75], v[70:71]
    s_and_b64 s[82:83], s[54:55], s[80:81]
    s_cbranch_scc1 L2_c55
L2_d55:
    v_mov_b64 v[84:85], v[70:71]
    v_mov_b32 v7, v93
    v_mov_b64 v[86:87], v[74:75]
    s_or_b64 s[80:81], s[80:81], s[54:55]
    s_mov_b64 exec, s[50:51]
    s_and_b64 s[82:83], s[50:51], s[80:81]
    s_cbranch_scc1 L2_c56
L2_d56:
    v_mov_b64 v[84:85], v[68:69]
    v_mov_b32 v7, v92
    v_mov_b64 v[86:87], v[72:73]
    s_mov_b64 exec, -1
    s_or_b64 s[80:81], s[80:81], s[50:51]
    ds_read_b64 v[70:71], v95 offset:65408
    ds_read_b64 v[68:69], v94 offset:65408
    s_waitcnt vmcnt(11)
    v_and_b32 v46, 0x20000000, v33
    v_lshrrev_b32 v47, 14, v29
    v_bitop3_b32 v47, v47, v5, v46 bitop3:0xea
    ds_read_b64 v[102:103], v47
    v_bitop3_b32 v93, v29, v5, v46 bitop3:0xea
    v_and_b32 v46, 0x10000000, v33
    v_lshrrev_b32 v47, 14, v28
    v_bitop3_b32 v47, v47, v5, v46 bitop3:0xea
    ds_read_b64 v[100:101], v47
    v_bitop3_b32 v92, v28, v5, v46 bitop3:0xea
    s_waitcnt lgkmcnt(2)
    v_mfma_f32_4x4x4_16b_bf16 v[80:83], v[10:11], v[70:71], v[80:83]
    v_mfma_f32_4x4x4_16b_bf16 v[76:79], v[10:11], v[68:69], v[76:79]
    v_perm_b32 v15, v29, v32, s45
    v_bitop3_b32 v46, v29, 0.5, -0.5 bitop3:0xa8
    v_perm_b32 v14, v28, v32, s44
    v_bitop3_b32 v47, v28, 0.5, -0.5 bitop3:0xa8
    v_cvt_pk_bf16_f32 v80, v80, v81
    v_cvt_pk_bf16_f32 v81, v82, v83
    ds_wrxchg_rtn_b64 v[74:75], v95, v[80:81] offset:65408
    v_cvt_pk_bf16_f32 v76, v76, v77
    v_cvt_pk_bf16_f32 v77, v78, v79
    ds_wrxchg_rtn_b64 v[72:73], v94, v[76:77] offset:65408
    s_waitcnt lgkmcnt(2)
    v_mfma_f32_4x4x4_16b_bf16 v[80:83], v[8:9], v[102:103], 0
    v_mfma_f32_4x4x4_16b_bf16 v[76:79], v[8:9], v[100:101], 0
    v_bitop3_b32 v15, v6, v15, v46 bitop3:0xca
    v_bitop3_b32 v14, v6, v14, v47 bitop3:0xca
    v_cmp_lt_u32 s[84:85], v5, v92
    s_nop 0
    v_pk_mul_f32 v[80:81], v[80:81], v[14:15] op_sel:[0,1] op_sel_hi:[1,1]
    v_pk_mul_f32 v[82:83], v[82:83], v[14:15] op_sel:[0,1] op_sel_hi:[1,1]
    v_pk_mul_f32 v[76:77], v[76:77], v[14:15] op_sel:[0,0] op_sel_hi:[1,0]
    v_pk_mul_f32 v[78:79], v[78:79], v[14:15] op_sel:[0,0] op_sel_hi:[1,0]
    s_waitcnt lgkmcnt(0)
    v_cmp_ne_u64 s[50:51], v[72:73], v[68:69]
    v_cmpx_ne_u64 s[54:55], v[74:75], v[70:71]
    s_and_b64 s[82:83], s[54:55], s[80:81]
    s_cbranch_scc1 L2_c57
L2_d57:
    v_mov_b64 v[84:85], v[70:71]
    v_mov_b32 v7, v95
    v_mov_b64 v[86:87], v[74:75]
    s_or_b64 s[80:81], s[80:81], s[54:55]
    s_mov_b64 exec, s[50:51]
    s_and_b64 s[82:83], s[50:51], s[80:81]
    s_cbranch_scc1 L2_c58
L2_d58:
    v_mov_b64 v[84:85], v[68:69]
    v_mov_b32 v7, v94
    v_mov_b64 v[86:87], v[72:73]
    s_mov_b64 exec, -1
    s_or_b64 s[80:81], s[80:81], s[50:51]
    ds_read_b64 v[70:71], v93 offset:65408
    s_and_b64 exec, s[84:85], s[80:81]
    v_mfma_f32_4x4x4_16b_bf16 v[76:79], v[12:13], v[84:85], 0
    v_mov_b32 v92, v7
    s_andn2_b64 s[80:81], s[80:81], s[84:85]
    v_mfma_f32_4x4x4_16b_bf16 v[76:79], v[10:11], v[86:87], v[76:79]
    s_mov_b64 exec, -1
    ds_read_b64 v[68:69], v92 offset:65408
    v_and_b32 v46, 0x80000000, v33
    v_lshrrev_b32 v47, 14, v31
    v_bitop3_b32 v47, v47, v5, v46 bitop3:0xea
    ds_read_b64 v[106:107], v47
    v_bitop3_b32 v95, v31, v5, v46 bitop3:0xea
    v_and_b32 v46, 0x40000000, v33
    v_lshrrev_b32 v47, 14, v30
    v_bitop3_b32 v47, v47, v5, v46 bitop3:0xea
    ds_read_b64 v[104:105], v47
    v_bitop3_b32 v94, v30, v5, v46 bitop3:0xea
    s_waitcnt lgkmcnt(2)
    v_mfma_f32_4x4x4_16b_bf16 v[80:83], v[10:11], v[70:71], v[80:83]
    v_mfma_f32_4x4x4_16b_bf16 v[76:79], v[10:11], v[68:69], v[76:79]
    v_perm_b32 v15, v31, v32, s47
    v_bitop3_b32 v46, v31, 0.5, -0.5 bitop3:0xa8
    v_perm_b32 v14, v30, v32, s46
    v_bitop3_b32 v47, v30, 0.5, -0.5 bitop3:0xa8
    v_cvt_pk_bf16_f32 v80, v80, v81
    v_cvt_pk_bf16_f32 v81, v82, v83
    ds_wrxchg_rtn_b64 v[74:75], v93, v[80:81] offset:65408
    v_cvt_pk_bf16_f32 v76, v76, v77
    v_cvt_pk_bf16_f32 v77, v78, v79
    ds_wrxchg_rtn_b64 v[72:73], v92, v[76:77] offset:65408
    v_and_b32 v88, 0x0fffffff, v42
    v_mov_b32 v33, v42
    buffer_load_dwordx2 v[28:29], v88, s[8:11], 0 offen
    buffer_load_dwordx3 v[30:32], v88, s[8:11], 0 offen offset:8
    s_setprio 0
    s_waitcnt lgkmcnt(2)
    v_mfma_f32_4x4x4_16b_bf16 v[80:83], v[8:9], v[106:107], 0
    v_mfma_f32_4x4x4_16b_bf16 v[76:79], v[8:9], v[104:105], 0
    v_bitop3_b32 v15, v6, v15, v46 bitop3:0xca
    v_bitop3_b32 v14, v6, v14, v47 bitop3:0xca
    s_nop 1
    v_pk_mul_f32 v[80:81], v[80:81], v[14:15] op_sel:[0,1] op_sel_hi:[1,1]
    v_pk_mul_f32 v[82:83], v[82:83], v[14:15] op_sel:[0,1] op_sel_hi:[1,1]
    v_pk_mul_f32 v[76:77], v[76:77], v[14:15] op_sel:[0,0] op_sel_hi:[1,0]
    v_pk_mul_f32 v[78:79], v[78:79], v[14:15] op_sel:[0,0] op_sel_hi:[1,0]
    s_add_u32 s40, s40, 0xfff24000
    s_waitcnt lgkmcnt(0)
    v_cmp_ne_u64 s[50:51], v[72:73], v[68:69]
    v_cmpx_ne_u64 s[54:55], v[74:75], v[70:71]
    s_and_b64 s[82:83], s[54:55], s[80:81]
    s_cbranch_scc1 L2_c59
L2_d59:
    v_mov_b64 v[84:85], v[70:71]
    v_mov_b32 v7, v93
    v_mov_b64 v[86:87], v[74:75]
    s_or_b64 s[80:81], s[80:81], s[54:55]
    s_mov_b64 exec, s[50:51]
    s_and_b64 s[82:83], s[50:51], s[80:81]
    s_cbranch_scc1 L2_c60
L2_d60:
    v_mov_b64 v[84:85], v[68:69]
    v_mov_b32 v7, v92
    v_mov_b64 v[86:87], v[72:73]
    s_mov_b64 exec, -1
    s_or_b64 s[80:81], s[80:81], s[50:51]
    ds_read_b64 v[70:71], v95 offset:65408
    ds_read_b64 v[68:69], v94 offset:65408
    s_waitcnt vmcnt(8)
    v_and_b32 v46, 0x20000000, v39
    v_lshrrev_b32 v47, 14, v35
    v_bitop3_b32 v47, v47, v5, v46 bitop3:0xea
    ds_read_b64 v[102:103], v47
    v_bitop3_b32 v93, v35, v5, v46 bitop3:0xea
    v_and_b32 v46, 0x10000000, v39
    v_lshrrev_b32 v47, 14, v34
    v_bitop3_b32 v47, v47, v5, v46 bitop3:0xea
    ds_read_b64 v[100:101], v47
    v_bitop3_b32 v92, v34, v5, v46 bitop3:0xea
    v_and_b32 v46, 0x80000000, v39
    v_lshrrev_b32 v47, 14, v37
    v_bitop3_b32 v47, v47, v5, v46 bitop3:0xea
    ds_read_b64 v[106:107], v47
    v_and_b32 v46, 0x40000000, v39
    v_lshrrev_b32 v47, 14, v36
    v_bitop3_b32 v47, v47, v5, v46 bitop3:0xea
    ds_read_b64 v[104:105], v47
    s_waitcnt lgkmcnt(4)
    v_mfma_f32_4x4x4_16b_bf16 v[80:83], v[10:11], v[70:71], v[80:83]
    v_mfma_f32_4x4x4_16b_bf16 v[76:79], v[10:11], v[68:69], v[76:79]
    v_perm_b32 v15, v35, v38, s45
    v_bitop3_b32 v46, v35, 0.5, -0.5 bitop3:0xa8
    v_perm_b32 v14, v34, v38, s44
    v_bitop3_b32 v47, v34, 0.5, -0.5 bitop3:0xa8
    v_cvt_pk_bf16_f32 v80, v80, v81
    v_cvt_pk_bf16_f32 v81, v82, v83
    ds_wrxchg_rtn_b64 v[74:75], v95, v[80:81] offset:65408
    v_cvt_pk_bf16_f32 v76, v76, v77
    v_cvt_pk_bf16_f32 v77, v78, v79
    ds_wrxchg_rtn_b64 v[72:73], v94, v[76:77] offset:65408
    s_waitcnt lgkmcnt(2)
    s_barrier
    s_setprio 3
    s_mov_b32 m0, s100
    s_nop 0
    ds_write_addtid_b32 v116 offset:32768
    ds_write_addtid_b32 v117 offset:33024
    ds_write_addtid_b32 v118 offset:33280
    ds_write_addtid_b32 v119 offset:33536
    buffer_load_dwordx4 v[116:119], v3, s[16:19], s40 offen offset:2048
    ds_write_addtid_b32 v120 offset:33792
    ds_write_addtid_b32 v121 offset:34048
    ds_write_addtid_b32 v122 offset:34304
    ds_write_addtid_b32 v123 offset:34560
    buffer_load_dwordx4 v[120:123], v3, s[16:19], s40 offen offset:3072
    v_mfma_f32_4x4x4_16b_bf16 v[80:83], v[8:9], v[102:103], 0
    v_mfma_f32_4x4x4_16b_bf16 v[76:79], v[8:9], v[100:101], 0
    v_bitop3_b32 v15, v6, v15, v46 bitop3:0xca
    v_bitop3_b32 v14, v6, v14, v47 bitop3:0xca
    v_cmp_lt_u32 s[84:85], v5, v92
    s_nop 0
    v_pk_mul_f32 v[80:81], v[80:81], v[14:15] op_sel:[0,1] op_sel_hi:[1,1]
    v_pk_mul_f32 v[82:83], v[82:83], v[14:15] op_sel:[0,1] op_sel_hi:[1,1]
    v_pk_mul_f32 v[76:77], v[76:77], v[14:15] op_sel:[0,0] op_sel_hi:[1,0]
    v_pk_mul_f32 v[78:79], v[78:79], v[14:15] op_sel:[0,0] op_sel_hi:[1,0]
    v_mov_b32 v44, v43
    s_cmp_gt_u32 s37, 1024
    s_cbranch_scc1 L2_xs61
    s_cmp_lg_u32 s101, 0
    s_cbranch_scc1 L2_xa61
L2_xb61:
    v_lshlrev_b32 v89, 16, v96
    v_add_u32 v90, 60, v97
    v_bitop3_b32 v90, v89, v45, v90 bitop3:0x6a
    ds_write_b32 v98, v90 offset:12
    v_lshlrev_b32 v89, 20, v96
    v_add_u32 v90, 40, v97
    v_bitop3_b32 v90, v89, v45, v90 bitop3:0x6a
    ds_write_b32 v98, v90 offset:8
    v_lshlrev_b32 v89, 24, v96
    v_add_u32 v90, 20, v97
    v_bitop3_b32 v90, v89, v45, v90 bitop3:0x6a
    ds_write_b32 v98, v90 offset:4
    v_lshlrev_b32 v89, 28, v96
    v_bitop3_b32 v90, v89, v45, v97 bitop3:0x6a
    ds_write_b32 v98, v90 offset:0
    v_mov_b32_dpp v91, v64 quad_perm:[0,0,0,0] row_mask:0xf bank_mask:0xf
    v_and_b32 v89, 3, v91
    v_and_b32 v97, 0xfffc, v91
    v_sub_u16_dpp v88, v64, v91 quad_perm:[2,2,2,2] row_mask:0xf bank_mask:0xf
    v_mad_u32_u24 v97, v97, 5, v4
    v_add_u32 v99, v88, v89
    v_bfm_b32 v96, v88, v89
    v_cmp_lt_u32 s[58:59], 16, v99
    v_lshlrev_b32 v89, v1, v96
    v_and_b32 v89, v45, v89
    v_cmp_ne_u32 vcc, 0, v89
    v_xor_b32 v90, v97, v89
    s_add_u32 s3, s37, s38
    v_mbcnt_lo_u32_b32 v98, vcc_lo, 0
    v_mbcnt_hi_u32_b32 v98, vcc_hi, v98
    s_bcnt1_i32_b64 s41, vcc
    v_lshl_add_u32 v98, v98, 2, s3
    s_mov_b64 exec, vcc
    ds_write_b32 v98, v90
    s_mov_b64 exec, -1
    s_lshl2_add_u32 s37, s41, s37
    s_cmp_lg_u64 s[58:59], 0
    s_cbranch_scc1 L2_xe61
L2_xr61:
    v_add_u32 v98, s37, v0
    v_mov_b32 v90, -1
    ds_write_b32 v98, v90
    ds_read2st64_b32 v[40:41], v0 offset0:0 offset1:1
    ds_read2st64_b32 v[42:43], v0 offset0:2 offset1:3
    s_sub_u32 s3, s37, 768
    s_cmp_gt_u32 s3, 256
    s_cbranch_scc1 L2_xf61
L2_xg61:
    s_setprio 2
    ds_write_addtid_b32 v124 offset:34816
    ds_write_addtid_b32 v125 offset:35072
    ds_write_addtid_b32 v126 offset:35328
    ds_write_addtid_b32 v127 offset:35584
    s_add_u32 s3, s40, 4096
    buffer_load_dwordx4 v[124:127], v3, s[16:19], s3 offen
    s_waitcnt lgkmcnt(14)
    v_cmp_ne_u64 s[50:51], v[72:73], v[68:69]
    v_cmpx_ne_u64 s[54:55], v[74:75], v[70:71]
    s_and_b64 s[82:83], s[54:55], s[80:81]
    s_cbranch_scc1 L2_c62
L2_d62:
    v_mov_b64 v[84:85], v[70:71]
    v_mov_b32 v7, v95
    v_mov_b64 v[86:87], v[74:75]
    s_or_b64 s[80:81], s[80:81], s[54:55]
    s_mov_b64 exec, s[50:51]
    s_and_b64 s[82:83], s[50:51], s[80:81]
    s_cbranch_scc1 L2_c63
L2_d63:
    v_mov_b64 v[84:85], v[68:69]
    v_mov_b32 v7, v94
    v_mov_b64 v[86:87], v[72:73]
    s_mov_b64 exec, -1
    s_or_b64 s[80:81], s[80:81], s[50:51]
    ds_read_b64 v[70:71], v93 offset:65408
    s_and_b64 exec, s[84:85], s[80:81]
    v_mfma_f32_4x4x4_16b_bf16 v[76:79], v[12:13], v[84:85], 0
    v_mov_b32 v92, v7
    s_andn2_b64 s[80:81], s[80:81], s[84:85]
    v_mfma_f32_4x4x4_16b_bf16 v[76:79], v[10:11], v[86:87], v[76:79]
    s_mov_b64 exec, -1
    ds_read_b64 v[68:69], v92 offset:65408
    s_setprio 1
    s_waitcnt vmcnt(10)
    s_mov_b32 m0, s38
    s_nop 0
    ds_write_addtid_b32 v108 offset:0
    ds_write_addtid_b32 v109 offset:256
    ds_write_addtid_b32 v110 offset:512
    ds_write_addtid_b32 v111 offset:768
    s_waitcnt lgkmcnt(4)
    v_mfma_f32_4x4x4_16b_bf16 v[80:83], v[10:11], v[70:71], v[80:83]
    v_mfma_f32_4x4x4_16b_bf16 v[76:79], v[10:11], v[68:69], v[76:79]
    v_and_b32 v46, 0x40000000, v39
    v_bitop3_b32 v94, v36, v5, v46 bitop3:0xea
    v_and_b32 v46, 0x80000000, v39
    v_bitop3_b32 v95, v37, v5, v46 bitop3:0xea
    v_perm_b32 v15, v37, v38, s47
    v_bitop3_b32 v46, v37, 0.5, -0.5 bitop3:0xa8
    v_perm_b32 v14, v36, v38, s46
    v_bitop3_b32 v47, v36, 0.5, -0.5 bitop3:0xa8
    v_cvt_pk_bf16_f32 v80, v80, v81
    v_cvt_pk_bf16_f32 v81, v82, v83
    ds_wrxchg_rtn_b64 v[74:75], v93, v[80:81] offset:65408
    v_cvt_pk_bf16_f32 v76, v76, v77
    v_cvt_pk_bf16_f32 v77, v78, v79
    ds_wrxchg_rtn_b64 v[72:73], v92, v[76:77] offset:65408
    v_and_b32 v88, 0x0fffffff, v44
    v_mov_b32 v39, v44
    buffer_load_dwordx2 v[34:35], v88, s[8:11], 0 offen
    buffer_load_dwordx3 v[36:38], v88, s[8:11], 0 offen offset:8
    s_setprio 0
    s_waitcnt vmcnt(11)
    ds_write_addtid_b32 v112 offset:1024
    ds_write_addtid_b32 v113 offset:1280
    ds_write_addtid_b32 v114 offset:1536
    ds_write_addtid_b32 v115 offset:1792
    v_mfma_f32_4x4x4_16b_bf16 v[80:83], v[8:9], v[106:107], 0
    v_mfma_f32_4x4x4_16b_bf16 v[76:79], v[8:9], v[104:105], 0
    v_bitop3_b32 v15, v6, v15, v46 bitop3:0xca
    v_bitop3_b32 v14, v6, v14, v47 bitop3:0xca
    s_nop 1
    v_pk_mul_f32 v[80:81], v[80:81], v[14:15] op_sel:[0,1] op_sel_hi:[1,1]
    v_pk_mul_f32 v[82:83], v[82:83], v[14:15] op_sel:[0,1] op_sel_hi:[1,1]
    v_pk_mul_f32 v[76:77], v[76:77], v[14:15] op_sel:[0,0] op_sel_hi:[1,0]
    v_pk_mul_f32 v[78:79], v[78:79], v[14:15] op_sel:[0,0] op_sel_hi:[1,0]
    s_add_u32 s42, s42, 1
    s_waitcnt lgkmcnt(0)
    s_barrier
    s_bitcmp1_b32 s36, s42
    s_cbranch_scc1 L2_slow
L2_ret3:
    s_setprio 3
    buffer_load_dwordx4 v[108:111], v3, s[16:19], s40 offen offset:0
    v_cmp_ne_u64 s[50:51], v[72:73], v[68:69]
    v_cmpx_ne_u64 s[54:55], v[74:75], v[70:71]
    s_and_b64 s[82:83], s[54:55], s[80:81]
    s_cbranch_scc1 L2_c64
L2_d64:
    v_mov_b64 v[84:85], v[70:71]
    v_mov_b32 v7, v93
    v_mov_b64 v[86:87], v[74:75]
    s_or_b64 s[80:81], s[80:81], s[54:55]
    s_mov_b64 exec, s[50:51]
    s_and_b64 s[82:83], s[50:51], s[80:81]
    s_cbranch_scc1 L2_c65
L2_d65:
    v_mov_b64 v[84:85], v[68:69]
    v_mov_b32 v7, v92
    v_mov_b64 v[86:87], v[72:73]
    s_mov_b64 exec, -1
    s_or_b64 s[80:81], s[80:81], s[50:51]
    ds_read_b64 v[70:71], v95 offset:65408
    ds_read_b64 v[68:69], v94 offset:65408
    s_waitcnt vmcnt(10)
    v_and_b32 v46, 0x20000000, v21
    v_lshrrev_b32 v47, 14, v17
    v_bitop3_b32 v47, v47, v5, v46 bitop3:0xea
    ds_read_b64 v[102:103], v47
    v_bitop3_b32 v93, v17, v5, v46 bitop3:0xea
    v_and_b32 v46, 0x10000000, v21
    v_lshrrev_b32 v47, 14, v16
    v_bitop3_b32 v47, v47, v5, v46 bitop3:0xea
    ds_read_b64 v[100:101], v47
    v_bitop3_b32 v92, v16, v5, v46 bitop3:0xea
    s_waitcnt lgkmcnt(2)
    v_mfma_f32_4x4x4_16b_bf16 v[80:83], v[10:11], v[70:71], v[80:83]
    v_mfma_f32_4x4x4_16b_bf16 v[76:79], v[10:11], v[68:69], v[76:79]
    v_perm_b32 v15, v17, v20, s45
    v_bitop3_b32 v46, v17, 0.5, -0.5 bitop3:0xa8
    v_perm_b32 v14, v16, v20, s44
    v_bitop3_b32 v47, v16, 0.5, -0.5 bitop3:0xa8
    v_cvt_pk_bf16_f32 v80, v80, v81
    v_cvt_pk_bf16_f32 v81, v82, v83
    ds_wrxchg_rtn_b64 v[74:75], v95, v[80:81] offset:65408
    v_cvt_pk_bf16_f32 v76, v76, v77
    v_cvt_pk_bf16_f32 v77, v78, v79
    ds_wrxchg_rtn_b64 v[72:73], v94, v[76:77] offset:65408
    s_waitcnt lgkmcnt(2)
    v_mfma_f32_4x4x4_16b_bf16 v[80:83], v[8:9], v[102:103], 0
    v_mfma_f32_4x4x4_16b_bf16 v[76:79], v[8:9], v[100:101], 0
    v_bitop3_b32 v15, v6, v15, v46 bitop3:0xca
    v_bitop3_b32 v14, v6, v14, v47 bitop3:0xca
    v_cmp_lt_u32 s[84:85], v5, v92
    s_nop 0
    v_pk_mul_f32 v[80:81], v[80:81], v[14:15] op_sel:[0,1] op_sel_hi:[1,1]
    v_pk_mul_f32 v[82:83], v[82:83], v[14:15] op_sel:[0,1] op_sel_hi:[1,1]
    v_pk_mul_f32 v[76:77], v[76:77], v[14:15] op_sel:[0,0] op_sel_hi:[1,0]
    v_pk_mul_f32 v[78:79], v[78:79], v[14:15] op_sel:[0,0] op_sel_hi:[1,0]
    buffer_load_dwordx4 v[112:115], v3, s[16:19], s40 offen offset:1024
    s_waitcnt lgkmcnt(0)
    v_cmp_ne_u64 s[50:51], v[72:73], v[68:69]
    v_cmpx_ne_u64 s[54:55], v[74:75], v[70:71]
    s_and_b64 s[82:83], s[54:55], s[80:81]
    s_cbranch_scc1 L2_c66
L2_d66:
    v_mov_b64 v[84:85], v[70:71]
    v_mov_b32 v7, v95
    v_mov_b64 v[86:87], v[74:75]
    s_or_b64 s[80:81], s[80:81], s[54:55]
    s_mov_b64 exec, s[50:51]
    s_and_b64 s[82:83], s[50:51], s[80:81]
    s_cbranch_scc1 L2_c67
L2_d67:
    v_mov_b64 v[84:85], v[68:69]
    v_mov_b32 v7, v94
    v_mov_b64 v[86:87], v[72:73]
    s_mov_b64 exec, -1
    s_or_b64 s[80:81], s[80:81], s[50:51]
    ds_read_b64 v[70:71], v93 offset:65408
    s_and_b64 exec, s[84:85], s[80:81]
    v_mfma_f32_4x4x4_16b_bf16 v[76:79], v[12:13], v[84:85], 0
    v_mov_b32 v92, v7
    s_andn2_b64 s[80:81], s[80:81], s[84:85]
    v_mfma_f32_4x4x4_16b_bf16 v[76:79], v[10:11], v[86:87], v[76:79]
    s_mov_b64 exec, -1
    ds_read_b64 v[68:69], v92 offset:65408
    v_and_b32 v46, 0x80000000, v21
    v_lshrrev_b32 v47, 14, v19
    v_bitop3_b32 v47, v47, v5, v46 bitop3:0xea
    ds_read_b64 v[106:107], v47
    v_bitop3_b32 v95, v19, v5, v46 bitop3:0xea
    v_and_b32 v46, 0x40000000, v21
    v_lshrrev_b32 v47, 14, v18
    v_bitop3_b32 v47, v47, v5, v46 bitop3:0xea
    ds_read_b64 v[104:105], v47
    v_bitop3_b32 v94, v18, v5, v46 bitop3:0xea
    s_waitcnt lgkmcnt(2)
    v_mfma_f32_4x4x4_16b_bf16 v[80:83], v[10:11], v[70:71], v[80:83]
    v_mfma_f32_4x4x4_16b_bf16 v[76:79], v[10:11], v[68:69], v[76:79]
    v_perm_b32 v15, v19, v20, s47
    v_bitop3_b32 v46, v19, 0.5, -0.5 bitop3:0xa8
    v_perm_b32 v14, v18, v20, s46
    v_bitop3_b32 v47, v18, 0.5, -0.5 bitop3:0xa8
    v_cvt_pk_bf16_f32 v80, v80, v81
    v_cvt_pk_bf16_f32 v81, v82, v83
    ds_wrxchg_rtn_b64 v[74:75], v93, v[80:81] offset:65408
    v_cvt_pk_bf16_f32 v76, v76, v77
    v_cvt_pk_bf16_f32 v77, v78, v79
    ds_wrxchg_rtn_b64 v[72:73], v92, v[76:77] offset:65408
    v_and_b32 v88, 0x0fffffff, v40
    v_mov_b32 v21, v40
    buffer_load_dwordx2 v[16:17], v88, s[8:11], 0 offen
    buffer_load_dwordx3 v[18:20], v88, s[8:11], 0 offen offset:8
    s_setprio 2
    s_waitcnt lgkmcnt(2)
    v_mfma_f32_4x4x4_16b_bf16 v[80:83], v[8:9], v[106:107], 0
    v_mfma_f32_4x4x4_16b_bf16 v[76:79], v[8:9], v[104:105], 0
    v_bitop3_b32 v15, v6, v15, v46 bitop3:0xca
    v_bitop3_b32 v14, v6, v14, v47 bitop3:0xca
    s_nop 1
    v_pk_mul_f32 v[80:81], v[80:81], v[14:15] op_sel:[0,1] op_sel_hi:[1,1]
    v_pk_mul_f32 v[82:83], v[82:83], v[14:15] op_sel:[0,1] op_sel_hi:[1,1]
    v_pk_mul_f32 v[76:77], v[76:77], v[14:15] op_sel:[0,0] op_sel_hi:[1,0]
    v_pk_mul_f32 v[78:79], v[78:79], v[14:15] op_sel:[0,0] op_sel_hi:[1,0]
    v_sub_u16 v88, v58, v50
    v_and_b32 v89, 3, v50
    v_add3_u32 v99, v88, v89, 3
    v_and_b32 v99, -4, v99
    v_max_u32 v99, 4, v99
    v_and_b32 v97, 0xfffc, v50
    v_bfm_b32 v96, v88, v89
    v_add_u32_dpp v91, v99, v99 row_shr:1 row_mask:0xf bank_mask:0xf bound_ctrl:1
    v_mad_u32_u24 v97, v97, 5, v2
    v_cmp_lt_u32 vcc, 16, v99
    v_add_u32_dpp v91, v91, v91 row_shr:2 row_mask:0xf bank_mask:0xf bound_ctrl:1
    v_sub_u32 v98, s38, v99
    v_lshrrev_b64 v[50:51], 16, v[50:51]
    v_add_u32_dpp v91, v91, v91 row_shr:4 row_mask:0xf bank_mask:0xf bound_ctrl:1
    v_lshrrev_b64 v[58:59], 16, v[58:59]
    s_mov_b32 s101, 0
    v_add_u32_dpp v91, v91, v91 row_shr:8 row_mask:0xf bank_mask:0xf bound_ctrl:1
    s_nop 1
    v_add_u32_dpp v91, v91, v91 row_bcast:15 row_mask:0xa bank_mask:0xf
    s_nop 1
    v_add_u32_dpp v91, v91, v91 row_bcast:31 row_mask:0xc bank_mask:0xf
    v_add_u32 v98, v98, v91
    v_readlane_b32 s37, v91, 63
    s_cbranch_vccnz L2_xo68
L2_xp68:
    s_waitcnt lgkmcnt(0)
    v_cmp_ne_u64 s[50:51], v[72:73], v[68:69]
    v_cmpx_ne_u64 s[54:55], v[74:75], v[70:71]
    s_and_b64 s[82:83], s[54:55], s[80:81]
    s_cbranch_scc1 L2_c69
L2_d69:
    v_mov_b64 v[84:85], v[70:71]
    v_mov_b32 v7, v93
    v_mov_b64 v[86:87], v[74:75]
    s_or_b64 s[80:81], s[80:81], s[54:55]
    s_mov_b64 exec, s[50:51]
    s_and_b64 s[82:83], s[50:51], s[80:81]
    s_cbranch_scc1 L2_c70
L2_d70:
    v_mov_b64 v[84:85], v[68:69]
    v_mov_b32 v7, v92
    v_mov_b64 v[86:87], v[72:73]
    s_mov_b64 exec, -1
    s_or_b64 s[80:81], s[80:81], s[50:51]
    ds_read_b64 v[70:71], v95 offset:65408
    ds_read_b64 v[68:69], v94 offset:65408
    s_waitcnt vmcnt(11)
    v_and_b32 v46, 0x20000000, v27
    v_lshrrev_b32 v47, 14, v23
    v_bitop3_b32 v47, v47, v5, v46 bitop3:0xea
    ds_read_b64 v[102:103], v47
    v_bitop3_b32 v93, v23, v5, v46 bitop3:0xea
    v_and_b32 v46, 0x10000000, v27
    v_lshrrev_b32 v47, 14, v22
    v_bitop3_b32 v47, v47, v5, v46 bitop3:0xea
    ds_read_b64 v[100:101], v47
    v_bitop3_b32 v92, v22, v5, v46 bitop3:0xea
    s_waitcnt lgkmcnt(2)
    v_mfma_f32_4x4x4_16b_bf16 v[80:83], v[10:11], v[70:71], v[80:83]
    v_mfma_f32_4x4x4_16b_bf16 v[76:79], v[10:11], v[68:69], v[76:79]
    v_perm_b32 v15, v23, v26, s45
    v_bitop3_b32 v46, v23, 0.5, -0.5 bitop3:0xa8
    v_perm_b32 v14, v22, v26, s44
    v_bitop3_b32 v47, v22, 0.5, -0.5 bitop3:0xa8
    v_cvt_pk_bf16_f32 v80, v80, v81
    v_cvt_pk_bf16_f32 v81, v82, v83
    ds_wrxchg_rtn_b64 v[74:75], v95, v[80:81] offset:65408
    v_cvt_pk_bf16_f32 v76, v76, v77
    v_cvt_pk_bf16_f32 v77, v78, v79
    ds_wrxchg_rtn_b64 v[72:73], v94, v[76:77] offset:65408
    s_waitcnt lgkmcnt(2)
    v_mfma_f32_4x4x4_16b_bf16 v[80:83], v[8:9], v[102:103], 0
    v_mfma_f32_4x4x4_16b_bf16 v[76:79], v[8:9], v[100:101], 0
    v_bitop3_b32 v15, v6, v15, v46 bitop3:0xca
    v_bitop3_b32 v14, v6, v14, v47 bitop3:0xca
    v_cmp_lt_u32 s[84:85], v5, v92
    s_nop 0
    v_pk_mul_f32 v[80:81], v[80:81], v[14:15] op_sel:[0,1] op_sel_hi:[1,1]
    v_pk_mul_f32 v[82:83], v[82:83], v[14:15] op_sel:[0,1] op_sel_hi:[1,1]
    v_pk_mul_f32 v[76:77], v[76:77], v[14:15] op_sel:[0,0] op_sel_hi:[1,0]
    v_pk_mul_f32 v[78:79], v[78:79], v[14:15] op_sel:[0,0] op_sel_hi:[1,0]
    s_waitcnt lgkmcnt(0)
    v_cmp_ne_u64 s[50:51], v[72:73], v[68:69]
    v_cmpx_ne_u64 s[54:55], v[74:75], v[70:71]
    s_and_b64 s[82:83], s[54:55], s[80:81]
    s_cbranch_scc1 L2_c71
L2_d71:
    v_mov_b64 v[84:85], v[70:71]
    v_mov_b32 v7, v95
    v_mov_b64 v[86:87], v[74:75]
    s_or_b64 s[80:81], s[80:81], s[54:55]
    s_mov_b64 exec, s[50:51]
    s_and_b64 s[82:83], s[50:51], s[80:81]
    s_cbranch_scc1 L2_c72
L2_d72:
    v_mov_b64 v[84:85], v[68:69]
    v_mov_b32 v7, v94
    v_mov_b64 v[86:87], v[72:73]
    s_mov_b64 exec, -1
    s_or_b64 s[80:81], s[80:81], s[50:51]
    ds_read_b64 v[70:71], v93 offset:65408
    s_and_b64 exec, s[84:85], s[80:81]
    v_mfma_f32_4x4x4_16b_bf16 v[76:79], v[12:13], v[84:85], 0
    v_mov_b32 v92, v7
    s_andn2_b64 s[80:81], s[80:81], s[84:85]
    v_mfma_f32_4x4x4_16b_bf16 v[76:79], v[10:11], v[86:87], v[76:79]
    s_mov_b64 exec, -1
    ds_read_b64 v[68:69], v92 offset:65408
    v_and_b32 v46, 0x80000000, v27
    v_lshrrev_b32 v47, 14, v25
    v_bitop3_b32 v47, v47, v5, v46 bitop3:0xea
    ds_read_b64 v[106:107], v47
    v_bitop3_b32 v95, v25, v5, v46 bitop3:0xea
    v_and_b32 v46, 0x40000000, v27
    v_lshrrev_b32 v47, 14, v24
    v_bitop3_b32 v47, v47, v5, v46 bitop3:0xea
    ds_read_b64 v[104:105], v47
    v_bitop3_b32 v94, v24, v5, v46 bitop3:0xea
    s_waitcnt lgkmcnt(2)
    v_mfma_f32_4x4x4_16b_bf16 v[80:83], v[10:11], v[70:71], v[80:83]
    v_mfma_f32_4x4x4_16b_bf16 v[76:79], v[10:11], v[68:69], v[76:79]
    v_perm_b32 v15, v25, v26, s47
    v_bitop3_b32 v46, v25, 0.5, -0.5 bitop3:0xa8
    v_perm_b32 v14, v24, v26, s46
    v_bitop3_b32 v47, v24, 0.5, -0.5 bitop3:0xa8
    v_cvt_pk_bf16_f32 v80, v80, v81
    v_cvt_pk_bf16_f32 v81, v82, v83
    ds_wrxchg_rtn_b64 v[74:75], v93, v[80:81] offset:65408
    v_cvt_pk_bf16_f32 v76, v76, v77
    v_cvt_pk_bf16_f32 v77, v78, v79
    ds_wrxchg_rtn_b64 v[72:73], v92, v[76:77] offset:65408
    v_and_b32 v88, 0x0fffffff, v41
    v_mov_b32 v27, v41
    buffer_load_dwordx2 v[22:23], v88, s[8:11], 0 offen
    buffer_load_dwordx3 v[24:26], v88, s[8:11], 0 offen offset:8
    s_setprio 1
    s_waitcnt lgkmcnt(2)
    v_mfma_f32_4x4x4_16b_bf16 v[80:83], v[8:9], v[106:107], 0
    v_mfma_f32_4x4x4_16b_bf16 v[76:79], v[8:9], v[104:105], 0
    v_bitop3_b32 v15, v6, v15, v46 bitop3:0xca
    v_bitop3_b32 v14, v6, v14, v47 bitop3:0xca
    s_nop 1
    v_pk_mul_f32 v[80:81], v[80:81], v[14:15] op_sel:[0,1] op_sel_hi:[1,1]
    v_pk_mul_f32 v[82:83], v[82:83], v[14:15] op_sel:[0,1] op_sel_hi:[1,1]
    v_pk_mul_f32 v[76:77], v[76:77], v[14:15] op_sel:[0,0] op_sel_hi:[1,0]
    v_pk_mul_f32 v[78:79], v[78:79], v[14:15] op_sel:[0,0] op_sel_hi:[1,0]
    s_waitcnt lgkmcnt(0)
    v_cmp_ne_u64 s[50:51], v[72:73], v[68:69]
    v_cmpx_ne_u64 s[54:55], v[74:75], v[70:71]
    s_and_b64 s[82:83], s[54:55], s[80:81]
    s_cbranch_scc1 L2_c73
L2_d73:
    v_mov_b64 v[84:85], v[70:71]
    v_mov_b32 v7, v93
    v_mov_b64 v[86:87], v[74:75]
    s_or_b64 s[80:81], s[80:81], s[54:55]
    s_mov_b64 exec, s[50:51]
    s_and_b64 s[82:83], s[50:51], s[80:81]
    s_cbranch_scc1 L2_c74
L2_d74:
    v_mov_b64 v[84:85], v[68:69]
    v_mov_b32 v7, v92
    v_mov_b64 v[86:87], v[72:73]
    s_mov_b64 exec, -1
    s_or_b64 s[80:81], s[80:81], s[50:51]
    ds_read_b64 v[70:71], v95 offset:65408
    ds_read_b64 v[68:69], v94 offset:65408
    s_waitcnt vmcnt(11)
    v_and_b32 v46, 0x20000000, v33
    v_lshrrev_b32 v47, 14, v29
    v_bitop3_b32 v47, v47, v5, v46 bitop3:0xea
    ds_read_b64 v[102:103], v47
    v_bitop3_b32 v93, v29, v5, v46 bitop3:0xea
    v_and_b32 v46, 0x10000000, v33
    v_lshrrev_b32 v47, 14, v28
    v_bitop3_b32 v47, v47, v5, v46 bitop3:0xea
    ds_read_b64 v[100:101], v47
    v_bitop3_b32 v92, v28, v5, v46 bitop3:0xea
    s_waitcnt lgkmcnt(2)
    v_mfma_f32_4x4x4_16b_bf16 v[80:83], v[10:11], v[70:71], v[80:83]
    v_mfma_f32_4x4x4_16b_bf16 v[76:79], v[10:11], v[68:69], v[76:79]
    v_perm_b32 v15, v29, v32, s45
    v_bitop3_b32 v46, v29, 0.5, -0.5 bitop3:0xa8
    v_perm_b32 v14, v28, v32, s44
    v_bitop3_b32 v47, v28, 0.5, -0.5 bitop3:0xa8
    v_cvt_pk_bf16_f32 v80, v80, v81
    v_cvt_pk_bf16_f32 v81, v82, v83
    ds_wrxchg_rtn_b64 v[74:75], v95, v[80:81] offset:65408
    v_cvt_pk_bf16_f32 v76, v76, v77
    v_cvt_pk_bf16_f32 v77, v78, v79
    ds_wrxchg_rtn_b64 v[72:73], v94, v[76:77] offset:65408
    s_waitcnt lgkmcnt(2)
    v_mfma_f32_4x4x4_16b_bf16 v[80:83], v[8:9], v[102:103], 0
    v_mfma_f32_4x4x4_16b_bf16 v[76:79], v[8:9], v[100:101], 0
    v_bitop3_b32 v15, v6, v15, v46 bitop3:0xca
    v_bitop3_b32 v14, v6, v14, v47 bitop3:0xca
    v_cmp_lt_u32 s[84:85], v5, v92
    s_nop 0
    v_pk_mul_f32 v[80:81], v[80:81], v[14:15] op_sel:[0,1] op_sel_hi:[1,1]
    v_pk_mul_f32 v[82:83], v[82:83], v[14:15] op_sel:[0,1] op_sel_hi:[1,1]
    v_pk_mul_f32 v[76:77], v[76:77], v[14:15] op_sel:[0,0] op_sel_hi:[1,0]
    v_pk_mul_f32 v[78:79], v[78:79], v[14:15] op_sel:[0,0] op_sel_hi:[1,0]
    s_waitcnt lgkmcnt(0)
    v_cmp_ne_u64 s[50:51], v[72:73], v[68:69]
    v_cmpx_ne_u64 s[54:55], v[74:75], v[70:71]
    s_and_b64 s[82:83], s[54:55], s[80:81]
    s_cbranch_scc1 L2_c75
L2_d75:
    v_mov_b64 v[84:85], v[70:71]
    v_mov_b32 v7, v95
    v_mov_b64 v[86:87], v[74:75]
    s_or_b64 s[80:81], s[80:81], s[54:55]
    s_mov_b64 exec, s[50:51]
    s_and_b64 s[82:83], s[50:51], s[80:81]
    s_cbranch_scc1 L2_c76
L2_d76:
    v_mov_b64 v[84:85], v[68:69]
    v_mov_b32 v7, v94
    v_mov_b64 v[86:87], v[72:73]
    s_mov_b64 exec, -1
    s_or_b64 s[80:81], s[80:81], s[50:51]
    ds_read_b64 v[70:71], v93 offset:65408
    s_and_b64 exec, s[84:85], s[80:81]
    v_mfma_f32_4x4x4_16b_bf16 v[76:79], v[12:13], v[84:85], 0
    v_mov_b32 v92, v7
    s_andn2_b64 s[80:81], s[80:81], s[84:85]
    v_mfma_f32_4x4x4_16b_bf16 v[76:79], v[10:11], v[86:87], v[76:79]
    s_mov_b64 exec, -1
    ds_read_b64 v[68:69], v92 offset:65408
    v_and_b32 v46, 0x80000000, v33
    v_lshrrev_b32 v47, 14, v31
    v_bitop3_b32 v47, v47, v5, v46 bitop3:0xea
    ds_read_b64 v[106:107], v47
    v_bitop3_b32 v95, v31, v5, v46 bitop3:0xea
    v_and_b32 v46, 0x40000000, v33
    v_lshrrev_b32 v47, 14, v30
    v_bitop3_b32 v47, v47, v5, v46 bitop3:0xea
    ds_read_b64 v[104:105], v47
    v_bitop3_b32 v94, v30, v5, v46 bitop3:0xea
    s_waitcnt lgkmcnt(2)
    v_mfma_f32_4x4x4_16b_bf16 v[80:83], v[10:11], v[70:71], v[80:83]
    v_mfma_f32_4x4x4_16b_bf16 v[76:79], v[10:11], v[68:69], v[76:79]
    v_perm_b32 v15, v31, v32, s47
    v_bitop3_b32 v46, v31, 0.5, -0.5 bitop3:0xa8
    v_perm_b32 v14, v30, v32, s46
    v_bitop3_b32 v47, v30, 0.5, -0.5 bitop3:0xa8
    v_cvt_pk_bf16_f32 v80, v80, v81
    v_cvt_pk_bf16_f32 v81, v82, v83
    ds_wrxchg_rtn_b64 v[74:75], v93, v[80:81] offset:65408
    v_cvt_pk_bf16_f32 v76, v76, v77
    v_cvt_pk_bf16_f32 v77, v78, v79
    ds_wrxchg_rtn_b64 v[72:73], v92, v[76:77] offset:65408
    v_and_b32 v88, 0x0fffffff, v42
    v_mov_b32 v33, v42
    buffer_load_dwordx2 v[28:29], v88, s[8:11], 0 offen
    buffer_load_dwordx3 v[30:32], v88, s[8:11], 0 offen offset:8
    s_setprio 0
    s_waitcnt lgkmcnt(2)
    v_mfma_f32_4x4x4_16b_bf16 v[80:83], v[8:9], v[106:107], 0
    v_mfma_f32_4x4x4_16b_bf16 v[76:79], v[8:9], v[104:105], 0
    v_bitop3_b32 v15, v6, v15, v46 bitop3:0xca
    v_bitop3_b32 v14, v6, v14, v47 bitop3:0xca
    s_nop 1
    v_pk_mul_f32 v[80:81], v[80:81], v[14:15] op_sel:[0,1] op_sel_hi:[1,1]
    v_pk_mul_f32 v[82:83], v[82:83], v[14:15] op_sel:[0,1] op_sel_hi:[1,1]
    v_pk_mul_f32 v[76:77], v[76:77], v[14:15] op_sel:[0,0] op_sel_hi:[1,0]
    v_pk_mul_f32 v[78:79], v[78:79], v[14:15] op_sel:[0,0] op_sel_hi:[1,0]
    s_add_u32 s40, s40, 0x50000
    s_waitcnt lgkmcnt(0)
    v_cmp_ne_u64 s[50:51], v[72:73], v[68:69]
    v_cmpx_ne_u64 s[54:55], v[74:75], v[70:71]
    s_and_b64 s[82:83], s[54:55], s[80:81]
    s_cbranch_scc1 L2_c77
L2_d77:
    v_mov_b64 v[84:85], v[70:71]
    v_mov_b32 v7, v93
    v_mov_b64 v[86:87], v[74:75]
    s_or_b64 s[80:81], s[80:81], s[54:55]
    s_mov_b64 exec, s[50:51]
    s_and_b64 s[82:83], s[50:51], s[80:81]
    s_cbranch_scc1 L2_c78
L2_d78:
    v_mov_b64 v[84:85], v[68:69]
    v_mov_b32 v7, v92
    v_mov_b64 v[86:87], v[72:73]
    s_mov_b64 exec, -1
    s_or_b64 s[80:81], s[80:81], s[50:51]
    ds_read_b64 v[70:71], v95 offset:65408
    ds_read_b64 v[68:69], v94 offset:65408
    s_waitcnt vmcnt(8)
    v_and_b32 v46, 0x20000000, v39
    v_lshrrev_b32 v47, 14, v35
    v_bitop3_b32 v47, v47, v5, v46 bitop3:0xea
    ds_read_b64 v[102:103], v47
    v_bitop3_b32 v93, v35, v5, v46 bitop3:0xea
    v_and_b32 v46, 0x10000000, v39
    v_lshrrev_b32 v47, 14, v34
    v_bitop3_b32 v47, v47, v5, v46 bitop3:0xea
    ds_read_b64 v[100:101], v47
    v_bitop3_b32 v92, v34, v5, v46 bitop3:0xea
    v_and_b32 v46, 0x80000000, v39
    v_lshrrev_b32 v47, 14, v37
    v_bitop3_b32 v47, v47, v5, v46 bitop3:0xea
    ds_read_b64 v[106:107], v47
    v_and_b32 v46, 0x40000000, v39
    v_lshrrev_b32 v47, 14, v36
    v_bitop3_b32 v47, v47, v5, v46 bitop3:0xea
    ds_read_b64 v[104:105], v47
    s_waitcnt lgkmcnt(4)
    v_mfma_f32_4x4x4_16b_bf16 v[80:83], v[10:11], v[70:71], v[80:83]
    v_mfma_f32_4x4x4_16b_bf16 v[76:79], v[10:11], v[68:69], v[76:79]
    v_perm_b32 v15, v35, v38, s45
    v_bitop3_b32 v46, v35, 0.5, -0.5 bitop3:0xa8
    v_perm_b32 v14, v34, v38, s44
    v_bitop3_b32 v47, v34, 0.5, -0.5 bitop3:0xa8
    v_cvt_pk_bf16_f32 v80, v80, v81
    v_cvt_pk_bf16_f32 v81, v82, v83
    ds_wrxchg_rtn_b64 v[74:75], v95, v[80:81] offset:65408
    v_cvt_pk_bf16_f32 v76, v76, v77
    v_cvt_pk_bf16_f32 v77, v78, v79
    ds_wrxchg_rtn_b64 v[72:73], v94, v[76:77] offset:65408
    s_waitcnt lgkmcnt(2)
    s_barrier
    s_setprio 3
    s_mov_b32 m0, s100
    s_nop 0
    ds_write_addtid_b32 v116 offset:32768
    ds_write_addtid_b32 v117 offset:33024
    ds_write_addtid_b32 v118 offset:33280
    ds_write_addtid_b32 v119 offset:33536
    buffer_load_dwordx4 v[116:119], v3, s[16:19], s40 offen offset:2048
    ds_write_addtid_b32 v120 offset:33792
    ds_write_addtid_b32 v121 offset:34048
    ds_write_addtid_b32 v122 offset:34304
    ds_write_addtid_b32 v123 offset:34560
    buffer_load_dwordx4 v[120:123], v3, s[16:19], s40 offen offset:3072
    v_mfma_f32_4x4x4_16b_bf16 v[80:83], v[8:9], v[102:103], 0
    v_mfma_f32_4x4x4_16b_bf16 v[76:79], v[8:9], v[100:101], 0
    v_bitop3_b32 v15, v6, v15, v46 bitop3:0xca
    v_bitop3_b32 v14, v6, v14, v47 bitop3:0xca
    v_cmp_lt_u32 s[84:85], v5, v92
    s_nop 0
    v_pk_mul_f32 v[80:81], v[80:81], v[14:15] op_sel:[0,1] op_sel_hi:[1,1]
    v_pk_mul_f32 v[82:83], v[82:83], v[14:15] op_sel:[0,1] op_sel_hi:[1,1]
    v_pk_mul_f32 v[76:77], v[76:77], v[14:15] op_sel:[0,0] op_sel_hi:[1,0]
    v_pk_mul_f32 v[78:79], v[78:79], v[14:15] op_sel:[0,0] op_sel_hi:[1,0]
    v_mov_b32 v44, v43
    s_cmp_gt_u32 s37, 1024
    s_cbranch_scc1 L2_xs79
    s_cmp_lg_u32 s101, 0
    s_cbranch_scc1 L2_xa79
L2_xb79:
    v_lshlrev_b32 v89, 16, v96
    v_add_u32 v90, 60, v97
    v_bitop3_b32 v90, v89, v45, v90 bitop3:0x6a
    ds_write_b32 v98, v90 offset:12
    v_lshlrev_b32 v89, 20, v96
    v_add_u32 v90, 40, v97
    v_bitop3_b32 v90, v89, v45, v90 bitop3:0x6a
    ds_write_b32 v98, v90 offset:8
    v_lshlrev_b32 v89, 24, v96
    v_add_u32 v90, 20, v97
    v_bitop3_b32 v90, v89, v45, v90 bitop3:0x6a
    ds_write_b32 v98, v90 offset:4
    v_lshlrev_b32 v89, 28, v96
    v_bitop3_b32 v90, v89, v45, v97 bitop3:0x6a
    ds_write_b32 v98, v90 offset:0
    v_mov_b32_dpp v91, v66 quad_perm:[0,0,0,0] row_mask:0xf bank_mask:0xf
    v_and_b32 v89, 3, v91
    v_and_b32 v97, 0xfffc, v91
    v_sub_u16_dpp v88, v66, v91 quad_perm:[2,2,2,2] row_mask:0xf bank_mask:0xf
    v_mad_u32_u24 v97, v97, 5, v4
    v_add_u32 v99, v88, v89
    v_bfm_b32 v96, v88, v89
    v_cmp_lt_u32 s[58:59], 16, v99
    v_lshlrev_b32 v89, v1, v96
    v_and_b32 v89, v45, v89
    v_cmp_ne_u32 vcc, 0, v89
    v_xor_b32 v90, v97, v89
    s_add_u32 s3, s37, s38
    v_mbcnt_lo_u32_b32 v98, vcc_lo, 0
    v_mbcnt_hi_u32_b32 v98, vcc_hi, v98
    s_bcnt1_i32_b64 s41, vcc
    v_lshl_add_u32 v98, v98, 2, s3
    s_mov_b64 exec, vcc
    ds_write_b32 v98, v90
    s_mov_b64 exec, -1
    s_lshl2_add_u32 s37, s41, s37
    s_cmp_lg_u64 s[58:59], 0
    s_cbranch_scc1 L2_xe79
L2_xr79:
    v_add_u32 v98, s37, v0
    v_mov_b32 v90, -1
    ds_write_b32 v98, v90
    ds_read2st64_b32 v[40:41], v0 offset0:0 offset1:1
    ds_read2st64_b32 v[42:43], v0 offset0:2 offset1:3
    s_sub_u32 s3, s37, 768
    s_cmp_gt_u32 s3, 256
    s_cbranch_scc1 L2_xf79
L2_xg79:
    s_setprio 2
    ds_write_addtid_b32 v124 offset:34816
    ds_write_addtid_b32 v125 offset:35072
    ds_write_addtid_b32 v126 offset:35328
    ds_write_addtid_b32 v127 offset:35584
    s_add_u32 s3, s40, 4096
    buffer_load_dwordx4 v[124:127], v3, s[16:19], s3 offen
    s_waitcnt lgkmcnt(14)
    v_cmp_ne_u64 s[50:51], v[72:73], v[68:69]
    v_cmpx_ne_u64 s[54:55], v[74:75], v[70:71]
    s_and_b64 s[82:83], s[54:55], s[80:81]
    s_cbranch_scc1 L2_c80
L2_d80:
    v_mov_b64 v[84:85], v[70:71]
    v_mov_b32 v7, v95
    v_mov_b64 v[86:87], v[74:75]
    s_or_b64 s[80:81], s[80:81], s[54:55]
    s_mov_b64 exec, s[50:51]
    s_and_b64 s[82:83], s[50:51], s[80:81]
    s_cbranch_scc1 L2_c81
L2_d81:
    v_mov_b64 v[84:85], v[68:69]
    v_mov_b32 v7, v94
    v_mov_b64 v[86:87], v[72:73]
    s_mov_b64 exec, -1
    s_or_b64 s[80:81], s[80:81], s[50:51]
    ds_read_b64 v[70:71], v93 offset:65408
    s_and_b64 exec, s[84:85], s[80:81]
    v_mfma_f32_4x4x4_16b_bf16 v[76:79], v[12:13], v[84:85], 0
    v_mov_b32 v92, v7
    s_andn2_b64 s[80:81], s[80:81], s[84:85]
    v_mfma_f32_4x4x4_16b_bf16 v[76:79], v[10:11], v[86:87], v[76:79]
    s_mov_b64 exec, -1
    ds_read_b64 v[68:69], v92 offset:65408
    s_setprio 1
    s_waitcnt vmcnt(10)
    s_mov_b32 m0, s38
    s_nop 0
    ds_write_addtid_b32 v108 offset:0
    ds_write_addtid_b32 v109 offset:256
    ds_write_addtid_b32 v110 offset:512
    ds_write_addtid_b32 v111 offset:768
    s_waitcnt lgkmcnt(4)
    v_mfma_f32_4x4x4_16b_bf16 v[80:83], v[10:11], v[70:71], v[80:83]
    v_mfma_f32_4x4x4_16b_bf16 v[76:79], v[10:11], v[68:69], v[76:79]
    v_and_b32 v46, 0x40000000, v39
    v_bitop3_b32 v94, v36, v5, v46 bitop3:0xea
    v_and_b32 v46, 0x80000000, v39
    v_bitop3_b32 v95, v37, v5, v46 bitop3:0xea
    v_perm_b32 v15, v37, v38, s47
    v_bitop3_b32 v46, v37, 0.5, -0.5 bitop3:0xa8
    v_perm_b32 v14, v36, v38, s46
    v_bitop3_b32 v47, v36, 0.5, -0.5 bitop3:0xa8
    v_cvt_pk_bf16_f32 v80, v80, v81
    v_cvt_pk_bf16_f32 v81, v82, v83
    ds_wrxchg_rtn_b64 v[74:75], v93, v[80:81] offset:65408
    v_cvt_pk_bf16_f32 v76, v76, v77
    v_cvt_pk_bf16_f32 v77, v78, v79
    ds_wrxchg_rtn_b64 v[72:73], v92, v[76:77] offset:65408
    v_and_b32 v88, 0x0fffffff, v44
    v_mov_b32 v39, v44
    buffer_load_dwordx2 v[34:35], v88, s[8:11], 0 offen
    buffer_load_dwordx3 v[36:38], v88, s[8:11], 0 offen offset:8
    s_setprio 0
    s_waitcnt vmcnt(11)
    ds_write_addtid_b32 v112 offset:1024
    ds_write_addtid_b32 v113 offset:1280
    ds_write_addtid_b32 v114 offset:1536
    ds_write_addtid_b32 v115 offset:1792
    v_mfma_f32_4x4x4_16b_bf16 v[80:83], v[8:9], v[106:107], 0
    v_mfma_f32_4x4x4_16b_bf16 v[76:79], v[8:9], v[104:105], 0
    v_bitop3_b32 v15, v6, v15, v46 bitop3:0xca
    v_bitop3_b32 v14, v6, v14, v47 bitop3:0xca
    s_nop 1
    v_pk_mul_f32 v[80:81], v[80:81], v[14:15] op_sel:[0,1] op_sel_hi:[1,1]
    v_pk_mul_f32 v[82:83], v[82:83], v[14:15] op_sel:[0,1] op_sel_hi:[1,1]
    v_pk_mul_f32 v[76:77], v[76:77], v[14:15] op_sel:[0,0] op_sel_hi:[1,0]
    v_pk_mul_f32 v[78:79], v[78:79], v[14:15] op_sel:[0,0] op_sel_hi:[1,0]
    s_add_u32 s42, s42, 1
    s_waitcnt lgkmcnt(0)
    s_barrier
    s_bitcmp1_b32 s36, s42
    s_cbranch_scc1 L2_slow
L2_ret4:
    s_setprio 3
    buffer_load_dwordx4 v[108:111], v3, s[16:19], s40 offen offset:0
    v_cmp_ne_u64 s[50:51], v[72:73], v[68:69]
    v_cmpx_ne_u64 s[54:55], v[74:75], v[70:71]
    s_and_b64 s[82:83], s[54:55], s[80:81]
    s_cbranch_scc1 L2_c82
L2_d82:
    v_mov_b64 v[84:85], v[70:71]
    v_mov_b32 v7, v93
    v_mov_b64 v[86:87], v[74:75]
    s_or_b64 s[80:81], s[80:81], s[54:55]
    s_mov_b64 exec, s[50:51]
    s_and_b64 s[82:83], s[50:51], s[80:81]
    s_cbranch_scc1 L2_c83
L2_d83:
    v_mov_b64 v[84:85], v[68:69]
    v_mov_b32 v7, v92
    v_mov_b64 v[86:87], v[72:73]
    s_mov_b64 exec, -1
    s_or_b64 s[80:81], s[80:81], s[50:51]
    ds_read_b64 v[70:71], v95 offset:65408
    ds_read_b64 v[68:69], v94 offset:65408
    s_waitcnt vmcnt(10)
    v_and_b32 v46, 0x20000000, v21
    v_lshrrev_b32 v47, 14, v17
    v_bitop3_b32 v47, v47, v5, v46 bitop3:0xea
    ds_read_b64 v[102:103], v47
    v_bitop3_b32 v93, v17, v5, v46 bitop3:0xea
    v_and_b32 v46, 0x10000000, v21
    v_lshrrev_b32 v47, 14, v16
    v_bitop3_b32 v47, v47, v5, v46 bitop3:0xea
    ds_read_b64 v[100:101], v47
    v_bitop3_b32 v92, v16, v5, v46 bitop3:0xea
    s_waitcnt lgkmcnt(2)
    v_mfma_f32_4x4x4_16b_bf16 v[80:83], v[10:11], v[70:71], v[80:83]
    v_mfma_f32_4x4x4_16b_bf16 v[76:79], v[10:11], v[68:69], v[76:79]
    v_perm_b32 v15, v17, v20, s45
    v_bitop3_b32 v46, v17, 0.5, -0.5 bitop3:0xa8
    v_perm_b32 v14, v16, v20, s44
    v_bitop3_b32 v47, v16, 0.5, -0.5 bitop3:0xa8
    v_cvt_pk_bf16_f32 v80, v80, v81
    v_cvt_pk_bf16_f32 v81, v82, v83
    ds_wrxchg_rtn_b64 v[74:75], v95, v[80:81] offset:65408
    v_cvt_pk_bf16_f32 v76, v76, v77
    v_cvt_pk_bf16_f32 v77, v78, v79
    ds_wrxchg_rtn_b64 v[72:73], v94, v[76:77] offset:65408
    s_waitcnt lgkmcnt(2)
    v_mfma_f32_4x4x4_16b_bf16 v[80:83], v[8:9], v[102:103], 0
    v_mfma_f32_4x4x4_16b_bf16 v[76:79], v[8:9], v[100:101], 0
    v_bitop3_b32 v15, v6, v15, v46 bitop3:0xca
    v_bitop3_b32 v14, v6, v14, v47 bitop3:0xca
    v_cmp_lt_u32 s[84:85], v5, v92
    s_nop 0
    v_pk_mul_f32 v[80:81], v[80:81], v[14:15] op_sel:[0,1] op_sel_hi:[1,1]
    v_pk_mul_f32 v[82:83], v[82:83], v[14:15] op_sel:[0,1] op_sel_hi:[1,1]
    v_pk_mul_f32 v[76:77], v[76:77], v[14:15] op_sel:[0,0] op_sel_hi:[1,0]
    v_pk_mul_f32 v[78:79], v[78:79], v[14:15] op_sel:[0,0] op_sel_hi:[1,0]
    buffer_load_dwordx4 v[112:115], v3, s[16:19], s40 offen offset:1024
    s_waitcnt lgkmcnt(0)
    v_cmp_ne_u64 s[50:51], v[72:73], v[68:69]
    v_cmpx_ne_u64 s[54:55], v[74:75], v[70:71]
    s_and_b64 s[82:83], s[54:55], s[80:81]
    s_cbranch_scc1 L2_c84
L2_d84:
    v_mov_b64 v[84:85], v[70:71]
    v_mov_b32 v7, v95
    v_mov_b64 v[86:87], v[74:75]
    s_or_b64 s[80:81], s[80:81], s[54:55]
    s_mov_b64 exec, s[50:51]
    s_and_b64 s[82:83], s[50:51], s[80:81]
    s_cbranch_scc1 L2_c85
L2_d85:
    v_mov_b64 v[84:85], v[68:69]
    v_mov_b32 v7, v94
    v_mov_b64 v[86:87], v[72:73]
    s_mov_b64 exec, -1
    s_or_b64 s[80:81], s[80:81], s[50:51]
    ds_read_b64 v[70:71], v93 offset:65408
    s_and_b64 exec, s[84:85], s[80:81]
    v_mfma_f32_4x4x4_16b_bf16 v[76:79], v[12:13], v[84:85], 0
    v_mov_b32 v92, v7
    s_andn2_b64 s[80:81], s[80:81], s[84:85]
    v_mfma_f32_4x4x4_16b_bf16 v[76:79], v[10:11], v[86:87], v[76:79]
    s_mov_b64 exec, -1
    ds_read_b64 v[68:69], v92 offset:65408
    v_and_b32 v46, 0x80000000, v21
    v_lshrrev_b32 v47, 14, v19
    v_bitop3_b32 v47, v47, v5, v46 bitop3:0xea
    ds_read_b64 v[106:107], v47
    v_bitop3_b32 v95, v19, v5, v46 bitop3:0xea
    v_and_b32 v46, 0x40000000, v21
    v_lshrrev_b32 v47, 14, v18
    v_bitop3_b32 v47, v47, v5, v46 bitop3:0xea
    ds_read_b64 v[104:105], v47
    v_bitop3_b32 v94, v18, v5, v46 bitop3:0xea
    s_waitcnt lgkmcnt(2)
    v_mfma_f32_4x4x4_16b_bf16 v[80:83], v[10:11], v[70:71], v[80:83]
    v_mfma_f32_4x4x4_16b_bf16 v[76:79], v[10:11], v[68:69], v[76:79]
    v_perm_b32 v15, v19, v20, s47
    v_bitop3_b32 v46, v19, 0.5, -0.5 bitop3:0xa8
    v_perm_b32 v14, v18, v20, s46
    v_bitop3_b32 v47, v18, 0.5, -0.5 bitop3:0xa8
    v_cvt_pk_bf16_f32 v80, v80, v81
    v_cvt_pk_bf16_f32 v81, v82, v83
    ds_wrxchg_rtn_b64 v[74:75], v93, v[80:81] offset:65408
    v_cvt_pk_bf16_f32 v76, v76, v77
    v_cvt_pk_bf16_f32 v77, v78, v79
    ds_wrxchg_rtn_b64 v[72:73], v92, v[76:77] offset:65408
    v_and_b32 v88, 0x0fffffff, v40
    v_mov_b32 v21, v40
    buffer_load_dwordx2 v[16:17], v88, s[8:11], 0 offen
    buffer_load_dwordx3 v[18:20], v88, s[8:11], 0 offen offset:8
    s_setprio 2
    s_waitcnt lgkmcnt(2)
    v_mfma_f32_4x4x4_16b_bf16 v[80:83], v[8:9], v[106:107], 0
    v_mfma_f32_4x4x4_16b_bf16 v[76:79], v[8:9], v[104:105], 0
    v_bitop3_b32 v15, v6, v15, v46 bitop3:0xca
    v_bitop3_b32 v14, v6, v14, v47 bitop3:0xca
    s_nop 1
    v_pk_mul_f32 v[80:81], v[80:81], v[14:15] op_sel:[0,1] op_sel_hi:[1,1]
    v_pk_mul_f32 v[82:83], v[82:83], v[14:15] op_sel:[0,1] op_sel_hi:[1,1]
    v_pk_mul_f32 v[76:77], v[76:77], v[14:15] op_sel:[0,0] op_sel_hi:[1,0]
    v_pk_mul_f32 v[78:79], v[78:79], v[14:15] op_sel:[0,0] op_sel_hi:[1,0]
    v_sub_u16 v88, v60, v52
    v_and_b32 v89, 3, v52
    v_add3_u32 v99, v88, v89, 3
    v_and_b32 v99, -4, v99
    v_max_u32 v99, 4, v99
    v_and_b32 v97, 0xfffc, v52
    v_bfm_b32 v96, v88, v89
    v_add_u32_dpp v91, v99, v99 row_shr:1 row_mask:0xf bank_mask:0xf bound_ctrl:1
    v_mad_u32_u24 v97, v97, 5, v2
    v_cmp_lt_u32 vcc, 16, v99
    v_add_u32_dpp v91, v91, v91 row_shr:2 row_mask:0xf bank_mask:0xf bound_ctrl:1
    v_sub_u32 v98, s38, v99
    v_lshrrev_b64 v[52:53], 16, v[52:53]
    v_add_u32_dpp v91, v91, v91 row_shr:4 row_mask:0xf bank_mask:0xf bound_ctrl:1
    v_lshrrev_b64 v[60:61], 16, v[60:61]
    s_mov_b32 s101, 0
    v_add_u32_dpp v91, v91, v91 row_shr:8 row_mask:0xf bank_mask:0xf bound_ctrl:1
    s_nop 1
    v_add_u32_dpp v91, v91, v91 row_bcast:15 row_mask:0xa bank_mask:0xf
    s_nop 1
    v_add_u32_dpp v91, v91, v91 row_bcast:31 row_mask:0xc bank_mask:0xf
    v_add_u32 v98, v98, v91
    v_readlane_b32 s37, v91, 63
    s_cbranch_vccnz L2_xo86
L2_xp86:
    s_waitcnt lgkmcnt(0)
    v_cmp_ne_u64 s[50:51], v[72:73], v[68:69]
    v_cmpx_ne_u64 s[54:55], v[74:75], v[70:71]
    s_and_b64 s[82:83], s[54:55], s[80:81]
    s_cbranch_scc1 L2_c87
L2_d87:
    v_mov_b64 v[84:85], v[70:71]
    v_mov_b32 v7, v93
    v_mov_b64 v[86:87], v[74:75]
    s_or_b64 s[80:81], s[80:81], s[54:55]
    s_mov_b64 exec, s[50:51]
    s_and_b64 s[82:83], s[50:51], s[80:81]
    s_cbranch_scc1 L2_c88
L2_d88:
    v_mov_b64 v[84:85], v[68:69]
    v_mov_b32 v7, v92
    v_mov_b64 v[86:87], v[72:73]
    s_mov_b64 exec, -1
    s_or_b64 s[80:81], s[80:81], s[50:51]
    ds_read_b64 v[70:71], v95 offset:65408
    ds_read_b64 v[68:69], v94 offset:65408
    s_waitcnt vmcnt(11)
    v_and_b32 v46, 0x20000000, v27
    v_lshrrev_b32 v47, 14, v23
    v_bitop3_b32 v47, v47, v5, v46 bitop3:0xea
    ds_read_b64 v[102:103], v47
    v_bitop3_b32 v93, v23, v5, v46 bitop3:0xea
    v_and_b32 v46, 0x10000000, v27
    v_lshrrev_b32 v47, 14, v22
    v_bitop3_b32 v47, v47, v5, v46 bitop3:0xea
    ds_read_b64 v[100:101], v47
    v_bitop3_b32 v92, v22, v5, v46 bitop3:0xea
    s_waitcnt lgkmcnt(2)
    v_mfma_f32_4x4x4_16b_bf16 v[80:83], v[10:11], v[70:71], v[80:83]
    v_mfma_f32_4x4x4_16b_bf16 v[76:79], v[10:11], v[68:69], v[76:79]
    v_perm_b32 v15, v23, v26, s45
    v_bitop3_b32 v46, v23, 0.5, -0.5 bitop3:0xa8
    v_perm_b32 v14, v22, v26, s44
    v_bitop3_b32 v47, v22, 0.5, -0.5 bitop3:0xa8
    v_cvt_pk_bf16_f32 v80, v80, v81
    v_cvt_pk_bf16_f32 v81, v82, v83
    ds_wrxchg_rtn_b64 v[74:75], v95, v[80:81] offset:65408
    v_cvt_pk_bf16_f32 v76, v76, v77
    v_cvt_pk_bf16_f32 v77, v78, v79
    ds_wrxchg_rtn_b64 v[72:73], v94, v[76:77] offset:65408
    s_waitcnt lgkmcnt(2)
    v_mfma_f32_4x4x4_16b_bf16 v[80:83], v[8:9], v[102:103], 0
    v_mfma_f32_4x4x4_16b_bf16 v[76:79], v[8:9], v[100:101], 0
    v_bitop3_b32 v15, v6, v15, v46 bitop3:0xca
    v_bitop3_b32 v14, v6, v14, v47 bitop3:0xca
    v_cmp_lt_u32 s[84:85], v5, v92
    s_nop 0
    v_pk_mul_f32 v[80:81], v[80:81], v[14:15] op_sel:[0,1] op_sel_hi:[1,1]
    v_pk_mul_f32 v[82:83], v[82:83], v[14:15] op_sel:[0,1] op_sel_hi:[1,1]
    v_pk_mul_f32 v[76:77], v[76:77], v[14:15] op_sel:[0,0] op_sel_hi:[1,0]
    v_pk_mul_f32 v[78:79], v[78:79], v[14:15] op_sel:[0,0] op_sel_hi:[1,0]
    s_waitcnt lgkmcnt(0)
    v_cmp_ne_u64 s[50:51], v[72:73], v[68:69]
    v_cmpx_ne_u64 s[54:55], v[74:75], v[70:71]
    s_and_b64 s[82:83], s[54:55], s[80:81]
    s_cbranch_scc1 L2_c89
L2_d89:
    v_mov_b64 v[84:85], v[70:71]
    v_mov_b32 v7, v95
    v_mov_b64 v[86:87], v[74:75]
    s_or_b64 s[80:81], s[80:81], s[54:55]
    s_mov_b64 exec, s[50:51]
    s_and_b64 s[82:83], s[50:51], s[80:81]
    s_cbranch_scc1 L2_c90
L2_d90:
    v_mov_b64 v[84:85], v[68:69]
    v_mov_b32 v7, v94
    v_mov_b64 v[86:87], v[72:73]
    s_mov_b64 exec, -1
    s_or_b64 s[80:81], s[80:81], s[50:51]
    ds_read_b64 v[70:71], v93 offset:65408
    s_and_b64 exec, s[84:85], s[80:81]
    v_mfma_f32_4x4x4_16b_bf16 v[76:79], v[12:13], v[84:85], 0
    v_mov_b32 v92, v7
    s_andn2_b64 s[80:81], s[80:81], s[84:85]
    v_mfma_f32_4x4x4_16b_bf16 v[76:79], v[10:11], v[86:87], v[76:79]
    s_mov_b64 exec, -1
    ds_read_b64 v[68:69], v92 offset:65408
    v_and_b32 v46, 0x80000000, v27
    v_lshrrev_b32 v47, 14, v25
    v_bitop3_b32 v47, v47, v5, v46 bitop3:0xea
    ds_read_b64 v[106:107], v47
    v_bitop3_b32 v95, v25, v5, v46 bitop3:0xea
    v_and_b32 v46, 0x40000000, v27
    v_lshrrev_b32 v47, 14, v24
    v_bitop3_b32 v47, v47, v5, v46 bitop3:0xea
    ds_read_b64 v[104:105], v47
    v_bitop3_b32 v94, v24, v5, v46 bitop3:0xea
    s_waitcnt lgkmcnt(2)
    v_mfma_f32_4x4x4_16b_bf16 v[80:83], v[10:11], v[70:71], v[80:83]
    v_mfma_f32_4x4x4_16b_bf16 v[76:79], v[10:11], v[68:69], v[76:79]
    v_perm_b32 v15, v25, v26, s47
    v_bitop3_b32 v46, v25, 0.5, -0.5 bitop3:0xa8
    v_perm_b32 v14, v24, v26, s46
    v_bitop3_b32 v47, v24, 0.5, -0.5 bitop3:0xa8
    v_cvt_pk_bf16_f32 v80, v80, v81
    v_cvt_pk_bf16_f32 v81, v82, v83
    ds_wrxchg_rtn_b64 v[74:75], v93, v[80:81] offset:65408
    v_cvt_pk_bf16_f32 v76, v76, v77
    v_cvt_pk_bf16_f32 v77, v78, v79
    ds_wrxchg_rtn_b64 v[72:73], v92, v[76:77] offset:65408
    v_and_b32 v88, 0x0fffffff, v41
    v_mov_b32 v27, v41
    buffer_load_dwordx2 v[22:23], v88, s[8:11], 0 offen
    buffer_load_dwordx3 v[24:26], v88, s[8:11], 0 offen offset:8
    s_setprio 1
    s_waitcnt lgkmcnt(2)
    v_mfma_f32_4x4x4_16b_bf16 v[80:83], v[8:9], v[106:107], 0
    v_mfma_f32_4x4x4_16b_bf16 v[76:79], v[8:9], v[104:105], 0
    v_bitop3_b32 v15, v6, v15, v46 bitop3:0xca
    v_bitop3_b32 v14, v6, v14, v47 bitop3:0xca
    s_nop 1
    v_pk_mul_f32 v[80:81], v[80:81], v[14:15] op_sel:[0,1] op_sel_hi:[1,1]
    v_pk_mul_f32 v[82:83], v[82:83], v[14:15] op_sel:[0,1] op_sel_hi:[1,1]
    v_pk_mul_f32 v[76:77], v[76:77], v[14:15] op_sel:[0,0] op_sel_hi:[1,0]
    v_pk_mul_f32 v[78:79], v[78:79], v[14:15] op_sel:[0,0] op_sel_hi:[1,0]
    s_waitcnt lgkmcnt(0)
    v_cmp_ne_u64 s[50:51], v[72:73], v[68:69]
    v_cmpx_ne_u64 s[54:55], v[74:75], v[70:71]
    s_and_b64 s[82:83], s[54:55], s[80:81]
    s_cbranch_scc1 L2_c91
L2_d91:
    v_mov_b64 v[84:85], v[70:71]
    v_mov_b32 v7, v93
    v_mov_b64 v[86:87], v[74:75]
    s_or_b64 s[80:81], s[80:81], s[54:55]
    s_mov_b64 exec, s[50:51]
    s_and_b64 s[82:83], s[50:51], s[80:81]
    s_cbranch_scc1 L2_c92
L2_d92:
    v_mov_b64 v[84:85], v[68:69]
    v_mov_b32 v7, v92
    v_mov_b64 v[86:87], v[72:73]
    s_mov_b64 exec, -1
    s_or_b64 s[80:81], s[80:81], s[50:51]
    ds_read_b64 v[70:71], v95 offset:65408
    ds_read_b64 v[68:69], v94 offset:65408
    s_waitcnt vmcnt(11)
    v_and_b32 v46, 0x20000000, v33
    v_lshrrev_b32 v47, 14, v29
    v_bitop3_b32 v47, v47, v5, v46 bitop3:0xea
    ds_read_b64 v[102:103], v47
    v_bitop3_b32 v93, v29, v5, v46 bitop3:0xea
    v_and_b32 v46, 0x10000000, v33
    v_lshrrev_b32 v47, 14, v28
    v_bitop3_b32 v47, v47, v5, v46 bitop3:0xea
    ds_read_b64 v[100:101], v47
    v_bitop3_b32 v92, v28, v5, v46 bitop3:0xea
    s_waitcnt lgkmcnt(2)
    v_mfma_f32_4x4x4_16b_bf16 v[80:83], v[10:11], v[70:71], v[80:83]
    v_mfma_f32_4x4x4_16b_bf16 v[76:79], v[10:11], v[68:69], v[76:79]
    v_perm_b32 v15, v29, v32, s45
    v_bitop3_b32 v46, v29, 0.5, -0.5 bitop3:0xa8
    v_perm_b32 v14, v28, v32, s44
    v_bitop3_b32 v47, v28, 0.5, -0.5 bitop3:0xa8
    v_cvt_pk_bf16_f32 v80, v80, v81
    v_cvt_pk_bf16_f32 v81, v82, v83
    ds_wrxchg_rtn_b64 v[74:75], v95, v[80:81] offset:65408
    v_cvt_pk_bf16_f32 v76, v76, v77
    v_cvt_pk_bf16_f32 v77, v78, v79
    ds_wrxchg_rtn_b64 v[72:73], v94, v[76:77] offset:65408
    s_waitcnt lgkmcnt(2)
    v_mfma_f32_4x4x4_16b_bf16 v[80:83], v[8:9], v[102:103], 0
    v_mfma_f32_4x4x4_16b_bf16 v[76:79], v[8:9], v[100:101], 0
    v_bitop3_b32 v15, v6, v15, v46 bitop3:0xca
    v_bitop3_b32 v14, v6, v14, v47 bitop3:0xca
    v_cmp_lt_u32 s[84:85], v5, v92
    s_nop 0
    v_pk_mul_f32 v[80:81], v[80:81], v[14:15] op_sel:[0,1] op_sel_hi:[1,1]
    v_pk_mul_f32 v[82:83], v[82:83], v[14:15] op_sel:[0,1] op_sel_hi:[1,1]
    v_pk_mul_f32 v[76:77], v[76:77], v[14:15] op_sel:[0,0] op_sel_hi:[1,0]
    v_pk_mul_f32 v[78:79], v[78:79], v[14:15] op_sel:[0,0] op_sel_hi:[1,0]
    s_waitcnt lgkmcnt(0)
    v_cmp_ne_u64 s[50:51], v[72:73], v[68:69]
    v_cmpx_ne_u64 s[54:55], v[74:75], v[70:71]
    s_and_b64 s[82:83], s[54:55], s[80:81]
    s_cbranch_scc1 L2_c93
L2_d93:
    v_mov_b64 v[84:85], v[70:71]
    v_mov_b32 v7, v95
    v_mov_b64 v[86:87], v[74:75]
    s_or_b64 s[80:81], s[80:81], s[54:55]
    s_mov_b64 exec, s[50:51]
    s_and_b64 s[82:83], s[50:51], s[80:81]
    s_cbranch_scc1 L2_c94
L2_d94:
    v_mov_b64 v[84:85], v[68:69]
    v_mov_b32 v7, v94
    v_mov_b64 v[86:87], v[72:73]
    s_mov_b64 exec, -1
    s_or_b64 s[80:81], s[80:81], s[50:51]
    ds_read_b64 v[70:71], v93 offset:65408
    s_and_b64 exec, s[84:85], s[80:81]
    v_mfma_f32_4x4x4_16b_bf16 v[76:79], v[12:13], v[84:85], 0
    v_mov_b32 v92, v7
    s_andn2_b64 s[80:81], s[80:81], s[84:85]
    v_mfma_f32_4x4x4_16b_bf16 v[76:79], v[10:11], v[86:87], v[76:79]
    s_mov_b64 exec, -1
    ds_read_b64 v[68:69], v92 offset:65408
    v_and_b32 v46, 0x80000000, v33
    v_lshrrev_b32 v47, 14, v31
    v_bitop3_b32 v47, v47, v5, v46 bitop3:0xea
    ds_read_b64 v[106:107], v47
    v_bitop3_b32 v95, v31, v5, v46 bitop3:0xea
    v_and_b32 v46, 0x40000000, v33
    v_lshrrev_b32 v47, 14, v30
    v_bitop3_b32 v47, v47, v5, v46 bitop3:0xea
    ds_read_b64 v[104:105], v47
    v_bitop3_b32 v94, v30, v5, v46 bitop3:0xea
    s_waitcnt lgkmcnt(2)
    v_mfma_f32_4x4x4_16b_bf16 v[80:83], v[10:11], v[70:71], v[80:83]
    v_mfma_f32_4x4x4_16b_bf16 v[76:79], v[10:11], v[68:69], v[76:79]
    v_perm_b32 v15, v31, v32, s47
    v_bitop3_b32 v46, v31, 0.5, -0.5 bitop3:0xa8
    v_perm_b32 v14, v30, v32, s46
    v_bitop3_b32 v47, v30, 0.5, -0.5 bitop3:0xa8
    v_cvt_pk_bf16_f32 v80, v80, v81
    v_cvt_pk_bf16_f32 v81, v82, v83
    ds_wrxchg_rtn_b64 v[74:75], v93, v[80:81] offset:65408
    v_cvt_pk_bf16_f32 v76, v76, v77
    v_cvt_pk_bf16_f32 v77, v78, v79
    ds_wrxchg_rtn_b64 v[72:73], v92, v[76:77] offset:65408
    v_and_b32 v88, 0x0fffffff, v42
    v_mov_b32 v33, v42
    buffer_load_dwordx2 v[28:29], v88, s[8:11], 0 offen
    buffer_load_dwordx3 v[30:32], v88, s[8:11], 0 offen offset:8
    s_setprio 0
    s_waitcnt lgkmcnt(2)
    v_mfma_f32_4x4x4_16b_bf16 v[80:83], v[8:9], v[106:107], 0
    v_mfma_f32_4x4x4_16b_bf16 v[76:79], v[8:9], v[104:105], 0
    v_bitop3_b32 v15, v6, v15, v46 bitop3:0xca
    v_bitop3_b32 v14, v6, v14, v47 bitop3:0xca
    s_nop 1
    v_pk_mul_f32 v[80:81], v[80:81], v[14:15] op_sel:[0,1] op_sel_hi:[1,1]
    v_pk_mul_f32 v[82:83], v[82:83], v[14:15] op_sel:[0,1] op_sel_hi:[1,1]
    v_pk_mul_f32 v[76:77], v[76:77], v[14:15] op_sel:[0,0] op_sel_hi:[1,0]
    v_pk_mul_f32 v[78:79], v[78:79], v[14:15] op_sel:[0,0] op_sel_hi:[1,0]
    s_add_u32 s40, s40, 0x50000
    s_waitcnt lgkmcnt(0)
    v_cmp_ne_u64 s[50:51], v[72:73], v[68:69]
    v_cmpx_ne_u64 s[54:55], v[74:75], v[70:71]
    s_and_b64 s[82:83], s[54:55], s[80:81]
    s_cbranch_scc1 L2_c95
L2_d95:
    v_mov_b64 v[84:85], v[70:71]
    v_mov_b32 v7, v93
    v_mov_b64 v[86:87], v[74:75]
    s_or_b64 s[80:81], s[80:81], s[54:55]
    s_mov_b64 exec, s[50:51]
    s_and_b64 s[82:83], s[50:51], s[80:81]
    s_cbranch_scc1 L2_c96
L2_d96:
    v_mov_b64 v[84:85], v[68:69]
    v_mov_b32 v7, v92
    v_mov_b64 v[86:87], v[72:73]
    s_mov_b64 exec, -1
    s_or_b64 s[80:81], s[80:81], s[50:51]
    ds_read_b64 v[70:71], v95 offset:65408
    ds_read_b64 v[68:69], v94 offset:65408
    s_waitcnt vmcnt(8)
    v_and_b32 v46, 0x20000000, v39
    v_lshrrev_b32 v47, 14, v35
    v_bitop3_b32 v47, v47, v5, v46 bitop3:0xea
    ds_read_b64 v[102:103], v47
    v_bitop3_b32 v93, v35, v5, v46 bitop3:0xea
    v_and_b32 v46, 0x10000000, v39
    v_lshrrev_b32 v47, 14, v34
    v_bitop3_b32 v47, v47, v5, v46 bitop3:0xea
    ds_read_b64 v[100:101], v47
    v_bitop3_b32 v92, v34, v5, v46 bitop3:0xea
    v_and_b32 v46, 0x80000000, v39
    v_lshrrev_b32 v47, 14, v37
    v_bitop3_b32 v47, v47, v5, v46 bitop3:0xea
    ds_read_b64 v[106:107], v47
    v_and_b32 v46, 0x40000000, v39
    v_lshrrev_b32 v47, 14, v36
    v_bitop3_b32 v47, v47, v5, v46 bitop3:0xea
    ds_read_b64 v[104:105], v47
    s_waitcnt lgkmcnt(4)
    v_mfma_f32_4x4x4_16b_bf16 v[80:83], v[10:11], v[70:71], v[80:83]
    v_mfma_f32_4x4x4_16b_bf16 v[76:79], v[10:11], v[68:69], v[76:79]
    v_perm_b32 v15, v35, v38, s45
    v_bitop3_b32 v46, v35, 0.5, -0.5 bitop3:0xa8
    v_perm_b32 v14, v34, v38, s44
    v_bitop3_b32 v47, v34, 0.5, -0.5 bitop3:0xa8
    v_cvt_pk_bf16_f32 v80, v80, v81
    v_cvt_pk_bf16_f32 v81, v82, v83
    ds_wrxchg_rtn_b64 v[74:75], v95, v[80:81] offset:65408
    v_cvt_pk_bf16_f32 v76, v76, v77
    v_cvt_pk_bf16_f32 v77, v78, v79
    ds_wrxchg_rtn_b64 v[72:73], v94, v[76:77] offset:65408
    s_waitcnt lgkmcnt(2)
    s_barrier
    s_setprio 3
    s_mov_b32 m0, s100
    s_nop 0
    ds_write_addtid_b32 v116 offset:32768
    ds_write_addtid_b32 v117 offset:33024
    ds_write_addtid_b32 v118 offset:33280
    ds_write_addtid_b32 v119 offset:33536
    buffer_load_dwordx4 v[116:119], v3, s[16:19], s40 offen offset:2048
    ds_write_addtid_b32 v120 offset:33792
    ds_write_addtid_b32 v121 offset:34048
    ds_write_addtid_b32 v122 offset:34304
    ds_write_addtid_b32 v123 offset:34560
    buffer_load_dwordx4 v[120:123], v3, s[16:19], s40 offen offset:3072
    v_mfma_f32_4x4x4_16b_bf16 v[80:83], v[8:9], v[102:103], 0
    v_mfma_f32_4x4x4_16b_bf16 v[76:79], v[8:9], v[100:101], 0
    v_bitop3_b32 v15, v6, v15, v46 bitop3:0xca
    v_bitop3_b32 v14, v6, v14, v47 bitop3:0xca
    v_cmp_lt_u32 s[84:85], v5, v92
    s_nop 0
    v_pk_mul_f32 v[80:81], v[80:81], v[14:15] op_sel:[0,1] op_sel_hi:[1,1]
    v_pk_mul_f32 v[82:83], v[82:83], v[14:15] op_sel:[0,1] op_sel_hi:[1,1]
    v_pk_mul_f32 v[76:77], v[76:77], v[14:15] op_sel:[0,0] op_sel_hi:[1,0]
    v_pk_mul_f32 v[78:79], v[78:79], v[14:15] op_sel:[0,0] op_sel_hi:[1,0]
    v_mov_b32 v44, v43
    s_cmp_gt_u32 s37, 1024
    s_cbranch_scc1 L2_xs97
    s_cmp_lg_u32 s101, 0
    s_cbranch_scc1 L2_xa97
L2_xb97:
    v_lshlrev_b32 v89, 16, v96
    v_add_u32 v90, 60, v97
    v_bitop3_b32 v90, v89, v45, v90 bitop3:0x6a
    ds_write_b32 v98, v90 offset:12
    v_lshlrev_b32 v89, 20, v96
    v_add_u32 v90, 40, v97
    v_bitop3_b32 v90, v89, v45, v90 bitop3:0x6a
    ds_write_b32 v98, v90 offset:8
    v_lshlrev_b32 v89, 24, v96
    v_add_u32 v90, 20, v97
    v_bitop3_b32 v90, v89, v45, v90 bitop3:0x6a
    ds_write_b32 v98, v90 offset:4
    v_lshlrev_b32 v89, 28, v96
    v_bitop3_b32 v90, v89, v45, v97 bitop3:0x6a
    ds_write_b32 v98, v90 offset:0
    v_mov_b32_dpp v91, v64 quad_perm:[1,1,1,1] row_mask:0xf bank_mask:0xf
    v_and_b32 v89, 3, v91
    v_and_b32 v97, 0xfffc, v91
    v_sub_u16_dpp v88, v64, v91 quad_perm:[3,3,3,3] row_mask:0xf bank_mask:0xf
    v_mad_u32_u24 v97, v97, 5, v4
    v_add_u32 v99, v88, v89
    v_bfm_b32 v96, v88, v89
    v_cmp_lt_u32 s[58:59], 16, v99
    v_lshlrev_b32 v89, v1, v96
    v_and_b32 v89, v45, v89
    v_cmp_ne_u32 vcc, 0, v89
    v_xor_b32 v90, v97, v89
    s_add_u32 s3, s37, s38
    v_mbcnt_lo_u32_b32 v98, vcc_lo, 0
    v_mbcnt_hi_u32_b32 v98, vcc_hi, v98
    s_bcnt1_i32_b64 s41, vcc
    v_lshl_add_u32 v98, v98, 2, s3
    s_mov_b64 exec, vcc
    ds_write_b32 v98, v90
    s_mov_b64 exec, -1
    s_lshl2_add_u32 s37, s41, s37
    s_cmp_lg_u64 s[58:59], 0
    s_cbranch_scc1 L2_xe97
L2_xr97:
    v_add_u32 v98, s37, v0
    v_mov_b32 v90, -1
    ds_write_b32 v98, v90
    ds_read2st64_b32 v[40:41], v0 offset0:0 offset1:1
    ds_read2st64_b32 v[42:43], v0 offset0:2 offset1:3
    s_sub_u32 s3, s37, 768
    s_cmp_gt_u32 s3, 256
    s_cbranch_scc1 L2_xf97
L2_xg97:
    s_setprio 2
    ds_write_addtid_b32 v124 offset:34816
    ds_write_addtid_b32 v125 offset:35072
    ds_write_addtid_b32 v126 offset:35328
    ds_write_addtid_b32 v127 offset:35584
    s_add_u32 s3, s40, 4096
    buffer_load_dwordx4 v[124:127], v3, s[16:19], s3 offen
    s_waitcnt lgkmcnt(14)
    v_cmp_ne_u64 s[50:51], v[72:73], v[68:69]
    v_cmpx_ne_u64 s[54:55], v[74:75], v[70:71]
    s_and_b64 s[82:83], s[54:55], s[80:81]
    s_cbranch_scc1 L2_c98
L2_d98:
    v_mov_b64 v[84:85], v[70:71]
    v_mov_b32 v7, v95
    v_mov_b64 v[86:87], v[74:75]
    s_or_b64 s[80:81], s[80:81], s[54:55]
    s_mov_b64 exec, s[50:51]
    s_and_b64 s[82:83], s[50:51], s[80:81]
    s_cbranch_scc1 L2_c99
L2_d99:
    v_mov_b64 v[84:85], v[68:69]
    v_mov_b32 v7, v94
    v_mov_b64 v[86:87], v[72:73]
    s_mov_b64 exec, -1
    s_or_b64 s[80:81], s[80:81], s[50:51]
    ds_read_b64 v[70:71], v93 offset:65408
    s_and_b64 exec, s[84:85], s[80:81]
    v_mfma_f32_4x4x4_16b_bf16 v[76:79], v[12:13], v[84:85], 0
    v_mov_b32 v92, v7
    s_andn2_b64 s[80:81], s[80:81], s[84:85]
    v_mfma_f32_4x4x4_16b_bf16 v[76:79], v[10:11], v[86:87], v[76:79]
    s_mov_b64 exec, -1
    ds_read_b64 v[68:69], v92 offset:65408
    s_setprio 1
    s_waitcnt vmcnt(10)
    s_mov_b32 m0, s38
    s_nop 0
    ds_write_addtid_b32 v108 offset:0
    ds_write_addtid_b32 v109 offset:256
    ds_write_addtid_b32 v110 offset:512
    ds_write_addtid_b32 v111 offset:768
    s_waitcnt lgkmcnt(4)
    v_mfma_f32_4x4x4_16b_bf16 v[80:83], v[10:11], v[70:71], v[80:83]
    v_mfma_f32_4x4x4_16b_bf16 v[76:79], v[10:11], v[68:69], v[76:79]
    v_and_b32 v46, 0x40000000, v39
    v_bitop3_b32 v94, v36, v5, v46 bitop3:0xea
    v_and_b32 v46, 0x80000000, v39
    v_bitop3_b32 v95, v37, v5, v46 bitop3:0xea
    v_perm_b32 v15, v37, v38, s47
    v_bitop3_b32 v46, v37, 0.5, -0.5 bitop3:0xa8
    v_perm_b32 v14, v36, v38, s46
    v_bitop3_b32 v47, v36, 0.5, -0.5 bitop3:0xa8
    v_cvt_pk_bf16_f32 v80, v80, v81
    v_cvt_pk_bf16_f32 v81, v82, v83
    ds_wrxchg_rtn_b64 v[74:75], v93, v[80:81] offset:65408
    v_cvt_pk_bf16_f32 v76, v76, v77
    v_cvt_pk_bf16_f32 v77, v78, v79
    ds_wrxchg_rtn_b64 v[72:73], v92, v[76:77] offset:65408
    v_and_b32 v88, 0x0fffffff, v44
    v_mov_b32 v39, v44
    buffer_load_dwordx2 v[34:35], v88, s[8:11], 0 offen
    buffer_load_dwordx3 v[36:38], v88, s[8:11], 0 offen offset:8
    s_setprio 0
    s_waitcnt vmcnt(11)
    ds_write_addtid_b32 v112 offset:1024
    ds_write_addtid_b32 v113 offset:1280
    ds_write_addtid_b32 v114 offset:1536
    ds_write_addtid_b32 v115 offset:1792
    v_mfma_f32_4x4x4_16b_bf16 v[80:83], v[8:9], v[106:107], 0
    v_mfma_f32_4x4x4_16b_bf16 v[76:79], v[8:9], v[104:105], 0
    v_bitop3_b32 v15, v6, v15, v46 bitop3:0xca
    v_bitop3_b32 v14, v6, v14, v47 bitop3:0xca
    s_nop 1
    v_pk_mul_f32 v[80:81], v[80:81], v[14:15] op_sel:[0,1] op_sel_hi:[1,1]
    v_pk_mul_f32 v[82:83], v[82:83], v[14:15] op_sel:[0,1] op_sel_hi:[1,1]
    v_pk_mul_f32 v[76:77], v[76:77], v[14:15] op_sel:[0,0] op_sel_hi:[1,0]
    v_pk_mul_f32 v[78:79], v[78:79], v[14:15] op_sel:[0,0] op_sel_hi:[1,0]
    s_add_u32 s42, s42, 1
    s_waitcnt lgkmcnt(0)
    s_barrier
    s_bitcmp1_b32 s36, s42
    s_cbranch_scc1 L2_slow
L2_ret5:
    s_setprio 3
    buffer_load_dwordx4 v[108:111], v3, s[16:19], s40 offen offset:0
    v_cmp_ne_u64 s[50:51], v[72:73], v[68:69]
    v_cmpx_ne_u64 s[54:55], v[74:75], v[70:71]
    s_and_b64 s[82:83], s[54:55], s[80:81]
    s_cbranch_scc1 L2_c100
L2_d100:
    v_mov_b64 v[84:85], v[70:71]
    v_mov_b32 v7, v93
    v_mov_b64 v[86:87], v[74:75]
    s_or_b64 s[80:81], s[80:81], s[54:55]
    s_mov_b64 exec, s[50:51]
    s_and_b64 s[82:83], s[50:51], s[80:81]
    s_cbranch_scc1 L2_c101
L2_d101:
    v_mov_b64 v[84:85], v[68:69]
    v_mov_b32 v7, v92
    v_mov_b64 v[86:87], v[72:73]
    s_mov_b64 exec, -1
    s_or_b64 s[80:81], s[80:81], s[50:51]
    ds_read_b64 v[70:71], v95 offset:65408
    ds_read_b64 v[68:69], v94 offset:65408
    s_waitcnt vmcnt(10)
    v_and_b32 v46, 0x20000000, v21
    v_lshrrev_b32 v47, 14, v17
    v_bitop3_b32 v47, v47, v5, v46 bitop3:0xea
    ds_read_b64 v[102:103], v47
    v_bitop3_b32 v93, v17, v5, v46 bitop3:0xea
    v_and_b32 v46, 0x10000000, v21
    v_lshrrev_b32 v47, 14, v16
    v_bitop3_b32 v47, v47, v5, v46 bitop3:0xea
    ds_read_b64 v[100:101], v47
    v_bitop3_b32 v92, v16, v5, v46 bitop3:0xea
    s_waitcnt lgkmcnt(2)
    v_mfma_f32_4x4x4_16b_bf16 v[80:83], v[10:11], v[70:71], v[80:83]
    v_mfma_f32_4x4x4_16b_bf16 v[76:79], v[10:11], v[68:69], v[76:79]
    v_perm_b32 v15, v17, v20, s45
    v_bitop3_b32 v46, v17, 0.5, -0.5 bitop3:0xa8
    v_perm_b32 v14, v16, v20, s44
    v_bitop3_b32 v47, v16, 0.5, -0.5 bitop3:0xa8
    v_cvt_pk_bf16_f32 v80, v80, v81
    v_cvt_pk_bf16_f32 v81, v82, v83
    ds_wrxchg_rtn_b64 v[74:75], v95, v[80:81] offset:65408
    v_cvt_pk_bf16_f32 v76, v76, v77
    v_cvt_pk_bf16_f32 v77, v78, v79
    ds_wrxchg_rtn_b64 v[72:73], v94, v[76:77] offset:65408
    s_waitcnt lgkmcnt(2)
    v_mfma_f32_4x4x4_16b_bf16 v[80:83], v[8:9], v[102:103], 0
    v_mfma_f32_4x4x4_16b_bf16 v[76:79], v[8:9], v[100:101], 0
    v_bitop3_b32 v15, v6, v15, v46 bitop3:0xca
    v_bitop3_b32 v14, v6, v14, v47 bitop3:0xca
    v_cmp_lt_u32 s[84:85], v5, v92
    s_nop 0
    v_pk_mul_f32 v[80:81], v[80:81], v[14:15] op_sel:[0,1] op_sel_hi:[1,1]
    v_pk_mul_f32 v[82:83], v[82:83], v[14:15] op_sel:[0,1] op_sel_hi:[1,1]
    v_pk_mul_f32 v[76:77], v[76:77], v[14:15] op_sel:[0,0] op_sel_hi:[1,0]
    v_pk_mul_f32 v[78:79], v[78:79], v[14:15] op_sel:[0,0] op_sel_hi:[1,0]
    buffer_load_dwordx4 v[112:115], v3, s[16:19], s40 offen offset:1024
    s_waitcnt lgkmcnt(0)
    v_cmp_ne_u64 s[50:51], v[72:73], v[68:69]
    v_cmpx_ne_u64 s[54:55], v[74:75], v[70:71]
    s_and_b64 s[82:83], s[54:55], s[80:81]
    s_cbranch_scc1 L2_c102
L2_d102:
    v_mov_b64 v[84:85], v[70:71]
    v_mov_b32 v7, v95
    v_mov_b64 v[86:87], v[74:75]
    s_or_b64 s[80:81], s[80:81], s[54:55]
    s_mov_b64 exec, s[50:51]
    s_and_b64 s[82:83], s[50:51], s[80:81]
    s_cbranch_scc1 L2_c103
L2_d103:
    v_mov_b64 v[84:85], v[68:69]
    v_mov_b32 v7, v94
    v_mov_b64 v[86:87], v[72:73]
    s_mov_b64 exec, -1
    s_or_b64 s[80:81], s[80:81], s[50:51]
    ds_read_b64 v[70:71], v93 offset:65408
    s_and_b64 exec, s[84:85], s[80:81]
    v_mfma_f32_4x4x4_16b_bf16 v[76:79], v[12:13], v[84:85], 0
    v_mov_b32 v92, v7
    s_andn2_b64 s[80:81], s[80:81], s[84:85]
    v_mfma_f32_4x4x4_16b_bf16 v[76:79], v[10:11], v[86:87], v[76:79]
    s_mov_b64 exec, -1
    ds_read_b64 v[68:69], v92 offset:65408
    v_and_b32 v46, 0x80000000, v21
    v_lshrrev_b32 v47, 14, v19
    v_bitop3_b32 v47, v47, v5, v46 bitop3:0xea
    ds_read_b64 v[106:107], v47
    v_bitop3_b32 v95, v19, v5, v46 bitop3:0xea
    v_and_b32 v46, 0x40000000, v21
    v_lshrrev_b32 v47, 14, v18
    v_bitop3_b32 v47, v47, v5, v46 bitop3:0xea
    ds_read_b64 v[104:105], v47
    v_bitop3_b32 v94, v18, v5, v46 bitop3:0xea
    s_waitcnt lgkmcnt(2)
    v_mfma_f32_4x4x4_16b_bf16 v[80:83], v[10:11], v[70:71], v[80:83]
    v_mfma_f32_4x4x4_16b_bf16 v[76:79], v[10:11], v[68:69], v[76:79]
    v_perm_b32 v15, v19, v20, s47
    v_bitop3_b32 v46, v19, 0.5, -0.5 bitop3:0xa8
    v_perm_b32 v14, v18, v20, s46
    v_bitop3_b32 v47, v18, 0.5, -0.5 bitop3:0xa8
    v_cvt_pk_bf16_f32 v80, v80, v81
    v_cvt_pk_bf16_f32 v81, v82, v83
    ds_wrxchg_rtn_b64 v[74:75], v93, v[80:81] offset:65408
    v_cvt_pk_bf16_f32 v76, v76, v77
    v_cvt_pk_bf16_f32 v77, v78, v79
    ds_wrxchg_rtn_b64 v[72:73], v92, v[76:77] offset:65408
    v_and_b32 v88, 0x0fffffff, v40
    v_mov_b32 v21, v40
    buffer_load_dwordx2 v[16:17], v88, s[8:11], 0 offen
    buffer_load_dwordx3 v[18:20], v88, s[8:11], 0 offen offset:8
    s_setprio 2
    s_waitcnt lgkmcnt(2)
    v_mfma_f32_4x4x4_16b_bf16 v[80:83], v[8:9], v[106:107], 0
    v_mfma_f32_4x4x4_16b_bf16 v[76:79], v[8:9], v[104:105], 0
    v_bitop3_b32 v15, v6, v15, v46 bitop3:0xca
    v_bitop3_b32 v14, v6, v14, v47 bitop3:0xca
    s_nop 1
    v_pk_mul_f32 v[80:81], v[80:81], v[14:15] op_sel:[0,1] op_sel_hi:[1,1]
    v_pk_mul_f32 v[82:83], v[82:83], v[14:15] op_sel:[0,1] op_sel_hi:[1,1]
    v_pk_mul_f32 v[76:77], v[76:77], v[14:15] op_sel:[0,0] op_sel_hi:[1,0]
    v_pk_mul_f32 v[78:79], v[78:79], v[14:15] op_sel:[0,0] op_sel_hi:[1,0]
    v_sub_u16 v88, v62, v54
    v_and_b32 v89, 3, v54
    v_add3_u32 v99, v88, v89, 3
    v_and_b32 v99, -4, v99
    v_max_u32 v99, 4, v99
    v_and_b32 v97, 0xfffc, v54
    v_bfm_b32 v96, v88, v89
    v_add_u32_dpp v91, v99, v99 row_shr:1 row_mask:0xf bank_mask:0xf bound_ctrl:1
    v_mad_u32_u24 v97, v97, 5, v2
    v_cmp_lt_u32 vcc, 16, v99
    v_add_u32_dpp v91, v91, v91 row_shr:2 row_mask:0xf bank_mask:0xf bound_ctrl:1
    v_sub_u32 v98, s38, v99
    v_lshrrev_b64 v[54:55], 16, v[54:55]
    v_add_u32_dpp v91, v91, v91 row_shr:4 row_mask:0xf bank_mask:0xf bound_ctrl:1
    v_lshrrev_b64 v[62:63], 16, v[62:63]
    s_mov_b32 s101, 0
    v_add_u32_dpp v91, v91, v91 row_shr:8 row_mask:0xf bank_mask:0xf bound_ctrl:1
    s_nop 1
    v_add_u32_dpp v91, v91, v91 row_bcast:15 row_mask:0xa bank_mask:0xf
    s_nop 1
    v_add_u32_dpp v91, v91, v91 row_bcast:31 row_mask:0xc bank_mask:0xf
    v_add_u32 v98, v98, v91
    v_readlane_b32 s37, v91, 63
    s_cbranch_vccnz L2_xo104
L2_xp104:
    s_waitcnt lgkmcnt(0)
    v_cmp_ne_u64 s[50:51], v[72:73], v[68:69]
    v_cmpx_ne_u64 s[54:55], v[74:75], v[70:71]
    s_and_b64 s[82:83], s[54:55], s[80:81]
    s_cbranch_scc1 L2_c105
L2_d105:
    v_mov_b64 v[84:85], v[70:71]
    v_mov_b32 v7, v93
    v_mov_b64 v[86:87], v[74:75]
    s_or_b64 s[80:81], s[80:81], s[54:55]
    s_mov_b64 exec, s[50:51]
    s_and_b64 s[82:83], s[50:51], s[80:81]
    s_cbranch_scc1 L2_c106
L2_d106:
    v_mov_b64 v[84:85], v[68:69]
    v_mov_b32 v7, v92
    v_mov_b64 v[86:87], v[72:73]
    s_mov_b64 exec, -1
    s_or_b64 s[80:81], s[80:81], s[50:51]
    ds_read_b64 v[70:71], v95 offset:65408
    ds_read_b64 v[68:69], v94 offset:65408
    s_waitcnt vmcnt(11)
    v_and_b32 v46, 0x20000000, v27
    v_lshrrev_b32 v47, 14, v23
    v_bitop3_b32 v47, v47, v5, v46 bitop3:0xea
    ds_read_b64 v[102:103], v47
    v_bitop3_b32 v93, v23, v5, v46 bitop3:0xea
    v_and_b32 v46, 0x10000000, v27
    v_lshrrev_b32 v47, 14, v22
    v_bitop3_b32 v47, v47, v5, v46 bitop3:0xea
    ds_read_b64 v[100:101], v47
    v_bitop3_b32 v92, v22, v5, v46 bitop3:0xea
    s_waitcnt lgkmcnt(2)
    v_mfma_f32_4x4x4_16b_bf16 v[80:83], v[10:11], v[70:71], v[80:83]
    v_mfma_f32_4x4x4_16b_bf16 v[76:79], v[10:11], v[68:69], v[76:79]
    v_perm_b32 v15, v23, v26, s45
    v_bitop3_b32 v46, v23, 0.5, -0.5 bitop3:0xa8
    v_perm_b32 v14, v22, v26, s44
    v_bitop3_b32 v47, v22, 0.5, -0.5 bitop3:0xa8
    v_cvt_pk_bf16_f32 v80, v80, v81
    v_cvt_pk_bf16_f32 v81, v82, v83
    ds_wrxchg_rtn_b64 v[74:75], v95, v[80:81] offset:65408
    v_cvt_pk_bf16_f32 v76, v76, v77
    v_cvt_pk_bf16_f32 v77, v78, v79
    ds_wrxchg_rtn_b64 v[72:73], v94, v[76:77] offset:65408
    s_waitcnt lgkmcnt(2)
    v_mfma_f32_4x4x4_16b_bf16 v[80:83], v[8:9], v[102:103], 0
    v_mfma_f32_4x4x4_16b_bf16 v[76:79], v[8:9], v[100:101], 0
    v_bitop3_b32 v15, v6, v15, v46 bitop3:0xca
    v_bitop3_b32 v14, v6, v14, v47 bitop3:0xca
    v_cmp_lt_u32 s[84:85], v5, v92
    s_nop 0
    v_pk_mul_f32 v[80:81], v[80:81], v[14:15] op_sel:[0,1] op_sel_hi:[1,1]
    v_pk_mul_f32 v[82:83], v[82:83], v[14:15] op_sel:[0,1] op_sel_hi:[1,1]
    v_pk_mul_f32 v[76:77], v[76:77], v[14:15] op_sel:[0,0] op_sel_hi:[1,0]
    v_pk_mul_f32 v[78:79], v[78:79], v[14:15] op_sel:[0,0] op_sel_hi:[1,0]
    s_waitcnt lgkmcnt(0)
    v_cmp_ne_u64 s[50:51], v[72:73], v[68:69]
    v_cmpx_ne_u64 s[54:55], v[74:75], v[70:71]
    s_and_b64 s[82:83], s[54:55], s[80:81]
    s_cbranch_scc1 L2_c107
L2_d107:
    v_mov_b64 v[84:85], v[70:71]
    v_mov_b32 v7, v95
    v_mov_b64 v[86:87], v[74:75]
    s_or_b64 s[80:81], s[80:81], s[54:55]
    s_mov_b64 exec, s[50:51]
    s_and_b64 s[82:83], s[50:51], s[80:81]
    s_cbranch_scc1 L2_c108
L2_d108:
    v_mov_b64 v[84:85], v[68:69]
    v_mov_b32 v7, v94
    v_mov_b64 v[86:87], v[72:73]
    s_mov_b64 exec, -1
    s_or_b64 s[80:81], s[80:81], s[50:51]
    ds_read_b64 v[70:71], v93 offset:65408
    s_and_b64 exec, s[84:85], s[80:81]
    v_mfma_f32_4x4x4_16b_bf16 v[76:79], v[12:13], v[84:85], 0
    v_mov_b32 v92, v7
    s_andn2_b64 s[80:81], s[80:81], s[84:85]
    v_mfma_f32_4x4x4_16b_bf16 v[76:79], v[10:11], v[86:87], v[76:79]
    s_mov_b64 exec, -1
    ds_read_b64 v[68:69], v92 offset:65408
    v_and_b32 v46, 0x80000000, v27
    v_lshrrev_b32 v47, 14, v25
    v_bitop3_b32 v47, v47, v5, v46 bitop3:0xea
    ds_read_b64 v[106:107], v47
    v_bitop3_b32 v95, v25, v5, v46 bitop3:0xea
    v_and_b32 v46, 0x40000000, v27
    v_lshrrev_b32 v47, 14, v24
    v_bitop3_b32 v47, v47, v5, v46 bitop3:0xea
    ds_read_b64 v[104:105], v47
    v_bitop3_b32 v94, v24, v5, v46 bitop3:0xea
    s_waitcnt lgkmcnt(2)
    v_mfma_f32_4x4x4_16b_bf16 v[80:83], v[10:11], v[70:71], v[80:83]
    v_mfma_f32_4x4x4_16b_bf16 v[76:79], v[10:11], v[68:69], v[76:79]
    v_perm_b32 v15, v25, v26, s47
    v_bitop3_b32 v46, v25, 0.5, -0.5 bitop3:0xa8
    v_perm_b32 v14, v24, v26, s46
    v_bitop3_b32 v47, v24, 0.5, -0.5 bitop3:0xa8
    v_cvt_pk_bf16_f32 v80, v80, v81
    v_cvt_pk_bf16_f32 v81, v82, v83
    ds_wrxchg_rtn_b64 v[74:75], v93, v[80:81] offset:65408
    v_cvt_pk_bf16_f32 v76, v76, v77
    v_cvt_pk_bf16_f32 v77, v78, v79
    ds_wrxchg_rtn_b64 v[72:73], v92, v[76:77] offset:65408
    v_and_b32 v88, 0x0fffffff, v41
    v_mov_b32 v27, v41
    buffer_load_dwordx2 v[22:23], v88, s[8:11], 0 offen
    buffer_load_dwordx3 v[24:26], v88, s[8:11], 0 offen offset:8
    s_setprio 1
    s_waitcnt lgkmcnt(2)
    v_mfma_f32_4x4x4_16b_bf16 v[80:83], v[8:9], v[106:107], 0
    v_mfma_f32_4x4x4_16b_bf16 v[76:79], v[8:9], v[104:105], 0
    v_bitop3_b32 v15, v6, v15, v46 bitop3:0xca
    v_bitop3_b32 v14, v6, v14, v47 bitop3:0xca
    s_nop 1
    v_pk_mul_f32 v[80:81], v[80:81], v[14:15] op_sel:[0,1] op_sel_hi:[1,1]
    v_pk_mul_f32 v[82:83], v[82:83], v[14:15] op_sel:[0,1] op_sel_hi:[1,1]
    v_pk_mul_f32 v[76:77], v[76:77], v[14:15] op_sel:[0,0] op_sel_hi:[1,0]
    v_pk_mul_f32 v[78:79], v[78:79], v[14:15] op_sel:[0,0] op_sel_hi:[1,0]
    s_waitcnt lgkmcnt(0)
    v_cmp_ne_u64 s[50:51], v[72:73], v[68:69]
    v_cmpx_ne_u64 s[54:55], v[74:75], v[70:71]
    s_and_b64 s[82:83], s[54:55], s[80:81]
    s_cbranch_scc1 L2_c109
L2_d109:
    v_mov_b64 v[84:85], v[70:71]
    v_mov_b32 v7, v93
    v_mov_b64 v[86:87], v[74:75]
    s_or_b64 s[80:81], s[80:81], s[54:55]
    s_mov_b64 exec, s[50:51]
    s_and_b64 s[82:83], s[50:51], s[80:81]
    s_cbranch_scc1 L2_c110
L2_d110:
    v_mov_b64 v[84:85], v[68:69]
    v_mov_b32 v7, v92
    v_mov_b64 v[86:87], v[72:73]
    s_mov_b64 exec, -1
    s_or_b64 s[80:81], s[80:81], s[50:51]
    ds_read_b64 v[70:71], v95 offset:65408
    ds_read_b64 v[68:69], v94 offset:65408
    s_waitcnt vmcnt(11)
    v_and_b32 v46, 0x20000000, v33
    v_lshrrev_b32 v47, 14, v29
    v_bitop3_b32 v47, v47, v5, v46 bitop3:0xea
    ds_read_b64 v[102:103], v47
    v_bitop3_b32 v93, v29, v5, v46 bitop3:0xea
    v_and_b32 v46, 0x10000000, v33
    v_lshrrev_b32 v47, 14, v28
    v_bitop3_b32 v47, v47, v5, v46 bitop3:0xea
    ds_read_b64 v[100:101], v47
    v_bitop3_b32 v92, v28, v5, v46 bitop3:0xea
    s_waitcnt lgkmcnt(2)
    v_mfma_f32_4x4x4_16b_bf16 v[80:83], v[10:11], v[70:71], v[80:83]
    v_mfma_f32_4x4x4_16b_bf16 v[76:79], v[10:11], v[68:69], v[76:79]
    v_perm_b32 v15, v29, v32, s45
    v_bitop3_b32 v46, v29, 0.5, -0.5 bitop3:0xa8
    v_perm_b32 v14, v28, v32, s44
    v_bitop3_b32 v47, v28, 0.5, -0.5 bitop3:0xa8
    v_cvt_pk_bf16_f32 v80, v80, v81
    v_cvt_pk_bf16_f32 v81, v82, v83
    ds_wrxchg_rtn_b64 v[74:75], v95, v[80:81] offset:65408
    v_cvt_pk_bf16_f32 v76, v76, v77
    v_cvt_pk_bf16_f32 v77, v78, v79
    ds_wrxchg_rtn_b64 v[72:73], v94, v[76:77] offset:65408
    s_waitcnt lgkmcnt(2)
    v_mfma_f32_4x4x4_16b_bf16 v[80:83], v[8:9], v[102:103], 0
    v_mfma_f32_4x4x4_16b_bf16 v[76:79], v[8:9], v[100:101], 0
    v_bitop3_b32 v15, v6, v15, v46 bitop3:0xca
    v_bitop3_b32 v14, v6, v14, v47 bitop3:0xca
    v_cmp_lt_u32 s[84:85], v5, v92
    s_nop 0
    v_pk_mul_f32 v[80:81], v[80:81], v[14:15] op_sel:[0,1] op_sel_hi:[1,1]
    v_pk_mul_f32 v[82:83], v[82:83], v[14:15] op_sel:[0,1] op_sel_hi:[1,1]
    v_pk_mul_f32 v[76:77], v[76:77], v[14:15] op_sel:[0,0] op_sel_hi:[1,0]
    v_pk_mul_f32 v[78:79], v[78:79], v[14:15] op_sel:[0,0] op_sel_hi:[1,0]
    s_waitcnt lgkmcnt(0)
    v_cmp_ne_u64 s[50:51], v[72:73], v[68:69]
    v_cmpx_ne_u64 s[54:55], v[74:75], v[70:71]
    s_and_b64 s[82:83], s[54:55], s[80:81]
    s_cbranch_scc1 L2_c111
L2_d111:
    v_mov_b64 v[84:85], v[70:71]
    v_mov_b32 v7, v95
    v_mov_b64 v[86:87], v[74:75]
    s_or_b64 s[80:81], s[80:81], s[54:55]
    s_mov_b64 exec, s[50:51]
    s_and_b64 s[82:83], s[50:51], s[80:81]
    s_cbranch_scc1 L2_c112
L2_d112:
    v_mov_b64 v[84:85], v[68:69]
    v_mov_b32 v7, v94
    v_mov_b64 v[86:87], v[72:73]
    s_mov_b64 exec, -1
    s_or_b64 s[80:81], s[80:81], s[50:51]
    ds_read_b64 v[70:71], v93 offset:65408
    s_and_b64 exec, s[84:85], s[80:81]
    v_mfma_f32_4x4x4_16b_bf16 v[76:79], v[12:13], v[84:85], 0
    v_mov_b32 v92, v7
    s_andn2_b64 s[80:81], s[80:81], s[84:85]
    v_mfma_f32_4x4x4_16b_bf16 v[76:79], v[10:11], v[86:87], v[76:79]
    s_mov_b64 exec, -1
    ds_read_b64 v[68:69], v92 offset:65408
    v_and_b32 v46, 0x80000000, v33
    v_lshrrev_b32 v47, 14, v31
    v_bitop3_b32 v47, v47, v5, v46 bitop3:0xea
    ds_read_b64 v[106:107], v47
    v_bitop3_b32 v95, v31, v5, v46 bitop3:0xea
    v_and_b32 v46, 0x40000000, v33
    v_lshrrev_b32 v47, 14, v30
    v_bitop3_b32 v47, v47, v5, v46 bitop3:0xea
    ds_read_b64 v[104:105], v47
    v_bitop3_b32 v94, v30, v5, v46 bitop3:0xea
    s_waitcnt lgkmcnt(2)
    v_mfma_f32_4x4x4_16b_bf16 v[80:83], v[10:11], v[70:71], v[80:83]
    v_mfma_f32_4x4x4_16b_bf16 v[76:79], v[10:11], v[68:69], v[76:79]
    v_perm_b32 v15, v31, v32, s47
    v_bitop3_b32 v46, v31, 0.5, -0.5 bitop3:0xa8
    v_perm_b32 v14, v30, v32, s46
    v_bitop3_b32 v47, v30, 0.5, -0.5 bitop3:0xa8
    v_cvt_pk_bf16_f32 v80, v80, v81
    v_cvt_pk_bf16_f32 v81, v82, v83
    ds_wrxchg_rtn_b64 v[74:75], v93, v[80:81] offset:65408
    v_cvt_pk_bf16_f32 v76, v76, v77
    v_cvt_pk_bf16_f32 v77, v78, v79
    ds_wrxchg_rtn_b64 v[72:73], v92, v[76:77] offset:65408
    v_and_b32 v88, 0x0fffffff, v42
    v_mov_b32 v33, v42
    buffer_load_dwordx2 v[28:29], v88, s[8:11], 0 offen
    buffer_load_dwordx3 v[30:32], v88, s[8:11], 0 offen offset:8
    s_setprio 0
    s_waitcnt lgkmcnt(2)
    v_mfma_f32_4x4x4_16b_bf16 v[80:83], v[8:9], v[106:107], 0
    v_mfma_f32_4x4x4_16b_bf16 v[76:79], v[8:9], v[104:105], 0
    v_bitop3_b32 v15, v6, v15, v46 bitop3:0xca
    v_bitop3_b32 v14, v6, v14, v47 bitop3:0xca
    s_nop 1
    v_pk_mul_f32 v[80:81], v[80:81], v[14:15] op_sel:[0,1] op_sel_hi:[1,1]
    v_pk_mul_f32 v[82:83], v[82:83], v[14:15] op_sel:[0,1] op_sel_hi:[1,1]
    v_pk_mul_f32 v[76:77], v[76:77], v[14:15] op_sel:[0,0] op_sel_hi:[1,0]
    v_pk_mul_f32 v[78:79], v[78:79], v[14:15] op_sel:[0,0] op_sel_hi:[1,0]
    s_add_u32 s40, s40, 0x50000
    s_waitcnt lgkmcnt(0)
    v_cmp_ne_u64 s[50:51], v[72:73], v[68:69]
    v_cmpx_ne_u64 s[54:55], v[74:75], v[70:71]
    s_and_b64 s[82:83], s[54:55], s[80:81]
    s_cbranch_scc1 L2_c113
L2_d113:
    v_mov_b64 v[84:85], v[70:71]
    v_mov_b32 v7, v93
    v_mov_b64 v[86:87], v[74:75]
    s_or_b64 s[80:81], s[80:81], s[54:55]
    s_mov_b64 exec, s[50:51]
    s_and_b64 s[82:83], s[50:51], s[80:81]
    s_cbranch_scc1 L2_c114
L2_d114:
    v_mov_b64 v[84:85], v[68:69]
    v_mov_b32 v7, v92
    v_mov_b64 v[86:87], v[72:73]
    s_mov_b64 exec, -1
    s_or_b64 s[80:81], s[80:81], s[50:51]
    ds_read_b64 v[70:71], v95 offset:65408
    ds_read_b64 v[68:69], v94 offset:65408
    s_waitcnt vmcnt(8)
    v_and_b32 v46, 0x20000000, v39
    v_lshrrev_b32 v47, 14, v35
    v_bitop3_b32 v47, v47, v5, v46 bitop3:0xea
    ds_read_b64 v[102:103], v47
    v_bitop3_b32 v93, v35, v5, v46 bitop3:0xea
    v_and_b32 v46, 0x10000000, v39
    v_lshrrev_b32 v47, 14, v34
    v_bitop3_b32 v47, v47, v5, v46 bitop3:0xea
    ds_read_b64 v[100:101], v47
    v_bitop3_b32 v92, v34, v5, v46 bitop3:0xea
    v_and_b32 v46, 0x80000000, v39
    v_lshrrev_b32 v47, 14, v37
    v_bitop3_b32 v47, v47, v5, v46 bitop3:0xea
    ds_read_b64 v[106:107], v47
    v_and_b32 v46, 0x40000000, v39
    v_lshrrev_b32 v47, 14, v36
    v_bitop3_b32 v47, v47, v5, v46 bitop3:0xea
    ds_read_b64 v[104:105], v47
    s_waitcnt lgkmcnt(4)
    v_mfma_f32_4x4x4_16b_bf16 v[80:83], v[10:11], v[70:71], v[80:83]
    v_mfma_f32_4x4x4_16b_bf16 v[76:79], v[10:11], v[68:69], v[76:79]
    v_perm_b32 v15, v35, v38, s45
    v_bitop3_b32 v46, v35, 0.5, -0.5 bitop3:0xa8
    v_perm_b32 v14, v34, v38, s44
    v_bitop3_b32 v47, v34, 0.5, -0.5 bitop3:0xa8
    v_cvt_pk_bf16_f32 v80, v80, v81
    v_cvt_pk_bf16_f32 v81, v82, v83
    ds_wrxchg_rtn_b64 v[74:75], v95, v[80:81] offset:65408
    v_cvt_pk_bf16_f32 v76, v76, v77
    v_cvt_pk_bf16_f32 v77, v78, v79
    ds_wrxchg_rtn_b64 v[72:73], v94, v[76:77] offset:65408
    s_waitcnt lgkmcnt(2)
    s_barrier
    s_setprio 3
    s_mov_b32 m0, s100
    s_nop 0
    ds_write_addtid_b32 v116 offset:32768
    ds_write_addtid_b32 v117 offset:33024
    ds_write_addtid_b32 v118 offset:33280
    ds_write_addtid_b32 v119 offset:33536
    buffer_load_dwordx4 v[116:119], v3, s[16:19], s40 offen offset:2048
    ds_write_addtid_b32 v120 offset:33792
    ds_write_addtid_b32 v121 offset:34048
    ds_write_addtid_b32 v122 offset:34304
    ds_write_addtid_b32 v123 offset:34560
    buffer_load_dwordx4 v[120:123], v3, s[16:19], s40 offen offset:3072
    v_mfma_f32_4x4x4_16b_bf16 v[80:83], v[8:9], v[102:103], 0
    v_mfma_f32_4x4x4_16b_bf16 v[76:79], v[8:9], v[100:101], 0
    v_bitop3_b32 v15, v6, v15, v46 bitop3:0xca
    v_bitop3_b32 v14, v6, v14, v47 bitop3:0xca
    v_cmp_lt_u32 s[84:85], v5, v92
    s_nop 0
    v_pk_mul_f32 v[80:81], v[80:81], v[14:15] op_sel:[0,1] op_sel_hi:[1,1]
    v_pk_mul_f32 v[82:83], v[82:83], v[14:15] op_sel:[0,1] op_sel_hi:[1,1]
    v_pk_mul_f32 v[76:77], v[76:77], v[14:15] op_sel:[0,0] op_sel_hi:[1,0]
    v_pk_mul_f32 v[78:79], v[78:79], v[14:15] op_sel:[0,0] op_sel_hi:[1,0]
    v_mov_b32 v44, v43
    s_cmp_gt_u32 s37, 1024
    s_cbranch_scc1 L2_xs115
    s_cmp_lg_u32 s101, 0
    s_cbranch_scc1 L2_xa115
L2_xb115:
    v_lshlrev_b32 v89, 16, v96
    v_add_u32 v90, 60, v97
    v_bitop3_b32 v90, v89, v45, v90 bitop3:0x6a
    ds_write_b32 v98, v90 offset:12
    v_lshlrev_b32 v89, 20, v96
    v_add_u32 v90, 40, v97
    v_bitop3_b32 v90, v89, v45, v90 bitop3:0x6a
    ds_write_b32 v98, v90 offset:8
    v_lshlrev_b32 v89, 24, v96
    v_add_u32 v90, 20, v97
    v_bitop3_b32 v90, v89, v45, v90 bitop3:0x6a
    ds_write_b32 v98, v90 offset:4
    v_lshlrev_b32 v89, 28, v96
    v_bitop3_b32 v90, v89, v45, v97 bitop3:0x6a
    ds_write_b32 v98, v90 offset:0
    v_mov_b32_dpp v91, v66 quad_perm:[1,1,1,1] row_mask:0xf bank_mask:0xf
    v_and_b32 v89, 3, v91
    v_and_b32 v97, 0xfffc, v91
    v_sub_u16_dpp v88, v66, v91 quad_perm:[3,3,3,3] row_mask:0xf bank_mask:0xf
    v_mad_u32_u24 v97, v97, 5, v4
    v_add_u32 v99, v88, v89
    v_bfm_b32 v96, v88, v89
    v_cmp_lt_u32 s[58:59], 16, v99
    v_lshlrev_b32 v89, v1, v96
    v_and_b32 v89, v45, v89
    v_cmp_ne_u32 vcc, 0, v89
    v_xor_b32 v90, v97, v89
    s_add_u32 s3, s37, s38
    v_mbcnt_lo_u32_b32 v98, vcc_lo, 0
    v_mbcnt_hi_u32_b32 v98, vcc_hi, v98
    s_bcnt1_i32_b64 s41, vcc
    v_lshl_add_u32 v98, v98, 2, s3
    s_mov_b64 exec, vcc
    ds_write_b32 v98, v90
    s_mov_b64 exec, -1
    s_lshl2_add_u32 s37, s41, s37
    s_cmp_lg_u64 s[58:59], 0
    s_cbranch_scc1 L2_xe115
L2_xr115:
    v_add_u32 v98, s37, v0
    v_mov_b32 v90, -1
    ds_write_b32 v98, v90
    ds_read2st64_b32 v[40:41], v0 offset0:0 offset1:1
    ds_read2st64_b32 v[42:43], v0 offset0:2 offset1:3
    s_sub_u32 s3, s37, 768
    s_cmp_gt_u32 s3, 256
    s_cbranch_scc1 L2_xf115
L2_xg115:
    v_lshrrev_b64 v[64:65], 16, v[64:65]
    v_lshrrev_b64 v[66:67], 16, v[66:67]
    s_setprio 2
    ds_write_addtid_b32 v124 offset:34816
    ds_write_addtid_b32 v125 offset:35072
    ds_write_addtid_b32 v126 offset:35328
    ds_write_addtid_b32 v127 offset:35584
    s_add_u32 s3, s40, 4096
    buffer_load_dwordx4 v[124:127], v3, s[16:19], s3 offen
    s_waitcnt lgkmcnt(14)
    v_cmp_ne_u64 s[50:51], v[72:73], v[68:69]
    v_cmpx_ne_u64 s[54:55], v[74:75], v[70:71]
    s_and_b64 s[82:83], s[54:55], s[80:81]
    s_cbranch_scc1 L2_c116
L2_d116:
    v_mov_b64 v[84:85], v[70:71]
    v_mov_b32 v7, v95
    v_mov_b64 v[86:87], v[74:75]
    s_or_b64 s[80:81], s[80:81], s[54:55]
    s_mov_b64 exec, s[50:51]
    s_and_b64 s[82:83], s[50:51], s[80:81]
    s_cbranch_scc1 L2_c117
L2_d117:
    v_mov_b64 v[84:85], v[68:69]
    v_mov_b32 v7, v94
    v_mov_b64 v[86:87], v[72:73]
    s_mov_b64 exec, -1
    s_or_b64 s[80:81], s[80:81], s[50:51]
    ds_read_b64 v[70:71], v93 offset:65408
    s_and_b64 exec, s[84:85], s[80:81]
    v_mfma_f32_4x4x4_16b_bf16 v[76:79], v[12:13], v[84:85], 0
    v_mov_b32 v92, v7
    s_andn2_b64 s[80:81], s[80:81], s[84:85]
    v_mfma_f32_4x4x4_16b_bf16 v[76:79], v[10:11], v[86:87], v[76:79]
    s_mov_b64 exec, -1
    ds_read_b64 v[68:69], v92 offset:65408
    s_setprio 1
    s_waitcnt vmcnt(10)
    s_mov_b32 m0, s38
    s_nop 0
    ds_write_addtid_b32 v108 offset:0
    ds_write_addtid_b32 v109 offset:256
    ds_write_addtid_b32 v110 offset:512
    ds_write_addtid_b32 v111 offset:768
    s_waitcnt lgkmcnt(4)
    v_mfma_f32_4x4x4_16b_bf16 v[80:83], v[10:11], v[70:71], v[80:83]
    v_mfma_f32_4x4x4_16b_bf16 v[76:79], v[10:11], v[68:69], v[76:79]
    v_and_b32 v46, 0x40000000, v39
    v_bitop3_b32 v94, v36, v5, v46 bitop3:0xea
    v_and_b32 v46, 0x80000000, v39
    v_bitop3_b32 v95, v37, v5, v46 bitop3:0xea
    v_perm_b32 v15, v37, v38, s47
    v_bitop3_b32 v46, v37, 0.5, -0.5 bitop3:0xa8
    v_perm_b32 v14, v36, v38, s46
    v_bitop3_b32 v47, v36, 0.5, -0.5 bitop3:0xa8
    v_cvt_pk_bf16_f32 v80, v80, v81
    v_cvt_pk_bf16_f32 v81, v82, v83
    ds_wrxchg_rtn_b64 v[74:75], v93, v[80:81] offset:65408
    v_cvt_pk_bf16_f32 v76, v76, v77
    v_cvt_pk_bf16_f32 v77, v78, v79
    ds_wrxchg_rtn_b64 v[72:73], v92, v[76:77] offset:65408
    v_and_b32 v88, 0x0fffffff, v44
    v_mov_b32 v39, v44
    buffer_load_dwordx2 v[34:35], v88, s[8:11], 0 offen
    buffer_load_dwordx3 v[36:38], v88, s[8:11], 0 offen offset:8
    s_setprio 0
    s_waitcnt vmcnt(11)
    ds_write_addtid_b32 v112 offset:1024
    ds_write_addtid_b32 v113 offset:1280
    ds_write_addtid_b32 v114 offset:1536
    ds_write_addtid_b32 v115 offset:1792
    v_mfma_f32_4x4x4_16b_bf16 v[80:83], v[8:9], v[106:107], 0
    v_mfma_f32_4x4x4_16b_bf16 v[76:79], v[8:9], v[104:105], 0
    v_bitop3_b32 v15, v6, v15, v46 bitop3:0xca
    v_bitop3_b32 v14, v6, v14, v47 bitop3:0xca
    s_nop 1
    v_pk_mul_f32 v[80:81], v[80:81], v[14:15] op_sel:[0,1] op_sel_hi:[1,1]
    v_pk_mul_f32 v[82:83], v[82:83], v[14:15] op_sel:[0,1] op_sel_hi:[1,1]
    v_pk_mul_f32 v[76:77], v[76:77], v[14:15] op_sel:[0,0] op_sel_hi:[1,0]
    v_pk_mul_f32 v[78:79], v[78:79], v[14:15] op_sel:[0,0] op_sel_hi:[1,0]
    s_add_u32 s42, s42, 1
    s_waitcnt lgkmcnt(0)
    s_cmp_lg_u32 s42, 14
    s_cbranch_scc1 L2_loop
    s_barrier
    s_bitcmp1_b32 s36, s42
    s_cbranch_scc1 L2_slow
L2_ret6:
    s_setprio 3
    buffer_load_dwordx4 v[108:111], v3, s[16:19], s40 offen offset:0
    v_cmp_ne_u64 s[50:51], v[72:73], v[68:69]
    v_cmpx_ne_u64 s[54:55], v[74:75], v[70:71]
    s_and_b64 s[82:83], s[54:55], s[80:81]
    s_cbranch_scc1 L2_c118
L2_d118:
    v_mov_b64 v[84:85], v[70:71]
    v_mov_b32 v7, v93
    v_mov_b64 v[86:87], v[74:75]
    s_or_b64 s[80:81], s[80:81], s[54:55]
    s_mov_b64 exec, s[50:51]
    s_and_b64 s[82:83], s[50:51], s[80:81]
    s_cbranch_scc1 L2_c119
L2_d119:
    v_mov_b64 v[84:85], v[68:69]
    v_mov_b32 v7, v92
    v_mov_b64 v[86:87], v[72:73]
    s_mov_b64 exec, -1
    s_or_b64 s[80:81], s[80:81], s[50:51]
    ds_read_b64 v[70:71], v95 offset:65408
    ds_read_b64 v[68:69], v94 offset:65408
    s_waitcnt vmcnt(10)
    v_and_b32 v46, 0x20000000, v21
    v_lshrrev_b32 v47, 14, v17
    v_bitop3_b32 v47, v47, v5, v46 bitop3:0xea
    ds_read_b64 v[102:103], v47
    v_bitop3_b32 v93, v17, v5, v46 bitop3:0xea
    v_and_b32 v46, 0x10000000, v21
    v_lshrrev_b32 v47, 14, v16
    v_bitop3_b32 v47, v47, v5, v46 bitop3:0xea
    ds_read_b64 v[100:101], v47
    v_bitop3_b32 v92, v16, v5, v46 bitop3:0xea
    s_waitcnt lgkmcnt(2)
    v_mfma_f32_4x4x4_16b_bf16 v[80:83], v[10:11], v[70:71], v[80:83]
    v_mfma_f32_4x4x4_16b_bf16 v[76:79], v[10:11], v[68:69], v[76:79]
    v_perm_b32 v15, v17, v20, s45
    v_bitop3_b32 v46, v17, 0.5, -0.5 bitop3:0xa8
    v_perm_b32 v14, v16, v20, s44
    v_bitop3_b32 v47, v16, 0.5, -0.5 bitop3:0xa8
    v_cvt_pk_bf16_f32 v80, v80, v81
    v_cvt_pk_bf16_f32 v81, v82, v83
    ds_wrxchg_rtn_b64 v[74:75], v95, v[80:81] offset:65408
    v_cvt_pk_bf16_f32 v76, v76, v77
    v_cvt_pk_bf16_f32 v77, v78, v79
    ds_wrxchg_rtn_b64 v[72:73], v94, v[76:77] offset:65408
    s_waitcnt lgkmcnt(2)
    v_mfma_f32_4x4x4_16b_bf16 v[80:83], v[8:9], v[102:103], 0
    v_mfma_f32_4x4x4_16b_bf16 v[76:79], v[8:9], v[100:101], 0
    v_bitop3_b32 v15, v6, v15, v46 bitop3:0xca
    v_bitop3_b32 v14, v6, v14, v47 bitop3:0xca
    v_cmp_lt_u32 s[84:85], v5, v92
    s_nop 0
    v_pk_mul_f32 v[80:81], v[80:81], v[14:15] op_sel:[0,1] op_sel_hi:[1,1]
    v_pk_mul_f32 v[82:83], v[82:83], v[14:15] op_sel:[0,1] op_sel_hi:[1,1]
    v_pk_mul_f32 v[76:77], v[76:77], v[14:15] op_sel:[0,0] op_sel_hi:[1,0]
    v_pk_mul_f32 v[78:79], v[78:79], v[14:15] op_sel:[0,0] op_sel_hi:[1,0]
    buffer_load_dwordx4 v[112:115], v3, s[16:19], s40 offen offset:1024
    s_waitcnt lgkmcnt(0)
    v_cmp_ne_u64 s[50:51], v[72:73], v[68:69]
    v_cmpx_ne_u64 s[54:55], v[74:75], v[70:71]
    s_and_b64 s[82:83], s[54:55], s[80:81]
    s_cbranch_scc1 L2_c120
L2_d120:
    v_mov_b64 v[84:85], v[70:71]
    v_mov_b32 v7, v95
    v_mov_b64 v[86:87], v[74:75]
    s_or_b64 s[80:81], s[80:81], s[54:55]
    s_mov_b64 exec, s[50:51]
    s_and_b64 s[82:83], s[50:51], s[80:81]
    s_cbranch_scc1 L2_c121
L2_d121:
    v_mov_b64 v[84:85], v[68:69]
    v_mov_b32 v7, v94
    v_mov_b64 v[86:87], v[72:73]
    s_mov_b64 exec, -1
    s_or_b64 s[80:81], s[80:81], s[50:51]
    ds_read_b64 v[70:71], v93 offset:65408
    s_and_b64 exec, s[84:85], s[80:81]
    v_mfma_f32_4x4x4_16b_bf16 v[76:79], v[12:13], v[84:85], 0
    v_mov_b32 v92, v7
    s_andn2_b64 s[80:81], s[80:81], s[84:85]
    v_mfma_f32_4x4x4_16b_bf16 v[76:79], v[10:11], v[86:87], v[76:79]
    s_mov_b64 exec, -1
    ds_read_b64 v[68:69], v92 offset:65408
    v_and_b32 v46, 0x80000000, v21
    v_lshrrev_b32 v47, 14, v19
    v_bitop3_b32 v47, v47, v5, v46 bitop3:0xea
    ds_read_b64 v[106:107], v47
    v_bitop3_b32 v95, v19, v5, v46 bitop3:0xea
    v_and_b32 v46, 0x40000000, v21
    v_lshrrev_b32 v47, 14, v18
    v_bitop3_b32 v47, v47, v5, v46 bitop3:0xea
    ds_read_b64 v[104:105], v47
    v_bitop3_b32 v94, v18, v5, v46 bitop3:0xea
    s_waitcnt lgkmcnt(2)
    v_mfma_f32_4x4x4_16b_bf16 v[80:83], v[10:11], v[70:71], v[80:83]
    v_mfma_f32_4x4x4_16b_bf16 v[76:79], v[10:11], v[68:69], v[76:79]
    v_perm_b32 v15, v19, v20, s47
    v_bitop3_b32 v46, v19, 0.5, -0.5 bitop3:0xa8
    v_perm_b32 v14, v18, v20, s46
    v_bitop3_b32 v47, v18, 0.5, -0.5 bitop3:0xa8
    v_cvt_pk_bf16_f32 v80, v80, v81
    v_cvt_pk_bf16_f32 v81, v82, v83
    ds_wrxchg_rtn_b64 v[74:75], v93, v[80:81] offset:65408
    v_cvt_pk_bf16_f32 v76, v76, v77
    v_cvt_pk_bf16_f32 v77, v78, v79
    ds_wrxchg_rtn_b64 v[72:73], v92, v[76:77] offset:65408
    v_and_b32 v88, 0x0fffffff, v40
    v_mov_b32 v21, v40
    buffer_load_dwordx2 v[16:17], v88, s[8:11], 0 offen
    buffer_load_dwordx3 v[18:20], v88, s[8:11], 0 offen offset:8
    s_setprio 2
    s_waitcnt lgkmcnt(2)
    v_mfma_f32_4x4x4_16b_bf16 v[80:83], v[8:9], v[106:107], 0
    v_mfma_f32_4x4x4_16b_bf16 v[76:79], v[8:9], v[104:105], 0
    v_bitop3_b32 v15, v6, v15, v46 bitop3:0xca
    v_bitop3_b32 v14, v6, v14, v47 bitop3:0xca
    s_nop 1
    v_pk_mul_f32 v[80:81], v[80:81], v[14:15] op_sel:[0,1] op_sel_hi:[1,1]
    v_pk_mul_f32 v[82:83], v[82:83], v[14:15] op_sel:[0,1] op_sel_hi:[1,1]
    v_pk_mul_f32 v[76:77], v[76:77], v[14:15] op_sel:[0,0] op_sel_hi:[1,0]
    v_pk_mul_f32 v[78:79], v[78:79], v[14:15] op_sel:[0,0] op_sel_hi:[1,0]
    s_waitcnt lgkmcnt(0)
    v_cmp_ne_u64 s[50:51], v[72:73], v[68:69]
    v_cmpx_ne_u64 s[54:55], v[74:75], v[70:71]
    s_and_b64 s[82:83], s[54:55], s[80:81]
    s_cbranch_scc1 L2_c122
L2_d122:
    v_mov_b64 v[84:85], v[70:71]
    v_mov_b32 v7, v93
    v_mov_b64 v[86:87], v[74:75]
    s_or_b64 s[80:81], s[80:81], s[54:55]
    s_mov_b64 exec, s[50:51]
    s_and_b64 s[82:83], s[50:51], s[80:81]
    s_cbranch_scc1 L2_c123
L2_d123:
    v_mov_b64 v[84:85], v[68:69]
    v_mov_b32 v7, v92
    v_mov_b64 v[86:87], v[72:73]
    s_mov_b64 exec, -1
    s_or_b64 s[80:81], s[80:81], s[50:51]
    ds_read_b64 v[70:71], v95 offset:65408
    ds_read_b64 v[68:69], v94 offset:65408
    s_waitcnt vmcnt(11)
    v_and_b32 v46, 0x20000000, v27
    v_lshrrev_b32 v47, 14, v23
    v_bitop3_b32 v47, v47, v5, v46 bitop3:0xea
    ds_read_b64 v[102:103], v47
    v_bitop3_b32 v93, v23, v5, v46 bitop3:0xea
    v_and_b32 v46, 0x10000000, v27
    v_lshrrev_b32 v47, 14, v22
    v_bitop3_b32 v47, v47, v5, v46 bitop3:0xea
    ds_read_b64 v[100:101], v47
    v_bitop3_b32 v92, v22, v5, v46 bitop3:0xea
    s_waitcnt lgkmcnt(2)
    v_mfma_f32_4x4x4_16b_bf16 v[80:83], v[10:11], v[70:71], v[80:83]
    v_mfma_f32_4x4x4_16b_bf16 v[76:79], v[10:11], v[68:69], v[76:79]
    v_perm_b32 v15, v23, v26, s45
    v_bitop3_b32 v46, v23, 0.5, -0.5 bitop3:0xa8
    v_perm_b32 v14, v22, v26, s44
    v_bitop3_b32 v47, v22, 0.5, -0.5 bitop3:0xa8
    v_cvt_pk_bf16_f32 v80, v80, v81
    v_cvt_pk_bf16_f32 v81, v82, v83
    ds_wrxchg_rtn_b64 v[74:75], v95, v[80:81] offset:65408
    v_cvt_pk_bf16_f32 v76, v76, v77
    v_cvt_pk_bf16_f32 v77, v78, v79
    ds_wrxchg_rtn_b64 v[72:73], v94, v[76:77] offset:65408
    s_waitcnt lgkmcnt(2)
    v_mfma_f32_4x4x4_16b_bf16 v[80:83], v[8:9], v[102:103], 0
    v_mfma_f32_4x4x4_16b_bf16 v[76:79], v[8:9], v[100:101], 0
    v_bitop3_b32 v15, v6, v15, v46 bitop3:0xca
    v_bitop3_b32 v14, v6, v14, v47 bitop3:0xca
    v_cmp_lt_u32 s[84:85], v5, v92
    s_nop 0
    v_pk_mul_f32 v[80:81], v[80:81], v[14:15] op_sel:[0,1] op_sel_hi:[1,1]
    v_pk_mul_f32 v[82:83], v[82:83], v[14:15] op_sel:[0,1] op_sel_hi:[1,1]
    v_pk_mul_f32 v[76:77], v[76:77], v[14:15] op_sel:[0,0] op_sel_hi:[1,0]
    v_pk_mul_f32 v[78:79], v[78:79], v[14:15] op_sel:[0,0] op_sel_hi:[1,0]
    s_waitcnt lgkmcnt(0)
    v_cmp_ne_u64 s[50:51], v[72:73], v[68:69]
    v_cmpx_ne_u64 s[54:55], v[74:75], v[70:71]
    s_and_b64 s[82:83], s[54:55], s[80:81]
    s_cbranch_scc1 L2_c124
L2_d124:
    v_mov_b64 v[84:85], v[70:71]
    v_mov_b32 v7, v95
    v_mov_b64 v[86:87], v[74:75]
    s_or_b64 s[80:81], s[80:81], s[54:55]
    s_mov_b64 exec, s[50:51]
    s_and_b64 s[82:83], s[50:51], s[80:81]
    s_cbranch_scc1 L2_c125
L2_d125:
    v_mov_b64 v[84:85], v[68:69]
    v_mov_b32 v7, v94
    v_mov_b64 v[86:87], v[72:73]
    s_mov_b64 exec, -1
    s_or_b64 s[80:81], s[80:81], s[50:51]
    ds_read_b64 v[70:71], v93 offset:65408
    s_and_b64 exec, s[84:85], s[80:81]
    v_mfma_f32_4x4x4_16b_bf16 v[76:79], v[12:13], v[84:85], 0
    v_mov_b32 v92, v7
    s_andn2_b64 s[80:81], s[80:81], s[84:85]
    v_mfma_f32_4x4x4_16b_bf16 v[76:79], v[10:11], v[86:87], v[76:79]
    s_mov_b64 exec, -1
    ds_read_b64 v[68:69], v92 offset:65408
    v_and_b32 v46, 0x80000000, v27
    v_lshrrev_b32 v47, 14, v25
    v_bitop3_b32 v47, v47, v5, v46 bitop3:0xea
    ds_read_b64 v[106:107], v47
    v_bitop3_b32 v95, v25, v5, v46 bitop3:0xea
    v_and_b32 v46, 0x40000000, v27
    v_lshrrev_b32 v47, 14, v24
    v_bitop3_b32 v47, v47, v5, v46 bitop3:0xea
    ds_read_b64 v[104:105], v47
    v_bitop3_b32 v94, v24, v5, v46 bitop3:0xea
    s_waitcnt lgkmcnt(2)
    v_mfma_f32_4x4x4_16b_bf16 v[80:83], v[10:11], v[70:71], v[80:83]
    v_mfma_f32_4x4x4_16b_bf16 v[76:79], v[10:11], v[68:69], v[76:79]
    v_perm_b32 v15, v25, v26, s47
    v_bitop3_b32 v46, v25, 0.5, -0.5 bitop3:0xa8
    v_perm_b32 v14, v24, v26, s46
    v_bitop3_b32 v47, v24, 0.5, -0.5 bitop3:0xa8
    v_cvt_pk_bf16_f32 v80, v80, v81
    v_cvt_pk_bf16_f32 v81, v82, v83
    ds_wrxchg_rtn_b64 v[74:75], v93, v[80:81] offset:65408
    v_cvt_pk_bf16_f32 v76, v76, v77
    v_cvt_pk_bf16_f32 v77, v78, v79
    ds_wrxchg_rtn_b64 v[72:73], v92, v[76:77] offset:65408
    v_and_b32 v88, 0x0fffffff, v41
    v_mov_b32 v27, v41
    buffer_load_dwordx2 v[22:23], v88, s[8:11], 0 offen
    buffer_load_dwordx3 v[24:26], v88, s[8:11], 0 offen offset:8
    s_setprio 1
    s_waitcnt lgkmcnt(2)
    v_mfma_f32_4x4x4_16b_bf16 v[80:83], v[8:9], v[106:107], 0
    v_mfma_f32_4x4x4_16b_bf16 v[76:79], v[8:9], v[104:105], 0
    v_bitop3_b32 v15, v6, v15, v46 bitop3:0xca
    v_bitop3_b32 v14, v6, v14, v47 bitop3:0xca
    s_nop 1
    v_pk_mul_f32 v[80:81], v[80:81], v[14:15] op_sel:[0,1] op_sel_hi:[1,1]
    v_pk_mul_f32 v[82:83], v[82:83], v[14:15] op_sel:[0,1] op_sel_hi:[1,1]
    v_pk_mul_f32 v[76:77], v[76:77], v[14:15] op_sel:[0,0] op_sel_hi:[1,0]
    v_pk_mul_f32 v[78:79], v[78:79], v[14:15] op_sel:[0,0] op_sel_hi:[1,0]
    s_waitcnt lgkmcnt(0)
    v_cmp_ne_u64 s[50:51], v[72:73], v[68:69]
    v_cmpx_ne_u64 s[54:55], v[74:75], v[70:71]
    s_and_b64 s[82:83], s[54:55], s[80:81]
    s_cbranch_scc1 L2_c126
L2_d126:
    v_mov_b64 v[84:85], v[70:71]
    v_mov_b32 v7, v93
    v_mov_b64 v[86:87], v[74:75]
    s_or_b64 s[80:81], s[80:81], s[54:55]
    s_mov_b64 exec, s[50:51]
    s_and_b64 s[82:83], s[50:51], s[80:81]
    s_cbranch_scc1 L2_c127
L2_d127:
    v_mov_b64 v[84:85], v[68:69]
    v_mov_b32 v7, v92
    v_mov_b64 v[86:87], v[72:73]
    s_mov_b64 exec, -1
    s_or_b64 s[80:81], s[80:81], s[50:51]
    ds_read_b64 v[70:71], v95 offset:65408
    ds_read_b64 v[68:69], v94 offset:65408
    s_waitcnt vmcnt(11)
    v_and_b32 v46, 0x20000000, v33
    v_lshrrev_b32 v47, 14, v29
    v_bitop3_b32 v47, v47, v5, v46 bitop3:0xea
    ds_read_b64 v[102:103], v47
    v_bitop3_b32 v93, v29, v5, v46 bitop3:0xea
    v_and_b32 v46, 0x10000000, v33
    v_lshrrev_b32 v47, 14, v28
    v_bitop3_b32 v47, v47, v5, v46 bitop3:0xea
    ds_read_b64 v[100:101], v47
    v_bitop3_b32 v92, v28, v5, v46 bitop3:0xea
    s_waitcnt lgkmcnt(2)
    v_mfma_f32_4x4x4_16b_bf16 v[80:83], v[10:11], v[70:71], v[80:83]
    v_mfma_f32_4x4x4_16b_bf16 v[76:79], v[10:11], v[68:69], v[76:79]
    v_perm_b32 v15, v29, v32, s45
    v_bitop3_b32 v46, v29, 0.5, -0.5 bitop3:0xa8
    v_perm_b32 v14, v28, v32, s44
    v_bitop3_b32 v47, v28, 0.5, -0.5 bitop3:0xa8
    v_cvt_pk_bf16_f32 v80, v80, v81
    v_cvt_pk_bf16_f32 v81, v82, v83
    ds_wrxchg_rtn_b64 v[74:75], v95, v[80:81] offset:65408
    v_cvt_pk_bf16_f32 v76, v76, v77
    v_cvt_pk_bf16_f32 v77, v78, v79
    ds_wrxchg_rtn_b64 v[72:73], v94, v[76:77] offset:65408
    s_waitcnt lgkmcnt(2)
    v_mfma_f32_4x4x4_16b_bf16 v[80:83], v[8:9], v[102:103], 0
    v_mfma_f32_4x4x4_16b_bf16 v[76:79], v[8:9], v[100:101], 0
    v_bitop3_b32 v15, v6, v15, v46 bitop3:0xca
    v_bitop3_b32 v14, v6, v14, v47 bitop3:0xca
    v_cmp_lt_u32 s[84:85], v5, v92
    s_nop 0
    v_pk_mul_f32 v[80:81], v[80:81], v[14:15] op_sel:[0,1] op_sel_hi:[1,1]
    v_pk_mul_f32 v[82:83], v[82:83], v[14:15] op_sel:[0,1] op_sel_hi:[1,1]
    v_pk_mul_f32 v[76:77], v[76:77], v[14:15] op_sel:[0,0] op_sel_hi:[1,0]
    v_pk_mul_f32 v[78:79], v[78:79], v[14:15] op_sel:[0,0] op_sel_hi:[1,0]
    s_waitcnt lgkmcnt(0)
    v_cmp_ne_u64 s[50:51], v[72:73], v[68:69]
    v_cmpx_ne_u64 s[54:55], v[74:75], v[70:71]
    s_and_b64 s[82:83], s[54:55], s[80:81]
    s_cbranch_scc1 L2_c128
L2_d128:
    v_mov_b64 v[84:85], v[70:71]
    v_mov_b32 v7, v95
    v_mov_b64 v[86:87], v[74:75]
    s_or_b64 s[80:81], s[80:81], s[54:55]
    s_mov_b64 exec, s[50:51]
    s_and_b64 s[82:83], s[50:51], s[80:81]
    s_cbranch_scc1 L2_c129
L2_d129:
    v_mov_b64 v[84:85], v[68:69]
    v_mov_b32 v7, v94
    v_mov_b64 v[86:87], v[72:73]
    s_mov_b64 exec, -1
    s_or_b64 s[80:81], s[80:81], s[50:51]
    ds_read_b64 v[70:71], v93 offset:65408
    s_and_b64 exec, s[84:85], s[80:81]
    v_mfma_f32_4x4x4_16b_bf16 v[76:79], v[12:13], v[84:85], 0
    v_mov_b32 v92, v7
    s_andn2_b64 s[80:81], s[80:81], s[84:85]
    v_mfma_f32_4x4x4_16b_bf16 v[76:79], v[10:11], v[86:87], v[76:79]
    s_mov_b64 exec, -1
    ds_read_b64 v[68:69], v92 offset:65408
    v_and_b32 v46, 0x80000000, v33
    v_lshrrev_b32 v47, 14, v31
    v_bitop3_b32 v47, v47, v5, v46 bitop3:0xea
    ds_read_b64 v[106:107], v47
    v_bitop3_b32 v95, v31, v5, v46 bitop3:0xea
    v_and_b32 v46, 0x40000000, v33
    v_lshrrev_b32 v47, 14, v30
    v_bitop3_b32 v47, v47, v5, v46 bitop3:0xea
    ds_read_b64 v[104:105], v47
    v_bitop3_b32 v94, v30, v5, v46 bitop3:0xea
    s_waitcnt lgkmcnt(2)
    v_mfma_f32_4x4x4_16b_bf16 v[80:83], v[10:11], v[70:71], v[80:83]
    v_mfma_f32_4x4x4_16b_bf16 v[76:79], v[10:11], v[68:69], v[76:79]
    v_perm_b32 v15, v31, v32, s47
    v_bitop3_b32 v46, v31, 0.5, -0.5 bitop3:0xa8
    v_perm_b32 v14, v30, v32, s46
    v_bitop3_b32 v47, v30, 0.5, -0.5 bitop3:0xa8
    v_cvt_pk_bf16_f32 v80, v80, v81
    v_cvt_pk_bf16_f32 v81, v82, v83
    ds_wrxchg_rtn_b64 v[74:75], v93, v[80:81] offset:65408
    v_cvt_pk_bf16_f32 v76, v76, v77
    v_cvt_pk_bf16_f32 v77, v78, v79
    ds_wrxchg_rtn_b64 v[72:73], v92, v[76:77] offset:65408
    v_and_b32 v88, 0x0fffffff, v42
    v_mov_b32 v33, v42
    buffer_load_dwordx2 v[28:29], v88, s[8:11], 0 offen
    buffer_load_dwordx3 v[30:32], v88, s[8:11], 0 offen offset:8
    s_setprio 0
    s_waitcnt lgkmcnt(2)
    v_mfma_f32_4x4x4_16b_bf16 v[80:83], v[8:9], v[106:107], 0
    v_mfma_f32_4x4x4_16b_bf16 v[76:79], v[8:9], v[104:105], 0
    v_bitop3_b32 v15, v6, v15, v46 bitop3:0xca
    v_bitop3_b32 v14, v6, v14, v47 bitop3:0xca
    s_nop 1
    v_pk_mul_f32 v[80:81], v[80:81], v[14:15] op_sel:[0,1] op_sel_hi:[1,1]
    v_pk_mul_f32 v[82:83], v[82:83], v[14:15] op_sel:[0,1] op_sel_hi:[1,1]
    v_pk_mul_f32 v[76:77], v[76:77], v[14:15] op_sel:[0,0] op_sel_hi:[1,0]
    v_pk_mul_f32 v[78:79], v[78:79], v[14:15] op_sel:[0,0] op_sel_hi:[1,0]
    s_add_u32 s40, s40, 0xfff24000
    s_waitcnt lgkmcnt(0)
    v_cmp_ne_u64 s[50:51], v[72:73], v[68:69]
    v_cmpx_ne_u64 s[54:55], v[74:75], v[70:71]
    s_and_b64 s[82:83], s[54:55], s[80:81]
    s_cbranch_scc1 L2_c130
L2_d130:
    v_mov_b64 v[84:85], v[70:71]
    v_mov_b32 v7, v93
    v_mov_b64 v[86:87], v[74:75]
    s_or_b64 s[80:81], s[80:81], s[54:55]
    s_mov_b64 exec, s[50:51]
    s_and_b64 s[82:83], s[50:51], s[80:81]
    s_cbranch_scc1 L2_c131
L2_d131:
    v_mov_b64 v[84:85], v[68:69]
    v_mov_b32 v7, v92
    v_mov_b64 v[86:87], v[72:73]
    s_mov_b64 exec, -1
    s_or_b64 s[80:81], s[80:81], s[50:51]
    ds_read_b64 v[70:71], v95 offset:65408
    ds_read_b64 v[68:69], v94 offset:65408
    s_waitcnt vmcnt(8)
    v_and_b32 v46, 0x20000000, v39
    v_lshrrev_b32 v47, 14, v35
    v_bitop3_b32 v47, v47, v5, v46 bitop3:0xea
    ds_read_b64 v[102:103], v47
    v_bitop3_b32 v93, v35, v5, v46 bitop3:0xea
    v_and_b32 v46, 0x10000000, v39
    v_lshrrev_b32 v47, 14, v34
    v_bitop3_b32 v47, v47, v5, v46 bitop3:0xea
    ds_read_b64 v[100:101], v47
    v_bitop3_b32 v92, v34, v5, v46 bitop3:0xea
    v_and_b32 v46, 0x80000000, v39
    v_lshrrev_b32 v47, 14, v37
    v_bitop3_b32 v47, v47, v5, v46 bitop3:0xea
    ds_read_b64 v[106:107], v47
    v_and_b32 v46, 0x40000000, v39
    v_lshrrev_b32 v47, 14, v36
    v_bitop3_b32 v47, v47, v5, v46 bitop3:0xea
    ds_read_b64 v[104:105], v47
    s_waitcnt lgkmcnt(4)
    v_mfma_f32_4x4x4_16b_bf16 v[80:83], v[10:11], v[70:71], v[80:83]
    v_mfma_f32_4x4x4_16b_bf16 v[76:79], v[10:11], v[68:69], v[76:79]
    v_perm_b32 v15, v35, v38, s45
    v_bitop3_b32 v46, v35, 0.5, -0.5 bitop3:0xa8
    v_perm_b32 v14, v34, v38, s44
    v_bitop3_b32 v47, v34, 0.5, -0.5 bitop3:0xa8
    v_cvt_pk_bf16_f32 v80, v80, v81
    v_cvt_pk_bf16_f32 v81, v82, v83
    ds_wrxchg_rtn_b64 v[74:75], v95, v[80:81] offset:65408
    v_cvt_pk_bf16_f32 v76, v76, v77
    v_cvt_pk_bf16_f32 v77, v78, v79
    ds_wrxchg_rtn_b64 v[72:73], v94, v[76:77] offset:65408
    s_waitcnt lgkmcnt(2)
    s_barrier
    s_setprio 3
    s_mov_b32 m0, s100
    s_nop 0
    ds_write_addtid_b32 v116 offset:32768
    ds_write_addtid_b32 v117 offset:33024
    ds_write_addtid_b32 v118 offset:33280
    ds_write_addtid_b32 v119 offset:33536
    ds_write_addtid_b32 v120 offset:33792
    ds_write_addtid_b32 v121 offset:34048
    ds_write_addtid_b32 v122 offset:34304
    ds_write_addtid_b32 v123 offset:34560
    v_mfma_f32_4x4x4_16b_bf16 v[80:83], v[8:9], v[102:103], 0
    v_mfma_f32_4x4x4_16b_bf16 v[76:79], v[8:9], v[100:101], 0
    v_bitop3_b32 v15, v6, v15, v46 bitop3:0xca
    v_bitop3_b32 v14, v6, v14, v47 bitop3:0xca
    v_cmp_lt_u32 s[84:85], v5, v92
    s_nop 0
    v_pk_mul_f32 v[80:81], v[80:81], v[14:15] op_sel:[0,1] op_sel_hi:[1,1]
    v_pk_mul_f32 v[82:83], v[82:83], v[14:15] op_sel:[0,1] op_sel_hi:[1,1]
    v_pk_mul_f32 v[76:77], v[76:77], v[14:15] op_sel:[0,0] op_sel_hi:[1,0]
    v_pk_mul_f32 v[78:79], v[78:79], v[14:15] op_sel:[0,0] op_sel_hi:[1,0]
    v_mov_b32 v44, v43
    s_setprio 2
    ds_write_addtid_b32 v124 offset:34816
    ds_write_addtid_b32 v125 offset:35072
    ds_write_addtid_b32 v126 offset:35328
    ds_write_addtid_b32 v127 offset:35584
    s_waitcnt lgkmcnt(12)
    v_cmp_ne_u64 s[50:51], v[72:73], v[68:69]
    v_cmpx_ne_u64 s[54:55], v[74:75], v[70:71]
    s_and_b64 s[82:83], s[54:55], s[80:81]
    s_cbranch_scc1 L2_c132
L2_d132:
    v_mov_b64 v[84:85], v[70:71]
    v_mov_b32 v7, v95
    v_mov_b64 v[86:87], v[74:75]
    s_or_b64 s[80:81], s[80:81], s[54:55]
    s_mov_b64 exec, s[50:51]
    s_and_b64 s[82:83], s[50:51], s[80:81]
    s_cbranch_scc1 L2_c133
L2_d133:
    v_mov_b64 v[84:85], v[68:69]
    v_mov_b32 v7, v94
    v_mov_b64 v[86:87], v[72:73]
    s_mov_b64 exec, -1
    s_or_b64 s[80:81], s[80:81], s[50:51]
    ds_read_b64 v[70:71], v93 offset:65408
    s_and_b64 exec, s[84:85], s[80:81]
    v_mfma_f32_4x4x4_16b_bf16 v[76:79], v[12:13], v[84:85], 0
    v_mov_b32 v92, v7
    s_andn2_b64 s[80:81], s[80:81], s[84:85]
    v_mfma_f32_4x4x4_16b_bf16 v[76:79], v[10:11], v[86:87], v[76:79]
    s_mov_b64 exec, -1
    ds_read_b64 v[68:69], v92 offset:65408
    s_setprio 1
    s_waitcnt vmcnt(7)
    s_mov_b32 m0, s38
    s_nop 0
    ds_write_addtid_b32 v108 offset:0
    ds_write_addtid_b32 v109 offset:256
    ds_write_addtid_b32 v110 offset:512
    ds_write_addtid_b32 v111 offset:768
    s_waitcnt lgkmcnt(4)
    v_mfma_f32_4x4x4_16b_bf16 v[80:83], v[10:11], v[70:71], v[80:83]
    v_mfma_f32_4x4x4_16b_bf16 v[76:79], v[10:11], v[68:69], v[76:79]
    v_and_b32 v46, 0x40000000, v39
    v_bitop3_b32 v94, v36, v5, v46 bitop3:0xea
    v_and_b32 v46, 0x80000000, v39
    v_bitop3_b32 v95, v37, v5, v46 bitop3:0xea
    v_perm_b32 v15, v37, v38, s47
    v_bitop3_b32 v46, v37, 0.5, -0.5 bitop3:0xa8
    v_perm_b32 v14, v36, v38, s46
    v_bitop3_b32 v47, v36, 0.5, -0.5 bitop3:0xa8
    v_cvt_pk_bf16_f32 v80, v80, v81
    v_cvt_pk_bf16_f32 v81, v82, v83
    ds_wrxchg_rtn_b64 v[74:75], v93, v[80:81] offset:65408
    v_cvt_pk_bf16_f32 v76, v76, v77
    v_cvt_pk_bf16_f32 v77, v78, v79
    ds_wrxchg_rtn_b64 v[72:73], v92, v[76:77] offset:65408
    v_and_b32 v88, 0x0fffffff, v44
    v_mov_b32 v39, v44
    buffer_load_dwordx2 v[34:35], v88, s[8:11], 0 offen
    buffer_load_dwordx3 v[36:38], v88, s[8:11], 0 offen offset:8
    s_setprio 0
    s_waitcnt vmcnt(8)
    ds_write_addtid_b32 v112 offset:1024
    ds_write_addtid_b32 v113 offset:1280
    ds_write_addtid_b32 v114 offset:1536
    ds_write_addtid_b32 v115 offset:1792
    v_mfma_f32_4x4x4_16b_bf16 v[80:83], v[8:9], v[106:107], 0
    v_mfma_f32_4x4x4_16b_bf16 v[76:79], v[8:9], v[104:105], 0
    v_bitop3_b32 v15, v6, v15, v46 bitop3:0xca
    v_bitop3_b32 v14, v6, v14, v47 bitop3:0xca
    s_nop 1
    v_pk_mul_f32 v[80:81], v[80:81], v[14:15] op_sel:[0,1] op_sel_hi:[1,1]
    v_pk_mul_f32 v[82:83], v[82:83], v[14:15] op_sel:[0,1] op_sel_hi:[1,1]
    v_pk_mul_f32 v[76:77], v[76:77], v[14:15] op_sel:[0,0] op_sel_hi:[1,0]
    v_pk_mul_f32 v[78:79], v[78:79], v[14:15] op_sel:[0,0] op_sel_hi:[1,0]
    s_add_u32 s42, s42, 1
    s_waitcnt lgkmcnt(0)
    s_barrier
    s_bitcmp1_b32 s36, s42
    s_cbranch_scc1 L2_slow
L2_ret7:
    s_setprio 3
    v_cmp_ne_u64 s[50:51], v[72:73], v[68:69]
    v_cmpx_ne_u64 s[54:55], v[74:75], v[70:71]
    s_and_b64 s[82:83], s[54:55], s[80:81]
    s_cbranch_scc1 L2_c134
L2_d134:
    v_mov_b64 v[84:85], v[70:71]
    v_mov_b32 v7, v93
    v_mov_b64 v[86:87], v[74:75]
    s_or_b64 s[80:81], s[80:81], s[54:55]
    s_mov_b64 exec, s[50:51]
    s_and_b64 s[82:83], s[50:51], s[80:81]
    s_cbranch_scc1 L2_c135
L2_d135:
    v_mov_b64 v[84:85], v[68:69]
    v_mov_b32 v7, v92
    v_mov_b64 v[86:87], v[72:73]
    s_mov_b64 exec, -1
    s_or_b64 s[80:81], s[80:81], s[50:51]
    ds_read_b64 v[70:71], v95 offset:65408
    ds_read_b64 v[68:69], v94 offset:65408
    s_waitcnt vmcnt(6)
    v_and_b32 v46, 0x20000000, v21
    v_lshrrev_b32 v47, 14, v17
    v_bitop3_b32 v47, v47, v5, v46 bitop3:0xea
    ds_read_b64 v[102:103], v47
    v_bitop3_b32 v93, v17, v5, v46 bitop3:0xea
    v_and_b32 v46, 0x10000000, v21
    v_lshrrev_b32 v47, 14, v16
    v_bitop3_b32 v47, v47, v5, v46 bitop3:0xea
    ds_read_b64 v[100:101], v47
    v_bitop3_b32 v92, v16, v5, v46 bitop3:0xea
    s_waitcnt lgkmcnt(2)
    v_mfma_f32_4x4x4_16b_bf16 v[80:83], v[10:11], v[70:71], v[80:83]
    v_mfma_f32_4x4x4_16b_bf16 v[76:79], v[10:11], v[68:69], v[76:79]
    v_perm_b32 v15, v17, v20, s45
    v_bitop3_b32 v46, v17, 0.5, -0.5 bitop3:0xa8
    v_perm_b32 v14, v16, v20, s44
    v_bitop3_b32 v47, v16, 0.5, -0.5 bitop3:0xa8
    v_cvt_pk_bf16_f32 v80, v80, v81
    v_cvt_pk_bf16_f32 v81, v82, v83
    ds_wrxchg_rtn_b64 v[74:75], v95, v[80:81] offset:65408
    v_cvt_pk_bf16_f32 v76, v76, v77
    v_cvt_pk_bf16_f32 v77, v78, v79
    ds_wrxchg_rtn_b64 v[72:73], v94, v[76:77] offset:65408
    s_waitcnt lgkmcnt(2)
    v_mfma_f32_4x4x4_16b_bf16 v[80:83], v[8:9], v[102:103], 0
    v_mfma_f32_4x4x4_16b_bf16 v[76:79], v[8:9], v[100:101], 0
    v_bitop3_b32 v15, v6, v15, v46 bitop3:0xca
    v_bitop3_b32 v14, v6, v14, v47 bitop3:0xca
    v_cmp_lt_u32 s[84:85], v5, v92
    s_nop 0
    v_pk_mul_f32 v[80:81], v[80:81], v[14:15] op_sel:[0,1] op_sel_hi:[1,1]
    v_pk_mul_f32 v[82:83], v[82:83], v[14:15] op_sel:[0,1] op_sel_hi:[1,1]
    v_pk_mul_f32 v[76:77], v[76:77], v[14:15] op_sel:[0,0] op_sel_hi:[1,0]
    v_pk_mul_f32 v[78:79], v[78:79], v[14:15] op_sel:[0,0] op_sel_hi:[1,0]
    s_waitcnt lgkmcnt(0)
    v_cmp_ne_u64 s[50:51], v[72:73], v[68:69]
    v_cmpx_ne_u64 s[54:55], v[74:75], v[70:71]
    s_and_b64 s[82:83], s[54:55], s[80:81]
    s_cbranch_scc1 L2_c136
L2_d136:
    v_mov_b64 v[84:85], v[70:71]
    v_mov_b32 v7, v95
    v_mov_b64 v[86:87], v[74:75]
    s_or_b64 s[80:81], s[80:81], s[54:55]
    s_mov_b64 exec, s[50:51]
    s_and_b64 s[82:83], s[50:51], s[80:81]
    s_cbranch_scc1 L2_c137
L2_d137:
    v_mov_b64 v[84:85], v[68:69]
    v_mov_b32 v7, v94
    v_mov_b64 v[86:87], v[72:73]
    s_mov_b64 exec, -1
    s_or_b64 s[80:81], s[80:81], s[50:51]
    ds_read_b64 v[70:71], v93 offset:65408
    s_and_b64 exec, s[84:85], s[80:81]
    v_mfma_f32_4x4x4_16b_bf16 v[76:79], v[12:13], v[84:85], 0
    v_mov_b32 v92, v7
    s_andn2_b64 s[80:81], s[80:81], s[84:85]
    v_mfma_f32_4x4x4_16b_bf16 v[76:79], v[10:11], v[86:87], v[76:79]
    s_mov_b64 exec, -1
    ds_read_b64 v[68:69], v92 offset:65408
    v_and_b32 v46, 0x80000000, v21
    v_lshrrev_b32 v47, 14, v19
    v_bitop3_b32 v47, v47, v5, v46 bitop3:0xea
    ds_read_b64 v[106:107], v47
    v_bitop3_b32 v95, v19, v5, v46 bitop3:0xea
    v_and_b32 v46, 0x40000000, v21
    v_lshrrev_b32 v47, 14, v18
    v_bitop3_b32 v47, v47, v5, v46 bitop3:0xea
    ds_read_b64 v[104:105], v47
    v_bitop3_b32 v94, v18, v5, v46 bitop3:0xea
    s_waitcnt lgkmcnt(2)
    v_mfma_f32_4x4x4_16b_bf16 v[80:83], v[10:11], v[70:71], v[80:83]
    v_mfma_f32_4x4x4_16b_bf16 v[76:79], v[10:11], v[68:69], v[76:79]
    v_perm_b32 v15, v19, v20, s47
    v_bitop3_b32 v46, v19, 0.5, -0.5 bitop3:0xa8
    v_perm_b32 v14, v18, v20, s46
    v_bitop3_b32 v47, v18, 0.5, -0.5 bitop3:0xa8
    v_cvt_pk_bf16_f32 v80, v80, v81
    v_cvt_pk_bf16_f32 v81, v82, v83
    ds_wrxchg_rtn_b64 v[74:75], v93, v[80:81] offset:65408
    v_cvt_pk_bf16_f32 v76, v76, v77
    v_cvt_pk_bf16_f32 v77, v78, v79
    ds_wrxchg_rtn_b64 v[72:73], v92, v[76:77] offset:65408
    s_setprio 2
    s_waitcnt lgkmcnt(2)
    v_mfma_f32_4x4x4_16b_bf16 v[80:83], v[8:9], v[106:107], 0
    v_mfma_f32_4x4x4_16b_bf16 v[76:79], v[8:9], v[104:105], 0
    v_bitop3_b32 v15, v6, v15, v46 bitop3:0xca
    v_bitop3_b32 v14, v6, v14, v47 bitop3:0xca
    s_nop 1
    v_pk_mul_f32 v[80:81], v[80:81], v[14:15] op_sel:[0,1] op_sel_hi:[1,1]
    v_pk_mul_f32 v[82:83], v[82:83], v[14:15] op_sel:[0,1] op_sel_hi:[1,1]
    v_pk_mul_f32 v[76:77], v[76:77], v[14:15] op_sel:[0,0] op_sel_hi:[1,0]
    v_pk_mul_f32 v[78:79], v[78:79], v[14:15] op_sel:[0,0] op_sel_hi:[1,0]
    s_waitcnt lgkmcnt(0)
    v_cmp_ne_u64 s[50:51], v[72:73], v[68:69]
    v_cmpx_ne_u64 s[54:55], v[74:75], v[70:71]
    s_and_b64 s[82:83], s[54:55], s[80:81]
    s_cbranch_scc1 L2_c138
L2_d138:
    v_mov_b64 v[84:85], v[70:71]
    v_mov_b32 v7, v93
    v_mov_b64 v[86:87], v[74:75]
    s_or_b64 s[80:81], s[80:81], s[54:55]
    s_mov_b64 exec, s[50:51]
    s_and_b64 s[82:83], s[50:51], s[80:81]
    s_cbranch_scc1 L2_c139
L2_d139:
    v_mov_b64 v[84:85], v[68:69]
    v_mov_b32 v7, v92
    v_mov_b64 v[86:87], v[72:73]
    s_mov_b64 exec, -1
    s_or_b64 s[80:81], s[80:81], s[50:51]
    ds_read_b64 v[70:71], v95 offset:65408
    ds_read_b64 v[68:69], v94 offset:65408
    s_waitcnt vmcnt(4)
    v_and_b32 v46, 0x20000000, v27
    v_lshrrev_b32 v47, 14, v23
    v_bitop3_b32 v47, v47, v5, v46 bitop3:0xea
    ds_read_b64 v[102:103], v47
    v_bitop3_b32 v93, v23, v5, v46 bitop3:0xea
    v_and_b32 v46, 0x10000000, v27
    v_lshrrev_b32 v47, 14, v22
    v_bitop3_b32 v47, v47, v5, v46 bitop3:0xea
    ds_read_b64 v[100:101], v47
    v_bitop3_b32 v92, v22, v5, v46 bitop3:0xea
    s_waitcnt lgkmcnt(2)
    v_mfma_f32_4x4x4_16b_bf16 v[80:83], v[10:11], v[70:71], v[80:83]
    v_mfma_f32_4x4x4_16b_bf16 v[76:79], v[10:11], v[68:69], v[76:79]
    v_perm_b32 v15, v23, v26, s45
    v_bitop3_b32 v46, v23, 0.5, -0.5 bitop3:0xa8
    v_perm_b32 v14, v22, v26, s44
    v_bitop3_b32 v47, v22, 0.5, -0.5 bitop3:0xa8
    v_cvt_pk_bf16_f32 v80, v80, v81
    v_cvt_pk_bf16_f32 v81, v82, v83
    ds_wrxchg_rtn_b64 v[74:75], v95, v[80:81] offset:65408
    v_cvt_pk_bf16_f32 v76, v76, v77
    v_cvt_pk_bf16_f32 v77, v78, v79
    ds_wrxchg_rtn_b64 v[72:73], v94, v[76:77] offset:65408
    s_waitcnt lgkmcnt(2)
    v_mfma_f32_4x4x4_16b_bf16 v[80:83], v[8:9], v[102:103], 0
    v_mfma_f32_4x4x4_16b_bf16 v[76:79], v[8:9], v[100:101], 0
    v_bitop3_b32 v15, v6, v15, v46 bitop3:0xca
    v_bitop3_b32 v14, v6, v14, v47 bitop3:0xca
    v_cmp_lt_u32 s[84:85], v5, v92
    s_nop 0
    v_pk_mul_f32 v[80:81], v[80:81], v[14:15] op_sel:[0,1] op_sel_hi:[1,1]
    v_pk_mul_f32 v[82:83], v[82:83], v[14:15] op_sel:[0,1] op_sel_hi:[1,1]
    v_pk_mul_f32 v[76:77], v[76:77], v[14:15] op_sel:[0,0] op_sel_hi:[1,0]
    v_pk_mul_f32 v[78:79], v[78:79], v[14:15] op_sel:[0,0] op_sel_hi:[1,0]
    s_waitcnt lgkmcnt(0)
    v_cmp_ne_u64 s[50:51], v[72:73], v[68:69]
    v_cmpx_ne_u64 s[54:55], v[74:75], v[70:71]
    s_and_b64 s[82:83], s[54:55], s[80:81]
    s_cbranch_scc1 L2_c140
L2_d140:
    v_mov_b64 v[84:85], v[70:71]
    v_mov_b32 v7, v95
    v_mov_b64 v[86:87], v[74:75]
    s_or_b64 s[80:81], s[80:81], s[54:55]
    s_mov_b64 exec, s[50:51]
    s_and_b64 s[82:83], s[50:51], s[80:81]
    s_cbranch_scc1 L2_c141
L2_d141:
    v_mov_b64 v[84:85], v[68:69]
    v_mov_b32 v7, v94
    v_mov_b64 v[86:87], v[72:73]
    s_mov_b64 exec, -1
    s_or_b64 s[80:81], s[80:81], s[50:51]
    ds_read_b64 v[70:71], v93 offset:65408
    s_and_b64 exec, s[84:85], s[80:81]
    v_mfma_f32_4x4x4_16b_bf16 v[76:79], v[12:13], v[84:85], 0
    v_mov_b32 v92, v7
    s_andn2_b64 s[80:81], s[80:81], s[84:85]
    v_mfma_f32_4x4x4_16b_bf16 v[76:79], v[10:11], v[86:87], v[76:79]
    s_mov_b64 exec, -1
    ds_read_b64 v[68:69], v92 offset:65408
    v_and_b32 v46, 0x80000000, v27
    v_lshrrev_b32 v47, 14, v25
    v_bitop3_b32 v47, v47, v5, v46 bitop3:0xea
    ds_read_b64 v[106:107], v47
    v_bitop3_b32 v95, v25, v5, v46 bitop3:0xea
    v_and_b32 v46, 0x40000000, v27
    v_lshrrev_b32 v47, 14, v24
    v_bitop3_b32 v47, v47, v5, v46 bitop3:0xea
    ds_read_b64 v[104:105], v47
    v_bitop3_b32 v94, v24, v5, v46 bitop3:0xea
    s_waitcnt lgkmcnt(2)
    v_mfma_f32_4x4x4_16b_bf16 v[80:83], v[10:11], v[70:71], v[80:83]
    v_mfma_f32_4x4x4_16b_bf16 v[76:79], v[10:11], v[68:69], v[76:79]
    v_perm_b32 v15, v25, v26, s47
    v_bitop3_b32 v46, v25, 0.5, -0.5 bitop3:0xa8
    v_perm_b32 v14, v24, v26, s46
    v_bitop3_b32 v47, v24, 0.5, -0.5 bitop3:0xa8
    v_cvt_pk_bf16_f32 v80, v80, v81
    v_cvt_pk_bf16_f32 v81, v82, v83
    ds_wrxchg_rtn_b64 v[74:75], v93, v[80:81] offset:65408
    v_cvt_pk_bf16_f32 v76, v76, v77
    v_cvt_pk_bf16_f32 v77, v78, v79
    ds_wrxchg_rtn_b64 v[72:73], v92, v[76:77] offset:65408
    s_setprio 1
    s_waitcnt lgkmcnt(2)
    v_mfma_f32_4x4x4_16b_bf16 v[80:83], v[8:9], v[106:107], 0
    v_mfma_f32_4x4x4_16b_bf16 v[76:79], v[8:9], v[104:105], 0
    v_bitop3_b32 v15, v6, v15, v46 bitop3:0xca
    v_bitop3_b32 v14, v6, v14, v47 bitop3:0xca
    s_nop 1
    v_pk_mul_f32 v[80:81], v[80:81], v[14:15] op_sel:[0,1] op_sel_hi:[1,1]
    v_pk_mul_f32 v[82:83], v[82:83], v[14:15] op_sel:[0,1] op_sel_hi:[1,1]
    v_pk_mul_f32 v[76:77], v[76:77], v[14:15] op_sel:[0,0] op_sel_hi:[1,0]
    v_pk_mul_f32 v[78:79], v[78:79], v[14:15] op_sel:[0,0] op_sel_hi:[1,0]
    s_lshl_b32 s3, s32, 12
    v_subrev_u32 v122, s3, v3
    s_mul_i32 s3, s33, 20000
    v_add_u32 v118, s3, v122
    v_add_u32 v119, 0x4000, v118
    s_lshl_b32 s3, s34, 7
    v_lshrrev_b32 v123, 7, v118
    v_and_b32 v120, 0x70, v118
    v_lshl_add_u32 v120, v123, 13, v120
    v_add_u32 v120, s3, v120
    v_lshrrev_b32 v123, 7, v119
    v_and_b32 v121, 0x70, v119
    v_lshl_add_u32 v121, v123, 13, v121
    v_add_u32 v121, s3, v121
    v_cmp_le_u32 vcc, 3616, v122
    s_mov_b64 exec, vcc
    v_mov_b32 v119, 2.0
    v_mov_b32 v121, 2.0
    s_mov_b64 exec, -1
    v_and_b32 v123, 0x30, v122
    v_lshlrev_b32 v123, 2, v123
    buffer_load_dwordx4 v[48:51], v123, s[24:27], 0 offen
    buffer_load_dwordx4 v[52:55], v123, s[24:27], 0 offen offset:16
    buffer_load_dwordx2 v[56:57], v123, s[24:27], 0 offen offset:32
    s_mov_b32 s12, s4
    s_mov_b32 s13, s5
    s_mov_b32 s14, 0x138800
    s_mov_b32 s15, 0x20000
    s_mov_b32 s16, s28
    s_mov_b32 s17, s29
    s_mov_b32 s18, 0x4e2000
    s_mov_b32 s19, 0x20000
    v_lshrrev_b32 v123, 2, v120
    buffer_load_dword v116, v123, s[12:15], 0 offen
    buffer_load_dwordx4 v[108:111], v120, s[16:19], 0 offen
    v_lshrrev_b32 v123, 2, v121
    buffer_load_dword v117, v123, s[12:15], 0 offen
    buffer_load_dwordx4 v[112:115], v121, s[16:19], 0 offen
    s_waitcnt lgkmcnt(0)
    v_cmp_ne_u64 s[50:51], v[72:73], v[68:69]
    v_cmpx_ne_u64 s[54:55], v[74:75], v[70:71]
    s_and_b64 s[82:83], s[54:55], s[80:81]
    s_cbranch_scc1 L2_c142
L2_d142:
    v_mov_b64 v[84:85], v[70:71]
    v_mov_b32 v7, v93
    v_mov_b64 v[86:87], v[74:75]
    s_or_b64 s[80:81], s[80:81], s[54:55]
    s_mov_b64 exec, s[50:51]
    s_and_b64 s[82:83], s[50:51], s[80:81]
    s_cbranch_scc1 L2_c143
L2_d143:
    v_mov_b64 v[84:85], v[68:69]
    v_mov_b32 v7, v92
    v_mov_b64 v[86:87], v[72:73]
    s_mov_b64 exec, -1
    s_or_b64 s[80:81], s[80:81], s[50:51]
    ds_read_b64 v[70:71], v95 offset:65408
    ds_read_b64 v[68:69], v94 offset:65408
    s_waitcnt vmcnt(9)
    v_and_b32 v46, 0x20000000, v33
    v_lshrrev_b32 v47, 14, v29
    v_bitop3_b32 v47, v47, v5, v46 bitop3:0xea
    ds_read_b64 v[102:103], v47
    v_bitop3_b32 v93, v29, v5, v46 bitop3:0xea
    v_and_b32 v46, 0x10000000, v33
    v_lshrrev_b32 v47, 14, v28
    v_bitop3_b32 v47, v47, v5, v46 bitop3:0xea
    ds_read_b64 v[100:101], v47
    v_bitop3_b32 v92, v28, v5, v46 bitop3:0xea
    s_waitcnt lgkmcnt(2)
    v_mfma_f32_4x4x4_16b_bf16 v[80:83], v[10:11], v[70:71], v[80:83]
    v_mfma_f32_4x4x4_16b_bf16 v[76:79], v[10:11], v[68:69], v[76:79]
    v_perm_b32 v15, v29, v32, s45
    v_bitop3_b32 v46, v29, 0.5, -0.5 bitop3:0xa8
    v_perm_b32 v14, v28, v32, s44
    v_bitop3_b32 v47, v28, 0.5, -0.5 bitop3:0xa8
    v_cvt_pk_bf16_f32 v80, v80, v81
    v_cvt_pk_bf16_f32 v81, v82, v83
    ds_wrxchg_rtn_b64 v[74:75], v95, v[80:81] offset:65408
    v_cvt_pk_bf16_f32 v76, v76, v77
    v_cvt_pk_bf16_f32 v77, v78, v79
    ds_wrxchg_rtn_b64 v[72:73], v94, v[76:77] offset:65408
    s_waitcnt lgkmcnt(2)
    v_mfma_f32_4x4x4_16b_bf16 v[80:83], v[8:9], v[102:103], 0
    v_mfma_f32_4x4x4_16b_bf16 v[76:79], v[8:9], v[100:101], 0
    v_bitop3_b32 v15, v6, v15, v46 bitop3:0xca
    v_bitop3_b32 v14, v6, v14, v47 bitop3:0xca
    v_cmp_lt_u32 s[84:85], v5, v92
    s_nop 0
    v_pk_mul_f32 v[80:81], v[80:81], v[14:15] op_sel:[0,1] op_sel_hi:[1,1]
    v_pk_mul_f32 v[82:83], v[82:83], v[14:15] op_sel:[0,1] op_sel_hi:[1,1]
    v_pk_mul_f32 v[76:77], v[76:77], v[14:15] op_sel:[0,0] op_sel_hi:[1,0]
    v_pk_mul_f32 v[78:79], v[78:79], v[14:15] op_sel:[0,0] op_sel_hi:[1,0]
    s_waitcnt lgkmcnt(0)
    v_cmp_ne_u64 s[50:51], v[72:73], v[68:69]
    v_cmpx_ne_u64 s[54:55], v[74:75], v[70:71]
    s_and_b64 s[82:83], s[54:55], s[80:81]
    s_cbranch_scc1 L2_c144
L2_d144:
    v_mov_b64 v[84:85], v[70:71]
    v_mov_b32 v7, v95
    v_mov_b64 v[86:87], v[74:75]
    s_or_b64 s[80:81], s[80:81], s[54:55]
    s_mov_b64 exec, s[50:51]
    s_and_b64 s[82:83], s[50:51], s[80:81]
    s_cbranch_scc1 L2_c145
L2_d145:
    v_mov_b64 v[84:85], v[68:69]
    v_mov_b32 v7, v94
    v_mov_b64 v[86:87], v[72:73]
    s_mov_b64 exec, -1
    s_or_b64 s[80:81], s[80:81], s[50:51]
    ds_read_b64 v[70:71], v93 offset:65408
    s_and_b64 exec, s[84:85], s[80:81]
    v_mfma_f32_4x4x4_16b_bf16 v[76:79], v[12:13], v[84:85], 0
    v_mov_b32 v92, v7
    s_andn2_b64 s[80:81], s[80:81], s[84:85]
    v_mfma_f32_4x4x4_16b_bf16 v[76:79], v[10:11], v[86:87], v[76:79]
    s_mov_b64 exec, -1
    ds_read_b64 v[68:69], v92 offset:65408
    v_and_b32 v46, 0x80000000, v33
    v_lshrrev_b32 v47, 14, v31
    v_bitop3_b32 v47, v47, v5, v46 bitop3:0xea
    ds_read_b64 v[106:107], v47
    v_bitop3_b32 v95, v31, v5, v46 bitop3:0xea
    v_and_b32 v46, 0x40000000, v33
    v_lshrrev_b32 v47, 14, v30
    v_bitop3_b32 v47, v47, v5, v46 bitop3:0xea
    ds_read_b64 v[104:105], v47
    v_bitop3_b32 v94, v30, v5, v46 bitop3:0xea
    s_waitcnt lgkmcnt(2)
    v_mfma_f32_4x4x4_16b_bf16 v[80:83], v[10:11], v[70:71], v[80:83]
    v_mfma_f32_4x4x4_16b_bf16 v[76:79], v[10:11], v[68:69], v[76:79]
    v_perm_b32 v15, v31, v32, s47
    v_bitop3_b32 v46, v31, 0.5, -0.5 bitop3:0xa8
    v_perm_b32 v14, v30, v32, s46
    v_bitop3_b32 v47, v30, 0.5, -0.5 bitop3:0xa8
    v_cvt_pk_bf16_f32 v80, v80, v81
    v_cvt_pk_bf16_f32 v81, v82, v83
    ds_wrxchg_rtn_b64 v[74:75], v93, v[80:81] offset:65408
    v_cvt_pk_bf16_f32 v76, v76, v77
    v_cvt_pk_bf16_f32 v77, v78, v79
    ds_wrxchg_rtn_b64 v[72:73], v92, v[76:77] offset:65408
    s_setprio 0
    s_waitcnt lgkmcnt(2)
    v_mfma_f32_4x4x4_16b_bf16 v[80:83], v[8:9], v[106:107], 0
    v_mfma_f32_4x4x4_16b_bf16 v[76:79], v[8:9], v[104:105], 0
    v_bitop3_b32 v15, v6, v15, v46 bitop3:0xca
    v_bitop3_b32 v14, v6, v14, v47 bitop3:0xca
    s_nop 1
    v_pk_mul_f32 v[80:81], v[80:81], v[14:15] op_sel:[0,1] op_sel_hi:[1,1]
    v_pk_mul_f32 v[82:83], v[82:83], v[14:15] op_sel:[0,1] op_sel_hi:[1,1]
    v_pk_mul_f32 v[76:77], v[76:77], v[14:15] op_sel:[0,0] op_sel_hi:[1,0]
    v_pk_mul_f32 v[78:79], v[78:79], v[14:15] op_sel:[0,0] op_sel_hi:[1,0]
    s_waitcnt lgkmcnt(0)
    v_cmp_ne_u64 s[50:51], v[72:73], v[68:69]
    v_cmpx_ne_u64 s[54:55], v[74:75], v[70:71]
    s_and_b64 s[82:83], s[54:55], s[80:81]
    s_cbranch_scc1 L2_c146
L2_d146:
    v_mov_b64 v[84:85], v[70:71]
    v_mov_b32 v7, v93
    v_mov_b64 v[86:87], v[74:75]
    s_or_b64 s[80:81], s[80:81], s[54:55]
    s_mov_b64 exec, s[50:51]
    s_and_b64 s[82:83], s[50:51], s[80:81]
    s_cbranch_scc1 L2_c147
L2_d147:
    v_mov_b64 v[84:85], v[68:69]
    v_mov_b32 v7, v92
    v_mov_b64 v[86:87], v[72:73]
    s_mov_b64 exec, -1
    s_or_b64 s[80:81], s[80:81], s[50:51]
    ds_read_b64 v[70:71], v95 offset:65408
    ds_read_b64 v[68:69], v94 offset:65408
    s_waitcnt vmcnt(7)
    v_and_b32 v46, 0x20000000, v39
    v_lshrrev_b32 v47, 14, v35
    v_bitop3_b32 v47, v47, v5, v46 bitop3:0xea
    ds_read_b64 v[102:103], v47
    v_bitop3_b32 v93, v35, v5, v46 bitop3:0xea
    v_and_b32 v46, 0x10000000, v39
    v_lshrrev_b32 v47, 14, v34
    v_bitop3_b32 v47, v47, v5, v46 bitop3:0xea
    ds_read_b64 v[100:101], v47
    v_bitop3_b32 v92, v34, v5, v46 bitop3:0xea
    v_and_b32 v46, 0x80000000, v39
    v_lshrrev_b32 v47, 14, v37
    v_bitop3_b32 v47, v47, v5, v46 bitop3:0xea
    ds_read_b64 v[106:107], v47
    v_and_b32 v46, 0x40000000, v39
    v_lshrrev_b32 v47, 14, v36
    v_bitop3_b32 v47, v47, v5, v46 bitop3:0xea
    ds_read_b64 v[104:105], v47
    s_waitcnt lgkmcnt(4)
    v_mfma_f32_4x4x4_16b_bf16 v[80:83], v[10:11], v[70:71], v[80:83]
    v_mfma_f32_4x4x4_16b_bf16 v[76:79], v[10:11], v[68:69], v[76:79]
    v_perm_b32 v15, v35, v38, s45
    v_bitop3_b32 v46, v35, 0.5, -0.5 bitop3:0xa8
    v_perm_b32 v14, v34, v38, s44
    v_bitop3_b32 v47, v34, 0.5, -0.5 bitop3:0xa8
    v_cvt_pk_bf16_f32 v80, v80, v81
    v_cvt_pk_bf16_f32 v81, v82, v83
    ds_wrxchg_rtn_b64 v[74:75], v95, v[80:81] offset:65408
    v_cvt_pk_bf16_f32 v76, v76, v77
    v_cvt_pk_bf16_f32 v77, v78, v79
    ds_wrxchg_rtn_b64 v[72:73], v94, v[76:77] offset:65408
    s_waitcnt lgkmcnt(4)
    v_mfma_f32_4x4x4_16b_bf16 v[80:83], v[8:9], v[102:103], 0
    v_mfma_f32_4x4x4_16b_bf16 v[76:79], v[8:9], v[100:101], 0
    v_bitop3_b32 v15, v6, v15, v46 bitop3:0xca
    v_bitop3_b32 v14, v6, v14, v47 bitop3:0xca
    v_cmp_lt_u32 s[84:85], v5, v92
    s_nop 0
    v_pk_mul_f32 v[80:81], v[80:81], v[14:15] op_sel:[0,1] op_sel_hi:[1,1]
    v_pk_mul_f32 v[82:83], v[82:83], v[14:15] op_sel:[0,1] op_sel_hi:[1,1]
    v_pk_mul_f32 v[76:77], v[76:77], v[14:15] op_sel:[0,0] op_sel_hi:[1,0]
    v_pk_mul_f32 v[78:79], v[78:79], v[14:15] op_sel:[0,0] op_sel_hi:[1,0]
    s_waitcnt lgkmcnt(0)
    v_cmp_ne_u64 s[50:51], v[72:73], v[68:69]
    v_cmpx_ne_u64 s[54:55], v[74:75], v[70:71]
    s_and_b64 s[82:83], s[54:55], s[80:81]
    s_cbranch_scc1 L2_c148
L2_d148:
    v_mov_b64 v[84:85], v[70:71]
    v_mov_b32 v7, v95
    v_mov_b64 v[86:87], v[74:75]
    s_or_b64 s[80:81], s[80:81], s[54:55]
    s_mov_b64 exec, s[50:51]
    s_and_b64 s[82:83], s[50:51], s[80:81]
    s_cbranch_scc1 L2_c149
L2_d149:
    v_mov_b64 v[84:85], v[68:69]
    v_mov_b32 v7, v94
    v_mov_b64 v[86:87], v[72:73]
    s_mov_b64 exec, -1
    s_or_b64 s[80:81], s[80:81], s[50:51]
    ds_read_b64 v[70:71], v93 offset:65408
    s_and_b64 exec, s[84:85], s[80:81]
    v_mfma_f32_4x4x4_16b_bf16 v[76:79], v[12:13], v[84:85], 0
    v_mov_b32 v92, v7
    s_andn2_b64 s[80:81], s[80:81], s[84:85]
    v_mfma_f32_4x4x4_16b_bf16 v[76:79], v[10:11], v[86:87], v[76:79]
    s_mov_b64 exec, -1
    ds_read_b64 v[68:69], v92 offset:65408
    s_waitcnt lgkmcnt(0)
    v_mfma_f32_4x4x4_16b_bf16 v[80:83], v[10:11], v[70:71], v[80:83]
    v_mfma_f32_4x4x4_16b_bf16 v[76:79], v[10:11], v[68:69], v[76:79]
    v_and_b32 v46, 0x40000000, v39
    v_bitop3_b32 v94, v36, v5, v46 bitop3:0xea
    v_and_b32 v46, 0x80000000, v39
    v_bitop3_b32 v95, v37, v5, v46 bitop3:0xea
    v_perm_b32 v15, v37, v38, s47
    v_bitop3_b32 v46, v37, 0.5, -0.5 bitop3:0xa8
    v_perm_b32 v14, v36, v38, s46
    v_bitop3_b32 v47, v36, 0.5, -0.5 bitop3:0xa8
    v_cvt_pk_bf16_f32 v80, v80, v81
    v_cvt_pk_bf16_f32 v81, v82, v83
    ds_wrxchg_rtn_b64 v[74:75], v93, v[80:81] offset:65408
    v_cvt_pk_bf16_f32 v76, v76, v77
    v_cvt_pk_bf16_f32 v77, v78, v79
    ds_wrxchg_rtn_b64 v[72:73], v92, v[76:77] offset:65408
    v_mfma_f32_4x4x4_16b_bf16 v[80:83], v[8:9], v[106:107], 0
    v_mfma_f32_4x4x4_16b_bf16 v[76:79], v[8:9], v[104:105], 0
    v_bitop3_b32 v15, v6, v15, v46 bitop3:0xca
    v_bitop3_b32 v14, v6, v14, v47 bitop3:0xca
    s_nop 1
    v_pk_mul_f32 v[80:81], v[80:81], v[14:15] op_sel:[0,1] op_sel_hi:[1,1]
    v_pk_mul_f32 v[82:83], v[82:83], v[14:15] op_sel:[0,1] op_sel_hi:[1,1]
    v_pk_mul_f32 v[76:77], v[76:77], v[14:15] op_sel:[0,0] op_sel_hi:[1,0]
    v_pk_mul_f32 v[78:79], v[78:79], v[14:15] op_sel:[0,0] op_sel_hi:[1,0]
    s_waitcnt lgkmcnt(0)
    v_cmp_ne_u64 s[50:51], v[72:73], v[68:69]
    v_cmpx_ne_u64 s[54:55], v[74:75], v[70:71]
    s_and_b64 s[82:83], s[54:55], s[80:81]
    s_cbranch_scc1 L2_c150
L2_d150:
    v_mov_b64 v[84:85], v[70:71]
    v_mov_b32 v7, v93
    v_mov_b64 v[86:87], v[74:75]
    s_or_b64 s[80:81], s[80:81], s[54:55]
    s_mov_b64 exec, s[50:51]
    s_and_b64 s[82:83], s[50:51], s[80:81]
    s_cbranch_scc1 L2_c151
L2_d151:
    v_mov_b64 v[84:85], v[68:69]
    v_mov_b32 v7, v92
    v_mov_b64 v[86:87], v[72:73]
    s_mov_b64 exec, -1
    s_or_b64 s[80:81], s[80:81], s[50:51]
    ds_read_b64 v[70:71], v95 offset:65408
    ds_read_b64 v[68:69], v94 offset:65408
    s_waitcnt lgkmcnt(0)
    v_mfma_f32_4x4x4_16b_bf16 v[80:83], v[10:11], v[70:71], v[80:83]
    v_mfma_f32_4x4x4_16b_bf16 v[76:79], v[10:11], v[68:69], v[76:79]
    s_nop 3
    v_cvt_pk_bf16_f32 v80, v80, v81
    v_cvt_pk_bf16_f32 v81, v82, v83
    ds_wrxchg_rtn_b64 v[74:75], v95, v[80:81] offset:65408
    v_cvt_pk_bf16_f32 v76, v76, v77
    v_cvt_pk_bf16_f32 v77, v78, v79
    ds_wrxchg_rtn_b64 v[72:73], v94, v[76:77] offset:65408
    s_waitcnt lgkmcnt(0)
    v_cmpx_ne_u64 vcc, v[74:75], v[70:71]
    s_and_b64 s[82:83], vcc, s[80:81]
    s_cbranch_scc1 L2_c152
L2_d152:
    v_mov_b64 v[84:85], v[70:71]
    v_mov_b32 v7, v95
    v_mov_b64 v[86:87], v[74:75]
    s_mov_b64 exec, -1
    s_or_b64 s[80:81], s[80:81], vcc
    v_cmpx_ne_u64 vcc, v[72:73], v[68:69]
    s_and_b64 s[82:83], vcc, s[80:81]
    s_cbranch_scc1 L2_c153
L2_d153:
    v_mov_b64 v[84:85], v[68:69]
    v_mov_b32 v7, v94
    v_mov_b64 v[86:87], v[72:73]
    s_mov_b64 exec, -1
    s_or_b64 s[80:81], s[80:81], vcc
    s_mov_b64 exec, s[80:81]
    s_nop 1
    v_mfma_f32_4x4x4_16b_bf16 v[88:91], v[12:13], v[84:85], 0
    s_nop 1
    v_mfma_f32_4x4x4_16b_bf16 v[88:91], v[10:11], v[86:87], v[88:91]
    s_nop 4
    v_cvt_pk_bf16_f32 v88, v88, v89
    v_cvt_pk_bf16_f32 v89, v90, v91
    ds_pk_add_bf16 v7, v88 offset:65408
    ds_pk_add_bf16 v7, v89 offset:65412
    s_mov_b64 exec, -1
    s_load_dwordx2 s[4:5], s[0:1], 88
    v_add_u32 v123, 0x4000, v122
    s_lshl_b32 s50, s96, 16
    s_and_b32 s51, s96, 0xffff0000
    s_lshl_b32 s52, s97, 16
    s_and_b32 s53, s97, 0xffff0000
    s_lshl_b32 s54, s98, 16
    s_and_b32 s55, s98, 0xffff0000
    s_lshl_b32 s56, s99, 16
    s_and_b32 s57, s99, 0xffff0000
    s_waitcnt vmcnt(0) lgkmcnt(0)
    s_barrier
    s_add_u32 s8, s30, 0xec46000
    s_addc_u32 s9, s31, 0
    s_mov_b32 s10, 0x8000
    s_mov_b32 s11, 0x20000
    s_mov_b32 s12, s4
    s_mov_b32 s13, s5
    s_mov_b32 s14, 0x4e2000
    s_mov_b32 s15, 0x20000
    s_add_u32 s20, s30, 0xd845000
    s_addc_u32 s21, s31, 0
    s_mov_b32 s22, 0x1400000
    s_mov_b32 s23, 0x20000
    s_lshl2_add_u32 s4, s34, s33
    s_mul_i32 s4, s4, 81920
    s_add_u32 s3, s33, 1
    s_and_b32 s3, s3, 3
    s_mul_i32 s36, s3, 20000
    s_add_u32 s36, s36, 81920
    s_mul_i32 s40, s3, 20480
    s_add_u32 s40, s40, s4
    s_lshl2_add_u32 s3, s34, s3
    s_mul_i32 s3, s3, 81920
    s_mul_i32 s44, s33, 20480
    s_add_u32 s44, s44, s3
    s_add_u32 s3, s33, 2
    s_and_b32 s3, s3, 3
    s_mul_i32 s37, s3, 20000
    s_add_u32 s37, s37, 81920
    s_mul_i32 s41, s3, 20480
    s_add_u32 s41, s41, s4
    s_lshl2_add_u32 s3, s34, s3
    s_mul_i32 s3, s3, 81920
    s_mul_i32 s45, s33, 20480
    s_add_u32 s45, s45, s3
    s_add_u32 s3, s33, 3
    s_and_b32 s3, s3, 3
    s_mul_i32 s38, s3, 20000
    s_add_u32 s38, s38, 81920
    s_mul_i32 s42, s3, 20480
    s_add_u32 s42, s42, s4
    s_lshl2_add_u32 s3, s34, s3
    s_mul_i32 s3, s3, 81920
    s_mul_i32 s46, s33, 20480
    s_add_u32 s46, s46, s3
    v_add_u32 v104, s36, v122
    ds_read_b128 v[16:19], v104
    v_add_u32 v104, s37, v122
    ds_read_b128 v[20:23], v104
    v_add_u32 v104, s38, v122
    ds_read_b128 v[24:27], v104
    s_waitcnt lgkmcnt(2)
    buffer_store_dwordx4 v[16:19], v122, s[20:23], s40 offen sc1
    s_waitcnt lgkmcnt(1)
    buffer_store_dwordx4 v[20:23], v122, s[20:23], s41 offen sc1
    s_waitcnt lgkmcnt(0)
    buffer_store_dwordx4 v[24:27], v122, s[20:23], s42 offen sc1
    s_cmp_ge_u32 s32, 4
    s_cbranch_scc1 L2_g0
    v_add_u32 v104, s36, v123
    ds_read_b128 v[36:39], v104
    v_add_u32 v104, s37, v123
    ds_read_b128 v[40:43], v104
    v_add_u32 v104, s38, v123
    ds_read_b128 v[44:47], v104
    s_waitcnt lgkmcnt(2)
    buffer_store_dwordx4 v[36:39], v123, s[20:23], s40 offen sc1
    s_waitcnt lgkmcnt(1)
    buffer_store_dwordx4 v[40:43], v123, s[20:23], s41 offen sc1
    s_waitcnt lgkmcnt(0)
    buffer_store_dwordx4 v[44:47], v123, s[20:23], s42 offen sc1
L2_g0:
    v_lshlrev_b32 v80, 16, v116
    v_subrev_f32 v60, s50, v80
    v_subrev_f32 v61, s51, v80
    v_subrev_f32 v62, s52, v80
    v_subrev_f32 v63, s53, v80
    v_subrev_f32 v64, s54, v80
    v_subrev_f32 v65, s55, v80
    v_subrev_f32 v66, s56, v80
    v_subrev_f32 v67, s57, v80
    v_cvt_pk_bf16_f32 v68, v60, v61
    v_cvt_pk_bf16_f32 v69, v62, v63
    v_cvt_pk_bf16_f32 v70, v64, v65
    v_cvt_pk_bf16_f32 v71, v66, v67
    v_lshlrev_b32 v60, 16, v68
    v_and_b32 v61, 0xffff0000, v68
    v_lshlrev_b32 v62, 16, v69
    v_and_b32 v63, 0xffff0000, v69
    v_lshlrev_b32 v64, 16, v70
    v_and_b32 v65, 0xffff0000, v70
    v_lshlrev_b32 v66, 16, v71
    v_and_b32 v67, 0xffff0000, v71
    v_mul_f32 v60, v60, v60
    v_mul_f32 v61, v61, v61
    v_mul_f32 v62, v62, v62
    v_mul_f32 v63, v63, v63
    v_mul_f32 v64, v64, v64
    v_mul_f32 v65, v65, v65
    v_mul_f32 v66, v66, v66
    v_mul_f32 v67, v67, v67
    v_cvt_pk_bf16_f32 v68, v60, v61
    v_cvt_pk_bf16_f32 v69, v62, v63
    v_cvt_pk_bf16_f32 v70, v64, v65
    v_cvt_pk_bf16_f32 v71, v66, v67
    v_lshlrev_b32 v60, 16, v68
    v_and_b32 v61, 0xffff0000, v68
    v_lshlrev_b32 v62, 16, v69
    v_and_b32 v63, 0xffff0000, v69
    v_lshlrev_b32 v64, 16, v70
    v_and_b32 v65, 0xffff0000, v70
    v_lshlrev_b32 v66, 16, v71
    v_and_b32 v67, 0xffff0000, v71
    v_mul_f32 v60, 0xc1200000, v60
    v_mul_f32 v61, 0xc1200000, v61
    v_mul_f32 v62, 0xc1200000, v62
    v_mul_f32 v63, 0xc1200000, v63
    v_mul_f32 v64, 0xc1200000, v64
    v_mul_f32 v65, 0xc1200000, v65
    v_mul_f32 v66, 0xc1200000, v66
    v_mul_f32 v67, 0xc1200000, v67
    v_cvt_pk_bf16_f32 v68, v60, v61
    v_cvt_pk_bf16_f32 v69, v62, v63
    v_cvt_pk_bf16_f32 v70, v64, v65
    v_cvt_pk_bf16_f32 v71, v66, v67
    v_lshlrev_b32 v60, 16, v68
    v_and_b32 v61, 0xffff0000, v68
    v_lshlrev_b32 v62, 16, v69
    v_and_b32 v63, 0xffff0000, v69
    v_lshlrev_b32 v64, 16, v70
    v_and_b32 v65, 0xffff0000, v70
    v_lshlrev_b32 v66, 16, v71
    v_and_b32 v67, 0xffff0000, v71
    v_mul_f32 v60, 0x3fb8aa3b, v60
    v_mul_f32 v61, 0x3fb8aa3b, v61
    v_mul_f32 v62, 0x3fb8aa3b, v62
    v_mul_f32 v63, 0x3fb8aa3b, v63
    v_mul_f32 v64, 0x3fb8aa3b, v64
    v_mul_f32 v65, 0x3fb8aa3b, v65
    v_mul_f32 v66, 0x3fb8aa3b, v66
    v_mul_f32 v67, 0x3fb8aa3b, v67
    v_exp_f32 v60, v60
    v_exp_f32 v61, v61
    v_exp_f32 v62, v62
    v_exp_f32 v63, v63
    v_exp_f32 v64, v64
    v_exp_f32 v65, v65
    v_exp_f32 v66, v66
    v_exp_f32 v67, v67
    v_cvt_pk_bf16_f32 v72, v60, v61
    v_cvt_pk_bf16_f32 v73, v62, v63
    v_cvt_pk_bf16_f32 v74, v64, v65
    v_cvt_pk_bf16_f32 v75, v66, v67
    v_and_b32 v80, 0xffff0000, v116
    v_subrev_f32 v60, s50, v80
    v_subrev_f32 v61, s51, v80
    v_subrev_f32 v62, s52, v80
    v_subrev_f32 v63, s53, v80
    v_subrev_f32 v64, s54, v80
    v_subrev_f32 v65, s55, v80
    v_subrev_f32 v66, s56, v80
    v_subrev_f32 v67, s57, v80
    v_cvt_pk_bf16_f32 v68, v60, v61
    v_cvt_pk_bf16_f32 v69, v62, v63
    v_cvt_pk_bf16_f32 v70, v64, v65
    v_cvt_pk_bf16_f32 v71, v66, v67
    v_lshlrev_b32 v60, 16, v68
    v_and_b32 v61, 0xffff0000, v68
    v_lshlrev_b32 v62, 16, v69
    v_and_b32 v63, 0xffff0000, v69
    v_lshlrev_b32 v64, 16, v70
    v_and_b32 v65, 0xffff0000, v70
    v_lshlrev_b32 v66, 16, v71
    v_and_b32 v67, 0xffff0000, v71
    v_mul_f32 v60, v60, v60
    v_mul_f32 v61, v61, v61
    v_mul_f32 v62, v62, v62
    v_mul_f32 v63, v63, v63
    v_mul_f32 v64, v64, v64
    v_mul_f32 v65, v65, v65
    v_mul_f32 v66, v66, v66
    v_mul_f32 v67, v67, v67
    v_cvt_pk_bf16_f32 v68, v60, v61
    v_cvt_pk_bf16_f32 v69, v62, v63
    v_cvt_pk_bf16_f32 v70, v64, v65
    v_cvt_pk_bf16_f32 v71, v66, v67
    v_lshlrev_b32 v60, 16, v68
    v_and_b32 v61, 0xffff0000, v68
    v_lshlrev_b32 v62, 16, v69
    v_and_b32 v63, 0xffff0000, v69
    v_lshlrev_b32 v64, 16, v70
    v_and_b32 v65, 0xffff0000, v70
    v_lshlrev_b32 v66, 16, v71
    v_and_b32 v67, 0xffff0000, v71
    v_mul_f32 v60, 0xc1200000, v60
    v_mul_f32 v61, 0xc1200000, v61
    v_mul_f32 v62, 0xc1200000, v62
    v_mul_f32 v63, 0xc1200000, v63
    v_mul_f32 v64, 0xc1200000, v64
    v_mul_f32 v65, 0xc1200000, v65
    v_mul_f32 v66, 0xc1200000, v66
    v_mul_f32 v67, 0xc1200000, v67
    v_cvt_pk_bf16_f32 v68, v60, v61
    v_cvt_pk_bf16_f32 v69, v62, v63
    v_cvt_pk_bf16_f32 v70, v64, v65
    v_cvt_pk_bf16_f32 v71, v66, v67
    v_lshlrev_b32 v60, 16, v68
    v_and_b32 v61, 0xffff0000, v68
    v_lshlrev_b32 v62, 16, v69
    v_and_b32 v63, 0xffff0000, v69
    v_lshlrev_b32 v64, 16, v70
    v_and_b32 v65, 0xffff0000, v70
    v_lshlrev_b32 v66, 16, v71
    v_and_b32 v67, 0xffff0000, v71
    v_mul_f32 v60, 0x3fb8aa3b, v60
    v_mul_f32 v61, 0x3fb8aa3b, v61
    v_mul_f32 v62, 0x3fb8aa3b, v62
    v_mul_f32 v63, 0x3fb8aa3b, v63
    v_mul_f32 v64, 0x3fb8aa3b, v64
    v_mul_f32 v65, 0x3fb8aa3b, v65
    v_mul_f32 v66, 0x3fb8aa3b, v66
    v_mul_f32 v67, 0x3fb8aa3b, v67
    v_exp_f32 v60, v60
    v_exp_f32 v61, v61
    v_exp_f32 v62, v62
    v_exp_f32 v63, v63
    v_exp_f32 v64, v64
    v_exp_f32 v65, v65
    v_exp_f32 v66, v66
    v_exp_f32 v67, v67
    v_cvt_pk_bf16_f32 v76, v60, v61
    v_cvt_pk_bf16_f32 v77, v62, v63
    v_cvt_pk_bf16_f32 v78, v64, v65
    v_cvt_pk_bf16_f32 v79, v66, v67
    v_mfma_f32_4x4x4_16b_bf16 v[80:83], v[48:49], v[72:73], 0
    v_mfma_f32_4x4x4_16b_bf16 v[88:91], v[52:53], v[72:73], 0
    v_mfma_f32_4x4x4_16b_bf16 v[84:87], v[48:49], v[76:77], 0
    v_mfma_f32_4x4x4_16b_bf16 v[92:95], v[52:53], v[76:77], 0
    v_mfma_f32_4x4x4_16b_bf16 v[80:83], v[50:51], v[74:75], v[80:83]
    v_mfma_f32_4x4x4_16b_bf16 v[88:91], v[54:55], v[74:75], v[88:91]
    v_mfma_f32_4x4x4_16b_bf16 v[84:87], v[50:51], v[78:79], v[84:87]
    v_mfma_f32_4x4x4_16b_bf16 v[92:95], v[54:55], v[78:79], v[92:95]
    s_lshl_b32 s3, s34, 9
    s_lshl_b32 s4, s33, 7
    s_add_u32 s4, s4, s3
    v_mov_b32 v104, 1
    v_and_b32 v105, 0x3f0, v122
    v_lshlrev_b32 v105, 3, v105
    v_add_u32 v106, 81920, v118
    ds_read_b128 v[32:35], v106
    v_add_u32 v106, 81920, v119
    ds_read_b128 v[60:63], v106
    s_waitcnt vmcnt(0)
    s_barrier
    s_cmp_lg_u32 s32, 0
    s_cbranch_scc1 L2_f2
    s_mov_b64 exec, 1
    buffer_store_dword v104, off, s[8:11], s4 sc1
    s_mov_b64 exec, 15
    s_bitset0_b64 exec, s33
L2_f3:
    buffer_load_dword v104, v105, s[8:11], s3 offen sc1
    s_waitcnt vmcnt(0)
    v_cmp_ne_u32 vcc, 1, v104
    s_cbranch_vccnz L2_f3s
    s_mov_b64 exec, -1
L2_f2:
    s_barrier
    buffer_load_dwordx4 v[36:39], v122, s[20:23], s44 offen sc1
    buffer_load_dwordx4 v[40:43], v122, s[20:23], s45 offen sc1
    buffer_load_dwordx4 v[44:47], v122, s[20:23], s46 offen sc1
    s_cmp_ge_u32 s32, 4
    s_cbranch_scc1 L2_f5
    buffer_load_dwordx4 v[64:67], v123, s[20:23], s44 offen sc1
    buffer_load_dwordx4 v[68:71], v123, s[20:23], s45 offen sc1
    buffer_load_dwordx4 v[72:75], v123, s[20:23], s46 offen sc1
    v_lshlrev_b32 v16, 16, v117
    v_subrev_f32 v96, s50, v16
    v_subrev_f32 v97, s51, v16
    v_subrev_f32 v98, s52, v16
    v_subrev_f32 v99, s53, v16
    v_subrev_f32 v100, s54, v16
    v_subrev_f32 v101, s55, v16
    v_subrev_f32 v102, s56, v16
    v_subrev_f32 v103, s57, v16
    v_cvt_pk_bf16_f32 v0, v96, v97
    v_cvt_pk_bf16_f32 v1, v98, v99
    v_cvt_pk_bf16_f32 v2, v100, v101
    v_cvt_pk_bf16_f32 v3, v102, v103
    v_lshlrev_b32 v96, 16, v0
    v_and_b32 v97, 0xffff0000, v0
    v_lshlrev_b32 v98, 16, v1
    v_and_b32 v99, 0xffff0000, v1
    v_lshlrev_b32 v100, 16, v2
    v_and_b32 v101, 0xffff0000, v2
    v_lshlrev_b32 v102, 16, v3
    v_and_b32 v103, 0xffff0000, v3
    v_mul_f32 v96, v96, v96
    v_mul_f32 v97, v97, v97
    v_mul_f32 v98, v98, v98
    v_mul_f32 v99, v99, v99
    v_mul_f32 v100, v100, v100
    v_mul_f32 v101, v101, v101
    v_mul_f32 v102, v102, v102
    v_mul_f32 v103, v103, v103
    v_cvt_pk_bf16_f32 v0, v96, v97
    v_cvt_pk_bf16_f32 v1, v98, v99
    v_cvt_pk_bf16_f32 v2, v100, v101
    v_cvt_pk_bf16_f32 v3, v102, v103
    v_lshlrev_b32 v96, 16, v0
    v_and_b32 v97, 0xffff0000, v0
    v_lshlrev_b32 v98, 16, v1
    v_and_b32 v99, 0xffff0000, v1
    v_lshlrev_b32 v100, 16, v2
    v_and_b32 v101, 0xffff0000, v2
    v_lshlrev_b32 v102, 16, v3
    v_and_b32 v103, 0xffff0000, v3
    v_mul_f32 v96, 0xc1200000, v96
    v_mul_f32 v97, 0xc1200000, v97
    v_mul_f32 v98, 0xc1200000, v98
    v_mul_f32 v99, 0xc1200000, v99
    v_mul_f32 v100, 0xc1200000, v100
    v_mul_f32 v101, 0xc1200000, v101
    v_mul_f32 v102, 0xc1200000, v102
    v_mul_f32 v103, 0xc1200000, v103
    v_cvt_pk_bf16_f32 v0, v96, v97
    v_cvt_pk_bf16_f32 v1, v98, v99
    v_cvt_pk_bf16_f32 v2, v100, v101
    v_cvt_pk_bf16_f32 v3, v102, v103
    v_lshlrev_b32 v96, 16, v0
    v_and_b32 v97, 0xffff0000, v0
    v_lshlrev_b32 v98, 16, v1
    v_and_b32 v99, 0xffff0000, v1
    v_lshlrev_b32 v100, 16, v2
    v_and_b32 v101, 0xffff0000, v2
    v_lshlrev_b32 v102, 16, v3
    v_and_b32 v103, 0xffff0000, v3
    v_mul_f32 v96, 0x3fb8aa3b, v96
    v_mul_f32 v97, 0x3fb8aa3b, v97
    v_mul_f32 v98, 0x3fb8aa3b, v98
    v_mul_f32 v99, 0x3fb8aa3b, v99
    v_mul_f32 v100, 0x3fb8aa3b, v100
    v_mul_f32 v101, 0x3fb8aa3b, v101
    v_mul_f32 v102, 0x3fb8aa3b, v102
    v_mul_f32 v103, 0x3fb8aa3b, v103
    v_exp_f32 v96, v96
    v_exp_f32 v97, v97
    v_exp_f32 v98, v98
    v_exp_f32 v99, v99
    v_exp_f32 v100, v100
    v_exp_f32 v101, v101
    v_exp_f32 v102, v102
    v_exp_f32 v103, v103
    v_cvt_pk_bf16_f32 v104, v96, v97
    v_cvt_pk_bf16_f32 v105, v98, v99
    v_cvt_pk_bf16_f32 v106, v100, v101
    v_cvt_pk_bf16_f32 v107, v102, v103
    v_and_b32 v16, 0xffff0000, v117
    v_subrev_f32 v96, s50, v16
    v_subrev_f32 v97, s51, v16
    v_subrev_f32 v98, s52, v16
    v_subrev_f32 v99, s53, v16
    v_subrev_f32 v100, s54, v16
    v_subrev_f32 v101, s55, v16
    v_subrev_f32 v102, s56, v16
    v_subrev_f32 v103, s57, v16
    v_cvt_pk_bf16_f32 v0, v96, v97
    v_cvt_pk_bf16_f32 v1, v98, v99
    v_cvt_pk_bf16_f32 v2, v100, v101
    v_cvt_pk_bf16_f32 v3, v102, v103
    v_lshlrev_b32 v96, 16, v0
    v_and_b32 v97, 0xffff0000, v0
    v_lshlrev_b32 v98, 16, v1
    v_and_b32 v99, 0xffff0000, v1
    v_lshlrev_b32 v100, 16, v2
    v_and_b32 v101, 0xffff0000, v2
    v_lshlrev_b32 v102, 16, v3
    v_and_b32 v103, 0xffff0000, v3
    v_mul_f32 v96, v96, v96
    v_mul_f32 v97, v97, v97
    v_mul_f32 v98, v98, v98
    v_mul_f32 v99, v99, v99
    v_mul_f32 v100, v100, v100
    v_mul_f32 v101, v101, v101
    v_mul_f32 v102, v102, v102
    v_mul_f32 v103, v103, v103
    v_cvt_pk_bf16_f32 v0, v96, v97
    v_cvt_pk_bf16_f32 v1, v98, v99
    v_cvt_pk_bf16_f32 v2, v100, v101
    v_cvt_pk_bf16_f32 v3, v102, v103
    v_lshlrev_b32 v96, 16, v0
    v_and_b32 v97, 0xffff0000, v0
    v_lshlrev_b32 v98, 16, v1
    v_and_b32 v99, 0xffff0000, v1
    v_lshlrev_b32 v100, 16, v2
    v_and_b32 v101, 0xffff0000, v2
    v_lshlrev_b32 v102, 16, v3
    v_and_b32 v103, 0xffff0000, v3
    v_mul_f32 v96, 0xc1200000, v96
    v_mul_f32 v97, 0xc1200000, v97
    v_mul_f32 v98, 0xc1200000, v98
    v_mul_f32 v99, 0xc1200000, v99
    v_mul_f32 v100, 0xc1200000, v100
    v_mul_f32 v101, 0xc1200000, v101
    v_mul_f32 v102, 0xc1200000, v102
    v_mul_f32 v103, 0xc1200000, v103
    v_cvt_pk_bf16_f32 v0, v96, v97
    v_cvt_pk_bf16_f32 v1, v98, v99
    v_cvt_pk_bf16_f32 v2, v100, v101
    v_cvt_pk_bf16_f32 v3, v102, v103
    v_lshlrev_b32 v96, 16, v0
    v_and_b32 v97, 0xffff0000, v0
    v_lshlrev_b32 v98, 16, v1
    v_and_b32 v99, 0xffff0000, v1
    v_lshlrev_b32 v100, 16, v2
    v_and_b32 v101, 0xffff0000, v2
    v_lshlrev_b32 v102, 16, v3
    v_and_b32 v103, 0xffff0000, v3
    v_mul_f32 v96, 0x3fb8aa3b, v96
    v_mul_f32 v97, 0x3fb8aa3b, v97
    v_mul_f32 v98, 0x3fb8aa3b, v98
    v_mul_f32 v99, 0x3fb8aa3b, v99
    v_mul_f32 v100, 0x3fb8aa3b, v100
    v_mul_f32 v101, 0x3fb8aa3b, v101
    v_mul_f32 v102, 0x3fb8aa3b, v102
    v_mul_f32 v103, 0x3fb8aa3b, v103
    v_exp_f32 v96, v96
    v_exp_f32 v97, v97
    v_exp_f32 v98, v98
    v_exp_f32 v99, v99
    v_exp_f32 v100, v100
    v_exp_f32 v101, v101
    v_exp_f32 v102, v102
    v_exp_f32 v103, v103
    v_cvt_pk_bf16_f32 v76, v96, v97
    v_cvt_pk_bf16_f32 v77, v98, v99
    v_cvt_pk_bf16_f32 v78, v100, v101
    v_cvt_pk_bf16_f32 v79, v102, v103
    v_mfma_f32_4x4x4_16b_bf16 v[16:19], v[48:49], v[104:105], 0
    v_mfma_f32_4x4x4_16b_bf16 v[24:27], v[52:53], v[104:105], 0
    v_mfma_f32_4x4x4_16b_bf16 v[20:23], v[48:49], v[76:77], 0
    v_mfma_f32_4x4x4_16b_bf16 v[28:31], v[52:53], v[76:77], 0
    v_mfma_f32_4x4x4_16b_bf16 v[16:19], v[50:51], v[106:107], v[16:19]
    v_mfma_f32_4x4x4_16b_bf16 v[24:27], v[54:55], v[106:107], v[24:27]
    v_mfma_f32_4x4x4_16b_bf16 v[20:23], v[50:51], v[78:79], v[20:23]
    v_mfma_f32_4x4x4_16b_bf16 v[28:31], v[54:55], v[78:79], v[28:31]
L2_f5:
    s_waitcnt vmcnt(0) lgkmcnt(0)
    v_mfma_f32_4x4x4_16b_bf16 v[96:99], v[10:11], v[32:33], 0
    v_mfma_f32_4x4x4_16b_bf16 v[100:103], v[10:11], v[34:35], 0
    s_nop 0
    v_mfma_f32_4x4x4_16b_bf16 v[96:99], v[10:11], v[36:37], v[96:99]
    v_mfma_f32_4x4x4_16b_bf16 v[100:103], v[10:11], v[38:39], v[100:103]
    s_nop 0
    v_mfma_f32_4x4x4_16b_bf16 v[96:99], v[10:11], v[40:41], v[96:99]
    v_mfma_f32_4x4x4_16b_bf16 v[100:103], v[10:11], v[42:43], v[100:103]
    s_nop 0
    v_mfma_f32_4x4x4_16b_bf16 v[96:99], v[10:11], v[44:45], v[96:99]
    v_mfma_f32_4x4x4_16b_bf16 v[100:103], v[10:11], v[46:47], v[100:103]
    s_nop 3
    v_mul_f32 v96, v96, v80
    v_mul_f32 v97, v97, v81
    v_mul_f32 v98, v98, v82
    v_mul_f32 v99, v99, v83
    v_cvt_pk_bf16_f32 v32, v96, v97
    v_cvt_pk_bf16_f32 v33, v98, v99
    v_mul_f32 v100, v100, v84
    v_mul_f32 v101, v101, v85
    v_mul_f32 v102, v102, v86
    v_mul_f32 v103, v103, v87
    v_cvt_pk_bf16_f32 v34, v100, v101
    v_cvt_pk_bf16_f32 v35, v102, v103
    v_mfma_f32_4x4x4_16b_bf16 v[80:83], v[56:57], v[32:33], 0
    s_nop 0
    v_mfma_f32_4x4x4_16b_bf16 v[84:87], v[56:57], v[34:35], 0
    s_nop 2
    v_mul_f32 v80, v80, v88
    v_mul_f32 v81, v81, v89
    v_mul_f32 v82, v82, v90
    v_mul_f32 v83, v83, v91
    v_mul_f32 v84, v84, v92
    v_mul_f32 v85, v85, v93
    v_mul_f32 v86, v86, v94
    v_mul_f32 v87, v87, v95
    v_mfma_f32_4x4x4_16b_bf16 v[96:99], v[10:11], v[108:109], v[80:83]
    s_nop 0
    v_mfma_f32_4x4x4_16b_bf16 v[100:103], v[10:11], v[110:111], v[84:87]
    s_nop 2
    v_cvt_pk_bf16_f32 v36, v96, v97
    v_cvt_pk_bf16_f32 v37, v98, v99
    v_cvt_pk_bf16_f32 v38, v100, v101
    v_cvt_pk_bf16_f32 v39, v102, v103
    buffer_store_dwordx4 v[36:39], v120, s[12:15], 0 offen nt
    s_cmp_ge_u32 s32, 4
    s_cbranch_scc1 L2_f6
    v_mfma_f32_4x4x4_16b_bf16 v[96:99], v[10:11], v[60:61], 0
    v_mfma_f32_4x4x4_16b_bf16 v[100:103], v[10:11], v[62:63], 0
    s_nop 0
    v_mfma_f32_4x4x4_16b_bf16 v[96:99], v[10:11], v[64:65], v[96:99]
    v_mfma_f32_4x4x4_16b_bf16 v[100:103], v[10:11], v[66:67], v[100:103]
    s_nop 0
    v_mfma_f32_4x4x4_16b_bf16 v[96:99], v[10:11], v[68:69], v[96:99]
    v_mfma_f32_4x4x4_16b_bf16 v[100:103], v[10:11], v[70:71], v[100:103]
    s_nop 0
    v_mfma_f32_4x4x4_16b_bf16 v[96:99], v[10:11], v[72:73], v[96:99]
    v_mfma_f32_4x4x4_16b_bf16 v[100:103], v[10:11], v[74:75], v[100:103]
    s_nop 3
    v_mul_f32 v96, v96, v16
    v_mul_f32 v97, v97, v17
    v_mul_f32 v98, v98, v18
    v_mul_f32 v99, v99, v19
    v_cvt_pk_bf16_f32 v60, v96, v97
    v_cvt_pk_bf16_f32 v61, v98, v99
    v_mul_f32 v100, v100, v20
    v_mul_f32 v101, v101, v21
    v_mul_f32 v102, v102, v22
    v_mul_f32 v103, v103, v23
    v_cvt_pk_bf16_f32 v62, v100, v101
    v_cvt_pk_bf16_f32 v63, v102, v103
    v_mfma_f32_4x4x4_16b_bf16 v[16:19], v[56:57], v[60:61], 0
    s_nop 0
    v_mfma_f32_4x4x4_16b_bf16 v[20:23], v[56:57], v[62:63], 0
    s_nop 2
    v_mul_f32 v16, v16, v24
    v_mul_f32 v17, v17, v25
    v_mul_f32 v18, v18, v26
    v_mul_f32 v19, v19, v27
    v_mul_f32 v20, v20, v28
    v_mul_f32 v21, v21, v29
    v_mul_f32 v22, v22, v30
    v_mul_f32 v23, v23, v31
    v_mfma_f32_4x4x4_16b_bf16 v[96:99], v[10:11], v[112:113], v[16:19]
    s_nop 0
    v_mfma_f32_4x4x4_16b_bf16 v[100:103], v[10:11], v[114:115], v[20:23]
    s_nop 2
    v_cvt_pk_bf16_f32 v64, v96, v97
    v_cvt_pk_bf16_f32 v65, v98, v99
    v_cvt_pk_bf16_f32 v66, v100, v101
    v_cvt_pk_bf16_f32 v67, v102, v103
    buffer_store_dwordx4 v[64:67], v121, s[12:15], 0 offen nt
L2_f6:
L2_end:
    s_endpgm
L2_slow:
    s_lshr_b32 s35, s42, 2
    s_lshl_b32 s50, s32, 4
    s_and_b32 s3, s42, 3
    s_lshl_b32 s53, s3, 3
    s_add_u32 s53, s53, s39
    s_and_b32 s3, s35, 2
    s_lshl_b32 s3, s3, 1
    s_add_u32 s53, s53, s3
    s_and_b32 s54, s35, 1
    s_lshl_b32 s54, s54, 4
L2_sl_seg:
    s_mul_i32 s55, s50, 173056
    s_and_b32 s3, s50, 3
    s_lshl_b32 s3, s3, 5
    s_add_u32 s3, s3, s55
    s_add_u32 s3, s3, s53
    buffer_load_dword v104, off, s[12:15], s3 sc1
    buffer_load_dword v105, off, s[12:15], s3 offset:32 sc1
    s_waitcnt vmcnt(0)
    v_readfirstlane_b32 s51, v104
    v_readfirstlane_b32 s52, v105
    s_lshr_b32 s51, s51, s54
    s_and_b32 s51, s51, 0xffff
    s_lshr_b32 s52, s52, s54
    s_and_b32 s52, s52, 0xffff
L2_sl_rec:
    s_cmp_ge_u32 s51, s52
    s_cbranch_scc1 L2_sl_next
    v_mbcnt_lo_u32_b32 v102, -1, 0
    v_mbcnt_hi_u32_b32 v102, -1, v102
    v_add_u32 v102, s51, v102
    v_and_b32 v103, -4, v102
    v_lshl_add_u32 v104, v102, 2, v103
    v_lshl_add_u32 v105, v103, 2, v102
    v_cmp_gt_u32 vcc, s52, v102
    s_mov_b64 exec, vcc
    buffer_load_dword v106, v104, s[8:11], s55 offen
    buffer_load_ubyte v107, v105, s[8:11], s55 offen offset:16
    s_waitcnt vmcnt(0)
    v_lshrrev_b32 v98, 14, v106
    v_and_b32 v98, v5, v98
    ds_read_b64 v[100:101], v98
    v_perm_b32 v97, v106, v107, s44
    v_and_b32 v96, v5, v106
    v_bitop3_b32 v103, v106, 0.5, -0.5 bitop3:0xa8
    v_bitop3_b32 v97, v6, v97, v103 bitop3:0xca
    s_waitcnt lgkmcnt(0)
    v_mfma_f32_4x4x4_16b_bf16 v[88:91], v[8:9], v[100:101], 0
    s_nop 4
    v_mul_f32 v88, v97, v88
    v_mul_f32 v89, v97, v89
    v_mul_f32 v90, v97, v90
    v_mul_f32 v91, v97, v91
    v_cvt_pk_bf16_f32 v88, v88, v89
    v_cvt_pk_bf16_f32 v89, v90, v91
    ds_pk_add_bf16 v96, v88 offset:65408
    ds_pk_add_bf16 v96, v89 offset:65412
    s_mov_b64 exec, -1
    s_add_u32 s51, s51, 64
    s_branch L2_sl_rec
L2_sl_next:
    s_add_u32 s50, s50, 1
    s_and_b32 s3, s50, 15
    s_cbranch_scc1 L2_sl_seg
    s_add_u32 s50, s50, 240
    s_cmp_lt_u32 s50, 1280
    s_cbranch_scc1 L2_sl_seg
    s_waitcnt lgkmcnt(0)
    s_cmp_eq_u32 s42, 0
    s_cbranch_scc1 L2_ret0
    s_cmp_eq_u32 s42, 1
    s_cbranch_scc1 L2_ret1
    s_cmp_eq_u32 s42, 14
    s_cbranch_scc1 L2_ret6
    s_cmp_eq_u32 s42, 15
    s_cbranch_scc1 L2_ret7
    s_and_b32 s3, s42, 3
    s_cmp_eq_u32 s3, 2
    s_cbranch_scc1 L2_ret2
    s_cmp_eq_u32 s3, 3
    s_cbranch_scc1 L2_ret3
    s_cmp_eq_u32 s3, 0
    s_cbranch_scc1 L2_ret4
    s_branch L2_ret5
L2_p1s:
    s_sleep 32
    s_branch L2_p1
L2_xo3:
    v_cmp_lt_u32 vcc, 20, v99
    s_mov_b32 s101, 1
    s_cbranch_vccz L2_xp3
    v_cmp_lt_u32 vcc, 32, v99
    v_cmp_lt_u32 s[58:59], 31, v88
    s_mov_b32 s101, 2
    s_or_b64 vcc, vcc, s[58:59]
    s_cbranch_scc0 L2_xp3
    s_mov_b32 s37, 0x10000
    s_branch L2_xp3
L2_xa4:
    s_cmp_eq_u32 s101, 1
    s_cbranch_scc1 L2_xc4
    v_lshlrev_b32 v89, 0, v96
    v_add_u32 v90, 140, v97
    v_bitop3_b32 v90, v89, v45, v90 bitop3:0x6a
    ds_write_b32 v98, v90 offset:28
    v_lshlrev_b32 v89, 4, v96
    v_add_u32 v90, 120, v97
    v_bitop3_b32 v90, v89, v45, v90 bitop3:0x6a
    ds_write_b32 v98, v90 offset:24
    v_lshlrev_b32 v89, 8, v96
    v_add_u32 v90, 100, v97
    v_bitop3_b32 v90, v89, v45, v90 bitop3:0x6a
    ds_write_b32 v98, v90 offset:20
L2_xc4:
    v_lshlrev_b32 v89, 12, v96
    v_add_u32 v90, 80, v97
    v_bitop3_b32 v90, v89, v45, v90 bitop3:0x6a
    ds_write_b32 v98, v90 offset:16
    s_branch L2_xb4
L2_xe4:
    v_cmp_lt_u32 vcc, 32, v99
    v_cmp_lt_u32 s[58:59], 31, v88
    v_lshrrev_b32 v89, 16, v96
    v_add_u32 v97, 80, v97
    s_or_b64 vcc, vcc, s[58:59]
    s_cbranch_scc1 L2_xs4
    v_lshlrev_b32 v89, v1, v89
    v_and_b32 v89, v45, v89
    v_cmp_ne_u32 vcc, 0, v89
    v_xor_b32 v90, v97, v89
    s_add_u32 s3, s37, s38
    v_mbcnt_lo_u32_b32 v98, vcc_lo, 0
    v_mbcnt_hi_u32_b32 v98, vcc_hi, v98
    s_bcnt1_i32_b64 s41, vcc
    v_lshl_add_u32 v98, v98, 2, s3
    s_mov_b64 exec, vcc
    ds_write_b32 v98, v90
    s_mov_b64 exec, -1
    s_lshl2_add_u32 s37, s41, s37
    s_branch L2_xr4
L2_xf4:
    s_waitcnt lgkmcnt(0)
    s_cmp_gt_u32 s37, 1024
    s_cbranch_scc1 L2_xs4
    v_mov_b32 v43, -1
    s_cmp_ge_u32 s37, 512
    s_cbranch_scc1 L2_xg4
    v_mov_b32 v42, -1
    s_cmp_ge_u32 s37, 256
    s_cbranch_scc1 L2_xg4
    v_mov_b32 v41, -1
    s_branch L2_xg4
L2_xs4:
    s_waitcnt lgkmcnt(0)
    v_mov_b32 v40, -1
    v_mov_b32 v41, -1
    v_mov_b32 v42, -1
    v_mov_b32 v43, -1
    s_add_u32 s3, s42, 0
    s_bitset1_b32 s36, s3
    s_branch L2_xg4
L2_xo5:
    v_cmp_lt_u32 vcc, 20, v99
    s_mov_b32 s101, 1
    s_cbranch_vccz L2_xp5
    v_cmp_lt_u32 vcc, 32, v99
    v_cmp_lt_u32 s[58:59], 31, v88
    s_mov_b32 s101, 2
    s_or_b64 vcc, vcc, s[58:59]
    s_cbranch_scc0 L2_xp5
    s_mov_b32 s37, 0x10000
    s_branch L2_xp5
L2_xa6:
    s_cmp_eq_u32 s101, 1
    s_cbranch_scc1 L2_xc6
    v_lshlrev_b32 v89, 0, v96
    v_add_u32 v90, 140, v97
    v_bitop3_b32 v90, v89, v45, v90 bitop3:0x6a
    ds_write_b32 v98, v90 offset:28
    v_lshlrev_b32 v89, 4, v96
    v_add_u32 v90, 120, v97
    v_bitop3_b32 v90, v89, v45, v90 bitop3:0x6a
    ds_write_b32 v98, v90 offset:24
    v_lshlrev_b32 v89, 8, v96
    v_add_u32 v90, 100, v97
    v_bitop3_b32 v90, v89, v45, v90 bitop3:0x6a
    ds_write_b32 v98, v90 offset:20
L2_xc6:
    v_lshlrev_b32 v89, 12, v96
    v_add_u32 v90, 80, v97
    v_bitop3_b32 v90, v89, v45, v90 bitop3:0x6a
    ds_write_b32 v98, v90 offset:16
    s_branch L2_xb6
L2_xe6:
    v_cmp_lt_u32 vcc, 32, v99
    v_cmp_lt_u32 s[58:59], 31, v88
    v_lshrrev_b32 v89, 16, v96
    v_add_u32 v97, 80, v97
    s_or_b64 vcc, vcc, s[58:59]
    s_cbranch_scc1 L2_xs6
    v_lshlrev_b32 v89, v1, v89
    v_and_b32 v89, v45, v89
    v_cmp_ne_u32 vcc, 0, v89
    v_xor_b32 v90, v97, v89
    s_add_u32 s3, s37, s38
    v_mbcnt_lo_u32_b32 v98, vcc_lo, 0
    v_mbcnt_hi_u32_b32 v98, vcc_hi, v98
    s_bcnt1_i32_b64 s41, vcc
    v_lshl_add_u32 v98, v98, 2, s3
    s_mov_b64 exec, vcc
    ds_write_b32 v98, v90
    s_mov_b64 exec, -1
    s_lshl2_add_u32 s37, s41, s37
    s_branch L2_xr6
L2_xf6:
    s_waitcnt lgkmcnt(0)
    s_cmp_gt_u32 s37, 1024
    s_cbranch_scc1 L2_xs6
    v_mov_b32 v43, -1
    s_cmp_ge_u32 s37, 512
    s_cbranch_scc1 L2_xg6
    v_mov_b32 v42, -1
    s_cmp_ge_u32 s37, 256
    s_cbranch_scc1 L2_xg6
    v_mov_b32 v41, -1
    s_branch L2_xg6
L2_xs6:
    s_waitcnt lgkmcnt(0)
    v_mov_b32 v40, -1
    v_mov_b32 v41, -1
    v_mov_b32 v42, -1
    v_mov_b32 v43, -1
    s_add_u32 s3, s42, 1
    s_bitset1_b32 s36, s3
    s_branch L2_xg6
L2_p2s:
    s_sleep 8
    s_branch L2_p2
L2_c7:
    s_lshl_b64 s[52:53], s[82:83], 1
    s_andn2_b64 s[52:53], s[52:53], s[80:81]
    s_andn2_b64 s[52:53], s[52:53], s[54:55]
    s_or_b64 s[80:81], s[80:81], s[52:53]
    s_not_b64 vcc, s[52:53]
    s_mov_b64 exec, -1
    v_cndmask_b32_dpp v84, v84, v84, vcc wave_shr:1 row_mask:0xf bank_mask:0xf
    v_cndmask_b32_dpp v85, v85, v85, vcc wave_shr:1 row_mask:0xf bank_mask:0xf
    s_lshr_b64 s[52:53], s[52:53], 1
    v_cndmask_b32_dpp v86, v86, v86, vcc wave_shr:1 row_mask:0xf bank_mask:0xf
    v_cndmask_b32_dpp v87, v87, v87, vcc wave_shr:1 row_mask:0xf bank_mask:0xf
    s_andn2_b64 s[82:83], s[82:83], s[52:53]
    v_cndmask_b32_dpp v7, v7, v7, vcc wave_shr:1 row_mask:0xf bank_mask:0xf
    s_mov_b64 exec, s[54:55]
    s_cbranch_scc0 L2_d7
    s_mov_b64 exec, s[82:83]
    s_nop 1
    v_mfma_f32_4x4x4_16b_bf16 v[88:91], v[12:13], v[84:85], 0
    s_nop 1
    v_mfma_f32_4x4x4_16b_bf16 v[88:91], v[10:11], v[86:87], v[88:91]
    s_nop 4
    v_cvt_pk_bf16_f32 v88, v88, v89
    v_cvt_pk_bf16_f32 v89, v90, v91
    ds_pk_add_bf16 v7, v88 offset:65408
    ds_pk_add_bf16 v7, v89 offset:65412
    s_mov_b64 exec, s[54:55]
    s_branch L2_d7
L2_c8:
    s_lshl_b64 s[52:53], s[82:83], 1
    s_andn2_b64 s[52:53], s[52:53], s[80:81]
    s_andn2_b64 s[52:53], s[52:53], s[50:51]
    s_or_b64 s[80:81], s[80:81], s[52:53]
    s_not_b64 vcc, s[52:53]
    s_mov_b64 exec, -1
    v_cndmask_b32_dpp v84, v84, v84, vcc wave_shr:1 row_mask:0xf bank_mask:0xf
    v_cndmask_b32_dpp v85, v85, v85, vcc wave_shr:1 row_mask:0xf bank_mask:0xf
    s_lshr_b64 s[52:53], s[52:53], 1
    v_cndmask_b32_dpp v86, v86, v86, vcc wave_shr:1 row_mask:0xf bank_mask:0xf
    v_cndmask_b32_dpp v87, v87, v87, vcc wave_shr:1 row_mask:0xf bank_mask:0xf
    s_andn2_b64 s[82:83], s[82:83], s[52:53]
    v_cndmask_b32_dpp v7, v7, v7, vcc wave_shr:1 row_mask:0xf bank_mask:0xf
    s_mov_b64 exec, s[50:51]
    s_cbranch_scc0 L2_d8
    s_mov_b64 exec, s[82:83]
    s_nop 1
    v_mfma_f32_4x4x4_16b_bf16 v[88:91], v[12:13], v[84:85], 0
    s_nop 1
    v_mfma_f32_4x4x4_16b_bf16 v[88:91], v[10:11], v[86:87], v[88:91]
    s_nop 4
    v_cvt_pk_bf16_f32 v88, v88, v89
    v_cvt_pk_bf16_f32 v89, v90, v91
    ds_pk_add_bf16 v7, v88 offset:65408
    ds_pk_add_bf16 v7, v89 offset:65412
    s_mov_b64 exec, s[50:51]
    s_branch L2_d8
L2_xo9:
    v_cmp_lt_u32 vcc, 20, v99
    s_mov_b32 s101, 1
    s_cbranch_vccz L2_xp9
    v_cmp_lt_u32 vcc, 32, v99
    v_cmp_lt_u32 s[58:59], 31, v88
    s_mov_b32 s101, 2
    s_or_b64 vcc, vcc, s[58:59]
    s_cbranch_scc0 L2_xp9
    s_mov_b32 s37, 0x10000
    s_branch L2_xp9
L2_c12:
    s_lshl_b64 s[52:53], s[82:83], 1
    s_andn2_b64 s[52:53], s[52:53], s[80:81]
    s_andn2_b64 s[52:53], s[52:53], s[54:55]
    s_or_b64 s[80:81], s[80:81], s[52:53]
    s_not_b64 vcc, s[52:53]
    s_mov_b64 exec, -1
    v_cndmask_b32_dpp v84, v84, v84, vcc wave_shr:1 row_mask:0xf bank_mask:0xf
    v_cndmask_b32_dpp v85, v85, v85, vcc wave_shr:1 row_mask:0xf bank_mask:0xf
    s_lshr_b64 s[52:53], s[52:53], 1
    v_cndmask_b32_dpp v86, v86, v86, vcc wave_shr:1 row_mask:0xf bank_mask:0xf
    v_cndmask_b32_dpp v87, v87, v87, vcc wave_shr:1 row_mask:0xf bank_mask:0xf
    s_andn2_b64 s[82:83], s[82:83], s[52:53]
    v_cndmask_b32_dpp v7, v7, v7, vcc wave_shr:1 row_mask:0xf bank_mask:0xf
    s_mov_b64 exec, s[54:55]
    s_cbranch_scc0 L2_d12
    s_mov_b64 exec, s[82:83]
    s_nop 1
    v_mfma_f32_4x4x4_16b_bf16 v[88:91], v[12:13], v[84:85], 0
    s_nop 1
    v_mfma_f32_4x4x4_16b_bf16 v[88:91], v[10:11], v[86:87], v[88:91]
    s_nop 4
    v_cvt_pk_bf16_f32 v88, v88, v89
    v_cvt_pk_bf16_f32 v89, v90, v91
    ds_pk_add_bf16 v7, v88 offset:65408
    ds_pk_add_bf16 v7, v89 offset:65412
    s_mov_b64 exec, s[54:55]
    s_branch L2_d12
L2_c13:
    s_lshl_b64 s[52:53], s[82:83], 1
    s_andn2_b64 s[52:53], s[52:53], s[80:81]
    s_andn2_b64 s[52:53], s[52:53], s[50:51]
    s_or_b64 s[80:81], s[80:81], s[52:53]
    s_not_b64 vcc, s[52:53]
    s_mov_b64 exec, -1
    v_cndmask_b32_dpp v84, v84, v84, vcc wave_shr:1 row_mask:0xf bank_mask:0xf
    v_cndmask_b32_dpp v85, v85, v85, vcc wave_shr:1 row_mask:0xf bank_mask:0xf
    s_lshr_b64 s[52:53], s[52:53], 1
    v_cndmask_b32_dpp v86, v86, v86, vcc wave_shr:1 row_mask:0xf bank_mask:0xf
    v_cndmask_b32_dpp v87, v87, v87, vcc wave_shr:1 row_mask:0xf bank_mask:0xf
    s_andn2_b64 s[82:83], s[82:83], s[52:53]
    v_cndmask_b32_dpp v7, v7, v7, vcc wave_shr:1 row_mask:0xf bank_mask:0xf
    s_mov_b64 exec, s[50:51]
    s_cbranch_scc0 L2_d13
    s_mov_b64 exec, s[82:83]
    s_nop 1
    v_mfma_f32_4x4x4_16b_bf16 v[88:91], v[12:13], v[84:85], 0
    s_nop 1
    v_mfma_f32_4x4x4_16b_bf16 v[88:91], v[10:11], v[86:87], v[88:91]
    s_nop 4
    v_cvt_pk_bf16_f32 v88, v88, v89
    v_cvt_pk_bf16_f32 v89, v90, v91
    ds_pk_add_bf16 v7, v88 offset:65408
    ds_pk_add_bf16 v7, v89 offset:65412
    s_mov_b64 exec, s[50:51]
    s_branch L2_d13
L2_c15:
    s_lshl_b64 s[52:53], s[82:83], 1
    s_andn2_b64 s[52:53], s[52:53], s[80:81]
    s_andn2_b64 s[52:53], s[52:53], s[54:55]
    s_or_b64 s[80:81], s[80:81], s[52:53]
    s_not_b64 vcc, s[52:53]
    s_mov_b64 exec, -1
    v_cndmask_b32_dpp v84, v84, v84, vcc wave_shr:1 row_mask:0xf bank_mask:0xf
    v_cndmask_b32_dpp v85, v85, v85, vcc wave_shr:1 row_mask:0xf bank_mask:0xf
    s_lshr_b64 s[52:53], s[52:53], 1
    v_cndmask_b32_dpp v86, v86, v86, vcc wave_shr:1 row_mask:0xf bank_mask:0xf
    v_cndmask_b32_dpp v87, v87, v87, vcc wave_shr:1 row_mask:0xf bank_mask:0xf
    s_andn2_b64 s[82:83], s[82:83], s[52:53]
    v_cndmask_b32_dpp v7, v7, v7, vcc wave_shr:1 row_mask:0xf bank_mask:0xf
    s_mov_b64 exec, s[54:55]
    s_cbranch_scc0 L2_d15
    s_mov_b64 exec, s[82:83]
    s_nop 1
    v_mfma_f32_4x4x4_16b_bf16 v[88:91], v[12:13], v[84:85], 0
    s_nop 1
    v_mfma_f32_4x4x4_16b_bf16 v[88:91], v[10:11], v[86:87], v[88:91]
    s_nop 4
    v_cvt_pk_bf16_f32 v88, v88, v89
    v_cvt_pk_bf16_f32 v89, v90, v91
    ds_pk_add_bf16 v7, v88 offset:65408
    ds_pk_add_bf16 v7, v89 offset:65412
    s_mov_b64 exec, s[54:55]
    s_branch L2_d15
L2_c16:
    s_lshl_b64 s[52:53], s[82:83], 1
    s_andn2_b64 s[52:53], s[52:53], s[80:81]
    s_andn2_b64 s[52:53], s[52:53], s[50:51]
    s_or_b64 s[80:81], s[80:81], s[52:53]
    s_not_b64 vcc, s[52:53]
    s_mov_b64 exec, -1
    v_cndmask_b32_dpp v84, v84, v84, vcc wave_shr:1 row_mask:0xf bank_mask:0xf
    v_cndmask_b32_dpp v85, v85, v85, vcc wave_shr:1 row_mask:0xf bank_mask:0xf
    s_lshr_b64 s[52:53], s[52:53], 1
    v_cndmask_b32_dpp v86, v86, v86, vcc wave_shr:1 row_mask:0xf bank_mask:0xf
    v_cndmask_b32_dpp v87, v87, v87, vcc wave_shr:1 row_mask:0xf bank_mask:0xf
    s_andn2_b64 s[82:83], s[82:83], s[52:53]
    v_cndmask_b32_dpp v7, v7, v7, vcc wave_shr:1 row_mask:0xf bank_mask:0xf
    s_mov_b64 exec, s[50:51]
    s_cbranch_scc0 L2_d16
    s_mov_b64 exec, s[82:83]
    s_nop 1
    v_mfma_f32_4x4x4_16b_bf16 v[88:91], v[12:13], v[84:85], 0
    s_nop 1
    v_mfma_f32_4x4x4_16b_bf16 v[88:91], v[10:11], v[86:87], v[88:91]
    s_nop 4
    v_cvt_pk_bf16_f32 v88, v88, v89
    v_cvt_pk_bf16_f32 v89, v90, v91
    ds_pk_add_bf16 v7, v88 offset:65408
    ds_pk_add_bf16 v7, v89 offset:65412
    s_mov_b64 exec, s[50:51]
    s_branch L2_d16
L2_c19:
    s_lshl_b64 s[52:53], s[82:83], 1
    s_andn2_b64 s[52:53], s[52:53], s[80:81]
    s_andn2_b64 s[52:53], s[52:53], s[54:55]
    s_or_b64 s[80:81], s[80:81], s[52:53]
    s_not_b64 vcc, s[52:53]
    s_mov_b64 exec, -1
    v_cndmask_b32_dpp v84, v84, v84, vcc wave_shr:1 row_mask:0xf bank_mask:0xf
    v_cndmask_b32_dpp v85, v85, v85, vcc wave_shr:1 row_mask:0xf bank_mask:0xf
    s_lshr_b64 s[52:53], s[52:53], 1
    v_cndmask_b32_dpp v86, v86, v86, vcc wave_shr:1 row_mask:0xf bank_mask:0xf
    v_cndmask_b32_dpp v87, v87, v87, vcc wave_shr:1 row_mask:0xf bank_mask:0xf
    s_andn2_b64 s[82:83], s[82:83], s[52:53]
    v_cndmask_b32_dpp v7, v7, v7, vcc wave_shr:1 row_mask:0xf bank_mask:0xf
    s_mov_b64 exec, s[54:55]
    s_cbranch_scc0 L2_d19
    s_mov_b64 exec, s[82:83]
    s_nop 1
    v_mfma_f32_4x4x4_16b_bf16 v[88:91], v[12:13], v[84:85], 0
    s_nop 1
    v_mfma_f32_4x4x4_16b_bf16 v[88:91], v[10:11], v[86:87], v[88:91]
    s_nop 4
    v_cvt_pk_bf16_f32 v88, v88, v89
    v_cvt_pk_bf16_f32 v89, v90, v91
    ds_pk_add_bf16 v7, v88 offset:65408
    ds_pk_add_bf16 v7, v89 offset:65412
    s_mov_b64 exec, s[54:55]
    s_branch L2_d19
L2_c20:
    s_lshl_b64 s[52:53], s[82:83], 1
    s_andn2_b64 s[52:53], s[52:53], s[80:81]
    s_andn2_b64 s[52:53], s[52:53], s[50:51]
    s_or_b64 s[80:81], s[80:81], s[52:53]
    s_not_b64 vcc, s[52:53]
    s_mov_b64 exec, -1
    v_cndmask_b32_dpp v84, v84, v84, vcc wave_shr:1 row_mask:0xf bank_mask:0xf
    v_cndmask_b32_dpp v85, v85, v85, vcc wave_shr:1 row_mask:0xf bank_mask:0xf
    s_lshr_b64 s[52:53], s[52:53], 1
    v_cndmask_b32_dpp v86, v86, v86, vcc wave_shr:1 row_mask:0xf bank_mask:0xf
    v_cndmask_b32_dpp v87, v87, v87, vcc wave_shr:1 row_mask:0xf bank_mask:0xf
    s_andn2_b64 s[82:83], s[82:83], s[52:53]
    v_cndmask_b32_dpp v7, v7, v7, vcc wave_shr:1 row_mask:0xf bank_mask:0xf
    s_mov_b64 exec, s[50:51]
    s_cbranch_scc0 L2_d20
    s_mov_b64 exec, s[82:83]
    s_nop 1
    v_mfma_f32_4x4x4_16b_bf16 v[88:91], v[12:13], v[84:85], 0
    s_nop 1
    v_mfma_f32_4x4x4_16b_bf16 v[88:91], v[10:11], v[86:87], v[88:91]
    s_nop 4
    v_cvt_pk_bf16_f32 v88, v88, v89
    v_cvt_pk_bf16_f32 v89, v90, v91
    ds_pk_add_bf16 v7, v88 offset:65408
    ds_pk_add_bf16 v7, v89 offset:65412
    s_mov_b64 exec, s[50:51]
    s_branch L2_d20
L2_c21:
    s_lshl_b64 s[52:53], s[82:83], 1
    s_andn2_b64 s[52:53], s[52:53], s[80:81]
    s_andn2_b64 s[52:53], s[52:53], s[54:55]
    s_or_b64 s[80:81], s[80:81], s[52:53]
    s_not_b64 vcc, s[52:53]
    s_mov_b64 exec, -1
    v_cndmask_b32_dpp v84, v84, v84, vcc wave_shr:1 row_mask:0xf bank_mask:0xf
    v_cndmask_b32_dpp v85, v85, v85, vcc wave_shr:1 row_mask:0xf bank_mask:0xf
    s_lshr_b64 s[52:53], s[52:53], 1
    v_cndmask_b32_dpp v86, v86, v86, vcc wave_shr:1 row_mask:0xf bank_mask:0xf
    v_cndmask_b32_dpp v87, v87, v87, vcc wave_shr:1 row_mask:0xf bank_mask:0xf
    s_andn2_b64 s[82:83], s[82:83], s[52:53]
    v_cndmask_b32_dpp v7, v7, v7, vcc wave_shr:1 row_mask:0xf bank_mask:0xf
    s_mov_b64 exec, s[54:55]
    s_cbranch_scc0 L2_d21
    s_mov_b64 exec, s[82:83]
    s_nop 1
    v_mfma_f32_4x4x4_16b_bf16 v[88:91], v[12:13], v[84:85], 0
    s_nop 1
    v_mfma_f32_4x4x4_16b_bf16 v[88:91], v[10:11], v[86:87], v[88:91]
    s_nop 4
    v_cvt_pk_bf16_f32 v88, v88, v89
    v_cvt_pk_bf16_f32 v89, v90, v91
    ds_pk_add_bf16 v7, v88 offset:65408
    ds_pk_add_bf16 v7, v89 offset:65412
    s_mov_b64 exec, s[54:55]
    s_branch L2_d21
L2_c22:
    s_lshl_b64 s[52:53], s[82:83], 1
    s_andn2_b64 s[52:53], s[52:53], s[80:81]
    s_andn2_b64 s[52:53], s[52:53], s[50:51]
    s_or_b64 s[80:81], s[80:81], s[52:53]
    s_not_b64 vcc, s[52:53]
    s_mov_b64 exec, -1
    v_cndmask_b32_dpp v84, v84, v84, vcc wave_shr:1 row_mask:0xf bank_mask:0xf
    v_cndmask_b32_dpp v85, v85, v85, vcc wave_shr:1 row_mask:0xf bank_mask:0xf
    s_lshr_b64 s[52:53], s[52:53], 1
    v_cndmask_b32_dpp v86, v86, v86, vcc wave_shr:1 row_mask:0xf bank_mask:0xf
    v_cndmask_b32_dpp v87, v87, v87, vcc wave_shr:1 row_mask:0xf bank_mask:0xf
    s_andn2_b64 s[82:83], s[82:83], s[52:53]
    v_cndmask_b32_dpp v7, v7, v7, vcc wave_shr:1 row_mask:0xf bank_mask:0xf
    s_mov_b64 exec, s[50:51]
    s_cbranch_scc0 L2_d22
    s_mov_b64 exec, s[82:83]
    s_nop 1
    v_mfma_f32_4x4x4_16b_bf16 v[88:91], v[12:13], v[84:85], 0
    s_nop 1
    v_mfma_f32_4x4x4_16b_bf16 v[88:91], v[10:11], v[86:87], v[88:91]
    s_nop 4
    v_cvt_pk_bf16_f32 v88, v88, v89
    v_cvt_pk_bf16_f32 v89, v90, v91
    ds_pk_add_bf16 v7, v88 offset:65408
    ds_pk_add_bf16 v7, v89 offset:65412
    s_mov_b64 exec, s[50:51]
    s_branch L2_d22
L2_c23:
    s_lshl_b64 s[52:53], s[82:83], 1
    s_andn2_b64 s[52:53], s[52:53], s[80:81]
    s_andn2_b64 s[52:53], s[52:53], s[54:55]
    s_or_b64 s[80:81], s[80:81], s[52:53]
    s_not_b64 vcc, s[52:53]
    s_mov_b64 exec, -1
    v_cndmask_b32_dpp v84, v84, v84, vcc wave_shr:1 row_mask:0xf bank_mask:0xf
    v_cndmask_b32_dpp v85, v85, v85, vcc wave_shr:1 row_mask:0xf bank_mask:0xf
    s_lshr_b64 s[52:53], s[52:53], 1
    v_cndmask_b32_dpp v86, v86, v86, vcc wave_shr:1 row_mask:0xf bank_mask:0xf
    v_cndmask_b32_dpp v87, v87, v87, vcc wave_shr:1 row_mask:0xf bank_mask:0xf
    s_andn2_b64 s[82:83], s[82:83], s[52:53]
    v_cndmask_b32_dpp v7, v7, v7, vcc wave_shr:1 row_mask:0xf bank_mask:0xf
    s_mov_b64 exec, s[54:55]
    s_cbranch_scc0 L2_d23
    s_mov_b64 exec, s[82:83]
    s_nop 1
    v_mfma_f32_4x4x4_16b_bf16 v[88:91], v[12:13], v[84:85], 0
    s_nop 1
    v_mfma_f32_4x4x4_16b_bf16 v[88:91], v[10:11], v[86:87], v[88:91]
    s_nop 4
    v_cvt_pk_bf16_f32 v88, v88, v89
    v_cvt_pk_bf16_f32 v89, v90, v91
    ds_pk_add_bf16 v7, v88 offset:65408
    ds_pk_add_bf16 v7, v89 offset:65412
    s_mov_b64 exec, s[54:55]
    s_branch L2_d23
L2_c24:
    s_lshl_b64 s[52:53], s[82:83], 1
    s_andn2_b64 s[52:53], s[52:53], s[80:81]
    s_andn2_b64 s[52:53], s[52:53], s[50:51]
    s_or_b64 s[80:81], s[80:81], s[52:53]
    s_not_b64 vcc, s[52:53]
    s_mov_b64 exec, -1
    v_cndmask_b32_dpp v84, v84, v84, vcc wave_shr:1 row_mask:0xf bank_mask:0xf
    v_cndmask_b32_dpp v85, v85, v85, vcc wave_shr:1 row_mask:0xf bank_mask:0xf
    s_lshr_b64 s[52:53], s[52:53], 1
    v_cndmask_b32_dpp v86, v86, v86, vcc wave_shr:1 row_mask:0xf bank_mask:0xf
    v_cndmask_b32_dpp v87, v87, v87, vcc wave_shr:1 row_mask:0xf bank_mask:0xf
    s_andn2_b64 s[82:83], s[82:83], s[52:53]
    v_cndmask_b32_dpp v7, v7, v7, vcc wave_shr:1 row_mask:0xf bank_mask:0xf
    s_mov_b64 exec, s[50:51]
    s_cbranch_scc0 L2_d24
    s_mov_b64 exec, s[82:83]
    s_nop 1
    v_mfma_f32_4x4x4_16b_bf16 v[88:91], v[12:13], v[84:85], 0
    s_nop 1
    v_mfma_f32_4x4x4_16b_bf16 v[88:91], v[10:11], v[86:87], v[88:91]
    s_nop 4
    v_cvt_pk_bf16_f32 v88, v88, v89
    v_cvt_pk_bf16_f32 v89, v90, v91
    ds_pk_add_bf16 v7, v88 offset:65408
    ds_pk_add_bf16 v7, v89 offset:65412
    s_mov_b64 exec, s[50:51]
    s_branch L2_d24
L2_xa25:
    s_cmp_eq_u32 s101, 1
    s_cbranch_scc1 L2_xc25
    v_lshlrev_b32 v89, 0, v96
    v_add_u32 v90, 140, v97
    v_bitop3_b32 v90, v89, v45, v90 bitop3:0x6a
    ds_write_b32 v98, v90 offset:28
    v_lshlrev_b32 v89, 4, v96
    v_add_u32 v90, 120, v97
    v_bitop3_b32 v90, v89, v45, v90 bitop3:0x6a
    ds_write_b32 v98, v90 offset:24
    v_lshlrev_b32 v89, 8, v96
    v_add_u32 v90, 100, v97
    v_bitop3_b32 v90, v89, v45, v90 bitop3:0x6a
    ds_write_b32 v98, v90 offset:20
L2_xc25:
    v_lshlrev_b32 v89, 12, v96
    v_add_u32 v90, 80, v97
    v_bitop3_b32 v90, v89, v45, v90 bitop3:0x6a
    ds_write_b32 v98, v90 offset:16
    s_branch L2_xb25
L2_xe25:
    v_cmp_lt_u32 vcc, 32, v99
    v_cmp_lt_u32 s[58:59], 31, v88
    v_lshrrev_b32 v89, 16, v96
    v_add_u32 v97, 80, v97
    s_or_b64 vcc, vcc, s[58:59]
    s_cbranch_scc1 L2_xs25
    v_lshlrev_b32 v89, v1, v89
    v_and_b32 v89, v45, v89
    v_cmp_ne_u32 vcc, 0, v89
    v_xor_b32 v90, v97, v89
    s_add_u32 s3, s37, s38
    v_mbcnt_lo_u32_b32 v98, vcc_lo, 0
    v_mbcnt_hi_u32_b32 v98, vcc_hi, v98
    s_bcnt1_i32_b64 s41, vcc
    v_lshl_add_u32 v98, v98, 2, s3
    s_mov_b64 exec, vcc
    ds_write_b32 v98, v90
    s_mov_b64 exec, -1
    s_lshl2_add_u32 s37, s41, s37
    s_branch L2_xr25
L2_xf25:
    s_waitcnt lgkmcnt(0)
    s_cmp_gt_u32 s37, 1024
    s_cbranch_scc1 L2_xs25
    v_mov_b32 v43, -1
    s_cmp_ge_u32 s37, 512
    s_cbranch_scc1 L2_xg25
    v_mov_b32 v42, -1
    s_cmp_ge_u32 s37, 256
    s_cbranch_scc1 L2_xg25
    v_mov_b32 v41, -1
    s_branch L2_xg25
L2_xs25:
    s_waitcnt lgkmcnt(0)
    v_mov_b32 v40, -1
    v_mov_b32 v41, -1
    v_mov_b32 v42, -1
    v_mov_b32 v43, -1
    s_add_u32 s3, s42, 2
    s_bitset1_b32 s36, s3
    s_branch L2_xg25
L2_c26:
    s_lshl_b64 s[52:53], s[82:83], 1
    s_andn2_b64 s[52:53], s[52:53], s[80:81]
    s_andn2_b64 s[52:53], s[52:53], s[54:55]
    s_or_b64 s[80:81], s[80:81], s[52:53]
    s_not_b64 vcc, s[52:53]
    s_mov_b64 exec, -1
    v_cndmask_b32_dpp v84, v84, v84, vcc wave_shr:1 row_mask:0xf bank_mask:0xf
    v_cndmask_b32_dpp v85, v85, v85, vcc wave_shr:1 row_mask:0xf bank_mask:0xf
    s_lshr_b64 s[52:53], s[52:53], 1
    v_cndmask_b32_dpp v86, v86, v86, vcc wave_shr:1 row_mask:0xf bank_mask:0xf
    v_cndmask_b32_dpp v87, v87, v87, vcc wave_shr:1 row_mask:0xf bank_mask:0xf
    s_andn2_b64 s[82:83], s[82:83], s[52:53]
    v_cndmask_b32_dpp v7, v7, v7, vcc wave_shr:1 row_mask:0xf bank_mask:0xf
    s_mov_b64 exec, s[54:55]
    s_cbranch_scc0 L2_d26
    s_mov_b64 exec, s[82:83]
    s_nop 1
    v_mfma_f32_4x4x4_16b_bf16 v[88:91], v[12:13], v[84:85], 0
    s_nop 1
    v_mfma_f32_4x4x4_16b_bf16 v[88:91], v[10:11], v[86:87], v[88:91]
    s_nop 4
    v_cvt_pk_bf16_f32 v88, v88, v89
    v_cvt_pk_bf16_f32 v89, v90, v91
    ds_pk_add_bf16 v7, v88 offset:65408
    ds_pk_add_bf16 v7, v89 offset:65412
    s_mov_b64 exec, s[54:55]
    s_branch L2_d26
L2_c27:
    s_lshl_b64 s[52:53], s[82:83], 1
    s_andn2_b64 s[52:53], s[52:53], s[80:81]
    s_andn2_b64 s[52:53], s[52:53], s[50:51]
    s_or_b64 s[80:81], s[80:81], s[52:53]
    s_not_b64 vcc, s[52:53]
    s_mov_b64 exec, -1
    v_cndmask_b32_dpp v84, v84, v84, vcc wave_shr:1 row_mask:0xf bank_mask:0xf
    v_cndmask_b32_dpp v85, v85, v85, vcc wave_shr:1 row_mask:0xf bank_mask:0xf
    s_lshr_b64 s[52:53], s[52:53], 1
    v_cndmask_b32_dpp v86, v86, v86, vcc wave_shr:1 row_mask:0xf bank_mask:0xf
    v_cndmask_b32_dpp v87, v87, v87, vcc wave_shr:1 row_mask:0xf bank_mask:0xf
    s_andn2_b64 s[82:83], s[82:83], s[52:53]
    v_cndmask_b32_dpp v7, v7, v7, vcc wave_shr:1 row_mask:0xf bank_mask:0xf
    s_mov_b64 exec, s[50:51]
    s_cbranch_scc0 L2_d27
    s_mov_b64 exec, s[82:83]
    s_nop 1
    v_mfma_f32_4x4x4_16b_bf16 v[88:91], v[12:13], v[84:85], 0
    s_nop 1
    v_mfma_f32_4x4x4_16b_bf16 v[88:91], v[10:11], v[86:87], v[88:91]
    s_nop 4
    v_cvt_pk_bf16_f32 v88, v88, v89
    v_cvt_pk_bf16_f32 v89, v90, v91
    ds_pk_add_bf16 v7, v88 offset:65408
    ds_pk_add_bf16 v7, v89 offset:65412
    s_mov_b64 exec, s[50:51]
    s_branch L2_d27
L2_c28:
    s_lshl_b64 s[52:53], s[82:83], 1
    s_andn2_b64 s[52:53], s[52:53], s[80:81]
    s_andn2_b64 s[52:53], s[52:53], s[54:55]
    s_or_b64 s[80:81], s[80:81], s[52:53]
    s_not_b64 vcc, s[52:53]
    s_mov_b64 exec, -1
    v_cndmask_b32_dpp v84, v84, v84, vcc wave_shr:1 row_mask:0xf bank_mask:0xf
    v_cndmask_b32_dpp v85, v85, v85, vcc wave_shr:1 row_mask:0xf bank_mask:0xf
    s_lshr_b64 s[52:53], s[52:53], 1
    v_cndmask_b32_dpp v86, v86, v86, vcc wave_shr:1 row_mask:0xf bank_mask:0xf
    v_cndmask_b32_dpp v87, v87, v87, vcc wave_shr:1 row_mask:0xf bank_mask:0xf
    s_andn2_b64 s[82:83], s[82:83], s[52:53]
    v_cndmask_b32_dpp v7, v7, v7, vcc wave_shr:1 row_mask:0xf bank_mask:0xf
    s_mov_b64 exec, s[54:55]
    s_cbranch_scc0 L2_d28
    s_mov_b64 exec, s[82:83]
    s_nop 1
    v_mfma_f32_4x4x4_16b_bf16 v[88:91], v[12:13], v[84:85], 0
    s_nop 1
    v_mfma_f32_4x4x4_16b_bf16 v[88:91], v[10:11], v[86:87], v[88:91]
    s_nop 4
    v_cvt_pk_bf16_f32 v88, v88, v89
    v_cvt_pk_bf16_f32 v89, v90, v91
    ds_pk_add_bf16 v7, v88 offset:65408
    ds_pk_add_bf16 v7, v89 offset:65412
    s_mov_b64 exec, s[54:55]
    s_branch L2_d28
L2_c29:
    s_lshl_b64 s[52:53], s[82:83], 1
    s_andn2_b64 s[52:53], s[52:53], s[80:81]
    s_andn2_b64 s[52:53], s[52:53], s[50:51]
    s_or_b64 s[80:81], s[80:81], s[52:53]
    s_not_b64 vcc, s[52:53]
    s_mov_b64 exec, -1
    v_cndmask_b32_dpp v84, v84, v84, vcc wave_shr:1 row_mask:0xf bank_mask:0xf
    v_cndmask_b32_dpp v85, v85, v85, vcc wave_shr:1 row_mask:0xf bank_mask:0xf
    s_lshr_b64 s[52:53], s[52:53], 1
    v_cndmask_b32_dpp v86, v86, v86, vcc wave_shr:1 row_mask:0xf bank_mask:0xf
    v_cndmask_b32_dpp v87, v87, v87, vcc wave_shr:1 row_mask:0xf bank_mask:0xf
    s_andn2_b64 s[82:83], s[82:83], s[52:53]
    v_cndmask_b32_dpp v7, v7, v7, vcc wave_shr:1 row_mask:0xf bank_mask:0xf
    s_mov_b64 exec, s[50:51]
    s_cbranch_scc0 L2_d29
    s_mov_b64 exec, s[82:83]
    s_nop 1
    v_mfma_f32_4x4x4_16b_bf16 v[88:91], v[12:13], v[84:85], 0
    s_nop 1
    v_mfma_f32_4x4x4_16b_bf16 v[88:91], v[10:11], v[86:87], v[88:91]
    s_nop 4
    v_cvt_pk_bf16_f32 v88, v88, v89
    v_cvt_pk_bf16_f32 v89, v90, v91
    ds_pk_add_bf16 v7, v88 offset:65408
    ds_pk_add_bf16 v7, v89 offset:65412
    s_mov_b64 exec, s[50:51]
    s_branch L2_d29
L2_c30:
    s_lshl_b64 s[52:53], s[82:83], 1
    s_andn2_b64 s[52:53], s[52:53], s[80:81]
    s_andn2_b64 s[52:53], s[52:53], s[54:55]
    s_or_b64 s[80:81], s[80:81], s[52:53]
    s_not_b64 vcc, s[52:53]
    s_mov_b64 exec, -1
    v_cndmask_b32_dpp v84, v84, v84, vcc wave_shr:1 row_mask:0xf bank_mask:0xf
    v_cndmask_b32_dpp v85, v85, v85, vcc wave_shr:1 row_mask:0xf bank_mask:0xf
    s_lshr_b64 s[52:53], s[52:53], 1
    v_cndmask_b32_dpp v86, v86, v86, vcc wave_shr:1 row_mask:0xf bank_mask:0xf
    v_cndmask_b32_dpp v87, v87, v87, vcc wave_shr:1 row_mask:0xf bank_mask:0xf
    s_andn2_b64 s[82:83], s[82:83], s[52:53]
    v_cndmask_b32_dpp v7, v7, v7, vcc wave_shr:1 row_mask:0xf bank_mask:0xf
    s_mov_b64 exec, s[54:55]
    s_cbranch_scc0 L2_d30
    s_mov_b64 exec, s[82:83]
    s_nop 1
    v_mfma_f32_4x4x4_16b_bf16 v[88:91], v[12:13], v[84:85], 0
    s_nop 1
    v_mfma_f32_4x4x4_16b_bf16 v[88:91], v[10:11], v[86:87], v[88:91]
    s_nop 4
    v_cvt_pk_bf16_f32 v88, v88, v89
    v_cvt_pk_bf16_f32 v89, v90, v91
    ds_pk_add_bf16 v7, v88 offset:65408
    ds_pk_add_bf16 v7, v89 offset:65412
    s_mov_b64 exec, s[54:55]
    s_branch L2_d30
L2_c31:
    s_lshl_b64 s[52:53], s[82:83], 1
    s_andn2_b64 s[52:53], s[52:53], s[80:81]
    s_andn2_b64 s[52:53], s[52:53], s[50:51]
    s_or_b64 s[80:81], s[80:81], s[52:53]
    s_not_b64 vcc, s[52:53]
    s_mov_b64 exec, -1
    v_cndmask_b32_dpp v84, v84, v84, vcc wave_shr:1 row_mask:0xf bank_mask:0xf
    v_cndmask_b32_dpp v85, v85, v85, vcc wave_shr:1 row_mask:0xf bank_mask:0xf
    s_lshr_b64 s[52:53], s[52:53], 1
    v_cndmask_b32_dpp v86, v86, v86, vcc wave_shr:1 row_mask:0xf bank_mask:0xf
    v_cndmask_b32_dpp v87, v87, v87, vcc wave_shr:1 row_mask:0xf bank_mask:0xf
    s_andn2_b64 s[82:83], s[82:83], s[52:53]
    v_cndmask_b32_dpp v7, v7, v7, vcc wave_shr:1 row_mask:0xf bank_mask:0xf
    s_mov_b64 exec, s[50:51]
    s_cbranch_scc0 L2_d31
    s_mov_b64 exec, s[82:83]
    s_nop 1
    v_mfma_f32_4x4x4_16b_bf16 v[88:91], v[12:13], v[84:85], 0
    s_nop 1
    v_mfma_f32_4x4x4_16b_bf16 v[88:91], v[10:11], v[86:87], v[88:91]
    s_nop 4
    v_cvt_pk_bf16_f32 v88, v88, v89
    v_cvt_pk_bf16_f32 v89, v90, v91
    ds_pk_add_bf16 v7, v88 offset:65408
    ds_pk_add_bf16 v7, v89 offset:65412
    s_mov_b64 exec, s[50:51]
    s_branch L2_d31
L2_xo32:
    v_cmp_lt_u32 vcc, 20, v99
    s_mov_b32 s101, 1
    s_cbranch_vccz L2_xp32
    v_cmp_lt_u32 vcc, 32, v99
    v_cmp_lt_u32 s[58:59], 31, v88
    s_mov_b32 s101, 2
    s_or_b64 vcc, vcc, s[58:59]
    s_cbranch_scc0 L2_xp32
    s_mov_b32 s37, 0x10000
    s_branch L2_xp32
L2_c33:
    s_lshl_b64 s[52:53], s[82:83], 1
    s_andn2_b64 s[52:53], s[52:53], s[80:81]
    s_andn2_b64 s[52:53], s[52:53], s[54:55]
    s_or_b64 s[80:81], s[80:81], s[52:53]
    s_not_b64 vcc, s[52:53]
    s_mov_b64 exec, -1
    v_cndmask_b32_dpp v84, v84, v84, vcc wave_shr:1 row_mask:0xf bank_mask:0xf
    v_cndmask_b32_dpp v85, v85, v85, vcc wave_shr:1 row_mask:0xf bank_mask:0xf
    s_lshr_b64 s[52:53], s[52:53], 1
    v_cndmask_b32_dpp v86, v86, v86, vcc wave_shr:1 row_mask:0xf bank_mask:0xf
    v_cndmask_b32_dpp v87, v87, v87, vcc wave_shr:1 row_mask:0xf bank_mask:0xf
    s_andn2_b64 s[82:83], s[82:83], s[52:53]
    v_cndmask_b32_dpp v7, v7, v7, vcc wave_shr:1 row_mask:0xf bank_mask:0xf
    s_mov_b64 exec, s[54:55]
    s_cbranch_scc0 L2_d33
    s_mov_b64 exec, s[82:83]
    s_nop 1
    v_mfma_f32_4x4x4_16b_bf16 v[88:91], v[12:13], v[84:85], 0
    s_nop 1
    v_mfma_f32_4x4x4_16b_bf16 v[88:91], v[10:11], v[86:87], v[88:91]
    s_nop 4
    v_cvt_pk_bf16_f32 v88, v88, v89
    v_cvt_pk_bf16_f32 v89, v90, v91
    ds_pk_add_bf16 v7, v88 offset:65408
    ds_pk_add_bf16 v7, v89 offset:65412
    s_mov_b64 exec, s[54:55]
    s_branch L2_d33
L2_c34:
    s_lshl_b64 s[52:53], s[82:83], 1
    s_andn2_b64 s[52:53], s[52:53], s[80:81]
    s_andn2_b64 s[52:53], s[52:53], s[50:51]
    s_or_b64 s[80:81], s[80:81], s[52:53]
    s_not_b64 vcc, s[52:53]
    s_mov_b64 exec, -1
    v_cndmask_b32_dpp v84, v84, v84, vcc wave_shr:1 row_mask:0xf bank_mask:0xf
    v_cndmask_b32_dpp v85, v85, v85, vcc wave_shr:1 row_mask:0xf bank_mask:0xf
    s_lshr_b64 s[52:53], s[52:53], 1
    v_cndmask_b32_dpp v86, v86, v86, vcc wave_shr:1 row_mask:0xf bank_mask:0xf
    v_cndmask_b32_dpp v87, v87, v87, vcc wave_shr:1 row_mask:0xf bank_mask:0xf
    s_andn2_b64 s[82:83], s[82:83], s[52:53]
    v_cndmask_b32_dpp v7, v7, v7, vcc wave_shr:1 row_mask:0xf bank_mask:0xf
    s_mov_b64 exec, s[50:51]
    s_cbranch_scc0 L2_d34
    s_mov_b64 exec, s[82:83]
    s_nop 1
    v_mfma_f32_4x4x4_16b_bf16 v[88:91], v[12:13], v[84:85], 0
    s_nop 1
    v_mfma_f32_4x4x4_16b_bf16 v[88:91], v[10:11], v[86:87], v[88:91]
    s_nop 4
    v_cvt_pk_bf16_f32 v88, v88, v89
    v_cvt_pk_bf16_f32 v89, v90, v91
    ds_pk_add_bf16 v7, v88 offset:65408
    ds_pk_add_bf16 v7, v89 offset:65412
    s_mov_b64 exec, s[50:51]
    s_branch L2_d34
L2_c35:
    s_lshl_b64 s[52:53], s[82:83], 1
    s_andn2_b64 s[52:53], s[52:53], s[80:81]
    s_andn2_b64 s[52:53], s[52:53], s[54:55]
    s_or_b64 s[80:81], s[80:81], s[52:53]
    s_not_b64 vcc, s[52:53]
    s_mov_b64 exec, -1
    v_cndmask_b32_dpp v84, v84, v84, vcc wave_shr:1 row_mask:0xf bank_mask:0xf
    v_cndmask_b32_dpp v85, v85, v85, vcc wave_shr:1 row_mask:0xf bank_mask:0xf
    s_lshr_b64 s[52:53], s[52:53], 1
    v_cndmask_b32_dpp v86, v86, v86, vcc wave_shr:1 row_mask:0xf bank_mask:0xf
    v_cndmask_b32_dpp v87, v87, v87, vcc wave_shr:1 row_mask:0xf bank_mask:0xf
    s_andn2_b64 s[82:83], s[82:83], s[52:53]
    v_cndmask_b32_dpp v7, v7, v7, vcc wave_shr:1 row_mask:0xf bank_mask:0xf
    s_mov_b64 exec, s[54:55]
    s_cbranch_scc0 L2_d35
    s_mov_b64 exec, s[82:83]
    s_nop 1
    v_mfma_f32_4x4x4_16b_bf16 v[88:91], v[12:13], v[84:85], 0
    s_nop 1
    v_mfma_f32_4x4x4_16b_bf16 v[88:91], v[10:11], v[86:87], v[88:91]
    s_nop 4
    v_cvt_pk_bf16_f32 v88, v88, v89
    v_cvt_pk_bf16_f32 v89, v90, v91
    ds_pk_add_bf16 v7, v88 offset:65408
    ds_pk_add_bf16 v7, v89 offset:65412
    s_mov_b64 exec, s[54:55]
    s_branch L2_d35
L2_c36:
    s_lshl_b64 s[52:53], s[82:83], 1
    s_andn2_b64 s[52:53], s[52:53], s[80:81]
    s_andn2_b64 s[52:53], s[52:53], s[50:51]
    s_or_b64 s[80:81], s[80:81], s[52:53]
    s_not_b64 vcc, s[52:53]
    s_mov_b64 exec, -1
    v_cndmask_b32_dpp v84, v84, v84, vcc wave_shr:1 row_mask:0xf bank_mask:0xf
    v_cndmask_b32_dpp v85, v85, v85, vcc wave_shr:1 row_mask:0xf bank_mask:0xf
    s_lshr_b64 s[52:53], s[52:53], 1
    v_cndmask_b32_dpp v86, v86, v86, vcc wave_shr:1 row_mask:0xf bank_mask:0xf
    v_cndmask_b32_dpp v87, v87, v87, vcc wave_shr:1 row_mask:0xf bank_mask:0xf
    s_andn2_b64 s[82:83], s[82:83], s[52:53]
    v_cndmask_b32_dpp v7, v7, v7, vcc wave_shr:1 row_mask:0xf bank_mask:0xf
    s_mov_b64 exec, s[50:51]
    s_cbranch_scc0 L2_d36
    s_mov_b64 exec, s[82:83]
    s_nop 1
    v_mfma_f32_4x4x4_16b_bf16 v[88:91], v[12:13], v[84:85], 0
    s_nop 1
    v_mfma_f32_4x4x4_16b_bf16 v[88:91], v[10:11], v[86:87], v[88:91]
    s_nop 4
    v_cvt_pk_bf16_f32 v88, v88, v89
    v_cvt_pk_bf16_f32 v89, v90, v91
    ds_pk_add_bf16 v7, v88 offset:65408
    ds_pk_add_bf16 v7, v89 offset:65412
    s_mov_b64 exec, s[50:51]
    s_branch L2_d36
L2_c37:
    s_lshl_b64 s[52:53], s[82:83], 1
    s_andn2_b64 s[52:53], s[52:53], s[80:81]
    s_andn2_b64 s[52:53], s[52:53], s[54:55]
    s_or_b64 s[80:81], s[80:81], s[52:53]
    s_not_b64 vcc, s[52:53]
    s_mov_b64 exec, -1
    v_cndmask_b32_dpp v84, v84, v84, vcc wave_shr:1 row_mask:0xf bank_mask:0xf
    v_cndmask_b32_dpp v85, v85, v85, vcc wave_shr:1 row_mask:0xf bank_mask:0xf
    s_lshr_b64 s[52:53], s[52:53], 1
    v_cndmask_b32_dpp v86, v86, v86, vcc wave_shr:1 row_mask:0xf bank_mask:0xf
    v_cndmask_b32_dpp v87, v87, v87, vcc wave_shr:1 row_mask:0xf bank_mask:0xf
    s_andn2_b64 s[82:83], s[82:83], s[52:53]
    v_cndmask_b32_dpp v7, v7, v7, vcc wave_shr:1 row_mask:0xf bank_mask:0xf
    s_mov_b64 exec, s[54:55]
    s_cbranch_scc0 L2_d37
    s_mov_b64 exec, s[82:83]
    s_nop 1
    v_mfma_f32_4x4x4_16b_bf16 v[88:91], v[12:13], v[84:85], 0
    s_nop 1
    v_mfma_f32_4x4x4_16b_bf16 v[88:91], v[10:11], v[86:87], v[88:91]
    s_nop 4
    v_cvt_pk_bf16_f32 v88, v88, v89
    v_cvt_pk_bf16_f32 v89, v90, v91
    ds_pk_add_bf16 v7, v88 offset:65408
    ds_pk_add_bf16 v7, v89 offset:65412
    s_mov_b64 exec, s[54:55]
    s_branch L2_d37
L2_c38:
    s_lshl_b64 s[52:53], s[82:83], 1
    s_andn2_b64 s[52:53], s[52:53], s[80:81]
    s_andn2_b64 s[52:53], s[52:53], s[50:51]
    s_or_b64 s[80:81], s[80:81], s[52:53]
    s_not_b64 vcc, s[52:53]
    s_mov_b64 exec, -1
    v_cndmask_b32_dpp v84, v84, v84, vcc wave_shr:1 row_mask:0xf bank_mask:0xf
    v_cndmask_b32_dpp v85, v85, v85, vcc wave_shr:1 row_mask:0xf bank_mask:0xf
    s_lshr_b64 s[52:53], s[52:53], 1
    v_cndmask_b32_dpp v86, v86, v86, vcc wave_shr:1 row_mask:0xf bank_mask:0xf
    v_cndmask_b32_dpp v87, v87, v87, vcc wave_shr:1 row_mask:0xf bank_mask:0xf
    s_andn2_b64 s[82:83], s[82:83], s[52:53]
    v_cndmask_b32_dpp v7, v7, v7, vcc wave_shr:1 row_mask:0xf bank_mask:0xf
    s_mov_b64 exec, s[50:51]
    s_cbranch_scc0 L2_d38
    s_mov_b64 exec, s[82:83]
    s_nop 1
    v_mfma_f32_4x4x4_16b_bf16 v[88:91], v[12:13], v[84:85], 0
    s_nop 1
    v_mfma_f32_4x4x4_16b_bf16 v[88:91], v[10:11], v[86:87], v[88:91]
    s_nop 4
    v_cvt_pk_bf16_f32 v88, v88, v89
    v_cvt_pk_bf16_f32 v89, v90, v91
    ds_pk_add_bf16 v7, v88 offset:65408
    ds_pk_add_bf16 v7, v89 offset:65412
    s_mov_b64 exec, s[50:51]
    s_branch L2_d38
L2_c39:
    s_lshl_b64 s[52:53], s[82:83], 1
    s_andn2_b64 s[52:53], s[52:53], s[80:81]
    s_andn2_b64 s[52:53], s[52:53], s[54:55]
    s_or_b64 s[80:81], s[80:81], s[52:53]
    s_not_b64 vcc, s[52:53]
    s_mov_b64 exec, -1
    v_cndmask_b32_dpp v84, v84, v84, vcc wave_shr:1 row_mask:0xf bank_mask:0xf
    v_cndmask_b32_dpp v85, v85, v85, vcc wave_shr:1 row_mask:0xf bank_mask:0xf
    s_lshr_b64 s[52:53], s[52:53], 1
    v_cndmask_b32_dpp v86, v86, v86, vcc wave_shr:1 row_mask:0xf bank_mask:0xf
    v_cndmask_b32_dpp v87, v87, v87, vcc wave_shr:1 row_mask:0xf bank_mask:0xf
    s_andn2_b64 s[82:83], s[82:83], s[52:53]
    v_cndmask_b32_dpp v7, v7, v7, vcc wave_shr:1 row_mask:0xf bank_mask:0xf
    s_mov_b64 exec, s[54:55]
    s_cbranch_scc0 L2_d39
    s_mov_b64 exec, s[82:83]
    s_nop 1
    v_mfma_f32_4x4x4_16b_bf16 v[88:91], v[12:13], v[84:85], 0
    s_nop 1
    v_mfma_f32_4x4x4_16b_bf16 v[88:91], v[10:11], v[86:87], v[88:91]
    s_nop 4
    v_cvt_pk_bf16_f32 v88, v88, v89
    v_cvt_pk_bf16_f32 v89, v90, v91
    ds_pk_add_bf16 v7, v88 offset:65408
    ds_pk_add_bf16 v7, v89 offset:65412
    s_mov_b64 exec, s[54:55]
    s_branch L2_d39
L2_c40:
    s_lshl_b64 s[52:53], s[82:83], 1
    s_andn2_b64 s[52:53], s[52:53], s[80:81]
    s_andn2_b64 s[52:53], s[52:53], s[50:51]
    s_or_b64 s[80:81], s[80:81], s[52:53]
    s_not_b64 vcc, s[52:53]
    s_mov_b64 exec, -1
    v_cndmask_b32_dpp v84, v84, v84, vcc wave_shr:1 row_mask:0xf bank_mask:0xf
    v_cndmask_b32_dpp v85, v85, v85, vcc wave_shr:1 row_mask:0xf bank_mask:0xf
    s_lshr_b64 s[52:53], s[52:53], 1
    v_cndmask_b32_dpp v86, v86, v86, vcc wave_shr:1 row_mask:0xf bank_mask:0xf
    v_cndmask_b32_dpp v87, v87, v87, vcc wave_shr:1 row_mask:0xf bank_mask:0xf
    s_andn2_b64 s[82:83], s[82:83], s[52:53]
    v_cndmask_b32_dpp v7, v7, v7, vcc wave_shr:1 row_mask:0xf bank_mask:0xf
    s_mov_b64 exec, s[50:51]
    s_cbranch_scc0 L2_d40
    s_mov_b64 exec, s[82:83]
    s_nop 1
    v_mfma_f32_4x4x4_16b_bf16 v[88:91], v[12:13], v[84:85], 0
    s_nop 1
    v_mfma_f32_4x4x4_16b_bf16 v[88:91], v[10:11], v[86:87], v[88:91]
    s_nop 4
    v_cvt_pk_bf16_f32 v88, v88, v89
    v_cvt_pk_bf16_f32 v89, v90, v91
    ds_pk_add_bf16 v7, v88 offset:65408
    ds_pk_add_bf16 v7, v89 offset:65412
    s_mov_b64 exec, s[50:51]
    s_branch L2_d40
L2_c41:
    s_lshl_b64 s[52:53], s[82:83], 1
    s_andn2_b64 s[52:53], s[52:53], s[80:81]
    s_andn2_b64 s[52:53], s[52:53], s[54:55]
    s_or_b64 s[80:81], s[80:81], s[52:53]
    s_not_b64 vcc, s[52:53]
    s_mov_b64 exec, -1
    v_cndmask_b32_dpp v84, v84, v84, vcc wave_shr:1 row_mask:0xf bank_mask:0xf
    v_cndmask_b32_dpp v85, v85, v85, vcc wave_shr:1 row_mask:0xf bank_mask:0xf
    s_lshr_b64 s[52:53], s[52:53], 1
    v_cndmask_b32_dpp v86, v86, v86, vcc wave_shr:1 row_mask:0xf bank_mask:0xf
    v_cndmask_b32_dpp v87, v87, v87, vcc wave_shr:1 row_mask:0xf bank_mask:0xf
    s_andn2_b64 s[82:83], s[82:83], s[52:53]
    v_cndmask_b32_dpp v7, v7, v7, vcc wave_shr:1 row_mask:0xf bank_mask:0xf
    s_mov_b64 exec, s[54:55]
    s_cbranch_scc0 L2_d41
    s_mov_b64 exec, s[82:83]
    s_nop 1
    v_mfma_f32_4x4x4_16b_bf16 v[88:91], v[12:13], v[84:85], 0
    s_nop 1
    v_mfma_f32_4x4x4_16b_bf16 v[88:91], v[10:11], v[86:87], v[88:91]
    s_nop 4
    v_cvt_pk_bf16_f32 v88, v88, v89
    v_cvt_pk_bf16_f32 v89, v90, v91
    ds_pk_add_bf16 v7, v88 offset:65408
    ds_pk_add_bf16 v7, v89 offset:65412
    s_mov_b64 exec, s[54:55]
    s_branch L2_d41
L2_c42:
    s_lshl_b64 s[52:53], s[82:83], 1
    s_andn2_b64 s[52:53], s[52:53], s[80:81]
    s_andn2_b64 s[52:53], s[52:53], s[50:51]
    s_or_b64 s[80:81], s[80:81], s[52:53]
    s_not_b64 vcc, s[52:53]
    s_mov_b64 exec, -1
    v_cndmask_b32_dpp v84, v84, v84, vcc wave_shr:1 row_mask:0xf bank_mask:0xf
    v_cndmask_b32_dpp v85, v85, v85, vcc wave_shr:1 row_mask:0xf bank_mask:0xf
    s_lshr_b64 s[52:53], s[52:53], 1
    v_cndmask_b32_dpp v86, v86, v86, vcc wave_shr:1 row_mask:0xf bank_mask:0xf
    v_cndmask_b32_dpp v87, v87, v87, vcc wave_shr:1 row_mask:0xf bank_mask:0xf
    s_andn2_b64 s[82:83], s[82:83], s[52:53]
    v_cndmask_b32_dpp v7, v7, v7, vcc wave_shr:1 row_mask:0xf bank_mask:0xf
    s_mov_b64 exec, s[50:51]
    s_cbranch_scc0 L2_d42
    s_mov_b64 exec, s[82:83]
    s_nop 1
    v_mfma_f32_4x4x4_16b_bf16 v[88:91], v[12:13], v[84:85], 0
    s_nop 1
    v_mfma_f32_4x4x4_16b_bf16 v[88:91], v[10:11], v[86:87], v[88:91]
    s_nop 4
    v_cvt_pk_bf16_f32 v88, v88, v89
    v_cvt_pk_bf16_f32 v89, v90, v91
    ds_pk_add_bf16 v7, v88 offset:65408
    ds_pk_add_bf16 v7, v89 offset:65412
    s_mov_b64 exec, s[50:51]
    s_branch L2_d42
L2_xa43:
    s_cmp_eq_u32 s101, 1
    s_cbranch_scc1 L2_xc43
    v_lshlrev_b32 v89, 0, v96
    v_add_u32 v90, 140, v97
    v_bitop3_b32 v90, v89, v45, v90 bitop3:0x6a
    ds_write_b32 v98, v90 offset:28
    v_lshlrev_b32 v89, 4, v96
    v_add_u32 v90, 120, v97
    v_bitop3_b32 v90, v89, v45, v90 bitop3:0x6a
    ds_write_b32 v98, v90 offset:24
    v_lshlrev_b32 v89, 8, v96
    v_add_u32 v90, 100, v97
    v_bitop3_b32 v90, v89, v45, v90 bitop3:0x6a
    ds_write_b32 v98, v90 offset:20
L2_xc43:
    v_lshlrev_b32 v89, 12, v96
    v_add_u32 v90, 80, v97
    v_bitop3_b32 v90, v89, v45, v90 bitop3:0x6a
    ds_write_b32 v98, v90 offset:16
    s_branch L2_xb43
L2_xe43:
    v_cmp_lt_u32 vcc, 32, v99
    v_cmp_lt_u32 s[58:59], 31, v88
    v_lshrrev_b32 v89, 16, v96
    v_add_u32 v97, 80, v97
    s_or_b64 vcc, vcc, s[58:59]
    s_cbranch_scc1 L2_xs43
    v_lshlrev_b32 v89, v1, v89
    v_and_b32 v89, v45, v89
    v_cmp_ne_u32 vcc, 0, v89
    v_xor_b32 v90, v97, v89
    s_add_u32 s3, s37, s38
    v_mbcnt_lo_u32_b32 v98, vcc_lo, 0
    v_mbcnt_hi_u32_b32 v98, vcc_hi, v98
    s_bcnt1_i32_b64 s41, vcc
    v_lshl_add_u32 v98, v98, 2, s3
    s_mov_b64 exec, vcc
    ds_write_b32 v98, v90
    s_mov_b64 exec, -1
    s_lshl2_add_u32 s37, s41, s37
    s_branch L2_xr43
L2_xf43:
    s_waitcnt lgkmcnt(0)
    s_cmp_gt_u32 s37, 1024
    s_cbranch_scc1 L2_xs43
    v_mov_b32 v43, -1
    s_cmp_ge_u32 s37, 512
    s_cbranch_scc1 L2_xg43
    v_mov_b32 v42, -1
    s_cmp_ge_u32 s37, 256
    s_cbranch_scc1 L2_xg43
    v_mov_b32 v41, -1
    s_branch L2_xg43
L2_xs43:
    s_waitcnt lgkmcnt(0)
    v_mov_b32 v40, -1
    v_mov_b32 v41, -1
    v_mov_b32 v42, -1
    v_mov_b32 v43, -1
    s_add_u32 s3, s42, 2
    s_bitset1_b32 s36, s3
    s_branch L2_xg43
L2_c44:
    s_lshl_b64 s[52:53], s[82:83], 1
    s_andn2_b64 s[52:53], s[52:53], s[80:81]
    s_andn2_b64 s[52:53], s[52:53], s[54:55]
    s_or_b64 s[80:81], s[80:81], s[52:53]
    s_not_b64 vcc, s[52:53]
    s_mov_b64 exec, -1
    v_cndmask_b32_dpp v84, v84, v84, vcc wave_shr:1 row_mask:0xf bank_mask:0xf
    v_cndmask_b32_dpp v85, v85, v85, vcc wave_shr:1 row_mask:0xf bank_mask:0xf
    s_lshr_b64 s[52:53], s[52:53], 1
    v_cndmask_b32_dpp v86, v86, v86, vcc wave_shr:1 row_mask:0xf bank_mask:0xf
    v_cndmask_b32_dpp v87, v87, v87, vcc wave_shr:1 row_mask:0xf bank_mask:0xf
    s_andn2_b64 s[82:83], s[82:83], s[52:53]
    v_cndmask_b32_dpp v7, v7, v7, vcc wave_shr:1 row_mask:0xf bank_mask:0xf
    s_mov_b64 exec, s[54:55]
    s_cbranch_scc0 L2_d44
    s_mov_b64 exec, s[82:83]
    s_nop 1
    v_mfma_f32_4x4x4_16b_bf16 v[88:91], v[12:13], v[84:85], 0
    s_nop 1
    v_mfma_f32_4x4x4_16b_bf16 v[88:91], v[10:11], v[86:87], v[88:91]
    s_nop 4
    v_cvt_pk_bf16_f32 v88, v88, v89
    v_cvt_pk_bf16_f32 v89, v90, v91
    ds_pk_add_bf16 v7, v88 offset:65408
    ds_pk_add_bf16 v7, v89 offset:65412
    s_mov_b64 exec, s[54:55]
    s_branch L2_d44
L2_c45:
    s_lshl_b64 s[52:53], s[82:83], 1
    s_andn2_b64 s[52:53], s[52:53], s[80:81]
    s_andn2_b64 s[52:53], s[52:53], s[50:51]
    s_or_b64 s[80:81], s[80:81], s[52:53]
    s_not_b64 vcc, s[52:53]
    s_mov_b64 exec, -1
    v_cndmask_b32_dpp v84, v84, v84, vcc wave_shr:1 row_mask:0xf bank_mask:0xf
    v_cndmask_b32_dpp v85, v85, v85, vcc wave_shr:1 row_mask:0xf bank_mask:0xf
    s_lshr_b64 s[52:53], s[52:53], 1
    v_cndmask_b32_dpp v86, v86, v86, vcc wave_shr:1 row_mask:0xf bank_mask:0xf
    v_cndmask_b32_dpp v87, v87, v87, vcc wave_shr:1 row_mask:0xf bank_mask:0xf
    s_andn2_b64 s[82:83], s[82:83], s[52:53]
    v_cndmask_b32_dpp v7, v7, v7, vcc wave_shr:1 row_mask:0xf bank_mask:0xf
    s_mov_b64 exec, s[50:51]
    s_cbranch_scc0 L2_d45
    s_mov_b64 exec, s[82:83]
    s_nop 1
    v_mfma_f32_4x4x4_16b_bf16 v[88:91], v[12:13], v[84:85], 0
    s_nop 1
    v_mfma_f32_4x4x4_16b_bf16 v[88:91], v[10:11], v[86:87], v[88:91]
    s_nop 4
    v_cvt_pk_bf16_f32 v88, v88, v89
    v_cvt_pk_bf16_f32 v89, v90, v91
    ds_pk_add_bf16 v7, v88 offset:65408
    ds_pk_add_bf16 v7, v89 offset:65412
    s_mov_b64 exec, s[50:51]
    s_branch L2_d45
L2_c46:
    s_lshl_b64 s[52:53], s[82:83], 1
    s_andn2_b64 s[52:53], s[52:53], s[80:81]
    s_andn2_b64 s[52:53], s[52:53], s[54:55]
    s_or_b64 s[80:81], s[80:81], s[52:53]
    s_not_b64 vcc, s[52:53]
    s_mov_b64 exec, -1
    v_cndmask_b32_dpp v84, v84, v84, vcc wave_shr:1 row_mask:0xf bank_mask:0xf
    v_cndmask_b32_dpp v85, v85, v85, vcc wave_shr:1 row_mask:0xf bank_mask:0xf
    s_lshr_b64 s[52:53], s[52:53], 1
    v_cndmask_b32_dpp v86, v86, v86, vcc wave_shr:1 row_mask:0xf bank_mask:0xf
    v_cndmask_b32_dpp v87, v87, v87, vcc wave_shr:1 row_mask:0xf bank_mask:0xf
    s_andn2_b64 s[82:83], s[82:83], s[52:53]
    v_cndmask_b32_dpp v7, v7, v7, vcc wave_shr:1 row_mask:0xf bank_mask:0xf
    s_mov_b64 exec, s[54:55]
    s_cbranch_scc0 L2_d46
    s_mov_b64 exec, s[82:83]
    s_nop 1
    v_mfma_f32_4x4x4_16b_bf16 v[88:91], v[12:13], v[84:85], 0
    s_nop 1
    v_mfma_f32_4x4x4_16b_bf16 v[88:91], v[10:11], v[86:87], v[88:91]
    s_nop 4
    v_cvt_pk_bf16_f32 v88, v88, v89
    v_cvt_pk_bf16_f32 v89, v90, v91
    ds_pk_add_bf16 v7, v88 offset:65408
    ds_pk_add_bf16 v7, v89 offset:65412
    s_mov_b64 exec, s[54:55]
    s_branch L2_d46
L2_c47:
    s_lshl_b64 s[52:53], s[82:83], 1
    s_andn2_b64 s[52:53], s[52:53], s[80:81]
    s_andn2_b64 s[52:53], s[52:53], s[50:51]
    s_or_b64 s[80:81], s[80:81], s[52:53]
    s_not_b64 vcc, s[52:53]
    s_mov_b64 exec, -1
    v_cndmask_b32_dpp v84, v84, v84, vcc wave_shr:1 row_mask:0xf bank_mask:0xf
    v_cndmask_b32_dpp v85, v85, v85, vcc wave_shr:1 row_mask:0xf bank_mask:0xf
    s_lshr_b64 s[52:53], s[52:53], 1
    v_cndmask_b32_dpp v86, v86, v86, vcc wave_shr:1 row_mask:0xf bank_mask:0xf
    v_cndmask_b32_dpp v87, v87, v87, vcc wave_shr:1 row_mask:0xf bank_mask:0xf
    s_andn2_b64 s[82:83], s[82:83], s[52:53]
    v_cndmask_b32_dpp v7, v7, v7, vcc wave_shr:1 row_mask:0xf bank_mask:0xf
    s_mov_b64 exec, s[50:51]
    s_cbranch_scc0 L2_d47
    s_mov_b64 exec, s[82:83]
    s_nop 1
    v_mfma_f32_4x4x4_16b_bf16 v[88:91], v[12:13], v[84:85], 0
    s_nop 1
    v_mfma_f32_4x4x4_16b_bf16 v[88:91], v[10:11], v[86:87], v[88:91]
    s_nop 4
    v_cvt_pk_bf16_f32 v88, v88, v89
    v_cvt_pk_bf16_f32 v89, v90, v91
    ds_pk_add_bf16 v7, v88 offset:65408
    ds_pk_add_bf16 v7, v89 offset:65412
    s_mov_b64 exec, s[50:51]
    s_branch L2_d47
L2_c48:
    s_lshl_b64 s[52:53], s[82:83], 1
    s_andn2_b64 s[52:53], s[52:53], s[80:81]
    s_andn2_b64 s[52:53], s[52:53], s[54:55]
    s_or_b64 s[80:81], s[80:81], s[52:53]
    s_not_b64 vcc, s[52:53]
    s_mov_b64 exec, -1
    v_cndmask_b32_dpp v84, v84, v84, vcc wave_shr:1 row_mask:0xf bank_mask:0xf
    v_cndmask_b32_dpp v85, v85, v85, vcc wave_shr:1 row_mask:0xf bank_mask:0xf
    s_lshr_b64 s[52:53], s[52:53], 1
    v_cndmask_b32_dpp v86, v86, v86, vcc wave_shr:1 row_mask:0xf bank_mask:0xf
    v_cndmask_b32_dpp v87, v87, v87, vcc wave_shr:1 row_mask:0xf bank_mask:0xf
    s_andn2_b64 s[82:83], s[82:83], s[52:53]
    v_cndmask_b32_dpp v7, v7, v7, vcc wave_shr:1 row_mask:0xf bank_mask:0xf
    s_mov_b64 exec, s[54:55]
    s_cbranch_scc0 L2_d48
    s_mov_b64 exec, s[82:83]
    s_nop 1
    v_mfma_f32_4x4x4_16b_bf16 v[88:91], v[12:13], v[84:85], 0
    s_nop 1
    v_mfma_f32_4x4x4_16b_bf16 v[88:91], v[10:11], v[86:87], v[88:91]
    s_nop 4
    v_cvt_pk_bf16_f32 v88, v88, v89
    v_cvt_pk_bf16_f32 v89, v90, v91
    ds_pk_add_bf16 v7, v88 offset:65408
    ds_pk_add_bf16 v7, v89 offset:65412
    s_mov_b64 exec, s[54:55]
    s_branch L2_d48
L2_c49:
    s_lshl_b64 s[52:53], s[82:83], 1
    s_andn2_b64 s[52:53], s[52:53], s[80:81]
    s_andn2_b64 s[52:53], s[52:53], s[50:51]
    s_or_b64 s[80:81], s[80:81], s[52:53]
    s_not_b64 vcc, s[52:53]
    s_mov_b64 exec, -1
    v_cndmask_b32_dpp v84, v84, v84, vcc wave_shr:1 row_mask:0xf bank_mask:0xf
    v_cndmask_b32_dpp v85, v85, v85, vcc wave_shr:1 row_mask:0xf bank_mask:0xf
    s_lshr_b64 s[52:53], s[52:53], 1
    v_cndmask_b32_dpp v86, v86, v86, vcc wave_shr:1 row_mask:0xf bank_mask:0xf
    v_cndmask_b32_dpp v87, v87, v87, vcc wave_shr:1 row_mask:0xf bank_mask:0xf
    s_andn2_b64 s[82:83], s[82:83], s[52:53]
    v_cndmask_b32_dpp v7, v7, v7, vcc wave_shr:1 row_mask:0xf bank_mask:0xf
    s_mov_b64 exec, s[50:51]
    s_cbranch_scc0 L2_d49
    s_mov_b64 exec, s[82:83]
    s_nop 1
    v_mfma_f32_4x4x4_16b_bf16 v[88:91], v[12:13], v[84:85], 0
    s_nop 1
    v_mfma_f32_4x4x4_16b_bf16 v[88:91], v[10:11], v[86:87], v[88:91]
    s_nop 4
    v_cvt_pk_bf16_f32 v88, v88, v89
    v_cvt_pk_bf16_f32 v89, v90, v91
    ds_pk_add_bf16 v7, v88 offset:65408
    ds_pk_add_bf16 v7, v89 offset:65412
    s_mov_b64 exec, s[50:51]
    s_branch L2_d49
L2_xo50:
    v_cmp_lt_u32 vcc, 20, v99
    s_mov_b32 s101, 1
    s_cbranch_vccz L2_xp50
    v_cmp_lt_u32 vcc, 32, v99
    v_cmp_lt_u32 s[58:59], 31, v88
    s_mov_b32 s101, 2
    s_or_b64 vcc, vcc, s[58:59]
    s_cbranch_scc0 L2_xp50
    s_mov_b32 s37, 0x10000
    s_branch L2_xp50
L2_c51:
    s_lshl_b64 s[52:53], s[82:83], 1
    s_andn2_b64 s[52:53], s[52:53], s[80:81]
    s_andn2_b64 s[52:53], s[52:53], s[54:55]
    s_or_b64 s[80:81], s[80:81], s[52:53]
    s_not_b64 vcc, s[52:53]
    s_mov_b64 exec, -1
    v_cndmask_b32_dpp v84, v84, v84, vcc wave_shr:1 row_mask:0xf bank_mask:0xf
    v_cndmask_b32_dpp v85, v85, v85, vcc wave_shr:1 row_mask:0xf bank_mask:0xf
    s_lshr_b64 s[52:53], s[52:53], 1
    v_cndmask_b32_dpp v86, v86, v86, vcc wave_shr:1 row_mask:0xf bank_mask:0xf
    v_cndmask_b32_dpp v87, v87, v87, vcc wave_shr:1 row_mask:0xf bank_mask:0xf
    s_andn2_b64 s[82:83], s[82:83], s[52:53]
    v_cndmask_b32_dpp v7, v7, v7, vcc wave_shr:1 row_mask:0xf bank_mask:0xf
    s_mov_b64 exec, s[54:55]
    s_cbranch_scc0 L2_d51
    s_mov_b64 exec, s[82:83]
    s_nop 1
    v_mfma_f32_4x4x4_16b_bf16 v[88:91], v[12:13], v[84:85], 0
    s_nop 1
    v_mfma_f32_4x4x4_16b_bf16 v[88:91], v[10:11], v[86:87], v[88:91]
    s_nop 4
    v_cvt_pk_bf16_f32 v88, v88, v89
    v_cvt_pk_bf16_f32 v89, v90, v91
    ds_pk_add_bf16 v7, v88 offset:65408
    ds_pk_add_bf16 v7, v89 offset:65412
    s_mov_b64 exec, s[54:55]
    s_branch L2_d51
L2_c52:
    s_lshl_b64 s[52:53], s[82:83], 1
    s_andn2_b64 s[52:53], s[52:53], s[80:81]
    s_andn2_b64 s[52:53], s[52:53], s[50:51]
    s_or_b64 s[80:81], s[80:81], s[52:53]
    s_not_b64 vcc, s[52:53]
    s_mov_b64 exec, -1
    v_cndmask_b32_dpp v84, v84, v84, vcc wave_shr:1 row_mask:0xf bank_mask:0xf
    v_cndmask_b32_dpp v85, v85, v85, vcc wave_shr:1 row_mask:0xf bank_mask:0xf
    s_lshr_b64 s[52:53], s[52:53], 1
    v_cndmask_b32_dpp v86, v86, v86, vcc wave_shr:1 row_mask:0xf bank_mask:0xf
    v_cndmask_b32_dpp v87, v87, v87, vcc wave_shr:1 row_mask:0xf bank_mask:0xf
    s_andn2_b64 s[82:83], s[82:83], s[52:53]
    v_cndmask_b32_dpp v7, v7, v7, vcc wave_shr:1 row_mask:0xf bank_mask:0xf
    s_mov_b64 exec, s[50:51]
    s_cbranch_scc0 L2_d52
    s_mov_b64 exec, s[82:83]
    s_nop 1
    v_mfma_f32_4x4x4_16b_bf16 v[88:91], v[12:13], v[84:85], 0
    s_nop 1
    v_mfma_f32_4x4x4_16b_bf16 v[88:91], v[10:11], v[86:87], v[88:91]
    s_nop 4
    v_cvt_pk_bf16_f32 v88, v88, v89
    v_cvt_pk_bf16_f32 v89, v90, v91
    ds_pk_add_bf16 v7, v88 offset:65408
    ds_pk_add_bf16 v7, v89 offset:65412
    s_mov_b64 exec, s[50:51]
    s_branch L2_d52
L2_c53:
    s_lshl_b64 s[52:53], s[82:83], 1
    s_andn2_b64 s[52:53], s[52:53], s[80:81]
    s_andn2_b64 s[52:53], s[52:53], s[54:55]
    s_or_b64 s[80:81], s[80:81], s[52:53]
    s_not_b64 vcc, s[52:53]
    s_mov_b64 exec, -1
    v_cndmask_b32_dpp v84, v84, v84, vcc wave_shr:1 row_mask:0xf bank_mask:0xf
    v_cndmask_b32_dpp v85, v85, v85, vcc wave_shr:1 row_mask:0xf bank_mask:0xf
    s_lshr_b64 s[52:53], s[52:53], 1
    v_cndmask_b32_dpp v86, v86, v86, vcc wave_shr:1 row_mask:0xf bank_mask:0xf
    v_cndmask_b32_dpp v87, v87, v87, vcc wave_shr:1 row_mask:0xf bank_mask:0xf
    s_andn2_b64 s[82:83], s[82:83], s[52:53]
    v_cndmask_b32_dpp v7, v7, v7, vcc wave_shr:1 row_mask:0xf bank_mask:0xf
    s_mov_b64 exec, s[54:55]
    s_cbranch_scc0 L2_d53
    s_mov_b64 exec, s[82:83]
    s_nop 1
    v_mfma_f32_4x4x4_16b_bf16 v[88:91], v[12:13], v[84:85], 0
    s_nop 1
    v_mfma_f32_4x4x4_16b_bf16 v[88:91], v[10:11], v[86:87], v[88:91]
    s_nop 4
    v_cvt_pk_bf16_f32 v88, v88, v89
    v_cvt_pk_bf16_f32 v89, v90, v91
    ds_pk_add_bf16 v7, v88 offset:65408
    ds_pk_add_bf16 v7, v89 offset:65412
    s_mov_b64 exec, s[54:55]
    s_branch L2_d53
L2_c54:
    s_lshl_b64 s[52:53], s[82:83], 1
    s_andn2_b64 s[52:53], s[52:53], s[80:81]
    s_andn2_b64 s[52:53], s[52:53], s[50:51]
    s_or_b64 s[80:81], s[80:81], s[52:53]
    s_not_b64 vcc, s[52:53]
    s_mov_b64 exec, -1
    v_cndmask_b32_dpp v84, v84, v84, vcc wave_shr:1 row_mask:0xf bank_mask:0xf
    v_cndmask_b32_dpp v85, v85, v85, vcc wave_shr:1 row_mask:0xf bank_mask:0xf
    s_lshr_b64 s[52:53], s[52:53], 1
    v_cndmask_b32_dpp v86, v86, v86, vcc wave_shr:1 row_mask:0xf bank_mask:0xf
    v_cndmask_b32_dpp v87, v87, v87, vcc wave_shr:1 row_mask:0xf bank_mask:0xf
    s_andn2_b64 s[82:83], s[82:83], s[52:53]
    v_cndmask_b32_dpp v7, v7, v7, vcc wave_shr:1 row_mask:0xf bank_mask:0xf
    s_mov_b64 exec, s[50:51]
    s_cbranch_scc0 L2_d54
    s_mov_b64 exec, s[82:83]
    s_nop 1
    v_mfma_f32_4x4x4_16b_bf16 v[88:91], v[12:13], v[84:85], 0
    s_nop 1
    v_mfma_f32_4x4x4_16b_bf16 v[88:91], v[10:11], v[86:87], v[88:91]
    s_nop 4
    v_cvt_pk_bf16_f32 v88, v88, v89
    v_cvt_pk_bf16_f32 v89, v90, v91
    ds_pk_add_bf16 v7, v88 offset:65408
    ds_pk_add_bf16 v7, v89 offset:65412
    s_mov_b64 exec, s[50:51]
    s_branch L2_d54
L2_c55:
    s_lshl_b64 s[52:53], s[82:83], 1
    s_andn2_b64 s[52:53], s[52:53], s[80:81]
    s_andn2_b64 s[52:53], s[52:53], s[54:55]
    s_or_b64 s[80:81], s[80:81], s[52:53]
    s_not_b64 vcc, s[52:53]
    s_mov_b64 exec, -1
    v_cndmask_b32_dpp v84, v84, v84, vcc wave_shr:1 row_mask:0xf bank_mask:0xf
    v_cndmask_b32_dpp v85, v85, v85, vcc wave_shr:1 row_mask:0xf bank_mask:0xf
    s_lshr_b64 s[52:53], s[52:53], 1
    v_cndmask_b32_dpp v86, v86, v86, vcc wave_shr:1 row_mask:0xf bank_mask:0xf
    v_cndmask_b32_dpp v87, v87, v87, vcc wave_shr:1 row_mask:0xf bank_mask:0xf
    s_andn2_b64 s[82:83], s[82:83], s[52:53]
    v_cndmask_b32_dpp v7, v7, v7, vcc wave_shr:1 row_mask:0xf bank_mask:0xf
    s_mov_b64 exec, s[54:55]
    s_cbranch_scc0 L2_d55
    s_mov_b64 exec, s[82:83]
    s_nop 1
    v_mfma_f32_4x4x4_16b_bf16 v[88:91], v[12:13], v[84:85], 0
    s_nop 1
    v_mfma_f32_4x4x4_16b_bf16 v[88:91], v[10:11], v[86:87], v[88:91]
    s_nop 4
    v_cvt_pk_bf16_f32 v88, v88, v89
    v_cvt_pk_bf16_f32 v89, v90, v91
    ds_pk_add_bf16 v7, v88 offset:65408
    ds_pk_add_bf16 v7, v89 offset:65412
    s_mov_b64 exec, s[54:55]
    s_branch L2_d55
L2_c56:
    s_lshl_b64 s[52:53], s[82:83], 1
    s_andn2_b64 s[52:53], s[52:53], s[80:81]
    s_andn2_b64 s[52:53], s[52:53], s[50:51]
    s_or_b64 s[80:81], s[80:81], s[52:53]
    s_not_b64 vcc, s[52:53]
    s_mov_b64 exec, -1
    v_cndmask_b32_dpp v84, v84, v84, vcc wave_shr:1 row_mask:0xf bank_mask:0xf
    v_cndmask_b32_dpp v85, v85, v85, vcc wave_shr:1 row_mask:0xf bank_mask:0xf
    s_lshr_b64 s[52:53], s[52:53], 1
    v_cndmask_b32_dpp v86, v86, v86, vcc wave_shr:1 row_mask:0xf bank_mask:0xf
    v_cndmask_b32_dpp v87, v87, v87, vcc wave_shr:1 row_mask:0xf bank_mask:0xf
    s_andn2_b64 s[82:83], s[82:83], s[52:53]
    v_cndmask_b32_dpp v7, v7, v7, vcc wave_shr:1 row_mask:0xf bank_mask:0xf
    s_mov_b64 exec, s[50:51]
    s_cbranch_scc0 L2_d56
    s_mov_b64 exec, s[82:83]
    s_nop 1
    v_mfma_f32_4x4x4_16b_bf16 v[88:91], v[12:13], v[84:85], 0
    s_nop 1
    v_mfma_f32_4x4x4_16b_bf16 v[88:91], v[10:11], v[86:87], v[88:91]
    s_nop 4
    v_cvt_pk_bf16_f32 v88, v88, v89
    v_cvt_pk_bf16_f32 v89, v90, v91
    ds_pk_add_bf16 v7, v88 offset:65408
    ds_pk_add_bf16 v7, v89 offset:65412
    s_mov_b64 exec, s[50:51]
    s_branch L2_d56
L2_c57:
    s_lshl_b64 s[52:53], s[82:83], 1
    s_andn2_b64 s[52:53], s[52:53], s[80:81]
    s_andn2_b64 s[52:53], s[52:53], s[54:55]
    s_or_b64 s[80:81], s[80:81], s[52:53]
    s_not_b64 vcc, s[52:53]
    s_mov_b64 exec, -1
    v_cndmask_b32_dpp v84, v84, v84, vcc wave_shr:1 row_mask:0xf bank_mask:0xf
    v_cndmask_b32_dpp v85, v85, v85, vcc wave_shr:1 row_mask:0xf bank_mask:0xf
    s_lshr_b64 s[52:53], s[52:53], 1
    v_cndmask_b32_dpp v86, v86, v86, vcc wave_shr:1 row_mask:0xf bank_mask:0xf
    v_cndmask_b32_dpp v87, v87, v87, vcc wave_shr:1 row_mask:0xf bank_mask:0xf
    s_andn2_b64 s[82:83], s[82:83], s[52:53]
    v_cndmask_b32_dpp v7, v7, v7, vcc wave_shr:1 row_mask:0xf bank_mask:0xf
    s_mov_b64 exec, s[54:55]
    s_cbranch_scc0 L2_d57
    s_mov_b64 exec, s[82:83]
    s_nop 1
    v_mfma_f32_4x4x4_16b_bf16 v[88:91], v[12:13], v[84:85], 0
    s_nop 1
    v_mfma_f32_4x4x4_16b_bf16 v[88:91], v[10:11], v[86:87], v[88:91]
    s_nop 4
    v_cvt_pk_bf16_f32 v88, v88, v89
    v_cvt_pk_bf16_f32 v89, v90, v91
    ds_pk_add_bf16 v7, v88 offset:65408
    ds_pk_add_bf16 v7, v89 offset:65412
    s_mov_b64 exec, s[54:55]
    s_branch L2_d57
L2_c58:
    s_lshl_b64 s[52:53], s[82:83], 1
    s_andn2_b64 s[52:53], s[52:53], s[80:81]
    s_andn2_b64 s[52:53], s[52:53], s[50:51]
    s_or_b64 s[80:81], s[80:81], s[52:53]
    s_not_b64 vcc, s[52:53]
    s_mov_b64 exec, -1
    v_cndmask_b32_dpp v84, v84, v84, vcc wave_shr:1 row_mask:0xf bank_mask:0xf
    v_cndmask_b32_dpp v85, v85, v85, vcc wave_shr:1 row_mask:0xf bank_mask:0xf
    s_lshr_b64 s[52:53], s[52:53], 1
    v_cndmask_b32_dpp v86, v86, v86, vcc wave_shr:1 row_mask:0xf bank_mask:0xf
    v_cndmask_b32_dpp v87, v87, v87, vcc wave_shr:1 row_mask:0xf bank_mask:0xf
    s_andn2_b64 s[82:83], s[82:83], s[52:53]
    v_cndmask_b32_dpp v7, v7, v7, vcc wave_shr:1 row_mask:0xf bank_mask:0xf
    s_mov_b64 exec, s[50:51]
    s_cbranch_scc0 L2_d58
    s_mov_b64 exec, s[82:83]
    s_nop 1
    v_mfma_f32_4x4x4_16b_bf16 v[88:91], v[12:13], v[84:85], 0
    s_nop 1
    v_mfma_f32_4x4x4_16b_bf16 v[88:91], v[10:11], v[86:87], v[88:91]
    s_nop 4
    v_cvt_pk_bf16_f32 v88, v88, v89
    v_cvt_pk_bf16_f32 v89, v90, v91
    ds_pk_add_bf16 v7, v88 offset:65408
    ds_pk_add_bf16 v7, v89 offset:65412
    s_mov_b64 exec, s[50:51]
    s_branch L2_d58
L2_c59:
    s_lshl_b64 s[52:53], s[82:83], 1
    s_andn2_b64 s[52:53], s[52:53], s[80:81]
    s_andn2_b64 s[52:53], s[52:53], s[54:55]
    s_or_b64 s[80:81], s[80:81], s[52:53]
    s_not_b64 vcc, s[52:53]
    s_mov_b64 exec, -1
    v_cndmask_b32_dpp v84, v84, v84, vcc wave_shr:1 row_mask:0xf bank_mask:0xf
    v_cndmask_b32_dpp v85, v85, v85, vcc wave_shr:1 row_mask:0xf bank_mask:0xf
    s_lshr_b64 s[52:53], s[52:53], 1
    v_cndmask_b32_dpp v86, v86, v86, vcc wave_shr:1 row_mask:0xf bank_mask:0xf
    v_cndmask_b32_dpp v87, v87, v87, vcc wave_shr:1 row_mask:0xf bank_mask:0xf
    s_andn2_b64 s[82:83], s[82:83], s[52:53]
    v_cndmask_b32_dpp v7, v7, v7, vcc wave_shr:1 row_mask:0xf bank_mask:0xf
    s_mov_b64 exec, s[54:55]
    s_cbranch_scc0 L2_d59
    s_mov_b64 exec, s[82:83]
    s_nop 1
    v_mfma_f32_4x4x4_16b_bf16 v[88:91], v[12:13], v[84:85], 0
    s_nop 1
    v_mfma_f32_4x4x4_16b_bf16 v[88:91], v[10:11], v[86:87], v[88:91]
    s_nop 4
    v_cvt_pk_bf16_f32 v88, v88, v89
    v_cvt_pk_bf16_f32 v89, v90, v91
    ds_pk_add_bf16 v7, v88 offset:65408
    ds_pk_add_bf16 v7, v89 offset:65412
    s_mov_b64 exec, s[54:55]
    s_branch L2_d59
L2_c60:
    s_lshl_b64 s[52:53], s[82:83], 1
    s_andn2_b64 s[52:53], s[52:53], s[80:81]
    s_andn2_b64 s[52:53], s[52:53], s[50:51]
    s_or_b64 s[80:81], s[80:81], s[52:53]
    s_not_b64 vcc, s[52:53]
    s_mov_b64 exec, -1
    v_cndmask_b32_dpp v84, v84, v84, vcc wave_shr:1 row_mask:0xf bank_mask:0xf
    v_cndmask_b32_dpp v85, v85, v85, vcc wave_shr:1 row_mask:0xf bank_mask:0xf
    s_lshr_b64 s[52:53], s[52:53], 1
    v_cndmask_b32_dpp v86, v86, v86, vcc wave_shr:1 row_mask:0xf bank_mask:0xf
    v_cndmask_b32_dpp v87, v87, v87, vcc wave_shr:1 row_mask:0xf bank_mask:0xf
    s_andn2_b64 s[82:83], s[82:83], s[52:53]
    v_cndmask_b32_dpp v7, v7, v7, vcc wave_shr:1 row_mask:0xf bank_mask:0xf
    s_mov_b64 exec, s[50:51]
    s_cbranch_scc0 L2_d60
    s_mov_b64 exec, s[82:83]
    s_nop 1
    v_mfma_f32_4x4x4_16b_bf16 v[88:91], v[12:13], v[84:85], 0
    s_nop 1
    v_mfma_f32_4x4x4_16b_bf16 v[88:91], v[10:11], v[86:87], v[88:91]
    s_nop 4
    v_cvt_pk_bf16_f32 v88, v88, v89
    v_cvt_pk_bf16_f32 v89, v90, v91
    ds_pk_add_bf16 v7, v88 offset:65408
    ds_pk_add_bf16 v7, v89 offset:65412
    s_mov_b64 exec, s[50:51]
    s_branch L2_d60
L2_xa61:
    s_cmp_eq_u32 s101, 1
    s_cbranch_scc1 L2_xc61
    v_lshlrev_b32 v89, 0, v96
    v_add_u32 v90, 140, v97
    v_bitop3_b32 v90, v89, v45, v90 bitop3:0x6a
    ds_write_b32 v98, v90 offset:28
    v_lshlrev_b32 v89, 4, v96
    v_add_u32 v90, 120, v97
    v_bitop3_b32 v90, v89, v45, v90 bitop3:0x6a
    ds_write_b32 v98, v90 offset:24
    v_lshlrev_b32 v89, 8, v96
    v_add_u32 v90, 100, v97
    v_bitop3_b32 v90, v89, v45, v90 bitop3:0x6a
    ds_write_b32 v98, v90 offset:20
L2_xc61:
    v_lshlrev_b32 v89, 12, v96
    v_add_u32 v90, 80, v97
    v_bitop3_b32 v90, v89, v45, v90 bitop3:0x6a
    ds_write_b32 v98, v90 offset:16
    s_branch L2_xb61
L2_xe61:
    v_cmp_lt_u32 vcc, 32, v99
    v_cmp_lt_u32 s[58:59], 31, v88
    v_lshrrev_b32 v89, 16, v96
    v_add_u32 v97, 80, v97
    s_or_b64 vcc, vcc, s[58:59]
    s_cbranch_scc1 L2_xs61
    v_lshlrev_b32 v89, v1, v89
    v_and_b32 v89, v45, v89
    v_cmp_ne_u32 vcc, 0, v89
    v_xor_b32 v90, v97, v89
    s_add_u32 s3, s37, s38
    v_mbcnt_lo_u32_b32 v98, vcc_lo, 0
    v_mbcnt_hi_u32_b32 v98, vcc_hi, v98
    s_bcnt1_i32_b64 s41, vcc
    v_lshl_add_u32 v98, v98, 2, s3
    s_mov_b64 exec, vcc
    ds_write_b32 v98, v90
    s_mov_b64 exec, -1
    s_lshl2_add_u32 s37, s41, s37
    s_branch L2_xr61
L2_xf61:
    s_waitcnt lgkmcnt(0)
    s_cmp_gt_u32 s37, 1024
    s_cbranch_scc1 L2_xs61
    v_mov_b32 v43, -1
    s_cmp_ge_u32 s37, 512
    s_cbranch_scc1 L2_xg61
    v_mov_b32 v42, -1
    s_cmp_ge_u32 s37, 256
    s_cbranch_scc1 L2_xg61
    v_mov_b32 v41, -1
    s_branch L2_xg61
L2_xs61:
    s_waitcnt lgkmcnt(0)
    v_mov_b32 v40, -1
    v_mov_b32 v41, -1
    v_mov_b32 v42, -1
    v_mov_b32 v43, -1
    s_add_u32 s3, s42, 2
    s_bitset1_b32 s36, s3
    s_branch L2_xg61
L2_c62:
    s_lshl_b64 s[52:53], s[82:83], 1
    s_andn2_b64 s[52:53], s[52:53], s[80:81]
    s_andn2_b64 s[52:53], s[52:53], s[54:55]
    s_or_b64 s[80:81], s[80:81], s[52:53]
    s_not_b64 vcc, s[52:53]
    s_mov_b64 exec, -1
    v_cndmask_b32_dpp v84, v84, v84, vcc wave_shr:1 row_mask:0xf bank_mask:0xf
    v_cndmask_b32_dpp v85, v85, v85, vcc wave_shr:1 row_mask:0xf bank_mask:0xf
    s_lshr_b64 s[52:53], s[52:53], 1
    v_cndmask_b32_dpp v86, v86, v86, vcc wave_shr:1 row_mask:0xf bank_mask:0xf
    v_cndmask_b32_dpp v87, v87, v87, vcc wave_shr:1 row_mask:0xf bank_mask:0xf
    s_andn2_b64 s[82:83], s[82:83], s[52:53]
    v_cndmask_b32_dpp v7, v7, v7, vcc wave_shr:1 row_mask:0xf bank_mask:0xf
    s_mov_b64 exec, s[54:55]
    s_cbranch_scc0 L2_d62
    s_mov_b64 exec, s[82:83]
    s_nop 1
    v_mfma_f32_4x4x4_16b_bf16 v[88:91], v[12:13], v[84:85], 0
    s_nop 1
    v_mfma_f32_4x4x4_16b_bf16 v[88:91], v[10:11], v[86:87], v[88:91]
    s_nop 4
    v_cvt_pk_bf16_f32 v88, v88, v89
    v_cvt_pk_bf16_f32 v89, v90, v91
    ds_pk_add_bf16 v7, v88 offset:65408
    ds_pk_add_bf16 v7, v89 offset:65412
    s_mov_b64 exec, s[54:55]
    s_branch L2_d62
L2_c63:
    s_lshl_b64 s[52:53], s[82:83], 1
    s_andn2_b64 s[52:53], s[52:53], s[80:81]
    s_andn2_b64 s[52:53], s[52:53], s[50:51]
    s_or_b64 s[80:81], s[80:81], s[52:53]
    s_not_b64 vcc, s[52:53]
    s_mov_b64 exec, -1
    v_cndmask_b32_dpp v84, v84, v84, vcc wave_shr:1 row_mask:0xf bank_mask:0xf
    v_cndmask_b32_dpp v85, v85, v85, vcc wave_shr:1 row_mask:0xf bank_mask:0xf
    s_lshr_b64 s[52:53], s[52:53], 1
    v_cndmask_b32_dpp v86, v86, v86, vcc wave_shr:1 row_mask:0xf bank_mask:0xf
    v_cndmask_b32_dpp v87, v87, v87, vcc wave_shr:1 row_mask:0xf bank_mask:0xf
    s_andn2_b64 s[82:83], s[82:83], s[52:53]
    v_cndmask_b32_dpp v7, v7, v7, vcc wave_shr:1 row_mask:0xf bank_mask:0xf
    s_mov_b64 exec, s[50:51]
    s_cbranch_scc0 L2_d63
    s_mov_b64 exec, s[82:83]
    s_nop 1
    v_mfma_f32_4x4x4_16b_bf16 v[88:91], v[12:13], v[84:85], 0
    s_nop 1
    v_mfma_f32_4x4x4_16b_bf16 v[88:91], v[10:11], v[86:87], v[88:91]
    s_nop 4
    v_cvt_pk_bf16_f32 v88, v88, v89
    v_cvt_pk_bf16_f32 v89, v90, v91
    ds_pk_add_bf16 v7, v88 offset:65408
    ds_pk_add_bf16 v7, v89 offset:65412
    s_mov_b64 exec, s[50:51]
    s_branch L2_d63
L2_c64:
    s_lshl_b64 s[52:53], s[82:83], 1
    s_andn2_b64 s[52:53], s[52:53], s[80:81]
    s_andn2_b64 s[52:53], s[52:53], s[54:55]
    s_or_b64 s[80:81], s[80:81], s[52:53]
    s_not_b64 vcc, s[52:53]
    s_mov_b64 exec, -1
    v_cndmask_b32_dpp v84, v84, v84, vcc wave_shr:1 row_mask:0xf bank_mask:0xf
    v_cndmask_b32_dpp v85, v85, v85, vcc wave_shr:1 row_mask:0xf bank_mask:0xf
    s_lshr_b64 s[52:53], s[52:53], 1
    v_cndmask_b32_dpp v86, v86, v86, vcc wave_shr:1 row_mask:0xf bank_mask:0xf
    v_cndmask_b32_dpp v87, v87, v87, vcc wave_shr:1 row_mask:0xf bank_mask:0xf
    s_andn2_b64 s[82:83], s[82:83], s[52:53]
    v_cndmask_b32_dpp v7, v7, v7, vcc wave_shr:1 row_mask:0xf bank_mask:0xf
    s_mov_b64 exec, s[54:55]
    s_cbranch_scc0 L2_d64
    s_mov_b64 exec, s[82:83]
    s_nop 1
    v_mfma_f32_4x4x4_16b_bf16 v[88:91], v[12:13], v[84:85], 0
    s_nop 1
    v_mfma_f32_4x4x4_16b_bf16 v[88:91], v[10:11], v[86:87], v[88:91]
    s_nop 4
    v_cvt_pk_bf16_f32 v88, v88, v89
    v_cvt_pk_bf16_f32 v89, v90, v91
    ds_pk_add_bf16 v7, v88 offset:65408
    ds_pk_add_bf16 v7, v89 offset:65412
    s_mov_b64 exec, s[54:55]
    s_branch L2_d64
L2_c65:
    s_lshl_b64 s[52:53], s[82:83], 1
    s_andn2_b64 s[52:53], s[52:53], s[80:81]
    s_andn2_b64 s[52:53], s[52:53], s[50:51]
    s_or_b64 s[80:81], s[80:81], s[52:53]
    s_not_b64 vcc, s[52:53]
    s_mov_b64 exec, -1
    v_cndmask_b32_dpp v84, v84, v84, vcc wave_shr:1 row_mask:0xf bank_mask:0xf
    v_cndmask_b32_dpp v85, v85, v85, vcc wave_shr:1 row_mask:0xf bank_mask:0xf
    s_lshr_b64 s[52:53], s[52:53], 1
    v_cndmask_b32_dpp v86, v86, v86, vcc wave_shr:1 row_mask:0xf bank_mask:0xf
    v_cndmask_b32_dpp v87, v87, v87, vcc wave_shr:1 row_mask:0xf bank_mask:0xf
    s_andn2_b64 s[82:83], s[82:83], s[52:53]
    v_cndmask_b32_dpp v7, v7, v7, vcc wave_shr:1 row_mask:0xf bank_mask:0xf
    s_mov_b64 exec, s[50:51]
    s_cbranch_scc0 L2_d65
    s_mov_b64 exec, s[82:83]
    s_nop 1
    v_mfma_f32_4x4x4_16b_bf16 v[88:91], v[12:13], v[84:85], 0
    s_nop 1
    v_mfma_f32_4x4x4_16b_bf16 v[88:91], v[10:11], v[86:87], v[88:91]
    s_nop 4
    v_cvt_pk_bf16_f32 v88, v88, v89
    v_cvt_pk_bf16_f32 v89, v90, v91
    ds_pk_add_bf16 v7, v88 offset:65408
    ds_pk_add_bf16 v7, v89 offset:65412
    s_mov_b64 exec, s[50:51]
    s_branch L2_d65
L2_c66:
    s_lshl_b64 s[52:53], s[82:83], 1
    s_andn2_b64 s[52:53], s[52:53], s[80:81]
    s_andn2_b64 s[52:53], s[52:53], s[54:55]
    s_or_b64 s[80:81], s[80:81], s[52:53]
    s_not_b64 vcc, s[52:53]
    s_mov_b64 exec, -1
    v_cndmask_b32_dpp v84, v84, v84, vcc wave_shr:1 row_mask:0xf bank_mask:0xf
    v_cndmask_b32_dpp v85, v85, v85, vcc wave_shr:1 row_mask:0xf bank_mask:0xf
    s_lshr_b64 s[52:53], s[52:53], 1
    v_cndmask_b32_dpp v86, v86, v86, vcc wave_shr:1 row_mask:0xf bank_mask:0xf
    v_cndmask_b32_dpp v87, v87, v87, vcc wave_shr:1 row_mask:0xf bank_mask:0xf
    s_andn2_b64 s[82:83], s[82:83], s[52:53]
    v_cndmask_b32_dpp v7, v7, v7, vcc wave_shr:1 row_mask:0xf bank_mask:0xf
    s_mov_b64 exec, s[54:55]
    s_cbranch_scc0 L2_d66
    s_mov_b64 exec, s[82:83]
    s_nop 1
    v_mfma_f32_4x4x4_16b_bf16 v[88:91], v[12:13], v[84:85], 0
    s_nop 1
    v_mfma_f32_4x4x4_16b_bf16 v[88:91], v[10:11], v[86:87], v[88:91]
    s_nop 4
    v_cvt_pk_bf16_f32 v88, v88, v89
    v_cvt_pk_bf16_f32 v89, v90, v91
    ds_pk_add_bf16 v7, v88 offset:65408
    ds_pk_add_bf16 v7, v89 offset:65412
    s_mov_b64 exec, s[54:55]
    s_branch L2_d66
L2_c67:
    s_lshl_b64 s[52:53], s[82:83], 1
    s_andn2_b64 s[52:53], s[52:53], s[80:81]
    s_andn2_b64 s[52:53], s[52:53], s[50:51]
    s_or_b64 s[80:81], s[80:81], s[52:53]
    s_not_b64 vcc, s[52:53]
    s_mov_b64 exec, -1
    v_cndmask_b32_dpp v84, v84, v84, vcc wave_shr:1 row_mask:0xf bank_mask:0xf
    v_cndmask_b32_dpp v85, v85, v85, vcc wave_shr:1 row_mask:0xf bank_mask:0xf
    s_lshr_b64 s[52:53], s[52:53], 1
    v_cndmask_b32_dpp v86, v86, v86, vcc wave_shr:1 row_mask:0xf bank_mask:0xf
    v_cndmask_b32_dpp v87, v87, v87, vcc wave_shr:1 row_mask:0xf bank_mask:0xf
    s_andn2_b64 s[82:83], s[82:83], s[52:53]
    v_cndmask_b32_dpp v7, v7, v7, vcc wave_shr:1 row_mask:0xf bank_mask:0xf
    s_mov_b64 exec, s[50:51]
    s_cbranch_scc0 L2_d67
    s_mov_b64 exec, s[82:83]
    s_nop 1
    v_mfma_f32_4x4x4_16b_bf16 v[88:91], v[12:13], v[84:85], 0
    s_nop 1
    v_mfma_f32_4x4x4_16b_bf16 v[88:91], v[10:11], v[86:87], v[88:91]
    s_nop 4
    v_cvt_pk_bf16_f32 v88, v88, v89
    v_cvt_pk_bf16_f32 v89, v90, v91
    ds_pk_add_bf16 v7, v88 offset:65408
    ds_pk_add_bf16 v7, v89 offset:65412
    s_mov_b64 exec, s[50:51]
    s_branch L2_d67
L2_xo68:
    v_cmp_lt_u32 vcc, 20, v99
    s_mov_b32 s101, 1
    s_cbranch_vccz L2_xp68
    v_cmp_lt_u32 vcc, 32, v99
    v_cmp_lt_u32 s[58:59], 31, v88
    s_mov_b32 s101, 2
    s_or_b64 vcc, vcc, s[58:59]
    s_cbranch_scc0 L2_xp68
    s_mov_b32 s37, 0x10000
    s_branch L2_xp68
L2_c69:
    s_lshl_b64 s[52:53], s[82:83], 1
    s_andn2_b64 s[52:53], s[52:53], s[80:81]
    s_andn2_b64 s[52:53], s[52:53], s[54:55]
    s_or_b64 s[80:81], s[80:81], s[52:53]
    s_not_b64 vcc, s[52:53]
    s_mov_b64 exec, -1
    v_cndmask_b32_dpp v84, v84, v84, vcc wave_shr:1 row_mask:0xf bank_mask:0xf
    v_cndmask_b32_dpp v85, v85, v85, vcc wave_shr:1 row_mask:0xf bank_mask:0xf
    s_lshr_b64 s[52:53], s[52:53], 1
    v_cndmask_b32_dpp v86, v86, v86, vcc wave_shr:1 row_mask:0xf bank_mask:0xf
    v_cndmask_b32_dpp v87, v87, v87, vcc wave_shr:1 row_mask:0xf bank_mask:0xf
    s_andn2_b64 s[82:83], s[82:83], s[52:53]
    v_cndmask_b32_dpp v7, v7, v7, vcc wave_shr:1 row_mask:0xf bank_mask:0xf
    s_mov_b64 exec, s[54:55]
    s_cbranch_scc0 L2_d69
    s_mov_b64 exec, s[82:83]
    s_nop 1
    v_mfma_f32_4x4x4_16b_bf16 v[88:91], v[12:13], v[84:85], 0
    s_nop 1
    v_mfma_f32_4x4x4_16b_bf16 v[88:91], v[10:11], v[86:87], v[88:91]
    s_nop 4
    v_cvt_pk_bf16_f32 v88, v88, v89
    v_cvt_pk_bf16_f32 v89, v90, v91
    ds_pk_add_bf16 v7, v88 offset:65408
    ds_pk_add_bf16 v7, v89 offset:65412
    s_mov_b64 exec, s[54:55]
    s_branch L2_d69
L2_c70:
    s_lshl_b64 s[52:53], s[82:83], 1
    s_andn2_b64 s[52:53], s[52:53], s[80:81]
    s_andn2_b64 s[52:53], s[52:53], s[50:51]
    s_or_b64 s[80:81], s[80:81], s[52:53]
    s_not_b64 vcc, s[52:53]
    s_mov_b64 exec, -1
    v_cndmask_b32_dpp v84, v84, v84, vcc wave_shr:1 row_mask:0xf bank_mask:0xf
    v_cndmask_b32_dpp v85, v85, v85, vcc wave_shr:1 row_mask:0xf bank_mask:0xf
    s_lshr_b64 s[52:53], s[52:53], 1
    v_cndmask_b32_dpp v86, v86, v86, vcc wave_shr:1 row_mask:0xf bank_mask:0xf
    v_cndmask_b32_dpp v87, v87, v87, vcc wave_shr:1 row_mask:0xf bank_mask:0xf
    s_andn2_b64 s[82:83], s[82:83], s[52:53]
    v_cndmask_b32_dpp v7, v7, v7, vcc wave_shr:1 row_mask:0xf bank_mask:0xf
    s_mov_b64 exec, s[50:51]
    s_cbranch_scc0 L2_d70
    s_mov_b64 exec, s[82:83]
    s_nop 1
    v_mfma_f32_4x4x4_16b_bf16 v[88:91], v[12:13], v[84:85], 0
    s_nop 1
    v_mfma_f32_4x4x4_16b_bf16 v[88:91], v[10:11], v[86:87], v[88:91]
    s_nop 4
    v_cvt_pk_bf16_f32 v88, v88, v89
    v_cvt_pk_bf16_f32 v89, v90, v91
    ds_pk_add_bf16 v7, v88 offset:65408
    ds_pk_add_bf16 v7, v89 offset:65412
    s_mov_b64 exec, s[50:51]
    s_branch L2_d70
L2_c71:
    s_lshl_b64 s[52:53], s[82:83], 1
    s_andn2_b64 s[52:53], s[52:53], s[80:81]
    s_andn2_b64 s[52:53], s[52:53], s[54:55]
    s_or_b64 s[80:81], s[80:81], s[52:53]
    s_not_b64 vcc, s[52:53]
    s_mov_b64 exec, -1
    v_cndmask_b32_dpp v84, v84, v84, vcc wave_shr:1 row_mask:0xf bank_mask:0xf
    v_cndmask_b32_dpp v85, v85, v85, vcc wave_shr:1 row_mask:0xf bank_mask:0xf
    s_lshr_b64 s[52:53], s[52:53], 1
    v_cndmask_b32_dpp v86, v86, v86, vcc wave_shr:1 row_mask:0xf bank_mask:0xf
    v_cndmask_b32_dpp v87, v87, v87, vcc wave_shr:1 row_mask:0xf bank_mask:0xf
    s_andn2_b64 s[82:83], s[82:83], s[52:53]
    v_cndmask_b32_dpp v7, v7, v7, vcc wave_shr:1 row_mask:0xf bank_mask:0xf
    s_mov_b64 exec, s[54:55]
    s_cbranch_scc0 L2_d71
    s_mov_b64 exec, s[82:83]
    s_nop 1
    v_mfma_f32_4x4x4_16b_bf16 v[88:91], v[12:13], v[84:85], 0
    s_nop 1
    v_mfma_f32_4x4x4_16b_bf16 v[88:91], v[10:11], v[86:87], v[88:91]
    s_nop 4
    v_cvt_pk_bf16_f32 v88, v88, v89
    v_cvt_pk_bf16_f32 v89, v90, v91
    ds_pk_add_bf16 v7, v88 offset:65408
    ds_pk_add_bf16 v7, v89 offset:65412
    s_mov_b64 exec, s[54:55]
    s_branch L2_d71
L2_c72:
    s_lshl_b64 s[52:53], s[82:83], 1
    s_andn2_b64 s[52:53], s[52:53], s[80:81]
    s_andn2_b64 s[52:53], s[52:53], s[50:51]
    s_or_b64 s[80:81], s[80:81], s[52:53]
    s_not_b64 vcc, s[52:53]
    s_mov_b64 exec, -1
    v_cndmask_b32_dpp v84, v84, v84, vcc wave_shr:1 row_mask:0xf bank_mask:0xf
    v_cndmask_b32_dpp v85, v85, v85, vcc wave_shr:1 row_mask:0xf bank_mask:0xf
    s_lshr_b64 s[52:53], s[52:53], 1
    v_cndmask_b32_dpp v86, v86, v86, vcc wave_shr:1 row_mask:0xf bank_mask:0xf
    v_cndmask_b32_dpp v87, v87, v87, vcc wave_shr:1 row_mask:0xf bank_mask:0xf
    s_andn2_b64 s[82:83], s[82:83], s[52:53]
    v_cndmask_b32_dpp v7, v7, v7, vcc wave_shr:1 row_mask:0xf bank_mask:0xf
    s_mov_b64 exec, s[50:51]
    s_cbranch_scc0 L2_d72
    s_mov_b64 exec, s[82:83]
    s_nop 1
    v_mfma_f32_4x4x4_16b_bf16 v[88:91], v[12:13], v[84:85], 0
    s_nop 1
    v_mfma_f32_4x4x4_16b_bf16 v[88:91], v[10:11], v[86:87], v[88:91]
    s_nop 4
    v_cvt_pk_bf16_f32 v88, v88, v89
    v_cvt_pk_bf16_f32 v89, v90, v91
    ds_pk_add_bf16 v7, v88 offset:65408
    ds_pk_add_bf16 v7, v89 offset:65412
    s_mov_b64 exec, s[50:51]
    s_branch L2_d72
L2_c73:
    s_lshl_b64 s[52:53], s[82:83], 1
    s_andn2_b64 s[52:53], s[52:53], s[80:81]
    s_andn2_b64 s[52:53], s[52:53], s[54:55]
    s_or_b64 s[80:81], s[80:81], s[52:53]
    s_not_b64 vcc, s[52:53]
    s_mov_b64 exec, -1
    v_cndmask_b32_dpp v84, v84, v84, vcc wave_shr:1 row_mask:0xf bank_mask:0xf
    v_cndmask_b32_dpp v85, v85, v85, vcc wave_shr:1 row_mask:0xf bank_mask:0xf
    s_lshr_b64 s[52:53], s[52:53], 1
    v_cndmask_b32_dpp v86, v86, v86, vcc wave_shr:1 row_mask:0xf bank_mask:0xf
    v_cndmask_b32_dpp v87, v87, v87, vcc wave_shr:1 row_mask:0xf bank_mask:0xf
    s_andn2_b64 s[82:83], s[82:83], s[52:53]
    v_cndmask_b32_dpp v7, v7, v7, vcc wave_shr:1 row_mask:0xf bank_mask:0xf
    s_mov_b64 exec, s[54:55]
    s_cbranch_scc0 L2_d73
    s_mov_b64 exec, s[82:83]
    s_nop 1
    v_mfma_f32_4x4x4_16b_bf16 v[88:91], v[12:13], v[84:85], 0
    s_nop 1
    v_mfma_f32_4x4x4_16b_bf16 v[88:91], v[10:11], v[86:87], v[88:91]
    s_nop 4
    v_cvt_pk_bf16_f32 v88, v88, v89
    v_cvt_pk_bf16_f32 v89, v90, v91
    ds_pk_add_bf16 v7, v88 offset:65408
    ds_pk_add_bf16 v7, v89 offset:65412
    s_mov_b64 exec, s[54:55]
    s_branch L2_d73
L2_c74:
    s_lshl_b64 s[52:53], s[82:83], 1
    s_andn2_b64 s[52:53], s[52:53], s[80:81]
    s_andn2_b64 s[52:53], s[52:53], s[50:51]
    s_or_b64 s[80:81], s[80:81], s[52:53]
    s_not_b64 vcc, s[52:53]
    s_mov_b64 exec, -1
    v_cndmask_b32_dpp v84, v84, v84, vcc wave_shr:1 row_mask:0xf bank_mask:0xf
    v_cndmask_b32_dpp v85, v85, v85, vcc wave_shr:1 row_mask:0xf bank_mask:0xf
    s_lshr_b64 s[52:53], s[52:53], 1
    v_cndmask_b32_dpp v86, v86, v86, vcc wave_shr:1 row_mask:0xf bank_mask:0xf
    v_cndmask_b32_dpp v87, v87, v87, vcc wave_shr:1 row_mask:0xf bank_mask:0xf
    s_andn2_b64 s[82:83], s[82:83], s[52:53]
    v_cndmask_b32_dpp v7, v7, v7, vcc wave_shr:1 row_mask:0xf bank_mask:0xf
    s_mov_b64 exec, s[50:51]
    s_cbranch_scc0 L2_d74
    s_mov_b64 exec, s[82:83]
    s_nop 1
    v_mfma_f32_4x4x4_16b_bf16 v[88:91], v[12:13], v[84:85], 0
    s_nop 1
    v_mfma_f32_4x4x4_16b_bf16 v[88:91], v[10:11], v[86:87], v[88:91]
    s_nop 4
    v_cvt_pk_bf16_f32 v88, v88, v89
    v_cvt_pk_bf16_f32 v89, v90, v91
    ds_pk_add_bf16 v7, v88 offset:65408
    ds_pk_add_bf16 v7, v89 offset:65412
    s_mov_b64 exec, s[50:51]
    s_branch L2_d74
L2_c75:
    s_lshl_b64 s[52:53], s[82:83], 1
    s_andn2_b64 s[52:53], s[52:53], s[80:81]
    s_andn2_b64 s[52:53], s[52:53], s[54:55]
    s_or_b64 s[80:81], s[80:81], s[52:53]
    s_not_b64 vcc, s[52:53]
    s_mov_b64 exec, -1
    v_cndmask_b32_dpp v84, v84, v84, vcc wave_shr:1 row_mask:0xf bank_mask:0xf
    v_cndmask_b32_dpp v85, v85, v85, vcc wave_shr:1 row_mask:0xf bank_mask:0xf
    s_lshr_b64 s[52:53], s[52:53], 1
    v_cndmask_b32_dpp v86, v86, v86, vcc wave_shr:1 row_mask:0xf bank_mask:0xf
    v_cndmask_b32_dpp v87, v87, v87, vcc wave_shr:1 row_mask:0xf bank_mask:0xf
    s_andn2_b64 s[82:83], s[82:83], s[52:53]
    v_cndmask_b32_dpp v7, v7, v7, vcc wave_shr:1 row_mask:0xf bank_mask:0xf
    s_mov_b64 exec, s[54:55]
    s_cbranch_scc0 L2_d75
    s_mov_b64 exec, s[82:83]
    s_nop 1
    v_mfma_f32_4x4x4_16b_bf16 v[88:91], v[12:13], v[84:85], 0
    s_nop 1
    v_mfma_f32_4x4x4_16b_bf16 v[88:91], v[10:11], v[86:87], v[88:91]
    s_nop 4
    v_cvt_pk_bf16_f32 v88, v88, v89
    v_cvt_pk_bf16_f32 v89, v90, v91
    ds_pk_add_bf16 v7, v88 offset:65408
    ds_pk_add_bf16 v7, v89 offset:65412
    s_mov_b64 exec, s[54:55]
    s_branch L2_d75
L2_c76:
    s_lshl_b64 s[52:53], s[82:83], 1
    s_andn2_b64 s[52:53], s[52:53], s[80:81]
    s_andn2_b64 s[52:53], s[52:53], s[50:51]
    s_or_b64 s[80:81], s[80:81], s[52:53]
    s_not_b64 vcc, s[52:53]
    s_mov_b64 exec, -1
    v_cndmask_b32_dpp v84, v84, v84, vcc wave_shr:1 row_mask:0xf bank_mask:0xf
    v_cndmask_b32_dpp v85, v85, v85, vcc wave_shr:1 row_mask:0xf bank_mask:0xf
    s_lshr_b64 s[52:53], s[52:53], 1
    v_cndmask_b32_dpp v86, v86, v86, vcc wave_shr:1 row_mask:0xf bank_mask:0xf
    v_cndmask_b32_dpp v87, v87, v87, vcc wave_shr:1 row_mask:0xf bank_mask:0xf
    s_andn2_b64 s[82:83], s[82:83], s[52:53]
    v_cndmask_b32_dpp v7, v7, v7, vcc wave_shr:1 row_mask:0xf bank_mask:0xf
    s_mov_b64 exec, s[50:51]
    s_cbranch_scc0 L2_d76
    s_mov_b64 exec, s[82:83]
    s_nop 1
    v_mfma_f32_4x4x4_16b_bf16 v[88:91], v[12:13], v[84:85], 0
    s_nop 1
    v_mfma_f32_4x4x4_16b_bf16 v[88:91], v[10:11], v[86:87], v[88:91]
    s_nop 4
    v_cvt_pk_bf16_f32 v88, v88, v89
    v_cvt_pk_bf16_f32 v89, v90, v91
    ds_pk_add_bf16 v7, v88 offset:65408
    ds_pk_add_bf16 v7, v89 offset:65412
    s_mov_b64 exec, s[50:51]
    s_branch L2_d76
L2_c77:
    s_lshl_b64 s[52:53], s[82:83], 1
    s_andn2_b64 s[52:53], s[52:53], s[80:81]
    s_andn2_b64 s[52:53], s[52:53], s[54:55]
    s_or_b64 s[80:81], s[80:81], s[52:53]
    s_not_b64 vcc, s[52:53]
    s_mov_b64 exec, -1
    v_cndmask_b32_dpp v84, v84, v84, vcc wave_shr:1 row_mask:0xf bank_mask:0xf
    v_cndmask_b32_dpp v85, v85, v85, vcc wave_shr:1 row_mask:0xf bank_mask:0xf
    s_lshr_b64 s[52:53], s[52:53], 1
    v_cndmask_b32_dpp v86, v86, v86, vcc wave_shr:1 row_mask:0xf bank_mask:0xf
    v_cndmask_b32_dpp v87, v87, v87, vcc wave_shr:1 row_mask:0xf bank_mask:0xf
    s_andn2_b64 s[82:83], s[82:83], s[52:53]
    v_cndmask_b32_dpp v7, v7, v7, vcc wave_shr:1 row_mask:0xf bank_mask:0xf
    s_mov_b64 exec, s[54:55]
    s_cbranch_scc0 L2_d77
    s_mov_b64 exec, s[82:83]
    s_nop 1
    v_mfma_f32_4x4x4_16b_bf16 v[88:91], v[12:13], v[84:85], 0
    s_nop 1
    v_mfma_f32_4x4x4_16b_bf16 v[88:91], v[10:11], v[86:87], v[88:91]
    s_nop 4
    v_cvt_pk_bf16_f32 v88, v88, v89
    v_cvt_pk_bf16_f32 v89, v90, v91
    ds_pk_add_bf16 v7, v88 offset:65408
    ds_pk_add_bf16 v7, v89 offset:65412
    s_mov_b64 exec, s[54:55]
    s_branch L2_d77
L2_c78:
    s_lshl_b64 s[52:53], s[82:83], 1
    s_andn2_b64 s[52:53], s[52:53], s[80:81]
    s_andn2_b64 s[52:53], s[52:53], s[50:51]
    s_or_b64 s[80:81], s[80:81], s[52:53]
    s_not_b64 vcc, s[52:53]
    s_mov_b64 exec, -1
    v_cndmask_b32_dpp v84, v84, v84, vcc wave_shr:1 row_mask:0xf bank_mask:0xf
    v_cndmask_b32_dpp v85, v85, v85, vcc wave_shr:1 row_mask:0xf bank_mask:0xf
    s_lshr_b64 s[52:53], s[52:53], 1
    v_cndmask_b32_dpp v86, v86, v86, vcc wave_shr:1 row_mask:0xf bank_mask:0xf
    v_cndmask_b32_dpp v87, v87, v87, vcc wave_shr:1 row_mask:0xf bank_mask:0xf
    s_andn2_b64 s[82:83], s[82:83], s[52:53]
    v_cndmask_b32_dpp v7, v7, v7, vcc wave_shr:1 row_mask:0xf bank_mask:0xf
    s_mov_b64 exec, s[50:51]
    s_cbranch_scc0 L2_d78
    s_mov_b64 exec, s[82:83]
    s_nop 1
    v_mfma_f32_4x4x4_16b_bf16 v[88:91], v[12:13], v[84:85], 0
    s_nop 1
    v_mfma_f32_4x4x4_16b_bf16 v[88:91], v[10:11], v[86:87], v[88:91]
    s_nop 4
    v_cvt_pk_bf16_f32 v88, v88, v89
    v_cvt_pk_bf16_f32 v89, v90, v91
    ds_pk_add_bf16 v7, v88 offset:65408
    ds_pk_add_bf16 v7, v89 offset:65412
    s_mov_b64 exec, s[50:51]
    s_branch L2_d78
L2_xa79:
    s_cmp_eq_u32 s101, 1
    s_cbranch_scc1 L2_xc79
    v_lshlrev_b32 v89, 0, v96
    v_add_u32 v90, 140, v97
    v_bitop3_b32 v90, v89, v45, v90 bitop3:0x6a
    ds_write_b32 v98, v90 offset:28
    v_lshlrev_b32 v89, 4, v96
    v_add_u32 v90, 120, v97
    v_bitop3_b32 v90, v89, v45, v90 bitop3:0x6a
    ds_write_b32 v98, v90 offset:24
    v_lshlrev_b32 v89, 8, v96
    v_add_u32 v90, 100, v97
    v_bitop3_b32 v90, v89, v45, v90 bitop3:0x6a
    ds_write_b32 v98, v90 offset:20
L2_xc79:
    v_lshlrev_b32 v89, 12, v96
    v_add_u32 v90, 80, v97
    v_bitop3_b32 v90, v89, v45, v90 bitop3:0x6a
    ds_write_b32 v98, v90 offset:16
    s_branch L2_xb79
L2_xe79:
    v_cmp_lt_u32 vcc, 32, v99
    v_cmp_lt_u32 s[58:59], 31, v88
    v_lshrrev_b32 v89, 16, v96
    v_add_u32 v97, 80, v97
    s_or_b64 vcc, vcc, s[58:59]
    s_cbranch_scc1 L2_xs79
    v_lshlrev_b32 v89, v1, v89
    v_and_b32 v89, v45, v89
    v_cmp_ne_u32 vcc, 0, v89
    v_xor_b32 v90, v97, v89
    s_add_u32 s3, s37, s38
    v_mbcnt_lo_u32_b32 v98, vcc_lo, 0
    v_mbcnt_hi_u32_b32 v98, vcc_hi, v98
    s_bcnt1_i32_b64 s41, vcc
    v_lshl_add_u32 v98, v98, 2, s3
    s_mov_b64 exec, vcc
    ds_write_b32 v98, v90
    s_mov_b64 exec, -1
    s_lshl2_add_u32 s37, s41, s37
    s_branch L2_xr79
L2_xf79:
    s_waitcnt lgkmcnt(0)
    s_cmp_gt_u32 s37, 1024
    s_cbranch_scc1 L2_xs79
    v_mov_b32 v43, -1
    s_cmp_ge_u32 s37, 512
    s_cbranch_scc1 L2_xg79
    v_mov_b32 v42, -1
    s_cmp_ge_u32 s37, 256
    s_cbranch_scc1 L2_xg79
    v_mov_b32 v41, -1
    s_branch L2_xg79
L2_xs79:
    s_waitcnt lgkmcnt(0)
    v_mov_b32 v40, -1
    v_mov_b32 v41, -1
    v_mov_b32 v42, -1
    v_mov_b32 v43, -1
    s_add_u32 s3, s42, 2
    s_bitset1_b32 s36, s3
    s_branch L2_xg79
L2_c80:
    s_lshl_b64 s[52:53], s[82:83], 1
    s_andn2_b64 s[52:53], s[52:53], s[80:81]
    s_andn2_b64 s[52:53], s[52:53], s[54:55]
    s_or_b64 s[80:81], s[80:81], s[52:53]
    s_not_b64 vcc, s[52:53]
    s_mov_b64 exec, -1
    v_cndmask_b32_dpp v84, v84, v84, vcc wave_shr:1 row_mask:0xf bank_mask:0xf
    v_cndmask_b32_dpp v85, v85, v85, vcc wave_shr:1 row_mask:0xf bank_mask:0xf
    s_lshr_b64 s[52:53], s[52:53], 1
    v_cndmask_b32_dpp v86, v86, v86, vcc wave_shr:1 row_mask:0xf bank_mask:0xf
    v_cndmask_b32_dpp v87, v87, v87, vcc wave_shr:1 row_mask:0xf bank_mask:0xf
    s_andn2_b64 s[82:83], s[82:83], s[52:53]
    v_cndmask_b32_dpp v7, v7, v7, vcc wave_shr:1 row_mask:0xf bank_mask:0xf
    s_mov_b64 exec, s[54:55]
    s_cbranch_scc0 L2_d80
    s_mov_b64 exec, s[82:83]
    s_nop 1
    v_mfma_f32_4x4x4_16b_bf16 v[88:91], v[12:13], v[84:85], 0
    s_nop 1
    v_mfma_f32_4x4x4_16b_bf16 v[88:91], v[10:11], v[86:87], v[88:91]
    s_nop 4
    v_cvt_pk_bf16_f32 v88, v88, v89
    v_cvt_pk_bf16_f32 v89, v90, v91
    ds_pk_add_bf16 v7, v88 offset:65408
    ds_pk_add_bf16 v7, v89 offset:65412
    s_mov_b64 exec, s[54:55]
    s_branch L2_d80
L2_c81:
    s_lshl_b64 s[52:53], s[82:83], 1
    s_andn2_b64 s[52:53], s[52:53], s[80:81]
    s_andn2_b64 s[52:53], s[52:53], s[50:51]
    s_or_b64 s[80:81], s[80:81], s[52:53]
    s_not_b64 vcc, s[52:53]
    s_mov_b64 exec, -1
    v_cndmask_b32_dpp v84, v84, v84, vcc wave_shr:1 row_mask:0xf bank_mask:0xf
    v_cndmask_b32_dpp v85, v85, v85, vcc wave_shr:1 row_mask:0xf bank_mask:0xf
    s_lshr_b64 s[52:53], s[52:53], 1
    v_cndmask_b32_dpp v86, v86, v86, vcc wave_shr:1 row_mask:0xf bank_mask:0xf
    v_cndmask_b32_dpp v87, v87, v87, vcc wave_shr:1 row_mask:0xf bank_mask:0xf
    s_andn2_b64 s[82:83], s[82:83], s[52:53]
    v_cndmask_b32_dpp v7, v7, v7, vcc wave_shr:1 row_mask:0xf bank_mask:0xf
    s_mov_b64 exec, s[50:51]
    s_cbranch_scc0 L2_d81
    s_mov_b64 exec, s[82:83]
    s_nop 1
    v_mfma_f32_4x4x4_16b_bf16 v[88:91], v[12:13], v[84:85], 0
    s_nop 1
    v_mfma_f32_4x4x4_16b_bf16 v[88:91], v[10:11], v[86:87], v[88:91]
    s_nop 4
    v_cvt_pk_bf16_f32 v88, v88, v89
    v_cvt_pk_bf16_f32 v89, v90, v91
    ds_pk_add_bf16 v7, v88 offset:65408
    ds_pk_add_bf16 v7, v89 offset:65412
    s_mov_b64 exec, s[50:51]
    s_branch L2_d81
L2_c82:
    s_lshl_b64 s[52:53], s[82:83], 1
    s_andn2_b64 s[52:53], s[52:53], s[80:81]
    s_andn2_b64 s[52:53], s[52:53], s[54:55]
    s_or_b64 s[80:81], s[80:81], s[52:53]
    s_not_b64 vcc, s[52:53]
    s_mov_b64 exec, -1
    v_cndmask_b32_dpp v84, v84, v84, vcc wave_shr:1 row_mask:0xf bank_mask:0xf
    v_cndmask_b32_dpp v85, v85, v85, vcc wave_shr:1 row_mask:0xf bank_mask:0xf
    s_lshr_b64 s[52:53], s[52:53], 1
    v_cndmask_b32_dpp v86, v86, v86, vcc wave_shr:1 row_mask:0xf bank_mask:0xf
    v_cndmask_b32_dpp v87, v87, v87, vcc wave_shr:1 row_mask:0xf bank_mask:0xf
    s_andn2_b64 s[82:83], s[82:83], s[52:53]
    v_cndmask_b32_dpp v7, v7, v7, vcc wave_shr:1 row_mask:0xf bank_mask:0xf
    s_mov_b64 exec, s[54:55]
    s_cbranch_scc0 L2_d82
    s_mov_b64 exec, s[82:83]
    s_nop 1
    v_mfma_f32_4x4x4_16b_bf16 v[88:91], v[12:13], v[84:85], 0
    s_nop 1
    v_mfma_f32_4x4x4_16b_bf16 v[88:91], v[10:11], v[86:87], v[88:91]
    s_nop 4
    v_cvt_pk_bf16_f32 v88, v88, v89
    v_cvt_pk_bf16_f32 v89, v90, v91
    ds_pk_add_bf16 v7, v88 offset:65408
    ds_pk_add_bf16 v7, v89 offset:65412
    s_mov_b64 exec, s[54:55]
    s_branch L2_d82
L2_c83:
    s_lshl_b64 s[52:53], s[82:83], 1
    s_andn2_b64 s[52:53], s[52:53], s[80:81]
    s_andn2_b64 s[52:53], s[52:53], s[50:51]
    s_or_b64 s[80:81], s[80:81], s[52:53]
    s_not_b64 vcc, s[52:53]
    s_mov_b64 exec, -1
    v_cndmask_b32_dpp v84, v84, v84, vcc wave_shr:1 row_mask:0xf bank_mask:0xf
    v_cndmask_b32_dpp v85, v85, v85, vcc wave_shr:1 row_mask:0xf bank_mask:0xf
    s_lshr_b64 s[52:53], s[52:53], 1
    v_cndmask_b32_dpp v86, v86, v86, vcc wave_shr:1 row_mask:0xf bank_mask:0xf
    v_cndmask_b32_dpp v87, v87, v87, vcc wave_shr:1 row_mask:0xf bank_mask:0xf
    s_andn2_b64 s[82:83], s[82:83], s[52:53]
    v_cndmask_b32_dpp v7, v7, v7, vcc wave_shr:1 row_mask:0xf bank_mask:0xf
    s_mov_b64 exec, s[50:51]
    s_cbranch_scc0 L2_d83
    s_mov_b64 exec, s[82:83]
    s_nop 1
    v_mfma_f32_4x4x4_16b_bf16 v[88:91], v[12:13], v[84:85], 0
    s_nop 1
    v_mfma_f32_4x4x4_16b_bf16 v[88:91], v[10:11], v[86:87], v[88:91]
    s_nop 4
    v_cvt_pk_bf16_f32 v88, v88, v89
    v_cvt_pk_bf16_f32 v89, v90, v91
    ds_pk_add_bf16 v7, v88 offset:65408
    ds_pk_add_bf16 v7, v89 offset:65412
    s_mov_b64 exec, s[50:51]
    s_branch L2_d83
L2_c84:
    s_lshl_b64 s[52:53], s[82:83], 1
    s_andn2_b64 s[52:53], s[52:53], s[80:81]
    s_andn2_b64 s[52:53], s[52:53], s[54:55]
    s_or_b64 s[80:81], s[80:81], s[52:53]
    s_not_b64 vcc, s[52:53]
    s_mov_b64 exec, -1
    v_cndmask_b32_dpp v84, v84, v84, vcc wave_shr:1 row_mask:0xf bank_mask:0xf
    v_cndmask_b32_dpp v85, v85, v85, vcc wave_shr:1 row_mask:0xf bank_mask:0xf
    s_lshr_b64 s[52:53], s[52:53], 1
    v_cndmask_b32_dpp v86, v86, v86, vcc wave_shr:1 row_mask:0xf bank_mask:0xf
    v_cndmask_b32_dpp v87, v87, v87, vcc wave_shr:1 row_mask:0xf bank_mask:0xf
    s_andn2_b64 s[82:83], s[82:83], s[52:53]
    v_cndmask_b32_dpp v7, v7, v7, vcc wave_shr:1 row_mask:0xf bank_mask:0xf
    s_mov_b64 exec, s[54:55]
    s_cbranch_scc0 L2_d84
    s_mov_b64 exec, s[82:83]
    s_nop 1
    v_mfma_f32_4x4x4_16b_bf16 v[88:91], v[12:13], v[84:85], 0
    s_nop 1
    v_mfma_f32_4x4x4_16b_bf16 v[88:91], v[10:11], v[86:87], v[88:91]
    s_nop 4
    v_cvt_pk_bf16_f32 v88, v88, v89
    v_cvt_pk_bf16_f32 v89, v90, v91
    ds_pk_add_bf16 v7, v88 offset:65408
    ds_pk_add_bf16 v7, v89 offset:65412
    s_mov_b64 exec, s[54:55]
    s_branch L2_d84
L2_c85:
    s_lshl_b64 s[52:53], s[82:83], 1
    s_andn2_b64 s[52:53], s[52:53], s[80:81]
    s_andn2_b64 s[52:53], s[52:53], s[50:51]
    s_or_b64 s[80:81], s[80:81], s[52:53]
    s_not_b64 vcc, s[52:53]
    s_mov_b64 exec, -1
    v_cndmask_b32_dpp v84, v84, v84, vcc wave_shr:1 row_mask:0xf bank_mask:0xf
    v_cndmask_b32_dpp v85, v85, v85, vcc wave_shr:1 row_mask:0xf bank_mask:0xf
    s_lshr_b64 s[52:53], s[52:53], 1
    v_cndmask_b32_dpp v86, v86, v86, vcc wave_shr:1 row_mask:0xf bank_mask:0xf
    v_cndmask_b32_dpp v87, v87, v87, vcc wave_shr:1 row_mask:0xf bank_mask:0xf
    s_andn2_b64 s[82:83], s[82:83], s[52:53]
    v_cndmask_b32_dpp v7, v7, v7, vcc wave_shr:1 row_mask:0xf bank_mask:0xf
    s_mov_b64 exec, s[50:51]
    s_cbranch_scc0 L2_d85
    s_mov_b64 exec, s[82:83]
    s_nop 1
    v_mfma_f32_4x4x4_16b_bf16 v[88:91], v[12:13], v[84:85], 0
    s_nop 1
    v_mfma_f32_4x4x4_16b_bf16 v[88:91], v[10:11], v[86:87], v[88:91]
    s_nop 4
    v_cvt_pk_bf16_f32 v88, v88, v89
    v_cvt_pk_bf16_f32 v89, v90, v91
    ds_pk_add_bf16 v7, v88 offset:65408
    ds_pk_add_bf16 v7, v89 offset:65412
    s_mov_b64 exec, s[50:51]
    s_branch L2_d85
L2_xo86:
    v_cmp_lt_u32 vcc, 20, v99
    s_mov_b32 s101, 1
    s_cbranch_vccz L2_xp86
    v_cmp_lt_u32 vcc, 32, v99
    v_cmp_lt_u32 s[58:59], 31, v88
    s_mov_b32 s101, 2
    s_or_b64 vcc, vcc, s[58:59]
    s_cbranch_scc0 L2_xp86
    s_mov_b32 s37, 0x10000
    s_branch L2_xp86
L2_c87:
    s_lshl_b64 s[52:53], s[82:83], 1
    s_andn2_b64 s[52:53], s[52:53], s[80:81]
    s_andn2_b64 s[52:53], s[52:53], s[54:55]
    s_or_b64 s[80:81], s[80:81], s[52:53]
    s_not_b64 vcc, s[52:53]
    s_mov_b64 exec, -1
    v_cndmask_b32_dpp v84, v84, v84, vcc wave_shr:1 row_mask:0xf bank_mask:0xf
    v_cndmask_b32_dpp v85, v85, v85, vcc wave_shr:1 row_mask:0xf bank_mask:0xf
    s_lshr_b64 s[52:53], s[52:53], 1
    v_cndmask_b32_dpp v86, v86, v86, vcc wave_shr:1 row_mask:0xf bank_mask:0xf
    v_cndmask_b32_dpp v87, v87, v87, vcc wave_shr:1 row_mask:0xf bank_mask:0xf
    s_andn2_b64 s[82:83], s[82:83], s[52:53]
    v_cndmask_b32_dpp v7, v7, v7, vcc wave_shr:1 row_mask:0xf bank_mask:0xf
    s_mov_b64 exec, s[54:55]
    s_cbranch_scc0 L2_d87
    s_mov_b64 exec, s[82:83]
    s_nop 1
    v_mfma_f32_4x4x4_16b_bf16 v[88:91], v[12:13], v[84:85], 0
    s_nop 1
    v_mfma_f32_4x4x4_16b_bf16 v[88:91], v[10:11], v[86:87], v[88:91]
    s_nop 4
    v_cvt_pk_bf16_f32 v88, v88, v89
    v_cvt_pk_bf16_f32 v89, v90, v91
    ds_pk_add_bf16 v7, v88 offset:65408
    ds_pk_add_bf16 v7, v89 offset:65412
    s_mov_b64 exec, s[54:55]
    s_branch L2_d87
L2_c88:
    s_lshl_b64 s[52:53], s[82:83], 1
    s_andn2_b64 s[52:53], s[52:53], s[80:81]
    s_andn2_b64 s[52:53], s[52:53], s[50:51]
    s_or_b64 s[80:81], s[80:81], s[52:53]
    s_not_b64 vcc, s[52:53]
    s_mov_b64 exec, -1
    v_cndmask_b32_dpp v84, v84, v84, vcc wave_shr:1 row_mask:0xf bank_mask:0xf
    v_cndmask_b32_dpp v85, v85, v85, vcc wave_shr:1 row_mask:0xf bank_mask:0xf
    s_lshr_b64 s[52:53], s[52:53], 1
    v_cndmask_b32_dpp v86, v86, v86, vcc wave_shr:1 row_mask:0xf bank_mask:0xf
    v_cndmask_b32_dpp v87, v87, v87, vcc wave_shr:1 row_mask:0xf bank_mask:0xf
    s_andn2_b64 s[82:83], s[82:83], s[52:53]
    v_cndmask_b32_dpp v7, v7, v7, vcc wave_shr:1 row_mask:0xf bank_mask:0xf
    s_mov_b64 exec, s[50:51]
    s_cbranch_scc0 L2_d88
    s_mov_b64 exec, s[82:83]
    s_nop 1
    v_mfma_f32_4x4x4_16b_bf16 v[88:91], v[12:13], v[84:85], 0
    s_nop 1
    v_mfma_f32_4x4x4_16b_bf16 v[88:91], v[10:11], v[86:87], v[88:91]
    s_nop 4
    v_cvt_pk_bf16_f32 v88, v88, v89
    v_cvt_pk_bf16_f32 v89, v90, v91
    ds_pk_add_bf16 v7, v88 offset:65408
    ds_pk_add_bf16 v7, v89 offset:65412
    s_mov_b64 exec, s[50:51]
    s_branch L2_d88
L2_c89:
    s_lshl_b64 s[52:53], s[82:83], 1
    s_andn2_b64 s[52:53], s[52:53], s[80:81]
    s_andn2_b64 s[52:53], s[52:53], s[54:55]
    s_or_b64 s[80:81], s[80:81], s[52:53]
    s_not_b64 vcc, s[52:53]
    s_mov_b64 exec, -1
    v_cndmask_b32_dpp v84, v84, v84, vcc wave_shr:1 row_mask:0xf bank_mask:0xf
    v_cndmask_b32_dpp v85, v85, v85, vcc wave_shr:1 row_mask:0xf bank_mask:0xf
    s_lshr_b64 s[52:53], s[52:53], 1
    v_cndmask_b32_dpp v86, v86, v86, vcc wave_shr:1 row_mask:0xf bank_mask:0xf
    v_cndmask_b32_dpp v87, v87, v87, vcc wave_shr:1 row_mask:0xf bank_mask:0xf
    s_andn2_b64 s[82:83], s[82:83], s[52:53]
    v_cndmask_b32_dpp v7, v7, v7, vcc wave_shr:1 row_mask:0xf bank_mask:0xf
    s_mov_b64 exec, s[54:55]
    s_cbranch_scc0 L2_d89
    s_mov_b64 exec, s[82:83]
    s_nop 1
    v_mfma_f32_4x4x4_16b_bf16 v[88:91], v[12:13], v[84:85], 0
    s_nop 1
    v_mfma_f32_4x4x4_16b_bf16 v[88:91], v[10:11], v[86:87], v[88:91]
    s_nop 4
    v_cvt_pk_bf16_f32 v88, v88, v89
    v_cvt_pk_bf16_f32 v89, v90, v91
    ds_pk_add_bf16 v7, v88 offset:65408
    ds_pk_add_bf16 v7, v89 offset:65412
    s_mov_b64 exec, s[54:55]
    s_branch L2_d89
L2_c90:
    s_lshl_b64 s[52:53], s[82:83], 1
    s_andn2_b64 s[52:53], s[52:53], s[80:81]
    s_andn2_b64 s[52:53], s[52:53], s[50:51]
    s_or_b64 s[80:81], s[80:81], s[52:53]
    s_not_b64 vcc, s[52:53]
    s_mov_b64 exec, -1
    v_cndmask_b32_dpp v84, v84, v84, vcc wave_shr:1 row_mask:0xf bank_mask:0xf
    v_cndmask_b32_dpp v85, v85, v85, vcc wave_shr:1 row_mask:0xf bank_mask:0xf
    s_lshr_b64 s[52:53], s[52:53], 1
    v_cndmask_b32_dpp v86, v86, v86, vcc wave_shr:1 row_mask:0xf bank_mask:0xf
    v_cndmask_b32_dpp v87, v87, v87, vcc wave_shr:1 row_mask:0xf bank_mask:0xf
    s_andn2_b64 s[82:83], s[82:83], s[52:53]
    v_cndmask_b32_dpp v7, v7, v7, vcc wave_shr:1 row_mask:0xf bank_mask:0xf
    s_mov_b64 exec, s[50:51]
    s_cbranch_scc0 L2_d90
    s_mov_b64 exec, s[82:83]
    s_nop 1
    v_mfma_f32_4x4x4_16b_bf16 v[88:91], v[12:13], v[84:85], 0
    s_nop 1
    v_mfma_f32_4x4x4_16b_bf16 v[88:91], v[10:11], v[86:87], v[88:91]
    s_nop 4
    v_cvt_pk_bf16_f32 v88, v88, v89
    v_cvt_pk_bf16_f32 v89, v90, v91
    ds_pk_add_bf16 v7, v88 offset:65408
    ds_pk_add_bf16 v7, v89 offset:65412
    s_mov_b64 exec, s[50:51]
    s_branch L2_d90
L2_c91:
    s_lshl_b64 s[52:53], s[82:83], 1
    s_andn2_b64 s[52:53], s[52:53], s[80:81]
    s_andn2_b64 s[52:53], s[52:53], s[54:55]
    s_or_b64 s[80:81], s[80:81], s[52:53]
    s_not_b64 vcc, s[52:53]
    s_mov_b64 exec, -1
    v_cndmask_b32_dpp v84, v84, v84, vcc wave_shr:1 row_mask:0xf bank_mask:0xf
    v_cndmask_b32_dpp v85, v85, v85, vcc wave_shr:1 row_mask:0xf bank_mask:0xf
    s_lshr_b64 s[52:53], s[52:53], 1
    v_cndmask_b32_dpp v86, v86, v86, vcc wave_shr:1 row_mask:0xf bank_mask:0xf
    v_cndmask_b32_dpp v87, v87, v87, vcc wave_shr:1 row_mask:0xf bank_mask:0xf
    s_andn2_b64 s[82:83], s[82:83], s[52:53]
    v_cndmask_b32_dpp v7, v7, v7, vcc wave_shr:1 row_mask:0xf bank_mask:0xf
    s_mov_b64 exec, s[54:55]
    s_cbranch_scc0 L2_d91
    s_mov_b64 exec, s[82:83]
    s_nop 1
    v_mfma_f32_4x4x4_16b_bf16 v[88:91], v[12:13], v[84:85], 0
    s_nop 1
    v_mfma_f32_4x4x4_16b_bf16 v[88:91], v[10:11], v[86:87], v[88:91]
    s_nop 4
    v_cvt_pk_bf16_f32 v88, v88, v89
    v_cvt_pk_bf16_f32 v89, v90, v91
    ds_pk_add_bf16 v7, v88 offset:65408
    ds_pk_add_bf16 v7, v89 offset:65412
    s_mov_b64 exec, s[54:55]
    s_branch L2_d91
L2_c92:
    s_lshl_b64 s[52:53], s[82:83], 1
    s_andn2_b64 s[52:53], s[52:53], s[80:81]
    s_andn2_b64 s[52:53], s[52:53], s[50:51]
    s_or_b64 s[80:81], s[80:81], s[52:53]
    s_not_b64 vcc, s[52:53]
    s_mov_b64 exec, -1
    v_cndmask_b32_dpp v84, v84, v84, vcc wave_shr:1 row_mask:0xf bank_mask:0xf
    v_cndmask_b32_dpp v85, v85, v85, vcc wave_shr:1 row_mask:0xf bank_mask:0xf
    s_lshr_b64 s[52:53], s[52:53], 1
    v_cndmask_b32_dpp v86, v86, v86, vcc wave_shr:1 row_mask:0xf bank_mask:0xf
    v_cndmask_b32_dpp v87, v87, v87, vcc wave_shr:1 row_mask:0xf bank_mask:0xf
    s_andn2_b64 s[82:83], s[82:83], s[52:53]
    v_cndmask_b32_dpp v7, v7, v7, vcc wave_shr:1 row_mask:0xf bank_mask:0xf
    s_mov_b64 exec, s[50:51]
    s_cbranch_scc0 L2_d92
    s_mov_b64 exec, s[82:83]
    s_nop 1
    v_mfma_f32_4x4x4_16b_bf16 v[88:91], v[12:13], v[84:85], 0
    s_nop 1
    v_mfma_f32_4x4x4_16b_bf16 v[88:91], v[10:11], v[86:87], v[88:91]
    s_nop 4
    v_cvt_pk_bf16_f32 v88, v88, v89
    v_cvt_pk_bf16_f32 v89, v90, v91
    ds_pk_add_bf16 v7, v88 offset:65408
    ds_pk_add_bf16 v7, v89 offset:65412
    s_mov_b64 exec, s[50:51]
    s_branch L2_d92
L2_c93:
    s_lshl_b64 s[52:53], s[82:83], 1
    s_andn2_b64 s[52:53], s[52:53], s[80:81]
    s_andn2_b64 s[52:53], s[52:53], s[54:55]
    s_or_b64 s[80:81], s[80:81], s[52:53]
    s_not_b64 vcc, s[52:53]
    s_mov_b64 exec, -1
    v_cndmask_b32_dpp v84, v84, v84, vcc wave_shr:1 row_mask:0xf bank_mask:0xf
    v_cndmask_b32_dpp v85, v85, v85, vcc wave_shr:1 row_mask:0xf bank_mask:0xf
    s_lshr_b64 s[52:53], s[52:53], 1
    v_cndmask_b32_dpp v86, v86, v86, vcc wave_shr:1 row_mask:0xf bank_mask:0xf
    v_cndmask_b32_dpp v87, v87, v87, vcc wave_shr:1 row_mask:0xf bank_mask:0xf
    s_andn2_b64 s[82:83], s[82:83], s[52:53]
    v_cndmask_b32_dpp v7, v7, v7, vcc wave_shr:1 row_mask:0xf bank_mask:0xf
    s_mov_b64 exec, s[54:55]
    s_cbranch_scc0 L2_d93
    s_mov_b64 exec, s[82:83]
    s_nop 1
    v_mfma_f32_4x4x4_16b_bf16 v[88:91], v[12:13], v[84:85], 0
    s_nop 1
    v_mfma_f32_4x4x4_16b_bf16 v[88:91], v[10:11], v[86:87], v[88:91]
    s_nop 4
    v_cvt_pk_bf16_f32 v88, v88, v89
    v_cvt_pk_bf16_f32 v89, v90, v91
    ds_pk_add_bf16 v7, v88 offset:65408
    ds_pk_add_bf16 v7, v89 offset:65412
    s_mov_b64 exec, s[54:55]
    s_branch L2_d93
L2_c94:
    s_lshl_b64 s[52:53], s[82:83], 1
    s_andn2_b64 s[52:53], s[52:53], s[80:81]
    s_andn2_b64 s[52:53], s[52:53], s[50:51]
    s_or_b64 s[80:81], s[80:81], s[52:53]
    s_not_b64 vcc, s[52:53]
    s_mov_b64 exec, -1
    v_cndmask_b32_dpp v84, v84, v84, vcc wave_shr:1 row_mask:0xf bank_mask:0xf
    v_cndmask_b32_dpp v85, v85, v85, vcc wave_shr:1 row_mask:0xf bank_mask:0xf
    s_lshr_b64 s[52:53], s[52:53], 1
    v_cndmask_b32_dpp v86, v86, v86, vcc wave_shr:1 row_mask:0xf bank_mask:0xf
    v_cndmask_b32_dpp v87, v87, v87, vcc wave_shr:1 row_mask:0xf bank_mask:0xf
    s_andn2_b64 s[82:83], s[82:83], s[52:53]
    v_cndmask_b32_dpp v7, v7, v7, vcc wave_shr:1 row_mask:0xf bank_mask:0xf
    s_mov_b64 exec, s[50:51]
    s_cbranch_scc0 L2_d94
    s_mov_b64 exec, s[82:83]
    s_nop 1
    v_mfma_f32_4x4x4_16b_bf16 v[88:91], v[12:13], v[84:85], 0
    s_nop 1
    v_mfma_f32_4x4x4_16b_bf16 v[88:91], v[10:11], v[86:87], v[88:91]
    s_nop 4
    v_cvt_pk_bf16_f32 v88, v88, v89
    v_cvt_pk_bf16_f32 v89, v90, v91
    ds_pk_add_bf16 v7, v88 offset:65408
    ds_pk_add_bf16 v7, v89 offset:65412
    s_mov_b64 exec, s[50:51]
    s_branch L2_d94
L2_c95:
    s_lshl_b64 s[52:53], s[82:83], 1
    s_andn2_b64 s[52:53], s[52:53], s[80:81]
    s_andn2_b64 s[52:53], s[52:53], s[54:55]
    s_or_b64 s[80:81], s[80:81], s[52:53]
    s_not_b64 vcc, s[52:53]
    s_mov_b64 exec, -1
    v_cndmask_b32_dpp v84, v84, v84, vcc wave_shr:1 row_mask:0xf bank_mask:0xf
    v_cndmask_b32_dpp v85, v85, v85, vcc wave_shr:1 row_mask:0xf bank_mask:0xf
    s_lshr_b64 s[52:53], s[52:53], 1
    v_cndmask_b32_dpp v86, v86, v86, vcc wave_shr:1 row_mask:0xf bank_mask:0xf
    v_cndmask_b32_dpp v87, v87, v87, vcc wave_shr:1 row_mask:0xf bank_mask:0xf
    s_andn2_b64 s[82:83], s[82:83], s[52:53]
    v_cndmask_b32_dpp v7, v7, v7, vcc wave_shr:1 row_mask:0xf bank_mask:0xf
    s_mov_b64 exec, s[54:55]
    s_cbranch_scc0 L2_d95
    s_mov_b64 exec, s[82:83]
    s_nop 1
    v_mfma_f32_4x4x4_16b_bf16 v[88:91], v[12:13], v[84:85], 0
    s_nop 1
    v_mfma_f32_4x4x4_16b_bf16 v[88:91], v[10:11], v[86:87], v[88:91]
    s_nop 4
    v_cvt_pk_bf16_f32 v88, v88, v89
    v_cvt_pk_bf16_f32 v89, v90, v91
    ds_pk_add_bf16 v7, v88 offset:65408
    ds_pk_add_bf16 v7, v89 offset:65412
    s_mov_b64 exec, s[54:55]
    s_branch L2_d95
L2_c96:
    s_lshl_b64 s[52:53], s[82:83], 1
    s_andn2_b64 s[52:53], s[52:53], s[80:81]
    s_andn2_b64 s[52:53], s[52:53], s[50:51]
    s_or_b64 s[80:81], s[80:81], s[52:53]
    s_not_b64 vcc, s[52:53]
    s_mov_b64 exec, -1
    v_cndmask_b32_dpp v84, v84, v84, vcc wave_shr:1 row_mask:0xf bank_mask:0xf
    v_cndmask_b32_dpp v85, v85, v85, vcc wave_shr:1 row_mask:0xf bank_mask:0xf
    s_lshr_b64 s[52:53], s[52:53], 1
    v_cndmask_b32_dpp v86, v86, v86, vcc wave_shr:1 row_mask:0xf bank_mask:0xf
    v_cndmask_b32_dpp v87, v87, v87, vcc wave_shr:1 row_mask:0xf bank_mask:0xf
    s_andn2_b64 s[82:83], s[82:83], s[52:53]
    v_cndmask_b32_dpp v7, v7, v7, vcc wave_shr:1 row_mask:0xf bank_mask:0xf
    s_mov_b64 exec, s[50:51]
    s_cbranch_scc0 L2_d96
    s_mov_b64 exec, s[82:83]
    s_nop 1
    v_mfma_f32_4x4x4_16b_bf16 v[88:91], v[12:13], v[84:85], 0
    s_nop 1
    v_mfma_f32_4x4x4_16b_bf16 v[88:91], v[10:11], v[86:87], v[88:91]
    s_nop 4
    v_cvt_pk_bf16_f32 v88, v88, v89
    v_cvt_pk_bf16_f32 v89, v90, v91
    ds_pk_add_bf16 v7, v88 offset:65408
    ds_pk_add_bf16 v7, v89 offset:65412
    s_mov_b64 exec, s[50:51]
    s_branch L2_d96
L2_xa97:
    s_cmp_eq_u32 s101, 1
    s_cbranch_scc1 L2_xc97
    v_lshlrev_b32 v89, 0, v96
    v_add_u32 v90, 140, v97
    v_bitop3_b32 v90, v89, v45, v90 bitop3:0x6a
    ds_write_b32 v98, v90 offset:28
    v_lshlrev_b32 v89, 4, v96
    v_add_u32 v90, 120, v97
    v_bitop3_b32 v90, v89, v45, v90 bitop3:0x6a
    ds_write_b32 v98, v90 offset:24
    v_lshlrev_b32 v89, 8, v96
    v_add_u32 v90, 100, v97
    v_bitop3_b32 v90, v89, v45, v90 bitop3:0x6a
    ds_write_b32 v98, v90 offset:20
L2_xc97:
    v_lshlrev_b32 v89, 12, v96
    v_add_u32 v90, 80, v97
    v_bitop3_b32 v90, v89, v45, v90 bitop3:0x6a
    ds_write_b32 v98, v90 offset:16
    s_branch L2_xb97
L2_xe97:
    v_cmp_lt_u32 vcc, 32, v99
    v_cmp_lt_u32 s[58:59], 31, v88
    v_lshrrev_b32 v89, 16, v96
    v_add_u32 v97, 80, v97
    s_or_b64 vcc, vcc, s[58:59]
    s_cbranch_scc1 L2_xs97
    v_lshlrev_b32 v89, v1, v89
    v_and_b32 v89, v45, v89
    v_cmp_ne_u32 vcc, 0, v89
    v_xor_b32 v90, v97, v89
    s_add_u32 s3, s37, s38
    v_mbcnt_lo_u32_b32 v98, vcc_lo, 0
    v_mbcnt_hi_u32_b32 v98, vcc_hi, v98
    s_bcnt1_i32_b64 s41, vcc
    v_lshl_add_u32 v98, v98, 2, s3
    s_mov_b64 exec, vcc
    ds_write_b32 v98, v90
    s_mov_b64 exec, -1
    s_lshl2_add_u32 s37, s41, s37
    s_branch L2_xr97
L2_xf97:
    s_waitcnt lgkmcnt(0)
    s_cmp_gt_u32 s37, 1024
    s_cbranch_scc1 L2_xs97
    v_mov_b32 v43, -1
    s_cmp_ge_u32 s37, 512
    s_cbranch_scc1 L2_xg97
    v_mov_b32 v42, -1
    s_cmp_ge_u32 s37, 256
    s_cbranch_scc1 L2_xg97
    v_mov_b32 v41, -1
    s_branch L2_xg97
L2_xs97:
    s_waitcnt lgkmcnt(0)
    v_mov_b32 v40, -1
    v_mov_b32 v41, -1
    v_mov_b32 v42, -1
    v_mov_b32 v43, -1
    s_add_u32 s3, s42, 2
    s_bitset1_b32 s36, s3
    s_branch L2_xg97
L2_c98:
    s_lshl_b64 s[52:53], s[82:83], 1
    s_andn2_b64 s[52:53], s[52:53], s[80:81]
    s_andn2_b64 s[52:53], s[52:53], s[54:55]
    s_or_b64 s[80:81], s[80:81], s[52:53]
    s_not_b64 vcc, s[52:53]
    s_mov_b64 exec, -1
    v_cndmask_b32_dpp v84, v84, v84, vcc wave_shr:1 row_mask:0xf bank_mask:0xf
    v_cndmask_b32_dpp v85, v85, v85, vcc wave_shr:1 row_mask:0xf bank_mask:0xf
    s_lshr_b64 s[52:53], s[52:53], 1
    v_cndmask_b32_dpp v86, v86, v86, vcc wave_shr:1 row_mask:0xf bank_mask:0xf
    v_cndmask_b32_dpp v87, v87, v87, vcc wave_shr:1 row_mask:0xf bank_mask:0xf
    s_andn2_b64 s[82:83], s[82:83], s[52:53]
    v_cndmask_b32_dpp v7, v7, v7, vcc wave_shr:1 row_mask:0xf bank_mask:0xf
    s_mov_b64 exec, s[54:55]
    s_cbranch_scc0 L2_d98
    s_mov_b64 exec, s[82:83]
    s_nop 1
    v_mfma_f32_4x4x4_16b_bf16 v[88:91], v[12:13], v[84:85], 0
    s_nop 1
    v_mfma_f32_4x4x4_16b_bf16 v[88:91], v[10:11], v[86:87], v[88:91]
    s_nop 4
    v_cvt_pk_bf16_f32 v88, v88, v89
    v_cvt_pk_bf16_f32 v89, v90, v91
    ds_pk_add_bf16 v7, v88 offset:65408
    ds_pk_add_bf16 v7, v89 offset:65412
    s_mov_b64 exec, s[54:55]
    s_branch L2_d98
L2_c99:
    s_lshl_b64 s[52:53], s[82:83], 1
    s_andn2_b64 s[52:53], s[52:53], s[80:81]
    s_andn2_b64 s[52:53], s[52:53], s[50:51]
    s_or_b64 s[80:81], s[80:81], s[52:53]
    s_not_b64 vcc, s[52:53]
    s_mov_b64 exec, -1
    v_cndmask_b32_dpp v84, v84, v84, vcc wave_shr:1 row_mask:0xf bank_mask:0xf
    v_cndmask_b32_dpp v85, v85, v85, vcc wave_shr:1 row_mask:0xf bank_mask:0xf
    s_lshr_b64 s[52:53], s[52:53], 1
    v_cndmask_b32_dpp v86, v86, v86, vcc wave_shr:1 row_mask:0xf bank_mask:0xf
    v_cndmask_b32_dpp v87, v87, v87, vcc wave_shr:1 row_mask:0xf bank_mask:0xf
    s_andn2_b64 s[82:83], s[82:83], s[52:53]
    v_cndmask_b32_dpp v7, v7, v7, vcc wave_shr:1 row_mask:0xf bank_mask:0xf
    s_mov_b64 exec, s[50:51]
    s_cbranch_scc0 L2_d99
    s_mov_b64 exec, s[82:83]
    s_nop 1
    v_mfma_f32_4x4x4_16b_bf16 v[88:91], v[12:13], v[84:85], 0
    s_nop 1
    v_mfma_f32_4x4x4_16b_bf16 v[88:91], v[10:11], v[86:87], v[88:91]
    s_nop 4
    v_cvt_pk_bf16_f32 v88, v88, v89
    v_cvt_pk_bf16_f32 v89, v90, v91
    ds_pk_add_bf16 v7, v88 offset:65408
    ds_pk_add_bf16 v7, v89 offset:65412
    s_mov_b64 exec, s[50:51]
    s_branch L2_d99
L2_c100:
    s_lshl_b64 s[52:53], s[82:83], 1
    s_andn2_b64 s[52:53], s[52:53], s[80:81]
    s_andn2_b64 s[52:53], s[52:53], s[54:55]
    s_or_b64 s[80:81], s[80:81], s[52:53]
    s_not_b64 vcc, s[52:53]
    s_mov_b64 exec, -1
    v_cndmask_b32_dpp v84, v84, v84, vcc wave_shr:1 row_mask:0xf bank_mask:0xf
    v_cndmask_b32_dpp v85, v85, v85, vcc wave_shr:1 row_mask:0xf bank_mask:0xf
    s_lshr_b64 s[52:53], s[52:53], 1
    v_cndmask_b32_dpp v86, v86, v86, vcc wave_shr:1 row_mask:0xf bank_mask:0xf
    v_cndmask_b32_dpp v87, v87, v87, vcc wave_shr:1 row_mask:0xf bank_mask:0xf
    s_andn2_b64 s[82:83], s[82:83], s[52:53]
    v_cndmask_b32_dpp v7, v7, v7, vcc wave_shr:1 row_mask:0xf bank_mask:0xf
    s_mov_b64 exec, s[54:55]
    s_cbranch_scc0 L2_d100
    s_mov_b64 exec, s[82:83]
    s_nop 1
    v_mfma_f32_4x4x4_16b_bf16 v[88:91], v[12:13], v[84:85], 0
    s_nop 1
    v_mfma_f32_4x4x4_16b_bf16 v[88:91], v[10:11], v[86:87], v[88:91]
    s_nop 4
    v_cvt_pk_bf16_f32 v88, v88, v89
    v_cvt_pk_bf16_f32 v89, v90, v91
    ds_pk_add_bf16 v7, v88 offset:65408
    ds_pk_add_bf16 v7, v89 offset:65412
    s_mov_b64 exec, s[54:55]
    s_branch L2_d100
L2_c101:
    s_lshl_b64 s[52:53], s[82:83], 1
    s_andn2_b64 s[52:53], s[52:53], s[80:81]
    s_andn2_b64 s[52:53], s[52:53], s[50:51]
    s_or_b64 s[80:81], s[80:81], s[52:53]
    s_not_b64 vcc, s[52:53]
    s_mov_b64 exec, -1
    v_cndmask_b32_dpp v84, v84, v84, vcc wave_shr:1 row_mask:0xf bank_mask:0xf
    v_cndmask_b32_dpp v85, v85, v85, vcc wave_shr:1 row_mask:0xf bank_mask:0xf
    s_lshr_b64 s[52:53], s[52:53], 1
    v_cndmask_b32_dpp v86, v86, v86, vcc wave_shr:1 row_mask:0xf bank_mask:0xf
    v_cndmask_b32_dpp v87, v87, v87, vcc wave_shr:1 row_mask:0xf bank_mask:0xf
    s_andn2_b64 s[82:83], s[82:83], s[52:53]
    v_cndmask_b32_dpp v7, v7, v7, vcc wave_shr:1 row_mask:0xf bank_mask:0xf
    s_mov_b64 exec, s[50:51]
    s_cbranch_scc0 L2_d101
    s_mov_b64 exec, s[82:83]
    s_nop 1
    v_mfma_f32_4x4x4_16b_bf16 v[88:91], v[12:13], v[84:85], 0
    s_nop 1
    v_mfma_f32_4x4x4_16b_bf16 v[88:91], v[10:11], v[86:87], v[88:91]
    s_nop 4
    v_cvt_pk_bf16_f32 v88, v88, v89
    v_cvt_pk_bf16_f32 v89, v90, v91
    ds_pk_add_bf16 v7, v88 offset:65408
    ds_pk_add_bf16 v7, v89 offset:65412
    s_mov_b64 exec, s[50:51]
    s_branch L2_d101
L2_c102:
    s_lshl_b64 s[52:53], s[82:83], 1
    s_andn2_b64 s[52:53], s[52:53], s[80:81]
    s_andn2_b64 s[52:53], s[52:53], s[54:55]
    s_or_b64 s[80:81], s[80:81], s[52:53]
    s_not_b64 vcc, s[52:53]
    s_mov_b64 exec, -1
    v_cndmask_b32_dpp v84, v84, v84, vcc wave_shr:1 row_mask:0xf bank_mask:0xf
    v_cndmask_b32_dpp v85, v85, v85, vcc wave_shr:1 row_mask:0xf bank_mask:0xf
    s_lshr_b64 s[52:53], s[52:53], 1
    v_cndmask_b32_dpp v86, v86, v86, vcc wave_shr:1 row_mask:0xf bank_mask:0xf
    v_cndmask_b32_dpp v87, v87, v87, vcc wave_shr:1 row_mask:0xf bank_mask:0xf
    s_andn2_b64 s[82:83], s[82:83], s[52:53]
    v_cndmask_b32_dpp v7, v7, v7, vcc wave_shr:1 row_mask:0xf bank_mask:0xf
    s_mov_b64 exec, s[54:55]
    s_cbranch_scc0 L2_d102
    s_mov_b64 exec, s[82:83]
    s_nop 1
    v_mfma_f32_4x4x4_16b_bf16 v[88:91], v[12:13], v[84:85], 0
    s_nop 1
    v_mfma_f32_4x4x4_16b_bf16 v[88:91], v[10:11], v[86:87], v[88:91]
    s_nop 4
    v_cvt_pk_bf16_f32 v88, v88, v89
    v_cvt_pk_bf16_f32 v89, v90, v91
    ds_pk_add_bf16 v7, v88 offset:65408
    ds_pk_add_bf16 v7, v89 offset:65412
    s_mov_b64 exec, s[54:55]
    s_branch L2_d102
L2_c103:
    s_lshl_b64 s[52:53], s[82:83], 1
    s_andn2_b64 s[52:53], s[52:53], s[80:81]
    s_andn2_b64 s[52:53], s[52:53], s[50:51]
    s_or_b64 s[80:81], s[80:81], s[52:53]
    s_not_b64 vcc, s[52:53]
    s_mov_b64 exec, -1
    v_cndmask_b32_dpp v84, v84, v84, vcc wave_shr:1 row_mask:0xf bank_mask:0xf
    v_cndmask_b32_dpp v85, v85, v85, vcc wave_shr:1 row_mask:0xf bank_mask:0xf
    s_lshr_b64 s[52:53], s[52:53], 1
    v_cndmask_b32_dpp v86, v86, v86, vcc wave_shr:1 row_mask:0xf bank_mask:0xf
    v_cndmask_b32_dpp v87, v87, v87, vcc wave_shr:1 row_mask:0xf bank_mask:0xf
    s_andn2_b64 s[82:83], s[82:83], s[52:53]
    v_cndmask_b32_dpp v7, v7, v7, vcc wave_shr:1 row_mask:0xf bank_mask:0xf
    s_mov_b64 exec, s[50:51]
    s_cbranch_scc0 L2_d103
    s_mov_b64 exec, s[82:83]
    s_nop 1
    v_mfma_f32_4x4x4_16b_bf16 v[88:91], v[12:13], v[84:85], 0
    s_nop 1
    v_mfma_f32_4x4x4_16b_bf16 v[88:91], v[10:11], v[86:87], v[88:91]
    s_nop 4
    v_cvt_pk_bf16_f32 v88, v88, v89
    v_cvt_pk_bf16_f32 v89, v90, v91
    ds_pk_add_bf16 v7, v88 offset:65408
    ds_pk_add_bf16 v7, v89 offset:65412
    s_mov_b64 exec, s[50:51]
    s_branch L2_d103
L2_xo104:
    v_cmp_lt_u32 vcc, 20, v99
    s_mov_b32 s101, 1
    s_cbranch_vccz L2_xp104
    v_cmp_lt_u32 vcc, 32, v99
    v_cmp_lt_u32 s[58:59], 31, v88
    s_mov_b32 s101, 2
    s_or_b64 vcc, vcc, s[58:59]
    s_cbranch_scc0 L2_xp104
    s_mov_b32 s37, 0x10000
    s_branch L2_xp104
L2_c105:
    s_lshl_b64 s[52:53], s[82:83], 1
    s_andn2_b64 s[52:53], s[52:53], s[80:81]
    s_andn2_b64 s[52:53], s[52:53], s[54:55]
    s_or_b64 s[80:81], s[80:81], s[52:53]
    s_not_b64 vcc, s[52:53]
    s_mov_b64 exec, -1
    v_cndmask_b32_dpp v84, v84, v84, vcc wave_shr:1 row_mask:0xf bank_mask:0xf
    v_cndmask_b32_dpp v85, v85, v85, vcc wave_shr:1 row_mask:0xf bank_mask:0xf
    s_lshr_b64 s[52:53], s[52:53], 1
    v_cndmask_b32_dpp v86, v86, v86, vcc wave_shr:1 row_mask:0xf bank_mask:0xf
    v_cndmask_b32_dpp v87, v87, v87, vcc wave_shr:1 row_mask:0xf bank_mask:0xf
    s_andn2_b64 s[82:83], s[82:83], s[52:53]
    v_cndmask_b32_dpp v7, v7, v7, vcc wave_shr:1 row_mask:0xf bank_mask:0xf
    s_mov_b64 exec, s[54:55]
    s_cbranch_scc0 L2_d105
    s_mov_b64 exec, s[82:83]
    s_nop 1
    v_mfma_f32_4x4x4_16b_bf16 v[88:91], v[12:13], v[84:85], 0
    s_nop 1
    v_mfma_f32_4x4x4_16b_bf16 v[88:91], v[10:11], v[86:87], v[88:91]
    s_nop 4
    v_cvt_pk_bf16_f32 v88, v88, v89
    v_cvt_pk_bf16_f32 v89, v90, v91
    ds_pk_add_bf16 v7, v88 offset:65408
    ds_pk_add_bf16 v7, v89 offset:65412
    s_mov_b64 exec, s[54:55]
    s_branch L2_d105
L2_c106:
    s_lshl_b64 s[52:53], s[82:83], 1
    s_andn2_b64 s[52:53], s[52:53], s[80:81]
    s_andn2_b64 s[52:53], s[52:53], s[50:51]
    s_or_b64 s[80:81], s[80:81], s[52:53]
    s_not_b64 vcc, s[52:53]
    s_mov_b64 exec, -1
    v_cndmask_b32_dpp v84, v84, v84, vcc wave_shr:1 row_mask:0xf bank_mask:0xf
    v_cndmask_b32_dpp v85, v85, v85, vcc wave_shr:1 row_mask:0xf bank_mask:0xf
    s_lshr_b64 s[52:53], s[52:53], 1
    v_cndmask_b32_dpp v86, v86, v86, vcc wave_shr:1 row_mask:0xf bank_mask:0xf
    v_cndmask_b32_dpp v87, v87, v87, vcc wave_shr:1 row_mask:0xf bank_mask:0xf
    s_andn2_b64 s[82:83], s[82:83], s[52:53]
    v_cndmask_b32_dpp v7, v7, v7, vcc wave_shr:1 row_mask:0xf bank_mask:0xf
    s_mov_b64 exec, s[50:51]
    s_cbranch_scc0 L2_d106
    s_mov_b64 exec, s[82:83]
    s_nop 1
    v_mfma_f32_4x4x4_16b_bf16 v[88:91], v[12:13], v[84:85], 0
    s_nop 1
    v_mfma_f32_4x4x4_16b_bf16 v[88:91], v[10:11], v[86:87], v[88:91]
    s_nop 4
    v_cvt_pk_bf16_f32 v88, v88, v89
    v_cvt_pk_bf16_f32 v89, v90, v91
    ds_pk_add_bf16 v7, v88 offset:65408
    ds_pk_add_bf16 v7, v89 offset:65412
    s_mov_b64 exec, s[50:51]
    s_branch L2_d106
L2_c107:
    s_lshl_b64 s[52:53], s[82:83], 1
    s_andn2_b64 s[52:53], s[52:53], s[80:81]
    s_andn2_b64 s[52:53], s[52:53], s[54:55]
    s_or_b64 s[80:81], s[80:81], s[52:53]
    s_not_b64 vcc, s[52:53]
    s_mov_b64 exec, -1
    v_cndmask_b32_dpp v84, v84, v84, vcc wave_shr:1 row_mask:0xf bank_mask:0xf
    v_cndmask_b32_dpp v85, v85, v85, vcc wave_shr:1 row_mask:0xf bank_mask:0xf
    s_lshr_b64 s[52:53], s[52:53], 1
    v_cndmask_b32_dpp v86, v86, v86, vcc wave_shr:1 row_mask:0xf bank_mask:0xf
    v_cndmask_b32_dpp v87, v87, v87, vcc wave_shr:1 row_mask:0xf bank_mask:0xf
    s_andn2_b64 s[82:83], s[82:83], s[52:53]
    v_cndmask_b32_dpp v7, v7, v7, vcc wave_shr:1 row_mask:0xf bank_mask:0xf
    s_mov_b64 exec, s[54:55]
    s_cbranch_scc0 L2_d107
    s_mov_b64 exec, s[82:83]
    s_nop 1
    v_mfma_f32_4x4x4_16b_bf16 v[88:91], v[12:13], v[84:85], 0
    s_nop 1
    v_mfma_f32_4x4x4_16b_bf16 v[88:91], v[10:11], v[86:87], v[88:91]
    s_nop 4
    v_cvt_pk_bf16_f32 v88, v88, v89
    v_cvt_pk_bf16_f32 v89, v90, v91
    ds_pk_add_bf16 v7, v88 offset:65408
    ds_pk_add_bf16 v7, v89 offset:65412
    s_mov_b64 exec, s[54:55]
    s_branch L2_d107
L2_c108:
    s_lshl_b64 s[52:53], s[82:83], 1
    s_andn2_b64 s[52:53], s[52:53], s[80:81]
    s_andn2_b64 s[52:53], s[52:53], s[50:51]
    s_or_b64 s[80:81], s[80:81], s[52:53]
    s_not_b64 vcc, s[52:53]
    s_mov_b64 exec, -1
    v_cndmask_b32_dpp v84, v84, v84, vcc wave_shr:1 row_mask:0xf bank_mask:0xf
    v_cndmask_b32_dpp v85, v85, v85, vcc wave_shr:1 row_mask:0xf bank_mask:0xf
    s_lshr_b64 s[52:53], s[52:53], 1
    v_cndmask_b32_dpp v86, v86, v86, vcc wave_shr:1 row_mask:0xf bank_mask:0xf
    v_cndmask_b32_dpp v87, v87, v87, vcc wave_shr:1 row_mask:0xf bank_mask:0xf
    s_andn2_b64 s[82:83], s[82:83], s[52:53]
    v_cndmask_b32_dpp v7, v7, v7, vcc wave_shr:1 row_mask:0xf bank_mask:0xf
    s_mov_b64 exec, s[50:51]
    s_cbranch_scc0 L2_d108
    s_mov_b64 exec, s[82:83]
    s_nop 1
    v_mfma_f32_4x4x4_16b_bf16 v[88:91], v[12:13], v[84:85], 0
    s_nop 1
    v_mfma_f32_4x4x4_16b_bf16 v[88:91], v[10:11], v[86:87], v[88:91]
    s_nop 4
    v_cvt_pk_bf16_f32 v88, v88, v89
    v_cvt_pk_bf16_f32 v89, v90, v91
    ds_pk_add_bf16 v7, v88 offset:65408
    ds_pk_add_bf16 v7, v89 offset:65412
    s_mov_b64 exec, s[50:51]
    s_branch L2_d108
L2_c109:
    s_lshl_b64 s[52:53], s[82:83], 1
    s_andn2_b64 s[52:53], s[52:53], s[80:81]
    s_andn2_b64 s[52:53], s[52:53], s[54:55]
    s_or_b64 s[80:81], s[80:81], s[52:53]
    s_not_b64 vcc, s[52:53]
    s_mov_b64 exec, -1
    v_cndmask_b32_dpp v84, v84, v84, vcc wave_shr:1 row_mask:0xf bank_mask:0xf
    v_cndmask_b32_dpp v85, v85, v85, vcc wave_shr:1 row_mask:0xf bank_mask:0xf
    s_lshr_b64 s[52:53], s[52:53], 1
    v_cndmask_b32_dpp v86, v86, v86, vcc wave_shr:1 row_mask:0xf bank_mask:0xf
    v_cndmask_b32_dpp v87, v87, v87, vcc wave_shr:1 row_mask:0xf bank_mask:0xf
    s_andn2_b64 s[82:83], s[82:83], s[52:53]
    v_cndmask_b32_dpp v7, v7, v7, vcc wave_shr:1 row_mask:0xf bank_mask:0xf
    s_mov_b64 exec, s[54:55]
    s_cbranch_scc0 L2_d109
    s_mov_b64 exec, s[82:83]
    s_nop 1
    v_mfma_f32_4x4x4_16b_bf16 v[88:91], v[12:13], v[84:85], 0
    s_nop 1
    v_mfma_f32_4x4x4_16b_bf16 v[88:91], v[10:11], v[86:87], v[88:91]
    s_nop 4
    v_cvt_pk_bf16_f32 v88, v88, v89
    v_cvt_pk_bf16_f32 v89, v90, v91
    ds_pk_add_bf16 v7, v88 offset:65408
    ds_pk_add_bf16 v7, v89 offset:65412
    s_mov_b64 exec, s[54:55]
    s_branch L2_d109
L2_c110:
    s_lshl_b64 s[52:53], s[82:83], 1
    s_andn2_b64 s[52:53], s[52:53], s[80:81]
    s_andn2_b64 s[52:53], s[52:53], s[50:51]
    s_or_b64 s[80:81], s[80:81], s[52:53]
    s_not_b64 vcc, s[52:53]
    s_mov_b64 exec, -1
    v_cndmask_b32_dpp v84, v84, v84, vcc wave_shr:1 row_mask:0xf bank_mask:0xf
    v_cndmask_b32_dpp v85, v85, v85, vcc wave_shr:1 row_mask:0xf bank_mask:0xf
    s_lshr_b64 s[52:53], s[52:53], 1
    v_cndmask_b32_dpp v86, v86, v86, vcc wave_shr:1 row_mask:0xf bank_mask:0xf
    v_cndmask_b32_dpp v87, v87, v87, vcc wave_shr:1 row_mask:0xf bank_mask:0xf
    s_andn2_b64 s[82:83], s[82:83], s[52:53]
    v_cndmask_b32_dpp v7, v7, v7, vcc wave_shr:1 row_mask:0xf bank_mask:0xf
    s_mov_b64 exec, s[50:51]
    s_cbranch_scc0 L2_d110
    s_mov_b64 exec, s[82:83]
    s_nop 1
    v_mfma_f32_4x4x4_16b_bf16 v[88:91], v[12:13], v[84:85], 0
    s_nop 1
    v_mfma_f32_4x4x4_16b_bf16 v[88:91], v[10:11], v[86:87], v[88:91]
    s_nop 4
    v_cvt_pk_bf16_f32 v88, v88, v89
    v_cvt_pk_bf16_f32 v89, v90, v91
    ds_pk_add_bf16 v7, v88 offset:65408
    ds_pk_add_bf16 v7, v89 offset:65412
    s_mov_b64 exec, s[50:51]
    s_branch L2_d110
L2_c111:
    s_lshl_b64 s[52:53], s[82:83], 1
    s_andn2_b64 s[52:53], s[52:53], s[80:81]
    s_andn2_b64 s[52:53], s[52:53], s[54:55]
    s_or_b64 s[80:81], s[80:81], s[52:53]
    s_not_b64 vcc, s[52:53]
    s_mov_b64 exec, -1
    v_cndmask_b32_dpp v84, v84, v84, vcc wave_shr:1 row_mask:0xf bank_mask:0xf
    v_cndmask_b32_dpp v85, v85, v85, vcc wave_shr:1 row_mask:0xf bank_mask:0xf
    s_lshr_b64 s[52:53], s[52:53], 1
    v_cndmask_b32_dpp v86, v86, v86, vcc wave_shr:1 row_mask:0xf bank_mask:0xf
    v_cndmask_b32_dpp v87, v87, v87, vcc wave_shr:1 row_mask:0xf bank_mask:0xf
    s_andn2_b64 s[82:83], s[82:83], s[52:53]
    v_cndmask_b32_dpp v7, v7, v7, vcc wave_shr:1 row_mask:0xf bank_mask:0xf
    s_mov_b64 exec, s[54:55]
    s_cbranch_scc0 L2_d111
    s_mov_b64 exec, s[82:83]
    s_nop 1
    v_mfma_f32_4x4x4_16b_bf16 v[88:91], v[12:13], v[84:85], 0
    s_nop 1
    v_mfma_f32_4x4x4_16b_bf16 v[88:91], v[10:11], v[86:87], v[88:91]
    s_nop 4
    v_cvt_pk_bf16_f32 v88, v88, v89
    v_cvt_pk_bf16_f32 v89, v90, v91
    ds_pk_add_bf16 v7, v88 offset:65408
    ds_pk_add_bf16 v7, v89 offset:65412
    s_mov_b64 exec, s[54:55]
    s_branch L2_d111
L2_c112:
    s_lshl_b64 s[52:53], s[82:83], 1
    s_andn2_b64 s[52:53], s[52:53], s[80:81]
    s_andn2_b64 s[52:53], s[52:53], s[50:51]
    s_or_b64 s[80:81], s[80:81], s[52:53]
    s_not_b64 vcc, s[52:53]
    s_mov_b64 exec, -1
    v_cndmask_b32_dpp v84, v84, v84, vcc wave_shr:1 row_mask:0xf bank_mask:0xf
    v_cndmask_b32_dpp v85, v85, v85, vcc wave_shr:1 row_mask:0xf bank_mask:0xf
    s_lshr_b64 s[52:53], s[52:53], 1
    v_cndmask_b32_dpp v86, v86, v86, vcc wave_shr:1 row_mask:0xf bank_mask:0xf
    v_cndmask_b32_dpp v87, v87, v87, vcc wave_shr:1 row_mask:0xf bank_mask:0xf
    s_andn2_b64 s[82:83], s[82:83], s[52:53]
    v_cndmask_b32_dpp v7, v7, v7, vcc wave_shr:1 row_mask:0xf bank_mask:0xf
    s_mov_b64 exec, s[50:51]
    s_cbranch_scc0 L2_d112
    s_mov_b64 exec, s[82:83]
    s_nop 1
    v_mfma_f32_4x4x4_16b_bf16 v[88:91], v[12:13], v[84:85], 0
    s_nop 1
    v_mfma_f32_4x4x4_16b_bf16 v[88:91], v[10:11], v[86:87], v[88:91]
    s_nop 4
    v_cvt_pk_bf16_f32 v88, v88, v89
    v_cvt_pk_bf16_f32 v89, v90, v91
    ds_pk_add_bf16 v7, v88 offset:65408
    ds_pk_add_bf16 v7, v89 offset:65412
    s_mov_b64 exec, s[50:51]
    s_branch L2_d112
L2_c113:
    s_lshl_b64 s[52:53], s[82:83], 1
    s_andn2_b64 s[52:53], s[52:53], s[80:81]
    s_andn2_b64 s[52:53], s[52:53], s[54:55]
    s_or_b64 s[80:81], s[80:81], s[52:53]
    s_not_b64 vcc, s[52:53]
    s_mov_b64 exec, -1
    v_cndmask_b32_dpp v84, v84, v84, vcc wave_shr:1 row_mask:0xf bank_mask:0xf
    v_cndmask_b32_dpp v85, v85, v85, vcc wave_shr:1 row_mask:0xf bank_mask:0xf
    s_lshr_b64 s[52:53], s[52:53], 1
    v_cndmask_b32_dpp v86, v86, v86, vcc wave_shr:1 row_mask:0xf bank_mask:0xf
    v_cndmask_b32_dpp v87, v87, v87, vcc wave_shr:1 row_mask:0xf bank_mask:0xf
    s_andn2_b64 s[82:83], s[82:83], s[52:53]
    v_cndmask_b32_dpp v7, v7, v7, vcc wave_shr:1 row_mask:0xf bank_mask:0xf
    s_mov_b64 exec, s[54:55]
    s_cbranch_scc0 L2_d113
    s_mov_b64 exec, s[82:83]
    s_nop 1
    v_mfma_f32_4x4x4_16b_bf16 v[88:91], v[12:13], v[84:85], 0
    s_nop 1
    v_mfma_f32_4x4x4_16b_bf16 v[88:91], v[10:11], v[86:87], v[88:91]
    s_nop 4
    v_cvt_pk_bf16_f32 v88, v88, v89
    v_cvt_pk_bf16_f32 v89, v90, v91
    ds_pk_add_bf16 v7, v88 offset:65408
    ds_pk_add_bf16 v7, v89 offset:65412
    s_mov_b64 exec, s[54:55]
    s_branch L2_d113
L2_c114:
    s_lshl_b64 s[52:53], s[82:83], 1
    s_andn2_b64 s[52:53], s[52:53], s[80:81]
    s_andn2_b64 s[52:53], s[52:53], s[50:51]
    s_or_b64 s[80:81], s[80:81], s[52:53]
    s_not_b64 vcc, s[52:53]
    s_mov_b64 exec, -1
    v_cndmask_b32_dpp v84, v84, v84, vcc wave_shr:1 row_mask:0xf bank_mask:0xf
    v_cndmask_b32_dpp v85, v85, v85, vcc wave_shr:1 row_mask:0xf bank_mask:0xf
    s_lshr_b64 s[52:53], s[52:53], 1
    v_cndmask_b32_dpp v86, v86, v86, vcc wave_shr:1 row_mask:0xf bank_mask:0xf
    v_cndmask_b32_dpp v87, v87, v87, vcc wave_shr:1 row_mask:0xf bank_mask:0xf
    s_andn2_b64 s[82:83], s[82:83], s[52:53]
    v_cndmask_b32_dpp v7, v7, v7, vcc wave_shr:1 row_mask:0xf bank_mask:0xf
    s_mov_b64 exec, s[50:51]
    s_cbranch_scc0 L2_d114
    s_mov_b64 exec, s[82:83]
    s_nop 1
    v_mfma_f32_4x4x4_16b_bf16 v[88:91], v[12:13], v[84:85], 0
    s_nop 1
    v_mfma_f32_4x4x4_16b_bf16 v[88:91], v[10:11], v[86:87], v[88:91]
    s_nop 4
    v_cvt_pk_bf16_f32 v88, v88, v89
    v_cvt_pk_bf16_f32 v89, v90, v91
    ds_pk_add_bf16 v7, v88 offset:65408
    ds_pk_add_bf16 v7, v89 offset:65412
    s_mov_b64 exec, s[50:51]
    s_branch L2_d114
L2_xa115:
    s_cmp_eq_u32 s101, 1
    s_cbranch_scc1 L2_xc115
    v_lshlrev_b32 v89, 0, v96
    v_add_u32 v90, 140, v97
    v_bitop3_b32 v90, v89, v45, v90 bitop3:0x6a
    ds_write_b32 v98, v90 offset:28
    v_lshlrev_b32 v89, 4, v96
    v_add_u32 v90, 120, v97
    v_bitop3_b32 v90, v89, v45, v90 bitop3:0x6a
    ds_write_b32 v98, v90 offset:24
    v_lshlrev_b32 v89, 8, v96
    v_add_u32 v90, 100, v97
    v_bitop3_b32 v90, v89, v45, v90 bitop3:0x6a
    ds_write_b32 v98, v90 offset:20
L2_xc115:
    v_lshlrev_b32 v89, 12, v96
    v_add_u32 v90, 80, v97
    v_bitop3_b32 v90, v89, v45, v90 bitop3:0x6a
    ds_write_b32 v98, v90 offset:16
    s_branch L2_xb115
L2_xe115:
    v_cmp_lt_u32 vcc, 32, v99
    v_cmp_lt_u32 s[58:59], 31, v88
    v_lshrrev_b32 v89, 16, v96
    v_add_u32 v97, 80, v97
    s_or_b64 vcc, vcc, s[58:59]
    s_cbranch_scc1 L2_xs115
    v_lshlrev_b32 v89, v1, v89
    v_and_b32 v89, v45, v89
    v_cmp_ne_u32 vcc, 0, v89
    v_xor_b32 v90, v97, v89
    s_add_u32 s3, s37, s38
    v_mbcnt_lo_u32_b32 v98, vcc_lo, 0
    v_mbcnt_hi_u32_b32 v98, vcc_hi, v98
    s_bcnt1_i32_b64 s41, vcc
    v_lshl_add_u32 v98, v98, 2, s3
    s_mov_b64 exec, vcc
    ds_write_b32 v98, v90
    s_mov_b64 exec, -1
    s_lshl2_add_u32 s37, s41, s37
    s_branch L2_xr115
L2_xf115:
    s_waitcnt lgkmcnt(0)
    s_cmp_gt_u32 s37, 1024
    s_cbranch_scc1 L2_xs115
    v_mov_b32 v43, -1
    s_cmp_ge_u32 s37, 512
    s_cbranch_scc1 L2_xg115
    v_mov_b32 v42, -1
    s_cmp_ge_u32 s37, 256
    s_cbranch_scc1 L2_xg115
    v_mov_b32 v41, -1
    s_branch L2_xg115
L2_xs115:
    s_waitcnt lgkmcnt(0)
    v_mov_b32 v40, -1
    v_mov_b32 v41, -1
    v_mov_b32 v42, -1
    v_mov_b32 v43, -1
    s_add_u32 s3, s42, 2
    s_bitset1_b32 s36, s3
    s_branch L2_xg115
L2_c116:
    s_lshl_b64 s[52:53], s[82:83], 1
    s_andn2_b64 s[52:53], s[52:53], s[80:81]
    s_andn2_b64 s[52:53], s[52:53], s[54:55]
    s_or_b64 s[80:81], s[80:81], s[52:53]
    s_not_b64 vcc, s[52:53]
    s_mov_b64 exec, -1
    v_cndmask_b32_dpp v84, v84, v84, vcc wave_shr:1 row_mask:0xf bank_mask:0xf
    v_cndmask_b32_dpp v85, v85, v85, vcc wave_shr:1 row_mask:0xf bank_mask:0xf
    s_lshr_b64 s[52:53], s[52:53], 1
    v_cndmask_b32_dpp v86, v86, v86, vcc wave_shr:1 row_mask:0xf bank_mask:0xf
    v_cndmask_b32_dpp v87, v87, v87, vcc wave_shr:1 row_mask:0xf bank_mask:0xf
    s_andn2_b64 s[82:83], s[82:83], s[52:53]
    v_cndmask_b32_dpp v7, v7, v7, vcc wave_shr:1 row_mask:0xf bank_mask:0xf
    s_mov_b64 exec, s[54:55]
    s_cbranch_scc0 L2_d116
    s_mov_b64 exec, s[82:83]
    s_nop 1
    v_mfma_f32_4x4x4_16b_bf16 v[88:91], v[12:13], v[84:85], 0
    s_nop 1
    v_mfma_f32_4x4x4_16b_bf16 v[88:91], v[10:11], v[86:87], v[88:91]
    s_nop 4
    v_cvt_pk_bf16_f32 v88, v88, v89
    v_cvt_pk_bf16_f32 v89, v90, v91
    ds_pk_add_bf16 v7, v88 offset:65408
    ds_pk_add_bf16 v7, v89 offset:65412
    s_mov_b64 exec, s[54:55]
    s_branch L2_d116
L2_c117:
    s_lshl_b64 s[52:53], s[82:83], 1
    s_andn2_b64 s[52:53], s[52:53], s[80:81]
    s_andn2_b64 s[52:53], s[52:53], s[50:51]
    s_or_b64 s[80:81], s[80:81], s[52:53]
    s_not_b64 vcc, s[52:53]
    s_mov_b64 exec, -1
    v_cndmask_b32_dpp v84, v84, v84, vcc wave_shr:1 row_mask:0xf bank_mask:0xf
    v_cndmask_b32_dpp v85, v85, v85, vcc wave_shr:1 row_mask:0xf bank_mask:0xf
    s_lshr_b64 s[52:53], s[52:53], 1
    v_cndmask_b32_dpp v86, v86, v86, vcc wave_shr:1 row_mask:0xf bank_mask:0xf
    v_cndmask_b32_dpp v87, v87, v87, vcc wave_shr:1 row_mask:0xf bank_mask:0xf
    s_andn2_b64 s[82:83], s[82:83], s[52:53]
    v_cndmask_b32_dpp v7, v7, v7, vcc wave_shr:1 row_mask:0xf bank_mask:0xf
    s_mov_b64 exec, s[50:51]
    s_cbranch_scc0 L2_d117
    s_mov_b64 exec, s[82:83]
    s_nop 1
    v_mfma_f32_4x4x4_16b_bf16 v[88:91], v[12:13], v[84:85], 0
    s_nop 1
    v_mfma_f32_4x4x4_16b_bf16 v[88:91], v[10:11], v[86:87], v[88:91]
    s_nop 4
    v_cvt_pk_bf16_f32 v88, v88, v89
    v_cvt_pk_bf16_f32 v89, v90, v91
    ds_pk_add_bf16 v7, v88 offset:65408
    ds_pk_add_bf16 v7, v89 offset:65412
    s_mov_b64 exec, s[50:51]
    s_branch L2_d117
L2_c118:
    s_lshl_b64 s[52:53], s[82:83], 1
    s_andn2_b64 s[52:53], s[52:53], s[80:81]
    s_andn2_b64 s[52:53], s[52:53], s[54:55]
    s_or_b64 s[80:81], s[80:81], s[52:53]
    s_not_b64 vcc, s[52:53]
    s_mov_b64 exec, -1
    v_cndmask_b32_dpp v84, v84, v84, vcc wave_shr:1 row_mask:0xf bank_mask:0xf
    v_cndmask_b32_dpp v85, v85, v85, vcc wave_shr:1 row_mask:0xf bank_mask:0xf
    s_lshr_b64 s[52:53], s[52:53], 1
    v_cndmask_b32_dpp v86, v86, v86, vcc wave_shr:1 row_mask:0xf bank_mask:0xf
    v_cndmask_b32_dpp v87, v87, v87, vcc wave_shr:1 row_mask:0xf bank_mask:0xf
    s_andn2_b64 s[82:83], s[82:83], s[52:53]
    v_cndmask_b32_dpp v7, v7, v7, vcc wave_shr:1 row_mask:0xf bank_mask:0xf
    s_mov_b64 exec, s[54:55]
    s_cbranch_scc0 L2_d118
    s_mov_b64 exec, s[82:83]
    s_nop 1
    v_mfma_f32_4x4x4_16b_bf16 v[88:91], v[12:13], v[84:85], 0
    s_nop 1
    v_mfma_f32_4x4x4_16b_bf16 v[88:91], v[10:11], v[86:87], v[88:91]
    s_nop 4
    v_cvt_pk_bf16_f32 v88, v88, v89
    v_cvt_pk_bf16_f32 v89, v90, v91
    ds_pk_add_bf16 v7, v88 offset:65408
    ds_pk_add_bf16 v7, v89 offset:65412
    s_mov_b64 exec, s[54:55]
    s_branch L2_d118
L2_c119:
    s_lshl_b64 s[52:53], s[82:83], 1
    s_andn2_b64 s[52:53], s[52:53], s[80:81]
    s_andn2_b64 s[52:53], s[52:53], s[50:51]
    s_or_b64 s[80:81], s[80:81], s[52:53]
    s_not_b64 vcc, s[52:53]
    s_mov_b64 exec, -1
    v_cndmask_b32_dpp v84, v84, v84, vcc wave_shr:1 row_mask:0xf bank_mask:0xf
    v_cndmask_b32_dpp v85, v85, v85, vcc wave_shr:1 row_mask:0xf bank_mask:0xf
    s_lshr_b64 s[52:53], s[52:53], 1
    v_cndmask_b32_dpp v86, v86, v86, vcc wave_shr:1 row_mask:0xf bank_mask:0xf
    v_cndmask_b32_dpp v87, v87, v87, vcc wave_shr:1 row_mask:0xf bank_mask:0xf
    s_andn2_b64 s[82:83], s[82:83], s[52:53]
    v_cndmask_b32_dpp v7, v7, v7, vcc wave_shr:1 row_mask:0xf bank_mask:0xf
    s_mov_b64 exec, s[50:51]
    s_cbranch_scc0 L2_d119
    s_mov_b64 exec, s[82:83]
    s_nop 1
    v_mfma_f32_4x4x4_16b_bf16 v[88:91], v[12:13], v[84:85], 0
    s_nop 1
    v_mfma_f32_4x4x4_16b_bf16 v[88:91], v[10:11], v[86:87], v[88:91]
    s_nop 4
    v_cvt_pk_bf16_f32 v88, v88, v89
    v_cvt_pk_bf16_f32 v89, v90, v91
    ds_pk_add_bf16 v7, v88 offset:65408
    ds_pk_add_bf16 v7, v89 offset:65412
    s_mov_b64 exec, s[50:51]
    s_branch L2_d119
L2_c120:
    s_lshl_b64 s[52:53], s[82:83], 1
    s_andn2_b64 s[52:53], s[52:53], s[80:81]
    s_andn2_b64 s[52:53], s[52:53], s[54:55]
    s_or_b64 s[80:81], s[80:81], s[52:53]
    s_not_b64 vcc, s[52:53]
    s_mov_b64 exec, -1
    v_cndmask_b32_dpp v84, v84, v84, vcc wave_shr:1 row_mask:0xf bank_mask:0xf
    v_cndmask_b32_dpp v85, v85, v85, vcc wave_shr:1 row_mask:0xf bank_mask:0xf
    s_lshr_b64 s[52:53], s[52:53], 1
    v_cndmask_b32_dpp v86, v86, v86, vcc wave_shr:1 row_mask:0xf bank_mask:0xf
    v_cndmask_b32_dpp v87, v87, v87, vcc wave_shr:1 row_mask:0xf bank_mask:0xf
    s_andn2_b64 s[82:83], s[82:83], s[52:53]
    v_cndmask_b32_dpp v7, v7, v7, vcc wave_shr:1 row_mask:0xf bank_mask:0xf
    s_mov_b64 exec, s[54:55]
    s_cbranch_scc0 L2_d120
    s_mov_b64 exec, s[82:83]
    s_nop 1
    v_mfma_f32_4x4x4_16b_bf16 v[88:91], v[12:13], v[84:85], 0
    s_nop 1
    v_mfma_f32_4x4x4_16b_bf16 v[88:91], v[10:11], v[86:87], v[88:91]
    s_nop 4
    v_cvt_pk_bf16_f32 v88, v88, v89
    v_cvt_pk_bf16_f32 v89, v90, v91
    ds_pk_add_bf16 v7, v88 offset:65408
    ds_pk_add_bf16 v7, v89 offset:65412
    s_mov_b64 exec, s[54:55]
    s_branch L2_d120
L2_c121:
    s_lshl_b64 s[52:53], s[82:83], 1
    s_andn2_b64 s[52:53], s[52:53], s[80:81]
    s_andn2_b64 s[52:53], s[52:53], s[50:51]
    s_or_b64 s[80:81], s[80:81], s[52:53]
    s_not_b64 vcc, s[52:53]
    s_mov_b64 exec, -1
    v_cndmask_b32_dpp v84, v84, v84, vcc wave_shr:1 row_mask:0xf bank_mask:0xf
    v_cndmask_b32_dpp v85, v85, v85, vcc wave_shr:1 row_mask:0xf bank_mask:0xf
    s_lshr_b64 s[52:53], s[52:53], 1
    v_cndmask_b32_dpp v86, v86, v86, vcc wave_shr:1 row_mask:0xf bank_mask:0xf
    v_cndmask_b32_dpp v87, v87, v87, vcc wave_shr:1 row_mask:0xf bank_mask:0xf
    s_andn2_b64 s[82:83], s[82:83], s[52:53]
    v_cndmask_b32_dpp v7, v7, v7, vcc wave_shr:1 row_mask:0xf bank_mask:0xf
    s_mov_b64 exec, s[50:51]
    s_cbranch_scc0 L2_d121
    s_mov_b64 exec, s[82:83]
    s_nop 1
    v_mfma_f32_4x4x4_16b_bf16 v[88:91], v[12:13], v[84:85], 0
    s_nop 1
    v_mfma_f32_4x4x4_16b_bf16 v[88:91], v[10:11], v[86:87], v[88:91]
    s_nop 4
    v_cvt_pk_bf16_f32 v88, v88, v89
    v_cvt_pk_bf16_f32 v89, v90, v91
    ds_pk_add_bf16 v7, v88 offset:65408
    ds_pk_add_bf16 v7, v89 offset:65412
    s_mov_b64 exec, s[50:51]
    s_branch L2_d121
L2_c122:
    s_lshl_b64 s[52:53], s[82:83], 1
    s_andn2_b64 s[52:53], s[52:53], s[80:81]
    s_andn2_b64 s[52:53], s[52:53], s[54:55]
    s_or_b64 s[80:81], s[80:81], s[52:53]
    s_not_b64 vcc, s[52:53]
    s_mov_b64 exec, -1
    v_cndmask_b32_dpp v84, v84, v84, vcc wave_shr:1 row_mask:0xf bank_mask:0xf
    v_cndmask_b32_dpp v85, v85, v85, vcc wave_shr:1 row_mask:0xf bank_mask:0xf
    s_lshr_b64 s[52:53], s[52:53], 1
    v_cndmask_b32_dpp v86, v86, v86, vcc wave_shr:1 row_mask:0xf bank_mask:0xf
    v_cndmask_b32_dpp v87, v87, v87, vcc wave_shr:1 row_mask:0xf bank_mask:0xf
    s_andn2_b64 s[82:83], s[82:83], s[52:53]
    v_cndmask_b32_dpp v7, v7, v7, vcc wave_shr:1 row_mask:0xf bank_mask:0xf
    s_mov_b64 exec, s[54:55]
    s_cbranch_scc0 L2_d122
    s_mov_b64 exec, s[82:83]
    s_nop 1
    v_mfma_f32_4x4x4_16b_bf16 v[88:91], v[12:13], v[84:85], 0
    s_nop 1
    v_mfma_f32_4x4x4_16b_bf16 v[88:91], v[10:11], v[86:87], v[88:91]
    s_nop 4
    v_cvt_pk_bf16_f32 v88, v88, v89
    v_cvt_pk_bf16_f32 v89, v90, v91
    ds_pk_add_bf16 v7, v88 offset:65408
    ds_pk_add_bf16 v7, v89 offset:65412
    s_mov_b64 exec, s[54:55]
    s_branch L2_d122
L2_c123:
    s_lshl_b64 s[52:53], s[82:83], 1
    s_andn2_b64 s[52:53], s[52:53], s[80:81]
    s_andn2_b64 s[52:53], s[52:53], s[50:51]
    s_or_b64 s[80:81], s[80:81], s[52:53]
    s_not_b64 vcc, s[52:53]
    s_mov_b64 exec, -1
    v_cndmask_b32_dpp v84, v84, v84, vcc wave_shr:1 row_mask:0xf bank_mask:0xf
    v_cndmask_b32_dpp v85, v85, v85, vcc wave_shr:1 row_mask:0xf bank_mask:0xf
    s_lshr_b64 s[52:53], s[52:53], 1
    v_cndmask_b32_dpp v86, v86, v86, vcc wave_shr:1 row_mask:0xf bank_mask:0xf
    v_cndmask_b32_dpp v87, v87, v87, vcc wave_shr:1 row_mask:0xf bank_mask:0xf
    s_andn2_b64 s[82:83], s[82:83], s[52:53]
    v_cndmask_b32_dpp v7, v7, v7, vcc wave_shr:1 row_mask:0xf bank_mask:0xf
    s_mov_b64 exec, s[50:51]
    s_cbranch_scc0 L2_d123
    s_mov_b64 exec, s[82:83]
    s_nop 1
    v_mfma_f32_4x4x4_16b_bf16 v[88:91], v[12:13], v[84:85], 0
    s_nop 1
    v_mfma_f32_4x4x4_16b_bf16 v[88:91], v[10:11], v[86:87], v[88:91]
    s_nop 4
    v_cvt_pk_bf16_f32 v88, v88, v89
    v_cvt_pk_bf16_f32 v89, v90, v91
    ds_pk_add_bf16 v7, v88 offset:65408
    ds_pk_add_bf16 v7, v89 offset:65412
    s_mov_b64 exec, s[50:51]
    s_branch L2_d123
L2_c124:
    s_lshl_b64 s[52:53], s[82:83], 1
    s_andn2_b64 s[52:53], s[52:53], s[80:81]
    s_andn2_b64 s[52:53], s[52:53], s[54:55]
    s_or_b64 s[80:81], s[80:81], s[52:53]
    s_not_b64 vcc, s[52:53]
    s_mov_b64 exec, -1
    v_cndmask_b32_dpp v84, v84, v84, vcc wave_shr:1 row_mask:0xf bank_mask:0xf
    v_cndmask_b32_dpp v85, v85, v85, vcc wave_shr:1 row_mask:0xf bank_mask:0xf
    s_lshr_b64 s[52:53], s[52:53], 1
    v_cndmask_b32_dpp v86, v86, v86, vcc wave_shr:1 row_mask:0xf bank_mask:0xf
    v_cndmask_b32_dpp v87, v87, v87, vcc wave_shr:1 row_mask:0xf bank_mask:0xf
    s_andn2_b64 s[82:83], s[82:83], s[52:53]
    v_cndmask_b32_dpp v7, v7, v7, vcc wave_shr:1 row_mask:0xf bank_mask:0xf
    s_mov_b64 exec, s[54:55]
    s_cbranch_scc0 L2_d124
    s_mov_b64 exec, s[82:83]
    s_nop 1
    v_mfma_f32_4x4x4_16b_bf16 v[88:91], v[12:13], v[84:85], 0
    s_nop 1
    v_mfma_f32_4x4x4_16b_bf16 v[88:91], v[10:11], v[86:87], v[88:91]
    s_nop 4
    v_cvt_pk_bf16_f32 v88, v88, v89
    v_cvt_pk_bf16_f32 v89, v90, v91
    ds_pk_add_bf16 v7, v88 offset:65408
    ds_pk_add_bf16 v7, v89 offset:65412
    s_mov_b64 exec, s[54:55]
    s_branch L2_d124
L2_c125:
    s_lshl_b64 s[52:53], s[82:83], 1
    s_andn2_b64 s[52:53], s[52:53], s[80:81]
    s_andn2_b64 s[52:53], s[52:53], s[50:51]
    s_or_b64 s[80:81], s[80:81], s[52:53]
    s_not_b64 vcc, s[52:53]
    s_mov_b64 exec, -1
    v_cndmask_b32_dpp v84, v84, v84, vcc wave_shr:1 row_mask:0xf bank_mask:0xf
    v_cndmask_b32_dpp v85, v85, v85, vcc wave_shr:1 row_mask:0xf bank_mask:0xf
    s_lshr_b64 s[52:53], s[52:53], 1
    v_cndmask_b32_dpp v86, v86, v86, vcc wave_shr:1 row_mask:0xf bank_mask:0xf
    v_cndmask_b32_dpp v87, v87, v87, vcc wave_shr:1 row_mask:0xf bank_mask:0xf
    s_andn2_b64 s[82:83], s[82:83], s[52:53]
    v_cndmask_b32_dpp v7, v7, v7, vcc wave_shr:1 row_mask:0xf bank_mask:0xf
    s_mov_b64 exec, s[50:51]
    s_cbranch_scc0 L2_d125
    s_mov_b64 exec, s[82:83]
    s_nop 1
    v_mfma_f32_4x4x4_16b_bf16 v[88:91], v[12:13], v[84:85], 0
    s_nop 1
    v_mfma_f32_4x4x4_16b_bf16 v[88:91], v[10:11], v[86:87], v[88:91]
    s_nop 4
    v_cvt_pk_bf16_f32 v88, v88, v89
    v_cvt_pk_bf16_f32 v89, v90, v91
    ds_pk_add_bf16 v7, v88 offset:65408
    ds_pk_add_bf16 v7, v89 offset:65412
    s_mov_b64 exec, s[50:51]
    s_branch L2_d125
L2_c126:
    s_lshl_b64 s[52:53], s[82:83], 1
    s_andn2_b64 s[52:53], s[52:53], s[80:81]
    s_andn2_b64 s[52:53], s[52:53], s[54:55]
    s_or_b64 s[80:81], s[80:81], s[52:53]
    s_not_b64 vcc, s[52:53]
    s_mov_b64 exec, -1
    v_cndmask_b32_dpp v84, v84, v84, vcc wave_shr:1 row_mask:0xf bank_mask:0xf
    v_cndmask_b32_dpp v85, v85, v85, vcc wave_shr:1 row_mask:0xf bank_mask:0xf
    s_lshr_b64 s[52:53], s[52:53], 1
    v_cndmask_b32_dpp v86, v86, v86, vcc wave_shr:1 row_mask:0xf bank_mask:0xf
    v_cndmask_b32_dpp v87, v87, v87, vcc wave_shr:1 row_mask:0xf bank_mask:0xf
    s_andn2_b64 s[82:83], s[82:83], s[52:53]
    v_cndmask_b32_dpp v7, v7, v7, vcc wave_shr:1 row_mask:0xf bank_mask:0xf
    s_mov_b64 exec, s[54:55]
    s_cbranch_scc0 L2_d126
    s_mov_b64 exec, s[82:83]
    s_nop 1
    v_mfma_f32_4x4x4_16b_bf16 v[88:91], v[12:13], v[84:85], 0
    s_nop 1
    v_mfma_f32_4x4x4_16b_bf16 v[88:91], v[10:11], v[86:87], v[88:91]
    s_nop 4
    v_cvt_pk_bf16_f32 v88, v88, v89
    v_cvt_pk_bf16_f32 v89, v90, v91
    ds_pk_add_bf16 v7, v88 offset:65408
    ds_pk_add_bf16 v7, v89 offset:65412
    s_mov_b64 exec, s[54:55]
    s_branch L2_d126
L2_c127:
    s_lshl_b64 s[52:53], s[82:83], 1
    s_andn2_b64 s[52:53], s[52:53], s[80:81]
    s_andn2_b64 s[52:53], s[52:53], s[50:51]
    s_or_b64 s[80:81], s[80:81], s[52:53]
    s_not_b64 vcc, s[52:53]
    s_mov_b64 exec, -1
    v_cndmask_b32_dpp v84, v84, v84, vcc wave_shr:1 row_mask:0xf bank_mask:0xf
    v_cndmask_b32_dpp v85, v85, v85, vcc wave_shr:1 row_mask:0xf bank_mask:0xf
    s_lshr_b64 s[52:53], s[52:53], 1
    v_cndmask_b32_dpp v86, v86, v86, vcc wave_shr:1 row_mask:0xf bank_mask:0xf
    v_cndmask_b32_dpp v87, v87, v87, vcc wave_shr:1 row_mask:0xf bank_mask:0xf
    s_andn2_b64 s[82:83], s[82:83], s[52:53]
    v_cndmask_b32_dpp v7, v7, v7, vcc wave_shr:1 row_mask:0xf bank_mask:0xf
    s_mov_b64 exec, s[50:51]
    s_cbranch_scc0 L2_d127
    s_mov_b64 exec, s[82:83]
    s_nop 1
    v_mfma_f32_4x4x4_16b_bf16 v[88:91], v[12:13], v[84:85], 0
    s_nop 1
    v_mfma_f32_4x4x4_16b_bf16 v[88:91], v[10:11], v[86:87], v[88:91]
    s_nop 4
    v_cvt_pk_bf16_f32 v88, v88, v89
    v_cvt_pk_bf16_f32 v89, v90, v91
    ds_pk_add_bf16 v7, v88 offset:65408
    ds_pk_add_bf16 v7, v89 offset:65412
    s_mov_b64 exec, s[50:51]
    s_branch L2_d127
L2_c128:
    s_lshl_b64 s[52:53], s[82:83], 1
    s_andn2_b64 s[52:53], s[52:53], s[80:81]
    s_andn2_b64 s[52:53], s[52:53], s[54:55]
    s_or_b64 s[80:81], s[80:81], s[52:53]
    s_not_b64 vcc, s[52:53]
    s_mov_b64 exec, -1
    v_cndmask_b32_dpp v84, v84, v84, vcc wave_shr:1 row_mask:0xf bank_mask:0xf
    v_cndmask_b32_dpp v85, v85, v85, vcc wave_shr:1 row_mask:0xf bank_mask:0xf
    s_lshr_b64 s[52:53], s[52:53], 1
    v_cndmask_b32_dpp v86, v86, v86, vcc wave_shr:1 row_mask:0xf bank_mask:0xf
    v_cndmask_b32_dpp v87, v87, v87, vcc wave_shr:1 row_mask:0xf bank_mask:0xf
    s_andn2_b64 s[82:83], s[82:83], s[52:53]
    v_cndmask_b32_dpp v7, v7, v7, vcc wave_shr:1 row_mask:0xf bank_mask:0xf
    s_mov_b64 exec, s[54:55]
    s_cbranch_scc0 L2_d128
    s_mov_b64 exec, s[82:83]
    s_nop 1
    v_mfma_f32_4x4x4_16b_bf16 v[88:91], v[12:13], v[84:85], 0
    s_nop 1
    v_mfma_f32_4x4x4_16b_bf16 v[88:91], v[10:11], v[86:87], v[88:91]
    s_nop 4
    v_cvt_pk_bf16_f32 v88, v88, v89
    v_cvt_pk_bf16_f32 v89, v90, v91
    ds_pk_add_bf16 v7, v88 offset:65408
    ds_pk_add_bf16 v7, v89 offset:65412
    s_mov_b64 exec, s[54:55]
    s_branch L2_d128
L2_c129:
    s_lshl_b64 s[52:53], s[82:83], 1
    s_andn2_b64 s[52:53], s[52:53], s[80:81]
    s_andn2_b64 s[52:53], s[52:53], s[50:51]
    s_or_b64 s[80:81], s[80:81], s[52:53]
    s_not_b64 vcc, s[52:53]
    s_mov_b64 exec, -1
    v_cndmask_b32_dpp v84, v84, v84, vcc wave_shr:1 row_mask:0xf bank_mask:0xf
    v_cndmask_b32_dpp v85, v85, v85, vcc wave_shr:1 row_mask:0xf bank_mask:0xf
    s_lshr_b64 s[52:53], s[52:53], 1
    v_cndmask_b32_dpp v86, v86, v86, vcc wave_shr:1 row_mask:0xf bank_mask:0xf
    v_cndmask_b32_dpp v87, v87, v87, vcc wave_shr:1 row_mask:0xf bank_mask:0xf
    s_andn2_b64 s[82:83], s[82:83], s[52:53]
    v_cndmask_b32_dpp v7, v7, v7, vcc wave_shr:1 row_mask:0xf bank_mask:0xf
    s_mov_b64 exec, s[50:51]
    s_cbranch_scc0 L2_d129
    s_mov_b64 exec, s[82:83]
    s_nop 1
    v_mfma_f32_4x4x4_16b_bf16 v[88:91], v[12:13], v[84:85], 0
    s_nop 1
    v_mfma_f32_4x4x4_16b_bf16 v[88:91], v[10:11], v[86:87], v[88:91]
    s_nop 4
    v_cvt_pk_bf16_f32 v88, v88, v89
    v_cvt_pk_bf16_f32 v89, v90, v91
    ds_pk_add_bf16 v7, v88 offset:65408
    ds_pk_add_bf16 v7, v89 offset:65412
    s_mov_b64 exec, s[50:51]
    s_branch L2_d129
L2_c130:
    s_lshl_b64 s[52:53], s[82:83], 1
    s_andn2_b64 s[52:53], s[52:53], s[80:81]
    s_andn2_b64 s[52:53], s[52:53], s[54:55]
    s_or_b64 s[80:81], s[80:81], s[52:53]
    s_not_b64 vcc, s[52:53]
    s_mov_b64 exec, -1
    v_cndmask_b32_dpp v84, v84, v84, vcc wave_shr:1 row_mask:0xf bank_mask:0xf
    v_cndmask_b32_dpp v85, v85, v85, vcc wave_shr:1 row_mask:0xf bank_mask:0xf
    s_lshr_b64 s[52:53], s[52:53], 1
    v_cndmask_b32_dpp v86, v86, v86, vcc wave_shr:1 row_mask:0xf bank_mask:0xf
    v_cndmask_b32_dpp v87, v87, v87, vcc wave_shr:1 row_mask:0xf bank_mask:0xf
    s_andn2_b64 s[82:83], s[82:83], s[52:53]
    v_cndmask_b32_dpp v7, v7, v7, vcc wave_shr:1 row_mask:0xf bank_mask:0xf
    s_mov_b64 exec, s[54:55]
    s_cbranch_scc0 L2_d130
    s_mov_b64 exec, s[82:83]
    s_nop 1
    v_mfma_f32_4x4x4_16b_bf16 v[88:91], v[12:13], v[84:85], 0
    s_nop 1
    v_mfma_f32_4x4x4_16b_bf16 v[88:91], v[10:11], v[86:87], v[88:91]
    s_nop 4
    v_cvt_pk_bf16_f32 v88, v88, v89
    v_cvt_pk_bf16_f32 v89, v90, v91
    ds_pk_add_bf16 v7, v88 offset:65408
    ds_pk_add_bf16 v7, v89 offset:65412
    s_mov_b64 exec, s[54:55]
    s_branch L2_d130
L2_c131:
    s_lshl_b64 s[52:53], s[82:83], 1
    s_andn2_b64 s[52:53], s[52:53], s[80:81]
    s_andn2_b64 s[52:53], s[52:53], s[50:51]
    s_or_b64 s[80:81], s[80:81], s[52:53]
    s_not_b64 vcc, s[52:53]
    s_mov_b64 exec, -1
    v_cndmask_b32_dpp v84, v84, v84, vcc wave_shr:1 row_mask:0xf bank_mask:0xf
    v_cndmask_b32_dpp v85, v85, v85, vcc wave_shr:1 row_mask:0xf bank_mask:0xf
    s_lshr_b64 s[52:53], s[52:53], 1
    v_cndmask_b32_dpp v86, v86, v86, vcc wave_shr:1 row_mask:0xf bank_mask:0xf
    v_cndmask_b32_dpp v87, v87, v87, vcc wave_shr:1 row_mask:0xf bank_mask:0xf
    s_andn2_b64 s[82:83], s[82:83], s[52:53]
    v_cndmask_b32_dpp v7, v7, v7, vcc wave_shr:1 row_mask:0xf bank_mask:0xf
    s_mov_b64 exec, s[50:51]
    s_cbranch_scc0 L2_d131
    s_mov_b64 exec, s[82:83]
    s_nop 1
    v_mfma_f32_4x4x4_16b_bf16 v[88:91], v[12:13], v[84:85], 0
    s_nop 1
    v_mfma_f32_4x4x4_16b_bf16 v[88:91], v[10:11], v[86:87], v[88:91]
    s_nop 4
    v_cvt_pk_bf16_f32 v88, v88, v89
    v_cvt_pk_bf16_f32 v89, v90, v91
    ds_pk_add_bf16 v7, v88 offset:65408
    ds_pk_add_bf16 v7, v89 offset:65412
    s_mov_b64 exec, s[50:51]
    s_branch L2_d131
L2_c132:
    s_lshl_b64 s[52:53], s[82:83], 1
    s_andn2_b64 s[52:53], s[52:53], s[80:81]
    s_andn2_b64 s[52:53], s[52:53], s[54:55]
    s_or_b64 s[80:81], s[80:81], s[52:53]
    s_not_b64 vcc, s[52:53]
    s_mov_b64 exec, -1
    v_cndmask_b32_dpp v84, v84, v84, vcc wave_shr:1 row_mask:0xf bank_mask:0xf
    v_cndmask_b32_dpp v85, v85, v85, vcc wave_shr:1 row_mask:0xf bank_mask:0xf
    s_lshr_b64 s[52:53], s[52:53], 1
    v_cndmask_b32_dpp v86, v86, v86, vcc wave_shr:1 row_mask:0xf bank_mask:0xf
    v_cndmask_b32_dpp v87, v87, v87, vcc wave_shr:1 row_mask:0xf bank_mask:0xf
    s_andn2_b64 s[82:83], s[82:83], s[52:53]
    v_cndmask_b32_dpp v7, v7, v7, vcc wave_shr:1 row_mask:0xf bank_mask:0xf
    s_mov_b64 exec, s[54:55]
    s_cbranch_scc0 L2_d132
    s_mov_b64 exec, s[82:83]
    s_nop 1
    v_mfma_f32_4x4x4_16b_bf16 v[88:91], v[12:13], v[84:85], 0
    s_nop 1
    v_mfma_f32_4x4x4_16b_bf16 v[88:91], v[10:11], v[86:87], v[88:91]
    s_nop 4
    v_cvt_pk_bf16_f32 v88, v88, v89
    v_cvt_pk_bf16_f32 v89, v90, v91
    ds_pk_add_bf16 v7, v88 offset:65408
    ds_pk_add_bf16 v7, v89 offset:65412
    s_mov_b64 exec, s[54:55]
    s_branch L2_d132
L2_c133:
    s_lshl_b64 s[52:53], s[82:83], 1
    s_andn2_b64 s[52:53], s[52:53], s[80:81]
    s_andn2_b64 s[52:53], s[52:53], s[50:51]
    s_or_b64 s[80:81], s[80:81], s[52:53]
    s_not_b64 vcc, s[52:53]
    s_mov_b64 exec, -1
    v_cndmask_b32_dpp v84, v84, v84, vcc wave_shr:1 row_mask:0xf bank_mask:0xf
    v_cndmask_b32_dpp v85, v85, v85, vcc wave_shr:1 row_mask:0xf bank_mask:0xf
    s_lshr_b64 s[52:53], s[52:53], 1
    v_cndmask_b32_dpp v86, v86, v86, vcc wave_shr:1 row_mask:0xf bank_mask:0xf
    v_cndmask_b32_dpp v87, v87, v87, vcc wave_shr:1 row_mask:0xf bank_mask:0xf
    s_andn2_b64 s[82:83], s[82:83], s[52:53]
    v_cndmask_b32_dpp v7, v7, v7, vcc wave_shr:1 row_mask:0xf bank_mask:0xf
    s_mov_b64 exec, s[50:51]
    s_cbranch_scc0 L2_d133
    s_mov_b64 exec, s[82:83]
    s_nop 1
    v_mfma_f32_4x4x4_16b_bf16 v[88:91], v[12:13], v[84:85], 0
    s_nop 1
    v_mfma_f32_4x4x4_16b_bf16 v[88:91], v[10:11], v[86:87], v[88:91]
    s_nop 4
    v_cvt_pk_bf16_f32 v88, v88, v89
    v_cvt_pk_bf16_f32 v89, v90, v91
    ds_pk_add_bf16 v7, v88 offset:65408
    ds_pk_add_bf16 v7, v89 offset:65412
    s_mov_b64 exec, s[50:51]
    s_branch L2_d133
L2_c134:
    s_lshl_b64 s[52:53], s[82:83], 1
    s_andn2_b64 s[52:53], s[52:53], s[80:81]
    s_andn2_b64 s[52:53], s[52:53], s[54:55]
    s_or_b64 s[80:81], s[80:81], s[52:53]
    s_not_b64 vcc, s[52:53]
    s_mov_b64 exec, -1
    v_cndmask_b32_dpp v84, v84, v84, vcc wave_shr:1 row_mask:0xf bank_mask:0xf
    v_cndmask_b32_dpp v85, v85, v85, vcc wave_shr:1 row_mask:0xf bank_mask:0xf
    s_lshr_b64 s[52:53], s[52:53], 1
    v_cndmask_b32_dpp v86, v86, v86, vcc wave_shr:1 row_mask:0xf bank_mask:0xf
    v_cndmask_b32_dpp v87, v87, v87, vcc wave_shr:1 row_mask:0xf bank_mask:0xf
    s_andn2_b64 s[82:83], s[82:83], s[52:53]
    v_cndmask_b32_dpp v7, v7, v7, vcc wave_shr:1 row_mask:0xf bank_mask:0xf
    s_mov_b64 exec, s[54:55]
    s_cbranch_scc0 L2_d134
    s_mov_b64 exec, s[82:83]
    s_nop 1
    v_mfma_f32_4x4x4_16b_bf16 v[88:91], v[12:13], v[84:85], 0
    s_nop 1
    v_mfma_f32_4x4x4_16b_bf16 v[88:91], v[10:11], v[86:87], v[88:91]
    s_nop 4
    v_cvt_pk_bf16_f32 v88, v88, v89
    v_cvt_pk_bf16_f32 v89, v90, v91
    ds_pk_add_bf16 v7, v88 offset:65408
    ds_pk_add_bf16 v7, v89 offset:65412
    s_mov_b64 exec, s[54:55]
    s_branch L2_d134
L2_c135:
    s_lshl_b64 s[52:53], s[82:83], 1
    s_andn2_b64 s[52:53], s[52:53], s[80:81]
    s_andn2_b64 s[52:53], s[52:53], s[50:51]
    s_or_b64 s[80:81], s[80:81], s[52:53]
    s_not_b64 vcc, s[52:53]
    s_mov_b64 exec, -1
    v_cndmask_b32_dpp v84, v84, v84, vcc wave_shr:1 row_mask:0xf bank_mask:0xf
    v_cndmask_b32_dpp v85, v85, v85, vcc wave_shr:1 row_mask:0xf bank_mask:0xf
    s_lshr_b64 s[52:53], s[52:53], 1
    v_cndmask_b32_dpp v86, v86, v86, vcc wave_shr:1 row_mask:0xf bank_mask:0xf
    v_cndmask_b32_dpp v87, v87, v87, vcc wave_shr:1 row_mask:0xf bank_mask:0xf
    s_andn2_b64 s[82:83], s[82:83], s[52:53]
    v_cndmask_b32_dpp v7, v7, v7, vcc wave_shr:1 row_mask:0xf bank_mask:0xf
    s_mov_b64 exec, s[50:51]
    s_cbranch_scc0 L2_d135
    s_mov_b64 exec, s[82:83]
    s_nop 1
    v_mfma_f32_4x4x4_16b_bf16 v[88:91], v[12:13], v[84:85], 0
    s_nop 1
    v_mfma_f32_4x4x4_16b_bf16 v[88:91], v[10:11], v[86:87], v[88:91]
    s_nop 4
    v_cvt_pk_bf16_f32 v88, v88, v89
    v_cvt_pk_bf16_f32 v89, v90, v91
    ds_pk_add_bf16 v7, v88 offset:65408
    ds_pk_add_bf16 v7, v89 offset:65412
    s_mov_b64 exec, s[50:51]
    s_branch L2_d135
L2_c136:
    s_lshl_b64 s[52:53], s[82:83], 1
    s_andn2_b64 s[52:53], s[52:53], s[80:81]
    s_andn2_b64 s[52:53], s[52:53], s[54:55]
    s_or_b64 s[80:81], s[80:81], s[52:53]
    s_not_b64 vcc, s[52:53]
    s_mov_b64 exec, -1
    v_cndmask_b32_dpp v84, v84, v84, vcc wave_shr:1 row_mask:0xf bank_mask:0xf
    v_cndmask_b32_dpp v85, v85, v85, vcc wave_shr:1 row_mask:0xf bank_mask:0xf
    s_lshr_b64 s[52:53], s[52:53], 1
    v_cndmask_b32_dpp v86, v86, v86, vcc wave_shr:1 row_mask:0xf bank_mask:0xf
    v_cndmask_b32_dpp v87, v87, v87, vcc wave_shr:1 row_mask:0xf bank_mask:0xf
    s_andn2_b64 s[82:83], s[82:83], s[52:53]
    v_cndmask_b32_dpp v7, v7, v7, vcc wave_shr:1 row_mask:0xf bank_mask:0xf
    s_mov_b64 exec, s[54:55]
    s_cbranch_scc0 L2_d136
    s_mov_b64 exec, s[82:83]
    s_nop 1
    v_mfma_f32_4x4x4_16b_bf16 v[88:91], v[12:13], v[84:85], 0
    s_nop 1
    v_mfma_f32_4x4x4_16b_bf16 v[88:91], v[10:11], v[86:87], v[88:91]
    s_nop 4
    v_cvt_pk_bf16_f32 v88, v88, v89
    v_cvt_pk_bf16_f32 v89, v90, v91
    ds_pk_add_bf16 v7, v88 offset:65408
    ds_pk_add_bf16 v7, v89 offset:65412
    s_mov_b64 exec, s[54:55]
    s_branch L2_d136
L2_c137:
    s_lshl_b64 s[52:53], s[82:83], 1
    s_andn2_b64 s[52:53], s[52:53], s[80:81]
    s_andn2_b64 s[52:53], s[52:53], s[50:51]
    s_or_b64 s[80:81], s[80:81], s[52:53]
    s_not_b64 vcc, s[52:53]
    s_mov_b64 exec, -1
    v_cndmask_b32_dpp v84, v84, v84, vcc wave_shr:1 row_mask:0xf bank_mask:0xf
    v_cndmask_b32_dpp v85, v85, v85, vcc wave_shr:1 row_mask:0xf bank_mask:0xf
    s_lshr_b64 s[52:53], s[52:53], 1
    v_cndmask_b32_dpp v86, v86, v86, vcc wave_shr:1 row_mask:0xf bank_mask:0xf
    v_cndmask_b32_dpp v87, v87, v87, vcc wave_shr:1 row_mask:0xf bank_mask:0xf
    s_andn2_b64 s[82:83], s[82:83], s[52:53]
    v_cndmask_b32_dpp v7, v7, v7, vcc wave_shr:1 row_mask:0xf bank_mask:0xf
    s_mov_b64 exec, s[50:51]
    s_cbranch_scc0 L2_d137
    s_mov_b64 exec, s[82:83]
    s_nop 1
    v_mfma_f32_4x4x4_16b_bf16 v[88:91], v[12:13], v[84:85], 0
    s_nop 1
    v_mfma_f32_4x4x4_16b_bf16 v[88:91], v[10:11], v[86:87], v[88:91]
    s_nop 4
    v_cvt_pk_bf16_f32 v88, v88, v89
    v_cvt_pk_bf16_f32 v89, v90, v91
    ds_pk_add_bf16 v7, v88 offset:65408
    ds_pk_add_bf16 v7, v89 offset:65412
    s_mov_b64 exec, s[50:51]
    s_branch L2_d137
L2_c138:
    s_lshl_b64 s[52:53], s[82:83], 1
    s_andn2_b64 s[52:53], s[52:53], s[80:81]
    s_andn2_b64 s[52:53], s[52:53], s[54:55]
    s_or_b64 s[80:81], s[80:81], s[52:53]
    s_not_b64 vcc, s[52:53]
    s_mov_b64 exec, -1
    v_cndmask_b32_dpp v84, v84, v84, vcc wave_shr:1 row_mask:0xf bank_mask:0xf
    v_cndmask_b32_dpp v85, v85, v85, vcc wave_shr:1 row_mask:0xf bank_mask:0xf
    s_lshr_b64 s[52:53], s[52:53], 1
    v_cndmask_b32_dpp v86, v86, v86, vcc wave_shr:1 row_mask:0xf bank_mask:0xf
    v_cndmask_b32_dpp v87, v87, v87, vcc wave_shr:1 row_mask:0xf bank_mask:0xf
    s_andn2_b64 s[82:83], s[82:83], s[52:53]
    v_cndmask_b32_dpp v7, v7, v7, vcc wave_shr:1 row_mask:0xf bank_mask:0xf
    s_mov_b64 exec, s[54:55]
    s_cbranch_scc0 L2_d138
    s_mov_b64 exec, s[82:83]
    s_nop 1
    v_mfma_f32_4x4x4_16b_bf16 v[88:91], v[12:13], v[84:85], 0
    s_nop 1
    v_mfma_f32_4x4x4_16b_bf16 v[88:91], v[10:11], v[86:87], v[88:91]
    s_nop 4
    v_cvt_pk_bf16_f32 v88, v88, v89
    v_cvt_pk_bf16_f32 v89, v90, v91
    ds_pk_add_bf16 v7, v88 offset:65408
    ds_pk_add_bf16 v7, v89 offset:65412
    s_mov_b64 exec, s[54:55]
    s_branch L2_d138
L2_c139:
    s_lshl_b64 s[52:53], s[82:83], 1
    s_andn2_b64 s[52:53], s[52:53], s[80:81]
    s_andn2_b64 s[52:53], s[52:53], s[50:51]
    s_or_b64 s[80:81], s[80:81], s[52:53]
    s_not_b64 vcc, s[52:53]
    s_mov_b64 exec, -1
    v_cndmask_b32_dpp v84, v84, v84, vcc wave_shr:1 row_mask:0xf bank_mask:0xf
    v_cndmask_b32_dpp v85, v85, v85, vcc wave_shr:1 row_mask:0xf bank_mask:0xf
    s_lshr_b64 s[52:53], s[52:53], 1
    v_cndmask_b32_dpp v86, v86, v86, vcc wave_shr:1 row_mask:0xf bank_mask:0xf
    v_cndmask_b32_dpp v87, v87, v87, vcc wave_shr:1 row_mask:0xf bank_mask:0xf
    s_andn2_b64 s[82:83], s[82:83], s[52:53]
    v_cndmask_b32_dpp v7, v7, v7, vcc wave_shr:1 row_mask:0xf bank_mask:0xf
    s_mov_b64 exec, s[50:51]
    s_cbranch_scc0 L2_d139
    s_mov_b64 exec, s[82:83]
    s_nop 1
    v_mfma_f32_4x4x4_16b_bf16 v[88:91], v[12:13], v[84:85], 0
    s_nop 1
    v_mfma_f32_4x4x4_16b_bf16 v[88:91], v[10:11], v[86:87], v[88:91]
    s_nop 4
    v_cvt_pk_bf16_f32 v88, v88, v89
    v_cvt_pk_bf16_f32 v89, v90, v91
    ds_pk_add_bf16 v7, v88 offset:65408
    ds_pk_add_bf16 v7, v89 offset:65412
    s_mov_b64 exec, s[50:51]
    s_branch L2_d139
L2_c140:
    s_lshl_b64 s[52:53], s[82:83], 1
    s_andn2_b64 s[52:53], s[52:53], s[80:81]
    s_andn2_b64 s[52:53], s[52:53], s[54:55]
    s_or_b64 s[80:81], s[80:81], s[52:53]
    s_not_b64 vcc, s[52:53]
    s_mov_b64 exec, -1
    v_cndmask_b32_dpp v84, v84, v84, vcc wave_shr:1 row_mask:0xf bank_mask:0xf
    v_cndmask_b32_dpp v85, v85, v85, vcc wave_shr:1 row_mask:0xf bank_mask:0xf
    s_lshr_b64 s[52:53], s[52:53], 1
    v_cndmask_b32_dpp v86, v86, v86, vcc wave_shr:1 row_mask:0xf bank_mask:0xf
    v_cndmask_b32_dpp v87, v87, v87, vcc wave_shr:1 row_mask:0xf bank_mask:0xf
    s_andn2_b64 s[82:83], s[82:83], s[52:53]
    v_cndmask_b32_dpp v7, v7, v7, vcc wave_shr:1 row_mask:0xf bank_mask:0xf
    s_mov_b64 exec, s[54:55]
    s_cbranch_scc0 L2_d140
    s_mov_b64 exec, s[82:83]
    s_nop 1
    v_mfma_f32_4x4x4_16b_bf16 v[88:91], v[12:13], v[84:85], 0
    s_nop 1
    v_mfma_f32_4x4x4_16b_bf16 v[88:91], v[10:11], v[86:87], v[88:91]
    s_nop 4
    v_cvt_pk_bf16_f32 v88, v88, v89
    v_cvt_pk_bf16_f32 v89, v90, v91
    ds_pk_add_bf16 v7, v88 offset:65408
    ds_pk_add_bf16 v7, v89 offset:65412
    s_mov_b64 exec, s[54:55]
    s_branch L2_d140
L2_c141:
    s_lshl_b64 s[52:53], s[82:83], 1
    s_andn2_b64 s[52:53], s[52:53], s[80:81]
    s_andn2_b64 s[52:53], s[52:53], s[50:51]
    s_or_b64 s[80:81], s[80:81], s[52:53]
    s_not_b64 vcc, s[52:53]
    s_mov_b64 exec, -1
    v_cndmask_b32_dpp v84, v84, v84, vcc wave_shr:1 row_mask:0xf bank_mask:0xf
    v_cndmask_b32_dpp v85, v85, v85, vcc wave_shr:1 row_mask:0xf bank_mask:0xf
    s_lshr_b64 s[52:53], s[52:53], 1
    v_cndmask_b32_dpp v86, v86, v86, vcc wave_shr:1 row_mask:0xf bank_mask:0xf
    v_cndmask_b32_dpp v87, v87, v87, vcc wave_shr:1 row_mask:0xf bank_mask:0xf
    s_andn2_b64 s[82:83], s[82:83], s[52:53]
    v_cndmask_b32_dpp v7, v7, v7, vcc wave_shr:1 row_mask:0xf bank_mask:0xf
    s_mov_b64 exec, s[50:51]
    s_cbranch_scc0 L2_d141
    s_mov_b64 exec, s[82:83]
    s_nop 1
    v_mfma_f32_4x4x4_16b_bf16 v[88:91], v[12:13], v[84:85], 0
    s_nop 1
    v_mfma_f32_4x4x4_16b_bf16 v[88:91], v[10:11], v[86:87], v[88:91]
    s_nop 4
    v_cvt_pk_bf16_f32 v88, v88, v89
    v_cvt_pk_bf16_f32 v89, v90, v91
    ds_pk_add_bf16 v7, v88 offset:65408
    ds_pk_add_bf16 v7, v89 offset:65412
    s_mov_b64 exec, s[50:51]
    s_branch L2_d141
L2_c142:
    s_lshl_b64 s[52:53], s[82:83], 1
    s_andn2_b64 s[52:53], s[52:53], s[80:81]
    s_andn2_b64 s[52:53], s[52:53], s[54:55]
    s_or_b64 s[80:81], s[80:81], s[52:53]
    s_not_b64 vcc, s[52:53]
    s_mov_b64 exec, -1
    v_cndmask_b32_dpp v84, v84, v84, vcc wave_shr:1 row_mask:0xf bank_mask:0xf
    v_cndmask_b32_dpp v85, v85, v85, vcc wave_shr:1 row_mask:0xf bank_mask:0xf
    s_lshr_b64 s[52:53], s[52:53], 1
    v_cndmask_b32_dpp v86, v86, v86, vcc wave_shr:1 row_mask:0xf bank_mask:0xf
    v_cndmask_b32_dpp v87, v87, v87, vcc wave_shr:1 row_mask:0xf bank_mask:0xf
    s_andn2_b64 s[82:83], s[82:83], s[52:53]
    v_cndmask_b32_dpp v7, v7, v7, vcc wave_shr:1 row_mask:0xf bank_mask:0xf
    s_mov_b64 exec, s[54:55]
    s_cbranch_scc0 L2_d142
    s_mov_b64 exec, s[82:83]
    s_nop 1
    v_mfma_f32_4x4x4_16b_bf16 v[88:91], v[12:13], v[84:85], 0
    s_nop 1
    v_mfma_f32_4x4x4_16b_bf16 v[88:91], v[10:11], v[86:87], v[88:91]
    s_nop 4
    v_cvt_pk_bf16_f32 v88, v88, v89
    v_cvt_pk_bf16_f32 v89, v90, v91
    ds_pk_add_bf16 v7, v88 offset:65408
    ds_pk_add_bf16 v7, v89 offset:65412
    s_mov_b64 exec, s[54:55]
    s_branch L2_d142
L2_c143:
    s_lshl_b64 s[52:53], s[82:83], 1
    s_andn2_b64 s[52:53], s[52:53], s[80:81]
    s_andn2_b64 s[52:53], s[52:53], s[50:51]
    s_or_b64 s[80:81], s[80:81], s[52:53]
    s_not_b64 vcc, s[52:53]
    s_mov_b64 exec, -1
    v_cndmask_b32_dpp v84, v84, v84, vcc wave_shr:1 row_mask:0xf bank_mask:0xf
    v_cndmask_b32_dpp v85, v85, v85, vcc wave_shr:1 row_mask:0xf bank_mask:0xf
    s_lshr_b64 s[52:53], s[52:53], 1
    v_cndmask_b32_dpp v86, v86, v86, vcc wave_shr:1 row_mask:0xf bank_mask:0xf
    v_cndmask_b32_dpp v87, v87, v87, vcc wave_shr:1 row_mask:0xf bank_mask:0xf
    s_andn2_b64 s[82:83], s[82:83], s[52:53]
    v_cndmask_b32_dpp v7, v7, v7, vcc wave_shr:1 row_mask:0xf bank_mask:0xf
    s_mov_b64 exec, s[50:51]
    s_cbranch_scc0 L2_d143
    s_mov_b64 exec, s[82:83]
    s_nop 1
    v_mfma_f32_4x4x4_16b_bf16 v[88:91], v[12:13], v[84:85], 0
    s_nop 1
    v_mfma_f32_4x4x4_16b_bf16 v[88:91], v[10:11], v[86:87], v[88:91]
    s_nop 4
    v_cvt_pk_bf16_f32 v88, v88, v89
    v_cvt_pk_bf16_f32 v89, v90, v91
    ds_pk_add_bf16 v7, v88 offset:65408
    ds_pk_add_bf16 v7, v89 offset:65412
    s_mov_b64 exec, s[50:51]
    s_branch L2_d143
L2_c144:
    s_lshl_b64 s[52:53], s[82:83], 1
    s_andn2_b64 s[52:53], s[52:53], s[80:81]
    s_andn2_b64 s[52:53], s[52:53], s[54:55]
    s_or_b64 s[80:81], s[80:81], s[52:53]
    s_not_b64 vcc, s[52:53]
    s_mov_b64 exec, -1
    v_cndmask_b32_dpp v84, v84, v84, vcc wave_shr:1 row_mask:0xf bank_mask:0xf
    v_cndmask_b32_dpp v85, v85, v85, vcc wave_shr:1 row_mask:0xf bank_mask:0xf
    s_lshr_b64 s[52:53], s[52:53], 1
    v_cndmask_b32_dpp v86, v86, v86, vcc wave_shr:1 row_mask:0xf bank_mask:0xf
    v_cndmask_b32_dpp v87, v87, v87, vcc wave_shr:1 row_mask:0xf bank_mask:0xf
    s_andn2_b64 s[82:83], s[82:83], s[52:53]
    v_cndmask_b32_dpp v7, v7, v7, vcc wave_shr:1 row_mask:0xf bank_mask:0xf
    s_mov_b64 exec, s[54:55]
    s_cbranch_scc0 L2_d144
    s_mov_b64 exec, s[82:83]
    s_nop 1
    v_mfma_f32_4x4x4_16b_bf16 v[88:91], v[12:13], v[84:85], 0
    s_nop 1
    v_mfma_f32_4x4x4_16b_bf16 v[88:91], v[10:11], v[86:87], v[88:91]
    s_nop 4
    v_cvt_pk_bf16_f32 v88, v88, v89
    v_cvt_pk_bf16_f32 v89, v90, v91
    ds_pk_add_bf16 v7, v88 offset:65408
    ds_pk_add_bf16 v7, v89 offset:65412
    s_mov_b64 exec, s[54:55]
    s_branch L2_d144
L2_c145:
    s_lshl_b64 s[52:53], s[82:83], 1
    s_andn2_b64 s[52:53], s[52:53], s[80:81]
    s_andn2_b64 s[52:53], s[52:53], s[50:51]
    s_or_b64 s[80:81], s[80:81], s[52:53]
    s_not_b64 vcc, s[52:53]
    s_mov_b64 exec, -1
    v_cndmask_b32_dpp v84, v84, v84, vcc wave_shr:1 row_mask:0xf bank_mask:0xf
    v_cndmask_b32_dpp v85, v85, v85, vcc wave_shr:1 row_mask:0xf bank_mask:0xf
    s_lshr_b64 s[52:53], s[52:53], 1
    v_cndmask_b32_dpp v86, v86, v86, vcc wave_shr:1 row_mask:0xf bank_mask:0xf
    v_cndmask_b32_dpp v87, v87, v87, vcc wave_shr:1 row_mask:0xf bank_mask:0xf
    s_andn2_b64 s[82:83], s[82:83], s[52:53]
    v_cndmask_b32_dpp v7, v7, v7, vcc wave_shr:1 row_mask:0xf bank_mask:0xf
    s_mov_b64 exec, s[50:51]
    s_cbranch_scc0 L2_d145
    s_mov_b64 exec, s[82:83]
    s_nop 1
    v_mfma_f32_4x4x4_16b_bf16 v[88:91], v[12:13], v[84:85], 0
    s_nop 1
    v_mfma_f32_4x4x4_16b_bf16 v[88:91], v[10:11], v[86:87], v[88:91]
    s_nop 4
    v_cvt_pk_bf16_f32 v88, v88, v89
    v_cvt_pk_bf16_f32 v89, v90, v91
    ds_pk_add_bf16 v7, v88 offset:65408
    ds_pk_add_bf16 v7, v89 offset:65412
    s_mov_b64 exec, s[50:51]
    s_branch L2_d145
L2_c146:
    s_lshl_b64 s[52:53], s[82:83], 1
    s_andn2_b64 s[52:53], s[52:53], s[80:81]
    s_andn2_b64 s[52:53], s[52:53], s[54:55]
    s_or_b64 s[80:81], s[80:81], s[52:53]
    s_not_b64 vcc, s[52:53]
    s_mov_b64 exec, -1
    v_cndmask_b32_dpp v84, v84, v84, vcc wave_shr:1 row_mask:0xf bank_mask:0xf
    v_cndmask_b32_dpp v85, v85, v85, vcc wave_shr:1 row_mask:0xf bank_mask:0xf
    s_lshr_b64 s[52:53], s[52:53], 1
    v_cndmask_b32_dpp v86, v86, v86, vcc wave_shr:1 row_mask:0xf bank_mask:0xf
    v_cndmask_b32_dpp v87, v87, v87, vcc wave_shr:1 row_mask:0xf bank_mask:0xf
    s_andn2_b64 s[82:83], s[82:83], s[52:53]
    v_cndmask_b32_dpp v7, v7, v7, vcc wave_shr:1 row_mask:0xf bank_mask:0xf
    s_mov_b64 exec, s[54:55]
    s_cbranch_scc0 L2_d146
    s_mov_b64 exec, s[82:83]
    s_nop 1
    v_mfma_f32_4x4x4_16b_bf16 v[88:91], v[12:13], v[84:85], 0
    s_nop 1
    v_mfma_f32_4x4x4_16b_bf16 v[88:91], v[10:11], v[86:87], v[88:91]
    s_nop 4
    v_cvt_pk_bf16_f32 v88, v88, v89
    v_cvt_pk_bf16_f32 v89, v90, v91
    ds_pk_add_bf16 v7, v88 offset:65408
    ds_pk_add_bf16 v7, v89 offset:65412
    s_mov_b64 exec, s[54:55]
    s_branch L2_d146
L2_c147:
    s_lshl_b64 s[52:53], s[82:83], 1
    s_andn2_b64 s[52:53], s[52:53], s[80:81]
    s_andn2_b64 s[52:53], s[52:53], s[50:51]
    s_or_b64 s[80:81], s[80:81], s[52:53]
    s_not_b64 vcc, s[52:53]
    s_mov_b64 exec, -1
    v_cndmask_b32_dpp v84, v84, v84, vcc wave_shr:1 row_mask:0xf bank_mask:0xf
    v_cndmask_b32_dpp v85, v85, v85, vcc wave_shr:1 row_mask:0xf bank_mask:0xf
    s_lshr_b64 s[52:53], s[52:53], 1
    v_cndmask_b32_dpp v86, v86, v86, vcc wave_shr:1 row_mask:0xf bank_mask:0xf
    v_cndmask_b32_dpp v87, v87, v87, vcc wave_shr:1 row_mask:0xf bank_mask:0xf
    s_andn2_b64 s[82:83], s[82:83], s[52:53]
    v_cndmask_b32_dpp v7, v7, v7, vcc wave_shr:1 row_mask:0xf bank_mask:0xf
    s_mov_b64 exec, s[50:51]
    s_cbranch_scc0 L2_d147
    s_mov_b64 exec, s[82:83]
    s_nop 1
    v_mfma_f32_4x4x4_16b_bf16 v[88:91], v[12:13], v[84:85], 0
    s_nop 1
    v_mfma_f32_4x4x4_16b_bf16 v[88:91], v[10:11], v[86:87], v[88:91]
    s_nop 4
    v_cvt_pk_bf16_f32 v88, v88, v89
    v_cvt_pk_bf16_f32 v89, v90, v91
    ds_pk_add_bf16 v7, v88 offset:65408
    ds_pk_add_bf16 v7, v89 offset:65412
    s_mov_b64 exec, s[50:51]
    s_branch L2_d147
L2_c148:
    s_lshl_b64 s[52:53], s[82:83], 1
    s_andn2_b64 s[52:53], s[52:53], s[80:81]
    s_andn2_b64 s[52:53], s[52:53], s[54:55]
    s_or_b64 s[80:81], s[80:81], s[52:53]
    s_not_b64 vcc, s[52:53]
    s_mov_b64 exec, -1
    v_cndmask_b32_dpp v84, v84, v84, vcc wave_shr:1 row_mask:0xf bank_mask:0xf
    v_cndmask_b32_dpp v85, v85, v85, vcc wave_shr:1 row_mask:0xf bank_mask:0xf
    s_lshr_b64 s[52:53], s[52:53], 1
    v_cndmask_b32_dpp v86, v86, v86, vcc wave_shr:1 row_mask:0xf bank_mask:0xf
    v_cndmask_b32_dpp v87, v87, v87, vcc wave_shr:1 row_mask:0xf bank_mask:0xf
    s_andn2_b64 s[82:83], s[82:83], s[52:53]
    v_cndmask_b32_dpp v7, v7, v7, vcc wave_shr:1 row_mask:0xf bank_mask:0xf
    s_mov_b64 exec, s[54:55]
    s_cbranch_scc0 L2_d148
    s_mov_b64 exec, s[82:83]
    s_nop 1
    v_mfma_f32_4x4x4_16b_bf16 v[88:91], v[12:13], v[84:85], 0
    s_nop 1
    v_mfma_f32_4x4x4_16b_bf16 v[88:91], v[10:11], v[86:87], v[88:91]
    s_nop 4
    v_cvt_pk_bf16_f32 v88, v88, v89
    v_cvt_pk_bf16_f32 v89, v90, v91
    ds_pk_add_bf16 v7, v88 offset:65408
    ds_pk_add_bf16 v7, v89 offset:65412
    s_mov_b64 exec, s[54:55]
    s_branch L2_d148
L2_c149:
    s_lshl_b64 s[52:53], s[82:83], 1
    s_andn2_b64 s[52:53], s[52:53], s[80:81]
    s_andn2_b64 s[52:53], s[52:53], s[50:51]
    s_or_b64 s[80:81], s[80:81], s[52:53]
    s_not_b64 vcc, s[52:53]
    s_mov_b64 exec, -1
    v_cndmask_b32_dpp v84, v84, v84, vcc wave_shr:1 row_mask:0xf bank_mask:0xf
    v_cndmask_b32_dpp v85, v85, v85, vcc wave_shr:1 row_mask:0xf bank_mask:0xf
    s_lshr_b64 s[52:53], s[52:53], 1
    v_cndmask_b32_dpp v86, v86, v86, vcc wave_shr:1 row_mask:0xf bank_mask:0xf
    v_cndmask_b32_dpp v87, v87, v87, vcc wave_shr:1 row_mask:0xf bank_mask:0xf
    s_andn2_b64 s[82:83], s[82:83], s[52:53]
    v_cndmask_b32_dpp v7, v7, v7, vcc wave_shr:1 row_mask:0xf bank_mask:0xf
    s_mov_b64 exec, s[50:51]
    s_cbranch_scc0 L2_d149
    s_mov_b64 exec, s[82:83]
    s_nop 1
    v_mfma_f32_4x4x4_16b_bf16 v[88:91], v[12:13], v[84:85], 0
    s_nop 1
    v_mfma_f32_4x4x4_16b_bf16 v[88:91], v[10:11], v[86:87], v[88:91]
    s_nop 4
    v_cvt_pk_bf16_f32 v88, v88, v89
    v_cvt_pk_bf16_f32 v89, v90, v91
    ds_pk_add_bf16 v7, v88 offset:65408
    ds_pk_add_bf16 v7, v89 offset:65412
    s_mov_b64 exec, s[50:51]
    s_branch L2_d149
L2_c150:
    s_lshl_b64 s[52:53], s[82:83], 1
    s_andn2_b64 s[52:53], s[52:53], s[80:81]
    s_andn2_b64 s[52:53], s[52:53], s[54:55]
    s_or_b64 s[80:81], s[80:81], s[52:53]
    s_not_b64 vcc, s[52:53]
    s_mov_b64 exec, -1
    v_cndmask_b32_dpp v84, v84, v84, vcc wave_shr:1 row_mask:0xf bank_mask:0xf
    v_cndmask_b32_dpp v85, v85, v85, vcc wave_shr:1 row_mask:0xf bank_mask:0xf
    s_lshr_b64 s[52:53], s[52:53], 1
    v_cndmask_b32_dpp v86, v86, v86, vcc wave_shr:1 row_mask:0xf bank_mask:0xf
    v_cndmask_b32_dpp v87, v87, v87, vcc wave_shr:1 row_mask:0xf bank_mask:0xf
    s_andn2_b64 s[82:83], s[82:83], s[52:53]
    v_cndmask_b32_dpp v7, v7, v7, vcc wave_shr:1 row_mask:0xf bank_mask:0xf
    s_mov_b64 exec, s[54:55]
    s_cbranch_scc0 L2_d150
    s_mov_b64 exec, s[82:83]
    s_nop 1
    v_mfma_f32_4x4x4_16b_bf16 v[88:91], v[12:13], v[84:85], 0
    s_nop 1
    v_mfma_f32_4x4x4_16b_bf16 v[88:91], v[10:11], v[86:87], v[88:91]
    s_nop 4
    v_cvt_pk_bf16_f32 v88, v88, v89
    v_cvt_pk_bf16_f32 v89, v90, v91
    ds_pk_add_bf16 v7, v88 offset:65408
    ds_pk_add_bf16 v7, v89 offset:65412
    s_mov_b64 exec, s[54:55]
    s_branch L2_d150
L2_c151:
    s_lshl_b64 s[52:53], s[82:83], 1
    s_andn2_b64 s[52:53], s[52:53], s[80:81]
    s_andn2_b64 s[52:53], s[52:53], s[50:51]
    s_or_b64 s[80:81], s[80:81], s[52:53]
    s_not_b64 vcc, s[52:53]
    s_mov_b64 exec, -1
    v_cndmask_b32_dpp v84, v84, v84, vcc wave_shr:1 row_mask:0xf bank_mask:0xf
    v_cndmask_b32_dpp v85, v85, v85, vcc wave_shr:1 row_mask:0xf bank_mask:0xf
    s_lshr_b64 s[52:53], s[52:53], 1
    v_cndmask_b32_dpp v86, v86, v86, vcc wave_shr:1 row_mask:0xf bank_mask:0xf
    v_cndmask_b32_dpp v87, v87, v87, vcc wave_shr:1 row_mask:0xf bank_mask:0xf
    s_andn2_b64 s[82:83], s[82:83], s[52:53]
    v_cndmask_b32_dpp v7, v7, v7, vcc wave_shr:1 row_mask:0xf bank_mask:0xf
    s_mov_b64 exec, s[50:51]
    s_cbranch_scc0 L2_d151
    s_mov_b64 exec, s[82:83]
    s_nop 1
    v_mfma_f32_4x4x4_16b_bf16 v[88:91], v[12:13], v[84:85], 0
    s_nop 1
    v_mfma_f32_4x4x4_16b_bf16 v[88:91], v[10:11], v[86:87], v[88:91]
    s_nop 4
    v_cvt_pk_bf16_f32 v88, v88, v89
    v_cvt_pk_bf16_f32 v89, v90, v91
    ds_pk_add_bf16 v7, v88 offset:65408
    ds_pk_add_bf16 v7, v89 offset:65412
    s_mov_b64 exec, s[50:51]
    s_branch L2_d151
L2_c152:
    s_mov_b64 s[50:51], vcc
    s_lshl_b64 s[52:53], s[82:83], 1
    s_andn2_b64 s[52:53], s[52:53], s[80:81]
    s_andn2_b64 s[52:53], s[52:53], s[50:51]
    s_or_b64 s[80:81], s[80:81], s[52:53]
    s_not_b64 vcc, s[52:53]
    s_mov_b64 exec, -1
    v_cndmask_b32_dpp v84, v84, v84, vcc wave_shr:1 row_mask:0xf bank_mask:0xf
    v_cndmask_b32_dpp v85, v85, v85, vcc wave_shr:1 row_mask:0xf bank_mask:0xf
    s_lshr_b64 s[52:53], s[52:53], 1
    v_cndmask_b32_dpp v86, v86, v86, vcc wave_shr:1 row_mask:0xf bank_mask:0xf
    v_cndmask_b32_dpp v87, v87, v87, vcc wave_shr:1 row_mask:0xf bank_mask:0xf
    s_andn2_b64 s[82:83], s[82:83], s[52:53]
    v_cndmask_b32_dpp v7, v7, v7, vcc wave_shr:1 row_mask:0xf bank_mask:0xf
    s_mov_b64 vcc, s[50:51]
    s_mov_b64 exec, s[50:51]
    s_cbranch_scc0 L2_d152
    s_mov_b64 exec, s[82:83]
    s_nop 1
    v_mfma_f32_4x4x4_16b_bf16 v[88:91], v[12:13], v[84:85], 0
    s_nop 1
    v_mfma_f32_4x4x4_16b_bf16 v[88:91], v[10:11], v[86:87], v[88:91]
    s_nop 4
    v_cvt_pk_bf16_f32 v88, v88, v89
    v_cvt_pk_bf16_f32 v89, v90, v91
    ds_pk_add_bf16 v7, v88 offset:65408
    ds_pk_add_bf16 v7, v89 offset:65412
    s_mov_b64 exec, vcc
    s_branch L2_d152
L2_c153:
    s_mov_b64 s[50:51], vcc
    s_lshl_b64 s[52:53], s[82:83], 1
    s_andn2_b64 s[52:53], s[52:53], s[80:81]
    s_andn2_b64 s[52:53], s[52:53], s[50:51]
    s_or_b64 s[80:81], s[80:81], s[52:53]
    s_not_b64 vcc, s[52:53]
    s_mov_b64 exec, -1
    v_cndmask_b32_dpp v84, v84, v84, vcc wave_shr:1 row_mask:0xf bank_mask:0xf
    v_cndmask_b32_dpp v85, v85, v85, vcc wave_shr:1 row_mask:0xf bank_mask:0xf
    s_lshr_b64 s[52:53], s[52:53], 1
    v_cndmask_b32_dpp v86, v86, v86, vcc wave_shr:1 row_mask:0xf bank_mask:0xf
    v_cndmask_b32_dpp v87, v87, v87, vcc wave_shr:1 row_mask:0xf bank_mask:0xf
    s_andn2_b64 s[82:83], s[82:83], s[52:53]
    v_cndmask_b32_dpp v7, v7, v7, vcc wave_shr:1 row_mask:0xf bank_mask:0xf
    s_mov_b64 vcc, s[50:51]
    s_mov_b64 exec, s[50:51]
    s_cbranch_scc0 L2_d153
    s_mov_b64 exec, s[82:83]
    s_nop 1
    v_mfma_f32_4x4x4_16b_bf16 v[88:91], v[12:13], v[84:85], 0
    s_nop 1
    v_mfma_f32_4x4x4_16b_bf16 v[88:91], v[10:11], v[86:87], v[88:91]
    s_nop 4
    v_cvt_pk_bf16_f32 v88, v88, v89
    v_cvt_pk_bf16_f32 v89, v90, v91
    ds_pk_add_bf16 v7, v88 offset:65408
    ds_pk_add_bf16 v7, v89 offset:65412
    s_mov_b64 exec, vcc
    s_branch L2_d153
L2_f3s:
    s_branch L2_f3
.section .rodata,"a"
.p2align 6
.amdhsa_kernel gather_scatter__molecular_angular_gemnet__graph_kernel
  .amdhsa_next_free_vgpr 128
  .amdhsa_next_free_sgpr 102
  .amdhsa_accum_offset 128
  .amdhsa_group_segment_fixed_size 0
  .amdhsa_kernarg_size 112
  .amdhsa_user_sgpr_count 2
  .amdhsa_user_sgpr_kernarg_segment_ptr 1
  .amdhsa_system_sgpr_workgroup_id_x 1
  .amdhsa_float_denorm_mode_32 3
.end_amdhsa_kernel
```

```asm
; @launch grid=(256,1,1) block=(1024,1,1) lds=163840
.amdgcn_target "amdgcn-amd-amdhsa--gfx950"
.text
.globl gather_scatter__molecular_angular_gemnet__graph_kernel
.p2align 8
.type gather_scatter__molecular_angular_gemnet__graph_kernel,@function
gather_scatter__molecular_angular_gemnet__graph_kernel:
    s_cmp_ge_u32 s2, 256
    s_cbranch_scc0 L1_go
    s_endpgm
L1_go:
    s_load_dwordx4 s[4:7], s[0:1], 8
    s_load_dwordx2 s[28:29], s[0:1], 32
    s_load_dwordx2 s[30:31], s[0:1], 104
    s_load_dwordx2 s[56:57], s[0:1], 96
    s_load_dwordx2 s[86:87], s[0:1], 0
    s_load_dwordx4 s[60:63], s[0:1], 56
    s_load_dwordx4 s[64:67], s[0:1], 72
    v_lshrrev_b32 v7, 6, v0
    v_lshlrev_b32 v1, 3, v0
    v_readfirstlane_b32 s32, v7
    v_lshlrev_b32 v0, 4, v0
    v_and_b32 v1, 0x1f8, v1
    v_lshlrev_b32 v15, 1, v1
    s_lshr_b32 s3, s32, 1
    s_and_b32 s44, s32, 1
    s_lshl_b32 s44, s44, 3
    s_or_b32 s3, s3, s44
    s_lshl_b32 s3, s3, 10
    s_lshl_b32 s96, s2, 14
    s_add_u32 s96, s96, s3
    s_lshr_b32 s3, s32, 1
    s_and_b32 s44, s32, 1
    s_lshl_b32 s44, s44, 3
    s_or_b32 s3, s3, s44
    s_lshl_b32 s3, s3, 10
    s_lshl_b32 s97, s2, 14
    s_add_u32 s97, s97, s3
    s_lshr_b32 s3, s32, 1
    s_and_b32 s44, s32, 1
    s_lshl_b32 s44, s44, 3
    s_or_b32 s3, s3, s44
    s_lshl_b32 s3, s3, 10
    s_lshl_b32 s98, s2, 14
    s_add_u32 s98, s98, s3
    s_lshr_b32 s3, s32, 1
    s_and_b32 s44, s32, 1
    s_lshl_b32 s44, s44, 3
    s_or_b32 s3, s3, s44
    s_lshl_b32 s3, s3, 10
    s_lshl_b32 s99, s2, 14
    s_add_u32 s99, s99, s3
    s_waitcnt lgkmcnt(0)
    s_mov_b32 s8, s4
    s_mov_b32 s9, s5
    s_mov_b32 s10, 0x9c40000
    s_mov_b32 s11, 0x20000
    s_mov_b32 s12, s6
    s_mov_b32 s13, s7
    s_mov_b32 s14, 0x9c40000
    s_mov_b32 s15, 0x20000
    s_mov_b32 s16, s28
    s_mov_b32 s17, s29
    s_mov_b32 s18, 0x4e20000
    s_mov_b32 s19, 0x20000
    s_mov_b32 s68, s62
    s_mov_b32 s69, s63
    s_mov_b32 s70, 0x40
    s_mov_b32 s71, 0x20000
    s_mov_b32 s72, s60
    s_mov_b32 s73, s61
    s_mov_b32 s74, 0x40
    s_mov_b32 s75, 0x20000
    s_mov_b32 s20, s66
    s_mov_b32 s21, s67
    s_mov_b32 s22, 0x20
    s_mov_b32 s23, 0x20000
    s_mov_b32 s80, s64
    s_mov_b32 s81, s65
    s_mov_b32 s82, 0x20
    s_mov_b32 s83, 0x20000
    s_add_u32 s24, s30, 0xec45000
    s_addc_u32 s25, s31, 0
    s_mov_b32 s26, 0x100
    s_mov_b32 s27, 0x20000
    v_lshrrev_b32 v2, 3, v0
    v_and_b32 v2, 6, v2
    v_lshlrev_b32 v3, 2, v0
    s_lshl_b32 s3, s32, 8
    s_add_u32 s3, s3, s2
    s_cmp_lg_u32 s3, 254
    s_cbranch_scc1 L1_wt
    buffer_load_ushort v96, v2, s[68:71], 0 offen offset:0
    buffer_load_ushort v108, v2, s[68:71], 0 offen offset:8
    buffer_load_ushort v97, v2, s[68:71], 0 offen offset:16
    buffer_load_ushort v109, v2, s[68:71], 0 offen offset:24
    buffer_load_ushort v98, v2, s[68:71], 0 offen offset:32
    buffer_load_ushort v110, v2, s[68:71], 0 offen offset:40
    buffer_load_ushort v99, v2, s[68:71], 0 offen offset:48
    buffer_load_ushort v111, v2, s[68:71], 0 offen offset:56
    buffer_load_ushort v100, v2, s[72:75], 0 offen offset:0
    buffer_load_ushort v112, v2, s[72:75], 0 offen offset:8
    buffer_load_ushort v101, v2, s[72:75], 0 offen offset:16
    buffer_load_ushort v113, v2, s[72:75], 0 offen offset:24
    buffer_load_ushort v102, v2, s[72:75], 0 offen offset:32
    buffer_load_ushort v114, v2, s[72:75], 0 offen offset:40
    buffer_load_ushort v103, v2, s[72:75], 0 offen offset:48
    buffer_load_ushort v115, v2, s[72:75], 0 offen offset:56
    buffer_load_ushort v104, v2, s[20:23], 0 offen offset:0
    buffer_load_ushort v116, v2, s[20:23], 0 offen offset:8
    buffer_load_ushort v105, v2, s[20:23], 0 offen offset:16
    buffer_load_ushort v117, v2, s[20:23], 0 offen offset:24
    buffer_load_ushort v106, v2, s[80:83], 0 offen offset:0
    buffer_load_ushort v118, v2, s[80:83], 0 offen offset:8
    buffer_load_ushort v107, v2, s[80:83], 0 offen offset:16
    buffer_load_ushort v119, v2, s[80:83], 0 offen offset:24
    s_waitcnt vmcnt(0)
    v_lshl_or_b32 v96, v108, 16, v96
    v_lshl_or_b32 v97, v109, 16, v97
    v_lshl_or_b32 v98, v110, 16, v98
    v_lshl_or_b32 v99, v111, 16, v99
    v_lshl_or_b32 v100, v112, 16, v100
    v_lshl_or_b32 v101, v113, 16, v101
    v_lshl_or_b32 v102, v114, 16, v102
    v_lshl_or_b32 v103, v115, 16, v103
    v_lshl_or_b32 v104, v116, 16, v104
    v_lshl_or_b32 v105, v117, 16, v105
    v_lshl_or_b32 v106, v118, 16, v106
    v_lshl_or_b32 v107, v119, 16, v107
    buffer_store_dwordx4 v[96:99], v3, s[24:27], 0 offen offset:0 sc1
    buffer_store_dwordx4 v[100:103], v3, s[24:27], 0 offen offset:16 sc1
    buffer_store_dwordx4 v[104:107], v3, s[24:27], 0 offen offset:32 sc1
L1_wt:
    s_nop 1
    s_add_u32 s44, s96, 0x0
    v_lshlrev_b32 v16, 1, v1
    buffer_load_dwordx4 v[16:19], v16, s[8:11], s44 offen nt
    s_add_u32 s45, s96, 0x0
    v_lshlrev_b32 v20, 1, v1
    buffer_load_dwordx4 v[20:23], v20, s[12:15], s45 offen nt
    s_add_u32 s46, s96, 0x0
    s_lshr_b32 s46, s46, 1
    buffer_load_dwordx2 v[24:25], v1, s[16:19], s46 offen nt
    s_add_u32 s47, s97, 0x400000
    s_lshr_b32 s47, s47, 1
    buffer_load_dwordx2 v[26:27], v1, s[16:19], s47 offen nt
    s_add_u32 s44, s97, 0x400000
    v_lshlrev_b32 v28, 1, v1
    buffer_load_dwordx4 v[28:31], v28, s[8:11], s44 offen nt
    s_add_u32 s45, s97, 0x400000
    v_lshlrev_b32 v32, 1, v1
    buffer_load_dwordx4 v[32:35], v32, s[12:15], s45 offen nt
    s_add_u32 s46, s98, 0x800000
    v_lshlrev_b32 v36, 1, v1
    buffer_load_dwordx4 v[36:39], v36, s[8:11], s46 offen nt
    s_add_u32 s47, s98, 0x800000
    v_lshlrev_b32 v40, 1, v1
    buffer_load_dwordx4 v[40:43], v40, s[12:15], s47 offen nt
    s_add_u32 s44, s98, 0x800000
    s_lshr_b32 s44, s44, 1
    buffer_load_dwordx2 v[44:45], v1, s[16:19], s44 offen nt
    s_add_u32 s45, s99, 0xc00000
    s_lshr_b32 s45, s45, 1
    buffer_load_dwordx2 v[46:47], v1, s[16:19], s45 offen nt
    s_mov_b32 s20, s30
    s_mov_b32 s21, s31
    s_mov_b32 s22, 0xd344000
    s_mov_b32 s23, 0x20000
    s_add_u32 s24, s30, 0x2c000
    s_addc_u32 s25, s31, 0
    s_mov_b32 s26, 0xd318000
    s_mov_b32 s27, 0x20000
    s_add_u32 s3, s32, 0
    s_mul_i32 s4, s3, 205
    s_lshr_b32 s4, s4, 10
    s_mul_i32 s5, s4, 5
    s_sub_u32 s5, s3, s5
    s_lshl_b32 s5, s5, 5
    s_add_u32 s4, s4, s5
    s_sub_u32 s4, s4, s32
    s_lshl_b32 s72, s4, 10
    s_add_u32 s3, s32, 16
    s_mul_i32 s4, s3, 205
    s_lshr_b32 s4, s4, 10
    s_mul_i32 s5, s4, 5
    s_sub_u32 s5, s3, s5
    s_lshl_b32 s5, s5, 5
    s_add_u32 s4, s4, s5
    s_sub_u32 s4, s4, s32
    s_lshl_b32 s73, s4, 10
    s_add_u32 s3, s32, 32
    s_mul_i32 s4, s3, 205
    s_lshr_b32 s4, s4, 10
    s_mul_i32 s5, s4, 5
    s_sub_u32 s5, s3, s5
    s_lshl_b32 s5, s5, 5
    s_add_u32 s4, s4, s5
    s_sub_u32 s4, s4, s32
    s_lshl_b32 s85, s4, 10
    s_add_u32 s3, s32, 48
    s_mul_i32 s4, s3, 205
    s_lshr_b32 s4, s4, 10
    s_mul_i32 s5, s4, 5
    s_sub_u32 s5, s3, s5
    s_lshl_b32 s5, s5, 5
    s_add_u32 s4, s4, s5
    s_sub_u32 s4, s4, s32
    s_lshl_b32 s91, s4, 10
    s_add_u32 s3, s32, 64
    s_mul_i32 s4, s3, 205
    s_lshr_b32 s4, s4, 10
    s_mul_i32 s5, s4, 5
    s_sub_u32 s5, s3, s5
    s_lshl_b32 s5, s5, 5
    s_add_u32 s4, s4, s5
    s_sub_u32 s4, s4, s32
    s_lshl_b32 s93, s4, 10
    s_mov_b32 s80, s86
    s_mov_b32 s81, s87
    s_mov_b32 s82, 0x4e2000
    s_mov_b32 s83, 0x20000
    s_mul_i32 s35, s2, 173056
    s_and_b32 s37, s32, 3
    s_lshl_b32 s37, s37, 3
    s_mov_b32 s36, s37
    s_lshr_b32 s37, s32, 2
    s_mul_i32 s37, s37, 2080
    s_add_u32 s36, s36, s37
    s_and_b32 s37, s2, 3
    s_lshl_b32 s37, s37, 5
    s_add_u32 s36, s36, s37
    s_mul_i32 s4, s2, 5
    s_add_u32 s4, s4, 8192
    s_lshl_b32 s38, s4, 14
    s_lshl_b32 s39, s4, 13
    v_mov_b32 v2, 1
    v_mov_b32 v4, 0x80000007
    v_mov_b32 v5, 0xfc
    v_mov_b32 v6, 0x78
    s_mov_b32 s40, 16512
    s_mov_b32 s55, -10000
    s_mov_b32 s41, 0x010c0c01
    s_mov_b32 s42, 0x030c0c03
    v_mov_b32 v8, 0
    v_mov_b32 v9, 0
    v_mov_b32 v10, 0
    v_mov_b32 v11, 0
    ds_write_b128 v0, v[8:11]
    s_add_u32 s60, s30, 0xec4e000
    s_addc_u32 s61, s31, 0
    s_mov_b32 s62, 0x8000
    s_mov_b32 s63, 0x20000
    s_mov_b64 s[66:67], s[56:57]
    s_lshl_b32 s57, s2, 7
    s_add_u32 s68, s30, 0xec46000
    s_addc_u32 s69, s31, 0
    s_mov_b32 s70, 0x80
    s_mov_b32 s71, 0x20000
    s_lshl_b32 s3, s2, 7
    s_add_u32 s68, s68, s3
    s_addc_u32 s69, s69, 0
    s_cmp_lg_u32 s32, 0
    s_cbranch_scc1 L1_fl
    buffer_store_dwordx4 v[8:11], v0, s[68:71], 0 offen sc1
    s_mov_b64 exec, 0xff
    buffer_store_dwordx4 v[8:11], v0, s[60:63], s57 offen sc1
    s_mov_b64 exec, -1
L1_fl:
    s_waitcnt lgkmcnt(0)
    s_barrier
    s_setprio 3
    s_add_u32 s46, s99, 0xc00000
    v_lshlrev_b32 v48, 1, v1
    buffer_load_dwordx4 v[48:51], v48, s[8:11], s46 offen nt
    s_add_u32 s47, s99, 0xc00000
    v_lshlrev_b32 v52, 1, v1
    buffer_load_dwordx4 v[52:55], v52, s[12:15], s47 offen nt
    s_waitcnt vmcnt(8)
    v_lshlrev_b32 v7, 16, v24
    v_and_b32 v8, 0xffff0000, v24
    v_lshlrev_b32 v9, 16, v25
    v_and_b32 v10, 0xffff0000, v25
    v_mul_f32 v7, 0.15915494, v7
    v_mul_f32 v8, 0.15915494, v8
    v_mul_f32 v9, 0.15915494, v9
    v_mul_f32 v10, 0.15915494, v10
    v_mul_hi_u32_u24 v14, 429497, v16
    v_lshrrev_b32 v12, 3, v20
    v_cos_f32 v7, v7
    v_lshlrev_b16 v13, 3, v20
    v_mad_i32_i24 v11, v14, s55, v16
    v_bitop3_b32 v12, v6, v13, v12 bitop3:0xca
    v_lshl_add_u32 v11, v11, 17, s40
    v_lshlrev_b16 v14, 8, v14
    v_lshrrev_b32 v13, 2, v20
    v_add_u32 v16, v12, v11
    v_bitop3_b32 v20, v5, v13, v14 bitop3:0xea
    ds_add_u32 v20, v2
    v_mul_hi_u32_u24 v14, 429497, v17
    v_lshrrev_b32 v12, 3, v21
    v_cos_f32 v8, v8
    v_lshlrev_b16 v13, 3, v21
    v_mad_i32_i24 v11, v14, s55, v17
    v_bitop3_b32 v12, v6, v13, v12 bitop3:0xca
    v_lshl_add_u32 v11, v11, 17, s40
    v_lshlrev_b16 v14, 8, v14
    v_lshrrev_b32 v13, 2, v21
    v_add_u32 v17, v12, v11
    v_bitop3_b32 v21, v5, v13, v14 bitop3:0xea
    ds_add_u32 v21, v2
    v_cvt_pk_bf16_f32 v24, v7, v8
    v_perm_b32 v12, v24, v24, s41
    v_bitop3_b32 v16, v4, v12, v16 bitop3:0xca
    v_perm_b32 v13, v24, v24, s42
    v_bitop3_b32 v17, v4, v13, v17 bitop3:0xca
    v_mul_hi_u32_u24 v14, 429497, v18
    v_lshrrev_b32 v12, 3, v22
    v_cos_f32 v9, v9
    v_lshlrev_b16 v13, 3, v22
    v_mad_i32_i24 v11, v14, s55, v18
    v_bitop3_b32 v12, v6, v13, v12 bitop3:0xca
    v_lshl_add_u32 v11, v11, 17, s40
    v_lshlrev_b16 v14, 8, v14
    v_lshrrev_b32 v13, 2, v22
    v_add_u32 v18, v12, v11
    v_bitop3_b32 v22, v5, v13, v14 bitop3:0xea
    ds_add_u32 v22, v2
    v_mul_hi_u32_u24 v14, 429497, v19
    v_lshrrev_b32 v12, 3, v23
    v_cos_f32 v10, v10
    v_lshlrev_b16 v13, 3, v23
    v_mad_i32_i24 v11, v14, s55, v19
    v_bitop3_b32 v12, v6, v13, v12 bitop3:0xca
    v_lshl_add_u32 v11, v11, 17, s40
    v_lshlrev_b16 v14, 8, v14
    v_lshrrev_b32 v13, 2, v23
    v_add_u32 v19, v12, v11
    v_bitop3_b32 v23, v5, v13, v14 bitop3:0xea
    ds_add_u32 v23, v2
    v_cvt_pk_bf16_f32 v25, v9, v10
    v_perm_b32 v12, v25, v25, s41
    v_bitop3_b32 v18, v4, v12, v18 bitop3:0xca
    v_perm_b32 v13, v25, v25, s42
    v_bitop3_b32 v19, v4, v13, v19 bitop3:0xca
    s_add_u32 s44, s96, 0x1000000
    v_lshlrev_b32 v56, 1, v1
    buffer_load_dwordx4 v[56:59], v56, s[8:11], s44 offen nt
    s_add_u32 s45, s96, 0x1000000
    v_lshlrev_b32 v60, 1, v1
    buffer_load_dwordx4 v[60:63], v60, s[12:15], s45 offen nt
    s_add_u32 s46, s96, 0x1000000
    s_lshr_b32 s46, s46, 1
    buffer_load_dwordx2 v[64:65], v1, s[16:19], s46 offen nt
    s_add_u32 s47, s97, 0x1400000
    s_lshr_b32 s47, s47, 1
    buffer_load_dwordx2 v[66:67], v1, s[16:19], s47 offen nt
    s_waitcnt vmcnt(10)
    v_lshlrev_b32 v7, 16, v26
    v_and_b32 v8, 0xffff0000, v26
    v_lshlrev_b32 v9, 16, v27
    v_and_b32 v10, 0xffff0000, v27
    v_mul_f32 v7, 0.15915494, v7
    v_mul_f32 v8, 0.15915494, v8
    v_mul_f32 v9, 0.15915494, v9
    v_mul_f32 v10, 0.15915494, v10
    v_mul_hi_u32_u24 v14, 429497, v28
    v_lshrrev_b32 v12, 3, v32
    v_cos_f32 v7, v7
    v_lshlrev_b16 v13, 3, v32
    v_mad_i32_i24 v11, v14, s55, v28
    v_bitop3_b32 v12, v6, v13, v12 bitop3:0xca
    v_lshl_add_u32 v11, v11, 17, s40
    v_lshlrev_b16 v14, 8, v14
    v_lshrrev_b32 v13, 2, v32
    v_add_u32 v28, v12, v11
    v_bitop3_b32 v32, v5, v13, v14 bitop3:0xea
    ds_add_u32 v32, v2
    v_mul_hi_u32_u24 v14, 429497, v29
    v_lshrrev_b32 v12, 3, v33
    v_cos_f32 v8, v8
    v_lshlrev_b16 v13, 3, v33
    v_mad_i32_i24 v11, v14, s55, v29
    v_bitop3_b32 v12, v6, v13, v12 bitop3:0xca
    v_lshl_add_u32 v11, v11, 17, s40
    v_lshlrev_b16 v14, 8, v14
    v_lshrrev_b32 v13, 2, v33
    v_add_u32 v29, v12, v11
    v_bitop3_b32 v33, v5, v13, v14 bitop3:0xea
    ds_add_u32 v33, v2
    v_cvt_pk_bf16_f32 v26, v7, v8
    v_perm_b32 v12, v26, v26, s41
    v_bitop3_b32 v28, v4, v12, v28 bitop3:0xca
    v_perm_b32 v13, v26, v26, s42
    v_bitop3_b32 v29, v4, v13, v29 bitop3:0xca
    v_mul_hi_u32_u24 v14, 429497, v30
    v_lshrrev_b32 v12, 3, v34
    v_cos_f32 v9, v9
    v_lshlrev_b16 v13, 3, v34
    v_mad_i32_i24 v11, v14, s55, v30
    v_bitop3_b32 v12, v6, v13, v12 bitop3:0xca
    v_lshl_add_u32 v11, v11, 17, s40
    v_lshlrev_b16 v14, 8, v14
    v_lshrrev_b32 v13, 2, v34
    v_add_u32 v30, v12, v11
    v_bitop3_b32 v34, v5, v13, v14 bitop3:0xea
    ds_add_u32 v34, v2
    v_mul_hi_u32_u24 v14, 429497, v31
    v_lshrrev_b32 v12, 3, v35
    v_cos_f32 v10, v10
    v_lshlrev_b16 v13, 3, v35
    v_mad_i32_i24 v11, v14, s55, v31
    v_bitop3_b32 v12, v6, v13, v12 bitop3:0xca
    v_lshl_add_u32 v11, v11, 17, s40
    v_lshlrev_b16 v14, 8, v14
    v_lshrrev_b32 v13, 2, v35
    v_add_u32 v31, v12, v11
    v_bitop3_b32 v35, v5, v13, v14 bitop3:0xea
    ds_add_u32 v35, v2
    v_cvt_pk_bf16_f32 v27, v9, v10
    v_perm_b32 v12, v27, v27, s41
    v_bitop3_b32 v30, v4, v12, v30 bitop3:0xca
    v_perm_b32 v13, v27, v27, s42
    v_bitop3_b32 v31, v4, v13, v31 bitop3:0xca
    s_setprio 2
    s_add_u32 s44, s97, 0x1400000
    v_lshlrev_b32 v68, 1, v1
    buffer_load_dwordx4 v[68:71], v68, s[8:11], s44 offen nt
    s_add_u32 s45, s97, 0x1400000
    v_lshlrev_b32 v72, 1, v1
    buffer_load_dwordx4 v[72:75], v72, s[12:15], s45 offen nt
    s_waitcnt vmcnt(8)
    v_lshlrev_b32 v7, 16, v44
    v_and_b32 v8, 0xffff0000, v44
    v_lshlrev_b32 v9, 16, v45
    v_and_b32 v10, 0xffff0000, v45
    v_mul_f32 v7, 0.15915494, v7
    v_mul_f32 v8, 0.15915494, v8
    v_mul_f32 v9, 0.15915494, v9
    v_mul_f32 v10, 0.15915494, v10
    v_mul_hi_u32_u24 v14, 429497, v36
    v_lshrrev_b32 v12, 3, v40
    v_cos_f32 v7, v7
    v_lshlrev_b16 v13, 3, v40
    v_mad_i32_i24 v11, v14, s55, v36
    v_bitop3_b32 v12, v6, v13, v12 bitop3:0xca
    v_lshl_add_u32 v11, v11, 17, s40
    v_lshlrev_b16 v14, 8, v14
    v_lshrrev_b32 v13, 2, v40
    v_add_u32 v36, v12, v11
    v_bitop3_b32 v40, v5, v13, v14 bitop3:0xea
    ds_add_u32 v40, v2
    v_mul_hi_u32_u24 v14, 429497, v37
    v_lshrrev_b32 v12, 3, v41
    v_cos_f32 v8, v8
    v_lshlrev_b16 v13, 3, v41
    v_mad_i32_i24 v11, v14, s55, v37
    v_bitop3_b32 v12, v6, v13, v12 bitop3:0xca
    v_lshl_add_u32 v11, v11, 17, s40
    v_lshlrev_b16 v14, 8, v14
    v_lshrrev_b32 v13, 2, v41
    v_add_u32 v37, v12, v11
    v_bitop3_b32 v41, v5, v13, v14 bitop3:0xea
    ds_add_u32 v41, v2
    v_cvt_pk_bf16_f32 v44, v7, v8
    v_perm_b32 v12, v44, v44, s41
    v_bitop3_b32 v36, v4, v12, v36 bitop3:0xca
    v_perm_b32 v13, v44, v44, s42
    v_bitop3_b32 v37, v4, v13, v37 bitop3:0xca
    v_mul_hi_u32_u24 v14, 429497, v38
    v_lshrrev_b32 v12, 3, v42
    v_cos_f32 v9, v9
    v_lshlrev_b16 v13, 3, v42
    v_mad_i32_i24 v11, v14, s55, v38
    v_bitop3_b32 v12, v6, v13, v12 bitop3:0xca
    v_lshl_add_u32 v11, v11, 17, s40
    v_lshlrev_b16 v14, 8, v14
    v_lshrrev_b32 v13, 2, v42
    v_add_u32 v38, v12, v11
    v_bitop3_b32 v42, v5, v13, v14 bitop3:0xea
    ds_add_u32 v42, v2
    v_mul_hi_u32_u24 v14, 429497, v39
    v_lshrrev_b32 v12, 3, v43
    v_cos_f32 v10, v10
    v_lshlrev_b16 v13, 3, v43
    v_mad_i32_i24 v11, v14, s55, v39
    v_bitop3_b32 v12, v6, v13, v12 bitop3:0xca
    v_lshl_add_u32 v11, v11, 17, s40
    v_lshlrev_b16 v14, 8, v14
    v_lshrrev_b32 v13, 2, v43
    v_add_u32 v39, v12, v11
    v_bitop3_b32 v43, v5, v13, v14 bitop3:0xea
    ds_add_u32 v43, v2
    v_cvt_pk_bf16_f32 v45, v9, v10
    v_perm_b32 v12, v45, v45, s41
    v_bitop3_b32 v38, v4, v12, v38 bitop3:0xca
    v_perm_b32 v13, v45, v45, s42
    v_bitop3_b32 v39, v4, v13, v39 bitop3:0xca
    s_add_u32 s46, s98, 0x1800000
    v_lshlrev_b32 v76, 1, v1
    buffer_load_dwordx4 v[76:79], v76, s[8:11], s46 offen nt
    s_add_u32 s47, s98, 0x1800000
    v_lshlrev_b32 v80, 1, v1
    buffer_load_dwordx4 v[80:83], v80, s[12:15], s47 offen nt
    s_add_u32 s44, s98, 0x1800000
    s_lshr_b32 s44, s44, 1
    buffer_load_dwordx2 v[84:85], v1, s[16:19], s44 offen nt
    s_add_u32 s45, s99, 0x1c00000
    s_lshr_b32 s45, s45, 1
    buffer_load_dwordx2 v[86:87], v1, s[16:19], s45 offen nt
    s_waitcnt vmcnt(10)
    v_lshlrev_b32 v7, 16, v46
    v_and_b32 v8, 0xffff0000, v46
    v_lshlrev_b32 v9, 16, v47
    v_and_b32 v10, 0xffff0000, v47
    v_mul_f32 v7, 0.15915494, v7
    v_mul_f32 v8, 0.15915494, v8
    v_mul_f32 v9, 0.15915494, v9
    v_mul_f32 v10, 0.15915494, v10
    v_mul_hi_u32_u24 v14, 429497, v48
    v_lshrrev_b32 v12, 3, v52
    v_cos_f32 v7, v7
    v_lshlrev_b16 v13, 3, v52
    v_mad_i32_i24 v11, v14, s55, v48
    v_bitop3_b32 v12, v6, v13, v12 bitop3:0xca
    v_lshl_add_u32 v11, v11, 17, s40
    v_lshlrev_b16 v14, 8, v14
    v_lshrrev_b32 v13, 2, v52
    v_add_u32 v48, v12, v11
    v_bitop3_b32 v52, v5, v13, v14 bitop3:0xea
    ds_add_u32 v52, v2
    v_mul_hi_u32_u24 v14, 429497, v49
    v_lshrrev_b32 v12, 3, v53
    v_cos_f32 v8, v8
    v_lshlrev_b16 v13, 3, v53
    v_mad_i32_i24 v11, v14, s55, v49
    v_bitop3_b32 v12, v6, v13, v12 bitop3:0xca
    v_lshl_add_u32 v11, v11, 17, s40
    v_lshlrev_b16 v14, 8, v14
    v_lshrrev_b32 v13, 2, v53
    v_add_u32 v49, v12, v11
    v_bitop3_b32 v53, v5, v13, v14 bitop3:0xea
    ds_add_u32 v53, v2
    v_cvt_pk_bf16_f32 v46, v7, v8
    v_perm_b32 v12, v46, v46, s41
    v_bitop3_b32 v48, v4, v12, v48 bitop3:0xca
    v_perm_b32 v13, v46, v46, s42
    v_bitop3_b32 v49, v4, v13, v49 bitop3:0xca
    v_mul_hi_u32_u24 v14, 429497, v50
    v_lshrrev_b32 v12, 3, v54
    v_cos_f32 v9, v9
    v_lshlrev_b16 v13, 3, v54
    v_mad_i32_i24 v11, v14, s55, v50
    v_bitop3_b32 v12, v6, v13, v12 bitop3:0xca
    v_lshl_add_u32 v11, v11, 17, s40
    v_lshlrev_b16 v14, 8, v14
    v_lshrrev_b32 v13, 2, v54
    v_add_u32 v50, v12, v11
    v_bitop3_b32 v54, v5, v13, v14 bitop3:0xea
    ds_add_u32 v54, v2
    v_mul_hi_u32_u24 v14, 429497, v51
    v_lshrrev_b32 v12, 3, v55
    v_cos_f32 v10, v10
    v_lshlrev_b16 v13, 3, v55
    v_mad_i32_i24 v11, v14, s55, v51
    v_bitop3_b32 v12, v6, v13, v12 bitop3:0xca
    v_lshl_add_u32 v11, v11, 17, s40
    v_lshlrev_b16 v14, 8, v14
    v_lshrrev_b32 v13, 2, v55
    v_add_u32 v51, v12, v11
    v_bitop3_b32 v55, v5, v13, v14 bitop3:0xea
    ds_add_u32 v55, v2
    v_cvt_pk_bf16_f32 v47, v9, v10
    v_perm_b32 v12, v47, v47, s41
    v_bitop3_b32 v50, v4, v12, v50 bitop3:0xca
    v_perm_b32 v13, v47, v47, s42
    v_bitop3_b32 v51, v4, v13, v51 bitop3:0xca
    s_setprio 1
    s_add_u32 s46, s99, 0x1c00000
    v_lshlrev_b32 v88, 1, v1
    buffer_load_dwordx4 v[88:91], v88, s[8:11], s46 offen nt
    s_add_u32 s47, s99, 0x1c00000
    v_lshlrev_b32 v92, 1, v1
    buffer_load_dwordx4 v[92:95], v92, s[12:15], s47 offen nt
    s_waitcnt vmcnt(8)
    v_lshlrev_b32 v7, 16, v64
    v_and_b32 v8, 0xffff0000, v64
    v_lshlrev_b32 v9, 16, v65
    v_and_b32 v10, 0xffff0000, v65
    v_mul_f32 v7, 0.15915494, v7
    v_mul_f32 v8, 0.15915494, v8
    v_mul_f32 v9, 0.15915494, v9
    v_mul_f32 v10, 0.15915494, v10
    v_mul_hi_u32_u24 v14, 429497, v56
    v_lshrrev_b32 v12, 3, v60
    v_cos_f32 v7, v7
    v_lshlrev_b16 v13, 3, v60
    v_mad_i32_i24 v11, v14, s55, v56
    v_bitop3_b32 v12, v6, v13, v12 bitop3:0xca
    v_lshl_add_u32 v11, v11, 17, s40
    v_lshlrev_b16 v14, 8, v14
    v_lshrrev_b32 v13, 2, v60
    v_add_u32 v56, v12, v11
    v_bitop3_b32 v60, v5, v13, v14 bitop3:0xea
    ds_add_u32 v60, v2
    v_mul_hi_u32_u24 v14, 429497, v57
    v_lshrrev_b32 v12, 3, v61
    v_cos_f32 v8, v8
    v_lshlrev_b16 v13, 3, v61
    v_mad_i32_i24 v11, v14, s55, v57
    v_bitop3_b32 v12, v6, v13, v12 bitop3:0xca
    v_lshl_add_u32 v11, v11, 17, s40
    v_lshlrev_b16 v14, 8, v14
    v_lshrrev_b32 v13, 2, v61
    v_add_u32 v57, v12, v11
    v_bitop3_b32 v61, v5, v13, v14 bitop3:0xea
    ds_add_u32 v61, v2
    v_cvt_pk_bf16_f32 v64, v7, v8
    v_perm_b32 v12, v64, v64, s41
    v_bitop3_b32 v56, v4, v12, v56 bitop3:0xca
    v_perm_b32 v13, v64, v64, s42
    v_bitop3_b32 v57, v4, v13, v57 bitop3:0xca
    v_mul_hi_u32_u24 v14, 429497, v58
    v_lshrrev_b32 v12, 3, v62
    v_cos_f32 v9, v9
    v_lshlrev_b16 v13, 3, v62
    v_mad_i32_i24 v11, v14, s55, v58
    v_bitop3_b32 v12, v6, v13, v12 bitop3:0xca
    v_lshl_add_u32 v11, v11, 17, s40
    v_lshlrev_b16 v14, 8, v14
    v_lshrrev_b32 v13, 2, v62
    v_add_u32 v58, v12, v11
    v_bitop3_b32 v62, v5, v13, v14 bitop3:0xea
    ds_add_u32 v62, v2
    v_mul_hi_u32_u24 v14, 429497, v59
    v_lshrrev_b32 v12, 3, v63
    v_cos_f32 v10, v10
    v_lshlrev_b16 v13, 3, v63
    v_mad_i32_i24 v11, v14, s55, v59
    v_bitop3_b32 v12, v6, v13, v12 bitop3:0xca
    v_lshl_add_u32 v11, v11, 17, s40
    v_lshlrev_b16 v14, 8, v14
    v_lshrrev_b32 v13, 2, v63
    v_add_u32 v59, v12, v11
    v_bitop3_b32 v63, v5, v13, v14 bitop3:0xea
    ds_add_u32 v63, v2
    v_cvt_pk_bf16_f32 v65, v9, v10
    v_perm_b32 v12, v65, v65, s41
    v_bitop3_b32 v58, v4, v12, v58 bitop3:0xca
    v_perm_b32 v13, v65, v65, s42
    v_bitop3_b32 v59, v4, v13, v59 bitop3:0xca
    s_add_u32 s44, s96, 0x2000000
    v_lshlrev_b32 v96, 1, v1
    buffer_load_dwordx4 v[96:99], v96, s[8:11], s44 offen nt
    s_add_u32 s45, s96, 0x2000000
    v_lshlrev_b32 v104, 1, v1
    buffer_load_dwordx4 v[104:107], v104, s[12:15], s45 offen nt
    s_add_u32 s46, s96, 0x2000000
    s_lshr_b32 s46, s46, 1
    buffer_load_dwordx2 v[108:109], v1, s[16:19], s46 offen nt
    s_add_u32 s47, s97, 0x2400000
    s_lshr_b32 s47, s47, 1
    buffer_load_dwordx2 v[110:111], v1, s[16:19], s47 offen nt
    s_waitcnt vmcnt(10)
    v_lshlrev_b32 v7, 16, v66
    v_and_b32 v8, 0xffff0000, v66
    v_lshlrev_b32 v9, 16, v67
    v_and_b32 v10, 0xffff0000, v67
    v_mul_f32 v7, 0.15915494, v7
    v_mul_f32 v8, 0.15915494, v8
    v_mul_f32 v9, 0.15915494, v9
    v_mul_f32 v10, 0.15915494, v10
    v_mul_hi_u32_u24 v14, 429497, v68
    v_lshrrev_b32 v12, 3, v72
    v_cos_f32 v7, v7
    v_lshlrev_b16 v13, 3, v72
    v_mad_i32_i24 v11, v14, s55, v68
    v_bitop3_b32 v12, v6, v13, v12 bitop3:0xca
    v_lshl_add_u32 v11, v11, 17, s40
    v_lshlrev_b16 v14, 8, v14
    v_lshrrev_b32 v13, 2, v72
    v_add_u32 v68, v12, v11
    v_bitop3_b32 v72, v5, v13, v14 bitop3:0xea
    ds_add_u32 v72, v2
    v_mul_hi_u32_u24 v14, 429497, v69
    v_lshrrev_b32 v12, 3, v73
    v_cos_f32 v8, v8
    v_lshlrev_b16 v13, 3, v73
    v_mad_i32_i24 v11, v14, s55, v69
    v_bitop3_b32 v12, v6, v13, v12 bitop3:0xca
    v_lshl_add_u32 v11, v11, 17, s40
    v_lshlrev_b16 v14, 8, v14
    v_lshrrev_b32 v13, 2, v73
    v_add_u32 v69, v12, v11
    v_bitop3_b32 v73, v5, v13, v14 bitop3:0xea
    ds_add_u32 v73, v2
    v_cvt_pk_bf16_f32 v66, v7, v8
    v_perm_b32 v12, v66, v66, s41
    v_bitop3_b32 v68, v4, v12, v68 bitop3:0xca
    v_perm_b32 v13, v66, v66, s42
    v_bitop3_b32 v69, v4, v13, v69 bitop3:0xca
    v_mul_hi_u32_u24 v14, 429497, v70
    v_lshrrev_b32 v12, 3, v74
    v_cos_f32 v9, v9
    v_lshlrev_b16 v13, 3, v74
    v_mad_i32_i24 v11, v14, s55, v70
    v_bitop3_b32 v12, v6, v13, v12 bitop3:0xca
    v_lshl_add_u32 v11, v11, 17, s40
    v_lshlrev_b16 v14, 8, v14
    v_lshrrev_b32 v13, 2, v74
    v_add_u32 v70, v12, v11
    v_bitop3_b32 v74, v5, v13, v14 bitop3:0xea
    ds_add_u32 v74, v2
    v_mul_hi_u32_u24 v14, 429497, v71
    v_lshrrev_b32 v12, 3, v75
    v_cos_f32 v10, v10
    v_lshlrev_b16 v13, 3, v75
    v_mad_i32_i24 v11, v14, s55, v71
    v_bitop3_b32 v12, v6, v13, v12 bitop3:0xca
    v_lshl_add_u32 v11, v11, 17, s40
    v_lshlrev_b16 v14, 8, v14
    v_lshrrev_b32 v13, 2, v75
    v_add_u32 v71, v12, v11
    v_bitop3_b32 v75, v5, v13, v14 bitop3:0xea
    ds_add_u32 v75, v2
    v_cvt_pk_bf16_f32 v67, v9, v10
    v_perm_b32 v12, v67, v67, s41
    v_bitop3_b32 v70, v4, v12, v70 bitop3:0xca
    v_perm_b32 v13, v67, v67, s42
    v_bitop3_b32 v71, v4, v13, v71 bitop3:0xca
    s_setprio 0
    s_add_u32 s44, s97, 0x2400000
    v_lshlrev_b32 v100, 1, v1
    buffer_load_dwordx4 v[100:103], v100, s[8:11], s44 offen nt
    s_waitcnt vmcnt(7)
    v_lshlrev_b32 v7, 16, v84
    v_and_b32 v8, 0xffff0000, v84
    v_lshlrev_b32 v9, 16, v85
    v_and_b32 v10, 0xffff0000, v85
    v_mul_f32 v7, 0.15915494, v7
    v_mul_f32 v8, 0.15915494, v8
    v_mul_f32 v9, 0.15915494, v9
    v_mul_f32 v10, 0.15915494, v10
    v_mul_hi_u32_u24 v14, 429497, v76
    v_lshrrev_b32 v12, 3, v80
    v_cos_f32 v7, v7
    v_lshlrev_b16 v13, 3, v80
    v_mad_i32_i24 v11, v14, s55, v76
    v_bitop3_b32 v12, v6, v13, v12 bitop3:0xca
    v_lshl_add_u32 v11, v11, 17, s40
    v_lshlrev_b16 v14, 8, v14
    v_lshrrev_b32 v13, 2, v80
    v_add_u32 v76, v12, v11
    v_bitop3_b32 v80, v5, v13, v14 bitop3:0xea
    ds_add_u32 v80, v2
    v_mul_hi_u32_u24 v14, 429497, v77
    v_lshrrev_b32 v12, 3, v81
    v_cos_f32 v8, v8
    v_lshlrev_b16 v13, 3, v81
    v_mad_i32_i24 v11, v14, s55, v77
    v_bitop3_b32 v12, v6, v13, v12 bitop3:0xca
    v_lshl_add_u32 v11, v11, 17, s40
    v_lshlrev_b16 v14, 8, v14
    v_lshrrev_b32 v13, 2, v81
    v_add_u32 v77, v12, v11
    v_bitop3_b32 v81, v5, v13, v14 bitop3:0xea
    ds_add_u32 v81, v2
    v_cvt_pk_bf16_f32 v84, v7, v8
    v_perm_b32 v12, v84, v84, s41
    v_bitop3_b32 v76, v4, v12, v76 bitop3:0xca
    v_perm_b32 v13, v84, v84, s42
    v_bitop3_b32 v77, v4, v13, v77 bitop3:0xca
    v_mul_hi_u32_u24 v14, 429497, v78
    v_lshrrev_b32 v12, 3, v82
    v_cos_f32 v9, v9
    v_lshlrev_b16 v13, 3, v82
    v_mad_i32_i24 v11, v14, s55, v78
    v_bitop3_b32 v12, v6, v13, v12 bitop3:0xca
    v_lshl_add_u32 v11, v11, 17, s40
    v_lshlrev_b16 v14, 8, v14
    v_lshrrev_b32 v13, 2, v82
    v_add_u32 v78, v12, v11
    v_bitop3_b32 v82, v5, v13, v14 bitop3:0xea
    ds_add_u32 v82, v2
    v_mul_hi_u32_u24 v14, 429497, v79
    v_lshrrev_b32 v12, 3, v83
    v_cos_f32 v10, v10
    v_lshlrev_b16 v13, 3, v83
    v_mad_i32_i24 v11, v14, s55, v79
    v_bitop3_b32 v12, v6, v13, v12 bitop3:0xca
    v_lshl_add_u32 v11, v11, 17, s40
    v_lshlrev_b16 v14, 8, v14
    v_lshrrev_b32 v13, 2, v83
    v_add_u32 v79, v12, v11
    v_bitop3_b32 v83, v5, v13, v14 bitop3:0xea
    ds_add_u32 v83, v2
    v_cvt_pk_bf16_f32 v85, v9, v10
    v_perm_b32 v12, v85, v85, s41
    v_bitop3_b32 v78, v4, v12, v78 bitop3:0xca
    v_perm_b32 v13, v85, v85, s42
    v_bitop3_b32 v79, v4, v13, v79 bitop3:0xca
    s_waitcnt vmcnt(5)
    v_lshlrev_b32 v7, 16, v86
    v_and_b32 v8, 0xffff0000, v86
    v_lshlrev_b32 v9, 16, v87
    v_and_b32 v10, 0xffff0000, v87
    v_mul_f32 v7, 0.15915494, v7
    v_mul_f32 v8, 0.15915494, v8
    v_mul_f32 v9, 0.15915494, v9
    v_mul_f32 v10, 0.15915494, v10
    v_mul_hi_u32_u24 v14, 429497, v88
    v_lshrrev_b32 v12, 3, v92
    v_cos_f32 v7, v7
    v_lshlrev_b16 v13, 3, v92
    v_mad_i32_i24 v11, v14, s55, v88
    v_bitop3_b32 v12, v6, v13, v12 bitop3:0xca
    v_lshl_add_u32 v11, v11, 17, s40
    v_lshlrev_b16 v14, 8, v14
    v_lshrrev_b32 v13, 2, v92
    v_add_u32 v88, v12, v11
    v_bitop3_b32 v92, v5, v13, v14 bitop3:0xea
    ds_add_u32 v92, v2
    v_mul_hi_u32_u24 v14, 429497, v89
    v_lshrrev_b32 v12, 3, v93
    v_cos_f32 v8, v8
    v_lshlrev_b16 v13, 3, v93
    v_mad_i32_i24 v11, v14, s55, v89
    v_bitop3_b32 v12, v6, v13, v12 bitop3:0xca
    v_lshl_add_u32 v11, v11, 17, s40
    v_lshlrev_b16 v14, 8, v14
    v_lshrrev_b32 v13, 2, v93
    v_add_u32 v89, v12, v11
    v_bitop3_b32 v93, v5, v13, v14 bitop3:0xea
    ds_add_u32 v93, v2
    v_cvt_pk_bf16_f32 v86, v7, v8
    v_perm_b32 v12, v86, v86, s41
    v_bitop3_b32 v88, v4, v12, v88 bitop3:0xca
    v_perm_b32 v13, v86, v86, s42
    v_bitop3_b32 v89, v4, v13, v89 bitop3:0xca
    v_mul_hi_u32_u24 v14, 429497, v90
    v_lshrrev_b32 v12, 3, v94
    v_cos_f32 v9, v9
    v_lshlrev_b16 v13, 3, v94
    v_mad_i32_i24 v11, v14, s55, v90
    v_bitop3_b32 v12, v6, v13, v12 bitop3:0xca
    v_lshl_add_u32 v11, v11, 17, s40
    v_lshlrev_b16 v14, 8, v14
    v_lshrrev_b32 v13, 2, v94
    v_add_u32 v90, v12, v11
    v_bitop3_b32 v94, v5, v13, v14 bitop3:0xea
    ds_add_u32 v94, v2
    v_mul_hi_u32_u24 v14, 429497, v91
    v_lshrrev_b32 v12, 3, v95
    v_cos_f32 v10, v10
    v_lshlrev_b16 v13, 3, v95
    v_mad_i32_i24 v11, v14, s55, v91
    v_bitop3_b32 v12, v6, v13, v12 bitop3:0xca
    v_lshl_add_u32 v11, v11, 17, s40
    v_lshlrev_b16 v14, 8, v14
    v_lshrrev_b32 v13, 2, v95
    v_add_u32 v91, v12, v11
    v_bitop3_b32 v95, v5, v13, v14 bitop3:0xea
    ds_add_u32 v95, v2
    v_cvt_pk_bf16_f32 v87, v9, v10
    v_perm_b32 v12, v87, v87, s41
    v_bitop3_b32 v90, v4, v12, v90 bitop3:0xca
    v_perm_b32 v13, v87, v87, s42
    v_bitop3_b32 v91, v4, v13, v91 bitop3:0xca
    v_lshrrev_b32 v8, 2, v0
    v_and_b32 v7, 0x3c00, v0
    v_bitop3_b32 v7, v5, v8, v7 bitop3:0xea
    s_waitcnt lgkmcnt(0)
    s_barrier
    ds_read2st64_b32 v[8:9], v7 offset0:0 offset1:1
    ds_read2st64_b32 v[10:11], v7 offset0:2 offset1:3
    s_add_u32 s45, s97, 0x2400000
    v_lshlrev_b32 v112, 1, v1
    buffer_load_dwordx4 v[112:115], v112, s[12:15], s45 offen nt
    s_waitcnt lgkmcnt(0)
    v_lshl_or_b32 v12, v9, 16, v8
    v_lshl_or_b32 v13, v11, 16, v10
    v_mov_b32 v14, v12
    v_mov_b32 v15, v13
    s_nop 0
    v_add_u32_dpp v14, v14, v14 row_shr:1 row_mask:0xf bank_mask:0xf bound_ctrl:1
    v_add_u32_dpp v15, v15, v15 row_shr:1 row_mask:0xf bank_mask:0xf bound_ctrl:1
    s_nop 0
    v_add_u32_dpp v14, v14, v14 row_shr:2 row_mask:0xf bank_mask:0xf bound_ctrl:1
    v_add_u32_dpp v15, v15, v15 row_shr:2 row_mask:0xf bank_mask:0xf bound_ctrl:1
    s_nop 0
    v_add_u32_dpp v14, v14, v14 row_shr:4 row_mask:0xf bank_mask:0xf bound_ctrl:1
    v_add_u32_dpp v15, v15, v15 row_shr:4 row_mask:0xf bank_mask:0xf bound_ctrl:1
    s_nop 0
    v_add_u32_dpp v14, v14, v14 row_shr:8 row_mask:0xf bank_mask:0xf bound_ctrl:1
    v_add_u32_dpp v15, v15, v15 row_shr:8 row_mask:0xf bank_mask:0xf bound_ctrl:1
    s_nop 0
    v_add_u32_dpp v14, v14, v14 row_bcast:15 row_mask:0xa bank_mask:0xf
    v_add_u32_dpp v15, v15, v15 row_bcast:15 row_mask:0xa bank_mask:0xf
    s_nop 0
    v_add_u32_dpp v14, v14, v14 row_bcast:31 row_mask:0xc bank_mask:0xf
    v_add_u32_dpp v15, v15, v15 row_bcast:31 row_mask:0xc bank_mask:0xf
    v_readlane_b32 s48, v14, 63
    v_readlane_b32 s49, v15, 63
    s_lshl_b32 s54, s32, 2
    v_mov_b32 v8, s54
    s_and_b32 s50, s48, 0xffff
    s_lshr_b32 s51, s48, 16
    s_and_b32 s52, s49, 0xffff
    s_lshr_b32 s53, s49, 16
    s_add_u32 s51, s51, s50
    s_add_u32 s52, s52, s51
    s_add_u32 s53, s53, s52
    v_mov_b32 v9, s53
    s_mov_b64 exec, 1
    ds_write_b32 v8, v9 offset:16384
    s_mov_b64 exec, -1
    v_and_b32 v8, 60, v7
    s_waitcnt lgkmcnt(0)
    s_barrier
    ds_read_b32 v9, v8 offset:16384
    s_waitcnt lgkmcnt(0)
    v_add_u32_dpp v9, v9, v9 row_shr:1 row_mask:0xf bank_mask:0xf bound_ctrl:1
    s_nop 1
    v_add_u32_dpp v9, v9, v9 row_shr:2 row_mask:0xf bank_mask:0xf bound_ctrl:1
    s_nop 1
    v_add_u32_dpp v9, v9, v9 row_shr:4 row_mask:0xf bank_mask:0xf bound_ctrl:1
    s_nop 1
    v_add_u32_dpp v9, v9, v9 row_shr:8 row_mask:0xf bank_mask:0xf bound_ctrl:1
    s_nop 0
    v_readlane_b32 s54, v9, s32
    s_sub_u32 s54, s54, s53
    s_add_u32 s50, s50, s54
    s_add_u32 s51, s51, s54
    s_add_u32 s52, s52, s54
    s_pack_ll_b32_b16 s48, s54, s50
    s_pack_ll_b32_b16 s49, s51, s52
    v_add_u32 v14, s48, v14
    v_add_u32 v15, s49, v15
    v_sub_u32 v12, v14, v12
    v_sub_u32 v13, v15, v13
    v_and_b32 v8, 0xffff, v12
    v_lshrrev_b32 v9, 16, v12
    v_and_b32 v10, 0xffff, v13
    v_lshrrev_b32 v11, 16, v13
    ds_write2st64_b32 v7, v8, v9 offset0:0 offset1:1
    ds_write2st64_b32 v7, v10, v11 offset0:2 offset1:3
    v_and_b32 v8, 0x3f0, v0
    v_lshl_add_u32 v8, v8, 1, s36
    ds_write_b64 v8, v[12:13] offset:20480
    s_bitset0_b64 exec, 63
    s_not_b64 exec, exec
    ds_write_b64 v8, v[14:15] offset:20512
    s_mov_b64 exec, -1
    s_waitcnt lgkmcnt(0)
    s_barrier
    s_setprio 3
    ds_add_rtn_u32 v20, v20, v2
    ds_add_rtn_u32 v21, v21, v2
    ds_add_rtn_u32 v22, v22, v2
    ds_add_rtn_u32 v23, v23, v2
    ds_read_b128 v[12:15], v0 offset:20480
    v_cmp_gt_u32 vcc, 8448, v0
    ds_add_rtn_u32 v32, v32, v2
    ds_add_rtn_u32 v33, v33, v2
    ds_add_rtn_u32 v34, v34, v2
    ds_add_rtn_u32 v35, v35, v2
    s_setprio 2
    ds_add_rtn_u32 v40, v40, v2
    ds_add_rtn_u32 v41, v41, v2
    ds_add_rtn_u32 v42, v42, v2
    ds_add_rtn_u32 v43, v43, v2
    s_waitcnt lgkmcnt(8)
    s_cbranch_vccz L1_p1
    s_add_u32 s46, s35, 0x0
    s_mov_b64 exec, vcc
    buffer_store_dwordx4 v[12:15], v0, s[24:27], s46 offen sc1
    s_mov_b64 exec, -1
L1_p1:
    s_add_u32 s47, s98, 0x2800000
    v_lshlrev_b32 v116, 1, v1
    buffer_load_dwordx4 v[116:119], v116, s[8:11], s47 offen nt
    ds_add_rtn_u32 v52, v52, v2
    ds_add_rtn_u32 v53, v53, v2
    ds_add_rtn_u32 v54, v54, v2
    ds_add_rtn_u32 v55, v55, v2
    s_setprio 1
    ds_add_rtn_u32 v60, v60, v2
    ds_add_rtn_u32 v61, v61, v2
    ds_add_rtn_u32 v62, v62, v2
    ds_add_rtn_u32 v63, v63, v2
    ds_add_rtn_u32 v72, v72, v2
    ds_add_rtn_u32 v73, v73, v2
    ds_add_rtn_u32 v74, v74, v2
    ds_add_rtn_u32 v75, v75, v2
    s_add_u32 s44, s98, 0x2800000
    v_lshlrev_b32 v120, 1, v1
    buffer_load_dwordx4 v[120:123], v120, s[12:15], s44 offen nt
    s_setprio 0
    ds_add_rtn_u32 v80, v80, v2
    ds_add_rtn_u32 v81, v81, v2
    ds_add_rtn_u32 v82, v82, v2
    ds_add_rtn_u32 v83, v83, v2
    ds_add_rtn_u32 v92, v92, v2
    ds_add_rtn_u32 v93, v93, v2
    ds_add_rtn_u32 v94, v94, v2
    ds_add_rtn_u32 v95, v95, v2
    s_waitcnt lgkmcnt(0)
    s_barrier
    s_setprio 3
    v_and_b32 v7, -4, v20
    v_lshl_add_u32 v8, v20, 2, v7
    ds_write_b32 v8, v16
    v_lshl_add_u32 v7, v7, 2, v20
    ds_write_b8 v7, v24 offset:16
    v_and_b32 v9, -4, v21
    v_lshl_add_u32 v10, v21, 2, v9
    ds_write_b32 v10, v17
    v_lshl_add_u32 v9, v9, 2, v21
    ds_write_b8_d16_hi v9, v24 offset:16
    v_and_b32 v7, -4, v22
    v_lshl_add_u32 v8, v22, 2, v7
    ds_write_b32 v8, v18
    v_lshl_add_u32 v7, v7, 2, v22
    ds_write_b8 v7, v25 offset:16
    v_and_b32 v9, -4, v23
    v_lshl_add_u32 v10, v23, 2, v9
    ds_write_b32 v10, v19
    v_lshl_add_u32 v9, v9, 2, v23
    ds_write_b8_d16_hi v9, v25 offset:16
    s_add_u32 s45, s98, 0x2800000
    s_lshr_b32 s45, s45, 1
    buffer_load_dwordx2 v[124:125], v1, s[16:19], s45 offen nt
    s_add_u32 s46, s99, 0x2c00000
    s_lshr_b32 s46, s46, 1
    buffer_load_dwordx2 v[126:127], v1, s[16:19], s46 offen nt
    s_add_u32 s47, s99, 0x2c00000
    v_lshlrev_b32 v16, 1, v1
    buffer_load_dwordx4 v[16:19], v16, s[8:11], s47 offen nt
    v_and_b32 v7, -4, v32
    v_lshl_add_u32 v8, v32, 2, v7
    ds_write_b32 v8, v28
    v_lshl_add_u32 v7, v7, 2, v32
    ds_write_b8 v7, v26 offset:16
    v_and_b32 v9, -4, v33
    v_lshl_add_u32 v10, v33, 2, v9
    ds_write_b32 v10, v29
    v_lshl_add_u32 v9, v9, 2, v33
    ds_write_b8_d16_hi v9, v26 offset:16
    v_and_b32 v7, -4, v34
    v_lshl_add_u32 v8, v34, 2, v7
    ds_write_b32 v8, v30
    v_lshl_add_u32 v7, v7, 2, v34
    ds_write_b8 v7, v27 offset:16
    v_and_b32 v9, -4, v35
    v_lshl_add_u32 v10, v35, 2, v9
    ds_write_b32 v10, v31
    v_lshl_add_u32 v9, v9, 2, v35
    ds_write_b8_d16_hi v9, v27 offset:16
    s_add_u32 s44, s99, 0x2c00000
    v_lshlrev_b32 v20, 1, v1
    buffer_load_dwordx4 v[20:23], v20, s[12:15], s44 offen nt
    s_setprio 2
    v_and_b32 v7, -4, v40
    v_lshl_add_u32 v8, v40, 2, v7
    ds_write_b32 v8, v36
    v_lshl_add_u32 v7, v7, 2, v40
    ds_write_b8 v7, v44 offset:16
    v_and_b32 v9, -4, v41
    v_lshl_add_u32 v10, v41, 2, v9
    ds_write_b32 v10, v37
    v_lshl_add_u32 v9, v9, 2, v41
    ds_write_b8_d16_hi v9, v44 offset:16
    v_and_b32 v7, -4, v42
    v_lshl_add_u32 v8, v42, 2, v7
    ds_write_b32 v8, v38
    v_lshl_add_u32 v7, v7, 2, v42
    ds_write_b8 v7, v45 offset:16
    v_and_b32 v9, -4, v43
    v_lshl_add_u32 v10, v43, 2, v9
    ds_write_b32 v10, v39
    v_lshl_add_u32 v9, v9, 2, v43
    ds_write_b8_d16_hi v9, v45 offset:16
    s_add_u32 s45, s96, 0x3000000
    v_lshlrev_b32 v28, 1, v1
    buffer_load_dwordx4 v[28:31], v28, s[8:11], s45 offen nt
    s_add_u32 s46, s96, 0x3000000
    v_lshlrev_b32 v32, 1, v1
    buffer_load_dwordx4 v[32:35], v32, s[12:15], s46 offen nt
    v_and_b32 v7, -4, v52
    v_lshl_add_u32 v8, v52, 2, v7
    ds_write_b32 v8, v48
    v_lshl_add_u32 v7, v7, 2, v52
    ds_write_b8 v7, v46 offset:16
    v_and_b32 v9, -4, v53
    v_lshl_add_u32 v10, v53, 2, v9
    ds_write_b32 v10, v49
    v_lshl_add_u32 v9, v9, 2, v53
    ds_write_b8_d16_hi v9, v46 offset:16
    v_and_b32 v7, -4, v54
    v_lshl_add_u32 v8, v54, 2, v7
    ds_write_b32 v8, v50
    v_lshl_add_u32 v7, v7, 2, v54
    ds_write_b8 v7, v47 offset:16
    v_and_b32 v9, -4, v55
    v_lshl_add_u32 v10, v55, 2, v9
    ds_write_b32 v10, v51
    v_lshl_add_u32 v9, v9, 2, v55
    ds_write_b8_d16_hi v9, v47 offset:16
    s_add_u32 s47, s96, 0x3000000
    s_lshr_b32 s47, s47, 1
    buffer_load_dwordx2 v[24:25], v1, s[16:19], s47 offen nt
    s_add_u32 s44, s97, 0x3400000
    s_lshr_b32 s44, s44, 1
    buffer_load_dwordx2 v[26:27], v1, s[16:19], s44 offen nt
    s_setprio 1
    v_and_b32 v7, -4, v60
    v_lshl_add_u32 v8, v60, 2, v7
    ds_write_b32 v8, v56
    v_lshl_add_u32 v7, v7, 2, v60
    ds_write_b8 v7, v64 offset:16
    v_and_b32 v9, -4, v61
    v_lshl_add_u32 v10, v61, 2, v9
    ds_write_b32 v10, v57
    v_lshl_add_u32 v9, v9, 2, v61
    ds_write_b8_d16_hi v9, v64 offset:16
    v_and_b32 v7, -4, v62
    v_lshl_add_u32 v8, v62, 2, v7
    ds_write_b32 v8, v58
    v_lshl_add_u32 v7, v7, 2, v62
    ds_write_b8 v7, v65 offset:16
    v_and_b32 v9, -4, v63
    v_lshl_add_u32 v10, v63, 2, v9
    ds_write_b32 v10, v59
    v_lshl_add_u32 v9, v9, 2, v63
    ds_write_b8_d16_hi v9, v65 offset:16
    s_add_u32 s45, s97, 0x3400000
    v_lshlrev_b32 v36, 1, v1
    buffer_load_dwordx4 v[36:39], v36, s[8:11], s45 offen nt
    v_and_b32 v7, -4, v72
    v_lshl_add_u32 v8, v72, 2, v7
    ds_write_b32 v8, v68
    v_lshl_add_u32 v7, v7, 2, v72
    ds_write_b8 v7, v66 offset:16
    v_and_b32 v9, -4, v73
    v_lshl_add_u32 v10, v73, 2, v9
    ds_write_b32 v10, v69
    v_lshl_add_u32 v9, v9, 2, v73
    ds_write_b8_d16_hi v9, v66 offset:16
    v_and_b32 v7, -4, v74
    v_lshl_add_u32 v8, v74, 2, v7
    ds_write_b32 v8, v70
    v_lshl_add_u32 v7, v7, 2, v74
    ds_write_b8 v7, v67 offset:16
    v_and_b32 v9, -4, v75
    v_lshl_add_u32 v10, v75, 2, v9
    ds_write_b32 v10, v71
    v_lshl_add_u32 v9, v9, 2, v75
    ds_write_b8_d16_hi v9, v67 offset:16
    s_add_u32 s46, s97, 0x3400000
    v_lshlrev_b32 v40, 1, v1
    buffer_load_dwordx4 v[40:43], v40, s[12:15], s46 offen nt
    s_add_u32 s47, s98, 0x3800000
    v_lshlrev_b32 v48, 1, v1
    buffer_load_dwordx4 v[48:51], v48, s[8:11], s47 offen nt
    s_setprio 0
    v_and_b32 v7, -4, v80
    v_lshl_add_u32 v8, v80, 2, v7
    ds_write_b32 v8, v76
    v_lshl_add_u32 v7, v7, 2, v80
    ds_write_b8 v7, v84 offset:16
    v_and_b32 v9, -4, v81
    v_lshl_add_u32 v10, v81, 2, v9
    ds_write_b32 v10, v77
    v_lshl_add_u32 v9, v9, 2, v81
    ds_write_b8_d16_hi v9, v84 offset:16
    v_and_b32 v7, -4, v82
    v_lshl_add_u32 v8, v82, 2, v7
    ds_write_b32 v8, v78
    v_lshl_add_u32 v7, v7, 2, v82
    ds_write_b8 v7, v85 offset:16
    v_and_b32 v9, -4, v83
    v_lshl_add_u32 v10, v83, 2, v9
    ds_write_b32 v10, v79
    v_lshl_add_u32 v9, v9, 2, v83
    ds_write_b8_d16_hi v9, v85 offset:16
    s_add_u32 s44, s98, 0x3800000
    v_lshlrev_b32 v52, 1, v1
    buffer_load_dwordx4 v[52:55], v52, s[12:15], s44 offen nt
    v_and_b32 v7, -4, v92
    v_lshl_add_u32 v8, v92, 2, v7
    ds_write_b32 v8, v88
    v_lshl_add_u32 v7, v7, 2, v92
    ds_write_b8 v7, v86 offset:16
    v_and_b32 v9, -4, v93
    v_lshl_add_u32 v10, v93, 2, v9
    ds_write_b32 v10, v89
    v_lshl_add_u32 v9, v9, 2, v93
    ds_write_b8_d16_hi v9, v86 offset:16
    v_and_b32 v7, -4, v94
    v_lshl_add_u32 v8, v94, 2, v7
    ds_write_b32 v8, v90
    v_lshl_add_u32 v7, v7, 2, v94
    ds_write_b8 v7, v87 offset:16
    v_and_b32 v9, -4, v95
    v_lshl_add_u32 v10, v95, 2, v9
    ds_write_b32 v10, v91
    v_lshl_add_u32 v9, v9, 2, v95
    ds_write_b8_d16_hi v9, v87 offset:16
    s_add_u32 s45, s98, 0x3800000
    s_lshr_b32 s45, s45, 1
    buffer_load_dwordx2 v[44:45], v1, s[16:19], s45 offen nt
    s_add_u32 s46, s99, 0x3c00000
    s_lshr_b32 s46, s46, 1
    buffer_load_dwordx2 v[46:47], v1, s[16:19], s46 offen nt
    v_add_u32 v7, s72, v0
    v_add_u32 v12, s73, v0
    v_add_u32 v13, s85, v0
    v_add_u32 v14, s91, v0
    v_add_u32 v15, s93, v0
    s_min_i32 s3, s72, s73
    s_min_i32 s3, s3, s85
    s_min_i32 s3, s3, s91
    s_min_i32 s3, s3, s93
    v_add_u32 v3, s3, v0
    v_mov_b32 v8, 0
    v_mov_b32 v9, 0
    v_mov_b32 v10, 0
    v_mov_b32 v11, 0
    s_waitcnt lgkmcnt(0)
    s_barrier
    ds_read_b128 v[56:59], v7 offset:0
    ds_read_b128 v[60:63], v12 offset:0
    ds_read_b128 v[68:71], v13 offset:0
    ds_read_b128 v[72:75], v14 offset:0
    ds_read_b128 v[64:67], v15 offset:0
    ds_write_b128 v3, v[8:11]
    ds_read_b128 v[76:79], v7 offset:16384
    ds_read_b128 v[80:83], v12 offset:16384
    ds_read_b128 v[88:91], v13 offset:16384
    ds_read_b128 v[92:95], v14 offset:16384
    ds_read_b128 v[84:87], v15 offset:16384
    s_waitcnt lgkmcnt(0)
    s_barrier
    s_setprio 3
    s_add_u32 s47, s35, 0x4000
    s_add_u32 s47, s47, s72
    buffer_store_dwordx4 v[56:59], v0, s[20:23], s47 offen sc1
    s_add_u32 s44, s99, 0x3c00000
    s_nop 0
    v_lshlrev_b32 v56, 1, v1
    buffer_load_dwordx4 v[56:59], v56, s[8:11], s44 offen nt
    s_add_u32 s45, s35, 0x4000
    s_add_u32 s45, s45, s73
    buffer_store_dwordx4 v[60:63], v0, s[20:23], s45 offen sc1
    s_add_u32 s46, s99, 0x3c00000
    s_nop 0
    v_lshlrev_b32 v60, 1, v1
    buffer_load_dwordx4 v[60:63], v60, s[12:15], s46 offen nt
    s_waitcnt vmcnt(22)
    v_lshlrev_b32 v7, 16, v108
    v_and_b32 v8, 0xffff0000, v108
    v_lshlrev_b32 v9, 16, v109
    v_and_b32 v10, 0xffff0000, v109
    v_mul_f32 v7, 0.15915494, v7
    v_mul_f32 v8, 0.15915494, v8
    v_mul_f32 v9, 0.15915494, v9
    v_mul_f32 v10, 0.15915494, v10
    v_mul_hi_u32_u24 v14, 429497, v96
    v_lshrrev_b32 v12, 3, v104
    v_cos_f32 v7, v7
    v_lshlrev_b16 v13, 3, v104
    v_mad_i32_i24 v11, v14, s55, v96
    v_bitop3_b32 v12, v6, v13, v12 bitop3:0xca
    v_lshl_add_u32 v11, v11, 17, s40
    v_lshlrev_b16 v14, 8, v14
    v_lshrrev_b32 v13, 2, v104
    v_add_u32 v96, v12, v11
    v_bitop3_b32 v104, v5, v13, v14 bitop3:0xea
    ds_add_u32 v104, v2
    v_mul_hi_u32_u24 v14, 429497, v97
    v_lshrrev_b32 v12, 3, v105
    v_cos_f32 v8, v8
    v_lshlrev_b16 v13, 3, v105
    v_mad_i32_i24 v11, v14, s55, v97
    v_bitop3_b32 v12, v6, v13, v12 bitop3:0xca
    v_lshl_add_u32 v11, v11, 17, s40
    v_lshlrev_b16 v14, 8, v14
    v_lshrrev_b32 v13, 2, v105
    v_add_u32 v97, v12, v11
    v_bitop3_b32 v105, v5, v13, v14 bitop3:0xea
    ds_add_u32 v105, v2
    v_cvt_pk_bf16_f32 v108, v7, v8
    v_perm_b32 v12, v108, v108, s41
    v_bitop3_b32 v96, v4, v12, v96 bitop3:0xca
    v_perm_b32 v13, v108, v108, s42
    v_bitop3_b32 v97, v4, v13, v97 bitop3:0xca
    v_mul_hi_u32_u24 v14, 429497, v98
    v_lshrrev_b32 v12, 3, v106
    v_cos_f32 v9, v9
    v_lshlrev_b16 v13, 3, v106
    v_mad_i32_i24 v11, v14, s55, v98
    v_bitop3_b32 v12, v6, v13, v12 bitop3:0xca
    v_lshl_add_u32 v11, v11, 17, s40
    v_lshlrev_b16 v14, 8, v14
    v_lshrrev_b32 v13, 2, v106
    v_add_u32 v98, v12, v11
    v_bitop3_b32 v106, v5, v13, v14 bitop3:0xea
    ds_add_u32 v106, v2
    v_mul_hi_u32_u24 v14, 429497, v99
    v_lshrrev_b32 v12, 3, v107
    v_cos_f32 v10, v10
    v_lshlrev_b16 v13, 3, v107
    v_mad_i32_i24 v11, v14, s55, v99
    v_bitop3_b32 v12, v6, v13, v12 bitop3:0xca
    v_lshl_add_u32 v11, v11, 17, s40
    v_lshlrev_b16 v14, 8, v14
    v_lshrrev_b32 v13, 2, v107
    v_add_u32 v99, v12, v11
    v_bitop3_b32 v107, v5, v13, v14 bitop3:0xea
    ds_add_u32 v107, v2
    v_cvt_pk_bf16_f32 v109, v9, v10
    v_perm_b32 v12, v109, v109, s41
    v_bitop3_b32 v98, v4, v12, v98 bitop3:0xca
    v_perm_b32 v13, v109, v109, s42
    v_bitop3_b32 v99, v4, v13, v99 bitop3:0xca
    s_waitcnt vmcnt(20)
    v_lshlrev_b32 v7, 16, v110
    v_and_b32 v8, 0xffff0000, v110
    v_lshlrev_b32 v9, 16, v111
    v_and_b32 v10, 0xffff0000, v111
    v_mul_f32 v7, 0.15915494, v7
    v_mul_f32 v8, 0.15915494, v8
    v_mul_f32 v9, 0.15915494, v9
    v_mul_f32 v10, 0.15915494, v10
    v_mul_hi_u32_u24 v14, 429497, v100
    v_lshrrev_b32 v12, 3, v112
    v_cos_f32 v7, v7
    v_lshlrev_b16 v13, 3, v112
    v_mad_i32_i24 v11, v14, s55, v100
    v_bitop3_b32 v12, v6, v13, v12 bitop3:0xca
    v_lshl_add_u32 v11, v11, 17, s40
    v_lshlrev_b16 v14, 8, v14
    v_lshrrev_b32 v13, 2, v112
    v_add_u32 v100, v12, v11
    v_bitop3_b32 v112, v5, v13, v14 bitop3:0xea
    ds_add_u32 v112, v2
    v_mul_hi_u32_u24 v14, 429497, v101
    v_lshrrev_b32 v12, 3, v113
    v_cos_f32 v8, v8
    v_lshlrev_b16 v13, 3, v113
    v_mad_i32_i24 v11, v14, s55, v101
    v_bitop3_b32 v12, v6, v13, v12 bitop3:0xca
    v_lshl_add_u32 v11, v11, 17, s40
    v_lshlrev_b16 v14, 8, v14
    v_lshrrev_b32 v13, 2, v113
    v_add_u32 v101, v12, v11
    v_bitop3_b32 v113, v5, v13, v14 bitop3:0xea
    ds_add_u32 v113, v2
    v_cvt_pk_bf16_f32 v110, v7, v8
    v_perm_b32 v12, v110, v110, s41
    v_bitop3_b32 v100, v4, v12, v100 bitop3:0xca
    v_perm_b32 v13, v110, v110, s42
    v_bitop3_b32 v101, v4, v13, v101 bitop3:0xca
    v_mul_hi_u32_u24 v14, 429497, v102
    v_lshrrev_b32 v12, 3, v114
    v_cos_f32 v9, v9
    v_lshlrev_b16 v13, 3, v114
    v_mad_i32_i24 v11, v14, s55, v102
    v_bitop3_b32 v12, v6, v13, v12 bitop3:0xca
    v_lshl_add_u32 v11, v11, 17, s40
    v_lshlrev_b16 v14, 8, v14
    v_lshrrev_b32 v13, 2, v114
    v_add_u32 v102, v12, v11
    v_bitop3_b32 v114, v5, v13, v14 bitop3:0xea
    ds_add_u32 v114, v2
    v_mul_hi_u32_u24 v14, 429497, v103
    v_lshrrev_b32 v12, 3, v115
    v_cos_f32 v10, v10
    v_lshlrev_b16 v13, 3, v115
    v_mad_i32_i24 v11, v14, s55, v103
    v_bitop3_b32 v12, v6, v13, v12 bitop3:0xca
    v_lshl_add_u32 v11, v11, 17, s40
    v_lshlrev_b16 v14, 8, v14
    v_lshrrev_b32 v13, 2, v115
    v_add_u32 v103, v12, v11
    v_bitop3_b32 v115, v5, v13, v14 bitop3:0xea
    ds_add_u32 v115, v2
    v_cvt_pk_bf16_f32 v111, v9, v10
    v_perm_b32 v12, v111, v111, s41
    v_bitop3_b32 v102, v4, v12, v102 bitop3:0xca
    v_perm_b32 v13, v111, v111, s42
    v_bitop3_b32 v103, v4, v13, v103 bitop3:0xca
    s_setprio 2
    s_waitcnt vmcnt(16)
    v_lshlrev_b32 v7, 16, v124
    v_and_b32 v8, 0xffff0000, v124
    v_lshlrev_b32 v9, 16, v125
    v_and_b32 v10, 0xffff0000, v125
    v_mul_f32 v7, 0.15915494, v7
    v_mul_f32 v8, 0.15915494, v8
    v_mul_f32 v9, 0.15915494, v9
    v_mul_f32 v10, 0.15915494, v10
    v_mul_hi_u32_u24 v14, 429497, v116
    v_lshrrev_b32 v12, 3, v120
    v_cos_f32 v7, v7
    v_lshlrev_b16 v13, 3, v120
    v_mad_i32_i24 v11, v14, s55, v116
    v_bitop3_b32 v12, v6, v13, v12 bitop3:0xca
    v_lshl_add_u32 v11, v11, 17, s40
    v_lshlrev_b16 v14, 8, v14
    v_lshrrev_b32 v13, 2, v120
    v_add_u32 v116, v12, v11
    v_bitop3_b32 v120, v5, v13, v14 bitop3:0xea
    ds_add_u32 v120, v2
    v_mul_hi_u32_u24 v14, 429497, v117
    v_lshrrev_b32 v12, 3, v121
    v_cos_f32 v8, v8
    v_lshlrev_b16 v13, 3, v121
    v_mad_i32_i24 v11, v14, s55, v117
    v_bitop3_b32 v12, v6, v13, v12 bitop3:0xca
    v_lshl_add_u32 v11, v11, 17, s40
    v_lshlrev_b16 v14, 8, v14
    v_lshrrev_b32 v13, 2, v121
    v_add_u32 v117, v12, v11
    v_bitop3_b32 v121, v5, v13, v14 bitop3:0xea
    ds_add_u32 v121, v2
    v_cvt_pk_bf16_f32 v124, v7, v8
    v_perm_b32 v12, v124, v124, s41
    v_bitop3_b32 v116, v4, v12, v116 bitop3:0xca
    v_perm_b32 v13, v124, v124, s42
    v_bitop3_b32 v117, v4, v13, v117 bitop3:0xca
    v_mul_hi_u32_u24 v14, 429497, v118
    v_lshrrev_b32 v12, 3, v122
    v_cos_f32 v9, v9
    v_lshlrev_b16 v13, 3, v122
    v_mad_i32_i24 v11, v14, s55, v118
    v_bitop3_b32 v12, v6, v13, v12 bitop3:0xca
    v_lshl_add_u32 v11, v11, 17, s40
    v_lshlrev_b16 v14, 8, v14
    v_lshrrev_b32 v13, 2, v122
    v_add_u32 v118, v12, v11
    v_bitop3_b32 v122, v5, v13, v14 bitop3:0xea
    ds_add_u32 v122, v2
    v_mul_hi_u32_u24 v14, 429497, v119
    v_lshrrev_b32 v12, 3, v123
    v_cos_f32 v10, v10
    v_lshlrev_b16 v13, 3, v123
    v_mad_i32_i24 v11, v14, s55, v119
    v_bitop3_b32 v12, v6, v13, v12 bitop3:0xca
    v_lshl_add_u32 v11, v11, 17, s40
    v_lshlrev_b16 v14, 8, v14
    v_lshrrev_b32 v13, 2, v123
    v_add_u32 v119, v12, v11
    v_bitop3_b32 v123, v5, v13, v14 bitop3:0xea
    ds_add_u32 v123, v2
    v_cvt_pk_bf16_f32 v125, v9, v10
    v_perm_b32 v12, v125, v125, s41
    v_bitop3_b32 v118, v4, v12, v118 bitop3:0xca
    v_perm_b32 v13, v125, v125, s42
    v_bitop3_b32 v119, v4, v13, v119 bitop3:0xca
    s_add_u32 s47, s35, 0x4000
    s_add_u32 s47, s47, s85
    buffer_store_dwordx4 v[68:71], v0, s[20:23], s47 offen sc1
    s_add_u32 s44, s96, 0x4000000
    s_nop 0
    v_lshlrev_b32 v68, 1, v1
    buffer_load_dwordx4 v[68:71], v68, s[8:11], s44 offen nt
    s_waitcnt vmcnt(16)
    v_lshlrev_b32 v7, 16, v126
    v_and_b32 v8, 0xffff0000, v126
    v_lshlrev_b32 v9, 16, v127
    v_and_b32 v10, 0xffff0000, v127
    v_mul_f32 v7, 0.15915494, v7
    v_mul_f32 v8, 0.15915494, v8
    v_mul_f32 v9, 0.15915494, v9
    v_mul_f32 v10, 0.15915494, v10
    v_mul_hi_u32_u24 v14, 429497, v16
    v_lshrrev_b32 v12, 3, v20
    v_cos_f32 v7, v7
    v_lshlrev_b16 v13, 3, v20
    v_mad_i32_i24 v11, v14, s55, v16
    v_bitop3_b32 v12, v6, v13, v12 bitop3:0xca
    v_lshl_add_u32 v11, v11, 17, s40
    v_lshlrev_b16 v14, 8, v14
    v_lshrrev_b32 v13, 2, v20
    v_add_u32 v16, v12, v11
    v_bitop3_b32 v20, v5, v13, v14 bitop3:0xea
    ds_add_u32 v20, v2
    v_mul_hi_u32_u24 v14, 429497, v17
    v_lshrrev_b32 v12, 3, v21
    v_cos_f32 v8, v8
    v_lshlrev_b16 v13, 3, v21
    v_mad_i32_i24 v11, v14, s55, v17
    v_bitop3_b32 v12, v6, v13, v12 bitop3:0xca
    v_lshl_add_u32 v11, v11, 17, s40
    v_lshlrev_b16 v14, 8, v14
    v_lshrrev_b32 v13, 2, v21
    v_add_u32 v17, v12, v11
    v_bitop3_b32 v21, v5, v13, v14 bitop3:0xea
    ds_add_u32 v21, v2
    v_cvt_pk_bf16_f32 v126, v7, v8
    v_perm_b32 v12, v126, v126, s41
    v_bitop3_b32 v16, v4, v12, v16 bitop3:0xca
    v_perm_b32 v13, v126, v126, s42
    v_bitop3_b32 v17, v4, v13, v17 bitop3:0xca
    v_mul_hi_u32_u24 v14, 429497, v18
    v_lshrrev_b32 v12, 3, v22
    v_cos_f32 v9, v9
    v_lshlrev_b16 v13, 3, v22
    v_mad_i32_i24 v11, v14, s55, v18
    v_bitop3_b32 v12, v6, v13, v12 bitop3:0xca
    v_lshl_add_u32 v11, v11, 17, s40
    v_lshlrev_b16 v14, 8, v14
    v_lshrrev_b32 v13, 2, v22
    v_add_u32 v18, v12, v11
    v_bitop3_b32 v22, v5, v13, v14 bitop3:0xea
    ds_add_u32 v22, v2
    v_mul_hi_u32_u24 v14, 429497, v19
    v_lshrrev_b32 v12, 3, v23
    v_cos_f32 v10, v10
    v_lshlrev_b16 v13, 3, v23
    v_mad_i32_i24 v11, v14, s55, v19
    v_bitop3_b32 v12, v6, v13, v12 bitop3:0xca
    v_lshl_add_u32 v11, v11, 17, s40
    v_lshlrev_b16 v14, 8, v14
    v_lshrrev_b32 v13, 2, v23
    v_add_u32 v19, v12, v11
    v_bitop3_b32 v23, v5, v13, v14 bitop3:0xea
    ds_add_u32 v23, v2
    v_cvt_pk_bf16_f32 v127, v9, v10
    v_perm_b32 v12, v127, v127, s41
    v_bitop3_b32 v18, v4, v12, v18 bitop3:0xca
    v_perm_b32 v13, v127, v127, s42
    v_bitop3_b32 v19, v4, v13, v19 bitop3:0xca
    s_setprio 1
    s_waitcnt vmcnt(12)
    v_lshlrev_b32 v7, 16, v24
    v_and_b32 v8, 0xffff0000, v24
    v_lshlrev_b32 v9, 16, v25
    v_and_b32 v10, 0xffff0000, v25
    v_mul_f32 v7, 0.15915494, v7
    v_mul_f32 v8, 0.15915494, v8
    v_mul_f32 v9, 0.15915494, v9
    v_mul_f32 v10, 0.15915494, v10
    v_mul_hi_u32_u24 v14, 429497, v28
    v_lshrrev_b32 v12, 3, v32
    v_cos_f32 v7, v7
    v_lshlrev_b16 v13, 3, v32
    v_mad_i32_i24 v11, v14, s55, v28
    v_bitop3_b32 v12, v6, v13, v12 bitop3:0xca
    v_lshl_add_u32 v11, v11, 17, s40
    v_lshlrev_b16 v14, 8, v14
    v_lshrrev_b32 v13, 2, v32
    v_add_u32 v28, v12, v11
    v_bitop3_b32 v32, v5, v13, v14 bitop3:0xea
    ds_add_u32 v32, v2
    v_mul_hi_u32_u24 v14, 429497, v29
    v_lshrrev_b32 v12, 3, v33
    v_cos_f32 v8, v8
    v_lshlrev_b16 v13, 3, v33
    v_mad_i32_i24 v11, v14, s55, v29
    v_bitop3_b32 v12, v6, v13, v12 bitop3:0xca
    v_lshl_add_u32 v11, v11, 17, s40
    v_lshlrev_b16 v14, 8, v14
    v_lshrrev_b32 v13, 2, v33
    v_add_u32 v29, v12, v11
    v_bitop3_b32 v33, v5, v13, v14 bitop3:0xea
    ds_add_u32 v33, v2
    v_cvt_pk_bf16_f32 v24, v7, v8
    v_perm_b32 v12, v24, v24, s41
    v_bitop3_b32 v28, v4, v12, v28 bitop3:0xca
    v_perm_b32 v13, v24, v24, s42
    v_bitop3_b32 v29, v4, v13, v29 bitop3:0xca
    v_mul_hi_u32_u24 v14, 429497, v30
    v_lshrrev_b32 v12, 3, v34
    v_cos_f32 v9, v9
    v_lshlrev_b16 v13, 3, v34
    v_mad_i32_i24 v11, v14, s55, v30
    v_bitop3_b32 v12, v6, v13, v12 bitop3:0xca
    v_lshl_add_u32 v11, v11, 17, s40
    v_lshlrev_b16 v14, 8, v14
    v_lshrrev_b32 v13, 2, v34
    v_add_u32 v30, v12, v11
    v_bitop3_b32 v34, v5, v13, v14 bitop3:0xea
    ds_add_u32 v34, v2
    v_mul_hi_u32_u24 v14, 429497, v31
    v_lshrrev_b32 v12, 3, v35
    v_cos_f32 v10, v10
    v_lshlrev_b16 v13, 3, v35
    v_mad_i32_i24 v11, v14, s55, v31
    v_bitop3_b32 v12, v6, v13, v12 bitop3:0xca
    v_lshl_add_u32 v11, v11, 17, s40
    v_lshlrev_b16 v14, 8, v14
    v_lshrrev_b32 v13, 2, v35
    v_add_u32 v31, v12, v11
    v_bitop3_b32 v35, v5, v13, v14 bitop3:0xea
    ds_add_u32 v35, v2
    v_cvt_pk_bf16_f32 v25, v9, v10
    v_perm_b32 v12, v25, v25, s41
    v_bitop3_b32 v30, v4, v12, v30 bitop3:0xca
    v_perm_b32 v13, v25, v25, s42
    v_bitop3_b32 v31, v4, v13, v31 bitop3:0xca
    s_waitcnt vmcnt(10)
    v_lshlrev_b32 v7, 16, v26
    v_and_b32 v8, 0xffff0000, v26
    v_lshlrev_b32 v9, 16, v27
    v_and_b32 v10, 0xffff0000, v27
    v_mul_f32 v7, 0.15915494, v7
    v_mul_f32 v8, 0.15915494, v8
    v_mul_f32 v9, 0.15915494, v9
    v_mul_f32 v10, 0.15915494, v10
    v_mul_hi_u32_u24 v14, 429497, v36
    v_lshrrev_b32 v12, 3, v40
    v_cos_f32 v7, v7
    v_lshlrev_b16 v13, 3, v40
    v_mad_i32_i24 v11, v14, s55, v36
    v_bitop3_b32 v12, v6, v13, v12 bitop3:0xca
    v_lshl_add_u32 v11, v11, 17, s40
    v_lshlrev_b16 v14, 8, v14
    v_lshrrev_b32 v13, 2, v40
    v_add_u32 v36, v12, v11
    v_bitop3_b32 v40, v5, v13, v14 bitop3:0xea
    ds_add_u32 v40, v2
    v_mul_hi_u32_u24 v14, 429497, v37
    v_lshrrev_b32 v12, 3, v41
    v_cos_f32 v8, v8
    v_lshlrev_b16 v13, 3, v41
    v_mad_i32_i24 v11, v14, s55, v37
    v_bitop3_b32 v12, v6, v13, v12 bitop3:0xca
    v_lshl_add_u32 v11, v11, 17, s40
    v_lshlrev_b16 v14, 8, v14
    v_lshrrev_b32 v13, 2, v41
    v_add_u32 v37, v12, v11
    v_bitop3_b32 v41, v5, v13, v14 bitop3:0xea
    ds_add_u32 v41, v2
    v_cvt_pk_bf16_f32 v26, v7, v8
    v_perm_b32 v12, v26, v26, s41
    v_bitop3_b32 v36, v4, v12, v36 bitop3:0xca
    v_perm_b32 v13, v26, v26, s42
    v_bitop3_b32 v37, v4, v13, v37 bitop3:0xca
    v_mul_hi_u32_u24 v14, 429497, v38
    v_lshrrev_b32 v12, 3, v42
    v_cos_f32 v9, v9
    v_lshlrev_b16 v13, 3, v42
    v_mad_i32_i24 v11, v14, s55, v38
    v_bitop3_b32 v12, v6, v13, v12 bitop3:0xca
    v_lshl_add_u32 v11, v11, 17, s40
    v_lshlrev_b16 v14, 8, v14
    v_lshrrev_b32 v13, 2, v42
    v_add_u32 v38, v12, v11
    v_bitop3_b32 v42, v5, v13, v14 bitop3:0xea
    ds_add_u32 v42, v2
    v_mul_hi_u32_u24 v14, 429497, v39
    v_lshrrev_b32 v12, 3, v43
    v_cos_f32 v10, v10
    v_lshlrev_b16 v13, 3, v43
    v_mad_i32_i24 v11, v14, s55, v39
    v_bitop3_b32 v12, v6, v13, v12 bitop3:0xca
    v_lshl_add_u32 v11, v11, 17, s40
    v_lshlrev_b16 v14, 8, v14
    v_lshrrev_b32 v13, 2, v43
    v_add_u32 v39, v12, v11
    v_bitop3_b32 v43, v5, v13, v14 bitop3:0xea
    ds_add_u32 v43, v2
    v_cvt_pk_bf16_f32 v27, v9, v10
    v_perm_b32 v12, v27, v27, s41
    v_bitop3_b32 v38, v4, v12, v38 bitop3:0xca
    v_perm_b32 v13, v27, v27, s42
    v_bitop3_b32 v39, v4, v13, v39 bitop3:0xca
    s_setprio 0
    s_add_u32 s45, s35, 0x4000
    s_add_u32 s45, s45, s91
    buffer_store_dwordx4 v[72:75], v0, s[20:23], s45 offen sc1
    s_add_u32 s46, s96, 0x4000000
    s_nop 0
    v_lshlrev_b32 v72, 1, v1
    buffer_load_dwordx4 v[72:75], v72, s[12:15], s46 offen nt
    s_waitcnt vmcnt(8)
    v_lshlrev_b32 v7, 16, v44
    v_and_b32 v8, 0xffff0000, v44
    v_lshlrev_b32 v9, 16, v45
    v_and_b32 v10, 0xffff0000, v45
    v_mul_f32 v7, 0.15915494, v7
    v_mul_f32 v8, 0.15915494, v8
    v_mul_f32 v9, 0.15915494, v9
    v_mul_f32 v10, 0.15915494, v10
    v_mul_hi_u32_u24 v14, 429497, v48
    v_lshrrev_b32 v12, 3, v52
    v_cos_f32 v7, v7
    v_lshlrev_b16 v13, 3, v52
    v_mad_i32_i24 v11, v14, s55, v48
    v_bitop3_b32 v12, v6, v13, v12 bitop3:0xca
    v_lshl_add_u32 v11, v11, 17, s40
    v_lshlrev_b16 v14, 8, v14
    v_lshrrev_b32 v13, 2, v52
    v_add_u32 v48, v12, v11
    v_bitop3_b32 v52, v5, v13, v14 bitop3:0xea
    ds_add_u32 v52, v2
    v_mul_hi_u32_u24 v14, 429497, v49
    v_lshrrev_b32 v12, 3, v53
    v_cos_f32 v8, v8
    v_lshlrev_b16 v13, 3, v53
    v_mad_i32_i24 v11, v14, s55, v49
    v_bitop3_b32 v12, v6, v13, v12 bitop3:0xca
    v_lshl_add_u32 v11, v11, 17, s40
    v_lshlrev_b16 v14, 8, v14
    v_lshrrev_b32 v13, 2, v53
    v_add_u32 v49, v12, v11
    v_bitop3_b32 v53, v5, v13, v14 bitop3:0xea
    ds_add_u32 v53, v2
    v_cvt_pk_bf16_f32 v44, v7, v8
    v_perm_b32 v12, v44, v44, s41
    v_bitop3_b32 v48, v4, v12, v48 bitop3:0xca
    v_perm_b32 v13, v44, v44, s42
    v_bitop3_b32 v49, v4, v13, v49 bitop3:0xca
    v_mul_hi_u32_u24 v14, 429497, v50
    v_lshrrev_b32 v12, 3, v54
    v_cos_f32 v9, v9
    v_lshlrev_b16 v13, 3, v54
    v_mad_i32_i24 v11, v14, s55, v50
    v_bitop3_b32 v12, v6, v13, v12 bitop3:0xca
    v_lshl_add_u32 v11, v11, 17, s40
    v_lshlrev_b16 v14, 8, v14
    v_lshrrev_b32 v13, 2, v54
    v_add_u32 v50, v12, v11
    v_bitop3_b32 v54, v5, v13, v14 bitop3:0xea
    ds_add_u32 v54, v2
    v_mul_hi_u32_u24 v14, 429497, v51
    v_lshrrev_b32 v12, 3, v55
    v_cos_f32 v10, v10
    v_lshlrev_b16 v13, 3, v55
    v_mad_i32_i24 v11, v14, s55, v51
    v_bitop3_b32 v12, v6, v13, v12 bitop3:0xca
    v_lshl_add_u32 v11, v11, 17, s40
    v_lshlrev_b16 v14, 8, v14
    v_lshrrev_b32 v13, 2, v55
    v_add_u32 v51, v12, v11
    v_bitop3_b32 v55, v5, v13, v14 bitop3:0xea
    ds_add_u32 v55, v2
    v_cvt_pk_bf16_f32 v45, v9, v10
    v_perm_b32 v12, v45, v45, s41
    v_bitop3_b32 v50, v4, v12, v50 bitop3:0xca
    v_perm_b32 v13, v45, v45, s42
    v_bitop3_b32 v51, v4, v13, v51 bitop3:0xca
    s_waitcnt vmcnt(4)
    v_lshlrev_b32 v7, 16, v46
    v_and_b32 v8, 0xffff0000, v46
    v_lshlrev_b32 v9, 16, v47
    v_and_b32 v10, 0xffff0000, v47
    v_mul_f32 v7, 0.15915494, v7
    v_mul_f32 v8, 0.15915494, v8
    v_mul_f32 v9, 0.15915494, v9
    v_mul_f32 v10, 0.15915494, v10
    v_mul_hi_u32_u24 v14, 429497, v56
    v_lshrrev_b32 v12, 3, v60
    v_cos_f32 v7, v7
    v_lshlrev_b16 v13, 3, v60
    v_mad_i32_i24 v11, v14, s55, v56
    v_bitop3_b32 v12, v6, v13, v12 bitop3:0xca
    v_lshl_add_u32 v11, v11, 17, s40
    v_lshlrev_b16 v14, 8, v14
    v_lshrrev_b32 v13, 2, v60
    v_add_u32 v56, v12, v11
    v_bitop3_b32 v60, v5, v13, v14 bitop3:0xea
    ds_add_u32 v60, v2
    v_mul_hi_u32_u24 v14, 429497, v57
    v_lshrrev_b32 v12, 3, v61
    v_cos_f32 v8, v8
    v_lshlrev_b16 v13, 3, v61
    v_mad_i32_i24 v11, v14, s55, v57
    v_bitop3_b32 v12, v6, v13, v12 bitop3:0xca
    v_lshl_add_u32 v11, v11, 17, s40
    v_lshlrev_b16 v14, 8, v14
    v_lshrrev_b32 v13, 2, v61
    v_add_u32 v57, v12, v11
    v_bitop3_b32 v61, v5, v13, v14 bitop3:0xea
    ds_add_u32 v61, v2
    v_cvt_pk_bf16_f32 v46, v7, v8
    v_perm_b32 v12, v46, v46, s41
    v_bitop3_b32 v56, v4, v12, v56 bitop3:0xca
    v_perm_b32 v13, v46, v46, s42
    v_bitop3_b32 v57, v4, v13, v57 bitop3:0xca
    v_mul_hi_u32_u24 v14, 429497, v58
    v_lshrrev_b32 v12, 3, v62
    v_cos_f32 v9, v9
    v_lshlrev_b16 v13, 3, v62
    v_mad_i32_i24 v11, v14, s55, v58
    v_bitop3_b32 v12, v6, v13, v12 bitop3:0xca
    v_lshl_add_u32 v11, v11, 17, s40
    v_lshlrev_b16 v14, 8, v14
    v_lshrrev_b32 v13, 2, v62
    v_add_u32 v58, v12, v11
    v_bitop3_b32 v62, v5, v13, v14 bitop3:0xea
    ds_add_u32 v62, v2
    v_mul_hi_u32_u24 v14, 429497, v59
    v_lshrrev_b32 v12, 3, v63
    v_cos_f32 v10, v10
    v_lshlrev_b16 v13, 3, v63
    v_mad_i32_i24 v11, v14, s55, v59
    v_bitop3_b32 v12, v6, v13, v12 bitop3:0xca
    v_lshl_add_u32 v11, v11, 17, s40
    v_lshlrev_b16 v14, 8, v14
    v_lshrrev_b32 v13, 2, v63
    v_add_u32 v59, v12, v11
    v_bitop3_b32 v63, v5, v13, v14 bitop3:0xea
    ds_add_u32 v63, v2
    v_cvt_pk_bf16_f32 v47, v9, v10
    v_perm_b32 v12, v47, v47, s41
    v_bitop3_b32 v58, v4, v12, v58 bitop3:0xca
    v_perm_b32 v13, v47, v47, s42
    v_bitop3_b32 v59, v4, v13, v59 bitop3:0xca
    v_lshrrev_b32 v8, 2, v0
    v_and_b32 v7, 0x3c00, v0
    v_bitop3_b32 v7, v5, v8, v7 bitop3:0xea
    s_waitcnt lgkmcnt(0)
    s_barrier
    ds_read2st64_b32 v[8:9], v7 offset0:0 offset1:1
    ds_read2st64_b32 v[10:11], v7 offset0:2 offset1:3
    s_add_u32 s47, s35, 0x4000
    s_add_u32 s47, s47, s93
    buffer_store_dwordx4 v[64:67], v0, s[20:23], s47 offen sc1
    s_add_u32 s44, s96, 0x4000000
    s_lshr_b32 s44, s44, 1
    buffer_load_dwordx2 v[64:65], v1, s[16:19], s44 offen nt
    s_add_u32 s45, s97, 0x4400000
    s_lshr_b32 s45, s45, 1
    buffer_load_dwordx2 v[66:67], v1, s[16:19], s45 offen nt
    s_waitcnt lgkmcnt(0)
    v_lshl_or_b32 v12, v9, 16, v8
    v_lshl_or_b32 v13, v11, 16, v10
    v_mov_b32 v14, v12
    v_mov_b32 v15, v13
    s_nop 0
    v_add_u32_dpp v14, v14, v14 row_shr:1 row_mask:0xf bank_mask:0xf bound_ctrl:1
    v_add_u32_dpp v15, v15, v15 row_shr:1 row_mask:0xf bank_mask:0xf bound_ctrl:1
    s_nop 0
    v_add_u32_dpp v14, v14, v14 row_shr:2 row_mask:0xf bank_mask:0xf bound_ctrl:1
    v_add_u32_dpp v15, v15, v15 row_shr:2 row_mask:0xf bank_mask:0xf bound_ctrl:1
    s_nop 0
    v_add_u32_dpp v14, v14, v14 row_shr:4 row_mask:0xf bank_mask:0xf bound_ctrl:1
    v_add_u32_dpp v15, v15, v15 row_shr:4 row_mask:0xf bank_mask:0xf bound_ctrl:1
    s_nop 0
    v_add_u32_dpp v14, v14, v14 row_shr:8 row_mask:0xf bank_mask:0xf bound_ctrl:1
    v_add_u32_dpp v15, v15, v15 row_shr:8 row_mask:0xf bank_mask:0xf bound_ctrl:1
    s_nop 0
    v_add_u32_dpp v14, v14, v14 row_bcast:15 row_mask:0xa bank_mask:0xf
    v_add_u32_dpp v15, v15, v15 row_bcast:15 row_mask:0xa bank_mask:0xf
    s_nop 0
    v_add_u32_dpp v14, v14, v14 row_bcast:31 row_mask:0xc bank_mask:0xf
    v_add_u32_dpp v15, v15, v15 row_bcast:31 row_mask:0xc bank_mask:0xf
    v_readlane_b32 s48, v14, 63
    v_readlane_b32 s49, v15, 63
    s_lshl_b32 s54, s32, 2
    v_mov_b32 v8, s54
    s_and_b32 s50, s48, 0xffff
    s_lshr_b32 s51, s48, 16
    s_and_b32 s52, s49, 0xffff
    s_lshr_b32 s53, s49, 16
    s_add_u32 s51, s51, s50
    s_add_u32 s52, s52, s51
    s_add_u32 s53, s53, s52
    v_mov_b32 v9, s53
    s_mov_b64 exec, 1
    ds_write_b32 v8, v9 offset:16384
    s_mov_b64 exec, -1
    v_and_b32 v8, 60, v7
    s_waitcnt lgkmcnt(0)
    s_barrier
    ds_read_b32 v9, v8 offset:16384
    s_waitcnt lgkmcnt(0)
    v_add_u32_dpp v9, v9, v9 row_shr:1 row_mask:0xf bank_mask:0xf bound_ctrl:1
    s_nop 1
    v_add_u32_dpp v9, v9, v9 row_shr:2 row_mask:0xf bank_mask:0xf bound_ctrl:1
    s_nop 1
    v_add_u32_dpp v9, v9, v9 row_shr:4 row_mask:0xf bank_mask:0xf bound_ctrl:1
    s_nop 1
    v_add_u32_dpp v9, v9, v9 row_shr:8 row_mask:0xf bank_mask:0xf bound_ctrl:1
    s_nop 0
    v_readlane_b32 s54, v9, s32
    s_sub_u32 s54, s54, s53
    s_add_u32 s50, s50, s54
    s_add_u32 s51, s51, s54
    s_add_u32 s52, s52, s54
    s_pack_ll_b32_b16 s48, s54, s50
    s_pack_ll_b32_b16 s49, s51, s52
    v_add_u32 v14, s48, v14
    v_add_u32 v15, s49, v15
    v_sub_u32 v12, v14, v12
    v_sub_u32 v13, v15, v13
    v_and_b32 v8, 0xffff, v12
    v_lshrrev_b32 v9, 16, v12
    v_and_b32 v10, 0xffff, v13
    v_lshrrev_b32 v11, 16, v13
    ds_write2st64_b32 v7, v8, v9 offset0:0 offset1:1
    ds_write2st64_b32 v7, v10, v11 offset0:2 offset1:3
    v_and_b32 v8, 0x3f0, v0
    v_lshl_add_u32 v8, v8, 1, s36
    ds_write_b64 v8, v[12:13] offset:20480
    s_bitset0_b64 exec, 63
    s_not_b64 exec, exec
    ds_write_b64 v8, v[14:15] offset:20512
    s_mov_b64 exec, -1
    s_waitcnt lgkmcnt(0)
    s_barrier
    s_setprio 3
    ds_add_rtn_u32 v104, v104, v2
    ds_add_rtn_u32 v105, v105, v2
    ds_add_rtn_u32 v106, v106, v2
    ds_add_rtn_u32 v107, v107, v2
    ds_read_b128 v[12:15], v0 offset:20480
    v_cmp_gt_u32 vcc, 8448, v0
    ds_add_rtn_u32 v112, v112, v2
    ds_add_rtn_u32 v113, v113, v2
    ds_add_rtn_u32 v114, v114, v2
    ds_add_rtn_u32 v115, v115, v2
    s_setprio 2
    ds_add_rtn_u32 v120, v120, v2
    ds_add_rtn_u32 v121, v121, v2
    ds_add_rtn_u32 v122, v122, v2
    ds_add_rtn_u32 v123, v123, v2
    s_waitcnt lgkmcnt(8)
    s_cbranch_vccz L1_p2
    s_add_u32 s46, s35, 0x2a40000
    s_mov_b64 exec, vcc
    buffer_store_dwordx4 v[12:15], v0, s[24:27], s46 offen sc1
    s_mov_b64 exec, -1
L1_p2:
    s_add_u32 s47, s35, 0x8000
    s_add_u32 s47, s47, s72
    buffer_store_dwordx4 v[76:79], v0, s[20:23], s47 offen sc1
    s_add_u32 s44, s97, 0x4400000
    s_nop 0
    v_lshlrev_b32 v76, 1, v1
    buffer_load_dwordx4 v[76:79], v76, s[8:11], s44 offen nt
    ds_add_rtn_u32 v20, v20, v2
    ds_add_rtn_u32 v21, v21, v2
    ds_add_rtn_u32 v22, v22, v2
    ds_add_rtn_u32 v23, v23, v2
    s_setprio 1
    ds_add_rtn_u32 v32, v32, v2
    ds_add_rtn_u32 v33, v33, v2
    ds_add_rtn_u32 v34, v34, v2
    ds_add_rtn_u32 v35, v35, v2
    ds_add_rtn_u32 v40, v40, v2
    ds_add_rtn_u32 v41, v41, v2
    ds_add_rtn_u32 v42, v42, v2
    ds_add_rtn_u32 v43, v43, v2
    s_add_u32 s45, s35, 0x8000
    s_add_u32 s45, s45, s73
    buffer_store_dwordx4 v[80:83], v0, s[20:23], s45 offen sc1
    s_add_u32 s46, s97, 0x4400000
    s_nop 0
    v_lshlrev_b32 v80, 1, v1
    buffer_load_dwordx4 v[80:83], v80, s[12:15], s46 offen nt
    s_setprio 0
    ds_add_rtn_u32 v52, v52, v2
    ds_add_rtn_u32 v53, v53, v2
    ds_add_rtn_u32 v54, v54, v2
    ds_add_rtn_u32 v55, v55, v2
    ds_add_rtn_u32 v60, v60, v2
    ds_add_rtn_u32 v61, v61, v2
    ds_add_rtn_u32 v62, v62, v2
    ds_add_rtn_u32 v63, v63, v2
    s_waitcnt lgkmcnt(0)
    s_barrier
    s_setprio 3
    v_and_b32 v7, -4, v104
    v_lshl_add_u32 v8, v104, 2, v7
    ds_write_b32 v8, v96
    v_lshl_add_u32 v7, v7, 2, v104
    ds_write_b8 v7, v108 offset:16
    v_and_b32 v9, -4, v105
    v_lshl_add_u32 v10, v105, 2, v9
    ds_write_b32 v10, v97
    v_lshl_add_u32 v9, v9, 2, v105
    ds_write_b8_d16_hi v9, v108 offset:16
    v_and_b32 v7, -4, v106
    v_lshl_add_u32 v8, v106, 2, v7
    ds_write_b32 v8, v98
    v_lshl_add_u32 v7, v7, 2, v106
    ds_write_b8 v7, v109 offset:16
    v_and_b32 v9, -4, v107
    v_lshl_add_u32 v10, v107, 2, v9
    ds_write_b32 v10, v99
    v_lshl_add_u32 v9, v9, 2, v107
    ds_write_b8_d16_hi v9, v109 offset:16
    s_add_u32 s47, s35, 0x8000
    s_add_u32 s47, s47, s85
    buffer_store_dwordx4 v[88:91], v0, s[20:23], s47 offen sc1
    s_add_u32 s44, s98, 0x4800000
    v_lshlrev_b32 v96, 1, v1
    buffer_load_dwordx4 v[96:99], v96, s[8:11], s44 offen nt
    s_add_u32 s45, s98, 0x4800000
    v_lshlrev_b32 v104, 1, v1
    buffer_load_dwordx4 v[104:107], v104, s[12:15], s45 offen nt
    v_and_b32 v7, -4, v112
    v_lshl_add_u32 v8, v112, 2, v7
    ds_write_b32 v8, v100
    v_lshl_add_u32 v7, v7, 2, v112
    ds_write_b8 v7, v110 offset:16
    v_and_b32 v9, -4, v113
    v_lshl_add_u32 v10, v113, 2, v9
    ds_write_b32 v10, v101
    v_lshl_add_u32 v9, v9, 2, v113
    ds_write_b8_d16_hi v9, v110 offset:16
    v_and_b32 v7, -4, v114
    v_lshl_add_u32 v8, v114, 2, v7
    ds_write_b32 v8, v102
    v_lshl_add_u32 v7, v7, 2, v114
    ds_write_b8 v7, v111 offset:16
    v_and_b32 v9, -4, v115
    v_lshl_add_u32 v10, v115, 2, v9
    ds_write_b32 v10, v103
    v_lshl_add_u32 v9, v9, 2, v115
    ds_write_b8_d16_hi v9, v111 offset:16
    s_add_u32 s46, s98, 0x4800000
    s_lshr_b32 s46, s46, 1
    buffer_load_dwordx2 v[88:89], v1, s[16:19], s46 offen nt
    s_add_u32 s47, s99, 0x4c00000
    s_lshr_b32 s47, s47, 1
    buffer_load_dwordx2 v[90:91], v1, s[16:19], s47 offen nt
    s_add_u32 s44, s99, 0x4c00000
    v_lshlrev_b32 v100, 1, v1
    buffer_load_dwordx4 v[100:103], v100, s[8:11], s44 offen nt
    s_setprio 2
    v_and_b32 v7, -4, v120
    v_lshl_add_u32 v8, v120, 2, v7
    ds_write_b32 v8, v116
    v_lshl_add_u32 v7, v7, 2, v120
    ds_write_b8 v7, v124 offset:16
    v_and_b32 v9, -4, v121
    v_lshl_add_u32 v10, v121, 2, v9
    ds_write_b32 v10, v117
    v_lshl_add_u32 v9, v9, 2, v121
    ds_write_b8_d16_hi v9, v124 offset:16
    v_and_b32 v7, -4, v122
    v_lshl_add_u32 v8, v122, 2, v7
    ds_write_b32 v8, v118
    v_lshl_add_u32 v7, v7, 2, v122
    ds_write_b8 v7, v125 offset:16
    v_and_b32 v9, -4, v123
    v_lshl_add_u32 v10, v123, 2, v9
    ds_write_b32 v10, v119
    v_lshl_add_u32 v9, v9, 2, v123
    ds_write_b8_d16_hi v9, v125 offset:16
    s_add_u32 s45, s35, 0x8000
    s_add_u32 s45, s45, s91
    buffer_store_dwordx4 v[92:95], v0, s[20:23], s45 offen sc1
    s_add_u32 s46, s99, 0x4c00000
    v_lshlrev_b32 v112, 1, v1
    buffer_load_dwordx4 v[112:115], v112, s[12:15], s46 offen nt
    v_and_b32 v7, -4, v20
    v_lshl_add_u32 v8, v20, 2, v7
    ds_write_b32 v8, v16
    v_lshl_add_u32 v7, v7, 2, v20
    ds_write_b8 v7, v126 offset:16
    v_and_b32 v9, -4, v21
    v_lshl_add_u32 v10, v21, 2, v9
    ds_write_b32 v10, v17
    v_lshl_add_u32 v9, v9, 2, v21
    ds_write_b8_d16_hi v9, v126 offset:16
    v_and_b32 v7, -4, v22
    v_lshl_add_u32 v8, v22, 2, v7
    ds_write_b32 v8, v18
    v_lshl_add_u32 v7, v7, 2, v22
    ds_write_b8 v7, v127 offset:16
    v_and_b32 v9, -4, v23
    v_lshl_add_u32 v10, v23, 2, v9
    ds_write_b32 v10, v19
    v_lshl_add_u32 v9, v9, 2, v23
    ds_write_b8_d16_hi v9, v127 offset:16
    s_add_u32 s47, s96, 0x5000000
    v_lshlrev_b32 v108, 1, v1
    buffer_load_dwordx4 v[108:111], v108, s[8:11], s47 offen nt
    s_add_u32 s44, s96, 0x5000000
    v_lshlrev_b32 v116, 1, v1
    buffer_load_dwordx4 v[116:119], v116, s[12:15], s44 offen nt
    s_setprio 1
    v_and_b32 v7, -4, v32
    v_lshl_add_u32 v8, v32, 2, v7
    ds_write_b32 v8, v28
    v_lshl_add_u32 v7, v7, 2, v32
    ds_write_b8 v7, v24 offset:16
    v_and_b32 v9, -4, v33
    v_lshl_add_u32 v10, v33, 2, v9
    ds_write_b32 v10, v29
    v_lshl_add_u32 v9, v9, 2, v33
    ds_write_b8_d16_hi v9, v24 offset:16
    v_and_b32 v7, -4, v34
    v_lshl_add_u32 v8, v34, 2, v7
    ds_write_b32 v8, v30
    v_lshl_add_u32 v7, v7, 2, v34
    ds_write_b8 v7, v25 offset:16
    v_and_b32 v9, -4, v35
    v_lshl_add_u32 v10, v35, 2, v9
    ds_write_b32 v10, v31
    v_lshl_add_u32 v9, v9, 2, v35
    ds_write_b8_d16_hi v9, v25 offset:16
    s_add_u32 s45, s96, 0x5000000
    s_lshr_b32 s45, s45, 1
    buffer_load_dwordx2 v[120:121], v1, s[16:19], s45 offen nt
    s_add_u32 s46, s97, 0x5400000
    s_lshr_b32 s46, s46, 1
    buffer_load_dwordx2 v[122:123], v1, s[16:19], s46 offen nt
    s_add_u32 s47, s97, 0x5400000
    v_lshlrev_b32 v92, 1, v1
    buffer_load_dwordx4 v[92:95], v92, s[8:11], s47 offen nt
    v_and_b32 v7, -4, v40
    v_lshl_add_u32 v8, v40, 2, v7
    ds_write_b32 v8, v36
    v_lshl_add_u32 v7, v7, 2, v40
    ds_write_b8 v7, v26 offset:16
    v_and_b32 v9, -4, v41
    v_lshl_add_u32 v10, v41, 2, v9
    ds_write_b32 v10, v37
    v_lshl_add_u32 v9, v9, 2, v41
    ds_write_b8_d16_hi v9, v26 offset:16
    v_and_b32 v7, -4, v42
    v_lshl_add_u32 v8, v42, 2, v7
    ds_write_b32 v8, v38
    v_lshl_add_u32 v7, v7, 2, v42
    ds_write_b8 v7, v27 offset:16
    v_and_b32 v9, -4, v43
    v_lshl_add_u32 v10, v43, 2, v9
    ds_write_b32 v10, v39
    v_lshl_add_u32 v9, v9, 2, v43
    ds_write_b8_d16_hi v9, v27 offset:16
    s_add_u32 s44, s35, 0x8000
    s_add_u32 s44, s44, s93
    buffer_store_dwordx4 v[84:87], v0, s[20:23], s44 offen sc1
    s_add_u32 s45, s97, 0x5400000
    v_lshlrev_b32 v16, 1, v1
    buffer_load_dwordx4 v[16:19], v16, s[12:15], s45 offen nt
    s_setprio 0
    v_and_b32 v7, -4, v52
    v_lshl_add_u32 v8, v52, 2, v7
    ds_write_b32 v8, v48
    v_lshl_add_u32 v7, v7, 2, v52
    ds_write_b8 v7, v44 offset:16
    v_and_b32 v9, -4, v53
    v_lshl_add_u32 v10, v53, 2, v9
    ds_write_b32 v10, v49
    v_lshl_add_u32 v9, v9, 2, v53
    ds_write_b8_d16_hi v9, v44 offset:16
    v_and_b32 v7, -4, v54
    v_lshl_add_u32 v8, v54, 2, v7
    ds_write_b32 v8, v50
    v_lshl_add_u32 v7, v7, 2, v54
    ds_write_b8 v7, v45 offset:16
    v_and_b32 v9, -4, v55
    v_lshl_add_u32 v10, v55, 2, v9
    ds_write_b32 v10, v51
    v_lshl_add_u32 v9, v9, 2, v55
    ds_write_b8_d16_hi v9, v45 offset:16
    s_add_u32 s46, s98, 0x5800000
    v_lshlrev_b32 v20, 1, v1
    buffer_load_dwordx4 v[20:23], v20, s[8:11], s46 offen nt
    s_add_u32 s47, s98, 0x5800000
    v_lshlrev_b32 v124, 1, v1
    buffer_load_dwordx4 v[124:127], v124, s[12:15], s47 offen nt
    v_and_b32 v7, -4, v60
    v_lshl_add_u32 v8, v60, 2, v7
    ds_write_b32 v8, v56
    v_lshl_add_u32 v7, v7, 2, v60
    ds_write_b8 v7, v46 offset:16
    v_and_b32 v9, -4, v61
    v_lshl_add_u32 v10, v61, 2, v9
    ds_write_b32 v10, v57
    v_lshl_add_u32 v9, v9, 2, v61
    ds_write_b8_d16_hi v9, v46 offset:16
    v_and_b32 v7, -4, v62
    v_lshl_add_u32 v8, v62, 2, v7
    ds_write_b32 v8, v58
    v_lshl_add_u32 v7, v7, 2, v62
    ds_write_b8 v7, v47 offset:16
    v_and_b32 v9, -4, v63
    v_lshl_add_u32 v10, v63, 2, v9
    ds_write_b32 v10, v59
    v_lshl_add_u32 v9, v9, 2, v63
    ds_write_b8_d16_hi v9, v47 offset:16
    s_add_u32 s44, s98, 0x5800000
    s_lshr_b32 s44, s44, 1
    buffer_load_dwordx2 v[28:29], v1, s[16:19], s44 offen nt
    s_add_u32 s45, s99, 0x5c00000
    s_lshr_b32 s45, s45, 1
    buffer_load_dwordx2 v[30:31], v1, s[16:19], s45 offen nt
    v_add_u32 v7, s72, v0
    v_add_u32 v12, s73, v0
    v_add_u32 v13, s85, v0
    v_add_u32 v14, s91, v0
    v_add_u32 v15, s93, v0
    s_min_i32 s3, s72, s73
    s_min_i32 s3, s3, s85
    s_min_i32 s3, s3, s91
    s_min_i32 s3, s3, s93
    v_add_u32 v3, s3, v0
    v_mov_b32 v8, 0
    v_mov_b32 v9, 0
    v_mov_b32 v10, 0
    v_mov_b32 v11, 0
    s_waitcnt lgkmcnt(0)
    s_barrier
    ds_read_b128 v[32:35], v7 offset:0
    ds_read_b128 v[36:39], v12 offset:0
    ds_read_b128 v[40:43], v13 offset:0
    ds_read_b128 v[24:27], v14 offset:0
    ds_read_b128 v[84:87], v15 offset:0
    ds_write_b128 v3, v[8:11]
    ds_read_b128 v[48:51], v7 offset:16384
    ds_read_b128 v[52:55], v12 offset:16384
    ds_read_b128 v[56:59], v13 offset:16384
    ds_read_b128 v[60:63], v14 offset:16384
    ds_read_b128 v[44:47], v15 offset:16384
    s_waitcnt lgkmcnt(0)
    s_barrier
    s_setprio 3
    s_add_u32 s46, s35, 0x2a44000
    s_add_u32 s46, s46, s72
    buffer_store_dwordx4 v[32:35], v0, s[20:23], s46 offen sc1
    s_add_u32 s47, s99, 0x5c00000
    s_nop 0
    v_lshlrev_b32 v32, 1, v1
    buffer_load_dwordx4 v[32:35], v32, s[8:11], s47 offen nt
    s_add_u32 s44, s35, 0x2a44000
    s_add_u32 s44, s44, s73
    buffer_store_dwordx4 v[36:39], v0, s[20:23], s44 offen sc1
    s_add_u32 s45, s99, 0x5c00000
    s_nop 0
    v_lshlrev_b32 v36, 1, v1
    buffer_load_dwordx4 v[36:39], v36, s[12:15], s45 offen nt
    s_waitcnt vmcnt(27)
    v_lshlrev_b32 v7, 16, v64
    v_and_b32 v8, 0xffff0000, v64
    v_lshlrev_b32 v9, 16, v65
    v_and_b32 v10, 0xffff0000, v65
    v_mul_f32 v7, 0.15915494, v7
    v_mul_f32 v8, 0.15915494, v8
    v_mul_f32 v9, 0.15915494, v9
    v_mul_f32 v10, 0.15915494, v10
    v_mul_hi_u32_u24 v14, 429497, v68
    v_lshrrev_b32 v12, 3, v72
    v_cos_f32 v7, v7
    v_lshlrev_b16 v13, 3, v72
    v_mad_i32_i24 v11, v14, s55, v68
    v_bitop3_b32 v12, v6, v13, v12 bitop3:0xca
    v_lshl_add_u32 v11, v11, 17, s40
    v_lshlrev_b16 v14, 8, v14
    v_lshrrev_b32 v13, 2, v72
    v_add_u32 v68, v12, v11
    v_bitop3_b32 v72, v5, v13, v14 bitop3:0xea
    ds_add_u32 v72, v2
    v_mul_hi_u32_u24 v14, 429497, v69
    v_lshrrev_b32 v12, 3, v73
    v_cos_f32 v8, v8
    v_lshlrev_b16 v13, 3, v73
    v_mad_i32_i24 v11, v14, s55, v69
    v_bitop3_b32 v12, v6, v13, v12 bitop3:0xca
    v_lshl_add_u32 v11, v11, 17, s40
    v_lshlrev_b16 v14, 8, v14
    v_lshrrev_b32 v13, 2, v73
    v_add_u32 v69, v12, v11
    v_bitop3_b32 v73, v5, v13, v14 bitop3:0xea
    ds_add_u32 v73, v2
    v_cvt_pk_bf16_f32 v64, v7, v8
    v_perm_b32 v12, v64, v64, s41
    v_bitop3_b32 v68, v4, v12, v68 bitop3:0xca
    v_perm_b32 v13, v64, v64, s42
    v_bitop3_b32 v69, v4, v13, v69 bitop3:0xca
    v_mul_hi_u32_u24 v14, 429497, v70
    v_lshrrev_b32 v12, 3, v74
    v_cos_f32 v9, v9
    v_lshlrev_b16 v13, 3, v74
    v_mad_i32_i24 v11, v14, s55, v70
    v_bitop3_b32 v12, v6, v13, v12 bitop3:0xca
    v_lshl_add_u32 v11, v11, 17, s40
    v_lshlrev_b16 v14, 8, v14
    v_lshrrev_b32 v13, 2, v74
    v_add_u32 v70, v12, v11
    v_bitop3_b32 v74, v5, v13, v14 bitop3:0xea
    ds_add_u32 v74, v2
    v_mul_hi_u32_u24 v14, 429497, v71
    v_lshrrev_b32 v12, 3, v75
    v_cos_f32 v10, v10
    v_lshlrev_b16 v13, 3, v75
    v_mad_i32_i24 v11, v14, s55, v71
    v_bitop3_b32 v12, v6, v13, v12 bitop3:0xca
    v_lshl_add_u32 v11, v11, 17, s40
    v_lshlrev_b16 v14, 8, v14
    v_lshrrev_b32 v13, 2, v75
    v_add_u32 v71, v12, v11
    v_bitop3_b32 v75, v5, v13, v14 bitop3:0xea
    ds_add_u32 v75, v2
    v_cvt_pk_bf16_f32 v65, v9, v10
    v_perm_b32 v12, v65, v65, s41
    v_bitop3_b32 v70, v4, v12, v70 bitop3:0xca
    v_perm_b32 v13, v65, v65, s42
    v_bitop3_b32 v71, v4, v13, v71 bitop3:0xca
    s_waitcnt vmcnt(23)
    v_lshlrev_b32 v7, 16, v66
    v_and_b32 v8, 0xffff0000, v66
    v_lshlrev_b32 v9, 16, v67
    v_and_b32 v10, 0xffff0000, v67
    v_mul_f32 v7, 0.15915494, v7
    v_mul_f32 v8, 0.15915494, v8
    v_mul_f32 v9, 0.15915494, v9
    v_mul_f32 v10, 0.15915494, v10
    v_mul_hi_u32_u24 v14, 429497, v76
    v_lshrrev_b32 v12, 3, v80
    v_cos_f32 v7, v7
    v_lshlrev_b16 v13, 3, v80
    v_mad_i32_i24 v11, v14, s55, v76
    v_bitop3_b32 v12, v6, v13, v12 bitop3:0xca
    v_lshl_add_u32 v11, v11, 17, s40
    v_lshlrev_b16 v14, 8, v14
    v_lshrrev_b32 v13, 2, v80
    v_add_u32 v76, v12, v11
    v_bitop3_b32 v80, v5, v13, v14 bitop3:0xea
    ds_add_u32 v80, v2
    v_mul_hi_u32_u24 v14, 429497, v77
    v_lshrrev_b32 v12, 3, v81
    v_cos_f32 v8, v8
    v_lshlrev_b16 v13, 3, v81
    v_mad_i32_i24 v11, v14, s55, v77
    v_bitop3_b32 v12, v6, v13, v12 bitop3:0xca
    v_lshl_add_u32 v11, v11, 17, s40
    v_lshlrev_b16 v14, 8, v14
    v_lshrrev_b32 v13, 2, v81
    v_add_u32 v77, v12, v11
    v_bitop3_b32 v81, v5, v13, v14 bitop3:0xea
    ds_add_u32 v81, v2
    v_cvt_pk_bf16_f32 v66, v7, v8
    v_perm_b32 v12, v66, v66, s41
    v_bitop3_b32 v76, v4, v12, v76 bitop3:0xca
    v_perm_b32 v13, v66, v66, s42
    v_bitop3_b32 v77, v4, v13, v77 bitop3:0xca
    v_mul_hi_u32_u24 v14, 429497, v78
    v_lshrrev_b32 v12, 3, v82
    v_cos_f32 v9, v9
    v_lshlrev_b16 v13, 3, v82
    v_mad_i32_i24 v11, v14, s55, v78
    v_bitop3_b32 v12, v6, v13, v12 bitop3:0xca
    v_lshl_add_u32 v11, v11, 17, s40
    v_lshlrev_b16 v14, 8, v14
    v_lshrrev_b32 v13, 2, v82
    v_add_u32 v78, v12, v11
    v_bitop3_b32 v82, v5, v13, v14 bitop3:0xea
    ds_add_u32 v82, v2
    v_mul_hi_u32_u24 v14, 429497, v79
    v_lshrrev_b32 v12, 3, v83
    v_cos_f32 v10, v10
    v_lshlrev_b16 v13, 3, v83
    v_mad_i32_i24 v11, v14, s55, v79
    v_bitop3_b32 v12, v6, v13, v12 bitop3:0xca
    v_lshl_add_u32 v11, v11, 17, s40
    v_lshlrev_b16 v14, 8, v14
    v_lshrrev_b32 v13, 2, v83
    v_add_u32 v79, v12, v11
    v_bitop3_b32 v83, v5, v13, v14 bitop3:0xea
    ds_add_u32 v83, v2
    v_cvt_pk_bf16_f32 v67, v9, v10
    v_perm_b32 v12, v67, v67, s41
    v_bitop3_b32 v78, v4, v12, v78 bitop3:0xca
    v_perm_b32 v13, v67, v67, s42
    v_bitop3_b32 v79, v4, v13, v79 bitop3:0xca
    s_setprio 2
    s_waitcnt vmcnt(18)
    v_lshlrev_b32 v7, 16, v88
    v_and_b32 v8, 0xffff0000, v88
    v_lshlrev_b32 v9, 16, v89
    v_and_b32 v10, 0xffff0000, v89
    v_mul_f32 v7, 0.15915494, v7
    v_mul_f32 v8, 0.15915494, v8
    v_mul_f32 v9, 0.15915494, v9
    v_mul_f32 v10, 0.15915494, v10
    v_mul_hi_u32_u24 v14, 429497, v96
    v_lshrrev_b32 v12, 3, v104
    v_cos_f32 v7, v7
    v_lshlrev_b16 v13, 3, v104
    v_mad_i32_i24 v11, v14, s55, v96
    v_bitop3_b32 v12, v6, v13, v12 bitop3:0xca
    v_lshl_add_u32 v11, v11, 17, s40
    v_lshlrev_b16 v14, 8, v14
    v_lshrrev_b32 v13, 2, v104
    v_add_u32 v96, v12, v11
    v_bitop3_b32 v104, v5, v13, v14 bitop3:0xea
    ds_add_u32 v104, v2
    v_mul_hi_u32_u24 v14, 429497, v97
    v_lshrrev_b32 v12, 3, v105
    v_cos_f32 v8, v8
    v_lshlrev_b16 v13, 3, v105
    v_mad_i32_i24 v11, v14, s55, v97
    v_bitop3_b32 v12, v6, v13, v12 bitop3:0xca
    v_lshl_add_u32 v11, v11, 17, s40
    v_lshlrev_b16 v14, 8, v14
    v_lshrrev_b32 v13, 2, v105
    v_add_u32 v97, v12, v11
    v_bitop3_b32 v105, v5, v13, v14 bitop3:0xea
    ds_add_u32 v105, v2
    v_cvt_pk_bf16_f32 v88, v7, v8
    v_perm_b32 v12, v88, v88, s41
    v_bitop3_b32 v96, v4, v12, v96 bitop3:0xca
    v_perm_b32 v13, v88, v88, s42
    v_bitop3_b32 v97, v4, v13, v97 bitop3:0xca
    v_mul_hi_u32_u24 v14, 429497, v98
    v_lshrrev_b32 v12, 3, v106
    v_cos_f32 v9, v9
    v_lshlrev_b16 v13, 3, v106
    v_mad_i32_i24 v11, v14, s55, v98
    v_bitop3_b32 v12, v6, v13, v12 bitop3:0xca
    v_lshl_add_u32 v11, v11, 17, s40
    v_lshlrev_b16 v14, 8, v14
    v_lshrrev_b32 v13, 2, v106
    v_add_u32 v98, v12, v11
    v_bitop3_b32 v106, v5, v13, v14 bitop3:0xea
    ds_add_u32 v106, v2
    v_mul_hi_u32_u24 v14, 429497, v99
    v_lshrrev_b32 v12, 3, v107
    v_cos_f32 v10, v10
    v_lshlrev_b16 v13, 3, v107
    v_mad_i32_i24 v11, v14, s55, v99
    v_bitop3_b32 v12, v6, v13, v12 bitop3:0xca
    v_lshl_add_u32 v11, v11, 17, s40
    v_lshlrev_b16 v14, 8, v14
    v_lshrrev_b32 v13, 2, v107
    v_add_u32 v99, v12, v11
    v_bitop3_b32 v107, v5, v13, v14 bitop3:0xea
    ds_add_u32 v107, v2
    v_cvt_pk_bf16_f32 v89, v9, v10
    v_perm_b32 v12, v89, v89, s41
    v_bitop3_b32 v98, v4, v12, v98 bitop3:0xca
    v_perm_b32 v13, v89, v89, s42
    v_bitop3_b32 v99, v4, v13, v99 bitop3:0xca
    s_add_u32 s46, s35, 0x2a44000
    s_add_u32 s46, s46, s85
    buffer_store_dwordx4 v[40:43], v0, s[20:23], s46 offen sc1
    s_add_u32 s47, s96, 0x6000000
    s_nop 0
    v_lshlrev_b32 v40, 1, v1
    buffer_load_dwordx4 v[40:43], v40, s[8:11], s47 offen nt
    s_waitcnt vmcnt(17)
    v_lshlrev_b32 v7, 16, v90
    v_and_b32 v8, 0xffff0000, v90
    v_lshlrev_b32 v9, 16, v91
    v_and_b32 v10, 0xffff0000, v91
    v_mul_f32 v7, 0.15915494, v7
    v_mul_f32 v8, 0.15915494, v8
    v_mul_f32 v9, 0.15915494, v9
    v_mul_f32 v10, 0.15915494, v10
    v_mul_hi_u32_u24 v14, 429497, v100
    v_lshrrev_b32 v12, 3, v112
    v_cos_f32 v7, v7
    v_lshlrev_b16 v13, 3, v112
    v_mad_i32_i24 v11, v14, s55, v100
    v_bitop3_b32 v12, v6, v13, v12 bitop3:0xca
    v_lshl_add_u32 v11, v11, 17, s40
    v_lshlrev_b16 v14, 8, v14
    v_lshrrev_b32 v13, 2, v112
    v_add_u32 v100, v12, v11
    v_bitop3_b32 v112, v5, v13, v14 bitop3:0xea
    ds_add_u32 v112, v2
    v_mul_hi_u32_u24 v14, 429497, v101
    v_lshrrev_b32 v12, 3, v113
    v_cos_f32 v8, v8
    v_lshlrev_b16 v13, 3, v113
    v_mad_i32_i24 v11, v14, s55, v101
    v_bitop3_b32 v12, v6, v13, v12 bitop3:0xca
    v_lshl_add_u32 v11, v11, 17, s40
    v_lshlrev_b16 v14, 8, v14
    v_lshrrev_b32 v13, 2, v113
    v_add_u32 v101, v12, v11
    v_bitop3_b32 v113, v5, v13, v14 bitop3:0xea
    ds_add_u32 v113, v2
    v_cvt_pk_bf16_f32 v90, v7, v8
    v_perm_b32 v12, v90, v90, s41
    v_bitop3_b32 v100, v4, v12, v100 bitop3:0xca
    v_perm_b32 v13, v90, v90, s42
    v_bitop3_b32 v101, v4, v13, v101 bitop3:0xca
    v_mul_hi_u32_u24 v14, 429497, v102
    v_lshrrev_b32 v12, 3, v114
    v_cos_f32 v9, v9
    v_lshlrev_b16 v13, 3, v114
    v_mad_i32_i24 v11, v14, s55, v102
    v_bitop3_b32 v12, v6, v13, v12 bitop3:0xca
    v_lshl_add_u32 v11, v11, 17, s40
    v_lshlrev_b16 v14, 8, v14
    v_lshrrev_b32 v13, 2, v114
    v_add_u32 v102, v12, v11
    v_bitop3_b32 v114, v5, v13, v14 bitop3:0xea
    ds_add_u32 v114, v2
    v_mul_hi_u32_u24 v14, 429497, v103
    v_lshrrev_b32 v12, 3, v115
    v_cos_f32 v10, v10
    v_lshlrev_b16 v13, 3, v115
    v_mad_i32_i24 v11, v14, s55, v103
    v_bitop3_b32 v12, v6, v13, v12 bitop3:0xca
    v_lshl_add_u32 v11, v11, 17, s40
    v_lshlrev_b16 v14, 8, v14
    v_lshrrev_b32 v13, 2, v115
    v_add_u32 v103, v12, v11
    v_bitop3_b32 v115, v5, v13, v14 bitop3:0xea
    ds_add_u32 v115, v2
    v_cvt_pk_bf16_f32 v91, v9, v10
    v_perm_b32 v12, v91, v91, s41
    v_bitop3_b32 v102, v4, v12, v102 bitop3:0xca
    v_perm_b32 v13, v91, v91, s42
    v_bitop3_b32 v103, v4, v13, v103 bitop3:0xca
    s_setprio 1
    s_waitcnt vmcnt(13)
    v_lshlrev_b32 v7, 16, v120
    v_and_b32 v8, 0xffff0000, v120
    v_lshlrev_b32 v9, 16, v121
    v_and_b32 v10, 0xffff0000, v121
    v_mul_f32 v7, 0.15915494, v7
    v_mul_f32 v8, 0.15915494, v8
    v_mul_f32 v9, 0.15915494, v9
    v_mul_f32 v10, 0.15915494, v10
    v_mul_hi_u32_u24 v14, 429497, v108
    v_lshrrev_b32 v12, 3, v116
    v_cos_f32 v7, v7
    v_lshlrev_b16 v13, 3, v116
    v_mad_i32_i24 v11, v14, s55, v108
    v_bitop3_b32 v12, v6, v13, v12 bitop3:0xca
    v_lshl_add_u32 v11, v11, 17, s40
    v_lshlrev_b16 v14, 8, v14
    v_lshrrev_b32 v13, 2, v116
    v_add_u32 v108, v12, v11
    v_bitop3_b32 v116, v5, v13, v14 bitop3:0xea
    ds_add_u32 v116, v2
    v_mul_hi_u32_u24 v14, 429497, v109
    v_lshrrev_b32 v12, 3, v117
    v_cos_f32 v8, v8
    v_lshlrev_b16 v13, 3, v117
    v_mad_i32_i24 v11, v14, s55, v109
    v_bitop3_b32 v12, v6, v13, v12 bitop3:0xca
    v_lshl_add_u32 v11, v11, 17, s40
    v_lshlrev_b16 v14, 8, v14
    v_lshrrev_b32 v13, 2, v117
    v_add_u32 v109, v12, v11
    v_bitop3_b32 v117, v5, v13, v14 bitop3:0xea
    ds_add_u32 v117, v2
    v_cvt_pk_bf16_f32 v120, v7, v8
    v_perm_b32 v12, v120, v120, s41
    v_bitop3_b32 v108, v4, v12, v108 bitop3:0xca
    v_perm_b32 v13, v120, v120, s42
    v_bitop3_b32 v109, v4, v13, v109 bitop3:0xca
    v_mul_hi_u32_u24 v14, 429497, v110
    v_lshrrev_b32 v12, 3, v118
    v_cos_f32 v9, v9
    v_lshlrev_b16 v13, 3, v118
    v_mad_i32_i24 v11, v14, s55, v110
    v_bitop3_b32 v12, v6, v13, v12 bitop3:0xca
    v_lshl_add_u32 v11, v11, 17, s40
    v_lshlrev_b16 v14, 8, v14
    v_lshrrev_b32 v13, 2, v118
    v_add_u32 v110, v12, v11
    v_bitop3_b32 v118, v5, v13, v14 bitop3:0xea
    ds_add_u32 v118, v2
    v_mul_hi_u32_u24 v14, 429497, v111
    v_lshrrev_b32 v12, 3, v119
    v_cos_f32 v10, v10
    v_lshlrev_b16 v13, 3, v119
    v_mad_i32_i24 v11, v14, s55, v111
    v_bitop3_b32 v12, v6, v13, v12 bitop3:0xca
    v_lshl_add_u32 v11, v11, 17, s40
    v_lshlrev_b16 v14, 8, v14
    v_lshrrev_b32 v13, 2, v119
    v_add_u32 v111, v12, v11
    v_bitop3_b32 v119, v5, v13, v14 bitop3:0xea
    ds_add_u32 v119, v2
    v_cvt_pk_bf16_f32 v121, v9, v10
    v_perm_b32 v12, v121, v121, s41
    v_bitop3_b32 v110, v4, v12, v110 bitop3:0xca
    v_perm_b32 v13, v121, v121, s42
    v_bitop3_b32 v111, v4, v13, v111 bitop3:0xca
    s_waitcnt vmcnt(10)
    v_lshlrev_b32 v7, 16, v122
    v_and_b32 v8, 0xffff0000, v122
    v_lshlrev_b32 v9, 16, v123
    v_and_b32 v10, 0xffff0000, v123
    v_mul_f32 v7, 0.15915494, v7
    v_mul_f32 v8, 0.15915494, v8
    v_mul_f32 v9, 0.15915494, v9
    v_mul_f32 v10, 0.15915494, v10
    v_mul_hi_u32_u24 v14, 429497, v92
    v_lshrrev_b32 v12, 3, v16
    v_cos_f32 v7, v7
    v_lshlrev_b16 v13, 3, v16
    v_mad_i32_i24 v11, v14, s55, v92
    v_bitop3_b32 v12, v6, v13, v12 bitop3:0xca
    v_lshl_add_u32 v11, v11, 17, s40
    v_lshlrev_b16 v14, 8, v14
    v_lshrrev_b32 v13, 2, v16
    v_add_u32 v92, v12, v11
    v_bitop3_b32 v16, v5, v13, v14 bitop3:0xea
    ds_add_u32 v16, v2
    v_mul_hi_u32_u24 v14, 429497, v93
    v_lshrrev_b32 v12, 3, v17
    v_cos_f32 v8, v8
    v_lshlrev_b16 v13, 3, v17
    v_mad_i32_i24 v11, v14, s55, v93
    v_bitop3_b32 v12, v6, v13, v12 bitop3:0xca
    v_lshl_add_u32 v11, v11, 17, s40
    v_lshlrev_b16 v14, 8, v14
    v_lshrrev_b32 v13, 2, v17
    v_add_u32 v93, v12, v11
    v_bitop3_b32 v17, v5, v13, v14 bitop3:0xea
    ds_add_u32 v17, v2
    v_cvt_pk_bf16_f32 v122, v7, v8
    v_perm_b32 v12, v122, v122, s41
    v_bitop3_b32 v92, v4, v12, v92 bitop3:0xca
    v_perm_b32 v13, v122, v122, s42
    v_bitop3_b32 v93, v4, v13, v93 bitop3:0xca
    v_mul_hi_u32_u24 v14, 429497, v94
    v_lshrrev_b32 v12, 3, v18
    v_cos_f32 v9, v9
    v_lshlrev_b16 v13, 3, v18
    v_mad_i32_i24 v11, v14, s55, v94
    v_bitop3_b32 v12, v6, v13, v12 bitop3:0xca
    v_lshl_add_u32 v11, v11, 17, s40
    v_lshlrev_b16 v14, 8, v14
    v_lshrrev_b32 v13, 2, v18
    v_add_u32 v94, v12, v11
    v_bitop3_b32 v18, v5, v13, v14 bitop3:0xea
    ds_add_u32 v18, v2
    v_mul_hi_u32_u24 v14, 429497, v95
    v_lshrrev_b32 v12, 3, v19
    v_cos_f32 v10, v10
    v_lshlrev_b16 v13, 3, v19
    v_mad_i32_i24 v11, v14, s55, v95
    v_bitop3_b32 v12, v6, v13, v12 bitop3:0xca
    v_lshl_add_u32 v11, v11, 17, s40
    v_lshlrev_b16 v14, 8, v14
    v_lshrrev_b32 v13, 2, v19
    v_add_u32 v95, v12, v11
    v_bitop3_b32 v19, v5, v13, v14 bitop3:0xea
    ds_add_u32 v19, v2
    v_cvt_pk_bf16_f32 v123, v9, v10
    v_perm_b32 v12, v123, v123, s41
    v_bitop3_b32 v94, v4, v12, v94 bitop3:0xca
    v_perm_b32 v13, v123, v123, s42
    v_bitop3_b32 v95, v4, v13, v95 bitop3:0xca
    s_setprio 0
    s_add_u32 s44, s35, 0x2a44000
    s_add_u32 s44, s44, s91
    buffer_store_dwordx4 v[24:27], v0, s[20:23], s44 offen sc1
    s_add_u32 s45, s96, 0x6000000
    s_nop 0
    v_lshlrev_b32 v24, 1, v1
    buffer_load_dwordx4 v[24:27], v24, s[12:15], s45 offen nt
    s_waitcnt vmcnt(8)
    v_lshlrev_b32 v7, 16, v28
    v_and_b32 v8, 0xffff0000, v28
    v_lshlrev_b32 v9, 16, v29
    v_and_b32 v10, 0xffff0000, v29
    v_mul_f32 v7, 0.15915494, v7
    v_mul_f32 v8, 0.15915494, v8
    v_mul_f32 v9, 0.15915494, v9
    v_mul_f32 v10, 0.15915494, v10
    v_mul_hi_u32_u24 v14, 429497, v20
    v_lshrrev_b32 v12, 3, v124
    v_cos_f32 v7, v7
    v_lshlrev_b16 v13, 3, v124
    v_mad_i32_i24 v11, v14, s55, v20
    v_bitop3_b32 v12, v6, v13, v12 bitop3:0xca
    v_lshl_add_u32 v11, v11, 17, s40
    v_lshlrev_b16 v14, 8, v14
    v_lshrrev_b32 v13, 2, v124
    v_add_u32 v20, v12, v11
    v_bitop3_b32 v124, v5, v13, v14 bitop3:0xea
    ds_add_u32 v124, v2
    v_mul_hi_u32_u24 v14, 429497, v21
    v_lshrrev_b32 v12, 3, v125
    v_cos_f32 v8, v8
    v_lshlrev_b16 v13, 3, v125
    v_mad_i32_i24 v11, v14, s55, v21
    v_bitop3_b32 v12, v6, v13, v12 bitop3:0xca
    v_lshl_add_u32 v11, v11, 17, s40
    v_lshlrev_b16 v14, 8, v14
    v_lshrrev_b32 v13, 2, v125
    v_add_u32 v21, v12, v11
    v_bitop3_b32 v125, v5, v13, v14 bitop3:0xea
    ds_add_u32 v125, v2
    v_cvt_pk_bf16_f32 v28, v7, v8
    v_perm_b32 v12, v28, v28, s41
    v_bitop3_b32 v20, v4, v12, v20 bitop3:0xca
    v_perm_b32 v13, v28, v28, s42
    v_bitop3_b32 v21, v4, v13, v21 bitop3:0xca
    v_mul_hi_u32_u24 v14, 429497, v22
    v_lshrrev_b32 v12, 3, v126
    v_cos_f32 v9, v9
    v_lshlrev_b16 v13, 3, v126
    v_mad_i32_i24 v11, v14, s55, v22
    v_bitop3_b32 v12, v6, v13, v12 bitop3:0xca
    v_lshl_add_u32 v11, v11, 17, s40
    v_lshlrev_b16 v14, 8, v14
    v_lshrrev_b32 v13, 2, v126
    v_add_u32 v22, v12, v11
    v_bitop3_b32 v126, v5, v13, v14 bitop3:0xea
    ds_add_u32 v126, v2
    v_mul_hi_u32_u24 v14, 429497, v23
    v_lshrrev_b32 v12, 3, v127
    v_cos_f32 v10, v10
    v_lshlrev_b16 v13, 3, v127
    v_mad_i32_i24 v11, v14, s55, v23
    v_bitop3_b32 v12, v6, v13, v12 bitop3:0xca
    v_lshl_add_u32 v11, v11, 17, s40
    v_lshlrev_b16 v14, 8, v14
    v_lshrrev_b32 v13, 2, v127
    v_add_u32 v23, v12, v11
    v_bitop3_b32 v127, v5, v13, v14 bitop3:0xea
    ds_add_u32 v127, v2
    v_cvt_pk_bf16_f32 v29, v9, v10
    v_perm_b32 v12, v29, v29, s41
    v_bitop3_b32 v22, v4, v12, v22 bitop3:0xca
    v_perm_b32 v13, v29, v29, s42
    v_bitop3_b32 v23, v4, v13, v23 bitop3:0xca
    s_waitcnt vmcnt(4)
    v_lshlrev_b32 v7, 16, v30
    v_and_b32 v8, 0xffff0000, v30
    v_lshlrev_b32 v9, 16, v31
    v_and_b32 v10, 0xffff0000, v31
    v_mul_f32 v7, 0.15915494, v7
    v_mul_f32 v8, 0.15915494, v8
    v_mul_f32 v9, 0.15915494, v9
    v_mul_f32 v10, 0.15915494, v10
    v_mul_hi_u32_u24 v14, 429497, v32
    v_lshrrev_b32 v12, 3, v36
    v_cos_f32 v7, v7
    v_lshlrev_b16 v13, 3, v36
    v_mad_i32_i24 v11, v14, s55, v32
    v_bitop3_b32 v12, v6, v13, v12 bitop3:0xca
    v_lshl_add_u32 v11, v11, 17, s40
    v_lshlrev_b16 v14, 8, v14
    v_lshrrev_b32 v13, 2, v36
    v_add_u32 v32, v12, v11
    v_bitop3_b32 v36, v5, v13, v14 bitop3:0xea
    ds_add_u32 v36, v2
    v_mul_hi_u32_u24 v14, 429497, v33
    v_lshrrev_b32 v12, 3, v37
    v_cos_f32 v8, v8
    v_lshlrev_b16 v13, 3, v37
    v_mad_i32_i24 v11, v14, s55, v33
    v_bitop3_b32 v12, v6, v13, v12 bitop3:0xca
    v_lshl_add_u32 v11, v11, 17, s40
    v_lshlrev_b16 v14, 8, v14
    v_lshrrev_b32 v13, 2, v37
    v_add_u32 v33, v12, v11
    v_bitop3_b32 v37, v5, v13, v14 bitop3:0xea
    ds_add_u32 v37, v2
    v_cvt_pk_bf16_f32 v30, v7, v8
    v_perm_b32 v12, v30, v30, s41
    v_bitop3_b32 v32, v4, v12, v32 bitop3:0xca
    v_perm_b32 v13, v30, v30, s42
    v_bitop3_b32 v33, v4, v13, v33 bitop3:0xca
    v_mul_hi_u32_u24 v14, 429497, v34
    v_lshrrev_b32 v12, 3, v38
    v_cos_f32 v9, v9
    v_lshlrev_b16 v13, 3, v38
    v_mad_i32_i24 v11, v14, s55, v34
    v_bitop3_b32 v12, v6, v13, v12 bitop3:0xca
    v_lshl_add_u32 v11, v11, 17, s40
    v_lshlrev_b16 v14, 8, v14
    v_lshrrev_b32 v13, 2, v38
    v_add_u32 v34, v12, v11
    v_bitop3_b32 v38, v5, v13, v14 bitop3:0xea
    ds_add_u32 v38, v2
    v_mul_hi_u32_u24 v14, 429497, v35
    v_lshrrev_b32 v12, 3, v39
    v_cos_f32 v10, v10
    v_lshlrev_b16 v13, 3, v39
    v_mad_i32_i24 v11, v14, s55, v35
    v_bitop3_b32 v12, v6, v13, v12 bitop3:0xca
    v_lshl_add_u32 v11, v11, 17, s40
    v_lshlrev_b16 v14, 8, v14
    v_lshrrev_b32 v13, 2, v39
    v_add_u32 v35, v12, v11
    v_bitop3_b32 v39, v5, v13, v14 bitop3:0xea
    ds_add_u32 v39, v2
    v_cvt_pk_bf16_f32 v31, v9, v10
    v_perm_b32 v12, v31, v31, s41
    v_bitop3_b32 v34, v4, v12, v34 bitop3:0xca
    v_perm_b32 v13, v31, v31, s42
    v_bitop3_b32 v35, v4, v13, v35 bitop3:0xca
    v_lshrrev_b32 v8, 2, v0
    v_and_b32 v7, 0x3c00, v0
    v_bitop3_b32 v7, v5, v8, v7 bitop3:0xea
    s_waitcnt lgkmcnt(0)
    s_barrier
    ds_read2st64_b32 v[8:9], v7 offset0:0 offset1:1
    ds_read2st64_b32 v[10:11], v7 offset0:2 offset1:3
    s_add_u32 s46, s35, 0x2a44000
    s_add_u32 s46, s46, s93
    buffer_store_dwordx4 v[84:87], v0, s[20:23], s46 offen sc1
    s_add_u32 s47, s96, 0x6000000
    s_lshr_b32 s47, s47, 1
    buffer_load_dwordx2 v[84:85], v1, s[16:19], s47 offen nt
    s_add_u32 s44, s97, 0x6400000
    s_lshr_b32 s44, s44, 1
    buffer_load_dwordx2 v[86:87], v1, s[16:19], s44 offen nt
    s_waitcnt lgkmcnt(0)
    v_lshl_or_b32 v12, v9, 16, v8
    v_lshl_or_b32 v13, v11, 16, v10
    v_mov_b32 v14, v12
    v_mov_b32 v15, v13
    s_nop 0
    v_add_u32_dpp v14, v14, v14 row_shr:1 row_mask:0xf bank_mask:0xf bound_ctrl:1
    v_add_u32_dpp v15, v15, v15 row_shr:1 row_mask:0xf bank_mask:0xf bound_ctrl:1
    s_nop 0
    v_add_u32_dpp v14, v14, v14 row_shr:2 row_mask:0xf bank_mask:0xf bound_ctrl:1
    v_add_u32_dpp v15, v15, v15 row_shr:2 row_mask:0xf bank_mask:0xf bound_ctrl:1
    s_nop 0
    v_add_u32_dpp v14, v14, v14 row_shr:4 row_mask:0xf bank_mask:0xf bound_ctrl:1
    v_add_u32_dpp v15, v15, v15 row_shr:4 row_mask:0xf bank_mask:0xf bound_ctrl:1
    s_nop 0
    v_add_u32_dpp v14, v14, v14 row_shr:8 row_mask:0xf bank_mask:0xf bound_ctrl:1
    v_add_u32_dpp v15, v15, v15 row_shr:8 row_mask:0xf bank_mask:0xf bound_ctrl:1
    s_nop 0
    v_add_u32_dpp v14, v14, v14 row_bcast:15 row_mask:0xa bank_mask:0xf
    v_add_u32_dpp v15, v15, v15 row_bcast:15 row_mask:0xa bank_mask:0xf
    s_nop 0
    v_add_u32_dpp v14, v14, v14 row_bcast:31 row_mask:0xc bank_mask:0xf
    v_add_u32_dpp v15, v15, v15 row_bcast:31 row_mask:0xc bank_mask:0xf
    v_readlane_b32 s48, v14, 63
    v_readlane_b32 s49, v15, 63
    s_lshl_b32 s54, s32, 2
    v_mov_b32 v8, s54
    s_and_b32 s50, s48, 0xffff
    s_lshr_b32 s51, s48, 16
    s_and_b32 s52, s49, 0xffff
    s_lshr_b32 s53, s49, 16
    s_add_u32 s51, s51, s50
    s_add_u32 s52, s52, s51
    s_add_u32 s53, s53, s52
    v_mov_b32 v9, s53
    s_mov_b64 exec, 1
    ds_write_b32 v8, v9 offset:16384
    s_mov_b64 exec, -1
    v_and_b32 v8, 60, v7
    s_waitcnt lgkmcnt(0)
    s_barrier
    ds_read_b32 v9, v8 offset:16384
    s_waitcnt lgkmcnt(0)
    v_add_u32_dpp v9, v9, v9 row_shr:1 row_mask:0xf bank_mask:0xf bound_ctrl:1
    s_nop 1
    v_add_u32_dpp v9, v9, v9 row_shr:2 row_mask:0xf bank_mask:0xf bound_ctrl:1
    s_nop 1
    v_add_u32_dpp v9, v9, v9 row_shr:4 row_mask:0xf bank_mask:0xf bound_ctrl:1
    s_nop 1
    v_add_u32_dpp v9, v9, v9 row_shr:8 row_mask:0xf bank_mask:0xf bound_ctrl:1
    s_nop 0
    v_readlane_b32 s54, v9, s32
    s_sub_u32 s54, s54, s53
    s_add_u32 s50, s50, s54
    s_add_u32 s51, s51, s54
    s_add_u32 s52, s52, s54
    s_pack_ll_b32_b16 s48, s54, s50
    s_pack_ll_b32_b16 s49, s51, s52
    v_add_u32 v14, s48, v14
    v_add_u32 v15, s49, v15
    v_sub_u32 v12, v14, v12
    v_sub_u32 v13, v15, v13
    v_and_b32 v8, 0xffff, v12
    v_lshrrev_b32 v9, 16, v12
    v_and_b32 v10, 0xffff, v13
    v_lshrrev_b32 v11, 16, v13
    ds_write2st64_b32 v7, v8, v9 offset0:0 offset1:1
    ds_write2st64_b32 v7, v10, v11 offset0:2 offset1:3
    v_and_b32 v8, 0x3f0, v0
    v_lshl_add_u32 v8, v8, 1, s36
    ds_write_b64 v8, v[12:13] offset:20480
    s_bitset0_b64 exec, 63
    s_not_b64 exec, exec
    ds_write_b64 v8, v[14:15] offset:20512
    s_mov_b64 exec, -1
    s_waitcnt lgkmcnt(0)
    s_barrier
    s_setprio 3
    ds_add_rtn_u32 v72, v72, v2
    ds_add_rtn_u32 v73, v73, v2
    ds_add_rtn_u32 v74, v74, v2
    ds_add_rtn_u32 v75, v75, v2
    ds_read_b128 v[12:15], v0 offset:20480
    v_cmp_gt_u32 vcc, 8448, v0
    ds_add_rtn_u32 v80, v80, v2
    ds_add_rtn_u32 v81, v81, v2
    ds_add_rtn_u32 v82, v82, v2
    ds_add_rtn_u32 v83, v83, v2
    s_setprio 2
    ds_add_rtn_u32 v104, v104, v2
    ds_add_rtn_u32 v105, v105, v2
    ds_add_rtn_u32 v106, v106, v2
    ds_add_rtn_u32 v107, v107, v2
    s_waitcnt lgkmcnt(8)
    s_cbranch_vccz L1_p3
    s_add_u32 s45, s35, 0x5480000
    s_mov_b64 exec, vcc
    buffer_store_dwordx4 v[12:15], v0, s[24:27], s45 offen sc1
    s_mov_b64 exec, -1
L1_p3:
    s_add_u32 s46, s35, 0x2a48000
    s_add_u32 s46, s46, s72
    buffer_store_dwordx4 v[48:51], v0, s[20:23], s46 offen sc1
    s_add_u32 s47, s97, 0x6400000
    s_nop 0
    v_lshlrev_b32 v48, 1, v1
    buffer_load_dwordx4 v[48:51], v48, s[8:11], s47 offen nt
    ds_add_rtn_u32 v112, v112, v2
    ds_add_rtn_u32 v113, v113, v2
    ds_add_rtn_u32 v114, v114, v2
    ds_add_rtn_u32 v115, v115, v2
    s_setprio 1
    ds_add_rtn_u32 v116, v116, v2
    ds_add_rtn_u32 v117, v117, v2
    ds_add_rtn_u32 v118, v118, v2
    ds_add_rtn_u32 v119, v119, v2
    ds_add_rtn_u32 v16, v16, v2
    ds_add_rtn_u32 v17, v17, v2
    ds_add_rtn_u32 v18, v18, v2
    ds_add_rtn_u32 v19, v19, v2
    s_add_u32 s44, s35, 0x2a48000
    s_add_u32 s44, s44, s73
    buffer_store_dwordx4 v[52:55], v0, s[20:23], s44 offen sc1
    s_add_u32 s45, s97, 0x6400000
    s_nop 0
    v_lshlrev_b32 v52, 1, v1
    buffer_load_dwordx4 v[52:55], v52, s[12:15], s45 offen nt
    s_setprio 0
    ds_add_rtn_u32 v124, v124, v2
    ds_add_rtn_u32 v125, v125, v2
    ds_add_rtn_u32 v126, v126, v2
    ds_add_rtn_u32 v127, v127, v2
    ds_add_rtn_u32 v36, v36, v2
    ds_add_rtn_u32 v37, v37, v2
    ds_add_rtn_u32 v38, v38, v2
    ds_add_rtn_u32 v39, v39, v2
    s_waitcnt lgkmcnt(0)
    s_barrier
    s_setprio 3
    v_and_b32 v7, -4, v72
    v_lshl_add_u32 v8, v72, 2, v7
    ds_write_b32 v8, v68
    v_lshl_add_u32 v7, v7, 2, v72
    ds_write_b8 v7, v64 offset:16
    v_and_b32 v9, -4, v73
    v_lshl_add_u32 v10, v73, 2, v9
    ds_write_b32 v10, v69
    v_lshl_add_u32 v9, v9, 2, v73
    ds_write_b8_d16_hi v9, v64 offset:16
    v_and_b32 v7, -4, v74
    v_lshl_add_u32 v8, v74, 2, v7
    ds_write_b32 v8, v70
    v_lshl_add_u32 v7, v7, 2, v74
    ds_write_b8 v7, v65 offset:16
    v_and_b32 v9, -4, v75
    v_lshl_add_u32 v10, v75, 2, v9
    ds_write_b32 v10, v71
    v_lshl_add_u32 v9, v9, 2, v75
    ds_write_b8_d16_hi v9, v65 offset:16
    s_add_u32 s46, s35, 0x2a48000
    s_add_u32 s46, s46, s85
    buffer_store_dwordx4 v[56:59], v0, s[20:23], s46 offen sc1
    s_add_u32 s47, s98, 0x6800000
    v_lshlrev_b32 v68, 1, v1
    buffer_load_dwordx4 v[68:71], v68, s[8:11], s47 offen nt
    s_add_u32 s44, s98, 0x6800000
    v_lshlrev_b32 v72, 1, v1
    buffer_load_dwordx4 v[72:75], v72, s[12:15], s44 offen nt
    v_and_b32 v7, -4, v80
    v_lshl_add_u32 v8, v80, 2, v7
    ds_write_b32 v8, v76
    v_lshl_add_u32 v7, v7, 2, v80
    ds_write_b8 v7, v66 offset:16
    v_and_b32 v9, -4, v81
    v_lshl_add_u32 v10, v81, 2, v9
    ds_write_b32 v10, v77
    v_lshl_add_u32 v9, v9, 2, v81
    ds_write_b8_d16_hi v9, v66 offset:16
    v_and_b32 v7, -4, v82
    v_lshl_add_u32 v8, v82, 2, v7
    ds_write_b32 v8, v78
    v_lshl_add_u32 v7, v7, 2, v82
    ds_write_b8 v7, v67 offset:16
    v_and_b32 v9, -4, v83
    v_lshl_add_u32 v10, v83, 2, v9
    ds_write_b32 v10, v79
    v_lshl_add_u32 v9, v9, 2, v83
    ds_write_b8_d16_hi v9, v67 offset:16
    s_add_u32 s45, s98, 0x6800000
    s_lshr_b32 s45, s45, 1
    buffer_load_dwordx2 v[56:57], v1, s[16:19], s45 offen nt
    s_add_u32 s46, s99, 0x6c00000
    s_lshr_b32 s46, s46, 1
    buffer_load_dwordx2 v[58:59], v1, s[16:19], s46 offen nt
    s_add_u32 s47, s99, 0x6c00000
    v_lshlrev_b32 v76, 1, v1
    buffer_load_dwordx4 v[76:79], v76, s[8:11], s47 offen nt
    s_setprio 2
    v_and_b32 v7, -4, v104
    v_lshl_add_u32 v8, v104, 2, v7
    ds_write_b32 v8, v96
    v_lshl_add_u32 v7, v7, 2, v104
    ds_write_b8 v7, v88 offset:16
    v_and_b32 v9, -4, v105
    v_lshl_add_u32 v10, v105, 2, v9
    ds_write_b32 v10, v97
    v_lshl_add_u32 v9, v9, 2, v105
    ds_write_b8_d16_hi v9, v88 offset:16
    v_and_b32 v7, -4, v106
    v_lshl_add_u32 v8, v106, 2, v7
    ds_write_b32 v8, v98
    v_lshl_add_u32 v7, v7, 2, v106
    ds_write_b8 v7, v89 offset:16
    v_and_b32 v9, -4, v107
    v_lshl_add_u32 v10, v107, 2, v9
    ds_write_b32 v10, v99
    v_lshl_add_u32 v9, v9, 2, v107
    ds_write_b8_d16_hi v9, v89 offset:16
    s_add_u32 s44, s35, 0x2a48000
    s_add_u32 s44, s44, s91
    buffer_store_dwordx4 v[60:63], v0, s[20:23], s44 offen sc1
    s_add_u32 s45, s99, 0x6c00000
    v_lshlrev_b32 v80, 1, v1
    buffer_load_dwordx4 v[80:83], v80, s[12:15], s45 offen nt
    v_and_b32 v7, -4, v112
    v_lshl_add_u32 v8, v112, 2, v7
    ds_write_b32 v8, v100
    v_lshl_add_u32 v7, v7, 2, v112
    ds_write_b8 v7, v90 offset:16
    v_and_b32 v9, -4, v113
    v_lshl_add_u32 v10, v113, 2, v9
    ds_write_b32 v10, v101
    v_lshl_add_u32 v9, v9, 2, v113
    ds_write_b8_d16_hi v9, v90 offset:16
    v_and_b32 v7, -4, v114
    v_lshl_add_u32 v8, v114, 2, v7
    ds_write_b32 v8, v102
    v_lshl_add_u32 v7, v7, 2, v114
    ds_write_b8 v7, v91 offset:16
    v_and_b32 v9, -4, v115
    v_lshl_add_u32 v10, v115, 2, v9
    ds_write_b32 v10, v103
    v_lshl_add_u32 v9, v9, 2, v115
    ds_write_b8_d16_hi v9, v91 offset:16
    s_add_u32 s46, s96, 0x7000000
    v_lshlrev_b32 v64, 1, v1
    buffer_load_dwordx4 v[64:67], v64, s[8:11], s46 offen nt
    s_add_u32 s47, s96, 0x7000000
    v_lshlrev_b32 v96, 1, v1
    buffer_load_dwordx4 v[96:99], v96, s[12:15], s47 offen nt
    s_setprio 1
    v_and_b32 v7, -4, v116
    v_lshl_add_u32 v8, v116, 2, v7
    ds_write_b32 v8, v108
    v_lshl_add_u32 v7, v7, 2, v116
    ds_write_b8 v7, v120 offset:16
    v_and_b32 v9, -4, v117
    v_lshl_add_u32 v10, v117, 2, v9
    ds_write_b32 v10, v109
    v_lshl_add_u32 v9, v9, 2, v117
    ds_write_b8_d16_hi v9, v120 offset:16
    v_and_b32 v7, -4, v118
    v_lshl_add_u32 v8, v118, 2, v7
    ds_write_b32 v8, v110
    v_lshl_add_u32 v7, v7, 2, v118
    ds_write_b8 v7, v121 offset:16
    v_and_b32 v9, -4, v119
    v_lshl_add_u32 v10, v119, 2, v9
    ds_write_b32 v10, v111
    v_lshl_add_u32 v9, v9, 2, v119
    ds_write_b8_d16_hi v9, v121 offset:16
    s_add_u32 s44, s96, 0x7000000
    s_lshr_b32 s44, s44, 1
    buffer_load_dwordx2 v[104:105], v1, s[16:19], s44 offen nt
    s_add_u32 s45, s97, 0x7400000
    s_lshr_b32 s45, s45, 1
    buffer_load_dwordx2 v[106:107], v1, s[16:19], s45 offen nt
    s_add_u32 s46, s97, 0x7400000
    v_lshlrev_b32 v60, 1, v1
    buffer_load_dwordx4 v[60:63], v60, s[8:11], s46 offen nt
    v_and_b32 v7, -4, v16
    v_lshl_add_u32 v8, v16, 2, v7
    ds_write_b32 v8, v92
    v_lshl_add_u32 v7, v7, 2, v16
    ds_write_b8 v7, v122 offset:16
    v_and_b32 v9, -4, v17
    v_lshl_add_u32 v10, v17, 2, v9
    ds_write_b32 v10, v93
    v_lshl_add_u32 v9, v9, 2, v17
    ds_write_b8_d16_hi v9, v122 offset:16
    v_and_b32 v7, -4, v18
    v_lshl_add_u32 v8, v18, 2, v7
    ds_write_b32 v8, v94
    v_lshl_add_u32 v7, v7, 2, v18
    ds_write_b8 v7, v123 offset:16
    v_and_b32 v9, -4, v19
    v_lshl_add_u32 v10, v19, 2, v9
    ds_write_b32 v10, v95
    v_lshl_add_u32 v9, v9, 2, v19
    ds_write_b8_d16_hi v9, v123 offset:16
    s_add_u32 s47, s35, 0x2a48000
    s_add_u32 s47, s47, s93
    buffer_store_dwordx4 v[44:47], v0, s[20:23], s47 offen sc1
    s_add_u32 s44, s97, 0x7400000
    v_lshlrev_b32 v100, 1, v1
    buffer_load_dwordx4 v[100:103], v100, s[12:15], s44 offen nt
    s_setprio 0
    v_and_b32 v7, -4, v124
    v_lshl_add_u32 v8, v124, 2, v7
    ds_write_b32 v8, v20
    v_lshl_add_u32 v7, v7, 2, v124
    ds_write_b8 v7, v28 offset:16
    v_and_b32 v9, -4, v125
    v_lshl_add_u32 v10, v125, 2, v9
    ds_write_b32 v10, v21
    v_lshl_add_u32 v9, v9, 2, v125
    ds_write_b8_d16_hi v9, v28 offset:16
    v_and_b32 v7, -4, v126
    v_lshl_add_u32 v8, v126, 2, v7
    ds_write_b32 v8, v22
    v_lshl_add_u32 v7, v7, 2, v126
    ds_write_b8 v7, v29 offset:16
    v_and_b32 v9, -4, v127
    v_lshl_add_u32 v10, v127, 2, v9
    ds_write_b32 v10, v23
    v_lshl_add_u32 v9, v9, 2, v127
    ds_write_b8_d16_hi v9, v29 offset:16
    s_add_u32 s45, s98, 0x7800000
    v_lshlrev_b32 v112, 1, v1
    buffer_load_dwordx4 v[112:115], v112, s[8:11], s45 offen nt
    s_add_u32 s46, s98, 0x7800000
    v_lshlrev_b32 v88, 1, v1
    buffer_load_dwordx4 v[88:91], v88, s[12:15], s46 offen nt
    v_and_b32 v7, -4, v36
    v_lshl_add_u32 v8, v36, 2, v7
    ds_write_b32 v8, v32
    v_lshl_add_u32 v7, v7, 2, v36
    ds_write_b8 v7, v30 offset:16
    v_and_b32 v9, -4, v37
    v_lshl_add_u32 v10, v37, 2, v9
    ds_write_b32 v10, v33
    v_lshl_add_u32 v9, v9, 2, v37
    ds_write_b8_d16_hi v9, v30 offset:16
    v_and_b32 v7, -4, v38
    v_lshl_add_u32 v8, v38, 2, v7
    ds_write_b32 v8, v34
    v_lshl_add_u32 v7, v7, 2, v38
    ds_write_b8 v7, v31 offset:16
    v_and_b32 v9, -4, v39
    v_lshl_add_u32 v10, v39, 2, v9
    ds_write_b32 v10, v35
    v_lshl_add_u32 v9, v9, 2, v39
    ds_write_b8_d16_hi v9, v31 offset:16
    s_add_u32 s47, s98, 0x7800000
    s_lshr_b32 s47, s47, 1
    buffer_load_dwordx2 v[108:109], v1, s[16:19], s47 offen nt
    s_add_u32 s44, s99, 0x7c00000
    s_lshr_b32 s44, s44, 1
    buffer_load_dwordx2 v[110:111], v1, s[16:19], s44 offen nt
    v_add_u32 v7, s72, v0
    v_add_u32 v12, s73, v0
    v_add_u32 v13, s85, v0
    v_add_u32 v14, s91, v0
    v_add_u32 v15, s93, v0
    s_min_i32 s3, s72, s73
    s_min_i32 s3, s3, s85
    s_min_i32 s3, s3, s91
    s_min_i32 s3, s3, s93
    v_add_u32 v3, s3, v0
    v_mov_b32 v8, 0
    v_mov_b32 v9, 0
    v_mov_b32 v10, 0
    v_mov_b32 v11, 0
    s_waitcnt lgkmcnt(0)
    s_barrier
    ds_read_b128 v[116:119], v7 offset:0
    ds_read_b128 v[92:95], v12 offset:0
    ds_read_b128 v[16:19], v13 offset:0
    ds_read_b128 v[120:123], v14 offset:0
    ds_read_b128 v[44:47], v15 offset:0
    ds_write_b128 v3, v[8:11]
    ds_read_b128 v[20:23], v7 offset:16384
    ds_read_b128 v[124:127], v12 offset:16384
    ds_read_b128 v[32:35], v13 offset:16384
    ds_read_b128 v[36:39], v14 offset:16384
    ds_read_b128 v[28:31], v15 offset:16384
    s_waitcnt lgkmcnt(0)
    s_barrier
    s_setprio 3
    s_add_u32 s45, s35, 0x5484000
    s_add_u32 s45, s45, s72
    buffer_store_dwordx4 v[116:119], v0, s[20:23], s45 offen sc1
    s_add_u32 s46, s99, 0x7c00000
    s_nop 0
    v_lshlrev_b32 v116, 1, v1
    buffer_load_dwordx4 v[116:119], v116, s[8:11], s46 offen nt
    s_add_u32 s47, s35, 0x5484000
    s_add_u32 s47, s47, s73
    buffer_store_dwordx4 v[92:95], v0, s[20:23], s47 offen sc1
    s_add_u32 s44, s99, 0x7c00000
    s_nop 0
    v_lshlrev_b32 v92, 1, v1
    buffer_load_dwordx4 v[92:95], v92, s[12:15], s44 offen nt
    s_waitcnt vmcnt(27)
    v_lshlrev_b32 v7, 16, v84
    v_and_b32 v8, 0xffff0000, v84
    v_lshlrev_b32 v9, 16, v85
    v_and_b32 v10, 0xffff0000, v85
    v_mul_f32 v7, 0.15915494, v7
    v_mul_f32 v8, 0.15915494, v8
    v_mul_f32 v9, 0.15915494, v9
    v_mul_f32 v10, 0.15915494, v10
    v_mul_hi_u32_u24 v14, 429497, v40
    v_lshrrev_b32 v12, 3, v24
    v_cos_f32 v7, v7
    v_lshlrev_b16 v13, 3, v24
    v_mad_i32_i24 v11, v14, s55, v40
    v_bitop3_b32 v12, v6, v13, v12 bitop3:0xca
    v_lshl_add_u32 v11, v11, 17, s40
    v_lshlrev_b16 v14, 8, v14
    v_lshrrev_b32 v13, 2, v24
    v_add_u32 v40, v12, v11
    v_bitop3_b32 v24, v5, v13, v14 bitop3:0xea
    ds_add_u32 v24, v2
    v_mul_hi_u32_u24 v14, 429497, v41
    v_lshrrev_b32 v12, 3, v25
    v_cos_f32 v8, v8
    v_lshlrev_b16 v13, 3, v25
    v_mad_i32_i24 v11, v14, s55, v41
    v_bitop3_b32 v12, v6, v13, v12 bitop3:0xca
    v_lshl_add_u32 v11, v11, 17, s40
    v_lshlrev_b16 v14, 8, v14
    v_lshrrev_b32 v13, 2, v25
    v_add_u32 v41, v12, v11
    v_bitop3_b32 v25, v5, v13, v14 bitop3:0xea
    ds_add_u32 v25, v2
    v_cvt_pk_bf16_f32 v84, v7, v8
    v_perm_b32 v12, v84, v84, s41
    v_bitop3_b32 v40, v4, v12, v40 bitop3:0xca
    v_perm_b32 v13, v84, v84, s42
    v_bitop3_b32 v41, v4, v13, v41 bitop3:0xca
    v_mul_hi_u32_u24 v14, 429497, v42
    v_lshrrev_b32 v12, 3, v26
    v_cos_f32 v9, v9
    v_lshlrev_b16 v13, 3, v26
    v_mad_i32_i24 v11, v14, s55, v42
    v_bitop3_b32 v12, v6, v13, v12 bitop3:0xca
    v_lshl_add_u32 v11, v11, 17, s40
    v_lshlrev_b16 v14, 8, v14
    v_lshrrev_b32 v13, 2, v26
    v_add_u32 v42, v12, v11
    v_bitop3_b32 v26, v5, v13, v14 bitop3:0xea
    ds_add_u32 v26, v2
    v_mul_hi_u32_u24 v14, 429497, v43
    v_lshrrev_b32 v12, 3, v27
    v_cos_f32 v10, v10
    v_lshlrev_b16 v13, 3, v27
    v_mad_i32_i24 v11, v14, s55, v43
    v_bitop3_b32 v12, v6, v13, v12 bitop3:0xca
    v_lshl_add_u32 v11, v11, 17, s40
    v_lshlrev_b16 v14, 8, v14
    v_lshrrev_b32 v13, 2, v27
    v_add_u32 v43, v12, v11
    v_bitop3_b32 v27, v5, v13, v14 bitop3:0xea
    ds_add_u32 v27, v2
    v_cvt_pk_bf16_f32 v85, v9, v10
    v_perm_b32 v12, v85, v85, s41
    v_bitop3_b32 v42, v4, v12, v42 bitop3:0xca
    v_perm_b32 v13, v85, v85, s42
    v_bitop3_b32 v43, v4, v13, v43 bitop3:0xca
    s_waitcnt vmcnt(23)
    v_lshlrev_b32 v7, 16, v86
    v_and_b32 v8, 0xffff0000, v86
    v_lshlrev_b32 v9, 16, v87
    v_and_b32 v10, 0xffff0000, v87
    v_mul_f32 v7, 0.15915494, v7
    v_mul_f32 v8, 0.15915494, v8
    v_mul_f32 v9, 0.15915494, v9
    v_mul_f32 v10, 0.15915494, v10
    v_mul_hi_u32_u24 v14, 429497, v48
    v_lshrrev_b32 v12, 3, v52
    v_cos_f32 v7, v7
    v_lshlrev_b16 v13, 3, v52
    v_mad_i32_i24 v11, v14, s55, v48
    v_bitop3_b32 v12, v6, v13, v12 bitop3:0xca
    v_lshl_add_u32 v11, v11, 17, s40
    v_lshlrev_b16 v14, 8, v14
    v_lshrrev_b32 v13, 2, v52
    v_add_u32 v48, v12, v11
    v_bitop3_b32 v52, v5, v13, v14 bitop3:0xea
    ds_add_u32 v52, v2
    v_mul_hi_u32_u24 v14, 429497, v49
    v_lshrrev_b32 v12, 3, v53
    v_cos_f32 v8, v8
    v_lshlrev_b16 v13, 3, v53
    v_mad_i32_i24 v11, v14, s55, v49
    v_bitop3_b32 v12, v6, v13, v12 bitop3:0xca
    v_lshl_add_u32 v11, v11, 17, s40
    v_lshlrev_b16 v14, 8, v14
    v_lshrrev_b32 v13, 2, v53
    v_add_u32 v49, v12, v11
    v_bitop3_b32 v53, v5, v13, v14 bitop3:0xea
    ds_add_u32 v53, v2
    v_cvt_pk_bf16_f32 v86, v7, v8
    v_perm_b32 v12, v86, v86, s41
    v_bitop3_b32 v48, v4, v12, v48 bitop3:0xca
    v_perm_b32 v13, v86, v86, s42
    v_bitop3_b32 v49, v4, v13, v49 bitop3:0xca
    v_mul_hi_u32_u24 v14, 429497, v50
    v_lshrrev_b32 v12, 3, v54
    v_cos_f32 v9, v9
    v_lshlrev_b16 v13, 3, v54
    v_mad_i32_i24 v11, v14, s55, v50
    v_bitop3_b32 v12, v6, v13, v12 bitop3:0xca
    v_lshl_add_u32 v11, v11, 17, s40
    v_lshlrev_b16 v14, 8, v14
    v_lshrrev_b32 v13, 2, v54
    v_add_u32 v50, v12, v11
    v_bitop3_b32 v54, v5, v13, v14 bitop3:0xea
    ds_add_u32 v54, v2
    v_mul_hi_u32_u24 v14, 429497, v51
    v_lshrrev_b32 v12, 3, v55
    v_cos_f32 v10, v10
    v_lshlrev_b16 v13, 3, v55
    v_mad_i32_i24 v11, v14, s55, v51
    v_bitop3_b32 v12, v6, v13, v12 bitop3:0xca
    v_lshl_add_u32 v11, v11, 17, s40
    v_lshlrev_b16 v14, 8, v14
    v_lshrrev_b32 v13, 2, v55
    v_add_u32 v51, v12, v11
    v_bitop3_b32 v55, v5, v13, v14 bitop3:0xea
    ds_add_u32 v55, v2
    v_cvt_pk_bf16_f32 v87, v9, v10
    v_perm_b32 v12, v87, v87, s41
    v_bitop3_b32 v50, v4, v12, v50 bitop3:0xca
    v_perm_b32 v13, v87, v87, s42
    v_bitop3_b32 v51, v4, v13, v51 bitop3:0xca
    s_setprio 2
    s_waitcnt vmcnt(18)
    v_lshlrev_b32 v7, 16, v56
    v_and_b32 v8, 0xffff0000, v56
    v_lshlrev_b32 v9, 16, v57
    v_and_b32 v10, 0xffff0000, v57
    v_mul_f32 v7, 0.15915494, v7
    v_mul_f32 v8, 0.15915494, v8
    v_mul_f32 v9, 0.15915494, v9
    v_mul_f32 v10, 0.15915494, v10
    v_mul_hi_u32_u24 v14, 429497, v68
    v_lshrrev_b32 v12, 3, v72
    v_cos_f32 v7, v7
    v_lshlrev_b16 v13, 3, v72
    v_mad_i32_i24 v11, v14, s55, v68
    v_bitop3_b32 v12, v6, v13, v12 bitop3:0xca
    v_lshl_add_u32 v11, v11, 17, s40
    v_lshlrev_b16 v14, 8, v14
    v_lshrrev_b32 v13, 2, v72
    v_add_u32 v68, v12, v11
    v_bitop3_b32 v72, v5, v13, v14 bitop3:0xea
    ds_add_u32 v72, v2
    v_mul_hi_u32_u24 v14, 429497, v69
    v_lshrrev_b32 v12, 3, v73
    v_cos_f32 v8, v8
    v_lshlrev_b16 v13, 3, v73
    v_mad_i32_i24 v11, v14, s55, v69
    v_bitop3_b32 v12, v6, v13, v12 bitop3:0xca
    v_lshl_add_u32 v11, v11, 17, s40
    v_lshlrev_b16 v14, 8, v14
    v_lshrrev_b32 v13, 2, v73
    v_add_u32 v69, v12, v11
    v_bitop3_b32 v73, v5, v13, v14 bitop3:0xea
    ds_add_u32 v73, v2
    v_cvt_pk_bf16_f32 v56, v7, v8
    v_perm_b32 v12, v56, v56, s41
    v_bitop3_b32 v68, v4, v12, v68 bitop3:0xca
    v_perm_b32 v13, v56, v56, s42
    v_bitop3_b32 v69, v4, v13, v69 bitop3:0xca
    v_mul_hi_u32_u24 v14, 429497, v70
    v_lshrrev_b32 v12, 3, v74
    v_cos_f32 v9, v9
    v_lshlrev_b16 v13, 3, v74
    v_mad_i32_i24 v11, v14, s55, v70
    v_bitop3_b32 v12, v6, v13, v12 bitop3:0xca
    v_lshl_add_u32 v11, v11, 17, s40
    v_lshlrev_b16 v14, 8, v14
    v_lshrrev_b32 v13, 2, v74
    v_add_u32 v70, v12, v11
    v_bitop3_b32 v74, v5, v13, v14 bitop3:0xea
    ds_add_u32 v74, v2
    v_mul_hi_u32_u24 v14, 429497, v71
    v_lshrrev_b32 v12, 3, v75
    v_cos_f32 v10, v10
    v_lshlrev_b16 v13, 3, v75
    v_mad_i32_i24 v11, v14, s55, v71
    v_bitop3_b32 v12, v6, v13, v12 bitop3:0xca
    v_lshl_add_u32 v11, v11, 17, s40
    v_lshlrev_b16 v14, 8, v14
    v_lshrrev_b32 v13, 2, v75
    v_add_u32 v71, v12, v11
    v_bitop3_b32 v75, v5, v13, v14 bitop3:0xea
    ds_add_u32 v75, v2
    v_cvt_pk_bf16_f32 v57, v9, v10
    v_perm_b32 v12, v57, v57, s41
    v_bitop3_b32 v70, v4, v12, v70 bitop3:0xca
    v_perm_b32 v13, v57, v57, s42
    v_bitop3_b32 v71, v4, v13, v71 bitop3:0xca
    s_add_u32 s45, s35, 0x5484000
    s_add_u32 s45, s45, s85
    buffer_store_dwordx4 v[16:19], v0, s[20:23], s45 offen sc1
    s_add_u32 s46, s96, 0x8000000
    s_nop 0
    v_lshlrev_b32 v16, 1, v1
    buffer_load_dwordx4 v[16:19], v16, s[8:11], s46 offen nt
    s_waitcnt vmcnt(17)
    v_lshlrev_b32 v7, 16, v58
    v_and_b32 v8, 0xffff0000, v58
    v_lshlrev_b32 v9, 16, v59
    v_and_b32 v10, 0xffff0000, v59
    v_mul_f32 v7, 0.15915494, v7
    v_mul_f32 v8, 0.15915494, v8
    v_mul_f32 v9, 0.15915494, v9
    v_mul_f32 v10, 0.15915494, v10
    v_mul_hi_u32_u24 v14, 429497, v76
    v_lshrrev_b32 v12, 3, v80
    v_cos_f32 v7, v7
    v_lshlrev_b16 v13, 3, v80
    v_mad_i32_i24 v11, v14, s55, v76
    v_bitop3_b32 v12, v6, v13, v12 bitop3:0xca
    v_lshl_add_u32 v11, v11, 17, s40
    v_lshlrev_b16 v14, 8, v14
    v_lshrrev_b32 v13, 2, v80
    v_add_u32 v76, v12, v11
    v_bitop3_b32 v80, v5, v13, v14 bitop3:0xea
    ds_add_u32 v80, v2
    v_mul_hi_u32_u24 v14, 429497, v77
    v_lshrrev_b32 v12, 3, v81
    v_cos_f32 v8, v8
    v_lshlrev_b16 v13, 3, v81
    v_mad_i32_i24 v11, v14, s55, v77
    v_bitop3_b32 v12, v6, v13, v12 bitop3:0xca
    v_lshl_add_u32 v11, v11, 17, s40
    v_lshlrev_b16 v14, 8, v14
    v_lshrrev_b32 v13, 2, v81
    v_add_u32 v77, v12, v11
    v_bitop3_b32 v81, v5, v13, v14 bitop3:0xea
    ds_add_u32 v81, v2
    v_cvt_pk_bf16_f32 v58, v7, v8
    v_perm_b32 v12, v58, v58, s41
    v_bitop3_b32 v76, v4, v12, v76 bitop3:0xca
    v_perm_b32 v13, v58, v58, s42
    v_bitop3_b32 v77, v4, v13, v77 bitop3:0xca
    v_mul_hi_u32_u24 v14, 429497, v78
    v_lshrrev_b32 v12, 3, v82
    v_cos_f32 v9, v9
    v_lshlrev_b16 v13, 3, v82
    v_mad_i32_i24 v11, v14, s55, v78
    v_bitop3_b32 v12, v6, v13, v12 bitop3:0xca
    v_lshl_add_u32 v11, v11, 17, s40
    v_lshlrev_b16 v14, 8, v14
    v_lshrrev_b32 v13, 2, v82
    v_add_u32 v78, v12, v11
    v_bitop3_b32 v82, v5, v13, v14 bitop3:0xea
    ds_add_u32 v82, v2
    v_mul_hi_u32_u24 v14, 429497, v79
    v_lshrrev_b32 v12, 3, v83
    v_cos_f32 v10, v10
    v_lshlrev_b16 v13, 3, v83
    v_mad_i32_i24 v11, v14, s55, v79
    v_bitop3_b32 v12, v6, v13, v12 bitop3:0xca
    v_lshl_add_u32 v11, v11, 17, s40
    v_lshlrev_b16 v14, 8, v14
    v_lshrrev_b32 v13, 2, v83
    v_add_u32 v79, v12, v11
    v_bitop3_b32 v83, v5, v13, v14 bitop3:0xea
    ds_add_u32 v83, v2
    v_cvt_pk_bf16_f32 v59, v9, v10
    v_perm_b32 v12, v59, v59, s41
    v_bitop3_b32 v78, v4, v12, v78 bitop3:0xca
    v_perm_b32 v13, v59, v59, s42
    v_bitop3_b32 v79, v4, v13, v79 bitop3:0xca
    s_setprio 1
    s_waitcnt vmcnt(13)
    v_lshlrev_b32 v7, 16, v104
    v_and_b32 v8, 0xffff0000, v104
    v_lshlrev_b32 v9, 16, v105
    v_and_b32 v10, 0xffff0000, v105
    v_mul_f32 v7, 0.15915494, v7
    v_mul_f32 v8, 0.15915494, v8
    v_mul_f32 v9, 0.15915494, v9
    v_mul_f32 v10, 0.15915494, v10
    v_mul_hi_u32_u24 v14, 429497, v64
    v_lshrrev_b32 v12, 3, v96
    v_cos_f32 v7, v7
    v_lshlrev_b16 v13, 3, v96
    v_mad_i32_i24 v11, v14, s55, v64
    v_bitop3_b32 v12, v6, v13, v12 bitop3:0xca
    v_lshl_add_u32 v11, v11, 17, s40
    v_lshlrev_b16 v14, 8, v14
    v_lshrrev_b32 v13, 2, v96
    v_add_u32 v64, v12, v11
    v_bitop3_b32 v96, v5, v13, v14 bitop3:0xea
    ds_add_u32 v96, v2
    v_mul_hi_u32_u24 v14, 429497, v65
    v_lshrrev_b32 v12, 3, v97
    v_cos_f32 v8, v8
    v_lshlrev_b16 v13, 3, v97
    v_mad_i32_i24 v11, v14, s55, v65
    v_bitop3_b32 v12, v6, v13, v12 bitop3:0xca
    v_lshl_add_u32 v11, v11, 17, s40
    v_lshlrev_b16 v14, 8, v14
    v_lshrrev_b32 v13, 2, v97
    v_add_u32 v65, v12, v11
    v_bitop3_b32 v97, v5, v13, v14 bitop3:0xea
    ds_add_u32 v97, v2
    v_cvt_pk_bf16_f32 v104, v7, v8
    v_perm_b32 v12, v104, v104, s41
    v_bitop3_b32 v64, v4, v12, v64 bitop3:0xca
    v_perm_b32 v13, v104, v104, s42
    v_bitop3_b32 v65, v4, v13, v65 bitop3:0xca
    v_mul_hi_u32_u24 v14, 429497, v66
    v_lshrrev_b32 v12, 3, v98
    v_cos_f32 v9, v9
    v_lshlrev_b16 v13, 3, v98
    v_mad_i32_i24 v11, v14, s55, v66
    v_bitop3_b32 v12, v6, v13, v12 bitop3:0xca
    v_lshl_add_u32 v11, v11, 17, s40
    v_lshlrev_b16 v14, 8, v14
    v_lshrrev_b32 v13, 2, v98
    v_add_u32 v66, v12, v11
    v_bitop3_b32 v98, v5, v13, v14 bitop3:0xea
    ds_add_u32 v98, v2
    v_mul_hi_u32_u24 v14, 429497, v67
    v_lshrrev_b32 v12, 3, v99
    v_cos_f32 v10, v10
    v_lshlrev_b16 v13, 3, v99
    v_mad_i32_i24 v11, v14, s55, v67
    v_bitop3_b32 v12, v6, v13, v12 bitop3:0xca
    v_lshl_add_u32 v11, v11, 17, s40
    v_lshlrev_b16 v14, 8, v14
    v_lshrrev_b32 v13, 2, v99
    v_add_u32 v67, v12, v11
    v_bitop3_b32 v99, v5, v13, v14 bitop3:0xea
    ds_add_u32 v99, v2
    v_cvt_pk_bf16_f32 v105, v9, v10
    v_perm_b32 v12, v105, v105, s41
    v_bitop3_b32 v66, v4, v12, v66 bitop3:0xca
    v_perm_b32 v13, v105, v105, s42
    v_bitop3_b32 v67, v4, v13, v67 bitop3:0xca
    s_mov_b32 s68, s66
    s_mov_b32 s69, s67
    s_mov_b32 s70, 0x100
    s_mov_b32 s71, 0x20000
    v_mov_b32 v3, 1
    s_cmp_lg_u32 s32, 15
    s_cbranch_scc1 L1_tk
    s_mov_b64 exec, 1
    s_and_b32 s3, s2, 1
    s_lshl_b32 s3, s3, 7
    buffer_atomic_add v3, off, s[68:71], s3 sc0
    s_mov_b64 exec, -1
L1_tk:
    s_waitcnt vmcnt(10)
    v_lshlrev_b32 v7, 16, v106
    v_and_b32 v8, 0xffff0000, v106
    v_lshlrev_b32 v9, 16, v107
    v_and_b32 v10, 0xffff0000, v107
    v_mul_f32 v7, 0.15915494, v7
    v_mul_f32 v8, 0.15915494, v8
    v_mul_f32 v9, 0.15915494, v9
    v_mul_f32 v10, 0.15915494, v10
    v_mul_hi_u32_u24 v14, 429497, v60
    v_lshrrev_b32 v12, 3, v100
    v_cos_f32 v7, v7
    v_lshlrev_b16 v13, 3, v100
    v_mad_i32_i24 v11, v14, s55, v60
    v_bitop3_b32 v12, v6, v13, v12 bitop3:0xca
    v_lshl_add_u32 v11, v11, 17, s40
    v_lshlrev_b16 v14, 8, v14
    v_lshrrev_b32 v13, 2, v100
    v_add_u32 v60, v12, v11
    v_bitop3_b32 v100, v5, v13, v14 bitop3:0xea
    ds_add_u32 v100, v2
    v_mul_hi_u32_u24 v14, 429497, v61
    v_lshrrev_b32 v12, 3, v101
    v_cos_f32 v8, v8
    v_lshlrev_b16 v13, 3, v101
    v_mad_i32_i24 v11, v14, s55, v61
    v_bitop3_b32 v12, v6, v13, v12 bitop3:0xca
    v_lshl_add_u32 v11, v11, 17, s40
    v_lshlrev_b16 v14, 8, v14
    v_lshrrev_b32 v13, 2, v101
    v_add_u32 v61, v12, v11
    v_bitop3_b32 v101, v5, v13, v14 bitop3:0xea
    ds_add_u32 v101, v2
    v_cvt_pk_bf16_f32 v106, v7, v8
    v_perm_b32 v12, v106, v106, s41
    v_bitop3_b32 v60, v4, v12, v60 bitop3:0xca
    v_perm_b32 v13, v106, v106, s42
    v_bitop3_b32 v61, v4, v13, v61 bitop3:0xca
    v_mul_hi_u32_u24 v14, 429497, v62
    v_lshrrev_b32 v12, 3, v102
    v_cos_f32 v9, v9
    v_lshlrev_b16 v13, 3, v102
    v_mad_i32_i24 v11, v14, s55, v62
    v_bitop3_b32 v12, v6, v13, v12 bitop3:0xca
    v_lshl_add_u32 v11, v11, 17, s40
    v_lshlrev_b16 v14, 8, v14
    v_lshrrev_b32 v13, 2, v102
    v_add_u32 v62, v12, v11
    v_bitop3_b32 v102, v5, v13, v14 bitop3:0xea
    ds_add_u32 v102, v2
    v_mul_hi_u32_u24 v14, 429497, v63
    v_lshrrev_b32 v12, 3, v103
    v_cos_f32 v10, v10
    v_lshlrev_b16 v13, 3, v103
    v_mad_i32_i24 v11, v14, s55, v63
    v_bitop3_b32 v12, v6, v13, v12 bitop3:0xca
    v_lshl_add_u32 v11, v11, 17, s40
    v_lshlrev_b16 v14, 8, v14
    v_lshrrev_b32 v13, 2, v103
    v_add_u32 v63, v12, v11
    v_bitop3_b32 v103, v5, v13, v14 bitop3:0xea
    ds_add_u32 v103, v2
    v_cvt_pk_bf16_f32 v107, v9, v10
    v_perm_b32 v12, v107, v107, s41
    v_bitop3_b32 v62, v4, v12, v62 bitop3:0xca
    v_perm_b32 v13, v107, v107, s42
    v_bitop3_b32 v63, v4, v13, v63 bitop3:0xca
    s_setprio 0
    s_add_u32 s47, s35, 0x5484000
    s_add_u32 s47, s47, s91
    buffer_store_dwordx4 v[120:123], v0, s[20:23], s47 offen sc1
    s_add_u32 s44, s96, 0x8000000
    s_nop 0
    v_lshlrev_b32 v120, 1, v1
    buffer_load_dwordx4 v[120:123], v120, s[12:15], s44 offen nt
    s_waitcnt vmcnt(8)
    v_lshlrev_b32 v7, 16, v108
    v_and_b32 v8, 0xffff0000, v108
    v_lshlrev_b32 v9, 16, v109
    v_and_b32 v10, 0xffff0000, v109
    v_mul_f32 v7, 0.15915494, v7
    v_mul_f32 v8, 0.15915494, v8
    v_mul_f32 v9, 0.15915494, v9
    v_mul_f32 v10, 0.15915494, v10
    v_mul_hi_u32_u24 v14, 429497, v112
    v_lshrrev_b32 v12, 3, v88
    v_cos_f32 v7, v7
    v_lshlrev_b16 v13, 3, v88
    v_mad_i32_i24 v11, v14, s55, v112
    v_bitop3_b32 v12, v6, v13, v12 bitop3:0xca
    v_lshl_add_u32 v11, v11, 17, s40
    v_lshlrev_b16 v14, 8, v14
    v_lshrrev_b32 v13, 2, v88
    v_add_u32 v112, v12, v11
    v_bitop3_b32 v88, v5, v13, v14 bitop3:0xea
    ds_add_u32 v88, v2
    v_mul_hi_u32_u24 v14, 429497, v113
    v_lshrrev_b32 v12, 3, v89
    v_cos_f32 v8, v8
    v_lshlrev_b16 v13, 3, v89
    v_mad_i32_i24 v11, v14, s55, v113
    v_bitop3_b32 v12, v6, v13, v12 bitop3:0xca
    v_lshl_add_u32 v11, v11, 17, s40
    v_lshlrev_b16 v14, 8, v14
    v_lshrrev_b32 v13, 2, v89
    v_add_u32 v113, v12, v11
    v_bitop3_b32 v89, v5, v13, v14 bitop3:0xea
    ds_add_u32 v89, v2
    v_cvt_pk_bf16_f32 v108, v7, v8
    v_perm_b32 v12, v108, v108, s41
    v_bitop3_b32 v112, v4, v12, v112 bitop3:0xca
    v_perm_b32 v13, v108, v108, s42
    v_bitop3_b32 v113, v4, v13, v113 bitop3:0xca
    v_mul_hi_u32_u24 v14, 429497, v114
    v_lshrrev_b32 v12, 3, v90
    v_cos_f32 v9, v9
    v_lshlrev_b16 v13, 3, v90
    v_mad_i32_i24 v11, v14, s55, v114
    v_bitop3_b32 v12, v6, v13, v12 bitop3:0xca
    v_lshl_add_u32 v11, v11, 17, s40
    v_lshlrev_b16 v14, 8, v14
    v_lshrrev_b32 v13, 2, v90
    v_add_u32 v114, v12, v11
    v_bitop3_b32 v90, v5, v13, v14 bitop3:0xea
    ds_add_u32 v90, v2
    v_mul_hi_u32_u24 v14, 429497, v115
    v_lshrrev_b32 v12, 3, v91
    v_cos_f32 v10, v10
    v_lshlrev_b16 v13, 3, v91
    v_mad_i32_i24 v11, v14, s55, v115
    v_bitop3_b32 v12, v6, v13, v12 bitop3:0xca
    v_lshl_add_u32 v11, v11, 17, s40
    v_lshlrev_b16 v14, 8, v14
    v_lshrrev_b32 v13, 2, v91
    v_add_u32 v115, v12, v11
    v_bitop3_b32 v91, v5, v13, v14 bitop3:0xea
    ds_add_u32 v91, v2
    v_cvt_pk_bf16_f32 v109, v9, v10
    v_perm_b32 v12, v109, v109, s41
    v_bitop3_b32 v114, v4, v12, v114 bitop3:0xca
    v_perm_b32 v13, v109, v109, s42
    v_bitop3_b32 v115, v4, v13, v115 bitop3:0xca
    s_waitcnt vmcnt(4)
    v_lshlrev_b32 v7, 16, v110
    v_and_b32 v8, 0xffff0000, v110
    v_lshlrev_b32 v9, 16, v111
    v_and_b32 v10, 0xffff0000, v111
    v_mul_f32 v7, 0.15915494, v7
    v_mul_f32 v8, 0.15915494, v8
    v_mul_f32 v9, 0.15915494, v9
    v_mul_f32 v10, 0.15915494, v10
    v_mul_hi_u32_u24 v14, 429497, v116
    v_lshrrev_b32 v12, 3, v92
    v_cos_f32 v7, v7
    v_lshlrev_b16 v13, 3, v92
    v_mad_i32_i24 v11, v14, s55, v116
    v_bitop3_b32 v12, v6, v13, v12 bitop3:0xca
    v_lshl_add_u32 v11, v11, 17, s40
    v_lshlrev_b16 v14, 8, v14
    v_lshrrev_b32 v13, 2, v92
    v_add_u32 v116, v12, v11
    v_bitop3_b32 v92, v5, v13, v14 bitop3:0xea
    ds_add_u32 v92, v2
    v_mul_hi_u32_u24 v14, 429497, v117
    v_lshrrev_b32 v12, 3, v93
    v_cos_f32 v8, v8
    v_lshlrev_b16 v13, 3, v93
    v_mad_i32_i24 v11, v14, s55, v117
    v_bitop3_b32 v12, v6, v13, v12 bitop3:0xca
    v_lshl_add_u32 v11, v11, 17, s40
    v_lshlrev_b16 v14, 8, v14
    v_lshrrev_b32 v13, 2, v93
    v_add_u32 v117, v12, v11
    v_bitop3_b32 v93, v5, v13, v14 bitop3:0xea
    ds_add_u32 v93, v2
    v_cvt_pk_bf16_f32 v110, v7, v8
    v_perm_b32 v12, v110, v110, s41
    v_bitop3_b32 v116, v4, v12, v116 bitop3:0xca
    v_perm_b32 v13, v110, v110, s42
    v_bitop3_b32 v117, v4, v13, v117 bitop3:0xca
    v_mul_hi_u32_u24 v14, 429497, v118
    v_lshrrev_b32 v12, 3, v94
    v_cos_f32 v9, v9
    v_lshlrev_b16 v13, 3, v94
    v_mad_i32_i24 v11, v14, s55, v118
    v_bitop3_b32 v12, v6, v13, v12 bitop3:0xca
    v_lshl_add_u32 v11, v11, 17, s40
    v_lshlrev_b16 v14, 8, v14
    v_lshrrev_b32 v13, 2, v94
    v_add_u32 v118, v12, v11
    v_bitop3_b32 v94, v5, v13, v14 bitop3:0xea
    ds_add_u32 v94, v2
    v_mul_hi_u32_u24 v14, 429497, v119
    v_lshrrev_b32 v12, 3, v95
    v_cos_f32 v10, v10
    v_lshlrev_b16 v13, 3, v95
    v_mad_i32_i24 v11, v14, s55, v119
    v_bitop3_b32 v12, v6, v13, v12 bitop3:0xca
    v_lshl_add_u32 v11, v11, 17, s40
    v_lshlrev_b16 v14, 8, v14
    v_lshrrev_b32 v13, 2, v95
    v_add_u32 v119, v12, v11
    v_bitop3_b32 v95, v5, v13, v14 bitop3:0xea
    ds_add_u32 v95, v2
    v_cvt_pk_bf16_f32 v111, v9, v10
    v_perm_b32 v12, v111, v111, s41
    v_bitop3_b32 v118, v4, v12, v118 bitop3:0xca
    v_perm_b32 v13, v111, v111, s42
    v_bitop3_b32 v119, v4, v13, v119 bitop3:0xca
    v_lshrrev_b32 v8, 2, v0
    v_and_b32 v7, 0x3c00, v0
    v_bitop3_b32 v7, v5, v8, v7 bitop3:0xea
    s_waitcnt lgkmcnt(0)
    s_barrier
    ds_read2st64_b32 v[8:9], v7 offset0:0 offset1:1
    ds_read2st64_b32 v[10:11], v7 offset0:2 offset1:3
    s_add_u32 s45, s35, 0x5484000
    s_add_u32 s45, s45, s93
    buffer_store_dwordx4 v[44:47], v0, s[20:23], s45 offen sc1
    s_add_u32 s46, s96, 0x8000000
    s_lshr_b32 s46, s46, 1
    buffer_load_dwordx2 v[44:45], v1, s[16:19], s46 offen nt
    s_add_u32 s47, s97, 0x8400000
    s_lshr_b32 s47, s47, 1
    buffer_load_dwordx2 v[46:47], v1, s[16:19], s47 offen nt
    s_waitcnt lgkmcnt(0)
    v_lshl_or_b32 v12, v9, 16, v8
    v_lshl_or_b32 v13, v11, 16, v10
    v_mov_b32 v14, v12
    v_mov_b32 v15, v13
    s_nop 0
    v_add_u32_dpp v14, v14, v14 row_shr:1 row_mask:0xf bank_mask:0xf bound_ctrl:1
    v_add_u32_dpp v15, v15, v15 row_shr:1 row_mask:0xf bank_mask:0xf bound_ctrl:1
    s_nop 0
    v_add_u32_dpp v14, v14, v14 row_shr:2 row_mask:0xf bank_mask:0xf bound_ctrl:1
    v_add_u32_dpp v15, v15, v15 row_shr:2 row_mask:0xf bank_mask:0xf bound_ctrl:1
    s_nop 0
    v_add_u32_dpp v14, v14, v14 row_shr:4 row_mask:0xf bank_mask:0xf bound_ctrl:1
    v_add_u32_dpp v15, v15, v15 row_shr:4 row_mask:0xf bank_mask:0xf bound_ctrl:1
    s_nop 0
    v_add_u32_dpp v14, v14, v14 row_shr:8 row_mask:0xf bank_mask:0xf bound_ctrl:1
    v_add_u32_dpp v15, v15, v15 row_shr:8 row_mask:0xf bank_mask:0xf bound_ctrl:1
    s_nop 0
    v_add_u32_dpp v14, v14, v14 row_bcast:15 row_mask:0xa bank_mask:0xf
    v_add_u32_dpp v15, v15, v15 row_bcast:15 row_mask:0xa bank_mask:0xf
    s_nop 0
    v_add_u32_dpp v14, v14, v14 row_bcast:31 row_mask:0xc bank_mask:0xf
    v_add_u32_dpp v15, v15, v15 row_bcast:31 row_mask:0xc bank_mask:0xf
    v_readlane_b32 s48, v14, 63
    v_readlane_b32 s49, v15, 63
    s_lshl_b32 s54, s32, 2
    v_mov_b32 v8, s54
    s_and_b32 s50, s48, 0xffff
    s_lshr_b32 s51, s48, 16
    s_and_b32 s52, s49, 0xffff
    s_lshr_b32 s53, s49, 16
    s_add_u32 s51, s51, s50
    s_add_u32 s52, s52, s51
    s_add_u32 s53, s53, s52
    v_mov_b32 v9, s53
    s_mov_b64 exec, 1
    ds_write_b32 v8, v9 offset:16384
    s_cmp_lg_u32 s32, 15
    s_cbranch_scc1 L1_tk2
    s_waitcnt vmcnt(3)
L1_tk2:
    ds_write_b32 v8, v3 offset:16448
    s_mov_b64 exec, -1
    v_and_b32 v8, 60, v7
    s_waitcnt lgkmcnt(0)
    s_barrier
    ds_read_b32 v9, v8 offset:16384
    ds_read_b32 v10, v8 offset:16448
    s_waitcnt lgkmcnt(0)
    v_readlane_b32 s84, v10, 15
    s_and_b32 s3, s2, 1
    s_lshl_b32 s3, s3, 7
    s_add_u32 s84, s84, s3
    s_min_u32 s4, s84, 80
    s_min_u32 s5, s84, 208
    s_min_u32 s6, s84, 240
    s_add_u32 s4, s4, s5
    s_add_u32 s4, s4, s6
    s_add_u32 s4, s4, 9467
    s_mov_b32 s4, s84
    s_lshl_b32 s58, s4, 14
    s_lshl_b32 s5, s32, 10
    s_add_u32 s58, s58, s5
    s_lshr_b32 s59, s58, 1
    s_mov_b32 s43, 5
    s_cmp_lt_u32 s84, 80
    s_addc_u32 s43, s43, 0
    s_cmp_lt_u32 s84, 208
    s_addc_u32 s43, s43, 0
    s_cmp_lt_u32 s84, 240
    s_addc_u32 s43, s43, 0
    v_add_u32_dpp v9, v9, v9 row_shr:1 row_mask:0xf bank_mask:0xf bound_ctrl:1
    s_nop 1
    v_add_u32_dpp v9, v9, v9 row_shr:2 row_mask:0xf bank_mask:0xf bound_ctrl:1
    s_nop 1
    v_add_u32_dpp v9, v9, v9 row_shr:4 row_mask:0xf bank_mask:0xf bound_ctrl:1
    s_nop 1
    v_add_u32_dpp v9, v9, v9 row_shr:8 row_mask:0xf bank_mask:0xf bound_ctrl:1
    s_nop 0
    v_readlane_b32 s54, v9, s32
    s_sub_u32 s54, s54, s53
    s_add_u32 s50, s50, s54
    s_add_u32 s51, s51, s54
    s_add_u32 s52, s52, s54
    s_pack_ll_b32_b16 s48, s54, s50
    s_pack_ll_b32_b16 s49, s51, s52
    v_add_u32 v14, s48, v14
    v_add_u32 v15, s49, v15
    v_sub_u32 v12, v14, v12
    v_sub_u32 v13, v15, v13
    v_and_b32 v8, 0xffff, v12
    v_lshrrev_b32 v9, 16, v12
    v_and_b32 v10, 0xffff, v13
    v_lshrrev_b32 v11, 16, v13
    ds_write2st64_b32 v7, v8, v9 offset0:0 offset1:1
    ds_write2st64_b32 v7, v10, v11 offset0:2 offset1:3
    v_and_b32 v8, 0x3f0, v0
    v_lshl_add_u32 v8, v8, 1, s36
    ds_write_b64 v8, v[12:13] offset:20480
    s_bitset0_b64 exec, 63
    s_not_b64 exec, exec
    ds_write_b64 v8, v[14:15] offset:20512
    s_mov_b64 exec, -1
    s_waitcnt lgkmcnt(0)
    s_barrier
    s_setprio 3
    ds_add_rtn_u32 v24, v24, v2
    ds_add_rtn_u32 v25, v25, v2
    ds_add_rtn_u32 v26, v26, v2
    ds_add_rtn_u32 v27, v27, v2
    ds_read_b128 v[12:15], v0 offset:20480
    v_cmp_gt_u32 vcc, 8448, v0
    ds_add_rtn_u32 v52, v52, v2
    ds_add_rtn_u32 v53, v53, v2
    ds_add_rtn_u32 v54, v54, v2
    ds_add_rtn_u32 v55, v55, v2
    s_setprio 2
    ds_add_rtn_u32 v72, v72, v2
    ds_add_rtn_u32 v73, v73, v2
    ds_add_rtn_u32 v74, v74, v2
    ds_add_rtn_u32 v75, v75, v2
    s_waitcnt lgkmcnt(8)
    s_cbranch_vccz L1_p4
    s_add_u32 s44, s35, 0x7ec0000
    s_mov_b64 exec, vcc
    buffer_store_dwordx4 v[12:15], v0, s[24:27], s44 offen sc1
    s_mov_b64 exec, -1
L1_p4:
    s_add_u32 s45, s35, 0x5488000
    s_add_u32 s45, s45, s72
    buffer_store_dwordx4 v[20:23], v0, s[20:23], s45 offen sc1
    s_add_u32 s46, s97, 0x8400000
    s_nop 0
    v_lshlrev_b32 v20, 1, v1
    buffer_load_dwordx4 v[20:23], v20, s[8:11], s46 offen nt
    ds_add_rtn_u32 v80, v80, v2
    ds_add_rtn_u32 v81, v81, v2
    ds_add_rtn_u32 v82, v82, v2
    ds_add_rtn_u32 v83, v83, v2
    s_setprio 1
    ds_add_rtn_u32 v96, v96, v2
    ds_add_rtn_u32 v97, v97, v2
    ds_add_rtn_u32 v98, v98, v2
    ds_add_rtn_u32 v99, v99, v2
    ds_add_rtn_u32 v100, v100, v2
    ds_add_rtn_u32 v101, v101, v2
    ds_add_rtn_u32 v102, v102, v2
    ds_add_rtn_u32 v103, v103, v2
    s_add_u32 s47, s35, 0x5488000
    s_add_u32 s47, s47, s73
    buffer_store_dwordx4 v[124:127], v0, s[20:23], s47 offen sc1
    s_add_u32 s44, s97, 0x8400000
    s_nop 0
    v_lshlrev_b32 v124, 1, v1
    buffer_load_dwordx4 v[124:127], v124, s[12:15], s44 offen nt
    s_setprio 0
    ds_add_rtn_u32 v88, v88, v2
    ds_add_rtn_u32 v89, v89, v2
    ds_add_rtn_u32 v90, v90, v2
    ds_add_rtn_u32 v91, v91, v2
    ds_add_rtn_u32 v92, v92, v2
    ds_add_rtn_u32 v93, v93, v2
    ds_add_rtn_u32 v94, v94, v2
    ds_add_rtn_u32 v95, v95, v2
    s_waitcnt lgkmcnt(0)
    s_barrier
    s_setprio 3
    v_and_b32 v7, -4, v24
    v_lshl_add_u32 v8, v24, 2, v7
    ds_write_b32 v8, v40
    v_lshl_add_u32 v7, v7, 2, v24
    ds_write_b8 v7, v84 offset:16
    v_and_b32 v9, -4, v25
    v_lshl_add_u32 v10, v25, 2, v9
    ds_write_b32 v10, v41
    v_lshl_add_u32 v9, v9, 2, v25
    ds_write_b8_d16_hi v9, v84 offset:16
    v_and_b32 v7, -4, v26
    v_lshl_add_u32 v8, v26, 2, v7
    ds_write_b32 v8, v42
    v_lshl_add_u32 v7, v7, 2, v26
    ds_write_b8 v7, v85 offset:16
    v_and_b32 v9, -4, v27
    v_lshl_add_u32 v10, v27, 2, v9
    ds_write_b32 v10, v43
    v_lshl_add_u32 v9, v9, 2, v27
    ds_write_b8_d16_hi v9, v85 offset:16
    s_add_u32 s45, s35, 0x5488000
    s_add_u32 s45, s45, s85
    buffer_store_dwordx4 v[32:35], v0, s[20:23], s45 offen sc1
    s_add_u32 s46, s98, 0x8800000
    v_lshlrev_b32 v40, 1, v1
    buffer_load_dwordx4 v[40:43], v40, s[8:11], s46 offen nt
    s_add_u32 s47, s98, 0x8800000
    v_lshlrev_b32 v24, 1, v1
    buffer_load_dwordx4 v[24:27], v24, s[12:15], s47 offen nt
    v_and_b32 v7, -4, v52
    v_lshl_add_u32 v8, v52, 2, v7
    ds_write_b32 v8, v48
    v_lshl_add_u32 v7, v7, 2, v52
    ds_write_b8 v7, v86 offset:16
    v_and_b32 v9, -4, v53
    v_lshl_add_u32 v10, v53, 2, v9
    ds_write_b32 v10, v49
    v_lshl_add_u32 v9, v9, 2, v53
    ds_write_b8_d16_hi v9, v86 offset:16
    v_and_b32 v7, -4, v54
    v_lshl_add_u32 v8, v54, 2, v7
    ds_write_b32 v8, v50
    v_lshl_add_u32 v7, v7, 2, v54
    ds_write_b8 v7, v87 offset:16
    v_and_b32 v9, -4, v55
    v_lshl_add_u32 v10, v55, 2, v9
    ds_write_b32 v10, v51
    v_lshl_add_u32 v9, v9, 2, v55
    ds_write_b8_d16_hi v9, v87 offset:16
    s_add_u32 s44, s98, 0x8800000
    s_lshr_b32 s44, s44, 1
    buffer_load_dwordx2 v[32:33], v1, s[16:19], s44 offen nt
    s_add_u32 s45, s99, 0x8c00000
    s_lshr_b32 s45, s45, 1
    buffer_load_dwordx2 v[34:35], v1, s[16:19], s45 offen nt
    s_add_u32 s46, s99, 0x8c00000
    v_lshlrev_b32 v48, 1, v1
    buffer_load_dwordx4 v[48:51], v48, s[8:11], s46 offen nt
    s_setprio 2
    v_and_b32 v7, -4, v72
    v_lshl_add_u32 v8, v72, 2, v7
    ds_write_b32 v8, v68
    v_lshl_add_u32 v7, v7, 2, v72
    ds_write_b8 v7, v56 offset:16
    v_and_b32 v9, -4, v73
    v_lshl_add_u32 v10, v73, 2, v9
    ds_write_b32 v10, v69
    v_lshl_add_u32 v9, v9, 2, v73
    ds_write_b8_d16_hi v9, v56 offset:16
    v_and_b32 v7, -4, v74
    v_lshl_add_u32 v8, v74, 2, v7
    ds_write_b32 v8, v70
    v_lshl_add_u32 v7, v7, 2, v74
    ds_write_b8 v7, v57 offset:16
    v_and_b32 v9, -4, v75
    v_lshl_add_u32 v10, v75, 2, v9
    ds_write_b32 v10, v71
    v_lshl_add_u32 v9, v9, 2, v75
    ds_write_b8_d16_hi v9, v57 offset:16
    s_add_u32 s47, s35, 0x5488000
    s_add_u32 s47, s47, s91
    buffer_store_dwordx4 v[36:39], v0, s[20:23], s47 offen sc1
    s_add_u32 s44, s99, 0x8c00000
    v_lshlrev_b32 v52, 1, v1
    buffer_load_dwordx4 v[52:55], v52, s[12:15], s44 offen nt
    v_and_b32 v7, -4, v80
    v_lshl_add_u32 v8, v80, 2, v7
    ds_write_b32 v8, v76
    v_lshl_add_u32 v7, v7, 2, v80
    ds_write_b8 v7, v58 offset:16
    v_and_b32 v9, -4, v81
    v_lshl_add_u32 v10, v81, 2, v9
    ds_write_b32 v10, v77
    v_lshl_add_u32 v9, v9, 2, v81
    ds_write_b8_d16_hi v9, v58 offset:16
    v_and_b32 v7, -4, v82
    v_lshl_add_u32 v8, v82, 2, v7
    ds_write_b32 v8, v78
    v_lshl_add_u32 v7, v7, 2, v82
    ds_write_b8 v7, v59 offset:16
    v_and_b32 v9, -4, v83
    v_lshl_add_u32 v10, v83, 2, v9
    ds_write_b32 v10, v79
    v_lshl_add_u32 v9, v9, 2, v83
    ds_write_b8_d16_hi v9, v59 offset:16
    s_add_u32 s45, s96, 0x9000000
    v_lshlrev_b32 v84, 1, v1
    buffer_load_dwordx4 v[84:87], v84, s[8:11], s45 offen nt
    s_add_u32 s46, s96, 0x9000000
    v_lshlrev_b32 v68, 1, v1
    buffer_load_dwordx4 v[68:71], v68, s[12:15], s46 offen nt
    s_setprio 1
    v_and_b32 v7, -4, v96
    v_lshl_add_u32 v8, v96, 2, v7
    ds_write_b32 v8, v64
    v_lshl_add_u32 v7, v7, 2, v96
    ds_write_b8 v7, v104 offset:16
    v_and_b32 v9, -4, v97
    v_lshl_add_u32 v10, v97, 2, v9
    ds_write_b32 v10, v65
    v_lshl_add_u32 v9, v9, 2, v97
    ds_write_b8_d16_hi v9, v104 offset:16
    v_and_b32 v7, -4, v98
    v_lshl_add_u32 v8, v98, 2, v7
    ds_write_b32 v8, v66
    v_lshl_add_u32 v7, v7, 2, v98
    ds_write_b8 v7, v105 offset:16
    v_and_b32 v9, -4, v99
    v_lshl_add_u32 v10, v99, 2, v9
    ds_write_b32 v10, v67
    v_lshl_add_u32 v9, v9, 2, v99
    ds_write_b8_d16_hi v9, v105 offset:16
    s_add_u32 s47, s96, 0x9000000
    s_lshr_b32 s47, s47, 1
    buffer_load_dwordx2 v[72:73], v1, s[16:19], s47 offen nt
    s_cmp_le_u32 s43, 5
    s_cselect_b32 s18, 0, s18
    s_add_u32 s44, s59, 0x4a00000
    buffer_load_dwordx2 v[74:75], v1, s[16:19], s44 offen nt
    s_cmp_le_u32 s43, 5
    s_cselect_b32 s10, 0, s10
    s_add_u32 s45, s58, 0x9400000
    v_lshlrev_b32 v36, 1, v1
    buffer_load_dwordx4 v[36:39], v36, s[8:11], s45 offen nt
    v_and_b32 v7, -4, v100
    v_lshl_add_u32 v8, v100, 2, v7
    ds_write_b32 v8, v60
    v_lshl_add_u32 v7, v7, 2, v100
    ds_write_b8 v7, v106 offset:16
    v_and_b32 v9, -4, v101
    v_lshl_add_u32 v10, v101, 2, v9
    ds_write_b32 v10, v61
    v_lshl_add_u32 v9, v9, 2, v101
    ds_write_b8_d16_hi v9, v106 offset:16
    v_and_b32 v7, -4, v102
    v_lshl_add_u32 v8, v102, 2, v7
    ds_write_b32 v8, v62
    v_lshl_add_u32 v7, v7, 2, v102
    ds_write_b8 v7, v107 offset:16
    v_and_b32 v9, -4, v103
    v_lshl_add_u32 v10, v103, 2, v9
    ds_write_b32 v10, v63
    v_lshl_add_u32 v9, v9, 2, v103
    ds_write_b8_d16_hi v9, v107 offset:16
    s_add_u32 s46, s35, 0x5488000
    s_add_u32 s46, s46, s93
    buffer_store_dwordx4 v[28:31], v0, s[20:23], s46 offen sc1
    s_cmp_le_u32 s43, 5
    s_cselect_b32 s14, 0, s14
    s_add_u32 s47, s58, 0x9400000
    v_lshlrev_b32 v76, 1, v1
    buffer_load_dwordx4 v[76:79], v76, s[12:15], s47 offen nt
    s_setprio 0
    v_and_b32 v7, -4, v88
    v_lshl_add_u32 v8, v88, 2, v7
    ds_write_b32 v8, v112
    v_lshl_add_u32 v7, v7, 2, v88
    ds_write_b8 v7, v108 offset:16
    v_and_b32 v9, -4, v89
    v_lshl_add_u32 v10, v89, 2, v9
    ds_write_b32 v10, v113
    v_lshl_add_u32 v9, v9, 2, v89
    ds_write_b8_d16_hi v9, v108 offset:16
    v_and_b32 v7, -4, v90
    v_lshl_add_u32 v8, v90, 2, v7
    ds_write_b32 v8, v114
    v_lshl_add_u32 v7, v7, 2, v90
    ds_write_b8 v7, v109 offset:16
    v_and_b32 v9, -4, v91
    v_lshl_add_u32 v10, v91, 2, v9
    ds_write_b32 v10, v115
    v_lshl_add_u32 v9, v9, 2, v91
    ds_write_b8_d16_hi v9, v109 offset:16
    s_cmp_le_u32 s43, 6
    s_cselect_b32 s10, 0, s10
    s_add_u32 s44, s58, 0x97c0000
    v_lshlrev_b32 v80, 1, v1
    buffer_load_dwordx4 v[80:83], v80, s[8:11], s44 offen nt
    s_cmp_le_u32 s43, 6
    s_cselect_b32 s14, 0, s14
    s_add_u32 s45, s58, 0x97c0000
    v_lshlrev_b32 v56, 1, v1
    buffer_load_dwordx4 v[56:59], v56, s[12:15], s45 offen nt
    v_and_b32 v7, -4, v92
    v_lshl_add_u32 v8, v92, 2, v7
    ds_write_b32 v8, v116
    v_lshl_add_u32 v7, v7, 2, v92
    ds_write_b8 v7, v110 offset:16
    v_and_b32 v9, -4, v93
    v_lshl_add_u32 v10, v93, 2, v9
    ds_write_b32 v10, v117
    v_lshl_add_u32 v9, v9, 2, v93
    ds_write_b8_d16_hi v9, v110 offset:16
    v_and_b32 v7, -4, v94
    v_lshl_add_u32 v8, v94, 2, v7
    ds_write_b32 v8, v118
    v_lshl_add_u32 v7, v7, 2, v94
    ds_write_b8 v7, v111 offset:16
    v_and_b32 v9, -4, v95
    v_lshl_add_u32 v10, v95, 2, v9
    ds_write_b32 v10, v119
    v_lshl_add_u32 v9, v9, 2, v95
    ds_write_b8_d16_hi v9, v111 offset:16
    s_cmp_le_u32 s43, 6
    s_cselect_b32 s18, 0, s18
    s_add_u32 s46, s59, 0x4be0000
    buffer_load_dwordx2 v[64:65], v1, s[16:19], s46 offen nt
    s_cmp_le_u32 s43, 7
    s_cselect_b32 s18, 0, s18
    s_add_u32 s47, s59, 0x4d80000
    buffer_load_dwordx2 v[66:67], v1, s[16:19], s47 offen nt
    v_add_u32 v7, s72, v0
    v_add_u32 v12, s73, v0
    v_add_u32 v13, s85, v0
    v_add_u32 v14, s91, v0
    v_add_u32 v15, s93, v0
    s_min_i32 s3, s72, s73
    s_min_i32 s3, s3, s85
    s_min_i32 s3, s3, s91
    s_min_i32 s3, s3, s93
    v_add_u32 v3, s3, v0
    v_mov_b32 v8, 0
    v_mov_b32 v9, 0
    v_mov_b32 v10, 0
    v_mov_b32 v11, 0
    s_waitcnt lgkmcnt(0)
    s_barrier
    ds_read_b128 v[96:99], v7 offset:0
    ds_read_b128 v[60:63], v12 offset:0
    ds_read_b128 v[100:103], v13 offset:0
    ds_read_b128 v[104:107], v14 offset:0
    ds_read_b128 v[28:31], v15 offset:0
    ds_write_b128 v3, v[8:11]
    ds_read_b128 v[112:115], v7 offset:16384
    ds_read_b128 v[88:91], v12 offset:16384
    ds_read_b128 v[116:119], v13 offset:16384
    ds_read_b128 v[92:95], v14 offset:16384
    ds_read_b128 v[108:111], v15 offset:16384
    s_waitcnt lgkmcnt(0)
    s_barrier
    v_lshlrev_b32 v3, 3, v0
    v_and_b32 v3, 0x80, v3
    s_cmp_lg_u32 s32, 15
    s_cbranch_scc1 L2_k0
    s_mov_b64 exec, 3
    buffer_load_dword v3, v3, s[68:71], 0 offen sc1
    s_mov_b64 exec, -1
L2_k0:
    s_add_u32 s44, s35, 0x7ec4000
    s_add_u32 s44, s44, s72
    buffer_store_dwordx4 v[96:99], v0, s[20:23], s44 offen sc1
    s_cmp_le_u32 s43, 7
    s_cselect_b32 s10, 0, s10
    s_add_u32 s45, s58, 0x9b00000
    v_lshlrev_b32 v96, 1, v1
    buffer_load_dwordx4 v[96:99], v96, s[8:11], s45 offen nt
    s_add_u32 s46, s35, 0x7ec4000
    s_add_u32 s46, s46, s73
    buffer_store_dwordx4 v[60:63], v0, s[20:23], s46 offen sc1
    s_cmp_le_u32 s43, 7
    s_cselect_b32 s14, 0, s14
    s_add_u32 s47, s58, 0x9b00000
    v_lshlrev_b32 v60, 1, v1
    buffer_load_dwordx4 v[60:63], v60, s[12:15], s47 offen nt
    s_setprio 3
    s_waitcnt vmcnt(27)
    v_lshlrev_b32 v7, 16, v44
    v_and_b32 v8, 0xffff0000, v44
    v_lshlrev_b32 v9, 16, v45
    v_and_b32 v10, 0xffff0000, v45
    v_mul_f32 v7, 0.15915494, v7
    v_mul_f32 v8, 0.15915494, v8
    v_mul_f32 v9, 0.15915494, v9
    v_mul_f32 v10, 0.15915494, v10
    v_mul_hi_u32_u24 v14, 429497, v16
    v_lshrrev_b32 v12, 3, v120
    v_cos_f32 v7, v7
    v_lshlrev_b16 v13, 3, v120
    v_mad_i32_i24 v11, v14, s55, v16
    v_bitop3_b32 v12, v6, v13, v12 bitop3:0xca
    v_lshl_add_u32 v11, v11, 17, s40
    v_lshlrev_b16 v14, 8, v14
    v_lshrrev_b32 v13, 2, v120
    v_add_u32 v16, v12, v11
    v_bitop3_b32 v120, v5, v13, v14 bitop3:0xea
    ds_add_u32 v120, v2
    v_mul_hi_u32_u24 v14, 429497, v17
    v_lshrrev_b32 v12, 3, v121
    v_cos_f32 v8, v8
    v_lshlrev_b16 v13, 3, v121
    v_mad_i32_i24 v11, v14, s55, v17
    v_bitop3_b32 v12, v6, v13, v12 bitop3:0xca
    v_lshl_add_u32 v11, v11, 17, s40
    v_lshlrev_b16 v14, 8, v14
    v_lshrrev_b32 v13, 2, v121
    v_add_u32 v17, v12, v11
    v_bitop3_b32 v121, v5, v13, v14 bitop3:0xea
    ds_add_u32 v121, v2
    v_cvt_pk_bf16_f32 v44, v7, v8
    v_perm_b32 v12, v44, v44, s41
    v_bitop3_b32 v16, v4, v12, v16 bitop3:0xca
    v_perm_b32 v13, v44, v44, s42
    v_bitop3_b32 v17, v4, v13, v17 bitop3:0xca
    v_mul_hi_u32_u24 v14, 429497, v18
    v_lshrrev_b32 v12, 3, v122
    v_cos_f32 v9, v9
    v_lshlrev_b16 v13, 3, v122
    v_mad_i32_i24 v11, v14, s55, v18
    v_bitop3_b32 v12, v6, v13, v12 bitop3:0xca
    v_lshl_add_u32 v11, v11, 17, s40
    v_lshlrev_b16 v14, 8, v14
    v_lshrrev_b32 v13, 2, v122
    v_add_u32 v18, v12, v11
    v_bitop3_b32 v122, v5, v13, v14 bitop3:0xea
    ds_add_u32 v122, v2
    v_mul_hi_u32_u24 v14, 429497, v19
    v_lshrrev_b32 v12, 3, v123
    v_cos_f32 v10, v10
    v_lshlrev_b16 v13, 3, v123
    v_mad_i32_i24 v11, v14, s55, v19
    v_bitop3_b32 v12, v6, v13, v12 bitop3:0xca
    v_lshl_add_u32 v11, v11, 17, s40
    v_lshlrev_b16 v14, 8, v14
    v_lshrrev_b32 v13, 2, v123
    v_add_u32 v19, v12, v11
    v_bitop3_b32 v123, v5, v13, v14 bitop3:0xea
    ds_add_u32 v123, v2
    v_cvt_pk_bf16_f32 v45, v9, v10
    v_perm_b32 v12, v45, v45, s41
    v_bitop3_b32 v18, v4, v12, v18 bitop3:0xca
    v_perm_b32 v13, v45, v45, s42
    v_bitop3_b32 v19, v4, v13, v19 bitop3:0xca
    s_waitcnt vmcnt(23)
    v_lshlrev_b32 v7, 16, v46
    v_and_b32 v8, 0xffff0000, v46
    v_lshlrev_b32 v9, 16, v47
    v_and_b32 v10, 0xffff0000, v47
    v_mul_f32 v7, 0.15915494, v7
    v_mul_f32 v8, 0.15915494, v8
    v_mul_f32 v9, 0.15915494, v9
    v_mul_f32 v10, 0.15915494, v10
    v_mul_hi_u32_u24 v14, 429497, v20
    v_lshrrev_b32 v12, 3, v124
    v_cos_f32 v7, v7
    v_lshlrev_b16 v13, 3, v124
    v_mad_i32_i24 v11, v14, s55, v20
    v_bitop3_b32 v12, v6, v13, v12 bitop3:0xca
    v_lshl_add_u32 v11, v11, 17, s40
    v_lshlrev_b16 v14, 8, v14
    v_lshrrev_b32 v13, 2, v124
    v_add_u32 v20, v12, v11
    v_bitop3_b32 v124, v5, v13, v14 bitop3:0xea
    ds_add_u32 v124, v2
    v_mul_hi_u32_u24 v14, 429497, v21
    v_lshrrev_b32 v12, 3, v125
    v_cos_f32 v8, v8
    v_lshlrev_b16 v13, 3, v125
    v_mad_i32_i24 v11, v14, s55, v21
    v_bitop3_b32 v12, v6, v13, v12 bitop3:0xca
    v_lshl_add_u32 v11, v11, 17, s40
    v_lshlrev_b16 v14, 8, v14
    v_lshrrev_b32 v13, 2, v125
    v_add_u32 v21, v12, v11
    v_bitop3_b32 v125, v5, v13, v14 bitop3:0xea
    ds_add_u32 v125, v2
    v_cvt_pk_bf16_f32 v46, v7, v8
    v_perm_b32 v12, v46, v46, s41
    v_bitop3_b32 v20, v4, v12, v20 bitop3:0xca
    v_perm_b32 v13, v46, v46, s42
    v_bitop3_b32 v21, v4, v13, v21 bitop3:0xca
    v_mul_hi_u32_u24 v14, 429497, v22
    v_lshrrev_b32 v12, 3, v126
    v_cos_f32 v9, v9
    v_lshlrev_b16 v13, 3, v126
    v_mad_i32_i24 v11, v14, s55, v22
    v_bitop3_b32 v12, v6, v13, v12 bitop3:0xca
    v_lshl_add_u32 v11, v11, 17, s40
    v_lshlrev_b16 v14, 8, v14
    v_lshrrev_b32 v13, 2, v126
    v_add_u32 v22, v12, v11
    v_bitop3_b32 v126, v5, v13, v14 bitop3:0xea
    ds_add_u32 v126, v2
    v_mul_hi_u32_u24 v14, 429497, v23
    v_lshrrev_b32 v12, 3, v127
    v_cos_f32 v10, v10
    v_lshlrev_b16 v13, 3, v127
    v_mad_i32_i24 v11, v14, s55, v23
    v_bitop3_b32 v12, v6, v13, v12 bitop3:0xca
    v_lshl_add_u32 v11, v11, 17, s40
    v_lshlrev_b16 v14, 8, v14
    v_lshrrev_b32 v13, 2, v127
    v_add_u32 v23, v12, v11
    v_bitop3_b32 v127, v5, v13, v14 bitop3:0xea
    ds_add_u32 v127, v2
    v_cvt_pk_bf16_f32 v47, v9, v10
    v_perm_b32 v12, v47, v47, s41
    v_bitop3_b32 v22, v4, v12, v22 bitop3:0xca
    v_perm_b32 v13, v47, v47, s42
    v_bitop3_b32 v23, v4, v13, v23 bitop3:0xca
    s_setprio 2
    s_add_u32 s44, s35, 0x7ec4000
    s_add_u32 s44, s44, s85
    buffer_store_dwordx4 v[100:103], v0, s[20:23], s44 offen sc1
    s_waitcnt vmcnt(19)
    v_lshlrev_b32 v7, 16, v32
    v_and_b32 v8, 0xffff0000, v32
    v_lshlrev_b32 v9, 16, v33
    v_and_b32 v10, 0xffff0000, v33
    v_mul_f32 v7, 0.15915494, v7
    v_mul_f32 v8, 0.15915494, v8
    v_mul_f32 v9, 0.15915494, v9
    v_mul_f32 v10, 0.15915494, v10
    v_mul_hi_u32_u24 v14, 429497, v40
    v_lshrrev_b32 v12, 3, v24
    v_cos_f32 v7, v7
    v_lshlrev_b16 v13, 3, v24
    v_mad_i32_i24 v11, v14, s55, v40
    v_bitop3_b32 v12, v6, v13, v12 bitop3:0xca
    v_lshl_add_u32 v11, v11, 17, s40
    v_lshlrev_b16 v14, 8, v14
    v_lshrrev_b32 v13, 2, v24
    v_add_u32 v40, v12, v11
    v_bitop3_b32 v24, v5, v13, v14 bitop3:0xea
    ds_add_u32 v24, v2
    v_mul_hi_u32_u24 v14, 429497, v41
    v_lshrrev_b32 v12, 3, v25
    v_cos_f32 v8, v8
    v_lshlrev_b16 v13, 3, v25
    v_mad_i32_i24 v11, v14, s55, v41
    v_bitop3_b32 v12, v6, v13, v12 bitop3:0xca
    v_lshl_add_u32 v11, v11, 17, s40
    v_lshlrev_b16 v14, 8, v14
    v_lshrrev_b32 v13, 2, v25
    v_add_u32 v41, v12, v11
    v_bitop3_b32 v25, v5, v13, v14 bitop3:0xea
    ds_add_u32 v25, v2
    v_cvt_pk_bf16_f32 v32, v7, v8
    v_perm_b32 v12, v32, v32, s41
    v_bitop3_b32 v40, v4, v12, v40 bitop3:0xca
    v_perm_b32 v13, v32, v32, s42
    v_bitop3_b32 v41, v4, v13, v41 bitop3:0xca
    v_mul_hi_u32_u24 v14, 429497, v42
    v_lshrrev_b32 v12, 3, v26
    v_cos_f32 v9, v9
    v_lshlrev_b16 v13, 3, v26
    v_mad_i32_i24 v11, v14, s55, v42
    v_bitop3_b32 v12, v6, v13, v12 bitop3:0xca
    v_lshl_add_u32 v11, v11, 17, s40
    v_lshlrev_b16 v14, 8, v14
    v_lshrrev_b32 v13, 2, v26
    v_add_u32 v42, v12, v11
    v_bitop3_b32 v26, v5, v13, v14 bitop3:0xea
    ds_add_u32 v26, v2
    v_mul_hi_u32_u24 v14, 429497, v43
    v_lshrrev_b32 v12, 3, v27
    v_cos_f32 v10, v10
    v_lshlrev_b16 v13, 3, v27
    v_mad_i32_i24 v11, v14, s55, v43
    v_bitop3_b32 v12, v6, v13, v12 bitop3:0xca
    v_lshl_add_u32 v11, v11, 17, s40
    v_lshlrev_b16 v14, 8, v14
    v_lshrrev_b32 v13, 2, v27
    v_add_u32 v43, v12, v11
    v_bitop3_b32 v27, v5, v13, v14 bitop3:0xea
    ds_add_u32 v27, v2
    v_cvt_pk_bf16_f32 v33, v9, v10
    v_perm_b32 v12, v33, v33, s41
    v_bitop3_b32 v42, v4, v12, v42 bitop3:0xca
    v_perm_b32 v13, v33, v33, s42
    v_bitop3_b32 v43, v4, v13, v43 bitop3:0xca
    s_waitcnt vmcnt(16)
    v_lshlrev_b32 v7, 16, v34
    v_and_b32 v8, 0xffff0000, v34
    v_lshlrev_b32 v9, 16, v35
    v_and_b32 v10, 0xffff0000, v35
    v_mul_f32 v7, 0.15915494, v7
    v_mul_f32 v8, 0.15915494, v8
    v_mul_f32 v9, 0.15915494, v9
    v_mul_f32 v10, 0.15915494, v10
    v_mul_hi_u32_u24 v14, 429497, v48
    v_lshrrev_b32 v12, 3, v52
    v_cos_f32 v7, v7
    v_lshlrev_b16 v13, 3, v52
    v_mad_i32_i24 v11, v14, s55, v48
    v_bitop3_b32 v12, v6, v13, v12 bitop3:0xca
    v_lshl_add_u32 v11, v11, 17, s40
    v_lshlrev_b16 v14, 8, v14
    v_lshrrev_b32 v13, 2, v52
    v_add_u32 v48, v12, v11
    v_bitop3_b32 v52, v5, v13, v14 bitop3:0xea
    ds_add_u32 v52, v2
    v_mul_hi_u32_u24 v14, 429497, v49
    v_lshrrev_b32 v12, 3, v53
    v_cos_f32 v8, v8
    v_lshlrev_b16 v13, 3, v53
    v_mad_i32_i24 v11, v14, s55, v49
    v_bitop3_b32 v12, v6, v13, v12 bitop3:0xca
    v_lshl_add_u32 v11, v11, 17, s40
    v_lshlrev_b16 v14, 8, v14
    v_lshrrev_b32 v13, 2, v53
    v_add_u32 v49, v12, v11
    v_bitop3_b32 v53, v5, v13, v14 bitop3:0xea
    ds_add_u32 v53, v2
    v_cvt_pk_bf16_f32 v34, v7, v8
    v_perm_b32 v12, v34, v34, s41
    v_bitop3_b32 v48, v4, v12, v48 bitop3:0xca
    v_perm_b32 v13, v34, v34, s42
    v_bitop3_b32 v49, v4, v13, v49 bitop3:0xca
    v_mul_hi_u32_u24 v14, 429497, v50
    v_lshrrev_b32 v12, 3, v54
    v_cos_f32 v9, v9
    v_lshlrev_b16 v13, 3, v54
    v_mad_i32_i24 v11, v14, s55, v50
    v_bitop3_b32 v12, v6, v13, v12 bitop3:0xca
    v_lshl_add_u32 v11, v11, 17, s40
    v_lshlrev_b16 v14, 8, v14
    v_lshrrev_b32 v13, 2, v54
    v_add_u32 v50, v12, v11
    v_bitop3_b32 v54, v5, v13, v14 bitop3:0xea
    ds_add_u32 v54, v2
    v_mul_hi_u32_u24 v14, 429497, v51
    v_lshrrev_b32 v12, 3, v55
    v_cos_f32 v10, v10
    v_lshlrev_b16 v13, 3, v55
    v_mad_i32_i24 v11, v14, s55, v51
    v_bitop3_b32 v12, v6, v13, v12 bitop3:0xca
    v_lshl_add_u32 v11, v11, 17, s40
    v_lshlrev_b16 v14, 8, v14
    v_lshrrev_b32 v13, 2, v55
    v_add_u32 v51, v12, v11
    v_bitop3_b32 v55, v5, v13, v14 bitop3:0xea
    ds_add_u32 v55, v2
    v_cvt_pk_bf16_f32 v35, v9, v10
    v_perm_b32 v12, v35, v35, s41
    v_bitop3_b32 v50, v4, v12, v50 bitop3:0xca
    v_perm_b32 v13, v35, v35, s42
    v_bitop3_b32 v51, v4, v13, v51 bitop3:0xca
    s_setprio 1
    s_waitcnt vmcnt(12)
    v_lshlrev_b32 v7, 16, v72
    v_and_b32 v8, 0xffff0000, v72
    v_lshlrev_b32 v9, 16, v73
    v_and_b32 v10, 0xffff0000, v73
    v_mul_f32 v7, 0.15915494, v7
    v_mul_f32 v8, 0.15915494, v8
    v_mul_f32 v9, 0.15915494, v9
    v_mul_f32 v10, 0.15915494, v10
    v_mul_hi_u32_u24 v14, 429497, v84
    v_lshrrev_b32 v12, 3, v68
    v_cos_f32 v7, v7
    v_lshlrev_b16 v13, 3, v68
    v_mad_i32_i24 v11, v14, s55, v84
    v_bitop3_b32 v12, v6, v13, v12 bitop3:0xca
    v_lshl_add_u32 v11, v11, 17, s40
    v_lshlrev_b16 v14, 8, v14
    v_lshrrev_b32 v13, 2, v68
    v_add_u32 v84, v12, v11
    v_bitop3_b32 v68, v5, v13, v14 bitop3:0xea
    ds_add_u32 v68, v2
    v_mul_hi_u32_u24 v14, 429497, v85
    v_lshrrev_b32 v12, 3, v69
    v_cos_f32 v8, v8
    v_lshlrev_b16 v13, 3, v69
    v_mad_i32_i24 v11, v14, s55, v85
    v_bitop3_b32 v12, v6, v13, v12 bitop3:0xca
    v_lshl_add_u32 v11, v11, 17, s40
    v_lshlrev_b16 v14, 8, v14
    v_lshrrev_b32 v13, 2, v69
    v_add_u32 v85, v12, v11
    v_bitop3_b32 v69, v5, v13, v14 bitop3:0xea
    ds_add_u32 v69, v2
    v_cvt_pk_bf16_f32 v72, v7, v8
    v_perm_b32 v12, v72, v72, s41
    v_bitop3_b32 v84, v4, v12, v84 bitop3:0xca
    v_perm_b32 v13, v72, v72, s42
    v_bitop3_b32 v85, v4, v13, v85 bitop3:0xca
    v_mul_hi_u32_u24 v14, 429497, v86
    v_lshrrev_b32 v12, 3, v70
    v_cos_f32 v9, v9
    v_lshlrev_b16 v13, 3, v70
    v_mad_i32_i24 v11, v14, s55, v86
    v_bitop3_b32 v12, v6, v13, v12 bitop3:0xca
    v_lshl_add_u32 v11, v11, 17, s40
    v_lshlrev_b16 v14, 8, v14
    v_lshrrev_b32 v13, 2, v70
    v_add_u32 v86, v12, v11
    v_bitop3_b32 v70, v5, v13, v14 bitop3:0xea
    ds_add_u32 v70, v2
    v_mul_hi_u32_u24 v14, 429497, v87
    v_lshrrev_b32 v12, 3, v71
    v_cos_f32 v10, v10
    v_lshlrev_b16 v13, 3, v71
    v_mad_i32_i24 v11, v14, s55, v87
    v_bitop3_b32 v12, v6, v13, v12 bitop3:0xca
    v_lshl_add_u32 v11, v11, 17, s40
    v_lshlrev_b16 v14, 8, v14
    v_lshrrev_b32 v13, 2, v71
    v_add_u32 v87, v12, v11
    v_bitop3_b32 v71, v5, v13, v14 bitop3:0xea
    ds_add_u32 v71, v2
    v_cvt_pk_bf16_f32 v73, v9, v10
    v_perm_b32 v12, v73, v73, s41
    v_bitop3_b32 v86, v4, v12, v86 bitop3:0xca
    v_perm_b32 v13, v73, v73, s42
    v_bitop3_b32 v87, v4, v13, v87 bitop3:0xca
    s_add_u32 s45, s35, 0x7ec4000
    s_add_u32 s45, s45, s91
    buffer_store_dwordx4 v[104:107], v0, s[20:23], s45 offen sc1
    s_waitcnt vmcnt(10)
    s_cmp_le_u32 s43, 5
    s_cbranch_scc1 L1_s5
    v_lshlrev_b32 v7, 16, v74
    v_and_b32 v8, 0xffff0000, v74
    v_lshlrev_b32 v9, 16, v75
    v_and_b32 v10, 0xffff0000, v75
    v_mul_f32 v7, 0.15915494, v7
    v_mul_f32 v8, 0.15915494, v8
    v_mul_f32 v9, 0.15915494, v9
    v_mul_f32 v10, 0.15915494, v10
    v_mul_hi_u32_u24 v14, 429497, v36
    v_lshrrev_b32 v12, 3, v76
    v_cos_f32 v7, v7
    v_lshlrev_b16 v13, 3, v76
    v_mad_i32_i24 v11, v14, s55, v36
    v_bitop3_b32 v12, v6, v13, v12 bitop3:0xca
    v_lshl_add_u32 v11, v11, 17, s40
    v_lshlrev_b16 v14, 8, v14
    v_lshrrev_b32 v13, 2, v76
    v_add_u32 v36, v12, v11
    v_bitop3_b32 v76, v5, v13, v14 bitop3:0xea
    ds_add_u32 v76, v2
    v_mul_hi_u32_u24 v14, 429497, v37
    v_lshrrev_b32 v12, 3, v77
    v_cos_f32 v8, v8
    v_lshlrev_b16 v13, 3, v77
    v_mad_i32_i24 v11, v14, s55, v37
    v_bitop3_b32 v12, v6, v13, v12 bitop3:0xca
    v_lshl_add_u32 v11, v11, 17, s40
    v_lshlrev_b16 v14, 8, v14
    v_lshrrev_b32 v13, 2, v77
    v_add_u32 v37, v12, v11
    v_bitop3_b32 v77, v5, v13, v14 bitop3:0xea
    ds_add_u32 v77, v2
    v_cvt_pk_bf16_f32 v74, v7, v8
    v_perm_b32 v12, v74, v74, s41
    v_bitop3_b32 v36, v4, v12, v36 bitop3:0xca
    v_perm_b32 v13, v74, v74, s42
    v_bitop3_b32 v37, v4, v13, v37 bitop3:0xca
    v_mul_hi_u32_u24 v14, 429497, v38
    v_lshrrev_b32 v12, 3, v78
    v_cos_f32 v9, v9
    v_lshlrev_b16 v13, 3, v78
    v_mad_i32_i24 v11, v14, s55, v38
    v_bitop3_b32 v12, v6, v13, v12 bitop3:0xca
    v_lshl_add_u32 v11, v11, 17, s40
    v_lshlrev_b16 v14, 8, v14
    v_lshrrev_b32 v13, 2, v78
    v_add_u32 v38, v12, v11
    v_bitop3_b32 v78, v5, v13, v14 bitop3:0xea
    ds_add_u32 v78, v2
    v_mul_hi_u32_u24 v14, 429497, v39
    v_lshrrev_b32 v12, 3, v79
    v_cos_f32 v10, v10
    v_lshlrev_b16 v13, 3, v79
    v_mad_i32_i24 v11, v14, s55, v39
    v_bitop3_b32 v12, v6, v13, v12 bitop3:0xca
    v_lshl_add_u32 v11, v11, 17, s40
    v_lshlrev_b16 v14, 8, v14
    v_lshrrev_b32 v13, 2, v79
    v_add_u32 v39, v12, v11
    v_bitop3_b32 v79, v5, v13, v14 bitop3:0xea
    ds_add_u32 v79, v2
    v_cvt_pk_bf16_f32 v75, v9, v10
    v_perm_b32 v12, v75, v75, s41
    v_bitop3_b32 v38, v4, v12, v38 bitop3:0xca
    v_perm_b32 v13, v75, v75, s42
    v_bitop3_b32 v39, v4, v13, v39 bitop3:0xca
L1_s5:
    s_setprio 0
    s_waitcnt vmcnt(6)
    s_cmp_le_u32 s43, 6
    s_cbranch_scc1 L1_s6
    v_lshlrev_b32 v7, 16, v64
    v_and_b32 v8, 0xffff0000, v64
    v_lshlrev_b32 v9, 16, v65
    v_and_b32 v10, 0xffff0000, v65
    v_mul_f32 v7, 0.15915494, v7
    v_mul_f32 v8, 0.15915494, v8
    v_mul_f32 v9, 0.15915494, v9
    v_mul_f32 v10, 0.15915494, v10
    v_mul_hi_u32_u24 v14, 429497, v80
    v_lshrrev_b32 v12, 3, v56
    v_cos_f32 v7, v7
    v_lshlrev_b16 v13, 3, v56
    v_mad_i32_i24 v11, v14, s55, v80
    v_bitop3_b32 v12, v6, v13, v12 bitop3:0xca
    v_lshl_add_u32 v11, v11, 17, s40
    v_lshlrev_b16 v14, 8, v14
    v_lshrrev_b32 v13, 2, v56
    v_add_u32 v80, v12, v11
    v_bitop3_b32 v56, v5, v13, v14 bitop3:0xea
    ds_add_u32 v56, v2
    v_mul_hi_u32_u24 v14, 429497, v81
    v_lshrrev_b32 v12, 3, v57
    v_cos_f32 v8, v8
    v_lshlrev_b16 v13, 3, v57
    v_mad_i32_i24 v11, v14, s55, v81
    v_bitop3_b32 v12, v6, v13, v12 bitop3:0xca
    v_lshl_add_u32 v11, v11, 17, s40
    v_lshlrev_b16 v14, 8, v14
    v_lshrrev_b32 v13, 2, v57
    v_add_u32 v81, v12, v11
    v_bitop3_b32 v57, v5, v13, v14 bitop3:0xea
    ds_add_u32 v57, v2
    v_cvt_pk_bf16_f32 v64, v7, v8
    v_perm_b32 v12, v64, v64, s41
    v_bitop3_b32 v80, v4, v12, v80 bitop3:0xca
    v_perm_b32 v13, v64, v64, s42
    v_bitop3_b32 v81, v4, v13, v81 bitop3:0xca
    v_mul_hi_u32_u24 v14, 429497, v82
    v_lshrrev_b32 v12, 3, v58
    v_cos_f32 v9, v9
    v_lshlrev_b16 v13, 3, v58
    v_mad_i32_i24 v11, v14, s55, v82
    v_bitop3_b32 v12, v6, v13, v12 bitop3:0xca
    v_lshl_add_u32 v11, v11, 17, s40
    v_lshlrev_b16 v14, 8, v14
    v_lshrrev_b32 v13, 2, v58
    v_add_u32 v82, v12, v11
    v_bitop3_b32 v58, v5, v13, v14 bitop3:0xea
    ds_add_u32 v58, v2
    v_mul_hi_u32_u24 v14, 429497, v83
    v_lshrrev_b32 v12, 3, v59
    v_cos_f32 v10, v10
    v_lshlrev_b16 v13, 3, v59
    v_mad_i32_i24 v11, v14, s55, v83
    v_bitop3_b32 v12, v6, v13, v12 bitop3:0xca
    v_lshl_add_u32 v11, v11, 17, s40
    v_lshlrev_b16 v14, 8, v14
    v_lshrrev_b32 v13, 2, v59
    v_add_u32 v83, v12, v11
    v_bitop3_b32 v59, v5, v13, v14 bitop3:0xea
    ds_add_u32 v59, v2
    v_cvt_pk_bf16_f32 v65, v9, v10
    v_perm_b32 v12, v65, v65, s41
    v_bitop3_b32 v82, v4, v12, v82 bitop3:0xca
    v_perm_b32 v13, v65, v65, s42
    v_bitop3_b32 v83, v4, v13, v83 bitop3:0xca
L1_s6:
    s_waitcnt vmcnt(2)
    s_cmp_le_u32 s43, 7
    s_cbranch_scc1 L1_s7
    v_lshlrev_b32 v7, 16, v66
    v_and_b32 v8, 0xffff0000, v66
    v_lshlrev_b32 v9, 16, v67
    v_and_b32 v10, 0xffff0000, v67
    v_mul_f32 v7, 0.15915494, v7
    v_mul_f32 v8, 0.15915494, v8
    v_mul_f32 v9, 0.15915494, v9
    v_mul_f32 v10, 0.15915494, v10
    v_mul_hi_u32_u24 v14, 429497, v96
    v_lshrrev_b32 v12, 3, v60
    v_cos_f32 v7, v7
    v_lshlrev_b16 v13, 3, v60
    v_mad_i32_i24 v11, v14, s55, v96
    v_bitop3_b32 v12, v6, v13, v12 bitop3:0xca
    v_lshl_add_u32 v11, v11, 17, s40
    v_lshlrev_b16 v14, 8, v14
    v_lshrrev_b32 v13, 2, v60
    v_add_u32 v96, v12, v11
    v_bitop3_b32 v60, v5, v13, v14 bitop3:0xea
    ds_add_u32 v60, v2
    v_mul_hi_u32_u24 v14, 429497, v97
    v_lshrrev_b32 v12, 3, v61
    v_cos_f32 v8, v8
    v_lshlrev_b16 v13, 3, v61
    v_mad_i32_i24 v11, v14, s55, v97
    v_bitop3_b32 v12, v6, v13, v12 bitop3:0xca
    v_lshl_add_u32 v11, v11, 17, s40
    v_lshlrev_b16 v14, 8, v14
    v_lshrrev_b32 v13, 2, v61
    v_add_u32 v97, v12, v11
    v_bitop3_b32 v61, v5, v13, v14 bitop3:0xea
    ds_add_u32 v61, v2
    v_cvt_pk_bf16_f32 v66, v7, v8
    v_perm_b32 v12, v66, v66, s41
    v_bitop3_b32 v96, v4, v12, v96 bitop3:0xca
    v_perm_b32 v13, v66, v66, s42
    v_bitop3_b32 v97, v4, v13, v97 bitop3:0xca
    v_mul_hi_u32_u24 v14, 429497, v98
    v_lshrrev_b32 v12, 3, v62
    v_cos_f32 v9, v9
    v_lshlrev_b16 v13, 3, v62
    v_mad_i32_i24 v11, v14, s55, v98
    v_bitop3_b32 v12, v6, v13, v12 bitop3:0xca
    v_lshl_add_u32 v11, v11, 17, s40
    v_lshlrev_b16 v14, 8, v14
    v_lshrrev_b32 v13, 2, v62
    v_add_u32 v98, v12, v11
    v_bitop3_b32 v62, v5, v13, v14 bitop3:0xea
    ds_add_u32 v62, v2
    v_mul_hi_u32_u24 v14, 429497, v99
    v_lshrrev_b32 v12, 3, v63
    v_cos_f32 v10, v10
    v_lshlrev_b16 v13, 3, v63
    v_mad_i32_i24 v11, v14, s55, v99
    v_bitop3_b32 v12, v6, v13, v12 bitop3:0xca
    v_lshl_add_u32 v11, v11, 17, s40
    v_lshlrev_b16 v14, 8, v14
    v_lshrrev_b32 v13, 2, v63
    v_add_u32 v99, v12, v11
    v_bitop3_b32 v63, v5, v13, v14 bitop3:0xea
    ds_add_u32 v63, v2
    v_cvt_pk_bf16_f32 v67, v9, v10
    v_perm_b32 v12, v67, v67, s41
    v_bitop3_b32 v98, v4, v12, v98 bitop3:0xca
    v_perm_b32 v13, v67, v67, s42
    v_bitop3_b32 v99, v4, v13, v99 bitop3:0xca
L1_s7:
    v_lshrrev_b32 v8, 2, v0
    v_and_b32 v7, 0x3c00, v0
    v_bitop3_b32 v7, v5, v8, v7 bitop3:0xea
    s_waitcnt lgkmcnt(0)
    s_barrier
    ds_read2st64_b32 v[8:9], v7 offset0:0 offset1:1
    ds_read2st64_b32 v[10:11], v7 offset0:2 offset1:3
    s_add_u32 s46, s35, 0x7ec4000
    s_add_u32 s46, s46, s93
    buffer_store_dwordx4 v[28:31], v0, s[20:23], s46 offen sc1
    s_waitcnt lgkmcnt(0)
    v_lshl_or_b32 v12, v9, 16, v8
    v_lshl_or_b32 v13, v11, 16, v10
    v_mov_b32 v14, v12
    v_mov_b32 v15, v13
    s_nop 0
    v_add_u32_dpp v14, v14, v14 row_shr:1 row_mask:0xf bank_mask:0xf bound_ctrl:1
    v_add_u32_dpp v15, v15, v15 row_shr:1 row_mask:0xf bank_mask:0xf bound_ctrl:1
    s_nop 0
    v_add_u32_dpp v14, v14, v14 row_shr:2 row_mask:0xf bank_mask:0xf bound_ctrl:1
    v_add_u32_dpp v15, v15, v15 row_shr:2 row_mask:0xf bank_mask:0xf bound_ctrl:1
    s_nop 0
    v_add_u32_dpp v14, v14, v14 row_shr:4 row_mask:0xf bank_mask:0xf bound_ctrl:1
    v_add_u32_dpp v15, v15, v15 row_shr:4 row_mask:0xf bank_mask:0xf bound_ctrl:1
    s_nop 0
    v_add_u32_dpp v14, v14, v14 row_shr:8 row_mask:0xf bank_mask:0xf bound_ctrl:1
    v_add_u32_dpp v15, v15, v15 row_shr:8 row_mask:0xf bank_mask:0xf bound_ctrl:1
    s_nop 0
    v_add_u32_dpp v14, v14, v14 row_bcast:15 row_mask:0xa bank_mask:0xf
    v_add_u32_dpp v15, v15, v15 row_bcast:15 row_mask:0xa bank_mask:0xf
    s_nop 0
    v_add_u32_dpp v14, v14, v14 row_bcast:31 row_mask:0xc bank_mask:0xf
    v_add_u32_dpp v15, v15, v15 row_bcast:31 row_mask:0xc bank_mask:0xf
    v_readlane_b32 s48, v14, 63
    v_readlane_b32 s49, v15, 63
    s_lshl_b32 s54, s32, 2
    v_mov_b32 v8, s54
    s_and_b32 s50, s48, 0xffff
    s_lshr_b32 s51, s48, 16
    s_and_b32 s52, s49, 0xffff
    s_lshr_b32 s53, s49, 16
    s_add_u32 s51, s51, s50
    s_add_u32 s52, s52, s51
    s_add_u32 s53, s53, s52
    v_mov_b32 v9, s53
    v_and_b32_dpp v3, v3, v3 quad_perm:[1,0,3,2] row_mask:0xf bank_mask:0xf
    s_mov_b64 exec, 1
    ds_write_b32 v8, v9 offset:16384
    ds_write_b32 v8, v3 offset:16448
    s_mov_b64 exec, -1
    v_and_b32 v8, 60, v7
    s_waitcnt lgkmcnt(0)
    s_barrier
    ds_read_b32 v9, v8 offset:16384
    ds_read_b32 v10, v8 offset:16448
    s_waitcnt lgkmcnt(0)
    v_readlane_b32 s56, v10, 15
    s_xor_b32 s56, s56, 0x80
    v_add_u32_dpp v9, v9, v9 row_shr:1 row_mask:0xf bank_mask:0xf bound_ctrl:1
    s_nop 1
    v_add_u32_dpp v9, v9, v9 row_shr:2 row_mask:0xf bank_mask:0xf bound_ctrl:1
    s_nop 1
    v_add_u32_dpp v9, v9, v9 row_shr:4 row_mask:0xf bank_mask:0xf bound_ctrl:1
    s_nop 1
    v_add_u32_dpp v9, v9, v9 row_shr:8 row_mask:0xf bank_mask:0xf bound_ctrl:1
    s_nop 0
    v_readlane_b32 s54, v9, s32
    s_sub_u32 s54, s54, s53
    s_add_u32 s50, s50, s54
    s_add_u32 s51, s51, s54
    s_add_u32 s52, s52, s54
    s_pack_ll_b32_b16 s48, s54, s50
    s_pack_ll_b32_b16 s49, s51, s52
    v_add_u32 v14, s48, v14
    v_add_u32 v15, s49, v15
    v_sub_u32 v12, v14, v12
    v_sub_u32 v13, v15, v13
    v_and_b32 v8, 0xffff, v12
    v_lshrrev_b32 v9, 16, v12
    v_and_b32 v10, 0xffff, v13
    v_lshrrev_b32 v11, 16, v13
    ds_write2st64_b32 v7, v8, v9 offset0:0 offset1:1
    ds_write2st64_b32 v7, v10, v11 offset0:2 offset1:3
    v_and_b32 v8, 0x3f0, v0
    v_lshl_add_u32 v8, v8, 1, s36
    ds_write_b64 v8, v[12:13] offset:20480
    s_bitset0_b64 exec, 63
    s_not_b64 exec, exec
    ds_write_b64 v8, v[14:15] offset:20512
    s_mov_b64 exec, -1
    s_waitcnt lgkmcnt(0)
    s_barrier
    s_setprio 3
    ds_add_rtn_u32 v120, v120, v2
    ds_add_rtn_u32 v121, v121, v2
    ds_add_rtn_u32 v122, v122, v2
    ds_add_rtn_u32 v123, v123, v2
    ds_read_b128 v[12:15], v0 offset:20480
    v_cmp_gt_u32 vcc, 8448, v0
    ds_add_rtn_u32 v124, v124, v2
    ds_add_rtn_u32 v125, v125, v2
    ds_add_rtn_u32 v126, v126, v2
    ds_add_rtn_u32 v127, v127, v2
    s_setprio 2
    ds_add_rtn_u32 v24, v24, v2
    ds_add_rtn_u32 v25, v25, v2
    ds_add_rtn_u32 v26, v26, v2
    ds_add_rtn_u32 v27, v27, v2
    s_waitcnt lgkmcnt(8)
    s_cbranch_vccz L1_p8
    s_add_u32 s47, s35, 0xa900000
    s_mov_b64 exec, vcc
    buffer_store_dwordx4 v[12:15], v0, s[24:27], s47 offen sc1
    s_mov_b64 exec, -1
L1_p8:
    s_add_u32 s44, s35, 0x7ec8000
    s_add_u32 s44, s44, s72
    buffer_store_dwordx4 v[112:115], v0, s[20:23], s44 offen sc1
    ds_add_rtn_u32 v52, v52, v2
    ds_add_rtn_u32 v53, v53, v2
    ds_add_rtn_u32 v54, v54, v2
    ds_add_rtn_u32 v55, v55, v2
    s_load_dwordx2 s[28:29], s[0:1], 0
    s_load_dwordx2 s[50:51], s[0:1], 40
    s_load_dwordx2 s[52:53], s[0:1], 24
    s_setprio 1
    ds_add_rtn_u32 v68, v68, v2
    ds_add_rtn_u32 v69, v69, v2
    ds_add_rtn_u32 v70, v70, v2
    ds_add_rtn_u32 v71, v71, v2
    s_cmp_le_u32 s43, 5
    s_cbranch_scc1 L1_s9
    ds_add_rtn_u32 v76, v76, v2
    ds_add_rtn_u32 v77, v77, v2
    ds_add_rtn_u32 v78, v78, v2
    ds_add_rtn_u32 v79, v79, v2
L1_s9:
    s_add_u32 s45, s35, 0x7ec8000
    s_add_u32 s45, s45, s73
    buffer_store_dwordx4 v[88:91], v0, s[20:23], s45 offen sc1
    s_setprio 0
    s_cmp_le_u32 s43, 6
    s_cbranch_scc1 L1_s10
    ds_add_rtn_u32 v56, v56, v2
    ds_add_rtn_u32 v57, v57, v2
    ds_add_rtn_u32 v58, v58, v2
    ds_add_rtn_u32 v59, v59, v2
L1_s10:
    s_cmp_le_u32 s43, 7
    s_cbranch_scc1 L1_s11
    ds_add_rtn_u32 v60, v60, v2
    ds_add_rtn_u32 v61, v61, v2
    ds_add_rtn_u32 v62, v62, v2
    ds_add_rtn_u32 v63, v63, v2
L1_s11:
    s_waitcnt lgkmcnt(0)
    s_barrier
    s_load_dwordx4 s[96:99], s[50:51], 0
    s_mov_b64 s[4:5], s[52:53]
    s_bfe_u32 s33, s2, 0x20001
    s_and_b32 s34, s2, 1
    s_lshl_b32 s34, s34, 5
    s_lshr_b32 s3, s2, 3
    s_add_u32 s34, s34, s3
    s_mul_i32 s39, s33, 2080
    s_lshl_b32 s3, s34, 5
    s_add_u32 s39, s39, s3
    s_mul_i32 s40, s33, 1310720
    s_add_u32 s40, s40, 0x50000
    s_lshl_b32 s38, s32, 11
    s_mul_i32 s100, s32, 3072
    s_add_u32 s8, s30, 0x4000
    s_addc_u32 s9, s31, 0
    s_mov_b32 s10, 0xd340000
    s_mov_b32 s11, 0x20000
    s_add_u32 s12, s30, 0x2c000
    s_addc_u32 s13, s31, 0
    s_mov_b32 s14, 0xd318000
    s_mov_b32 s15, 0x20000
    s_mov_b32 s16, s64
    s_mov_b32 s17, s65
    s_mov_b32 s18, 0x20
    s_mov_b32 s19, 0x20000
    s_mov_b32 s24, s28
    s_mov_b32 s25, s29
    s_mov_b32 s26, 0x4e2000
    s_mov_b32 s27, 0x20000
    s_setprio 3
    v_and_b32 v7, -4, v120
    v_lshl_add_u32 v8, v120, 2, v7
    ds_write_b32 v8, v16
    v_lshl_add_u32 v7, v7, 2, v120
    ds_write_b8 v7, v44 offset:16
    v_and_b32 v9, -4, v121
    v_lshl_add_u32 v10, v121, 2, v9
    ds_write_b32 v10, v17
    v_lshl_add_u32 v9, v9, 2, v121
    ds_write_b8_d16_hi v9, v44 offset:16
    v_and_b32 v7, -4, v122
    v_lshl_add_u32 v8, v122, 2, v7
    ds_write_b32 v8, v18
    v_lshl_add_u32 v7, v7, 2, v122
    ds_write_b8 v7, v45 offset:16
    v_and_b32 v9, -4, v123
    v_lshl_add_u32 v10, v123, 2, v9
    ds_write_b32 v10, v19
    v_lshl_add_u32 v9, v9, 2, v123
    ds_write_b8_d16_hi v9, v45 offset:16
    s_add_u32 s46, s35, 0x7ec8000
    s_add_u32 s46, s46, s85
    buffer_store_dwordx4 v[116:119], v0, s[20:23], s46 offen sc1
    v_and_b32 v13, 0x3f0, v0
    v_and_b32 v14, 0x300, v13
    v_bfe_u32 v15, v13, 4, 4
    s_lshl_b32 s3, s32, 4
    v_add3_u32 v14, v14, v15, s3
    v_mul_u32_u24 v2, 173056, v14
    v_lshrrev_b32 v14, 6, v13
    s_add_u32 s3, s3, 0x400
    v_add_u32 v14, s3, v14
    v_mul_u32_u24 v4, 173056, v14
    v_and_b32 v14, 3, v14
    v_and_b32 v15, 0x30, v13
    v_lshl_add_u32 v14, v14, 5, v15
    v_add_u32 v6, v14, v4
    v_lshl_add_u32 v5, v15, 1, v2
    v_lshrrev_b32 v14, 3, v15
    buffer_load_ushort v100, v14, s[16:19], 0 offen offset:0
    buffer_load_ushort v101, v14, s[16:19], 0 offen offset:8
    buffer_load_ushort v102, v14, s[16:19], 0 offen offset:16
    buffer_load_ushort v103, v14, s[16:19], 0 offen offset:24
    s_mul_i32 s3, s32, 5120
    v_add_u32 v3, s3, v13
    v_lshrrev_b32 v14, 2, v13
    v_add_u32 v14, s38, v14
    v_and_b32 v7, -4, v124
    v_lshl_add_u32 v8, v124, 2, v7
    ds_write_b32 v8, v20
    v_lshl_add_u32 v7, v7, 2, v124
    ds_write_b8 v7, v46 offset:16
    v_and_b32 v9, -4, v125
    v_lshl_add_u32 v10, v125, 2, v9
    ds_write_b32 v10, v21
    v_lshl_add_u32 v9, v9, 2, v125
    ds_write_b8_d16_hi v9, v46 offset:16
    v_and_b32 v7, -4, v126
    v_lshl_add_u32 v8, v126, 2, v7
    ds_write_b32 v8, v22
    v_lshl_add_u32 v7, v7, 2, v126
    ds_write_b8 v7, v47 offset:16
    v_and_b32 v9, -4, v127
    v_lshl_add_u32 v10, v127, 2, v9
    ds_write_b32 v10, v23
    v_lshl_add_u32 v9, v9, 2, v127
    ds_write_b8_d16_hi v9, v47 offset:16
    v_lshrrev_b32 v11, 2, v0
    v_and_b32 v11, 0xfc, v11
    s_cmp_ge_u32 s84, 128
    s_cselect_b32 s82, 0, s82
    s_and_b32 s3, s84, 1
    s_mul_i32 s3, s3, 40
    s_add_u32 s3, s3, s32
    s_mul_i32 s74, s3, 205
    s_lshr_b32 s74, s74, 10
    s_mul_i32 s75, s74, 5
    s_sub_u32 s75, s3, s75
    s_lshl_b32 s48, s74, 1
    s_add_u32 s48, s48, s75
    s_add_u32 s49, s48, s74
    s_add_u32 s49, s49, 30
    s_cmp_lt_u32 s75, 2
    s_cselect_b32 s48, s48, s49
    s_lshl_b32 s48, s48, 10
    s_lshr_b32 s49, s84, 1
    s_mul_i32 s49, s49, 80000
    s_add_u32 s48, s48, s49
    buffer_load_dword v104, v11, s[80:83], s48 offen offset:0
    buffer_load_dword v105, v11, s[80:83], s48 offen offset:256
    buffer_load_dword v106, v11, s[80:83], s48 offen offset:512
    buffer_load_dword v107, v11, s[80:83], s48 offen offset:768
    s_and_b32 s3, s84, 1
    s_mul_i32 s3, s3, 40
    s_add_u32 s3, s3, s32
    s_add_u32 s3, s3, 16
    s_mul_i32 s74, s3, 205
    s_lshr_b32 s74, s74, 10
    s_mul_i32 s75, s74, 5
    s_sub_u32 s75, s3, s75
    s_lshl_b32 s48, s74, 1
    s_add_u32 s48, s48, s75
    s_add_u32 s49, s48, s74
    s_add_u32 s49, s49, 30
    s_cmp_lt_u32 s75, 2
    s_cselect_b32 s48, s48, s49
    s_lshl_b32 s48, s48, 10
    s_lshr_b32 s49, s84, 1
    s_mul_i32 s49, s49, 80000
    s_add_u32 s48, s48, s49
    buffer_load_dword v28, v11, s[80:83], s48 offen offset:0
    buffer_load_dword v29, v11, s[80:83], s48 offen offset:256
    buffer_load_dword v30, v11, s[80:83], s48 offen offset:512
    buffer_load_dword v31, v11, s[80:83], s48 offen offset:768
    s_and_b32 s3, s84, 1
    s_mul_i32 s3, s3, 40
    s_add_u32 s3, s3, s32
    s_add_u32 s3, s3, 32
    s_cmp_ge_u32 s32, 8
    s_cselect_b32 s82, 0, s82
    s_mul_i32 s74, s3, 205
    s_lshr_b32 s74, s74, 10
    s_mul_i32 s75, s74, 5
    s_sub_u32 s75, s3, s75
    s_lshl_b32 s48, s74, 1
    s_add_u32 s48, s48, s75
    s_add_u32 s49, s48, s74
    s_add_u32 s49, s49, 30
    s_cmp_lt_u32 s75, 2
    s_cselect_b32 s48, s48, s49
    s_lshl_b32 s48, s48, 10
    s_lshr_b32 s49, s84, 1
    s_mul_i32 s49, s49, 80000
    s_add_u32 s48, s48, s49
    buffer_load_dword v112, v11, s[80:83], s48 offen offset:0
    buffer_load_dword v113, v11, s[80:83], s48 offen offset:256
    buffer_load_dword v114, v11, s[80:83], s48 offen offset:512
    buffer_load_dword v115, v11, s[80:83], s48 offen offset:768
    s_setprio 2
    v_and_b32 v7, -4, v24
    v_lshl_add_u32 v8, v24, 2, v7
    ds_write_b32 v8, v40
    v_lshl_add_u32 v7, v7, 2, v24
    ds_write_b8 v7, v32 offset:16
    v_and_b32 v9, -4, v25
    v_lshl_add_u32 v10, v25, 2, v9
    ds_write_b32 v10, v41
    v_lshl_add_u32 v9, v9, 2, v25
    ds_write_b8_d16_hi v9, v32 offset:16
    v_and_b32 v7, -4, v26
    v_lshl_add_u32 v8, v26, 2, v7
    ds_write_b32 v8, v42
    v_lshl_add_u32 v7, v7, 2, v26
    ds_write_b8 v7, v33 offset:16
    v_and_b32 v9, -4, v27
    v_lshl_add_u32 v10, v27, 2, v9
    ds_write_b32 v10, v43
    v_lshl_add_u32 v9, v9, 2, v27
    ds_write_b8_d16_hi v9, v33 offset:16
    s_add_u32 s47, s35, 0x7ec8000
    s_add_u32 s47, s47, s91
    buffer_store_dwordx4 v[92:95], v0, s[20:23], s47 offen sc1
    v_and_b32 v7, -4, v52
    v_lshl_add_u32 v8, v52, 2, v7
    ds_write_b32 v8, v48
    v_lshl_add_u32 v7, v7, 2, v52
    ds_write_b8 v7, v34 offset:16
    v_and_b32 v9, -4, v53
    v_lshl_add_u32 v10, v53, 2, v9
    ds_write_b32 v10, v49
    v_lshl_add_u32 v9, v9, 2, v53
    ds_write_b8_d16_hi v9, v34 offset:16
    v_and_b32 v7, -4, v54
    v_lshl_add_u32 v8, v54, 2, v7
    ds_write_b32 v8, v50
    v_lshl_add_u32 v7, v7, 2, v54
    ds_write_b8 v7, v35 offset:16
    v_and_b32 v9, -4, v55
    v_lshl_add_u32 v10, v55, 2, v9
    ds_write_b32 v10, v51
    v_lshl_add_u32 v9, v9, 2, v55
    ds_write_b8_d16_hi v9, v35 offset:16
    s_setprio 1
    v_and_b32 v7, -4, v68
    v_lshl_add_u32 v8, v68, 2, v7
    ds_write_b32 v8, v84
    v_lshl_add_u32 v7, v7, 2, v68
    ds_write_b8 v7, v72 offset:16
    v_and_b32 v9, -4, v69
    v_lshl_add_u32 v10, v69, 2, v9
    ds_write_b32 v10, v85
    v_lshl_add_u32 v9, v9, 2, v69
    ds_write_b8_d16_hi v9, v72 offset:16
    v_and_b32 v7, -4, v70
    v_lshl_add_u32 v8, v70, 2, v7
    ds_write_b32 v8, v86
    v_lshl_add_u32 v7, v7, 2, v70
    ds_write_b8 v7, v73 offset:16
    v_and_b32 v9, -4, v71
    v_lshl_add_u32 v10, v71, 2, v9
    ds_write_b32 v10, v87
    v_lshl_add_u32 v9, v9, 2, v71
    ds_write_b8_d16_hi v9, v73 offset:16
    s_cmp_le_u32 s43, 5
    s_cbranch_scc1 L1_s12
    v_and_b32 v7, -4, v76
    v_lshl_add_u32 v8, v76, 2, v7
    ds_write_b32 v8, v36
    v_lshl_add_u32 v7, v7, 2, v76
    ds_write_b8 v7, v74 offset:16
    v_and_b32 v9, -4, v77
    v_lshl_add_u32 v10, v77, 2, v9
    ds_write_b32 v10, v37
    v_lshl_add_u32 v9, v9, 2, v77
    ds_write_b8_d16_hi v9, v74 offset:16
    v_and_b32 v7, -4, v78
    v_lshl_add_u32 v8, v78, 2, v7
    ds_write_b32 v8, v38
    v_lshl_add_u32 v7, v7, 2, v78
    ds_write_b8 v7, v75 offset:16
    v_and_b32 v9, -4, v79
    v_lshl_add_u32 v10, v79, 2, v9
    ds_write_b32 v10, v39
    v_lshl_add_u32 v9, v9, 2, v79
    ds_write_b8_d16_hi v9, v75 offset:16
L1_s12:
    s_add_u32 s44, s35, 0x7ec8000
    s_add_u32 s44, s44, s93
    buffer_store_dwordx4 v[108:111], v0, s[20:23], s44 offen sc1
    s_setprio 0
    s_cmp_le_u32 s43, 6
    s_cbranch_scc1 L1_s13
    v_and_b32 v7, -4, v56
    v_lshl_add_u32 v8, v56, 2, v7
    ds_write_b32 v8, v80
    v_lshl_add_u32 v7, v7, 2, v56
    ds_write_b8 v7, v64 offset:16
    v_and_b32 v9, -4, v57
    v_lshl_add_u32 v10, v57, 2, v9
    ds_write_b32 v10, v81
    v_lshl_add_u32 v9, v9, 2, v57
    ds_write_b8_d16_hi v9, v64 offset:16
    v_and_b32 v7, -4, v58
    v_lshl_add_u32 v8, v58, 2, v7
    ds_write_b32 v8, v82
    v_lshl_add_u32 v7, v7, 2, v58
    ds_write_b8 v7, v65 offset:16
    v_and_b32 v9, -4, v59
    v_lshl_add_u32 v10, v59, 2, v9
    ds_write_b32 v10, v83
    v_lshl_add_u32 v9, v9, 2, v59
    ds_write_b8_d16_hi v9, v65 offset:16
L1_s13:
    s_add_u32 s80, s30, 0xd344000
    s_addc_u32 s81, s31, 0
    s_mov_b32 s82, 0xa000
    s_mov_b32 s83, 0x20000
    s_min_u32 s3, s84, 127
    s_mul_i32 s3, s3, 40960
    s_add_u32 s80, s80, s3
    s_addc_u32 s81, s81, 0
    s_cmp_ge_u32 s84, 128
    s_cselect_b32 s82, 0, s82
    s_waitcnt vmcnt(2)
    v_add_u32 v11, 0, v0
    buffer_store_dwordx4 v[104:107], v11, s[80:83], 0 offen sc1
    v_add_u32 v11, 16384, v0
    buffer_store_dwordx4 v[28:31], v11, s[80:83], 0 offen sc1
    v_add_u32 v11, 32768, v0
    buffer_store_dwordx4 v[112:115], v11, s[80:83], 0 offen sc1
    s_cmp_le_u32 s43, 7
    s_cbranch_scc1 L1_s14
    v_and_b32 v7, -4, v60
    v_lshl_add_u32 v8, v60, 2, v7
    ds_write_b32 v8, v96
    v_lshl_add_u32 v7, v7, 2, v60
    ds_write_b8 v7, v66 offset:16
    v_and_b32 v9, -4, v61
    v_lshl_add_u32 v10, v61, 2, v9
    ds_write_b32 v10, v97
    v_lshl_add_u32 v9, v9, 2, v61
    ds_write_b8_d16_hi v9, v66 offset:16
    v_and_b32 v7, -4, v62
    v_lshl_add_u32 v8, v62, 2, v7
    ds_write_b32 v8, v98
    v_lshl_add_u32 v7, v7, 2, v62
    ds_write_b8 v7, v67 offset:16
    v_and_b32 v9, -4, v63
    v_lshl_add_u32 v10, v63, 2, v9
    ds_write_b32 v10, v99
    v_lshl_add_u32 v9, v9, 2, v63
    ds_write_b8_d16_hi v9, v67 offset:16
L1_s14:
    v_add_u32 v7, 0x10000, v0
    v_add_u32 v12, 0x20000, v0
    s_waitcnt lgkmcnt(0)
    s_barrier
    ds_read_b128 v[24:27], v0 offset:0
    ds_read_b128 v[28:31], v0 offset:16384
    ds_read_b128 v[32:35], v0 offset:32768
    ds_read_b128 v[36:39], v0 offset:49152
    ds_read_b128 v[76:79], v7 offset:0
    ds_read_b128 v[80:83], v7 offset:16384
    ds_read_b128 v[84:87], v7 offset:32768
    ds_read_b128 v[104:107], v7 offset:49152
    ds_read_b128 v[68:71], v12 offset:0
    ds_read_b128 v[72:75], v12 offset:16384
    s_cmp_lg_u32 s32, 0
    s_cbranch_scc1 L2_sg1
    s_mov_b32 exec_hi, 0
    v_mov_b32 v11, 1
    buffer_store_dword v11, v14, s[60:63], s57 offen sc1
    s_mov_b64 exec, -1
L2_sg1:
    s_waitcnt lgkmcnt(9)
    s_add_u32 s45, s35, 0xa904000
    buffer_store_dwordx4 v[24:27], v0, s[20:23], s45 offen sc1
    s_waitcnt lgkmcnt(8)
    s_add_u32 s46, s35, 0xa908000
    buffer_store_dwordx4 v[28:31], v0, s[20:23], s46 offen sc1
    s_waitcnt lgkmcnt(7)
    s_add_u32 s47, s35, 0xa90c000
    buffer_store_dwordx4 v[32:35], v0, s[20:23], s47 offen sc1
    s_waitcnt lgkmcnt(6)
    s_add_u32 s44, s35, 0xa910000
    buffer_store_dwordx4 v[36:39], v0, s[20:23], s44 offen sc1
    s_waitcnt lgkmcnt(5)
    s_add_u32 s45, s35, 0xa914000
    buffer_store_dwordx4 v[76:79], v0, s[20:23], s45 offen sc1
    s_waitcnt lgkmcnt(4)
    s_add_u32 s46, s35, 0xa918000
    buffer_store_dwordx4 v[80:83], v0, s[20:23], s46 offen sc1
    s_waitcnt lgkmcnt(3)
    s_add_u32 s47, s35, 0xa91c000
    buffer_store_dwordx4 v[84:87], v0, s[20:23], s47 offen sc1
    s_waitcnt lgkmcnt(2)
    s_cmp_le_u32 s43, 5
    s_cbranch_scc1 L1_q15
    s_add_u32 s44, s35, 0xa920000
    buffer_store_dwordx4 v[104:107], v0, s[20:23], s44 offen sc1
L1_q15:
    s_waitcnt lgkmcnt(1)
    s_cmp_le_u32 s43, 6
    s_cbranch_scc1 L1_q16
    s_add_u32 s45, s35, 0xa924000
    buffer_store_dwordx4 v[68:71], v0, s[20:23], s45 offen sc1
L1_q16:
    s_waitcnt lgkmcnt(0)
    s_cmp_le_u32 s43, 7
    s_cbranch_scc1 L1_q17
    s_add_u32 s46, s35, 0xa928000
    buffer_store_dwordx4 v[72:75], v0, s[20:23], s46 offen sc1
L1_q17:
    s_waitcnt lgkmcnt(0)
    s_setprio 3
    v_mov_b32 v92, v0
    v_mov_b32 v93, v6
    v_mov_b32 v94, v13
    v_mov_b32 v95, v5
    v_mov_b32 v0, v14
    v_lshl_add_u32 v7, v13, 3, s38
    v_lshrrev_b32 v16, 2, v15
    v_mad_u32_u24 v4, v16, 5, v4
    v_or_b32 v4, 0xf0000000, v4
    v_or_b32 v2, 0xf0000000, v2
    v_sub_u32 v1, 28, v16
    v_lshrrev_b32 v17, 2, v16
    v_and_b32 v18, 3, v17
    v_lshlrev_b32 v18, 4, v18
    v_mov_b32 v10, 0x3f80
    v_mov_b32 v11, 0
    v_lshlrev_b64 v[10:11], v18, v[10:11]
    v_and_b32 v18, 3, v17
    v_lshlrev_b32 v18, 4, v18
    v_mov_b32 v12, 0xbf80
    v_mov_b32 v13, 0
    v_lshlrev_b64 v[12:13], v18, v[12:13]
    v_mov_b32 v45, 0xf0000000
    v_mov_b32 v5, 0x1fff8
    v_mov_b32 v6, 0x07ff0000
    v_mov_b32 v16, 0
    v_mov_b32 v17, 0
    v_mov_b32 v18, 0
    v_mov_b32 v19, 0
    v_add_u32 v20, 81920, v92
    v_add_u32 v21, 0x10000, v20
    s_setprio 1
    s_setprio 0
    s_mov_b32 s44, 0x4000c0c
    s_mov_b32 s45, 0x4010c0c
    s_mov_b32 s46, 0x4020c0c
    s_mov_b32 s47, 0x4030c0c
    s_mov_b32 s36, 0
    s_mov_b32 s43, 0
    s_mov_b32 s42, 0
    s_mov_b64 s[80:81], 0
    s_mov_b64 s[48:49], 0
    s_add_u32 s16, s30, 0xd344000
    s_addc_u32 s17, s31, 0
    s_mov_b32 s18, 0x500000
    s_mov_b32 s19, 0x20000
    v_mov_b32 v68, 0
    v_mov_b32 v69, 0
    v_mov_b32 v70, 0
    v_mov_b32 v71, 0
    v_mov_b32 v72, 0
    v_mov_b32 v73, 0
    v_mov_b32 v74, 0
    v_mov_b32 v75, 0
    s_waitcnt vmcnt(0)
    v_lshl_or_b32 v8, v101, 16, v100
    v_lshl_or_b32 v9, v103, 16, v102
    s_barrier
    s_cmp_lg_u32 s32, 0
    s_cbranch_scc1 L2_sg2
    s_mov_b32 exec_hi, 0
    v_mov_b32 v88, 2
    buffer_store_dword v88, v0, s[60:63], s57 offen sc1
    s_mov_b64 exec, -1
L2_sg2:
    s_mov_b64 s[84:85], 0
    s_mul_i32 s3, s33, 1280000
    s_add_u32 s3, s3, s100
    s_add_u32 s3, s3, 32768
    buffer_load_dwordx4 v[124:127], v94, s[24:27], s3 offen offset:2048
    s_mul_i32 s3, s33, 1280000
    s_add_u32 s3, s3, s100
    s_add_u32 s3, s3, 32768
    buffer_load_dwordx4 v[116:119], v94, s[24:27], s3 offen offset:0
    s_mul_i32 s3, s33, 1280000
    s_add_u32 s3, s3, s100
    s_add_u32 s3, s3, 32768
    buffer_load_dwordx4 v[120:123], v94, s[24:27], s3 offen offset:1024
    s_mul_i32 s3, s33, 1280000
    s_add_u32 s3, s3, s38
    s_add_u32 s3, s3, 0
    buffer_load_dwordx4 v[108:111], v94, s[24:27], s3 offen offset:0
    s_mul_i32 s3, s33, 1280000
    s_add_u32 s3, s3, s38
    s_add_u32 s3, s3, 0
    buffer_load_dwordx4 v[112:115], v94, s[24:27], s3 offen offset:1024
    ds_write_b128 v20, v[16:19] offset:0
    ds_write_b128 v20, v[16:19] offset:16384
    ds_write_b128 v20, v[16:19] offset:32768
    ds_write_b128 v20, v[16:19] offset:49152
    ds_write_b128 v21, v[16:19]
    s_cmp_eq_u32 s56, 0
    s_cbranch_scc1 L2_e3
    v_lshlrev_b32 v16, 3, v94
    v_and_b32 v16, 0x80, v16
L2_e4:
    buffer_load_dword v88, v16, s[68:71], 0 offen sc1
    s_waitcnt vmcnt(0)
    v_cmp_gt_u32 vcc, 0x80, v88
    s_cbranch_vccnz L2_e4
L2_e3:
    s_mov_b64 exec, 0xffff
L2_p1:
    buffer_load_dword v88, v7, s[60:63], 0 offen sc1
    s_waitcnt vmcnt(0)
    v_cmpx_gt_u32 vcc, 1, v88
    s_cbranch_vccnz L2_p1s
    s_mov_b64 exec, -1
    v_cmp_gt_u32 vcc, 2, v88
    s_and_b32 s56, vcc_lo, 0xffff
    buffer_load_dwordx4 v[48:51], v95, s[12:15], s39 offen offset:0
    buffer_load_dwordx4 v[56:59], v95, s[12:15], s39 offen offset:32
    buffer_load_dwordx4 v[52:55], v95, s[12:15], s39 offen offset:16
    buffer_load_dwordx4 v[60:63], v95, s[12:15], s39 offen offset:48
    buffer_load_dwordx4 v[64:67], v93, s[12:15], s39 offen
    s_waitcnt vmcnt(0)
    v_sub_u16 v88, v56, v48
    v_and_b32 v89, 3, v48
    v_add3_u32 v99, v88, v89, 3
    v_and_b32 v99, -4, v99
    v_max_u32 v99, 4, v99
    v_and_b32 v97, 0xfffc, v48
    v_bfm_b32 v96, v88, v89
    v_add_u32_dpp v91, v99, v99 row_shr:1 row_mask:0xf bank_mask:0xf bound_ctrl:1
    v_mad_u32_u24 v97, v97, 5, v2
    v_cmp_lt_u32 vcc, 16, v99
    v_add_u32_dpp v91, v91, v91 row_shr:2 row_mask:0xf bank_mask:0xf bound_ctrl:1
    v_sub_u32 v98, s38, v99
    v_lshrrev_b64 v[48:49], 16, v[48:49]
    v_add_u32_dpp v91, v91, v91 row_shr:4 row_mask:0xf bank_mask:0xf bound_ctrl:1
    v_lshrrev_b64 v[56:57], 16, v[56:57]
    s_mov_b32 s101, 0
    v_add_u32_dpp v91, v91, v91 row_shr:8 row_mask:0xf bank_mask:0xf bound_ctrl:1
    s_nop 1
    v_add_u32_dpp v91, v91, v91 row_bcast:15 row_mask:0xa bank_mask:0xf
    s_nop 1
    v_add_u32_dpp v91, v91, v91 row_bcast:31 row_mask:0xc bank_mask:0xf
    v_add_u32 v98, v98, v91
    v_readlane_b32 s37, v91, 63
    s_cbranch_vccnz L2_xo3
L2_xp3:
    v_mov_b32 v44, v43
    s_cmp_gt_u32 s37, 1024
    s_cbranch_scc1 L2_xs4
    s_cmp_lg_u32 s101, 0
    s_cbranch_scc1 L2_xa4
L2_xb4:
    v_lshlrev_b32 v89, 16, v96
    v_add_u32 v90, 60, v97
    v_bitop3_b32 v90, v89, v45, v90 bitop3:0x6a
    ds_write_b32 v98, v90 offset:12
    v_lshlrev_b32 v89, 20, v96
    v_add_u32 v90, 40, v97
    v_bitop3_b32 v90, v89, v45, v90 bitop3:0x6a
    ds_write_b32 v98, v90 offset:8
    v_lshlrev_b32 v89, 24, v96
    v_add_u32 v90, 20, v97
    v_bitop3_b32 v90, v89, v45, v90 bitop3:0x6a
    ds_write_b32 v98, v90 offset:4
    v_lshlrev_b32 v89, 28, v96
    v_bitop3_b32 v90, v89, v45, v97 bitop3:0x6a
    ds_write_b32 v98, v90 offset:0
    v_mov_b32_dpp v91, v64 quad_perm:[0,0,0,0] row_mask:0xf bank_mask:0xf
    v_and_b32 v89, 3, v91
    v_and_b32 v97, 0xfffc, v91
    v_sub_u16_dpp v88, v64, v91 quad_perm:[2,2,2,2] row_mask:0xf bank_mask:0xf
    v_mad_u32_u24 v97, v97, 5, v4
    v_add_u32 v99, v88, v89
    v_bfm_b32 v96, v88, v89
    v_cmp_lt_u32 s[58:59], 16, v99
    v_lshlrev_b32 v89, v1, v96
    v_and_b32 v89, v45, v89
    v_cmp_ne_u32 vcc, 0, v89
    v_xor_b32 v90, v97, v89
    s_add_u32 s3, s37, s38
    v_mbcnt_lo_u32_b32 v98, vcc_lo, 0
    v_mbcnt_hi_u32_b32 v98, vcc_hi, v98
    s_bcnt1_i32_b64 s41, vcc
    v_lshl_add_u32 v98, v98, 2, s3
    s_mov_b64 exec, vcc
    ds_write_b32 v98, v90
    s_mov_b64 exec, -1
    s_lshl2_add_u32 s37, s41, s37
    s_cmp_lg_u64 s[58:59], 0
    s_cbranch_scc1 L2_xe4
L2_xr4:
    v_add_u32 v98, s37, v0
    v_mov_b32 v90, -1
    ds_write_b32 v98, v90
    ds_read2st64_b32 v[40:41], v0 offset0:0 offset1:1
    ds_read2st64_b32 v[42:43], v0 offset0:2 offset1:3
    s_sub_u32 s3, s37, 768
    s_cmp_gt_u32 s3, 256
    s_cbranch_scc1 L2_xf4
L2_xg4:
    v_sub_u16 v88, v58, v50
    v_and_b32 v89, 3, v50
    v_add3_u32 v99, v88, v89, 3
    v_and_b32 v99, -4, v99
    v_max_u32 v99, 4, v99
    v_and_b32 v97, 0xfffc, v50
    v_bfm_b32 v96, v88, v89
    v_add_u32_dpp v91, v99, v99 row_shr:1 row_mask:0xf bank_mask:0xf bound_ctrl:1
    v_mad_u32_u24 v97, v97, 5, v2
    v_cmp_lt_u32 vcc, 16, v99
    v_add_u32_dpp v91, v91, v91 row_shr:2 row_mask:0xf bank_mask:0xf bound_ctrl:1
    v_sub_u32 v98, s38, v99
    v_lshrrev_b64 v[50:51], 16, v[50:51]
    v_add_u32_dpp v91, v91, v91 row_shr:4 row_mask:0xf bank_mask:0xf bound_ctrl:1
    v_lshrrev_b64 v[58:59], 16, v[58:59]
    s_mov_b32 s101, 0
    v_add_u32_dpp v91, v91, v91 row_shr:8 row_mask:0xf bank_mask:0xf bound_ctrl:1
    s_nop 1
    v_add_u32_dpp v91, v91, v91 row_bcast:15 row_mask:0xa bank_mask:0xf
    s_nop 1
    v_add_u32_dpp v91, v91, v91 row_bcast:31 row_mask:0xc bank_mask:0xf
    v_add_u32 v98, v98, v91
    v_readlane_b32 s37, v91, 63
    s_cbranch_vccnz L2_xo5
L2_xp5:
    s_waitcnt lgkmcnt(0)
    v_mov_b32 v21, v40
    v_mov_b32 v27, v41
    v_mov_b32 v33, v42
    v_mov_b32 v39, v43
    v_mov_b32 v44, v43
    s_cmp_gt_u32 s37, 1024
    s_cbranch_scc1 L2_xs6
    s_cmp_lg_u32 s101, 0
    s_cbranch_scc1 L2_xa6
L2_xb6:
    v_lshlrev_b32 v89, 16, v96
    v_add_u32 v90, 60, v97
    v_bitop3_b32 v90, v89, v45, v90 bitop3:0x6a
    ds_write_b32 v98, v90 offset:12
    v_lshlrev_b32 v89, 20, v96
    v_add_u32 v90, 40, v97
    v_bitop3_b32 v90, v89, v45, v90 bitop3:0x6a
    ds_write_b32 v98, v90 offset:8
    v_lshlrev_b32 v89, 24, v96
    v_add_u32 v90, 20, v97
    v_bitop3_b32 v90, v89, v45, v90 bitop3:0x6a
    ds_write_b32 v98, v90 offset:4
    v_lshlrev_b32 v89, 28, v96
    v_bitop3_b32 v90, v89, v45, v97 bitop3:0x6a
    ds_write_b32 v98, v90 offset:0
    v_mov_b32_dpp v91, v66 quad_perm:[0,0,0,0] row_mask:0xf bank_mask:0xf
    v_and_b32 v89, 3, v91
    v_and_b32 v97, 0xfffc, v91
    v_sub_u16_dpp v88, v66, v91 quad_perm:[2,2,2,2] row_mask:0xf bank_mask:0xf
    v_mad_u32_u24 v97, v97, 5, v4
    v_add_u32 v99, v88, v89
    v_bfm_b32 v96, v88, v89
    v_cmp_lt_u32 s[58:59], 16, v99
    v_lshlrev_b32 v89, v1, v96
    v_and_b32 v89, v45, v89
    v_cmp_ne_u32 vcc, 0, v89
    v_xor_b32 v90, v97, v89
    s_add_u32 s3, s37, s38
    v_mbcnt_lo_u32_b32 v98, vcc_lo, 0
    v_mbcnt_hi_u32_b32 v98, vcc_hi, v98
    s_bcnt1_i32_b64 s41, vcc
    v_lshl_add_u32 v98, v98, 2, s3
    s_mov_b64 exec, vcc
    ds_write_b32 v98, v90
    s_mov_b64 exec, -1
    s_lshl2_add_u32 s37, s41, s37
    s_cmp_lg_u64 s[58:59], 0
    s_cbranch_scc1 L2_xe6
L2_xr6:
    v_add_u32 v98, s37, v0
    v_mov_b32 v90, -1
    ds_write_b32 v98, v90
    ds_read2st64_b32 v[40:41], v0 offset0:0 offset1:1
    ds_read2st64_b32 v[42:43], v0 offset0:2 offset1:3
    s_sub_u32 s3, s37, 768
    s_cmp_gt_u32 s3, 256
    s_cbranch_scc1 L2_xf6
L2_xg6:
    v_subrev_u32 v88, s38, v3
    ds_write_b128 v88, v[124:127] offset:34816
    v_subrev_u32 v88, s38, v3
    ds_write_b128 v88, v[116:119] offset:32768
    v_subrev_u32 v88, s38, v3
    ds_write_b128 v88, v[120:123] offset:33792
    v_subrev_u32 v88, s100, v3
    ds_write_b128 v88, v[108:111] offset:0
    v_subrev_u32 v88, s100, v3
    ds_write_b128 v88, v[112:115] offset:1024
    s_cmp_eq_u32 s56, 0
    s_cbranch_scc1 L2_e2
    s_mov_b32 exec_lo, s56
    s_mov_b32 exec_hi, 0
    buffer_load_dword v88, v7, s[60:63], 0 offen sc1
    s_mov_b64 exec, -1
    s_waitcnt vmcnt(0)
    v_cmp_gt_u32 vcc, 2, v88
    s_and_b32 s56, vcc_lo, s56
    s_cbranch_scc0 L2_e2
    s_mul_i32 s3, s33, 1280000
    s_add_u32 s3, s3, s100
    s_add_u32 s3, s3, 352768
    buffer_load_dwordx4 v[124:127], v94, s[24:27], s3 offen offset:2048
    s_mul_i32 s3, s33, 1280000
    s_add_u32 s3, s3, s100
    s_add_u32 s3, s3, 352768
    buffer_load_dwordx4 v[116:119], v94, s[24:27], s3 offen offset:0
    s_mul_i32 s3, s33, 1280000
    s_add_u32 s3, s3, s100
    s_add_u32 s3, s3, 352768
    buffer_load_dwordx4 v[120:123], v94, s[24:27], s3 offen offset:1024
    s_mul_i32 s3, s33, 1280000
    s_add_u32 s3, s3, s38
    s_add_u32 s3, s3, 320000
    buffer_load_dwordx4 v[108:111], v94, s[24:27], s3 offen offset:0
    s_mul_i32 s3, s33, 1280000
    s_add_u32 s3, s3, s38
    s_add_u32 s3, s3, 320000
    buffer_load_dwordx4 v[112:115], v94, s[24:27], s3 offen offset:1024
    s_mov_b32 exec_lo, s56
    s_mov_b32 exec_hi, 0
L2_p2:
    buffer_load_dword v88, v7, s[60:63], 0 offen sc1
    s_waitcnt vmcnt(0)
    v_cmpx_gt_u32 vcc, 2, v88
    s_cbranch_vccnz L2_p2s
    s_mov_b64 exec, -1
L2_e2:
    s_mov_b32 s6, 0xaaaaaaaa
    s_mov_b32 s7, 0xaaaaaaaa
    v_and_b32 v47, 0x0fffffff, v21
    buffer_load_dwordx2 v[16:17], v47, s[8:11], 0 offen
    buffer_load_dwordx3 v[18:20], v47, s[8:11], 0 offen offset:8
    s_waitcnt lgkmcnt(0)
    s_barrier
    s_bitcmp1_b32 s36, s42
    s_cbranch_scc1 L2_slow
L2_ret0:
    s_setprio 3
    v_and_b32 v47, 0x0fffffff, v27
    buffer_load_dwordx2 v[22:23], v47, s[8:11], 0 offen
    buffer_load_dwordx3 v[24:26], v47, s[8:11], 0 offen offset:8
    s_waitcnt vmcnt(2)
    v_and_b32 v46, 0x20000000, v21
    v_lshrrev_b32 v47, 14, v17
    v_bitop3_b32 v47, v47, v5, v46 bitop3:0xea
    ds_read_b64 v[102:103], v47
    v_bitop3_b32 v93, v17, v5, v46 bitop3:0xea
    v_and_b32 v46, 0x10000000, v21
    v_lshrrev_b32 v47, 14, v16
    v_bitop3_b32 v47, v47, v5, v46 bitop3:0xea
    ds_read_b64 v[100:101], v47
    v_bitop3_b32 v92, v16, v5, v46 bitop3:0xea
    v_perm_b32 v15, v17, v20, s45
    v_bitop3_b32 v46, v17, 0.5, -0.5 bitop3:0xa8
    v_perm_b32 v14, v16, v20, s44
    v_bitop3_b32 v47, v16, 0.5, -0.5 bitop3:0xa8
    s_waitcnt lgkmcnt(0)
    v_mfma_f32_4x4x4_16b_bf16 v[80:83], v[8:9], v[102:103], 0
    v_mfma_f32_4x4x4_16b_bf16 v[76:79], v[8:9], v[100:101], 0
    v_bitop3_b32 v15, v6, v15, v46 bitop3:0xca
    v_bitop3_b32 v14, v6, v14, v47 bitop3:0xca
    v_cmp_lt_u32 s[84:85], v5, v92
    s_nop 0
    v_pk_mul_f32 v[80:81], v[80:81], v[14:15] op_sel:[0,1] op_sel_hi:[1,1]
    v_pk_mul_f32 v[82:83], v[82:83], v[14:15] op_sel:[0,1] op_sel_hi:[1,1]
    v_pk_mul_f32 v[76:77], v[76:77], v[14:15] op_sel:[0,0] op_sel_hi:[1,0]
    v_pk_mul_f32 v[78:79], v[78:79], v[14:15] op_sel:[0,0] op_sel_hi:[1,0]
    v_and_b32 v47, 0x0fffffff, v33
    buffer_load_dwordx2 v[28:29], v47, s[8:11], 0 offen
    buffer_load_dwordx3 v[30:32], v47, s[8:11], 0 offen offset:8
    v_cmp_ne_u64 s[50:51], v[72:73], v[68:69]
    v_cmpx_ne_u64 s[54:55], v[74:75], v[70:71]
    s_and_b64 s[82:83], s[54:55], s[80:81]
    s_cbranch_scc1 L2_c7
L2_d7:
    v_mov_b64 v[84:85], v[70:71]
    v_mov_b32 v7, v95
    v_mov_b64 v[86:87], v[74:75]
    s_or_b64 s[80:81], s[80:81], s[54:55]
    s_mov_b64 exec, s[50:51]
    s_and_b64 s[82:83], s[50:51], s[80:81]
    s_cbranch_scc1 L2_c8
L2_d8:
    v_mov_b64 v[84:85], v[68:69]
    v_mov_b32 v7, v94
    v_mov_b64 v[86:87], v[72:73]
    s_mov_b64 exec, -1
    s_or_b64 s[80:81], s[80:81], s[50:51]
    ds_read_b64 v[70:71], v93 offset:65408
    s_and_b64 exec, s[84:85], s[80:81]
    v_mfma_f32_4x4x4_16b_bf16 v[76:79], v[12:13], v[84:85], 0
    v_mov_b32 v92, v7
    s_andn2_b64 s[80:81], s[80:81], s[84:85]
    v_mfma_f32_4x4x4_16b_bf16 v[76:79], v[10:11], v[86:87], v[76:79]
    s_mov_b64 exec, -1
    ds_read_b64 v[68:69], v92 offset:65408
    v_and_b32 v46, 0x80000000, v21
    v_lshrrev_b32 v47, 14, v19
    v_bitop3_b32 v47, v47, v5, v46 bitop3:0xea
    ds_read_b64 v[106:107], v47
    v_bitop3_b32 v95, v19, v5, v46 bitop3:0xea
    v_and_b32 v46, 0x40000000, v21
    v_lshrrev_b32 v47, 14, v18
    v_bitop3_b32 v47, v47, v5, v46 bitop3:0xea
    ds_read_b64 v[104:105], v47
    v_bitop3_b32 v94, v18, v5, v46 bitop3:0xea
    s_waitcnt lgkmcnt(2)
    v_mfma_f32_4x4x4_16b_bf16 v[80:83], v[10:11], v[70:71], v[80:83]
    v_mfma_f32_4x4x4_16b_bf16 v[76:79], v[10:11], v[68:69], v[76:79]
    v_perm_b32 v15, v19, v20, s47
    v_bitop3_b32 v46, v19, 0.5, -0.5 bitop3:0xa8
    v_perm_b32 v14, v18, v20, s46
    v_bitop3_b32 v47, v18, 0.5, -0.5 bitop3:0xa8
    v_cvt_pk_bf16_f32 v80, v80, v81
    v_cvt_pk_bf16_f32 v81, v82, v83
    ds_wrxchg_rtn_b64 v[74:75], v93, v[80:81] offset:65408
    v_cvt_pk_bf16_f32 v76, v76, v77
    v_cvt_pk_bf16_f32 v77, v78, v79
    ds_wrxchg_rtn_b64 v[72:73], v92, v[76:77] offset:65408
    s_setprio 2
    s_waitcnt lgkmcnt(2)
    v_mfma_f32_4x4x4_16b_bf16 v[80:83], v[8:9], v[106:107], 0
    v_mfma_f32_4x4x4_16b_bf16 v[76:79], v[8:9], v[104:105], 0
    v_bitop3_b32 v15, v6, v15, v46 bitop3:0xca
    v_bitop3_b32 v14, v6, v14, v47 bitop3:0xca
    s_nop 1
    v_pk_mul_f32 v[80:81], v[80:81], v[14:15] op_sel:[0,1] op_sel_hi:[1,1]
    v_pk_mul_f32 v[82:83], v[82:83], v[14:15] op_sel:[0,1] op_sel_hi:[1,1]
    v_pk_mul_f32 v[76:77], v[76:77], v[14:15] op_sel:[0,0] op_sel_hi:[1,0]
    v_pk_mul_f32 v[78:79], v[78:79], v[14:15] op_sel:[0,0] op_sel_hi:[1,0]
    v_sub_u16 v88, v60, v52
    v_and_b32 v89, 3, v52
    v_add3_u32 v99, v88, v89, 3
    v_and_b32 v99, -4, v99
    v_max_u32 v99, 4, v99
    v_and_b32 v97, 0xfffc, v52
    v_bfm_b32 v96, v88, v89
    v_add_u32_dpp v91, v99, v99 row_shr:1 row_mask:0xf bank_mask:0xf bound_ctrl:1
    v_mad_u32_u24 v97, v97, 5, v2
    v_cmp_lt_u32 vcc, 16, v99
    v_add_u32_dpp v91, v91, v91 row_shr:2 row_mask:0xf bank_mask:0xf bound_ctrl:1
    v_sub_u32 v98, s38, v99
    v_lshrrev_b64 v[52:53], 16, v[52:53]
    v_add_u32_dpp v91, v91, v91 row_shr:4 row_mask:0xf bank_mask:0xf bound_ctrl:1
    v_lshrrev_b64 v[60:61], 16, v[60:61]
    s_mov_b32 s101, 0
    v_add_u32_dpp v91, v91, v91 row_shr:8 row_mask:0xf bank_mask:0xf bound_ctrl:1
    s_nop 1
    v_add_u32_dpp v91, v91, v91 row_bcast:15 row_mask:0xa bank_mask:0xf
    s_nop 1
    v_add_u32_dpp v91, v91, v91 row_bcast:31 row_mask:0xc bank_mask:0xf
    v_add_u32 v98, v98, v91
    v_readlane_b32 s37, v91, 63
    s_cbranch_vccnz L2_xo9
L2_xp9:
    v_and_b32 v47, 0x3f0, v3
    s_cmp_lg_u32 s56, 0
    s_cbranch_scc1 L2_m10
    s_mul_i32 s3, s33, 1280000
    s_add_u32 s3, s3, s100
    s_add_u32 s3, s3, 352768
    buffer_load_dwordx4 v[124:127], v47, s[24:27], s3 offen offset:2048
L2_m10:
    v_and_b32 v47, 0x3f0, v3
    s_cmp_lg_u32 s56, 0
    s_cbranch_scc1 L2_m11
    s_mul_i32 s3, s33, 1280000
    s_add_u32 s3, s3, s100
    s_add_u32 s3, s3, 352768
    buffer_load_dwordx4 v[116:119], v47, s[24:27], s3 offen offset:0
L2_m11:
    s_waitcnt lgkmcnt(0)
    v_cmp_ne_u64 s[50:51], v[72:73], v[68:69]
    v_cmpx_ne_u64 s[54:55], v[74:75], v[70:71]
    s_and_b64 s[82:83], s[54:55], s[80:81]
    s_cbranch_scc1 L2_c12
L2_d12:
    v_mov_b64 v[84:85], v[70:71]
    v_mov_b32 v7, v93
    v_mov_b64 v[86:87], v[74:75]
    s_or_b64 s[80:81], s[80:81], s[54:55]
    s_mov_b64 exec, s[50:51]
    s_and_b64 s[82:83], s[50:51], s[80:81]
    s_cbranch_scc1 L2_c13
L2_d13:
    v_mov_b64 v[84:85], v[68:69]
    v_mov_b32 v7, v92
    v_mov_b64 v[86:87], v[72:73]
    s_mov_b64 exec, -1
    s_or_b64 s[80:81], s[80:81], s[50:51]
    ds_read_b64 v[70:71], v95 offset:65408
    ds_read_b64 v[68:69], v94 offset:65408
    s_waitcnt vmcnt(2)
    v_and_b32 v46, 0x20000000, v27
    v_lshrrev_b32 v47, 14, v23
    v_bitop3_b32 v47, v47, v5, v46 bitop3:0xea
    ds_read_b64 v[102:103], v47
    v_bitop3_b32 v93, v23, v5, v46 bitop3:0xea
    v_and_b32 v46, 0x10000000, v27
    v_lshrrev_b32 v47, 14, v22
    v_bitop3_b32 v47, v47, v5, v46 bitop3:0xea
    ds_read_b64 v[100:101], v47
    v_bitop3_b32 v92, v22, v5, v46 bitop3:0xea
    s_waitcnt lgkmcnt(2)
    v_mfma_f32_4x4x4_16b_bf16 v[80:83], v[10:11], v[70:71], v[80:83]
    v_mfma_f32_4x4x4_16b_bf16 v[76:79], v[10:11], v[68:69], v[76:79]
    v_perm_b32 v15, v23, v26, s45
    v_bitop3_b32 v46, v23, 0.5, -0.5 bitop3:0xa8
    v_perm_b32 v14, v22, v26, s44
    v_bitop3_b32 v47, v22, 0.5, -0.5 bitop3:0xa8
    v_cvt_pk_bf16_f32 v80, v80, v81
    v_cvt_pk_bf16_f32 v81, v82, v83
    ds_wrxchg_rtn_b64 v[74:75], v95, v[80:81] offset:65408
    v_cvt_pk_bf16_f32 v76, v76, v77
    v_cvt_pk_bf16_f32 v77, v78, v79
    ds_wrxchg_rtn_b64 v[72:73], v94, v[76:77] offset:65408
    s_waitcnt lgkmcnt(2)
    v_mfma_f32_4x4x4_16b_bf16 v[80:83], v[8:9], v[102:103], 0
    v_mfma_f32_4x4x4_16b_bf16 v[76:79], v[8:9], v[100:101], 0
    v_bitop3_b32 v15, v6, v15, v46 bitop3:0xca
    v_bitop3_b32 v14, v6, v14, v47 bitop3:0xca
    v_cmp_lt_u32 s[84:85], v5, v92
    s_nop 0
    v_pk_mul_f32 v[80:81], v[80:81], v[14:15] op_sel:[0,1] op_sel_hi:[1,1]
    v_pk_mul_f32 v[82:83], v[82:83], v[14:15] op_sel:[0,1] op_sel_hi:[1,1]
    v_pk_mul_f32 v[76:77], v[76:77], v[14:15] op_sel:[0,0] op_sel_hi:[1,0]
    v_pk_mul_f32 v[78:79], v[78:79], v[14:15] op_sel:[0,0] op_sel_hi:[1,0]
    v_and_b32 v47, 0x0fffffff, v39
    buffer_load_dwordx2 v[34:35], v47, s[8:11], 0 offen
    buffer_load_dwordx3 v[36:38], v47, s[8:11], 0 offen offset:8
    v_and_b32 v47, 0x3f0, v3
    s_cmp_lg_u32 s56, 0
    s_cbranch_scc1 L2_m14
    s_mul_i32 s3, s33, 1280000
    s_add_u32 s3, s3, s100
    s_add_u32 s3, s3, 352768
    buffer_load_dwordx4 v[120:123], v47, s[24:27], s3 offen offset:1024
L2_m14:
    s_waitcnt lgkmcnt(0)
    v_cmp_ne_u64 s[50:51], v[72:73], v[68:69]
    v_cmpx_ne_u64 s[54:55], v[74:75], v[70:71]
    s_and_b64 s[82:83], s[54:55], s[80:81]
    s_cbranch_scc1 L2_c15
L2_d15:
    v_mov_b64 v[84:85], v[70:71]
    v_mov_b32 v7, v95
    v_mov_b64 v[86:87], v[74:75]
    s_or_b64 s[80:81], s[80:81], s[54:55]
    s_mov_b64 exec, s[50:51]
    s_and_b64 s[82:83], s[50:51], s[80:81]
    s_cbranch_scc1 L2_c16
L2_d16:
    v_mov_b64 v[84:85], v[68:69]
    v_mov_b32 v7, v94
    v_mov_b64 v[86:87], v[72:73]
    s_mov_b64 exec, -1
    s_or_b64 s[80:81], s[80:81], s[50:51]
    ds_read_b64 v[70:71], v93 offset:65408
    s_and_b64 exec, s[84:85], s[80:81]
    v_mfma_f32_4x4x4_16b_bf16 v[76:79], v[12:13], v[84:85], 0
    v_mov_b32 v92, v7
    s_andn2_b64 s[80:81], s[80:81], s[84:85]
    v_mfma_f32_4x4x4_16b_bf16 v[76:79], v[10:11], v[86:87], v[76:79]
    s_mov_b64 exec, -1
    ds_read_b64 v[68:69], v92 offset:65408
    v_and_b32 v46, 0x80000000, v27
    v_lshrrev_b32 v47, 14, v25
    v_bitop3_b32 v47, v47, v5, v46 bitop3:0xea
    ds_read_b64 v[106:107], v47
    v_bitop3_b32 v95, v25, v5, v46 bitop3:0xea
    v_and_b32 v46, 0x40000000, v27
    v_lshrrev_b32 v47, 14, v24
    v_bitop3_b32 v47, v47, v5, v46 bitop3:0xea
    ds_read_b64 v[104:105], v47
    v_bitop3_b32 v94, v24, v5, v46 bitop3:0xea
    s_waitcnt lgkmcnt(2)
    v_mfma_f32_4x4x4_16b_bf16 v[80:83], v[10:11], v[70:71], v[80:83]
    v_mfma_f32_4x4x4_16b_bf16 v[76:79], v[10:11], v[68:69], v[76:79]
    v_perm_b32 v15, v25, v26, s47
    v_bitop3_b32 v46, v25, 0.5, -0.5 bitop3:0xa8
    v_perm_b32 v14, v24, v26, s46
    v_bitop3_b32 v47, v24, 0.5, -0.5 bitop3:0xa8
    v_cvt_pk_bf16_f32 v80, v80, v81
    v_cvt_pk_bf16_f32 v81, v82, v83
    ds_wrxchg_rtn_b64 v[74:75], v93, v[80:81] offset:65408
    v_cvt_pk_bf16_f32 v76, v76, v77
    v_cvt_pk_bf16_f32 v77, v78, v79
    ds_wrxchg_rtn_b64 v[72:73], v92, v[76:77] offset:65408
    s_setprio 1
    s_waitcnt lgkmcnt(2)
    v_mfma_f32_4x4x4_16b_bf16 v[80:83], v[8:9], v[106:107], 0
    v_mfma_f32_4x4x4_16b_bf16 v[76:79], v[8:9], v[104:105], 0
    v_bitop3_b32 v15, v6, v15, v46 bitop3:0xca
    v_bitop3_b32 v14, v6, v14, v47 bitop3:0xca
    s_nop 1
    v_pk_mul_f32 v[80:81], v[80:81], v[14:15] op_sel:[0,1] op_sel_hi:[1,1]
    v_pk_mul_f32 v[82:83], v[82:83], v[14:15] op_sel:[0,1] op_sel_hi:[1,1]
    v_pk_mul_f32 v[76:77], v[76:77], v[14:15] op_sel:[0,0] op_sel_hi:[1,0]
    v_pk_mul_f32 v[78:79], v[78:79], v[14:15] op_sel:[0,0] op_sel_hi:[1,0]
    v_and_b32 v47, 0x3f0, v3
    s_cmp_lg_u32 s56, 0
    s_cbranch_scc1 L2_m17
    s_mul_i32 s3, s33, 1280000
    s_add_u32 s3, s3, s38
    s_add_u32 s3, s3, 320000
    buffer_load_dwordx4 v[108:111], v47, s[24:27], s3 offen offset:0
L2_m17:
    v_and_b32 v47, 0x3f0, v3
    s_cmp_lg_u32 s56, 0
    s_cbranch_scc1 L2_m18
    s_mul_i32 s3, s33, 1280000
    s_add_u32 s3, s3, s38
    s_add_u32 s3, s3, 320000
    buffer_load_dwordx4 v[112:115], v47, s[24:27], s3 offen offset:1024
L2_m18:
    v_and_b32 v47, 0x0fffffff, v40
    v_mov_b32 v21, v40
    buffer_load_dwordx2 v[16:17], v47, s[8:11], 0 offen
    buffer_load_dwordx3 v[18:20], v47, s[8:11], 0 offen offset:8
    s_waitcnt lgkmcnt(0)
    v_cmp_ne_u64 s[50:51], v[72:73], v[68:69]
    v_cmpx_ne_u64 s[54:55], v[74:75], v[70:71]
    s_and_b64 s[82:83], s[54:55], s[80:81]
    s_cbranch_scc1 L2_c19
L2_d19:
    v_mov_b64 v[84:85], v[70:71]
    v_mov_b32 v7, v93
    v_mov_b64 v[86:87], v[74:75]
    s_or_b64 s[80:81], s[80:81], s[54:55]
    s_mov_b64 exec, s[50:51]
    s_and_b64 s[82:83], s[50:51], s[80:81]
    s_cbranch_scc1 L2_c20
L2_d20:
    v_mov_b64 v[84:85], v[68:69]
    v_mov_b32 v7, v92
    v_mov_b64 v[86:87], v[72:73]
    s_mov_b64 exec, -1
    s_or_b64 s[80:81], s[80:81], s[50:51]
    ds_read_b64 v[70:71], v95 offset:65408
    ds_read_b64 v[68:69], v94 offset:65408
    s_waitcnt vmcnt(4)
    v_and_b32 v46, 0x20000000, v33
    v_lshrrev_b32 v47, 14, v29
    v_bitop3_b32 v47, v47, v5, v46 bitop3:0xea
    ds_read_b64 v[102:103], v47
    v_bitop3_b32 v93, v29, v5, v46 bitop3:0xea
    v_and_b32 v46, 0x10000000, v33
    v_lshrrev_b32 v47, 14, v28
    v_bitop3_b32 v47, v47, v5, v46 bitop3:0xea
    ds_read_b64 v[100:101], v47
    v_bitop3_b32 v92, v28, v5, v46 bitop3:0xea
    s_waitcnt lgkmcnt(2)
    v_mfma_f32_4x4x4_16b_bf16 v[80:83], v[10:11], v[70:71], v[80:83]
    v_mfma_f32_4x4x4_16b_bf16 v[76:79], v[10:11], v[68:69], v[76:79]
    v_perm_b32 v15, v29, v32, s45
    v_bitop3_b32 v46, v29, 0.5, -0.5 bitop3:0xa8
    v_perm_b32 v14, v28, v32, s44
    v_bitop3_b32 v47, v28, 0.5, -0.5 bitop3:0xa8
    v_cvt_pk_bf16_f32 v80, v80, v81
    v_cvt_pk_bf16_f32 v81, v82, v83
    ds_wrxchg_rtn_b64 v[74:75], v95, v[80:81] offset:65408
    v_cvt_pk_bf16_f32 v76, v76, v77
    v_cvt_pk_bf16_f32 v77, v78, v79
    ds_wrxchg_rtn_b64 v[72:73], v94, v[76:77] offset:65408
    s_waitcnt lgkmcnt(2)
    v_mfma_f32_4x4x4_16b_bf16 v[80:83], v[8:9], v[102:103], 0
    v_mfma_f32_4x4x4_16b_bf16 v[76:79], v[8:9], v[100:101], 0
    v_bitop3_b32 v15, v6, v15, v46 bitop3:0xca
    v_bitop3_b32 v14, v6, v14, v47 bitop3:0xca
    v_cmp_lt_u32 s[84:85], v5, v92
    s_nop 0
    v_pk_mul_f32 v[80:81], v[80:81], v[14:15] op_sel:[0,1] op_sel_hi:[1,1]
    v_pk_mul_f32 v[82:83], v[82:83], v[14:15] op_sel:[0,1] op_sel_hi:[1,1]
    v_pk_mul_f32 v[76:77], v[76:77], v[14:15] op_sel:[0,0] op_sel_hi:[1,0]
    v_pk_mul_f32 v[78:79], v[78:79], v[14:15] op_sel:[0,0] op_sel_hi:[1,0]
    s_waitcnt lgkmcnt(0)
    v_cmp_ne_u64 s[50:51], v[72:73], v[68:69]
    v_cmpx_ne_u64 s[54:55], v[74:75], v[70:71]
    s_and_b64 s[82:83], s[54:55], s[80:81]
    s_cbranch_scc1 L2_c21
L2_d21:
    v_mov_b64 v[84:85], v[70:71]
    v_mov_b32 v7, v95
    v_mov_b64 v[86:87], v[74:75]
    s_or_b64 s[80:81], s[80:81], s[54:55]
    s_mov_b64 exec, s[50:51]
    s_and_b64 s[82:83], s[50:51], s[80:81]
    s_cbranch_scc1 L2_c22
L2_d22:
    v_mov_b64 v[84:85], v[68:69]
    v_mov_b32 v7, v94
    v_mov_b64 v[86:87], v[72:73]
    s_mov_b64 exec, -1
    s_or_b64 s[80:81], s[80:81], s[50:51]
    ds_read_b64 v[70:71], v93 offset:65408
    s_and_b64 exec, s[84:85], s[80:81]
    v_mfma_f32_4x4x4_16b_bf16 v[76:79], v[12:13], v[84:85], 0
    v_mov_b32 v92, v7
    s_andn2_b64 s[80:81], s[80:81], s[84:85]
    v_mfma_f32_4x4x4_16b_bf16 v[76:79], v[10:11], v[86:87], v[76:79]
    s_mov_b64 exec, -1
    ds_read_b64 v[68:69], v92 offset:65408
    v_and_b32 v46, 0x80000000, v33
    v_lshrrev_b32 v47, 14, v31
    v_bitop3_b32 v47, v47, v5, v46 bitop3:0xea
    ds_read_b64 v[106:107], v47
    v_bitop3_b32 v95, v31, v5, v46 bitop3:0xea
    v_and_b32 v46, 0x40000000, v33
    v_lshrrev_b32 v47, 14, v30
    v_bitop3_b32 v47, v47, v5, v46 bitop3:0xea
    ds_read_b64 v[104:105], v47
    v_bitop3_b32 v94, v30, v5, v46 bitop3:0xea
    s_waitcnt lgkmcnt(2)
    v_mfma_f32_4x4x4_16b_bf16 v[80:83], v[10:11], v[70:71], v[80:83]
    v_mfma_f32_4x4x4_16b_bf16 v[76:79], v[10:11], v[68:69], v[76:79]
    v_perm_b32 v15, v31, v32, s47
    v_bitop3_b32 v46, v31, 0.5, -0.5 bitop3:0xa8
    v_perm_b32 v14, v30, v32, s46
    v_bitop3_b32 v47, v30, 0.5, -0.5 bitop3:0xa8
    v_cvt_pk_bf16_f32 v80, v80, v81
    v_cvt_pk_bf16_f32 v81, v82, v83
    ds_wrxchg_rtn_b64 v[74:75], v93, v[80:81] offset:65408
    v_cvt_pk_bf16_f32 v76, v76, v77
    v_cvt_pk_bf16_f32 v77, v78, v79
    ds_wrxchg_rtn_b64 v[72:73], v92, v[76:77] offset:65408
    s_setprio 0
    s_waitcnt lgkmcnt(2)
    v_mfma_f32_4x4x4_16b_bf16 v[80:83], v[8:9], v[106:107], 0
    v_mfma_f32_4x4x4_16b_bf16 v[76:79], v[8:9], v[104:105], 0
    v_bitop3_b32 v15, v6, v15, v46 bitop3:0xca
    v_bitop3_b32 v14, v6, v14, v47 bitop3:0xca
    s_nop 1
    v_pk_mul_f32 v[80:81], v[80:81], v[14:15] op_sel:[0,1] op_sel_hi:[1,1]
    v_pk_mul_f32 v[82:83], v[82:83], v[14:15] op_sel:[0,1] op_sel_hi:[1,1]
    v_pk_mul_f32 v[76:77], v[76:77], v[14:15] op_sel:[0,0] op_sel_hi:[1,0]
    v_pk_mul_f32 v[78:79], v[78:79], v[14:15] op_sel:[0,0] op_sel_hi:[1,0]
    s_add_u32 s40, s40, 0x50000
    v_and_b32 v47, 0x0fffffff, v41
    v_mov_b32 v27, v41
    buffer_load_dwordx2 v[22:23], v47, s[8:11], 0 offen
    buffer_load_dwordx3 v[24:26], v47, s[8:11], 0 offen offset:8
    s_waitcnt lgkmcnt(0)
    v_cmp_ne_u64 s[50:51], v[72:73], v[68:69]
    v_cmpx_ne_u64 s[54:55], v[74:75], v[70:71]
    s_and_b64 s[82:83], s[54:55], s[80:81]
    s_cbranch_scc1 L2_c23
L2_d23:
    v_mov_b64 v[84:85], v[70:71]
    v_mov_b32 v7, v93
    v_mov_b64 v[86:87], v[74:75]
    s_or_b64 s[80:81], s[80:81], s[54:55]
    s_mov_b64 exec, s[50:51]
    s_and_b64 s[82:83], s[50:51], s[80:81]
    s_cbranch_scc1 L2_c24
L2_d24:
    v_mov_b64 v[84:85], v[68:69]
    v_mov_b32 v7, v92
    v_mov_b64 v[86:87], v[72:73]
    s_mov_b64 exec, -1
    s_or_b64 s[80:81], s[80:81], s[50:51]
    ds_read_b64 v[70:71], v95 offset:65408
    ds_read_b64 v[68:69], v94 offset:65408
    s_waitcnt vmcnt(4)
    v_and_b32 v46, 0x20000000, v39
    v_lshrrev_b32 v47, 14, v35
    v_bitop3_b32 v47, v47, v5, v46 bitop3:0xea
    ds_read_b64 v[102:103], v47
    v_bitop3_b32 v93, v35, v5, v46 bitop3:0xea
    v_and_b32 v46, 0x10000000, v39
    v_lshrrev_b32 v47, 14, v34
    v_bitop3_b32 v47, v47, v5, v46 bitop3:0xea
    ds_read_b64 v[100:101], v47
    v_bitop3_b32 v92, v34, v5, v46 bitop3:0xea
    v_and_b32 v46, 0x80000000, v39
    v_lshrrev_b32 v47, 14, v37
    v_bitop3_b32 v47, v47, v5, v46 bitop3:0xea
    ds_read_b64 v[106:107], v47
    v_and_b32 v46, 0x40000000, v39
    v_lshrrev_b32 v47, 14, v36
    v_bitop3_b32 v47, v47, v5, v46 bitop3:0xea
    ds_read_b64 v[104:105], v47
    s_waitcnt lgkmcnt(4)
    v_mfma_f32_4x4x4_16b_bf16 v[80:83], v[10:11], v[70:71], v[80:83]
    v_mfma_f32_4x4x4_16b_bf16 v[76:79], v[10:11], v[68:69], v[76:79]
    v_perm_b32 v15, v35, v38, s45
    v_bitop3_b32 v46, v35, 0.5, -0.5 bitop3:0xa8
    v_perm_b32 v14, v34, v38, s44
    v_bitop3_b32 v47, v34, 0.5, -0.5 bitop3:0xa8
    v_cvt_pk_bf16_f32 v80, v80, v81
    v_cvt_pk_bf16_f32 v81, v82, v83
    ds_wrxchg_rtn_b64 v[74:75], v95, v[80:81] offset:65408
    v_cvt_pk_bf16_f32 v76, v76, v77
    v_cvt_pk_bf16_f32 v77, v78, v79
    ds_wrxchg_rtn_b64 v[72:73], v94, v[76:77] offset:65408
    s_waitcnt lgkmcnt(2)
    s_barrier
    s_setprio 3
    s_waitcnt vmcnt(6)
    v_subrev_u32 v88, s38, v3
    ds_write_b128 v88, v[116:119] offset:32768
    buffer_load_dwordx4 v[116:119], v3, s[16:19], s40 offen offset:2048
    s_waitcnt vmcnt(5)
    v_subrev_u32 v88, s38, v3
    ds_write_b128 v88, v[120:123] offset:33792
    buffer_load_dwordx4 v[120:123], v3, s[16:19], s40 offen offset:3072
    v_mfma_f32_4x4x4_16b_bf16 v[80:83], v[8:9], v[102:103], 0
    v_mfma_f32_4x4x4_16b_bf16 v[76:79], v[8:9], v[100:101], 0
    v_bitop3_b32 v15, v6, v15, v46 bitop3:0xca
    v_bitop3_b32 v14, v6, v14, v47 bitop3:0xca
    v_cmp_lt_u32 s[84:85], v5, v92
    s_nop 0
    v_pk_mul_f32 v[80:81], v[80:81], v[14:15] op_sel:[0,1] op_sel_hi:[1,1]
    v_pk_mul_f32 v[82:83], v[82:83], v[14:15] op_sel:[0,1] op_sel_hi:[1,1]
    v_pk_mul_f32 v[76:77], v[76:77], v[14:15] op_sel:[0,0] op_sel_hi:[1,0]
    v_pk_mul_f32 v[78:79], v[78:79], v[14:15] op_sel:[0,0] op_sel_hi:[1,0]
    v_and_b32 v47, 0x0fffffff, v42
    v_mov_b32 v33, v42
    buffer_load_dwordx2 v[28:29], v47, s[8:11], 0 offen
    buffer_load_dwordx3 v[30:32], v47, s[8:11], 0 offen offset:8
    v_mov_b32 v44, v43
    s_cmp_gt_u32 s37, 1024
    s_cbranch_scc1 L2_xs25
    s_cmp_lg_u32 s101, 0
    s_cbranch_scc1 L2_xa25
L2_xb25:
    v_lshlrev_b32 v89, 16, v96
    v_add_u32 v90, 60, v97
    v_bitop3_b32 v90, v89, v45, v90 bitop3:0x6a
    ds_write_b32 v98, v90 offset:12
    v_lshlrev_b32 v89, 20, v96
    v_add_u32 v90, 40, v97
    v_bitop3_b32 v90, v89, v45, v90 bitop3:0x6a
    ds_write_b32 v98, v90 offset:8
    v_lshlrev_b32 v89, 24, v96
    v_add_u32 v90, 20, v97
    v_bitop3_b32 v90, v89, v45, v90 bitop3:0x6a
    ds_write_b32 v98, v90 offset:4
    v_lshlrev_b32 v89, 28, v96
    v_bitop3_b32 v90, v89, v45, v97 bitop3:0x6a
    ds_write_b32 v98, v90 offset:0
    v_mov_b32_dpp v91, v64 quad_perm:[1,1,1,1] row_mask:0xf bank_mask:0xf
    v_and_b32 v89, 3, v91
    v_and_b32 v97, 0xfffc, v91
    v_sub_u16_dpp v88, v64, v91 quad_perm:[3,3,3,3] row_mask:0xf bank_mask:0xf
    v_mad_u32_u24 v97, v97, 5, v4
    v_add_u32 v99, v88, v89
    v_bfm_b32 v96, v88, v89
    v_cmp_lt_u32 s[58:59], 16, v99
    v_lshlrev_b32 v89, v1, v96
    v_and_b32 v89, v45, v89
    v_cmp_ne_u32 vcc, 0, v89
    v_xor_b32 v90, v97, v89
    s_add_u32 s3, s37, s38
    v_mbcnt_lo_u32_b32 v98, vcc_lo, 0
    v_mbcnt_hi_u32_b32 v98, vcc_hi, v98
    s_bcnt1_i32_b64 s41, vcc
    v_lshl_add_u32 v98, v98, 2, s3
    s_mov_b64 exec, vcc
    ds_write_b32 v98, v90
    s_mov_b64 exec, -1
    s_lshl2_add_u32 s37, s41, s37
    s_cmp_lg_u64 s[58:59], 0
    s_cbranch_scc1 L2_xe25
L2_xr25:
    v_add_u32 v98, s37, v0
    v_mov_b32 v90, -1
    ds_write_b32 v98, v90
    ds_read2st64_b32 v[40:41], v0 offset0:0 offset1:1
    ds_read2st64_b32 v[42:43], v0 offset0:2 offset1:3
    s_sub_u32 s3, s37, 768
    s_cmp_gt_u32 s3, 256
    s_cbranch_scc1 L2_xf25
L2_xg25:
    s_setprio 2
    s_waitcnt vmcnt(10)
    v_subrev_u32 v88, s38, v3
    ds_write_b128 v88, v[124:127] offset:34816
    s_add_u32 s3, s40, 4096
    buffer_load_dwordx4 v[124:127], v3, s[16:19], s3 offen
    s_waitcnt lgkmcnt(11)
    v_cmp_ne_u64 s[50:51], v[72:73], v[68:69]
    v_cmpx_ne_u64 s[54:55], v[74:75], v[70:71]
    s_and_b64 s[82:83], s[54:55], s[80:81]
    s_cbranch_scc1 L2_c26
L2_d26:
    v_mov_b64 v[84:85], v[70:71]
    v_mov_b32 v7, v95
    v_mov_b64 v[86:87], v[74:75]
    s_or_b64 s[80:81], s[80:81], s[54:55]
    s_mov_b64 exec, s[50:51]
    s_and_b64 s[82:83], s[50:51], s[80:81]
    s_cbranch_scc1 L2_c27
L2_d27:
    v_mov_b64 v[84:85], v[68:69]
    v_mov_b32 v7, v94
    v_mov_b64 v[86:87], v[72:73]
    s_mov_b64 exec, -1
    s_or_b64 s[80:81], s[80:81], s[50:51]
    ds_read_b64 v[70:71], v93 offset:65408
    s_and_b64 exec, s[84:85], s[80:81]
    v_mfma_f32_4x4x4_16b_bf16 v[76:79], v[12:13], v[84:85], 0
    v_mov_b32 v92, v7
    s_andn2_b64 s[80:81], s[80:81], s[84:85]
    v_mfma_f32_4x4x4_16b_bf16 v[76:79], v[10:11], v[86:87], v[76:79]
    s_mov_b64 exec, -1
    ds_read_b64 v[68:69], v92 offset:65408
    s_setprio 1
    s_waitcnt vmcnt(9)
    v_subrev_u32 v88, s100, v3
    ds_write_b128 v88, v[108:111] offset:0
    s_waitcnt lgkmcnt(1)
    v_mfma_f32_4x4x4_16b_bf16 v[80:83], v[10:11], v[70:71], v[80:83]
    v_mfma_f32_4x4x4_16b_bf16 v[76:79], v[10:11], v[68:69], v[76:79]
    v_and_b32 v46, 0x40000000, v39
    v_bitop3_b32 v94, v36, v5, v46 bitop3:0xea
    v_and_b32 v46, 0x80000000, v39
    v_bitop3_b32 v95, v37, v5, v46 bitop3:0xea
    v_perm_b32 v15, v37, v38, s47
    v_bitop3_b32 v46, v37, 0.5, -0.5 bitop3:0xa8
    v_perm_b32 v14, v36, v38, s46
    v_bitop3_b32 v47, v36, 0.5, -0.5 bitop3:0xa8
    v_cvt_pk_bf16_f32 v80, v80, v81
    v_cvt_pk_bf16_f32 v81, v82, v83
    ds_wrxchg_rtn_b64 v[74:75], v93, v[80:81] offset:65408
    v_cvt_pk_bf16_f32 v76, v76, v77
    v_cvt_pk_bf16_f32 v77, v78, v79
    ds_wrxchg_rtn_b64 v[72:73], v92, v[76:77] offset:65408
    s_setprio 0
    s_waitcnt vmcnt(9)
    v_subrev_u32 v88, s100, v3
    ds_write_b128 v88, v[112:115] offset:1024
    v_mfma_f32_4x4x4_16b_bf16 v[80:83], v[8:9], v[106:107], 0
    v_mfma_f32_4x4x4_16b_bf16 v[76:79], v[8:9], v[104:105], 0
    v_bitop3_b32 v15, v6, v15, v46 bitop3:0xca
    v_bitop3_b32 v14, v6, v14, v47 bitop3:0xca
    s_nop 1
    v_pk_mul_f32 v[80:81], v[80:81], v[14:15] op_sel:[0,1] op_sel_hi:[1,1]
    v_pk_mul_f32 v[82:83], v[82:83], v[14:15] op_sel:[0,1] op_sel_hi:[1,1]
    v_pk_mul_f32 v[76:77], v[76:77], v[14:15] op_sel:[0,0] op_sel_hi:[1,0]
    v_pk_mul_f32 v[78:79], v[78:79], v[14:15] op_sel:[0,0] op_sel_hi:[1,0]
    s_add_u32 s42, s42, 1
    s_waitcnt lgkmcnt(0)
    s_add_u32 s24, s30, 0xec45000
    s_addc_u32 s25, s31, 0
    s_mov_b32 s26, 0x100
    s_mov_b32 s27, 0x20000
    s_barrier
    s_bitcmp1_b32 s36, s42
    s_cbranch_scc1 L2_slow
L2_ret1:
    s_setprio 3
    v_and_b32 v47, 0x0fffffff, v44
    v_mov_b32 v39, v44
    buffer_load_dwordx2 v[34:35], v47, s[8:11], 0 offen
    buffer_load_dwordx3 v[36:38], v47, s[8:11], 0 offen offset:8
    buffer_load_dwordx4 v[108:111], v3, s[16:19], s40 offen offset:0
    v_cmp_ne_u64 s[50:51], v[72:73], v[68:69]
    v_cmpx_ne_u64 s[54:55], v[74:75], v[70:71]
    s_and_b64 s[82:83], s[54:55], s[80:81]
    s_cbranch_scc1 L2_c28
L2_d28:
    v_mov_b64 v[84:85], v[70:71]
    v_mov_b32 v7, v93
    v_mov_b64 v[86:87], v[74:75]
    s_or_b64 s[80:81], s[80:81], s[54:55]
    s_mov_b64 exec, s[50:51]
    s_and_b64 s[82:83], s[50:51], s[80:81]
    s_cbranch_scc1 L2_c29
L2_d29:
    v_mov_b64 v[84:85], v[68:69]
    v_mov_b32 v7, v92
    v_mov_b64 v[86:87], v[72:73]
    s_mov_b64 exec, -1
    s_or_b64 s[80:81], s[80:81], s[50:51]
    ds_read_b64 v[70:71], v95 offset:65408
    ds_read_b64 v[68:69], v94 offset:65408
    s_waitcnt vmcnt(10)
    v_and_b32 v46, 0x20000000, v21
    v_lshrrev_b32 v47, 14, v17
    v_bitop3_b32 v47, v47, v5, v46 bitop3:0xea
    ds_read_b64 v[102:103], v47
    v_bitop3_b32 v93, v17, v5, v46 bitop3:0xea
    v_and_b32 v46, 0x10000000, v21
    v_lshrrev_b32 v47, 14, v16
    v_bitop3_b32 v47, v47, v5, v46 bitop3:0xea
    ds_read_b64 v[100:101], v47
    v_bitop3_b32 v92, v16, v5, v46 bitop3:0xea
    s_waitcnt lgkmcnt(2)
    v_mfma_f32_4x4x4_16b_bf16 v[80:83], v[10:11], v[70:71], v[80:83]
    v_mfma_f32_4x4x4_16b_bf16 v[76:79], v[10:11], v[68:69], v[76:79]
    v_perm_b32 v15, v17, v20, s45
    v_bitop3_b32 v46, v17, 0.5, -0.5 bitop3:0xa8
    v_perm_b32 v14, v16, v20, s44
    v_bitop3_b32 v47, v16, 0.5, -0.5 bitop3:0xa8
    v_cvt_pk_bf16_f32 v80, v80, v81
    v_cvt_pk_bf16_f32 v81, v82, v83
    ds_wrxchg_rtn_b64 v[74:75], v95, v[80:81] offset:65408
    v_cvt_pk_bf16_f32 v76, v76, v77
    v_cvt_pk_bf16_f32 v77, v78, v79
    ds_wrxchg_rtn_b64 v[72:73], v94, v[76:77] offset:65408
    s_waitcnt lgkmcnt(2)
    v_mfma_f32_4x4x4_16b_bf16 v[80:83], v[8:9], v[102:103], 0
    v_mfma_f32_4x4x4_16b_bf16 v[76:79], v[8:9], v[100:101], 0
    v_bitop3_b32 v15, v6, v15, v46 bitop3:0xca
    v_bitop3_b32 v14, v6, v14, v47 bitop3:0xca
    v_cmp_lt_u32 s[84:85], v5, v92
    s_nop 0
    v_pk_mul_f32 v[80:81], v[80:81], v[14:15] op_sel:[0,1] op_sel_hi:[1,1]
    v_pk_mul_f32 v[82:83], v[82:83], v[14:15] op_sel:[0,1] op_sel_hi:[1,1]
    v_pk_mul_f32 v[76:77], v[76:77], v[14:15] op_sel:[0,0] op_sel_hi:[1,0]
    v_pk_mul_f32 v[78:79], v[78:79], v[14:15] op_sel:[0,0] op_sel_hi:[1,0]
    buffer_load_dwordx4 v[112:115], v3, s[16:19], s40 offen offset:1024
    s_waitcnt lgkmcnt(0)
    v_cmp_ne_u64 s[50:51], v[72:73], v[68:69]
    v_cmpx_ne_u64 s[54:55], v[74:75], v[70:71]
    s_and_b64 s[82:83], s[54:55], s[80:81]
    s_cbranch_scc1 L2_c30
L2_d30:
    v_mov_b64 v[84:85], v[70:71]
    v_mov_b32 v7, v95
    v_mov_b64 v[86:87], v[74:75]
    s_or_b64 s[80:81], s[80:81], s[54:55]
    s_mov_b64 exec, s[50:51]
    s_and_b64 s[82:83], s[50:51], s[80:81]
    s_cbranch_scc1 L2_c31
L2_d31:
    v_mov_b64 v[84:85], v[68:69]
    v_mov_b32 v7, v94
    v_mov_b64 v[86:87], v[72:73]
    s_mov_b64 exec, -1
    s_or_b64 s[80:81], s[80:81], s[50:51]
    ds_read_b64 v[70:71], v93 offset:65408
    s_and_b64 exec, s[84:85], s[80:81]
    v_mfma_f32_4x4x4_16b_bf16 v[76:79], v[12:13], v[84:85], 0
    v_mov_b32 v92, v7
    s_andn2_b64 s[80:81], s[80:81], s[84:85]
    v_mfma_f32_4x4x4_16b_bf16 v[76:79], v[10:11], v[86:87], v[76:79]
    s_mov_b64 exec, -1
    ds_read_b64 v[68:69], v92 offset:65408
    v_and_b32 v46, 0x80000000, v21
    v_lshrrev_b32 v47, 14, v19
    v_bitop3_b32 v47, v47, v5, v46 bitop3:0xea
    ds_read_b64 v[106:107], v47
    v_bitop3_b32 v95, v19, v5, v46 bitop3:0xea
    v_and_b32 v46, 0x40000000, v21
    v_lshrrev_b32 v47, 14, v18
    v_bitop3_b32 v47, v47, v5, v46 bitop3:0xea
    ds_read_b64 v[104:105], v47
    v_bitop3_b32 v94, v18, v5, v46 bitop3:0xea
    s_waitcnt lgkmcnt(2)
    v_mfma_f32_4x4x4_16b_bf16 v[80:83], v[10:11], v[70:71], v[80:83]
    v_mfma_f32_4x4x4_16b_bf16 v[76:79], v[10:11], v[68:69], v[76:79]
    v_perm_b32 v15, v19, v20, s47
    v_bitop3_b32 v46, v19, 0.5, -0.5 bitop3:0xa8
    v_perm_b32 v14, v18, v20, s46
    v_bitop3_b32 v47, v18, 0.5, -0.5 bitop3:0xa8
    v_cvt_pk_bf16_f32 v80, v80, v81
    v_cvt_pk_bf16_f32 v81, v82, v83
    ds_wrxchg_rtn_b64 v[74:75], v93, v[80:81] offset:65408
    v_cvt_pk_bf16_f32 v76, v76, v77
    v_cvt_pk_bf16_f32 v77, v78, v79
    ds_wrxchg_rtn_b64 v[72:73], v92, v[76:77] offset:65408
    s_setprio 2
    s_waitcnt lgkmcnt(2)
    v_mfma_f32_4x4x4_16b_bf16 v[80:83], v[8:9], v[106:107], 0
    v_mfma_f32_4x4x4_16b_bf16 v[76:79], v[8:9], v[104:105], 0
    v_bitop3_b32 v15, v6, v15, v46 bitop3:0xca
    v_bitop3_b32 v14, v6, v14, v47 bitop3:0xca
    s_nop 1
    v_pk_mul_f32 v[80:81], v[80:81], v[14:15] op_sel:[0,1] op_sel_hi:[1,1]
    v_pk_mul_f32 v[82:83], v[82:83], v[14:15] op_sel:[0,1] op_sel_hi:[1,1]
    v_pk_mul_f32 v[76:77], v[76:77], v[14:15] op_sel:[0,0] op_sel_hi:[1,0]
    v_pk_mul_f32 v[78:79], v[78:79], v[14:15] op_sel:[0,0] op_sel_hi:[1,0]
    v_sub_u16 v88, v62, v54
    v_and_b32 v89, 3, v54
    v_add3_u32 v99, v88, v89, 3
    v_and_b32 v99, -4, v99
    v_max_u32 v99, 4, v99
    v_and_b32 v97, 0xfffc, v54
    v_bfm_b32 v96, v88, v89
    v_add_u32_dpp v91, v99, v99 row_shr:1 row_mask:0xf bank_mask:0xf bound_ctrl:1
    v_mad_u32_u24 v97, v97, 5, v2
    v_cmp_lt_u32 vcc, 16, v99
    v_add_u32_dpp v91, v91, v91 row_shr:2 row_mask:0xf bank_mask:0xf bound_ctrl:1
    v_sub_u32 v98, s38, v99
    v_lshrrev_b64 v[54:55], 16, v[54:55]
    v_add_u32_dpp v91, v91, v91 row_shr:4 row_mask:0xf bank_mask:0xf bound_ctrl:1
    v_lshrrev_b64 v[62:63], 16, v[62:63]
    s_mov_b32 s101, 0
    v_add_u32_dpp v91, v91, v91 row_shr:8 row_mask:0xf bank_mask:0xf bound_ctrl:1
    s_nop 1
    v_add_u32_dpp v91, v91, v91 row_bcast:15 row_mask:0xa bank_mask:0xf
    s_nop 1
    v_add_u32_dpp v91, v91, v91 row_bcast:31 row_mask:0xc bank_mask:0xf
    v_add_u32 v98, v98, v91
    v_readlane_b32 s37, v91, 63
    s_cbranch_vccnz L2_xo32
L2_xp32:
    v_and_b32 v47, 0x0fffffff, v40
    v_mov_b32 v21, v40
    buffer_load_dwordx2 v[16:17], v47, s[8:11], 0 offen
    buffer_load_dwordx3 v[18:20], v47, s[8:11], 0 offen offset:8
    s_waitcnt lgkmcnt(0)
    v_cmp_ne_u64 s[50:51], v[72:73], v[68:69]
    v_cmpx_ne_u64 s[54:55], v[74:75], v[70:71]
    s_and_b64 s[82:83], s[54:55], s[80:81]
    s_cbranch_scc1 L2_c33
L2_d33:
    v_mov_b64 v[84:85], v[70:71]
    v_mov_b32 v7, v93
    v_mov_b64 v[86:87], v[74:75]
    s_or_b64 s[80:81], s[80:81], s[54:55]
    s_mov_b64 exec, s[50:51]
    s_and_b64 s[82:83], s[50:51], s[80:81]
    s_cbranch_scc1 L2_c34
L2_d34:
    v_mov_b64 v[84:85], v[68:69]
    v_mov_b32 v7, v92
    v_mov_b64 v[86:87], v[72:73]
    s_mov_b64 exec, -1
    s_or_b64 s[80:81], s[80:81], s[50:51]
    ds_read_b64 v[70:71], v95 offset:65408
    ds_read_b64 v[68:69], v94 offset:65408
    s_waitcnt vmcnt(11)
    v_and_b32 v46, 0x20000000, v27
    v_lshrrev_b32 v47, 14, v23
    v_bitop3_b32 v47, v47, v5, v46 bitop3:0xea
    ds_read_b64 v[102:103], v47
    v_bitop3_b32 v93, v23, v5, v46 bitop3:0xea
    v_and_b32 v46, 0x10000000, v27
    v_lshrrev_b32 v47, 14, v22
    v_bitop3_b32 v47, v47, v5, v46 bitop3:0xea
    ds_read_b64 v[100:101], v47
    v_bitop3_b32 v92, v22, v5, v46 bitop3:0xea
    s_waitcnt lgkmcnt(2)
    v_mfma_f32_4x4x4_16b_bf16 v[80:83], v[10:11], v[70:71], v[80:83]
    v_mfma_f32_4x4x4_16b_bf16 v[76:79], v[10:11], v[68:69], v[76:79]
    v_perm_b32 v15, v23, v26, s45
    v_bitop3_b32 v46, v23, 0.5, -0.5 bitop3:0xa8
    v_perm_b32 v14, v22, v26, s44
    v_bitop3_b32 v47, v22, 0.5, -0.5 bitop3:0xa8
    v_cvt_pk_bf16_f32 v80, v80, v81
    v_cvt_pk_bf16_f32 v81, v82, v83
    ds_wrxchg_rtn_b64 v[74:75], v95, v[80:81] offset:65408
    v_cvt_pk_bf16_f32 v76, v76, v77
    v_cvt_pk_bf16_f32 v77, v78, v79
    ds_wrxchg_rtn_b64 v[72:73], v94, v[76:77] offset:65408
    s_waitcnt lgkmcnt(2)
    v_mfma_f32_4x4x4_16b_bf16 v[80:83], v[8:9], v[102:103], 0
    v_mfma_f32_4x4x4_16b_bf16 v[76:79], v[8:9], v[100:101], 0
    v_bitop3_b32 v15, v6, v15, v46 bitop3:0xca
    v_bitop3_b32 v14, v6, v14, v47 bitop3:0xca
    v_cmp_lt_u32 s[84:85], v5, v92
    s_nop 0
    v_pk_mul_f32 v[80:81], v[80:81], v[14:15] op_sel:[0,1] op_sel_hi:[1,1]
    v_pk_mul_f32 v[82:83], v[82:83], v[14:15] op_sel:[0,1] op_sel_hi:[1,1]
    v_pk_mul_f32 v[76:77], v[76:77], v[14:15] op_sel:[0,0] op_sel_hi:[1,0]
    v_pk_mul_f32 v[78:79], v[78:79], v[14:15] op_sel:[0,0] op_sel_hi:[1,0]
    s_waitcnt lgkmcnt(0)
    v_cmp_ne_u64 s[50:51], v[72:73], v[68:69]
    v_cmpx_ne_u64 s[54:55], v[74:75], v[70:71]
    s_and_b64 s[82:83], s[54:55], s[80:81]
    s_cbranch_scc1 L2_c35
L2_d35:
    v_mov_b64 v[84:85], v[70:71]
    v_mov_b32 v7, v95
    v_mov_b64 v[86:87], v[74:75]
    s_or_b64 s[80:81], s[80:81], s[54:55]
    s_mov_b64 exec, s[50:51]
    s_and_b64 s[82:83], s[50:51], s[80:81]
    s_cbranch_scc1 L2_c36
L2_d36:
    v_mov_b64 v[84:85], v[68:69]
    v_mov_b32 v7, v94
    v_mov_b64 v[86:87], v[72:73]
    s_mov_b64 exec, -1
    s_or_b64 s[80:81], s[80:81], s[50:51]
    ds_read_b64 v[70:71], v93 offset:65408
    s_and_b64 exec, s[84:85], s[80:81]
    v_mfma_f32_4x4x4_16b_bf16 v[76:79], v[12:13], v[84:85], 0
    v_mov_b32 v92, v7
    s_andn2_b64 s[80:81], s[80:81], s[84:85]
    v_mfma_f32_4x4x4_16b_bf16 v[76:79], v[10:11], v[86:87], v[76:79]
    s_mov_b64 exec, -1
    ds_read_b64 v[68:69], v92 offset:65408
    v_and_b32 v46, 0x80000000, v27
    v_lshrrev_b32 v47, 14, v25
    v_bitop3_b32 v47, v47, v5, v46 bitop3:0xea
    ds_read_b64 v[106:107], v47
    v_bitop3_b32 v95, v25, v5, v46 bitop3:0xea
    v_and_b32 v46, 0x40000000, v27
    v_lshrrev_b32 v47, 14, v24
    v_bitop3_b32 v47, v47, v5, v46 bitop3:0xea
    ds_read_b64 v[104:105], v47
    v_bitop3_b32 v94, v24, v5, v46 bitop3:0xea
    s_waitcnt lgkmcnt(2)
    v_mfma_f32_4x4x4_16b_bf16 v[80:83], v[10:11], v[70:71], v[80:83]
    v_mfma_f32_4x4x4_16b_bf16 v[76:79], v[10:11], v[68:69], v[76:79]
    v_perm_b32 v15, v25, v26, s47
    v_bitop3_b32 v46, v25, 0.5, -0.5 bitop3:0xa8
    v_perm_b32 v14, v24, v26, s46
    v_bitop3_b32 v47, v24, 0.5, -0.5 bitop3:0xa8
    v_cvt_pk_bf16_f32 v80, v80, v81
    v_cvt_pk_bf16_f32 v81, v82, v83
    ds_wrxchg_rtn_b64 v[74:75], v93, v[80:81] offset:65408
    v_cvt_pk_bf16_f32 v76, v76, v77
    v_cvt_pk_bf16_f32 v77, v78, v79
    ds_wrxchg_rtn_b64 v[72:73], v92, v[76:77] offset:65408
    s_setprio 1
    s_waitcnt lgkmcnt(2)
    v_mfma_f32_4x4x4_16b_bf16 v[80:83], v[8:9], v[106:107], 0
    v_mfma_f32_4x4x4_16b_bf16 v[76:79], v[8:9], v[104:105], 0
    v_bitop3_b32 v15, v6, v15, v46 bitop3:0xca
    v_bitop3_b32 v14, v6, v14, v47 bitop3:0xca
    s_nop 1
    v_pk_mul_f32 v[80:81], v[80:81], v[14:15] op_sel:[0,1] op_sel_hi:[1,1]
    v_pk_mul_f32 v[82:83], v[82:83], v[14:15] op_sel:[0,1] op_sel_hi:[1,1]
    v_pk_mul_f32 v[76:77], v[76:77], v[14:15] op_sel:[0,0] op_sel_hi:[1,0]
    v_pk_mul_f32 v[78:79], v[78:79], v[14:15] op_sel:[0,0] op_sel_hi:[1,0]
    v_and_b32 v47, 0x0fffffff, v41
    v_mov_b32 v27, v41
    buffer_load_dwordx2 v[22:23], v47, s[8:11], 0 offen
    buffer_load_dwordx3 v[24:26], v47, s[8:11], 0 offen offset:8
    s_waitcnt lgkmcnt(0)
    v_cmp_ne_u64 s[50:51], v[72:73], v[68:69]
    v_cmpx_ne_u64 s[54:55], v[74:75], v[70:71]
    s_and_b64 s[82:83], s[54:55], s[80:81]
    s_cbranch_scc1 L2_c37
L2_d37:
    v_mov_b64 v[84:85], v[70:71]
    v_mov_b32 v7, v93
    v_mov_b64 v[86:87], v[74:75]
    s_or_b64 s[80:81], s[80:81], s[54:55]
    s_mov_b64 exec, s[50:51]
    s_and_b64 s[82:83], s[50:51], s[80:81]
    s_cbranch_scc1 L2_c38
L2_d38:
    v_mov_b64 v[84:85], v[68:69]
    v_mov_b32 v7, v92
    v_mov_b64 v[86:87], v[72:73]
    s_mov_b64 exec, -1
    s_or_b64 s[80:81], s[80:81], s[50:51]
    ds_read_b64 v[70:71], v95 offset:65408
    ds_read_b64 v[68:69], v94 offset:65408
    s_waitcnt vmcnt(9)
    v_and_b32 v46, 0x20000000, v33
    v_lshrrev_b32 v47, 14, v29
    v_bitop3_b32 v47, v47, v5, v46 bitop3:0xea
    ds_read_b64 v[102:103], v47
    v_bitop3_b32 v93, v29, v5, v46 bitop3:0xea
    v_and_b32 v46, 0x10000000, v33
    v_lshrrev_b32 v47, 14, v28
    v_bitop3_b32 v47, v47, v5, v46 bitop3:0xea
    ds_read_b64 v[100:101], v47
    v_bitop3_b32 v92, v28, v5, v46 bitop3:0xea
    s_waitcnt lgkmcnt(2)
    v_mfma_f32_4x4x4_16b_bf16 v[80:83], v[10:11], v[70:71], v[80:83]
    v_mfma_f32_4x4x4_16b_bf16 v[76:79], v[10:11], v[68:69], v[76:79]
    v_perm_b32 v15, v29, v32, s45
    v_bitop3_b32 v46, v29, 0.5, -0.5 bitop3:0xa8
    v_perm_b32 v14, v28, v32, s44
    v_bitop3_b32 v47, v28, 0.5, -0.5 bitop3:0xa8
    v_cvt_pk_bf16_f32 v80, v80, v81
    v_cvt_pk_bf16_f32 v81, v82, v83
    ds_wrxchg_rtn_b64 v[74:75], v95, v[80:81] offset:65408
    v_cvt_pk_bf16_f32 v76, v76, v77
    v_cvt_pk_bf16_f32 v77, v78, v79
    ds_wrxchg_rtn_b64 v[72:73], v94, v[76:77] offset:65408
    s_waitcnt lgkmcnt(2)
    v_mfma_f32_4x4x4_16b_bf16 v[80:83], v[8:9], v[102:103], 0
    v_mfma_f32_4x4x4_16b_bf16 v[76:79], v[8:9], v[100:101], 0
    v_bitop3_b32 v15, v6, v15, v46 bitop3:0xca
    v_bitop3_b32 v14, v6, v14, v47 bitop3:0xca
    v_cmp_lt_u32 s[84:85], v5, v92
    s_nop 0
    v_pk_mul_f32 v[80:81], v[80:81], v[14:15] op_sel:[0,1] op_sel_hi:[1,1]
    v_pk_mul_f32 v[82:83], v[82:83], v[14:15] op_sel:[0,1] op_sel_hi:[1,1]
    v_pk_mul_f32 v[76:77], v[76:77], v[14:15] op_sel:[0,0] op_sel_hi:[1,0]
    v_pk_mul_f32 v[78:79], v[78:79], v[14:15] op_sel:[0,0] op_sel_hi:[1,0]
    s_waitcnt lgkmcnt(0)
    v_cmp_ne_u64 s[50:51], v[72:73], v[68:69]
    v_cmpx_ne_u64 s[54:55], v[74:75], v[70:71]
    s_and_b64 s[82:83], s[54:55], s[80:81]
    s_cbranch_scc1 L2_c39
L2_d39:
    v_mov_b64 v[84:85], v[70:71]
    v_mov_b32 v7, v95
    v_mov_b64 v[86:87], v[74:75]
    s_or_b64 s[80:81], s[80:81], s[54:55]
    s_mov_b64 exec, s[50:51]
    s_and_b64 s[82:83], s[50:51], s[80:81]
    s_cbranch_scc1 L2_c40
L2_d40:
    v_mov_b64 v[84:85], v[68:69]
    v_mov_b32 v7, v94
    v_mov_b64 v[86:87], v[72:73]
    s_mov_b64 exec, -1
    s_or_b64 s[80:81], s[80:81], s[50:51]
    ds_read_b64 v[70:71], v93 offset:65408
    s_and_b64 exec, s[84:85], s[80:81]
    v_mfma_f32_4x4x4_16b_bf16 v[76:79], v[12:13], v[84:85], 0
    v_mov_b32 v92, v7
    s_andn2_b64 s[80:81], s[80:81], s[84:85]
    v_mfma_f32_4x4x4_16b_bf16 v[76:79], v[10:11], v[86:87], v[76:79]
    s_mov_b64 exec, -1
    ds_read_b64 v[68:69], v92 offset:65408
    v_and_b32 v46, 0x80000000, v33
    v_lshrrev_b32 v47, 14, v31
    v_bitop3_b32 v47, v47, v5, v46 bitop3:0xea
    ds_read_b64 v[106:107], v47
    v_bitop3_b32 v95, v31, v5, v46 bitop3:0xea
    v_and_b32 v46, 0x40000000, v33
    v_lshrrev_b32 v47, 14, v30
    v_bitop3_b32 v47, v47, v5, v46 bitop3:0xea
    ds_read_b64 v[104:105], v47
    v_bitop3_b32 v94, v30, v5, v46 bitop3:0xea
    s_waitcnt lgkmcnt(2)
    v_mfma_f32_4x4x4_16b_bf16 v[80:83], v[10:11], v[70:71], v[80:83]
    v_mfma_f32_4x4x4_16b_bf16 v[76:79], v[10:11], v[68:69], v[76:79]
    v_perm_b32 v15, v31, v32, s47
    v_bitop3_b32 v46, v31, 0.5, -0.5 bitop3:0xa8
    v_perm_b32 v14, v30, v32, s46
    v_bitop3_b32 v47, v30, 0.5, -0.5 bitop3:0xa8
    v_cvt_pk_bf16_f32 v80, v80, v81
    v_cvt_pk_bf16_f32 v81, v82, v83
    ds_wrxchg_rtn_b64 v[74:75], v93, v[80:81] offset:65408
    v_cvt_pk_bf16_f32 v76, v76, v77
    v_cvt_pk_bf16_f32 v77, v78, v79
    ds_wrxchg_rtn_b64 v[72:73], v92, v[76:77] offset:65408
    s_setprio 0
    s_waitcnt lgkmcnt(2)
    v_mfma_f32_4x4x4_16b_bf16 v[80:83], v[8:9], v[106:107], 0
    v_mfma_f32_4x4x4_16b_bf16 v[76:79], v[8:9], v[104:105], 0
    v_bitop3_b32 v15, v6, v15, v46 bitop3:0xca
    v_bitop3_b32 v14, v6, v14, v47 bitop3:0xca
    s_nop 1
    v_pk_mul_f32 v[80:81], v[80:81], v[14:15] op_sel:[0,1] op_sel_hi:[1,1]
    v_pk_mul_f32 v[82:83], v[82:83], v[14:15] op_sel:[0,1] op_sel_hi:[1,1]
    v_pk_mul_f32 v[76:77], v[76:77], v[14:15] op_sel:[0,0] op_sel_hi:[1,0]
    v_pk_mul_f32 v[78:79], v[78:79], v[14:15] op_sel:[0,0] op_sel_hi:[1,0]
    s_add_u32 s40, s40, 0x50000
    v_and_b32 v47, 0x0fffffff, v42
    v_mov_b32 v33, v42
    buffer_load_dwordx2 v[28:29], v47, s[8:11], 0 offen
    buffer_load_dwordx3 v[30:32], v47, s[8:11], 0 offen offset:8
    s_waitcnt lgkmcnt(0)
    v_cmp_ne_u64 s[50:51], v[72:73], v[68:69]
    v_cmpx_ne_u64 s[54:55], v[74:75], v[70:71]
    s_and_b64 s[82:83], s[54:55], s[80:81]
    s_cbranch_scc1 L2_c41
L2_d41:
    v_mov_b64 v[84:85], v[70:71]
    v_mov_b32 v7, v93
    v_mov_b64 v[86:87], v[74:75]
    s_or_b64 s[80:81], s[80:81], s[54:55]
    s_mov_b64 exec, s[50:51]
    s_and_b64 s[82:83], s[50:51], s[80:81]
    s_cbranch_scc1 L2_c42
L2_d42:
    v_mov_b64 v[84:85], v[68:69]
    v_mov_b32 v7, v92
    v_mov_b64 v[86:87], v[72:73]
    s_mov_b64 exec, -1
    s_or_b64 s[80:81], s[80:81], s[50:51]
    ds_read_b64 v[70:71], v95 offset:65408
    ds_read_b64 v[68:69], v94 offset:65408
    s_waitcnt vmcnt(8)
    v_and_b32 v46, 0x20000000, v39
    v_lshrrev_b32 v47, 14, v35
    v_bitop3_b32 v47, v47, v5, v46 bitop3:0xea
    ds_read_b64 v[102:103], v47
    v_bitop3_b32 v93, v35, v5, v46 bitop3:0xea
    v_and_b32 v46, 0x10000000, v39
    v_lshrrev_b32 v47, 14, v34
    v_bitop3_b32 v47, v47, v5, v46 bitop3:0xea
    ds_read_b64 v[100:101], v47
    v_bitop3_b32 v92, v34, v5, v46 bitop3:0xea
    v_and_b32 v46, 0x80000000, v39
    v_lshrrev_b32 v47, 14, v37
    v_bitop3_b32 v47, v47, v5, v46 bitop3:0xea
    ds_read_b64 v[106:107], v47
    v_and_b32 v46, 0x40000000, v39
    v_lshrrev_b32 v47, 14, v36
    v_bitop3_b32 v47, v47, v5, v46 bitop3:0xea
    ds_read_b64 v[104:105], v47
    s_waitcnt lgkmcnt(4)
    v_mfma_f32_4x4x4_16b_bf16 v[80:83], v[10:11], v[70:71], v[80:83]
    v_mfma_f32_4x4x4_16b_bf16 v[76:79], v[10:11], v[68:69], v[76:79]
    v_perm_b32 v15, v35, v38, s45
    v_bitop3_b32 v46, v35, 0.5, -0.5 bitop3:0xa8
    v_perm_b32 v14, v34, v38, s44
    v_bitop3_b32 v47, v34, 0.5, -0.5 bitop3:0xa8
    v_cvt_pk_bf16_f32 v80, v80, v81
    v_cvt_pk_bf16_f32 v81, v82, v83
    ds_wrxchg_rtn_b64 v[74:75], v95, v[80:81] offset:65408
    v_cvt_pk_bf16_f32 v76, v76, v77
    v_cvt_pk_bf16_f32 v77, v78, v79
    ds_wrxchg_rtn_b64 v[72:73], v94, v[76:77] offset:65408
    s_waitcnt lgkmcnt(2)
    s_barrier
    s_setprio 3
    s_mov_b32 m0, s100
    s_nop 0
    ds_write_addtid_b32 v116 offset:32768
    ds_write_addtid_b32 v117 offset:33024
    ds_write_addtid_b32 v118 offset:33280
    ds_write_addtid_b32 v119 offset:33536
    buffer_load_dwordx4 v[116:119], v3, s[16:19], s40 offen offset:2048
    ds_write_addtid_b32 v120 offset:33792
    ds_write_addtid_b32 v121 offset:34048
    ds_write_addtid_b32 v122 offset:34304
    ds_write_addtid_b32 v123 offset:34560
    buffer_load_dwordx4 v[120:123], v3, s[16:19], s40 offen offset:3072
    v_mfma_f32_4x4x4_16b_bf16 v[80:83], v[8:9], v[102:103], 0
    v_mfma_f32_4x4x4_16b_bf16 v[76:79], v[8:9], v[100:101], 0
    v_bitop3_b32 v15, v6, v15, v46 bitop3:0xca
    v_bitop3_b32 v14, v6, v14, v47 bitop3:0xca
    v_cmp_lt_u32 s[84:85], v5, v92
    s_nop 0
    v_pk_mul_f32 v[80:81], v[80:81], v[14:15] op_sel:[0,1] op_sel_hi:[1,1]
    v_pk_mul_f32 v[82:83], v[82:83], v[14:15] op_sel:[0,1] op_sel_hi:[1,1]
    v_pk_mul_f32 v[76:77], v[76:77], v[14:15] op_sel:[0,0] op_sel_hi:[1,0]
    v_pk_mul_f32 v[78:79], v[78:79], v[14:15] op_sel:[0,0] op_sel_hi:[1,0]
    v_mov_b32 v44, v43
    s_cmp_gt_u32 s37, 1024
    s_cbranch_scc1 L2_xs43
    s_cmp_lg_u32 s101, 0
    s_cbranch_scc1 L2_xa43
L2_xb43:
    v_lshlrev_b32 v89, 16, v96
    v_add_u32 v90, 60, v97
    v_bitop3_b32 v90, v89, v45, v90 bitop3:0x6a
    ds_write_b32 v98, v90 offset:12
    v_lshlrev_b32 v89, 20, v96
    v_add_u32 v90, 40, v97
    v_bitop3_b32 v90, v89, v45, v90 bitop3:0x6a
    ds_write_b32 v98, v90 offset:8
    v_lshlrev_b32 v89, 24, v96
    v_add_u32 v90, 20, v97
    v_bitop3_b32 v90, v89, v45, v90 bitop3:0x6a
    ds_write_b32 v98, v90 offset:4
    v_lshlrev_b32 v89, 28, v96
    v_bitop3_b32 v90, v89, v45, v97 bitop3:0x6a
    ds_write_b32 v98, v90 offset:0
    v_mov_b32_dpp v91, v66 quad_perm:[1,1,1,1] row_mask:0xf bank_mask:0xf
    v_and_b32 v89, 3, v91
    v_and_b32 v97, 0xfffc, v91
    v_sub_u16_dpp v88, v66, v91 quad_perm:[3,3,3,3] row_mask:0xf bank_mask:0xf
    v_mad_u32_u24 v97, v97, 5, v4
    v_add_u32 v99, v88, v89
    v_bfm_b32 v96, v88, v89
    v_cmp_lt_u32 s[58:59], 16, v99
    v_lshlrev_b32 v89, v1, v96
    v_and_b32 v89, v45, v89
    v_cmp_ne_u32 vcc, 0, v89
    v_xor_b32 v90, v97, v89
    s_add_u32 s3, s37, s38
    v_mbcnt_lo_u32_b32 v98, vcc_lo, 0
    v_mbcnt_hi_u32_b32 v98, vcc_hi, v98
    s_bcnt1_i32_b64 s41, vcc
    v_lshl_add_u32 v98, v98, 2, s3
    s_mov_b64 exec, vcc
    ds_write_b32 v98, v90
    s_mov_b64 exec, -1
    s_lshl2_add_u32 s37, s41, s37
    s_cmp_lg_u64 s[58:59], 0
    s_cbranch_scc1 L2_xe43
L2_xr43:
    v_add_u32 v98, s37, v0
    v_mov_b32 v90, -1
    ds_write_b32 v98, v90
    ds_read2st64_b32 v[40:41], v0 offset0:0 offset1:1
    ds_read2st64_b32 v[42:43], v0 offset0:2 offset1:3
    s_sub_u32 s3, s37, 768
    s_cmp_gt_u32 s3, 256
    s_cbranch_scc1 L2_xf43
L2_xg43:
    v_lshrrev_b64 v[64:65], 16, v[64:65]
    v_lshrrev_b64 v[66:67], 16, v[66:67]
    s_setprio 2
    ds_write_addtid_b32 v124 offset:34816
    ds_write_addtid_b32 v125 offset:35072
    ds_write_addtid_b32 v126 offset:35328
    ds_write_addtid_b32 v127 offset:35584
    s_add_u32 s3, s40, 4096
    buffer_load_dwordx4 v[124:127], v3, s[16:19], s3 offen
    s_waitcnt lgkmcnt(14)
    v_cmp_ne_u64 s[50:51], v[72:73], v[68:69]
    v_cmpx_ne_u64 s[54:55], v[74:75], v[70:71]
    s_and_b64 s[82:83], s[54:55], s[80:81]
    s_cbranch_scc1 L2_c44
L2_d44:
    v_mov_b64 v[84:85], v[70:71]
    v_mov_b32 v7, v95
    v_mov_b64 v[86:87], v[74:75]
    s_or_b64 s[80:81], s[80:81], s[54:55]
    s_mov_b64 exec, s[50:51]
    s_and_b64 s[82:83], s[50:51], s[80:81]
    s_cbranch_scc1 L2_c45
L2_d45:
    v_mov_b64 v[84:85], v[68:69]
    v_mov_b32 v7, v94
    v_mov_b64 v[86:87], v[72:73]
    s_mov_b64 exec, -1
    s_or_b64 s[80:81], s[80:81], s[50:51]
    ds_read_b64 v[70:71], v93 offset:65408
    s_and_b64 exec, s[84:85], s[80:81]
    v_mfma_f32_4x4x4_16b_bf16 v[76:79], v[12:13], v[84:85], 0
    v_mov_b32 v92, v7
    s_andn2_b64 s[80:81], s[80:81], s[84:85]
    v_mfma_f32_4x4x4_16b_bf16 v[76:79], v[10:11], v[86:87], v[76:79]
    s_mov_b64 exec, -1
    ds_read_b64 v[68:69], v92 offset:65408
    s_setprio 1
    s_waitcnt vmcnt(10)
    s_mov_b32 m0, s38
    s_nop 0
    ds_write_addtid_b32 v108 offset:0
    ds_write_addtid_b32 v109 offset:256
    ds_write_addtid_b32 v110 offset:512
    ds_write_addtid_b32 v111 offset:768
    s_waitcnt lgkmcnt(4)
    v_mfma_f32_4x4x4_16b_bf16 v[80:83], v[10:11], v[70:71], v[80:83]
    v_mfma_f32_4x4x4_16b_bf16 v[76:79], v[10:11], v[68:69], v[76:79]
    v_and_b32 v46, 0x40000000, v39
    v_bitop3_b32 v94, v36, v5, v46 bitop3:0xea
    v_and_b32 v46, 0x80000000, v39
    v_bitop3_b32 v95, v37, v5, v46 bitop3:0xea
    v_perm_b32 v15, v37, v38, s47
    v_bitop3_b32 v46, v37, 0.5, -0.5 bitop3:0xa8
    v_perm_b32 v14, v36, v38, s46
    v_bitop3_b32 v47, v36, 0.5, -0.5 bitop3:0xa8
    v_cvt_pk_bf16_f32 v80, v80, v81
    v_cvt_pk_bf16_f32 v81, v82, v83
    ds_wrxchg_rtn_b64 v[74:75], v93, v[80:81] offset:65408
    v_cvt_pk_bf16_f32 v76, v76, v77
    v_cvt_pk_bf16_f32 v77, v78, v79
    ds_wrxchg_rtn_b64 v[72:73], v92, v[76:77] offset:65408
    v_and_b32 v88, 0x0fffffff, v44
    v_mov_b32 v39, v44
    buffer_load_dwordx2 v[34:35], v88, s[8:11], 0 offen
    buffer_load_dwordx3 v[36:38], v88, s[8:11], 0 offen offset:8
    s_setprio 0
    s_waitcnt vmcnt(11)
    ds_write_addtid_b32 v112 offset:1024
    ds_write_addtid_b32 v113 offset:1280
    ds_write_addtid_b32 v114 offset:1536
    ds_write_addtid_b32 v115 offset:1792
    v_mfma_f32_4x4x4_16b_bf16 v[80:83], v[8:9], v[106:107], 0
    v_mfma_f32_4x4x4_16b_bf16 v[76:79], v[8:9], v[104:105], 0
    v_bitop3_b32 v15, v6, v15, v46 bitop3:0xca
    v_bitop3_b32 v14, v6, v14, v47 bitop3:0xca
    s_nop 1
    v_pk_mul_f32 v[80:81], v[80:81], v[14:15] op_sel:[0,1] op_sel_hi:[1,1]
    v_pk_mul_f32 v[82:83], v[82:83], v[14:15] op_sel:[0,1] op_sel_hi:[1,1]
    v_pk_mul_f32 v[76:77], v[76:77], v[14:15] op_sel:[0,0] op_sel_hi:[1,0]
    v_pk_mul_f32 v[78:79], v[78:79], v[14:15] op_sel:[0,0] op_sel_hi:[1,0]
    s_add_u32 s42, s42, 1
    s_waitcnt lgkmcnt(0)
L2_loop:
    s_barrier
    s_bitcmp1_b32 s36, s42
    s_cbranch_scc1 L2_slow
L2_ret2:
    s_setprio 3
    buffer_load_dwordx4 v[108:111], v3, s[16:19], s40 offen offset:0
    v_cmp_ne_u64 s[50:51], v[72:73], v[68:69]
    v_cmpx_ne_u64 s[54:55], v[74:75], v[70:71]
    s_and_b64 s[82:83], s[54:55], s[80:81]
    s_cbranch_scc1 L2_c46
L2_d46:
    v_mov_b64 v[84:85], v[70:71]
    v_mov_b32 v7, v93
    v_mov_b64 v[86:87], v[74:75]
    s_or_b64 s[80:81], s[80:81], s[54:55]
    s_mov_b64 exec, s[50:51]
    s_and_b64 s[82:83], s[50:51], s[80:81]
    s_cbranch_scc1 L2_c47
L2_d47:
    v_mov_b64 v[84:85], v[68:69]
    v_mov_b32 v7, v92
    v_mov_b64 v[86:87], v[72:73]
    s_mov_b64 exec, -1
    s_or_b64 s[80:81], s[80:81], s[50:51]
    ds_read_b64 v[70:71], v95 offset:65408
    ds_read_b64 v[68:69], v94 offset:65408
    s_waitcnt vmcnt(10)
    v_and_b32 v46, 0x20000000, v21
    v_lshrrev_b32 v47, 14, v17
    v_bitop3_b32 v47, v47, v5, v46 bitop3:0xea
    ds_read_b64 v[102:103], v47
    v_bitop3_b32 v93, v17, v5, v46 bitop3:0xea
    v_and_b32 v46, 0x10000000, v21
    v_lshrrev_b32 v47, 14, v16
    v_bitop3_b32 v47, v47, v5, v46 bitop3:0xea
    ds_read_b64 v[100:101], v47
    v_bitop3_b32 v92, v16, v5, v46 bitop3:0xea
    s_waitcnt lgkmcnt(2)
    v_mfma_f32_4x4x4_16b_bf16 v[80:83], v[10:11], v[70:71], v[80:83]
    v_mfma_f32_4x4x4_16b_bf16 v[76:79], v[10:11], v[68:69], v[76:79]
    v_perm_b32 v15, v17, v20, s45
    v_bitop3_b32 v46, v17, 0.5, -0.5 bitop3:0xa8
    v_perm_b32 v14, v16, v20, s44
    v_bitop3_b32 v47, v16, 0.5, -0.5 bitop3:0xa8
    v_cvt_pk_bf16_f32 v80, v80, v81
    v_cvt_pk_bf16_f32 v81, v82, v83
    ds_wrxchg_rtn_b64 v[74:75], v95, v[80:81] offset:65408
    v_cvt_pk_bf16_f32 v76, v76, v77
    v_cvt_pk_bf16_f32 v77, v78, v79
    ds_wrxchg_rtn_b64 v[72:73], v94, v[76:77] offset:65408
    s_waitcnt lgkmcnt(2)
    v_mfma_f32_4x4x4_16b_bf16 v[80:83], v[8:9], v[102:103], 0
    v_mfma_f32_4x4x4_16b_bf16 v[76:79], v[8:9], v[100:101], 0
    v_bitop3_b32 v15, v6, v15, v46 bitop3:0xca
    v_bitop3_b32 v14, v6, v14, v47 bitop3:0xca
    v_cmp_lt_u32 s[84:85], v5, v92
    s_nop 0
    v_pk_mul_f32 v[80:81], v[80:81], v[14:15] op_sel:[0,1] op_sel_hi:[1,1]
    v_pk_mul_f32 v[82:83], v[82:83], v[14:15] op_sel:[0,1] op_sel_hi:[1,1]
    v_pk_mul_f32 v[76:77], v[76:77], v[14:15] op_sel:[0,0] op_sel_hi:[1,0]
    v_pk_mul_f32 v[78:79], v[78:79], v[14:15] op_sel:[0,0] op_sel_hi:[1,0]
    buffer_load_dwordx4 v[112:115], v3, s[16:19], s40 offen offset:1024
    s_waitcnt lgkmcnt(0)
    v_cmp_ne_u64 s[50:51], v[72:73], v[68:69]
    v_cmpx_ne_u64 s[54:55], v[74:75], v[70:71]
    s_and_b64 s[82:83], s[54:55], s[80:81]
    s_cbranch_scc1 L2_c48
L2_d48:
    v_mov_b64 v[84:85], v[70:71]
    v_mov_b32 v7, v95
    v_mov_b64 v[86:87], v[74:75]
    s_or_b64 s[80:81], s[80:81], s[54:55]
    s_mov_b64 exec, s[50:51]
    s_and_b64 s[82:83], s[50:51], s[80:81]
    s_cbranch_scc1 L2_c49
L2_d49:
    v_mov_b64 v[84:85], v[68:69]
    v_mov_b32 v7, v94
    v_mov_b64 v[86:87], v[72:73]
    s_mov_b64 exec, -1
    s_or_b64 s[80:81], s[80:81], s[50:51]
    ds_read_b64 v[70:71], v93 offset:65408
    s_and_b64 exec, s[84:85], s[80:81]
    v_mfma_f32_4x4x4_16b_bf16 v[76:79], v[12:13], v[84:85], 0
    v_mov_b32 v92, v7
    s_andn2_b64 s[80:81], s[80:81], s[84:85]
    v_mfma_f32_4x4x4_16b_bf16 v[76:79], v[10:11], v[86:87], v[76:79]
    s_mov_b64 exec, -1
    ds_read_b64 v[68:69], v92 offset:65408
    v_and_b32 v46, 0x80000000, v21
    v_lshrrev_b32 v47, 14, v19
    v_bitop3_b32 v47, v47, v5, v46 bitop3:0xea
    ds_read_b64 v[106:107], v47
    v_bitop3_b32 v95, v19, v5, v46 bitop3:0xea
    v_and_b32 v46, 0x40000000, v21
    v_lshrrev_b32 v47, 14, v18
    v_bitop3_b32 v47, v47, v5, v46 bitop3:0xea
    ds_read_b64 v[104:105], v47
    v_bitop3_b32 v94, v18, v5, v46 bitop3:0xea
    s_waitcnt lgkmcnt(2)
    v_mfma_f32_4x4x4_16b_bf16 v[80:83], v[10:11], v[70:71], v[80:83]
    v_mfma_f32_4x4x4_16b_bf16 v[76:79], v[10:11], v[68:69], v[76:79]
    v_perm_b32 v15, v19, v20, s47
    v_bitop3_b32 v46, v19, 0.5, -0.5 bitop3:0xa8
    v_perm_b32 v14, v18, v20, s46
    v_bitop3_b32 v47, v18, 0.5, -0.5 bitop3:0xa8
    v_cvt_pk_bf16_f32 v80, v80, v81
    v_cvt_pk_bf16_f32 v81, v82, v83
    ds_wrxchg_rtn_b64 v[74:75], v93, v[80:81] offset:65408
    v_cvt_pk_bf16_f32 v76, v76, v77
    v_cvt_pk_bf16_f32 v77, v78, v79
    ds_wrxchg_rtn_b64 v[72:73], v92, v[76:77] offset:65408
    v_and_b32 v88, 0x0fffffff, v40
    v_mov_b32 v21, v40
    buffer_load_dwordx2 v[16:17], v88, s[8:11], 0 offen
    buffer_load_dwordx3 v[18:20], v88, s[8:11], 0 offen offset:8
    s_setprio 2
    s_waitcnt lgkmcnt(2)
    v_mfma_f32_4x4x4_16b_bf16 v[80:83], v[8:9], v[106:107], 0
    v_mfma_f32_4x4x4_16b_bf16 v[76:79], v[8:9], v[104:105], 0
    v_bitop3_b32 v15, v6, v15, v46 bitop3:0xca
    v_bitop3_b32 v14, v6, v14, v47 bitop3:0xca
    s_nop 1
    v_pk_mul_f32 v[80:81], v[80:81], v[14:15] op_sel:[0,1] op_sel_hi:[1,1]
    v_pk_mul_f32 v[82:83], v[82:83], v[14:15] op_sel:[0,1] op_sel_hi:[1,1]
    v_pk_mul_f32 v[76:77], v[76:77], v[14:15] op_sel:[0,0] op_sel_hi:[1,0]
    v_pk_mul_f32 v[78:79], v[78:79], v[14:15] op_sel:[0,0] op_sel_hi:[1,0]
    v_sub_u16 v88, v56, v48
    v_and_b32 v89, 3, v48
    v_add3_u32 v99, v88, v89, 3
    v_and_b32 v99, -4, v99
    v_max_u32 v99, 4, v99
    v_and_b32 v97, 0xfffc, v48
    v_bfm_b32 v96, v88, v89
    v_add_u32_dpp v91, v99, v99 row_shr:1 row_mask:0xf bank_mask:0xf bound_ctrl:1
    v_mad_u32_u24 v97, v97, 5, v2
    v_cmp_lt_u32 vcc, 16, v99
    v_add_u32_dpp v91, v91, v91 row_shr:2 row_mask:0xf bank_mask:0xf bound_ctrl:1
    v_sub_u32 v98, s38, v99
    v_lshrrev_b64 v[48:49], 16, v[48:49]
    v_add_u32_dpp v91, v91, v91 row_shr:4 row_mask:0xf bank_mask:0xf bound_ctrl:1
    v_lshrrev_b64 v[56:57], 16, v[56:57]
    s_mov_b32 s101, 0
    v_add_u32_dpp v91, v91, v91 row_shr:8 row_mask:0xf bank_mask:0xf bound_ctrl:1
    s_nop 1
    v_add_u32_dpp v91, v91, v91 row_bcast:15 row_mask:0xa bank_mask:0xf
    s_nop 1
    v_add_u32_dpp v91, v91, v91 row_bcast:31 row_mask:0xc bank_mask:0xf
    v_add_u32 v98, v98, v91
    v_readlane_b32 s37, v91, 63
    s_cbranch_vccnz L2_xo50
L2_xp50:
    s_waitcnt lgkmcnt(0)
    v_cmp_ne_u64 s[50:51], v[72:73], v[68:69]
    v_cmpx_ne_u64 s[54:55], v[74:75], v[70:71]
    s_and_b64 s[82:83], s[54:55], s[80:81]
    s_cbranch_scc1 L2_c51
L2_d51:
    v_mov_b64 v[84:85], v[70:71]
    v_mov_b32 v7, v93
    v_mov_b64 v[86:87], v[74:75]
    s_or_b64 s[80:81], s[80:81], s[54:55]
    s_mov_b64 exec, s[50:51]
    s_and_b64 s[82:83], s[50:51], s[80:81]
    s_cbranch_scc1 L2_c52
L2_d52:
    v_mov_b64 v[84:85], v[68:69]
    v_mov_b32 v7, v92
    v_mov_b64 v[86:87], v[72:73]
    s_mov_b64 exec, -1
    s_or_b64 s[80:81], s[80:81], s[50:51]
    ds_read_b64 v[70:71], v95 offset:65408
    ds_read_b64 v[68:69], v94 offset:65408
    s_waitcnt vmcnt(11)
    v_and_b32 v46, 0x20000000, v27
    v_lshrrev_b32 v47, 14, v23
    v_bitop3_b32 v47, v47, v5, v46 bitop3:0xea
    ds_read_b64 v[102:103], v47
    v_bitop3_b32 v93, v23, v5, v46 bitop3:0xea
    v_and_b32 v46, 0x10000000, v27
    v_lshrrev_b32 v47, 14, v22
    v_bitop3_b32 v47, v47, v5, v46 bitop3:0xea
    ds_read_b64 v[100:101], v47
    v_bitop3_b32 v92, v22, v5, v46 bitop3:0xea
    s_waitcnt lgkmcnt(2)
    v_mfma_f32_4x4x4_16b_bf16 v[80:83], v[10:11], v[70:71], v[80:83]
    v_mfma_f32_4x4x4_16b_bf16 v[76:79], v[10:11], v[68:69], v[76:79]
    v_perm_b32 v15, v23, v26, s45
    v_bitop3_b32 v46, v23, 0.5, -0.5 bitop3:0xa8
    v_perm_b32 v14, v22, v26, s44
    v_bitop3_b32 v47, v22, 0.5, -0.5 bitop3:0xa8
    v_cvt_pk_bf16_f32 v80, v80, v81
    v_cvt_pk_bf16_f32 v81, v82, v83
    ds_wrxchg_rtn_b64 v[74:75], v95, v[80:81] offset:65408
    v_cvt_pk_bf16_f32 v76, v76, v77
    v_cvt_pk_bf16_f32 v77, v78, v79
    ds_wrxchg_rtn_b64 v[72:73], v94, v[76:77] offset:65408
    s_waitcnt lgkmcnt(2)
    v_mfma_f32_4x4x4_16b_bf16 v[80:83], v[8:9], v[102:103], 0
    v_mfma_f32_4x4x4_16b_bf16 v[76:79], v[8:9], v[100:101], 0
    v_bitop3_b32 v15, v6, v15, v46 bitop3:0xca
    v_bitop3_b32 v14, v6, v14, v47 bitop3:0xca
    v_cmp_lt_u32 s[84:85], v5, v92
    s_nop 0
    v_pk_mul_f32 v[80:81], v[80:81], v[14:15] op_sel:[0,1] op_sel_hi:[1,1]
    v_pk_mul_f32 v[82:83], v[82:83], v[14:15] op_sel:[0,1] op_sel_hi:[1,1]
    v_pk_mul_f32 v[76:77], v[76:77], v[14:15] op_sel:[0,0] op_sel_hi:[1,0]
    v_pk_mul_f32 v[78:79], v[78:79], v[14:15] op_sel:[0,0] op_sel_hi:[1,0]
    s_waitcnt lgkmcnt(0)
    v_cmp_ne_u64 s[50:51], v[72:73], v[68:69]
    v_cmpx_ne_u64 s[54:55], v[74:75], v[70:71]
    s_and_b64 s[82:83], s[54:55], s[80:81]
    s_cbranch_scc1 L2_c53
L2_d53:
    v_mov_b64 v[84:85], v[70:71]
    v_mov_b32 v7, v95
    v_mov_b64 v[86:87], v[74:75]
    s_or_b64 s[80:81], s[80:81], s[54:55]
    s_mov_b64 exec, s[50:51]
    s_and_b64 s[82:83], s[50:51], s[80:81]
    s_cbranch_scc1 L2_c54
L2_d54:
    v_mov_b64 v[84:85], v[68:69]
    v_mov_b32 v7, v94
    v_mov_b64 v[86:87], v[72:73]
    s_mov_b64 exec, -1
    s_or_b64 s[80:81], s[80:81], s[50:51]
    ds_read_b64 v[70:71], v93 offset:65408
    s_and_b64 exec, s[84:85], s[80:81]
    v_mfma_f32_4x4x4_16b_bf16 v[76:79], v[12:13], v[84:85], 0
    v_mov_b32 v92, v7
    s_andn2_b64 s[80:81], s[80:81], s[84:85]
    v_mfma_f32_4x4x4_16b_bf16 v[76:79], v[10:11], v[86:87], v[76:79]
    s_mov_b64 exec, -1
    ds_read_b64 v[68:69], v92 offset:65408
    v_and_b32 v46, 0x80000000, v27
    v_lshrrev_b32 v47, 14, v25
    v_bitop3_b32 v47, v47, v5, v46 bitop3:0xea
    ds_read_b64 v[106:107], v47
    v_bitop3_b32 v95, v25, v5, v46 bitop3:0xea
    v_and_b32 v46, 0x40000000, v27
    v_lshrrev_b32 v47, 14, v24
    v_bitop3_b32 v47, v47, v5, v46 bitop3:0xea
    ds_read_b64 v[104:105], v47
    v_bitop3_b32 v94, v24, v5, v46 bitop3:0xea
    s_waitcnt lgkmcnt(2)
    v_mfma_f32_4x4x4_16b_bf16 v[80:83], v[10:11], v[70:71], v[80:83]
    v_mfma_f32_4x4x4_16b_bf16 v[76:79], v[10:11], v[68:69], v[76:79]
    v_perm_b32 v15, v25, v26, s47
    v_bitop3_b32 v46, v25, 0.5, -0.5 bitop3:0xa8
    v_perm_b32 v14, v24, v26, s46
    v_bitop3_b32 v47, v24, 0.5, -0.5 bitop3:0xa8
    v_cvt_pk_bf16_f32 v80, v80, v81
    v_cvt_pk_bf16_f32 v81, v82, v83
    ds_wrxchg_rtn_b64 v[74:75], v93, v[80:81] offset:65408
    v_cvt_pk_bf16_f32 v76, v76, v77
    v_cvt_pk_bf16_f32 v77, v78, v79
    ds_wrxchg_rtn_b64 v[72:73], v92, v[76:77] offset:65408
    v_and_b32 v88, 0x0fffffff, v41
    v_mov_b32 v27, v41
    buffer_load_dwordx2 v[22:23], v88, s[8:11], 0 offen
    buffer_load_dwordx3 v[24:26], v88, s[8:11], 0 offen offset:8
    s_setprio 1
    s_waitcnt lgkmcnt(2)
    v_mfma_f32_4x4x4_16b_bf16 v[80:83], v[8:9], v[106:107], 0
    v_mfma_f32_4x4x4_16b_bf16 v[76:79], v[8:9], v[104:105], 0
    v_bitop3_b32 v15, v6, v15, v46 bitop3:0xca
    v_bitop3_b32 v14, v6, v14, v47 bitop3:0xca
    s_nop 1
    v_pk_mul_f32 v[80:81], v[80:81], v[14:15] op_sel:[0,1] op_sel_hi:[1,1]
    v_pk_mul_f32 v[82:83], v[82:83], v[14:15] op_sel:[0,1] op_sel_hi:[1,1]
    v_pk_mul_f32 v[76:77], v[76:77], v[14:15] op_sel:[0,0] op_sel_hi:[1,0]
    v_pk_mul_f32 v[78:79], v[78:79], v[14:15] op_sel:[0,0] op_sel_hi:[1,0]
    s_waitcnt lgkmcnt(0)
    v_cmp_ne_u64 s[50:51], v[72:73], v[68:69]
    v_cmpx_ne_u64 s[54:55], v[74:75], v[70:71]
    s_and_b64 s[82:83], s[54:55], s[80:81]
    s_cbranch_scc1 L2_c55
L2_d55:
    v_mov_b64 v[84:85], v[70:71]
    v_mov_b32 v7, v93
    v_mov_b64 v[86:87], v[74:75]
    s_or_b64 s[80:81], s[80:81], s[54:55]
    s_mov_b64 exec, s[50:51]
    s_and_b64 s[82:83], s[50:51], s[80:81]
    s_cbranch_scc1 L2_c56
L2_d56:
    v_mov_b64 v[84:85], v[68:69]
    v_mov_b32 v7, v92
    v_mov_b64 v[86:87], v[72:73]
    s_mov_b64 exec, -1
    s_or_b64 s[80:81], s[80:81], s[50:51]
    ds_read_b64 v[70:71], v95 offset:65408
    ds_read_b64 v[68:69], v94 offset:65408
    s_waitcnt vmcnt(11)
    v_and_b32 v46, 0x20000000, v33
    v_lshrrev_b32 v47, 14, v29
    v_bitop3_b32 v47, v47, v5, v46 bitop3:0xea
    ds_read_b64 v[102:103], v47
    v_bitop3_b32 v93, v29, v5, v46 bitop3:0xea
    v_and_b32 v46, 0x10000000, v33
    v_lshrrev_b32 v47, 14, v28
    v_bitop3_b32 v47, v47, v5, v46 bitop3:0xea
    ds_read_b64 v[100:101], v47
    v_bitop3_b32 v92, v28, v5, v46 bitop3:0xea
    s_waitcnt lgkmcnt(2)
    v_mfma_f32_4x4x4_16b_bf16 v[80:83], v[10:11], v[70:71], v[80:83]
    v_mfma_f32_4x4x4_16b_bf16 v[76:79], v[10:11], v[68:69], v[76:79]
    v_perm_b32 v15, v29, v32, s45
    v_bitop3_b32 v46, v29, 0.5, -0.5 bitop3:0xa8
    v_perm_b32 v14, v28, v32, s44
    v_bitop3_b32 v47, v28, 0.5, -0.5 bitop3:0xa8
    v_cvt_pk_bf16_f32 v80, v80, v81
    v_cvt_pk_bf16_f32 v81, v82, v83
    ds_wrxchg_rtn_b64 v[74:75], v95, v[80:81] offset:65408
    v_cvt_pk_bf16_f32 v76, v76, v77
    v_cvt_pk_bf16_f32 v77, v78, v79
    ds_wrxchg_rtn_b64 v[72:73], v94, v[76:77] offset:65408
    s_waitcnt lgkmcnt(2)
    v_mfma_f32_4x4x4_16b_bf16 v[80:83], v[8:9], v[102:103], 0
    v_mfma_f32_4x4x4_16b_bf16 v[76:79], v[8:9], v[100:101], 0
    v_bitop3_b32 v15, v6, v15, v46 bitop3:0xca
    v_bitop3_b32 v14, v6, v14, v47 bitop3:0xca
    v_cmp_lt_u32 s[84:85], v5, v92
    s_nop 0
    v_pk_mul_f32 v[80:81], v[80:81], v[14:15] op_sel:[0,1] op_sel_hi:[1,1]
    v_pk_mul_f32 v[82:83], v[82:83], v[14:15] op_sel:[0,1] op_sel_hi:[1,1]
    v_pk_mul_f32 v[76:77], v[76:77], v[14:15] op_sel:[0,0] op_sel_hi:[1,0]
    v_pk_mul_f32 v[78:79], v[78:79], v[14:15] op_sel:[0,0] op_sel_hi:[1,0]
    s_waitcnt lgkmcnt(0)
    v_cmp_ne_u64 s[50:51], v[72:73], v[68:69]
    v_cmpx_ne_u64 s[54:55], v[74:75], v[70:71]
    s_and_b64 s[82:83], s[54:55], s[80:81]
    s_cbranch_scc1 L2_c57
L2_d57:
    v_mov_b64 v[84:85], v[70:71]
    v_mov_b32 v7, v95
    v_mov_b64 v[86:87], v[74:75]
    s_or_b64 s[80:81], s[80:81], s[54:55]
    s_mov_b64 exec, s[50:51]
    s_and_b64 s[82:83], s[50:51], s[80:81]
    s_cbranch_scc1 L2_c58
L2_d58:
    v_mov_b64 v[84:85], v[68:69]
    v_mov_b32 v7, v94
    v_mov_b64 v[86:87], v[72:73]
    s_mov_b64 exec, -1
    s_or_b64 s[80:81], s[80:81], s[50:51]
    ds_read_b64 v[70:71], v93 offset:65408
    s_and_b64 exec, s[84:85], s[80:81]
    v_mfma_f32_4x4x4_16b_bf16 v[76:79], v[12:13], v[84:85], 0
    v_mov_b32 v92, v7
    s_andn2_b64 s[80:81], s[80:81], s[84:85]
    v_mfma_f32_4x4x4_16b_bf16 v[76:79], v[10:11], v[86:87], v[76:79]
    s_mov_b64 exec, -1
    ds_read_b64 v[68:69], v92 offset:65408
    v_and_b32 v46, 0x80000000, v33
    v_lshrrev_b32 v47, 14, v31
    v_bitop3_b32 v47, v47, v5, v46 bitop3:0xea
    ds_read_b64 v[106:107], v47
    v_bitop3_b32 v95, v31, v5, v46 bitop3:0xea
    v_and_b32 v46, 0x40000000, v33
    v_lshrrev_b32 v47, 14, v30
    v_bitop3_b32 v47, v47, v5, v46 bitop3:0xea
    ds_read_b64 v[104:105], v47
    v_bitop3_b32 v94, v30, v5, v46 bitop3:0xea
    s_waitcnt lgkmcnt(2)
    v_mfma_f32_4x4x4_16b_bf16 v[80:83], v[10:11], v[70:71], v[80:83]
    v_mfma_f32_4x4x4_16b_bf16 v[76:79], v[10:11], v[68:69], v[76:79]
    v_perm_b32 v15, v31, v32, s47
    v_bitop3_b32 v46, v31, 0.5, -0.5 bitop3:0xa8
    v_perm_b32 v14, v30, v32, s46
    v_bitop3_b32 v47, v30, 0.5, -0.5 bitop3:0xa8
    v_cvt_pk_bf16_f32 v80, v80, v81
    v_cvt_pk_bf16_f32 v81, v82, v83
    ds_wrxchg_rtn_b64 v[74:75], v93, v[80:81] offset:65408
    v_cvt_pk_bf16_f32 v76, v76, v77
    v_cvt_pk_bf16_f32 v77, v78, v79
    ds_wrxchg_rtn_b64 v[72:73], v92, v[76:77] offset:65408
    v_and_b32 v88, 0x0fffffff, v42
    v_mov_b32 v33, v42
    buffer_load_dwordx2 v[28:29], v88, s[8:11], 0 offen
    buffer_load_dwordx3 v[30:32], v88, s[8:11], 0 offen offset:8
    s_setprio 0
    s_waitcnt lgkmcnt(2)
    v_mfma_f32_4x4x4_16b_bf16 v[80:83], v[8:9], v[106:107], 0
    v_mfma_f32_4x4x4_16b_bf16 v[76:79], v[8:9], v[104:105], 0
    v_bitop3_b32 v15, v6, v15, v46 bitop3:0xca
    v_bitop3_b32 v14, v6, v14, v47 bitop3:0xca
    s_nop 1
    v_pk_mul_f32 v[80:81], v[80:81], v[14:15] op_sel:[0,1] op_sel_hi:[1,1]
    v_pk_mul_f32 v[82:83], v[82:83], v[14:15] op_sel:[0,1] op_sel_hi:[1,1]
    v_pk_mul_f32 v[76:77], v[76:77], v[14:15] op_sel:[0,0] op_sel_hi:[1,0]
    v_pk_mul_f32 v[78:79], v[78:79], v[14:15] op_sel:[0,0] op_sel_hi:[1,0]
    s_add_u32 s40, s40, 0xfff24000
    s_waitcnt lgkmcnt(0)
    v_cmp_ne_u64 s[50:51], v[72:73], v[68:69]
    v_cmpx_ne_u64 s[54:55], v[74:75], v[70:71]
    s_and_b64 s[82:83], s[54:55], s[80:81]
    s_cbranch_scc1 L2_c59
L2_d59:
    v_mov_b64 v[84:85], v[70:71]
    v_mov_b32 v7, v93
    v_mov_b64 v[86:87], v[74:75]
    s_or_b64 s[80:81], s[80:81], s[54:55]
    s_mov_b64 exec, s[50:51]
    s_and_b64 s[82:83], s[50:51], s[80:81]
    s_cbranch_scc1 L2_c60
L2_d60:
    v_mov_b64 v[84:85], v[68:69]
    v_mov_b32 v7, v92
    v_mov_b64 v[86:87], v[72:73]
    s_mov_b64 exec, -1
    s_or_b64 s[80:81], s[80:81], s[50:51]
    ds_read_b64 v[70:71], v95 offset:65408
    ds_read_b64 v[68:69], v94 offset:65408
    s_waitcnt vmcnt(8)
    v_and_b32 v46, 0x20000000, v39
    v_lshrrev_b32 v47, 14, v35
    v_bitop3_b32 v47, v47, v5, v46 bitop3:0xea
    ds_read_b64 v[102:103], v47
    v_bitop3_b32 v93, v35, v5, v46 bitop3:0xea
    v_and_b32 v46, 0x10000000, v39
    v_lshrrev_b32 v47, 14, v34
    v_bitop3_b32 v47, v47, v5, v46 bitop3:0xea
    ds_read_b64 v[100:101], v47
    v_bitop3_b32 v92, v34, v5, v46 bitop3:0xea
    v_and_b32 v46, 0x80000000, v39
    v_lshrrev_b32 v47, 14, v37
    v_bitop3_b32 v47, v47, v5, v46 bitop3:0xea
    ds_read_b64 v[106:107], v47
    v_and_b32 v46, 0x40000000, v39
    v_lshrrev_b32 v47, 14, v36
    v_bitop3_b32 v47, v47, v5, v46 bitop3:0xea
    ds_read_b64 v[104:105], v47
    s_waitcnt lgkmcnt(4)
    v_mfma_f32_4x4x4_16b_bf16 v[80:83], v[10:11], v[70:71], v[80:83]
    v_mfma_f32_4x4x4_16b_bf16 v[76:79], v[10:11], v[68:69], v[76:79]
    v_perm_b32 v15, v35, v38, s45
    v_bitop3_b32 v46, v35, 0.5, -0.5 bitop3:0xa8
    v_perm_b32 v14, v34, v38, s44
    v_bitop3_b32 v47, v34, 0.5, -0.5 bitop3:0xa8
    v_cvt_pk_bf16_f32 v80, v80, v81
    v_cvt_pk_bf16_f32 v81, v82, v83
    ds_wrxchg_rtn_b64 v[74:75], v95, v[80:81] offset:65408
    v_cvt_pk_bf16_f32 v76, v76, v77
    v_cvt_pk_bf16_f32 v77, v78, v79
    ds_wrxchg_rtn_b64 v[72:73], v94, v[76:77] offset:65408
    s_waitcnt lgkmcnt(2)
    s_barrier
    s_setprio 3
    s_mov_b32 m0, s100
    s_nop 0
    ds_write_addtid_b32 v116 offset:32768
    ds_write_addtid_b32 v117 offset:33024
    ds_write_addtid_b32 v118 offset:33280
    ds_write_addtid_b32 v119 offset:33536
    buffer_load_dwordx4 v[116:119], v3, s[16:19], s40 offen offset:2048
    ds_write_addtid_b32 v120 offset:33792
    ds_write_addtid_b32 v121 offset:34048
    ds_write_addtid_b32 v122 offset:34304
    ds_write_addtid_b32 v123 offset:34560
    buffer_load_dwordx4 v[120:123], v3, s[16:19], s40 offen offset:3072
    v_mfma_f32_4x4x4_16b_bf16 v[80:83], v[8:9], v[102:103], 0
    v_mfma_f32_4x4x4_16b_bf16 v[76:79], v[8:9], v[100:101], 0
    v_bitop3_b32 v15, v6, v15, v46 bitop3:0xca
    v_bitop3_b32 v14, v6, v14, v47 bitop3:0xca
    v_cmp_lt_u32 s[84:85], v5, v92
    s_nop 0
    v_pk_mul_f32 v[80:81], v[80:81], v[14:15] op_sel:[0,1] op_sel_hi:[1,1]
    v_pk_mul_f32 v[82:83], v[82:83], v[14:15] op_sel:[0,1] op_sel_hi:[1,1]
    v_pk_mul_f32 v[76:77], v[76:77], v[14:15] op_sel:[0,0] op_sel_hi:[1,0]
    v_pk_mul_f32 v[78:79], v[78:79], v[14:15] op_sel:[0,0] op_sel_hi:[1,0]
    v_mov_b32 v44, v43
    s_cmp_gt_u32 s37, 1024
    s_cbranch_scc1 L2_xs61
    s_cmp_lg_u32 s101, 0
    s_cbranch_scc1 L2_xa61
L2_xb61:
    v_lshlrev_b32 v89, 16, v96
    v_add_u32 v90, 60, v97
    v_bitop3_b32 v90, v89, v45, v90 bitop3:0x6a
    ds_write_b32 v98, v90 offset:12
    v_lshlrev_b32 v89, 20, v96
    v_add_u32 v90, 40, v97
    v_bitop3_b32 v90, v89, v45, v90 bitop3:0x6a
    ds_write_b32 v98, v90 offset:8
    v_lshlrev_b32 v89, 24, v96
    v_add_u32 v90, 20, v97
    v_bitop3_b32 v90, v89, v45, v90 bitop3:0x6a
    ds_write_b32 v98, v90 offset:4
    v_lshlrev_b32 v89, 28, v96
    v_bitop3_b32 v90, v89, v45, v97 bitop3:0x6a
    ds_write_b32 v98, v90 offset:0
    v_mov_b32_dpp v91, v64 quad_perm:[0,0,0,0] row_mask:0xf bank_mask:0xf
    v_and_b32 v89, 3, v91
    v_and_b32 v97, 0xfffc, v91
    v_sub_u16_dpp v88, v64, v91 quad_perm:[2,2,2,2] row_mask:0xf bank_mask:0xf
    v_mad_u32_u24 v97, v97, 5, v4
    v_add_u32 v99, v88, v89
    v_bfm_b32 v96, v88, v89
    v_cmp_lt_u32 s[58:59], 16, v99
    v_lshlrev_b32 v89, v1, v96
    v_and_b32 v89, v45, v89
    v_cmp_ne_u32 vcc, 0, v89
    v_xor_b32 v90, v97, v89
    s_add_u32 s3, s37, s38
    v_mbcnt_lo_u32_b32 v98, vcc_lo, 0
    v_mbcnt_hi_u32_b32 v98, vcc_hi, v98
    s_bcnt1_i32_b64 s41, vcc
    v_lshl_add_u32 v98, v98, 2, s3
    s_mov_b64 exec, vcc
    ds_write_b32 v98, v90
    s_mov_b64 exec, -1
    s_lshl2_add_u32 s37, s41, s37
    s_cmp_lg_u64 s[58:59], 0
    s_cbranch_scc1 L2_xe61
L2_xr61:
    v_add_u32 v98, s37, v0
    v_mov_b32 v90, -1
    ds_write_b32 v98, v90
    ds_read2st64_b32 v[40:41], v0 offset0:0 offset1:1
    ds_read2st64_b32 v[42:43], v0 offset0:2 offset1:3
    s_sub_u32 s3, s37, 768
    s_cmp_gt_u32 s3, 256
    s_cbranch_scc1 L2_xf61
L2_xg61:
    s_setprio 2
    ds_write_addtid_b32 v124 offset:34816
    ds_write_addtid_b32 v125 offset:35072
    ds_write_addtid_b32 v126 offset:35328
    ds_write_addtid_b32 v127 offset:35584
    s_add_u32 s3, s40, 4096
    buffer_load_dwordx4 v[124:127], v3, s[16:19], s3 offen
    s_waitcnt lgkmcnt(14)
    v_cmp_ne_u64 s[50:51], v[72:73], v[68:69]
    v_cmpx_ne_u64 s[54:55], v[74:75], v[70:71]
    s_and_b64 s[82:83], s[54:55], s[80:81]
    s_cbranch_scc1 L2_c62
L2_d62:
    v_mov_b64 v[84:85], v[70:71]
    v_mov_b32 v7, v95
    v_mov_b64 v[86:87], v[74:75]
    s_or_b64 s[80:81], s[80:81], s[54:55]
    s_mov_b64 exec, s[50:51]
    s_and_b64 s[82:83], s[50:51], s[80:81]
    s_cbranch_scc1 L2_c63
L2_d63:
    v_mov_b64 v[84:85], v[68:69]
    v_mov_b32 v7, v94
    v_mov_b64 v[86:87], v[72:73]
    s_mov_b64 exec, -1
    s_or_b64 s[80:81], s[80:81], s[50:51]
    ds_read_b64 v[70:71], v93 offset:65408
    s_and_b64 exec, s[84:85], s[80:81]
    v_mfma_f32_4x4x4_16b_bf16 v[76:79], v[12:13], v[84:85], 0
    v_mov_b32 v92, v7
    s_andn2_b64 s[80:81], s[80:81], s[84:85]
    v_mfma_f32_4x4x4_16b_bf16 v[76:79], v[10:11], v[86:87], v[76:79]
    s_mov_b64 exec, -1
    ds_read_b64 v[68:69], v92 offset:65408
    s_setprio 1
    s_waitcnt vmcnt(10)
    s_mov_b32 m0, s38
    s_nop 0
    ds_write_addtid_b32 v108 offset:0
    ds_write_addtid_b32 v109 offset:256
    ds_write_addtid_b32 v110 offset:512
    ds_write_addtid_b32 v111 offset:768
    s_waitcnt lgkmcnt(4)
    v_mfma_f32_4x4x4_16b_bf16 v[80:83], v[10:11], v[70:71], v[80:83]
    v_mfma_f32_4x4x4_16b_bf16 v[76:79], v[10:11], v[68:69], v[76:79]
    v_and_b32 v46, 0x40000000, v39
    v_bitop3_b32 v94, v36, v5, v46 bitop3:0xea
    v_and_b32 v46, 0x80000000, v39
    v_bitop3_b32 v95, v37, v5, v46 bitop3:0xea
    v_perm_b32 v15, v37, v38, s47
    v_bitop3_b32 v46, v37, 0.5, -0.5 bitop3:0xa8
    v_perm_b32 v14, v36, v38, s46
    v_bitop3_b32 v47, v36, 0.5, -0.5 bitop3:0xa8
    v_cvt_pk_bf16_f32 v80, v80, v81
    v_cvt_pk_bf16_f32 v81, v82, v83
    ds_wrxchg_rtn_b64 v[74:75], v93, v[80:81] offset:65408
    v_cvt_pk_bf16_f32 v76, v76, v77
    v_cvt_pk_bf16_f32 v77, v78, v79
    ds_wrxchg_rtn_b64 v[72:73], v92, v[76:77] offset:65408
    v_and_b32 v88, 0x0fffffff, v44
    v_mov_b32 v39, v44
    buffer_load_dwordx2 v[34:35], v88, s[8:11], 0 offen
    buffer_load_dwordx3 v[36:38], v88, s[8:11], 0 offen offset:8
    s_setprio 0
    s_waitcnt vmcnt(11)
    ds_write_addtid_b32 v112 offset:1024
    ds_write_addtid_b32 v113 offset:1280
    ds_write_addtid_b32 v114 offset:1536
    ds_write_addtid_b32 v115 offset:1792
    v_mfma_f32_4x4x4_16b_bf16 v[80:83], v[8:9], v[106:107], 0
    v_mfma_f32_4x4x4_16b_bf16 v[76:79], v[8:9], v[104:105], 0
    v_bitop3_b32 v15, v6, v15, v46 bitop3:0xca
    v_bitop3_b32 v14, v6, v14, v47 bitop3:0xca
    s_nop 1
    v_pk_mul_f32 v[80:81], v[80:81], v[14:15] op_sel:[0,1] op_sel_hi:[1,1]
    v_pk_mul_f32 v[82:83], v[82:83], v[14:15] op_sel:[0,1] op_sel_hi:[1,1]
    v_pk_mul_f32 v[76:77], v[76:77], v[14:15] op_sel:[0,0] op_sel_hi:[1,0]
    v_pk_mul_f32 v[78:79], v[78:79], v[14:15] op_sel:[0,0] op_sel_hi:[1,0]
    s_add_u32 s42, s42, 1
    s_waitcnt lgkmcnt(0)
    s_barrier
    s_bitcmp1_b32 s36, s42
    s_cbranch_scc1 L2_slow
L2_ret3:
    s_setprio 3
    buffer_load_dwordx4 v[108:111], v3, s[16:19], s40 offen offset:0
    v_cmp_ne_u64 s[50:51], v[72:73], v[68:69]
    v_cmpx_ne_u64 s[54:55], v[74:75], v[70:71]
    s_and_b64 s[82:83], s[54:55], s[80:81]
    s_cbranch_scc1 L2_c64
L2_d64:
    v_mov_b64 v[84:85], v[70:71]
    v_mov_b32 v7, v93
    v_mov_b64 v[86:87], v[74:75]
    s_or_b64 s[80:81], s[80:81], s[54:55]
    s_mov_b64 exec, s[50:51]
    s_and_b64 s[82:83], s[50:51], s[80:81]
    s_cbranch_scc1 L2_c65
L2_d65:
    v_mov_b64 v[84:85], v[68:69]
    v_mov_b32 v7, v92
    v_mov_b64 v[86:87], v[72:73]
    s_mov_b64 exec, -1
    s_or_b64 s[80:81], s[80:81], s[50:51]
    ds_read_b64 v[70:71], v95 offset:65408
    ds_read_b64 v[68:69], v94 offset:65408
    s_waitcnt vmcnt(10)
    v_and_b32 v46, 0x20000000, v21
    v_lshrrev_b32 v47, 14, v17
    v_bitop3_b32 v47, v47, v5, v46 bitop3:0xea
    ds_read_b64 v[102:103], v47
    v_bitop3_b32 v93, v17, v5, v46 bitop3:0xea
    v_and_b32 v46, 0x10000000, v21
    v_lshrrev_b32 v47, 14, v16
    v_bitop3_b32 v47, v47, v5, v46 bitop3:0xea
    ds_read_b64 v[100:101], v47
    v_bitop3_b32 v92, v16, v5, v46 bitop3:0xea
    s_waitcnt lgkmcnt(2)
    v_mfma_f32_4x4x4_16b_bf16 v[80:83], v[10:11], v[70:71], v[80:83]
    v_mfma_f32_4x4x4_16b_bf16 v[76:79], v[10:11], v[68:69], v[76:79]
    v_perm_b32 v15, v17, v20, s45
    v_bitop3_b32 v46, v17, 0.5, -0.5 bitop3:0xa8
    v_perm_b32 v14, v16, v20, s44
    v_bitop3_b32 v47, v16, 0.5, -0.5 bitop3:0xa8
    v_cvt_pk_bf16_f32 v80, v80, v81
    v_cvt_pk_bf16_f32 v81, v82, v83
    ds_wrxchg_rtn_b64 v[74:75], v95, v[80:81] offset:65408
    v_cvt_pk_bf16_f32 v76, v76, v77
    v_cvt_pk_bf16_f32 v77, v78, v79
    ds_wrxchg_rtn_b64 v[72:73], v94, v[76:77] offset:65408
    s_waitcnt lgkmcnt(2)
    v_mfma_f32_4x4x4_16b_bf16 v[80:83], v[8:9], v[102:103], 0
    v_mfma_f32_4x4x4_16b_bf16 v[76:79], v[8:9], v[100:101], 0
    v_bitop3_b32 v15, v6, v15, v46 bitop3:0xca
    v_bitop3_b32 v14, v6, v14, v47 bitop3:0xca
    v_cmp_lt_u32 s[84:85], v5, v92
    s_nop 0
    v_pk_mul_f32 v[80:81], v[80:81], v[14:15] op_sel:[0,1] op_sel_hi:[1,1]
    v_pk_mul_f32 v[82:83], v[82:83], v[14:15] op_sel:[0,1] op_sel_hi:[1,1]
    v_pk_mul_f32 v[76:77], v[76:77], v[14:15] op_sel:[0,0] op_sel_hi:[1,0]
    v_pk_mul_f32 v[78:79], v[78:79], v[14:15] op_sel:[0,0] op_sel_hi:[1,0]
    buffer_load_dwordx4 v[112:115], v3, s[16:19], s40 offen offset:1024
    s_waitcnt lgkmcnt(0)
    v_cmp_ne_u64 s[50:51], v[72:73], v[68:69]
    v_cmpx_ne_u64 s[54:55], v[74:75], v[70:71]
    s_and_b64 s[82:83], s[54:55], s[80:81]
    s_cbranch_scc1 L2_c66
L2_d66:
    v_mov_b64 v[84:85], v[70:71]
    v_mov_b32 v7, v95
    v_mov_b64 v[86:87], v[74:75]
    s_or_b64 s[80:81], s[80:81], s[54:55]
    s_mov_b64 exec, s[50:51]
    s_and_b64 s[82:83], s[50:51], s[80:81]
    s_cbranch_scc1 L2_c67
L2_d67:
    v_mov_b64 v[84:85], v[68:69]
    v_mov_b32 v7, v94
    v_mov_b64 v[86:87], v[72:73]
    s_mov_b64 exec, -1
    s_or_b64 s[80:81], s[80:81], s[50:51]
    ds_read_b64 v[70:71], v93 offset:65408
    s_and_b64 exec, s[84:85], s[80:81]
    v_mfma_f32_4x4x4_16b_bf16 v[76:79], v[12:13], v[84:85], 0
    v_mov_b32 v92, v7
    s_andn2_b64 s[80:81], s[80:81], s[84:85]
    v_mfma_f32_4x4x4_16b_bf16 v[76:79], v[10:11], v[86:87], v[76:79]
    s_mov_b64 exec, -1
    ds_read_b64 v[68:69], v92 offset:65408
    v_and_b32 v46, 0x80000000, v21
    v_lshrrev_b32 v47, 14, v19
    v_bitop3_b32 v47, v47, v5, v46 bitop3:0xea
    ds_read_b64 v[106:107], v47
    v_bitop3_b32 v95, v19, v5, v46 bitop3:0xea
    v_and_b32 v46, 0x40000000, v21
    v_lshrrev_b32 v47, 14, v18
    v_bitop3_b32 v47, v47, v5, v46 bitop3:0xea
    ds_read_b64 v[104:105], v47
    v_bitop3_b32 v94, v18, v5, v46 bitop3:0xea
    s_waitcnt lgkmcnt(2)
    v_mfma_f32_4x4x4_16b_bf16 v[80:83], v[10:11], v[70:71], v[80:83]
    v_mfma_f32_4x4x4_16b_bf16 v[76:79], v[10:11], v[68:69], v[76:79]
    v_perm_b32 v15, v19, v20, s47
    v_bitop3_b32 v46, v19, 0.5, -0.5 bitop3:0xa8
    v_perm_b32 v14, v18, v20, s46
    v_bitop3_b32 v47, v18, 0.5, -0.5 bitop3:0xa8
    v_cvt_pk_bf16_f32 v80, v80, v81
    v_cvt_pk_bf16_f32 v81, v82, v83
    ds_wrxchg_rtn_b64 v[74:75], v93, v[80:81] offset:65408
    v_cvt_pk_bf16_f32 v76, v76, v77
    v_cvt_pk_bf16_f32 v77, v78, v79
    ds_wrxchg_rtn_b64 v[72:73], v92, v[76:77] offset:65408
    v_and_b32 v88, 0x0fffffff, v40
    v_mov_b32 v21, v40
    buffer_load_dwordx2 v[16:17], v88, s[8:11], 0 offen
    buffer_load_dwordx3 v[18:20], v88, s[8:11], 0 offen offset:8
    s_setprio 2
    s_waitcnt lgkmcnt(2)
    v_mfma_f32_4x4x4_16b_bf16 v[80:83], v[8:9], v[106:107], 0
    v_mfma_f32_4x4x4_16b_bf16 v[76:79], v[8:9], v[104:105], 0
    v_bitop3_b32 v15, v6, v15, v46 bitop3:0xca
    v_bitop3_b32 v14, v6, v14, v47 bitop3:0xca
    s_nop 1
    v_pk_mul_f32 v[80:81], v[80:81], v[14:15] op_sel:[0,1] op_sel_hi:[1,1]
    v_pk_mul_f32 v[82:83], v[82:83], v[14:15] op_sel:[0,1] op_sel_hi:[1,1]
    v_pk_mul_f32 v[76:77], v[76:77], v[14:15] op_sel:[0,0] op_sel_hi:[1,0]
    v_pk_mul_f32 v[78:79], v[78:79], v[14:15] op_sel:[0,0] op_sel_hi:[1,0]
    v_sub_u16 v88, v58, v50
    v_and_b32 v89, 3, v50
    v_add3_u32 v99, v88, v89, 3
    v_and_b32 v99, -4, v99
    v_max_u32 v99, 4, v99
    v_and_b32 v97, 0xfffc, v50
    v_bfm_b32 v96, v88, v89
    v_add_u32_dpp v91, v99, v99 row_shr:1 row_mask:0xf bank_mask:0xf bound_ctrl:1
    v_mad_u32_u24 v97, v97, 5, v2
    v_cmp_lt_u32 vcc, 16, v99
    v_add_u32_dpp v91, v91, v91 row_shr:2 row_mask:0xf bank_mask:0xf bound_ctrl:1
    v_sub_u32 v98, s38, v99
    v_lshrrev_b64 v[50:51], 16, v[50:51]
    v_add_u32_dpp v91, v91, v91 row_shr:4 row_mask:0xf bank_mask:0xf bound_ctrl:1
    v_lshrrev_b64 v[58:59], 16, v[58:59]
    s_mov_b32 s101, 0
    v_add_u32_dpp v91, v91, v91 row_shr:8 row_mask:0xf bank_mask:0xf bound_ctrl:1
    s_nop 1
    v_add_u32_dpp v91, v91, v91 row_bcast:15 row_mask:0xa bank_mask:0xf
    s_nop 1
    v_add_u32_dpp v91, v91, v91 row_bcast:31 row_mask:0xc bank_mask:0xf
    v_add_u32 v98, v98, v91
    v_readlane_b32 s37, v91, 63
    s_cbranch_vccnz L2_xo68
L2_xp68:
    s_waitcnt lgkmcnt(0)
    v_cmp_ne_u64 s[50:51], v[72:73], v[68:69]
    v_cmpx_ne_u64 s[54:55], v[74:75], v[70:71]
    s_and_b64 s[82:83], s[54:55], s[80:81]
    s_cbranch_scc1 L2_c69
L2_d69:
    v_mov_b64 v[84:85], v[70:71]
    v_mov_b32 v7, v93
    v_mov_b64 v[86:87], v[74:75]
    s_or_b64 s[80:81], s[80:81], s[54:55]
    s_mov_b64 exec, s[50:51]
    s_and_b64 s[82:83], s[50:51], s[80:81]
    s_cbranch_scc1 L2_c70
L2_d70:
    v_mov_b64 v[84:85], v[68:69]
    v_mov_b32 v7, v92
    v_mov_b64 v[86:87], v[72:73]
    s_mov_b64 exec, -1
    s_or_b64 s[80:81], s[80:81], s[50:51]
    ds_read_b64 v[70:71], v95 offset:65408
    ds_read_b64 v[68:69], v94 offset:65408
    s_waitcnt vmcnt(11)
    v_and_b32 v46, 0x20000000, v27
    v_lshrrev_b32 v47, 14, v23
    v_bitop3_b32 v47, v47, v5, v46 bitop3:0xea
    ds_read_b64 v[102:103], v47
    v_bitop3_b32 v93, v23, v5, v46 bitop3:0xea
    v_and_b32 v46, 0x10000000, v27
    v_lshrrev_b32 v47, 14, v22
    v_bitop3_b32 v47, v47, v5, v46 bitop3:0xea
    ds_read_b64 v[100:101], v47
    v_bitop3_b32 v92, v22, v5, v46 bitop3:0xea
    s_waitcnt lgkmcnt(2)
    v_mfma_f32_4x4x4_16b_bf16 v[80:83], v[10:11], v[70:71], v[80:83]
    v_mfma_f32_4x4x4_16b_bf16 v[76:79], v[10:11], v[68:69], v[76:79]
    v_perm_b32 v15, v23, v26, s45
    v_bitop3_b32 v46, v23, 0.5, -0.5 bitop3:0xa8
    v_perm_b32 v14, v22, v26, s44
    v_bitop3_b32 v47, v22, 0.5, -0.5 bitop3:0xa8
    v_cvt_pk_bf16_f32 v80, v80, v81
    v_cvt_pk_bf16_f32 v81, v82, v83
    ds_wrxchg_rtn_b64 v[74:75], v95, v[80:81] offset:65408
    v_cvt_pk_bf16_f32 v76, v76, v77
    v_cvt_pk_bf16_f32 v77, v78, v79
    ds_wrxchg_rtn_b64 v[72:73], v94, v[76:77] offset:65408
    s_waitcnt lgkmcnt(2)
    v_mfma_f32_4x4x4_16b_bf16 v[80:83], v[8:9], v[102:103], 0
    v_mfma_f32_4x4x4_16b_bf16 v[76:79], v[8:9], v[100:101], 0
    v_bitop3_b32 v15, v6, v15, v46 bitop3:0xca
    v_bitop3_b32 v14, v6, v14, v47 bitop3:0xca
    v_cmp_lt_u32 s[84:85], v5, v92
    s_nop 0
    v_pk_mul_f32 v[80:81], v[80:81], v[14:15] op_sel:[0,1] op_sel_hi:[1,1]
    v_pk_mul_f32 v[82:83], v[82:83], v[14:15] op_sel:[0,1] op_sel_hi:[1,1]
    v_pk_mul_f32 v[76:77], v[76:77], v[14:15] op_sel:[0,0] op_sel_hi:[1,0]
    v_pk_mul_f32 v[78:79], v[78:79], v[14:15] op_sel:[0,0] op_sel_hi:[1,0]
    s_waitcnt lgkmcnt(0)
    v_cmp_ne_u64 s[50:51], v[72:73], v[68:69]
    v_cmpx_ne_u64 s[54:55], v[74:75], v[70:71]
    s_and_b64 s[82:83], s[54:55], s[80:81]
    s_cbranch_scc1 L2_c71
L2_d71:
    v_mov_b64 v[84:85], v[70:71]
    v_mov_b32 v7, v95
    v_mov_b64 v[86:87], v[74:75]
    s_or_b64 s[80:81], s[80:81], s[54:55]
    s_mov_b64 exec, s[50:51]
    s_and_b64 s[82:83], s[50:51], s[80:81]
    s_cbranch_scc1 L2_c72
L2_d72:
    v_mov_b64 v[84:85], v[68:69]
    v_mov_b32 v7, v94
    v_mov_b64 v[86:87], v[72:73]
    s_mov_b64 exec, -1
    s_or_b64 s[80:81], s[80:81], s[50:51]
    ds_read_b64 v[70:71], v93 offset:65408
    s_and_b64 exec, s[84:85], s[80:81]
    v_mfma_f32_4x4x4_16b_bf16 v[76:79], v[12:13], v[84:85], 0
    v_mov_b32 v92, v7
    s_andn2_b64 s[80:81], s[80:81], s[84:85]
    v_mfma_f32_4x4x4_16b_bf16 v[76:79], v[10:11], v[86:87], v[76:79]
    s_mov_b64 exec, -1
    ds_read_b64 v[68:69], v92 offset:65408
    v_and_b32 v46, 0x80000000, v27
    v_lshrrev_b32 v47, 14, v25
    v_bitop3_b32 v47, v47, v5, v46 bitop3:0xea
    ds_read_b64 v[106:107], v47
    v_bitop3_b32 v95, v25, v5, v46 bitop3:0xea
    v_and_b32 v46, 0x40000000, v27
    v_lshrrev_b32 v47, 14, v24
    v_bitop3_b32 v47, v47, v5, v46 bitop3:0xea
    ds_read_b64 v[104:105], v47
    v_bitop3_b32 v94, v24, v5, v46 bitop3:0xea
    s_waitcnt lgkmcnt(2)
    v_mfma_f32_4x4x4_16b_bf16 v[80:83], v[10:11], v[70:71], v[80:83]
    v_mfma_f32_4x4x4_16b_bf16 v[76:79], v[10:11], v[68:69], v[76:79]
    v_perm_b32 v15, v25, v26, s47
    v_bitop3_b32 v46, v25, 0.5, -0.5 bitop3:0xa8
    v_perm_b32 v14, v24, v26, s46
    v_bitop3_b32 v47, v24, 0.5, -0.5 bitop3:0xa8
    v_cvt_pk_bf16_f32 v80, v80, v81
    v_cvt_pk_bf16_f32 v81, v82, v83
    ds_wrxchg_rtn_b64 v[74:75], v93, v[80:81] offset:65408
    v_cvt_pk_bf16_f32 v76, v76, v77
    v_cvt_pk_bf16_f32 v77, v78, v79
    ds_wrxchg_rtn_b64 v[72:73], v92, v[76:77] offset:65408
    v_and_b32 v88, 0x0fffffff, v41
    v_mov_b32 v27, v41
    buffer_load_dwordx2 v[22:23], v88, s[8:11], 0 offen
    buffer_load_dwordx3 v[24:26], v88, s[8:11], 0 offen offset:8
    s_setprio 1
    s_waitcnt lgkmcnt(2)
    v_mfma_f32_4x4x4_16b_bf16 v[80:83], v[8:9], v[106:107], 0
    v_mfma_f32_4x4x4_16b_bf16 v[76:79], v[8:9], v[104:105], 0
    v_bitop3_b32 v15, v6, v15, v46 bitop3:0xca
    v_bitop3_b32 v14, v6, v14, v47 bitop3:0xca
    s_nop 1
    v_pk_mul_f32 v[80:81], v[80:81], v[14:15] op_sel:[0,1] op_sel_hi:[1,1]
    v_pk_mul_f32 v[82:83], v[82:83], v[14:15] op_sel:[0,1] op_sel_hi:[1,1]
    v_pk_mul_f32 v[76:77], v[76:77], v[14:15] op_sel:[0,0] op_sel_hi:[1,0]
    v_pk_mul_f32 v[78:79], v[78:79], v[14:15] op_sel:[0,0] op_sel_hi:[1,0]
    s_waitcnt lgkmcnt(0)
    v_cmp_ne_u64 s[50:51], v[72:73], v[68:69]
    v_cmpx_ne_u64 s[54:55], v[74:75], v[70:71]
    s_and_b64 s[82:83], s[54:55], s[80:81]
    s_cbranch_scc1 L2_c73
L2_d73:
    v_mov_b64 v[84:85], v[70:71]
    v_mov_b32 v7, v93
    v_mov_b64 v[86:87], v[74:75]
    s_or_b64 s[80:81], s[80:81], s[54:55]
    s_mov_b64 exec, s[50:51]
    s_and_b64 s[82:83], s[50:51], s[80:81]
    s_cbranch_scc1 L2_c74
L2_d74:
    v_mov_b64 v[84:85], v[68:69]
    v_mov_b32 v7, v92
    v_mov_b64 v[86:87], v[72:73]
    s_mov_b64 exec, -1
    s_or_b64 s[80:81], s[80:81], s[50:51]
    ds_read_b64 v[70:71], v95 offset:65408
    ds_read_b64 v[68:69], v94 offset:65408
    s_waitcnt vmcnt(11)
    v_and_b32 v46, 0x20000000, v33
    v_lshrrev_b32 v47, 14, v29
    v_bitop3_b32 v47, v47, v5, v46 bitop3:0xea
    ds_read_b64 v[102:103], v47
    v_bitop3_b32 v93, v29, v5, v46 bitop3:0xea
    v_and_b32 v46, 0x10000000, v33
    v_lshrrev_b32 v47, 14, v28
    v_bitop3_b32 v47, v47, v5, v46 bitop3:0xea
    ds_read_b64 v[100:101], v47
    v_bitop3_b32 v92, v28, v5, v46 bitop3:0xea
    s_waitcnt lgkmcnt(2)
    v_mfma_f32_4x4x4_16b_bf16 v[80:83], v[10:11], v[70:71], v[80:83]
    v_mfma_f32_4x4x4_16b_bf16 v[76:79], v[10:11], v[68:69], v[76:79]
    v_perm_b32 v15, v29, v32, s45
    v_bitop3_b32 v46, v29, 0.5, -0.5 bitop3:0xa8
    v_perm_b32 v14, v28, v32, s44
    v_bitop3_b32 v47, v28, 0.5, -0.5 bitop3:0xa8
    v_cvt_pk_bf16_f32 v80, v80, v81
    v_cvt_pk_bf16_f32 v81, v82, v83
    ds_wrxchg_rtn_b64 v[74:75], v95, v[80:81] offset:65408
    v_cvt_pk_bf16_f32 v76, v76, v77
    v_cvt_pk_bf16_f32 v77, v78, v79
    ds_wrxchg_rtn_b64 v[72:73], v94, v[76:77] offset:65408
    s_waitcnt lgkmcnt(2)
    v_mfma_f32_4x4x4_16b_bf16 v[80:83], v[8:9], v[102:103], 0
    v_mfma_f32_4x4x4_16b_bf16 v[76:79], v[8:9], v[100:101], 0
    v_bitop3_b32 v15, v6, v15, v46 bitop3:0xca
    v_bitop3_b32 v14, v6, v14, v47 bitop3:0xca
    v_cmp_lt_u32 s[84:85], v5, v92
    s_nop 0
    v_pk_mul_f32 v[80:81], v[80:81], v[14:15] op_sel:[0,1] op_sel_hi:[1,1]
    v_pk_mul_f32 v[82:83], v[82:83], v[14:15] op_sel:[0,1] op_sel_hi:[1,1]
    v_pk_mul_f32 v[76:77], v[76:77], v[14:15] op_sel:[0,0] op_sel_hi:[1,0]
    v_pk_mul_f32 v[78:79], v[78:79], v[14:15] op_sel:[0,0] op_sel_hi:[1,0]
    s_waitcnt lgkmcnt(0)
    v_cmp_ne_u64 s[50:51], v[72:73], v[68:69]
    v_cmpx_ne_u64 s[54:55], v[74:75], v[70:71]
    s_and_b64 s[82:83], s[54:55], s[80:81]
    s_cbranch_scc1 L2_c75
L2_d75:
    v_mov_b64 v[84:85], v[70:71]
    v_mov_b32 v7, v95
    v_mov_b64 v[86:87], v[74:75]
    s_or_b64 s[80:81], s[80:81], s[54:55]
    s_mov_b64 exec, s[50:51]
    s_and_b64 s[82:83], s[50:51], s[80:81]
    s_cbranch_scc1 L2_c76
L2_d76:
    v_mov_b64 v[84:85], v[68:69]
    v_mov_b32 v7, v94
    v_mov_b64 v[86:87], v[72:73]
    s_mov_b64 exec, -1
    s_or_b64 s[80:81], s[80:81], s[50:51]
    ds_read_b64 v[70:71], v93 offset:65408
    s_and_b64 exec, s[84:85], s[80:81]
    v_mfma_f32_4x4x4_16b_bf16 v[76:79], v[12:13], v[84:85], 0
    v_mov_b32 v92, v7
    s_andn2_b64 s[80:81], s[80:81], s[84:85]
    v_mfma_f32_4x4x4_16b_bf16 v[76:79], v[10:11], v[86:87], v[76:79]
    s_mov_b64 exec, -1
    ds_read_b64 v[68:69], v92 offset:65408
    v_and_b32 v46, 0x80000000, v33
    v_lshrrev_b32 v47, 14, v31
    v_bitop3_b32 v47, v47, v5, v46 bitop3:0xea
    ds_read_b64 v[106:107], v47
    v_bitop3_b32 v95, v31, v5, v46 bitop3:0xea
    v_and_b32 v46, 0x40000000, v33
    v_lshrrev_b32 v47, 14, v30
    v_bitop3_b32 v47, v47, v5, v46 bitop3:0xea
    ds_read_b64 v[104:105], v47
    v_bitop3_b32 v94, v30, v5, v46 bitop3:0xea
    s_waitcnt lgkmcnt(2)
    v_mfma_f32_4x4x4_16b_bf16 v[80:83], v[10:11], v[70:71], v[80:83]
    v_mfma_f32_4x4x4_16b_bf16 v[76:79], v[10:11], v[68:69], v[76:79]
    v_perm_b32 v15, v31, v32, s47
    v_bitop3_b32 v46, v31, 0.5, -0.5 bitop3:0xa8
    v_perm_b32 v14, v30, v32, s46
    v_bitop3_b32 v47, v30, 0.5, -0.5 bitop3:0xa8
    v_cvt_pk_bf16_f32 v80, v80, v81
    v_cvt_pk_bf16_f32 v81, v82, v83
    ds_wrxchg_rtn_b64 v[74:75], v93, v[80:81] offset:65408
    v_cvt_pk_bf16_f32 v76, v76, v77
    v_cvt_pk_bf16_f32 v77, v78, v79
    ds_wrxchg_rtn_b64 v[72:73], v92, v[76:77] offset:65408
    v_and_b32 v88, 0x0fffffff, v42
    v_mov_b32 v33, v42
    buffer_load_dwordx2 v[28:29], v88, s[8:11], 0 offen
    buffer_load_dwordx3 v[30:32], v88, s[8:11], 0 offen offset:8
    s_setprio 0
    s_waitcnt lgkmcnt(2)
    v_mfma_f32_4x4x4_16b_bf16 v[80:83], v[8:9], v[106:107], 0
    v_mfma_f32_4x4x4_16b_bf16 v[76:79], v[8:9], v[104:105], 0
    v_bitop3_b32 v15, v6, v15, v46 bitop3:0xca
    v_bitop3_b32 v14, v6, v14, v47 bitop3:0xca
    s_nop 1
    v_pk_mul_f32 v[80:81], v[80:81], v[14:15] op_sel:[0,1] op_sel_hi:[1,1]
    v_pk_mul_f32 v[82:83], v[82:83], v[14:15] op_sel:[0,1] op_sel_hi:[1,1]
    v_pk_mul_f32 v[76:77], v[76:77], v[14:15] op_sel:[0,0] op_sel_hi:[1,0]
    v_pk_mul_f32 v[78:79], v[78:79], v[14:15] op_sel:[0,0] op_sel_hi:[1,0]
    s_add_u32 s40, s40, 0x50000
    s_waitcnt lgkmcnt(0)
    v_cmp_ne_u64 s[50:51], v[72:73], v[68:69]
    v_cmpx_ne_u64 s[54:55], v[74:75], v[70:71]
    s_and_b64 s[82:83], s[54:55], s[80:81]
    s_cbranch_scc1 L2_c77
L2_d77:
    v_mov_b64 v[84:85], v[70:71]
    v_mov_b32 v7, v93
    v_mov_b64 v[86:87], v[74:75]
    s_or_b64 s[80:81], s[80:81], s[54:55]
    s_mov_b64 exec, s[50:51]
    s_and_b64 s[82:83], s[50:51], s[80:81]
    s_cbranch_scc1 L2_c78
L2_d78:
    v_mov_b64 v[84:85], v[68:69]
    v_mov_b32 v7, v92
    v_mov_b64 v[86:87], v[72:73]
    s_mov_b64 exec, -1
    s_or_b64 s[80:81], s[80:81], s[50:51]
    ds_read_b64 v[70:71], v95 offset:65408
    ds_read_b64 v[68:69], v94 offset:65408
    s_waitcnt vmcnt(8)
    v_and_b32 v46, 0x20000000, v39
    v_lshrrev_b32 v47, 14, v35
    v_bitop3_b32 v47, v47, v5, v46 bitop3:0xea
    ds_read_b64 v[102:103], v47
    v_bitop3_b32 v93, v35, v5, v46 bitop3:0xea
    v_and_b32 v46, 0x10000000, v39
    v_lshrrev_b32 v47, 14, v34
    v_bitop3_b32 v47, v47, v5, v46 bitop3:0xea
    ds_read_b64 v[100:101], v47
    v_bitop3_b32 v92, v34, v5, v46 bitop3:0xea
    v_and_b32 v46, 0x80000000, v39
    v_lshrrev_b32 v47, 14, v37
    v_bitop3_b32 v47, v47, v5, v46 bitop3:0xea
    ds_read_b64 v[106:107], v47
    v_and_b32 v46, 0x40000000, v39
    v_lshrrev_b32 v47, 14, v36
    v_bitop3_b32 v47, v47, v5, v46 bitop3:0xea
    ds_read_b64 v[104:105], v47
    s_waitcnt lgkmcnt(4)
    v_mfma_f32_4x4x4_16b_bf16 v[80:83], v[10:11], v[70:71], v[80:83]
    v_mfma_f32_4x4x4_16b_bf16 v[76:79], v[10:11], v[68:69], v[76:79]
    v_perm_b32 v15, v35, v38, s45
    v_bitop3_b32 v46, v35, 0.5, -0.5 bitop3:0xa8
    v_perm_b32 v14, v34, v38, s44
    v_bitop3_b32 v47, v34, 0.5, -0.5 bitop3:0xa8
    v_cvt_pk_bf16_f32 v80, v80, v81
    v_cvt_pk_bf16_f32 v81, v82, v83
    ds_wrxchg_rtn_b64 v[74:75], v95, v[80:81] offset:65408
    v_cvt_pk_bf16_f32 v76, v76, v77
    v_cvt_pk_bf16_f32 v77, v78, v79
    ds_wrxchg_rtn_b64 v[72:73], v94, v[76:77] offset:65408
    s_waitcnt lgkmcnt(2)
    s_barrier
    s_setprio 3
    s_mov_b32 m0, s100
    s_nop 0
    ds_write_addtid_b32 v116 offset:32768
    ds_write_addtid_b32 v117 offset:33024
    ds_write_addtid_b32 v118 offset:33280
    ds_write_addtid_b32 v119 offset:33536
    buffer_load_dwordx4 v[116:119], v3, s[16:19], s40 offen offset:2048
    ds_write_addtid_b32 v120 offset:33792
    ds_write_addtid_b32 v121 offset:34048
    ds_write_addtid_b32 v122 offset:34304
    ds_write_addtid_b32 v123 offset:34560
    buffer_load_dwordx4 v[120:123], v3, s[16:19], s40 offen offset:3072
    v_mfma_f32_4x4x4_16b_bf16 v[80:83], v[8:9], v[102:103], 0
    v_mfma_f32_4x4x4_16b_bf16 v[76:79], v[8:9], v[100:101], 0
    v_bitop3_b32 v15, v6, v15, v46 bitop3:0xca
    v_bitop3_b32 v14, v6, v14, v47 bitop3:0xca
    v_cmp_lt_u32 s[84:85], v5, v92
    s_nop 0
    v_pk_mul_f32 v[80:81], v[80:81], v[14:15] op_sel:[0,1] op_sel_hi:[1,1]
    v_pk_mul_f32 v[82:83], v[82:83], v[14:15] op_sel:[0,1] op_sel_hi:[1,1]
    v_pk_mul_f32 v[76:77], v[76:77], v[14:15] op_sel:[0,0] op_sel_hi:[1,0]
    v_pk_mul_f32 v[78:79], v[78:79], v[14:15] op_sel:[0,0] op_sel_hi:[1,0]
    v_mov_b32 v44, v43
    s_cmp_gt_u32 s37, 1024
    s_cbranch_scc1 L2_xs79
    s_cmp_lg_u32 s101, 0
    s_cbranch_scc1 L2_xa79
L2_xb79:
    v_lshlrev_b32 v89, 16, v96
    v_add_u32 v90, 60, v97
    v_bitop3_b32 v90, v89, v45, v90 bitop3:0x6a
    ds_write_b32 v98, v90 offset:12
    v_lshlrev_b32 v89, 20, v96
    v_add_u32 v90, 40, v97
    v_bitop3_b32 v90, v89, v45, v90 bitop3:0x6a
    ds_write_b32 v98, v90 offset:8
    v_lshlrev_b32 v89, 24, v96
    v_add_u32 v90, 20, v97
    v_bitop3_b32 v90, v89, v45, v90 bitop3:0x6a
    ds_write_b32 v98, v90 offset:4
    v_lshlrev_b32 v89, 28, v96
    v_bitop3_b32 v90, v89, v45, v97 bitop3:0x6a
    ds_write_b32 v98, v90 offset:0
    v_mov_b32_dpp v91, v66 quad_perm:[0,0,0,0] row_mask:0xf bank_mask:0xf
    v_and_b32 v89, 3, v91
    v_and_b32 v97, 0xfffc, v91
    v_sub_u16_dpp v88, v66, v91 quad_perm:[2,2,2,2] row_mask:0xf bank_mask:0xf
    v_mad_u32_u24 v97, v97, 5, v4
    v_add_u32 v99, v88, v89
    v_bfm_b32 v96, v88, v89
    v_cmp_lt_u32 s[58:59], 16, v99
    v_lshlrev_b32 v89, v1, v96
    v_and_b32 v89, v45, v89
    v_cmp_ne_u32 vcc, 0, v89
    v_xor_b32 v90, v97, v89
    s_add_u32 s3, s37, s38
    v_mbcnt_lo_u32_b32 v98, vcc_lo, 0
    v_mbcnt_hi_u32_b32 v98, vcc_hi, v98
    s_bcnt1_i32_b64 s41, vcc
    v_lshl_add_u32 v98, v98, 2, s3
    s_mov_b64 exec, vcc
    ds_write_b32 v98, v90
    s_mov_b64 exec, -1
    s_lshl2_add_u32 s37, s41, s37
    s_cmp_lg_u64 s[58:59], 0
    s_cbranch_scc1 L2_xe79
L2_xr79:
    v_add_u32 v98, s37, v0
    v_mov_b32 v90, -1
    ds_write_b32 v98, v90
    ds_read2st64_b32 v[40:41], v0 offset0:0 offset1:1
    ds_read2st64_b32 v[42:43], v0 offset0:2 offset1:3
    s_sub_u32 s3, s37, 768
    s_cmp_gt_u32 s3, 256
    s_cbranch_scc1 L2_xf79
L2_xg79:
    s_setprio 2
    ds_write_addtid_b32 v124 offset:34816
    ds_write_addtid_b32 v125 offset:35072
    ds_write_addtid_b32 v126 offset:35328
    ds_write_addtid_b32 v127 offset:35584
    s_add_u32 s3, s40, 4096
    buffer_load_dwordx4 v[124:127], v3, s[16:19], s3 offen
    s_waitcnt lgkmcnt(14)
    v_cmp_ne_u64 s[50:51], v[72:73], v[68:69]
    v_cmpx_ne_u64 s[54:55], v[74:75], v[70:71]
    s_and_b64 s[82:83], s[54:55], s[80:81]
    s_cbranch_scc1 L2_c80
L2_d80:
    v_mov_b64 v[84:85], v[70:71]
    v_mov_b32 v7, v95
    v_mov_b64 v[86:87], v[74:75]
    s_or_b64 s[80:81], s[80:81], s[54:55]
    s_mov_b64 exec, s[50:51]
    s_and_b64 s[82:83], s[50:51], s[80:81]
    s_cbranch_scc1 L2_c81
L2_d81:
    v_mov_b64 v[84:85], v[68:69]
    v_mov_b32 v7, v94
    v_mov_b64 v[86:87], v[72:73]
    s_mov_b64 exec, -1
    s_or_b64 s[80:81], s[80:81], s[50:51]
    ds_read_b64 v[70:71], v93 offset:65408
    s_and_b64 exec, s[84:85], s[80:81]
    v_mfma_f32_4x4x4_16b_bf16 v[76:79], v[12:13], v[84:85], 0
    v_mov_b32 v92, v7
    s_andn2_b64 s[80:81], s[80:81], s[84:85]
    v_mfma_f32_4x4x4_16b_bf16 v[76:79], v[10:11], v[86:87], v[76:79]
    s_mov_b64 exec, -1
    ds_read_b64 v[68:69], v92 offset:65408
    s_setprio 1
    s_waitcnt vmcnt(10)
    s_mov_b32 m0, s38
    s_nop 0
    ds_write_addtid_b32 v108 offset:0
    ds_write_addtid_b32 v109 offset:256
    ds_write_addtid_b32 v110 offset:512
    ds_write_addtid_b32 v111 offset:768
    s_waitcnt lgkmcnt(4)
    v_mfma_f32_4x4x4_16b_bf16 v[80:83], v[10:11], v[70:71], v[80:83]
    v_mfma_f32_4x4x4_16b_bf16 v[76:79], v[10:11], v[68:69], v[76:79]
    v_and_b32 v46, 0x40000000, v39
    v_bitop3_b32 v94, v36, v5, v46 bitop3:0xea
    v_and_b32 v46, 0x80000000, v39
    v_bitop3_b32 v95, v37, v5, v46 bitop3:0xea
    v_perm_b32 v15, v37, v38, s47
    v_bitop3_b32 v46, v37, 0.5, -0.5 bitop3:0xa8
    v_perm_b32 v14, v36, v38, s46
    v_bitop3_b32 v47, v36, 0.5, -0.5 bitop3:0xa8
    v_cvt_pk_bf16_f32 v80, v80, v81
    v_cvt_pk_bf16_f32 v81, v82, v83
    ds_wrxchg_rtn_b64 v[74:75], v93, v[80:81] offset:65408
    v_cvt_pk_bf16_f32 v76, v76, v77
    v_cvt_pk_bf16_f32 v77, v78, v79
    ds_wrxchg_rtn_b64 v[72:73], v92, v[76:77] offset:65408
    v_and_b32 v88, 0x0fffffff, v44
    v_mov_b32 v39, v44
    buffer_load_dwordx2 v[34:35], v88, s[8:11], 0 offen
    buffer_load_dwordx3 v[36:38], v88, s[8:11], 0 offen offset:8
    s_setprio 0
    s_waitcnt vmcnt(11)
    ds_write_addtid_b32 v112 offset:1024
    ds_write_addtid_b32 v113 offset:1280
    ds_write_addtid_b32 v114 offset:1536
    ds_write_addtid_b32 v115 offset:1792
    v_mfma_f32_4x4x4_16b_bf16 v[80:83], v[8:9], v[106:107], 0
    v_mfma_f32_4x4x4_16b_bf16 v[76:79], v[8:9], v[104:105], 0
    v_bitop3_b32 v15, v6, v15, v46 bitop3:0xca
    v_bitop3_b32 v14, v6, v14, v47 bitop3:0xca
    s_nop 1
    v_pk_mul_f32 v[80:81], v[80:81], v[14:15] op_sel:[0,1] op_sel_hi:[1,1]
    v_pk_mul_f32 v[82:83], v[82:83], v[14:15] op_sel:[0,1] op_sel_hi:[1,1]
    v_pk_mul_f32 v[76:77], v[76:77], v[14:15] op_sel:[0,0] op_sel_hi:[1,0]
    v_pk_mul_f32 v[78:79], v[78:79], v[14:15] op_sel:[0,0] op_sel_hi:[1,0]
    s_add_u32 s42, s42, 1
    s_waitcnt lgkmcnt(0)
    s_barrier
    s_bitcmp1_b32 s36, s42
    s_cbranch_scc1 L2_slow
L2_ret4:
    s_setprio 3
    buffer_load_dwordx4 v[108:111], v3, s[16:19], s40 offen offset:0
    v_cmp_ne_u64 s[50:51], v[72:73], v[68:69]
    v_cmpx_ne_u64 s[54:55], v[74:75], v[70:71]
    s_and_b64 s[82:83], s[54:55], s[80:81]
    s_cbranch_scc1 L2_c82
L2_d82:
    v_mov_b64 v[84:85], v[70:71]
    v_mov_b32 v7, v93
    v_mov_b64 v[86:87], v[74:75]
    s_or_b64 s[80:81], s[80:81], s[54:55]
    s_mov_b64 exec, s[50:51]
    s_and_b64 s[82:83], s[50:51], s[80:81]
    s_cbranch_scc1 L2_c83
L2_d83:
    v_mov_b64 v[84:85], v[68:69]
    v_mov_b32 v7, v92
    v_mov_b64 v[86:87], v[72:73]
    s_mov_b64 exec, -1
    s_or_b64 s[80:81], s[80:81], s[50:51]
    ds_read_b64 v[70:71], v95 offset:65408
    ds_read_b64 v[68:69], v94 offset:65408
    s_waitcnt vmcnt(10)
    v_and_b32 v46, 0x20000000, v21
    v_lshrrev_b32 v47, 14, v17
    v_bitop3_b32 v47, v47, v5, v46 bitop3:0xea
    ds_read_b64 v[102:103], v47
    v_bitop3_b32 v93, v17, v5, v46 bitop3:0xea
    v_and_b32 v46, 0x10000000, v21
    v_lshrrev_b32 v47, 14, v16
    v_bitop3_b32 v47, v47, v5, v46 bitop3:0xea
    ds_read_b64 v[100:101], v47
    v_bitop3_b32 v92, v16, v5, v46 bitop3:0xea
    s_waitcnt lgkmcnt(2)
    v_mfma_f32_4x4x4_16b_bf16 v[80:83], v[10:11], v[70:71], v[80:83]
    v_mfma_f32_4x4x4_16b_bf16 v[76:79], v[10:11], v[68:69], v[76:79]
    v_perm_b32 v15, v17, v20, s45
    v_bitop3_b32 v46, v17, 0.5, -0.5 bitop3:0xa8
    v_perm_b32 v14, v16, v20, s44
    v_bitop3_b32 v47, v16, 0.5, -0.5 bitop3:0xa8
    v_cvt_pk_bf16_f32 v80, v80, v81
    v_cvt_pk_bf16_f32 v81, v82, v83
    ds_wrxchg_rtn_b64 v[74:75], v95, v[80:81] offset:65408
    v_cvt_pk_bf16_f32 v76, v76, v77
    v_cvt_pk_bf16_f32 v77, v78, v79
    ds_wrxchg_rtn_b64 v[72:73], v94, v[76:77] offset:65408
    s_waitcnt lgkmcnt(2)
    v_mfma_f32_4x4x4_16b_bf16 v[80:83], v[8:9], v[102:103], 0
    v_mfma_f32_4x4x4_16b_bf16 v[76:79], v[8:9], v[100:101], 0
    v_bitop3_b32 v15, v6, v15, v46 bitop3:0xca
    v_bitop3_b32 v14, v6, v14, v47 bitop3:0xca
    v_cmp_lt_u32 s[84:85], v5, v92
    s_nop 0
    v_pk_mul_f32 v[80:81], v[80:81], v[14:15] op_sel:[0,1] op_sel_hi:[1,1]
    v_pk_mul_f32 v[82:83], v[82:83], v[14:15] op_sel:[0,1] op_sel_hi:[1,1]
    v_pk_mul_f32 v[76:77], v[76:77], v[14:15] op_sel:[0,0] op_sel_hi:[1,0]
    v_pk_mul_f32 v[78:79], v[78:79], v[14:15] op_sel:[0,0] op_sel_hi:[1,0]
    buffer_load_dwordx4 v[112:115], v3, s[16:19], s40 offen offset:1024
    s_waitcnt lgkmcnt(0)
    v_cmp_ne_u64 s[50:51], v[72:73], v[68:69]
    v_cmpx_ne_u64 s[54:55], v[74:75], v[70:71]
    s_and_b64 s[82:83], s[54:55], s[80:81]
    s_cbranch_scc1 L2_c84
L2_d84:
    v_mov_b64 v[84:85], v[70:71]
    v_mov_b32 v7, v95
    v_mov_b64 v[86:87], v[74:75]
    s_or_b64 s[80:81], s[80:81], s[54:55]
    s_mov_b64 exec, s[50:51]
    s_and_b64 s[82:83], s[50:51], s[80:81]
    s_cbranch_scc1 L2_c85
L2_d85:
    v_mov_b64 v[84:85], v[68:69]
    v_mov_b32 v7, v94
    v_mov_b64 v[86:87], v[72:73]
    s_mov_b64 exec, -1
    s_or_b64 s[80:81], s[80:81], s[50:51]
    ds_read_b64 v[70:71], v93 offset:65408
    s_and_b64 exec, s[84:85], s[80:81]
    v_mfma_f32_4x4x4_16b_bf16 v[76:79], v[12:13], v[84:85], 0
    v_mov_b32 v92, v7
    s_andn2_b64 s[80:81], s[80:81], s[84:85]
    v_mfma_f32_4x4x4_16b_bf16 v[76:79], v[10:11], v[86:87], v[76:79]
    s_mov_b64 exec, -1
    ds_read_b64 v[68:69], v92 offset:65408
    v_and_b32 v46, 0x80000000, v21
    v_lshrrev_b32 v47, 14, v19
    v_bitop3_b32 v47, v47, v5, v46 bitop3:0xea
    ds_read_b64 v[106:107], v47
    v_bitop3_b32 v95, v19, v5, v46 bitop3:0xea
    v_and_b32 v46, 0x40000000, v21
    v_lshrrev_b32 v47, 14, v18
    v_bitop3_b32 v47, v47, v5, v46 bitop3:0xea
    ds_read_b64 v[104:105], v47
    v_bitop3_b32 v94, v18, v5, v46 bitop3:0xea
    s_waitcnt lgkmcnt(2)
    v_mfma_f32_4x4x4_16b_bf16 v[80:83], v[10:11], v[70:71], v[80:83]
    v_mfma_f32_4x4x4_16b_bf16 v[76:79], v[10:11], v[68:69], v[76:79]
    v_perm_b32 v15, v19, v20, s47
    v_bitop3_b32 v46, v19, 0.5, -0.5 bitop3:0xa8
    v_perm_b32 v14, v18, v20, s46
    v_bitop3_b32 v47, v18, 0.5, -0.5 bitop3:0xa8
    v_cvt_pk_bf16_f32 v80, v80, v81
    v_cvt_pk_bf16_f32 v81, v82, v83
    ds_wrxchg_rtn_b64 v[74:75], v93, v[80:81] offset:65408
    v_cvt_pk_bf16_f32 v76, v76, v77
    v_cvt_pk_bf16_f32 v77, v78, v79
    ds_wrxchg_rtn_b64 v[72:73], v92, v[76:77] offset:65408
    v_and_b32 v88, 0x0fffffff, v40
    v_mov_b32 v21, v40
    buffer_load_dwordx2 v[16:17], v88, s[8:11], 0 offen
    buffer_load_dwordx3 v[18:20], v88, s[8:11], 0 offen offset:8
    s_setprio 2
    s_waitcnt lgkmcnt(2)
    v_mfma_f32_4x4x4_16b_bf16 v[80:83], v[8:9], v[106:107], 0
    v_mfma_f32_4x4x4_16b_bf16 v[76:79], v[8:9], v[104:105], 0
    v_bitop3_b32 v15, v6, v15, v46 bitop3:0xca
    v_bitop3_b32 v14, v6, v14, v47 bitop3:0xca
    s_nop 1
    v_pk_mul_f32 v[80:81], v[80:81], v[14:15] op_sel:[0,1] op_sel_hi:[1,1]
    v_pk_mul_f32 v[82:83], v[82:83], v[14:15] op_sel:[0,1] op_sel_hi:[1,1]
    v_pk_mul_f32 v[76:77], v[76:77], v[14:15] op_sel:[0,0] op_sel_hi:[1,0]
    v_pk_mul_f32 v[78:79], v[78:79], v[14:15] op_sel:[0,0] op_sel_hi:[1,0]
    v_sub_u16 v88, v60, v52
    v_and_b32 v89, 3, v52
    v_add3_u32 v99, v88, v89, 3
    v_and_b32 v99, -4, v99
    v_max_u32 v99, 4, v99
    v_and_b32 v97, 0xfffc, v52
    v_bfm_b32 v96, v88, v89
    v_add_u32_dpp v91, v99, v99 row_shr:1 row_mask:0xf bank_mask:0xf bound_ctrl:1
    v_mad_u32_u24 v97, v97, 5, v2
    v_cmp_lt_u32 vcc, 16, v99
    v_add_u32_dpp v91, v91, v91 row_shr:2 row_mask:0xf bank_mask:0xf bound_ctrl:1
    v_sub_u32 v98, s38, v99
    v_lshrrev_b64 v[52:53], 16, v[52:53]
    v_add_u32_dpp v91, v91, v91 row_shr:4 row_mask:0xf bank_mask:0xf bound_ctrl:1
    v_lshrrev_b64 v[60:61], 16, v[60:61]
    s_mov_b32 s101, 0
    v_add_u32_dpp v91, v91, v91 row_shr:8 row_mask:0xf bank_mask:0xf bound_ctrl:1
    s_nop 1
    v_add_u32_dpp v91, v91, v91 row_bcast:15 row_mask:0xa bank_mask:0xf
    s_nop 1
    v_add_u32_dpp v91, v91, v91 row_bcast:31 row_mask:0xc bank_mask:0xf
    v_add_u32 v98, v98, v91
    v_readlane_b32 s37, v91, 63
    s_cbranch_vccnz L2_xo86
L2_xp86:
    s_waitcnt lgkmcnt(0)
    v_cmp_ne_u64 s[50:51], v[72:73], v[68:69]
    v_cmpx_ne_u64 s[54:55], v[74:75], v[70:71]
    s_and_b64 s[82:83], s[54:55], s[80:81]
    s_cbranch_scc1 L2_c87
L2_d87:
    v_mov_b64 v[84:85], v[70:71]
    v_mov_b32 v7, v93
    v_mov_b64 v[86:87], v[74:75]
    s_or_b64 s[80:81], s[80:81], s[54:55]
    s_mov_b64 exec, s[50:51]
    s_and_b64 s[82:83], s[50:51], s[80:81]
    s_cbranch_scc1 L2_c88
L2_d88:
    v_mov_b64 v[84:85], v[68:69]
    v_mov_b32 v7, v92
    v_mov_b64 v[86:87], v[72:73]
    s_mov_b64 exec, -1
    s_or_b64 s[80:81], s[80:81], s[50:51]
    ds_read_b64 v[70:71], v95 offset:65408
    ds_read_b64 v[68:69], v94 offset:65408
    s_waitcnt vmcnt(11)
    v_and_b32 v46, 0x20000000, v27
    v_lshrrev_b32 v47, 14, v23
    v_bitop3_b32 v47, v47, v5, v46 bitop3:0xea
    ds_read_b64 v[102:103], v47
    v_bitop3_b32 v93, v23, v5, v46 bitop3:0xea
    v_and_b32 v46, 0x10000000, v27
    v_lshrrev_b32 v47, 14, v22
    v_bitop3_b32 v47, v47, v5, v46 bitop3:0xea
    ds_read_b64 v[100:101], v47
    v_bitop3_b32 v92, v22, v5, v46 bitop3:0xea
    s_waitcnt lgkmcnt(2)
    v_mfma_f32_4x4x4_16b_bf16 v[80:83], v[10:11], v[70:71], v[80:83]
    v_mfma_f32_4x4x4_16b_bf16 v[76:79], v[10:11], v[68:69], v[76:79]
    v_perm_b32 v15, v23, v26, s45
    v_bitop3_b32 v46, v23, 0.5, -0.5 bitop3:0xa8
    v_perm_b32 v14, v22, v26, s44
    v_bitop3_b32 v47, v22, 0.5, -0.5 bitop3:0xa8
    v_cvt_pk_bf16_f32 v80, v80, v81
    v_cvt_pk_bf16_f32 v81, v82, v83
    ds_wrxchg_rtn_b64 v[74:75], v95, v[80:81] offset:65408
    v_cvt_pk_bf16_f32 v76, v76, v77
    v_cvt_pk_bf16_f32 v77, v78, v79
    ds_wrxchg_rtn_b64 v[72:73], v94, v[76:77] offset:65408
    s_waitcnt lgkmcnt(2)
    v_mfma_f32_4x4x4_16b_bf16 v[80:83], v[8:9], v[102:103], 0
    v_mfma_f32_4x4x4_16b_bf16 v[76:79], v[8:9], v[100:101], 0
    v_bitop3_b32 v15, v6, v15, v46 bitop3:0xca
    v_bitop3_b32 v14, v6, v14, v47 bitop3:0xca
    v_cmp_lt_u32 s[84:85], v5, v92
    s_nop 0
    v_pk_mul_f32 v[80:81], v[80:81], v[14:15] op_sel:[0,1] op_sel_hi:[1,1]
    v_pk_mul_f32 v[82:83], v[82:83], v[14:15] op_sel:[0,1] op_sel_hi:[1,1]
    v_pk_mul_f32 v[76:77], v[76:77], v[14:15] op_sel:[0,0] op_sel_hi:[1,0]
    v_pk_mul_f32 v[78:79], v[78:79], v[14:15] op_sel:[0,0] op_sel_hi:[1,0]
    s_waitcnt lgkmcnt(0)
    v_cmp_ne_u64 s[50:51], v[72:73], v[68:69]
    v_cmpx_ne_u64 s[54:55], v[74:75], v[70:71]
    s_and_b64 s[82:83], s[54:55], s[80:81]
    s_cbranch_scc1 L2_c89
L2_d89:
    v_mov_b64 v[84:85], v[70:71]
    v_mov_b32 v7, v95
    v_mov_b64 v[86:87], v[74:75]
    s_or_b64 s[80:81], s[80:81], s[54:55]
    s_mov_b64 exec, s[50:51]
    s_and_b64 s[82:83], s[50:51], s[80:81]
    s_cbranch_scc1 L2_c90
L2_d90:
    v_mov_b64 v[84:85], v[68:69]
    v_mov_b32 v7, v94
    v_mov_b64 v[86:87], v[72:73]
    s_mov_b64 exec, -1
    s_or_b64 s[80:81], s[80:81], s[50:51]
    ds_read_b64 v[70:71], v93 offset:65408
    s_and_b64 exec, s[84:85], s[80:81]
    v_mfma_f32_4x4x4_16b_bf16 v[76:79], v[12:13], v[84:85], 0
    v_mov_b32 v92, v7
    s_andn2_b64 s[80:81], s[80:81], s[84:85]
    v_mfma_f32_4x4x4_16b_bf16 v[76:79], v[10:11], v[86:87], v[76:79]
    s_mov_b64 exec, -1
    ds_read_b64 v[68:69], v92 offset:65408
    v_and_b32 v46, 0x80000000, v27
    v_lshrrev_b32 v47, 14, v25
    v_bitop3_b32 v47, v47, v5, v46 bitop3:0xea
    ds_read_b64 v[106:107], v47
    v_bitop3_b32 v95, v25, v5, v46 bitop3:0xea
    v_and_b32 v46, 0x40000000, v27
    v_lshrrev_b32 v47, 14, v24
    v_bitop3_b32 v47, v47, v5, v46 bitop3:0xea
    ds_read_b64 v[104:105], v47
    v_bitop3_b32 v94, v24, v5, v46 bitop3:0xea
    s_waitcnt lgkmcnt(2)
    v_mfma_f32_4x4x4_16b_bf16 v[80:83], v[10:11], v[70:71], v[80:83]
    v_mfma_f32_4x4x4_16b_bf16 v[76:79], v[10:11], v[68:69], v[76:79]
    v_perm_b32 v15, v25, v26, s47
    v_bitop3_b32 v46, v25, 0.5, -0.5 bitop3:0xa8
    v_perm_b32 v14, v24, v26, s46
    v_bitop3_b32 v47, v24, 0.5, -0.5 bitop3:0xa8
    v_cvt_pk_bf16_f32 v80, v80, v81
    v_cvt_pk_bf16_f32 v81, v82, v83
    ds_wrxchg_rtn_b64 v[74:75], v93, v[80:81] offset:65408
    v_cvt_pk_bf16_f32 v76, v76, v77
    v_cvt_pk_bf16_f32 v77, v78, v79
    ds_wrxchg_rtn_b64 v[72:73], v92, v[76:77] offset:65408
    v_and_b32 v88, 0x0fffffff, v41
    v_mov_b32 v27, v41
    buffer_load_dwordx2 v[22:23], v88, s[8:11], 0 offen
    buffer_load_dwordx3 v[24:26], v88, s[8:11], 0 offen offset:8
    s_setprio 1
    s_waitcnt lgkmcnt(2)
    v_mfma_f32_4x4x4_16b_bf16 v[80:83], v[8:9], v[106:107], 0
    v_mfma_f32_4x4x4_16b_bf16 v[76:79], v[8:9], v[104:105], 0
    v_bitop3_b32 v15, v6, v15, v46 bitop3:0xca
    v_bitop3_b32 v14, v6, v14, v47 bitop3:0xca
    s_nop 1
    v_pk_mul_f32 v[80:81], v[80:81], v[14:15] op_sel:[0,1] op_sel_hi:[1,1]
    v_pk_mul_f32 v[82:83], v[82:83], v[14:15] op_sel:[0,1] op_sel_hi:[1,1]
    v_pk_mul_f32 v[76:77], v[76:77], v[14:15] op_sel:[0,0] op_sel_hi:[1,0]
    v_pk_mul_f32 v[78:79], v[78:79], v[14:15] op_sel:[0,0] op_sel_hi:[1,0]
    s_waitcnt lgkmcnt(0)
    v_cmp_ne_u64 s[50:51], v[72:73], v[68:69]
    v_cmpx_ne_u64 s[54:55], v[74:75], v[70:71]
    s_and_b64 s[82:83], s[54:55], s[80:81]
    s_cbranch_scc1 L2_c91
L2_d91:
    v_mov_b64 v[84:85], v[70:71]
    v_mov_b32 v7, v93
    v_mov_b64 v[86:87], v[74:75]
    s_or_b64 s[80:81], s[80:81], s[54:55]
    s_mov_b64 exec, s[50:51]
    s_and_b64 s[82:83], s[50:51], s[80:81]
    s_cbranch_scc1 L2_c92
L2_d92:
    v_mov_b64 v[84:85], v[68:69]
    v_mov_b32 v7, v92
    v_mov_b64 v[86:87], v[72:73]
    s_mov_b64 exec, -1
    s_or_b64 s[80:81], s[80:81], s[50:51]
    ds_read_b64 v[70:71], v95 offset:65408
    ds_read_b64 v[68:69], v94 offset:65408
    s_waitcnt vmcnt(11)
    v_and_b32 v46, 0x20000000, v33
    v_lshrrev_b32 v47, 14, v29
    v_bitop3_b32 v47, v47, v5, v46 bitop3:0xea
    ds_read_b64 v[102:103], v47
    v_bitop3_b32 v93, v29, v5, v46 bitop3:0xea
    v_and_b32 v46, 0x10000000, v33
    v_lshrrev_b32 v47, 14, v28
    v_bitop3_b32 v47, v47, v5, v46 bitop3:0xea
    ds_read_b64 v[100:101], v47
    v_bitop3_b32 v92, v28, v5, v46 bitop3:0xea
    s_waitcnt lgkmcnt(2)
    v_mfma_f32_4x4x4_16b_bf16 v[80:83], v[10:11], v[70:71], v[80:83]
    v_mfma_f32_4x4x4_16b_bf16 v[76:79], v[10:11], v[68:69], v[76:79]
    v_perm_b32 v15, v29, v32, s45
    v_bitop3_b32 v46, v29, 0.5, -0.5 bitop3:0xa8
    v_perm_b32 v14, v28, v32, s44
    v_bitop3_b32 v47, v28, 0.5, -0.5 bitop3:0xa8
    v_cvt_pk_bf16_f32 v80, v80, v81
    v_cvt_pk_bf16_f32 v81, v82, v83
    ds_wrxchg_rtn_b64 v[74:75], v95, v[80:81] offset:65408
    v_cvt_pk_bf16_f32 v76, v76, v77
    v_cvt_pk_bf16_f32 v77, v78, v79
    ds_wrxchg_rtn_b64 v[72:73], v94, v[76:77] offset:65408
    s_waitcnt lgkmcnt(2)
    v_mfma_f32_4x4x4_16b_bf16 v[80:83], v[8:9], v[102:103], 0
    v_mfma_f32_4x4x4_16b_bf16 v[76:79], v[8:9], v[100:101], 0
    v_bitop3_b32 v15, v6, v15, v46 bitop3:0xca
    v_bitop3_b32 v14, v6, v14, v47 bitop3:0xca
    v_cmp_lt_u32 s[84:85], v5, v92
    s_nop 0
    v_pk_mul_f32 v[80:81], v[80:81], v[14:15] op_sel:[0,1] op_sel_hi:[1,1]
    v_pk_mul_f32 v[82:83], v[82:83], v[14:15] op_sel:[0,1] op_sel_hi:[1,1]
    v_pk_mul_f32 v[76:77], v[76:77], v[14:15] op_sel:[0,0] op_sel_hi:[1,0]
    v_pk_mul_f32 v[78:79], v[78:79], v[14:15] op_sel:[0,0] op_sel_hi:[1,0]
    s_waitcnt lgkmcnt(0)
    v_cmp_ne_u64 s[50:51], v[72:73], v[68:69]
    v_cmpx_ne_u64 s[54:55], v[74:75], v[70:71]
    s_and_b64 s[82:83], s[54:55], s[80:81]
    s_cbranch_scc1 L2_c93
L2_d93:
    v_mov_b64 v[84:85], v[70:71]
    v_mov_b32 v7, v95
    v_mov_b64 v[86:87], v[74:75]
    s_or_b64 s[80:81], s[80:81], s[54:55]
    s_mov_b64 exec, s[50:51]
    s_and_b64 s[82:83], s[50:51], s[80:81]
    s_cbranch_scc1 L2_c94
L2_d94:
    v_mov_b64 v[84:85], v[68:69]
    v_mov_b32 v7, v94
    v_mov_b64 v[86:87], v[72:73]
    s_mov_b64 exec, -1
    s_or_b64 s[80:81], s[80:81], s[50:51]
    ds_read_b64 v[70:71], v93 offset:65408
    s_and_b64 exec, s[84:85], s[80:81]
    v_mfma_f32_4x4x4_16b_bf16 v[76:79], v[12:13], v[84:85], 0
    v_mov_b32 v92, v7
    s_andn2_b64 s[80:81], s[80:81], s[84:85]
    v_mfma_f32_4x4x4_16b_bf16 v[76:79], v[10:11], v[86:87], v[76:79]
    s_mov_b64 exec, -1
    ds_read_b64 v[68:69], v92 offset:65408
    v_and_b32 v46, 0x80000000, v33
    v_lshrrev_b32 v47, 14, v31
    v_bitop3_b32 v47, v47, v5, v46 bitop3:0xea
    ds_read_b64 v[106:107], v47
    v_bitop3_b32 v95, v31, v5, v46 bitop3:0xea
    v_and_b32 v46, 0x40000000, v33
    v_lshrrev_b32 v47, 14, v30
    v_bitop3_b32 v47, v47, v5, v46 bitop3:0xea
    ds_read_b64 v[104:105], v47
    v_bitop3_b32 v94, v30, v5, v46 bitop3:0xea
    s_waitcnt lgkmcnt(2)
    v_mfma_f32_4x4x4_16b_bf16 v[80:83], v[10:11], v[70:71], v[80:83]
    v_mfma_f32_4x4x4_16b_bf16 v[76:79], v[10:11], v[68:69], v[76:79]
    v_perm_b32 v15, v31, v32, s47
    v_bitop3_b32 v46, v31, 0.5, -0.5 bitop3:0xa8
    v_perm_b32 v14, v30, v32, s46
    v_bitop3_b32 v47, v30, 0.5, -0.5 bitop3:0xa8
    v_cvt_pk_bf16_f32 v80, v80, v81
    v_cvt_pk_bf16_f32 v81, v82, v83
    ds_wrxchg_rtn_b64 v[74:75], v93, v[80:81] offset:65408
    v_cvt_pk_bf16_f32 v76, v76, v77
    v_cvt_pk_bf16_f32 v77, v78, v79
    ds_wrxchg_rtn_b64 v[72:73], v92, v[76:77] offset:65408
    v_and_b32 v88, 0x0fffffff, v42
    v_mov_b32 v33, v42
    buffer_load_dwordx2 v[28:29], v88, s[8:11], 0 offen
    buffer_load_dwordx3 v[30:32], v88, s[8:11], 0 offen offset:8
    s_setprio 0
    s_waitcnt lgkmcnt(2)
    v_mfma_f32_4x4x4_16b_bf16 v[80:83], v[8:9], v[106:107], 0
    v_mfma_f32_4x4x4_16b_bf16 v[76:79], v[8:9], v[104:105], 0
    v_bitop3_b32 v15, v6, v15, v46 bitop3:0xca
    v_bitop3_b32 v14, v6, v14, v47 bitop3:0xca
    s_nop 1
    v_pk_mul_f32 v[80:81], v[80:81], v[14:15] op_sel:[0,1] op_sel_hi:[1,1]
    v_pk_mul_f32 v[82:83], v[82:83], v[14:15] op_sel:[0,1] op_sel_hi:[1,1]
    v_pk_mul_f32 v[76:77], v[76:77], v[14:15] op_sel:[0,0] op_sel_hi:[1,0]
    v_pk_mul_f32 v[78:79], v[78:79], v[14:15] op_sel:[0,0] op_sel_hi:[1,0]
    s_add_u32 s40, s40, 0x50000
    s_waitcnt lgkmcnt(0)
    v_cmp_ne_u64 s[50:51], v[72:73], v[68:69]
    v_cmpx_ne_u64 s[54:55], v[74:75], v[70:71]
    s_and_b64 s[82:83], s[54:55], s[80:81]
    s_cbranch_scc1 L2_c95
L2_d95:
    v_mov_b64 v[84:85], v[70:71]
    v_mov_b32 v7, v93
    v_mov_b64 v[86:87], v[74:75]
    s_or_b64 s[80:81], s[80:81], s[54:55]
    s_mov_b64 exec, s[50:51]
    s_and_b64 s[82:83], s[50:51], s[80:81]
    s_cbranch_scc1 L2_c96
L2_d96:
    v_mov_b64 v[84:85], v[68:69]
    v_mov_b32 v7, v92
    v_mov_b64 v[86:87], v[72:73]
    s_mov_b64 exec, -1
    s_or_b64 s[80:81], s[80:81], s[50:51]
    ds_read_b64 v[70:71], v95 offset:65408
    ds_read_b64 v[68:69], v94 offset:65408
    s_waitcnt vmcnt(8)
    v_and_b32 v46, 0x20000000, v39
    v_lshrrev_b32 v47, 14, v35
    v_bitop3_b32 v47, v47, v5, v46 bitop3:0xea
    ds_read_b64 v[102:103], v47
    v_bitop3_b32 v93, v35, v5, v46 bitop3:0xea
    v_and_b32 v46, 0x10000000, v39
    v_lshrrev_b32 v47, 14, v34
    v_bitop3_b32 v47, v47, v5, v46 bitop3:0xea
    ds_read_b64 v[100:101], v47
    v_bitop3_b32 v92, v34, v5, v46 bitop3:0xea
    v_and_b32 v46, 0x80000000, v39
    v_lshrrev_b32 v47, 14, v37
    v_bitop3_b32 v47, v47, v5, v46 bitop3:0xea
    ds_read_b64 v[106:107], v47
    v_and_b32 v46, 0x40000000, v39
    v_lshrrev_b32 v47, 14, v36
    v_bitop3_b32 v47, v47, v5, v46 bitop3:0xea
    ds_read_b64 v[104:105], v47
    s_waitcnt lgkmcnt(4)
    v_mfma_f32_4x4x4_16b_bf16 v[80:83], v[10:11], v[70:71], v[80:83]
    v_mfma_f32_4x4x4_16b_bf16 v[76:79], v[10:11], v[68:69], v[76:79]
    v_perm_b32 v15, v35, v38, s45
    v_bitop3_b32 v46, v35, 0.5, -0.5 bitop3:0xa8
    v_perm_b32 v14, v34, v38, s44
    v_bitop3_b32 v47, v34, 0.5, -0.5 bitop3:0xa8
    v_cvt_pk_bf16_f32 v80, v80, v81
    v_cvt_pk_bf16_f32 v81, v82, v83
    ds_wrxchg_rtn_b64 v[74:75], v95, v[80:81] offset:65408
    v_cvt_pk_bf16_f32 v76, v76, v77
    v_cvt_pk_bf16_f32 v77, v78, v79
    ds_wrxchg_rtn_b64 v[72:73], v94, v[76:77] offset:65408
    s_waitcnt lgkmcnt(2)
    s_barrier
    s_setprio 3
    s_mov_b32 m0, s100
    s_nop 0
    ds_write_addtid_b32 v116 offset:32768
    ds_write_addtid_b32 v117 offset:33024
    ds_write_addtid_b32 v118 offset:33280
    ds_write_addtid_b32 v119 offset:33536
    buffer_load_dwordx4 v[116:119], v3, s[16:19], s40 offen offset:2048
    ds_write_addtid_b32 v120 offset:33792
    ds_write_addtid_b32 v121 offset:34048
    ds_write_addtid_b32 v122 offset:34304
    ds_write_addtid_b32 v123 offset:34560
    buffer_load_dwordx4 v[120:123], v3, s[16:19], s40 offen offset:3072
    v_mfma_f32_4x4x4_16b_bf16 v[80:83], v[8:9], v[102:103], 0
    v_mfma_f32_4x4x4_16b_bf16 v[76:79], v[8:9], v[100:101], 0
    v_bitop3_b32 v15, v6, v15, v46 bitop3:0xca
    v_bitop3_b32 v14, v6, v14, v47 bitop3:0xca
    v_cmp_lt_u32 s[84:85], v5, v92
    s_nop 0
    v_pk_mul_f32 v[80:81], v[80:81], v[14:15] op_sel:[0,1] op_sel_hi:[1,1]
    v_pk_mul_f32 v[82:83], v[82:83], v[14:15] op_sel:[0,1] op_sel_hi:[1,1]
    v_pk_mul_f32 v[76:77], v[76:77], v[14:15] op_sel:[0,0] op_sel_hi:[1,0]
    v_pk_mul_f32 v[78:79], v[78:79], v[14:15] op_sel:[0,0] op_sel_hi:[1,0]
    v_mov_b32 v44, v43
    s_cmp_gt_u32 s37, 1024
    s_cbranch_scc1 L2_xs97
    s_cmp_lg_u32 s101, 0
    s_cbranch_scc1 L2_xa97
L2_xb97:
    v_lshlrev_b32 v89, 16, v96
    v_add_u32 v90, 60, v97
    v_bitop3_b32 v90, v89, v45, v90 bitop3:0x6a
    ds_write_b32 v98, v90 offset:12
    v_lshlrev_b32 v89, 20, v96
    v_add_u32 v90, 40, v97
    v_bitop3_b32 v90, v89, v45, v90 bitop3:0x6a
    ds_write_b32 v98, v90 offset:8
    v_lshlrev_b32 v89, 24, v96
    v_add_u32 v90, 20, v97
    v_bitop3_b32 v90, v89, v45, v90 bitop3:0x6a
    ds_write_b32 v98, v90 offset:4
    v_lshlrev_b32 v89, 28, v96
    v_bitop3_b32 v90, v89, v45, v97 bitop3:0x6a
    ds_write_b32 v98, v90 offset:0
    v_mov_b32_dpp v91, v64 quad_perm:[1,1,1,1] row_mask:0xf bank_mask:0xf
    v_and_b32 v89, 3, v91
    v_and_b32 v97, 0xfffc, v91
    v_sub_u16_dpp v88, v64, v91 quad_perm:[3,3,3,3] row_mask:0xf bank_mask:0xf
    v_mad_u32_u24 v97, v97, 5, v4
    v_add_u32 v99, v88, v89
    v_bfm_b32 v96, v88, v89
    v_cmp_lt_u32 s[58:59], 16, v99
    v_lshlrev_b32 v89, v1, v96
    v_and_b32 v89, v45, v89
    v_cmp_ne_u32 vcc, 0, v89
    v_xor_b32 v90, v97, v89
    s_add_u32 s3, s37, s38
    v_mbcnt_lo_u32_b32 v98, vcc_lo, 0
    v_mbcnt_hi_u32_b32 v98, vcc_hi, v98
    s_bcnt1_i32_b64 s41, vcc
    v_lshl_add_u32 v98, v98, 2, s3
    s_mov_b64 exec, vcc
    ds_write_b32 v98, v90
    s_mov_b64 exec, -1
    s_lshl2_add_u32 s37, s41, s37
    s_cmp_lg_u64 s[58:59], 0
    s_cbranch_scc1 L2_xe97
L2_xr97:
    v_add_u32 v98, s37, v0
    v_mov_b32 v90, -1
    ds_write_b32 v98, v90
    ds_read2st64_b32 v[40:41], v0 offset0:0 offset1:1
    ds_read2st64_b32 v[42:43], v0 offset0:2 offset1:3
    s_sub_u32 s3, s37, 768
    s_cmp_gt_u32 s3, 256
    s_cbranch_scc1 L2_xf97
L2_xg97:
    s_setprio 2
    ds_write_addtid_b32 v124 offset:34816
    ds_write_addtid_b32 v125 offset:35072
    ds_write_addtid_b32 v126 offset:35328
    ds_write_addtid_b32 v127 offset:35584
    s_add_u32 s3, s40, 4096
    buffer_load_dwordx4 v[124:127], v3, s[16:19], s3 offen
    s_waitcnt lgkmcnt(14)
    v_cmp_ne_u64 s[50:51], v[72:73], v[68:69]
    v_cmpx_ne_u64 s[54:55], v[74:75], v[70:71]
    s_and_b64 s[82:83], s[54:55], s[80:81]
    s_cbranch_scc1 L2_c98
L2_d98:
    v_mov_b64 v[84:85], v[70:71]
    v_mov_b32 v7, v95
    v_mov_b64 v[86:87], v[74:75]
    s_or_b64 s[80:81], s[80:81], s[54:55]
    s_mov_b64 exec, s[50:51]
    s_and_b64 s[82:83], s[50:51], s[80:81]
    s_cbranch_scc1 L2_c99
L2_d99:
    v_mov_b64 v[84:85], v[68:69]
    v_mov_b32 v7, v94
    v_mov_b64 v[86:87], v[72:73]
    s_mov_b64 exec, -1
    s_or_b64 s[80:81], s[80:81], s[50:51]
    ds_read_b64 v[70:71], v93 offset:65408
    s_and_b64 exec, s[84:85], s[80:81]
    v_mfma_f32_4x4x4_16b_bf16 v[76:79], v[12:13], v[84:85], 0
    v_mov_b32 v92, v7
    s_andn2_b64 s[80:81], s[80:81], s[84:85]
    v_mfma_f32_4x4x4_16b_bf16 v[76:79], v[10:11], v[86:87], v[76:79]
    s_mov_b64 exec, -1
    ds_read_b64 v[68:69], v92 offset:65408
    s_setprio 1
    s_waitcnt vmcnt(10)
    s_mov_b32 m0, s38
    s_nop 0
    ds_write_addtid_b32 v108 offset:0
    ds_write_addtid_b32 v109 offset:256
    ds_write_addtid_b32 v110 offset:512
    ds_write_addtid_b32 v111 offset:768
    s_waitcnt lgkmcnt(4)
    v_mfma_f32_4x4x4_16b_bf16 v[80:83], v[10:11], v[70:71], v[80:83]
    v_mfma_f32_4x4x4_16b_bf16 v[76:79], v[10:11], v[68:69], v[76:79]
    v_and_b32 v46, 0x40000000, v39
    v_bitop3_b32 v94, v36, v5, v46 bitop3:0xea
    v_and_b32 v46, 0x80000000, v39
    v_bitop3_b32 v95, v37, v5, v46 bitop3:0xea
    v_perm_b32 v15, v37, v38, s47
    v_bitop3_b32 v46, v37, 0.5, -0.5 bitop3:0xa8
    v_perm_b32 v14, v36, v38, s46
    v_bitop3_b32 v47, v36, 0.5, -0.5 bitop3:0xa8
    v_cvt_pk_bf16_f32 v80, v80, v81
    v_cvt_pk_bf16_f32 v81, v82, v83
    ds_wrxchg_rtn_b64 v[74:75], v93, v[80:81] offset:65408
    v_cvt_pk_bf16_f32 v76, v76, v77
    v_cvt_pk_bf16_f32 v77, v78, v79
    ds_wrxchg_rtn_b64 v[72:73], v92, v[76:77] offset:65408
    v_and_b32 v88, 0x0fffffff, v44
    v_mov_b32 v39, v44
    buffer_load_dwordx2 v[34:35], v88, s[8:11], 0 offen
    buffer_load_dwordx3 v[36:38], v88, s[8:11], 0 offen offset:8
    s_setprio 0
    s_waitcnt vmcnt(11)
    ds_write_addtid_b32 v112 offset:1024
    ds_write_addtid_b32 v113 offset:1280
    ds_write_addtid_b32 v114 offset:1536
    ds_write_addtid_b32 v115 offset:1792
    v_mfma_f32_4x4x4_16b_bf16 v[80:83], v[8:9], v[106:107], 0
    v_mfma_f32_4x4x4_16b_bf16 v[76:79], v[8:9], v[104:105], 0
    v_bitop3_b32 v15, v6, v15, v46 bitop3:0xca
    v_bitop3_b32 v14, v6, v14, v47 bitop3:0xca
    s_nop 1
    v_pk_mul_f32 v[80:81], v[80:81], v[14:15] op_sel:[0,1] op_sel_hi:[1,1]
    v_pk_mul_f32 v[82:83], v[82:83], v[14:15] op_sel:[0,1] op_sel_hi:[1,1]
    v_pk_mul_f32 v[76:77], v[76:77], v[14:15] op_sel:[0,0] op_sel_hi:[1,0]
    v_pk_mul_f32 v[78:79], v[78:79], v[14:15] op_sel:[0,0] op_sel_hi:[1,0]
    s_add_u32 s42, s42, 1
    s_waitcnt lgkmcnt(0)
    s_barrier
    s_bitcmp1_b32 s36, s42
    s_cbranch_scc1 L2_slow
L2_ret5:
    s_setprio 3
    buffer_load_dwordx4 v[108:111], v3, s[16:19], s40 offen offset:0
    v_cmp_ne_u64 s[50:51], v[72:73], v[68:69]
    v_cmpx_ne_u64 s[54:55], v[74:75], v[70:71]
    s_and_b64 s[82:83], s[54:55], s[80:81]
    s_cbranch_scc1 L2_c100
L2_d100:
    v_mov_b64 v[84:85], v[70:71]
    v_mov_b32 v7, v93
    v_mov_b64 v[86:87], v[74:75]
    s_or_b64 s[80:81], s[80:81], s[54:55]
    s_mov_b64 exec, s[50:51]
    s_and_b64 s[82:83], s[50:51], s[80:81]
    s_cbranch_scc1 L2_c101
L2_d101:
    v_mov_b64 v[84:85], v[68:69]
    v_mov_b32 v7, v92
    v_mov_b64 v[86:87], v[72:73]
    s_mov_b64 exec, -1
    s_or_b64 s[80:81], s[80:81], s[50:51]
    ds_read_b64 v[70:71], v95 offset:65408
    ds_read_b64 v[68:69], v94 offset:65408
    s_waitcnt vmcnt(10)
    v_and_b32 v46, 0x20000000, v21
    v_lshrrev_b32 v47, 14, v17
    v_bitop3_b32 v47, v47, v5, v46 bitop3:0xea
    ds_read_b64 v[102:103], v47
    v_bitop3_b32 v93, v17, v5, v46 bitop3:0xea
    v_and_b32 v46, 0x10000000, v21
    v_lshrrev_b32 v47, 14, v16
    v_bitop3_b32 v47, v47, v5, v46 bitop3:0xea
    ds_read_b64 v[100:101], v47
    v_bitop3_b32 v92, v16, v5, v46 bitop3:0xea
    s_waitcnt lgkmcnt(2)
    v_mfma_f32_4x4x4_16b_bf16 v[80:83], v[10:11], v[70:71], v[80:83]
    v_mfma_f32_4x4x4_16b_bf16 v[76:79], v[10:11], v[68:69], v[76:79]
    v_perm_b32 v15, v17, v20, s45
    v_bitop3_b32 v46, v17, 0.5, -0.5 bitop3:0xa8
    v_perm_b32 v14, v16, v20, s44
    v_bitop3_b32 v47, v16, 0.5, -0.5 bitop3:0xa8
    v_cvt_pk_bf16_f32 v80, v80, v81
    v_cvt_pk_bf16_f32 v81, v82, v83
    ds_wrxchg_rtn_b64 v[74:75], v95, v[80:81] offset:65408
    v_cvt_pk_bf16_f32 v76, v76, v77
    v_cvt_pk_bf16_f32 v77, v78, v79
    ds_wrxchg_rtn_b64 v[72:73], v94, v[76:77] offset:65408
    s_waitcnt lgkmcnt(2)
    v_mfma_f32_4x4x4_16b_bf16 v[80:83], v[8:9], v[102:103], 0
    v_mfma_f32_4x4x4_16b_bf16 v[76:79], v[8:9], v[100:101], 0
    v_bitop3_b32 v15, v6, v15, v46 bitop3:0xca
    v_bitop3_b32 v14, v6, v14, v47 bitop3:0xca
    v_cmp_lt_u32 s[84:85], v5, v92
    s_nop 0
    v_pk_mul_f32 v[80:81], v[80:81], v[14:15] op_sel:[0,1] op_sel_hi:[1,1]
    v_pk_mul_f32 v[82:83], v[82:83], v[14:15] op_sel:[0,1] op_sel_hi:[1,1]
    v_pk_mul_f32 v[76:77], v[76:77], v[14:15] op_sel:[0,0] op_sel_hi:[1,0]
    v_pk_mul_f32 v[78:79], v[78:79], v[14:15] op_sel:[0,0] op_sel_hi:[1,0]
    buffer_load_dwordx4 v[112:115], v3, s[16:19], s40 offen offset:1024
    s_waitcnt lgkmcnt(0)
    v_cmp_ne_u64 s[50:51], v[72:73], v[68:69]
    v_cmpx_ne_u64 s[54:55], v[74:75], v[70:71]
    s_and_b64 s[82:83], s[54:55], s[80:81]
    s_cbranch_scc1 L2_c102
L2_d102:
    v_mov_b64 v[84:85], v[70:71]
    v_mov_b32 v7, v95
    v_mov_b64 v[86:87], v[74:75]
    s_or_b64 s[80:81], s[80:81], s[54:55]
    s_mov_b64 exec, s[50:51]
    s_and_b64 s[82:83], s[50:51], s[80:81]
    s_cbranch_scc1 L2_c103
L2_d103:
    v_mov_b64 v[84:85], v[68:69]
    v_mov_b32 v7, v94
    v_mov_b64 v[86:87], v[72:73]
    s_mov_b64 exec, -1
    s_or_b64 s[80:81], s[80:81], s[50:51]
    ds_read_b64 v[70:71], v93 offset:65408
    s_and_b64 exec, s[84:85], s[80:81]
    v_mfma_f32_4x4x4_16b_bf16 v[76:79], v[12:13], v[84:85], 0
    v_mov_b32 v92, v7
    s_andn2_b64 s[80:81], s[80:81], s[84:85]
    v_mfma_f32_4x4x4_16b_bf16 v[76:79], v[10:11], v[86:87], v[76:79]
    s_mov_b64 exec, -1
    ds_read_b64 v[68:69], v92 offset:65408
    v_and_b32 v46, 0x80000000, v21
    v_lshrrev_b32 v47, 14, v19
    v_bitop3_b32 v47, v47, v5, v46 bitop3:0xea
    ds_read_b64 v[106:107], v47
    v_bitop3_b32 v95, v19, v5, v46 bitop3:0xea
    v_and_b32 v46, 0x40000000, v21
    v_lshrrev_b32 v47, 14, v18
    v_bitop3_b32 v47, v47, v5, v46 bitop3:0xea
    ds_read_b64 v[104:105], v47
    v_bitop3_b32 v94, v18, v5, v46 bitop3:0xea
    s_waitcnt lgkmcnt(2)
    v_mfma_f32_4x4x4_16b_bf16 v[80:83], v[10:11], v[70:71], v[80:83]
    v_mfma_f32_4x4x4_16b_bf16 v[76:79], v[10:11], v[68:69], v[76:79]
    v_perm_b32 v15, v19, v20, s47
    v_bitop3_b32 v46, v19, 0.5, -0.5 bitop3:0xa8
    v_perm_b32 v14, v18, v20, s46
    v_bitop3_b32 v47, v18, 0.5, -0.5 bitop3:0xa8
    v_cvt_pk_bf16_f32 v80, v80, v81
    v_cvt_pk_bf16_f32 v81, v82, v83
    ds_wrxchg_rtn_b64 v[74:75], v93, v[80:81] offset:65408
    v_cvt_pk_bf16_f32 v76, v76, v77
    v_cvt_pk_bf16_f32 v77, v78, v79
    ds_wrxchg_rtn_b64 v[72:73], v92, v[76:77] offset:65408
    v_and_b32 v88, 0x0fffffff, v40
    v_mov_b32 v21, v40
    buffer_load_dwordx2 v[16:17], v88, s[8:11], 0 offen
    buffer_load_dwordx3 v[18:20], v88, s[8:11], 0 offen offset:8
    s_setprio 2
    s_waitcnt lgkmcnt(2)
    v_mfma_f32_4x4x4_16b_bf16 v[80:83], v[8:9], v[106:107], 0
    v_mfma_f32_4x4x4_16b_bf16 v[76:79], v[8:9], v[104:105], 0
    v_bitop3_b32 v15, v6, v15, v46 bitop3:0xca
    v_bitop3_b32 v14, v6, v14, v47 bitop3:0xca
    s_nop 1
    v_pk_mul_f32 v[80:81], v[80:81], v[14:15] op_sel:[0,1] op_sel_hi:[1,1]
    v_pk_mul_f32 v[82:83], v[82:83], v[14:15] op_sel:[0,1] op_sel_hi:[1,1]
    v_pk_mul_f32 v[76:77], v[76:77], v[14:15] op_sel:[0,0] op_sel_hi:[1,0]
    v_pk_mul_f32 v[78:79], v[78:79], v[14:15] op_sel:[0,0] op_sel_hi:[1,0]
    v_sub_u16 v88, v62, v54
    v_and_b32 v89, 3, v54
    v_add3_u32 v99, v88, v89, 3
    v_and_b32 v99, -4, v99
    v_max_u32 v99, 4, v99
    v_and_b32 v97, 0xfffc, v54
    v_bfm_b32 v96, v88, v89
    v_add_u32_dpp v91, v99, v99 row_shr:1 row_mask:0xf bank_mask:0xf bound_ctrl:1
    v_mad_u32_u24 v97, v97, 5, v2
    v_cmp_lt_u32 vcc, 16, v99
    v_add_u32_dpp v91, v91, v91 row_shr:2 row_mask:0xf bank_mask:0xf bound_ctrl:1
    v_sub_u32 v98, s38, v99
    v_lshrrev_b64 v[54:55], 16, v[54:55]
    v_add_u32_dpp v91, v91, v91 row_shr:4 row_mask:0xf bank_mask:0xf bound_ctrl:1
    v_lshrrev_b64 v[62:63], 16, v[62:63]
    s_mov_b32 s101, 0
    v_add_u32_dpp v91, v91, v91 row_shr:8 row_mask:0xf bank_mask:0xf bound_ctrl:1
    s_nop 1
    v_add_u32_dpp v91, v91, v91 row_bcast:15 row_mask:0xa bank_mask:0xf
    s_nop 1
    v_add_u32_dpp v91, v91, v91 row_bcast:31 row_mask:0xc bank_mask:0xf
    v_add_u32 v98, v98, v91
    v_readlane_b32 s37, v91, 63
    s_cbranch_vccnz L2_xo104
L2_xp104:
    s_waitcnt lgkmcnt(0)
    v_cmp_ne_u64 s[50:51], v[72:73], v[68:69]
    v_cmpx_ne_u64 s[54:55], v[74:75], v[70:71]
    s_and_b64 s[82:83], s[54:55], s[80:81]
    s_cbranch_scc1 L2_c105
L2_d105:
    v_mov_b64 v[84:85], v[70:71]
    v_mov_b32 v7, v93
    v_mov_b64 v[86:87], v[74:75]
    s_or_b64 s[80:81], s[80:81], s[54:55]
    s_mov_b64 exec, s[50:51]
    s_and_b64 s[82:83], s[50:51], s[80:81]
    s_cbranch_scc1 L2_c106
L2_d106:
    v_mov_b64 v[84:85], v[68:69]
    v_mov_b32 v7, v92
    v_mov_b64 v[86:87], v[72:73]
    s_mov_b64 exec, -1
    s_or_b64 s[80:81], s[80:81], s[50:51]
    ds_read_b64 v[70:71], v95 offset:65408
    ds_read_b64 v[68:69], v94 offset:65408
    s_waitcnt vmcnt(11)
    v_and_b32 v46, 0x20000000, v27
    v_lshrrev_b32 v47, 14, v23
    v_bitop3_b32 v47, v47, v5, v46 bitop3:0xea
    ds_read_b64 v[102:103], v47
    v_bitop3_b32 v93, v23, v5, v46 bitop3:0xea
    v_and_b32 v46, 0x10000000, v27
    v_lshrrev_b32 v47, 14, v22
    v_bitop3_b32 v47, v47, v5, v46 bitop3:0xea
    ds_read_b64 v[100:101], v47
    v_bitop3_b32 v92, v22, v5, v46 bitop3:0xea
    s_waitcnt lgkmcnt(2)
    v_mfma_f32_4x4x4_16b_bf16 v[80:83], v[10:11], v[70:71], v[80:83]
    v_mfma_f32_4x4x4_16b_bf16 v[76:79], v[10:11], v[68:69], v[76:79]
    v_perm_b32 v15, v23, v26, s45
    v_bitop3_b32 v46, v23, 0.5, -0.5 bitop3:0xa8
    v_perm_b32 v14, v22, v26, s44
    v_bitop3_b32 v47, v22, 0.5, -0.5 bitop3:0xa8
    v_cvt_pk_bf16_f32 v80, v80, v81
    v_cvt_pk_bf16_f32 v81, v82, v83
    ds_wrxchg_rtn_b64 v[74:75], v95, v[80:81] offset:65408
    v_cvt_pk_bf16_f32 v76, v76, v77
    v_cvt_pk_bf16_f32 v77, v78, v79
    ds_wrxchg_rtn_b64 v[72:73], v94, v[76:77] offset:65408
    s_waitcnt lgkmcnt(2)
    v_mfma_f32_4x4x4_16b_bf16 v[80:83], v[8:9], v[102:103], 0
    v_mfma_f32_4x4x4_16b_bf16 v[76:79], v[8:9], v[100:101], 0
    v_bitop3_b32 v15, v6, v15, v46 bitop3:0xca
    v_bitop3_b32 v14, v6, v14, v47 bitop3:0xca
    v_cmp_lt_u32 s[84:85], v5, v92
    s_nop 0
    v_pk_mul_f32 v[80:81], v[80:81], v[14:15] op_sel:[0,1] op_sel_hi:[1,1]
    v_pk_mul_f32 v[82:83], v[82:83], v[14:15] op_sel:[0,1] op_sel_hi:[1,1]
    v_pk_mul_f32 v[76:77], v[76:77], v[14:15] op_sel:[0,0] op_sel_hi:[1,0]
    v_pk_mul_f32 v[78:79], v[78:79], v[14:15] op_sel:[0,0] op_sel_hi:[1,0]
    s_waitcnt lgkmcnt(0)
    v_cmp_ne_u64 s[50:51], v[72:73], v[68:69]
    v_cmpx_ne_u64 s[54:55], v[74:75], v[70:71]
    s_and_b64 s[82:83], s[54:55], s[80:81]
    s_cbranch_scc1 L2_c107
L2_d107:
    v_mov_b64 v[84:85], v[70:71]
    v_mov_b32 v7, v95
    v_mov_b64 v[86:87], v[74:75]
    s_or_b64 s[80:81], s[80:81], s[54:55]
    s_mov_b64 exec, s[50:51]
    s_and_b64 s[82:83], s[50:51], s[80:81]
    s_cbranch_scc1 L2_c108
L2_d108:
    v_mov_b64 v[84:85], v[68:69]
    v_mov_b32 v7, v94
    v_mov_b64 v[86:87], v[72:73]
    s_mov_b64 exec, -1
    s_or_b64 s[80:81], s[80:81], s[50:51]
    ds_read_b64 v[70:71], v93 offset:65408
    s_and_b64 exec, s[84:85], s[80:81]
    v_mfma_f32_4x4x4_16b_bf16 v[76:79], v[12:13], v[84:85], 0
    v_mov_b32 v92, v7
    s_andn2_b64 s[80:81], s[80:81], s[84:85]
    v_mfma_f32_4x4x4_16b_bf16 v[76:79], v[10:11], v[86:87], v[76:79]
    s_mov_b64 exec, -1
    ds_read_b64 v[68:69], v92 offset:65408
    v_and_b32 v46, 0x80000000, v27
    v_lshrrev_b32 v47, 14, v25
    v_bitop3_b32 v47, v47, v5, v46 bitop3:0xea
    ds_read_b64 v[106:107], v47
    v_bitop3_b32 v95, v25, v5, v46 bitop3:0xea
    v_and_b32 v46, 0x40000000, v27
    v_lshrrev_b32 v47, 14, v24
    v_bitop3_b32 v47, v47, v5, v46 bitop3:0xea
    ds_read_b64 v[104:105], v47
    v_bitop3_b32 v94, v24, v5, v46 bitop3:0xea
    s_waitcnt lgkmcnt(2)
    v_mfma_f32_4x4x4_16b_bf16 v[80:83], v[10:11], v[70:71], v[80:83]
    v_mfma_f32_4x4x4_16b_bf16 v[76:79], v[10:11], v[68:69], v[76:79]
    v_perm_b32 v15, v25, v26, s47
    v_bitop3_b32 v46, v25, 0.5, -0.5 bitop3:0xa8
    v_perm_b32 v14, v24, v26, s46
    v_bitop3_b32 v47, v24, 0.5, -0.5 bitop3:0xa8
    v_cvt_pk_bf16_f32 v80, v80, v81
    v_cvt_pk_bf16_f32 v81, v82, v83
    ds_wrxchg_rtn_b64 v[74:75], v93, v[80:81] offset:65408
    v_cvt_pk_bf16_f32 v76, v76, v77
    v_cvt_pk_bf16_f32 v77, v78, v79
    ds_wrxchg_rtn_b64 v[72:73], v92, v[76:77] offset:65408
    v_and_b32 v88, 0x0fffffff, v41
    v_mov_b32 v27, v41
    buffer_load_dwordx2 v[22:23], v88, s[8:11], 0 offen
    buffer_load_dwordx3 v[24:26], v88, s[8:11], 0 offen offset:8
    s_setprio 1
    s_waitcnt lgkmcnt(2)
    v_mfma_f32_4x4x4_16b_bf16 v[80:83], v[8:9], v[106:107], 0
    v_mfma_f32_4x4x4_16b_bf16 v[76:79], v[8:9], v[104:105], 0
    v_bitop3_b32 v15, v6, v15, v46 bitop3:0xca
    v_bitop3_b32 v14, v6, v14, v47 bitop3:0xca
    s_nop 1
    v_pk_mul_f32 v[80:81], v[80:81], v[14:15] op_sel:[0,1] op_sel_hi:[1,1]
    v_pk_mul_f32 v[82:83], v[82:83], v[14:15] op_sel:[0,1] op_sel_hi:[1,1]
    v_pk_mul_f32 v[76:77], v[76:77], v[14:15] op_sel:[0,0] op_sel_hi:[1,0]
    v_pk_mul_f32 v[78:79], v[78:79], v[14:15] op_sel:[0,0] op_sel_hi:[1,0]
    s_waitcnt lgkmcnt(0)
    v_cmp_ne_u64 s[50:51], v[72:73], v[68:69]
    v_cmpx_ne_u64 s[54:55], v[74:75], v[70:71]
    s_and_b64 s[82:83], s[54:55], s[80:81]
    s_cbranch_scc1 L2_c109
L2_d109:
    v_mov_b64 v[84:85], v[70:71]
    v_mov_b32 v7, v93
    v_mov_b64 v[86:87], v[74:75]
    s_or_b64 s[80:81], s[80:81], s[54:55]
    s_mov_b64 exec, s[50:51]
    s_and_b64 s[82:83], s[50:51], s[80:81]
    s_cbranch_scc1 L2_c110
L2_d110:
    v_mov_b64 v[84:85], v[68:69]
    v_mov_b32 v7, v92
    v_mov_b64 v[86:87], v[72:73]
    s_mov_b64 exec, -1
    s_or_b64 s[80:81], s[80:81], s[50:51]
    ds_read_b64 v[70:71], v95 offset:65408
    ds_read_b64 v[68:69], v94 offset:65408
    s_waitcnt vmcnt(11)
    v_and_b32 v46, 0x20000000, v33
    v_lshrrev_b32 v47, 14, v29
    v_bitop3_b32 v47, v47, v5, v46 bitop3:0xea
    ds_read_b64 v[102:103], v47
    v_bitop3_b32 v93, v29, v5, v46 bitop3:0xea
    v_and_b32 v46, 0x10000000, v33
    v_lshrrev_b32 v47, 14, v28
    v_bitop3_b32 v47, v47, v5, v46 bitop3:0xea
    ds_read_b64 v[100:101], v47
    v_bitop3_b32 v92, v28, v5, v46 bitop3:0xea
    s_waitcnt lgkmcnt(2)
    v_mfma_f32_4x4x4_16b_bf16 v[80:83], v[10:11], v[70:71], v[80:83]
    v_mfma_f32_4x4x4_16b_bf16 v[76:79], v[10:11], v[68:69], v[76:79]
    v_perm_b32 v15, v29, v32, s45
    v_bitop3_b32 v46, v29, 0.5, -0.5 bitop3:0xa8
    v_perm_b32 v14, v28, v32, s44
    v_bitop3_b32 v47, v28, 0.5, -0.5 bitop3:0xa8
    v_cvt_pk_bf16_f32 v80, v80, v81
    v_cvt_pk_bf16_f32 v81, v82, v83
    ds_wrxchg_rtn_b64 v[74:75], v95, v[80:81] offset:65408
    v_cvt_pk_bf16_f32 v76, v76, v77
    v_cvt_pk_bf16_f32 v77, v78, v79
    ds_wrxchg_rtn_b64 v[72:73], v94, v[76:77] offset:65408
    s_waitcnt lgkmcnt(2)
    v_mfma_f32_4x4x4_16b_bf16 v[80:83], v[8:9], v[102:103], 0
    v_mfma_f32_4x4x4_16b_bf16 v[76:79], v[8:9], v[100:101], 0
    v_bitop3_b32 v15, v6, v15, v46 bitop3:0xca
    v_bitop3_b32 v14, v6, v14, v47 bitop3:0xca
    v_cmp_lt_u32 s[84:85], v5, v92
    s_nop 0
    v_pk_mul_f32 v[80:81], v[80:81], v[14:15] op_sel:[0,1] op_sel_hi:[1,1]
    v_pk_mul_f32 v[82:83], v[82:83], v[14:15] op_sel:[0,1] op_sel_hi:[1,1]
    v_pk_mul_f32 v[76:77], v[76:77], v[14:15] op_sel:[0,0] op_sel_hi:[1,0]
    v_pk_mul_f32 v[78:79], v[78:79], v[14:15] op_sel:[0,0] op_sel_hi:[1,0]
    s_waitcnt lgkmcnt(0)
    v_cmp_ne_u64 s[50:51], v[72:73], v[68:69]
    v_cmpx_ne_u64 s[54:55], v[74:75], v[70:71]
    s_and_b64 s[82:83], s[54:55], s[80:81]
    s_cbranch_scc1 L2_c111
L2_d111:
    v_mov_b64 v[84:85], v[70:71]
    v_mov_b32 v7, v95
    v_mov_b64 v[86:87], v[74:75]
    s_or_b64 s[80:81], s[80:81], s[54:55]
    s_mov_b64 exec, s[50:51]
    s_and_b64 s[82:83], s[50:51], s[80:81]
    s_cbranch_scc1 L2_c112
L2_d112:
    v_mov_b64 v[84:85], v[68:69]
    v_mov_b32 v7, v94
    v_mov_b64 v[86:87], v[72:73]
    s_mov_b64 exec, -1
    s_or_b64 s[80:81], s[80:81], s[50:51]
    ds_read_b64 v[70:71], v93 offset:65408
    s_and_b64 exec, s[84:85], s[80:81]
    v_mfma_f32_4x4x4_16b_bf16 v[76:79], v[12:13], v[84:85], 0
    v_mov_b32 v92, v7
    s_andn2_b64 s[80:81], s[80:81], s[84:85]
    v_mfma_f32_4x4x4_16b_bf16 v[76:79], v[10:11], v[86:87], v[76:79]
    s_mov_b64 exec, -1
    ds_read_b64 v[68:69], v92 offset:65408
    v_and_b32 v46, 0x80000000, v33
    v_lshrrev_b32 v47, 14, v31
    v_bitop3_b32 v47, v47, v5, v46 bitop3:0xea
    ds_read_b64 v[106:107], v47
    v_bitop3_b32 v95, v31, v5, v46 bitop3:0xea
    v_and_b32 v46, 0x40000000, v33
    v_lshrrev_b32 v47, 14, v30
    v_bitop3_b32 v47, v47, v5, v46 bitop3:0xea
    ds_read_b64 v[104:105], v47
    v_bitop3_b32 v94, v30, v5, v46 bitop3:0xea
    s_waitcnt lgkmcnt(2)
    v_mfma_f32_4x4x4_16b_bf16 v[80:83], v[10:11], v[70:71], v[80:83]
    v_mfma_f32_4x4x4_16b_bf16 v[76:79], v[10:11], v[68:69], v[76:79]
    v_perm_b32 v15, v31, v32, s47
    v_bitop3_b32 v46, v31, 0.5, -0.5 bitop3:0xa8
    v_perm_b32 v14, v30, v32, s46
    v_bitop3_b32 v47, v30, 0.5, -0.5 bitop3:0xa8
    v_cvt_pk_bf16_f32 v80, v80, v81
    v_cvt_pk_bf16_f32 v81, v82, v83
    ds_wrxchg_rtn_b64 v[74:75], v93, v[80:81] offset:65408
    v_cvt_pk_bf16_f32 v76, v76, v77
    v_cvt_pk_bf16_f32 v77, v78, v79
    ds_wrxchg_rtn_b64 v[72:73], v92, v[76:77] offset:65408
    v_and_b32 v88, 0x0fffffff, v42
    v_mov_b32 v33, v42
    buffer_load_dwordx2 v[28:29], v88, s[8:11], 0 offen
    buffer_load_dwordx3 v[30:32], v88, s[8:11], 0 offen offset:8
    s_setprio 0
    s_waitcnt lgkmcnt(2)
    v_mfma_f32_4x4x4_16b_bf16 v[80:83], v[8:9], v[106:107], 0
    v_mfma_f32_4x4x4_16b_bf16 v[76:79], v[8:9], v[104:105], 0
    v_bitop3_b32 v15, v6, v15, v46 bitop3:0xca
    v_bitop3_b32 v14, v6, v14, v47 bitop3:0xca
    s_nop 1
    v_pk_mul_f32 v[80:81], v[80:81], v[14:15] op_sel:[0,1] op_sel_hi:[1,1]
    v_pk_mul_f32 v[82:83], v[82:83], v[14:15] op_sel:[0,1] op_sel_hi:[1,1]
    v_pk_mul_f32 v[76:77], v[76:77], v[14:15] op_sel:[0,0] op_sel_hi:[1,0]
    v_pk_mul_f32 v[78:79], v[78:79], v[14:15] op_sel:[0,0] op_sel_hi:[1,0]
    s_add_u32 s40, s40, 0x50000
    s_waitcnt lgkmcnt(0)
    v_cmp_ne_u64 s[50:51], v[72:73], v[68:69]
    v_cmpx_ne_u64 s[54:55], v[74:75], v[70:71]
    s_and_b64 s[82:83], s[54:55], s[80:81]
    s_cbranch_scc1 L2_c113
L2_d113:
    v_mov_b64 v[84:85], v[70:71]
    v_mov_b32 v7, v93
    v_mov_b64 v[86:87], v[74:75]
    s_or_b64 s[80:81], s[80:81], s[54:55]
    s_mov_b64 exec, s[50:51]
    s_and_b64 s[82:83], s[50:51], s[80:81]
    s_cbranch_scc1 L2_c114
L2_d114:
    v_mov_b64 v[84:85], v[68:69]
    v_mov_b32 v7, v92
    v_mov_b64 v[86:87], v[72:73]
    s_mov_b64 exec, -1
    s_or_b64 s[80:81], s[80:81], s[50:51]
    ds_read_b64 v[70:71], v95 offset:65408
    ds_read_b64 v[68:69], v94 offset:65408
    s_waitcnt vmcnt(8)
    v_and_b32 v46, 0x20000000, v39
    v_lshrrev_b32 v47, 14, v35
    v_bitop3_b32 v47, v47, v5, v46 bitop3:0xea
    ds_read_b64 v[102:103], v47
    v_bitop3_b32 v93, v35, v5, v46 bitop3:0xea
    v_and_b32 v46, 0x10000000, v39
    v_lshrrev_b32 v47, 14, v34
    v_bitop3_b32 v47, v47, v5, v46 bitop3:0xea
    ds_read_b64 v[100:101], v47
    v_bitop3_b32 v92, v34, v5, v46 bitop3:0xea
    v_and_b32 v46, 0x80000000, v39
    v_lshrrev_b32 v47, 14, v37
    v_bitop3_b32 v47, v47, v5, v46 bitop3:0xea
    ds_read_b64 v[106:107], v47
    v_and_b32 v46, 0x40000000, v39
    v_lshrrev_b32 v47, 14, v36
    v_bitop3_b32 v47, v47, v5, v46 bitop3:0xea
    ds_read_b64 v[104:105], v47
    s_waitcnt lgkmcnt(4)
    v_mfma_f32_4x4x4_16b_bf16 v[80:83], v[10:11], v[70:71], v[80:83]
    v_mfma_f32_4x4x4_16b_bf16 v[76:79], v[10:11], v[68:69], v[76:79]
    v_perm_b32 v15, v35, v38, s45
    v_bitop3_b32 v46, v35, 0.5, -0.5 bitop3:0xa8
    v_perm_b32 v14, v34, v38, s44
    v_bitop3_b32 v47, v34, 0.5, -0.5 bitop3:0xa8
    v_cvt_pk_bf16_f32 v80, v80, v81
    v_cvt_pk_bf16_f32 v81, v82, v83
    ds_wrxchg_rtn_b64 v[74:75], v95, v[80:81] offset:65408
    v_cvt_pk_bf16_f32 v76, v76, v77
    v_cvt_pk_bf16_f32 v77, v78, v79
    ds_wrxchg_rtn_b64 v[72:73], v94, v[76:77] offset:65408
    s_waitcnt lgkmcnt(2)
    s_barrier
    s_setprio 3
    s_mov_b32 m0, s100
    s_nop 0
    ds_write_addtid_b32 v116 offset:32768
    ds_write_addtid_b32 v117 offset:33024
    ds_write_addtid_b32 v118 offset:33280
    ds_write_addtid_b32 v119 offset:33536
    buffer_load_dwordx4 v[116:119], v3, s[16:19], s40 offen offset:2048
    ds_write_addtid_b32 v120 offset:33792
    ds_write_addtid_b32 v121 offset:34048
    ds_write_addtid_b32 v122 offset:34304
    ds_write_addtid_b32 v123 offset:34560
    buffer_load_dwordx4 v[120:123], v3, s[16:19], s40 offen offset:3072
    v_mfma_f32_4x4x4_16b_bf16 v[80:83], v[8:9], v[102:103], 0
    v_mfma_f32_4x4x4_16b_bf16 v[76:79], v[8:9], v[100:101], 0
    v_bitop3_b32 v15, v6, v15, v46 bitop3:0xca
    v_bitop3_b32 v14, v6, v14, v47 bitop3:0xca
    v_cmp_lt_u32 s[84:85], v5, v92
    s_nop 0
    v_pk_mul_f32 v[80:81], v[80:81], v[14:15] op_sel:[0,1] op_sel_hi:[1,1]
    v_pk_mul_f32 v[82:83], v[82:83], v[14:15] op_sel:[0,1] op_sel_hi:[1,1]
    v_pk_mul_f32 v[76:77], v[76:77], v[14:15] op_sel:[0,0] op_sel_hi:[1,0]
    v_pk_mul_f32 v[78:79], v[78:79], v[14:15] op_sel:[0,0] op_sel_hi:[1,0]
    v_mov_b32 v44, v43
    s_cmp_gt_u32 s37, 1024
    s_cbranch_scc1 L2_xs115
    s_cmp_lg_u32 s101, 0
    s_cbranch_scc1 L2_xa115
L2_xb115:
    v_lshlrev_b32 v89, 16, v96
    v_add_u32 v90, 60, v97
    v_bitop3_b32 v90, v89, v45, v90 bitop3:0x6a
    ds_write_b32 v98, v90 offset:12
    v_lshlrev_b32 v89, 20, v96
    v_add_u32 v90, 40, v97
    v_bitop3_b32 v90, v89, v45, v90 bitop3:0x6a
    ds_write_b32 v98, v90 offset:8
    v_lshlrev_b32 v89, 24, v96
    v_add_u32 v90, 20, v97
    v_bitop3_b32 v90, v89, v45, v90 bitop3:0x6a
    ds_write_b32 v98, v90 offset:4
    v_lshlrev_b32 v89, 28, v96
    v_bitop3_b32 v90, v89, v45, v97 bitop3:0x6a
    ds_write_b32 v98, v90 offset:0
    v_mov_b32_dpp v91, v66 quad_perm:[1,1,1,1] row_mask:0xf bank_mask:0xf
    v_and_b32 v89, 3, v91
    v_and_b32 v97, 0xfffc, v91
    v_sub_u16_dpp v88, v66, v91 quad_perm:[3,3,3,3] row_mask:0xf bank_mask:0xf
    v_mad_u32_u24 v97, v97, 5, v4
    v_add_u32 v99, v88, v89
    v_bfm_b32 v96, v88, v89
    v_cmp_lt_u32 s[58:59], 16, v99
    v_lshlrev_b32 v89, v1, v96
    v_and_b32 v89, v45, v89
    v_cmp_ne_u32 vcc, 0, v89
    v_xor_b32 v90, v97, v89
    s_add_u32 s3, s37, s38
    v_mbcnt_lo_u32_b32 v98, vcc_lo, 0
    v_mbcnt_hi_u32_b32 v98, vcc_hi, v98
    s_bcnt1_i32_b64 s41, vcc
    v_lshl_add_u32 v98, v98, 2, s3
    s_mov_b64 exec, vcc
    ds_write_b32 v98, v90
    s_mov_b64 exec, -1
    s_lshl2_add_u32 s37, s41, s37
    s_cmp_lg_u64 s[58:59], 0
    s_cbranch_scc1 L2_xe115
L2_xr115:
    v_add_u32 v98, s37, v0
    v_mov_b32 v90, -1
    ds_write_b32 v98, v90
    ds_read2st64_b32 v[40:41], v0 offset0:0 offset1:1
    ds_read2st64_b32 v[42:43], v0 offset0:2 offset1:3
    s_sub_u32 s3, s37, 768
    s_cmp_gt_u32 s3, 256
    s_cbranch_scc1 L2_xf115
L2_xg115:
    v_lshrrev_b64 v[64:65], 16, v[64:65]
    v_lshrrev_b64 v[66:67], 16, v[66:67]
    s_setprio 2
    ds_write_addtid_b32 v124 offset:34816
    ds_write_addtid_b32 v125 offset:35072
    ds_write_addtid_b32 v126 offset:35328
    ds_write_addtid_b32 v127 offset:35584
    s_add_u32 s3, s40, 4096
    buffer_load_dwordx4 v[124:127], v3, s[16:19], s3 offen
    s_waitcnt lgkmcnt(14)
    v_cmp_ne_u64 s[50:51], v[72:73], v[68:69]
    v_cmpx_ne_u64 s[54:55], v[74:75], v[70:71]
    s_and_b64 s[82:83], s[54:55], s[80:81]
    s_cbranch_scc1 L2_c116
L2_d116:
    v_mov_b64 v[84:85], v[70:71]
    v_mov_b32 v7, v95
    v_mov_b64 v[86:87], v[74:75]
    s_or_b64 s[80:81], s[80:81], s[54:55]
    s_mov_b64 exec, s[50:51]
    s_and_b64 s[82:83], s[50:51], s[80:81]
    s_cbranch_scc1 L2_c117
L2_d117:
    v_mov_b64 v[84:85], v[68:69]
    v_mov_b32 v7, v94
    v_mov_b64 v[86:87], v[72:73]
    s_mov_b64 exec, -1
    s_or_b64 s[80:81], s[80:81], s[50:51]
    ds_read_b64 v[70:71], v93 offset:65408
    s_and_b64 exec, s[84:85], s[80:81]
    v_mfma_f32_4x4x4_16b_bf16 v[76:79], v[12:13], v[84:85], 0
    v_mov_b32 v92, v7
    s_andn2_b64 s[80:81], s[80:81], s[84:85]
    v_mfma_f32_4x4x4_16b_bf16 v[76:79], v[10:11], v[86:87], v[76:79]
    s_mov_b64 exec, -1
    ds_read_b64 v[68:69], v92 offset:65408
    s_setprio 1
    s_waitcnt vmcnt(10)
    s_mov_b32 m0, s38
    s_nop 0
    ds_write_addtid_b32 v108 offset:0
    ds_write_addtid_b32 v109 offset:256
    ds_write_addtid_b32 v110 offset:512
    ds_write_addtid_b32 v111 offset:768
    s_waitcnt lgkmcnt(4)
    v_mfma_f32_4x4x4_16b_bf16 v[80:83], v[10:11], v[70:71], v[80:83]
    v_mfma_f32_4x4x4_16b_bf16 v[76:79], v[10:11], v[68:69], v[76:79]
    v_and_b32 v46, 0x40000000, v39
    v_bitop3_b32 v94, v36, v5, v46 bitop3:0xea
    v_and_b32 v46, 0x80000000, v39
    v_bitop3_b32 v95, v37, v5, v46 bitop3:0xea
    v_perm_b32 v15, v37, v38, s47
    v_bitop3_b32 v46, v37, 0.5, -0.5 bitop3:0xa8
    v_perm_b32 v14, v36, v38, s46
    v_bitop3_b32 v47, v36, 0.5, -0.5 bitop3:0xa8
    v_cvt_pk_bf16_f32 v80, v80, v81
    v_cvt_pk_bf16_f32 v81, v82, v83
    ds_wrxchg_rtn_b64 v[74:75], v93, v[80:81] offset:65408
    v_cvt_pk_bf16_f32 v76, v76, v77
    v_cvt_pk_bf16_f32 v77, v78, v79
    ds_wrxchg_rtn_b64 v[72:73], v92, v[76:77] offset:65408
    v_and_b32 v88, 0x0fffffff, v44
    v_mov_b32 v39, v44
    buffer_load_dwordx2 v[34:35], v88, s[8:11], 0 offen
    buffer_load_dwordx3 v[36:38], v88, s[8:11], 0 offen offset:8
    s_setprio 0
    s_waitcnt vmcnt(11)
    ds_write_addtid_b32 v112 offset:1024
    ds_write_addtid_b32 v113 offset:1280
    ds_write_addtid_b32 v114 offset:1536
    ds_write_addtid_b32 v115 offset:1792
    v_mfma_f32_4x4x4_16b_bf16 v[80:83], v[8:9], v[106:107], 0
    v_mfma_f32_4x4x4_16b_bf16 v[76:79], v[8:9], v[104:105], 0
    v_bitop3_b32 v15, v6, v15, v46 bitop3:0xca
    v_bitop3_b32 v14, v6, v14, v47 bitop3:0xca
    s_nop 1
    v_pk_mul_f32 v[80:81], v[80:81], v[14:15] op_sel:[0,1] op_sel_hi:[1,1]
    v_pk_mul_f32 v[82:83], v[82:83], v[14:15] op_sel:[0,1] op_sel_hi:[1,1]
    v_pk_mul_f32 v[76:77], v[76:77], v[14:15] op_sel:[0,0] op_sel_hi:[1,0]
    v_pk_mul_f32 v[78:79], v[78:79], v[14:15] op_sel:[0,0] op_sel_hi:[1,0]
    s_add_u32 s42, s42, 1
    s_waitcnt lgkmcnt(0)
    s_cmp_lg_u32 s42, 14
    s_cbranch_scc1 L2_loop
    s_barrier
    s_bitcmp1_b32 s36, s42
    s_cbranch_scc1 L2_slow
L2_ret6:
    s_setprio 3
    buffer_load_dwordx4 v[108:111], v3, s[16:19], s40 offen offset:0
    v_cmp_ne_u64 s[50:51], v[72:73], v[68:69]
    v_cmpx_ne_u64 s[54:55], v[74:75], v[70:71]
    s_and_b64 s[82:83], s[54:55], s[80:81]
    s_cbranch_scc1 L2_c118
L2_d118:
    v_mov_b64 v[84:85], v[70:71]
    v_mov_b32 v7, v93
    v_mov_b64 v[86:87], v[74:75]
    s_or_b64 s[80:81], s[80:81], s[54:55]
    s_mov_b64 exec, s[50:51]
    s_and_b64 s[82:83], s[50:51], s[80:81]
    s_cbranch_scc1 L2_c119
L2_d119:
    v_mov_b64 v[84:85], v[68:69]
    v_mov_b32 v7, v92
    v_mov_b64 v[86:87], v[72:73]
    s_mov_b64 exec, -1
    s_or_b64 s[80:81], s[80:81], s[50:51]
    ds_read_b64 v[70:71], v95 offset:65408
    ds_read_b64 v[68:69], v94 offset:65408
    s_waitcnt vmcnt(10)
    v_and_b32 v46, 0x20000000, v21
    v_lshrrev_b32 v47, 14, v17
    v_bitop3_b32 v47, v47, v5, v46 bitop3:0xea
    ds_read_b64 v[102:103], v47
    v_bitop3_b32 v93, v17, v5, v46 bitop3:0xea
    v_and_b32 v46, 0x10000000, v21
    v_lshrrev_b32 v47, 14, v16
    v_bitop3_b32 v47, v47, v5, v46 bitop3:0xea
    ds_read_b64 v[100:101], v47
    v_bitop3_b32 v92, v16, v5, v46 bitop3:0xea
    s_waitcnt lgkmcnt(2)
    v_mfma_f32_4x4x4_16b_bf16 v[80:83], v[10:11], v[70:71], v[80:83]
    v_mfma_f32_4x4x4_16b_bf16 v[76:79], v[10:11], v[68:69], v[76:79]
    v_perm_b32 v15, v17, v20, s45
    v_bitop3_b32 v46, v17, 0.5, -0.5 bitop3:0xa8
    v_perm_b32 v14, v16, v20, s44
    v_bitop3_b32 v47, v16, 0.5, -0.5 bitop3:0xa8
    v_cvt_pk_bf16_f32 v80, v80, v81
    v_cvt_pk_bf16_f32 v81, v82, v83
    ds_wrxchg_rtn_b64 v[74:75], v95, v[80:81] offset:65408
    v_cvt_pk_bf16_f32 v76, v76, v77
    v_cvt_pk_bf16_f32 v77, v78, v79
    ds_wrxchg_rtn_b64 v[72:73], v94, v[76:77] offset:65408
    s_waitcnt lgkmcnt(2)
    v_mfma_f32_4x4x4_16b_bf16 v[80:83], v[8:9], v[102:103], 0
    v_mfma_f32_4x4x4_16b_bf16 v[76:79], v[8:9], v[100:101], 0
    v_bitop3_b32 v15, v6, v15, v46 bitop3:0xca
    v_bitop3_b32 v14, v6, v14, v47 bitop3:0xca
    v_cmp_lt_u32 s[84:85], v5, v92
    s_nop 0
    v_pk_mul_f32 v[80:81], v[80:81], v[14:15] op_sel:[0,1] op_sel_hi:[1,1]
    v_pk_mul_f32 v[82:83], v[82:83], v[14:15] op_sel:[0,1] op_sel_hi:[1,1]
    v_pk_mul_f32 v[76:77], v[76:77], v[14:15] op_sel:[0,0] op_sel_hi:[1,0]
    v_pk_mul_f32 v[78:79], v[78:79], v[14:15] op_sel:[0,0] op_sel_hi:[1,0]
    buffer_load_dwordx4 v[112:115], v3, s[16:19], s40 offen offset:1024
    s_waitcnt lgkmcnt(0)
    v_cmp_ne_u64 s[50:51], v[72:73], v[68:69]
    v_cmpx_ne_u64 s[54:55], v[74:75], v[70:71]
    s_and_b64 s[82:83], s[54:55], s[80:81]
    s_cbranch_scc1 L2_c120
L2_d120:
    v_mov_b64 v[84:85], v[70:71]
    v_mov_b32 v7, v95
    v_mov_b64 v[86:87], v[74:75]
    s_or_b64 s[80:81], s[80:81], s[54:55]
    s_mov_b64 exec, s[50:51]
    s_and_b64 s[82:83], s[50:51], s[80:81]
    s_cbranch_scc1 L2_c121
L2_d121:
    v_mov_b64 v[84:85], v[68:69]
    v_mov_b32 v7, v94
    v_mov_b64 v[86:87], v[72:73]
    s_mov_b64 exec, -1
    s_or_b64 s[80:81], s[80:81], s[50:51]
    ds_read_b64 v[70:71], v93 offset:65408
    s_and_b64 exec, s[84:85], s[80:81]
    v_mfma_f32_4x4x4_16b_bf16 v[76:79], v[12:13], v[84:85], 0
    v_mov_b32 v92, v7
    s_andn2_b64 s[80:81], s[80:81], s[84:85]
    v_mfma_f32_4x4x4_16b_bf16 v[76:79], v[10:11], v[86:87], v[76:79]
    s_mov_b64 exec, -1
    ds_read_b64 v[68:69], v92 offset:65408
    v_and_b32 v46, 0x80000000, v21
    v_lshrrev_b32 v47, 14, v19
    v_bitop3_b32 v47, v47, v5, v46 bitop3:0xea
    ds_read_b64 v[106:107], v47
    v_bitop3_b32 v95, v19, v5, v46 bitop3:0xea
    v_and_b32 v46, 0x40000000, v21
    v_lshrrev_b32 v47, 14, v18
    v_bitop3_b32 v47, v47, v5, v46 bitop3:0xea
    ds_read_b64 v[104:105], v47
    v_bitop3_b32 v94, v18, v5, v46 bitop3:0xea
    s_waitcnt lgkmcnt(2)
    v_mfma_f32_4x4x4_16b_bf16 v[80:83], v[10:11], v[70:71], v[80:83]
    v_mfma_f32_4x4x4_16b_bf16 v[76:79], v[10:11], v[68:69], v[76:79]
    v_perm_b32 v15, v19, v20, s47
    v_bitop3_b32 v46, v19, 0.5, -0.5 bitop3:0xa8
    v_perm_b32 v14, v18, v20, s46
    v_bitop3_b32 v47, v18, 0.5, -0.5 bitop3:0xa8
    v_cvt_pk_bf16_f32 v80, v80, v81
    v_cvt_pk_bf16_f32 v81, v82, v83
    ds_wrxchg_rtn_b64 v[74:75], v93, v[80:81] offset:65408
    v_cvt_pk_bf16_f32 v76, v76, v77
    v_cvt_pk_bf16_f32 v77, v78, v79
    ds_wrxchg_rtn_b64 v[72:73], v92, v[76:77] offset:65408
    v_and_b32 v88, 0x0fffffff, v40
    v_mov_b32 v21, v40
    buffer_load_dwordx2 v[16:17], v88, s[8:11], 0 offen
    buffer_load_dwordx3 v[18:20], v88, s[8:11], 0 offen offset:8
    s_setprio 2
    s_waitcnt lgkmcnt(2)
    v_mfma_f32_4x4x4_16b_bf16 v[80:83], v[8:9], v[106:107], 0
    v_mfma_f32_4x4x4_16b_bf16 v[76:79], v[8:9], v[104:105], 0
    v_bitop3_b32 v15, v6, v15, v46 bitop3:0xca
    v_bitop3_b32 v14, v6, v14, v47 bitop3:0xca
    s_nop 1
    v_pk_mul_f32 v[80:81], v[80:81], v[14:15] op_sel:[0,1] op_sel_hi:[1,1]
    v_pk_mul_f32 v[82:83], v[82:83], v[14:15] op_sel:[0,1] op_sel_hi:[1,1]
    v_pk_mul_f32 v[76:77], v[76:77], v[14:15] op_sel:[0,0] op_sel_hi:[1,0]
    v_pk_mul_f32 v[78:79], v[78:79], v[14:15] op_sel:[0,0] op_sel_hi:[1,0]
    s_waitcnt lgkmcnt(0)
    v_cmp_ne_u64 s[50:51], v[72:73], v[68:69]
    v_cmpx_ne_u64 s[54:55], v[74:75], v[70:71]
    s_and_b64 s[82:83], s[54:55], s[80:81]
    s_cbranch_scc1 L2_c122
L2_d122:
    v_mov_b64 v[84:85], v[70:71]
    v_mov_b32 v7, v93
    v_mov_b64 v[86:87], v[74:75]
    s_or_b64 s[80:81], s[80:81], s[54:55]
    s_mov_b64 exec, s[50:51]
    s_and_b64 s[82:83], s[50:51], s[80:81]
    s_cbranch_scc1 L2_c123
L2_d123:
    v_mov_b64 v[84:85], v[68:69]
    v_mov_b32 v7, v92
    v_mov_b64 v[86:87], v[72:73]
    s_mov_b64 exec, -1
    s_or_b64 s[80:81], s[80:81], s[50:51]
    ds_read_b64 v[70:71], v95 offset:65408
    ds_read_b64 v[68:69], v94 offset:65408
    s_waitcnt vmcnt(11)
    v_and_b32 v46, 0x20000000, v27
    v_lshrrev_b32 v47, 14, v23
    v_bitop3_b32 v47, v47, v5, v46 bitop3:0xea
    ds_read_b64 v[102:103], v47
    v_bitop3_b32 v93, v23, v5, v46 bitop3:0xea
    v_and_b32 v46, 0x10000000, v27
    v_lshrrev_b32 v47, 14, v22
    v_bitop3_b32 v47, v47, v5, v46 bitop3:0xea
    ds_read_b64 v[100:101], v47
    v_bitop3_b32 v92, v22, v5, v46 bitop3:0xea
    s_waitcnt lgkmcnt(2)
    v_mfma_f32_4x4x4_16b_bf16 v[80:83], v[10:11], v[70:71], v[80:83]
    v_mfma_f32_4x4x4_16b_bf16 v[76:79], v[10:11], v[68:69], v[76:79]
    v_perm_b32 v15, v23, v26, s45
    v_bitop3_b32 v46, v23, 0.5, -0.5 bitop3:0xa8
    v_perm_b32 v14, v22, v26, s44
    v_bitop3_b32 v47, v22, 0.5, -0.5 bitop3:0xa8
    v_cvt_pk_bf16_f32 v80, v80, v81
    v_cvt_pk_bf16_f32 v81, v82, v83
    ds_wrxchg_rtn_b64 v[74:75], v95, v[80:81] offset:65408
    v_cvt_pk_bf16_f32 v76, v76, v77
    v_cvt_pk_bf16_f32 v77, v78, v79
    ds_wrxchg_rtn_b64 v[72:73], v94, v[76:77] offset:65408
    s_waitcnt lgkmcnt(2)
    v_mfma_f32_4x4x4_16b_bf16 v[80:83], v[8:9], v[102:103], 0
    v_mfma_f32_4x4x4_16b_bf16 v[76:79], v[8:9], v[100:101], 0
    v_bitop3_b32 v15, v6, v15, v46 bitop3:0xca
    v_bitop3_b32 v14, v6, v14, v47 bitop3:0xca
    v_cmp_lt_u32 s[84:85], v5, v92
    s_nop 0
    v_pk_mul_f32 v[80:81], v[80:81], v[14:15] op_sel:[0,1] op_sel_hi:[1,1]
    v_pk_mul_f32 v[82:83], v[82:83], v[14:15] op_sel:[0,1] op_sel_hi:[1,1]
    v_pk_mul_f32 v[76:77], v[76:77], v[14:15] op_sel:[0,0] op_sel_hi:[1,0]
    v_pk_mul_f32 v[78:79], v[78:79], v[14:15] op_sel:[0,0] op_sel_hi:[1,0]
    s_waitcnt lgkmcnt(0)
    v_cmp_ne_u64 s[50:51], v[72:73], v[68:69]
    v_cmpx_ne_u64 s[54:55], v[74:75], v[70:71]
    s_and_b64 s[82:83], s[54:55], s[80:81]
    s_cbranch_scc1 L2_c124
L2_d124:
    v_mov_b64 v[84:85], v[70:71]
    v_mov_b32 v7, v95
    v_mov_b64 v[86:87], v[74:75]
    s_or_b64 s[80:81], s[80:81], s[54:55]
    s_mov_b64 exec, s[50:51]
    s_and_b64 s[82:83], s[50:51], s[80:81]
    s_cbranch_scc1 L2_c125
L2_d125:
    v_mov_b64 v[84:85], v[68:69]
    v_mov_b32 v7, v94
    v_mov_b64 v[86:87], v[72:73]
    s_mov_b64 exec, -1
    s_or_b64 s[80:81], s[80:81], s[50:51]
    ds_read_b64 v[70:71], v93 offset:65408
    s_and_b64 exec, s[84:85], s[80:81]
    v_mfma_f32_4x4x4_16b_bf16 v[76:79], v[12:13], v[84:85], 0
    v_mov_b32 v92, v7
    s_andn2_b64 s[80:81], s[80:81], s[84:85]
    v_mfma_f32_4x4x4_16b_bf16 v[76:79], v[10:11], v[86:87], v[76:79]
    s_mov_b64 exec, -1
    ds_read_b64 v[68:69], v92 offset:65408
    v_and_b32 v46, 0x80000000, v27
    v_lshrrev_b32 v47, 14, v25
    v_bitop3_b32 v47, v47, v5, v46 bitop3:0xea
    ds_read_b64 v[106:107], v47
    v_bitop3_b32 v95, v25, v5, v46 bitop3:0xea
    v_and_b32 v46, 0x40000000, v27
    v_lshrrev_b32 v47, 14, v24
    v_bitop3_b32 v47, v47, v5, v46 bitop3:0xea
    ds_read_b64 v[104:105], v47
    v_bitop3_b32 v94, v24, v5, v46 bitop3:0xea
    s_waitcnt lgkmcnt(2)
    v_mfma_f32_4x4x4_16b_bf16 v[80:83], v[10:11], v[70:71], v[80:83]
    v_mfma_f32_4x4x4_16b_bf16 v[76:79], v[10:11], v[68:69], v[76:79]
    v_perm_b32 v15, v25, v26, s47
    v_bitop3_b32 v46, v25, 0.5, -0.5 bitop3:0xa8
    v_perm_b32 v14, v24, v26, s46
    v_bitop3_b32 v47, v24, 0.5, -0.5 bitop3:0xa8
    v_cvt_pk_bf16_f32 v80, v80, v81
    v_cvt_pk_bf16_f32 v81, v82, v83
    ds_wrxchg_rtn_b64 v[74:75], v93, v[80:81] offset:65408
    v_cvt_pk_bf16_f32 v76, v76, v77
    v_cvt_pk_bf16_f32 v77, v78, v79
    ds_wrxchg_rtn_b64 v[72:73], v92, v[76:77] offset:65408
    v_and_b32 v88, 0x0fffffff, v41
    v_mov_b32 v27, v41
    buffer_load_dwordx2 v[22:23], v88, s[8:11], 0 offen
    buffer_load_dwordx3 v[24:26], v88, s[8:11], 0 offen offset:8
    s_setprio 1
    s_waitcnt lgkmcnt(2)
    v_mfma_f32_4x4x4_16b_bf16 v[80:83], v[8:9], v[106:107], 0
    v_mfma_f32_4x4x4_16b_bf16 v[76:79], v[8:9], v[104:105], 0
    v_bitop3_b32 v15, v6, v15, v46 bitop3:0xca
    v_bitop3_b32 v14, v6, v14, v47 bitop3:0xca
    s_nop 1
    v_pk_mul_f32 v[80:81], v[80:81], v[14:15] op_sel:[0,1] op_sel_hi:[1,1]
    v_pk_mul_f32 v[82:83], v[82:83], v[14:15] op_sel:[0,1] op_sel_hi:[1,1]
    v_pk_mul_f32 v[76:77], v[76:77], v[14:15] op_sel:[0,0] op_sel_hi:[1,0]
    v_pk_mul_f32 v[78:79], v[78:79], v[14:15] op_sel:[0,0] op_sel_hi:[1,0]
    s_waitcnt lgkmcnt(0)
    v_cmp_ne_u64 s[50:51], v[72:73], v[68:69]
    v_cmpx_ne_u64 s[54:55], v[74:75], v[70:71]
    s_and_b64 s[82:83], s[54:55], s[80:81]
    s_cbranch_scc1 L2_c126
L2_d126:
    v_mov_b64 v[84:85], v[70:71]
    v_mov_b32 v7, v93
    v_mov_b64 v[86:87], v[74:75]
    s_or_b64 s[80:81], s[80:81], s[54:55]
    s_mov_b64 exec, s[50:51]
    s_and_b64 s[82:83], s[50:51], s[80:81]
    s_cbranch_scc1 L2_c127
L2_d127:
    v_mov_b64 v[84:85], v[68:69]
    v_mov_b32 v7, v92
    v_mov_b64 v[86:87], v[72:73]
    s_mov_b64 exec, -1
    s_or_b64 s[80:81], s[80:81], s[50:51]
    ds_read_b64 v[70:71], v95 offset:65408
    ds_read_b64 v[68:69], v94 offset:65408
    s_waitcnt vmcnt(11)
    v_and_b32 v46, 0x20000000, v33
    v_lshrrev_b32 v47, 14, v29
    v_bitop3_b32 v47, v47, v5, v46 bitop3:0xea
    ds_read_b64 v[102:103], v47
    v_bitop3_b32 v93, v29, v5, v46 bitop3:0xea
    v_and_b32 v46, 0x10000000, v33
    v_lshrrev_b32 v47, 14, v28
    v_bitop3_b32 v47, v47, v5, v46 bitop3:0xea
    ds_read_b64 v[100:101], v47
    v_bitop3_b32 v92, v28, v5, v46 bitop3:0xea
    s_waitcnt lgkmcnt(2)
    v_mfma_f32_4x4x4_16b_bf16 v[80:83], v[10:11], v[70:71], v[80:83]
    v_mfma_f32_4x4x4_16b_bf16 v[76:79], v[10:11], v[68:69], v[76:79]
    v_perm_b32 v15, v29, v32, s45
    v_bitop3_b32 v46, v29, 0.5, -0.5 bitop3:0xa8
    v_perm_b32 v14, v28, v32, s44
    v_bitop3_b32 v47, v28, 0.5, -0.5 bitop3:0xa8
    v_cvt_pk_bf16_f32 v80, v80, v81
    v_cvt_pk_bf16_f32 v81, v82, v83
    ds_wrxchg_rtn_b64 v[74:75], v95, v[80:81] offset:65408
    v_cvt_pk_bf16_f32 v76, v76, v77
    v_cvt_pk_bf16_f32 v77, v78, v79
    ds_wrxchg_rtn_b64 v[72:73], v94, v[76:77] offset:65408
    s_waitcnt lgkmcnt(2)
    v_mfma_f32_4x4x4_16b_bf16 v[80:83], v[8:9], v[102:103], 0
    v_mfma_f32_4x4x4_16b_bf16 v[76:79], v[8:9], v[100:101], 0
    v_bitop3_b32 v15, v6, v15, v46 bitop3:0xca
    v_bitop3_b32 v14, v6, v14, v47 bitop3:0xca
    v_cmp_lt_u32 s[84:85], v5, v92
    s_nop 0
    v_pk_mul_f32 v[80:81], v[80:81], v[14:15] op_sel:[0,1] op_sel_hi:[1,1]
    v_pk_mul_f32 v[82:83], v[82:83], v[14:15] op_sel:[0,1] op_sel_hi:[1,1]
    v_pk_mul_f32 v[76:77], v[76:77], v[14:15] op_sel:[0,0] op_sel_hi:[1,0]
    v_pk_mul_f32 v[78:79], v[78:79], v[14:15] op_sel:[0,0] op_sel_hi:[1,0]
    s_waitcnt lgkmcnt(0)
    v_cmp_ne_u64 s[50:51], v[72:73], v[68:69]
    v_cmpx_ne_u64 s[54:55], v[74:75], v[70:71]
    s_and_b64 s[82:83], s[54:55], s[80:81]
    s_cbranch_scc1 L2_c128
L2_d128:
    v_mov_b64 v[84:85], v[70:71]
    v_mov_b32 v7, v95
    v_mov_b64 v[86:87], v[74:75]
    s_or_b64 s[80:81], s[80:81], s[54:55]
    s_mov_b64 exec, s[50:51]
    s_and_b64 s[82:83], s[50:51], s[80:81]
    s_cbranch_scc1 L2_c129
L2_d129:
    v_mov_b64 v[84:85], v[68:69]
    v_mov_b32 v7, v94
    v_mov_b64 v[86:87], v[72:73]
    s_mov_b64 exec, -1
    s_or_b64 s[80:81], s[80:81], s[50:51]
    ds_read_b64 v[70:71], v93 offset:65408
    s_and_b64 exec, s[84:85], s[80:81]
    v_mfma_f32_4x4x4_16b_bf16 v[76:79], v[12:13], v[84:85], 0
    v_mov_b32 v92, v7
    s_andn2_b64 s[80:81], s[80:81], s[84:85]
    v_mfma_f32_4x4x4_16b_bf16 v[76:79], v[10:11], v[86:87], v[76:79]
    s_mov_b64 exec, -1
    ds_read_b64 v[68:69], v92 offset:65408
    v_and_b32 v46, 0x80000000, v33
    v_lshrrev_b32 v47, 14, v31
    v_bitop3_b32 v47, v47, v5, v46 bitop3:0xea
    ds_read_b64 v[106:107], v47
    v_bitop3_b32 v95, v31, v5, v46 bitop3:0xea
    v_and_b32 v46, 0x40000000, v33
    v_lshrrev_b32 v47, 14, v30
    v_bitop3_b32 v47, v47, v5, v46 bitop3:0xea
    ds_read_b64 v[104:105], v47
    v_bitop3_b32 v94, v30, v5, v46 bitop3:0xea
    s_waitcnt lgkmcnt(2)
    v_mfma_f32_4x4x4_16b_bf16 v[80:83], v[10:11], v[70:71], v[80:83]
    v_mfma_f32_4x4x4_16b_bf16 v[76:79], v[10:11], v[68:69], v[76:79]
    v_perm_b32 v15, v31, v32, s47
    v_bitop3_b32 v46, v31, 0.5, -0.5 bitop3:0xa8
    v_perm_b32 v14, v30, v32, s46
    v_bitop3_b32 v47, v30, 0.5, -0.5 bitop3:0xa8
    v_cvt_pk_bf16_f32 v80, v80, v81
    v_cvt_pk_bf16_f32 v81, v82, v83
    ds_wrxchg_rtn_b64 v[74:75], v93, v[80:81] offset:65408
    v_cvt_pk_bf16_f32 v76, v76, v77
    v_cvt_pk_bf16_f32 v77, v78, v79
    ds_wrxchg_rtn_b64 v[72:73], v92, v[76:77] offset:65408
    v_and_b32 v88, 0x0fffffff, v42
    v_mov_b32 v33, v42
    buffer_load_dwordx2 v[28:29], v88, s[8:11], 0 offen
    buffer_load_dwordx3 v[30:32], v88, s[8:11], 0 offen offset:8
    s_setprio 0
    s_waitcnt lgkmcnt(2)
    v_mfma_f32_4x4x4_16b_bf16 v[80:83], v[8:9], v[106:107], 0
    v_mfma_f32_4x4x4_16b_bf16 v[76:79], v[8:9], v[104:105], 0
    v_bitop3_b32 v15, v6, v15, v46 bitop3:0xca
    v_bitop3_b32 v14, v6, v14, v47 bitop3:0xca
    s_nop 1
    v_pk_mul_f32 v[80:81], v[80:81], v[14:15] op_sel:[0,1] op_sel_hi:[1,1]
    v_pk_mul_f32 v[82:83], v[82:83], v[14:15] op_sel:[0,1] op_sel_hi:[1,1]
    v_pk_mul_f32 v[76:77], v[76:77], v[14:15] op_sel:[0,0] op_sel_hi:[1,0]
    v_pk_mul_f32 v[78:79], v[78:79], v[14:15] op_sel:[0,0] op_sel_hi:[1,0]
    s_add_u32 s40, s40, 0xfff24000
    s_waitcnt lgkmcnt(0)
    v_cmp_ne_u64 s[50:51], v[72:73], v[68:69]
    v_cmpx_ne_u64 s[54:55], v[74:75], v[70:71]
    s_and_b64 s[82:83], s[54:55], s[80:81]
    s_cbranch_scc1 L2_c130
L2_d130:
    v_mov_b64 v[84:85], v[70:71]
    v_mov_b32 v7, v93
    v_mov_b64 v[86:87], v[74:75]
    s_or_b64 s[80:81], s[80:81], s[54:55]
    s_mov_b64 exec, s[50:51]
    s_and_b64 s[82:83], s[50:51], s[80:81]
    s_cbranch_scc1 L2_c131
L2_d131:
    v_mov_b64 v[84:85], v[68:69]
    v_mov_b32 v7, v92
    v_mov_b64 v[86:87], v[72:73]
    s_mov_b64 exec, -1
    s_or_b64 s[80:81], s[80:81], s[50:51]
    ds_read_b64 v[70:71], v95 offset:65408
    ds_read_b64 v[68:69], v94 offset:65408
    s_waitcnt vmcnt(8)
    v_and_b32 v46, 0x20000000, v39
    v_lshrrev_b32 v47, 14, v35
    v_bitop3_b32 v47, v47, v5, v46 bitop3:0xea
    ds_read_b64 v[102:103], v47
    v_bitop3_b32 v93, v35, v5, v46 bitop3:0xea
    v_and_b32 v46, 0x10000000, v39
    v_lshrrev_b32 v47, 14, v34
    v_bitop3_b32 v47, v47, v5, v46 bitop3:0xea
    ds_read_b64 v[100:101], v47
    v_bitop3_b32 v92, v34, v5, v46 bitop3:0xea
    v_and_b32 v46, 0x80000000, v39
    v_lshrrev_b32 v47, 14, v37
    v_bitop3_b32 v47, v47, v5, v46 bitop3:0xea
    ds_read_b64 v[106:107], v47
    v_and_b32 v46, 0x40000000, v39
    v_lshrrev_b32 v47, 14, v36
    v_bitop3_b32 v47, v47, v5, v46 bitop3:0xea
    ds_read_b64 v[104:105], v47
    s_waitcnt lgkmcnt(4)
    v_mfma_f32_4x4x4_16b_bf16 v[80:83], v[10:11], v[70:71], v[80:83]
    v_mfma_f32_4x4x4_16b_bf16 v[76:79], v[10:11], v[68:69], v[76:79]
    v_perm_b32 v15, v35, v38, s45
    v_bitop3_b32 v46, v35, 0.5, -0.5 bitop3:0xa8
    v_perm_b32 v14, v34, v38, s44
    v_bitop3_b32 v47, v34, 0.5, -0.5 bitop3:0xa8
    v_cvt_pk_bf16_f32 v80, v80, v81
    v_cvt_pk_bf16_f32 v81, v82, v83
    ds_wrxchg_rtn_b64 v[74:75], v95, v[80:81] offset:65408
    v_cvt_pk_bf16_f32 v76, v76, v77
    v_cvt_pk_bf16_f32 v77, v78, v79
    ds_wrxchg_rtn_b64 v[72:73], v94, v[76:77] offset:65408
    s_waitcnt lgkmcnt(2)
    s_barrier
    s_setprio 3
    s_mov_b32 m0, s100
    s_nop 0
    ds_write_addtid_b32 v116 offset:32768
    ds_write_addtid_b32 v117 offset:33024
    ds_write_addtid_b32 v118 offset:33280
    ds_write_addtid_b32 v119 offset:33536
    ds_write_addtid_b32 v120 offset:33792
    ds_write_addtid_b32 v121 offset:34048
    ds_write_addtid_b32 v122 offset:34304
    ds_write_addtid_b32 v123 offset:34560
    v_mfma_f32_4x4x4_16b_bf16 v[80:83], v[8:9], v[102:103], 0
    v_mfma_f32_4x4x4_16b_bf16 v[76:79], v[8:9], v[100:101], 0
    v_bitop3_b32 v15, v6, v15, v46 bitop3:0xca
    v_bitop3_b32 v14, v6, v14, v47 bitop3:0xca
    v_cmp_lt_u32 s[84:85], v5, v92
    s_nop 0
    v_pk_mul_f32 v[80:81], v[80:81], v[14:15] op_sel:[0,1] op_sel_hi:[1,1]
    v_pk_mul_f32 v[82:83], v[82:83], v[14:15] op_sel:[0,1] op_sel_hi:[1,1]
    v_pk_mul_f32 v[76:77], v[76:77], v[14:15] op_sel:[0,0] op_sel_hi:[1,0]
    v_pk_mul_f32 v[78:79], v[78:79], v[14:15] op_sel:[0,0] op_sel_hi:[1,0]
    v_mov_b32 v44, v43
    s_setprio 2
    ds_write_addtid_b32 v124 offset:34816
    ds_write_addtid_b32 v125 offset:35072
    ds_write_addtid_b32 v126 offset:35328
    ds_write_addtid_b32 v127 offset:35584
    s_waitcnt lgkmcnt(12)
    v_cmp_ne_u64 s[50:51], v[72:73], v[68:69]
    v_cmpx_ne_u64 s[54:55], v[74:75], v[70:71]
    s_and_b64 s[82:83], s[54:55], s[80:81]
    s_cbranch_scc1 L2_c132
L2_d132:
    v_mov_b64 v[84:85], v[70:71]
    v_mov_b32 v7, v95
    v_mov_b64 v[86:87], v[74:75]
    s_or_b64 s[80:81], s[80:81], s[54:55]
    s_mov_b64 exec, s[50:51]
    s_and_b64 s[82:83], s[50:51], s[80:81]
    s_cbranch_scc1 L2_c133
L2_d133:
    v_mov_b64 v[84:85], v[68:69]
    v_mov_b32 v7, v94
    v_mov_b64 v[86:87], v[72:73]
    s_mov_b64 exec, -1
    s_or_b64 s[80:81], s[80:81], s[50:51]
    ds_read_b64 v[70:71], v93 offset:65408
    s_and_b64 exec, s[84:85], s[80:81]
    v_mfma_f32_4x4x4_16b_bf16 v[76:79], v[12:13], v[84:85], 0
    v_mov_b32 v92, v7
    s_andn2_b64 s[80:81], s[80:81], s[84:85]
    v_mfma_f32_4x4x4_16b_bf16 v[76:79], v[10:11], v[86:87], v[76:79]
    s_mov_b64 exec, -1
    ds_read_b64 v[68:69], v92 offset:65408
    s_setprio 1
    s_waitcnt vmcnt(7)
    s_mov_b32 m0, s38
    s_nop 0
    ds_write_addtid_b32 v108 offset:0
    ds_write_addtid_b32 v109 offset:256
    ds_write_addtid_b32 v110 offset:512
    ds_write_addtid_b32 v111 offset:768
    s_waitcnt lgkmcnt(4)
    v_mfma_f32_4x4x4_16b_bf16 v[80:83], v[10:11], v[70:71], v[80:83]
    v_mfma_f32_4x4x4_16b_bf16 v[76:79], v[10:11], v[68:69], v[76:79]
    v_and_b32 v46, 0x40000000, v39
    v_bitop3_b32 v94, v36, v5, v46 bitop3:0xea
    v_and_b32 v46, 0x80000000, v39
    v_bitop3_b32 v95, v37, v5, v46 bitop3:0xea
    v_perm_b32 v15, v37, v38, s47
    v_bitop3_b32 v46, v37, 0.5, -0.5 bitop3:0xa8
    v_perm_b32 v14, v36, v38, s46
    v_bitop3_b32 v47, v36, 0.5, -0.5 bitop3:0xa8
    v_cvt_pk_bf16_f32 v80, v80, v81
    v_cvt_pk_bf16_f32 v81, v82, v83
    ds_wrxchg_rtn_b64 v[74:75], v93, v[80:81] offset:65408
    v_cvt_pk_bf16_f32 v76, v76, v77
    v_cvt_pk_bf16_f32 v77, v78, v79
    ds_wrxchg_rtn_b64 v[72:73], v92, v[76:77] offset:65408
    v_and_b32 v88, 0x0fffffff, v44
    v_mov_b32 v39, v44
    buffer_load_dwordx2 v[34:35], v88, s[8:11], 0 offen
    buffer_load_dwordx3 v[36:38], v88, s[8:11], 0 offen offset:8
    s_setprio 0
    s_waitcnt vmcnt(8)
    ds_write_addtid_b32 v112 offset:1024
    ds_write_addtid_b32 v113 offset:1280
    ds_write_addtid_b32 v114 offset:1536
    ds_write_addtid_b32 v115 offset:1792
    v_mfma_f32_4x4x4_16b_bf16 v[80:83], v[8:9], v[106:107], 0
    v_mfma_f32_4x4x4_16b_bf16 v[76:79], v[8:9], v[104:105], 0
    v_bitop3_b32 v15, v6, v15, v46 bitop3:0xca
    v_bitop3_b32 v14, v6, v14, v47 bitop3:0xca
    s_nop 1
    v_pk_mul_f32 v[80:81], v[80:81], v[14:15] op_sel:[0,1] op_sel_hi:[1,1]
    v_pk_mul_f32 v[82:83], v[82:83], v[14:15] op_sel:[0,1] op_sel_hi:[1,1]
    v_pk_mul_f32 v[76:77], v[76:77], v[14:15] op_sel:[0,0] op_sel_hi:[1,0]
    v_pk_mul_f32 v[78:79], v[78:79], v[14:15] op_sel:[0,0] op_sel_hi:[1,0]
    s_add_u32 s42, s42, 1
    s_waitcnt lgkmcnt(0)
    s_barrier
    s_bitcmp1_b32 s36, s42
    s_cbranch_scc1 L2_slow
L2_ret7:
    s_setprio 3
    v_cmp_ne_u64 s[50:51], v[72:73], v[68:69]
    v_cmpx_ne_u64 s[54:55], v[74:75], v[70:71]
    s_and_b64 s[82:83], s[54:55], s[80:81]
    s_cbranch_scc1 L2_c134
L2_d134:
    v_mov_b64 v[84:85], v[70:71]
    v_mov_b32 v7, v93
    v_mov_b64 v[86:87], v[74:75]
    s_or_b64 s[80:81], s[80:81], s[54:55]
    s_mov_b64 exec, s[50:51]
    s_and_b64 s[82:83], s[50:51], s[80:81]
    s_cbranch_scc1 L2_c135
L2_d135:
    v_mov_b64 v[84:85], v[68:69]
    v_mov_b32 v7, v92
    v_mov_b64 v[86:87], v[72:73]
    s_mov_b64 exec, -1
    s_or_b64 s[80:81], s[80:81], s[50:51]
    ds_read_b64 v[70:71], v95 offset:65408
    ds_read_b64 v[68:69], v94 offset:65408
    s_waitcnt vmcnt(6)
    v_and_b32 v46, 0x20000000, v21
    v_lshrrev_b32 v47, 14, v17
    v_bitop3_b32 v47, v47, v5, v46 bitop3:0xea
    ds_read_b64 v[102:103], v47
    v_bitop3_b32 v93, v17, v5, v46 bitop3:0xea
    v_and_b32 v46, 0x10000000, v21
    v_lshrrev_b32 v47, 14, v16
    v_bitop3_b32 v47, v47, v5, v46 bitop3:0xea
    ds_read_b64 v[100:101], v47
    v_bitop3_b32 v92, v16, v5, v46 bitop3:0xea
    s_waitcnt lgkmcnt(2)
    v_mfma_f32_4x4x4_16b_bf16 v[80:83], v[10:11], v[70:71], v[80:83]
    v_mfma_f32_4x4x4_16b_bf16 v[76:79], v[10:11], v[68:69], v[76:79]
    v_perm_b32 v15, v17, v20, s45
    v_bitop3_b32 v46, v17, 0.5, -0.5 bitop3:0xa8
    v_perm_b32 v14, v16, v20, s44
    v_bitop3_b32 v47, v16, 0.5, -0.5 bitop3:0xa8
    v_cvt_pk_bf16_f32 v80, v80, v81
    v_cvt_pk_bf16_f32 v81, v82, v83
    ds_wrxchg_rtn_b64 v[74:75], v95, v[80:81] offset:65408
    v_cvt_pk_bf16_f32 v76, v76, v77
    v_cvt_pk_bf16_f32 v77, v78, v79
    ds_wrxchg_rtn_b64 v[72:73], v94, v[76:77] offset:65408
    s_waitcnt lgkmcnt(2)
    v_mfma_f32_4x4x4_16b_bf16 v[80:83], v[8:9], v[102:103], 0
    v_mfma_f32_4x4x4_16b_bf16 v[76:79], v[8:9], v[100:101], 0
    v_bitop3_b32 v15, v6, v15, v46 bitop3:0xca
    v_bitop3_b32 v14, v6, v14, v47 bitop3:0xca
    v_cmp_lt_u32 s[84:85], v5, v92
    s_nop 0
    v_pk_mul_f32 v[80:81], v[80:81], v[14:15] op_sel:[0,1] op_sel_hi:[1,1]
    v_pk_mul_f32 v[82:83], v[82:83], v[14:15] op_sel:[0,1] op_sel_hi:[1,1]
    v_pk_mul_f32 v[76:77], v[76:77], v[14:15] op_sel:[0,0] op_sel_hi:[1,0]
    v_pk_mul_f32 v[78:79], v[78:79], v[14:15] op_sel:[0,0] op_sel_hi:[1,0]
    s_waitcnt lgkmcnt(0)
    v_cmp_ne_u64 s[50:51], v[72:73], v[68:69]
    v_cmpx_ne_u64 s[54:55], v[74:75], v[70:71]
    s_and_b64 s[82:83], s[54:55], s[80:81]
    s_cbranch_scc1 L2_c136
L2_d136:
    v_mov_b64 v[84:85], v[70:71]
    v_mov_b32 v7, v95
    v_mov_b64 v[86:87], v[74:75]
    s_or_b64 s[80:81], s[80:81], s[54:55]
    s_mov_b64 exec, s[50:51]
    s_and_b64 s[82:83], s[50:51], s[80:81]
    s_cbranch_scc1 L2_c137
L2_d137:
    v_mov_b64 v[84:85], v[68:69]
    v_mov_b32 v7, v94
    v_mov_b64 v[86:87], v[72:73]
    s_mov_b64 exec, -1
    s_or_b64 s[80:81], s[80:81], s[50:51]
    ds_read_b64 v[70:71], v93 offset:65408
    s_and_b64 exec, s[84:85], s[80:81]
    v_mfma_f32_4x4x4_16b_bf16 v[76:79], v[12:13], v[84:85], 0
    v_mov_b32 v92, v7
    s_andn2_b64 s[80:81], s[80:81], s[84:85]
    v_mfma_f32_4x4x4_16b_bf16 v[76:79], v[10:11], v[86:87], v[76:79]
    s_mov_b64 exec, -1
    ds_read_b64 v[68:69], v92 offset:65408
    v_and_b32 v46, 0x80000000, v21
    v_lshrrev_b32 v47, 14, v19
    v_bitop3_b32 v47, v47, v5, v46 bitop3:0xea
    ds_read_b64 v[106:107], v47
    v_bitop3_b32 v95, v19, v5, v46 bitop3:0xea
    v_and_b32 v46, 0x40000000, v21
    v_lshrrev_b32 v47, 14, v18
    v_bitop3_b32 v47, v47, v5, v46 bitop3:0xea
    ds_read_b64 v[104:105], v47
    v_bitop3_b32 v94, v18, v5, v46 bitop3:0xea
    s_waitcnt lgkmcnt(2)
    v_mfma_f32_4x4x4_16b_bf16 v[80:83], v[10:11], v[70:71], v[80:83]
    v_mfma_f32_4x4x4_16b_bf16 v[76:79], v[10:11], v[68:69], v[76:79]
    v_perm_b32 v15, v19, v20, s47
    v_bitop3_b32 v46, v19, 0.5, -0.5 bitop3:0xa8
    v_perm_b32 v14, v18, v20, s46
    v_bitop3_b32 v47, v18, 0.5, -0.5 bitop3:0xa8
    v_cvt_pk_bf16_f32 v80, v80, v81
    v_cvt_pk_bf16_f32 v81, v82, v83
    ds_wrxchg_rtn_b64 v[74:75], v93, v[80:81] offset:65408
    v_cvt_pk_bf16_f32 v76, v76, v77
    v_cvt_pk_bf16_f32 v77, v78, v79
    ds_wrxchg_rtn_b64 v[72:73], v92, v[76:77] offset:65408
    s_setprio 2
    s_waitcnt lgkmcnt(2)
    v_mfma_f32_4x4x4_16b_bf16 v[80:83], v[8:9], v[106:107], 0
    v_mfma_f32_4x4x4_16b_bf16 v[76:79], v[8:9], v[104:105], 0
    v_bitop3_b32 v15, v6, v15, v46 bitop3:0xca
    v_bitop3_b32 v14, v6, v14, v47 bitop3:0xca
    s_nop 1
    v_pk_mul_f32 v[80:81], v[80:81], v[14:15] op_sel:[0,1] op_sel_hi:[1,1]
    v_pk_mul_f32 v[82:83], v[82:83], v[14:15] op_sel:[0,1] op_sel_hi:[1,1]
    v_pk_mul_f32 v[76:77], v[76:77], v[14:15] op_sel:[0,0] op_sel_hi:[1,0]
    v_pk_mul_f32 v[78:79], v[78:79], v[14:15] op_sel:[0,0] op_sel_hi:[1,0]
    s_waitcnt lgkmcnt(0)
    v_cmp_ne_u64 s[50:51], v[72:73], v[68:69]
    v_cmpx_ne_u64 s[54:55], v[74:75], v[70:71]
    s_and_b64 s[82:83], s[54:55], s[80:81]
    s_cbranch_scc1 L2_c138
L2_d138:
    v_mov_b64 v[84:85], v[70:71]
    v_mov_b32 v7, v93
    v_mov_b64 v[86:87], v[74:75]
    s_or_b64 s[80:81], s[80:81], s[54:55]
    s_mov_b64 exec, s[50:51]
    s_and_b64 s[82:83], s[50:51], s[80:81]
    s_cbranch_scc1 L2_c139
L2_d139:
    v_mov_b64 v[84:85], v[68:69]
    v_mov_b32 v7, v92
    v_mov_b64 v[86:87], v[72:73]
    s_mov_b64 exec, -1
    s_or_b64 s[80:81], s[80:81], s[50:51]
    ds_read_b64 v[70:71], v95 offset:65408
    ds_read_b64 v[68:69], v94 offset:65408
    s_waitcnt vmcnt(4)
    v_and_b32 v46, 0x20000000, v27
    v_lshrrev_b32 v47, 14, v23
    v_bitop3_b32 v47, v47, v5, v46 bitop3:0xea
    ds_read_b64 v[102:103], v47
    v_bitop3_b32 v93, v23, v5, v46 bitop3:0xea
    v_and_b32 v46, 0x10000000, v27
    v_lshrrev_b32 v47, 14, v22
    v_bitop3_b32 v47, v47, v5, v46 bitop3:0xea
    ds_read_b64 v[100:101], v47
    v_bitop3_b32 v92, v22, v5, v46 bitop3:0xea
    s_waitcnt lgkmcnt(2)
    v_mfma_f32_4x4x4_16b_bf16 v[80:83], v[10:11], v[70:71], v[80:83]
    v_mfma_f32_4x4x4_16b_bf16 v[76:79], v[10:11], v[68:69], v[76:79]
    v_perm_b32 v15, v23, v26, s45
    v_bitop3_b32 v46, v23, 0.5, -0.5 bitop3:0xa8
    v_perm_b32 v14, v22, v26, s44
    v_bitop3_b32 v47, v22, 0.5, -0.5 bitop3:0xa8
    v_cvt_pk_bf16_f32 v80, v80, v81
    v_cvt_pk_bf16_f32 v81, v82, v83
    ds_wrxchg_rtn_b64 v[74:75], v95, v[80:81] offset:65408
    v_cvt_pk_bf16_f32 v76, v76, v77
    v_cvt_pk_bf16_f32 v77, v78, v79
    ds_wrxchg_rtn_b64 v[72:73], v94, v[76:77] offset:65408
    s_waitcnt lgkmcnt(2)
    v_mfma_f32_4x4x4_16b_bf16 v[80:83], v[8:9], v[102:103], 0
    v_mfma_f32_4x4x4_16b_bf16 v[76:79], v[8:9], v[100:101], 0
    v_bitop3_b32 v15, v6, v15, v46 bitop3:0xca
    v_bitop3_b32 v14, v6, v14, v47 bitop3:0xca
    v_cmp_lt_u32 s[84:85], v5, v92
    s_nop 0
    v_pk_mul_f32 v[80:81], v[80:81], v[14:15] op_sel:[0,1] op_sel_hi:[1,1]
    v_pk_mul_f32 v[82:83], v[82:83], v[14:15] op_sel:[0,1] op_sel_hi:[1,1]
    v_pk_mul_f32 v[76:77], v[76:77], v[14:15] op_sel:[0,0] op_sel_hi:[1,0]
    v_pk_mul_f32 v[78:79], v[78:79], v[14:15] op_sel:[0,0] op_sel_hi:[1,0]
    s_waitcnt lgkmcnt(0)
    v_cmp_ne_u64 s[50:51], v[72:73], v[68:69]
    v_cmpx_ne_u64 s[54:55], v[74:75], v[70:71]
    s_and_b64 s[82:83], s[54:55], s[80:81]
    s_cbranch_scc1 L2_c140
L2_d140:
    v_mov_b64 v[84:85], v[70:71]
    v_mov_b32 v7, v95
    v_mov_b64 v[86:87], v[74:75]
    s_or_b64 s[80:81], s[80:81], s[54:55]
    s_mov_b64 exec, s[50:51]
    s_and_b64 s[82:83], s[50:51], s[80:81]
    s_cbranch_scc1 L2_c141
L2_d141:
    v_mov_b64 v[84:85], v[68:69]
    v_mov_b32 v7, v94
    v_mov_b64 v[86:87], v[72:73]
    s_mov_b64 exec, -1
    s_or_b64 s[80:81], s[80:81], s[50:51]
    ds_read_b64 v[70:71], v93 offset:65408
    s_and_b64 exec, s[84:85], s[80:81]
    v_mfma_f32_4x4x4_16b_bf16 v[76:79], v[12:13], v[84:85], 0
    v_mov_b32 v92, v7
    s_andn2_b64 s[80:81], s[80:81], s[84:85]
    v_mfma_f32_4x4x4_16b_bf16 v[76:79], v[10:11], v[86:87], v[76:79]
    s_mov_b64 exec, -1
    ds_read_b64 v[68:69], v92 offset:65408
    v_and_b32 v46, 0x80000000, v27
    v_lshrrev_b32 v47, 14, v25
    v_bitop3_b32 v47, v47, v5, v46 bitop3:0xea
    ds_read_b64 v[106:107], v47
    v_bitop3_b32 v95, v25, v5, v46 bitop3:0xea
    v_and_b32 v46, 0x40000000, v27
    v_lshrrev_b32 v47, 14, v24
    v_bitop3_b32 v47, v47, v5, v46 bitop3:0xea
    ds_read_b64 v[104:105], v47
    v_bitop3_b32 v94, v24, v5, v46 bitop3:0xea
    s_waitcnt lgkmcnt(2)
    v_mfma_f32_4x4x4_16b_bf16 v[80:83], v[10:11], v[70:71], v[80:83]
    v_mfma_f32_4x4x4_16b_bf16 v[76:79], v[10:11], v[68:69], v[76:79]
    v_perm_b32 v15, v25, v26, s47
    v_bitop3_b32 v46, v25, 0.5, -0.5 bitop3:0xa8
    v_perm_b32 v14, v24, v26, s46
    v_bitop3_b32 v47, v24, 0.5, -0.5 bitop3:0xa8
    v_cvt_pk_bf16_f32 v80, v80, v81
    v_cvt_pk_bf16_f32 v81, v82, v83
    ds_wrxchg_rtn_b64 v[74:75], v93, v[80:81] offset:65408
    v_cvt_pk_bf16_f32 v76, v76, v77
    v_cvt_pk_bf16_f32 v77, v78, v79
    ds_wrxchg_rtn_b64 v[72:73], v92, v[76:77] offset:65408
    s_setprio 1
    s_waitcnt lgkmcnt(2)
    v_mfma_f32_4x4x4_16b_bf16 v[80:83], v[8:9], v[106:107], 0
    v_mfma_f32_4x4x4_16b_bf16 v[76:79], v[8:9], v[104:105], 0
    v_bitop3_b32 v15, v6, v15, v46 bitop3:0xca
    v_bitop3_b32 v14, v6, v14, v47 bitop3:0xca
    s_nop 1
    v_pk_mul_f32 v[80:81], v[80:81], v[14:15] op_sel:[0,1] op_sel_hi:[1,1]
    v_pk_mul_f32 v[82:83], v[82:83], v[14:15] op_sel:[0,1] op_sel_hi:[1,1]
    v_pk_mul_f32 v[76:77], v[76:77], v[14:15] op_sel:[0,0] op_sel_hi:[1,0]
    v_pk_mul_f32 v[78:79], v[78:79], v[14:15] op_sel:[0,0] op_sel_hi:[1,0]
    s_lshl_b32 s3, s32, 12
    v_subrev_u32 v122, s3, v3
    s_mul_i32 s3, s33, 20000
    v_add_u32 v118, s3, v122
    v_add_u32 v119, 0x4000, v118
    s_lshl_b32 s3, s34, 7
    v_lshrrev_b32 v123, 7, v118
    v_and_b32 v120, 0x70, v118
    v_lshl_add_u32 v120, v123, 13, v120
    v_add_u32 v120, s3, v120
    v_lshrrev_b32 v123, 7, v119
    v_and_b32 v121, 0x70, v119
    v_lshl_add_u32 v121, v123, 13, v121
    v_add_u32 v121, s3, v121
    v_cmp_le_u32 vcc, 3616, v122
    s_mov_b64 exec, vcc
    v_mov_b32 v119, 2.0
    v_mov_b32 v121, 2.0
    s_mov_b64 exec, -1
    v_and_b32 v123, 0x30, v122
    v_lshlrev_b32 v123, 2, v123
    buffer_load_dwordx4 v[48:51], v123, s[24:27], 0 offen
    buffer_load_dwordx4 v[52:55], v123, s[24:27], 0 offen offset:16
    buffer_load_dwordx2 v[56:57], v123, s[24:27], 0 offen offset:32
    s_mov_b32 s12, s4
    s_mov_b32 s13, s5
    s_mov_b32 s14, 0x138800
    s_mov_b32 s15, 0x20000
    s_mov_b32 s16, s28
    s_mov_b32 s17, s29
    s_mov_b32 s18, 0x4e2000
    s_mov_b32 s19, 0x20000
    v_lshrrev_b32 v123, 2, v120
    buffer_load_dword v116, v123, s[12:15], 0 offen
    buffer_load_dwordx4 v[108:111], v120, s[16:19], 0 offen
    v_lshrrev_b32 v123, 2, v121
    buffer_load_dword v117, v123, s[12:15], 0 offen
    buffer_load_dwordx4 v[112:115], v121, s[16:19], 0 offen
    s_waitcnt lgkmcnt(0)
    v_cmp_ne_u64 s[50:51], v[72:73], v[68:69]
    v_cmpx_ne_u64 s[54:55], v[74:75], v[70:71]
    s_and_b64 s[82:83], s[54:55], s[80:81]
    s_cbranch_scc1 L2_c142
L2_d142:
    v_mov_b64 v[84:85], v[70:71]
    v_mov_b32 v7, v93
    v_mov_b64 v[86:87], v[74:75]
    s_or_b64 s[80:81], s[80:81], s[54:55]
    s_mov_b64 exec, s[50:51]
    s_and_b64 s[82:83], s[50:51], s[80:81]
    s_cbranch_scc1 L2_c143
L2_d143:
    v_mov_b64 v[84:85], v[68:69]
    v_mov_b32 v7, v92
    v_mov_b64 v[86:87], v[72:73]
    s_mov_b64 exec, -1
    s_or_b64 s[80:81], s[80:81], s[50:51]
    ds_read_b64 v[70:71], v95 offset:65408
    ds_read_b64 v[68:69], v94 offset:65408
    s_waitcnt vmcnt(9)
    v_and_b32 v46, 0x20000000, v33
    v_lshrrev_b32 v47, 14, v29
    v_bitop3_b32 v47, v47, v5, v46 bitop3:0xea
    ds_read_b64 v[102:103], v47
    v_bitop3_b32 v93, v29, v5, v46 bitop3:0xea
    v_and_b32 v46, 0x10000000, v33
    v_lshrrev_b32 v47, 14, v28
    v_bitop3_b32 v47, v47, v5, v46 bitop3:0xea
    ds_read_b64 v[100:101], v47
    v_bitop3_b32 v92, v28, v5, v46 bitop3:0xea
    s_waitcnt lgkmcnt(2)
    v_mfma_f32_4x4x4_16b_bf16 v[80:83], v[10:11], v[70:71], v[80:83]
    v_mfma_f32_4x4x4_16b_bf16 v[76:79], v[10:11], v[68:69], v[76:79]
    v_perm_b32 v15, v29, v32, s45
    v_bitop3_b32 v46, v29, 0.5, -0.5 bitop3:0xa8
    v_perm_b32 v14, v28, v32, s44
    v_bitop3_b32 v47, v28, 0.5, -0.5 bitop3:0xa8
    v_cvt_pk_bf16_f32 v80, v80, v81
    v_cvt_pk_bf16_f32 v81, v82, v83
    ds_wrxchg_rtn_b64 v[74:75], v95, v[80:81] offset:65408
    v_cvt_pk_bf16_f32 v76, v76, v77
    v_cvt_pk_bf16_f32 v77, v78, v79
    ds_wrxchg_rtn_b64 v[72:73], v94, v[76:77] offset:65408
    s_waitcnt lgkmcnt(2)
    v_mfma_f32_4x4x4_16b_bf16 v[80:83], v[8:9], v[102:103], 0
    v_mfma_f32_4x4x4_16b_bf16 v[76:79], v[8:9], v[100:101], 0
    v_bitop3_b32 v15, v6, v15, v46 bitop3:0xca
    v_bitop3_b32 v14, v6, v14, v47 bitop3:0xca
    v_cmp_lt_u32 s[84:85], v5, v92
    s_nop 0
    v_pk_mul_f32 v[80:81], v[80:81], v[14:15] op_sel:[0,1] op_sel_hi:[1,1]
    v_pk_mul_f32 v[82:83], v[82:83], v[14:15] op_sel:[0,1] op_sel_hi:[1,1]
    v_pk_mul_f32 v[76:77], v[76:77], v[14:15] op_sel:[0,0] op_sel_hi:[1,0]
    v_pk_mul_f32 v[78:79], v[78:79], v[14:15] op_sel:[0,0] op_sel_hi:[1,0]
    s_waitcnt lgkmcnt(0)
    v_cmp_ne_u64 s[50:51], v[72:73], v[68:69]
    v_cmpx_ne_u64 s[54:55], v[74:75], v[70:71]
    s_and_b64 s[82:83], s[54:55], s[80:81]
    s_cbranch_scc1 L2_c144
L2_d144:
    v_mov_b64 v[84:85], v[70:71]
    v_mov_b32 v7, v95
    v_mov_b64 v[86:87], v[74:75]
    s_or_b64 s[80:81], s[80:81], s[54:55]
    s_mov_b64 exec, s[50:51]
    s_and_b64 s[82:83], s[50:51], s[80:81]
    s_cbranch_scc1 L2_c145
L2_d145:
    v_mov_b64 v[84:85], v[68:69]
    v_mov_b32 v7, v94
    v_mov_b64 v[86:87], v[72:73]
    s_mov_b64 exec, -1
    s_or_b64 s[80:81], s[80:81], s[50:51]
    ds_read_b64 v[70:71], v93 offset:65408
    s_and_b64 exec, s[84:85], s[80:81]
    v_mfma_f32_4x4x4_16b_bf16 v[76:79], v[12:13], v[84:85], 0
    v_mov_b32 v92, v7
    s_andn2_b64 s[80:81], s[80:81], s[84:85]
    v_mfma_f32_4x4x4_16b_bf16 v[76:79], v[10:11], v[86:87], v[76:79]
    s_mov_b64 exec, -1
    ds_read_b64 v[68:69], v92 offset:65408
    v_and_b32 v46, 0x80000000, v33
    v_lshrrev_b32 v47, 14, v31
    v_bitop3_b32 v47, v47, v5, v46 bitop3:0xea
    ds_read_b64 v[106:107], v47
    v_bitop3_b32 v95, v31, v5, v46 bitop3:0xea
    v_and_b32 v46, 0x40000000, v33
    v_lshrrev_b32 v47, 14, v30
    v_bitop3_b32 v47, v47, v5, v46 bitop3:0xea
    ds_read_b64 v[104:105], v47
    v_bitop3_b32 v94, v30, v5, v46 bitop3:0xea
    s_waitcnt lgkmcnt(2)
    v_mfma_f32_4x4x4_16b_bf16 v[80:83], v[10:11], v[70:71], v[80:83]
    v_mfma_f32_4x4x4_16b_bf16 v[76:79], v[10:11], v[68:69], v[76:79]
    v_perm_b32 v15, v31, v32, s47
    v_bitop3_b32 v46, v31, 0.5, -0.5 bitop3:0xa8
    v_perm_b32 v14, v30, v32, s46
    v_bitop3_b32 v47, v30, 0.5, -0.5 bitop3:0xa8
    v_cvt_pk_bf16_f32 v80, v80, v81
    v_cvt_pk_bf16_f32 v81, v82, v83
    ds_wrxchg_rtn_b64 v[74:75], v93, v[80:81] offset:65408
    v_cvt_pk_bf16_f32 v76, v76, v77
    v_cvt_pk_bf16_f32 v77, v78, v79
    ds_wrxchg_rtn_b64 v[72:73], v92, v[76:77] offset:65408
    s_setprio 0
    s_waitcnt lgkmcnt(2)
    v_mfma_f32_4x4x4_16b_bf16 v[80:83], v[8:9], v[106:107], 0
    v_mfma_f32_4x4x4_16b_bf16 v[76:79], v[8:9], v[104:105], 0
    v_bitop3_b32 v15, v6, v15, v46 bitop3:0xca
    v_bitop3_b32 v14, v6, v14, v47 bitop3:0xca
    s_nop 1
    v_pk_mul_f32 v[80:81], v[80:81], v[14:15] op_sel:[0,1] op_sel_hi:[1,1]
    v_pk_mul_f32 v[82:83], v[82:83], v[14:15] op_sel:[0,1] op_sel_hi:[1,1]
    v_pk_mul_f32 v[76:77], v[76:77], v[14:15] op_sel:[0,0] op_sel_hi:[1,0]
    v_pk_mul_f32 v[78:79], v[78:79], v[14:15] op_sel:[0,0] op_sel_hi:[1,0]
    s_waitcnt lgkmcnt(0)
    v_cmp_ne_u64 s[50:51], v[72:73], v[68:69]
    v_cmpx_ne_u64 s[54:55], v[74:75], v[70:71]
    s_and_b64 s[82:83], s[54:55], s[80:81]
    s_cbranch_scc1 L2_c146
L2_d146:
    v_mov_b64 v[84:85], v[70:71]
    v_mov_b32 v7, v93
    v_mov_b64 v[86:87], v[74:75]
    s_or_b64 s[80:81], s[80:81], s[54:55]
    s_mov_b64 exec, s[50:51]
    s_and_b64 s[82:83], s[50:51], s[80:81]
    s_cbranch_scc1 L2_c147
L2_d147:
    v_mov_b64 v[84:85], v[68:69]
    v_mov_b32 v7, v92
    v_mov_b64 v[86:87], v[72:73]
    s_mov_b64 exec, -1
    s_or_b64 s[80:81], s[80:81], s[50:51]
    ds_read_b64 v[70:71], v95 offset:65408
    ds_read_b64 v[68:69], v94 offset:65408
    s_waitcnt vmcnt(7)
    v_and_b32 v46, 0x20000000, v39
    v_lshrrev_b32 v47, 14, v35
    v_bitop3_b32 v47, v47, v5, v46 bitop3:0xea
    ds_read_b64 v[102:103], v47
    v_bitop3_b32 v93, v35, v5, v46 bitop3:0xea
    v_and_b32 v46, 0x10000000, v39
    v_lshrrev_b32 v47, 14, v34
    v_bitop3_b32 v47, v47, v5, v46 bitop3:0xea
    ds_read_b64 v[100:101], v47
    v_bitop3_b32 v92, v34, v5, v46 bitop3:0xea
    v_and_b32 v46, 0x80000000, v39
    v_lshrrev_b32 v47, 14, v37
    v_bitop3_b32 v47, v47, v5, v46 bitop3:0xea
    ds_read_b64 v[106:107], v47
    v_and_b32 v46, 0x40000000, v39
    v_lshrrev_b32 v47, 14, v36
    v_bitop3_b32 v47, v47, v5, v46 bitop3:0xea
    ds_read_b64 v[104:105], v47
    s_waitcnt lgkmcnt(4)
    v_mfma_f32_4x4x4_16b_bf16 v[80:83], v[10:11], v[70:71], v[80:83]
    v_mfma_f32_4x4x4_16b_bf16 v[76:79], v[10:11], v[68:69], v[76:79]
    v_perm_b32 v15, v35, v38, s45
    v_bitop3_b32 v46, v35, 0.5, -0.5 bitop3:0xa8
    v_perm_b32 v14, v34, v38, s44
    v_bitop3_b32 v47, v34, 0.5, -0.5 bitop3:0xa8
    v_cvt_pk_bf16_f32 v80, v80, v81
    v_cvt_pk_bf16_f32 v81, v82, v83
    ds_wrxchg_rtn_b64 v[74:75], v95, v[80:81] offset:65408
    v_cvt_pk_bf16_f32 v76, v76, v77
    v_cvt_pk_bf16_f32 v77, v78, v79
    ds_wrxchg_rtn_b64 v[72:73], v94, v[76:77] offset:65408
    s_waitcnt lgkmcnt(4)
    v_mfma_f32_4x4x4_16b_bf16 v[80:83], v[8:9], v[102:103], 0
    v_mfma_f32_4x4x4_16b_bf16 v[76:79], v[8:9], v[100:101], 0
    v_bitop3_b32 v15, v6, v15, v46 bitop3:0xca
    v_bitop3_b32 v14, v6, v14, v47 bitop3:0xca
    v_cmp_lt_u32 s[84:85], v5, v92
    s_nop 0
    v_pk_mul_f32 v[80:81], v[80:81], v[14:15] op_sel:[0,1] op_sel_hi:[1,1]
    v_pk_mul_f32 v[82:83], v[82:83], v[14:15] op_sel:[0,1] op_sel_hi:[1,1]
    v_pk_mul_f32 v[76:77], v[76:77], v[14:15] op_sel:[0,0] op_sel_hi:[1,0]
    v_pk_mul_f32 v[78:79], v[78:79], v[14:15] op_sel:[0,0] op_sel_hi:[1,0]
    s_waitcnt lgkmcnt(0)
    v_cmp_ne_u64 s[50:51], v[72:73], v[68:69]
    v_cmpx_ne_u64 s[54:55], v[74:75], v[70:71]
    s_and_b64 s[82:83], s[54:55], s[80:81]
    s_cbranch_scc1 L2_c148
L2_d148:
    v_mov_b64 v[84:85], v[70:71]
    v_mov_b32 v7, v95
    v_mov_b64 v[86:87], v[74:75]
    s_or_b64 s[80:81], s[80:81], s[54:55]
    s_mov_b64 exec, s[50:51]
    s_and_b64 s[82:83], s[50:51], s[80:81]
    s_cbranch_scc1 L2_c149
L2_d149:
    v_mov_b64 v[84:85], v[68:69]
    v_mov_b32 v7, v94
    v_mov_b64 v[86:87], v[72:73]
    s_mov_b64 exec, -1
    s_or_b64 s[80:81], s[80:81], s[50:51]
    ds_read_b64 v[70:71], v93 offset:65408
    s_and_b64 exec, s[84:85], s[80:81]
    v_mfma_f32_4x4x4_16b_bf16 v[76:79], v[12:13], v[84:85], 0
    v_mov_b32 v92, v7
    s_andn2_b64 s[80:81], s[80:81], s[84:85]
    v_mfma_f32_4x4x4_16b_bf16 v[76:79], v[10:11], v[86:87], v[76:79]
    s_mov_b64 exec, -1
    ds_read_b64 v[68:69], v92 offset:65408
    s_waitcnt lgkmcnt(0)
    v_mfma_f32_4x4x4_16b_bf16 v[80:83], v[10:11], v[70:71], v[80:83]
    v_mfma_f32_4x4x4_16b_bf16 v[76:79], v[10:11], v[68:69], v[76:79]
    v_and_b32 v46, 0x40000000, v39
    v_bitop3_b32 v94, v36, v5, v46 bitop3:0xea
    v_and_b32 v46, 0x80000000, v39
    v_bitop3_b32 v95, v37, v5, v46 bitop3:0xea
    v_perm_b32 v15, v37, v38, s47
    v_bitop3_b32 v46, v37, 0.5, -0.5 bitop3:0xa8
    v_perm_b32 v14, v36, v38, s46
    v_bitop3_b32 v47, v36, 0.5, -0.5 bitop3:0xa8
    v_cvt_pk_bf16_f32 v80, v80, v81
    v_cvt_pk_bf16_f32 v81, v82, v83
    ds_wrxchg_rtn_b64 v[74:75], v93, v[80:81] offset:65408
    v_cvt_pk_bf16_f32 v76, v76, v77
    v_cvt_pk_bf16_f32 v77, v78, v79
    ds_wrxchg_rtn_b64 v[72:73], v92, v[76:77] offset:65408
    v_mfma_f32_4x4x4_16b_bf16 v[80:83], v[8:9], v[106:107], 0
    v_mfma_f32_4x4x4_16b_bf16 v[76:79], v[8:9], v[104:105], 0
    v_bitop3_b32 v15, v6, v15, v46 bitop3:0xca
    v_bitop3_b32 v14, v6, v14, v47 bitop3:0xca
    s_nop 1
    v_pk_mul_f32 v[80:81], v[80:81], v[14:15] op_sel:[0,1] op_sel_hi:[1,1]
    v_pk_mul_f32 v[82:83], v[82:83], v[14:15] op_sel:[0,1] op_sel_hi:[1,1]
    v_pk_mul_f32 v[76:77], v[76:77], v[14:15] op_sel:[0,0] op_sel_hi:[1,0]
    v_pk_mul_f32 v[78:79], v[78:79], v[14:15] op_sel:[0,0] op_sel_hi:[1,0]
    s_waitcnt lgkmcnt(0)
    v_cmp_ne_u64 s[50:51], v[72:73], v[68:69]
    v_cmpx_ne_u64 s[54:55], v[74:75], v[70:71]
    s_and_b64 s[82:83], s[54:55], s[80:81]
    s_cbranch_scc1 L2_c150
L2_d150:
    v_mov_b64 v[84:85], v[70:71]
    v_mov_b32 v7, v93
    v_mov_b64 v[86:87], v[74:75]
    s_or_b64 s[80:81], s[80:81], s[54:55]
    s_mov_b64 exec, s[50:51]
    s_and_b64 s[82:83], s[50:51], s[80:81]
    s_cbranch_scc1 L2_c151
L2_d151:
    v_mov_b64 v[84:85], v[68:69]
    v_mov_b32 v7, v92
    v_mov_b64 v[86:87], v[72:73]
    s_mov_b64 exec, -1
    s_or_b64 s[80:81], s[80:81], s[50:51]
    ds_read_b64 v[70:71], v95 offset:65408
    ds_read_b64 v[68:69], v94 offset:65408
    s_waitcnt lgkmcnt(0)
    v_mfma_f32_4x4x4_16b_bf16 v[80:83], v[10:11], v[70:71], v[80:83]
    v_mfma_f32_4x4x4_16b_bf16 v[76:79], v[10:11], v[68:69], v[76:79]
    s_nop 3
    v_cvt_pk_bf16_f32 v80, v80, v81
    v_cvt_pk_bf16_f32 v81, v82, v83
    ds_wrxchg_rtn_b64 v[74:75], v95, v[80:81] offset:65408
    v_cvt_pk_bf16_f32 v76, v76, v77
    v_cvt_pk_bf16_f32 v77, v78, v79
    ds_wrxchg_rtn_b64 v[72:73], v94, v[76:77] offset:65408
    s_waitcnt lgkmcnt(0)
    v_cmpx_ne_u64 vcc, v[74:75], v[70:71]
    s_and_b64 s[82:83], vcc, s[80:81]
    s_cbranch_scc1 L2_c152
L2_d152:
    v_mov_b64 v[84:85], v[70:71]
    v_mov_b32 v7, v95
    v_mov_b64 v[86:87], v[74:75]
    s_mov_b64 exec, -1
    s_or_b64 s[80:81], s[80:81], vcc
    v_cmpx_ne_u64 vcc, v[72:73], v[68:69]
    s_and_b64 s[82:83], vcc, s[80:81]
    s_cbranch_scc1 L2_c153
L2_d153:
    v_mov_b64 v[84:85], v[68:69]
    v_mov_b32 v7, v94
    v_mov_b64 v[86:87], v[72:73]
    s_mov_b64 exec, -1
    s_or_b64 s[80:81], s[80:81], vcc
    s_mov_b64 exec, s[80:81]
    s_nop 1
    v_mfma_f32_4x4x4_16b_bf16 v[88:91], v[12:13], v[84:85], 0
    s_nop 1
    v_mfma_f32_4x4x4_16b_bf16 v[88:91], v[10:11], v[86:87], v[88:91]
    s_nop 4
    v_cvt_pk_bf16_f32 v88, v88, v89
    v_cvt_pk_bf16_f32 v89, v90, v91
    ds_pk_add_bf16 v7, v88 offset:65408
    ds_pk_add_bf16 v7, v89 offset:65412
    s_mov_b64 exec, -1
    s_load_dwordx2 s[4:5], s[0:1], 88
    v_add_u32 v123, 0x4000, v122
    s_lshl_b32 s50, s96, 16
    s_and_b32 s51, s96, 0xffff0000
    s_lshl_b32 s52, s97, 16
    s_and_b32 s53, s97, 0xffff0000
    s_lshl_b32 s54, s98, 16
    s_and_b32 s55, s98, 0xffff0000
    s_lshl_b32 s56, s99, 16
    s_and_b32 s57, s99, 0xffff0000
    s_waitcnt vmcnt(0) lgkmcnt(0)
    s_barrier
    s_add_u32 s8, s30, 0xec46000
    s_addc_u32 s9, s31, 0
    s_mov_b32 s10, 0x8000
    s_mov_b32 s11, 0x20000
    s_mov_b32 s12, s4
    s_mov_b32 s13, s5
    s_mov_b32 s14, 0x4e2000
    s_mov_b32 s15, 0x20000
    s_add_u32 s20, s30, 0xd845000
    s_addc_u32 s21, s31, 0
    s_mov_b32 s22, 0x1400000
    s_mov_b32 s23, 0x20000
    s_lshl2_add_u32 s4, s34, s33
    s_mul_i32 s4, s4, 81920
    s_add_u32 s3, s33, 1
    s_and_b32 s3, s3, 3
    s_mul_i32 s36, s3, 20000
    s_add_u32 s36, s36, 81920
    s_mul_i32 s40, s3, 20480
    s_add_u32 s40, s40, s4
    s_lshl2_add_u32 s3, s34, s3
    s_mul_i32 s3, s3, 81920
    s_mul_i32 s44, s33, 20480
    s_add_u32 s44, s44, s3
    s_add_u32 s3, s33, 2
    s_and_b32 s3, s3, 3
    s_mul_i32 s37, s3, 20000
    s_add_u32 s37, s37, 81920
    s_mul_i32 s41, s3, 20480
    s_add_u32 s41, s41, s4
    s_lshl2_add_u32 s3, s34, s3
    s_mul_i32 s3, s3, 81920
    s_mul_i32 s45, s33, 20480
    s_add_u32 s45, s45, s3
    s_add_u32 s3, s33, 3
    s_and_b32 s3, s3, 3
    s_mul_i32 s38, s3, 20000
    s_add_u32 s38, s38, 81920
    s_mul_i32 s42, s3, 20480
    s_add_u32 s42, s42, s4
    s_lshl2_add_u32 s3, s34, s3
    s_mul_i32 s3, s3, 81920
    s_mul_i32 s46, s33, 20480
    s_add_u32 s46, s46, s3
    v_add_u32 v104, s36, v122
    ds_read_b128 v[16:19], v104
    v_add_u32 v104, s37, v122
    ds_read_b128 v[20:23], v104
    v_add_u32 v104, s38, v122
    ds_read_b128 v[24:27], v104
    s_waitcnt lgkmcnt(2)
    buffer_store_dwordx4 v[16:19], v122, s[20:23], s40 offen sc1
    s_waitcnt lgkmcnt(1)
    buffer_store_dwordx4 v[20:23], v122, s[20:23], s41 offen sc1
    s_waitcnt lgkmcnt(0)
    buffer_store_dwordx4 v[24:27], v122, s[20:23], s42 offen sc1
    s_cmp_ge_u32 s32, 4
    s_cbranch_scc1 L2_g0
    v_add_u32 v104, s36, v123
    ds_read_b128 v[36:39], v104
    v_add_u32 v104, s37, v123
    ds_read_b128 v[40:43], v104
    v_add_u32 v104, s38, v123
    ds_read_b128 v[44:47], v104
    s_waitcnt lgkmcnt(2)
    buffer_store_dwordx4 v[36:39], v123, s[20:23], s40 offen sc1
    s_waitcnt lgkmcnt(1)
    buffer_store_dwordx4 v[40:43], v123, s[20:23], s41 offen sc1
    s_waitcnt lgkmcnt(0)
    buffer_store_dwordx4 v[44:47], v123, s[20:23], s42 offen sc1
L2_g0:
    v_lshlrev_b32 v80, 16, v116
    v_subrev_f32 v60, s50, v80
    v_subrev_f32 v61, s51, v80
    v_subrev_f32 v62, s52, v80
    v_subrev_f32 v63, s53, v80
    v_subrev_f32 v64, s54, v80
    v_subrev_f32 v65, s55, v80
    v_subrev_f32 v66, s56, v80
    v_subrev_f32 v67, s57, v80
    v_cvt_pk_bf16_f32 v68, v60, v61
    v_cvt_pk_bf16_f32 v69, v62, v63
    v_cvt_pk_bf16_f32 v70, v64, v65
    v_cvt_pk_bf16_f32 v71, v66, v67
    v_lshlrev_b32 v60, 16, v68
    v_and_b32 v61, 0xffff0000, v68
    v_lshlrev_b32 v62, 16, v69
    v_and_b32 v63, 0xffff0000, v69
    v_lshlrev_b32 v64, 16, v70
    v_and_b32 v65, 0xffff0000, v70
    v_lshlrev_b32 v66, 16, v71
    v_and_b32 v67, 0xffff0000, v71
    v_mul_f32 v60, v60, v60
    v_mul_f32 v61, v61, v61
    v_mul_f32 v62, v62, v62
    v_mul_f32 v63, v63, v63
    v_mul_f32 v64, v64, v64
    v_mul_f32 v65, v65, v65
    v_mul_f32 v66, v66, v66
    v_mul_f32 v67, v67, v67
    v_cvt_pk_bf16_f32 v68, v60, v61
    v_cvt_pk_bf16_f32 v69, v62, v63
    v_cvt_pk_bf16_f32 v70, v64, v65
    v_cvt_pk_bf16_f32 v71, v66, v67
    v_lshlrev_b32 v60, 16, v68
    v_and_b32 v61, 0xffff0000, v68
    v_lshlrev_b32 v62, 16, v69
    v_and_b32 v63, 0xffff0000, v69
    v_lshlrev_b32 v64, 16, v70
    v_and_b32 v65, 0xffff0000, v70
    v_lshlrev_b32 v66, 16, v71
    v_and_b32 v67, 0xffff0000, v71
    v_mul_f32 v60, 0xc1200000, v60
    v_mul_f32 v61, 0xc1200000, v61
    v_mul_f32 v62, 0xc1200000, v62
    v_mul_f32 v63, 0xc1200000, v63
    v_mul_f32 v64, 0xc1200000, v64
    v_mul_f32 v65, 0xc1200000, v65
    v_mul_f32 v66, 0xc1200000, v66
    v_mul_f32 v67, 0xc1200000, v67
    v_cvt_pk_bf16_f32 v68, v60, v61
    v_cvt_pk_bf16_f32 v69, v62, v63
    v_cvt_pk_bf16_f32 v70, v64, v65
    v_cvt_pk_bf16_f32 v71, v66, v67
    v_lshlrev_b32 v60, 16, v68
    v_and_b32 v61, 0xffff0000, v68
    v_lshlrev_b32 v62, 16, v69
    v_and_b32 v63, 0xffff0000, v69
    v_lshlrev_b32 v64, 16, v70
    v_and_b32 v65, 0xffff0000, v70
    v_lshlrev_b32 v66, 16, v71
    v_and_b32 v67, 0xffff0000, v71
    v_mul_f32 v60, 0x3fb8aa3b, v60
    v_mul_f32 v61, 0x3fb8aa3b, v61
    v_mul_f32 v62, 0x3fb8aa3b, v62
    v_mul_f32 v63, 0x3fb8aa3b, v63
    v_mul_f32 v64, 0x3fb8aa3b, v64
    v_mul_f32 v65, 0x3fb8aa3b, v65
    v_mul_f32 v66, 0x3fb8aa3b, v66
    v_mul_f32 v67, 0x3fb8aa3b, v67
    v_exp_f32 v60, v60
    v_exp_f32 v61, v61
    v_exp_f32 v62, v62
    v_exp_f32 v63, v63
    v_exp_f32 v64, v64
    v_exp_f32 v65, v65
    v_exp_f32 v66, v66
    v_exp_f32 v67, v67
    v_cvt_pk_bf16_f32 v72, v60, v61
    v_cvt_pk_bf16_f32 v73, v62, v63
    v_cvt_pk_bf16_f32 v74, v64, v65
    v_cvt_pk_bf16_f32 v75, v66, v67
    v_and_b32 v80, 0xffff0000, v116
    v_subrev_f32 v60, s50, v80
    v_subrev_f32 v61, s51, v80
    v_subrev_f32 v62, s52, v80
    v_subrev_f32 v63, s53, v80
    v_subrev_f32 v64, s54, v80
    v_subrev_f32 v65, s55, v80
    v_subrev_f32 v66, s56, v80
    v_subrev_f32 v67, s57, v80
    v_cvt_pk_bf16_f32 v68, v60, v61
    v_cvt_pk_bf16_f32 v69, v62, v63
    v_cvt_pk_bf16_f32 v70, v64, v65
    v_cvt_pk_bf16_f32 v71, v66, v67
    v_lshlrev_b32 v60, 16, v68
    v_and_b32 v61, 0xffff0000, v68
    v_lshlrev_b32 v62, 16, v69
    v_and_b32 v63, 0xffff0000, v69
    v_lshlrev_b32 v64, 16, v70
    v_and_b32 v65, 0xffff0000, v70
    v_lshlrev_b32 v66, 16, v71
    v_and_b32 v67, 0xffff0000, v71
    v_mul_f32 v60, v60, v60
    v_mul_f32 v61, v61, v61
    v_mul_f32 v62, v62, v62
    v_mul_f32 v63, v63, v63
    v_mul_f32 v64, v64, v64
    v_mul_f32 v65, v65, v65
    v_mul_f32 v66, v66, v66
    v_mul_f32 v67, v67, v67
    v_cvt_pk_bf16_f32 v68, v60, v61
    v_cvt_pk_bf16_f32 v69, v62, v63
    v_cvt_pk_bf16_f32 v70, v64, v65
    v_cvt_pk_bf16_f32 v71, v66, v67
    v_lshlrev_b32 v60, 16, v68
    v_and_b32 v61, 0xffff0000, v68
    v_lshlrev_b32 v62, 16, v69
    v_and_b32 v63, 0xffff0000, v69
    v_lshlrev_b32 v64, 16, v70
    v_and_b32 v65, 0xffff0000, v70
    v_lshlrev_b32 v66, 16, v71
    v_and_b32 v67, 0xffff0000, v71
    v_mul_f32 v60, 0xc1200000, v60
    v_mul_f32 v61, 0xc1200000, v61
    v_mul_f32 v62, 0xc1200000, v62
    v_mul_f32 v63, 0xc1200000, v63
    v_mul_f32 v64, 0xc1200000, v64
    v_mul_f32 v65, 0xc1200000, v65
    v_mul_f32 v66, 0xc1200000, v66
    v_mul_f32 v67, 0xc1200000, v67
    v_cvt_pk_bf16_f32 v68, v60, v61
    v_cvt_pk_bf16_f32 v69, v62, v63
    v_cvt_pk_bf16_f32 v70, v64, v65
    v_cvt_pk_bf16_f32 v71, v66, v67
    v_lshlrev_b32 v60, 16, v68
    v_and_b32 v61, 0xffff0000, v68
    v_lshlrev_b32 v62, 16, v69
    v_and_b32 v63, 0xffff0000, v69
    v_lshlrev_b32 v64, 16, v70
    v_and_b32 v65, 0xffff0000, v70
    v_lshlrev_b32 v66, 16, v71
    v_and_b32 v67, 0xffff0000, v71
    v_mul_f32 v60, 0x3fb8aa3b, v60
    v_mul_f32 v61, 0x3fb8aa3b, v61
    v_mul_f32 v62, 0x3fb8aa3b, v62
    v_mul_f32 v63, 0x3fb8aa3b, v63
    v_mul_f32 v64, 0x3fb8aa3b, v64
    v_mul_f32 v65, 0x3fb8aa3b, v65
    v_mul_f32 v66, 0x3fb8aa3b, v66
    v_mul_f32 v67, 0x3fb8aa3b, v67
    v_exp_f32 v60, v60
    v_exp_f32 v61, v61
    v_exp_f32 v62, v62
    v_exp_f32 v63, v63
    v_exp_f32 v64, v64
    v_exp_f32 v65, v65
    v_exp_f32 v66, v66
    v_exp_f32 v67, v67
    v_cvt_pk_bf16_f32 v76, v60, v61
    v_cvt_pk_bf16_f32 v77, v62, v63
    v_cvt_pk_bf16_f32 v78, v64, v65
    v_cvt_pk_bf16_f32 v79, v66, v67
    v_mfma_f32_4x4x4_16b_bf16 v[80:83], v[48:49], v[72:73], 0
    v_mfma_f32_4x4x4_16b_bf16 v[88:91], v[52:53], v[72:73], 0
    v_mfma_f32_4x4x4_16b_bf16 v[84:87], v[48:49], v[76:77], 0
    v_mfma_f32_4x4x4_16b_bf16 v[92:95], v[52:53], v[76:77], 0
    v_mfma_f32_4x4x4_16b_bf16 v[80:83], v[50:51], v[74:75], v[80:83]
    v_mfma_f32_4x4x4_16b_bf16 v[88:91], v[54:55], v[74:75], v[88:91]
    v_mfma_f32_4x4x4_16b_bf16 v[84:87], v[50:51], v[78:79], v[84:87]
    v_mfma_f32_4x4x4_16b_bf16 v[92:95], v[54:55], v[78:79], v[92:95]
    s_lshl_b32 s3, s34, 9
    s_lshl_b32 s4, s33, 7
    s_add_u32 s4, s4, s3
    v_mov_b32 v104, 1
    v_and_b32 v105, 0x3f0, v122
    v_lshlrev_b32 v105, 3, v105
    v_add_u32 v106, 81920, v118
    ds_read_b128 v[32:35], v106
    v_add_u32 v106, 81920, v119
    ds_read_b128 v[60:63], v106
    s_waitcnt vmcnt(0)
    s_barrier
    s_cmp_lg_u32 s32, 0
    s_cbranch_scc1 L2_f2
    s_mov_b64 exec, 1
    buffer_store_dword v104, off, s[8:11], s4 sc1
    s_mov_b64 exec, 15
    s_bitset0_b64 exec, s33
L2_f3:
    buffer_load_dword v104, v105, s[8:11], s3 offen sc1
    s_waitcnt vmcnt(0)
    v_cmp_ne_u32 vcc, 1, v104
    s_cbranch_vccnz L2_f3s
    s_mov_b64 exec, -1
L2_f2:
    s_barrier
    buffer_load_dwordx4 v[36:39], v122, s[20:23], s44 offen sc1
    buffer_load_dwordx4 v[40:43], v122, s[20:23], s45 offen sc1
    buffer_load_dwordx4 v[44:47], v122, s[20:23], s46 offen sc1
    s_cmp_ge_u32 s32, 4
    s_cbranch_scc1 L2_f5
    buffer_load_dwordx4 v[64:67], v123, s[20:23], s44 offen sc1
    buffer_load_dwordx4 v[68:71], v123, s[20:23], s45 offen sc1
    buffer_load_dwordx4 v[72:75], v123, s[20:23], s46 offen sc1
    v_lshlrev_b32 v16, 16, v117
    v_subrev_f32 v96, s50, v16
    v_subrev_f32 v97, s51, v16
    v_subrev_f32 v98, s52, v16
    v_subrev_f32 v99, s53, v16
    v_subrev_f32 v100, s54, v16
    v_subrev_f32 v101, s55, v16
    v_subrev_f32 v102, s56, v16
    v_subrev_f32 v103, s57, v16
    v_cvt_pk_bf16_f32 v0, v96, v97
    v_cvt_pk_bf16_f32 v1, v98, v99
    v_cvt_pk_bf16_f32 v2, v100, v101
    v_cvt_pk_bf16_f32 v3, v102, v103
    v_lshlrev_b32 v96, 16, v0
    v_and_b32 v97, 0xffff0000, v0
    v_lshlrev_b32 v98, 16, v1
    v_and_b32 v99, 0xffff0000, v1
    v_lshlrev_b32 v100, 16, v2
    v_and_b32 v101, 0xffff0000, v2
    v_lshlrev_b32 v102, 16, v3
    v_and_b32 v103, 0xffff0000, v3
    v_mul_f32 v96, v96, v96
    v_mul_f32 v97, v97, v97
    v_mul_f32 v98, v98, v98
    v_mul_f32 v99, v99, v99
    v_mul_f32 v100, v100, v100
    v_mul_f32 v101, v101, v101
    v_mul_f32 v102, v102, v102
    v_mul_f32 v103, v103, v103
    v_cvt_pk_bf16_f32 v0, v96, v97
    v_cvt_pk_bf16_f32 v1, v98, v99
    v_cvt_pk_bf16_f32 v2, v100, v101
    v_cvt_pk_bf16_f32 v3, v102, v103
    v_lshlrev_b32 v96, 16, v0
    v_and_b32 v97, 0xffff0000, v0
    v_lshlrev_b32 v98, 16, v1
    v_and_b32 v99, 0xffff0000, v1
    v_lshlrev_b32 v100, 16, v2
    v_and_b32 v101, 0xffff0000, v2
    v_lshlrev_b32 v102, 16, v3
    v_and_b32 v103, 0xffff0000, v3
    v_mul_f32 v96, 0xc1200000, v96
    v_mul_f32 v97, 0xc1200000, v97
    v_mul_f32 v98, 0xc1200000, v98
    v_mul_f32 v99, 0xc1200000, v99
    v_mul_f32 v100, 0xc1200000, v100
    v_mul_f32 v101, 0xc1200000, v101
    v_mul_f32 v102, 0xc1200000, v102
    v_mul_f32 v103, 0xc1200000, v103
    v_cvt_pk_bf16_f32 v0, v96, v97
    v_cvt_pk_bf16_f32 v1, v98, v99
    v_cvt_pk_bf16_f32 v2, v100, v101
    v_cvt_pk_bf16_f32 v3, v102, v103
    v_lshlrev_b32 v96, 16, v0
    v_and_b32 v97, 0xffff0000, v0
    v_lshlrev_b32 v98, 16, v1
    v_and_b32 v99, 0xffff0000, v1
    v_lshlrev_b32 v100, 16, v2
    v_and_b32 v101, 0xffff0000, v2
    v_lshlrev_b32 v102, 16, v3
    v_and_b32 v103, 0xffff0000, v3
    v_mul_f32 v96, 0x3fb8aa3b, v96
    v_mul_f32 v97, 0x3fb8aa3b, v97
    v_mul_f32 v98, 0x3fb8aa3b, v98
    v_mul_f32 v99, 0x3fb8aa3b, v99
    v_mul_f32 v100, 0x3fb8aa3b, v100
    v_mul_f32 v101, 0x3fb8aa3b, v101
    v_mul_f32 v102, 0x3fb8aa3b, v102
    v_mul_f32 v103, 0x3fb8aa3b, v103
    v_exp_f32 v96, v96
    v_exp_f32 v97, v97
    v_exp_f32 v98, v98
    v_exp_f32 v99, v99
    v_exp_f32 v100, v100
    v_exp_f32 v101, v101
    v_exp_f32 v102, v102
    v_exp_f32 v103, v103
    v_cvt_pk_bf16_f32 v104, v96, v97
    v_cvt_pk_bf16_f32 v105, v98, v99
    v_cvt_pk_bf16_f32 v106, v100, v101
    v_cvt_pk_bf16_f32 v107, v102, v103
    v_and_b32 v16, 0xffff0000, v117
    v_subrev_f32 v96, s50, v16
    v_subrev_f32 v97, s51, v16
    v_subrev_f32 v98, s52, v16
    v_subrev_f32 v99, s53, v16
    v_subrev_f32 v100, s54, v16
    v_subrev_f32 v101, s55, v16
    v_subrev_f32 v102, s56, v16
    v_subrev_f32 v103, s57, v16
    v_cvt_pk_bf16_f32 v0, v96, v97
    v_cvt_pk_bf16_f32 v1, v98, v99
    v_cvt_pk_bf16_f32 v2, v100, v101
    v_cvt_pk_bf16_f32 v3, v102, v103
    v_lshlrev_b32 v96, 16, v0
    v_and_b32 v97, 0xffff0000, v0
    v_lshlrev_b32 v98, 16, v1
    v_and_b32 v99, 0xffff0000, v1
    v_lshlrev_b32 v100, 16, v2
    v_and_b32 v101, 0xffff0000, v2
    v_lshlrev_b32 v102, 16, v3
    v_and_b32 v103, 0xffff0000, v3
    v_mul_f32 v96, v96, v96
    v_mul_f32 v97, v97, v97
    v_mul_f32 v98, v98, v98
    v_mul_f32 v99, v99, v99
    v_mul_f32 v100, v100, v100
    v_mul_f32 v101, v101, v101
    v_mul_f32 v102, v102, v102
    v_mul_f32 v103, v103, v103
    v_cvt_pk_bf16_f32 v0, v96, v97
    v_cvt_pk_bf16_f32 v1, v98, v99
    v_cvt_pk_bf16_f32 v2, v100, v101
    v_cvt_pk_bf16_f32 v3, v102, v103
    v_lshlrev_b32 v96, 16, v0
    v_and_b32 v97, 0xffff0000, v0
    v_lshlrev_b32 v98, 16, v1
    v_and_b32 v99, 0xffff0000, v1
    v_lshlrev_b32 v100, 16, v2
    v_and_b32 v101, 0xffff0000, v2
    v_lshlrev_b32 v102, 16, v3
    v_and_b32 v103, 0xffff0000, v3
    v_mul_f32 v96, 0xc1200000, v96
    v_mul_f32 v97, 0xc1200000, v97
    v_mul_f32 v98, 0xc1200000, v98
    v_mul_f32 v99, 0xc1200000, v99
    v_mul_f32 v100, 0xc1200000, v100
    v_mul_f32 v101, 0xc1200000, v101
    v_mul_f32 v102, 0xc1200000, v102
    v_mul_f32 v103, 0xc1200000, v103
    v_cvt_pk_bf16_f32 v0, v96, v97
    v_cvt_pk_bf16_f32 v1, v98, v99
    v_cvt_pk_bf16_f32 v2, v100, v101
    v_cvt_pk_bf16_f32 v3, v102, v103
    v_lshlrev_b32 v96, 16, v0
    v_and_b32 v97, 0xffff0000, v0
    v_lshlrev_b32 v98, 16, v1
    v_and_b32 v99, 0xffff0000, v1
    v_lshlrev_b32 v100, 16, v2
    v_and_b32 v101, 0xffff0000, v2
    v_lshlrev_b32 v102, 16, v3
    v_and_b32 v103, 0xffff0000, v3
    v_mul_f32 v96, 0x3fb8aa3b, v96
    v_mul_f32 v97, 0x3fb8aa3b, v97
    v_mul_f32 v98, 0x3fb8aa3b, v98
    v_mul_f32 v99, 0x3fb8aa3b, v99
    v_mul_f32 v100, 0x3fb8aa3b, v100
    v_mul_f32 v101, 0x3fb8aa3b, v101
    v_mul_f32 v102, 0x3fb8aa3b, v102
    v_mul_f32 v103, 0x3fb8aa3b, v103
    v_exp_f32 v96, v96
    v_exp_f32 v97, v97
    v_exp_f32 v98, v98
    v_exp_f32 v99, v99
    v_exp_f32 v100, v100
    v_exp_f32 v101, v101
    v_exp_f32 v102, v102
    v_exp_f32 v103, v103
    v_cvt_pk_bf16_f32 v76, v96, v97
    v_cvt_pk_bf16_f32 v77, v98, v99
    v_cvt_pk_bf16_f32 v78, v100, v101
    v_cvt_pk_bf16_f32 v79, v102, v103
    v_mfma_f32_4x4x4_16b_bf16 v[16:19], v[48:49], v[104:105], 0
    v_mfma_f32_4x4x4_16b_bf16 v[24:27], v[52:53], v[104:105], 0
    v_mfma_f32_4x4x4_16b_bf16 v[20:23], v[48:49], v[76:77], 0
    v_mfma_f32_4x4x4_16b_bf16 v[28:31], v[52:53], v[76:77], 0
    v_mfma_f32_4x4x4_16b_bf16 v[16:19], v[50:51], v[106:107], v[16:19]
    v_mfma_f32_4x4x4_16b_bf16 v[24:27], v[54:55], v[106:107], v[24:27]
    v_mfma_f32_4x4x4_16b_bf16 v[20:23], v[50:51], v[78:79], v[20:23]
    v_mfma_f32_4x4x4_16b_bf16 v[28:31], v[54:55], v[78:79], v[28:31]
L2_f5:
    s_waitcnt vmcnt(0) lgkmcnt(0)
    v_mfma_f32_4x4x4_16b_bf16 v[96:99], v[10:11], v[32:33], 0
    v_mfma_f32_4x4x4_16b_bf16 v[100:103], v[10:11], v[34:35], 0
    s_nop 0
    v_mfma_f32_4x4x4_16b_bf16 v[96:99], v[10:11], v[36:37], v[96:99]
    v_mfma_f32_4x4x4_16b_bf16 v[100:103], v[10:11], v[38:39], v[100:103]
    s_nop 0
    v_mfma_f32_4x4x4_16b_bf16 v[96:99], v[10:11], v[40:41], v[96:99]
    v_mfma_f32_4x4x4_16b_bf16 v[100:103], v[10:11], v[42:43], v[100:103]
    s_nop 0
    v_mfma_f32_4x4x4_16b_bf16 v[96:99], v[10:11], v[44:45], v[96:99]
    v_mfma_f32_4x4x4_16b_bf16 v[100:103], v[10:11], v[46:47], v[100:103]
    s_nop 3
    v_mul_f32 v96, v96, v80
    v_mul_f32 v97, v97, v81
    v_mul_f32 v98, v98, v82
    v_mul_f32 v99, v99, v83
    v_cvt_pk_bf16_f32 v32, v96, v97
    v_cvt_pk_bf16_f32 v33, v98, v99
    v_mul_f32 v100, v100, v84
    v_mul_f32 v101, v101, v85
    v_mul_f32 v102, v102, v86
    v_mul_f32 v103, v103, v87
    v_cvt_pk_bf16_f32 v34, v100, v101
    v_cvt_pk_bf16_f32 v35, v102, v103
    v_mfma_f32_4x4x4_16b_bf16 v[80:83], v[56:57], v[32:33], 0
    s_nop 0
    v_mfma_f32_4x4x4_16b_bf16 v[84:87], v[56:57], v[34:35], 0
    s_nop 2
    v_mul_f32 v80, v80, v88
    v_mul_f32 v81, v81, v89
    v_mul_f32 v82, v82, v90
    v_mul_f32 v83, v83, v91
    v_mul_f32 v84, v84, v92
    v_mul_f32 v85, v85, v93
    v_mul_f32 v86, v86, v94
    v_mul_f32 v87, v87, v95
    v_mfma_f32_4x4x4_16b_bf16 v[96:99], v[10:11], v[108:109], v[80:83]
    s_nop 0
    v_mfma_f32_4x4x4_16b_bf16 v[100:103], v[10:11], v[110:111], v[84:87]
    s_nop 2
    v_cvt_pk_bf16_f32 v36, v96, v97
    v_cvt_pk_bf16_f32 v37, v98, v99
    v_cvt_pk_bf16_f32 v38, v100, v101
    v_cvt_pk_bf16_f32 v39, v102, v103
    buffer_store_dwordx4 v[36:39], v120, s[12:15], 0 offen nt
    s_cmp_ge_u32 s32, 4
    s_cbranch_scc1 L2_f6
    v_mfma_f32_4x4x4_16b_bf16 v[96:99], v[10:11], v[60:61], 0
    v_mfma_f32_4x4x4_16b_bf16 v[100:103], v[10:11], v[62:63], 0
    s_nop 0
    v_mfma_f32_4x4x4_16b_bf16 v[96:99], v[10:11], v[64:65], v[96:99]
    v_mfma_f32_4x4x4_16b_bf16 v[100:103], v[10:11], v[66:67], v[100:103]
    s_nop 0
    v_mfma_f32_4x4x4_16b_bf16 v[96:99], v[10:11], v[68:69], v[96:99]
    v_mfma_f32_4x4x4_16b_bf16 v[100:103], v[10:11], v[70:71], v[100:103]
    s_nop 0
    v_mfma_f32_4x4x4_16b_bf16 v[96:99], v[10:11], v[72:73], v[96:99]
    v_mfma_f32_4x4x4_16b_bf16 v[100:103], v[10:11], v[74:75], v[100:103]
    s_nop 3
    v_mul_f32 v96, v96, v16
    v_mul_f32 v97, v97, v17
    v_mul_f32 v98, v98, v18
    v_mul_f32 v99, v99, v19
    v_cvt_pk_bf16_f32 v60, v96, v97
    v_cvt_pk_bf16_f32 v61, v98, v99
    v_mul_f32 v100, v100, v20
    v_mul_f32 v101, v101, v21
    v_mul_f32 v102, v102, v22
    v_mul_f32 v103, v103, v23
    v_cvt_pk_bf16_f32 v62, v100, v101
    v_cvt_pk_bf16_f32 v63, v102, v103
    v_mfma_f32_4x4x4_16b_bf16 v[16:19], v[56:57], v[60:61], 0
    s_nop 0
    v_mfma_f32_4x4x4_16b_bf16 v[20:23], v[56:57], v[62:63], 0
    s_nop 2
    v_mul_f32 v16, v16, v24
    v_mul_f32 v17, v17, v25
    v_mul_f32 v18, v18, v26
    v_mul_f32 v19, v19, v27
    v_mul_f32 v20, v20, v28
    v_mul_f32 v21, v21, v29
    v_mul_f32 v22, v22, v30
    v_mul_f32 v23, v23, v31
    v_mfma_f32_4x4x4_16b_bf16 v[96:99], v[10:11], v[112:113], v[16:19]
    s_nop 0
    v_mfma_f32_4x4x4_16b_bf16 v[100:103], v[10:11], v[114:115], v[20:23]
    s_nop 2
    v_cvt_pk_bf16_f32 v64, v96, v97
    v_cvt_pk_bf16_f32 v65, v98, v99
    v_cvt_pk_bf16_f32 v66, v100, v101
    v_cvt_pk_bf16_f32 v67, v102, v103
    buffer_store_dwordx4 v[64:67], v121, s[12:15], 0 offen nt
L2_f6:
L2_end:
    s_endpgm
L2_slow:
    s_lshr_b32 s35, s42, 2
    s_lshl_b32 s50, s32, 4
    s_and_b32 s3, s42, 3
    s_lshl_b32 s53, s3, 3
    s_add_u32 s53, s53, s39
    s_and_b32 s3, s35, 2
    s_lshl_b32 s3, s3, 1
    s_add_u32 s53, s53, s3
    s_and_b32 s54, s35, 1
    s_lshl_b32 s54, s54, 4
L2_sl_seg:
    s_mul_i32 s55, s50, 173056
    s_and_b32 s3, s50, 3
    s_lshl_b32 s3, s3, 5
    s_add_u32 s3, s3, s55
    s_add_u32 s3, s3, s53
    buffer_load_dword v104, off, s[12:15], s3 sc1
    buffer_load_dword v105, off, s[12:15], s3 offset:32 sc1
    s_waitcnt vmcnt(0)
    v_readfirstlane_b32 s51, v104
    v_readfirstlane_b32 s52, v105
    s_lshr_b32 s51, s51, s54
    s_and_b32 s51, s51, 0xffff
    s_lshr_b32 s52, s52, s54
    s_and_b32 s52, s52, 0xffff
L2_sl_rec:
    s_cmp_ge_u32 s51, s52
    s_cbranch_scc1 L2_sl_next
    v_mbcnt_lo_u32_b32 v102, -1, 0
    v_mbcnt_hi_u32_b32 v102, -1, v102
    v_add_u32 v102, s51, v102
    v_and_b32 v103, -4, v102
    v_lshl_add_u32 v104, v102, 2, v103
    v_lshl_add_u32 v105, v103, 2, v102
    v_cmp_gt_u32 vcc, s52, v102
    s_mov_b64 exec, vcc
    buffer_load_dword v106, v104, s[8:11], s55 offen
    buffer_load_ubyte v107, v105, s[8:11], s55 offen offset:16
    s_waitcnt vmcnt(0)
    v_lshrrev_b32 v98, 14, v106
    v_and_b32 v98, v5, v98
    ds_read_b64 v[100:101], v98
    v_perm_b32 v97, v106, v107, s44
    v_and_b32 v96, v5, v106
    v_bitop3_b32 v103, v106, 0.5, -0.5 bitop3:0xa8
    v_bitop3_b32 v97, v6, v97, v103 bitop3:0xca
    s_waitcnt lgkmcnt(0)
    v_mfma_f32_4x4x4_16b_bf16 v[88:91], v[8:9], v[100:101], 0
    s_nop 4
    v_mul_f32 v88, v97, v88
    v_mul_f32 v89, v97, v89
    v_mul_f32 v90, v97, v90
    v_mul_f32 v91, v97, v91
    v_cvt_pk_bf16_f32 v88, v88, v89
    v_cvt_pk_bf16_f32 v89, v90, v91
    ds_pk_add_bf16 v96, v88 offset:65408
    ds_pk_add_bf16 v96, v89 offset:65412
    s_mov_b64 exec, -1
    s_add_u32 s51, s51, 64
    s_branch L2_sl_rec
L2_sl_next:
    s_add_u32 s50, s50, 1
    s_and_b32 s3, s50, 15
    s_cbranch_scc1 L2_sl_seg
    s_add_u32 s50, s50, 240
    s_cmp_lt_u32 s50, 1280
    s_cbranch_scc1 L2_sl_seg
    s_waitcnt lgkmcnt(0)
    s_cmp_eq_u32 s42, 0
    s_cbranch_scc1 L2_ret0
    s_cmp_eq_u32 s42, 1
    s_cbranch_scc1 L2_ret1
    s_cmp_eq_u32 s42, 14
    s_cbranch_scc1 L2_ret6
    s_cmp_eq_u32 s42, 15
    s_cbranch_scc1 L2_ret7
    s_and_b32 s3, s42, 3
    s_cmp_eq_u32 s3, 2
    s_cbranch_scc1 L2_ret2
    s_cmp_eq_u32 s3, 3
    s_cbranch_scc1 L2_ret3
    s_cmp_eq_u32 s3, 0
    s_cbranch_scc1 L2_ret4
    s_branch L2_ret5
L2_p1s:
    s_sleep 32
    s_branch L2_p1
L2_xo3:
    v_cmp_lt_u32 vcc, 20, v99
    s_mov_b32 s101, 1
    s_cbranch_vccz L2_xp3
    v_cmp_lt_u32 vcc, 32, v99
    v_cmp_lt_u32 s[58:59], 31, v88
    s_mov_b32 s101, 2
    s_or_b64 vcc, vcc, s[58:59]
    s_cbranch_scc0 L2_xp3
    s_mov_b32 s37, 0x10000
    s_branch L2_xp3
L2_xa4:
    s_cmp_eq_u32 s101, 1
    s_cbranch_scc1 L2_xc4
    v_lshlrev_b32 v89, 0, v96
    v_add_u32 v90, 140, v97
    v_bitop3_b32 v90, v89, v45, v90 bitop3:0x6a
    ds_write_b32 v98, v90 offset:28
    v_lshlrev_b32 v89, 4, v96
    v_add_u32 v90, 120, v97
    v_bitop3_b32 v90, v89, v45, v90 bitop3:0x6a
    ds_write_b32 v98, v90 offset:24
    v_lshlrev_b32 v89, 8, v96
    v_add_u32 v90, 100, v97
    v_bitop3_b32 v90, v89, v45, v90 bitop3:0x6a
    ds_write_b32 v98, v90 offset:20
L2_xc4:
    v_lshlrev_b32 v89, 12, v96
    v_add_u32 v90, 80, v97
    v_bitop3_b32 v90, v89, v45, v90 bitop3:0x6a
    ds_write_b32 v98, v90 offset:16
    s_branch L2_xb4
L2_xe4:
    v_cmp_lt_u32 vcc, 32, v99
    v_cmp_lt_u32 s[58:59], 31, v88
    v_lshrrev_b32 v89, 16, v96
    v_add_u32 v97, 80, v97
    s_or_b64 vcc, vcc, s[58:59]
    s_cbranch_scc1 L2_xs4
    v_lshlrev_b32 v89, v1, v89
    v_and_b32 v89, v45, v89
    v_cmp_ne_u32 vcc, 0, v89
    v_xor_b32 v90, v97, v89
    s_add_u32 s3, s37, s38
    v_mbcnt_lo_u32_b32 v98, vcc_lo, 0
    v_mbcnt_hi_u32_b32 v98, vcc_hi, v98
    s_bcnt1_i32_b64 s41, vcc
    v_lshl_add_u32 v98, v98, 2, s3
    s_mov_b64 exec, vcc
    ds_write_b32 v98, v90
    s_mov_b64 exec, -1
    s_lshl2_add_u32 s37, s41, s37
    s_branch L2_xr4
L2_xf4:
    s_waitcnt lgkmcnt(0)
    s_cmp_gt_u32 s37, 1024
    s_cbranch_scc1 L2_xs4
    v_mov_b32 v43, -1
    s_cmp_ge_u32 s37, 512
    s_cbranch_scc1 L2_xg4
    v_mov_b32 v42, -1
    s_cmp_ge_u32 s37, 256
    s_cbranch_scc1 L2_xg4
    v_mov_b32 v41, -1
    s_branch L2_xg4
L2_xs4:
    s_waitcnt lgkmcnt(0)
    v_mov_b32 v40, -1
    v_mov_b32 v41, -1
    v_mov_b32 v42, -1
    v_mov_b32 v43, -1
    s_add_u32 s3, s42, 0
    s_bitset1_b32 s36, s3
    s_branch L2_xg4
L2_xo5:
    v_cmp_lt_u32 vcc, 20, v99
    s_mov_b32 s101, 1
    s_cbranch_vccz L2_xp5
    v_cmp_lt_u32 vcc, 32, v99
    v_cmp_lt_u32 s[58:59], 31, v88
    s_mov_b32 s101, 2
    s_or_b64 vcc, vcc, s[58:59]
    s_cbranch_scc0 L2_xp5
    s_mov_b32 s37, 0x10000
    s_branch L2_xp5
L2_xa6:
    s_cmp_eq_u32 s101, 1
    s_cbranch_scc1 L2_xc6
    v_lshlrev_b32 v89, 0, v96
    v_add_u32 v90, 140, v97
    v_bitop3_b32 v90, v89, v45, v90 bitop3:0x6a
    ds_write_b32 v98, v90 offset:28
    v_lshlrev_b32 v89, 4, v96
    v_add_u32 v90, 120, v97
    v_bitop3_b32 v90, v89, v45, v90 bitop3:0x6a
    ds_write_b32 v98, v90 offset:24
    v_lshlrev_b32 v89, 8, v96
    v_add_u32 v90, 100, v97
    v_bitop3_b32 v90, v89, v45, v90 bitop3:0x6a
    ds_write_b32 v98, v90 offset:20
L2_xc6:
    v_lshlrev_b32 v89, 12, v96
    v_add_u32 v90, 80, v97
    v_bitop3_b32 v90, v89, v45, v90 bitop3:0x6a
    ds_write_b32 v98, v90 offset:16
    s_branch L2_xb6
L2_xe6:
    v_cmp_lt_u32 vcc, 32, v99
    v_cmp_lt_u32 s[58:59], 31, v88
    v_lshrrev_b32 v89, 16, v96
    v_add_u32 v97, 80, v97
    s_or_b64 vcc, vcc, s[58:59]
    s_cbranch_scc1 L2_xs6
    v_lshlrev_b32 v89, v1, v89
    v_and_b32 v89, v45, v89
    v_cmp_ne_u32 vcc, 0, v89
    v_xor_b32 v90, v97, v89
    s_add_u32 s3, s37, s38
    v_mbcnt_lo_u32_b32 v98, vcc_lo, 0
    v_mbcnt_hi_u32_b32 v98, vcc_hi, v98
    s_bcnt1_i32_b64 s41, vcc
    v_lshl_add_u32 v98, v98, 2, s3
    s_mov_b64 exec, vcc
    ds_write_b32 v98, v90
    s_mov_b64 exec, -1
    s_lshl2_add_u32 s37, s41, s37
    s_branch L2_xr6
L2_xf6:
    s_waitcnt lgkmcnt(0)
    s_cmp_gt_u32 s37, 1024
    s_cbranch_scc1 L2_xs6
    v_mov_b32 v43, -1
    s_cmp_ge_u32 s37, 512
    s_cbranch_scc1 L2_xg6
    v_mov_b32 v42, -1
    s_cmp_ge_u32 s37, 256
    s_cbranch_scc1 L2_xg6
    v_mov_b32 v41, -1
    s_branch L2_xg6
L2_xs6:
    s_waitcnt lgkmcnt(0)
    v_mov_b32 v40, -1
    v_mov_b32 v41, -1
    v_mov_b32 v42, -1
    v_mov_b32 v43, -1
    s_add_u32 s3, s42, 1
    s_bitset1_b32 s36, s3
    s_branch L2_xg6
L2_p2s:
    s_sleep 8
    s_branch L2_p2
L2_c7:
    s_lshl_b64 s[52:53], s[82:83], 1
    s_andn2_b64 s[52:53], s[52:53], s[80:81]
    s_andn2_b64 s[52:53], s[52:53], s[54:55]
    s_or_b64 s[80:81], s[80:81], s[52:53]
    s_not_b64 vcc, s[52:53]
    s_mov_b64 exec, -1
    v_cndmask_b32_dpp v84, v84, v84, vcc wave_shr:1 row_mask:0xf bank_mask:0xf
    v_cndmask_b32_dpp v85, v85, v85, vcc wave_shr:1 row_mask:0xf bank_mask:0xf
    s_lshr_b64 s[52:53], s[52:53], 1
    v_cndmask_b32_dpp v86, v86, v86, vcc wave_shr:1 row_mask:0xf bank_mask:0xf
    v_cndmask_b32_dpp v87, v87, v87, vcc wave_shr:1 row_mask:0xf bank_mask:0xf
    s_andn2_b64 s[82:83], s[82:83], s[52:53]
    v_cndmask_b32_dpp v7, v7, v7, vcc wave_shr:1 row_mask:0xf bank_mask:0xf
    s_mov_b64 exec, s[54:55]
    s_cbranch_scc0 L2_d7
    s_mov_b64 exec, s[82:83]
    s_nop 1
    v_mfma_f32_4x4x4_16b_bf16 v[88:91], v[12:13], v[84:85], 0
    s_nop 1
    v_mfma_f32_4x4x4_16b_bf16 v[88:91], v[10:11], v[86:87], v[88:91]
    s_nop 4
    v_cvt_pk_bf16_f32 v88, v88, v89
    v_cvt_pk_bf16_f32 v89, v90, v91
    ds_pk_add_bf16 v7, v88 offset:65408
    ds_pk_add_bf16 v7, v89 offset:65412
    s_mov_b64 exec, s[54:55]
    s_branch L2_d7
L2_c8:
    s_lshl_b64 s[52:53], s[82:83], 1
    s_andn2_b64 s[52:53], s[52:53], s[80:81]
    s_andn2_b64 s[52:53], s[52:53], s[50:51]
    s_or_b64 s[80:81], s[80:81], s[52:53]
    s_not_b64 vcc, s[52:53]
    s_mov_b64 exec, -1
    v_cndmask_b32_dpp v84, v84, v84, vcc wave_shr:1 row_mask:0xf bank_mask:0xf
    v_cndmask_b32_dpp v85, v85, v85, vcc wave_shr:1 row_mask:0xf bank_mask:0xf
    s_lshr_b64 s[52:53], s[52:53], 1
    v_cndmask_b32_dpp v86, v86, v86, vcc wave_shr:1 row_mask:0xf bank_mask:0xf
    v_cndmask_b32_dpp v87, v87, v87, vcc wave_shr:1 row_mask:0xf bank_mask:0xf
    s_andn2_b64 s[82:83], s[82:83], s[52:53]
    v_cndmask_b32_dpp v7, v7, v7, vcc wave_shr:1 row_mask:0xf bank_mask:0xf
    s_mov_b64 exec, s[50:51]
    s_cbranch_scc0 L2_d8
    s_mov_b64 exec, s[82:83]
    s_nop 1
    v_mfma_f32_4x4x4_16b_bf16 v[88:91], v[12:13], v[84:85], 0
    s_nop 1
    v_mfma_f32_4x4x4_16b_bf16 v[88:91], v[10:11], v[86:87], v[88:91]
    s_nop 4
    v_cvt_pk_bf16_f32 v88, v88, v89
    v_cvt_pk_bf16_f32 v89, v90, v91
    ds_pk_add_bf16 v7, v88 offset:65408
    ds_pk_add_bf16 v7, v89 offset:65412
    s_mov_b64 exec, s[50:51]
    s_branch L2_d8
L2_xo9:
    v_cmp_lt_u32 vcc, 20, v99
    s_mov_b32 s101, 1
    s_cbranch_vccz L2_xp9
    v_cmp_lt_u32 vcc, 32, v99
    v_cmp_lt_u32 s[58:59], 31, v88
    s_mov_b32 s101, 2
    s_or_b64 vcc, vcc, s[58:59]
    s_cbranch_scc0 L2_xp9
    s_mov_b32 s37, 0x10000
    s_branch L2_xp9
L2_c12:
    s_lshl_b64 s[52:53], s[82:83], 1
    s_andn2_b64 s[52:53], s[52:53], s[80:81]
    s_andn2_b64 s[52:53], s[52:53], s[54:55]
    s_or_b64 s[80:81], s[80:81], s[52:53]
    s_not_b64 vcc, s[52:53]
    s_mov_b64 exec, -1
    v_cndmask_b32_dpp v84, v84, v84, vcc wave_shr:1 row_mask:0xf bank_mask:0xf
    v_cndmask_b32_dpp v85, v85, v85, vcc wave_shr:1 row_mask:0xf bank_mask:0xf
    s_lshr_b64 s[52:53], s[52:53], 1
    v_cndmask_b32_dpp v86, v86, v86, vcc wave_shr:1 row_mask:0xf bank_mask:0xf
    v_cndmask_b32_dpp v87, v87, v87, vcc wave_shr:1 row_mask:0xf bank_mask:0xf
    s_andn2_b64 s[82:83], s[82:83], s[52:53]
    v_cndmask_b32_dpp v7, v7, v7, vcc wave_shr:1 row_mask:0xf bank_mask:0xf
    s_mov_b64 exec, s[54:55]
    s_cbranch_scc0 L2_d12
    s_mov_b64 exec, s[82:83]
    s_nop 1
    v_mfma_f32_4x4x4_16b_bf16 v[88:91], v[12:13], v[84:85], 0
    s_nop 1
    v_mfma_f32_4x4x4_16b_bf16 v[88:91], v[10:11], v[86:87], v[88:91]
    s_nop 4
    v_cvt_pk_bf16_f32 v88, v88, v89
    v_cvt_pk_bf16_f32 v89, v90, v91
    ds_pk_add_bf16 v7, v88 offset:65408
    ds_pk_add_bf16 v7, v89 offset:65412
    s_mov_b64 exec, s[54:55]
    s_branch L2_d12
L2_c13:
    s_lshl_b64 s[52:53], s[82:83], 1
    s_andn2_b64 s[52:53], s[52:53], s[80:81]
    s_andn2_b64 s[52:53], s[52:53], s[50:51]
    s_or_b64 s[80:81], s[80:81], s[52:53]
    s_not_b64 vcc, s[52:53]
    s_mov_b64 exec, -1
    v_cndmask_b32_dpp v84, v84, v84, vcc wave_shr:1 row_mask:0xf bank_mask:0xf
    v_cndmask_b32_dpp v85, v85, v85, vcc wave_shr:1 row_mask:0xf bank_mask:0xf
    s_lshr_b64 s[52:53], s[52:53], 1
    v_cndmask_b32_dpp v86, v86, v86, vcc wave_shr:1 row_mask:0xf bank_mask:0xf
    v_cndmask_b32_dpp v87, v87, v87, vcc wave_shr:1 row_mask:0xf bank_mask:0xf
    s_andn2_b64 s[82:83], s[82:83], s[52:53]
    v_cndmask_b32_dpp v7, v7, v7, vcc wave_shr:1 row_mask:0xf bank_mask:0xf
    s_mov_b64 exec, s[50:51]
    s_cbranch_scc0 L2_d13
    s_mov_b64 exec, s[82:83]
    s_nop 1
    v_mfma_f32_4x4x4_16b_bf16 v[88:91], v[12:13], v[84:85], 0
    s_nop 1
    v_mfma_f32_4x4x4_16b_bf16 v[88:91], v[10:11], v[86:87], v[88:91]
    s_nop 4
    v_cvt_pk_bf16_f32 v88, v88, v89
    v_cvt_pk_bf16_f32 v89, v90, v91
    ds_pk_add_bf16 v7, v88 offset:65408
    ds_pk_add_bf16 v7, v89 offset:65412
    s_mov_b64 exec, s[50:51]
    s_branch L2_d13
L2_c15:
    s_lshl_b64 s[52:53], s[82:83], 1
    s_andn2_b64 s[52:53], s[52:53], s[80:81]
    s_andn2_b64 s[52:53], s[52:53], s[54:55]
    s_or_b64 s[80:81], s[80:81], s[52:53]
    s_not_b64 vcc, s[52:53]
    s_mov_b64 exec, -1
    v_cndmask_b32_dpp v84, v84, v84, vcc wave_shr:1 row_mask:0xf bank_mask:0xf
    v_cndmask_b32_dpp v85, v85, v85, vcc wave_shr:1 row_mask:0xf bank_mask:0xf
    s_lshr_b64 s[52:53], s[52:53], 1
    v_cndmask_b32_dpp v86, v86, v86, vcc wave_shr:1 row_mask:0xf bank_mask:0xf
    v_cndmask_b32_dpp v87, v87, v87, vcc wave_shr:1 row_mask:0xf bank_mask:0xf
    s_andn2_b64 s[82:83], s[82:83], s[52:53]
    v_cndmask_b32_dpp v7, v7, v7, vcc wave_shr:1 row_mask:0xf bank_mask:0xf
    s_mov_b64 exec, s[54:55]
    s_cbranch_scc0 L2_d15
    s_mov_b64 exec, s[82:83]
    s_nop 1
    v_mfma_f32_4x4x4_16b_bf16 v[88:91], v[12:13], v[84:85], 0
    s_nop 1
    v_mfma_f32_4x4x4_16b_bf16 v[88:91], v[10:11], v[86:87], v[88:91]
    s_nop 4
    v_cvt_pk_bf16_f32 v88, v88, v89
    v_cvt_pk_bf16_f32 v89, v90, v91
    ds_pk_add_bf16 v7, v88 offset:65408
    ds_pk_add_bf16 v7, v89 offset:65412
    s_mov_b64 exec, s[54:55]
    s_branch L2_d15
L2_c16:
    s_lshl_b64 s[52:53], s[82:83], 1
    s_andn2_b64 s[52:53], s[52:53], s[80:81]
    s_andn2_b64 s[52:53], s[52:53], s[50:51]
    s_or_b64 s[80:81], s[80:81], s[52:53]
    s_not_b64 vcc, s[52:53]
    s_mov_b64 exec, -1
    v_cndmask_b32_dpp v84, v84, v84, vcc wave_shr:1 row_mask:0xf bank_mask:0xf
    v_cndmask_b32_dpp v85, v85, v85, vcc wave_shr:1 row_mask:0xf bank_mask:0xf
    s_lshr_b64 s[52:53], s[52:53], 1
    v_cndmask_b32_dpp v86, v86, v86, vcc wave_shr:1 row_mask:0xf bank_mask:0xf
    v_cndmask_b32_dpp v87, v87, v87, vcc wave_shr:1 row_mask:0xf bank_mask:0xf
    s_andn2_b64 s[82:83], s[82:83], s[52:53]
    v_cndmask_b32_dpp v7, v7, v7, vcc wave_shr:1 row_mask:0xf bank_mask:0xf
    s_mov_b64 exec, s[50:51]
    s_cbranch_scc0 L2_d16
    s_mov_b64 exec, s[82:83]
    s_nop 1
    v_mfma_f32_4x4x4_16b_bf16 v[88:91], v[12:13], v[84:85], 0
    s_nop 1
    v_mfma_f32_4x4x4_16b_bf16 v[88:91], v[10:11], v[86:87], v[88:91]
    s_nop 4
    v_cvt_pk_bf16_f32 v88, v88, v89
    v_cvt_pk_bf16_f32 v89, v90, v91
    ds_pk_add_bf16 v7, v88 offset:65408
    ds_pk_add_bf16 v7, v89 offset:65412
    s_mov_b64 exec, s[50:51]
    s_branch L2_d16
L2_c19:
    s_lshl_b64 s[52:53], s[82:83], 1
    s_andn2_b64 s[52:53], s[52:53], s[80:81]
    s_andn2_b64 s[52:53], s[52:53], s[54:55]
    s_or_b64 s[80:81], s[80:81], s[52:53]
    s_not_b64 vcc, s[52:53]
    s_mov_b64 exec, -1
    v_cndmask_b32_dpp v84, v84, v84, vcc wave_shr:1 row_mask:0xf bank_mask:0xf
    v_cndmask_b32_dpp v85, v85, v85, vcc wave_shr:1 row_mask:0xf bank_mask:0xf
    s_lshr_b64 s[52:53], s[52:53], 1
    v_cndmask_b32_dpp v86, v86, v86, vcc wave_shr:1 row_mask:0xf bank_mask:0xf
    v_cndmask_b32_dpp v87, v87, v87, vcc wave_shr:1 row_mask:0xf bank_mask:0xf
    s_andn2_b64 s[82:83], s[82:83], s[52:53]
    v_cndmask_b32_dpp v7, v7, v7, vcc wave_shr:1 row_mask:0xf bank_mask:0xf
    s_mov_b64 exec, s[54:55]
    s_cbranch_scc0 L2_d19
    s_mov_b64 exec, s[82:83]
    s_nop 1
    v_mfma_f32_4x4x4_16b_bf16 v[88:91], v[12:13], v[84:85], 0
    s_nop 1
    v_mfma_f32_4x4x4_16b_bf16 v[88:91], v[10:11], v[86:87], v[88:91]
    s_nop 4
    v_cvt_pk_bf16_f32 v88, v88, v89
    v_cvt_pk_bf16_f32 v89, v90, v91
    ds_pk_add_bf16 v7, v88 offset:65408
    ds_pk_add_bf16 v7, v89 offset:65412
    s_mov_b64 exec, s[54:55]
    s_branch L2_d19
L2_c20:
    s_lshl_b64 s[52:53], s[82:83], 1
    s_andn2_b64 s[52:53], s[52:53], s[80:81]
    s_andn2_b64 s[52:53], s[52:53], s[50:51]
    s_or_b64 s[80:81], s[80:81], s[52:53]
    s_not_b64 vcc, s[52:53]
    s_mov_b64 exec, -1
    v_cndmask_b32_dpp v84, v84, v84, vcc wave_shr:1 row_mask:0xf bank_mask:0xf
    v_cndmask_b32_dpp v85, v85, v85, vcc wave_shr:1 row_mask:0xf bank_mask:0xf
    s_lshr_b64 s[52:53], s[52:53], 1
    v_cndmask_b32_dpp v86, v86, v86, vcc wave_shr:1 row_mask:0xf bank_mask:0xf
    v_cndmask_b32_dpp v87, v87, v87, vcc wave_shr:1 row_mask:0xf bank_mask:0xf
    s_andn2_b64 s[82:83], s[82:83], s[52:53]
    v_cndmask_b32_dpp v7, v7, v7, vcc wave_shr:1 row_mask:0xf bank_mask:0xf
    s_mov_b64 exec, s[50:51]
    s_cbranch_scc0 L2_d20
    s_mov_b64 exec, s[82:83]
    s_nop 1
    v_mfma_f32_4x4x4_16b_bf16 v[88:91], v[12:13], v[84:85], 0
    s_nop 1
    v_mfma_f32_4x4x4_16b_bf16 v[88:91], v[10:11], v[86:87], v[88:91]
    s_nop 4
    v_cvt_pk_bf16_f32 v88, v88, v89
    v_cvt_pk_bf16_f32 v89, v90, v91
    ds_pk_add_bf16 v7, v88 offset:65408
    ds_pk_add_bf16 v7, v89 offset:65412
    s_mov_b64 exec, s[50:51]
    s_branch L2_d20
L2_c21:
    s_lshl_b64 s[52:53], s[82:83], 1
    s_andn2_b64 s[52:53], s[52:53], s[80:81]
    s_andn2_b64 s[52:53], s[52:53], s[54:55]
    s_or_b64 s[80:81], s[80:81], s[52:53]
    s_not_b64 vcc, s[52:53]
    s_mov_b64 exec, -1
    v_cndmask_b32_dpp v84, v84, v84, vcc wave_shr:1 row_mask:0xf bank_mask:0xf
    v_cndmask_b32_dpp v85, v85, v85, vcc wave_shr:1 row_mask:0xf bank_mask:0xf
    s_lshr_b64 s[52:53], s[52:53], 1
    v_cndmask_b32_dpp v86, v86, v86, vcc wave_shr:1 row_mask:0xf bank_mask:0xf
    v_cndmask_b32_dpp v87, v87, v87, vcc wave_shr:1 row_mask:0xf bank_mask:0xf
    s_andn2_b64 s[82:83], s[82:83], s[52:53]
    v_cndmask_b32_dpp v7, v7, v7, vcc wave_shr:1 row_mask:0xf bank_mask:0xf
    s_mov_b64 exec, s[54:55]
    s_cbranch_scc0 L2_d21
    s_mov_b64 exec, s[82:83]
    s_nop 1
    v_mfma_f32_4x4x4_16b_bf16 v[88:91], v[12:13], v[84:85], 0
    s_nop 1
    v_mfma_f32_4x4x4_16b_bf16 v[88:91], v[10:11], v[86:87], v[88:91]
    s_nop 4
    v_cvt_pk_bf16_f32 v88, v88, v89
    v_cvt_pk_bf16_f32 v89, v90, v91
    ds_pk_add_bf16 v7, v88 offset:65408
    ds_pk_add_bf16 v7, v89 offset:65412
    s_mov_b64 exec, s[54:55]
    s_branch L2_d21
L2_c22:
    s_lshl_b64 s[52:53], s[82:83], 1
    s_andn2_b64 s[52:53], s[52:53], s[80:81]
    s_andn2_b64 s[52:53], s[52:53], s[50:51]
    s_or_b64 s[80:81], s[80:81], s[52:53]
    s_not_b64 vcc, s[52:53]
    s_mov_b64 exec, -1
    v_cndmask_b32_dpp v84, v84, v84, vcc wave_shr:1 row_mask:0xf bank_mask:0xf
    v_cndmask_b32_dpp v85, v85, v85, vcc wave_shr:1 row_mask:0xf bank_mask:0xf
    s_lshr_b64 s[52:53], s[52:53], 1
    v_cndmask_b32_dpp v86, v86, v86, vcc wave_shr:1 row_mask:0xf bank_mask:0xf
    v_cndmask_b32_dpp v87, v87, v87, vcc wave_shr:1 row_mask:0xf bank_mask:0xf
    s_andn2_b64 s[82:83], s[82:83], s[52:53]
    v_cndmask_b32_dpp v7, v7, v7, vcc wave_shr:1 row_mask:0xf bank_mask:0xf
    s_mov_b64 exec, s[50:51]
    s_cbranch_scc0 L2_d22
    s_mov_b64 exec, s[82:83]
    s_nop 1
    v_mfma_f32_4x4x4_16b_bf16 v[88:91], v[12:13], v[84:85], 0
    s_nop 1
    v_mfma_f32_4x4x4_16b_bf16 v[88:91], v[10:11], v[86:87], v[88:91]
    s_nop 4
    v_cvt_pk_bf16_f32 v88, v88, v89
    v_cvt_pk_bf16_f32 v89, v90, v91
    ds_pk_add_bf16 v7, v88 offset:65408
    ds_pk_add_bf16 v7, v89 offset:65412
    s_mov_b64 exec, s[50:51]
    s_branch L2_d22
L2_c23:
    s_lshl_b64 s[52:53], s[82:83], 1
    s_andn2_b64 s[52:53], s[52:53], s[80:81]
    s_andn2_b64 s[52:53], s[52:53], s[54:55]
    s_or_b64 s[80:81], s[80:81], s[52:53]
    s_not_b64 vcc, s[52:53]
    s_mov_b64 exec, -1
    v_cndmask_b32_dpp v84, v84, v84, vcc wave_shr:1 row_mask:0xf bank_mask:0xf
    v_cndmask_b32_dpp v85, v85, v85, vcc wave_shr:1 row_mask:0xf bank_mask:0xf
    s_lshr_b64 s[52:53], s[52:53], 1
    v_cndmask_b32_dpp v86, v86, v86, vcc wave_shr:1 row_mask:0xf bank_mask:0xf
    v_cndmask_b32_dpp v87, v87, v87, vcc wave_shr:1 row_mask:0xf bank_mask:0xf
    s_andn2_b64 s[82:83], s[82:83], s[52:53]
    v_cndmask_b32_dpp v7, v7, v7, vcc wave_shr:1 row_mask:0xf bank_mask:0xf
    s_mov_b64 exec, s[54:55]
    s_cbranch_scc0 L2_d23
    s_mov_b64 exec, s[82:83]
    s_nop 1
    v_mfma_f32_4x4x4_16b_bf16 v[88:91], v[12:13], v[84:85], 0
    s_nop 1
    v_mfma_f32_4x4x4_16b_bf16 v[88:91], v[10:11], v[86:87], v[88:91]
    s_nop 4
    v_cvt_pk_bf16_f32 v88, v88, v89
    v_cvt_pk_bf16_f32 v89, v90, v91
    ds_pk_add_bf16 v7, v88 offset:65408
    ds_pk_add_bf16 v7, v89 offset:65412
    s_mov_b64 exec, s[54:55]
    s_branch L2_d23
L2_c24:
    s_lshl_b64 s[52:53], s[82:83], 1
    s_andn2_b64 s[52:53], s[52:53], s[80:81]
    s_andn2_b64 s[52:53], s[52:53], s[50:51]
    s_or_b64 s[80:81], s[80:81], s[52:53]
    s_not_b64 vcc, s[52:53]
    s_mov_b64 exec, -1
    v_cndmask_b32_dpp v84, v84, v84, vcc wave_shr:1 row_mask:0xf bank_mask:0xf
    v_cndmask_b32_dpp v85, v85, v85, vcc wave_shr:1 row_mask:0xf bank_mask:0xf
    s_lshr_b64 s[52:53], s[52:53], 1
    v_cndmask_b32_dpp v86, v86, v86, vcc wave_shr:1 row_mask:0xf bank_mask:0xf
    v_cndmask_b32_dpp v87, v87, v87, vcc wave_shr:1 row_mask:0xf bank_mask:0xf
    s_andn2_b64 s[82:83], s[82:83], s[52:53]
    v_cndmask_b32_dpp v7, v7, v7, vcc wave_shr:1 row_mask:0xf bank_mask:0xf
    s_mov_b64 exec, s[50:51]
    s_cbranch_scc0 L2_d24
    s_mov_b64 exec, s[82:83]
    s_nop 1
    v_mfma_f32_4x4x4_16b_bf16 v[88:91], v[12:13], v[84:85], 0
    s_nop 1
    v_mfma_f32_4x4x4_16b_bf16 v[88:91], v[10:11], v[86:87], v[88:91]
    s_nop 4
    v_cvt_pk_bf16_f32 v88, v88, v89
    v_cvt_pk_bf16_f32 v89, v90, v91
    ds_pk_add_bf16 v7, v88 offset:65408
    ds_pk_add_bf16 v7, v89 offset:65412
    s_mov_b64 exec, s[50:51]
    s_branch L2_d24
L2_xa25:
    s_cmp_eq_u32 s101, 1
    s_cbranch_scc1 L2_xc25
    v_lshlrev_b32 v89, 0, v96
    v_add_u32 v90, 140, v97
    v_bitop3_b32 v90, v89, v45, v90 bitop3:0x6a
    ds_write_b32 v98, v90 offset:28
    v_lshlrev_b32 v89, 4, v96
    v_add_u32 v90, 120, v97
    v_bitop3_b32 v90, v89, v45, v90 bitop3:0x6a
    ds_write_b32 v98, v90 offset:24
    v_lshlrev_b32 v89, 8, v96
    v_add_u32 v90, 100, v97
    v_bitop3_b32 v90, v89, v45, v90 bitop3:0x6a
    ds_write_b32 v98, v90 offset:20
L2_xc25:
    v_lshlrev_b32 v89, 12, v96
    v_add_u32 v90, 80, v97
    v_bitop3_b32 v90, v89, v45, v90 bitop3:0x6a
    ds_write_b32 v98, v90 offset:16
    s_branch L2_xb25
L2_xe25:
    v_cmp_lt_u32 vcc, 32, v99
    v_cmp_lt_u32 s[58:59], 31, v88
    v_lshrrev_b32 v89, 16, v96
    v_add_u32 v97, 80, v97
    s_or_b64 vcc, vcc, s[58:59]
    s_cbranch_scc1 L2_xs25
    v_lshlrev_b32 v89, v1, v89
    v_and_b32 v89, v45, v89
    v_cmp_ne_u32 vcc, 0, v89
    v_xor_b32 v90, v97, v89
    s_add_u32 s3, s37, s38
    v_mbcnt_lo_u32_b32 v98, vcc_lo, 0
    v_mbcnt_hi_u32_b32 v98, vcc_hi, v98
    s_bcnt1_i32_b64 s41, vcc
    v_lshl_add_u32 v98, v98, 2, s3
    s_mov_b64 exec, vcc
    ds_write_b32 v98, v90
    s_mov_b64 exec, -1
    s_lshl2_add_u32 s37, s41, s37
    s_branch L2_xr25
L2_xf25:
    s_waitcnt lgkmcnt(0)
    s_cmp_gt_u32 s37, 1024
    s_cbranch_scc1 L2_xs25
    v_mov_b32 v43, -1
    s_cmp_ge_u32 s37, 512
    s_cbranch_scc1 L2_xg25
    v_mov_b32 v42, -1
    s_cmp_ge_u32 s37, 256
    s_cbranch_scc1 L2_xg25
    v_mov_b32 v41, -1
    s_branch L2_xg25
L2_xs25:
    s_waitcnt lgkmcnt(0)
    v_mov_b32 v40, -1
    v_mov_b32 v41, -1
    v_mov_b32 v42, -1
    v_mov_b32 v43, -1
    s_add_u32 s3, s42, 2
    s_bitset1_b32 s36, s3
    s_branch L2_xg25
L2_c26:
    s_lshl_b64 s[52:53], s[82:83], 1
    s_andn2_b64 s[52:53], s[52:53], s[80:81]
    s_andn2_b64 s[52:53], s[52:53], s[54:55]
    s_or_b64 s[80:81], s[80:81], s[52:53]
    s_not_b64 vcc, s[52:53]
    s_mov_b64 exec, -1
    v_cndmask_b32_dpp v84, v84, v84, vcc wave_shr:1 row_mask:0xf bank_mask:0xf
    v_cndmask_b32_dpp v85, v85, v85, vcc wave_shr:1 row_mask:0xf bank_mask:0xf
    s_lshr_b64 s[52:53], s[52:53], 1
    v_cndmask_b32_dpp v86, v86, v86, vcc wave_shr:1 row_mask:0xf bank_mask:0xf
    v_cndmask_b32_dpp v87, v87, v87, vcc wave_shr:1 row_mask:0xf bank_mask:0xf
    s_andn2_b64 s[82:83], s[82:83], s[52:53]
    v_cndmask_b32_dpp v7, v7, v7, vcc wave_shr:1 row_mask:0xf bank_mask:0xf
    s_mov_b64 exec, s[54:55]
    s_cbranch_scc0 L2_d26
    s_mov_b64 exec, s[82:83]
    s_nop 1
    v_mfma_f32_4x4x4_16b_bf16 v[88:91], v[12:13], v[84:85], 0
    s_nop 1
    v_mfma_f32_4x4x4_16b_bf16 v[88:91], v[10:11], v[86:87], v[88:91]
    s_nop 4
    v_cvt_pk_bf16_f32 v88, v88, v89
    v_cvt_pk_bf16_f32 v89, v90, v91
    ds_pk_add_bf16 v7, v88 offset:65408
    ds_pk_add_bf16 v7, v89 offset:65412
    s_mov_b64 exec, s[54:55]
    s_branch L2_d26
L2_c27:
    s_lshl_b64 s[52:53], s[82:83], 1
    s_andn2_b64 s[52:53], s[52:53], s[80:81]
    s_andn2_b64 s[52:53], s[52:53], s[50:51]
    s_or_b64 s[80:81], s[80:81], s[52:53]
    s_not_b64 vcc, s[52:53]
    s_mov_b64 exec, -1
    v_cndmask_b32_dpp v84, v84, v84, vcc wave_shr:1 row_mask:0xf bank_mask:0xf
    v_cndmask_b32_dpp v85, v85, v85, vcc wave_shr:1 row_mask:0xf bank_mask:0xf
    s_lshr_b64 s[52:53], s[52:53], 1
    v_cndmask_b32_dpp v86, v86, v86, vcc wave_shr:1 row_mask:0xf bank_mask:0xf
    v_cndmask_b32_dpp v87, v87, v87, vcc wave_shr:1 row_mask:0xf bank_mask:0xf
    s_andn2_b64 s[82:83], s[82:83], s[52:53]
    v_cndmask_b32_dpp v7, v7, v7, vcc wave_shr:1 row_mask:0xf bank_mask:0xf
    s_mov_b64 exec, s[50:51]
    s_cbranch_scc0 L2_d27
    s_mov_b64 exec, s[82:83]
    s_nop 1
    v_mfma_f32_4x4x4_16b_bf16 v[88:91], v[12:13], v[84:85], 0
    s_nop 1
    v_mfma_f32_4x4x4_16b_bf16 v[88:91], v[10:11], v[86:87], v[88:91]
    s_nop 4
    v_cvt_pk_bf16_f32 v88, v88, v89
    v_cvt_pk_bf16_f32 v89, v90, v91
    ds_pk_add_bf16 v7, v88 offset:65408
    ds_pk_add_bf16 v7, v89 offset:65412
    s_mov_b64 exec, s[50:51]
    s_branch L2_d27
L2_c28:
    s_lshl_b64 s[52:53], s[82:83], 1
    s_andn2_b64 s[52:53], s[52:53], s[80:81]
    s_andn2_b64 s[52:53], s[52:53], s[54:55]
    s_or_b64 s[80:81], s[80:81], s[52:53]
    s_not_b64 vcc, s[52:53]
    s_mov_b64 exec, -1
    v_cndmask_b32_dpp v84, v84, v84, vcc wave_shr:1 row_mask:0xf bank_mask:0xf
    v_cndmask_b32_dpp v85, v85, v85, vcc wave_shr:1 row_mask:0xf bank_mask:0xf
    s_lshr_b64 s[52:53], s[52:53], 1
    v_cndmask_b32_dpp v86, v86, v86, vcc wave_shr:1 row_mask:0xf bank_mask:0xf
    v_cndmask_b32_dpp v87, v87, v87, vcc wave_shr:1 row_mask:0xf bank_mask:0xf
    s_andn2_b64 s[82:83], s[82:83], s[52:53]
    v_cndmask_b32_dpp v7, v7, v7, vcc wave_shr:1 row_mask:0xf bank_mask:0xf
    s_mov_b64 exec, s[54:55]
    s_cbranch_scc0 L2_d28
    s_mov_b64 exec, s[82:83]
    s_nop 1
    v_mfma_f32_4x4x4_16b_bf16 v[88:91], v[12:13], v[84:85], 0
    s_nop 1
    v_mfma_f32_4x4x4_16b_bf16 v[88:91], v[10:11], v[86:87], v[88:91]
    s_nop 4
    v_cvt_pk_bf16_f32 v88, v88, v89
    v_cvt_pk_bf16_f32 v89, v90, v91
    ds_pk_add_bf16 v7, v88 offset:65408
    ds_pk_add_bf16 v7, v89 offset:65412
    s_mov_b64 exec, s[54:55]
    s_branch L2_d28
L2_c29:
    s_lshl_b64 s[52:53], s[82:83], 1
    s_andn2_b64 s[52:53], s[52:53], s[80:81]
    s_andn2_b64 s[52:53], s[52:53], s[50:51]
    s_or_b64 s[80:81], s[80:81], s[52:53]
    s_not_b64 vcc, s[52:53]
    s_mov_b64 exec, -1
    v_cndmask_b32_dpp v84, v84, v84, vcc wave_shr:1 row_mask:0xf bank_mask:0xf
    v_cndmask_b32_dpp v85, v85, v85, vcc wave_shr:1 row_mask:0xf bank_mask:0xf
    s_lshr_b64 s[52:53], s[52:53], 1
    v_cndmask_b32_dpp v86, v86, v86, vcc wave_shr:1 row_mask:0xf bank_mask:0xf
    v_cndmask_b32_dpp v87, v87, v87, vcc wave_shr:1 row_mask:0xf bank_mask:0xf
    s_andn2_b64 s[82:83], s[82:83], s[52:53]
    v_cndmask_b32_dpp v7, v7, v7, vcc wave_shr:1 row_mask:0xf bank_mask:0xf
    s_mov_b64 exec, s[50:51]
    s_cbranch_scc0 L2_d29
    s_mov_b64 exec, s[82:83]
    s_nop 1
    v_mfma_f32_4x4x4_16b_bf16 v[88:91], v[12:13], v[84:85], 0
    s_nop 1
    v_mfma_f32_4x4x4_16b_bf16 v[88:91], v[10:11], v[86:87], v[88:91]
    s_nop 4
    v_cvt_pk_bf16_f32 v88, v88, v89
    v_cvt_pk_bf16_f32 v89, v90, v91
    ds_pk_add_bf16 v7, v88 offset:65408
    ds_pk_add_bf16 v7, v89 offset:65412
    s_mov_b64 exec, s[50:51]
    s_branch L2_d29
L2_c30:
    s_lshl_b64 s[52:53], s[82:83], 1
    s_andn2_b64 s[52:53], s[52:53], s[80:81]
    s_andn2_b64 s[52:53], s[52:53], s[54:55]
    s_or_b64 s[80:81], s[80:81], s[52:53]
    s_not_b64 vcc, s[52:53]
    s_mov_b64 exec, -1
    v_cndmask_b32_dpp v84, v84, v84, vcc wave_shr:1 row_mask:0xf bank_mask:0xf
    v_cndmask_b32_dpp v85, v85, v85, vcc wave_shr:1 row_mask:0xf bank_mask:0xf
    s_lshr_b64 s[52:53], s[52:53], 1
    v_cndmask_b32_dpp v86, v86, v86, vcc wave_shr:1 row_mask:0xf bank_mask:0xf
    v_cndmask_b32_dpp v87, v87, v87, vcc wave_shr:1 row_mask:0xf bank_mask:0xf
    s_andn2_b64 s[82:83], s[82:83], s[52:53]
    v_cndmask_b32_dpp v7, v7, v7, vcc wave_shr:1 row_mask:0xf bank_mask:0xf
    s_mov_b64 exec, s[54:55]
    s_cbranch_scc0 L2_d30
    s_mov_b64 exec, s[82:83]
    s_nop 1
    v_mfma_f32_4x4x4_16b_bf16 v[88:91], v[12:13], v[84:85], 0
    s_nop 1
    v_mfma_f32_4x4x4_16b_bf16 v[88:91], v[10:11], v[86:87], v[88:91]
    s_nop 4
    v_cvt_pk_bf16_f32 v88, v88, v89
    v_cvt_pk_bf16_f32 v89, v90, v91
    ds_pk_add_bf16 v7, v88 offset:65408
    ds_pk_add_bf16 v7, v89 offset:65412
    s_mov_b64 exec, s[54:55]
    s_branch L2_d30
L2_c31:
    s_lshl_b64 s[52:53], s[82:83], 1
    s_andn2_b64 s[52:53], s[52:53], s[80:81]
    s_andn2_b64 s[52:53], s[52:53], s[50:51]
    s_or_b64 s[80:81], s[80:81], s[52:53]
    s_not_b64 vcc, s[52:53]
    s_mov_b64 exec, -1
    v_cndmask_b32_dpp v84, v84, v84, vcc wave_shr:1 row_mask:0xf bank_mask:0xf
    v_cndmask_b32_dpp v85, v85, v85, vcc wave_shr:1 row_mask:0xf bank_mask:0xf
    s_lshr_b64 s[52:53], s[52:53], 1
    v_cndmask_b32_dpp v86, v86, v86, vcc wave_shr:1 row_mask:0xf bank_mask:0xf
    v_cndmask_b32_dpp v87, v87, v87, vcc wave_shr:1 row_mask:0xf bank_mask:0xf
    s_andn2_b64 s[82:83], s[82:83], s[52:53]
    v_cndmask_b32_dpp v7, v7, v7, vcc wave_shr:1 row_mask:0xf bank_mask:0xf
    s_mov_b64 exec, s[50:51]
    s_cbranch_scc0 L2_d31
    s_mov_b64 exec, s[82:83]
    s_nop 1
    v_mfma_f32_4x4x4_16b_bf16 v[88:91], v[12:13], v[84:85], 0
    s_nop 1
    v_mfma_f32_4x4x4_16b_bf16 v[88:91], v[10:11], v[86:87], v[88:91]
    s_nop 4
    v_cvt_pk_bf16_f32 v88, v88, v89
    v_cvt_pk_bf16_f32 v89, v90, v91
    ds_pk_add_bf16 v7, v88 offset:65408
    ds_pk_add_bf16 v7, v89 offset:65412
    s_mov_b64 exec, s[50:51]
    s_branch L2_d31
L2_xo32:
    v_cmp_lt_u32 vcc, 20, v99
    s_mov_b32 s101, 1
    s_cbranch_vccz L2_xp32
    v_cmp_lt_u32 vcc, 32, v99
    v_cmp_lt_u32 s[58:59], 31, v88
    s_mov_b32 s101, 2
    s_or_b64 vcc, vcc, s[58:59]
    s_cbranch_scc0 L2_xp32
    s_mov_b32 s37, 0x10000
    s_branch L2_xp32
L2_c33:
    s_lshl_b64 s[52:53], s[82:83], 1
    s_andn2_b64 s[52:53], s[52:53], s[80:81]
    s_andn2_b64 s[52:53], s[52:53], s[54:55]
    s_or_b64 s[80:81], s[80:81], s[52:53]
    s_not_b64 vcc, s[52:53]
    s_mov_b64 exec, -1
    v_cndmask_b32_dpp v84, v84, v84, vcc wave_shr:1 row_mask:0xf bank_mask:0xf
    v_cndmask_b32_dpp v85, v85, v85, vcc wave_shr:1 row_mask:0xf bank_mask:0xf
    s_lshr_b64 s[52:53], s[52:53], 1
    v_cndmask_b32_dpp v86, v86, v86, vcc wave_shr:1 row_mask:0xf bank_mask:0xf
    v_cndmask_b32_dpp v87, v87, v87, vcc wave_shr:1 row_mask:0xf bank_mask:0xf
    s_andn2_b64 s[82:83], s[82:83], s[52:53]
    v_cndmask_b32_dpp v7, v7, v7, vcc wave_shr:1 row_mask:0xf bank_mask:0xf
    s_mov_b64 exec, s[54:55]
    s_cbranch_scc0 L2_d33
    s_mov_b64 exec, s[82:83]
    s_nop 1
    v_mfma_f32_4x4x4_16b_bf16 v[88:91], v[12:13], v[84:85], 0
    s_nop 1
    v_mfma_f32_4x4x4_16b_bf16 v[88:91], v[10:11], v[86:87], v[88:91]
    s_nop 4
    v_cvt_pk_bf16_f32 v88, v88, v89
    v_cvt_pk_bf16_f32 v89, v90, v91
    ds_pk_add_bf16 v7, v88 offset:65408
    ds_pk_add_bf16 v7, v89 offset:65412
    s_mov_b64 exec, s[54:55]
    s_branch L2_d33
L2_c34:
    s_lshl_b64 s[52:53], s[82:83], 1
    s_andn2_b64 s[52:53], s[52:53], s[80:81]
    s_andn2_b64 s[52:53], s[52:53], s[50:51]
    s_or_b64 s[80:81], s[80:81], s[52:53]
    s_not_b64 vcc, s[52:53]
    s_mov_b64 exec, -1
    v_cndmask_b32_dpp v84, v84, v84, vcc wave_shr:1 row_mask:0xf bank_mask:0xf
    v_cndmask_b32_dpp v85, v85, v85, vcc wave_shr:1 row_mask:0xf bank_mask:0xf
    s_lshr_b64 s[52:53], s[52:53], 1
    v_cndmask_b32_dpp v86, v86, v86, vcc wave_shr:1 row_mask:0xf bank_mask:0xf
    v_cndmask_b32_dpp v87, v87, v87, vcc wave_shr:1 row_mask:0xf bank_mask:0xf
    s_andn2_b64 s[82:83], s[82:83], s[52:53]
    v_cndmask_b32_dpp v7, v7, v7, vcc wave_shr:1 row_mask:0xf bank_mask:0xf
    s_mov_b64 exec, s[50:51]
    s_cbranch_scc0 L2_d34
    s_mov_b64 exec, s[82:83]
    s_nop 1
    v_mfma_f32_4x4x4_16b_bf16 v[88:91], v[12:13], v[84:85], 0
    s_nop 1
    v_mfma_f32_4x4x4_16b_bf16 v[88:91], v[10:11], v[86:87], v[88:91]
    s_nop 4
    v_cvt_pk_bf16_f32 v88, v88, v89
    v_cvt_pk_bf16_f32 v89, v90, v91
    ds_pk_add_bf16 v7, v88 offset:65408
    ds_pk_add_bf16 v7, v89 offset:65412
    s_mov_b64 exec, s[50:51]
    s_branch L2_d34
L2_c35:
    s_lshl_b64 s[52:53], s[82:83], 1
    s_andn2_b64 s[52:53], s[52:53], s[80:81]
    s_andn2_b64 s[52:53], s[52:53], s[54:55]
    s_or_b64 s[80:81], s[80:81], s[52:53]
    s_not_b64 vcc, s[52:53]
    s_mov_b64 exec, -1
    v_cndmask_b32_dpp v84, v84, v84, vcc wave_shr:1 row_mask:0xf bank_mask:0xf
    v_cndmask_b32_dpp v85, v85, v85, vcc wave_shr:1 row_mask:0xf bank_mask:0xf
    s_lshr_b64 s[52:53], s[52:53], 1
    v_cndmask_b32_dpp v86, v86, v86, vcc wave_shr:1 row_mask:0xf bank_mask:0xf
    v_cndmask_b32_dpp v87, v87, v87, vcc wave_shr:1 row_mask:0xf bank_mask:0xf
    s_andn2_b64 s[82:83], s[82:83], s[52:53]
    v_cndmask_b32_dpp v7, v7, v7, vcc wave_shr:1 row_mask:0xf bank_mask:0xf
    s_mov_b64 exec, s[54:55]
    s_cbranch_scc0 L2_d35
    s_mov_b64 exec, s[82:83]
    s_nop 1
    v_mfma_f32_4x4x4_16b_bf16 v[88:91], v[12:13], v[84:85], 0
    s_nop 1
    v_mfma_f32_4x4x4_16b_bf16 v[88:91], v[10:11], v[86:87], v[88:91]
    s_nop 4
    v_cvt_pk_bf16_f32 v88, v88, v89
    v_cvt_pk_bf16_f32 v89, v90, v91
    ds_pk_add_bf16 v7, v88 offset:65408
    ds_pk_add_bf16 v7, v89 offset:65412
    s_mov_b64 exec, s[54:55]
    s_branch L2_d35
L2_c36:
    s_lshl_b64 s[52:53], s[82:83], 1
    s_andn2_b64 s[52:53], s[52:53], s[80:81]
    s_andn2_b64 s[52:53], s[52:53], s[50:51]
    s_or_b64 s[80:81], s[80:81], s[52:53]
    s_not_b64 vcc, s[52:53]
    s_mov_b64 exec, -1
    v_cndmask_b32_dpp v84, v84, v84, vcc wave_shr:1 row_mask:0xf bank_mask:0xf
    v_cndmask_b32_dpp v85, v85, v85, vcc wave_shr:1 row_mask:0xf bank_mask:0xf
    s_lshr_b64 s[52:53], s[52:53], 1
    v_cndmask_b32_dpp v86, v86, v86, vcc wave_shr:1 row_mask:0xf bank_mask:0xf
    v_cndmask_b32_dpp v87, v87, v87, vcc wave_shr:1 row_mask:0xf bank_mask:0xf
    s_andn2_b64 s[82:83], s[82:83], s[52:53]
    v_cndmask_b32_dpp v7, v7, v7, vcc wave_shr:1 row_mask:0xf bank_mask:0xf
    s_mov_b64 exec, s[50:51]
    s_cbranch_scc0 L2_d36
    s_mov_b64 exec, s[82:83]
    s_nop 1
    v_mfma_f32_4x4x4_16b_bf16 v[88:91], v[12:13], v[84:85], 0
    s_nop 1
    v_mfma_f32_4x4x4_16b_bf16 v[88:91], v[10:11], v[86:87], v[88:91]
    s_nop 4
    v_cvt_pk_bf16_f32 v88, v88, v89
    v_cvt_pk_bf16_f32 v89, v90, v91
    ds_pk_add_bf16 v7, v88 offset:65408
    ds_pk_add_bf16 v7, v89 offset:65412
    s_mov_b64 exec, s[50:51]
    s_branch L2_d36
L2_c37:
    s_lshl_b64 s[52:53], s[82:83], 1
    s_andn2_b64 s[52:53], s[52:53], s[80:81]
    s_andn2_b64 s[52:53], s[52:53], s[54:55]
    s_or_b64 s[80:81], s[80:81], s[52:53]
    s_not_b64 vcc, s[52:53]
    s_mov_b64 exec, -1
    v_cndmask_b32_dpp v84, v84, v84, vcc wave_shr:1 row_mask:0xf bank_mask:0xf
    v_cndmask_b32_dpp v85, v85, v85, vcc wave_shr:1 row_mask:0xf bank_mask:0xf
    s_lshr_b64 s[52:53], s[52:53], 1
    v_cndmask_b32_dpp v86, v86, v86, vcc wave_shr:1 row_mask:0xf bank_mask:0xf
    v_cndmask_b32_dpp v87, v87, v87, vcc wave_shr:1 row_mask:0xf bank_mask:0xf
    s_andn2_b64 s[82:83], s[82:83], s[52:53]
    v_cndmask_b32_dpp v7, v7, v7, vcc wave_shr:1 row_mask:0xf bank_mask:0xf
    s_mov_b64 exec, s[54:55]
    s_cbranch_scc0 L2_d37
    s_mov_b64 exec, s[82:83]
    s_nop 1
    v_mfma_f32_4x4x4_16b_bf16 v[88:91], v[12:13], v[84:85], 0
    s_nop 1
    v_mfma_f32_4x4x4_16b_bf16 v[88:91], v[10:11], v[86:87], v[88:91]
    s_nop 4
    v_cvt_pk_bf16_f32 v88, v88, v89
    v_cvt_pk_bf16_f32 v89, v90, v91
    ds_pk_add_bf16 v7, v88 offset:65408
    ds_pk_add_bf16 v7, v89 offset:65412
    s_mov_b64 exec, s[54:55]
    s_branch L2_d37
L2_c38:
    s_lshl_b64 s[52:53], s[82:83], 1
    s_andn2_b64 s[52:53], s[52:53], s[80:81]
    s_andn2_b64 s[52:53], s[52:53], s[50:51]
    s_or_b64 s[80:81], s[80:81], s[52:53]
    s_not_b64 vcc, s[52:53]
    s_mov_b64 exec, -1
    v_cndmask_b32_dpp v84, v84, v84, vcc wave_shr:1 row_mask:0xf bank_mask:0xf
    v_cndmask_b32_dpp v85, v85, v85, vcc wave_shr:1 row_mask:0xf bank_mask:0xf
    s_lshr_b64 s[52:53], s[52:53], 1
    v_cndmask_b32_dpp v86, v86, v86, vcc wave_shr:1 row_mask:0xf bank_mask:0xf
    v_cndmask_b32_dpp v87, v87, v87, vcc wave_shr:1 row_mask:0xf bank_mask:0xf
    s_andn2_b64 s[82:83], s[82:83], s[52:53]
    v_cndmask_b32_dpp v7, v7, v7, vcc wave_shr:1 row_mask:0xf bank_mask:0xf
    s_mov_b64 exec, s[50:51]
    s_cbranch_scc0 L2_d38
    s_mov_b64 exec, s[82:83]
    s_nop 1
    v_mfma_f32_4x4x4_16b_bf16 v[88:91], v[12:13], v[84:85], 0
    s_nop 1
    v_mfma_f32_4x4x4_16b_bf16 v[88:91], v[10:11], v[86:87], v[88:91]
    s_nop 4
    v_cvt_pk_bf16_f32 v88, v88, v89
    v_cvt_pk_bf16_f32 v89, v90, v91
    ds_pk_add_bf16 v7, v88 offset:65408
    ds_pk_add_bf16 v7, v89 offset:65412
    s_mov_b64 exec, s[50:51]
    s_branch L2_d38
L2_c39:
    s_lshl_b64 s[52:53], s[82:83], 1
    s_andn2_b64 s[52:53], s[52:53], s[80:81]
    s_andn2_b64 s[52:53], s[52:53], s[54:55]
    s_or_b64 s[80:81], s[80:81], s[52:53]
    s_not_b64 vcc, s[52:53]
    s_mov_b64 exec, -1
    v_cndmask_b32_dpp v84, v84, v84, vcc wave_shr:1 row_mask:0xf bank_mask:0xf
    v_cndmask_b32_dpp v85, v85, v85, vcc wave_shr:1 row_mask:0xf bank_mask:0xf
    s_lshr_b64 s[52:53], s[52:53], 1
    v_cndmask_b32_dpp v86, v86, v86, vcc wave_shr:1 row_mask:0xf bank_mask:0xf
    v_cndmask_b32_dpp v87, v87, v87, vcc wave_shr:1 row_mask:0xf bank_mask:0xf
    s_andn2_b64 s[82:83], s[82:83], s[52:53]
    v_cndmask_b32_dpp v7, v7, v7, vcc wave_shr:1 row_mask:0xf bank_mask:0xf
    s_mov_b64 exec, s[54:55]
    s_cbranch_scc0 L2_d39
    s_mov_b64 exec, s[82:83]
    s_nop 1
    v_mfma_f32_4x4x4_16b_bf16 v[88:91], v[12:13], v[84:85], 0
    s_nop 1
    v_mfma_f32_4x4x4_16b_bf16 v[88:91], v[10:11], v[86:87], v[88:91]
    s_nop 4
    v_cvt_pk_bf16_f32 v88, v88, v89
    v_cvt_pk_bf16_f32 v89, v90, v91
    ds_pk_add_bf16 v7, v88 offset:65408
    ds_pk_add_bf16 v7, v89 offset:65412
    s_mov_b64 exec, s[54:55]
    s_branch L2_d39
L2_c40:
    s_lshl_b64 s[52:53], s[82:83], 1
    s_andn2_b64 s[52:53], s[52:53], s[80:81]
    s_andn2_b64 s[52:53], s[52:53], s[50:51]
    s_or_b64 s[80:81], s[80:81], s[52:53]
    s_not_b64 vcc, s[52:53]
    s_mov_b64 exec, -1
    v_cndmask_b32_dpp v84, v84, v84, vcc wave_shr:1 row_mask:0xf bank_mask:0xf
    v_cndmask_b32_dpp v85, v85, v85, vcc wave_shr:1 row_mask:0xf bank_mask:0xf
    s_lshr_b64 s[52:53], s[52:53], 1
    v_cndmask_b32_dpp v86, v86, v86, vcc wave_shr:1 row_mask:0xf bank_mask:0xf
    v_cndmask_b32_dpp v87, v87, v87, vcc wave_shr:1 row_mask:0xf bank_mask:0xf
    s_andn2_b64 s[82:83], s[82:83], s[52:53]
    v_cndmask_b32_dpp v7, v7, v7, vcc wave_shr:1 row_mask:0xf bank_mask:0xf
    s_mov_b64 exec, s[50:51]
    s_cbranch_scc0 L2_d40
    s_mov_b64 exec, s[82:83]
    s_nop 1
    v_mfma_f32_4x4x4_16b_bf16 v[88:91], v[12:13], v[84:85], 0
    s_nop 1
    v_mfma_f32_4x4x4_16b_bf16 v[88:91], v[10:11], v[86:87], v[88:91]
    s_nop 4
    v_cvt_pk_bf16_f32 v88, v88, v89
    v_cvt_pk_bf16_f32 v89, v90, v91
    ds_pk_add_bf16 v7, v88 offset:65408
    ds_pk_add_bf16 v7, v89 offset:65412
    s_mov_b64 exec, s[50:51]
    s_branch L2_d40
L2_c41:
    s_lshl_b64 s[52:53], s[82:83], 1
    s_andn2_b64 s[52:53], s[52:53], s[80:81]
    s_andn2_b64 s[52:53], s[52:53], s[54:55]
    s_or_b64 s[80:81], s[80:81], s[52:53]
    s_not_b64 vcc, s[52:53]
    s_mov_b64 exec, -1
    v_cndmask_b32_dpp v84, v84, v84, vcc wave_shr:1 row_mask:0xf bank_mask:0xf
    v_cndmask_b32_dpp v85, v85, v85, vcc wave_shr:1 row_mask:0xf bank_mask:0xf
    s_lshr_b64 s[52:53], s[52:53], 1
    v_cndmask_b32_dpp v86, v86, v86, vcc wave_shr:1 row_mask:0xf bank_mask:0xf
    v_cndmask_b32_dpp v87, v87, v87, vcc wave_shr:1 row_mask:0xf bank_mask:0xf
    s_andn2_b64 s[82:83], s[82:83], s[52:53]
    v_cndmask_b32_dpp v7, v7, v7, vcc wave_shr:1 row_mask:0xf bank_mask:0xf
    s_mov_b64 exec, s[54:55]
    s_cbranch_scc0 L2_d41
    s_mov_b64 exec, s[82:83]
    s_nop 1
    v_mfma_f32_4x4x4_16b_bf16 v[88:91], v[12:13], v[84:85], 0
    s_nop 1
    v_mfma_f32_4x4x4_16b_bf16 v[88:91], v[10:11], v[86:87], v[88:91]
    s_nop 4
    v_cvt_pk_bf16_f32 v88, v88, v89
    v_cvt_pk_bf16_f32 v89, v90, v91
    ds_pk_add_bf16 v7, v88 offset:65408
    ds_pk_add_bf16 v7, v89 offset:65412
    s_mov_b64 exec, s[54:55]
    s_branch L2_d41
L2_c42:
    s_lshl_b64 s[52:53], s[82:83], 1
    s_andn2_b64 s[52:53], s[52:53], s[80:81]
    s_andn2_b64 s[52:53], s[52:53], s[50:51]
    s_or_b64 s[80:81], s[80:81], s[52:53]
    s_not_b64 vcc, s[52:53]
    s_mov_b64 exec, -1
    v_cndmask_b32_dpp v84, v84, v84, vcc wave_shr:1 row_mask:0xf bank_mask:0xf
    v_cndmask_b32_dpp v85, v85, v85, vcc wave_shr:1 row_mask:0xf bank_mask:0xf
    s_lshr_b64 s[52:53], s[52:53], 1
    v_cndmask_b32_dpp v86, v86, v86, vcc wave_shr:1 row_mask:0xf bank_mask:0xf
    v_cndmask_b32_dpp v87, v87, v87, vcc wave_shr:1 row_mask:0xf bank_mask:0xf
    s_andn2_b64 s[82:83], s[82:83], s[52:53]
    v_cndmask_b32_dpp v7, v7, v7, vcc wave_shr:1 row_mask:0xf bank_mask:0xf
    s_mov_b64 exec, s[50:51]
    s_cbranch_scc0 L2_d42
    s_mov_b64 exec, s[82:83]
    s_nop 1
    v_mfma_f32_4x4x4_16b_bf16 v[88:91], v[12:13], v[84:85], 0
    s_nop 1
    v_mfma_f32_4x4x4_16b_bf16 v[88:91], v[10:11], v[86:87], v[88:91]
    s_nop 4
    v_cvt_pk_bf16_f32 v88, v88, v89
    v_cvt_pk_bf16_f32 v89, v90, v91
    ds_pk_add_bf16 v7, v88 offset:65408
    ds_pk_add_bf16 v7, v89 offset:65412
    s_mov_b64 exec, s[50:51]
    s_branch L2_d42
L2_xa43:
    s_cmp_eq_u32 s101, 1
    s_cbranch_scc1 L2_xc43
    v_lshlrev_b32 v89, 0, v96
    v_add_u32 v90, 140, v97
    v_bitop3_b32 v90, v89, v45, v90 bitop3:0x6a
    ds_write_b32 v98, v90 offset:28
    v_lshlrev_b32 v89, 4, v96
    v_add_u32 v90, 120, v97
    v_bitop3_b32 v90, v89, v45, v90 bitop3:0x6a
    ds_write_b32 v98, v90 offset:24
    v_lshlrev_b32 v89, 8, v96
    v_add_u32 v90, 100, v97
    v_bitop3_b32 v90, v89, v45, v90 bitop3:0x6a
    ds_write_b32 v98, v90 offset:20
L2_xc43:
    v_lshlrev_b32 v89, 12, v96
    v_add_u32 v90, 80, v97
    v_bitop3_b32 v90, v89, v45, v90 bitop3:0x6a
    ds_write_b32 v98, v90 offset:16
    s_branch L2_xb43
L2_xe43:
    v_cmp_lt_u32 vcc, 32, v99
    v_cmp_lt_u32 s[58:59], 31, v88
    v_lshrrev_b32 v89, 16, v96
    v_add_u32 v97, 80, v97
    s_or_b64 vcc, vcc, s[58:59]
    s_cbranch_scc1 L2_xs43
    v_lshlrev_b32 v89, v1, v89
    v_and_b32 v89, v45, v89
    v_cmp_ne_u32 vcc, 0, v89
    v_xor_b32 v90, v97, v89
    s_add_u32 s3, s37, s38
    v_mbcnt_lo_u32_b32 v98, vcc_lo, 0
    v_mbcnt_hi_u32_b32 v98, vcc_hi, v98
    s_bcnt1_i32_b64 s41, vcc
    v_lshl_add_u32 v98, v98, 2, s3
    s_mov_b64 exec, vcc
    ds_write_b32 v98, v90
    s_mov_b64 exec, -1
    s_lshl2_add_u32 s37, s41, s37
    s_branch L2_xr43
L2_xf43:
    s_waitcnt lgkmcnt(0)
    s_cmp_gt_u32 s37, 1024
    s_cbranch_scc1 L2_xs43
    v_mov_b32 v43, -1
    s_cmp_ge_u32 s37, 512
    s_cbranch_scc1 L2_xg43
    v_mov_b32 v42, -1
    s_cmp_ge_u32 s37, 256
    s_cbranch_scc1 L2_xg43
    v_mov_b32 v41, -1
    s_branch L2_xg43
L2_xs43:
    s_waitcnt lgkmcnt(0)
    v_mov_b32 v40, -1
    v_mov_b32 v41, -1
    v_mov_b32 v42, -1
    v_mov_b32 v43, -1
    s_add_u32 s3, s42, 2
    s_bitset1_b32 s36, s3
    s_branch L2_xg43
L2_c44:
    s_lshl_b64 s[52:53], s[82:83], 1
    s_andn2_b64 s[52:53], s[52:53], s[80:81]
    s_andn2_b64 s[52:53], s[52:53], s[54:55]
    s_or_b64 s[80:81], s[80:81], s[52:53]
    s_not_b64 vcc, s[52:53]
    s_mov_b64 exec, -1
    v_cndmask_b32_dpp v84, v84, v84, vcc wave_shr:1 row_mask:0xf bank_mask:0xf
    v_cndmask_b32_dpp v85, v85, v85, vcc wave_shr:1 row_mask:0xf bank_mask:0xf
    s_lshr_b64 s[52:53], s[52:53], 1
    v_cndmask_b32_dpp v86, v86, v86, vcc wave_shr:1 row_mask:0xf bank_mask:0xf
    v_cndmask_b32_dpp v87, v87, v87, vcc wave_shr:1 row_mask:0xf bank_mask:0xf
    s_andn2_b64 s[82:83], s[82:83], s[52:53]
    v_cndmask_b32_dpp v7, v7, v7, vcc wave_shr:1 row_mask:0xf bank_mask:0xf
    s_mov_b64 exec, s[54:55]
    s_cbranch_scc0 L2_d44
    s_mov_b64 exec, s[82:83]
    s_nop 1
    v_mfma_f32_4x4x4_16b_bf16 v[88:91], v[12:13], v[84:85], 0
    s_nop 1
    v_mfma_f32_4x4x4_16b_bf16 v[88:91], v[10:11], v[86:87], v[88:91]
    s_nop 4
    v_cvt_pk_bf16_f32 v88, v88, v89
    v_cvt_pk_bf16_f32 v89, v90, v91
    ds_pk_add_bf16 v7, v88 offset:65408
    ds_pk_add_bf16 v7, v89 offset:65412
    s_mov_b64 exec, s[54:55]
    s_branch L2_d44
L2_c45:
    s_lshl_b64 s[52:53], s[82:83], 1
    s_andn2_b64 s[52:53], s[52:53], s[80:81]
    s_andn2_b64 s[52:53], s[52:53], s[50:51]
    s_or_b64 s[80:81], s[80:81], s[52:53]
    s_not_b64 vcc, s[52:53]
    s_mov_b64 exec, -1
    v_cndmask_b32_dpp v84, v84, v84, vcc wave_shr:1 row_mask:0xf bank_mask:0xf
    v_cndmask_b32_dpp v85, v85, v85, vcc wave_shr:1 row_mask:0xf bank_mask:0xf
    s_lshr_b64 s[52:53], s[52:53], 1
    v_cndmask_b32_dpp v86, v86, v86, vcc wave_shr:1 row_mask:0xf bank_mask:0xf
    v_cndmask_b32_dpp v87, v87, v87, vcc wave_shr:1 row_mask:0xf bank_mask:0xf
    s_andn2_b64 s[82:83], s[82:83], s[52:53]
    v_cndmask_b32_dpp v7, v7, v7, vcc wave_shr:1 row_mask:0xf bank_mask:0xf
    s_mov_b64 exec, s[50:51]
    s_cbranch_scc0 L2_d45
    s_mov_b64 exec, s[82:83]
    s_nop 1
    v_mfma_f32_4x4x4_16b_bf16 v[88:91], v[12:13], v[84:85], 0
    s_nop 1
    v_mfma_f32_4x4x4_16b_bf16 v[88:91], v[10:11], v[86:87], v[88:91]
    s_nop 4
    v_cvt_pk_bf16_f32 v88, v88, v89
    v_cvt_pk_bf16_f32 v89, v90, v91
    ds_pk_add_bf16 v7, v88 offset:65408
    ds_pk_add_bf16 v7, v89 offset:65412
    s_mov_b64 exec, s[50:51]
    s_branch L2_d45
L2_c46:
    s_lshl_b64 s[52:53], s[82:83], 1
    s_andn2_b64 s[52:53], s[52:53], s[80:81]
    s_andn2_b64 s[52:53], s[52:53], s[54:55]
    s_or_b64 s[80:81], s[80:81], s[52:53]
    s_not_b64 vcc, s[52:53]
    s_mov_b64 exec, -1
    v_cndmask_b32_dpp v84, v84, v84, vcc wave_shr:1 row_mask:0xf bank_mask:0xf
    v_cndmask_b32_dpp v85, v85, v85, vcc wave_shr:1 row_mask:0xf bank_mask:0xf
    s_lshr_b64 s[52:53], s[52:53], 1
    v_cndmask_b32_dpp v86, v86, v86, vcc wave_shr:1 row_mask:0xf bank_mask:0xf
    v_cndmask_b32_dpp v87, v87, v87, vcc wave_shr:1 row_mask:0xf bank_mask:0xf
    s_andn2_b64 s[82:83], s[82:83], s[52:53]
    v_cndmask_b32_dpp v7, v7, v7, vcc wave_shr:1 row_mask:0xf bank_mask:0xf
    s_mov_b64 exec, s[54:55]
    s_cbranch_scc0 L2_d46
    s_mov_b64 exec, s[82:83]
    s_nop 1
    v_mfma_f32_4x4x4_16b_bf16 v[88:91], v[12:13], v[84:85], 0
    s_nop 1
    v_mfma_f32_4x4x4_16b_bf16 v[88:91], v[10:11], v[86:87], v[88:91]
    s_nop 4
    v_cvt_pk_bf16_f32 v88, v88, v89
    v_cvt_pk_bf16_f32 v89, v90, v91
    ds_pk_add_bf16 v7, v88 offset:65408
    ds_pk_add_bf16 v7, v89 offset:65412
    s_mov_b64 exec, s[54:55]
    s_branch L2_d46
L2_c47:
    s_lshl_b64 s[52:53], s[82:83], 1
    s_andn2_b64 s[52:53], s[52:53], s[80:81]
    s_andn2_b64 s[52:53], s[52:53], s[50:51]
    s_or_b64 s[80:81], s[80:81], s[52:53]
    s_not_b64 vcc, s[52:53]
    s_mov_b64 exec, -1
    v_cndmask_b32_dpp v84, v84, v84, vcc wave_shr:1 row_mask:0xf bank_mask:0xf
    v_cndmask_b32_dpp v85, v85, v85, vcc wave_shr:1 row_mask:0xf bank_mask:0xf
    s_lshr_b64 s[52:53], s[52:53], 1
    v_cndmask_b32_dpp v86, v86, v86, vcc wave_shr:1 row_mask:0xf bank_mask:0xf
    v_cndmask_b32_dpp v87, v87, v87, vcc wave_shr:1 row_mask:0xf bank_mask:0xf
    s_andn2_b64 s[82:83], s[82:83], s[52:53]
    v_cndmask_b32_dpp v7, v7, v7, vcc wave_shr:1 row_mask:0xf bank_mask:0xf
    s_mov_b64 exec, s[50:51]
    s_cbranch_scc0 L2_d47
    s_mov_b64 exec, s[82:83]
    s_nop 1
    v_mfma_f32_4x4x4_16b_bf16 v[88:91], v[12:13], v[84:85], 0
    s_nop 1
    v_mfma_f32_4x4x4_16b_bf16 v[88:91], v[10:11], v[86:87], v[88:91]
    s_nop 4
    v_cvt_pk_bf16_f32 v88, v88, v89
    v_cvt_pk_bf16_f32 v89, v90, v91
    ds_pk_add_bf16 v7, v88 offset:65408
    ds_pk_add_bf16 v7, v89 offset:65412
    s_mov_b64 exec, s[50:51]
    s_branch L2_d47
L2_c48:
    s_lshl_b64 s[52:53], s[82:83], 1
    s_andn2_b64 s[52:53], s[52:53], s[80:81]
    s_andn2_b64 s[52:53], s[52:53], s[54:55]
    s_or_b64 s[80:81], s[80:81], s[52:53]
    s_not_b64 vcc, s[52:53]
    s_mov_b64 exec, -1
    v_cndmask_b32_dpp v84, v84, v84, vcc wave_shr:1 row_mask:0xf bank_mask:0xf
    v_cndmask_b32_dpp v85, v85, v85, vcc wave_shr:1 row_mask:0xf bank_mask:0xf
    s_lshr_b64 s[52:53], s[52:53], 1
    v_cndmask_b32_dpp v86, v86, v86, vcc wave_shr:1 row_mask:0xf bank_mask:0xf
    v_cndmask_b32_dpp v87, v87, v87, vcc wave_shr:1 row_mask:0xf bank_mask:0xf
    s_andn2_b64 s[82:83], s[82:83], s[52:53]
    v_cndmask_b32_dpp v7, v7, v7, vcc wave_shr:1 row_mask:0xf bank_mask:0xf
    s_mov_b64 exec, s[54:55]
    s_cbranch_scc0 L2_d48
    s_mov_b64 exec, s[82:83]
    s_nop 1
    v_mfma_f32_4x4x4_16b_bf16 v[88:91], v[12:13], v[84:85], 0
    s_nop 1
    v_mfma_f32_4x4x4_16b_bf16 v[88:91], v[10:11], v[86:87], v[88:91]
    s_nop 4
    v_cvt_pk_bf16_f32 v88, v88, v89
    v_cvt_pk_bf16_f32 v89, v90, v91
    ds_pk_add_bf16 v7, v88 offset:65408
    ds_pk_add_bf16 v7, v89 offset:65412
    s_mov_b64 exec, s[54:55]
    s_branch L2_d48
L2_c49:
    s_lshl_b64 s[52:53], s[82:83], 1
    s_andn2_b64 s[52:53], s[52:53], s[80:81]
    s_andn2_b64 s[52:53], s[52:53], s[50:51]
    s_or_b64 s[80:81], s[80:81], s[52:53]
    s_not_b64 vcc, s[52:53]
    s_mov_b64 exec, -1
    v_cndmask_b32_dpp v84, v84, v84, vcc wave_shr:1 row_mask:0xf bank_mask:0xf
    v_cndmask_b32_dpp v85, v85, v85, vcc wave_shr:1 row_mask:0xf bank_mask:0xf
    s_lshr_b64 s[52:53], s[52:53], 1
    v_cndmask_b32_dpp v86, v86, v86, vcc wave_shr:1 row_mask:0xf bank_mask:0xf
    v_cndmask_b32_dpp v87, v87, v87, vcc wave_shr:1 row_mask:0xf bank_mask:0xf
    s_andn2_b64 s[82:83], s[82:83], s[52:53]
    v_cndmask_b32_dpp v7, v7, v7, vcc wave_shr:1 row_mask:0xf bank_mask:0xf
    s_mov_b64 exec, s[50:51]
    s_cbranch_scc0 L2_d49
    s_mov_b64 exec, s[82:83]
    s_nop 1
    v_mfma_f32_4x4x4_16b_bf16 v[88:91], v[12:13], v[84:85], 0
    s_nop 1
    v_mfma_f32_4x4x4_16b_bf16 v[88:91], v[10:11], v[86:87], v[88:91]
    s_nop 4
    v_cvt_pk_bf16_f32 v88, v88, v89
    v_cvt_pk_bf16_f32 v89, v90, v91
    ds_pk_add_bf16 v7, v88 offset:65408
    ds_pk_add_bf16 v7, v89 offset:65412
    s_mov_b64 exec, s[50:51]
    s_branch L2_d49
L2_xo50:
    v_cmp_lt_u32 vcc, 20, v99
    s_mov_b32 s101, 1
    s_cbranch_vccz L2_xp50
    v_cmp_lt_u32 vcc, 32, v99
    v_cmp_lt_u32 s[58:59], 31, v88
    s_mov_b32 s101, 2
    s_or_b64 vcc, vcc, s[58:59]
    s_cbranch_scc0 L2_xp50
    s_mov_b32 s37, 0x10000
    s_branch L2_xp50
L2_c51:
    s_lshl_b64 s[52:53], s[82:83], 1
    s_andn2_b64 s[52:53], s[52:53], s[80:81]
    s_andn2_b64 s[52:53], s[52:53], s[54:55]
    s_or_b64 s[80:81], s[80:81], s[52:53]
    s_not_b64 vcc, s[52:53]
    s_mov_b64 exec, -1
    v_cndmask_b32_dpp v84, v84, v84, vcc wave_shr:1 row_mask:0xf bank_mask:0xf
    v_cndmask_b32_dpp v85, v85, v85, vcc wave_shr:1 row_mask:0xf bank_mask:0xf
    s_lshr_b64 s[52:53], s[52:53], 1
    v_cndmask_b32_dpp v86, v86, v86, vcc wave_shr:1 row_mask:0xf bank_mask:0xf
    v_cndmask_b32_dpp v87, v87, v87, vcc wave_shr:1 row_mask:0xf bank_mask:0xf
    s_andn2_b64 s[82:83], s[82:83], s[52:53]
    v_cndmask_b32_dpp v7, v7, v7, vcc wave_shr:1 row_mask:0xf bank_mask:0xf
    s_mov_b64 exec, s[54:55]
    s_cbranch_scc0 L2_d51
    s_mov_b64 exec, s[82:83]
    s_nop 1
    v_mfma_f32_4x4x4_16b_bf16 v[88:91], v[12:13], v[84:85], 0
    s_nop 1
    v_mfma_f32_4x4x4_16b_bf16 v[88:91], v[10:11], v[86:87], v[88:91]
    s_nop 4
    v_cvt_pk_bf16_f32 v88, v88, v89
    v_cvt_pk_bf16_f32 v89, v90, v91
    ds_pk_add_bf16 v7, v88 offset:65408
    ds_pk_add_bf16 v7, v89 offset:65412
    s_mov_b64 exec, s[54:55]
    s_branch L2_d51
L2_c52:
    s_lshl_b64 s[52:53], s[82:83], 1
    s_andn2_b64 s[52:53], s[52:53], s[80:81]
    s_andn2_b64 s[52:53], s[52:53], s[50:51]
    s_or_b64 s[80:81], s[80:81], s[52:53]
    s_not_b64 vcc, s[52:53]
    s_mov_b64 exec, -1
    v_cndmask_b32_dpp v84, v84, v84, vcc wave_shr:1 row_mask:0xf bank_mask:0xf
    v_cndmask_b32_dpp v85, v85, v85, vcc wave_shr:1 row_mask:0xf bank_mask:0xf
    s_lshr_b64 s[52:53], s[52:53], 1
    v_cndmask_b32_dpp v86, v86, v86, vcc wave_shr:1 row_mask:0xf bank_mask:0xf
    v_cndmask_b32_dpp v87, v87, v87, vcc wave_shr:1 row_mask:0xf bank_mask:0xf
    s_andn2_b64 s[82:83], s[82:83], s[52:53]
    v_cndmask_b32_dpp v7, v7, v7, vcc wave_shr:1 row_mask:0xf bank_mask:0xf
    s_mov_b64 exec, s[50:51]
    s_cbranch_scc0 L2_d52
    s_mov_b64 exec, s[82:83]
    s_nop 1
    v_mfma_f32_4x4x4_16b_bf16 v[88:91], v[12:13], v[84:85], 0
    s_nop 1
    v_mfma_f32_4x4x4_16b_bf16 v[88:91], v[10:11], v[86:87], v[88:91]
    s_nop 4
    v_cvt_pk_bf16_f32 v88, v88, v89
    v_cvt_pk_bf16_f32 v89, v90, v91
    ds_pk_add_bf16 v7, v88 offset:65408
    ds_pk_add_bf16 v7, v89 offset:65412
    s_mov_b64 exec, s[50:51]
    s_branch L2_d52
L2_c53:
    s_lshl_b64 s[52:53], s[82:83], 1
    s_andn2_b64 s[52:53], s[52:53], s[80:81]
    s_andn2_b64 s[52:53], s[52:53], s[54:55]
    s_or_b64 s[80:81], s[80:81], s[52:53]
    s_not_b64 vcc, s[52:53]
    s_mov_b64 exec, -1
    v_cndmask_b32_dpp v84, v84, v84, vcc wave_shr:1 row_mask:0xf bank_mask:0xf
    v_cndmask_b32_dpp v85, v85, v85, vcc wave_shr:1 row_mask:0xf bank_mask:0xf
    s_lshr_b64 s[52:53], s[52:53], 1
    v_cndmask_b32_dpp v86, v86, v86, vcc wave_shr:1 row_mask:0xf bank_mask:0xf
    v_cndmask_b32_dpp v87, v87, v87, vcc wave_shr:1 row_mask:0xf bank_mask:0xf
    s_andn2_b64 s[82:83], s[82:83], s[52:53]
    v_cndmask_b32_dpp v7, v7, v7, vcc wave_shr:1 row_mask:0xf bank_mask:0xf
    s_mov_b64 exec, s[54:55]
    s_cbranch_scc0 L2_d53
    s_mov_b64 exec, s[82:83]
    s_nop 1
    v_mfma_f32_4x4x4_16b_bf16 v[88:91], v[12:13], v[84:85], 0
    s_nop 1
    v_mfma_f32_4x4x4_16b_bf16 v[88:91], v[10:11], v[86:87], v[88:91]
    s_nop 4
    v_cvt_pk_bf16_f32 v88, v88, v89
    v_cvt_pk_bf16_f32 v89, v90, v91
    ds_pk_add_bf16 v7, v88 offset:65408
    ds_pk_add_bf16 v7, v89 offset:65412
    s_mov_b64 exec, s[54:55]
    s_branch L2_d53
L2_c54:
    s_lshl_b64 s[52:53], s[82:83], 1
    s_andn2_b64 s[52:53], s[52:53], s[80:81]
    s_andn2_b64 s[52:53], s[52:53], s[50:51]
    s_or_b64 s[80:81], s[80:81], s[52:53]
    s_not_b64 vcc, s[52:53]
    s_mov_b64 exec, -1
    v_cndmask_b32_dpp v84, v84, v84, vcc wave_shr:1 row_mask:0xf bank_mask:0xf
    v_cndmask_b32_dpp v85, v85, v85, vcc wave_shr:1 row_mask:0xf bank_mask:0xf
    s_lshr_b64 s[52:53], s[52:53], 1
    v_cndmask_b32_dpp v86, v86, v86, vcc wave_shr:1 row_mask:0xf bank_mask:0xf
    v_cndmask_b32_dpp v87, v87, v87, vcc wave_shr:1 row_mask:0xf bank_mask:0xf
    s_andn2_b64 s[82:83], s[82:83], s[52:53]
    v_cndmask_b32_dpp v7, v7, v7, vcc wave_shr:1 row_mask:0xf bank_mask:0xf
    s_mov_b64 exec, s[50:51]
    s_cbranch_scc0 L2_d54
    s_mov_b64 exec, s[82:83]
    s_nop 1
    v_mfma_f32_4x4x4_16b_bf16 v[88:91], v[12:13], v[84:85], 0
    s_nop 1
    v_mfma_f32_4x4x4_16b_bf16 v[88:91], v[10:11], v[86:87], v[88:91]
    s_nop 4
    v_cvt_pk_bf16_f32 v88, v88, v89
    v_cvt_pk_bf16_f32 v89, v90, v91
    ds_pk_add_bf16 v7, v88 offset:65408
    ds_pk_add_bf16 v7, v89 offset:65412
    s_mov_b64 exec, s[50:51]
    s_branch L2_d54
L2_c55:
    s_lshl_b64 s[52:53], s[82:83], 1
    s_andn2_b64 s[52:53], s[52:53], s[80:81]
    s_andn2_b64 s[52:53], s[52:53], s[54:55]
    s_or_b64 s[80:81], s[80:81], s[52:53]
    s_not_b64 vcc, s[52:53]
    s_mov_b64 exec, -1
    v_cndmask_b32_dpp v84, v84, v84, vcc wave_shr:1 row_mask:0xf bank_mask:0xf
    v_cndmask_b32_dpp v85, v85, v85, vcc wave_shr:1 row_mask:0xf bank_mask:0xf
    s_lshr_b64 s[52:53], s[52:53], 1
    v_cndmask_b32_dpp v86, v86, v86, vcc wave_shr:1 row_mask:0xf bank_mask:0xf
    v_cndmask_b32_dpp v87, v87, v87, vcc wave_shr:1 row_mask:0xf bank_mask:0xf
    s_andn2_b64 s[82:83], s[82:83], s[52:53]
    v_cndmask_b32_dpp v7, v7, v7, vcc wave_shr:1 row_mask:0xf bank_mask:0xf
    s_mov_b64 exec, s[54:55]
    s_cbranch_scc0 L2_d55
    s_mov_b64 exec, s[82:83]
    s_nop 1
    v_mfma_f32_4x4x4_16b_bf16 v[88:91], v[12:13], v[84:85], 0
    s_nop 1
    v_mfma_f32_4x4x4_16b_bf16 v[88:91], v[10:11], v[86:87], v[88:91]
    s_nop 4
    v_cvt_pk_bf16_f32 v88, v88, v89
    v_cvt_pk_bf16_f32 v89, v90, v91
    ds_pk_add_bf16 v7, v88 offset:65408
    ds_pk_add_bf16 v7, v89 offset:65412
    s_mov_b64 exec, s[54:55]
    s_branch L2_d55
L2_c56:
    s_lshl_b64 s[52:53], s[82:83], 1
    s_andn2_b64 s[52:53], s[52:53], s[80:81]
    s_andn2_b64 s[52:53], s[52:53], s[50:51]
    s_or_b64 s[80:81], s[80:81], s[52:53]
    s_not_b64 vcc, s[52:53]
    s_mov_b64 exec, -1
    v_cndmask_b32_dpp v84, v84, v84, vcc wave_shr:1 row_mask:0xf bank_mask:0xf
    v_cndmask_b32_dpp v85, v85, v85, vcc wave_shr:1 row_mask:0xf bank_mask:0xf
    s_lshr_b64 s[52:53], s[52:53], 1
    v_cndmask_b32_dpp v86, v86, v86, vcc wave_shr:1 row_mask:0xf bank_mask:0xf
    v_cndmask_b32_dpp v87, v87, v87, vcc wave_shr:1 row_mask:0xf bank_mask:0xf
    s_andn2_b64 s[82:83], s[82:83], s[52:53]
    v_cndmask_b32_dpp v7, v7, v7, vcc wave_shr:1 row_mask:0xf bank_mask:0xf
    s_mov_b64 exec, s[50:51]
    s_cbranch_scc0 L2_d56
    s_mov_b64 exec, s[82:83]
    s_nop 1
    v_mfma_f32_4x4x4_16b_bf16 v[88:91], v[12:13], v[84:85], 0
    s_nop 1
    v_mfma_f32_4x4x4_16b_bf16 v[88:91], v[10:11], v[86:87], v[88:91]
    s_nop 4
    v_cvt_pk_bf16_f32 v88, v88, v89
    v_cvt_pk_bf16_f32 v89, v90, v91
    ds_pk_add_bf16 v7, v88 offset:65408
    ds_pk_add_bf16 v7, v89 offset:65412
    s_mov_b64 exec, s[50:51]
    s_branch L2_d56
L2_c57:
    s_lshl_b64 s[52:53], s[82:83], 1
    s_andn2_b64 s[52:53], s[52:53], s[80:81]
    s_andn2_b64 s[52:53], s[52:53], s[54:55]
    s_or_b64 s[80:81], s[80:81], s[52:53]
    s_not_b64 vcc, s[52:53]
    s_mov_b64 exec, -1
    v_cndmask_b32_dpp v84, v84, v84, vcc wave_shr:1 row_mask:0xf bank_mask:0xf
    v_cndmask_b32_dpp v85, v85, v85, vcc wave_shr:1 row_mask:0xf bank_mask:0xf
    s_lshr_b64 s[52:53], s[52:53], 1
    v_cndmask_b32_dpp v86, v86, v86, vcc wave_shr:1 row_mask:0xf bank_mask:0xf
    v_cndmask_b32_dpp v87, v87, v87, vcc wave_shr:1 row_mask:0xf bank_mask:0xf
    s_andn2_b64 s[82:83], s[82:83], s[52:53]
    v_cndmask_b32_dpp v7, v7, v7, vcc wave_shr:1 row_mask:0xf bank_mask:0xf
    s_mov_b64 exec, s[54:55]
    s_cbranch_scc0 L2_d57
    s_mov_b64 exec, s[82:83]
    s_nop 1
    v_mfma_f32_4x4x4_16b_bf16 v[88:91], v[12:13], v[84:85], 0
    s_nop 1
    v_mfma_f32_4x4x4_16b_bf16 v[88:91], v[10:11], v[86:87], v[88:91]
    s_nop 4
    v_cvt_pk_bf16_f32 v88, v88, v89
    v_cvt_pk_bf16_f32 v89, v90, v91
    ds_pk_add_bf16 v7, v88 offset:65408
    ds_pk_add_bf16 v7, v89 offset:65412
    s_mov_b64 exec, s[54:55]
    s_branch L2_d57
L2_c58:
    s_lshl_b64 s[52:53], s[82:83], 1
    s_andn2_b64 s[52:53], s[52:53], s[80:81]
    s_andn2_b64 s[52:53], s[52:53], s[50:51]
    s_or_b64 s[80:81], s[80:81], s[52:53]
    s_not_b64 vcc, s[52:53]
    s_mov_b64 exec, -1
    v_cndmask_b32_dpp v84, v84, v84, vcc wave_shr:1 row_mask:0xf bank_mask:0xf
    v_cndmask_b32_dpp v85, v85, v85, vcc wave_shr:1 row_mask:0xf bank_mask:0xf
    s_lshr_b64 s[52:53], s[52:53], 1
    v_cndmask_b32_dpp v86, v86, v86, vcc wave_shr:1 row_mask:0xf bank_mask:0xf
    v_cndmask_b32_dpp v87, v87, v87, vcc wave_shr:1 row_mask:0xf bank_mask:0xf
    s_andn2_b64 s[82:83], s[82:83], s[52:53]
    v_cndmask_b32_dpp v7, v7, v7, vcc wave_shr:1 row_mask:0xf bank_mask:0xf
    s_mov_b64 exec, s[50:51]
    s_cbranch_scc0 L2_d58
    s_mov_b64 exec, s[82:83]
    s_nop 1
    v_mfma_f32_4x4x4_16b_bf16 v[88:91], v[12:13], v[84:85], 0
    s_nop 1
    v_mfma_f32_4x4x4_16b_bf16 v[88:91], v[10:11], v[86:87], v[88:91]
    s_nop 4
    v_cvt_pk_bf16_f32 v88, v88, v89
    v_cvt_pk_bf16_f32 v89, v90, v91
    ds_pk_add_bf16 v7, v88 offset:65408
    ds_pk_add_bf16 v7, v89 offset:65412
    s_mov_b64 exec, s[50:51]
    s_branch L2_d58
L2_c59:
    s_lshl_b64 s[52:53], s[82:83], 1
    s_andn2_b64 s[52:53], s[52:53], s[80:81]
    s_andn2_b64 s[52:53], s[52:53], s[54:55]
    s_or_b64 s[80:81], s[80:81], s[52:53]
    s_not_b64 vcc, s[52:53]
    s_mov_b64 exec, -1
    v_cndmask_b32_dpp v84, v84, v84, vcc wave_shr:1 row_mask:0xf bank_mask:0xf
    v_cndmask_b32_dpp v85, v85, v85, vcc wave_shr:1 row_mask:0xf bank_mask:0xf
    s_lshr_b64 s[52:53], s[52:53], 1
    v_cndmask_b32_dpp v86, v86, v86, vcc wave_shr:1 row_mask:0xf bank_mask:0xf
    v_cndmask_b32_dpp v87, v87, v87, vcc wave_shr:1 row_mask:0xf bank_mask:0xf
    s_andn2_b64 s[82:83], s[82:83], s[52:53]
    v_cndmask_b32_dpp v7, v7, v7, vcc wave_shr:1 row_mask:0xf bank_mask:0xf
    s_mov_b64 exec, s[54:55]
    s_cbranch_scc0 L2_d59
    s_mov_b64 exec, s[82:83]
    s_nop 1
    v_mfma_f32_4x4x4_16b_bf16 v[88:91], v[12:13], v[84:85], 0
    s_nop 1
    v_mfma_f32_4x4x4_16b_bf16 v[88:91], v[10:11], v[86:87], v[88:91]
    s_nop 4
    v_cvt_pk_bf16_f32 v88, v88, v89
    v_cvt_pk_bf16_f32 v89, v90, v91
    ds_pk_add_bf16 v7, v88 offset:65408
    ds_pk_add_bf16 v7, v89 offset:65412
    s_mov_b64 exec, s[54:55]
    s_branch L2_d59
L2_c60:
    s_lshl_b64 s[52:53], s[82:83], 1
    s_andn2_b64 s[52:53], s[52:53], s[80:81]
    s_andn2_b64 s[52:53], s[52:53], s[50:51]
    s_or_b64 s[80:81], s[80:81], s[52:53]
    s_not_b64 vcc, s[52:53]
    s_mov_b64 exec, -1
    v_cndmask_b32_dpp v84, v84, v84, vcc wave_shr:1 row_mask:0xf bank_mask:0xf
    v_cndmask_b32_dpp v85, v85, v85, vcc wave_shr:1 row_mask:0xf bank_mask:0xf
    s_lshr_b64 s[52:53], s[52:53], 1
    v_cndmask_b32_dpp v86, v86, v86, vcc wave_shr:1 row_mask:0xf bank_mask:0xf
    v_cndmask_b32_dpp v87, v87, v87, vcc wave_shr:1 row_mask:0xf bank_mask:0xf
    s_andn2_b64 s[82:83], s[82:83], s[52:53]
    v_cndmask_b32_dpp v7, v7, v7, vcc wave_shr:1 row_mask:0xf bank_mask:0xf
    s_mov_b64 exec, s[50:51]
    s_cbranch_scc0 L2_d60
    s_mov_b64 exec, s[82:83]
    s_nop 1
    v_mfma_f32_4x4x4_16b_bf16 v[88:91], v[12:13], v[84:85], 0
    s_nop 1
    v_mfma_f32_4x4x4_16b_bf16 v[88:91], v[10:11], v[86:87], v[88:91]
    s_nop 4
    v_cvt_pk_bf16_f32 v88, v88, v89
    v_cvt_pk_bf16_f32 v89, v90, v91
    ds_pk_add_bf16 v7, v88 offset:65408
    ds_pk_add_bf16 v7, v89 offset:65412
    s_mov_b64 exec, s[50:51]
    s_branch L2_d60
L2_xa61:
    s_cmp_eq_u32 s101, 1
    s_cbranch_scc1 L2_xc61
    v_lshlrev_b32 v89, 0, v96
    v_add_u32 v90, 140, v97
    v_bitop3_b32 v90, v89, v45, v90 bitop3:0x6a
    ds_write_b32 v98, v90 offset:28
    v_lshlrev_b32 v89, 4, v96
    v_add_u32 v90, 120, v97
    v_bitop3_b32 v90, v89, v45, v90 bitop3:0x6a
    ds_write_b32 v98, v90 offset:24
    v_lshlrev_b32 v89, 8, v96
    v_add_u32 v90, 100, v97
    v_bitop3_b32 v90, v89, v45, v90 bitop3:0x6a
    ds_write_b32 v98, v90 offset:20
L2_xc61:
    v_lshlrev_b32 v89, 12, v96
    v_add_u32 v90, 80, v97
    v_bitop3_b32 v90, v89, v45, v90 bitop3:0x6a
    ds_write_b32 v98, v90 offset:16
    s_branch L2_xb61
L2_xe61:
    v_cmp_lt_u32 vcc, 32, v99
    v_cmp_lt_u32 s[58:59], 31, v88
    v_lshrrev_b32 v89, 16, v96
    v_add_u32 v97, 80, v97
    s_or_b64 vcc, vcc, s[58:59]
    s_cbranch_scc1 L2_xs61
    v_lshlrev_b32 v89, v1, v89
    v_and_b32 v89, v45, v89
    v_cmp_ne_u32 vcc, 0, v89
    v_xor_b32 v90, v97, v89
    s_add_u32 s3, s37, s38
    v_mbcnt_lo_u32_b32 v98, vcc_lo, 0
    v_mbcnt_hi_u32_b32 v98, vcc_hi, v98
    s_bcnt1_i32_b64 s41, vcc
    v_lshl_add_u32 v98, v98, 2, s3
    s_mov_b64 exec, vcc
    ds_write_b32 v98, v90
    s_mov_b64 exec, -1
    s_lshl2_add_u32 s37, s41, s37
    s_branch L2_xr61
L2_xf61:
    s_waitcnt lgkmcnt(0)
    s_cmp_gt_u32 s37, 1024
    s_cbranch_scc1 L2_xs61
    v_mov_b32 v43, -1
    s_cmp_ge_u32 s37, 512
    s_cbranch_scc1 L2_xg61
    v_mov_b32 v42, -1
    s_cmp_ge_u32 s37, 256
    s_cbranch_scc1 L2_xg61
    v_mov_b32 v41, -1
    s_branch L2_xg61
L2_xs61:
    s_waitcnt lgkmcnt(0)
    v_mov_b32 v40, -1
    v_mov_b32 v41, -1
    v_mov_b32 v42, -1
    v_mov_b32 v43, -1
    s_add_u32 s3, s42, 2
    s_bitset1_b32 s36, s3
    s_branch L2_xg61
L2_c62:
    s_lshl_b64 s[52:53], s[82:83], 1
    s_andn2_b64 s[52:53], s[52:53], s[80:81]
    s_andn2_b64 s[52:53], s[52:53], s[54:55]
    s_or_b64 s[80:81], s[80:81], s[52:53]
    s_not_b64 vcc, s[52:53]
    s_mov_b64 exec, -1
    v_cndmask_b32_dpp v84, v84, v84, vcc wave_shr:1 row_mask:0xf bank_mask:0xf
    v_cndmask_b32_dpp v85, v85, v85, vcc wave_shr:1 row_mask:0xf bank_mask:0xf
    s_lshr_b64 s[52:53], s[52:53], 1
    v_cndmask_b32_dpp v86, v86, v86, vcc wave_shr:1 row_mask:0xf bank_mask:0xf
    v_cndmask_b32_dpp v87, v87, v87, vcc wave_shr:1 row_mask:0xf bank_mask:0xf
    s_andn2_b64 s[82:83], s[82:83], s[52:53]
    v_cndmask_b32_dpp v7, v7, v7, vcc wave_shr:1 row_mask:0xf bank_mask:0xf
    s_mov_b64 exec, s[54:55]
    s_cbranch_scc0 L2_d62
    s_mov_b64 exec, s[82:83]
    s_nop 1
    v_mfma_f32_4x4x4_16b_bf16 v[88:91], v[12:13], v[84:85], 0
    s_nop 1
    v_mfma_f32_4x4x4_16b_bf16 v[88:91], v[10:11], v[86:87], v[88:91]
    s_nop 4
    v_cvt_pk_bf16_f32 v88, v88, v89
    v_cvt_pk_bf16_f32 v89, v90, v91
    ds_pk_add_bf16 v7, v88 offset:65408
    ds_pk_add_bf16 v7, v89 offset:65412
    s_mov_b64 exec, s[54:55]
    s_branch L2_d62
L2_c63:
    s_lshl_b64 s[52:53], s[82:83], 1
    s_andn2_b64 s[52:53], s[52:53], s[80:81]
    s_andn2_b64 s[52:53], s[52:53], s[50:51]
    s_or_b64 s[80:81], s[80:81], s[52:53]
    s_not_b64 vcc, s[52:53]
    s_mov_b64 exec, -1
    v_cndmask_b32_dpp v84, v84, v84, vcc wave_shr:1 row_mask:0xf bank_mask:0xf
    v_cndmask_b32_dpp v85, v85, v85, vcc wave_shr:1 row_mask:0xf bank_mask:0xf
    s_lshr_b64 s[52:53], s[52:53], 1
    v_cndmask_b32_dpp v86, v86, v86, vcc wave_shr:1 row_mask:0xf bank_mask:0xf
    v_cndmask_b32_dpp v87, v87, v87, vcc wave_shr:1 row_mask:0xf bank_mask:0xf
    s_andn2_b64 s[82:83], s[82:83], s[52:53]
    v_cndmask_b32_dpp v7, v7, v7, vcc wave_shr:1 row_mask:0xf bank_mask:0xf
    s_mov_b64 exec, s[50:51]
    s_cbranch_scc0 L2_d63
    s_mov_b64 exec, s[82:83]
    s_nop 1
    v_mfma_f32_4x4x4_16b_bf16 v[88:91], v[12:13], v[84:85], 0
    s_nop 1
    v_mfma_f32_4x4x4_16b_bf16 v[88:91], v[10:11], v[86:87], v[88:91]
    s_nop 4
    v_cvt_pk_bf16_f32 v88, v88, v89
    v_cvt_pk_bf16_f32 v89, v90, v91
    ds_pk_add_bf16 v7, v88 offset:65408
    ds_pk_add_bf16 v7, v89 offset:65412
    s_mov_b64 exec, s[50:51]
    s_branch L2_d63
L2_c64:
    s_lshl_b64 s[52:53], s[82:83], 1
    s_andn2_b64 s[52:53], s[52:53], s[80:81]
    s_andn2_b64 s[52:53], s[52:53], s[54:55]
    s_or_b64 s[80:81], s[80:81], s[52:53]
    s_not_b64 vcc, s[52:53]
    s_mov_b64 exec, -1
    v_cndmask_b32_dpp v84, v84, v84, vcc wave_shr:1 row_mask:0xf bank_mask:0xf
    v_cndmask_b32_dpp v85, v85, v85, vcc wave_shr:1 row_mask:0xf bank_mask:0xf
    s_lshr_b64 s[52:53], s[52:53], 1
    v_cndmask_b32_dpp v86, v86, v86, vcc wave_shr:1 row_mask:0xf bank_mask:0xf
    v_cndmask_b32_dpp v87, v87, v87, vcc wave_shr:1 row_mask:0xf bank_mask:0xf
    s_andn2_b64 s[82:83], s[82:83], s[52:53]
    v_cndmask_b32_dpp v7, v7, v7, vcc wave_shr:1 row_mask:0xf bank_mask:0xf
    s_mov_b64 exec, s[54:55]
    s_cbranch_scc0 L2_d64
    s_mov_b64 exec, s[82:83]
    s_nop 1
    v_mfma_f32_4x4x4_16b_bf16 v[88:91], v[12:13], v[84:85], 0
    s_nop 1
    v_mfma_f32_4x4x4_16b_bf16 v[88:91], v[10:11], v[86:87], v[88:91]
    s_nop 4
    v_cvt_pk_bf16_f32 v88, v88, v89
    v_cvt_pk_bf16_f32 v89, v90, v91
    ds_pk_add_bf16 v7, v88 offset:65408
    ds_pk_add_bf16 v7, v89 offset:65412
    s_mov_b64 exec, s[54:55]
    s_branch L2_d64
L2_c65:
    s_lshl_b64 s[52:53], s[82:83], 1
    s_andn2_b64 s[52:53], s[52:53], s[80:81]
    s_andn2_b64 s[52:53], s[52:53], s[50:51]
    s_or_b64 s[80:81], s[80:81], s[52:53]
    s_not_b64 vcc, s[52:53]
    s_mov_b64 exec, -1
    v_cndmask_b32_dpp v84, v84, v84, vcc wave_shr:1 row_mask:0xf bank_mask:0xf
    v_cndmask_b32_dpp v85, v85, v85, vcc wave_shr:1 row_mask:0xf bank_mask:0xf
    s_lshr_b64 s[52:53], s[52:53], 1
    v_cndmask_b32_dpp v86, v86, v86, vcc wave_shr:1 row_mask:0xf bank_mask:0xf
    v_cndmask_b32_dpp v87, v87, v87, vcc wave_shr:1 row_mask:0xf bank_mask:0xf
    s_andn2_b64 s[82:83], s[82:83], s[52:53]
    v_cndmask_b32_dpp v7, v7, v7, vcc wave_shr:1 row_mask:0xf bank_mask:0xf
    s_mov_b64 exec, s[50:51]
    s_cbranch_scc0 L2_d65
    s_mov_b64 exec, s[82:83]
    s_nop 1
    v_mfma_f32_4x4x4_16b_bf16 v[88:91], v[12:13], v[84:85], 0
    s_nop 1
    v_mfma_f32_4x4x4_16b_bf16 v[88:91], v[10:11], v[86:87], v[88:91]
    s_nop 4
    v_cvt_pk_bf16_f32 v88, v88, v89
    v_cvt_pk_bf16_f32 v89, v90, v91
    ds_pk_add_bf16 v7, v88 offset:65408
    ds_pk_add_bf16 v7, v89 offset:65412
    s_mov_b64 exec, s[50:51]
    s_branch L2_d65
L2_c66:
    s_lshl_b64 s[52:53], s[82:83], 1
    s_andn2_b64 s[52:53], s[52:53], s[80:81]
    s_andn2_b64 s[52:53], s[52:53], s[54:55]
    s_or_b64 s[80:81], s[80:81], s[52:53]
    s_not_b64 vcc, s[52:53]
    s_mov_b64 exec, -1
    v_cndmask_b32_dpp v84, v84, v84, vcc wave_shr:1 row_mask:0xf bank_mask:0xf
    v_cndmask_b32_dpp v85, v85, v85, vcc wave_shr:1 row_mask:0xf bank_mask:0xf
    s_lshr_b64 s[52:53], s[52:53], 1
    v_cndmask_b32_dpp v86, v86, v86, vcc wave_shr:1 row_mask:0xf bank_mask:0xf
    v_cndmask_b32_dpp v87, v87, v87, vcc wave_shr:1 row_mask:0xf bank_mask:0xf
    s_andn2_b64 s[82:83], s[82:83], s[52:53]
    v_cndmask_b32_dpp v7, v7, v7, vcc wave_shr:1 row_mask:0xf bank_mask:0xf
    s_mov_b64 exec, s[54:55]
    s_cbranch_scc0 L2_d66
    s_mov_b64 exec, s[82:83]
    s_nop 1
    v_mfma_f32_4x4x4_16b_bf16 v[88:91], v[12:13], v[84:85], 0
    s_nop 1
    v_mfma_f32_4x4x4_16b_bf16 v[88:91], v[10:11], v[86:87], v[88:91]
    s_nop 4
    v_cvt_pk_bf16_f32 v88, v88, v89
    v_cvt_pk_bf16_f32 v89, v90, v91
    ds_pk_add_bf16 v7, v88 offset:65408
    ds_pk_add_bf16 v7, v89 offset:65412
    s_mov_b64 exec, s[54:55]
    s_branch L2_d66
L2_c67:
    s_lshl_b64 s[52:53], s[82:83], 1
    s_andn2_b64 s[52:53], s[52:53], s[80:81]
    s_andn2_b64 s[52:53], s[52:53], s[50:51]
    s_or_b64 s[80:81], s[80:81], s[52:53]
    s_not_b64 vcc, s[52:53]
    s_mov_b64 exec, -1
    v_cndmask_b32_dpp v84, v84, v84, vcc wave_shr:1 row_mask:0xf bank_mask:0xf
    v_cndmask_b32_dpp v85, v85, v85, vcc wave_shr:1 row_mask:0xf bank_mask:0xf
    s_lshr_b64 s[52:53], s[52:53], 1
    v_cndmask_b32_dpp v86, v86, v86, vcc wave_shr:1 row_mask:0xf bank_mask:0xf
    v_cndmask_b32_dpp v87, v87, v87, vcc wave_shr:1 row_mask:0xf bank_mask:0xf
    s_andn2_b64 s[82:83], s[82:83], s[52:53]
    v_cndmask_b32_dpp v7, v7, v7, vcc wave_shr:1 row_mask:0xf bank_mask:0xf
    s_mov_b64 exec, s[50:51]
    s_cbranch_scc0 L2_d67
    s_mov_b64 exec, s[82:83]
    s_nop 1
    v_mfma_f32_4x4x4_16b_bf16 v[88:91], v[12:13], v[84:85], 0
    s_nop 1
    v_mfma_f32_4x4x4_16b_bf16 v[88:91], v[10:11], v[86:87], v[88:91]
    s_nop 4
    v_cvt_pk_bf16_f32 v88, v88, v89
    v_cvt_pk_bf16_f32 v89, v90, v91
    ds_pk_add_bf16 v7, v88 offset:65408
    ds_pk_add_bf16 v7, v89 offset:65412
    s_mov_b64 exec, s[50:51]
    s_branch L2_d67
L2_xo68:
    v_cmp_lt_u32 vcc, 20, v99
    s_mov_b32 s101, 1
    s_cbranch_vccz L2_xp68
    v_cmp_lt_u32 vcc, 32, v99
    v_cmp_lt_u32 s[58:59], 31, v88
    s_mov_b32 s101, 2
    s_or_b64 vcc, vcc, s[58:59]
    s_cbranch_scc0 L2_xp68
    s_mov_b32 s37, 0x10000
    s_branch L2_xp68
L2_c69:
    s_lshl_b64 s[52:53], s[82:83], 1
    s_andn2_b64 s[52:53], s[52:53], s[80:81]
    s_andn2_b64 s[52:53], s[52:53], s[54:55]
    s_or_b64 s[80:81], s[80:81], s[52:53]
    s_not_b64 vcc, s[52:53]
    s_mov_b64 exec, -1
    v_cndmask_b32_dpp v84, v84, v84, vcc wave_shr:1 row_mask:0xf bank_mask:0xf
    v_cndmask_b32_dpp v85, v85, v85, vcc wave_shr:1 row_mask:0xf bank_mask:0xf
    s_lshr_b64 s[52:53], s[52:53], 1
    v_cndmask_b32_dpp v86, v86, v86, vcc wave_shr:1 row_mask:0xf bank_mask:0xf
    v_cndmask_b32_dpp v87, v87, v87, vcc wave_shr:1 row_mask:0xf bank_mask:0xf
    s_andn2_b64 s[82:83], s[82:83], s[52:53]
    v_cndmask_b32_dpp v7, v7, v7, vcc wave_shr:1 row_mask:0xf bank_mask:0xf
    s_mov_b64 exec, s[54:55]
    s_cbranch_scc0 L2_d69
    s_mov_b64 exec, s[82:83]
    s_nop 1
    v_mfma_f32_4x4x4_16b_bf16 v[88:91], v[12:13], v[84:85], 0
    s_nop 1
    v_mfma_f32_4x4x4_16b_bf16 v[88:91], v[10:11], v[86:87], v[88:91]
    s_nop 4
    v_cvt_pk_bf16_f32 v88, v88, v89
    v_cvt_pk_bf16_f32 v89, v90, v91
    ds_pk_add_bf16 v7, v88 offset:65408
    ds_pk_add_bf16 v7, v89 offset:65412
    s_mov_b64 exec, s[54:55]
    s_branch L2_d69
L2_c70:
    s_lshl_b64 s[52:53], s[82:83], 1
    s_andn2_b64 s[52:53], s[52:53], s[80:81]
    s_andn2_b64 s[52:53], s[52:53], s[50:51]
    s_or_b64 s[80:81], s[80:81], s[52:53]
    s_not_b64 vcc, s[52:53]
    s_mov_b64 exec, -1
    v_cndmask_b32_dpp v84, v84, v84, vcc wave_shr:1 row_mask:0xf bank_mask:0xf
    v_cndmask_b32_dpp v85, v85, v85, vcc wave_shr:1 row_mask:0xf bank_mask:0xf
    s_lshr_b64 s[52:53], s[52:53], 1
    v_cndmask_b32_dpp v86, v86, v86, vcc wave_shr:1 row_mask:0xf bank_mask:0xf
    v_cndmask_b32_dpp v87, v87, v87, vcc wave_shr:1 row_mask:0xf bank_mask:0xf
    s_andn2_b64 s[82:83], s[82:83], s[52:53]
    v_cndmask_b32_dpp v7, v7, v7, vcc wave_shr:1 row_mask:0xf bank_mask:0xf
    s_mov_b64 exec, s[50:51]
    s_cbranch_scc0 L2_d70
    s_mov_b64 exec, s[82:83]
    s_nop 1
    v_mfma_f32_4x4x4_16b_bf16 v[88:91], v[12:13], v[84:85], 0
    s_nop 1
    v_mfma_f32_4x4x4_16b_bf16 v[88:91], v[10:11], v[86:87], v[88:91]
    s_nop 4
    v_cvt_pk_bf16_f32 v88, v88, v89
    v_cvt_pk_bf16_f32 v89, v90, v91
    ds_pk_add_bf16 v7, v88 offset:65408
    ds_pk_add_bf16 v7, v89 offset:65412
    s_mov_b64 exec, s[50:51]
    s_branch L2_d70
L2_c71:
    s_lshl_b64 s[52:53], s[82:83], 1
    s_andn2_b64 s[52:53], s[52:53], s[80:81]
    s_andn2_b64 s[52:53], s[52:53], s[54:55]
    s_or_b64 s[80:81], s[80:81], s[52:53]
    s_not_b64 vcc, s[52:53]
    s_mov_b64 exec, -1
    v_cndmask_b32_dpp v84, v84, v84, vcc wave_shr:1 row_mask:0xf bank_mask:0xf
    v_cndmask_b32_dpp v85, v85, v85, vcc wave_shr:1 row_mask:0xf bank_mask:0xf
    s_lshr_b64 s[52:53], s[52:53], 1
    v_cndmask_b32_dpp v86, v86, v86, vcc wave_shr:1 row_mask:0xf bank_mask:0xf
    v_cndmask_b32_dpp v87, v87, v87, vcc wave_shr:1 row_mask:0xf bank_mask:0xf
    s_andn2_b64 s[82:83], s[82:83], s[52:53]
    v_cndmask_b32_dpp v7, v7, v7, vcc wave_shr:1 row_mask:0xf bank_mask:0xf
    s_mov_b64 exec, s[54:55]
    s_cbranch_scc0 L2_d71
    s_mov_b64 exec, s[82:83]
    s_nop 1
    v_mfma_f32_4x4x4_16b_bf16 v[88:91], v[12:13], v[84:85], 0
    s_nop 1
    v_mfma_f32_4x4x4_16b_bf16 v[88:91], v[10:11], v[86:87], v[88:91]
    s_nop 4
    v_cvt_pk_bf16_f32 v88, v88, v89
    v_cvt_pk_bf16_f32 v89, v90, v91
    ds_pk_add_bf16 v7, v88 offset:65408
    ds_pk_add_bf16 v7, v89 offset:65412
    s_mov_b64 exec, s[54:55]
    s_branch L2_d71
L2_c72:
    s_lshl_b64 s[52:53], s[82:83], 1
    s_andn2_b64 s[52:53], s[52:53], s[80:81]
    s_andn2_b64 s[52:53], s[52:53], s[50:51]
    s_or_b64 s[80:81], s[80:81], s[52:53]
    s_not_b64 vcc, s[52:53]
    s_mov_b64 exec, -1
    v_cndmask_b32_dpp v84, v84, v84, vcc wave_shr:1 row_mask:0xf bank_mask:0xf
    v_cndmask_b32_dpp v85, v85, v85, vcc wave_shr:1 row_mask:0xf bank_mask:0xf
    s_lshr_b64 s[52:53], s[52:53], 1
    v_cndmask_b32_dpp v86, v86, v86, vcc wave_shr:1 row_mask:0xf bank_mask:0xf
    v_cndmask_b32_dpp v87, v87, v87, vcc wave_shr:1 row_mask:0xf bank_mask:0xf
    s_andn2_b64 s[82:83], s[82:83], s[52:53]
    v_cndmask_b32_dpp v7, v7, v7, vcc wave_shr:1 row_mask:0xf bank_mask:0xf
    s_mov_b64 exec, s[50:51]
    s_cbranch_scc0 L2_d72
    s_mov_b64 exec, s[82:83]
    s_nop 1
    v_mfma_f32_4x4x4_16b_bf16 v[88:91], v[12:13], v[84:85], 0
    s_nop 1
    v_mfma_f32_4x4x4_16b_bf16 v[88:91], v[10:11], v[86:87], v[88:91]
    s_nop 4
    v_cvt_pk_bf16_f32 v88, v88, v89
    v_cvt_pk_bf16_f32 v89, v90, v91
    ds_pk_add_bf16 v7, v88 offset:65408
    ds_pk_add_bf16 v7, v89 offset:65412
    s_mov_b64 exec, s[50:51]
    s_branch L2_d72
L2_c73:
    s_lshl_b64 s[52:53], s[82:83], 1
    s_andn2_b64 s[52:53], s[52:53], s[80:81]
    s_andn2_b64 s[52:53], s[52:53], s[54:55]
    s_or_b64 s[80:81], s[80:81], s[52:53]
    s_not_b64 vcc, s[52:53]
    s_mov_b64 exec, -1
    v_cndmask_b32_dpp v84, v84, v84, vcc wave_shr:1 row_mask:0xf bank_mask:0xf
    v_cndmask_b32_dpp v85, v85, v85, vcc wave_shr:1 row_mask:0xf bank_mask:0xf
    s_lshr_b64 s[52:53], s[52:53], 1
    v_cndmask_b32_dpp v86, v86, v86, vcc wave_shr:1 row_mask:0xf bank_mask:0xf
    v_cndmask_b32_dpp v87, v87, v87, vcc wave_shr:1 row_mask:0xf bank_mask:0xf
    s_andn2_b64 s[82:83], s[82:83], s[52:53]
    v_cndmask_b32_dpp v7, v7, v7, vcc wave_shr:1 row_mask:0xf bank_mask:0xf
    s_mov_b64 exec, s[54:55]
    s_cbranch_scc0 L2_d73
    s_mov_b64 exec, s[82:83]
    s_nop 1
    v_mfma_f32_4x4x4_16b_bf16 v[88:91], v[12:13], v[84:85], 0
    s_nop 1
    v_mfma_f32_4x4x4_16b_bf16 v[88:91], v[10:11], v[86:87], v[88:91]
    s_nop 4
    v_cvt_pk_bf16_f32 v88, v88, v89
    v_cvt_pk_bf16_f32 v89, v90, v91
    ds_pk_add_bf16 v7, v88 offset:65408
    ds_pk_add_bf16 v7, v89 offset:65412
    s_mov_b64 exec, s[54:55]
    s_branch L2_d73
L2_c74:
    s_lshl_b64 s[52:53], s[82:83], 1
    s_andn2_b64 s[52:53], s[52:53], s[80:81]
    s_andn2_b64 s[52:53], s[52:53], s[50:51]
    s_or_b64 s[80:81], s[80:81], s[52:53]
    s_not_b64 vcc, s[52:53]
    s_mov_b64 exec, -1
    v_cndmask_b32_dpp v84, v84, v84, vcc wave_shr:1 row_mask:0xf bank_mask:0xf
    v_cndmask_b32_dpp v85, v85, v85, vcc wave_shr:1 row_mask:0xf bank_mask:0xf
    s_lshr_b64 s[52:53], s[52:53], 1
    v_cndmask_b32_dpp v86, v86, v86, vcc wave_shr:1 row_mask:0xf bank_mask:0xf
    v_cndmask_b32_dpp v87, v87, v87, vcc wave_shr:1 row_mask:0xf bank_mask:0xf
    s_andn2_b64 s[82:83], s[82:83], s[52:53]
    v_cndmask_b32_dpp v7, v7, v7, vcc wave_shr:1 row_mask:0xf bank_mask:0xf
    s_mov_b64 exec, s[50:51]
    s_cbranch_scc0 L2_d74
    s_mov_b64 exec, s[82:83]
    s_nop 1
    v_mfma_f32_4x4x4_16b_bf16 v[88:91], v[12:13], v[84:85], 0
    s_nop 1
    v_mfma_f32_4x4x4_16b_bf16 v[88:91], v[10:11], v[86:87], v[88:91]
    s_nop 4
    v_cvt_pk_bf16_f32 v88, v88, v89
    v_cvt_pk_bf16_f32 v89, v90, v91
    ds_pk_add_bf16 v7, v88 offset:65408
    ds_pk_add_bf16 v7, v89 offset:65412
    s_mov_b64 exec, s[50:51]
    s_branch L2_d74
L2_c75:
    s_lshl_b64 s[52:53], s[82:83], 1
    s_andn2_b64 s[52:53], s[52:53], s[80:81]
    s_andn2_b64 s[52:53], s[52:53], s[54:55]
    s_or_b64 s[80:81], s[80:81], s[52:53]
    s_not_b64 vcc, s[52:53]
    s_mov_b64 exec, -1
    v_cndmask_b32_dpp v84, v84, v84, vcc wave_shr:1 row_mask:0xf bank_mask:0xf
    v_cndmask_b32_dpp v85, v85, v85, vcc wave_shr:1 row_mask:0xf bank_mask:0xf
    s_lshr_b64 s[52:53], s[52:53], 1
    v_cndmask_b32_dpp v86, v86, v86, vcc wave_shr:1 row_mask:0xf bank_mask:0xf
    v_cndmask_b32_dpp v87, v87, v87, vcc wave_shr:1 row_mask:0xf bank_mask:0xf
    s_andn2_b64 s[82:83], s[82:83], s[52:53]
    v_cndmask_b32_dpp v7, v7, v7, vcc wave_shr:1 row_mask:0xf bank_mask:0xf
    s_mov_b64 exec, s[54:55]
    s_cbranch_scc0 L2_d75
    s_mov_b64 exec, s[82:83]
    s_nop 1
    v_mfma_f32_4x4x4_16b_bf16 v[88:91], v[12:13], v[84:85], 0
    s_nop 1
    v_mfma_f32_4x4x4_16b_bf16 v[88:91], v[10:11], v[86:87], v[88:91]
    s_nop 4
    v_cvt_pk_bf16_f32 v88, v88, v89
    v_cvt_pk_bf16_f32 v89, v90, v91
    ds_pk_add_bf16 v7, v88 offset:65408
    ds_pk_add_bf16 v7, v89 offset:65412
    s_mov_b64 exec, s[54:55]
    s_branch L2_d75
L2_c76:
    s_lshl_b64 s[52:53], s[82:83], 1
    s_andn2_b64 s[52:53], s[52:53], s[80:81]
    s_andn2_b64 s[52:53], s[52:53], s[50:51]
    s_or_b64 s[80:81], s[80:81], s[52:53]
    s_not_b64 vcc, s[52:53]
    s_mov_b64 exec, -1
    v_cndmask_b32_dpp v84, v84, v84, vcc wave_shr:1 row_mask:0xf bank_mask:0xf
    v_cndmask_b32_dpp v85, v85, v85, vcc wave_shr:1 row_mask:0xf bank_mask:0xf
    s_lshr_b64 s[52:53], s[52:53], 1
    v_cndmask_b32_dpp v86, v86, v86, vcc wave_shr:1 row_mask:0xf bank_mask:0xf
    v_cndmask_b32_dpp v87, v87, v87, vcc wave_shr:1 row_mask:0xf bank_mask:0xf
    s_andn2_b64 s[82:83], s[82:83], s[52:53]
    v_cndmask_b32_dpp v7, v7, v7, vcc wave_shr:1 row_mask:0xf bank_mask:0xf
    s_mov_b64 exec, s[50:51]
    s_cbranch_scc0 L2_d76
    s_mov_b64 exec, s[82:83]
    s_nop 1
    v_mfma_f32_4x4x4_16b_bf16 v[88:91], v[12:13], v[84:85], 0
    s_nop 1
    v_mfma_f32_4x4x4_16b_bf16 v[88:91], v[10:11], v[86:87], v[88:91]
    s_nop 4
    v_cvt_pk_bf16_f32 v88, v88, v89
    v_cvt_pk_bf16_f32 v89, v90, v91
    ds_pk_add_bf16 v7, v88 offset:65408
    ds_pk_add_bf16 v7, v89 offset:65412
    s_mov_b64 exec, s[50:51]
    s_branch L2_d76
L2_c77:
    s_lshl_b64 s[52:53], s[82:83], 1
    s_andn2_b64 s[52:53], s[52:53], s[80:81]
    s_andn2_b64 s[52:53], s[52:53], s[54:55]
    s_or_b64 s[80:81], s[80:81], s[52:53]
    s_not_b64 vcc, s[52:53]
    s_mov_b64 exec, -1
    v_cndmask_b32_dpp v84, v84, v84, vcc wave_shr:1 row_mask:0xf bank_mask:0xf
    v_cndmask_b32_dpp v85, v85, v85, vcc wave_shr:1 row_mask:0xf bank_mask:0xf
    s_lshr_b64 s[52:53], s[52:53], 1
    v_cndmask_b32_dpp v86, v86, v86, vcc wave_shr:1 row_mask:0xf bank_mask:0xf
    v_cndmask_b32_dpp v87, v87, v87, vcc wave_shr:1 row_mask:0xf bank_mask:0xf
    s_andn2_b64 s[82:83], s[82:83], s[52:53]
    v_cndmask_b32_dpp v7, v7, v7, vcc wave_shr:1 row_mask:0xf bank_mask:0xf
    s_mov_b64 exec, s[54:55]
    s_cbranch_scc0 L2_d77
    s_mov_b64 exec, s[82:83]
    s_nop 1
    v_mfma_f32_4x4x4_16b_bf16 v[88:91], v[12:13], v[84:85], 0
    s_nop 1
    v_mfma_f32_4x4x4_16b_bf16 v[88:91], v[10:11], v[86:87], v[88:91]
    s_nop 4
    v_cvt_pk_bf16_f32 v88, v88, v89
    v_cvt_pk_bf16_f32 v89, v90, v91
    ds_pk_add_bf16 v7, v88 offset:65408
    ds_pk_add_bf16 v7, v89 offset:65412
    s_mov_b64 exec, s[54:55]
    s_branch L2_d77
L2_c78:
    s_lshl_b64 s[52:53], s[82:83], 1
    s_andn2_b64 s[52:53], s[52:53], s[80:81]
    s_andn2_b64 s[52:53], s[52:53], s[50:51]
    s_or_b64 s[80:81], s[80:81], s[52:53]
    s_not_b64 vcc, s[52:53]
    s_mov_b64 exec, -1
    v_cndmask_b32_dpp v84, v84, v84, vcc wave_shr:1 row_mask:0xf bank_mask:0xf
    v_cndmask_b32_dpp v85, v85, v85, vcc wave_shr:1 row_mask:0xf bank_mask:0xf
    s_lshr_b64 s[52:53], s[52:53], 1
    v_cndmask_b32_dpp v86, v86, v86, vcc wave_shr:1 row_mask:0xf bank_mask:0xf
    v_cndmask_b32_dpp v87, v87, v87, vcc wave_shr:1 row_mask:0xf bank_mask:0xf
    s_andn2_b64 s[82:83], s[82:83], s[52:53]
    v_cndmask_b32_dpp v7, v7, v7, vcc wave_shr:1 row_mask:0xf bank_mask:0xf
    s_mov_b64 exec, s[50:51]
    s_cbranch_scc0 L2_d78
    s_mov_b64 exec, s[82:83]
    s_nop 1
    v_mfma_f32_4x4x4_16b_bf16 v[88:91], v[12:13], v[84:85], 0
    s_nop 1
    v_mfma_f32_4x4x4_16b_bf16 v[88:91], v[10:11], v[86:87], v[88:91]
    s_nop 4
    v_cvt_pk_bf16_f32 v88, v88, v89
    v_cvt_pk_bf16_f32 v89, v90, v91
    ds_pk_add_bf16 v7, v88 offset:65408
    ds_pk_add_bf16 v7, v89 offset:65412
    s_mov_b64 exec, s[50:51]
    s_branch L2_d78
L2_xa79:
    s_cmp_eq_u32 s101, 1
    s_cbranch_scc1 L2_xc79
    v_lshlrev_b32 v89, 0, v96
    v_add_u32 v90, 140, v97
    v_bitop3_b32 v90, v89, v45, v90 bitop3:0x6a
    ds_write_b32 v98, v90 offset:28
    v_lshlrev_b32 v89, 4, v96
    v_add_u32 v90, 120, v97
    v_bitop3_b32 v90, v89, v45, v90 bitop3:0x6a
    ds_write_b32 v98, v90 offset:24
    v_lshlrev_b32 v89, 8, v96
    v_add_u32 v90, 100, v97
    v_bitop3_b32 v90, v89, v45, v90 bitop3:0x6a
    ds_write_b32 v98, v90 offset:20
L2_xc79:
    v_lshlrev_b32 v89, 12, v96
    v_add_u32 v90, 80, v97
    v_bitop3_b32 v90, v89, v45, v90 bitop3:0x6a
    ds_write_b32 v98, v90 offset:16
    s_branch L2_xb79
L2_xe79:
    v_cmp_lt_u32 vcc, 32, v99
    v_cmp_lt_u32 s[58:59], 31, v88
    v_lshrrev_b32 v89, 16, v96
    v_add_u32 v97, 80, v97
    s_or_b64 vcc, vcc, s[58:59]
    s_cbranch_scc1 L2_xs79
    v_lshlrev_b32 v89, v1, v89
    v_and_b32 v89, v45, v89
    v_cmp_ne_u32 vcc, 0, v89
    v_xor_b32 v90, v97, v89
    s_add_u32 s3, s37, s38
    v_mbcnt_lo_u32_b32 v98, vcc_lo, 0
    v_mbcnt_hi_u32_b32 v98, vcc_hi, v98
    s_bcnt1_i32_b64 s41, vcc
    v_lshl_add_u32 v98, v98, 2, s3
    s_mov_b64 exec, vcc
    ds_write_b32 v98, v90
    s_mov_b64 exec, -1
    s_lshl2_add_u32 s37, s41, s37
    s_branch L2_xr79
L2_xf79:
    s_waitcnt lgkmcnt(0)
    s_cmp_gt_u32 s37, 1024
    s_cbranch_scc1 L2_xs79
    v_mov_b32 v43, -1
    s_cmp_ge_u32 s37, 512
    s_cbranch_scc1 L2_xg79
    v_mov_b32 v42, -1
    s_cmp_ge_u32 s37, 256
    s_cbranch_scc1 L2_xg79
    v_mov_b32 v41, -1
    s_branch L2_xg79
L2_xs79:
    s_waitcnt lgkmcnt(0)
    v_mov_b32 v40, -1
    v_mov_b32 v41, -1
    v_mov_b32 v42, -1
    v_mov_b32 v43, -1
    s_add_u32 s3, s42, 2
    s_bitset1_b32 s36, s3
    s_branch L2_xg79
L2_c80:
    s_lshl_b64 s[52:53], s[82:83], 1
    s_andn2_b64 s[52:53], s[52:53], s[80:81]
    s_andn2_b64 s[52:53], s[52:53], s[54:55]
    s_or_b64 s[80:81], s[80:81], s[52:53]
    s_not_b64 vcc, s[52:53]
    s_mov_b64 exec, -1
    v_cndmask_b32_dpp v84, v84, v84, vcc wave_shr:1 row_mask:0xf bank_mask:0xf
    v_cndmask_b32_dpp v85, v85, v85, vcc wave_shr:1 row_mask:0xf bank_mask:0xf
    s_lshr_b64 s[52:53], s[52:53], 1
    v_cndmask_b32_dpp v86, v86, v86, vcc wave_shr:1 row_mask:0xf bank_mask:0xf
    v_cndmask_b32_dpp v87, v87, v87, vcc wave_shr:1 row_mask:0xf bank_mask:0xf
    s_andn2_b64 s[82:83], s[82:83], s[52:53]
    v_cndmask_b32_dpp v7, v7, v7, vcc wave_shr:1 row_mask:0xf bank_mask:0xf
    s_mov_b64 exec, s[54:55]
    s_cbranch_scc0 L2_d80
    s_mov_b64 exec, s[82:83]
    s_nop 1
    v_mfma_f32_4x4x4_16b_bf16 v[88:91], v[12:13], v[84:85], 0
    s_nop 1
    v_mfma_f32_4x4x4_16b_bf16 v[88:91], v[10:11], v[86:87], v[88:91]
    s_nop 4
    v_cvt_pk_bf16_f32 v88, v88, v89
    v_cvt_pk_bf16_f32 v89, v90, v91
    ds_pk_add_bf16 v7, v88 offset:65408
    ds_pk_add_bf16 v7, v89 offset:65412
    s_mov_b64 exec, s[54:55]
    s_branch L2_d80
L2_c81:
    s_lshl_b64 s[52:53], s[82:83], 1
    s_andn2_b64 s[52:53], s[52:53], s[80:81]
    s_andn2_b64 s[52:53], s[52:53], s[50:51]
    s_or_b64 s[80:81], s[80:81], s[52:53]
    s_not_b64 vcc, s[52:53]
    s_mov_b64 exec, -1
    v_cndmask_b32_dpp v84, v84, v84, vcc wave_shr:1 row_mask:0xf bank_mask:0xf
    v_cndmask_b32_dpp v85, v85, v85, vcc wave_shr:1 row_mask:0xf bank_mask:0xf
    s_lshr_b64 s[52:53], s[52:53], 1
    v_cndmask_b32_dpp v86, v86, v86, vcc wave_shr:1 row_mask:0xf bank_mask:0xf
    v_cndmask_b32_dpp v87, v87, v87, vcc wave_shr:1 row_mask:0xf bank_mask:0xf
    s_andn2_b64 s[82:83], s[82:83], s[52:53]
    v_cndmask_b32_dpp v7, v7, v7, vcc wave_shr:1 row_mask:0xf bank_mask:0xf
    s_mov_b64 exec, s[50:51]
    s_cbranch_scc0 L2_d81
    s_mov_b64 exec, s[82:83]
    s_nop 1
    v_mfma_f32_4x4x4_16b_bf16 v[88:91], v[12:13], v[84:85], 0
    s_nop 1
    v_mfma_f32_4x4x4_16b_bf16 v[88:91], v[10:11], v[86:87], v[88:91]
    s_nop 4
    v_cvt_pk_bf16_f32 v88, v88, v89
    v_cvt_pk_bf16_f32 v89, v90, v91
    ds_pk_add_bf16 v7, v88 offset:65408
    ds_pk_add_bf16 v7, v89 offset:65412
    s_mov_b64 exec, s[50:51]
    s_branch L2_d81
L2_c82:
    s_lshl_b64 s[52:53], s[82:83], 1
    s_andn2_b64 s[52:53], s[52:53], s[80:81]
    s_andn2_b64 s[52:53], s[52:53], s[54:55]
    s_or_b64 s[80:81], s[80:81], s[52:53]
    s_not_b64 vcc, s[52:53]
    s_mov_b64 exec, -1
    v_cndmask_b32_dpp v84, v84, v84, vcc wave_shr:1 row_mask:0xf bank_mask:0xf
    v_cndmask_b32_dpp v85, v85, v85, vcc wave_shr:1 row_mask:0xf bank_mask:0xf
    s_lshr_b64 s[52:53], s[52:53], 1
    v_cndmask_b32_dpp v86, v86, v86, vcc wave_shr:1 row_mask:0xf bank_mask:0xf
    v_cndmask_b32_dpp v87, v87, v87, vcc wave_shr:1 row_mask:0xf bank_mask:0xf
    s_andn2_b64 s[82:83], s[82:83], s[52:53]
    v_cndmask_b32_dpp v7, v7, v7, vcc wave_shr:1 row_mask:0xf bank_mask:0xf
    s_mov_b64 exec, s[54:55]
    s_cbranch_scc0 L2_d82
    s_mov_b64 exec, s[82:83]
    s_nop 1
    v_mfma_f32_4x4x4_16b_bf16 v[88:91], v[12:13], v[84:85], 0
    s_nop 1
    v_mfma_f32_4x4x4_16b_bf16 v[88:91], v[10:11], v[86:87], v[88:91]
    s_nop 4
    v_cvt_pk_bf16_f32 v88, v88, v89
    v_cvt_pk_bf16_f32 v89, v90, v91
    ds_pk_add_bf16 v7, v88 offset:65408
    ds_pk_add_bf16 v7, v89 offset:65412
    s_mov_b64 exec, s[54:55]
    s_branch L2_d82
L2_c83:
    s_lshl_b64 s[52:53], s[82:83], 1
    s_andn2_b64 s[52:53], s[52:53], s[80:81]
    s_andn2_b64 s[52:53], s[52:53], s[50:51]
    s_or_b64 s[80:81], s[80:81], s[52:53]
    s_not_b64 vcc, s[52:53]
    s_mov_b64 exec, -1
    v_cndmask_b32_dpp v84, v84, v84, vcc wave_shr:1 row_mask:0xf bank_mask:0xf
    v_cndmask_b32_dpp v85, v85, v85, vcc wave_shr:1 row_mask:0xf bank_mask:0xf
    s_lshr_b64 s[52:53], s[52:53], 1
    v_cndmask_b32_dpp v86, v86, v86, vcc wave_shr:1 row_mask:0xf bank_mask:0xf
    v_cndmask_b32_dpp v87, v87, v87, vcc wave_shr:1 row_mask:0xf bank_mask:0xf
    s_andn2_b64 s[82:83], s[82:83], s[52:53]
    v_cndmask_b32_dpp v7, v7, v7, vcc wave_shr:1 row_mask:0xf bank_mask:0xf
    s_mov_b64 exec, s[50:51]
    s_cbranch_scc0 L2_d83
    s_mov_b64 exec, s[82:83]
    s_nop 1
    v_mfma_f32_4x4x4_16b_bf16 v[88:91], v[12:13], v[84:85], 0
    s_nop 1
    v_mfma_f32_4x4x4_16b_bf16 v[88:91], v[10:11], v[86:87], v[88:91]
    s_nop 4
    v_cvt_pk_bf16_f32 v88, v88, v89
    v_cvt_pk_bf16_f32 v89, v90, v91
    ds_pk_add_bf16 v7, v88 offset:65408
    ds_pk_add_bf16 v7, v89 offset:65412
    s_mov_b64 exec, s[50:51]
    s_branch L2_d83
L2_c84:
    s_lshl_b64 s[52:53], s[82:83], 1
    s_andn2_b64 s[52:53], s[52:53], s[80:81]
    s_andn2_b64 s[52:53], s[52:53], s[54:55]
    s_or_b64 s[80:81], s[80:81], s[52:53]
    s_not_b64 vcc, s[52:53]
    s_mov_b64 exec, -1
    v_cndmask_b32_dpp v84, v84, v84, vcc wave_shr:1 row_mask:0xf bank_mask:0xf
    v_cndmask_b32_dpp v85, v85, v85, vcc wave_shr:1 row_mask:0xf bank_mask:0xf
    s_lshr_b64 s[52:53], s[52:53], 1
    v_cndmask_b32_dpp v86, v86, v86, vcc wave_shr:1 row_mask:0xf bank_mask:0xf
    v_cndmask_b32_dpp v87, v87, v87, vcc wave_shr:1 row_mask:0xf bank_mask:0xf
    s_andn2_b64 s[82:83], s[82:83], s[52:53]
    v_cndmask_b32_dpp v7, v7, v7, vcc wave_shr:1 row_mask:0xf bank_mask:0xf
    s_mov_b64 exec, s[54:55]
    s_cbranch_scc0 L2_d84
    s_mov_b64 exec, s[82:83]
    s_nop 1
    v_mfma_f32_4x4x4_16b_bf16 v[88:91], v[12:13], v[84:85], 0
    s_nop 1
    v_mfma_f32_4x4x4_16b_bf16 v[88:91], v[10:11], v[86:87], v[88:91]
    s_nop 4
    v_cvt_pk_bf16_f32 v88, v88, v89
    v_cvt_pk_bf16_f32 v89, v90, v91
    ds_pk_add_bf16 v7, v88 offset:65408
    ds_pk_add_bf16 v7, v89 offset:65412
    s_mov_b64 exec, s[54:55]
    s_branch L2_d84
L2_c85:
    s_lshl_b64 s[52:53], s[82:83], 1
    s_andn2_b64 s[52:53], s[52:53], s[80:81]
    s_andn2_b64 s[52:53], s[52:53], s[50:51]
    s_or_b64 s[80:81], s[80:81], s[52:53]
    s_not_b64 vcc, s[52:53]
    s_mov_b64 exec, -1
    v_cndmask_b32_dpp v84, v84, v84, vcc wave_shr:1 row_mask:0xf bank_mask:0xf
    v_cndmask_b32_dpp v85, v85, v85, vcc wave_shr:1 row_mask:0xf bank_mask:0xf
    s_lshr_b64 s[52:53], s[52:53], 1
    v_cndmask_b32_dpp v86, v86, v86, vcc wave_shr:1 row_mask:0xf bank_mask:0xf
    v_cndmask_b32_dpp v87, v87, v87, vcc wave_shr:1 row_mask:0xf bank_mask:0xf
    s_andn2_b64 s[82:83], s[82:83], s[52:53]
    v_cndmask_b32_dpp v7, v7, v7, vcc wave_shr:1 row_mask:0xf bank_mask:0xf
    s_mov_b64 exec, s[50:51]
    s_cbranch_scc0 L2_d85
    s_mov_b64 exec, s[82:83]
    s_nop 1
    v_mfma_f32_4x4x4_16b_bf16 v[88:91], v[12:13], v[84:85], 0
    s_nop 1
    v_mfma_f32_4x4x4_16b_bf16 v[88:91], v[10:11], v[86:87], v[88:91]
    s_nop 4
    v_cvt_pk_bf16_f32 v88, v88, v89
    v_cvt_pk_bf16_f32 v89, v90, v91
    ds_pk_add_bf16 v7, v88 offset:65408
    ds_pk_add_bf16 v7, v89 offset:65412
    s_mov_b64 exec, s[50:51]
    s_branch L2_d85
L2_xo86:
    v_cmp_lt_u32 vcc, 20, v99
    s_mov_b32 s101, 1
    s_cbranch_vccz L2_xp86
    v_cmp_lt_u32 vcc, 32, v99
    v_cmp_lt_u32 s[58:59], 31, v88
    s_mov_b32 s101, 2
    s_or_b64 vcc, vcc, s[58:59]
    s_cbranch_scc0 L2_xp86
    s_mov_b32 s37, 0x10000
    s_branch L2_xp86
L2_c87:
    s_lshl_b64 s[52:53], s[82:83], 1
    s_andn2_b64 s[52:53], s[52:53], s[80:81]
    s_andn2_b64 s[52:53], s[52:53], s[54:55]
    s_or_b64 s[80:81], s[80:81], s[52:53]
    s_not_b64 vcc, s[52:53]
    s_mov_b64 exec, -1
    v_cndmask_b32_dpp v84, v84, v84, vcc wave_shr:1 row_mask:0xf bank_mask:0xf
    v_cndmask_b32_dpp v85, v85, v85, vcc wave_shr:1 row_mask:0xf bank_mask:0xf
    s_lshr_b64 s[52:53], s[52:53], 1
    v_cndmask_b32_dpp v86, v86, v86, vcc wave_shr:1 row_mask:0xf bank_mask:0xf
    v_cndmask_b32_dpp v87, v87, v87, vcc wave_shr:1 row_mask:0xf bank_mask:0xf
    s_andn2_b64 s[82:83], s[82:83], s[52:53]
    v_cndmask_b32_dpp v7, v7, v7, vcc wave_shr:1 row_mask:0xf bank_mask:0xf
    s_mov_b64 exec, s[54:55]
    s_cbranch_scc0 L2_d87
    s_mov_b64 exec, s[82:83]
    s_nop 1
    v_mfma_f32_4x4x4_16b_bf16 v[88:91], v[12:13], v[84:85], 0
    s_nop 1
    v_mfma_f32_4x4x4_16b_bf16 v[88:91], v[10:11], v[86:87], v[88:91]
    s_nop 4
    v_cvt_pk_bf16_f32 v88, v88, v89
    v_cvt_pk_bf16_f32 v89, v90, v91
    ds_pk_add_bf16 v7, v88 offset:65408
    ds_pk_add_bf16 v7, v89 offset:65412
    s_mov_b64 exec, s[54:55]
    s_branch L2_d87
L2_c88:
    s_lshl_b64 s[52:53], s[82:83], 1
    s_andn2_b64 s[52:53], s[52:53], s[80:81]
    s_andn2_b64 s[52:53], s[52:53], s[50:51]
    s_or_b64 s[80:81], s[80:81], s[52:53]
    s_not_b64 vcc, s[52:53]
    s_mov_b64 exec, -1
    v_cndmask_b32_dpp v84, v84, v84, vcc wave_shr:1 row_mask:0xf bank_mask:0xf
    v_cndmask_b32_dpp v85, v85, v85, vcc wave_shr:1 row_mask:0xf bank_mask:0xf
    s_lshr_b64 s[52:53], s[52:53], 1
    v_cndmask_b32_dpp v86, v86, v86, vcc wave_shr:1 row_mask:0xf bank_mask:0xf
    v_cndmask_b32_dpp v87, v87, v87, vcc wave_shr:1 row_mask:0xf bank_mask:0xf
    s_andn2_b64 s[82:83], s[82:83], s[52:53]
    v_cndmask_b32_dpp v7, v7, v7, vcc wave_shr:1 row_mask:0xf bank_mask:0xf
    s_mov_b64 exec, s[50:51]
    s_cbranch_scc0 L2_d88
    s_mov_b64 exec, s[82:83]
    s_nop 1
    v_mfma_f32_4x4x4_16b_bf16 v[88:91], v[12:13], v[84:85], 0
    s_nop 1
    v_mfma_f32_4x4x4_16b_bf16 v[88:91], v[10:11], v[86:87], v[88:91]
    s_nop 4
    v_cvt_pk_bf16_f32 v88, v88, v89
    v_cvt_pk_bf16_f32 v89, v90, v91
    ds_pk_add_bf16 v7, v88 offset:65408
    ds_pk_add_bf16 v7, v89 offset:65412
    s_mov_b64 exec, s[50:51]
    s_branch L2_d88
L2_c89:
    s_lshl_b64 s[52:53], s[82:83], 1
    s_andn2_b64 s[52:53], s[52:53], s[80:81]
    s_andn2_b64 s[52:53], s[52:53], s[54:55]
    s_or_b64 s[80:81], s[80:81], s[52:53]
    s_not_b64 vcc, s[52:53]
    s_mov_b64 exec, -1
    v_cndmask_b32_dpp v84, v84, v84, vcc wave_shr:1 row_mask:0xf bank_mask:0xf
    v_cndmask_b32_dpp v85, v85, v85, vcc wave_shr:1 row_mask:0xf bank_mask:0xf
    s_lshr_b64 s[52:53], s[52:53], 1
    v_cndmask_b32_dpp v86, v86, v86, vcc wave_shr:1 row_mask:0xf bank_mask:0xf
    v_cndmask_b32_dpp v87, v87, v87, vcc wave_shr:1 row_mask:0xf bank_mask:0xf
    s_andn2_b64 s[82:83], s[82:83], s[52:53]
    v_cndmask_b32_dpp v7, v7, v7, vcc wave_shr:1 row_mask:0xf bank_mask:0xf
    s_mov_b64 exec, s[54:55]
    s_cbranch_scc0 L2_d89
    s_mov_b64 exec, s[82:83]
    s_nop 1
    v_mfma_f32_4x4x4_16b_bf16 v[88:91], v[12:13], v[84:85], 0
    s_nop 1
    v_mfma_f32_4x4x4_16b_bf16 v[88:91], v[10:11], v[86:87], v[88:91]
    s_nop 4
    v_cvt_pk_bf16_f32 v88, v88, v89
    v_cvt_pk_bf16_f32 v89, v90, v91
    ds_pk_add_bf16 v7, v88 offset:65408
    ds_pk_add_bf16 v7, v89 offset:65412
    s_mov_b64 exec, s[54:55]
    s_branch L2_d89
L2_c90:
    s_lshl_b64 s[52:53], s[82:83], 1
    s_andn2_b64 s[52:53], s[52:53], s[80:81]
    s_andn2_b64 s[52:53], s[52:53], s[50:51]
    s_or_b64 s[80:81], s[80:81], s[52:53]
    s_not_b64 vcc, s[52:53]
    s_mov_b64 exec, -1
    v_cndmask_b32_dpp v84, v84, v84, vcc wave_shr:1 row_mask:0xf bank_mask:0xf
    v_cndmask_b32_dpp v85, v85, v85, vcc wave_shr:1 row_mask:0xf bank_mask:0xf
    s_lshr_b64 s[52:53], s[52:53], 1
    v_cndmask_b32_dpp v86, v86, v86, vcc wave_shr:1 row_mask:0xf bank_mask:0xf
    v_cndmask_b32_dpp v87, v87, v87, vcc wave_shr:1 row_mask:0xf bank_mask:0xf
    s_andn2_b64 s[82:83], s[82:83], s[52:53]
    v_cndmask_b32_dpp v7, v7, v7, vcc wave_shr:1 row_mask:0xf bank_mask:0xf
    s_mov_b64 exec, s[50:51]
    s_cbranch_scc0 L2_d90
    s_mov_b64 exec, s[82:83]
    s_nop 1
    v_mfma_f32_4x4x4_16b_bf16 v[88:91], v[12:13], v[84:85], 0
    s_nop 1
    v_mfma_f32_4x4x4_16b_bf16 v[88:91], v[10:11], v[86:87], v[88:91]
    s_nop 4
    v_cvt_pk_bf16_f32 v88, v88, v89
    v_cvt_pk_bf16_f32 v89, v90, v91
    ds_pk_add_bf16 v7, v88 offset:65408
    ds_pk_add_bf16 v7, v89 offset:65412
    s_mov_b64 exec, s[50:51]
    s_branch L2_d90
L2_c91:
    s_lshl_b64 s[52:53], s[82:83], 1
    s_andn2_b64 s[52:53], s[52:53], s[80:81]
    s_andn2_b64 s[52:53], s[52:53], s[54:55]
    s_or_b64 s[80:81], s[80:81], s[52:53]
    s_not_b64 vcc, s[52:53]
    s_mov_b64 exec, -1
    v_cndmask_b32_dpp v84, v84, v84, vcc wave_shr:1 row_mask:0xf bank_mask:0xf
    v_cndmask_b32_dpp v85, v85, v85, vcc wave_shr:1 row_mask:0xf bank_mask:0xf
    s_lshr_b64 s[52:53], s[52:53], 1
    v_cndmask_b32_dpp v86, v86, v86, vcc wave_shr:1 row_mask:0xf bank_mask:0xf
    v_cndmask_b32_dpp v87, v87, v87, vcc wave_shr:1 row_mask:0xf bank_mask:0xf
    s_andn2_b64 s[82:83], s[82:83], s[52:53]
    v_cndmask_b32_dpp v7, v7, v7, vcc wave_shr:1 row_mask:0xf bank_mask:0xf
    s_mov_b64 exec, s[54:55]
    s_cbranch_scc0 L2_d91
    s_mov_b64 exec, s[82:83]
    s_nop 1
    v_mfma_f32_4x4x4_16b_bf16 v[88:91], v[12:13], v[84:85], 0
    s_nop 1
    v_mfma_f32_4x4x4_16b_bf16 v[88:91], v[10:11], v[86:87], v[88:91]
    s_nop 4
    v_cvt_pk_bf16_f32 v88, v88, v89
    v_cvt_pk_bf16_f32 v89, v90, v91
    ds_pk_add_bf16 v7, v88 offset:65408
    ds_pk_add_bf16 v7, v89 offset:65412
    s_mov_b64 exec, s[54:55]
    s_branch L2_d91
L2_c92:
    s_lshl_b64 s[52:53], s[82:83], 1
    s_andn2_b64 s[52:53], s[52:53], s[80:81]
    s_andn2_b64 s[52:53], s[52:53], s[50:51]
    s_or_b64 s[80:81], s[80:81], s[52:53]
    s_not_b64 vcc, s[52:53]
    s_mov_b64 exec, -1
    v_cndmask_b32_dpp v84, v84, v84, vcc wave_shr:1 row_mask:0xf bank_mask:0xf
    v_cndmask_b32_dpp v85, v85, v85, vcc wave_shr:1 row_mask:0xf bank_mask:0xf
    s_lshr_b64 s[52:53], s[52:53], 1
    v_cndmask_b32_dpp v86, v86, v86, vcc wave_shr:1 row_mask:0xf bank_mask:0xf
    v_cndmask_b32_dpp v87, v87, v87, vcc wave_shr:1 row_mask:0xf bank_mask:0xf
    s_andn2_b64 s[82:83], s[82:83], s[52:53]
    v_cndmask_b32_dpp v7, v7, v7, vcc wave_shr:1 row_mask:0xf bank_mask:0xf
    s_mov_b64 exec, s[50:51]
    s_cbranch_scc0 L2_d92
    s_mov_b64 exec, s[82:83]
    s_nop 1
    v_mfma_f32_4x4x4_16b_bf16 v[88:91], v[12:13], v[84:85], 0
    s_nop 1
    v_mfma_f32_4x4x4_16b_bf16 v[88:91], v[10:11], v[86:87], v[88:91]
    s_nop 4
    v_cvt_pk_bf16_f32 v88, v88, v89
    v_cvt_pk_bf16_f32 v89, v90, v91
    ds_pk_add_bf16 v7, v88 offset:65408
    ds_pk_add_bf16 v7, v89 offset:65412
    s_mov_b64 exec, s[50:51]
    s_branch L2_d92
L2_c93:
    s_lshl_b64 s[52:53], s[82:83], 1
    s_andn2_b64 s[52:53], s[52:53], s[80:81]
    s_andn2_b64 s[52:53], s[52:53], s[54:55]
    s_or_b64 s[80:81], s[80:81], s[52:53]
    s_not_b64 vcc, s[52:53]
    s_mov_b64 exec, -1
    v_cndmask_b32_dpp v84, v84, v84, vcc wave_shr:1 row_mask:0xf bank_mask:0xf
    v_cndmask_b32_dpp v85, v85, v85, vcc wave_shr:1 row_mask:0xf bank_mask:0xf
    s_lshr_b64 s[52:53], s[52:53], 1
    v_cndmask_b32_dpp v86, v86, v86, vcc wave_shr:1 row_mask:0xf bank_mask:0xf
    v_cndmask_b32_dpp v87, v87, v87, vcc wave_shr:1 row_mask:0xf bank_mask:0xf
    s_andn2_b64 s[82:83], s[82:83], s[52:53]
    v_cndmask_b32_dpp v7, v7, v7, vcc wave_shr:1 row_mask:0xf bank_mask:0xf
    s_mov_b64 exec, s[54:55]
    s_cbranch_scc0 L2_d93
    s_mov_b64 exec, s[82:83]
    s_nop 1
    v_mfma_f32_4x4x4_16b_bf16 v[88:91], v[12:13], v[84:85], 0
    s_nop 1
    v_mfma_f32_4x4x4_16b_bf16 v[88:91], v[10:11], v[86:87], v[88:91]
    s_nop 4
    v_cvt_pk_bf16_f32 v88, v88, v89
    v_cvt_pk_bf16_f32 v89, v90, v91
    ds_pk_add_bf16 v7, v88 offset:65408
    ds_pk_add_bf16 v7, v89 offset:65412
    s_mov_b64 exec, s[54:55]
    s_branch L2_d93
L2_c94:
    s_lshl_b64 s[52:53], s[82:83], 1
    s_andn2_b64 s[52:53], s[52:53], s[80:81]
    s_andn2_b64 s[52:53], s[52:53], s[50:51]
    s_or_b64 s[80:81], s[80:81], s[52:53]
    s_not_b64 vcc, s[52:53]
    s_mov_b64 exec, -1
    v_cndmask_b32_dpp v84, v84, v84, vcc wave_shr:1 row_mask:0xf bank_mask:0xf
    v_cndmask_b32_dpp v85, v85, v85, vcc wave_shr:1 row_mask:0xf bank_mask:0xf
    s_lshr_b64 s[52:53], s[52:53], 1
    v_cndmask_b32_dpp v86, v86, v86, vcc wave_shr:1 row_mask:0xf bank_mask:0xf
    v_cndmask_b32_dpp v87, v87, v87, vcc wave_shr:1 row_mask:0xf bank_mask:0xf
    s_andn2_b64 s[82:83], s[82:83], s[52:53]
    v_cndmask_b32_dpp v7, v7, v7, vcc wave_shr:1 row_mask:0xf bank_mask:0xf
    s_mov_b64 exec, s[50:51]
    s_cbranch_scc0 L2_d94
    s_mov_b64 exec, s[82:83]
    s_nop 1
    v_mfma_f32_4x4x4_16b_bf16 v[88:91], v[12:13], v[84:85], 0
    s_nop 1
    v_mfma_f32_4x4x4_16b_bf16 v[88:91], v[10:11], v[86:87], v[88:91]
    s_nop 4
    v_cvt_pk_bf16_f32 v88, v88, v89
    v_cvt_pk_bf16_f32 v89, v90, v91
    ds_pk_add_bf16 v7, v88 offset:65408
    ds_pk_add_bf16 v7, v89 offset:65412
    s_mov_b64 exec, s[50:51]
    s_branch L2_d94
L2_c95:
    s_lshl_b64 s[52:53], s[82:83], 1
    s_andn2_b64 s[52:53], s[52:53], s[80:81]
    s_andn2_b64 s[52:53], s[52:53], s[54:55]
    s_or_b64 s[80:81], s[80:81], s[52:53]
    s_not_b64 vcc, s[52:53]
    s_mov_b64 exec, -1
    v_cndmask_b32_dpp v84, v84, v84, vcc wave_shr:1 row_mask:0xf bank_mask:0xf
    v_cndmask_b32_dpp v85, v85, v85, vcc wave_shr:1 row_mask:0xf bank_mask:0xf
    s_lshr_b64 s[52:53], s[52:53], 1
    v_cndmask_b32_dpp v86, v86, v86, vcc wave_shr:1 row_mask:0xf bank_mask:0xf
    v_cndmask_b32_dpp v87, v87, v87, vcc wave_shr:1 row_mask:0xf bank_mask:0xf
    s_andn2_b64 s[82:83], s[82:83], s[52:53]
    v_cndmask_b32_dpp v7, v7, v7, vcc wave_shr:1 row_mask:0xf bank_mask:0xf
    s_mov_b64 exec, s[54:55]
    s_cbranch_scc0 L2_d95
    s_mov_b64 exec, s[82:83]
    s_nop 1
    v_mfma_f32_4x4x4_16b_bf16 v[88:91], v[12:13], v[84:85], 0
    s_nop 1
    v_mfma_f32_4x4x4_16b_bf16 v[88:91], v[10:11], v[86:87], v[88:91]
    s_nop 4
    v_cvt_pk_bf16_f32 v88, v88, v89
    v_cvt_pk_bf16_f32 v89, v90, v91
    ds_pk_add_bf16 v7, v88 offset:65408
    ds_pk_add_bf16 v7, v89 offset:65412
    s_mov_b64 exec, s[54:55]
    s_branch L2_d95
L2_c96:
    s_lshl_b64 s[52:53], s[82:83], 1
    s_andn2_b64 s[52:53], s[52:53], s[80:81]
    s_andn2_b64 s[52:53], s[52:53], s[50:51]
    s_or_b64 s[80:81], s[80:81], s[52:53]
    s_not_b64 vcc, s[52:53]
    s_mov_b64 exec, -1
    v_cndmask_b32_dpp v84, v84, v84, vcc wave_shr:1 row_mask:0xf bank_mask:0xf
    v_cndmask_b32_dpp v85, v85, v85, vcc wave_shr:1 row_mask:0xf bank_mask:0xf
    s_lshr_b64 s[52:53], s[52:53], 1
    v_cndmask_b32_dpp v86, v86, v86, vcc wave_shr:1 row_mask:0xf bank_mask:0xf
    v_cndmask_b32_dpp v87, v87, v87, vcc wave_shr:1 row_mask:0xf bank_mask:0xf
    s_andn2_b64 s[82:83], s[82:83], s[52:53]
    v_cndmask_b32_dpp v7, v7, v7, vcc wave_shr:1 row_mask:0xf bank_mask:0xf
    s_mov_b64 exec, s[50:51]
    s_cbranch_scc0 L2_d96
    s_mov_b64 exec, s[82:83]
    s_nop 1
    v_mfma_f32_4x4x4_16b_bf16 v[88:91], v[12:13], v[84:85], 0
    s_nop 1
    v_mfma_f32_4x4x4_16b_bf16 v[88:91], v[10:11], v[86:87], v[88:91]
    s_nop 4
    v_cvt_pk_bf16_f32 v88, v88, v89
    v_cvt_pk_bf16_f32 v89, v90, v91
    ds_pk_add_bf16 v7, v88 offset:65408
    ds_pk_add_bf16 v7, v89 offset:65412
    s_mov_b64 exec, s[50:51]
    s_branch L2_d96
L2_xa97:
    s_cmp_eq_u32 s101, 1
    s_cbranch_scc1 L2_xc97
    v_lshlrev_b32 v89, 0, v96
    v_add_u32 v90, 140, v97
    v_bitop3_b32 v90, v89, v45, v90 bitop3:0x6a
    ds_write_b32 v98, v90 offset:28
    v_lshlrev_b32 v89, 4, v96
    v_add_u32 v90, 120, v97
    v_bitop3_b32 v90, v89, v45, v90 bitop3:0x6a
    ds_write_b32 v98, v90 offset:24
    v_lshlrev_b32 v89, 8, v96
    v_add_u32 v90, 100, v97
    v_bitop3_b32 v90, v89, v45, v90 bitop3:0x6a
    ds_write_b32 v98, v90 offset:20
L2_xc97:
    v_lshlrev_b32 v89, 12, v96
    v_add_u32 v90, 80, v97
    v_bitop3_b32 v90, v89, v45, v90 bitop3:0x6a
    ds_write_b32 v98, v90 offset:16
    s_branch L2_xb97
L2_xe97:
    v_cmp_lt_u32 vcc, 32, v99
    v_cmp_lt_u32 s[58:59], 31, v88
    v_lshrrev_b32 v89, 16, v96
    v_add_u32 v97, 80, v97
    s_or_b64 vcc, vcc, s[58:59]
    s_cbranch_scc1 L2_xs97
    v_lshlrev_b32 v89, v1, v89
    v_and_b32 v89, v45, v89
    v_cmp_ne_u32 vcc, 0, v89
    v_xor_b32 v90, v97, v89
    s_add_u32 s3, s37, s38
    v_mbcnt_lo_u32_b32 v98, vcc_lo, 0
    v_mbcnt_hi_u32_b32 v98, vcc_hi, v98
    s_bcnt1_i32_b64 s41, vcc
    v_lshl_add_u32 v98, v98, 2, s3
    s_mov_b64 exec, vcc
    ds_write_b32 v98, v90
    s_mov_b64 exec, -1
    s_lshl2_add_u32 s37, s41, s37
    s_branch L2_xr97
L2_xf97:
    s_waitcnt lgkmcnt(0)
    s_cmp_gt_u32 s37, 1024
    s_cbranch_scc1 L2_xs97
    v_mov_b32 v43, -1
    s_cmp_ge_u32 s37, 512
    s_cbranch_scc1 L2_xg97
    v_mov_b32 v42, -1
    s_cmp_ge_u32 s37, 256
    s_cbranch_scc1 L2_xg97
    v_mov_b32 v41, -1
    s_branch L2_xg97
L2_xs97:
    s_waitcnt lgkmcnt(0)
    v_mov_b32 v40, -1
    v_mov_b32 v41, -1
    v_mov_b32 v42, -1
    v_mov_b32 v43, -1
    s_add_u32 s3, s42, 2
    s_bitset1_b32 s36, s3
    s_branch L2_xg97
L2_c98:
    s_lshl_b64 s[52:53], s[82:83], 1
    s_andn2_b64 s[52:53], s[52:53], s[80:81]
    s_andn2_b64 s[52:53], s[52:53], s[54:55]
    s_or_b64 s[80:81], s[80:81], s[52:53]
    s_not_b64 vcc, s[52:53]
    s_mov_b64 exec, -1
    v_cndmask_b32_dpp v84, v84, v84, vcc wave_shr:1 row_mask:0xf bank_mask:0xf
    v_cndmask_b32_dpp v85, v85, v85, vcc wave_shr:1 row_mask:0xf bank_mask:0xf
    s_lshr_b64 s[52:53], s[52:53], 1
    v_cndmask_b32_dpp v86, v86, v86, vcc wave_shr:1 row_mask:0xf bank_mask:0xf
    v_cndmask_b32_dpp v87, v87, v87, vcc wave_shr:1 row_mask:0xf bank_mask:0xf
    s_andn2_b64 s[82:83], s[82:83], s[52:53]
    v_cndmask_b32_dpp v7, v7, v7, vcc wave_shr:1 row_mask:0xf bank_mask:0xf
    s_mov_b64 exec, s[54:55]
    s_cbranch_scc0 L2_d98
    s_mov_b64 exec, s[82:83]
    s_nop 1
    v_mfma_f32_4x4x4_16b_bf16 v[88:91], v[12:13], v[84:85], 0
    s_nop 1
    v_mfma_f32_4x4x4_16b_bf16 v[88:91], v[10:11], v[86:87], v[88:91]
    s_nop 4
    v_cvt_pk_bf16_f32 v88, v88, v89
    v_cvt_pk_bf16_f32 v89, v90, v91
    ds_pk_add_bf16 v7, v88 offset:65408
    ds_pk_add_bf16 v7, v89 offset:65412
    s_mov_b64 exec, s[54:55]
    s_branch L2_d98
L2_c99:
    s_lshl_b64 s[52:53], s[82:83], 1
    s_andn2_b64 s[52:53], s[52:53], s[80:81]
    s_andn2_b64 s[52:53], s[52:53], s[50:51]
    s_or_b64 s[80:81], s[80:81], s[52:53]
    s_not_b64 vcc, s[52:53]
    s_mov_b64 exec, -1
    v_cndmask_b32_dpp v84, v84, v84, vcc wave_shr:1 row_mask:0xf bank_mask:0xf
    v_cndmask_b32_dpp v85, v85, v85, vcc wave_shr:1 row_mask:0xf bank_mask:0xf
    s_lshr_b64 s[52:53], s[52:53], 1
    v_cndmask_b32_dpp v86, v86, v86, vcc wave_shr:1 row_mask:0xf bank_mask:0xf
    v_cndmask_b32_dpp v87, v87, v87, vcc wave_shr:1 row_mask:0xf bank_mask:0xf
    s_andn2_b64 s[82:83], s[82:83], s[52:53]
    v_cndmask_b32_dpp v7, v7, v7, vcc wave_shr:1 row_mask:0xf bank_mask:0xf
    s_mov_b64 exec, s[50:51]
    s_cbranch_scc0 L2_d99
    s_mov_b64 exec, s[82:83]
    s_nop 1
    v_mfma_f32_4x4x4_16b_bf16 v[88:91], v[12:13], v[84:85], 0
    s_nop 1
    v_mfma_f32_4x4x4_16b_bf16 v[88:91], v[10:11], v[86:87], v[88:91]
    s_nop 4
    v_cvt_pk_bf16_f32 v88, v88, v89
    v_cvt_pk_bf16_f32 v89, v90, v91
    ds_pk_add_bf16 v7, v88 offset:65408
    ds_pk_add_bf16 v7, v89 offset:65412
    s_mov_b64 exec, s[50:51]
    s_branch L2_d99
L2_c100:
    s_lshl_b64 s[52:53], s[82:83], 1
    s_andn2_b64 s[52:53], s[52:53], s[80:81]
    s_andn2_b64 s[52:53], s[52:53], s[54:55]
    s_or_b64 s[80:81], s[80:81], s[52:53]
    s_not_b64 vcc, s[52:53]
    s_mov_b64 exec, -1
    v_cndmask_b32_dpp v84, v84, v84, vcc wave_shr:1 row_mask:0xf bank_mask:0xf
    v_cndmask_b32_dpp v85, v85, v85, vcc wave_shr:1 row_mask:0xf bank_mask:0xf
    s_lshr_b64 s[52:53], s[52:53], 1
    v_cndmask_b32_dpp v86, v86, v86, vcc wave_shr:1 row_mask:0xf bank_mask:0xf
    v_cndmask_b32_dpp v87, v87, v87, vcc wave_shr:1 row_mask:0xf bank_mask:0xf
    s_andn2_b64 s[82:83], s[82:83], s[52:53]
    v_cndmask_b32_dpp v7, v7, v7, vcc wave_shr:1 row_mask:0xf bank_mask:0xf
    s_mov_b64 exec, s[54:55]
    s_cbranch_scc0 L2_d100
    s_mov_b64 exec, s[82:83]
    s_nop 1
    v_mfma_f32_4x4x4_16b_bf16 v[88:91], v[12:13], v[84:85], 0
    s_nop 1
    v_mfma_f32_4x4x4_16b_bf16 v[88:91], v[10:11], v[86:87], v[88:91]
    s_nop 4
    v_cvt_pk_bf16_f32 v88, v88, v89
    v_cvt_pk_bf16_f32 v89, v90, v91
    ds_pk_add_bf16 v7, v88 offset:65408
    ds_pk_add_bf16 v7, v89 offset:65412
    s_mov_b64 exec, s[54:55]
    s_branch L2_d100
L2_c101:
    s_lshl_b64 s[52:53], s[82:83], 1
    s_andn2_b64 s[52:53], s[52:53], s[80:81]
    s_andn2_b64 s[52:53], s[52:53], s[50:51]
    s_or_b64 s[80:81], s[80:81], s[52:53]
    s_not_b64 vcc, s[52:53]
    s_mov_b64 exec, -1
    v_cndmask_b32_dpp v84, v84, v84, vcc wave_shr:1 row_mask:0xf bank_mask:0xf
    v_cndmask_b32_dpp v85, v85, v85, vcc wave_shr:1 row_mask:0xf bank_mask:0xf
    s_lshr_b64 s[52:53], s[52:53], 1
    v_cndmask_b32_dpp v86, v86, v86, vcc wave_shr:1 row_mask:0xf bank_mask:0xf
    v_cndmask_b32_dpp v87, v87, v87, vcc wave_shr:1 row_mask:0xf bank_mask:0xf
    s_andn2_b64 s[82:83], s[82:83], s[52:53]
    v_cndmask_b32_dpp v7, v7, v7, vcc wave_shr:1 row_mask:0xf bank_mask:0xf
    s_mov_b64 exec, s[50:51]
    s_cbranch_scc0 L2_d101
    s_mov_b64 exec, s[82:83]
    s_nop 1
    v_mfma_f32_4x4x4_16b_bf16 v[88:91], v[12:13], v[84:85], 0
    s_nop 1
    v_mfma_f32_4x4x4_16b_bf16 v[88:91], v[10:11], v[86:87], v[88:91]
    s_nop 4
    v_cvt_pk_bf16_f32 v88, v88, v89
    v_cvt_pk_bf16_f32 v89, v90, v91
    ds_pk_add_bf16 v7, v88 offset:65408
    ds_pk_add_bf16 v7, v89 offset:65412
    s_mov_b64 exec, s[50:51]
    s_branch L2_d101
L2_c102:
    s_lshl_b64 s[52:53], s[82:83], 1
    s_andn2_b64 s[52:53], s[52:53], s[80:81]
    s_andn2_b64 s[52:53], s[52:53], s[54:55]
    s_or_b64 s[80:81], s[80:81], s[52:53]
    s_not_b64 vcc, s[52:53]
    s_mov_b64 exec, -1
    v_cndmask_b32_dpp v84, v84, v84, vcc wave_shr:1 row_mask:0xf bank_mask:0xf
    v_cndmask_b32_dpp v85, v85, v85, vcc wave_shr:1 row_mask:0xf bank_mask:0xf
    s_lshr_b64 s[52:53], s[52:53], 1
    v_cndmask_b32_dpp v86, v86, v86, vcc wave_shr:1 row_mask:0xf bank_mask:0xf
    v_cndmask_b32_dpp v87, v87, v87, vcc wave_shr:1 row_mask:0xf bank_mask:0xf
    s_andn2_b64 s[82:83], s[82:83], s[52:53]
    v_cndmask_b32_dpp v7, v7, v7, vcc wave_shr:1 row_mask:0xf bank_mask:0xf
    s_mov_b64 exec, s[54:55]
    s_cbranch_scc0 L2_d102
    s_mov_b64 exec, s[82:83]
    s_nop 1
    v_mfma_f32_4x4x4_16b_bf16 v[88:91], v[12:13], v[84:85], 0
    s_nop 1
    v_mfma_f32_4x4x4_16b_bf16 v[88:91], v[10:11], v[86:87], v[88:91]
    s_nop 4
    v_cvt_pk_bf16_f32 v88, v88, v89
    v_cvt_pk_bf16_f32 v89, v90, v91
    ds_pk_add_bf16 v7, v88 offset:65408
    ds_pk_add_bf16 v7, v89 offset:65412
    s_mov_b64 exec, s[54:55]
    s_branch L2_d102
L2_c103:
    s_lshl_b64 s[52:53], s[82:83], 1
    s_andn2_b64 s[52:53], s[52:53], s[80:81]
    s_andn2_b64 s[52:53], s[52:53], s[50:51]
    s_or_b64 s[80:81], s[80:81], s[52:53]
    s_not_b64 vcc, s[52:53]
    s_mov_b64 exec, -1
    v_cndmask_b32_dpp v84, v84, v84, vcc wave_shr:1 row_mask:0xf bank_mask:0xf
    v_cndmask_b32_dpp v85, v85, v85, vcc wave_shr:1 row_mask:0xf bank_mask:0xf
    s_lshr_b64 s[52:53], s[52:53], 1
    v_cndmask_b32_dpp v86, v86, v86, vcc wave_shr:1 row_mask:0xf bank_mask:0xf
    v_cndmask_b32_dpp v87, v87, v87, vcc wave_shr:1 row_mask:0xf bank_mask:0xf
    s_andn2_b64 s[82:83], s[82:83], s[52:53]
    v_cndmask_b32_dpp v7, v7, v7, vcc wave_shr:1 row_mask:0xf bank_mask:0xf
    s_mov_b64 exec, s[50:51]
    s_cbranch_scc0 L2_d103
    s_mov_b64 exec, s[82:83]
    s_nop 1
    v_mfma_f32_4x4x4_16b_bf16 v[88:91], v[12:13], v[84:85], 0
    s_nop 1
    v_mfma_f32_4x4x4_16b_bf16 v[88:91], v[10:11], v[86:87], v[88:91]
    s_nop 4
    v_cvt_pk_bf16_f32 v88, v88, v89
    v_cvt_pk_bf16_f32 v89, v90, v91
    ds_pk_add_bf16 v7, v88 offset:65408
    ds_pk_add_bf16 v7, v89 offset:65412
    s_mov_b64 exec, s[50:51]
    s_branch L2_d103
L2_xo104:
    v_cmp_lt_u32 vcc, 20, v99
    s_mov_b32 s101, 1
    s_cbranch_vccz L2_xp104
    v_cmp_lt_u32 vcc, 32, v99
    v_cmp_lt_u32 s[58:59], 31, v88
    s_mov_b32 s101, 2
    s_or_b64 vcc, vcc, s[58:59]
    s_cbranch_scc0 L2_xp104
    s_mov_b32 s37, 0x10000
    s_branch L2_xp104
L2_c105:
    s_lshl_b64 s[52:53], s[82:83], 1
    s_andn2_b64 s[52:53], s[52:53], s[80:81]
    s_andn2_b64 s[52:53], s[52:53], s[54:55]
    s_or_b64 s[80:81], s[80:81], s[52:53]
    s_not_b64 vcc, s[52:53]
    s_mov_b64 exec, -1
    v_cndmask_b32_dpp v84, v84, v84, vcc wave_shr:1 row_mask:0xf bank_mask:0xf
    v_cndmask_b32_dpp v85, v85, v85, vcc wave_shr:1 row_mask:0xf bank_mask:0xf
    s_lshr_b64 s[52:53], s[52:53], 1
    v_cndmask_b32_dpp v86, v86, v86, vcc wave_shr:1 row_mask:0xf bank_mask:0xf
    v_cndmask_b32_dpp v87, v87, v87, vcc wave_shr:1 row_mask:0xf bank_mask:0xf
    s_andn2_b64 s[82:83], s[82:83], s[52:53]
    v_cndmask_b32_dpp v7, v7, v7, vcc wave_shr:1 row_mask:0xf bank_mask:0xf
    s_mov_b64 exec, s[54:55]
    s_cbranch_scc0 L2_d105
    s_mov_b64 exec, s[82:83]
    s_nop 1
    v_mfma_f32_4x4x4_16b_bf16 v[88:91], v[12:13], v[84:85], 0
    s_nop 1
    v_mfma_f32_4x4x4_16b_bf16 v[88:91], v[10:11], v[86:87], v[88:91]
    s_nop 4
    v_cvt_pk_bf16_f32 v88, v88, v89
    v_cvt_pk_bf16_f32 v89, v90, v91
    ds_pk_add_bf16 v7, v88 offset:65408
    ds_pk_add_bf16 v7, v89 offset:65412
    s_mov_b64 exec, s[54:55]
    s_branch L2_d105
L2_c106:
    s_lshl_b64 s[52:53], s[82:83], 1
    s_andn2_b64 s[52:53], s[52:53], s[80:81]
    s_andn2_b64 s[52:53], s[52:53], s[50:51]
    s_or_b64 s[80:81], s[80:81], s[52:53]
    s_not_b64 vcc, s[52:53]
    s_mov_b64 exec, -1
    v_cndmask_b32_dpp v84, v84, v84, vcc wave_shr:1 row_mask:0xf bank_mask:0xf
    v_cndmask_b32_dpp v85, v85, v85, vcc wave_shr:1 row_mask:0xf bank_mask:0xf
    s_lshr_b64 s[52:53], s[52:53], 1
    v_cndmask_b32_dpp v86, v86, v86, vcc wave_shr:1 row_mask:0xf bank_mask:0xf
    v_cndmask_b32_dpp v87, v87, v87, vcc wave_shr:1 row_mask:0xf bank_mask:0xf
    s_andn2_b64 s[82:83], s[82:83], s[52:53]
    v_cndmask_b32_dpp v7, v7, v7, vcc wave_shr:1 row_mask:0xf bank_mask:0xf
    s_mov_b64 exec, s[50:51]
    s_cbranch_scc0 L2_d106
    s_mov_b64 exec, s[82:83]
    s_nop 1
    v_mfma_f32_4x4x4_16b_bf16 v[88:91], v[12:13], v[84:85], 0
    s_nop 1
    v_mfma_f32_4x4x4_16b_bf16 v[88:91], v[10:11], v[86:87], v[88:91]
    s_nop 4
    v_cvt_pk_bf16_f32 v88, v88, v89
    v_cvt_pk_bf16_f32 v89, v90, v91
    ds_pk_add_bf16 v7, v88 offset:65408
    ds_pk_add_bf16 v7, v89 offset:65412
    s_mov_b64 exec, s[50:51]
    s_branch L2_d106
L2_c107:
    s_lshl_b64 s[52:53], s[82:83], 1
    s_andn2_b64 s[52:53], s[52:53], s[80:81]
    s_andn2_b64 s[52:53], s[52:53], s[54:55]
    s_or_b64 s[80:81], s[80:81], s[52:53]
    s_not_b64 vcc, s[52:53]
    s_mov_b64 exec, -1
    v_cndmask_b32_dpp v84, v84, v84, vcc wave_shr:1 row_mask:0xf bank_mask:0xf
    v_cndmask_b32_dpp v85, v85, v85, vcc wave_shr:1 row_mask:0xf bank_mask:0xf
    s_lshr_b64 s[52:53], s[52:53], 1
    v_cndmask_b32_dpp v86, v86, v86, vcc wave_shr:1 row_mask:0xf bank_mask:0xf
    v_cndmask_b32_dpp v87, v87, v87, vcc wave_shr:1 row_mask:0xf bank_mask:0xf
    s_andn2_b64 s[82:83], s[82:83], s[52:53]
    v_cndmask_b32_dpp v7, v7, v7, vcc wave_shr:1 row_mask:0xf bank_mask:0xf
    s_mov_b64 exec, s[54:55]
    s_cbranch_scc0 L2_d107
    s_mov_b64 exec, s[82:83]
    s_nop 1
    v_mfma_f32_4x4x4_16b_bf16 v[88:91], v[12:13], v[84:85], 0
    s_nop 1
    v_mfma_f32_4x4x4_16b_bf16 v[88:91], v[10:11], v[86:87], v[88:91]
    s_nop 4
    v_cvt_pk_bf16_f32 v88, v88, v89
    v_cvt_pk_bf16_f32 v89, v90, v91
    ds_pk_add_bf16 v7, v88 offset:65408
    ds_pk_add_bf16 v7, v89 offset:65412
    s_mov_b64 exec, s[54:55]
    s_branch L2_d107
L2_c108:
    s_lshl_b64 s[52:53], s[82:83], 1
    s_andn2_b64 s[52:53], s[52:53], s[80:81]
    s_andn2_b64 s[52:53], s[52:53], s[50:51]
    s_or_b64 s[80:81], s[80:81], s[52:53]
    s_not_b64 vcc, s[52:53]
    s_mov_b64 exec, -1
    v_cndmask_b32_dpp v84, v84, v84, vcc wave_shr:1 row_mask:0xf bank_mask:0xf
    v_cndmask_b32_dpp v85, v85, v85, vcc wave_shr:1 row_mask:0xf bank_mask:0xf
    s_lshr_b64 s[52:53], s[52:53], 1
    v_cndmask_b32_dpp v86, v86, v86, vcc wave_shr:1 row_mask:0xf bank_mask:0xf
    v_cndmask_b32_dpp v87, v87, v87, vcc wave_shr:1 row_mask:0xf bank_mask:0xf
    s_andn2_b64 s[82:83], s[82:83], s[52:53]
    v_cndmask_b32_dpp v7, v7, v7, vcc wave_shr:1 row_mask:0xf bank_mask:0xf
    s_mov_b64 exec, s[50:51]
    s_cbranch_scc0 L2_d108
    s_mov_b64 exec, s[82:83]
    s_nop 1
    v_mfma_f32_4x4x4_16b_bf16 v[88:91], v[12:13], v[84:85], 0
    s_nop 1
    v_mfma_f32_4x4x4_16b_bf16 v[88:91], v[10:11], v[86:87], v[88:91]
    s_nop 4
    v_cvt_pk_bf16_f32 v88, v88, v89
    v_cvt_pk_bf16_f32 v89, v90, v91
    ds_pk_add_bf16 v7, v88 offset:65408
    ds_pk_add_bf16 v7, v89 offset:65412
    s_mov_b64 exec, s[50:51]
    s_branch L2_d108
L2_c109:
    s_lshl_b64 s[52:53], s[82:83], 1
    s_andn2_b64 s[52:53], s[52:53], s[80:81]
    s_andn2_b64 s[52:53], s[52:53], s[54:55]
    s_or_b64 s[80:81], s[80:81], s[52:53]
    s_not_b64 vcc, s[52:53]
    s_mov_b64 exec, -1
    v_cndmask_b32_dpp v84, v84, v84, vcc wave_shr:1 row_mask:0xf bank_mask:0xf
    v_cndmask_b32_dpp v85, v85, v85, vcc wave_shr:1 row_mask:0xf bank_mask:0xf
    s_lshr_b64 s[52:53], s[52:53], 1
    v_cndmask_b32_dpp v86, v86, v86, vcc wave_shr:1 row_mask:0xf bank_mask:0xf
    v_cndmask_b32_dpp v87, v87, v87, vcc wave_shr:1 row_mask:0xf bank_mask:0xf
    s_andn2_b64 s[82:83], s[82:83], s[52:53]
    v_cndmask_b32_dpp v7, v7, v7, vcc wave_shr:1 row_mask:0xf bank_mask:0xf
    s_mov_b64 exec, s[54:55]
    s_cbranch_scc0 L2_d109
    s_mov_b64 exec, s[82:83]
    s_nop 1
    v_mfma_f32_4x4x4_16b_bf16 v[88:91], v[12:13], v[84:85], 0
    s_nop 1
    v_mfma_f32_4x4x4_16b_bf16 v[88:91], v[10:11], v[86:87], v[88:91]
    s_nop 4
    v_cvt_pk_bf16_f32 v88, v88, v89
    v_cvt_pk_bf16_f32 v89, v90, v91
    ds_pk_add_bf16 v7, v88 offset:65408
    ds_pk_add_bf16 v7, v89 offset:65412
    s_mov_b64 exec, s[54:55]
    s_branch L2_d109
L2_c110:
    s_lshl_b64 s[52:53], s[82:83], 1
    s_andn2_b64 s[52:53], s[52:53], s[80:81]
    s_andn2_b64 s[52:53], s[52:53], s[50:51]
    s_or_b64 s[80:81], s[80:81], s[52:53]
    s_not_b64 vcc, s[52:53]
    s_mov_b64 exec, -1
    v_cndmask_b32_dpp v84, v84, v84, vcc wave_shr:1 row_mask:0xf bank_mask:0xf
    v_cndmask_b32_dpp v85, v85, v85, vcc wave_shr:1 row_mask:0xf bank_mask:0xf
    s_lshr_b64 s[52:53], s[52:53], 1
    v_cndmask_b32_dpp v86, v86, v86, vcc wave_shr:1 row_mask:0xf bank_mask:0xf
    v_cndmask_b32_dpp v87, v87, v87, vcc wave_shr:1 row_mask:0xf bank_mask:0xf
    s_andn2_b64 s[82:83], s[82:83], s[52:53]
    v_cndmask_b32_dpp v7, v7, v7, vcc wave_shr:1 row_mask:0xf bank_mask:0xf
    s_mov_b64 exec, s[50:51]
    s_cbranch_scc0 L2_d110
    s_mov_b64 exec, s[82:83]
    s_nop 1
    v_mfma_f32_4x4x4_16b_bf16 v[88:91], v[12:13], v[84:85], 0
    s_nop 1
    v_mfma_f32_4x4x4_16b_bf16 v[88:91], v[10:11], v[86:87], v[88:91]
    s_nop 4
    v_cvt_pk_bf16_f32 v88, v88, v89
    v_cvt_pk_bf16_f32 v89, v90, v91
    ds_pk_add_bf16 v7, v88 offset:65408
    ds_pk_add_bf16 v7, v89 offset:65412
    s_mov_b64 exec, s[50:51]
    s_branch L2_d110
L2_c111:
    s_lshl_b64 s[52:53], s[82:83], 1
    s_andn2_b64 s[52:53], s[52:53], s[80:81]
    s_andn2_b64 s[52:53], s[52:53], s[54:55]
    s_or_b64 s[80:81], s[80:81], s[52:53]
    s_not_b64 vcc, s[52:53]
    s_mov_b64 exec, -1
    v_cndmask_b32_dpp v84, v84, v84, vcc wave_shr:1 row_mask:0xf bank_mask:0xf
    v_cndmask_b32_dpp v85, v85, v85, vcc wave_shr:1 row_mask:0xf bank_mask:0xf
    s_lshr_b64 s[52:53], s[52:53], 1
    v_cndmask_b32_dpp v86, v86, v86, vcc wave_shr:1 row_mask:0xf bank_mask:0xf
    v_cndmask_b32_dpp v87, v87, v87, vcc wave_shr:1 row_mask:0xf bank_mask:0xf
    s_andn2_b64 s[82:83], s[82:83], s[52:53]
    v_cndmask_b32_dpp v7, v7, v7, vcc wave_shr:1 row_mask:0xf bank_mask:0xf
    s_mov_b64 exec, s[54:55]
    s_cbranch_scc0 L2_d111
    s_mov_b64 exec, s[82:83]
    s_nop 1
    v_mfma_f32_4x4x4_16b_bf16 v[88:91], v[12:13], v[84:85], 0
    s_nop 1
    v_mfma_f32_4x4x4_16b_bf16 v[88:91], v[10:11], v[86:87], v[88:91]
    s_nop 4
    v_cvt_pk_bf16_f32 v88, v88, v89
    v_cvt_pk_bf16_f32 v89, v90, v91
    ds_pk_add_bf16 v7, v88 offset:65408
    ds_pk_add_bf16 v7, v89 offset:65412
    s_mov_b64 exec, s[54:55]
    s_branch L2_d111
L2_c112:
    s_lshl_b64 s[52:53], s[82:83], 1
    s_andn2_b64 s[52:53], s[52:53], s[80:81]
    s_andn2_b64 s[52:53], s[52:53], s[50:51]
    s_or_b64 s[80:81], s[80:81], s[52:53]
    s_not_b64 vcc, s[52:53]
    s_mov_b64 exec, -1
    v_cndmask_b32_dpp v84, v84, v84, vcc wave_shr:1 row_mask:0xf bank_mask:0xf
    v_cndmask_b32_dpp v85, v85, v85, vcc wave_shr:1 row_mask:0xf bank_mask:0xf
    s_lshr_b64 s[52:53], s[52:53], 1
    v_cndmask_b32_dpp v86, v86, v86, vcc wave_shr:1 row_mask:0xf bank_mask:0xf
    v_cndmask_b32_dpp v87, v87, v87, vcc wave_shr:1 row_mask:0xf bank_mask:0xf
    s_andn2_b64 s[82:83], s[82:83], s[52:53]
    v_cndmask_b32_dpp v7, v7, v7, vcc wave_shr:1 row_mask:0xf bank_mask:0xf
    s_mov_b64 exec, s[50:51]
    s_cbranch_scc0 L2_d112
    s_mov_b64 exec, s[82:83]
    s_nop 1
    v_mfma_f32_4x4x4_16b_bf16 v[88:91], v[12:13], v[84:85], 0
    s_nop 1
    v_mfma_f32_4x4x4_16b_bf16 v[88:91], v[10:11], v[86:87], v[88:91]
    s_nop 4
    v_cvt_pk_bf16_f32 v88, v88, v89
    v_cvt_pk_bf16_f32 v89, v90, v91
    ds_pk_add_bf16 v7, v88 offset:65408
    ds_pk_add_bf16 v7, v89 offset:65412
    s_mov_b64 exec, s[50:51]
    s_branch L2_d112
L2_c113:
    s_lshl_b64 s[52:53], s[82:83], 1
    s_andn2_b64 s[52:53], s[52:53], s[80:81]
    s_andn2_b64 s[52:53], s[52:53], s[54:55]
    s_or_b64 s[80:81], s[80:81], s[52:53]
    s_not_b64 vcc, s[52:53]
    s_mov_b64 exec, -1
    v_cndmask_b32_dpp v84, v84, v84, vcc wave_shr:1 row_mask:0xf bank_mask:0xf
    v_cndmask_b32_dpp v85, v85, v85, vcc wave_shr:1 row_mask:0xf bank_mask:0xf
    s_lshr_b64 s[52:53], s[52:53], 1
    v_cndmask_b32_dpp v86, v86, v86, vcc wave_shr:1 row_mask:0xf bank_mask:0xf
    v_cndmask_b32_dpp v87, v87, v87, vcc wave_shr:1 row_mask:0xf bank_mask:0xf
    s_andn2_b64 s[82:83], s[82:83], s[52:53]
    v_cndmask_b32_dpp v7, v7, v7, vcc wave_shr:1 row_mask:0xf bank_mask:0xf
    s_mov_b64 exec, s[54:55]
    s_cbranch_scc0 L2_d113
    s_mov_b64 exec, s[82:83]
    s_nop 1
    v_mfma_f32_4x4x4_16b_bf16 v[88:91], v[12:13], v[84:85], 0
    s_nop 1
    v_mfma_f32_4x4x4_16b_bf16 v[88:91], v[10:11], v[86:87], v[88:91]
    s_nop 4
    v_cvt_pk_bf16_f32 v88, v88, v89
    v_cvt_pk_bf16_f32 v89, v90, v91
    ds_pk_add_bf16 v7, v88 offset:65408
    ds_pk_add_bf16 v7, v89 offset:65412
    s_mov_b64 exec, s[54:55]
    s_branch L2_d113
L2_c114:
    s_lshl_b64 s[52:53], s[82:83], 1
    s_andn2_b64 s[52:53], s[52:53], s[80:81]
    s_andn2_b64 s[52:53], s[52:53], s[50:51]
    s_or_b64 s[80:81], s[80:81], s[52:53]
    s_not_b64 vcc, s[52:53]
    s_mov_b64 exec, -1
    v_cndmask_b32_dpp v84, v84, v84, vcc wave_shr:1 row_mask:0xf bank_mask:0xf
    v_cndmask_b32_dpp v85, v85, v85, vcc wave_shr:1 row_mask:0xf bank_mask:0xf
    s_lshr_b64 s[52:53], s[52:53], 1
    v_cndmask_b32_dpp v86, v86, v86, vcc wave_shr:1 row_mask:0xf bank_mask:0xf
    v_cndmask_b32_dpp v87, v87, v87, vcc wave_shr:1 row_mask:0xf bank_mask:0xf
    s_andn2_b64 s[82:83], s[82:83], s[52:53]
    v_cndmask_b32_dpp v7, v7, v7, vcc wave_shr:1 row_mask:0xf bank_mask:0xf
    s_mov_b64 exec, s[50:51]
    s_cbranch_scc0 L2_d114
    s_mov_b64 exec, s[82:83]
    s_nop 1
    v_mfma_f32_4x4x4_16b_bf16 v[88:91], v[12:13], v[84:85], 0
    s_nop 1
    v_mfma_f32_4x4x4_16b_bf16 v[88:91], v[10:11], v[86:87], v[88:91]
    s_nop 4
    v_cvt_pk_bf16_f32 v88, v88, v89
    v_cvt_pk_bf16_f32 v89, v90, v91
    ds_pk_add_bf16 v7, v88 offset:65408
    ds_pk_add_bf16 v7, v89 offset:65412
    s_mov_b64 exec, s[50:51]
    s_branch L2_d114
L2_xa115:
    s_cmp_eq_u32 s101, 1
    s_cbranch_scc1 L2_xc115
    v_lshlrev_b32 v89, 0, v96
    v_add_u32 v90, 140, v97
    v_bitop3_b32 v90, v89, v45, v90 bitop3:0x6a
    ds_write_b32 v98, v90 offset:28
    v_lshlrev_b32 v89, 4, v96
    v_add_u32 v90, 120, v97
    v_bitop3_b32 v90, v89, v45, v90 bitop3:0x6a
    ds_write_b32 v98, v90 offset:24
    v_lshlrev_b32 v89, 8, v96
    v_add_u32 v90, 100, v97
    v_bitop3_b32 v90, v89, v45, v90 bitop3:0x6a
    ds_write_b32 v98, v90 offset:20
L2_xc115:
    v_lshlrev_b32 v89, 12, v96
    v_add_u32 v90, 80, v97
    v_bitop3_b32 v90, v89, v45, v90 bitop3:0x6a
    ds_write_b32 v98, v90 offset:16
    s_branch L2_xb115
L2_xe115:
    v_cmp_lt_u32 vcc, 32, v99
    v_cmp_lt_u32 s[58:59], 31, v88
    v_lshrrev_b32 v89, 16, v96
    v_add_u32 v97, 80, v97
    s_or_b64 vcc, vcc, s[58:59]
    s_cbranch_scc1 L2_xs115
    v_lshlrev_b32 v89, v1, v89
    v_and_b32 v89, v45, v89
    v_cmp_ne_u32 vcc, 0, v89
    v_xor_b32 v90, v97, v89
    s_add_u32 s3, s37, s38
    v_mbcnt_lo_u32_b32 v98, vcc_lo, 0
    v_mbcnt_hi_u32_b32 v98, vcc_hi, v98
    s_bcnt1_i32_b64 s41, vcc
    v_lshl_add_u32 v98, v98, 2, s3
    s_mov_b64 exec, vcc
    ds_write_b32 v98, v90
    s_mov_b64 exec, -1
    s_lshl2_add_u32 s37, s41, s37
    s_branch L2_xr115
L2_xf115:
    s_waitcnt lgkmcnt(0)
    s_cmp_gt_u32 s37, 1024
    s_cbranch_scc1 L2_xs115
    v_mov_b32 v43, -1
    s_cmp_ge_u32 s37, 512
    s_cbranch_scc1 L2_xg115
    v_mov_b32 v42, -1
    s_cmp_ge_u32 s37, 256
    s_cbranch_scc1 L2_xg115
    v_mov_b32 v41, -1
    s_branch L2_xg115
L2_xs115:
    s_waitcnt lgkmcnt(0)
    v_mov_b32 v40, -1
    v_mov_b32 v41, -1
    v_mov_b32 v42, -1
    v_mov_b32 v43, -1
    s_add_u32 s3, s42, 2
    s_bitset1_b32 s36, s3
    s_branch L2_xg115
L2_c116:
    s_lshl_b64 s[52:53], s[82:83], 1
    s_andn2_b64 s[52:53], s[52:53], s[80:81]
    s_andn2_b64 s[52:53], s[52:53], s[54:55]
    s_or_b64 s[80:81], s[80:81], s[52:53]
    s_not_b64 vcc, s[52:53]
    s_mov_b64 exec, -1
    v_cndmask_b32_dpp v84, v84, v84, vcc wave_shr:1 row_mask:0xf bank_mask:0xf
    v_cndmask_b32_dpp v85, v85, v85, vcc wave_shr:1 row_mask:0xf bank_mask:0xf
    s_lshr_b64 s[52:53], s[52:53], 1
    v_cndmask_b32_dpp v86, v86, v86, vcc wave_shr:1 row_mask:0xf bank_mask:0xf
    v_cndmask_b32_dpp v87, v87, v87, vcc wave_shr:1 row_mask:0xf bank_mask:0xf
    s_andn2_b64 s[82:83], s[82:83], s[52:53]
    v_cndmask_b32_dpp v7, v7, v7, vcc wave_shr:1 row_mask:0xf bank_mask:0xf
    s_mov_b64 exec, s[54:55]
    s_cbranch_scc0 L2_d116
    s_mov_b64 exec, s[82:83]
    s_nop 1
    v_mfma_f32_4x4x4_16b_bf16 v[88:91], v[12:13], v[84:85], 0
    s_nop 1
    v_mfma_f32_4x4x4_16b_bf16 v[88:91], v[10:11], v[86:87], v[88:91]
    s_nop 4
    v_cvt_pk_bf16_f32 v88, v88, v89
    v_cvt_pk_bf16_f32 v89, v90, v91
    ds_pk_add_bf16 v7, v88 offset:65408
    ds_pk_add_bf16 v7, v89 offset:65412
    s_mov_b64 exec, s[54:55]
    s_branch L2_d116
L2_c117:
    s_lshl_b64 s[52:53], s[82:83], 1
    s_andn2_b64 s[52:53], s[52:53], s[80:81]
    s_andn2_b64 s[52:53], s[52:53], s[50:51]
    s_or_b64 s[80:81], s[80:81], s[52:53]
    s_not_b64 vcc, s[52:53]
    s_mov_b64 exec, -1
    v_cndmask_b32_dpp v84, v84, v84, vcc wave_shr:1 row_mask:0xf bank_mask:0xf
    v_cndmask_b32_dpp v85, v85, v85, vcc wave_shr:1 row_mask:0xf bank_mask:0xf
    s_lshr_b64 s[52:53], s[52:53], 1
    v_cndmask_b32_dpp v86, v86, v86, vcc wave_shr:1 row_mask:0xf bank_mask:0xf
    v_cndmask_b32_dpp v87, v87, v87, vcc wave_shr:1 row_mask:0xf bank_mask:0xf
    s_andn2_b64 s[82:83], s[82:83], s[52:53]
    v_cndmask_b32_dpp v7, v7, v7, vcc wave_shr:1 row_mask:0xf bank_mask:0xf
    s_mov_b64 exec, s[50:51]
    s_cbranch_scc0 L2_d117
    s_mov_b64 exec, s[82:83]
    s_nop 1
    v_mfma_f32_4x4x4_16b_bf16 v[88:91], v[12:13], v[84:85], 0
    s_nop 1
    v_mfma_f32_4x4x4_16b_bf16 v[88:91], v[10:11], v[86:87], v[88:91]
    s_nop 4
    v_cvt_pk_bf16_f32 v88, v88, v89
    v_cvt_pk_bf16_f32 v89, v90, v91
    ds_pk_add_bf16 v7, v88 offset:65408
    ds_pk_add_bf16 v7, v89 offset:65412
    s_mov_b64 exec, s[50:51]
    s_branch L2_d117
L2_c118:
    s_lshl_b64 s[52:53], s[82:83], 1
    s_andn2_b64 s[52:53], s[52:53], s[80:81]
    s_andn2_b64 s[52:53], s[52:53], s[54:55]
    s_or_b64 s[80:81], s[80:81], s[52:53]
    s_not_b64 vcc, s[52:53]
    s_mov_b64 exec, -1
    v_cndmask_b32_dpp v84, v84, v84, vcc wave_shr:1 row_mask:0xf bank_mask:0xf
    v_cndmask_b32_dpp v85, v85, v85, vcc wave_shr:1 row_mask:0xf bank_mask:0xf
    s_lshr_b64 s[52:53], s[52:53], 1
    v_cndmask_b32_dpp v86, v86, v86, vcc wave_shr:1 row_mask:0xf bank_mask:0xf
    v_cndmask_b32_dpp v87, v87, v87, vcc wave_shr:1 row_mask:0xf bank_mask:0xf
    s_andn2_b64 s[82:83], s[82:83], s[52:53]
    v_cndmask_b32_dpp v7, v7, v7, vcc wave_shr:1 row_mask:0xf bank_mask:0xf
    s_mov_b64 exec, s[54:55]
    s_cbranch_scc0 L2_d118
    s_mov_b64 exec, s[82:83]
    s_nop 1
    v_mfma_f32_4x4x4_16b_bf16 v[88:91], v[12:13], v[84:85], 0
    s_nop 1
    v_mfma_f32_4x4x4_16b_bf16 v[88:91], v[10:11], v[86:87], v[88:91]
    s_nop 4
    v_cvt_pk_bf16_f32 v88, v88, v89
    v_cvt_pk_bf16_f32 v89, v90, v91
    ds_pk_add_bf16 v7, v88 offset:65408
    ds_pk_add_bf16 v7, v89 offset:65412
    s_mov_b64 exec, s[54:55]
    s_branch L2_d118
L2_c119:
    s_lshl_b64 s[52:53], s[82:83], 1
    s_andn2_b64 s[52:53], s[52:53], s[80:81]
    s_andn2_b64 s[52:53], s[52:53], s[50:51]
    s_or_b64 s[80:81], s[80:81], s[52:53]
    s_not_b64 vcc, s[52:53]
    s_mov_b64 exec, -1
    v_cndmask_b32_dpp v84, v84, v84, vcc wave_shr:1 row_mask:0xf bank_mask:0xf
    v_cndmask_b32_dpp v85, v85, v85, vcc wave_shr:1 row_mask:0xf bank_mask:0xf
    s_lshr_b64 s[52:53], s[52:53], 1
    v_cndmask_b32_dpp v86, v86, v86, vcc wave_shr:1 row_mask:0xf bank_mask:0xf
    v_cndmask_b32_dpp v87, v87, v87, vcc wave_shr:1 row_mask:0xf bank_mask:0xf
    s_andn2_b64 s[82:83], s[82:83], s[52:53]
    v_cndmask_b32_dpp v7, v7, v7, vcc wave_shr:1 row_mask:0xf bank_mask:0xf
    s_mov_b64 exec, s[50:51]
    s_cbranch_scc0 L2_d119
    s_mov_b64 exec, s[82:83]
    s_nop 1
    v_mfma_f32_4x4x4_16b_bf16 v[88:91], v[12:13], v[84:85], 0
    s_nop 1
    v_mfma_f32_4x4x4_16b_bf16 v[88:91], v[10:11], v[86:87], v[88:91]
    s_nop 4
    v_cvt_pk_bf16_f32 v88, v88, v89
    v_cvt_pk_bf16_f32 v89, v90, v91
    ds_pk_add_bf16 v7, v88 offset:65408
    ds_pk_add_bf16 v7, v89 offset:65412
    s_mov_b64 exec, s[50:51]
    s_branch L2_d119
L2_c120:
    s_lshl_b64 s[52:53], s[82:83], 1
    s_andn2_b64 s[52:53], s[52:53], s[80:81]
    s_andn2_b64 s[52:53], s[52:53], s[54:55]
    s_or_b64 s[80:81], s[80:81], s[52:53]
    s_not_b64 vcc, s[52:53]
    s_mov_b64 exec, -1
    v_cndmask_b32_dpp v84, v84, v84, vcc wave_shr:1 row_mask:0xf bank_mask:0xf
    v_cndmask_b32_dpp v85, v85, v85, vcc wave_shr:1 row_mask:0xf bank_mask:0xf
    s_lshr_b64 s[52:53], s[52:53], 1
    v_cndmask_b32_dpp v86, v86, v86, vcc wave_shr:1 row_mask:0xf bank_mask:0xf
    v_cndmask_b32_dpp v87, v87, v87, vcc wave_shr:1 row_mask:0xf bank_mask:0xf
    s_andn2_b64 s[82:83], s[82:83], s[52:53]
    v_cndmask_b32_dpp v7, v7, v7, vcc wave_shr:1 row_mask:0xf bank_mask:0xf
    s_mov_b64 exec, s[54:55]
    s_cbranch_scc0 L2_d120
    s_mov_b64 exec, s[82:83]
    s_nop 1
    v_mfma_f32_4x4x4_16b_bf16 v[88:91], v[12:13], v[84:85], 0
    s_nop 1
    v_mfma_f32_4x4x4_16b_bf16 v[88:91], v[10:11], v[86:87], v[88:91]
    s_nop 4
    v_cvt_pk_bf16_f32 v88, v88, v89
    v_cvt_pk_bf16_f32 v89, v90, v91
    ds_pk_add_bf16 v7, v88 offset:65408
    ds_pk_add_bf16 v7, v89 offset:65412
    s_mov_b64 exec, s[54:55]
    s_branch L2_d120
L2_c121:
    s_lshl_b64 s[52:53], s[82:83], 1
    s_andn2_b64 s[52:53], s[52:53], s[80:81]
    s_andn2_b64 s[52:53], s[52:53], s[50:51]
    s_or_b64 s[80:81], s[80:81], s[52:53]
    s_not_b64 vcc, s[52:53]
    s_mov_b64 exec, -1
    v_cndmask_b32_dpp v84, v84, v84, vcc wave_shr:1 row_mask:0xf bank_mask:0xf
    v_cndmask_b32_dpp v85, v85, v85, vcc wave_shr:1 row_mask:0xf bank_mask:0xf
    s_lshr_b64 s[52:53], s[52:53], 1
    v_cndmask_b32_dpp v86, v86, v86, vcc wave_shr:1 row_mask:0xf bank_mask:0xf
    v_cndmask_b32_dpp v87, v87, v87, vcc wave_shr:1 row_mask:0xf bank_mask:0xf
    s_andn2_b64 s[82:83], s[82:83], s[52:53]
    v_cndmask_b32_dpp v7, v7, v7, vcc wave_shr:1 row_mask:0xf bank_mask:0xf
    s_mov_b64 exec, s[50:51]
    s_cbranch_scc0 L2_d121
    s_mov_b64 exec, s[82:83]
    s_nop 1
    v_mfma_f32_4x4x4_16b_bf16 v[88:91], v[12:13], v[84:85], 0
    s_nop 1
    v_mfma_f32_4x4x4_16b_bf16 v[88:91], v[10:11], v[86:87], v[88:91]
    s_nop 4
    v_cvt_pk_bf16_f32 v88, v88, v89
    v_cvt_pk_bf16_f32 v89, v90, v91
    ds_pk_add_bf16 v7, v88 offset:65408
    ds_pk_add_bf16 v7, v89 offset:65412
    s_mov_b64 exec, s[50:51]
    s_branch L2_d121
L2_c122:
    s_lshl_b64 s[52:53], s[82:83], 1
    s_andn2_b64 s[52:53], s[52:53], s[80:81]
    s_andn2_b64 s[52:53], s[52:53], s[54:55]
    s_or_b64 s[80:81], s[80:81], s[52:53]
    s_not_b64 vcc, s[52:53]
    s_mov_b64 exec, -1
    v_cndmask_b32_dpp v84, v84, v84, vcc wave_shr:1 row_mask:0xf bank_mask:0xf
    v_cndmask_b32_dpp v85, v85, v85, vcc wave_shr:1 row_mask:0xf bank_mask:0xf
    s_lshr_b64 s[52:53], s[52:53], 1
    v_cndmask_b32_dpp v86, v86, v86, vcc wave_shr:1 row_mask:0xf bank_mask:0xf
    v_cndmask_b32_dpp v87, v87, v87, vcc wave_shr:1 row_mask:0xf bank_mask:0xf
    s_andn2_b64 s[82:83], s[82:83], s[52:53]
    v_cndmask_b32_dpp v7, v7, v7, vcc wave_shr:1 row_mask:0xf bank_mask:0xf
    s_mov_b64 exec, s[54:55]
    s_cbranch_scc0 L2_d122
    s_mov_b64 exec, s[82:83]
    s_nop 1
    v_mfma_f32_4x4x4_16b_bf16 v[88:91], v[12:13], v[84:85], 0
    s_nop 1
    v_mfma_f32_4x4x4_16b_bf16 v[88:91], v[10:11], v[86:87], v[88:91]
    s_nop 4
    v_cvt_pk_bf16_f32 v88, v88, v89
    v_cvt_pk_bf16_f32 v89, v90, v91
    ds_pk_add_bf16 v7, v88 offset:65408
    ds_pk_add_bf16 v7, v89 offset:65412
    s_mov_b64 exec, s[54:55]
    s_branch L2_d122
L2_c123:
    s_lshl_b64 s[52:53], s[82:83], 1
    s_andn2_b64 s[52:53], s[52:53], s[80:81]
    s_andn2_b64 s[52:53], s[52:53], s[50:51]
    s_or_b64 s[80:81], s[80:81], s[52:53]
    s_not_b64 vcc, s[52:53]
    s_mov_b64 exec, -1
    v_cndmask_b32_dpp v84, v84, v84, vcc wave_shr:1 row_mask:0xf bank_mask:0xf
    v_cndmask_b32_dpp v85, v85, v85, vcc wave_shr:1 row_mask:0xf bank_mask:0xf
    s_lshr_b64 s[52:53], s[52:53], 1
    v_cndmask_b32_dpp v86, v86, v86, vcc wave_shr:1 row_mask:0xf bank_mask:0xf
    v_cndmask_b32_dpp v87, v87, v87, vcc wave_shr:1 row_mask:0xf bank_mask:0xf
    s_andn2_b64 s[82:83], s[82:83], s[52:53]
    v_cndmask_b32_dpp v7, v7, v7, vcc wave_shr:1 row_mask:0xf bank_mask:0xf
    s_mov_b64 exec, s[50:51]
    s_cbranch_scc0 L2_d123
    s_mov_b64 exec, s[82:83]
    s_nop 1
    v_mfma_f32_4x4x4_16b_bf16 v[88:91], v[12:13], v[84:85], 0
    s_nop 1
    v_mfma_f32_4x4x4_16b_bf16 v[88:91], v[10:11], v[86:87], v[88:91]
    s_nop 4
    v_cvt_pk_bf16_f32 v88, v88, v89
    v_cvt_pk_bf16_f32 v89, v90, v91
    ds_pk_add_bf16 v7, v88 offset:65408
    ds_pk_add_bf16 v7, v89 offset:65412
    s_mov_b64 exec, s[50:51]
    s_branch L2_d123
L2_c124:
    s_lshl_b64 s[52:53], s[82:83], 1
    s_andn2_b64 s[52:53], s[52:53], s[80:81]
    s_andn2_b64 s[52:53], s[52:53], s[54:55]
    s_or_b64 s[80:81], s[80:81], s[52:53]
    s_not_b64 vcc, s[52:53]
    s_mov_b64 exec, -1
    v_cndmask_b32_dpp v84, v84, v84, vcc wave_shr:1 row_mask:0xf bank_mask:0xf
    v_cndmask_b32_dpp v85, v85, v85, vcc wave_shr:1 row_mask:0xf bank_mask:0xf
    s_lshr_b64 s[52:53], s[52:53], 1
    v_cndmask_b32_dpp v86, v86, v86, vcc wave_shr:1 row_mask:0xf bank_mask:0xf
    v_cndmask_b32_dpp v87, v87, v87, vcc wave_shr:1 row_mask:0xf bank_mask:0xf
    s_andn2_b64 s[82:83], s[82:83], s[52:53]
    v_cndmask_b32_dpp v7, v7, v7, vcc wave_shr:1 row_mask:0xf bank_mask:0xf
    s_mov_b64 exec, s[54:55]
    s_cbranch_scc0 L2_d124
    s_mov_b64 exec, s[82:83]
    s_nop 1
    v_mfma_f32_4x4x4_16b_bf16 v[88:91], v[12:13], v[84:85], 0
    s_nop 1
    v_mfma_f32_4x4x4_16b_bf16 v[88:91], v[10:11], v[86:87], v[88:91]
    s_nop 4
    v_cvt_pk_bf16_f32 v88, v88, v89
    v_cvt_pk_bf16_f32 v89, v90, v91
    ds_pk_add_bf16 v7, v88 offset:65408
    ds_pk_add_bf16 v7, v89 offset:65412
    s_mov_b64 exec, s[54:55]
    s_branch L2_d124
L2_c125:
    s_lshl_b64 s[52:53], s[82:83], 1
    s_andn2_b64 s[52:53], s[52:53], s[80:81]
    s_andn2_b64 s[52:53], s[52:53], s[50:51]
    s_or_b64 s[80:81], s[80:81], s[52:53]
    s_not_b64 vcc, s[52:53]
    s_mov_b64 exec, -1
    v_cndmask_b32_dpp v84, v84, v84, vcc wave_shr:1 row_mask:0xf bank_mask:0xf
    v_cndmask_b32_dpp v85, v85, v85, vcc wave_shr:1 row_mask:0xf bank_mask:0xf
    s_lshr_b64 s[52:53], s[52:53], 1
    v_cndmask_b32_dpp v86, v86, v86, vcc wave_shr:1 row_mask:0xf bank_mask:0xf
    v_cndmask_b32_dpp v87, v87, v87, vcc wave_shr:1 row_mask:0xf bank_mask:0xf
    s_andn2_b64 s[82:83], s[82:83], s[52:53]
    v_cndmask_b32_dpp v7, v7, v7, vcc wave_shr:1 row_mask:0xf bank_mask:0xf
    s_mov_b64 exec, s[50:51]
    s_cbranch_scc0 L2_d125
    s_mov_b64 exec, s[82:83]
    s_nop 1
    v_mfma_f32_4x4x4_16b_bf16 v[88:91], v[12:13], v[84:85], 0
    s_nop 1
    v_mfma_f32_4x4x4_16b_bf16 v[88:91], v[10:11], v[86:87], v[88:91]
    s_nop 4
    v_cvt_pk_bf16_f32 v88, v88, v89
    v_cvt_pk_bf16_f32 v89, v90, v91
    ds_pk_add_bf16 v7, v88 offset:65408
    ds_pk_add_bf16 v7, v89 offset:65412
    s_mov_b64 exec, s[50:51]
    s_branch L2_d125
L2_c126:
    s_lshl_b64 s[52:53], s[82:83], 1
    s_andn2_b64 s[52:53], s[52:53], s[80:81]
    s_andn2_b64 s[52:53], s[52:53], s[54:55]
    s_or_b64 s[80:81], s[80:81], s[52:53]
    s_not_b64 vcc, s[52:53]
    s_mov_b64 exec, -1
    v_cndmask_b32_dpp v84, v84, v84, vcc wave_shr:1 row_mask:0xf bank_mask:0xf
    v_cndmask_b32_dpp v85, v85, v85, vcc wave_shr:1 row_mask:0xf bank_mask:0xf
    s_lshr_b64 s[52:53], s[52:53], 1
    v_cndmask_b32_dpp v86, v86, v86, vcc wave_shr:1 row_mask:0xf bank_mask:0xf
    v_cndmask_b32_dpp v87, v87, v87, vcc wave_shr:1 row_mask:0xf bank_mask:0xf
    s_andn2_b64 s[82:83], s[82:83], s[52:53]
    v_cndmask_b32_dpp v7, v7, v7, vcc wave_shr:1 row_mask:0xf bank_mask:0xf
    s_mov_b64 exec, s[54:55]
    s_cbranch_scc0 L2_d126
    s_mov_b64 exec, s[82:83]
    s_nop 1
    v_mfma_f32_4x4x4_16b_bf16 v[88:91], v[12:13], v[84:85], 0
    s_nop 1
    v_mfma_f32_4x4x4_16b_bf16 v[88:91], v[10:11], v[86:87], v[88:91]
    s_nop 4
    v_cvt_pk_bf16_f32 v88, v88, v89
    v_cvt_pk_bf16_f32 v89, v90, v91
    ds_pk_add_bf16 v7, v88 offset:65408
    ds_pk_add_bf16 v7, v89 offset:65412
    s_mov_b64 exec, s[54:55]
    s_branch L2_d126
L2_c127:
    s_lshl_b64 s[52:53], s[82:83], 1
    s_andn2_b64 s[52:53], s[52:53], s[80:81]
    s_andn2_b64 s[52:53], s[52:53], s[50:51]
    s_or_b64 s[80:81], s[80:81], s[52:53]
    s_not_b64 vcc, s[52:53]
    s_mov_b64 exec, -1
    v_cndmask_b32_dpp v84, v84, v84, vcc wave_shr:1 row_mask:0xf bank_mask:0xf
    v_cndmask_b32_dpp v85, v85, v85, vcc wave_shr:1 row_mask:0xf bank_mask:0xf
    s_lshr_b64 s[52:53], s[52:53], 1
    v_cndmask_b32_dpp v86, v86, v86, vcc wave_shr:1 row_mask:0xf bank_mask:0xf
    v_cndmask_b32_dpp v87, v87, v87, vcc wave_shr:1 row_mask:0xf bank_mask:0xf
    s_andn2_b64 s[82:83], s[82:83], s[52:53]
    v_cndmask_b32_dpp v7, v7, v7, vcc wave_shr:1 row_mask:0xf bank_mask:0xf
    s_mov_b64 exec, s[50:51]
    s_cbranch_scc0 L2_d127
    s_mov_b64 exec, s[82:83]
    s_nop 1
    v_mfma_f32_4x4x4_16b_bf16 v[88:91], v[12:13], v[84:85], 0
    s_nop 1
    v_mfma_f32_4x4x4_16b_bf16 v[88:91], v[10:11], v[86:87], v[88:91]
    s_nop 4
    v_cvt_pk_bf16_f32 v88, v88, v89
    v_cvt_pk_bf16_f32 v89, v90, v91
    ds_pk_add_bf16 v7, v88 offset:65408
    ds_pk_add_bf16 v7, v89 offset:65412
    s_mov_b64 exec, s[50:51]
    s_branch L2_d127
L2_c128:
    s_lshl_b64 s[52:53], s[82:83], 1
    s_andn2_b64 s[52:53], s[52:53], s[80:81]
    s_andn2_b64 s[52:53], s[52:53], s[54:55]
    s_or_b64 s[80:81], s[80:81], s[52:53]
    s_not_b64 vcc, s[52:53]
    s_mov_b64 exec, -1
    v_cndmask_b32_dpp v84, v84, v84, vcc wave_shr:1 row_mask:0xf bank_mask:0xf
    v_cndmask_b32_dpp v85, v85, v85, vcc wave_shr:1 row_mask:0xf bank_mask:0xf
    s_lshr_b64 s[52:53], s[52:53], 1
    v_cndmask_b32_dpp v86, v86, v86, vcc wave_shr:1 row_mask:0xf bank_mask:0xf
    v_cndmask_b32_dpp v87, v87, v87, vcc wave_shr:1 row_mask:0xf bank_mask:0xf
    s_andn2_b64 s[82:83], s[82:83], s[52:53]
    v_cndmask_b32_dpp v7, v7, v7, vcc wave_shr:1 row_mask:0xf bank_mask:0xf
    s_mov_b64 exec, s[54:55]
    s_cbranch_scc0 L2_d128
    s_mov_b64 exec, s[82:83]
    s_nop 1
    v_mfma_f32_4x4x4_16b_bf16 v[88:91], v[12:13], v[84:85], 0
    s_nop 1
    v_mfma_f32_4x4x4_16b_bf16 v[88:91], v[10:11], v[86:87], v[88:91]
    s_nop 4
    v_cvt_pk_bf16_f32 v88, v88, v89
    v_cvt_pk_bf16_f32 v89, v90, v91
    ds_pk_add_bf16 v7, v88 offset:65408
    ds_pk_add_bf16 v7, v89 offset:65412
    s_mov_b64 exec, s[54:55]
    s_branch L2_d128
L2_c129:
    s_lshl_b64 s[52:53], s[82:83], 1
    s_andn2_b64 s[52:53], s[52:53], s[80:81]
    s_andn2_b64 s[52:53], s[52:53], s[50:51]
    s_or_b64 s[80:81], s[80:81], s[52:53]
    s_not_b64 vcc, s[52:53]
    s_mov_b64 exec, -1
    v_cndmask_b32_dpp v84, v84, v84, vcc wave_shr:1 row_mask:0xf bank_mask:0xf
    v_cndmask_b32_dpp v85, v85, v85, vcc wave_shr:1 row_mask:0xf bank_mask:0xf
    s_lshr_b64 s[52:53], s[52:53], 1
    v_cndmask_b32_dpp v86, v86, v86, vcc wave_shr:1 row_mask:0xf bank_mask:0xf
    v_cndmask_b32_dpp v87, v87, v87, vcc wave_shr:1 row_mask:0xf bank_mask:0xf
    s_andn2_b64 s[82:83], s[82:83], s[52:53]
    v_cndmask_b32_dpp v7, v7, v7, vcc wave_shr:1 row_mask:0xf bank_mask:0xf
    s_mov_b64 exec, s[50:51]
    s_cbranch_scc0 L2_d129
    s_mov_b64 exec, s[82:83]
    s_nop 1
    v_mfma_f32_4x4x4_16b_bf16 v[88:91], v[12:13], v[84:85], 0
    s_nop 1
    v_mfma_f32_4x4x4_16b_bf16 v[88:91], v[10:11], v[86:87], v[88:91]
    s_nop 4
    v_cvt_pk_bf16_f32 v88, v88, v89
    v_cvt_pk_bf16_f32 v89, v90, v91
    ds_pk_add_bf16 v7, v88 offset:65408
    ds_pk_add_bf16 v7, v89 offset:65412
    s_mov_b64 exec, s[50:51]
    s_branch L2_d129
L2_c130:
    s_lshl_b64 s[52:53], s[82:83], 1
    s_andn2_b64 s[52:53], s[52:53], s[80:81]
    s_andn2_b64 s[52:53], s[52:53], s[54:55]
    s_or_b64 s[80:81], s[80:81], s[52:53]
    s_not_b64 vcc, s[52:53]
    s_mov_b64 exec, -1
    v_cndmask_b32_dpp v84, v84, v84, vcc wave_shr:1 row_mask:0xf bank_mask:0xf
    v_cndmask_b32_dpp v85, v85, v85, vcc wave_shr:1 row_mask:0xf bank_mask:0xf
    s_lshr_b64 s[52:53], s[52:53], 1
    v_cndmask_b32_dpp v86, v86, v86, vcc wave_shr:1 row_mask:0xf bank_mask:0xf
    v_cndmask_b32_dpp v87, v87, v87, vcc wave_shr:1 row_mask:0xf bank_mask:0xf
    s_andn2_b64 s[82:83], s[82:83], s[52:53]
    v_cndmask_b32_dpp v7, v7, v7, vcc wave_shr:1 row_mask:0xf bank_mask:0xf
    s_mov_b64 exec, s[54:55]
    s_cbranch_scc0 L2_d130
    s_mov_b64 exec, s[82:83]
    s_nop 1
    v_mfma_f32_4x4x4_16b_bf16 v[88:91], v[12:13], v[84:85], 0
    s_nop 1
    v_mfma_f32_4x4x4_16b_bf16 v[88:91], v[10:11], v[86:87], v[88:91]
    s_nop 4
    v_cvt_pk_bf16_f32 v88, v88, v89
    v_cvt_pk_bf16_f32 v89, v90, v91
    ds_pk_add_bf16 v7, v88 offset:65408
    ds_pk_add_bf16 v7, v89 offset:65412
    s_mov_b64 exec, s[54:55]
    s_branch L2_d130
L2_c131:
    s_lshl_b64 s[52:53], s[82:83], 1
    s_andn2_b64 s[52:53], s[52:53], s[80:81]
    s_andn2_b64 s[52:53], s[52:53], s[50:51]
    s_or_b64 s[80:81], s[80:81], s[52:53]
    s_not_b64 vcc, s[52:53]
    s_mov_b64 exec, -1
    v_cndmask_b32_dpp v84, v84, v84, vcc wave_shr:1 row_mask:0xf bank_mask:0xf
    v_cndmask_b32_dpp v85, v85, v85, vcc wave_shr:1 row_mask:0xf bank_mask:0xf
    s_lshr_b64 s[52:53], s[52:53], 1
    v_cndmask_b32_dpp v86, v86, v86, vcc wave_shr:1 row_mask:0xf bank_mask:0xf
    v_cndmask_b32_dpp v87, v87, v87, vcc wave_shr:1 row_mask:0xf bank_mask:0xf
    s_andn2_b64 s[82:83], s[82:83], s[52:53]
    v_cndmask_b32_dpp v7, v7, v7, vcc wave_shr:1 row_mask:0xf bank_mask:0xf
    s_mov_b64 exec, s[50:51]
    s_cbranch_scc0 L2_d131
    s_mov_b64 exec, s[82:83]
    s_nop 1
    v_mfma_f32_4x4x4_16b_bf16 v[88:91], v[12:13], v[84:85], 0
    s_nop 1
    v_mfma_f32_4x4x4_16b_bf16 v[88:91], v[10:11], v[86:87], v[88:91]
    s_nop 4
    v_cvt_pk_bf16_f32 v88, v88, v89
    v_cvt_pk_bf16_f32 v89, v90, v91
    ds_pk_add_bf16 v7, v88 offset:65408
    ds_pk_add_bf16 v7, v89 offset:65412
    s_mov_b64 exec, s[50:51]
    s_branch L2_d131
L2_c132:
    s_lshl_b64 s[52:53], s[82:83], 1
    s_andn2_b64 s[52:53], s[52:53], s[80:81]
    s_andn2_b64 s[52:53], s[52:53], s[54:55]
    s_or_b64 s[80:81], s[80:81], s[52:53]
    s_not_b64 vcc, s[52:53]
    s_mov_b64 exec, -1
    v_cndmask_b32_dpp v84, v84, v84, vcc wave_shr:1 row_mask:0xf bank_mask:0xf
    v_cndmask_b32_dpp v85, v85, v85, vcc wave_shr:1 row_mask:0xf bank_mask:0xf
    s_lshr_b64 s[52:53], s[52:53], 1
    v_cndmask_b32_dpp v86, v86, v86, vcc wave_shr:1 row_mask:0xf bank_mask:0xf
    v_cndmask_b32_dpp v87, v87, v87, vcc wave_shr:1 row_mask:0xf bank_mask:0xf
    s_andn2_b64 s[82:83], s[82:83], s[52:53]
    v_cndmask_b32_dpp v7, v7, v7, vcc wave_shr:1 row_mask:0xf bank_mask:0xf
    s_mov_b64 exec, s[54:55]
    s_cbranch_scc0 L2_d132
    s_mov_b64 exec, s[82:83]
    s_nop 1
    v_mfma_f32_4x4x4_16b_bf16 v[88:91], v[12:13], v[84:85], 0
    s_nop 1
    v_mfma_f32_4x4x4_16b_bf16 v[88:91], v[10:11], v[86:87], v[88:91]
    s_nop 4
    v_cvt_pk_bf16_f32 v88, v88, v89
    v_cvt_pk_bf16_f32 v89, v90, v91
    ds_pk_add_bf16 v7, v88 offset:65408
    ds_pk_add_bf16 v7, v89 offset:65412
    s_mov_b64 exec, s[54:55]
    s_branch L2_d132
L2_c133:
    s_lshl_b64 s[52:53], s[82:83], 1
    s_andn2_b64 s[52:53], s[52:53], s[80:81]
    s_andn2_b64 s[52:53], s[52:53], s[50:51]
    s_or_b64 s[80:81], s[80:81], s[52:53]
    s_not_b64 vcc, s[52:53]
    s_mov_b64 exec, -1
    v_cndmask_b32_dpp v84, v84, v84, vcc wave_shr:1 row_mask:0xf bank_mask:0xf
    v_cndmask_b32_dpp v85, v85, v85, vcc wave_shr:1 row_mask:0xf bank_mask:0xf
    s_lshr_b64 s[52:53], s[52:53], 1
    v_cndmask_b32_dpp v86, v86, v86, vcc wave_shr:1 row_mask:0xf bank_mask:0xf
    v_cndmask_b32_dpp v87, v87, v87, vcc wave_shr:1 row_mask:0xf bank_mask:0xf
    s_andn2_b64 s[82:83], s[82:83], s[52:53]
    v_cndmask_b32_dpp v7, v7, v7, vcc wave_shr:1 row_mask:0xf bank_mask:0xf
    s_mov_b64 exec, s[50:51]
    s_cbranch_scc0 L2_d133
    s_mov_b64 exec, s[82:83]
    s_nop 1
    v_mfma_f32_4x4x4_16b_bf16 v[88:91], v[12:13], v[84:85], 0
    s_nop 1
    v_mfma_f32_4x4x4_16b_bf16 v[88:91], v[10:11], v[86:87], v[88:91]
    s_nop 4
    v_cvt_pk_bf16_f32 v88, v88, v89
    v_cvt_pk_bf16_f32 v89, v90, v91
    ds_pk_add_bf16 v7, v88 offset:65408
    ds_pk_add_bf16 v7, v89 offset:65412
    s_mov_b64 exec, s[50:51]
    s_branch L2_d133
L2_c134:
    s_lshl_b64 s[52:53], s[82:83], 1
    s_andn2_b64 s[52:53], s[52:53], s[80:81]
    s_andn2_b64 s[52:53], s[52:53], s[54:55]
    s_or_b64 s[80:81], s[80:81], s[52:53]
    s_not_b64 vcc, s[52:53]
    s_mov_b64 exec, -1
    v_cndmask_b32_dpp v84, v84, v84, vcc wave_shr:1 row_mask:0xf bank_mask:0xf
    v_cndmask_b32_dpp v85, v85, v85, vcc wave_shr:1 row_mask:0xf bank_mask:0xf
    s_lshr_b64 s[52:53], s[52:53], 1
    v_cndmask_b32_dpp v86, v86, v86, vcc wave_shr:1 row_mask:0xf bank_mask:0xf
    v_cndmask_b32_dpp v87, v87, v87, vcc wave_shr:1 row_mask:0xf bank_mask:0xf
    s_andn2_b64 s[82:83], s[82:83], s[52:53]
    v_cndmask_b32_dpp v7, v7, v7, vcc wave_shr:1 row_mask:0xf bank_mask:0xf
    s_mov_b64 exec, s[54:55]
    s_cbranch_scc0 L2_d134
    s_mov_b64 exec, s[82:83]
    s_nop 1
    v_mfma_f32_4x4x4_16b_bf16 v[88:91], v[12:13], v[84:85], 0
    s_nop 1
    v_mfma_f32_4x4x4_16b_bf16 v[88:91], v[10:11], v[86:87], v[88:91]
    s_nop 4
    v_cvt_pk_bf16_f32 v88, v88, v89
    v_cvt_pk_bf16_f32 v89, v90, v91
    ds_pk_add_bf16 v7, v88 offset:65408
    ds_pk_add_bf16 v7, v89 offset:65412
    s_mov_b64 exec, s[54:55]
    s_branch L2_d134
L2_c135:
    s_lshl_b64 s[52:53], s[82:83], 1
    s_andn2_b64 s[52:53], s[52:53], s[80:81]
    s_andn2_b64 s[52:53], s[52:53], s[50:51]
    s_or_b64 s[80:81], s[80:81], s[52:53]
    s_not_b64 vcc, s[52:53]
    s_mov_b64 exec, -1
    v_cndmask_b32_dpp v84, v84, v84, vcc wave_shr:1 row_mask:0xf bank_mask:0xf
    v_cndmask_b32_dpp v85, v85, v85, vcc wave_shr:1 row_mask:0xf bank_mask:0xf
    s_lshr_b64 s[52:53], s[52:53], 1
    v_cndmask_b32_dpp v86, v86, v86, vcc wave_shr:1 row_mask:0xf bank_mask:0xf
    v_cndmask_b32_dpp v87, v87, v87, vcc wave_shr:1 row_mask:0xf bank_mask:0xf
    s_andn2_b64 s[82:83], s[82:83], s[52:53]
    v_cndmask_b32_dpp v7, v7, v7, vcc wave_shr:1 row_mask:0xf bank_mask:0xf
    s_mov_b64 exec, s[50:51]
    s_cbranch_scc0 L2_d135
    s_mov_b64 exec, s[82:83]
    s_nop 1
    v_mfma_f32_4x4x4_16b_bf16 v[88:91], v[12:13], v[84:85], 0
    s_nop 1
    v_mfma_f32_4x4x4_16b_bf16 v[88:91], v[10:11], v[86:87], v[88:91]
    s_nop 4
    v_cvt_pk_bf16_f32 v88, v88, v89
    v_cvt_pk_bf16_f32 v89, v90, v91
    ds_pk_add_bf16 v7, v88 offset:65408
    ds_pk_add_bf16 v7, v89 offset:65412
    s_mov_b64 exec, s[50:51]
    s_branch L2_d135
L2_c136:
    s_lshl_b64 s[52:53], s[82:83], 1
    s_andn2_b64 s[52:53], s[52:53], s[80:81]
    s_andn2_b64 s[52:53], s[52:53], s[54:55]
    s_or_b64 s[80:81], s[80:81], s[52:53]
    s_not_b64 vcc, s[52:53]
    s_mov_b64 exec, -1
    v_cndmask_b32_dpp v84, v84, v84, vcc wave_shr:1 row_mask:0xf bank_mask:0xf
    v_cndmask_b32_dpp v85, v85, v85, vcc wave_shr:1 row_mask:0xf bank_mask:0xf
    s_lshr_b64 s[52:53], s[52:53], 1
    v_cndmask_b32_dpp v86, v86, v86, vcc wave_shr:1 row_mask:0xf bank_mask:0xf
    v_cndmask_b32_dpp v87, v87, v87, vcc wave_shr:1 row_mask:0xf bank_mask:0xf
    s_andn2_b64 s[82:83], s[82:83], s[52:53]
    v_cndmask_b32_dpp v7, v7, v7, vcc wave_shr:1 row_mask:0xf bank_mask:0xf
    s_mov_b64 exec, s[54:55]
    s_cbranch_scc0 L2_d136
    s_mov_b64 exec, s[82:83]
    s_nop 1
    v_mfma_f32_4x4x4_16b_bf16 v[88:91], v[12:13], v[84:85], 0
    s_nop 1
    v_mfma_f32_4x4x4_16b_bf16 v[88:91], v[10:11], v[86:87], v[88:91]
    s_nop 4
    v_cvt_pk_bf16_f32 v88, v88, v89
    v_cvt_pk_bf16_f32 v89, v90, v91
    ds_pk_add_bf16 v7, v88 offset:65408
    ds_pk_add_bf16 v7, v89 offset:65412
    s_mov_b64 exec, s[54:55]
    s_branch L2_d136
L2_c137:
    s_lshl_b64 s[52:53], s[82:83], 1
    s_andn2_b64 s[52:53], s[52:53], s[80:81]
    s_andn2_b64 s[52:53], s[52:53], s[50:51]
    s_or_b64 s[80:81], s[80:81], s[52:53]
    s_not_b64 vcc, s[52:53]
    s_mov_b64 exec, -1
    v_cndmask_b32_dpp v84, v84, v84, vcc wave_shr:1 row_mask:0xf bank_mask:0xf
    v_cndmask_b32_dpp v85, v85, v85, vcc wave_shr:1 row_mask:0xf bank_mask:0xf
    s_lshr_b64 s[52:53], s[52:53], 1
    v_cndmask_b32_dpp v86, v86, v86, vcc wave_shr:1 row_mask:0xf bank_mask:0xf
    v_cndmask_b32_dpp v87, v87, v87, vcc wave_shr:1 row_mask:0xf bank_mask:0xf
    s_andn2_b64 s[82:83], s[82:83], s[52:53]
    v_cndmask_b32_dpp v7, v7, v7, vcc wave_shr:1 row_mask:0xf bank_mask:0xf
    s_mov_b64 exec, s[50:51]
    s_cbranch_scc0 L2_d137
    s_mov_b64 exec, s[82:83]
    s_nop 1
    v_mfma_f32_4x4x4_16b_bf16 v[88:91], v[12:13], v[84:85], 0
    s_nop 1
    v_mfma_f32_4x4x4_16b_bf16 v[88:91], v[10:11], v[86:87], v[88:91]
    s_nop 4
    v_cvt_pk_bf16_f32 v88, v88, v89
    v_cvt_pk_bf16_f32 v89, v90, v91
    ds_pk_add_bf16 v7, v88 offset:65408
    ds_pk_add_bf16 v7, v89 offset:65412
    s_mov_b64 exec, s[50:51]
    s_branch L2_d137
L2_c138:
    s_lshl_b64 s[52:53], s[82:83], 1
    s_andn2_b64 s[52:53], s[52:53], s[80:81]
    s_andn2_b64 s[52:53], s[52:53], s[54:55]
    s_or_b64 s[80:81], s[80:81], s[52:53]
    s_not_b64 vcc, s[52:53]
    s_mov_b64 exec, -1
    v_cndmask_b32_dpp v84, v84, v84, vcc wave_shr:1 row_mask:0xf bank_mask:0xf
    v_cndmask_b32_dpp v85, v85, v85, vcc wave_shr:1 row_mask:0xf bank_mask:0xf
    s_lshr_b64 s[52:53], s[52:53], 1
    v_cndmask_b32_dpp v86, v86, v86, vcc wave_shr:1 row_mask:0xf bank_mask:0xf
    v_cndmask_b32_dpp v87, v87, v87, vcc wave_shr:1 row_mask:0xf bank_mask:0xf
    s_andn2_b64 s[82:83], s[82:83], s[52:53]
    v_cndmask_b32_dpp v7, v7, v7, vcc wave_shr:1 row_mask:0xf bank_mask:0xf
    s_mov_b64 exec, s[54:55]
    s_cbranch_scc0 L2_d138
    s_mov_b64 exec, s[82:83]
    s_nop 1
    v_mfma_f32_4x4x4_16b_bf16 v[88:91], v[12:13], v[84:85], 0
    s_nop 1
    v_mfma_f32_4x4x4_16b_bf16 v[88:91], v[10:11], v[86:87], v[88:91]
    s_nop 4
    v_cvt_pk_bf16_f32 v88, v88, v89
    v_cvt_pk_bf16_f32 v89, v90, v91
    ds_pk_add_bf16 v7, v88 offset:65408
    ds_pk_add_bf16 v7, v89 offset:65412
    s_mov_b64 exec, s[54:55]
    s_branch L2_d138
L2_c139:
    s_lshl_b64 s[52:53], s[82:83], 1
    s_andn2_b64 s[52:53], s[52:53], s[80:81]
    s_andn2_b64 s[52:53], s[52:53], s[50:51]
    s_or_b64 s[80:81], s[80:81], s[52:53]
    s_not_b64 vcc, s[52:53]
    s_mov_b64 exec, -1
    v_cndmask_b32_dpp v84, v84, v84, vcc wave_shr:1 row_mask:0xf bank_mask:0xf
    v_cndmask_b32_dpp v85, v85, v85, vcc wave_shr:1 row_mask:0xf bank_mask:0xf
    s_lshr_b64 s[52:53], s[52:53], 1
    v_cndmask_b32_dpp v86, v86, v86, vcc wave_shr:1 row_mask:0xf bank_mask:0xf
    v_cndmask_b32_dpp v87, v87, v87, vcc wave_shr:1 row_mask:0xf bank_mask:0xf
    s_andn2_b64 s[82:83], s[82:83], s[52:53]
    v_cndmask_b32_dpp v7, v7, v7, vcc wave_shr:1 row_mask:0xf bank_mask:0xf
    s_mov_b64 exec, s[50:51]
    s_cbranch_scc0 L2_d139
    s_mov_b64 exec, s[82:83]
    s_nop 1
    v_mfma_f32_4x4x4_16b_bf16 v[88:91], v[12:13], v[84:85], 0
    s_nop 1
    v_mfma_f32_4x4x4_16b_bf16 v[88:91], v[10:11], v[86:87], v[88:91]
    s_nop 4
    v_cvt_pk_bf16_f32 v88, v88, v89
    v_cvt_pk_bf16_f32 v89, v90, v91
    ds_pk_add_bf16 v7, v88 offset:65408
    ds_pk_add_bf16 v7, v89 offset:65412
    s_mov_b64 exec, s[50:51]
    s_branch L2_d139
L2_c140:
    s_lshl_b64 s[52:53], s[82:83], 1
    s_andn2_b64 s[52:53], s[52:53], s[80:81]
    s_andn2_b64 s[52:53], s[52:53], s[54:55]
    s_or_b64 s[80:81], s[80:81], s[52:53]
    s_not_b64 vcc, s[52:53]
    s_mov_b64 exec, -1
    v_cndmask_b32_dpp v84, v84, v84, vcc wave_shr:1 row_mask:0xf bank_mask:0xf
    v_cndmask_b32_dpp v85, v85, v85, vcc wave_shr:1 row_mask:0xf bank_mask:0xf
    s_lshr_b64 s[52:53], s[52:53], 1
    v_cndmask_b32_dpp v86, v86, v86, vcc wave_shr:1 row_mask:0xf bank_mask:0xf
    v_cndmask_b32_dpp v87, v87, v87, vcc wave_shr:1 row_mask:0xf bank_mask:0xf
    s_andn2_b64 s[82:83], s[82:83], s[52:53]
    v_cndmask_b32_dpp v7, v7, v7, vcc wave_shr:1 row_mask:0xf bank_mask:0xf
    s_mov_b64 exec, s[54:55]
    s_cbranch_scc0 L2_d140
    s_mov_b64 exec, s[82:83]
    s_nop 1
    v_mfma_f32_4x4x4_16b_bf16 v[88:91], v[12:13], v[84:85], 0
    s_nop 1
    v_mfma_f32_4x4x4_16b_bf16 v[88:91], v[10:11], v[86:87], v[88:91]
    s_nop 4
    v_cvt_pk_bf16_f32 v88, v88, v89
    v_cvt_pk_bf16_f32 v89, v90, v91
    ds_pk_add_bf16 v7, v88 offset:65408
    ds_pk_add_bf16 v7, v89 offset:65412
    s_mov_b64 exec, s[54:55]
    s_branch L2_d140
L2_c141:
    s_lshl_b64 s[52:53], s[82:83], 1
    s_andn2_b64 s[52:53], s[52:53], s[80:81]
    s_andn2_b64 s[52:53], s[52:53], s[50:51]
    s_or_b64 s[80:81], s[80:81], s[52:53]
    s_not_b64 vcc, s[52:53]
    s_mov_b64 exec, -1
    v_cndmask_b32_dpp v84, v84, v84, vcc wave_shr:1 row_mask:0xf bank_mask:0xf
    v_cndmask_b32_dpp v85, v85, v85, vcc wave_shr:1 row_mask:0xf bank_mask:0xf
    s_lshr_b64 s[52:53], s[52:53], 1
    v_cndmask_b32_dpp v86, v86, v86, vcc wave_shr:1 row_mask:0xf bank_mask:0xf
    v_cndmask_b32_dpp v87, v87, v87, vcc wave_shr:1 row_mask:0xf bank_mask:0xf
    s_andn2_b64 s[82:83], s[82:83], s[52:53]
    v_cndmask_b32_dpp v7, v7, v7, vcc wave_shr:1 row_mask:0xf bank_mask:0xf
    s_mov_b64 exec, s[50:51]
    s_cbranch_scc0 L2_d141
    s_mov_b64 exec, s[82:83]
    s_nop 1
    v_mfma_f32_4x4x4_16b_bf16 v[88:91], v[12:13], v[84:85], 0
    s_nop 1
    v_mfma_f32_4x4x4_16b_bf16 v[88:91], v[10:11], v[86:87], v[88:91]
    s_nop 4
    v_cvt_pk_bf16_f32 v88, v88, v89
    v_cvt_pk_bf16_f32 v89, v90, v91
    ds_pk_add_bf16 v7, v88 offset:65408
    ds_pk_add_bf16 v7, v89 offset:65412
    s_mov_b64 exec, s[50:51]
    s_branch L2_d141
L2_c142:
    s_lshl_b64 s[52:53], s[82:83], 1
    s_andn2_b64 s[52:53], s[52:53], s[80:81]
    s_andn2_b64 s[52:53], s[52:53], s[54:55]
    s_or_b64 s[80:81], s[80:81], s[52:53]
    s_not_b64 vcc, s[52:53]
    s_mov_b64 exec, -1
    v_cndmask_b32_dpp v84, v84, v84, vcc wave_shr:1 row_mask:0xf bank_mask:0xf
    v_cndmask_b32_dpp v85, v85, v85, vcc wave_shr:1 row_mask:0xf bank_mask:0xf
    s_lshr_b64 s[52:53], s[52:53], 1
    v_cndmask_b32_dpp v86, v86, v86, vcc wave_shr:1 row_mask:0xf bank_mask:0xf
    v_cndmask_b32_dpp v87, v87, v87, vcc wave_shr:1 row_mask:0xf bank_mask:0xf
    s_andn2_b64 s[82:83], s[82:83], s[52:53]
    v_cndmask_b32_dpp v7, v7, v7, vcc wave_shr:1 row_mask:0xf bank_mask:0xf
    s_mov_b64 exec, s[54:55]
    s_cbranch_scc0 L2_d142
    s_mov_b64 exec, s[82:83]
    s_nop 1
    v_mfma_f32_4x4x4_16b_bf16 v[88:91], v[12:13], v[84:85], 0
    s_nop 1
    v_mfma_f32_4x4x4_16b_bf16 v[88:91], v[10:11], v[86:87], v[88:91]
    s_nop 4
    v_cvt_pk_bf16_f32 v88, v88, v89
    v_cvt_pk_bf16_f32 v89, v90, v91
    ds_pk_add_bf16 v7, v88 offset:65408
    ds_pk_add_bf16 v7, v89 offset:65412
    s_mov_b64 exec, s[54:55]
    s_branch L2_d142
L2_c143:
    s_lshl_b64 s[52:53], s[82:83], 1
    s_andn2_b64 s[52:53], s[52:53], s[80:81]
    s_andn2_b64 s[52:53], s[52:53], s[50:51]
    s_or_b64 s[80:81], s[80:81], s[52:53]
    s_not_b64 vcc, s[52:53]
    s_mov_b64 exec, -1
    v_cndmask_b32_dpp v84, v84, v84, vcc wave_shr:1 row_mask:0xf bank_mask:0xf
    v_cndmask_b32_dpp v85, v85, v85, vcc wave_shr:1 row_mask:0xf bank_mask:0xf
    s_lshr_b64 s[52:53], s[52:53], 1
    v_cndmask_b32_dpp v86, v86, v86, vcc wave_shr:1 row_mask:0xf bank_mask:0xf
    v_cndmask_b32_dpp v87, v87, v87, vcc wave_shr:1 row_mask:0xf bank_mask:0xf
    s_andn2_b64 s[82:83], s[82:83], s[52:53]
    v_cndmask_b32_dpp v7, v7, v7, vcc wave_shr:1 row_mask:0xf bank_mask:0xf
    s_mov_b64 exec, s[50:51]
    s_cbranch_scc0 L2_d143
    s_mov_b64 exec, s[82:83]
    s_nop 1
    v_mfma_f32_4x4x4_16b_bf16 v[88:91], v[12:13], v[84:85], 0
    s_nop 1
    v_mfma_f32_4x4x4_16b_bf16 v[88:91], v[10:11], v[86:87], v[88:91]
    s_nop 4
    v_cvt_pk_bf16_f32 v88, v88, v89
    v_cvt_pk_bf16_f32 v89, v90, v91
    ds_pk_add_bf16 v7, v88 offset:65408
    ds_pk_add_bf16 v7, v89 offset:65412
    s_mov_b64 exec, s[50:51]
    s_branch L2_d143
L2_c144:
    s_lshl_b64 s[52:53], s[82:83], 1
    s_andn2_b64 s[52:53], s[52:53], s[80:81]
    s_andn2_b64 s[52:53], s[52:53], s[54:55]
    s_or_b64 s[80:81], s[80:81], s[52:53]
    s_not_b64 vcc, s[52:53]
    s_mov_b64 exec, -1
    v_cndmask_b32_dpp v84, v84, v84, vcc wave_shr:1 row_mask:0xf bank_mask:0xf
    v_cndmask_b32_dpp v85, v85, v85, vcc wave_shr:1 row_mask:0xf bank_mask:0xf
    s_lshr_b64 s[52:53], s[52:53], 1
    v_cndmask_b32_dpp v86, v86, v86, vcc wave_shr:1 row_mask:0xf bank_mask:0xf
    v_cndmask_b32_dpp v87, v87, v87, vcc wave_shr:1 row_mask:0xf bank_mask:0xf
    s_andn2_b64 s[82:83], s[82:83], s[52:53]
    v_cndmask_b32_dpp v7, v7, v7, vcc wave_shr:1 row_mask:0xf bank_mask:0xf
    s_mov_b64 exec, s[54:55]
    s_cbranch_scc0 L2_d144
    s_mov_b64 exec, s[82:83]
    s_nop 1
    v_mfma_f32_4x4x4_16b_bf16 v[88:91], v[12:13], v[84:85], 0
    s_nop 1
    v_mfma_f32_4x4x4_16b_bf16 v[88:91], v[10:11], v[86:87], v[88:91]
    s_nop 4
    v_cvt_pk_bf16_f32 v88, v88, v89
    v_cvt_pk_bf16_f32 v89, v90, v91
    ds_pk_add_bf16 v7, v88 offset:65408
    ds_pk_add_bf16 v7, v89 offset:65412
    s_mov_b64 exec, s[54:55]
    s_branch L2_d144
L2_c145:
    s_lshl_b64 s[52:53], s[82:83], 1
    s_andn2_b64 s[52:53], s[52:53], s[80:81]
    s_andn2_b64 s[52:53], s[52:53], s[50:51]
    s_or_b64 s[80:81], s[80:81], s[52:53]
    s_not_b64 vcc, s[52:53]
    s_mov_b64 exec, -1
    v_cndmask_b32_dpp v84, v84, v84, vcc wave_shr:1 row_mask:0xf bank_mask:0xf
    v_cndmask_b32_dpp v85, v85, v85, vcc wave_shr:1 row_mask:0xf bank_mask:0xf
    s_lshr_b64 s[52:53], s[52:53], 1
    v_cndmask_b32_dpp v86, v86, v86, vcc wave_shr:1 row_mask:0xf bank_mask:0xf
    v_cndmask_b32_dpp v87, v87, v87, vcc wave_shr:1 row_mask:0xf bank_mask:0xf
    s_andn2_b64 s[82:83], s[82:83], s[52:53]
    v_cndmask_b32_dpp v7, v7, v7, vcc wave_shr:1 row_mask:0xf bank_mask:0xf
    s_mov_b64 exec, s[50:51]
    s_cbranch_scc0 L2_d145
    s_mov_b64 exec, s[82:83]
    s_nop 1
    v_mfma_f32_4x4x4_16b_bf16 v[88:91], v[12:13], v[84:85], 0
    s_nop 1
    v_mfma_f32_4x4x4_16b_bf16 v[88:91], v[10:11], v[86:87], v[88:91]
    s_nop 4
    v_cvt_pk_bf16_f32 v88, v88, v89
    v_cvt_pk_bf16_f32 v89, v90, v91
    ds_pk_add_bf16 v7, v88 offset:65408
    ds_pk_add_bf16 v7, v89 offset:65412
    s_mov_b64 exec, s[50:51]
    s_branch L2_d145
L2_c146:
    s_lshl_b64 s[52:53], s[82:83], 1
    s_andn2_b64 s[52:53], s[52:53], s[80:81]
    s_andn2_b64 s[52:53], s[52:53], s[54:55]
    s_or_b64 s[80:81], s[80:81], s[52:53]
    s_not_b64 vcc, s[52:53]
    s_mov_b64 exec, -1
    v_cndmask_b32_dpp v84, v84, v84, vcc wave_shr:1 row_mask:0xf bank_mask:0xf
    v_cndmask_b32_dpp v85, v85, v85, vcc wave_shr:1 row_mask:0xf bank_mask:0xf
    s_lshr_b64 s[52:53], s[52:53], 1
    v_cndmask_b32_dpp v86, v86, v86, vcc wave_shr:1 row_mask:0xf bank_mask:0xf
    v_cndmask_b32_dpp v87, v87, v87, vcc wave_shr:1 row_mask:0xf bank_mask:0xf
    s_andn2_b64 s[82:83], s[82:83], s[52:53]
    v_cndmask_b32_dpp v7, v7, v7, vcc wave_shr:1 row_mask:0xf bank_mask:0xf
    s_mov_b64 exec, s[54:55]
    s_cbranch_scc0 L2_d146
    s_mov_b64 exec, s[82:83]
    s_nop 1
    v_mfma_f32_4x4x4_16b_bf16 v[88:91], v[12:13], v[84:85], 0
    s_nop 1
    v_mfma_f32_4x4x4_16b_bf16 v[88:91], v[10:11], v[86:87], v[88:91]
    s_nop 4
    v_cvt_pk_bf16_f32 v88, v88, v89
    v_cvt_pk_bf16_f32 v89, v90, v91
    ds_pk_add_bf16 v7, v88 offset:65408
    ds_pk_add_bf16 v7, v89 offset:65412
    s_mov_b64 exec, s[54:55]
    s_branch L2_d146
L2_c147:
    s_lshl_b64 s[52:53], s[82:83], 1
    s_andn2_b64 s[52:53], s[52:53], s[80:81]
    s_andn2_b64 s[52:53], s[52:53], s[50:51]
    s_or_b64 s[80:81], s[80:81], s[52:53]
    s_not_b64 vcc, s[52:53]
    s_mov_b64 exec, -1
    v_cndmask_b32_dpp v84, v84, v84, vcc wave_shr:1 row_mask:0xf bank_mask:0xf
    v_cndmask_b32_dpp v85, v85, v85, vcc wave_shr:1 row_mask:0xf bank_mask:0xf
    s_lshr_b64 s[52:53], s[52:53], 1
    v_cndmask_b32_dpp v86, v86, v86, vcc wave_shr:1 row_mask:0xf bank_mask:0xf
    v_cndmask_b32_dpp v87, v87, v87, vcc wave_shr:1 row_mask:0xf bank_mask:0xf
    s_andn2_b64 s[82:83], s[82:83], s[52:53]
    v_cndmask_b32_dpp v7, v7, v7, vcc wave_shr:1 row_mask:0xf bank_mask:0xf
    s_mov_b64 exec, s[50:51]
    s_cbranch_scc0 L2_d147
    s_mov_b64 exec, s[82:83]
    s_nop 1
    v_mfma_f32_4x4x4_16b_bf16 v[88:91], v[12:13], v[84:85], 0
    s_nop 1
    v_mfma_f32_4x4x4_16b_bf16 v[88:91], v[10:11], v[86:87], v[88:91]
    s_nop 4
    v_cvt_pk_bf16_f32 v88, v88, v89
    v_cvt_pk_bf16_f32 v89, v90, v91
    ds_pk_add_bf16 v7, v88 offset:65408
    ds_pk_add_bf16 v7, v89 offset:65412
    s_mov_b64 exec, s[50:51]
    s_branch L2_d147
L2_c148:
    s_lshl_b64 s[52:53], s[82:83], 1
    s_andn2_b64 s[52:53], s[52:53], s[80:81]
    s_andn2_b64 s[52:53], s[52:53], s[54:55]
    s_or_b64 s[80:81], s[80:81], s[52:53]
    s_not_b64 vcc, s[52:53]
    s_mov_b64 exec, -1
    v_cndmask_b32_dpp v84, v84, v84, vcc wave_shr:1 row_mask:0xf bank_mask:0xf
    v_cndmask_b32_dpp v85, v85, v85, vcc wave_shr:1 row_mask:0xf bank_mask:0xf
    s_lshr_b64 s[52:53], s[52:53], 1
    v_cndmask_b32_dpp v86, v86, v86, vcc wave_shr:1 row_mask:0xf bank_mask:0xf
    v_cndmask_b32_dpp v87, v87, v87, vcc wave_shr:1 row_mask:0xf bank_mask:0xf
    s_andn2_b64 s[82:83], s[82:83], s[52:53]
    v_cndmask_b32_dpp v7, v7, v7, vcc wave_shr:1 row_mask:0xf bank_mask:0xf
    s_mov_b64 exec, s[54:55]
    s_cbranch_scc0 L2_d148
    s_mov_b64 exec, s[82:83]
    s_nop 1
    v_mfma_f32_4x4x4_16b_bf16 v[88:91], v[12:13], v[84:85], 0
    s_nop 1
    v_mfma_f32_4x4x4_16b_bf16 v[88:91], v[10:11], v[86:87], v[88:91]
    s_nop 4
    v_cvt_pk_bf16_f32 v88, v88, v89
    v_cvt_pk_bf16_f32 v89, v90, v91
    ds_pk_add_bf16 v7, v88 offset:65408
    ds_pk_add_bf16 v7, v89 offset:65412
    s_mov_b64 exec, s[54:55]
    s_branch L2_d148
L2_c149:
    s_lshl_b64 s[52:53], s[82:83], 1
    s_andn2_b64 s[52:53], s[52:53], s[80:81]
    s_andn2_b64 s[52:53], s[52:53], s[50:51]
    s_or_b64 s[80:81], s[80:81], s[52:53]
    s_not_b64 vcc, s[52:53]
    s_mov_b64 exec, -1
    v_cndmask_b32_dpp v84, v84, v84, vcc wave_shr:1 row_mask:0xf bank_mask:0xf
    v_cndmask_b32_dpp v85, v85, v85, vcc wave_shr:1 row_mask:0xf bank_mask:0xf
    s_lshr_b64 s[52:53], s[52:53], 1
    v_cndmask_b32_dpp v86, v86, v86, vcc wave_shr:1 row_mask:0xf bank_mask:0xf
    v_cndmask_b32_dpp v87, v87, v87, vcc wave_shr:1 row_mask:0xf bank_mask:0xf
    s_andn2_b64 s[82:83], s[82:83], s[52:53]
    v_cndmask_b32_dpp v7, v7, v7, vcc wave_shr:1 row_mask:0xf bank_mask:0xf
    s_mov_b64 exec, s[50:51]
    s_cbranch_scc0 L2_d149
    s_mov_b64 exec, s[82:83]
    s_nop 1
    v_mfma_f32_4x4x4_16b_bf16 v[88:91], v[12:13], v[84:85], 0
    s_nop 1
    v_mfma_f32_4x4x4_16b_bf16 v[88:91], v[10:11], v[86:87], v[88:91]
    s_nop 4
    v_cvt_pk_bf16_f32 v88, v88, v89
    v_cvt_pk_bf16_f32 v89, v90, v91
    ds_pk_add_bf16 v7, v88 offset:65408
    ds_pk_add_bf16 v7, v89 offset:65412
    s_mov_b64 exec, s[50:51]
    s_branch L2_d149
L2_c150:
    s_lshl_b64 s[52:53], s[82:83], 1
    s_andn2_b64 s[52:53], s[52:53], s[80:81]
    s_andn2_b64 s[52:53], s[52:53], s[54:55]
    s_or_b64 s[80:81], s[80:81], s[52:53]
    s_not_b64 vcc, s[52:53]
    s_mov_b64 exec, -1
    v_cndmask_b32_dpp v84, v84, v84, vcc wave_shr:1 row_mask:0xf bank_mask:0xf
    v_cndmask_b32_dpp v85, v85, v85, vcc wave_shr:1 row_mask:0xf bank_mask:0xf
    s_lshr_b64 s[52:53], s[52:53], 1
    v_cndmask_b32_dpp v86, v86, v86, vcc wave_shr:1 row_mask:0xf bank_mask:0xf
    v_cndmask_b32_dpp v87, v87, v87, vcc wave_shr:1 row_mask:0xf bank_mask:0xf
    s_andn2_b64 s[82:83], s[82:83], s[52:53]
    v_cndmask_b32_dpp v7, v7, v7, vcc wave_shr:1 row_mask:0xf bank_mask:0xf
    s_mov_b64 exec, s[54:55]
    s_cbranch_scc0 L2_d150
    s_mov_b64 exec, s[82:83]
    s_nop 1
    v_mfma_f32_4x4x4_16b_bf16 v[88:91], v[12:13], v[84:85], 0
    s_nop 1
    v_mfma_f32_4x4x4_16b_bf16 v[88:91], v[10:11], v[86:87], v[88:91]
    s_nop 4
    v_cvt_pk_bf16_f32 v88, v88, v89
    v_cvt_pk_bf16_f32 v89, v90, v91
    ds_pk_add_bf16 v7, v88 offset:65408
    ds_pk_add_bf16 v7, v89 offset:65412
    s_mov_b64 exec, s[54:55]
    s_branch L2_d150
L2_c151:
    s_lshl_b64 s[52:53], s[82:83], 1
    s_andn2_b64 s[52:53], s[52:53], s[80:81]
    s_andn2_b64 s[52:53], s[52:53], s[50:51]
    s_or_b64 s[80:81], s[80:81], s[52:53]
    s_not_b64 vcc, s[52:53]
    s_mov_b64 exec, -1
    v_cndmask_b32_dpp v84, v84, v84, vcc wave_shr:1 row_mask:0xf bank_mask:0xf
    v_cndmask_b32_dpp v85, v85, v85, vcc wave_shr:1 row_mask:0xf bank_mask:0xf
    s_lshr_b64 s[52:53], s[52:53], 1
    v_cndmask_b32_dpp v86, v86, v86, vcc wave_shr:1 row_mask:0xf bank_mask:0xf
    v_cndmask_b32_dpp v87, v87, v87, vcc wave_shr:1 row_mask:0xf bank_mask:0xf
    s_andn2_b64 s[82:83], s[82:83], s[52:53]
    v_cndmask_b32_dpp v7, v7, v7, vcc wave_shr:1 row_mask:0xf bank_mask:0xf
    s_mov_b64 exec, s[50:51]
    s_cbranch_scc0 L2_d151
    s_mov_b64 exec, s[82:83]
    s_nop 1
    v_mfma_f32_4x4x4_16b_bf16 v[88:91], v[12:13], v[84:85], 0
    s_nop 1
    v_mfma_f32_4x4x4_16b_bf16 v[88:91], v[10:11], v[86:87], v[88:91]
    s_nop 4
    v_cvt_pk_bf16_f32 v88, v88, v89
    v_cvt_pk_bf16_f32 v89, v90, v91
    ds_pk_add_bf16 v7, v88 offset:65408
    ds_pk_add_bf16 v7, v89 offset:65412
    s_mov_b64 exec, s[50:51]
    s_branch L2_d151
L2_c152:
    s_mov_b64 s[50:51], vcc
    s_lshl_b64 s[52:53], s[82:83], 1
    s_andn2_b64 s[52:53], s[52:53], s[80:81]
    s_andn2_b64 s[52:53], s[52:53], s[50:51]
    s_or_b64 s[80:81], s[80:81], s[52:53]
    s_not_b64 vcc, s[52:53]
    s_mov_b64 exec, -1
    v_cndmask_b32_dpp v84, v84, v84, vcc wave_shr:1 row_mask:0xf bank_mask:0xf
    v_cndmask_b32_dpp v85, v85, v85, vcc wave_shr:1 row_mask:0xf bank_mask:0xf
    s_lshr_b64 s[52:53], s[52:53], 1
    v_cndmask_b32_dpp v86, v86, v86, vcc wave_shr:1 row_mask:0xf bank_mask:0xf
    v_cndmask_b32_dpp v87, v87, v87, vcc wave_shr:1 row_mask:0xf bank_mask:0xf
    s_andn2_b64 s[82:83], s[82:83], s[52:53]
    v_cndmask_b32_dpp v7, v7, v7, vcc wave_shr:1 row_mask:0xf bank_mask:0xf
    s_mov_b64 vcc, s[50:51]
    s_mov_b64 exec, s[50:51]
    s_cbranch_scc0 L2_d152
    s_mov_b64 exec, s[82:83]
    s_nop 1
    v_mfma_f32_4x4x4_16b_bf16 v[88:91], v[12:13], v[84:85], 0
    s_nop 1
    v_mfma_f32_4x4x4_16b_bf16 v[88:91], v[10:11], v[86:87], v[88:91]
    s_nop 4
    v_cvt_pk_bf16_f32 v88, v88, v89
    v_cvt_pk_bf16_f32 v89, v90, v91
    ds_pk_add_bf16 v7, v88 offset:65408
    ds_pk_add_bf16 v7, v89 offset:65412
    s_mov_b64 exec, vcc
    s_branch L2_d152
L2_c153:
    s_mov_b64 s[50:51], vcc
    s_lshl_b64 s[52:53], s[82:83], 1
    s_andn2_b64 s[52:53], s[52:53], s[80:81]
    s_andn2_b64 s[52:53], s[52:53], s[50:51]
    s_or_b64 s[80:81], s[80:81], s[52:53]
    s_not_b64 vcc, s[52:53]
    s_mov_b64 exec, -1
    v_cndmask_b32_dpp v84, v84, v84, vcc wave_shr:1 row_mask:0xf bank_mask:0xf
    v_cndmask_b32_dpp v85, v85, v85, vcc wave_shr:1 row_mask:0xf bank_mask:0xf
    s_lshr_b64 s[52:53], s[52:53], 1
    v_cndmask_b32_dpp v86, v86, v86, vcc wave_shr:1 row_mask:0xf bank_mask:0xf
    v_cndmask_b32_dpp v87, v87, v87, vcc wave_shr:1 row_mask:0xf bank_mask:0xf
    s_andn2_b64 s[82:83], s[82:83], s[52:53]
    v_cndmask_b32_dpp v7, v7, v7, vcc wave_shr:1 row_mask:0xf bank_mask:0xf
    s_mov_b64 vcc, s[50:51]
    s_mov_b64 exec, s[50:51]
    s_cbranch_scc0 L2_d153
    s_mov_b64 exec, s[82:83]
    s_nop 1
    v_mfma_f32_4x4x4_16b_bf16 v[88:91], v[12:13], v[84:85], 0
    s_nop 1
    v_mfma_f32_4x4x4_16b_bf16 v[88:91], v[10:11], v[86:87], v[88:91]
    s_nop 4
    v_cvt_pk_bf16_f32 v88, v88, v89
    v_cvt_pk_bf16_f32 v89, v90, v91
    ds_pk_add_bf16 v7, v88 offset:65408
    ds_pk_add_bf16 v7, v89 offset:65412
    s_mov_b64 exec, vcc
    s_branch L2_d153
L2_f3s:
    s_branch L2_f3
.section .rodata,"a"
.p2align 6
.amdhsa_kernel gather_scatter__molecular_angular_gemnet__graph_kernel
  .amdhsa_next_free_vgpr 128
  .amdhsa_next_free_sgpr 102
  .amdhsa_accum_offset 128
  .amdhsa_group_segment_fixed_size 0
  .amdhsa_kernarg_size 112
  .amdhsa_user_sgpr_count 2
  .amdhsa_user_sgpr_kernarg_segment_ptr 1
  .amdhsa_system_sgpr_workgroup_id_x 1
  .amdhsa_float_denorm_mode_32 3
.end_amdhsa_kernel
```

```asm
; @launch grid=(256,1,1) block=(1024,1,1) lds=163840
.amdgcn_target "amdgcn-amd-amdhsa--gfx950"
.text
.globl gather_scatter__molecular_angular_gemnet__graph_kernel
.p2align 8
.type gather_scatter__molecular_angular_gemnet__graph_kernel,@function
gather_scatter__molecular_angular_gemnet__graph_kernel:
    s_cmp_ge_u32 s2, 256
    s_cbranch_scc0 L1_go
    s_endpgm
L1_go:
    s_load_dwordx4 s[4:7], s[0:1], 8
    s_load_dwordx2 s[28:29], s[0:1], 32
    s_load_dwordx2 s[30:31], s[0:1], 104
    s_load_dwordx2 s[56:57], s[0:1], 96
    s_load_dwordx2 s[86:87], s[0:1], 0
    s_load_dwordx4 s[60:63], s[0:1], 56
    s_load_dwordx4 s[64:67], s[0:1], 72
    v_lshrrev_b32 v7, 6, v0
    v_lshlrev_b32 v1, 3, v0
    v_readfirstlane_b32 s32, v7
    v_lshlrev_b32 v0, 4, v0
    v_and_b32 v1, 0x1f8, v1
    v_lshlrev_b32 v15, 1, v1
    s_lshr_b32 s3, s32, 1
    s_and_b32 s44, s32, 1
    s_lshl_b32 s44, s44, 3
    s_or_b32 s3, s3, s44
    s_lshl_b32 s3, s3, 10
    s_lshl_b32 s96, s2, 14
    s_add_u32 s96, s96, s3
    s_lshr_b32 s3, s32, 1
    s_and_b32 s44, s32, 1
    s_lshl_b32 s44, s44, 3
    s_or_b32 s3, s3, s44
    s_lshl_b32 s3, s3, 10
    s_lshl_b32 s97, s2, 14
    s_add_u32 s97, s97, s3
    s_lshr_b32 s3, s32, 1
    s_and_b32 s44, s32, 1
    s_lshl_b32 s44, s44, 3
    s_or_b32 s3, s3, s44
    s_lshl_b32 s3, s3, 10
    s_lshl_b32 s98, s2, 14
    s_add_u32 s98, s98, s3
    s_lshr_b32 s3, s32, 1
    s_and_b32 s44, s32, 1
    s_lshl_b32 s44, s44, 3
    s_or_b32 s3, s3, s44
    s_lshl_b32 s3, s3, 10
    s_lshl_b32 s99, s2, 14
    s_add_u32 s99, s99, s3
    s_waitcnt lgkmcnt(0)
    s_mov_b32 s8, s4
    s_mov_b32 s9, s5
    s_mov_b32 s10, 0x9c40000
    s_mov_b32 s11, 0x20000
    s_mov_b32 s12, s6
    s_mov_b32 s13, s7
    s_mov_b32 s14, 0x9c40000
    s_mov_b32 s15, 0x20000
    s_mov_b32 s16, s28
    s_mov_b32 s17, s29
    s_mov_b32 s18, 0x4e20000
    s_mov_b32 s19, 0x20000
    s_mov_b32 s68, s62
    s_mov_b32 s69, s63
    s_mov_b32 s70, 0x40
    s_mov_b32 s71, 0x20000
    s_mov_b32 s72, s60
    s_mov_b32 s73, s61
    s_mov_b32 s74, 0x40
    s_mov_b32 s75, 0x20000
    s_mov_b32 s20, s66
    s_mov_b32 s21, s67
    s_mov_b32 s22, 0x20
    s_mov_b32 s23, 0x20000
    s_mov_b32 s80, s64
    s_mov_b32 s81, s65
    s_mov_b32 s82, 0x20
    s_mov_b32 s83, 0x20000
    s_add_u32 s24, s30, 0xec45000
    s_addc_u32 s25, s31, 0
    s_mov_b32 s26, 0x100
    s_mov_b32 s27, 0x20000
    v_lshrrev_b32 v2, 3, v0
    v_and_b32 v2, 6, v2
    v_lshlrev_b32 v3, 2, v0
    s_lshl_b32 s3, s32, 8
    s_add_u32 s3, s3, s2
    s_cmp_lg_u32 s3, 254
    s_cbranch_scc1 L1_wt
    buffer_load_ushort v96, v2, s[68:71], 0 offen offset:0
    buffer_load_ushort v108, v2, s[68:71], 0 offen offset:8
    buffer_load_ushort v97, v2, s[68:71], 0 offen offset:16
    buffer_load_ushort v109, v2, s[68:71], 0 offen offset:24
    buffer_load_ushort v98, v2, s[68:71], 0 offen offset:32
    buffer_load_ushort v110, v2, s[68:71], 0 offen offset:40
    buffer_load_ushort v99, v2, s[68:71], 0 offen offset:48
    buffer_load_ushort v111, v2, s[68:71], 0 offen offset:56
    buffer_load_ushort v100, v2, s[72:75], 0 offen offset:0
    buffer_load_ushort v112, v2, s[72:75], 0 offen offset:8
    buffer_load_ushort v101, v2, s[72:75], 0 offen offset:16
    buffer_load_ushort v113, v2, s[72:75], 0 offen offset:24
    buffer_load_ushort v102, v2, s[72:75], 0 offen offset:32
    buffer_load_ushort v114, v2, s[72:75], 0 offen offset:40
    buffer_load_ushort v103, v2, s[72:75], 0 offen offset:48
    buffer_load_ushort v115, v2, s[72:75], 0 offen offset:56
    buffer_load_ushort v104, v2, s[20:23], 0 offen offset:0
    buffer_load_ushort v116, v2, s[20:23], 0 offen offset:8
    buffer_load_ushort v105, v2, s[20:23], 0 offen offset:16
    buffer_load_ushort v117, v2, s[20:23], 0 offen offset:24
    buffer_load_ushort v106, v2, s[80:83], 0 offen offset:0
    buffer_load_ushort v118, v2, s[80:83], 0 offen offset:8
    buffer_load_ushort v107, v2, s[80:83], 0 offen offset:16
    buffer_load_ushort v119, v2, s[80:83], 0 offen offset:24
    s_waitcnt vmcnt(0)
    v_lshl_or_b32 v96, v108, 16, v96
    v_lshl_or_b32 v97, v109, 16, v97
    v_lshl_or_b32 v98, v110, 16, v98
    v_lshl_or_b32 v99, v111, 16, v99
    v_lshl_or_b32 v100, v112, 16, v100
    v_lshl_or_b32 v101, v113, 16, v101
    v_lshl_or_b32 v102, v114, 16, v102
    v_lshl_or_b32 v103, v115, 16, v103
    v_lshl_or_b32 v104, v116, 16, v104
    v_lshl_or_b32 v105, v117, 16, v105
    v_lshl_or_b32 v106, v118, 16, v106
    v_lshl_or_b32 v107, v119, 16, v107
    buffer_store_dwordx4 v[96:99], v3, s[24:27], 0 offen offset:0 sc1
    buffer_store_dwordx4 v[100:103], v3, s[24:27], 0 offen offset:16 sc1
    buffer_store_dwordx4 v[104:107], v3, s[24:27], 0 offen offset:32 sc1
L1_wt:
    s_nop 1
    s_add_u32 s44, s96, 0x0
    v_lshlrev_b32 v16, 1, v1
    buffer_load_dwordx4 v[16:19], v16, s[8:11], s44 offen nt
    s_add_u32 s45, s96, 0x0
    v_lshlrev_b32 v20, 1, v1
    buffer_load_dwordx4 v[20:23], v20, s[12:15], s45 offen nt
    s_add_u32 s46, s96, 0x0
    s_lshr_b32 s46, s46, 1
    buffer_load_dwordx2 v[24:25], v1, s[16:19], s46 offen nt
    s_add_u32 s47, s97, 0x400000
    s_lshr_b32 s47, s47, 1
    buffer_load_dwordx2 v[26:27], v1, s[16:19], s47 offen nt
    s_add_u32 s44, s97, 0x400000
    v_lshlrev_b32 v28, 1, v1
    buffer_load_dwordx4 v[28:31], v28, s[8:11], s44 offen nt
    s_add_u32 s45, s97, 0x400000
    v_lshlrev_b32 v32, 1, v1
    buffer_load_dwordx4 v[32:35], v32, s[12:15], s45 offen nt
    s_add_u32 s46, s98, 0x800000
    v_lshlrev_b32 v36, 1, v1
    buffer_load_dwordx4 v[36:39], v36, s[8:11], s46 offen nt
    s_add_u32 s47, s98, 0x800000
    v_lshlrev_b32 v40, 1, v1
    buffer_load_dwordx4 v[40:43], v40, s[12:15], s47 offen nt
    s_add_u32 s44, s98, 0x800000
    s_lshr_b32 s44, s44, 1
    buffer_load_dwordx2 v[44:45], v1, s[16:19], s44 offen nt
    s_add_u32 s45, s99, 0xc00000
    s_lshr_b32 s45, s45, 1
    buffer_load_dwordx2 v[46:47], v1, s[16:19], s45 offen nt
    s_mov_b32 s20, s30
    s_mov_b32 s21, s31
    s_mov_b32 s22, 0xd344000
    s_mov_b32 s23, 0x20000
    s_add_u32 s24, s30, 0x2c000
    s_addc_u32 s25, s31, 0
    s_mov_b32 s26, 0xd318000
    s_mov_b32 s27, 0x20000
    s_add_u32 s3, s32, 0
    s_mul_i32 s4, s3, 205
    s_lshr_b32 s4, s4, 10
    s_mul_i32 s5, s4, 5
    s_sub_u32 s5, s3, s5
    s_lshl_b32 s5, s5, 5
    s_add_u32 s4, s4, s5
    s_sub_u32 s4, s4, s32
    s_lshl_b32 s72, s4, 10
    s_add_u32 s3, s32, 16
    s_mul_i32 s4, s3, 205
    s_lshr_b32 s4, s4, 10
    s_mul_i32 s5, s4, 5
    s_sub_u32 s5, s3, s5
    s_lshl_b32 s5, s5, 5
    s_add_u32 s4, s4, s5
    s_sub_u32 s4, s4, s32
    s_lshl_b32 s73, s4, 10
    s_add_u32 s3, s32, 32
    s_mul_i32 s4, s3, 205
    s_lshr_b32 s4, s4, 10
    s_mul_i32 s5, s4, 5
    s_sub_u32 s5, s3, s5
    s_lshl_b32 s5, s5, 5
    s_add_u32 s4, s4, s5
    s_sub_u32 s4, s4, s32
    s_lshl_b32 s85, s4, 10
    s_add_u32 s3, s32, 48
    s_mul_i32 s4, s3, 205
    s_lshr_b32 s4, s4, 10
    s_mul_i32 s5, s4, 5
    s_sub_u32 s5, s3, s5
    s_lshl_b32 s5, s5, 5
    s_add_u32 s4, s4, s5
    s_sub_u32 s4, s4, s32
    s_lshl_b32 s91, s4, 10
    s_add_u32 s3, s32, 64
    s_mul_i32 s4, s3, 205
    s_lshr_b32 s4, s4, 10
    s_mul_i32 s5, s4, 5
    s_sub_u32 s5, s3, s5
    s_lshl_b32 s5, s5, 5
    s_add_u32 s4, s4, s5
    s_sub_u32 s4, s4, s32
    s_lshl_b32 s93, s4, 10
    s_mov_b32 s80, s86
    s_mov_b32 s81, s87
    s_mov_b32 s82, 0x4e2000
    s_mov_b32 s83, 0x20000
    s_mul_i32 s35, s2, 173056
    s_and_b32 s37, s32, 3
    s_lshl_b32 s37, s37, 3
    s_mov_b32 s36, s37
    s_lshr_b32 s37, s32, 2
    s_mul_i32 s37, s37, 2080
    s_add_u32 s36, s36, s37
    s_and_b32 s37, s2, 3
    s_lshl_b32 s37, s37, 5
    s_add_u32 s36, s36, s37
    s_mul_i32 s4, s2, 5
    s_add_u32 s4, s4, 8192
    s_lshl_b32 s38, s4, 14
    s_lshl_b32 s39, s4, 13
    v_mov_b32 v2, 1
    v_mov_b32 v4, 0x80000007
    v_mov_b32 v5, 0xfc
    v_mov_b32 v6, 0x78
    s_mov_b32 s40, 16512
    s_mov_b32 s55, -10000
    s_mov_b32 s41, 0x010c0c01
    s_mov_b32 s42, 0x030c0c03
    v_mov_b32 v8, 0
    v_mov_b32 v9, 0
    v_mov_b32 v10, 0
    v_mov_b32 v11, 0
    ds_write_b128 v0, v[8:11]
    s_add_u32 s60, s30, 0xec4e000
    s_addc_u32 s61, s31, 0
    s_mov_b32 s62, 0x8000
    s_mov_b32 s63, 0x20000
    s_mov_b64 s[66:67], s[56:57]
    s_lshl_b32 s57, s2, 7
    s_add_u32 s68, s30, 0xec46000
    s_addc_u32 s69, s31, 0
    s_mov_b32 s70, 0x80
    s_mov_b32 s71, 0x20000
    s_lshl_b32 s3, s2, 7
    s_add_u32 s68, s68, s3
    s_addc_u32 s69, s69, 0
    s_cmp_lg_u32 s32, 0
    s_cbranch_scc1 L1_fl
    buffer_store_dwordx4 v[8:11], v0, s[68:71], 0 offen sc1
    s_mov_b64 exec, 0xff
    buffer_store_dwordx4 v[8:11], v0, s[60:63], s57 offen sc1
    s_mov_b64 exec, -1
L1_fl:
    s_waitcnt lgkmcnt(0)
    s_barrier
    s_setprio 3
    s_add_u32 s46, s99, 0xc00000
    v_lshlrev_b32 v48, 1, v1
    buffer_load_dwordx4 v[48:51], v48, s[8:11], s46 offen nt
    s_add_u32 s47, s99, 0xc00000
    v_lshlrev_b32 v52, 1, v1
    buffer_load_dwordx4 v[52:55], v52, s[12:15], s47 offen nt
    s_waitcnt vmcnt(8)
    v_lshlrev_b32 v7, 16, v24
    v_and_b32 v8, 0xffff0000, v24
    v_lshlrev_b32 v9, 16, v25
    v_and_b32 v10, 0xffff0000, v25
    v_mul_f32 v7, 0.15915494, v7
    v_mul_f32 v8, 0.15915494, v8
    v_mul_f32 v9, 0.15915494, v9
    v_mul_f32 v10, 0.15915494, v10
    v_mul_hi_u32_u24 v14, 429497, v16
    v_lshrrev_b32 v12, 3, v20
    v_cos_f32 v7, v7
    v_lshlrev_b16 v13, 3, v20
    v_mad_i32_i24 v11, v14, s55, v16
    v_bitop3_b32 v12, v6, v13, v12 bitop3:0xca
    v_lshl_add_u32 v11, v11, 17, s40
    v_lshlrev_b16 v14, 8, v14
    v_lshrrev_b32 v13, 2, v20
    v_add_u32 v16, v12, v11
    v_bitop3_b32 v20, v5, v13, v14 bitop3:0xea
    ds_add_u32 v20, v2
    v_mul_hi_u32_u24 v14, 429497, v17
    v_lshrrev_b32 v12, 3, v21
    v_cos_f32 v8, v8
    v_lshlrev_b16 v13, 3, v21
    v_mad_i32_i24 v11, v14, s55, v17
    v_bitop3_b32 v12, v6, v13, v12 bitop3:0xca
    v_lshl_add_u32 v11, v11, 17, s40
    v_lshlrev_b16 v14, 8, v14
    v_lshrrev_b32 v13, 2, v21
    v_add_u32 v17, v12, v11
    v_bitop3_b32 v21, v5, v13, v14 bitop3:0xea
    ds_add_u32 v21, v2
    v_cvt_pk_bf16_f32 v24, v7, v8
    v_perm_b32 v12, v24, v24, s41
    v_bitop3_b32 v16, v4, v12, v16 bitop3:0xca
    v_perm_b32 v13, v24, v24, s42
    v_bitop3_b32 v17, v4, v13, v17 bitop3:0xca
    v_mul_hi_u32_u24 v14, 429497, v18
    v_lshrrev_b32 v12, 3, v22
    v_cos_f32 v9, v9
    v_lshlrev_b16 v13, 3, v22
    v_mad_i32_i24 v11, v14, s55, v18
    v_bitop3_b32 v12, v6, v13, v12 bitop3:0xca
    v_lshl_add_u32 v11, v11, 17, s40
    v_lshlrev_b16 v14, 8, v14
    v_lshrrev_b32 v13, 2, v22
    v_add_u32 v18, v12, v11
    v_bitop3_b32 v22, v5, v13, v14 bitop3:0xea
    ds_add_u32 v22, v2
    v_mul_hi_u32_u24 v14, 429497, v19
    v_lshrrev_b32 v12, 3, v23
    v_cos_f32 v10, v10
    v_lshlrev_b16 v13, 3, v23
    v_mad_i32_i24 v11, v14, s55, v19
    v_bitop3_b32 v12, v6, v13, v12 bitop3:0xca
    v_lshl_add_u32 v11, v11, 17, s40
    v_lshlrev_b16 v14, 8, v14
    v_lshrrev_b32 v13, 2, v23
    v_add_u32 v19, v12, v11
    v_bitop3_b32 v23, v5, v13, v14 bitop3:0xea
    ds_add_u32 v23, v2
    v_cvt_pk_bf16_f32 v25, v9, v10
    v_perm_b32 v12, v25, v25, s41
    v_bitop3_b32 v18, v4, v12, v18 bitop3:0xca
    v_perm_b32 v13, v25, v25, s42
    v_bitop3_b32 v19, v4, v13, v19 bitop3:0xca
    s_add_u32 s44, s96, 0x1000000
    v_lshlrev_b32 v56, 1, v1
    buffer_load_dwordx4 v[56:59], v56, s[8:11], s44 offen nt
    s_add_u32 s45, s96, 0x1000000
    v_lshlrev_b32 v60, 1, v1
    buffer_load_dwordx4 v[60:63], v60, s[12:15], s45 offen nt
    s_add_u32 s46, s96, 0x1000000
    s_lshr_b32 s46, s46, 1
    buffer_load_dwordx2 v[64:65], v1, s[16:19], s46 offen nt
    s_add_u32 s47, s97, 0x1400000
    s_lshr_b32 s47, s47, 1
    buffer_load_dwordx2 v[66:67], v1, s[16:19], s47 offen nt
    s_waitcnt vmcnt(10)
    v_lshlrev_b32 v7, 16, v26
    v_and_b32 v8, 0xffff0000, v26
    v_lshlrev_b32 v9, 16, v27
    v_and_b32 v10, 0xffff0000, v27
    v_mul_f32 v7, 0.15915494, v7
    v_mul_f32 v8, 0.15915494, v8
    v_mul_f32 v9, 0.15915494, v9
    v_mul_f32 v10, 0.15915494, v10
    v_mul_hi_u32_u24 v14, 429497, v28
    v_lshrrev_b32 v12, 3, v32
    v_cos_f32 v7, v7
    v_lshlrev_b16 v13, 3, v32
    v_mad_i32_i24 v11, v14, s55, v28
    v_bitop3_b32 v12, v6, v13, v12 bitop3:0xca
    v_lshl_add_u32 v11, v11, 17, s40
    v_lshlrev_b16 v14, 8, v14
    v_lshrrev_b32 v13, 2, v32
    v_add_u32 v28, v12, v11
    v_bitop3_b32 v32, v5, v13, v14 bitop3:0xea
    ds_add_u32 v32, v2
    v_mul_hi_u32_u24 v14, 429497, v29
    v_lshrrev_b32 v12, 3, v33
    v_cos_f32 v8, v8
    v_lshlrev_b16 v13, 3, v33
    v_mad_i32_i24 v11, v14, s55, v29
    v_bitop3_b32 v12, v6, v13, v12 bitop3:0xca
    v_lshl_add_u32 v11, v11, 17, s40
    v_lshlrev_b16 v14, 8, v14
    v_lshrrev_b32 v13, 2, v33
    v_add_u32 v29, v12, v11
    v_bitop3_b32 v33, v5, v13, v14 bitop3:0xea
    ds_add_u32 v33, v2
    v_cvt_pk_bf16_f32 v26, v7, v8
    v_perm_b32 v12, v26, v26, s41
    v_bitop3_b32 v28, v4, v12, v28 bitop3:0xca
    v_perm_b32 v13, v26, v26, s42
    v_bitop3_b32 v29, v4, v13, v29 bitop3:0xca
    v_mul_hi_u32_u24 v14, 429497, v30
    v_lshrrev_b32 v12, 3, v34
    v_cos_f32 v9, v9
    v_lshlrev_b16 v13, 3, v34
    v_mad_i32_i24 v11, v14, s55, v30
    v_bitop3_b32 v12, v6, v13, v12 bitop3:0xca
    v_lshl_add_u32 v11, v11, 17, s40
    v_lshlrev_b16 v14, 8, v14
    v_lshrrev_b32 v13, 2, v34
    v_add_u32 v30, v12, v11
    v_bitop3_b32 v34, v5, v13, v14 bitop3:0xea
    ds_add_u32 v34, v2
    v_mul_hi_u32_u24 v14, 429497, v31
    v_lshrrev_b32 v12, 3, v35
    v_cos_f32 v10, v10
    v_lshlrev_b16 v13, 3, v35
    v_mad_i32_i24 v11, v14, s55, v31
    v_bitop3_b32 v12, v6, v13, v12 bitop3:0xca
    v_lshl_add_u32 v11, v11, 17, s40
    v_lshlrev_b16 v14, 8, v14
    v_lshrrev_b32 v13, 2, v35
    v_add_u32 v31, v12, v11
    v_bitop3_b32 v35, v5, v13, v14 bitop3:0xea
    ds_add_u32 v35, v2
    v_cvt_pk_bf16_f32 v27, v9, v10
    v_perm_b32 v12, v27, v27, s41
    v_bitop3_b32 v30, v4, v12, v30 bitop3:0xca
    v_perm_b32 v13, v27, v27, s42
    v_bitop3_b32 v31, v4, v13, v31 bitop3:0xca
    s_setprio 2
    s_add_u32 s44, s97, 0x1400000
    v_lshlrev_b32 v68, 1, v1
    buffer_load_dwordx4 v[68:71], v68, s[8:11], s44 offen nt
    s_add_u32 s45, s97, 0x1400000
    v_lshlrev_b32 v72, 1, v1
    buffer_load_dwordx4 v[72:75], v72, s[12:15], s45 offen nt
    s_waitcnt vmcnt(8)
    v_lshlrev_b32 v7, 16, v44
    v_and_b32 v8, 0xffff0000, v44
    v_lshlrev_b32 v9, 16, v45
    v_and_b32 v10, 0xffff0000, v45
    v_mul_f32 v7, 0.15915494, v7
    v_mul_f32 v8, 0.15915494, v8
    v_mul_f32 v9, 0.15915494, v9
    v_mul_f32 v10, 0.15915494, v10
    v_mul_hi_u32_u24 v14, 429497, v36
    v_lshrrev_b32 v12, 3, v40
    v_cos_f32 v7, v7
    v_lshlrev_b16 v13, 3, v40
    v_mad_i32_i24 v11, v14, s55, v36
    v_bitop3_b32 v12, v6, v13, v12 bitop3:0xca
    v_lshl_add_u32 v11, v11, 17, s40
    v_lshlrev_b16 v14, 8, v14
    v_lshrrev_b32 v13, 2, v40
    v_add_u32 v36, v12, v11
    v_bitop3_b32 v40, v5, v13, v14 bitop3:0xea
    ds_add_u32 v40, v2
    v_mul_hi_u32_u24 v14, 429497, v37
    v_lshrrev_b32 v12, 3, v41
    v_cos_f32 v8, v8
    v_lshlrev_b16 v13, 3, v41
    v_mad_i32_i24 v11, v14, s55, v37
    v_bitop3_b32 v12, v6, v13, v12 bitop3:0xca
    v_lshl_add_u32 v11, v11, 17, s40
    v_lshlrev_b16 v14, 8, v14
    v_lshrrev_b32 v13, 2, v41
    v_add_u32 v37, v12, v11
    v_bitop3_b32 v41, v5, v13, v14 bitop3:0xea
    ds_add_u32 v41, v2
    v_cvt_pk_bf16_f32 v44, v7, v8
    v_perm_b32 v12, v44, v44, s41
    v_bitop3_b32 v36, v4, v12, v36 bitop3:0xca
    v_perm_b32 v13, v44, v44, s42
    v_bitop3_b32 v37, v4, v13, v37 bitop3:0xca
    v_mul_hi_u32_u24 v14, 429497, v38
    v_lshrrev_b32 v12, 3, v42
    v_cos_f32 v9, v9
    v_lshlrev_b16 v13, 3, v42
    v_mad_i32_i24 v11, v14, s55, v38
    v_bitop3_b32 v12, v6, v13, v12 bitop3:0xca
    v_lshl_add_u32 v11, v11, 17, s40
    v_lshlrev_b16 v14, 8, v14
    v_lshrrev_b32 v13, 2, v42
    v_add_u32 v38, v12, v11
    v_bitop3_b32 v42, v5, v13, v14 bitop3:0xea
    ds_add_u32 v42, v2
    v_mul_hi_u32_u24 v14, 429497, v39
    v_lshrrev_b32 v12, 3, v43
    v_cos_f32 v10, v10
    v_lshlrev_b16 v13, 3, v43
    v_mad_i32_i24 v11, v14, s55, v39
    v_bitop3_b32 v12, v6, v13, v12 bitop3:0xca
    v_lshl_add_u32 v11, v11, 17, s40
    v_lshlrev_b16 v14, 8, v14
    v_lshrrev_b32 v13, 2, v43
    v_add_u32 v39, v12, v11
    v_bitop3_b32 v43, v5, v13, v14 bitop3:0xea
    ds_add_u32 v43, v2
    v_cvt_pk_bf16_f32 v45, v9, v10
    v_perm_b32 v12, v45, v45, s41
    v_bitop3_b32 v38, v4, v12, v38 bitop3:0xca
    v_perm_b32 v13, v45, v45, s42
    v_bitop3_b32 v39, v4, v13, v39 bitop3:0xca
    s_add_u32 s46, s98, 0x1800000
    v_lshlrev_b32 v76, 1, v1
    buffer_load_dwordx4 v[76:79], v76, s[8:11], s46 offen nt
    s_add_u32 s47, s98, 0x1800000
    v_lshlrev_b32 v80, 1, v1
    buffer_load_dwordx4 v[80:83], v80, s[12:15], s47 offen nt
    s_add_u32 s44, s98, 0x1800000
    s_lshr_b32 s44, s44, 1
    buffer_load_dwordx2 v[84:85], v1, s[16:19], s44 offen nt
    s_add_u32 s45, s99, 0x1c00000
    s_lshr_b32 s45, s45, 1
    buffer_load_dwordx2 v[86:87], v1, s[16:19], s45 offen nt
    s_waitcnt vmcnt(10)
    v_lshlrev_b32 v7, 16, v46
    v_and_b32 v8, 0xffff0000, v46
    v_lshlrev_b32 v9, 16, v47
    v_and_b32 v10, 0xffff0000, v47
    v_mul_f32 v7, 0.15915494, v7
    v_mul_f32 v8, 0.15915494, v8
    v_mul_f32 v9, 0.15915494, v9
    v_mul_f32 v10, 0.15915494, v10
    v_mul_hi_u32_u24 v14, 429497, v48
    v_lshrrev_b32 v12, 3, v52
    v_cos_f32 v7, v7
    v_lshlrev_b16 v13, 3, v52
    v_mad_i32_i24 v11, v14, s55, v48
    v_bitop3_b32 v12, v6, v13, v12 bitop3:0xca
    v_lshl_add_u32 v11, v11, 17, s40
    v_lshlrev_b16 v14, 8, v14
    v_lshrrev_b32 v13, 2, v52
    v_add_u32 v48, v12, v11
    v_bitop3_b32 v52, v5, v13, v14 bitop3:0xea
    ds_add_u32 v52, v2
    v_mul_hi_u32_u24 v14, 429497, v49
    v_lshrrev_b32 v12, 3, v53
    v_cos_f32 v8, v8
    v_lshlrev_b16 v13, 3, v53
    v_mad_i32_i24 v11, v14, s55, v49
    v_bitop3_b32 v12, v6, v13, v12 bitop3:0xca
    v_lshl_add_u32 v11, v11, 17, s40
    v_lshlrev_b16 v14, 8, v14
    v_lshrrev_b32 v13, 2, v53
    v_add_u32 v49, v12, v11
    v_bitop3_b32 v53, v5, v13, v14 bitop3:0xea
    ds_add_u32 v53, v2
    v_cvt_pk_bf16_f32 v46, v7, v8
    v_perm_b32 v12, v46, v46, s41
    v_bitop3_b32 v48, v4, v12, v48 bitop3:0xca
    v_perm_b32 v13, v46, v46, s42
    v_bitop3_b32 v49, v4, v13, v49 bitop3:0xca
    v_mul_hi_u32_u24 v14, 429497, v50
    v_lshrrev_b32 v12, 3, v54
    v_cos_f32 v9, v9
    v_lshlrev_b16 v13, 3, v54
    v_mad_i32_i24 v11, v14, s55, v50
    v_bitop3_b32 v12, v6, v13, v12 bitop3:0xca
    v_lshl_add_u32 v11, v11, 17, s40
    v_lshlrev_b16 v14, 8, v14
    v_lshrrev_b32 v13, 2, v54
    v_add_u32 v50, v12, v11
    v_bitop3_b32 v54, v5, v13, v14 bitop3:0xea
    ds_add_u32 v54, v2
    v_mul_hi_u32_u24 v14, 429497, v51
    v_lshrrev_b32 v12, 3, v55
    v_cos_f32 v10, v10
    v_lshlrev_b16 v13, 3, v55
    v_mad_i32_i24 v11, v14, s55, v51
    v_bitop3_b32 v12, v6, v13, v12 bitop3:0xca
    v_lshl_add_u32 v11, v11, 17, s40
    v_lshlrev_b16 v14, 8, v14
    v_lshrrev_b32 v13, 2, v55
    v_add_u32 v51, v12, v11
    v_bitop3_b32 v55, v5, v13, v14 bitop3:0xea
    ds_add_u32 v55, v2
    v_cvt_pk_bf16_f32 v47, v9, v10
    v_perm_b32 v12, v47, v47, s41
    v_bitop3_b32 v50, v4, v12, v50 bitop3:0xca
    v_perm_b32 v13, v47, v47, s42
    v_bitop3_b32 v51, v4, v13, v51 bitop3:0xca
    s_setprio 1
    s_add_u32 s46, s99, 0x1c00000
    v_lshlrev_b32 v88, 1, v1
    buffer_load_dwordx4 v[88:91], v88, s[8:11], s46 offen nt
    s_add_u32 s47, s99, 0x1c00000
    v_lshlrev_b32 v92, 1, v1
    buffer_load_dwordx4 v[92:95], v92, s[12:15], s47 offen nt
    s_waitcnt vmcnt(8)
    v_lshlrev_b32 v7, 16, v64
    v_and_b32 v8, 0xffff0000, v64
    v_lshlrev_b32 v9, 16, v65
    v_and_b32 v10, 0xffff0000, v65
    v_mul_f32 v7, 0.15915494, v7
    v_mul_f32 v8, 0.15915494, v8
    v_mul_f32 v9, 0.15915494, v9
    v_mul_f32 v10, 0.15915494, v10
    v_mul_hi_u32_u24 v14, 429497, v56
    v_lshrrev_b32 v12, 3, v60
    v_cos_f32 v7, v7
    v_lshlrev_b16 v13, 3, v60
    v_mad_i32_i24 v11, v14, s55, v56
    v_bitop3_b32 v12, v6, v13, v12 bitop3:0xca
    v_lshl_add_u32 v11, v11, 17, s40
    v_lshlrev_b16 v14, 8, v14
    v_lshrrev_b32 v13, 2, v60
    v_add_u32 v56, v12, v11
    v_bitop3_b32 v60, v5, v13, v14 bitop3:0xea
    ds_add_u32 v60, v2
    v_mul_hi_u32_u24 v14, 429497, v57
    v_lshrrev_b32 v12, 3, v61
    v_cos_f32 v8, v8
    v_lshlrev_b16 v13, 3, v61
    v_mad_i32_i24 v11, v14, s55, v57
    v_bitop3_b32 v12, v6, v13, v12 bitop3:0xca
    v_lshl_add_u32 v11, v11, 17, s40
    v_lshlrev_b16 v14, 8, v14
    v_lshrrev_b32 v13, 2, v61
    v_add_u32 v57, v12, v11
    v_bitop3_b32 v61, v5, v13, v14 bitop3:0xea
    ds_add_u32 v61, v2
    v_cvt_pk_bf16_f32 v64, v7, v8
    v_perm_b32 v12, v64, v64, s41
    v_bitop3_b32 v56, v4, v12, v56 bitop3:0xca
    v_perm_b32 v13, v64, v64, s42
    v_bitop3_b32 v57, v4, v13, v57 bitop3:0xca
    v_mul_hi_u32_u24 v14, 429497, v58
    v_lshrrev_b32 v12, 3, v62
    v_cos_f32 v9, v9
    v_lshlrev_b16 v13, 3, v62
    v_mad_i32_i24 v11, v14, s55, v58
    v_bitop3_b32 v12, v6, v13, v12 bitop3:0xca
    v_lshl_add_u32 v11, v11, 17, s40
    v_lshlrev_b16 v14, 8, v14
    v_lshrrev_b32 v13, 2, v62
    v_add_u32 v58, v12, v11
    v_bitop3_b32 v62, v5, v13, v14 bitop3:0xea
    ds_add_u32 v62, v2
    v_mul_hi_u32_u24 v14, 429497, v59
    v_lshrrev_b32 v12, 3, v63
    v_cos_f32 v10, v10
    v_lshlrev_b16 v13, 3, v63
    v_mad_i32_i24 v11, v14, s55, v59
    v_bitop3_b32 v12, v6, v13, v12 bitop3:0xca
    v_lshl_add_u32 v11, v11, 17, s40
    v_lshlrev_b16 v14, 8, v14
    v_lshrrev_b32 v13, 2, v63
    v_add_u32 v59, v12, v11
    v_bitop3_b32 v63, v5, v13, v14 bitop3:0xea
    ds_add_u32 v63, v2
    v_cvt_pk_bf16_f32 v65, v9, v10
    v_perm_b32 v12, v65, v65, s41
    v_bitop3_b32 v58, v4, v12, v58 bitop3:0xca
    v_perm_b32 v13, v65, v65, s42
    v_bitop3_b32 v59, v4, v13, v59 bitop3:0xca
    s_add_u32 s44, s96, 0x2000000
    v_lshlrev_b32 v96, 1, v1
    buffer_load_dwordx4 v[96:99], v96, s[8:11], s44 offen nt
    s_add_u32 s45, s96, 0x2000000
    v_lshlrev_b32 v104, 1, v1
    buffer_load_dwordx4 v[104:107], v104, s[12:15], s45 offen nt
    s_add_u32 s46, s96, 0x2000000
    s_lshr_b32 s46, s46, 1
    buffer_load_dwordx2 v[108:109], v1, s[16:19], s46 offen nt
    s_add_u32 s47, s97, 0x2400000
    s_lshr_b32 s47, s47, 1
    buffer_load_dwordx2 v[110:111], v1, s[16:19], s47 offen nt
    s_waitcnt vmcnt(10)
    v_lshlrev_b32 v7, 16, v66
    v_and_b32 v8, 0xffff0000, v66
    v_lshlrev_b32 v9, 16, v67
    v_and_b32 v10, 0xffff0000, v67
    v_mul_f32 v7, 0.15915494, v7
    v_mul_f32 v8, 0.15915494, v8
    v_mul_f32 v9, 0.15915494, v9
    v_mul_f32 v10, 0.15915494, v10
    v_mul_hi_u32_u24 v14, 429497, v68
    v_lshrrev_b32 v12, 3, v72
    v_cos_f32 v7, v7
    v_lshlrev_b16 v13, 3, v72
    v_mad_i32_i24 v11, v14, s55, v68
    v_bitop3_b32 v12, v6, v13, v12 bitop3:0xca
    v_lshl_add_u32 v11, v11, 17, s40
    v_lshlrev_b16 v14, 8, v14
    v_lshrrev_b32 v13, 2, v72
    v_add_u32 v68, v12, v11
    v_bitop3_b32 v72, v5, v13, v14 bitop3:0xea
    ds_add_u32 v72, v2
    v_mul_hi_u32_u24 v14, 429497, v69
    v_lshrrev_b32 v12, 3, v73
    v_cos_f32 v8, v8
    v_lshlrev_b16 v13, 3, v73
    v_mad_i32_i24 v11, v14, s55, v69
    v_bitop3_b32 v12, v6, v13, v12 bitop3:0xca
    v_lshl_add_u32 v11, v11, 17, s40
    v_lshlrev_b16 v14, 8, v14
    v_lshrrev_b32 v13, 2, v73
    v_add_u32 v69, v12, v11
    v_bitop3_b32 v73, v5, v13, v14 bitop3:0xea
    ds_add_u32 v73, v2
    v_cvt_pk_bf16_f32 v66, v7, v8
    v_perm_b32 v12, v66, v66, s41
    v_bitop3_b32 v68, v4, v12, v68 bitop3:0xca
    v_perm_b32 v13, v66, v66, s42
    v_bitop3_b32 v69, v4, v13, v69 bitop3:0xca
    v_mul_hi_u32_u24 v14, 429497, v70
    v_lshrrev_b32 v12, 3, v74
    v_cos_f32 v9, v9
    v_lshlrev_b16 v13, 3, v74
    v_mad_i32_i24 v11, v14, s55, v70
    v_bitop3_b32 v12, v6, v13, v12 bitop3:0xca
    v_lshl_add_u32 v11, v11, 17, s40
    v_lshlrev_b16 v14, 8, v14
    v_lshrrev_b32 v13, 2, v74
    v_add_u32 v70, v12, v11
    v_bitop3_b32 v74, v5, v13, v14 bitop3:0xea
    ds_add_u32 v74, v2
    v_mul_hi_u32_u24 v14, 429497, v71
    v_lshrrev_b32 v12, 3, v75
    v_cos_f32 v10, v10
    v_lshlrev_b16 v13, 3, v75
    v_mad_i32_i24 v11, v14, s55, v71
    v_bitop3_b32 v12, v6, v13, v12 bitop3:0xca
    v_lshl_add_u32 v11, v11, 17, s40
    v_lshlrev_b16 v14, 8, v14
    v_lshrrev_b32 v13, 2, v75
    v_add_u32 v71, v12, v11
    v_bitop3_b32 v75, v5, v13, v14 bitop3:0xea
    ds_add_u32 v75, v2
    v_cvt_pk_bf16_f32 v67, v9, v10
    v_perm_b32 v12, v67, v67, s41
    v_bitop3_b32 v70, v4, v12, v70 bitop3:0xca
    v_perm_b32 v13, v67, v67, s42
    v_bitop3_b32 v71, v4, v13, v71 bitop3:0xca
    s_setprio 0
    s_add_u32 s44, s97, 0x2400000
    v_lshlrev_b32 v100, 1, v1
    buffer_load_dwordx4 v[100:103], v100, s[8:11], s44 offen nt
    s_waitcnt vmcnt(7)
    v_lshlrev_b32 v7, 16, v84
    v_and_b32 v8, 0xffff0000, v84
    v_lshlrev_b32 v9, 16, v85
    v_and_b32 v10, 0xffff0000, v85
    v_mul_f32 v7, 0.15915494, v7
    v_mul_f32 v8, 0.15915494, v8
    v_mul_f32 v9, 0.15915494, v9
    v_mul_f32 v10, 0.15915494, v10
    v_mul_hi_u32_u24 v14, 429497, v76
    v_lshrrev_b32 v12, 3, v80
    v_cos_f32 v7, v7
    v_lshlrev_b16 v13, 3, v80
    v_mad_i32_i24 v11, v14, s55, v76
    v_bitop3_b32 v12, v6, v13, v12 bitop3:0xca
    v_lshl_add_u32 v11, v11, 17, s40
    v_lshlrev_b16 v14, 8, v14
    v_lshrrev_b32 v13, 2, v80
    v_add_u32 v76, v12, v11
    v_bitop3_b32 v80, v5, v13, v14 bitop3:0xea
    ds_add_u32 v80, v2
    v_mul_hi_u32_u24 v14, 429497, v77
    v_lshrrev_b32 v12, 3, v81
    v_cos_f32 v8, v8
    v_lshlrev_b16 v13, 3, v81
    v_mad_i32_i24 v11, v14, s55, v77
    v_bitop3_b32 v12, v6, v13, v12 bitop3:0xca
    v_lshl_add_u32 v11, v11, 17, s40
    v_lshlrev_b16 v14, 8, v14
    v_lshrrev_b32 v13, 2, v81
    v_add_u32 v77, v12, v11
    v_bitop3_b32 v81, v5, v13, v14 bitop3:0xea
    ds_add_u32 v81, v2
    v_cvt_pk_bf16_f32 v84, v7, v8
    v_perm_b32 v12, v84, v84, s41
    v_bitop3_b32 v76, v4, v12, v76 bitop3:0xca
    v_perm_b32 v13, v84, v84, s42
    v_bitop3_b32 v77, v4, v13, v77 bitop3:0xca
    v_mul_hi_u32_u24 v14, 429497, v78
    v_lshrrev_b32 v12, 3, v82
    v_cos_f32 v9, v9
    v_lshlrev_b16 v13, 3, v82
    v_mad_i32_i24 v11, v14, s55, v78
    v_bitop3_b32 v12, v6, v13, v12 bitop3:0xca
    v_lshl_add_u32 v11, v11, 17, s40
    v_lshlrev_b16 v14, 8, v14
    v_lshrrev_b32 v13, 2, v82
    v_add_u32 v78, v12, v11
    v_bitop3_b32 v82, v5, v13, v14 bitop3:0xea
    ds_add_u32 v82, v2
    v_mul_hi_u32_u24 v14, 429497, v79
    v_lshrrev_b32 v12, 3, v83
    v_cos_f32 v10, v10
    v_lshlrev_b16 v13, 3, v83
    v_mad_i32_i24 v11, v14, s55, v79
    v_bitop3_b32 v12, v6, v13, v12 bitop3:0xca
    v_lshl_add_u32 v11, v11, 17, s40
    v_lshlrev_b16 v14, 8, v14
    v_lshrrev_b32 v13, 2, v83
    v_add_u32 v79, v12, v11
    v_bitop3_b32 v83, v5, v13, v14 bitop3:0xea
    ds_add_u32 v83, v2
    v_cvt_pk_bf16_f32 v85, v9, v10
    v_perm_b32 v12, v85, v85, s41
    v_bitop3_b32 v78, v4, v12, v78 bitop3:0xca
    v_perm_b32 v13, v85, v85, s42
    v_bitop3_b32 v79, v4, v13, v79 bitop3:0xca
    s_waitcnt vmcnt(5)
    v_lshlrev_b32 v7, 16, v86
    v_and_b32 v8, 0xffff0000, v86
    v_lshlrev_b32 v9, 16, v87
    v_and_b32 v10, 0xffff0000, v87
    v_mul_f32 v7, 0.15915494, v7
    v_mul_f32 v8, 0.15915494, v8
    v_mul_f32 v9, 0.15915494, v9
    v_mul_f32 v10, 0.15915494, v10
    v_mul_hi_u32_u24 v14, 429497, v88
    v_lshrrev_b32 v12, 3, v92
    v_cos_f32 v7, v7
    v_lshlrev_b16 v13, 3, v92
    v_mad_i32_i24 v11, v14, s55, v88
    v_bitop3_b32 v12, v6, v13, v12 bitop3:0xca
    v_lshl_add_u32 v11, v11, 17, s40
    v_lshlrev_b16 v14, 8, v14
    v_lshrrev_b32 v13, 2, v92
    v_add_u32 v88, v12, v11
    v_bitop3_b32 v92, v5, v13, v14 bitop3:0xea
    ds_add_u32 v92, v2
    v_mul_hi_u32_u24 v14, 429497, v89
    v_lshrrev_b32 v12, 3, v93
    v_cos_f32 v8, v8
    v_lshlrev_b16 v13, 3, v93
    v_mad_i32_i24 v11, v14, s55, v89
    v_bitop3_b32 v12, v6, v13, v12 bitop3:0xca
    v_lshl_add_u32 v11, v11, 17, s40
    v_lshlrev_b16 v14, 8, v14
    v_lshrrev_b32 v13, 2, v93
    v_add_u32 v89, v12, v11
    v_bitop3_b32 v93, v5, v13, v14 bitop3:0xea
    ds_add_u32 v93, v2
    v_cvt_pk_bf16_f32 v86, v7, v8
    v_perm_b32 v12, v86, v86, s41
    v_bitop3_b32 v88, v4, v12, v88 bitop3:0xca
    v_perm_b32 v13, v86, v86, s42
    v_bitop3_b32 v89, v4, v13, v89 bitop3:0xca
    v_mul_hi_u32_u24 v14, 429497, v90
    v_lshrrev_b32 v12, 3, v94
    v_cos_f32 v9, v9
    v_lshlrev_b16 v13, 3, v94
    v_mad_i32_i24 v11, v14, s55, v90
    v_bitop3_b32 v12, v6, v13, v12 bitop3:0xca
    v_lshl_add_u32 v11, v11, 17, s40
    v_lshlrev_b16 v14, 8, v14
    v_lshrrev_b32 v13, 2, v94
    v_add_u32 v90, v12, v11
    v_bitop3_b32 v94, v5, v13, v14 bitop3:0xea
    ds_add_u32 v94, v2
    v_mul_hi_u32_u24 v14, 429497, v91
    v_lshrrev_b32 v12, 3, v95
    v_cos_f32 v10, v10
    v_lshlrev_b16 v13, 3, v95
    v_mad_i32_i24 v11, v14, s55, v91
    v_bitop3_b32 v12, v6, v13, v12 bitop3:0xca
    v_lshl_add_u32 v11, v11, 17, s40
    v_lshlrev_b16 v14, 8, v14
    v_lshrrev_b32 v13, 2, v95
    v_add_u32 v91, v12, v11
    v_bitop3_b32 v95, v5, v13, v14 bitop3:0xea
    ds_add_u32 v95, v2
    v_cvt_pk_bf16_f32 v87, v9, v10
    v_perm_b32 v12, v87, v87, s41
    v_bitop3_b32 v90, v4, v12, v90 bitop3:0xca
    v_perm_b32 v13, v87, v87, s42
    v_bitop3_b32 v91, v4, v13, v91 bitop3:0xca
    v_lshrrev_b32 v8, 2, v0
    v_and_b32 v7, 0x3c00, v0
    v_bitop3_b32 v7, v5, v8, v7 bitop3:0xea
    s_waitcnt lgkmcnt(0)
    s_barrier
    ds_read2st64_b32 v[8:9], v7 offset0:0 offset1:1
    ds_read2st64_b32 v[10:11], v7 offset0:2 offset1:3
    s_add_u32 s45, s97, 0x2400000
    v_lshlrev_b32 v112, 1, v1
    buffer_load_dwordx4 v[112:115], v112, s[12:15], s45 offen nt
    s_waitcnt lgkmcnt(0)
    v_lshl_or_b32 v12, v9, 16, v8
    v_lshl_or_b32 v13, v11, 16, v10
    v_mov_b32 v14, v12
    v_mov_b32 v15, v13
    s_nop 0
    v_add_u32_dpp v14, v14, v14 row_shr:1 row_mask:0xf bank_mask:0xf bound_ctrl:1
    v_add_u32_dpp v15, v15, v15 row_shr:1 row_mask:0xf bank_mask:0xf bound_ctrl:1
    s_nop 0
    v_add_u32_dpp v14, v14, v14 row_shr:2 row_mask:0xf bank_mask:0xf bound_ctrl:1
    v_add_u32_dpp v15, v15, v15 row_shr:2 row_mask:0xf bank_mask:0xf bound_ctrl:1
    s_nop 0
    v_add_u32_dpp v14, v14, v14 row_shr:4 row_mask:0xf bank_mask:0xf bound_ctrl:1
    v_add_u32_dpp v15, v15, v15 row_shr:4 row_mask:0xf bank_mask:0xf bound_ctrl:1
    s_nop 0
    v_add_u32_dpp v14, v14, v14 row_shr:8 row_mask:0xf bank_mask:0xf bound_ctrl:1
    v_add_u32_dpp v15, v15, v15 row_shr:8 row_mask:0xf bank_mask:0xf bound_ctrl:1
    s_nop 0
    v_add_u32_dpp v14, v14, v14 row_bcast:15 row_mask:0xa bank_mask:0xf
    v_add_u32_dpp v15, v15, v15 row_bcast:15 row_mask:0xa bank_mask:0xf
    s_nop 0
    v_add_u32_dpp v14, v14, v14 row_bcast:31 row_mask:0xc bank_mask:0xf
    v_add_u32_dpp v15, v15, v15 row_bcast:31 row_mask:0xc bank_mask:0xf
    v_readlane_b32 s48, v14, 63
    v_readlane_b32 s49, v15, 63
    s_lshl_b32 s54, s32, 2
    v_mov_b32 v8, s54
    s_and_b32 s50, s48, 0xffff
    s_lshr_b32 s51, s48, 16
    s_and_b32 s52, s49, 0xffff
    s_lshr_b32 s53, s49, 16
    s_add_u32 s51, s51, s50
    s_add_u32 s52, s52, s51
    s_add_u32 s53, s53, s52
    v_mov_b32 v9, s53
    s_mov_b64 exec, 1
    ds_write_b32 v8, v9 offset:16384
    s_mov_b64 exec, -1
    v_and_b32 v8, 60, v7
    s_waitcnt lgkmcnt(0)
    s_barrier
    ds_read_b32 v9, v8 offset:16384
    s_waitcnt lgkmcnt(0)
    v_add_u32_dpp v9, v9, v9 row_shr:1 row_mask:0xf bank_mask:0xf bound_ctrl:1
    s_nop 1
    v_add_u32_dpp v9, v9, v9 row_shr:2 row_mask:0xf bank_mask:0xf bound_ctrl:1
    s_nop 1
    v_add_u32_dpp v9, v9, v9 row_shr:4 row_mask:0xf bank_mask:0xf bound_ctrl:1
    s_nop 1
    v_add_u32_dpp v9, v9, v9 row_shr:8 row_mask:0xf bank_mask:0xf bound_ctrl:1
    s_nop 0
    v_readlane_b32 s54, v9, s32
    s_sub_u32 s54, s54, s53
    s_add_u32 s50, s50, s54
    s_add_u32 s51, s51, s54
    s_add_u32 s52, s52, s54
    s_pack_ll_b32_b16 s48, s54, s50
    s_pack_ll_b32_b16 s49, s51, s52
    v_add_u32 v14, s48, v14
    v_add_u32 v15, s49, v15
    v_sub_u32 v12, v14, v12
    v_sub_u32 v13, v15, v13
    v_and_b32 v8, 0xffff, v12
    v_lshrrev_b32 v9, 16, v12
    v_and_b32 v10, 0xffff, v13
    v_lshrrev_b32 v11, 16, v13
    ds_write2st64_b32 v7, v8, v9 offset0:0 offset1:1
    ds_write2st64_b32 v7, v10, v11 offset0:2 offset1:3
    v_and_b32 v8, 0x3f0, v0
    v_lshl_add_u32 v8, v8, 1, s36
    ds_write_b64 v8, v[12:13] offset:20480
    s_bitset0_b64 exec, 63
    s_not_b64 exec, exec
    ds_write_b64 v8, v[14:15] offset:20512
    s_mov_b64 exec, -1
    s_waitcnt lgkmcnt(0)
    s_barrier
    s_setprio 3
    ds_add_rtn_u32 v20, v20, v2
    ds_add_rtn_u32 v21, v21, v2
    ds_add_rtn_u32 v22, v22, v2
    ds_add_rtn_u32 v23, v23, v2
    ds_read_b128 v[12:15], v0 offset:20480
    v_cmp_gt_u32 vcc, 8448, v0
    ds_add_rtn_u32 v32, v32, v2
    ds_add_rtn_u32 v33, v33, v2
    ds_add_rtn_u32 v34, v34, v2
    ds_add_rtn_u32 v35, v35, v2
    s_setprio 2
    ds_add_rtn_u32 v40, v40, v2
    ds_add_rtn_u32 v41, v41, v2
    ds_add_rtn_u32 v42, v42, v2
    ds_add_rtn_u32 v43, v43, v2
    s_waitcnt lgkmcnt(8)
    s_cbranch_vccz L1_p1
    s_add_u32 s46, s35, 0x0
    s_mov_b64 exec, vcc
    buffer_store_dwordx4 v[12:15], v0, s[24:27], s46 offen sc1
    s_mov_b64 exec, -1
L1_p1:
    s_add_u32 s47, s98, 0x2800000
    v_lshlrev_b32 v116, 1, v1
    buffer_load_dwordx4 v[116:119], v116, s[8:11], s47 offen nt
    ds_add_rtn_u32 v52, v52, v2
    ds_add_rtn_u32 v53, v53, v2
    ds_add_rtn_u32 v54, v54, v2
    ds_add_rtn_u32 v55, v55, v2
    s_setprio 1
    ds_add_rtn_u32 v60, v60, v2
    ds_add_rtn_u32 v61, v61, v2
    ds_add_rtn_u32 v62, v62, v2
    ds_add_rtn_u32 v63, v63, v2
    ds_add_rtn_u32 v72, v72, v2
    ds_add_rtn_u32 v73, v73, v2
    ds_add_rtn_u32 v74, v74, v2
    ds_add_rtn_u32 v75, v75, v2
    s_add_u32 s44, s98, 0x2800000
    v_lshlrev_b32 v120, 1, v1
    buffer_load_dwordx4 v[120:123], v120, s[12:15], s44 offen nt
    s_setprio 0
    ds_add_rtn_u32 v80, v80, v2
    ds_add_rtn_u32 v81, v81, v2
    ds_add_rtn_u32 v82, v82, v2
    ds_add_rtn_u32 v83, v83, v2
    ds_add_rtn_u32 v92, v92, v2
    ds_add_rtn_u32 v93, v93, v2
    ds_add_rtn_u32 v94, v94, v2
    ds_add_rtn_u32 v95, v95, v2
    s_waitcnt lgkmcnt(0)
    s_barrier
    s_setprio 3
    v_and_b32 v7, -4, v20
    v_lshl_add_u32 v8, v20, 2, v7
    ds_write_b32 v8, v16
    v_lshl_add_u32 v7, v7, 2, v20
    ds_write_b8 v7, v24 offset:16
    v_and_b32 v9, -4, v21
    v_lshl_add_u32 v10, v21, 2, v9
    ds_write_b32 v10, v17
    v_lshl_add_u32 v9, v9, 2, v21
    ds_write_b8_d16_hi v9, v24 offset:16
    v_and_b32 v7, -4, v22
    v_lshl_add_u32 v8, v22, 2, v7
    ds_write_b32 v8, v18
    v_lshl_add_u32 v7, v7, 2, v22
    ds_write_b8 v7, v25 offset:16
    v_and_b32 v9, -4, v23
    v_lshl_add_u32 v10, v23, 2, v9
    ds_write_b32 v10, v19
    v_lshl_add_u32 v9, v9, 2, v23
    ds_write_b8_d16_hi v9, v25 offset:16
    s_add_u32 s45, s98, 0x2800000
    s_lshr_b32 s45, s45, 1
    buffer_load_dwordx2 v[124:125], v1, s[16:19], s45 offen nt
    s_add_u32 s46, s99, 0x2c00000
    s_lshr_b32 s46, s46, 1
    buffer_load_dwordx2 v[126:127], v1, s[16:19], s46 offen nt
    s_add_u32 s47, s99, 0x2c00000
    v_lshlrev_b32 v16, 1, v1
    buffer_load_dwordx4 v[16:19], v16, s[8:11], s47 offen nt
    v_and_b32 v7, -4, v32
    v_lshl_add_u32 v8, v32, 2, v7
    ds_write_b32 v8, v28
    v_lshl_add_u32 v7, v7, 2, v32
    ds_write_b8 v7, v26 offset:16
    v_and_b32 v9, -4, v33
    v_lshl_add_u32 v10, v33, 2, v9
    ds_write_b32 v10, v29
    v_lshl_add_u32 v9, v9, 2, v33
    ds_write_b8_d16_hi v9, v26 offset:16
    v_and_b32 v7, -4, v34
    v_lshl_add_u32 v8, v34, 2, v7
    ds_write_b32 v8, v30
    v_lshl_add_u32 v7, v7, 2, v34
    ds_write_b8 v7, v27 offset:16
    v_and_b32 v9, -4, v35
    v_lshl_add_u32 v10, v35, 2, v9
    ds_write_b32 v10, v31
    v_lshl_add_u32 v9, v9, 2, v35
    ds_write_b8_d16_hi v9, v27 offset:16
    s_add_u32 s44, s99, 0x2c00000
    v_lshlrev_b32 v20, 1, v1
    buffer_load_dwordx4 v[20:23], v20, s[12:15], s44 offen nt
    s_setprio 2
    v_and_b32 v7, -4, v40
    v_lshl_add_u32 v8, v40, 2, v7
    ds_write_b32 v8, v36
    v_lshl_add_u32 v7, v7, 2, v40
    ds_write_b8 v7, v44 offset:16
    v_and_b32 v9, -4, v41
    v_lshl_add_u32 v10, v41, 2, v9
    ds_write_b32 v10, v37
    v_lshl_add_u32 v9, v9, 2, v41
    ds_write_b8_d16_hi v9, v44 offset:16
    v_and_b32 v7, -4, v42
    v_lshl_add_u32 v8, v42, 2, v7
    ds_write_b32 v8, v38
    v_lshl_add_u32 v7, v7, 2, v42
    ds_write_b8 v7, v45 offset:16
    v_and_b32 v9, -4, v43
    v_lshl_add_u32 v10, v43, 2, v9
    ds_write_b32 v10, v39
    v_lshl_add_u32 v9, v9, 2, v43
    ds_write_b8_d16_hi v9, v45 offset:16
    s_add_u32 s45, s96, 0x3000000
    v_lshlrev_b32 v28, 1, v1
    buffer_load_dwordx4 v[28:31], v28, s[8:11], s45 offen nt
    s_add_u32 s46, s96, 0x3000000
    v_lshlrev_b32 v32, 1, v1
    buffer_load_dwordx4 v[32:35], v32, s[12:15], s46 offen nt
    v_and_b32 v7, -4, v52
    v_lshl_add_u32 v8, v52, 2, v7
    ds_write_b32 v8, v48
    v_lshl_add_u32 v7, v7, 2, v52
    ds_write_b8 v7, v46 offset:16
    v_and_b32 v9, -4, v53
    v_lshl_add_u32 v10, v53, 2, v9
    ds_write_b32 v10, v49
    v_lshl_add_u32 v9, v9, 2, v53
    ds_write_b8_d16_hi v9, v46 offset:16
    v_and_b32 v7, -4, v54
    v_lshl_add_u32 v8, v54, 2, v7
    ds_write_b32 v8, v50
    v_lshl_add_u32 v7, v7, 2, v54
    ds_write_b8 v7, v47 offset:16
    v_and_b32 v9, -4, v55
    v_lshl_add_u32 v10, v55, 2, v9
    ds_write_b32 v10, v51
    v_lshl_add_u32 v9, v9, 2, v55
    ds_write_b8_d16_hi v9, v47 offset:16
    s_add_u32 s47, s96, 0x3000000
    s_lshr_b32 s47, s47, 1
    buffer_load_dwordx2 v[24:25], v1, s[16:19], s47 offen nt
    s_add_u32 s44, s97, 0x3400000
    s_lshr_b32 s44, s44, 1
    buffer_load_dwordx2 v[26:27], v1, s[16:19], s44 offen nt
    s_setprio 1
    v_and_b32 v7, -4, v60
    v_lshl_add_u32 v8, v60, 2, v7
    ds_write_b32 v8, v56
    v_lshl_add_u32 v7, v7, 2, v60
    ds_write_b8 v7, v64 offset:16
    v_and_b32 v9, -4, v61
    v_lshl_add_u32 v10, v61, 2, v9
    ds_write_b32 v10, v57
    v_lshl_add_u32 v9, v9, 2, v61
    ds_write_b8_d16_hi v9, v64 offset:16
    v_and_b32 v7, -4, v62
    v_lshl_add_u32 v8, v62, 2, v7
    ds_write_b32 v8, v58
    v_lshl_add_u32 v7, v7, 2, v62
    ds_write_b8 v7, v65 offset:16
    v_and_b32 v9, -4, v63
    v_lshl_add_u32 v10, v63, 2, v9
    ds_write_b32 v10, v59
    v_lshl_add_u32 v9, v9, 2, v63
    ds_write_b8_d16_hi v9, v65 offset:16
    s_add_u32 s45, s97, 0x3400000
    v_lshlrev_b32 v36, 1, v1
    buffer_load_dwordx4 v[36:39], v36, s[8:11], s45 offen nt
    v_and_b32 v7, -4, v72
    v_lshl_add_u32 v8, v72, 2, v7
    ds_write_b32 v8, v68
    v_lshl_add_u32 v7, v7, 2, v72
    ds_write_b8 v7, v66 offset:16
    v_and_b32 v9, -4, v73
    v_lshl_add_u32 v10, v73, 2, v9
    ds_write_b32 v10, v69
    v_lshl_add_u32 v9, v9, 2, v73
    ds_write_b8_d16_hi v9, v66 offset:16
    v_and_b32 v7, -4, v74
    v_lshl_add_u32 v8, v74, 2, v7
    ds_write_b32 v8, v70
    v_lshl_add_u32 v7, v7, 2, v74
    ds_write_b8 v7, v67 offset:16
    v_and_b32 v9, -4, v75
    v_lshl_add_u32 v10, v75, 2, v9
    ds_write_b32 v10, v71
    v_lshl_add_u32 v9, v9, 2, v75
    ds_write_b8_d16_hi v9, v67 offset:16
    s_add_u32 s46, s97, 0x3400000
    v_lshlrev_b32 v40, 1, v1
    buffer_load_dwordx4 v[40:43], v40, s[12:15], s46 offen nt
    s_add_u32 s47, s98, 0x3800000
    v_lshlrev_b32 v48, 1, v1
    buffer_load_dwordx4 v[48:51], v48, s[8:11], s47 offen nt
    s_setprio 0
    v_and_b32 v7, -4, v80
    v_lshl_add_u32 v8, v80, 2, v7
    ds_write_b32 v8, v76
    v_lshl_add_u32 v7, v7, 2, v80
    ds_write_b8 v7, v84 offset:16
    v_and_b32 v9, -4, v81
    v_lshl_add_u32 v10, v81, 2, v9
    ds_write_b32 v10, v77
    v_lshl_add_u32 v9, v9, 2, v81
    ds_write_b8_d16_hi v9, v84 offset:16
    v_and_b32 v7, -4, v82
    v_lshl_add_u32 v8, v82, 2, v7
    ds_write_b32 v8, v78
    v_lshl_add_u32 v7, v7, 2, v82
    ds_write_b8 v7, v85 offset:16
    v_and_b32 v9, -4, v83
    v_lshl_add_u32 v10, v83, 2, v9
    ds_write_b32 v10, v79
    v_lshl_add_u32 v9, v9, 2, v83
    ds_write_b8_d16_hi v9, v85 offset:16
    s_add_u32 s44, s98, 0x3800000
    v_lshlrev_b32 v52, 1, v1
    buffer_load_dwordx4 v[52:55], v52, s[12:15], s44 offen nt
    v_and_b32 v7, -4, v92
    v_lshl_add_u32 v8, v92, 2, v7
    ds_write_b32 v8, v88
    v_lshl_add_u32 v7, v7, 2, v92
    ds_write_b8 v7, v86 offset:16
    v_and_b32 v9, -4, v93
    v_lshl_add_u32 v10, v93, 2, v9
    ds_write_b32 v10, v89
    v_lshl_add_u32 v9, v9, 2, v93
    ds_write_b8_d16_hi v9, v86 offset:16
    v_and_b32 v7, -4, v94
    v_lshl_add_u32 v8, v94, 2, v7
    ds_write_b32 v8, v90
    v_lshl_add_u32 v7, v7, 2, v94
    ds_write_b8 v7, v87 offset:16
    v_and_b32 v9, -4, v95
    v_lshl_add_u32 v10, v95, 2, v9
    ds_write_b32 v10, v91
    v_lshl_add_u32 v9, v9, 2, v95
    ds_write_b8_d16_hi v9, v87 offset:16
    s_add_u32 s45, s98, 0x3800000
    s_lshr_b32 s45, s45, 1
    buffer_load_dwordx2 v[44:45], v1, s[16:19], s45 offen nt
    s_add_u32 s46, s99, 0x3c00000
    s_lshr_b32 s46, s46, 1
    buffer_load_dwordx2 v[46:47], v1, s[16:19], s46 offen nt
    v_add_u32 v7, s72, v0
    v_add_u32 v12, s73, v0
    v_add_u32 v13, s85, v0
    v_add_u32 v14, s91, v0
    v_add_u32 v15, s93, v0
    s_min_i32 s3, s72, s73
    s_min_i32 s3, s3, s85
    s_min_i32 s3, s3, s91
    s_min_i32 s3, s3, s93
    v_add_u32 v3, s3, v0
    v_mov_b32 v8, 0
    v_mov_b32 v9, 0
    v_mov_b32 v10, 0
    v_mov_b32 v11, 0
    s_waitcnt lgkmcnt(0)
    s_barrier
    ds_read_b128 v[56:59], v7 offset:0
    ds_read_b128 v[60:63], v12 offset:0
    ds_read_b128 v[68:71], v13 offset:0
    ds_read_b128 v[72:75], v14 offset:0
    ds_read_b128 v[64:67], v15 offset:0
    ds_write_b128 v3, v[8:11]
    ds_read_b128 v[76:79], v7 offset:16384
    ds_read_b128 v[80:83], v12 offset:16384
    ds_read_b128 v[88:91], v13 offset:16384
    ds_read_b128 v[92:95], v14 offset:16384
    ds_read_b128 v[84:87], v15 offset:16384
    s_waitcnt lgkmcnt(0)
    s_barrier
    s_setprio 3
    s_add_u32 s47, s35, 0x4000
    s_add_u32 s47, s47, s72
    buffer_store_dwordx4 v[56:59], v0, s[20:23], s47 offen sc1
    s_add_u32 s44, s99, 0x3c00000
    s_nop 0
    v_lshlrev_b32 v56, 1, v1
    buffer_load_dwordx4 v[56:59], v56, s[8:11], s44 offen nt
    s_add_u32 s45, s35, 0x4000
    s_add_u32 s45, s45, s73
    buffer_store_dwordx4 v[60:63], v0, s[20:23], s45 offen sc1
    s_add_u32 s46, s99, 0x3c00000
    s_nop 0
    v_lshlrev_b32 v60, 1, v1
    buffer_load_dwordx4 v[60:63], v60, s[12:15], s46 offen nt
    s_waitcnt vmcnt(22)
    v_lshlrev_b32 v7, 16, v108
    v_and_b32 v8, 0xffff0000, v108
    v_lshlrev_b32 v9, 16, v109
    v_and_b32 v10, 0xffff0000, v109
    v_mul_f32 v7, 0.15915494, v7
    v_mul_f32 v8, 0.15915494, v8
    v_mul_f32 v9, 0.15915494, v9
    v_mul_f32 v10, 0.15915494, v10
    v_mul_hi_u32_u24 v14, 429497, v96
    v_lshrrev_b32 v12, 3, v104
    v_cos_f32 v7, v7
    v_lshlrev_b16 v13, 3, v104
    v_mad_i32_i24 v11, v14, s55, v96
    v_bitop3_b32 v12, v6, v13, v12 bitop3:0xca
    v_lshl_add_u32 v11, v11, 17, s40
    v_lshlrev_b16 v14, 8, v14
    v_lshrrev_b32 v13, 2, v104
    v_add_u32 v96, v12, v11
    v_bitop3_b32 v104, v5, v13, v14 bitop3:0xea
    ds_add_u32 v104, v2
    v_mul_hi_u32_u24 v14, 429497, v97
    v_lshrrev_b32 v12, 3, v105
    v_cos_f32 v8, v8
    v_lshlrev_b16 v13, 3, v105
    v_mad_i32_i24 v11, v14, s55, v97
    v_bitop3_b32 v12, v6, v13, v12 bitop3:0xca
    v_lshl_add_u32 v11, v11, 17, s40
    v_lshlrev_b16 v14, 8, v14
    v_lshrrev_b32 v13, 2, v105
    v_add_u32 v97, v12, v11
    v_bitop3_b32 v105, v5, v13, v14 bitop3:0xea
    ds_add_u32 v105, v2
    v_cvt_pk_bf16_f32 v108, v7, v8
    v_perm_b32 v12, v108, v108, s41
    v_bitop3_b32 v96, v4, v12, v96 bitop3:0xca
    v_perm_b32 v13, v108, v108, s42
    v_bitop3_b32 v97, v4, v13, v97 bitop3:0xca
    v_mul_hi_u32_u24 v14, 429497, v98
    v_lshrrev_b32 v12, 3, v106
    v_cos_f32 v9, v9
    v_lshlrev_b16 v13, 3, v106
    v_mad_i32_i24 v11, v14, s55, v98
    v_bitop3_b32 v12, v6, v13, v12 bitop3:0xca
    v_lshl_add_u32 v11, v11, 17, s40
    v_lshlrev_b16 v14, 8, v14
    v_lshrrev_b32 v13, 2, v106
    v_add_u32 v98, v12, v11
    v_bitop3_b32 v106, v5, v13, v14 bitop3:0xea
    ds_add_u32 v106, v2
    v_mul_hi_u32_u24 v14, 429497, v99
    v_lshrrev_b32 v12, 3, v107
    v_cos_f32 v10, v10
    v_lshlrev_b16 v13, 3, v107
    v_mad_i32_i24 v11, v14, s55, v99
    v_bitop3_b32 v12, v6, v13, v12 bitop3:0xca
    v_lshl_add_u32 v11, v11, 17, s40
    v_lshlrev_b16 v14, 8, v14
    v_lshrrev_b32 v13, 2, v107
    v_add_u32 v99, v12, v11
    v_bitop3_b32 v107, v5, v13, v14 bitop3:0xea
    ds_add_u32 v107, v2
    v_cvt_pk_bf16_f32 v109, v9, v10
    v_perm_b32 v12, v109, v109, s41
    v_bitop3_b32 v98, v4, v12, v98 bitop3:0xca
    v_perm_b32 v13, v109, v109, s42
    v_bitop3_b32 v99, v4, v13, v99 bitop3:0xca
    s_waitcnt vmcnt(20)
    v_lshlrev_b32 v7, 16, v110
    v_and_b32 v8, 0xffff0000, v110
    v_lshlrev_b32 v9, 16, v111
    v_and_b32 v10, 0xffff0000, v111
    v_mul_f32 v7, 0.15915494, v7
    v_mul_f32 v8, 0.15915494, v8
    v_mul_f32 v9, 0.15915494, v9
    v_mul_f32 v10, 0.15915494, v10
    v_mul_hi_u32_u24 v14, 429497, v100
    v_lshrrev_b32 v12, 3, v112
    v_cos_f32 v7, v7
    v_lshlrev_b16 v13, 3, v112
    v_mad_i32_i24 v11, v14, s55, v100
    v_bitop3_b32 v12, v6, v13, v12 bitop3:0xca
    v_lshl_add_u32 v11, v11, 17, s40
    v_lshlrev_b16 v14, 8, v14
    v_lshrrev_b32 v13, 2, v112
    v_add_u32 v100, v12, v11
    v_bitop3_b32 v112, v5, v13, v14 bitop3:0xea
    ds_add_u32 v112, v2
    v_mul_hi_u32_u24 v14, 429497, v101
    v_lshrrev_b32 v12, 3, v113
    v_cos_f32 v8, v8
    v_lshlrev_b16 v13, 3, v113
    v_mad_i32_i24 v11, v14, s55, v101
    v_bitop3_b32 v12, v6, v13, v12 bitop3:0xca
    v_lshl_add_u32 v11, v11, 17, s40
    v_lshlrev_b16 v14, 8, v14
    v_lshrrev_b32 v13, 2, v113
    v_add_u32 v101, v12, v11
    v_bitop3_b32 v113, v5, v13, v14 bitop3:0xea
    ds_add_u32 v113, v2
    v_cvt_pk_bf16_f32 v110, v7, v8
    v_perm_b32 v12, v110, v110, s41
    v_bitop3_b32 v100, v4, v12, v100 bitop3:0xca
    v_perm_b32 v13, v110, v110, s42
    v_bitop3_b32 v101, v4, v13, v101 bitop3:0xca
    v_mul_hi_u32_u24 v14, 429497, v102
    v_lshrrev_b32 v12, 3, v114
    v_cos_f32 v9, v9
    v_lshlrev_b16 v13, 3, v114
    v_mad_i32_i24 v11, v14, s55, v102
    v_bitop3_b32 v12, v6, v13, v12 bitop3:0xca
    v_lshl_add_u32 v11, v11, 17, s40
    v_lshlrev_b16 v14, 8, v14
    v_lshrrev_b32 v13, 2, v114
    v_add_u32 v102, v12, v11
    v_bitop3_b32 v114, v5, v13, v14 bitop3:0xea
    ds_add_u32 v114, v2
    v_mul_hi_u32_u24 v14, 429497, v103
    v_lshrrev_b32 v12, 3, v115
    v_cos_f32 v10, v10
    v_lshlrev_b16 v13, 3, v115
    v_mad_i32_i24 v11, v14, s55, v103
    v_bitop3_b32 v12, v6, v13, v12 bitop3:0xca
    v_lshl_add_u32 v11, v11, 17, s40
    v_lshlrev_b16 v14, 8, v14
    v_lshrrev_b32 v13, 2, v115
    v_add_u32 v103, v12, v11
    v_bitop3_b32 v115, v5, v13, v14 bitop3:0xea
    ds_add_u32 v115, v2
    v_cvt_pk_bf16_f32 v111, v9, v10
    v_perm_b32 v12, v111, v111, s41
    v_bitop3_b32 v102, v4, v12, v102 bitop3:0xca
    v_perm_b32 v13, v111, v111, s42
    v_bitop3_b32 v103, v4, v13, v103 bitop3:0xca
    s_setprio 2
    s_waitcnt vmcnt(16)
    v_lshlrev_b32 v7, 16, v124
    v_and_b32 v8, 0xffff0000, v124
    v_lshlrev_b32 v9, 16, v125
    v_and_b32 v10, 0xffff0000, v125
    v_mul_f32 v7, 0.15915494, v7
    v_mul_f32 v8, 0.15915494, v8
    v_mul_f32 v9, 0.15915494, v9
    v_mul_f32 v10, 0.15915494, v10
    v_mul_hi_u32_u24 v14, 429497, v116
    v_lshrrev_b32 v12, 3, v120
    v_cos_f32 v7, v7
    v_lshlrev_b16 v13, 3, v120
    v_mad_i32_i24 v11, v14, s55, v116
    v_bitop3_b32 v12, v6, v13, v12 bitop3:0xca
    v_lshl_add_u32 v11, v11, 17, s40
    v_lshlrev_b16 v14, 8, v14
    v_lshrrev_b32 v13, 2, v120
    v_add_u32 v116, v12, v11
    v_bitop3_b32 v120, v5, v13, v14 bitop3:0xea
    ds_add_u32 v120, v2
    v_mul_hi_u32_u24 v14, 429497, v117
    v_lshrrev_b32 v12, 3, v121
    v_cos_f32 v8, v8
    v_lshlrev_b16 v13, 3, v121
    v_mad_i32_i24 v11, v14, s55, v117
    v_bitop3_b32 v12, v6, v13, v12 bitop3:0xca
    v_lshl_add_u32 v11, v11, 17, s40
    v_lshlrev_b16 v14, 8, v14
    v_lshrrev_b32 v13, 2, v121
    v_add_u32 v117, v12, v11
    v_bitop3_b32 v121, v5, v13, v14 bitop3:0xea
    ds_add_u32 v121, v2
    v_cvt_pk_bf16_f32 v124, v7, v8
    v_perm_b32 v12, v124, v124, s41
    v_bitop3_b32 v116, v4, v12, v116 bitop3:0xca
    v_perm_b32 v13, v124, v124, s42
    v_bitop3_b32 v117, v4, v13, v117 bitop3:0xca
    v_mul_hi_u32_u24 v14, 429497, v118
    v_lshrrev_b32 v12, 3, v122
    v_cos_f32 v9, v9
    v_lshlrev_b16 v13, 3, v122
    v_mad_i32_i24 v11, v14, s55, v118
    v_bitop3_b32 v12, v6, v13, v12 bitop3:0xca
    v_lshl_add_u32 v11, v11, 17, s40
    v_lshlrev_b16 v14, 8, v14
    v_lshrrev_b32 v13, 2, v122
    v_add_u32 v118, v12, v11
    v_bitop3_b32 v122, v5, v13, v14 bitop3:0xea
    ds_add_u32 v122, v2
    v_mul_hi_u32_u24 v14, 429497, v119
    v_lshrrev_b32 v12, 3, v123
    v_cos_f32 v10, v10
    v_lshlrev_b16 v13, 3, v123
    v_mad_i32_i24 v11, v14, s55, v119
    v_bitop3_b32 v12, v6, v13, v12 bitop3:0xca
    v_lshl_add_u32 v11, v11, 17, s40
    v_lshlrev_b16 v14, 8, v14
    v_lshrrev_b32 v13, 2, v123
    v_add_u32 v119, v12, v11
    v_bitop3_b32 v123, v5, v13, v14 bitop3:0xea
    ds_add_u32 v123, v2
    v_cvt_pk_bf16_f32 v125, v9, v10
    v_perm_b32 v12, v125, v125, s41
    v_bitop3_b32 v118, v4, v12, v118 bitop3:0xca
    v_perm_b32 v13, v125, v125, s42
    v_bitop3_b32 v119, v4, v13, v119 bitop3:0xca
    s_add_u32 s47, s35, 0x4000
    s_add_u32 s47, s47, s85
    buffer_store_dwordx4 v[68:71], v0, s[20:23], s47 offen sc1
    s_add_u32 s44, s96, 0x4000000
    s_nop 0
    v_lshlrev_b32 v68, 1, v1
    buffer_load_dwordx4 v[68:71], v68, s[8:11], s44 offen nt
    s_waitcnt vmcnt(16)
    v_lshlrev_b32 v7, 16, v126
    v_and_b32 v8, 0xffff0000, v126
    v_lshlrev_b32 v9, 16, v127
    v_and_b32 v10, 0xffff0000, v127
    v_mul_f32 v7, 0.15915494, v7
    v_mul_f32 v8, 0.15915494, v8
    v_mul_f32 v9, 0.15915494, v9
    v_mul_f32 v10, 0.15915494, v10
    v_mul_hi_u32_u24 v14, 429497, v16
    v_lshrrev_b32 v12, 3, v20
    v_cos_f32 v7, v7
    v_lshlrev_b16 v13, 3, v20
    v_mad_i32_i24 v11, v14, s55, v16
    v_bitop3_b32 v12, v6, v13, v12 bitop3:0xca
    v_lshl_add_u32 v11, v11, 17, s40
    v_lshlrev_b16 v14, 8, v14
    v_lshrrev_b32 v13, 2, v20
    v_add_u32 v16, v12, v11
    v_bitop3_b32 v20, v5, v13, v14 bitop3:0xea
    ds_add_u32 v20, v2
    v_mul_hi_u32_u24 v14, 429497, v17
    v_lshrrev_b32 v12, 3, v21
    v_cos_f32 v8, v8
    v_lshlrev_b16 v13, 3, v21
    v_mad_i32_i24 v11, v14, s55, v17
    v_bitop3_b32 v12, v6, v13, v12 bitop3:0xca
    v_lshl_add_u32 v11, v11, 17, s40
    v_lshlrev_b16 v14, 8, v14
    v_lshrrev_b32 v13, 2, v21
    v_add_u32 v17, v12, v11
    v_bitop3_b32 v21, v5, v13, v14 bitop3:0xea
    ds_add_u32 v21, v2
    v_cvt_pk_bf16_f32 v126, v7, v8
    v_perm_b32 v12, v126, v126, s41
    v_bitop3_b32 v16, v4, v12, v16 bitop3:0xca
    v_perm_b32 v13, v126, v126, s42
    v_bitop3_b32 v17, v4, v13, v17 bitop3:0xca
    v_mul_hi_u32_u24 v14, 429497, v18
    v_lshrrev_b32 v12, 3, v22
    v_cos_f32 v9, v9
    v_lshlrev_b16 v13, 3, v22
    v_mad_i32_i24 v11, v14, s55, v18
    v_bitop3_b32 v12, v6, v13, v12 bitop3:0xca
    v_lshl_add_u32 v11, v11, 17, s40
    v_lshlrev_b16 v14, 8, v14
    v_lshrrev_b32 v13, 2, v22
    v_add_u32 v18, v12, v11
    v_bitop3_b32 v22, v5, v13, v14 bitop3:0xea
    ds_add_u32 v22, v2
    v_mul_hi_u32_u24 v14, 429497, v19
    v_lshrrev_b32 v12, 3, v23
    v_cos_f32 v10, v10
    v_lshlrev_b16 v13, 3, v23
    v_mad_i32_i24 v11, v14, s55, v19
    v_bitop3_b32 v12, v6, v13, v12 bitop3:0xca
    v_lshl_add_u32 v11, v11, 17, s40
    v_lshlrev_b16 v14, 8, v14
    v_lshrrev_b32 v13, 2, v23
    v_add_u32 v19, v12, v11
    v_bitop3_b32 v23, v5, v13, v14 bitop3:0xea
    ds_add_u32 v23, v2
    v_cvt_pk_bf16_f32 v127, v9, v10
    v_perm_b32 v12, v127, v127, s41
    v_bitop3_b32 v18, v4, v12, v18 bitop3:0xca
    v_perm_b32 v13, v127, v127, s42
    v_bitop3_b32 v19, v4, v13, v19 bitop3:0xca
    s_setprio 1
    s_waitcnt vmcnt(12)
    v_lshlrev_b32 v7, 16, v24
    v_and_b32 v8, 0xffff0000, v24
    v_lshlrev_b32 v9, 16, v25
    v_and_b32 v10, 0xffff0000, v25
    v_mul_f32 v7, 0.15915494, v7
    v_mul_f32 v8, 0.15915494, v8
    v_mul_f32 v9, 0.15915494, v9
    v_mul_f32 v10, 0.15915494, v10
    v_mul_hi_u32_u24 v14, 429497, v28
    v_lshrrev_b32 v12, 3, v32
    v_cos_f32 v7, v7
    v_lshlrev_b16 v13, 3, v32
    v_mad_i32_i24 v11, v14, s55, v28
    v_bitop3_b32 v12, v6, v13, v12 bitop3:0xca
    v_lshl_add_u32 v11, v11, 17, s40
    v_lshlrev_b16 v14, 8, v14
    v_lshrrev_b32 v13, 2, v32
    v_add_u32 v28, v12, v11
    v_bitop3_b32 v32, v5, v13, v14 bitop3:0xea
    ds_add_u32 v32, v2
    v_mul_hi_u32_u24 v14, 429497, v29
    v_lshrrev_b32 v12, 3, v33
    v_cos_f32 v8, v8
    v_lshlrev_b16 v13, 3, v33
    v_mad_i32_i24 v11, v14, s55, v29
    v_bitop3_b32 v12, v6, v13, v12 bitop3:0xca
    v_lshl_add_u32 v11, v11, 17, s40
    v_lshlrev_b16 v14, 8, v14
    v_lshrrev_b32 v13, 2, v33
    v_add_u32 v29, v12, v11
    v_bitop3_b32 v33, v5, v13, v14 bitop3:0xea
    ds_add_u32 v33, v2
    v_cvt_pk_bf16_f32 v24, v7, v8
    v_perm_b32 v12, v24, v24, s41
    v_bitop3_b32 v28, v4, v12, v28 bitop3:0xca
    v_perm_b32 v13, v24, v24, s42
    v_bitop3_b32 v29, v4, v13, v29 bitop3:0xca
    v_mul_hi_u32_u24 v14, 429497, v30
    v_lshrrev_b32 v12, 3, v34
    v_cos_f32 v9, v9
    v_lshlrev_b16 v13, 3, v34
    v_mad_i32_i24 v11, v14, s55, v30
    v_bitop3_b32 v12, v6, v13, v12 bitop3:0xca
    v_lshl_add_u32 v11, v11, 17, s40
    v_lshlrev_b16 v14, 8, v14
    v_lshrrev_b32 v13, 2, v34
    v_add_u32 v30, v12, v11
    v_bitop3_b32 v34, v5, v13, v14 bitop3:0xea
    ds_add_u32 v34, v2
    v_mul_hi_u32_u24 v14, 429497, v31
    v_lshrrev_b32 v12, 3, v35
    v_cos_f32 v10, v10
    v_lshlrev_b16 v13, 3, v35
    v_mad_i32_i24 v11, v14, s55, v31
    v_bitop3_b32 v12, v6, v13, v12 bitop3:0xca
    v_lshl_add_u32 v11, v11, 17, s40
    v_lshlrev_b16 v14, 8, v14
    v_lshrrev_b32 v13, 2, v35
    v_add_u32 v31, v12, v11
    v_bitop3_b32 v35, v5, v13, v14 bitop3:0xea
    ds_add_u32 v35, v2
    v_cvt_pk_bf16_f32 v25, v9, v10
    v_perm_b32 v12, v25, v25, s41
    v_bitop3_b32 v30, v4, v12, v30 bitop3:0xca
    v_perm_b32 v13, v25, v25, s42
    v_bitop3_b32 v31, v4, v13, v31 bitop3:0xca
    s_waitcnt vmcnt(10)
    v_lshlrev_b32 v7, 16, v26
    v_and_b32 v8, 0xffff0000, v26
    v_lshlrev_b32 v9, 16, v27
    v_and_b32 v10, 0xffff0000, v27
    v_mul_f32 v7, 0.15915494, v7
    v_mul_f32 v8, 0.15915494, v8
    v_mul_f32 v9, 0.15915494, v9
    v_mul_f32 v10, 0.15915494, v10
    v_mul_hi_u32_u24 v14, 429497, v36
    v_lshrrev_b32 v12, 3, v40
    v_cos_f32 v7, v7
    v_lshlrev_b16 v13, 3, v40
    v_mad_i32_i24 v11, v14, s55, v36
    v_bitop3_b32 v12, v6, v13, v12 bitop3:0xca
    v_lshl_add_u32 v11, v11, 17, s40
    v_lshlrev_b16 v14, 8, v14
    v_lshrrev_b32 v13, 2, v40
    v_add_u32 v36, v12, v11
    v_bitop3_b32 v40, v5, v13, v14 bitop3:0xea
    ds_add_u32 v40, v2
    v_mul_hi_u32_u24 v14, 429497, v37
    v_lshrrev_b32 v12, 3, v41
    v_cos_f32 v8, v8
    v_lshlrev_b16 v13, 3, v41
    v_mad_i32_i24 v11, v14, s55, v37
    v_bitop3_b32 v12, v6, v13, v12 bitop3:0xca
    v_lshl_add_u32 v11, v11, 17, s40
    v_lshlrev_b16 v14, 8, v14
    v_lshrrev_b32 v13, 2, v41
    v_add_u32 v37, v12, v11
    v_bitop3_b32 v41, v5, v13, v14 bitop3:0xea
    ds_add_u32 v41, v2
    v_cvt_pk_bf16_f32 v26, v7, v8
    v_perm_b32 v12, v26, v26, s41
    v_bitop3_b32 v36, v4, v12, v36 bitop3:0xca
    v_perm_b32 v13, v26, v26, s42
    v_bitop3_b32 v37, v4, v13, v37 bitop3:0xca
    v_mul_hi_u32_u24 v14, 429497, v38
    v_lshrrev_b32 v12, 3, v42
    v_cos_f32 v9, v9
    v_lshlrev_b16 v13, 3, v42
    v_mad_i32_i24 v11, v14, s55, v38
    v_bitop3_b32 v12, v6, v13, v12 bitop3:0xca
    v_lshl_add_u32 v11, v11, 17, s40
    v_lshlrev_b16 v14, 8, v14
    v_lshrrev_b32 v13, 2, v42
    v_add_u32 v38, v12, v11
    v_bitop3_b32 v42, v5, v13, v14 bitop3:0xea
    ds_add_u32 v42, v2
    v_mul_hi_u32_u24 v14, 429497, v39
    v_lshrrev_b32 v12, 3, v43
    v_cos_f32 v10, v10
    v_lshlrev_b16 v13, 3, v43
    v_mad_i32_i24 v11, v14, s55, v39
    v_bitop3_b32 v12, v6, v13, v12 bitop3:0xca
    v_lshl_add_u32 v11, v11, 17, s40
    v_lshlrev_b16 v14, 8, v14
    v_lshrrev_b32 v13, 2, v43
    v_add_u32 v39, v12, v11
    v_bitop3_b32 v43, v5, v13, v14 bitop3:0xea
    ds_add_u32 v43, v2
    v_cvt_pk_bf16_f32 v27, v9, v10
    v_perm_b32 v12, v27, v27, s41
    v_bitop3_b32 v38, v4, v12, v38 bitop3:0xca
    v_perm_b32 v13, v27, v27, s42
    v_bitop3_b32 v39, v4, v13, v39 bitop3:0xca
    s_setprio 0
    s_add_u32 s45, s35, 0x4000
    s_add_u32 s45, s45, s91
    buffer_store_dwordx4 v[72:75], v0, s[20:23], s45 offen sc1
    s_add_u32 s46, s96, 0x4000000
    s_nop 0
    v_lshlrev_b32 v72, 1, v1
    buffer_load_dwordx4 v[72:75], v72, s[12:15], s46 offen nt
    s_waitcnt vmcnt(8)
    v_lshlrev_b32 v7, 16, v44
    v_and_b32 v8, 0xffff0000, v44
    v_lshlrev_b32 v9, 16, v45
    v_and_b32 v10, 0xffff0000, v45
    v_mul_f32 v7, 0.15915494, v7
    v_mul_f32 v8, 0.15915494, v8
    v_mul_f32 v9, 0.15915494, v9
    v_mul_f32 v10, 0.15915494, v10
    v_mul_hi_u32_u24 v14, 429497, v48
    v_lshrrev_b32 v12, 3, v52
    v_cos_f32 v7, v7
    v_lshlrev_b16 v13, 3, v52
    v_mad_i32_i24 v11, v14, s55, v48
    v_bitop3_b32 v12, v6, v13, v12 bitop3:0xca
    v_lshl_add_u32 v11, v11, 17, s40
    v_lshlrev_b16 v14, 8, v14
    v_lshrrev_b32 v13, 2, v52
    v_add_u32 v48, v12, v11
    v_bitop3_b32 v52, v5, v13, v14 bitop3:0xea
    ds_add_u32 v52, v2
    v_mul_hi_u32_u24 v14, 429497, v49
    v_lshrrev_b32 v12, 3, v53
    v_cos_f32 v8, v8
    v_lshlrev_b16 v13, 3, v53
    v_mad_i32_i24 v11, v14, s55, v49
    v_bitop3_b32 v12, v6, v13, v12 bitop3:0xca
    v_lshl_add_u32 v11, v11, 17, s40
    v_lshlrev_b16 v14, 8, v14
    v_lshrrev_b32 v13, 2, v53
    v_add_u32 v49, v12, v11
    v_bitop3_b32 v53, v5, v13, v14 bitop3:0xea
    ds_add_u32 v53, v2
    v_cvt_pk_bf16_f32 v44, v7, v8
    v_perm_b32 v12, v44, v44, s41
    v_bitop3_b32 v48, v4, v12, v48 bitop3:0xca
    v_perm_b32 v13, v44, v44, s42
    v_bitop3_b32 v49, v4, v13, v49 bitop3:0xca
    v_mul_hi_u32_u24 v14, 429497, v50
    v_lshrrev_b32 v12, 3, v54
    v_cos_f32 v9, v9
    v_lshlrev_b16 v13, 3, v54
    v_mad_i32_i24 v11, v14, s55, v50
    v_bitop3_b32 v12, v6, v13, v12 bitop3:0xca
    v_lshl_add_u32 v11, v11, 17, s40
    v_lshlrev_b16 v14, 8, v14
    v_lshrrev_b32 v13, 2, v54
    v_add_u32 v50, v12, v11
    v_bitop3_b32 v54, v5, v13, v14 bitop3:0xea
    ds_add_u32 v54, v2
    v_mul_hi_u32_u24 v14, 429497, v51
    v_lshrrev_b32 v12, 3, v55
    v_cos_f32 v10, v10
    v_lshlrev_b16 v13, 3, v55
    v_mad_i32_i24 v11, v14, s55, v51
    v_bitop3_b32 v12, v6, v13, v12 bitop3:0xca
    v_lshl_add_u32 v11, v11, 17, s40
    v_lshlrev_b16 v14, 8, v14
    v_lshrrev_b32 v13, 2, v55
    v_add_u32 v51, v12, v11
    v_bitop3_b32 v55, v5, v13, v14 bitop3:0xea
    ds_add_u32 v55, v2
    v_cvt_pk_bf16_f32 v45, v9, v10
    v_perm_b32 v12, v45, v45, s41
    v_bitop3_b32 v50, v4, v12, v50 bitop3:0xca
    v_perm_b32 v13, v45, v45, s42
    v_bitop3_b32 v51, v4, v13, v51 bitop3:0xca
    s_waitcnt vmcnt(4)
    v_lshlrev_b32 v7, 16, v46
    v_and_b32 v8, 0xffff0000, v46
    v_lshlrev_b32 v9, 16, v47
    v_and_b32 v10, 0xffff0000, v47
    v_mul_f32 v7, 0.15915494, v7
    v_mul_f32 v8, 0.15915494, v8
    v_mul_f32 v9, 0.15915494, v9
    v_mul_f32 v10, 0.15915494, v10
    v_mul_hi_u32_u24 v14, 429497, v56
    v_lshrrev_b32 v12, 3, v60
    v_cos_f32 v7, v7
    v_lshlrev_b16 v13, 3, v60
    v_mad_i32_i24 v11, v14, s55, v56
    v_bitop3_b32 v12, v6, v13, v12 bitop3:0xca
    v_lshl_add_u32 v11, v11, 17, s40
    v_lshlrev_b16 v14, 8, v14
    v_lshrrev_b32 v13, 2, v60
    v_add_u32 v56, v12, v11
    v_bitop3_b32 v60, v5, v13, v14 bitop3:0xea
    ds_add_u32 v60, v2
    v_mul_hi_u32_u24 v14, 429497, v57
    v_lshrrev_b32 v12, 3, v61
    v_cos_f32 v8, v8
    v_lshlrev_b16 v13, 3, v61
    v_mad_i32_i24 v11, v14, s55, v57
    v_bitop3_b32 v12, v6, v13, v12 bitop3:0xca
    v_lshl_add_u32 v11, v11, 17, s40
    v_lshlrev_b16 v14, 8, v14
    v_lshrrev_b32 v13, 2, v61
    v_add_u32 v57, v12, v11
    v_bitop3_b32 v61, v5, v13, v14 bitop3:0xea
    ds_add_u32 v61, v2
    v_cvt_pk_bf16_f32 v46, v7, v8
    v_perm_b32 v12, v46, v46, s41
    v_bitop3_b32 v56, v4, v12, v56 bitop3:0xca
    v_perm_b32 v13, v46, v46, s42
    v_bitop3_b32 v57, v4, v13, v57 bitop3:0xca
    v_mul_hi_u32_u24 v14, 429497, v58
    v_lshrrev_b32 v12, 3, v62
    v_cos_f32 v9, v9
    v_lshlrev_b16 v13, 3, v62
    v_mad_i32_i24 v11, v14, s55, v58
    v_bitop3_b32 v12, v6, v13, v12 bitop3:0xca
    v_lshl_add_u32 v11, v11, 17, s40
    v_lshlrev_b16 v14, 8, v14
    v_lshrrev_b32 v13, 2, v62
    v_add_u32 v58, v12, v11
    v_bitop3_b32 v62, v5, v13, v14 bitop3:0xea
    ds_add_u32 v62, v2
    v_mul_hi_u32_u24 v14, 429497, v59
    v_lshrrev_b32 v12, 3, v63
    v_cos_f32 v10, v10
    v_lshlrev_b16 v13, 3, v63
    v_mad_i32_i24 v11, v14, s55, v59
    v_bitop3_b32 v12, v6, v13, v12 bitop3:0xca
    v_lshl_add_u32 v11, v11, 17, s40
    v_lshlrev_b16 v14, 8, v14
    v_lshrrev_b32 v13, 2, v63
    v_add_u32 v59, v12, v11
    v_bitop3_b32 v63, v5, v13, v14 bitop3:0xea
    ds_add_u32 v63, v2
    v_cvt_pk_bf16_f32 v47, v9, v10
    v_perm_b32 v12, v47, v47, s41
    v_bitop3_b32 v58, v4, v12, v58 bitop3:0xca
    v_perm_b32 v13, v47, v47, s42
    v_bitop3_b32 v59, v4, v13, v59 bitop3:0xca
    v_lshrrev_b32 v8, 2, v0
    v_and_b32 v7, 0x3c00, v0
    v_bitop3_b32 v7, v5, v8, v7 bitop3:0xea
    s_waitcnt lgkmcnt(0)
    s_barrier
    ds_read2st64_b32 v[8:9], v7 offset0:0 offset1:1
    ds_read2st64_b32 v[10:11], v7 offset0:2 offset1:3
    s_add_u32 s47, s35, 0x4000
    s_add_u32 s47, s47, s93
    buffer_store_dwordx4 v[64:67], v0, s[20:23], s47 offen sc1
    s_add_u32 s44, s96, 0x4000000
    s_lshr_b32 s44, s44, 1
    buffer_load_dwordx2 v[64:65], v1, s[16:19], s44 offen nt
    s_add_u32 s45, s97, 0x4400000
    s_lshr_b32 s45, s45, 1
    buffer_load_dwordx2 v[66:67], v1, s[16:19], s45 offen nt
    s_waitcnt lgkmcnt(0)
    v_lshl_or_b32 v12, v9, 16, v8
    v_lshl_or_b32 v13, v11, 16, v10
    v_mov_b32 v14, v12
    v_mov_b32 v15, v13
    s_nop 0
    v_add_u32_dpp v14, v14, v14 row_shr:1 row_mask:0xf bank_mask:0xf bound_ctrl:1
    v_add_u32_dpp v15, v15, v15 row_shr:1 row_mask:0xf bank_mask:0xf bound_ctrl:1
    s_nop 0
    v_add_u32_dpp v14, v14, v14 row_shr:2 row_mask:0xf bank_mask:0xf bound_ctrl:1
    v_add_u32_dpp v15, v15, v15 row_shr:2 row_mask:0xf bank_mask:0xf bound_ctrl:1
    s_nop 0
    v_add_u32_dpp v14, v14, v14 row_shr:4 row_mask:0xf bank_mask:0xf bound_ctrl:1
    v_add_u32_dpp v15, v15, v15 row_shr:4 row_mask:0xf bank_mask:0xf bound_ctrl:1
    s_nop 0
    v_add_u32_dpp v14, v14, v14 row_shr:8 row_mask:0xf bank_mask:0xf bound_ctrl:1
    v_add_u32_dpp v15, v15, v15 row_shr:8 row_mask:0xf bank_mask:0xf bound_ctrl:1
    s_nop 0
    v_add_u32_dpp v14, v14, v14 row_bcast:15 row_mask:0xa bank_mask:0xf
    v_add_u32_dpp v15, v15, v15 row_bcast:15 row_mask:0xa bank_mask:0xf
    s_nop 0
    v_add_u32_dpp v14, v14, v14 row_bcast:31 row_mask:0xc bank_mask:0xf
    v_add_u32_dpp v15, v15, v15 row_bcast:31 row_mask:0xc bank_mask:0xf
    v_readlane_b32 s48, v14, 63
    v_readlane_b32 s49, v15, 63
    s_lshl_b32 s54, s32, 2
    v_mov_b32 v8, s54
    s_and_b32 s50, s48, 0xffff
    s_lshr_b32 s51, s48, 16
    s_and_b32 s52, s49, 0xffff
    s_lshr_b32 s53, s49, 16
    s_add_u32 s51, s51, s50
    s_add_u32 s52, s52, s51
    s_add_u32 s53, s53, s52
    v_mov_b32 v9, s53
    s_mov_b64 exec, 1
    ds_write_b32 v8, v9 offset:16384
    s_mov_b64 exec, -1
    v_and_b32 v8, 60, v7
    s_waitcnt lgkmcnt(0)
    s_barrier
    ds_read_b32 v9, v8 offset:16384
    s_waitcnt lgkmcnt(0)
    v_add_u32_dpp v9, v9, v9 row_shr:1 row_mask:0xf bank_mask:0xf bound_ctrl:1
    s_nop 1
    v_add_u32_dpp v9, v9, v9 row_shr:2 row_mask:0xf bank_mask:0xf bound_ctrl:1
    s_nop 1
    v_add_u32_dpp v9, v9, v9 row_shr:4 row_mask:0xf bank_mask:0xf bound_ctrl:1
    s_nop 1
    v_add_u32_dpp v9, v9, v9 row_shr:8 row_mask:0xf bank_mask:0xf bound_ctrl:1
    s_nop 0
    v_readlane_b32 s54, v9, s32
    s_sub_u32 s54, s54, s53
    s_add_u32 s50, s50, s54
    s_add_u32 s51, s51, s54
    s_add_u32 s52, s52, s54
    s_pack_ll_b32_b16 s48, s54, s50
    s_pack_ll_b32_b16 s49, s51, s52
    v_add_u32 v14, s48, v14
    v_add_u32 v15, s49, v15
    v_sub_u32 v12, v14, v12
    v_sub_u32 v13, v15, v13
    v_and_b32 v8, 0xffff, v12
    v_lshrrev_b32 v9, 16, v12
    v_and_b32 v10, 0xffff, v13
    v_lshrrev_b32 v11, 16, v13
    ds_write2st64_b32 v7, v8, v9 offset0:0 offset1:1
    ds_write2st64_b32 v7, v10, v11 offset0:2 offset1:3
    v_and_b32 v8, 0x3f0, v0
    v_lshl_add_u32 v8, v8, 1, s36
    ds_write_b64 v8, v[12:13] offset:20480
    s_bitset0_b64 exec, 63
    s_not_b64 exec, exec
    ds_write_b64 v8, v[14:15] offset:20512
    s_mov_b64 exec, -1
    s_waitcnt lgkmcnt(0)
    s_barrier
    s_setprio 3
    ds_add_rtn_u32 v104, v104, v2
    ds_add_rtn_u32 v105, v105, v2
    ds_add_rtn_u32 v106, v106, v2
    ds_add_rtn_u32 v107, v107, v2
    ds_read_b128 v[12:15], v0 offset:20480
    v_cmp_gt_u32 vcc, 8448, v0
    ds_add_rtn_u32 v112, v112, v2
    ds_add_rtn_u32 v113, v113, v2
    ds_add_rtn_u32 v114, v114, v2
    ds_add_rtn_u32 v115, v115, v2
    s_setprio 2
    ds_add_rtn_u32 v120, v120, v2
    ds_add_rtn_u32 v121, v121, v2
    ds_add_rtn_u32 v122, v122, v2
    ds_add_rtn_u32 v123, v123, v2
    s_waitcnt lgkmcnt(8)
    s_cbranch_vccz L1_p2
    s_add_u32 s46, s35, 0x2a40000
    s_mov_b64 exec, vcc
    buffer_store_dwordx4 v[12:15], v0, s[24:27], s46 offen sc1
    s_mov_b64 exec, -1
L1_p2:
    s_add_u32 s47, s35, 0x8000
    s_add_u32 s47, s47, s72
    buffer_store_dwordx4 v[76:79], v0, s[20:23], s47 offen sc1
    s_add_u32 s44, s97, 0x4400000
    s_nop 0
    v_lshlrev_b32 v76, 1, v1
    buffer_load_dwordx4 v[76:79], v76, s[8:11], s44 offen nt
    ds_add_rtn_u32 v20, v20, v2
    ds_add_rtn_u32 v21, v21, v2
    ds_add_rtn_u32 v22, v22, v2
    ds_add_rtn_u32 v23, v23, v2
    s_setprio 1
    ds_add_rtn_u32 v32, v32, v2
    ds_add_rtn_u32 v33, v33, v2
    ds_add_rtn_u32 v34, v34, v2
    ds_add_rtn_u32 v35, v35, v2
    ds_add_rtn_u32 v40, v40, v2
    ds_add_rtn_u32 v41, v41, v2
    ds_add_rtn_u32 v42, v42, v2
    ds_add_rtn_u32 v43, v43, v2
    s_add_u32 s45, s35, 0x8000
    s_add_u32 s45, s45, s73
    buffer_store_dwordx4 v[80:83], v0, s[20:23], s45 offen sc1
    s_add_u32 s46, s97, 0x4400000
    s_nop 0
    v_lshlrev_b32 v80, 1, v1
    buffer_load_dwordx4 v[80:83], v80, s[12:15], s46 offen nt
    s_setprio 0
    ds_add_rtn_u32 v52, v52, v2
    ds_add_rtn_u32 v53, v53, v2
    ds_add_rtn_u32 v54, v54, v2
    ds_add_rtn_u32 v55, v55, v2
    ds_add_rtn_u32 v60, v60, v2
    ds_add_rtn_u32 v61, v61, v2
    ds_add_rtn_u32 v62, v62, v2
    ds_add_rtn_u32 v63, v63, v2
    s_waitcnt lgkmcnt(0)
    s_barrier
    s_setprio 3
    v_and_b32 v7, -4, v104
    v_lshl_add_u32 v8, v104, 2, v7
    ds_write_b32 v8, v96
    v_lshl_add_u32 v7, v7, 2, v104
    ds_write_b8 v7, v108 offset:16
    v_and_b32 v9, -4, v105
    v_lshl_add_u32 v10, v105, 2, v9
    ds_write_b32 v10, v97
    v_lshl_add_u32 v9, v9, 2, v105
    ds_write_b8_d16_hi v9, v108 offset:16
    v_and_b32 v7, -4, v106
    v_lshl_add_u32 v8, v106, 2, v7
    ds_write_b32 v8, v98
    v_lshl_add_u32 v7, v7, 2, v106
    ds_write_b8 v7, v109 offset:16
    v_and_b32 v9, -4, v107
    v_lshl_add_u32 v10, v107, 2, v9
    ds_write_b32 v10, v99
    v_lshl_add_u32 v9, v9, 2, v107
    ds_write_b8_d16_hi v9, v109 offset:16
    s_add_u32 s47, s35, 0x8000
    s_add_u32 s47, s47, s85
    buffer_store_dwordx4 v[88:91], v0, s[20:23], s47 offen sc1
    s_add_u32 s44, s98, 0x4800000
    v_lshlrev_b32 v96, 1, v1
    buffer_load_dwordx4 v[96:99], v96, s[8:11], s44 offen nt
    s_add_u32 s45, s98, 0x4800000
    v_lshlrev_b32 v104, 1, v1
    buffer_load_dwordx4 v[104:107], v104, s[12:15], s45 offen nt
    v_and_b32 v7, -4, v112
    v_lshl_add_u32 v8, v112, 2, v7
    ds_write_b32 v8, v100
    v_lshl_add_u32 v7, v7, 2, v112
    ds_write_b8 v7, v110 offset:16
    v_and_b32 v9, -4, v113
    v_lshl_add_u32 v10, v113, 2, v9
    ds_write_b32 v10, v101
    v_lshl_add_u32 v9, v9, 2, v113
    ds_write_b8_d16_hi v9, v110 offset:16
    v_and_b32 v7, -4, v114
    v_lshl_add_u32 v8, v114, 2, v7
    ds_write_b32 v8, v102
    v_lshl_add_u32 v7, v7, 2, v114
    ds_write_b8 v7, v111 offset:16
    v_and_b32 v9, -4, v115
    v_lshl_add_u32 v10, v115, 2, v9
    ds_write_b32 v10, v103
    v_lshl_add_u32 v9, v9, 2, v115
    ds_write_b8_d16_hi v9, v111 offset:16
    s_add_u32 s46, s98, 0x4800000
    s_lshr_b32 s46, s46, 1
    buffer_load_dwordx2 v[88:89], v1, s[16:19], s46 offen nt
    s_add_u32 s47, s99, 0x4c00000
    s_lshr_b32 s47, s47, 1
    buffer_load_dwordx2 v[90:91], v1, s[16:19], s47 offen nt
    s_add_u32 s44, s99, 0x4c00000
    v_lshlrev_b32 v100, 1, v1
    buffer_load_dwordx4 v[100:103], v100, s[8:11], s44 offen nt
    s_setprio 2
    v_and_b32 v7, -4, v120
    v_lshl_add_u32 v8, v120, 2, v7
    ds_write_b32 v8, v116
    v_lshl_add_u32 v7, v7, 2, v120
    ds_write_b8 v7, v124 offset:16
    v_and_b32 v9, -4, v121
    v_lshl_add_u32 v10, v121, 2, v9
    ds_write_b32 v10, v117
    v_lshl_add_u32 v9, v9, 2, v121
    ds_write_b8_d16_hi v9, v124 offset:16
    v_and_b32 v7, -4, v122
    v_lshl_add_u32 v8, v122, 2, v7
    ds_write_b32 v8, v118
    v_lshl_add_u32 v7, v7, 2, v122
    ds_write_b8 v7, v125 offset:16
    v_and_b32 v9, -4, v123
    v_lshl_add_u32 v10, v123, 2, v9
    ds_write_b32 v10, v119
    v_lshl_add_u32 v9, v9, 2, v123
    ds_write_b8_d16_hi v9, v125 offset:16
    s_add_u32 s45, s35, 0x8000
    s_add_u32 s45, s45, s91
    buffer_store_dwordx4 v[92:95], v0, s[20:23], s45 offen sc1
    s_add_u32 s46, s99, 0x4c00000
    v_lshlrev_b32 v112, 1, v1
    buffer_load_dwordx4 v[112:115], v112, s[12:15], s46 offen nt
    v_and_b32 v7, -4, v20
    v_lshl_add_u32 v8, v20, 2, v7
    ds_write_b32 v8, v16
    v_lshl_add_u32 v7, v7, 2, v20
    ds_write_b8 v7, v126 offset:16
    v_and_b32 v9, -4, v21
    v_lshl_add_u32 v10, v21, 2, v9
    ds_write_b32 v10, v17
    v_lshl_add_u32 v9, v9, 2, v21
    ds_write_b8_d16_hi v9, v126 offset:16
    v_and_b32 v7, -4, v22
    v_lshl_add_u32 v8, v22, 2, v7
    ds_write_b32 v8, v18
    v_lshl_add_u32 v7, v7, 2, v22
    ds_write_b8 v7, v127 offset:16
    v_and_b32 v9, -4, v23
    v_lshl_add_u32 v10, v23, 2, v9
    ds_write_b32 v10, v19
    v_lshl_add_u32 v9, v9, 2, v23
    ds_write_b8_d16_hi v9, v127 offset:16
    s_add_u32 s47, s96, 0x5000000
    v_lshlrev_b32 v108, 1, v1
    buffer_load_dwordx4 v[108:111], v108, s[8:11], s47 offen nt
    s_add_u32 s44, s96, 0x5000000
    v_lshlrev_b32 v116, 1, v1
    buffer_load_dwordx4 v[116:119], v116, s[12:15], s44 offen nt
    s_setprio 1
    v_and_b32 v7, -4, v32
    v_lshl_add_u32 v8, v32, 2, v7
    ds_write_b32 v8, v28
    v_lshl_add_u32 v7, v7, 2, v32
    ds_write_b8 v7, v24 offset:16
    v_and_b32 v9, -4, v33
    v_lshl_add_u32 v10, v33, 2, v9
    ds_write_b32 v10, v29
    v_lshl_add_u32 v9, v9, 2, v33
    ds_write_b8_d16_hi v9, v24 offset:16
    v_and_b32 v7, -4, v34
    v_lshl_add_u32 v8, v34, 2, v7
    ds_write_b32 v8, v30
    v_lshl_add_u32 v7, v7, 2, v34
    ds_write_b8 v7, v25 offset:16
    v_and_b32 v9, -4, v35
    v_lshl_add_u32 v10, v35, 2, v9
    ds_write_b32 v10, v31
    v_lshl_add_u32 v9, v9, 2, v35
    ds_write_b8_d16_hi v9, v25 offset:16
    s_add_u32 s45, s96, 0x5000000
    s_lshr_b32 s45, s45, 1
    buffer_load_dwordx2 v[120:121], v1, s[16:19], s45 offen nt
    s_add_u32 s46, s97, 0x5400000
    s_lshr_b32 s46, s46, 1
    buffer_load_dwordx2 v[122:123], v1, s[16:19], s46 offen nt
    s_add_u32 s47, s97, 0x5400000
    v_lshlrev_b32 v92, 1, v1
    buffer_load_dwordx4 v[92:95], v92, s[8:11], s47 offen nt
    v_and_b32 v7, -4, v40
    v_lshl_add_u32 v8, v40, 2, v7
    ds_write_b32 v8, v36
    v_lshl_add_u32 v7, v7, 2, v40
    ds_write_b8 v7, v26 offset:16
    v_and_b32 v9, -4, v41
    v_lshl_add_u32 v10, v41, 2, v9
    ds_write_b32 v10, v37
    v_lshl_add_u32 v9, v9, 2, v41
    ds_write_b8_d16_hi v9, v26 offset:16
    v_and_b32 v7, -4, v42
    v_lshl_add_u32 v8, v42, 2, v7
    ds_write_b32 v8, v38
    v_lshl_add_u32 v7, v7, 2, v42
    ds_write_b8 v7, v27 offset:16
    v_and_b32 v9, -4, v43
    v_lshl_add_u32 v10, v43, 2, v9
    ds_write_b32 v10, v39
    v_lshl_add_u32 v9, v9, 2, v43
    ds_write_b8_d16_hi v9, v27 offset:16
    s_add_u32 s44, s35, 0x8000
    s_add_u32 s44, s44, s93
    buffer_store_dwordx4 v[84:87], v0, s[20:23], s44 offen sc1
    s_add_u32 s45, s97, 0x5400000
    v_lshlrev_b32 v16, 1, v1
    buffer_load_dwordx4 v[16:19], v16, s[12:15], s45 offen nt
    s_setprio 0
    v_and_b32 v7, -4, v52
    v_lshl_add_u32 v8, v52, 2, v7
    ds_write_b32 v8, v48
    v_lshl_add_u32 v7, v7, 2, v52
    ds_write_b8 v7, v44 offset:16
    v_and_b32 v9, -4, v53
    v_lshl_add_u32 v10, v53, 2, v9
    ds_write_b32 v10, v49
    v_lshl_add_u32 v9, v9, 2, v53
    ds_write_b8_d16_hi v9, v44 offset:16
    v_and_b32 v7, -4, v54
    v_lshl_add_u32 v8, v54, 2, v7
    ds_write_b32 v8, v50
    v_lshl_add_u32 v7, v7, 2, v54
    ds_write_b8 v7, v45 offset:16
    v_and_b32 v9, -4, v55
    v_lshl_add_u32 v10, v55, 2, v9
    ds_write_b32 v10, v51
    v_lshl_add_u32 v9, v9, 2, v55
    ds_write_b8_d16_hi v9, v45 offset:16
    s_add_u32 s46, s98, 0x5800000
    v_lshlrev_b32 v20, 1, v1
    buffer_load_dwordx4 v[20:23], v20, s[8:11], s46 offen nt
    s_add_u32 s47, s98, 0x5800000
    v_lshlrev_b32 v124, 1, v1
    buffer_load_dwordx4 v[124:127], v124, s[12:15], s47 offen nt
    v_and_b32 v7, -4, v60
    v_lshl_add_u32 v8, v60, 2, v7
    ds_write_b32 v8, v56
    v_lshl_add_u32 v7, v7, 2, v60
    ds_write_b8 v7, v46 offset:16
    v_and_b32 v9, -4, v61
    v_lshl_add_u32 v10, v61, 2, v9
    ds_write_b32 v10, v57
    v_lshl_add_u32 v9, v9, 2, v61
    ds_write_b8_d16_hi v9, v46 offset:16
    v_and_b32 v7, -4, v62
    v_lshl_add_u32 v8, v62, 2, v7
    ds_write_b32 v8, v58
    v_lshl_add_u32 v7, v7, 2, v62
    ds_write_b8 v7, v47 offset:16
    v_and_b32 v9, -4, v63
    v_lshl_add_u32 v10, v63, 2, v9
    ds_write_b32 v10, v59
    v_lshl_add_u32 v9, v9, 2, v63
    ds_write_b8_d16_hi v9, v47 offset:16
    s_add_u32 s44, s98, 0x5800000
    s_lshr_b32 s44, s44, 1
    buffer_load_dwordx2 v[28:29], v1, s[16:19], s44 offen nt
    s_add_u32 s45, s99, 0x5c00000
    s_lshr_b32 s45, s45, 1
    buffer_load_dwordx2 v[30:31], v1, s[16:19], s45 offen nt
    v_add_u32 v7, s72, v0
    v_add_u32 v12, s73, v0
    v_add_u32 v13, s85, v0
    v_add_u32 v14, s91, v0
    v_add_u32 v15, s93, v0
    s_min_i32 s3, s72, s73
    s_min_i32 s3, s3, s85
    s_min_i32 s3, s3, s91
    s_min_i32 s3, s3, s93
    v_add_u32 v3, s3, v0
    v_mov_b32 v8, 0
    v_mov_b32 v9, 0
    v_mov_b32 v10, 0
    v_mov_b32 v11, 0
    s_waitcnt lgkmcnt(0)
    s_barrier
    ds_read_b128 v[32:35], v7 offset:0
    ds_read_b128 v[36:39], v12 offset:0
    ds_read_b128 v[40:43], v13 offset:0
    ds_read_b128 v[24:27], v14 offset:0
    ds_read_b128 v[84:87], v15 offset:0
    ds_write_b128 v3, v[8:11]
    ds_read_b128 v[48:51], v7 offset:16384
    ds_read_b128 v[52:55], v12 offset:16384
    ds_read_b128 v[56:59], v13 offset:16384
    ds_read_b128 v[60:63], v14 offset:16384
    ds_read_b128 v[44:47], v15 offset:16384
    s_waitcnt lgkmcnt(0)
    s_barrier
    s_setprio 3
    s_add_u32 s46, s35, 0x2a44000
    s_add_u32 s46, s46, s72
    buffer_store_dwordx4 v[32:35], v0, s[20:23], s46 offen sc1
    s_add_u32 s47, s99, 0x5c00000
    s_nop 0
    v_lshlrev_b32 v32, 1, v1
    buffer_load_dwordx4 v[32:35], v32, s[8:11], s47 offen nt
    s_add_u32 s44, s35, 0x2a44000
    s_add_u32 s44, s44, s73
    buffer_store_dwordx4 v[36:39], v0, s[20:23], s44 offen sc1
    s_add_u32 s45, s99, 0x5c00000
    s_nop 0
    v_lshlrev_b32 v36, 1, v1
    buffer_load_dwordx4 v[36:39], v36, s[12:15], s45 offen nt
    s_waitcnt vmcnt(27)
    v_lshlrev_b32 v7, 16, v64
    v_and_b32 v8, 0xffff0000, v64
    v_lshlrev_b32 v9, 16, v65
    v_and_b32 v10, 0xffff0000, v65
    v_mul_f32 v7, 0.15915494, v7
    v_mul_f32 v8, 0.15915494, v8
    v_mul_f32 v9, 0.15915494, v9
    v_mul_f32 v10, 0.15915494, v10
    v_mul_hi_u32_u24 v14, 429497, v68
    v_lshrrev_b32 v12, 3, v72
    v_cos_f32 v7, v7
    v_lshlrev_b16 v13, 3, v72
    v_mad_i32_i24 v11, v14, s55, v68
    v_bitop3_b32 v12, v6, v13, v12 bitop3:0xca
    v_lshl_add_u32 v11, v11, 17, s40
    v_lshlrev_b16 v14, 8, v14
    v_lshrrev_b32 v13, 2, v72
    v_add_u32 v68, v12, v11
    v_bitop3_b32 v72, v5, v13, v14 bitop3:0xea
    ds_add_u32 v72, v2
    v_mul_hi_u32_u24 v14, 429497, v69
    v_lshrrev_b32 v12, 3, v73
    v_cos_f32 v8, v8
    v_lshlrev_b16 v13, 3, v73
    v_mad_i32_i24 v11, v14, s55, v69
    v_bitop3_b32 v12, v6, v13, v12 bitop3:0xca
    v_lshl_add_u32 v11, v11, 17, s40
    v_lshlrev_b16 v14, 8, v14
    v_lshrrev_b32 v13, 2, v73
    v_add_u32 v69, v12, v11
    v_bitop3_b32 v73, v5, v13, v14 bitop3:0xea
    ds_add_u32 v73, v2
    v_cvt_pk_bf16_f32 v64, v7, v8
    v_perm_b32 v12, v64, v64, s41
    v_bitop3_b32 v68, v4, v12, v68 bitop3:0xca
    v_perm_b32 v13, v64, v64, s42
    v_bitop3_b32 v69, v4, v13, v69 bitop3:0xca
    v_mul_hi_u32_u24 v14, 429497, v70
    v_lshrrev_b32 v12, 3, v74
    v_cos_f32 v9, v9
    v_lshlrev_b16 v13, 3, v74
    v_mad_i32_i24 v11, v14, s55, v70
    v_bitop3_b32 v12, v6, v13, v12 bitop3:0xca
    v_lshl_add_u32 v11, v11, 17, s40
    v_lshlrev_b16 v14, 8, v14
    v_lshrrev_b32 v13, 2, v74
    v_add_u32 v70, v12, v11
    v_bitop3_b32 v74, v5, v13, v14 bitop3:0xea
    ds_add_u32 v74, v2
    v_mul_hi_u32_u24 v14, 429497, v71
    v_lshrrev_b32 v12, 3, v75
    v_cos_f32 v10, v10
    v_lshlrev_b16 v13, 3, v75
    v_mad_i32_i24 v11, v14, s55, v71
    v_bitop3_b32 v12, v6, v13, v12 bitop3:0xca
    v_lshl_add_u32 v11, v11, 17, s40
    v_lshlrev_b16 v14, 8, v14
    v_lshrrev_b32 v13, 2, v75
    v_add_u32 v71, v12, v11
    v_bitop3_b32 v75, v5, v13, v14 bitop3:0xea
    ds_add_u32 v75, v2
    v_cvt_pk_bf16_f32 v65, v9, v10
    v_perm_b32 v12, v65, v65, s41
    v_bitop3_b32 v70, v4, v12, v70 bitop3:0xca
    v_perm_b32 v13, v65, v65, s42
    v_bitop3_b32 v71, v4, v13, v71 bitop3:0xca
    s_waitcnt vmcnt(23)
    v_lshlrev_b32 v7, 16, v66
    v_and_b32 v8, 0xffff0000, v66
    v_lshlrev_b32 v9, 16, v67
    v_and_b32 v10, 0xffff0000, v67
    v_mul_f32 v7, 0.15915494, v7
    v_mul_f32 v8, 0.15915494, v8
    v_mul_f32 v9, 0.15915494, v9
    v_mul_f32 v10, 0.15915494, v10
    v_mul_hi_u32_u24 v14, 429497, v76
    v_lshrrev_b32 v12, 3, v80
    v_cos_f32 v7, v7
    v_lshlrev_b16 v13, 3, v80
    v_mad_i32_i24 v11, v14, s55, v76
    v_bitop3_b32 v12, v6, v13, v12 bitop3:0xca
    v_lshl_add_u32 v11, v11, 17, s40
    v_lshlrev_b16 v14, 8, v14
    v_lshrrev_b32 v13, 2, v80
    v_add_u32 v76, v12, v11
    v_bitop3_b32 v80, v5, v13, v14 bitop3:0xea
    ds_add_u32 v80, v2
    v_mul_hi_u32_u24 v14, 429497, v77
    v_lshrrev_b32 v12, 3, v81
    v_cos_f32 v8, v8
    v_lshlrev_b16 v13, 3, v81
    v_mad_i32_i24 v11, v14, s55, v77
    v_bitop3_b32 v12, v6, v13, v12 bitop3:0xca
    v_lshl_add_u32 v11, v11, 17, s40
    v_lshlrev_b16 v14, 8, v14
    v_lshrrev_b32 v13, 2, v81
    v_add_u32 v77, v12, v11
    v_bitop3_b32 v81, v5, v13, v14 bitop3:0xea
    ds_add_u32 v81, v2
    v_cvt_pk_bf16_f32 v66, v7, v8
    v_perm_b32 v12, v66, v66, s41
    v_bitop3_b32 v76, v4, v12, v76 bitop3:0xca
    v_perm_b32 v13, v66, v66, s42
    v_bitop3_b32 v77, v4, v13, v77 bitop3:0xca
    v_mul_hi_u32_u24 v14, 429497, v78
    v_lshrrev_b32 v12, 3, v82
    v_cos_f32 v9, v9
    v_lshlrev_b16 v13, 3, v82
    v_mad_i32_i24 v11, v14, s55, v78
    v_bitop3_b32 v12, v6, v13, v12 bitop3:0xca
    v_lshl_add_u32 v11, v11, 17, s40
    v_lshlrev_b16 v14, 8, v14
    v_lshrrev_b32 v13, 2, v82
    v_add_u32 v78, v12, v11
    v_bitop3_b32 v82, v5, v13, v14 bitop3:0xea
    ds_add_u32 v82, v2
    v_mul_hi_u32_u24 v14, 429497, v79
    v_lshrrev_b32 v12, 3, v83
    v_cos_f32 v10, v10
    v_lshlrev_b16 v13, 3, v83
    v_mad_i32_i24 v11, v14, s55, v79
    v_bitop3_b32 v12, v6, v13, v12 bitop3:0xca
    v_lshl_add_u32 v11, v11, 17, s40
    v_lshlrev_b16 v14, 8, v14
    v_lshrrev_b32 v13, 2, v83
    v_add_u32 v79, v12, v11
    v_bitop3_b32 v83, v5, v13, v14 bitop3:0xea
    ds_add_u32 v83, v2
    v_cvt_pk_bf16_f32 v67, v9, v10
    v_perm_b32 v12, v67, v67, s41
    v_bitop3_b32 v78, v4, v12, v78 bitop3:0xca
    v_perm_b32 v13, v67, v67, s42
    v_bitop3_b32 v79, v4, v13, v79 bitop3:0xca
    s_setprio 2
    s_waitcnt vmcnt(18)
    v_lshlrev_b32 v7, 16, v88
    v_and_b32 v8, 0xffff0000, v88
    v_lshlrev_b32 v9, 16, v89
    v_and_b32 v10, 0xffff0000, v89
    v_mul_f32 v7, 0.15915494, v7
    v_mul_f32 v8, 0.15915494, v8
    v_mul_f32 v9, 0.15915494, v9
    v_mul_f32 v10, 0.15915494, v10
    v_mul_hi_u32_u24 v14, 429497, v96
    v_lshrrev_b32 v12, 3, v104
    v_cos_f32 v7, v7
    v_lshlrev_b16 v13, 3, v104
    v_mad_i32_i24 v11, v14, s55, v96
    v_bitop3_b32 v12, v6, v13, v12 bitop3:0xca
    v_lshl_add_u32 v11, v11, 17, s40
    v_lshlrev_b16 v14, 8, v14
    v_lshrrev_b32 v13, 2, v104
    v_add_u32 v96, v12, v11
    v_bitop3_b32 v104, v5, v13, v14 bitop3:0xea
    ds_add_u32 v104, v2
    v_mul_hi_u32_u24 v14, 429497, v97
    v_lshrrev_b32 v12, 3, v105
    v_cos_f32 v8, v8
    v_lshlrev_b16 v13, 3, v105
    v_mad_i32_i24 v11, v14, s55, v97
    v_bitop3_b32 v12, v6, v13, v12 bitop3:0xca
    v_lshl_add_u32 v11, v11, 17, s40
    v_lshlrev_b16 v14, 8, v14
    v_lshrrev_b32 v13, 2, v105
    v_add_u32 v97, v12, v11
    v_bitop3_b32 v105, v5, v13, v14 bitop3:0xea
    ds_add_u32 v105, v2
    v_cvt_pk_bf16_f32 v88, v7, v8
    v_perm_b32 v12, v88, v88, s41
    v_bitop3_b32 v96, v4, v12, v96 bitop3:0xca
    v_perm_b32 v13, v88, v88, s42
    v_bitop3_b32 v97, v4, v13, v97 bitop3:0xca
    v_mul_hi_u32_u24 v14, 429497, v98
    v_lshrrev_b32 v12, 3, v106
    v_cos_f32 v9, v9
    v_lshlrev_b16 v13, 3, v106
    v_mad_i32_i24 v11, v14, s55, v98
    v_bitop3_b32 v12, v6, v13, v12 bitop3:0xca
    v_lshl_add_u32 v11, v11, 17, s40
    v_lshlrev_b16 v14, 8, v14
    v_lshrrev_b32 v13, 2, v106
    v_add_u32 v98, v12, v11
    v_bitop3_b32 v106, v5, v13, v14 bitop3:0xea
    ds_add_u32 v106, v2
    v_mul_hi_u32_u24 v14, 429497, v99
    v_lshrrev_b32 v12, 3, v107
    v_cos_f32 v10, v10
    v_lshlrev_b16 v13, 3, v107
    v_mad_i32_i24 v11, v14, s55, v99
    v_bitop3_b32 v12, v6, v13, v12 bitop3:0xca
    v_lshl_add_u32 v11, v11, 17, s40
    v_lshlrev_b16 v14, 8, v14
    v_lshrrev_b32 v13, 2, v107
    v_add_u32 v99, v12, v11
    v_bitop3_b32 v107, v5, v13, v14 bitop3:0xea
    ds_add_u32 v107, v2
    v_cvt_pk_bf16_f32 v89, v9, v10
    v_perm_b32 v12, v89, v89, s41
    v_bitop3_b32 v98, v4, v12, v98 bitop3:0xca
    v_perm_b32 v13, v89, v89, s42
    v_bitop3_b32 v99, v4, v13, v99 bitop3:0xca
    s_add_u32 s46, s35, 0x2a44000
    s_add_u32 s46, s46, s85
    buffer_store_dwordx4 v[40:43], v0, s[20:23], s46 offen sc1
    s_add_u32 s47, s96, 0x6000000
    s_nop 0
    v_lshlrev_b32 v40, 1, v1
    buffer_load_dwordx4 v[40:43], v40, s[8:11], s47 offen nt
    s_waitcnt vmcnt(17)
    v_lshlrev_b32 v7, 16, v90
    v_and_b32 v8, 0xffff0000, v90
    v_lshlrev_b32 v9, 16, v91
    v_and_b32 v10, 0xffff0000, v91
    v_mul_f32 v7, 0.15915494, v7
    v_mul_f32 v8, 0.15915494, v8
    v_mul_f32 v9, 0.15915494, v9
    v_mul_f32 v10, 0.15915494, v10
    v_mul_hi_u32_u24 v14, 429497, v100
    v_lshrrev_b32 v12, 3, v112
    v_cos_f32 v7, v7
    v_lshlrev_b16 v13, 3, v112
    v_mad_i32_i24 v11, v14, s55, v100
    v_bitop3_b32 v12, v6, v13, v12 bitop3:0xca
    v_lshl_add_u32 v11, v11, 17, s40
    v_lshlrev_b16 v14, 8, v14
    v_lshrrev_b32 v13, 2, v112
    v_add_u32 v100, v12, v11
    v_bitop3_b32 v112, v5, v13, v14 bitop3:0xea
    ds_add_u32 v112, v2
    v_mul_hi_u32_u24 v14, 429497, v101
    v_lshrrev_b32 v12, 3, v113
    v_cos_f32 v8, v8
    v_lshlrev_b16 v13, 3, v113
    v_mad_i32_i24 v11, v14, s55, v101
    v_bitop3_b32 v12, v6, v13, v12 bitop3:0xca
    v_lshl_add_u32 v11, v11, 17, s40
    v_lshlrev_b16 v14, 8, v14
    v_lshrrev_b32 v13, 2, v113
    v_add_u32 v101, v12, v11
    v_bitop3_b32 v113, v5, v13, v14 bitop3:0xea
    ds_add_u32 v113, v2
    v_cvt_pk_bf16_f32 v90, v7, v8
    v_perm_b32 v12, v90, v90, s41
    v_bitop3_b32 v100, v4, v12, v100 bitop3:0xca
    v_perm_b32 v13, v90, v90, s42
    v_bitop3_b32 v101, v4, v13, v101 bitop3:0xca
    v_mul_hi_u32_u24 v14, 429497, v102
    v_lshrrev_b32 v12, 3, v114
    v_cos_f32 v9, v9
    v_lshlrev_b16 v13, 3, v114
    v_mad_i32_i24 v11, v14, s55, v102
    v_bitop3_b32 v12, v6, v13, v12 bitop3:0xca
    v_lshl_add_u32 v11, v11, 17, s40
    v_lshlrev_b16 v14, 8, v14
    v_lshrrev_b32 v13, 2, v114
    v_add_u32 v102, v12, v11
    v_bitop3_b32 v114, v5, v13, v14 bitop3:0xea
    ds_add_u32 v114, v2
    v_mul_hi_u32_u24 v14, 429497, v103
    v_lshrrev_b32 v12, 3, v115
    v_cos_f32 v10, v10
    v_lshlrev_b16 v13, 3, v115
    v_mad_i32_i24 v11, v14, s55, v103
    v_bitop3_b32 v12, v6, v13, v12 bitop3:0xca
    v_lshl_add_u32 v11, v11, 17, s40
    v_lshlrev_b16 v14, 8, v14
    v_lshrrev_b32 v13, 2, v115
    v_add_u32 v103, v12, v11
    v_bitop3_b32 v115, v5, v13, v14 bitop3:0xea
    ds_add_u32 v115, v2
    v_cvt_pk_bf16_f32 v91, v9, v10
    v_perm_b32 v12, v91, v91, s41
    v_bitop3_b32 v102, v4, v12, v102 bitop3:0xca
    v_perm_b32 v13, v91, v91, s42
    v_bitop3_b32 v103, v4, v13, v103 bitop3:0xca
    s_setprio 1
    s_waitcnt vmcnt(13)
    v_lshlrev_b32 v7, 16, v120
    v_and_b32 v8, 0xffff0000, v120
    v_lshlrev_b32 v9, 16, v121
    v_and_b32 v10, 0xffff0000, v121
    v_mul_f32 v7, 0.15915494, v7
    v_mul_f32 v8, 0.15915494, v8
    v_mul_f32 v9, 0.15915494, v9
    v_mul_f32 v10, 0.15915494, v10
    v_mul_hi_u32_u24 v14, 429497, v108
    v_lshrrev_b32 v12, 3, v116
    v_cos_f32 v7, v7
    v_lshlrev_b16 v13, 3, v116
    v_mad_i32_i24 v11, v14, s55, v108
    v_bitop3_b32 v12, v6, v13, v12 bitop3:0xca
    v_lshl_add_u32 v11, v11, 17, s40
    v_lshlrev_b16 v14, 8, v14
    v_lshrrev_b32 v13, 2, v116
    v_add_u32 v108, v12, v11
    v_bitop3_b32 v116, v5, v13, v14 bitop3:0xea
    ds_add_u32 v116, v2
    v_mul_hi_u32_u24 v14, 429497, v109
    v_lshrrev_b32 v12, 3, v117
    v_cos_f32 v8, v8
    v_lshlrev_b16 v13, 3, v117
    v_mad_i32_i24 v11, v14, s55, v109
    v_bitop3_b32 v12, v6, v13, v12 bitop3:0xca
    v_lshl_add_u32 v11, v11, 17, s40
    v_lshlrev_b16 v14, 8, v14
    v_lshrrev_b32 v13, 2, v117
    v_add_u32 v109, v12, v11
    v_bitop3_b32 v117, v5, v13, v14 bitop3:0xea
    ds_add_u32 v117, v2
    v_cvt_pk_bf16_f32 v120, v7, v8
    v_perm_b32 v12, v120, v120, s41
    v_bitop3_b32 v108, v4, v12, v108 bitop3:0xca
    v_perm_b32 v13, v120, v120, s42
    v_bitop3_b32 v109, v4, v13, v109 bitop3:0xca
    v_mul_hi_u32_u24 v14, 429497, v110
    v_lshrrev_b32 v12, 3, v118
    v_cos_f32 v9, v9
    v_lshlrev_b16 v13, 3, v118
    v_mad_i32_i24 v11, v14, s55, v110
    v_bitop3_b32 v12, v6, v13, v12 bitop3:0xca
    v_lshl_add_u32 v11, v11, 17, s40
    v_lshlrev_b16 v14, 8, v14
    v_lshrrev_b32 v13, 2, v118
    v_add_u32 v110, v12, v11
    v_bitop3_b32 v118, v5, v13, v14 bitop3:0xea
    ds_add_u32 v118, v2
    v_mul_hi_u32_u24 v14, 429497, v111
    v_lshrrev_b32 v12, 3, v119
    v_cos_f32 v10, v10
    v_lshlrev_b16 v13, 3, v119
    v_mad_i32_i24 v11, v14, s55, v111
    v_bitop3_b32 v12, v6, v13, v12 bitop3:0xca
    v_lshl_add_u32 v11, v11, 17, s40
    v_lshlrev_b16 v14, 8, v14
    v_lshrrev_b32 v13, 2, v119
    v_add_u32 v111, v12, v11
    v_bitop3_b32 v119, v5, v13, v14 bitop3:0xea
    ds_add_u32 v119, v2
    v_cvt_pk_bf16_f32 v121, v9, v10
    v_perm_b32 v12, v121, v121, s41
    v_bitop3_b32 v110, v4, v12, v110 bitop3:0xca
    v_perm_b32 v13, v121, v121, s42
    v_bitop3_b32 v111, v4, v13, v111 bitop3:0xca
    s_waitcnt vmcnt(10)
    v_lshlrev_b32 v7, 16, v122
    v_and_b32 v8, 0xffff0000, v122
    v_lshlrev_b32 v9, 16, v123
    v_and_b32 v10, 0xffff0000, v123
    v_mul_f32 v7, 0.15915494, v7
    v_mul_f32 v8, 0.15915494, v8
    v_mul_f32 v9, 0.15915494, v9
    v_mul_f32 v10, 0.15915494, v10
    v_mul_hi_u32_u24 v14, 429497, v92
    v_lshrrev_b32 v12, 3, v16
    v_cos_f32 v7, v7
    v_lshlrev_b16 v13, 3, v16
    v_mad_i32_i24 v11, v14, s55, v92
    v_bitop3_b32 v12, v6, v13, v12 bitop3:0xca
    v_lshl_add_u32 v11, v11, 17, s40
    v_lshlrev_b16 v14, 8, v14
    v_lshrrev_b32 v13, 2, v16
    v_add_u32 v92, v12, v11
    v_bitop3_b32 v16, v5, v13, v14 bitop3:0xea
    ds_add_u32 v16, v2
    v_mul_hi_u32_u24 v14, 429497, v93
    v_lshrrev_b32 v12, 3, v17
    v_cos_f32 v8, v8
    v_lshlrev_b16 v13, 3, v17
    v_mad_i32_i24 v11, v14, s55, v93
    v_bitop3_b32 v12, v6, v13, v12 bitop3:0xca
    v_lshl_add_u32 v11, v11, 17, s40
    v_lshlrev_b16 v14, 8, v14
    v_lshrrev_b32 v13, 2, v17
    v_add_u32 v93, v12, v11
    v_bitop3_b32 v17, v5, v13, v14 bitop3:0xea
    ds_add_u32 v17, v2
    v_cvt_pk_bf16_f32 v122, v7, v8
    v_perm_b32 v12, v122, v122, s41
    v_bitop3_b32 v92, v4, v12, v92 bitop3:0xca
    v_perm_b32 v13, v122, v122, s42
    v_bitop3_b32 v93, v4, v13, v93 bitop3:0xca
    v_mul_hi_u32_u24 v14, 429497, v94
    v_lshrrev_b32 v12, 3, v18
    v_cos_f32 v9, v9
    v_lshlrev_b16 v13, 3, v18
    v_mad_i32_i24 v11, v14, s55, v94
    v_bitop3_b32 v12, v6, v13, v12 bitop3:0xca
    v_lshl_add_u32 v11, v11, 17, s40
    v_lshlrev_b16 v14, 8, v14
    v_lshrrev_b32 v13, 2, v18
    v_add_u32 v94, v12, v11
    v_bitop3_b32 v18, v5, v13, v14 bitop3:0xea
    ds_add_u32 v18, v2
    v_mul_hi_u32_u24 v14, 429497, v95
    v_lshrrev_b32 v12, 3, v19
    v_cos_f32 v10, v10
    v_lshlrev_b16 v13, 3, v19
    v_mad_i32_i24 v11, v14, s55, v95
    v_bitop3_b32 v12, v6, v13, v12 bitop3:0xca
    v_lshl_add_u32 v11, v11, 17, s40
    v_lshlrev_b16 v14, 8, v14
    v_lshrrev_b32 v13, 2, v19
    v_add_u32 v95, v12, v11
    v_bitop3_b32 v19, v5, v13, v14 bitop3:0xea
    ds_add_u32 v19, v2
    v_cvt_pk_bf16_f32 v123, v9, v10
    v_perm_b32 v12, v123, v123, s41
    v_bitop3_b32 v94, v4, v12, v94 bitop3:0xca
    v_perm_b32 v13, v123, v123, s42
    v_bitop3_b32 v95, v4, v13, v95 bitop3:0xca
    s_setprio 0
    s_add_u32 s44, s35, 0x2a44000
    s_add_u32 s44, s44, s91
    buffer_store_dwordx4 v[24:27], v0, s[20:23], s44 offen sc1
    s_add_u32 s45, s96, 0x6000000
    s_nop 0
    v_lshlrev_b32 v24, 1, v1
    buffer_load_dwordx4 v[24:27], v24, s[12:15], s45 offen nt
    s_waitcnt vmcnt(8)
    v_lshlrev_b32 v7, 16, v28
    v_and_b32 v8, 0xffff0000, v28
    v_lshlrev_b32 v9, 16, v29
    v_and_b32 v10, 0xffff0000, v29
    v_mul_f32 v7, 0.15915494, v7
    v_mul_f32 v8, 0.15915494, v8
    v_mul_f32 v9, 0.15915494, v9
    v_mul_f32 v10, 0.15915494, v10
    v_mul_hi_u32_u24 v14, 429497, v20
    v_lshrrev_b32 v12, 3, v124
    v_cos_f32 v7, v7
    v_lshlrev_b16 v13, 3, v124
    v_mad_i32_i24 v11, v14, s55, v20
    v_bitop3_b32 v12, v6, v13, v12 bitop3:0xca
    v_lshl_add_u32 v11, v11, 17, s40
    v_lshlrev_b16 v14, 8, v14
    v_lshrrev_b32 v13, 2, v124
    v_add_u32 v20, v12, v11
    v_bitop3_b32 v124, v5, v13, v14 bitop3:0xea
    ds_add_u32 v124, v2
    v_mul_hi_u32_u24 v14, 429497, v21
    v_lshrrev_b32 v12, 3, v125
    v_cos_f32 v8, v8
    v_lshlrev_b16 v13, 3, v125
    v_mad_i32_i24 v11, v14, s55, v21
    v_bitop3_b32 v12, v6, v13, v12 bitop3:0xca
    v_lshl_add_u32 v11, v11, 17, s40
    v_lshlrev_b16 v14, 8, v14
    v_lshrrev_b32 v13, 2, v125
    v_add_u32 v21, v12, v11
    v_bitop3_b32 v125, v5, v13, v14 bitop3:0xea
    ds_add_u32 v125, v2
    v_cvt_pk_bf16_f32 v28, v7, v8
    v_perm_b32 v12, v28, v28, s41
    v_bitop3_b32 v20, v4, v12, v20 bitop3:0xca
    v_perm_b32 v13, v28, v28, s42
    v_bitop3_b32 v21, v4, v13, v21 bitop3:0xca
    v_mul_hi_u32_u24 v14, 429497, v22
    v_lshrrev_b32 v12, 3, v126
    v_cos_f32 v9, v9
    v_lshlrev_b16 v13, 3, v126
    v_mad_i32_i24 v11, v14, s55, v22
    v_bitop3_b32 v12, v6, v13, v12 bitop3:0xca
    v_lshl_add_u32 v11, v11, 17, s40
    v_lshlrev_b16 v14, 8, v14
    v_lshrrev_b32 v13, 2, v126
    v_add_u32 v22, v12, v11
    v_bitop3_b32 v126, v5, v13, v14 bitop3:0xea
    ds_add_u32 v126, v2
    v_mul_hi_u32_u24 v14, 429497, v23
    v_lshrrev_b32 v12, 3, v127
    v_cos_f32 v10, v10
    v_lshlrev_b16 v13, 3, v127
    v_mad_i32_i24 v11, v14, s55, v23
    v_bitop3_b32 v12, v6, v13, v12 bitop3:0xca
    v_lshl_add_u32 v11, v11, 17, s40
    v_lshlrev_b16 v14, 8, v14
    v_lshrrev_b32 v13, 2, v127
    v_add_u32 v23, v12, v11
    v_bitop3_b32 v127, v5, v13, v14 bitop3:0xea
    ds_add_u32 v127, v2
    v_cvt_pk_bf16_f32 v29, v9, v10
    v_perm_b32 v12, v29, v29, s41
    v_bitop3_b32 v22, v4, v12, v22 bitop3:0xca
    v_perm_b32 v13, v29, v29, s42
    v_bitop3_b32 v23, v4, v13, v23 bitop3:0xca
    s_waitcnt vmcnt(4)
    v_lshlrev_b32 v7, 16, v30
    v_and_b32 v8, 0xffff0000, v30
    v_lshlrev_b32 v9, 16, v31
    v_and_b32 v10, 0xffff0000, v31
    v_mul_f32 v7, 0.15915494, v7
    v_mul_f32 v8, 0.15915494, v8
    v_mul_f32 v9, 0.15915494, v9
    v_mul_f32 v10, 0.15915494, v10
    v_mul_hi_u32_u24 v14, 429497, v32
    v_lshrrev_b32 v12, 3, v36
    v_cos_f32 v7, v7
    v_lshlrev_b16 v13, 3, v36
    v_mad_i32_i24 v11, v14, s55, v32
    v_bitop3_b32 v12, v6, v13, v12 bitop3:0xca
    v_lshl_add_u32 v11, v11, 17, s40
    v_lshlrev_b16 v14, 8, v14
    v_lshrrev_b32 v13, 2, v36
    v_add_u32 v32, v12, v11
    v_bitop3_b32 v36, v5, v13, v14 bitop3:0xea
    ds_add_u32 v36, v2
    v_mul_hi_u32_u24 v14, 429497, v33
    v_lshrrev_b32 v12, 3, v37
    v_cos_f32 v8, v8
    v_lshlrev_b16 v13, 3, v37
    v_mad_i32_i24 v11, v14, s55, v33
    v_bitop3_b32 v12, v6, v13, v12 bitop3:0xca
    v_lshl_add_u32 v11, v11, 17, s40
    v_lshlrev_b16 v14, 8, v14
    v_lshrrev_b32 v13, 2, v37
    v_add_u32 v33, v12, v11
    v_bitop3_b32 v37, v5, v13, v14 bitop3:0xea
    ds_add_u32 v37, v2
    v_cvt_pk_bf16_f32 v30, v7, v8
    v_perm_b32 v12, v30, v30, s41
    v_bitop3_b32 v32, v4, v12, v32 bitop3:0xca
    v_perm_b32 v13, v30, v30, s42
    v_bitop3_b32 v33, v4, v13, v33 bitop3:0xca
    v_mul_hi_u32_u24 v14, 429497, v34
    v_lshrrev_b32 v12, 3, v38
    v_cos_f32 v9, v9
    v_lshlrev_b16 v13, 3, v38
    v_mad_i32_i24 v11, v14, s55, v34
    v_bitop3_b32 v12, v6, v13, v12 bitop3:0xca
    v_lshl_add_u32 v11, v11, 17, s40
    v_lshlrev_b16 v14, 8, v14
    v_lshrrev_b32 v13, 2, v38
    v_add_u32 v34, v12, v11
    v_bitop3_b32 v38, v5, v13, v14 bitop3:0xea
    ds_add_u32 v38, v2
    v_mul_hi_u32_u24 v14, 429497, v35
    v_lshrrev_b32 v12, 3, v39
    v_cos_f32 v10, v10
    v_lshlrev_b16 v13, 3, v39
    v_mad_i32_i24 v11, v14, s55, v35
    v_bitop3_b32 v12, v6, v13, v12 bitop3:0xca
    v_lshl_add_u32 v11, v11, 17, s40
    v_lshlrev_b16 v14, 8, v14
    v_lshrrev_b32 v13, 2, v39
    v_add_u32 v35, v12, v11
    v_bitop3_b32 v39, v5, v13, v14 bitop3:0xea
    ds_add_u32 v39, v2
    v_cvt_pk_bf16_f32 v31, v9, v10
    v_perm_b32 v12, v31, v31, s41
    v_bitop3_b32 v34, v4, v12, v34 bitop3:0xca
    v_perm_b32 v13, v31, v31, s42
    v_bitop3_b32 v35, v4, v13, v35 bitop3:0xca
    v_lshrrev_b32 v8, 2, v0
    v_and_b32 v7, 0x3c00, v0
    v_bitop3_b32 v7, v5, v8, v7 bitop3:0xea
    s_waitcnt lgkmcnt(0)
    s_barrier
    ds_read2st64_b32 v[8:9], v7 offset0:0 offset1:1
    ds_read2st64_b32 v[10:11], v7 offset0:2 offset1:3
    s_add_u32 s46, s35, 0x2a44000
    s_add_u32 s46, s46, s93
    buffer_store_dwordx4 v[84:87], v0, s[20:23], s46 offen sc1
    s_add_u32 s47, s96, 0x6000000
    s_lshr_b32 s47, s47, 1
    buffer_load_dwordx2 v[84:85], v1, s[16:19], s47 offen nt
    s_add_u32 s44, s97, 0x6400000
    s_lshr_b32 s44, s44, 1
    buffer_load_dwordx2 v[86:87], v1, s[16:19], s44 offen nt
    s_waitcnt lgkmcnt(0)
    v_lshl_or_b32 v12, v9, 16, v8
    v_lshl_or_b32 v13, v11, 16, v10
    v_mov_b32 v14, v12
    v_mov_b32 v15, v13
    s_nop 0
    v_add_u32_dpp v14, v14, v14 row_shr:1 row_mask:0xf bank_mask:0xf bound_ctrl:1
    v_add_u32_dpp v15, v15, v15 row_shr:1 row_mask:0xf bank_mask:0xf bound_ctrl:1
    s_nop 0
    v_add_u32_dpp v14, v14, v14 row_shr:2 row_mask:0xf bank_mask:0xf bound_ctrl:1
    v_add_u32_dpp v15, v15, v15 row_shr:2 row_mask:0xf bank_mask:0xf bound_ctrl:1
    s_nop 0
    v_add_u32_dpp v14, v14, v14 row_shr:4 row_mask:0xf bank_mask:0xf bound_ctrl:1
    v_add_u32_dpp v15, v15, v15 row_shr:4 row_mask:0xf bank_mask:0xf bound_ctrl:1
    s_nop 0
    v_add_u32_dpp v14, v14, v14 row_shr:8 row_mask:0xf bank_mask:0xf bound_ctrl:1
    v_add_u32_dpp v15, v15, v15 row_shr:8 row_mask:0xf bank_mask:0xf bound_ctrl:1
    s_nop 0
    v_add_u32_dpp v14, v14, v14 row_bcast:15 row_mask:0xa bank_mask:0xf
    v_add_u32_dpp v15, v15, v15 row_bcast:15 row_mask:0xa bank_mask:0xf
    s_nop 0
    v_add_u32_dpp v14, v14, v14 row_bcast:31 row_mask:0xc bank_mask:0xf
    v_add_u32_dpp v15, v15, v15 row_bcast:31 row_mask:0xc bank_mask:0xf
    v_readlane_b32 s48, v14, 63
    v_readlane_b32 s49, v15, 63
    s_lshl_b32 s54, s32, 2
    v_mov_b32 v8, s54
    s_and_b32 s50, s48, 0xffff
    s_lshr_b32 s51, s48, 16
    s_and_b32 s52, s49, 0xffff
    s_lshr_b32 s53, s49, 16
    s_add_u32 s51, s51, s50
    s_add_u32 s52, s52, s51
    s_add_u32 s53, s53, s52
    v_mov_b32 v9, s53
    s_mov_b64 exec, 1
    ds_write_b32 v8, v9 offset:16384
    s_mov_b64 exec, -1
    v_and_b32 v8, 60, v7
    s_waitcnt lgkmcnt(0)
    s_barrier
    ds_read_b32 v9, v8 offset:16384
    s_waitcnt lgkmcnt(0)
    v_add_u32_dpp v9, v9, v9 row_shr:1 row_mask:0xf bank_mask:0xf bound_ctrl:1
    s_nop 1
    v_add_u32_dpp v9, v9, v9 row_shr:2 row_mask:0xf bank_mask:0xf bound_ctrl:1
    s_nop 1
    v_add_u32_dpp v9, v9, v9 row_shr:4 row_mask:0xf bank_mask:0xf bound_ctrl:1
    s_nop 1
    v_add_u32_dpp v9, v9, v9 row_shr:8 row_mask:0xf bank_mask:0xf bound_ctrl:1
    s_nop 0
    v_readlane_b32 s54, v9, s32
    s_sub_u32 s54, s54, s53
    s_add_u32 s50, s50, s54
    s_add_u32 s51, s51, s54
    s_add_u32 s52, s52, s54
    s_pack_ll_b32_b16 s48, s54, s50
    s_pack_ll_b32_b16 s49, s51, s52
    v_add_u32 v14, s48, v14
    v_add_u32 v15, s49, v15
    v_sub_u32 v12, v14, v12
    v_sub_u32 v13, v15, v13
    v_and_b32 v8, 0xffff, v12
    v_lshrrev_b32 v9, 16, v12
    v_and_b32 v10, 0xffff, v13
    v_lshrrev_b32 v11, 16, v13
    ds_write2st64_b32 v7, v8, v9 offset0:0 offset1:1
    ds_write2st64_b32 v7, v10, v11 offset0:2 offset1:3
    v_and_b32 v8, 0x3f0, v0
    v_lshl_add_u32 v8, v8, 1, s36
    ds_write_b64 v8, v[12:13] offset:20480
    s_bitset0_b64 exec, 63
    s_not_b64 exec, exec
    ds_write_b64 v8, v[14:15] offset:20512
    s_mov_b64 exec, -1
    s_waitcnt lgkmcnt(0)
    s_barrier
    s_setprio 3
    ds_add_rtn_u32 v72, v72, v2
    ds_add_rtn_u32 v73, v73, v2
    ds_add_rtn_u32 v74, v74, v2
    ds_add_rtn_u32 v75, v75, v2
    ds_read_b128 v[12:15], v0 offset:20480
    v_cmp_gt_u32 vcc, 8448, v0
    ds_add_rtn_u32 v80, v80, v2
    ds_add_rtn_u32 v81, v81, v2
    ds_add_rtn_u32 v82, v82, v2
    ds_add_rtn_u32 v83, v83, v2
    s_setprio 2
    ds_add_rtn_u32 v104, v104, v2
    ds_add_rtn_u32 v105, v105, v2
    ds_add_rtn_u32 v106, v106, v2
    ds_add_rtn_u32 v107, v107, v2
    s_waitcnt lgkmcnt(8)
    s_cbranch_vccz L1_p3
    s_add_u32 s45, s35, 0x5480000
    s_mov_b64 exec, vcc
    buffer_store_dwordx4 v[12:15], v0, s[24:27], s45 offen sc1
    s_mov_b64 exec, -1
L1_p3:
    s_add_u32 s46, s35, 0x2a48000
    s_add_u32 s46, s46, s72
    buffer_store_dwordx4 v[48:51], v0, s[20:23], s46 offen sc1
    s_add_u32 s47, s97, 0x6400000
    s_nop 0
    v_lshlrev_b32 v48, 1, v1
    buffer_load_dwordx4 v[48:51], v48, s[8:11], s47 offen nt
    ds_add_rtn_u32 v112, v112, v2
    ds_add_rtn_u32 v113, v113, v2
    ds_add_rtn_u32 v114, v114, v2
    ds_add_rtn_u32 v115, v115, v2
    s_setprio 1
    ds_add_rtn_u32 v116, v116, v2
    ds_add_rtn_u32 v117, v117, v2
    ds_add_rtn_u32 v118, v118, v2
    ds_add_rtn_u32 v119, v119, v2
    ds_add_rtn_u32 v16, v16, v2
    ds_add_rtn_u32 v17, v17, v2
    ds_add_rtn_u32 v18, v18, v2
    ds_add_rtn_u32 v19, v19, v2
    s_add_u32 s44, s35, 0x2a48000
    s_add_u32 s44, s44, s73
    buffer_store_dwordx4 v[52:55], v0, s[20:23], s44 offen sc1
    s_add_u32 s45, s97, 0x6400000
    s_nop 0
    v_lshlrev_b32 v52, 1, v1
    buffer_load_dwordx4 v[52:55], v52, s[12:15], s45 offen nt
    s_setprio 0
    ds_add_rtn_u32 v124, v124, v2
    ds_add_rtn_u32 v125, v125, v2
    ds_add_rtn_u32 v126, v126, v2
    ds_add_rtn_u32 v127, v127, v2
    ds_add_rtn_u32 v36, v36, v2
    ds_add_rtn_u32 v37, v37, v2
    ds_add_rtn_u32 v38, v38, v2
    ds_add_rtn_u32 v39, v39, v2
    s_waitcnt lgkmcnt(0)
    s_barrier
    s_setprio 3
    v_and_b32 v7, -4, v72
    v_lshl_add_u32 v8, v72, 2, v7
    ds_write_b32 v8, v68
    v_lshl_add_u32 v7, v7, 2, v72
    ds_write_b8 v7, v64 offset:16
    v_and_b32 v9, -4, v73
    v_lshl_add_u32 v10, v73, 2, v9
    ds_write_b32 v10, v69
    v_lshl_add_u32 v9, v9, 2, v73
    ds_write_b8_d16_hi v9, v64 offset:16
    v_and_b32 v7, -4, v74
    v_lshl_add_u32 v8, v74, 2, v7
    ds_write_b32 v8, v70
    v_lshl_add_u32 v7, v7, 2, v74
    ds_write_b8 v7, v65 offset:16
    v_and_b32 v9, -4, v75
    v_lshl_add_u32 v10, v75, 2, v9
    ds_write_b32 v10, v71
    v_lshl_add_u32 v9, v9, 2, v75
    ds_write_b8_d16_hi v9, v65 offset:16
    s_add_u32 s46, s35, 0x2a48000
    s_add_u32 s46, s46, s85
    buffer_store_dwordx4 v[56:59], v0, s[20:23], s46 offen sc1
    s_add_u32 s47, s98, 0x6800000
    v_lshlrev_b32 v68, 1, v1
    buffer_load_dwordx4 v[68:71], v68, s[8:11], s47 offen nt
    s_add_u32 s44, s98, 0x6800000
    v_lshlrev_b32 v72, 1, v1
    buffer_load_dwordx4 v[72:75], v72, s[12:15], s44 offen nt
    v_and_b32 v7, -4, v80
    v_lshl_add_u32 v8, v80, 2, v7
    ds_write_b32 v8, v76
    v_lshl_add_u32 v7, v7, 2, v80
    ds_write_b8 v7, v66 offset:16
    v_and_b32 v9, -4, v81
    v_lshl_add_u32 v10, v81, 2, v9
    ds_write_b32 v10, v77
    v_lshl_add_u32 v9, v9, 2, v81
    ds_write_b8_d16_hi v9, v66 offset:16
    v_and_b32 v7, -4, v82
    v_lshl_add_u32 v8, v82, 2, v7
    ds_write_b32 v8, v78
    v_lshl_add_u32 v7, v7, 2, v82
    ds_write_b8 v7, v67 offset:16
    v_and_b32 v9, -4, v83
    v_lshl_add_u32 v10, v83, 2, v9
    ds_write_b32 v10, v79
    v_lshl_add_u32 v9, v9, 2, v83
    ds_write_b8_d16_hi v9, v67 offset:16
    s_add_u32 s45, s98, 0x6800000
    s_lshr_b32 s45, s45, 1
    buffer_load_dwordx2 v[56:57], v1, s[16:19], s45 offen nt
    s_add_u32 s46, s99, 0x6c00000
    s_lshr_b32 s46, s46, 1
    buffer_load_dwordx2 v[58:59], v1, s[16:19], s46 offen nt
    s_add_u32 s47, s99, 0x6c00000
    v_lshlrev_b32 v76, 1, v1
    buffer_load_dwordx4 v[76:79], v76, s[8:11], s47 offen nt
    s_setprio 2
    v_and_b32 v7, -4, v104
    v_lshl_add_u32 v8, v104, 2, v7
    ds_write_b32 v8, v96
    v_lshl_add_u32 v7, v7, 2, v104
    ds_write_b8 v7, v88 offset:16
    v_and_b32 v9, -4, v105
    v_lshl_add_u32 v10, v105, 2, v9
    ds_write_b32 v10, v97
    v_lshl_add_u32 v9, v9, 2, v105
    ds_write_b8_d16_hi v9, v88 offset:16
    v_and_b32 v7, -4, v106
    v_lshl_add_u32 v8, v106, 2, v7
    ds_write_b32 v8, v98
    v_lshl_add_u32 v7, v7, 2, v106
    ds_write_b8 v7, v89 offset:16
    v_and_b32 v9, -4, v107
    v_lshl_add_u32 v10, v107, 2, v9
    ds_write_b32 v10, v99
    v_lshl_add_u32 v9, v9, 2, v107
    ds_write_b8_d16_hi v9, v89 offset:16
    s_add_u32 s44, s35, 0x2a48000
    s_add_u32 s44, s44, s91
    buffer_store_dwordx4 v[60:63], v0, s[20:23], s44 offen sc1
    s_add_u32 s45, s99, 0x6c00000
    v_lshlrev_b32 v80, 1, v1
    buffer_load_dwordx4 v[80:83], v80, s[12:15], s45 offen nt
    v_and_b32 v7, -4, v112
    v_lshl_add_u32 v8, v112, 2, v7
    ds_write_b32 v8, v100
    v_lshl_add_u32 v7, v7, 2, v112
    ds_write_b8 v7, v90 offset:16
    v_and_b32 v9, -4, v113
    v_lshl_add_u32 v10, v113, 2, v9
    ds_write_b32 v10, v101
    v_lshl_add_u32 v9, v9, 2, v113
    ds_write_b8_d16_hi v9, v90 offset:16
    v_and_b32 v7, -4, v114
    v_lshl_add_u32 v8, v114, 2, v7
    ds_write_b32 v8, v102
    v_lshl_add_u32 v7, v7, 2, v114
    ds_write_b8 v7, v91 offset:16
    v_and_b32 v9, -4, v115
    v_lshl_add_u32 v10, v115, 2, v9
    ds_write_b32 v10, v103
    v_lshl_add_u32 v9, v9, 2, v115
    ds_write_b8_d16_hi v9, v91 offset:16
    s_add_u32 s46, s96, 0x7000000
    v_lshlrev_b32 v64, 1, v1
    buffer_load_dwordx4 v[64:67], v64, s[8:11], s46 offen nt
    s_add_u32 s47, s96, 0x7000000
    v_lshlrev_b32 v96, 1, v1
    buffer_load_dwordx4 v[96:99], v96, s[12:15], s47 offen nt
    s_setprio 1
    v_and_b32 v7, -4, v116
    v_lshl_add_u32 v8, v116, 2, v7
    ds_write_b32 v8, v108
    v_lshl_add_u32 v7, v7, 2, v116
    ds_write_b8 v7, v120 offset:16
    v_and_b32 v9, -4, v117
    v_lshl_add_u32 v10, v117, 2, v9
    ds_write_b32 v10, v109
    v_lshl_add_u32 v9, v9, 2, v117
    ds_write_b8_d16_hi v9, v120 offset:16
    v_and_b32 v7, -4, v118
    v_lshl_add_u32 v8, v118, 2, v7
    ds_write_b32 v8, v110
    v_lshl_add_u32 v7, v7, 2, v118
    ds_write_b8 v7, v121 offset:16
    v_and_b32 v9, -4, v119
    v_lshl_add_u32 v10, v119, 2, v9
    ds_write_b32 v10, v111
    v_lshl_add_u32 v9, v9, 2, v119
    ds_write_b8_d16_hi v9, v121 offset:16
    s_add_u32 s44, s96, 0x7000000
    s_lshr_b32 s44, s44, 1
    buffer_load_dwordx2 v[104:105], v1, s[16:19], s44 offen nt
    s_add_u32 s45, s97, 0x7400000
    s_lshr_b32 s45, s45, 1
    buffer_load_dwordx2 v[106:107], v1, s[16:19], s45 offen nt
    s_add_u32 s46, s97, 0x7400000
    v_lshlrev_b32 v60, 1, v1
    buffer_load_dwordx4 v[60:63], v60, s[8:11], s46 offen nt
    v_and_b32 v7, -4, v16
    v_lshl_add_u32 v8, v16, 2, v7
    ds_write_b32 v8, v92
    v_lshl_add_u32 v7, v7, 2, v16
    ds_write_b8 v7, v122 offset:16
    v_and_b32 v9, -4, v17
    v_lshl_add_u32 v10, v17, 2, v9
    ds_write_b32 v10, v93
    v_lshl_add_u32 v9, v9, 2, v17
    ds_write_b8_d16_hi v9, v122 offset:16
    v_and_b32 v7, -4, v18
    v_lshl_add_u32 v8, v18, 2, v7
    ds_write_b32 v8, v94
    v_lshl_add_u32 v7, v7, 2, v18
    ds_write_b8 v7, v123 offset:16
    v_and_b32 v9, -4, v19
    v_lshl_add_u32 v10, v19, 2, v9
    ds_write_b32 v10, v95
    v_lshl_add_u32 v9, v9, 2, v19
    ds_write_b8_d16_hi v9, v123 offset:16
    s_add_u32 s47, s35, 0x2a48000
    s_add_u32 s47, s47, s93
    buffer_store_dwordx4 v[44:47], v0, s[20:23], s47 offen sc1
    s_add_u32 s44, s97, 0x7400000
    v_lshlrev_b32 v100, 1, v1
    buffer_load_dwordx4 v[100:103], v100, s[12:15], s44 offen nt
    s_setprio 0
    v_and_b32 v7, -4, v124
    v_lshl_add_u32 v8, v124, 2, v7
    ds_write_b32 v8, v20
    v_lshl_add_u32 v7, v7, 2, v124
    ds_write_b8 v7, v28 offset:16
    v_and_b32 v9, -4, v125
    v_lshl_add_u32 v10, v125, 2, v9
    ds_write_b32 v10, v21
    v_lshl_add_u32 v9, v9, 2, v125
    ds_write_b8_d16_hi v9, v28 offset:16
    v_and_b32 v7, -4, v126
    v_lshl_add_u32 v8, v126, 2, v7
    ds_write_b32 v8, v22
    v_lshl_add_u32 v7, v7, 2, v126
    ds_write_b8 v7, v29 offset:16
    v_and_b32 v9, -4, v127
    v_lshl_add_u32 v10, v127, 2, v9
    ds_write_b32 v10, v23
    v_lshl_add_u32 v9, v9, 2, v127
    ds_write_b8_d16_hi v9, v29 offset:16
    s_add_u32 s45, s98, 0x7800000
    v_lshlrev_b32 v112, 1, v1
    buffer_load_dwordx4 v[112:115], v112, s[8:11], s45 offen nt
    s_add_u32 s46, s98, 0x7800000
    v_lshlrev_b32 v88, 1, v1
    buffer_load_dwordx4 v[88:91], v88, s[12:15], s46 offen nt
    v_and_b32 v7, -4, v36
    v_lshl_add_u32 v8, v36, 2, v7
    ds_write_b32 v8, v32
    v_lshl_add_u32 v7, v7, 2, v36
    ds_write_b8 v7, v30 offset:16
    v_and_b32 v9, -4, v37
    v_lshl_add_u32 v10, v37, 2, v9
    ds_write_b32 v10, v33
    v_lshl_add_u32 v9, v9, 2, v37
    ds_write_b8_d16_hi v9, v30 offset:16
    v_and_b32 v7, -4, v38
    v_lshl_add_u32 v8, v38, 2, v7
    ds_write_b32 v8, v34
    v_lshl_add_u32 v7, v7, 2, v38
    ds_write_b8 v7, v31 offset:16
    v_and_b32 v9, -4, v39
    v_lshl_add_u32 v10, v39, 2, v9
    ds_write_b32 v10, v35
    v_lshl_add_u32 v9, v9, 2, v39
    ds_write_b8_d16_hi v9, v31 offset:16
    s_add_u32 s47, s98, 0x7800000
    s_lshr_b32 s47, s47, 1
    buffer_load_dwordx2 v[108:109], v1, s[16:19], s47 offen nt
    s_add_u32 s44, s99, 0x7c00000
    s_lshr_b32 s44, s44, 1
    buffer_load_dwordx2 v[110:111], v1, s[16:19], s44 offen nt
    v_add_u32 v7, s72, v0
    v_add_u32 v12, s73, v0
    v_add_u32 v13, s85, v0
    v_add_u32 v14, s91, v0
    v_add_u32 v15, s93, v0
    s_min_i32 s3, s72, s73
    s_min_i32 s3, s3, s85
    s_min_i32 s3, s3, s91
    s_min_i32 s3, s3, s93
    v_add_u32 v3, s3, v0
    v_mov_b32 v8, 0
    v_mov_b32 v9, 0
    v_mov_b32 v10, 0
    v_mov_b32 v11, 0
    s_waitcnt lgkmcnt(0)
    s_barrier
    ds_read_b128 v[116:119], v7 offset:0
    ds_read_b128 v[92:95], v12 offset:0
    ds_read_b128 v[16:19], v13 offset:0
    ds_read_b128 v[120:123], v14 offset:0
    ds_read_b128 v[44:47], v15 offset:0
    ds_write_b128 v3, v[8:11]
    ds_read_b128 v[20:23], v7 offset:16384
    ds_read_b128 v[124:127], v12 offset:16384
    ds_read_b128 v[32:35], v13 offset:16384
    ds_read_b128 v[36:39], v14 offset:16384
    ds_read_b128 v[28:31], v15 offset:16384
    s_waitcnt lgkmcnt(0)
    s_barrier
    s_setprio 3
    s_add_u32 s45, s35, 0x5484000
    s_add_u32 s45, s45, s72
    buffer_store_dwordx4 v[116:119], v0, s[20:23], s45 offen sc1
    s_add_u32 s46, s99, 0x7c00000
    s_nop 0
    v_lshlrev_b32 v116, 1, v1
    buffer_load_dwordx4 v[116:119], v116, s[8:11], s46 offen nt
    s_add_u32 s47, s35, 0x5484000
    s_add_u32 s47, s47, s73
    buffer_store_dwordx4 v[92:95], v0, s[20:23], s47 offen sc1
    s_add_u32 s44, s99, 0x7c00000
    s_nop 0
    v_lshlrev_b32 v92, 1, v1
    buffer_load_dwordx4 v[92:95], v92, s[12:15], s44 offen nt
    s_waitcnt vmcnt(27)
    v_lshlrev_b32 v7, 16, v84
    v_and_b32 v8, 0xffff0000, v84
    v_lshlrev_b32 v9, 16, v85
    v_and_b32 v10, 0xffff0000, v85
    v_mul_f32 v7, 0.15915494, v7
    v_mul_f32 v8, 0.15915494, v8
    v_mul_f32 v9, 0.15915494, v9
    v_mul_f32 v10, 0.15915494, v10
    v_mul_hi_u32_u24 v14, 429497, v40
    v_lshrrev_b32 v12, 3, v24
    v_cos_f32 v7, v7
    v_lshlrev_b16 v13, 3, v24
    v_mad_i32_i24 v11, v14, s55, v40
    v_bitop3_b32 v12, v6, v13, v12 bitop3:0xca
    v_lshl_add_u32 v11, v11, 17, s40
    v_lshlrev_b16 v14, 8, v14
    v_lshrrev_b32 v13, 2, v24
    v_add_u32 v40, v12, v11
    v_bitop3_b32 v24, v5, v13, v14 bitop3:0xea
    ds_add_u32 v24, v2
    v_mul_hi_u32_u24 v14, 429497, v41
    v_lshrrev_b32 v12, 3, v25
    v_cos_f32 v8, v8
    v_lshlrev_b16 v13, 3, v25
    v_mad_i32_i24 v11, v14, s55, v41
    v_bitop3_b32 v12, v6, v13, v12 bitop3:0xca
    v_lshl_add_u32 v11, v11, 17, s40
    v_lshlrev_b16 v14, 8, v14
    v_lshrrev_b32 v13, 2, v25
    v_add_u32 v41, v12, v11
    v_bitop3_b32 v25, v5, v13, v14 bitop3:0xea
    ds_add_u32 v25, v2
    v_cvt_pk_bf16_f32 v84, v7, v8
    v_perm_b32 v12, v84, v84, s41
    v_bitop3_b32 v40, v4, v12, v40 bitop3:0xca
    v_perm_b32 v13, v84, v84, s42
    v_bitop3_b32 v41, v4, v13, v41 bitop3:0xca
    v_mul_hi_u32_u24 v14, 429497, v42
    v_lshrrev_b32 v12, 3, v26
    v_cos_f32 v9, v9
    v_lshlrev_b16 v13, 3, v26
    v_mad_i32_i24 v11, v14, s55, v42
    v_bitop3_b32 v12, v6, v13, v12 bitop3:0xca
    v_lshl_add_u32 v11, v11, 17, s40
    v_lshlrev_b16 v14, 8, v14
    v_lshrrev_b32 v13, 2, v26
    v_add_u32 v42, v12, v11
    v_bitop3_b32 v26, v5, v13, v14 bitop3:0xea
    ds_add_u32 v26, v2
    v_mul_hi_u32_u24 v14, 429497, v43
    v_lshrrev_b32 v12, 3, v27
    v_cos_f32 v10, v10
    v_lshlrev_b16 v13, 3, v27
    v_mad_i32_i24 v11, v14, s55, v43
    v_bitop3_b32 v12, v6, v13, v12 bitop3:0xca
    v_lshl_add_u32 v11, v11, 17, s40
    v_lshlrev_b16 v14, 8, v14
    v_lshrrev_b32 v13, 2, v27
    v_add_u32 v43, v12, v11
    v_bitop3_b32 v27, v5, v13, v14 bitop3:0xea
    ds_add_u32 v27, v2
    v_cvt_pk_bf16_f32 v85, v9, v10
    v_perm_b32 v12, v85, v85, s41
    v_bitop3_b32 v42, v4, v12, v42 bitop3:0xca
    v_perm_b32 v13, v85, v85, s42
    v_bitop3_b32 v43, v4, v13, v43 bitop3:0xca
    s_waitcnt vmcnt(23)
    v_lshlrev_b32 v7, 16, v86
    v_and_b32 v8, 0xffff0000, v86
    v_lshlrev_b32 v9, 16, v87
    v_and_b32 v10, 0xffff0000, v87
    v_mul_f32 v7, 0.15915494, v7
    v_mul_f32 v8, 0.15915494, v8
    v_mul_f32 v9, 0.15915494, v9
    v_mul_f32 v10, 0.15915494, v10
    v_mul_hi_u32_u24 v14, 429497, v48
    v_lshrrev_b32 v12, 3, v52
    v_cos_f32 v7, v7
    v_lshlrev_b16 v13, 3, v52
    v_mad_i32_i24 v11, v14, s55, v48
    v_bitop3_b32 v12, v6, v13, v12 bitop3:0xca
    v_lshl_add_u32 v11, v11, 17, s40
    v_lshlrev_b16 v14, 8, v14
    v_lshrrev_b32 v13, 2, v52
    v_add_u32 v48, v12, v11
    v_bitop3_b32 v52, v5, v13, v14 bitop3:0xea
    ds_add_u32 v52, v2
    v_mul_hi_u32_u24 v14, 429497, v49
    v_lshrrev_b32 v12, 3, v53
    v_cos_f32 v8, v8
    v_lshlrev_b16 v13, 3, v53
    v_mad_i32_i24 v11, v14, s55, v49
    v_bitop3_b32 v12, v6, v13, v12 bitop3:0xca
    v_lshl_add_u32 v11, v11, 17, s40
    v_lshlrev_b16 v14, 8, v14
    v_lshrrev_b32 v13, 2, v53
    v_add_u32 v49, v12, v11
    v_bitop3_b32 v53, v5, v13, v14 bitop3:0xea
    ds_add_u32 v53, v2
    v_cvt_pk_bf16_f32 v86, v7, v8
    v_perm_b32 v12, v86, v86, s41
    v_bitop3_b32 v48, v4, v12, v48 bitop3:0xca
    v_perm_b32 v13, v86, v86, s42
    v_bitop3_b32 v49, v4, v13, v49 bitop3:0xca
    v_mul_hi_u32_u24 v14, 429497, v50
    v_lshrrev_b32 v12, 3, v54
    v_cos_f32 v9, v9
    v_lshlrev_b16 v13, 3, v54
    v_mad_i32_i24 v11, v14, s55, v50
    v_bitop3_b32 v12, v6, v13, v12 bitop3:0xca
    v_lshl_add_u32 v11, v11, 17, s40
    v_lshlrev_b16 v14, 8, v14
    v_lshrrev_b32 v13, 2, v54
    v_add_u32 v50, v12, v11
    v_bitop3_b32 v54, v5, v13, v14 bitop3:0xea
    ds_add_u32 v54, v2
    v_mul_hi_u32_u24 v14, 429497, v51
    v_lshrrev_b32 v12, 3, v55
    v_cos_f32 v10, v10
    v_lshlrev_b16 v13, 3, v55
    v_mad_i32_i24 v11, v14, s55, v51
    v_bitop3_b32 v12, v6, v13, v12 bitop3:0xca
    v_lshl_add_u32 v11, v11, 17, s40
    v_lshlrev_b16 v14, 8, v14
    v_lshrrev_b32 v13, 2, v55
    v_add_u32 v51, v12, v11
    v_bitop3_b32 v55, v5, v13, v14 bitop3:0xea
    ds_add_u32 v55, v2
    v_cvt_pk_bf16_f32 v87, v9, v10
    v_perm_b32 v12, v87, v87, s41
    v_bitop3_b32 v50, v4, v12, v50 bitop3:0xca
    v_perm_b32 v13, v87, v87, s42
    v_bitop3_b32 v51, v4, v13, v51 bitop3:0xca
    s_setprio 2
    s_waitcnt vmcnt(18)
    v_lshlrev_b32 v7, 16, v56
    v_and_b32 v8, 0xffff0000, v56
    v_lshlrev_b32 v9, 16, v57
    v_and_b32 v10, 0xffff0000, v57
    v_mul_f32 v7, 0.15915494, v7
    v_mul_f32 v8, 0.15915494, v8
    v_mul_f32 v9, 0.15915494, v9
    v_mul_f32 v10, 0.15915494, v10
    v_mul_hi_u32_u24 v14, 429497, v68
    v_lshrrev_b32 v12, 3, v72
    v_cos_f32 v7, v7
    v_lshlrev_b16 v13, 3, v72
    v_mad_i32_i24 v11, v14, s55, v68
    v_bitop3_b32 v12, v6, v13, v12 bitop3:0xca
    v_lshl_add_u32 v11, v11, 17, s40
    v_lshlrev_b16 v14, 8, v14
    v_lshrrev_b32 v13, 2, v72
    v_add_u32 v68, v12, v11
    v_bitop3_b32 v72, v5, v13, v14 bitop3:0xea
    ds_add_u32 v72, v2
    v_mul_hi_u32_u24 v14, 429497, v69
    v_lshrrev_b32 v12, 3, v73
    v_cos_f32 v8, v8
    v_lshlrev_b16 v13, 3, v73
    v_mad_i32_i24 v11, v14, s55, v69
    v_bitop3_b32 v12, v6, v13, v12 bitop3:0xca
    v_lshl_add_u32 v11, v11, 17, s40
    v_lshlrev_b16 v14, 8, v14
    v_lshrrev_b32 v13, 2, v73
    v_add_u32 v69, v12, v11
    v_bitop3_b32 v73, v5, v13, v14 bitop3:0xea
    ds_add_u32 v73, v2
    v_cvt_pk_bf16_f32 v56, v7, v8
    v_perm_b32 v12, v56, v56, s41
    v_bitop3_b32 v68, v4, v12, v68 bitop3:0xca
    v_perm_b32 v13, v56, v56, s42
    v_bitop3_b32 v69, v4, v13, v69 bitop3:0xca
    v_mul_hi_u32_u24 v14, 429497, v70
    v_lshrrev_b32 v12, 3, v74
    v_cos_f32 v9, v9
    v_lshlrev_b16 v13, 3, v74
    v_mad_i32_i24 v11, v14, s55, v70
    v_bitop3_b32 v12, v6, v13, v12 bitop3:0xca
    v_lshl_add_u32 v11, v11, 17, s40
    v_lshlrev_b16 v14, 8, v14
    v_lshrrev_b32 v13, 2, v74
    v_add_u32 v70, v12, v11
    v_bitop3_b32 v74, v5, v13, v14 bitop3:0xea
    ds_add_u32 v74, v2
    v_mul_hi_u32_u24 v14, 429497, v71
    v_lshrrev_b32 v12, 3, v75
    v_cos_f32 v10, v10
    v_lshlrev_b16 v13, 3, v75
    v_mad_i32_i24 v11, v14, s55, v71
    v_bitop3_b32 v12, v6, v13, v12 bitop3:0xca
    v_lshl_add_u32 v11, v11, 17, s40
    v_lshlrev_b16 v14, 8, v14
    v_lshrrev_b32 v13, 2, v75
    v_add_u32 v71, v12, v11
    v_bitop3_b32 v75, v5, v13, v14 bitop3:0xea
    ds_add_u32 v75, v2
    v_cvt_pk_bf16_f32 v57, v9, v10
    v_perm_b32 v12, v57, v57, s41
    v_bitop3_b32 v70, v4, v12, v70 bitop3:0xca
    v_perm_b32 v13, v57, v57, s42
    v_bitop3_b32 v71, v4, v13, v71 bitop3:0xca
    s_add_u32 s45, s35, 0x5484000
    s_add_u32 s45, s45, s85
    buffer_store_dwordx4 v[16:19], v0, s[20:23], s45 offen sc1
    s_add_u32 s46, s96, 0x8000000
    s_nop 0
    v_lshlrev_b32 v16, 1, v1
    buffer_load_dwordx4 v[16:19], v16, s[8:11], s46 offen nt
    s_waitcnt vmcnt(17)
    v_lshlrev_b32 v7, 16, v58
    v_and_b32 v8, 0xffff0000, v58
    v_lshlrev_b32 v9, 16, v59
    v_and_b32 v10, 0xffff0000, v59
    v_mul_f32 v7, 0.15915494, v7
    v_mul_f32 v8, 0.15915494, v8
    v_mul_f32 v9, 0.15915494, v9
    v_mul_f32 v10, 0.15915494, v10
    v_mul_hi_u32_u24 v14, 429497, v76
    v_lshrrev_b32 v12, 3, v80
    v_cos_f32 v7, v7
    v_lshlrev_b16 v13, 3, v80
    v_mad_i32_i24 v11, v14, s55, v76
    v_bitop3_b32 v12, v6, v13, v12 bitop3:0xca
    v_lshl_add_u32 v11, v11, 17, s40
    v_lshlrev_b16 v14, 8, v14
    v_lshrrev_b32 v13, 2, v80
    v_add_u32 v76, v12, v11
    v_bitop3_b32 v80, v5, v13, v14 bitop3:0xea
    ds_add_u32 v80, v2
    v_mul_hi_u32_u24 v14, 429497, v77
    v_lshrrev_b32 v12, 3, v81
    v_cos_f32 v8, v8
    v_lshlrev_b16 v13, 3, v81
    v_mad_i32_i24 v11, v14, s55, v77
    v_bitop3_b32 v12, v6, v13, v12 bitop3:0xca
    v_lshl_add_u32 v11, v11, 17, s40
    v_lshlrev_b16 v14, 8, v14
    v_lshrrev_b32 v13, 2, v81
    v_add_u32 v77, v12, v11
    v_bitop3_b32 v81, v5, v13, v14 bitop3:0xea
    ds_add_u32 v81, v2
    v_cvt_pk_bf16_f32 v58, v7, v8
    v_perm_b32 v12, v58, v58, s41
    v_bitop3_b32 v76, v4, v12, v76 bitop3:0xca
    v_perm_b32 v13, v58, v58, s42
    v_bitop3_b32 v77, v4, v13, v77 bitop3:0xca
    v_mul_hi_u32_u24 v14, 429497, v78
    v_lshrrev_b32 v12, 3, v82
    v_cos_f32 v9, v9
    v_lshlrev_b16 v13, 3, v82
    v_mad_i32_i24 v11, v14, s55, v78
    v_bitop3_b32 v12, v6, v13, v12 bitop3:0xca
    v_lshl_add_u32 v11, v11, 17, s40
    v_lshlrev_b16 v14, 8, v14
    v_lshrrev_b32 v13, 2, v82
    v_add_u32 v78, v12, v11
    v_bitop3_b32 v82, v5, v13, v14 bitop3:0xea
    ds_add_u32 v82, v2
    v_mul_hi_u32_u24 v14, 429497, v79
    v_lshrrev_b32 v12, 3, v83
    v_cos_f32 v10, v10
    v_lshlrev_b16 v13, 3, v83
    v_mad_i32_i24 v11, v14, s55, v79
    v_bitop3_b32 v12, v6, v13, v12 bitop3:0xca
    v_lshl_add_u32 v11, v11, 17, s40
    v_lshlrev_b16 v14, 8, v14
    v_lshrrev_b32 v13, 2, v83
    v_add_u32 v79, v12, v11
    v_bitop3_b32 v83, v5, v13, v14 bitop3:0xea
    ds_add_u32 v83, v2
    v_cvt_pk_bf16_f32 v59, v9, v10
    v_perm_b32 v12, v59, v59, s41
    v_bitop3_b32 v78, v4, v12, v78 bitop3:0xca
    v_perm_b32 v13, v59, v59, s42
    v_bitop3_b32 v79, v4, v13, v79 bitop3:0xca
    s_setprio 1
    s_waitcnt vmcnt(13)
    v_lshlrev_b32 v7, 16, v104
    v_and_b32 v8, 0xffff0000, v104
    v_lshlrev_b32 v9, 16, v105
    v_and_b32 v10, 0xffff0000, v105
    v_mul_f32 v7, 0.15915494, v7
    v_mul_f32 v8, 0.15915494, v8
    v_mul_f32 v9, 0.15915494, v9
    v_mul_f32 v10, 0.15915494, v10
    v_mul_hi_u32_u24 v14, 429497, v64
    v_lshrrev_b32 v12, 3, v96
    v_cos_f32 v7, v7
    v_lshlrev_b16 v13, 3, v96
    v_mad_i32_i24 v11, v14, s55, v64
    v_bitop3_b32 v12, v6, v13, v12 bitop3:0xca
    v_lshl_add_u32 v11, v11, 17, s40
    v_lshlrev_b16 v14, 8, v14
    v_lshrrev_b32 v13, 2, v96
    v_add_u32 v64, v12, v11
    v_bitop3_b32 v96, v5, v13, v14 bitop3:0xea
    ds_add_u32 v96, v2
    v_mul_hi_u32_u24 v14, 429497, v65
    v_lshrrev_b32 v12, 3, v97
    v_cos_f32 v8, v8
    v_lshlrev_b16 v13, 3, v97
    v_mad_i32_i24 v11, v14, s55, v65
    v_bitop3_b32 v12, v6, v13, v12 bitop3:0xca
    v_lshl_add_u32 v11, v11, 17, s40
    v_lshlrev_b16 v14, 8, v14
    v_lshrrev_b32 v13, 2, v97
    v_add_u32 v65, v12, v11
    v_bitop3_b32 v97, v5, v13, v14 bitop3:0xea
    ds_add_u32 v97, v2
    v_cvt_pk_bf16_f32 v104, v7, v8
    v_perm_b32 v12, v104, v104, s41
    v_bitop3_b32 v64, v4, v12, v64 bitop3:0xca
    v_perm_b32 v13, v104, v104, s42
    v_bitop3_b32 v65, v4, v13, v65 bitop3:0xca
    v_mul_hi_u32_u24 v14, 429497, v66
    v_lshrrev_b32 v12, 3, v98
    v_cos_f32 v9, v9
    v_lshlrev_b16 v13, 3, v98
    v_mad_i32_i24 v11, v14, s55, v66
    v_bitop3_b32 v12, v6, v13, v12 bitop3:0xca
    v_lshl_add_u32 v11, v11, 17, s40
    v_lshlrev_b16 v14, 8, v14
    v_lshrrev_b32 v13, 2, v98
    v_add_u32 v66, v12, v11
    v_bitop3_b32 v98, v5, v13, v14 bitop3:0xea
    ds_add_u32 v98, v2
    v_mul_hi_u32_u24 v14, 429497, v67
    v_lshrrev_b32 v12, 3, v99
    v_cos_f32 v10, v10
    v_lshlrev_b16 v13, 3, v99
    v_mad_i32_i24 v11, v14, s55, v67
    v_bitop3_b32 v12, v6, v13, v12 bitop3:0xca
    v_lshl_add_u32 v11, v11, 17, s40
    v_lshlrev_b16 v14, 8, v14
    v_lshrrev_b32 v13, 2, v99
    v_add_u32 v67, v12, v11
    v_bitop3_b32 v99, v5, v13, v14 bitop3:0xea
    ds_add_u32 v99, v2
    v_cvt_pk_bf16_f32 v105, v9, v10
    v_perm_b32 v12, v105, v105, s41
    v_bitop3_b32 v66, v4, v12, v66 bitop3:0xca
    v_perm_b32 v13, v105, v105, s42
    v_bitop3_b32 v67, v4, v13, v67 bitop3:0xca
    s_mov_b32 s68, s66
    s_mov_b32 s69, s67
    s_mov_b32 s70, 0x100
    s_mov_b32 s71, 0x20000
    v_mov_b32 v3, 1
    s_cmp_lg_u32 s32, 15
    s_cbranch_scc1 L1_tk
    s_mov_b64 exec, 1
    s_and_b32 s3, s2, 1
    s_lshl_b32 s3, s3, 7
    buffer_atomic_add v3, off, s[68:71], s3 sc0
    s_mov_b64 exec, -1
L1_tk:
    s_waitcnt vmcnt(10)
    v_lshlrev_b32 v7, 16, v106
    v_and_b32 v8, 0xffff0000, v106
    v_lshlrev_b32 v9, 16, v107
    v_and_b32 v10, 0xffff0000, v107
    v_mul_f32 v7, 0.15915494, v7
    v_mul_f32 v8, 0.15915494, v8
    v_mul_f32 v9, 0.15915494, v9
    v_mul_f32 v10, 0.15915494, v10
    v_mul_hi_u32_u24 v14, 429497, v60
    v_lshrrev_b32 v12, 3, v100
    v_cos_f32 v7, v7
    v_lshlrev_b16 v13, 3, v100
    v_mad_i32_i24 v11, v14, s55, v60
    v_bitop3_b32 v12, v6, v13, v12 bitop3:0xca
    v_lshl_add_u32 v11, v11, 17, s40
    v_lshlrev_b16 v14, 8, v14
    v_lshrrev_b32 v13, 2, v100
    v_add_u32 v60, v12, v11
    v_bitop3_b32 v100, v5, v13, v14 bitop3:0xea
    ds_add_u32 v100, v2
    v_mul_hi_u32_u24 v14, 429497, v61
    v_lshrrev_b32 v12, 3, v101
    v_cos_f32 v8, v8
    v_lshlrev_b16 v13, 3, v101
    v_mad_i32_i24 v11, v14, s55, v61
    v_bitop3_b32 v12, v6, v13, v12 bitop3:0xca
    v_lshl_add_u32 v11, v11, 17, s40
    v_lshlrev_b16 v14, 8, v14
    v_lshrrev_b32 v13, 2, v101
    v_add_u32 v61, v12, v11
    v_bitop3_b32 v101, v5, v13, v14 bitop3:0xea
    ds_add_u32 v101, v2
    v_cvt_pk_bf16_f32 v106, v7, v8
    v_perm_b32 v12, v106, v106, s41
    v_bitop3_b32 v60, v4, v12, v60 bitop3:0xca
    v_perm_b32 v13, v106, v106, s42
    v_bitop3_b32 v61, v4, v13, v61 bitop3:0xca
    v_mul_hi_u32_u24 v14, 429497, v62
    v_lshrrev_b32 v12, 3, v102
    v_cos_f32 v9, v9
    v_lshlrev_b16 v13, 3, v102
    v_mad_i32_i24 v11, v14, s55, v62
    v_bitop3_b32 v12, v6, v13, v12 bitop3:0xca
    v_lshl_add_u32 v11, v11, 17, s40
    v_lshlrev_b16 v14, 8, v14
    v_lshrrev_b32 v13, 2, v102
    v_add_u32 v62, v12, v11
    v_bitop3_b32 v102, v5, v13, v14 bitop3:0xea
    ds_add_u32 v102, v2
    v_mul_hi_u32_u24 v14, 429497, v63
    v_lshrrev_b32 v12, 3, v103
    v_cos_f32 v10, v10
    v_lshlrev_b16 v13, 3, v103
    v_mad_i32_i24 v11, v14, s55, v63
    v_bitop3_b32 v12, v6, v13, v12 bitop3:0xca
    v_lshl_add_u32 v11, v11, 17, s40
    v_lshlrev_b16 v14, 8, v14
    v_lshrrev_b32 v13, 2, v103
    v_add_u32 v63, v12, v11
    v_bitop3_b32 v103, v5, v13, v14 bitop3:0xea
    ds_add_u32 v103, v2
    v_cvt_pk_bf16_f32 v107, v9, v10
    v_perm_b32 v12, v107, v107, s41
    v_bitop3_b32 v62, v4, v12, v62 bitop3:0xca
    v_perm_b32 v13, v107, v107, s42
    v_bitop3_b32 v63, v4, v13, v63 bitop3:0xca
    s_setprio 0
    s_add_u32 s47, s35, 0x5484000
    s_add_u32 s47, s47, s91
    buffer_store_dwordx4 v[120:123], v0, s[20:23], s47 offen sc1
    s_add_u32 s44, s96, 0x8000000
    s_nop 0
    v_lshlrev_b32 v120, 1, v1
    buffer_load_dwordx4 v[120:123], v120, s[12:15], s44 offen nt
    s_waitcnt vmcnt(8)
    v_lshlrev_b32 v7, 16, v108
    v_and_b32 v8, 0xffff0000, v108
    v_lshlrev_b32 v9, 16, v109
    v_and_b32 v10, 0xffff0000, v109
    v_mul_f32 v7, 0.15915494, v7
    v_mul_f32 v8, 0.15915494, v8
    v_mul_f32 v9, 0.15915494, v9
    v_mul_f32 v10, 0.15915494, v10
    v_mul_hi_u32_u24 v14, 429497, v112
    v_lshrrev_b32 v12, 3, v88
    v_cos_f32 v7, v7
    v_lshlrev_b16 v13, 3, v88
    v_mad_i32_i24 v11, v14, s55, v112
    v_bitop3_b32 v12, v6, v13, v12 bitop3:0xca
    v_lshl_add_u32 v11, v11, 17, s40
    v_lshlrev_b16 v14, 8, v14
    v_lshrrev_b32 v13, 2, v88
    v_add_u32 v112, v12, v11
    v_bitop3_b32 v88, v5, v13, v14 bitop3:0xea
    ds_add_u32 v88, v2
    v_mul_hi_u32_u24 v14, 429497, v113
    v_lshrrev_b32 v12, 3, v89
    v_cos_f32 v8, v8
    v_lshlrev_b16 v13, 3, v89
    v_mad_i32_i24 v11, v14, s55, v113
    v_bitop3_b32 v12, v6, v13, v12 bitop3:0xca
    v_lshl_add_u32 v11, v11, 17, s40
    v_lshlrev_b16 v14, 8, v14
    v_lshrrev_b32 v13, 2, v89
    v_add_u32 v113, v12, v11
    v_bitop3_b32 v89, v5, v13, v14 bitop3:0xea
    ds_add_u32 v89, v2
    v_cvt_pk_bf16_f32 v108, v7, v8
    v_perm_b32 v12, v108, v108, s41
    v_bitop3_b32 v112, v4, v12, v112 bitop3:0xca
    v_perm_b32 v13, v108, v108, s42
    v_bitop3_b32 v113, v4, v13, v113 bitop3:0xca
    v_mul_hi_u32_u24 v14, 429497, v114
    v_lshrrev_b32 v12, 3, v90
    v_cos_f32 v9, v9
    v_lshlrev_b16 v13, 3, v90
    v_mad_i32_i24 v11, v14, s55, v114
    v_bitop3_b32 v12, v6, v13, v12 bitop3:0xca
    v_lshl_add_u32 v11, v11, 17, s40
    v_lshlrev_b16 v14, 8, v14
    v_lshrrev_b32 v13, 2, v90
    v_add_u32 v114, v12, v11
    v_bitop3_b32 v90, v5, v13, v14 bitop3:0xea
    ds_add_u32 v90, v2
    v_mul_hi_u32_u24 v14, 429497, v115
    v_lshrrev_b32 v12, 3, v91
    v_cos_f32 v10, v10
    v_lshlrev_b16 v13, 3, v91
    v_mad_i32_i24 v11, v14, s55, v115
    v_bitop3_b32 v12, v6, v13, v12 bitop3:0xca
    v_lshl_add_u32 v11, v11, 17, s40
    v_lshlrev_b16 v14, 8, v14
    v_lshrrev_b32 v13, 2, v91
    v_add_u32 v115, v12, v11
    v_bitop3_b32 v91, v5, v13, v14 bitop3:0xea
    ds_add_u32 v91, v2
    v_cvt_pk_bf16_f32 v109, v9, v10
    v_perm_b32 v12, v109, v109, s41
    v_bitop3_b32 v114, v4, v12, v114 bitop3:0xca
    v_perm_b32 v13, v109, v109, s42
    v_bitop3_b32 v115, v4, v13, v115 bitop3:0xca
    s_waitcnt vmcnt(4)
    v_lshlrev_b32 v7, 16, v110
    v_and_b32 v8, 0xffff0000, v110
    v_lshlrev_b32 v9, 16, v111
    v_and_b32 v10, 0xffff0000, v111
    v_mul_f32 v7, 0.15915494, v7
    v_mul_f32 v8, 0.15915494, v8
    v_mul_f32 v9, 0.15915494, v9
    v_mul_f32 v10, 0.15915494, v10
    v_mul_hi_u32_u24 v14, 429497, v116
    v_lshrrev_b32 v12, 3, v92
    v_cos_f32 v7, v7
    v_lshlrev_b16 v13, 3, v92
    v_mad_i32_i24 v11, v14, s55, v116
    v_bitop3_b32 v12, v6, v13, v12 bitop3:0xca
    v_lshl_add_u32 v11, v11, 17, s40
    v_lshlrev_b16 v14, 8, v14
    v_lshrrev_b32 v13, 2, v92
    v_add_u32 v116, v12, v11
    v_bitop3_b32 v92, v5, v13, v14 bitop3:0xea
    ds_add_u32 v92, v2
    v_mul_hi_u32_u24 v14, 429497, v117
    v_lshrrev_b32 v12, 3, v93
    v_cos_f32 v8, v8
    v_lshlrev_b16 v13, 3, v93
    v_mad_i32_i24 v11, v14, s55, v117
    v_bitop3_b32 v12, v6, v13, v12 bitop3:0xca
    v_lshl_add_u32 v11, v11, 17, s40
    v_lshlrev_b16 v14, 8, v14
    v_lshrrev_b32 v13, 2, v93
    v_add_u32 v117, v12, v11
    v_bitop3_b32 v93, v5, v13, v14 bitop3:0xea
    ds_add_u32 v93, v2
    v_cvt_pk_bf16_f32 v110, v7, v8
    v_perm_b32 v12, v110, v110, s41
    v_bitop3_b32 v116, v4, v12, v116 bitop3:0xca
    v_perm_b32 v13, v110, v110, s42
    v_bitop3_b32 v117, v4, v13, v117 bitop3:0xca
    v_mul_hi_u32_u24 v14, 429497, v118
    v_lshrrev_b32 v12, 3, v94
    v_cos_f32 v9, v9
    v_lshlrev_b16 v13, 3, v94
    v_mad_i32_i24 v11, v14, s55, v118
    v_bitop3_b32 v12, v6, v13, v12 bitop3:0xca
    v_lshl_add_u32 v11, v11, 17, s40
    v_lshlrev_b16 v14, 8, v14
    v_lshrrev_b32 v13, 2, v94
    v_add_u32 v118, v12, v11
    v_bitop3_b32 v94, v5, v13, v14 bitop3:0xea
    ds_add_u32 v94, v2
    v_mul_hi_u32_u24 v14, 429497, v119
    v_lshrrev_b32 v12, 3, v95
    v_cos_f32 v10, v10
    v_lshlrev_b16 v13, 3, v95
    v_mad_i32_i24 v11, v14, s55, v119
    v_bitop3_b32 v12, v6, v13, v12 bitop3:0xca
    v_lshl_add_u32 v11, v11, 17, s40
    v_lshlrev_b16 v14, 8, v14
    v_lshrrev_b32 v13, 2, v95
    v_add_u32 v119, v12, v11
    v_bitop3_b32 v95, v5, v13, v14 bitop3:0xea
    ds_add_u32 v95, v2
    v_cvt_pk_bf16_f32 v111, v9, v10
    v_perm_b32 v12, v111, v111, s41
    v_bitop3_b32 v118, v4, v12, v118 bitop3:0xca
    v_perm_b32 v13, v111, v111, s42
    v_bitop3_b32 v119, v4, v13, v119 bitop3:0xca
    v_lshrrev_b32 v8, 2, v0
    v_and_b32 v7, 0x3c00, v0
    v_bitop3_b32 v7, v5, v8, v7 bitop3:0xea
    s_waitcnt lgkmcnt(0)
    s_barrier
    ds_read2st64_b32 v[8:9], v7 offset0:0 offset1:1
    ds_read2st64_b32 v[10:11], v7 offset0:2 offset1:3
    s_add_u32 s45, s35, 0x5484000
    s_add_u32 s45, s45, s93
    buffer_store_dwordx4 v[44:47], v0, s[20:23], s45 offen sc1
    s_add_u32 s46, s96, 0x8000000
    s_lshr_b32 s46, s46, 1
    buffer_load_dwordx2 v[44:45], v1, s[16:19], s46 offen nt
    s_add_u32 s47, s97, 0x8400000
    s_lshr_b32 s47, s47, 1
    buffer_load_dwordx2 v[46:47], v1, s[16:19], s47 offen nt
    s_waitcnt lgkmcnt(0)
    v_lshl_or_b32 v12, v9, 16, v8
    v_lshl_or_b32 v13, v11, 16, v10
    v_mov_b32 v14, v12
    v_mov_b32 v15, v13
    s_nop 0
    v_add_u32_dpp v14, v14, v14 row_shr:1 row_mask:0xf bank_mask:0xf bound_ctrl:1
    v_add_u32_dpp v15, v15, v15 row_shr:1 row_mask:0xf bank_mask:0xf bound_ctrl:1
    s_nop 0
    v_add_u32_dpp v14, v14, v14 row_shr:2 row_mask:0xf bank_mask:0xf bound_ctrl:1
    v_add_u32_dpp v15, v15, v15 row_shr:2 row_mask:0xf bank_mask:0xf bound_ctrl:1
    s_nop 0
    v_add_u32_dpp v14, v14, v14 row_shr:4 row_mask:0xf bank_mask:0xf bound_ctrl:1
    v_add_u32_dpp v15, v15, v15 row_shr:4 row_mask:0xf bank_mask:0xf bound_ctrl:1
    s_nop 0
    v_add_u32_dpp v14, v14, v14 row_shr:8 row_mask:0xf bank_mask:0xf bound_ctrl:1
    v_add_u32_dpp v15, v15, v15 row_shr:8 row_mask:0xf bank_mask:0xf bound_ctrl:1
    s_nop 0
    v_add_u32_dpp v14, v14, v14 row_bcast:15 row_mask:0xa bank_mask:0xf
    v_add_u32_dpp v15, v15, v15 row_bcast:15 row_mask:0xa bank_mask:0xf
    s_nop 0
    v_add_u32_dpp v14, v14, v14 row_bcast:31 row_mask:0xc bank_mask:0xf
    v_add_u32_dpp v15, v15, v15 row_bcast:31 row_mask:0xc bank_mask:0xf
    v_readlane_b32 s48, v14, 63
    v_readlane_b32 s49, v15, 63
    s_lshl_b32 s54, s32, 2
    v_mov_b32 v8, s54
    s_and_b32 s50, s48, 0xffff
    s_lshr_b32 s51, s48, 16
    s_and_b32 s52, s49, 0xffff
    s_lshr_b32 s53, s49, 16
    s_add_u32 s51, s51, s50
    s_add_u32 s52, s52, s51
    s_add_u32 s53, s53, s52
    v_mov_b32 v9, s53
    s_mov_b64 exec, 1
    ds_write_b32 v8, v9 offset:16384
    s_cmp_lg_u32 s32, 15
    s_cbranch_scc1 L1_tk2
    s_waitcnt vmcnt(3)
L1_tk2:
    ds_write_b32 v8, v3 offset:16448
    s_mov_b64 exec, -1
    v_and_b32 v8, 60, v7
    s_waitcnt lgkmcnt(0)
    s_barrier
    ds_read_b32 v9, v8 offset:16384
    ds_read_b32 v10, v8 offset:16448
    s_waitcnt lgkmcnt(0)
    v_readlane_b32 s84, v10, 15
    s_and_b32 s3, s2, 1
    s_lshl_b32 s3, s3, 7
    s_add_u32 s84, s84, s3
    s_min_u32 s4, s84, 72
    s_min_u32 s5, s84, 216
    s_min_u32 s6, s84, 240
    s_add_u32 s4, s4, s5
    s_add_u32 s4, s4, s6
    s_add_u32 s4, s4, 9467
    s_mov_b32 s4, s84
    s_lshl_b32 s58, s4, 14
    s_lshl_b32 s5, s32, 10
    s_add_u32 s58, s58, s5
    s_lshr_b32 s59, s58, 1
    s_mov_b32 s43, 5
    s_cmp_lt_u32 s84, 72
    s_addc_u32 s43, s43, 0
    s_cmp_lt_u32 s84, 216
    s_addc_u32 s43, s43, 0
    s_cmp_lt_u32 s84, 240
    s_addc_u32 s43, s43, 0
    v_add_u32_dpp v9, v9, v9 row_shr:1 row_mask:0xf bank_mask:0xf bound_ctrl:1
    s_nop 1
    v_add_u32_dpp v9, v9, v9 row_shr:2 row_mask:0xf bank_mask:0xf bound_ctrl:1
    s_nop 1
    v_add_u32_dpp v9, v9, v9 row_shr:4 row_mask:0xf bank_mask:0xf bound_ctrl:1
    s_nop 1
    v_add_u32_dpp v9, v9, v9 row_shr:8 row_mask:0xf bank_mask:0xf bound_ctrl:1
    s_nop 0
    v_readlane_b32 s54, v9, s32
    s_sub_u32 s54, s54, s53
    s_add_u32 s50, s50, s54
    s_add_u32 s51, s51, s54
    s_add_u32 s52, s52, s54
    s_pack_ll_b32_b16 s48, s54, s50
    s_pack_ll_b32_b16 s49, s51, s52
    v_add_u32 v14, s48, v14
    v_add_u32 v15, s49, v15
    v_sub_u32 v12, v14, v12
    v_sub_u32 v13, v15, v13
    v_and_b32 v8, 0xffff, v12
    v_lshrrev_b32 v9, 16, v12
    v_and_b32 v10, 0xffff, v13
    v_lshrrev_b32 v11, 16, v13
    ds_write2st64_b32 v7, v8, v9 offset0:0 offset1:1
    ds_write2st64_b32 v7, v10, v11 offset0:2 offset1:3
    v_and_b32 v8, 0x3f0, v0
    v_lshl_add_u32 v8, v8, 1, s36
    ds_write_b64 v8, v[12:13] offset:20480
    s_bitset0_b64 exec, 63
    s_not_b64 exec, exec
    ds_write_b64 v8, v[14:15] offset:20512
    s_mov_b64 exec, -1
    s_waitcnt lgkmcnt(0)
    s_barrier
    s_setprio 3
    ds_add_rtn_u32 v24, v24, v2
    ds_add_rtn_u32 v25, v25, v2
    ds_add_rtn_u32 v26, v26, v2
    ds_add_rtn_u32 v27, v27, v2
    ds_read_b128 v[12:15], v0 offset:20480
    v_cmp_gt_u32 vcc, 8448, v0
    ds_add_rtn_u32 v52, v52, v2
    ds_add_rtn_u32 v53, v53, v2
    ds_add_rtn_u32 v54, v54, v2
    ds_add_rtn_u32 v55, v55, v2
    s_setprio 2
    ds_add_rtn_u32 v72, v72, v2
    ds_add_rtn_u32 v73, v73, v2
    ds_add_rtn_u32 v74, v74, v2
    ds_add_rtn_u32 v75, v75, v2
    s_waitcnt lgkmcnt(8)
    s_cbranch_vccz L1_p4
    s_add_u32 s44, s35, 0x7ec0000
    s_mov_b64 exec, vcc
    buffer_store_dwordx4 v[12:15], v0, s[24:27], s44 offen sc1
    s_mov_b64 exec, -1
L1_p4:
    s_add_u32 s45, s35, 0x5488000
    s_add_u32 s45, s45, s72
    buffer_store_dwordx4 v[20:23], v0, s[20:23], s45 offen sc1
    s_add_u32 s46, s97, 0x8400000
    s_nop 0
    v_lshlrev_b32 v20, 1, v1
    buffer_load_dwordx4 v[20:23], v20, s[8:11], s46 offen nt
    ds_add_rtn_u32 v80, v80, v2
    ds_add_rtn_u32 v81, v81, v2
    ds_add_rtn_u32 v82, v82, v2
    ds_add_rtn_u32 v83, v83, v2
    s_setprio 1
    ds_add_rtn_u32 v96, v96, v2
    ds_add_rtn_u32 v97, v97, v2
    ds_add_rtn_u32 v98, v98, v2
    ds_add_rtn_u32 v99, v99, v2
    ds_add_rtn_u32 v100, v100, v2
    ds_add_rtn_u32 v101, v101, v2
    ds_add_rtn_u32 v102, v102, v2
    ds_add_rtn_u32 v103, v103, v2
    s_add_u32 s47, s35, 0x5488000
    s_add_u32 s47, s47, s73
    buffer_store_dwordx4 v[124:127], v0, s[20:23], s47 offen sc1
    s_add_u32 s44, s97, 0x8400000
    s_nop 0
    v_lshlrev_b32 v124, 1, v1
    buffer_load_dwordx4 v[124:127], v124, s[12:15], s44 offen nt
    s_setprio 0
    ds_add_rtn_u32 v88, v88, v2
    ds_add_rtn_u32 v89, v89, v2
    ds_add_rtn_u32 v90, v90, v2
    ds_add_rtn_u32 v91, v91, v2
    ds_add_rtn_u32 v92, v92, v2
    ds_add_rtn_u32 v93, v93, v2
    ds_add_rtn_u32 v94, v94, v2
    ds_add_rtn_u32 v95, v95, v2
    s_waitcnt lgkmcnt(0)
    s_barrier
    s_setprio 3
    v_and_b32 v7, -4, v24
    v_lshl_add_u32 v8, v24, 2, v7
    ds_write_b32 v8, v40
    v_lshl_add_u32 v7, v7, 2, v24
    ds_write_b8 v7, v84 offset:16
    v_and_b32 v9, -4, v25
    v_lshl_add_u32 v10, v25, 2, v9
    ds_write_b32 v10, v41
    v_lshl_add_u32 v9, v9, 2, v25
    ds_write_b8_d16_hi v9, v84 offset:16
    v_and_b32 v7, -4, v26
    v_lshl_add_u32 v8, v26, 2, v7
    ds_write_b32 v8, v42
    v_lshl_add_u32 v7, v7, 2, v26
    ds_write_b8 v7, v85 offset:16
    v_and_b32 v9, -4, v27
    v_lshl_add_u32 v10, v27, 2, v9
    ds_write_b32 v10, v43
    v_lshl_add_u32 v9, v9, 2, v27
    ds_write_b8_d16_hi v9, v85 offset:16
    s_add_u32 s45, s35, 0x5488000
    s_add_u32 s45, s45, s85
    buffer_store_dwordx4 v[32:35], v0, s[20:23], s45 offen sc1
    s_add_u32 s46, s98, 0x8800000
    v_lshlrev_b32 v40, 1, v1
    buffer_load_dwordx4 v[40:43], v40, s[8:11], s46 offen nt
    s_add_u32 s47, s98, 0x8800000
    v_lshlrev_b32 v24, 1, v1
    buffer_load_dwordx4 v[24:27], v24, s[12:15], s47 offen nt
    v_and_b32 v7, -4, v52
    v_lshl_add_u32 v8, v52, 2, v7
    ds_write_b32 v8, v48
    v_lshl_add_u32 v7, v7, 2, v52
    ds_write_b8 v7, v86 offset:16
    v_and_b32 v9, -4, v53
    v_lshl_add_u32 v10, v53, 2, v9
    ds_write_b32 v10, v49
    v_lshl_add_u32 v9, v9, 2, v53
    ds_write_b8_d16_hi v9, v86 offset:16
    v_and_b32 v7, -4, v54
    v_lshl_add_u32 v8, v54, 2, v7
    ds_write_b32 v8, v50
    v_lshl_add_u32 v7, v7, 2, v54
    ds_write_b8 v7, v87 offset:16
    v_and_b32 v9, -4, v55
    v_lshl_add_u32 v10, v55, 2, v9
    ds_write_b32 v10, v51
    v_lshl_add_u32 v9, v9, 2, v55
    ds_write_b8_d16_hi v9, v87 offset:16
    s_add_u32 s44, s98, 0x8800000
    s_lshr_b32 s44, s44, 1
    buffer_load_dwordx2 v[32:33], v1, s[16:19], s44 offen nt
    s_add_u32 s45, s99, 0x8c00000
    s_lshr_b32 s45, s45, 1
    buffer_load_dwordx2 v[34:35], v1, s[16:19], s45 offen nt
    s_add_u32 s46, s99, 0x8c00000
    v_lshlrev_b32 v48, 1, v1
    buffer_load_dwordx4 v[48:51], v48, s[8:11], s46 offen nt
    s_setprio 2
    v_and_b32 v7, -4, v72
    v_lshl_add_u32 v8, v72, 2, v7
    ds_write_b32 v8, v68
    v_lshl_add_u32 v7, v7, 2, v72
    ds_write_b8 v7, v56 offset:16
    v_and_b32 v9, -4, v73
    v_lshl_add_u32 v10, v73, 2, v9
    ds_write_b32 v10, v69
    v_lshl_add_u32 v9, v9, 2, v73
    ds_write_b8_d16_hi v9, v56 offset:16
    v_and_b32 v7, -4, v74
    v_lshl_add_u32 v8, v74, 2, v7
    ds_write_b32 v8, v70
    v_lshl_add_u32 v7, v7, 2, v74
    ds_write_b8 v7, v57 offset:16
    v_and_b32 v9, -4, v75
    v_lshl_add_u32 v10, v75, 2, v9
    ds_write_b32 v10, v71
    v_lshl_add_u32 v9, v9, 2, v75
    ds_write_b8_d16_hi v9, v57 offset:16
    s_add_u32 s47, s35, 0x5488000
    s_add_u32 s47, s47, s91
    buffer_store_dwordx4 v[36:39], v0, s[20:23], s47 offen sc1
    s_add_u32 s44, s99, 0x8c00000
    v_lshlrev_b32 v52, 1, v1
    buffer_load_dwordx4 v[52:55], v52, s[12:15], s44 offen nt
    v_and_b32 v7, -4, v80
    v_lshl_add_u32 v8, v80, 2, v7
    ds_write_b32 v8, v76
    v_lshl_add_u32 v7, v7, 2, v80
    ds_write_b8 v7, v58 offset:16
    v_and_b32 v9, -4, v81
    v_lshl_add_u32 v10, v81, 2, v9
    ds_write_b32 v10, v77
    v_lshl_add_u32 v9, v9, 2, v81
    ds_write_b8_d16_hi v9, v58 offset:16
    v_and_b32 v7, -4, v82
    v_lshl_add_u32 v8, v82, 2, v7
    ds_write_b32 v8, v78
    v_lshl_add_u32 v7, v7, 2, v82
    ds_write_b8 v7, v59 offset:16
    v_and_b32 v9, -4, v83
    v_lshl_add_u32 v10, v83, 2, v9
    ds_write_b32 v10, v79
    v_lshl_add_u32 v9, v9, 2, v83
    ds_write_b8_d16_hi v9, v59 offset:16
    s_add_u32 s45, s96, 0x9000000
    v_lshlrev_b32 v84, 1, v1
    buffer_load_dwordx4 v[84:87], v84, s[8:11], s45 offen nt
    s_add_u32 s46, s96, 0x9000000
    v_lshlrev_b32 v68, 1, v1
    buffer_load_dwordx4 v[68:71], v68, s[12:15], s46 offen nt
    s_setprio 1
    v_and_b32 v7, -4, v96
    v_lshl_add_u32 v8, v96, 2, v7
    ds_write_b32 v8, v64
    v_lshl_add_u32 v7, v7, 2, v96
    ds_write_b8 v7, v104 offset:16
    v_and_b32 v9, -4, v97
    v_lshl_add_u32 v10, v97, 2, v9
    ds_write_b32 v10, v65
    v_lshl_add_u32 v9, v9, 2, v97
    ds_write_b8_d16_hi v9, v104 offset:16
    v_and_b32 v7, -4, v98
    v_lshl_add_u32 v8, v98, 2, v7
    ds_write_b32 v8, v66
    v_lshl_add_u32 v7, v7, 2, v98
    ds_write_b8 v7, v105 offset:16
    v_and_b32 v9, -4, v99
    v_lshl_add_u32 v10, v99, 2, v9
    ds_write_b32 v10, v67
    v_lshl_add_u32 v9, v9, 2, v99
    ds_write_b8_d16_hi v9, v105 offset:16
    s_add_u32 s47, s96, 0x9000000
    s_lshr_b32 s47, s47, 1
    buffer_load_dwordx2 v[72:73], v1, s[16:19], s47 offen nt
    s_cmp_le_u32 s43, 5
    s_cselect_b32 s18, 0, s18
    s_add_u32 s44, s59, 0x4a00000
    buffer_load_dwordx2 v[74:75], v1, s[16:19], s44 offen nt
    s_cmp_le_u32 s43, 5
    s_cselect_b32 s10, 0, s10
    s_add_u32 s45, s58, 0x9400000
    v_lshlrev_b32 v36, 1, v1
    buffer_load_dwordx4 v[36:39], v36, s[8:11], s45 offen nt
    v_and_b32 v7, -4, v100
    v_lshl_add_u32 v8, v100, 2, v7
    ds_write_b32 v8, v60
    v_lshl_add_u32 v7, v7, 2, v100
    ds_write_b8 v7, v106 offset:16
    v_and_b32 v9, -4, v101
    v_lshl_add_u32 v10, v101, 2, v9
    ds_write_b32 v10, v61
    v_lshl_add_u32 v9, v9, 2, v101
    ds_write_b8_d16_hi v9, v106 offset:16
    v_and_b32 v7, -4, v102
    v_lshl_add_u32 v8, v102, 2, v7
    ds_write_b32 v8, v62
    v_lshl_add_u32 v7, v7, 2, v102
    ds_write_b8 v7, v107 offset:16
    v_and_b32 v9, -4, v103
    v_lshl_add_u32 v10, v103, 2, v9
    ds_write_b32 v10, v63
    v_lshl_add_u32 v9, v9, 2, v103
    ds_write_b8_d16_hi v9, v107 offset:16
    s_add_u32 s46, s35, 0x5488000
    s_add_u32 s46, s46, s93
    buffer_store_dwordx4 v[28:31], v0, s[20:23], s46 offen sc1
    s_cmp_le_u32 s43, 5
    s_cselect_b32 s14, 0, s14
    s_add_u32 s47, s58, 0x9400000
    v_lshlrev_b32 v76, 1, v1
    buffer_load_dwordx4 v[76:79], v76, s[12:15], s47 offen nt
    s_setprio 0
    v_and_b32 v7, -4, v88
    v_lshl_add_u32 v8, v88, 2, v7
    ds_write_b32 v8, v112
    v_lshl_add_u32 v7, v7, 2, v88
    ds_write_b8 v7, v108 offset:16
    v_and_b32 v9, -4, v89
    v_lshl_add_u32 v10, v89, 2, v9
    ds_write_b32 v10, v113
    v_lshl_add_u32 v9, v9, 2, v89
    ds_write_b8_d16_hi v9, v108 offset:16
    v_and_b32 v7, -4, v90
    v_lshl_add_u32 v8, v90, 2, v7
    ds_write_b32 v8, v114
    v_lshl_add_u32 v7, v7, 2, v90
    ds_write_b8 v7, v109 offset:16
    v_and_b32 v9, -4, v91
    v_lshl_add_u32 v10, v91, 2, v9
    ds_write_b32 v10, v115
    v_lshl_add_u32 v9, v9, 2, v91
    ds_write_b8_d16_hi v9, v109 offset:16
    s_cmp_le_u32 s43, 6
    s_cselect_b32 s10, 0, s10
    s_add_u32 s44, s58, 0x97c0000
    v_lshlrev_b32 v80, 1, v1
    buffer_load_dwordx4 v[80:83], v80, s[8:11], s44 offen nt
    s_cmp_le_u32 s43, 6
    s_cselect_b32 s14, 0, s14
    s_add_u32 s45, s58, 0x97c0000
    v_lshlrev_b32 v56, 1, v1
    buffer_load_dwordx4 v[56:59], v56, s[12:15], s45 offen nt
    v_and_b32 v7, -4, v92
    v_lshl_add_u32 v8, v92, 2, v7
    ds_write_b32 v8, v116
    v_lshl_add_u32 v7, v7, 2, v92
    ds_write_b8 v7, v110 offset:16
    v_and_b32 v9, -4, v93
    v_lshl_add_u32 v10, v93, 2, v9
    ds_write_b32 v10, v117
    v_lshl_add_u32 v9, v9, 2, v93
    ds_write_b8_d16_hi v9, v110 offset:16
    v_and_b32 v7, -4, v94
    v_lshl_add_u32 v8, v94, 2, v7
    ds_write_b32 v8, v118
    v_lshl_add_u32 v7, v7, 2, v94
    ds_write_b8 v7, v111 offset:16
    v_and_b32 v9, -4, v95
    v_lshl_add_u32 v10, v95, 2, v9
    ds_write_b32 v10, v119
    v_lshl_add_u32 v9, v9, 2, v95
    ds_write_b8_d16_hi v9, v111 offset:16
    s_cmp_le_u32 s43, 6
    s_cselect_b32 s18, 0, s18
    s_add_u32 s46, s59, 0x4be0000
    buffer_load_dwordx2 v[64:65], v1, s[16:19], s46 offen nt
    s_cmp_le_u32 s43, 7
    s_cselect_b32 s18, 0, s18
    s_add_u32 s47, s59, 0x4d90000
    buffer_load_dwordx2 v[66:67], v1, s[16:19], s47 offen nt
    v_add_u32 v7, s72, v0
    v_add_u32 v12, s73, v0
    v_add_u32 v13, s85, v0
    v_add_u32 v14, s91, v0
    v_add_u32 v15, s93, v0
    s_min_i32 s3, s72, s73
    s_min_i32 s3, s3, s85
    s_min_i32 s3, s3, s91
    s_min_i32 s3, s3, s93
    v_add_u32 v3, s3, v0
    v_mov_b32 v8, 0
    v_mov_b32 v9, 0
    v_mov_b32 v10, 0
    v_mov_b32 v11, 0
    s_waitcnt lgkmcnt(0)
    s_barrier
    ds_read_b128 v[96:99], v7 offset:0
    ds_read_b128 v[60:63], v12 offset:0
    ds_read_b128 v[100:103], v13 offset:0
    ds_read_b128 v[104:107], v14 offset:0
    ds_read_b128 v[28:31], v15 offset:0
    ds_write_b128 v3, v[8:11]
    ds_read_b128 v[112:115], v7 offset:16384
    ds_read_b128 v[88:91], v12 offset:16384
    ds_read_b128 v[116:119], v13 offset:16384
    ds_read_b128 v[92:95], v14 offset:16384
    ds_read_b128 v[108:111], v15 offset:16384
    s_waitcnt lgkmcnt(0)
    s_barrier
    v_lshlrev_b32 v3, 3, v0
    v_and_b32 v3, 0x80, v3
    s_cmp_lg_u32 s32, 15
    s_cbranch_scc1 L2_k0
    s_mov_b64 exec, 3
    buffer_load_dword v3, v3, s[68:71], 0 offen sc1
    s_mov_b64 exec, -1
L2_k0:
    s_add_u32 s44, s35, 0x7ec4000
    s_add_u32 s44, s44, s72
    buffer_store_dwordx4 v[96:99], v0, s[20:23], s44 offen sc1
    s_cmp_le_u32 s43, 7
    s_cselect_b32 s10, 0, s10
    s_add_u32 s45, s58, 0x9b20000
    v_lshlrev_b32 v96, 1, v1
    buffer_load_dwordx4 v[96:99], v96, s[8:11], s45 offen nt
    s_add_u32 s46, s35, 0x7ec4000
    s_add_u32 s46, s46, s73
    buffer_store_dwordx4 v[60:63], v0, s[20:23], s46 offen sc1
    s_cmp_le_u32 s43, 7
    s_cselect_b32 s14, 0, s14
    s_add_u32 s47, s58, 0x9b20000
    v_lshlrev_b32 v60, 1, v1
    buffer_load_dwordx4 v[60:63], v60, s[12:15], s47 offen nt
    s_setprio 3
    s_waitcnt vmcnt(27)
    v_lshlrev_b32 v7, 16, v44
    v_and_b32 v8, 0xffff0000, v44
    v_lshlrev_b32 v9, 16, v45
    v_and_b32 v10, 0xffff0000, v45
    v_mul_f32 v7, 0.15915494, v7
    v_mul_f32 v8, 0.15915494, v8
    v_mul_f32 v9, 0.15915494, v9
    v_mul_f32 v10, 0.15915494, v10
    v_mul_hi_u32_u24 v14, 429497, v16
    v_lshrrev_b32 v12, 3, v120
    v_cos_f32 v7, v7
    v_lshlrev_b16 v13, 3, v120
    v_mad_i32_i24 v11, v14, s55, v16
    v_bitop3_b32 v12, v6, v13, v12 bitop3:0xca
    v_lshl_add_u32 v11, v11, 17, s40
    v_lshlrev_b16 v14, 8, v14
    v_lshrrev_b32 v13, 2, v120
    v_add_u32 v16, v12, v11
    v_bitop3_b32 v120, v5, v13, v14 bitop3:0xea
    ds_add_u32 v120, v2
    v_mul_hi_u32_u24 v14, 429497, v17
    v_lshrrev_b32 v12, 3, v121
    v_cos_f32 v8, v8
    v_lshlrev_b16 v13, 3, v121
    v_mad_i32_i24 v11, v14, s55, v17
    v_bitop3_b32 v12, v6, v13, v12 bitop3:0xca
    v_lshl_add_u32 v11, v11, 17, s40
    v_lshlrev_b16 v14, 8, v14
    v_lshrrev_b32 v13, 2, v121
    v_add_u32 v17, v12, v11
    v_bitop3_b32 v121, v5, v13, v14 bitop3:0xea
    ds_add_u32 v121, v2
    v_cvt_pk_bf16_f32 v44, v7, v8
    v_perm_b32 v12, v44, v44, s41
    v_bitop3_b32 v16, v4, v12, v16 bitop3:0xca
    v_perm_b32 v13, v44, v44, s42
    v_bitop3_b32 v17, v4, v13, v17 bitop3:0xca
    v_mul_hi_u32_u24 v14, 429497, v18
    v_lshrrev_b32 v12, 3, v122
    v_cos_f32 v9, v9
    v_lshlrev_b16 v13, 3, v122
    v_mad_i32_i24 v11, v14, s55, v18
    v_bitop3_b32 v12, v6, v13, v12 bitop3:0xca
    v_lshl_add_u32 v11, v11, 17, s40
    v_lshlrev_b16 v14, 8, v14
    v_lshrrev_b32 v13, 2, v122
    v_add_u32 v18, v12, v11
    v_bitop3_b32 v122, v5, v13, v14 bitop3:0xea
    ds_add_u32 v122, v2
    v_mul_hi_u32_u24 v14, 429497, v19
    v_lshrrev_b32 v12, 3, v123
    v_cos_f32 v10, v10
    v_lshlrev_b16 v13, 3, v123
    v_mad_i32_i24 v11, v14, s55, v19
    v_bitop3_b32 v12, v6, v13, v12 bitop3:0xca
    v_lshl_add_u32 v11, v11, 17, s40
    v_lshlrev_b16 v14, 8, v14
    v_lshrrev_b32 v13, 2, v123
    v_add_u32 v19, v12, v11
    v_bitop3_b32 v123, v5, v13, v14 bitop3:0xea
    ds_add_u32 v123, v2
    v_cvt_pk_bf16_f32 v45, v9, v10
    v_perm_b32 v12, v45, v45, s41
    v_bitop3_b32 v18, v4, v12, v18 bitop3:0xca
    v_perm_b32 v13, v45, v45, s42
    v_bitop3_b32 v19, v4, v13, v19 bitop3:0xca
    s_waitcnt vmcnt(23)
    v_lshlrev_b32 v7, 16, v46
    v_and_b32 v8, 0xffff0000, v46
    v_lshlrev_b32 v9, 16, v47
    v_and_b32 v10, 0xffff0000, v47
    v_mul_f32 v7, 0.15915494, v7
    v_mul_f32 v8, 0.15915494, v8
    v_mul_f32 v9, 0.15915494, v9
    v_mul_f32 v10, 0.15915494, v10
    v_mul_hi_u32_u24 v14, 429497, v20
    v_lshrrev_b32 v12, 3, v124
    v_cos_f32 v7, v7
    v_lshlrev_b16 v13, 3, v124
    v_mad_i32_i24 v11, v14, s55, v20
    v_bitop3_b32 v12, v6, v13, v12 bitop3:0xca
    v_lshl_add_u32 v11, v11, 17, s40
    v_lshlrev_b16 v14, 8, v14
    v_lshrrev_b32 v13, 2, v124
    v_add_u32 v20, v12, v11
    v_bitop3_b32 v124, v5, v13, v14 bitop3:0xea
    ds_add_u32 v124, v2
    v_mul_hi_u32_u24 v14, 429497, v21
    v_lshrrev_b32 v12, 3, v125
    v_cos_f32 v8, v8
    v_lshlrev_b16 v13, 3, v125
    v_mad_i32_i24 v11, v14, s55, v21
    v_bitop3_b32 v12, v6, v13, v12 bitop3:0xca
    v_lshl_add_u32 v11, v11, 17, s40
    v_lshlrev_b16 v14, 8, v14
    v_lshrrev_b32 v13, 2, v125
    v_add_u32 v21, v12, v11
    v_bitop3_b32 v125, v5, v13, v14 bitop3:0xea
    ds_add_u32 v125, v2
    v_cvt_pk_bf16_f32 v46, v7, v8
    v_perm_b32 v12, v46, v46, s41
    v_bitop3_b32 v20, v4, v12, v20 bitop3:0xca
    v_perm_b32 v13, v46, v46, s42
    v_bitop3_b32 v21, v4, v13, v21 bitop3:0xca
    v_mul_hi_u32_u24 v14, 429497, v22
    v_lshrrev_b32 v12, 3, v126
    v_cos_f32 v9, v9
    v_lshlrev_b16 v13, 3, v126
    v_mad_i32_i24 v11, v14, s55, v22
    v_bitop3_b32 v12, v6, v13, v12 bitop3:0xca
    v_lshl_add_u32 v11, v11, 17, s40
    v_lshlrev_b16 v14, 8, v14
    v_lshrrev_b32 v13, 2, v126
    v_add_u32 v22, v12, v11
    v_bitop3_b32 v126, v5, v13, v14 bitop3:0xea
    ds_add_u32 v126, v2
    v_mul_hi_u32_u24 v14, 429497, v23
    v_lshrrev_b32 v12, 3, v127
    v_cos_f32 v10, v10
    v_lshlrev_b16 v13, 3, v127
    v_mad_i32_i24 v11, v14, s55, v23
    v_bitop3_b32 v12, v6, v13, v12 bitop3:0xca
    v_lshl_add_u32 v11, v11, 17, s40
    v_lshlrev_b16 v14, 8, v14
    v_lshrrev_b32 v13, 2, v127
    v_add_u32 v23, v12, v11
    v_bitop3_b32 v127, v5, v13, v14 bitop3:0xea
    ds_add_u32 v127, v2
    v_cvt_pk_bf16_f32 v47, v9, v10
    v_perm_b32 v12, v47, v47, s41
    v_bitop3_b32 v22, v4, v12, v22 bitop3:0xca
    v_perm_b32 v13, v47, v47, s42
    v_bitop3_b32 v23, v4, v13, v23 bitop3:0xca
    s_setprio 2
    s_add_u32 s44, s35, 0x7ec4000
    s_add_u32 s44, s44, s85
    buffer_store_dwordx4 v[100:103], v0, s[20:23], s44 offen sc1
    s_waitcnt vmcnt(19)
    v_lshlrev_b32 v7, 16, v32
    v_and_b32 v8, 0xffff0000, v32
    v_lshlrev_b32 v9, 16, v33
    v_and_b32 v10, 0xffff0000, v33
    v_mul_f32 v7, 0.15915494, v7
    v_mul_f32 v8, 0.15915494, v8
    v_mul_f32 v9, 0.15915494, v9
    v_mul_f32 v10, 0.15915494, v10
    v_mul_hi_u32_u24 v14, 429497, v40
    v_lshrrev_b32 v12, 3, v24
    v_cos_f32 v7, v7
    v_lshlrev_b16 v13, 3, v24
    v_mad_i32_i24 v11, v14, s55, v40
    v_bitop3_b32 v12, v6, v13, v12 bitop3:0xca
    v_lshl_add_u32 v11, v11, 17, s40
    v_lshlrev_b16 v14, 8, v14
    v_lshrrev_b32 v13, 2, v24
    v_add_u32 v40, v12, v11
    v_bitop3_b32 v24, v5, v13, v14 bitop3:0xea
    ds_add_u32 v24, v2
    v_mul_hi_u32_u24 v14, 429497, v41
    v_lshrrev_b32 v12, 3, v25
    v_cos_f32 v8, v8
    v_lshlrev_b16 v13, 3, v25
    v_mad_i32_i24 v11, v14, s55, v41
    v_bitop3_b32 v12, v6, v13, v12 bitop3:0xca
    v_lshl_add_u32 v11, v11, 17, s40
    v_lshlrev_b16 v14, 8, v14
    v_lshrrev_b32 v13, 2, v25
    v_add_u32 v41, v12, v11
    v_bitop3_b32 v25, v5, v13, v14 bitop3:0xea
    ds_add_u32 v25, v2
    v_cvt_pk_bf16_f32 v32, v7, v8
    v_perm_b32 v12, v32, v32, s41
    v_bitop3_b32 v40, v4, v12, v40 bitop3:0xca
    v_perm_b32 v13, v32, v32, s42
    v_bitop3_b32 v41, v4, v13, v41 bitop3:0xca
    v_mul_hi_u32_u24 v14, 429497, v42
    v_lshrrev_b32 v12, 3, v26
    v_cos_f32 v9, v9
    v_lshlrev_b16 v13, 3, v26
    v_mad_i32_i24 v11, v14, s55, v42
    v_bitop3_b32 v12, v6, v13, v12 bitop3:0xca
    v_lshl_add_u32 v11, v11, 17, s40
    v_lshlrev_b16 v14, 8, v14
    v_lshrrev_b32 v13, 2, v26
    v_add_u32 v42, v12, v11
    v_bitop3_b32 v26, v5, v13, v14 bitop3:0xea
    ds_add_u32 v26, v2
    v_mul_hi_u32_u24 v14, 429497, v43
    v_lshrrev_b32 v12, 3, v27
    v_cos_f32 v10, v10
    v_lshlrev_b16 v13, 3, v27
    v_mad_i32_i24 v11, v14, s55, v43
    v_bitop3_b32 v12, v6, v13, v12 bitop3:0xca
    v_lshl_add_u32 v11, v11, 17, s40
    v_lshlrev_b16 v14, 8, v14
    v_lshrrev_b32 v13, 2, v27
    v_add_u32 v43, v12, v11
    v_bitop3_b32 v27, v5, v13, v14 bitop3:0xea
    ds_add_u32 v27, v2
    v_cvt_pk_bf16_f32 v33, v9, v10
    v_perm_b32 v12, v33, v33, s41
    v_bitop3_b32 v42, v4, v12, v42 bitop3:0xca
    v_perm_b32 v13, v33, v33, s42
    v_bitop3_b32 v43, v4, v13, v43 bitop3:0xca
    s_waitcnt vmcnt(16)
    v_lshlrev_b32 v7, 16, v34
    v_and_b32 v8, 0xffff0000, v34
    v_lshlrev_b32 v9, 16, v35
    v_and_b32 v10, 0xffff0000, v35
    v_mul_f32 v7, 0.15915494, v7
    v_mul_f32 v8, 0.15915494, v8
    v_mul_f32 v9, 0.15915494, v9
    v_mul_f32 v10, 0.15915494, v10
    v_mul_hi_u32_u24 v14, 429497, v48
    v_lshrrev_b32 v12, 3, v52
    v_cos_f32 v7, v7
    v_lshlrev_b16 v13, 3, v52
    v_mad_i32_i24 v11, v14, s55, v48
    v_bitop3_b32 v12, v6, v13, v12 bitop3:0xca
    v_lshl_add_u32 v11, v11, 17, s40
    v_lshlrev_b16 v14, 8, v14
    v_lshrrev_b32 v13, 2, v52
    v_add_u32 v48, v12, v11
    v_bitop3_b32 v52, v5, v13, v14 bitop3:0xea
    ds_add_u32 v52, v2
    v_mul_hi_u32_u24 v14, 429497, v49
    v_lshrrev_b32 v12, 3, v53
    v_cos_f32 v8, v8
    v_lshlrev_b16 v13, 3, v53
    v_mad_i32_i24 v11, v14, s55, v49
    v_bitop3_b32 v12, v6, v13, v12 bitop3:0xca
    v_lshl_add_u32 v11, v11, 17, s40
    v_lshlrev_b16 v14, 8, v14
    v_lshrrev_b32 v13, 2, v53
    v_add_u32 v49, v12, v11
    v_bitop3_b32 v53, v5, v13, v14 bitop3:0xea
    ds_add_u32 v53, v2
    v_cvt_pk_bf16_f32 v34, v7, v8
    v_perm_b32 v12, v34, v34, s41
    v_bitop3_b32 v48, v4, v12, v48 bitop3:0xca
    v_perm_b32 v13, v34, v34, s42
    v_bitop3_b32 v49, v4, v13, v49 bitop3:0xca
    v_mul_hi_u32_u24 v14, 429497, v50
    v_lshrrev_b32 v12, 3, v54
    v_cos_f32 v9, v9
    v_lshlrev_b16 v13, 3, v54
    v_mad_i32_i24 v11, v14, s55, v50
    v_bitop3_b32 v12, v6, v13, v12 bitop3:0xca
    v_lshl_add_u32 v11, v11, 17, s40
    v_lshlrev_b16 v14, 8, v14
    v_lshrrev_b32 v13, 2, v54
    v_add_u32 v50, v12, v11
    v_bitop3_b32 v54, v5, v13, v14 bitop3:0xea
    ds_add_u32 v54, v2
    v_mul_hi_u32_u24 v14, 429497, v51
    v_lshrrev_b32 v12, 3, v55
    v_cos_f32 v10, v10
    v_lshlrev_b16 v13, 3, v55
    v_mad_i32_i24 v11, v14, s55, v51
    v_bitop3_b32 v12, v6, v13, v12 bitop3:0xca
    v_lshl_add_u32 v11, v11, 17, s40
    v_lshlrev_b16 v14, 8, v14
    v_lshrrev_b32 v13, 2, v55
    v_add_u32 v51, v12, v11
    v_bitop3_b32 v55, v5, v13, v14 bitop3:0xea
    ds_add_u32 v55, v2
    v_cvt_pk_bf16_f32 v35, v9, v10
    v_perm_b32 v12, v35, v35, s41
    v_bitop3_b32 v50, v4, v12, v50 bitop3:0xca
    v_perm_b32 v13, v35, v35, s42
    v_bitop3_b32 v51, v4, v13, v51 bitop3:0xca
    s_setprio 1
    s_waitcnt vmcnt(12)
    v_lshlrev_b32 v7, 16, v72
    v_and_b32 v8, 0xffff0000, v72
    v_lshlrev_b32 v9, 16, v73
    v_and_b32 v10, 0xffff0000, v73
    v_mul_f32 v7, 0.15915494, v7
    v_mul_f32 v8, 0.15915494, v8
    v_mul_f32 v9, 0.15915494, v9
    v_mul_f32 v10, 0.15915494, v10
    v_mul_hi_u32_u24 v14, 429497, v84
    v_lshrrev_b32 v12, 3, v68
    v_cos_f32 v7, v7
    v_lshlrev_b16 v13, 3, v68
    v_mad_i32_i24 v11, v14, s55, v84
    v_bitop3_b32 v12, v6, v13, v12 bitop3:0xca
    v_lshl_add_u32 v11, v11, 17, s40
    v_lshlrev_b16 v14, 8, v14
    v_lshrrev_b32 v13, 2, v68
    v_add_u32 v84, v12, v11
    v_bitop3_b32 v68, v5, v13, v14 bitop3:0xea
    ds_add_u32 v68, v2
    v_mul_hi_u32_u24 v14, 429497, v85
    v_lshrrev_b32 v12, 3, v69
    v_cos_f32 v8, v8
    v_lshlrev_b16 v13, 3, v69
    v_mad_i32_i24 v11, v14, s55, v85
    v_bitop3_b32 v12, v6, v13, v12 bitop3:0xca
    v_lshl_add_u32 v11, v11, 17, s40
    v_lshlrev_b16 v14, 8, v14
    v_lshrrev_b32 v13, 2, v69
    v_add_u32 v85, v12, v11
    v_bitop3_b32 v69, v5, v13, v14 bitop3:0xea
    ds_add_u32 v69, v2
    v_cvt_pk_bf16_f32 v72, v7, v8
    v_perm_b32 v12, v72, v72, s41
    v_bitop3_b32 v84, v4, v12, v84 bitop3:0xca
    v_perm_b32 v13, v72, v72, s42
    v_bitop3_b32 v85, v4, v13, v85 bitop3:0xca
    v_mul_hi_u32_u24 v14, 429497, v86
    v_lshrrev_b32 v12, 3, v70
    v_cos_f32 v9, v9
    v_lshlrev_b16 v13, 3, v70
    v_mad_i32_i24 v11, v14, s55, v86
    v_bitop3_b32 v12, v6, v13, v12 bitop3:0xca
    v_lshl_add_u32 v11, v11, 17, s40
    v_lshlrev_b16 v14, 8, v14
    v_lshrrev_b32 v13, 2, v70
    v_add_u32 v86, v12, v11
    v_bitop3_b32 v70, v5, v13, v14 bitop3:0xea
    ds_add_u32 v70, v2
    v_mul_hi_u32_u24 v14, 429497, v87
    v_lshrrev_b32 v12, 3, v71
    v_cos_f32 v10, v10
    v_lshlrev_b16 v13, 3, v71
    v_mad_i32_i24 v11, v14, s55, v87
    v_bitop3_b32 v12, v6, v13, v12 bitop3:0xca
    v_lshl_add_u32 v11, v11, 17, s40
    v_lshlrev_b16 v14, 8, v14
    v_lshrrev_b32 v13, 2, v71
    v_add_u32 v87, v12, v11
    v_bitop3_b32 v71, v5, v13, v14 bitop3:0xea
    ds_add_u32 v71, v2
    v_cvt_pk_bf16_f32 v73, v9, v10
    v_perm_b32 v12, v73, v73, s41
    v_bitop3_b32 v86, v4, v12, v86 bitop3:0xca
    v_perm_b32 v13, v73, v73, s42
    v_bitop3_b32 v87, v4, v13, v87 bitop3:0xca
    s_add_u32 s45, s35, 0x7ec4000
    s_add_u32 s45, s45, s91
    buffer_store_dwordx4 v[104:107], v0, s[20:23], s45 offen sc1
    s_waitcnt vmcnt(10)
    s_cmp_le_u32 s43, 5
    s_cbranch_scc1 L1_s5
    v_lshlrev_b32 v7, 16, v74
    v_and_b32 v8, 0xffff0000, v74
    v_lshlrev_b32 v9, 16, v75
    v_and_b32 v10, 0xffff0000, v75
    v_mul_f32 v7, 0.15915494, v7
    v_mul_f32 v8, 0.15915494, v8
    v_mul_f32 v9, 0.15915494, v9
    v_mul_f32 v10, 0.15915494, v10
    v_mul_hi_u32_u24 v14, 429497, v36
    v_lshrrev_b32 v12, 3, v76
    v_cos_f32 v7, v7
    v_lshlrev_b16 v13, 3, v76
    v_mad_i32_i24 v11, v14, s55, v36
    v_bitop3_b32 v12, v6, v13, v12 bitop3:0xca
    v_lshl_add_u32 v11, v11, 17, s40
    v_lshlrev_b16 v14, 8, v14
    v_lshrrev_b32 v13, 2, v76
    v_add_u32 v36, v12, v11
    v_bitop3_b32 v76, v5, v13, v14 bitop3:0xea
    ds_add_u32 v76, v2
    v_mul_hi_u32_u24 v14, 429497, v37
    v_lshrrev_b32 v12, 3, v77
    v_cos_f32 v8, v8
    v_lshlrev_b16 v13, 3, v77
    v_mad_i32_i24 v11, v14, s55, v37
    v_bitop3_b32 v12, v6, v13, v12 bitop3:0xca
    v_lshl_add_u32 v11, v11, 17, s40
    v_lshlrev_b16 v14, 8, v14
    v_lshrrev_b32 v13, 2, v77
    v_add_u32 v37, v12, v11
    v_bitop3_b32 v77, v5, v13, v14 bitop3:0xea
    ds_add_u32 v77, v2
    v_cvt_pk_bf16_f32 v74, v7, v8
    v_perm_b32 v12, v74, v74, s41
    v_bitop3_b32 v36, v4, v12, v36 bitop3:0xca
    v_perm_b32 v13, v74, v74, s42
    v_bitop3_b32 v37, v4, v13, v37 bitop3:0xca
    v_mul_hi_u32_u24 v14, 429497, v38
    v_lshrrev_b32 v12, 3, v78
    v_cos_f32 v9, v9
    v_lshlrev_b16 v13, 3, v78
    v_mad_i32_i24 v11, v14, s55, v38
    v_bitop3_b32 v12, v6, v13, v12 bitop3:0xca
    v_lshl_add_u32 v11, v11, 17, s40
    v_lshlrev_b16 v14, 8, v14
    v_lshrrev_b32 v13, 2, v78
    v_add_u32 v38, v12, v11
    v_bitop3_b32 v78, v5, v13, v14 bitop3:0xea
    ds_add_u32 v78, v2
    v_mul_hi_u32_u24 v14, 429497, v39
    v_lshrrev_b32 v12, 3, v79
    v_cos_f32 v10, v10
    v_lshlrev_b16 v13, 3, v79
    v_mad_i32_i24 v11, v14, s55, v39
    v_bitop3_b32 v12, v6, v13, v12 bitop3:0xca
    v_lshl_add_u32 v11, v11, 17, s40
    v_lshlrev_b16 v14, 8, v14
    v_lshrrev_b32 v13, 2, v79
    v_add_u32 v39, v12, v11
    v_bitop3_b32 v79, v5, v13, v14 bitop3:0xea
    ds_add_u32 v79, v2
    v_cvt_pk_bf16_f32 v75, v9, v10
    v_perm_b32 v12, v75, v75, s41
    v_bitop3_b32 v38, v4, v12, v38 bitop3:0xca
    v_perm_b32 v13, v75, v75, s42
    v_bitop3_b32 v39, v4, v13, v39 bitop3:0xca
L1_s5:
    s_setprio 0
    s_waitcnt vmcnt(6)
    s_cmp_le_u32 s43, 6
    s_cbranch_scc1 L1_s6
    v_lshlrev_b32 v7, 16, v64
    v_and_b32 v8, 0xffff0000, v64
    v_lshlrev_b32 v9, 16, v65
    v_and_b32 v10, 0xffff0000, v65
    v_mul_f32 v7, 0.15915494, v7
    v_mul_f32 v8, 0.15915494, v8
    v_mul_f32 v9, 0.15915494, v9
    v_mul_f32 v10, 0.15915494, v10
    v_mul_hi_u32_u24 v14, 429497, v80
    v_lshrrev_b32 v12, 3, v56
    v_cos_f32 v7, v7
    v_lshlrev_b16 v13, 3, v56
    v_mad_i32_i24 v11, v14, s55, v80
    v_bitop3_b32 v12, v6, v13, v12 bitop3:0xca
    v_lshl_add_u32 v11, v11, 17, s40
    v_lshlrev_b16 v14, 8, v14
    v_lshrrev_b32 v13, 2, v56
    v_add_u32 v80, v12, v11
    v_bitop3_b32 v56, v5, v13, v14 bitop3:0xea
    ds_add_u32 v56, v2
    v_mul_hi_u32_u24 v14, 429497, v81
    v_lshrrev_b32 v12, 3, v57
    v_cos_f32 v8, v8
    v_lshlrev_b16 v13, 3, v57
    v_mad_i32_i24 v11, v14, s55, v81
    v_bitop3_b32 v12, v6, v13, v12 bitop3:0xca
    v_lshl_add_u32 v11, v11, 17, s40
    v_lshlrev_b16 v14, 8, v14
    v_lshrrev_b32 v13, 2, v57
    v_add_u32 v81, v12, v11
    v_bitop3_b32 v57, v5, v13, v14 bitop3:0xea
    ds_add_u32 v57, v2
    v_cvt_pk_bf16_f32 v64, v7, v8
    v_perm_b32 v12, v64, v64, s41
    v_bitop3_b32 v80, v4, v12, v80 bitop3:0xca
    v_perm_b32 v13, v64, v64, s42
    v_bitop3_b32 v81, v4, v13, v81 bitop3:0xca
    v_mul_hi_u32_u24 v14, 429497, v82
    v_lshrrev_b32 v12, 3, v58
    v_cos_f32 v9, v9
    v_lshlrev_b16 v13, 3, v58
    v_mad_i32_i24 v11, v14, s55, v82
    v_bitop3_b32 v12, v6, v13, v12 bitop3:0xca
    v_lshl_add_u32 v11, v11, 17, s40
    v_lshlrev_b16 v14, 8, v14
    v_lshrrev_b32 v13, 2, v58
    v_add_u32 v82, v12, v11
    v_bitop3_b32 v58, v5, v13, v14 bitop3:0xea
    ds_add_u32 v58, v2
    v_mul_hi_u32_u24 v14, 429497, v83
    v_lshrrev_b32 v12, 3, v59
    v_cos_f32 v10, v10
    v_lshlrev_b16 v13, 3, v59
    v_mad_i32_i24 v11, v14, s55, v83
    v_bitop3_b32 v12, v6, v13, v12 bitop3:0xca
    v_lshl_add_u32 v11, v11, 17, s40
    v_lshlrev_b16 v14, 8, v14
    v_lshrrev_b32 v13, 2, v59
    v_add_u32 v83, v12, v11
    v_bitop3_b32 v59, v5, v13, v14 bitop3:0xea
    ds_add_u32 v59, v2
    v_cvt_pk_bf16_f32 v65, v9, v10
    v_perm_b32 v12, v65, v65, s41
    v_bitop3_b32 v82, v4, v12, v82 bitop3:0xca
    v_perm_b32 v13, v65, v65, s42
    v_bitop3_b32 v83, v4, v13, v83 bitop3:0xca
L1_s6:
    s_waitcnt vmcnt(2)
    s_cmp_le_u32 s43, 7
    s_cbranch_scc1 L1_s7
    v_lshlrev_b32 v7, 16, v66
    v_and_b32 v8, 0xffff0000, v66
    v_lshlrev_b32 v9, 16, v67
    v_and_b32 v10, 0xffff0000, v67
    v_mul_f32 v7, 0.15915494, v7
    v_mul_f32 v8, 0.15915494, v8
    v_mul_f32 v9, 0.15915494, v9
    v_mul_f32 v10, 0.15915494, v10
    v_mul_hi_u32_u24 v14, 429497, v96
    v_lshrrev_b32 v12, 3, v60
    v_cos_f32 v7, v7
    v_lshlrev_b16 v13, 3, v60
    v_mad_i32_i24 v11, v14, s55, v96
    v_bitop3_b32 v12, v6, v13, v12 bitop3:0xca
    v_lshl_add_u32 v11, v11, 17, s40
    v_lshlrev_b16 v14, 8, v14
    v_lshrrev_b32 v13, 2, v60
    v_add_u32 v96, v12, v11
    v_bitop3_b32 v60, v5, v13, v14 bitop3:0xea
    ds_add_u32 v60, v2
    v_mul_hi_u32_u24 v14, 429497, v97
    v_lshrrev_b32 v12, 3, v61
    v_cos_f32 v8, v8
    v_lshlrev_b16 v13, 3, v61
    v_mad_i32_i24 v11, v14, s55, v97
    v_bitop3_b32 v12, v6, v13, v12 bitop3:0xca
    v_lshl_add_u32 v11, v11, 17, s40
    v_lshlrev_b16 v14, 8, v14
    v_lshrrev_b32 v13, 2, v61
    v_add_u32 v97, v12, v11
    v_bitop3_b32 v61, v5, v13, v14 bitop3:0xea
    ds_add_u32 v61, v2
    v_cvt_pk_bf16_f32 v66, v7, v8
    v_perm_b32 v12, v66, v66, s41
    v_bitop3_b32 v96, v4, v12, v96 bitop3:0xca
    v_perm_b32 v13, v66, v66, s42
    v_bitop3_b32 v97, v4, v13, v97 bitop3:0xca
    v_mul_hi_u32_u24 v14, 429497, v98
    v_lshrrev_b32 v12, 3, v62
    v_cos_f32 v9, v9
    v_lshlrev_b16 v13, 3, v62
    v_mad_i32_i24 v11, v14, s55, v98
    v_bitop3_b32 v12, v6, v13, v12 bitop3:0xca
    v_lshl_add_u32 v11, v11, 17, s40
    v_lshlrev_b16 v14, 8, v14
    v_lshrrev_b32 v13, 2, v62
    v_add_u32 v98, v12, v11
    v_bitop3_b32 v62, v5, v13, v14 bitop3:0xea
    ds_add_u32 v62, v2
    v_mul_hi_u32_u24 v14, 429497, v99
    v_lshrrev_b32 v12, 3, v63
    v_cos_f32 v10, v10
    v_lshlrev_b16 v13, 3, v63
    v_mad_i32_i24 v11, v14, s55, v99
    v_bitop3_b32 v12, v6, v13, v12 bitop3:0xca
    v_lshl_add_u32 v11, v11, 17, s40
    v_lshlrev_b16 v14, 8, v14
    v_lshrrev_b32 v13, 2, v63
    v_add_u32 v99, v12, v11
    v_bitop3_b32 v63, v5, v13, v14 bitop3:0xea
    ds_add_u32 v63, v2
    v_cvt_pk_bf16_f32 v67, v9, v10
    v_perm_b32 v12, v67, v67, s41
    v_bitop3_b32 v98, v4, v12, v98 bitop3:0xca
    v_perm_b32 v13, v67, v67, s42
    v_bitop3_b32 v99, v4, v13, v99 bitop3:0xca
L1_s7:
    v_lshrrev_b32 v8, 2, v0
    v_and_b32 v7, 0x3c00, v0
    v_bitop3_b32 v7, v5, v8, v7 bitop3:0xea
    s_waitcnt lgkmcnt(0)
    s_barrier
    ds_read2st64_b32 v[8:9], v7 offset0:0 offset1:1
    ds_read2st64_b32 v[10:11], v7 offset0:2 offset1:3
    s_add_u32 s46, s35, 0x7ec4000
    s_add_u32 s46, s46, s93
    buffer_store_dwordx4 v[28:31], v0, s[20:23], s46 offen sc1
    s_waitcnt lgkmcnt(0)
    v_lshl_or_b32 v12, v9, 16, v8
    v_lshl_or_b32 v13, v11, 16, v10
    v_mov_b32 v14, v12
    v_mov_b32 v15, v13
    s_nop 0
    v_add_u32_dpp v14, v14, v14 row_shr:1 row_mask:0xf bank_mask:0xf bound_ctrl:1
    v_add_u32_dpp v15, v15, v15 row_shr:1 row_mask:0xf bank_mask:0xf bound_ctrl:1
    s_nop 0
    v_add_u32_dpp v14, v14, v14 row_shr:2 row_mask:0xf bank_mask:0xf bound_ctrl:1
    v_add_u32_dpp v15, v15, v15 row_shr:2 row_mask:0xf bank_mask:0xf bound_ctrl:1
    s_nop 0
    v_add_u32_dpp v14, v14, v14 row_shr:4 row_mask:0xf bank_mask:0xf bound_ctrl:1
    v_add_u32_dpp v15, v15, v15 row_shr:4 row_mask:0xf bank_mask:0xf bound_ctrl:1
    s_nop 0
    v_add_u32_dpp v14, v14, v14 row_shr:8 row_mask:0xf bank_mask:0xf bound_ctrl:1
    v_add_u32_dpp v15, v15, v15 row_shr:8 row_mask:0xf bank_mask:0xf bound_ctrl:1
    s_nop 0
    v_add_u32_dpp v14, v14, v14 row_bcast:15 row_mask:0xa bank_mask:0xf
    v_add_u32_dpp v15, v15, v15 row_bcast:15 row_mask:0xa bank_mask:0xf
    s_nop 0
    v_add_u32_dpp v14, v14, v14 row_bcast:31 row_mask:0xc bank_mask:0xf
    v_add_u32_dpp v15, v15, v15 row_bcast:31 row_mask:0xc bank_mask:0xf
    v_readlane_b32 s48, v14, 63
    v_readlane_b32 s49, v15, 63
    s_lshl_b32 s54, s32, 2
    v_mov_b32 v8, s54
    s_and_b32 s50, s48, 0xffff
    s_lshr_b32 s51, s48, 16
    s_and_b32 s52, s49, 0xffff
    s_lshr_b32 s53, s49, 16
    s_add_u32 s51, s51, s50
    s_add_u32 s52, s52, s51
    s_add_u32 s53, s53, s52
    v_mov_b32 v9, s53
    v_and_b32_dpp v3, v3, v3 quad_perm:[1,0,3,2] row_mask:0xf bank_mask:0xf
    s_mov_b64 exec, 1
    ds_write_b32 v8, v9 offset:16384
    ds_write_b32 v8, v3 offset:16448
    s_mov_b64 exec, -1
    v_and_b32 v8, 60, v7
    s_waitcnt lgkmcnt(0)
    s_barrier
    ds_read_b32 v9, v8 offset:16384
    ds_read_b32 v10, v8 offset:16448
    s_waitcnt lgkmcnt(0)
    v_readlane_b32 s56, v10, 15
    s_xor_b32 s56, s56, 0x80
    v_add_u32_dpp v9, v9, v9 row_shr:1 row_mask:0xf bank_mask:0xf bound_ctrl:1
    s_nop 1
    v_add_u32_dpp v9, v9, v9 row_shr:2 row_mask:0xf bank_mask:0xf bound_ctrl:1
    s_nop 1
    v_add_u32_dpp v9, v9, v9 row_shr:4 row_mask:0xf bank_mask:0xf bound_ctrl:1
    s_nop 1
    v_add_u32_dpp v9, v9, v9 row_shr:8 row_mask:0xf bank_mask:0xf bound_ctrl:1
    s_nop 0
    v_readlane_b32 s54, v9, s32
    s_sub_u32 s54, s54, s53
    s_add_u32 s50, s50, s54
    s_add_u32 s51, s51, s54
    s_add_u32 s52, s52, s54
    s_pack_ll_b32_b16 s48, s54, s50
    s_pack_ll_b32_b16 s49, s51, s52
    v_add_u32 v14, s48, v14
    v_add_u32 v15, s49, v15
    v_sub_u32 v12, v14, v12
    v_sub_u32 v13, v15, v13
    v_and_b32 v8, 0xffff, v12
    v_lshrrev_b32 v9, 16, v12
    v_and_b32 v10, 0xffff, v13
    v_lshrrev_b32 v11, 16, v13
    ds_write2st64_b32 v7, v8, v9 offset0:0 offset1:1
    ds_write2st64_b32 v7, v10, v11 offset0:2 offset1:3
    v_and_b32 v8, 0x3f0, v0
    v_lshl_add_u32 v8, v8, 1, s36
    ds_write_b64 v8, v[12:13] offset:20480
    s_bitset0_b64 exec, 63
    s_not_b64 exec, exec
    ds_write_b64 v8, v[14:15] offset:20512
    s_mov_b64 exec, -1
    s_waitcnt lgkmcnt(0)
    s_barrier
    s_setprio 3
    ds_add_rtn_u32 v120, v120, v2
    ds_add_rtn_u32 v121, v121, v2
    ds_add_rtn_u32 v122, v122, v2
    ds_add_rtn_u32 v123, v123, v2
    ds_read_b128 v[12:15], v0 offset:20480
    v_cmp_gt_u32 vcc, 8448, v0
    ds_add_rtn_u32 v124, v124, v2
    ds_add_rtn_u32 v125, v125, v2
    ds_add_rtn_u32 v126, v126, v2
    ds_add_rtn_u32 v127, v127, v2
    s_setprio 2
    ds_add_rtn_u32 v24, v24, v2
    ds_add_rtn_u32 v25, v25, v2
    ds_add_rtn_u32 v26, v26, v2
    ds_add_rtn_u32 v27, v27, v2
    s_waitcnt lgkmcnt(8)
    s_cbranch_vccz L1_p8
    s_add_u32 s47, s35, 0xa900000
    s_mov_b64 exec, vcc
    buffer_store_dwordx4 v[12:15], v0, s[24:27], s47 offen sc1
    s_mov_b64 exec, -1
L1_p8:
    s_add_u32 s44, s35, 0x7ec8000
    s_add_u32 s44, s44, s72
    buffer_store_dwordx4 v[112:115], v0, s[20:23], s44 offen sc1
    ds_add_rtn_u32 v52, v52, v2
    ds_add_rtn_u32 v53, v53, v2
    ds_add_rtn_u32 v54, v54, v2
    ds_add_rtn_u32 v55, v55, v2
    s_load_dwordx2 s[28:29], s[0:1], 0
    s_load_dwordx2 s[50:51], s[0:1], 40
    s_load_dwordx2 s[52:53], s[0:1], 24
    s_setprio 1
    ds_add_rtn_u32 v68, v68, v2
    ds_add_rtn_u32 v69, v69, v2
    ds_add_rtn_u32 v70, v70, v2
    ds_add_rtn_u32 v71, v71, v2
    s_cmp_le_u32 s43, 5
    s_cbranch_scc1 L1_s9
    ds_add_rtn_u32 v76, v76, v2
    ds_add_rtn_u32 v77, v77, v2
    ds_add_rtn_u32 v78, v78, v2
    ds_add_rtn_u32 v79, v79, v2
L1_s9:
    s_add_u32 s45, s35, 0x7ec8000
    s_add_u32 s45, s45, s73
    buffer_store_dwordx4 v[88:91], v0, s[20:23], s45 offen sc1
    s_setprio 0
    s_cmp_le_u32 s43, 6
    s_cbranch_scc1 L1_s10
    ds_add_rtn_u32 v56, v56, v2
    ds_add_rtn_u32 v57, v57, v2
    ds_add_rtn_u32 v58, v58, v2
    ds_add_rtn_u32 v59, v59, v2
L1_s10:
    s_cmp_le_u32 s43, 7
    s_cbranch_scc1 L1_s11
    ds_add_rtn_u32 v60, v60, v2
    ds_add_rtn_u32 v61, v61, v2
    ds_add_rtn_u32 v62, v62, v2
    ds_add_rtn_u32 v63, v63, v2
L1_s11:
    s_waitcnt lgkmcnt(0)
    s_barrier
    s_load_dwordx4 s[96:99], s[50:51], 0
    s_mov_b64 s[4:5], s[52:53]
    s_bfe_u32 s33, s2, 0x20001
    s_and_b32 s34, s2, 1
    s_lshl_b32 s34, s34, 5
    s_lshr_b32 s3, s2, 3
    s_add_u32 s34, s34, s3
    s_mul_i32 s39, s33, 2080
    s_lshl_b32 s3, s34, 5
    s_add_u32 s39, s39, s3
    s_mul_i32 s40, s33, 1310720
    s_add_u32 s40, s40, 0x50000
    s_lshl_b32 s38, s32, 11
    s_mul_i32 s100, s32, 3072
    s_add_u32 s8, s30, 0x4000
    s_addc_u32 s9, s31, 0
    s_mov_b32 s10, 0xd340000
    s_mov_b32 s11, 0x20000
    s_add_u32 s12, s30, 0x2c000
    s_addc_u32 s13, s31, 0
    s_mov_b32 s14, 0xd318000
    s_mov_b32 s15, 0x20000
    s_mov_b32 s16, s64
    s_mov_b32 s17, s65
    s_mov_b32 s18, 0x20
    s_mov_b32 s19, 0x20000
    s_mov_b32 s24, s28
    s_mov_b32 s25, s29
    s_mov_b32 s26, 0x4e2000
    s_mov_b32 s27, 0x20000
    s_setprio 3
    v_and_b32 v7, -4, v120
    v_lshl_add_u32 v8, v120, 2, v7
    ds_write_b32 v8, v16
    v_lshl_add_u32 v7, v7, 2, v120
    ds_write_b8 v7, v44 offset:16
    v_and_b32 v9, -4, v121
    v_lshl_add_u32 v10, v121, 2, v9
    ds_write_b32 v10, v17
    v_lshl_add_u32 v9, v9, 2, v121
    ds_write_b8_d16_hi v9, v44 offset:16
    v_and_b32 v7, -4, v122
    v_lshl_add_u32 v8, v122, 2, v7
    ds_write_b32 v8, v18
    v_lshl_add_u32 v7, v7, 2, v122
    ds_write_b8 v7, v45 offset:16
    v_and_b32 v9, -4, v123
    v_lshl_add_u32 v10, v123, 2, v9
    ds_write_b32 v10, v19
    v_lshl_add_u32 v9, v9, 2, v123
    ds_write_b8_d16_hi v9, v45 offset:16
    s_add_u32 s46, s35, 0x7ec8000
    s_add_u32 s46, s46, s85
    buffer_store_dwordx4 v[116:119], v0, s[20:23], s46 offen sc1
    v_and_b32 v13, 0x3f0, v0
    v_and_b32 v14, 0x300, v13
    v_bfe_u32 v15, v13, 4, 4
    s_lshl_b32 s3, s32, 4
    v_add3_u32 v14, v14, v15, s3
    v_mul_u32_u24 v2, 173056, v14
    v_lshrrev_b32 v14, 6, v13
    s_add_u32 s3, s3, 0x400
    v_add_u32 v14, s3, v14
    v_mul_u32_u24 v4, 173056, v14
    v_and_b32 v14, 3, v14
    v_and_b32 v15, 0x30, v13
    v_lshl_add_u32 v14, v14, 5, v15
    v_add_u32 v6, v14, v4
    v_lshl_add_u32 v5, v15, 1, v2
    v_lshrrev_b32 v14, 3, v15
    buffer_load_ushort v100, v14, s[16:19], 0 offen offset:0
    buffer_load_ushort v101, v14, s[16:19], 0 offen offset:8
    buffer_load_ushort v102, v14, s[16:19], 0 offen offset:16
    buffer_load_ushort v103, v14, s[16:19], 0 offen offset:24
    s_mul_i32 s3, s32, 5120
    v_add_u32 v3, s3, v13
    v_lshrrev_b32 v14, 2, v13
    v_add_u32 v14, s38, v14
    v_and_b32 v7, -4, v124
    v_lshl_add_u32 v8, v124, 2, v7
    ds_write_b32 v8, v20
    v_lshl_add_u32 v7, v7, 2, v124
    ds_write_b8 v7, v46 offset:16
    v_and_b32 v9, -4, v125
    v_lshl_add_u32 v10, v125, 2, v9
    ds_write_b32 v10, v21
    v_lshl_add_u32 v9, v9, 2, v125
    ds_write_b8_d16_hi v9, v46 offset:16
    v_and_b32 v7, -4, v126
    v_lshl_add_u32 v8, v126, 2, v7
    ds_write_b32 v8, v22
    v_lshl_add_u32 v7, v7, 2, v126
    ds_write_b8 v7, v47 offset:16
    v_and_b32 v9, -4, v127
    v_lshl_add_u32 v10, v127, 2, v9
    ds_write_b32 v10, v23
    v_lshl_add_u32 v9, v9, 2, v127
    ds_write_b8_d16_hi v9, v47 offset:16
    v_lshrrev_b32 v11, 2, v0
    v_and_b32 v11, 0xfc, v11
    s_cmp_ge_u32 s84, 128
    s_cselect_b32 s82, 0, s82
    s_and_b32 s3, s84, 1
    s_mul_i32 s3, s3, 40
    s_add_u32 s3, s3, s32
    s_mul_i32 s74, s3, 205
    s_lshr_b32 s74, s74, 10
    s_mul_i32 s75, s74, 5
    s_sub_u32 s75, s3, s75
    s_lshl_b32 s48, s74, 1
    s_add_u32 s48, s48, s75
    s_add_u32 s49, s48, s74
    s_add_u32 s49, s49, 30
    s_cmp_lt_u32 s75, 2
    s_cselect_b32 s48, s48, s49
    s_lshl_b32 s48, s48, 10
    s_lshr_b32 s49, s84, 1
    s_mul_i32 s49, s49, 80000
    s_add_u32 s48, s48, s49
    buffer_load_dword v104, v11, s[80:83], s48 offen offset:0
    buffer_load_dword v105, v11, s[80:83], s48 offen offset:256
    buffer_load_dword v106, v11, s[80:83], s48 offen offset:512
    buffer_load_dword v107, v11, s[80:83], s48 offen offset:768
    s_and_b32 s3, s84, 1
    s_mul_i32 s3, s3, 40
    s_add_u32 s3, s3, s32
    s_add_u32 s3, s3, 16
    s_mul_i32 s74, s3, 205
    s_lshr_b32 s74, s74, 10
    s_mul_i32 s75, s74, 5
    s_sub_u32 s75, s3, s75
    s_lshl_b32 s48, s74, 1
    s_add_u32 s48, s48, s75
    s_add_u32 s49, s48, s74
    s_add_u32 s49, s49, 30
    s_cmp_lt_u32 s75, 2
    s_cselect_b32 s48, s48, s49
    s_lshl_b32 s48, s48, 10
    s_lshr_b32 s49, s84, 1
    s_mul_i32 s49, s49, 80000
    s_add_u32 s48, s48, s49
    buffer_load_dword v28, v11, s[80:83], s48 offen offset:0
    buffer_load_dword v29, v11, s[80:83], s48 offen offset:256
    buffer_load_dword v30, v11, s[80:83], s48 offen offset:512
    buffer_load_dword v31, v11, s[80:83], s48 offen offset:768
    s_and_b32 s3, s84, 1
    s_mul_i32 s3, s3, 40
    s_add_u32 s3, s3, s32
    s_add_u32 s3, s3, 32
    s_cmp_ge_u32 s32, 8
    s_cselect_b32 s82, 0, s82
    s_mul_i32 s74, s3, 205
    s_lshr_b32 s74, s74, 10
    s_mul_i32 s75, s74, 5
    s_sub_u32 s75, s3, s75
    s_lshl_b32 s48, s74, 1
    s_add_u32 s48, s48, s75
    s_add_u32 s49, s48, s74
    s_add_u32 s49, s49, 30
    s_cmp_lt_u32 s75, 2
    s_cselect_b32 s48, s48, s49
    s_lshl_b32 s48, s48, 10
    s_lshr_b32 s49, s84, 1
    s_mul_i32 s49, s49, 80000
    s_add_u32 s48, s48, s49
    buffer_load_dword v112, v11, s[80:83], s48 offen offset:0
    buffer_load_dword v113, v11, s[80:83], s48 offen offset:256
    buffer_load_dword v114, v11, s[80:83], s48 offen offset:512
    buffer_load_dword v115, v11, s[80:83], s48 offen offset:768
    s_setprio 2
    v_and_b32 v7, -4, v24
    v_lshl_add_u32 v8, v24, 2, v7
    ds_write_b32 v8, v40
    v_lshl_add_u32 v7, v7, 2, v24
    ds_write_b8 v7, v32 offset:16
    v_and_b32 v9, -4, v25
    v_lshl_add_u32 v10, v25, 2, v9
    ds_write_b32 v10, v41
    v_lshl_add_u32 v9, v9, 2, v25
    ds_write_b8_d16_hi v9, v32 offset:16
    v_and_b32 v7, -4, v26
    v_lshl_add_u32 v8, v26, 2, v7
    ds_write_b32 v8, v42
    v_lshl_add_u32 v7, v7, 2, v26
    ds_write_b8 v7, v33 offset:16
    v_and_b32 v9, -4, v27
    v_lshl_add_u32 v10, v27, 2, v9
    ds_write_b32 v10, v43
    v_lshl_add_u32 v9, v9, 2, v27
    ds_write_b8_d16_hi v9, v33 offset:16
    s_add_u32 s47, s35, 0x7ec8000
    s_add_u32 s47, s47, s91
    buffer_store_dwordx4 v[92:95], v0, s[20:23], s47 offen sc1
    v_and_b32 v7, -4, v52
    v_lshl_add_u32 v8, v52, 2, v7
    ds_write_b32 v8, v48
    v_lshl_add_u32 v7, v7, 2, v52
    ds_write_b8 v7, v34 offset:16
    v_and_b32 v9, -4, v53
    v_lshl_add_u32 v10, v53, 2, v9
    ds_write_b32 v10, v49
    v_lshl_add_u32 v9, v9, 2, v53
    ds_write_b8_d16_hi v9, v34 offset:16
    v_and_b32 v7, -4, v54
    v_lshl_add_u32 v8, v54, 2, v7
    ds_write_b32 v8, v50
    v_lshl_add_u32 v7, v7, 2, v54
    ds_write_b8 v7, v35 offset:16
    v_and_b32 v9, -4, v55
    v_lshl_add_u32 v10, v55, 2, v9
    ds_write_b32 v10, v51
    v_lshl_add_u32 v9, v9, 2, v55
    ds_write_b8_d16_hi v9, v35 offset:16
    s_setprio 1
    v_and_b32 v7, -4, v68
    v_lshl_add_u32 v8, v68, 2, v7
    ds_write_b32 v8, v84
    v_lshl_add_u32 v7, v7, 2, v68
    ds_write_b8 v7, v72 offset:16
    v_and_b32 v9, -4, v69
    v_lshl_add_u32 v10, v69, 2, v9
    ds_write_b32 v10, v85
    v_lshl_add_u32 v9, v9, 2, v69
    ds_write_b8_d16_hi v9, v72 offset:16
    v_and_b32 v7, -4, v70
    v_lshl_add_u32 v8, v70, 2, v7
    ds_write_b32 v8, v86
    v_lshl_add_u32 v7, v7, 2, v70
    ds_write_b8 v7, v73 offset:16
    v_and_b32 v9, -4, v71
    v_lshl_add_u32 v10, v71, 2, v9
    ds_write_b32 v10, v87
    v_lshl_add_u32 v9, v9, 2, v71
    ds_write_b8_d16_hi v9, v73 offset:16
    s_cmp_le_u32 s43, 5
    s_cbranch_scc1 L1_s12
    v_and_b32 v7, -4, v76
    v_lshl_add_u32 v8, v76, 2, v7
    ds_write_b32 v8, v36
    v_lshl_add_u32 v7, v7, 2, v76
    ds_write_b8 v7, v74 offset:16
    v_and_b32 v9, -4, v77
    v_lshl_add_u32 v10, v77, 2, v9
    ds_write_b32 v10, v37
    v_lshl_add_u32 v9, v9, 2, v77
    ds_write_b8_d16_hi v9, v74 offset:16
    v_and_b32 v7, -4, v78
    v_lshl_add_u32 v8, v78, 2, v7
    ds_write_b32 v8, v38
    v_lshl_add_u32 v7, v7, 2, v78
    ds_write_b8 v7, v75 offset:16
    v_and_b32 v9, -4, v79
    v_lshl_add_u32 v10, v79, 2, v9
    ds_write_b32 v10, v39
    v_lshl_add_u32 v9, v9, 2, v79
    ds_write_b8_d16_hi v9, v75 offset:16
L1_s12:
    s_add_u32 s44, s35, 0x7ec8000
    s_add_u32 s44, s44, s93
    buffer_store_dwordx4 v[108:111], v0, s[20:23], s44 offen sc1
    s_setprio 0
    s_cmp_le_u32 s43, 6
    s_cbranch_scc1 L1_s13
    v_and_b32 v7, -4, v56
    v_lshl_add_u32 v8, v56, 2, v7
    ds_write_b32 v8, v80
    v_lshl_add_u32 v7, v7, 2, v56
    ds_write_b8 v7, v64 offset:16
    v_and_b32 v9, -4, v57
    v_lshl_add_u32 v10, v57, 2, v9
    ds_write_b32 v10, v81
    v_lshl_add_u32 v9, v9, 2, v57
    ds_write_b8_d16_hi v9, v64 offset:16
    v_and_b32 v7, -4, v58
    v_lshl_add_u32 v8, v58, 2, v7
    ds_write_b32 v8, v82
    v_lshl_add_u32 v7, v7, 2, v58
    ds_write_b8 v7, v65 offset:16
    v_and_b32 v9, -4, v59
    v_lshl_add_u32 v10, v59, 2, v9
    ds_write_b32 v10, v83
    v_lshl_add_u32 v9, v9, 2, v59
    ds_write_b8_d16_hi v9, v65 offset:16
L1_s13:
    s_add_u32 s80, s30, 0xd344000
    s_addc_u32 s81, s31, 0
    s_mov_b32 s82, 0xa000
    s_mov_b32 s83, 0x20000
    s_min_u32 s3, s84, 127
    s_mul_i32 s3, s3, 40960
    s_add_u32 s80, s80, s3
    s_addc_u32 s81, s81, 0
    s_cmp_ge_u32 s84, 128
    s_cselect_b32 s82, 0, s82
    s_waitcnt vmcnt(2)
    v_add_u32 v11, 0, v0
    buffer_store_dwordx4 v[104:107], v11, s[80:83], 0 offen sc1
    v_add_u32 v11, 16384, v0
    buffer_store_dwordx4 v[28:31], v11, s[80:83], 0 offen sc1
    v_add_u32 v11, 32768, v0
    buffer_store_dwordx4 v[112:115], v11, s[80:83], 0 offen sc1
    s_cmp_le_u32 s43, 7
    s_cbranch_scc1 L1_s14
    v_and_b32 v7, -4, v60
    v_lshl_add_u32 v8, v60, 2, v7
    ds_write_b32 v8, v96
    v_lshl_add_u32 v7, v7, 2, v60
    ds_write_b8 v7, v66 offset:16
    v_and_b32 v9, -4, v61
    v_lshl_add_u32 v10, v61, 2, v9
    ds_write_b32 v10, v97
    v_lshl_add_u32 v9, v9, 2, v61
    ds_write_b8_d16_hi v9, v66 offset:16
    v_and_b32 v7, -4, v62
    v_lshl_add_u32 v8, v62, 2, v7
    ds_write_b32 v8, v98
    v_lshl_add_u32 v7, v7, 2, v62
    ds_write_b8 v7, v67 offset:16
    v_and_b32 v9, -4, v63
    v_lshl_add_u32 v10, v63, 2, v9
    ds_write_b32 v10, v99
    v_lshl_add_u32 v9, v9, 2, v63
    ds_write_b8_d16_hi v9, v67 offset:16
L1_s14:
    v_add_u32 v7, 0x10000, v0
    v_add_u32 v12, 0x20000, v0
    s_waitcnt lgkmcnt(0)
    s_barrier
    ds_read_b128 v[24:27], v0 offset:0
    ds_read_b128 v[28:31], v0 offset:16384
    ds_read_b128 v[32:35], v0 offset:32768
    ds_read_b128 v[36:39], v0 offset:49152
    ds_read_b128 v[76:79], v7 offset:0
    ds_read_b128 v[80:83], v7 offset:16384
    ds_read_b128 v[84:87], v7 offset:32768
    ds_read_b128 v[104:107], v7 offset:49152
    ds_read_b128 v[68:71], v12 offset:0
    ds_read_b128 v[72:75], v12 offset:16384
    s_cmp_lg_u32 s32, 0
    s_cbranch_scc1 L2_sg1
    s_mov_b32 exec_hi, 0
    v_mov_b32 v11, 1
    buffer_store_dword v11, v14, s[60:63], s57 offen sc1
    s_mov_b64 exec, -1
L2_sg1:
    s_waitcnt lgkmcnt(9)
    s_add_u32 s45, s35, 0xa904000
    buffer_store_dwordx4 v[24:27], v0, s[20:23], s45 offen sc1
    s_waitcnt lgkmcnt(8)
    s_add_u32 s46, s35, 0xa908000
    buffer_store_dwordx4 v[28:31], v0, s[20:23], s46 offen sc1
    s_waitcnt lgkmcnt(7)
    s_add_u32 s47, s35, 0xa90c000
    buffer_store_dwordx4 v[32:35], v0, s[20:23], s47 offen sc1
    s_waitcnt lgkmcnt(6)
    s_add_u32 s44, s35, 0xa910000
    buffer_store_dwordx4 v[36:39], v0, s[20:23], s44 offen sc1
    s_waitcnt lgkmcnt(5)
    s_add_u32 s45, s35, 0xa914000
    buffer_store_dwordx4 v[76:79], v0, s[20:23], s45 offen sc1
    s_waitcnt lgkmcnt(4)
    s_add_u32 s46, s35, 0xa918000
    buffer_store_dwordx4 v[80:83], v0, s[20:23], s46 offen sc1
    s_waitcnt lgkmcnt(3)
    s_add_u32 s47, s35, 0xa91c000
    buffer_store_dwordx4 v[84:87], v0, s[20:23], s47 offen sc1
    s_waitcnt lgkmcnt(2)
    s_cmp_le_u32 s43, 5
    s_cbranch_scc1 L1_q15
    s_add_u32 s44, s35, 0xa920000
    buffer_store_dwordx4 v[104:107], v0, s[20:23], s44 offen sc1
L1_q15:
    s_waitcnt lgkmcnt(1)
    s_cmp_le_u32 s43, 6
    s_cbranch_scc1 L1_q16
    s_add_u32 s45, s35, 0xa924000
    buffer_store_dwordx4 v[68:71], v0, s[20:23], s45 offen sc1
L1_q16:
    s_waitcnt lgkmcnt(0)
    s_cmp_le_u32 s43, 7
    s_cbranch_scc1 L1_q17
    s_add_u32 s46, s35, 0xa928000
    buffer_store_dwordx4 v[72:75], v0, s[20:23], s46 offen sc1
L1_q17:
    s_waitcnt lgkmcnt(0)
    s_setprio 3
    v_mov_b32 v92, v0
    v_mov_b32 v93, v6
    v_mov_b32 v94, v13
    v_mov_b32 v95, v5
    v_mov_b32 v0, v14
    v_lshl_add_u32 v7, v13, 3, s38
    v_lshrrev_b32 v16, 2, v15
    v_mad_u32_u24 v4, v16, 5, v4
    v_or_b32 v4, 0xf0000000, v4
    v_or_b32 v2, 0xf0000000, v2
    v_sub_u32 v1, 28, v16
    v_lshrrev_b32 v17, 2, v16
    v_and_b32 v18, 3, v17
    v_lshlrev_b32 v18, 4, v18
    v_mov_b32 v10, 0x3f80
    v_mov_b32 v11, 0
    v_lshlrev_b64 v[10:11], v18, v[10:11]
    v_and_b32 v18, 3, v17
    v_lshlrev_b32 v18, 4, v18
    v_mov_b32 v12, 0xbf80
    v_mov_b32 v13, 0
    v_lshlrev_b64 v[12:13], v18, v[12:13]
    v_mov_b32 v45, 0xf0000000
    v_mov_b32 v5, 0x1fff8
    v_mov_b32 v6, 0x07ff0000
    v_mov_b32 v16, 0
    v_mov_b32 v17, 0
    v_mov_b32 v18, 0
    v_mov_b32 v19, 0
    v_add_u32 v20, 81920, v92
    v_add_u32 v21, 0x10000, v20
    s_setprio 1
    s_setprio 0
    s_mov_b32 s44, 0x4000c0c
    s_mov_b32 s45, 0x4010c0c
    s_mov_b32 s46, 0x4020c0c
    s_mov_b32 s47, 0x4030c0c
    s_mov_b32 s36, 0
    s_mov_b32 s43, 0
    s_mov_b32 s42, 0
    s_mov_b64 s[80:81], 0
    s_mov_b64 s[48:49], 0
    s_add_u32 s16, s30, 0xd344000
    s_addc_u32 s17, s31, 0
    s_mov_b32 s18, 0x500000
    s_mov_b32 s19, 0x20000
    v_mov_b32 v68, 0
    v_mov_b32 v69, 0
    v_mov_b32 v70, 0
    v_mov_b32 v71, 0
    v_mov_b32 v72, 0
    v_mov_b32 v73, 0
    v_mov_b32 v74, 0
    v_mov_b32 v75, 0
    s_waitcnt vmcnt(0)
    v_lshl_or_b32 v8, v101, 16, v100
    v_lshl_or_b32 v9, v103, 16, v102
    s_barrier
    s_cmp_lg_u32 s32, 0
    s_cbranch_scc1 L2_sg2
    s_mov_b32 exec_hi, 0
    v_mov_b32 v88, 2
    buffer_store_dword v88, v0, s[60:63], s57 offen sc1
    s_mov_b64 exec, -1
L2_sg2:
    s_mov_b64 s[84:85], 0
    s_mul_i32 s3, s33, 1280000
    s_add_u32 s3, s3, s100
    s_add_u32 s3, s3, 32768
    buffer_load_dwordx4 v[124:127], v94, s[24:27], s3 offen offset:2048
    s_mul_i32 s3, s33, 1280000
    s_add_u32 s3, s3, s100
    s_add_u32 s3, s3, 32768
    buffer_load_dwordx4 v[116:119], v94, s[24:27], s3 offen offset:0
    s_mul_i32 s3, s33, 1280000
    s_add_u32 s3, s3, s100
    s_add_u32 s3, s3, 32768
    buffer_load_dwordx4 v[120:123], v94, s[24:27], s3 offen offset:1024
    s_mul_i32 s3, s33, 1280000
    s_add_u32 s3, s3, s38
    s_add_u32 s3, s3, 0
    buffer_load_dwordx4 v[108:111], v94, s[24:27], s3 offen offset:0
    s_mul_i32 s3, s33, 1280000
    s_add_u32 s3, s3, s38
    s_add_u32 s3, s3, 0
    buffer_load_dwordx4 v[112:115], v94, s[24:27], s3 offen offset:1024
    ds_write_b128 v20, v[16:19] offset:0
    ds_write_b128 v20, v[16:19] offset:16384
    ds_write_b128 v20, v[16:19] offset:32768
    ds_write_b128 v20, v[16:19] offset:49152
    ds_write_b128 v21, v[16:19]
    s_cmp_eq_u32 s56, 0
    s_cbranch_scc1 L2_e3
    v_lshlrev_b32 v16, 3, v94
    v_and_b32 v16, 0x80, v16
L2_e4:
    buffer_load_dword v88, v16, s[68:71], 0 offen sc1
    s_waitcnt vmcnt(0)
    v_cmp_gt_u32 vcc, 0x80, v88
    s_cbranch_vccnz L2_e4
L2_e3:
    s_mov_b64 exec, 0xffff
L2_p1:
    buffer_load_dword v88, v7, s[60:63], 0 offen sc1
    s_waitcnt vmcnt(0)
    v_cmpx_gt_u32 vcc, 1, v88
    s_cbranch_vccnz L2_p1s
    s_mov_b64 exec, -1
    v_cmp_gt_u32 vcc, 2, v88
    s_and_b32 s56, vcc_lo, 0xffff
    buffer_load_dwordx4 v[48:51], v95, s[12:15], s39 offen offset:0
    buffer_load_dwordx4 v[56:59], v95, s[12:15], s39 offen offset:32
    buffer_load_dwordx4 v[52:55], v95, s[12:15], s39 offen offset:16
    buffer_load_dwordx4 v[60:63], v95, s[12:15], s39 offen offset:48
    buffer_load_dwordx4 v[64:67], v93, s[12:15], s39 offen
    s_waitcnt vmcnt(0)
    v_sub_u16 v88, v56, v48
    v_and_b32 v89, 3, v48
    v_add3_u32 v99, v88, v89, 3
    v_and_b32 v99, -4, v99
    v_max_u32 v99, 4, v99
    v_and_b32 v97, 0xfffc, v48
    v_bfm_b32 v96, v88, v89
    v_add_u32_dpp v91, v99, v99 row_shr:1 row_mask:0xf bank_mask:0xf bound_ctrl:1
    v_mad_u32_u24 v97, v97, 5, v2
    v_cmp_lt_u32 vcc, 16, v99
    v_add_u32_dpp v91, v91, v91 row_shr:2 row_mask:0xf bank_mask:0xf bound_ctrl:1
    v_sub_u32 v98, s38, v99
    v_lshrrev_b64 v[48:49], 16, v[48:49]
    v_add_u32_dpp v91, v91, v91 row_shr:4 row_mask:0xf bank_mask:0xf bound_ctrl:1
    v_lshrrev_b64 v[56:57], 16, v[56:57]
    s_mov_b32 s101, 0
    v_add_u32_dpp v91, v91, v91 row_shr:8 row_mask:0xf bank_mask:0xf bound_ctrl:1
    s_nop 1
    v_add_u32_dpp v91, v91, v91 row_bcast:15 row_mask:0xa bank_mask:0xf
    s_nop 1
    v_add_u32_dpp v91, v91, v91 row_bcast:31 row_mask:0xc bank_mask:0xf
    v_add_u32 v98, v98, v91
    v_readlane_b32 s37, v91, 63
    s_cbranch_vccnz L2_xo3
L2_xp3:
    v_mov_b32 v44, v43
    s_cmp_gt_u32 s37, 1024
    s_cbranch_scc1 L2_xs4
    s_cmp_lg_u32 s101, 0
    s_cbranch_scc1 L2_xa4
L2_xb4:
    v_lshlrev_b32 v89, 16, v96
    v_add_u32 v90, 60, v97
    v_bitop3_b32 v90, v89, v45, v90 bitop3:0x6a
    ds_write_b32 v98, v90 offset:12
    v_lshlrev_b32 v89, 20, v96
    v_add_u32 v90, 40, v97
    v_bitop3_b32 v90, v89, v45, v90 bitop3:0x6a
    ds_write_b32 v98, v90 offset:8
    v_lshlrev_b32 v89, 24, v96
    v_add_u32 v90, 20, v97
    v_bitop3_b32 v90, v89, v45, v90 bitop3:0x6a
    ds_write_b32 v98, v90 offset:4
    v_lshlrev_b32 v89, 28, v96
    v_bitop3_b32 v90, v89, v45, v97 bitop3:0x6a
    ds_write_b32 v98, v90 offset:0
    v_mov_b32_dpp v91, v64 quad_perm:[0,0,0,0] row_mask:0xf bank_mask:0xf
    v_and_b32 v89, 3, v91
    v_and_b32 v97, 0xfffc, v91
    v_sub_u16_dpp v88, v64, v91 quad_perm:[2,2,2,2] row_mask:0xf bank_mask:0xf
    v_mad_u32_u24 v97, v97, 5, v4
    v_add_u32 v99, v88, v89
    v_bfm_b32 v96, v88, v89
    v_cmp_lt_u32 s[58:59], 16, v99
    v_lshlrev_b32 v89, v1, v96
    v_and_b32 v89, v45, v89
    v_cmp_ne_u32 vcc, 0, v89
    v_xor_b32 v90, v97, v89
    s_add_u32 s3, s37, s38
    v_mbcnt_lo_u32_b32 v98, vcc_lo, 0
    v_mbcnt_hi_u32_b32 v98, vcc_hi, v98
    s_bcnt1_i32_b64 s41, vcc
    v_lshl_add_u32 v98, v98, 2, s3
    s_mov_b64 exec, vcc
    ds_write_b32 v98, v90
    s_mov_b64 exec, -1
    s_lshl2_add_u32 s37, s41, s37
    s_cmp_lg_u64 s[58:59], 0
    s_cbranch_scc1 L2_xe4
L2_xr4:
    v_add_u32 v98, s37, v0
    v_mov_b32 v90, -1
    ds_write_b32 v98, v90
    ds_read2st64_b32 v[40:41], v0 offset0:0 offset1:1
    ds_read2st64_b32 v[42:43], v0 offset0:2 offset1:3
    s_sub_u32 s3, s37, 768
    s_cmp_gt_u32 s3, 256
    s_cbranch_scc1 L2_xf4
L2_xg4:
    v_sub_u16 v88, v58, v50
    v_and_b32 v89, 3, v50
    v_add3_u32 v99, v88, v89, 3
    v_and_b32 v99, -4, v99
    v_max_u32 v99, 4, v99
    v_and_b32 v97, 0xfffc, v50
    v_bfm_b32 v96, v88, v89
    v_add_u32_dpp v91, v99, v99 row_shr:1 row_mask:0xf bank_mask:0xf bound_ctrl:1
    v_mad_u32_u24 v97, v97, 5, v2
    v_cmp_lt_u32 vcc, 16, v99
    v_add_u32_dpp v91, v91, v91 row_shr:2 row_mask:0xf bank_mask:0xf bound_ctrl:1
    v_sub_u32 v98, s38, v99
    v_lshrrev_b64 v[50:51], 16, v[50:51]
    v_add_u32_dpp v91, v91, v91 row_shr:4 row_mask:0xf bank_mask:0xf bound_ctrl:1
    v_lshrrev_b64 v[58:59], 16, v[58:59]
    s_mov_b32 s101, 0
    v_add_u32_dpp v91, v91, v91 row_shr:8 row_mask:0xf bank_mask:0xf bound_ctrl:1
    s_nop 1
    v_add_u32_dpp v91, v91, v91 row_bcast:15 row_mask:0xa bank_mask:0xf
    s_nop 1
    v_add_u32_dpp v91, v91, v91 row_bcast:31 row_mask:0xc bank_mask:0xf
    v_add_u32 v98, v98, v91
    v_readlane_b32 s37, v91, 63
    s_cbranch_vccnz L2_xo5
L2_xp5:
    s_waitcnt lgkmcnt(0)
    v_mov_b32 v21, v40
    v_mov_b32 v27, v41
    v_mov_b32 v33, v42
    v_mov_b32 v39, v43
    v_mov_b32 v44, v43
    s_cmp_gt_u32 s37, 1024
    s_cbranch_scc1 L2_xs6
    s_cmp_lg_u32 s101, 0
    s_cbranch_scc1 L2_xa6
L2_xb6:
    v_lshlrev_b32 v89, 16, v96
    v_add_u32 v90, 60, v97
    v_bitop3_b32 v90, v89, v45, v90 bitop3:0x6a
    ds_write_b32 v98, v90 offset:12
    v_lshlrev_b32 v89, 20, v96
    v_add_u32 v90, 40, v97
    v_bitop3_b32 v90, v89, v45, v90 bitop3:0x6a
    ds_write_b32 v98, v90 offset:8
    v_lshlrev_b32 v89, 24, v96
    v_add_u32 v90, 20, v97
    v_bitop3_b32 v90, v89, v45, v90 bitop3:0x6a
    ds_write_b32 v98, v90 offset:4
    v_lshlrev_b32 v89, 28, v96
    v_bitop3_b32 v90, v89, v45, v97 bitop3:0x6a
    ds_write_b32 v98, v90 offset:0
    v_mov_b32_dpp v91, v66 quad_perm:[0,0,0,0] row_mask:0xf bank_mask:0xf
    v_and_b32 v89, 3, v91
    v_and_b32 v97, 0xfffc, v91
    v_sub_u16_dpp v88, v66, v91 quad_perm:[2,2,2,2] row_mask:0xf bank_mask:0xf
    v_mad_u32_u24 v97, v97, 5, v4
    v_add_u32 v99, v88, v89
    v_bfm_b32 v96, v88, v89
    v_cmp_lt_u32 s[58:59], 16, v99
    v_lshlrev_b32 v89, v1, v96
    v_and_b32 v89, v45, v89
    v_cmp_ne_u32 vcc, 0, v89
    v_xor_b32 v90, v97, v89
    s_add_u32 s3, s37, s38
    v_mbcnt_lo_u32_b32 v98, vcc_lo, 0
    v_mbcnt_hi_u32_b32 v98, vcc_hi, v98
    s_bcnt1_i32_b64 s41, vcc
    v_lshl_add_u32 v98, v98, 2, s3
    s_mov_b64 exec, vcc
    ds_write_b32 v98, v90
    s_mov_b64 exec, -1
    s_lshl2_add_u32 s37, s41, s37
    s_cmp_lg_u64 s[58:59], 0
    s_cbranch_scc1 L2_xe6
L2_xr6:
    v_add_u32 v98, s37, v0
    v_mov_b32 v90, -1
    ds_write_b32 v98, v90
    ds_read2st64_b32 v[40:41], v0 offset0:0 offset1:1
    ds_read2st64_b32 v[42:43], v0 offset0:2 offset1:3
    s_sub_u32 s3, s37, 768
    s_cmp_gt_u32 s3, 256
    s_cbranch_scc1 L2_xf6
L2_xg6:
    v_subrev_u32 v88, s38, v3
    ds_write_b128 v88, v[124:127] offset:34816
    v_subrev_u32 v88, s38, v3
    ds_write_b128 v88, v[116:119] offset:32768
    v_subrev_u32 v88, s38, v3
    ds_write_b128 v88, v[120:123] offset:33792
    v_subrev_u32 v88, s100, v3
    ds_write_b128 v88, v[108:111] offset:0
    v_subrev_u32 v88, s100, v3
    ds_write_b128 v88, v[112:115] offset:1024
    s_cmp_eq_u32 s56, 0
    s_cbranch_scc1 L2_e2
    s_mov_b32 exec_lo, s56
    s_mov_b32 exec_hi, 0
    buffer_load_dword v88, v7, s[60:63], 0 offen sc1
    s_mov_b64 exec, -1
    s_waitcnt vmcnt(0)
    v_cmp_gt_u32 vcc, 2, v88
    s_and_b32 s56, vcc_lo, s56
    s_cbranch_scc0 L2_e2
    s_mul_i32 s3, s33, 1280000
    s_add_u32 s3, s3, s100
    s_add_u32 s3, s3, 352768
    buffer_load_dwordx4 v[124:127], v94, s[24:27], s3 offen offset:2048
    s_mul_i32 s3, s33, 1280000
    s_add_u32 s3, s3, s100
    s_add_u32 s3, s3, 352768
    buffer_load_dwordx4 v[116:119], v94, s[24:27], s3 offen offset:0
    s_mul_i32 s3, s33, 1280000
    s_add_u32 s3, s3, s100
    s_add_u32 s3, s3, 352768
    buffer_load_dwordx4 v[120:123], v94, s[24:27], s3 offen offset:1024
    s_mul_i32 s3, s33, 1280000
    s_add_u32 s3, s3, s38
    s_add_u32 s3, s3, 320000
    buffer_load_dwordx4 v[108:111], v94, s[24:27], s3 offen offset:0
    s_mul_i32 s3, s33, 1280000
    s_add_u32 s3, s3, s38
    s_add_u32 s3, s3, 320000
    buffer_load_dwordx4 v[112:115], v94, s[24:27], s3 offen offset:1024
    s_mov_b32 exec_lo, s56
    s_mov_b32 exec_hi, 0
L2_p2:
    buffer_load_dword v88, v7, s[60:63], 0 offen sc1
    s_waitcnt vmcnt(0)
    v_cmpx_gt_u32 vcc, 2, v88
    s_cbranch_vccnz L2_p2s
    s_mov_b64 exec, -1
L2_e2:
    s_mov_b32 s6, 0xaaaaaaaa
    s_mov_b32 s7, 0xaaaaaaaa
    v_and_b32 v47, 0x0fffffff, v21
    buffer_load_dwordx2 v[16:17], v47, s[8:11], 0 offen
    buffer_load_dwordx3 v[18:20], v47, s[8:11], 0 offen offset:8
    s_waitcnt lgkmcnt(0)
    s_barrier
    s_bitcmp1_b32 s36, s42
    s_cbranch_scc1 L2_slow
L2_ret0:
    s_setprio 3
    v_and_b32 v47, 0x0fffffff, v27
    buffer_load_dwordx2 v[22:23], v47, s[8:11], 0 offen
    buffer_load_dwordx3 v[24:26], v47, s[8:11], 0 offen offset:8
    s_waitcnt vmcnt(2)
    v_and_b32 v46, 0x20000000, v21
    v_lshrrev_b32 v47, 14, v17
    v_bitop3_b32 v47, v47, v5, v46 bitop3:0xea
    ds_read_b64 v[102:103], v47
    v_bitop3_b32 v93, v17, v5, v46 bitop3:0xea
    v_and_b32 v46, 0x10000000, v21
    v_lshrrev_b32 v47, 14, v16
    v_bitop3_b32 v47, v47, v5, v46 bitop3:0xea
    ds_read_b64 v[100:101], v47
    v_bitop3_b32 v92, v16, v5, v46 bitop3:0xea
    v_perm_b32 v15, v17, v20, s45
    v_bitop3_b32 v46, v17, 0.5, -0.5 bitop3:0xa8
    v_perm_b32 v14, v16, v20, s44
    v_bitop3_b32 v47, v16, 0.5, -0.5 bitop3:0xa8
    s_waitcnt lgkmcnt(0)
    v_mfma_f32_4x4x4_16b_bf16 v[80:83], v[8:9], v[102:103], 0
    v_mfma_f32_4x4x4_16b_bf16 v[76:79], v[8:9], v[100:101], 0
    v_bitop3_b32 v15, v6, v15, v46 bitop3:0xca
    v_bitop3_b32 v14, v6, v14, v47 bitop3:0xca
    v_cmp_lt_u32 s[84:85], v5, v92
    s_nop 0
    v_pk_mul_f32 v[80:81], v[80:81], v[14:15] op_sel:[0,1] op_sel_hi:[1,1]
    v_pk_mul_f32 v[82:83], v[82:83], v[14:15] op_sel:[0,1] op_sel_hi:[1,1]
    v_pk_mul_f32 v[76:77], v[76:77], v[14:15] op_sel:[0,0] op_sel_hi:[1,0]
    v_pk_mul_f32 v[78:79], v[78:79], v[14:15] op_sel:[0,0] op_sel_hi:[1,0]
    v_and_b32 v47, 0x0fffffff, v33
    buffer_load_dwordx2 v[28:29], v47, s[8:11], 0 offen
    buffer_load_dwordx3 v[30:32], v47, s[8:11], 0 offen offset:8
    v_cmp_ne_u64 s[50:51], v[72:73], v[68:69]
    v_cmpx_ne_u64 s[54:55], v[74:75], v[70:71]
    s_and_b64 s[82:83], s[54:55], s[80:81]
    s_cbranch_scc1 L2_c7
L2_d7:
    v_mov_b64 v[84:85], v[70:71]
    v_mov_b32 v7, v95
    v_mov_b64 v[86:87], v[74:75]
    s_or_b64 s[80:81], s[80:81], s[54:55]
    s_mov_b64 exec, s[50:51]
    s_and_b64 s[82:83], s[50:51], s[80:81]
    s_cbranch_scc1 L2_c8
L2_d8:
    v_mov_b64 v[84:85], v[68:69]
    v_mov_b32 v7, v94
    v_mov_b64 v[86:87], v[72:73]
    s_mov_b64 exec, -1
    s_or_b64 s[80:81], s[80:81], s[50:51]
    ds_read_b64 v[70:71], v93 offset:65408
    s_and_b64 exec, s[84:85], s[80:81]
    v_mfma_f32_4x4x4_16b_bf16 v[76:79], v[12:13], v[84:85], 0
    v_mov_b32 v92, v7
    s_andn2_b64 s[80:81], s[80:81], s[84:85]
    v_mfma_f32_4x4x4_16b_bf16 v[76:79], v[10:11], v[86:87], v[76:79]
    s_mov_b64 exec, -1
    ds_read_b64 v[68:69], v92 offset:65408
    v_and_b32 v46, 0x80000000, v21
    v_lshrrev_b32 v47, 14, v19
    v_bitop3_b32 v47, v47, v5, v46 bitop3:0xea
    ds_read_b64 v[106:107], v47
    v_bitop3_b32 v95, v19, v5, v46 bitop3:0xea
    v_and_b32 v46, 0x40000000, v21
    v_lshrrev_b32 v47, 14, v18
    v_bitop3_b32 v47, v47, v5, v46 bitop3:0xea
    ds_read_b64 v[104:105], v47
    v_bitop3_b32 v94, v18, v5, v46 bitop3:0xea
    s_waitcnt lgkmcnt(2)
    v_mfma_f32_4x4x4_16b_bf16 v[80:83], v[10:11], v[70:71], v[80:83]
    v_mfma_f32_4x4x4_16b_bf16 v[76:79], v[10:11], v[68:69], v[76:79]
    v_perm_b32 v15, v19, v20, s47
    v_bitop3_b32 v46, v19, 0.5, -0.5 bitop3:0xa8
    v_perm_b32 v14, v18, v20, s46
    v_bitop3_b32 v47, v18, 0.5, -0.5 bitop3:0xa8
    v_cvt_pk_bf16_f32 v80, v80, v81
    v_cvt_pk_bf16_f32 v81, v82, v83
    ds_wrxchg_rtn_b64 v[74:75], v93, v[80:81] offset:65408
    v_cvt_pk_bf16_f32 v76, v76, v77
    v_cvt_pk_bf16_f32 v77, v78, v79
    ds_wrxchg_rtn_b64 v[72:73], v92, v[76:77] offset:65408
    s_setprio 2
    s_waitcnt lgkmcnt(2)
    v_mfma_f32_4x4x4_16b_bf16 v[80:83], v[8:9], v[106:107], 0
    v_mfma_f32_4x4x4_16b_bf16 v[76:79], v[8:9], v[104:105], 0
    v_bitop3_b32 v15, v6, v15, v46 bitop3:0xca
    v_bitop3_b32 v14, v6, v14, v47 bitop3:0xca
    s_nop 1
    v_pk_mul_f32 v[80:81], v[80:81], v[14:15] op_sel:[0,1] op_sel_hi:[1,1]
    v_pk_mul_f32 v[82:83], v[82:83], v[14:15] op_sel:[0,1] op_sel_hi:[1,1]
    v_pk_mul_f32 v[76:77], v[76:77], v[14:15] op_sel:[0,0] op_sel_hi:[1,0]
    v_pk_mul_f32 v[78:79], v[78:79], v[14:15] op_sel:[0,0] op_sel_hi:[1,0]
    v_sub_u16 v88, v60, v52
    v_and_b32 v89, 3, v52
    v_add3_u32 v99, v88, v89, 3
    v_and_b32 v99, -4, v99
    v_max_u32 v99, 4, v99
    v_and_b32 v97, 0xfffc, v52
    v_bfm_b32 v96, v88, v89
    v_add_u32_dpp v91, v99, v99 row_shr:1 row_mask:0xf bank_mask:0xf bound_ctrl:1
    v_mad_u32_u24 v97, v97, 5, v2
    v_cmp_lt_u32 vcc, 16, v99
    v_add_u32_dpp v91, v91, v91 row_shr:2 row_mask:0xf bank_mask:0xf bound_ctrl:1
    v_sub_u32 v98, s38, v99
    v_lshrrev_b64 v[52:53], 16, v[52:53]
    v_add_u32_dpp v91, v91, v91 row_shr:4 row_mask:0xf bank_mask:0xf bound_ctrl:1
    v_lshrrev_b64 v[60:61], 16, v[60:61]
    s_mov_b32 s101, 0
    v_add_u32_dpp v91, v91, v91 row_shr:8 row_mask:0xf bank_mask:0xf bound_ctrl:1
    s_nop 1
    v_add_u32_dpp v91, v91, v91 row_bcast:15 row_mask:0xa bank_mask:0xf
    s_nop 1
    v_add_u32_dpp v91, v91, v91 row_bcast:31 row_mask:0xc bank_mask:0xf
    v_add_u32 v98, v98, v91
    v_readlane_b32 s37, v91, 63
    s_cbranch_vccnz L2_xo9
L2_xp9:
    v_and_b32 v47, 0x3f0, v3
    s_cmp_lg_u32 s56, 0
    s_cbranch_scc1 L2_m10
    s_mul_i32 s3, s33, 1280000
    s_add_u32 s3, s3, s100
    s_add_u32 s3, s3, 352768
    buffer_load_dwordx4 v[124:127], v47, s[24:27], s3 offen offset:2048
L2_m10:
    v_and_b32 v47, 0x3f0, v3
    s_cmp_lg_u32 s56, 0
    s_cbranch_scc1 L2_m11
    s_mul_i32 s3, s33, 1280000
    s_add_u32 s3, s3, s100
    s_add_u32 s3, s3, 352768
    buffer_load_dwordx4 v[116:119], v47, s[24:27], s3 offen offset:0
L2_m11:
    s_waitcnt lgkmcnt(0)
    v_cmp_ne_u64 s[50:51], v[72:73], v[68:69]
    v_cmpx_ne_u64 s[54:55], v[74:75], v[70:71]
    s_and_b64 s[82:83], s[54:55], s[80:81]
    s_cbranch_scc1 L2_c12
L2_d12:
    v_mov_b64 v[84:85], v[70:71]
    v_mov_b32 v7, v93
    v_mov_b64 v[86:87], v[74:75]
    s_or_b64 s[80:81], s[80:81], s[54:55]
    s_mov_b64 exec, s[50:51]
    s_and_b64 s[82:83], s[50:51], s[80:81]
    s_cbranch_scc1 L2_c13
L2_d13:
    v_mov_b64 v[84:85], v[68:69]
    v_mov_b32 v7, v92
    v_mov_b64 v[86:87], v[72:73]
    s_mov_b64 exec, -1
    s_or_b64 s[80:81], s[80:81], s[50:51]
    ds_read_b64 v[70:71], v95 offset:65408
    ds_read_b64 v[68:69], v94 offset:65408
    s_waitcnt vmcnt(2)
    v_and_b32 v46, 0x20000000, v27
    v_lshrrev_b32 v47, 14, v23
    v_bitop3_b32 v47, v47, v5, v46 bitop3:0xea
    ds_read_b64 v[102:103], v47
    v_bitop3_b32 v93, v23, v5, v46 bitop3:0xea
    v_and_b32 v46, 0x10000000, v27
    v_lshrrev_b32 v47, 14, v22
    v_bitop3_b32 v47, v47, v5, v46 bitop3:0xea
    ds_read_b64 v[100:101], v47
    v_bitop3_b32 v92, v22, v5, v46 bitop3:0xea
    s_waitcnt lgkmcnt(2)
    v_mfma_f32_4x4x4_16b_bf16 v[80:83], v[10:11], v[70:71], v[80:83]
    v_mfma_f32_4x4x4_16b_bf16 v[76:79], v[10:11], v[68:69], v[76:79]
    v_perm_b32 v15, v23, v26, s45
    v_bitop3_b32 v46, v23, 0.5, -0.5 bitop3:0xa8
    v_perm_b32 v14, v22, v26, s44
    v_bitop3_b32 v47, v22, 0.5, -0.5 bitop3:0xa8
    v_cvt_pk_bf16_f32 v80, v80, v81
    v_cvt_pk_bf16_f32 v81, v82, v83
    ds_wrxchg_rtn_b64 v[74:75], v95, v[80:81] offset:65408
    v_cvt_pk_bf16_f32 v76, v76, v77
    v_cvt_pk_bf16_f32 v77, v78, v79
    ds_wrxchg_rtn_b64 v[72:73], v94, v[76:77] offset:65408
    s_waitcnt lgkmcnt(2)
    v_mfma_f32_4x4x4_16b_bf16 v[80:83], v[8:9], v[102:103], 0
    v_mfma_f32_4x4x4_16b_bf16 v[76:79], v[8:9], v[100:101], 0
    v_bitop3_b32 v15, v6, v15, v46 bitop3:0xca
    v_bitop3_b32 v14, v6, v14, v47 bitop3:0xca
    v_cmp_lt_u32 s[84:85], v5, v92
    s_nop 0
    v_pk_mul_f32 v[80:81], v[80:81], v[14:15] op_sel:[0,1] op_sel_hi:[1,1]
    v_pk_mul_f32 v[82:83], v[82:83], v[14:15] op_sel:[0,1] op_sel_hi:[1,1]
    v_pk_mul_f32 v[76:77], v[76:77], v[14:15] op_sel:[0,0] op_sel_hi:[1,0]
    v_pk_mul_f32 v[78:79], v[78:79], v[14:15] op_sel:[0,0] op_sel_hi:[1,0]
    v_and_b32 v47, 0x0fffffff, v39
    buffer_load_dwordx2 v[34:35], v47, s[8:11], 0 offen
    buffer_load_dwordx3 v[36:38], v47, s[8:11], 0 offen offset:8
    v_and_b32 v47, 0x3f0, v3
    s_cmp_lg_u32 s56, 0
    s_cbranch_scc1 L2_m14
    s_mul_i32 s3, s33, 1280000
    s_add_u32 s3, s3, s100
    s_add_u32 s3, s3, 352768
    buffer_load_dwordx4 v[120:123], v47, s[24:27], s3 offen offset:1024
L2_m14:
    s_waitcnt lgkmcnt(0)
    v_cmp_ne_u64 s[50:51], v[72:73], v[68:69]
    v_cmpx_ne_u64 s[54:55], v[74:75], v[70:71]
    s_and_b64 s[82:83], s[54:55], s[80:81]
    s_cbranch_scc1 L2_c15
L2_d15:
    v_mov_b64 v[84:85], v[70:71]
    v_mov_b32 v7, v95
    v_mov_b64 v[86:87], v[74:75]
    s_or_b64 s[80:81], s[80:81], s[54:55]
    s_mov_b64 exec, s[50:51]
    s_and_b64 s[82:83], s[50:51], s[80:81]
    s_cbranch_scc1 L2_c16
L2_d16:
    v_mov_b64 v[84:85], v[68:69]
    v_mov_b32 v7, v94
    v_mov_b64 v[86:87], v[72:73]
    s_mov_b64 exec, -1
    s_or_b64 s[80:81], s[80:81], s[50:51]
    ds_read_b64 v[70:71], v93 offset:65408
    s_and_b64 exec, s[84:85], s[80:81]
    v_mfma_f32_4x4x4_16b_bf16 v[76:79], v[12:13], v[84:85], 0
    v_mov_b32 v92, v7
    s_andn2_b64 s[80:81], s[80:81], s[84:85]
    v_mfma_f32_4x4x4_16b_bf16 v[76:79], v[10:11], v[86:87], v[76:79]
    s_mov_b64 exec, -1
    ds_read_b64 v[68:69], v92 offset:65408
    v_and_b32 v46, 0x80000000, v27
    v_lshrrev_b32 v47, 14, v25
    v_bitop3_b32 v47, v47, v5, v46 bitop3:0xea
    ds_read_b64 v[106:107], v47
    v_bitop3_b32 v95, v25, v5, v46 bitop3:0xea
    v_and_b32 v46, 0x40000000, v27
    v_lshrrev_b32 v47, 14, v24
    v_bitop3_b32 v47, v47, v5, v46 bitop3:0xea
    ds_read_b64 v[104:105], v47
    v_bitop3_b32 v94, v24, v5, v46 bitop3:0xea
    s_waitcnt lgkmcnt(2)
    v_mfma_f32_4x4x4_16b_bf16 v[80:83], v[10:11], v[70:71], v[80:83]
    v_mfma_f32_4x4x4_16b_bf16 v[76:79], v[10:11], v[68:69], v[76:79]
    v_perm_b32 v15, v25, v26, s47
    v_bitop3_b32 v46, v25, 0.5, -0.5 bitop3:0xa8
    v_perm_b32 v14, v24, v26, s46
    v_bitop3_b32 v47, v24, 0.5, -0.5 bitop3:0xa8
    v_cvt_pk_bf16_f32 v80, v80, v81
    v_cvt_pk_bf16_f32 v81, v82, v83
    ds_wrxchg_rtn_b64 v[74:75], v93, v[80:81] offset:65408
    v_cvt_pk_bf16_f32 v76, v76, v77
    v_cvt_pk_bf16_f32 v77, v78, v79
    ds_wrxchg_rtn_b64 v[72:73], v92, v[76:77] offset:65408
    s_setprio 1
    s_waitcnt lgkmcnt(2)
    v_mfma_f32_4x4x4_16b_bf16 v[80:83], v[8:9], v[106:107], 0
    v_mfma_f32_4x4x4_16b_bf16 v[76:79], v[8:9], v[104:105], 0
    v_bitop3_b32 v15, v6, v15, v46 bitop3:0xca
    v_bitop3_b32 v14, v6, v14, v47 bitop3:0xca
    s_nop 1
    v_pk_mul_f32 v[80:81], v[80:81], v[14:15] op_sel:[0,1] op_sel_hi:[1,1]
    v_pk_mul_f32 v[82:83], v[82:83], v[14:15] op_sel:[0,1] op_sel_hi:[1,1]
    v_pk_mul_f32 v[76:77], v[76:77], v[14:15] op_sel:[0,0] op_sel_hi:[1,0]
    v_pk_mul_f32 v[78:79], v[78:79], v[14:15] op_sel:[0,0] op_sel_hi:[1,0]
    v_and_b32 v47, 0x3f0, v3
    s_cmp_lg_u32 s56, 0
    s_cbranch_scc1 L2_m17
    s_mul_i32 s3, s33, 1280000
    s_add_u32 s3, s3, s38
    s_add_u32 s3, s3, 320000
    buffer_load_dwordx4 v[108:111], v47, s[24:27], s3 offen offset:0
L2_m17:
    v_and_b32 v47, 0x3f0, v3
    s_cmp_lg_u32 s56, 0
    s_cbranch_scc1 L2_m18
    s_mul_i32 s3, s33, 1280000
    s_add_u32 s3, s3, s38
    s_add_u32 s3, s3, 320000
    buffer_load_dwordx4 v[112:115], v47, s[24:27], s3 offen offset:1024
L2_m18:
    v_and_b32 v47, 0x0fffffff, v40
    v_mov_b32 v21, v40
    buffer_load_dwordx2 v[16:17], v47, s[8:11], 0 offen
    buffer_load_dwordx3 v[18:20], v47, s[8:11], 0 offen offset:8
    s_waitcnt lgkmcnt(0)
    v_cmp_ne_u64 s[50:51], v[72:73], v[68:69]
    v_cmpx_ne_u64 s[54:55], v[74:75], v[70:71]
    s_and_b64 s[82:83], s[54:55], s[80:81]
    s_cbranch_scc1 L2_c19
L2_d19:
    v_mov_b64 v[84:85], v[70:71]
    v_mov_b32 v7, v93
    v_mov_b64 v[86:87], v[74:75]
    s_or_b64 s[80:81], s[80:81], s[54:55]
    s_mov_b64 exec, s[50:51]
    s_and_b64 s[82:83], s[50:51], s[80:81]
    s_cbranch_scc1 L2_c20
L2_d20:
    v_mov_b64 v[84:85], v[68:69]
    v_mov_b32 v7, v92
    v_mov_b64 v[86:87], v[72:73]
    s_mov_b64 exec, -1
    s_or_b64 s[80:81], s[80:81], s[50:51]
    ds_read_b64 v[70:71], v95 offset:65408
    ds_read_b64 v[68:69], v94 offset:65408
    s_waitcnt vmcnt(4)
    v_and_b32 v46, 0x20000000, v33
    v_lshrrev_b32 v47, 14, v29
    v_bitop3_b32 v47, v47, v5, v46 bitop3:0xea
    ds_read_b64 v[102:103], v47
    v_bitop3_b32 v93, v29, v5, v46 bitop3:0xea
    v_and_b32 v46, 0x10000000, v33
    v_lshrrev_b32 v47, 14, v28
    v_bitop3_b32 v47, v47, v5, v46 bitop3:0xea
    ds_read_b64 v[100:101], v47
    v_bitop3_b32 v92, v28, v5, v46 bitop3:0xea
    s_waitcnt lgkmcnt(2)
    v_mfma_f32_4x4x4_16b_bf16 v[80:83], v[10:11], v[70:71], v[80:83]
    v_mfma_f32_4x4x4_16b_bf16 v[76:79], v[10:11], v[68:69], v[76:79]
    v_perm_b32 v15, v29, v32, s45
    v_bitop3_b32 v46, v29, 0.5, -0.5 bitop3:0xa8
    v_perm_b32 v14, v28, v32, s44
    v_bitop3_b32 v47, v28, 0.5, -0.5 bitop3:0xa8
    v_cvt_pk_bf16_f32 v80, v80, v81
    v_cvt_pk_bf16_f32 v81, v82, v83
    ds_wrxchg_rtn_b64 v[74:75], v95, v[80:81] offset:65408
    v_cvt_pk_bf16_f32 v76, v76, v77
    v_cvt_pk_bf16_f32 v77, v78, v79
    ds_wrxchg_rtn_b64 v[72:73], v94, v[76:77] offset:65408
    s_waitcnt lgkmcnt(2)
    v_mfma_f32_4x4x4_16b_bf16 v[80:83], v[8:9], v[102:103], 0
    v_mfma_f32_4x4x4_16b_bf16 v[76:79], v[8:9], v[100:101], 0
    v_bitop3_b32 v15, v6, v15, v46 bitop3:0xca
    v_bitop3_b32 v14, v6, v14, v47 bitop3:0xca
    v_cmp_lt_u32 s[84:85], v5, v92
    s_nop 0
    v_pk_mul_f32 v[80:81], v[80:81], v[14:15] op_sel:[0,1] op_sel_hi:[1,1]
    v_pk_mul_f32 v[82:83], v[82:83], v[14:15] op_sel:[0,1] op_sel_hi:[1,1]
    v_pk_mul_f32 v[76:77], v[76:77], v[14:15] op_sel:[0,0] op_sel_hi:[1,0]
    v_pk_mul_f32 v[78:79], v[78:79], v[14:15] op_sel:[0,0] op_sel_hi:[1,0]
    s_waitcnt lgkmcnt(0)
    v_cmp_ne_u64 s[50:51], v[72:73], v[68:69]
    v_cmpx_ne_u64 s[54:55], v[74:75], v[70:71]
    s_and_b64 s[82:83], s[54:55], s[80:81]
    s_cbranch_scc1 L2_c21
L2_d21:
    v_mov_b64 v[84:85], v[70:71]
    v_mov_b32 v7, v95
    v_mov_b64 v[86:87], v[74:75]
    s_or_b64 s[80:81], s[80:81], s[54:55]
    s_mov_b64 exec, s[50:51]
    s_and_b64 s[82:83], s[50:51], s[80:81]
    s_cbranch_scc1 L2_c22
L2_d22:
    v_mov_b64 v[84:85], v[68:69]
    v_mov_b32 v7, v94
    v_mov_b64 v[86:87], v[72:73]
    s_mov_b64 exec, -1
    s_or_b64 s[80:81], s[80:81], s[50:51]
    ds_read_b64 v[70:71], v93 offset:65408
    s_and_b64 exec, s[84:85], s[80:81]
    v_mfma_f32_4x4x4_16b_bf16 v[76:79], v[12:13], v[84:85], 0
    v_mov_b32 v92, v7
    s_andn2_b64 s[80:81], s[80:81], s[84:85]
    v_mfma_f32_4x4x4_16b_bf16 v[76:79], v[10:11], v[86:87], v[76:79]
    s_mov_b64 exec, -1
    ds_read_b64 v[68:69], v92 offset:65408
    v_and_b32 v46, 0x80000000, v33
    v_lshrrev_b32 v47, 14, v31
    v_bitop3_b32 v47, v47, v5, v46 bitop3:0xea
    ds_read_b64 v[106:107], v47
    v_bitop3_b32 v95, v31, v5, v46 bitop3:0xea
    v_and_b32 v46, 0x40000000, v33
    v_lshrrev_b32 v47, 14, v30
    v_bitop3_b32 v47, v47, v5, v46 bitop3:0xea
    ds_read_b64 v[104:105], v47
    v_bitop3_b32 v94, v30, v5, v46 bitop3:0xea
    s_waitcnt lgkmcnt(2)
    v_mfma_f32_4x4x4_16b_bf16 v[80:83], v[10:11], v[70:71], v[80:83]
    v_mfma_f32_4x4x4_16b_bf16 v[76:79], v[10:11], v[68:69], v[76:79]
    v_perm_b32 v15, v31, v32, s47
    v_bitop3_b32 v46, v31, 0.5, -0.5 bitop3:0xa8
    v_perm_b32 v14, v30, v32, s46
    v_bitop3_b32 v47, v30, 0.5, -0.5 bitop3:0xa8
    v_cvt_pk_bf16_f32 v80, v80, v81
    v_cvt_pk_bf16_f32 v81, v82, v83
    ds_wrxchg_rtn_b64 v[74:75], v93, v[80:81] offset:65408
    v_cvt_pk_bf16_f32 v76, v76, v77
    v_cvt_pk_bf16_f32 v77, v78, v79
    ds_wrxchg_rtn_b64 v[72:73], v92, v[76:77] offset:65408
    s_setprio 0
    s_waitcnt lgkmcnt(2)
    v_mfma_f32_4x4x4_16b_bf16 v[80:83], v[8:9], v[106:107], 0
    v_mfma_f32_4x4x4_16b_bf16 v[76:79], v[8:9], v[104:105], 0
    v_bitop3_b32 v15, v6, v15, v46 bitop3:0xca
    v_bitop3_b32 v14, v6, v14, v47 bitop3:0xca
    s_nop 1
    v_pk_mul_f32 v[80:81], v[80:81], v[14:15] op_sel:[0,1] op_sel_hi:[1,1]
    v_pk_mul_f32 v[82:83], v[82:83], v[14:15] op_sel:[0,1] op_sel_hi:[1,1]
    v_pk_mul_f32 v[76:77], v[76:77], v[14:15] op_sel:[0,0] op_sel_hi:[1,0]
    v_pk_mul_f32 v[78:79], v[78:79], v[14:15] op_sel:[0,0] op_sel_hi:[1,0]
    s_add_u32 s40, s40, 0x50000
    v_and_b32 v47, 0x0fffffff, v41
    v_mov_b32 v27, v41
    buffer_load_dwordx2 v[22:23], v47, s[8:11], 0 offen
    buffer_load_dwordx3 v[24:26], v47, s[8:11], 0 offen offset:8
    s_waitcnt lgkmcnt(0)
    v_cmp_ne_u64 s[50:51], v[72:73], v[68:69]
    v_cmpx_ne_u64 s[54:55], v[74:75], v[70:71]
    s_and_b64 s[82:83], s[54:55], s[80:81]
    s_cbranch_scc1 L2_c23
L2_d23:
    v_mov_b64 v[84:85], v[70:71]
    v_mov_b32 v7, v93
    v_mov_b64 v[86:87], v[74:75]
    s_or_b64 s[80:81], s[80:81], s[54:55]
    s_mov_b64 exec, s[50:51]
    s_and_b64 s[82:83], s[50:51], s[80:81]
    s_cbranch_scc1 L2_c24
L2_d24:
    v_mov_b64 v[84:85], v[68:69]
    v_mov_b32 v7, v92
    v_mov_b64 v[86:87], v[72:73]
    s_mov_b64 exec, -1
    s_or_b64 s[80:81], s[80:81], s[50:51]
    ds_read_b64 v[70:71], v95 offset:65408
    ds_read_b64 v[68:69], v94 offset:65408
    s_waitcnt vmcnt(4)
    v_and_b32 v46, 0x20000000, v39
    v_lshrrev_b32 v47, 14, v35
    v_bitop3_b32 v47, v47, v5, v46 bitop3:0xea
    ds_read_b64 v[102:103], v47
    v_bitop3_b32 v93, v35, v5, v46 bitop3:0xea
    v_and_b32 v46, 0x10000000, v39
    v_lshrrev_b32 v47, 14, v34
    v_bitop3_b32 v47, v47, v5, v46 bitop3:0xea
    ds_read_b64 v[100:101], v47
    v_bitop3_b32 v92, v34, v5, v46 bitop3:0xea
    v_and_b32 v46, 0x80000000, v39
    v_lshrrev_b32 v47, 14, v37
    v_bitop3_b32 v47, v47, v5, v46 bitop3:0xea
    ds_read_b64 v[106:107], v47
    v_and_b32 v46, 0x40000000, v39
    v_lshrrev_b32 v47, 14, v36
    v_bitop3_b32 v47, v47, v5, v46 bitop3:0xea
    ds_read_b64 v[104:105], v47
    s_waitcnt lgkmcnt(4)
    v_mfma_f32_4x4x4_16b_bf16 v[80:83], v[10:11], v[70:71], v[80:83]
    v_mfma_f32_4x4x4_16b_bf16 v[76:79], v[10:11], v[68:69], v[76:79]
    v_perm_b32 v15, v35, v38, s45
    v_bitop3_b32 v46, v35, 0.5, -0.5 bitop3:0xa8
    v_perm_b32 v14, v34, v38, s44
    v_bitop3_b32 v47, v34, 0.5, -0.5 bitop3:0xa8
    v_cvt_pk_bf16_f32 v80, v80, v81
    v_cvt_pk_bf16_f32 v81, v82, v83
    ds_wrxchg_rtn_b64 v[74:75], v95, v[80:81] offset:65408
    v_cvt_pk_bf16_f32 v76, v76, v77
    v_cvt_pk_bf16_f32 v77, v78, v79
    ds_wrxchg_rtn_b64 v[72:73], v94, v[76:77] offset:65408
    s_waitcnt lgkmcnt(2)
    s_barrier
    s_setprio 3
    s_waitcnt vmcnt(6)
    v_subrev_u32 v88, s38, v3
    ds_write_b128 v88, v[116:119] offset:32768
    buffer_load_dwordx4 v[116:119], v3, s[16:19], s40 offen offset:2048
    s_waitcnt vmcnt(5)
    v_subrev_u32 v88, s38, v3
    ds_write_b128 v88, v[120:123] offset:33792
    buffer_load_dwordx4 v[120:123], v3, s[16:19], s40 offen offset:3072
    v_mfma_f32_4x4x4_16b_bf16 v[80:83], v[8:9], v[102:103], 0
    v_mfma_f32_4x4x4_16b_bf16 v[76:79], v[8:9], v[100:101], 0
    v_bitop3_b32 v15, v6, v15, v46 bitop3:0xca
    v_bitop3_b32 v14, v6, v14, v47 bitop3:0xca
    v_cmp_lt_u32 s[84:85], v5, v92
    s_nop 0
    v_pk_mul_f32 v[80:81], v[80:81], v[14:15] op_sel:[0,1] op_sel_hi:[1,1]
    v_pk_mul_f32 v[82:83], v[82:83], v[14:15] op_sel:[0,1] op_sel_hi:[1,1]
    v_pk_mul_f32 v[76:77], v[76:77], v[14:15] op_sel:[0,0] op_sel_hi:[1,0]
    v_pk_mul_f32 v[78:79], v[78:79], v[14:15] op_sel:[0,0] op_sel_hi:[1,0]
    v_and_b32 v47, 0x0fffffff, v42
    v_mov_b32 v33, v42
    buffer_load_dwordx2 v[28:29], v47, s[8:11], 0 offen
    buffer_load_dwordx3 v[30:32], v47, s[8:11], 0 offen offset:8
    v_mov_b32 v44, v43
    s_cmp_gt_u32 s37, 1024
    s_cbranch_scc1 L2_xs25
    s_cmp_lg_u32 s101, 0
    s_cbranch_scc1 L2_xa25
L2_xb25:
    v_lshlrev_b32 v89, 16, v96
    v_add_u32 v90, 60, v97
    v_bitop3_b32 v90, v89, v45, v90 bitop3:0x6a
    ds_write_b32 v98, v90 offset:12
    v_lshlrev_b32 v89, 20, v96
    v_add_u32 v90, 40, v97
    v_bitop3_b32 v90, v89, v45, v90 bitop3:0x6a
    ds_write_b32 v98, v90 offset:8
    v_lshlrev_b32 v89, 24, v96
    v_add_u32 v90, 20, v97
    v_bitop3_b32 v90, v89, v45, v90 bitop3:0x6a
    ds_write_b32 v98, v90 offset:4
    v_lshlrev_b32 v89, 28, v96
    v_bitop3_b32 v90, v89, v45, v97 bitop3:0x6a
    ds_write_b32 v98, v90 offset:0
    v_mov_b32_dpp v91, v64 quad_perm:[1,1,1,1] row_mask:0xf bank_mask:0xf
    v_and_b32 v89, 3, v91
    v_and_b32 v97, 0xfffc, v91
    v_sub_u16_dpp v88, v64, v91 quad_perm:[3,3,3,3] row_mask:0xf bank_mask:0xf
    v_mad_u32_u24 v97, v97, 5, v4
    v_add_u32 v99, v88, v89
    v_bfm_b32 v96, v88, v89
    v_cmp_lt_u32 s[58:59], 16, v99
    v_lshlrev_b32 v89, v1, v96
    v_and_b32 v89, v45, v89
    v_cmp_ne_u32 vcc, 0, v89
    v_xor_b32 v90, v97, v89
    s_add_u32 s3, s37, s38
    v_mbcnt_lo_u32_b32 v98, vcc_lo, 0
    v_mbcnt_hi_u32_b32 v98, vcc_hi, v98
    s_bcnt1_i32_b64 s41, vcc
    v_lshl_add_u32 v98, v98, 2, s3
    s_mov_b64 exec, vcc
    ds_write_b32 v98, v90
    s_mov_b64 exec, -1
    s_lshl2_add_u32 s37, s41, s37
    s_cmp_lg_u64 s[58:59], 0
    s_cbranch_scc1 L2_xe25
L2_xr25:
    v_add_u32 v98, s37, v0
    v_mov_b32 v90, -1
    ds_write_b32 v98, v90
    ds_read2st64_b32 v[40:41], v0 offset0:0 offset1:1
    ds_read2st64_b32 v[42:43], v0 offset0:2 offset1:3
    s_sub_u32 s3, s37, 768
    s_cmp_gt_u32 s3, 256
    s_cbranch_scc1 L2_xf25
L2_xg25:
    s_setprio 2
    s_waitcnt vmcnt(10)
    v_subrev_u32 v88, s38, v3
    ds_write_b128 v88, v[124:127] offset:34816
    s_add_u32 s3, s40, 4096
    buffer_load_dwordx4 v[124:127], v3, s[16:19], s3 offen
    s_waitcnt lgkmcnt(11)
    v_cmp_ne_u64 s[50:51], v[72:73], v[68:69]
    v_cmpx_ne_u64 s[54:55], v[74:75], v[70:71]
    s_and_b64 s[82:83], s[54:55], s[80:81]
    s_cbranch_scc1 L2_c26
L2_d26:
    v_mov_b64 v[84:85], v[70:71]
    v_mov_b32 v7, v95
    v_mov_b64 v[86:87], v[74:75]
    s_or_b64 s[80:81], s[80:81], s[54:55]
    s_mov_b64 exec, s[50:51]
    s_and_b64 s[82:83], s[50:51], s[80:81]
    s_cbranch_scc1 L2_c27
L2_d27:
    v_mov_b64 v[84:85], v[68:69]
    v_mov_b32 v7, v94
    v_mov_b64 v[86:87], v[72:73]
    s_mov_b64 exec, -1
    s_or_b64 s[80:81], s[80:81], s[50:51]
    ds_read_b64 v[70:71], v93 offset:65408
    s_and_b64 exec, s[84:85], s[80:81]
    v_mfma_f32_4x4x4_16b_bf16 v[76:79], v[12:13], v[84:85], 0
    v_mov_b32 v92, v7
    s_andn2_b64 s[80:81], s[80:81], s[84:85]
    v_mfma_f32_4x4x4_16b_bf16 v[76:79], v[10:11], v[86:87], v[76:79]
    s_mov_b64 exec, -1
    ds_read_b64 v[68:69], v92 offset:65408
    s_setprio 1
    s_waitcnt vmcnt(9)
    v_subrev_u32 v88, s100, v3
    ds_write_b128 v88, v[108:111] offset:0
    s_waitcnt lgkmcnt(1)
    v_mfma_f32_4x4x4_16b_bf16 v[80:83], v[10:11], v[70:71], v[80:83]
    v_mfma_f32_4x4x4_16b_bf16 v[76:79], v[10:11], v[68:69], v[76:79]
    v_and_b32 v46, 0x40000000, v39
    v_bitop3_b32 v94, v36, v5, v46 bitop3:0xea
    v_and_b32 v46, 0x80000000, v39
    v_bitop3_b32 v95, v37, v5, v46 bitop3:0xea
    v_perm_b32 v15, v37, v38, s47
    v_bitop3_b32 v46, v37, 0.5, -0.5 bitop3:0xa8
    v_perm_b32 v14, v36, v38, s46
    v_bitop3_b32 v47, v36, 0.5, -0.5 bitop3:0xa8
    v_cvt_pk_bf16_f32 v80, v80, v81
    v_cvt_pk_bf16_f32 v81, v82, v83
    ds_wrxchg_rtn_b64 v[74:75], v93, v[80:81] offset:65408
    v_cvt_pk_bf16_f32 v76, v76, v77
    v_cvt_pk_bf16_f32 v77, v78, v79
    ds_wrxchg_rtn_b64 v[72:73], v92, v[76:77] offset:65408
    s_setprio 0
    s_waitcnt vmcnt(9)
    v_subrev_u32 v88, s100, v3
    ds_write_b128 v88, v[112:115] offset:1024
    v_mfma_f32_4x4x4_16b_bf16 v[80:83], v[8:9], v[106:107], 0
    v_mfma_f32_4x4x4_16b_bf16 v[76:79], v[8:9], v[104:105], 0
    v_bitop3_b32 v15, v6, v15, v46 bitop3:0xca
    v_bitop3_b32 v14, v6, v14, v47 bitop3:0xca
    s_nop 1
    v_pk_mul_f32 v[80:81], v[80:81], v[14:15] op_sel:[0,1] op_sel_hi:[1,1]
    v_pk_mul_f32 v[82:83], v[82:83], v[14:15] op_sel:[0,1] op_sel_hi:[1,1]
    v_pk_mul_f32 v[76:77], v[76:77], v[14:15] op_sel:[0,0] op_sel_hi:[1,0]
    v_pk_mul_f32 v[78:79], v[78:79], v[14:15] op_sel:[0,0] op_sel_hi:[1,0]
    s_add_u32 s42, s42, 1
    s_waitcnt lgkmcnt(0)
    s_add_u32 s24, s30, 0xec45000
    s_addc_u32 s25, s31, 0
    s_mov_b32 s26, 0x100
    s_mov_b32 s27, 0x20000
    s_barrier
    s_bitcmp1_b32 s36, s42
    s_cbranch_scc1 L2_slow
L2_ret1:
    s_setprio 3
    v_and_b32 v47, 0x0fffffff, v44
    v_mov_b32 v39, v44
    buffer_load_dwordx2 v[34:35], v47, s[8:11], 0 offen
    buffer_load_dwordx3 v[36:38], v47, s[8:11], 0 offen offset:8
    buffer_load_dwordx4 v[108:111], v3, s[16:19], s40 offen offset:0
    v_cmp_ne_u64 s[50:51], v[72:73], v[68:69]
    v_cmpx_ne_u64 s[54:55], v[74:75], v[70:71]
    s_and_b64 s[82:83], s[54:55], s[80:81]
    s_cbranch_scc1 L2_c28
L2_d28:
    v_mov_b64 v[84:85], v[70:71]
    v_mov_b32 v7, v93
    v_mov_b64 v[86:87], v[74:75]
    s_or_b64 s[80:81], s[80:81], s[54:55]
    s_mov_b64 exec, s[50:51]
    s_and_b64 s[82:83], s[50:51], s[80:81]
    s_cbranch_scc1 L2_c29
L2_d29:
    v_mov_b64 v[84:85], v[68:69]
    v_mov_b32 v7, v92
    v_mov_b64 v[86:87], v[72:73]
    s_mov_b64 exec, -1
    s_or_b64 s[80:81], s[80:81], s[50:51]
    ds_read_b64 v[70:71], v95 offset:65408
    ds_read_b64 v[68:69], v94 offset:65408
    s_waitcnt vmcnt(10)
    v_and_b32 v46, 0x20000000, v21
    v_lshrrev_b32 v47, 14, v17
    v_bitop3_b32 v47, v47, v5, v46 bitop3:0xea
    ds_read_b64 v[102:103], v47
    v_bitop3_b32 v93, v17, v5, v46 bitop3:0xea
    v_and_b32 v46, 0x10000000, v21
    v_lshrrev_b32 v47, 14, v16
    v_bitop3_b32 v47, v47, v5, v46 bitop3:0xea
    ds_read_b64 v[100:101], v47
    v_bitop3_b32 v92, v16, v5, v46 bitop3:0xea
    s_waitcnt lgkmcnt(2)
    v_mfma_f32_4x4x4_16b_bf16 v[80:83], v[10:11], v[70:71], v[80:83]
    v_mfma_f32_4x4x4_16b_bf16 v[76:79], v[10:11], v[68:69], v[76:79]
    v_perm_b32 v15, v17, v20, s45
    v_bitop3_b32 v46, v17, 0.5, -0.5 bitop3:0xa8
    v_perm_b32 v14, v16, v20, s44
    v_bitop3_b32 v47, v16, 0.5, -0.5 bitop3:0xa8
    v_cvt_pk_bf16_f32 v80, v80, v81
    v_cvt_pk_bf16_f32 v81, v82, v83
    ds_wrxchg_rtn_b64 v[74:75], v95, v[80:81] offset:65408
    v_cvt_pk_bf16_f32 v76, v76, v77
    v_cvt_pk_bf16_f32 v77, v78, v79
    ds_wrxchg_rtn_b64 v[72:73], v94, v[76:77] offset:65408
    s_waitcnt lgkmcnt(2)
    v_mfma_f32_4x4x4_16b_bf16 v[80:83], v[8:9], v[102:103], 0
    v_mfma_f32_4x4x4_16b_bf16 v[76:79], v[8:9], v[100:101], 0
    v_bitop3_b32 v15, v6, v15, v46 bitop3:0xca
    v_bitop3_b32 v14, v6, v14, v47 bitop3:0xca
    v_cmp_lt_u32 s[84:85], v5, v92
    s_nop 0
    v_pk_mul_f32 v[80:81], v[80:81], v[14:15] op_sel:[0,1] op_sel_hi:[1,1]
    v_pk_mul_f32 v[82:83], v[82:83], v[14:15] op_sel:[0,1] op_sel_hi:[1,1]
    v_pk_mul_f32 v[76:77], v[76:77], v[14:15] op_sel:[0,0] op_sel_hi:[1,0]
    v_pk_mul_f32 v[78:79], v[78:79], v[14:15] op_sel:[0,0] op_sel_hi:[1,0]
    buffer_load_dwordx4 v[112:115], v3, s[16:19], s40 offen offset:1024
    s_waitcnt lgkmcnt(0)
    v_cmp_ne_u64 s[50:51], v[72:73], v[68:69]
    v_cmpx_ne_u64 s[54:55], v[74:75], v[70:71]
    s_and_b64 s[82:83], s[54:55], s[80:81]
    s_cbranch_scc1 L2_c30
L2_d30:
    v_mov_b64 v[84:85], v[70:71]
    v_mov_b32 v7, v95
    v_mov_b64 v[86:87], v[74:75]
    s_or_b64 s[80:81], s[80:81], s[54:55]
    s_mov_b64 exec, s[50:51]
    s_and_b64 s[82:83], s[50:51], s[80:81]
    s_cbranch_scc1 L2_c31
L2_d31:
    v_mov_b64 v[84:85], v[68:69]
    v_mov_b32 v7, v94
    v_mov_b64 v[86:87], v[72:73]
    s_mov_b64 exec, -1
    s_or_b64 s[80:81], s[80:81], s[50:51]
    ds_read_b64 v[70:71], v93 offset:65408
    s_and_b64 exec, s[84:85], s[80:81]
    v_mfma_f32_4x4x4_16b_bf16 v[76:79], v[12:13], v[84:85], 0
    v_mov_b32 v92, v7
    s_andn2_b64 s[80:81], s[80:81], s[84:85]
    v_mfma_f32_4x4x4_16b_bf16 v[76:79], v[10:11], v[86:87], v[76:79]
    s_mov_b64 exec, -1
    ds_read_b64 v[68:69], v92 offset:65408
    v_and_b32 v46, 0x80000000, v21
    v_lshrrev_b32 v47, 14, v19
    v_bitop3_b32 v47, v47, v5, v46 bitop3:0xea
    ds_read_b64 v[106:107], v47
    v_bitop3_b32 v95, v19, v5, v46 bitop3:0xea
    v_and_b32 v46, 0x40000000, v21
    v_lshrrev_b32 v47, 14, v18
    v_bitop3_b32 v47, v47, v5, v46 bitop3:0xea
    ds_read_b64 v[104:105], v47
    v_bitop3_b32 v94, v18, v5, v46 bitop3:0xea
    s_waitcnt lgkmcnt(2)
    v_mfma_f32_4x4x4_16b_bf16 v[80:83], v[10:11], v[70:71], v[80:83]
    v_mfma_f32_4x4x4_16b_bf16 v[76:79], v[10:11], v[68:69], v[76:79]
    v_perm_b32 v15, v19, v20, s47
    v_bitop3_b32 v46, v19, 0.5, -0.5 bitop3:0xa8
    v_perm_b32 v14, v18, v20, s46
    v_bitop3_b32 v47, v18, 0.5, -0.5 bitop3:0xa8
    v_cvt_pk_bf16_f32 v80, v80, v81
    v_cvt_pk_bf16_f32 v81, v82, v83
    ds_wrxchg_rtn_b64 v[74:75], v93, v[80:81] offset:65408
    v_cvt_pk_bf16_f32 v76, v76, v77
    v_cvt_pk_bf16_f32 v77, v78, v79
    ds_wrxchg_rtn_b64 v[72:73], v92, v[76:77] offset:65408
    s_setprio 2
    s_waitcnt lgkmcnt(2)
    v_mfma_f32_4x4x4_16b_bf16 v[80:83], v[8:9], v[106:107], 0
    v_mfma_f32_4x4x4_16b_bf16 v[76:79], v[8:9], v[104:105], 0
    v_bitop3_b32 v15, v6, v15, v46 bitop3:0xca
    v_bitop3_b32 v14, v6, v14, v47 bitop3:0xca
    s_nop 1
    v_pk_mul_f32 v[80:81], v[80:81], v[14:15] op_sel:[0,1] op_sel_hi:[1,1]
    v_pk_mul_f32 v[82:83], v[82:83], v[14:15] op_sel:[0,1] op_sel_hi:[1,1]
    v_pk_mul_f32 v[76:77], v[76:77], v[14:15] op_sel:[0,0] op_sel_hi:[1,0]
    v_pk_mul_f32 v[78:79], v[78:79], v[14:15] op_sel:[0,0] op_sel_hi:[1,0]
    v_sub_u16 v88, v62, v54
    v_and_b32 v89, 3, v54
    v_add3_u32 v99, v88, v89, 3
    v_and_b32 v99, -4, v99
    v_max_u32 v99, 4, v99
    v_and_b32 v97, 0xfffc, v54
    v_bfm_b32 v96, v88, v89
    v_add_u32_dpp v91, v99, v99 row_shr:1 row_mask:0xf bank_mask:0xf bound_ctrl:1
    v_mad_u32_u24 v97, v97, 5, v2
    v_cmp_lt_u32 vcc, 16, v99
    v_add_u32_dpp v91, v91, v91 row_shr:2 row_mask:0xf bank_mask:0xf bound_ctrl:1
    v_sub_u32 v98, s38, v99
    v_lshrrev_b64 v[54:55], 16, v[54:55]
    v_add_u32_dpp v91, v91, v91 row_shr:4 row_mask:0xf bank_mask:0xf bound_ctrl:1
    v_lshrrev_b64 v[62:63], 16, v[62:63]
    s_mov_b32 s101, 0
    v_add_u32_dpp v91, v91, v91 row_shr:8 row_mask:0xf bank_mask:0xf bound_ctrl:1
    s_nop 1
    v_add_u32_dpp v91, v91, v91 row_bcast:15 row_mask:0xa bank_mask:0xf
    s_nop 1
    v_add_u32_dpp v91, v91, v91 row_bcast:31 row_mask:0xc bank_mask:0xf
    v_add_u32 v98, v98, v91
    v_readlane_b32 s37, v91, 63
    s_cbranch_vccnz L2_xo32
L2_xp32:
    v_and_b32 v47, 0x0fffffff, v40
    v_mov_b32 v21, v40
    buffer_load_dwordx2 v[16:17], v47, s[8:11], 0 offen
    buffer_load_dwordx3 v[18:20], v47, s[8:11], 0 offen offset:8
    s_waitcnt lgkmcnt(0)
    v_cmp_ne_u64 s[50:51], v[72:73], v[68:69]
    v_cmpx_ne_u64 s[54:55], v[74:75], v[70:71]
    s_and_b64 s[82:83], s[54:55], s[80:81]
    s_cbranch_scc1 L2_c33
L2_d33:
    v_mov_b64 v[84:85], v[70:71]
    v_mov_b32 v7, v93
    v_mov_b64 v[86:87], v[74:75]
    s_or_b64 s[80:81], s[80:81], s[54:55]
    s_mov_b64 exec, s[50:51]
    s_and_b64 s[82:83], s[50:51], s[80:81]
    s_cbranch_scc1 L2_c34
L2_d34:
    v_mov_b64 v[84:85], v[68:69]
    v_mov_b32 v7, v92
    v_mov_b64 v[86:87], v[72:73]
    s_mov_b64 exec, -1
    s_or_b64 s[80:81], s[80:81], s[50:51]
    ds_read_b64 v[70:71], v95 offset:65408
    ds_read_b64 v[68:69], v94 offset:65408
    s_waitcnt vmcnt(11)
    v_and_b32 v46, 0x20000000, v27
    v_lshrrev_b32 v47, 14, v23
    v_bitop3_b32 v47, v47, v5, v46 bitop3:0xea
    ds_read_b64 v[102:103], v47
    v_bitop3_b32 v93, v23, v5, v46 bitop3:0xea
    v_and_b32 v46, 0x10000000, v27
    v_lshrrev_b32 v47, 14, v22
    v_bitop3_b32 v47, v47, v5, v46 bitop3:0xea
    ds_read_b64 v[100:101], v47
    v_bitop3_b32 v92, v22, v5, v46 bitop3:0xea
    s_waitcnt lgkmcnt(2)
    v_mfma_f32_4x4x4_16b_bf16 v[80:83], v[10:11], v[70:71], v[80:83]
    v_mfma_f32_4x4x4_16b_bf16 v[76:79], v[10:11], v[68:69], v[76:79]
    v_perm_b32 v15, v23, v26, s45
    v_bitop3_b32 v46, v23, 0.5, -0.5 bitop3:0xa8
    v_perm_b32 v14, v22, v26, s44
    v_bitop3_b32 v47, v22, 0.5, -0.5 bitop3:0xa8
    v_cvt_pk_bf16_f32 v80, v80, v81
    v_cvt_pk_bf16_f32 v81, v82, v83
    ds_wrxchg_rtn_b64 v[74:75], v95, v[80:81] offset:65408
    v_cvt_pk_bf16_f32 v76, v76, v77
    v_cvt_pk_bf16_f32 v77, v78, v79
    ds_wrxchg_rtn_b64 v[72:73], v94, v[76:77] offset:65408
    s_waitcnt lgkmcnt(2)
    v_mfma_f32_4x4x4_16b_bf16 v[80:83], v[8:9], v[102:103], 0
    v_mfma_f32_4x4x4_16b_bf16 v[76:79], v[8:9], v[100:101], 0
    v_bitop3_b32 v15, v6, v15, v46 bitop3:0xca
    v_bitop3_b32 v14, v6, v14, v47 bitop3:0xca
    v_cmp_lt_u32 s[84:85], v5, v92
    s_nop 0
    v_pk_mul_f32 v[80:81], v[80:81], v[14:15] op_sel:[0,1] op_sel_hi:[1,1]
    v_pk_mul_f32 v[82:83], v[82:83], v[14:15] op_sel:[0,1] op_sel_hi:[1,1]
    v_pk_mul_f32 v[76:77], v[76:77], v[14:15] op_sel:[0,0] op_sel_hi:[1,0]
    v_pk_mul_f32 v[78:79], v[78:79], v[14:15] op_sel:[0,0] op_sel_hi:[1,0]
    s_waitcnt lgkmcnt(0)
    v_cmp_ne_u64 s[50:51], v[72:73], v[68:69]
    v_cmpx_ne_u64 s[54:55], v[74:75], v[70:71]
    s_and_b64 s[82:83], s[54:55], s[80:81]
    s_cbranch_scc1 L2_c35
L2_d35:
    v_mov_b64 v[84:85], v[70:71]
    v_mov_b32 v7, v95
    v_mov_b64 v[86:87], v[74:75]
    s_or_b64 s[80:81], s[80:81], s[54:55]
    s_mov_b64 exec, s[50:51]
    s_and_b64 s[82:83], s[50:51], s[80:81]
    s_cbranch_scc1 L2_c36
L2_d36:
    v_mov_b64 v[84:85], v[68:69]
    v_mov_b32 v7, v94
    v_mov_b64 v[86:87], v[72:73]
    s_mov_b64 exec, -1
    s_or_b64 s[80:81], s[80:81], s[50:51]
    ds_read_b64 v[70:71], v93 offset:65408
    s_and_b64 exec, s[84:85], s[80:81]
    v_mfma_f32_4x4x4_16b_bf16 v[76:79], v[12:13], v[84:85], 0
    v_mov_b32 v92, v7
    s_andn2_b64 s[80:81], s[80:81], s[84:85]
    v_mfma_f32_4x4x4_16b_bf16 v[76:79], v[10:11], v[86:87], v[76:79]
    s_mov_b64 exec, -1
    ds_read_b64 v[68:69], v92 offset:65408
    v_and_b32 v46, 0x80000000, v27
    v_lshrrev_b32 v47, 14, v25
    v_bitop3_b32 v47, v47, v5, v46 bitop3:0xea
    ds_read_b64 v[106:107], v47
    v_bitop3_b32 v95, v25, v5, v46 bitop3:0xea
    v_and_b32 v46, 0x40000000, v27
    v_lshrrev_b32 v47, 14, v24
    v_bitop3_b32 v47, v47, v5, v46 bitop3:0xea
    ds_read_b64 v[104:105], v47
    v_bitop3_b32 v94, v24, v5, v46 bitop3:0xea
    s_waitcnt lgkmcnt(2)
    v_mfma_f32_4x4x4_16b_bf16 v[80:83], v[10:11], v[70:71], v[80:83]
    v_mfma_f32_4x4x4_16b_bf16 v[76:79], v[10:11], v[68:69], v[76:79]
    v_perm_b32 v15, v25, v26, s47
    v_bitop3_b32 v46, v25, 0.5, -0.5 bitop3:0xa8
    v_perm_b32 v14, v24, v26, s46
    v_bitop3_b32 v47, v24, 0.5, -0.5 bitop3:0xa8
    v_cvt_pk_bf16_f32 v80, v80, v81
    v_cvt_pk_bf16_f32 v81, v82, v83
    ds_wrxchg_rtn_b64 v[74:75], v93, v[80:81] offset:65408
    v_cvt_pk_bf16_f32 v76, v76, v77
    v_cvt_pk_bf16_f32 v77, v78, v79
    ds_wrxchg_rtn_b64 v[72:73], v92, v[76:77] offset:65408
    s_setprio 1
    s_waitcnt lgkmcnt(2)
    v_mfma_f32_4x4x4_16b_bf16 v[80:83], v[8:9], v[106:107], 0
    v_mfma_f32_4x4x4_16b_bf16 v[76:79], v[8:9], v[104:105], 0
    v_bitop3_b32 v15, v6, v15, v46 bitop3:0xca
    v_bitop3_b32 v14, v6, v14, v47 bitop3:0xca
    s_nop 1
    v_pk_mul_f32 v[80:81], v[80:81], v[14:15] op_sel:[0,1] op_sel_hi:[1,1]
    v_pk_mul_f32 v[82:83], v[82:83], v[14:15] op_sel:[0,1] op_sel_hi:[1,1]
    v_pk_mul_f32 v[76:77], v[76:77], v[14:15] op_sel:[0,0] op_sel_hi:[1,0]
    v_pk_mul_f32 v[78:79], v[78:79], v[14:15] op_sel:[0,0] op_sel_hi:[1,0]
    v_and_b32 v47, 0x0fffffff, v41
    v_mov_b32 v27, v41
    buffer_load_dwordx2 v[22:23], v47, s[8:11], 0 offen
    buffer_load_dwordx3 v[24:26], v47, s[8:11], 0 offen offset:8
    s_waitcnt lgkmcnt(0)
    v_cmp_ne_u64 s[50:51], v[72:73], v[68:69]
    v_cmpx_ne_u64 s[54:55], v[74:75], v[70:71]
    s_and_b64 s[82:83], s[54:55], s[80:81]
    s_cbranch_scc1 L2_c37
L2_d37:
    v_mov_b64 v[84:85], v[70:71]
    v_mov_b32 v7, v93
    v_mov_b64 v[86:87], v[74:75]
    s_or_b64 s[80:81], s[80:81], s[54:55]
    s_mov_b64 exec, s[50:51]
    s_and_b64 s[82:83], s[50:51], s[80:81]
    s_cbranch_scc1 L2_c38
L2_d38:
    v_mov_b64 v[84:85], v[68:69]
    v_mov_b32 v7, v92
    v_mov_b64 v[86:87], v[72:73]
    s_mov_b64 exec, -1
    s_or_b64 s[80:81], s[80:81], s[50:51]
    ds_read_b64 v[70:71], v95 offset:65408
    ds_read_b64 v[68:69], v94 offset:65408
    s_waitcnt vmcnt(9)
    v_and_b32 v46, 0x20000000, v33
    v_lshrrev_b32 v47, 14, v29
    v_bitop3_b32 v47, v47, v5, v46 bitop3:0xea
    ds_read_b64 v[102:103], v47
    v_bitop3_b32 v93, v29, v5, v46 bitop3:0xea
    v_and_b32 v46, 0x10000000, v33
    v_lshrrev_b32 v47, 14, v28
    v_bitop3_b32 v47, v47, v5, v46 bitop3:0xea
    ds_read_b64 v[100:101], v47
    v_bitop3_b32 v92, v28, v5, v46 bitop3:0xea
    s_waitcnt lgkmcnt(2)
    v_mfma_f32_4x4x4_16b_bf16 v[80:83], v[10:11], v[70:71], v[80:83]
    v_mfma_f32_4x4x4_16b_bf16 v[76:79], v[10:11], v[68:69], v[76:79]
    v_perm_b32 v15, v29, v32, s45
    v_bitop3_b32 v46, v29, 0.5, -0.5 bitop3:0xa8
    v_perm_b32 v14, v28, v32, s44
    v_bitop3_b32 v47, v28, 0.5, -0.5 bitop3:0xa8
    v_cvt_pk_bf16_f32 v80, v80, v81
    v_cvt_pk_bf16_f32 v81, v82, v83
    ds_wrxchg_rtn_b64 v[74:75], v95, v[80:81] offset:65408
    v_cvt_pk_bf16_f32 v76, v76, v77
    v_cvt_pk_bf16_f32 v77, v78, v79
    ds_wrxchg_rtn_b64 v[72:73], v94, v[76:77] offset:65408
    s_waitcnt lgkmcnt(2)
    v_mfma_f32_4x4x4_16b_bf16 v[80:83], v[8:9], v[102:103], 0
    v_mfma_f32_4x4x4_16b_bf16 v[76:79], v[8:9], v[100:101], 0
    v_bitop3_b32 v15, v6, v15, v46 bitop3:0xca
    v_bitop3_b32 v14, v6, v14, v47 bitop3:0xca
    v_cmp_lt_u32 s[84:85], v5, v92
    s_nop 0
    v_pk_mul_f32 v[80:81], v[80:81], v[14:15] op_sel:[0,1] op_sel_hi:[1,1]
    v_pk_mul_f32 v[82:83], v[82:83], v[14:15] op_sel:[0,1] op_sel_hi:[1,1]
    v_pk_mul_f32 v[76:77], v[76:77], v[14:15] op_sel:[0,0] op_sel_hi:[1,0]
    v_pk_mul_f32 v[78:79], v[78:79], v[14:15] op_sel:[0,0] op_sel_hi:[1,0]
    s_waitcnt lgkmcnt(0)
    v_cmp_ne_u64 s[50:51], v[72:73], v[68:69]
    v_cmpx_ne_u64 s[54:55], v[74:75], v[70:71]
    s_and_b64 s[82:83], s[54:55], s[80:81]
    s_cbranch_scc1 L2_c39
L2_d39:
    v_mov_b64 v[84:85], v[70:71]
    v_mov_b32 v7, v95
    v_mov_b64 v[86:87], v[74:75]
    s_or_b64 s[80:81], s[80:81], s[54:55]
    s_mov_b64 exec, s[50:51]
    s_and_b64 s[82:83], s[50:51], s[80:81]
    s_cbranch_scc1 L2_c40
L2_d40:
    v_mov_b64 v[84:85], v[68:69]
    v_mov_b32 v7, v94
    v_mov_b64 v[86:87], v[72:73]
    s_mov_b64 exec, -1
    s_or_b64 s[80:81], s[80:81], s[50:51]
    ds_read_b64 v[70:71], v93 offset:65408
    s_and_b64 exec, s[84:85], s[80:81]
    v_mfma_f32_4x4x4_16b_bf16 v[76:79], v[12:13], v[84:85], 0
    v_mov_b32 v92, v7
    s_andn2_b64 s[80:81], s[80:81], s[84:85]
    v_mfma_f32_4x4x4_16b_bf16 v[76:79], v[10:11], v[86:87], v[76:79]
    s_mov_b64 exec, -1
    ds_read_b64 v[68:69], v92 offset:65408
    v_and_b32 v46, 0x80000000, v33
    v_lshrrev_b32 v47, 14, v31
    v_bitop3_b32 v47, v47, v5, v46 bitop3:0xea
    ds_read_b64 v[106:107], v47
    v_bitop3_b32 v95, v31, v5, v46 bitop3:0xea
    v_and_b32 v46, 0x40000000, v33
    v_lshrrev_b32 v47, 14, v30
    v_bitop3_b32 v47, v47, v5, v46 bitop3:0xea
    ds_read_b64 v[104:105], v47
    v_bitop3_b32 v94, v30, v5, v46 bitop3:0xea
    s_waitcnt lgkmcnt(2)
    v_mfma_f32_4x4x4_16b_bf16 v[80:83], v[10:11], v[70:71], v[80:83]
    v_mfma_f32_4x4x4_16b_bf16 v[76:79], v[10:11], v[68:69], v[76:79]
    v_perm_b32 v15, v31, v32, s47
    v_bitop3_b32 v46, v31, 0.5, -0.5 bitop3:0xa8
    v_perm_b32 v14, v30, v32, s46
    v_bitop3_b32 v47, v30, 0.5, -0.5 bitop3:0xa8
    v_cvt_pk_bf16_f32 v80, v80, v81
    v_cvt_pk_bf16_f32 v81, v82, v83
    ds_wrxchg_rtn_b64 v[74:75], v93, v[80:81] offset:65408
    v_cvt_pk_bf16_f32 v76, v76, v77
    v_cvt_pk_bf16_f32 v77, v78, v79
    ds_wrxchg_rtn_b64 v[72:73], v92, v[76:77] offset:65408
    s_setprio 0
    s_waitcnt lgkmcnt(2)
    v_mfma_f32_4x4x4_16b_bf16 v[80:83], v[8:9], v[106:107], 0
    v_mfma_f32_4x4x4_16b_bf16 v[76:79], v[8:9], v[104:105], 0
    v_bitop3_b32 v15, v6, v15, v46 bitop3:0xca
    v_bitop3_b32 v14, v6, v14, v47 bitop3:0xca
    s_nop 1
    v_pk_mul_f32 v[80:81], v[80:81], v[14:15] op_sel:[0,1] op_sel_hi:[1,1]
    v_pk_mul_f32 v[82:83], v[82:83], v[14:15] op_sel:[0,1] op_sel_hi:[1,1]
    v_pk_mul_f32 v[76:77], v[76:77], v[14:15] op_sel:[0,0] op_sel_hi:[1,0]
    v_pk_mul_f32 v[78:79], v[78:79], v[14:15] op_sel:[0,0] op_sel_hi:[1,0]
    s_add_u32 s40, s40, 0x50000
    v_and_b32 v47, 0x0fffffff, v42
    v_mov_b32 v33, v42
    buffer_load_dwordx2 v[28:29], v47, s[8:11], 0 offen
    buffer_load_dwordx3 v[30:32], v47, s[8:11], 0 offen offset:8
    s_waitcnt lgkmcnt(0)
    v_cmp_ne_u64 s[50:51], v[72:73], v[68:69]
    v_cmpx_ne_u64 s[54:55], v[74:75], v[70:71]
    s_and_b64 s[82:83], s[54:55], s[80:81]
    s_cbranch_scc1 L2_c41
L2_d41:
    v_mov_b64 v[84:85], v[70:71]
    v_mov_b32 v7, v93
    v_mov_b64 v[86:87], v[74:75]
    s_or_b64 s[80:81], s[80:81], s[54:55]
    s_mov_b64 exec, s[50:51]
    s_and_b64 s[82:83], s[50:51], s[80:81]
    s_cbranch_scc1 L2_c42
L2_d42:
    v_mov_b64 v[84:85], v[68:69]
    v_mov_b32 v7, v92
    v_mov_b64 v[86:87], v[72:73]
    s_mov_b64 exec, -1
    s_or_b64 s[80:81], s[80:81], s[50:51]
    ds_read_b64 v[70:71], v95 offset:65408
    ds_read_b64 v[68:69], v94 offset:65408
    s_waitcnt vmcnt(8)
    v_and_b32 v46, 0x20000000, v39
    v_lshrrev_b32 v47, 14, v35
    v_bitop3_b32 v47, v47, v5, v46 bitop3:0xea
    ds_read_b64 v[102:103], v47
    v_bitop3_b32 v93, v35, v5, v46 bitop3:0xea
    v_and_b32 v46, 0x10000000, v39
    v_lshrrev_b32 v47, 14, v34
    v_bitop3_b32 v47, v47, v5, v46 bitop3:0xea
    ds_read_b64 v[100:101], v47
    v_bitop3_b32 v92, v34, v5, v46 bitop3:0xea
    v_and_b32 v46, 0x80000000, v39
    v_lshrrev_b32 v47, 14, v37
    v_bitop3_b32 v47, v47, v5, v46 bitop3:0xea
    ds_read_b64 v[106:107], v47
    v_and_b32 v46, 0x40000000, v39
    v_lshrrev_b32 v47, 14, v36
    v_bitop3_b32 v47, v47, v5, v46 bitop3:0xea
    ds_read_b64 v[104:105], v47
    s_waitcnt lgkmcnt(4)
    v_mfma_f32_4x4x4_16b_bf16 v[80:83], v[10:11], v[70:71], v[80:83]
    v_mfma_f32_4x4x4_16b_bf16 v[76:79], v[10:11], v[68:69], v[76:79]
    v_perm_b32 v15, v35, v38, s45
    v_bitop3_b32 v46, v35, 0.5, -0.5 bitop3:0xa8
    v_perm_b32 v14, v34, v38, s44
    v_bitop3_b32 v47, v34, 0.5, -0.5 bitop3:0xa8
    v_cvt_pk_bf16_f32 v80, v80, v81
    v_cvt_pk_bf16_f32 v81, v82, v83
    ds_wrxchg_rtn_b64 v[74:75], v95, v[80:81] offset:65408
    v_cvt_pk_bf16_f32 v76, v76, v77
    v_cvt_pk_bf16_f32 v77, v78, v79
    ds_wrxchg_rtn_b64 v[72:73], v94, v[76:77] offset:65408
    s_waitcnt lgkmcnt(2)
    s_barrier
    s_setprio 3
    s_mov_b32 m0, s100
    s_nop 0
    ds_write_addtid_b32 v116 offset:32768
    ds_write_addtid_b32 v117 offset:33024
    ds_write_addtid_b32 v118 offset:33280
    ds_write_addtid_b32 v119 offset:33536
    buffer_load_dwordx4 v[116:119], v3, s[16:19], s40 offen offset:2048
    ds_write_addtid_b32 v120 offset:33792
    ds_write_addtid_b32 v121 offset:34048
    ds_write_addtid_b32 v122 offset:34304
    ds_write_addtid_b32 v123 offset:34560
    buffer_load_dwordx4 v[120:123], v3, s[16:19], s40 offen offset:3072
    v_mfma_f32_4x4x4_16b_bf16 v[80:83], v[8:9], v[102:103], 0
    v_mfma_f32_4x4x4_16b_bf16 v[76:79], v[8:9], v[100:101], 0
    v_bitop3_b32 v15, v6, v15, v46 bitop3:0xca
    v_bitop3_b32 v14, v6, v14, v47 bitop3:0xca
    v_cmp_lt_u32 s[84:85], v5, v92
    s_nop 0
    v_pk_mul_f32 v[80:81], v[80:81], v[14:15] op_sel:[0,1] op_sel_hi:[1,1]
    v_pk_mul_f32 v[82:83], v[82:83], v[14:15] op_sel:[0,1] op_sel_hi:[1,1]
    v_pk_mul_f32 v[76:77], v[76:77], v[14:15] op_sel:[0,0] op_sel_hi:[1,0]
    v_pk_mul_f32 v[78:79], v[78:79], v[14:15] op_sel:[0,0] op_sel_hi:[1,0]
    v_mov_b32 v44, v43
    s_cmp_gt_u32 s37, 1024
    s_cbranch_scc1 L2_xs43
    s_cmp_lg_u32 s101, 0
    s_cbranch_scc1 L2_xa43
L2_xb43:
    v_lshlrev_b32 v89, 16, v96
    v_add_u32 v90, 60, v97
    v_bitop3_b32 v90, v89, v45, v90 bitop3:0x6a
    ds_write_b32 v98, v90 offset:12
    v_lshlrev_b32 v89, 20, v96
    v_add_u32 v90, 40, v97
    v_bitop3_b32 v90, v89, v45, v90 bitop3:0x6a
    ds_write_b32 v98, v90 offset:8
    v_lshlrev_b32 v89, 24, v96
    v_add_u32 v90, 20, v97
    v_bitop3_b32 v90, v89, v45, v90 bitop3:0x6a
    ds_write_b32 v98, v90 offset:4
    v_lshlrev_b32 v89, 28, v96
    v_bitop3_b32 v90, v89, v45, v97 bitop3:0x6a
    ds_write_b32 v98, v90 offset:0
    v_mov_b32_dpp v91, v66 quad_perm:[1,1,1,1] row_mask:0xf bank_mask:0xf
    v_and_b32 v89, 3, v91
    v_and_b32 v97, 0xfffc, v91
    v_sub_u16_dpp v88, v66, v91 quad_perm:[3,3,3,3] row_mask:0xf bank_mask:0xf
    v_mad_u32_u24 v97, v97, 5, v4
    v_add_u32 v99, v88, v89
    v_bfm_b32 v96, v88, v89
    v_cmp_lt_u32 s[58:59], 16, v99
    v_lshlrev_b32 v89, v1, v96
    v_and_b32 v89, v45, v89
    v_cmp_ne_u32 vcc, 0, v89
    v_xor_b32 v90, v97, v89
    s_add_u32 s3, s37, s38
    v_mbcnt_lo_u32_b32 v98, vcc_lo, 0
    v_mbcnt_hi_u32_b32 v98, vcc_hi, v98
    s_bcnt1_i32_b64 s41, vcc
    v_lshl_add_u32 v98, v98, 2, s3
    s_mov_b64 exec, vcc
    ds_write_b32 v98, v90
    s_mov_b64 exec, -1
    s_lshl2_add_u32 s37, s41, s37
    s_cmp_lg_u64 s[58:59], 0
    s_cbranch_scc1 L2_xe43
L2_xr43:
    v_add_u32 v98, s37, v0
    v_mov_b32 v90, -1
    ds_write_b32 v98, v90
    ds_read2st64_b32 v[40:41], v0 offset0:0 offset1:1
    ds_read2st64_b32 v[42:43], v0 offset0:2 offset1:3
    s_sub_u32 s3, s37, 768
    s_cmp_gt_u32 s3, 256
    s_cbranch_scc1 L2_xf43
L2_xg43:
    v_lshrrev_b64 v[64:65], 16, v[64:65]
    v_lshrrev_b64 v[66:67], 16, v[66:67]
    s_setprio 2
    ds_write_addtid_b32 v124 offset:34816
    ds_write_addtid_b32 v125 offset:35072
    ds_write_addtid_b32 v126 offset:35328
    ds_write_addtid_b32 v127 offset:35584
    s_add_u32 s3, s40, 4096
    buffer_load_dwordx4 v[124:127], v3, s[16:19], s3 offen
    s_waitcnt lgkmcnt(14)
    v_cmp_ne_u64 s[50:51], v[72:73], v[68:69]
    v_cmpx_ne_u64 s[54:55], v[74:75], v[70:71]
    s_and_b64 s[82:83], s[54:55], s[80:81]
    s_cbranch_scc1 L2_c44
L2_d44:
    v_mov_b64 v[84:85], v[70:71]
    v_mov_b32 v7, v95
    v_mov_b64 v[86:87], v[74:75]
    s_or_b64 s[80:81], s[80:81], s[54:55]
    s_mov_b64 exec, s[50:51]
    s_and_b64 s[82:83], s[50:51], s[80:81]
    s_cbranch_scc1 L2_c45
L2_d45:
    v_mov_b64 v[84:85], v[68:69]
    v_mov_b32 v7, v94
    v_mov_b64 v[86:87], v[72:73]
    s_mov_b64 exec, -1
    s_or_b64 s[80:81], s[80:81], s[50:51]
    ds_read_b64 v[70:71], v93 offset:65408
    s_and_b64 exec, s[84:85], s[80:81]
    v_mfma_f32_4x4x4_16b_bf16 v[76:79], v[12:13], v[84:85], 0
    v_mov_b32 v92, v7
    s_andn2_b64 s[80:81], s[80:81], s[84:85]
    v_mfma_f32_4x4x4_16b_bf16 v[76:79], v[10:11], v[86:87], v[76:79]
    s_mov_b64 exec, -1
    ds_read_b64 v[68:69], v92 offset:65408
    s_setprio 1
    s_waitcnt vmcnt(10)
    s_mov_b32 m0, s38
    s_nop 0
    ds_write_addtid_b32 v108 offset:0
    ds_write_addtid_b32 v109 offset:256
    ds_write_addtid_b32 v110 offset:512
    ds_write_addtid_b32 v111 offset:768
    s_waitcnt lgkmcnt(4)
    v_mfma_f32_4x4x4_16b_bf16 v[80:83], v[10:11], v[70:71], v[80:83]
    v_mfma_f32_4x4x4_16b_bf16 v[76:79], v[10:11], v[68:69], v[76:79]
    v_and_b32 v46, 0x40000000, v39
    v_bitop3_b32 v94, v36, v5, v46 bitop3:0xea
    v_and_b32 v46, 0x80000000, v39
    v_bitop3_b32 v95, v37, v5, v46 bitop3:0xea
    v_perm_b32 v15, v37, v38, s47
    v_bitop3_b32 v46, v37, 0.5, -0.5 bitop3:0xa8
    v_perm_b32 v14, v36, v38, s46
    v_bitop3_b32 v47, v36, 0.5, -0.5 bitop3:0xa8
    v_cvt_pk_bf16_f32 v80, v80, v81
    v_cvt_pk_bf16_f32 v81, v82, v83
    ds_wrxchg_rtn_b64 v[74:75], v93, v[80:81] offset:65408
    v_cvt_pk_bf16_f32 v76, v76, v77
    v_cvt_pk_bf16_f32 v77, v78, v79
    ds_wrxchg_rtn_b64 v[72:73], v92, v[76:77] offset:65408
    v_and_b32 v88, 0x0fffffff, v44
    v_mov_b32 v39, v44
    buffer_load_dwordx2 v[34:35], v88, s[8:11], 0 offen
    buffer_load_dwordx3 v[36:38], v88, s[8:11], 0 offen offset:8
    s_setprio 0
    s_waitcnt vmcnt(11)
    ds_write_addtid_b32 v112 offset:1024
    ds_write_addtid_b32 v113 offset:1280
    ds_write_addtid_b32 v114 offset:1536
    ds_write_addtid_b32 v115 offset:1792
    v_mfma_f32_4x4x4_16b_bf16 v[80:83], v[8:9], v[106:107], 0
    v_mfma_f32_4x4x4_16b_bf16 v[76:79], v[8:9], v[104:105], 0
    v_bitop3_b32 v15, v6, v15, v46 bitop3:0xca
    v_bitop3_b32 v14, v6, v14, v47 bitop3:0xca
    s_nop 1
    v_pk_mul_f32 v[80:81], v[80:81], v[14:15] op_sel:[0,1] op_sel_hi:[1,1]
    v_pk_mul_f32 v[82:83], v[82:83], v[14:15] op_sel:[0,1] op_sel_hi:[1,1]
    v_pk_mul_f32 v[76:77], v[76:77], v[14:15] op_sel:[0,0] op_sel_hi:[1,0]
    v_pk_mul_f32 v[78:79], v[78:79], v[14:15] op_sel:[0,0] op_sel_hi:[1,0]
    s_add_u32 s42, s42, 1
    s_waitcnt lgkmcnt(0)
L2_loop:
    s_barrier
    s_bitcmp1_b32 s36, s42
    s_cbranch_scc1 L2_slow
L2_ret2:
    s_setprio 3
    buffer_load_dwordx4 v[108:111], v3, s[16:19], s40 offen offset:0
    v_cmp_ne_u64 s[50:51], v[72:73], v[68:69]
    v_cmpx_ne_u64 s[54:55], v[74:75], v[70:71]
    s_and_b64 s[82:83], s[54:55], s[80:81]
    s_cbranch_scc1 L2_c46
L2_d46:
    v_mov_b64 v[84:85], v[70:71]
    v_mov_b32 v7, v93
    v_mov_b64 v[86:87], v[74:75]
    s_or_b64 s[80:81], s[80:81], s[54:55]
    s_mov_b64 exec, s[50:51]
    s_and_b64 s[82:83], s[50:51], s[80:81]
    s_cbranch_scc1 L2_c47
L2_d47:
    v_mov_b64 v[84:85], v[68:69]
    v_mov_b32 v7, v92
    v_mov_b64 v[86:87], v[72:73]
    s_mov_b64 exec, -1
    s_or_b64 s[80:81], s[80:81], s[50:51]
    ds_read_b64 v[70:71], v95 offset:65408
    ds_read_b64 v[68:69], v94 offset:65408
    s_waitcnt vmcnt(10)
    v_and_b32 v46, 0x20000000, v21
    v_lshrrev_b32 v47, 14, v17
    v_bitop3_b32 v47, v47, v5, v46 bitop3:0xea
    ds_read_b64 v[102:103], v47
    v_bitop3_b32 v93, v17, v5, v46 bitop3:0xea
    v_and_b32 v46, 0x10000000, v21
    v_lshrrev_b32 v47, 14, v16
    v_bitop3_b32 v47, v47, v5, v46 bitop3:0xea
    ds_read_b64 v[100:101], v47
    v_bitop3_b32 v92, v16, v5, v46 bitop3:0xea
    s_waitcnt lgkmcnt(2)
    v_mfma_f32_4x4x4_16b_bf16 v[80:83], v[10:11], v[70:71], v[80:83]
    v_mfma_f32_4x4x4_16b_bf16 v[76:79], v[10:11], v[68:69], v[76:79]
    v_perm_b32 v15, v17, v20, s45
    v_bitop3_b32 v46, v17, 0.5, -0.5 bitop3:0xa8
    v_perm_b32 v14, v16, v20, s44
    v_bitop3_b32 v47, v16, 0.5, -0.5 bitop3:0xa8
    v_cvt_pk_bf16_f32 v80, v80, v81
    v_cvt_pk_bf16_f32 v81, v82, v83
    ds_wrxchg_rtn_b64 v[74:75], v95, v[80:81] offset:65408
    v_cvt_pk_bf16_f32 v76, v76, v77
    v_cvt_pk_bf16_f32 v77, v78, v79
    ds_wrxchg_rtn_b64 v[72:73], v94, v[76:77] offset:65408
    s_waitcnt lgkmcnt(2)
    v_mfma_f32_4x4x4_16b_bf16 v[80:83], v[8:9], v[102:103], 0
    v_mfma_f32_4x4x4_16b_bf16 v[76:79], v[8:9], v[100:101], 0
    v_bitop3_b32 v15, v6, v15, v46 bitop3:0xca
    v_bitop3_b32 v14, v6, v14, v47 bitop3:0xca
    v_cmp_lt_u32 s[84:85], v5, v92
    s_nop 0
    v_pk_mul_f32 v[80:81], v[80:81], v[14:15] op_sel:[0,1] op_sel_hi:[1,1]
    v_pk_mul_f32 v[82:83], v[82:83], v[14:15] op_sel:[0,1] op_sel_hi:[1,1]
    v_pk_mul_f32 v[76:77], v[76:77], v[14:15] op_sel:[0,0] op_sel_hi:[1,0]
    v_pk_mul_f32 v[78:79], v[78:79], v[14:15] op_sel:[0,0] op_sel_hi:[1,0]
    buffer_load_dwordx4 v[112:115], v3, s[16:19], s40 offen offset:1024
    s_waitcnt lgkmcnt(0)
    v_cmp_ne_u64 s[50:51], v[72:73], v[68:69]
    v_cmpx_ne_u64 s[54:55], v[74:75], v[70:71]
    s_and_b64 s[82:83], s[54:55], s[80:81]
    s_cbranch_scc1 L2_c48
L2_d48:
    v_mov_b64 v[84:85], v[70:71]
    v_mov_b32 v7, v95
    v_mov_b64 v[86:87], v[74:75]
    s_or_b64 s[80:81], s[80:81], s[54:55]
    s_mov_b64 exec, s[50:51]
    s_and_b64 s[82:83], s[50:51], s[80:81]
    s_cbranch_scc1 L2_c49
L2_d49:
    v_mov_b64 v[84:85], v[68:69]
    v_mov_b32 v7, v94
    v_mov_b64 v[86:87], v[72:73]
    s_mov_b64 exec, -1
    s_or_b64 s[80:81], s[80:81], s[50:51]
    ds_read_b64 v[70:71], v93 offset:65408
    s_and_b64 exec, s[84:85], s[80:81]
    v_mfma_f32_4x4x4_16b_bf16 v[76:79], v[12:13], v[84:85], 0
    v_mov_b32 v92, v7
    s_andn2_b64 s[80:81], s[80:81], s[84:85]
    v_mfma_f32_4x4x4_16b_bf16 v[76:79], v[10:11], v[86:87], v[76:79]
    s_mov_b64 exec, -1
    ds_read_b64 v[68:69], v92 offset:65408
    v_and_b32 v46, 0x80000000, v21
    v_lshrrev_b32 v47, 14, v19
    v_bitop3_b32 v47, v47, v5, v46 bitop3:0xea
    ds_read_b64 v[106:107], v47
    v_bitop3_b32 v95, v19, v5, v46 bitop3:0xea
    v_and_b32 v46, 0x40000000, v21
    v_lshrrev_b32 v47, 14, v18
    v_bitop3_b32 v47, v47, v5, v46 bitop3:0xea
    ds_read_b64 v[104:105], v47
    v_bitop3_b32 v94, v18, v5, v46 bitop3:0xea
    s_waitcnt lgkmcnt(2)
    v_mfma_f32_4x4x4_16b_bf16 v[80:83], v[10:11], v[70:71], v[80:83]
    v_mfma_f32_4x4x4_16b_bf16 v[76:79], v[10:11], v[68:69], v[76:79]
    v_perm_b32 v15, v19, v20, s47
    v_bitop3_b32 v46, v19, 0.5, -0.5 bitop3:0xa8
    v_perm_b32 v14, v18, v20, s46
    v_bitop3_b32 v47, v18, 0.5, -0.5 bitop3:0xa8
    v_cvt_pk_bf16_f32 v80, v80, v81
    v_cvt_pk_bf16_f32 v81, v82, v83
    ds_wrxchg_rtn_b64 v[74:75], v93, v[80:81] offset:65408
    v_cvt_pk_bf16_f32 v76, v76, v77
    v_cvt_pk_bf16_f32 v77, v78, v79
    ds_wrxchg_rtn_b64 v[72:73], v92, v[76:77] offset:65408
    v_and_b32 v88, 0x0fffffff, v40
    v_mov_b32 v21, v40
    buffer_load_dwordx2 v[16:17], v88, s[8:11], 0 offen
    buffer_load_dwordx3 v[18:20], v88, s[8:11], 0 offen offset:8
    s_setprio 2
    s_waitcnt lgkmcnt(2)
    v_mfma_f32_4x4x4_16b_bf16 v[80:83], v[8:9], v[106:107], 0
    v_mfma_f32_4x4x4_16b_bf16 v[76:79], v[8:9], v[104:105], 0
    v_bitop3_b32 v15, v6, v15, v46 bitop3:0xca
    v_bitop3_b32 v14, v6, v14, v47 bitop3:0xca
    s_nop 1
    v_pk_mul_f32 v[80:81], v[80:81], v[14:15] op_sel:[0,1] op_sel_hi:[1,1]
    v_pk_mul_f32 v[82:83], v[82:83], v[14:15] op_sel:[0,1] op_sel_hi:[1,1]
    v_pk_mul_f32 v[76:77], v[76:77], v[14:15] op_sel:[0,0] op_sel_hi:[1,0]
    v_pk_mul_f32 v[78:79], v[78:79], v[14:15] op_sel:[0,0] op_sel_hi:[1,0]
    v_sub_u16 v88, v56, v48
    v_and_b32 v89, 3, v48
    v_add3_u32 v99, v88, v89, 3
    v_and_b32 v99, -4, v99
    v_max_u32 v99, 4, v99
    v_and_b32 v97, 0xfffc, v48
    v_bfm_b32 v96, v88, v89
    v_add_u32_dpp v91, v99, v99 row_shr:1 row_mask:0xf bank_mask:0xf bound_ctrl:1
    v_mad_u32_u24 v97, v97, 5, v2
    v_cmp_lt_u32 vcc, 16, v99
    v_add_u32_dpp v91, v91, v91 row_shr:2 row_mask:0xf bank_mask:0xf bound_ctrl:1
    v_sub_u32 v98, s38, v99
    v_lshrrev_b64 v[48:49], 16, v[48:49]
    v_add_u32_dpp v91, v91, v91 row_shr:4 row_mask:0xf bank_mask:0xf bound_ctrl:1
    v_lshrrev_b64 v[56:57], 16, v[56:57]
    s_mov_b32 s101, 0
    v_add_u32_dpp v91, v91, v91 row_shr:8 row_mask:0xf bank_mask:0xf bound_ctrl:1
    s_nop 1
    v_add_u32_dpp v91, v91, v91 row_bcast:15 row_mask:0xa bank_mask:0xf
    s_nop 1
    v_add_u32_dpp v91, v91, v91 row_bcast:31 row_mask:0xc bank_mask:0xf
    v_add_u32 v98, v98, v91
    v_readlane_b32 s37, v91, 63
    s_cbranch_vccnz L2_xo50
L2_xp50:
    s_waitcnt lgkmcnt(0)
    v_cmp_ne_u64 s[50:51], v[72:73], v[68:69]
    v_cmpx_ne_u64 s[54:55], v[74:75], v[70:71]
    s_and_b64 s[82:83], s[54:55], s[80:81]
    s_cbranch_scc1 L2_c51
L2_d51:
    v_mov_b64 v[84:85], v[70:71]
    v_mov_b32 v7, v93
    v_mov_b64 v[86:87], v[74:75]
    s_or_b64 s[80:81], s[80:81], s[54:55]
    s_mov_b64 exec, s[50:51]
    s_and_b64 s[82:83], s[50:51], s[80:81]
    s_cbranch_scc1 L2_c52
L2_d52:
    v_mov_b64 v[84:85], v[68:69]
    v_mov_b32 v7, v92
    v_mov_b64 v[86:87], v[72:73]
    s_mov_b64 exec, -1
    s_or_b64 s[80:81], s[80:81], s[50:51]
    ds_read_b64 v[70:71], v95 offset:65408
    ds_read_b64 v[68:69], v94 offset:65408
    s_waitcnt vmcnt(11)
    v_and_b32 v46, 0x20000000, v27
    v_lshrrev_b32 v47, 14, v23
    v_bitop3_b32 v47, v47, v5, v46 bitop3:0xea
    ds_read_b64 v[102:103], v47
    v_bitop3_b32 v93, v23, v5, v46 bitop3:0xea
    v_and_b32 v46, 0x10000000, v27
    v_lshrrev_b32 v47, 14, v22
    v_bitop3_b32 v47, v47, v5, v46 bitop3:0xea
    ds_read_b64 v[100:101], v47
    v_bitop3_b32 v92, v22, v5, v46 bitop3:0xea
    s_waitcnt lgkmcnt(2)
    v_mfma_f32_4x4x4_16b_bf16 v[80:83], v[10:11], v[70:71], v[80:83]
    v_mfma_f32_4x4x4_16b_bf16 v[76:79], v[10:11], v[68:69], v[76:79]
    v_perm_b32 v15, v23, v26, s45
    v_bitop3_b32 v46, v23, 0.5, -0.5 bitop3:0xa8
    v_perm_b32 v14, v22, v26, s44
    v_bitop3_b32 v47, v22, 0.5, -0.5 bitop3:0xa8
    v_cvt_pk_bf16_f32 v80, v80, v81
    v_cvt_pk_bf16_f32 v81, v82, v83
    ds_wrxchg_rtn_b64 v[74:75], v95, v[80:81] offset:65408
    v_cvt_pk_bf16_f32 v76, v76, v77
    v_cvt_pk_bf16_f32 v77, v78, v79
    ds_wrxchg_rtn_b64 v[72:73], v94, v[76:77] offset:65408
    s_waitcnt lgkmcnt(2)
    v_mfma_f32_4x4x4_16b_bf16 v[80:83], v[8:9], v[102:103], 0
    v_mfma_f32_4x4x4_16b_bf16 v[76:79], v[8:9], v[100:101], 0
    v_bitop3_b32 v15, v6, v15, v46 bitop3:0xca
    v_bitop3_b32 v14, v6, v14, v47 bitop3:0xca
    v_cmp_lt_u32 s[84:85], v5, v92
    s_nop 0
    v_pk_mul_f32 v[80:81], v[80:81], v[14:15] op_sel:[0,1] op_sel_hi:[1,1]
    v_pk_mul_f32 v[82:83], v[82:83], v[14:15] op_sel:[0,1] op_sel_hi:[1,1]
    v_pk_mul_f32 v[76:77], v[76:77], v[14:15] op_sel:[0,0] op_sel_hi:[1,0]
    v_pk_mul_f32 v[78:79], v[78:79], v[14:15] op_sel:[0,0] op_sel_hi:[1,0]
    s_waitcnt lgkmcnt(0)
    v_cmp_ne_u64 s[50:51], v[72:73], v[68:69]
    v_cmpx_ne_u64 s[54:55], v[74:75], v[70:71]
    s_and_b64 s[82:83], s[54:55], s[80:81]
    s_cbranch_scc1 L2_c53
L2_d53:
    v_mov_b64 v[84:85], v[70:71]
    v_mov_b32 v7, v95
    v_mov_b64 v[86:87], v[74:75]
    s_or_b64 s[80:81], s[80:81], s[54:55]
    s_mov_b64 exec, s[50:51]
    s_and_b64 s[82:83], s[50:51], s[80:81]
    s_cbranch_scc1 L2_c54
L2_d54:
    v_mov_b64 v[84:85], v[68:69]
    v_mov_b32 v7, v94
    v_mov_b64 v[86:87], v[72:73]
    s_mov_b64 exec, -1
    s_or_b64 s[80:81], s[80:81], s[50:51]
    ds_read_b64 v[70:71], v93 offset:65408
    s_and_b64 exec, s[84:85], s[80:81]
    v_mfma_f32_4x4x4_16b_bf16 v[76:79], v[12:13], v[84:85], 0
    v_mov_b32 v92, v7
    s_andn2_b64 s[80:81], s[80:81], s[84:85]
    v_mfma_f32_4x4x4_16b_bf16 v[76:79], v[10:11], v[86:87], v[76:79]
    s_mov_b64 exec, -1
    ds_read_b64 v[68:69], v92 offset:65408
    v_and_b32 v46, 0x80000000, v27
    v_lshrrev_b32 v47, 14, v25
    v_bitop3_b32 v47, v47, v5, v46 bitop3:0xea
    ds_read_b64 v[106:107], v47
    v_bitop3_b32 v95, v25, v5, v46 bitop3:0xea
    v_and_b32 v46, 0x40000000, v27
    v_lshrrev_b32 v47, 14, v24
    v_bitop3_b32 v47, v47, v5, v46 bitop3:0xea
    ds_read_b64 v[104:105], v47
    v_bitop3_b32 v94, v24, v5, v46 bitop3:0xea
    s_waitcnt lgkmcnt(2)
    v_mfma_f32_4x4x4_16b_bf16 v[80:83], v[10:11], v[70:71], v[80:83]
    v_mfma_f32_4x4x4_16b_bf16 v[76:79], v[10:11], v[68:69], v[76:79]
    v_perm_b32 v15, v25, v26, s47
    v_bitop3_b32 v46, v25, 0.5, -0.5 bitop3:0xa8
    v_perm_b32 v14, v24, v26, s46
    v_bitop3_b32 v47, v24, 0.5, -0.5 bitop3:0xa8
    v_cvt_pk_bf16_f32 v80, v80, v81
    v_cvt_pk_bf16_f32 v81, v82, v83
    ds_wrxchg_rtn_b64 v[74:75], v93, v[80:81] offset:65408
    v_cvt_pk_bf16_f32 v76, v76, v77
    v_cvt_pk_bf16_f32 v77, v78, v79
    ds_wrxchg_rtn_b64 v[72:73], v92, v[76:77] offset:65408
    v_and_b32 v88, 0x0fffffff, v41
    v_mov_b32 v27, v41
    buffer_load_dwordx2 v[22:23], v88, s[8:11], 0 offen
    buffer_load_dwordx3 v[24:26], v88, s[8:11], 0 offen offset:8
    s_setprio 1
    s_waitcnt lgkmcnt(2)
    v_mfma_f32_4x4x4_16b_bf16 v[80:83], v[8:9], v[106:107], 0
    v_mfma_f32_4x4x4_16b_bf16 v[76:79], v[8:9], v[104:105], 0
    v_bitop3_b32 v15, v6, v15, v46 bitop3:0xca
    v_bitop3_b32 v14, v6, v14, v47 bitop3:0xca
    s_nop 1
    v_pk_mul_f32 v[80:81], v[80:81], v[14:15] op_sel:[0,1] op_sel_hi:[1,1]
    v_pk_mul_f32 v[82:83], v[82:83], v[14:15] op_sel:[0,1] op_sel_hi:[1,1]
    v_pk_mul_f32 v[76:77], v[76:77], v[14:15] op_sel:[0,0] op_sel_hi:[1,0]
    v_pk_mul_f32 v[78:79], v[78:79], v[14:15] op_sel:[0,0] op_sel_hi:[1,0]
    s_waitcnt lgkmcnt(0)
    v_cmp_ne_u64 s[50:51], v[72:73], v[68:69]
    v_cmpx_ne_u64 s[54:55], v[74:75], v[70:71]
    s_and_b64 s[82:83], s[54:55], s[80:81]
    s_cbranch_scc1 L2_c55
L2_d55:
    v_mov_b64 v[84:85], v[70:71]
    v_mov_b32 v7, v93
    v_mov_b64 v[86:87], v[74:75]
    s_or_b64 s[80:81], s[80:81], s[54:55]
    s_mov_b64 exec, s[50:51]
    s_and_b64 s[82:83], s[50:51], s[80:81]
    s_cbranch_scc1 L2_c56
L2_d56:
    v_mov_b64 v[84:85], v[68:69]
    v_mov_b32 v7, v92
    v_mov_b64 v[86:87], v[72:73]
    s_mov_b64 exec, -1
    s_or_b64 s[80:81], s[80:81], s[50:51]
    ds_read_b64 v[70:71], v95 offset:65408
    ds_read_b64 v[68:69], v94 offset:65408
    s_waitcnt vmcnt(11)
    v_and_b32 v46, 0x20000000, v33
    v_lshrrev_b32 v47, 14, v29
    v_bitop3_b32 v47, v47, v5, v46 bitop3:0xea
    ds_read_b64 v[102:103], v47
    v_bitop3_b32 v93, v29, v5, v46 bitop3:0xea
    v_and_b32 v46, 0x10000000, v33
    v_lshrrev_b32 v47, 14, v28
    v_bitop3_b32 v47, v47, v5, v46 bitop3:0xea
    ds_read_b64 v[100:101], v47
    v_bitop3_b32 v92, v28, v5, v46 bitop3:0xea
    s_waitcnt lgkmcnt(2)
    v_mfma_f32_4x4x4_16b_bf16 v[80:83], v[10:11], v[70:71], v[80:83]
    v_mfma_f32_4x4x4_16b_bf16 v[76:79], v[10:11], v[68:69], v[76:79]
    v_perm_b32 v15, v29, v32, s45
    v_bitop3_b32 v46, v29, 0.5, -0.5 bitop3:0xa8
    v_perm_b32 v14, v28, v32, s44
    v_bitop3_b32 v47, v28, 0.5, -0.5 bitop3:0xa8
    v_cvt_pk_bf16_f32 v80, v80, v81
    v_cvt_pk_bf16_f32 v81, v82, v83
    ds_wrxchg_rtn_b64 v[74:75], v95, v[80:81] offset:65408
    v_cvt_pk_bf16_f32 v76, v76, v77
    v_cvt_pk_bf16_f32 v77, v78, v79
    ds_wrxchg_rtn_b64 v[72:73], v94, v[76:77] offset:65408
    s_waitcnt lgkmcnt(2)
    v_mfma_f32_4x4x4_16b_bf16 v[80:83], v[8:9], v[102:103], 0
    v_mfma_f32_4x4x4_16b_bf16 v[76:79], v[8:9], v[100:101], 0
    v_bitop3_b32 v15, v6, v15, v46 bitop3:0xca
    v_bitop3_b32 v14, v6, v14, v47 bitop3:0xca
    v_cmp_lt_u32 s[84:85], v5, v92
    s_nop 0
    v_pk_mul_f32 v[80:81], v[80:81], v[14:15] op_sel:[0,1] op_sel_hi:[1,1]
    v_pk_mul_f32 v[82:83], v[82:83], v[14:15] op_sel:[0,1] op_sel_hi:[1,1]
    v_pk_mul_f32 v[76:77], v[76:77], v[14:15] op_sel:[0,0] op_sel_hi:[1,0]
    v_pk_mul_f32 v[78:79], v[78:79], v[14:15] op_sel:[0,0] op_sel_hi:[1,0]
    s_waitcnt lgkmcnt(0)
    v_cmp_ne_u64 s[50:51], v[72:73], v[68:69]
    v_cmpx_ne_u64 s[54:55], v[74:75], v[70:71]
    s_and_b64 s[82:83], s[54:55], s[80:81]
    s_cbranch_scc1 L2_c57
L2_d57:
    v_mov_b64 v[84:85], v[70:71]
    v_mov_b32 v7, v95
    v_mov_b64 v[86:87], v[74:75]
    s_or_b64 s[80:81], s[80:81], s[54:55]
    s_mov_b64 exec, s[50:51]
    s_and_b64 s[82:83], s[50:51], s[80:81]
    s_cbranch_scc1 L2_c58
L2_d58:
    v_mov_b64 v[84:85], v[68:69]
    v_mov_b32 v7, v94
    v_mov_b64 v[86:87], v[72:73]
    s_mov_b64 exec, -1
    s_or_b64 s[80:81], s[80:81], s[50:51]
    ds_read_b64 v[70:71], v93 offset:65408
    s_and_b64 exec, s[84:85], s[80:81]
    v_mfma_f32_4x4x4_16b_bf16 v[76:79], v[12:13], v[84:85], 0
    v_mov_b32 v92, v7
    s_andn2_b64 s[80:81], s[80:81], s[84:85]
    v_mfma_f32_4x4x4_16b_bf16 v[76:79], v[10:11], v[86:87], v[76:79]
    s_mov_b64 exec, -1
    ds_read_b64 v[68:69], v92 offset:65408
    v_and_b32 v46, 0x80000000, v33
    v_lshrrev_b32 v47, 14, v31
    v_bitop3_b32 v47, v47, v5, v46 bitop3:0xea
    ds_read_b64 v[106:107], v47
    v_bitop3_b32 v95, v31, v5, v46 bitop3:0xea
    v_and_b32 v46, 0x40000000, v33
    v_lshrrev_b32 v47, 14, v30
    v_bitop3_b32 v47, v47, v5, v46 bitop3:0xea
    ds_read_b64 v[104:105], v47
    v_bitop3_b32 v94, v30, v5, v46 bitop3:0xea
    s_waitcnt lgkmcnt(2)
    v_mfma_f32_4x4x4_16b_bf16 v[80:83], v[10:11], v[70:71], v[80:83]
    v_mfma_f32_4x4x4_16b_bf16 v[76:79], v[10:11], v[68:69], v[76:79]
    v_perm_b32 v15, v31, v32, s47
    v_bitop3_b32 v46, v31, 0.5, -0.5 bitop3:0xa8
    v_perm_b32 v14, v30, v32, s46
    v_bitop3_b32 v47, v30, 0.5, -0.5 bitop3:0xa8
    v_cvt_pk_bf16_f32 v80, v80, v81
    v_cvt_pk_bf16_f32 v81, v82, v83
    ds_wrxchg_rtn_b64 v[74:75], v93, v[80:81] offset:65408
    v_cvt_pk_bf16_f32 v76, v76, v77
    v_cvt_pk_bf16_f32 v77, v78, v79
    ds_wrxchg_rtn_b64 v[72:73], v92, v[76:77] offset:65408
    v_and_b32 v88, 0x0fffffff, v42
    v_mov_b32 v33, v42
    buffer_load_dwordx2 v[28:29], v88, s[8:11], 0 offen
    buffer_load_dwordx3 v[30:32], v88, s[8:11], 0 offen offset:8
    s_setprio 0
    s_waitcnt lgkmcnt(2)
    v_mfma_f32_4x4x4_16b_bf16 v[80:83], v[8:9], v[106:107], 0
    v_mfma_f32_4x4x4_16b_bf16 v[76:79], v[8:9], v[104:105], 0
    v_bitop3_b32 v15, v6, v15, v46 bitop3:0xca
    v_bitop3_b32 v14, v6, v14, v47 bitop3:0xca
    s_nop 1
    v_pk_mul_f32 v[80:81], v[80:81], v[14:15] op_sel:[0,1] op_sel_hi:[1,1]
    v_pk_mul_f32 v[82:83], v[82:83], v[14:15] op_sel:[0,1] op_sel_hi:[1,1]
    v_pk_mul_f32 v[76:77], v[76:77], v[14:15] op_sel:[0,0] op_sel_hi:[1,0]
    v_pk_mul_f32 v[78:79], v[78:79], v[14:15] op_sel:[0,0] op_sel_hi:[1,0]
    s_add_u32 s40, s40, 0xfff24000
    s_waitcnt lgkmcnt(0)
    v_cmp_ne_u64 s[50:51], v[72:73], v[68:69]
    v_cmpx_ne_u64 s[54:55], v[74:75], v[70:71]
    s_and_b64 s[82:83], s[54:55], s[80:81]
    s_cbranch_scc1 L2_c59
L2_d59:
    v_mov_b64 v[84:85], v[70:71]
    v_mov_b32 v7, v93
    v_mov_b64 v[86:87], v[74:75]
    s_or_b64 s[80:81], s[80:81], s[54:55]
    s_mov_b64 exec, s[50:51]
    s_and_b64 s[82:83], s[50:51], s[80:81]
    s_cbranch_scc1 L2_c60
L2_d60:
    v_mov_b64 v[84:85], v[68:69]
    v_mov_b32 v7, v92
    v_mov_b64 v[86:87], v[72:73]
    s_mov_b64 exec, -1
    s_or_b64 s[80:81], s[80:81], s[50:51]
    ds_read_b64 v[70:71], v95 offset:65408
    ds_read_b64 v[68:69], v94 offset:65408
    s_waitcnt vmcnt(8)
    v_and_b32 v46, 0x20000000, v39
    v_lshrrev_b32 v47, 14, v35
    v_bitop3_b32 v47, v47, v5, v46 bitop3:0xea
    ds_read_b64 v[102:103], v47
    v_bitop3_b32 v93, v35, v5, v46 bitop3:0xea
    v_and_b32 v46, 0x10000000, v39
    v_lshrrev_b32 v47, 14, v34
    v_bitop3_b32 v47, v47, v5, v46 bitop3:0xea
    ds_read_b64 v[100:101], v47
    v_bitop3_b32 v92, v34, v5, v46 bitop3:0xea
    v_and_b32 v46, 0x80000000, v39
    v_lshrrev_b32 v47, 14, v37
    v_bitop3_b32 v47, v47, v5, v46 bitop3:0xea
    ds_read_b64 v[106:107], v47
    v_and_b32 v46, 0x40000000, v39
    v_lshrrev_b32 v47, 14, v36
    v_bitop3_b32 v47, v47, v5, v46 bitop3:0xea
    ds_read_b64 v[104:105], v47
    s_waitcnt lgkmcnt(4)
    v_mfma_f32_4x4x4_16b_bf16 v[80:83], v[10:11], v[70:71], v[80:83]
    v_mfma_f32_4x4x4_16b_bf16 v[76:79], v[10:11], v[68:69], v[76:79]
    v_perm_b32 v15, v35, v38, s45
    v_bitop3_b32 v46, v35, 0.5, -0.5 bitop3:0xa8
    v_perm_b32 v14, v34, v38, s44
    v_bitop3_b32 v47, v34, 0.5, -0.5 bitop3:0xa8
    v_cvt_pk_bf16_f32 v80, v80, v81
    v_cvt_pk_bf16_f32 v81, v82, v83
    ds_wrxchg_rtn_b64 v[74:75], v95, v[80:81] offset:65408
    v_cvt_pk_bf16_f32 v76, v76, v77
    v_cvt_pk_bf16_f32 v77, v78, v79
    ds_wrxchg_rtn_b64 v[72:73], v94, v[76:77] offset:65408
    s_waitcnt lgkmcnt(2)
    s_barrier
    s_setprio 3
    s_mov_b32 m0, s100
    s_nop 0
    ds_write_addtid_b32 v116 offset:32768
    ds_write_addtid_b32 v117 offset:33024
    ds_write_addtid_b32 v118 offset:33280
    ds_write_addtid_b32 v119 offset:33536
    buffer_load_dwordx4 v[116:119], v3, s[16:19], s40 offen offset:2048
    ds_write_addtid_b32 v120 offset:33792
    ds_write_addtid_b32 v121 offset:34048
    ds_write_addtid_b32 v122 offset:34304
    ds_write_addtid_b32 v123 offset:34560
    buffer_load_dwordx4 v[120:123], v3, s[16:19], s40 offen offset:3072
    v_mfma_f32_4x4x4_16b_bf16 v[80:83], v[8:9], v[102:103], 0
    v_mfma_f32_4x4x4_16b_bf16 v[76:79], v[8:9], v[100:101], 0
    v_bitop3_b32 v15, v6, v15, v46 bitop3:0xca
    v_bitop3_b32 v14, v6, v14, v47 bitop3:0xca
    v_cmp_lt_u32 s[84:85], v5, v92
    s_nop 0
    v_pk_mul_f32 v[80:81], v[80:81], v[14:15] op_sel:[0,1] op_sel_hi:[1,1]
    v_pk_mul_f32 v[82:83], v[82:83], v[14:15] op_sel:[0,1] op_sel_hi:[1,1]
    v_pk_mul_f32 v[76:77], v[76:77], v[14:15] op_sel:[0,0] op_sel_hi:[1,0]
    v_pk_mul_f32 v[78:79], v[78:79], v[14:15] op_sel:[0,0] op_sel_hi:[1,0]
    v_mov_b32 v44, v43
    s_cmp_gt_u32 s37, 1024
    s_cbranch_scc1 L2_xs61
    s_cmp_lg_u32 s101, 0
    s_cbranch_scc1 L2_xa61
L2_xb61:
    v_lshlrev_b32 v89, 16, v96
    v_add_u32 v90, 60, v97
    v_bitop3_b32 v90, v89, v45, v90 bitop3:0x6a
    ds_write_b32 v98, v90 offset:12
    v_lshlrev_b32 v89, 20, v96
    v_add_u32 v90, 40, v97
    v_bitop3_b32 v90, v89, v45, v90 bitop3:0x6a
    ds_write_b32 v98, v90 offset:8
    v_lshlrev_b32 v89, 24, v96
    v_add_u32 v90, 20, v97
    v_bitop3_b32 v90, v89, v45, v90 bitop3:0x6a
    ds_write_b32 v98, v90 offset:4
    v_lshlrev_b32 v89, 28, v96
    v_bitop3_b32 v90, v89, v45, v97 bitop3:0x6a
    ds_write_b32 v98, v90 offset:0
    v_mov_b32_dpp v91, v64 quad_perm:[0,0,0,0] row_mask:0xf bank_mask:0xf
    v_and_b32 v89, 3, v91
    v_and_b32 v97, 0xfffc, v91
    v_sub_u16_dpp v88, v64, v91 quad_perm:[2,2,2,2] row_mask:0xf bank_mask:0xf
    v_mad_u32_u24 v97, v97, 5, v4
    v_add_u32 v99, v88, v89
    v_bfm_b32 v96, v88, v89
    v_cmp_lt_u32 s[58:59], 16, v99
    v_lshlrev_b32 v89, v1, v96
    v_and_b32 v89, v45, v89
    v_cmp_ne_u32 vcc, 0, v89
    v_xor_b32 v90, v97, v89
    s_add_u32 s3, s37, s38
    v_mbcnt_lo_u32_b32 v98, vcc_lo, 0
    v_mbcnt_hi_u32_b32 v98, vcc_hi, v98
    s_bcnt1_i32_b64 s41, vcc
    v_lshl_add_u32 v98, v98, 2, s3
    s_mov_b64 exec, vcc
    ds_write_b32 v98, v90
    s_mov_b64 exec, -1
    s_lshl2_add_u32 s37, s41, s37
    s_cmp_lg_u64 s[58:59], 0
    s_cbranch_scc1 L2_xe61
L2_xr61:
    v_add_u32 v98, s37, v0
    v_mov_b32 v90, -1
    ds_write_b32 v98, v90
    ds_read2st64_b32 v[40:41], v0 offset0:0 offset1:1
    ds_read2st64_b32 v[42:43], v0 offset0:2 offset1:3
    s_sub_u32 s3, s37, 768
    s_cmp_gt_u32 s3, 256
    s_cbranch_scc1 L2_xf61
L2_xg61:
    s_setprio 2
    ds_write_addtid_b32 v124 offset:34816
    ds_write_addtid_b32 v125 offset:35072
    ds_write_addtid_b32 v126 offset:35328
    ds_write_addtid_b32 v127 offset:35584
    s_add_u32 s3, s40, 4096
    buffer_load_dwordx4 v[124:127], v3, s[16:19], s3 offen
    s_waitcnt lgkmcnt(14)
    v_cmp_ne_u64 s[50:51], v[72:73], v[68:69]
    v_cmpx_ne_u64 s[54:55], v[74:75], v[70:71]
    s_and_b64 s[82:83], s[54:55], s[80:81]
    s_cbranch_scc1 L2_c62
L2_d62:
    v_mov_b64 v[84:85], v[70:71]
    v_mov_b32 v7, v95
    v_mov_b64 v[86:87], v[74:75]
    s_or_b64 s[80:81], s[80:81], s[54:55]
    s_mov_b64 exec, s[50:51]
    s_and_b64 s[82:83], s[50:51], s[80:81]
    s_cbranch_scc1 L2_c63
L2_d63:
    v_mov_b64 v[84:85], v[68:69]
    v_mov_b32 v7, v94
    v_mov_b64 v[86:87], v[72:73]
    s_mov_b64 exec, -1
    s_or_b64 s[80:81], s[80:81], s[50:51]
    ds_read_b64 v[70:71], v93 offset:65408
    s_and_b64 exec, s[84:85], s[80:81]
    v_mfma_f32_4x4x4_16b_bf16 v[76:79], v[12:13], v[84:85], 0
    v_mov_b32 v92, v7
    s_andn2_b64 s[80:81], s[80:81], s[84:85]
    v_mfma_f32_4x4x4_16b_bf16 v[76:79], v[10:11], v[86:87], v[76:79]
    s_mov_b64 exec, -1
    ds_read_b64 v[68:69], v92 offset:65408
    s_setprio 1
    s_waitcnt vmcnt(10)
    s_mov_b32 m0, s38
    s_nop 0
    ds_write_addtid_b32 v108 offset:0
    ds_write_addtid_b32 v109 offset:256
    ds_write_addtid_b32 v110 offset:512
    ds_write_addtid_b32 v111 offset:768
    s_waitcnt lgkmcnt(4)
    v_mfma_f32_4x4x4_16b_bf16 v[80:83], v[10:11], v[70:71], v[80:83]
    v_mfma_f32_4x4x4_16b_bf16 v[76:79], v[10:11], v[68:69], v[76:79]
    v_and_b32 v46, 0x40000000, v39
    v_bitop3_b32 v94, v36, v5, v46 bitop3:0xea
    v_and_b32 v46, 0x80000000, v39
    v_bitop3_b32 v95, v37, v5, v46 bitop3:0xea
    v_perm_b32 v15, v37, v38, s47
    v_bitop3_b32 v46, v37, 0.5, -0.5 bitop3:0xa8
    v_perm_b32 v14, v36, v38, s46
    v_bitop3_b32 v47, v36, 0.5, -0.5 bitop3:0xa8
    v_cvt_pk_bf16_f32 v80, v80, v81
    v_cvt_pk_bf16_f32 v81, v82, v83
    ds_wrxchg_rtn_b64 v[74:75], v93, v[80:81] offset:65408
    v_cvt_pk_bf16_f32 v76, v76, v77
    v_cvt_pk_bf16_f32 v77, v78, v79
    ds_wrxchg_rtn_b64 v[72:73], v92, v[76:77] offset:65408
    v_and_b32 v88, 0x0fffffff, v44
    v_mov_b32 v39, v44
    buffer_load_dwordx2 v[34:35], v88, s[8:11], 0 offen
    buffer_load_dwordx3 v[36:38], v88, s[8:11], 0 offen offset:8
    s_setprio 0
    s_waitcnt vmcnt(11)
    ds_write_addtid_b32 v112 offset:1024
    ds_write_addtid_b32 v113 offset:1280
    ds_write_addtid_b32 v114 offset:1536
    ds_write_addtid_b32 v115 offset:1792
    v_mfma_f32_4x4x4_16b_bf16 v[80:83], v[8:9], v[106:107], 0
    v_mfma_f32_4x4x4_16b_bf16 v[76:79], v[8:9], v[104:105], 0
    v_bitop3_b32 v15, v6, v15, v46 bitop3:0xca
    v_bitop3_b32 v14, v6, v14, v47 bitop3:0xca
    s_nop 1
    v_pk_mul_f32 v[80:81], v[80:81], v[14:15] op_sel:[0,1] op_sel_hi:[1,1]
    v_pk_mul_f32 v[82:83], v[82:83], v[14:15] op_sel:[0,1] op_sel_hi:[1,1]
    v_pk_mul_f32 v[76:77], v[76:77], v[14:15] op_sel:[0,0] op_sel_hi:[1,0]
    v_pk_mul_f32 v[78:79], v[78:79], v[14:15] op_sel:[0,0] op_sel_hi:[1,0]
    s_add_u32 s42, s42, 1
    s_waitcnt lgkmcnt(0)
    s_barrier
    s_bitcmp1_b32 s36, s42
    s_cbranch_scc1 L2_slow
L2_ret3:
    s_setprio 3
    buffer_load_dwordx4 v[108:111], v3, s[16:19], s40 offen offset:0
    v_cmp_ne_u64 s[50:51], v[72:73], v[68:69]
    v_cmpx_ne_u64 s[54:55], v[74:75], v[70:71]
    s_and_b64 s[82:83], s[54:55], s[80:81]
    s_cbranch_scc1 L2_c64
L2_d64:
    v_mov_b64 v[84:85], v[70:71]
    v_mov_b32 v7, v93
    v_mov_b64 v[86:87], v[74:75]
    s_or_b64 s[80:81], s[80:81], s[54:55]
    s_mov_b64 exec, s[50:51]
    s_and_b64 s[82:83], s[50:51], s[80:81]
    s_cbranch_scc1 L2_c65
L2_d65:
    v_mov_b64 v[84:85], v[68:69]
    v_mov_b32 v7, v92
    v_mov_b64 v[86:87], v[72:73]
    s_mov_b64 exec, -1
    s_or_b64 s[80:81], s[80:81], s[50:51]
    ds_read_b64 v[70:71], v95 offset:65408
    ds_read_b64 v[68:69], v94 offset:65408
    s_waitcnt vmcnt(10)
    v_and_b32 v46, 0x20000000, v21
    v_lshrrev_b32 v47, 14, v17
    v_bitop3_b32 v47, v47, v5, v46 bitop3:0xea
    ds_read_b64 v[102:103], v47
    v_bitop3_b32 v93, v17, v5, v46 bitop3:0xea
    v_and_b32 v46, 0x10000000, v21
    v_lshrrev_b32 v47, 14, v16
    v_bitop3_b32 v47, v47, v5, v46 bitop3:0xea
    ds_read_b64 v[100:101], v47
    v_bitop3_b32 v92, v16, v5, v46 bitop3:0xea
    s_waitcnt lgkmcnt(2)
    v_mfma_f32_4x4x4_16b_bf16 v[80:83], v[10:11], v[70:71], v[80:83]
    v_mfma_f32_4x4x4_16b_bf16 v[76:79], v[10:11], v[68:69], v[76:79]
    v_perm_b32 v15, v17, v20, s45
    v_bitop3_b32 v46, v17, 0.5, -0.5 bitop3:0xa8
    v_perm_b32 v14, v16, v20, s44
    v_bitop3_b32 v47, v16, 0.5, -0.5 bitop3:0xa8
    v_cvt_pk_bf16_f32 v80, v80, v81
    v_cvt_pk_bf16_f32 v81, v82, v83
    ds_wrxchg_rtn_b64 v[74:75], v95, v[80:81] offset:65408
    v_cvt_pk_bf16_f32 v76, v76, v77
    v_cvt_pk_bf16_f32 v77, v78, v79
    ds_wrxchg_rtn_b64 v[72:73], v94, v[76:77] offset:65408
    s_waitcnt lgkmcnt(2)
    v_mfma_f32_4x4x4_16b_bf16 v[80:83], v[8:9], v[102:103], 0
    v_mfma_f32_4x4x4_16b_bf16 v[76:79], v[8:9], v[100:101], 0
    v_bitop3_b32 v15, v6, v15, v46 bitop3:0xca
    v_bitop3_b32 v14, v6, v14, v47 bitop3:0xca
    v_cmp_lt_u32 s[84:85], v5, v92
    s_nop 0
    v_pk_mul_f32 v[80:81], v[80:81], v[14:15] op_sel:[0,1] op_sel_hi:[1,1]
    v_pk_mul_f32 v[82:83], v[82:83], v[14:15] op_sel:[0,1] op_sel_hi:[1,1]
    v_pk_mul_f32 v[76:77], v[76:77], v[14:15] op_sel:[0,0] op_sel_hi:[1,0]
    v_pk_mul_f32 v[78:79], v[78:79], v[14:15] op_sel:[0,0] op_sel_hi:[1,0]
    buffer_load_dwordx4 v[112:115], v3, s[16:19], s40 offen offset:1024
    s_waitcnt lgkmcnt(0)
    v_cmp_ne_u64 s[50:51], v[72:73], v[68:69]
    v_cmpx_ne_u64 s[54:55], v[74:75], v[70:71]
    s_and_b64 s[82:83], s[54:55], s[80:81]
    s_cbranch_scc1 L2_c66
L2_d66:
    v_mov_b64 v[84:85], v[70:71]
    v_mov_b32 v7, v95
    v_mov_b64 v[86:87], v[74:75]
    s_or_b64 s[80:81], s[80:81], s[54:55]
    s_mov_b64 exec, s[50:51]
    s_and_b64 s[82:83], s[50:51], s[80:81]
    s_cbranch_scc1 L2_c67
L2_d67:
    v_mov_b64 v[84:85], v[68:69]
    v_mov_b32 v7, v94
    v_mov_b64 v[86:87], v[72:73]
    s_mov_b64 exec, -1
    s_or_b64 s[80:81], s[80:81], s[50:51]
    ds_read_b64 v[70:71], v93 offset:65408
    s_and_b64 exec, s[84:85], s[80:81]
    v_mfma_f32_4x4x4_16b_bf16 v[76:79], v[12:13], v[84:85], 0
    v_mov_b32 v92, v7
    s_andn2_b64 s[80:81], s[80:81], s[84:85]
    v_mfma_f32_4x4x4_16b_bf16 v[76:79], v[10:11], v[86:87], v[76:79]
    s_mov_b64 exec, -1
    ds_read_b64 v[68:69], v92 offset:65408
    v_and_b32 v46, 0x80000000, v21
    v_lshrrev_b32 v47, 14, v19
    v_bitop3_b32 v47, v47, v5, v46 bitop3:0xea
    ds_read_b64 v[106:107], v47
    v_bitop3_b32 v95, v19, v5, v46 bitop3:0xea
    v_and_b32 v46, 0x40000000, v21
    v_lshrrev_b32 v47, 14, v18
    v_bitop3_b32 v47, v47, v5, v46 bitop3:0xea
    ds_read_b64 v[104:105], v47
    v_bitop3_b32 v94, v18, v5, v46 bitop3:0xea
    s_waitcnt lgkmcnt(2)
    v_mfma_f32_4x4x4_16b_bf16 v[80:83], v[10:11], v[70:71], v[80:83]
    v_mfma_f32_4x4x4_16b_bf16 v[76:79], v[10:11], v[68:69], v[76:79]
    v_perm_b32 v15, v19, v20, s47
    v_bitop3_b32 v46, v19, 0.5, -0.5 bitop3:0xa8
    v_perm_b32 v14, v18, v20, s46
    v_bitop3_b32 v47, v18, 0.5, -0.5 bitop3:0xa8
    v_cvt_pk_bf16_f32 v80, v80, v81
    v_cvt_pk_bf16_f32 v81, v82, v83
    ds_wrxchg_rtn_b64 v[74:75], v93, v[80:81] offset:65408
    v_cvt_pk_bf16_f32 v76, v76, v77
    v_cvt_pk_bf16_f32 v77, v78, v79
    ds_wrxchg_rtn_b64 v[72:73], v92, v[76:77] offset:65408
    v_and_b32 v88, 0x0fffffff, v40
    v_mov_b32 v21, v40
    buffer_load_dwordx2 v[16:17], v88, s[8:11], 0 offen
    buffer_load_dwordx3 v[18:20], v88, s[8:11], 0 offen offset:8
    s_setprio 2
    s_waitcnt lgkmcnt(2)
    v_mfma_f32_4x4x4_16b_bf16 v[80:83], v[8:9], v[106:107], 0
    v_mfma_f32_4x4x4_16b_bf16 v[76:79], v[8:9], v[104:105], 0
    v_bitop3_b32 v15, v6, v15, v46 bitop3:0xca
    v_bitop3_b32 v14, v6, v14, v47 bitop3:0xca
    s_nop 1
    v_pk_mul_f32 v[80:81], v[80:81], v[14:15] op_sel:[0,1] op_sel_hi:[1,1]
    v_pk_mul_f32 v[82:83], v[82:83], v[14:15] op_sel:[0,1] op_sel_hi:[1,1]
    v_pk_mul_f32 v[76:77], v[76:77], v[14:15] op_sel:[0,0] op_sel_hi:[1,0]
    v_pk_mul_f32 v[78:79], v[78:79], v[14:15] op_sel:[0,0] op_sel_hi:[1,0]
    v_sub_u16 v88, v58, v50
    v_and_b32 v89, 3, v50
    v_add3_u32 v99, v88, v89, 3
    v_and_b32 v99, -4, v99
    v_max_u32 v99, 4, v99
    v_and_b32 v97, 0xfffc, v50
    v_bfm_b32 v96, v88, v89
    v_add_u32_dpp v91, v99, v99 row_shr:1 row_mask:0xf bank_mask:0xf bound_ctrl:1
    v_mad_u32_u24 v97, v97, 5, v2
    v_cmp_lt_u32 vcc, 16, v99
    v_add_u32_dpp v91, v91, v91 row_shr:2 row_mask:0xf bank_mask:0xf bound_ctrl:1
    v_sub_u32 v98, s38, v99
    v_lshrrev_b64 v[50:51], 16, v[50:51]
    v_add_u32_dpp v91, v91, v91 row_shr:4 row_mask:0xf bank_mask:0xf bound_ctrl:1
    v_lshrrev_b64 v[58:59], 16, v[58:59]
    s_mov_b32 s101, 0
    v_add_u32_dpp v91, v91, v91 row_shr:8 row_mask:0xf bank_mask:0xf bound_ctrl:1
    s_nop 1
    v_add_u32_dpp v91, v91, v91 row_bcast:15 row_mask:0xa bank_mask:0xf
    s_nop 1
    v_add_u32_dpp v91, v91, v91 row_bcast:31 row_mask:0xc bank_mask:0xf
    v_add_u32 v98, v98, v91
    v_readlane_b32 s37, v91, 63
    s_cbranch_vccnz L2_xo68
L2_xp68:
    s_waitcnt lgkmcnt(0)
    v_cmp_ne_u64 s[50:51], v[72:73], v[68:69]
    v_cmpx_ne_u64 s[54:55], v[74:75], v[70:71]
    s_and_b64 s[82:83], s[54:55], s[80:81]
    s_cbranch_scc1 L2_c69
L2_d69:
    v_mov_b64 v[84:85], v[70:71]
    v_mov_b32 v7, v93
    v_mov_b64 v[86:87], v[74:75]
    s_or_b64 s[80:81], s[80:81], s[54:55]
    s_mov_b64 exec, s[50:51]
    s_and_b64 s[82:83], s[50:51], s[80:81]
    s_cbranch_scc1 L2_c70
L2_d70:
    v_mov_b64 v[84:85], v[68:69]
    v_mov_b32 v7, v92
    v_mov_b64 v[86:87], v[72:73]
    s_mov_b64 exec, -1
    s_or_b64 s[80:81], s[80:81], s[50:51]
    ds_read_b64 v[70:71], v95 offset:65408
    ds_read_b64 v[68:69], v94 offset:65408
    s_waitcnt vmcnt(11)
    v_and_b32 v46, 0x20000000, v27
    v_lshrrev_b32 v47, 14, v23
    v_bitop3_b32 v47, v47, v5, v46 bitop3:0xea
    ds_read_b64 v[102:103], v47
    v_bitop3_b32 v93, v23, v5, v46 bitop3:0xea
    v_and_b32 v46, 0x10000000, v27
    v_lshrrev_b32 v47, 14, v22
    v_bitop3_b32 v47, v47, v5, v46 bitop3:0xea
    ds_read_b64 v[100:101], v47
    v_bitop3_b32 v92, v22, v5, v46 bitop3:0xea
    s_waitcnt lgkmcnt(2)
    v_mfma_f32_4x4x4_16b_bf16 v[80:83], v[10:11], v[70:71], v[80:83]
    v_mfma_f32_4x4x4_16b_bf16 v[76:79], v[10:11], v[68:69], v[76:79]
    v_perm_b32 v15, v23, v26, s45
    v_bitop3_b32 v46, v23, 0.5, -0.5 bitop3:0xa8
    v_perm_b32 v14, v22, v26, s44
    v_bitop3_b32 v47, v22, 0.5, -0.5 bitop3:0xa8
    v_cvt_pk_bf16_f32 v80, v80, v81
    v_cvt_pk_bf16_f32 v81, v82, v83
    ds_wrxchg_rtn_b64 v[74:75], v95, v[80:81] offset:65408
    v_cvt_pk_bf16_f32 v76, v76, v77
    v_cvt_pk_bf16_f32 v77, v78, v79
    ds_wrxchg_rtn_b64 v[72:73], v94, v[76:77] offset:65408
    s_waitcnt lgkmcnt(2)
    v_mfma_f32_4x4x4_16b_bf16 v[80:83], v[8:9], v[102:103], 0
    v_mfma_f32_4x4x4_16b_bf16 v[76:79], v[8:9], v[100:101], 0
    v_bitop3_b32 v15, v6, v15, v46 bitop3:0xca
    v_bitop3_b32 v14, v6, v14, v47 bitop3:0xca
    v_cmp_lt_u32 s[84:85], v5, v92
    s_nop 0
    v_pk_mul_f32 v[80:81], v[80:81], v[14:15] op_sel:[0,1] op_sel_hi:[1,1]
    v_pk_mul_f32 v[82:83], v[82:83], v[14:15] op_sel:[0,1] op_sel_hi:[1,1]
    v_pk_mul_f32 v[76:77], v[76:77], v[14:15] op_sel:[0,0] op_sel_hi:[1,0]
    v_pk_mul_f32 v[78:79], v[78:79], v[14:15] op_sel:[0,0] op_sel_hi:[1,0]
    s_waitcnt lgkmcnt(0)
    v_cmp_ne_u64 s[50:51], v[72:73], v[68:69]
    v_cmpx_ne_u64 s[54:55], v[74:75], v[70:71]
    s_and_b64 s[82:83], s[54:55], s[80:81]
    s_cbranch_scc1 L2_c71
L2_d71:
    v_mov_b64 v[84:85], v[70:71]
    v_mov_b32 v7, v95
    v_mov_b64 v[86:87], v[74:75]
    s_or_b64 s[80:81], s[80:81], s[54:55]
    s_mov_b64 exec, s[50:51]
    s_and_b64 s[82:83], s[50:51], s[80:81]
    s_cbranch_scc1 L2_c72
L2_d72:
    v_mov_b64 v[84:85], v[68:69]
    v_mov_b32 v7, v94
    v_mov_b64 v[86:87], v[72:73]
    s_mov_b64 exec, -1
    s_or_b64 s[80:81], s[80:81], s[50:51]
    ds_read_b64 v[70:71], v93 offset:65408
    s_and_b64 exec, s[84:85], s[80:81]
    v_mfma_f32_4x4x4_16b_bf16 v[76:79], v[12:13], v[84:85], 0
    v_mov_b32 v92, v7
    s_andn2_b64 s[80:81], s[80:81], s[84:85]
    v_mfma_f32_4x4x4_16b_bf16 v[76:79], v[10:11], v[86:87], v[76:79]
    s_mov_b64 exec, -1
    ds_read_b64 v[68:69], v92 offset:65408
    v_and_b32 v46, 0x80000000, v27
    v_lshrrev_b32 v47, 14, v25
    v_bitop3_b32 v47, v47, v5, v46 bitop3:0xea
    ds_read_b64 v[106:107], v47
    v_bitop3_b32 v95, v25, v5, v46 bitop3:0xea
    v_and_b32 v46, 0x40000000, v27
    v_lshrrev_b32 v47, 14, v24
    v_bitop3_b32 v47, v47, v5, v46 bitop3:0xea
    ds_read_b64 v[104:105], v47
    v_bitop3_b32 v94, v24, v5, v46 bitop3:0xea
    s_waitcnt lgkmcnt(2)
    v_mfma_f32_4x4x4_16b_bf16 v[80:83], v[10:11], v[70:71], v[80:83]
    v_mfma_f32_4x4x4_16b_bf16 v[76:79], v[10:11], v[68:69], v[76:79]
    v_perm_b32 v15, v25, v26, s47
    v_bitop3_b32 v46, v25, 0.5, -0.5 bitop3:0xa8
    v_perm_b32 v14, v24, v26, s46
    v_bitop3_b32 v47, v24, 0.5, -0.5 bitop3:0xa8
    v_cvt_pk_bf16_f32 v80, v80, v81
    v_cvt_pk_bf16_f32 v81, v82, v83
    ds_wrxchg_rtn_b64 v[74:75], v93, v[80:81] offset:65408
    v_cvt_pk_bf16_f32 v76, v76, v77
    v_cvt_pk_bf16_f32 v77, v78, v79
    ds_wrxchg_rtn_b64 v[72:73], v92, v[76:77] offset:65408
    v_and_b32 v88, 0x0fffffff, v41
    v_mov_b32 v27, v41
    buffer_load_dwordx2 v[22:23], v88, s[8:11], 0 offen
    buffer_load_dwordx3 v[24:26], v88, s[8:11], 0 offen offset:8
    s_setprio 1
    s_waitcnt lgkmcnt(2)
    v_mfma_f32_4x4x4_16b_bf16 v[80:83], v[8:9], v[106:107], 0
    v_mfma_f32_4x4x4_16b_bf16 v[76:79], v[8:9], v[104:105], 0
    v_bitop3_b32 v15, v6, v15, v46 bitop3:0xca
    v_bitop3_b32 v14, v6, v14, v47 bitop3:0xca
    s_nop 1
    v_pk_mul_f32 v[80:81], v[80:81], v[14:15] op_sel:[0,1] op_sel_hi:[1,1]
    v_pk_mul_f32 v[82:83], v[82:83], v[14:15] op_sel:[0,1] op_sel_hi:[1,1]
    v_pk_mul_f32 v[76:77], v[76:77], v[14:15] op_sel:[0,0] op_sel_hi:[1,0]
    v_pk_mul_f32 v[78:79], v[78:79], v[14:15] op_sel:[0,0] op_sel_hi:[1,0]
    s_waitcnt lgkmcnt(0)
    v_cmp_ne_u64 s[50:51], v[72:73], v[68:69]
    v_cmpx_ne_u64 s[54:55], v[74:75], v[70:71]
    s_and_b64 s[82:83], s[54:55], s[80:81]
    s_cbranch_scc1 L2_c73
L2_d73:
    v_mov_b64 v[84:85], v[70:71]
    v_mov_b32 v7, v93
    v_mov_b64 v[86:87], v[74:75]
    s_or_b64 s[80:81], s[80:81], s[54:55]
    s_mov_b64 exec, s[50:51]
    s_and_b64 s[82:83], s[50:51], s[80:81]
    s_cbranch_scc1 L2_c74
L2_d74:
    v_mov_b64 v[84:85], v[68:69]
    v_mov_b32 v7, v92
    v_mov_b64 v[86:87], v[72:73]
    s_mov_b64 exec, -1
    s_or_b64 s[80:81], s[80:81], s[50:51]
    ds_read_b64 v[70:71], v95 offset:65408
    ds_read_b64 v[68:69], v94 offset:65408
    s_waitcnt vmcnt(11)
    v_and_b32 v46, 0x20000000, v33
    v_lshrrev_b32 v47, 14, v29
    v_bitop3_b32 v47, v47, v5, v46 bitop3:0xea
    ds_read_b64 v[102:103], v47
    v_bitop3_b32 v93, v29, v5, v46 bitop3:0xea
    v_and_b32 v46, 0x10000000, v33
    v_lshrrev_b32 v47, 14, v28
    v_bitop3_b32 v47, v47, v5, v46 bitop3:0xea
    ds_read_b64 v[100:101], v47
    v_bitop3_b32 v92, v28, v5, v46 bitop3:0xea
    s_waitcnt lgkmcnt(2)
    v_mfma_f32_4x4x4_16b_bf16 v[80:83], v[10:11], v[70:71], v[80:83]
    v_mfma_f32_4x4x4_16b_bf16 v[76:79], v[10:11], v[68:69], v[76:79]
    v_perm_b32 v15, v29, v32, s45
    v_bitop3_b32 v46, v29, 0.5, -0.5 bitop3:0xa8
    v_perm_b32 v14, v28, v32, s44
    v_bitop3_b32 v47, v28, 0.5, -0.5 bitop3:0xa8
    v_cvt_pk_bf16_f32 v80, v80, v81
    v_cvt_pk_bf16_f32 v81, v82, v83
    ds_wrxchg_rtn_b64 v[74:75], v95, v[80:81] offset:65408
    v_cvt_pk_bf16_f32 v76, v76, v77
    v_cvt_pk_bf16_f32 v77, v78, v79
    ds_wrxchg_rtn_b64 v[72:73], v94, v[76:77] offset:65408
    s_waitcnt lgkmcnt(2)
    v_mfma_f32_4x4x4_16b_bf16 v[80:83], v[8:9], v[102:103], 0
    v_mfma_f32_4x4x4_16b_bf16 v[76:79], v[8:9], v[100:101], 0
    v_bitop3_b32 v15, v6, v15, v46 bitop3:0xca
    v_bitop3_b32 v14, v6, v14, v47 bitop3:0xca
    v_cmp_lt_u32 s[84:85], v5, v92
    s_nop 0
    v_pk_mul_f32 v[80:81], v[80:81], v[14:15] op_sel:[0,1] op_sel_hi:[1,1]
    v_pk_mul_f32 v[82:83], v[82:83], v[14:15] op_sel:[0,1] op_sel_hi:[1,1]
    v_pk_mul_f32 v[76:77], v[76:77], v[14:15] op_sel:[0,0] op_sel_hi:[1,0]
    v_pk_mul_f32 v[78:79], v[78:79], v[14:15] op_sel:[0,0] op_sel_hi:[1,0]
    s_waitcnt lgkmcnt(0)
    v_cmp_ne_u64 s[50:51], v[72:73], v[68:69]
    v_cmpx_ne_u64 s[54:55], v[74:75], v[70:71]
    s_and_b64 s[82:83], s[54:55], s[80:81]
    s_cbranch_scc1 L2_c75
L2_d75:
    v_mov_b64 v[84:85], v[70:71]
    v_mov_b32 v7, v95
    v_mov_b64 v[86:87], v[74:75]
    s_or_b64 s[80:81], s[80:81], s[54:55]
    s_mov_b64 exec, s[50:51]
    s_and_b64 s[82:83], s[50:51], s[80:81]
    s_cbranch_scc1 L2_c76
L2_d76:
    v_mov_b64 v[84:85], v[68:69]
    v_mov_b32 v7, v94
    v_mov_b64 v[86:87], v[72:73]
    s_mov_b64 exec, -1
    s_or_b64 s[80:81], s[80:81], s[50:51]
    ds_read_b64 v[70:71], v93 offset:65408
    s_and_b64 exec, s[84:85], s[80:81]
    v_mfma_f32_4x4x4_16b_bf16 v[76:79], v[12:13], v[84:85], 0
    v_mov_b32 v92, v7
    s_andn2_b64 s[80:81], s[80:81], s[84:85]
    v_mfma_f32_4x4x4_16b_bf16 v[76:79], v[10:11], v[86:87], v[76:79]
    s_mov_b64 exec, -1
    ds_read_b64 v[68:69], v92 offset:65408
    v_and_b32 v46, 0x80000000, v33
    v_lshrrev_b32 v47, 14, v31
    v_bitop3_b32 v47, v47, v5, v46 bitop3:0xea
    ds_read_b64 v[106:107], v47
    v_bitop3_b32 v95, v31, v5, v46 bitop3:0xea
    v_and_b32 v46, 0x40000000, v33
    v_lshrrev_b32 v47, 14, v30
    v_bitop3_b32 v47, v47, v5, v46 bitop3:0xea
    ds_read_b64 v[104:105], v47
    v_bitop3_b32 v94, v30, v5, v46 bitop3:0xea
    s_waitcnt lgkmcnt(2)
    v_mfma_f32_4x4x4_16b_bf16 v[80:83], v[10:11], v[70:71], v[80:83]
    v_mfma_f32_4x4x4_16b_bf16 v[76:79], v[10:11], v[68:69], v[76:79]
    v_perm_b32 v15, v31, v32, s47
    v_bitop3_b32 v46, v31, 0.5, -0.5 bitop3:0xa8
    v_perm_b32 v14, v30, v32, s46
    v_bitop3_b32 v47, v30, 0.5, -0.5 bitop3:0xa8
    v_cvt_pk_bf16_f32 v80, v80, v81
    v_cvt_pk_bf16_f32 v81, v82, v83
    ds_wrxchg_rtn_b64 v[74:75], v93, v[80:81] offset:65408
    v_cvt_pk_bf16_f32 v76, v76, v77
    v_cvt_pk_bf16_f32 v77, v78, v79
    ds_wrxchg_rtn_b64 v[72:73], v92, v[76:77] offset:65408
    v_and_b32 v88, 0x0fffffff, v42
    v_mov_b32 v33, v42
    buffer_load_dwordx2 v[28:29], v88, s[8:11], 0 offen
    buffer_load_dwordx3 v[30:32], v88, s[8:11], 0 offen offset:8
    s_setprio 0
    s_waitcnt lgkmcnt(2)
    v_mfma_f32_4x4x4_16b_bf16 v[80:83], v[8:9], v[106:107], 0
    v_mfma_f32_4x4x4_16b_bf16 v[76:79], v[8:9], v[104:105], 0
    v_bitop3_b32 v15, v6, v15, v46 bitop3:0xca
    v_bitop3_b32 v14, v6, v14, v47 bitop3:0xca
    s_nop 1
    v_pk_mul_f32 v[80:81], v[80:81], v[14:15] op_sel:[0,1] op_sel_hi:[1,1]
    v_pk_mul_f32 v[82:83], v[82:83], v[14:15] op_sel:[0,1] op_sel_hi:[1,1]
    v_pk_mul_f32 v[76:77], v[76:77], v[14:15] op_sel:[0,0] op_sel_hi:[1,0]
    v_pk_mul_f32 v[78:79], v[78:79], v[14:15] op_sel:[0,0] op_sel_hi:[1,0]
    s_add_u32 s40, s40, 0x50000
    s_waitcnt lgkmcnt(0)
    v_cmp_ne_u64 s[50:51], v[72:73], v[68:69]
    v_cmpx_ne_u64 s[54:55], v[74:75], v[70:71]
    s_and_b64 s[82:83], s[54:55], s[80:81]
    s_cbranch_scc1 L2_c77
L2_d77:
    v_mov_b64 v[84:85], v[70:71]
    v_mov_b32 v7, v93
    v_mov_b64 v[86:87], v[74:75]
    s_or_b64 s[80:81], s[80:81], s[54:55]
    s_mov_b64 exec, s[50:51]
    s_and_b64 s[82:83], s[50:51], s[80:81]
    s_cbranch_scc1 L2_c78
L2_d78:
    v_mov_b64 v[84:85], v[68:69]
    v_mov_b32 v7, v92
    v_mov_b64 v[86:87], v[72:73]
    s_mov_b64 exec, -1
    s_or_b64 s[80:81], s[80:81], s[50:51]
    ds_read_b64 v[70:71], v95 offset:65408
    ds_read_b64 v[68:69], v94 offset:65408
    s_waitcnt vmcnt(8)
    v_and_b32 v46, 0x20000000, v39
    v_lshrrev_b32 v47, 14, v35
    v_bitop3_b32 v47, v47, v5, v46 bitop3:0xea
    ds_read_b64 v[102:103], v47
    v_bitop3_b32 v93, v35, v5, v46 bitop3:0xea
    v_and_b32 v46, 0x10000000, v39
    v_lshrrev_b32 v47, 14, v34
    v_bitop3_b32 v47, v47, v5, v46 bitop3:0xea
    ds_read_b64 v[100:101], v47
    v_bitop3_b32 v92, v34, v5, v46 bitop3:0xea
    v_and_b32 v46, 0x80000000, v39
    v_lshrrev_b32 v47, 14, v37
    v_bitop3_b32 v47, v47, v5, v46 bitop3:0xea
    ds_read_b64 v[106:107], v47
    v_and_b32 v46, 0x40000000, v39
    v_lshrrev_b32 v47, 14, v36
    v_bitop3_b32 v47, v47, v5, v46 bitop3:0xea
    ds_read_b64 v[104:105], v47
    s_waitcnt lgkmcnt(4)
    v_mfma_f32_4x4x4_16b_bf16 v[80:83], v[10:11], v[70:71], v[80:83]
    v_mfma_f32_4x4x4_16b_bf16 v[76:79], v[10:11], v[68:69], v[76:79]
    v_perm_b32 v15, v35, v38, s45
    v_bitop3_b32 v46, v35, 0.5, -0.5 bitop3:0xa8
    v_perm_b32 v14, v34, v38, s44
    v_bitop3_b32 v47, v34, 0.5, -0.5 bitop3:0xa8
    v_cvt_pk_bf16_f32 v80, v80, v81
    v_cvt_pk_bf16_f32 v81, v82, v83
    ds_wrxchg_rtn_b64 v[74:75], v95, v[80:81] offset:65408
    v_cvt_pk_bf16_f32 v76, v76, v77
    v_cvt_pk_bf16_f32 v77, v78, v79
    ds_wrxchg_rtn_b64 v[72:73], v94, v[76:77] offset:65408
    s_waitcnt lgkmcnt(2)
    s_barrier
    s_setprio 3
    s_mov_b32 m0, s100
    s_nop 0
    ds_write_addtid_b32 v116 offset:32768
    ds_write_addtid_b32 v117 offset:33024
    ds_write_addtid_b32 v118 offset:33280
    ds_write_addtid_b32 v119 offset:33536
    buffer_load_dwordx4 v[116:119], v3, s[16:19], s40 offen offset:2048
    ds_write_addtid_b32 v120 offset:33792
    ds_write_addtid_b32 v121 offset:34048
    ds_write_addtid_b32 v122 offset:34304
    ds_write_addtid_b32 v123 offset:34560
    buffer_load_dwordx4 v[120:123], v3, s[16:19], s40 offen offset:3072
    v_mfma_f32_4x4x4_16b_bf16 v[80:83], v[8:9], v[102:103], 0
    v_mfma_f32_4x4x4_16b_bf16 v[76:79], v[8:9], v[100:101], 0
    v_bitop3_b32 v15, v6, v15, v46 bitop3:0xca
    v_bitop3_b32 v14, v6, v14, v47 bitop3:0xca
    v_cmp_lt_u32 s[84:85], v5, v92
    s_nop 0
    v_pk_mul_f32 v[80:81], v[80:81], v[14:15] op_sel:[0,1] op_sel_hi:[1,1]
    v_pk_mul_f32 v[82:83], v[82:83], v[14:15] op_sel:[0,1] op_sel_hi:[1,1]
    v_pk_mul_f32 v[76:77], v[76:77], v[14:15] op_sel:[0,0] op_sel_hi:[1,0]
    v_pk_mul_f32 v[78:79], v[78:79], v[14:15] op_sel:[0,0] op_sel_hi:[1,0]
    v_mov_b32 v44, v43
    s_cmp_gt_u32 s37, 1024
    s_cbranch_scc1 L2_xs79
    s_cmp_lg_u32 s101, 0
    s_cbranch_scc1 L2_xa79
L2_xb79:
    v_lshlrev_b32 v89, 16, v96
    v_add_u32 v90, 60, v97
    v_bitop3_b32 v90, v89, v45, v90 bitop3:0x6a
    ds_write_b32 v98, v90 offset:12
    v_lshlrev_b32 v89, 20, v96
    v_add_u32 v90, 40, v97
    v_bitop3_b32 v90, v89, v45, v90 bitop3:0x6a
    ds_write_b32 v98, v90 offset:8
    v_lshlrev_b32 v89, 24, v96
    v_add_u32 v90, 20, v97
    v_bitop3_b32 v90, v89, v45, v90 bitop3:0x6a
    ds_write_b32 v98, v90 offset:4
    v_lshlrev_b32 v89, 28, v96
    v_bitop3_b32 v90, v89, v45, v97 bitop3:0x6a
    ds_write_b32 v98, v90 offset:0
    v_mov_b32_dpp v91, v66 quad_perm:[0,0,0,0] row_mask:0xf bank_mask:0xf
    v_and_b32 v89, 3, v91
    v_and_b32 v97, 0xfffc, v91
    v_sub_u16_dpp v88, v66, v91 quad_perm:[2,2,2,2] row_mask:0xf bank_mask:0xf
    v_mad_u32_u24 v97, v97, 5, v4
    v_add_u32 v99, v88, v89
    v_bfm_b32 v96, v88, v89
    v_cmp_lt_u32 s[58:59], 16, v99
    v_lshlrev_b32 v89, v1, v96
    v_and_b32 v89, v45, v89
    v_cmp_ne_u32 vcc, 0, v89
    v_xor_b32 v90, v97, v89
    s_add_u32 s3, s37, s38
    v_mbcnt_lo_u32_b32 v98, vcc_lo, 0
    v_mbcnt_hi_u32_b32 v98, vcc_hi, v98
    s_bcnt1_i32_b64 s41, vcc
    v_lshl_add_u32 v98, v98, 2, s3
    s_mov_b64 exec, vcc
    ds_write_b32 v98, v90
    s_mov_b64 exec, -1
    s_lshl2_add_u32 s37, s41, s37
    s_cmp_lg_u64 s[58:59], 0
    s_cbranch_scc1 L2_xe79
L2_xr79:
    v_add_u32 v98, s37, v0
    v_mov_b32 v90, -1
    ds_write_b32 v98, v90
    ds_read2st64_b32 v[40:41], v0 offset0:0 offset1:1
    ds_read2st64_b32 v[42:43], v0 offset0:2 offset1:3
    s_sub_u32 s3, s37, 768
    s_cmp_gt_u32 s3, 256
    s_cbranch_scc1 L2_xf79
L2_xg79:
    s_setprio 2
    ds_write_addtid_b32 v124 offset:34816
    ds_write_addtid_b32 v125 offset:35072
    ds_write_addtid_b32 v126 offset:35328
    ds_write_addtid_b32 v127 offset:35584
    s_add_u32 s3, s40, 4096
    buffer_load_dwordx4 v[124:127], v3, s[16:19], s3 offen
    s_waitcnt lgkmcnt(14)
    v_cmp_ne_u64 s[50:51], v[72:73], v[68:69]
    v_cmpx_ne_u64 s[54:55], v[74:75], v[70:71]
    s_and_b64 s[82:83], s[54:55], s[80:81]
    s_cbranch_scc1 L2_c80
L2_d80:
    v_mov_b64 v[84:85], v[70:71]
    v_mov_b32 v7, v95
    v_mov_b64 v[86:87], v[74:75]
    s_or_b64 s[80:81], s[80:81], s[54:55]
    s_mov_b64 exec, s[50:51]
    s_and_b64 s[82:83], s[50:51], s[80:81]
    s_cbranch_scc1 L2_c81
L2_d81:
    v_mov_b64 v[84:85], v[68:69]
    v_mov_b32 v7, v94
    v_mov_b64 v[86:87], v[72:73]
    s_mov_b64 exec, -1
    s_or_b64 s[80:81], s[80:81], s[50:51]
    ds_read_b64 v[70:71], v93 offset:65408
    s_and_b64 exec, s[84:85], s[80:81]
    v_mfma_f32_4x4x4_16b_bf16 v[76:79], v[12:13], v[84:85], 0
    v_mov_b32 v92, v7
    s_andn2_b64 s[80:81], s[80:81], s[84:85]
    v_mfma_f32_4x4x4_16b_bf16 v[76:79], v[10:11], v[86:87], v[76:79]
    s_mov_b64 exec, -1
    ds_read_b64 v[68:69], v92 offset:65408
    s_setprio 1
    s_waitcnt vmcnt(10)
    s_mov_b32 m0, s38
    s_nop 0
    ds_write_addtid_b32 v108 offset:0
    ds_write_addtid_b32 v109 offset:256
    ds_write_addtid_b32 v110 offset:512
    ds_write_addtid_b32 v111 offset:768
    s_waitcnt lgkmcnt(4)
    v_mfma_f32_4x4x4_16b_bf16 v[80:83], v[10:11], v[70:71], v[80:83]
    v_mfma_f32_4x4x4_16b_bf16 v[76:79], v[10:11], v[68:69], v[76:79]
    v_and_b32 v46, 0x40000000, v39
    v_bitop3_b32 v94, v36, v5, v46 bitop3:0xea
    v_and_b32 v46, 0x80000000, v39
    v_bitop3_b32 v95, v37, v5, v46 bitop3:0xea
    v_perm_b32 v15, v37, v38, s47
    v_bitop3_b32 v46, v37, 0.5, -0.5 bitop3:0xa8
    v_perm_b32 v14, v36, v38, s46
    v_bitop3_b32 v47, v36, 0.5, -0.5 bitop3:0xa8
    v_cvt_pk_bf16_f32 v80, v80, v81
    v_cvt_pk_bf16_f32 v81, v82, v83
    ds_wrxchg_rtn_b64 v[74:75], v93, v[80:81] offset:65408
    v_cvt_pk_bf16_f32 v76, v76, v77
    v_cvt_pk_bf16_f32 v77, v78, v79
    ds_wrxchg_rtn_b64 v[72:73], v92, v[76:77] offset:65408
    v_and_b32 v88, 0x0fffffff, v44
    v_mov_b32 v39, v44
    buffer_load_dwordx2 v[34:35], v88, s[8:11], 0 offen
    buffer_load_dwordx3 v[36:38], v88, s[8:11], 0 offen offset:8
    s_setprio 0
    s_waitcnt vmcnt(11)
    ds_write_addtid_b32 v112 offset:1024
    ds_write_addtid_b32 v113 offset:1280
    ds_write_addtid_b32 v114 offset:1536
    ds_write_addtid_b32 v115 offset:1792
    v_mfma_f32_4x4x4_16b_bf16 v[80:83], v[8:9], v[106:107], 0
    v_mfma_f32_4x4x4_16b_bf16 v[76:79], v[8:9], v[104:105], 0
    v_bitop3_b32 v15, v6, v15, v46 bitop3:0xca
    v_bitop3_b32 v14, v6, v14, v47 bitop3:0xca
    s_nop 1
    v_pk_mul_f32 v[80:81], v[80:81], v[14:15] op_sel:[0,1] op_sel_hi:[1,1]
    v_pk_mul_f32 v[82:83], v[82:83], v[14:15] op_sel:[0,1] op_sel_hi:[1,1]
    v_pk_mul_f32 v[76:77], v[76:77], v[14:15] op_sel:[0,0] op_sel_hi:[1,0]
    v_pk_mul_f32 v[78:79], v[78:79], v[14:15] op_sel:[0,0] op_sel_hi:[1,0]
    s_add_u32 s42, s42, 1
    s_waitcnt lgkmcnt(0)
    s_barrier
    s_bitcmp1_b32 s36, s42
    s_cbranch_scc1 L2_slow
L2_ret4:
    s_setprio 3
    buffer_load_dwordx4 v[108:111], v3, s[16:19], s40 offen offset:0
    v_cmp_ne_u64 s[50:51], v[72:73], v[68:69]
    v_cmpx_ne_u64 s[54:55], v[74:75], v[70:71]
    s_and_b64 s[82:83], s[54:55], s[80:81]
    s_cbranch_scc1 L2_c82
L2_d82:
    v_mov_b64 v[84:85], v[70:71]
    v_mov_b32 v7, v93
    v_mov_b64 v[86:87], v[74:75]
    s_or_b64 s[80:81], s[80:81], s[54:55]
    s_mov_b64 exec, s[50:51]
    s_and_b64 s[82:83], s[50:51], s[80:81]
    s_cbranch_scc1 L2_c83
L2_d83:
    v_mov_b64 v[84:85], v[68:69]
    v_mov_b32 v7, v92
    v_mov_b64 v[86:87], v[72:73]
    s_mov_b64 exec, -1
    s_or_b64 s[80:81], s[80:81], s[50:51]
    ds_read_b64 v[70:71], v95 offset:65408
    ds_read_b64 v[68:69], v94 offset:65408
    s_waitcnt vmcnt(10)
    v_and_b32 v46, 0x20000000, v21
    v_lshrrev_b32 v47, 14, v17
    v_bitop3_b32 v47, v47, v5, v46 bitop3:0xea
    ds_read_b64 v[102:103], v47
    v_bitop3_b32 v93, v17, v5, v46 bitop3:0xea
    v_and_b32 v46, 0x10000000, v21
    v_lshrrev_b32 v47, 14, v16
    v_bitop3_b32 v47, v47, v5, v46 bitop3:0xea
    ds_read_b64 v[100:101], v47
    v_bitop3_b32 v92, v16, v5, v46 bitop3:0xea
    s_waitcnt lgkmcnt(2)
    v_mfma_f32_4x4x4_16b_bf16 v[80:83], v[10:11], v[70:71], v[80:83]
    v_mfma_f32_4x4x4_16b_bf16 v[76:79], v[10:11], v[68:69], v[76:79]
    v_perm_b32 v15, v17, v20, s45
    v_bitop3_b32 v46, v17, 0.5, -0.5 bitop3:0xa8
    v_perm_b32 v14, v16, v20, s44
    v_bitop3_b32 v47, v16, 0.5, -0.5 bitop3:0xa8
    v_cvt_pk_bf16_f32 v80, v80, v81
    v_cvt_pk_bf16_f32 v81, v82, v83
    ds_wrxchg_rtn_b64 v[74:75], v95, v[80:81] offset:65408
    v_cvt_pk_bf16_f32 v76, v76, v77
    v_cvt_pk_bf16_f32 v77, v78, v79
    ds_wrxchg_rtn_b64 v[72:73], v94, v[76:77] offset:65408
    s_waitcnt lgkmcnt(2)
    v_mfma_f32_4x4x4_16b_bf16 v[80:83], v[8:9], v[102:103], 0
    v_mfma_f32_4x4x4_16b_bf16 v[76:79], v[8:9], v[100:101], 0
    v_bitop3_b32 v15, v6, v15, v46 bitop3:0xca
    v_bitop3_b32 v14, v6, v14, v47 bitop3:0xca
    v_cmp_lt_u32 s[84:85], v5, v92
    s_nop 0
    v_pk_mul_f32 v[80:81], v[80:81], v[14:15] op_sel:[0,1] op_sel_hi:[1,1]
    v_pk_mul_f32 v[82:83], v[82:83], v[14:15] op_sel:[0,1] op_sel_hi:[1,1]
    v_pk_mul_f32 v[76:77], v[76:77], v[14:15] op_sel:[0,0] op_sel_hi:[1,0]
    v_pk_mul_f32 v[78:79], v[78:79], v[14:15] op_sel:[0,0] op_sel_hi:[1,0]
    buffer_load_dwordx4 v[112:115], v3, s[16:19], s40 offen offset:1024
    s_waitcnt lgkmcnt(0)
    v_cmp_ne_u64 s[50:51], v[72:73], v[68:69]
    v_cmpx_ne_u64 s[54:55], v[74:75], v[70:71]
    s_and_b64 s[82:83], s[54:55], s[80:81]
    s_cbranch_scc1 L2_c84
L2_d84:
    v_mov_b64 v[84:85], v[70:71]
    v_mov_b32 v7, v95
    v_mov_b64 v[86:87], v[74:75]
    s_or_b64 s[80:81], s[80:81], s[54:55]
    s_mov_b64 exec, s[50:51]
    s_and_b64 s[82:83], s[50:51], s[80:81]
    s_cbranch_scc1 L2_c85
L2_d85:
    v_mov_b64 v[84:85], v[68:69]
    v_mov_b32 v7, v94
    v_mov_b64 v[86:87], v[72:73]
    s_mov_b64 exec, -1
    s_or_b64 s[80:81], s[80:81], s[50:51]
    ds_read_b64 v[70:71], v93 offset:65408
    s_and_b64 exec, s[84:85], s[80:81]
    v_mfma_f32_4x4x4_16b_bf16 v[76:79], v[12:13], v[84:85], 0
    v_mov_b32 v92, v7
    s_andn2_b64 s[80:81], s[80:81], s[84:85]
    v_mfma_f32_4x4x4_16b_bf16 v[76:79], v[10:11], v[86:87], v[76:79]
    s_mov_b64 exec, -1
    ds_read_b64 v[68:69], v92 offset:65408
    v_and_b32 v46, 0x80000000, v21
    v_lshrrev_b32 v47, 14, v19
    v_bitop3_b32 v47, v47, v5, v46 bitop3:0xea
    ds_read_b64 v[106:107], v47
    v_bitop3_b32 v95, v19, v5, v46 bitop3:0xea
    v_and_b32 v46, 0x40000000, v21
    v_lshrrev_b32 v47, 14, v18
    v_bitop3_b32 v47, v47, v5, v46 bitop3:0xea
    ds_read_b64 v[104:105], v47
    v_bitop3_b32 v94, v18, v5, v46 bitop3:0xea
    s_waitcnt lgkmcnt(2)
    v_mfma_f32_4x4x4_16b_bf16 v[80:83], v[10:11], v[70:71], v[80:83]
    v_mfma_f32_4x4x4_16b_bf16 v[76:79], v[10:11], v[68:69], v[76:79]
    v_perm_b32 v15, v19, v20, s47
    v_bitop3_b32 v46, v19, 0.5, -0.5 bitop3:0xa8
    v_perm_b32 v14, v18, v20, s46
    v_bitop3_b32 v47, v18, 0.5, -0.5 bitop3:0xa8
    v_cvt_pk_bf16_f32 v80, v80, v81
    v_cvt_pk_bf16_f32 v81, v82, v83
    ds_wrxchg_rtn_b64 v[74:75], v93, v[80:81] offset:65408
    v_cvt_pk_bf16_f32 v76, v76, v77
    v_cvt_pk_bf16_f32 v77, v78, v79
    ds_wrxchg_rtn_b64 v[72:73], v92, v[76:77] offset:65408
    v_and_b32 v88, 0x0fffffff, v40
    v_mov_b32 v21, v40
    buffer_load_dwordx2 v[16:17], v88, s[8:11], 0 offen
    buffer_load_dwordx3 v[18:20], v88, s[8:11], 0 offen offset:8
    s_setprio 2
    s_waitcnt lgkmcnt(2)
    v_mfma_f32_4x4x4_16b_bf16 v[80:83], v[8:9], v[106:107], 0
    v_mfma_f32_4x4x4_16b_bf16 v[76:79], v[8:9], v[104:105], 0
    v_bitop3_b32 v15, v6, v15, v46 bitop3:0xca
    v_bitop3_b32 v14, v6, v14, v47 bitop3:0xca
    s_nop 1
    v_pk_mul_f32 v[80:81], v[80:81], v[14:15] op_sel:[0,1] op_sel_hi:[1,1]
    v_pk_mul_f32 v[82:83], v[82:83], v[14:15] op_sel:[0,1] op_sel_hi:[1,1]
    v_pk_mul_f32 v[76:77], v[76:77], v[14:15] op_sel:[0,0] op_sel_hi:[1,0]
    v_pk_mul_f32 v[78:79], v[78:79], v[14:15] op_sel:[0,0] op_sel_hi:[1,0]
    v_sub_u16 v88, v60, v52
    v_and_b32 v89, 3, v52
    v_add3_u32 v99, v88, v89, 3
    v_and_b32 v99, -4, v99
    v_max_u32 v99, 4, v99
    v_and_b32 v97, 0xfffc, v52
    v_bfm_b32 v96, v88, v89
    v_add_u32_dpp v91, v99, v99 row_shr:1 row_mask:0xf bank_mask:0xf bound_ctrl:1
    v_mad_u32_u24 v97, v97, 5, v2
    v_cmp_lt_u32 vcc, 16, v99
    v_add_u32_dpp v91, v91, v91 row_shr:2 row_mask:0xf bank_mask:0xf bound_ctrl:1
    v_sub_u32 v98, s38, v99
    v_lshrrev_b64 v[52:53], 16, v[52:53]
    v_add_u32_dpp v91, v91, v91 row_shr:4 row_mask:0xf bank_mask:0xf bound_ctrl:1
    v_lshrrev_b64 v[60:61], 16, v[60:61]
    s_mov_b32 s101, 0
    v_add_u32_dpp v91, v91, v91 row_shr:8 row_mask:0xf bank_mask:0xf bound_ctrl:1
    s_nop 1
    v_add_u32_dpp v91, v91, v91 row_bcast:15 row_mask:0xa bank_mask:0xf
    s_nop 1
    v_add_u32_dpp v91, v91, v91 row_bcast:31 row_mask:0xc bank_mask:0xf
    v_add_u32 v98, v98, v91
    v_readlane_b32 s37, v91, 63
    s_cbranch_vccnz L2_xo86
L2_xp86:
    s_waitcnt lgkmcnt(0)
    v_cmp_ne_u64 s[50:51], v[72:73], v[68:69]
    v_cmpx_ne_u64 s[54:55], v[74:75], v[70:71]
    s_and_b64 s[82:83], s[54:55], s[80:81]
    s_cbranch_scc1 L2_c87
L2_d87:
    v_mov_b64 v[84:85], v[70:71]
    v_mov_b32 v7, v93
    v_mov_b64 v[86:87], v[74:75]
    s_or_b64 s[80:81], s[80:81], s[54:55]
    s_mov_b64 exec, s[50:51]
    s_and_b64 s[82:83], s[50:51], s[80:81]
    s_cbranch_scc1 L2_c88
L2_d88:
    v_mov_b64 v[84:85], v[68:69]
    v_mov_b32 v7, v92
    v_mov_b64 v[86:87], v[72:73]
    s_mov_b64 exec, -1
    s_or_b64 s[80:81], s[80:81], s[50:51]
    ds_read_b64 v[70:71], v95 offset:65408
    ds_read_b64 v[68:69], v94 offset:65408
    s_waitcnt vmcnt(11)
    v_and_b32 v46, 0x20000000, v27
    v_lshrrev_b32 v47, 14, v23
    v_bitop3_b32 v47, v47, v5, v46 bitop3:0xea
    ds_read_b64 v[102:103], v47
    v_bitop3_b32 v93, v23, v5, v46 bitop3:0xea
    v_and_b32 v46, 0x10000000, v27
    v_lshrrev_b32 v47, 14, v22
    v_bitop3_b32 v47, v47, v5, v46 bitop3:0xea
    ds_read_b64 v[100:101], v47
    v_bitop3_b32 v92, v22, v5, v46 bitop3:0xea
    s_waitcnt lgkmcnt(2)
    v_mfma_f32_4x4x4_16b_bf16 v[80:83], v[10:11], v[70:71], v[80:83]
    v_mfma_f32_4x4x4_16b_bf16 v[76:79], v[10:11], v[68:69], v[76:79]
    v_perm_b32 v15, v23, v26, s45
    v_bitop3_b32 v46, v23, 0.5, -0.5 bitop3:0xa8
    v_perm_b32 v14, v22, v26, s44
    v_bitop3_b32 v47, v22, 0.5, -0.5 bitop3:0xa8
    v_cvt_pk_bf16_f32 v80, v80, v81
    v_cvt_pk_bf16_f32 v81, v82, v83
    ds_wrxchg_rtn_b64 v[74:75], v95, v[80:81] offset:65408
    v_cvt_pk_bf16_f32 v76, v76, v77
    v_cvt_pk_bf16_f32 v77, v78, v79
    ds_wrxchg_rtn_b64 v[72:73], v94, v[76:77] offset:65408
    s_waitcnt lgkmcnt(2)
    v_mfma_f32_4x4x4_16b_bf16 v[80:83], v[8:9], v[102:103], 0
    v_mfma_f32_4x4x4_16b_bf16 v[76:79], v[8:9], v[100:101], 0
    v_bitop3_b32 v15, v6, v15, v46 bitop3:0xca
    v_bitop3_b32 v14, v6, v14, v47 bitop3:0xca
    v_cmp_lt_u32 s[84:85], v5, v92
    s_nop 0
    v_pk_mul_f32 v[80:81], v[80:81], v[14:15] op_sel:[0,1] op_sel_hi:[1,1]
    v_pk_mul_f32 v[82:83], v[82:83], v[14:15] op_sel:[0,1] op_sel_hi:[1,1]
    v_pk_mul_f32 v[76:77], v[76:77], v[14:15] op_sel:[0,0] op_sel_hi:[1,0]
    v_pk_mul_f32 v[78:79], v[78:79], v[14:15] op_sel:[0,0] op_sel_hi:[1,0]
    s_waitcnt lgkmcnt(0)
    v_cmp_ne_u64 s[50:51], v[72:73], v[68:69]
    v_cmpx_ne_u64 s[54:55], v[74:75], v[70:71]
    s_and_b64 s[82:83], s[54:55], s[80:81]
    s_cbranch_scc1 L2_c89
L2_d89:
    v_mov_b64 v[84:85], v[70:71]
    v_mov_b32 v7, v95
    v_mov_b64 v[86:87], v[74:75]
    s_or_b64 s[80:81], s[80:81], s[54:55]
    s_mov_b64 exec, s[50:51]
    s_and_b64 s[82:83], s[50:51], s[80:81]
    s_cbranch_scc1 L2_c90
L2_d90:
    v_mov_b64 v[84:85], v[68:69]
    v_mov_b32 v7, v94
    v_mov_b64 v[86:87], v[72:73]
    s_mov_b64 exec, -1
    s_or_b64 s[80:81], s[80:81], s[50:51]
    ds_read_b64 v[70:71], v93 offset:65408
    s_and_b64 exec, s[84:85], s[80:81]
    v_mfma_f32_4x4x4_16b_bf16 v[76:79], v[12:13], v[84:85], 0
    v_mov_b32 v92, v7
    s_andn2_b64 s[80:81], s[80:81], s[84:85]
    v_mfma_f32_4x4x4_16b_bf16 v[76:79], v[10:11], v[86:87], v[76:79]
    s_mov_b64 exec, -1
    ds_read_b64 v[68:69], v92 offset:65408
    v_and_b32 v46, 0x80000000, v27
    v_lshrrev_b32 v47, 14, v25
    v_bitop3_b32 v47, v47, v5, v46 bitop3:0xea
    ds_read_b64 v[106:107], v47
    v_bitop3_b32 v95, v25, v5, v46 bitop3:0xea
    v_and_b32 v46, 0x40000000, v27
    v_lshrrev_b32 v47, 14, v24
    v_bitop3_b32 v47, v47, v5, v46 bitop3:0xea
    ds_read_b64 v[104:105], v47
    v_bitop3_b32 v94, v24, v5, v46 bitop3:0xea
    s_waitcnt lgkmcnt(2)
    v_mfma_f32_4x4x4_16b_bf16 v[80:83], v[10:11], v[70:71], v[80:83]
    v_mfma_f32_4x4x4_16b_bf16 v[76:79], v[10:11], v[68:69], v[76:79]
    v_perm_b32 v15, v25, v26, s47
    v_bitop3_b32 v46, v25, 0.5, -0.5 bitop3:0xa8
    v_perm_b32 v14, v24, v26, s46
    v_bitop3_b32 v47, v24, 0.5, -0.5 bitop3:0xa8
    v_cvt_pk_bf16_f32 v80, v80, v81
    v_cvt_pk_bf16_f32 v81, v82, v83
    ds_wrxchg_rtn_b64 v[74:75], v93, v[80:81] offset:65408
    v_cvt_pk_bf16_f32 v76, v76, v77
    v_cvt_pk_bf16_f32 v77, v78, v79
    ds_wrxchg_rtn_b64 v[72:73], v92, v[76:77] offset:65408
    v_and_b32 v88, 0x0fffffff, v41
    v_mov_b32 v27, v41
    buffer_load_dwordx2 v[22:23], v88, s[8:11], 0 offen
    buffer_load_dwordx3 v[24:26], v88, s[8:11], 0 offen offset:8
    s_setprio 1
    s_waitcnt lgkmcnt(2)
    v_mfma_f32_4x4x4_16b_bf16 v[80:83], v[8:9], v[106:107], 0
    v_mfma_f32_4x4x4_16b_bf16 v[76:79], v[8:9], v[104:105], 0
    v_bitop3_b32 v15, v6, v15, v46 bitop3:0xca
    v_bitop3_b32 v14, v6, v14, v47 bitop3:0xca
    s_nop 1
    v_pk_mul_f32 v[80:81], v[80:81], v[14:15] op_sel:[0,1] op_sel_hi:[1,1]
    v_pk_mul_f32 v[82:83], v[82:83], v[14:15] op_sel:[0,1] op_sel_hi:[1,1]
    v_pk_mul_f32 v[76:77], v[76:77], v[14:15] op_sel:[0,0] op_sel_hi:[1,0]
    v_pk_mul_f32 v[78:79], v[78:79], v[14:15] op_sel:[0,0] op_sel_hi:[1,0]
    s_waitcnt lgkmcnt(0)
    v_cmp_ne_u64 s[50:51], v[72:73], v[68:69]
    v_cmpx_ne_u64 s[54:55], v[74:75], v[70:71]
    s_and_b64 s[82:83], s[54:55], s[80:81]
    s_cbranch_scc1 L2_c91
L2_d91:
    v_mov_b64 v[84:85], v[70:71]
    v_mov_b32 v7, v93
    v_mov_b64 v[86:87], v[74:75]
    s_or_b64 s[80:81], s[80:81], s[54:55]
    s_mov_b64 exec, s[50:51]
    s_and_b64 s[82:83], s[50:51], s[80:81]
    s_cbranch_scc1 L2_c92
L2_d92:
    v_mov_b64 v[84:85], v[68:69]
    v_mov_b32 v7, v92
    v_mov_b64 v[86:87], v[72:73]
    s_mov_b64 exec, -1
    s_or_b64 s[80:81], s[80:81], s[50:51]
    ds_read_b64 v[70:71], v95 offset:65408
    ds_read_b64 v[68:69], v94 offset:65408
    s_waitcnt vmcnt(11)
    v_and_b32 v46, 0x20000000, v33
    v_lshrrev_b32 v47, 14, v29
    v_bitop3_b32 v47, v47, v5, v46 bitop3:0xea
    ds_read_b64 v[102:103], v47
    v_bitop3_b32 v93, v29, v5, v46 bitop3:0xea
    v_and_b32 v46, 0x10000000, v33
    v_lshrrev_b32 v47, 14, v28
    v_bitop3_b32 v47, v47, v5, v46 bitop3:0xea
    ds_read_b64 v[100:101], v47
    v_bitop3_b32 v92, v28, v5, v46 bitop3:0xea
    s_waitcnt lgkmcnt(2)
    v_mfma_f32_4x4x4_16b_bf16 v[80:83], v[10:11], v[70:71], v[80:83]
    v_mfma_f32_4x4x4_16b_bf16 v[76:79], v[10:11], v[68:69], v[76:79]
    v_perm_b32 v15, v29, v32, s45
    v_bitop3_b32 v46, v29, 0.5, -0.5 bitop3:0xa8
    v_perm_b32 v14, v28, v32, s44
    v_bitop3_b32 v47, v28, 0.5, -0.5 bitop3:0xa8
    v_cvt_pk_bf16_f32 v80, v80, v81
    v_cvt_pk_bf16_f32 v81, v82, v83
    ds_wrxchg_rtn_b64 v[74:75], v95, v[80:81] offset:65408
    v_cvt_pk_bf16_f32 v76, v76, v77
    v_cvt_pk_bf16_f32 v77, v78, v79
    ds_wrxchg_rtn_b64 v[72:73], v94, v[76:77] offset:65408
    s_waitcnt lgkmcnt(2)
    v_mfma_f32_4x4x4_16b_bf16 v[80:83], v[8:9], v[102:103], 0
    v_mfma_f32_4x4x4_16b_bf16 v[76:79], v[8:9], v[100:101], 0
    v_bitop3_b32 v15, v6, v15, v46 bitop3:0xca
    v_bitop3_b32 v14, v6, v14, v47 bitop3:0xca
    v_cmp_lt_u32 s[84:85], v5, v92
    s_nop 0
    v_pk_mul_f32 v[80:81], v[80:81], v[14:15] op_sel:[0,1] op_sel_hi:[1,1]
    v_pk_mul_f32 v[82:83], v[82:83], v[14:15] op_sel:[0,1] op_sel_hi:[1,1]
    v_pk_mul_f32 v[76:77], v[76:77], v[14:15] op_sel:[0,0] op_sel_hi:[1,0]
    v_pk_mul_f32 v[78:79], v[78:79], v[14:15] op_sel:[0,0] op_sel_hi:[1,0]
    s_waitcnt lgkmcnt(0)
    v_cmp_ne_u64 s[50:51], v[72:73], v[68:69]
    v_cmpx_ne_u64 s[54:55], v[74:75], v[70:71]
    s_and_b64 s[82:83], s[54:55], s[80:81]
    s_cbranch_scc1 L2_c93
L2_d93:
    v_mov_b64 v[84:85], v[70:71]
    v_mov_b32 v7, v95
    v_mov_b64 v[86:87], v[74:75]
    s_or_b64 s[80:81], s[80:81], s[54:55]
    s_mov_b64 exec, s[50:51]
    s_and_b64 s[82:83], s[50:51], s[80:81]
    s_cbranch_scc1 L2_c94
L2_d94:
    v_mov_b64 v[84:85], v[68:69]
    v_mov_b32 v7, v94
    v_mov_b64 v[86:87], v[72:73]
    s_mov_b64 exec, -1
    s_or_b64 s[80:81], s[80:81], s[50:51]
    ds_read_b64 v[70:71], v93 offset:65408
    s_and_b64 exec, s[84:85], s[80:81]
    v_mfma_f32_4x4x4_16b_bf16 v[76:79], v[12:13], v[84:85], 0
    v_mov_b32 v92, v7
    s_andn2_b64 s[80:81], s[80:81], s[84:85]
    v_mfma_f32_4x4x4_16b_bf16 v[76:79], v[10:11], v[86:87], v[76:79]
    s_mov_b64 exec, -1
    ds_read_b64 v[68:69], v92 offset:65408
    v_and_b32 v46, 0x80000000, v33
    v_lshrrev_b32 v47, 14, v31
    v_bitop3_b32 v47, v47, v5, v46 bitop3:0xea
    ds_read_b64 v[106:107], v47
    v_bitop3_b32 v95, v31, v5, v46 bitop3:0xea
    v_and_b32 v46, 0x40000000, v33
    v_lshrrev_b32 v47, 14, v30
    v_bitop3_b32 v47, v47, v5, v46 bitop3:0xea
    ds_read_b64 v[104:105], v47
    v_bitop3_b32 v94, v30, v5, v46 bitop3:0xea
    s_waitcnt lgkmcnt(2)
    v_mfma_f32_4x4x4_16b_bf16 v[80:83], v[10:11], v[70:71], v[80:83]
    v_mfma_f32_4x4x4_16b_bf16 v[76:79], v[10:11], v[68:69], v[76:79]
    v_perm_b32 v15, v31, v32, s47
    v_bitop3_b32 v46, v31, 0.5, -0.5 bitop3:0xa8
    v_perm_b32 v14, v30, v32, s46
    v_bitop3_b32 v47, v30, 0.5, -0.5 bitop3:0xa8
    v_cvt_pk_bf16_f32 v80, v80, v81
    v_cvt_pk_bf16_f32 v81, v82, v83
    ds_wrxchg_rtn_b64 v[74:75], v93, v[80:81] offset:65408
    v_cvt_pk_bf16_f32 v76, v76, v77
    v_cvt_pk_bf16_f32 v77, v78, v79
    ds_wrxchg_rtn_b64 v[72:73], v92, v[76:77] offset:65408
    v_and_b32 v88, 0x0fffffff, v42
    v_mov_b32 v33, v42
    buffer_load_dwordx2 v[28:29], v88, s[8:11], 0 offen
    buffer_load_dwordx3 v[30:32], v88, s[8:11], 0 offen offset:8
    s_setprio 0
    s_waitcnt lgkmcnt(2)
    v_mfma_f32_4x4x4_16b_bf16 v[80:83], v[8:9], v[106:107], 0
    v_mfma_f32_4x4x4_16b_bf16 v[76:79], v[8:9], v[104:105], 0
    v_bitop3_b32 v15, v6, v15, v46 bitop3:0xca
    v_bitop3_b32 v14, v6, v14, v47 bitop3:0xca
    s_nop 1
    v_pk_mul_f32 v[80:81], v[80:81], v[14:15] op_sel:[0,1] op_sel_hi:[1,1]
    v_pk_mul_f32 v[82:83], v[82:83], v[14:15] op_sel:[0,1] op_sel_hi:[1,1]
    v_pk_mul_f32 v[76:77], v[76:77], v[14:15] op_sel:[0,0] op_sel_hi:[1,0]
    v_pk_mul_f32 v[78:79], v[78:79], v[14:15] op_sel:[0,0] op_sel_hi:[1,0]
    s_add_u32 s40, s40, 0x50000
    s_waitcnt lgkmcnt(0)
    v_cmp_ne_u64 s[50:51], v[72:73], v[68:69]
    v_cmpx_ne_u64 s[54:55], v[74:75], v[70:71]
    s_and_b64 s[82:83], s[54:55], s[80:81]
    s_cbranch_scc1 L2_c95
L2_d95:
    v_mov_b64 v[84:85], v[70:71]
    v_mov_b32 v7, v93
    v_mov_b64 v[86:87], v[74:75]
    s_or_b64 s[80:81], s[80:81], s[54:55]
    s_mov_b64 exec, s[50:51]
    s_and_b64 s[82:83], s[50:51], s[80:81]
    s_cbranch_scc1 L2_c96
L2_d96:
    v_mov_b64 v[84:85], v[68:69]
    v_mov_b32 v7, v92
    v_mov_b64 v[86:87], v[72:73]
    s_mov_b64 exec, -1
    s_or_b64 s[80:81], s[80:81], s[50:51]
    ds_read_b64 v[70:71], v95 offset:65408
    ds_read_b64 v[68:69], v94 offset:65408
    s_waitcnt vmcnt(8)
    v_and_b32 v46, 0x20000000, v39
    v_lshrrev_b32 v47, 14, v35
    v_bitop3_b32 v47, v47, v5, v46 bitop3:0xea
    ds_read_b64 v[102:103], v47
    v_bitop3_b32 v93, v35, v5, v46 bitop3:0xea
    v_and_b32 v46, 0x10000000, v39
    v_lshrrev_b32 v47, 14, v34
    v_bitop3_b32 v47, v47, v5, v46 bitop3:0xea
    ds_read_b64 v[100:101], v47
    v_bitop3_b32 v92, v34, v5, v46 bitop3:0xea
    v_and_b32 v46, 0x80000000, v39
    v_lshrrev_b32 v47, 14, v37
    v_bitop3_b32 v47, v47, v5, v46 bitop3:0xea
    ds_read_b64 v[106:107], v47
    v_and_b32 v46, 0x40000000, v39
    v_lshrrev_b32 v47, 14, v36
    v_bitop3_b32 v47, v47, v5, v46 bitop3:0xea
    ds_read_b64 v[104:105], v47
    s_waitcnt lgkmcnt(4)
    v_mfma_f32_4x4x4_16b_bf16 v[80:83], v[10:11], v[70:71], v[80:83]
    v_mfma_f32_4x4x4_16b_bf16 v[76:79], v[10:11], v[68:69], v[76:79]
    v_perm_b32 v15, v35, v38, s45
    v_bitop3_b32 v46, v35, 0.5, -0.5 bitop3:0xa8
    v_perm_b32 v14, v34, v38, s44
    v_bitop3_b32 v47, v34, 0.5, -0.5 bitop3:0xa8
    v_cvt_pk_bf16_f32 v80, v80, v81
    v_cvt_pk_bf16_f32 v81, v82, v83
    ds_wrxchg_rtn_b64 v[74:75], v95, v[80:81] offset:65408
    v_cvt_pk_bf16_f32 v76, v76, v77
    v_cvt_pk_bf16_f32 v77, v78, v79
    ds_wrxchg_rtn_b64 v[72:73], v94, v[76:77] offset:65408
    s_waitcnt lgkmcnt(2)
    s_barrier
    s_setprio 3
    s_mov_b32 m0, s100
    s_nop 0
    ds_write_addtid_b32 v116 offset:32768
    ds_write_addtid_b32 v117 offset:33024
    ds_write_addtid_b32 v118 offset:33280
    ds_write_addtid_b32 v119 offset:33536
    buffer_load_dwordx4 v[116:119], v3, s[16:19], s40 offen offset:2048
    ds_write_addtid_b32 v120 offset:33792
    ds_write_addtid_b32 v121 offset:34048
    ds_write_addtid_b32 v122 offset:34304
    ds_write_addtid_b32 v123 offset:34560
    buffer_load_dwordx4 v[120:123], v3, s[16:19], s40 offen offset:3072
    v_mfma_f32_4x4x4_16b_bf16 v[80:83], v[8:9], v[102:103], 0
    v_mfma_f32_4x4x4_16b_bf16 v[76:79], v[8:9], v[100:101], 0
    v_bitop3_b32 v15, v6, v15, v46 bitop3:0xca
    v_bitop3_b32 v14, v6, v14, v47 bitop3:0xca
    v_cmp_lt_u32 s[84:85], v5, v92
    s_nop 0
    v_pk_mul_f32 v[80:81], v[80:81], v[14:15] op_sel:[0,1] op_sel_hi:[1,1]
    v_pk_mul_f32 v[82:83], v[82:83], v[14:15] op_sel:[0,1] op_sel_hi:[1,1]
    v_pk_mul_f32 v[76:77], v[76:77], v[14:15] op_sel:[0,0] op_sel_hi:[1,0]
    v_pk_mul_f32 v[78:79], v[78:79], v[14:15] op_sel:[0,0] op_sel_hi:[1,0]
    v_mov_b32 v44, v43
    s_cmp_gt_u32 s37, 1024
    s_cbranch_scc1 L2_xs97
    s_cmp_lg_u32 s101, 0
    s_cbranch_scc1 L2_xa97
L2_xb97:
    v_lshlrev_b32 v89, 16, v96
    v_add_u32 v90, 60, v97
    v_bitop3_b32 v90, v89, v45, v90 bitop3:0x6a
    ds_write_b32 v98, v90 offset:12
    v_lshlrev_b32 v89, 20, v96
    v_add_u32 v90, 40, v97
    v_bitop3_b32 v90, v89, v45, v90 bitop3:0x6a
    ds_write_b32 v98, v90 offset:8
    v_lshlrev_b32 v89, 24, v96
    v_add_u32 v90, 20, v97
    v_bitop3_b32 v90, v89, v45, v90 bitop3:0x6a
    ds_write_b32 v98, v90 offset:4
    v_lshlrev_b32 v89, 28, v96
    v_bitop3_b32 v90, v89, v45, v97 bitop3:0x6a
    ds_write_b32 v98, v90 offset:0
    v_mov_b32_dpp v91, v64 quad_perm:[1,1,1,1] row_mask:0xf bank_mask:0xf
    v_and_b32 v89, 3, v91
    v_and_b32 v97, 0xfffc, v91
    v_sub_u16_dpp v88, v64, v91 quad_perm:[3,3,3,3] row_mask:0xf bank_mask:0xf
    v_mad_u32_u24 v97, v97, 5, v4
    v_add_u32 v99, v88, v89
    v_bfm_b32 v96, v88, v89
    v_cmp_lt_u32 s[58:59], 16, v99
    v_lshlrev_b32 v89, v1, v96
    v_and_b32 v89, v45, v89
    v_cmp_ne_u32 vcc, 0, v89
    v_xor_b32 v90, v97, v89
    s_add_u32 s3, s37, s38
    v_mbcnt_lo_u32_b32 v98, vcc_lo, 0
    v_mbcnt_hi_u32_b32 v98, vcc_hi, v98
    s_bcnt1_i32_b64 s41, vcc
    v_lshl_add_u32 v98, v98, 2, s3
    s_mov_b64 exec, vcc
    ds_write_b32 v98, v90
    s_mov_b64 exec, -1
    s_lshl2_add_u32 s37, s41, s37
    s_cmp_lg_u64 s[58:59], 0
    s_cbranch_scc1 L2_xe97
L2_xr97:
    v_add_u32 v98, s37, v0
    v_mov_b32 v90, -1
    ds_write_b32 v98, v90
    ds_read2st64_b32 v[40:41], v0 offset0:0 offset1:1
    ds_read2st64_b32 v[42:43], v0 offset0:2 offset1:3
    s_sub_u32 s3, s37, 768
    s_cmp_gt_u32 s3, 256
    s_cbranch_scc1 L2_xf97
L2_xg97:
    s_setprio 2
    ds_write_addtid_b32 v124 offset:34816
    ds_write_addtid_b32 v125 offset:35072
    ds_write_addtid_b32 v126 offset:35328
    ds_write_addtid_b32 v127 offset:35584
    s_add_u32 s3, s40, 4096
    buffer_load_dwordx4 v[124:127], v3, s[16:19], s3 offen
    s_waitcnt lgkmcnt(14)
    v_cmp_ne_u64 s[50:51], v[72:73], v[68:69]
    v_cmpx_ne_u64 s[54:55], v[74:75], v[70:71]
    s_and_b64 s[82:83], s[54:55], s[80:81]
    s_cbranch_scc1 L2_c98
L2_d98:
    v_mov_b64 v[84:85], v[70:71]
    v_mov_b32 v7, v95
    v_mov_b64 v[86:87], v[74:75]
    s_or_b64 s[80:81], s[80:81], s[54:55]
    s_mov_b64 exec, s[50:51]
    s_and_b64 s[82:83], s[50:51], s[80:81]
    s_cbranch_scc1 L2_c99
L2_d99:
    v_mov_b64 v[84:85], v[68:69]
    v_mov_b32 v7, v94
    v_mov_b64 v[86:87], v[72:73]
    s_mov_b64 exec, -1
    s_or_b64 s[80:81], s[80:81], s[50:51]
    ds_read_b64 v[70:71], v93 offset:65408
    s_and_b64 exec, s[84:85], s[80:81]
    v_mfma_f32_4x4x4_16b_bf16 v[76:79], v[12:13], v[84:85], 0
    v_mov_b32 v92, v7
    s_andn2_b64 s[80:81], s[80:81], s[84:85]
    v_mfma_f32_4x4x4_16b_bf16 v[76:79], v[10:11], v[86:87], v[76:79]
    s_mov_b64 exec, -1
    ds_read_b64 v[68:69], v92 offset:65408
    s_setprio 1
    s_waitcnt vmcnt(10)
    s_mov_b32 m0, s38
    s_nop 0
    ds_write_addtid_b32 v108 offset:0
    ds_write_addtid_b32 v109 offset:256
    ds_write_addtid_b32 v110 offset:512
    ds_write_addtid_b32 v111 offset:768
    s_waitcnt lgkmcnt(4)
    v_mfma_f32_4x4x4_16b_bf16 v[80:83], v[10:11], v[70:71], v[80:83]
    v_mfma_f32_4x4x4_16b_bf16 v[76:79], v[10:11], v[68:69], v[76:79]
    v_and_b32 v46, 0x40000000, v39
    v_bitop3_b32 v94, v36, v5, v46 bitop3:0xea
    v_and_b32 v46, 0x80000000, v39
    v_bitop3_b32 v95, v37, v5, v46 bitop3:0xea
    v_perm_b32 v15, v37, v38, s47
    v_bitop3_b32 v46, v37, 0.5, -0.5 bitop3:0xa8
    v_perm_b32 v14, v36, v38, s46
    v_bitop3_b32 v47, v36, 0.5, -0.5 bitop3:0xa8
    v_cvt_pk_bf16_f32 v80, v80, v81
    v_cvt_pk_bf16_f32 v81, v82, v83
    ds_wrxchg_rtn_b64 v[74:75], v93, v[80:81] offset:65408
    v_cvt_pk_bf16_f32 v76, v76, v77
    v_cvt_pk_bf16_f32 v77, v78, v79
    ds_wrxchg_rtn_b64 v[72:73], v92, v[76:77] offset:65408
    v_and_b32 v88, 0x0fffffff, v44
    v_mov_b32 v39, v44
    buffer_load_dwordx2 v[34:35], v88, s[8:11], 0 offen
    buffer_load_dwordx3 v[36:38], v88, s[8:11], 0 offen offset:8
    s_setprio 0
    s_waitcnt vmcnt(11)
    ds_write_addtid_b32 v112 offset:1024
    ds_write_addtid_b32 v113 offset:1280
    ds_write_addtid_b32 v114 offset:1536
    ds_write_addtid_b32 v115 offset:1792
    v_mfma_f32_4x4x4_16b_bf16 v[80:83], v[8:9], v[106:107], 0
    v_mfma_f32_4x4x4_16b_bf16 v[76:79], v[8:9], v[104:105], 0
    v_bitop3_b32 v15, v6, v15, v46 bitop3:0xca
    v_bitop3_b32 v14, v6, v14, v47 bitop3:0xca
    s_nop 1
    v_pk_mul_f32 v[80:81], v[80:81], v[14:15] op_sel:[0,1] op_sel_hi:[1,1]
    v_pk_mul_f32 v[82:83], v[82:83], v[14:15] op_sel:[0,1] op_sel_hi:[1,1]
    v_pk_mul_f32 v[76:77], v[76:77], v[14:15] op_sel:[0,0] op_sel_hi:[1,0]
    v_pk_mul_f32 v[78:79], v[78:79], v[14:15] op_sel:[0,0] op_sel_hi:[1,0]
    s_add_u32 s42, s42, 1
    s_waitcnt lgkmcnt(0)
    s_barrier
    s_bitcmp1_b32 s36, s42
    s_cbranch_scc1 L2_slow
L2_ret5:
    s_setprio 3
    buffer_load_dwordx4 v[108:111], v3, s[16:19], s40 offen offset:0
    v_cmp_ne_u64 s[50:51], v[72:73], v[68:69]
    v_cmpx_ne_u64 s[54:55], v[74:75], v[70:71]
    s_and_b64 s[82:83], s[54:55], s[80:81]
    s_cbranch_scc1 L2_c100
L2_d100:
    v_mov_b64 v[84:85], v[70:71]
    v_mov_b32 v7, v93
    v_mov_b64 v[86:87], v[74:75]
    s_or_b64 s[80:81], s[80:81], s[54:55]
    s_mov_b64 exec, s[50:51]
    s_and_b64 s[82:83], s[50:51], s[80:81]
    s_cbranch_scc1 L2_c101
L2_d101:
    v_mov_b64 v[84:85], v[68:69]
    v_mov_b32 v7, v92
    v_mov_b64 v[86:87], v[72:73]
    s_mov_b64 exec, -1
    s_or_b64 s[80:81], s[80:81], s[50:51]
    ds_read_b64 v[70:71], v95 offset:65408
    ds_read_b64 v[68:69], v94 offset:65408
    s_waitcnt vmcnt(10)
    v_and_b32 v46, 0x20000000, v21
    v_lshrrev_b32 v47, 14, v17
    v_bitop3_b32 v47, v47, v5, v46 bitop3:0xea
    ds_read_b64 v[102:103], v47
    v_bitop3_b32 v93, v17, v5, v46 bitop3:0xea
    v_and_b32 v46, 0x10000000, v21
    v_lshrrev_b32 v47, 14, v16
    v_bitop3_b32 v47, v47, v5, v46 bitop3:0xea
    ds_read_b64 v[100:101], v47
    v_bitop3_b32 v92, v16, v5, v46 bitop3:0xea
    s_waitcnt lgkmcnt(2)
    v_mfma_f32_4x4x4_16b_bf16 v[80:83], v[10:11], v[70:71], v[80:83]
    v_mfma_f32_4x4x4_16b_bf16 v[76:79], v[10:11], v[68:69], v[76:79]
    v_perm_b32 v15, v17, v20, s45
    v_bitop3_b32 v46, v17, 0.5, -0.5 bitop3:0xa8
    v_perm_b32 v14, v16, v20, s44
    v_bitop3_b32 v47, v16, 0.5, -0.5 bitop3:0xa8
    v_cvt_pk_bf16_f32 v80, v80, v81
    v_cvt_pk_bf16_f32 v81, v82, v83
    ds_wrxchg_rtn_b64 v[74:75], v95, v[80:81] offset:65408
    v_cvt_pk_bf16_f32 v76, v76, v77
    v_cvt_pk_bf16_f32 v77, v78, v79
    ds_wrxchg_rtn_b64 v[72:73], v94, v[76:77] offset:65408
    s_waitcnt lgkmcnt(2)
    v_mfma_f32_4x4x4_16b_bf16 v[80:83], v[8:9], v[102:103], 0
    v_mfma_f32_4x4x4_16b_bf16 v[76:79], v[8:9], v[100:101], 0
    v_bitop3_b32 v15, v6, v15, v46 bitop3:0xca
    v_bitop3_b32 v14, v6, v14, v47 bitop3:0xca
    v_cmp_lt_u32 s[84:85], v5, v92
    s_nop 0
    v_pk_mul_f32 v[80:81], v[80:81], v[14:15] op_sel:[0,1] op_sel_hi:[1,1]
    v_pk_mul_f32 v[82:83], v[82:83], v[14:15] op_sel:[0,1] op_sel_hi:[1,1]
    v_pk_mul_f32 v[76:77], v[76:77], v[14:15] op_sel:[0,0] op_sel_hi:[1,0]
    v_pk_mul_f32 v[78:79], v[78:79], v[14:15] op_sel:[0,0] op_sel_hi:[1,0]
    buffer_load_dwordx4 v[112:115], v3, s[16:19], s40 offen offset:1024
    s_waitcnt lgkmcnt(0)
    v_cmp_ne_u64 s[50:51], v[72:73], v[68:69]
    v_cmpx_ne_u64 s[54:55], v[74:75], v[70:71]
    s_and_b64 s[82:83], s[54:55], s[80:81]
    s_cbranch_scc1 L2_c102
L2_d102:
    v_mov_b64 v[84:85], v[70:71]
    v_mov_b32 v7, v95
    v_mov_b64 v[86:87], v[74:75]
    s_or_b64 s[80:81], s[80:81], s[54:55]
    s_mov_b64 exec, s[50:51]
    s_and_b64 s[82:83], s[50:51], s[80:81]
    s_cbranch_scc1 L2_c103
L2_d103:
    v_mov_b64 v[84:85], v[68:69]
    v_mov_b32 v7, v94
    v_mov_b64 v[86:87], v[72:73]
    s_mov_b64 exec, -1
    s_or_b64 s[80:81], s[80:81], s[50:51]
    ds_read_b64 v[70:71], v93 offset:65408
    s_and_b64 exec, s[84:85], s[80:81]
    v_mfma_f32_4x4x4_16b_bf16 v[76:79], v[12:13], v[84:85], 0
    v_mov_b32 v92, v7
    s_andn2_b64 s[80:81], s[80:81], s[84:85]
    v_mfma_f32_4x4x4_16b_bf16 v[76:79], v[10:11], v[86:87], v[76:79]
    s_mov_b64 exec, -1
    ds_read_b64 v[68:69], v92 offset:65408
    v_and_b32 v46, 0x80000000, v21
    v_lshrrev_b32 v47, 14, v19
    v_bitop3_b32 v47, v47, v5, v46 bitop3:0xea
    ds_read_b64 v[106:107], v47
    v_bitop3_b32 v95, v19, v5, v46 bitop3:0xea
    v_and_b32 v46, 0x40000000, v21
    v_lshrrev_b32 v47, 14, v18
    v_bitop3_b32 v47, v47, v5, v46 bitop3:0xea
    ds_read_b64 v[104:105], v47
    v_bitop3_b32 v94, v18, v5, v46 bitop3:0xea
    s_waitcnt lgkmcnt(2)
    v_mfma_f32_4x4x4_16b_bf16 v[80:83], v[10:11], v[70:71], v[80:83]
    v_mfma_f32_4x4x4_16b_bf16 v[76:79], v[10:11], v[68:69], v[76:79]
    v_perm_b32 v15, v19, v20, s47
    v_bitop3_b32 v46, v19, 0.5, -0.5 bitop3:0xa8
    v_perm_b32 v14, v18, v20, s46
    v_bitop3_b32 v47, v18, 0.5, -0.5 bitop3:0xa8
    v_cvt_pk_bf16_f32 v80, v80, v81
    v_cvt_pk_bf16_f32 v81, v82, v83
    ds_wrxchg_rtn_b64 v[74:75], v93, v[80:81] offset:65408
    v_cvt_pk_bf16_f32 v76, v76, v77
    v_cvt_pk_bf16_f32 v77, v78, v79
    ds_wrxchg_rtn_b64 v[72:73], v92, v[76:77] offset:65408
    v_and_b32 v88, 0x0fffffff, v40
    v_mov_b32 v21, v40
    buffer_load_dwordx2 v[16:17], v88, s[8:11], 0 offen
    buffer_load_dwordx3 v[18:20], v88, s[8:11], 0 offen offset:8
    s_setprio 2
    s_waitcnt lgkmcnt(2)
    v_mfma_f32_4x4x4_16b_bf16 v[80:83], v[8:9], v[106:107], 0
    v_mfma_f32_4x4x4_16b_bf16 v[76:79], v[8:9], v[104:105], 0
    v_bitop3_b32 v15, v6, v15, v46 bitop3:0xca
    v_bitop3_b32 v14, v6, v14, v47 bitop3:0xca
    s_nop 1
    v_pk_mul_f32 v[80:81], v[80:81], v[14:15] op_sel:[0,1] op_sel_hi:[1,1]
    v_pk_mul_f32 v[82:83], v[82:83], v[14:15] op_sel:[0,1] op_sel_hi:[1,1]
    v_pk_mul_f32 v[76:77], v[76:77], v[14:15] op_sel:[0,0] op_sel_hi:[1,0]
    v_pk_mul_f32 v[78:79], v[78:79], v[14:15] op_sel:[0,0] op_sel_hi:[1,0]
    v_sub_u16 v88, v62, v54
    v_and_b32 v89, 3, v54
    v_add3_u32 v99, v88, v89, 3
    v_and_b32 v99, -4, v99
    v_max_u32 v99, 4, v99
    v_and_b32 v97, 0xfffc, v54
    v_bfm_b32 v96, v88, v89
    v_add_u32_dpp v91, v99, v99 row_shr:1 row_mask:0xf bank_mask:0xf bound_ctrl:1
    v_mad_u32_u24 v97, v97, 5, v2
    v_cmp_lt_u32 vcc, 16, v99
    v_add_u32_dpp v91, v91, v91 row_shr:2 row_mask:0xf bank_mask:0xf bound_ctrl:1
    v_sub_u32 v98, s38, v99
    v_lshrrev_b64 v[54:55], 16, v[54:55]
    v_add_u32_dpp v91, v91, v91 row_shr:4 row_mask:0xf bank_mask:0xf bound_ctrl:1
    v_lshrrev_b64 v[62:63], 16, v[62:63]
    s_mov_b32 s101, 0
    v_add_u32_dpp v91, v91, v91 row_shr:8 row_mask:0xf bank_mask:0xf bound_ctrl:1
    s_nop 1
    v_add_u32_dpp v91, v91, v91 row_bcast:15 row_mask:0xa bank_mask:0xf
    s_nop 1
    v_add_u32_dpp v91, v91, v91 row_bcast:31 row_mask:0xc bank_mask:0xf
    v_add_u32 v98, v98, v91
    v_readlane_b32 s37, v91, 63
    s_cbranch_vccnz L2_xo104
L2_xp104:
    s_waitcnt lgkmcnt(0)
    v_cmp_ne_u64 s[50:51], v[72:73], v[68:69]
    v_cmpx_ne_u64 s[54:55], v[74:75], v[70:71]
    s_and_b64 s[82:83], s[54:55], s[80:81]
    s_cbranch_scc1 L2_c105
L2_d105:
    v_mov_b64 v[84:85], v[70:71]
    v_mov_b32 v7, v93
    v_mov_b64 v[86:87], v[74:75]
    s_or_b64 s[80:81], s[80:81], s[54:55]
    s_mov_b64 exec, s[50:51]
    s_and_b64 s[82:83], s[50:51], s[80:81]
    s_cbranch_scc1 L2_c106
L2_d106:
    v_mov_b64 v[84:85], v[68:69]
    v_mov_b32 v7, v92
    v_mov_b64 v[86:87], v[72:73]
    s_mov_b64 exec, -1
    s_or_b64 s[80:81], s[80:81], s[50:51]
    ds_read_b64 v[70:71], v95 offset:65408
    ds_read_b64 v[68:69], v94 offset:65408
    s_waitcnt vmcnt(11)
    v_and_b32 v46, 0x20000000, v27
    v_lshrrev_b32 v47, 14, v23
    v_bitop3_b32 v47, v47, v5, v46 bitop3:0xea
    ds_read_b64 v[102:103], v47
    v_bitop3_b32 v93, v23, v5, v46 bitop3:0xea
    v_and_b32 v46, 0x10000000, v27
    v_lshrrev_b32 v47, 14, v22
    v_bitop3_b32 v47, v47, v5, v46 bitop3:0xea
    ds_read_b64 v[100:101], v47
    v_bitop3_b32 v92, v22, v5, v46 bitop3:0xea
    s_waitcnt lgkmcnt(2)
    v_mfma_f32_4x4x4_16b_bf16 v[80:83], v[10:11], v[70:71], v[80:83]
    v_mfma_f32_4x4x4_16b_bf16 v[76:79], v[10:11], v[68:69], v[76:79]
    v_perm_b32 v15, v23, v26, s45
    v_bitop3_b32 v46, v23, 0.5, -0.5 bitop3:0xa8
    v_perm_b32 v14, v22, v26, s44
    v_bitop3_b32 v47, v22, 0.5, -0.5 bitop3:0xa8
    v_cvt_pk_bf16_f32 v80, v80, v81
    v_cvt_pk_bf16_f32 v81, v82, v83
    ds_wrxchg_rtn_b64 v[74:75], v95, v[80:81] offset:65408
    v_cvt_pk_bf16_f32 v76, v76, v77
    v_cvt_pk_bf16_f32 v77, v78, v79
    ds_wrxchg_rtn_b64 v[72:73], v94, v[76:77] offset:65408
    s_waitcnt lgkmcnt(2)
    v_mfma_f32_4x4x4_16b_bf16 v[80:83], v[8:9], v[102:103], 0
    v_mfma_f32_4x4x4_16b_bf16 v[76:79], v[8:9], v[100:101], 0
    v_bitop3_b32 v15, v6, v15, v46 bitop3:0xca
    v_bitop3_b32 v14, v6, v14, v47 bitop3:0xca
    v_cmp_lt_u32 s[84:85], v5, v92
    s_nop 0
    v_pk_mul_f32 v[80:81], v[80:81], v[14:15] op_sel:[0,1] op_sel_hi:[1,1]
    v_pk_mul_f32 v[82:83], v[82:83], v[14:15] op_sel:[0,1] op_sel_hi:[1,1]
    v_pk_mul_f32 v[76:77], v[76:77], v[14:15] op_sel:[0,0] op_sel_hi:[1,0]
    v_pk_mul_f32 v[78:79], v[78:79], v[14:15] op_sel:[0,0] op_sel_hi:[1,0]
    s_waitcnt lgkmcnt(0)
    v_cmp_ne_u64 s[50:51], v[72:73], v[68:69]
    v_cmpx_ne_u64 s[54:55], v[74:75], v[70:71]
    s_and_b64 s[82:83], s[54:55], s[80:81]
    s_cbranch_scc1 L2_c107
L2_d107:
    v_mov_b64 v[84:85], v[70:71]
    v_mov_b32 v7, v95
    v_mov_b64 v[86:87], v[74:75]
    s_or_b64 s[80:81], s[80:81], s[54:55]
    s_mov_b64 exec, s[50:51]
    s_and_b64 s[82:83], s[50:51], s[80:81]
    s_cbranch_scc1 L2_c108
L2_d108:
    v_mov_b64 v[84:85], v[68:69]
    v_mov_b32 v7, v94
    v_mov_b64 v[86:87], v[72:73]
    s_mov_b64 exec, -1
    s_or_b64 s[80:81], s[80:81], s[50:51]
    ds_read_b64 v[70:71], v93 offset:65408
    s_and_b64 exec, s[84:85], s[80:81]
    v_mfma_f32_4x4x4_16b_bf16 v[76:79], v[12:13], v[84:85], 0
    v_mov_b32 v92, v7
    s_andn2_b64 s[80:81], s[80:81], s[84:85]
    v_mfma_f32_4x4x4_16b_bf16 v[76:79], v[10:11], v[86:87], v[76:79]
    s_mov_b64 exec, -1
    ds_read_b64 v[68:69], v92 offset:65408
    v_and_b32 v46, 0x80000000, v27
    v_lshrrev_b32 v47, 14, v25
    v_bitop3_b32 v47, v47, v5, v46 bitop3:0xea
    ds_read_b64 v[106:107], v47
    v_bitop3_b32 v95, v25, v5, v46 bitop3:0xea
    v_and_b32 v46, 0x40000000, v27
    v_lshrrev_b32 v47, 14, v24
    v_bitop3_b32 v47, v47, v5, v46 bitop3:0xea
    ds_read_b64 v[104:105], v47
    v_bitop3_b32 v94, v24, v5, v46 bitop3:0xea
    s_waitcnt lgkmcnt(2)
    v_mfma_f32_4x4x4_16b_bf16 v[80:83], v[10:11], v[70:71], v[80:83]
    v_mfma_f32_4x4x4_16b_bf16 v[76:79], v[10:11], v[68:69], v[76:79]
    v_perm_b32 v15, v25, v26, s47
    v_bitop3_b32 v46, v25, 0.5, -0.5 bitop3:0xa8
    v_perm_b32 v14, v24, v26, s46
    v_bitop3_b32 v47, v24, 0.5, -0.5 bitop3:0xa8
    v_cvt_pk_bf16_f32 v80, v80, v81
    v_cvt_pk_bf16_f32 v81, v82, v83
    ds_wrxchg_rtn_b64 v[74:75], v93, v[80:81] offset:65408
    v_cvt_pk_bf16_f32 v76, v76, v77
    v_cvt_pk_bf16_f32 v77, v78, v79
    ds_wrxchg_rtn_b64 v[72:73], v92, v[76:77] offset:65408
    v_and_b32 v88, 0x0fffffff, v41
    v_mov_b32 v27, v41
    buffer_load_dwordx2 v[22:23], v88, s[8:11], 0 offen
    buffer_load_dwordx3 v[24:26], v88, s[8:11], 0 offen offset:8
    s_setprio 1
    s_waitcnt lgkmcnt(2)
    v_mfma_f32_4x4x4_16b_bf16 v[80:83], v[8:9], v[106:107], 0
    v_mfma_f32_4x4x4_16b_bf16 v[76:79], v[8:9], v[104:105], 0
    v_bitop3_b32 v15, v6, v15, v46 bitop3:0xca
    v_bitop3_b32 v14, v6, v14, v47 bitop3:0xca
    s_nop 1
    v_pk_mul_f32 v[80:81], v[80:81], v[14:15] op_sel:[0,1] op_sel_hi:[1,1]
    v_pk_mul_f32 v[82:83], v[82:83], v[14:15] op_sel:[0,1] op_sel_hi:[1,1]
    v_pk_mul_f32 v[76:77], v[76:77], v[14:15] op_sel:[0,0] op_sel_hi:[1,0]
    v_pk_mul_f32 v[78:79], v[78:79], v[14:15] op_sel:[0,0] op_sel_hi:[1,0]
    s_waitcnt lgkmcnt(0)
    v_cmp_ne_u64 s[50:51], v[72:73], v[68:69]
    v_cmpx_ne_u64 s[54:55], v[74:75], v[70:71]
    s_and_b64 s[82:83], s[54:55], s[80:81]
    s_cbranch_scc1 L2_c109
L2_d109:
    v_mov_b64 v[84:85], v[70:71]
    v_mov_b32 v7, v93
    v_mov_b64 v[86:87], v[74:75]
    s_or_b64 s[80:81], s[80:81], s[54:55]
    s_mov_b64 exec, s[50:51]
    s_and_b64 s[82:83], s[50:51], s[80:81]
    s_cbranch_scc1 L2_c110
L2_d110:
    v_mov_b64 v[84:85], v[68:69]
    v_mov_b32 v7, v92
    v_mov_b64 v[86:87], v[72:73]
    s_mov_b64 exec, -1
    s_or_b64 s[80:81], s[80:81], s[50:51]
    ds_read_b64 v[70:71], v95 offset:65408
    ds_read_b64 v[68:69], v94 offset:65408
    s_waitcnt vmcnt(11)
    v_and_b32 v46, 0x20000000, v33
    v_lshrrev_b32 v47, 14, v29
    v_bitop3_b32 v47, v47, v5, v46 bitop3:0xea
    ds_read_b64 v[102:103], v47
    v_bitop3_b32 v93, v29, v5, v46 bitop3:0xea
    v_and_b32 v46, 0x10000000, v33
    v_lshrrev_b32 v47, 14, v28
    v_bitop3_b32 v47, v47, v5, v46 bitop3:0xea
    ds_read_b64 v[100:101], v47
    v_bitop3_b32 v92, v28, v5, v46 bitop3:0xea
    s_waitcnt lgkmcnt(2)
    v_mfma_f32_4x4x4_16b_bf16 v[80:83], v[10:11], v[70:71], v[80:83]
    v_mfma_f32_4x4x4_16b_bf16 v[76:79], v[10:11], v[68:69], v[76:79]
    v_perm_b32 v15, v29, v32, s45
    v_bitop3_b32 v46, v29, 0.5, -0.5 bitop3:0xa8
    v_perm_b32 v14, v28, v32, s44
    v_bitop3_b32 v47, v28, 0.5, -0.5 bitop3:0xa8
    v_cvt_pk_bf16_f32 v80, v80, v81
    v_cvt_pk_bf16_f32 v81, v82, v83
    ds_wrxchg_rtn_b64 v[74:75], v95, v[80:81] offset:65408
    v_cvt_pk_bf16_f32 v76, v76, v77
    v_cvt_pk_bf16_f32 v77, v78, v79
    ds_wrxchg_rtn_b64 v[72:73], v94, v[76:77] offset:65408
    s_waitcnt lgkmcnt(2)
    v_mfma_f32_4x4x4_16b_bf16 v[80:83], v[8:9], v[102:103], 0
    v_mfma_f32_4x4x4_16b_bf16 v[76:79], v[8:9], v[100:101], 0
    v_bitop3_b32 v15, v6, v15, v46 bitop3:0xca
    v_bitop3_b32 v14, v6, v14, v47 bitop3:0xca
    v_cmp_lt_u32 s[84:85], v5, v92
    s_nop 0
    v_pk_mul_f32 v[80:81], v[80:81], v[14:15] op_sel:[0,1] op_sel_hi:[1,1]
    v_pk_mul_f32 v[82:83], v[82:83], v[14:15] op_sel:[0,1] op_sel_hi:[1,1]
    v_pk_mul_f32 v[76:77], v[76:77], v[14:15] op_sel:[0,0] op_sel_hi:[1,0]
    v_pk_mul_f32 v[78:79], v[78:79], v[14:15] op_sel:[0,0] op_sel_hi:[1,0]
    s_waitcnt lgkmcnt(0)
    v_cmp_ne_u64 s[50:51], v[72:73], v[68:69]
    v_cmpx_ne_u64 s[54:55], v[74:75], v[70:71]
    s_and_b64 s[82:83], s[54:55], s[80:81]
    s_cbranch_scc1 L2_c111
L2_d111:
    v_mov_b64 v[84:85], v[70:71]
    v_mov_b32 v7, v95
    v_mov_b64 v[86:87], v[74:75]
    s_or_b64 s[80:81], s[80:81], s[54:55]
    s_mov_b64 exec, s[50:51]
    s_and_b64 s[82:83], s[50:51], s[80:81]
    s_cbranch_scc1 L2_c112
L2_d112:
    v_mov_b64 v[84:85], v[68:69]
    v_mov_b32 v7, v94
    v_mov_b64 v[86:87], v[72:73]
    s_mov_b64 exec, -1
    s_or_b64 s[80:81], s[80:81], s[50:51]
    ds_read_b64 v[70:71], v93 offset:65408
    s_and_b64 exec, s[84:85], s[80:81]
    v_mfma_f32_4x4x4_16b_bf16 v[76:79], v[12:13], v[84:85], 0
    v_mov_b32 v92, v7
    s_andn2_b64 s[80:81], s[80:81], s[84:85]
    v_mfma_f32_4x4x4_16b_bf16 v[76:79], v[10:11], v[86:87], v[76:79]
    s_mov_b64 exec, -1
    ds_read_b64 v[68:69], v92 offset:65408
    v_and_b32 v46, 0x80000000, v33
    v_lshrrev_b32 v47, 14, v31
    v_bitop3_b32 v47, v47, v5, v46 bitop3:0xea
    ds_read_b64 v[106:107], v47
    v_bitop3_b32 v95, v31, v5, v46 bitop3:0xea
    v_and_b32 v46, 0x40000000, v33
    v_lshrrev_b32 v47, 14, v30
    v_bitop3_b32 v47, v47, v5, v46 bitop3:0xea
    ds_read_b64 v[104:105], v47
    v_bitop3_b32 v94, v30, v5, v46 bitop3:0xea
    s_waitcnt lgkmcnt(2)
    v_mfma_f32_4x4x4_16b_bf16 v[80:83], v[10:11], v[70:71], v[80:83]
    v_mfma_f32_4x4x4_16b_bf16 v[76:79], v[10:11], v[68:69], v[76:79]
    v_perm_b32 v15, v31, v32, s47
    v_bitop3_b32 v46, v31, 0.5, -0.5 bitop3:0xa8
    v_perm_b32 v14, v30, v32, s46
    v_bitop3_b32 v47, v30, 0.5, -0.5 bitop3:0xa8
    v_cvt_pk_bf16_f32 v80, v80, v81
    v_cvt_pk_bf16_f32 v81, v82, v83
    ds_wrxchg_rtn_b64 v[74:75], v93, v[80:81] offset:65408
    v_cvt_pk_bf16_f32 v76, v76, v77
    v_cvt_pk_bf16_f32 v77, v78, v79
    ds_wrxchg_rtn_b64 v[72:73], v92, v[76:77] offset:65408
    v_and_b32 v88, 0x0fffffff, v42
    v_mov_b32 v33, v42
    buffer_load_dwordx2 v[28:29], v88, s[8:11], 0 offen
    buffer_load_dwordx3 v[30:32], v88, s[8:11], 0 offen offset:8
    s_setprio 0
    s_waitcnt lgkmcnt(2)
    v_mfma_f32_4x4x4_16b_bf16 v[80:83], v[8:9], v[106:107], 0
    v_mfma_f32_4x4x4_16b_bf16 v[76:79], v[8:9], v[104:105], 0
    v_bitop3_b32 v15, v6, v15, v46 bitop3:0xca
    v_bitop3_b32 v14, v6, v14, v47 bitop3:0xca
    s_nop 1
    v_pk_mul_f32 v[80:81], v[80:81], v[14:15] op_sel:[0,1] op_sel_hi:[1,1]
    v_pk_mul_f32 v[82:83], v[82:83], v[14:15] op_sel:[0,1] op_sel_hi:[1,1]
    v_pk_mul_f32 v[76:77], v[76:77], v[14:15] op_sel:[0,0] op_sel_hi:[1,0]
    v_pk_mul_f32 v[78:79], v[78:79], v[14:15] op_sel:[0,0] op_sel_hi:[1,0]
    s_add_u32 s40, s40, 0x50000
    s_waitcnt lgkmcnt(0)
    v_cmp_ne_u64 s[50:51], v[72:73], v[68:69]
    v_cmpx_ne_u64 s[54:55], v[74:75], v[70:71]
    s_and_b64 s[82:83], s[54:55], s[80:81]
    s_cbranch_scc1 L2_c113
L2_d113:
    v_mov_b64 v[84:85], v[70:71]
    v_mov_b32 v7, v93
    v_mov_b64 v[86:87], v[74:75]
    s_or_b64 s[80:81], s[80:81], s[54:55]
    s_mov_b64 exec, s[50:51]
    s_and_b64 s[82:83], s[50:51], s[80:81]
    s_cbranch_scc1 L2_c114
L2_d114:
    v_mov_b64 v[84:85], v[68:69]
    v_mov_b32 v7, v92
    v_mov_b64 v[86:87], v[72:73]
    s_mov_b64 exec, -1
    s_or_b64 s[80:81], s[80:81], s[50:51]
    ds_read_b64 v[70:71], v95 offset:65408
    ds_read_b64 v[68:69], v94 offset:65408
    s_waitcnt vmcnt(8)
    v_and_b32 v46, 0x20000000, v39
    v_lshrrev_b32 v47, 14, v35
    v_bitop3_b32 v47, v47, v5, v46 bitop3:0xea
    ds_read_b64 v[102:103], v47
    v_bitop3_b32 v93, v35, v5, v46 bitop3:0xea
    v_and_b32 v46, 0x10000000, v39
    v_lshrrev_b32 v47, 14, v34
    v_bitop3_b32 v47, v47, v5, v46 bitop3:0xea
    ds_read_b64 v[100:101], v47
    v_bitop3_b32 v92, v34, v5, v46 bitop3:0xea
    v_and_b32 v46, 0x80000000, v39
    v_lshrrev_b32 v47, 14, v37
    v_bitop3_b32 v47, v47, v5, v46 bitop3:0xea
    ds_read_b64 v[106:107], v47
    v_and_b32 v46, 0x40000000, v39
    v_lshrrev_b32 v47, 14, v36
    v_bitop3_b32 v47, v47, v5, v46 bitop3:0xea
    ds_read_b64 v[104:105], v47
    s_waitcnt lgkmcnt(4)
    v_mfma_f32_4x4x4_16b_bf16 v[80:83], v[10:11], v[70:71], v[80:83]
    v_mfma_f32_4x4x4_16b_bf16 v[76:79], v[10:11], v[68:69], v[76:79]
    v_perm_b32 v15, v35, v38, s45
    v_bitop3_b32 v46, v35, 0.5, -0.5 bitop3:0xa8
    v_perm_b32 v14, v34, v38, s44
    v_bitop3_b32 v47, v34, 0.5, -0.5 bitop3:0xa8
    v_cvt_pk_bf16_f32 v80, v80, v81
    v_cvt_pk_bf16_f32 v81, v82, v83
    ds_wrxchg_rtn_b64 v[74:75], v95, v[80:81] offset:65408
    v_cvt_pk_bf16_f32 v76, v76, v77
    v_cvt_pk_bf16_f32 v77, v78, v79
    ds_wrxchg_rtn_b64 v[72:73], v94, v[76:77] offset:65408
    s_waitcnt lgkmcnt(2)
    s_barrier
    s_setprio 3
    s_mov_b32 m0, s100
    s_nop 0
    ds_write_addtid_b32 v116 offset:32768
    ds_write_addtid_b32 v117 offset:33024
    ds_write_addtid_b32 v118 offset:33280
    ds_write_addtid_b32 v119 offset:33536
    buffer_load_dwordx4 v[116:119], v3, s[16:19], s40 offen offset:2048
    ds_write_addtid_b32 v120 offset:33792
    ds_write_addtid_b32 v121 offset:34048
    ds_write_addtid_b32 v122 offset:34304
    ds_write_addtid_b32 v123 offset:34560
    buffer_load_dwordx4 v[120:123], v3, s[16:19], s40 offen offset:3072
    v_mfma_f32_4x4x4_16b_bf16 v[80:83], v[8:9], v[102:103], 0
    v_mfma_f32_4x4x4_16b_bf16 v[76:79], v[8:9], v[100:101], 0
    v_bitop3_b32 v15, v6, v15, v46 bitop3:0xca
    v_bitop3_b32 v14, v6, v14, v47 bitop3:0xca
    v_cmp_lt_u32 s[84:85], v5, v92
    s_nop 0
    v_pk_mul_f32 v[80:81], v[80:81], v[14:15] op_sel:[0,1] op_sel_hi:[1,1]
    v_pk_mul_f32 v[82:83], v[82:83], v[14:15] op_sel:[0,1] op_sel_hi:[1,1]
    v_pk_mul_f32 v[76:77], v[76:77], v[14:15] op_sel:[0,0] op_sel_hi:[1,0]
    v_pk_mul_f32 v[78:79], v[78:79], v[14:15] op_sel:[0,0] op_sel_hi:[1,0]
    v_mov_b32 v44, v43
    s_cmp_gt_u32 s37, 1024
    s_cbranch_scc1 L2_xs115
    s_cmp_lg_u32 s101, 0
    s_cbranch_scc1 L2_xa115
L2_xb115:
    v_lshlrev_b32 v89, 16, v96
    v_add_u32 v90, 60, v97
    v_bitop3_b32 v90, v89, v45, v90 bitop3:0x6a
    ds_write_b32 v98, v90 offset:12
    v_lshlrev_b32 v89, 20, v96
    v_add_u32 v90, 40, v97
    v_bitop3_b32 v90, v89, v45, v90 bitop3:0x6a
    ds_write_b32 v98, v90 offset:8
    v_lshlrev_b32 v89, 24, v96
    v_add_u32 v90, 20, v97
    v_bitop3_b32 v90, v89, v45, v90 bitop3:0x6a
    ds_write_b32 v98, v90 offset:4
    v_lshlrev_b32 v89, 28, v96
    v_bitop3_b32 v90, v89, v45, v97 bitop3:0x6a
    ds_write_b32 v98, v90 offset:0
    v_mov_b32_dpp v91, v66 quad_perm:[1,1,1,1] row_mask:0xf bank_mask:0xf
    v_and_b32 v89, 3, v91
    v_and_b32 v97, 0xfffc, v91
    v_sub_u16_dpp v88, v66, v91 quad_perm:[3,3,3,3] row_mask:0xf bank_mask:0xf
    v_mad_u32_u24 v97, v97, 5, v4
    v_add_u32 v99, v88, v89
    v_bfm_b32 v96, v88, v89
    v_cmp_lt_u32 s[58:59], 16, v99
    v_lshlrev_b32 v89, v1, v96
    v_and_b32 v89, v45, v89
    v_cmp_ne_u32 vcc, 0, v89
    v_xor_b32 v90, v97, v89
    s_add_u32 s3, s37, s38
    v_mbcnt_lo_u32_b32 v98, vcc_lo, 0
    v_mbcnt_hi_u32_b32 v98, vcc_hi, v98
    s_bcnt1_i32_b64 s41, vcc
    v_lshl_add_u32 v98, v98, 2, s3
    s_mov_b64 exec, vcc
    ds_write_b32 v98, v90
    s_mov_b64 exec, -1
    s_lshl2_add_u32 s37, s41, s37
    s_cmp_lg_u64 s[58:59], 0
    s_cbranch_scc1 L2_xe115
L2_xr115:
    v_add_u32 v98, s37, v0
    v_mov_b32 v90, -1
    ds_write_b32 v98, v90
    ds_read2st64_b32 v[40:41], v0 offset0:0 offset1:1
    ds_read2st64_b32 v[42:43], v0 offset0:2 offset1:3
    s_sub_u32 s3, s37, 768
    s_cmp_gt_u32 s3, 256
    s_cbranch_scc1 L2_xf115
L2_xg115:
    v_lshrrev_b64 v[64:65], 16, v[64:65]
    v_lshrrev_b64 v[66:67], 16, v[66:67]
    s_setprio 2
    ds_write_addtid_b32 v124 offset:34816
    ds_write_addtid_b32 v125 offset:35072
    ds_write_addtid_b32 v126 offset:35328
    ds_write_addtid_b32 v127 offset:35584
    s_add_u32 s3, s40, 4096
    buffer_load_dwordx4 v[124:127], v3, s[16:19], s3 offen
    s_waitcnt lgkmcnt(14)
    v_cmp_ne_u64 s[50:51], v[72:73], v[68:69]
    v_cmpx_ne_u64 s[54:55], v[74:75], v[70:71]
    s_and_b64 s[82:83], s[54:55], s[80:81]
    s_cbranch_scc1 L2_c116
L2_d116:
    v_mov_b64 v[84:85], v[70:71]
    v_mov_b32 v7, v95
    v_mov_b64 v[86:87], v[74:75]
    s_or_b64 s[80:81], s[80:81], s[54:55]
    s_mov_b64 exec, s[50:51]
    s_and_b64 s[82:83], s[50:51], s[80:81]
    s_cbranch_scc1 L2_c117
L2_d117:
    v_mov_b64 v[84:85], v[68:69]
    v_mov_b32 v7, v94
    v_mov_b64 v[86:87], v[72:73]
    s_mov_b64 exec, -1
    s_or_b64 s[80:81], s[80:81], s[50:51]
    ds_read_b64 v[70:71], v93 offset:65408
    s_and_b64 exec, s[84:85], s[80:81]
    v_mfma_f32_4x4x4_16b_bf16 v[76:79], v[12:13], v[84:85], 0
    v_mov_b32 v92, v7
    s_andn2_b64 s[80:81], s[80:81], s[84:85]
    v_mfma_f32_4x4x4_16b_bf16 v[76:79], v[10:11], v[86:87], v[76:79]
    s_mov_b64 exec, -1
    ds_read_b64 v[68:69], v92 offset:65408
    s_setprio 1
    s_waitcnt vmcnt(10)
    s_mov_b32 m0, s38
    s_nop 0
    ds_write_addtid_b32 v108 offset:0
    ds_write_addtid_b32 v109 offset:256
    ds_write_addtid_b32 v110 offset:512
    ds_write_addtid_b32 v111 offset:768
    s_waitcnt lgkmcnt(4)
    v_mfma_f32_4x4x4_16b_bf16 v[80:83], v[10:11], v[70:71], v[80:83]
    v_mfma_f32_4x4x4_16b_bf16 v[76:79], v[10:11], v[68:69], v[76:79]
    v_and_b32 v46, 0x40000000, v39
    v_bitop3_b32 v94, v36, v5, v46 bitop3:0xea
    v_and_b32 v46, 0x80000000, v39
    v_bitop3_b32 v95, v37, v5, v46 bitop3:0xea
    v_perm_b32 v15, v37, v38, s47
    v_bitop3_b32 v46, v37, 0.5, -0.5 bitop3:0xa8
    v_perm_b32 v14, v36, v38, s46
    v_bitop3_b32 v47, v36, 0.5, -0.5 bitop3:0xa8
    v_cvt_pk_bf16_f32 v80, v80, v81
    v_cvt_pk_bf16_f32 v81, v82, v83
    ds_wrxchg_rtn_b64 v[74:75], v93, v[80:81] offset:65408
    v_cvt_pk_bf16_f32 v76, v76, v77
    v_cvt_pk_bf16_f32 v77, v78, v79
    ds_wrxchg_rtn_b64 v[72:73], v92, v[76:77] offset:65408
    v_and_b32 v88, 0x0fffffff, v44
    v_mov_b32 v39, v44
    buffer_load_dwordx2 v[34:35], v88, s[8:11], 0 offen
    buffer_load_dwordx3 v[36:38], v88, s[8:11], 0 offen offset:8
    s_setprio 0
    s_waitcnt vmcnt(11)
    ds_write_addtid_b32 v112 offset:1024
    ds_write_addtid_b32 v113 offset:1280
    ds_write_addtid_b32 v114 offset:1536
    ds_write_addtid_b32 v115 offset:1792
    v_mfma_f32_4x4x4_16b_bf16 v[80:83], v[8:9], v[106:107], 0
    v_mfma_f32_4x4x4_16b_bf16 v[76:79], v[8:9], v[104:105], 0
    v_bitop3_b32 v15, v6, v15, v46 bitop3:0xca
    v_bitop3_b32 v14, v6, v14, v47 bitop3:0xca
    s_nop 1
    v_pk_mul_f32 v[80:81], v[80:81], v[14:15] op_sel:[0,1] op_sel_hi:[1,1]
    v_pk_mul_f32 v[82:83], v[82:83], v[14:15] op_sel:[0,1] op_sel_hi:[1,1]
    v_pk_mul_f32 v[76:77], v[76:77], v[14:15] op_sel:[0,0] op_sel_hi:[1,0]
    v_pk_mul_f32 v[78:79], v[78:79], v[14:15] op_sel:[0,0] op_sel_hi:[1,0]
    s_add_u32 s42, s42, 1
    s_waitcnt lgkmcnt(0)
    s_cmp_lg_u32 s42, 14
    s_cbranch_scc1 L2_loop
    s_barrier
    s_bitcmp1_b32 s36, s42
    s_cbranch_scc1 L2_slow
L2_ret6:
    s_setprio 3
    buffer_load_dwordx4 v[108:111], v3, s[16:19], s40 offen offset:0
    v_cmp_ne_u64 s[50:51], v[72:73], v[68:69]
    v_cmpx_ne_u64 s[54:55], v[74:75], v[70:71]
    s_and_b64 s[82:83], s[54:55], s[80:81]
    s_cbranch_scc1 L2_c118
L2_d118:
    v_mov_b64 v[84:85], v[70:71]
    v_mov_b32 v7, v93
    v_mov_b64 v[86:87], v[74:75]
    s_or_b64 s[80:81], s[80:81], s[54:55]
    s_mov_b64 exec, s[50:51]
    s_and_b64 s[82:83], s[50:51], s[80:81]
    s_cbranch_scc1 L2_c119
L2_d119:
    v_mov_b64 v[84:85], v[68:69]
    v_mov_b32 v7, v92
    v_mov_b64 v[86:87], v[72:73]
    s_mov_b64 exec, -1
    s_or_b64 s[80:81], s[80:81], s[50:51]
    ds_read_b64 v[70:71], v95 offset:65408
    ds_read_b64 v[68:69], v94 offset:65408
    s_waitcnt vmcnt(10)
    v_and_b32 v46, 0x20000000, v21
    v_lshrrev_b32 v47, 14, v17
    v_bitop3_b32 v47, v47, v5, v46 bitop3:0xea
    ds_read_b64 v[102:103], v47
    v_bitop3_b32 v93, v17, v5, v46 bitop3:0xea
    v_and_b32 v46, 0x10000000, v21
    v_lshrrev_b32 v47, 14, v16
    v_bitop3_b32 v47, v47, v5, v46 bitop3:0xea
    ds_read_b64 v[100:101], v47
    v_bitop3_b32 v92, v16, v5, v46 bitop3:0xea
    s_waitcnt lgkmcnt(2)
    v_mfma_f32_4x4x4_16b_bf16 v[80:83], v[10:11], v[70:71], v[80:83]
    v_mfma_f32_4x4x4_16b_bf16 v[76:79], v[10:11], v[68:69], v[76:79]
    v_perm_b32 v15, v17, v20, s45
    v_bitop3_b32 v46, v17, 0.5, -0.5 bitop3:0xa8
    v_perm_b32 v14, v16, v20, s44
    v_bitop3_b32 v47, v16, 0.5, -0.5 bitop3:0xa8
    v_cvt_pk_bf16_f32 v80, v80, v81
    v_cvt_pk_bf16_f32 v81, v82, v83
    ds_wrxchg_rtn_b64 v[74:75], v95, v[80:81] offset:65408
    v_cvt_pk_bf16_f32 v76, v76, v77
    v_cvt_pk_bf16_f32 v77, v78, v79
    ds_wrxchg_rtn_b64 v[72:73], v94, v[76:77] offset:65408
    s_waitcnt lgkmcnt(2)
    v_mfma_f32_4x4x4_16b_bf16 v[80:83], v[8:9], v[102:103], 0
    v_mfma_f32_4x4x4_16b_bf16 v[76:79], v[8:9], v[100:101], 0
    v_bitop3_b32 v15, v6, v15, v46 bitop3:0xca
    v_bitop3_b32 v14, v6, v14, v47 bitop3:0xca
    v_cmp_lt_u32 s[84:85], v5, v92
    s_nop 0
    v_pk_mul_f32 v[80:81], v[80:81], v[14:15] op_sel:[0,1] op_sel_hi:[1,1]
    v_pk_mul_f32 v[82:83], v[82:83], v[14:15] op_sel:[0,1] op_sel_hi:[1,1]
    v_pk_mul_f32 v[76:77], v[76:77], v[14:15] op_sel:[0,0] op_sel_hi:[1,0]
    v_pk_mul_f32 v[78:79], v[78:79], v[14:15] op_sel:[0,0] op_sel_hi:[1,0]
    buffer_load_dwordx4 v[112:115], v3, s[16:19], s40 offen offset:1024
    s_waitcnt lgkmcnt(0)
    v_cmp_ne_u64 s[50:51], v[72:73], v[68:69]
    v_cmpx_ne_u64 s[54:55], v[74:75], v[70:71]
    s_and_b64 s[82:83], s[54:55], s[80:81]
    s_cbranch_scc1 L2_c120
L2_d120:
    v_mov_b64 v[84:85], v[70:71]
    v_mov_b32 v7, v95
    v_mov_b64 v[86:87], v[74:75]
    s_or_b64 s[80:81], s[80:81], s[54:55]
    s_mov_b64 exec, s[50:51]
    s_and_b64 s[82:83], s[50:51], s[80:81]
    s_cbranch_scc1 L2_c121
L2_d121:
    v_mov_b64 v[84:85], v[68:69]
    v_mov_b32 v7, v94
    v_mov_b64 v[86:87], v[72:73]
    s_mov_b64 exec, -1
    s_or_b64 s[80:81], s[80:81], s[50:51]
    ds_read_b64 v[70:71], v93 offset:65408
    s_and_b64 exec, s[84:85], s[80:81]
    v_mfma_f32_4x4x4_16b_bf16 v[76:79], v[12:13], v[84:85], 0
    v_mov_b32 v92, v7
    s_andn2_b64 s[80:81], s[80:81], s[84:85]
    v_mfma_f32_4x4x4_16b_bf16 v[76:79], v[10:11], v[86:87], v[76:79]
    s_mov_b64 exec, -1
    ds_read_b64 v[68:69], v92 offset:65408
    v_and_b32 v46, 0x80000000, v21
    v_lshrrev_b32 v47, 14, v19
    v_bitop3_b32 v47, v47, v5, v46 bitop3:0xea
    ds_read_b64 v[106:107], v47
    v_bitop3_b32 v95, v19, v5, v46 bitop3:0xea
    v_and_b32 v46, 0x40000000, v21
    v_lshrrev_b32 v47, 14, v18
    v_bitop3_b32 v47, v47, v5, v46 bitop3:0xea
    ds_read_b64 v[104:105], v47
    v_bitop3_b32 v94, v18, v5, v46 bitop3:0xea
    s_waitcnt lgkmcnt(2)
    v_mfma_f32_4x4x4_16b_bf16 v[80:83], v[10:11], v[70:71], v[80:83]
    v_mfma_f32_4x4x4_16b_bf16 v[76:79], v[10:11], v[68:69], v[76:79]
    v_perm_b32 v15, v19, v20, s47
    v_bitop3_b32 v46, v19, 0.5, -0.5 bitop3:0xa8
    v_perm_b32 v14, v18, v20, s46
    v_bitop3_b32 v47, v18, 0.5, -0.5 bitop3:0xa8
    v_cvt_pk_bf16_f32 v80, v80, v81
    v_cvt_pk_bf16_f32 v81, v82, v83
    ds_wrxchg_rtn_b64 v[74:75], v93, v[80:81] offset:65408
    v_cvt_pk_bf16_f32 v76, v76, v77
    v_cvt_pk_bf16_f32 v77, v78, v79
    ds_wrxchg_rtn_b64 v[72:73], v92, v[76:77] offset:65408
    v_and_b32 v88, 0x0fffffff, v40
    v_mov_b32 v21, v40
    buffer_load_dwordx2 v[16:17], v88, s[8:11], 0 offen
    buffer_load_dwordx3 v[18:20], v88, s[8:11], 0 offen offset:8
    s_setprio 2
    s_waitcnt lgkmcnt(2)
    v_mfma_f32_4x4x4_16b_bf16 v[80:83], v[8:9], v[106:107], 0
    v_mfma_f32_4x4x4_16b_bf16 v[76:79], v[8:9], v[104:105], 0
    v_bitop3_b32 v15, v6, v15, v46 bitop3:0xca
    v_bitop3_b32 v14, v6, v14, v47 bitop3:0xca
    s_nop 1
    v_pk_mul_f32 v[80:81], v[80:81], v[14:15] op_sel:[0,1] op_sel_hi:[1,1]
    v_pk_mul_f32 v[82:83], v[82:83], v[14:15] op_sel:[0,1] op_sel_hi:[1,1]
    v_pk_mul_f32 v[76:77], v[76:77], v[14:15] op_sel:[0,0] op_sel_hi:[1,0]
    v_pk_mul_f32 v[78:79], v[78:79], v[14:15] op_sel:[0,0] op_sel_hi:[1,0]
    s_waitcnt lgkmcnt(0)
    v_cmp_ne_u64 s[50:51], v[72:73], v[68:69]
    v_cmpx_ne_u64 s[54:55], v[74:75], v[70:71]
    s_and_b64 s[82:83], s[54:55], s[80:81]
    s_cbranch_scc1 L2_c122
L2_d122:
    v_mov_b64 v[84:85], v[70:71]
    v_mov_b32 v7, v93
    v_mov_b64 v[86:87], v[74:75]
    s_or_b64 s[80:81], s[80:81], s[54:55]
    s_mov_b64 exec, s[50:51]
    s_and_b64 s[82:83], s[50:51], s[80:81]
    s_cbranch_scc1 L2_c123
L2_d123:
    v_mov_b64 v[84:85], v[68:69]
    v_mov_b32 v7, v92
    v_mov_b64 v[86:87], v[72:73]
    s_mov_b64 exec, -1
    s_or_b64 s[80:81], s[80:81], s[50:51]
    ds_read_b64 v[70:71], v95 offset:65408
    ds_read_b64 v[68:69], v94 offset:65408
    s_waitcnt vmcnt(11)
    v_and_b32 v46, 0x20000000, v27
    v_lshrrev_b32 v47, 14, v23
    v_bitop3_b32 v47, v47, v5, v46 bitop3:0xea
    ds_read_b64 v[102:103], v47
    v_bitop3_b32 v93, v23, v5, v46 bitop3:0xea
    v_and_b32 v46, 0x10000000, v27
    v_lshrrev_b32 v47, 14, v22
    v_bitop3_b32 v47, v47, v5, v46 bitop3:0xea
    ds_read_b64 v[100:101], v47
    v_bitop3_b32 v92, v22, v5, v46 bitop3:0xea
    s_waitcnt lgkmcnt(2)
    v_mfma_f32_4x4x4_16b_bf16 v[80:83], v[10:11], v[70:71], v[80:83]
    v_mfma_f32_4x4x4_16b_bf16 v[76:79], v[10:11], v[68:69], v[76:79]
    v_perm_b32 v15, v23, v26, s45
    v_bitop3_b32 v46, v23, 0.5, -0.5 bitop3:0xa8
    v_perm_b32 v14, v22, v26, s44
    v_bitop3_b32 v47, v22, 0.5, -0.5 bitop3:0xa8
    v_cvt_pk_bf16_f32 v80, v80, v81
    v_cvt_pk_bf16_f32 v81, v82, v83
    ds_wrxchg_rtn_b64 v[74:75], v95, v[80:81] offset:65408
    v_cvt_pk_bf16_f32 v76, v76, v77
    v_cvt_pk_bf16_f32 v77, v78, v79
    ds_wrxchg_rtn_b64 v[72:73], v94, v[76:77] offset:65408
    s_waitcnt lgkmcnt(2)
    v_mfma_f32_4x4x4_16b_bf16 v[80:83], v[8:9], v[102:103], 0
    v_mfma_f32_4x4x4_16b_bf16 v[76:79], v[8:9], v[100:101], 0
    v_bitop3_b32 v15, v6, v15, v46 bitop3:0xca
    v_bitop3_b32 v14, v6, v14, v47 bitop3:0xca
    v_cmp_lt_u32 s[84:85], v5, v92
    s_nop 0
    v_pk_mul_f32 v[80:81], v[80:81], v[14:15] op_sel:[0,1] op_sel_hi:[1,1]
    v_pk_mul_f32 v[82:83], v[82:83], v[14:15] op_sel:[0,1] op_sel_hi:[1,1]
    v_pk_mul_f32 v[76:77], v[76:77], v[14:15] op_sel:[0,0] op_sel_hi:[1,0]
    v_pk_mul_f32 v[78:79], v[78:79], v[14:15] op_sel:[0,0] op_sel_hi:[1,0]
    s_waitcnt lgkmcnt(0)
    v_cmp_ne_u64 s[50:51], v[72:73], v[68:69]
    v_cmpx_ne_u64 s[54:55], v[74:75], v[70:71]
    s_and_b64 s[82:83], s[54:55], s[80:81]
    s_cbranch_scc1 L2_c124
L2_d124:
    v_mov_b64 v[84:85], v[70:71]
    v_mov_b32 v7, v95
    v_mov_b64 v[86:87], v[74:75]
    s_or_b64 s[80:81], s[80:81], s[54:55]
    s_mov_b64 exec, s[50:51]
    s_and_b64 s[82:83], s[50:51], s[80:81]
    s_cbranch_scc1 L2_c125
L2_d125:
    v_mov_b64 v[84:85], v[68:69]
    v_mov_b32 v7, v94
    v_mov_b64 v[86:87], v[72:73]
    s_mov_b64 exec, -1
    s_or_b64 s[80:81], s[80:81], s[50:51]
    ds_read_b64 v[70:71], v93 offset:65408
    s_and_b64 exec, s[84:85], s[80:81]
    v_mfma_f32_4x4x4_16b_bf16 v[76:79], v[12:13], v[84:85], 0
    v_mov_b32 v92, v7
    s_andn2_b64 s[80:81], s[80:81], s[84:85]
    v_mfma_f32_4x4x4_16b_bf16 v[76:79], v[10:11], v[86:87], v[76:79]
    s_mov_b64 exec, -1
    ds_read_b64 v[68:69], v92 offset:65408
    v_and_b32 v46, 0x80000000, v27
    v_lshrrev_b32 v47, 14, v25
    v_bitop3_b32 v47, v47, v5, v46 bitop3:0xea
    ds_read_b64 v[106:107], v47
    v_bitop3_b32 v95, v25, v5, v46 bitop3:0xea
    v_and_b32 v46, 0x40000000, v27
    v_lshrrev_b32 v47, 14, v24
    v_bitop3_b32 v47, v47, v5, v46 bitop3:0xea
    ds_read_b64 v[104:105], v47
    v_bitop3_b32 v94, v24, v5, v46 bitop3:0xea
    s_waitcnt lgkmcnt(2)
    v_mfma_f32_4x4x4_16b_bf16 v[80:83], v[10:11], v[70:71], v[80:83]
    v_mfma_f32_4x4x4_16b_bf16 v[76:79], v[10:11], v[68:69], v[76:79]
    v_perm_b32 v15, v25, v26, s47
    v_bitop3_b32 v46, v25, 0.5, -0.5 bitop3:0xa8
    v_perm_b32 v14, v24, v26, s46
    v_bitop3_b32 v47, v24, 0.5, -0.5 bitop3:0xa8
    v_cvt_pk_bf16_f32 v80, v80, v81
    v_cvt_pk_bf16_f32 v81, v82, v83
    ds_wrxchg_rtn_b64 v[74:75], v93, v[80:81] offset:65408
    v_cvt_pk_bf16_f32 v76, v76, v77
    v_cvt_pk_bf16_f32 v77, v78, v79
    ds_wrxchg_rtn_b64 v[72:73], v92, v[76:77] offset:65408
    v_and_b32 v88, 0x0fffffff, v41
    v_mov_b32 v27, v41
    buffer_load_dwordx2 v[22:23], v88, s[8:11], 0 offen
    buffer_load_dwordx3 v[24:26], v88, s[8:11], 0 offen offset:8
    s_setprio 1
    s_waitcnt lgkmcnt(2)
    v_mfma_f32_4x4x4_16b_bf16 v[80:83], v[8:9], v[106:107], 0
    v_mfma_f32_4x4x4_16b_bf16 v[76:79], v[8:9], v[104:105], 0
    v_bitop3_b32 v15, v6, v15, v46 bitop3:0xca
    v_bitop3_b32 v14, v6, v14, v47 bitop3:0xca
    s_nop 1
    v_pk_mul_f32 v[80:81], v[80:81], v[14:15] op_sel:[0,1] op_sel_hi:[1,1]
    v_pk_mul_f32 v[82:83], v[82:83], v[14:15] op_sel:[0,1] op_sel_hi:[1,1]
    v_pk_mul_f32 v[76:77], v[76:77], v[14:15] op_sel:[0,0] op_sel_hi:[1,0]
    v_pk_mul_f32 v[78:79], v[78:79], v[14:15] op_sel:[0,0] op_sel_hi:[1,0]
    s_waitcnt lgkmcnt(0)
    v_cmp_ne_u64 s[50:51], v[72:73], v[68:69]
    v_cmpx_ne_u64 s[54:55], v[74:75], v[70:71]
    s_and_b64 s[82:83], s[54:55], s[80:81]
    s_cbranch_scc1 L2_c126
L2_d126:
    v_mov_b64 v[84:85], v[70:71]
    v_mov_b32 v7, v93
    v_mov_b64 v[86:87], v[74:75]
    s_or_b64 s[80:81], s[80:81], s[54:55]
    s_mov_b64 exec, s[50:51]
    s_and_b64 s[82:83], s[50:51], s[80:81]
    s_cbranch_scc1 L2_c127
L2_d127:
    v_mov_b64 v[84:85], v[68:69]
    v_mov_b32 v7, v92
    v_mov_b64 v[86:87], v[72:73]
    s_mov_b64 exec, -1
    s_or_b64 s[80:81], s[80:81], s[50:51]
    ds_read_b64 v[70:71], v95 offset:65408
    ds_read_b64 v[68:69], v94 offset:65408
    s_waitcnt vmcnt(11)
    v_and_b32 v46, 0x20000000, v33
    v_lshrrev_b32 v47, 14, v29
    v_bitop3_b32 v47, v47, v5, v46 bitop3:0xea
    ds_read_b64 v[102:103], v47
    v_bitop3_b32 v93, v29, v5, v46 bitop3:0xea
    v_and_b32 v46, 0x10000000, v33
    v_lshrrev_b32 v47, 14, v28
    v_bitop3_b32 v47, v47, v5, v46 bitop3:0xea
    ds_read_b64 v[100:101], v47
    v_bitop3_b32 v92, v28, v5, v46 bitop3:0xea
    s_waitcnt lgkmcnt(2)
    v_mfma_f32_4x4x4_16b_bf16 v[80:83], v[10:11], v[70:71], v[80:83]
    v_mfma_f32_4x4x4_16b_bf16 v[76:79], v[10:11], v[68:69], v[76:79]
    v_perm_b32 v15, v29, v32, s45
    v_bitop3_b32 v46, v29, 0.5, -0.5 bitop3:0xa8
    v_perm_b32 v14, v28, v32, s44
    v_bitop3_b32 v47, v28, 0.5, -0.5 bitop3:0xa8
    v_cvt_pk_bf16_f32 v80, v80, v81
    v_cvt_pk_bf16_f32 v81, v82, v83
    ds_wrxchg_rtn_b64 v[74:75], v95, v[80:81] offset:65408
    v_cvt_pk_bf16_f32 v76, v76, v77
    v_cvt_pk_bf16_f32 v77, v78, v79
    ds_wrxchg_rtn_b64 v[72:73], v94, v[76:77] offset:65408
    s_waitcnt lgkmcnt(2)
    v_mfma_f32_4x4x4_16b_bf16 v[80:83], v[8:9], v[102:103], 0
    v_mfma_f32_4x4x4_16b_bf16 v[76:79], v[8:9], v[100:101], 0
    v_bitop3_b32 v15, v6, v15, v46 bitop3:0xca
    v_bitop3_b32 v14, v6, v14, v47 bitop3:0xca
    v_cmp_lt_u32 s[84:85], v5, v92
    s_nop 0
    v_pk_mul_f32 v[80:81], v[80:81], v[14:15] op_sel:[0,1] op_sel_hi:[1,1]
    v_pk_mul_f32 v[82:83], v[82:83], v[14:15] op_sel:[0,1] op_sel_hi:[1,1]
    v_pk_mul_f32 v[76:77], v[76:77], v[14:15] op_sel:[0,0] op_sel_hi:[1,0]
    v_pk_mul_f32 v[78:79], v[78:79], v[14:15] op_sel:[0,0] op_sel_hi:[1,0]
    s_waitcnt lgkmcnt(0)
    v_cmp_ne_u64 s[50:51], v[72:73], v[68:69]
    v_cmpx_ne_u64 s[54:55], v[74:75], v[70:71]
    s_and_b64 s[82:83], s[54:55], s[80:81]
    s_cbranch_scc1 L2_c128
L2_d128:
    v_mov_b64 v[84:85], v[70:71]
    v_mov_b32 v7, v95
    v_mov_b64 v[86:87], v[74:75]
    s_or_b64 s[80:81], s[80:81], s[54:55]
    s_mov_b64 exec, s[50:51]
    s_and_b64 s[82:83], s[50:51], s[80:81]
    s_cbranch_scc1 L2_c129
L2_d129:
    v_mov_b64 v[84:85], v[68:69]
    v_mov_b32 v7, v94
    v_mov_b64 v[86:87], v[72:73]
    s_mov_b64 exec, -1
    s_or_b64 s[80:81], s[80:81], s[50:51]
    ds_read_b64 v[70:71], v93 offset:65408
    s_and_b64 exec, s[84:85], s[80:81]
    v_mfma_f32_4x4x4_16b_bf16 v[76:79], v[12:13], v[84:85], 0
    v_mov_b32 v92, v7
    s_andn2_b64 s[80:81], s[80:81], s[84:85]
    v_mfma_f32_4x4x4_16b_bf16 v[76:79], v[10:11], v[86:87], v[76:79]
    s_mov_b64 exec, -1
    ds_read_b64 v[68:69], v92 offset:65408
    v_and_b32 v46, 0x80000000, v33
    v_lshrrev_b32 v47, 14, v31
    v_bitop3_b32 v47, v47, v5, v46 bitop3:0xea
    ds_read_b64 v[106:107], v47
    v_bitop3_b32 v95, v31, v5, v46 bitop3:0xea
    v_and_b32 v46, 0x40000000, v33
    v_lshrrev_b32 v47, 14, v30
    v_bitop3_b32 v47, v47, v5, v46 bitop3:0xea
    ds_read_b64 v[104:105], v47
    v_bitop3_b32 v94, v30, v5, v46 bitop3:0xea
    s_waitcnt lgkmcnt(2)
    v_mfma_f32_4x4x4_16b_bf16 v[80:83], v[10:11], v[70:71], v[80:83]
    v_mfma_f32_4x4x4_16b_bf16 v[76:79], v[10:11], v[68:69], v[76:79]
    v_perm_b32 v15, v31, v32, s47
    v_bitop3_b32 v46, v31, 0.5, -0.5 bitop3:0xa8
    v_perm_b32 v14, v30, v32, s46
    v_bitop3_b32 v47, v30, 0.5, -0.5 bitop3:0xa8
    v_cvt_pk_bf16_f32 v80, v80, v81
    v_cvt_pk_bf16_f32 v81, v82, v83
    ds_wrxchg_rtn_b64 v[74:75], v93, v[80:81] offset:65408
    v_cvt_pk_bf16_f32 v76, v76, v77
    v_cvt_pk_bf16_f32 v77, v78, v79
    ds_wrxchg_rtn_b64 v[72:73], v92, v[76:77] offset:65408
    v_and_b32 v88, 0x0fffffff, v42
    v_mov_b32 v33, v42
    buffer_load_dwordx2 v[28:29], v88, s[8:11], 0 offen
    buffer_load_dwordx3 v[30:32], v88, s[8:11], 0 offen offset:8
    s_setprio 0
    s_waitcnt lgkmcnt(2)
    v_mfma_f32_4x4x4_16b_bf16 v[80:83], v[8:9], v[106:107], 0
    v_mfma_f32_4x4x4_16b_bf16 v[76:79], v[8:9], v[104:105], 0
    v_bitop3_b32 v15, v6, v15, v46 bitop3:0xca
    v_bitop3_b32 v14, v6, v14, v47 bitop3:0xca
    s_nop 1
    v_pk_mul_f32 v[80:81], v[80:81], v[14:15] op_sel:[0,1] op_sel_hi:[1,1]
    v_pk_mul_f32 v[82:83], v[82:83], v[14:15] op_sel:[0,1] op_sel_hi:[1,1]
    v_pk_mul_f32 v[76:77], v[76:77], v[14:15] op_sel:[0,0] op_sel_hi:[1,0]
    v_pk_mul_f32 v[78:79], v[78:79], v[14:15] op_sel:[0,0] op_sel_hi:[1,0]
    s_add_u32 s40, s40, 0xfff24000
    s_waitcnt lgkmcnt(0)
    v_cmp_ne_u64 s[50:51], v[72:73], v[68:69]
    v_cmpx_ne_u64 s[54:55], v[74:75], v[70:71]
    s_and_b64 s[82:83], s[54:55], s[80:81]
    s_cbranch_scc1 L2_c130
L2_d130:
    v_mov_b64 v[84:85], v[70:71]
    v_mov_b32 v7, v93
    v_mov_b64 v[86:87], v[74:75]
    s_or_b64 s[80:81], s[80:81], s[54:55]
    s_mov_b64 exec, s[50:51]
    s_and_b64 s[82:83], s[50:51], s[80:81]
    s_cbranch_scc1 L2_c131
L2_d131:
    v_mov_b64 v[84:85], v[68:69]
    v_mov_b32 v7, v92
    v_mov_b64 v[86:87], v[72:73]
    s_mov_b64 exec, -1
    s_or_b64 s[80:81], s[80:81], s[50:51]
    ds_read_b64 v[70:71], v95 offset:65408
    ds_read_b64 v[68:69], v94 offset:65408
    s_waitcnt vmcnt(8)
    v_and_b32 v46, 0x20000000, v39
    v_lshrrev_b32 v47, 14, v35
    v_bitop3_b32 v47, v47, v5, v46 bitop3:0xea
    ds_read_b64 v[102:103], v47
    v_bitop3_b32 v93, v35, v5, v46 bitop3:0xea
    v_and_b32 v46, 0x10000000, v39
    v_lshrrev_b32 v47, 14, v34
    v_bitop3_b32 v47, v47, v5, v46 bitop3:0xea
    ds_read_b64 v[100:101], v47
    v_bitop3_b32 v92, v34, v5, v46 bitop3:0xea
    v_and_b32 v46, 0x80000000, v39
    v_lshrrev_b32 v47, 14, v37
    v_bitop3_b32 v47, v47, v5, v46 bitop3:0xea
    ds_read_b64 v[106:107], v47
    v_and_b32 v46, 0x40000000, v39
    v_lshrrev_b32 v47, 14, v36
    v_bitop3_b32 v47, v47, v5, v46 bitop3:0xea
    ds_read_b64 v[104:105], v47
    s_waitcnt lgkmcnt(4)
    v_mfma_f32_4x4x4_16b_bf16 v[80:83], v[10:11], v[70:71], v[80:83]
    v_mfma_f32_4x4x4_16b_bf16 v[76:79], v[10:11], v[68:69], v[76:79]
    v_perm_b32 v15, v35, v38, s45
    v_bitop3_b32 v46, v35, 0.5, -0.5 bitop3:0xa8
    v_perm_b32 v14, v34, v38, s44
    v_bitop3_b32 v47, v34, 0.5, -0.5 bitop3:0xa8
    v_cvt_pk_bf16_f32 v80, v80, v81
    v_cvt_pk_bf16_f32 v81, v82, v83
    ds_wrxchg_rtn_b64 v[74:75], v95, v[80:81] offset:65408
    v_cvt_pk_bf16_f32 v76, v76, v77
    v_cvt_pk_bf16_f32 v77, v78, v79
    ds_wrxchg_rtn_b64 v[72:73], v94, v[76:77] offset:65408
    s_waitcnt lgkmcnt(2)
    s_barrier
    s_setprio 3
    s_mov_b32 m0, s100
    s_nop 0
    ds_write_addtid_b32 v116 offset:32768
    ds_write_addtid_b32 v117 offset:33024
    ds_write_addtid_b32 v118 offset:33280
    ds_write_addtid_b32 v119 offset:33536
    ds_write_addtid_b32 v120 offset:33792
    ds_write_addtid_b32 v121 offset:34048
    ds_write_addtid_b32 v122 offset:34304
    ds_write_addtid_b32 v123 offset:34560
    v_mfma_f32_4x4x4_16b_bf16 v[80:83], v[8:9], v[102:103], 0
    v_mfma_f32_4x4x4_16b_bf16 v[76:79], v[8:9], v[100:101], 0
    v_bitop3_b32 v15, v6, v15, v46 bitop3:0xca
    v_bitop3_b32 v14, v6, v14, v47 bitop3:0xca
    v_cmp_lt_u32 s[84:85], v5, v92
    s_nop 0
    v_pk_mul_f32 v[80:81], v[80:81], v[14:15] op_sel:[0,1] op_sel_hi:[1,1]
    v_pk_mul_f32 v[82:83], v[82:83], v[14:15] op_sel:[0,1] op_sel_hi:[1,1]
    v_pk_mul_f32 v[76:77], v[76:77], v[14:15] op_sel:[0,0] op_sel_hi:[1,0]
    v_pk_mul_f32 v[78:79], v[78:79], v[14:15] op_sel:[0,0] op_sel_hi:[1,0]
    v_mov_b32 v44, v43
    s_setprio 2
    ds_write_addtid_b32 v124 offset:34816
    ds_write_addtid_b32 v125 offset:35072
    ds_write_addtid_b32 v126 offset:35328
    ds_write_addtid_b32 v127 offset:35584
    s_waitcnt lgkmcnt(12)
    v_cmp_ne_u64 s[50:51], v[72:73], v[68:69]
    v_cmpx_ne_u64 s[54:55], v[74:75], v[70:71]
    s_and_b64 s[82:83], s[54:55], s[80:81]
    s_cbranch_scc1 L2_c132
L2_d132:
    v_mov_b64 v[84:85], v[70:71]
    v_mov_b32 v7, v95
    v_mov_b64 v[86:87], v[74:75]
    s_or_b64 s[80:81], s[80:81], s[54:55]
    s_mov_b64 exec, s[50:51]
    s_and_b64 s[82:83], s[50:51], s[80:81]
    s_cbranch_scc1 L2_c133
L2_d133:
    v_mov_b64 v[84:85], v[68:69]
    v_mov_b32 v7, v94
    v_mov_b64 v[86:87], v[72:73]
    s_mov_b64 exec, -1
    s_or_b64 s[80:81], s[80:81], s[50:51]
    ds_read_b64 v[70:71], v93 offset:65408
    s_and_b64 exec, s[84:85], s[80:81]
    v_mfma_f32_4x4x4_16b_bf16 v[76:79], v[12:13], v[84:85], 0
    v_mov_b32 v92, v7
    s_andn2_b64 s[80:81], s[80:81], s[84:85]
    v_mfma_f32_4x4x4_16b_bf16 v[76:79], v[10:11], v[86:87], v[76:79]
    s_mov_b64 exec, -1
    ds_read_b64 v[68:69], v92 offset:65408
    s_setprio 1
    s_waitcnt vmcnt(7)
    s_mov_b32 m0, s38
    s_nop 0
    ds_write_addtid_b32 v108 offset:0
    ds_write_addtid_b32 v109 offset:256
    ds_write_addtid_b32 v110 offset:512
    ds_write_addtid_b32 v111 offset:768
    s_waitcnt lgkmcnt(4)
    v_mfma_f32_4x4x4_16b_bf16 v[80:83], v[10:11], v[70:71], v[80:83]
    v_mfma_f32_4x4x4_16b_bf16 v[76:79], v[10:11], v[68:69], v[76:79]
    v_and_b32 v46, 0x40000000, v39
    v_bitop3_b32 v94, v36, v5, v46 bitop3:0xea
    v_and_b32 v46, 0x80000000, v39
    v_bitop3_b32 v95, v37, v5, v46 bitop3:0xea
    v_perm_b32 v15, v37, v38, s47
    v_bitop3_b32 v46, v37, 0.5, -0.5 bitop3:0xa8
    v_perm_b32 v14, v36, v38, s46
    v_bitop3_b32 v47, v36, 0.5, -0.5 bitop3:0xa8
    v_cvt_pk_bf16_f32 v80, v80, v81
    v_cvt_pk_bf16_f32 v81, v82, v83
    ds_wrxchg_rtn_b64 v[74:75], v93, v[80:81] offset:65408
    v_cvt_pk_bf16_f32 v76, v76, v77
    v_cvt_pk_bf16_f32 v77, v78, v79
    ds_wrxchg_rtn_b64 v[72:73], v92, v[76:77] offset:65408
    v_and_b32 v88, 0x0fffffff, v44
    v_mov_b32 v39, v44
    buffer_load_dwordx2 v[34:35], v88, s[8:11], 0 offen
    buffer_load_dwordx3 v[36:38], v88, s[8:11], 0 offen offset:8
    s_setprio 0
    s_waitcnt vmcnt(8)
    ds_write_addtid_b32 v112 offset:1024
    ds_write_addtid_b32 v113 offset:1280
    ds_write_addtid_b32 v114 offset:1536
    ds_write_addtid_b32 v115 offset:1792
    v_mfma_f32_4x4x4_16b_bf16 v[80:83], v[8:9], v[106:107], 0
    v_mfma_f32_4x4x4_16b_bf16 v[76:79], v[8:9], v[104:105], 0
    v_bitop3_b32 v15, v6, v15, v46 bitop3:0xca
    v_bitop3_b32 v14, v6, v14, v47 bitop3:0xca
    s_nop 1
    v_pk_mul_f32 v[80:81], v[80:81], v[14:15] op_sel:[0,1] op_sel_hi:[1,1]
    v_pk_mul_f32 v[82:83], v[82:83], v[14:15] op_sel:[0,1] op_sel_hi:[1,1]
    v_pk_mul_f32 v[76:77], v[76:77], v[14:15] op_sel:[0,0] op_sel_hi:[1,0]
    v_pk_mul_f32 v[78:79], v[78:79], v[14:15] op_sel:[0,0] op_sel_hi:[1,0]
    s_add_u32 s42, s42, 1
    s_waitcnt lgkmcnt(0)
    s_barrier
    s_bitcmp1_b32 s36, s42
    s_cbranch_scc1 L2_slow
L2_ret7:
    s_setprio 3
    v_cmp_ne_u64 s[50:51], v[72:73], v[68:69]
    v_cmpx_ne_u64 s[54:55], v[74:75], v[70:71]
    s_and_b64 s[82:83], s[54:55], s[80:81]
    s_cbranch_scc1 L2_c134
L2_d134:
    v_mov_b64 v[84:85], v[70:71]
    v_mov_b32 v7, v93
    v_mov_b64 v[86:87], v[74:75]
    s_or_b64 s[80:81], s[80:81], s[54:55]
    s_mov_b64 exec, s[50:51]
    s_and_b64 s[82:83], s[50:51], s[80:81]
    s_cbranch_scc1 L2_c135
L2_d135:
    v_mov_b64 v[84:85], v[68:69]
    v_mov_b32 v7, v92
    v_mov_b64 v[86:87], v[72:73]
    s_mov_b64 exec, -1
    s_or_b64 s[80:81], s[80:81], s[50:51]
    ds_read_b64 v[70:71], v95 offset:65408
    ds_read_b64 v[68:69], v94 offset:65408
    s_waitcnt vmcnt(6)
    v_and_b32 v46, 0x20000000, v21
    v_lshrrev_b32 v47, 14, v17
    v_bitop3_b32 v47, v47, v5, v46 bitop3:0xea
    ds_read_b64 v[102:103], v47
    v_bitop3_b32 v93, v17, v5, v46 bitop3:0xea
    v_and_b32 v46, 0x10000000, v21
    v_lshrrev_b32 v47, 14, v16
    v_bitop3_b32 v47, v47, v5, v46 bitop3:0xea
    ds_read_b64 v[100:101], v47
    v_bitop3_b32 v92, v16, v5, v46 bitop3:0xea
    s_waitcnt lgkmcnt(2)
    v_mfma_f32_4x4x4_16b_bf16 v[80:83], v[10:11], v[70:71], v[80:83]
    v_mfma_f32_4x4x4_16b_bf16 v[76:79], v[10:11], v[68:69], v[76:79]
    v_perm_b32 v15, v17, v20, s45
    v_bitop3_b32 v46, v17, 0.5, -0.5 bitop3:0xa8
    v_perm_b32 v14, v16, v20, s44
    v_bitop3_b32 v47, v16, 0.5, -0.5 bitop3:0xa8
    v_cvt_pk_bf16_f32 v80, v80, v81
    v_cvt_pk_bf16_f32 v81, v82, v83
    ds_wrxchg_rtn_b64 v[74:75], v95, v[80:81] offset:65408
    v_cvt_pk_bf16_f32 v76, v76, v77
    v_cvt_pk_bf16_f32 v77, v78, v79
    ds_wrxchg_rtn_b64 v[72:73], v94, v[76:77] offset:65408
    s_waitcnt lgkmcnt(2)
    v_mfma_f32_4x4x4_16b_bf16 v[80:83], v[8:9], v[102:103], 0
    v_mfma_f32_4x4x4_16b_bf16 v[76:79], v[8:9], v[100:101], 0
    v_bitop3_b32 v15, v6, v15, v46 bitop3:0xca
    v_bitop3_b32 v14, v6, v14, v47 bitop3:0xca
    v_cmp_lt_u32 s[84:85], v5, v92
    s_nop 0
    v_pk_mul_f32 v[80:81], v[80:81], v[14:15] op_sel:[0,1] op_sel_hi:[1,1]
    v_pk_mul_f32 v[82:83], v[82:83], v[14:15] op_sel:[0,1] op_sel_hi:[1,1]
    v_pk_mul_f32 v[76:77], v[76:77], v[14:15] op_sel:[0,0] op_sel_hi:[1,0]
    v_pk_mul_f32 v[78:79], v[78:79], v[14:15] op_sel:[0,0] op_sel_hi:[1,0]
    s_waitcnt lgkmcnt(0)
    v_cmp_ne_u64 s[50:51], v[72:73], v[68:69]
    v_cmpx_ne_u64 s[54:55], v[74:75], v[70:71]
    s_and_b64 s[82:83], s[54:55], s[80:81]
    s_cbranch_scc1 L2_c136
L2_d136:
    v_mov_b64 v[84:85], v[70:71]
    v_mov_b32 v7, v95
    v_mov_b64 v[86:87], v[74:75]
    s_or_b64 s[80:81], s[80:81], s[54:55]
    s_mov_b64 exec, s[50:51]
    s_and_b64 s[82:83], s[50:51], s[80:81]
    s_cbranch_scc1 L2_c137
L2_d137:
    v_mov_b64 v[84:85], v[68:69]
    v_mov_b32 v7, v94
    v_mov_b64 v[86:87], v[72:73]
    s_mov_b64 exec, -1
    s_or_b64 s[80:81], s[80:81], s[50:51]
    ds_read_b64 v[70:71], v93 offset:65408
    s_and_b64 exec, s[84:85], s[80:81]
    v_mfma_f32_4x4x4_16b_bf16 v[76:79], v[12:13], v[84:85], 0
    v_mov_b32 v92, v7
    s_andn2_b64 s[80:81], s[80:81], s[84:85]
    v_mfma_f32_4x4x4_16b_bf16 v[76:79], v[10:11], v[86:87], v[76:79]
    s_mov_b64 exec, -1
    ds_read_b64 v[68:69], v92 offset:65408
    v_and_b32 v46, 0x80000000, v21
    v_lshrrev_b32 v47, 14, v19
    v_bitop3_b32 v47, v47, v5, v46 bitop3:0xea
    ds_read_b64 v[106:107], v47
    v_bitop3_b32 v95, v19, v5, v46 bitop3:0xea
    v_and_b32 v46, 0x40000000, v21
    v_lshrrev_b32 v47, 14, v18
    v_bitop3_b32 v47, v47, v5, v46 bitop3:0xea
    ds_read_b64 v[104:105], v47
    v_bitop3_b32 v94, v18, v5, v46 bitop3:0xea
    s_waitcnt lgkmcnt(2)
    v_mfma_f32_4x4x4_16b_bf16 v[80:83], v[10:11], v[70:71], v[80:83]
    v_mfma_f32_4x4x4_16b_bf16 v[76:79], v[10:11], v[68:69], v[76:79]
    v_perm_b32 v15, v19, v20, s47
    v_bitop3_b32 v46, v19, 0.5, -0.5 bitop3:0xa8
    v_perm_b32 v14, v18, v20, s46
    v_bitop3_b32 v47, v18, 0.5, -0.5 bitop3:0xa8
    v_cvt_pk_bf16_f32 v80, v80, v81
    v_cvt_pk_bf16_f32 v81, v82, v83
    ds_wrxchg_rtn_b64 v[74:75], v93, v[80:81] offset:65408
    v_cvt_pk_bf16_f32 v76, v76, v77
    v_cvt_pk_bf16_f32 v77, v78, v79
    ds_wrxchg_rtn_b64 v[72:73], v92, v[76:77] offset:65408
    s_setprio 2
    s_waitcnt lgkmcnt(2)
    v_mfma_f32_4x4x4_16b_bf16 v[80:83], v[8:9], v[106:107], 0
    v_mfma_f32_4x4x4_16b_bf16 v[76:79], v[8:9], v[104:105], 0
    v_bitop3_b32 v15, v6, v15, v46 bitop3:0xca
    v_bitop3_b32 v14, v6, v14, v47 bitop3:0xca
    s_nop 1
    v_pk_mul_f32 v[80:81], v[80:81], v[14:15] op_sel:[0,1] op_sel_hi:[1,1]
    v_pk_mul_f32 v[82:83], v[82:83], v[14:15] op_sel:[0,1] op_sel_hi:[1,1]
    v_pk_mul_f32 v[76:77], v[76:77], v[14:15] op_sel:[0,0] op_sel_hi:[1,0]
    v_pk_mul_f32 v[78:79], v[78:79], v[14:15] op_sel:[0,0] op_sel_hi:[1,0]
    s_waitcnt lgkmcnt(0)
    v_cmp_ne_u64 s[50:51], v[72:73], v[68:69]
    v_cmpx_ne_u64 s[54:55], v[74:75], v[70:71]
    s_and_b64 s[82:83], s[54:55], s[80:81]
    s_cbranch_scc1 L2_c138
L2_d138:
    v_mov_b64 v[84:85], v[70:71]
    v_mov_b32 v7, v93
    v_mov_b64 v[86:87], v[74:75]
    s_or_b64 s[80:81], s[80:81], s[54:55]
    s_mov_b64 exec, s[50:51]
    s_and_b64 s[82:83], s[50:51], s[80:81]
    s_cbranch_scc1 L2_c139
L2_d139:
    v_mov_b64 v[84:85], v[68:69]
    v_mov_b32 v7, v92
    v_mov_b64 v[86:87], v[72:73]
    s_mov_b64 exec, -1
    s_or_b64 s[80:81], s[80:81], s[50:51]
    ds_read_b64 v[70:71], v95 offset:65408
    ds_read_b64 v[68:69], v94 offset:65408
    s_waitcnt vmcnt(4)
    v_and_b32 v46, 0x20000000, v27
    v_lshrrev_b32 v47, 14, v23
    v_bitop3_b32 v47, v47, v5, v46 bitop3:0xea
    ds_read_b64 v[102:103], v47
    v_bitop3_b32 v93, v23, v5, v46 bitop3:0xea
    v_and_b32 v46, 0x10000000, v27
    v_lshrrev_b32 v47, 14, v22
    v_bitop3_b32 v47, v47, v5, v46 bitop3:0xea
    ds_read_b64 v[100:101], v47
    v_bitop3_b32 v92, v22, v5, v46 bitop3:0xea
    s_waitcnt lgkmcnt(2)
    v_mfma_f32_4x4x4_16b_bf16 v[80:83], v[10:11], v[70:71], v[80:83]
    v_mfma_f32_4x4x4_16b_bf16 v[76:79], v[10:11], v[68:69], v[76:79]
    v_perm_b32 v15, v23, v26, s45
    v_bitop3_b32 v46, v23, 0.5, -0.5 bitop3:0xa8
    v_perm_b32 v14, v22, v26, s44
    v_bitop3_b32 v47, v22, 0.5, -0.5 bitop3:0xa8
    v_cvt_pk_bf16_f32 v80, v80, v81
    v_cvt_pk_bf16_f32 v81, v82, v83
    ds_wrxchg_rtn_b64 v[74:75], v95, v[80:81] offset:65408
    v_cvt_pk_bf16_f32 v76, v76, v77
    v_cvt_pk_bf16_f32 v77, v78, v79
    ds_wrxchg_rtn_b64 v[72:73], v94, v[76:77] offset:65408
    s_waitcnt lgkmcnt(2)
    v_mfma_f32_4x4x4_16b_bf16 v[80:83], v[8:9], v[102:103], 0
    v_mfma_f32_4x4x4_16b_bf16 v[76:79], v[8:9], v[100:101], 0
    v_bitop3_b32 v15, v6, v15, v46 bitop3:0xca
    v_bitop3_b32 v14, v6, v14, v47 bitop3:0xca
    v_cmp_lt_u32 s[84:85], v5, v92
    s_nop 0
    v_pk_mul_f32 v[80:81], v[80:81], v[14:15] op_sel:[0,1] op_sel_hi:[1,1]
    v_pk_mul_f32 v[82:83], v[82:83], v[14:15] op_sel:[0,1] op_sel_hi:[1,1]
    v_pk_mul_f32 v[76:77], v[76:77], v[14:15] op_sel:[0,0] op_sel_hi:[1,0]
    v_pk_mul_f32 v[78:79], v[78:79], v[14:15] op_sel:[0,0] op_sel_hi:[1,0]
    s_waitcnt lgkmcnt(0)
    v_cmp_ne_u64 s[50:51], v[72:73], v[68:69]
    v_cmpx_ne_u64 s[54:55], v[74:75], v[70:71]
    s_and_b64 s[82:83], s[54:55], s[80:81]
    s_cbranch_scc1 L2_c140
L2_d140:
    v_mov_b64 v[84:85], v[70:71]
    v_mov_b32 v7, v95
    v_mov_b64 v[86:87], v[74:75]
    s_or_b64 s[80:81], s[80:81], s[54:55]
    s_mov_b64 exec, s[50:51]
    s_and_b64 s[82:83], s[50:51], s[80:81]
    s_cbranch_scc1 L2_c141
L2_d141:
    v_mov_b64 v[84:85], v[68:69]
    v_mov_b32 v7, v94
    v_mov_b64 v[86:87], v[72:73]
    s_mov_b64 exec, -1
    s_or_b64 s[80:81], s[80:81], s[50:51]
    ds_read_b64 v[70:71], v93 offset:65408
    s_and_b64 exec, s[84:85], s[80:81]
    v_mfma_f32_4x4x4_16b_bf16 v[76:79], v[12:13], v[84:85], 0
    v_mov_b32 v92, v7
    s_andn2_b64 s[80:81], s[80:81], s[84:85]
    v_mfma_f32_4x4x4_16b_bf16 v[76:79], v[10:11], v[86:87], v[76:79]
    s_mov_b64 exec, -1
    ds_read_b64 v[68:69], v92 offset:65408
    v_and_b32 v46, 0x80000000, v27
    v_lshrrev_b32 v47, 14, v25
    v_bitop3_b32 v47, v47, v5, v46 bitop3:0xea
    ds_read_b64 v[106:107], v47
    v_bitop3_b32 v95, v25, v5, v46 bitop3:0xea
    v_and_b32 v46, 0x40000000, v27
    v_lshrrev_b32 v47, 14, v24
    v_bitop3_b32 v47, v47, v5, v46 bitop3:0xea
    ds_read_b64 v[104:105], v47
    v_bitop3_b32 v94, v24, v5, v46 bitop3:0xea
    s_waitcnt lgkmcnt(2)
    v_mfma_f32_4x4x4_16b_bf16 v[80:83], v[10:11], v[70:71], v[80:83]
    v_mfma_f32_4x4x4_16b_bf16 v[76:79], v[10:11], v[68:69], v[76:79]
    v_perm_b32 v15, v25, v26, s47
    v_bitop3_b32 v46, v25, 0.5, -0.5 bitop3:0xa8
    v_perm_b32 v14, v24, v26, s46
    v_bitop3_b32 v47, v24, 0.5, -0.5 bitop3:0xa8
    v_cvt_pk_bf16_f32 v80, v80, v81
    v_cvt_pk_bf16_f32 v81, v82, v83
    ds_wrxchg_rtn_b64 v[74:75], v93, v[80:81] offset:65408
    v_cvt_pk_bf16_f32 v76, v76, v77
    v_cvt_pk_bf16_f32 v77, v78, v79
    ds_wrxchg_rtn_b64 v[72:73], v92, v[76:77] offset:65408
    s_setprio 1
    s_waitcnt lgkmcnt(2)
    v_mfma_f32_4x4x4_16b_bf16 v[80:83], v[8:9], v[106:107], 0
    v_mfma_f32_4x4x4_16b_bf16 v[76:79], v[8:9], v[104:105], 0
    v_bitop3_b32 v15, v6, v15, v46 bitop3:0xca
    v_bitop3_b32 v14, v6, v14, v47 bitop3:0xca
    s_nop 1
    v_pk_mul_f32 v[80:81], v[80:81], v[14:15] op_sel:[0,1] op_sel_hi:[1,1]
    v_pk_mul_f32 v[82:83], v[82:83], v[14:15] op_sel:[0,1] op_sel_hi:[1,1]
    v_pk_mul_f32 v[76:77], v[76:77], v[14:15] op_sel:[0,0] op_sel_hi:[1,0]
    v_pk_mul_f32 v[78:79], v[78:79], v[14:15] op_sel:[0,0] op_sel_hi:[1,0]
    s_lshl_b32 s3, s32, 12
    v_subrev_u32 v122, s3, v3
    s_mul_i32 s3, s33, 20000
    v_add_u32 v118, s3, v122
    v_add_u32 v119, 0x4000, v118
    s_lshl_b32 s3, s34, 7
    v_lshrrev_b32 v123, 7, v118
    v_and_b32 v120, 0x70, v118
    v_lshl_add_u32 v120, v123, 13, v120
    v_add_u32 v120, s3, v120
    v_lshrrev_b32 v123, 7, v119
    v_and_b32 v121, 0x70, v119
    v_lshl_add_u32 v121, v123, 13, v121
    v_add_u32 v121, s3, v121
    v_cmp_le_u32 vcc, 3616, v122
    s_mov_b64 exec, vcc
    v_mov_b32 v119, 2.0
    v_mov_b32 v121, 2.0
    s_mov_b64 exec, -1
    v_and_b32 v123, 0x30, v122
    v_lshlrev_b32 v123, 2, v123
    buffer_load_dwordx4 v[48:51], v123, s[24:27], 0 offen
    buffer_load_dwordx4 v[52:55], v123, s[24:27], 0 offen offset:16
    buffer_load_dwordx2 v[56:57], v123, s[24:27], 0 offen offset:32
    s_mov_b32 s12, s4
    s_mov_b32 s13, s5
    s_mov_b32 s14, 0x138800
    s_mov_b32 s15, 0x20000
    s_mov_b32 s16, s28
    s_mov_b32 s17, s29
    s_mov_b32 s18, 0x4e2000
    s_mov_b32 s19, 0x20000
    v_lshrrev_b32 v123, 2, v120
    buffer_load_dword v116, v123, s[12:15], 0 offen
    buffer_load_dwordx4 v[108:111], v120, s[16:19], 0 offen
    v_lshrrev_b32 v123, 2, v121
    buffer_load_dword v117, v123, s[12:15], 0 offen
    buffer_load_dwordx4 v[112:115], v121, s[16:19], 0 offen
    s_waitcnt lgkmcnt(0)
    v_cmp_ne_u64 s[50:51], v[72:73], v[68:69]
    v_cmpx_ne_u64 s[54:55], v[74:75], v[70:71]
    s_and_b64 s[82:83], s[54:55], s[80:81]
    s_cbranch_scc1 L2_c142
L2_d142:
    v_mov_b64 v[84:85], v[70:71]
    v_mov_b32 v7, v93
    v_mov_b64 v[86:87], v[74:75]
    s_or_b64 s[80:81], s[80:81], s[54:55]
    s_mov_b64 exec, s[50:51]
    s_and_b64 s[82:83], s[50:51], s[80:81]
    s_cbranch_scc1 L2_c143
L2_d143:
    v_mov_b64 v[84:85], v[68:69]
    v_mov_b32 v7, v92
    v_mov_b64 v[86:87], v[72:73]
    s_mov_b64 exec, -1
    s_or_b64 s[80:81], s[80:81], s[50:51]
    ds_read_b64 v[70:71], v95 offset:65408
    ds_read_b64 v[68:69], v94 offset:65408
    s_waitcnt vmcnt(9)
    v_and_b32 v46, 0x20000000, v33
    v_lshrrev_b32 v47, 14, v29
    v_bitop3_b32 v47, v47, v5, v46 bitop3:0xea
    ds_read_b64 v[102:103], v47
    v_bitop3_b32 v93, v29, v5, v46 bitop3:0xea
    v_and_b32 v46, 0x10000000, v33
    v_lshrrev_b32 v47, 14, v28
    v_bitop3_b32 v47, v47, v5, v46 bitop3:0xea
    ds_read_b64 v[100:101], v47
    v_bitop3_b32 v92, v28, v5, v46 bitop3:0xea
    s_waitcnt lgkmcnt(2)
    v_mfma_f32_4x4x4_16b_bf16 v[80:83], v[10:11], v[70:71], v[80:83]
    v_mfma_f32_4x4x4_16b_bf16 v[76:79], v[10:11], v[68:69], v[76:79]
    v_perm_b32 v15, v29, v32, s45
    v_bitop3_b32 v46, v29, 0.5, -0.5 bitop3:0xa8
    v_perm_b32 v14, v28, v32, s44
    v_bitop3_b32 v47, v28, 0.5, -0.5 bitop3:0xa8
    v_cvt_pk_bf16_f32 v80, v80, v81
    v_cvt_pk_bf16_f32 v81, v82, v83
    ds_wrxchg_rtn_b64 v[74:75], v95, v[80:81] offset:65408
    v_cvt_pk_bf16_f32 v76, v76, v77
    v_cvt_pk_bf16_f32 v77, v78, v79
    ds_wrxchg_rtn_b64 v[72:73], v94, v[76:77] offset:65408
    s_waitcnt lgkmcnt(2)
    v_mfma_f32_4x4x4_16b_bf16 v[80:83], v[8:9], v[102:103], 0
    v_mfma_f32_4x4x4_16b_bf16 v[76:79], v[8:9], v[100:101], 0
    v_bitop3_b32 v15, v6, v15, v46 bitop3:0xca
    v_bitop3_b32 v14, v6, v14, v47 bitop3:0xca
    v_cmp_lt_u32 s[84:85], v5, v92
    s_nop 0
    v_pk_mul_f32 v[80:81], v[80:81], v[14:15] op_sel:[0,1] op_sel_hi:[1,1]
    v_pk_mul_f32 v[82:83], v[82:83], v[14:15] op_sel:[0,1] op_sel_hi:[1,1]
    v_pk_mul_f32 v[76:77], v[76:77], v[14:15] op_sel:[0,0] op_sel_hi:[1,0]
    v_pk_mul_f32 v[78:79], v[78:79], v[14:15] op_sel:[0,0] op_sel_hi:[1,0]
    s_waitcnt lgkmcnt(0)
    v_cmp_ne_u64 s[50:51], v[72:73], v[68:69]
    v_cmpx_ne_u64 s[54:55], v[74:75], v[70:71]
    s_and_b64 s[82:83], s[54:55], s[80:81]
    s_cbranch_scc1 L2_c144
L2_d144:
    v_mov_b64 v[84:85], v[70:71]
    v_mov_b32 v7, v95
    v_mov_b64 v[86:87], v[74:75]
    s_or_b64 s[80:81], s[80:81], s[54:55]
    s_mov_b64 exec, s[50:51]
    s_and_b64 s[82:83], s[50:51], s[80:81]
    s_cbranch_scc1 L2_c145
L2_d145:
    v_mov_b64 v[84:85], v[68:69]
    v_mov_b32 v7, v94
    v_mov_b64 v[86:87], v[72:73]
    s_mov_b64 exec, -1
    s_or_b64 s[80:81], s[80:81], s[50:51]
    ds_read_b64 v[70:71], v93 offset:65408
    s_and_b64 exec, s[84:85], s[80:81]
    v_mfma_f32_4x4x4_16b_bf16 v[76:79], v[12:13], v[84:85], 0
    v_mov_b32 v92, v7
    s_andn2_b64 s[80:81], s[80:81], s[84:85]
    v_mfma_f32_4x4x4_16b_bf16 v[76:79], v[10:11], v[86:87], v[76:79]
    s_mov_b64 exec, -1
    ds_read_b64 v[68:69], v92 offset:65408
    v_and_b32 v46, 0x80000000, v33
    v_lshrrev_b32 v47, 14, v31
    v_bitop3_b32 v47, v47, v5, v46 bitop3:0xea
    ds_read_b64 v[106:107], v47
    v_bitop3_b32 v95, v31, v5, v46 bitop3:0xea
    v_and_b32 v46, 0x40000000, v33
    v_lshrrev_b32 v47, 14, v30
    v_bitop3_b32 v47, v47, v5, v46 bitop3:0xea
    ds_read_b64 v[104:105], v47
    v_bitop3_b32 v94, v30, v5, v46 bitop3:0xea
    s_waitcnt lgkmcnt(2)
    v_mfma_f32_4x4x4_16b_bf16 v[80:83], v[10:11], v[70:71], v[80:83]
    v_mfma_f32_4x4x4_16b_bf16 v[76:79], v[10:11], v[68:69], v[76:79]
    v_perm_b32 v15, v31, v32, s47
    v_bitop3_b32 v46, v31, 0.5, -0.5 bitop3:0xa8
    v_perm_b32 v14, v30, v32, s46
    v_bitop3_b32 v47, v30, 0.5, -0.5 bitop3:0xa8
    v_cvt_pk_bf16_f32 v80, v80, v81
    v_cvt_pk_bf16_f32 v81, v82, v83
    ds_wrxchg_rtn_b64 v[74:75], v93, v[80:81] offset:65408
    v_cvt_pk_bf16_f32 v76, v76, v77
    v_cvt_pk_bf16_f32 v77, v78, v79
    ds_wrxchg_rtn_b64 v[72:73], v92, v[76:77] offset:65408
    s_setprio 0
    s_waitcnt lgkmcnt(2)
    v_mfma_f32_4x4x4_16b_bf16 v[80:83], v[8:9], v[106:107], 0
    v_mfma_f32_4x4x4_16b_bf16 v[76:79], v[8:9], v[104:105], 0
    v_bitop3_b32 v15, v6, v15, v46 bitop3:0xca
    v_bitop3_b32 v14, v6, v14, v47 bitop3:0xca
    s_nop 1
    v_pk_mul_f32 v[80:81], v[80:81], v[14:15] op_sel:[0,1] op_sel_hi:[1,1]
    v_pk_mul_f32 v[82:83], v[82:83], v[14:15] op_sel:[0,1] op_sel_hi:[1,1]
    v_pk_mul_f32 v[76:77], v[76:77], v[14:15] op_sel:[0,0] op_sel_hi:[1,0]
    v_pk_mul_f32 v[78:79], v[78:79], v[14:15] op_sel:[0,0] op_sel_hi:[1,0]
    s_waitcnt lgkmcnt(0)
    v_cmp_ne_u64 s[50:51], v[72:73], v[68:69]
    v_cmpx_ne_u64 s[54:55], v[74:75], v[70:71]
    s_and_b64 s[82:83], s[54:55], s[80:81]
    s_cbranch_scc1 L2_c146
L2_d146:
    v_mov_b64 v[84:85], v[70:71]
    v_mov_b32 v7, v93
    v_mov_b64 v[86:87], v[74:75]
    s_or_b64 s[80:81], s[80:81], s[54:55]
    s_mov_b64 exec, s[50:51]
    s_and_b64 s[82:83], s[50:51], s[80:81]
    s_cbranch_scc1 L2_c147
L2_d147:
    v_mov_b64 v[84:85], v[68:69]
    v_mov_b32 v7, v92
    v_mov_b64 v[86:87], v[72:73]
    s_mov_b64 exec, -1
    s_or_b64 s[80:81], s[80:81], s[50:51]
    ds_read_b64 v[70:71], v95 offset:65408
    ds_read_b64 v[68:69], v94 offset:65408
    s_waitcnt vmcnt(7)
    v_and_b32 v46, 0x20000000, v39
    v_lshrrev_b32 v47, 14, v35
    v_bitop3_b32 v47, v47, v5, v46 bitop3:0xea
    ds_read_b64 v[102:103], v47
    v_bitop3_b32 v93, v35, v5, v46 bitop3:0xea
    v_and_b32 v46, 0x10000000, v39
    v_lshrrev_b32 v47, 14, v34
    v_bitop3_b32 v47, v47, v5, v46 bitop3:0xea
    ds_read_b64 v[100:101], v47
    v_bitop3_b32 v92, v34, v5, v46 bitop3:0xea
    v_and_b32 v46, 0x80000000, v39
    v_lshrrev_b32 v47, 14, v37
    v_bitop3_b32 v47, v47, v5, v46 bitop3:0xea
    ds_read_b64 v[106:107], v47
    v_and_b32 v46, 0x40000000, v39
    v_lshrrev_b32 v47, 14, v36
    v_bitop3_b32 v47, v47, v5, v46 bitop3:0xea
    ds_read_b64 v[104:105], v47
    s_waitcnt lgkmcnt(4)
    v_mfma_f32_4x4x4_16b_bf16 v[80:83], v[10:11], v[70:71], v[80:83]
    v_mfma_f32_4x4x4_16b_bf16 v[76:79], v[10:11], v[68:69], v[76:79]
    v_perm_b32 v15, v35, v38, s45
    v_bitop3_b32 v46, v35, 0.5, -0.5 bitop3:0xa8
    v_perm_b32 v14, v34, v38, s44
    v_bitop3_b32 v47, v34, 0.5, -0.5 bitop3:0xa8
    v_cvt_pk_bf16_f32 v80, v80, v81
    v_cvt_pk_bf16_f32 v81, v82, v83
    ds_wrxchg_rtn_b64 v[74:75], v95, v[80:81] offset:65408
    v_cvt_pk_bf16_f32 v76, v76, v77
    v_cvt_pk_bf16_f32 v77, v78, v79
    ds_wrxchg_rtn_b64 v[72:73], v94, v[76:77] offset:65408
    s_waitcnt lgkmcnt(4)
    v_mfma_f32_4x4x4_16b_bf16 v[80:83], v[8:9], v[102:103], 0
    v_mfma_f32_4x4x4_16b_bf16 v[76:79], v[8:9], v[100:101], 0
    v_bitop3_b32 v15, v6, v15, v46 bitop3:0xca
    v_bitop3_b32 v14, v6, v14, v47 bitop3:0xca
    v_cmp_lt_u32 s[84:85], v5, v92
    s_nop 0
    v_pk_mul_f32 v[80:81], v[80:81], v[14:15] op_sel:[0,1] op_sel_hi:[1,1]
    v_pk_mul_f32 v[82:83], v[82:83], v[14:15] op_sel:[0,1] op_sel_hi:[1,1]
    v_pk_mul_f32 v[76:77], v[76:77], v[14:15] op_sel:[0,0] op_sel_hi:[1,0]
    v_pk_mul_f32 v[78:79], v[78:79], v[14:15] op_sel:[0,0] op_sel_hi:[1,0]
    s_waitcnt lgkmcnt(0)
    v_cmp_ne_u64 s[50:51], v[72:73], v[68:69]
    v_cmpx_ne_u64 s[54:55], v[74:75], v[70:71]
    s_and_b64 s[82:83], s[54:55], s[80:81]
    s_cbranch_scc1 L2_c148
L2_d148:
    v_mov_b64 v[84:85], v[70:71]
    v_mov_b32 v7, v95
    v_mov_b64 v[86:87], v[74:75]
    s_or_b64 s[80:81], s[80:81], s[54:55]
    s_mov_b64 exec, s[50:51]
    s_and_b64 s[82:83], s[50:51], s[80:81]
    s_cbranch_scc1 L2_c149
L2_d149:
    v_mov_b64 v[84:85], v[68:69]
    v_mov_b32 v7, v94
    v_mov_b64 v[86:87], v[72:73]
    s_mov_b64 exec, -1
    s_or_b64 s[80:81], s[80:81], s[50:51]
    ds_read_b64 v[70:71], v93 offset:65408
    s_and_b64 exec, s[84:85], s[80:81]
    v_mfma_f32_4x4x4_16b_bf16 v[76:79], v[12:13], v[84:85], 0
    v_mov_b32 v92, v7
    s_andn2_b64 s[80:81], s[80:81], s[84:85]
    v_mfma_f32_4x4x4_16b_bf16 v[76:79], v[10:11], v[86:87], v[76:79]
    s_mov_b64 exec, -1
    ds_read_b64 v[68:69], v92 offset:65408
    s_waitcnt lgkmcnt(0)
    v_mfma_f32_4x4x4_16b_bf16 v[80:83], v[10:11], v[70:71], v[80:83]
    v_mfma_f32_4x4x4_16b_bf16 v[76:79], v[10:11], v[68:69], v[76:79]
    v_and_b32 v46, 0x40000000, v39
    v_bitop3_b32 v94, v36, v5, v46 bitop3:0xea
    v_and_b32 v46, 0x80000000, v39
    v_bitop3_b32 v95, v37, v5, v46 bitop3:0xea
    v_perm_b32 v15, v37, v38, s47
    v_bitop3_b32 v46, v37, 0.5, -0.5 bitop3:0xa8
    v_perm_b32 v14, v36, v38, s46
    v_bitop3_b32 v47, v36, 0.5, -0.5 bitop3:0xa8
    v_cvt_pk_bf16_f32 v80, v80, v81
    v_cvt_pk_bf16_f32 v81, v82, v83
    ds_wrxchg_rtn_b64 v[74:75], v93, v[80:81] offset:65408
    v_cvt_pk_bf16_f32 v76, v76, v77
    v_cvt_pk_bf16_f32 v77, v78, v79
    ds_wrxchg_rtn_b64 v[72:73], v92, v[76:77] offset:65408
    v_mfma_f32_4x4x4_16b_bf16 v[80:83], v[8:9], v[106:107], 0
    v_mfma_f32_4x4x4_16b_bf16 v[76:79], v[8:9], v[104:105], 0
    v_bitop3_b32 v15, v6, v15, v46 bitop3:0xca
    v_bitop3_b32 v14, v6, v14, v47 bitop3:0xca
    s_nop 1
    v_pk_mul_f32 v[80:81], v[80:81], v[14:15] op_sel:[0,1] op_sel_hi:[1,1]
    v_pk_mul_f32 v[82:83], v[82:83], v[14:15] op_sel:[0,1] op_sel_hi:[1,1]
    v_pk_mul_f32 v[76:77], v[76:77], v[14:15] op_sel:[0,0] op_sel_hi:[1,0]
    v_pk_mul_f32 v[78:79], v[78:79], v[14:15] op_sel:[0,0] op_sel_hi:[1,0]
    s_waitcnt lgkmcnt(0)
    v_cmp_ne_u64 s[50:51], v[72:73], v[68:69]
    v_cmpx_ne_u64 s[54:55], v[74:75], v[70:71]
    s_and_b64 s[82:83], s[54:55], s[80:81]
    s_cbranch_scc1 L2_c150
L2_d150:
    v_mov_b64 v[84:85], v[70:71]
    v_mov_b32 v7, v93
    v_mov_b64 v[86:87], v[74:75]
    s_or_b64 s[80:81], s[80:81], s[54:55]
    s_mov_b64 exec, s[50:51]
    s_and_b64 s[82:83], s[50:51], s[80:81]
    s_cbranch_scc1 L2_c151
L2_d151:
    v_mov_b64 v[84:85], v[68:69]
    v_mov_b32 v7, v92
    v_mov_b64 v[86:87], v[72:73]
    s_mov_b64 exec, -1
    s_or_b64 s[80:81], s[80:81], s[50:51]
    ds_read_b64 v[70:71], v95 offset:65408
    ds_read_b64 v[68:69], v94 offset:65408
    s_waitcnt lgkmcnt(0)
    v_mfma_f32_4x4x4_16b_bf16 v[80:83], v[10:11], v[70:71], v[80:83]
    v_mfma_f32_4x4x4_16b_bf16 v[76:79], v[10:11], v[68:69], v[76:79]
    s_nop 3
    v_cvt_pk_bf16_f32 v80, v80, v81
    v_cvt_pk_bf16_f32 v81, v82, v83
    ds_wrxchg_rtn_b64 v[74:75], v95, v[80:81] offset:65408
    v_cvt_pk_bf16_f32 v76, v76, v77
    v_cvt_pk_bf16_f32 v77, v78, v79
    ds_wrxchg_rtn_b64 v[72:73], v94, v[76:77] offset:65408
    s_waitcnt lgkmcnt(0)
    v_cmpx_ne_u64 vcc, v[74:75], v[70:71]
    s_and_b64 s[82:83], vcc, s[80:81]
    s_cbranch_scc1 L2_c152
L2_d152:
    v_mov_b64 v[84:85], v[70:71]
    v_mov_b32 v7, v95
    v_mov_b64 v[86:87], v[74:75]
    s_mov_b64 exec, -1
    s_or_b64 s[80:81], s[80:81], vcc
    v_cmpx_ne_u64 vcc, v[72:73], v[68:69]
    s_and_b64 s[82:83], vcc, s[80:81]
    s_cbranch_scc1 L2_c153
L2_d153:
    v_mov_b64 v[84:85], v[68:69]
    v_mov_b32 v7, v94
    v_mov_b64 v[86:87], v[72:73]
    s_mov_b64 exec, -1
    s_or_b64 s[80:81], s[80:81], vcc
    s_mov_b64 exec, s[80:81]
    ds_read_b64 v[68:69], v7 offset:65408
    v_mfma_f32_4x4x4_16b_bf16 v[76:79], v[12:13], v[84:85], 0
    s_nop 1
    v_mfma_f32_4x4x4_16b_bf16 v[76:79], v[10:11], v[86:87], v[76:79]
    s_waitcnt lgkmcnt(0)
    s_nop 0
    v_mfma_f32_4x4x4_16b_bf16 v[76:79], v[10:11], v[68:69], v[76:79]
    v_mov_b64 v[84:85], v[68:69]
    s_nop 3
    v_cvt_pk_bf16_f32 v76, v76, v77
    v_cvt_pk_bf16_f32 v77, v78, v79
    ds_wrxchg_rtn_b64 v[86:87], v7, v[76:77] offset:65408
    s_waitcnt lgkmcnt(0)
    v_cmp_ne_u64 s[80:81], v[86:87], v[84:85]
    s_mov_b64 exec, s[80:81]
    s_nop 1
    v_mfma_f32_4x4x4_16b_bf16 v[88:91], v[12:13], v[84:85], 0
    s_nop 1
    v_mfma_f32_4x4x4_16b_bf16 v[88:91], v[10:11], v[86:87], v[88:91]
    s_nop 4
    v_cvt_pk_bf16_f32 v88, v88, v89
    v_cvt_pk_bf16_f32 v89, v90, v91
    ds_pk_add_bf16 v7, v88 offset:65408
    ds_pk_add_bf16 v7, v89 offset:65412
    s_mov_b64 exec, -1
    s_load_dwordx2 s[4:5], s[0:1], 88
    v_add_u32 v123, 0x4000, v122
    s_lshl_b32 s50, s96, 16
    s_and_b32 s51, s96, 0xffff0000
    s_lshl_b32 s52, s97, 16
    s_and_b32 s53, s97, 0xffff0000
    s_lshl_b32 s54, s98, 16
    s_and_b32 s55, s98, 0xffff0000
    s_lshl_b32 s56, s99, 16
    s_and_b32 s57, s99, 0xffff0000
    s_waitcnt vmcnt(0) lgkmcnt(0)
    s_barrier
    s_add_u32 s8, s30, 0xec46000
    s_addc_u32 s9, s31, 0
    s_mov_b32 s10, 0x8000
    s_mov_b32 s11, 0x20000
    s_mov_b32 s12, s4
    s_mov_b32 s13, s5
    s_mov_b32 s14, 0x4e2000
    s_mov_b32 s15, 0x20000
    s_add_u32 s20, s30, 0xd845000
    s_addc_u32 s21, s31, 0
    s_mov_b32 s22, 0x1400000
    s_mov_b32 s23, 0x20000
    s_lshl2_add_u32 s4, s34, s33
    s_mul_i32 s4, s4, 81920
    s_add_u32 s3, s33, 1
    s_and_b32 s3, s3, 3
    s_mul_i32 s36, s3, 20000
    s_add_u32 s36, s36, 81920
    s_mul_i32 s40, s3, 20480
    s_add_u32 s40, s40, s4
    s_lshl2_add_u32 s3, s34, s3
    s_mul_i32 s3, s3, 81920
    s_mul_i32 s44, s33, 20480
    s_add_u32 s44, s44, s3
    s_add_u32 s3, s33, 2
    s_and_b32 s3, s3, 3
    s_mul_i32 s37, s3, 20000
    s_add_u32 s37, s37, 81920
    s_mul_i32 s41, s3, 20480
    s_add_u32 s41, s41, s4
    s_lshl2_add_u32 s3, s34, s3
    s_mul_i32 s3, s3, 81920
    s_mul_i32 s45, s33, 20480
    s_add_u32 s45, s45, s3
    s_add_u32 s3, s33, 3
    s_and_b32 s3, s3, 3
    s_mul_i32 s38, s3, 20000
    s_add_u32 s38, s38, 81920
    s_mul_i32 s42, s3, 20480
    s_add_u32 s42, s42, s4
    s_lshl2_add_u32 s3, s34, s3
    s_mul_i32 s3, s3, 81920
    s_mul_i32 s46, s33, 20480
    s_add_u32 s46, s46, s3
    v_add_u32 v104, s36, v122
    ds_read_b128 v[16:19], v104
    v_add_u32 v104, s37, v122
    ds_read_b128 v[20:23], v104
    v_add_u32 v104, s38, v122
    ds_read_b128 v[24:27], v104
    s_waitcnt lgkmcnt(2)
    buffer_store_dwordx4 v[16:19], v122, s[20:23], s40 offen sc1
    s_waitcnt lgkmcnt(1)
    buffer_store_dwordx4 v[20:23], v122, s[20:23], s41 offen sc1
    s_waitcnt lgkmcnt(0)
    buffer_store_dwordx4 v[24:27], v122, s[20:23], s42 offen sc1
    s_cmp_ge_u32 s32, 4
    s_cbranch_scc1 L2_g0
    v_add_u32 v104, s36, v123
    ds_read_b128 v[36:39], v104
    v_add_u32 v104, s37, v123
    ds_read_b128 v[40:43], v104
    v_add_u32 v104, s38, v123
    ds_read_b128 v[44:47], v104
    s_waitcnt lgkmcnt(2)
    buffer_store_dwordx4 v[36:39], v123, s[20:23], s40 offen sc1
    s_waitcnt lgkmcnt(1)
    buffer_store_dwordx4 v[40:43], v123, s[20:23], s41 offen sc1
    s_waitcnt lgkmcnt(0)
    buffer_store_dwordx4 v[44:47], v123, s[20:23], s42 offen sc1
L2_g0:
    v_lshlrev_b32 v80, 16, v116
    v_subrev_f32 v60, s50, v80
    v_subrev_f32 v61, s51, v80
    v_subrev_f32 v62, s52, v80
    v_subrev_f32 v63, s53, v80
    v_subrev_f32 v64, s54, v80
    v_subrev_f32 v65, s55, v80
    v_subrev_f32 v66, s56, v80
    v_subrev_f32 v67, s57, v80
    v_cvt_pk_bf16_f32 v68, v60, v61
    v_cvt_pk_bf16_f32 v69, v62, v63
    v_cvt_pk_bf16_f32 v70, v64, v65
    v_cvt_pk_bf16_f32 v71, v66, v67
    v_lshlrev_b32 v60, 16, v68
    v_and_b32 v61, 0xffff0000, v68
    v_lshlrev_b32 v62, 16, v69
    v_and_b32 v63, 0xffff0000, v69
    v_lshlrev_b32 v64, 16, v70
    v_and_b32 v65, 0xffff0000, v70
    v_lshlrev_b32 v66, 16, v71
    v_and_b32 v67, 0xffff0000, v71
    v_mul_f32 v60, v60, v60
    v_mul_f32 v61, v61, v61
    v_mul_f32 v62, v62, v62
    v_mul_f32 v63, v63, v63
    v_mul_f32 v64, v64, v64
    v_mul_f32 v65, v65, v65
    v_mul_f32 v66, v66, v66
    v_mul_f32 v67, v67, v67
    v_cvt_pk_bf16_f32 v68, v60, v61
    v_cvt_pk_bf16_f32 v69, v62, v63
    v_cvt_pk_bf16_f32 v70, v64, v65
    v_cvt_pk_bf16_f32 v71, v66, v67
    v_lshlrev_b32 v60, 16, v68
    v_and_b32 v61, 0xffff0000, v68
    v_lshlrev_b32 v62, 16, v69
    v_and_b32 v63, 0xffff0000, v69
    v_lshlrev_b32 v64, 16, v70
    v_and_b32 v65, 0xffff0000, v70
    v_lshlrev_b32 v66, 16, v71
    v_and_b32 v67, 0xffff0000, v71
    v_mul_f32 v60, 0xc1200000, v60
    v_mul_f32 v61, 0xc1200000, v61
    v_mul_f32 v62, 0xc1200000, v62
    v_mul_f32 v63, 0xc1200000, v63
    v_mul_f32 v64, 0xc1200000, v64
    v_mul_f32 v65, 0xc1200000, v65
    v_mul_f32 v66, 0xc1200000, v66
    v_mul_f32 v67, 0xc1200000, v67
    v_cvt_pk_bf16_f32 v68, v60, v61
    v_cvt_pk_bf16_f32 v69, v62, v63
    v_cvt_pk_bf16_f32 v70, v64, v65
    v_cvt_pk_bf16_f32 v71, v66, v67
    v_lshlrev_b32 v60, 16, v68
    v_and_b32 v61, 0xffff0000, v68
    v_lshlrev_b32 v62, 16, v69
    v_and_b32 v63, 0xffff0000, v69
    v_lshlrev_b32 v64, 16, v70
    v_and_b32 v65, 0xffff0000, v70
    v_lshlrev_b32 v66, 16, v71
    v_and_b32 v67, 0xffff0000, v71
    v_mul_f32 v60, 0x3fb8aa3b, v60
    v_mul_f32 v61, 0x3fb8aa3b, v61
    v_mul_f32 v62, 0x3fb8aa3b, v62
    v_mul_f32 v63, 0x3fb8aa3b, v63
    v_mul_f32 v64, 0x3fb8aa3b, v64
    v_mul_f32 v65, 0x3fb8aa3b, v65
    v_mul_f32 v66, 0x3fb8aa3b, v66
    v_mul_f32 v67, 0x3fb8aa3b, v67
    v_exp_f32 v60, v60
    v_exp_f32 v61, v61
    v_exp_f32 v62, v62
    v_exp_f32 v63, v63
    v_exp_f32 v64, v64
    v_exp_f32 v65, v65
    v_exp_f32 v66, v66
    v_exp_f32 v67, v67
    v_cvt_pk_bf16_f32 v72, v60, v61
    v_cvt_pk_bf16_f32 v73, v62, v63
    v_cvt_pk_bf16_f32 v74, v64, v65
    v_cvt_pk_bf16_f32 v75, v66, v67
    v_and_b32 v80, 0xffff0000, v116
    v_subrev_f32 v60, s50, v80
    v_subrev_f32 v61, s51, v80
    v_subrev_f32 v62, s52, v80
    v_subrev_f32 v63, s53, v80
    v_subrev_f32 v64, s54, v80
    v_subrev_f32 v65, s55, v80
    v_subrev_f32 v66, s56, v80
    v_subrev_f32 v67, s57, v80
    v_cvt_pk_bf16_f32 v68, v60, v61
    v_cvt_pk_bf16_f32 v69, v62, v63
    v_cvt_pk_bf16_f32 v70, v64, v65
    v_cvt_pk_bf16_f32 v71, v66, v67
    v_lshlrev_b32 v60, 16, v68
    v_and_b32 v61, 0xffff0000, v68
    v_lshlrev_b32 v62, 16, v69
    v_and_b32 v63, 0xffff0000, v69
    v_lshlrev_b32 v64, 16, v70
    v_and_b32 v65, 0xffff0000, v70
    v_lshlrev_b32 v66, 16, v71
    v_and_b32 v67, 0xffff0000, v71
    v_mul_f32 v60, v60, v60
    v_mul_f32 v61, v61, v61
    v_mul_f32 v62, v62, v62
    v_mul_f32 v63, v63, v63
    v_mul_f32 v64, v64, v64
    v_mul_f32 v65, v65, v65
    v_mul_f32 v66, v66, v66
    v_mul_f32 v67, v67, v67
    v_cvt_pk_bf16_f32 v68, v60, v61
    v_cvt_pk_bf16_f32 v69, v62, v63
    v_cvt_pk_bf16_f32 v70, v64, v65
    v_cvt_pk_bf16_f32 v71, v66, v67
    v_lshlrev_b32 v60, 16, v68
    v_and_b32 v61, 0xffff0000, v68
    v_lshlrev_b32 v62, 16, v69
    v_and_b32 v63, 0xffff0000, v69
    v_lshlrev_b32 v64, 16, v70
    v_and_b32 v65, 0xffff0000, v70
    v_lshlrev_b32 v66, 16, v71
    v_and_b32 v67, 0xffff0000, v71
    v_mul_f32 v60, 0xc1200000, v60
    v_mul_f32 v61, 0xc1200000, v61
    v_mul_f32 v62, 0xc1200000, v62
    v_mul_f32 v63, 0xc1200000, v63
    v_mul_f32 v64, 0xc1200000, v64
    v_mul_f32 v65, 0xc1200000, v65
    v_mul_f32 v66, 0xc1200000, v66
    v_mul_f32 v67, 0xc1200000, v67
    v_cvt_pk_bf16_f32 v68, v60, v61
    v_cvt_pk_bf16_f32 v69, v62, v63
    v_cvt_pk_bf16_f32 v70, v64, v65
    v_cvt_pk_bf16_f32 v71, v66, v67
    v_lshlrev_b32 v60, 16, v68
    v_and_b32 v61, 0xffff0000, v68
    v_lshlrev_b32 v62, 16, v69
    v_and_b32 v63, 0xffff0000, v69
    v_lshlrev_b32 v64, 16, v70
    v_and_b32 v65, 0xffff0000, v70
    v_lshlrev_b32 v66, 16, v71
    v_and_b32 v67, 0xffff0000, v71
    v_mul_f32 v60, 0x3fb8aa3b, v60
    v_mul_f32 v61, 0x3fb8aa3b, v61
    v_mul_f32 v62, 0x3fb8aa3b, v62
    v_mul_f32 v63, 0x3fb8aa3b, v63
    v_mul_f32 v64, 0x3fb8aa3b, v64
    v_mul_f32 v65, 0x3fb8aa3b, v65
    v_mul_f32 v66, 0x3fb8aa3b, v66
    v_mul_f32 v67, 0x3fb8aa3b, v67
    v_exp_f32 v60, v60
    v_exp_f32 v61, v61
    v_exp_f32 v62, v62
    v_exp_f32 v63, v63
    v_exp_f32 v64, v64
    v_exp_f32 v65, v65
    v_exp_f32 v66, v66
    v_exp_f32 v67, v67
    v_cvt_pk_bf16_f32 v76, v60, v61
    v_cvt_pk_bf16_f32 v77, v62, v63
    v_cvt_pk_bf16_f32 v78, v64, v65
    v_cvt_pk_bf16_f32 v79, v66, v67
    v_mfma_f32_4x4x4_16b_bf16 v[80:83], v[48:49], v[72:73], 0
    v_mfma_f32_4x4x4_16b_bf16 v[88:91], v[52:53], v[72:73], 0
    v_mfma_f32_4x4x4_16b_bf16 v[84:87], v[48:49], v[76:77], 0
    v_mfma_f32_4x4x4_16b_bf16 v[92:95], v[52:53], v[76:77], 0
    v_mfma_f32_4x4x4_16b_bf16 v[80:83], v[50:51], v[74:75], v[80:83]
    v_mfma_f32_4x4x4_16b_bf16 v[88:91], v[54:55], v[74:75], v[88:91]
    v_mfma_f32_4x4x4_16b_bf16 v[84:87], v[50:51], v[78:79], v[84:87]
    v_mfma_f32_4x4x4_16b_bf16 v[92:95], v[54:55], v[78:79], v[92:95]
    s_lshl_b32 s3, s34, 9
    s_lshl_b32 s4, s33, 7
    s_add_u32 s4, s4, s3
    v_mov_b32 v104, 1
    v_and_b32 v105, 0x3f0, v122
    v_lshlrev_b32 v105, 3, v105
    v_add_u32 v106, 81920, v118
    ds_read_b128 v[32:35], v106
    v_add_u32 v106, 81920, v119
    ds_read_b128 v[60:63], v106
    s_waitcnt vmcnt(0)
    s_barrier
    s_cmp_lg_u32 s32, 0
    s_cbranch_scc1 L2_f2
    s_mov_b64 exec, 1
    buffer_store_dword v104, off, s[8:11], s4 sc1
    s_mov_b64 exec, 15
    s_bitset0_b64 exec, s33
L2_f3:
    buffer_load_dword v104, v105, s[8:11], s3 offen sc1
    s_waitcnt vmcnt(0)
    v_cmp_ne_u32 vcc, 1, v104
    s_cbranch_vccnz L2_f3s
    s_mov_b64 exec, -1
L2_f2:
    s_barrier
    buffer_load_dwordx4 v[36:39], v122, s[20:23], s44 offen sc1
    buffer_load_dwordx4 v[40:43], v122, s[20:23], s45 offen sc1
    buffer_load_dwordx4 v[44:47], v122, s[20:23], s46 offen sc1
    s_cmp_ge_u32 s32, 4
    s_cbranch_scc1 L2_f5
    buffer_load_dwordx4 v[64:67], v123, s[20:23], s44 offen sc1
    buffer_load_dwordx4 v[68:71], v123, s[20:23], s45 offen sc1
    buffer_load_dwordx4 v[72:75], v123, s[20:23], s46 offen sc1
    v_lshlrev_b32 v16, 16, v117
    v_subrev_f32 v96, s50, v16
    v_subrev_f32 v97, s51, v16
    v_subrev_f32 v98, s52, v16
    v_subrev_f32 v99, s53, v16
    v_subrev_f32 v100, s54, v16
    v_subrev_f32 v101, s55, v16
    v_subrev_f32 v102, s56, v16
    v_subrev_f32 v103, s57, v16
    v_cvt_pk_bf16_f32 v0, v96, v97
    v_cvt_pk_bf16_f32 v1, v98, v99
    v_cvt_pk_bf16_f32 v2, v100, v101
    v_cvt_pk_bf16_f32 v3, v102, v103
    v_lshlrev_b32 v96, 16, v0
    v_and_b32 v97, 0xffff0000, v0
    v_lshlrev_b32 v98, 16, v1
    v_and_b32 v99, 0xffff0000, v1
    v_lshlrev_b32 v100, 16, v2
    v_and_b32 v101, 0xffff0000, v2
    v_lshlrev_b32 v102, 16, v3
    v_and_b32 v103, 0xffff0000, v3
    v_mul_f32 v96, v96, v96
    v_mul_f32 v97, v97, v97
    v_mul_f32 v98, v98, v98
    v_mul_f32 v99, v99, v99
    v_mul_f32 v100, v100, v100
    v_mul_f32 v101, v101, v101
    v_mul_f32 v102, v102, v102
    v_mul_f32 v103, v103, v103
    v_cvt_pk_bf16_f32 v0, v96, v97
    v_cvt_pk_bf16_f32 v1, v98, v99
    v_cvt_pk_bf16_f32 v2, v100, v101
    v_cvt_pk_bf16_f32 v3, v102, v103
    v_lshlrev_b32 v96, 16, v0
    v_and_b32 v97, 0xffff0000, v0
    v_lshlrev_b32 v98, 16, v1
    v_and_b32 v99, 0xffff0000, v1
    v_lshlrev_b32 v100, 16, v2
    v_and_b32 v101, 0xffff0000, v2
    v_lshlrev_b32 v102, 16, v3
    v_and_b32 v103, 0xffff0000, v3
    v_mul_f32 v96, 0xc1200000, v96
    v_mul_f32 v97, 0xc1200000, v97
    v_mul_f32 v98, 0xc1200000, v98
    v_mul_f32 v99, 0xc1200000, v99
    v_mul_f32 v100, 0xc1200000, v100
    v_mul_f32 v101, 0xc1200000, v101
    v_mul_f32 v102, 0xc1200000, v102
    v_mul_f32 v103, 0xc1200000, v103
    v_cvt_pk_bf16_f32 v0, v96, v97
    v_cvt_pk_bf16_f32 v1, v98, v99
    v_cvt_pk_bf16_f32 v2, v100, v101
    v_cvt_pk_bf16_f32 v3, v102, v103
    v_lshlrev_b32 v96, 16, v0
    v_and_b32 v97, 0xffff0000, v0
    v_lshlrev_b32 v98, 16, v1
    v_and_b32 v99, 0xffff0000, v1
    v_lshlrev_b32 v100, 16, v2
    v_and_b32 v101, 0xffff0000, v2
    v_lshlrev_b32 v102, 16, v3
    v_and_b32 v103, 0xffff0000, v3
    v_mul_f32 v96, 0x3fb8aa3b, v96
    v_mul_f32 v97, 0x3fb8aa3b, v97
    v_mul_f32 v98, 0x3fb8aa3b, v98
    v_mul_f32 v99, 0x3fb8aa3b, v99
    v_mul_f32 v100, 0x3fb8aa3b, v100
    v_mul_f32 v101, 0x3fb8aa3b, v101
    v_mul_f32 v102, 0x3fb8aa3b, v102
    v_mul_f32 v103, 0x3fb8aa3b, v103
    v_exp_f32 v96, v96
    v_exp_f32 v97, v97
    v_exp_f32 v98, v98
    v_exp_f32 v99, v99
    v_exp_f32 v100, v100
    v_exp_f32 v101, v101
    v_exp_f32 v102, v102
    v_exp_f32 v103, v103
    v_cvt_pk_bf16_f32 v104, v96, v97
    v_cvt_pk_bf16_f32 v105, v98, v99
    v_cvt_pk_bf16_f32 v106, v100, v101
    v_cvt_pk_bf16_f32 v107, v102, v103
    v_and_b32 v16, 0xffff0000, v117
    v_subrev_f32 v96, s50, v16
    v_subrev_f32 v97, s51, v16
    v_subrev_f32 v98, s52, v16
    v_subrev_f32 v99, s53, v16
    v_subrev_f32 v100, s54, v16
    v_subrev_f32 v101, s55, v16
    v_subrev_f32 v102, s56, v16
    v_subrev_f32 v103, s57, v16
    v_cvt_pk_bf16_f32 v0, v96, v97
    v_cvt_pk_bf16_f32 v1, v98, v99
    v_cvt_pk_bf16_f32 v2, v100, v101
    v_cvt_pk_bf16_f32 v3, v102, v103
    v_lshlrev_b32 v96, 16, v0
    v_and_b32 v97, 0xffff0000, v0
    v_lshlrev_b32 v98, 16, v1
    v_and_b32 v99, 0xffff0000, v1
    v_lshlrev_b32 v100, 16, v2
    v_and_b32 v101, 0xffff0000, v2
    v_lshlrev_b32 v102, 16, v3
    v_and_b32 v103, 0xffff0000, v3
    v_mul_f32 v96, v96, v96
    v_mul_f32 v97, v97, v97
    v_mul_f32 v98, v98, v98
    v_mul_f32 v99, v99, v99
    v_mul_f32 v100, v100, v100
    v_mul_f32 v101, v101, v101
    v_mul_f32 v102, v102, v102
    v_mul_f32 v103, v103, v103
    v_cvt_pk_bf16_f32 v0, v96, v97
    v_cvt_pk_bf16_f32 v1, v98, v99
    v_cvt_pk_bf16_f32 v2, v100, v101
    v_cvt_pk_bf16_f32 v3, v102, v103
    v_lshlrev_b32 v96, 16, v0
    v_and_b32 v97, 0xffff0000, v0
    v_lshlrev_b32 v98, 16, v1
    v_and_b32 v99, 0xffff0000, v1
    v_lshlrev_b32 v100, 16, v2
    v_and_b32 v101, 0xffff0000, v2
    v_lshlrev_b32 v102, 16, v3
    v_and_b32 v103, 0xffff0000, v3
    v_mul_f32 v96, 0xc1200000, v96
    v_mul_f32 v97, 0xc1200000, v97
    v_mul_f32 v98, 0xc1200000, v98
    v_mul_f32 v99, 0xc1200000, v99
    v_mul_f32 v100, 0xc1200000, v100
    v_mul_f32 v101, 0xc1200000, v101
    v_mul_f32 v102, 0xc1200000, v102
    v_mul_f32 v103, 0xc1200000, v103
    v_cvt_pk_bf16_f32 v0, v96, v97
    v_cvt_pk_bf16_f32 v1, v98, v99
    v_cvt_pk_bf16_f32 v2, v100, v101
    v_cvt_pk_bf16_f32 v3, v102, v103
    v_lshlrev_b32 v96, 16, v0
    v_and_b32 v97, 0xffff0000, v0
    v_lshlrev_b32 v98, 16, v1
    v_and_b32 v99, 0xffff0000, v1
    v_lshlrev_b32 v100, 16, v2
    v_and_b32 v101, 0xffff0000, v2
    v_lshlrev_b32 v102, 16, v3
    v_and_b32 v103, 0xffff0000, v3
    v_mul_f32 v96, 0x3fb8aa3b, v96
    v_mul_f32 v97, 0x3fb8aa3b, v97
    v_mul_f32 v98, 0x3fb8aa3b, v98
    v_mul_f32 v99, 0x3fb8aa3b, v99
    v_mul_f32 v100, 0x3fb8aa3b, v100
    v_mul_f32 v101, 0x3fb8aa3b, v101
    v_mul_f32 v102, 0x3fb8aa3b, v102
    v_mul_f32 v103, 0x3fb8aa3b, v103
    v_exp_f32 v96, v96
    v_exp_f32 v97, v97
    v_exp_f32 v98, v98
    v_exp_f32 v99, v99
    v_exp_f32 v100, v100
    v_exp_f32 v101, v101
    v_exp_f32 v102, v102
    v_exp_f32 v103, v103
    v_cvt_pk_bf16_f32 v76, v96, v97
    v_cvt_pk_bf16_f32 v77, v98, v99
    v_cvt_pk_bf16_f32 v78, v100, v101
    v_cvt_pk_bf16_f32 v79, v102, v103
    v_mfma_f32_4x4x4_16b_bf16 v[16:19], v[48:49], v[104:105], 0
    v_mfma_f32_4x4x4_16b_bf16 v[24:27], v[52:53], v[104:105], 0
    v_mfma_f32_4x4x4_16b_bf16 v[20:23], v[48:49], v[76:77], 0
    v_mfma_f32_4x4x4_16b_bf16 v[28:31], v[52:53], v[76:77], 0
    v_mfma_f32_4x4x4_16b_bf16 v[16:19], v[50:51], v[106:107], v[16:19]
    v_mfma_f32_4x4x4_16b_bf16 v[24:27], v[54:55], v[106:107], v[24:27]
    v_mfma_f32_4x4x4_16b_bf16 v[20:23], v[50:51], v[78:79], v[20:23]
    v_mfma_f32_4x4x4_16b_bf16 v[28:31], v[54:55], v[78:79], v[28:31]
L2_f5:
    s_waitcnt vmcnt(0) lgkmcnt(0)
    v_mfma_f32_4x4x4_16b_bf16 v[96:99], v[10:11], v[32:33], 0
    v_mfma_f32_4x4x4_16b_bf16 v[100:103], v[10:11], v[34:35], 0
    s_nop 0
    v_mfma_f32_4x4x4_16b_bf16 v[96:99], v[10:11], v[36:37], v[96:99]
    v_mfma_f32_4x4x4_16b_bf16 v[100:103], v[10:11], v[38:39], v[100:103]
    s_nop 0
    v_mfma_f32_4x4x4_16b_bf16 v[96:99], v[10:11], v[40:41], v[96:99]
    v_mfma_f32_4x4x4_16b_bf16 v[100:103], v[10:11], v[42:43], v[100:103]
    s_nop 0
    v_mfma_f32_4x4x4_16b_bf16 v[96:99], v[10:11], v[44:45], v[96:99]
    v_mfma_f32_4x4x4_16b_bf16 v[100:103], v[10:11], v[46:47], v[100:103]
    s_nop 3
    v_mul_f32 v96, v96, v80
    v_mul_f32 v97, v97, v81
    v_mul_f32 v98, v98, v82
    v_mul_f32 v99, v99, v83
    v_cvt_pk_bf16_f32 v32, v96, v97
    v_cvt_pk_bf16_f32 v33, v98, v99
    v_mul_f32 v100, v100, v84
    v_mul_f32 v101, v101, v85
    v_mul_f32 v102, v102, v86
    v_mul_f32 v103, v103, v87
    v_cvt_pk_bf16_f32 v34, v100, v101
    v_cvt_pk_bf16_f32 v35, v102, v103
    v_mfma_f32_4x4x4_16b_bf16 v[80:83], v[56:57], v[32:33], 0
    s_nop 0
    v_mfma_f32_4x4x4_16b_bf16 v[84:87], v[56:57], v[34:35], 0
    s_nop 2
    v_mul_f32 v80, v80, v88
    v_mul_f32 v81, v81, v89
    v_mul_f32 v82, v82, v90
    v_mul_f32 v83, v83, v91
    v_mul_f32 v84, v84, v92
    v_mul_f32 v85, v85, v93
    v_mul_f32 v86, v86, v94
    v_mul_f32 v87, v87, v95
    v_mfma_f32_4x4x4_16b_bf16 v[96:99], v[10:11], v[108:109], v[80:83]
    s_nop 0
    v_mfma_f32_4x4x4_16b_bf16 v[100:103], v[10:11], v[110:111], v[84:87]
    s_nop 2
    v_cvt_pk_bf16_f32 v36, v96, v97
    v_cvt_pk_bf16_f32 v37, v98, v99
    v_cvt_pk_bf16_f32 v38, v100, v101
    v_cvt_pk_bf16_f32 v39, v102, v103
    buffer_store_dwordx4 v[36:39], v120, s[12:15], 0 offen nt
    s_cmp_ge_u32 s32, 4
    s_cbranch_scc1 L2_f6
    v_mfma_f32_4x4x4_16b_bf16 v[96:99], v[10:11], v[60:61], 0
    v_mfma_f32_4x4x4_16b_bf16 v[100:103], v[10:11], v[62:63], 0
    s_nop 0
    v_mfma_f32_4x4x4_16b_bf16 v[96:99], v[10:11], v[64:65], v[96:99]
    v_mfma_f32_4x4x4_16b_bf16 v[100:103], v[10:11], v[66:67], v[100:103]
    s_nop 0
    v_mfma_f32_4x4x4_16b_bf16 v[96:99], v[10:11], v[68:69], v[96:99]
    v_mfma_f32_4x4x4_16b_bf16 v[100:103], v[10:11], v[70:71], v[100:103]
    s_nop 0
    v_mfma_f32_4x4x4_16b_bf16 v[96:99], v[10:11], v[72:73], v[96:99]
    v_mfma_f32_4x4x4_16b_bf16 v[100:103], v[10:11], v[74:75], v[100:103]
    s_nop 3
    v_mul_f32 v96, v96, v16
    v_mul_f32 v97, v97, v17
    v_mul_f32 v98, v98, v18
    v_mul_f32 v99, v99, v19
    v_cvt_pk_bf16_f32 v60, v96, v97
    v_cvt_pk_bf16_f32 v61, v98, v99
    v_mul_f32 v100, v100, v20
    v_mul_f32 v101, v101, v21
    v_mul_f32 v102, v102, v22
    v_mul_f32 v103, v103, v23
    v_cvt_pk_bf16_f32 v62, v100, v101
    v_cvt_pk_bf16_f32 v63, v102, v103
    v_mfma_f32_4x4x4_16b_bf16 v[16:19], v[56:57], v[60:61], 0
    s_nop 0
    v_mfma_f32_4x4x4_16b_bf16 v[20:23], v[56:57], v[62:63], 0
    s_nop 2
    v_mul_f32 v16, v16, v24
    v_mul_f32 v17, v17, v25
    v_mul_f32 v18, v18, v26
    v_mul_f32 v19, v19, v27
    v_mul_f32 v20, v20, v28
    v_mul_f32 v21, v21, v29
    v_mul_f32 v22, v22, v30
    v_mul_f32 v23, v23, v31
    v_mfma_f32_4x4x4_16b_bf16 v[96:99], v[10:11], v[112:113], v[16:19]
    s_nop 0
    v_mfma_f32_4x4x4_16b_bf16 v[100:103], v[10:11], v[114:115], v[20:23]
    s_nop 2
    v_cvt_pk_bf16_f32 v64, v96, v97
    v_cvt_pk_bf16_f32 v65, v98, v99
    v_cvt_pk_bf16_f32 v66, v100, v101
    v_cvt_pk_bf16_f32 v67, v102, v103
    buffer_store_dwordx4 v[64:67], v121, s[12:15], 0 offen nt
L2_f6:
L2_end:
    s_endpgm
L2_slow:
    s_lshr_b32 s35, s42, 2
    s_lshl_b32 s50, s32, 4
    s_and_b32 s3, s42, 3
    s_lshl_b32 s53, s3, 3
    s_add_u32 s53, s53, s39
    s_and_b32 s3, s35, 2
    s_lshl_b32 s3, s3, 1
    s_add_u32 s53, s53, s3
    s_and_b32 s54, s35, 1
    s_lshl_b32 s54, s54, 4
L2_sl_seg:
    s_mul_i32 s55, s50, 173056
    s_and_b32 s3, s50, 3
    s_lshl_b32 s3, s3, 5
    s_add_u32 s3, s3, s55
    s_add_u32 s3, s3, s53
    buffer_load_dword v104, off, s[12:15], s3 sc1
    buffer_load_dword v105, off, s[12:15], s3 offset:32 sc1
    s_waitcnt vmcnt(0)
    v_readfirstlane_b32 s51, v104
    v_readfirstlane_b32 s52, v105
    s_lshr_b32 s51, s51, s54
    s_and_b32 s51, s51, 0xffff
    s_lshr_b32 s52, s52, s54
    s_and_b32 s52, s52, 0xffff
L2_sl_rec:
    s_cmp_ge_u32 s51, s52
    s_cbranch_scc1 L2_sl_next
    v_mbcnt_lo_u32_b32 v102, -1, 0
    v_mbcnt_hi_u32_b32 v102, -1, v102
    v_add_u32 v102, s51, v102
    v_and_b32 v103, -4, v102
    v_lshl_add_u32 v104, v102, 2, v103
    v_lshl_add_u32 v105, v103, 2, v102
    v_cmp_gt_u32 vcc, s52, v102
    s_mov_b64 exec, vcc
    buffer_load_dword v106, v104, s[8:11], s55 offen
    buffer_load_ubyte v107, v105, s[8:11], s55 offen offset:16
    s_waitcnt vmcnt(0)
    v_lshrrev_b32 v98, 14, v106
    v_and_b32 v98, v5, v98
    ds_read_b64 v[100:101], v98
    v_perm_b32 v97, v106, v107, s44
    v_and_b32 v96, v5, v106
    v_bitop3_b32 v103, v106, 0.5, -0.5 bitop3:0xa8
    v_bitop3_b32 v97, v6, v97, v103 bitop3:0xca
    s_waitcnt lgkmcnt(0)
    v_mfma_f32_4x4x4_16b_bf16 v[88:91], v[8:9], v[100:101], 0
    s_nop 4
    v_mul_f32 v88, v97, v88
    v_mul_f32 v89, v97, v89
    v_mul_f32 v90, v97, v90
    v_mul_f32 v91, v97, v91
    v_cvt_pk_bf16_f32 v88, v88, v89
    v_cvt_pk_bf16_f32 v89, v90, v91
    ds_pk_add_bf16 v96, v88 offset:65408
    ds_pk_add_bf16 v96, v89 offset:65412
    s_mov_b64 exec, -1
    s_add_u32 s51, s51, 64
    s_branch L2_sl_rec
L2_sl_next:
    s_add_u32 s50, s50, 1
    s_and_b32 s3, s50, 15
    s_cbranch_scc1 L2_sl_seg
    s_add_u32 s50, s50, 240
    s_cmp_lt_u32 s50, 1280
    s_cbranch_scc1 L2_sl_seg
    s_waitcnt lgkmcnt(0)
    s_cmp_eq_u32 s42, 0
    s_cbranch_scc1 L2_ret0
    s_cmp_eq_u32 s42, 1
    s_cbranch_scc1 L2_ret1
    s_cmp_eq_u32 s42, 14
    s_cbranch_scc1 L2_ret6
    s_cmp_eq_u32 s42, 15
    s_cbranch_scc1 L2_ret7
    s_and_b32 s3, s42, 3
    s_cmp_eq_u32 s3, 2
    s_cbranch_scc1 L2_ret2
    s_cmp_eq_u32 s3, 3
    s_cbranch_scc1 L2_ret3
    s_cmp_eq_u32 s3, 0
    s_cbranch_scc1 L2_ret4
    s_branch L2_ret5
L2_p1s:
    s_sleep 32
    s_branch L2_p1
L2_xo3:
    v_cmp_lt_u32 vcc, 20, v99
    s_mov_b32 s101, 1
    s_cbranch_vccz L2_xp3
    v_cmp_lt_u32 vcc, 32, v99
    v_cmp_lt_u32 s[58:59], 31, v88
    s_mov_b32 s101, 2
    s_or_b64 vcc, vcc, s[58:59]
    s_cbranch_scc0 L2_xp3
    s_mov_b32 s37, 0x10000
    s_branch L2_xp3
L2_xa4:
    s_cmp_eq_u32 s101, 1
    s_cbranch_scc1 L2_xc4
    v_lshlrev_b32 v89, 0, v96
    v_add_u32 v90, 140, v97
    v_bitop3_b32 v90, v89, v45, v90 bitop3:0x6a
    ds_write_b32 v98, v90 offset:28
    v_lshlrev_b32 v89, 4, v96
    v_add_u32 v90, 120, v97
    v_bitop3_b32 v90, v89, v45, v90 bitop3:0x6a
    ds_write_b32 v98, v90 offset:24
    v_lshlrev_b32 v89, 8, v96
    v_add_u32 v90, 100, v97
    v_bitop3_b32 v90, v89, v45, v90 bitop3:0x6a
    ds_write_b32 v98, v90 offset:20
L2_xc4:
    v_lshlrev_b32 v89, 12, v96
    v_add_u32 v90, 80, v97
    v_bitop3_b32 v90, v89, v45, v90 bitop3:0x6a
    ds_write_b32 v98, v90 offset:16
    s_branch L2_xb4
L2_xe4:
    v_cmp_lt_u32 vcc, 32, v99
    v_cmp_lt_u32 s[58:59], 31, v88
    v_lshrrev_b32 v89, 16, v96
    v_add_u32 v97, 80, v97
    s_or_b64 vcc, vcc, s[58:59]
    s_cbranch_scc1 L2_xs4
    v_lshlrev_b32 v89, v1, v89
    v_and_b32 v89, v45, v89
    v_cmp_ne_u32 vcc, 0, v89
    v_xor_b32 v90, v97, v89
    s_add_u32 s3, s37, s38
    v_mbcnt_lo_u32_b32 v98, vcc_lo, 0
    v_mbcnt_hi_u32_b32 v98, vcc_hi, v98
    s_bcnt1_i32_b64 s41, vcc
    v_lshl_add_u32 v98, v98, 2, s3
    s_mov_b64 exec, vcc
    ds_write_b32 v98, v90
    s_mov_b64 exec, -1
    s_lshl2_add_u32 s37, s41, s37
    s_branch L2_xr4
L2_xf4:
    s_waitcnt lgkmcnt(0)
    s_cmp_gt_u32 s37, 1024
    s_cbranch_scc1 L2_xs4
    v_mov_b32 v43, -1
    s_cmp_ge_u32 s37, 512
    s_cbranch_scc1 L2_xg4
    v_mov_b32 v42, -1
    s_cmp_ge_u32 s37, 256
    s_cbranch_scc1 L2_xg4
    v_mov_b32 v41, -1
    s_branch L2_xg4
L2_xs4:
    s_waitcnt lgkmcnt(0)
    v_mov_b32 v40, -1
    v_mov_b32 v41, -1
    v_mov_b32 v42, -1
    v_mov_b32 v43, -1
    s_add_u32 s3, s42, 0
    s_bitset1_b32 s36, s3
    s_branch L2_xg4
L2_xo5:
    v_cmp_lt_u32 vcc, 20, v99
    s_mov_b32 s101, 1
    s_cbranch_vccz L2_xp5
    v_cmp_lt_u32 vcc, 32, v99
    v_cmp_lt_u32 s[58:59], 31, v88
    s_mov_b32 s101, 2
    s_or_b64 vcc, vcc, s[58:59]
    s_cbranch_scc0 L2_xp5
    s_mov_b32 s37, 0x10000
    s_branch L2_xp5
L2_xa6:
    s_cmp_eq_u32 s101, 1
    s_cbranch_scc1 L2_xc6
    v_lshlrev_b32 v89, 0, v96
    v_add_u32 v90, 140, v97
    v_bitop3_b32 v90, v89, v45, v90 bitop3:0x6a
    ds_write_b32 v98, v90 offset:28
    v_lshlrev_b32 v89, 4, v96
    v_add_u32 v90, 120, v97
    v_bitop3_b32 v90, v89, v45, v90 bitop3:0x6a
    ds_write_b32 v98, v90 offset:24
    v_lshlrev_b32 v89, 8, v96
    v_add_u32 v90, 100, v97
    v_bitop3_b32 v90, v89, v45, v90 bitop3:0x6a
    ds_write_b32 v98, v90 offset:20
L2_xc6:
    v_lshlrev_b32 v89, 12, v96
    v_add_u32 v90, 80, v97
    v_bitop3_b32 v90, v89, v45, v90 bitop3:0x6a
    ds_write_b32 v98, v90 offset:16
    s_branch L2_xb6
L2_xe6:
    v_cmp_lt_u32 vcc, 32, v99
    v_cmp_lt_u32 s[58:59], 31, v88
    v_lshrrev_b32 v89, 16, v96
    v_add_u32 v97, 80, v97
    s_or_b64 vcc, vcc, s[58:59]
    s_cbranch_scc1 L2_xs6
    v_lshlrev_b32 v89, v1, v89
    v_and_b32 v89, v45, v89
    v_cmp_ne_u32 vcc, 0, v89
    v_xor_b32 v90, v97, v89
    s_add_u32 s3, s37, s38
    v_mbcnt_lo_u32_b32 v98, vcc_lo, 0
    v_mbcnt_hi_u32_b32 v98, vcc_hi, v98
    s_bcnt1_i32_b64 s41, vcc
    v_lshl_add_u32 v98, v98, 2, s3
    s_mov_b64 exec, vcc
    ds_write_b32 v98, v90
    s_mov_b64 exec, -1
    s_lshl2_add_u32 s37, s41, s37
    s_branch L2_xr6
L2_xf6:
    s_waitcnt lgkmcnt(0)
    s_cmp_gt_u32 s37, 1024
    s_cbranch_scc1 L2_xs6
    v_mov_b32 v43, -1
    s_cmp_ge_u32 s37, 512
    s_cbranch_scc1 L2_xg6
    v_mov_b32 v42, -1
    s_cmp_ge_u32 s37, 256
    s_cbranch_scc1 L2_xg6
    v_mov_b32 v41, -1
    s_branch L2_xg6
L2_xs6:
    s_waitcnt lgkmcnt(0)
    v_mov_b32 v40, -1
    v_mov_b32 v41, -1
    v_mov_b32 v42, -1
    v_mov_b32 v43, -1
    s_add_u32 s3, s42, 1
    s_bitset1_b32 s36, s3
    s_branch L2_xg6
L2_p2s:
    s_sleep 8
    s_branch L2_p2
L2_c7:
    s_lshl_b64 s[52:53], s[82:83], 1
    s_andn2_b64 s[52:53], s[52:53], s[80:81]
    s_andn2_b64 s[52:53], s[52:53], s[54:55]
    s_or_b64 s[80:81], s[80:81], s[52:53]
    s_not_b64 vcc, s[52:53]
    s_mov_b64 exec, -1
    v_cndmask_b32_dpp v84, v84, v84, vcc wave_shr:1 row_mask:0xf bank_mask:0xf
    v_cndmask_b32_dpp v85, v85, v85, vcc wave_shr:1 row_mask:0xf bank_mask:0xf
    s_lshr_b64 s[52:53], s[52:53], 1
    v_cndmask_b32_dpp v86, v86, v86, vcc wave_shr:1 row_mask:0xf bank_mask:0xf
    v_cndmask_b32_dpp v87, v87, v87, vcc wave_shr:1 row_mask:0xf bank_mask:0xf
    s_andn2_b64 s[82:83], s[82:83], s[52:53]
    v_cndmask_b32_dpp v7, v7, v7, vcc wave_shr:1 row_mask:0xf bank_mask:0xf
    s_mov_b64 exec, s[54:55]
    s_cbranch_scc0 L2_d7
    s_mov_b64 exec, s[82:83]
    s_nop 1
    v_mfma_f32_4x4x4_16b_bf16 v[88:91], v[12:13], v[84:85], 0
    s_nop 1
    v_mfma_f32_4x4x4_16b_bf16 v[88:91], v[10:11], v[86:87], v[88:91]
    s_nop 4
    v_cvt_pk_bf16_f32 v88, v88, v89
    v_cvt_pk_bf16_f32 v89, v90, v91
    ds_pk_add_bf16 v7, v88 offset:65408
    ds_pk_add_bf16 v7, v89 offset:65412
    s_mov_b64 exec, s[54:55]
    s_branch L2_d7
L2_c8:
    s_lshl_b64 s[52:53], s[82:83], 1
    s_andn2_b64 s[52:53], s[52:53], s[80:81]
    s_andn2_b64 s[52:53], s[52:53], s[50:51]
    s_or_b64 s[80:81], s[80:81], s[52:53]
    s_not_b64 vcc, s[52:53]
    s_mov_b64 exec, -1
    v_cndmask_b32_dpp v84, v84, v84, vcc wave_shr:1 row_mask:0xf bank_mask:0xf
    v_cndmask_b32_dpp v85, v85, v85, vcc wave_shr:1 row_mask:0xf bank_mask:0xf
    s_lshr_b64 s[52:53], s[52:53], 1
    v_cndmask_b32_dpp v86, v86, v86, vcc wave_shr:1 row_mask:0xf bank_mask:0xf
    v_cndmask_b32_dpp v87, v87, v87, vcc wave_shr:1 row_mask:0xf bank_mask:0xf
    s_andn2_b64 s[82:83], s[82:83], s[52:53]
    v_cndmask_b32_dpp v7, v7, v7, vcc wave_shr:1 row_mask:0xf bank_mask:0xf
    s_mov_b64 exec, s[50:51]
    s_cbranch_scc0 L2_d8
    s_mov_b64 exec, s[82:83]
    s_nop 1
    v_mfma_f32_4x4x4_16b_bf16 v[88:91], v[12:13], v[84:85], 0
    s_nop 1
    v_mfma_f32_4x4x4_16b_bf16 v[88:91], v[10:11], v[86:87], v[88:91]
    s_nop 4
    v_cvt_pk_bf16_f32 v88, v88, v89
    v_cvt_pk_bf16_f32 v89, v90, v91
    ds_pk_add_bf16 v7, v88 offset:65408
    ds_pk_add_bf16 v7, v89 offset:65412
    s_mov_b64 exec, s[50:51]
    s_branch L2_d8
L2_xo9:
    v_cmp_lt_u32 vcc, 20, v99
    s_mov_b32 s101, 1
    s_cbranch_vccz L2_xp9
    v_cmp_lt_u32 vcc, 32, v99
    v_cmp_lt_u32 s[58:59], 31, v88
    s_mov_b32 s101, 2
    s_or_b64 vcc, vcc, s[58:59]
    s_cbranch_scc0 L2_xp9
    s_mov_b32 s37, 0x10000
    s_branch L2_xp9
L2_c12:
    s_lshl_b64 s[52:53], s[82:83], 1
    s_andn2_b64 s[52:53], s[52:53], s[80:81]
    s_andn2_b64 s[52:53], s[52:53], s[54:55]
    s_or_b64 s[80:81], s[80:81], s[52:53]
    s_not_b64 vcc, s[52:53]
    s_mov_b64 exec, -1
    v_cndmask_b32_dpp v84, v84, v84, vcc wave_shr:1 row_mask:0xf bank_mask:0xf
    v_cndmask_b32_dpp v85, v85, v85, vcc wave_shr:1 row_mask:0xf bank_mask:0xf
    s_lshr_b64 s[52:53], s[52:53], 1
    v_cndmask_b32_dpp v86, v86, v86, vcc wave_shr:1 row_mask:0xf bank_mask:0xf
    v_cndmask_b32_dpp v87, v87, v87, vcc wave_shr:1 row_mask:0xf bank_mask:0xf
    s_andn2_b64 s[82:83], s[82:83], s[52:53]
    v_cndmask_b32_dpp v7, v7, v7, vcc wave_shr:1 row_mask:0xf bank_mask:0xf
    s_mov_b64 exec, s[54:55]
    s_cbranch_scc0 L2_d12
    s_mov_b64 exec, s[82:83]
    s_nop 1
    v_mfma_f32_4x4x4_16b_bf16 v[88:91], v[12:13], v[84:85], 0
    s_nop 1
    v_mfma_f32_4x4x4_16b_bf16 v[88:91], v[10:11], v[86:87], v[88:91]
    s_nop 4
    v_cvt_pk_bf16_f32 v88, v88, v89
    v_cvt_pk_bf16_f32 v89, v90, v91
    ds_pk_add_bf16 v7, v88 offset:65408
    ds_pk_add_bf16 v7, v89 offset:65412
    s_mov_b64 exec, s[54:55]
    s_branch L2_d12
L2_c13:
    s_lshl_b64 s[52:53], s[82:83], 1
    s_andn2_b64 s[52:53], s[52:53], s[80:81]
    s_andn2_b64 s[52:53], s[52:53], s[50:51]
    s_or_b64 s[80:81], s[80:81], s[52:53]
    s_not_b64 vcc, s[52:53]
    s_mov_b64 exec, -1
    v_cndmask_b32_dpp v84, v84, v84, vcc wave_shr:1 row_mask:0xf bank_mask:0xf
    v_cndmask_b32_dpp v85, v85, v85, vcc wave_shr:1 row_mask:0xf bank_mask:0xf
    s_lshr_b64 s[52:53], s[52:53], 1
    v_cndmask_b32_dpp v86, v86, v86, vcc wave_shr:1 row_mask:0xf bank_mask:0xf
    v_cndmask_b32_dpp v87, v87, v87, vcc wave_shr:1 row_mask:0xf bank_mask:0xf
    s_andn2_b64 s[82:83], s[82:83], s[52:53]
    v_cndmask_b32_dpp v7, v7, v7, vcc wave_shr:1 row_mask:0xf bank_mask:0xf
    s_mov_b64 exec, s[50:51]
    s_cbranch_scc0 L2_d13
    s_mov_b64 exec, s[82:83]
    s_nop 1
    v_mfma_f32_4x4x4_16b_bf16 v[88:91], v[12:13], v[84:85], 0
    s_nop 1
    v_mfma_f32_4x4x4_16b_bf16 v[88:91], v[10:11], v[86:87], v[88:91]
    s_nop 4
    v_cvt_pk_bf16_f32 v88, v88, v89
    v_cvt_pk_bf16_f32 v89, v90, v91
    ds_pk_add_bf16 v7, v88 offset:65408
    ds_pk_add_bf16 v7, v89 offset:65412
    s_mov_b64 exec, s[50:51]
    s_branch L2_d13
L2_c15:
    s_lshl_b64 s[52:53], s[82:83], 1
    s_andn2_b64 s[52:53], s[52:53], s[80:81]
    s_andn2_b64 s[52:53], s[52:53], s[54:55]
    s_or_b64 s[80:81], s[80:81], s[52:53]
    s_not_b64 vcc, s[52:53]
    s_mov_b64 exec, -1
    v_cndmask_b32_dpp v84, v84, v84, vcc wave_shr:1 row_mask:0xf bank_mask:0xf
    v_cndmask_b32_dpp v85, v85, v85, vcc wave_shr:1 row_mask:0xf bank_mask:0xf
    s_lshr_b64 s[52:53], s[52:53], 1
    v_cndmask_b32_dpp v86, v86, v86, vcc wave_shr:1 row_mask:0xf bank_mask:0xf
    v_cndmask_b32_dpp v87, v87, v87, vcc wave_shr:1 row_mask:0xf bank_mask:0xf
    s_andn2_b64 s[82:83], s[82:83], s[52:53]
    v_cndmask_b32_dpp v7, v7, v7, vcc wave_shr:1 row_mask:0xf bank_mask:0xf
    s_mov_b64 exec, s[54:55]
    s_cbranch_scc0 L2_d15
    s_mov_b64 exec, s[82:83]
    s_nop 1
    v_mfma_f32_4x4x4_16b_bf16 v[88:91], v[12:13], v[84:85], 0
    s_nop 1
    v_mfma_f32_4x4x4_16b_bf16 v[88:91], v[10:11], v[86:87], v[88:91]
    s_nop 4
    v_cvt_pk_bf16_f32 v88, v88, v89
    v_cvt_pk_bf16_f32 v89, v90, v91
    ds_pk_add_bf16 v7, v88 offset:65408
    ds_pk_add_bf16 v7, v89 offset:65412
    s_mov_b64 exec, s[54:55]
    s_branch L2_d15
L2_c16:
    s_lshl_b64 s[52:53], s[82:83], 1
    s_andn2_b64 s[52:53], s[52:53], s[80:81]
    s_andn2_b64 s[52:53], s[52:53], s[50:51]
    s_or_b64 s[80:81], s[80:81], s[52:53]
    s_not_b64 vcc, s[52:53]
    s_mov_b64 exec, -1
    v_cndmask_b32_dpp v84, v84, v84, vcc wave_shr:1 row_mask:0xf bank_mask:0xf
    v_cndmask_b32_dpp v85, v85, v85, vcc wave_shr:1 row_mask:0xf bank_mask:0xf
    s_lshr_b64 s[52:53], s[52:53], 1
    v_cndmask_b32_dpp v86, v86, v86, vcc wave_shr:1 row_mask:0xf bank_mask:0xf
    v_cndmask_b32_dpp v87, v87, v87, vcc wave_shr:1 row_mask:0xf bank_mask:0xf
    s_andn2_b64 s[82:83], s[82:83], s[52:53]
    v_cndmask_b32_dpp v7, v7, v7, vcc wave_shr:1 row_mask:0xf bank_mask:0xf
    s_mov_b64 exec, s[50:51]
    s_cbranch_scc0 L2_d16
    s_mov_b64 exec, s[82:83]
    s_nop 1
    v_mfma_f32_4x4x4_16b_bf16 v[88:91], v[12:13], v[84:85], 0
    s_nop 1
    v_mfma_f32_4x4x4_16b_bf16 v[88:91], v[10:11], v[86:87], v[88:91]
    s_nop 4
    v_cvt_pk_bf16_f32 v88, v88, v89
    v_cvt_pk_bf16_f32 v89, v90, v91
    ds_pk_add_bf16 v7, v88 offset:65408
    ds_pk_add_bf16 v7, v89 offset:65412
    s_mov_b64 exec, s[50:51]
    s_branch L2_d16
L2_c19:
    s_lshl_b64 s[52:53], s[82:83], 1
    s_andn2_b64 s[52:53], s[52:53], s[80:81]
    s_andn2_b64 s[52:53], s[52:53], s[54:55]
    s_or_b64 s[80:81], s[80:81], s[52:53]
    s_not_b64 vcc, s[52:53]
    s_mov_b64 exec, -1
    v_cndmask_b32_dpp v84, v84, v84, vcc wave_shr:1 row_mask:0xf bank_mask:0xf
    v_cndmask_b32_dpp v85, v85, v85, vcc wave_shr:1 row_mask:0xf bank_mask:0xf
    s_lshr_b64 s[52:53], s[52:53], 1
    v_cndmask_b32_dpp v86, v86, v86, vcc wave_shr:1 row_mask:0xf bank_mask:0xf
    v_cndmask_b32_dpp v87, v87, v87, vcc wave_shr:1 row_mask:0xf bank_mask:0xf
    s_andn2_b64 s[82:83], s[82:83], s[52:53]
    v_cndmask_b32_dpp v7, v7, v7, vcc wave_shr:1 row_mask:0xf bank_mask:0xf
    s_mov_b64 exec, s[54:55]
    s_cbranch_scc0 L2_d19
    s_mov_b64 exec, s[82:83]
    s_nop 1
    v_mfma_f32_4x4x4_16b_bf16 v[88:91], v[12:13], v[84:85], 0
    s_nop 1
    v_mfma_f32_4x4x4_16b_bf16 v[88:91], v[10:11], v[86:87], v[88:91]
    s_nop 4
    v_cvt_pk_bf16_f32 v88, v88, v89
    v_cvt_pk_bf16_f32 v89, v90, v91
    ds_pk_add_bf16 v7, v88 offset:65408
    ds_pk_add_bf16 v7, v89 offset:65412
    s_mov_b64 exec, s[54:55]
    s_branch L2_d19
L2_c20:
    s_lshl_b64 s[52:53], s[82:83], 1
    s_andn2_b64 s[52:53], s[52:53], s[80:81]
    s_andn2_b64 s[52:53], s[52:53], s[50:51]
    s_or_b64 s[80:81], s[80:81], s[52:53]
    s_not_b64 vcc, s[52:53]
    s_mov_b64 exec, -1
    v_cndmask_b32_dpp v84, v84, v84, vcc wave_shr:1 row_mask:0xf bank_mask:0xf
    v_cndmask_b32_dpp v85, v85, v85, vcc wave_shr:1 row_mask:0xf bank_mask:0xf
    s_lshr_b64 s[52:53], s[52:53], 1
    v_cndmask_b32_dpp v86, v86, v86, vcc wave_shr:1 row_mask:0xf bank_mask:0xf
    v_cndmask_b32_dpp v87, v87, v87, vcc wave_shr:1 row_mask:0xf bank_mask:0xf
    s_andn2_b64 s[82:83], s[82:83], s[52:53]
    v_cndmask_b32_dpp v7, v7, v7, vcc wave_shr:1 row_mask:0xf bank_mask:0xf
    s_mov_b64 exec, s[50:51]
    s_cbranch_scc0 L2_d20
    s_mov_b64 exec, s[82:83]
    s_nop 1
    v_mfma_f32_4x4x4_16b_bf16 v[88:91], v[12:13], v[84:85], 0
    s_nop 1
    v_mfma_f32_4x4x4_16b_bf16 v[88:91], v[10:11], v[86:87], v[88:91]
    s_nop 4
    v_cvt_pk_bf16_f32 v88, v88, v89
    v_cvt_pk_bf16_f32 v89, v90, v91
    ds_pk_add_bf16 v7, v88 offset:65408
    ds_pk_add_bf16 v7, v89 offset:65412
    s_mov_b64 exec, s[50:51]
    s_branch L2_d20
L2_c21:
    s_lshl_b64 s[52:53], s[82:83], 1
    s_andn2_b64 s[52:53], s[52:53], s[80:81]
    s_andn2_b64 s[52:53], s[52:53], s[54:55]
    s_or_b64 s[80:81], s[80:81], s[52:53]
    s_not_b64 vcc, s[52:53]
    s_mov_b64 exec, -1
    v_cndmask_b32_dpp v84, v84, v84, vcc wave_shr:1 row_mask:0xf bank_mask:0xf
    v_cndmask_b32_dpp v85, v85, v85, vcc wave_shr:1 row_mask:0xf bank_mask:0xf
    s_lshr_b64 s[52:53], s[52:53], 1
    v_cndmask_b32_dpp v86, v86, v86, vcc wave_shr:1 row_mask:0xf bank_mask:0xf
    v_cndmask_b32_dpp v87, v87, v87, vcc wave_shr:1 row_mask:0xf bank_mask:0xf
    s_andn2_b64 s[82:83], s[82:83], s[52:53]
    v_cndmask_b32_dpp v7, v7, v7, vcc wave_shr:1 row_mask:0xf bank_mask:0xf
    s_mov_b64 exec, s[54:55]
    s_cbranch_scc0 L2_d21
    s_mov_b64 exec, s[82:83]
    s_nop 1
    v_mfma_f32_4x4x4_16b_bf16 v[88:91], v[12:13], v[84:85], 0
    s_nop 1
    v_mfma_f32_4x4x4_16b_bf16 v[88:91], v[10:11], v[86:87], v[88:91]
    s_nop 4
    v_cvt_pk_bf16_f32 v88, v88, v89
    v_cvt_pk_bf16_f32 v89, v90, v91
    ds_pk_add_bf16 v7, v88 offset:65408
    ds_pk_add_bf16 v7, v89 offset:65412
    s_mov_b64 exec, s[54:55]
    s_branch L2_d21
L2_c22:
    s_lshl_b64 s[52:53], s[82:83], 1
    s_andn2_b64 s[52:53], s[52:53], s[80:81]
    s_andn2_b64 s[52:53], s[52:53], s[50:51]
    s_or_b64 s[80:81], s[80:81], s[52:53]
    s_not_b64 vcc, s[52:53]
    s_mov_b64 exec, -1
    v_cndmask_b32_dpp v84, v84, v84, vcc wave_shr:1 row_mask:0xf bank_mask:0xf
    v_cndmask_b32_dpp v85, v85, v85, vcc wave_shr:1 row_mask:0xf bank_mask:0xf
    s_lshr_b64 s[52:53], s[52:53], 1
    v_cndmask_b32_dpp v86, v86, v86, vcc wave_shr:1 row_mask:0xf bank_mask:0xf
    v_cndmask_b32_dpp v87, v87, v87, vcc wave_shr:1 row_mask:0xf bank_mask:0xf
    s_andn2_b64 s[82:83], s[82:83], s[52:53]
    v_cndmask_b32_dpp v7, v7, v7, vcc wave_shr:1 row_mask:0xf bank_mask:0xf
    s_mov_b64 exec, s[50:51]
    s_cbranch_scc0 L2_d22
    s_mov_b64 exec, s[82:83]
    s_nop 1
    v_mfma_f32_4x4x4_16b_bf16 v[88:91], v[12:13], v[84:85], 0
    s_nop 1
    v_mfma_f32_4x4x4_16b_bf16 v[88:91], v[10:11], v[86:87], v[88:91]
    s_nop 4
    v_cvt_pk_bf16_f32 v88, v88, v89
    v_cvt_pk_bf16_f32 v89, v90, v91
    ds_pk_add_bf16 v7, v88 offset:65408
    ds_pk_add_bf16 v7, v89 offset:65412
    s_mov_b64 exec, s[50:51]
    s_branch L2_d22
L2_c23:
    s_lshl_b64 s[52:53], s[82:83], 1
    s_andn2_b64 s[52:53], s[52:53], s[80:81]
    s_andn2_b64 s[52:53], s[52:53], s[54:55]
    s_or_b64 s[80:81], s[80:81], s[52:53]
    s_not_b64 vcc, s[52:53]
    s_mov_b64 exec, -1
    v_cndmask_b32_dpp v84, v84, v84, vcc wave_shr:1 row_mask:0xf bank_mask:0xf
    v_cndmask_b32_dpp v85, v85, v85, vcc wave_shr:1 row_mask:0xf bank_mask:0xf
    s_lshr_b64 s[52:53], s[52:53], 1
    v_cndmask_b32_dpp v86, v86, v86, vcc wave_shr:1 row_mask:0xf bank_mask:0xf
    v_cndmask_b32_dpp v87, v87, v87, vcc wave_shr:1 row_mask:0xf bank_mask:0xf
    s_andn2_b64 s[82:83], s[82:83], s[52:53]
    v_cndmask_b32_dpp v7, v7, v7, vcc wave_shr:1 row_mask:0xf bank_mask:0xf
    s_mov_b64 exec, s[54:55]
    s_cbranch_scc0 L2_d23
    s_mov_b64 exec, s[82:83]
    s_nop 1
    v_mfma_f32_4x4x4_16b_bf16 v[88:91], v[12:13], v[84:85], 0
    s_nop 1
    v_mfma_f32_4x4x4_16b_bf16 v[88:91], v[10:11], v[86:87], v[88:91]
    s_nop 4
    v_cvt_pk_bf16_f32 v88, v88, v89
    v_cvt_pk_bf16_f32 v89, v90, v91
    ds_pk_add_bf16 v7, v88 offset:65408
    ds_pk_add_bf16 v7, v89 offset:65412
    s_mov_b64 exec, s[54:55]
    s_branch L2_d23
L2_c24:
    s_lshl_b64 s[52:53], s[82:83], 1
    s_andn2_b64 s[52:53], s[52:53], s[80:81]
    s_andn2_b64 s[52:53], s[52:53], s[50:51]
    s_or_b64 s[80:81], s[80:81], s[52:53]
    s_not_b64 vcc, s[52:53]
    s_mov_b64 exec, -1
    v_cndmask_b32_dpp v84, v84, v84, vcc wave_shr:1 row_mask:0xf bank_mask:0xf
    v_cndmask_b32_dpp v85, v85, v85, vcc wave_shr:1 row_mask:0xf bank_mask:0xf
    s_lshr_b64 s[52:53], s[52:53], 1
    v_cndmask_b32_dpp v86, v86, v86, vcc wave_shr:1 row_mask:0xf bank_mask:0xf
    v_cndmask_b32_dpp v87, v87, v87, vcc wave_shr:1 row_mask:0xf bank_mask:0xf
    s_andn2_b64 s[82:83], s[82:83], s[52:53]
    v_cndmask_b32_dpp v7, v7, v7, vcc wave_shr:1 row_mask:0xf bank_mask:0xf
    s_mov_b64 exec, s[50:51]
    s_cbranch_scc0 L2_d24
    s_mov_b64 exec, s[82:83]
    s_nop 1
    v_mfma_f32_4x4x4_16b_bf16 v[88:91], v[12:13], v[84:85], 0
    s_nop 1
    v_mfma_f32_4x4x4_16b_bf16 v[88:91], v[10:11], v[86:87], v[88:91]
    s_nop 4
    v_cvt_pk_bf16_f32 v88, v88, v89
    v_cvt_pk_bf16_f32 v89, v90, v91
    ds_pk_add_bf16 v7, v88 offset:65408
    ds_pk_add_bf16 v7, v89 offset:65412
    s_mov_b64 exec, s[50:51]
    s_branch L2_d24
L2_xa25:
    s_cmp_eq_u32 s101, 1
    s_cbranch_scc1 L2_xc25
    v_lshlrev_b32 v89, 0, v96
    v_add_u32 v90, 140, v97
    v_bitop3_b32 v90, v89, v45, v90 bitop3:0x6a
    ds_write_b32 v98, v90 offset:28
    v_lshlrev_b32 v89, 4, v96
    v_add_u32 v90, 120, v97
    v_bitop3_b32 v90, v89, v45, v90 bitop3:0x6a
    ds_write_b32 v98, v90 offset:24
    v_lshlrev_b32 v89, 8, v96
    v_add_u32 v90, 100, v97
    v_bitop3_b32 v90, v89, v45, v90 bitop3:0x6a
    ds_write_b32 v98, v90 offset:20
L2_xc25:
    v_lshlrev_b32 v89, 12, v96
    v_add_u32 v90, 80, v97
    v_bitop3_b32 v90, v89, v45, v90 bitop3:0x6a
    ds_write_b32 v98, v90 offset:16
    s_branch L2_xb25
L2_xe25:
    v_cmp_lt_u32 vcc, 32, v99
    v_cmp_lt_u32 s[58:59], 31, v88
    v_lshrrev_b32 v89, 16, v96
    v_add_u32 v97, 80, v97
    s_or_b64 vcc, vcc, s[58:59]
    s_cbranch_scc1 L2_xs25
    v_lshlrev_b32 v89, v1, v89
    v_and_b32 v89, v45, v89
    v_cmp_ne_u32 vcc, 0, v89
    v_xor_b32 v90, v97, v89
    s_add_u32 s3, s37, s38
    v_mbcnt_lo_u32_b32 v98, vcc_lo, 0
    v_mbcnt_hi_u32_b32 v98, vcc_hi, v98
    s_bcnt1_i32_b64 s41, vcc
    v_lshl_add_u32 v98, v98, 2, s3
    s_mov_b64 exec, vcc
    ds_write_b32 v98, v90
    s_mov_b64 exec, -1
    s_lshl2_add_u32 s37, s41, s37
    s_branch L2_xr25
L2_xf25:
    s_waitcnt lgkmcnt(0)
    s_cmp_gt_u32 s37, 1024
    s_cbranch_scc1 L2_xs25
    v_mov_b32 v43, -1
    s_cmp_ge_u32 s37, 512
    s_cbranch_scc1 L2_xg25
    v_mov_b32 v42, -1
    s_cmp_ge_u32 s37, 256
    s_cbranch_scc1 L2_xg25
    v_mov_b32 v41, -1
    s_branch L2_xg25
L2_xs25:
    s_waitcnt lgkmcnt(0)
    v_mov_b32 v40, -1
    v_mov_b32 v41, -1
    v_mov_b32 v42, -1
    v_mov_b32 v43, -1
    s_add_u32 s3, s42, 2
    s_bitset1_b32 s36, s3
    s_branch L2_xg25
L2_c26:
    s_lshl_b64 s[52:53], s[82:83], 1
    s_andn2_b64 s[52:53], s[52:53], s[80:81]
    s_andn2_b64 s[52:53], s[52:53], s[54:55]
    s_or_b64 s[80:81], s[80:81], s[52:53]
    s_not_b64 vcc, s[52:53]
    s_mov_b64 exec, -1
    v_cndmask_b32_dpp v84, v84, v84, vcc wave_shr:1 row_mask:0xf bank_mask:0xf
    v_cndmask_b32_dpp v85, v85, v85, vcc wave_shr:1 row_mask:0xf bank_mask:0xf
    s_lshr_b64 s[52:53], s[52:53], 1
    v_cndmask_b32_dpp v86, v86, v86, vcc wave_shr:1 row_mask:0xf bank_mask:0xf
    v_cndmask_b32_dpp v87, v87, v87, vcc wave_shr:1 row_mask:0xf bank_mask:0xf
    s_andn2_b64 s[82:83], s[82:83], s[52:53]
    v_cndmask_b32_dpp v7, v7, v7, vcc wave_shr:1 row_mask:0xf bank_mask:0xf
    s_mov_b64 exec, s[54:55]
    s_cbranch_scc0 L2_d26
    s_mov_b64 exec, s[82:83]
    s_nop 1
    v_mfma_f32_4x4x4_16b_bf16 v[88:91], v[12:13], v[84:85], 0
    s_nop 1
    v_mfma_f32_4x4x4_16b_bf16 v[88:91], v[10:11], v[86:87], v[88:91]
    s_nop 4
    v_cvt_pk_bf16_f32 v88, v88, v89
    v_cvt_pk_bf16_f32 v89, v90, v91
    ds_pk_add_bf16 v7, v88 offset:65408
    ds_pk_add_bf16 v7, v89 offset:65412
    s_mov_b64 exec, s[54:55]
    s_branch L2_d26
L2_c27:
    s_lshl_b64 s[52:53], s[82:83], 1
    s_andn2_b64 s[52:53], s[52:53], s[80:81]
    s_andn2_b64 s[52:53], s[52:53], s[50:51]
    s_or_b64 s[80:81], s[80:81], s[52:53]
    s_not_b64 vcc, s[52:53]
    s_mov_b64 exec, -1
    v_cndmask_b32_dpp v84, v84, v84, vcc wave_shr:1 row_mask:0xf bank_mask:0xf
    v_cndmask_b32_dpp v85, v85, v85, vcc wave_shr:1 row_mask:0xf bank_mask:0xf
    s_lshr_b64 s[52:53], s[52:53], 1
    v_cndmask_b32_dpp v86, v86, v86, vcc wave_shr:1 row_mask:0xf bank_mask:0xf
    v_cndmask_b32_dpp v87, v87, v87, vcc wave_shr:1 row_mask:0xf bank_mask:0xf
    s_andn2_b64 s[82:83], s[82:83], s[52:53]
    v_cndmask_b32_dpp v7, v7, v7, vcc wave_shr:1 row_mask:0xf bank_mask:0xf
    s_mov_b64 exec, s[50:51]
    s_cbranch_scc0 L2_d27
    s_mov_b64 exec, s[82:83]
    s_nop 1
    v_mfma_f32_4x4x4_16b_bf16 v[88:91], v[12:13], v[84:85], 0
    s_nop 1
    v_mfma_f32_4x4x4_16b_bf16 v[88:91], v[10:11], v[86:87], v[88:91]
    s_nop 4
    v_cvt_pk_bf16_f32 v88, v88, v89
    v_cvt_pk_bf16_f32 v89, v90, v91
    ds_pk_add_bf16 v7, v88 offset:65408
    ds_pk_add_bf16 v7, v89 offset:65412
    s_mov_b64 exec, s[50:51]
    s_branch L2_d27
L2_c28:
    s_lshl_b64 s[52:53], s[82:83], 1
    s_andn2_b64 s[52:53], s[52:53], s[80:81]
    s_andn2_b64 s[52:53], s[52:53], s[54:55]
    s_or_b64 s[80:81], s[80:81], s[52:53]
    s_not_b64 vcc, s[52:53]
    s_mov_b64 exec, -1
    v_cndmask_b32_dpp v84, v84, v84, vcc wave_shr:1 row_mask:0xf bank_mask:0xf
    v_cndmask_b32_dpp v85, v85, v85, vcc wave_shr:1 row_mask:0xf bank_mask:0xf
    s_lshr_b64 s[52:53], s[52:53], 1
    v_cndmask_b32_dpp v86, v86, v86, vcc wave_shr:1 row_mask:0xf bank_mask:0xf
    v_cndmask_b32_dpp v87, v87, v87, vcc wave_shr:1 row_mask:0xf bank_mask:0xf
    s_andn2_b64 s[82:83], s[82:83], s[52:53]
    v_cndmask_b32_dpp v7, v7, v7, vcc wave_shr:1 row_mask:0xf bank_mask:0xf
    s_mov_b64 exec, s[54:55]
    s_cbranch_scc0 L2_d28
    s_mov_b64 exec, s[82:83]
    s_nop 1
    v_mfma_f32_4x4x4_16b_bf16 v[88:91], v[12:13], v[84:85], 0
    s_nop 1
    v_mfma_f32_4x4x4_16b_bf16 v[88:91], v[10:11], v[86:87], v[88:91]
    s_nop 4
    v_cvt_pk_bf16_f32 v88, v88, v89
    v_cvt_pk_bf16_f32 v89, v90, v91
    ds_pk_add_bf16 v7, v88 offset:65408
    ds_pk_add_bf16 v7, v89 offset:65412
    s_mov_b64 exec, s[54:55]
    s_branch L2_d28
L2_c29:
    s_lshl_b64 s[52:53], s[82:83], 1
    s_andn2_b64 s[52:53], s[52:53], s[80:81]
    s_andn2_b64 s[52:53], s[52:53], s[50:51]
    s_or_b64 s[80:81], s[80:81], s[52:53]
    s_not_b64 vcc, s[52:53]
    s_mov_b64 exec, -1
    v_cndmask_b32_dpp v84, v84, v84, vcc wave_shr:1 row_mask:0xf bank_mask:0xf
    v_cndmask_b32_dpp v85, v85, v85, vcc wave_shr:1 row_mask:0xf bank_mask:0xf
    s_lshr_b64 s[52:53], s[52:53], 1
    v_cndmask_b32_dpp v86, v86, v86, vcc wave_shr:1 row_mask:0xf bank_mask:0xf
    v_cndmask_b32_dpp v87, v87, v87, vcc wave_shr:1 row_mask:0xf bank_mask:0xf
    s_andn2_b64 s[82:83], s[82:83], s[52:53]
    v_cndmask_b32_dpp v7, v7, v7, vcc wave_shr:1 row_mask:0xf bank_mask:0xf
    s_mov_b64 exec, s[50:51]
    s_cbranch_scc0 L2_d29
    s_mov_b64 exec, s[82:83]
    s_nop 1
    v_mfma_f32_4x4x4_16b_bf16 v[88:91], v[12:13], v[84:85], 0
    s_nop 1
    v_mfma_f32_4x4x4_16b_bf16 v[88:91], v[10:11], v[86:87], v[88:91]
    s_nop 4
    v_cvt_pk_bf16_f32 v88, v88, v89
    v_cvt_pk_bf16_f32 v89, v90, v91
    ds_pk_add_bf16 v7, v88 offset:65408
    ds_pk_add_bf16 v7, v89 offset:65412
    s_mov_b64 exec, s[50:51]
    s_branch L2_d29
L2_c30:
    s_lshl_b64 s[52:53], s[82:83], 1
    s_andn2_b64 s[52:53], s[52:53], s[80:81]
    s_andn2_b64 s[52:53], s[52:53], s[54:55]
    s_or_b64 s[80:81], s[80:81], s[52:53]
    s_not_b64 vcc, s[52:53]
    s_mov_b64 exec, -1
    v_cndmask_b32_dpp v84, v84, v84, vcc wave_shr:1 row_mask:0xf bank_mask:0xf
    v_cndmask_b32_dpp v85, v85, v85, vcc wave_shr:1 row_mask:0xf bank_mask:0xf
    s_lshr_b64 s[52:53], s[52:53], 1
    v_cndmask_b32_dpp v86, v86, v86, vcc wave_shr:1 row_mask:0xf bank_mask:0xf
    v_cndmask_b32_dpp v87, v87, v87, vcc wave_shr:1 row_mask:0xf bank_mask:0xf
    s_andn2_b64 s[82:83], s[82:83], s[52:53]
    v_cndmask_b32_dpp v7, v7, v7, vcc wave_shr:1 row_mask:0xf bank_mask:0xf
    s_mov_b64 exec, s[54:55]
    s_cbranch_scc0 L2_d30
    s_mov_b64 exec, s[82:83]
    s_nop 1
    v_mfma_f32_4x4x4_16b_bf16 v[88:91], v[12:13], v[84:85], 0
    s_nop 1
    v_mfma_f32_4x4x4_16b_bf16 v[88:91], v[10:11], v[86:87], v[88:91]
    s_nop 4
    v_cvt_pk_bf16_f32 v88, v88, v89
    v_cvt_pk_bf16_f32 v89, v90, v91
    ds_pk_add_bf16 v7, v88 offset:65408
    ds_pk_add_bf16 v7, v89 offset:65412
    s_mov_b64 exec, s[54:55]
    s_branch L2_d30
L2_c31:
    s_lshl_b64 s[52:53], s[82:83], 1
    s_andn2_b64 s[52:53], s[52:53], s[80:81]
    s_andn2_b64 s[52:53], s[52:53], s[50:51]
    s_or_b64 s[80:81], s[80:81], s[52:53]
    s_not_b64 vcc, s[52:53]
    s_mov_b64 exec, -1
    v_cndmask_b32_dpp v84, v84, v84, vcc wave_shr:1 row_mask:0xf bank_mask:0xf
    v_cndmask_b32_dpp v85, v85, v85, vcc wave_shr:1 row_mask:0xf bank_mask:0xf
    s_lshr_b64 s[52:53], s[52:53], 1
    v_cndmask_b32_dpp v86, v86, v86, vcc wave_shr:1 row_mask:0xf bank_mask:0xf
    v_cndmask_b32_dpp v87, v87, v87, vcc wave_shr:1 row_mask:0xf bank_mask:0xf
    s_andn2_b64 s[82:83], s[82:83], s[52:53]
    v_cndmask_b32_dpp v7, v7, v7, vcc wave_shr:1 row_mask:0xf bank_mask:0xf
    s_mov_b64 exec, s[50:51]
    s_cbranch_scc0 L2_d31
    s_mov_b64 exec, s[82:83]
    s_nop 1
    v_mfma_f32_4x4x4_16b_bf16 v[88:91], v[12:13], v[84:85], 0
    s_nop 1
    v_mfma_f32_4x4x4_16b_bf16 v[88:91], v[10:11], v[86:87], v[88:91]
    s_nop 4
    v_cvt_pk_bf16_f32 v88, v88, v89
    v_cvt_pk_bf16_f32 v89, v90, v91
    ds_pk_add_bf16 v7, v88 offset:65408
    ds_pk_add_bf16 v7, v89 offset:65412
    s_mov_b64 exec, s[50:51]
    s_branch L2_d31
L2_xo32:
    v_cmp_lt_u32 vcc, 20, v99
    s_mov_b32 s101, 1
    s_cbranch_vccz L2_xp32
    v_cmp_lt_u32 vcc, 32, v99
    v_cmp_lt_u32 s[58:59], 31, v88
    s_mov_b32 s101, 2
    s_or_b64 vcc, vcc, s[58:59]
    s_cbranch_scc0 L2_xp32
    s_mov_b32 s37, 0x10000
    s_branch L2_xp32
L2_c33:
    s_lshl_b64 s[52:53], s[82:83], 1
    s_andn2_b64 s[52:53], s[52:53], s[80:81]
    s_andn2_b64 s[52:53], s[52:53], s[54:55]
    s_or_b64 s[80:81], s[80:81], s[52:53]
    s_not_b64 vcc, s[52:53]
    s_mov_b64 exec, -1
    v_cndmask_b32_dpp v84, v84, v84, vcc wave_shr:1 row_mask:0xf bank_mask:0xf
    v_cndmask_b32_dpp v85, v85, v85, vcc wave_shr:1 row_mask:0xf bank_mask:0xf
    s_lshr_b64 s[52:53], s[52:53], 1
    v_cndmask_b32_dpp v86, v86, v86, vcc wave_shr:1 row_mask:0xf bank_mask:0xf
    v_cndmask_b32_dpp v87, v87, v87, vcc wave_shr:1 row_mask:0xf bank_mask:0xf
    s_andn2_b64 s[82:83], s[82:83], s[52:53]
    v_cndmask_b32_dpp v7, v7, v7, vcc wave_shr:1 row_mask:0xf bank_mask:0xf
    s_mov_b64 exec, s[54:55]
    s_cbranch_scc0 L2_d33
    s_mov_b64 exec, s[82:83]
    s_nop 1
    v_mfma_f32_4x4x4_16b_bf16 v[88:91], v[12:13], v[84:85], 0
    s_nop 1
    v_mfma_f32_4x4x4_16b_bf16 v[88:91], v[10:11], v[86:87], v[88:91]
    s_nop 4
    v_cvt_pk_bf16_f32 v88, v88, v89
    v_cvt_pk_bf16_f32 v89, v90, v91
    ds_pk_add_bf16 v7, v88 offset:65408
    ds_pk_add_bf16 v7, v89 offset:65412
    s_mov_b64 exec, s[54:55]
    s_branch L2_d33
L2_c34:
    s_lshl_b64 s[52:53], s[82:83], 1
    s_andn2_b64 s[52:53], s[52:53], s[80:81]
    s_andn2_b64 s[52:53], s[52:53], s[50:51]
    s_or_b64 s[80:81], s[80:81], s[52:53]
    s_not_b64 vcc, s[52:53]
    s_mov_b64 exec, -1
    v_cndmask_b32_dpp v84, v84, v84, vcc wave_shr:1 row_mask:0xf bank_mask:0xf
    v_cndmask_b32_dpp v85, v85, v85, vcc wave_shr:1 row_mask:0xf bank_mask:0xf
    s_lshr_b64 s[52:53], s[52:53], 1
    v_cndmask_b32_dpp v86, v86, v86, vcc wave_shr:1 row_mask:0xf bank_mask:0xf
    v_cndmask_b32_dpp v87, v87, v87, vcc wave_shr:1 row_mask:0xf bank_mask:0xf
    s_andn2_b64 s[82:83], s[82:83], s[52:53]
    v_cndmask_b32_dpp v7, v7, v7, vcc wave_shr:1 row_mask:0xf bank_mask:0xf
    s_mov_b64 exec, s[50:51]
    s_cbranch_scc0 L2_d34
    s_mov_b64 exec, s[82:83]
    s_nop 1
    v_mfma_f32_4x4x4_16b_bf16 v[88:91], v[12:13], v[84:85], 0
    s_nop 1
    v_mfma_f32_4x4x4_16b_bf16 v[88:91], v[10:11], v[86:87], v[88:91]
    s_nop 4
    v_cvt_pk_bf16_f32 v88, v88, v89
    v_cvt_pk_bf16_f32 v89, v90, v91
    ds_pk_add_bf16 v7, v88 offset:65408
    ds_pk_add_bf16 v7, v89 offset:65412
    s_mov_b64 exec, s[50:51]
    s_branch L2_d34
L2_c35:
    s_lshl_b64 s[52:53], s[82:83], 1
    s_andn2_b64 s[52:53], s[52:53], s[80:81]
    s_andn2_b64 s[52:53], s[52:53], s[54:55]
    s_or_b64 s[80:81], s[80:81], s[52:53]
    s_not_b64 vcc, s[52:53]
    s_mov_b64 exec, -1
    v_cndmask_b32_dpp v84, v84, v84, vcc wave_shr:1 row_mask:0xf bank_mask:0xf
    v_cndmask_b32_dpp v85, v85, v85, vcc wave_shr:1 row_mask:0xf bank_mask:0xf
    s_lshr_b64 s[52:53], s[52:53], 1
    v_cndmask_b32_dpp v86, v86, v86, vcc wave_shr:1 row_mask:0xf bank_mask:0xf
    v_cndmask_b32_dpp v87, v87, v87, vcc wave_shr:1 row_mask:0xf bank_mask:0xf
    s_andn2_b64 s[82:83], s[82:83], s[52:53]
    v_cndmask_b32_dpp v7, v7, v7, vcc wave_shr:1 row_mask:0xf bank_mask:0xf
    s_mov_b64 exec, s[54:55]
    s_cbranch_scc0 L2_d35
    s_mov_b64 exec, s[82:83]
    s_nop 1
    v_mfma_f32_4x4x4_16b_bf16 v[88:91], v[12:13], v[84:85], 0
    s_nop 1
    v_mfma_f32_4x4x4_16b_bf16 v[88:91], v[10:11], v[86:87], v[88:91]
    s_nop 4
    v_cvt_pk_bf16_f32 v88, v88, v89
    v_cvt_pk_bf16_f32 v89, v90, v91
    ds_pk_add_bf16 v7, v88 offset:65408
    ds_pk_add_bf16 v7, v89 offset:65412
    s_mov_b64 exec, s[54:55]
    s_branch L2_d35
L2_c36:
    s_lshl_b64 s[52:53], s[82:83], 1
    s_andn2_b64 s[52:53], s[52:53], s[80:81]
    s_andn2_b64 s[52:53], s[52:53], s[50:51]
    s_or_b64 s[80:81], s[80:81], s[52:53]
    s_not_b64 vcc, s[52:53]
    s_mov_b64 exec, -1
    v_cndmask_b32_dpp v84, v84, v84, vcc wave_shr:1 row_mask:0xf bank_mask:0xf
    v_cndmask_b32_dpp v85, v85, v85, vcc wave_shr:1 row_mask:0xf bank_mask:0xf
    s_lshr_b64 s[52:53], s[52:53], 1
    v_cndmask_b32_dpp v86, v86, v86, vcc wave_shr:1 row_mask:0xf bank_mask:0xf
    v_cndmask_b32_dpp v87, v87, v87, vcc wave_shr:1 row_mask:0xf bank_mask:0xf
    s_andn2_b64 s[82:83], s[82:83], s[52:53]
    v_cndmask_b32_dpp v7, v7, v7, vcc wave_shr:1 row_mask:0xf bank_mask:0xf
    s_mov_b64 exec, s[50:51]
    s_cbranch_scc0 L2_d36
    s_mov_b64 exec, s[82:83]
    s_nop 1
    v_mfma_f32_4x4x4_16b_bf16 v[88:91], v[12:13], v[84:85], 0
    s_nop 1
    v_mfma_f32_4x4x4_16b_bf16 v[88:91], v[10:11], v[86:87], v[88:91]
    s_nop 4
    v_cvt_pk_bf16_f32 v88, v88, v89
    v_cvt_pk_bf16_f32 v89, v90, v91
    ds_pk_add_bf16 v7, v88 offset:65408
    ds_pk_add_bf16 v7, v89 offset:65412
    s_mov_b64 exec, s[50:51]
    s_branch L2_d36
L2_c37:
    s_lshl_b64 s[52:53], s[82:83], 1
    s_andn2_b64 s[52:53], s[52:53], s[80:81]
    s_andn2_b64 s[52:53], s[52:53], s[54:55]
    s_or_b64 s[80:81], s[80:81], s[52:53]
    s_not_b64 vcc, s[52:53]
    s_mov_b64 exec, -1
    v_cndmask_b32_dpp v84, v84, v84, vcc wave_shr:1 row_mask:0xf bank_mask:0xf
    v_cndmask_b32_dpp v85, v85, v85, vcc wave_shr:1 row_mask:0xf bank_mask:0xf
    s_lshr_b64 s[52:53], s[52:53], 1
    v_cndmask_b32_dpp v86, v86, v86, vcc wave_shr:1 row_mask:0xf bank_mask:0xf
    v_cndmask_b32_dpp v87, v87, v87, vcc wave_shr:1 row_mask:0xf bank_mask:0xf
    s_andn2_b64 s[82:83], s[82:83], s[52:53]
    v_cndmask_b32_dpp v7, v7, v7, vcc wave_shr:1 row_mask:0xf bank_mask:0xf
    s_mov_b64 exec, s[54:55]
    s_cbranch_scc0 L2_d37
    s_mov_b64 exec, s[82:83]
    s_nop 1
    v_mfma_f32_4x4x4_16b_bf16 v[88:91], v[12:13], v[84:85], 0
    s_nop 1
    v_mfma_f32_4x4x4_16b_bf16 v[88:91], v[10:11], v[86:87], v[88:91]
    s_nop 4
    v_cvt_pk_bf16_f32 v88, v88, v89
    v_cvt_pk_bf16_f32 v89, v90, v91
    ds_pk_add_bf16 v7, v88 offset:65408
    ds_pk_add_bf16 v7, v89 offset:65412
    s_mov_b64 exec, s[54:55]
    s_branch L2_d37
L2_c38:
    s_lshl_b64 s[52:53], s[82:83], 1
    s_andn2_b64 s[52:53], s[52:53], s[80:81]
    s_andn2_b64 s[52:53], s[52:53], s[50:51]
    s_or_b64 s[80:81], s[80:81], s[52:53]
    s_not_b64 vcc, s[52:53]
    s_mov_b64 exec, -1
    v_cndmask_b32_dpp v84, v84, v84, vcc wave_shr:1 row_mask:0xf bank_mask:0xf
    v_cndmask_b32_dpp v85, v85, v85, vcc wave_shr:1 row_mask:0xf bank_mask:0xf
    s_lshr_b64 s[52:53], s[52:53], 1
    v_cndmask_b32_dpp v86, v86, v86, vcc wave_shr:1 row_mask:0xf bank_mask:0xf
    v_cndmask_b32_dpp v87, v87, v87, vcc wave_shr:1 row_mask:0xf bank_mask:0xf
    s_andn2_b64 s[82:83], s[82:83], s[52:53]
    v_cndmask_b32_dpp v7, v7, v7, vcc wave_shr:1 row_mask:0xf bank_mask:0xf
    s_mov_b64 exec, s[50:51]
    s_cbranch_scc0 L2_d38
    s_mov_b64 exec, s[82:83]
    s_nop 1
    v_mfma_f32_4x4x4_16b_bf16 v[88:91], v[12:13], v[84:85], 0
    s_nop 1
    v_mfma_f32_4x4x4_16b_bf16 v[88:91], v[10:11], v[86:87], v[88:91]
    s_nop 4
    v_cvt_pk_bf16_f32 v88, v88, v89
    v_cvt_pk_bf16_f32 v89, v90, v91
    ds_pk_add_bf16 v7, v88 offset:65408
    ds_pk_add_bf16 v7, v89 offset:65412
    s_mov_b64 exec, s[50:51]
    s_branch L2_d38
L2_c39:
    s_lshl_b64 s[52:53], s[82:83], 1
    s_andn2_b64 s[52:53], s[52:53], s[80:81]
    s_andn2_b64 s[52:53], s[52:53], s[54:55]
    s_or_b64 s[80:81], s[80:81], s[52:53]
    s_not_b64 vcc, s[52:53]
    s_mov_b64 exec, -1
    v_cndmask_b32_dpp v84, v84, v84, vcc wave_shr:1 row_mask:0xf bank_mask:0xf
    v_cndmask_b32_dpp v85, v85, v85, vcc wave_shr:1 row_mask:0xf bank_mask:0xf
    s_lshr_b64 s[52:53], s[52:53], 1
    v_cndmask_b32_dpp v86, v86, v86, vcc wave_shr:1 row_mask:0xf bank_mask:0xf
    v_cndmask_b32_dpp v87, v87, v87, vcc wave_shr:1 row_mask:0xf bank_mask:0xf
    s_andn2_b64 s[82:83], s[82:83], s[52:53]
    v_cndmask_b32_dpp v7, v7, v7, vcc wave_shr:1 row_mask:0xf bank_mask:0xf
    s_mov_b64 exec, s[54:55]
    s_cbranch_scc0 L2_d39
    s_mov_b64 exec, s[82:83]
    s_nop 1
    v_mfma_f32_4x4x4_16b_bf16 v[88:91], v[12:13], v[84:85], 0
    s_nop 1
    v_mfma_f32_4x4x4_16b_bf16 v[88:91], v[10:11], v[86:87], v[88:91]
    s_nop 4
    v_cvt_pk_bf16_f32 v88, v88, v89
    v_cvt_pk_bf16_f32 v89, v90, v91
    ds_pk_add_bf16 v7, v88 offset:65408
    ds_pk_add_bf16 v7, v89 offset:65412
    s_mov_b64 exec, s[54:55]
    s_branch L2_d39
L2_c40:
    s_lshl_b64 s[52:53], s[82:83], 1
    s_andn2_b64 s[52:53], s[52:53], s[80:81]
    s_andn2_b64 s[52:53], s[52:53], s[50:51]
    s_or_b64 s[80:81], s[80:81], s[52:53]
    s_not_b64 vcc, s[52:53]
    s_mov_b64 exec, -1
    v_cndmask_b32_dpp v84, v84, v84, vcc wave_shr:1 row_mask:0xf bank_mask:0xf
    v_cndmask_b32_dpp v85, v85, v85, vcc wave_shr:1 row_mask:0xf bank_mask:0xf
    s_lshr_b64 s[52:53], s[52:53], 1
    v_cndmask_b32_dpp v86, v86, v86, vcc wave_shr:1 row_mask:0xf bank_mask:0xf
    v_cndmask_b32_dpp v87, v87, v87, vcc wave_shr:1 row_mask:0xf bank_mask:0xf
    s_andn2_b64 s[82:83], s[82:83], s[52:53]
    v_cndmask_b32_dpp v7, v7, v7, vcc wave_shr:1 row_mask:0xf bank_mask:0xf
    s_mov_b64 exec, s[50:51]
    s_cbranch_scc0 L2_d40
    s_mov_b64 exec, s[82:83]
    s_nop 1
    v_mfma_f32_4x4x4_16b_bf16 v[88:91], v[12:13], v[84:85], 0
    s_nop 1
    v_mfma_f32_4x4x4_16b_bf16 v[88:91], v[10:11], v[86:87], v[88:91]
    s_nop 4
    v_cvt_pk_bf16_f32 v88, v88, v89
    v_cvt_pk_bf16_f32 v89, v90, v91
    ds_pk_add_bf16 v7, v88 offset:65408
    ds_pk_add_bf16 v7, v89 offset:65412
    s_mov_b64 exec, s[50:51]
    s_branch L2_d40
L2_c41:
    s_lshl_b64 s[52:53], s[82:83], 1
    s_andn2_b64 s[52:53], s[52:53], s[80:81]
    s_andn2_b64 s[52:53], s[52:53], s[54:55]
    s_or_b64 s[80:81], s[80:81], s[52:53]
    s_not_b64 vcc, s[52:53]
    s_mov_b64 exec, -1
    v_cndmask_b32_dpp v84, v84, v84, vcc wave_shr:1 row_mask:0xf bank_mask:0xf
    v_cndmask_b32_dpp v85, v85, v85, vcc wave_shr:1 row_mask:0xf bank_mask:0xf
    s_lshr_b64 s[52:53], s[52:53], 1
    v_cndmask_b32_dpp v86, v86, v86, vcc wave_shr:1 row_mask:0xf bank_mask:0xf
    v_cndmask_b32_dpp v87, v87, v87, vcc wave_shr:1 row_mask:0xf bank_mask:0xf
    s_andn2_b64 s[82:83], s[82:83], s[52:53]
    v_cndmask_b32_dpp v7, v7, v7, vcc wave_shr:1 row_mask:0xf bank_mask:0xf
    s_mov_b64 exec, s[54:55]
    s_cbranch_scc0 L2_d41
    s_mov_b64 exec, s[82:83]
    s_nop 1
    v_mfma_f32_4x4x4_16b_bf16 v[88:91], v[12:13], v[84:85], 0
    s_nop 1
    v_mfma_f32_4x4x4_16b_bf16 v[88:91], v[10:11], v[86:87], v[88:91]
    s_nop 4
    v_cvt_pk_bf16_f32 v88, v88, v89
    v_cvt_pk_bf16_f32 v89, v90, v91
    ds_pk_add_bf16 v7, v88 offset:65408
    ds_pk_add_bf16 v7, v89 offset:65412
    s_mov_b64 exec, s[54:55]
    s_branch L2_d41
L2_c42:
    s_lshl_b64 s[52:53], s[82:83], 1
    s_andn2_b64 s[52:53], s[52:53], s[80:81]
    s_andn2_b64 s[52:53], s[52:53], s[50:51]
    s_or_b64 s[80:81], s[80:81], s[52:53]
    s_not_b64 vcc, s[52:53]
    s_mov_b64 exec, -1
    v_cndmask_b32_dpp v84, v84, v84, vcc wave_shr:1 row_mask:0xf bank_mask:0xf
    v_cndmask_b32_dpp v85, v85, v85, vcc wave_shr:1 row_mask:0xf bank_mask:0xf
    s_lshr_b64 s[52:53], s[52:53], 1
    v_cndmask_b32_dpp v86, v86, v86, vcc wave_shr:1 row_mask:0xf bank_mask:0xf
    v_cndmask_b32_dpp v87, v87, v87, vcc wave_shr:1 row_mask:0xf bank_mask:0xf
    s_andn2_b64 s[82:83], s[82:83], s[52:53]
    v_cndmask_b32_dpp v7, v7, v7, vcc wave_shr:1 row_mask:0xf bank_mask:0xf
    s_mov_b64 exec, s[50:51]
    s_cbranch_scc0 L2_d42
    s_mov_b64 exec, s[82:83]
    s_nop 1
    v_mfma_f32_4x4x4_16b_bf16 v[88:91], v[12:13], v[84:85], 0
    s_nop 1
    v_mfma_f32_4x4x4_16b_bf16 v[88:91], v[10:11], v[86:87], v[88:91]
    s_nop 4
    v_cvt_pk_bf16_f32 v88, v88, v89
    v_cvt_pk_bf16_f32 v89, v90, v91
    ds_pk_add_bf16 v7, v88 offset:65408
    ds_pk_add_bf16 v7, v89 offset:65412
    s_mov_b64 exec, s[50:51]
    s_branch L2_d42
L2_xa43:
    s_cmp_eq_u32 s101, 1
    s_cbranch_scc1 L2_xc43
    v_lshlrev_b32 v89, 0, v96
    v_add_u32 v90, 140, v97
    v_bitop3_b32 v90, v89, v45, v90 bitop3:0x6a
    ds_write_b32 v98, v90 offset:28
    v_lshlrev_b32 v89, 4, v96
    v_add_u32 v90, 120, v97
    v_bitop3_b32 v90, v89, v45, v90 bitop3:0x6a
    ds_write_b32 v98, v90 offset:24
    v_lshlrev_b32 v89, 8, v96
    v_add_u32 v90, 100, v97
    v_bitop3_b32 v90, v89, v45, v90 bitop3:0x6a
    ds_write_b32 v98, v90 offset:20
L2_xc43:
    v_lshlrev_b32 v89, 12, v96
    v_add_u32 v90, 80, v97
    v_bitop3_b32 v90, v89, v45, v90 bitop3:0x6a
    ds_write_b32 v98, v90 offset:16
    s_branch L2_xb43
L2_xe43:
    v_cmp_lt_u32 vcc, 32, v99
    v_cmp_lt_u32 s[58:59], 31, v88
    v_lshrrev_b32 v89, 16, v96
    v_add_u32 v97, 80, v97
    s_or_b64 vcc, vcc, s[58:59]
    s_cbranch_scc1 L2_xs43
    v_lshlrev_b32 v89, v1, v89
    v_and_b32 v89, v45, v89
    v_cmp_ne_u32 vcc, 0, v89
    v_xor_b32 v90, v97, v89
    s_add_u32 s3, s37, s38
    v_mbcnt_lo_u32_b32 v98, vcc_lo, 0
    v_mbcnt_hi_u32_b32 v98, vcc_hi, v98
    s_bcnt1_i32_b64 s41, vcc
    v_lshl_add_u32 v98, v98, 2, s3
    s_mov_b64 exec, vcc
    ds_write_b32 v98, v90
    s_mov_b64 exec, -1
    s_lshl2_add_u32 s37, s41, s37
    s_branch L2_xr43
L2_xf43:
    s_waitcnt lgkmcnt(0)
    s_cmp_gt_u32 s37, 1024
    s_cbranch_scc1 L2_xs43
    v_mov_b32 v43, -1
    s_cmp_ge_u32 s37, 512
    s_cbranch_scc1 L2_xg43
    v_mov_b32 v42, -1
    s_cmp_ge_u32 s37, 256
    s_cbranch_scc1 L2_xg43
    v_mov_b32 v41, -1
    s_branch L2_xg43
L2_xs43:
    s_waitcnt lgkmcnt(0)
    v_mov_b32 v40, -1
    v_mov_b32 v41, -1
    v_mov_b32 v42, -1
    v_mov_b32 v43, -1
    s_add_u32 s3, s42, 2
    s_bitset1_b32 s36, s3
    s_branch L2_xg43
L2_c44:
    s_lshl_b64 s[52:53], s[82:83], 1
    s_andn2_b64 s[52:53], s[52:53], s[80:81]
    s_andn2_b64 s[52:53], s[52:53], s[54:55]
    s_or_b64 s[80:81], s[80:81], s[52:53]
    s_not_b64 vcc, s[52:53]
    s_mov_b64 exec, -1
    v_cndmask_b32_dpp v84, v84, v84, vcc wave_shr:1 row_mask:0xf bank_mask:0xf
    v_cndmask_b32_dpp v85, v85, v85, vcc wave_shr:1 row_mask:0xf bank_mask:0xf
    s_lshr_b64 s[52:53], s[52:53], 1
    v_cndmask_b32_dpp v86, v86, v86, vcc wave_shr:1 row_mask:0xf bank_mask:0xf
    v_cndmask_b32_dpp v87, v87, v87, vcc wave_shr:1 row_mask:0xf bank_mask:0xf
    s_andn2_b64 s[82:83], s[82:83], s[52:53]
    v_cndmask_b32_dpp v7, v7, v7, vcc wave_shr:1 row_mask:0xf bank_mask:0xf
    s_mov_b64 exec, s[54:55]
    s_cbranch_scc0 L2_d44
    s_mov_b64 exec, s[82:83]
    s_nop 1
    v_mfma_f32_4x4x4_16b_bf16 v[88:91], v[12:13], v[84:85], 0
    s_nop 1
    v_mfma_f32_4x4x4_16b_bf16 v[88:91], v[10:11], v[86:87], v[88:91]
    s_nop 4
    v_cvt_pk_bf16_f32 v88, v88, v89
    v_cvt_pk_bf16_f32 v89, v90, v91
    ds_pk_add_bf16 v7, v88 offset:65408
    ds_pk_add_bf16 v7, v89 offset:65412
    s_mov_b64 exec, s[54:55]
    s_branch L2_d44
L2_c45:
    s_lshl_b64 s[52:53], s[82:83], 1
    s_andn2_b64 s[52:53], s[52:53], s[80:81]
    s_andn2_b64 s[52:53], s[52:53], s[50:51]
    s_or_b64 s[80:81], s[80:81], s[52:53]
    s_not_b64 vcc, s[52:53]
    s_mov_b64 exec, -1
    v_cndmask_b32_dpp v84, v84, v84, vcc wave_shr:1 row_mask:0xf bank_mask:0xf
    v_cndmask_b32_dpp v85, v85, v85, vcc wave_shr:1 row_mask:0xf bank_mask:0xf
    s_lshr_b64 s[52:53], s[52:53], 1
    v_cndmask_b32_dpp v86, v86, v86, vcc wave_shr:1 row_mask:0xf bank_mask:0xf
    v_cndmask_b32_dpp v87, v87, v87, vcc wave_shr:1 row_mask:0xf bank_mask:0xf
    s_andn2_b64 s[82:83], s[82:83], s[52:53]
    v_cndmask_b32_dpp v7, v7, v7, vcc wave_shr:1 row_mask:0xf bank_mask:0xf
    s_mov_b64 exec, s[50:51]
    s_cbranch_scc0 L2_d45
    s_mov_b64 exec, s[82:83]
    s_nop 1
    v_mfma_f32_4x4x4_16b_bf16 v[88:91], v[12:13], v[84:85], 0
    s_nop 1
    v_mfma_f32_4x4x4_16b_bf16 v[88:91], v[10:11], v[86:87], v[88:91]
    s_nop 4
    v_cvt_pk_bf16_f32 v88, v88, v89
    v_cvt_pk_bf16_f32 v89, v90, v91
    ds_pk_add_bf16 v7, v88 offset:65408
    ds_pk_add_bf16 v7, v89 offset:65412
    s_mov_b64 exec, s[50:51]
    s_branch L2_d45
L2_c46:
    s_lshl_b64 s[52:53], s[82:83], 1
    s_andn2_b64 s[52:53], s[52:53], s[80:81]
    s_andn2_b64 s[52:53], s[52:53], s[54:55]
    s_or_b64 s[80:81], s[80:81], s[52:53]
    s_not_b64 vcc, s[52:53]
    s_mov_b64 exec, -1
    v_cndmask_b32_dpp v84, v84, v84, vcc wave_shr:1 row_mask:0xf bank_mask:0xf
    v_cndmask_b32_dpp v85, v85, v85, vcc wave_shr:1 row_mask:0xf bank_mask:0xf
    s_lshr_b64 s[52:53], s[52:53], 1
    v_cndmask_b32_dpp v86, v86, v86, vcc wave_shr:1 row_mask:0xf bank_mask:0xf
    v_cndmask_b32_dpp v87, v87, v87, vcc wave_shr:1 row_mask:0xf bank_mask:0xf
    s_andn2_b64 s[82:83], s[82:83], s[52:53]
    v_cndmask_b32_dpp v7, v7, v7, vcc wave_shr:1 row_mask:0xf bank_mask:0xf
    s_mov_b64 exec, s[54:55]
    s_cbranch_scc0 L2_d46
    s_mov_b64 exec, s[82:83]
    s_nop 1
    v_mfma_f32_4x4x4_16b_bf16 v[88:91], v[12:13], v[84:85], 0
    s_nop 1
    v_mfma_f32_4x4x4_16b_bf16 v[88:91], v[10:11], v[86:87], v[88:91]
    s_nop 4
    v_cvt_pk_bf16_f32 v88, v88, v89
    v_cvt_pk_bf16_f32 v89, v90, v91
    ds_pk_add_bf16 v7, v88 offset:65408
    ds_pk_add_bf16 v7, v89 offset:65412
    s_mov_b64 exec, s[54:55]
    s_branch L2_d46
L2_c47:
    s_lshl_b64 s[52:53], s[82:83], 1
    s_andn2_b64 s[52:53], s[52:53], s[80:81]
    s_andn2_b64 s[52:53], s[52:53], s[50:51]
    s_or_b64 s[80:81], s[80:81], s[52:53]
    s_not_b64 vcc, s[52:53]
    s_mov_b64 exec, -1
    v_cndmask_b32_dpp v84, v84, v84, vcc wave_shr:1 row_mask:0xf bank_mask:0xf
    v_cndmask_b32_dpp v85, v85, v85, vcc wave_shr:1 row_mask:0xf bank_mask:0xf
    s_lshr_b64 s[52:53], s[52:53], 1
    v_cndmask_b32_dpp v86, v86, v86, vcc wave_shr:1 row_mask:0xf bank_mask:0xf
    v_cndmask_b32_dpp v87, v87, v87, vcc wave_shr:1 row_mask:0xf bank_mask:0xf
    s_andn2_b64 s[82:83], s[82:83], s[52:53]
    v_cndmask_b32_dpp v7, v7, v7, vcc wave_shr:1 row_mask:0xf bank_mask:0xf
    s_mov_b64 exec, s[50:51]
    s_cbranch_scc0 L2_d47
    s_mov_b64 exec, s[82:83]
    s_nop 1
    v_mfma_f32_4x4x4_16b_bf16 v[88:91], v[12:13], v[84:85], 0
    s_nop 1
    v_mfma_f32_4x4x4_16b_bf16 v[88:91], v[10:11], v[86:87], v[88:91]
    s_nop 4
    v_cvt_pk_bf16_f32 v88, v88, v89
    v_cvt_pk_bf16_f32 v89, v90, v91
    ds_pk_add_bf16 v7, v88 offset:65408
    ds_pk_add_bf16 v7, v89 offset:65412
    s_mov_b64 exec, s[50:51]
    s_branch L2_d47
L2_c48:
    s_lshl_b64 s[52:53], s[82:83], 1
    s_andn2_b64 s[52:53], s[52:53], s[80:81]
    s_andn2_b64 s[52:53], s[52:53], s[54:55]
    s_or_b64 s[80:81], s[80:81], s[52:53]
    s_not_b64 vcc, s[52:53]
    s_mov_b64 exec, -1
    v_cndmask_b32_dpp v84, v84, v84, vcc wave_shr:1 row_mask:0xf bank_mask:0xf
    v_cndmask_b32_dpp v85, v85, v85, vcc wave_shr:1 row_mask:0xf bank_mask:0xf
    s_lshr_b64 s[52:53], s[52:53], 1
    v_cndmask_b32_dpp v86, v86, v86, vcc wave_shr:1 row_mask:0xf bank_mask:0xf
    v_cndmask_b32_dpp v87, v87, v87, vcc wave_shr:1 row_mask:0xf bank_mask:0xf
    s_andn2_b64 s[82:83], s[82:83], s[52:53]
    v_cndmask_b32_dpp v7, v7, v7, vcc wave_shr:1 row_mask:0xf bank_mask:0xf
    s_mov_b64 exec, s[54:55]
    s_cbranch_scc0 L2_d48
    s_mov_b64 exec, s[82:83]
    s_nop 1
    v_mfma_f32_4x4x4_16b_bf16 v[88:91], v[12:13], v[84:85], 0
    s_nop 1
    v_mfma_f32_4x4x4_16b_bf16 v[88:91], v[10:11], v[86:87], v[88:91]
    s_nop 4
    v_cvt_pk_bf16_f32 v88, v88, v89
    v_cvt_pk_bf16_f32 v89, v90, v91
    ds_pk_add_bf16 v7, v88 offset:65408
    ds_pk_add_bf16 v7, v89 offset:65412
    s_mov_b64 exec, s[54:55]
    s_branch L2_d48
L2_c49:
    s_lshl_b64 s[52:53], s[82:83], 1
    s_andn2_b64 s[52:53], s[52:53], s[80:81]
    s_andn2_b64 s[52:53], s[52:53], s[50:51]
    s_or_b64 s[80:81], s[80:81], s[52:53]
    s_not_b64 vcc, s[52:53]
    s_mov_b64 exec, -1
    v_cndmask_b32_dpp v84, v84, v84, vcc wave_shr:1 row_mask:0xf bank_mask:0xf
    v_cndmask_b32_dpp v85, v85, v85, vcc wave_shr:1 row_mask:0xf bank_mask:0xf
    s_lshr_b64 s[52:53], s[52:53], 1
    v_cndmask_b32_dpp v86, v86, v86, vcc wave_shr:1 row_mask:0xf bank_mask:0xf
    v_cndmask_b32_dpp v87, v87, v87, vcc wave_shr:1 row_mask:0xf bank_mask:0xf
    s_andn2_b64 s[82:83], s[82:83], s[52:53]
    v_cndmask_b32_dpp v7, v7, v7, vcc wave_shr:1 row_mask:0xf bank_mask:0xf
    s_mov_b64 exec, s[50:51]
    s_cbranch_scc0 L2_d49
    s_mov_b64 exec, s[82:83]
    s_nop 1
    v_mfma_f32_4x4x4_16b_bf16 v[88:91], v[12:13], v[84:85], 0
    s_nop 1
    v_mfma_f32_4x4x4_16b_bf16 v[88:91], v[10:11], v[86:87], v[88:91]
    s_nop 4
    v_cvt_pk_bf16_f32 v88, v88, v89
    v_cvt_pk_bf16_f32 v89, v90, v91
    ds_pk_add_bf16 v7, v88 offset:65408
    ds_pk_add_bf16 v7, v89 offset:65412
    s_mov_b64 exec, s[50:51]
    s_branch L2_d49
L2_xo50:
    v_cmp_lt_u32 vcc, 20, v99
    s_mov_b32 s101, 1
    s_cbranch_vccz L2_xp50
    v_cmp_lt_u32 vcc, 32, v99
    v_cmp_lt_u32 s[58:59], 31, v88
    s_mov_b32 s101, 2
    s_or_b64 vcc, vcc, s[58:59]
    s_cbranch_scc0 L2_xp50
    s_mov_b32 s37, 0x10000
    s_branch L2_xp50
L2_c51:
    s_lshl_b64 s[52:53], s[82:83], 1
    s_andn2_b64 s[52:53], s[52:53], s[80:81]
    s_andn2_b64 s[52:53], s[52:53], s[54:55]
    s_or_b64 s[80:81], s[80:81], s[52:53]
    s_not_b64 vcc, s[52:53]
    s_mov_b64 exec, -1
    v_cndmask_b32_dpp v84, v84, v84, vcc wave_shr:1 row_mask:0xf bank_mask:0xf
    v_cndmask_b32_dpp v85, v85, v85, vcc wave_shr:1 row_mask:0xf bank_mask:0xf
    s_lshr_b64 s[52:53], s[52:53], 1
    v_cndmask_b32_dpp v86, v86, v86, vcc wave_shr:1 row_mask:0xf bank_mask:0xf
    v_cndmask_b32_dpp v87, v87, v87, vcc wave_shr:1 row_mask:0xf bank_mask:0xf
    s_andn2_b64 s[82:83], s[82:83], s[52:53]
    v_cndmask_b32_dpp v7, v7, v7, vcc wave_shr:1 row_mask:0xf bank_mask:0xf
    s_mov_b64 exec, s[54:55]
    s_cbranch_scc0 L2_d51
    s_mov_b64 exec, s[82:83]
    s_nop 1
    v_mfma_f32_4x4x4_16b_bf16 v[88:91], v[12:13], v[84:85], 0
    s_nop 1
    v_mfma_f32_4x4x4_16b_bf16 v[88:91], v[10:11], v[86:87], v[88:91]
    s_nop 4
    v_cvt_pk_bf16_f32 v88, v88, v89
    v_cvt_pk_bf16_f32 v89, v90, v91
    ds_pk_add_bf16 v7, v88 offset:65408
    ds_pk_add_bf16 v7, v89 offset:65412
    s_mov_b64 exec, s[54:55]
    s_branch L2_d51
L2_c52:
    s_lshl_b64 s[52:53], s[82:83], 1
    s_andn2_b64 s[52:53], s[52:53], s[80:81]
    s_andn2_b64 s[52:53], s[52:53], s[50:51]
    s_or_b64 s[80:81], s[80:81], s[52:53]
    s_not_b64 vcc, s[52:53]
    s_mov_b64 exec, -1
    v_cndmask_b32_dpp v84, v84, v84, vcc wave_shr:1 row_mask:0xf bank_mask:0xf
    v_cndmask_b32_dpp v85, v85, v85, vcc wave_shr:1 row_mask:0xf bank_mask:0xf
    s_lshr_b64 s[52:53], s[52:53], 1
    v_cndmask_b32_dpp v86, v86, v86, vcc wave_shr:1 row_mask:0xf bank_mask:0xf
    v_cndmask_b32_dpp v87, v87, v87, vcc wave_shr:1 row_mask:0xf bank_mask:0xf
    s_andn2_b64 s[82:83], s[82:83], s[52:53]
    v_cndmask_b32_dpp v7, v7, v7, vcc wave_shr:1 row_mask:0xf bank_mask:0xf
    s_mov_b64 exec, s[50:51]
    s_cbranch_scc0 L2_d52
    s_mov_b64 exec, s[82:83]
    s_nop 1
    v_mfma_f32_4x4x4_16b_bf16 v[88:91], v[12:13], v[84:85], 0
    s_nop 1
    v_mfma_f32_4x4x4_16b_bf16 v[88:91], v[10:11], v[86:87], v[88:91]
    s_nop 4
    v_cvt_pk_bf16_f32 v88, v88, v89
    v_cvt_pk_bf16_f32 v89, v90, v91
    ds_pk_add_bf16 v7, v88 offset:65408
    ds_pk_add_bf16 v7, v89 offset:65412
    s_mov_b64 exec, s[50:51]
    s_branch L2_d52
L2_c53:
    s_lshl_b64 s[52:53], s[82:83], 1
    s_andn2_b64 s[52:53], s[52:53], s[80:81]
    s_andn2_b64 s[52:53], s[52:53], s[54:55]
    s_or_b64 s[80:81], s[80:81], s[52:53]
    s_not_b64 vcc, s[52:53]
    s_mov_b64 exec, -1
    v_cndmask_b32_dpp v84, v84, v84, vcc wave_shr:1 row_mask:0xf bank_mask:0xf
    v_cndmask_b32_dpp v85, v85, v85, vcc wave_shr:1 row_mask:0xf bank_mask:0xf
    s_lshr_b64 s[52:53], s[52:53], 1
    v_cndmask_b32_dpp v86, v86, v86, vcc wave_shr:1 row_mask:0xf bank_mask:0xf
    v_cndmask_b32_dpp v87, v87, v87, vcc wave_shr:1 row_mask:0xf bank_mask:0xf
    s_andn2_b64 s[82:83], s[82:83], s[52:53]
    v_cndmask_b32_dpp v7, v7, v7, vcc wave_shr:1 row_mask:0xf bank_mask:0xf
    s_mov_b64 exec, s[54:55]
    s_cbranch_scc0 L2_d53
    s_mov_b64 exec, s[82:83]
    s_nop 1
    v_mfma_f32_4x4x4_16b_bf16 v[88:91], v[12:13], v[84:85], 0
    s_nop 1
    v_mfma_f32_4x4x4_16b_bf16 v[88:91], v[10:11], v[86:87], v[88:91]
    s_nop 4
    v_cvt_pk_bf16_f32 v88, v88, v89
    v_cvt_pk_bf16_f32 v89, v90, v91
    ds_pk_add_bf16 v7, v88 offset:65408
    ds_pk_add_bf16 v7, v89 offset:65412
    s_mov_b64 exec, s[54:55]
    s_branch L2_d53
L2_c54:
    s_lshl_b64 s[52:53], s[82:83], 1
    s_andn2_b64 s[52:53], s[52:53], s[80:81]
    s_andn2_b64 s[52:53], s[52:53], s[50:51]
    s_or_b64 s[80:81], s[80:81], s[52:53]
    s_not_b64 vcc, s[52:53]
    s_mov_b64 exec, -1
    v_cndmask_b32_dpp v84, v84, v84, vcc wave_shr:1 row_mask:0xf bank_mask:0xf
    v_cndmask_b32_dpp v85, v85, v85, vcc wave_shr:1 row_mask:0xf bank_mask:0xf
    s_lshr_b64 s[52:53], s[52:53], 1
    v_cndmask_b32_dpp v86, v86, v86, vcc wave_shr:1 row_mask:0xf bank_mask:0xf
    v_cndmask_b32_dpp v87, v87, v87, vcc wave_shr:1 row_mask:0xf bank_mask:0xf
    s_andn2_b64 s[82:83], s[82:83], s[52:53]
    v_cndmask_b32_dpp v7, v7, v7, vcc wave_shr:1 row_mask:0xf bank_mask:0xf
    s_mov_b64 exec, s[50:51]
    s_cbranch_scc0 L2_d54
    s_mov_b64 exec, s[82:83]
    s_nop 1
    v_mfma_f32_4x4x4_16b_bf16 v[88:91], v[12:13], v[84:85], 0
    s_nop 1
    v_mfma_f32_4x4x4_16b_bf16 v[88:91], v[10:11], v[86:87], v[88:91]
    s_nop 4
    v_cvt_pk_bf16_f32 v88, v88, v89
    v_cvt_pk_bf16_f32 v89, v90, v91
    ds_pk_add_bf16 v7, v88 offset:65408
    ds_pk_add_bf16 v7, v89 offset:65412
    s_mov_b64 exec, s[50:51]
    s_branch L2_d54
L2_c55:
    s_lshl_b64 s[52:53], s[82:83], 1
    s_andn2_b64 s[52:53], s[52:53], s[80:81]
    s_andn2_b64 s[52:53], s[52:53], s[54:55]
    s_or_b64 s[80:81], s[80:81], s[52:53]
    s_not_b64 vcc, s[52:53]
    s_mov_b64 exec, -1
    v_cndmask_b32_dpp v84, v84, v84, vcc wave_shr:1 row_mask:0xf bank_mask:0xf
    v_cndmask_b32_dpp v85, v85, v85, vcc wave_shr:1 row_mask:0xf bank_mask:0xf
    s_lshr_b64 s[52:53], s[52:53], 1
    v_cndmask_b32_dpp v86, v86, v86, vcc wave_shr:1 row_mask:0xf bank_mask:0xf
    v_cndmask_b32_dpp v87, v87, v87, vcc wave_shr:1 row_mask:0xf bank_mask:0xf
    s_andn2_b64 s[82:83], s[82:83], s[52:53]
    v_cndmask_b32_dpp v7, v7, v7, vcc wave_shr:1 row_mask:0xf bank_mask:0xf
    s_mov_b64 exec, s[54:55]
    s_cbranch_scc0 L2_d55
    s_mov_b64 exec, s[82:83]
    s_nop 1
    v_mfma_f32_4x4x4_16b_bf16 v[88:91], v[12:13], v[84:85], 0
    s_nop 1
    v_mfma_f32_4x4x4_16b_bf16 v[88:91], v[10:11], v[86:87], v[88:91]
    s_nop 4
    v_cvt_pk_bf16_f32 v88, v88, v89
    v_cvt_pk_bf16_f32 v89, v90, v91
    ds_pk_add_bf16 v7, v88 offset:65408
    ds_pk_add_bf16 v7, v89 offset:65412
    s_mov_b64 exec, s[54:55]
    s_branch L2_d55
L2_c56:
    s_lshl_b64 s[52:53], s[82:83], 1
    s_andn2_b64 s[52:53], s[52:53], s[80:81]
    s_andn2_b64 s[52:53], s[52:53], s[50:51]
    s_or_b64 s[80:81], s[80:81], s[52:53]
    s_not_b64 vcc, s[52:53]
    s_mov_b64 exec, -1
    v_cndmask_b32_dpp v84, v84, v84, vcc wave_shr:1 row_mask:0xf bank_mask:0xf
    v_cndmask_b32_dpp v85, v85, v85, vcc wave_shr:1 row_mask:0xf bank_mask:0xf
    s_lshr_b64 s[52:53], s[52:53], 1
    v_cndmask_b32_dpp v86, v86, v86, vcc wave_shr:1 row_mask:0xf bank_mask:0xf
    v_cndmask_b32_dpp v87, v87, v87, vcc wave_shr:1 row_mask:0xf bank_mask:0xf
    s_andn2_b64 s[82:83], s[82:83], s[52:53]
    v_cndmask_b32_dpp v7, v7, v7, vcc wave_shr:1 row_mask:0xf bank_mask:0xf
    s_mov_b64 exec, s[50:51]
    s_cbranch_scc0 L2_d56
    s_mov_b64 exec, s[82:83]
    s_nop 1
    v_mfma_f32_4x4x4_16b_bf16 v[88:91], v[12:13], v[84:85], 0
    s_nop 1
    v_mfma_f32_4x4x4_16b_bf16 v[88:91], v[10:11], v[86:87], v[88:91]
    s_nop 4
    v_cvt_pk_bf16_f32 v88, v88, v89
    v_cvt_pk_bf16_f32 v89, v90, v91
    ds_pk_add_bf16 v7, v88 offset:65408
    ds_pk_add_bf16 v7, v89 offset:65412
    s_mov_b64 exec, s[50:51]
    s_branch L2_d56
L2_c57:
    s_lshl_b64 s[52:53], s[82:83], 1
    s_andn2_b64 s[52:53], s[52:53], s[80:81]
    s_andn2_b64 s[52:53], s[52:53], s[54:55]
    s_or_b64 s[80:81], s[80:81], s[52:53]
    s_not_b64 vcc, s[52:53]
    s_mov_b64 exec, -1
    v_cndmask_b32_dpp v84, v84, v84, vcc wave_shr:1 row_mask:0xf bank_mask:0xf
    v_cndmask_b32_dpp v85, v85, v85, vcc wave_shr:1 row_mask:0xf bank_mask:0xf
    s_lshr_b64 s[52:53], s[52:53], 1
    v_cndmask_b32_dpp v86, v86, v86, vcc wave_shr:1 row_mask:0xf bank_mask:0xf
    v_cndmask_b32_dpp v87, v87, v87, vcc wave_shr:1 row_mask:0xf bank_mask:0xf
    s_andn2_b64 s[82:83], s[82:83], s[52:53]
    v_cndmask_b32_dpp v7, v7, v7, vcc wave_shr:1 row_mask:0xf bank_mask:0xf
    s_mov_b64 exec, s[54:55]
    s_cbranch_scc0 L2_d57
    s_mov_b64 exec, s[82:83]
    s_nop 1
    v_mfma_f32_4x4x4_16b_bf16 v[88:91], v[12:13], v[84:85], 0
    s_nop 1
    v_mfma_f32_4x4x4_16b_bf16 v[88:91], v[10:11], v[86:87], v[88:91]
    s_nop 4
    v_cvt_pk_bf16_f32 v88, v88, v89
    v_cvt_pk_bf16_f32 v89, v90, v91
    ds_pk_add_bf16 v7, v88 offset:65408
    ds_pk_add_bf16 v7, v89 offset:65412
    s_mov_b64 exec, s[54:55]
    s_branch L2_d57
L2_c58:
    s_lshl_b64 s[52:53], s[82:83], 1
    s_andn2_b64 s[52:53], s[52:53], s[80:81]
    s_andn2_b64 s[52:53], s[52:53], s[50:51]
    s_or_b64 s[80:81], s[80:81], s[52:53]
    s_not_b64 vcc, s[52:53]
    s_mov_b64 exec, -1
    v_cndmask_b32_dpp v84, v84, v84, vcc wave_shr:1 row_mask:0xf bank_mask:0xf
    v_cndmask_b32_dpp v85, v85, v85, vcc wave_shr:1 row_mask:0xf bank_mask:0xf
    s_lshr_b64 s[52:53], s[52:53], 1
    v_cndmask_b32_dpp v86, v86, v86, vcc wave_shr:1 row_mask:0xf bank_mask:0xf
    v_cndmask_b32_dpp v87, v87, v87, vcc wave_shr:1 row_mask:0xf bank_mask:0xf
    s_andn2_b64 s[82:83], s[82:83], s[52:53]
    v_cndmask_b32_dpp v7, v7, v7, vcc wave_shr:1 row_mask:0xf bank_mask:0xf
    s_mov_b64 exec, s[50:51]
    s_cbranch_scc0 L2_d58
    s_mov_b64 exec, s[82:83]
    s_nop 1
    v_mfma_f32_4x4x4_16b_bf16 v[88:91], v[12:13], v[84:85], 0
    s_nop 1
    v_mfma_f32_4x4x4_16b_bf16 v[88:91], v[10:11], v[86:87], v[88:91]
    s_nop 4
    v_cvt_pk_bf16_f32 v88, v88, v89
    v_cvt_pk_bf16_f32 v89, v90, v91
    ds_pk_add_bf16 v7, v88 offset:65408
    ds_pk_add_bf16 v7, v89 offset:65412
    s_mov_b64 exec, s[50:51]
    s_branch L2_d58
L2_c59:
    s_lshl_b64 s[52:53], s[82:83], 1
    s_andn2_b64 s[52:53], s[52:53], s[80:81]
    s_andn2_b64 s[52:53], s[52:53], s[54:55]
    s_or_b64 s[80:81], s[80:81], s[52:53]
    s_not_b64 vcc, s[52:53]
    s_mov_b64 exec, -1
    v_cndmask_b32_dpp v84, v84, v84, vcc wave_shr:1 row_mask:0xf bank_mask:0xf
    v_cndmask_b32_dpp v85, v85, v85, vcc wave_shr:1 row_mask:0xf bank_mask:0xf
    s_lshr_b64 s[52:53], s[52:53], 1
    v_cndmask_b32_dpp v86, v86, v86, vcc wave_shr:1 row_mask:0xf bank_mask:0xf
    v_cndmask_b32_dpp v87, v87, v87, vcc wave_shr:1 row_mask:0xf bank_mask:0xf
    s_andn2_b64 s[82:83], s[82:83], s[52:53]
    v_cndmask_b32_dpp v7, v7, v7, vcc wave_shr:1 row_mask:0xf bank_mask:0xf
    s_mov_b64 exec, s[54:55]
    s_cbranch_scc0 L2_d59
    s_mov_b64 exec, s[82:83]
    s_nop 1
    v_mfma_f32_4x4x4_16b_bf16 v[88:91], v[12:13], v[84:85], 0
    s_nop 1
    v_mfma_f32_4x4x4_16b_bf16 v[88:91], v[10:11], v[86:87], v[88:91]
    s_nop 4
    v_cvt_pk_bf16_f32 v88, v88, v89
    v_cvt_pk_bf16_f32 v89, v90, v91
    ds_pk_add_bf16 v7, v88 offset:65408
    ds_pk_add_bf16 v7, v89 offset:65412
    s_mov_b64 exec, s[54:55]
    s_branch L2_d59
L2_c60:
    s_lshl_b64 s[52:53], s[82:83], 1
    s_andn2_b64 s[52:53], s[52:53], s[80:81]
    s_andn2_b64 s[52:53], s[52:53], s[50:51]
    s_or_b64 s[80:81], s[80:81], s[52:53]
    s_not_b64 vcc, s[52:53]
    s_mov_b64 exec, -1
    v_cndmask_b32_dpp v84, v84, v84, vcc wave_shr:1 row_mask:0xf bank_mask:0xf
    v_cndmask_b32_dpp v85, v85, v85, vcc wave_shr:1 row_mask:0xf bank_mask:0xf
    s_lshr_b64 s[52:53], s[52:53], 1
    v_cndmask_b32_dpp v86, v86, v86, vcc wave_shr:1 row_mask:0xf bank_mask:0xf
    v_cndmask_b32_dpp v87, v87, v87, vcc wave_shr:1 row_mask:0xf bank_mask:0xf
    s_andn2_b64 s[82:83], s[82:83], s[52:53]
    v_cndmask_b32_dpp v7, v7, v7, vcc wave_shr:1 row_mask:0xf bank_mask:0xf
    s_mov_b64 exec, s[50:51]
    s_cbranch_scc0 L2_d60
    s_mov_b64 exec, s[82:83]
    s_nop 1
    v_mfma_f32_4x4x4_16b_bf16 v[88:91], v[12:13], v[84:85], 0
    s_nop 1
    v_mfma_f32_4x4x4_16b_bf16 v[88:91], v[10:11], v[86:87], v[88:91]
    s_nop 4
    v_cvt_pk_bf16_f32 v88, v88, v89
    v_cvt_pk_bf16_f32 v89, v90, v91
    ds_pk_add_bf16 v7, v88 offset:65408
    ds_pk_add_bf16 v7, v89 offset:65412
    s_mov_b64 exec, s[50:51]
    s_branch L2_d60
L2_xa61:
    s_cmp_eq_u32 s101, 1
    s_cbranch_scc1 L2_xc61
    v_lshlrev_b32 v89, 0, v96
    v_add_u32 v90, 140, v97
    v_bitop3_b32 v90, v89, v45, v90 bitop3:0x6a
    ds_write_b32 v98, v90 offset:28
    v_lshlrev_b32 v89, 4, v96
    v_add_u32 v90, 120, v97
    v_bitop3_b32 v90, v89, v45, v90 bitop3:0x6a
    ds_write_b32 v98, v90 offset:24
    v_lshlrev_b32 v89, 8, v96
    v_add_u32 v90, 100, v97
    v_bitop3_b32 v90, v89, v45, v90 bitop3:0x6a
    ds_write_b32 v98, v90 offset:20
L2_xc61:
    v_lshlrev_b32 v89, 12, v96
    v_add_u32 v90, 80, v97
    v_bitop3_b32 v90, v89, v45, v90 bitop3:0x6a
    ds_write_b32 v98, v90 offset:16
    s_branch L2_xb61
L2_xe61:
    v_cmp_lt_u32 vcc, 32, v99
    v_cmp_lt_u32 s[58:59], 31, v88
    v_lshrrev_b32 v89, 16, v96
    v_add_u32 v97, 80, v97
    s_or_b64 vcc, vcc, s[58:59]
    s_cbranch_scc1 L2_xs61
    v_lshlrev_b32 v89, v1, v89
    v_and_b32 v89, v45, v89
    v_cmp_ne_u32 vcc, 0, v89
    v_xor_b32 v90, v97, v89
    s_add_u32 s3, s37, s38
    v_mbcnt_lo_u32_b32 v98, vcc_lo, 0
    v_mbcnt_hi_u32_b32 v98, vcc_hi, v98
    s_bcnt1_i32_b64 s41, vcc
    v_lshl_add_u32 v98, v98, 2, s3
    s_mov_b64 exec, vcc
    ds_write_b32 v98, v90
    s_mov_b64 exec, -1
    s_lshl2_add_u32 s37, s41, s37
    s_branch L2_xr61
L2_xf61:
    s_waitcnt lgkmcnt(0)
    s_cmp_gt_u32 s37, 1024
    s_cbranch_scc1 L2_xs61
    v_mov_b32 v43, -1
    s_cmp_ge_u32 s37, 512
    s_cbranch_scc1 L2_xg61
    v_mov_b32 v42, -1
    s_cmp_ge_u32 s37, 256
    s_cbranch_scc1 L2_xg61
    v_mov_b32 v41, -1
    s_branch L2_xg61
L2_xs61:
    s_waitcnt lgkmcnt(0)
    v_mov_b32 v40, -1
    v_mov_b32 v41, -1
    v_mov_b32 v42, -1
    v_mov_b32 v43, -1
    s_add_u32 s3, s42, 2
    s_bitset1_b32 s36, s3
    s_branch L2_xg61
L2_c62:
    s_lshl_b64 s[52:53], s[82:83], 1
    s_andn2_b64 s[52:53], s[52:53], s[80:81]
    s_andn2_b64 s[52:53], s[52:53], s[54:55]
    s_or_b64 s[80:81], s[80:81], s[52:53]
    s_not_b64 vcc, s[52:53]
    s_mov_b64 exec, -1
    v_cndmask_b32_dpp v84, v84, v84, vcc wave_shr:1 row_mask:0xf bank_mask:0xf
    v_cndmask_b32_dpp v85, v85, v85, vcc wave_shr:1 row_mask:0xf bank_mask:0xf
    s_lshr_b64 s[52:53], s[52:53], 1
    v_cndmask_b32_dpp v86, v86, v86, vcc wave_shr:1 row_mask:0xf bank_mask:0xf
    v_cndmask_b32_dpp v87, v87, v87, vcc wave_shr:1 row_mask:0xf bank_mask:0xf
    s_andn2_b64 s[82:83], s[82:83], s[52:53]
    v_cndmask_b32_dpp v7, v7, v7, vcc wave_shr:1 row_mask:0xf bank_mask:0xf
    s_mov_b64 exec, s[54:55]
    s_cbranch_scc0 L2_d62
    s_mov_b64 exec, s[82:83]
    s_nop 1
    v_mfma_f32_4x4x4_16b_bf16 v[88:91], v[12:13], v[84:85], 0
    s_nop 1
    v_mfma_f32_4x4x4_16b_bf16 v[88:91], v[10:11], v[86:87], v[88:91]
    s_nop 4
    v_cvt_pk_bf16_f32 v88, v88, v89
    v_cvt_pk_bf16_f32 v89, v90, v91
    ds_pk_add_bf16 v7, v88 offset:65408
    ds_pk_add_bf16 v7, v89 offset:65412
    s_mov_b64 exec, s[54:55]
    s_branch L2_d62
L2_c63:
    s_lshl_b64 s[52:53], s[82:83], 1
    s_andn2_b64 s[52:53], s[52:53], s[80:81]
    s_andn2_b64 s[52:53], s[52:53], s[50:51]
    s_or_b64 s[80:81], s[80:81], s[52:53]
    s_not_b64 vcc, s[52:53]
    s_mov_b64 exec, -1
    v_cndmask_b32_dpp v84, v84, v84, vcc wave_shr:1 row_mask:0xf bank_mask:0xf
    v_cndmask_b32_dpp v85, v85, v85, vcc wave_shr:1 row_mask:0xf bank_mask:0xf
    s_lshr_b64 s[52:53], s[52:53], 1
    v_cndmask_b32_dpp v86, v86, v86, vcc wave_shr:1 row_mask:0xf bank_mask:0xf
    v_cndmask_b32_dpp v87, v87, v87, vcc wave_shr:1 row_mask:0xf bank_mask:0xf
    s_andn2_b64 s[82:83], s[82:83], s[52:53]
    v_cndmask_b32_dpp v7, v7, v7, vcc wave_shr:1 row_mask:0xf bank_mask:0xf
    s_mov_b64 exec, s[50:51]
    s_cbranch_scc0 L2_d63
    s_mov_b64 exec, s[82:83]
    s_nop 1
    v_mfma_f32_4x4x4_16b_bf16 v[88:91], v[12:13], v[84:85], 0
    s_nop 1
    v_mfma_f32_4x4x4_16b_bf16 v[88:91], v[10:11], v[86:87], v[88:91]
    s_nop 4
    v_cvt_pk_bf16_f32 v88, v88, v89
    v_cvt_pk_bf16_f32 v89, v90, v91
    ds_pk_add_bf16 v7, v88 offset:65408
    ds_pk_add_bf16 v7, v89 offset:65412
    s_mov_b64 exec, s[50:51]
    s_branch L2_d63
L2_c64:
    s_lshl_b64 s[52:53], s[82:83], 1
    s_andn2_b64 s[52:53], s[52:53], s[80:81]
    s_andn2_b64 s[52:53], s[52:53], s[54:55]
    s_or_b64 s[80:81], s[80:81], s[52:53]
    s_not_b64 vcc, s[52:53]
    s_mov_b64 exec, -1
    v_cndmask_b32_dpp v84, v84, v84, vcc wave_shr:1 row_mask:0xf bank_mask:0xf
    v_cndmask_b32_dpp v85, v85, v85, vcc wave_shr:1 row_mask:0xf bank_mask:0xf
    s_lshr_b64 s[52:53], s[52:53], 1
    v_cndmask_b32_dpp v86, v86, v86, vcc wave_shr:1 row_mask:0xf bank_mask:0xf
    v_cndmask_b32_dpp v87, v87, v87, vcc wave_shr:1 row_mask:0xf bank_mask:0xf
    s_andn2_b64 s[82:83], s[82:83], s[52:53]
    v_cndmask_b32_dpp v7, v7, v7, vcc wave_shr:1 row_mask:0xf bank_mask:0xf
    s_mov_b64 exec, s[54:55]
    s_cbranch_scc0 L2_d64
    s_mov_b64 exec, s[82:83]
    s_nop 1
    v_mfma_f32_4x4x4_16b_bf16 v[88:91], v[12:13], v[84:85], 0
    s_nop 1
    v_mfma_f32_4x4x4_16b_bf16 v[88:91], v[10:11], v[86:87], v[88:91]
    s_nop 4
    v_cvt_pk_bf16_f32 v88, v88, v89
    v_cvt_pk_bf16_f32 v89, v90, v91
    ds_pk_add_bf16 v7, v88 offset:65408
    ds_pk_add_bf16 v7, v89 offset:65412
    s_mov_b64 exec, s[54:55]
    s_branch L2_d64
L2_c65:
    s_lshl_b64 s[52:53], s[82:83], 1
    s_andn2_b64 s[52:53], s[52:53], s[80:81]
    s_andn2_b64 s[52:53], s[52:53], s[50:51]
    s_or_b64 s[80:81], s[80:81], s[52:53]
    s_not_b64 vcc, s[52:53]
    s_mov_b64 exec, -1
    v_cndmask_b32_dpp v84, v84, v84, vcc wave_shr:1 row_mask:0xf bank_mask:0xf
    v_cndmask_b32_dpp v85, v85, v85, vcc wave_shr:1 row_mask:0xf bank_mask:0xf
    s_lshr_b64 s[52:53], s[52:53], 1
    v_cndmask_b32_dpp v86, v86, v86, vcc wave_shr:1 row_mask:0xf bank_mask:0xf
    v_cndmask_b32_dpp v87, v87, v87, vcc wave_shr:1 row_mask:0xf bank_mask:0xf
    s_andn2_b64 s[82:83], s[82:83], s[52:53]
    v_cndmask_b32_dpp v7, v7, v7, vcc wave_shr:1 row_mask:0xf bank_mask:0xf
    s_mov_b64 exec, s[50:51]
    s_cbranch_scc0 L2_d65
    s_mov_b64 exec, s[82:83]
    s_nop 1
    v_mfma_f32_4x4x4_16b_bf16 v[88:91], v[12:13], v[84:85], 0
    s_nop 1
    v_mfma_f32_4x4x4_16b_bf16 v[88:91], v[10:11], v[86:87], v[88:91]
    s_nop 4
    v_cvt_pk_bf16_f32 v88, v88, v89
    v_cvt_pk_bf16_f32 v89, v90, v91
    ds_pk_add_bf16 v7, v88 offset:65408
    ds_pk_add_bf16 v7, v89 offset:65412
    s_mov_b64 exec, s[50:51]
    s_branch L2_d65
L2_c66:
    s_lshl_b64 s[52:53], s[82:83], 1
    s_andn2_b64 s[52:53], s[52:53], s[80:81]
    s_andn2_b64 s[52:53], s[52:53], s[54:55]
    s_or_b64 s[80:81], s[80:81], s[52:53]
    s_not_b64 vcc, s[52:53]
    s_mov_b64 exec, -1
    v_cndmask_b32_dpp v84, v84, v84, vcc wave_shr:1 row_mask:0xf bank_mask:0xf
    v_cndmask_b32_dpp v85, v85, v85, vcc wave_shr:1 row_mask:0xf bank_mask:0xf
    s_lshr_b64 s[52:53], s[52:53], 1
    v_cndmask_b32_dpp v86, v86, v86, vcc wave_shr:1 row_mask:0xf bank_mask:0xf
    v_cndmask_b32_dpp v87, v87, v87, vcc wave_shr:1 row_mask:0xf bank_mask:0xf
    s_andn2_b64 s[82:83], s[82:83], s[52:53]
    v_cndmask_b32_dpp v7, v7, v7, vcc wave_shr:1 row_mask:0xf bank_mask:0xf
    s_mov_b64 exec, s[54:55]
    s_cbranch_scc0 L2_d66
    s_mov_b64 exec, s[82:83]
    s_nop 1
    v_mfma_f32_4x4x4_16b_bf16 v[88:91], v[12:13], v[84:85], 0
    s_nop 1
    v_mfma_f32_4x4x4_16b_bf16 v[88:91], v[10:11], v[86:87], v[88:91]
    s_nop 4
    v_cvt_pk_bf16_f32 v88, v88, v89
    v_cvt_pk_bf16_f32 v89, v90, v91
    ds_pk_add_bf16 v7, v88 offset:65408
    ds_pk_add_bf16 v7, v89 offset:65412
    s_mov_b64 exec, s[54:55]
    s_branch L2_d66
L2_c67:
    s_lshl_b64 s[52:53], s[82:83], 1
    s_andn2_b64 s[52:53], s[52:53], s[80:81]
    s_andn2_b64 s[52:53], s[52:53], s[50:51]
    s_or_b64 s[80:81], s[80:81], s[52:53]
    s_not_b64 vcc, s[52:53]
    s_mov_b64 exec, -1
    v_cndmask_b32_dpp v84, v84, v84, vcc wave_shr:1 row_mask:0xf bank_mask:0xf
    v_cndmask_b32_dpp v85, v85, v85, vcc wave_shr:1 row_mask:0xf bank_mask:0xf
    s_lshr_b64 s[52:53], s[52:53], 1
    v_cndmask_b32_dpp v86, v86, v86, vcc wave_shr:1 row_mask:0xf bank_mask:0xf
    v_cndmask_b32_dpp v87, v87, v87, vcc wave_shr:1 row_mask:0xf bank_mask:0xf
    s_andn2_b64 s[82:83], s[82:83], s[52:53]
    v_cndmask_b32_dpp v7, v7, v7, vcc wave_shr:1 row_mask:0xf bank_mask:0xf
    s_mov_b64 exec, s[50:51]
    s_cbranch_scc0 L2_d67
    s_mov_b64 exec, s[82:83]
    s_nop 1
    v_mfma_f32_4x4x4_16b_bf16 v[88:91], v[12:13], v[84:85], 0
    s_nop 1
    v_mfma_f32_4x4x4_16b_bf16 v[88:91], v[10:11], v[86:87], v[88:91]
    s_nop 4
    v_cvt_pk_bf16_f32 v88, v88, v89
    v_cvt_pk_bf16_f32 v89, v90, v91
    ds_pk_add_bf16 v7, v88 offset:65408
    ds_pk_add_bf16 v7, v89 offset:65412
    s_mov_b64 exec, s[50:51]
    s_branch L2_d67
L2_xo68:
    v_cmp_lt_u32 vcc, 20, v99
    s_mov_b32 s101, 1
    s_cbranch_vccz L2_xp68
    v_cmp_lt_u32 vcc, 32, v99
    v_cmp_lt_u32 s[58:59], 31, v88
    s_mov_b32 s101, 2
    s_or_b64 vcc, vcc, s[58:59]
    s_cbranch_scc0 L2_xp68
    s_mov_b32 s37, 0x10000
    s_branch L2_xp68
L2_c69:
    s_lshl_b64 s[52:53], s[82:83], 1
    s_andn2_b64 s[52:53], s[52:53], s[80:81]
    s_andn2_b64 s[52:53], s[52:53], s[54:55]
    s_or_b64 s[80:81], s[80:81], s[52:53]
    s_not_b64 vcc, s[52:53]
    s_mov_b64 exec, -1
    v_cndmask_b32_dpp v84, v84, v84, vcc wave_shr:1 row_mask:0xf bank_mask:0xf
    v_cndmask_b32_dpp v85, v85, v85, vcc wave_shr:1 row_mask:0xf bank_mask:0xf
    s_lshr_b64 s[52:53], s[52:53], 1
    v_cndmask_b32_dpp v86, v86, v86, vcc wave_shr:1 row_mask:0xf bank_mask:0xf
    v_cndmask_b32_dpp v87, v87, v87, vcc wave_shr:1 row_mask:0xf bank_mask:0xf
    s_andn2_b64 s[82:83], s[82:83], s[52:53]
    v_cndmask_b32_dpp v7, v7, v7, vcc wave_shr:1 row_mask:0xf bank_mask:0xf
    s_mov_b64 exec, s[54:55]
    s_cbranch_scc0 L2_d69
    s_mov_b64 exec, s[82:83]
    s_nop 1
    v_mfma_f32_4x4x4_16b_bf16 v[88:91], v[12:13], v[84:85], 0
    s_nop 1
    v_mfma_f32_4x4x4_16b_bf16 v[88:91], v[10:11], v[86:87], v[88:91]
    s_nop 4
    v_cvt_pk_bf16_f32 v88, v88, v89
    v_cvt_pk_bf16_f32 v89, v90, v91
    ds_pk_add_bf16 v7, v88 offset:65408
    ds_pk_add_bf16 v7, v89 offset:65412
    s_mov_b64 exec, s[54:55]
    s_branch L2_d69
L2_c70:
    s_lshl_b64 s[52:53], s[82:83], 1
    s_andn2_b64 s[52:53], s[52:53], s[80:81]
    s_andn2_b64 s[52:53], s[52:53], s[50:51]
    s_or_b64 s[80:81], s[80:81], s[52:53]
    s_not_b64 vcc, s[52:53]
    s_mov_b64 exec, -1
    v_cndmask_b32_dpp v84, v84, v84, vcc wave_shr:1 row_mask:0xf bank_mask:0xf
    v_cndmask_b32_dpp v85, v85, v85, vcc wave_shr:1 row_mask:0xf bank_mask:0xf
    s_lshr_b64 s[52:53], s[52:53], 1
    v_cndmask_b32_dpp v86, v86, v86, vcc wave_shr:1 row_mask:0xf bank_mask:0xf
    v_cndmask_b32_dpp v87, v87, v87, vcc wave_shr:1 row_mask:0xf bank_mask:0xf
    s_andn2_b64 s[82:83], s[82:83], s[52:53]
    v_cndmask_b32_dpp v7, v7, v7, vcc wave_shr:1 row_mask:0xf bank_mask:0xf
    s_mov_b64 exec, s[50:51]
    s_cbranch_scc0 L2_d70
    s_mov_b64 exec, s[82:83]
    s_nop 1
    v_mfma_f32_4x4x4_16b_bf16 v[88:91], v[12:13], v[84:85], 0
    s_nop 1
    v_mfma_f32_4x4x4_16b_bf16 v[88:91], v[10:11], v[86:87], v[88:91]
    s_nop 4
    v_cvt_pk_bf16_f32 v88, v88, v89
    v_cvt_pk_bf16_f32 v89, v90, v91
    ds_pk_add_bf16 v7, v88 offset:65408
    ds_pk_add_bf16 v7, v89 offset:65412
    s_mov_b64 exec, s[50:51]
    s_branch L2_d70
L2_c71:
    s_lshl_b64 s[52:53], s[82:83], 1
    s_andn2_b64 s[52:53], s[52:53], s[80:81]
    s_andn2_b64 s[52:53], s[52:53], s[54:55]
    s_or_b64 s[80:81], s[80:81], s[52:53]
    s_not_b64 vcc, s[52:53]
    s_mov_b64 exec, -1
    v_cndmask_b32_dpp v84, v84, v84, vcc wave_shr:1 row_mask:0xf bank_mask:0xf
    v_cndmask_b32_dpp v85, v85, v85, vcc wave_shr:1 row_mask:0xf bank_mask:0xf
    s_lshr_b64 s[52:53], s[52:53], 1
    v_cndmask_b32_dpp v86, v86, v86, vcc wave_shr:1 row_mask:0xf bank_mask:0xf
    v_cndmask_b32_dpp v87, v87, v87, vcc wave_shr:1 row_mask:0xf bank_mask:0xf
    s_andn2_b64 s[82:83], s[82:83], s[52:53]
    v_cndmask_b32_dpp v7, v7, v7, vcc wave_shr:1 row_mask:0xf bank_mask:0xf
    s_mov_b64 exec, s[54:55]
    s_cbranch_scc0 L2_d71
    s_mov_b64 exec, s[82:83]
    s_nop 1
    v_mfma_f32_4x4x4_16b_bf16 v[88:91], v[12:13], v[84:85], 0
    s_nop 1
    v_mfma_f32_4x4x4_16b_bf16 v[88:91], v[10:11], v[86:87], v[88:91]
    s_nop 4
    v_cvt_pk_bf16_f32 v88, v88, v89
    v_cvt_pk_bf16_f32 v89, v90, v91
    ds_pk_add_bf16 v7, v88 offset:65408
    ds_pk_add_bf16 v7, v89 offset:65412
    s_mov_b64 exec, s[54:55]
    s_branch L2_d71
L2_c72:
    s_lshl_b64 s[52:53], s[82:83], 1
    s_andn2_b64 s[52:53], s[52:53], s[80:81]
    s_andn2_b64 s[52:53], s[52:53], s[50:51]
    s_or_b64 s[80:81], s[80:81], s[52:53]
    s_not_b64 vcc, s[52:53]
    s_mov_b64 exec, -1
    v_cndmask_b32_dpp v84, v84, v84, vcc wave_shr:1 row_mask:0xf bank_mask:0xf
    v_cndmask_b32_dpp v85, v85, v85, vcc wave_shr:1 row_mask:0xf bank_mask:0xf
    s_lshr_b64 s[52:53], s[52:53], 1
    v_cndmask_b32_dpp v86, v86, v86, vcc wave_shr:1 row_mask:0xf bank_mask:0xf
    v_cndmask_b32_dpp v87, v87, v87, vcc wave_shr:1 row_mask:0xf bank_mask:0xf
    s_andn2_b64 s[82:83], s[82:83], s[52:53]
    v_cndmask_b32_dpp v7, v7, v7, vcc wave_shr:1 row_mask:0xf bank_mask:0xf
    s_mov_b64 exec, s[50:51]
    s_cbranch_scc0 L2_d72
    s_mov_b64 exec, s[82:83]
    s_nop 1
    v_mfma_f32_4x4x4_16b_bf16 v[88:91], v[12:13], v[84:85], 0
    s_nop 1
    v_mfma_f32_4x4x4_16b_bf16 v[88:91], v[10:11], v[86:87], v[88:91]
    s_nop 4
    v_cvt_pk_bf16_f32 v88, v88, v89
    v_cvt_pk_bf16_f32 v89, v90, v91
    ds_pk_add_bf16 v7, v88 offset:65408
    ds_pk_add_bf16 v7, v89 offset:65412
    s_mov_b64 exec, s[50:51]
    s_branch L2_d72
L2_c73:
    s_lshl_b64 s[52:53], s[82:83], 1
    s_andn2_b64 s[52:53], s[52:53], s[80:81]
    s_andn2_b64 s[52:53], s[52:53], s[54:55]
    s_or_b64 s[80:81], s[80:81], s[52:53]
    s_not_b64 vcc, s[52:53]
    s_mov_b64 exec, -1
    v_cndmask_b32_dpp v84, v84, v84, vcc wave_shr:1 row_mask:0xf bank_mask:0xf
    v_cndmask_b32_dpp v85, v85, v85, vcc wave_shr:1 row_mask:0xf bank_mask:0xf
    s_lshr_b64 s[52:53], s[52:53], 1
    v_cndmask_b32_dpp v86, v86, v86, vcc wave_shr:1 row_mask:0xf bank_mask:0xf
    v_cndmask_b32_dpp v87, v87, v87, vcc wave_shr:1 row_mask:0xf bank_mask:0xf
    s_andn2_b64 s[82:83], s[82:83], s[52:53]
    v_cndmask_b32_dpp v7, v7, v7, vcc wave_shr:1 row_mask:0xf bank_mask:0xf
    s_mov_b64 exec, s[54:55]
    s_cbranch_scc0 L2_d73
    s_mov_b64 exec, s[82:83]
    s_nop 1
    v_mfma_f32_4x4x4_16b_bf16 v[88:91], v[12:13], v[84:85], 0
    s_nop 1
    v_mfma_f32_4x4x4_16b_bf16 v[88:91], v[10:11], v[86:87], v[88:91]
    s_nop 4
    v_cvt_pk_bf16_f32 v88, v88, v89
    v_cvt_pk_bf16_f32 v89, v90, v91
    ds_pk_add_bf16 v7, v88 offset:65408
    ds_pk_add_bf16 v7, v89 offset:65412
    s_mov_b64 exec, s[54:55]
    s_branch L2_d73
L2_c74:
    s_lshl_b64 s[52:53], s[82:83], 1
    s_andn2_b64 s[52:53], s[52:53], s[80:81]
    s_andn2_b64 s[52:53], s[52:53], s[50:51]
    s_or_b64 s[80:81], s[80:81], s[52:53]
    s_not_b64 vcc, s[52:53]
    s_mov_b64 exec, -1
    v_cndmask_b32_dpp v84, v84, v84, vcc wave_shr:1 row_mask:0xf bank_mask:0xf
    v_cndmask_b32_dpp v85, v85, v85, vcc wave_shr:1 row_mask:0xf bank_mask:0xf
    s_lshr_b64 s[52:53], s[52:53], 1
    v_cndmask_b32_dpp v86, v86, v86, vcc wave_shr:1 row_mask:0xf bank_mask:0xf
    v_cndmask_b32_dpp v87, v87, v87, vcc wave_shr:1 row_mask:0xf bank_mask:0xf
    s_andn2_b64 s[82:83], s[82:83], s[52:53]
    v_cndmask_b32_dpp v7, v7, v7, vcc wave_shr:1 row_mask:0xf bank_mask:0xf
    s_mov_b64 exec, s[50:51]
    s_cbranch_scc0 L2_d74
    s_mov_b64 exec, s[82:83]
    s_nop 1
    v_mfma_f32_4x4x4_16b_bf16 v[88:91], v[12:13], v[84:85], 0
    s_nop 1
    v_mfma_f32_4x4x4_16b_bf16 v[88:91], v[10:11], v[86:87], v[88:91]
    s_nop 4
    v_cvt_pk_bf16_f32 v88, v88, v89
    v_cvt_pk_bf16_f32 v89, v90, v91
    ds_pk_add_bf16 v7, v88 offset:65408
    ds_pk_add_bf16 v7, v89 offset:65412
    s_mov_b64 exec, s[50:51]
    s_branch L2_d74
L2_c75:
    s_lshl_b64 s[52:53], s[82:83], 1
    s_andn2_b64 s[52:53], s[52:53], s[80:81]
    s_andn2_b64 s[52:53], s[52:53], s[54:55]
    s_or_b64 s[80:81], s[80:81], s[52:53]
    s_not_b64 vcc, s[52:53]
    s_mov_b64 exec, -1
    v_cndmask_b32_dpp v84, v84, v84, vcc wave_shr:1 row_mask:0xf bank_mask:0xf
    v_cndmask_b32_dpp v85, v85, v85, vcc wave_shr:1 row_mask:0xf bank_mask:0xf
    s_lshr_b64 s[52:53], s[52:53], 1
    v_cndmask_b32_dpp v86, v86, v86, vcc wave_shr:1 row_mask:0xf bank_mask:0xf
    v_cndmask_b32_dpp v87, v87, v87, vcc wave_shr:1 row_mask:0xf bank_mask:0xf
    s_andn2_b64 s[82:83], s[82:83], s[52:53]
    v_cndmask_b32_dpp v7, v7, v7, vcc wave_shr:1 row_mask:0xf bank_mask:0xf
    s_mov_b64 exec, s[54:55]
    s_cbranch_scc0 L2_d75
    s_mov_b64 exec, s[82:83]
    s_nop 1
    v_mfma_f32_4x4x4_16b_bf16 v[88:91], v[12:13], v[84:85], 0
    s_nop 1
    v_mfma_f32_4x4x4_16b_bf16 v[88:91], v[10:11], v[86:87], v[88:91]
    s_nop 4
    v_cvt_pk_bf16_f32 v88, v88, v89
    v_cvt_pk_bf16_f32 v89, v90, v91
    ds_pk_add_bf16 v7, v88 offset:65408
    ds_pk_add_bf16 v7, v89 offset:65412
    s_mov_b64 exec, s[54:55]
    s_branch L2_d75
L2_c76:
    s_lshl_b64 s[52:53], s[82:83], 1
    s_andn2_b64 s[52:53], s[52:53], s[80:81]
    s_andn2_b64 s[52:53], s[52:53], s[50:51]
    s_or_b64 s[80:81], s[80:81], s[52:53]
    s_not_b64 vcc, s[52:53]
    s_mov_b64 exec, -1
    v_cndmask_b32_dpp v84, v84, v84, vcc wave_shr:1 row_mask:0xf bank_mask:0xf
    v_cndmask_b32_dpp v85, v85, v85, vcc wave_shr:1 row_mask:0xf bank_mask:0xf
    s_lshr_b64 s[52:53], s[52:53], 1
    v_cndmask_b32_dpp v86, v86, v86, vcc wave_shr:1 row_mask:0xf bank_mask:0xf
    v_cndmask_b32_dpp v87, v87, v87, vcc wave_shr:1 row_mask:0xf bank_mask:0xf
    s_andn2_b64 s[82:83], s[82:83], s[52:53]
    v_cndmask_b32_dpp v7, v7, v7, vcc wave_shr:1 row_mask:0xf bank_mask:0xf
    s_mov_b64 exec, s[50:51]
    s_cbranch_scc0 L2_d76
    s_mov_b64 exec, s[82:83]
    s_nop 1
    v_mfma_f32_4x4x4_16b_bf16 v[88:91], v[12:13], v[84:85], 0
    s_nop 1
    v_mfma_f32_4x4x4_16b_bf16 v[88:91], v[10:11], v[86:87], v[88:91]
    s_nop 4
    v_cvt_pk_bf16_f32 v88, v88, v89
    v_cvt_pk_bf16_f32 v89, v90, v91
    ds_pk_add_bf16 v7, v88 offset:65408
    ds_pk_add_bf16 v7, v89 offset:65412
    s_mov_b64 exec, s[50:51]
    s_branch L2_d76
L2_c77:
    s_lshl_b64 s[52:53], s[82:83], 1
    s_andn2_b64 s[52:53], s[52:53], s[80:81]
    s_andn2_b64 s[52:53], s[52:53], s[54:55]
    s_or_b64 s[80:81], s[80:81], s[52:53]
    s_not_b64 vcc, s[52:53]
    s_mov_b64 exec, -1
    v_cndmask_b32_dpp v84, v84, v84, vcc wave_shr:1 row_mask:0xf bank_mask:0xf
    v_cndmask_b32_dpp v85, v85, v85, vcc wave_shr:1 row_mask:0xf bank_mask:0xf
    s_lshr_b64 s[52:53], s[52:53], 1
    v_cndmask_b32_dpp v86, v86, v86, vcc wave_shr:1 row_mask:0xf bank_mask:0xf
    v_cndmask_b32_dpp v87, v87, v87, vcc wave_shr:1 row_mask:0xf bank_mask:0xf
    s_andn2_b64 s[82:83], s[82:83], s[52:53]
    v_cndmask_b32_dpp v7, v7, v7, vcc wave_shr:1 row_mask:0xf bank_mask:0xf
    s_mov_b64 exec, s[54:55]
    s_cbranch_scc0 L2_d77
    s_mov_b64 exec, s[82:83]
    s_nop 1
    v_mfma_f32_4x4x4_16b_bf16 v[88:91], v[12:13], v[84:85], 0
    s_nop 1
    v_mfma_f32_4x4x4_16b_bf16 v[88:91], v[10:11], v[86:87], v[88:91]
    s_nop 4
    v_cvt_pk_bf16_f32 v88, v88, v89
    v_cvt_pk_bf16_f32 v89, v90, v91
    ds_pk_add_bf16 v7, v88 offset:65408
    ds_pk_add_bf16 v7, v89 offset:65412
    s_mov_b64 exec, s[54:55]
    s_branch L2_d77
L2_c78:
    s_lshl_b64 s[52:53], s[82:83], 1
    s_andn2_b64 s[52:53], s[52:53], s[80:81]
    s_andn2_b64 s[52:53], s[52:53], s[50:51]
    s_or_b64 s[80:81], s[80:81], s[52:53]
    s_not_b64 vcc, s[52:53]
    s_mov_b64 exec, -1
    v_cndmask_b32_dpp v84, v84, v84, vcc wave_shr:1 row_mask:0xf bank_mask:0xf
    v_cndmask_b32_dpp v85, v85, v85, vcc wave_shr:1 row_mask:0xf bank_mask:0xf
    s_lshr_b64 s[52:53], s[52:53], 1
    v_cndmask_b32_dpp v86, v86, v86, vcc wave_shr:1 row_mask:0xf bank_mask:0xf
    v_cndmask_b32_dpp v87, v87, v87, vcc wave_shr:1 row_mask:0xf bank_mask:0xf
    s_andn2_b64 s[82:83], s[82:83], s[52:53]
    v_cndmask_b32_dpp v7, v7, v7, vcc wave_shr:1 row_mask:0xf bank_mask:0xf
    s_mov_b64 exec, s[50:51]
    s_cbranch_scc0 L2_d78
    s_mov_b64 exec, s[82:83]
    s_nop 1
    v_mfma_f32_4x4x4_16b_bf16 v[88:91], v[12:13], v[84:85], 0
    s_nop 1
    v_mfma_f32_4x4x4_16b_bf16 v[88:91], v[10:11], v[86:87], v[88:91]
    s_nop 4
    v_cvt_pk_bf16_f32 v88, v88, v89
    v_cvt_pk_bf16_f32 v89, v90, v91
    ds_pk_add_bf16 v7, v88 offset:65408
    ds_pk_add_bf16 v7, v89 offset:65412
    s_mov_b64 exec, s[50:51]
    s_branch L2_d78
L2_xa79:
    s_cmp_eq_u32 s101, 1
    s_cbranch_scc1 L2_xc79
    v_lshlrev_b32 v89, 0, v96
    v_add_u32 v90, 140, v97
    v_bitop3_b32 v90, v89, v45, v90 bitop3:0x6a
    ds_write_b32 v98, v90 offset:28
    v_lshlrev_b32 v89, 4, v96
    v_add_u32 v90, 120, v97
    v_bitop3_b32 v90, v89, v45, v90 bitop3:0x6a
    ds_write_b32 v98, v90 offset:24
    v_lshlrev_b32 v89, 8, v96
    v_add_u32 v90, 100, v97
    v_bitop3_b32 v90, v89, v45, v90 bitop3:0x6a
    ds_write_b32 v98, v90 offset:20
L2_xc79:
    v_lshlrev_b32 v89, 12, v96
    v_add_u32 v90, 80, v97
    v_bitop3_b32 v90, v89, v45, v90 bitop3:0x6a
    ds_write_b32 v98, v90 offset:16
    s_branch L2_xb79
L2_xe79:
    v_cmp_lt_u32 vcc, 32, v99
    v_cmp_lt_u32 s[58:59], 31, v88
    v_lshrrev_b32 v89, 16, v96
    v_add_u32 v97, 80, v97
    s_or_b64 vcc, vcc, s[58:59]
    s_cbranch_scc1 L2_xs79
    v_lshlrev_b32 v89, v1, v89
    v_and_b32 v89, v45, v89
    v_cmp_ne_u32 vcc, 0, v89
    v_xor_b32 v90, v97, v89
    s_add_u32 s3, s37, s38
    v_mbcnt_lo_u32_b32 v98, vcc_lo, 0
    v_mbcnt_hi_u32_b32 v98, vcc_hi, v98
    s_bcnt1_i32_b64 s41, vcc
    v_lshl_add_u32 v98, v98, 2, s3
    s_mov_b64 exec, vcc
    ds_write_b32 v98, v90
    s_mov_b64 exec, -1
    s_lshl2_add_u32 s37, s41, s37
    s_branch L2_xr79
L2_xf79:
    s_waitcnt lgkmcnt(0)
    s_cmp_gt_u32 s37, 1024
    s_cbranch_scc1 L2_xs79
    v_mov_b32 v43, -1
    s_cmp_ge_u32 s37, 512
    s_cbranch_scc1 L2_xg79
    v_mov_b32 v42, -1
    s_cmp_ge_u32 s37, 256
    s_cbranch_scc1 L2_xg79
    v_mov_b32 v41, -1
    s_branch L2_xg79
L2_xs79:
    s_waitcnt lgkmcnt(0)
    v_mov_b32 v40, -1
    v_mov_b32 v41, -1
    v_mov_b32 v42, -1
    v_mov_b32 v43, -1
    s_add_u32 s3, s42, 2
    s_bitset1_b32 s36, s3
    s_branch L2_xg79
L2_c80:
    s_lshl_b64 s[52:53], s[82:83], 1
    s_andn2_b64 s[52:53], s[52:53], s[80:81]
    s_andn2_b64 s[52:53], s[52:53], s[54:55]
    s_or_b64 s[80:81], s[80:81], s[52:53]
    s_not_b64 vcc, s[52:53]
    s_mov_b64 exec, -1
    v_cndmask_b32_dpp v84, v84, v84, vcc wave_shr:1 row_mask:0xf bank_mask:0xf
    v_cndmask_b32_dpp v85, v85, v85, vcc wave_shr:1 row_mask:0xf bank_mask:0xf
    s_lshr_b64 s[52:53], s[52:53], 1
    v_cndmask_b32_dpp v86, v86, v86, vcc wave_shr:1 row_mask:0xf bank_mask:0xf
    v_cndmask_b32_dpp v87, v87, v87, vcc wave_shr:1 row_mask:0xf bank_mask:0xf
    s_andn2_b64 s[82:83], s[82:83], s[52:53]
    v_cndmask_b32_dpp v7, v7, v7, vcc wave_shr:1 row_mask:0xf bank_mask:0xf
    s_mov_b64 exec, s[54:55]
    s_cbranch_scc0 L2_d80
    s_mov_b64 exec, s[82:83]
    s_nop 1
    v_mfma_f32_4x4x4_16b_bf16 v[88:91], v[12:13], v[84:85], 0
    s_nop 1
    v_mfma_f32_4x4x4_16b_bf16 v[88:91], v[10:11], v[86:87], v[88:91]
    s_nop 4
    v_cvt_pk_bf16_f32 v88, v88, v89
    v_cvt_pk_bf16_f32 v89, v90, v91
    ds_pk_add_bf16 v7, v88 offset:65408
    ds_pk_add_bf16 v7, v89 offset:65412
    s_mov_b64 exec, s[54:55]
    s_branch L2_d80
L2_c81:
    s_lshl_b64 s[52:53], s[82:83], 1
    s_andn2_b64 s[52:53], s[52:53], s[80:81]
    s_andn2_b64 s[52:53], s[52:53], s[50:51]
    s_or_b64 s[80:81], s[80:81], s[52:53]
    s_not_b64 vcc, s[52:53]
    s_mov_b64 exec, -1
    v_cndmask_b32_dpp v84, v84, v84, vcc wave_shr:1 row_mask:0xf bank_mask:0xf
    v_cndmask_b32_dpp v85, v85, v85, vcc wave_shr:1 row_mask:0xf bank_mask:0xf
    s_lshr_b64 s[52:53], s[52:53], 1
    v_cndmask_b32_dpp v86, v86, v86, vcc wave_shr:1 row_mask:0xf bank_mask:0xf
    v_cndmask_b32_dpp v87, v87, v87, vcc wave_shr:1 row_mask:0xf bank_mask:0xf
    s_andn2_b64 s[82:83], s[82:83], s[52:53]
    v_cndmask_b32_dpp v7, v7, v7, vcc wave_shr:1 row_mask:0xf bank_mask:0xf
    s_mov_b64 exec, s[50:51]
    s_cbranch_scc0 L2_d81
    s_mov_b64 exec, s[82:83]
    s_nop 1
    v_mfma_f32_4x4x4_16b_bf16 v[88:91], v[12:13], v[84:85], 0
    s_nop 1
    v_mfma_f32_4x4x4_16b_bf16 v[88:91], v[10:11], v[86:87], v[88:91]
    s_nop 4
    v_cvt_pk_bf16_f32 v88, v88, v89
    v_cvt_pk_bf16_f32 v89, v90, v91
    ds_pk_add_bf16 v7, v88 offset:65408
    ds_pk_add_bf16 v7, v89 offset:65412
    s_mov_b64 exec, s[50:51]
    s_branch L2_d81
L2_c82:
    s_lshl_b64 s[52:53], s[82:83], 1
    s_andn2_b64 s[52:53], s[52:53], s[80:81]
    s_andn2_b64 s[52:53], s[52:53], s[54:55]
    s_or_b64 s[80:81], s[80:81], s[52:53]
    s_not_b64 vcc, s[52:53]
    s_mov_b64 exec, -1
    v_cndmask_b32_dpp v84, v84, v84, vcc wave_shr:1 row_mask:0xf bank_mask:0xf
    v_cndmask_b32_dpp v85, v85, v85, vcc wave_shr:1 row_mask:0xf bank_mask:0xf
    s_lshr_b64 s[52:53], s[52:53], 1
    v_cndmask_b32_dpp v86, v86, v86, vcc wave_shr:1 row_mask:0xf bank_mask:0xf
    v_cndmask_b32_dpp v87, v87, v87, vcc wave_shr:1 row_mask:0xf bank_mask:0xf
    s_andn2_b64 s[82:83], s[82:83], s[52:53]
    v_cndmask_b32_dpp v7, v7, v7, vcc wave_shr:1 row_mask:0xf bank_mask:0xf
    s_mov_b64 exec, s[54:55]
    s_cbranch_scc0 L2_d82
    s_mov_b64 exec, s[82:83]
    s_nop 1
    v_mfma_f32_4x4x4_16b_bf16 v[88:91], v[12:13], v[84:85], 0
    s_nop 1
    v_mfma_f32_4x4x4_16b_bf16 v[88:91], v[10:11], v[86:87], v[88:91]
    s_nop 4
    v_cvt_pk_bf16_f32 v88, v88, v89
    v_cvt_pk_bf16_f32 v89, v90, v91
    ds_pk_add_bf16 v7, v88 offset:65408
    ds_pk_add_bf16 v7, v89 offset:65412
    s_mov_b64 exec, s[54:55]
    s_branch L2_d82
L2_c83:
    s_lshl_b64 s[52:53], s[82:83], 1
    s_andn2_b64 s[52:53], s[52:53], s[80:81]
    s_andn2_b64 s[52:53], s[52:53], s[50:51]
    s_or_b64 s[80:81], s[80:81], s[52:53]
    s_not_b64 vcc, s[52:53]
    s_mov_b64 exec, -1
    v_cndmask_b32_dpp v84, v84, v84, vcc wave_shr:1 row_mask:0xf bank_mask:0xf
    v_cndmask_b32_dpp v85, v85, v85, vcc wave_shr:1 row_mask:0xf bank_mask:0xf
    s_lshr_b64 s[52:53], s[52:53], 1
    v_cndmask_b32_dpp v86, v86, v86, vcc wave_shr:1 row_mask:0xf bank_mask:0xf
    v_cndmask_b32_dpp v87, v87, v87, vcc wave_shr:1 row_mask:0xf bank_mask:0xf
    s_andn2_b64 s[82:83], s[82:83], s[52:53]
    v_cndmask_b32_dpp v7, v7, v7, vcc wave_shr:1 row_mask:0xf bank_mask:0xf
    s_mov_b64 exec, s[50:51]
    s_cbranch_scc0 L2_d83
    s_mov_b64 exec, s[82:83]
    s_nop 1
    v_mfma_f32_4x4x4_16b_bf16 v[88:91], v[12:13], v[84:85], 0
    s_nop 1
    v_mfma_f32_4x4x4_16b_bf16 v[88:91], v[10:11], v[86:87], v[88:91]
    s_nop 4
    v_cvt_pk_bf16_f32 v88, v88, v89
    v_cvt_pk_bf16_f32 v89, v90, v91
    ds_pk_add_bf16 v7, v88 offset:65408
    ds_pk_add_bf16 v7, v89 offset:65412
    s_mov_b64 exec, s[50:51]
    s_branch L2_d83
L2_c84:
    s_lshl_b64 s[52:53], s[82:83], 1
    s_andn2_b64 s[52:53], s[52:53], s[80:81]
    s_andn2_b64 s[52:53], s[52:53], s[54:55]
    s_or_b64 s[80:81], s[80:81], s[52:53]
    s_not_b64 vcc, s[52:53]
    s_mov_b64 exec, -1
    v_cndmask_b32_dpp v84, v84, v84, vcc wave_shr:1 row_mask:0xf bank_mask:0xf
    v_cndmask_b32_dpp v85, v85, v85, vcc wave_shr:1 row_mask:0xf bank_mask:0xf
    s_lshr_b64 s[52:53], s[52:53], 1
    v_cndmask_b32_dpp v86, v86, v86, vcc wave_shr:1 row_mask:0xf bank_mask:0xf
    v_cndmask_b32_dpp v87, v87, v87, vcc wave_shr:1 row_mask:0xf bank_mask:0xf
    s_andn2_b64 s[82:83], s[82:83], s[52:53]
    v_cndmask_b32_dpp v7, v7, v7, vcc wave_shr:1 row_mask:0xf bank_mask:0xf
    s_mov_b64 exec, s[54:55]
    s_cbranch_scc0 L2_d84
    s_mov_b64 exec, s[82:83]
    s_nop 1
    v_mfma_f32_4x4x4_16b_bf16 v[88:91], v[12:13], v[84:85], 0
    s_nop 1
    v_mfma_f32_4x4x4_16b_bf16 v[88:91], v[10:11], v[86:87], v[88:91]
    s_nop 4
    v_cvt_pk_bf16_f32 v88, v88, v89
    v_cvt_pk_bf16_f32 v89, v90, v91
    ds_pk_add_bf16 v7, v88 offset:65408
    ds_pk_add_bf16 v7, v89 offset:65412
    s_mov_b64 exec, s[54:55]
    s_branch L2_d84
L2_c85:
    s_lshl_b64 s[52:53], s[82:83], 1
    s_andn2_b64 s[52:53], s[52:53], s[80:81]
    s_andn2_b64 s[52:53], s[52:53], s[50:51]
    s_or_b64 s[80:81], s[80:81], s[52:53]
    s_not_b64 vcc, s[52:53]
    s_mov_b64 exec, -1
    v_cndmask_b32_dpp v84, v84, v84, vcc wave_shr:1 row_mask:0xf bank_mask:0xf
    v_cndmask_b32_dpp v85, v85, v85, vcc wave_shr:1 row_mask:0xf bank_mask:0xf
    s_lshr_b64 s[52:53], s[52:53], 1
    v_cndmask_b32_dpp v86, v86, v86, vcc wave_shr:1 row_mask:0xf bank_mask:0xf
    v_cndmask_b32_dpp v87, v87, v87, vcc wave_shr:1 row_mask:0xf bank_mask:0xf
    s_andn2_b64 s[82:83], s[82:83], s[52:53]
    v_cndmask_b32_dpp v7, v7, v7, vcc wave_shr:1 row_mask:0xf bank_mask:0xf
    s_mov_b64 exec, s[50:51]
    s_cbranch_scc0 L2_d85
    s_mov_b64 exec, s[82:83]
    s_nop 1
    v_mfma_f32_4x4x4_16b_bf16 v[88:91], v[12:13], v[84:85], 0
    s_nop 1
    v_mfma_f32_4x4x4_16b_bf16 v[88:91], v[10:11], v[86:87], v[88:91]
    s_nop 4
    v_cvt_pk_bf16_f32 v88, v88, v89
    v_cvt_pk_bf16_f32 v89, v90, v91
    ds_pk_add_bf16 v7, v88 offset:65408
    ds_pk_add_bf16 v7, v89 offset:65412
    s_mov_b64 exec, s[50:51]
    s_branch L2_d85
L2_xo86:
    v_cmp_lt_u32 vcc, 20, v99
    s_mov_b32 s101, 1
    s_cbranch_vccz L2_xp86
    v_cmp_lt_u32 vcc, 32, v99
    v_cmp_lt_u32 s[58:59], 31, v88
    s_mov_b32 s101, 2
    s_or_b64 vcc, vcc, s[58:59]
    s_cbranch_scc0 L2_xp86
    s_mov_b32 s37, 0x10000
    s_branch L2_xp86
L2_c87:
    s_lshl_b64 s[52:53], s[82:83], 1
    s_andn2_b64 s[52:53], s[52:53], s[80:81]
    s_andn2_b64 s[52:53], s[52:53], s[54:55]
    s_or_b64 s[80:81], s[80:81], s[52:53]
    s_not_b64 vcc, s[52:53]
    s_mov_b64 exec, -1
    v_cndmask_b32_dpp v84, v84, v84, vcc wave_shr:1 row_mask:0xf bank_mask:0xf
    v_cndmask_b32_dpp v85, v85, v85, vcc wave_shr:1 row_mask:0xf bank_mask:0xf
    s_lshr_b64 s[52:53], s[52:53], 1
    v_cndmask_b32_dpp v86, v86, v86, vcc wave_shr:1 row_mask:0xf bank_mask:0xf
    v_cndmask_b32_dpp v87, v87, v87, vcc wave_shr:1 row_mask:0xf bank_mask:0xf
    s_andn2_b64 s[82:83], s[82:83], s[52:53]
    v_cndmask_b32_dpp v7, v7, v7, vcc wave_shr:1 row_mask:0xf bank_mask:0xf
    s_mov_b64 exec, s[54:55]
    s_cbranch_scc0 L2_d87
    s_mov_b64 exec, s[82:83]
    s_nop 1
    v_mfma_f32_4x4x4_16b_bf16 v[88:91], v[12:13], v[84:85], 0
    s_nop 1
    v_mfma_f32_4x4x4_16b_bf16 v[88:91], v[10:11], v[86:87], v[88:91]
    s_nop 4
    v_cvt_pk_bf16_f32 v88, v88, v89
    v_cvt_pk_bf16_f32 v89, v90, v91
    ds_pk_add_bf16 v7, v88 offset:65408
    ds_pk_add_bf16 v7, v89 offset:65412
    s_mov_b64 exec, s[54:55]
    s_branch L2_d87
L2_c88:
    s_lshl_b64 s[52:53], s[82:83], 1
    s_andn2_b64 s[52:53], s[52:53], s[80:81]
    s_andn2_b64 s[52:53], s[52:53], s[50:51]
    s_or_b64 s[80:81], s[80:81], s[52:53]
    s_not_b64 vcc, s[52:53]
    s_mov_b64 exec, -1
    v_cndmask_b32_dpp v84, v84, v84, vcc wave_shr:1 row_mask:0xf bank_mask:0xf
    v_cndmask_b32_dpp v85, v85, v85, vcc wave_shr:1 row_mask:0xf bank_mask:0xf
    s_lshr_b64 s[52:53], s[52:53], 1
    v_cndmask_b32_dpp v86, v86, v86, vcc wave_shr:1 row_mask:0xf bank_mask:0xf
    v_cndmask_b32_dpp v87, v87, v87, vcc wave_shr:1 row_mask:0xf bank_mask:0xf
    s_andn2_b64 s[82:83], s[82:83], s[52:53]
    v_cndmask_b32_dpp v7, v7, v7, vcc wave_shr:1 row_mask:0xf bank_mask:0xf
    s_mov_b64 exec, s[50:51]
    s_cbranch_scc0 L2_d88
    s_mov_b64 exec, s[82:83]
    s_nop 1
    v_mfma_f32_4x4x4_16b_bf16 v[88:91], v[12:13], v[84:85], 0
    s_nop 1
    v_mfma_f32_4x4x4_16b_bf16 v[88:91], v[10:11], v[86:87], v[88:91]
    s_nop 4
    v_cvt_pk_bf16_f32 v88, v88, v89
    v_cvt_pk_bf16_f32 v89, v90, v91
    ds_pk_add_bf16 v7, v88 offset:65408
    ds_pk_add_bf16 v7, v89 offset:65412
    s_mov_b64 exec, s[50:51]
    s_branch L2_d88
L2_c89:
    s_lshl_b64 s[52:53], s[82:83], 1
    s_andn2_b64 s[52:53], s[52:53], s[80:81]
    s_andn2_b64 s[52:53], s[52:53], s[54:55]
    s_or_b64 s[80:81], s[80:81], s[52:53]
    s_not_b64 vcc, s[52:53]
    s_mov_b64 exec, -1
    v_cndmask_b32_dpp v84, v84, v84, vcc wave_shr:1 row_mask:0xf bank_mask:0xf
    v_cndmask_b32_dpp v85, v85, v85, vcc wave_shr:1 row_mask:0xf bank_mask:0xf
    s_lshr_b64 s[52:53], s[52:53], 1
    v_cndmask_b32_dpp v86, v86, v86, vcc wave_shr:1 row_mask:0xf bank_mask:0xf
    v_cndmask_b32_dpp v87, v87, v87, vcc wave_shr:1 row_mask:0xf bank_mask:0xf
    s_andn2_b64 s[82:83], s[82:83], s[52:53]
    v_cndmask_b32_dpp v7, v7, v7, vcc wave_shr:1 row_mask:0xf bank_mask:0xf
    s_mov_b64 exec, s[54:55]
    s_cbranch_scc0 L2_d89
    s_mov_b64 exec, s[82:83]
    s_nop 1
    v_mfma_f32_4x4x4_16b_bf16 v[88:91], v[12:13], v[84:85], 0
    s_nop 1
    v_mfma_f32_4x4x4_16b_bf16 v[88:91], v[10:11], v[86:87], v[88:91]
    s_nop 4
    v_cvt_pk_bf16_f32 v88, v88, v89
    v_cvt_pk_bf16_f32 v89, v90, v91
    ds_pk_add_bf16 v7, v88 offset:65408
    ds_pk_add_bf16 v7, v89 offset:65412
    s_mov_b64 exec, s[54:55]
    s_branch L2_d89
L2_c90:
    s_lshl_b64 s[52:53], s[82:83], 1
    s_andn2_b64 s[52:53], s[52:53], s[80:81]
    s_andn2_b64 s[52:53], s[52:53], s[50:51]
    s_or_b64 s[80:81], s[80:81], s[52:53]
    s_not_b64 vcc, s[52:53]
    s_mov_b64 exec, -1
    v_cndmask_b32_dpp v84, v84, v84, vcc wave_shr:1 row_mask:0xf bank_mask:0xf
    v_cndmask_b32_dpp v85, v85, v85, vcc wave_shr:1 row_mask:0xf bank_mask:0xf
    s_lshr_b64 s[52:53], s[52:53], 1
    v_cndmask_b32_dpp v86, v86, v86, vcc wave_shr:1 row_mask:0xf bank_mask:0xf
    v_cndmask_b32_dpp v87, v87, v87, vcc wave_shr:1 row_mask:0xf bank_mask:0xf
    s_andn2_b64 s[82:83], s[82:83], s[52:53]
    v_cndmask_b32_dpp v7, v7, v7, vcc wave_shr:1 row_mask:0xf bank_mask:0xf
    s_mov_b64 exec, s[50:51]
    s_cbranch_scc0 L2_d90
    s_mov_b64 exec, s[82:83]
    s_nop 1
    v_mfma_f32_4x4x4_16b_bf16 v[88:91], v[12:13], v[84:85], 0
    s_nop 1
    v_mfma_f32_4x4x4_16b_bf16 v[88:91], v[10:11], v[86:87], v[88:91]
    s_nop 4
    v_cvt_pk_bf16_f32 v88, v88, v89
    v_cvt_pk_bf16_f32 v89, v90, v91
    ds_pk_add_bf16 v7, v88 offset:65408
    ds_pk_add_bf16 v7, v89 offset:65412
    s_mov_b64 exec, s[50:51]
    s_branch L2_d90
L2_c91:
    s_lshl_b64 s[52:53], s[82:83], 1
    s_andn2_b64 s[52:53], s[52:53], s[80:81]
    s_andn2_b64 s[52:53], s[52:53], s[54:55]
    s_or_b64 s[80:81], s[80:81], s[52:53]
    s_not_b64 vcc, s[52:53]
    s_mov_b64 exec, -1
    v_cndmask_b32_dpp v84, v84, v84, vcc wave_shr:1 row_mask:0xf bank_mask:0xf
    v_cndmask_b32_dpp v85, v85, v85, vcc wave_shr:1 row_mask:0xf bank_mask:0xf
    s_lshr_b64 s[52:53], s[52:53], 1
    v_cndmask_b32_dpp v86, v86, v86, vcc wave_shr:1 row_mask:0xf bank_mask:0xf
    v_cndmask_b32_dpp v87, v87, v87, vcc wave_shr:1 row_mask:0xf bank_mask:0xf
    s_andn2_b64 s[82:83], s[82:83], s[52:53]
    v_cndmask_b32_dpp v7, v7, v7, vcc wave_shr:1 row_mask:0xf bank_mask:0xf
    s_mov_b64 exec, s[54:55]
    s_cbranch_scc0 L2_d91
    s_mov_b64 exec, s[82:83]
    s_nop 1
    v_mfma_f32_4x4x4_16b_bf16 v[88:91], v[12:13], v[84:85], 0
    s_nop 1
    v_mfma_f32_4x4x4_16b_bf16 v[88:91], v[10:11], v[86:87], v[88:91]
    s_nop 4
    v_cvt_pk_bf16_f32 v88, v88, v89
    v_cvt_pk_bf16_f32 v89, v90, v91
    ds_pk_add_bf16 v7, v88 offset:65408
    ds_pk_add_bf16 v7, v89 offset:65412
    s_mov_b64 exec, s[54:55]
    s_branch L2_d91
L2_c92:
    s_lshl_b64 s[52:53], s[82:83], 1
    s_andn2_b64 s[52:53], s[52:53], s[80:81]
    s_andn2_b64 s[52:53], s[52:53], s[50:51]
    s_or_b64 s[80:81], s[80:81], s[52:53]
    s_not_b64 vcc, s[52:53]
    s_mov_b64 exec, -1
    v_cndmask_b32_dpp v84, v84, v84, vcc wave_shr:1 row_mask:0xf bank_mask:0xf
    v_cndmask_b32_dpp v85, v85, v85, vcc wave_shr:1 row_mask:0xf bank_mask:0xf
    s_lshr_b64 s[52:53], s[52:53], 1
    v_cndmask_b32_dpp v86, v86, v86, vcc wave_shr:1 row_mask:0xf bank_mask:0xf
    v_cndmask_b32_dpp v87, v87, v87, vcc wave_shr:1 row_mask:0xf bank_mask:0xf
    s_andn2_b64 s[82:83], s[82:83], s[52:53]
    v_cndmask_b32_dpp v7, v7, v7, vcc wave_shr:1 row_mask:0xf bank_mask:0xf
    s_mov_b64 exec, s[50:51]
    s_cbranch_scc0 L2_d92
    s_mov_b64 exec, s[82:83]
    s_nop 1
    v_mfma_f32_4x4x4_16b_bf16 v[88:91], v[12:13], v[84:85], 0
    s_nop 1
    v_mfma_f32_4x4x4_16b_bf16 v[88:91], v[10:11], v[86:87], v[88:91]
    s_nop 4
    v_cvt_pk_bf16_f32 v88, v88, v89
    v_cvt_pk_bf16_f32 v89, v90, v91
    ds_pk_add_bf16 v7, v88 offset:65408
    ds_pk_add_bf16 v7, v89 offset:65412
    s_mov_b64 exec, s[50:51]
    s_branch L2_d92
L2_c93:
    s_lshl_b64 s[52:53], s[82:83], 1
    s_andn2_b64 s[52:53], s[52:53], s[80:81]
    s_andn2_b64 s[52:53], s[52:53], s[54:55]
    s_or_b64 s[80:81], s[80:81], s[52:53]
    s_not_b64 vcc, s[52:53]
    s_mov_b64 exec, -1
    v_cndmask_b32_dpp v84, v84, v84, vcc wave_shr:1 row_mask:0xf bank_mask:0xf
    v_cndmask_b32_dpp v85, v85, v85, vcc wave_shr:1 row_mask:0xf bank_mask:0xf
    s_lshr_b64 s[52:53], s[52:53], 1
    v_cndmask_b32_dpp v86, v86, v86, vcc wave_shr:1 row_mask:0xf bank_mask:0xf
    v_cndmask_b32_dpp v87, v87, v87, vcc wave_shr:1 row_mask:0xf bank_mask:0xf
    s_andn2_b64 s[82:83], s[82:83], s[52:53]
    v_cndmask_b32_dpp v7, v7, v7, vcc wave_shr:1 row_mask:0xf bank_mask:0xf
    s_mov_b64 exec, s[54:55]
    s_cbranch_scc0 L2_d93
    s_mov_b64 exec, s[82:83]
    s_nop 1
    v_mfma_f32_4x4x4_16b_bf16 v[88:91], v[12:13], v[84:85], 0
    s_nop 1
    v_mfma_f32_4x4x4_16b_bf16 v[88:91], v[10:11], v[86:87], v[88:91]
    s_nop 4
    v_cvt_pk_bf16_f32 v88, v88, v89
    v_cvt_pk_bf16_f32 v89, v90, v91
    ds_pk_add_bf16 v7, v88 offset:65408
    ds_pk_add_bf16 v7, v89 offset:65412
    s_mov_b64 exec, s[54:55]
    s_branch L2_d93
L2_c94:
    s_lshl_b64 s[52:53], s[82:83], 1
    s_andn2_b64 s[52:53], s[52:53], s[80:81]
    s_andn2_b64 s[52:53], s[52:53], s[50:51]
    s_or_b64 s[80:81], s[80:81], s[52:53]
    s_not_b64 vcc, s[52:53]
    s_mov_b64 exec, -1
    v_cndmask_b32_dpp v84, v84, v84, vcc wave_shr:1 row_mask:0xf bank_mask:0xf
    v_cndmask_b32_dpp v85, v85, v85, vcc wave_shr:1 row_mask:0xf bank_mask:0xf
    s_lshr_b64 s[52:53], s[52:53], 1
    v_cndmask_b32_dpp v86, v86, v86, vcc wave_shr:1 row_mask:0xf bank_mask:0xf
    v_cndmask_b32_dpp v87, v87, v87, vcc wave_shr:1 row_mask:0xf bank_mask:0xf
    s_andn2_b64 s[82:83], s[82:83], s[52:53]
    v_cndmask_b32_dpp v7, v7, v7, vcc wave_shr:1 row_mask:0xf bank_mask:0xf
    s_mov_b64 exec, s[50:51]
    s_cbranch_scc0 L2_d94
    s_mov_b64 exec, s[82:83]
    s_nop 1
    v_mfma_f32_4x4x4_16b_bf16 v[88:91], v[12:13], v[84:85], 0
    s_nop 1
    v_mfma_f32_4x4x4_16b_bf16 v[88:91], v[10:11], v[86:87], v[88:91]
    s_nop 4
    v_cvt_pk_bf16_f32 v88, v88, v89
    v_cvt_pk_bf16_f32 v89, v90, v91
    ds_pk_add_bf16 v7, v88 offset:65408
    ds_pk_add_bf16 v7, v89 offset:65412
    s_mov_b64 exec, s[50:51]
    s_branch L2_d94
L2_c95:
    s_lshl_b64 s[52:53], s[82:83], 1
    s_andn2_b64 s[52:53], s[52:53], s[80:81]
    s_andn2_b64 s[52:53], s[52:53], s[54:55]
    s_or_b64 s[80:81], s[80:81], s[52:53]
    s_not_b64 vcc, s[52:53]
    s_mov_b64 exec, -1
    v_cndmask_b32_dpp v84, v84, v84, vcc wave_shr:1 row_mask:0xf bank_mask:0xf
    v_cndmask_b32_dpp v85, v85, v85, vcc wave_shr:1 row_mask:0xf bank_mask:0xf
    s_lshr_b64 s[52:53], s[52:53], 1
    v_cndmask_b32_dpp v86, v86, v86, vcc wave_shr:1 row_mask:0xf bank_mask:0xf
    v_cndmask_b32_dpp v87, v87, v87, vcc wave_shr:1 row_mask:0xf bank_mask:0xf
    s_andn2_b64 s[82:83], s[82:83], s[52:53]
    v_cndmask_b32_dpp v7, v7, v7, vcc wave_shr:1 row_mask:0xf bank_mask:0xf
    s_mov_b64 exec, s[54:55]
    s_cbranch_scc0 L2_d95
    s_mov_b64 exec, s[82:83]
    s_nop 1
    v_mfma_f32_4x4x4_16b_bf16 v[88:91], v[12:13], v[84:85], 0
    s_nop 1
    v_mfma_f32_4x4x4_16b_bf16 v[88:91], v[10:11], v[86:87], v[88:91]
    s_nop 4
    v_cvt_pk_bf16_f32 v88, v88, v89
    v_cvt_pk_bf16_f32 v89, v90, v91
    ds_pk_add_bf16 v7, v88 offset:65408
    ds_pk_add_bf16 v7, v89 offset:65412
    s_mov_b64 exec, s[54:55]
    s_branch L2_d95
L2_c96:
    s_lshl_b64 s[52:53], s[82:83], 1
    s_andn2_b64 s[52:53], s[52:53], s[80:81]
    s_andn2_b64 s[52:53], s[52:53], s[50:51]
    s_or_b64 s[80:81], s[80:81], s[52:53]
    s_not_b64 vcc, s[52:53]
    s_mov_b64 exec, -1
    v_cndmask_b32_dpp v84, v84, v84, vcc wave_shr:1 row_mask:0xf bank_mask:0xf
    v_cndmask_b32_dpp v85, v85, v85, vcc wave_shr:1 row_mask:0xf bank_mask:0xf
    s_lshr_b64 s[52:53], s[52:53], 1
    v_cndmask_b32_dpp v86, v86, v86, vcc wave_shr:1 row_mask:0xf bank_mask:0xf
    v_cndmask_b32_dpp v87, v87, v87, vcc wave_shr:1 row_mask:0xf bank_mask:0xf
    s_andn2_b64 s[82:83], s[82:83], s[52:53]
    v_cndmask_b32_dpp v7, v7, v7, vcc wave_shr:1 row_mask:0xf bank_mask:0xf
    s_mov_b64 exec, s[50:51]
    s_cbranch_scc0 L2_d96
    s_mov_b64 exec, s[82:83]
    s_nop 1
    v_mfma_f32_4x4x4_16b_bf16 v[88:91], v[12:13], v[84:85], 0
    s_nop 1
    v_mfma_f32_4x4x4_16b_bf16 v[88:91], v[10:11], v[86:87], v[88:91]
    s_nop 4
    v_cvt_pk_bf16_f32 v88, v88, v89
    v_cvt_pk_bf16_f32 v89, v90, v91
    ds_pk_add_bf16 v7, v88 offset:65408
    ds_pk_add_bf16 v7, v89 offset:65412
    s_mov_b64 exec, s[50:51]
    s_branch L2_d96
L2_xa97:
    s_cmp_eq_u32 s101, 1
    s_cbranch_scc1 L2_xc97
    v_lshlrev_b32 v89, 0, v96
    v_add_u32 v90, 140, v97
    v_bitop3_b32 v90, v89, v45, v90 bitop3:0x6a
    ds_write_b32 v98, v90 offset:28
    v_lshlrev_b32 v89, 4, v96
    v_add_u32 v90, 120, v97
    v_bitop3_b32 v90, v89, v45, v90 bitop3:0x6a
    ds_write_b32 v98, v90 offset:24
    v_lshlrev_b32 v89, 8, v96
    v_add_u32 v90, 100, v97
    v_bitop3_b32 v90, v89, v45, v90 bitop3:0x6a
    ds_write_b32 v98, v90 offset:20
L2_xc97:
    v_lshlrev_b32 v89, 12, v96
    v_add_u32 v90, 80, v97
    v_bitop3_b32 v90, v89, v45, v90 bitop3:0x6a
    ds_write_b32 v98, v90 offset:16
    s_branch L2_xb97
L2_xe97:
    v_cmp_lt_u32 vcc, 32, v99
    v_cmp_lt_u32 s[58:59], 31, v88
    v_lshrrev_b32 v89, 16, v96
    v_add_u32 v97, 80, v97
    s_or_b64 vcc, vcc, s[58:59]
    s_cbranch_scc1 L2_xs97
    v_lshlrev_b32 v89, v1, v89
    v_and_b32 v89, v45, v89
    v_cmp_ne_u32 vcc, 0, v89
    v_xor_b32 v90, v97, v89
    s_add_u32 s3, s37, s38
    v_mbcnt_lo_u32_b32 v98, vcc_lo, 0
    v_mbcnt_hi_u32_b32 v98, vcc_hi, v98
    s_bcnt1_i32_b64 s41, vcc
    v_lshl_add_u32 v98, v98, 2, s3
    s_mov_b64 exec, vcc
    ds_write_b32 v98, v90
    s_mov_b64 exec, -1
    s_lshl2_add_u32 s37, s41, s37
    s_branch L2_xr97
L2_xf97:
    s_waitcnt lgkmcnt(0)
    s_cmp_gt_u32 s37, 1024
    s_cbranch_scc1 L2_xs97
    v_mov_b32 v43, -1
    s_cmp_ge_u32 s37, 512
    s_cbranch_scc1 L2_xg97
    v_mov_b32 v42, -1
    s_cmp_ge_u32 s37, 256
    s_cbranch_scc1 L2_xg97
    v_mov_b32 v41, -1
    s_branch L2_xg97
L2_xs97:
    s_waitcnt lgkmcnt(0)
    v_mov_b32 v40, -1
    v_mov_b32 v41, -1
    v_mov_b32 v42, -1
    v_mov_b32 v43, -1
    s_add_u32 s3, s42, 2
    s_bitset1_b32 s36, s3
    s_branch L2_xg97
L2_c98:
    s_lshl_b64 s[52:53], s[82:83], 1
    s_andn2_b64 s[52:53], s[52:53], s[80:81]
    s_andn2_b64 s[52:53], s[52:53], s[54:55]
    s_or_b64 s[80:81], s[80:81], s[52:53]
    s_not_b64 vcc, s[52:53]
    s_mov_b64 exec, -1
    v_cndmask_b32_dpp v84, v84, v84, vcc wave_shr:1 row_mask:0xf bank_mask:0xf
    v_cndmask_b32_dpp v85, v85, v85, vcc wave_shr:1 row_mask:0xf bank_mask:0xf
    s_lshr_b64 s[52:53], s[52:53], 1
    v_cndmask_b32_dpp v86, v86, v86, vcc wave_shr:1 row_mask:0xf bank_mask:0xf
    v_cndmask_b32_dpp v87, v87, v87, vcc wave_shr:1 row_mask:0xf bank_mask:0xf
    s_andn2_b64 s[82:83], s[82:83], s[52:53]
    v_cndmask_b32_dpp v7, v7, v7, vcc wave_shr:1 row_mask:0xf bank_mask:0xf
    s_mov_b64 exec, s[54:55]
    s_cbranch_scc0 L2_d98
    s_mov_b64 exec, s[82:83]
    s_nop 1
    v_mfma_f32_4x4x4_16b_bf16 v[88:91], v[12:13], v[84:85], 0
    s_nop 1
    v_mfma_f32_4x4x4_16b_bf16 v[88:91], v[10:11], v[86:87], v[88:91]
    s_nop 4
    v_cvt_pk_bf16_f32 v88, v88, v89
    v_cvt_pk_bf16_f32 v89, v90, v91
    ds_pk_add_bf16 v7, v88 offset:65408
    ds_pk_add_bf16 v7, v89 offset:65412
    s_mov_b64 exec, s[54:55]
    s_branch L2_d98
L2_c99:
    s_lshl_b64 s[52:53], s[82:83], 1
    s_andn2_b64 s[52:53], s[52:53], s[80:81]
    s_andn2_b64 s[52:53], s[52:53], s[50:51]
    s_or_b64 s[80:81], s[80:81], s[52:53]
    s_not_b64 vcc, s[52:53]
    s_mov_b64 exec, -1
    v_cndmask_b32_dpp v84, v84, v84, vcc wave_shr:1 row_mask:0xf bank_mask:0xf
    v_cndmask_b32_dpp v85, v85, v85, vcc wave_shr:1 row_mask:0xf bank_mask:0xf
    s_lshr_b64 s[52:53], s[52:53], 1
    v_cndmask_b32_dpp v86, v86, v86, vcc wave_shr:1 row_mask:0xf bank_mask:0xf
    v_cndmask_b32_dpp v87, v87, v87, vcc wave_shr:1 row_mask:0xf bank_mask:0xf
    s_andn2_b64 s[82:83], s[82:83], s[52:53]
    v_cndmask_b32_dpp v7, v7, v7, vcc wave_shr:1 row_mask:0xf bank_mask:0xf
    s_mov_b64 exec, s[50:51]
    s_cbranch_scc0 L2_d99
    s_mov_b64 exec, s[82:83]
    s_nop 1
    v_mfma_f32_4x4x4_16b_bf16 v[88:91], v[12:13], v[84:85], 0
    s_nop 1
    v_mfma_f32_4x4x4_16b_bf16 v[88:91], v[10:11], v[86:87], v[88:91]
    s_nop 4
    v_cvt_pk_bf16_f32 v88, v88, v89
    v_cvt_pk_bf16_f32 v89, v90, v91
    ds_pk_add_bf16 v7, v88 offset:65408
    ds_pk_add_bf16 v7, v89 offset:65412
    s_mov_b64 exec, s[50:51]
    s_branch L2_d99
L2_c100:
    s_lshl_b64 s[52:53], s[82:83], 1
    s_andn2_b64 s[52:53], s[52:53], s[80:81]
    s_andn2_b64 s[52:53], s[52:53], s[54:55]
    s_or_b64 s[80:81], s[80:81], s[52:53]
    s_not_b64 vcc, s[52:53]
    s_mov_b64 exec, -1
    v_cndmask_b32_dpp v84, v84, v84, vcc wave_shr:1 row_mask:0xf bank_mask:0xf
    v_cndmask_b32_dpp v85, v85, v85, vcc wave_shr:1 row_mask:0xf bank_mask:0xf
    s_lshr_b64 s[52:53], s[52:53], 1
    v_cndmask_b32_dpp v86, v86, v86, vcc wave_shr:1 row_mask:0xf bank_mask:0xf
    v_cndmask_b32_dpp v87, v87, v87, vcc wave_shr:1 row_mask:0xf bank_mask:0xf
    s_andn2_b64 s[82:83], s[82:83], s[52:53]
    v_cndmask_b32_dpp v7, v7, v7, vcc wave_shr:1 row_mask:0xf bank_mask:0xf
    s_mov_b64 exec, s[54:55]
    s_cbranch_scc0 L2_d100
    s_mov_b64 exec, s[82:83]
    s_nop 1
    v_mfma_f32_4x4x4_16b_bf16 v[88:91], v[12:13], v[84:85], 0
    s_nop 1
    v_mfma_f32_4x4x4_16b_bf16 v[88:91], v[10:11], v[86:87], v[88:91]
    s_nop 4
    v_cvt_pk_bf16_f32 v88, v88, v89
    v_cvt_pk_bf16_f32 v89, v90, v91
    ds_pk_add_bf16 v7, v88 offset:65408
    ds_pk_add_bf16 v7, v89 offset:65412
    s_mov_b64 exec, s[54:55]
    s_branch L2_d100
L2_c101:
    s_lshl_b64 s[52:53], s[82:83], 1
    s_andn2_b64 s[52:53], s[52:53], s[80:81]
    s_andn2_b64 s[52:53], s[52:53], s[50:51]
    s_or_b64 s[80:81], s[80:81], s[52:53]
    s_not_b64 vcc, s[52:53]
    s_mov_b64 exec, -1
    v_cndmask_b32_dpp v84, v84, v84, vcc wave_shr:1 row_mask:0xf bank_mask:0xf
    v_cndmask_b32_dpp v85, v85, v85, vcc wave_shr:1 row_mask:0xf bank_mask:0xf
    s_lshr_b64 s[52:53], s[52:53], 1
    v_cndmask_b32_dpp v86, v86, v86, vcc wave_shr:1 row_mask:0xf bank_mask:0xf
    v_cndmask_b32_dpp v87, v87, v87, vcc wave_shr:1 row_mask:0xf bank_mask:0xf
    s_andn2_b64 s[82:83], s[82:83], s[52:53]
    v_cndmask_b32_dpp v7, v7, v7, vcc wave_shr:1 row_mask:0xf bank_mask:0xf
    s_mov_b64 exec, s[50:51]
    s_cbranch_scc0 L2_d101
    s_mov_b64 exec, s[82:83]
    s_nop 1
    v_mfma_f32_4x4x4_16b_bf16 v[88:91], v[12:13], v[84:85], 0
    s_nop 1
    v_mfma_f32_4x4x4_16b_bf16 v[88:91], v[10:11], v[86:87], v[88:91]
    s_nop 4
    v_cvt_pk_bf16_f32 v88, v88, v89
    v_cvt_pk_bf16_f32 v89, v90, v91
    ds_pk_add_bf16 v7, v88 offset:65408
    ds_pk_add_bf16 v7, v89 offset:65412
    s_mov_b64 exec, s[50:51]
    s_branch L2_d101
L2_c102:
    s_lshl_b64 s[52:53], s[82:83], 1
    s_andn2_b64 s[52:53], s[52:53], s[80:81]
    s_andn2_b64 s[52:53], s[52:53], s[54:55]
    s_or_b64 s[80:81], s[80:81], s[52:53]
    s_not_b64 vcc, s[52:53]
    s_mov_b64 exec, -1
    v_cndmask_b32_dpp v84, v84, v84, vcc wave_shr:1 row_mask:0xf bank_mask:0xf
    v_cndmask_b32_dpp v85, v85, v85, vcc wave_shr:1 row_mask:0xf bank_mask:0xf
    s_lshr_b64 s[52:53], s[52:53], 1
    v_cndmask_b32_dpp v86, v86, v86, vcc wave_shr:1 row_mask:0xf bank_mask:0xf
    v_cndmask_b32_dpp v87, v87, v87, vcc wave_shr:1 row_mask:0xf bank_mask:0xf
    s_andn2_b64 s[82:83], s[82:83], s[52:53]
    v_cndmask_b32_dpp v7, v7, v7, vcc wave_shr:1 row_mask:0xf bank_mask:0xf
    s_mov_b64 exec, s[54:55]
    s_cbranch_scc0 L2_d102
    s_mov_b64 exec, s[82:83]
    s_nop 1
    v_mfma_f32_4x4x4_16b_bf16 v[88:91], v[12:13], v[84:85], 0
    s_nop 1
    v_mfma_f32_4x4x4_16b_bf16 v[88:91], v[10:11], v[86:87], v[88:91]
    s_nop 4
    v_cvt_pk_bf16_f32 v88, v88, v89
    v_cvt_pk_bf16_f32 v89, v90, v91
    ds_pk_add_bf16 v7, v88 offset:65408
    ds_pk_add_bf16 v7, v89 offset:65412
    s_mov_b64 exec, s[54:55]
    s_branch L2_d102
L2_c103:
    s_lshl_b64 s[52:53], s[82:83], 1
    s_andn2_b64 s[52:53], s[52:53], s[80:81]
    s_andn2_b64 s[52:53], s[52:53], s[50:51]
    s_or_b64 s[80:81], s[80:81], s[52:53]
    s_not_b64 vcc, s[52:53]
    s_mov_b64 exec, -1
    v_cndmask_b32_dpp v84, v84, v84, vcc wave_shr:1 row_mask:0xf bank_mask:0xf
    v_cndmask_b32_dpp v85, v85, v85, vcc wave_shr:1 row_mask:0xf bank_mask:0xf
    s_lshr_b64 s[52:53], s[52:53], 1
    v_cndmask_b32_dpp v86, v86, v86, vcc wave_shr:1 row_mask:0xf bank_mask:0xf
    v_cndmask_b32_dpp v87, v87, v87, vcc wave_shr:1 row_mask:0xf bank_mask:0xf
    s_andn2_b64 s[82:83], s[82:83], s[52:53]
    v_cndmask_b32_dpp v7, v7, v7, vcc wave_shr:1 row_mask:0xf bank_mask:0xf
    s_mov_b64 exec, s[50:51]
    s_cbranch_scc0 L2_d103
    s_mov_b64 exec, s[82:83]
    s_nop 1
    v_mfma_f32_4x4x4_16b_bf16 v[88:91], v[12:13], v[84:85], 0
    s_nop 1
    v_mfma_f32_4x4x4_16b_bf16 v[88:91], v[10:11], v[86:87], v[88:91]
    s_nop 4
    v_cvt_pk_bf16_f32 v88, v88, v89
    v_cvt_pk_bf16_f32 v89, v90, v91
    ds_pk_add_bf16 v7, v88 offset:65408
    ds_pk_add_bf16 v7, v89 offset:65412
    s_mov_b64 exec, s[50:51]
    s_branch L2_d103
L2_xo104:
    v_cmp_lt_u32 vcc, 20, v99
    s_mov_b32 s101, 1
    s_cbranch_vccz L2_xp104
    v_cmp_lt_u32 vcc, 32, v99
    v_cmp_lt_u32 s[58:59], 31, v88
    s_mov_b32 s101, 2
    s_or_b64 vcc, vcc, s[58:59]
    s_cbranch_scc0 L2_xp104
    s_mov_b32 s37, 0x10000
    s_branch L2_xp104
L2_c105:
    s_lshl_b64 s[52:53], s[82:83], 1
    s_andn2_b64 s[52:53], s[52:53], s[80:81]
    s_andn2_b64 s[52:53], s[52:53], s[54:55]
    s_or_b64 s[80:81], s[80:81], s[52:53]
    s_not_b64 vcc, s[52:53]
    s_mov_b64 exec, -1
    v_cndmask_b32_dpp v84, v84, v84, vcc wave_shr:1 row_mask:0xf bank_mask:0xf
    v_cndmask_b32_dpp v85, v85, v85, vcc wave_shr:1 row_mask:0xf bank_mask:0xf
    s_lshr_b64 s[52:53], s[52:53], 1
    v_cndmask_b32_dpp v86, v86, v86, vcc wave_shr:1 row_mask:0xf bank_mask:0xf
    v_cndmask_b32_dpp v87, v87, v87, vcc wave_shr:1 row_mask:0xf bank_mask:0xf
    s_andn2_b64 s[82:83], s[82:83], s[52:53]
    v_cndmask_b32_dpp v7, v7, v7, vcc wave_shr:1 row_mask:0xf bank_mask:0xf
    s_mov_b64 exec, s[54:55]
    s_cbranch_scc0 L2_d105
    s_mov_b64 exec, s[82:83]
    s_nop 1
    v_mfma_f32_4x4x4_16b_bf16 v[88:91], v[12:13], v[84:85], 0
    s_nop 1
    v_mfma_f32_4x4x4_16b_bf16 v[88:91], v[10:11], v[86:87], v[88:91]
    s_nop 4
    v_cvt_pk_bf16_f32 v88, v88, v89
    v_cvt_pk_bf16_f32 v89, v90, v91
    ds_pk_add_bf16 v7, v88 offset:65408
    ds_pk_add_bf16 v7, v89 offset:65412
    s_mov_b64 exec, s[54:55]
    s_branch L2_d105
L2_c106:
    s_lshl_b64 s[52:53], s[82:83], 1
    s_andn2_b64 s[52:53], s[52:53], s[80:81]
    s_andn2_b64 s[52:53], s[52:53], s[50:51]
    s_or_b64 s[80:81], s[80:81], s[52:53]
    s_not_b64 vcc, s[52:53]
    s_mov_b64 exec, -1
    v_cndmask_b32_dpp v84, v84, v84, vcc wave_shr:1 row_mask:0xf bank_mask:0xf
    v_cndmask_b32_dpp v85, v85, v85, vcc wave_shr:1 row_mask:0xf bank_mask:0xf
    s_lshr_b64 s[52:53], s[52:53], 1
    v_cndmask_b32_dpp v86, v86, v86, vcc wave_shr:1 row_mask:0xf bank_mask:0xf
    v_cndmask_b32_dpp v87, v87, v87, vcc wave_shr:1 row_mask:0xf bank_mask:0xf
    s_andn2_b64 s[82:83], s[82:83], s[52:53]
    v_cndmask_b32_dpp v7, v7, v7, vcc wave_shr:1 row_mask:0xf bank_mask:0xf
    s_mov_b64 exec, s[50:51]
    s_cbranch_scc0 L2_d106
    s_mov_b64 exec, s[82:83]
    s_nop 1
    v_mfma_f32_4x4x4_16b_bf16 v[88:91], v[12:13], v[84:85], 0
    s_nop 1
    v_mfma_f32_4x4x4_16b_bf16 v[88:91], v[10:11], v[86:87], v[88:91]
    s_nop 4
    v_cvt_pk_bf16_f32 v88, v88, v89
    v_cvt_pk_bf16_f32 v89, v90, v91
    ds_pk_add_bf16 v7, v88 offset:65408
    ds_pk_add_bf16 v7, v89 offset:65412
    s_mov_b64 exec, s[50:51]
    s_branch L2_d106
L2_c107:
    s_lshl_b64 s[52:53], s[82:83], 1
    s_andn2_b64 s[52:53], s[52:53], s[80:81]
    s_andn2_b64 s[52:53], s[52:53], s[54:55]
    s_or_b64 s[80:81], s[80:81], s[52:53]
    s_not_b64 vcc, s[52:53]
    s_mov_b64 exec, -1
    v_cndmask_b32_dpp v84, v84, v84, vcc wave_shr:1 row_mask:0xf bank_mask:0xf
    v_cndmask_b32_dpp v85, v85, v85, vcc wave_shr:1 row_mask:0xf bank_mask:0xf
    s_lshr_b64 s[52:53], s[52:53], 1
    v_cndmask_b32_dpp v86, v86, v86, vcc wave_shr:1 row_mask:0xf bank_mask:0xf
    v_cndmask_b32_dpp v87, v87, v87, vcc wave_shr:1 row_mask:0xf bank_mask:0xf
    s_andn2_b64 s[82:83], s[82:83], s[52:53]
    v_cndmask_b32_dpp v7, v7, v7, vcc wave_shr:1 row_mask:0xf bank_mask:0xf
    s_mov_b64 exec, s[54:55]
    s_cbranch_scc0 L2_d107
    s_mov_b64 exec, s[82:83]
    s_nop 1
    v_mfma_f32_4x4x4_16b_bf16 v[88:91], v[12:13], v[84:85], 0
    s_nop 1
    v_mfma_f32_4x4x4_16b_bf16 v[88:91], v[10:11], v[86:87], v[88:91]
    s_nop 4
    v_cvt_pk_bf16_f32 v88, v88, v89
    v_cvt_pk_bf16_f32 v89, v90, v91
    ds_pk_add_bf16 v7, v88 offset:65408
    ds_pk_add_bf16 v7, v89 offset:65412
    s_mov_b64 exec, s[54:55]
    s_branch L2_d107
L2_c108:
    s_lshl_b64 s[52:53], s[82:83], 1
    s_andn2_b64 s[52:53], s[52:53], s[80:81]
    s_andn2_b64 s[52:53], s[52:53], s[50:51]
    s_or_b64 s[80:81], s[80:81], s[52:53]
    s_not_b64 vcc, s[52:53]
    s_mov_b64 exec, -1
    v_cndmask_b32_dpp v84, v84, v84, vcc wave_shr:1 row_mask:0xf bank_mask:0xf
    v_cndmask_b32_dpp v85, v85, v85, vcc wave_shr:1 row_mask:0xf bank_mask:0xf
    s_lshr_b64 s[52:53], s[52:53], 1
    v_cndmask_b32_dpp v86, v86, v86, vcc wave_shr:1 row_mask:0xf bank_mask:0xf
    v_cndmask_b32_dpp v87, v87, v87, vcc wave_shr:1 row_mask:0xf bank_mask:0xf
    s_andn2_b64 s[82:83], s[82:83], s[52:53]
    v_cndmask_b32_dpp v7, v7, v7, vcc wave_shr:1 row_mask:0xf bank_mask:0xf
    s_mov_b64 exec, s[50:51]
    s_cbranch_scc0 L2_d108
    s_mov_b64 exec, s[82:83]
    s_nop 1
    v_mfma_f32_4x4x4_16b_bf16 v[88:91], v[12:13], v[84:85], 0
    s_nop 1
    v_mfma_f32_4x4x4_16b_bf16 v[88:91], v[10:11], v[86:87], v[88:91]
    s_nop 4
    v_cvt_pk_bf16_f32 v88, v88, v89
    v_cvt_pk_bf16_f32 v89, v90, v91
    ds_pk_add_bf16 v7, v88 offset:65408
    ds_pk_add_bf16 v7, v89 offset:65412
    s_mov_b64 exec, s[50:51]
    s_branch L2_d108
L2_c109:
    s_lshl_b64 s[52:53], s[82:83], 1
    s_andn2_b64 s[52:53], s[52:53], s[80:81]
    s_andn2_b64 s[52:53], s[52:53], s[54:55]
    s_or_b64 s[80:81], s[80:81], s[52:53]
    s_not_b64 vcc, s[52:53]
    s_mov_b64 exec, -1
    v_cndmask_b32_dpp v84, v84, v84, vcc wave_shr:1 row_mask:0xf bank_mask:0xf
    v_cndmask_b32_dpp v85, v85, v85, vcc wave_shr:1 row_mask:0xf bank_mask:0xf
    s_lshr_b64 s[52:53], s[52:53], 1
    v_cndmask_b32_dpp v86, v86, v86, vcc wave_shr:1 row_mask:0xf bank_mask:0xf
    v_cndmask_b32_dpp v87, v87, v87, vcc wave_shr:1 row_mask:0xf bank_mask:0xf
    s_andn2_b64 s[82:83], s[82:83], s[52:53]
    v_cndmask_b32_dpp v7, v7, v7, vcc wave_shr:1 row_mask:0xf bank_mask:0xf
    s_mov_b64 exec, s[54:55]
    s_cbranch_scc0 L2_d109
    s_mov_b64 exec, s[82:83]
    s_nop 1
    v_mfma_f32_4x4x4_16b_bf16 v[88:91], v[12:13], v[84:85], 0
    s_nop 1
    v_mfma_f32_4x4x4_16b_bf16 v[88:91], v[10:11], v[86:87], v[88:91]
    s_nop 4
    v_cvt_pk_bf16_f32 v88, v88, v89
    v_cvt_pk_bf16_f32 v89, v90, v91
    ds_pk_add_bf16 v7, v88 offset:65408
    ds_pk_add_bf16 v7, v89 offset:65412
    s_mov_b64 exec, s[54:55]
    s_branch L2_d109
L2_c110:
    s_lshl_b64 s[52:53], s[82:83], 1
    s_andn2_b64 s[52:53], s[52:53], s[80:81]
    s_andn2_b64 s[52:53], s[52:53], s[50:51]
    s_or_b64 s[80:81], s[80:81], s[52:53]
    s_not_b64 vcc, s[52:53]
    s_mov_b64 exec, -1
    v_cndmask_b32_dpp v84, v84, v84, vcc wave_shr:1 row_mask:0xf bank_mask:0xf
    v_cndmask_b32_dpp v85, v85, v85, vcc wave_shr:1 row_mask:0xf bank_mask:0xf
    s_lshr_b64 s[52:53], s[52:53], 1
    v_cndmask_b32_dpp v86, v86, v86, vcc wave_shr:1 row_mask:0xf bank_mask:0xf
    v_cndmask_b32_dpp v87, v87, v87, vcc wave_shr:1 row_mask:0xf bank_mask:0xf
    s_andn2_b64 s[82:83], s[82:83], s[52:53]
    v_cndmask_b32_dpp v7, v7, v7, vcc wave_shr:1 row_mask:0xf bank_mask:0xf
    s_mov_b64 exec, s[50:51]
    s_cbranch_scc0 L2_d110
    s_mov_b64 exec, s[82:83]
    s_nop 1
    v_mfma_f32_4x4x4_16b_bf16 v[88:91], v[12:13], v[84:85], 0
    s_nop 1
    v_mfma_f32_4x4x4_16b_bf16 v[88:91], v[10:11], v[86:87], v[88:91]
    s_nop 4
    v_cvt_pk_bf16_f32 v88, v88, v89
    v_cvt_pk_bf16_f32 v89, v90, v91
    ds_pk_add_bf16 v7, v88 offset:65408
    ds_pk_add_bf16 v7, v89 offset:65412
    s_mov_b64 exec, s[50:51]
    s_branch L2_d110
L2_c111:
    s_lshl_b64 s[52:53], s[82:83], 1
    s_andn2_b64 s[52:53], s[52:53], s[80:81]
    s_andn2_b64 s[52:53], s[52:53], s[54:55]
    s_or_b64 s[80:81], s[80:81], s[52:53]
    s_not_b64 vcc, s[52:53]
    s_mov_b64 exec, -1
    v_cndmask_b32_dpp v84, v84, v84, vcc wave_shr:1 row_mask:0xf bank_mask:0xf
    v_cndmask_b32_dpp v85, v85, v85, vcc wave_shr:1 row_mask:0xf bank_mask:0xf
    s_lshr_b64 s[52:53], s[52:53], 1
    v_cndmask_b32_dpp v86, v86, v86, vcc wave_shr:1 row_mask:0xf bank_mask:0xf
    v_cndmask_b32_dpp v87, v87, v87, vcc wave_shr:1 row_mask:0xf bank_mask:0xf
    s_andn2_b64 s[82:83], s[82:83], s[52:53]
    v_cndmask_b32_dpp v7, v7, v7, vcc wave_shr:1 row_mask:0xf bank_mask:0xf
    s_mov_b64 exec, s[54:55]
    s_cbranch_scc0 L2_d111
    s_mov_b64 exec, s[82:83]
    s_nop 1
    v_mfma_f32_4x4x4_16b_bf16 v[88:91], v[12:13], v[84:85], 0
    s_nop 1
    v_mfma_f32_4x4x4_16b_bf16 v[88:91], v[10:11], v[86:87], v[88:91]
    s_nop 4
    v_cvt_pk_bf16_f32 v88, v88, v89
    v_cvt_pk_bf16_f32 v89, v90, v91
    ds_pk_add_bf16 v7, v88 offset:65408
    ds_pk_add_bf16 v7, v89 offset:65412
    s_mov_b64 exec, s[54:55]
    s_branch L2_d111
L2_c112:
    s_lshl_b64 s[52:53], s[82:83], 1
    s_andn2_b64 s[52:53], s[52:53], s[80:81]
    s_andn2_b64 s[52:53], s[52:53], s[50:51]
    s_or_b64 s[80:81], s[80:81], s[52:53]
    s_not_b64 vcc, s[52:53]
    s_mov_b64 exec, -1
    v_cndmask_b32_dpp v84, v84, v84, vcc wave_shr:1 row_mask:0xf bank_mask:0xf
    v_cndmask_b32_dpp v85, v85, v85, vcc wave_shr:1 row_mask:0xf bank_mask:0xf
    s_lshr_b64 s[52:53], s[52:53], 1
    v_cndmask_b32_dpp v86, v86, v86, vcc wave_shr:1 row_mask:0xf bank_mask:0xf
    v_cndmask_b32_dpp v87, v87, v87, vcc wave_shr:1 row_mask:0xf bank_mask:0xf
    s_andn2_b64 s[82:83], s[82:83], s[52:53]
    v_cndmask_b32_dpp v7, v7, v7, vcc wave_shr:1 row_mask:0xf bank_mask:0xf
    s_mov_b64 exec, s[50:51]
    s_cbranch_scc0 L2_d112
    s_mov_b64 exec, s[82:83]
    s_nop 1
    v_mfma_f32_4x4x4_16b_bf16 v[88:91], v[12:13], v[84:85], 0
    s_nop 1
    v_mfma_f32_4x4x4_16b_bf16 v[88:91], v[10:11], v[86:87], v[88:91]
    s_nop 4
    v_cvt_pk_bf16_f32 v88, v88, v89
    v_cvt_pk_bf16_f32 v89, v90, v91
    ds_pk_add_bf16 v7, v88 offset:65408
    ds_pk_add_bf16 v7, v89 offset:65412
    s_mov_b64 exec, s[50:51]
    s_branch L2_d112
L2_c113:
    s_lshl_b64 s[52:53], s[82:83], 1
    s_andn2_b64 s[52:53], s[52:53], s[80:81]
    s_andn2_b64 s[52:53], s[52:53], s[54:55]
    s_or_b64 s[80:81], s[80:81], s[52:53]
    s_not_b64 vcc, s[52:53]
    s_mov_b64 exec, -1
    v_cndmask_b32_dpp v84, v84, v84, vcc wave_shr:1 row_mask:0xf bank_mask:0xf
    v_cndmask_b32_dpp v85, v85, v85, vcc wave_shr:1 row_mask:0xf bank_mask:0xf
    s_lshr_b64 s[52:53], s[52:53], 1
    v_cndmask_b32_dpp v86, v86, v86, vcc wave_shr:1 row_mask:0xf bank_mask:0xf
    v_cndmask_b32_dpp v87, v87, v87, vcc wave_shr:1 row_mask:0xf bank_mask:0xf
    s_andn2_b64 s[82:83], s[82:83], s[52:53]
    v_cndmask_b32_dpp v7, v7, v7, vcc wave_shr:1 row_mask:0xf bank_mask:0xf
    s_mov_b64 exec, s[54:55]
    s_cbranch_scc0 L2_d113
    s_mov_b64 exec, s[82:83]
    s_nop 1
    v_mfma_f32_4x4x4_16b_bf16 v[88:91], v[12:13], v[84:85], 0
    s_nop 1
    v_mfma_f32_4x4x4_16b_bf16 v[88:91], v[10:11], v[86:87], v[88:91]
    s_nop 4
    v_cvt_pk_bf16_f32 v88, v88, v89
    v_cvt_pk_bf16_f32 v89, v90, v91
    ds_pk_add_bf16 v7, v88 offset:65408
    ds_pk_add_bf16 v7, v89 offset:65412
    s_mov_b64 exec, s[54:55]
    s_branch L2_d113
L2_c114:
    s_lshl_b64 s[52:53], s[82:83], 1
    s_andn2_b64 s[52:53], s[52:53], s[80:81]
    s_andn2_b64 s[52:53], s[52:53], s[50:51]
    s_or_b64 s[80:81], s[80:81], s[52:53]
    s_not_b64 vcc, s[52:53]
    s_mov_b64 exec, -1
    v_cndmask_b32_dpp v84, v84, v84, vcc wave_shr:1 row_mask:0xf bank_mask:0xf
    v_cndmask_b32_dpp v85, v85, v85, vcc wave_shr:1 row_mask:0xf bank_mask:0xf
    s_lshr_b64 s[52:53], s[52:53], 1
    v_cndmask_b32_dpp v86, v86, v86, vcc wave_shr:1 row_mask:0xf bank_mask:0xf
    v_cndmask_b32_dpp v87, v87, v87, vcc wave_shr:1 row_mask:0xf bank_mask:0xf
    s_andn2_b64 s[82:83], s[82:83], s[52:53]
    v_cndmask_b32_dpp v7, v7, v7, vcc wave_shr:1 row_mask:0xf bank_mask:0xf
    s_mov_b64 exec, s[50:51]
    s_cbranch_scc0 L2_d114
    s_mov_b64 exec, s[82:83]
    s_nop 1
    v_mfma_f32_4x4x4_16b_bf16 v[88:91], v[12:13], v[84:85], 0
    s_nop 1
    v_mfma_f32_4x4x4_16b_bf16 v[88:91], v[10:11], v[86:87], v[88:91]
    s_nop 4
    v_cvt_pk_bf16_f32 v88, v88, v89
    v_cvt_pk_bf16_f32 v89, v90, v91
    ds_pk_add_bf16 v7, v88 offset:65408
    ds_pk_add_bf16 v7, v89 offset:65412
    s_mov_b64 exec, s[50:51]
    s_branch L2_d114
L2_xa115:
    s_cmp_eq_u32 s101, 1
    s_cbranch_scc1 L2_xc115
    v_lshlrev_b32 v89, 0, v96
    v_add_u32 v90, 140, v97
    v_bitop3_b32 v90, v89, v45, v90 bitop3:0x6a
    ds_write_b32 v98, v90 offset:28
    v_lshlrev_b32 v89, 4, v96
    v_add_u32 v90, 120, v97
    v_bitop3_b32 v90, v89, v45, v90 bitop3:0x6a
    ds_write_b32 v98, v90 offset:24
    v_lshlrev_b32 v89, 8, v96
    v_add_u32 v90, 100, v97
    v_bitop3_b32 v90, v89, v45, v90 bitop3:0x6a
    ds_write_b32 v98, v90 offset:20
L2_xc115:
    v_lshlrev_b32 v89, 12, v96
    v_add_u32 v90, 80, v97
    v_bitop3_b32 v90, v89, v45, v90 bitop3:0x6a
    ds_write_b32 v98, v90 offset:16
    s_branch L2_xb115
L2_xe115:
    v_cmp_lt_u32 vcc, 32, v99
    v_cmp_lt_u32 s[58:59], 31, v88
    v_lshrrev_b32 v89, 16, v96
    v_add_u32 v97, 80, v97
    s_or_b64 vcc, vcc, s[58:59]
    s_cbranch_scc1 L2_xs115
    v_lshlrev_b32 v89, v1, v89
    v_and_b32 v89, v45, v89
    v_cmp_ne_u32 vcc, 0, v89
    v_xor_b32 v90, v97, v89
    s_add_u32 s3, s37, s38
    v_mbcnt_lo_u32_b32 v98, vcc_lo, 0
    v_mbcnt_hi_u32_b32 v98, vcc_hi, v98
    s_bcnt1_i32_b64 s41, vcc
    v_lshl_add_u32 v98, v98, 2, s3
    s_mov_b64 exec, vcc
    ds_write_b32 v98, v90
    s_mov_b64 exec, -1
    s_lshl2_add_u32 s37, s41, s37
    s_branch L2_xr115
L2_xf115:
    s_waitcnt lgkmcnt(0)
    s_cmp_gt_u32 s37, 1024
    s_cbranch_scc1 L2_xs115
    v_mov_b32 v43, -1
    s_cmp_ge_u32 s37, 512
    s_cbranch_scc1 L2_xg115
    v_mov_b32 v42, -1
    s_cmp_ge_u32 s37, 256
    s_cbranch_scc1 L2_xg115
    v_mov_b32 v41, -1
    s_branch L2_xg115
L2_xs115:
    s_waitcnt lgkmcnt(0)
    v_mov_b32 v40, -1
    v_mov_b32 v41, -1
    v_mov_b32 v42, -1
    v_mov_b32 v43, -1
    s_add_u32 s3, s42, 2
    s_bitset1_b32 s36, s3
    s_branch L2_xg115
L2_c116:
    s_lshl_b64 s[52:53], s[82:83], 1
    s_andn2_b64 s[52:53], s[52:53], s[80:81]
    s_andn2_b64 s[52:53], s[52:53], s[54:55]
    s_or_b64 s[80:81], s[80:81], s[52:53]
    s_not_b64 vcc, s[52:53]
    s_mov_b64 exec, -1
    v_cndmask_b32_dpp v84, v84, v84, vcc wave_shr:1 row_mask:0xf bank_mask:0xf
    v_cndmask_b32_dpp v85, v85, v85, vcc wave_shr:1 row_mask:0xf bank_mask:0xf
    s_lshr_b64 s[52:53], s[52:53], 1
    v_cndmask_b32_dpp v86, v86, v86, vcc wave_shr:1 row_mask:0xf bank_mask:0xf
    v_cndmask_b32_dpp v87, v87, v87, vcc wave_shr:1 row_mask:0xf bank_mask:0xf
    s_andn2_b64 s[82:83], s[82:83], s[52:53]
    v_cndmask_b32_dpp v7, v7, v7, vcc wave_shr:1 row_mask:0xf bank_mask:0xf
    s_mov_b64 exec, s[54:55]
    s_cbranch_scc0 L2_d116
    s_mov_b64 exec, s[82:83]
    s_nop 1
    v_mfma_f32_4x4x4_16b_bf16 v[88:91], v[12:13], v[84:85], 0
    s_nop 1
    v_mfma_f32_4x4x4_16b_bf16 v[88:91], v[10:11], v[86:87], v[88:91]
    s_nop 4
    v_cvt_pk_bf16_f32 v88, v88, v89
    v_cvt_pk_bf16_f32 v89, v90, v91
    ds_pk_add_bf16 v7, v88 offset:65408
    ds_pk_add_bf16 v7, v89 offset:65412
    s_mov_b64 exec, s[54:55]
    s_branch L2_d116
L2_c117:
    s_lshl_b64 s[52:53], s[82:83], 1
    s_andn2_b64 s[52:53], s[52:53], s[80:81]
    s_andn2_b64 s[52:53], s[52:53], s[50:51]
    s_or_b64 s[80:81], s[80:81], s[52:53]
    s_not_b64 vcc, s[52:53]
    s_mov_b64 exec, -1
    v_cndmask_b32_dpp v84, v84, v84, vcc wave_shr:1 row_mask:0xf bank_mask:0xf
    v_cndmask_b32_dpp v85, v85, v85, vcc wave_shr:1 row_mask:0xf bank_mask:0xf
    s_lshr_b64 s[52:53], s[52:53], 1
    v_cndmask_b32_dpp v86, v86, v86, vcc wave_shr:1 row_mask:0xf bank_mask:0xf
    v_cndmask_b32_dpp v87, v87, v87, vcc wave_shr:1 row_mask:0xf bank_mask:0xf
    s_andn2_b64 s[82:83], s[82:83], s[52:53]
    v_cndmask_b32_dpp v7, v7, v7, vcc wave_shr:1 row_mask:0xf bank_mask:0xf
    s_mov_b64 exec, s[50:51]
    s_cbranch_scc0 L2_d117
    s_mov_b64 exec, s[82:83]
    s_nop 1
    v_mfma_f32_4x4x4_16b_bf16 v[88:91], v[12:13], v[84:85], 0
    s_nop 1
    v_mfma_f32_4x4x4_16b_bf16 v[88:91], v[10:11], v[86:87], v[88:91]
    s_nop 4
    v_cvt_pk_bf16_f32 v88, v88, v89
    v_cvt_pk_bf16_f32 v89, v90, v91
    ds_pk_add_bf16 v7, v88 offset:65408
    ds_pk_add_bf16 v7, v89 offset:65412
    s_mov_b64 exec, s[50:51]
    s_branch L2_d117
L2_c118:
    s_lshl_b64 s[52:53], s[82:83], 1
    s_andn2_b64 s[52:53], s[52:53], s[80:81]
    s_andn2_b64 s[52:53], s[52:53], s[54:55]
    s_or_b64 s[80:81], s[80:81], s[52:53]
    s_not_b64 vcc, s[52:53]
    s_mov_b64 exec, -1
    v_cndmask_b32_dpp v84, v84, v84, vcc wave_shr:1 row_mask:0xf bank_mask:0xf
    v_cndmask_b32_dpp v85, v85, v85, vcc wave_shr:1 row_mask:0xf bank_mask:0xf
    s_lshr_b64 s[52:53], s[52:53], 1
    v_cndmask_b32_dpp v86, v86, v86, vcc wave_shr:1 row_mask:0xf bank_mask:0xf
    v_cndmask_b32_dpp v87, v87, v87, vcc wave_shr:1 row_mask:0xf bank_mask:0xf
    s_andn2_b64 s[82:83], s[82:83], s[52:53]
    v_cndmask_b32_dpp v7, v7, v7, vcc wave_shr:1 row_mask:0xf bank_mask:0xf
    s_mov_b64 exec, s[54:55]
    s_cbranch_scc0 L2_d118
    s_mov_b64 exec, s[82:83]
    s_nop 1
    v_mfma_f32_4x4x4_16b_bf16 v[88:91], v[12:13], v[84:85], 0
    s_nop 1
    v_mfma_f32_4x4x4_16b_bf16 v[88:91], v[10:11], v[86:87], v[88:91]
    s_nop 4
    v_cvt_pk_bf16_f32 v88, v88, v89
    v_cvt_pk_bf16_f32 v89, v90, v91
    ds_pk_add_bf16 v7, v88 offset:65408
    ds_pk_add_bf16 v7, v89 offset:65412
    s_mov_b64 exec, s[54:55]
    s_branch L2_d118
L2_c119:
    s_lshl_b64 s[52:53], s[82:83], 1
    s_andn2_b64 s[52:53], s[52:53], s[80:81]
    s_andn2_b64 s[52:53], s[52:53], s[50:51]
    s_or_b64 s[80:81], s[80:81], s[52:53]
    s_not_b64 vcc, s[52:53]
    s_mov_b64 exec, -1
    v_cndmask_b32_dpp v84, v84, v84, vcc wave_shr:1 row_mask:0xf bank_mask:0xf
    v_cndmask_b32_dpp v85, v85, v85, vcc wave_shr:1 row_mask:0xf bank_mask:0xf
    s_lshr_b64 s[52:53], s[52:53], 1
    v_cndmask_b32_dpp v86, v86, v86, vcc wave_shr:1 row_mask:0xf bank_mask:0xf
    v_cndmask_b32_dpp v87, v87, v87, vcc wave_shr:1 row_mask:0xf bank_mask:0xf
    s_andn2_b64 s[82:83], s[82:83], s[52:53]
    v_cndmask_b32_dpp v7, v7, v7, vcc wave_shr:1 row_mask:0xf bank_mask:0xf
    s_mov_b64 exec, s[50:51]
    s_cbranch_scc0 L2_d119
    s_mov_b64 exec, s[82:83]
    s_nop 1
    v_mfma_f32_4x4x4_16b_bf16 v[88:91], v[12:13], v[84:85], 0
    s_nop 1
    v_mfma_f32_4x4x4_16b_bf16 v[88:91], v[10:11], v[86:87], v[88:91]
    s_nop 4
    v_cvt_pk_bf16_f32 v88, v88, v89
    v_cvt_pk_bf16_f32 v89, v90, v91
    ds_pk_add_bf16 v7, v88 offset:65408
    ds_pk_add_bf16 v7, v89 offset:65412
    s_mov_b64 exec, s[50:51]
    s_branch L2_d119
L2_c120:
    s_lshl_b64 s[52:53], s[82:83], 1
    s_andn2_b64 s[52:53], s[52:53], s[80:81]
    s_andn2_b64 s[52:53], s[52:53], s[54:55]
    s_or_b64 s[80:81], s[80:81], s[52:53]
    s_not_b64 vcc, s[52:53]
    s_mov_b64 exec, -1
    v_cndmask_b32_dpp v84, v84, v84, vcc wave_shr:1 row_mask:0xf bank_mask:0xf
    v_cndmask_b32_dpp v85, v85, v85, vcc wave_shr:1 row_mask:0xf bank_mask:0xf
    s_lshr_b64 s[52:53], s[52:53], 1
    v_cndmask_b32_dpp v86, v86, v86, vcc wave_shr:1 row_mask:0xf bank_mask:0xf
    v_cndmask_b32_dpp v87, v87, v87, vcc wave_shr:1 row_mask:0xf bank_mask:0xf
    s_andn2_b64 s[82:83], s[82:83], s[52:53]
    v_cndmask_b32_dpp v7, v7, v7, vcc wave_shr:1 row_mask:0xf bank_mask:0xf
    s_mov_b64 exec, s[54:55]
    s_cbranch_scc0 L2_d120
    s_mov_b64 exec, s[82:83]
    s_nop 1
    v_mfma_f32_4x4x4_16b_bf16 v[88:91], v[12:13], v[84:85], 0
    s_nop 1
    v_mfma_f32_4x4x4_16b_bf16 v[88:91], v[10:11], v[86:87], v[88:91]
    s_nop 4
    v_cvt_pk_bf16_f32 v88, v88, v89
    v_cvt_pk_bf16_f32 v89, v90, v91
    ds_pk_add_bf16 v7, v88 offset:65408
    ds_pk_add_bf16 v7, v89 offset:65412
    s_mov_b64 exec, s[54:55]
    s_branch L2_d120
L2_c121:
    s_lshl_b64 s[52:53], s[82:83], 1
    s_andn2_b64 s[52:53], s[52:53], s[80:81]
    s_andn2_b64 s[52:53], s[52:53], s[50:51]
    s_or_b64 s[80:81], s[80:81], s[52:53]
    s_not_b64 vcc, s[52:53]
    s_mov_b64 exec, -1
    v_cndmask_b32_dpp v84, v84, v84, vcc wave_shr:1 row_mask:0xf bank_mask:0xf
    v_cndmask_b32_dpp v85, v85, v85, vcc wave_shr:1 row_mask:0xf bank_mask:0xf
    s_lshr_b64 s[52:53], s[52:53], 1
    v_cndmask_b32_dpp v86, v86, v86, vcc wave_shr:1 row_mask:0xf bank_mask:0xf
    v_cndmask_b32_dpp v87, v87, v87, vcc wave_shr:1 row_mask:0xf bank_mask:0xf
    s_andn2_b64 s[82:83], s[82:83], s[52:53]
    v_cndmask_b32_dpp v7, v7, v7, vcc wave_shr:1 row_mask:0xf bank_mask:0xf
    s_mov_b64 exec, s[50:51]
    s_cbranch_scc0 L2_d121
    s_mov_b64 exec, s[82:83]
    s_nop 1
    v_mfma_f32_4x4x4_16b_bf16 v[88:91], v[12:13], v[84:85], 0
    s_nop 1
    v_mfma_f32_4x4x4_16b_bf16 v[88:91], v[10:11], v[86:87], v[88:91]
    s_nop 4
    v_cvt_pk_bf16_f32 v88, v88, v89
    v_cvt_pk_bf16_f32 v89, v90, v91
    ds_pk_add_bf16 v7, v88 offset:65408
    ds_pk_add_bf16 v7, v89 offset:65412
    s_mov_b64 exec, s[50:51]
    s_branch L2_d121
L2_c122:
    s_lshl_b64 s[52:53], s[82:83], 1
    s_andn2_b64 s[52:53], s[52:53], s[80:81]
    s_andn2_b64 s[52:53], s[52:53], s[54:55]
    s_or_b64 s[80:81], s[80:81], s[52:53]
    s_not_b64 vcc, s[52:53]
    s_mov_b64 exec, -1
    v_cndmask_b32_dpp v84, v84, v84, vcc wave_shr:1 row_mask:0xf bank_mask:0xf
    v_cndmask_b32_dpp v85, v85, v85, vcc wave_shr:1 row_mask:0xf bank_mask:0xf
    s_lshr_b64 s[52:53], s[52:53], 1
    v_cndmask_b32_dpp v86, v86, v86, vcc wave_shr:1 row_mask:0xf bank_mask:0xf
    v_cndmask_b32_dpp v87, v87, v87, vcc wave_shr:1 row_mask:0xf bank_mask:0xf
    s_andn2_b64 s[82:83], s[82:83], s[52:53]
    v_cndmask_b32_dpp v7, v7, v7, vcc wave_shr:1 row_mask:0xf bank_mask:0xf
    s_mov_b64 exec, s[54:55]
    s_cbranch_scc0 L2_d122
    s_mov_b64 exec, s[82:83]
    s_nop 1
    v_mfma_f32_4x4x4_16b_bf16 v[88:91], v[12:13], v[84:85], 0
    s_nop 1
    v_mfma_f32_4x4x4_16b_bf16 v[88:91], v[10:11], v[86:87], v[88:91]
    s_nop 4
    v_cvt_pk_bf16_f32 v88, v88, v89
    v_cvt_pk_bf16_f32 v89, v90, v91
    ds_pk_add_bf16 v7, v88 offset:65408
    ds_pk_add_bf16 v7, v89 offset:65412
    s_mov_b64 exec, s[54:55]
    s_branch L2_d122
L2_c123:
    s_lshl_b64 s[52:53], s[82:83], 1
    s_andn2_b64 s[52:53], s[52:53], s[80:81]
    s_andn2_b64 s[52:53], s[52:53], s[50:51]
    s_or_b64 s[80:81], s[80:81], s[52:53]
    s_not_b64 vcc, s[52:53]
    s_mov_b64 exec, -1
    v_cndmask_b32_dpp v84, v84, v84, vcc wave_shr:1 row_mask:0xf bank_mask:0xf
    v_cndmask_b32_dpp v85, v85, v85, vcc wave_shr:1 row_mask:0xf bank_mask:0xf
    s_lshr_b64 s[52:53], s[52:53], 1
    v_cndmask_b32_dpp v86, v86, v86, vcc wave_shr:1 row_mask:0xf bank_mask:0xf
    v_cndmask_b32_dpp v87, v87, v87, vcc wave_shr:1 row_mask:0xf bank_mask:0xf
    s_andn2_b64 s[82:83], s[82:83], s[52:53]
    v_cndmask_b32_dpp v7, v7, v7, vcc wave_shr:1 row_mask:0xf bank_mask:0xf
    s_mov_b64 exec, s[50:51]
    s_cbranch_scc0 L2_d123
    s_mov_b64 exec, s[82:83]
    s_nop 1
    v_mfma_f32_4x4x4_16b_bf16 v[88:91], v[12:13], v[84:85], 0
    s_nop 1
    v_mfma_f32_4x4x4_16b_bf16 v[88:91], v[10:11], v[86:87], v[88:91]
    s_nop 4
    v_cvt_pk_bf16_f32 v88, v88, v89
    v_cvt_pk_bf16_f32 v89, v90, v91
    ds_pk_add_bf16 v7, v88 offset:65408
    ds_pk_add_bf16 v7, v89 offset:65412
    s_mov_b64 exec, s[50:51]
    s_branch L2_d123
L2_c124:
    s_lshl_b64 s[52:53], s[82:83], 1
    s_andn2_b64 s[52:53], s[52:53], s[80:81]
    s_andn2_b64 s[52:53], s[52:53], s[54:55]
    s_or_b64 s[80:81], s[80:81], s[52:53]
    s_not_b64 vcc, s[52:53]
    s_mov_b64 exec, -1
    v_cndmask_b32_dpp v84, v84, v84, vcc wave_shr:1 row_mask:0xf bank_mask:0xf
    v_cndmask_b32_dpp v85, v85, v85, vcc wave_shr:1 row_mask:0xf bank_mask:0xf
    s_lshr_b64 s[52:53], s[52:53], 1
    v_cndmask_b32_dpp v86, v86, v86, vcc wave_shr:1 row_mask:0xf bank_mask:0xf
    v_cndmask_b32_dpp v87, v87, v87, vcc wave_shr:1 row_mask:0xf bank_mask:0xf
    s_andn2_b64 s[82:83], s[82:83], s[52:53]
    v_cndmask_b32_dpp v7, v7, v7, vcc wave_shr:1 row_mask:0xf bank_mask:0xf
    s_mov_b64 exec, s[54:55]
    s_cbranch_scc0 L2_d124
    s_mov_b64 exec, s[82:83]
    s_nop 1
    v_mfma_f32_4x4x4_16b_bf16 v[88:91], v[12:13], v[84:85], 0
    s_nop 1
    v_mfma_f32_4x4x4_16b_bf16 v[88:91], v[10:11], v[86:87], v[88:91]
    s_nop 4
    v_cvt_pk_bf16_f32 v88, v88, v89
    v_cvt_pk_bf16_f32 v89, v90, v91
    ds_pk_add_bf16 v7, v88 offset:65408
    ds_pk_add_bf16 v7, v89 offset:65412
    s_mov_b64 exec, s[54:55]
    s_branch L2_d124
L2_c125:
    s_lshl_b64 s[52:53], s[82:83], 1
    s_andn2_b64 s[52:53], s[52:53], s[80:81]
    s_andn2_b64 s[52:53], s[52:53], s[50:51]
    s_or_b64 s[80:81], s[80:81], s[52:53]
    s_not_b64 vcc, s[52:53]
    s_mov_b64 exec, -1
    v_cndmask_b32_dpp v84, v84, v84, vcc wave_shr:1 row_mask:0xf bank_mask:0xf
    v_cndmask_b32_dpp v85, v85, v85, vcc wave_shr:1 row_mask:0xf bank_mask:0xf
    s_lshr_b64 s[52:53], s[52:53], 1
    v_cndmask_b32_dpp v86, v86, v86, vcc wave_shr:1 row_mask:0xf bank_mask:0xf
    v_cndmask_b32_dpp v87, v87, v87, vcc wave_shr:1 row_mask:0xf bank_mask:0xf
    s_andn2_b64 s[82:83], s[82:83], s[52:53]
    v_cndmask_b32_dpp v7, v7, v7, vcc wave_shr:1 row_mask:0xf bank_mask:0xf
    s_mov_b64 exec, s[50:51]
    s_cbranch_scc0 L2_d125
    s_mov_b64 exec, s[82:83]
    s_nop 1
    v_mfma_f32_4x4x4_16b_bf16 v[88:91], v[12:13], v[84:85], 0
    s_nop 1
    v_mfma_f32_4x4x4_16b_bf16 v[88:91], v[10:11], v[86:87], v[88:91]
    s_nop 4
    v_cvt_pk_bf16_f32 v88, v88, v89
    v_cvt_pk_bf16_f32 v89, v90, v91
    ds_pk_add_bf16 v7, v88 offset:65408
    ds_pk_add_bf16 v7, v89 offset:65412
    s_mov_b64 exec, s[50:51]
    s_branch L2_d125
L2_c126:
    s_lshl_b64 s[52:53], s[82:83], 1
    s_andn2_b64 s[52:53], s[52:53], s[80:81]
    s_andn2_b64 s[52:53], s[52:53], s[54:55]
    s_or_b64 s[80:81], s[80:81], s[52:53]
    s_not_b64 vcc, s[52:53]
    s_mov_b64 exec, -1
    v_cndmask_b32_dpp v84, v84, v84, vcc wave_shr:1 row_mask:0xf bank_mask:0xf
    v_cndmask_b32_dpp v85, v85, v85, vcc wave_shr:1 row_mask:0xf bank_mask:0xf
    s_lshr_b64 s[52:53], s[52:53], 1
    v_cndmask_b32_dpp v86, v86, v86, vcc wave_shr:1 row_mask:0xf bank_mask:0xf
    v_cndmask_b32_dpp v87, v87, v87, vcc wave_shr:1 row_mask:0xf bank_mask:0xf
    s_andn2_b64 s[82:83], s[82:83], s[52:53]
    v_cndmask_b32_dpp v7, v7, v7, vcc wave_shr:1 row_mask:0xf bank_mask:0xf
    s_mov_b64 exec, s[54:55]
    s_cbranch_scc0 L2_d126
    s_mov_b64 exec, s[82:83]
    s_nop 1
    v_mfma_f32_4x4x4_16b_bf16 v[88:91], v[12:13], v[84:85], 0
    s_nop 1
    v_mfma_f32_4x4x4_16b_bf16 v[88:91], v[10:11], v[86:87], v[88:91]
    s_nop 4
    v_cvt_pk_bf16_f32 v88, v88, v89
    v_cvt_pk_bf16_f32 v89, v90, v91
    ds_pk_add_bf16 v7, v88 offset:65408
    ds_pk_add_bf16 v7, v89 offset:65412
    s_mov_b64 exec, s[54:55]
    s_branch L2_d126
L2_c127:
    s_lshl_b64 s[52:53], s[82:83], 1
    s_andn2_b64 s[52:53], s[52:53], s[80:81]
    s_andn2_b64 s[52:53], s[52:53], s[50:51]
    s_or_b64 s[80:81], s[80:81], s[52:53]
    s_not_b64 vcc, s[52:53]
    s_mov_b64 exec, -1
    v_cndmask_b32_dpp v84, v84, v84, vcc wave_shr:1 row_mask:0xf bank_mask:0xf
    v_cndmask_b32_dpp v85, v85, v85, vcc wave_shr:1 row_mask:0xf bank_mask:0xf
    s_lshr_b64 s[52:53], s[52:53], 1
    v_cndmask_b32_dpp v86, v86, v86, vcc wave_shr:1 row_mask:0xf bank_mask:0xf
    v_cndmask_b32_dpp v87, v87, v87, vcc wave_shr:1 row_mask:0xf bank_mask:0xf
    s_andn2_b64 s[82:83], s[82:83], s[52:53]
    v_cndmask_b32_dpp v7, v7, v7, vcc wave_shr:1 row_mask:0xf bank_mask:0xf
    s_mov_b64 exec, s[50:51]
    s_cbranch_scc0 L2_d127
    s_mov_b64 exec, s[82:83]
    s_nop 1
    v_mfma_f32_4x4x4_16b_bf16 v[88:91], v[12:13], v[84:85], 0
    s_nop 1
    v_mfma_f32_4x4x4_16b_bf16 v[88:91], v[10:11], v[86:87], v[88:91]
    s_nop 4
    v_cvt_pk_bf16_f32 v88, v88, v89
    v_cvt_pk_bf16_f32 v89, v90, v91
    ds_pk_add_bf16 v7, v88 offset:65408
    ds_pk_add_bf16 v7, v89 offset:65412
    s_mov_b64 exec, s[50:51]
    s_branch L2_d127
L2_c128:
    s_lshl_b64 s[52:53], s[82:83], 1
    s_andn2_b64 s[52:53], s[52:53], s[80:81]
    s_andn2_b64 s[52:53], s[52:53], s[54:55]
    s_or_b64 s[80:81], s[80:81], s[52:53]
    s_not_b64 vcc, s[52:53]
    s_mov_b64 exec, -1
    v_cndmask_b32_dpp v84, v84, v84, vcc wave_shr:1 row_mask:0xf bank_mask:0xf
    v_cndmask_b32_dpp v85, v85, v85, vcc wave_shr:1 row_mask:0xf bank_mask:0xf
    s_lshr_b64 s[52:53], s[52:53], 1
    v_cndmask_b32_dpp v86, v86, v86, vcc wave_shr:1 row_mask:0xf bank_mask:0xf
    v_cndmask_b32_dpp v87, v87, v87, vcc wave_shr:1 row_mask:0xf bank_mask:0xf
    s_andn2_b64 s[82:83], s[82:83], s[52:53]
    v_cndmask_b32_dpp v7, v7, v7, vcc wave_shr:1 row_mask:0xf bank_mask:0xf
    s_mov_b64 exec, s[54:55]
    s_cbranch_scc0 L2_d128
    s_mov_b64 exec, s[82:83]
    s_nop 1
    v_mfma_f32_4x4x4_16b_bf16 v[88:91], v[12:13], v[84:85], 0
    s_nop 1
    v_mfma_f32_4x4x4_16b_bf16 v[88:91], v[10:11], v[86:87], v[88:91]
    s_nop 4
    v_cvt_pk_bf16_f32 v88, v88, v89
    v_cvt_pk_bf16_f32 v89, v90, v91
    ds_pk_add_bf16 v7, v88 offset:65408
    ds_pk_add_bf16 v7, v89 offset:65412
    s_mov_b64 exec, s[54:55]
    s_branch L2_d128
L2_c129:
    s_lshl_b64 s[52:53], s[82:83], 1
    s_andn2_b64 s[52:53], s[52:53], s[80:81]
    s_andn2_b64 s[52:53], s[52:53], s[50:51]
    s_or_b64 s[80:81], s[80:81], s[52:53]
    s_not_b64 vcc, s[52:53]
    s_mov_b64 exec, -1
    v_cndmask_b32_dpp v84, v84, v84, vcc wave_shr:1 row_mask:0xf bank_mask:0xf
    v_cndmask_b32_dpp v85, v85, v85, vcc wave_shr:1 row_mask:0xf bank_mask:0xf
    s_lshr_b64 s[52:53], s[52:53], 1
    v_cndmask_b32_dpp v86, v86, v86, vcc wave_shr:1 row_mask:0xf bank_mask:0xf
    v_cndmask_b32_dpp v87, v87, v87, vcc wave_shr:1 row_mask:0xf bank_mask:0xf
    s_andn2_b64 s[82:83], s[82:83], s[52:53]
    v_cndmask_b32_dpp v7, v7, v7, vcc wave_shr:1 row_mask:0xf bank_mask:0xf
    s_mov_b64 exec, s[50:51]
    s_cbranch_scc0 L2_d129
    s_mov_b64 exec, s[82:83]
    s_nop 1
    v_mfma_f32_4x4x4_16b_bf16 v[88:91], v[12:13], v[84:85], 0
    s_nop 1
    v_mfma_f32_4x4x4_16b_bf16 v[88:91], v[10:11], v[86:87], v[88:91]
    s_nop 4
    v_cvt_pk_bf16_f32 v88, v88, v89
    v_cvt_pk_bf16_f32 v89, v90, v91
    ds_pk_add_bf16 v7, v88 offset:65408
    ds_pk_add_bf16 v7, v89 offset:65412
    s_mov_b64 exec, s[50:51]
    s_branch L2_d129
L2_c130:
    s_lshl_b64 s[52:53], s[82:83], 1
    s_andn2_b64 s[52:53], s[52:53], s[80:81]
    s_andn2_b64 s[52:53], s[52:53], s[54:55]
    s_or_b64 s[80:81], s[80:81], s[52:53]
    s_not_b64 vcc, s[52:53]
    s_mov_b64 exec, -1
    v_cndmask_b32_dpp v84, v84, v84, vcc wave_shr:1 row_mask:0xf bank_mask:0xf
    v_cndmask_b32_dpp v85, v85, v85, vcc wave_shr:1 row_mask:0xf bank_mask:0xf
    s_lshr_b64 s[52:53], s[52:53], 1
    v_cndmask_b32_dpp v86, v86, v86, vcc wave_shr:1 row_mask:0xf bank_mask:0xf
    v_cndmask_b32_dpp v87, v87, v87, vcc wave_shr:1 row_mask:0xf bank_mask:0xf
    s_andn2_b64 s[82:83], s[82:83], s[52:53]
    v_cndmask_b32_dpp v7, v7, v7, vcc wave_shr:1 row_mask:0xf bank_mask:0xf
    s_mov_b64 exec, s[54:55]
    s_cbranch_scc0 L2_d130
    s_mov_b64 exec, s[82:83]
    s_nop 1
    v_mfma_f32_4x4x4_16b_bf16 v[88:91], v[12:13], v[84:85], 0
    s_nop 1
    v_mfma_f32_4x4x4_16b_bf16 v[88:91], v[10:11], v[86:87], v[88:91]
    s_nop 4
    v_cvt_pk_bf16_f32 v88, v88, v89
    v_cvt_pk_bf16_f32 v89, v90, v91
    ds_pk_add_bf16 v7, v88 offset:65408
    ds_pk_add_bf16 v7, v89 offset:65412
    s_mov_b64 exec, s[54:55]
    s_branch L2_d130
L2_c131:
    s_lshl_b64 s[52:53], s[82:83], 1
    s_andn2_b64 s[52:53], s[52:53], s[80:81]
    s_andn2_b64 s[52:53], s[52:53], s[50:51]
    s_or_b64 s[80:81], s[80:81], s[52:53]
    s_not_b64 vcc, s[52:53]
    s_mov_b64 exec, -1
    v_cndmask_b32_dpp v84, v84, v84, vcc wave_shr:1 row_mask:0xf bank_mask:0xf
    v_cndmask_b32_dpp v85, v85, v85, vcc wave_shr:1 row_mask:0xf bank_mask:0xf
    s_lshr_b64 s[52:53], s[52:53], 1
    v_cndmask_b32_dpp v86, v86, v86, vcc wave_shr:1 row_mask:0xf bank_mask:0xf
    v_cndmask_b32_dpp v87, v87, v87, vcc wave_shr:1 row_mask:0xf bank_mask:0xf
    s_andn2_b64 s[82:83], s[82:83], s[52:53]
    v_cndmask_b32_dpp v7, v7, v7, vcc wave_shr:1 row_mask:0xf bank_mask:0xf
    s_mov_b64 exec, s[50:51]
    s_cbranch_scc0 L2_d131
    s_mov_b64 exec, s[82:83]
    s_nop 1
    v_mfma_f32_4x4x4_16b_bf16 v[88:91], v[12:13], v[84:85], 0
    s_nop 1
    v_mfma_f32_4x4x4_16b_bf16 v[88:91], v[10:11], v[86:87], v[88:91]
    s_nop 4
    v_cvt_pk_bf16_f32 v88, v88, v89
    v_cvt_pk_bf16_f32 v89, v90, v91
    ds_pk_add_bf16 v7, v88 offset:65408
    ds_pk_add_bf16 v7, v89 offset:65412
    s_mov_b64 exec, s[50:51]
    s_branch L2_d131
L2_c132:
    s_lshl_b64 s[52:53], s[82:83], 1
    s_andn2_b64 s[52:53], s[52:53], s[80:81]
    s_andn2_b64 s[52:53], s[52:53], s[54:55]
    s_or_b64 s[80:81], s[80:81], s[52:53]
    s_not_b64 vcc, s[52:53]
    s_mov_b64 exec, -1
    v_cndmask_b32_dpp v84, v84, v84, vcc wave_shr:1 row_mask:0xf bank_mask:0xf
    v_cndmask_b32_dpp v85, v85, v85, vcc wave_shr:1 row_mask:0xf bank_mask:0xf
    s_lshr_b64 s[52:53], s[52:53], 1
    v_cndmask_b32_dpp v86, v86, v86, vcc wave_shr:1 row_mask:0xf bank_mask:0xf
    v_cndmask_b32_dpp v87, v87, v87, vcc wave_shr:1 row_mask:0xf bank_mask:0xf
    s_andn2_b64 s[82:83], s[82:83], s[52:53]
    v_cndmask_b32_dpp v7, v7, v7, vcc wave_shr:1 row_mask:0xf bank_mask:0xf
    s_mov_b64 exec, s[54:55]
    s_cbranch_scc0 L2_d132
    s_mov_b64 exec, s[82:83]
    s_nop 1
    v_mfma_f32_4x4x4_16b_bf16 v[88:91], v[12:13], v[84:85], 0
    s_nop 1
    v_mfma_f32_4x4x4_16b_bf16 v[88:91], v[10:11], v[86:87], v[88:91]
    s_nop 4
    v_cvt_pk_bf16_f32 v88, v88, v89
    v_cvt_pk_bf16_f32 v89, v90, v91
    ds_pk_add_bf16 v7, v88 offset:65408
    ds_pk_add_bf16 v7, v89 offset:65412
    s_mov_b64 exec, s[54:55]
    s_branch L2_d132
L2_c133:
    s_lshl_b64 s[52:53], s[82:83], 1
    s_andn2_b64 s[52:53], s[52:53], s[80:81]
    s_andn2_b64 s[52:53], s[52:53], s[50:51]
    s_or_b64 s[80:81], s[80:81], s[52:53]
    s_not_b64 vcc, s[52:53]
    s_mov_b64 exec, -1
    v_cndmask_b32_dpp v84, v84, v84, vcc wave_shr:1 row_mask:0xf bank_mask:0xf
    v_cndmask_b32_dpp v85, v85, v85, vcc wave_shr:1 row_mask:0xf bank_mask:0xf
    s_lshr_b64 s[52:53], s[52:53], 1
    v_cndmask_b32_dpp v86, v86, v86, vcc wave_shr:1 row_mask:0xf bank_mask:0xf
    v_cndmask_b32_dpp v87, v87, v87, vcc wave_shr:1 row_mask:0xf bank_mask:0xf
    s_andn2_b64 s[82:83], s[82:83], s[52:53]
    v_cndmask_b32_dpp v7, v7, v7, vcc wave_shr:1 row_mask:0xf bank_mask:0xf
    s_mov_b64 exec, s[50:51]
    s_cbranch_scc0 L2_d133
    s_mov_b64 exec, s[82:83]
    s_nop 1
    v_mfma_f32_4x4x4_16b_bf16 v[88:91], v[12:13], v[84:85], 0
    s_nop 1
    v_mfma_f32_4x4x4_16b_bf16 v[88:91], v[10:11], v[86:87], v[88:91]
    s_nop 4
    v_cvt_pk_bf16_f32 v88, v88, v89
    v_cvt_pk_bf16_f32 v89, v90, v91
    ds_pk_add_bf16 v7, v88 offset:65408
    ds_pk_add_bf16 v7, v89 offset:65412
    s_mov_b64 exec, s[50:51]
    s_branch L2_d133
L2_c134:
    s_lshl_b64 s[52:53], s[82:83], 1
    s_andn2_b64 s[52:53], s[52:53], s[80:81]
    s_andn2_b64 s[52:53], s[52:53], s[54:55]
    s_or_b64 s[80:81], s[80:81], s[52:53]
    s_not_b64 vcc, s[52:53]
    s_mov_b64 exec, -1
    v_cndmask_b32_dpp v84, v84, v84, vcc wave_shr:1 row_mask:0xf bank_mask:0xf
    v_cndmask_b32_dpp v85, v85, v85, vcc wave_shr:1 row_mask:0xf bank_mask:0xf
    s_lshr_b64 s[52:53], s[52:53], 1
    v_cndmask_b32_dpp v86, v86, v86, vcc wave_shr:1 row_mask:0xf bank_mask:0xf
    v_cndmask_b32_dpp v87, v87, v87, vcc wave_shr:1 row_mask:0xf bank_mask:0xf
    s_andn2_b64 s[82:83], s[82:83], s[52:53]
    v_cndmask_b32_dpp v7, v7, v7, vcc wave_shr:1 row_mask:0xf bank_mask:0xf
    s_mov_b64 exec, s[54:55]
    s_cbranch_scc0 L2_d134
    s_mov_b64 exec, s[82:83]
    s_nop 1
    v_mfma_f32_4x4x4_16b_bf16 v[88:91], v[12:13], v[84:85], 0
    s_nop 1
    v_mfma_f32_4x4x4_16b_bf16 v[88:91], v[10:11], v[86:87], v[88:91]
    s_nop 4
    v_cvt_pk_bf16_f32 v88, v88, v89
    v_cvt_pk_bf16_f32 v89, v90, v91
    ds_pk_add_bf16 v7, v88 offset:65408
    ds_pk_add_bf16 v7, v89 offset:65412
    s_mov_b64 exec, s[54:55]
    s_branch L2_d134
L2_c135:
    s_lshl_b64 s[52:53], s[82:83], 1
    s_andn2_b64 s[52:53], s[52:53], s[80:81]
    s_andn2_b64 s[52:53], s[52:53], s[50:51]
    s_or_b64 s[80:81], s[80:81], s[52:53]
    s_not_b64 vcc, s[52:53]
    s_mov_b64 exec, -1
    v_cndmask_b32_dpp v84, v84, v84, vcc wave_shr:1 row_mask:0xf bank_mask:0xf
    v_cndmask_b32_dpp v85, v85, v85, vcc wave_shr:1 row_mask:0xf bank_mask:0xf
    s_lshr_b64 s[52:53], s[52:53], 1
    v_cndmask_b32_dpp v86, v86, v86, vcc wave_shr:1 row_mask:0xf bank_mask:0xf
    v_cndmask_b32_dpp v87, v87, v87, vcc wave_shr:1 row_mask:0xf bank_mask:0xf
    s_andn2_b64 s[82:83], s[82:83], s[52:53]
    v_cndmask_b32_dpp v7, v7, v7, vcc wave_shr:1 row_mask:0xf bank_mask:0xf
    s_mov_b64 exec, s[50:51]
    s_cbranch_scc0 L2_d135
    s_mov_b64 exec, s[82:83]
    s_nop 1
    v_mfma_f32_4x4x4_16b_bf16 v[88:91], v[12:13], v[84:85], 0
    s_nop 1
    v_mfma_f32_4x4x4_16b_bf16 v[88:91], v[10:11], v[86:87], v[88:91]
    s_nop 4
    v_cvt_pk_bf16_f32 v88, v88, v89
    v_cvt_pk_bf16_f32 v89, v90, v91
    ds_pk_add_bf16 v7, v88 offset:65408
    ds_pk_add_bf16 v7, v89 offset:65412
    s_mov_b64 exec, s[50:51]
    s_branch L2_d135
L2_c136:
    s_lshl_b64 s[52:53], s[82:83], 1
    s_andn2_b64 s[52:53], s[52:53], s[80:81]
    s_andn2_b64 s[52:53], s[52:53], s[54:55]
    s_or_b64 s[80:81], s[80:81], s[52:53]
    s_not_b64 vcc, s[52:53]
    s_mov_b64 exec, -1
    v_cndmask_b32_dpp v84, v84, v84, vcc wave_shr:1 row_mask:0xf bank_mask:0xf
    v_cndmask_b32_dpp v85, v85, v85, vcc wave_shr:1 row_mask:0xf bank_mask:0xf
    s_lshr_b64 s[52:53], s[52:53], 1
    v_cndmask_b32_dpp v86, v86, v86, vcc wave_shr:1 row_mask:0xf bank_mask:0xf
    v_cndmask_b32_dpp v87, v87, v87, vcc wave_shr:1 row_mask:0xf bank_mask:0xf
    s_andn2_b64 s[82:83], s[82:83], s[52:53]
    v_cndmask_b32_dpp v7, v7, v7, vcc wave_shr:1 row_mask:0xf bank_mask:0xf
    s_mov_b64 exec, s[54:55]
    s_cbranch_scc0 L2_d136
    s_mov_b64 exec, s[82:83]
    s_nop 1
    v_mfma_f32_4x4x4_16b_bf16 v[88:91], v[12:13], v[84:85], 0
    s_nop 1
    v_mfma_f32_4x4x4_16b_bf16 v[88:91], v[10:11], v[86:87], v[88:91]
    s_nop 4
    v_cvt_pk_bf16_f32 v88, v88, v89
    v_cvt_pk_bf16_f32 v89, v90, v91
    ds_pk_add_bf16 v7, v88 offset:65408
    ds_pk_add_bf16 v7, v89 offset:65412
    s_mov_b64 exec, s[54:55]
    s_branch L2_d136
L2_c137:
    s_lshl_b64 s[52:53], s[82:83], 1
    s_andn2_b64 s[52:53], s[52:53], s[80:81]
    s_andn2_b64 s[52:53], s[52:53], s[50:51]
    s_or_b64 s[80:81], s[80:81], s[52:53]
    s_not_b64 vcc, s[52:53]
    s_mov_b64 exec, -1
    v_cndmask_b32_dpp v84, v84, v84, vcc wave_shr:1 row_mask:0xf bank_mask:0xf
    v_cndmask_b32_dpp v85, v85, v85, vcc wave_shr:1 row_mask:0xf bank_mask:0xf
    s_lshr_b64 s[52:53], s[52:53], 1
    v_cndmask_b32_dpp v86, v86, v86, vcc wave_shr:1 row_mask:0xf bank_mask:0xf
    v_cndmask_b32_dpp v87, v87, v87, vcc wave_shr:1 row_mask:0xf bank_mask:0xf
    s_andn2_b64 s[82:83], s[82:83], s[52:53]
    v_cndmask_b32_dpp v7, v7, v7, vcc wave_shr:1 row_mask:0xf bank_mask:0xf
    s_mov_b64 exec, s[50:51]
    s_cbranch_scc0 L2_d137
    s_mov_b64 exec, s[82:83]
    s_nop 1
    v_mfma_f32_4x4x4_16b_bf16 v[88:91], v[12:13], v[84:85], 0
    s_nop 1
    v_mfma_f32_4x4x4_16b_bf16 v[88:91], v[10:11], v[86:87], v[88:91]
    s_nop 4
    v_cvt_pk_bf16_f32 v88, v88, v89
    v_cvt_pk_bf16_f32 v89, v90, v91
    ds_pk_add_bf16 v7, v88 offset:65408
    ds_pk_add_bf16 v7, v89 offset:65412
    s_mov_b64 exec, s[50:51]
    s_branch L2_d137
L2_c138:
    s_lshl_b64 s[52:53], s[82:83], 1
    s_andn2_b64 s[52:53], s[52:53], s[80:81]
    s_andn2_b64 s[52:53], s[52:53], s[54:55]
    s_or_b64 s[80:81], s[80:81], s[52:53]
    s_not_b64 vcc, s[52:53]
    s_mov_b64 exec, -1
    v_cndmask_b32_dpp v84, v84, v84, vcc wave_shr:1 row_mask:0xf bank_mask:0xf
    v_cndmask_b32_dpp v85, v85, v85, vcc wave_shr:1 row_mask:0xf bank_mask:0xf
    s_lshr_b64 s[52:53], s[52:53], 1
    v_cndmask_b32_dpp v86, v86, v86, vcc wave_shr:1 row_mask:0xf bank_mask:0xf
    v_cndmask_b32_dpp v87, v87, v87, vcc wave_shr:1 row_mask:0xf bank_mask:0xf
    s_andn2_b64 s[82:83], s[82:83], s[52:53]
    v_cndmask_b32_dpp v7, v7, v7, vcc wave_shr:1 row_mask:0xf bank_mask:0xf
    s_mov_b64 exec, s[54:55]
    s_cbranch_scc0 L2_d138
    s_mov_b64 exec, s[82:83]
    s_nop 1
    v_mfma_f32_4x4x4_16b_bf16 v[88:91], v[12:13], v[84:85], 0
    s_nop 1
    v_mfma_f32_4x4x4_16b_bf16 v[88:91], v[10:11], v[86:87], v[88:91]
    s_nop 4
    v_cvt_pk_bf16_f32 v88, v88, v89
    v_cvt_pk_bf16_f32 v89, v90, v91
    ds_pk_add_bf16 v7, v88 offset:65408
    ds_pk_add_bf16 v7, v89 offset:65412
    s_mov_b64 exec, s[54:55]
    s_branch L2_d138
L2_c139:
    s_lshl_b64 s[52:53], s[82:83], 1
    s_andn2_b64 s[52:53], s[52:53], s[80:81]
    s_andn2_b64 s[52:53], s[52:53], s[50:51]
    s_or_b64 s[80:81], s[80:81], s[52:53]
    s_not_b64 vcc, s[52:53]
    s_mov_b64 exec, -1
    v_cndmask_b32_dpp v84, v84, v84, vcc wave_shr:1 row_mask:0xf bank_mask:0xf
    v_cndmask_b32_dpp v85, v85, v85, vcc wave_shr:1 row_mask:0xf bank_mask:0xf
    s_lshr_b64 s[52:53], s[52:53], 1
    v_cndmask_b32_dpp v86, v86, v86, vcc wave_shr:1 row_mask:0xf bank_mask:0xf
    v_cndmask_b32_dpp v87, v87, v87, vcc wave_shr:1 row_mask:0xf bank_mask:0xf
    s_andn2_b64 s[82:83], s[82:83], s[52:53]
    v_cndmask_b32_dpp v7, v7, v7, vcc wave_shr:1 row_mask:0xf bank_mask:0xf
    s_mov_b64 exec, s[50:51]
    s_cbranch_scc0 L2_d139
    s_mov_b64 exec, s[82:83]
    s_nop 1
    v_mfma_f32_4x4x4_16b_bf16 v[88:91], v[12:13], v[84:85], 0
    s_nop 1
    v_mfma_f32_4x4x4_16b_bf16 v[88:91], v[10:11], v[86:87], v[88:91]
    s_nop 4
    v_cvt_pk_bf16_f32 v88, v88, v89
    v_cvt_pk_bf16_f32 v89, v90, v91
    ds_pk_add_bf16 v7, v88 offset:65408
    ds_pk_add_bf16 v7, v89 offset:65412
    s_mov_b64 exec, s[50:51]
    s_branch L2_d139
L2_c140:
    s_lshl_b64 s[52:53], s[82:83], 1
    s_andn2_b64 s[52:53], s[52:53], s[80:81]
    s_andn2_b64 s[52:53], s[52:53], s[54:55]
    s_or_b64 s[80:81], s[80:81], s[52:53]
    s_not_b64 vcc, s[52:53]
    s_mov_b64 exec, -1
    v_cndmask_b32_dpp v84, v84, v84, vcc wave_shr:1 row_mask:0xf bank_mask:0xf
    v_cndmask_b32_dpp v85, v85, v85, vcc wave_shr:1 row_mask:0xf bank_mask:0xf
    s_lshr_b64 s[52:53], s[52:53], 1
    v_cndmask_b32_dpp v86, v86, v86, vcc wave_shr:1 row_mask:0xf bank_mask:0xf
    v_cndmask_b32_dpp v87, v87, v87, vcc wave_shr:1 row_mask:0xf bank_mask:0xf
    s_andn2_b64 s[82:83], s[82:83], s[52:53]
    v_cndmask_b32_dpp v7, v7, v7, vcc wave_shr:1 row_mask:0xf bank_mask:0xf
    s_mov_b64 exec, s[54:55]
    s_cbranch_scc0 L2_d140
    s_mov_b64 exec, s[82:83]
    s_nop 1
    v_mfma_f32_4x4x4_16b_bf16 v[88:91], v[12:13], v[84:85], 0
    s_nop 1
    v_mfma_f32_4x4x4_16b_bf16 v[88:91], v[10:11], v[86:87], v[88:91]
    s_nop 4
    v_cvt_pk_bf16_f32 v88, v88, v89
    v_cvt_pk_bf16_f32 v89, v90, v91
    ds_pk_add_bf16 v7, v88 offset:65408
    ds_pk_add_bf16 v7, v89 offset:65412
    s_mov_b64 exec, s[54:55]
    s_branch L2_d140
L2_c141:
    s_lshl_b64 s[52:53], s[82:83], 1
    s_andn2_b64 s[52:53], s[52:53], s[80:81]
    s_andn2_b64 s[52:53], s[52:53], s[50:51]
    s_or_b64 s[80:81], s[80:81], s[52:53]
    s_not_b64 vcc, s[52:53]
    s_mov_b64 exec, -1
    v_cndmask_b32_dpp v84, v84, v84, vcc wave_shr:1 row_mask:0xf bank_mask:0xf
    v_cndmask_b32_dpp v85, v85, v85, vcc wave_shr:1 row_mask:0xf bank_mask:0xf
    s_lshr_b64 s[52:53], s[52:53], 1
    v_cndmask_b32_dpp v86, v86, v86, vcc wave_shr:1 row_mask:0xf bank_mask:0xf
    v_cndmask_b32_dpp v87, v87, v87, vcc wave_shr:1 row_mask:0xf bank_mask:0xf
    s_andn2_b64 s[82:83], s[82:83], s[52:53]
    v_cndmask_b32_dpp v7, v7, v7, vcc wave_shr:1 row_mask:0xf bank_mask:0xf
    s_mov_b64 exec, s[50:51]
    s_cbranch_scc0 L2_d141
    s_mov_b64 exec, s[82:83]
    s_nop 1
    v_mfma_f32_4x4x4_16b_bf16 v[88:91], v[12:13], v[84:85], 0
    s_nop 1
    v_mfma_f32_4x4x4_16b_bf16 v[88:91], v[10:11], v[86:87], v[88:91]
    s_nop 4
    v_cvt_pk_bf16_f32 v88, v88, v89
    v_cvt_pk_bf16_f32 v89, v90, v91
    ds_pk_add_bf16 v7, v88 offset:65408
    ds_pk_add_bf16 v7, v89 offset:65412
    s_mov_b64 exec, s[50:51]
    s_branch L2_d141
L2_c142:
    s_lshl_b64 s[52:53], s[82:83], 1
    s_andn2_b64 s[52:53], s[52:53], s[80:81]
    s_andn2_b64 s[52:53], s[52:53], s[54:55]
    s_or_b64 s[80:81], s[80:81], s[52:53]
    s_not_b64 vcc, s[52:53]
    s_mov_b64 exec, -1
    v_cndmask_b32_dpp v84, v84, v84, vcc wave_shr:1 row_mask:0xf bank_mask:0xf
    v_cndmask_b32_dpp v85, v85, v85, vcc wave_shr:1 row_mask:0xf bank_mask:0xf
    s_lshr_b64 s[52:53], s[52:53], 1
    v_cndmask_b32_dpp v86, v86, v86, vcc wave_shr:1 row_mask:0xf bank_mask:0xf
    v_cndmask_b32_dpp v87, v87, v87, vcc wave_shr:1 row_mask:0xf bank_mask:0xf
    s_andn2_b64 s[82:83], s[82:83], s[52:53]
    v_cndmask_b32_dpp v7, v7, v7, vcc wave_shr:1 row_mask:0xf bank_mask:0xf
    s_mov_b64 exec, s[54:55]
    s_cbranch_scc0 L2_d142
    s_mov_b64 exec, s[82:83]
    s_nop 1
    v_mfma_f32_4x4x4_16b_bf16 v[88:91], v[12:13], v[84:85], 0
    s_nop 1
    v_mfma_f32_4x4x4_16b_bf16 v[88:91], v[10:11], v[86:87], v[88:91]
    s_nop 4
    v_cvt_pk_bf16_f32 v88, v88, v89
    v_cvt_pk_bf16_f32 v89, v90, v91
    ds_pk_add_bf16 v7, v88 offset:65408
    ds_pk_add_bf16 v7, v89 offset:65412
    s_mov_b64 exec, s[54:55]
    s_branch L2_d142
L2_c143:
    s_lshl_b64 s[52:53], s[82:83], 1
    s_andn2_b64 s[52:53], s[52:53], s[80:81]
    s_andn2_b64 s[52:53], s[52:53], s[50:51]
    s_or_b64 s[80:81], s[80:81], s[52:53]
    s_not_b64 vcc, s[52:53]
    s_mov_b64 exec, -1
    v_cndmask_b32_dpp v84, v84, v84, vcc wave_shr:1 row_mask:0xf bank_mask:0xf
    v_cndmask_b32_dpp v85, v85, v85, vcc wave_shr:1 row_mask:0xf bank_mask:0xf
    s_lshr_b64 s[52:53], s[52:53], 1
    v_cndmask_b32_dpp v86, v86, v86, vcc wave_shr:1 row_mask:0xf bank_mask:0xf
    v_cndmask_b32_dpp v87, v87, v87, vcc wave_shr:1 row_mask:0xf bank_mask:0xf
    s_andn2_b64 s[82:83], s[82:83], s[52:53]
    v_cndmask_b32_dpp v7, v7, v7, vcc wave_shr:1 row_mask:0xf bank_mask:0xf
    s_mov_b64 exec, s[50:51]
    s_cbranch_scc0 L2_d143
    s_mov_b64 exec, s[82:83]
    s_nop 1
    v_mfma_f32_4x4x4_16b_bf16 v[88:91], v[12:13], v[84:85], 0
    s_nop 1
    v_mfma_f32_4x4x4_16b_bf16 v[88:91], v[10:11], v[86:87], v[88:91]
    s_nop 4
    v_cvt_pk_bf16_f32 v88, v88, v89
    v_cvt_pk_bf16_f32 v89, v90, v91
    ds_pk_add_bf16 v7, v88 offset:65408
    ds_pk_add_bf16 v7, v89 offset:65412
    s_mov_b64 exec, s[50:51]
    s_branch L2_d143
L2_c144:
    s_lshl_b64 s[52:53], s[82:83], 1
    s_andn2_b64 s[52:53], s[52:53], s[80:81]
    s_andn2_b64 s[52:53], s[52:53], s[54:55]
    s_or_b64 s[80:81], s[80:81], s[52:53]
    s_not_b64 vcc, s[52:53]
    s_mov_b64 exec, -1
    v_cndmask_b32_dpp v84, v84, v84, vcc wave_shr:1 row_mask:0xf bank_mask:0xf
    v_cndmask_b32_dpp v85, v85, v85, vcc wave_shr:1 row_mask:0xf bank_mask:0xf
    s_lshr_b64 s[52:53], s[52:53], 1
    v_cndmask_b32_dpp v86, v86, v86, vcc wave_shr:1 row_mask:0xf bank_mask:0xf
    v_cndmask_b32_dpp v87, v87, v87, vcc wave_shr:1 row_mask:0xf bank_mask:0xf
    s_andn2_b64 s[82:83], s[82:83], s[52:53]
    v_cndmask_b32_dpp v7, v7, v7, vcc wave_shr:1 row_mask:0xf bank_mask:0xf
    s_mov_b64 exec, s[54:55]
    s_cbranch_scc0 L2_d144
    s_mov_b64 exec, s[82:83]
    s_nop 1
    v_mfma_f32_4x4x4_16b_bf16 v[88:91], v[12:13], v[84:85], 0
    s_nop 1
    v_mfma_f32_4x4x4_16b_bf16 v[88:91], v[10:11], v[86:87], v[88:91]
    s_nop 4
    v_cvt_pk_bf16_f32 v88, v88, v89
    v_cvt_pk_bf16_f32 v89, v90, v91
    ds_pk_add_bf16 v7, v88 offset:65408
    ds_pk_add_bf16 v7, v89 offset:65412
    s_mov_b64 exec, s[54:55]
    s_branch L2_d144
L2_c145:
    s_lshl_b64 s[52:53], s[82:83], 1
    s_andn2_b64 s[52:53], s[52:53], s[80:81]
    s_andn2_b64 s[52:53], s[52:53], s[50:51]
    s_or_b64 s[80:81], s[80:81], s[52:53]
    s_not_b64 vcc, s[52:53]
    s_mov_b64 exec, -1
    v_cndmask_b32_dpp v84, v84, v84, vcc wave_shr:1 row_mask:0xf bank_mask:0xf
    v_cndmask_b32_dpp v85, v85, v85, vcc wave_shr:1 row_mask:0xf bank_mask:0xf
    s_lshr_b64 s[52:53], s[52:53], 1
    v_cndmask_b32_dpp v86, v86, v86, vcc wave_shr:1 row_mask:0xf bank_mask:0xf
    v_cndmask_b32_dpp v87, v87, v87, vcc wave_shr:1 row_mask:0xf bank_mask:0xf
    s_andn2_b64 s[82:83], s[82:83], s[52:53]
    v_cndmask_b32_dpp v7, v7, v7, vcc wave_shr:1 row_mask:0xf bank_mask:0xf
    s_mov_b64 exec, s[50:51]
    s_cbranch_scc0 L2_d145
    s_mov_b64 exec, s[82:83]
    s_nop 1
    v_mfma_f32_4x4x4_16b_bf16 v[88:91], v[12:13], v[84:85], 0
    s_nop 1
    v_mfma_f32_4x4x4_16b_bf16 v[88:91], v[10:11], v[86:87], v[88:91]
    s_nop 4
    v_cvt_pk_bf16_f32 v88, v88, v89
    v_cvt_pk_bf16_f32 v89, v90, v91
    ds_pk_add_bf16 v7, v88 offset:65408
    ds_pk_add_bf16 v7, v89 offset:65412
    s_mov_b64 exec, s[50:51]
    s_branch L2_d145
L2_c146:
    s_lshl_b64 s[52:53], s[82:83], 1
    s_andn2_b64 s[52:53], s[52:53], s[80:81]
    s_andn2_b64 s[52:53], s[52:53], s[54:55]
    s_or_b64 s[80:81], s[80:81], s[52:53]
    s_not_b64 vcc, s[52:53]
    s_mov_b64 exec, -1
    v_cndmask_b32_dpp v84, v84, v84, vcc wave_shr:1 row_mask:0xf bank_mask:0xf
    v_cndmask_b32_dpp v85, v85, v85, vcc wave_shr:1 row_mask:0xf bank_mask:0xf
    s_lshr_b64 s[52:53], s[52:53], 1
    v_cndmask_b32_dpp v86, v86, v86, vcc wave_shr:1 row_mask:0xf bank_mask:0xf
    v_cndmask_b32_dpp v87, v87, v87, vcc wave_shr:1 row_mask:0xf bank_mask:0xf
    s_andn2_b64 s[82:83], s[82:83], s[52:53]
    v_cndmask_b32_dpp v7, v7, v7, vcc wave_shr:1 row_mask:0xf bank_mask:0xf
    s_mov_b64 exec, s[54:55]
    s_cbranch_scc0 L2_d146
    s_mov_b64 exec, s[82:83]
    s_nop 1
    v_mfma_f32_4x4x4_16b_bf16 v[88:91], v[12:13], v[84:85], 0
    s_nop 1
    v_mfma_f32_4x4x4_16b_bf16 v[88:91], v[10:11], v[86:87], v[88:91]
    s_nop 4
    v_cvt_pk_bf16_f32 v88, v88, v89
    v_cvt_pk_bf16_f32 v89, v90, v91
    ds_pk_add_bf16 v7, v88 offset:65408
    ds_pk_add_bf16 v7, v89 offset:65412
    s_mov_b64 exec, s[54:55]
    s_branch L2_d146
L2_c147:
    s_lshl_b64 s[52:53], s[82:83], 1
    s_andn2_b64 s[52:53], s[52:53], s[80:81]
    s_andn2_b64 s[52:53], s[52:53], s[50:51]
    s_or_b64 s[80:81], s[80:81], s[52:53]
    s_not_b64 vcc, s[52:53]
    s_mov_b64 exec, -1
    v_cndmask_b32_dpp v84, v84, v84, vcc wave_shr:1 row_mask:0xf bank_mask:0xf
    v_cndmask_b32_dpp v85, v85, v85, vcc wave_shr:1 row_mask:0xf bank_mask:0xf
    s_lshr_b64 s[52:53], s[52:53], 1
    v_cndmask_b32_dpp v86, v86, v86, vcc wave_shr:1 row_mask:0xf bank_mask:0xf
    v_cndmask_b32_dpp v87, v87, v87, vcc wave_shr:1 row_mask:0xf bank_mask:0xf
    s_andn2_b64 s[82:83], s[82:83], s[52:53]
    v_cndmask_b32_dpp v7, v7, v7, vcc wave_shr:1 row_mask:0xf bank_mask:0xf
    s_mov_b64 exec, s[50:51]
    s_cbranch_scc0 L2_d147
    s_mov_b64 exec, s[82:83]
    s_nop 1
    v_mfma_f32_4x4x4_16b_bf16 v[88:91], v[12:13], v[84:85], 0
    s_nop 1
    v_mfma_f32_4x4x4_16b_bf16 v[88:91], v[10:11], v[86:87], v[88:91]
    s_nop 4
    v_cvt_pk_bf16_f32 v88, v88, v89
    v_cvt_pk_bf16_f32 v89, v90, v91
    ds_pk_add_bf16 v7, v88 offset:65408
    ds_pk_add_bf16 v7, v89 offset:65412
    s_mov_b64 exec, s[50:51]
    s_branch L2_d147
L2_c148:
    s_lshl_b64 s[52:53], s[82:83], 1
    s_andn2_b64 s[52:53], s[52:53], s[80:81]
    s_andn2_b64 s[52:53], s[52:53], s[54:55]
    s_or_b64 s[80:81], s[80:81], s[52:53]
    s_not_b64 vcc, s[52:53]
    s_mov_b64 exec, -1
    v_cndmask_b32_dpp v84, v84, v84, vcc wave_shr:1 row_mask:0xf bank_mask:0xf
    v_cndmask_b32_dpp v85, v85, v85, vcc wave_shr:1 row_mask:0xf bank_mask:0xf
    s_lshr_b64 s[52:53], s[52:53], 1
    v_cndmask_b32_dpp v86, v86, v86, vcc wave_shr:1 row_mask:0xf bank_mask:0xf
    v_cndmask_b32_dpp v87, v87, v87, vcc wave_shr:1 row_mask:0xf bank_mask:0xf
    s_andn2_b64 s[82:83], s[82:83], s[52:53]
    v_cndmask_b32_dpp v7, v7, v7, vcc wave_shr:1 row_mask:0xf bank_mask:0xf
    s_mov_b64 exec, s[54:55]
    s_cbranch_scc0 L2_d148
    s_mov_b64 exec, s[82:83]
    s_nop 1
    v_mfma_f32_4x4x4_16b_bf16 v[88:91], v[12:13], v[84:85], 0
    s_nop 1
    v_mfma_f32_4x4x4_16b_bf16 v[88:91], v[10:11], v[86:87], v[88:91]
    s_nop 4
    v_cvt_pk_bf16_f32 v88, v88, v89
    v_cvt_pk_bf16_f32 v89, v90, v91
    ds_pk_add_bf16 v7, v88 offset:65408
    ds_pk_add_bf16 v7, v89 offset:65412
    s_mov_b64 exec, s[54:55]
    s_branch L2_d148
L2_c149:
    s_lshl_b64 s[52:53], s[82:83], 1
    s_andn2_b64 s[52:53], s[52:53], s[80:81]
    s_andn2_b64 s[52:53], s[52:53], s[50:51]
    s_or_b64 s[80:81], s[80:81], s[52:53]
    s_not_b64 vcc, s[52:53]
    s_mov_b64 exec, -1
    v_cndmask_b32_dpp v84, v84, v84, vcc wave_shr:1 row_mask:0xf bank_mask:0xf
    v_cndmask_b32_dpp v85, v85, v85, vcc wave_shr:1 row_mask:0xf bank_mask:0xf
    s_lshr_b64 s[52:53], s[52:53], 1
    v_cndmask_b32_dpp v86, v86, v86, vcc wave_shr:1 row_mask:0xf bank_mask:0xf
    v_cndmask_b32_dpp v87, v87, v87, vcc wave_shr:1 row_mask:0xf bank_mask:0xf
    s_andn2_b64 s[82:83], s[82:83], s[52:53]
    v_cndmask_b32_dpp v7, v7, v7, vcc wave_shr:1 row_mask:0xf bank_mask:0xf
    s_mov_b64 exec, s[50:51]
    s_cbranch_scc0 L2_d149
    s_mov_b64 exec, s[82:83]
    s_nop 1
    v_mfma_f32_4x4x4_16b_bf16 v[88:91], v[12:13], v[84:85], 0
    s_nop 1
    v_mfma_f32_4x4x4_16b_bf16 v[88:91], v[10:11], v[86:87], v[88:91]
    s_nop 4
    v_cvt_pk_bf16_f32 v88, v88, v89
    v_cvt_pk_bf16_f32 v89, v90, v91
    ds_pk_add_bf16 v7, v88 offset:65408
    ds_pk_add_bf16 v7, v89 offset:65412
    s_mov_b64 exec, s[50:51]
    s_branch L2_d149
L2_c150:
    s_lshl_b64 s[52:53], s[82:83], 1
    s_andn2_b64 s[52:53], s[52:53], s[80:81]
    s_andn2_b64 s[52:53], s[52:53], s[54:55]
    s_or_b64 s[80:81], s[80:81], s[52:53]
    s_not_b64 vcc, s[52:53]
    s_mov_b64 exec, -1
    v_cndmask_b32_dpp v84, v84, v84, vcc wave_shr:1 row_mask:0xf bank_mask:0xf
    v_cndmask_b32_dpp v85, v85, v85, vcc wave_shr:1 row_mask:0xf bank_mask:0xf
    s_lshr_b64 s[52:53], s[52:53], 1
    v_cndmask_b32_dpp v86, v86, v86, vcc wave_shr:1 row_mask:0xf bank_mask:0xf
    v_cndmask_b32_dpp v87, v87, v87, vcc wave_shr:1 row_mask:0xf bank_mask:0xf
    s_andn2_b64 s[82:83], s[82:83], s[52:53]
    v_cndmask_b32_dpp v7, v7, v7, vcc wave_shr:1 row_mask:0xf bank_mask:0xf
    s_mov_b64 exec, s[54:55]
    s_cbranch_scc0 L2_d150
    s_mov_b64 exec, s[82:83]
    s_nop 1
    v_mfma_f32_4x4x4_16b_bf16 v[88:91], v[12:13], v[84:85], 0
    s_nop 1
    v_mfma_f32_4x4x4_16b_bf16 v[88:91], v[10:11], v[86:87], v[88:91]
    s_nop 4
    v_cvt_pk_bf16_f32 v88, v88, v89
    v_cvt_pk_bf16_f32 v89, v90, v91
    ds_pk_add_bf16 v7, v88 offset:65408
    ds_pk_add_bf16 v7, v89 offset:65412
    s_mov_b64 exec, s[54:55]
    s_branch L2_d150
L2_c151:
    s_lshl_b64 s[52:53], s[82:83], 1
    s_andn2_b64 s[52:53], s[52:53], s[80:81]
    s_andn2_b64 s[52:53], s[52:53], s[50:51]
    s_or_b64 s[80:81], s[80:81], s[52:53]
    s_not_b64 vcc, s[52:53]
    s_mov_b64 exec, -1
    v_cndmask_b32_dpp v84, v84, v84, vcc wave_shr:1 row_mask:0xf bank_mask:0xf
    v_cndmask_b32_dpp v85, v85, v85, vcc wave_shr:1 row_mask:0xf bank_mask:0xf
    s_lshr_b64 s[52:53], s[52:53], 1
    v_cndmask_b32_dpp v86, v86, v86, vcc wave_shr:1 row_mask:0xf bank_mask:0xf
    v_cndmask_b32_dpp v87, v87, v87, vcc wave_shr:1 row_mask:0xf bank_mask:0xf
    s_andn2_b64 s[82:83], s[82:83], s[52:53]
    v_cndmask_b32_dpp v7, v7, v7, vcc wave_shr:1 row_mask:0xf bank_mask:0xf
    s_mov_b64 exec, s[50:51]
    s_cbranch_scc0 L2_d151
    s_mov_b64 exec, s[82:83]
    s_nop 1
    v_mfma_f32_4x4x4_16b_bf16 v[88:91], v[12:13], v[84:85], 0
    s_nop 1
    v_mfma_f32_4x4x4_16b_bf16 v[88:91], v[10:11], v[86:87], v[88:91]
    s_nop 4
    v_cvt_pk_bf16_f32 v88, v88, v89
    v_cvt_pk_bf16_f32 v89, v90, v91
    ds_pk_add_bf16 v7, v88 offset:65408
    ds_pk_add_bf16 v7, v89 offset:65412
    s_mov_b64 exec, s[50:51]
    s_branch L2_d151
L2_c152:
    s_mov_b64 s[50:51], vcc
    s_lshl_b64 s[52:53], s[82:83], 1
    s_andn2_b64 s[52:53], s[52:53], s[80:81]
    s_andn2_b64 s[52:53], s[52:53], s[50:51]
    s_or_b64 s[80:81], s[80:81], s[52:53]
    s_not_b64 vcc, s[52:53]
    s_mov_b64 exec, -1
    v_cndmask_b32_dpp v84, v84, v84, vcc wave_shr:1 row_mask:0xf bank_mask:0xf
    v_cndmask_b32_dpp v85, v85, v85, vcc wave_shr:1 row_mask:0xf bank_mask:0xf
    s_lshr_b64 s[52:53], s[52:53], 1
    v_cndmask_b32_dpp v86, v86, v86, vcc wave_shr:1 row_mask:0xf bank_mask:0xf
    v_cndmask_b32_dpp v87, v87, v87, vcc wave_shr:1 row_mask:0xf bank_mask:0xf
    s_andn2_b64 s[82:83], s[82:83], s[52:53]
    v_cndmask_b32_dpp v7, v7, v7, vcc wave_shr:1 row_mask:0xf bank_mask:0xf
    s_mov_b64 vcc, s[50:51]
    s_mov_b64 exec, s[50:51]
    s_cbranch_scc0 L2_d152
    s_mov_b64 exec, s[82:83]
    s_nop 1
    v_mfma_f32_4x4x4_16b_bf16 v[88:91], v[12:13], v[84:85], 0
    s_nop 1
    v_mfma_f32_4x4x4_16b_bf16 v[88:91], v[10:11], v[86:87], v[88:91]
    s_nop 4
    v_cvt_pk_bf16_f32 v88, v88, v89
    v_cvt_pk_bf16_f32 v89, v90, v91
    ds_pk_add_bf16 v7, v88 offset:65408
    ds_pk_add_bf16 v7, v89 offset:65412
    s_mov_b64 exec, vcc
    s_branch L2_d152
L2_c153:
    s_mov_b64 s[50:51], vcc
    s_lshl_b64 s[52:53], s[82:83], 1
    s_andn2_b64 s[52:53], s[52:53], s[80:81]
    s_andn2_b64 s[52:53], s[52:53], s[50:51]
    s_or_b64 s[80:81], s[80:81], s[52:53]
    s_not_b64 vcc, s[52:53]
    s_mov_b64 exec, -1
    v_cndmask_b32_dpp v84, v84, v84, vcc wave_shr:1 row_mask:0xf bank_mask:0xf
    v_cndmask_b32_dpp v85, v85, v85, vcc wave_shr:1 row_mask:0xf bank_mask:0xf
    s_lshr_b64 s[52:53], s[52:53], 1
    v_cndmask_b32_dpp v86, v86, v86, vcc wave_shr:1 row_mask:0xf bank_mask:0xf
    v_cndmask_b32_dpp v87, v87, v87, vcc wave_shr:1 row_mask:0xf bank_mask:0xf
    s_andn2_b64 s[82:83], s[82:83], s[52:53]
    v_cndmask_b32_dpp v7, v7, v7, vcc wave_shr:1 row_mask:0xf bank_mask:0xf
    s_mov_b64 vcc, s[50:51]
    s_mov_b64 exec, s[50:51]
    s_cbranch_scc0 L2_d153
    s_mov_b64 exec, s[82:83]
    s_nop 1
    v_mfma_f32_4x4x4_16b_bf16 v[88:91], v[12:13], v[84:85], 0
    s_nop 1
    v_mfma_f32_4x4x4_16b_bf16 v[88:91], v[10:11], v[86:87], v[88:91]
    s_nop 4
    v_cvt_pk_bf16_f32 v88, v88, v89
    v_cvt_pk_bf16_f32 v89, v90, v91
    ds_pk_add_bf16 v7, v88 offset:65408
    ds_pk_add_bf16 v7, v89 offset:65412
    s_mov_b64 exec, vcc
    s_branch L2_d153
L2_f3s:
    s_branch L2_f3
.section .rodata,"a"
.p2align 6
.amdhsa_kernel gather_scatter__molecular_angular_gemnet__graph_kernel
  .amdhsa_next_free_vgpr 128
  .amdhsa_next_free_sgpr 102
  .amdhsa_accum_offset 128
  .amdhsa_group_segment_fixed_size 0
  .amdhsa_kernarg_size 112
  .amdhsa_user_sgpr_count 2
  .amdhsa_user_sgpr_kernarg_segment_ptr 1
  .amdhsa_system_sgpr_workgroup_id_x 1
  .amdhsa_float_denorm_mode_32 3
.end_amdhsa_kernel
```

```asm
; @launch grid=(256,1,1) block=(1024,1,1) lds=163840
.amdgcn_target "amdgcn-amd-amdhsa--gfx950"
.text
.globl gather_scatter__molecular_angular_gemnet__graph_kernel
.p2align 8
.type gather_scatter__molecular_angular_gemnet__graph_kernel,@function
gather_scatter__molecular_angular_gemnet__graph_kernel:
    s_cmp_ge_u32 s2, 256
    s_cbranch_scc0 L1_go
    s_endpgm
L1_go:
    s_load_dwordx4 s[4:7], s[0:1], 8
    s_load_dwordx2 s[28:29], s[0:1], 32
    s_load_dwordx2 s[30:31], s[0:1], 104
    s_load_dwordx2 s[56:57], s[0:1], 96
    s_load_dwordx2 s[86:87], s[0:1], 0
    s_load_dwordx4 s[60:63], s[0:1], 56
    s_load_dwordx4 s[64:67], s[0:1], 72
    v_lshrrev_b32 v7, 6, v0
    v_lshlrev_b32 v1, 3, v0
    v_readfirstlane_b32 s32, v7
    v_lshlrev_b32 v0, 4, v0
    v_and_b32 v1, 0x1f8, v1
    v_lshlrev_b32 v15, 1, v1
    s_lshr_b32 s3, s32, 1
    s_and_b32 s44, s32, 1
    s_lshl_b32 s44, s44, 3
    s_or_b32 s3, s3, s44
    s_lshl_b32 s3, s3, 10
    s_lshl_b32 s96, s2, 14
    s_add_u32 s96, s96, s3
    s_lshr_b32 s3, s32, 1
    s_and_b32 s44, s32, 1
    s_lshl_b32 s44, s44, 3
    s_or_b32 s3, s3, s44
    s_lshl_b32 s3, s3, 10
    s_lshl_b32 s97, s2, 14
    s_add_u32 s97, s97, s3
    s_lshr_b32 s3, s32, 1
    s_and_b32 s44, s32, 1
    s_lshl_b32 s44, s44, 3
    s_or_b32 s3, s3, s44
    s_lshl_b32 s3, s3, 10
    s_lshl_b32 s98, s2, 14
    s_add_u32 s98, s98, s3
    s_lshr_b32 s3, s32, 1
    s_and_b32 s44, s32, 1
    s_lshl_b32 s44, s44, 3
    s_or_b32 s3, s3, s44
    s_lshl_b32 s3, s3, 10
    s_lshl_b32 s99, s2, 14
    s_add_u32 s99, s99, s3
    s_waitcnt lgkmcnt(0)
    s_mov_b32 s8, s4
    s_mov_b32 s9, s5
    s_mov_b32 s10, 0x9c40000
    s_mov_b32 s11, 0x20000
    s_mov_b32 s12, s6
    s_mov_b32 s13, s7
    s_mov_b32 s14, 0x9c40000
    s_mov_b32 s15, 0x20000
    s_mov_b32 s16, s28
    s_mov_b32 s17, s29
    s_mov_b32 s18, 0x4e20000
    s_mov_b32 s19, 0x20000
    s_mov_b32 s68, s62
    s_mov_b32 s69, s63
    s_mov_b32 s70, 0x40
    s_mov_b32 s71, 0x20000
    s_mov_b32 s72, s60
    s_mov_b32 s73, s61
    s_mov_b32 s74, 0x40
    s_mov_b32 s75, 0x20000
    s_mov_b32 s20, s66
    s_mov_b32 s21, s67
    s_mov_b32 s22, 0x20
    s_mov_b32 s23, 0x20000
    s_mov_b32 s80, s64
    s_mov_b32 s81, s65
    s_mov_b32 s82, 0x20
    s_mov_b32 s83, 0x20000
    s_add_u32 s24, s30, 0xec45000
    s_addc_u32 s25, s31, 0
    s_mov_b32 s26, 0x100
    s_mov_b32 s27, 0x20000
    v_lshrrev_b32 v2, 3, v0
    v_and_b32 v2, 6, v2
    v_lshlrev_b32 v3, 2, v0
    s_lshl_b32 s3, s32, 8
    s_add_u32 s3, s3, s2
    s_cmp_lg_u32 s3, 254
    s_cbranch_scc1 L1_wt
    buffer_load_ushort v96, v2, s[68:71], 0 offen offset:0
    buffer_load_ushort v108, v2, s[68:71], 0 offen offset:8
    buffer_load_ushort v97, v2, s[68:71], 0 offen offset:16
    buffer_load_ushort v109, v2, s[68:71], 0 offen offset:24
    buffer_load_ushort v98, v2, s[68:71], 0 offen offset:32
    buffer_load_ushort v110, v2, s[68:71], 0 offen offset:40
    buffer_load_ushort v99, v2, s[68:71], 0 offen offset:48
    buffer_load_ushort v111, v2, s[68:71], 0 offen offset:56
    buffer_load_ushort v100, v2, s[72:75], 0 offen offset:0
    buffer_load_ushort v112, v2, s[72:75], 0 offen offset:8
    buffer_load_ushort v101, v2, s[72:75], 0 offen offset:16
    buffer_load_ushort v113, v2, s[72:75], 0 offen offset:24
    buffer_load_ushort v102, v2, s[72:75], 0 offen offset:32
    buffer_load_ushort v114, v2, s[72:75], 0 offen offset:40
    buffer_load_ushort v103, v2, s[72:75], 0 offen offset:48
    buffer_load_ushort v115, v2, s[72:75], 0 offen offset:56
    buffer_load_ushort v104, v2, s[20:23], 0 offen offset:0
    buffer_load_ushort v116, v2, s[20:23], 0 offen offset:8
    buffer_load_ushort v105, v2, s[20:23], 0 offen offset:16
    buffer_load_ushort v117, v2, s[20:23], 0 offen offset:24
    buffer_load_ushort v106, v2, s[80:83], 0 offen offset:0
    buffer_load_ushort v118, v2, s[80:83], 0 offen offset:8
    buffer_load_ushort v107, v2, s[80:83], 0 offen offset:16
    buffer_load_ushort v119, v2, s[80:83], 0 offen offset:24
    s_waitcnt vmcnt(0)
    v_lshl_or_b32 v96, v108, 16, v96
    v_lshl_or_b32 v97, v109, 16, v97
    v_lshl_or_b32 v98, v110, 16, v98
    v_lshl_or_b32 v99, v111, 16, v99
    v_lshl_or_b32 v100, v112, 16, v100
    v_lshl_or_b32 v101, v113, 16, v101
    v_lshl_or_b32 v102, v114, 16, v102
    v_lshl_or_b32 v103, v115, 16, v103
    v_lshl_or_b32 v104, v116, 16, v104
    v_lshl_or_b32 v105, v117, 16, v105
    v_lshl_or_b32 v106, v118, 16, v106
    v_lshl_or_b32 v107, v119, 16, v107
    buffer_store_dwordx4 v[96:99], v3, s[24:27], 0 offen offset:0 sc1
    buffer_store_dwordx4 v[100:103], v3, s[24:27], 0 offen offset:16 sc1
    buffer_store_dwordx4 v[104:107], v3, s[24:27], 0 offen offset:32 sc1
L1_wt:
    s_nop 1
    s_add_u32 s44, s96, 0x0
    v_lshlrev_b32 v16, 1, v1
    buffer_load_dwordx4 v[16:19], v16, s[8:11], s44 offen nt
    s_add_u32 s45, s96, 0x0
    v_lshlrev_b32 v20, 1, v1
    buffer_load_dwordx4 v[20:23], v20, s[12:15], s45 offen nt
    s_add_u32 s46, s96, 0x0
    s_lshr_b32 s46, s46, 1
    buffer_load_dwordx2 v[24:25], v1, s[16:19], s46 offen nt
    s_add_u32 s47, s97, 0x400000
    s_lshr_b32 s47, s47, 1
    buffer_load_dwordx2 v[26:27], v1, s[16:19], s47 offen nt
    s_add_u32 s44, s97, 0x400000
    v_lshlrev_b32 v28, 1, v1
    buffer_load_dwordx4 v[28:31], v28, s[8:11], s44 offen nt
    s_add_u32 s45, s97, 0x400000
    v_lshlrev_b32 v32, 1, v1
    buffer_load_dwordx4 v[32:35], v32, s[12:15], s45 offen nt
    s_add_u32 s46, s98, 0x800000
    v_lshlrev_b32 v36, 1, v1
    buffer_load_dwordx4 v[36:39], v36, s[8:11], s46 offen nt
    s_add_u32 s47, s98, 0x800000
    v_lshlrev_b32 v40, 1, v1
    buffer_load_dwordx4 v[40:43], v40, s[12:15], s47 offen nt
    s_add_u32 s44, s98, 0x800000
    s_lshr_b32 s44, s44, 1
    buffer_load_dwordx2 v[44:45], v1, s[16:19], s44 offen nt
    s_add_u32 s45, s99, 0xc00000
    s_lshr_b32 s45, s45, 1
    buffer_load_dwordx2 v[46:47], v1, s[16:19], s45 offen nt
    s_mov_b32 s20, s30
    s_mov_b32 s21, s31
    s_mov_b32 s22, 0xd344000
    s_mov_b32 s23, 0x20000
    s_add_u32 s24, s30, 0x2c000
    s_addc_u32 s25, s31, 0
    s_mov_b32 s26, 0xd318000
    s_mov_b32 s27, 0x20000
    s_add_u32 s3, s32, 0
    s_mul_i32 s4, s3, 205
    s_lshr_b32 s4, s4, 10
    s_mul_i32 s5, s4, 5
    s_sub_u32 s5, s3, s5
    s_lshl_b32 s5, s5, 5
    s_add_u32 s4, s4, s5
    s_sub_u32 s4, s4, s32
    s_lshl_b32 s72, s4, 10
    s_add_u32 s3, s32, 16
    s_mul_i32 s4, s3, 205
    s_lshr_b32 s4, s4, 10
    s_mul_i32 s5, s4, 5
    s_sub_u32 s5, s3, s5
    s_lshl_b32 s5, s5, 5
    s_add_u32 s4, s4, s5
    s_sub_u32 s4, s4, s32
    s_lshl_b32 s73, s4, 10
    s_add_u32 s3, s32, 32
    s_mul_i32 s4, s3, 205
    s_lshr_b32 s4, s4, 10
    s_mul_i32 s5, s4, 5
    s_sub_u32 s5, s3, s5
    s_lshl_b32 s5, s5, 5
    s_add_u32 s4, s4, s5
    s_sub_u32 s4, s4, s32
    s_lshl_b32 s85, s4, 10
    s_add_u32 s3, s32, 48
    s_mul_i32 s4, s3, 205
    s_lshr_b32 s4, s4, 10
    s_mul_i32 s5, s4, 5
    s_sub_u32 s5, s3, s5
    s_lshl_b32 s5, s5, 5
    s_add_u32 s4, s4, s5
    s_sub_u32 s4, s4, s32
    s_lshl_b32 s91, s4, 10
    s_add_u32 s3, s32, 64
    s_mul_i32 s4, s3, 205
    s_lshr_b32 s4, s4, 10
    s_mul_i32 s5, s4, 5
    s_sub_u32 s5, s3, s5
    s_lshl_b32 s5, s5, 5
    s_add_u32 s4, s4, s5
    s_sub_u32 s4, s4, s32
    s_lshl_b32 s93, s4, 10
    s_mov_b32 s80, s86
    s_mov_b32 s81, s87
    s_mov_b32 s82, 0x4e2000
    s_mov_b32 s83, 0x20000
    s_mul_i32 s35, s2, 173056
    s_and_b32 s37, s32, 3
    s_lshl_b32 s37, s37, 3
    s_mov_b32 s36, s37
    s_lshr_b32 s37, s32, 2
    s_mul_i32 s37, s37, 2080
    s_add_u32 s36, s36, s37
    s_and_b32 s37, s2, 3
    s_lshl_b32 s37, s37, 5
    s_add_u32 s36, s36, s37
    s_mul_i32 s4, s2, 5
    s_add_u32 s4, s4, 8192
    s_lshl_b32 s38, s4, 14
    s_lshl_b32 s39, s4, 13
    v_mov_b32 v2, 1
    v_mov_b32 v4, 0x80000007
    v_mov_b32 v5, 0xfc
    v_mov_b32 v6, 0x78
    s_mov_b32 s40, 16512
    s_mov_b32 s55, -10000
    s_mov_b32 s41, 0x010c0c01
    s_mov_b32 s42, 0x030c0c03
    v_mov_b32 v8, 0
    v_mov_b32 v9, 0
    v_mov_b32 v10, 0
    v_mov_b32 v11, 0
    ds_write_b128 v0, v[8:11]
    s_add_u32 s60, s30, 0xec4e000
    s_addc_u32 s61, s31, 0
    s_mov_b32 s62, 0x8000
    s_mov_b32 s63, 0x20000
    s_mov_b64 s[66:67], s[56:57]
    s_lshl_b32 s57, s2, 7
    s_add_u32 s68, s30, 0xec46000
    s_addc_u32 s69, s31, 0
    s_mov_b32 s70, 0x80
    s_mov_b32 s71, 0x20000
    s_lshl_b32 s3, s2, 7
    s_add_u32 s68, s68, s3
    s_addc_u32 s69, s69, 0
    s_cmp_lg_u32 s32, 0
    s_cbranch_scc1 L1_fl
    buffer_store_dwordx4 v[8:11], v0, s[68:71], 0 offen sc1
    s_mov_b64 exec, 0xff
    buffer_store_dwordx4 v[8:11], v0, s[60:63], s57 offen sc1
    s_mov_b64 exec, -1
L1_fl:
    s_waitcnt lgkmcnt(0)
    s_barrier
    s_setprio 3
    s_add_u32 s46, s99, 0xc00000
    v_lshlrev_b32 v48, 1, v1
    buffer_load_dwordx4 v[48:51], v48, s[8:11], s46 offen nt
    s_add_u32 s47, s99, 0xc00000
    v_lshlrev_b32 v52, 1, v1
    buffer_load_dwordx4 v[52:55], v52, s[12:15], s47 offen nt
    s_waitcnt vmcnt(8)
    v_lshlrev_b32 v7, 16, v24
    v_and_b32 v8, 0xffff0000, v24
    v_lshlrev_b32 v9, 16, v25
    v_and_b32 v10, 0xffff0000, v25
    v_mul_f32 v7, 0.15915494, v7
    v_mul_f32 v8, 0.15915494, v8
    v_mul_f32 v9, 0.15915494, v9
    v_mul_f32 v10, 0.15915494, v10
    v_mul_hi_u32_u24 v14, 429497, v16
    v_lshrrev_b32 v12, 3, v20
    v_cos_f32 v7, v7
    v_lshlrev_b16 v13, 3, v20
    v_mad_i32_i24 v11, v14, s55, v16
    v_bitop3_b32 v12, v6, v13, v12 bitop3:0xca
    v_lshl_add_u32 v11, v11, 17, s40
    v_lshlrev_b16 v14, 8, v14
    v_lshrrev_b32 v13, 2, v20
    v_add_u32 v16, v12, v11
    v_bitop3_b32 v20, v5, v13, v14 bitop3:0xea
    ds_add_u32 v20, v2
    v_mul_hi_u32_u24 v14, 429497, v17
    v_lshrrev_b32 v12, 3, v21
    v_cos_f32 v8, v8
    v_lshlrev_b16 v13, 3, v21
    v_mad_i32_i24 v11, v14, s55, v17
    v_bitop3_b32 v12, v6, v13, v12 bitop3:0xca
    v_lshl_add_u32 v11, v11, 17, s40
    v_lshlrev_b16 v14, 8, v14
    v_lshrrev_b32 v13, 2, v21
    v_add_u32 v17, v12, v11
    v_bitop3_b32 v21, v5, v13, v14 bitop3:0xea
    ds_add_u32 v21, v2
    v_cvt_pk_bf16_f32 v24, v7, v8
    v_perm_b32 v12, v24, v24, s41
    v_bitop3_b32 v16, v4, v12, v16 bitop3:0xca
    v_perm_b32 v13, v24, v24, s42
    v_bitop3_b32 v17, v4, v13, v17 bitop3:0xca
    v_mul_hi_u32_u24 v14, 429497, v18
    v_lshrrev_b32 v12, 3, v22
    v_cos_f32 v9, v9
    v_lshlrev_b16 v13, 3, v22
    v_mad_i32_i24 v11, v14, s55, v18
    v_bitop3_b32 v12, v6, v13, v12 bitop3:0xca
    v_lshl_add_u32 v11, v11, 17, s40
    v_lshlrev_b16 v14, 8, v14
    v_lshrrev_b32 v13, 2, v22
    v_add_u32 v18, v12, v11
    v_bitop3_b32 v22, v5, v13, v14 bitop3:0xea
    ds_add_u32 v22, v2
    v_mul_hi_u32_u24 v14, 429497, v19
    v_lshrrev_b32 v12, 3, v23
    v_cos_f32 v10, v10
    v_lshlrev_b16 v13, 3, v23
    v_mad_i32_i24 v11, v14, s55, v19
    v_bitop3_b32 v12, v6, v13, v12 bitop3:0xca
    v_lshl_add_u32 v11, v11, 17, s40
    v_lshlrev_b16 v14, 8, v14
    v_lshrrev_b32 v13, 2, v23
    v_add_u32 v19, v12, v11
    v_bitop3_b32 v23, v5, v13, v14 bitop3:0xea
    ds_add_u32 v23, v2
    v_cvt_pk_bf16_f32 v25, v9, v10
    v_perm_b32 v12, v25, v25, s41
    v_bitop3_b32 v18, v4, v12, v18 bitop3:0xca
    v_perm_b32 v13, v25, v25, s42
    v_bitop3_b32 v19, v4, v13, v19 bitop3:0xca
    s_add_u32 s44, s96, 0x1000000
    v_lshlrev_b32 v56, 1, v1
    buffer_load_dwordx4 v[56:59], v56, s[8:11], s44 offen nt
    s_add_u32 s45, s96, 0x1000000
    v_lshlrev_b32 v60, 1, v1
    buffer_load_dwordx4 v[60:63], v60, s[12:15], s45 offen nt
    s_add_u32 s46, s96, 0x1000000
    s_lshr_b32 s46, s46, 1
    buffer_load_dwordx2 v[64:65], v1, s[16:19], s46 offen nt
    s_add_u32 s47, s97, 0x1400000
    s_lshr_b32 s47, s47, 1
    buffer_load_dwordx2 v[66:67], v1, s[16:19], s47 offen nt
    s_waitcnt vmcnt(10)
    v_lshlrev_b32 v7, 16, v26
    v_and_b32 v8, 0xffff0000, v26
    v_lshlrev_b32 v9, 16, v27
    v_and_b32 v10, 0xffff0000, v27
    v_mul_f32 v7, 0.15915494, v7
    v_mul_f32 v8, 0.15915494, v8
    v_mul_f32 v9, 0.15915494, v9
    v_mul_f32 v10, 0.15915494, v10
    v_mul_hi_u32_u24 v14, 429497, v28
    v_lshrrev_b32 v12, 3, v32
    v_cos_f32 v7, v7
    v_lshlrev_b16 v13, 3, v32
    v_mad_i32_i24 v11, v14, s55, v28
    v_bitop3_b32 v12, v6, v13, v12 bitop3:0xca
    v_lshl_add_u32 v11, v11, 17, s40
    v_lshlrev_b16 v14, 8, v14
    v_lshrrev_b32 v13, 2, v32
    v_add_u32 v28, v12, v11
    v_bitop3_b32 v32, v5, v13, v14 bitop3:0xea
    ds_add_u32 v32, v2
    v_mul_hi_u32_u24 v14, 429497, v29
    v_lshrrev_b32 v12, 3, v33
    v_cos_f32 v8, v8
    v_lshlrev_b16 v13, 3, v33
    v_mad_i32_i24 v11, v14, s55, v29
    v_bitop3_b32 v12, v6, v13, v12 bitop3:0xca
    v_lshl_add_u32 v11, v11, 17, s40
    v_lshlrev_b16 v14, 8, v14
    v_lshrrev_b32 v13, 2, v33
    v_add_u32 v29, v12, v11
    v_bitop3_b32 v33, v5, v13, v14 bitop3:0xea
    ds_add_u32 v33, v2
    v_cvt_pk_bf16_f32 v26, v7, v8
    v_perm_b32 v12, v26, v26, s41
    v_bitop3_b32 v28, v4, v12, v28 bitop3:0xca
    v_perm_b32 v13, v26, v26, s42
    v_bitop3_b32 v29, v4, v13, v29 bitop3:0xca
    v_mul_hi_u32_u24 v14, 429497, v30
    v_lshrrev_b32 v12, 3, v34
    v_cos_f32 v9, v9
    v_lshlrev_b16 v13, 3, v34
    v_mad_i32_i24 v11, v14, s55, v30
    v_bitop3_b32 v12, v6, v13, v12 bitop3:0xca
    v_lshl_add_u32 v11, v11, 17, s40
    v_lshlrev_b16 v14, 8, v14
    v_lshrrev_b32 v13, 2, v34
    v_add_u32 v30, v12, v11
    v_bitop3_b32 v34, v5, v13, v14 bitop3:0xea
    ds_add_u32 v34, v2
    v_mul_hi_u32_u24 v14, 429497, v31
    v_lshrrev_b32 v12, 3, v35
    v_cos_f32 v10, v10
    v_lshlrev_b16 v13, 3, v35
    v_mad_i32_i24 v11, v14, s55, v31
    v_bitop3_b32 v12, v6, v13, v12 bitop3:0xca
    v_lshl_add_u32 v11, v11, 17, s40
    v_lshlrev_b16 v14, 8, v14
    v_lshrrev_b32 v13, 2, v35
    v_add_u32 v31, v12, v11
    v_bitop3_b32 v35, v5, v13, v14 bitop3:0xea
    ds_add_u32 v35, v2
    v_cvt_pk_bf16_f32 v27, v9, v10
    v_perm_b32 v12, v27, v27, s41
    v_bitop3_b32 v30, v4, v12, v30 bitop3:0xca
    v_perm_b32 v13, v27, v27, s42
    v_bitop3_b32 v31, v4, v13, v31 bitop3:0xca
    s_setprio 2
    s_add_u32 s44, s97, 0x1400000
    v_lshlrev_b32 v68, 1, v1
    buffer_load_dwordx4 v[68:71], v68, s[8:11], s44 offen nt
    s_add_u32 s45, s97, 0x1400000
    v_lshlrev_b32 v72, 1, v1
    buffer_load_dwordx4 v[72:75], v72, s[12:15], s45 offen nt
    s_waitcnt vmcnt(8)
    v_lshlrev_b32 v7, 16, v44
    v_and_b32 v8, 0xffff0000, v44
    v_lshlrev_b32 v9, 16, v45
    v_and_b32 v10, 0xffff0000, v45
    v_mul_f32 v7, 0.15915494, v7
    v_mul_f32 v8, 0.15915494, v8
    v_mul_f32 v9, 0.15915494, v9
    v_mul_f32 v10, 0.15915494, v10
    v_mul_hi_u32_u24 v14, 429497, v36
    v_lshrrev_b32 v12, 3, v40
    v_cos_f32 v7, v7
    v_lshlrev_b16 v13, 3, v40
    v_mad_i32_i24 v11, v14, s55, v36
    v_bitop3_b32 v12, v6, v13, v12 bitop3:0xca
    v_lshl_add_u32 v11, v11, 17, s40
    v_lshlrev_b16 v14, 8, v14
    v_lshrrev_b32 v13, 2, v40
    v_add_u32 v36, v12, v11
    v_bitop3_b32 v40, v5, v13, v14 bitop3:0xea
    ds_add_u32 v40, v2
    v_mul_hi_u32_u24 v14, 429497, v37
    v_lshrrev_b32 v12, 3, v41
    v_cos_f32 v8, v8
    v_lshlrev_b16 v13, 3, v41
    v_mad_i32_i24 v11, v14, s55, v37
    v_bitop3_b32 v12, v6, v13, v12 bitop3:0xca
    v_lshl_add_u32 v11, v11, 17, s40
    v_lshlrev_b16 v14, 8, v14
    v_lshrrev_b32 v13, 2, v41
    v_add_u32 v37, v12, v11
    v_bitop3_b32 v41, v5, v13, v14 bitop3:0xea
    ds_add_u32 v41, v2
    v_cvt_pk_bf16_f32 v44, v7, v8
    v_perm_b32 v12, v44, v44, s41
    v_bitop3_b32 v36, v4, v12, v36 bitop3:0xca
    v_perm_b32 v13, v44, v44, s42
    v_bitop3_b32 v37, v4, v13, v37 bitop3:0xca
    v_mul_hi_u32_u24 v14, 429497, v38
    v_lshrrev_b32 v12, 3, v42
    v_cos_f32 v9, v9
    v_lshlrev_b16 v13, 3, v42
    v_mad_i32_i24 v11, v14, s55, v38
    v_bitop3_b32 v12, v6, v13, v12 bitop3:0xca
    v_lshl_add_u32 v11, v11, 17, s40
    v_lshlrev_b16 v14, 8, v14
    v_lshrrev_b32 v13, 2, v42
    v_add_u32 v38, v12, v11
    v_bitop3_b32 v42, v5, v13, v14 bitop3:0xea
    ds_add_u32 v42, v2
    v_mul_hi_u32_u24 v14, 429497, v39
    v_lshrrev_b32 v12, 3, v43
    v_cos_f32 v10, v10
    v_lshlrev_b16 v13, 3, v43
    v_mad_i32_i24 v11, v14, s55, v39
    v_bitop3_b32 v12, v6, v13, v12 bitop3:0xca
    v_lshl_add_u32 v11, v11, 17, s40
    v_lshlrev_b16 v14, 8, v14
    v_lshrrev_b32 v13, 2, v43
    v_add_u32 v39, v12, v11
    v_bitop3_b32 v43, v5, v13, v14 bitop3:0xea
    ds_add_u32 v43, v2
    v_cvt_pk_bf16_f32 v45, v9, v10
    v_perm_b32 v12, v45, v45, s41
    v_bitop3_b32 v38, v4, v12, v38 bitop3:0xca
    v_perm_b32 v13, v45, v45, s42
    v_bitop3_b32 v39, v4, v13, v39 bitop3:0xca
    s_add_u32 s46, s98, 0x1800000
    v_lshlrev_b32 v76, 1, v1
    buffer_load_dwordx4 v[76:79], v76, s[8:11], s46 offen nt
    s_add_u32 s47, s98, 0x1800000
    v_lshlrev_b32 v80, 1, v1
    buffer_load_dwordx4 v[80:83], v80, s[12:15], s47 offen nt
    s_add_u32 s44, s98, 0x1800000
    s_lshr_b32 s44, s44, 1
    buffer_load_dwordx2 v[84:85], v1, s[16:19], s44 offen nt
    s_add_u32 s45, s99, 0x1c00000
    s_lshr_b32 s45, s45, 1
    buffer_load_dwordx2 v[86:87], v1, s[16:19], s45 offen nt
    s_waitcnt vmcnt(10)
    v_lshlrev_b32 v7, 16, v46
    v_and_b32 v8, 0xffff0000, v46
    v_lshlrev_b32 v9, 16, v47
    v_and_b32 v10, 0xffff0000, v47
    v_mul_f32 v7, 0.15915494, v7
    v_mul_f32 v8, 0.15915494, v8
    v_mul_f32 v9, 0.15915494, v9
    v_mul_f32 v10, 0.15915494, v10
    v_mul_hi_u32_u24 v14, 429497, v48
    v_lshrrev_b32 v12, 3, v52
    v_cos_f32 v7, v7
    v_lshlrev_b16 v13, 3, v52
    v_mad_i32_i24 v11, v14, s55, v48
    v_bitop3_b32 v12, v6, v13, v12 bitop3:0xca
    v_lshl_add_u32 v11, v11, 17, s40
    v_lshlrev_b16 v14, 8, v14
    v_lshrrev_b32 v13, 2, v52
    v_add_u32 v48, v12, v11
    v_bitop3_b32 v52, v5, v13, v14 bitop3:0xea
    ds_add_u32 v52, v2
    v_mul_hi_u32_u24 v14, 429497, v49
    v_lshrrev_b32 v12, 3, v53
    v_cos_f32 v8, v8
    v_lshlrev_b16 v13, 3, v53
    v_mad_i32_i24 v11, v14, s55, v49
    v_bitop3_b32 v12, v6, v13, v12 bitop3:0xca
    v_lshl_add_u32 v11, v11, 17, s40
    v_lshlrev_b16 v14, 8, v14
    v_lshrrev_b32 v13, 2, v53
    v_add_u32 v49, v12, v11
    v_bitop3_b32 v53, v5, v13, v14 bitop3:0xea
    ds_add_u32 v53, v2
    v_cvt_pk_bf16_f32 v46, v7, v8
    v_perm_b32 v12, v46, v46, s41
    v_bitop3_b32 v48, v4, v12, v48 bitop3:0xca
    v_perm_b32 v13, v46, v46, s42
    v_bitop3_b32 v49, v4, v13, v49 bitop3:0xca
    v_mul_hi_u32_u24 v14, 429497, v50
    v_lshrrev_b32 v12, 3, v54
    v_cos_f32 v9, v9
    v_lshlrev_b16 v13, 3, v54
    v_mad_i32_i24 v11, v14, s55, v50
    v_bitop3_b32 v12, v6, v13, v12 bitop3:0xca
    v_lshl_add_u32 v11, v11, 17, s40
    v_lshlrev_b16 v14, 8, v14
    v_lshrrev_b32 v13, 2, v54
    v_add_u32 v50, v12, v11
    v_bitop3_b32 v54, v5, v13, v14 bitop3:0xea
    ds_add_u32 v54, v2
    v_mul_hi_u32_u24 v14, 429497, v51
    v_lshrrev_b32 v12, 3, v55
    v_cos_f32 v10, v10
    v_lshlrev_b16 v13, 3, v55
    v_mad_i32_i24 v11, v14, s55, v51
    v_bitop3_b32 v12, v6, v13, v12 bitop3:0xca
    v_lshl_add_u32 v11, v11, 17, s40
    v_lshlrev_b16 v14, 8, v14
    v_lshrrev_b32 v13, 2, v55
    v_add_u32 v51, v12, v11
    v_bitop3_b32 v55, v5, v13, v14 bitop3:0xea
    ds_add_u32 v55, v2
    v_cvt_pk_bf16_f32 v47, v9, v10
    v_perm_b32 v12, v47, v47, s41
    v_bitop3_b32 v50, v4, v12, v50 bitop3:0xca
    v_perm_b32 v13, v47, v47, s42
    v_bitop3_b32 v51, v4, v13, v51 bitop3:0xca
    s_setprio 1
    s_add_u32 s46, s99, 0x1c00000
    v_lshlrev_b32 v88, 1, v1
    buffer_load_dwordx4 v[88:91], v88, s[8:11], s46 offen nt
    s_add_u32 s47, s99, 0x1c00000
    v_lshlrev_b32 v92, 1, v1
    buffer_load_dwordx4 v[92:95], v92, s[12:15], s47 offen nt
    s_waitcnt vmcnt(8)
    v_lshlrev_b32 v7, 16, v64
    v_and_b32 v8, 0xffff0000, v64
    v_lshlrev_b32 v9, 16, v65
    v_and_b32 v10, 0xffff0000, v65
    v_mul_f32 v7, 0.15915494, v7
    v_mul_f32 v8, 0.15915494, v8
    v_mul_f32 v9, 0.15915494, v9
    v_mul_f32 v10, 0.15915494, v10
    v_mul_hi_u32_u24 v14, 429497, v56
    v_lshrrev_b32 v12, 3, v60
    v_cos_f32 v7, v7
    v_lshlrev_b16 v13, 3, v60
    v_mad_i32_i24 v11, v14, s55, v56
    v_bitop3_b32 v12, v6, v13, v12 bitop3:0xca
    v_lshl_add_u32 v11, v11, 17, s40
    v_lshlrev_b16 v14, 8, v14
    v_lshrrev_b32 v13, 2, v60
    v_add_u32 v56, v12, v11
    v_bitop3_b32 v60, v5, v13, v14 bitop3:0xea
    ds_add_u32 v60, v2
    v_mul_hi_u32_u24 v14, 429497, v57
    v_lshrrev_b32 v12, 3, v61
    v_cos_f32 v8, v8
    v_lshlrev_b16 v13, 3, v61
    v_mad_i32_i24 v11, v14, s55, v57
    v_bitop3_b32 v12, v6, v13, v12 bitop3:0xca
    v_lshl_add_u32 v11, v11, 17, s40
    v_lshlrev_b16 v14, 8, v14
    v_lshrrev_b32 v13, 2, v61
    v_add_u32 v57, v12, v11
    v_bitop3_b32 v61, v5, v13, v14 bitop3:0xea
    ds_add_u32 v61, v2
    v_cvt_pk_bf16_f32 v64, v7, v8
    v_perm_b32 v12, v64, v64, s41
    v_bitop3_b32 v56, v4, v12, v56 bitop3:0xca
    v_perm_b32 v13, v64, v64, s42
    v_bitop3_b32 v57, v4, v13, v57 bitop3:0xca
    v_mul_hi_u32_u24 v14, 429497, v58
    v_lshrrev_b32 v12, 3, v62
    v_cos_f32 v9, v9
    v_lshlrev_b16 v13, 3, v62
    v_mad_i32_i24 v11, v14, s55, v58
    v_bitop3_b32 v12, v6, v13, v12 bitop3:0xca
    v_lshl_add_u32 v11, v11, 17, s40
    v_lshlrev_b16 v14, 8, v14
    v_lshrrev_b32 v13, 2, v62
    v_add_u32 v58, v12, v11
    v_bitop3_b32 v62, v5, v13, v14 bitop3:0xea
    ds_add_u32 v62, v2
    v_mul_hi_u32_u24 v14, 429497, v59
    v_lshrrev_b32 v12, 3, v63
    v_cos_f32 v10, v10
    v_lshlrev_b16 v13, 3, v63
    v_mad_i32_i24 v11, v14, s55, v59
    v_bitop3_b32 v12, v6, v13, v12 bitop3:0xca
    v_lshl_add_u32 v11, v11, 17, s40
    v_lshlrev_b16 v14, 8, v14
    v_lshrrev_b32 v13, 2, v63
    v_add_u32 v59, v12, v11
    v_bitop3_b32 v63, v5, v13, v14 bitop3:0xea
    ds_add_u32 v63, v2
    v_cvt_pk_bf16_f32 v65, v9, v10
    v_perm_b32 v12, v65, v65, s41
    v_bitop3_b32 v58, v4, v12, v58 bitop3:0xca
    v_perm_b32 v13, v65, v65, s42
    v_bitop3_b32 v59, v4, v13, v59 bitop3:0xca
    s_add_u32 s44, s96, 0x2000000
    v_lshlrev_b32 v96, 1, v1
    buffer_load_dwordx4 v[96:99], v96, s[8:11], s44 offen nt
    s_add_u32 s45, s96, 0x2000000
    v_lshlrev_b32 v104, 1, v1
    buffer_load_dwordx4 v[104:107], v104, s[12:15], s45 offen nt
    s_add_u32 s46, s96, 0x2000000
    s_lshr_b32 s46, s46, 1
    buffer_load_dwordx2 v[108:109], v1, s[16:19], s46 offen nt
    s_add_u32 s47, s97, 0x2400000
    s_lshr_b32 s47, s47, 1
    buffer_load_dwordx2 v[110:111], v1, s[16:19], s47 offen nt
    s_waitcnt vmcnt(10)
    v_lshlrev_b32 v7, 16, v66
    v_and_b32 v8, 0xffff0000, v66
    v_lshlrev_b32 v9, 16, v67
    v_and_b32 v10, 0xffff0000, v67
    v_mul_f32 v7, 0.15915494, v7
    v_mul_f32 v8, 0.15915494, v8
    v_mul_f32 v9, 0.15915494, v9
    v_mul_f32 v10, 0.15915494, v10
    v_mul_hi_u32_u24 v14, 429497, v68
    v_lshrrev_b32 v12, 3, v72
    v_cos_f32 v7, v7
    v_lshlrev_b16 v13, 3, v72
    v_mad_i32_i24 v11, v14, s55, v68
    v_bitop3_b32 v12, v6, v13, v12 bitop3:0xca
    v_lshl_add_u32 v11, v11, 17, s40
    v_lshlrev_b16 v14, 8, v14
    v_lshrrev_b32 v13, 2, v72
    v_add_u32 v68, v12, v11
    v_bitop3_b32 v72, v5, v13, v14 bitop3:0xea
    ds_add_u32 v72, v2
    v_mul_hi_u32_u24 v14, 429497, v69
    v_lshrrev_b32 v12, 3, v73
    v_cos_f32 v8, v8
    v_lshlrev_b16 v13, 3, v73
    v_mad_i32_i24 v11, v14, s55, v69
    v_bitop3_b32 v12, v6, v13, v12 bitop3:0xca
    v_lshl_add_u32 v11, v11, 17, s40
    v_lshlrev_b16 v14, 8, v14
    v_lshrrev_b32 v13, 2, v73
    v_add_u32 v69, v12, v11
    v_bitop3_b32 v73, v5, v13, v14 bitop3:0xea
    ds_add_u32 v73, v2
    v_cvt_pk_bf16_f32 v66, v7, v8
    v_perm_b32 v12, v66, v66, s41
    v_bitop3_b32 v68, v4, v12, v68 bitop3:0xca
    v_perm_b32 v13, v66, v66, s42
    v_bitop3_b32 v69, v4, v13, v69 bitop3:0xca
    v_mul_hi_u32_u24 v14, 429497, v70
    v_lshrrev_b32 v12, 3, v74
    v_cos_f32 v9, v9
    v_lshlrev_b16 v13, 3, v74
    v_mad_i32_i24 v11, v14, s55, v70
    v_bitop3_b32 v12, v6, v13, v12 bitop3:0xca
    v_lshl_add_u32 v11, v11, 17, s40
    v_lshlrev_b16 v14, 8, v14
    v_lshrrev_b32 v13, 2, v74
    v_add_u32 v70, v12, v11
    v_bitop3_b32 v74, v5, v13, v14 bitop3:0xea
    ds_add_u32 v74, v2
    v_mul_hi_u32_u24 v14, 429497, v71
    v_lshrrev_b32 v12, 3, v75
    v_cos_f32 v10, v10
    v_lshlrev_b16 v13, 3, v75
    v_mad_i32_i24 v11, v14, s55, v71
    v_bitop3_b32 v12, v6, v13, v12 bitop3:0xca
    v_lshl_add_u32 v11, v11, 17, s40
    v_lshlrev_b16 v14, 8, v14
    v_lshrrev_b32 v13, 2, v75
    v_add_u32 v71, v12, v11
    v_bitop3_b32 v75, v5, v13, v14 bitop3:0xea
    ds_add_u32 v75, v2
    v_cvt_pk_bf16_f32 v67, v9, v10
    v_perm_b32 v12, v67, v67, s41
    v_bitop3_b32 v70, v4, v12, v70 bitop3:0xca
    v_perm_b32 v13, v67, v67, s42
    v_bitop3_b32 v71, v4, v13, v71 bitop3:0xca
    s_setprio 0
    s_add_u32 s44, s97, 0x2400000
    v_lshlrev_b32 v100, 1, v1
    buffer_load_dwordx4 v[100:103], v100, s[8:11], s44 offen nt
    s_waitcnt vmcnt(7)
    v_lshlrev_b32 v7, 16, v84
    v_and_b32 v8, 0xffff0000, v84
    v_lshlrev_b32 v9, 16, v85
    v_and_b32 v10, 0xffff0000, v85
    v_mul_f32 v7, 0.15915494, v7
    v_mul_f32 v8, 0.15915494, v8
    v_mul_f32 v9, 0.15915494, v9
    v_mul_f32 v10, 0.15915494, v10
    v_mul_hi_u32_u24 v14, 429497, v76
    v_lshrrev_b32 v12, 3, v80
    v_cos_f32 v7, v7
    v_lshlrev_b16 v13, 3, v80
    v_mad_i32_i24 v11, v14, s55, v76
    v_bitop3_b32 v12, v6, v13, v12 bitop3:0xca
    v_lshl_add_u32 v11, v11, 17, s40
    v_lshlrev_b16 v14, 8, v14
    v_lshrrev_b32 v13, 2, v80
    v_add_u32 v76, v12, v11
    v_bitop3_b32 v80, v5, v13, v14 bitop3:0xea
    ds_add_u32 v80, v2
    v_mul_hi_u32_u24 v14, 429497, v77
    v_lshrrev_b32 v12, 3, v81
    v_cos_f32 v8, v8
    v_lshlrev_b16 v13, 3, v81
    v_mad_i32_i24 v11, v14, s55, v77
    v_bitop3_b32 v12, v6, v13, v12 bitop3:0xca
    v_lshl_add_u32 v11, v11, 17, s40
    v_lshlrev_b16 v14, 8, v14
    v_lshrrev_b32 v13, 2, v81
    v_add_u32 v77, v12, v11
    v_bitop3_b32 v81, v5, v13, v14 bitop3:0xea
    ds_add_u32 v81, v2
    v_cvt_pk_bf16_f32 v84, v7, v8
    v_perm_b32 v12, v84, v84, s41
    v_bitop3_b32 v76, v4, v12, v76 bitop3:0xca
    v_perm_b32 v13, v84, v84, s42
    v_bitop3_b32 v77, v4, v13, v77 bitop3:0xca
    v_mul_hi_u32_u24 v14, 429497, v78
    v_lshrrev_b32 v12, 3, v82
    v_cos_f32 v9, v9
    v_lshlrev_b16 v13, 3, v82
    v_mad_i32_i24 v11, v14, s55, v78
    v_bitop3_b32 v12, v6, v13, v12 bitop3:0xca
    v_lshl_add_u32 v11, v11, 17, s40
    v_lshlrev_b16 v14, 8, v14
    v_lshrrev_b32 v13, 2, v82
    v_add_u32 v78, v12, v11
    v_bitop3_b32 v82, v5, v13, v14 bitop3:0xea
    ds_add_u32 v82, v2
    v_mul_hi_u32_u24 v14, 429497, v79
    v_lshrrev_b32 v12, 3, v83
    v_cos_f32 v10, v10
    v_lshlrev_b16 v13, 3, v83
    v_mad_i32_i24 v11, v14, s55, v79
    v_bitop3_b32 v12, v6, v13, v12 bitop3:0xca
    v_lshl_add_u32 v11, v11, 17, s40
    v_lshlrev_b16 v14, 8, v14
    v_lshrrev_b32 v13, 2, v83
    v_add_u32 v79, v12, v11
    v_bitop3_b32 v83, v5, v13, v14 bitop3:0xea
    ds_add_u32 v83, v2
    v_cvt_pk_bf16_f32 v85, v9, v10
    v_perm_b32 v12, v85, v85, s41
    v_bitop3_b32 v78, v4, v12, v78 bitop3:0xca
    v_perm_b32 v13, v85, v85, s42
    v_bitop3_b32 v79, v4, v13, v79 bitop3:0xca
    s_waitcnt vmcnt(5)
    v_lshlrev_b32 v7, 16, v86
    v_and_b32 v8, 0xffff0000, v86
    v_lshlrev_b32 v9, 16, v87
    v_and_b32 v10, 0xffff0000, v87
    v_mul_f32 v7, 0.15915494, v7
    v_mul_f32 v8, 0.15915494, v8
    v_mul_f32 v9, 0.15915494, v9
    v_mul_f32 v10, 0.15915494, v10
    v_mul_hi_u32_u24 v14, 429497, v88
    v_lshrrev_b32 v12, 3, v92
    v_cos_f32 v7, v7
    v_lshlrev_b16 v13, 3, v92
    v_mad_i32_i24 v11, v14, s55, v88
    v_bitop3_b32 v12, v6, v13, v12 bitop3:0xca
    v_lshl_add_u32 v11, v11, 17, s40
    v_lshlrev_b16 v14, 8, v14
    v_lshrrev_b32 v13, 2, v92
    v_add_u32 v88, v12, v11
    v_bitop3_b32 v92, v5, v13, v14 bitop3:0xea
    ds_add_u32 v92, v2
    v_mul_hi_u32_u24 v14, 429497, v89
    v_lshrrev_b32 v12, 3, v93
    v_cos_f32 v8, v8
    v_lshlrev_b16 v13, 3, v93
    v_mad_i32_i24 v11, v14, s55, v89
    v_bitop3_b32 v12, v6, v13, v12 bitop3:0xca
    v_lshl_add_u32 v11, v11, 17, s40
    v_lshlrev_b16 v14, 8, v14
    v_lshrrev_b32 v13, 2, v93
    v_add_u32 v89, v12, v11
    v_bitop3_b32 v93, v5, v13, v14 bitop3:0xea
    ds_add_u32 v93, v2
    v_cvt_pk_bf16_f32 v86, v7, v8
    v_perm_b32 v12, v86, v86, s41
    v_bitop3_b32 v88, v4, v12, v88 bitop3:0xca
    v_perm_b32 v13, v86, v86, s42
    v_bitop3_b32 v89, v4, v13, v89 bitop3:0xca
    v_mul_hi_u32_u24 v14, 429497, v90
    v_lshrrev_b32 v12, 3, v94
    v_cos_f32 v9, v9
    v_lshlrev_b16 v13, 3, v94
    v_mad_i32_i24 v11, v14, s55, v90
    v_bitop3_b32 v12, v6, v13, v12 bitop3:0xca
    v_lshl_add_u32 v11, v11, 17, s40
    v_lshlrev_b16 v14, 8, v14
    v_lshrrev_b32 v13, 2, v94
    v_add_u32 v90, v12, v11
    v_bitop3_b32 v94, v5, v13, v14 bitop3:0xea
    ds_add_u32 v94, v2
    v_mul_hi_u32_u24 v14, 429497, v91
    v_lshrrev_b32 v12, 3, v95
    v_cos_f32 v10, v10
    v_lshlrev_b16 v13, 3, v95
    v_mad_i32_i24 v11, v14, s55, v91
    v_bitop3_b32 v12, v6, v13, v12 bitop3:0xca
    v_lshl_add_u32 v11, v11, 17, s40
    v_lshlrev_b16 v14, 8, v14
    v_lshrrev_b32 v13, 2, v95
    v_add_u32 v91, v12, v11
    v_bitop3_b32 v95, v5, v13, v14 bitop3:0xea
    ds_add_u32 v95, v2
    v_cvt_pk_bf16_f32 v87, v9, v10
    v_perm_b32 v12, v87, v87, s41
    v_bitop3_b32 v90, v4, v12, v90 bitop3:0xca
    v_perm_b32 v13, v87, v87, s42
    v_bitop3_b32 v91, v4, v13, v91 bitop3:0xca
    v_lshrrev_b32 v8, 2, v0
    v_and_b32 v7, 0x3c00, v0
    v_bitop3_b32 v7, v5, v8, v7 bitop3:0xea
    s_waitcnt lgkmcnt(0)
    s_barrier
    ds_read2st64_b32 v[8:9], v7 offset0:0 offset1:1
    ds_read2st64_b32 v[10:11], v7 offset0:2 offset1:3
    s_add_u32 s45, s97, 0x2400000
    v_lshlrev_b32 v112, 1, v1
    buffer_load_dwordx4 v[112:115], v112, s[12:15], s45 offen nt
    s_waitcnt lgkmcnt(0)
    v_lshl_or_b32 v12, v9, 16, v8
    v_lshl_or_b32 v13, v11, 16, v10
    v_mov_b32 v14, v12
    v_mov_b32 v15, v13
    s_nop 0
    v_add_u32_dpp v14, v14, v14 row_shr:1 row_mask:0xf bank_mask:0xf bound_ctrl:1
    v_add_u32_dpp v15, v15, v15 row_shr:1 row_mask:0xf bank_mask:0xf bound_ctrl:1
    s_nop 0
    v_add_u32_dpp v14, v14, v14 row_shr:2 row_mask:0xf bank_mask:0xf bound_ctrl:1
    v_add_u32_dpp v15, v15, v15 row_shr:2 row_mask:0xf bank_mask:0xf bound_ctrl:1
    s_nop 0
    v_add_u32_dpp v14, v14, v14 row_shr:4 row_mask:0xf bank_mask:0xf bound_ctrl:1
    v_add_u32_dpp v15, v15, v15 row_shr:4 row_mask:0xf bank_mask:0xf bound_ctrl:1
    s_nop 0
    v_add_u32_dpp v14, v14, v14 row_shr:8 row_mask:0xf bank_mask:0xf bound_ctrl:1
    v_add_u32_dpp v15, v15, v15 row_shr:8 row_mask:0xf bank_mask:0xf bound_ctrl:1
    s_nop 0
    v_add_u32_dpp v14, v14, v14 row_bcast:15 row_mask:0xa bank_mask:0xf
    v_add_u32_dpp v15, v15, v15 row_bcast:15 row_mask:0xa bank_mask:0xf
    s_nop 0
    v_add_u32_dpp v14, v14, v14 row_bcast:31 row_mask:0xc bank_mask:0xf
    v_add_u32_dpp v15, v15, v15 row_bcast:31 row_mask:0xc bank_mask:0xf
    v_readlane_b32 s48, v14, 63
    v_readlane_b32 s49, v15, 63
    s_lshl_b32 s54, s32, 2
    v_mov_b32 v8, s54
    s_and_b32 s50, s48, 0xffff
    s_lshr_b32 s51, s48, 16
    s_and_b32 s52, s49, 0xffff
    s_lshr_b32 s53, s49, 16
    s_add_u32 s51, s51, s50
    s_add_u32 s52, s52, s51
    s_add_u32 s53, s53, s52
    v_mov_b32 v9, s53
    s_mov_b64 exec, 1
    ds_write_b32 v8, v9 offset:16384
    s_mov_b64 exec, -1
    v_and_b32 v8, 60, v7
    s_waitcnt lgkmcnt(0)
    s_barrier
    ds_read_b32 v9, v8 offset:16384
    s_waitcnt lgkmcnt(0)
    v_add_u32_dpp v9, v9, v9 row_shr:1 row_mask:0xf bank_mask:0xf bound_ctrl:1
    s_nop 1
    v_add_u32_dpp v9, v9, v9 row_shr:2 row_mask:0xf bank_mask:0xf bound_ctrl:1
    s_nop 1
    v_add_u32_dpp v9, v9, v9 row_shr:4 row_mask:0xf bank_mask:0xf bound_ctrl:1
    s_nop 1
    v_add_u32_dpp v9, v9, v9 row_shr:8 row_mask:0xf bank_mask:0xf bound_ctrl:1
    s_nop 0
    v_readlane_b32 s54, v9, s32
    s_sub_u32 s54, s54, s53
    s_add_u32 s50, s50, s54
    s_add_u32 s51, s51, s54
    s_add_u32 s52, s52, s54
    s_pack_ll_b32_b16 s48, s54, s50
    s_pack_ll_b32_b16 s49, s51, s52
    v_add_u32 v14, s48, v14
    v_add_u32 v15, s49, v15
    v_sub_u32 v12, v14, v12
    v_sub_u32 v13, v15, v13
    v_and_b32 v8, 0xffff, v12
    v_lshrrev_b32 v9, 16, v12
    v_and_b32 v10, 0xffff, v13
    v_lshrrev_b32 v11, 16, v13
    ds_write2st64_b32 v7, v8, v9 offset0:0 offset1:1
    ds_write2st64_b32 v7, v10, v11 offset0:2 offset1:3
    v_and_b32 v8, 0x3f0, v0
    v_lshl_add_u32 v8, v8, 1, s36
    ds_write_b64 v8, v[12:13] offset:20480
    s_bitset0_b64 exec, 63
    s_not_b64 exec, exec
    ds_write_b64 v8, v[14:15] offset:20512
    s_mov_b64 exec, -1
    s_waitcnt lgkmcnt(0)
    s_barrier
    s_setprio 3
    ds_add_rtn_u32 v20, v20, v2
    ds_add_rtn_u32 v21, v21, v2
    ds_add_rtn_u32 v22, v22, v2
    ds_add_rtn_u32 v23, v23, v2
    ds_read_b128 v[12:15], v0 offset:20480
    v_cmp_gt_u32 vcc, 8448, v0
    ds_add_rtn_u32 v32, v32, v2
    ds_add_rtn_u32 v33, v33, v2
    ds_add_rtn_u32 v34, v34, v2
    ds_add_rtn_u32 v35, v35, v2
    s_setprio 2
    ds_add_rtn_u32 v40, v40, v2
    ds_add_rtn_u32 v41, v41, v2
    ds_add_rtn_u32 v42, v42, v2
    ds_add_rtn_u32 v43, v43, v2
    s_waitcnt lgkmcnt(8)
    s_cbranch_vccz L1_p1
    s_add_u32 s46, s35, 0x0
    s_mov_b64 exec, vcc
    buffer_store_dwordx4 v[12:15], v0, s[24:27], s46 offen sc1
    s_mov_b64 exec, -1
L1_p1:
    s_add_u32 s47, s98, 0x2800000
    v_lshlrev_b32 v116, 1, v1
    buffer_load_dwordx4 v[116:119], v116, s[8:11], s47 offen nt
    ds_add_rtn_u32 v52, v52, v2
    ds_add_rtn_u32 v53, v53, v2
    ds_add_rtn_u32 v54, v54, v2
    ds_add_rtn_u32 v55, v55, v2
    s_setprio 1
    ds_add_rtn_u32 v60, v60, v2
    ds_add_rtn_u32 v61, v61, v2
    ds_add_rtn_u32 v62, v62, v2
    ds_add_rtn_u32 v63, v63, v2
    ds_add_rtn_u32 v72, v72, v2
    ds_add_rtn_u32 v73, v73, v2
    ds_add_rtn_u32 v74, v74, v2
    ds_add_rtn_u32 v75, v75, v2
    s_add_u32 s44, s98, 0x2800000
    v_lshlrev_b32 v120, 1, v1
    buffer_load_dwordx4 v[120:123], v120, s[12:15], s44 offen nt
    s_setprio 0
    ds_add_rtn_u32 v80, v80, v2
    ds_add_rtn_u32 v81, v81, v2
    ds_add_rtn_u32 v82, v82, v2
    ds_add_rtn_u32 v83, v83, v2
    ds_add_rtn_u32 v92, v92, v2
    ds_add_rtn_u32 v93, v93, v2
    ds_add_rtn_u32 v94, v94, v2
    ds_add_rtn_u32 v95, v95, v2
    s_waitcnt lgkmcnt(0)
    s_barrier
    s_setprio 3
    v_and_b32 v7, -4, v20
    v_lshl_add_u32 v8, v20, 2, v7
    ds_write_b32 v8, v16
    v_lshl_add_u32 v7, v7, 2, v20
    ds_write_b8 v7, v24 offset:16
    v_and_b32 v9, -4, v21
    v_lshl_add_u32 v10, v21, 2, v9
    ds_write_b32 v10, v17
    v_lshl_add_u32 v9, v9, 2, v21
    ds_write_b8_d16_hi v9, v24 offset:16
    v_and_b32 v7, -4, v22
    v_lshl_add_u32 v8, v22, 2, v7
    ds_write_b32 v8, v18
    v_lshl_add_u32 v7, v7, 2, v22
    ds_write_b8 v7, v25 offset:16
    v_and_b32 v9, -4, v23
    v_lshl_add_u32 v10, v23, 2, v9
    ds_write_b32 v10, v19
    v_lshl_add_u32 v9, v9, 2, v23
    ds_write_b8_d16_hi v9, v25 offset:16
    s_add_u32 s45, s98, 0x2800000
    s_lshr_b32 s45, s45, 1
    buffer_load_dwordx2 v[124:125], v1, s[16:19], s45 offen nt
    s_add_u32 s46, s99, 0x2c00000
    s_lshr_b32 s46, s46, 1
    buffer_load_dwordx2 v[126:127], v1, s[16:19], s46 offen nt
    s_add_u32 s47, s99, 0x2c00000
    v_lshlrev_b32 v16, 1, v1
    buffer_load_dwordx4 v[16:19], v16, s[8:11], s47 offen nt
    v_and_b32 v7, -4, v32
    v_lshl_add_u32 v8, v32, 2, v7
    ds_write_b32 v8, v28
    v_lshl_add_u32 v7, v7, 2, v32
    ds_write_b8 v7, v26 offset:16
    v_and_b32 v9, -4, v33
    v_lshl_add_u32 v10, v33, 2, v9
    ds_write_b32 v10, v29
    v_lshl_add_u32 v9, v9, 2, v33
    ds_write_b8_d16_hi v9, v26 offset:16
    v_and_b32 v7, -4, v34
    v_lshl_add_u32 v8, v34, 2, v7
    ds_write_b32 v8, v30
    v_lshl_add_u32 v7, v7, 2, v34
    ds_write_b8 v7, v27 offset:16
    v_and_b32 v9, -4, v35
    v_lshl_add_u32 v10, v35, 2, v9
    ds_write_b32 v10, v31
    v_lshl_add_u32 v9, v9, 2, v35
    ds_write_b8_d16_hi v9, v27 offset:16
    s_add_u32 s44, s99, 0x2c00000
    v_lshlrev_b32 v20, 1, v1
    buffer_load_dwordx4 v[20:23], v20, s[12:15], s44 offen nt
    s_setprio 2
    v_and_b32 v7, -4, v40
    v_lshl_add_u32 v8, v40, 2, v7
    ds_write_b32 v8, v36
    v_lshl_add_u32 v7, v7, 2, v40
    ds_write_b8 v7, v44 offset:16
    v_and_b32 v9, -4, v41
    v_lshl_add_u32 v10, v41, 2, v9
    ds_write_b32 v10, v37
    v_lshl_add_u32 v9, v9, 2, v41
    ds_write_b8_d16_hi v9, v44 offset:16
    v_and_b32 v7, -4, v42
    v_lshl_add_u32 v8, v42, 2, v7
    ds_write_b32 v8, v38
    v_lshl_add_u32 v7, v7, 2, v42
    ds_write_b8 v7, v45 offset:16
    v_and_b32 v9, -4, v43
    v_lshl_add_u32 v10, v43, 2, v9
    ds_write_b32 v10, v39
    v_lshl_add_u32 v9, v9, 2, v43
    ds_write_b8_d16_hi v9, v45 offset:16
    s_add_u32 s45, s96, 0x3000000
    v_lshlrev_b32 v28, 1, v1
    buffer_load_dwordx4 v[28:31], v28, s[8:11], s45 offen nt
    s_add_u32 s46, s96, 0x3000000
    v_lshlrev_b32 v32, 1, v1
    buffer_load_dwordx4 v[32:35], v32, s[12:15], s46 offen nt
    v_and_b32 v7, -4, v52
    v_lshl_add_u32 v8, v52, 2, v7
    ds_write_b32 v8, v48
    v_lshl_add_u32 v7, v7, 2, v52
    ds_write_b8 v7, v46 offset:16
    v_and_b32 v9, -4, v53
    v_lshl_add_u32 v10, v53, 2, v9
    ds_write_b32 v10, v49
    v_lshl_add_u32 v9, v9, 2, v53
    ds_write_b8_d16_hi v9, v46 offset:16
    v_and_b32 v7, -4, v54
    v_lshl_add_u32 v8, v54, 2, v7
    ds_write_b32 v8, v50
    v_lshl_add_u32 v7, v7, 2, v54
    ds_write_b8 v7, v47 offset:16
    v_and_b32 v9, -4, v55
    v_lshl_add_u32 v10, v55, 2, v9
    ds_write_b32 v10, v51
    v_lshl_add_u32 v9, v9, 2, v55
    ds_write_b8_d16_hi v9, v47 offset:16
    s_add_u32 s47, s96, 0x3000000
    s_lshr_b32 s47, s47, 1
    buffer_load_dwordx2 v[24:25], v1, s[16:19], s47 offen nt
    s_add_u32 s44, s97, 0x3400000
    s_lshr_b32 s44, s44, 1
    buffer_load_dwordx2 v[26:27], v1, s[16:19], s44 offen nt
    s_setprio 1
    v_and_b32 v7, -4, v60
    v_lshl_add_u32 v8, v60, 2, v7
    ds_write_b32 v8, v56
    v_lshl_add_u32 v7, v7, 2, v60
    ds_write_b8 v7, v64 offset:16
    v_and_b32 v9, -4, v61
    v_lshl_add_u32 v10, v61, 2, v9
    ds_write_b32 v10, v57
    v_lshl_add_u32 v9, v9, 2, v61
    ds_write_b8_d16_hi v9, v64 offset:16
    v_and_b32 v7, -4, v62
    v_lshl_add_u32 v8, v62, 2, v7
    ds_write_b32 v8, v58
    v_lshl_add_u32 v7, v7, 2, v62
    ds_write_b8 v7, v65 offset:16
    v_and_b32 v9, -4, v63
    v_lshl_add_u32 v10, v63, 2, v9
    ds_write_b32 v10, v59
    v_lshl_add_u32 v9, v9, 2, v63
    ds_write_b8_d16_hi v9, v65 offset:16
    s_add_u32 s45, s97, 0x3400000
    v_lshlrev_b32 v36, 1, v1
    buffer_load_dwordx4 v[36:39], v36, s[8:11], s45 offen nt
    v_and_b32 v7, -4, v72
    v_lshl_add_u32 v8, v72, 2, v7
    ds_write_b32 v8, v68
    v_lshl_add_u32 v7, v7, 2, v72
    ds_write_b8 v7, v66 offset:16
    v_and_b32 v9, -4, v73
    v_lshl_add_u32 v10, v73, 2, v9
    ds_write_b32 v10, v69
    v_lshl_add_u32 v9, v9, 2, v73
    ds_write_b8_d16_hi v9, v66 offset:16
    v_and_b32 v7, -4, v74
    v_lshl_add_u32 v8, v74, 2, v7
    ds_write_b32 v8, v70
    v_lshl_add_u32 v7, v7, 2, v74
    ds_write_b8 v7, v67 offset:16
    v_and_b32 v9, -4, v75
    v_lshl_add_u32 v10, v75, 2, v9
    ds_write_b32 v10, v71
    v_lshl_add_u32 v9, v9, 2, v75
    ds_write_b8_d16_hi v9, v67 offset:16
    s_add_u32 s46, s97, 0x3400000
    v_lshlrev_b32 v40, 1, v1
    buffer_load_dwordx4 v[40:43], v40, s[12:15], s46 offen nt
    s_add_u32 s47, s98, 0x3800000
    v_lshlrev_b32 v48, 1, v1
    buffer_load_dwordx4 v[48:51], v48, s[8:11], s47 offen nt
    s_setprio 0
    v_and_b32 v7, -4, v80
    v_lshl_add_u32 v8, v80, 2, v7
    ds_write_b32 v8, v76
    v_lshl_add_u32 v7, v7, 2, v80
    ds_write_b8 v7, v84 offset:16
    v_and_b32 v9, -4, v81
    v_lshl_add_u32 v10, v81, 2, v9
    ds_write_b32 v10, v77
    v_lshl_add_u32 v9, v9, 2, v81
    ds_write_b8_d16_hi v9, v84 offset:16
    v_and_b32 v7, -4, v82
    v_lshl_add_u32 v8, v82, 2, v7
    ds_write_b32 v8, v78
    v_lshl_add_u32 v7, v7, 2, v82
    ds_write_b8 v7, v85 offset:16
    v_and_b32 v9, -4, v83
    v_lshl_add_u32 v10, v83, 2, v9
    ds_write_b32 v10, v79
    v_lshl_add_u32 v9, v9, 2, v83
    ds_write_b8_d16_hi v9, v85 offset:16
    s_add_u32 s44, s98, 0x3800000
    v_lshlrev_b32 v52, 1, v1
    buffer_load_dwordx4 v[52:55], v52, s[12:15], s44 offen nt
    v_and_b32 v7, -4, v92
    v_lshl_add_u32 v8, v92, 2, v7
    ds_write_b32 v8, v88
    v_lshl_add_u32 v7, v7, 2, v92
    ds_write_b8 v7, v86 offset:16
    v_and_b32 v9, -4, v93
    v_lshl_add_u32 v10, v93, 2, v9
    ds_write_b32 v10, v89
    v_lshl_add_u32 v9, v9, 2, v93
    ds_write_b8_d16_hi v9, v86 offset:16
    v_and_b32 v7, -4, v94
    v_lshl_add_u32 v8, v94, 2, v7
    ds_write_b32 v8, v90
    v_lshl_add_u32 v7, v7, 2, v94
    ds_write_b8 v7, v87 offset:16
    v_and_b32 v9, -4, v95
    v_lshl_add_u32 v10, v95, 2, v9
    ds_write_b32 v10, v91
    v_lshl_add_u32 v9, v9, 2, v95
    ds_write_b8_d16_hi v9, v87 offset:16
    s_add_u32 s45, s98, 0x3800000
    s_lshr_b32 s45, s45, 1
    buffer_load_dwordx2 v[44:45], v1, s[16:19], s45 offen nt
    s_add_u32 s46, s99, 0x3c00000
    s_lshr_b32 s46, s46, 1
    buffer_load_dwordx2 v[46:47], v1, s[16:19], s46 offen nt
    v_add_u32 v7, s72, v0
    v_add_u32 v12, s73, v0
    v_add_u32 v13, s85, v0
    v_add_u32 v14, s91, v0
    v_add_u32 v15, s93, v0
    s_min_i32 s3, s72, s73
    s_min_i32 s3, s3, s85
    s_min_i32 s3, s3, s91
    s_min_i32 s3, s3, s93
    v_add_u32 v3, s3, v0
    v_mov_b32 v8, 0
    v_mov_b32 v9, 0
    v_mov_b32 v10, 0
    v_mov_b32 v11, 0
    s_waitcnt lgkmcnt(0)
    s_barrier
    ds_read_b128 v[56:59], v7 offset:0
    ds_read_b128 v[60:63], v12 offset:0
    ds_read_b128 v[68:71], v13 offset:0
    ds_read_b128 v[72:75], v14 offset:0
    ds_read_b128 v[64:67], v15 offset:0
    ds_write_b128 v3, v[8:11]
    ds_read_b128 v[76:79], v7 offset:16384
    ds_read_b128 v[80:83], v12 offset:16384
    ds_read_b128 v[88:91], v13 offset:16384
    ds_read_b128 v[92:95], v14 offset:16384
    ds_read_b128 v[84:87], v15 offset:16384
    s_waitcnt lgkmcnt(0)
    s_barrier
    s_setprio 3
    s_add_u32 s47, s35, 0x4000
    s_add_u32 s47, s47, s72
    buffer_store_dwordx4 v[56:59], v0, s[20:23], s47 offen sc1
    s_add_u32 s44, s99, 0x3c00000
    s_nop 0
    v_lshlrev_b32 v56, 1, v1
    buffer_load_dwordx4 v[56:59], v56, s[8:11], s44 offen nt
    s_add_u32 s45, s35, 0x4000
    s_add_u32 s45, s45, s73
    buffer_store_dwordx4 v[60:63], v0, s[20:23], s45 offen sc1
    s_add_u32 s46, s99, 0x3c00000
    s_nop 0
    v_lshlrev_b32 v60, 1, v1
    buffer_load_dwordx4 v[60:63], v60, s[12:15], s46 offen nt
    s_waitcnt vmcnt(22)
    v_lshlrev_b32 v7, 16, v108
    v_and_b32 v8, 0xffff0000, v108
    v_lshlrev_b32 v9, 16, v109
    v_and_b32 v10, 0xffff0000, v109
    v_mul_f32 v7, 0.15915494, v7
    v_mul_f32 v8, 0.15915494, v8
    v_mul_f32 v9, 0.15915494, v9
    v_mul_f32 v10, 0.15915494, v10
    v_mul_hi_u32_u24 v14, 429497, v96
    v_lshrrev_b32 v12, 3, v104
    v_cos_f32 v7, v7
    v_lshlrev_b16 v13, 3, v104
    v_mad_i32_i24 v11, v14, s55, v96
    v_bitop3_b32 v12, v6, v13, v12 bitop3:0xca
    v_lshl_add_u32 v11, v11, 17, s40
    v_lshlrev_b16 v14, 8, v14
    v_lshrrev_b32 v13, 2, v104
    v_add_u32 v96, v12, v11
    v_bitop3_b32 v104, v5, v13, v14 bitop3:0xea
    ds_add_u32 v104, v2
    v_mul_hi_u32_u24 v14, 429497, v97
    v_lshrrev_b32 v12, 3, v105
    v_cos_f32 v8, v8
    v_lshlrev_b16 v13, 3, v105
    v_mad_i32_i24 v11, v14, s55, v97
    v_bitop3_b32 v12, v6, v13, v12 bitop3:0xca
    v_lshl_add_u32 v11, v11, 17, s40
    v_lshlrev_b16 v14, 8, v14
    v_lshrrev_b32 v13, 2, v105
    v_add_u32 v97, v12, v11
    v_bitop3_b32 v105, v5, v13, v14 bitop3:0xea
    ds_add_u32 v105, v2
    v_cvt_pk_bf16_f32 v108, v7, v8
    v_perm_b32 v12, v108, v108, s41
    v_bitop3_b32 v96, v4, v12, v96 bitop3:0xca
    v_perm_b32 v13, v108, v108, s42
    v_bitop3_b32 v97, v4, v13, v97 bitop3:0xca
    v_mul_hi_u32_u24 v14, 429497, v98
    v_lshrrev_b32 v12, 3, v106
    v_cos_f32 v9, v9
    v_lshlrev_b16 v13, 3, v106
    v_mad_i32_i24 v11, v14, s55, v98
    v_bitop3_b32 v12, v6, v13, v12 bitop3:0xca
    v_lshl_add_u32 v11, v11, 17, s40
    v_lshlrev_b16 v14, 8, v14
    v_lshrrev_b32 v13, 2, v106
    v_add_u32 v98, v12, v11
    v_bitop3_b32 v106, v5, v13, v14 bitop3:0xea
    ds_add_u32 v106, v2
    v_mul_hi_u32_u24 v14, 429497, v99
    v_lshrrev_b32 v12, 3, v107
    v_cos_f32 v10, v10
    v_lshlrev_b16 v13, 3, v107
    v_mad_i32_i24 v11, v14, s55, v99
    v_bitop3_b32 v12, v6, v13, v12 bitop3:0xca
    v_lshl_add_u32 v11, v11, 17, s40
    v_lshlrev_b16 v14, 8, v14
    v_lshrrev_b32 v13, 2, v107
    v_add_u32 v99, v12, v11
    v_bitop3_b32 v107, v5, v13, v14 bitop3:0xea
    ds_add_u32 v107, v2
    v_cvt_pk_bf16_f32 v109, v9, v10
    v_perm_b32 v12, v109, v109, s41
    v_bitop3_b32 v98, v4, v12, v98 bitop3:0xca
    v_perm_b32 v13, v109, v109, s42
    v_bitop3_b32 v99, v4, v13, v99 bitop3:0xca
    s_waitcnt vmcnt(20)
    v_lshlrev_b32 v7, 16, v110
    v_and_b32 v8, 0xffff0000, v110
    v_lshlrev_b32 v9, 16, v111
    v_and_b32 v10, 0xffff0000, v111
    v_mul_f32 v7, 0.15915494, v7
    v_mul_f32 v8, 0.15915494, v8
    v_mul_f32 v9, 0.15915494, v9
    v_mul_f32 v10, 0.15915494, v10
    v_mul_hi_u32_u24 v14, 429497, v100
    v_lshrrev_b32 v12, 3, v112
    v_cos_f32 v7, v7
    v_lshlrev_b16 v13, 3, v112
    v_mad_i32_i24 v11, v14, s55, v100
    v_bitop3_b32 v12, v6, v13, v12 bitop3:0xca
    v_lshl_add_u32 v11, v11, 17, s40
    v_lshlrev_b16 v14, 8, v14
    v_lshrrev_b32 v13, 2, v112
    v_add_u32 v100, v12, v11
    v_bitop3_b32 v112, v5, v13, v14 bitop3:0xea
    ds_add_u32 v112, v2
    v_mul_hi_u32_u24 v14, 429497, v101
    v_lshrrev_b32 v12, 3, v113
    v_cos_f32 v8, v8
    v_lshlrev_b16 v13, 3, v113
    v_mad_i32_i24 v11, v14, s55, v101
    v_bitop3_b32 v12, v6, v13, v12 bitop3:0xca
    v_lshl_add_u32 v11, v11, 17, s40
    v_lshlrev_b16 v14, 8, v14
    v_lshrrev_b32 v13, 2, v113
    v_add_u32 v101, v12, v11
    v_bitop3_b32 v113, v5, v13, v14 bitop3:0xea
    ds_add_u32 v113, v2
    v_cvt_pk_bf16_f32 v110, v7, v8
    v_perm_b32 v12, v110, v110, s41
    v_bitop3_b32 v100, v4, v12, v100 bitop3:0xca
    v_perm_b32 v13, v110, v110, s42
    v_bitop3_b32 v101, v4, v13, v101 bitop3:0xca
    v_mul_hi_u32_u24 v14, 429497, v102
    v_lshrrev_b32 v12, 3, v114
    v_cos_f32 v9, v9
    v_lshlrev_b16 v13, 3, v114
    v_mad_i32_i24 v11, v14, s55, v102
    v_bitop3_b32 v12, v6, v13, v12 bitop3:0xca
    v_lshl_add_u32 v11, v11, 17, s40
    v_lshlrev_b16 v14, 8, v14
    v_lshrrev_b32 v13, 2, v114
    v_add_u32 v102, v12, v11
    v_bitop3_b32 v114, v5, v13, v14 bitop3:0xea
    ds_add_u32 v114, v2
    v_mul_hi_u32_u24 v14, 429497, v103
    v_lshrrev_b32 v12, 3, v115
    v_cos_f32 v10, v10
    v_lshlrev_b16 v13, 3, v115
    v_mad_i32_i24 v11, v14, s55, v103
    v_bitop3_b32 v12, v6, v13, v12 bitop3:0xca
    v_lshl_add_u32 v11, v11, 17, s40
    v_lshlrev_b16 v14, 8, v14
    v_lshrrev_b32 v13, 2, v115
    v_add_u32 v103, v12, v11
    v_bitop3_b32 v115, v5, v13, v14 bitop3:0xea
    ds_add_u32 v115, v2
    v_cvt_pk_bf16_f32 v111, v9, v10
    v_perm_b32 v12, v111, v111, s41
    v_bitop3_b32 v102, v4, v12, v102 bitop3:0xca
    v_perm_b32 v13, v111, v111, s42
    v_bitop3_b32 v103, v4, v13, v103 bitop3:0xca
    s_setprio 2
    s_waitcnt vmcnt(16)
    v_lshlrev_b32 v7, 16, v124
    v_and_b32 v8, 0xffff0000, v124
    v_lshlrev_b32 v9, 16, v125
    v_and_b32 v10, 0xffff0000, v125
    v_mul_f32 v7, 0.15915494, v7
    v_mul_f32 v8, 0.15915494, v8
    v_mul_f32 v9, 0.15915494, v9
    v_mul_f32 v10, 0.15915494, v10
    v_mul_hi_u32_u24 v14, 429497, v116
    v_lshrrev_b32 v12, 3, v120
    v_cos_f32 v7, v7
    v_lshlrev_b16 v13, 3, v120
    v_mad_i32_i24 v11, v14, s55, v116
    v_bitop3_b32 v12, v6, v13, v12 bitop3:0xca
    v_lshl_add_u32 v11, v11, 17, s40
    v_lshlrev_b16 v14, 8, v14
    v_lshrrev_b32 v13, 2, v120
    v_add_u32 v116, v12, v11
    v_bitop3_b32 v120, v5, v13, v14 bitop3:0xea
    ds_add_u32 v120, v2
    v_mul_hi_u32_u24 v14, 429497, v117
    v_lshrrev_b32 v12, 3, v121
    v_cos_f32 v8, v8
    v_lshlrev_b16 v13, 3, v121
    v_mad_i32_i24 v11, v14, s55, v117
    v_bitop3_b32 v12, v6, v13, v12 bitop3:0xca
    v_lshl_add_u32 v11, v11, 17, s40
    v_lshlrev_b16 v14, 8, v14
    v_lshrrev_b32 v13, 2, v121
    v_add_u32 v117, v12, v11
    v_bitop3_b32 v121, v5, v13, v14 bitop3:0xea
    ds_add_u32 v121, v2
    v_cvt_pk_bf16_f32 v124, v7, v8
    v_perm_b32 v12, v124, v124, s41
    v_bitop3_b32 v116, v4, v12, v116 bitop3:0xca
    v_perm_b32 v13, v124, v124, s42
    v_bitop3_b32 v117, v4, v13, v117 bitop3:0xca
    v_mul_hi_u32_u24 v14, 429497, v118
    v_lshrrev_b32 v12, 3, v122
    v_cos_f32 v9, v9
    v_lshlrev_b16 v13, 3, v122
    v_mad_i32_i24 v11, v14, s55, v118
    v_bitop3_b32 v12, v6, v13, v12 bitop3:0xca
    v_lshl_add_u32 v11, v11, 17, s40
    v_lshlrev_b16 v14, 8, v14
    v_lshrrev_b32 v13, 2, v122
    v_add_u32 v118, v12, v11
    v_bitop3_b32 v122, v5, v13, v14 bitop3:0xea
    ds_add_u32 v122, v2
    v_mul_hi_u32_u24 v14, 429497, v119
    v_lshrrev_b32 v12, 3, v123
    v_cos_f32 v10, v10
    v_lshlrev_b16 v13, 3, v123
    v_mad_i32_i24 v11, v14, s55, v119
    v_bitop3_b32 v12, v6, v13, v12 bitop3:0xca
    v_lshl_add_u32 v11, v11, 17, s40
    v_lshlrev_b16 v14, 8, v14
    v_lshrrev_b32 v13, 2, v123
    v_add_u32 v119, v12, v11
    v_bitop3_b32 v123, v5, v13, v14 bitop3:0xea
    ds_add_u32 v123, v2
    v_cvt_pk_bf16_f32 v125, v9, v10
    v_perm_b32 v12, v125, v125, s41
    v_bitop3_b32 v118, v4, v12, v118 bitop3:0xca
    v_perm_b32 v13, v125, v125, s42
    v_bitop3_b32 v119, v4, v13, v119 bitop3:0xca
    s_add_u32 s47, s35, 0x4000
    s_add_u32 s47, s47, s85
    buffer_store_dwordx4 v[68:71], v0, s[20:23], s47 offen sc1
    s_add_u32 s44, s96, 0x4000000
    s_nop 0
    v_lshlrev_b32 v68, 1, v1
    buffer_load_dwordx4 v[68:71], v68, s[8:11], s44 offen nt
    s_waitcnt vmcnt(16)
    v_lshlrev_b32 v7, 16, v126
    v_and_b32 v8, 0xffff0000, v126
    v_lshlrev_b32 v9, 16, v127
    v_and_b32 v10, 0xffff0000, v127
    v_mul_f32 v7, 0.15915494, v7
    v_mul_f32 v8, 0.15915494, v8
    v_mul_f32 v9, 0.15915494, v9
    v_mul_f32 v10, 0.15915494, v10
    v_mul_hi_u32_u24 v14, 429497, v16
    v_lshrrev_b32 v12, 3, v20
    v_cos_f32 v7, v7
    v_lshlrev_b16 v13, 3, v20
    v_mad_i32_i24 v11, v14, s55, v16
    v_bitop3_b32 v12, v6, v13, v12 bitop3:0xca
    v_lshl_add_u32 v11, v11, 17, s40
    v_lshlrev_b16 v14, 8, v14
    v_lshrrev_b32 v13, 2, v20
    v_add_u32 v16, v12, v11
    v_bitop3_b32 v20, v5, v13, v14 bitop3:0xea
    ds_add_u32 v20, v2
    v_mul_hi_u32_u24 v14, 429497, v17
    v_lshrrev_b32 v12, 3, v21
    v_cos_f32 v8, v8
    v_lshlrev_b16 v13, 3, v21
    v_mad_i32_i24 v11, v14, s55, v17
    v_bitop3_b32 v12, v6, v13, v12 bitop3:0xca
    v_lshl_add_u32 v11, v11, 17, s40
    v_lshlrev_b16 v14, 8, v14
    v_lshrrev_b32 v13, 2, v21
    v_add_u32 v17, v12, v11
    v_bitop3_b32 v21, v5, v13, v14 bitop3:0xea
    ds_add_u32 v21, v2
    v_cvt_pk_bf16_f32 v126, v7, v8
    v_perm_b32 v12, v126, v126, s41
    v_bitop3_b32 v16, v4, v12, v16 bitop3:0xca
    v_perm_b32 v13, v126, v126, s42
    v_bitop3_b32 v17, v4, v13, v17 bitop3:0xca
    v_mul_hi_u32_u24 v14, 429497, v18
    v_lshrrev_b32 v12, 3, v22
    v_cos_f32 v9, v9
    v_lshlrev_b16 v13, 3, v22
    v_mad_i32_i24 v11, v14, s55, v18
    v_bitop3_b32 v12, v6, v13, v12 bitop3:0xca
    v_lshl_add_u32 v11, v11, 17, s40
    v_lshlrev_b16 v14, 8, v14
    v_lshrrev_b32 v13, 2, v22
    v_add_u32 v18, v12, v11
    v_bitop3_b32 v22, v5, v13, v14 bitop3:0xea
    ds_add_u32 v22, v2
    v_mul_hi_u32_u24 v14, 429497, v19
    v_lshrrev_b32 v12, 3, v23
    v_cos_f32 v10, v10
    v_lshlrev_b16 v13, 3, v23
    v_mad_i32_i24 v11, v14, s55, v19
    v_bitop3_b32 v12, v6, v13, v12 bitop3:0xca
    v_lshl_add_u32 v11, v11, 17, s40
    v_lshlrev_b16 v14, 8, v14
    v_lshrrev_b32 v13, 2, v23
    v_add_u32 v19, v12, v11
    v_bitop3_b32 v23, v5, v13, v14 bitop3:0xea
    ds_add_u32 v23, v2
    v_cvt_pk_bf16_f32 v127, v9, v10
    v_perm_b32 v12, v127, v127, s41
    v_bitop3_b32 v18, v4, v12, v18 bitop3:0xca
    v_perm_b32 v13, v127, v127, s42
    v_bitop3_b32 v19, v4, v13, v19 bitop3:0xca
    s_setprio 1
    s_waitcnt vmcnt(12)
    v_lshlrev_b32 v7, 16, v24
    v_and_b32 v8, 0xffff0000, v24
    v_lshlrev_b32 v9, 16, v25
    v_and_b32 v10, 0xffff0000, v25
    v_mul_f32 v7, 0.15915494, v7
    v_mul_f32 v8, 0.15915494, v8
    v_mul_f32 v9, 0.15915494, v9
    v_mul_f32 v10, 0.15915494, v10
    v_mul_hi_u32_u24 v14, 429497, v28
    v_lshrrev_b32 v12, 3, v32
    v_cos_f32 v7, v7
    v_lshlrev_b16 v13, 3, v32
    v_mad_i32_i24 v11, v14, s55, v28
    v_bitop3_b32 v12, v6, v13, v12 bitop3:0xca
    v_lshl_add_u32 v11, v11, 17, s40
    v_lshlrev_b16 v14, 8, v14
    v_lshrrev_b32 v13, 2, v32
    v_add_u32 v28, v12, v11
    v_bitop3_b32 v32, v5, v13, v14 bitop3:0xea
    ds_add_u32 v32, v2
    v_mul_hi_u32_u24 v14, 429497, v29
    v_lshrrev_b32 v12, 3, v33
    v_cos_f32 v8, v8
    v_lshlrev_b16 v13, 3, v33
    v_mad_i32_i24 v11, v14, s55, v29
    v_bitop3_b32 v12, v6, v13, v12 bitop3:0xca
    v_lshl_add_u32 v11, v11, 17, s40
    v_lshlrev_b16 v14, 8, v14
    v_lshrrev_b32 v13, 2, v33
    v_add_u32 v29, v12, v11
    v_bitop3_b32 v33, v5, v13, v14 bitop3:0xea
    ds_add_u32 v33, v2
    v_cvt_pk_bf16_f32 v24, v7, v8
    v_perm_b32 v12, v24, v24, s41
    v_bitop3_b32 v28, v4, v12, v28 bitop3:0xca
    v_perm_b32 v13, v24, v24, s42
    v_bitop3_b32 v29, v4, v13, v29 bitop3:0xca
    v_mul_hi_u32_u24 v14, 429497, v30
    v_lshrrev_b32 v12, 3, v34
    v_cos_f32 v9, v9
    v_lshlrev_b16 v13, 3, v34
    v_mad_i32_i24 v11, v14, s55, v30
    v_bitop3_b32 v12, v6, v13, v12 bitop3:0xca
    v_lshl_add_u32 v11, v11, 17, s40
    v_lshlrev_b16 v14, 8, v14
    v_lshrrev_b32 v13, 2, v34
    v_add_u32 v30, v12, v11
    v_bitop3_b32 v34, v5, v13, v14 bitop3:0xea
    ds_add_u32 v34, v2
    v_mul_hi_u32_u24 v14, 429497, v31
    v_lshrrev_b32 v12, 3, v35
    v_cos_f32 v10, v10
    v_lshlrev_b16 v13, 3, v35
    v_mad_i32_i24 v11, v14, s55, v31
    v_bitop3_b32 v12, v6, v13, v12 bitop3:0xca
    v_lshl_add_u32 v11, v11, 17, s40
    v_lshlrev_b16 v14, 8, v14
    v_lshrrev_b32 v13, 2, v35
    v_add_u32 v31, v12, v11
    v_bitop3_b32 v35, v5, v13, v14 bitop3:0xea
    ds_add_u32 v35, v2
    v_cvt_pk_bf16_f32 v25, v9, v10
    v_perm_b32 v12, v25, v25, s41
    v_bitop3_b32 v30, v4, v12, v30 bitop3:0xca
    v_perm_b32 v13, v25, v25, s42
    v_bitop3_b32 v31, v4, v13, v31 bitop3:0xca
    s_waitcnt vmcnt(10)
    v_lshlrev_b32 v7, 16, v26
    v_and_b32 v8, 0xffff0000, v26
    v_lshlrev_b32 v9, 16, v27
    v_and_b32 v10, 0xffff0000, v27
    v_mul_f32 v7, 0.15915494, v7
    v_mul_f32 v8, 0.15915494, v8
    v_mul_f32 v9, 0.15915494, v9
    v_mul_f32 v10, 0.15915494, v10
    v_mul_hi_u32_u24 v14, 429497, v36
    v_lshrrev_b32 v12, 3, v40
    v_cos_f32 v7, v7
    v_lshlrev_b16 v13, 3, v40
    v_mad_i32_i24 v11, v14, s55, v36
    v_bitop3_b32 v12, v6, v13, v12 bitop3:0xca
    v_lshl_add_u32 v11, v11, 17, s40
    v_lshlrev_b16 v14, 8, v14
    v_lshrrev_b32 v13, 2, v40
    v_add_u32 v36, v12, v11
    v_bitop3_b32 v40, v5, v13, v14 bitop3:0xea
    ds_add_u32 v40, v2
    v_mul_hi_u32_u24 v14, 429497, v37
    v_lshrrev_b32 v12, 3, v41
    v_cos_f32 v8, v8
    v_lshlrev_b16 v13, 3, v41
    v_mad_i32_i24 v11, v14, s55, v37
    v_bitop3_b32 v12, v6, v13, v12 bitop3:0xca
    v_lshl_add_u32 v11, v11, 17, s40
    v_lshlrev_b16 v14, 8, v14
    v_lshrrev_b32 v13, 2, v41
    v_add_u32 v37, v12, v11
    v_bitop3_b32 v41, v5, v13, v14 bitop3:0xea
    ds_add_u32 v41, v2
    v_cvt_pk_bf16_f32 v26, v7, v8
    v_perm_b32 v12, v26, v26, s41
    v_bitop3_b32 v36, v4, v12, v36 bitop3:0xca
    v_perm_b32 v13, v26, v26, s42
    v_bitop3_b32 v37, v4, v13, v37 bitop3:0xca
    v_mul_hi_u32_u24 v14, 429497, v38
    v_lshrrev_b32 v12, 3, v42
    v_cos_f32 v9, v9
    v_lshlrev_b16 v13, 3, v42
    v_mad_i32_i24 v11, v14, s55, v38
    v_bitop3_b32 v12, v6, v13, v12 bitop3:0xca
    v_lshl_add_u32 v11, v11, 17, s40
    v_lshlrev_b16 v14, 8, v14
    v_lshrrev_b32 v13, 2, v42
    v_add_u32 v38, v12, v11
    v_bitop3_b32 v42, v5, v13, v14 bitop3:0xea
    ds_add_u32 v42, v2
    v_mul_hi_u32_u24 v14, 429497, v39
    v_lshrrev_b32 v12, 3, v43
    v_cos_f32 v10, v10
    v_lshlrev_b16 v13, 3, v43
    v_mad_i32_i24 v11, v14, s55, v39
    v_bitop3_b32 v12, v6, v13, v12 bitop3:0xca
    v_lshl_add_u32 v11, v11, 17, s40
    v_lshlrev_b16 v14, 8, v14
    v_lshrrev_b32 v13, 2, v43
    v_add_u32 v39, v12, v11
    v_bitop3_b32 v43, v5, v13, v14 bitop3:0xea
    ds_add_u32 v43, v2
    v_cvt_pk_bf16_f32 v27, v9, v10
    v_perm_b32 v12, v27, v27, s41
    v_bitop3_b32 v38, v4, v12, v38 bitop3:0xca
    v_perm_b32 v13, v27, v27, s42
    v_bitop3_b32 v39, v4, v13, v39 bitop3:0xca
    s_setprio 0
    s_add_u32 s45, s35, 0x4000
    s_add_u32 s45, s45, s91
    buffer_store_dwordx4 v[72:75], v0, s[20:23], s45 offen sc1
    s_add_u32 s46, s96, 0x4000000
    s_nop 0
    v_lshlrev_b32 v72, 1, v1
    buffer_load_dwordx4 v[72:75], v72, s[12:15], s46 offen nt
    s_waitcnt vmcnt(8)
    v_lshlrev_b32 v7, 16, v44
    v_and_b32 v8, 0xffff0000, v44
    v_lshlrev_b32 v9, 16, v45
    v_and_b32 v10, 0xffff0000, v45
    v_mul_f32 v7, 0.15915494, v7
    v_mul_f32 v8, 0.15915494, v8
    v_mul_f32 v9, 0.15915494, v9
    v_mul_f32 v10, 0.15915494, v10
    v_mul_hi_u32_u24 v14, 429497, v48
    v_lshrrev_b32 v12, 3, v52
    v_cos_f32 v7, v7
    v_lshlrev_b16 v13, 3, v52
    v_mad_i32_i24 v11, v14, s55, v48
    v_bitop3_b32 v12, v6, v13, v12 bitop3:0xca
    v_lshl_add_u32 v11, v11, 17, s40
    v_lshlrev_b16 v14, 8, v14
    v_lshrrev_b32 v13, 2, v52
    v_add_u32 v48, v12, v11
    v_bitop3_b32 v52, v5, v13, v14 bitop3:0xea
    ds_add_u32 v52, v2
    v_mul_hi_u32_u24 v14, 429497, v49
    v_lshrrev_b32 v12, 3, v53
    v_cos_f32 v8, v8
    v_lshlrev_b16 v13, 3, v53
    v_mad_i32_i24 v11, v14, s55, v49
    v_bitop3_b32 v12, v6, v13, v12 bitop3:0xca
    v_lshl_add_u32 v11, v11, 17, s40
    v_lshlrev_b16 v14, 8, v14
    v_lshrrev_b32 v13, 2, v53
    v_add_u32 v49, v12, v11
    v_bitop3_b32 v53, v5, v13, v14 bitop3:0xea
    ds_add_u32 v53, v2
    v_cvt_pk_bf16_f32 v44, v7, v8
    v_perm_b32 v12, v44, v44, s41
    v_bitop3_b32 v48, v4, v12, v48 bitop3:0xca
    v_perm_b32 v13, v44, v44, s42
    v_bitop3_b32 v49, v4, v13, v49 bitop3:0xca
    v_mul_hi_u32_u24 v14, 429497, v50
    v_lshrrev_b32 v12, 3, v54
    v_cos_f32 v9, v9
    v_lshlrev_b16 v13, 3, v54
    v_mad_i32_i24 v11, v14, s55, v50
    v_bitop3_b32 v12, v6, v13, v12 bitop3:0xca
    v_lshl_add_u32 v11, v11, 17, s40
    v_lshlrev_b16 v14, 8, v14
    v_lshrrev_b32 v13, 2, v54
    v_add_u32 v50, v12, v11
    v_bitop3_b32 v54, v5, v13, v14 bitop3:0xea
    ds_add_u32 v54, v2
    v_mul_hi_u32_u24 v14, 429497, v51
    v_lshrrev_b32 v12, 3, v55
    v_cos_f32 v10, v10
    v_lshlrev_b16 v13, 3, v55
    v_mad_i32_i24 v11, v14, s55, v51
    v_bitop3_b32 v12, v6, v13, v12 bitop3:0xca
    v_lshl_add_u32 v11, v11, 17, s40
    v_lshlrev_b16 v14, 8, v14
    v_lshrrev_b32 v13, 2, v55
    v_add_u32 v51, v12, v11
    v_bitop3_b32 v55, v5, v13, v14 bitop3:0xea
    ds_add_u32 v55, v2
    v_cvt_pk_bf16_f32 v45, v9, v10
    v_perm_b32 v12, v45, v45, s41
    v_bitop3_b32 v50, v4, v12, v50 bitop3:0xca
    v_perm_b32 v13, v45, v45, s42
    v_bitop3_b32 v51, v4, v13, v51 bitop3:0xca
    s_waitcnt vmcnt(4)
    v_lshlrev_b32 v7, 16, v46
    v_and_b32 v8, 0xffff0000, v46
    v_lshlrev_b32 v9, 16, v47
    v_and_b32 v10, 0xffff0000, v47
    v_mul_f32 v7, 0.15915494, v7
    v_mul_f32 v8, 0.15915494, v8
    v_mul_f32 v9, 0.15915494, v9
    v_mul_f32 v10, 0.15915494, v10
    v_mul_hi_u32_u24 v14, 429497, v56
    v_lshrrev_b32 v12, 3, v60
    v_cos_f32 v7, v7
    v_lshlrev_b16 v13, 3, v60
    v_mad_i32_i24 v11, v14, s55, v56
    v_bitop3_b32 v12, v6, v13, v12 bitop3:0xca
    v_lshl_add_u32 v11, v11, 17, s40
    v_lshlrev_b16 v14, 8, v14
    v_lshrrev_b32 v13, 2, v60
    v_add_u32 v56, v12, v11
    v_bitop3_b32 v60, v5, v13, v14 bitop3:0xea
    ds_add_u32 v60, v2
    v_mul_hi_u32_u24 v14, 429497, v57
    v_lshrrev_b32 v12, 3, v61
    v_cos_f32 v8, v8
    v_lshlrev_b16 v13, 3, v61
    v_mad_i32_i24 v11, v14, s55, v57
    v_bitop3_b32 v12, v6, v13, v12 bitop3:0xca
    v_lshl_add_u32 v11, v11, 17, s40
    v_lshlrev_b16 v14, 8, v14
    v_lshrrev_b32 v13, 2, v61
    v_add_u32 v57, v12, v11
    v_bitop3_b32 v61, v5, v13, v14 bitop3:0xea
    ds_add_u32 v61, v2
    v_cvt_pk_bf16_f32 v46, v7, v8
    v_perm_b32 v12, v46, v46, s41
    v_bitop3_b32 v56, v4, v12, v56 bitop3:0xca
    v_perm_b32 v13, v46, v46, s42
    v_bitop3_b32 v57, v4, v13, v57 bitop3:0xca
    v_mul_hi_u32_u24 v14, 429497, v58
    v_lshrrev_b32 v12, 3, v62
    v_cos_f32 v9, v9
    v_lshlrev_b16 v13, 3, v62
    v_mad_i32_i24 v11, v14, s55, v58
    v_bitop3_b32 v12, v6, v13, v12 bitop3:0xca
    v_lshl_add_u32 v11, v11, 17, s40
    v_lshlrev_b16 v14, 8, v14
    v_lshrrev_b32 v13, 2, v62
    v_add_u32 v58, v12, v11
    v_bitop3_b32 v62, v5, v13, v14 bitop3:0xea
    ds_add_u32 v62, v2
    v_mul_hi_u32_u24 v14, 429497, v59
    v_lshrrev_b32 v12, 3, v63
    v_cos_f32 v10, v10
    v_lshlrev_b16 v13, 3, v63
    v_mad_i32_i24 v11, v14, s55, v59
    v_bitop3_b32 v12, v6, v13, v12 bitop3:0xca
    v_lshl_add_u32 v11, v11, 17, s40
    v_lshlrev_b16 v14, 8, v14
    v_lshrrev_b32 v13, 2, v63
    v_add_u32 v59, v12, v11
    v_bitop3_b32 v63, v5, v13, v14 bitop3:0xea
    ds_add_u32 v63, v2
    v_cvt_pk_bf16_f32 v47, v9, v10
    v_perm_b32 v12, v47, v47, s41
    v_bitop3_b32 v58, v4, v12, v58 bitop3:0xca
    v_perm_b32 v13, v47, v47, s42
    v_bitop3_b32 v59, v4, v13, v59 bitop3:0xca
    v_lshrrev_b32 v8, 2, v0
    v_and_b32 v7, 0x3c00, v0
    v_bitop3_b32 v7, v5, v8, v7 bitop3:0xea
    s_waitcnt lgkmcnt(0)
    s_barrier
    ds_read2st64_b32 v[8:9], v7 offset0:0 offset1:1
    ds_read2st64_b32 v[10:11], v7 offset0:2 offset1:3
    s_add_u32 s47, s35, 0x4000
    s_add_u32 s47, s47, s93
    buffer_store_dwordx4 v[64:67], v0, s[20:23], s47 offen sc1
    s_add_u32 s44, s96, 0x4000000
    s_lshr_b32 s44, s44, 1
    buffer_load_dwordx2 v[64:65], v1, s[16:19], s44 offen nt
    s_add_u32 s45, s97, 0x4400000
    s_lshr_b32 s45, s45, 1
    buffer_load_dwordx2 v[66:67], v1, s[16:19], s45 offen nt
    s_waitcnt lgkmcnt(0)
    v_lshl_or_b32 v12, v9, 16, v8
    v_lshl_or_b32 v13, v11, 16, v10
    v_mov_b32 v14, v12
    v_mov_b32 v15, v13
    s_nop 0
    v_add_u32_dpp v14, v14, v14 row_shr:1 row_mask:0xf bank_mask:0xf bound_ctrl:1
    v_add_u32_dpp v15, v15, v15 row_shr:1 row_mask:0xf bank_mask:0xf bound_ctrl:1
    s_nop 0
    v_add_u32_dpp v14, v14, v14 row_shr:2 row_mask:0xf bank_mask:0xf bound_ctrl:1
    v_add_u32_dpp v15, v15, v15 row_shr:2 row_mask:0xf bank_mask:0xf bound_ctrl:1
    s_nop 0
    v_add_u32_dpp v14, v14, v14 row_shr:4 row_mask:0xf bank_mask:0xf bound_ctrl:1
    v_add_u32_dpp v15, v15, v15 row_shr:4 row_mask:0xf bank_mask:0xf bound_ctrl:1
    s_nop 0
    v_add_u32_dpp v14, v14, v14 row_shr:8 row_mask:0xf bank_mask:0xf bound_ctrl:1
    v_add_u32_dpp v15, v15, v15 row_shr:8 row_mask:0xf bank_mask:0xf bound_ctrl:1
    s_nop 0
    v_add_u32_dpp v14, v14, v14 row_bcast:15 row_mask:0xa bank_mask:0xf
    v_add_u32_dpp v15, v15, v15 row_bcast:15 row_mask:0xa bank_mask:0xf
    s_nop 0
    v_add_u32_dpp v14, v14, v14 row_bcast:31 row_mask:0xc bank_mask:0xf
    v_add_u32_dpp v15, v15, v15 row_bcast:31 row_mask:0xc bank_mask:0xf
    v_readlane_b32 s48, v14, 63
    v_readlane_b32 s49, v15, 63
    s_lshl_b32 s54, s32, 2
    v_mov_b32 v8, s54
    s_and_b32 s50, s48, 0xffff
    s_lshr_b32 s51, s48, 16
    s_and_b32 s52, s49, 0xffff
    s_lshr_b32 s53, s49, 16
    s_add_u32 s51, s51, s50
    s_add_u32 s52, s52, s51
    s_add_u32 s53, s53, s52
    v_mov_b32 v9, s53
    s_mov_b64 exec, 1
    ds_write_b32 v8, v9 offset:16384
    s_mov_b64 exec, -1
    v_and_b32 v8, 60, v7
    s_waitcnt lgkmcnt(0)
    s_barrier
    ds_read_b32 v9, v8 offset:16384
    s_waitcnt lgkmcnt(0)
    v_add_u32_dpp v9, v9, v9 row_shr:1 row_mask:0xf bank_mask:0xf bound_ctrl:1
    s_nop 1
    v_add_u32_dpp v9, v9, v9 row_shr:2 row_mask:0xf bank_mask:0xf bound_ctrl:1
    s_nop 1
    v_add_u32_dpp v9, v9, v9 row_shr:4 row_mask:0xf bank_mask:0xf bound_ctrl:1
    s_nop 1
    v_add_u32_dpp v9, v9, v9 row_shr:8 row_mask:0xf bank_mask:0xf bound_ctrl:1
    s_nop 0
    v_readlane_b32 s54, v9, s32
    s_sub_u32 s54, s54, s53
    s_add_u32 s50, s50, s54
    s_add_u32 s51, s51, s54
    s_add_u32 s52, s52, s54
    s_pack_ll_b32_b16 s48, s54, s50
    s_pack_ll_b32_b16 s49, s51, s52
    v_add_u32 v14, s48, v14
    v_add_u32 v15, s49, v15
    v_sub_u32 v12, v14, v12
    v_sub_u32 v13, v15, v13
    v_and_b32 v8, 0xffff, v12
    v_lshrrev_b32 v9, 16, v12
    v_and_b32 v10, 0xffff, v13
    v_lshrrev_b32 v11, 16, v13
    ds_write2st64_b32 v7, v8, v9 offset0:0 offset1:1
    ds_write2st64_b32 v7, v10, v11 offset0:2 offset1:3
    v_and_b32 v8, 0x3f0, v0
    v_lshl_add_u32 v8, v8, 1, s36
    ds_write_b64 v8, v[12:13] offset:20480
    s_bitset0_b64 exec, 63
    s_not_b64 exec, exec
    ds_write_b64 v8, v[14:15] offset:20512
    s_mov_b64 exec, -1
    s_waitcnt lgkmcnt(0)
    s_barrier
    s_setprio 3
    ds_add_rtn_u32 v104, v104, v2
    ds_add_rtn_u32 v105, v105, v2
    ds_add_rtn_u32 v106, v106, v2
    ds_add_rtn_u32 v107, v107, v2
    ds_read_b128 v[12:15], v0 offset:20480
    v_cmp_gt_u32 vcc, 8448, v0
    ds_add_rtn_u32 v112, v112, v2
    ds_add_rtn_u32 v113, v113, v2
    ds_add_rtn_u32 v114, v114, v2
    ds_add_rtn_u32 v115, v115, v2
    s_setprio 2
    ds_add_rtn_u32 v120, v120, v2
    ds_add_rtn_u32 v121, v121, v2
    ds_add_rtn_u32 v122, v122, v2
    ds_add_rtn_u32 v123, v123, v2
    s_waitcnt lgkmcnt(8)
    s_cbranch_vccz L1_p2
    s_add_u32 s46, s35, 0x2a40000
    s_mov_b64 exec, vcc
    buffer_store_dwordx4 v[12:15], v0, s[24:27], s46 offen sc1
    s_mov_b64 exec, -1
L1_p2:
    s_add_u32 s47, s35, 0x8000
    s_add_u32 s47, s47, s72
    buffer_store_dwordx4 v[76:79], v0, s[20:23], s47 offen sc1
    s_add_u32 s44, s97, 0x4400000
    s_nop 0
    v_lshlrev_b32 v76, 1, v1
    buffer_load_dwordx4 v[76:79], v76, s[8:11], s44 offen nt
    ds_add_rtn_u32 v20, v20, v2
    ds_add_rtn_u32 v21, v21, v2
    ds_add_rtn_u32 v22, v22, v2
    ds_add_rtn_u32 v23, v23, v2
    s_setprio 1
    ds_add_rtn_u32 v32, v32, v2
    ds_add_rtn_u32 v33, v33, v2
    ds_add_rtn_u32 v34, v34, v2
    ds_add_rtn_u32 v35, v35, v2
    ds_add_rtn_u32 v40, v40, v2
    ds_add_rtn_u32 v41, v41, v2
    ds_add_rtn_u32 v42, v42, v2
    ds_add_rtn_u32 v43, v43, v2
    s_add_u32 s45, s35, 0x8000
    s_add_u32 s45, s45, s73
    buffer_store_dwordx4 v[80:83], v0, s[20:23], s45 offen sc1
    s_add_u32 s46, s97, 0x4400000
    s_nop 0
    v_lshlrev_b32 v80, 1, v1
    buffer_load_dwordx4 v[80:83], v80, s[12:15], s46 offen nt
    s_setprio 0
    ds_add_rtn_u32 v52, v52, v2
    ds_add_rtn_u32 v53, v53, v2
    ds_add_rtn_u32 v54, v54, v2
    ds_add_rtn_u32 v55, v55, v2
    ds_add_rtn_u32 v60, v60, v2
    ds_add_rtn_u32 v61, v61, v2
    ds_add_rtn_u32 v62, v62, v2
    ds_add_rtn_u32 v63, v63, v2
    s_waitcnt lgkmcnt(0)
    s_barrier
    s_setprio 3
    v_and_b32 v7, -4, v104
    v_lshl_add_u32 v8, v104, 2, v7
    ds_write_b32 v8, v96
    v_lshl_add_u32 v7, v7, 2, v104
    ds_write_b8 v7, v108 offset:16
    v_and_b32 v9, -4, v105
    v_lshl_add_u32 v10, v105, 2, v9
    ds_write_b32 v10, v97
    v_lshl_add_u32 v9, v9, 2, v105
    ds_write_b8_d16_hi v9, v108 offset:16
    v_and_b32 v7, -4, v106
    v_lshl_add_u32 v8, v106, 2, v7
    ds_write_b32 v8, v98
    v_lshl_add_u32 v7, v7, 2, v106
    ds_write_b8 v7, v109 offset:16
    v_and_b32 v9, -4, v107
    v_lshl_add_u32 v10, v107, 2, v9
    ds_write_b32 v10, v99
    v_lshl_add_u32 v9, v9, 2, v107
    ds_write_b8_d16_hi v9, v109 offset:16
    s_add_u32 s47, s35, 0x8000
    s_add_u32 s47, s47, s85
    buffer_store_dwordx4 v[88:91], v0, s[20:23], s47 offen sc1
    s_add_u32 s44, s98, 0x4800000
    v_lshlrev_b32 v96, 1, v1
    buffer_load_dwordx4 v[96:99], v96, s[8:11], s44 offen nt
    s_add_u32 s45, s98, 0x4800000
    v_lshlrev_b32 v104, 1, v1
    buffer_load_dwordx4 v[104:107], v104, s[12:15], s45 offen nt
    v_and_b32 v7, -4, v112
    v_lshl_add_u32 v8, v112, 2, v7
    ds_write_b32 v8, v100
    v_lshl_add_u32 v7, v7, 2, v112
    ds_write_b8 v7, v110 offset:16
    v_and_b32 v9, -4, v113
    v_lshl_add_u32 v10, v113, 2, v9
    ds_write_b32 v10, v101
    v_lshl_add_u32 v9, v9, 2, v113
    ds_write_b8_d16_hi v9, v110 offset:16
    v_and_b32 v7, -4, v114
    v_lshl_add_u32 v8, v114, 2, v7
    ds_write_b32 v8, v102
    v_lshl_add_u32 v7, v7, 2, v114
    ds_write_b8 v7, v111 offset:16
    v_and_b32 v9, -4, v115
    v_lshl_add_u32 v10, v115, 2, v9
    ds_write_b32 v10, v103
    v_lshl_add_u32 v9, v9, 2, v115
    ds_write_b8_d16_hi v9, v111 offset:16
    s_add_u32 s46, s98, 0x4800000
    s_lshr_b32 s46, s46, 1
    buffer_load_dwordx2 v[88:89], v1, s[16:19], s46 offen nt
    s_add_u32 s47, s99, 0x4c00000
    s_lshr_b32 s47, s47, 1
    buffer_load_dwordx2 v[90:91], v1, s[16:19], s47 offen nt
    s_add_u32 s44, s99, 0x4c00000
    v_lshlrev_b32 v100, 1, v1
    buffer_load_dwordx4 v[100:103], v100, s[8:11], s44 offen nt
    s_setprio 2
    v_and_b32 v7, -4, v120
    v_lshl_add_u32 v8, v120, 2, v7
    ds_write_b32 v8, v116
    v_lshl_add_u32 v7, v7, 2, v120
    ds_write_b8 v7, v124 offset:16
    v_and_b32 v9, -4, v121
    v_lshl_add_u32 v10, v121, 2, v9
    ds_write_b32 v10, v117
    v_lshl_add_u32 v9, v9, 2, v121
    ds_write_b8_d16_hi v9, v124 offset:16
    v_and_b32 v7, -4, v122
    v_lshl_add_u32 v8, v122, 2, v7
    ds_write_b32 v8, v118
    v_lshl_add_u32 v7, v7, 2, v122
    ds_write_b8 v7, v125 offset:16
    v_and_b32 v9, -4, v123
    v_lshl_add_u32 v10, v123, 2, v9
    ds_write_b32 v10, v119
    v_lshl_add_u32 v9, v9, 2, v123
    ds_write_b8_d16_hi v9, v125 offset:16
    s_add_u32 s45, s35, 0x8000
    s_add_u32 s45, s45, s91
    buffer_store_dwordx4 v[92:95], v0, s[20:23], s45 offen sc1
    s_add_u32 s46, s99, 0x4c00000
    v_lshlrev_b32 v112, 1, v1
    buffer_load_dwordx4 v[112:115], v112, s[12:15], s46 offen nt
    v_and_b32 v7, -4, v20
    v_lshl_add_u32 v8, v20, 2, v7
    ds_write_b32 v8, v16
    v_lshl_add_u32 v7, v7, 2, v20
    ds_write_b8 v7, v126 offset:16
    v_and_b32 v9, -4, v21
    v_lshl_add_u32 v10, v21, 2, v9
    ds_write_b32 v10, v17
    v_lshl_add_u32 v9, v9, 2, v21
    ds_write_b8_d16_hi v9, v126 offset:16
    v_and_b32 v7, -4, v22
    v_lshl_add_u32 v8, v22, 2, v7
    ds_write_b32 v8, v18
    v_lshl_add_u32 v7, v7, 2, v22
    ds_write_b8 v7, v127 offset:16
    v_and_b32 v9, -4, v23
    v_lshl_add_u32 v10, v23, 2, v9
    ds_write_b32 v10, v19
    v_lshl_add_u32 v9, v9, 2, v23
    ds_write_b8_d16_hi v9, v127 offset:16
    s_add_u32 s47, s96, 0x5000000
    v_lshlrev_b32 v108, 1, v1
    buffer_load_dwordx4 v[108:111], v108, s[8:11], s47 offen nt
    s_add_u32 s44, s96, 0x5000000
    v_lshlrev_b32 v116, 1, v1
    buffer_load_dwordx4 v[116:119], v116, s[12:15], s44 offen nt
    s_setprio 1
    v_and_b32 v7, -4, v32
    v_lshl_add_u32 v8, v32, 2, v7
    ds_write_b32 v8, v28
    v_lshl_add_u32 v7, v7, 2, v32
    ds_write_b8 v7, v24 offset:16
    v_and_b32 v9, -4, v33
    v_lshl_add_u32 v10, v33, 2, v9
    ds_write_b32 v10, v29
    v_lshl_add_u32 v9, v9, 2, v33
    ds_write_b8_d16_hi v9, v24 offset:16
    v_and_b32 v7, -4, v34
    v_lshl_add_u32 v8, v34, 2, v7
    ds_write_b32 v8, v30
    v_lshl_add_u32 v7, v7, 2, v34
    ds_write_b8 v7, v25 offset:16
    v_and_b32 v9, -4, v35
    v_lshl_add_u32 v10, v35, 2, v9
    ds_write_b32 v10, v31
    v_lshl_add_u32 v9, v9, 2, v35
    ds_write_b8_d16_hi v9, v25 offset:16
    s_add_u32 s45, s96, 0x5000000
    s_lshr_b32 s45, s45, 1
    buffer_load_dwordx2 v[120:121], v1, s[16:19], s45 offen nt
    s_add_u32 s46, s97, 0x5400000
    s_lshr_b32 s46, s46, 1
    buffer_load_dwordx2 v[122:123], v1, s[16:19], s46 offen nt
    s_add_u32 s47, s97, 0x5400000
    v_lshlrev_b32 v92, 1, v1
    buffer_load_dwordx4 v[92:95], v92, s[8:11], s47 offen nt
    v_and_b32 v7, -4, v40
    v_lshl_add_u32 v8, v40, 2, v7
    ds_write_b32 v8, v36
    v_lshl_add_u32 v7, v7, 2, v40
    ds_write_b8 v7, v26 offset:16
    v_and_b32 v9, -4, v41
    v_lshl_add_u32 v10, v41, 2, v9
    ds_write_b32 v10, v37
    v_lshl_add_u32 v9, v9, 2, v41
    ds_write_b8_d16_hi v9, v26 offset:16
    v_and_b32 v7, -4, v42
    v_lshl_add_u32 v8, v42, 2, v7
    ds_write_b32 v8, v38
    v_lshl_add_u32 v7, v7, 2, v42
    ds_write_b8 v7, v27 offset:16
    v_and_b32 v9, -4, v43
    v_lshl_add_u32 v10, v43, 2, v9
    ds_write_b32 v10, v39
    v_lshl_add_u32 v9, v9, 2, v43
    ds_write_b8_d16_hi v9, v27 offset:16
    s_add_u32 s44, s35, 0x8000
    s_add_u32 s44, s44, s93
    buffer_store_dwordx4 v[84:87], v0, s[20:23], s44 offen sc1
    s_add_u32 s45, s97, 0x5400000
    v_lshlrev_b32 v16, 1, v1
    buffer_load_dwordx4 v[16:19], v16, s[12:15], s45 offen nt
    s_setprio 0
    v_and_b32 v7, -4, v52
    v_lshl_add_u32 v8, v52, 2, v7
    ds_write_b32 v8, v48
    v_lshl_add_u32 v7, v7, 2, v52
    ds_write_b8 v7, v44 offset:16
    v_and_b32 v9, -4, v53
    v_lshl_add_u32 v10, v53, 2, v9
    ds_write_b32 v10, v49
    v_lshl_add_u32 v9, v9, 2, v53
    ds_write_b8_d16_hi v9, v44 offset:16
    v_and_b32 v7, -4, v54
    v_lshl_add_u32 v8, v54, 2, v7
    ds_write_b32 v8, v50
    v_lshl_add_u32 v7, v7, 2, v54
    ds_write_b8 v7, v45 offset:16
    v_and_b32 v9, -4, v55
    v_lshl_add_u32 v10, v55, 2, v9
    ds_write_b32 v10, v51
    v_lshl_add_u32 v9, v9, 2, v55
    ds_write_b8_d16_hi v9, v45 offset:16
    s_add_u32 s46, s98, 0x5800000
    v_lshlrev_b32 v20, 1, v1
    buffer_load_dwordx4 v[20:23], v20, s[8:11], s46 offen nt
    s_add_u32 s47, s98, 0x5800000
    v_lshlrev_b32 v124, 1, v1
    buffer_load_dwordx4 v[124:127], v124, s[12:15], s47 offen nt
    v_and_b32 v7, -4, v60
    v_lshl_add_u32 v8, v60, 2, v7
    ds_write_b32 v8, v56
    v_lshl_add_u32 v7, v7, 2, v60
    ds_write_b8 v7, v46 offset:16
    v_and_b32 v9, -4, v61
    v_lshl_add_u32 v10, v61, 2, v9
    ds_write_b32 v10, v57
    v_lshl_add_u32 v9, v9, 2, v61
    ds_write_b8_d16_hi v9, v46 offset:16
    v_and_b32 v7, -4, v62
    v_lshl_add_u32 v8, v62, 2, v7
    ds_write_b32 v8, v58
    v_lshl_add_u32 v7, v7, 2, v62
    ds_write_b8 v7, v47 offset:16
    v_and_b32 v9, -4, v63
    v_lshl_add_u32 v10, v63, 2, v9
    ds_write_b32 v10, v59
    v_lshl_add_u32 v9, v9, 2, v63
    ds_write_b8_d16_hi v9, v47 offset:16
    s_add_u32 s44, s98, 0x5800000
    s_lshr_b32 s44, s44, 1
    buffer_load_dwordx2 v[28:29], v1, s[16:19], s44 offen nt
    s_add_u32 s45, s99, 0x5c00000
    s_lshr_b32 s45, s45, 1
    buffer_load_dwordx2 v[30:31], v1, s[16:19], s45 offen nt
    v_add_u32 v7, s72, v0
    v_add_u32 v12, s73, v0
    v_add_u32 v13, s85, v0
    v_add_u32 v14, s91, v0
    v_add_u32 v15, s93, v0
    s_min_i32 s3, s72, s73
    s_min_i32 s3, s3, s85
    s_min_i32 s3, s3, s91
    s_min_i32 s3, s3, s93
    v_add_u32 v3, s3, v0
    v_mov_b32 v8, 0
    v_mov_b32 v9, 0
    v_mov_b32 v10, 0
    v_mov_b32 v11, 0
    s_waitcnt lgkmcnt(0)
    s_barrier
    ds_read_b128 v[32:35], v7 offset:0
    ds_read_b128 v[36:39], v12 offset:0
    ds_read_b128 v[40:43], v13 offset:0
    ds_read_b128 v[24:27], v14 offset:0
    ds_read_b128 v[84:87], v15 offset:0
    ds_write_b128 v3, v[8:11]
    ds_read_b128 v[48:51], v7 offset:16384
    ds_read_b128 v[52:55], v12 offset:16384
    ds_read_b128 v[56:59], v13 offset:16384
    ds_read_b128 v[60:63], v14 offset:16384
    ds_read_b128 v[44:47], v15 offset:16384
    s_waitcnt lgkmcnt(0)
    s_barrier
    s_setprio 3
    s_add_u32 s46, s35, 0x2a44000
    s_add_u32 s46, s46, s72
    buffer_store_dwordx4 v[32:35], v0, s[20:23], s46 offen sc1
    s_add_u32 s47, s99, 0x5c00000
    s_nop 0
    v_lshlrev_b32 v32, 1, v1
    buffer_load_dwordx4 v[32:35], v32, s[8:11], s47 offen nt
    s_add_u32 s44, s35, 0x2a44000
    s_add_u32 s44, s44, s73
    buffer_store_dwordx4 v[36:39], v0, s[20:23], s44 offen sc1
    s_add_u32 s45, s99, 0x5c00000
    s_nop 0
    v_lshlrev_b32 v36, 1, v1
    buffer_load_dwordx4 v[36:39], v36, s[12:15], s45 offen nt
    s_waitcnt vmcnt(27)
    v_lshlrev_b32 v7, 16, v64
    v_and_b32 v8, 0xffff0000, v64
    v_lshlrev_b32 v9, 16, v65
    v_and_b32 v10, 0xffff0000, v65
    v_mul_f32 v7, 0.15915494, v7
    v_mul_f32 v8, 0.15915494, v8
    v_mul_f32 v9, 0.15915494, v9
    v_mul_f32 v10, 0.15915494, v10
    v_mul_hi_u32_u24 v14, 429497, v68
    v_lshrrev_b32 v12, 3, v72
    v_cos_f32 v7, v7
    v_lshlrev_b16 v13, 3, v72
    v_mad_i32_i24 v11, v14, s55, v68
    v_bitop3_b32 v12, v6, v13, v12 bitop3:0xca
    v_lshl_add_u32 v11, v11, 17, s40
    v_lshlrev_b16 v14, 8, v14
    v_lshrrev_b32 v13, 2, v72
    v_add_u32 v68, v12, v11
    v_bitop3_b32 v72, v5, v13, v14 bitop3:0xea
    ds_add_u32 v72, v2
    v_mul_hi_u32_u24 v14, 429497, v69
    v_lshrrev_b32 v12, 3, v73
    v_cos_f32 v8, v8
    v_lshlrev_b16 v13, 3, v73
    v_mad_i32_i24 v11, v14, s55, v69
    v_bitop3_b32 v12, v6, v13, v12 bitop3:0xca
    v_lshl_add_u32 v11, v11, 17, s40
    v_lshlrev_b16 v14, 8, v14
    v_lshrrev_b32 v13, 2, v73
    v_add_u32 v69, v12, v11
    v_bitop3_b32 v73, v5, v13, v14 bitop3:0xea
    ds_add_u32 v73, v2
    v_cvt_pk_bf16_f32 v64, v7, v8
    v_perm_b32 v12, v64, v64, s41
    v_bitop3_b32 v68, v4, v12, v68 bitop3:0xca
    v_perm_b32 v13, v64, v64, s42
    v_bitop3_b32 v69, v4, v13, v69 bitop3:0xca
    v_mul_hi_u32_u24 v14, 429497, v70
    v_lshrrev_b32 v12, 3, v74
    v_cos_f32 v9, v9
    v_lshlrev_b16 v13, 3, v74
    v_mad_i32_i24 v11, v14, s55, v70
    v_bitop3_b32 v12, v6, v13, v12 bitop3:0xca
    v_lshl_add_u32 v11, v11, 17, s40
    v_lshlrev_b16 v14, 8, v14
    v_lshrrev_b32 v13, 2, v74
    v_add_u32 v70, v12, v11
    v_bitop3_b32 v74, v5, v13, v14 bitop3:0xea
    ds_add_u32 v74, v2
    v_mul_hi_u32_u24 v14, 429497, v71
    v_lshrrev_b32 v12, 3, v75
    v_cos_f32 v10, v10
    v_lshlrev_b16 v13, 3, v75
    v_mad_i32_i24 v11, v14, s55, v71
    v_bitop3_b32 v12, v6, v13, v12 bitop3:0xca
    v_lshl_add_u32 v11, v11, 17, s40
    v_lshlrev_b16 v14, 8, v14
    v_lshrrev_b32 v13, 2, v75
    v_add_u32 v71, v12, v11
    v_bitop3_b32 v75, v5, v13, v14 bitop3:0xea
    ds_add_u32 v75, v2
    v_cvt_pk_bf16_f32 v65, v9, v10
    v_perm_b32 v12, v65, v65, s41
    v_bitop3_b32 v70, v4, v12, v70 bitop3:0xca
    v_perm_b32 v13, v65, v65, s42
    v_bitop3_b32 v71, v4, v13, v71 bitop3:0xca
    s_waitcnt vmcnt(23)
    v_lshlrev_b32 v7, 16, v66
    v_and_b32 v8, 0xffff0000, v66
    v_lshlrev_b32 v9, 16, v67
    v_and_b32 v10, 0xffff0000, v67
    v_mul_f32 v7, 0.15915494, v7
    v_mul_f32 v8, 0.15915494, v8
    v_mul_f32 v9, 0.15915494, v9
    v_mul_f32 v10, 0.15915494, v10
    v_mul_hi_u32_u24 v14, 429497, v76
    v_lshrrev_b32 v12, 3, v80
    v_cos_f32 v7, v7
    v_lshlrev_b16 v13, 3, v80
    v_mad_i32_i24 v11, v14, s55, v76
    v_bitop3_b32 v12, v6, v13, v12 bitop3:0xca
    v_lshl_add_u32 v11, v11, 17, s40
    v_lshlrev_b16 v14, 8, v14
    v_lshrrev_b32 v13, 2, v80
    v_add_u32 v76, v12, v11
    v_bitop3_b32 v80, v5, v13, v14 bitop3:0xea
    ds_add_u32 v80, v2
    v_mul_hi_u32_u24 v14, 429497, v77
    v_lshrrev_b32 v12, 3, v81
    v_cos_f32 v8, v8
    v_lshlrev_b16 v13, 3, v81
    v_mad_i32_i24 v11, v14, s55, v77
    v_bitop3_b32 v12, v6, v13, v12 bitop3:0xca
    v_lshl_add_u32 v11, v11, 17, s40
    v_lshlrev_b16 v14, 8, v14
    v_lshrrev_b32 v13, 2, v81
    v_add_u32 v77, v12, v11
    v_bitop3_b32 v81, v5, v13, v14 bitop3:0xea
    ds_add_u32 v81, v2
    v_cvt_pk_bf16_f32 v66, v7, v8
    v_perm_b32 v12, v66, v66, s41
    v_bitop3_b32 v76, v4, v12, v76 bitop3:0xca
    v_perm_b32 v13, v66, v66, s42
    v_bitop3_b32 v77, v4, v13, v77 bitop3:0xca
    v_mul_hi_u32_u24 v14, 429497, v78
    v_lshrrev_b32 v12, 3, v82
    v_cos_f32 v9, v9
    v_lshlrev_b16 v13, 3, v82
    v_mad_i32_i24 v11, v14, s55, v78
    v_bitop3_b32 v12, v6, v13, v12 bitop3:0xca
    v_lshl_add_u32 v11, v11, 17, s40
    v_lshlrev_b16 v14, 8, v14
    v_lshrrev_b32 v13, 2, v82
    v_add_u32 v78, v12, v11
    v_bitop3_b32 v82, v5, v13, v14 bitop3:0xea
    ds_add_u32 v82, v2
    v_mul_hi_u32_u24 v14, 429497, v79
    v_lshrrev_b32 v12, 3, v83
    v_cos_f32 v10, v10
    v_lshlrev_b16 v13, 3, v83
    v_mad_i32_i24 v11, v14, s55, v79
    v_bitop3_b32 v12, v6, v13, v12 bitop3:0xca
    v_lshl_add_u32 v11, v11, 17, s40
    v_lshlrev_b16 v14, 8, v14
    v_lshrrev_b32 v13, 2, v83
    v_add_u32 v79, v12, v11
    v_bitop3_b32 v83, v5, v13, v14 bitop3:0xea
    ds_add_u32 v83, v2
    v_cvt_pk_bf16_f32 v67, v9, v10
    v_perm_b32 v12, v67, v67, s41
    v_bitop3_b32 v78, v4, v12, v78 bitop3:0xca
    v_perm_b32 v13, v67, v67, s42
    v_bitop3_b32 v79, v4, v13, v79 bitop3:0xca
    s_setprio 2
    s_waitcnt vmcnt(18)
    v_lshlrev_b32 v7, 16, v88
    v_and_b32 v8, 0xffff0000, v88
    v_lshlrev_b32 v9, 16, v89
    v_and_b32 v10, 0xffff0000, v89
    v_mul_f32 v7, 0.15915494, v7
    v_mul_f32 v8, 0.15915494, v8
    v_mul_f32 v9, 0.15915494, v9
    v_mul_f32 v10, 0.15915494, v10
    v_mul_hi_u32_u24 v14, 429497, v96
    v_lshrrev_b32 v12, 3, v104
    v_cos_f32 v7, v7
    v_lshlrev_b16 v13, 3, v104
    v_mad_i32_i24 v11, v14, s55, v96
    v_bitop3_b32 v12, v6, v13, v12 bitop3:0xca
    v_lshl_add_u32 v11, v11, 17, s40
    v_lshlrev_b16 v14, 8, v14
    v_lshrrev_b32 v13, 2, v104
    v_add_u32 v96, v12, v11
    v_bitop3_b32 v104, v5, v13, v14 bitop3:0xea
    ds_add_u32 v104, v2
    v_mul_hi_u32_u24 v14, 429497, v97
    v_lshrrev_b32 v12, 3, v105
    v_cos_f32 v8, v8
    v_lshlrev_b16 v13, 3, v105
    v_mad_i32_i24 v11, v14, s55, v97
    v_bitop3_b32 v12, v6, v13, v12 bitop3:0xca
    v_lshl_add_u32 v11, v11, 17, s40
    v_lshlrev_b16 v14, 8, v14
    v_lshrrev_b32 v13, 2, v105
    v_add_u32 v97, v12, v11
    v_bitop3_b32 v105, v5, v13, v14 bitop3:0xea
    ds_add_u32 v105, v2
    v_cvt_pk_bf16_f32 v88, v7, v8
    v_perm_b32 v12, v88, v88, s41
    v_bitop3_b32 v96, v4, v12, v96 bitop3:0xca
    v_perm_b32 v13, v88, v88, s42
    v_bitop3_b32 v97, v4, v13, v97 bitop3:0xca
    v_mul_hi_u32_u24 v14, 429497, v98
    v_lshrrev_b32 v12, 3, v106
    v_cos_f32 v9, v9
    v_lshlrev_b16 v13, 3, v106
    v_mad_i32_i24 v11, v14, s55, v98
    v_bitop3_b32 v12, v6, v13, v12 bitop3:0xca
    v_lshl_add_u32 v11, v11, 17, s40
    v_lshlrev_b16 v14, 8, v14
    v_lshrrev_b32 v13, 2, v106
    v_add_u32 v98, v12, v11
    v_bitop3_b32 v106, v5, v13, v14 bitop3:0xea
    ds_add_u32 v106, v2
    v_mul_hi_u32_u24 v14, 429497, v99
    v_lshrrev_b32 v12, 3, v107
    v_cos_f32 v10, v10
    v_lshlrev_b16 v13, 3, v107
    v_mad_i32_i24 v11, v14, s55, v99
    v_bitop3_b32 v12, v6, v13, v12 bitop3:0xca
    v_lshl_add_u32 v11, v11, 17, s40
    v_lshlrev_b16 v14, 8, v14
    v_lshrrev_b32 v13, 2, v107
    v_add_u32 v99, v12, v11
    v_bitop3_b32 v107, v5, v13, v14 bitop3:0xea
    ds_add_u32 v107, v2
    v_cvt_pk_bf16_f32 v89, v9, v10
    v_perm_b32 v12, v89, v89, s41
    v_bitop3_b32 v98, v4, v12, v98 bitop3:0xca
    v_perm_b32 v13, v89, v89, s42
    v_bitop3_b32 v99, v4, v13, v99 bitop3:0xca
    s_add_u32 s46, s35, 0x2a44000
    s_add_u32 s46, s46, s85
    buffer_store_dwordx4 v[40:43], v0, s[20:23], s46 offen sc1
    s_add_u32 s47, s96, 0x6000000
    s_nop 0
    v_lshlrev_b32 v40, 1, v1
    buffer_load_dwordx4 v[40:43], v40, s[8:11], s47 offen nt
    s_waitcnt vmcnt(17)
    v_lshlrev_b32 v7, 16, v90
    v_and_b32 v8, 0xffff0000, v90
    v_lshlrev_b32 v9, 16, v91
    v_and_b32 v10, 0xffff0000, v91
    v_mul_f32 v7, 0.15915494, v7
    v_mul_f32 v8, 0.15915494, v8
    v_mul_f32 v9, 0.15915494, v9
    v_mul_f32 v10, 0.15915494, v10
    v_mul_hi_u32_u24 v14, 429497, v100
    v_lshrrev_b32 v12, 3, v112
    v_cos_f32 v7, v7
    v_lshlrev_b16 v13, 3, v112
    v_mad_i32_i24 v11, v14, s55, v100
    v_bitop3_b32 v12, v6, v13, v12 bitop3:0xca
    v_lshl_add_u32 v11, v11, 17, s40
    v_lshlrev_b16 v14, 8, v14
    v_lshrrev_b32 v13, 2, v112
    v_add_u32 v100, v12, v11
    v_bitop3_b32 v112, v5, v13, v14 bitop3:0xea
    ds_add_u32 v112, v2
    v_mul_hi_u32_u24 v14, 429497, v101
    v_lshrrev_b32 v12, 3, v113
    v_cos_f32 v8, v8
    v_lshlrev_b16 v13, 3, v113
    v_mad_i32_i24 v11, v14, s55, v101
    v_bitop3_b32 v12, v6, v13, v12 bitop3:0xca
    v_lshl_add_u32 v11, v11, 17, s40
    v_lshlrev_b16 v14, 8, v14
    v_lshrrev_b32 v13, 2, v113
    v_add_u32 v101, v12, v11
    v_bitop3_b32 v113, v5, v13, v14 bitop3:0xea
    ds_add_u32 v113, v2
    v_cvt_pk_bf16_f32 v90, v7, v8
    v_perm_b32 v12, v90, v90, s41
    v_bitop3_b32 v100, v4, v12, v100 bitop3:0xca
    v_perm_b32 v13, v90, v90, s42
    v_bitop3_b32 v101, v4, v13, v101 bitop3:0xca
    v_mul_hi_u32_u24 v14, 429497, v102
    v_lshrrev_b32 v12, 3, v114
    v_cos_f32 v9, v9
    v_lshlrev_b16 v13, 3, v114
    v_mad_i32_i24 v11, v14, s55, v102
    v_bitop3_b32 v12, v6, v13, v12 bitop3:0xca
    v_lshl_add_u32 v11, v11, 17, s40
    v_lshlrev_b16 v14, 8, v14
    v_lshrrev_b32 v13, 2, v114
    v_add_u32 v102, v12, v11
    v_bitop3_b32 v114, v5, v13, v14 bitop3:0xea
    ds_add_u32 v114, v2
    v_mul_hi_u32_u24 v14, 429497, v103
    v_lshrrev_b32 v12, 3, v115
    v_cos_f32 v10, v10
    v_lshlrev_b16 v13, 3, v115
    v_mad_i32_i24 v11, v14, s55, v103
    v_bitop3_b32 v12, v6, v13, v12 bitop3:0xca
    v_lshl_add_u32 v11, v11, 17, s40
    v_lshlrev_b16 v14, 8, v14
    v_lshrrev_b32 v13, 2, v115
    v_add_u32 v103, v12, v11
    v_bitop3_b32 v115, v5, v13, v14 bitop3:0xea
    ds_add_u32 v115, v2
    v_cvt_pk_bf16_f32 v91, v9, v10
    v_perm_b32 v12, v91, v91, s41
    v_bitop3_b32 v102, v4, v12, v102 bitop3:0xca
    v_perm_b32 v13, v91, v91, s42
    v_bitop3_b32 v103, v4, v13, v103 bitop3:0xca
    s_setprio 1
    s_waitcnt vmcnt(13)
    v_lshlrev_b32 v7, 16, v120
    v_and_b32 v8, 0xffff0000, v120
    v_lshlrev_b32 v9, 16, v121
    v_and_b32 v10, 0xffff0000, v121
    v_mul_f32 v7, 0.15915494, v7
    v_mul_f32 v8, 0.15915494, v8
    v_mul_f32 v9, 0.15915494, v9
    v_mul_f32 v10, 0.15915494, v10
    v_mul_hi_u32_u24 v14, 429497, v108
    v_lshrrev_b32 v12, 3, v116
    v_cos_f32 v7, v7
    v_lshlrev_b16 v13, 3, v116
    v_mad_i32_i24 v11, v14, s55, v108
    v_bitop3_b32 v12, v6, v13, v12 bitop3:0xca
    v_lshl_add_u32 v11, v11, 17, s40
    v_lshlrev_b16 v14, 8, v14
    v_lshrrev_b32 v13, 2, v116
    v_add_u32 v108, v12, v11
    v_bitop3_b32 v116, v5, v13, v14 bitop3:0xea
    ds_add_u32 v116, v2
    v_mul_hi_u32_u24 v14, 429497, v109
    v_lshrrev_b32 v12, 3, v117
    v_cos_f32 v8, v8
    v_lshlrev_b16 v13, 3, v117
    v_mad_i32_i24 v11, v14, s55, v109
    v_bitop3_b32 v12, v6, v13, v12 bitop3:0xca
    v_lshl_add_u32 v11, v11, 17, s40
    v_lshlrev_b16 v14, 8, v14
    v_lshrrev_b32 v13, 2, v117
    v_add_u32 v109, v12, v11
    v_bitop3_b32 v117, v5, v13, v14 bitop3:0xea
    ds_add_u32 v117, v2
    v_cvt_pk_bf16_f32 v120, v7, v8
    v_perm_b32 v12, v120, v120, s41
    v_bitop3_b32 v108, v4, v12, v108 bitop3:0xca
    v_perm_b32 v13, v120, v120, s42
    v_bitop3_b32 v109, v4, v13, v109 bitop3:0xca
    v_mul_hi_u32_u24 v14, 429497, v110
    v_lshrrev_b32 v12, 3, v118
    v_cos_f32 v9, v9
    v_lshlrev_b16 v13, 3, v118
    v_mad_i32_i24 v11, v14, s55, v110
    v_bitop3_b32 v12, v6, v13, v12 bitop3:0xca
    v_lshl_add_u32 v11, v11, 17, s40
    v_lshlrev_b16 v14, 8, v14
    v_lshrrev_b32 v13, 2, v118
    v_add_u32 v110, v12, v11
    v_bitop3_b32 v118, v5, v13, v14 bitop3:0xea
    ds_add_u32 v118, v2
    v_mul_hi_u32_u24 v14, 429497, v111
    v_lshrrev_b32 v12, 3, v119
    v_cos_f32 v10, v10
    v_lshlrev_b16 v13, 3, v119
    v_mad_i32_i24 v11, v14, s55, v111
    v_bitop3_b32 v12, v6, v13, v12 bitop3:0xca
    v_lshl_add_u32 v11, v11, 17, s40
    v_lshlrev_b16 v14, 8, v14
    v_lshrrev_b32 v13, 2, v119
    v_add_u32 v111, v12, v11
    v_bitop3_b32 v119, v5, v13, v14 bitop3:0xea
    ds_add_u32 v119, v2
    v_cvt_pk_bf16_f32 v121, v9, v10
    v_perm_b32 v12, v121, v121, s41
    v_bitop3_b32 v110, v4, v12, v110 bitop3:0xca
    v_perm_b32 v13, v121, v121, s42
    v_bitop3_b32 v111, v4, v13, v111 bitop3:0xca
    s_waitcnt vmcnt(10)
    v_lshlrev_b32 v7, 16, v122
    v_and_b32 v8, 0xffff0000, v122
    v_lshlrev_b32 v9, 16, v123
    v_and_b32 v10, 0xffff0000, v123
    v_mul_f32 v7, 0.15915494, v7
    v_mul_f32 v8, 0.15915494, v8
    v_mul_f32 v9, 0.15915494, v9
    v_mul_f32 v10, 0.15915494, v10
    v_mul_hi_u32_u24 v14, 429497, v92
    v_lshrrev_b32 v12, 3, v16
    v_cos_f32 v7, v7
    v_lshlrev_b16 v13, 3, v16
    v_mad_i32_i24 v11, v14, s55, v92
    v_bitop3_b32 v12, v6, v13, v12 bitop3:0xca
    v_lshl_add_u32 v11, v11, 17, s40
    v_lshlrev_b16 v14, 8, v14
    v_lshrrev_b32 v13, 2, v16
    v_add_u32 v92, v12, v11
    v_bitop3_b32 v16, v5, v13, v14 bitop3:0xea
    ds_add_u32 v16, v2
    v_mul_hi_u32_u24 v14, 429497, v93
    v_lshrrev_b32 v12, 3, v17
    v_cos_f32 v8, v8
    v_lshlrev_b16 v13, 3, v17
    v_mad_i32_i24 v11, v14, s55, v93
    v_bitop3_b32 v12, v6, v13, v12 bitop3:0xca
    v_lshl_add_u32 v11, v11, 17, s40
    v_lshlrev_b16 v14, 8, v14
    v_lshrrev_b32 v13, 2, v17
    v_add_u32 v93, v12, v11
    v_bitop3_b32 v17, v5, v13, v14 bitop3:0xea
    ds_add_u32 v17, v2
    v_cvt_pk_bf16_f32 v122, v7, v8
    v_perm_b32 v12, v122, v122, s41
    v_bitop3_b32 v92, v4, v12, v92 bitop3:0xca
    v_perm_b32 v13, v122, v122, s42
    v_bitop3_b32 v93, v4, v13, v93 bitop3:0xca
    v_mul_hi_u32_u24 v14, 429497, v94
    v_lshrrev_b32 v12, 3, v18
    v_cos_f32 v9, v9
    v_lshlrev_b16 v13, 3, v18
    v_mad_i32_i24 v11, v14, s55, v94
    v_bitop3_b32 v12, v6, v13, v12 bitop3:0xca
    v_lshl_add_u32 v11, v11, 17, s40
    v_lshlrev_b16 v14, 8, v14
    v_lshrrev_b32 v13, 2, v18
    v_add_u32 v94, v12, v11
    v_bitop3_b32 v18, v5, v13, v14 bitop3:0xea
    ds_add_u32 v18, v2
    v_mul_hi_u32_u24 v14, 429497, v95
    v_lshrrev_b32 v12, 3, v19
    v_cos_f32 v10, v10
    v_lshlrev_b16 v13, 3, v19
    v_mad_i32_i24 v11, v14, s55, v95
    v_bitop3_b32 v12, v6, v13, v12 bitop3:0xca
    v_lshl_add_u32 v11, v11, 17, s40
    v_lshlrev_b16 v14, 8, v14
    v_lshrrev_b32 v13, 2, v19
    v_add_u32 v95, v12, v11
    v_bitop3_b32 v19, v5, v13, v14 bitop3:0xea
    ds_add_u32 v19, v2
    v_cvt_pk_bf16_f32 v123, v9, v10
    v_perm_b32 v12, v123, v123, s41
    v_bitop3_b32 v94, v4, v12, v94 bitop3:0xca
    v_perm_b32 v13, v123, v123, s42
    v_bitop3_b32 v95, v4, v13, v95 bitop3:0xca
    s_setprio 0
    s_add_u32 s44, s35, 0x2a44000
    s_add_u32 s44, s44, s91
    buffer_store_dwordx4 v[24:27], v0, s[20:23], s44 offen sc1
    s_add_u32 s45, s96, 0x6000000
    s_nop 0
    v_lshlrev_b32 v24, 1, v1
    buffer_load_dwordx4 v[24:27], v24, s[12:15], s45 offen nt
    s_waitcnt vmcnt(8)
    v_lshlrev_b32 v7, 16, v28
    v_and_b32 v8, 0xffff0000, v28
    v_lshlrev_b32 v9, 16, v29
    v_and_b32 v10, 0xffff0000, v29
    v_mul_f32 v7, 0.15915494, v7
    v_mul_f32 v8, 0.15915494, v8
    v_mul_f32 v9, 0.15915494, v9
    v_mul_f32 v10, 0.15915494, v10
    v_mul_hi_u32_u24 v14, 429497, v20
    v_lshrrev_b32 v12, 3, v124
    v_cos_f32 v7, v7
    v_lshlrev_b16 v13, 3, v124
    v_mad_i32_i24 v11, v14, s55, v20
    v_bitop3_b32 v12, v6, v13, v12 bitop3:0xca
    v_lshl_add_u32 v11, v11, 17, s40
    v_lshlrev_b16 v14, 8, v14
    v_lshrrev_b32 v13, 2, v124
    v_add_u32 v20, v12, v11
    v_bitop3_b32 v124, v5, v13, v14 bitop3:0xea
    ds_add_u32 v124, v2
    v_mul_hi_u32_u24 v14, 429497, v21
    v_lshrrev_b32 v12, 3, v125
    v_cos_f32 v8, v8
    v_lshlrev_b16 v13, 3, v125
    v_mad_i32_i24 v11, v14, s55, v21
    v_bitop3_b32 v12, v6, v13, v12 bitop3:0xca
    v_lshl_add_u32 v11, v11, 17, s40
    v_lshlrev_b16 v14, 8, v14
    v_lshrrev_b32 v13, 2, v125
    v_add_u32 v21, v12, v11
    v_bitop3_b32 v125, v5, v13, v14 bitop3:0xea
    ds_add_u32 v125, v2
    v_cvt_pk_bf16_f32 v28, v7, v8
    v_perm_b32 v12, v28, v28, s41
    v_bitop3_b32 v20, v4, v12, v20 bitop3:0xca
    v_perm_b32 v13, v28, v28, s42
    v_bitop3_b32 v21, v4, v13, v21 bitop3:0xca
    v_mul_hi_u32_u24 v14, 429497, v22
    v_lshrrev_b32 v12, 3, v126
    v_cos_f32 v9, v9
    v_lshlrev_b16 v13, 3, v126
    v_mad_i32_i24 v11, v14, s55, v22
    v_bitop3_b32 v12, v6, v13, v12 bitop3:0xca
    v_lshl_add_u32 v11, v11, 17, s40
    v_lshlrev_b16 v14, 8, v14
    v_lshrrev_b32 v13, 2, v126
    v_add_u32 v22, v12, v11
    v_bitop3_b32 v126, v5, v13, v14 bitop3:0xea
    ds_add_u32 v126, v2
    v_mul_hi_u32_u24 v14, 429497, v23
    v_lshrrev_b32 v12, 3, v127
    v_cos_f32 v10, v10
    v_lshlrev_b16 v13, 3, v127
    v_mad_i32_i24 v11, v14, s55, v23
    v_bitop3_b32 v12, v6, v13, v12 bitop3:0xca
    v_lshl_add_u32 v11, v11, 17, s40
    v_lshlrev_b16 v14, 8, v14
    v_lshrrev_b32 v13, 2, v127
    v_add_u32 v23, v12, v11
    v_bitop3_b32 v127, v5, v13, v14 bitop3:0xea
    ds_add_u32 v127, v2
    v_cvt_pk_bf16_f32 v29, v9, v10
    v_perm_b32 v12, v29, v29, s41
    v_bitop3_b32 v22, v4, v12, v22 bitop3:0xca
    v_perm_b32 v13, v29, v29, s42
    v_bitop3_b32 v23, v4, v13, v23 bitop3:0xca
    s_waitcnt vmcnt(4)
    v_lshlrev_b32 v7, 16, v30
    v_and_b32 v8, 0xffff0000, v30
    v_lshlrev_b32 v9, 16, v31
    v_and_b32 v10, 0xffff0000, v31
    v_mul_f32 v7, 0.15915494, v7
    v_mul_f32 v8, 0.15915494, v8
    v_mul_f32 v9, 0.15915494, v9
    v_mul_f32 v10, 0.15915494, v10
    v_mul_hi_u32_u24 v14, 429497, v32
    v_lshrrev_b32 v12, 3, v36
    v_cos_f32 v7, v7
    v_lshlrev_b16 v13, 3, v36
    v_mad_i32_i24 v11, v14, s55, v32
    v_bitop3_b32 v12, v6, v13, v12 bitop3:0xca
    v_lshl_add_u32 v11, v11, 17, s40
    v_lshlrev_b16 v14, 8, v14
    v_lshrrev_b32 v13, 2, v36
    v_add_u32 v32, v12, v11
    v_bitop3_b32 v36, v5, v13, v14 bitop3:0xea
    ds_add_u32 v36, v2
    v_mul_hi_u32_u24 v14, 429497, v33
    v_lshrrev_b32 v12, 3, v37
    v_cos_f32 v8, v8
    v_lshlrev_b16 v13, 3, v37
    v_mad_i32_i24 v11, v14, s55, v33
    v_bitop3_b32 v12, v6, v13, v12 bitop3:0xca
    v_lshl_add_u32 v11, v11, 17, s40
    v_lshlrev_b16 v14, 8, v14
    v_lshrrev_b32 v13, 2, v37
    v_add_u32 v33, v12, v11
    v_bitop3_b32 v37, v5, v13, v14 bitop3:0xea
    ds_add_u32 v37, v2
    v_cvt_pk_bf16_f32 v30, v7, v8
    v_perm_b32 v12, v30, v30, s41
    v_bitop3_b32 v32, v4, v12, v32 bitop3:0xca
    v_perm_b32 v13, v30, v30, s42
    v_bitop3_b32 v33, v4, v13, v33 bitop3:0xca
    v_mul_hi_u32_u24 v14, 429497, v34
    v_lshrrev_b32 v12, 3, v38
    v_cos_f32 v9, v9
    v_lshlrev_b16 v13, 3, v38
    v_mad_i32_i24 v11, v14, s55, v34
    v_bitop3_b32 v12, v6, v13, v12 bitop3:0xca
    v_lshl_add_u32 v11, v11, 17, s40
    v_lshlrev_b16 v14, 8, v14
    v_lshrrev_b32 v13, 2, v38
    v_add_u32 v34, v12, v11
    v_bitop3_b32 v38, v5, v13, v14 bitop3:0xea
    ds_add_u32 v38, v2
    v_mul_hi_u32_u24 v14, 429497, v35
    v_lshrrev_b32 v12, 3, v39
    v_cos_f32 v10, v10
    v_lshlrev_b16 v13, 3, v39
    v_mad_i32_i24 v11, v14, s55, v35
    v_bitop3_b32 v12, v6, v13, v12 bitop3:0xca
    v_lshl_add_u32 v11, v11, 17, s40
    v_lshlrev_b16 v14, 8, v14
    v_lshrrev_b32 v13, 2, v39
    v_add_u32 v35, v12, v11
    v_bitop3_b32 v39, v5, v13, v14 bitop3:0xea
    ds_add_u32 v39, v2
    v_cvt_pk_bf16_f32 v31, v9, v10
    v_perm_b32 v12, v31, v31, s41
    v_bitop3_b32 v34, v4, v12, v34 bitop3:0xca
    v_perm_b32 v13, v31, v31, s42
    v_bitop3_b32 v35, v4, v13, v35 bitop3:0xca
    v_lshrrev_b32 v8, 2, v0
    v_and_b32 v7, 0x3c00, v0
    v_bitop3_b32 v7, v5, v8, v7 bitop3:0xea
    s_waitcnt lgkmcnt(0)
    s_barrier
    ds_read2st64_b32 v[8:9], v7 offset0:0 offset1:1
    ds_read2st64_b32 v[10:11], v7 offset0:2 offset1:3
    s_add_u32 s46, s35, 0x2a44000
    s_add_u32 s46, s46, s93
    buffer_store_dwordx4 v[84:87], v0, s[20:23], s46 offen sc1
    s_add_u32 s47, s96, 0x6000000
    s_lshr_b32 s47, s47, 1
    buffer_load_dwordx2 v[84:85], v1, s[16:19], s47 offen nt
    s_add_u32 s44, s97, 0x6400000
    s_lshr_b32 s44, s44, 1
    buffer_load_dwordx2 v[86:87], v1, s[16:19], s44 offen nt
    s_waitcnt lgkmcnt(0)
    v_lshl_or_b32 v12, v9, 16, v8
    v_lshl_or_b32 v13, v11, 16, v10
    v_mov_b32 v14, v12
    v_mov_b32 v15, v13
    s_nop 0
    v_add_u32_dpp v14, v14, v14 row_shr:1 row_mask:0xf bank_mask:0xf bound_ctrl:1
    v_add_u32_dpp v15, v15, v15 row_shr:1 row_mask:0xf bank_mask:0xf bound_ctrl:1
    s_nop 0
    v_add_u32_dpp v14, v14, v14 row_shr:2 row_mask:0xf bank_mask:0xf bound_ctrl:1
    v_add_u32_dpp v15, v15, v15 row_shr:2 row_mask:0xf bank_mask:0xf bound_ctrl:1
    s_nop 0
    v_add_u32_dpp v14, v14, v14 row_shr:4 row_mask:0xf bank_mask:0xf bound_ctrl:1
    v_add_u32_dpp v15, v15, v15 row_shr:4 row_mask:0xf bank_mask:0xf bound_ctrl:1
    s_nop 0
    v_add_u32_dpp v14, v14, v14 row_shr:8 row_mask:0xf bank_mask:0xf bound_ctrl:1
    v_add_u32_dpp v15, v15, v15 row_shr:8 row_mask:0xf bank_mask:0xf bound_ctrl:1
    s_nop 0
    v_add_u32_dpp v14, v14, v14 row_bcast:15 row_mask:0xa bank_mask:0xf
    v_add_u32_dpp v15, v15, v15 row_bcast:15 row_mask:0xa bank_mask:0xf
    s_nop 0
    v_add_u32_dpp v14, v14, v14 row_bcast:31 row_mask:0xc bank_mask:0xf
    v_add_u32_dpp v15, v15, v15 row_bcast:31 row_mask:0xc bank_mask:0xf
    v_readlane_b32 s48, v14, 63
    v_readlane_b32 s49, v15, 63
    s_lshl_b32 s54, s32, 2
    v_mov_b32 v8, s54
    s_and_b32 s50, s48, 0xffff
    s_lshr_b32 s51, s48, 16
    s_and_b32 s52, s49, 0xffff
    s_lshr_b32 s53, s49, 16
    s_add_u32 s51, s51, s50
    s_add_u32 s52, s52, s51
    s_add_u32 s53, s53, s52
    v_mov_b32 v9, s53
    s_mov_b64 exec, 1
    ds_write_b32 v8, v9 offset:16384
    s_mov_b64 exec, -1
    v_and_b32 v8, 60, v7
    s_waitcnt lgkmcnt(0)
    s_barrier
    ds_read_b32 v9, v8 offset:16384
    s_waitcnt lgkmcnt(0)
    v_add_u32_dpp v9, v9, v9 row_shr:1 row_mask:0xf bank_mask:0xf bound_ctrl:1
    s_nop 1
    v_add_u32_dpp v9, v9, v9 row_shr:2 row_mask:0xf bank_mask:0xf bound_ctrl:1
    s_nop 1
    v_add_u32_dpp v9, v9, v9 row_shr:4 row_mask:0xf bank_mask:0xf bound_ctrl:1
    s_nop 1
    v_add_u32_dpp v9, v9, v9 row_shr:8 row_mask:0xf bank_mask:0xf bound_ctrl:1
    s_nop 0
    v_readlane_b32 s54, v9, s32
    s_sub_u32 s54, s54, s53
    s_add_u32 s50, s50, s54
    s_add_u32 s51, s51, s54
    s_add_u32 s52, s52, s54
    s_pack_ll_b32_b16 s48, s54, s50
    s_pack_ll_b32_b16 s49, s51, s52
    v_add_u32 v14, s48, v14
    v_add_u32 v15, s49, v15
    v_sub_u32 v12, v14, v12
    v_sub_u32 v13, v15, v13
    v_and_b32 v8, 0xffff, v12
    v_lshrrev_b32 v9, 16, v12
    v_and_b32 v10, 0xffff, v13
    v_lshrrev_b32 v11, 16, v13
    ds_write2st64_b32 v7, v8, v9 offset0:0 offset1:1
    ds_write2st64_b32 v7, v10, v11 offset0:2 offset1:3
    v_and_b32 v8, 0x3f0, v0
    v_lshl_add_u32 v8, v8, 1, s36
    ds_write_b64 v8, v[12:13] offset:20480
    s_bitset0_b64 exec, 63
    s_not_b64 exec, exec
    ds_write_b64 v8, v[14:15] offset:20512
    s_mov_b64 exec, -1
    s_waitcnt lgkmcnt(0)
    s_barrier
    s_setprio 3
    ds_add_rtn_u32 v72, v72, v2
    ds_add_rtn_u32 v73, v73, v2
    ds_add_rtn_u32 v74, v74, v2
    ds_add_rtn_u32 v75, v75, v2
    ds_read_b128 v[12:15], v0 offset:20480
    v_cmp_gt_u32 vcc, 8448, v0
    ds_add_rtn_u32 v80, v80, v2
    ds_add_rtn_u32 v81, v81, v2
    ds_add_rtn_u32 v82, v82, v2
    ds_add_rtn_u32 v83, v83, v2
    s_setprio 2
    ds_add_rtn_u32 v104, v104, v2
    ds_add_rtn_u32 v105, v105, v2
    ds_add_rtn_u32 v106, v106, v2
    ds_add_rtn_u32 v107, v107, v2
    s_waitcnt lgkmcnt(8)
    s_cbranch_vccz L1_p3
    s_add_u32 s45, s35, 0x5480000
    s_mov_b64 exec, vcc
    buffer_store_dwordx4 v[12:15], v0, s[24:27], s45 offen sc1
    s_mov_b64 exec, -1
L1_p3:
    s_add_u32 s46, s35, 0x2a48000
    s_add_u32 s46, s46, s72
    buffer_store_dwordx4 v[48:51], v0, s[20:23], s46 offen sc1
    s_add_u32 s47, s97, 0x6400000
    s_nop 0
    v_lshlrev_b32 v48, 1, v1
    buffer_load_dwordx4 v[48:51], v48, s[8:11], s47 offen nt
    ds_add_rtn_u32 v112, v112, v2
    ds_add_rtn_u32 v113, v113, v2
    ds_add_rtn_u32 v114, v114, v2
    ds_add_rtn_u32 v115, v115, v2
    s_setprio 1
    ds_add_rtn_u32 v116, v116, v2
    ds_add_rtn_u32 v117, v117, v2
    ds_add_rtn_u32 v118, v118, v2
    ds_add_rtn_u32 v119, v119, v2
    ds_add_rtn_u32 v16, v16, v2
    ds_add_rtn_u32 v17, v17, v2
    ds_add_rtn_u32 v18, v18, v2
    ds_add_rtn_u32 v19, v19, v2
    s_add_u32 s44, s35, 0x2a48000
    s_add_u32 s44, s44, s73
    buffer_store_dwordx4 v[52:55], v0, s[20:23], s44 offen sc1
    s_add_u32 s45, s97, 0x6400000
    s_nop 0
    v_lshlrev_b32 v52, 1, v1
    buffer_load_dwordx4 v[52:55], v52, s[12:15], s45 offen nt
    s_setprio 0
    ds_add_rtn_u32 v124, v124, v2
    ds_add_rtn_u32 v125, v125, v2
    ds_add_rtn_u32 v126, v126, v2
    ds_add_rtn_u32 v127, v127, v2
    ds_add_rtn_u32 v36, v36, v2
    ds_add_rtn_u32 v37, v37, v2
    ds_add_rtn_u32 v38, v38, v2
    ds_add_rtn_u32 v39, v39, v2
    s_waitcnt lgkmcnt(0)
    s_barrier
    s_setprio 3
    v_and_b32 v7, -4, v72
    v_lshl_add_u32 v8, v72, 2, v7
    ds_write_b32 v8, v68
    v_lshl_add_u32 v7, v7, 2, v72
    ds_write_b8 v7, v64 offset:16
    v_and_b32 v9, -4, v73
    v_lshl_add_u32 v10, v73, 2, v9
    ds_write_b32 v10, v69
    v_lshl_add_u32 v9, v9, 2, v73
    ds_write_b8_d16_hi v9, v64 offset:16
    v_and_b32 v7, -4, v74
    v_lshl_add_u32 v8, v74, 2, v7
    ds_write_b32 v8, v70
    v_lshl_add_u32 v7, v7, 2, v74
    ds_write_b8 v7, v65 offset:16
    v_and_b32 v9, -4, v75
    v_lshl_add_u32 v10, v75, 2, v9
    ds_write_b32 v10, v71
    v_lshl_add_u32 v9, v9, 2, v75
    ds_write_b8_d16_hi v9, v65 offset:16
    s_add_u32 s46, s35, 0x2a48000
    s_add_u32 s46, s46, s85
    buffer_store_dwordx4 v[56:59], v0, s[20:23], s46 offen sc1
    s_add_u32 s47, s98, 0x6800000
    v_lshlrev_b32 v68, 1, v1
    buffer_load_dwordx4 v[68:71], v68, s[8:11], s47 offen nt
    s_add_u32 s44, s98, 0x6800000
    v_lshlrev_b32 v72, 1, v1
    buffer_load_dwordx4 v[72:75], v72, s[12:15], s44 offen nt
    v_and_b32 v7, -4, v80
    v_lshl_add_u32 v8, v80, 2, v7
    ds_write_b32 v8, v76
    v_lshl_add_u32 v7, v7, 2, v80
    ds_write_b8 v7, v66 offset:16
    v_and_b32 v9, -4, v81
    v_lshl_add_u32 v10, v81, 2, v9
    ds_write_b32 v10, v77
    v_lshl_add_u32 v9, v9, 2, v81
    ds_write_b8_d16_hi v9, v66 offset:16
    v_and_b32 v7, -4, v82
    v_lshl_add_u32 v8, v82, 2, v7
    ds_write_b32 v8, v78
    v_lshl_add_u32 v7, v7, 2, v82
    ds_write_b8 v7, v67 offset:16
    v_and_b32 v9, -4, v83
    v_lshl_add_u32 v10, v83, 2, v9
    ds_write_b32 v10, v79
    v_lshl_add_u32 v9, v9, 2, v83
    ds_write_b8_d16_hi v9, v67 offset:16
    s_add_u32 s45, s98, 0x6800000
    s_lshr_b32 s45, s45, 1
    buffer_load_dwordx2 v[56:57], v1, s[16:19], s45 offen nt
    s_add_u32 s46, s99, 0x6c00000
    s_lshr_b32 s46, s46, 1
    buffer_load_dwordx2 v[58:59], v1, s[16:19], s46 offen nt
    s_add_u32 s47, s99, 0x6c00000
    v_lshlrev_b32 v76, 1, v1
    buffer_load_dwordx4 v[76:79], v76, s[8:11], s47 offen nt
    s_setprio 2
    v_and_b32 v7, -4, v104
    v_lshl_add_u32 v8, v104, 2, v7
    ds_write_b32 v8, v96
    v_lshl_add_u32 v7, v7, 2, v104
    ds_write_b8 v7, v88 offset:16
    v_and_b32 v9, -4, v105
    v_lshl_add_u32 v10, v105, 2, v9
    ds_write_b32 v10, v97
    v_lshl_add_u32 v9, v9, 2, v105
    ds_write_b8_d16_hi v9, v88 offset:16
    v_and_b32 v7, -4, v106
    v_lshl_add_u32 v8, v106, 2, v7
    ds_write_b32 v8, v98
    v_lshl_add_u32 v7, v7, 2, v106
    ds_write_b8 v7, v89 offset:16
    v_and_b32 v9, -4, v107
    v_lshl_add_u32 v10, v107, 2, v9
    ds_write_b32 v10, v99
    v_lshl_add_u32 v9, v9, 2, v107
    ds_write_b8_d16_hi v9, v89 offset:16
    s_add_u32 s44, s35, 0x2a48000
    s_add_u32 s44, s44, s91
    buffer_store_dwordx4 v[60:63], v0, s[20:23], s44 offen sc1
    s_add_u32 s45, s99, 0x6c00000
    v_lshlrev_b32 v80, 1, v1
    buffer_load_dwordx4 v[80:83], v80, s[12:15], s45 offen nt
    v_and_b32 v7, -4, v112
    v_lshl_add_u32 v8, v112, 2, v7
    ds_write_b32 v8, v100
    v_lshl_add_u32 v7, v7, 2, v112
    ds_write_b8 v7, v90 offset:16
    v_and_b32 v9, -4, v113
    v_lshl_add_u32 v10, v113, 2, v9
    ds_write_b32 v10, v101
    v_lshl_add_u32 v9, v9, 2, v113
    ds_write_b8_d16_hi v9, v90 offset:16
    v_and_b32 v7, -4, v114
    v_lshl_add_u32 v8, v114, 2, v7
    ds_write_b32 v8, v102
    v_lshl_add_u32 v7, v7, 2, v114
    ds_write_b8 v7, v91 offset:16
    v_and_b32 v9, -4, v115
    v_lshl_add_u32 v10, v115, 2, v9
    ds_write_b32 v10, v103
    v_lshl_add_u32 v9, v9, 2, v115
    ds_write_b8_d16_hi v9, v91 offset:16
    s_add_u32 s46, s96, 0x7000000
    v_lshlrev_b32 v64, 1, v1
    buffer_load_dwordx4 v[64:67], v64, s[8:11], s46 offen nt
    s_add_u32 s47, s96, 0x7000000
    v_lshlrev_b32 v96, 1, v1
    buffer_load_dwordx4 v[96:99], v96, s[12:15], s47 offen nt
    s_setprio 1
    v_and_b32 v7, -4, v116
    v_lshl_add_u32 v8, v116, 2, v7
    ds_write_b32 v8, v108
    v_lshl_add_u32 v7, v7, 2, v116
    ds_write_b8 v7, v120 offset:16
    v_and_b32 v9, -4, v117
    v_lshl_add_u32 v10, v117, 2, v9
    ds_write_b32 v10, v109
    v_lshl_add_u32 v9, v9, 2, v117
    ds_write_b8_d16_hi v9, v120 offset:16
    v_and_b32 v7, -4, v118
    v_lshl_add_u32 v8, v118, 2, v7
    ds_write_b32 v8, v110
    v_lshl_add_u32 v7, v7, 2, v118
    ds_write_b8 v7, v121 offset:16
    v_and_b32 v9, -4, v119
    v_lshl_add_u32 v10, v119, 2, v9
    ds_write_b32 v10, v111
    v_lshl_add_u32 v9, v9, 2, v119
    ds_write_b8_d16_hi v9, v121 offset:16
    s_add_u32 s44, s96, 0x7000000
    s_lshr_b32 s44, s44, 1
    buffer_load_dwordx2 v[104:105], v1, s[16:19], s44 offen nt
    s_add_u32 s45, s97, 0x7400000
    s_lshr_b32 s45, s45, 1
    buffer_load_dwordx2 v[106:107], v1, s[16:19], s45 offen nt
    s_add_u32 s46, s97, 0x7400000
    v_lshlrev_b32 v60, 1, v1
    buffer_load_dwordx4 v[60:63], v60, s[8:11], s46 offen nt
    v_and_b32 v7, -4, v16
    v_lshl_add_u32 v8, v16, 2, v7
    ds_write_b32 v8, v92
    v_lshl_add_u32 v7, v7, 2, v16
    ds_write_b8 v7, v122 offset:16
    v_and_b32 v9, -4, v17
    v_lshl_add_u32 v10, v17, 2, v9
    ds_write_b32 v10, v93
    v_lshl_add_u32 v9, v9, 2, v17
    ds_write_b8_d16_hi v9, v122 offset:16
    v_and_b32 v7, -4, v18
    v_lshl_add_u32 v8, v18, 2, v7
    ds_write_b32 v8, v94
    v_lshl_add_u32 v7, v7, 2, v18
    ds_write_b8 v7, v123 offset:16
    v_and_b32 v9, -4, v19
    v_lshl_add_u32 v10, v19, 2, v9
    ds_write_b32 v10, v95
    v_lshl_add_u32 v9, v9, 2, v19
    ds_write_b8_d16_hi v9, v123 offset:16
    s_add_u32 s47, s35, 0x2a48000
    s_add_u32 s47, s47, s93
    buffer_store_dwordx4 v[44:47], v0, s[20:23], s47 offen sc1
    s_add_u32 s44, s97, 0x7400000
    v_lshlrev_b32 v100, 1, v1
    buffer_load_dwordx4 v[100:103], v100, s[12:15], s44 offen nt
    s_setprio 0
    v_and_b32 v7, -4, v124
    v_lshl_add_u32 v8, v124, 2, v7
    ds_write_b32 v8, v20
    v_lshl_add_u32 v7, v7, 2, v124
    ds_write_b8 v7, v28 offset:16
    v_and_b32 v9, -4, v125
    v_lshl_add_u32 v10, v125, 2, v9
    ds_write_b32 v10, v21
    v_lshl_add_u32 v9, v9, 2, v125
    ds_write_b8_d16_hi v9, v28 offset:16
    v_and_b32 v7, -4, v126
    v_lshl_add_u32 v8, v126, 2, v7
    ds_write_b32 v8, v22
    v_lshl_add_u32 v7, v7, 2, v126
    ds_write_b8 v7, v29 offset:16
    v_and_b32 v9, -4, v127
    v_lshl_add_u32 v10, v127, 2, v9
    ds_write_b32 v10, v23
    v_lshl_add_u32 v9, v9, 2, v127
    ds_write_b8_d16_hi v9, v29 offset:16
    s_add_u32 s45, s98, 0x7800000
    v_lshlrev_b32 v112, 1, v1
    buffer_load_dwordx4 v[112:115], v112, s[8:11], s45 offen nt
    s_add_u32 s46, s98, 0x7800000
    v_lshlrev_b32 v88, 1, v1
    buffer_load_dwordx4 v[88:91], v88, s[12:15], s46 offen nt
    v_and_b32 v7, -4, v36
    v_lshl_add_u32 v8, v36, 2, v7
    ds_write_b32 v8, v32
    v_lshl_add_u32 v7, v7, 2, v36
    ds_write_b8 v7, v30 offset:16
    v_and_b32 v9, -4, v37
    v_lshl_add_u32 v10, v37, 2, v9
    ds_write_b32 v10, v33
    v_lshl_add_u32 v9, v9, 2, v37
    ds_write_b8_d16_hi v9, v30 offset:16
    v_and_b32 v7, -4, v38
    v_lshl_add_u32 v8, v38, 2, v7
    ds_write_b32 v8, v34
    v_lshl_add_u32 v7, v7, 2, v38
    ds_write_b8 v7, v31 offset:16
    v_and_b32 v9, -4, v39
    v_lshl_add_u32 v10, v39, 2, v9
    ds_write_b32 v10, v35
    v_lshl_add_u32 v9, v9, 2, v39
    ds_write_b8_d16_hi v9, v31 offset:16
    s_add_u32 s47, s98, 0x7800000
    s_lshr_b32 s47, s47, 1
    buffer_load_dwordx2 v[108:109], v1, s[16:19], s47 offen nt
    s_add_u32 s44, s99, 0x7c00000
    s_lshr_b32 s44, s44, 1
    buffer_load_dwordx2 v[110:111], v1, s[16:19], s44 offen nt
    v_add_u32 v7, s72, v0
    v_add_u32 v12, s73, v0
    v_add_u32 v13, s85, v0
    v_add_u32 v14, s91, v0
    v_add_u32 v15, s93, v0
    s_min_i32 s3, s72, s73
    s_min_i32 s3, s3, s85
    s_min_i32 s3, s3, s91
    s_min_i32 s3, s3, s93
    v_add_u32 v3, s3, v0
    v_mov_b32 v8, 0
    v_mov_b32 v9, 0
    v_mov_b32 v10, 0
    v_mov_b32 v11, 0
    s_waitcnt lgkmcnt(0)
    s_barrier
    ds_read_b128 v[116:119], v7 offset:0
    ds_read_b128 v[92:95], v12 offset:0
    ds_read_b128 v[16:19], v13 offset:0
    ds_read_b128 v[120:123], v14 offset:0
    ds_read_b128 v[44:47], v15 offset:0
    ds_write_b128 v3, v[8:11]
    ds_read_b128 v[20:23], v7 offset:16384
    ds_read_b128 v[124:127], v12 offset:16384
    ds_read_b128 v[32:35], v13 offset:16384
    ds_read_b128 v[36:39], v14 offset:16384
    ds_read_b128 v[28:31], v15 offset:16384
    s_waitcnt lgkmcnt(0)
    s_barrier
    s_setprio 3
    s_add_u32 s45, s35, 0x5484000
    s_add_u32 s45, s45, s72
    buffer_store_dwordx4 v[116:119], v0, s[20:23], s45 offen sc1
    s_add_u32 s46, s99, 0x7c00000
    s_nop 0
    v_lshlrev_b32 v116, 1, v1
    buffer_load_dwordx4 v[116:119], v116, s[8:11], s46 offen nt
    s_add_u32 s47, s35, 0x5484000
    s_add_u32 s47, s47, s73
    buffer_store_dwordx4 v[92:95], v0, s[20:23], s47 offen sc1
    s_add_u32 s44, s99, 0x7c00000
    s_nop 0
    v_lshlrev_b32 v92, 1, v1
    buffer_load_dwordx4 v[92:95], v92, s[12:15], s44 offen nt
    s_waitcnt vmcnt(27)
    v_lshlrev_b32 v7, 16, v84
    v_and_b32 v8, 0xffff0000, v84
    v_lshlrev_b32 v9, 16, v85
    v_and_b32 v10, 0xffff0000, v85
    v_mul_f32 v7, 0.15915494, v7
    v_mul_f32 v8, 0.15915494, v8
    v_mul_f32 v9, 0.15915494, v9
    v_mul_f32 v10, 0.15915494, v10
    v_mul_hi_u32_u24 v14, 429497, v40
    v_lshrrev_b32 v12, 3, v24
    v_cos_f32 v7, v7
    v_lshlrev_b16 v13, 3, v24
    v_mad_i32_i24 v11, v14, s55, v40
    v_bitop3_b32 v12, v6, v13, v12 bitop3:0xca
    v_lshl_add_u32 v11, v11, 17, s40
    v_lshlrev_b16 v14, 8, v14
    v_lshrrev_b32 v13, 2, v24
    v_add_u32 v40, v12, v11
    v_bitop3_b32 v24, v5, v13, v14 bitop3:0xea
    ds_add_u32 v24, v2
    v_mul_hi_u32_u24 v14, 429497, v41
    v_lshrrev_b32 v12, 3, v25
    v_cos_f32 v8, v8
    v_lshlrev_b16 v13, 3, v25
    v_mad_i32_i24 v11, v14, s55, v41
    v_bitop3_b32 v12, v6, v13, v12 bitop3:0xca
    v_lshl_add_u32 v11, v11, 17, s40
    v_lshlrev_b16 v14, 8, v14
    v_lshrrev_b32 v13, 2, v25
    v_add_u32 v41, v12, v11
    v_bitop3_b32 v25, v5, v13, v14 bitop3:0xea
    ds_add_u32 v25, v2
    v_cvt_pk_bf16_f32 v84, v7, v8
    v_perm_b32 v12, v84, v84, s41
    v_bitop3_b32 v40, v4, v12, v40 bitop3:0xca
    v_perm_b32 v13, v84, v84, s42
    v_bitop3_b32 v41, v4, v13, v41 bitop3:0xca
    v_mul_hi_u32_u24 v14, 429497, v42
    v_lshrrev_b32 v12, 3, v26
    v_cos_f32 v9, v9
    v_lshlrev_b16 v13, 3, v26
    v_mad_i32_i24 v11, v14, s55, v42
    v_bitop3_b32 v12, v6, v13, v12 bitop3:0xca
    v_lshl_add_u32 v11, v11, 17, s40
    v_lshlrev_b16 v14, 8, v14
    v_lshrrev_b32 v13, 2, v26
    v_add_u32 v42, v12, v11
    v_bitop3_b32 v26, v5, v13, v14 bitop3:0xea
    ds_add_u32 v26, v2
    v_mul_hi_u32_u24 v14, 429497, v43
    v_lshrrev_b32 v12, 3, v27
    v_cos_f32 v10, v10
    v_lshlrev_b16 v13, 3, v27
    v_mad_i32_i24 v11, v14, s55, v43
    v_bitop3_b32 v12, v6, v13, v12 bitop3:0xca
    v_lshl_add_u32 v11, v11, 17, s40
    v_lshlrev_b16 v14, 8, v14
    v_lshrrev_b32 v13, 2, v27
    v_add_u32 v43, v12, v11
    v_bitop3_b32 v27, v5, v13, v14 bitop3:0xea
    ds_add_u32 v27, v2
    v_cvt_pk_bf16_f32 v85, v9, v10
    v_perm_b32 v12, v85, v85, s41
    v_bitop3_b32 v42, v4, v12, v42 bitop3:0xca
    v_perm_b32 v13, v85, v85, s42
    v_bitop3_b32 v43, v4, v13, v43 bitop3:0xca
    s_waitcnt vmcnt(23)
    v_lshlrev_b32 v7, 16, v86
    v_and_b32 v8, 0xffff0000, v86
    v_lshlrev_b32 v9, 16, v87
    v_and_b32 v10, 0xffff0000, v87
    v_mul_f32 v7, 0.15915494, v7
    v_mul_f32 v8, 0.15915494, v8
    v_mul_f32 v9, 0.15915494, v9
    v_mul_f32 v10, 0.15915494, v10
    v_mul_hi_u32_u24 v14, 429497, v48
    v_lshrrev_b32 v12, 3, v52
    v_cos_f32 v7, v7
    v_lshlrev_b16 v13, 3, v52
    v_mad_i32_i24 v11, v14, s55, v48
    v_bitop3_b32 v12, v6, v13, v12 bitop3:0xca
    v_lshl_add_u32 v11, v11, 17, s40
    v_lshlrev_b16 v14, 8, v14
    v_lshrrev_b32 v13, 2, v52
    v_add_u32 v48, v12, v11
    v_bitop3_b32 v52, v5, v13, v14 bitop3:0xea
    ds_add_u32 v52, v2
    v_mul_hi_u32_u24 v14, 429497, v49
    v_lshrrev_b32 v12, 3, v53
    v_cos_f32 v8, v8
    v_lshlrev_b16 v13, 3, v53
    v_mad_i32_i24 v11, v14, s55, v49
    v_bitop3_b32 v12, v6, v13, v12 bitop3:0xca
    v_lshl_add_u32 v11, v11, 17, s40
    v_lshlrev_b16 v14, 8, v14
    v_lshrrev_b32 v13, 2, v53
    v_add_u32 v49, v12, v11
    v_bitop3_b32 v53, v5, v13, v14 bitop3:0xea
    ds_add_u32 v53, v2
    v_cvt_pk_bf16_f32 v86, v7, v8
    v_perm_b32 v12, v86, v86, s41
    v_bitop3_b32 v48, v4, v12, v48 bitop3:0xca
    v_perm_b32 v13, v86, v86, s42
    v_bitop3_b32 v49, v4, v13, v49 bitop3:0xca
    v_mul_hi_u32_u24 v14, 429497, v50
    v_lshrrev_b32 v12, 3, v54
    v_cos_f32 v9, v9
    v_lshlrev_b16 v13, 3, v54
    v_mad_i32_i24 v11, v14, s55, v50
    v_bitop3_b32 v12, v6, v13, v12 bitop3:0xca
    v_lshl_add_u32 v11, v11, 17, s40
    v_lshlrev_b16 v14, 8, v14
    v_lshrrev_b32 v13, 2, v54
    v_add_u32 v50, v12, v11
    v_bitop3_b32 v54, v5, v13, v14 bitop3:0xea
    ds_add_u32 v54, v2
    v_mul_hi_u32_u24 v14, 429497, v51
    v_lshrrev_b32 v12, 3, v55
    v_cos_f32 v10, v10
    v_lshlrev_b16 v13, 3, v55
    v_mad_i32_i24 v11, v14, s55, v51
    v_bitop3_b32 v12, v6, v13, v12 bitop3:0xca
    v_lshl_add_u32 v11, v11, 17, s40
    v_lshlrev_b16 v14, 8, v14
    v_lshrrev_b32 v13, 2, v55
    v_add_u32 v51, v12, v11
    v_bitop3_b32 v55, v5, v13, v14 bitop3:0xea
    ds_add_u32 v55, v2
    v_cvt_pk_bf16_f32 v87, v9, v10
    v_perm_b32 v12, v87, v87, s41
    v_bitop3_b32 v50, v4, v12, v50 bitop3:0xca
    v_perm_b32 v13, v87, v87, s42
    v_bitop3_b32 v51, v4, v13, v51 bitop3:0xca
    s_setprio 2
    s_waitcnt vmcnt(18)
    v_lshlrev_b32 v7, 16, v56
    v_and_b32 v8, 0xffff0000, v56
    v_lshlrev_b32 v9, 16, v57
    v_and_b32 v10, 0xffff0000, v57
    v_mul_f32 v7, 0.15915494, v7
    v_mul_f32 v8, 0.15915494, v8
    v_mul_f32 v9, 0.15915494, v9
    v_mul_f32 v10, 0.15915494, v10
    v_mul_hi_u32_u24 v14, 429497, v68
    v_lshrrev_b32 v12, 3, v72
    v_cos_f32 v7, v7
    v_lshlrev_b16 v13, 3, v72
    v_mad_i32_i24 v11, v14, s55, v68
    v_bitop3_b32 v12, v6, v13, v12 bitop3:0xca
    v_lshl_add_u32 v11, v11, 17, s40
    v_lshlrev_b16 v14, 8, v14
    v_lshrrev_b32 v13, 2, v72
    v_add_u32 v68, v12, v11
    v_bitop3_b32 v72, v5, v13, v14 bitop3:0xea
    ds_add_u32 v72, v2
    v_mul_hi_u32_u24 v14, 429497, v69
    v_lshrrev_b32 v12, 3, v73
    v_cos_f32 v8, v8
    v_lshlrev_b16 v13, 3, v73
    v_mad_i32_i24 v11, v14, s55, v69
    v_bitop3_b32 v12, v6, v13, v12 bitop3:0xca
    v_lshl_add_u32 v11, v11, 17, s40
    v_lshlrev_b16 v14, 8, v14
    v_lshrrev_b32 v13, 2, v73
    v_add_u32 v69, v12, v11
    v_bitop3_b32 v73, v5, v13, v14 bitop3:0xea
    ds_add_u32 v73, v2
    v_cvt_pk_bf16_f32 v56, v7, v8
    v_perm_b32 v12, v56, v56, s41
    v_bitop3_b32 v68, v4, v12, v68 bitop3:0xca
    v_perm_b32 v13, v56, v56, s42
    v_bitop3_b32 v69, v4, v13, v69 bitop3:0xca
    v_mul_hi_u32_u24 v14, 429497, v70
    v_lshrrev_b32 v12, 3, v74
    v_cos_f32 v9, v9
    v_lshlrev_b16 v13, 3, v74
    v_mad_i32_i24 v11, v14, s55, v70
    v_bitop3_b32 v12, v6, v13, v12 bitop3:0xca
    v_lshl_add_u32 v11, v11, 17, s40
    v_lshlrev_b16 v14, 8, v14
    v_lshrrev_b32 v13, 2, v74
    v_add_u32 v70, v12, v11
    v_bitop3_b32 v74, v5, v13, v14 bitop3:0xea
    ds_add_u32 v74, v2
    v_mul_hi_u32_u24 v14, 429497, v71
    v_lshrrev_b32 v12, 3, v75
    v_cos_f32 v10, v10
    v_lshlrev_b16 v13, 3, v75
    v_mad_i32_i24 v11, v14, s55, v71
    v_bitop3_b32 v12, v6, v13, v12 bitop3:0xca
    v_lshl_add_u32 v11, v11, 17, s40
    v_lshlrev_b16 v14, 8, v14
    v_lshrrev_b32 v13, 2, v75
    v_add_u32 v71, v12, v11
    v_bitop3_b32 v75, v5, v13, v14 bitop3:0xea
    ds_add_u32 v75, v2
    v_cvt_pk_bf16_f32 v57, v9, v10
    v_perm_b32 v12, v57, v57, s41
    v_bitop3_b32 v70, v4, v12, v70 bitop3:0xca
    v_perm_b32 v13, v57, v57, s42
    v_bitop3_b32 v71, v4, v13, v71 bitop3:0xca
    s_add_u32 s45, s35, 0x5484000
    s_add_u32 s45, s45, s85
    buffer_store_dwordx4 v[16:19], v0, s[20:23], s45 offen sc1
    s_add_u32 s46, s96, 0x8000000
    s_nop 0
    v_lshlrev_b32 v16, 1, v1
    buffer_load_dwordx4 v[16:19], v16, s[8:11], s46 offen nt
    s_waitcnt vmcnt(17)
    v_lshlrev_b32 v7, 16, v58
    v_and_b32 v8, 0xffff0000, v58
    v_lshlrev_b32 v9, 16, v59
    v_and_b32 v10, 0xffff0000, v59
    v_mul_f32 v7, 0.15915494, v7
    v_mul_f32 v8, 0.15915494, v8
    v_mul_f32 v9, 0.15915494, v9
    v_mul_f32 v10, 0.15915494, v10
    v_mul_hi_u32_u24 v14, 429497, v76
    v_lshrrev_b32 v12, 3, v80
    v_cos_f32 v7, v7
    v_lshlrev_b16 v13, 3, v80
    v_mad_i32_i24 v11, v14, s55, v76
    v_bitop3_b32 v12, v6, v13, v12 bitop3:0xca
    v_lshl_add_u32 v11, v11, 17, s40
    v_lshlrev_b16 v14, 8, v14
    v_lshrrev_b32 v13, 2, v80
    v_add_u32 v76, v12, v11
    v_bitop3_b32 v80, v5, v13, v14 bitop3:0xea
    ds_add_u32 v80, v2
    v_mul_hi_u32_u24 v14, 429497, v77
    v_lshrrev_b32 v12, 3, v81
    v_cos_f32 v8, v8
    v_lshlrev_b16 v13, 3, v81
    v_mad_i32_i24 v11, v14, s55, v77
    v_bitop3_b32 v12, v6, v13, v12 bitop3:0xca
    v_lshl_add_u32 v11, v11, 17, s40
    v_lshlrev_b16 v14, 8, v14
    v_lshrrev_b32 v13, 2, v81
    v_add_u32 v77, v12, v11
    v_bitop3_b32 v81, v5, v13, v14 bitop3:0xea
    ds_add_u32 v81, v2
    v_cvt_pk_bf16_f32 v58, v7, v8
    v_perm_b32 v12, v58, v58, s41
    v_bitop3_b32 v76, v4, v12, v76 bitop3:0xca
    v_perm_b32 v13, v58, v58, s42
    v_bitop3_b32 v77, v4, v13, v77 bitop3:0xca
    v_mul_hi_u32_u24 v14, 429497, v78
    v_lshrrev_b32 v12, 3, v82
    v_cos_f32 v9, v9
    v_lshlrev_b16 v13, 3, v82
    v_mad_i32_i24 v11, v14, s55, v78
    v_bitop3_b32 v12, v6, v13, v12 bitop3:0xca
    v_lshl_add_u32 v11, v11, 17, s40
    v_lshlrev_b16 v14, 8, v14
    v_lshrrev_b32 v13, 2, v82
    v_add_u32 v78, v12, v11
    v_bitop3_b32 v82, v5, v13, v14 bitop3:0xea
    ds_add_u32 v82, v2
    v_mul_hi_u32_u24 v14, 429497, v79
    v_lshrrev_b32 v12, 3, v83
    v_cos_f32 v10, v10
    v_lshlrev_b16 v13, 3, v83
    v_mad_i32_i24 v11, v14, s55, v79
    v_bitop3_b32 v12, v6, v13, v12 bitop3:0xca
    v_lshl_add_u32 v11, v11, 17, s40
    v_lshlrev_b16 v14, 8, v14
    v_lshrrev_b32 v13, 2, v83
    v_add_u32 v79, v12, v11
    v_bitop3_b32 v83, v5, v13, v14 bitop3:0xea
    ds_add_u32 v83, v2
    v_cvt_pk_bf16_f32 v59, v9, v10
    v_perm_b32 v12, v59, v59, s41
    v_bitop3_b32 v78, v4, v12, v78 bitop3:0xca
    v_perm_b32 v13, v59, v59, s42
    v_bitop3_b32 v79, v4, v13, v79 bitop3:0xca
    s_setprio 1
    s_waitcnt vmcnt(13)
    v_lshlrev_b32 v7, 16, v104
    v_and_b32 v8, 0xffff0000, v104
    v_lshlrev_b32 v9, 16, v105
    v_and_b32 v10, 0xffff0000, v105
    v_mul_f32 v7, 0.15915494, v7
    v_mul_f32 v8, 0.15915494, v8
    v_mul_f32 v9, 0.15915494, v9
    v_mul_f32 v10, 0.15915494, v10
    v_mul_hi_u32_u24 v14, 429497, v64
    v_lshrrev_b32 v12, 3, v96
    v_cos_f32 v7, v7
    v_lshlrev_b16 v13, 3, v96
    v_mad_i32_i24 v11, v14, s55, v64
    v_bitop3_b32 v12, v6, v13, v12 bitop3:0xca
    v_lshl_add_u32 v11, v11, 17, s40
    v_lshlrev_b16 v14, 8, v14
    v_lshrrev_b32 v13, 2, v96
    v_add_u32 v64, v12, v11
    v_bitop3_b32 v96, v5, v13, v14 bitop3:0xea
    ds_add_u32 v96, v2
    v_mul_hi_u32_u24 v14, 429497, v65
    v_lshrrev_b32 v12, 3, v97
    v_cos_f32 v8, v8
    v_lshlrev_b16 v13, 3, v97
    v_mad_i32_i24 v11, v14, s55, v65
    v_bitop3_b32 v12, v6, v13, v12 bitop3:0xca
    v_lshl_add_u32 v11, v11, 17, s40
    v_lshlrev_b16 v14, 8, v14
    v_lshrrev_b32 v13, 2, v97
    v_add_u32 v65, v12, v11
    v_bitop3_b32 v97, v5, v13, v14 bitop3:0xea
    ds_add_u32 v97, v2
    v_cvt_pk_bf16_f32 v104, v7, v8
    v_perm_b32 v12, v104, v104, s41
    v_bitop3_b32 v64, v4, v12, v64 bitop3:0xca
    v_perm_b32 v13, v104, v104, s42
    v_bitop3_b32 v65, v4, v13, v65 bitop3:0xca
    v_mul_hi_u32_u24 v14, 429497, v66
    v_lshrrev_b32 v12, 3, v98
    v_cos_f32 v9, v9
    v_lshlrev_b16 v13, 3, v98
    v_mad_i32_i24 v11, v14, s55, v66
    v_bitop3_b32 v12, v6, v13, v12 bitop3:0xca
    v_lshl_add_u32 v11, v11, 17, s40
    v_lshlrev_b16 v14, 8, v14
    v_lshrrev_b32 v13, 2, v98
    v_add_u32 v66, v12, v11
    v_bitop3_b32 v98, v5, v13, v14 bitop3:0xea
    ds_add_u32 v98, v2
    v_mul_hi_u32_u24 v14, 429497, v67
    v_lshrrev_b32 v12, 3, v99
    v_cos_f32 v10, v10
    v_lshlrev_b16 v13, 3, v99
    v_mad_i32_i24 v11, v14, s55, v67
    v_bitop3_b32 v12, v6, v13, v12 bitop3:0xca
    v_lshl_add_u32 v11, v11, 17, s40
    v_lshlrev_b16 v14, 8, v14
    v_lshrrev_b32 v13, 2, v99
    v_add_u32 v67, v12, v11
    v_bitop3_b32 v99, v5, v13, v14 bitop3:0xea
    ds_add_u32 v99, v2
    v_cvt_pk_bf16_f32 v105, v9, v10
    v_perm_b32 v12, v105, v105, s41
    v_bitop3_b32 v66, v4, v12, v66 bitop3:0xca
    v_perm_b32 v13, v105, v105, s42
    v_bitop3_b32 v67, v4, v13, v67 bitop3:0xca
    s_mov_b32 s68, s66
    s_mov_b32 s69, s67
    s_mov_b32 s70, 0x100
    s_mov_b32 s71, 0x20000
    v_mov_b32 v3, 1
    s_cmp_lg_u32 s32, 15
    s_cbranch_scc1 L1_tk
    s_mov_b64 exec, 1
    s_and_b32 s3, s2, 1
    s_lshl_b32 s3, s3, 7
    buffer_atomic_add v3, off, s[68:71], s3 sc0
    s_mov_b64 exec, -1
L1_tk:
    s_waitcnt vmcnt(10)
    v_lshlrev_b32 v7, 16, v106
    v_and_b32 v8, 0xffff0000, v106
    v_lshlrev_b32 v9, 16, v107
    v_and_b32 v10, 0xffff0000, v107
    v_mul_f32 v7, 0.15915494, v7
    v_mul_f32 v8, 0.15915494, v8
    v_mul_f32 v9, 0.15915494, v9
    v_mul_f32 v10, 0.15915494, v10
    v_mul_hi_u32_u24 v14, 429497, v60
    v_lshrrev_b32 v12, 3, v100
    v_cos_f32 v7, v7
    v_lshlrev_b16 v13, 3, v100
    v_mad_i32_i24 v11, v14, s55, v60
    v_bitop3_b32 v12, v6, v13, v12 bitop3:0xca
    v_lshl_add_u32 v11, v11, 17, s40
    v_lshlrev_b16 v14, 8, v14
    v_lshrrev_b32 v13, 2, v100
    v_add_u32 v60, v12, v11
    v_bitop3_b32 v100, v5, v13, v14 bitop3:0xea
    ds_add_u32 v100, v2
    v_mul_hi_u32_u24 v14, 429497, v61
    v_lshrrev_b32 v12, 3, v101
    v_cos_f32 v8, v8
    v_lshlrev_b16 v13, 3, v101
    v_mad_i32_i24 v11, v14, s55, v61
    v_bitop3_b32 v12, v6, v13, v12 bitop3:0xca
    v_lshl_add_u32 v11, v11, 17, s40
    v_lshlrev_b16 v14, 8, v14
    v_lshrrev_b32 v13, 2, v101
    v_add_u32 v61, v12, v11
    v_bitop3_b32 v101, v5, v13, v14 bitop3:0xea
    ds_add_u32 v101, v2
    v_cvt_pk_bf16_f32 v106, v7, v8
    v_perm_b32 v12, v106, v106, s41
    v_bitop3_b32 v60, v4, v12, v60 bitop3:0xca
    v_perm_b32 v13, v106, v106, s42
    v_bitop3_b32 v61, v4, v13, v61 bitop3:0xca
    v_mul_hi_u32_u24 v14, 429497, v62
    v_lshrrev_b32 v12, 3, v102
    v_cos_f32 v9, v9
    v_lshlrev_b16 v13, 3, v102
    v_mad_i32_i24 v11, v14, s55, v62
    v_bitop3_b32 v12, v6, v13, v12 bitop3:0xca
    v_lshl_add_u32 v11, v11, 17, s40
    v_lshlrev_b16 v14, 8, v14
    v_lshrrev_b32 v13, 2, v102
    v_add_u32 v62, v12, v11
    v_bitop3_b32 v102, v5, v13, v14 bitop3:0xea
    ds_add_u32 v102, v2
    v_mul_hi_u32_u24 v14, 429497, v63
    v_lshrrev_b32 v12, 3, v103
    v_cos_f32 v10, v10
    v_lshlrev_b16 v13, 3, v103
    v_mad_i32_i24 v11, v14, s55, v63
    v_bitop3_b32 v12, v6, v13, v12 bitop3:0xca
    v_lshl_add_u32 v11, v11, 17, s40
    v_lshlrev_b16 v14, 8, v14
    v_lshrrev_b32 v13, 2, v103
    v_add_u32 v63, v12, v11
    v_bitop3_b32 v103, v5, v13, v14 bitop3:0xea
    ds_add_u32 v103, v2
    v_cvt_pk_bf16_f32 v107, v9, v10
    v_perm_b32 v12, v107, v107, s41
    v_bitop3_b32 v62, v4, v12, v62 bitop3:0xca
    v_perm_b32 v13, v107, v107, s42
    v_bitop3_b32 v63, v4, v13, v63 bitop3:0xca
    s_setprio 0
    s_add_u32 s47, s35, 0x5484000
    s_add_u32 s47, s47, s91
    buffer_store_dwordx4 v[120:123], v0, s[20:23], s47 offen sc1
    s_add_u32 s44, s96, 0x8000000
    s_nop 0
    v_lshlrev_b32 v120, 1, v1
    buffer_load_dwordx4 v[120:123], v120, s[12:15], s44 offen nt
    s_waitcnt vmcnt(8)
    v_lshlrev_b32 v7, 16, v108
    v_and_b32 v8, 0xffff0000, v108
    v_lshlrev_b32 v9, 16, v109
    v_and_b32 v10, 0xffff0000, v109
    v_mul_f32 v7, 0.15915494, v7
    v_mul_f32 v8, 0.15915494, v8
    v_mul_f32 v9, 0.15915494, v9
    v_mul_f32 v10, 0.15915494, v10
    v_mul_hi_u32_u24 v14, 429497, v112
    v_lshrrev_b32 v12, 3, v88
    v_cos_f32 v7, v7
    v_lshlrev_b16 v13, 3, v88
    v_mad_i32_i24 v11, v14, s55, v112
    v_bitop3_b32 v12, v6, v13, v12 bitop3:0xca
    v_lshl_add_u32 v11, v11, 17, s40
    v_lshlrev_b16 v14, 8, v14
    v_lshrrev_b32 v13, 2, v88
    v_add_u32 v112, v12, v11
    v_bitop3_b32 v88, v5, v13, v14 bitop3:0xea
    ds_add_u32 v88, v2
    v_mul_hi_u32_u24 v14, 429497, v113
    v_lshrrev_b32 v12, 3, v89
    v_cos_f32 v8, v8
    v_lshlrev_b16 v13, 3, v89
    v_mad_i32_i24 v11, v14, s55, v113
    v_bitop3_b32 v12, v6, v13, v12 bitop3:0xca
    v_lshl_add_u32 v11, v11, 17, s40
    v_lshlrev_b16 v14, 8, v14
    v_lshrrev_b32 v13, 2, v89
    v_add_u32 v113, v12, v11
    v_bitop3_b32 v89, v5, v13, v14 bitop3:0xea
    ds_add_u32 v89, v2
    v_cvt_pk_bf16_f32 v108, v7, v8
    v_perm_b32 v12, v108, v108, s41
    v_bitop3_b32 v112, v4, v12, v112 bitop3:0xca
    v_perm_b32 v13, v108, v108, s42
    v_bitop3_b32 v113, v4, v13, v113 bitop3:0xca
    v_mul_hi_u32_u24 v14, 429497, v114
    v_lshrrev_b32 v12, 3, v90
    v_cos_f32 v9, v9
    v_lshlrev_b16 v13, 3, v90
    v_mad_i32_i24 v11, v14, s55, v114
    v_bitop3_b32 v12, v6, v13, v12 bitop3:0xca
    v_lshl_add_u32 v11, v11, 17, s40
    v_lshlrev_b16 v14, 8, v14
    v_lshrrev_b32 v13, 2, v90
    v_add_u32 v114, v12, v11
    v_bitop3_b32 v90, v5, v13, v14 bitop3:0xea
    ds_add_u32 v90, v2
    v_mul_hi_u32_u24 v14, 429497, v115
    v_lshrrev_b32 v12, 3, v91
    v_cos_f32 v10, v10
    v_lshlrev_b16 v13, 3, v91
    v_mad_i32_i24 v11, v14, s55, v115
    v_bitop3_b32 v12, v6, v13, v12 bitop3:0xca
    v_lshl_add_u32 v11, v11, 17, s40
    v_lshlrev_b16 v14, 8, v14
    v_lshrrev_b32 v13, 2, v91
    v_add_u32 v115, v12, v11
    v_bitop3_b32 v91, v5, v13, v14 bitop3:0xea
    ds_add_u32 v91, v2
    v_cvt_pk_bf16_f32 v109, v9, v10
    v_perm_b32 v12, v109, v109, s41
    v_bitop3_b32 v114, v4, v12, v114 bitop3:0xca
    v_perm_b32 v13, v109, v109, s42
    v_bitop3_b32 v115, v4, v13, v115 bitop3:0xca
    s_waitcnt vmcnt(4)
    v_lshlrev_b32 v7, 16, v110
    v_and_b32 v8, 0xffff0000, v110
    v_lshlrev_b32 v9, 16, v111
    v_and_b32 v10, 0xffff0000, v111
    v_mul_f32 v7, 0.15915494, v7
    v_mul_f32 v8, 0.15915494, v8
    v_mul_f32 v9, 0.15915494, v9
    v_mul_f32 v10, 0.15915494, v10
    v_mul_hi_u32_u24 v14, 429497, v116
    v_lshrrev_b32 v12, 3, v92
    v_cos_f32 v7, v7
    v_lshlrev_b16 v13, 3, v92
    v_mad_i32_i24 v11, v14, s55, v116
    v_bitop3_b32 v12, v6, v13, v12 bitop3:0xca
    v_lshl_add_u32 v11, v11, 17, s40
    v_lshlrev_b16 v14, 8, v14
    v_lshrrev_b32 v13, 2, v92
    v_add_u32 v116, v12, v11
    v_bitop3_b32 v92, v5, v13, v14 bitop3:0xea
    ds_add_u32 v92, v2
    v_mul_hi_u32_u24 v14, 429497, v117
    v_lshrrev_b32 v12, 3, v93
    v_cos_f32 v8, v8
    v_lshlrev_b16 v13, 3, v93
    v_mad_i32_i24 v11, v14, s55, v117
    v_bitop3_b32 v12, v6, v13, v12 bitop3:0xca
    v_lshl_add_u32 v11, v11, 17, s40
    v_lshlrev_b16 v14, 8, v14
    v_lshrrev_b32 v13, 2, v93
    v_add_u32 v117, v12, v11
    v_bitop3_b32 v93, v5, v13, v14 bitop3:0xea
    ds_add_u32 v93, v2
    v_cvt_pk_bf16_f32 v110, v7, v8
    v_perm_b32 v12, v110, v110, s41
    v_bitop3_b32 v116, v4, v12, v116 bitop3:0xca
    v_perm_b32 v13, v110, v110, s42
    v_bitop3_b32 v117, v4, v13, v117 bitop3:0xca
    v_mul_hi_u32_u24 v14, 429497, v118
    v_lshrrev_b32 v12, 3, v94
    v_cos_f32 v9, v9
    v_lshlrev_b16 v13, 3, v94
    v_mad_i32_i24 v11, v14, s55, v118
    v_bitop3_b32 v12, v6, v13, v12 bitop3:0xca
    v_lshl_add_u32 v11, v11, 17, s40
    v_lshlrev_b16 v14, 8, v14
    v_lshrrev_b32 v13, 2, v94
    v_add_u32 v118, v12, v11
    v_bitop3_b32 v94, v5, v13, v14 bitop3:0xea
    ds_add_u32 v94, v2
    v_mul_hi_u32_u24 v14, 429497, v119
    v_lshrrev_b32 v12, 3, v95
    v_cos_f32 v10, v10
    v_lshlrev_b16 v13, 3, v95
    v_mad_i32_i24 v11, v14, s55, v119
    v_bitop3_b32 v12, v6, v13, v12 bitop3:0xca
    v_lshl_add_u32 v11, v11, 17, s40
    v_lshlrev_b16 v14, 8, v14
    v_lshrrev_b32 v13, 2, v95
    v_add_u32 v119, v12, v11
    v_bitop3_b32 v95, v5, v13, v14 bitop3:0xea
    ds_add_u32 v95, v2
    v_cvt_pk_bf16_f32 v111, v9, v10
    v_perm_b32 v12, v111, v111, s41
    v_bitop3_b32 v118, v4, v12, v118 bitop3:0xca
    v_perm_b32 v13, v111, v111, s42
    v_bitop3_b32 v119, v4, v13, v119 bitop3:0xca
    v_lshrrev_b32 v8, 2, v0
    v_and_b32 v7, 0x3c00, v0
    v_bitop3_b32 v7, v5, v8, v7 bitop3:0xea
    s_waitcnt lgkmcnt(0)
    s_barrier
    ds_read2st64_b32 v[8:9], v7 offset0:0 offset1:1
    ds_read2st64_b32 v[10:11], v7 offset0:2 offset1:3
    s_add_u32 s45, s35, 0x5484000
    s_add_u32 s45, s45, s93
    buffer_store_dwordx4 v[44:47], v0, s[20:23], s45 offen sc1
    s_add_u32 s46, s96, 0x8000000
    s_lshr_b32 s46, s46, 1
    buffer_load_dwordx2 v[44:45], v1, s[16:19], s46 offen nt
    s_add_u32 s47, s97, 0x8400000
    s_lshr_b32 s47, s47, 1
    buffer_load_dwordx2 v[46:47], v1, s[16:19], s47 offen nt
    s_waitcnt lgkmcnt(0)
    v_lshl_or_b32 v12, v9, 16, v8
    v_lshl_or_b32 v13, v11, 16, v10
    v_mov_b32 v14, v12
    v_mov_b32 v15, v13
    s_nop 0
    v_add_u32_dpp v14, v14, v14 row_shr:1 row_mask:0xf bank_mask:0xf bound_ctrl:1
    v_add_u32_dpp v15, v15, v15 row_shr:1 row_mask:0xf bank_mask:0xf bound_ctrl:1
    s_nop 0
    v_add_u32_dpp v14, v14, v14 row_shr:2 row_mask:0xf bank_mask:0xf bound_ctrl:1
    v_add_u32_dpp v15, v15, v15 row_shr:2 row_mask:0xf bank_mask:0xf bound_ctrl:1
    s_nop 0
    v_add_u32_dpp v14, v14, v14 row_shr:4 row_mask:0xf bank_mask:0xf bound_ctrl:1
    v_add_u32_dpp v15, v15, v15 row_shr:4 row_mask:0xf bank_mask:0xf bound_ctrl:1
    s_nop 0
    v_add_u32_dpp v14, v14, v14 row_shr:8 row_mask:0xf bank_mask:0xf bound_ctrl:1
    v_add_u32_dpp v15, v15, v15 row_shr:8 row_mask:0xf bank_mask:0xf bound_ctrl:1
    s_nop 0
    v_add_u32_dpp v14, v14, v14 row_bcast:15 row_mask:0xa bank_mask:0xf
    v_add_u32_dpp v15, v15, v15 row_bcast:15 row_mask:0xa bank_mask:0xf
    s_nop 0
    v_add_u32_dpp v14, v14, v14 row_bcast:31 row_mask:0xc bank_mask:0xf
    v_add_u32_dpp v15, v15, v15 row_bcast:31 row_mask:0xc bank_mask:0xf
    v_readlane_b32 s48, v14, 63
    v_readlane_b32 s49, v15, 63
    s_lshl_b32 s54, s32, 2
    v_mov_b32 v8, s54
    s_and_b32 s50, s48, 0xffff
    s_lshr_b32 s51, s48, 16
    s_and_b32 s52, s49, 0xffff
    s_lshr_b32 s53, s49, 16
    s_add_u32 s51, s51, s50
    s_add_u32 s52, s52, s51
    s_add_u32 s53, s53, s52
    v_mov_b32 v9, s53
    s_mov_b64 exec, 1
    ds_write_b32 v8, v9 offset:16384
    s_cmp_lg_u32 s32, 15
    s_cbranch_scc1 L1_tk2
    s_waitcnt vmcnt(3)
L1_tk2:
    ds_write_b32 v8, v3 offset:16448
    s_mov_b64 exec, -1
    v_and_b32 v8, 60, v7
    s_waitcnt lgkmcnt(0)
    s_barrier
    ds_read_b32 v9, v8 offset:16384
    ds_read_b32 v10, v8 offset:16448
    s_waitcnt lgkmcnt(0)
    v_readlane_b32 s84, v10, 15
    s_and_b32 s3, s2, 1
    s_lshl_b32 s3, s3, 7
    s_add_u32 s84, s84, s3
    s_min_u32 s4, s84, 72
    s_min_u32 s5, s84, 216
    s_min_u32 s6, s84, 240
    s_add_u32 s4, s4, s5
    s_add_u32 s4, s4, s6
    s_add_u32 s4, s4, 9467
    s_mov_b32 s4, s84
    s_lshl_b32 s58, s4, 14
    s_lshl_b32 s5, s32, 10
    s_add_u32 s58, s58, s5
    s_lshr_b32 s59, s58, 1
    s_mov_b32 s43, 5
    s_cmp_lt_u32 s84, 72
    s_addc_u32 s43, s43, 0
    s_cmp_lt_u32 s84, 216
    s_addc_u32 s43, s43, 0
    s_cmp_lt_u32 s84, 240
    s_addc_u32 s43, s43, 0
    v_add_u32_dpp v9, v9, v9 row_shr:1 row_mask:0xf bank_mask:0xf bound_ctrl:1
    s_nop 1
    v_add_u32_dpp v9, v9, v9 row_shr:2 row_mask:0xf bank_mask:0xf bound_ctrl:1
    s_nop 1
    v_add_u32_dpp v9, v9, v9 row_shr:4 row_mask:0xf bank_mask:0xf bound_ctrl:1
    s_nop 1
    v_add_u32_dpp v9, v9, v9 row_shr:8 row_mask:0xf bank_mask:0xf bound_ctrl:1
    s_nop 0
    v_readlane_b32 s54, v9, s32
    s_sub_u32 s54, s54, s53
    s_add_u32 s50, s50, s54
    s_add_u32 s51, s51, s54
    s_add_u32 s52, s52, s54
    s_pack_ll_b32_b16 s48, s54, s50
    s_pack_ll_b32_b16 s49, s51, s52
    v_add_u32 v14, s48, v14
    v_add_u32 v15, s49, v15
    v_sub_u32 v12, v14, v12
    v_sub_u32 v13, v15, v13
    v_and_b32 v8, 0xffff, v12
    v_lshrrev_b32 v9, 16, v12
    v_and_b32 v10, 0xffff, v13
    v_lshrrev_b32 v11, 16, v13
    ds_write2st64_b32 v7, v8, v9 offset0:0 offset1:1
    ds_write2st64_b32 v7, v10, v11 offset0:2 offset1:3
    v_and_b32 v8, 0x3f0, v0
    v_lshl_add_u32 v8, v8, 1, s36
    ds_write_b64 v8, v[12:13] offset:20480
    s_bitset0_b64 exec, 63
    s_not_b64 exec, exec
    ds_write_b64 v8, v[14:15] offset:20512
    s_mov_b64 exec, -1
    s_waitcnt lgkmcnt(0)
    s_barrier
    s_setprio 3
    ds_add_rtn_u32 v24, v24, v2
    ds_add_rtn_u32 v25, v25, v2
    ds_add_rtn_u32 v26, v26, v2
    ds_add_rtn_u32 v27, v27, v2
    ds_read_b128 v[12:15], v0 offset:20480
    v_cmp_gt_u32 vcc, 8448, v0
    ds_add_rtn_u32 v52, v52, v2
    ds_add_rtn_u32 v53, v53, v2
    ds_add_rtn_u32 v54, v54, v2
    ds_add_rtn_u32 v55, v55, v2
    s_setprio 2
    ds_add_rtn_u32 v72, v72, v2
    ds_add_rtn_u32 v73, v73, v2
    ds_add_rtn_u32 v74, v74, v2
    ds_add_rtn_u32 v75, v75, v2
    s_waitcnt lgkmcnt(8)
    s_cbranch_vccz L1_p4
    s_add_u32 s44, s35, 0x7ec0000
    s_mov_b64 exec, vcc
    buffer_store_dwordx4 v[12:15], v0, s[24:27], s44 offen sc1
    s_mov_b64 exec, -1
L1_p4:
    s_add_u32 s45, s35, 0x5488000
    s_add_u32 s45, s45, s72
    buffer_store_dwordx4 v[20:23], v0, s[20:23], s45 offen sc1
    s_add_u32 s46, s97, 0x8400000
    s_nop 0
    v_lshlrev_b32 v20, 1, v1
    buffer_load_dwordx4 v[20:23], v20, s[8:11], s46 offen nt
    ds_add_rtn_u32 v80, v80, v2
    ds_add_rtn_u32 v81, v81, v2
    ds_add_rtn_u32 v82, v82, v2
    ds_add_rtn_u32 v83, v83, v2
    s_setprio 1
    ds_add_rtn_u32 v96, v96, v2
    ds_add_rtn_u32 v97, v97, v2
    ds_add_rtn_u32 v98, v98, v2
    ds_add_rtn_u32 v99, v99, v2
    ds_add_rtn_u32 v100, v100, v2
    ds_add_rtn_u32 v101, v101, v2
    ds_add_rtn_u32 v102, v102, v2
    ds_add_rtn_u32 v103, v103, v2
    s_add_u32 s47, s35, 0x5488000
    s_add_u32 s47, s47, s73
    buffer_store_dwordx4 v[124:127], v0, s[20:23], s47 offen sc1
    s_add_u32 s44, s97, 0x8400000
    s_nop 0
    v_lshlrev_b32 v124, 1, v1
    buffer_load_dwordx4 v[124:127], v124, s[12:15], s44 offen nt
    s_setprio 0
    ds_add_rtn_u32 v88, v88, v2
    ds_add_rtn_u32 v89, v89, v2
    ds_add_rtn_u32 v90, v90, v2
    ds_add_rtn_u32 v91, v91, v2
    ds_add_rtn_u32 v92, v92, v2
    ds_add_rtn_u32 v93, v93, v2
    ds_add_rtn_u32 v94, v94, v2
    ds_add_rtn_u32 v95, v95, v2
    s_waitcnt lgkmcnt(0)
    s_barrier
    s_setprio 3
    v_and_b32 v7, -4, v24
    v_lshl_add_u32 v8, v24, 2, v7
    ds_write_b32 v8, v40
    v_lshl_add_u32 v7, v7, 2, v24
    ds_write_b8 v7, v84 offset:16
    v_and_b32 v9, -4, v25
    v_lshl_add_u32 v10, v25, 2, v9
    ds_write_b32 v10, v41
    v_lshl_add_u32 v9, v9, 2, v25
    ds_write_b8_d16_hi v9, v84 offset:16
    v_and_b32 v7, -4, v26
    v_lshl_add_u32 v8, v26, 2, v7
    ds_write_b32 v8, v42
    v_lshl_add_u32 v7, v7, 2, v26
    ds_write_b8 v7, v85 offset:16
    v_and_b32 v9, -4, v27
    v_lshl_add_u32 v10, v27, 2, v9
    ds_write_b32 v10, v43
    v_lshl_add_u32 v9, v9, 2, v27
    ds_write_b8_d16_hi v9, v85 offset:16
    s_add_u32 s45, s35, 0x5488000
    s_add_u32 s45, s45, s85
    buffer_store_dwordx4 v[32:35], v0, s[20:23], s45 offen sc1
    s_add_u32 s46, s98, 0x8800000
    v_lshlrev_b32 v40, 1, v1
    buffer_load_dwordx4 v[40:43], v40, s[8:11], s46 offen nt
    s_add_u32 s47, s98, 0x8800000
    v_lshlrev_b32 v24, 1, v1
    buffer_load_dwordx4 v[24:27], v24, s[12:15], s47 offen nt
    v_and_b32 v7, -4, v52
    v_lshl_add_u32 v8, v52, 2, v7
    ds_write_b32 v8, v48
    v_lshl_add_u32 v7, v7, 2, v52
    ds_write_b8 v7, v86 offset:16
    v_and_b32 v9, -4, v53
    v_lshl_add_u32 v10, v53, 2, v9
    ds_write_b32 v10, v49
    v_lshl_add_u32 v9, v9, 2, v53
    ds_write_b8_d16_hi v9, v86 offset:16
    v_and_b32 v7, -4, v54
    v_lshl_add_u32 v8, v54, 2, v7
    ds_write_b32 v8, v50
    v_lshl_add_u32 v7, v7, 2, v54
    ds_write_b8 v7, v87 offset:16
    v_and_b32 v9, -4, v55
    v_lshl_add_u32 v10, v55, 2, v9
    ds_write_b32 v10, v51
    v_lshl_add_u32 v9, v9, 2, v55
    ds_write_b8_d16_hi v9, v87 offset:16
    s_add_u32 s44, s98, 0x8800000
    s_lshr_b32 s44, s44, 1
    buffer_load_dwordx2 v[32:33], v1, s[16:19], s44 offen nt
    s_add_u32 s45, s99, 0x8c00000
    s_lshr_b32 s45, s45, 1
    buffer_load_dwordx2 v[34:35], v1, s[16:19], s45 offen nt
    s_add_u32 s46, s99, 0x8c00000
    v_lshlrev_b32 v48, 1, v1
    buffer_load_dwordx4 v[48:51], v48, s[8:11], s46 offen nt
    s_setprio 2
    v_and_b32 v7, -4, v72
    v_lshl_add_u32 v8, v72, 2, v7
    ds_write_b32 v8, v68
    v_lshl_add_u32 v7, v7, 2, v72
    ds_write_b8 v7, v56 offset:16
    v_and_b32 v9, -4, v73
    v_lshl_add_u32 v10, v73, 2, v9
    ds_write_b32 v10, v69
    v_lshl_add_u32 v9, v9, 2, v73
    ds_write_b8_d16_hi v9, v56 offset:16
    v_and_b32 v7, -4, v74
    v_lshl_add_u32 v8, v74, 2, v7
    ds_write_b32 v8, v70
    v_lshl_add_u32 v7, v7, 2, v74
    ds_write_b8 v7, v57 offset:16
    v_and_b32 v9, -4, v75
    v_lshl_add_u32 v10, v75, 2, v9
    ds_write_b32 v10, v71
    v_lshl_add_u32 v9, v9, 2, v75
    ds_write_b8_d16_hi v9, v57 offset:16
    s_add_u32 s47, s35, 0x5488000
    s_add_u32 s47, s47, s91
    buffer_store_dwordx4 v[36:39], v0, s[20:23], s47 offen sc1
    s_add_u32 s44, s99, 0x8c00000
    v_lshlrev_b32 v52, 1, v1
    buffer_load_dwordx4 v[52:55], v52, s[12:15], s44 offen nt
    v_and_b32 v7, -4, v80
    v_lshl_add_u32 v8, v80, 2, v7
    ds_write_b32 v8, v76
    v_lshl_add_u32 v7, v7, 2, v80
    ds_write_b8 v7, v58 offset:16
    v_and_b32 v9, -4, v81
    v_lshl_add_u32 v10, v81, 2, v9
    ds_write_b32 v10, v77
    v_lshl_add_u32 v9, v9, 2, v81
    ds_write_b8_d16_hi v9, v58 offset:16
    v_and_b32 v7, -4, v82
    v_lshl_add_u32 v8, v82, 2, v7
    ds_write_b32 v8, v78
    v_lshl_add_u32 v7, v7, 2, v82
    ds_write_b8 v7, v59 offset:16
    v_and_b32 v9, -4, v83
    v_lshl_add_u32 v10, v83, 2, v9
    ds_write_b32 v10, v79
    v_lshl_add_u32 v9, v9, 2, v83
    ds_write_b8_d16_hi v9, v59 offset:16
    s_add_u32 s45, s96, 0x9000000
    v_lshlrev_b32 v84, 1, v1
    buffer_load_dwordx4 v[84:87], v84, s[8:11], s45 offen nt
    s_add_u32 s46, s96, 0x9000000
    v_lshlrev_b32 v68, 1, v1
    buffer_load_dwordx4 v[68:71], v68, s[12:15], s46 offen nt
    s_setprio 1
    v_and_b32 v7, -4, v96
    v_lshl_add_u32 v8, v96, 2, v7
    ds_write_b32 v8, v64
    v_lshl_add_u32 v7, v7, 2, v96
    ds_write_b8 v7, v104 offset:16
    v_and_b32 v9, -4, v97
    v_lshl_add_u32 v10, v97, 2, v9
    ds_write_b32 v10, v65
    v_lshl_add_u32 v9, v9, 2, v97
    ds_write_b8_d16_hi v9, v104 offset:16
    v_and_b32 v7, -4, v98
    v_lshl_add_u32 v8, v98, 2, v7
    ds_write_b32 v8, v66
    v_lshl_add_u32 v7, v7, 2, v98
    ds_write_b8 v7, v105 offset:16
    v_and_b32 v9, -4, v99
    v_lshl_add_u32 v10, v99, 2, v9
    ds_write_b32 v10, v67
    v_lshl_add_u32 v9, v9, 2, v99
    ds_write_b8_d16_hi v9, v105 offset:16
    s_add_u32 s47, s96, 0x9000000
    s_lshr_b32 s47, s47, 1
    buffer_load_dwordx2 v[72:73], v1, s[16:19], s47 offen nt
    s_cmp_le_u32 s43, 5
    s_cselect_b32 s18, 0, s18
    s_add_u32 s44, s59, 0x4a00000
    buffer_load_dwordx2 v[74:75], v1, s[16:19], s44 offen nt
    s_cmp_le_u32 s43, 5
    s_cselect_b32 s10, 0, s10
    s_add_u32 s45, s58, 0x9400000
    v_lshlrev_b32 v36, 1, v1
    buffer_load_dwordx4 v[36:39], v36, s[8:11], s45 offen nt
    v_and_b32 v7, -4, v100
    v_lshl_add_u32 v8, v100, 2, v7
    ds_write_b32 v8, v60
    v_lshl_add_u32 v7, v7, 2, v100
    ds_write_b8 v7, v106 offset:16
    v_and_b32 v9, -4, v101
    v_lshl_add_u32 v10, v101, 2, v9
    ds_write_b32 v10, v61
    v_lshl_add_u32 v9, v9, 2, v101
    ds_write_b8_d16_hi v9, v106 offset:16
    v_and_b32 v7, -4, v102
    v_lshl_add_u32 v8, v102, 2, v7
    ds_write_b32 v8, v62
    v_lshl_add_u32 v7, v7, 2, v102
    ds_write_b8 v7, v107 offset:16
    v_and_b32 v9, -4, v103
    v_lshl_add_u32 v10, v103, 2, v9
    ds_write_b32 v10, v63
    v_lshl_add_u32 v9, v9, 2, v103
    ds_write_b8_d16_hi v9, v107 offset:16
    s_add_u32 s46, s35, 0x5488000
    s_add_u32 s46, s46, s93
    buffer_store_dwordx4 v[28:31], v0, s[20:23], s46 offen sc1
    s_cmp_le_u32 s43, 5
    s_cselect_b32 s14, 0, s14
    s_add_u32 s47, s58, 0x9400000
    v_lshlrev_b32 v76, 1, v1
    buffer_load_dwordx4 v[76:79], v76, s[12:15], s47 offen nt
    s_setprio 0
    v_and_b32 v7, -4, v88
    v_lshl_add_u32 v8, v88, 2, v7
    ds_write_b32 v8, v112
    v_lshl_add_u32 v7, v7, 2, v88
    ds_write_b8 v7, v108 offset:16
    v_and_b32 v9, -4, v89
    v_lshl_add_u32 v10, v89, 2, v9
    ds_write_b32 v10, v113
    v_lshl_add_u32 v9, v9, 2, v89
    ds_write_b8_d16_hi v9, v108 offset:16
    v_and_b32 v7, -4, v90
    v_lshl_add_u32 v8, v90, 2, v7
    ds_write_b32 v8, v114
    v_lshl_add_u32 v7, v7, 2, v90
    ds_write_b8 v7, v109 offset:16
    v_and_b32 v9, -4, v91
    v_lshl_add_u32 v10, v91, 2, v9
    ds_write_b32 v10, v115
    v_lshl_add_u32 v9, v9, 2, v91
    ds_write_b8_d16_hi v9, v109 offset:16
    s_cmp_le_u32 s43, 6
    s_cselect_b32 s10, 0, s10
    s_add_u32 s44, s58, 0x97c0000
    v_lshlrev_b32 v80, 1, v1
    buffer_load_dwordx4 v[80:83], v80, s[8:11], s44 offen nt
    s_cmp_le_u32 s43, 6
    s_cselect_b32 s14, 0, s14
    s_add_u32 s45, s58, 0x97c0000
    v_lshlrev_b32 v56, 1, v1
    buffer_load_dwordx4 v[56:59], v56, s[12:15], s45 offen nt
    v_and_b32 v7, -4, v92
    v_lshl_add_u32 v8, v92, 2, v7
    ds_write_b32 v8, v116
    v_lshl_add_u32 v7, v7, 2, v92
    ds_write_b8 v7, v110 offset:16
    v_and_b32 v9, -4, v93
    v_lshl_add_u32 v10, v93, 2, v9
    ds_write_b32 v10, v117
    v_lshl_add_u32 v9, v9, 2, v93
    ds_write_b8_d16_hi v9, v110 offset:16
    v_and_b32 v7, -4, v94
    v_lshl_add_u32 v8, v94, 2, v7
    ds_write_b32 v8, v118
    v_lshl_add_u32 v7, v7, 2, v94
    ds_write_b8 v7, v111 offset:16
    v_and_b32 v9, -4, v95
    v_lshl_add_u32 v10, v95, 2, v9
    ds_write_b32 v10, v119
    v_lshl_add_u32 v9, v9, 2, v95
    ds_write_b8_d16_hi v9, v111 offset:16
    s_cmp_le_u32 s43, 6
    s_cselect_b32 s18, 0, s18
    s_add_u32 s46, s59, 0x4be0000
    buffer_load_dwordx2 v[64:65], v1, s[16:19], s46 offen nt
    s_cmp_le_u32 s43, 7
    s_cselect_b32 s18, 0, s18
    s_add_u32 s47, s59, 0x4d90000
    buffer_load_dwordx2 v[66:67], v1, s[16:19], s47 offen nt
    v_add_u32 v7, s72, v0
    v_add_u32 v12, s73, v0
    v_add_u32 v13, s85, v0
    v_add_u32 v14, s91, v0
    v_add_u32 v15, s93, v0
    s_min_i32 s3, s72, s73
    s_min_i32 s3, s3, s85
    s_min_i32 s3, s3, s91
    s_min_i32 s3, s3, s93
    v_add_u32 v3, s3, v0
    v_mov_b32 v8, 0
    v_mov_b32 v9, 0
    v_mov_b32 v10, 0
    v_mov_b32 v11, 0
    s_waitcnt lgkmcnt(0)
    s_barrier
    ds_read_b128 v[96:99], v7 offset:0
    ds_read_b128 v[60:63], v12 offset:0
    ds_read_b128 v[100:103], v13 offset:0
    ds_read_b128 v[104:107], v14 offset:0
    ds_read_b128 v[28:31], v15 offset:0
    ds_write_b128 v3, v[8:11]
    ds_read_b128 v[112:115], v7 offset:16384
    ds_read_b128 v[88:91], v12 offset:16384
    ds_read_b128 v[116:119], v13 offset:16384
    ds_read_b128 v[92:95], v14 offset:16384
    ds_read_b128 v[108:111], v15 offset:16384
    s_waitcnt lgkmcnt(0)
    s_barrier
    v_lshlrev_b32 v3, 3, v0
    v_and_b32 v3, 0x80, v3
    s_cmp_lg_u32 s32, 15
    s_cbranch_scc1 L2_k0
    s_mov_b64 exec, 3
    buffer_load_dword v3, v3, s[68:71], 0 offen sc1
    s_mov_b64 exec, -1
L2_k0:
    s_add_u32 s44, s35, 0x7ec4000
    s_add_u32 s44, s44, s72
    buffer_store_dwordx4 v[96:99], v0, s[20:23], s44 offen sc1
    s_cmp_le_u32 s43, 7
    s_cselect_b32 s10, 0, s10
    s_add_u32 s45, s58, 0x9b20000
    v_lshlrev_b32 v96, 1, v1
    buffer_load_dwordx4 v[96:99], v96, s[8:11], s45 offen nt
    s_add_u32 s46, s35, 0x7ec4000
    s_add_u32 s46, s46, s73
    buffer_store_dwordx4 v[60:63], v0, s[20:23], s46 offen sc1
    s_cmp_le_u32 s43, 7
    s_cselect_b32 s14, 0, s14
    s_add_u32 s47, s58, 0x9b20000
    v_lshlrev_b32 v60, 1, v1
    buffer_load_dwordx4 v[60:63], v60, s[12:15], s47 offen nt
    s_setprio 3
    s_waitcnt vmcnt(27)
    v_lshlrev_b32 v7, 16, v44
    v_and_b32 v8, 0xffff0000, v44
    v_lshlrev_b32 v9, 16, v45
    v_and_b32 v10, 0xffff0000, v45
    v_mul_f32 v7, 0.15915494, v7
    v_mul_f32 v8, 0.15915494, v8
    v_mul_f32 v9, 0.15915494, v9
    v_mul_f32 v10, 0.15915494, v10
    v_mul_hi_u32_u24 v14, 429497, v16
    v_lshrrev_b32 v12, 3, v120
    v_cos_f32 v7, v7
    v_lshlrev_b16 v13, 3, v120
    v_mad_i32_i24 v11, v14, s55, v16
    v_bitop3_b32 v12, v6, v13, v12 bitop3:0xca
    v_lshl_add_u32 v11, v11, 17, s40
    v_lshlrev_b16 v14, 8, v14
    v_lshrrev_b32 v13, 2, v120
    v_add_u32 v16, v12, v11
    v_bitop3_b32 v120, v5, v13, v14 bitop3:0xea
    ds_add_u32 v120, v2
    v_mul_hi_u32_u24 v14, 429497, v17
    v_lshrrev_b32 v12, 3, v121
    v_cos_f32 v8, v8
    v_lshlrev_b16 v13, 3, v121
    v_mad_i32_i24 v11, v14, s55, v17
    v_bitop3_b32 v12, v6, v13, v12 bitop3:0xca
    v_lshl_add_u32 v11, v11, 17, s40
    v_lshlrev_b16 v14, 8, v14
    v_lshrrev_b32 v13, 2, v121
    v_add_u32 v17, v12, v11
    v_bitop3_b32 v121, v5, v13, v14 bitop3:0xea
    ds_add_u32 v121, v2
    v_cvt_pk_bf16_f32 v44, v7, v8
    v_perm_b32 v12, v44, v44, s41
    v_bitop3_b32 v16, v4, v12, v16 bitop3:0xca
    v_perm_b32 v13, v44, v44, s42
    v_bitop3_b32 v17, v4, v13, v17 bitop3:0xca
    v_mul_hi_u32_u24 v14, 429497, v18
    v_lshrrev_b32 v12, 3, v122
    v_cos_f32 v9, v9
    v_lshlrev_b16 v13, 3, v122
    v_mad_i32_i24 v11, v14, s55, v18
    v_bitop3_b32 v12, v6, v13, v12 bitop3:0xca
    v_lshl_add_u32 v11, v11, 17, s40
    v_lshlrev_b16 v14, 8, v14
    v_lshrrev_b32 v13, 2, v122
    v_add_u32 v18, v12, v11
    v_bitop3_b32 v122, v5, v13, v14 bitop3:0xea
    ds_add_u32 v122, v2
    v_mul_hi_u32_u24 v14, 429497, v19
    v_lshrrev_b32 v12, 3, v123
    v_cos_f32 v10, v10
    v_lshlrev_b16 v13, 3, v123
    v_mad_i32_i24 v11, v14, s55, v19
    v_bitop3_b32 v12, v6, v13, v12 bitop3:0xca
    v_lshl_add_u32 v11, v11, 17, s40
    v_lshlrev_b16 v14, 8, v14
    v_lshrrev_b32 v13, 2, v123
    v_add_u32 v19, v12, v11
    v_bitop3_b32 v123, v5, v13, v14 bitop3:0xea
    ds_add_u32 v123, v2
    v_cvt_pk_bf16_f32 v45, v9, v10
    v_perm_b32 v12, v45, v45, s41
    v_bitop3_b32 v18, v4, v12, v18 bitop3:0xca
    v_perm_b32 v13, v45, v45, s42
    v_bitop3_b32 v19, v4, v13, v19 bitop3:0xca
    s_waitcnt vmcnt(23)
    v_lshlrev_b32 v7, 16, v46
    v_and_b32 v8, 0xffff0000, v46
    v_lshlrev_b32 v9, 16, v47
    v_and_b32 v10, 0xffff0000, v47
    v_mul_f32 v7, 0.15915494, v7
    v_mul_f32 v8, 0.15915494, v8
    v_mul_f32 v9, 0.15915494, v9
    v_mul_f32 v10, 0.15915494, v10
    v_mul_hi_u32_u24 v14, 429497, v20
    v_lshrrev_b32 v12, 3, v124
    v_cos_f32 v7, v7
    v_lshlrev_b16 v13, 3, v124
    v_mad_i32_i24 v11, v14, s55, v20
    v_bitop3_b32 v12, v6, v13, v12 bitop3:0xca
    v_lshl_add_u32 v11, v11, 17, s40
    v_lshlrev_b16 v14, 8, v14
    v_lshrrev_b32 v13, 2, v124
    v_add_u32 v20, v12, v11
    v_bitop3_b32 v124, v5, v13, v14 bitop3:0xea
    ds_add_u32 v124, v2
    v_mul_hi_u32_u24 v14, 429497, v21
    v_lshrrev_b32 v12, 3, v125
    v_cos_f32 v8, v8
    v_lshlrev_b16 v13, 3, v125
    v_mad_i32_i24 v11, v14, s55, v21
    v_bitop3_b32 v12, v6, v13, v12 bitop3:0xca
    v_lshl_add_u32 v11, v11, 17, s40
    v_lshlrev_b16 v14, 8, v14
    v_lshrrev_b32 v13, 2, v125
    v_add_u32 v21, v12, v11
    v_bitop3_b32 v125, v5, v13, v14 bitop3:0xea
    ds_add_u32 v125, v2
    v_cvt_pk_bf16_f32 v46, v7, v8
    v_perm_b32 v12, v46, v46, s41
    v_bitop3_b32 v20, v4, v12, v20 bitop3:0xca
    v_perm_b32 v13, v46, v46, s42
    v_bitop3_b32 v21, v4, v13, v21 bitop3:0xca
    v_mul_hi_u32_u24 v14, 429497, v22
    v_lshrrev_b32 v12, 3, v126
    v_cos_f32 v9, v9
    v_lshlrev_b16 v13, 3, v126
    v_mad_i32_i24 v11, v14, s55, v22
    v_bitop3_b32 v12, v6, v13, v12 bitop3:0xca
    v_lshl_add_u32 v11, v11, 17, s40
    v_lshlrev_b16 v14, 8, v14
    v_lshrrev_b32 v13, 2, v126
    v_add_u32 v22, v12, v11
    v_bitop3_b32 v126, v5, v13, v14 bitop3:0xea
    ds_add_u32 v126, v2
    v_mul_hi_u32_u24 v14, 429497, v23
    v_lshrrev_b32 v12, 3, v127
    v_cos_f32 v10, v10
    v_lshlrev_b16 v13, 3, v127
    v_mad_i32_i24 v11, v14, s55, v23
    v_bitop3_b32 v12, v6, v13, v12 bitop3:0xca
    v_lshl_add_u32 v11, v11, 17, s40
    v_lshlrev_b16 v14, 8, v14
    v_lshrrev_b32 v13, 2, v127
    v_add_u32 v23, v12, v11
    v_bitop3_b32 v127, v5, v13, v14 bitop3:0xea
    ds_add_u32 v127, v2
    v_cvt_pk_bf16_f32 v47, v9, v10
    v_perm_b32 v12, v47, v47, s41
    v_bitop3_b32 v22, v4, v12, v22 bitop3:0xca
    v_perm_b32 v13, v47, v47, s42
    v_bitop3_b32 v23, v4, v13, v23 bitop3:0xca
    s_setprio 2
    s_add_u32 s44, s35, 0x7ec4000
    s_add_u32 s44, s44, s85
    buffer_store_dwordx4 v[100:103], v0, s[20:23], s44 offen sc1
    s_waitcnt vmcnt(19)
    v_lshlrev_b32 v7, 16, v32
    v_and_b32 v8, 0xffff0000, v32
    v_lshlrev_b32 v9, 16, v33
    v_and_b32 v10, 0xffff0000, v33
    v_mul_f32 v7, 0.15915494, v7
    v_mul_f32 v8, 0.15915494, v8
    v_mul_f32 v9, 0.15915494, v9
    v_mul_f32 v10, 0.15915494, v10
    v_mul_hi_u32_u24 v14, 429497, v40
    v_lshrrev_b32 v12, 3, v24
    v_cos_f32 v7, v7
    v_lshlrev_b16 v13, 3, v24
    v_mad_i32_i24 v11, v14, s55, v40
    v_bitop3_b32 v12, v6, v13, v12 bitop3:0xca
    v_lshl_add_u32 v11, v11, 17, s40
    v_lshlrev_b16 v14, 8, v14
    v_lshrrev_b32 v13, 2, v24
    v_add_u32 v40, v12, v11
    v_bitop3_b32 v24, v5, v13, v14 bitop3:0xea
    ds_add_u32 v24, v2
    v_mul_hi_u32_u24 v14, 429497, v41
    v_lshrrev_b32 v12, 3, v25
    v_cos_f32 v8, v8
    v_lshlrev_b16 v13, 3, v25
    v_mad_i32_i24 v11, v14, s55, v41
    v_bitop3_b32 v12, v6, v13, v12 bitop3:0xca
    v_lshl_add_u32 v11, v11, 17, s40
    v_lshlrev_b16 v14, 8, v14
    v_lshrrev_b32 v13, 2, v25
    v_add_u32 v41, v12, v11
    v_bitop3_b32 v25, v5, v13, v14 bitop3:0xea
    ds_add_u32 v25, v2
    v_cvt_pk_bf16_f32 v32, v7, v8
    v_perm_b32 v12, v32, v32, s41
    v_bitop3_b32 v40, v4, v12, v40 bitop3:0xca
    v_perm_b32 v13, v32, v32, s42
    v_bitop3_b32 v41, v4, v13, v41 bitop3:0xca
    v_mul_hi_u32_u24 v14, 429497, v42
    v_lshrrev_b32 v12, 3, v26
    v_cos_f32 v9, v9
    v_lshlrev_b16 v13, 3, v26
    v_mad_i32_i24 v11, v14, s55, v42
    v_bitop3_b32 v12, v6, v13, v12 bitop3:0xca
    v_lshl_add_u32 v11, v11, 17, s40
    v_lshlrev_b16 v14, 8, v14
    v_lshrrev_b32 v13, 2, v26
    v_add_u32 v42, v12, v11
    v_bitop3_b32 v26, v5, v13, v14 bitop3:0xea
    ds_add_u32 v26, v2
    v_mul_hi_u32_u24 v14, 429497, v43
    v_lshrrev_b32 v12, 3, v27
    v_cos_f32 v10, v10
    v_lshlrev_b16 v13, 3, v27
    v_mad_i32_i24 v11, v14, s55, v43
    v_bitop3_b32 v12, v6, v13, v12 bitop3:0xca
    v_lshl_add_u32 v11, v11, 17, s40
    v_lshlrev_b16 v14, 8, v14
    v_lshrrev_b32 v13, 2, v27
    v_add_u32 v43, v12, v11
    v_bitop3_b32 v27, v5, v13, v14 bitop3:0xea
    ds_add_u32 v27, v2
    v_cvt_pk_bf16_f32 v33, v9, v10
    v_perm_b32 v12, v33, v33, s41
    v_bitop3_b32 v42, v4, v12, v42 bitop3:0xca
    v_perm_b32 v13, v33, v33, s42
    v_bitop3_b32 v43, v4, v13, v43 bitop3:0xca
    s_waitcnt vmcnt(16)
    v_lshlrev_b32 v7, 16, v34
    v_and_b32 v8, 0xffff0000, v34
    v_lshlrev_b32 v9, 16, v35
    v_and_b32 v10, 0xffff0000, v35
    v_mul_f32 v7, 0.15915494, v7
    v_mul_f32 v8, 0.15915494, v8
    v_mul_f32 v9, 0.15915494, v9
    v_mul_f32 v10, 0.15915494, v10
    v_mul_hi_u32_u24 v14, 429497, v48
    v_lshrrev_b32 v12, 3, v52
    v_cos_f32 v7, v7
    v_lshlrev_b16 v13, 3, v52
    v_mad_i32_i24 v11, v14, s55, v48
    v_bitop3_b32 v12, v6, v13, v12 bitop3:0xca
    v_lshl_add_u32 v11, v11, 17, s40
    v_lshlrev_b16 v14, 8, v14
    v_lshrrev_b32 v13, 2, v52
    v_add_u32 v48, v12, v11
    v_bitop3_b32 v52, v5, v13, v14 bitop3:0xea
    ds_add_u32 v52, v2
    v_mul_hi_u32_u24 v14, 429497, v49
    v_lshrrev_b32 v12, 3, v53
    v_cos_f32 v8, v8
    v_lshlrev_b16 v13, 3, v53
    v_mad_i32_i24 v11, v14, s55, v49
    v_bitop3_b32 v12, v6, v13, v12 bitop3:0xca
    v_lshl_add_u32 v11, v11, 17, s40
    v_lshlrev_b16 v14, 8, v14
    v_lshrrev_b32 v13, 2, v53
    v_add_u32 v49, v12, v11
    v_bitop3_b32 v53, v5, v13, v14 bitop3:0xea
    ds_add_u32 v53, v2
    v_cvt_pk_bf16_f32 v34, v7, v8
    v_perm_b32 v12, v34, v34, s41
    v_bitop3_b32 v48, v4, v12, v48 bitop3:0xca
    v_perm_b32 v13, v34, v34, s42
    v_bitop3_b32 v49, v4, v13, v49 bitop3:0xca
    v_mul_hi_u32_u24 v14, 429497, v50
    v_lshrrev_b32 v12, 3, v54
    v_cos_f32 v9, v9
    v_lshlrev_b16 v13, 3, v54
    v_mad_i32_i24 v11, v14, s55, v50
    v_bitop3_b32 v12, v6, v13, v12 bitop3:0xca
    v_lshl_add_u32 v11, v11, 17, s40
    v_lshlrev_b16 v14, 8, v14
    v_lshrrev_b32 v13, 2, v54
    v_add_u32 v50, v12, v11
    v_bitop3_b32 v54, v5, v13, v14 bitop3:0xea
    ds_add_u32 v54, v2
    v_mul_hi_u32_u24 v14, 429497, v51
    v_lshrrev_b32 v12, 3, v55
    v_cos_f32 v10, v10
    v_lshlrev_b16 v13, 3, v55
    v_mad_i32_i24 v11, v14, s55, v51
    v_bitop3_b32 v12, v6, v13, v12 bitop3:0xca
    v_lshl_add_u32 v11, v11, 17, s40
    v_lshlrev_b16 v14, 8, v14
    v_lshrrev_b32 v13, 2, v55
    v_add_u32 v51, v12, v11
    v_bitop3_b32 v55, v5, v13, v14 bitop3:0xea
    ds_add_u32 v55, v2
    v_cvt_pk_bf16_f32 v35, v9, v10
    v_perm_b32 v12, v35, v35, s41
    v_bitop3_b32 v50, v4, v12, v50 bitop3:0xca
    v_perm_b32 v13, v35, v35, s42
    v_bitop3_b32 v51, v4, v13, v51 bitop3:0xca
    s_setprio 1
    s_waitcnt vmcnt(12)
    v_lshlrev_b32 v7, 16, v72
    v_and_b32 v8, 0xffff0000, v72
    v_lshlrev_b32 v9, 16, v73
    v_and_b32 v10, 0xffff0000, v73
    v_mul_f32 v7, 0.15915494, v7
    v_mul_f32 v8, 0.15915494, v8
    v_mul_f32 v9, 0.15915494, v9
    v_mul_f32 v10, 0.15915494, v10
    v_mul_hi_u32_u24 v14, 429497, v84
    v_lshrrev_b32 v12, 3, v68
    v_cos_f32 v7, v7
    v_lshlrev_b16 v13, 3, v68
    v_mad_i32_i24 v11, v14, s55, v84
    v_bitop3_b32 v12, v6, v13, v12 bitop3:0xca
    v_lshl_add_u32 v11, v11, 17, s40
    v_lshlrev_b16 v14, 8, v14
    v_lshrrev_b32 v13, 2, v68
    v_add_u32 v84, v12, v11
    v_bitop3_b32 v68, v5, v13, v14 bitop3:0xea
    ds_add_u32 v68, v2
    v_mul_hi_u32_u24 v14, 429497, v85
    v_lshrrev_b32 v12, 3, v69
    v_cos_f32 v8, v8
    v_lshlrev_b16 v13, 3, v69
    v_mad_i32_i24 v11, v14, s55, v85
    v_bitop3_b32 v12, v6, v13, v12 bitop3:0xca
    v_lshl_add_u32 v11, v11, 17, s40
    v_lshlrev_b16 v14, 8, v14
    v_lshrrev_b32 v13, 2, v69
    v_add_u32 v85, v12, v11
    v_bitop3_b32 v69, v5, v13, v14 bitop3:0xea
    ds_add_u32 v69, v2
    v_cvt_pk_bf16_f32 v72, v7, v8
    v_perm_b32 v12, v72, v72, s41
    v_bitop3_b32 v84, v4, v12, v84 bitop3:0xca
    v_perm_b32 v13, v72, v72, s42
    v_bitop3_b32 v85, v4, v13, v85 bitop3:0xca
    v_mul_hi_u32_u24 v14, 429497, v86
    v_lshrrev_b32 v12, 3, v70
    v_cos_f32 v9, v9
    v_lshlrev_b16 v13, 3, v70
    v_mad_i32_i24 v11, v14, s55, v86
    v_bitop3_b32 v12, v6, v13, v12 bitop3:0xca
    v_lshl_add_u32 v11, v11, 17, s40
    v_lshlrev_b16 v14, 8, v14
    v_lshrrev_b32 v13, 2, v70
    v_add_u32 v86, v12, v11
    v_bitop3_b32 v70, v5, v13, v14 bitop3:0xea
    ds_add_u32 v70, v2
    v_mul_hi_u32_u24 v14, 429497, v87
    v_lshrrev_b32 v12, 3, v71
    v_cos_f32 v10, v10
    v_lshlrev_b16 v13, 3, v71
    v_mad_i32_i24 v11, v14, s55, v87
    v_bitop3_b32 v12, v6, v13, v12 bitop3:0xca
    v_lshl_add_u32 v11, v11, 17, s40
    v_lshlrev_b16 v14, 8, v14
    v_lshrrev_b32 v13, 2, v71
    v_add_u32 v87, v12, v11
    v_bitop3_b32 v71, v5, v13, v14 bitop3:0xea
    ds_add_u32 v71, v2
    v_cvt_pk_bf16_f32 v73, v9, v10
    v_perm_b32 v12, v73, v73, s41
    v_bitop3_b32 v86, v4, v12, v86 bitop3:0xca
    v_perm_b32 v13, v73, v73, s42
    v_bitop3_b32 v87, v4, v13, v87 bitop3:0xca
    s_add_u32 s45, s35, 0x7ec4000
    s_add_u32 s45, s45, s91
    buffer_store_dwordx4 v[104:107], v0, s[20:23], s45 offen sc1
    s_waitcnt vmcnt(10)
    s_cmp_le_u32 s43, 5
    s_cbranch_scc1 L1_s5
    v_lshlrev_b32 v7, 16, v74
    v_and_b32 v8, 0xffff0000, v74
    v_lshlrev_b32 v9, 16, v75
    v_and_b32 v10, 0xffff0000, v75
    v_mul_f32 v7, 0.15915494, v7
    v_mul_f32 v8, 0.15915494, v8
    v_mul_f32 v9, 0.15915494, v9
    v_mul_f32 v10, 0.15915494, v10
    v_mul_hi_u32_u24 v14, 429497, v36
    v_lshrrev_b32 v12, 3, v76
    v_cos_f32 v7, v7
    v_lshlrev_b16 v13, 3, v76
    v_mad_i32_i24 v11, v14, s55, v36
    v_bitop3_b32 v12, v6, v13, v12 bitop3:0xca
    v_lshl_add_u32 v11, v11, 17, s40
    v_lshlrev_b16 v14, 8, v14
    v_lshrrev_b32 v13, 2, v76
    v_add_u32 v36, v12, v11
    v_bitop3_b32 v76, v5, v13, v14 bitop3:0xea
    ds_add_u32 v76, v2
    v_mul_hi_u32_u24 v14, 429497, v37
    v_lshrrev_b32 v12, 3, v77
    v_cos_f32 v8, v8
    v_lshlrev_b16 v13, 3, v77
    v_mad_i32_i24 v11, v14, s55, v37
    v_bitop3_b32 v12, v6, v13, v12 bitop3:0xca
    v_lshl_add_u32 v11, v11, 17, s40
    v_lshlrev_b16 v14, 8, v14
    v_lshrrev_b32 v13, 2, v77
    v_add_u32 v37, v12, v11
    v_bitop3_b32 v77, v5, v13, v14 bitop3:0xea
    ds_add_u32 v77, v2
    v_cvt_pk_bf16_f32 v74, v7, v8
    v_perm_b32 v12, v74, v74, s41
    v_bitop3_b32 v36, v4, v12, v36 bitop3:0xca
    v_perm_b32 v13, v74, v74, s42
    v_bitop3_b32 v37, v4, v13, v37 bitop3:0xca
    v_mul_hi_u32_u24 v14, 429497, v38
    v_lshrrev_b32 v12, 3, v78
    v_cos_f32 v9, v9
    v_lshlrev_b16 v13, 3, v78
    v_mad_i32_i24 v11, v14, s55, v38
    v_bitop3_b32 v12, v6, v13, v12 bitop3:0xca
    v_lshl_add_u32 v11, v11, 17, s40
    v_lshlrev_b16 v14, 8, v14
    v_lshrrev_b32 v13, 2, v78
    v_add_u32 v38, v12, v11
    v_bitop3_b32 v78, v5, v13, v14 bitop3:0xea
    ds_add_u32 v78, v2
    v_mul_hi_u32_u24 v14, 429497, v39
    v_lshrrev_b32 v12, 3, v79
    v_cos_f32 v10, v10
    v_lshlrev_b16 v13, 3, v79
    v_mad_i32_i24 v11, v14, s55, v39
    v_bitop3_b32 v12, v6, v13, v12 bitop3:0xca
    v_lshl_add_u32 v11, v11, 17, s40
    v_lshlrev_b16 v14, 8, v14
    v_lshrrev_b32 v13, 2, v79
    v_add_u32 v39, v12, v11
    v_bitop3_b32 v79, v5, v13, v14 bitop3:0xea
    ds_add_u32 v79, v2
    v_cvt_pk_bf16_f32 v75, v9, v10
    v_perm_b32 v12, v75, v75, s41
    v_bitop3_b32 v38, v4, v12, v38 bitop3:0xca
    v_perm_b32 v13, v75, v75, s42
    v_bitop3_b32 v39, v4, v13, v39 bitop3:0xca
L1_s5:
    s_setprio 0
    s_waitcnt vmcnt(6)
    s_cmp_le_u32 s43, 6
    s_cbranch_scc1 L1_s6
    v_lshlrev_b32 v7, 16, v64
    v_and_b32 v8, 0xffff0000, v64
    v_lshlrev_b32 v9, 16, v65
    v_and_b32 v10, 0xffff0000, v65
    v_mul_f32 v7, 0.15915494, v7
    v_mul_f32 v8, 0.15915494, v8
    v_mul_f32 v9, 0.15915494, v9
    v_mul_f32 v10, 0.15915494, v10
    v_mul_hi_u32_u24 v14, 429497, v80
    v_lshrrev_b32 v12, 3, v56
    v_cos_f32 v7, v7
    v_lshlrev_b16 v13, 3, v56
    v_mad_i32_i24 v11, v14, s55, v80
    v_bitop3_b32 v12, v6, v13, v12 bitop3:0xca
    v_lshl_add_u32 v11, v11, 17, s40
    v_lshlrev_b16 v14, 8, v14
    v_lshrrev_b32 v13, 2, v56
    v_add_u32 v80, v12, v11
    v_bitop3_b32 v56, v5, v13, v14 bitop3:0xea
    ds_add_u32 v56, v2
    v_mul_hi_u32_u24 v14, 429497, v81
    v_lshrrev_b32 v12, 3, v57
    v_cos_f32 v8, v8
    v_lshlrev_b16 v13, 3, v57
    v_mad_i32_i24 v11, v14, s55, v81
    v_bitop3_b32 v12, v6, v13, v12 bitop3:0xca
    v_lshl_add_u32 v11, v11, 17, s40
    v_lshlrev_b16 v14, 8, v14
    v_lshrrev_b32 v13, 2, v57
    v_add_u32 v81, v12, v11
    v_bitop3_b32 v57, v5, v13, v14 bitop3:0xea
    ds_add_u32 v57, v2
    v_cvt_pk_bf16_f32 v64, v7, v8
    v_perm_b32 v12, v64, v64, s41
    v_bitop3_b32 v80, v4, v12, v80 bitop3:0xca
    v_perm_b32 v13, v64, v64, s42
    v_bitop3_b32 v81, v4, v13, v81 bitop3:0xca
    v_mul_hi_u32_u24 v14, 429497, v82
    v_lshrrev_b32 v12, 3, v58
    v_cos_f32 v9, v9
    v_lshlrev_b16 v13, 3, v58
    v_mad_i32_i24 v11, v14, s55, v82
    v_bitop3_b32 v12, v6, v13, v12 bitop3:0xca
    v_lshl_add_u32 v11, v11, 17, s40
    v_lshlrev_b16 v14, 8, v14
    v_lshrrev_b32 v13, 2, v58
    v_add_u32 v82, v12, v11
    v_bitop3_b32 v58, v5, v13, v14 bitop3:0xea
    ds_add_u32 v58, v2
    v_mul_hi_u32_u24 v14, 429497, v83
    v_lshrrev_b32 v12, 3, v59
    v_cos_f32 v10, v10
    v_lshlrev_b16 v13, 3, v59
    v_mad_i32_i24 v11, v14, s55, v83
    v_bitop3_b32 v12, v6, v13, v12 bitop3:0xca
    v_lshl_add_u32 v11, v11, 17, s40
    v_lshlrev_b16 v14, 8, v14
    v_lshrrev_b32 v13, 2, v59
    v_add_u32 v83, v12, v11
    v_bitop3_b32 v59, v5, v13, v14 bitop3:0xea
    ds_add_u32 v59, v2
    v_cvt_pk_bf16_f32 v65, v9, v10
    v_perm_b32 v12, v65, v65, s41
    v_bitop3_b32 v82, v4, v12, v82 bitop3:0xca
    v_perm_b32 v13, v65, v65, s42
    v_bitop3_b32 v83, v4, v13, v83 bitop3:0xca
L1_s6:
    s_waitcnt vmcnt(2)
    s_cmp_le_u32 s43, 7
    s_cbranch_scc1 L1_s7
    v_lshlrev_b32 v7, 16, v66
    v_and_b32 v8, 0xffff0000, v66
    v_lshlrev_b32 v9, 16, v67
    v_and_b32 v10, 0xffff0000, v67
    v_mul_f32 v7, 0.15915494, v7
    v_mul_f32 v8, 0.15915494, v8
    v_mul_f32 v9, 0.15915494, v9
    v_mul_f32 v10, 0.15915494, v10
    v_mul_hi_u32_u24 v14, 429497, v96
    v_lshrrev_b32 v12, 3, v60
    v_cos_f32 v7, v7
    v_lshlrev_b16 v13, 3, v60
    v_mad_i32_i24 v11, v14, s55, v96
    v_bitop3_b32 v12, v6, v13, v12 bitop3:0xca
    v_lshl_add_u32 v11, v11, 17, s40
    v_lshlrev_b16 v14, 8, v14
    v_lshrrev_b32 v13, 2, v60
    v_add_u32 v96, v12, v11
    v_bitop3_b32 v60, v5, v13, v14 bitop3:0xea
    ds_add_u32 v60, v2
    v_mul_hi_u32_u24 v14, 429497, v97
    v_lshrrev_b32 v12, 3, v61
    v_cos_f32 v8, v8
    v_lshlrev_b16 v13, 3, v61
    v_mad_i32_i24 v11, v14, s55, v97
    v_bitop3_b32 v12, v6, v13, v12 bitop3:0xca
    v_lshl_add_u32 v11, v11, 17, s40
    v_lshlrev_b16 v14, 8, v14
    v_lshrrev_b32 v13, 2, v61
    v_add_u32 v97, v12, v11
    v_bitop3_b32 v61, v5, v13, v14 bitop3:0xea
    ds_add_u32 v61, v2
    v_cvt_pk_bf16_f32 v66, v7, v8
    v_perm_b32 v12, v66, v66, s41
    v_bitop3_b32 v96, v4, v12, v96 bitop3:0xca
    v_perm_b32 v13, v66, v66, s42
    v_bitop3_b32 v97, v4, v13, v97 bitop3:0xca
    v_mul_hi_u32_u24 v14, 429497, v98
    v_lshrrev_b32 v12, 3, v62
    v_cos_f32 v9, v9
    v_lshlrev_b16 v13, 3, v62
    v_mad_i32_i24 v11, v14, s55, v98
    v_bitop3_b32 v12, v6, v13, v12 bitop3:0xca
    v_lshl_add_u32 v11, v11, 17, s40
    v_lshlrev_b16 v14, 8, v14
    v_lshrrev_b32 v13, 2, v62
    v_add_u32 v98, v12, v11
    v_bitop3_b32 v62, v5, v13, v14 bitop3:0xea
    ds_add_u32 v62, v2
    v_mul_hi_u32_u24 v14, 429497, v99
    v_lshrrev_b32 v12, 3, v63
    v_cos_f32 v10, v10
    v_lshlrev_b16 v13, 3, v63
    v_mad_i32_i24 v11, v14, s55, v99
    v_bitop3_b32 v12, v6, v13, v12 bitop3:0xca
    v_lshl_add_u32 v11, v11, 17, s40
    v_lshlrev_b16 v14, 8, v14
    v_lshrrev_b32 v13, 2, v63
    v_add_u32 v99, v12, v11
    v_bitop3_b32 v63, v5, v13, v14 bitop3:0xea
    ds_add_u32 v63, v2
    v_cvt_pk_bf16_f32 v67, v9, v10
    v_perm_b32 v12, v67, v67, s41
    v_bitop3_b32 v98, v4, v12, v98 bitop3:0xca
    v_perm_b32 v13, v67, v67, s42
    v_bitop3_b32 v99, v4, v13, v99 bitop3:0xca
L1_s7:
    v_lshrrev_b32 v8, 2, v0
    v_and_b32 v7, 0x3c00, v0
    v_bitop3_b32 v7, v5, v8, v7 bitop3:0xea
    s_waitcnt lgkmcnt(0)
    s_barrier
    ds_read2st64_b32 v[8:9], v7 offset0:0 offset1:1
    ds_read2st64_b32 v[10:11], v7 offset0:2 offset1:3
    s_add_u32 s46, s35, 0x7ec4000
    s_add_u32 s46, s46, s93
    buffer_store_dwordx4 v[28:31], v0, s[20:23], s46 offen sc1
    s_waitcnt lgkmcnt(0)
    v_lshl_or_b32 v12, v9, 16, v8
    v_lshl_or_b32 v13, v11, 16, v10
    v_mov_b32 v14, v12
    v_mov_b32 v15, v13
    s_nop 0
    v_add_u32_dpp v14, v14, v14 row_shr:1 row_mask:0xf bank_mask:0xf bound_ctrl:1
    v_add_u32_dpp v15, v15, v15 row_shr:1 row_mask:0xf bank_mask:0xf bound_ctrl:1
    s_nop 0
    v_add_u32_dpp v14, v14, v14 row_shr:2 row_mask:0xf bank_mask:0xf bound_ctrl:1
    v_add_u32_dpp v15, v15, v15 row_shr:2 row_mask:0xf bank_mask:0xf bound_ctrl:1
    s_nop 0
    v_add_u32_dpp v14, v14, v14 row_shr:4 row_mask:0xf bank_mask:0xf bound_ctrl:1
    v_add_u32_dpp v15, v15, v15 row_shr:4 row_mask:0xf bank_mask:0xf bound_ctrl:1
    s_nop 0
    v_add_u32_dpp v14, v14, v14 row_shr:8 row_mask:0xf bank_mask:0xf bound_ctrl:1
    v_add_u32_dpp v15, v15, v15 row_shr:8 row_mask:0xf bank_mask:0xf bound_ctrl:1
    s_nop 0
    v_add_u32_dpp v14, v14, v14 row_bcast:15 row_mask:0xa bank_mask:0xf
    v_add_u32_dpp v15, v15, v15 row_bcast:15 row_mask:0xa bank_mask:0xf
    s_nop 0
    v_add_u32_dpp v14, v14, v14 row_bcast:31 row_mask:0xc bank_mask:0xf
    v_add_u32_dpp v15, v15, v15 row_bcast:31 row_mask:0xc bank_mask:0xf
    v_readlane_b32 s48, v14, 63
    v_readlane_b32 s49, v15, 63
    s_lshl_b32 s54, s32, 2
    v_mov_b32 v8, s54
    s_and_b32 s50, s48, 0xffff
    s_lshr_b32 s51, s48, 16
    s_and_b32 s52, s49, 0xffff
    s_lshr_b32 s53, s49, 16
    s_add_u32 s51, s51, s50
    s_add_u32 s52, s52, s51
    s_add_u32 s53, s53, s52
    v_mov_b32 v9, s53
    v_and_b32_dpp v3, v3, v3 quad_perm:[1,0,3,2] row_mask:0xf bank_mask:0xf
    s_mov_b64 exec, 1
    ds_write_b32 v8, v9 offset:16384
    ds_write_b32 v8, v3 offset:16448
    s_mov_b64 exec, -1
    v_and_b32 v8, 60, v7
    s_waitcnt lgkmcnt(0)
    s_barrier
    ds_read_b32 v9, v8 offset:16384
    ds_read_b32 v10, v8 offset:16448
    s_waitcnt lgkmcnt(0)
    v_readlane_b32 s56, v10, 15
    s_xor_b32 s56, s56, 0x80
    v_add_u32_dpp v9, v9, v9 row_shr:1 row_mask:0xf bank_mask:0xf bound_ctrl:1
    s_nop 1
    v_add_u32_dpp v9, v9, v9 row_shr:2 row_mask:0xf bank_mask:0xf bound_ctrl:1
    s_nop 1
    v_add_u32_dpp v9, v9, v9 row_shr:4 row_mask:0xf bank_mask:0xf bound_ctrl:1
    s_nop 1
    v_add_u32_dpp v9, v9, v9 row_shr:8 row_mask:0xf bank_mask:0xf bound_ctrl:1
    s_nop 0
    v_readlane_b32 s54, v9, s32
    s_sub_u32 s54, s54, s53
    s_add_u32 s50, s50, s54
    s_add_u32 s51, s51, s54
    s_add_u32 s52, s52, s54
    s_pack_ll_b32_b16 s48, s54, s50
    s_pack_ll_b32_b16 s49, s51, s52
    v_add_u32 v14, s48, v14
    v_add_u32 v15, s49, v15
    v_sub_u32 v12, v14, v12
    v_sub_u32 v13, v15, v13
    v_and_b32 v8, 0xffff, v12
    v_lshrrev_b32 v9, 16, v12
    v_and_b32 v10, 0xffff, v13
    v_lshrrev_b32 v11, 16, v13
    ds_write2st64_b32 v7, v8, v9 offset0:0 offset1:1
    ds_write2st64_b32 v7, v10, v11 offset0:2 offset1:3
    v_and_b32 v8, 0x3f0, v0
    v_lshl_add_u32 v8, v8, 1, s36
    ds_write_b64 v8, v[12:13] offset:20480
    s_bitset0_b64 exec, 63
    s_not_b64 exec, exec
    ds_write_b64 v8, v[14:15] offset:20512
    s_mov_b64 exec, -1
    s_waitcnt lgkmcnt(0)
    s_barrier
    s_setprio 3
    ds_add_rtn_u32 v120, v120, v2
    ds_add_rtn_u32 v121, v121, v2
    ds_add_rtn_u32 v122, v122, v2
    ds_add_rtn_u32 v123, v123, v2
    ds_read_b128 v[12:15], v0 offset:20480
    v_cmp_gt_u32 vcc, 8448, v0
    ds_add_rtn_u32 v124, v124, v2
    ds_add_rtn_u32 v125, v125, v2
    ds_add_rtn_u32 v126, v126, v2
    ds_add_rtn_u32 v127, v127, v2
    s_setprio 2
    ds_add_rtn_u32 v24, v24, v2
    ds_add_rtn_u32 v25, v25, v2
    ds_add_rtn_u32 v26, v26, v2
    ds_add_rtn_u32 v27, v27, v2
    s_waitcnt lgkmcnt(8)
    s_cbranch_vccz L1_p8
    s_add_u32 s47, s35, 0xa900000
    s_mov_b64 exec, vcc
    buffer_store_dwordx4 v[12:15], v0, s[24:27], s47 offen sc1
    s_mov_b64 exec, -1
L1_p8:
    s_add_u32 s44, s35, 0x7ec8000
    s_add_u32 s44, s44, s72
    buffer_store_dwordx4 v[112:115], v0, s[20:23], s44 offen sc1
    ds_add_rtn_u32 v52, v52, v2
    ds_add_rtn_u32 v53, v53, v2
    ds_add_rtn_u32 v54, v54, v2
    ds_add_rtn_u32 v55, v55, v2
    s_load_dwordx2 s[28:29], s[0:1], 0
    s_load_dwordx2 s[50:51], s[0:1], 40
    s_load_dwordx2 s[52:53], s[0:1], 24
    s_setprio 1
    ds_add_rtn_u32 v68, v68, v2
    ds_add_rtn_u32 v69, v69, v2
    ds_add_rtn_u32 v70, v70, v2
    ds_add_rtn_u32 v71, v71, v2
    s_cmp_le_u32 s43, 5
    s_cbranch_scc1 L1_s9
    ds_add_rtn_u32 v76, v76, v2
    ds_add_rtn_u32 v77, v77, v2
    ds_add_rtn_u32 v78, v78, v2
    ds_add_rtn_u32 v79, v79, v2
L1_s9:
    s_add_u32 s45, s35, 0x7ec8000
    s_add_u32 s45, s45, s73
    buffer_store_dwordx4 v[88:91], v0, s[20:23], s45 offen sc1
    s_setprio 0
    s_cmp_le_u32 s43, 6
    s_cbranch_scc1 L1_s10
    ds_add_rtn_u32 v56, v56, v2
    ds_add_rtn_u32 v57, v57, v2
    ds_add_rtn_u32 v58, v58, v2
    ds_add_rtn_u32 v59, v59, v2
L1_s10:
    s_cmp_le_u32 s43, 7
    s_cbranch_scc1 L1_s11
    ds_add_rtn_u32 v60, v60, v2
    ds_add_rtn_u32 v61, v61, v2
    ds_add_rtn_u32 v62, v62, v2
    ds_add_rtn_u32 v63, v63, v2
L1_s11:
    s_waitcnt lgkmcnt(0)
    s_barrier
    s_load_dwordx4 s[96:99], s[50:51], 0
    s_mov_b64 s[4:5], s[52:53]
    s_bfe_u32 s33, s2, 0x20001
    s_and_b32 s34, s2, 1
    s_lshl_b32 s34, s34, 5
    s_lshr_b32 s3, s2, 3
    s_add_u32 s34, s34, s3
    s_mul_i32 s39, s33, 2080
    s_lshl_b32 s3, s34, 5
    s_add_u32 s39, s39, s3
    s_mul_i32 s40, s33, 1310720
    s_add_u32 s40, s40, 0x50000
    s_lshl_b32 s38, s32, 11
    s_mul_i32 s100, s32, 3072
    s_add_u32 s8, s30, 0x4000
    s_addc_u32 s9, s31, 0
    s_mov_b32 s10, 0xd340000
    s_mov_b32 s11, 0x20000
    s_add_u32 s12, s30, 0x2c000
    s_addc_u32 s13, s31, 0
    s_mov_b32 s14, 0xd318000
    s_mov_b32 s15, 0x20000
    s_mov_b32 s16, s64
    s_mov_b32 s17, s65
    s_mov_b32 s18, 0x20
    s_mov_b32 s19, 0x20000
    s_mov_b32 s24, s28
    s_mov_b32 s25, s29
    s_mov_b32 s26, 0x4e2000
    s_mov_b32 s27, 0x20000
    s_setprio 3
    v_and_b32 v7, -4, v120
    v_lshl_add_u32 v8, v120, 2, v7
    ds_write_b32 v8, v16
    v_lshl_add_u32 v7, v7, 2, v120
    ds_write_b8 v7, v44 offset:16
    v_and_b32 v9, -4, v121
    v_lshl_add_u32 v10, v121, 2, v9
    ds_write_b32 v10, v17
    v_lshl_add_u32 v9, v9, 2, v121
    ds_write_b8_d16_hi v9, v44 offset:16
    v_and_b32 v7, -4, v122
    v_lshl_add_u32 v8, v122, 2, v7
    ds_write_b32 v8, v18
    v_lshl_add_u32 v7, v7, 2, v122
    ds_write_b8 v7, v45 offset:16
    v_and_b32 v9, -4, v123
    v_lshl_add_u32 v10, v123, 2, v9
    ds_write_b32 v10, v19
    v_lshl_add_u32 v9, v9, 2, v123
    ds_write_b8_d16_hi v9, v45 offset:16
    s_add_u32 s46, s35, 0x7ec8000
    s_add_u32 s46, s46, s85
    buffer_store_dwordx4 v[116:119], v0, s[20:23], s46 offen sc1
    v_and_b32 v13, 0x3f0, v0
    v_and_b32 v14, 0x300, v13
    v_bfe_u32 v15, v13, 4, 4
    s_lshl_b32 s3, s32, 4
    v_add3_u32 v14, v14, v15, s3
    v_mul_u32_u24 v2, 173056, v14
    v_lshrrev_b32 v14, 6, v13
    s_add_u32 s3, s3, 0x400
    v_add_u32 v14, s3, v14
    v_mul_u32_u24 v4, 173056, v14
    v_and_b32 v14, 3, v14
    v_and_b32 v15, 0x30, v13
    v_lshl_add_u32 v14, v14, 5, v15
    v_add_u32 v6, v14, v4
    v_lshl_add_u32 v5, v15, 1, v2
    v_lshrrev_b32 v14, 3, v15
    buffer_load_ushort v100, v14, s[16:19], 0 offen offset:0
    buffer_load_ushort v101, v14, s[16:19], 0 offen offset:8
    buffer_load_ushort v102, v14, s[16:19], 0 offen offset:16
    buffer_load_ushort v103, v14, s[16:19], 0 offen offset:24
    s_mul_i32 s3, s32, 5120
    v_add_u32 v3, s3, v13
    v_lshrrev_b32 v14, 2, v13
    v_add_u32 v14, s38, v14
    v_and_b32 v7, -4, v124
    v_lshl_add_u32 v8, v124, 2, v7
    ds_write_b32 v8, v20
    v_lshl_add_u32 v7, v7, 2, v124
    ds_write_b8 v7, v46 offset:16
    v_and_b32 v9, -4, v125
    v_lshl_add_u32 v10, v125, 2, v9
    ds_write_b32 v10, v21
    v_lshl_add_u32 v9, v9, 2, v125
    ds_write_b8_d16_hi v9, v46 offset:16
    v_and_b32 v7, -4, v126
    v_lshl_add_u32 v8, v126, 2, v7
    ds_write_b32 v8, v22
    v_lshl_add_u32 v7, v7, 2, v126
    ds_write_b8 v7, v47 offset:16
    v_and_b32 v9, -4, v127
    v_lshl_add_u32 v10, v127, 2, v9
    ds_write_b32 v10, v23
    v_lshl_add_u32 v9, v9, 2, v127
    ds_write_b8_d16_hi v9, v47 offset:16
    v_lshrrev_b32 v11, 2, v0
    v_and_b32 v11, 0xfc, v11
    s_cmp_ge_u32 s84, 128
    s_cselect_b32 s82, 0, s82
    s_and_b32 s3, s84, 1
    s_mul_i32 s3, s3, 40
    s_add_u32 s3, s3, s32
    s_mul_i32 s74, s3, 205
    s_lshr_b32 s74, s74, 10
    s_mul_i32 s75, s74, 5
    s_sub_u32 s75, s3, s75
    s_lshl_b32 s48, s74, 1
    s_add_u32 s48, s48, s75
    s_add_u32 s49, s48, s74
    s_add_u32 s49, s49, 30
    s_cmp_lt_u32 s75, 2
    s_cselect_b32 s48, s48, s49
    s_lshl_b32 s48, s48, 10
    s_lshr_b32 s49, s84, 1
    s_mul_i32 s49, s49, 80000
    s_add_u32 s48, s48, s49
    buffer_load_dword v104, v11, s[80:83], s48 offen offset:0
    buffer_load_dword v105, v11, s[80:83], s48 offen offset:256
    buffer_load_dword v106, v11, s[80:83], s48 offen offset:512
    buffer_load_dword v107, v11, s[80:83], s48 offen offset:768
    s_and_b32 s3, s84, 1
    s_mul_i32 s3, s3, 40
    s_add_u32 s3, s3, s32
    s_add_u32 s3, s3, 16
    s_mul_i32 s74, s3, 205
    s_lshr_b32 s74, s74, 10
    s_mul_i32 s75, s74, 5
    s_sub_u32 s75, s3, s75
    s_lshl_b32 s48, s74, 1
    s_add_u32 s48, s48, s75
    s_add_u32 s49, s48, s74
    s_add_u32 s49, s49, 30
    s_cmp_lt_u32 s75, 2
    s_cselect_b32 s48, s48, s49
    s_lshl_b32 s48, s48, 10
    s_lshr_b32 s49, s84, 1
    s_mul_i32 s49, s49, 80000
    s_add_u32 s48, s48, s49
    buffer_load_dword v28, v11, s[80:83], s48 offen offset:0
    buffer_load_dword v29, v11, s[80:83], s48 offen offset:256
    buffer_load_dword v30, v11, s[80:83], s48 offen offset:512
    buffer_load_dword v31, v11, s[80:83], s48 offen offset:768
    s_and_b32 s3, s84, 1
    s_mul_i32 s3, s3, 40
    s_add_u32 s3, s3, s32
    s_add_u32 s3, s3, 32
    s_cmp_ge_u32 s32, 8
    s_cselect_b32 s82, 0, s82
    s_mul_i32 s74, s3, 205
    s_lshr_b32 s74, s74, 10
    s_mul_i32 s75, s74, 5
    s_sub_u32 s75, s3, s75
    s_lshl_b32 s48, s74, 1
    s_add_u32 s48, s48, s75
    s_add_u32 s49, s48, s74
    s_add_u32 s49, s49, 30
    s_cmp_lt_u32 s75, 2
    s_cselect_b32 s48, s48, s49
    s_lshl_b32 s48, s48, 10
    s_lshr_b32 s49, s84, 1
    s_mul_i32 s49, s49, 80000
    s_add_u32 s48, s48, s49
    buffer_load_dword v112, v11, s[80:83], s48 offen offset:0
    buffer_load_dword v113, v11, s[80:83], s48 offen offset:256
    buffer_load_dword v114, v11, s[80:83], s48 offen offset:512
    buffer_load_dword v115, v11, s[80:83], s48 offen offset:768
    s_setprio 2
    v_and_b32 v7, -4, v24
    v_lshl_add_u32 v8, v24, 2, v7
    ds_write_b32 v8, v40
    v_lshl_add_u32 v7, v7, 2, v24
    ds_write_b8 v7, v32 offset:16
    v_and_b32 v9, -4, v25
    v_lshl_add_u32 v10, v25, 2, v9
    ds_write_b32 v10, v41
    v_lshl_add_u32 v9, v9, 2, v25
    ds_write_b8_d16_hi v9, v32 offset:16
    v_and_b32 v7, -4, v26
    v_lshl_add_u32 v8, v26, 2, v7
    ds_write_b32 v8, v42
    v_lshl_add_u32 v7, v7, 2, v26
    ds_write_b8 v7, v33 offset:16
    v_and_b32 v9, -4, v27
    v_lshl_add_u32 v10, v27, 2, v9
    ds_write_b32 v10, v43
    v_lshl_add_u32 v9, v9, 2, v27
    ds_write_b8_d16_hi v9, v33 offset:16
    s_add_u32 s47, s35, 0x7ec8000
    s_add_u32 s47, s47, s91
    buffer_store_dwordx4 v[92:95], v0, s[20:23], s47 offen sc1
    v_and_b32 v7, -4, v52
    v_lshl_add_u32 v8, v52, 2, v7
    ds_write_b32 v8, v48
    v_lshl_add_u32 v7, v7, 2, v52
    ds_write_b8 v7, v34 offset:16
    v_and_b32 v9, -4, v53
    v_lshl_add_u32 v10, v53, 2, v9
    ds_write_b32 v10, v49
    v_lshl_add_u32 v9, v9, 2, v53
    ds_write_b8_d16_hi v9, v34 offset:16
    v_and_b32 v7, -4, v54
    v_lshl_add_u32 v8, v54, 2, v7
    ds_write_b32 v8, v50
    v_lshl_add_u32 v7, v7, 2, v54
    ds_write_b8 v7, v35 offset:16
    v_and_b32 v9, -4, v55
    v_lshl_add_u32 v10, v55, 2, v9
    ds_write_b32 v10, v51
    v_lshl_add_u32 v9, v9, 2, v55
    ds_write_b8_d16_hi v9, v35 offset:16
    s_setprio 1
    v_and_b32 v7, -4, v68
    v_lshl_add_u32 v8, v68, 2, v7
    ds_write_b32 v8, v84
    v_lshl_add_u32 v7, v7, 2, v68
    ds_write_b8 v7, v72 offset:16
    v_and_b32 v9, -4, v69
    v_lshl_add_u32 v10, v69, 2, v9
    ds_write_b32 v10, v85
    v_lshl_add_u32 v9, v9, 2, v69
    ds_write_b8_d16_hi v9, v72 offset:16
    v_and_b32 v7, -4, v70
    v_lshl_add_u32 v8, v70, 2, v7
    ds_write_b32 v8, v86
    v_lshl_add_u32 v7, v7, 2, v70
    ds_write_b8 v7, v73 offset:16
    v_and_b32 v9, -4, v71
    v_lshl_add_u32 v10, v71, 2, v9
    ds_write_b32 v10, v87
    v_lshl_add_u32 v9, v9, 2, v71
    ds_write_b8_d16_hi v9, v73 offset:16
    s_cmp_le_u32 s43, 5
    s_cbranch_scc1 L1_s12
    v_and_b32 v7, -4, v76
    v_lshl_add_u32 v8, v76, 2, v7
    ds_write_b32 v8, v36
    v_lshl_add_u32 v7, v7, 2, v76
    ds_write_b8 v7, v74 offset:16
    v_and_b32 v9, -4, v77
    v_lshl_add_u32 v10, v77, 2, v9
    ds_write_b32 v10, v37
    v_lshl_add_u32 v9, v9, 2, v77
    ds_write_b8_d16_hi v9, v74 offset:16
    v_and_b32 v7, -4, v78
    v_lshl_add_u32 v8, v78, 2, v7
    ds_write_b32 v8, v38
    v_lshl_add_u32 v7, v7, 2, v78
    ds_write_b8 v7, v75 offset:16
    v_and_b32 v9, -4, v79
    v_lshl_add_u32 v10, v79, 2, v9
    ds_write_b32 v10, v39
    v_lshl_add_u32 v9, v9, 2, v79
    ds_write_b8_d16_hi v9, v75 offset:16
L1_s12:
    s_add_u32 s44, s35, 0x7ec8000
    s_add_u32 s44, s44, s93
    buffer_store_dwordx4 v[108:111], v0, s[20:23], s44 offen sc1
    s_setprio 0
    s_cmp_le_u32 s43, 6
    s_cbranch_scc1 L1_s13
    v_and_b32 v7, -4, v56
    v_lshl_add_u32 v8, v56, 2, v7
    ds_write_b32 v8, v80
    v_lshl_add_u32 v7, v7, 2, v56
    ds_write_b8 v7, v64 offset:16
    v_and_b32 v9, -4, v57
    v_lshl_add_u32 v10, v57, 2, v9
    ds_write_b32 v10, v81
    v_lshl_add_u32 v9, v9, 2, v57
    ds_write_b8_d16_hi v9, v64 offset:16
    v_and_b32 v7, -4, v58
    v_lshl_add_u32 v8, v58, 2, v7
    ds_write_b32 v8, v82
    v_lshl_add_u32 v7, v7, 2, v58
    ds_write_b8 v7, v65 offset:16
    v_and_b32 v9, -4, v59
    v_lshl_add_u32 v10, v59, 2, v9
    ds_write_b32 v10, v83
    v_lshl_add_u32 v9, v9, 2, v59
    ds_write_b8_d16_hi v9, v65 offset:16
L1_s13:
    s_add_u32 s80, s30, 0xd344000
    s_addc_u32 s81, s31, 0
    s_mov_b32 s82, 0xa000
    s_mov_b32 s83, 0x20000
    s_min_u32 s3, s84, 127
    s_mul_i32 s3, s3, 40960
    s_add_u32 s80, s80, s3
    s_addc_u32 s81, s81, 0
    s_cmp_ge_u32 s84, 128
    s_cselect_b32 s82, 0, s82
    s_waitcnt vmcnt(2)
    v_add_u32 v11, 0, v0
    buffer_store_dwordx4 v[104:107], v11, s[80:83], 0 offen sc1
    v_add_u32 v11, 16384, v0
    buffer_store_dwordx4 v[28:31], v11, s[80:83], 0 offen sc1
    v_add_u32 v11, 32768, v0
    buffer_store_dwordx4 v[112:115], v11, s[80:83], 0 offen sc1
    s_cmp_le_u32 s43, 7
    s_cbranch_scc1 L1_s14
    v_and_b32 v7, -4, v60
    v_lshl_add_u32 v8, v60, 2, v7
    ds_write_b32 v8, v96
    v_lshl_add_u32 v7, v7, 2, v60
    ds_write_b8 v7, v66 offset:16
    v_and_b32 v9, -4, v61
    v_lshl_add_u32 v10, v61, 2, v9
    ds_write_b32 v10, v97
    v_lshl_add_u32 v9, v9, 2, v61
    ds_write_b8_d16_hi v9, v66 offset:16
    v_and_b32 v7, -4, v62
    v_lshl_add_u32 v8, v62, 2, v7
    ds_write_b32 v8, v98
    v_lshl_add_u32 v7, v7, 2, v62
    ds_write_b8 v7, v67 offset:16
    v_and_b32 v9, -4, v63
    v_lshl_add_u32 v10, v63, 2, v9
    ds_write_b32 v10, v99
    v_lshl_add_u32 v9, v9, 2, v63
    ds_write_b8_d16_hi v9, v67 offset:16
L1_s14:
    v_add_u32 v7, 0x10000, v0
    v_add_u32 v12, 0x20000, v0
    s_waitcnt lgkmcnt(0)
    s_barrier
    ds_read_b128 v[24:27], v0 offset:0
    ds_read_b128 v[28:31], v0 offset:16384
    ds_read_b128 v[32:35], v0 offset:32768
    ds_read_b128 v[36:39], v0 offset:49152
    ds_read_b128 v[76:79], v7 offset:0
    ds_read_b128 v[80:83], v7 offset:16384
    ds_read_b128 v[84:87], v7 offset:32768
    ds_read_b128 v[104:107], v7 offset:49152
    ds_read_b128 v[68:71], v12 offset:0
    ds_read_b128 v[72:75], v12 offset:16384
    s_cmp_lg_u32 s32, 0
    s_cbranch_scc1 L2_sg1
    s_mov_b32 exec_hi, 0
    v_mov_b32 v11, 1
    buffer_store_dword v11, v14, s[60:63], s57 offen sc1
    s_mov_b64 exec, -1
L2_sg1:
    s_waitcnt lgkmcnt(9)
    s_add_u32 s45, s35, 0xa904000
    buffer_store_dwordx4 v[24:27], v0, s[20:23], s45 offen sc1
    s_waitcnt lgkmcnt(8)
    s_add_u32 s46, s35, 0xa908000
    buffer_store_dwordx4 v[28:31], v0, s[20:23], s46 offen sc1
    s_waitcnt lgkmcnt(7)
    s_add_u32 s47, s35, 0xa90c000
    buffer_store_dwordx4 v[32:35], v0, s[20:23], s47 offen sc1
    s_waitcnt lgkmcnt(6)
    s_add_u32 s44, s35, 0xa910000
    buffer_store_dwordx4 v[36:39], v0, s[20:23], s44 offen sc1
    s_waitcnt lgkmcnt(5)
    s_add_u32 s45, s35, 0xa914000
    buffer_store_dwordx4 v[76:79], v0, s[20:23], s45 offen sc1
    s_waitcnt lgkmcnt(4)
    s_add_u32 s46, s35, 0xa918000
    buffer_store_dwordx4 v[80:83], v0, s[20:23], s46 offen sc1
    s_waitcnt lgkmcnt(3)
    s_add_u32 s47, s35, 0xa91c000
    buffer_store_dwordx4 v[84:87], v0, s[20:23], s47 offen sc1
    s_waitcnt lgkmcnt(2)
    s_cmp_le_u32 s43, 5
    s_cbranch_scc1 L1_q15
    s_add_u32 s44, s35, 0xa920000
    buffer_store_dwordx4 v[104:107], v0, s[20:23], s44 offen sc1
L1_q15:
    s_waitcnt lgkmcnt(1)
    s_cmp_le_u32 s43, 6
    s_cbranch_scc1 L1_q16
    s_add_u32 s45, s35, 0xa924000
    buffer_store_dwordx4 v[68:71], v0, s[20:23], s45 offen sc1
L1_q16:
    s_waitcnt lgkmcnt(0)
    s_cmp_le_u32 s43, 7
    s_cbranch_scc1 L1_q17
    s_add_u32 s46, s35, 0xa928000
    buffer_store_dwordx4 v[72:75], v0, s[20:23], s46 offen sc1
L1_q17:
    s_waitcnt lgkmcnt(0)
    s_setprio 3
    v_mov_b32 v92, v0
    v_mov_b32 v93, v6
    v_mov_b32 v94, v13
    v_mov_b32 v95, v5
    v_mov_b32 v0, v14
    v_lshl_add_u32 v7, v13, 3, s38
    v_lshrrev_b32 v16, 2, v15
    v_mad_u32_u24 v4, v16, 5, v4
    v_or_b32 v4, 0xf0000000, v4
    v_or_b32 v2, 0xf0000000, v2
    v_sub_u32 v1, 28, v16
    v_lshrrev_b32 v17, 2, v16
    v_and_b32 v18, 3, v17
    v_lshlrev_b32 v18, 4, v18
    v_mov_b32 v10, 0x3f80
    v_mov_b32 v11, 0
    v_lshlrev_b64 v[10:11], v18, v[10:11]
    v_and_b32 v18, 3, v17
    v_lshlrev_b32 v18, 4, v18
    v_mov_b32 v12, 0xbf80
    v_mov_b32 v13, 0
    v_lshlrev_b64 v[12:13], v18, v[12:13]
    v_mov_b32 v45, 0xf0000000
    v_mov_b32 v5, 0x1fff8
    v_mov_b32 v6, 0x07ff0000
    v_mov_b32 v16, 0
    v_mov_b32 v17, 0
    v_mov_b32 v18, 0
    v_mov_b32 v19, 0
    v_add_u32 v20, 81920, v92
    v_add_u32 v21, 0x10000, v20
    s_setprio 1
    s_setprio 2
    s_mov_b32 s44, 0x4000c0c
    s_mov_b32 s45, 0x4010c0c
    s_mov_b32 s46, 0x4020c0c
    s_mov_b32 s47, 0x4030c0c
    s_mov_b32 s36, 0
    s_mov_b32 s43, 0
    s_mov_b32 s42, 0
    s_mov_b64 s[80:81], 0
    s_mov_b64 s[48:49], 0
    s_add_u32 s16, s30, 0xd344000
    s_addc_u32 s17, s31, 0
    s_mov_b32 s18, 0x500000
    s_mov_b32 s19, 0x20000
    v_mov_b32 v68, 0
    v_mov_b32 v69, 0
    v_mov_b32 v70, 0
    v_mov_b32 v71, 0
    v_mov_b32 v72, 0
    v_mov_b32 v73, 0
    v_mov_b32 v74, 0
    v_mov_b32 v75, 0
    s_waitcnt vmcnt(0)
    v_lshl_or_b32 v8, v101, 16, v100
    v_lshl_or_b32 v9, v103, 16, v102
    s_barrier
    s_cmp_lg_u32 s32, 0
    s_cbranch_scc1 L2_sg2
    s_mov_b32 exec_hi, 0
    v_mov_b32 v88, 2
    buffer_store_dword v88, v0, s[60:63], s57 offen sc1
    s_mov_b64 exec, -1
L2_sg2:
    s_mov_b64 s[84:85], 0
    s_mul_i32 s3, s33, 1280000
    s_add_u32 s3, s3, s100
    s_add_u32 s3, s3, 32768
    buffer_load_dwordx4 v[124:127], v94, s[24:27], s3 offen offset:2048
    s_mul_i32 s3, s33, 1280000
    s_add_u32 s3, s3, s100
    s_add_u32 s3, s3, 32768
    buffer_load_dwordx4 v[116:119], v94, s[24:27], s3 offen offset:0
    s_mul_i32 s3, s33, 1280000
    s_add_u32 s3, s3, s100
    s_add_u32 s3, s3, 32768
    buffer_load_dwordx4 v[120:123], v94, s[24:27], s3 offen offset:1024
    s_mul_i32 s3, s33, 1280000
    s_add_u32 s3, s3, s38
    s_add_u32 s3, s3, 0
    buffer_load_dwordx4 v[108:111], v94, s[24:27], s3 offen offset:0
    s_mul_i32 s3, s33, 1280000
    s_add_u32 s3, s3, s38
    s_add_u32 s3, s3, 0
    buffer_load_dwordx4 v[112:115], v94, s[24:27], s3 offen offset:1024
    ds_write_b128 v20, v[16:19] offset:0
    ds_write_b128 v20, v[16:19] offset:16384
    ds_write_b128 v20, v[16:19] offset:32768
    ds_write_b128 v20, v[16:19] offset:49152
    ds_write_b128 v21, v[16:19]
    s_cmp_eq_u32 s56, 0
    s_cbranch_scc1 L2_e3
    v_lshlrev_b32 v16, 3, v94
    v_and_b32 v16, 0x80, v16
L2_e4:
    buffer_load_dword v88, v16, s[68:71], 0 offen sc1
    s_waitcnt vmcnt(0)
    v_cmp_gt_u32 vcc, 0x80, v88
    s_cbranch_vccnz L2_e4
L2_e3:
    s_mov_b64 exec, 0xffff
L2_p1:
    buffer_load_dword v88, v7, s[60:63], 0 offen sc1
    s_waitcnt vmcnt(0)
    v_cmpx_gt_u32 vcc, 1, v88
    s_cbranch_vccnz L2_p1s
    s_mov_b64 exec, -1
    v_cmp_gt_u32 vcc, 2, v88
    s_and_b32 s56, vcc_lo, 0xffff
    buffer_load_dwordx4 v[48:51], v95, s[12:15], s39 offen offset:0
    buffer_load_dwordx4 v[56:59], v95, s[12:15], s39 offen offset:32
    buffer_load_dwordx4 v[52:55], v95, s[12:15], s39 offen offset:16
    buffer_load_dwordx4 v[60:63], v95, s[12:15], s39 offen offset:48
    buffer_load_dwordx4 v[64:67], v93, s[12:15], s39 offen
    s_waitcnt vmcnt(0)
    v_sub_u16 v88, v56, v48
    v_and_b32 v89, 3, v48
    v_add3_u32 v99, v88, v89, 3
    v_and_b32 v99, -4, v99
    v_max_u32 v99, 4, v99
    v_and_b32 v97, 0xfffc, v48
    v_bfm_b32 v96, v88, v89
    v_add_u32_dpp v91, v99, v99 row_shr:1 row_mask:0xf bank_mask:0xf bound_ctrl:1
    v_mad_u32_u24 v97, v97, 5, v2
    v_cmp_lt_u32 vcc, 16, v99
    v_add_u32_dpp v91, v91, v91 row_shr:2 row_mask:0xf bank_mask:0xf bound_ctrl:1
    v_sub_u32 v98, s38, v99
    v_lshrrev_b64 v[48:49], 16, v[48:49]
    v_add_u32_dpp v91, v91, v91 row_shr:4 row_mask:0xf bank_mask:0xf bound_ctrl:1
    v_lshrrev_b64 v[56:57], 16, v[56:57]
    s_mov_b32 s101, 0
    v_add_u32_dpp v91, v91, v91 row_shr:8 row_mask:0xf bank_mask:0xf bound_ctrl:1
    s_nop 1
    v_add_u32_dpp v91, v91, v91 row_bcast:15 row_mask:0xa bank_mask:0xf
    s_nop 1
    v_add_u32_dpp v91, v91, v91 row_bcast:31 row_mask:0xc bank_mask:0xf
    v_add_u32 v98, v98, v91
    v_readlane_b32 s37, v91, 63
    s_cbranch_vccnz L2_xo3
L2_xp3:
    v_mov_b32 v44, v43
    s_cmp_gt_u32 s37, 1024
    s_cbranch_scc1 L2_xs4
    s_cmp_lg_u32 s101, 0
    s_cbranch_scc1 L2_xa4
L2_xb4:
    v_lshlrev_b32 v89, 16, v96
    v_add_u32 v90, 60, v97
    v_bitop3_b32 v90, v89, v45, v90 bitop3:0x6a
    ds_write_b32 v98, v90 offset:12
    v_lshlrev_b32 v89, 20, v96
    v_add_u32 v90, 40, v97
    v_bitop3_b32 v90, v89, v45, v90 bitop3:0x6a
    ds_write_b32 v98, v90 offset:8
    v_lshlrev_b32 v89, 24, v96
    v_add_u32 v90, 20, v97
    v_bitop3_b32 v90, v89, v45, v90 bitop3:0x6a
    ds_write_b32 v98, v90 offset:4
    v_lshlrev_b32 v89, 28, v96
    v_bitop3_b32 v90, v89, v45, v97 bitop3:0x6a
    ds_write_b32 v98, v90 offset:0
    v_mov_b32_dpp v91, v64 quad_perm:[0,0,0,0] row_mask:0xf bank_mask:0xf
    v_and_b32 v89, 3, v91
    v_and_b32 v97, 0xfffc, v91
    v_sub_u16_dpp v88, v64, v91 quad_perm:[2,2,2,2] row_mask:0xf bank_mask:0xf
    v_mad_u32_u24 v97, v97, 5, v4
    v_add_u32 v99, v88, v89
    v_bfm_b32 v96, v88, v89
    v_cmp_lt_u32 s[58:59], 16, v99
    v_lshlrev_b32 v89, v1, v96
    v_and_b32 v89, v45, v89
    v_cmp_ne_u32 vcc, 0, v89
    v_xor_b32 v90, v97, v89
    s_add_u32 s3, s37, s38
    v_mbcnt_lo_u32_b32 v98, vcc_lo, 0
    v_mbcnt_hi_u32_b32 v98, vcc_hi, v98
    s_bcnt1_i32_b64 s41, vcc
    v_lshl_add_u32 v98, v98, 2, s3
    s_mov_b64 exec, vcc
    ds_write_b32 v98, v90
    s_mov_b64 exec, -1
    s_lshl2_add_u32 s37, s41, s37
    s_cmp_lg_u64 s[58:59], 0
    s_cbranch_scc1 L2_xe4
L2_xr4:
    v_add_u32 v98, s37, v0
    v_mov_b32 v90, -1
    ds_write_b32 v98, v90
    ds_read2st64_b32 v[40:41], v0 offset0:0 offset1:1
    ds_read2st64_b32 v[42:43], v0 offset0:2 offset1:3
    s_sub_u32 s3, s37, 768
    s_cmp_gt_u32 s3, 256
    s_cbranch_scc1 L2_xf4
L2_xg4:
    v_sub_u16 v88, v58, v50
    v_and_b32 v89, 3, v50
    v_add3_u32 v99, v88, v89, 3
    v_and_b32 v99, -4, v99
    v_max_u32 v99, 4, v99
    v_and_b32 v97, 0xfffc, v50
    v_bfm_b32 v96, v88, v89
    v_add_u32_dpp v91, v99, v99 row_shr:1 row_mask:0xf bank_mask:0xf bound_ctrl:1
    v_mad_u32_u24 v97, v97, 5, v2
    v_cmp_lt_u32 vcc, 16, v99
    v_add_u32_dpp v91, v91, v91 row_shr:2 row_mask:0xf bank_mask:0xf bound_ctrl:1
    v_sub_u32 v98, s38, v99
    v_lshrrev_b64 v[50:51], 16, v[50:51]
    v_add_u32_dpp v91, v91, v91 row_shr:4 row_mask:0xf bank_mask:0xf bound_ctrl:1
    v_lshrrev_b64 v[58:59], 16, v[58:59]
    s_mov_b32 s101, 0
    v_add_u32_dpp v91, v91, v91 row_shr:8 row_mask:0xf bank_mask:0xf bound_ctrl:1
    s_nop 1
    v_add_u32_dpp v91, v91, v91 row_bcast:15 row_mask:0xa bank_mask:0xf
    s_nop 1
    v_add_u32_dpp v91, v91, v91 row_bcast:31 row_mask:0xc bank_mask:0xf
    v_add_u32 v98, v98, v91
    v_readlane_b32 s37, v91, 63
    s_cbranch_vccnz L2_xo5
L2_xp5:
    s_waitcnt lgkmcnt(0)
    v_mov_b32 v21, v40
    v_mov_b32 v27, v41
    v_mov_b32 v33, v42
    v_mov_b32 v39, v43
    v_mov_b32 v44, v43
    s_cmp_gt_u32 s37, 1024
    s_cbranch_scc1 L2_xs6
    s_cmp_lg_u32 s101, 0
    s_cbranch_scc1 L2_xa6
L2_xb6:
    v_lshlrev_b32 v89, 16, v96
    v_add_u32 v90, 60, v97
    v_bitop3_b32 v90, v89, v45, v90 bitop3:0x6a
    ds_write_b32 v98, v90 offset:12
    v_lshlrev_b32 v89, 20, v96
    v_add_u32 v90, 40, v97
    v_bitop3_b32 v90, v89, v45, v90 bitop3:0x6a
    ds_write_b32 v98, v90 offset:8
    v_lshlrev_b32 v89, 24, v96
    v_add_u32 v90, 20, v97
    v_bitop3_b32 v90, v89, v45, v90 bitop3:0x6a
    ds_write_b32 v98, v90 offset:4
    v_lshlrev_b32 v89, 28, v96
    v_bitop3_b32 v90, v89, v45, v97 bitop3:0x6a
    ds_write_b32 v98, v90 offset:0
    v_mov_b32_dpp v91, v66 quad_perm:[0,0,0,0] row_mask:0xf bank_mask:0xf
    v_and_b32 v89, 3, v91
    v_and_b32 v97, 0xfffc, v91
    v_sub_u16_dpp v88, v66, v91 quad_perm:[2,2,2,2] row_mask:0xf bank_mask:0xf
    v_mad_u32_u24 v97, v97, 5, v4
    v_add_u32 v99, v88, v89
    v_bfm_b32 v96, v88, v89
    v_cmp_lt_u32 s[58:59], 16, v99
    v_lshlrev_b32 v89, v1, v96
    v_and_b32 v89, v45, v89
    v_cmp_ne_u32 vcc, 0, v89
    v_xor_b32 v90, v97, v89
    s_add_u32 s3, s37, s38
    v_mbcnt_lo_u32_b32 v98, vcc_lo, 0
    v_mbcnt_hi_u32_b32 v98, vcc_hi, v98
    s_bcnt1_i32_b64 s41, vcc
    v_lshl_add_u32 v98, v98, 2, s3
    s_mov_b64 exec, vcc
    ds_write_b32 v98, v90
    s_mov_b64 exec, -1
    s_lshl2_add_u32 s37, s41, s37
    s_cmp_lg_u64 s[58:59], 0
    s_cbranch_scc1 L2_xe6
L2_xr6:
    v_add_u32 v98, s37, v0
    v_mov_b32 v90, -1
    ds_write_b32 v98, v90
    ds_read2st64_b32 v[40:41], v0 offset0:0 offset1:1
    ds_read2st64_b32 v[42:43], v0 offset0:2 offset1:3
    s_sub_u32 s3, s37, 768
    s_cmp_gt_u32 s3, 256
    s_cbranch_scc1 L2_xf6
L2_xg6:
    v_subrev_u32 v88, s38, v3
    ds_write_b128 v88, v[124:127] offset:34816
    v_subrev_u32 v88, s38, v3
    ds_write_b128 v88, v[116:119] offset:32768
    v_subrev_u32 v88, s38, v3
    ds_write_b128 v88, v[120:123] offset:33792
    v_subrev_u32 v88, s100, v3
    ds_write_b128 v88, v[108:111] offset:0
    v_subrev_u32 v88, s100, v3
    ds_write_b128 v88, v[112:115] offset:1024
    s_cmp_eq_u32 s56, 0
    s_cbranch_scc1 L2_e2
    s_mov_b32 exec_lo, s56
    s_mov_b32 exec_hi, 0
    buffer_load_dword v88, v7, s[60:63], 0 offen sc1
    s_mov_b64 exec, -1
    s_waitcnt vmcnt(0)
    v_cmp_gt_u32 vcc, 2, v88
    s_and_b32 s56, vcc_lo, s56
    s_cbranch_scc0 L2_e2
    s_mul_i32 s3, s33, 1280000
    s_add_u32 s3, s3, s100
    s_add_u32 s3, s3, 352768
    buffer_load_dwordx4 v[124:127], v94, s[24:27], s3 offen offset:2048
    s_mul_i32 s3, s33, 1280000
    s_add_u32 s3, s3, s100
    s_add_u32 s3, s3, 352768
    buffer_load_dwordx4 v[116:119], v94, s[24:27], s3 offen offset:0
    s_mul_i32 s3, s33, 1280000
    s_add_u32 s3, s3, s100
    s_add_u32 s3, s3, 352768
    buffer_load_dwordx4 v[120:123], v94, s[24:27], s3 offen offset:1024
    s_mul_i32 s3, s33, 1280000
    s_add_u32 s3, s3, s38
    s_add_u32 s3, s3, 320000
    buffer_load_dwordx4 v[108:111], v94, s[24:27], s3 offen offset:0
    s_mul_i32 s3, s33, 1280000
    s_add_u32 s3, s3, s38
    s_add_u32 s3, s3, 320000
    buffer_load_dwordx4 v[112:115], v94, s[24:27], s3 offen offset:1024
    s_mov_b32 exec_lo, s56
    s_mov_b32 exec_hi, 0
L2_p2:
    buffer_load_dword v88, v7, s[60:63], 0 offen sc1
    s_waitcnt vmcnt(0)
    v_cmpx_gt_u32 vcc, 2, v88
    s_cbranch_vccnz L2_p2s
    s_mov_b64 exec, -1
L2_e2:
    s_mov_b32 s6, 0xaaaaaaaa
    s_mov_b32 s7, 0xaaaaaaaa
    v_and_b32 v47, 0x0fffffff, v21
    buffer_load_dwordx2 v[16:17], v47, s[8:11], 0 offen
    buffer_load_dwordx3 v[18:20], v47, s[8:11], 0 offen offset:8
    s_setprio 1
    v_and_b32 v47, 0x0fffffff, v27
    buffer_load_dwordx2 v[22:23], v47, s[8:11], 0 offen
    buffer_load_dwordx3 v[24:26], v47, s[8:11], 0 offen offset:8
    s_setprio 0
    v_and_b32 v47, 0x0fffffff, v33
    buffer_load_dwordx2 v[28:29], v47, s[8:11], 0 offen
    buffer_load_dwordx3 v[30:32], v47, s[8:11], 0 offen offset:8
    s_waitcnt lgkmcnt(0)
    s_barrier
    s_bitcmp1_b32 s36, s42
    s_cbranch_scc1 L2_slow
L2_ret0:
    s_setprio 3
    v_and_b32 v47, 0x0fffffff, v39
    buffer_load_dwordx2 v[34:35], v47, s[8:11], 0 offen
    buffer_load_dwordx3 v[36:38], v47, s[8:11], 0 offen offset:8
    s_waitcnt vmcnt(6)
    v_and_b32 v46, 0x20000000, v21
    v_lshrrev_b32 v47, 14, v17
    v_bitop3_b32 v47, v47, v5, v46 bitop3:0xea
    ds_read_b64 v[102:103], v47
    v_bitop3_b32 v93, v17, v5, v46 bitop3:0xea
    v_and_b32 v46, 0x10000000, v21
    v_lshrrev_b32 v47, 14, v16
    v_bitop3_b32 v47, v47, v5, v46 bitop3:0xea
    ds_read_b64 v[100:101], v47
    v_bitop3_b32 v92, v16, v5, v46 bitop3:0xea
    v_perm_b32 v15, v17, v20, s45
    v_bitop3_b32 v46, v17, 0.5, -0.5 bitop3:0xa8
    v_perm_b32 v14, v16, v20, s44
    v_bitop3_b32 v47, v16, 0.5, -0.5 bitop3:0xa8
    s_waitcnt lgkmcnt(0)
    v_mfma_f32_4x4x4_16b_bf16 v[80:83], v[8:9], v[102:103], 0
    v_mfma_f32_4x4x4_16b_bf16 v[76:79], v[8:9], v[100:101], 0
    v_bitop3_b32 v15, v6, v15, v46 bitop3:0xca
    v_bitop3_b32 v14, v6, v14, v47 bitop3:0xca
    v_cmp_lt_u32 s[84:85], v5, v92
    s_nop 0
    v_pk_mul_f32 v[80:81], v[80:81], v[14:15] op_sel:[0,1] op_sel_hi:[1,1]
    v_pk_mul_f32 v[82:83], v[82:83], v[14:15] op_sel:[0,1] op_sel_hi:[1,1]
    v_pk_mul_f32 v[76:77], v[76:77], v[14:15] op_sel:[0,0] op_sel_hi:[1,0]
    v_pk_mul_f32 v[78:79], v[78:79], v[14:15] op_sel:[0,0] op_sel_hi:[1,0]
    v_cmp_ne_u64 s[50:51], v[72:73], v[68:69]
    v_cmpx_ne_u64 s[54:55], v[74:75], v[70:71]
    s_and_b64 s[82:83], s[54:55], s[80:81]
    s_cbranch_scc1 L2_c7
L2_d7:
    v_mov_b64 v[84:85], v[70:71]
    v_mov_b32 v7, v95
    v_mov_b64 v[86:87], v[74:75]
    s_or_b64 s[80:81], s[80:81], s[54:55]
    s_mov_b64 exec, s[50:51]
    s_and_b64 s[82:83], s[50:51], s[80:81]
    s_cbranch_scc1 L2_c8
L2_d8:
    v_mov_b64 v[84:85], v[68:69]
    v_mov_b32 v7, v94
    v_mov_b64 v[86:87], v[72:73]
    s_mov_b64 exec, -1
    s_or_b64 s[80:81], s[80:81], s[50:51]
    ds_read_b64 v[70:71], v93 offset:65408
    s_and_b64 exec, s[84:85], s[80:81]
    v_mfma_f32_4x4x4_16b_bf16 v[76:79], v[12:13], v[84:85], 0
    v_mov_b32 v92, v7
    s_andn2_b64 s[80:81], s[80:81], s[84:85]
    v_mfma_f32_4x4x4_16b_bf16 v[76:79], v[10:11], v[86:87], v[76:79]
    s_mov_b64 exec, -1
    ds_read_b64 v[68:69], v92 offset:65408
    v_and_b32 v46, 0x80000000, v21
    v_lshrrev_b32 v47, 14, v19
    v_bitop3_b32 v47, v47, v5, v46 bitop3:0xea
    ds_read_b64 v[106:107], v47
    v_bitop3_b32 v95, v19, v5, v46 bitop3:0xea
    v_and_b32 v46, 0x40000000, v21
    v_lshrrev_b32 v47, 14, v18
    v_bitop3_b32 v47, v47, v5, v46 bitop3:0xea
    ds_read_b64 v[104:105], v47
    v_bitop3_b32 v94, v18, v5, v46 bitop3:0xea
    s_waitcnt lgkmcnt(2)
    v_mfma_f32_4x4x4_16b_bf16 v[80:83], v[10:11], v[70:71], v[80:83]
    v_mfma_f32_4x4x4_16b_bf16 v[76:79], v[10:11], v[68:69], v[76:79]
    v_perm_b32 v15, v19, v20, s47
    v_bitop3_b32 v46, v19, 0.5, -0.5 bitop3:0xa8
    v_perm_b32 v14, v18, v20, s46
    v_bitop3_b32 v47, v18, 0.5, -0.5 bitop3:0xa8
    v_cvt_pk_bf16_f32 v80, v80, v81
    v_cvt_pk_bf16_f32 v81, v82, v83
    ds_wrxchg_rtn_b64 v[74:75], v93, v[80:81] offset:65408
    v_cvt_pk_bf16_f32 v76, v76, v77
    v_cvt_pk_bf16_f32 v77, v78, v79
    ds_wrxchg_rtn_b64 v[72:73], v92, v[76:77] offset:65408
    s_setprio 2
    s_waitcnt lgkmcnt(2)
    v_mfma_f32_4x4x4_16b_bf16 v[80:83], v[8:9], v[106:107], 0
    v_mfma_f32_4x4x4_16b_bf16 v[76:79], v[8:9], v[104:105], 0
    v_bitop3_b32 v15, v6, v15, v46 bitop3:0xca
    v_bitop3_b32 v14, v6, v14, v47 bitop3:0xca
    s_nop 1
    v_pk_mul_f32 v[80:81], v[80:81], v[14:15] op_sel:[0,1] op_sel_hi:[1,1]
    v_pk_mul_f32 v[82:83], v[82:83], v[14:15] op_sel:[0,1] op_sel_hi:[1,1]
    v_pk_mul_f32 v[76:77], v[76:77], v[14:15] op_sel:[0,0] op_sel_hi:[1,0]
    v_pk_mul_f32 v[78:79], v[78:79], v[14:15] op_sel:[0,0] op_sel_hi:[1,0]
    v_sub_u16 v88, v60, v52
    v_and_b32 v89, 3, v52
    v_add3_u32 v99, v88, v89, 3
    v_and_b32 v99, -4, v99
    v_max_u32 v99, 4, v99
    v_and_b32 v97, 0xfffc, v52
    v_bfm_b32 v96, v88, v89
    v_add_u32_dpp v91, v99, v99 row_shr:1 row_mask:0xf bank_mask:0xf bound_ctrl:1
    v_mad_u32_u24 v97, v97, 5, v2
    v_cmp_lt_u32 vcc, 16, v99
    v_add_u32_dpp v91, v91, v91 row_shr:2 row_mask:0xf bank_mask:0xf bound_ctrl:1
    v_sub_u32 v98, s38, v99
    v_lshrrev_b64 v[52:53], 16, v[52:53]
    v_add_u32_dpp v91, v91, v91 row_shr:4 row_mask:0xf bank_mask:0xf bound_ctrl:1
    v_lshrrev_b64 v[60:61], 16, v[60:61]
    s_mov_b32 s101, 0
    v_add_u32_dpp v91, v91, v91 row_shr:8 row_mask:0xf bank_mask:0xf bound_ctrl:1
    s_nop 1
    v_add_u32_dpp v91, v91, v91 row_bcast:15 row_mask:0xa bank_mask:0xf
    s_nop 1
    v_add_u32_dpp v91, v91, v91 row_bcast:31 row_mask:0xc bank_mask:0xf
    v_add_u32 v98, v98, v91
    v_readlane_b32 s37, v91, 63
    s_cbranch_vccnz L2_xo9
L2_xp9:
    v_and_b32 v47, 0x3f0, v3
    s_cmp_lg_u32 s56, 0
    s_cbranch_scc1 L2_m10
    s_mul_i32 s3, s33, 1280000
    s_add_u32 s3, s3, s100
    s_add_u32 s3, s3, 352768
    buffer_load_dwordx4 v[124:127], v47, s[24:27], s3 offen offset:2048
L2_m10:
    v_and_b32 v47, 0x3f0, v3
    s_cmp_lg_u32 s56, 0
    s_cbranch_scc1 L2_m11
    s_mul_i32 s3, s33, 1280000
    s_add_u32 s3, s3, s100
    s_add_u32 s3, s3, 352768
    buffer_load_dwordx4 v[116:119], v47, s[24:27], s3 offen offset:0
L2_m11:
    v_and_b32 v47, 0x0fffffff, v40
    v_mov_b32 v21, v40
    buffer_load_dwordx2 v[16:17], v47, s[8:11], 0 offen
    buffer_load_dwordx3 v[18:20], v47, s[8:11], 0 offen offset:8
    s_waitcnt lgkmcnt(0)
    v_cmp_ne_u64 s[50:51], v[72:73], v[68:69]
    v_cmpx_ne_u64 s[54:55], v[74:75], v[70:71]
    s_and_b64 s[82:83], s[54:55], s[80:81]
    s_cbranch_scc1 L2_c12
L2_d12:
    v_mov_b64 v[84:85], v[70:71]
    v_mov_b32 v7, v93
    v_mov_b64 v[86:87], v[74:75]
    s_or_b64 s[80:81], s[80:81], s[54:55]
    s_mov_b64 exec, s[50:51]
    s_and_b64 s[82:83], s[50:51], s[80:81]
    s_cbranch_scc1 L2_c13
L2_d13:
    v_mov_b64 v[84:85], v[68:69]
    v_mov_b32 v7, v92
    v_mov_b64 v[86:87], v[72:73]
    s_mov_b64 exec, -1
    s_or_b64 s[80:81], s[80:81], s[50:51]
    ds_read_b64 v[70:71], v95 offset:65408
    ds_read_b64 v[68:69], v94 offset:65408
    s_waitcnt vmcnt(6)
    v_and_b32 v46, 0x20000000, v27
    v_lshrrev_b32 v47, 14, v23
    v_bitop3_b32 v47, v47, v5, v46 bitop3:0xea
    ds_read_b64 v[102:103], v47
    v_bitop3_b32 v93, v23, v5, v46 bitop3:0xea
    v_and_b32 v46, 0x10000000, v27
    v_lshrrev_b32 v47, 14, v22
    v_bitop3_b32 v47, v47, v5, v46 bitop3:0xea
    ds_read_b64 v[100:101], v47
    v_bitop3_b32 v92, v22, v5, v46 bitop3:0xea
    s_waitcnt lgkmcnt(2)
    v_mfma_f32_4x4x4_16b_bf16 v[80:83], v[10:11], v[70:71], v[80:83]
    v_mfma_f32_4x4x4_16b_bf16 v[76:79], v[10:11], v[68:69], v[76:79]
    v_perm_b32 v15, v23, v26, s45
    v_bitop3_b32 v46, v23, 0.5, -0.5 bitop3:0xa8
    v_perm_b32 v14, v22, v26, s44
    v_bitop3_b32 v47, v22, 0.5, -0.5 bitop3:0xa8
    v_cvt_pk_bf16_f32 v80, v80, v81
    v_cvt_pk_bf16_f32 v81, v82, v83
    ds_wrxchg_rtn_b64 v[74:75], v95, v[80:81] offset:65408
    v_cvt_pk_bf16_f32 v76, v76, v77
    v_cvt_pk_bf16_f32 v77, v78, v79
    ds_wrxchg_rtn_b64 v[72:73], v94, v[76:77] offset:65408
    s_waitcnt lgkmcnt(2)
    v_mfma_f32_4x4x4_16b_bf16 v[80:83], v[8:9], v[102:103], 0
    v_mfma_f32_4x4x4_16b_bf16 v[76:79], v[8:9], v[100:101], 0
    v_bitop3_b32 v15, v6, v15, v46 bitop3:0xca
    v_bitop3_b32 v14, v6, v14, v47 bitop3:0xca
    v_cmp_lt_u32 s[84:85], v5, v92
    s_nop 0
    v_pk_mul_f32 v[80:81], v[80:81], v[14:15] op_sel:[0,1] op_sel_hi:[1,1]
    v_pk_mul_f32 v[82:83], v[82:83], v[14:15] op_sel:[0,1] op_sel_hi:[1,1]
    v_pk_mul_f32 v[76:77], v[76:77], v[14:15] op_sel:[0,0] op_sel_hi:[1,0]
    v_pk_mul_f32 v[78:79], v[78:79], v[14:15] op_sel:[0,0] op_sel_hi:[1,0]
    v_and_b32 v47, 0x3f0, v3
    s_cmp_lg_u32 s56, 0
    s_cbranch_scc1 L2_m14
    s_mul_i32 s3, s33, 1280000
    s_add_u32 s3, s3, s100
    s_add_u32 s3, s3, 352768
    buffer_load_dwordx4 v[120:123], v47, s[24:27], s3 offen offset:1024
L2_m14:
    s_waitcnt lgkmcnt(0)
    v_cmp_ne_u64 s[50:51], v[72:73], v[68:69]
    v_cmpx_ne_u64 s[54:55], v[74:75], v[70:71]
    s_and_b64 s[82:83], s[54:55], s[80:81]
    s_cbranch_scc1 L2_c15
L2_d15:
    v_mov_b64 v[84:85], v[70:71]
    v_mov_b32 v7, v95
    v_mov_b64 v[86:87], v[74:75]
    s_or_b64 s[80:81], s[80:81], s[54:55]
    s_mov_b64 exec, s[50:51]
    s_and_b64 s[82:83], s[50:51], s[80:81]
    s_cbranch_scc1 L2_c16
L2_d16:
    v_mov_b64 v[84:85], v[68:69]
    v_mov_b32 v7, v94
    v_mov_b64 v[86:87], v[72:73]
    s_mov_b64 exec, -1
    s_or_b64 s[80:81], s[80:81], s[50:51]
    ds_read_b64 v[70:71], v93 offset:65408
    s_and_b64 exec, s[84:85], s[80:81]
    v_mfma_f32_4x4x4_16b_bf16 v[76:79], v[12:13], v[84:85], 0
    v_mov_b32 v92, v7
    s_andn2_b64 s[80:81], s[80:81], s[84:85]
    v_mfma_f32_4x4x4_16b_bf16 v[76:79], v[10:11], v[86:87], v[76:79]
    s_mov_b64 exec, -1
    ds_read_b64 v[68:69], v92 offset:65408
    v_and_b32 v46, 0x80000000, v27
    v_lshrrev_b32 v47, 14, v25
    v_bitop3_b32 v47, v47, v5, v46 bitop3:0xea
    ds_read_b64 v[106:107], v47
    v_bitop3_b32 v95, v25, v5, v46 bitop3:0xea
    v_and_b32 v46, 0x40000000, v27
    v_lshrrev_b32 v47, 14, v24
    v_bitop3_b32 v47, v47, v5, v46 bitop3:0xea
    ds_read_b64 v[104:105], v47
    v_bitop3_b32 v94, v24, v5, v46 bitop3:0xea
    s_waitcnt lgkmcnt(2)
    v_mfma_f32_4x4x4_16b_bf16 v[80:83], v[10:11], v[70:71], v[80:83]
    v_mfma_f32_4x4x4_16b_bf16 v[76:79], v[10:11], v[68:69], v[76:79]
    v_perm_b32 v15, v25, v26, s47
    v_bitop3_b32 v46, v25, 0.5, -0.5 bitop3:0xa8
    v_perm_b32 v14, v24, v26, s46
    v_bitop3_b32 v47, v24, 0.5, -0.5 bitop3:0xa8
    v_cvt_pk_bf16_f32 v80, v80, v81
    v_cvt_pk_bf16_f32 v81, v82, v83
    ds_wrxchg_rtn_b64 v[74:75], v93, v[80:81] offset:65408
    v_cvt_pk_bf16_f32 v76, v76, v77
    v_cvt_pk_bf16_f32 v77, v78, v79
    ds_wrxchg_rtn_b64 v[72:73], v92, v[76:77] offset:65408
    s_setprio 1
    s_waitcnt lgkmcnt(2)
    v_mfma_f32_4x4x4_16b_bf16 v[80:83], v[8:9], v[106:107], 0
    v_mfma_f32_4x4x4_16b_bf16 v[76:79], v[8:9], v[104:105], 0
    v_bitop3_b32 v15, v6, v15, v46 bitop3:0xca
    v_bitop3_b32 v14, v6, v14, v47 bitop3:0xca
    s_nop 1
    v_pk_mul_f32 v[80:81], v[80:81], v[14:15] op_sel:[0,1] op_sel_hi:[1,1]
    v_pk_mul_f32 v[82:83], v[82:83], v[14:15] op_sel:[0,1] op_sel_hi:[1,1]
    v_pk_mul_f32 v[76:77], v[76:77], v[14:15] op_sel:[0,0] op_sel_hi:[1,0]
    v_pk_mul_f32 v[78:79], v[78:79], v[14:15] op_sel:[0,0] op_sel_hi:[1,0]
    v_and_b32 v47, 0x3f0, v3
    s_cmp_lg_u32 s56, 0
    s_cbranch_scc1 L2_m17
    s_mul_i32 s3, s33, 1280000
    s_add_u32 s3, s3, s38
    s_add_u32 s3, s3, 320000
    buffer_load_dwordx4 v[108:111], v47, s[24:27], s3 offen offset:0
L2_m17:
    v_and_b32 v47, 0x3f0, v3
    s_cmp_lg_u32 s56, 0
    s_cbranch_scc1 L2_m18
    s_mul_i32 s3, s33, 1280000
    s_add_u32 s3, s3, s38
    s_add_u32 s3, s3, 320000
    buffer_load_dwordx4 v[112:115], v47, s[24:27], s3 offen offset:1024
L2_m18:
    v_and_b32 v47, 0x0fffffff, v41
    v_mov_b32 v27, v41
    buffer_load_dwordx2 v[22:23], v47, s[8:11], 0 offen
    buffer_load_dwordx3 v[24:26], v47, s[8:11], 0 offen offset:8
    s_waitcnt lgkmcnt(0)
    v_cmp_ne_u64 s[50:51], v[72:73], v[68:69]
    v_cmpx_ne_u64 s[54:55], v[74:75], v[70:71]
    s_and_b64 s[82:83], s[54:55], s[80:81]
    s_cbranch_scc1 L2_c19
L2_d19:
    v_mov_b64 v[84:85], v[70:71]
    v_mov_b32 v7, v93
    v_mov_b64 v[86:87], v[74:75]
    s_or_b64 s[80:81], s[80:81], s[54:55]
    s_mov_b64 exec, s[50:51]
    s_and_b64 s[82:83], s[50:51], s[80:81]
    s_cbranch_scc1 L2_c20
L2_d20:
    v_mov_b64 v[84:85], v[68:69]
    v_mov_b32 v7, v92
    v_mov_b64 v[86:87], v[72:73]
    s_mov_b64 exec, -1
    s_or_b64 s[80:81], s[80:81], s[50:51]
    ds_read_b64 v[70:71], v95 offset:65408
    ds_read_b64 v[68:69], v94 offset:65408
    s_waitcnt vmcnt(6)
    v_and_b32 v46, 0x20000000, v33
    v_lshrrev_b32 v47, 14, v29
    v_bitop3_b32 v47, v47, v5, v46 bitop3:0xea
    ds_read_b64 v[102:103], v47
    v_bitop3_b32 v93, v29, v5, v46 bitop3:0xea
    v_and_b32 v46, 0x10000000, v33
    v_lshrrev_b32 v47, 14, v28
    v_bitop3_b32 v47, v47, v5, v46 bitop3:0xea
    ds_read_b64 v[100:101], v47
    v_bitop3_b32 v92, v28, v5, v46 bitop3:0xea
    s_waitcnt lgkmcnt(2)
    v_mfma_f32_4x4x4_16b_bf16 v[80:83], v[10:11], v[70:71], v[80:83]
    v_mfma_f32_4x4x4_16b_bf16 v[76:79], v[10:11], v[68:69], v[76:79]
    v_perm_b32 v15, v29, v32, s45
    v_bitop3_b32 v46, v29, 0.5, -0.5 bitop3:0xa8
    v_perm_b32 v14, v28, v32, s44
    v_bitop3_b32 v47, v28, 0.5, -0.5 bitop3:0xa8
    v_cvt_pk_bf16_f32 v80, v80, v81
    v_cvt_pk_bf16_f32 v81, v82, v83
    ds_wrxchg_rtn_b64 v[74:75], v95, v[80:81] offset:65408
    v_cvt_pk_bf16_f32 v76, v76, v77
    v_cvt_pk_bf16_f32 v77, v78, v79
    ds_wrxchg_rtn_b64 v[72:73], v94, v[76:77] offset:65408
    s_waitcnt lgkmcnt(2)
    v_mfma_f32_4x4x4_16b_bf16 v[80:83], v[8:9], v[102:103], 0
    v_mfma_f32_4x4x4_16b_bf16 v[76:79], v[8:9], v[100:101], 0
    v_bitop3_b32 v15, v6, v15, v46 bitop3:0xca
    v_bitop3_b32 v14, v6, v14, v47 bitop3:0xca
    v_cmp_lt_u32 s[84:85], v5, v92
    s_nop 0
    v_pk_mul_f32 v[80:81], v[80:81], v[14:15] op_sel:[0,1] op_sel_hi:[1,1]
    v_pk_mul_f32 v[82:83], v[82:83], v[14:15] op_sel:[0,1] op_sel_hi:[1,1]
    v_pk_mul_f32 v[76:77], v[76:77], v[14:15] op_sel:[0,0] op_sel_hi:[1,0]
    v_pk_mul_f32 v[78:79], v[78:79], v[14:15] op_sel:[0,0] op_sel_hi:[1,0]
    s_waitcnt lgkmcnt(0)
    v_cmp_ne_u64 s[50:51], v[72:73], v[68:69]
    v_cmpx_ne_u64 s[54:55], v[74:75], v[70:71]
    s_and_b64 s[82:83], s[54:55], s[80:81]
    s_cbranch_scc1 L2_c21
L2_d21:
    v_mov_b64 v[84:85], v[70:71]
    v_mov_b32 v7, v95
    v_mov_b64 v[86:87], v[74:75]
    s_or_b64 s[80:81], s[80:81], s[54:55]
    s_mov_b64 exec, s[50:51]
    s_and_b64 s[82:83], s[50:51], s[80:81]
    s_cbranch_scc1 L2_c22
L2_d22:
    v_mov_b64 v[84:85], v[68:69]
    v_mov_b32 v7, v94
    v_mov_b64 v[86:87], v[72:73]
    s_mov_b64 exec, -1
    s_or_b64 s[80:81], s[80:81], s[50:51]
    ds_read_b64 v[70:71], v93 offset:65408
    s_and_b64 exec, s[84:85], s[80:81]
    v_mfma_f32_4x4x4_16b_bf16 v[76:79], v[12:13], v[84:85], 0
    v_mov_b32 v92, v7
    s_andn2_b64 s[80:81], s[80:81], s[84:85]
    v_mfma_f32_4x4x4_16b_bf16 v[76:79], v[10:11], v[86:87], v[76:79]
    s_mov_b64 exec, -1
    ds_read_b64 v[68:69], v92 offset:65408
    v_and_b32 v46, 0x80000000, v33
    v_lshrrev_b32 v47, 14, v31
    v_bitop3_b32 v47, v47, v5, v46 bitop3:0xea
    ds_read_b64 v[106:107], v47
    v_bitop3_b32 v95, v31, v5, v46 bitop3:0xea
    v_and_b32 v46, 0x40000000, v33
    v_lshrrev_b32 v47, 14, v30
    v_bitop3_b32 v47, v47, v5, v46 bitop3:0xea
    ds_read_b64 v[104:105], v47
    v_bitop3_b32 v94, v30, v5, v46 bitop3:0xea
    s_waitcnt lgkmcnt(2)
    v_mfma_f32_4x4x4_16b_bf16 v[80:83], v[10:11], v[70:71], v[80:83]
    v_mfma_f32_4x4x4_16b_bf16 v[76:79], v[10:11], v[68:69], v[76:79]
    v_perm_b32 v15, v31, v32, s47
    v_bitop3_b32 v46, v31, 0.5, -0.5 bitop3:0xa8
    v_perm_b32 v14, v30, v32, s46
    v_bitop3_b32 v47, v30, 0.5, -0.5 bitop3:0xa8
    v_cvt_pk_bf16_f32 v80, v80, v81
    v_cvt_pk_bf16_f32 v81, v82, v83
    ds_wrxchg_rtn_b64 v[74:75], v93, v[80:81] offset:65408
    v_cvt_pk_bf16_f32 v76, v76, v77
    v_cvt_pk_bf16_f32 v77, v78, v79
    ds_wrxchg_rtn_b64 v[72:73], v92, v[76:77] offset:65408
    s_setprio 0
    s_waitcnt lgkmcnt(2)
    v_mfma_f32_4x4x4_16b_bf16 v[80:83], v[8:9], v[106:107], 0
    v_mfma_f32_4x4x4_16b_bf16 v[76:79], v[8:9], v[104:105], 0
    v_bitop3_b32 v15, v6, v15, v46 bitop3:0xca
    v_bitop3_b32 v14, v6, v14, v47 bitop3:0xca
    s_nop 1
    v_pk_mul_f32 v[80:81], v[80:81], v[14:15] op_sel:[0,1] op_sel_hi:[1,1]
    v_pk_mul_f32 v[82:83], v[82:83], v[14:15] op_sel:[0,1] op_sel_hi:[1,1]
    v_pk_mul_f32 v[76:77], v[76:77], v[14:15] op_sel:[0,0] op_sel_hi:[1,0]
    v_pk_mul_f32 v[78:79], v[78:79], v[14:15] op_sel:[0,0] op_sel_hi:[1,0]
    s_add_u32 s40, s40, 0x50000
    v_and_b32 v47, 0x0fffffff, v42
    v_mov_b32 v33, v42
    buffer_load_dwordx2 v[28:29], v47, s[8:11], 0 offen
    buffer_load_dwordx3 v[30:32], v47, s[8:11], 0 offen offset:8
    s_waitcnt lgkmcnt(0)
    v_cmp_ne_u64 s[50:51], v[72:73], v[68:69]
    v_cmpx_ne_u64 s[54:55], v[74:75], v[70:71]
    s_and_b64 s[82:83], s[54:55], s[80:81]
    s_cbranch_scc1 L2_c23
L2_d23:
    v_mov_b64 v[84:85], v[70:71]
    v_mov_b32 v7, v93
    v_mov_b64 v[86:87], v[74:75]
    s_or_b64 s[80:81], s[80:81], s[54:55]
    s_mov_b64 exec, s[50:51]
    s_and_b64 s[82:83], s[50:51], s[80:81]
    s_cbranch_scc1 L2_c24
L2_d24:
    v_mov_b64 v[84:85], v[68:69]
    v_mov_b32 v7, v92
    v_mov_b64 v[86:87], v[72:73]
    s_mov_b64 exec, -1
    s_or_b64 s[80:81], s[80:81], s[50:51]
    ds_read_b64 v[70:71], v95 offset:65408
    ds_read_b64 v[68:69], v94 offset:65408
    s_waitcnt vmcnt(6)
    v_and_b32 v46, 0x20000000, v39
    v_lshrrev_b32 v47, 14, v35
    v_bitop3_b32 v47, v47, v5, v46 bitop3:0xea
    ds_read_b64 v[102:103], v47
    v_bitop3_b32 v93, v35, v5, v46 bitop3:0xea
    v_and_b32 v46, 0x10000000, v39
    v_lshrrev_b32 v47, 14, v34
    v_bitop3_b32 v47, v47, v5, v46 bitop3:0xea
    ds_read_b64 v[100:101], v47
    v_bitop3_b32 v92, v34, v5, v46 bitop3:0xea
    v_and_b32 v46, 0x80000000, v39
    v_lshrrev_b32 v47, 14, v37
    v_bitop3_b32 v47, v47, v5, v46 bitop3:0xea
    ds_read_b64 v[106:107], v47
    v_and_b32 v46, 0x40000000, v39
    v_lshrrev_b32 v47, 14, v36
    v_bitop3_b32 v47, v47, v5, v46 bitop3:0xea
    ds_read_b64 v[104:105], v47
    s_waitcnt lgkmcnt(4)
    v_mfma_f32_4x4x4_16b_bf16 v[80:83], v[10:11], v[70:71], v[80:83]
    v_mfma_f32_4x4x4_16b_bf16 v[76:79], v[10:11], v[68:69], v[76:79]
    v_perm_b32 v15, v35, v38, s45
    v_bitop3_b32 v46, v35, 0.5, -0.5 bitop3:0xa8
    v_perm_b32 v14, v34, v38, s44
    v_bitop3_b32 v47, v34, 0.5, -0.5 bitop3:0xa8
    v_cvt_pk_bf16_f32 v80, v80, v81
    v_cvt_pk_bf16_f32 v81, v82, v83
    ds_wrxchg_rtn_b64 v[74:75], v95, v[80:81] offset:65408
    v_cvt_pk_bf16_f32 v76, v76, v77
    v_cvt_pk_bf16_f32 v77, v78, v79
    ds_wrxchg_rtn_b64 v[72:73], v94, v[76:77] offset:65408
    s_waitcnt lgkmcnt(2)
    s_barrier
    s_setprio 3
    s_waitcnt vmcnt(6)
    v_subrev_u32 v88, s38, v3
    ds_write_b128 v88, v[116:119] offset:32768
    buffer_load_dwordx4 v[116:119], v3, s[16:19], s40 offen offset:2048
    s_waitcnt vmcnt(5)
    v_subrev_u32 v88, s38, v3
    ds_write_b128 v88, v[120:123] offset:33792
    buffer_load_dwordx4 v[120:123], v3, s[16:19], s40 offen offset:3072
    v_mfma_f32_4x4x4_16b_bf16 v[80:83], v[8:9], v[102:103], 0
    v_mfma_f32_4x4x4_16b_bf16 v[76:79], v[8:9], v[100:101], 0
    v_bitop3_b32 v15, v6, v15, v46 bitop3:0xca
    v_bitop3_b32 v14, v6, v14, v47 bitop3:0xca
    v_cmp_lt_u32 s[84:85], v5, v92
    s_nop 0
    v_pk_mul_f32 v[80:81], v[80:81], v[14:15] op_sel:[0,1] op_sel_hi:[1,1]
    v_pk_mul_f32 v[82:83], v[82:83], v[14:15] op_sel:[0,1] op_sel_hi:[1,1]
    v_pk_mul_f32 v[76:77], v[76:77], v[14:15] op_sel:[0,0] op_sel_hi:[1,0]
    v_pk_mul_f32 v[78:79], v[78:79], v[14:15] op_sel:[0,0] op_sel_hi:[1,0]
    v_mov_b32 v44, v43
    s_cmp_gt_u32 s37, 1024
    s_cbranch_scc1 L2_xs25
    s_cmp_lg_u32 s101, 0
    s_cbranch_scc1 L2_xa25
L2_xb25:
    v_lshlrev_b32 v89, 16, v96
    v_add_u32 v90, 60, v97
    v_bitop3_b32 v90, v89, v45, v90 bitop3:0x6a
    ds_write_b32 v98, v90 offset:12
    v_lshlrev_b32 v89, 20, v96
    v_add_u32 v90, 40, v97
    v_bitop3_b32 v90, v89, v45, v90 bitop3:0x6a
    ds_write_b32 v98, v90 offset:8
    v_lshlrev_b32 v89, 24, v96
    v_add_u32 v90, 20, v97
    v_bitop3_b32 v90, v89, v45, v90 bitop3:0x6a
    ds_write_b32 v98, v90 offset:4
    v_lshlrev_b32 v89, 28, v96
    v_bitop3_b32 v90, v89, v45, v97 bitop3:0x6a
    ds_write_b32 v98, v90 offset:0
    v_mov_b32_dpp v91, v64 quad_perm:[1,1,1,1] row_mask:0xf bank_mask:0xf
    v_and_b32 v89, 3, v91
    v_and_b32 v97, 0xfffc, v91
    v_sub_u16_dpp v88, v64, v91 quad_perm:[3,3,3,3] row_mask:0xf bank_mask:0xf
    v_mad_u32_u24 v97, v97, 5, v4
    v_add_u32 v99, v88, v89
    v_bfm_b32 v96, v88, v89
    v_cmp_lt_u32 s[58:59], 16, v99
    v_lshlrev_b32 v89, v1, v96
    v_and_b32 v89, v45, v89
    v_cmp_ne_u32 vcc, 0, v89
    v_xor_b32 v90, v97, v89
    s_add_u32 s3, s37, s38
    v_mbcnt_lo_u32_b32 v98, vcc_lo, 0
    v_mbcnt_hi_u32_b32 v98, vcc_hi, v98
    s_bcnt1_i32_b64 s41, vcc
    v_lshl_add_u32 v98, v98, 2, s3
    s_mov_b64 exec, vcc
    ds_write_b32 v98, v90
    s_mov_b64 exec, -1
    s_lshl2_add_u32 s37, s41, s37
    s_cmp_lg_u64 s[58:59], 0
    s_cbranch_scc1 L2_xe25
L2_xr25:
    v_add_u32 v98, s37, v0
    v_mov_b32 v90, -1
    ds_write_b32 v98, v90
    ds_read2st64_b32 v[40:41], v0 offset0:0 offset1:1
    ds_read2st64_b32 v[42:43], v0 offset0:2 offset1:3
    s_sub_u32 s3, s37, 768
    s_cmp_gt_u32 s3, 256
    s_cbranch_scc1 L2_xf25
L2_xg25:
    s_setprio 2
    s_waitcnt vmcnt(8)
    v_subrev_u32 v88, s38, v3
    ds_write_b128 v88, v[124:127] offset:34816
    s_add_u32 s3, s40, 4096
    buffer_load_dwordx4 v[124:127], v3, s[16:19], s3 offen
    s_waitcnt lgkmcnt(11)
    v_cmp_ne_u64 s[50:51], v[72:73], v[68:69]
    v_cmpx_ne_u64 s[54:55], v[74:75], v[70:71]
    s_and_b64 s[82:83], s[54:55], s[80:81]
    s_cbranch_scc1 L2_c26
L2_d26:
    v_mov_b64 v[84:85], v[70:71]
    v_mov_b32 v7, v95
    v_mov_b64 v[86:87], v[74:75]
    s_or_b64 s[80:81], s[80:81], s[54:55]
    s_mov_b64 exec, s[50:51]
    s_and_b64 s[82:83], s[50:51], s[80:81]
    s_cbranch_scc1 L2_c27
L2_d27:
    v_mov_b64 v[84:85], v[68:69]
    v_mov_b32 v7, v94
    v_mov_b64 v[86:87], v[72:73]
    s_mov_b64 exec, -1
    s_or_b64 s[80:81], s[80:81], s[50:51]
    ds_read_b64 v[70:71], v93 offset:65408
    s_and_b64 exec, s[84:85], s[80:81]
    v_mfma_f32_4x4x4_16b_bf16 v[76:79], v[12:13], v[84:85], 0
    v_mov_b32 v92, v7
    s_andn2_b64 s[80:81], s[80:81], s[84:85]
    v_mfma_f32_4x4x4_16b_bf16 v[76:79], v[10:11], v[86:87], v[76:79]
    s_mov_b64 exec, -1
    ds_read_b64 v[68:69], v92 offset:65408
    s_setprio 1
    s_waitcnt vmcnt(7)
    v_subrev_u32 v88, s100, v3
    ds_write_b128 v88, v[108:111] offset:0
    s_waitcnt lgkmcnt(1)
    v_mfma_f32_4x4x4_16b_bf16 v[80:83], v[10:11], v[70:71], v[80:83]
    v_mfma_f32_4x4x4_16b_bf16 v[76:79], v[10:11], v[68:69], v[76:79]
    v_and_b32 v46, 0x40000000, v39
    v_bitop3_b32 v94, v36, v5, v46 bitop3:0xea
    v_and_b32 v46, 0x80000000, v39
    v_bitop3_b32 v95, v37, v5, v46 bitop3:0xea
    v_perm_b32 v15, v37, v38, s47
    v_bitop3_b32 v46, v37, 0.5, -0.5 bitop3:0xa8
    v_perm_b32 v14, v36, v38, s46
    v_bitop3_b32 v47, v36, 0.5, -0.5 bitop3:0xa8
    v_cvt_pk_bf16_f32 v80, v80, v81
    v_cvt_pk_bf16_f32 v81, v82, v83
    ds_wrxchg_rtn_b64 v[74:75], v93, v[80:81] offset:65408
    v_cvt_pk_bf16_f32 v76, v76, v77
    v_cvt_pk_bf16_f32 v77, v78, v79
    ds_wrxchg_rtn_b64 v[72:73], v92, v[76:77] offset:65408
    s_setprio 0
    s_waitcnt vmcnt(7)
    v_subrev_u32 v88, s100, v3
    ds_write_b128 v88, v[112:115] offset:1024
    v_mfma_f32_4x4x4_16b_bf16 v[80:83], v[8:9], v[106:107], 0
    v_mfma_f32_4x4x4_16b_bf16 v[76:79], v[8:9], v[104:105], 0
    v_bitop3_b32 v15, v6, v15, v46 bitop3:0xca
    v_bitop3_b32 v14, v6, v14, v47 bitop3:0xca
    s_nop 1
    v_pk_mul_f32 v[80:81], v[80:81], v[14:15] op_sel:[0,1] op_sel_hi:[1,1]
    v_pk_mul_f32 v[82:83], v[82:83], v[14:15] op_sel:[0,1] op_sel_hi:[1,1]
    v_pk_mul_f32 v[76:77], v[76:77], v[14:15] op_sel:[0,0] op_sel_hi:[1,0]
    v_pk_mul_f32 v[78:79], v[78:79], v[14:15] op_sel:[0,0] op_sel_hi:[1,0]
    s_add_u32 s42, s42, 1
    s_waitcnt lgkmcnt(0)
    s_add_u32 s24, s30, 0xec45000
    s_addc_u32 s25, s31, 0
    s_mov_b32 s26, 0x100
    s_mov_b32 s27, 0x20000
    s_barrier
    s_bitcmp1_b32 s36, s42
    s_cbranch_scc1 L2_slow
L2_ret1:
    s_setprio 3
    v_and_b32 v47, 0x0fffffff, v44
    v_mov_b32 v39, v44
    buffer_load_dwordx2 v[34:35], v47, s[8:11], 0 offen
    buffer_load_dwordx3 v[36:38], v47, s[8:11], 0 offen offset:8
    buffer_load_dwordx4 v[108:111], v3, s[16:19], s40 offen offset:0
    v_cmp_ne_u64 s[50:51], v[72:73], v[68:69]
    v_cmpx_ne_u64 s[54:55], v[74:75], v[70:71]
    s_and_b64 s[82:83], s[54:55], s[80:81]
    s_cbranch_scc1 L2_c28
L2_d28:
    v_mov_b64 v[84:85], v[70:71]
    v_mov_b32 v7, v93
    v_mov_b64 v[86:87], v[74:75]
    s_or_b64 s[80:81], s[80:81], s[54:55]
    s_mov_b64 exec, s[50:51]
    s_and_b64 s[82:83], s[50:51], s[80:81]
    s_cbranch_scc1 L2_c29
L2_d29:
    v_mov_b64 v[84:85], v[68:69]
    v_mov_b32 v7, v92
    v_mov_b64 v[86:87], v[72:73]
    s_mov_b64 exec, -1
    s_or_b64 s[80:81], s[80:81], s[50:51]
    ds_read_b64 v[70:71], v95 offset:65408
    ds_read_b64 v[68:69], v94 offset:65408
    v_and_b32 v46, 0x20000000, v21
    v_lshrrev_b32 v47, 14, v17
    v_bitop3_b32 v47, v47, v5, v46 bitop3:0xea
    ds_read_b64 v[102:103], v47
    v_bitop3_b32 v93, v17, v5, v46 bitop3:0xea
    v_and_b32 v46, 0x10000000, v21
    v_lshrrev_b32 v47, 14, v16
    v_bitop3_b32 v47, v47, v5, v46 bitop3:0xea
    ds_read_b64 v[100:101], v47
    v_bitop3_b32 v92, v16, v5, v46 bitop3:0xea
    s_waitcnt lgkmcnt(2)
    v_mfma_f32_4x4x4_16b_bf16 v[80:83], v[10:11], v[70:71], v[80:83]
    v_mfma_f32_4x4x4_16b_bf16 v[76:79], v[10:11], v[68:69], v[76:79]
    v_perm_b32 v15, v17, v20, s45
    v_bitop3_b32 v46, v17, 0.5, -0.5 bitop3:0xa8
    v_perm_b32 v14, v16, v20, s44
    v_bitop3_b32 v47, v16, 0.5, -0.5 bitop3:0xa8
    v_cvt_pk_bf16_f32 v80, v80, v81
    v_cvt_pk_bf16_f32 v81, v82, v83
    ds_wrxchg_rtn_b64 v[74:75], v95, v[80:81] offset:65408
    v_cvt_pk_bf16_f32 v76, v76, v77
    v_cvt_pk_bf16_f32 v77, v78, v79
    ds_wrxchg_rtn_b64 v[72:73], v94, v[76:77] offset:65408
    s_waitcnt lgkmcnt(2)
    v_mfma_f32_4x4x4_16b_bf16 v[80:83], v[8:9], v[102:103], 0
    v_mfma_f32_4x4x4_16b_bf16 v[76:79], v[8:9], v[100:101], 0
    v_bitop3_b32 v15, v6, v15, v46 bitop3:0xca
    v_bitop3_b32 v14, v6, v14, v47 bitop3:0xca
    v_cmp_lt_u32 s[84:85], v5, v92
    s_nop 0
    v_pk_mul_f32 v[80:81], v[80:81], v[14:15] op_sel:[0,1] op_sel_hi:[1,1]
    v_pk_mul_f32 v[82:83], v[82:83], v[14:15] op_sel:[0,1] op_sel_hi:[1,1]
    v_pk_mul_f32 v[76:77], v[76:77], v[14:15] op_sel:[0,0] op_sel_hi:[1,0]
    v_pk_mul_f32 v[78:79], v[78:79], v[14:15] op_sel:[0,0] op_sel_hi:[1,0]
    buffer_load_dwordx4 v[112:115], v3, s[16:19], s40 offen offset:1024
    s_waitcnt lgkmcnt(0)
    v_cmp_ne_u64 s[50:51], v[72:73], v[68:69]
    v_cmpx_ne_u64 s[54:55], v[74:75], v[70:71]
    s_and_b64 s[82:83], s[54:55], s[80:81]
    s_cbranch_scc1 L2_c30
L2_d30:
    v_mov_b64 v[84:85], v[70:71]
    v_mov_b32 v7, v95
    v_mov_b64 v[86:87], v[74:75]
    s_or_b64 s[80:81], s[80:81], s[54:55]
    s_mov_b64 exec, s[50:51]
    s_and_b64 s[82:83], s[50:51], s[80:81]
    s_cbranch_scc1 L2_c31
L2_d31:
    v_mov_b64 v[84:85], v[68:69]
    v_mov_b32 v7, v94
    v_mov_b64 v[86:87], v[72:73]
    s_mov_b64 exec, -1
    s_or_b64 s[80:81], s[80:81], s[50:51]
    ds_read_b64 v[70:71], v93 offset:65408
    s_and_b64 exec, s[84:85], s[80:81]
    v_mfma_f32_4x4x4_16b_bf16 v[76:79], v[12:13], v[84:85], 0
    v_mov_b32 v92, v7
    s_andn2_b64 s[80:81], s[80:81], s[84:85]
    v_mfma_f32_4x4x4_16b_bf16 v[76:79], v[10:11], v[86:87], v[76:79]
    s_mov_b64 exec, -1
    ds_read_b64 v[68:69], v92 offset:65408
    v_and_b32 v46, 0x80000000, v21
    v_lshrrev_b32 v47, 14, v19
    v_bitop3_b32 v47, v47, v5, v46 bitop3:0xea
    ds_read_b64 v[106:107], v47
    v_bitop3_b32 v95, v19, v5, v46 bitop3:0xea
    v_and_b32 v46, 0x40000000, v21
    v_lshrrev_b32 v47, 14, v18
    v_bitop3_b32 v47, v47, v5, v46 bitop3:0xea
    ds_read_b64 v[104:105], v47
    v_bitop3_b32 v94, v18, v5, v46 bitop3:0xea
    s_waitcnt lgkmcnt(2)
    v_mfma_f32_4x4x4_16b_bf16 v[80:83], v[10:11], v[70:71], v[80:83]
    v_mfma_f32_4x4x4_16b_bf16 v[76:79], v[10:11], v[68:69], v[76:79]
    v_perm_b32 v15, v19, v20, s47
    v_bitop3_b32 v46, v19, 0.5, -0.5 bitop3:0xa8
    v_perm_b32 v14, v18, v20, s46
    v_bitop3_b32 v47, v18, 0.5, -0.5 bitop3:0xa8
    v_cvt_pk_bf16_f32 v80, v80, v81
    v_cvt_pk_bf16_f32 v81, v82, v83
    ds_wrxchg_rtn_b64 v[74:75], v93, v[80:81] offset:65408
    v_cvt_pk_bf16_f32 v76, v76, v77
    v_cvt_pk_bf16_f32 v77, v78, v79
    ds_wrxchg_rtn_b64 v[72:73], v92, v[76:77] offset:65408
    s_setprio 2
    s_waitcnt lgkmcnt(2)
    v_mfma_f32_4x4x4_16b_bf16 v[80:83], v[8:9], v[106:107], 0
    v_mfma_f32_4x4x4_16b_bf16 v[76:79], v[8:9], v[104:105], 0
    v_bitop3_b32 v15, v6, v15, v46 bitop3:0xca
    v_bitop3_b32 v14, v6, v14, v47 bitop3:0xca
    s_nop 1
    v_pk_mul_f32 v[80:81], v[80:81], v[14:15] op_sel:[0,1] op_sel_hi:[1,1]
    v_pk_mul_f32 v[82:83], v[82:83], v[14:15] op_sel:[0,1] op_sel_hi:[1,1]
    v_pk_mul_f32 v[76:77], v[76:77], v[14:15] op_sel:[0,0] op_sel_hi:[1,0]
    v_pk_mul_f32 v[78:79], v[78:79], v[14:15] op_sel:[0,0] op_sel_hi:[1,0]
    v_sub_u16 v88, v62, v54
    v_and_b32 v89, 3, v54
    v_add3_u32 v99, v88, v89, 3
    v_and_b32 v99, -4, v99
    v_max_u32 v99, 4, v99
    v_and_b32 v97, 0xfffc, v54
    v_bfm_b32 v96, v88, v89
    v_add_u32_dpp v91, v99, v99 row_shr:1 row_mask:0xf bank_mask:0xf bound_ctrl:1
    v_mad_u32_u24 v97, v97, 5, v2
    v_cmp_lt_u32 vcc, 16, v99
    v_add_u32_dpp v91, v91, v91 row_shr:2 row_mask:0xf bank_mask:0xf bound_ctrl:1
    v_sub_u32 v98, s38, v99
    v_lshrrev_b64 v[54:55], 16, v[54:55]
    v_add_u32_dpp v91, v91, v91 row_shr:4 row_mask:0xf bank_mask:0xf bound_ctrl:1
    v_lshrrev_b64 v[62:63], 16, v[62:63]
    s_mov_b32 s101, 0
    v_add_u32_dpp v91, v91, v91 row_shr:8 row_mask:0xf bank_mask:0xf bound_ctrl:1
    s_nop 1
    v_add_u32_dpp v91, v91, v91 row_bcast:15 row_mask:0xa bank_mask:0xf
    s_nop 1
    v_add_u32_dpp v91, v91, v91 row_bcast:31 row_mask:0xc bank_mask:0xf
    v_add_u32 v98, v98, v91
    v_readlane_b32 s37, v91, 63
    s_cbranch_vccnz L2_xo32
L2_xp32:
    v_and_b32 v47, 0x0fffffff, v40
    v_mov_b32 v21, v40
    buffer_load_dwordx2 v[16:17], v47, s[8:11], 0 offen
    buffer_load_dwordx3 v[18:20], v47, s[8:11], 0 offen offset:8
    s_waitcnt lgkmcnt(0)
    v_cmp_ne_u64 s[50:51], v[72:73], v[68:69]
    v_cmpx_ne_u64 s[54:55], v[74:75], v[70:71]
    s_and_b64 s[82:83], s[54:55], s[80:81]
    s_cbranch_scc1 L2_c33
L2_d33:
    v_mov_b64 v[84:85], v[70:71]
    v_mov_b32 v7, v93
    v_mov_b64 v[86:87], v[74:75]
    s_or_b64 s[80:81], s[80:81], s[54:55]
    s_mov_b64 exec, s[50:51]
    s_and_b64 s[82:83], s[50:51], s[80:81]
    s_cbranch_scc1 L2_c34
L2_d34:
    v_mov_b64 v[84:85], v[68:69]
    v_mov_b32 v7, v92
    v_mov_b64 v[86:87], v[72:73]
    s_mov_b64 exec, -1
    s_or_b64 s[80:81], s[80:81], s[50:51]
    ds_read_b64 v[70:71], v95 offset:65408
    ds_read_b64 v[68:69], v94 offset:65408
    s_waitcnt vmcnt(11)
    v_and_b32 v46, 0x20000000, v27
    v_lshrrev_b32 v47, 14, v23
    v_bitop3_b32 v47, v47, v5, v46 bitop3:0xea
    ds_read_b64 v[102:103], v47
    v_bitop3_b32 v93, v23, v5, v46 bitop3:0xea
    v_and_b32 v46, 0x10000000, v27
    v_lshrrev_b32 v47, 14, v22
    v_bitop3_b32 v47, v47, v5, v46 bitop3:0xea
    ds_read_b64 v[100:101], v47
    v_bitop3_b32 v92, v22, v5, v46 bitop3:0xea
    s_waitcnt lgkmcnt(2)
    v_mfma_f32_4x4x4_16b_bf16 v[80:83], v[10:11], v[70:71], v[80:83]
    v_mfma_f32_4x4x4_16b_bf16 v[76:79], v[10:11], v[68:69], v[76:79]
    v_perm_b32 v15, v23, v26, s45
    v_bitop3_b32 v46, v23, 0.5, -0.5 bitop3:0xa8
    v_perm_b32 v14, v22, v26, s44
    v_bitop3_b32 v47, v22, 0.5, -0.5 bitop3:0xa8
    v_cvt_pk_bf16_f32 v80, v80, v81
    v_cvt_pk_bf16_f32 v81, v82, v83
    ds_wrxchg_rtn_b64 v[74:75], v95, v[80:81] offset:65408
    v_cvt_pk_bf16_f32 v76, v76, v77
    v_cvt_pk_bf16_f32 v77, v78, v79
    ds_wrxchg_rtn_b64 v[72:73], v94, v[76:77] offset:65408
    s_waitcnt lgkmcnt(2)
    v_mfma_f32_4x4x4_16b_bf16 v[80:83], v[8:9], v[102:103], 0
    v_mfma_f32_4x4x4_16b_bf16 v[76:79], v[8:9], v[100:101], 0
    v_bitop3_b32 v15, v6, v15, v46 bitop3:0xca
    v_bitop3_b32 v14, v6, v14, v47 bitop3:0xca
    v_cmp_lt_u32 s[84:85], v5, v92
    s_nop 0
    v_pk_mul_f32 v[80:81], v[80:81], v[14:15] op_sel:[0,1] op_sel_hi:[1,1]
    v_pk_mul_f32 v[82:83], v[82:83], v[14:15] op_sel:[0,1] op_sel_hi:[1,1]
    v_pk_mul_f32 v[76:77], v[76:77], v[14:15] op_sel:[0,0] op_sel_hi:[1,0]
    v_pk_mul_f32 v[78:79], v[78:79], v[14:15] op_sel:[0,0] op_sel_hi:[1,0]
    s_waitcnt lgkmcnt(0)
    v_cmp_ne_u64 s[50:51], v[72:73], v[68:69]
    v_cmpx_ne_u64 s[54:55], v[74:75], v[70:71]
    s_and_b64 s[82:83], s[54:55], s[80:81]
    s_cbranch_scc1 L2_c35
L2_d35:
    v_mov_b64 v[84:85], v[70:71]
    v_mov_b32 v7, v95
    v_mov_b64 v[86:87], v[74:75]
    s_or_b64 s[80:81], s[80:81], s[54:55]
    s_mov_b64 exec, s[50:51]
    s_and_b64 s[82:83], s[50:51], s[80:81]
    s_cbranch_scc1 L2_c36
L2_d36:
    v_mov_b64 v[84:85], v[68:69]
    v_mov_b32 v7, v94
    v_mov_b64 v[86:87], v[72:73]
    s_mov_b64 exec, -1
    s_or_b64 s[80:81], s[80:81], s[50:51]
    ds_read_b64 v[70:71], v93 offset:65408
    s_and_b64 exec, s[84:85], s[80:81]
    v_mfma_f32_4x4x4_16b_bf16 v[76:79], v[12:13], v[84:85], 0
    v_mov_b32 v92, v7
    s_andn2_b64 s[80:81], s[80:81], s[84:85]
    v_mfma_f32_4x4x4_16b_bf16 v[76:79], v[10:11], v[86:87], v[76:79]
    s_mov_b64 exec, -1
    ds_read_b64 v[68:69], v92 offset:65408
    v_and_b32 v46, 0x80000000, v27
    v_lshrrev_b32 v47, 14, v25
    v_bitop3_b32 v47, v47, v5, v46 bitop3:0xea
    ds_read_b64 v[106:107], v47
    v_bitop3_b32 v95, v25, v5, v46 bitop3:0xea
    v_and_b32 v46, 0x40000000, v27
    v_lshrrev_b32 v47, 14, v24
    v_bitop3_b32 v47, v47, v5, v46 bitop3:0xea
    ds_read_b64 v[104:105], v47
    v_bitop3_b32 v94, v24, v5, v46 bitop3:0xea
    s_waitcnt lgkmcnt(2)
    v_mfma_f32_4x4x4_16b_bf16 v[80:83], v[10:11], v[70:71], v[80:83]
    v_mfma_f32_4x4x4_16b_bf16 v[76:79], v[10:11], v[68:69], v[76:79]
    v_perm_b32 v15, v25, v26, s47
    v_bitop3_b32 v46, v25, 0.5, -0.5 bitop3:0xa8
    v_perm_b32 v14, v24, v26, s46
    v_bitop3_b32 v47, v24, 0.5, -0.5 bitop3:0xa8
    v_cvt_pk_bf16_f32 v80, v80, v81
    v_cvt_pk_bf16_f32 v81, v82, v83
    ds_wrxchg_rtn_b64 v[74:75], v93, v[80:81] offset:65408
    v_cvt_pk_bf16_f32 v76, v76, v77
    v_cvt_pk_bf16_f32 v77, v78, v79
    ds_wrxchg_rtn_b64 v[72:73], v92, v[76:77] offset:65408
    s_setprio 1
    s_waitcnt lgkmcnt(2)
    v_mfma_f32_4x4x4_16b_bf16 v[80:83], v[8:9], v[106:107], 0
    v_mfma_f32_4x4x4_16b_bf16 v[76:79], v[8:9], v[104:105], 0
    v_bitop3_b32 v15, v6, v15, v46 bitop3:0xca
    v_bitop3_b32 v14, v6, v14, v47 bitop3:0xca
    s_nop 1
    v_pk_mul_f32 v[80:81], v[80:81], v[14:15] op_sel:[0,1] op_sel_hi:[1,1]
    v_pk_mul_f32 v[82:83], v[82:83], v[14:15] op_sel:[0,1] op_sel_hi:[1,1]
    v_pk_mul_f32 v[76:77], v[76:77], v[14:15] op_sel:[0,0] op_sel_hi:[1,0]
    v_pk_mul_f32 v[78:79], v[78:79], v[14:15] op_sel:[0,0] op_sel_hi:[1,0]
    v_and_b32 v47, 0x0fffffff, v41
    v_mov_b32 v27, v41
    buffer_load_dwordx2 v[22:23], v47, s[8:11], 0 offen
    buffer_load_dwordx3 v[24:26], v47, s[8:11], 0 offen offset:8
    s_waitcnt lgkmcnt(0)
    v_cmp_ne_u64 s[50:51], v[72:73], v[68:69]
    v_cmpx_ne_u64 s[54:55], v[74:75], v[70:71]
    s_and_b64 s[82:83], s[54:55], s[80:81]
    s_cbranch_scc1 L2_c37
L2_d37:
    v_mov_b64 v[84:85], v[70:71]
    v_mov_b32 v7, v93
    v_mov_b64 v[86:87], v[74:75]
    s_or_b64 s[80:81], s[80:81], s[54:55]
    s_mov_b64 exec, s[50:51]
    s_and_b64 s[82:83], s[50:51], s[80:81]
    s_cbranch_scc1 L2_c38
L2_d38:
    v_mov_b64 v[84:85], v[68:69]
    v_mov_b32 v7, v92
    v_mov_b64 v[86:87], v[72:73]
    s_mov_b64 exec, -1
    s_or_b64 s[80:81], s[80:81], s[50:51]
    ds_read_b64 v[70:71], v95 offset:65408
    ds_read_b64 v[68:69], v94 offset:65408
    s_waitcnt vmcnt(11)
    v_and_b32 v46, 0x20000000, v33
    v_lshrrev_b32 v47, 14, v29
    v_bitop3_b32 v47, v47, v5, v46 bitop3:0xea
    ds_read_b64 v[102:103], v47
    v_bitop3_b32 v93, v29, v5, v46 bitop3:0xea
    v_and_b32 v46, 0x10000000, v33
    v_lshrrev_b32 v47, 14, v28
    v_bitop3_b32 v47, v47, v5, v46 bitop3:0xea
    ds_read_b64 v[100:101], v47
    v_bitop3_b32 v92, v28, v5, v46 bitop3:0xea
    s_waitcnt lgkmcnt(2)
    v_mfma_f32_4x4x4_16b_bf16 v[80:83], v[10:11], v[70:71], v[80:83]
    v_mfma_f32_4x4x4_16b_bf16 v[76:79], v[10:11], v[68:69], v[76:79]
    v_perm_b32 v15, v29, v32, s45
    v_bitop3_b32 v46, v29, 0.5, -0.5 bitop3:0xa8
    v_perm_b32 v14, v28, v32, s44
    v_bitop3_b32 v47, v28, 0.5, -0.5 bitop3:0xa8
    v_cvt_pk_bf16_f32 v80, v80, v81
    v_cvt_pk_bf16_f32 v81, v82, v83
    ds_wrxchg_rtn_b64 v[74:75], v95, v[80:81] offset:65408
    v_cvt_pk_bf16_f32 v76, v76, v77
    v_cvt_pk_bf16_f32 v77, v78, v79
    ds_wrxchg_rtn_b64 v[72:73], v94, v[76:77] offset:65408
    s_waitcnt lgkmcnt(2)
    v_mfma_f32_4x4x4_16b_bf16 v[80:83], v[8:9], v[102:103], 0
    v_mfma_f32_4x4x4_16b_bf16 v[76:79], v[8:9], v[100:101], 0
    v_bitop3_b32 v15, v6, v15, v46 bitop3:0xca
    v_bitop3_b32 v14, v6, v14, v47 bitop3:0xca
    v_cmp_lt_u32 s[84:85], v5, v92
    s_nop 0
    v_pk_mul_f32 v[80:81], v[80:81], v[14:15] op_sel:[0,1] op_sel_hi:[1,1]
    v_pk_mul_f32 v[82:83], v[82:83], v[14:15] op_sel:[0,1] op_sel_hi:[1,1]
    v_pk_mul_f32 v[76:77], v[76:77], v[14:15] op_sel:[0,0] op_sel_hi:[1,0]
    v_pk_mul_f32 v[78:79], v[78:79], v[14:15] op_sel:[0,0] op_sel_hi:[1,0]
    s_waitcnt lgkmcnt(0)
    v_cmp_ne_u64 s[50:51], v[72:73], v[68:69]
    v_cmpx_ne_u64 s[54:55], v[74:75], v[70:71]
    s_and_b64 s[82:83], s[54:55], s[80:81]
    s_cbranch_scc1 L2_c39
L2_d39:
    v_mov_b64 v[84:85], v[70:71]
    v_mov_b32 v7, v95
    v_mov_b64 v[86:87], v[74:75]
    s_or_b64 s[80:81], s[80:81], s[54:55]
    s_mov_b64 exec, s[50:51]
    s_and_b64 s[82:83], s[50:51], s[80:81]
    s_cbranch_scc1 L2_c40
L2_d40:
    v_mov_b64 v[84:85], v[68:69]
    v_mov_b32 v7, v94
    v_mov_b64 v[86:87], v[72:73]
    s_mov_b64 exec, -1
    s_or_b64 s[80:81], s[80:81], s[50:51]
    ds_read_b64 v[70:71], v93 offset:65408
    s_and_b64 exec, s[84:85], s[80:81]
    v_mfma_f32_4x4x4_16b_bf16 v[76:79], v[12:13], v[84:85], 0
    v_mov_b32 v92, v7
    s_andn2_b64 s[80:81], s[80:81], s[84:85]
    v_mfma_f32_4x4x4_16b_bf16 v[76:79], v[10:11], v[86:87], v[76:79]
    s_mov_b64 exec, -1
    ds_read_b64 v[68:69], v92 offset:65408
    v_and_b32 v46, 0x80000000, v33
    v_lshrrev_b32 v47, 14, v31
    v_bitop3_b32 v47, v47, v5, v46 bitop3:0xea
    ds_read_b64 v[106:107], v47
    v_bitop3_b32 v95, v31, v5, v46 bitop3:0xea
    v_and_b32 v46, 0x40000000, v33
    v_lshrrev_b32 v47, 14, v30
    v_bitop3_b32 v47, v47, v5, v46 bitop3:0xea
    ds_read_b64 v[104:105], v47
    v_bitop3_b32 v94, v30, v5, v46 bitop3:0xea
    s_waitcnt lgkmcnt(2)
    v_mfma_f32_4x4x4_16b_bf16 v[80:83], v[10:11], v[70:71], v[80:83]
    v_mfma_f32_4x4x4_16b_bf16 v[76:79], v[10:11], v[68:69], v[76:79]
    v_perm_b32 v15, v31, v32, s47
    v_bitop3_b32 v46, v31, 0.5, -0.5 bitop3:0xa8
    v_perm_b32 v14, v30, v32, s46
    v_bitop3_b32 v47, v30, 0.5, -0.5 bitop3:0xa8
    v_cvt_pk_bf16_f32 v80, v80, v81
    v_cvt_pk_bf16_f32 v81, v82, v83
    ds_wrxchg_rtn_b64 v[74:75], v93, v[80:81] offset:65408
    v_cvt_pk_bf16_f32 v76, v76, v77
    v_cvt_pk_bf16_f32 v77, v78, v79
    ds_wrxchg_rtn_b64 v[72:73], v92, v[76:77] offset:65408
    s_setprio 0
    s_waitcnt lgkmcnt(2)
    v_mfma_f32_4x4x4_16b_bf16 v[80:83], v[8:9], v[106:107], 0
    v_mfma_f32_4x4x4_16b_bf16 v[76:79], v[8:9], v[104:105], 0
    v_bitop3_b32 v15, v6, v15, v46 bitop3:0xca
    v_bitop3_b32 v14, v6, v14, v47 bitop3:0xca
    s_nop 1
    v_pk_mul_f32 v[80:81], v[80:81], v[14:15] op_sel:[0,1] op_sel_hi:[1,1]
    v_pk_mul_f32 v[82:83], v[82:83], v[14:15] op_sel:[0,1] op_sel_hi:[1,1]
    v_pk_mul_f32 v[76:77], v[76:77], v[14:15] op_sel:[0,0] op_sel_hi:[1,0]
    v_pk_mul_f32 v[78:79], v[78:79], v[14:15] op_sel:[0,0] op_sel_hi:[1,0]
    s_add_u32 s40, s40, 0x50000
    v_and_b32 v47, 0x0fffffff, v42
    v_mov_b32 v33, v42
    buffer_load_dwordx2 v[28:29], v47, s[8:11], 0 offen
    buffer_load_dwordx3 v[30:32], v47, s[8:11], 0 offen offset:8
    s_waitcnt lgkmcnt(0)
    v_cmp_ne_u64 s[50:51], v[72:73], v[68:69]
    v_cmpx_ne_u64 s[54:55], v[74:75], v[70:71]
    s_and_b64 s[82:83], s[54:55], s[80:81]
    s_cbranch_scc1 L2_c41
L2_d41:
    v_mov_b64 v[84:85], v[70:71]
    v_mov_b32 v7, v93
    v_mov_b64 v[86:87], v[74:75]
    s_or_b64 s[80:81], s[80:81], s[54:55]
    s_mov_b64 exec, s[50:51]
    s_and_b64 s[82:83], s[50:51], s[80:81]
    s_cbranch_scc1 L2_c42
L2_d42:
    v_mov_b64 v[84:85], v[68:69]
    v_mov_b32 v7, v92
    v_mov_b64 v[86:87], v[72:73]
    s_mov_b64 exec, -1
    s_or_b64 s[80:81], s[80:81], s[50:51]
    ds_read_b64 v[70:71], v95 offset:65408
    ds_read_b64 v[68:69], v94 offset:65408
    s_waitcnt vmcnt(8)
    v_and_b32 v46, 0x20000000, v39
    v_lshrrev_b32 v47, 14, v35
    v_bitop3_b32 v47, v47, v5, v46 bitop3:0xea
    ds_read_b64 v[102:103], v47
    v_bitop3_b32 v93, v35, v5, v46 bitop3:0xea
    v_and_b32 v46, 0x10000000, v39
    v_lshrrev_b32 v47, 14, v34
    v_bitop3_b32 v47, v47, v5, v46 bitop3:0xea
    ds_read_b64 v[100:101], v47
    v_bitop3_b32 v92, v34, v5, v46 bitop3:0xea
    v_and_b32 v46, 0x80000000, v39
    v_lshrrev_b32 v47, 14, v37
    v_bitop3_b32 v47, v47, v5, v46 bitop3:0xea
    ds_read_b64 v[106:107], v47
    v_and_b32 v46, 0x40000000, v39
    v_lshrrev_b32 v47, 14, v36
    v_bitop3_b32 v47, v47, v5, v46 bitop3:0xea
    ds_read_b64 v[104:105], v47
    s_waitcnt lgkmcnt(4)
    v_mfma_f32_4x4x4_16b_bf16 v[80:83], v[10:11], v[70:71], v[80:83]
    v_mfma_f32_4x4x4_16b_bf16 v[76:79], v[10:11], v[68:69], v[76:79]
    v_perm_b32 v15, v35, v38, s45
    v_bitop3_b32 v46, v35, 0.5, -0.5 bitop3:0xa8
    v_perm_b32 v14, v34, v38, s44
    v_bitop3_b32 v47, v34, 0.5, -0.5 bitop3:0xa8
    v_cvt_pk_bf16_f32 v80, v80, v81
    v_cvt_pk_bf16_f32 v81, v82, v83
    ds_wrxchg_rtn_b64 v[74:75], v95, v[80:81] offset:65408
    v_cvt_pk_bf16_f32 v76, v76, v77
    v_cvt_pk_bf16_f32 v77, v78, v79
    ds_wrxchg_rtn_b64 v[72:73], v94, v[76:77] offset:65408
    s_waitcnt lgkmcnt(2)
    s_barrier
    s_setprio 3
    s_mov_b32 m0, s100
    s_nop 0
    ds_write_addtid_b32 v116 offset:32768
    ds_write_addtid_b32 v117 offset:33024
    ds_write_addtid_b32 v118 offset:33280
    ds_write_addtid_b32 v119 offset:33536
    buffer_load_dwordx4 v[116:119], v3, s[16:19], s40 offen offset:2048
    ds_write_addtid_b32 v120 offset:33792
    ds_write_addtid_b32 v121 offset:34048
    ds_write_addtid_b32 v122 offset:34304
    ds_write_addtid_b32 v123 offset:34560
    buffer_load_dwordx4 v[120:123], v3, s[16:19], s40 offen offset:3072
    v_mfma_f32_4x4x4_16b_bf16 v[80:83], v[8:9], v[102:103], 0
    v_mfma_f32_4x4x4_16b_bf16 v[76:79], v[8:9], v[100:101], 0
    v_bitop3_b32 v15, v6, v15, v46 bitop3:0xca
    v_bitop3_b32 v14, v6, v14, v47 bitop3:0xca
    v_cmp_lt_u32 s[84:85], v5, v92
    s_nop 0
    v_pk_mul_f32 v[80:81], v[80:81], v[14:15] op_sel:[0,1] op_sel_hi:[1,1]
    v_pk_mul_f32 v[82:83], v[82:83], v[14:15] op_sel:[0,1] op_sel_hi:[1,1]
    v_pk_mul_f32 v[76:77], v[76:77], v[14:15] op_sel:[0,0] op_sel_hi:[1,0]
    v_pk_mul_f32 v[78:79], v[78:79], v[14:15] op_sel:[0,0] op_sel_hi:[1,0]
    v_mov_b32 v44, v43
    s_cmp_gt_u32 s37, 1024
    s_cbranch_scc1 L2_xs43
    s_cmp_lg_u32 s101, 0
    s_cbranch_scc1 L2_xa43
L2_xb43:
    v_lshlrev_b32 v89, 16, v96
    v_add_u32 v90, 60, v97
    v_bitop3_b32 v90, v89, v45, v90 bitop3:0x6a
    ds_write_b32 v98, v90 offset:12
    v_lshlrev_b32 v89, 20, v96
    v_add_u32 v90, 40, v97
    v_bitop3_b32 v90, v89, v45, v90 bitop3:0x6a
    ds_write_b32 v98, v90 offset:8
    v_lshlrev_b32 v89, 24, v96
    v_add_u32 v90, 20, v97
    v_bitop3_b32 v90, v89, v45, v90 bitop3:0x6a
    ds_write_b32 v98, v90 offset:4
    v_lshlrev_b32 v89, 28, v96
    v_bitop3_b32 v90, v89, v45, v97 bitop3:0x6a
    ds_write_b32 v98, v90 offset:0
    v_mov_b32_dpp v91, v66 quad_perm:[1,1,1,1] row_mask:0xf bank_mask:0xf
    v_and_b32 v89, 3, v91
    v_and_b32 v97, 0xfffc, v91
    v_sub_u16_dpp v88, v66, v91 quad_perm:[3,3,3,3] row_mask:0xf bank_mask:0xf
    v_mad_u32_u24 v97, v97, 5, v4
    v_add_u32 v99, v88, v89
    v_bfm_b32 v96, v88, v89
    v_cmp_lt_u32 s[58:59], 16, v99
    v_lshlrev_b32 v89, v1, v96
    v_and_b32 v89, v45, v89
    v_cmp_ne_u32 vcc, 0, v89
    v_xor_b32 v90, v97, v89
    s_add_u32 s3, s37, s38
    v_mbcnt_lo_u32_b32 v98, vcc_lo, 0
    v_mbcnt_hi_u32_b32 v98, vcc_hi, v98
    s_bcnt1_i32_b64 s41, vcc
    v_lshl_add_u32 v98, v98, 2, s3
    s_mov_b64 exec, vcc
    ds_write_b32 v98, v90
    s_mov_b64 exec, -1
    s_lshl2_add_u32 s37, s41, s37
    s_cmp_lg_u64 s[58:59], 0
    s_cbranch_scc1 L2_xe43
L2_xr43:
    v_add_u32 v98, s37, v0
    v_mov_b32 v90, -1
    ds_write_b32 v98, v90
    ds_read2st64_b32 v[40:41], v0 offset0:0 offset1:1
    ds_read2st64_b32 v[42:43], v0 offset0:2 offset1:3
    s_sub_u32 s3, s37, 768
    s_cmp_gt_u32 s3, 256
    s_cbranch_scc1 L2_xf43
L2_xg43:
    v_lshrrev_b64 v[64:65], 16, v[64:65]
    v_lshrrev_b64 v[66:67], 16, v[66:67]
    s_setprio 2
    ds_write_addtid_b32 v124 offset:34816
    ds_write_addtid_b32 v125 offset:35072
    ds_write_addtid_b32 v126 offset:35328
    ds_write_addtid_b32 v127 offset:35584
    s_add_u32 s3, s40, 4096
    buffer_load_dwordx4 v[124:127], v3, s[16:19], s3 offen
    s_waitcnt lgkmcnt(14)
    v_cmp_ne_u64 s[50:51], v[72:73], v[68:69]
    v_cmpx_ne_u64 s[54:55], v[74:75], v[70:71]
    s_and_b64 s[82:83], s[54:55], s[80:81]
    s_cbranch_scc1 L2_c44
L2_d44:
    v_mov_b64 v[84:85], v[70:71]
    v_mov_b32 v7, v95
    v_mov_b64 v[86:87], v[74:75]
    s_or_b64 s[80:81], s[80:81], s[54:55]
    s_mov_b64 exec, s[50:51]
    s_and_b64 s[82:83], s[50:51], s[80:81]
    s_cbranch_scc1 L2_c45
L2_d45:
    v_mov_b64 v[84:85], v[68:69]
    v_mov_b32 v7, v94
    v_mov_b64 v[86:87], v[72:73]
    s_mov_b64 exec, -1
    s_or_b64 s[80:81], s[80:81], s[50:51]
    ds_read_b64 v[70:71], v93 offset:65408
    s_and_b64 exec, s[84:85], s[80:81]
    v_mfma_f32_4x4x4_16b_bf16 v[76:79], v[12:13], v[84:85], 0
    v_mov_b32 v92, v7
    s_andn2_b64 s[80:81], s[80:81], s[84:85]
    v_mfma_f32_4x4x4_16b_bf16 v[76:79], v[10:11], v[86:87], v[76:79]
    s_mov_b64 exec, -1
    ds_read_b64 v[68:69], v92 offset:65408
    s_setprio 1
    s_waitcnt vmcnt(10)
    s_mov_b32 m0, s38
    s_nop 0
    ds_write_addtid_b32 v108 offset:0
    ds_write_addtid_b32 v109 offset:256
    ds_write_addtid_b32 v110 offset:512
    ds_write_addtid_b32 v111 offset:768
    s_waitcnt lgkmcnt(4)
    v_mfma_f32_4x4x4_16b_bf16 v[80:83], v[10:11], v[70:71], v[80:83]
    v_mfma_f32_4x4x4_16b_bf16 v[76:79], v[10:11], v[68:69], v[76:79]
    v_and_b32 v46, 0x40000000, v39
    v_bitop3_b32 v94, v36, v5, v46 bitop3:0xea
    v_and_b32 v46, 0x80000000, v39
    v_bitop3_b32 v95, v37, v5, v46 bitop3:0xea
    v_perm_b32 v15, v37, v38, s47
    v_bitop3_b32 v46, v37, 0.5, -0.5 bitop3:0xa8
    v_perm_b32 v14, v36, v38, s46
    v_bitop3_b32 v47, v36, 0.5, -0.5 bitop3:0xa8
    v_cvt_pk_bf16_f32 v80, v80, v81
    v_cvt_pk_bf16_f32 v81, v82, v83
    ds_wrxchg_rtn_b64 v[74:75], v93, v[80:81] offset:65408
    v_cvt_pk_bf16_f32 v76, v76, v77
    v_cvt_pk_bf16_f32 v77, v78, v79
    ds_wrxchg_rtn_b64 v[72:73], v92, v[76:77] offset:65408
    v_and_b32 v88, 0x0fffffff, v44
    v_mov_b32 v39, v44
    buffer_load_dwordx2 v[34:35], v88, s[8:11], 0 offen
    buffer_load_dwordx3 v[36:38], v88, s[8:11], 0 offen offset:8
    s_setprio 0
    s_waitcnt vmcnt(11)
    ds_write_addtid_b32 v112 offset:1024
    ds_write_addtid_b32 v113 offset:1280
    ds_write_addtid_b32 v114 offset:1536
    ds_write_addtid_b32 v115 offset:1792
    v_mfma_f32_4x4x4_16b_bf16 v[80:83], v[8:9], v[106:107], 0
    v_mfma_f32_4x4x4_16b_bf16 v[76:79], v[8:9], v[104:105], 0
    v_bitop3_b32 v15, v6, v15, v46 bitop3:0xca
    v_bitop3_b32 v14, v6, v14, v47 bitop3:0xca
    s_nop 1
    v_pk_mul_f32 v[80:81], v[80:81], v[14:15] op_sel:[0,1] op_sel_hi:[1,1]
    v_pk_mul_f32 v[82:83], v[82:83], v[14:15] op_sel:[0,1] op_sel_hi:[1,1]
    v_pk_mul_f32 v[76:77], v[76:77], v[14:15] op_sel:[0,0] op_sel_hi:[1,0]
    v_pk_mul_f32 v[78:79], v[78:79], v[14:15] op_sel:[0,0] op_sel_hi:[1,0]
    s_add_u32 s42, s42, 1
    s_waitcnt lgkmcnt(0)
L2_loop:
    s_barrier
    s_bitcmp1_b32 s36, s42
    s_cbranch_scc1 L2_slow
L2_ret2:
    s_setprio 3
    buffer_load_dwordx4 v[108:111], v3, s[16:19], s40 offen offset:0
    v_cmp_ne_u64 s[50:51], v[72:73], v[68:69]
    v_cmpx_ne_u64 s[54:55], v[74:75], v[70:71]
    s_and_b64 s[82:83], s[54:55], s[80:81]
    s_cbranch_scc1 L2_c46
L2_d46:
    v_mov_b64 v[84:85], v[70:71]
    v_mov_b32 v7, v93
    v_mov_b64 v[86:87], v[74:75]
    s_or_b64 s[80:81], s[80:81], s[54:55]
    s_mov_b64 exec, s[50:51]
    s_and_b64 s[82:83], s[50:51], s[80:81]
    s_cbranch_scc1 L2_c47
L2_d47:
    v_mov_b64 v[84:85], v[68:69]
    v_mov_b32 v7, v92
    v_mov_b64 v[86:87], v[72:73]
    s_mov_b64 exec, -1
    s_or_b64 s[80:81], s[80:81], s[50:51]
    ds_read_b64 v[70:71], v95 offset:65408
    ds_read_b64 v[68:69], v94 offset:65408
    s_waitcnt vmcnt(10)
    v_and_b32 v46, 0x20000000, v21
    v_lshrrev_b32 v47, 14, v17
    v_bitop3_b32 v47, v47, v5, v46 bitop3:0xea
    ds_read_b64 v[102:103], v47
    v_bitop3_b32 v93, v17, v5, v46 bitop3:0xea
    v_and_b32 v46, 0x10000000, v21
    v_lshrrev_b32 v47, 14, v16
    v_bitop3_b32 v47, v47, v5, v46 bitop3:0xea
    ds_read_b64 v[100:101], v47
    v_bitop3_b32 v92, v16, v5, v46 bitop3:0xea
    s_waitcnt lgkmcnt(2)
    v_mfma_f32_4x4x4_16b_bf16 v[80:83], v[10:11], v[70:71], v[80:83]
    v_mfma_f32_4x4x4_16b_bf16 v[76:79], v[10:11], v[68:69], v[76:79]
    v_perm_b32 v15, v17, v20, s45
    v_bitop3_b32 v46, v17, 0.5, -0.5 bitop3:0xa8
    v_perm_b32 v14, v16, v20, s44
    v_bitop3_b32 v47, v16, 0.5, -0.5 bitop3:0xa8
    v_cvt_pk_bf16_f32 v80, v80, v81
    v_cvt_pk_bf16_f32 v81, v82, v83
    ds_wrxchg_rtn_b64 v[74:75], v95, v[80:81] offset:65408
    v_cvt_pk_bf16_f32 v76, v76, v77
    v_cvt_pk_bf16_f32 v77, v78, v79
    ds_wrxchg_rtn_b64 v[72:73], v94, v[76:77] offset:65408
    s_waitcnt lgkmcnt(2)
    v_mfma_f32_4x4x4_16b_bf16 v[80:83], v[8:9], v[102:103], 0
    v_mfma_f32_4x4x4_16b_bf16 v[76:79], v[8:9], v[100:101], 0
    v_bitop3_b32 v15, v6, v15, v46 bitop3:0xca
    v_bitop3_b32 v14, v6, v14, v47 bitop3:0xca
    v_cmp_lt_u32 s[84:85], v5, v92
    s_nop 0
    v_pk_mul_f32 v[80:81], v[80:81], v[14:15] op_sel:[0,1] op_sel_hi:[1,1]
    v_pk_mul_f32 v[82:83], v[82:83], v[14:15] op_sel:[0,1] op_sel_hi:[1,1]
    v_pk_mul_f32 v[76:77], v[76:77], v[14:15] op_sel:[0,0] op_sel_hi:[1,0]
    v_pk_mul_f32 v[78:79], v[78:79], v[14:15] op_sel:[0,0] op_sel_hi:[1,0]
    buffer_load_dwordx4 v[112:115], v3, s[16:19], s40 offen offset:1024
    s_waitcnt lgkmcnt(0)
    v_cmp_ne_u64 s[50:51], v[72:73], v[68:69]
    v_cmpx_ne_u64 s[54:55], v[74:75], v[70:71]
    s_and_b64 s[82:83], s[54:55], s[80:81]
    s_cbranch_scc1 L2_c48
L2_d48:
    v_mov_b64 v[84:85], v[70:71]
    v_mov_b32 v7, v95
    v_mov_b64 v[86:87], v[74:75]
    s_or_b64 s[80:81], s[80:81], s[54:55]
    s_mov_b64 exec, s[50:51]
    s_and_b64 s[82:83], s[50:51], s[80:81]
    s_cbranch_scc1 L2_c49
L2_d49:
    v_mov_b64 v[84:85], v[68:69]
    v_mov_b32 v7, v94
    v_mov_b64 v[86:87], v[72:73]
    s_mov_b64 exec, -1
    s_or_b64 s[80:81], s[80:81], s[50:51]
    ds_read_b64 v[70:71], v93 offset:65408
    s_and_b64 exec, s[84:85], s[80:81]
    v_mfma_f32_4x4x4_16b_bf16 v[76:79], v[12:13], v[84:85], 0
    v_mov_b32 v92, v7
    s_andn2_b64 s[80:81], s[80:81], s[84:85]
    v_mfma_f32_4x4x4_16b_bf16 v[76:79], v[10:11], v[86:87], v[76:79]
    s_mov_b64 exec, -1
    ds_read_b64 v[68:69], v92 offset:65408
    v_and_b32 v46, 0x80000000, v21
    v_lshrrev_b32 v47, 14, v19
    v_bitop3_b32 v47, v47, v5, v46 bitop3:0xea
    ds_read_b64 v[106:107], v47
    v_bitop3_b32 v95, v19, v5, v46 bitop3:0xea
    v_and_b32 v46, 0x40000000, v21
    v_lshrrev_b32 v47, 14, v18
    v_bitop3_b32 v47, v47, v5, v46 bitop3:0xea
    ds_read_b64 v[104:105], v47
    v_bitop3_b32 v94, v18, v5, v46 bitop3:0xea
    s_waitcnt lgkmcnt(2)
    v_mfma_f32_4x4x4_16b_bf16 v[80:83], v[10:11], v[70:71], v[80:83]
    v_mfma_f32_4x4x4_16b_bf16 v[76:79], v[10:11], v[68:69], v[76:79]
    v_perm_b32 v15, v19, v20, s47
    v_bitop3_b32 v46, v19, 0.5, -0.5 bitop3:0xa8
    v_perm_b32 v14, v18, v20, s46
    v_bitop3_b32 v47, v18, 0.5, -0.5 bitop3:0xa8
    v_cvt_pk_bf16_f32 v80, v80, v81
    v_cvt_pk_bf16_f32 v81, v82, v83
    ds_wrxchg_rtn_b64 v[74:75], v93, v[80:81] offset:65408
    v_cvt_pk_bf16_f32 v76, v76, v77
    v_cvt_pk_bf16_f32 v77, v78, v79
    ds_wrxchg_rtn_b64 v[72:73], v92, v[76:77] offset:65408
    v_and_b32 v88, 0x0fffffff, v40
    v_mov_b32 v21, v40
    buffer_load_dwordx2 v[16:17], v88, s[8:11], 0 offen
    buffer_load_dwordx3 v[18:20], v88, s[8:11], 0 offen offset:8
    s_setprio 2
    s_waitcnt lgkmcnt(2)
    v_mfma_f32_4x4x4_16b_bf16 v[80:83], v[8:9], v[106:107], 0
    v_mfma_f32_4x4x4_16b_bf16 v[76:79], v[8:9], v[104:105], 0
    v_bitop3_b32 v15, v6, v15, v46 bitop3:0xca
    v_bitop3_b32 v14, v6, v14, v47 bitop3:0xca
    s_nop 1
    v_pk_mul_f32 v[80:81], v[80:81], v[14:15] op_sel:[0,1] op_sel_hi:[1,1]
    v_pk_mul_f32 v[82:83], v[82:83], v[14:15] op_sel:[0,1] op_sel_hi:[1,1]
    v_pk_mul_f32 v[76:77], v[76:77], v[14:15] op_sel:[0,0] op_sel_hi:[1,0]
    v_pk_mul_f32 v[78:79], v[78:79], v[14:15] op_sel:[0,0] op_sel_hi:[1,0]
    v_sub_u16 v88, v56, v48
    v_and_b32 v89, 3, v48
    v_add3_u32 v99, v88, v89, 3
    v_and_b32 v99, -4, v99
    v_max_u32 v99, 4, v99
    v_and_b32 v97, 0xfffc, v48
    v_bfm_b32 v96, v88, v89
    v_add_u32_dpp v91, v99, v99 row_shr:1 row_mask:0xf bank_mask:0xf bound_ctrl:1
    v_mad_u32_u24 v97, v97, 5, v2
    v_cmp_lt_u32 vcc, 16, v99
    v_add_u32_dpp v91, v91, v91 row_shr:2 row_mask:0xf bank_mask:0xf bound_ctrl:1
    v_sub_u32 v98, s38, v99
    v_lshrrev_b64 v[48:49], 16, v[48:49]
    v_add_u32_dpp v91, v91, v91 row_shr:4 row_mask:0xf bank_mask:0xf bound_ctrl:1
    v_lshrrev_b64 v[56:57], 16, v[56:57]
    s_mov_b32 s101, 0
    v_add_u32_dpp v91, v91, v91 row_shr:8 row_mask:0xf bank_mask:0xf bound_ctrl:1
    s_nop 1
    v_add_u32_dpp v91, v91, v91 row_bcast:15 row_mask:0xa bank_mask:0xf
    s_nop 1
    v_add_u32_dpp v91, v91, v91 row_bcast:31 row_mask:0xc bank_mask:0xf
    v_add_u32 v98, v98, v91
    v_readlane_b32 s37, v91, 63
    s_cbranch_vccnz L2_xo50
L2_xp50:
    s_waitcnt lgkmcnt(0)
    v_cmp_ne_u64 s[50:51], v[72:73], v[68:69]
    v_cmpx_ne_u64 s[54:55], v[74:75], v[70:71]
    s_and_b64 s[82:83], s[54:55], s[80:81]
    s_cbranch_scc1 L2_c51
L2_d51:
    v_mov_b64 v[84:85], v[70:71]
    v_mov_b32 v7, v93
    v_mov_b64 v[86:87], v[74:75]
    s_or_b64 s[80:81], s[80:81], s[54:55]
    s_mov_b64 exec, s[50:51]
    s_and_b64 s[82:83], s[50:51], s[80:81]
    s_cbranch_scc1 L2_c52
L2_d52:
    v_mov_b64 v[84:85], v[68:69]
    v_mov_b32 v7, v92
    v_mov_b64 v[86:87], v[72:73]
    s_mov_b64 exec, -1
    s_or_b64 s[80:81], s[80:81], s[50:51]
    ds_read_b64 v[70:71], v95 offset:65408
    ds_read_b64 v[68:69], v94 offset:65408
    s_waitcnt vmcnt(11)
    v_and_b32 v46, 0x20000000, v27
    v_lshrrev_b32 v47, 14, v23
    v_bitop3_b32 v47, v47, v5, v46 bitop3:0xea
    ds_read_b64 v[102:103], v47
    v_bitop3_b32 v93, v23, v5, v46 bitop3:0xea
    v_and_b32 v46, 0x10000000, v27
    v_lshrrev_b32 v47, 14, v22
    v_bitop3_b32 v47, v47, v5, v46 bitop3:0xea
    ds_read_b64 v[100:101], v47
    v_bitop3_b32 v92, v22, v5, v46 bitop3:0xea
    s_waitcnt lgkmcnt(2)
    v_mfma_f32_4x4x4_16b_bf16 v[80:83], v[10:11], v[70:71], v[80:83]
    v_mfma_f32_4x4x4_16b_bf16 v[76:79], v[10:11], v[68:69], v[76:79]
    v_perm_b32 v15, v23, v26, s45
    v_bitop3_b32 v46, v23, 0.5, -0.5 bitop3:0xa8
    v_perm_b32 v14, v22, v26, s44
    v_bitop3_b32 v47, v22, 0.5, -0.5 bitop3:0xa8
    v_cvt_pk_bf16_f32 v80, v80, v81
    v_cvt_pk_bf16_f32 v81, v82, v83
    ds_wrxchg_rtn_b64 v[74:75], v95, v[80:81] offset:65408
    v_cvt_pk_bf16_f32 v76, v76, v77
    v_cvt_pk_bf16_f32 v77, v78, v79
    ds_wrxchg_rtn_b64 v[72:73], v94, v[76:77] offset:65408
    s_waitcnt lgkmcnt(2)
    v_mfma_f32_4x4x4_16b_bf16 v[80:83], v[8:9], v[102:103], 0
    v_mfma_f32_4x4x4_16b_bf16 v[76:79], v[8:9], v[100:101], 0
    v_bitop3_b32 v15, v6, v15, v46 bitop3:0xca
    v_bitop3_b32 v14, v6, v14, v47 bitop3:0xca
    v_cmp_lt_u32 s[84:85], v5, v92
    s_nop 0
    v_pk_mul_f32 v[80:81], v[80:81], v[14:15] op_sel:[0,1] op_sel_hi:[1,1]
    v_pk_mul_f32 v[82:83], v[82:83], v[14:15] op_sel:[0,1] op_sel_hi:[1,1]
    v_pk_mul_f32 v[76:77], v[76:77], v[14:15] op_sel:[0,0] op_sel_hi:[1,0]
    v_pk_mul_f32 v[78:79], v[78:79], v[14:15] op_sel:[0,0] op_sel_hi:[1,0]
    s_waitcnt lgkmcnt(0)
    v_cmp_ne_u64 s[50:51], v[72:73], v[68:69]
    v_cmpx_ne_u64 s[54:55], v[74:75], v[70:71]
    s_and_b64 s[82:83], s[54:55], s[80:81]
    s_cbranch_scc1 L2_c53
L2_d53:
    v_mov_b64 v[84:85], v[70:71]
    v_mov_b32 v7, v95
    v_mov_b64 v[86:87], v[74:75]
    s_or_b64 s[80:81], s[80:81], s[54:55]
    s_mov_b64 exec, s[50:51]
    s_and_b64 s[82:83], s[50:51], s[80:81]
    s_cbranch_scc1 L2_c54
L2_d54:
    v_mov_b64 v[84:85], v[68:69]
    v_mov_b32 v7, v94
    v_mov_b64 v[86:87], v[72:73]
    s_mov_b64 exec, -1
    s_or_b64 s[80:81], s[80:81], s[50:51]
    ds_read_b64 v[70:71], v93 offset:65408
    s_and_b64 exec, s[84:85], s[80:81]
    v_mfma_f32_4x4x4_16b_bf16 v[76:79], v[12:13], v[84:85], 0
    v_mov_b32 v92, v7
    s_andn2_b64 s[80:81], s[80:81], s[84:85]
    v_mfma_f32_4x4x4_16b_bf16 v[76:79], v[10:11], v[86:87], v[76:79]
    s_mov_b64 exec, -1
    ds_read_b64 v[68:69], v92 offset:65408
    v_and_b32 v46, 0x80000000, v27
    v_lshrrev_b32 v47, 14, v25
    v_bitop3_b32 v47, v47, v5, v46 bitop3:0xea
    ds_read_b64 v[106:107], v47
    v_bitop3_b32 v95, v25, v5, v46 bitop3:0xea
    v_and_b32 v46, 0x40000000, v27
    v_lshrrev_b32 v47, 14, v24
    v_bitop3_b32 v47, v47, v5, v46 bitop3:0xea
    ds_read_b64 v[104:105], v47
    v_bitop3_b32 v94, v24, v5, v46 bitop3:0xea
    s_waitcnt lgkmcnt(2)
    v_mfma_f32_4x4x4_16b_bf16 v[80:83], v[10:11], v[70:71], v[80:83]
    v_mfma_f32_4x4x4_16b_bf16 v[76:79], v[10:11], v[68:69], v[76:79]
    v_perm_b32 v15, v25, v26, s47
    v_bitop3_b32 v46, v25, 0.5, -0.5 bitop3:0xa8
    v_perm_b32 v14, v24, v26, s46
    v_bitop3_b32 v47, v24, 0.5, -0.5 bitop3:0xa8
    v_cvt_pk_bf16_f32 v80, v80, v81
    v_cvt_pk_bf16_f32 v81, v82, v83
    ds_wrxchg_rtn_b64 v[74:75], v93, v[80:81] offset:65408
    v_cvt_pk_bf16_f32 v76, v76, v77
    v_cvt_pk_bf16_f32 v77, v78, v79
    ds_wrxchg_rtn_b64 v[72:73], v92, v[76:77] offset:65408
    v_and_b32 v88, 0x0fffffff, v41
    v_mov_b32 v27, v41
    buffer_load_dwordx2 v[22:23], v88, s[8:11], 0 offen
    buffer_load_dwordx3 v[24:26], v88, s[8:11], 0 offen offset:8
    s_setprio 1
    s_waitcnt lgkmcnt(2)
    v_mfma_f32_4x4x4_16b_bf16 v[80:83], v[8:9], v[106:107], 0
    v_mfma_f32_4x4x4_16b_bf16 v[76:79], v[8:9], v[104:105], 0
    v_bitop3_b32 v15, v6, v15, v46 bitop3:0xca
    v_bitop3_b32 v14, v6, v14, v47 bitop3:0xca
    s_nop 1
    v_pk_mul_f32 v[80:81], v[80:81], v[14:15] op_sel:[0,1] op_sel_hi:[1,1]
    v_pk_mul_f32 v[82:83], v[82:83], v[14:15] op_sel:[0,1] op_sel_hi:[1,1]
    v_pk_mul_f32 v[76:77], v[76:77], v[14:15] op_sel:[0,0] op_sel_hi:[1,0]
    v_pk_mul_f32 v[78:79], v[78:79], v[14:15] op_sel:[0,0] op_sel_hi:[1,0]
    s_waitcnt lgkmcnt(0)
    v_cmp_ne_u64 s[50:51], v[72:73], v[68:69]
    v_cmpx_ne_u64 s[54:55], v[74:75], v[70:71]
    s_and_b64 s[82:83], s[54:55], s[80:81]
    s_cbranch_scc1 L2_c55
L2_d55:
    v_mov_b64 v[84:85], v[70:71]
    v_mov_b32 v7, v93
    v_mov_b64 v[86:87], v[74:75]
    s_or_b64 s[80:81], s[80:81], s[54:55]
    s_mov_b64 exec, s[50:51]
    s_and_b64 s[82:83], s[50:51], s[80:81]
    s_cbranch_scc1 L2_c56
L2_d56:
    v_mov_b64 v[84:85], v[68:69]
    v_mov_b32 v7, v92
    v_mov_b64 v[86:87], v[72:73]
    s_mov_b64 exec, -1
    s_or_b64 s[80:81], s[80:81], s[50:51]
    ds_read_b64 v[70:71], v95 offset:65408
    ds_read_b64 v[68:69], v94 offset:65408
    s_waitcnt vmcnt(11)
    v_and_b32 v46, 0x20000000, v33
    v_lshrrev_b32 v47, 14, v29
    v_bitop3_b32 v47, v47, v5, v46 bitop3:0xea
    ds_read_b64 v[102:103], v47
    v_bitop3_b32 v93, v29, v5, v46 bitop3:0xea
    v_and_b32 v46, 0x10000000, v33
    v_lshrrev_b32 v47, 14, v28
    v_bitop3_b32 v47, v47, v5, v46 bitop3:0xea
    ds_read_b64 v[100:101], v47
    v_bitop3_b32 v92, v28, v5, v46 bitop3:0xea
    s_waitcnt lgkmcnt(2)
    v_mfma_f32_4x4x4_16b_bf16 v[80:83], v[10:11], v[70:71], v[80:83]
    v_mfma_f32_4x4x4_16b_bf16 v[76:79], v[10:11], v[68:69], v[76:79]
    v_perm_b32 v15, v29, v32, s45
    v_bitop3_b32 v46, v29, 0.5, -0.5 bitop3:0xa8
    v_perm_b32 v14, v28, v32, s44
    v_bitop3_b32 v47, v28, 0.5, -0.5 bitop3:0xa8
    v_cvt_pk_bf16_f32 v80, v80, v81
    v_cvt_pk_bf16_f32 v81, v82, v83
    ds_wrxchg_rtn_b64 v[74:75], v95, v[80:81] offset:65408
    v_cvt_pk_bf16_f32 v76, v76, v77
    v_cvt_pk_bf16_f32 v77, v78, v79
    ds_wrxchg_rtn_b64 v[72:73], v94, v[76:77] offset:65408
    s_waitcnt lgkmcnt(2)
    v_mfma_f32_4x4x4_16b_bf16 v[80:83], v[8:9], v[102:103], 0
    v_mfma_f32_4x4x4_16b_bf16 v[76:79], v[8:9], v[100:101], 0
    v_bitop3_b32 v15, v6, v15, v46 bitop3:0xca
    v_bitop3_b32 v14, v6, v14, v47 bitop3:0xca
    v_cmp_lt_u32 s[84:85], v5, v92
    s_nop 0
    v_pk_mul_f32 v[80:81], v[80:81], v[14:15] op_sel:[0,1] op_sel_hi:[1,1]
    v_pk_mul_f32 v[82:83], v[82:83], v[14:15] op_sel:[0,1] op_sel_hi:[1,1]
    v_pk_mul_f32 v[76:77], v[76:77], v[14:15] op_sel:[0,0] op_sel_hi:[1,0]
    v_pk_mul_f32 v[78:79], v[78:79], v[14:15] op_sel:[0,0] op_sel_hi:[1,0]
    s_waitcnt lgkmcnt(0)
    v_cmp_ne_u64 s[50:51], v[72:73], v[68:69]
    v_cmpx_ne_u64 s[54:55], v[74:75], v[70:71]
    s_and_b64 s[82:83], s[54:55], s[80:81]
    s_cbranch_scc1 L2_c57
L2_d57:
    v_mov_b64 v[84:85], v[70:71]
    v_mov_b32 v7, v95
    v_mov_b64 v[86:87], v[74:75]
    s_or_b64 s[80:81], s[80:81], s[54:55]
    s_mov_b64 exec, s[50:51]
    s_and_b64 s[82:83], s[50:51], s[80:81]
    s_cbranch_scc1 L2_c58
L2_d58:
    v_mov_b64 v[84:85], v[68:69]
    v_mov_b32 v7, v94
    v_mov_b64 v[86:87], v[72:73]
    s_mov_b64 exec, -1
    s_or_b64 s[80:81], s[80:81], s[50:51]
    ds_read_b64 v[70:71], v93 offset:65408
    s_and_b64 exec, s[84:85], s[80:81]
    v_mfma_f32_4x4x4_16b_bf16 v[76:79], v[12:13], v[84:85], 0
    v_mov_b32 v92, v7
    s_andn2_b64 s[80:81], s[80:81], s[84:85]
    v_mfma_f32_4x4x4_16b_bf16 v[76:79], v[10:11], v[86:87], v[76:79]
    s_mov_b64 exec, -1
    ds_read_b64 v[68:69], v92 offset:65408
    v_and_b32 v46, 0x80000000, v33
    v_lshrrev_b32 v47, 14, v31
    v_bitop3_b32 v47, v47, v5, v46 bitop3:0xea
    ds_read_b64 v[106:107], v47
    v_bitop3_b32 v95, v31, v5, v46 bitop3:0xea
    v_and_b32 v46, 0x40000000, v33
    v_lshrrev_b32 v47, 14, v30
    v_bitop3_b32 v47, v47, v5, v46 bitop3:0xea
    ds_read_b64 v[104:105], v47
    v_bitop3_b32 v94, v30, v5, v46 bitop3:0xea
    s_waitcnt lgkmcnt(2)
    v_mfma_f32_4x4x4_16b_bf16 v[80:83], v[10:11], v[70:71], v[80:83]
    v_mfma_f32_4x4x4_16b_bf16 v[76:79], v[10:11], v[68:69], v[76:79]
    v_perm_b32 v15, v31, v32, s47
    v_bitop3_b32 v46, v31, 0.5, -0.5 bitop3:0xa8
    v_perm_b32 v14, v30, v32, s46
    v_bitop3_b32 v47, v30, 0.5, -0.5 bitop3:0xa8
    v_cvt_pk_bf16_f32 v80, v80, v81
    v_cvt_pk_bf16_f32 v81, v82, v83
    ds_wrxchg_rtn_b64 v[74:75], v93, v[80:81] offset:65408
    v_cvt_pk_bf16_f32 v76, v76, v77
    v_cvt_pk_bf16_f32 v77, v78, v79
    ds_wrxchg_rtn_b64 v[72:73], v92, v[76:77] offset:65408
    v_and_b32 v88, 0x0fffffff, v42
    v_mov_b32 v33, v42
    buffer_load_dwordx2 v[28:29], v88, s[8:11], 0 offen
    buffer_load_dwordx3 v[30:32], v88, s[8:11], 0 offen offset:8
    s_setprio 0
    s_waitcnt lgkmcnt(2)
    v_mfma_f32_4x4x4_16b_bf16 v[80:83], v[8:9], v[106:107], 0
    v_mfma_f32_4x4x4_16b_bf16 v[76:79], v[8:9], v[104:105], 0
    v_bitop3_b32 v15, v6, v15, v46 bitop3:0xca
    v_bitop3_b32 v14, v6, v14, v47 bitop3:0xca
    s_nop 1
    v_pk_mul_f32 v[80:81], v[80:81], v[14:15] op_sel:[0,1] op_sel_hi:[1,1]
    v_pk_mul_f32 v[82:83], v[82:83], v[14:15] op_sel:[0,1] op_sel_hi:[1,1]
    v_pk_mul_f32 v[76:77], v[76:77], v[14:15] op_sel:[0,0] op_sel_hi:[1,0]
    v_pk_mul_f32 v[78:79], v[78:79], v[14:15] op_sel:[0,0] op_sel_hi:[1,0]
    s_add_u32 s40, s40, 0xfff24000
    s_waitcnt lgkmcnt(0)
    v_cmp_ne_u64 s[50:51], v[72:73], v[68:69]
    v_cmpx_ne_u64 s[54:55], v[74:75], v[70:71]
    s_and_b64 s[82:83], s[54:55], s[80:81]
    s_cbranch_scc1 L2_c59
L2_d59:
    v_mov_b64 v[84:85], v[70:71]
    v_mov_b32 v7, v93
    v_mov_b64 v[86:87], v[74:75]
    s_or_b64 s[80:81], s[80:81], s[54:55]
    s_mov_b64 exec, s[50:51]
    s_and_b64 s[82:83], s[50:51], s[80:81]
    s_cbranch_scc1 L2_c60
L2_d60:
    v_mov_b64 v[84:85], v[68:69]
    v_mov_b32 v7, v92
    v_mov_b64 v[86:87], v[72:73]
    s_mov_b64 exec, -1
    s_or_b64 s[80:81], s[80:81], s[50:51]
    ds_read_b64 v[70:71], v95 offset:65408
    ds_read_b64 v[68:69], v94 offset:65408
    s_waitcnt vmcnt(8)
    v_and_b32 v46, 0x20000000, v39
    v_lshrrev_b32 v47, 14, v35
    v_bitop3_b32 v47, v47, v5, v46 bitop3:0xea
    ds_read_b64 v[102:103], v47
    v_bitop3_b32 v93, v35, v5, v46 bitop3:0xea
    v_and_b32 v46, 0x10000000, v39
    v_lshrrev_b32 v47, 14, v34
    v_bitop3_b32 v47, v47, v5, v46 bitop3:0xea
    ds_read_b64 v[100:101], v47
    v_bitop3_b32 v92, v34, v5, v46 bitop3:0xea
    v_and_b32 v46, 0x80000000, v39
    v_lshrrev_b32 v47, 14, v37
    v_bitop3_b32 v47, v47, v5, v46 bitop3:0xea
    ds_read_b64 v[106:107], v47
    v_and_b32 v46, 0x40000000, v39
    v_lshrrev_b32 v47, 14, v36
    v_bitop3_b32 v47, v47, v5, v46 bitop3:0xea
    ds_read_b64 v[104:105], v47
    s_waitcnt lgkmcnt(4)
    v_mfma_f32_4x4x4_16b_bf16 v[80:83], v[10:11], v[70:71], v[80:83]
    v_mfma_f32_4x4x4_16b_bf16 v[76:79], v[10:11], v[68:69], v[76:79]
    v_perm_b32 v15, v35, v38, s45
    v_bitop3_b32 v46, v35, 0.5, -0.5 bitop3:0xa8
    v_perm_b32 v14, v34, v38, s44
    v_bitop3_b32 v47, v34, 0.5, -0.5 bitop3:0xa8
    v_cvt_pk_bf16_f32 v80, v80, v81
    v_cvt_pk_bf16_f32 v81, v82, v83
    ds_wrxchg_rtn_b64 v[74:75], v95, v[80:81] offset:65408
    v_cvt_pk_bf16_f32 v76, v76, v77
    v_cvt_pk_bf16_f32 v77, v78, v79
    ds_wrxchg_rtn_b64 v[72:73], v94, v[76:77] offset:65408
    s_waitcnt lgkmcnt(2)
    s_barrier
    s_setprio 3
    s_mov_b32 m0, s100
    s_nop 0
    ds_write_addtid_b32 v116 offset:32768
    ds_write_addtid_b32 v117 offset:33024
    ds_write_addtid_b32 v118 offset:33280
    ds_write_addtid_b32 v119 offset:33536
    buffer_load_dwordx4 v[116:119], v3, s[16:19], s40 offen offset:2048
    ds_write_addtid_b32 v120 offset:33792
    ds_write_addtid_b32 v121 offset:34048
    ds_write_addtid_b32 v122 offset:34304
    ds_write_addtid_b32 v123 offset:34560
    buffer_load_dwordx4 v[120:123], v3, s[16:19], s40 offen offset:3072
    v_mfma_f32_4x4x4_16b_bf16 v[80:83], v[8:9], v[102:103], 0
    v_mfma_f32_4x4x4_16b_bf16 v[76:79], v[8:9], v[100:101], 0
    v_bitop3_b32 v15, v6, v15, v46 bitop3:0xca
    v_bitop3_b32 v14, v6, v14, v47 bitop3:0xca
    v_cmp_lt_u32 s[84:85], v5, v92
    s_nop 0
    v_pk_mul_f32 v[80:81], v[80:81], v[14:15] op_sel:[0,1] op_sel_hi:[1,1]
    v_pk_mul_f32 v[82:83], v[82:83], v[14:15] op_sel:[0,1] op_sel_hi:[1,1]
    v_pk_mul_f32 v[76:77], v[76:77], v[14:15] op_sel:[0,0] op_sel_hi:[1,0]
    v_pk_mul_f32 v[78:79], v[78:79], v[14:15] op_sel:[0,0] op_sel_hi:[1,0]
    v_mov_b32 v44, v43
    s_cmp_gt_u32 s37, 1024
    s_cbranch_scc1 L2_xs61
    s_cmp_lg_u32 s101, 0
    s_cbranch_scc1 L2_xa61
L2_xb61:
    v_lshlrev_b32 v89, 16, v96
    v_add_u32 v90, 60, v97
    v_bitop3_b32 v90, v89, v45, v90 bitop3:0x6a
    ds_write_b32 v98, v90 offset:12
    v_lshlrev_b32 v89, 20, v96
    v_add_u32 v90, 40, v97
    v_bitop3_b32 v90, v89, v45, v90 bitop3:0x6a
    ds_write_b32 v98, v90 offset:8
    v_lshlrev_b32 v89, 24, v96
    v_add_u32 v90, 20, v97
    v_bitop3_b32 v90, v89, v45, v90 bitop3:0x6a
    ds_write_b32 v98, v90 offset:4
    v_lshlrev_b32 v89, 28, v96
    v_bitop3_b32 v90, v89, v45, v97 bitop3:0x6a
    ds_write_b32 v98, v90 offset:0
    v_mov_b32_dpp v91, v64 quad_perm:[0,0,0,0] row_mask:0xf bank_mask:0xf
    v_and_b32 v89, 3, v91
    v_and_b32 v97, 0xfffc, v91
    v_sub_u16_dpp v88, v64, v91 quad_perm:[2,2,2,2] row_mask:0xf bank_mask:0xf
    v_mad_u32_u24 v97, v97, 5, v4
    v_add_u32 v99, v88, v89
    v_bfm_b32 v96, v88, v89
    v_cmp_lt_u32 s[58:59], 16, v99
    v_lshlrev_b32 v89, v1, v96
    v_and_b32 v89, v45, v89
    v_cmp_ne_u32 vcc, 0, v89
    v_xor_b32 v90, v97, v89
    s_add_u32 s3, s37, s38
    v_mbcnt_lo_u32_b32 v98, vcc_lo, 0
    v_mbcnt_hi_u32_b32 v98, vcc_hi, v98
    s_bcnt1_i32_b64 s41, vcc
    v_lshl_add_u32 v98, v98, 2, s3
    s_mov_b64 exec, vcc
    ds_write_b32 v98, v90
    s_mov_b64 exec, -1
    s_lshl2_add_u32 s37, s41, s37
    s_cmp_lg_u64 s[58:59], 0
    s_cbranch_scc1 L2_xe61
L2_xr61:
    v_add_u32 v98, s37, v0
    v_mov_b32 v90, -1
    ds_write_b32 v98, v90
    ds_read2st64_b32 v[40:41], v0 offset0:0 offset1:1
    ds_read2st64_b32 v[42:43], v0 offset0:2 offset1:3
    s_sub_u32 s3, s37, 768
    s_cmp_gt_u32 s3, 256
    s_cbranch_scc1 L2_xf61
L2_xg61:
    s_setprio 2
    ds_write_addtid_b32 v124 offset:34816
    ds_write_addtid_b32 v125 offset:35072
    ds_write_addtid_b32 v126 offset:35328
    ds_write_addtid_b32 v127 offset:35584
    s_add_u32 s3, s40, 4096
    buffer_load_dwordx4 v[124:127], v3, s[16:19], s3 offen
    s_waitcnt lgkmcnt(14)
    v_cmp_ne_u64 s[50:51], v[72:73], v[68:69]
    v_cmpx_ne_u64 s[54:55], v[74:75], v[70:71]
    s_and_b64 s[82:83], s[54:55], s[80:81]
    s_cbranch_scc1 L2_c62
L2_d62:
    v_mov_b64 v[84:85], v[70:71]
    v_mov_b32 v7, v95
    v_mov_b64 v[86:87], v[74:75]
    s_or_b64 s[80:81], s[80:81], s[54:55]
    s_mov_b64 exec, s[50:51]
    s_and_b64 s[82:83], s[50:51], s[80:81]
    s_cbranch_scc1 L2_c63
L2_d63:
    v_mov_b64 v[84:85], v[68:69]
    v_mov_b32 v7, v94
    v_mov_b64 v[86:87], v[72:73]
    s_mov_b64 exec, -1
    s_or_b64 s[80:81], s[80:81], s[50:51]
    ds_read_b64 v[70:71], v93 offset:65408
    s_and_b64 exec, s[84:85], s[80:81]
    v_mfma_f32_4x4x4_16b_bf16 v[76:79], v[12:13], v[84:85], 0
    v_mov_b32 v92, v7
    s_andn2_b64 s[80:81], s[80:81], s[84:85]
    v_mfma_f32_4x4x4_16b_bf16 v[76:79], v[10:11], v[86:87], v[76:79]
    s_mov_b64 exec, -1
    ds_read_b64 v[68:69], v92 offset:65408
    s_setprio 1
    s_waitcnt vmcnt(10)
    s_mov_b32 m0, s38
    s_nop 0
    ds_write_addtid_b32 v108 offset:0
    ds_write_addtid_b32 v109 offset:256
    ds_write_addtid_b32 v110 offset:512
    ds_write_addtid_b32 v111 offset:768
    s_waitcnt lgkmcnt(4)
    v_mfma_f32_4x4x4_16b_bf16 v[80:83], v[10:11], v[70:71], v[80:83]
    v_mfma_f32_4x4x4_16b_bf16 v[76:79], v[10:11], v[68:69], v[76:79]
    v_and_b32 v46, 0x40000000, v39
    v_bitop3_b32 v94, v36, v5, v46 bitop3:0xea
    v_and_b32 v46, 0x80000000, v39
    v_bitop3_b32 v95, v37, v5, v46 bitop3:0xea
    v_perm_b32 v15, v37, v38, s47
    v_bitop3_b32 v46, v37, 0.5, -0.5 bitop3:0xa8
    v_perm_b32 v14, v36, v38, s46
    v_bitop3_b32 v47, v36, 0.5, -0.5 bitop3:0xa8
    v_cvt_pk_bf16_f32 v80, v80, v81
    v_cvt_pk_bf16_f32 v81, v82, v83
    ds_wrxchg_rtn_b64 v[74:75], v93, v[80:81] offset:65408
    v_cvt_pk_bf16_f32 v76, v76, v77
    v_cvt_pk_bf16_f32 v77, v78, v79
    ds_wrxchg_rtn_b64 v[72:73], v92, v[76:77] offset:65408
    v_and_b32 v88, 0x0fffffff, v44
    v_mov_b32 v39, v44
    buffer_load_dwordx2 v[34:35], v88, s[8:11], 0 offen
    buffer_load_dwordx3 v[36:38], v88, s[8:11], 0 offen offset:8
    s_setprio 0
    s_waitcnt vmcnt(11)
    ds_write_addtid_b32 v112 offset:1024
    ds_write_addtid_b32 v113 offset:1280
    ds_write_addtid_b32 v114 offset:1536
    ds_write_addtid_b32 v115 offset:1792
    v_mfma_f32_4x4x4_16b_bf16 v[80:83], v[8:9], v[106:107], 0
    v_mfma_f32_4x4x4_16b_bf16 v[76:79], v[8:9], v[104:105], 0
    v_bitop3_b32 v15, v6, v15, v46 bitop3:0xca
    v_bitop3_b32 v14, v6, v14, v47 bitop3:0xca
    s_nop 1
    v_pk_mul_f32 v[80:81], v[80:81], v[14:15] op_sel:[0,1] op_sel_hi:[1,1]
    v_pk_mul_f32 v[82:83], v[82:83], v[14:15] op_sel:[0,1] op_sel_hi:[1,1]
    v_pk_mul_f32 v[76:77], v[76:77], v[14:15] op_sel:[0,0] op_sel_hi:[1,0]
    v_pk_mul_f32 v[78:79], v[78:79], v[14:15] op_sel:[0,0] op_sel_hi:[1,0]
    s_add_u32 s42, s42, 1
    s_waitcnt lgkmcnt(0)
    s_barrier
    s_bitcmp1_b32 s36, s42
    s_cbranch_scc1 L2_slow
L2_ret3:
    s_setprio 3
    buffer_load_dwordx4 v[108:111], v3, s[16:19], s40 offen offset:0
    v_cmp_ne_u64 s[50:51], v[72:73], v[68:69]
    v_cmpx_ne_u64 s[54:55], v[74:75], v[70:71]
    s_and_b64 s[82:83], s[54:55], s[80:81]
    s_cbranch_scc1 L2_c64
L2_d64:
    v_mov_b64 v[84:85], v[70:71]
    v_mov_b32 v7, v93
    v_mov_b64 v[86:87], v[74:75]
    s_or_b64 s[80:81], s[80:81], s[54:55]
    s_mov_b64 exec, s[50:51]
    s_and_b64 s[82:83], s[50:51], s[80:81]
    s_cbranch_scc1 L2_c65
L2_d65:
    v_mov_b64 v[84:85], v[68:69]
    v_mov_b32 v7, v92
    v_mov_b64 v[86:87], v[72:73]
    s_mov_b64 exec, -1
    s_or_b64 s[80:81], s[80:81], s[50:51]
    ds_read_b64 v[70:71], v95 offset:65408
    ds_read_b64 v[68:69], v94 offset:65408
    s_waitcnt vmcnt(10)
    v_and_b32 v46, 0x20000000, v21
    v_lshrrev_b32 v47, 14, v17
    v_bitop3_b32 v47, v47, v5, v46 bitop3:0xea
    ds_read_b64 v[102:103], v47
    v_bitop3_b32 v93, v17, v5, v46 bitop3:0xea
    v_and_b32 v46, 0x10000000, v21
    v_lshrrev_b32 v47, 14, v16
    v_bitop3_b32 v47, v47, v5, v46 bitop3:0xea
    ds_read_b64 v[100:101], v47
    v_bitop3_b32 v92, v16, v5, v46 bitop3:0xea
    s_waitcnt lgkmcnt(2)
    v_mfma_f32_4x4x4_16b_bf16 v[80:83], v[10:11], v[70:71], v[80:83]
    v_mfma_f32_4x4x4_16b_bf16 v[76:79], v[10:11], v[68:69], v[76:79]
    v_perm_b32 v15, v17, v20, s45
    v_bitop3_b32 v46, v17, 0.5, -0.5 bitop3:0xa8
    v_perm_b32 v14, v16, v20, s44
    v_bitop3_b32 v47, v16, 0.5, -0.5 bitop3:0xa8
    v_cvt_pk_bf16_f32 v80, v80, v81
    v_cvt_pk_bf16_f32 v81, v82, v83
    ds_wrxchg_rtn_b64 v[74:75], v95, v[80:81] offset:65408
    v_cvt_pk_bf16_f32 v76, v76, v77
    v_cvt_pk_bf16_f32 v77, v78, v79
    ds_wrxchg_rtn_b64 v[72:73], v94, v[76:77] offset:65408
    s_waitcnt lgkmcnt(2)
    v_mfma_f32_4x4x4_16b_bf16 v[80:83], v[8:9], v[102:103], 0
    v_mfma_f32_4x4x4_16b_bf16 v[76:79], v[8:9], v[100:101], 0
    v_bitop3_b32 v15, v6, v15, v46 bitop3:0xca
    v_bitop3_b32 v14, v6, v14, v47 bitop3:0xca
    v_cmp_lt_u32 s[84:85], v5, v92
    s_nop 0
    v_pk_mul_f32 v[80:81], v[80:81], v[14:15] op_sel:[0,1] op_sel_hi:[1,1]
    v_pk_mul_f32 v[82:83], v[82:83], v[14:15] op_sel:[0,1] op_sel_hi:[1,1]
    v_pk_mul_f32 v[76:77], v[76:77], v[14:15] op_sel:[0,0] op_sel_hi:[1,0]
    v_pk_mul_f32 v[78:79], v[78:79], v[14:15] op_sel:[0,0] op_sel_hi:[1,0]
    buffer_load_dwordx4 v[112:115], v3, s[16:19], s40 offen offset:1024
    s_waitcnt lgkmcnt(0)
    v_cmp_ne_u64 s[50:51], v[72:73], v[68:69]
    v_cmpx_ne_u64 s[54:55], v[74:75], v[70:71]
    s_and_b64 s[82:83], s[54:55], s[80:81]
    s_cbranch_scc1 L2_c66
L2_d66:
    v_mov_b64 v[84:85], v[70:71]
    v_mov_b32 v7, v95
    v_mov_b64 v[86:87], v[74:75]
    s_or_b64 s[80:81], s[80:81], s[54:55]
    s_mov_b64 exec, s[50:51]
    s_and_b64 s[82:83], s[50:51], s[80:81]
    s_cbranch_scc1 L2_c67
L2_d67:
    v_mov_b64 v[84:85], v[68:69]
    v_mov_b32 v7, v94
    v_mov_b64 v[86:87], v[72:73]
    s_mov_b64 exec, -1
    s_or_b64 s[80:81], s[80:81], s[50:51]
    ds_read_b64 v[70:71], v93 offset:65408
    s_and_b64 exec, s[84:85], s[80:81]
    v_mfma_f32_4x4x4_16b_bf16 v[76:79], v[12:13], v[84:85], 0
    v_mov_b32 v92, v7
    s_andn2_b64 s[80:81], s[80:81], s[84:85]
    v_mfma_f32_4x4x4_16b_bf16 v[76:79], v[10:11], v[86:87], v[76:79]
    s_mov_b64 exec, -1
    ds_read_b64 v[68:69], v92 offset:65408
    v_and_b32 v46, 0x80000000, v21
    v_lshrrev_b32 v47, 14, v19
    v_bitop3_b32 v47, v47, v5, v46 bitop3:0xea
    ds_read_b64 v[106:107], v47
    v_bitop3_b32 v95, v19, v5, v46 bitop3:0xea
    v_and_b32 v46, 0x40000000, v21
    v_lshrrev_b32 v47, 14, v18
    v_bitop3_b32 v47, v47, v5, v46 bitop3:0xea
    ds_read_b64 v[104:105], v47
    v_bitop3_b32 v94, v18, v5, v46 bitop3:0xea
    s_waitcnt lgkmcnt(2)
    v_mfma_f32_4x4x4_16b_bf16 v[80:83], v[10:11], v[70:71], v[80:83]
    v_mfma_f32_4x4x4_16b_bf16 v[76:79], v[10:11], v[68:69], v[76:79]
    v_perm_b32 v15, v19, v20, s47
    v_bitop3_b32 v46, v19, 0.5, -0.5 bitop3:0xa8
    v_perm_b32 v14, v18, v20, s46
    v_bitop3_b32 v47, v18, 0.5, -0.5 bitop3:0xa8
    v_cvt_pk_bf16_f32 v80, v80, v81
    v_cvt_pk_bf16_f32 v81, v82, v83
    ds_wrxchg_rtn_b64 v[74:75], v93, v[80:81] offset:65408
    v_cvt_pk_bf16_f32 v76, v76, v77
    v_cvt_pk_bf16_f32 v77, v78, v79
    ds_wrxchg_rtn_b64 v[72:73], v92, v[76:77] offset:65408
    v_and_b32 v88, 0x0fffffff, v40
    v_mov_b32 v21, v40
    buffer_load_dwordx2 v[16:17], v88, s[8:11], 0 offen
    buffer_load_dwordx3 v[18:20], v88, s[8:11], 0 offen offset:8
    s_setprio 2
    s_waitcnt lgkmcnt(2)
    v_mfma_f32_4x4x4_16b_bf16 v[80:83], v[8:9], v[106:107], 0
    v_mfma_f32_4x4x4_16b_bf16 v[76:79], v[8:9], v[104:105], 0
    v_bitop3_b32 v15, v6, v15, v46 bitop3:0xca
    v_bitop3_b32 v14, v6, v14, v47 bitop3:0xca
    s_nop 1
    v_pk_mul_f32 v[80:81], v[80:81], v[14:15] op_sel:[0,1] op_sel_hi:[1,1]
    v_pk_mul_f32 v[82:83], v[82:83], v[14:15] op_sel:[0,1] op_sel_hi:[1,1]
    v_pk_mul_f32 v[76:77], v[76:77], v[14:15] op_sel:[0,0] op_sel_hi:[1,0]
    v_pk_mul_f32 v[78:79], v[78:79], v[14:15] op_sel:[0,0] op_sel_hi:[1,0]
    v_sub_u16 v88, v58, v50
    v_and_b32 v89, 3, v50
    v_add3_u32 v99, v88, v89, 3
    v_and_b32 v99, -4, v99
    v_max_u32 v99, 4, v99
    v_and_b32 v97, 0xfffc, v50
    v_bfm_b32 v96, v88, v89
    v_add_u32_dpp v91, v99, v99 row_shr:1 row_mask:0xf bank_mask:0xf bound_ctrl:1
    v_mad_u32_u24 v97, v97, 5, v2
    v_cmp_lt_u32 vcc, 16, v99
    v_add_u32_dpp v91, v91, v91 row_shr:2 row_mask:0xf bank_mask:0xf bound_ctrl:1
    v_sub_u32 v98, s38, v99
    v_lshrrev_b64 v[50:51], 16, v[50:51]
    v_add_u32_dpp v91, v91, v91 row_shr:4 row_mask:0xf bank_mask:0xf bound_ctrl:1
    v_lshrrev_b64 v[58:59], 16, v[58:59]
    s_mov_b32 s101, 0
    v_add_u32_dpp v91, v91, v91 row_shr:8 row_mask:0xf bank_mask:0xf bound_ctrl:1
    s_nop 1
    v_add_u32_dpp v91, v91, v91 row_bcast:15 row_mask:0xa bank_mask:0xf
    s_nop 1
    v_add_u32_dpp v91, v91, v91 row_bcast:31 row_mask:0xc bank_mask:0xf
    v_add_u32 v98, v98, v91
    v_readlane_b32 s37, v91, 63
    s_cbranch_vccnz L2_xo68
L2_xp68:
    s_waitcnt lgkmcnt(0)
    v_cmp_ne_u64 s[50:51], v[72:73], v[68:69]
    v_cmpx_ne_u64 s[54:55], v[74:75], v[70:71]
    s_and_b64 s[82:83], s[54:55], s[80:81]
    s_cbranch_scc1 L2_c69
L2_d69:
    v_mov_b64 v[84:85], v[70:71]
    v_mov_b32 v7, v93
    v_mov_b64 v[86:87], v[74:75]
    s_or_b64 s[80:81], s[80:81], s[54:55]
    s_mov_b64 exec, s[50:51]
    s_and_b64 s[82:83], s[50:51], s[80:81]
    s_cbranch_scc1 L2_c70
L2_d70:
    v_mov_b64 v[84:85], v[68:69]
    v_mov_b32 v7, v92
    v_mov_b64 v[86:87], v[72:73]
    s_mov_b64 exec, -1
    s_or_b64 s[80:81], s[80:81], s[50:51]
    ds_read_b64 v[70:71], v95 offset:65408
    ds_read_b64 v[68:69], v94 offset:65408
    s_waitcnt vmcnt(11)
    v_and_b32 v46, 0x20000000, v27
    v_lshrrev_b32 v47, 14, v23
    v_bitop3_b32 v47, v47, v5, v46 bitop3:0xea
    ds_read_b64 v[102:103], v47
    v_bitop3_b32 v93, v23, v5, v46 bitop3:0xea
    v_and_b32 v46, 0x10000000, v27
    v_lshrrev_b32 v47, 14, v22
    v_bitop3_b32 v47, v47, v5, v46 bitop3:0xea
    ds_read_b64 v[100:101], v47
    v_bitop3_b32 v92, v22, v5, v46 bitop3:0xea
    s_waitcnt lgkmcnt(2)
    v_mfma_f32_4x4x4_16b_bf16 v[80:83], v[10:11], v[70:71], v[80:83]
    v_mfma_f32_4x4x4_16b_bf16 v[76:79], v[10:11], v[68:69], v[76:79]
    v_perm_b32 v15, v23, v26, s45
    v_bitop3_b32 v46, v23, 0.5, -0.5 bitop3:0xa8
    v_perm_b32 v14, v22, v26, s44
    v_bitop3_b32 v47, v22, 0.5, -0.5 bitop3:0xa8
    v_cvt_pk_bf16_f32 v80, v80, v81
    v_cvt_pk_bf16_f32 v81, v82, v83
    ds_wrxchg_rtn_b64 v[74:75], v95, v[80:81] offset:65408
    v_cvt_pk_bf16_f32 v76, v76, v77
    v_cvt_pk_bf16_f32 v77, v78, v79
    ds_wrxchg_rtn_b64 v[72:73], v94, v[76:77] offset:65408
    s_waitcnt lgkmcnt(2)
    v_mfma_f32_4x4x4_16b_bf16 v[80:83], v[8:9], v[102:103], 0
    v_mfma_f32_4x4x4_16b_bf16 v[76:79], v[8:9], v[100:101], 0
    v_bitop3_b32 v15, v6, v15, v46 bitop3:0xca
    v_bitop3_b32 v14, v6, v14, v47 bitop3:0xca
    v_cmp_lt_u32 s[84:85], v5, v92
    s_nop 0
    v_pk_mul_f32 v[80:81], v[80:81], v[14:15] op_sel:[0,1] op_sel_hi:[1,1]
    v_pk_mul_f32 v[82:83], v[82:83], v[14:15] op_sel:[0,1] op_sel_hi:[1,1]
    v_pk_mul_f32 v[76:77], v[76:77], v[14:15] op_sel:[0,0] op_sel_hi:[1,0]
    v_pk_mul_f32 v[78:79], v[78:79], v[14:15] op_sel:[0,0] op_sel_hi:[1,0]
    s_waitcnt lgkmcnt(0)
    v_cmp_ne_u64 s[50:51], v[72:73], v[68:69]
    v_cmpx_ne_u64 s[54:55], v[74:75], v[70:71]
    s_and_b64 s[82:83], s[54:55], s[80:81]
    s_cbranch_scc1 L2_c71
L2_d71:
    v_mov_b64 v[84:85], v[70:71]
    v_mov_b32 v7, v95
    v_mov_b64 v[86:87], v[74:75]
    s_or_b64 s[80:81], s[80:81], s[54:55]
    s_mov_b64 exec, s[50:51]
    s_and_b64 s[82:83], s[50:51], s[80:81]
    s_cbranch_scc1 L2_c72
L2_d72:
    v_mov_b64 v[84:85], v[68:69]
    v_mov_b32 v7, v94
    v_mov_b64 v[86:87], v[72:73]
    s_mov_b64 exec, -1
    s_or_b64 s[80:81], s[80:81], s[50:51]
    ds_read_b64 v[70:71], v93 offset:65408
    s_and_b64 exec, s[84:85], s[80:81]
    v_mfma_f32_4x4x4_16b_bf16 v[76:79], v[12:13], v[84:85], 0
    v_mov_b32 v92, v7
    s_andn2_b64 s[80:81], s[80:81], s[84:85]
    v_mfma_f32_4x4x4_16b_bf16 v[76:79], v[10:11], v[86:87], v[76:79]
    s_mov_b64 exec, -1
    ds_read_b64 v[68:69], v92 offset:65408
    v_and_b32 v46, 0x80000000, v27
    v_lshrrev_b32 v47, 14, v25
    v_bitop3_b32 v47, v47, v5, v46 bitop3:0xea
    ds_read_b64 v[106:107], v47
    v_bitop3_b32 v95, v25, v5, v46 bitop3:0xea
    v_and_b32 v46, 0x40000000, v27
    v_lshrrev_b32 v47, 14, v24
    v_bitop3_b32 v47, v47, v5, v46 bitop3:0xea
    ds_read_b64 v[104:105], v47
    v_bitop3_b32 v94, v24, v5, v46 bitop3:0xea
    s_waitcnt lgkmcnt(2)
    v_mfma_f32_4x4x4_16b_bf16 v[80:83], v[10:11], v[70:71], v[80:83]
    v_mfma_f32_4x4x4_16b_bf16 v[76:79], v[10:11], v[68:69], v[76:79]
    v_perm_b32 v15, v25, v26, s47
    v_bitop3_b32 v46, v25, 0.5, -0.5 bitop3:0xa8
    v_perm_b32 v14, v24, v26, s46
    v_bitop3_b32 v47, v24, 0.5, -0.5 bitop3:0xa8
    v_cvt_pk_bf16_f32 v80, v80, v81
    v_cvt_pk_bf16_f32 v81, v82, v83
    ds_wrxchg_rtn_b64 v[74:75], v93, v[80:81] offset:65408
    v_cvt_pk_bf16_f32 v76, v76, v77
    v_cvt_pk_bf16_f32 v77, v78, v79
    ds_wrxchg_rtn_b64 v[72:73], v92, v[76:77] offset:65408
    v_and_b32 v88, 0x0fffffff, v41
    v_mov_b32 v27, v41
    buffer_load_dwordx2 v[22:23], v88, s[8:11], 0 offen
    buffer_load_dwordx3 v[24:26], v88, s[8:11], 0 offen offset:8
    s_setprio 1
    s_waitcnt lgkmcnt(2)
    v_mfma_f32_4x4x4_16b_bf16 v[80:83], v[8:9], v[106:107], 0
    v_mfma_f32_4x4x4_16b_bf16 v[76:79], v[8:9], v[104:105], 0
    v_bitop3_b32 v15, v6, v15, v46 bitop3:0xca
    v_bitop3_b32 v14, v6, v14, v47 bitop3:0xca
    s_nop 1
    v_pk_mul_f32 v[80:81], v[80:81], v[14:15] op_sel:[0,1] op_sel_hi:[1,1]
    v_pk_mul_f32 v[82:83], v[82:83], v[14:15] op_sel:[0,1] op_sel_hi:[1,1]
    v_pk_mul_f32 v[76:77], v[76:77], v[14:15] op_sel:[0,0] op_sel_hi:[1,0]
    v_pk_mul_f32 v[78:79], v[78:79], v[14:15] op_sel:[0,0] op_sel_hi:[1,0]
    s_waitcnt lgkmcnt(0)
    v_cmp_ne_u64 s[50:51], v[72:73], v[68:69]
    v_cmpx_ne_u64 s[54:55], v[74:75], v[70:71]
    s_and_b64 s[82:83], s[54:55], s[80:81]
    s_cbranch_scc1 L2_c73
L2_d73:
    v_mov_b64 v[84:85], v[70:71]
    v_mov_b32 v7, v93
    v_mov_b64 v[86:87], v[74:75]
    s_or_b64 s[80:81], s[80:81], s[54:55]
    s_mov_b64 exec, s[50:51]
    s_and_b64 s[82:83], s[50:51], s[80:81]
    s_cbranch_scc1 L2_c74
L2_d74:
    v_mov_b64 v[84:85], v[68:69]
    v_mov_b32 v7, v92
    v_mov_b64 v[86:87], v[72:73]
    s_mov_b64 exec, -1
    s_or_b64 s[80:81], s[80:81], s[50:51]
    ds_read_b64 v[70:71], v95 offset:65408
    ds_read_b64 v[68:69], v94 offset:65408
    s_waitcnt vmcnt(11)
    v_and_b32 v46, 0x20000000, v33
    v_lshrrev_b32 v47, 14, v29
    v_bitop3_b32 v47, v47, v5, v46 bitop3:0xea
    ds_read_b64 v[102:103], v47
    v_bitop3_b32 v93, v29, v5, v46 bitop3:0xea
    v_and_b32 v46, 0x10000000, v33
    v_lshrrev_b32 v47, 14, v28
    v_bitop3_b32 v47, v47, v5, v46 bitop3:0xea
    ds_read_b64 v[100:101], v47
    v_bitop3_b32 v92, v28, v5, v46 bitop3:0xea
    s_waitcnt lgkmcnt(2)
    v_mfma_f32_4x4x4_16b_bf16 v[80:83], v[10:11], v[70:71], v[80:83]
    v_mfma_f32_4x4x4_16b_bf16 v[76:79], v[10:11], v[68:69], v[76:79]
    v_perm_b32 v15, v29, v32, s45
    v_bitop3_b32 v46, v29, 0.5, -0.5 bitop3:0xa8
    v_perm_b32 v14, v28, v32, s44
    v_bitop3_b32 v47, v28, 0.5, -0.5 bitop3:0xa8
    v_cvt_pk_bf16_f32 v80, v80, v81
    v_cvt_pk_bf16_f32 v81, v82, v83
    ds_wrxchg_rtn_b64 v[74:75], v95, v[80:81] offset:65408
    v_cvt_pk_bf16_f32 v76, v76, v77
    v_cvt_pk_bf16_f32 v77, v78, v79
    ds_wrxchg_rtn_b64 v[72:73], v94, v[76:77] offset:65408
    s_waitcnt lgkmcnt(2)
    v_mfma_f32_4x4x4_16b_bf16 v[80:83], v[8:9], v[102:103], 0
    v_mfma_f32_4x4x4_16b_bf16 v[76:79], v[8:9], v[100:101], 0
    v_bitop3_b32 v15, v6, v15, v46 bitop3:0xca
    v_bitop3_b32 v14, v6, v14, v47 bitop3:0xca
    v_cmp_lt_u32 s[84:85], v5, v92
    s_nop 0
    v_pk_mul_f32 v[80:81], v[80:81], v[14:15] op_sel:[0,1] op_sel_hi:[1,1]
    v_pk_mul_f32 v[82:83], v[82:83], v[14:15] op_sel:[0,1] op_sel_hi:[1,1]
    v_pk_mul_f32 v[76:77], v[76:77], v[14:15] op_sel:[0,0] op_sel_hi:[1,0]
    v_pk_mul_f32 v[78:79], v[78:79], v[14:15] op_sel:[0,0] op_sel_hi:[1,0]
    s_waitcnt lgkmcnt(0)
    v_cmp_ne_u64 s[50:51], v[72:73], v[68:69]
    v_cmpx_ne_u64 s[54:55], v[74:75], v[70:71]
    s_and_b64 s[82:83], s[54:55], s[80:81]
    s_cbranch_scc1 L2_c75
L2_d75:
    v_mov_b64 v[84:85], v[70:71]
    v_mov_b32 v7, v95
    v_mov_b64 v[86:87], v[74:75]
    s_or_b64 s[80:81], s[80:81], s[54:55]
    s_mov_b64 exec, s[50:51]
    s_and_b64 s[82:83], s[50:51], s[80:81]
    s_cbranch_scc1 L2_c76
L2_d76:
    v_mov_b64 v[84:85], v[68:69]
    v_mov_b32 v7, v94
    v_mov_b64 v[86:87], v[72:73]
    s_mov_b64 exec, -1
    s_or_b64 s[80:81], s[80:81], s[50:51]
    ds_read_b64 v[70:71], v93 offset:65408
    s_and_b64 exec, s[84:85], s[80:81]
    v_mfma_f32_4x4x4_16b_bf16 v[76:79], v[12:13], v[84:85], 0
    v_mov_b32 v92, v7
    s_andn2_b64 s[80:81], s[80:81], s[84:85]
    v_mfma_f32_4x4x4_16b_bf16 v[76:79], v[10:11], v[86:87], v[76:79]
    s_mov_b64 exec, -1
    ds_read_b64 v[68:69], v92 offset:65408
    v_and_b32 v46, 0x80000000, v33
    v_lshrrev_b32 v47, 14, v31
    v_bitop3_b32 v47, v47, v5, v46 bitop3:0xea
    ds_read_b64 v[106:107], v47
    v_bitop3_b32 v95, v31, v5, v46 bitop3:0xea
    v_and_b32 v46, 0x40000000, v33
    v_lshrrev_b32 v47, 14, v30
    v_bitop3_b32 v47, v47, v5, v46 bitop3:0xea
    ds_read_b64 v[104:105], v47
    v_bitop3_b32 v94, v30, v5, v46 bitop3:0xea
    s_waitcnt lgkmcnt(2)
    v_mfma_f32_4x4x4_16b_bf16 v[80:83], v[10:11], v[70:71], v[80:83]
    v_mfma_f32_4x4x4_16b_bf16 v[76:79], v[10:11], v[68:69], v[76:79]
    v_perm_b32 v15, v31, v32, s47
    v_bitop3_b32 v46, v31, 0.5, -0.5 bitop3:0xa8
    v_perm_b32 v14, v30, v32, s46
    v_bitop3_b32 v47, v30, 0.5, -0.5 bitop3:0xa8
    v_cvt_pk_bf16_f32 v80, v80, v81
    v_cvt_pk_bf16_f32 v81, v82, v83
    ds_wrxchg_rtn_b64 v[74:75], v93, v[80:81] offset:65408
    v_cvt_pk_bf16_f32 v76, v76, v77
    v_cvt_pk_bf16_f32 v77, v78, v79
    ds_wrxchg_rtn_b64 v[72:73], v92, v[76:77] offset:65408
    v_and_b32 v88, 0x0fffffff, v42
    v_mov_b32 v33, v42
    buffer_load_dwordx2 v[28:29], v88, s[8:11], 0 offen
    buffer_load_dwordx3 v[30:32], v88, s[8:11], 0 offen offset:8
    s_setprio 0
    s_waitcnt lgkmcnt(2)
    v_mfma_f32_4x4x4_16b_bf16 v[80:83], v[8:9], v[106:107], 0
    v_mfma_f32_4x4x4_16b_bf16 v[76:79], v[8:9], v[104:105], 0
    v_bitop3_b32 v15, v6, v15, v46 bitop3:0xca
    v_bitop3_b32 v14, v6, v14, v47 bitop3:0xca
    s_nop 1
    v_pk_mul_f32 v[80:81], v[80:81], v[14:15] op_sel:[0,1] op_sel_hi:[1,1]
    v_pk_mul_f32 v[82:83], v[82:83], v[14:15] op_sel:[0,1] op_sel_hi:[1,1]
    v_pk_mul_f32 v[76:77], v[76:77], v[14:15] op_sel:[0,0] op_sel_hi:[1,0]
    v_pk_mul_f32 v[78:79], v[78:79], v[14:15] op_sel:[0,0] op_sel_hi:[1,0]
    s_add_u32 s40, s40, 0x50000
    s_waitcnt lgkmcnt(0)
    v_cmp_ne_u64 s[50:51], v[72:73], v[68:69]
    v_cmpx_ne_u64 s[54:55], v[74:75], v[70:71]
    s_and_b64 s[82:83], s[54:55], s[80:81]
    s_cbranch_scc1 L2_c77
L2_d77:
    v_mov_b64 v[84:85], v[70:71]
    v_mov_b32 v7, v93
    v_mov_b64 v[86:87], v[74:75]
    s_or_b64 s[80:81], s[80:81], s[54:55]
    s_mov_b64 exec, s[50:51]
    s_and_b64 s[82:83], s[50:51], s[80:81]
    s_cbranch_scc1 L2_c78
L2_d78:
    v_mov_b64 v[84:85], v[68:69]
    v_mov_b32 v7, v92
    v_mov_b64 v[86:87], v[72:73]
    s_mov_b64 exec, -1
    s_or_b64 s[80:81], s[80:81], s[50:51]
    ds_read_b64 v[70:71], v95 offset:65408
    ds_read_b64 v[68:69], v94 offset:65408
    s_waitcnt vmcnt(8)
    v_and_b32 v46, 0x20000000, v39
    v_lshrrev_b32 v47, 14, v35
    v_bitop3_b32 v47, v47, v5, v46 bitop3:0xea
    ds_read_b64 v[102:103], v47
    v_bitop3_b32 v93, v35, v5, v46 bitop3:0xea
    v_and_b32 v46, 0x10000000, v39
    v_lshrrev_b32 v47, 14, v34
    v_bitop3_b32 v47, v47, v5, v46 bitop3:0xea
    ds_read_b64 v[100:101], v47
    v_bitop3_b32 v92, v34, v5, v46 bitop3:0xea
    v_and_b32 v46, 0x80000000, v39
    v_lshrrev_b32 v47, 14, v37
    v_bitop3_b32 v47, v47, v5, v46 bitop3:0xea
    ds_read_b64 v[106:107], v47
    v_and_b32 v46, 0x40000000, v39
    v_lshrrev_b32 v47, 14, v36
    v_bitop3_b32 v47, v47, v5, v46 bitop3:0xea
    ds_read_b64 v[104:105], v47
    s_waitcnt lgkmcnt(4)
    v_mfma_f32_4x4x4_16b_bf16 v[80:83], v[10:11], v[70:71], v[80:83]
    v_mfma_f32_4x4x4_16b_bf16 v[76:79], v[10:11], v[68:69], v[76:79]
    v_perm_b32 v15, v35, v38, s45
    v_bitop3_b32 v46, v35, 0.5, -0.5 bitop3:0xa8
    v_perm_b32 v14, v34, v38, s44
    v_bitop3_b32 v47, v34, 0.5, -0.5 bitop3:0xa8
    v_cvt_pk_bf16_f32 v80, v80, v81
    v_cvt_pk_bf16_f32 v81, v82, v83
    ds_wrxchg_rtn_b64 v[74:75], v95, v[80:81] offset:65408
    v_cvt_pk_bf16_f32 v76, v76, v77
    v_cvt_pk_bf16_f32 v77, v78, v79
    ds_wrxchg_rtn_b64 v[72:73], v94, v[76:77] offset:65408
    s_waitcnt lgkmcnt(2)
    s_barrier
    s_setprio 3
    s_mov_b32 m0, s100
    s_nop 0
    ds_write_addtid_b32 v116 offset:32768
    ds_write_addtid_b32 v117 offset:33024
    ds_write_addtid_b32 v118 offset:33280
    ds_write_addtid_b32 v119 offset:33536
    buffer_load_dwordx4 v[116:119], v3, s[16:19], s40 offen offset:2048
    ds_write_addtid_b32 v120 offset:33792
    ds_write_addtid_b32 v121 offset:34048
    ds_write_addtid_b32 v122 offset:34304
    ds_write_addtid_b32 v123 offset:34560
    buffer_load_dwordx4 v[120:123], v3, s[16:19], s40 offen offset:3072
    v_mfma_f32_4x4x4_16b_bf16 v[80:83], v[8:9], v[102:103], 0
    v_mfma_f32_4x4x4_16b_bf16 v[76:79], v[8:9], v[100:101], 0
    v_bitop3_b32 v15, v6, v15, v46 bitop3:0xca
    v_bitop3_b32 v14, v6, v14, v47 bitop3:0xca
    v_cmp_lt_u32 s[84:85], v5, v92
    s_nop 0
    v_pk_mul_f32 v[80:81], v[80:81], v[14:15] op_sel:[0,1] op_sel_hi:[1,1]
    v_pk_mul_f32 v[82:83], v[82:83], v[14:15] op_sel:[0,1] op_sel_hi:[1,1]
    v_pk_mul_f32 v[76:77], v[76:77], v[14:15] op_sel:[0,0] op_sel_hi:[1,0]
    v_pk_mul_f32 v[78:79], v[78:79], v[14:15] op_sel:[0,0] op_sel_hi:[1,0]
    v_mov_b32 v44, v43
    s_cmp_gt_u32 s37, 1024
    s_cbranch_scc1 L2_xs79
    s_cmp_lg_u32 s101, 0
    s_cbranch_scc1 L2_xa79
L2_xb79:
    v_lshlrev_b32 v89, 16, v96
    v_add_u32 v90, 60, v97
    v_bitop3_b32 v90, v89, v45, v90 bitop3:0x6a
    ds_write_b32 v98, v90 offset:12
    v_lshlrev_b32 v89, 20, v96
    v_add_u32 v90, 40, v97
    v_bitop3_b32 v90, v89, v45, v90 bitop3:0x6a
    ds_write_b32 v98, v90 offset:8
    v_lshlrev_b32 v89, 24, v96
    v_add_u32 v90, 20, v97
    v_bitop3_b32 v90, v89, v45, v90 bitop3:0x6a
    ds_write_b32 v98, v90 offset:4
    v_lshlrev_b32 v89, 28, v96
    v_bitop3_b32 v90, v89, v45, v97 bitop3:0x6a
    ds_write_b32 v98, v90 offset:0
    v_mov_b32_dpp v91, v66 quad_perm:[0,0,0,0] row_mask:0xf bank_mask:0xf
    v_and_b32 v89, 3, v91
    v_and_b32 v97, 0xfffc, v91
    v_sub_u16_dpp v88, v66, v91 quad_perm:[2,2,2,2] row_mask:0xf bank_mask:0xf
    v_mad_u32_u24 v97, v97, 5, v4
    v_add_u32 v99, v88, v89
    v_bfm_b32 v96, v88, v89
    v_cmp_lt_u32 s[58:59], 16, v99
    v_lshlrev_b32 v89, v1, v96
    v_and_b32 v89, v45, v89
    v_cmp_ne_u32 vcc, 0, v89
    v_xor_b32 v90, v97, v89
    s_add_u32 s3, s37, s38
    v_mbcnt_lo_u32_b32 v98, vcc_lo, 0
    v_mbcnt_hi_u32_b32 v98, vcc_hi, v98
    s_bcnt1_i32_b64 s41, vcc
    v_lshl_add_u32 v98, v98, 2, s3
    s_mov_b64 exec, vcc
    ds_write_b32 v98, v90
    s_mov_b64 exec, -1
    s_lshl2_add_u32 s37, s41, s37
    s_cmp_lg_u64 s[58:59], 0
    s_cbranch_scc1 L2_xe79
L2_xr79:
    v_add_u32 v98, s37, v0
    v_mov_b32 v90, -1
    ds_write_b32 v98, v90
    ds_read2st64_b32 v[40:41], v0 offset0:0 offset1:1
    ds_read2st64_b32 v[42:43], v0 offset0:2 offset1:3
    s_sub_u32 s3, s37, 768
    s_cmp_gt_u32 s3, 256
    s_cbranch_scc1 L2_xf79
L2_xg79:
    s_setprio 2
    ds_write_addtid_b32 v124 offset:34816
    ds_write_addtid_b32 v125 offset:35072
    ds_write_addtid_b32 v126 offset:35328
    ds_write_addtid_b32 v127 offset:35584
    s_add_u32 s3, s40, 4096
    buffer_load_dwordx4 v[124:127], v3, s[16:19], s3 offen
    s_waitcnt lgkmcnt(14)
    v_cmp_ne_u64 s[50:51], v[72:73], v[68:69]
    v_cmpx_ne_u64 s[54:55], v[74:75], v[70:71]
    s_and_b64 s[82:83], s[54:55], s[80:81]
    s_cbranch_scc1 L2_c80
L2_d80:
    v_mov_b64 v[84:85], v[70:71]
    v_mov_b32 v7, v95
    v_mov_b64 v[86:87], v[74:75]
    s_or_b64 s[80:81], s[80:81], s[54:55]
    s_mov_b64 exec, s[50:51]
    s_and_b64 s[82:83], s[50:51], s[80:81]
    s_cbranch_scc1 L2_c81
L2_d81:
    v_mov_b64 v[84:85], v[68:69]
    v_mov_b32 v7, v94
    v_mov_b64 v[86:87], v[72:73]
    s_mov_b64 exec, -1
    s_or_b64 s[80:81], s[80:81], s[50:51]
    ds_read_b64 v[70:71], v93 offset:65408
    s_and_b64 exec, s[84:85], s[80:81]
    v_mfma_f32_4x4x4_16b_bf16 v[76:79], v[12:13], v[84:85], 0
    v_mov_b32 v92, v7
    s_andn2_b64 s[80:81], s[80:81], s[84:85]
    v_mfma_f32_4x4x4_16b_bf16 v[76:79], v[10:11], v[86:87], v[76:79]
    s_mov_b64 exec, -1
    ds_read_b64 v[68:69], v92 offset:65408
    s_setprio 1
    s_waitcnt vmcnt(10)
    s_mov_b32 m0, s38
    s_nop 0
    ds_write_addtid_b32 v108 offset:0
    ds_write_addtid_b32 v109 offset:256
    ds_write_addtid_b32 v110 offset:512
    ds_write_addtid_b32 v111 offset:768
    s_waitcnt lgkmcnt(4)
    v_mfma_f32_4x4x4_16b_bf16 v[80:83], v[10:11], v[70:71], v[80:83]
    v_mfma_f32_4x4x4_16b_bf16 v[76:79], v[10:11], v[68:69], v[76:79]
    v_and_b32 v46, 0x40000000, v39
    v_bitop3_b32 v94, v36, v5, v46 bitop3:0xea
    v_and_b32 v46, 0x80000000, v39
    v_bitop3_b32 v95, v37, v5, v46 bitop3:0xea
    v_perm_b32 v15, v37, v38, s47
    v_bitop3_b32 v46, v37, 0.5, -0.5 bitop3:0xa8
    v_perm_b32 v14, v36, v38, s46
    v_bitop3_b32 v47, v36, 0.5, -0.5 bitop3:0xa8
    v_cvt_pk_bf16_f32 v80, v80, v81
    v_cvt_pk_bf16_f32 v81, v82, v83
    ds_wrxchg_rtn_b64 v[74:75], v93, v[80:81] offset:65408
    v_cvt_pk_bf16_f32 v76, v76, v77
    v_cvt_pk_bf16_f32 v77, v78, v79
    ds_wrxchg_rtn_b64 v[72:73], v92, v[76:77] offset:65408
    v_and_b32 v88, 0x0fffffff, v44
    v_mov_b32 v39, v44
    buffer_load_dwordx2 v[34:35], v88, s[8:11], 0 offen
    buffer_load_dwordx3 v[36:38], v88, s[8:11], 0 offen offset:8
    s_setprio 0
    s_waitcnt vmcnt(11)
    ds_write_addtid_b32 v112 offset:1024
    ds_write_addtid_b32 v113 offset:1280
    ds_write_addtid_b32 v114 offset:1536
    ds_write_addtid_b32 v115 offset:1792
    v_mfma_f32_4x4x4_16b_bf16 v[80:83], v[8:9], v[106:107], 0
    v_mfma_f32_4x4x4_16b_bf16 v[76:79], v[8:9], v[104:105], 0
    v_bitop3_b32 v15, v6, v15, v46 bitop3:0xca
    v_bitop3_b32 v14, v6, v14, v47 bitop3:0xca
    s_nop 1
    v_pk_mul_f32 v[80:81], v[80:81], v[14:15] op_sel:[0,1] op_sel_hi:[1,1]
    v_pk_mul_f32 v[82:83], v[82:83], v[14:15] op_sel:[0,1] op_sel_hi:[1,1]
    v_pk_mul_f32 v[76:77], v[76:77], v[14:15] op_sel:[0,0] op_sel_hi:[1,0]
    v_pk_mul_f32 v[78:79], v[78:79], v[14:15] op_sel:[0,0] op_sel_hi:[1,0]
    s_add_u32 s42, s42, 1
    s_waitcnt lgkmcnt(0)
    s_barrier
    s_bitcmp1_b32 s36, s42
    s_cbranch_scc1 L2_slow
L2_ret4:
    s_setprio 3
    buffer_load_dwordx4 v[108:111], v3, s[16:19], s40 offen offset:0
    v_cmp_ne_u64 s[50:51], v[72:73], v[68:69]
    v_cmpx_ne_u64 s[54:55], v[74:75], v[70:71]
    s_and_b64 s[82:83], s[54:55], s[80:81]
    s_cbranch_scc1 L2_c82
L2_d82:
    v_mov_b64 v[84:85], v[70:71]
    v_mov_b32 v7, v93
    v_mov_b64 v[86:87], v[74:75]
    s_or_b64 s[80:81], s[80:81], s[54:55]
    s_mov_b64 exec, s[50:51]
    s_and_b64 s[82:83], s[50:51], s[80:81]
    s_cbranch_scc1 L2_c83
L2_d83:
    v_mov_b64 v[84:85], v[68:69]
    v_mov_b32 v7, v92
    v_mov_b64 v[86:87], v[72:73]
    s_mov_b64 exec, -1
    s_or_b64 s[80:81], s[80:81], s[50:51]
    ds_read_b64 v[70:71], v95 offset:65408
    ds_read_b64 v[68:69], v94 offset:65408
    s_waitcnt vmcnt(10)
    v_and_b32 v46, 0x20000000, v21
    v_lshrrev_b32 v47, 14, v17
    v_bitop3_b32 v47, v47, v5, v46 bitop3:0xea
    ds_read_b64 v[102:103], v47
    v_bitop3_b32 v93, v17, v5, v46 bitop3:0xea
    v_and_b32 v46, 0x10000000, v21
    v_lshrrev_b32 v47, 14, v16
    v_bitop3_b32 v47, v47, v5, v46 bitop3:0xea
    ds_read_b64 v[100:101], v47
    v_bitop3_b32 v92, v16, v5, v46 bitop3:0xea
    s_waitcnt lgkmcnt(2)
    v_mfma_f32_4x4x4_16b_bf16 v[80:83], v[10:11], v[70:71], v[80:83]
    v_mfma_f32_4x4x4_16b_bf16 v[76:79], v[10:11], v[68:69], v[76:79]
    v_perm_b32 v15, v17, v20, s45
    v_bitop3_b32 v46, v17, 0.5, -0.5 bitop3:0xa8
    v_perm_b32 v14, v16, v20, s44
    v_bitop3_b32 v47, v16, 0.5, -0.5 bitop3:0xa8
    v_cvt_pk_bf16_f32 v80, v80, v81
    v_cvt_pk_bf16_f32 v81, v82, v83
    ds_wrxchg_rtn_b64 v[74:75], v95, v[80:81] offset:65408
    v_cvt_pk_bf16_f32 v76, v76, v77
    v_cvt_pk_bf16_f32 v77, v78, v79
    ds_wrxchg_rtn_b64 v[72:73], v94, v[76:77] offset:65408
    s_waitcnt lgkmcnt(2)
    v_mfma_f32_4x4x4_16b_bf16 v[80:83], v[8:9], v[102:103], 0
    v_mfma_f32_4x4x4_16b_bf16 v[76:79], v[8:9], v[100:101], 0
    v_bitop3_b32 v15, v6, v15, v46 bitop3:0xca
    v_bitop3_b32 v14, v6, v14, v47 bitop3:0xca
    v_cmp_lt_u32 s[84:85], v5, v92
    s_nop 0
    v_pk_mul_f32 v[80:81], v[80:81], v[14:15] op_sel:[0,1] op_sel_hi:[1,1]
    v_pk_mul_f32 v[82:83], v[82:83], v[14:15] op_sel:[0,1] op_sel_hi:[1,1]
    v_pk_mul_f32 v[76:77], v[76:77], v[14:15] op_sel:[0,0] op_sel_hi:[1,0]
    v_pk_mul_f32 v[78:79], v[78:79], v[14:15] op_sel:[0,0] op_sel_hi:[1,0]
    buffer_load_dwordx4 v[112:115], v3, s[16:19], s40 offen offset:1024
    s_waitcnt lgkmcnt(0)
    v_cmp_ne_u64 s[50:51], v[72:73], v[68:69]
    v_cmpx_ne_u64 s[54:55], v[74:75], v[70:71]
    s_and_b64 s[82:83], s[54:55], s[80:81]
    s_cbranch_scc1 L2_c84
L2_d84:
    v_mov_b64 v[84:85], v[70:71]
    v_mov_b32 v7, v95
    v_mov_b64 v[86:87], v[74:75]
    s_or_b64 s[80:81], s[80:81], s[54:55]
    s_mov_b64 exec, s[50:51]
    s_and_b64 s[82:83], s[50:51], s[80:81]
    s_cbranch_scc1 L2_c85
L2_d85:
    v_mov_b64 v[84:85], v[68:69]
    v_mov_b32 v7, v94
    v_mov_b64 v[86:87], v[72:73]
    s_mov_b64 exec, -1
    s_or_b64 s[80:81], s[80:81], s[50:51]
    ds_read_b64 v[70:71], v93 offset:65408
    s_and_b64 exec, s[84:85], s[80:81]
    v_mfma_f32_4x4x4_16b_bf16 v[76:79], v[12:13], v[84:85], 0
    v_mov_b32 v92, v7
    s_andn2_b64 s[80:81], s[80:81], s[84:85]
    v_mfma_f32_4x4x4_16b_bf16 v[76:79], v[10:11], v[86:87], v[76:79]
    s_mov_b64 exec, -1
    ds_read_b64 v[68:69], v92 offset:65408
    v_and_b32 v46, 0x80000000, v21
    v_lshrrev_b32 v47, 14, v19
    v_bitop3_b32 v47, v47, v5, v46 bitop3:0xea
    ds_read_b64 v[106:107], v47
    v_bitop3_b32 v95, v19, v5, v46 bitop3:0xea
    v_and_b32 v46, 0x40000000, v21
    v_lshrrev_b32 v47, 14, v18
    v_bitop3_b32 v47, v47, v5, v46 bitop3:0xea
    ds_read_b64 v[104:105], v47
    v_bitop3_b32 v94, v18, v5, v46 bitop3:0xea
    s_waitcnt lgkmcnt(2)
    v_mfma_f32_4x4x4_16b_bf16 v[80:83], v[10:11], v[70:71], v[80:83]
    v_mfma_f32_4x4x4_16b_bf16 v[76:79], v[10:11], v[68:69], v[76:79]
    v_perm_b32 v15, v19, v20, s47
    v_bitop3_b32 v46, v19, 0.5, -0.5 bitop3:0xa8
    v_perm_b32 v14, v18, v20, s46
    v_bitop3_b32 v47, v18, 0.5, -0.5 bitop3:0xa8
    v_cvt_pk_bf16_f32 v80, v80, v81
    v_cvt_pk_bf16_f32 v81, v82, v83
    ds_wrxchg_rtn_b64 v[74:75], v93, v[80:81] offset:65408
    v_cvt_pk_bf16_f32 v76, v76, v77
    v_cvt_pk_bf16_f32 v77, v78, v79
    ds_wrxchg_rtn_b64 v[72:73], v92, v[76:77] offset:65408
    v_and_b32 v88, 0x0fffffff, v40
    v_mov_b32 v21, v40
    buffer_load_dwordx2 v[16:17], v88, s[8:11], 0 offen
    buffer_load_dwordx3 v[18:20], v88, s[8:11], 0 offen offset:8
    s_setprio 2
    s_waitcnt lgkmcnt(2)
    v_mfma_f32_4x4x4_16b_bf16 v[80:83], v[8:9], v[106:107], 0
    v_mfma_f32_4x4x4_16b_bf16 v[76:79], v[8:9], v[104:105], 0
    v_bitop3_b32 v15, v6, v15, v46 bitop3:0xca
    v_bitop3_b32 v14, v6, v14, v47 bitop3:0xca
    s_nop 1
    v_pk_mul_f32 v[80:81], v[80:81], v[14:15] op_sel:[0,1] op_sel_hi:[1,1]
    v_pk_mul_f32 v[82:83], v[82:83], v[14:15] op_sel:[0,1] op_sel_hi:[1,1]
    v_pk_mul_f32 v[76:77], v[76:77], v[14:15] op_sel:[0,0] op_sel_hi:[1,0]
    v_pk_mul_f32 v[78:79], v[78:79], v[14:15] op_sel:[0,0] op_sel_hi:[1,0]
    v_sub_u16 v88, v60, v52
    v_and_b32 v89, 3, v52
    v_add3_u32 v99, v88, v89, 3
    v_and_b32 v99, -4, v99
    v_max_u32 v99, 4, v99
    v_and_b32 v97, 0xfffc, v52
    v_bfm_b32 v96, v88, v89
    v_add_u32_dpp v91, v99, v99 row_shr:1 row_mask:0xf bank_mask:0xf bound_ctrl:1
    v_mad_u32_u24 v97, v97, 5, v2
    v_cmp_lt_u32 vcc, 16, v99
    v_add_u32_dpp v91, v91, v91 row_shr:2 row_mask:0xf bank_mask:0xf bound_ctrl:1
    v_sub_u32 v98, s38, v99
    v_lshrrev_b64 v[52:53], 16, v[52:53]
    v_add_u32_dpp v91, v91, v91 row_shr:4 row_mask:0xf bank_mask:0xf bound_ctrl:1
    v_lshrrev_b64 v[60:61], 16, v[60:61]
    s_mov_b32 s101, 0
    v_add_u32_dpp v91, v91, v91 row_shr:8 row_mask:0xf bank_mask:0xf bound_ctrl:1
    s_nop 1
    v_add_u32_dpp v91, v91, v91 row_bcast:15 row_mask:0xa bank_mask:0xf
    s_nop 1
    v_add_u32_dpp v91, v91, v91 row_bcast:31 row_mask:0xc bank_mask:0xf
    v_add_u32 v98, v98, v91
    v_readlane_b32 s37, v91, 63
    s_cbranch_vccnz L2_xo86
L2_xp86:
    s_waitcnt lgkmcnt(0)
    v_cmp_ne_u64 s[50:51], v[72:73], v[68:69]
    v_cmpx_ne_u64 s[54:55], v[74:75], v[70:71]
    s_and_b64 s[82:83], s[54:55], s[80:81]
    s_cbranch_scc1 L2_c87
L2_d87:
    v_mov_b64 v[84:85], v[70:71]
    v_mov_b32 v7, v93
    v_mov_b64 v[86:87], v[74:75]
    s_or_b64 s[80:81], s[80:81], s[54:55]
    s_mov_b64 exec, s[50:51]
    s_and_b64 s[82:83], s[50:51], s[80:81]
    s_cbranch_scc1 L2_c88
L2_d88:
    v_mov_b64 v[84:85], v[68:69]
    v_mov_b32 v7, v92
    v_mov_b64 v[86:87], v[72:73]
    s_mov_b64 exec, -1
    s_or_b64 s[80:81], s[80:81], s[50:51]
    ds_read_b64 v[70:71], v95 offset:65408
    ds_read_b64 v[68:69], v94 offset:65408
    s_waitcnt vmcnt(11)
    v_and_b32 v46, 0x20000000, v27
    v_lshrrev_b32 v47, 14, v23
    v_bitop3_b32 v47, v47, v5, v46 bitop3:0xea
    ds_read_b64 v[102:103], v47
    v_bitop3_b32 v93, v23, v5, v46 bitop3:0xea
    v_and_b32 v46, 0x10000000, v27
    v_lshrrev_b32 v47, 14, v22
    v_bitop3_b32 v47, v47, v5, v46 bitop3:0xea
    ds_read_b64 v[100:101], v47
    v_bitop3_b32 v92, v22, v5, v46 bitop3:0xea
    s_waitcnt lgkmcnt(2)
    v_mfma_f32_4x4x4_16b_bf16 v[80:83], v[10:11], v[70:71], v[80:83]
    v_mfma_f32_4x4x4_16b_bf16 v[76:79], v[10:11], v[68:69], v[76:79]
    v_perm_b32 v15, v23, v26, s45
    v_bitop3_b32 v46, v23, 0.5, -0.5 bitop3:0xa8
    v_perm_b32 v14, v22, v26, s44
    v_bitop3_b32 v47, v22, 0.5, -0.5 bitop3:0xa8
    v_cvt_pk_bf16_f32 v80, v80, v81
    v_cvt_pk_bf16_f32 v81, v82, v83
    ds_wrxchg_rtn_b64 v[74:75], v95, v[80:81] offset:65408
    v_cvt_pk_bf16_f32 v76, v76, v77
    v_cvt_pk_bf16_f32 v77, v78, v79
    ds_wrxchg_rtn_b64 v[72:73], v94, v[76:77] offset:65408
    s_waitcnt lgkmcnt(2)
    v_mfma_f32_4x4x4_16b_bf16 v[80:83], v[8:9], v[102:103], 0
    v_mfma_f32_4x4x4_16b_bf16 v[76:79], v[8:9], v[100:101], 0
    v_bitop3_b32 v15, v6, v15, v46 bitop3:0xca
    v_bitop3_b32 v14, v6, v14, v47 bitop3:0xca
    v_cmp_lt_u32 s[84:85], v5, v92
    s_nop 0
    v_pk_mul_f32 v[80:81], v[80:81], v[14:15] op_sel:[0,1] op_sel_hi:[1,1]
    v_pk_mul_f32 v[82:83], v[82:83], v[14:15] op_sel:[0,1] op_sel_hi:[1,1]
    v_pk_mul_f32 v[76:77], v[76:77], v[14:15] op_sel:[0,0] op_sel_hi:[1,0]
    v_pk_mul_f32 v[78:79], v[78:79], v[14:15] op_sel:[0,0] op_sel_hi:[1,0]
    s_waitcnt lgkmcnt(0)
    v_cmp_ne_u64 s[50:51], v[72:73], v[68:69]
    v_cmpx_ne_u64 s[54:55], v[74:75], v[70:71]
    s_and_b64 s[82:83], s[54:55], s[80:81]
    s_cbranch_scc1 L2_c89
L2_d89:
    v_mov_b64 v[84:85], v[70:71]
    v_mov_b32 v7, v95
    v_mov_b64 v[86:87], v[74:75]
    s_or_b64 s[80:81], s[80:81], s[54:55]
    s_mov_b64 exec, s[50:51]
    s_and_b64 s[82:83], s[50:51], s[80:81]
    s_cbranch_scc1 L2_c90
L2_d90:
    v_mov_b64 v[84:85], v[68:69]
    v_mov_b32 v7, v94
    v_mov_b64 v[86:87], v[72:73]
    s_mov_b64 exec, -1
    s_or_b64 s[80:81], s[80:81], s[50:51]
    ds_read_b64 v[70:71], v93 offset:65408
    s_and_b64 exec, s[84:85], s[80:81]
    v_mfma_f32_4x4x4_16b_bf16 v[76:79], v[12:13], v[84:85], 0
    v_mov_b32 v92, v7
    s_andn2_b64 s[80:81], s[80:81], s[84:85]
    v_mfma_f32_4x4x4_16b_bf16 v[76:79], v[10:11], v[86:87], v[76:79]
    s_mov_b64 exec, -1
    ds_read_b64 v[68:69], v92 offset:65408
    v_and_b32 v46, 0x80000000, v27
    v_lshrrev_b32 v47, 14, v25
    v_bitop3_b32 v47, v47, v5, v46 bitop3:0xea
    ds_read_b64 v[106:107], v47
    v_bitop3_b32 v95, v25, v5, v46 bitop3:0xea
    v_and_b32 v46, 0x40000000, v27
    v_lshrrev_b32 v47, 14, v24
    v_bitop3_b32 v47, v47, v5, v46 bitop3:0xea
    ds_read_b64 v[104:105], v47
    v_bitop3_b32 v94, v24, v5, v46 bitop3:0xea
    s_waitcnt lgkmcnt(2)
    v_mfma_f32_4x4x4_16b_bf16 v[80:83], v[10:11], v[70:71], v[80:83]
    v_mfma_f32_4x4x4_16b_bf16 v[76:79], v[10:11], v[68:69], v[76:79]
    v_perm_b32 v15, v25, v26, s47
    v_bitop3_b32 v46, v25, 0.5, -0.5 bitop3:0xa8
    v_perm_b32 v14, v24, v26, s46
    v_bitop3_b32 v47, v24, 0.5, -0.5 bitop3:0xa8
    v_cvt_pk_bf16_f32 v80, v80, v81
    v_cvt_pk_bf16_f32 v81, v82, v83
    ds_wrxchg_rtn_b64 v[74:75], v93, v[80:81] offset:65408
    v_cvt_pk_bf16_f32 v76, v76, v77
    v_cvt_pk_bf16_f32 v77, v78, v79
    ds_wrxchg_rtn_b64 v[72:73], v92, v[76:77] offset:65408
    v_and_b32 v88, 0x0fffffff, v41
    v_mov_b32 v27, v41
    buffer_load_dwordx2 v[22:23], v88, s[8:11], 0 offen
    buffer_load_dwordx3 v[24:26], v88, s[8:11], 0 offen offset:8
    s_setprio 1
    s_waitcnt lgkmcnt(2)
    v_mfma_f32_4x4x4_16b_bf16 v[80:83], v[8:9], v[106:107], 0
    v_mfma_f32_4x4x4_16b_bf16 v[76:79], v[8:9], v[104:105], 0
    v_bitop3_b32 v15, v6, v15, v46 bitop3:0xca
    v_bitop3_b32 v14, v6, v14, v47 bitop3:0xca
    s_nop 1
    v_pk_mul_f32 v[80:81], v[80:81], v[14:15] op_sel:[0,1] op_sel_hi:[1,1]
    v_pk_mul_f32 v[82:83], v[82:83], v[14:15] op_sel:[0,1] op_sel_hi:[1,1]
    v_pk_mul_f32 v[76:77], v[76:77], v[14:15] op_sel:[0,0] op_sel_hi:[1,0]
    v_pk_mul_f32 v[78:79], v[78:79], v[14:15] op_sel:[0,0] op_sel_hi:[1,0]
    s_waitcnt lgkmcnt(0)
    v_cmp_ne_u64 s[50:51], v[72:73], v[68:69]
    v_cmpx_ne_u64 s[54:55], v[74:75], v[70:71]
    s_and_b64 s[82:83], s[54:55], s[80:81]
    s_cbranch_scc1 L2_c91
L2_d91:
    v_mov_b64 v[84:85], v[70:71]
    v_mov_b32 v7, v93
    v_mov_b64 v[86:87], v[74:75]
    s_or_b64 s[80:81], s[80:81], s[54:55]
    s_mov_b64 exec, s[50:51]
    s_and_b64 s[82:83], s[50:51], s[80:81]
    s_cbranch_scc1 L2_c92
L2_d92:
    v_mov_b64 v[84:85], v[68:69]
    v_mov_b32 v7, v92
    v_mov_b64 v[86:87], v[72:73]
    s_mov_b64 exec, -1
    s_or_b64 s[80:81], s[80:81], s[50:51]
    ds_read_b64 v[70:71], v95 offset:65408
    ds_read_b64 v[68:69], v94 offset:65408
    s_waitcnt vmcnt(11)
    v_and_b32 v46, 0x20000000, v33
    v_lshrrev_b32 v47, 14, v29
    v_bitop3_b32 v47, v47, v5, v46 bitop3:0xea
    ds_read_b64 v[102:103], v47
    v_bitop3_b32 v93, v29, v5, v46 bitop3:0xea
    v_and_b32 v46, 0x10000000, v33
    v_lshrrev_b32 v47, 14, v28
    v_bitop3_b32 v47, v47, v5, v46 bitop3:0xea
    ds_read_b64 v[100:101], v47
    v_bitop3_b32 v92, v28, v5, v46 bitop3:0xea
    s_waitcnt lgkmcnt(2)
    v_mfma_f32_4x4x4_16b_bf16 v[80:83], v[10:11], v[70:71], v[80:83]
    v_mfma_f32_4x4x4_16b_bf16 v[76:79], v[10:11], v[68:69], v[76:79]
    v_perm_b32 v15, v29, v32, s45
    v_bitop3_b32 v46, v29, 0.5, -0.5 bitop3:0xa8
    v_perm_b32 v14, v28, v32, s44
    v_bitop3_b32 v47, v28, 0.5, -0.5 bitop3:0xa8
    v_cvt_pk_bf16_f32 v80, v80, v81
    v_cvt_pk_bf16_f32 v81, v82, v83
    ds_wrxchg_rtn_b64 v[74:75], v95, v[80:81] offset:65408
    v_cvt_pk_bf16_f32 v76, v76, v77
    v_cvt_pk_bf16_f32 v77, v78, v79
    ds_wrxchg_rtn_b64 v[72:73], v94, v[76:77] offset:65408
    s_waitcnt lgkmcnt(2)
    v_mfma_f32_4x4x4_16b_bf16 v[80:83], v[8:9], v[102:103], 0
    v_mfma_f32_4x4x4_16b_bf16 v[76:79], v[8:9], v[100:101], 0
    v_bitop3_b32 v15, v6, v15, v46 bitop3:0xca
    v_bitop3_b32 v14, v6, v14, v47 bitop3:0xca
    v_cmp_lt_u32 s[84:85], v5, v92
    s_nop 0
    v_pk_mul_f32 v[80:81], v[80:81], v[14:15] op_sel:[0,1] op_sel_hi:[1,1]
    v_pk_mul_f32 v[82:83], v[82:83], v[14:15] op_sel:[0,1] op_sel_hi:[1,1]
    v_pk_mul_f32 v[76:77], v[76:77], v[14:15] op_sel:[0,0] op_sel_hi:[1,0]
    v_pk_mul_f32 v[78:79], v[78:79], v[14:15] op_sel:[0,0] op_sel_hi:[1,0]
    s_waitcnt lgkmcnt(0)
    v_cmp_ne_u64 s[50:51], v[72:73], v[68:69]
    v_cmpx_ne_u64 s[54:55], v[74:75], v[70:71]
    s_and_b64 s[82:83], s[54:55], s[80:81]
    s_cbranch_scc1 L2_c93
L2_d93:
    v_mov_b64 v[84:85], v[70:71]
    v_mov_b32 v7, v95
    v_mov_b64 v[86:87], v[74:75]
    s_or_b64 s[80:81], s[80:81], s[54:55]
    s_mov_b64 exec, s[50:51]
    s_and_b64 s[82:83], s[50:51], s[80:81]
    s_cbranch_scc1 L2_c94
L2_d94:
    v_mov_b64 v[84:85], v[68:69]
    v_mov_b32 v7, v94
    v_mov_b64 v[86:87], v[72:73]
    s_mov_b64 exec, -1
    s_or_b64 s[80:81], s[80:81], s[50:51]
    ds_read_b64 v[70:71], v93 offset:65408
    s_and_b64 exec, s[84:85], s[80:81]
    v_mfma_f32_4x4x4_16b_bf16 v[76:79], v[12:13], v[84:85], 0
    v_mov_b32 v92, v7
    s_andn2_b64 s[80:81], s[80:81], s[84:85]
    v_mfma_f32_4x4x4_16b_bf16 v[76:79], v[10:11], v[86:87], v[76:79]
    s_mov_b64 exec, -1
    ds_read_b64 v[68:69], v92 offset:65408
    v_and_b32 v46, 0x80000000, v33
    v_lshrrev_b32 v47, 14, v31
    v_bitop3_b32 v47, v47, v5, v46 bitop3:0xea
    ds_read_b64 v[106:107], v47
    v_bitop3_b32 v95, v31, v5, v46 bitop3:0xea
    v_and_b32 v46, 0x40000000, v33
    v_lshrrev_b32 v47, 14, v30
    v_bitop3_b32 v47, v47, v5, v46 bitop3:0xea
    ds_read_b64 v[104:105], v47
    v_bitop3_b32 v94, v30, v5, v46 bitop3:0xea
    s_waitcnt lgkmcnt(2)
    v_mfma_f32_4x4x4_16b_bf16 v[80:83], v[10:11], v[70:71], v[80:83]
    v_mfma_f32_4x4x4_16b_bf16 v[76:79], v[10:11], v[68:69], v[76:79]
    v_perm_b32 v15, v31, v32, s47
    v_bitop3_b32 v46, v31, 0.5, -0.5 bitop3:0xa8
    v_perm_b32 v14, v30, v32, s46
    v_bitop3_b32 v47, v30, 0.5, -0.5 bitop3:0xa8
    v_cvt_pk_bf16_f32 v80, v80, v81
    v_cvt_pk_bf16_f32 v81, v82, v83
    ds_wrxchg_rtn_b64 v[74:75], v93, v[80:81] offset:65408
    v_cvt_pk_bf16_f32 v76, v76, v77
    v_cvt_pk_bf16_f32 v77, v78, v79
    ds_wrxchg_rtn_b64 v[72:73], v92, v[76:77] offset:65408
    v_and_b32 v88, 0x0fffffff, v42
    v_mov_b32 v33, v42
    buffer_load_dwordx2 v[28:29], v88, s[8:11], 0 offen
    buffer_load_dwordx3 v[30:32], v88, s[8:11], 0 offen offset:8
    s_setprio 0
    s_waitcnt lgkmcnt(2)
    v_mfma_f32_4x4x4_16b_bf16 v[80:83], v[8:9], v[106:107], 0
    v_mfma_f32_4x4x4_16b_bf16 v[76:79], v[8:9], v[104:105], 0
    v_bitop3_b32 v15, v6, v15, v46 bitop3:0xca
    v_bitop3_b32 v14, v6, v14, v47 bitop3:0xca
    s_nop 1
    v_pk_mul_f32 v[80:81], v[80:81], v[14:15] op_sel:[0,1] op_sel_hi:[1,1]
    v_pk_mul_f32 v[82:83], v[82:83], v[14:15] op_sel:[0,1] op_sel_hi:[1,1]
    v_pk_mul_f32 v[76:77], v[76:77], v[14:15] op_sel:[0,0] op_sel_hi:[1,0]
    v_pk_mul_f32 v[78:79], v[78:79], v[14:15] op_sel:[0,0] op_sel_hi:[1,0]
    s_add_u32 s40, s40, 0x50000
    s_waitcnt lgkmcnt(0)
    v_cmp_ne_u64 s[50:51], v[72:73], v[68:69]
    v_cmpx_ne_u64 s[54:55], v[74:75], v[70:71]
    s_and_b64 s[82:83], s[54:55], s[80:81]
    s_cbranch_scc1 L2_c95
L2_d95:
    v_mov_b64 v[84:85], v[70:71]
    v_mov_b32 v7, v93
    v_mov_b64 v[86:87], v[74:75]
    s_or_b64 s[80:81], s[80:81], s[54:55]
    s_mov_b64 exec, s[50:51]
    s_and_b64 s[82:83], s[50:51], s[80:81]
    s_cbranch_scc1 L2_c96
L2_d96:
    v_mov_b64 v[84:85], v[68:69]
    v_mov_b32 v7, v92
    v_mov_b64 v[86:87], v[72:73]
    s_mov_b64 exec, -1
    s_or_b64 s[80:81], s[80:81], s[50:51]
    ds_read_b64 v[70:71], v95 offset:65408
    ds_read_b64 v[68:69], v94 offset:65408
    s_waitcnt vmcnt(8)
    v_and_b32 v46, 0x20000000, v39
    v_lshrrev_b32 v47, 14, v35
    v_bitop3_b32 v47, v47, v5, v46 bitop3:0xea
    ds_read_b64 v[102:103], v47
    v_bitop3_b32 v93, v35, v5, v46 bitop3:0xea
    v_and_b32 v46, 0x10000000, v39
    v_lshrrev_b32 v47, 14, v34
    v_bitop3_b32 v47, v47, v5, v46 bitop3:0xea
    ds_read_b64 v[100:101], v47
    v_bitop3_b32 v92, v34, v5, v46 bitop3:0xea
    v_and_b32 v46, 0x80000000, v39
    v_lshrrev_b32 v47, 14, v37
    v_bitop3_b32 v47, v47, v5, v46 bitop3:0xea
    ds_read_b64 v[106:107], v47
    v_and_b32 v46, 0x40000000, v39
    v_lshrrev_b32 v47, 14, v36
    v_bitop3_b32 v47, v47, v5, v46 bitop3:0xea
    ds_read_b64 v[104:105], v47
    s_waitcnt lgkmcnt(4)
    v_mfma_f32_4x4x4_16b_bf16 v[80:83], v[10:11], v[70:71], v[80:83]
    v_mfma_f32_4x4x4_16b_bf16 v[76:79], v[10:11], v[68:69], v[76:79]
    v_perm_b32 v15, v35, v38, s45
    v_bitop3_b32 v46, v35, 0.5, -0.5 bitop3:0xa8
    v_perm_b32 v14, v34, v38, s44
    v_bitop3_b32 v47, v34, 0.5, -0.5 bitop3:0xa8
    v_cvt_pk_bf16_f32 v80, v80, v81
    v_cvt_pk_bf16_f32 v81, v82, v83
    ds_wrxchg_rtn_b64 v[74:75], v95, v[80:81] offset:65408
    v_cvt_pk_bf16_f32 v76, v76, v77
    v_cvt_pk_bf16_f32 v77, v78, v79
    ds_wrxchg_rtn_b64 v[72:73], v94, v[76:77] offset:65408
    s_waitcnt lgkmcnt(2)
    s_barrier
    s_setprio 3
    s_mov_b32 m0, s100
    s_nop 0
    ds_write_addtid_b32 v116 offset:32768
    ds_write_addtid_b32 v117 offset:33024
    ds_write_addtid_b32 v118 offset:33280
    ds_write_addtid_b32 v119 offset:33536
    buffer_load_dwordx4 v[116:119], v3, s[16:19], s40 offen offset:2048
    ds_write_addtid_b32 v120 offset:33792
    ds_write_addtid_b32 v121 offset:34048
    ds_write_addtid_b32 v122 offset:34304
    ds_write_addtid_b32 v123 offset:34560
    buffer_load_dwordx4 v[120:123], v3, s[16:19], s40 offen offset:3072
    v_mfma_f32_4x4x4_16b_bf16 v[80:83], v[8:9], v[102:103], 0
    v_mfma_f32_4x4x4_16b_bf16 v[76:79], v[8:9], v[100:101], 0
    v_bitop3_b32 v15, v6, v15, v46 bitop3:0xca
    v_bitop3_b32 v14, v6, v14, v47 bitop3:0xca
    v_cmp_lt_u32 s[84:85], v5, v92
    s_nop 0
    v_pk_mul_f32 v[80:81], v[80:81], v[14:15] op_sel:[0,1] op_sel_hi:[1,1]
    v_pk_mul_f32 v[82:83], v[82:83], v[14:15] op_sel:[0,1] op_sel_hi:[1,1]
    v_pk_mul_f32 v[76:77], v[76:77], v[14:15] op_sel:[0,0] op_sel_hi:[1,0]
    v_pk_mul_f32 v[78:79], v[78:79], v[14:15] op_sel:[0,0] op_sel_hi:[1,0]
    v_mov_b32 v44, v43
    s_cmp_gt_u32 s37, 1024
    s_cbranch_scc1 L2_xs97
    s_cmp_lg_u32 s101, 0
    s_cbranch_scc1 L2_xa97
L2_xb97:
    v_lshlrev_b32 v89, 16, v96
    v_add_u32 v90, 60, v97
    v_bitop3_b32 v90, v89, v45, v90 bitop3:0x6a
    ds_write_b32 v98, v90 offset:12
    v_lshlrev_b32 v89, 20, v96
    v_add_u32 v90, 40, v97
    v_bitop3_b32 v90, v89, v45, v90 bitop3:0x6a
    ds_write_b32 v98, v90 offset:8
    v_lshlrev_b32 v89, 24, v96
    v_add_u32 v90, 20, v97
    v_bitop3_b32 v90, v89, v45, v90 bitop3:0x6a
    ds_write_b32 v98, v90 offset:4
    v_lshlrev_b32 v89, 28, v96
    v_bitop3_b32 v90, v89, v45, v97 bitop3:0x6a
    ds_write_b32 v98, v90 offset:0
    v_mov_b32_dpp v91, v64 quad_perm:[1,1,1,1] row_mask:0xf bank_mask:0xf
    v_and_b32 v89, 3, v91
    v_and_b32 v97, 0xfffc, v91
    v_sub_u16_dpp v88, v64, v91 quad_perm:[3,3,3,3] row_mask:0xf bank_mask:0xf
    v_mad_u32_u24 v97, v97, 5, v4
    v_add_u32 v99, v88, v89
    v_bfm_b32 v96, v88, v89
    v_cmp_lt_u32 s[58:59], 16, v99
    v_lshlrev_b32 v89, v1, v96
    v_and_b32 v89, v45, v89
    v_cmp_ne_u32 vcc, 0, v89
    v_xor_b32 v90, v97, v89
    s_add_u32 s3, s37, s38
    v_mbcnt_lo_u32_b32 v98, vcc_lo, 0
    v_mbcnt_hi_u32_b32 v98, vcc_hi, v98
    s_bcnt1_i32_b64 s41, vcc
    v_lshl_add_u32 v98, v98, 2, s3
    s_mov_b64 exec, vcc
    ds_write_b32 v98, v90
    s_mov_b64 exec, -1
    s_lshl2_add_u32 s37, s41, s37
    s_cmp_lg_u64 s[58:59], 0
    s_cbranch_scc1 L2_xe97
L2_xr97:
    v_add_u32 v98, s37, v0
    v_mov_b32 v90, -1
    ds_write_b32 v98, v90
    ds_read2st64_b32 v[40:41], v0 offset0:0 offset1:1
    ds_read2st64_b32 v[42:43], v0 offset0:2 offset1:3
    s_sub_u32 s3, s37, 768
    s_cmp_gt_u32 s3, 256
    s_cbranch_scc1 L2_xf97
L2_xg97:
    s_setprio 2
    ds_write_addtid_b32 v124 offset:34816
    ds_write_addtid_b32 v125 offset:35072
    ds_write_addtid_b32 v126 offset:35328
    ds_write_addtid_b32 v127 offset:35584
    s_add_u32 s3, s40, 4096
    buffer_load_dwordx4 v[124:127], v3, s[16:19], s3 offen
    s_waitcnt lgkmcnt(14)
    v_cmp_ne_u64 s[50:51], v[72:73], v[68:69]
    v_cmpx_ne_u64 s[54:55], v[74:75], v[70:71]
    s_and_b64 s[82:83], s[54:55], s[80:81]
    s_cbranch_scc1 L2_c98
L2_d98:
    v_mov_b64 v[84:85], v[70:71]
    v_mov_b32 v7, v95
    v_mov_b64 v[86:87], v[74:75]
    s_or_b64 s[80:81], s[80:81], s[54:55]
    s_mov_b64 exec, s[50:51]
    s_and_b64 s[82:83], s[50:51], s[80:81]
    s_cbranch_scc1 L2_c99
L2_d99:
    v_mov_b64 v[84:85], v[68:69]
    v_mov_b32 v7, v94
    v_mov_b64 v[86:87], v[72:73]
    s_mov_b64 exec, -1
    s_or_b64 s[80:81], s[80:81], s[50:51]
    ds_read_b64 v[70:71], v93 offset:65408
    s_and_b64 exec, s[84:85], s[80:81]
    v_mfma_f32_4x4x4_16b_bf16 v[76:79], v[12:13], v[84:85], 0
    v_mov_b32 v92, v7
    s_andn2_b64 s[80:81], s[80:81], s[84:85]
    v_mfma_f32_4x4x4_16b_bf16 v[76:79], v[10:11], v[86:87], v[76:79]
    s_mov_b64 exec, -1
    ds_read_b64 v[68:69], v92 offset:65408
    s_setprio 1
    s_waitcnt vmcnt(10)
    s_mov_b32 m0, s38
    s_nop 0
    ds_write_addtid_b32 v108 offset:0
    ds_write_addtid_b32 v109 offset:256
    ds_write_addtid_b32 v110 offset:512
    ds_write_addtid_b32 v111 offset:768
    s_waitcnt lgkmcnt(4)
    v_mfma_f32_4x4x4_16b_bf16 v[80:83], v[10:11], v[70:71], v[80:83]
    v_mfma_f32_4x4x4_16b_bf16 v[76:79], v[10:11], v[68:69], v[76:79]
    v_and_b32 v46, 0x40000000, v39
    v_bitop3_b32 v94, v36, v5, v46 bitop3:0xea
    v_and_b32 v46, 0x80000000, v39
    v_bitop3_b32 v95, v37, v5, v46 bitop3:0xea
    v_perm_b32 v15, v37, v38, s47
    v_bitop3_b32 v46, v37, 0.5, -0.5 bitop3:0xa8
    v_perm_b32 v14, v36, v38, s46
    v_bitop3_b32 v47, v36, 0.5, -0.5 bitop3:0xa8
    v_cvt_pk_bf16_f32 v80, v80, v81
    v_cvt_pk_bf16_f32 v81, v82, v83
    ds_wrxchg_rtn_b64 v[74:75], v93, v[80:81] offset:65408
    v_cvt_pk_bf16_f32 v76, v76, v77
    v_cvt_pk_bf16_f32 v77, v78, v79
    ds_wrxchg_rtn_b64 v[72:73], v92, v[76:77] offset:65408
    v_and_b32 v88, 0x0fffffff, v44
    v_mov_b32 v39, v44
    buffer_load_dwordx2 v[34:35], v88, s[8:11], 0 offen
    buffer_load_dwordx3 v[36:38], v88, s[8:11], 0 offen offset:8
    s_setprio 0
    s_waitcnt vmcnt(11)
    ds_write_addtid_b32 v112 offset:1024
    ds_write_addtid_b32 v113 offset:1280
    ds_write_addtid_b32 v114 offset:1536
    ds_write_addtid_b32 v115 offset:1792
    v_mfma_f32_4x4x4_16b_bf16 v[80:83], v[8:9], v[106:107], 0
    v_mfma_f32_4x4x4_16b_bf16 v[76:79], v[8:9], v[104:105], 0
    v_bitop3_b32 v15, v6, v15, v46 bitop3:0xca
    v_bitop3_b32 v14, v6, v14, v47 bitop3:0xca
    s_nop 1
    v_pk_mul_f32 v[80:81], v[80:81], v[14:15] op_sel:[0,1] op_sel_hi:[1,1]
    v_pk_mul_f32 v[82:83], v[82:83], v[14:15] op_sel:[0,1] op_sel_hi:[1,1]
    v_pk_mul_f32 v[76:77], v[76:77], v[14:15] op_sel:[0,0] op_sel_hi:[1,0]
    v_pk_mul_f32 v[78:79], v[78:79], v[14:15] op_sel:[0,0] op_sel_hi:[1,0]
    s_add_u32 s42, s42, 1
    s_waitcnt lgkmcnt(0)
    s_barrier
    s_bitcmp1_b32 s36, s42
    s_cbranch_scc1 L2_slow
L2_ret5:
    s_setprio 3
    buffer_load_dwordx4 v[108:111], v3, s[16:19], s40 offen offset:0
    v_cmp_ne_u64 s[50:51], v[72:73], v[68:69]
    v_cmpx_ne_u64 s[54:55], v[74:75], v[70:71]
    s_and_b64 s[82:83], s[54:55], s[80:81]
    s_cbranch_scc1 L2_c100
L2_d100:
    v_mov_b64 v[84:85], v[70:71]
    v_mov_b32 v7, v93
    v_mov_b64 v[86:87], v[74:75]
    s_or_b64 s[80:81], s[80:81], s[54:55]
    s_mov_b64 exec, s[50:51]
    s_and_b64 s[82:83], s[50:51], s[80:81]
    s_cbranch_scc1 L2_c101
L2_d101:
    v_mov_b64 v[84:85], v[68:69]
    v_mov_b32 v7, v92
    v_mov_b64 v[86:87], v[72:73]
    s_mov_b64 exec, -1
    s_or_b64 s[80:81], s[80:81], s[50:51]
    ds_read_b64 v[70:71], v95 offset:65408
    ds_read_b64 v[68:69], v94 offset:65408
    s_waitcnt vmcnt(10)
    v_and_b32 v46, 0x20000000, v21
    v_lshrrev_b32 v47, 14, v17
    v_bitop3_b32 v47, v47, v5, v46 bitop3:0xea
    ds_read_b64 v[102:103], v47
    v_bitop3_b32 v93, v17, v5, v46 bitop3:0xea
    v_and_b32 v46, 0x10000000, v21
    v_lshrrev_b32 v47, 14, v16
    v_bitop3_b32 v47, v47, v5, v46 bitop3:0xea
    ds_read_b64 v[100:101], v47
    v_bitop3_b32 v92, v16, v5, v46 bitop3:0xea
    s_waitcnt lgkmcnt(2)
    v_mfma_f32_4x4x4_16b_bf16 v[80:83], v[10:11], v[70:71], v[80:83]
    v_mfma_f32_4x4x4_16b_bf16 v[76:79], v[10:11], v[68:69], v[76:79]
    v_perm_b32 v15, v17, v20, s45
    v_bitop3_b32 v46, v17, 0.5, -0.5 bitop3:0xa8
    v_perm_b32 v14, v16, v20, s44
    v_bitop3_b32 v47, v16, 0.5, -0.5 bitop3:0xa8
    v_cvt_pk_bf16_f32 v80, v80, v81
    v_cvt_pk_bf16_f32 v81, v82, v83
    ds_wrxchg_rtn_b64 v[74:75], v95, v[80:81] offset:65408
    v_cvt_pk_bf16_f32 v76, v76, v77
    v_cvt_pk_bf16_f32 v77, v78, v79
    ds_wrxchg_rtn_b64 v[72:73], v94, v[76:77] offset:65408
    s_waitcnt lgkmcnt(2)
    v_mfma_f32_4x4x4_16b_bf16 v[80:83], v[8:9], v[102:103], 0
    v_mfma_f32_4x4x4_16b_bf16 v[76:79], v[8:9], v[100:101], 0
    v_bitop3_b32 v15, v6, v15, v46 bitop3:0xca
    v_bitop3_b32 v14, v6, v14, v47 bitop3:0xca
    v_cmp_lt_u32 s[84:85], v5, v92
    s_nop 0
    v_pk_mul_f32 v[80:81], v[80:81], v[14:15] op_sel:[0,1] op_sel_hi:[1,1]
    v_pk_mul_f32 v[82:83], v[82:83], v[14:15] op_sel:[0,1] op_sel_hi:[1,1]
    v_pk_mul_f32 v[76:77], v[76:77], v[14:15] op_sel:[0,0] op_sel_hi:[1,0]
    v_pk_mul_f32 v[78:79], v[78:79], v[14:15] op_sel:[0,0] op_sel_hi:[1,0]
    buffer_load_dwordx4 v[112:115], v3, s[16:19], s40 offen offset:1024
    s_waitcnt lgkmcnt(0)
    v_cmp_ne_u64 s[50:51], v[72:73], v[68:69]
    v_cmpx_ne_u64 s[54:55], v[74:75], v[70:71]
    s_and_b64 s[82:83], s[54:55], s[80:81]
    s_cbranch_scc1 L2_c102
L2_d102:
    v_mov_b64 v[84:85], v[70:71]
    v_mov_b32 v7, v95
    v_mov_b64 v[86:87], v[74:75]
    s_or_b64 s[80:81], s[80:81], s[54:55]
    s_mov_b64 exec, s[50:51]
    s_and_b64 s[82:83], s[50:51], s[80:81]
    s_cbranch_scc1 L2_c103
L2_d103:
    v_mov_b64 v[84:85], v[68:69]
    v_mov_b32 v7, v94
    v_mov_b64 v[86:87], v[72:73]
    s_mov_b64 exec, -1
    s_or_b64 s[80:81], s[80:81], s[50:51]
    ds_read_b64 v[70:71], v93 offset:65408
    s_and_b64 exec, s[84:85], s[80:81]
    v_mfma_f32_4x4x4_16b_bf16 v[76:79], v[12:13], v[84:85], 0
    v_mov_b32 v92, v7
    s_andn2_b64 s[80:81], s[80:81], s[84:85]
    v_mfma_f32_4x4x4_16b_bf16 v[76:79], v[10:11], v[86:87], v[76:79]
    s_mov_b64 exec, -1
    ds_read_b64 v[68:69], v92 offset:65408
    v_and_b32 v46, 0x80000000, v21
    v_lshrrev_b32 v47, 14, v19
    v_bitop3_b32 v47, v47, v5, v46 bitop3:0xea
    ds_read_b64 v[106:107], v47
    v_bitop3_b32 v95, v19, v5, v46 bitop3:0xea
    v_and_b32 v46, 0x40000000, v21
    v_lshrrev_b32 v47, 14, v18
    v_bitop3_b32 v47, v47, v5, v46 bitop3:0xea
    ds_read_b64 v[104:105], v47
    v_bitop3_b32 v94, v18, v5, v46 bitop3:0xea
    s_waitcnt lgkmcnt(2)
    v_mfma_f32_4x4x4_16b_bf16 v[80:83], v[10:11], v[70:71], v[80:83]
    v_mfma_f32_4x4x4_16b_bf16 v[76:79], v[10:11], v[68:69], v[76:79]
    v_perm_b32 v15, v19, v20, s47
    v_bitop3_b32 v46, v19, 0.5, -0.5 bitop3:0xa8
    v_perm_b32 v14, v18, v20, s46
    v_bitop3_b32 v47, v18, 0.5, -0.5 bitop3:0xa8
    v_cvt_pk_bf16_f32 v80, v80, v81
    v_cvt_pk_bf16_f32 v81, v82, v83
    ds_wrxchg_rtn_b64 v[74:75], v93, v[80:81] offset:65408
    v_cvt_pk_bf16_f32 v76, v76, v77
    v_cvt_pk_bf16_f32 v77, v78, v79
    ds_wrxchg_rtn_b64 v[72:73], v92, v[76:77] offset:65408
    v_and_b32 v88, 0x0fffffff, v40
    v_mov_b32 v21, v40
    buffer_load_dwordx2 v[16:17], v88, s[8:11], 0 offen
    buffer_load_dwordx3 v[18:20], v88, s[8:11], 0 offen offset:8
    s_setprio 2
    s_waitcnt lgkmcnt(2)
    v_mfma_f32_4x4x4_16b_bf16 v[80:83], v[8:9], v[106:107], 0
    v_mfma_f32_4x4x4_16b_bf16 v[76:79], v[8:9], v[104:105], 0
    v_bitop3_b32 v15, v6, v15, v46 bitop3:0xca
    v_bitop3_b32 v14, v6, v14, v47 bitop3:0xca
    s_nop 1
    v_pk_mul_f32 v[80:81], v[80:81], v[14:15] op_sel:[0,1] op_sel_hi:[1,1]
    v_pk_mul_f32 v[82:83], v[82:83], v[14:15] op_sel:[0,1] op_sel_hi:[1,1]
    v_pk_mul_f32 v[76:77], v[76:77], v[14:15] op_sel:[0,0] op_sel_hi:[1,0]
    v_pk_mul_f32 v[78:79], v[78:79], v[14:15] op_sel:[0,0] op_sel_hi:[1,0]
    v_sub_u16 v88, v62, v54
    v_and_b32 v89, 3, v54
    v_add3_u32 v99, v88, v89, 3
    v_and_b32 v99, -4, v99
    v_max_u32 v99, 4, v99
    v_and_b32 v97, 0xfffc, v54
    v_bfm_b32 v96, v88, v89
    v_add_u32_dpp v91, v99, v99 row_shr:1 row_mask:0xf bank_mask:0xf bound_ctrl:1
    v_mad_u32_u24 v97, v97, 5, v2
    v_cmp_lt_u32 vcc, 16, v99
    v_add_u32_dpp v91, v91, v91 row_shr:2 row_mask:0xf bank_mask:0xf bound_ctrl:1
    v_sub_u32 v98, s38, v99
    v_lshrrev_b64 v[54:55], 16, v[54:55]
    v_add_u32_dpp v91, v91, v91 row_shr:4 row_mask:0xf bank_mask:0xf bound_ctrl:1
    v_lshrrev_b64 v[62:63], 16, v[62:63]
    s_mov_b32 s101, 0
    v_add_u32_dpp v91, v91, v91 row_shr:8 row_mask:0xf bank_mask:0xf bound_ctrl:1
    s_nop 1
    v_add_u32_dpp v91, v91, v91 row_bcast:15 row_mask:0xa bank_mask:0xf
    s_nop 1
    v_add_u32_dpp v91, v91, v91 row_bcast:31 row_mask:0xc bank_mask:0xf
    v_add_u32 v98, v98, v91
    v_readlane_b32 s37, v91, 63
    s_cbranch_vccnz L2_xo104
L2_xp104:
    s_waitcnt lgkmcnt(0)
    v_cmp_ne_u64 s[50:51], v[72:73], v[68:69]
    v_cmpx_ne_u64 s[54:55], v[74:75], v[70:71]
    s_and_b64 s[82:83], s[54:55], s[80:81]
    s_cbranch_scc1 L2_c105
L2_d105:
    v_mov_b64 v[84:85], v[70:71]
    v_mov_b32 v7, v93
    v_mov_b64 v[86:87], v[74:75]
    s_or_b64 s[80:81], s[80:81], s[54:55]
    s_mov_b64 exec, s[50:51]
    s_and_b64 s[82:83], s[50:51], s[80:81]
    s_cbranch_scc1 L2_c106
L2_d106:
    v_mov_b64 v[84:85], v[68:69]
    v_mov_b32 v7, v92
    v_mov_b64 v[86:87], v[72:73]
    s_mov_b64 exec, -1
    s_or_b64 s[80:81], s[80:81], s[50:51]
    ds_read_b64 v[70:71], v95 offset:65408
    ds_read_b64 v[68:69], v94 offset:65408
    s_waitcnt vmcnt(11)
    v_and_b32 v46, 0x20000000, v27
    v_lshrrev_b32 v47, 14, v23
    v_bitop3_b32 v47, v47, v5, v46 bitop3:0xea
    ds_read_b64 v[102:103], v47
    v_bitop3_b32 v93, v23, v5, v46 bitop3:0xea
    v_and_b32 v46, 0x10000000, v27
    v_lshrrev_b32 v47, 14, v22
    v_bitop3_b32 v47, v47, v5, v46 bitop3:0xea
    ds_read_b64 v[100:101], v47
    v_bitop3_b32 v92, v22, v5, v46 bitop3:0xea
    s_waitcnt lgkmcnt(2)
    v_mfma_f32_4x4x4_16b_bf16 v[80:83], v[10:11], v[70:71], v[80:83]
    v_mfma_f32_4x4x4_16b_bf16 v[76:79], v[10:11], v[68:69], v[76:79]
    v_perm_b32 v15, v23, v26, s45
    v_bitop3_b32 v46, v23, 0.5, -0.5 bitop3:0xa8
    v_perm_b32 v14, v22, v26, s44
    v_bitop3_b32 v47, v22, 0.5, -0.5 bitop3:0xa8
    v_cvt_pk_bf16_f32 v80, v80, v81
    v_cvt_pk_bf16_f32 v81, v82, v83
    ds_wrxchg_rtn_b64 v[74:75], v95, v[80:81] offset:65408
    v_cvt_pk_bf16_f32 v76, v76, v77
    v_cvt_pk_bf16_f32 v77, v78, v79
    ds_wrxchg_rtn_b64 v[72:73], v94, v[76:77] offset:65408
    s_waitcnt lgkmcnt(2)
    v_mfma_f32_4x4x4_16b_bf16 v[80:83], v[8:9], v[102:103], 0
    v_mfma_f32_4x4x4_16b_bf16 v[76:79], v[8:9], v[100:101], 0
    v_bitop3_b32 v15, v6, v15, v46 bitop3:0xca
    v_bitop3_b32 v14, v6, v14, v47 bitop3:0xca
    v_cmp_lt_u32 s[84:85], v5, v92
    s_nop 0
    v_pk_mul_f32 v[80:81], v[80:81], v[14:15] op_sel:[0,1] op_sel_hi:[1,1]
    v_pk_mul_f32 v[82:83], v[82:83], v[14:15] op_sel:[0,1] op_sel_hi:[1,1]
    v_pk_mul_f32 v[76:77], v[76:77], v[14:15] op_sel:[0,0] op_sel_hi:[1,0]
    v_pk_mul_f32 v[78:79], v[78:79], v[14:15] op_sel:[0,0] op_sel_hi:[1,0]
    s_waitcnt lgkmcnt(0)
    v_cmp_ne_u64 s[50:51], v[72:73], v[68:69]
    v_cmpx_ne_u64 s[54:55], v[74:75], v[70:71]
    s_and_b64 s[82:83], s[54:55], s[80:81]
    s_cbranch_scc1 L2_c107
L2_d107:
    v_mov_b64 v[84:85], v[70:71]
    v_mov_b32 v7, v95
    v_mov_b64 v[86:87], v[74:75]
    s_or_b64 s[80:81], s[80:81], s[54:55]
    s_mov_b64 exec, s[50:51]
    s_and_b64 s[82:83], s[50:51], s[80:81]
    s_cbranch_scc1 L2_c108
L2_d108:
    v_mov_b64 v[84:85], v[68:69]
    v_mov_b32 v7, v94
    v_mov_b64 v[86:87], v[72:73]
    s_mov_b64 exec, -1
    s_or_b64 s[80:81], s[80:81], s[50:51]
    ds_read_b64 v[70:71], v93 offset:65408
    s_and_b64 exec, s[84:85], s[80:81]
    v_mfma_f32_4x4x4_16b_bf16 v[76:79], v[12:13], v[84:85], 0
    v_mov_b32 v92, v7
    s_andn2_b64 s[80:81], s[80:81], s[84:85]
    v_mfma_f32_4x4x4_16b_bf16 v[76:79], v[10:11], v[86:87], v[76:79]
    s_mov_b64 exec, -1
    ds_read_b64 v[68:69], v92 offset:65408
    v_and_b32 v46, 0x80000000, v27
    v_lshrrev_b32 v47, 14, v25
    v_bitop3_b32 v47, v47, v5, v46 bitop3:0xea
    ds_read_b64 v[106:107], v47
    v_bitop3_b32 v95, v25, v5, v46 bitop3:0xea
    v_and_b32 v46, 0x40000000, v27
    v_lshrrev_b32 v47, 14, v24
    v_bitop3_b32 v47, v47, v5, v46 bitop3:0xea
    ds_read_b64 v[104:105], v47
    v_bitop3_b32 v94, v24, v5, v46 bitop3:0xea
    s_waitcnt lgkmcnt(2)
    v_mfma_f32_4x4x4_16b_bf16 v[80:83], v[10:11], v[70:71], v[80:83]
    v_mfma_f32_4x4x4_16b_bf16 v[76:79], v[10:11], v[68:69], v[76:79]
    v_perm_b32 v15, v25, v26, s47
    v_bitop3_b32 v46, v25, 0.5, -0.5 bitop3:0xa8
    v_perm_b32 v14, v24, v26, s46
    v_bitop3_b32 v47, v24, 0.5, -0.5 bitop3:0xa8
    v_cvt_pk_bf16_f32 v80, v80, v81
    v_cvt_pk_bf16_f32 v81, v82, v83
    ds_wrxchg_rtn_b64 v[74:75], v93, v[80:81] offset:65408
    v_cvt_pk_bf16_f32 v76, v76, v77
    v_cvt_pk_bf16_f32 v77, v78, v79
    ds_wrxchg_rtn_b64 v[72:73], v92, v[76:77] offset:65408
    v_and_b32 v88, 0x0fffffff, v41
    v_mov_b32 v27, v41
    buffer_load_dwordx2 v[22:23], v88, s[8:11], 0 offen
    buffer_load_dwordx3 v[24:26], v88, s[8:11], 0 offen offset:8
    s_setprio 1
    s_waitcnt lgkmcnt(2)
    v_mfma_f32_4x4x4_16b_bf16 v[80:83], v[8:9], v[106:107], 0
    v_mfma_f32_4x4x4_16b_bf16 v[76:79], v[8:9], v[104:105], 0
    v_bitop3_b32 v15, v6, v15, v46 bitop3:0xca
    v_bitop3_b32 v14, v6, v14, v47 bitop3:0xca
    s_nop 1
    v_pk_mul_f32 v[80:81], v[80:81], v[14:15] op_sel:[0,1] op_sel_hi:[1,1]
    v_pk_mul_f32 v[82:83], v[82:83], v[14:15] op_sel:[0,1] op_sel_hi:[1,1]
    v_pk_mul_f32 v[76:77], v[76:77], v[14:15] op_sel:[0,0] op_sel_hi:[1,0]
    v_pk_mul_f32 v[78:79], v[78:79], v[14:15] op_sel:[0,0] op_sel_hi:[1,0]
    s_waitcnt lgkmcnt(0)
    v_cmp_ne_u64 s[50:51], v[72:73], v[68:69]
    v_cmpx_ne_u64 s[54:55], v[74:75], v[70:71]
    s_and_b64 s[82:83], s[54:55], s[80:81]
    s_cbranch_scc1 L2_c109
L2_d109:
    v_mov_b64 v[84:85], v[70:71]
    v_mov_b32 v7, v93
    v_mov_b64 v[86:87], v[74:75]
    s_or_b64 s[80:81], s[80:81], s[54:55]
    s_mov_b64 exec, s[50:51]
    s_and_b64 s[82:83], s[50:51], s[80:81]
    s_cbranch_scc1 L2_c110
L2_d110:
    v_mov_b64 v[84:85], v[68:69]
    v_mov_b32 v7, v92
    v_mov_b64 v[86:87], v[72:73]
    s_mov_b64 exec, -1
    s_or_b64 s[80:81], s[80:81], s[50:51]
    ds_read_b64 v[70:71], v95 offset:65408
    ds_read_b64 v[68:69], v94 offset:65408
    s_waitcnt vmcnt(11)
    v_and_b32 v46, 0x20000000, v33
    v_lshrrev_b32 v47, 14, v29
    v_bitop3_b32 v47, v47, v5, v46 bitop3:0xea
    ds_read_b64 v[102:103], v47
    v_bitop3_b32 v93, v29, v5, v46 bitop3:0xea
    v_and_b32 v46, 0x10000000, v33
    v_lshrrev_b32 v47, 14, v28
    v_bitop3_b32 v47, v47, v5, v46 bitop3:0xea
    ds_read_b64 v[100:101], v47
    v_bitop3_b32 v92, v28, v5, v46 bitop3:0xea
    s_waitcnt lgkmcnt(2)
    v_mfma_f32_4x4x4_16b_bf16 v[80:83], v[10:11], v[70:71], v[80:83]
    v_mfma_f32_4x4x4_16b_bf16 v[76:79], v[10:11], v[68:69], v[76:79]
    v_perm_b32 v15, v29, v32, s45
    v_bitop3_b32 v46, v29, 0.5, -0.5 bitop3:0xa8
    v_perm_b32 v14, v28, v32, s44
    v_bitop3_b32 v47, v28, 0.5, -0.5 bitop3:0xa8
    v_cvt_pk_bf16_f32 v80, v80, v81
    v_cvt_pk_bf16_f32 v81, v82, v83
    ds_wrxchg_rtn_b64 v[74:75], v95, v[80:81] offset:65408
    v_cvt_pk_bf16_f32 v76, v76, v77
    v_cvt_pk_bf16_f32 v77, v78, v79
    ds_wrxchg_rtn_b64 v[72:73], v94, v[76:77] offset:65408
    s_waitcnt lgkmcnt(2)
    v_mfma_f32_4x4x4_16b_bf16 v[80:83], v[8:9], v[102:103], 0
    v_mfma_f32_4x4x4_16b_bf16 v[76:79], v[8:9], v[100:101], 0
    v_bitop3_b32 v15, v6, v15, v46 bitop3:0xca
    v_bitop3_b32 v14, v6, v14, v47 bitop3:0xca
    v_cmp_lt_u32 s[84:85], v5, v92
    s_nop 0
    v_pk_mul_f32 v[80:81], v[80:81], v[14:15] op_sel:[0,1] op_sel_hi:[1,1]
    v_pk_mul_f32 v[82:83], v[82:83], v[14:15] op_sel:[0,1] op_sel_hi:[1,1]
    v_pk_mul_f32 v[76:77], v[76:77], v[14:15] op_sel:[0,0] op_sel_hi:[1,0]
    v_pk_mul_f32 v[78:79], v[78:79], v[14:15] op_sel:[0,0] op_sel_hi:[1,0]
    s_waitcnt lgkmcnt(0)
    v_cmp_ne_u64 s[50:51], v[72:73], v[68:69]
    v_cmpx_ne_u64 s[54:55], v[74:75], v[70:71]
    s_and_b64 s[82:83], s[54:55], s[80:81]
    s_cbranch_scc1 L2_c111
L2_d111:
    v_mov_b64 v[84:85], v[70:71]
    v_mov_b32 v7, v95
    v_mov_b64 v[86:87], v[74:75]
    s_or_b64 s[80:81], s[80:81], s[54:55]
    s_mov_b64 exec, s[50:51]
    s_and_b64 s[82:83], s[50:51], s[80:81]
    s_cbranch_scc1 L2_c112
L2_d112:
    v_mov_b64 v[84:85], v[68:69]
    v_mov_b32 v7, v94
    v_mov_b64 v[86:87], v[72:73]
    s_mov_b64 exec, -1
    s_or_b64 s[80:81], s[80:81], s[50:51]
    ds_read_b64 v[70:71], v93 offset:65408
    s_and_b64 exec, s[84:85], s[80:81]
    v_mfma_f32_4x4x4_16b_bf16 v[76:79], v[12:13], v[84:85], 0
    v_mov_b32 v92, v7
    s_andn2_b64 s[80:81], s[80:81], s[84:85]
    v_mfma_f32_4x4x4_16b_bf16 v[76:79], v[10:11], v[86:87], v[76:79]
    s_mov_b64 exec, -1
    ds_read_b64 v[68:69], v92 offset:65408
    v_and_b32 v46, 0x80000000, v33
    v_lshrrev_b32 v47, 14, v31
    v_bitop3_b32 v47, v47, v5, v46 bitop3:0xea
    ds_read_b64 v[106:107], v47
    v_bitop3_b32 v95, v31, v5, v46 bitop3:0xea
    v_and_b32 v46, 0x40000000, v33
    v_lshrrev_b32 v47, 14, v30
    v_bitop3_b32 v47, v47, v5, v46 bitop3:0xea
    ds_read_b64 v[104:105], v47
    v_bitop3_b32 v94, v30, v5, v46 bitop3:0xea
    s_waitcnt lgkmcnt(2)
    v_mfma_f32_4x4x4_16b_bf16 v[80:83], v[10:11], v[70:71], v[80:83]
    v_mfma_f32_4x4x4_16b_bf16 v[76:79], v[10:11], v[68:69], v[76:79]
    v_perm_b32 v15, v31, v32, s47
    v_bitop3_b32 v46, v31, 0.5, -0.5 bitop3:0xa8
    v_perm_b32 v14, v30, v32, s46
    v_bitop3_b32 v47, v30, 0.5, -0.5 bitop3:0xa8
    v_cvt_pk_bf16_f32 v80, v80, v81
    v_cvt_pk_bf16_f32 v81, v82, v83
    ds_wrxchg_rtn_b64 v[74:75], v93, v[80:81] offset:65408
    v_cvt_pk_bf16_f32 v76, v76, v77
    v_cvt_pk_bf16_f32 v77, v78, v79
    ds_wrxchg_rtn_b64 v[72:73], v92, v[76:77] offset:65408
    v_and_b32 v88, 0x0fffffff, v42
    v_mov_b32 v33, v42
    buffer_load_dwordx2 v[28:29], v88, s[8:11], 0 offen
    buffer_load_dwordx3 v[30:32], v88, s[8:11], 0 offen offset:8
    s_setprio 0
    s_waitcnt lgkmcnt(2)
    v_mfma_f32_4x4x4_16b_bf16 v[80:83], v[8:9], v[106:107], 0
    v_mfma_f32_4x4x4_16b_bf16 v[76:79], v[8:9], v[104:105], 0
    v_bitop3_b32 v15, v6, v15, v46 bitop3:0xca
    v_bitop3_b32 v14, v6, v14, v47 bitop3:0xca
    s_nop 1
    v_pk_mul_f32 v[80:81], v[80:81], v[14:15] op_sel:[0,1] op_sel_hi:[1,1]
    v_pk_mul_f32 v[82:83], v[82:83], v[14:15] op_sel:[0,1] op_sel_hi:[1,1]
    v_pk_mul_f32 v[76:77], v[76:77], v[14:15] op_sel:[0,0] op_sel_hi:[1,0]
    v_pk_mul_f32 v[78:79], v[78:79], v[14:15] op_sel:[0,0] op_sel_hi:[1,0]
    s_add_u32 s40, s40, 0x50000
    s_waitcnt lgkmcnt(0)
    v_cmp_ne_u64 s[50:51], v[72:73], v[68:69]
    v_cmpx_ne_u64 s[54:55], v[74:75], v[70:71]
    s_and_b64 s[82:83], s[54:55], s[80:81]
    s_cbranch_scc1 L2_c113
L2_d113:
    v_mov_b64 v[84:85], v[70:71]
    v_mov_b32 v7, v93
    v_mov_b64 v[86:87], v[74:75]
    s_or_b64 s[80:81], s[80:81], s[54:55]
    s_mov_b64 exec, s[50:51]
    s_and_b64 s[82:83], s[50:51], s[80:81]
    s_cbranch_scc1 L2_c114
L2_d114:
    v_mov_b64 v[84:85], v[68:69]
    v_mov_b32 v7, v92
    v_mov_b64 v[86:87], v[72:73]
    s_mov_b64 exec, -1
    s_or_b64 s[80:81], s[80:81], s[50:51]
    ds_read_b64 v[70:71], v95 offset:65408
    ds_read_b64 v[68:69], v94 offset:65408
    s_waitcnt vmcnt(8)
    v_and_b32 v46, 0x20000000, v39
    v_lshrrev_b32 v47, 14, v35
    v_bitop3_b32 v47, v47, v5, v46 bitop3:0xea
    ds_read_b64 v[102:103], v47
    v_bitop3_b32 v93, v35, v5, v46 bitop3:0xea
    v_and_b32 v46, 0x10000000, v39
    v_lshrrev_b32 v47, 14, v34
    v_bitop3_b32 v47, v47, v5, v46 bitop3:0xea
    ds_read_b64 v[100:101], v47
    v_bitop3_b32 v92, v34, v5, v46 bitop3:0xea
    v_and_b32 v46, 0x80000000, v39
    v_lshrrev_b32 v47, 14, v37
    v_bitop3_b32 v47, v47, v5, v46 bitop3:0xea
    ds_read_b64 v[106:107], v47
    v_and_b32 v46, 0x40000000, v39
    v_lshrrev_b32 v47, 14, v36
    v_bitop3_b32 v47, v47, v5, v46 bitop3:0xea
    ds_read_b64 v[104:105], v47
    s_waitcnt lgkmcnt(4)
    v_mfma_f32_4x4x4_16b_bf16 v[80:83], v[10:11], v[70:71], v[80:83]
    v_mfma_f32_4x4x4_16b_bf16 v[76:79], v[10:11], v[68:69], v[76:79]
    v_perm_b32 v15, v35, v38, s45
    v_bitop3_b32 v46, v35, 0.5, -0.5 bitop3:0xa8
    v_perm_b32 v14, v34, v38, s44
    v_bitop3_b32 v47, v34, 0.5, -0.5 bitop3:0xa8
    v_cvt_pk_bf16_f32 v80, v80, v81
    v_cvt_pk_bf16_f32 v81, v82, v83
    ds_wrxchg_rtn_b64 v[74:75], v95, v[80:81] offset:65408
    v_cvt_pk_bf16_f32 v76, v76, v77
    v_cvt_pk_bf16_f32 v77, v78, v79
    ds_wrxchg_rtn_b64 v[72:73], v94, v[76:77] offset:65408
    s_waitcnt lgkmcnt(2)
    s_barrier
    s_setprio 3
    s_mov_b32 m0, s100
    s_nop 0
    ds_write_addtid_b32 v116 offset:32768
    ds_write_addtid_b32 v117 offset:33024
    ds_write_addtid_b32 v118 offset:33280
    ds_write_addtid_b32 v119 offset:33536
    buffer_load_dwordx4 v[116:119], v3, s[16:19], s40 offen offset:2048
    ds_write_addtid_b32 v120 offset:33792
    ds_write_addtid_b32 v121 offset:34048
    ds_write_addtid_b32 v122 offset:34304
    ds_write_addtid_b32 v123 offset:34560
    buffer_load_dwordx4 v[120:123], v3, s[16:19], s40 offen offset:3072
    v_mfma_f32_4x4x4_16b_bf16 v[80:83], v[8:9], v[102:103], 0
    v_mfma_f32_4x4x4_16b_bf16 v[76:79], v[8:9], v[100:101], 0
    v_bitop3_b32 v15, v6, v15, v46 bitop3:0xca
    v_bitop3_b32 v14, v6, v14, v47 bitop3:0xca
    v_cmp_lt_u32 s[84:85], v5, v92
    s_nop 0
    v_pk_mul_f32 v[80:81], v[80:81], v[14:15] op_sel:[0,1] op_sel_hi:[1,1]
    v_pk_mul_f32 v[82:83], v[82:83], v[14:15] op_sel:[0,1] op_sel_hi:[1,1]
    v_pk_mul_f32 v[76:77], v[76:77], v[14:15] op_sel:[0,0] op_sel_hi:[1,0]
    v_pk_mul_f32 v[78:79], v[78:79], v[14:15] op_sel:[0,0] op_sel_hi:[1,0]
    v_mov_b32 v44, v43
    s_cmp_gt_u32 s37, 1024
    s_cbranch_scc1 L2_xs115
    s_cmp_lg_u32 s101, 0
    s_cbranch_scc1 L2_xa115
L2_xb115:
    v_lshlrev_b32 v89, 16, v96
    v_add_u32 v90, 60, v97
    v_bitop3_b32 v90, v89, v45, v90 bitop3:0x6a
    ds_write_b32 v98, v90 offset:12
    v_lshlrev_b32 v89, 20, v96
    v_add_u32 v90, 40, v97
    v_bitop3_b32 v90, v89, v45, v90 bitop3:0x6a
    ds_write_b32 v98, v90 offset:8
    v_lshlrev_b32 v89, 24, v96
    v_add_u32 v90, 20, v97
    v_bitop3_b32 v90, v89, v45, v90 bitop3:0x6a
    ds_write_b32 v98, v90 offset:4
    v_lshlrev_b32 v89, 28, v96
    v_bitop3_b32 v90, v89, v45, v97 bitop3:0x6a
    ds_write_b32 v98, v90 offset:0
    v_mov_b32_dpp v91, v66 quad_perm:[1,1,1,1] row_mask:0xf bank_mask:0xf
    v_and_b32 v89, 3, v91
    v_and_b32 v97, 0xfffc, v91
    v_sub_u16_dpp v88, v66, v91 quad_perm:[3,3,3,3] row_mask:0xf bank_mask:0xf
    v_mad_u32_u24 v97, v97, 5, v4
    v_add_u32 v99, v88, v89
    v_bfm_b32 v96, v88, v89
    v_cmp_lt_u32 s[58:59], 16, v99
    v_lshlrev_b32 v89, v1, v96
    v_and_b32 v89, v45, v89
    v_cmp_ne_u32 vcc, 0, v89
    v_xor_b32 v90, v97, v89
    s_add_u32 s3, s37, s38
    v_mbcnt_lo_u32_b32 v98, vcc_lo, 0
    v_mbcnt_hi_u32_b32 v98, vcc_hi, v98
    s_bcnt1_i32_b64 s41, vcc
    v_lshl_add_u32 v98, v98, 2, s3
    s_mov_b64 exec, vcc
    ds_write_b32 v98, v90
    s_mov_b64 exec, -1
    s_lshl2_add_u32 s37, s41, s37
    s_cmp_lg_u64 s[58:59], 0
    s_cbranch_scc1 L2_xe115
L2_xr115:
    v_add_u32 v98, s37, v0
    v_mov_b32 v90, -1
    ds_write_b32 v98, v90
    ds_read2st64_b32 v[40:41], v0 offset0:0 offset1:1
    ds_read2st64_b32 v[42:43], v0 offset0:2 offset1:3
    s_sub_u32 s3, s37, 768
    s_cmp_gt_u32 s3, 256
    s_cbranch_scc1 L2_xf115
L2_xg115:
    v_lshrrev_b64 v[64:65], 16, v[64:65]
    v_lshrrev_b64 v[66:67], 16, v[66:67]
    s_setprio 2
    ds_write_addtid_b32 v124 offset:34816
    ds_write_addtid_b32 v125 offset:35072
    ds_write_addtid_b32 v126 offset:35328
    ds_write_addtid_b32 v127 offset:35584
    s_add_u32 s3, s40, 4096
    buffer_load_dwordx4 v[124:127], v3, s[16:19], s3 offen
    s_waitcnt lgkmcnt(14)
    v_cmp_ne_u64 s[50:51], v[72:73], v[68:69]
    v_cmpx_ne_u64 s[54:55], v[74:75], v[70:71]
    s_and_b64 s[82:83], s[54:55], s[80:81]
    s_cbranch_scc1 L2_c116
L2_d116:
    v_mov_b64 v[84:85], v[70:71]
    v_mov_b32 v7, v95
    v_mov_b64 v[86:87], v[74:75]
    s_or_b64 s[80:81], s[80:81], s[54:55]
    s_mov_b64 exec, s[50:51]
    s_and_b64 s[82:83], s[50:51], s[80:81]
    s_cbranch_scc1 L2_c117
L2_d117:
    v_mov_b64 v[84:85], v[68:69]
    v_mov_b32 v7, v94
    v_mov_b64 v[86:87], v[72:73]
    s_mov_b64 exec, -1
    s_or_b64 s[80:81], s[80:81], s[50:51]
    ds_read_b64 v[70:71], v93 offset:65408
    s_and_b64 exec, s[84:85], s[80:81]
    v_mfma_f32_4x4x4_16b_bf16 v[76:79], v[12:13], v[84:85], 0
    v_mov_b32 v92, v7
    s_andn2_b64 s[80:81], s[80:81], s[84:85]
    v_mfma_f32_4x4x4_16b_bf16 v[76:79], v[10:11], v[86:87], v[76:79]
    s_mov_b64 exec, -1
    ds_read_b64 v[68:69], v92 offset:65408
    s_setprio 1
    s_waitcnt vmcnt(10)
    s_mov_b32 m0, s38
    s_nop 0
    ds_write_addtid_b32 v108 offset:0
    ds_write_addtid_b32 v109 offset:256
    ds_write_addtid_b32 v110 offset:512
    ds_write_addtid_b32 v111 offset:768
    s_waitcnt lgkmcnt(4)
    v_mfma_f32_4x4x4_16b_bf16 v[80:83], v[10:11], v[70:71], v[80:83]
    v_mfma_f32_4x4x4_16b_bf16 v[76:79], v[10:11], v[68:69], v[76:79]
    v_and_b32 v46, 0x40000000, v39
    v_bitop3_b32 v94, v36, v5, v46 bitop3:0xea
    v_and_b32 v46, 0x80000000, v39
    v_bitop3_b32 v95, v37, v5, v46 bitop3:0xea
    v_perm_b32 v15, v37, v38, s47
    v_bitop3_b32 v46, v37, 0.5, -0.5 bitop3:0xa8
    v_perm_b32 v14, v36, v38, s46
    v_bitop3_b32 v47, v36, 0.5, -0.5 bitop3:0xa8
    v_cvt_pk_bf16_f32 v80, v80, v81
    v_cvt_pk_bf16_f32 v81, v82, v83
    ds_wrxchg_rtn_b64 v[74:75], v93, v[80:81] offset:65408
    v_cvt_pk_bf16_f32 v76, v76, v77
    v_cvt_pk_bf16_f32 v77, v78, v79
    ds_wrxchg_rtn_b64 v[72:73], v92, v[76:77] offset:65408
    v_and_b32 v88, 0x0fffffff, v44
    v_mov_b32 v39, v44
    buffer_load_dwordx2 v[34:35], v88, s[8:11], 0 offen
    buffer_load_dwordx3 v[36:38], v88, s[8:11], 0 offen offset:8
    s_setprio 0
    s_waitcnt vmcnt(11)
    ds_write_addtid_b32 v112 offset:1024
    ds_write_addtid_b32 v113 offset:1280
    ds_write_addtid_b32 v114 offset:1536
    ds_write_addtid_b32 v115 offset:1792
    v_mfma_f32_4x4x4_16b_bf16 v[80:83], v[8:9], v[106:107], 0
    v_mfma_f32_4x4x4_16b_bf16 v[76:79], v[8:9], v[104:105], 0
    v_bitop3_b32 v15, v6, v15, v46 bitop3:0xca
    v_bitop3_b32 v14, v6, v14, v47 bitop3:0xca
    s_nop 1
    v_pk_mul_f32 v[80:81], v[80:81], v[14:15] op_sel:[0,1] op_sel_hi:[1,1]
    v_pk_mul_f32 v[82:83], v[82:83], v[14:15] op_sel:[0,1] op_sel_hi:[1,1]
    v_pk_mul_f32 v[76:77], v[76:77], v[14:15] op_sel:[0,0] op_sel_hi:[1,0]
    v_pk_mul_f32 v[78:79], v[78:79], v[14:15] op_sel:[0,0] op_sel_hi:[1,0]
    s_add_u32 s42, s42, 1
    s_waitcnt lgkmcnt(0)
    s_cmp_lg_u32 s42, 14
    s_cbranch_scc1 L2_loop
    s_barrier
    s_bitcmp1_b32 s36, s42
    s_cbranch_scc1 L2_slow
L2_ret6:
    s_setprio 3
    buffer_load_dwordx4 v[108:111], v3, s[16:19], s40 offen offset:0
    v_cmp_ne_u64 s[50:51], v[72:73], v[68:69]
    v_cmpx_ne_u64 s[54:55], v[74:75], v[70:71]
    s_and_b64 s[82:83], s[54:55], s[80:81]
    s_cbranch_scc1 L2_c118
L2_d118:
    v_mov_b64 v[84:85], v[70:71]
    v_mov_b32 v7, v93
    v_mov_b64 v[86:87], v[74:75]
    s_or_b64 s[80:81], s[80:81], s[54:55]
    s_mov_b64 exec, s[50:51]
    s_and_b64 s[82:83], s[50:51], s[80:81]
    s_cbranch_scc1 L2_c119
L2_d119:
    v_mov_b64 v[84:85], v[68:69]
    v_mov_b32 v7, v92
    v_mov_b64 v[86:87], v[72:73]
    s_mov_b64 exec, -1
    s_or_b64 s[80:81], s[80:81], s[50:51]
    ds_read_b64 v[70:71], v95 offset:65408
    ds_read_b64 v[68:69], v94 offset:65408
    s_waitcnt vmcnt(10)
    v_and_b32 v46, 0x20000000, v21
    v_lshrrev_b32 v47, 14, v17
    v_bitop3_b32 v47, v47, v5, v46 bitop3:0xea
    ds_read_b64 v[102:103], v47
    v_bitop3_b32 v93, v17, v5, v46 bitop3:0xea
    v_and_b32 v46, 0x10000000, v21
    v_lshrrev_b32 v47, 14, v16
    v_bitop3_b32 v47, v47, v5, v46 bitop3:0xea
    ds_read_b64 v[100:101], v47
    v_bitop3_b32 v92, v16, v5, v46 bitop3:0xea
    s_waitcnt lgkmcnt(2)
    v_mfma_f32_4x4x4_16b_bf16 v[80:83], v[10:11], v[70:71], v[80:83]
    v_mfma_f32_4x4x4_16b_bf16 v[76:79], v[10:11], v[68:69], v[76:79]
    v_perm_b32 v15, v17, v20, s45
    v_bitop3_b32 v46, v17, 0.5, -0.5 bitop3:0xa8
    v_perm_b32 v14, v16, v20, s44
    v_bitop3_b32 v47, v16, 0.5, -0.5 bitop3:0xa8
    v_cvt_pk_bf16_f32 v80, v80, v81
    v_cvt_pk_bf16_f32 v81, v82, v83
    ds_wrxchg_rtn_b64 v[74:75], v95, v[80:81] offset:65408
    v_cvt_pk_bf16_f32 v76, v76, v77
    v_cvt_pk_bf16_f32 v77, v78, v79
    ds_wrxchg_rtn_b64 v[72:73], v94, v[76:77] offset:65408
    s_waitcnt lgkmcnt(2)
    v_mfma_f32_4x4x4_16b_bf16 v[80:83], v[8:9], v[102:103], 0
    v_mfma_f32_4x4x4_16b_bf16 v[76:79], v[8:9], v[100:101], 0
    v_bitop3_b32 v15, v6, v15, v46 bitop3:0xca
    v_bitop3_b32 v14, v6, v14, v47 bitop3:0xca
    v_cmp_lt_u32 s[84:85], v5, v92
    s_nop 0
    v_pk_mul_f32 v[80:81], v[80:81], v[14:15] op_sel:[0,1] op_sel_hi:[1,1]
    v_pk_mul_f32 v[82:83], v[82:83], v[14:15] op_sel:[0,1] op_sel_hi:[1,1]
    v_pk_mul_f32 v[76:77], v[76:77], v[14:15] op_sel:[0,0] op_sel_hi:[1,0]
    v_pk_mul_f32 v[78:79], v[78:79], v[14:15] op_sel:[0,0] op_sel_hi:[1,0]
    buffer_load_dwordx4 v[112:115], v3, s[16:19], s40 offen offset:1024
    s_waitcnt lgkmcnt(0)
    v_cmp_ne_u64 s[50:51], v[72:73], v[68:69]
    v_cmpx_ne_u64 s[54:55], v[74:75], v[70:71]
    s_and_b64 s[82:83], s[54:55], s[80:81]
    s_cbranch_scc1 L2_c120
L2_d120:
    v_mov_b64 v[84:85], v[70:71]
    v_mov_b32 v7, v95
    v_mov_b64 v[86:87], v[74:75]
    s_or_b64 s[80:81], s[80:81], s[54:55]
    s_mov_b64 exec, s[50:51]
    s_and_b64 s[82:83], s[50:51], s[80:81]
    s_cbranch_scc1 L2_c121
L2_d121:
    v_mov_b64 v[84:85], v[68:69]
    v_mov_b32 v7, v94
    v_mov_b64 v[86:87], v[72:73]
    s_mov_b64 exec, -1
    s_or_b64 s[80:81], s[80:81], s[50:51]
    ds_read_b64 v[70:71], v93 offset:65408
    s_and_b64 exec, s[84:85], s[80:81]
    v_mfma_f32_4x4x4_16b_bf16 v[76:79], v[12:13], v[84:85], 0
    v_mov_b32 v92, v7
    s_andn2_b64 s[80:81], s[80:81], s[84:85]
    v_mfma_f32_4x4x4_16b_bf16 v[76:79], v[10:11], v[86:87], v[76:79]
    s_mov_b64 exec, -1
    ds_read_b64 v[68:69], v92 offset:65408
    v_and_b32 v46, 0x80000000, v21
    v_lshrrev_b32 v47, 14, v19
    v_bitop3_b32 v47, v47, v5, v46 bitop3:0xea
    ds_read_b64 v[106:107], v47
    v_bitop3_b32 v95, v19, v5, v46 bitop3:0xea
    v_and_b32 v46, 0x40000000, v21
    v_lshrrev_b32 v47, 14, v18
    v_bitop3_b32 v47, v47, v5, v46 bitop3:0xea
    ds_read_b64 v[104:105], v47
    v_bitop3_b32 v94, v18, v5, v46 bitop3:0xea
    s_waitcnt lgkmcnt(2)
    v_mfma_f32_4x4x4_16b_bf16 v[80:83], v[10:11], v[70:71], v[80:83]
    v_mfma_f32_4x4x4_16b_bf16 v[76:79], v[10:11], v[68:69], v[76:79]
    v_perm_b32 v15, v19, v20, s47
    v_bitop3_b32 v46, v19, 0.5, -0.5 bitop3:0xa8
    v_perm_b32 v14, v18, v20, s46
    v_bitop3_b32 v47, v18, 0.5, -0.5 bitop3:0xa8
    v_cvt_pk_bf16_f32 v80, v80, v81
    v_cvt_pk_bf16_f32 v81, v82, v83
    ds_wrxchg_rtn_b64 v[74:75], v93, v[80:81] offset:65408
    v_cvt_pk_bf16_f32 v76, v76, v77
    v_cvt_pk_bf16_f32 v77, v78, v79
    ds_wrxchg_rtn_b64 v[72:73], v92, v[76:77] offset:65408
    v_and_b32 v88, 0x0fffffff, v40
    v_mov_b32 v21, v40
    buffer_load_dwordx2 v[16:17], v88, s[8:11], 0 offen
    buffer_load_dwordx3 v[18:20], v88, s[8:11], 0 offen offset:8
    s_setprio 2
    s_waitcnt lgkmcnt(2)
    v_mfma_f32_4x4x4_16b_bf16 v[80:83], v[8:9], v[106:107], 0
    v_mfma_f32_4x4x4_16b_bf16 v[76:79], v[8:9], v[104:105], 0
    v_bitop3_b32 v15, v6, v15, v46 bitop3:0xca
    v_bitop3_b32 v14, v6, v14, v47 bitop3:0xca
    s_nop 1
    v_pk_mul_f32 v[80:81], v[80:81], v[14:15] op_sel:[0,1] op_sel_hi:[1,1]
    v_pk_mul_f32 v[82:83], v[82:83], v[14:15] op_sel:[0,1] op_sel_hi:[1,1]
    v_pk_mul_f32 v[76:77], v[76:77], v[14:15] op_sel:[0,0] op_sel_hi:[1,0]
    v_pk_mul_f32 v[78:79], v[78:79], v[14:15] op_sel:[0,0] op_sel_hi:[1,0]
    s_waitcnt lgkmcnt(0)
    v_cmp_ne_u64 s[50:51], v[72:73], v[68:69]
    v_cmpx_ne_u64 s[54:55], v[74:75], v[70:71]
    s_and_b64 s[82:83], s[54:55], s[80:81]
    s_cbranch_scc1 L2_c122
L2_d122:
    v_mov_b64 v[84:85], v[70:71]
    v_mov_b32 v7, v93
    v_mov_b64 v[86:87], v[74:75]
    s_or_b64 s[80:81], s[80:81], s[54:55]
    s_mov_b64 exec, s[50:51]
    s_and_b64 s[82:83], s[50:51], s[80:81]
    s_cbranch_scc1 L2_c123
L2_d123:
    v_mov_b64 v[84:85], v[68:69]
    v_mov_b32 v7, v92
    v_mov_b64 v[86:87], v[72:73]
    s_mov_b64 exec, -1
    s_or_b64 s[80:81], s[80:81], s[50:51]
    ds_read_b64 v[70:71], v95 offset:65408
    ds_read_b64 v[68:69], v94 offset:65408
    s_waitcnt vmcnt(11)
    v_and_b32 v46, 0x20000000, v27
    v_lshrrev_b32 v47, 14, v23
    v_bitop3_b32 v47, v47, v5, v46 bitop3:0xea
    ds_read_b64 v[102:103], v47
    v_bitop3_b32 v93, v23, v5, v46 bitop3:0xea
    v_and_b32 v46, 0x10000000, v27
    v_lshrrev_b32 v47, 14, v22
    v_bitop3_b32 v47, v47, v5, v46 bitop3:0xea
    ds_read_b64 v[100:101], v47
    v_bitop3_b32 v92, v22, v5, v46 bitop3:0xea
    s_waitcnt lgkmcnt(2)
    v_mfma_f32_4x4x4_16b_bf16 v[80:83], v[10:11], v[70:71], v[80:83]
    v_mfma_f32_4x4x4_16b_bf16 v[76:79], v[10:11], v[68:69], v[76:79]
    v_perm_b32 v15, v23, v26, s45
    v_bitop3_b32 v46, v23, 0.5, -0.5 bitop3:0xa8
    v_perm_b32 v14, v22, v26, s44
    v_bitop3_b32 v47, v22, 0.5, -0.5 bitop3:0xa8
    v_cvt_pk_bf16_f32 v80, v80, v81
    v_cvt_pk_bf16_f32 v81, v82, v83
    ds_wrxchg_rtn_b64 v[74:75], v95, v[80:81] offset:65408
    v_cvt_pk_bf16_f32 v76, v76, v77
    v_cvt_pk_bf16_f32 v77, v78, v79
    ds_wrxchg_rtn_b64 v[72:73], v94, v[76:77] offset:65408
    s_waitcnt lgkmcnt(2)
    v_mfma_f32_4x4x4_16b_bf16 v[80:83], v[8:9], v[102:103], 0
    v_mfma_f32_4x4x4_16b_bf16 v[76:79], v[8:9], v[100:101], 0
    v_bitop3_b32 v15, v6, v15, v46 bitop3:0xca
    v_bitop3_b32 v14, v6, v14, v47 bitop3:0xca
    v_cmp_lt_u32 s[84:85], v5, v92
    s_nop 0
    v_pk_mul_f32 v[80:81], v[80:81], v[14:15] op_sel:[0,1] op_sel_hi:[1,1]
    v_pk_mul_f32 v[82:83], v[82:83], v[14:15] op_sel:[0,1] op_sel_hi:[1,1]
    v_pk_mul_f32 v[76:77], v[76:77], v[14:15] op_sel:[0,0] op_sel_hi:[1,0]
    v_pk_mul_f32 v[78:79], v[78:79], v[14:15] op_sel:[0,0] op_sel_hi:[1,0]
    s_waitcnt lgkmcnt(0)
    v_cmp_ne_u64 s[50:51], v[72:73], v[68:69]
    v_cmpx_ne_u64 s[54:55], v[74:75], v[70:71]
    s_and_b64 s[82:83], s[54:55], s[80:81]
    s_cbranch_scc1 L2_c124
L2_d124:
    v_mov_b64 v[84:85], v[70:71]
    v_mov_b32 v7, v95
    v_mov_b64 v[86:87], v[74:75]
    s_or_b64 s[80:81], s[80:81], s[54:55]
    s_mov_b64 exec, s[50:51]
    s_and_b64 s[82:83], s[50:51], s[80:81]
    s_cbranch_scc1 L2_c125
L2_d125:
    v_mov_b64 v[84:85], v[68:69]
    v_mov_b32 v7, v94
    v_mov_b64 v[86:87], v[72:73]
    s_mov_b64 exec, -1
    s_or_b64 s[80:81], s[80:81], s[50:51]
    ds_read_b64 v[70:71], v93 offset:65408
    s_and_b64 exec, s[84:85], s[80:81]
    v_mfma_f32_4x4x4_16b_bf16 v[76:79], v[12:13], v[84:85], 0
    v_mov_b32 v92, v7
    s_andn2_b64 s[80:81], s[80:81], s[84:85]
    v_mfma_f32_4x4x4_16b_bf16 v[76:79], v[10:11], v[86:87], v[76:79]
    s_mov_b64 exec, -1
    ds_read_b64 v[68:69], v92 offset:65408
    v_and_b32 v46, 0x80000000, v27
    v_lshrrev_b32 v47, 14, v25
    v_bitop3_b32 v47, v47, v5, v46 bitop3:0xea
    ds_read_b64 v[106:107], v47
    v_bitop3_b32 v95, v25, v5, v46 bitop3:0xea
    v_and_b32 v46, 0x40000000, v27
    v_lshrrev_b32 v47, 14, v24
    v_bitop3_b32 v47, v47, v5, v46 bitop3:0xea
    ds_read_b64 v[104:105], v47
    v_bitop3_b32 v94, v24, v5, v46 bitop3:0xea
    s_waitcnt lgkmcnt(2)
    v_mfma_f32_4x4x4_16b_bf16 v[80:83], v[10:11], v[70:71], v[80:83]
    v_mfma_f32_4x4x4_16b_bf16 v[76:79], v[10:11], v[68:69], v[76:79]
    v_perm_b32 v15, v25, v26, s47
    v_bitop3_b32 v46, v25, 0.5, -0.5 bitop3:0xa8
    v_perm_b32 v14, v24, v26, s46
    v_bitop3_b32 v47, v24, 0.5, -0.5 bitop3:0xa8
    v_cvt_pk_bf16_f32 v80, v80, v81
    v_cvt_pk_bf16_f32 v81, v82, v83
    ds_wrxchg_rtn_b64 v[74:75], v93, v[80:81] offset:65408
    v_cvt_pk_bf16_f32 v76, v76, v77
    v_cvt_pk_bf16_f32 v77, v78, v79
    ds_wrxchg_rtn_b64 v[72:73], v92, v[76:77] offset:65408
    v_and_b32 v88, 0x0fffffff, v41
    v_mov_b32 v27, v41
    buffer_load_dwordx2 v[22:23], v88, s[8:11], 0 offen
    buffer_load_dwordx3 v[24:26], v88, s[8:11], 0 offen offset:8
    s_setprio 1
    s_waitcnt lgkmcnt(2)
    v_mfma_f32_4x4x4_16b_bf16 v[80:83], v[8:9], v[106:107], 0
    v_mfma_f32_4x4x4_16b_bf16 v[76:79], v[8:9], v[104:105], 0
    v_bitop3_b32 v15, v6, v15, v46 bitop3:0xca
    v_bitop3_b32 v14, v6, v14, v47 bitop3:0xca
    s_nop 1
    v_pk_mul_f32 v[80:81], v[80:81], v[14:15] op_sel:[0,1] op_sel_hi:[1,1]
    v_pk_mul_f32 v[82:83], v[82:83], v[14:15] op_sel:[0,1] op_sel_hi:[1,1]
    v_pk_mul_f32 v[76:77], v[76:77], v[14:15] op_sel:[0,0] op_sel_hi:[1,0]
    v_pk_mul_f32 v[78:79], v[78:79], v[14:15] op_sel:[0,0] op_sel_hi:[1,0]
    s_waitcnt lgkmcnt(0)
    v_cmp_ne_u64 s[50:51], v[72:73], v[68:69]
    v_cmpx_ne_u64 s[54:55], v[74:75], v[70:71]
    s_and_b64 s[82:83], s[54:55], s[80:81]
    s_cbranch_scc1 L2_c126
L2_d126:
    v_mov_b64 v[84:85], v[70:71]
    v_mov_b32 v7, v93
    v_mov_b64 v[86:87], v[74:75]
    s_or_b64 s[80:81], s[80:81], s[54:55]
    s_mov_b64 exec, s[50:51]
    s_and_b64 s[82:83], s[50:51], s[80:81]
    s_cbranch_scc1 L2_c127
L2_d127:
    v_mov_b64 v[84:85], v[68:69]
    v_mov_b32 v7, v92
    v_mov_b64 v[86:87], v[72:73]
    s_mov_b64 exec, -1
    s_or_b64 s[80:81], s[80:81], s[50:51]
    ds_read_b64 v[70:71], v95 offset:65408
    ds_read_b64 v[68:69], v94 offset:65408
    s_waitcnt vmcnt(11)
    v_and_b32 v46, 0x20000000, v33
    v_lshrrev_b32 v47, 14, v29
    v_bitop3_b32 v47, v47, v5, v46 bitop3:0xea
    ds_read_b64 v[102:103], v47
    v_bitop3_b32 v93, v29, v5, v46 bitop3:0xea
    v_and_b32 v46, 0x10000000, v33
    v_lshrrev_b32 v47, 14, v28
    v_bitop3_b32 v47, v47, v5, v46 bitop3:0xea
    ds_read_b64 v[100:101], v47
    v_bitop3_b32 v92, v28, v5, v46 bitop3:0xea
    s_waitcnt lgkmcnt(2)
    v_mfma_f32_4x4x4_16b_bf16 v[80:83], v[10:11], v[70:71], v[80:83]
    v_mfma_f32_4x4x4_16b_bf16 v[76:79], v[10:11], v[68:69], v[76:79]
    v_perm_b32 v15, v29, v32, s45
    v_bitop3_b32 v46, v29, 0.5, -0.5 bitop3:0xa8
    v_perm_b32 v14, v28, v32, s44
    v_bitop3_b32 v47, v28, 0.5, -0.5 bitop3:0xa8
    v_cvt_pk_bf16_f32 v80, v80, v81
    v_cvt_pk_bf16_f32 v81, v82, v83
    ds_wrxchg_rtn_b64 v[74:75], v95, v[80:81] offset:65408
    v_cvt_pk_bf16_f32 v76, v76, v77
    v_cvt_pk_bf16_f32 v77, v78, v79
    ds_wrxchg_rtn_b64 v[72:73], v94, v[76:77] offset:65408
    s_waitcnt lgkmcnt(2)
    v_mfma_f32_4x4x4_16b_bf16 v[80:83], v[8:9], v[102:103], 0
    v_mfma_f32_4x4x4_16b_bf16 v[76:79], v[8:9], v[100:101], 0
    v_bitop3_b32 v15, v6, v15, v46 bitop3:0xca
    v_bitop3_b32 v14, v6, v14, v47 bitop3:0xca
    v_cmp_lt_u32 s[84:85], v5, v92
    s_nop 0
    v_pk_mul_f32 v[80:81], v[80:81], v[14:15] op_sel:[0,1] op_sel_hi:[1,1]
    v_pk_mul_f32 v[82:83], v[82:83], v[14:15] op_sel:[0,1] op_sel_hi:[1,1]
    v_pk_mul_f32 v[76:77], v[76:77], v[14:15] op_sel:[0,0] op_sel_hi:[1,0]
    v_pk_mul_f32 v[78:79], v[78:79], v[14:15] op_sel:[0,0] op_sel_hi:[1,0]
    s_waitcnt lgkmcnt(0)
    v_cmp_ne_u64 s[50:51], v[72:73], v[68:69]
    v_cmpx_ne_u64 s[54:55], v[74:75], v[70:71]
    s_and_b64 s[82:83], s[54:55], s[80:81]
    s_cbranch_scc1 L2_c128
L2_d128:
    v_mov_b64 v[84:85], v[70:71]
    v_mov_b32 v7, v95
    v_mov_b64 v[86:87], v[74:75]
    s_or_b64 s[80:81], s[80:81], s[54:55]
    s_mov_b64 exec, s[50:51]
    s_and_b64 s[82:83], s[50:51], s[80:81]
    s_cbranch_scc1 L2_c129
L2_d129:
    v_mov_b64 v[84:85], v[68:69]
    v_mov_b32 v7, v94
    v_mov_b64 v[86:87], v[72:73]
    s_mov_b64 exec, -1
    s_or_b64 s[80:81], s[80:81], s[50:51]
    ds_read_b64 v[70:71], v93 offset:65408
    s_and_b64 exec, s[84:85], s[80:81]
    v_mfma_f32_4x4x4_16b_bf16 v[76:79], v[12:13], v[84:85], 0
    v_mov_b32 v92, v7
    s_andn2_b64 s[80:81], s[80:81], s[84:85]
    v_mfma_f32_4x4x4_16b_bf16 v[76:79], v[10:11], v[86:87], v[76:79]
    s_mov_b64 exec, -1
    ds_read_b64 v[68:69], v92 offset:65408
    v_and_b32 v46, 0x80000000, v33
    v_lshrrev_b32 v47, 14, v31
    v_bitop3_b32 v47, v47, v5, v46 bitop3:0xea
    ds_read_b64 v[106:107], v47
    v_bitop3_b32 v95, v31, v5, v46 bitop3:0xea
    v_and_b32 v46, 0x40000000, v33
    v_lshrrev_b32 v47, 14, v30
    v_bitop3_b32 v47, v47, v5, v46 bitop3:0xea
    ds_read_b64 v[104:105], v47
    v_bitop3_b32 v94, v30, v5, v46 bitop3:0xea
    s_waitcnt lgkmcnt(2)
    v_mfma_f32_4x4x4_16b_bf16 v[80:83], v[10:11], v[70:71], v[80:83]
    v_mfma_f32_4x4x4_16b_bf16 v[76:79], v[10:11], v[68:69], v[76:79]
    v_perm_b32 v15, v31, v32, s47
    v_bitop3_b32 v46, v31, 0.5, -0.5 bitop3:0xa8
    v_perm_b32 v14, v30, v32, s46
    v_bitop3_b32 v47, v30, 0.5, -0.5 bitop3:0xa8
    v_cvt_pk_bf16_f32 v80, v80, v81
    v_cvt_pk_bf16_f32 v81, v82, v83
    ds_wrxchg_rtn_b64 v[74:75], v93, v[80:81] offset:65408
    v_cvt_pk_bf16_f32 v76, v76, v77
    v_cvt_pk_bf16_f32 v77, v78, v79
    ds_wrxchg_rtn_b64 v[72:73], v92, v[76:77] offset:65408
    v_and_b32 v88, 0x0fffffff, v42
    v_mov_b32 v33, v42
    buffer_load_dwordx2 v[28:29], v88, s[8:11], 0 offen
    buffer_load_dwordx3 v[30:32], v88, s[8:11], 0 offen offset:8
    s_setprio 0
    s_waitcnt lgkmcnt(2)
    v_mfma_f32_4x4x4_16b_bf16 v[80:83], v[8:9], v[106:107], 0
    v_mfma_f32_4x4x4_16b_bf16 v[76:79], v[8:9], v[104:105], 0
    v_bitop3_b32 v15, v6, v15, v46 bitop3:0xca
    v_bitop3_b32 v14, v6, v14, v47 bitop3:0xca
    s_nop 1
    v_pk_mul_f32 v[80:81], v[80:81], v[14:15] op_sel:[0,1] op_sel_hi:[1,1]
    v_pk_mul_f32 v[82:83], v[82:83], v[14:15] op_sel:[0,1] op_sel_hi:[1,1]
    v_pk_mul_f32 v[76:77], v[76:77], v[14:15] op_sel:[0,0] op_sel_hi:[1,0]
    v_pk_mul_f32 v[78:79], v[78:79], v[14:15] op_sel:[0,0] op_sel_hi:[1,0]
    s_add_u32 s40, s40, 0xfff24000
    s_waitcnt lgkmcnt(0)
    v_cmp_ne_u64 s[50:51], v[72:73], v[68:69]
    v_cmpx_ne_u64 s[54:55], v[74:75], v[70:71]
    s_and_b64 s[82:83], s[54:55], s[80:81]
    s_cbranch_scc1 L2_c130
L2_d130:
    v_mov_b64 v[84:85], v[70:71]
    v_mov_b32 v7, v93
    v_mov_b64 v[86:87], v[74:75]
    s_or_b64 s[80:81], s[80:81], s[54:55]
    s_mov_b64 exec, s[50:51]
    s_and_b64 s[82:83], s[50:51], s[80:81]
    s_cbranch_scc1 L2_c131
L2_d131:
    v_mov_b64 v[84:85], v[68:69]
    v_mov_b32 v7, v92
    v_mov_b64 v[86:87], v[72:73]
    s_mov_b64 exec, -1
    s_or_b64 s[80:81], s[80:81], s[50:51]
    ds_read_b64 v[70:71], v95 offset:65408
    ds_read_b64 v[68:69], v94 offset:65408
    s_waitcnt vmcnt(8)
    v_and_b32 v46, 0x20000000, v39
    v_lshrrev_b32 v47, 14, v35
    v_bitop3_b32 v47, v47, v5, v46 bitop3:0xea
    ds_read_b64 v[102:103], v47
    v_bitop3_b32 v93, v35, v5, v46 bitop3:0xea
    v_and_b32 v46, 0x10000000, v39
    v_lshrrev_b32 v47, 14, v34
    v_bitop3_b32 v47, v47, v5, v46 bitop3:0xea
    ds_read_b64 v[100:101], v47
    v_bitop3_b32 v92, v34, v5, v46 bitop3:0xea
    v_and_b32 v46, 0x80000000, v39
    v_lshrrev_b32 v47, 14, v37
    v_bitop3_b32 v47, v47, v5, v46 bitop3:0xea
    ds_read_b64 v[106:107], v47
    v_and_b32 v46, 0x40000000, v39
    v_lshrrev_b32 v47, 14, v36
    v_bitop3_b32 v47, v47, v5, v46 bitop3:0xea
    ds_read_b64 v[104:105], v47
    s_waitcnt lgkmcnt(4)
    v_mfma_f32_4x4x4_16b_bf16 v[80:83], v[10:11], v[70:71], v[80:83]
    v_mfma_f32_4x4x4_16b_bf16 v[76:79], v[10:11], v[68:69], v[76:79]
    v_perm_b32 v15, v35, v38, s45
    v_bitop3_b32 v46, v35, 0.5, -0.5 bitop3:0xa8
    v_perm_b32 v14, v34, v38, s44
    v_bitop3_b32 v47, v34, 0.5, -0.5 bitop3:0xa8
    v_cvt_pk_bf16_f32 v80, v80, v81
    v_cvt_pk_bf16_f32 v81, v82, v83
    ds_wrxchg_rtn_b64 v[74:75], v95, v[80:81] offset:65408
    v_cvt_pk_bf16_f32 v76, v76, v77
    v_cvt_pk_bf16_f32 v77, v78, v79
    ds_wrxchg_rtn_b64 v[72:73], v94, v[76:77] offset:65408
    s_waitcnt lgkmcnt(2)
    s_barrier
    s_setprio 3
    s_mov_b32 m0, s100
    s_nop 0
    ds_write_addtid_b32 v116 offset:32768
    ds_write_addtid_b32 v117 offset:33024
    ds_write_addtid_b32 v118 offset:33280
    ds_write_addtid_b32 v119 offset:33536
    ds_write_addtid_b32 v120 offset:33792
    ds_write_addtid_b32 v121 offset:34048
    ds_write_addtid_b32 v122 offset:34304
    ds_write_addtid_b32 v123 offset:34560
    v_mfma_f32_4x4x4_16b_bf16 v[80:83], v[8:9], v[102:103], 0
    v_mfma_f32_4x4x4_16b_bf16 v[76:79], v[8:9], v[100:101], 0
    v_bitop3_b32 v15, v6, v15, v46 bitop3:0xca
    v_bitop3_b32 v14, v6, v14, v47 bitop3:0xca
    v_cmp_lt_u32 s[84:85], v5, v92
    s_nop 0
    v_pk_mul_f32 v[80:81], v[80:81], v[14:15] op_sel:[0,1] op_sel_hi:[1,1]
    v_pk_mul_f32 v[82:83], v[82:83], v[14:15] op_sel:[0,1] op_sel_hi:[1,1]
    v_pk_mul_f32 v[76:77], v[76:77], v[14:15] op_sel:[0,0] op_sel_hi:[1,0]
    v_pk_mul_f32 v[78:79], v[78:79], v[14:15] op_sel:[0,0] op_sel_hi:[1,0]
    v_mov_b32 v44, v43
    s_setprio 2
    ds_write_addtid_b32 v124 offset:34816
    ds_write_addtid_b32 v125 offset:35072
    ds_write_addtid_b32 v126 offset:35328
    ds_write_addtid_b32 v127 offset:35584
    s_waitcnt lgkmcnt(12)
    v_cmp_ne_u64 s[50:51], v[72:73], v[68:69]
    v_cmpx_ne_u64 s[54:55], v[74:75], v[70:71]
    s_and_b64 s[82:83], s[54:55], s[80:81]
    s_cbranch_scc1 L2_c132
L2_d132:
    v_mov_b64 v[84:85], v[70:71]
    v_mov_b32 v7, v95
    v_mov_b64 v[86:87], v[74:75]
    s_or_b64 s[80:81], s[80:81], s[54:55]
    s_mov_b64 exec, s[50:51]
    s_and_b64 s[82:83], s[50:51], s[80:81]
    s_cbranch_scc1 L2_c133
L2_d133:
    v_mov_b64 v[84:85], v[68:69]
    v_mov_b32 v7, v94
    v_mov_b64 v[86:87], v[72:73]
    s_mov_b64 exec, -1
    s_or_b64 s[80:81], s[80:81], s[50:51]
    ds_read_b64 v[70:71], v93 offset:65408
    s_and_b64 exec, s[84:85], s[80:81]
    v_mfma_f32_4x4x4_16b_bf16 v[76:79], v[12:13], v[84:85], 0
    v_mov_b32 v92, v7
    s_andn2_b64 s[80:81], s[80:81], s[84:85]
    v_mfma_f32_4x4x4_16b_bf16 v[76:79], v[10:11], v[86:87], v[76:79]
    s_mov_b64 exec, -1
    ds_read_b64 v[68:69], v92 offset:65408
    s_setprio 1
    s_waitcnt vmcnt(7)
    s_mov_b32 m0, s38
    s_nop 0
    ds_write_addtid_b32 v108 offset:0
    ds_write_addtid_b32 v109 offset:256
    ds_write_addtid_b32 v110 offset:512
    ds_write_addtid_b32 v111 offset:768
    s_waitcnt lgkmcnt(4)
    v_mfma_f32_4x4x4_16b_bf16 v[80:83], v[10:11], v[70:71], v[80:83]
    v_mfma_f32_4x4x4_16b_bf16 v[76:79], v[10:11], v[68:69], v[76:79]
    v_and_b32 v46, 0x40000000, v39
    v_bitop3_b32 v94, v36, v5, v46 bitop3:0xea
    v_and_b32 v46, 0x80000000, v39
    v_bitop3_b32 v95, v37, v5, v46 bitop3:0xea
    v_perm_b32 v15, v37, v38, s47
    v_bitop3_b32 v46, v37, 0.5, -0.5 bitop3:0xa8
    v_perm_b32 v14, v36, v38, s46
    v_bitop3_b32 v47, v36, 0.5, -0.5 bitop3:0xa8
    v_cvt_pk_bf16_f32 v80, v80, v81
    v_cvt_pk_bf16_f32 v81, v82, v83
    ds_wrxchg_rtn_b64 v[74:75], v93, v[80:81] offset:65408
    v_cvt_pk_bf16_f32 v76, v76, v77
    v_cvt_pk_bf16_f32 v77, v78, v79
    ds_wrxchg_rtn_b64 v[72:73], v92, v[76:77] offset:65408
    v_and_b32 v88, 0x0fffffff, v44
    v_mov_b32 v39, v44
    buffer_load_dwordx2 v[34:35], v88, s[8:11], 0 offen
    buffer_load_dwordx3 v[36:38], v88, s[8:11], 0 offen offset:8
    s_setprio 0
    s_waitcnt vmcnt(8)
    ds_write_addtid_b32 v112 offset:1024
    ds_write_addtid_b32 v113 offset:1280
    ds_write_addtid_b32 v114 offset:1536
    ds_write_addtid_b32 v115 offset:1792
    v_mfma_f32_4x4x4_16b_bf16 v[80:83], v[8:9], v[106:107], 0
    v_mfma_f32_4x4x4_16b_bf16 v[76:79], v[8:9], v[104:105], 0
    v_bitop3_b32 v15, v6, v15, v46 bitop3:0xca
    v_bitop3_b32 v14, v6, v14, v47 bitop3:0xca
    s_nop 1
    v_pk_mul_f32 v[80:81], v[80:81], v[14:15] op_sel:[0,1] op_sel_hi:[1,1]
    v_pk_mul_f32 v[82:83], v[82:83], v[14:15] op_sel:[0,1] op_sel_hi:[1,1]
    v_pk_mul_f32 v[76:77], v[76:77], v[14:15] op_sel:[0,0] op_sel_hi:[1,0]
    v_pk_mul_f32 v[78:79], v[78:79], v[14:15] op_sel:[0,0] op_sel_hi:[1,0]
    s_add_u32 s42, s42, 1
    s_waitcnt lgkmcnt(0)
    s_barrier
    s_bitcmp1_b32 s36, s42
    s_cbranch_scc1 L2_slow
L2_ret7:
    s_setprio 3
    v_cmp_ne_u64 s[50:51], v[72:73], v[68:69]
    v_cmpx_ne_u64 s[54:55], v[74:75], v[70:71]
    s_and_b64 s[82:83], s[54:55], s[80:81]
    s_cbranch_scc1 L2_c134
L2_d134:
    v_mov_b64 v[84:85], v[70:71]
    v_mov_b32 v7, v93
    v_mov_b64 v[86:87], v[74:75]
    s_or_b64 s[80:81], s[80:81], s[54:55]
    s_mov_b64 exec, s[50:51]
    s_and_b64 s[82:83], s[50:51], s[80:81]
    s_cbranch_scc1 L2_c135
L2_d135:
    v_mov_b64 v[84:85], v[68:69]
    v_mov_b32 v7, v92
    v_mov_b64 v[86:87], v[72:73]
    s_mov_b64 exec, -1
    s_or_b64 s[80:81], s[80:81], s[50:51]
    ds_read_b64 v[70:71], v95 offset:65408
    ds_read_b64 v[68:69], v94 offset:65408
    s_waitcnt vmcnt(6)
    v_and_b32 v46, 0x20000000, v21
    v_lshrrev_b32 v47, 14, v17
    v_bitop3_b32 v47, v47, v5, v46 bitop3:0xea
    ds_read_b64 v[102:103], v47
    v_bitop3_b32 v93, v17, v5, v46 bitop3:0xea
    v_and_b32 v46, 0x10000000, v21
    v_lshrrev_b32 v47, 14, v16
    v_bitop3_b32 v47, v47, v5, v46 bitop3:0xea
    ds_read_b64 v[100:101], v47
    v_bitop3_b32 v92, v16, v5, v46 bitop3:0xea
    s_waitcnt lgkmcnt(2)
    v_mfma_f32_4x4x4_16b_bf16 v[80:83], v[10:11], v[70:71], v[80:83]
    v_mfma_f32_4x4x4_16b_bf16 v[76:79], v[10:11], v[68:69], v[76:79]
    v_perm_b32 v15, v17, v20, s45
    v_bitop3_b32 v46, v17, 0.5, -0.5 bitop3:0xa8
    v_perm_b32 v14, v16, v20, s44
    v_bitop3_b32 v47, v16, 0.5, -0.5 bitop3:0xa8
    v_cvt_pk_bf16_f32 v80, v80, v81
    v_cvt_pk_bf16_f32 v81, v82, v83
    ds_wrxchg_rtn_b64 v[74:75], v95, v[80:81] offset:65408
    v_cvt_pk_bf16_f32 v76, v76, v77
    v_cvt_pk_bf16_f32 v77, v78, v79
    ds_wrxchg_rtn_b64 v[72:73], v94, v[76:77] offset:65408
    s_waitcnt lgkmcnt(2)
    v_mfma_f32_4x4x4_16b_bf16 v[80:83], v[8:9], v[102:103], 0
    v_mfma_f32_4x4x4_16b_bf16 v[76:79], v[8:9], v[100:101], 0
    v_bitop3_b32 v15, v6, v15, v46 bitop3:0xca
    v_bitop3_b32 v14, v6, v14, v47 bitop3:0xca
    v_cmp_lt_u32 s[84:85], v5, v92
    s_nop 0
    v_pk_mul_f32 v[80:81], v[80:81], v[14:15] op_sel:[0,1] op_sel_hi:[1,1]
    v_pk_mul_f32 v[82:83], v[82:83], v[14:15] op_sel:[0,1] op_sel_hi:[1,1]
    v_pk_mul_f32 v[76:77], v[76:77], v[14:15] op_sel:[0,0] op_sel_hi:[1,0]
    v_pk_mul_f32 v[78:79], v[78:79], v[14:15] op_sel:[0,0] op_sel_hi:[1,0]
    s_waitcnt lgkmcnt(0)
    v_cmp_ne_u64 s[50:51], v[72:73], v[68:69]
    v_cmpx_ne_u64 s[54:55], v[74:75], v[70:71]
    s_and_b64 s[82:83], s[54:55], s[80:81]
    s_cbranch_scc1 L2_c136
L2_d136:
    v_mov_b64 v[84:85], v[70:71]
    v_mov_b32 v7, v95
    v_mov_b64 v[86:87], v[74:75]
    s_or_b64 s[80:81], s[80:81], s[54:55]
    s_mov_b64 exec, s[50:51]
    s_and_b64 s[82:83], s[50:51], s[80:81]
    s_cbranch_scc1 L2_c137
L2_d137:
    v_mov_b64 v[84:85], v[68:69]
    v_mov_b32 v7, v94
    v_mov_b64 v[86:87], v[72:73]
    s_mov_b64 exec, -1
    s_or_b64 s[80:81], s[80:81], s[50:51]
    ds_read_b64 v[70:71], v93 offset:65408
    s_and_b64 exec, s[84:85], s[80:81]
    v_mfma_f32_4x4x4_16b_bf16 v[76:79], v[12:13], v[84:85], 0
    v_mov_b32 v92, v7
    s_andn2_b64 s[80:81], s[80:81], s[84:85]
    v_mfma_f32_4x4x4_16b_bf16 v[76:79], v[10:11], v[86:87], v[76:79]
    s_mov_b64 exec, -1
    ds_read_b64 v[68:69], v92 offset:65408
    v_and_b32 v46, 0x80000000, v21
    v_lshrrev_b32 v47, 14, v19
    v_bitop3_b32 v47, v47, v5, v46 bitop3:0xea
    ds_read_b64 v[106:107], v47
    v_bitop3_b32 v95, v19, v5, v46 bitop3:0xea
    v_and_b32 v46, 0x40000000, v21
    v_lshrrev_b32 v47, 14, v18
    v_bitop3_b32 v47, v47, v5, v46 bitop3:0xea
    ds_read_b64 v[104:105], v47
    v_bitop3_b32 v94, v18, v5, v46 bitop3:0xea
    s_waitcnt lgkmcnt(2)
    v_mfma_f32_4x4x4_16b_bf16 v[80:83], v[10:11], v[70:71], v[80:83]
    v_mfma_f32_4x4x4_16b_bf16 v[76:79], v[10:11], v[68:69], v[76:79]
    v_perm_b32 v15, v19, v20, s47
    v_bitop3_b32 v46, v19, 0.5, -0.5 bitop3:0xa8
    v_perm_b32 v14, v18, v20, s46
    v_bitop3_b32 v47, v18, 0.5, -0.5 bitop3:0xa8
    v_cvt_pk_bf16_f32 v80, v80, v81
    v_cvt_pk_bf16_f32 v81, v82, v83
    ds_wrxchg_rtn_b64 v[74:75], v93, v[80:81] offset:65408
    v_cvt_pk_bf16_f32 v76, v76, v77
    v_cvt_pk_bf16_f32 v77, v78, v79
    ds_wrxchg_rtn_b64 v[72:73], v92, v[76:77] offset:65408
    s_setprio 2
    s_waitcnt lgkmcnt(2)
    v_mfma_f32_4x4x4_16b_bf16 v[80:83], v[8:9], v[106:107], 0
    v_mfma_f32_4x4x4_16b_bf16 v[76:79], v[8:9], v[104:105], 0
    v_bitop3_b32 v15, v6, v15, v46 bitop3:0xca
    v_bitop3_b32 v14, v6, v14, v47 bitop3:0xca
    s_nop 1
    v_pk_mul_f32 v[80:81], v[80:81], v[14:15] op_sel:[0,1] op_sel_hi:[1,1]
    v_pk_mul_f32 v[82:83], v[82:83], v[14:15] op_sel:[0,1] op_sel_hi:[1,1]
    v_pk_mul_f32 v[76:77], v[76:77], v[14:15] op_sel:[0,0] op_sel_hi:[1,0]
    v_pk_mul_f32 v[78:79], v[78:79], v[14:15] op_sel:[0,0] op_sel_hi:[1,0]
    s_waitcnt lgkmcnt(0)
    v_cmp_ne_u64 s[50:51], v[72:73], v[68:69]
    v_cmpx_ne_u64 s[54:55], v[74:75], v[70:71]
    s_and_b64 s[82:83], s[54:55], s[80:81]
    s_cbranch_scc1 L2_c138
L2_d138:
    v_mov_b64 v[84:85], v[70:71]
    v_mov_b32 v7, v93
    v_mov_b64 v[86:87], v[74:75]
    s_or_b64 s[80:81], s[80:81], s[54:55]
    s_mov_b64 exec, s[50:51]
    s_and_b64 s[82:83], s[50:51], s[80:81]
    s_cbranch_scc1 L2_c139
L2_d139:
    v_mov_b64 v[84:85], v[68:69]
    v_mov_b32 v7, v92
    v_mov_b64 v[86:87], v[72:73]
    s_mov_b64 exec, -1
    s_or_b64 s[80:81], s[80:81], s[50:51]
    ds_read_b64 v[70:71], v95 offset:65408
    ds_read_b64 v[68:69], v94 offset:65408
    s_waitcnt vmcnt(4)
    v_and_b32 v46, 0x20000000, v27
    v_lshrrev_b32 v47, 14, v23
    v_bitop3_b32 v47, v47, v5, v46 bitop3:0xea
    ds_read_b64 v[102:103], v47
    v_bitop3_b32 v93, v23, v5, v46 bitop3:0xea
    v_and_b32 v46, 0x10000000, v27
    v_lshrrev_b32 v47, 14, v22
    v_bitop3_b32 v47, v47, v5, v46 bitop3:0xea
    ds_read_b64 v[100:101], v47
    v_bitop3_b32 v92, v22, v5, v46 bitop3:0xea
    s_waitcnt lgkmcnt(2)
    v_mfma_f32_4x4x4_16b_bf16 v[80:83], v[10:11], v[70:71], v[80:83]
    v_mfma_f32_4x4x4_16b_bf16 v[76:79], v[10:11], v[68:69], v[76:79]
    v_perm_b32 v15, v23, v26, s45
    v_bitop3_b32 v46, v23, 0.5, -0.5 bitop3:0xa8
    v_perm_b32 v14, v22, v26, s44
    v_bitop3_b32 v47, v22, 0.5, -0.5 bitop3:0xa8
    v_cvt_pk_bf16_f32 v80, v80, v81
    v_cvt_pk_bf16_f32 v81, v82, v83
    ds_wrxchg_rtn_b64 v[74:75], v95, v[80:81] offset:65408
    v_cvt_pk_bf16_f32 v76, v76, v77
    v_cvt_pk_bf16_f32 v77, v78, v79
    ds_wrxchg_rtn_b64 v[72:73], v94, v[76:77] offset:65408
    s_waitcnt lgkmcnt(2)
    v_mfma_f32_4x4x4_16b_bf16 v[80:83], v[8:9], v[102:103], 0
    v_mfma_f32_4x4x4_16b_bf16 v[76:79], v[8:9], v[100:101], 0
    v_bitop3_b32 v15, v6, v15, v46 bitop3:0xca
    v_bitop3_b32 v14, v6, v14, v47 bitop3:0xca
    v_cmp_lt_u32 s[84:85], v5, v92
    s_nop 0
    v_pk_mul_f32 v[80:81], v[80:81], v[14:15] op_sel:[0,1] op_sel_hi:[1,1]
    v_pk_mul_f32 v[82:83], v[82:83], v[14:15] op_sel:[0,1] op_sel_hi:[1,1]
    v_pk_mul_f32 v[76:77], v[76:77], v[14:15] op_sel:[0,0] op_sel_hi:[1,0]
    v_pk_mul_f32 v[78:79], v[78:79], v[14:15] op_sel:[0,0] op_sel_hi:[1,0]
    s_waitcnt lgkmcnt(0)
    v_cmp_ne_u64 s[50:51], v[72:73], v[68:69]
    v_cmpx_ne_u64 s[54:55], v[74:75], v[70:71]
    s_and_b64 s[82:83], s[54:55], s[80:81]
    s_cbranch_scc1 L2_c140
L2_d140:
    v_mov_b64 v[84:85], v[70:71]
    v_mov_b32 v7, v95
    v_mov_b64 v[86:87], v[74:75]
    s_or_b64 s[80:81], s[80:81], s[54:55]
    s_mov_b64 exec, s[50:51]
    s_and_b64 s[82:83], s[50:51], s[80:81]
    s_cbranch_scc1 L2_c141
L2_d141:
    v_mov_b64 v[84:85], v[68:69]
    v_mov_b32 v7, v94
    v_mov_b64 v[86:87], v[72:73]
    s_mov_b64 exec, -1
    s_or_b64 s[80:81], s[80:81], s[50:51]
    ds_read_b64 v[70:71], v93 offset:65408
    s_and_b64 exec, s[84:85], s[80:81]
    v_mfma_f32_4x4x4_16b_bf16 v[76:79], v[12:13], v[84:85], 0
    v_mov_b32 v92, v7
    s_andn2_b64 s[80:81], s[80:81], s[84:85]
    v_mfma_f32_4x4x4_16b_bf16 v[76:79], v[10:11], v[86:87], v[76:79]
    s_mov_b64 exec, -1
    ds_read_b64 v[68:69], v92 offset:65408
    v_and_b32 v46, 0x80000000, v27
    v_lshrrev_b32 v47, 14, v25
    v_bitop3_b32 v47, v47, v5, v46 bitop3:0xea
    ds_read_b64 v[106:107], v47
    v_bitop3_b32 v95, v25, v5, v46 bitop3:0xea
    v_and_b32 v46, 0x40000000, v27
    v_lshrrev_b32 v47, 14, v24
    v_bitop3_b32 v47, v47, v5, v46 bitop3:0xea
    ds_read_b64 v[104:105], v47
    v_bitop3_b32 v94, v24, v5, v46 bitop3:0xea
    s_waitcnt lgkmcnt(2)
    v_mfma_f32_4x4x4_16b_bf16 v[80:83], v[10:11], v[70:71], v[80:83]
    v_mfma_f32_4x4x4_16b_bf16 v[76:79], v[10:11], v[68:69], v[76:79]
    v_perm_b32 v15, v25, v26, s47
    v_bitop3_b32 v46, v25, 0.5, -0.5 bitop3:0xa8
    v_perm_b32 v14, v24, v26, s46
    v_bitop3_b32 v47, v24, 0.5, -0.5 bitop3:0xa8
    v_cvt_pk_bf16_f32 v80, v80, v81
    v_cvt_pk_bf16_f32 v81, v82, v83
    ds_wrxchg_rtn_b64 v[74:75], v93, v[80:81] offset:65408
    v_cvt_pk_bf16_f32 v76, v76, v77
    v_cvt_pk_bf16_f32 v77, v78, v79
    ds_wrxchg_rtn_b64 v[72:73], v92, v[76:77] offset:65408
    s_setprio 1
    s_waitcnt lgkmcnt(2)
    v_mfma_f32_4x4x4_16b_bf16 v[80:83], v[8:9], v[106:107], 0
    v_mfma_f32_4x4x4_16b_bf16 v[76:79], v[8:9], v[104:105], 0
    v_bitop3_b32 v15, v6, v15, v46 bitop3:0xca
    v_bitop3_b32 v14, v6, v14, v47 bitop3:0xca
    s_nop 1
    v_pk_mul_f32 v[80:81], v[80:81], v[14:15] op_sel:[0,1] op_sel_hi:[1,1]
    v_pk_mul_f32 v[82:83], v[82:83], v[14:15] op_sel:[0,1] op_sel_hi:[1,1]
    v_pk_mul_f32 v[76:77], v[76:77], v[14:15] op_sel:[0,0] op_sel_hi:[1,0]
    v_pk_mul_f32 v[78:79], v[78:79], v[14:15] op_sel:[0,0] op_sel_hi:[1,0]
    s_lshl_b32 s3, s32, 12
    v_subrev_u32 v122, s3, v3
    s_mul_i32 s3, s33, 20000
    v_add_u32 v118, s3, v122
    v_add_u32 v119, 0x4000, v118
    s_lshl_b32 s3, s34, 7
    v_lshrrev_b32 v123, 7, v118
    v_and_b32 v120, 0x70, v118
    v_lshl_add_u32 v120, v123, 13, v120
    v_add_u32 v120, s3, v120
    v_lshrrev_b32 v123, 7, v119
    v_and_b32 v121, 0x70, v119
    v_lshl_add_u32 v121, v123, 13, v121
    v_add_u32 v121, s3, v121
    v_cmp_le_u32 vcc, 3616, v122
    s_mov_b64 exec, vcc
    v_mov_b32 v119, 2.0
    v_mov_b32 v121, 2.0
    s_mov_b64 exec, -1
    v_and_b32 v123, 0x30, v122
    v_lshlrev_b32 v123, 2, v123
    buffer_load_dwordx4 v[48:51], v123, s[24:27], 0 offen
    buffer_load_dwordx4 v[52:55], v123, s[24:27], 0 offen offset:16
    buffer_load_dwordx2 v[56:57], v123, s[24:27], 0 offen offset:32
    s_mov_b32 s12, s4
    s_mov_b32 s13, s5
    s_mov_b32 s14, 0x138800
    s_mov_b32 s15, 0x20000
    s_mov_b32 s16, s28
    s_mov_b32 s17, s29
    s_mov_b32 s18, 0x4e2000
    s_mov_b32 s19, 0x20000
    v_lshrrev_b32 v123, 2, v120
    buffer_load_dword v116, v123, s[12:15], 0 offen
    buffer_load_dwordx4 v[108:111], v120, s[16:19], 0 offen
    v_lshrrev_b32 v123, 2, v121
    buffer_load_dword v117, v123, s[12:15], 0 offen
    buffer_load_dwordx4 v[112:115], v121, s[16:19], 0 offen
    s_waitcnt lgkmcnt(0)
    v_cmp_ne_u64 s[50:51], v[72:73], v[68:69]
    v_cmpx_ne_u64 s[54:55], v[74:75], v[70:71]
    s_and_b64 s[82:83], s[54:55], s[80:81]
    s_cbranch_scc1 L2_c142
L2_d142:
    v_mov_b64 v[84:85], v[70:71]
    v_mov_b32 v7, v93
    v_mov_b64 v[86:87], v[74:75]
    s_or_b64 s[80:81], s[80:81], s[54:55]
    s_mov_b64 exec, s[50:51]
    s_and_b64 s[82:83], s[50:51], s[80:81]
    s_cbranch_scc1 L2_c143
L2_d143:
    v_mov_b64 v[84:85], v[68:69]
    v_mov_b32 v7, v92
    v_mov_b64 v[86:87], v[72:73]
    s_mov_b64 exec, -1
    s_or_b64 s[80:81], s[80:81], s[50:51]
    ds_read_b64 v[70:71], v95 offset:65408
    ds_read_b64 v[68:69], v94 offset:65408
    s_waitcnt vmcnt(9)
    v_and_b32 v46, 0x20000000, v33
    v_lshrrev_b32 v47, 14, v29
    v_bitop3_b32 v47, v47, v5, v46 bitop3:0xea
    ds_read_b64 v[102:103], v47
    v_bitop3_b32 v93, v29, v5, v46 bitop3:0xea
    v_and_b32 v46, 0x10000000, v33
    v_lshrrev_b32 v47, 14, v28
    v_bitop3_b32 v47, v47, v5, v46 bitop3:0xea
    ds_read_b64 v[100:101], v47
    v_bitop3_b32 v92, v28, v5, v46 bitop3:0xea
    s_waitcnt lgkmcnt(2)
    v_mfma_f32_4x4x4_16b_bf16 v[80:83], v[10:11], v[70:71], v[80:83]
    v_mfma_f32_4x4x4_16b_bf16 v[76:79], v[10:11], v[68:69], v[76:79]
    v_perm_b32 v15, v29, v32, s45
    v_bitop3_b32 v46, v29, 0.5, -0.5 bitop3:0xa8
    v_perm_b32 v14, v28, v32, s44
    v_bitop3_b32 v47, v28, 0.5, -0.5 bitop3:0xa8
    v_cvt_pk_bf16_f32 v80, v80, v81
    v_cvt_pk_bf16_f32 v81, v82, v83
    ds_wrxchg_rtn_b64 v[74:75], v95, v[80:81] offset:65408
    v_cvt_pk_bf16_f32 v76, v76, v77
    v_cvt_pk_bf16_f32 v77, v78, v79
    ds_wrxchg_rtn_b64 v[72:73], v94, v[76:77] offset:65408
    s_waitcnt lgkmcnt(2)
    v_mfma_f32_4x4x4_16b_bf16 v[80:83], v[8:9], v[102:103], 0
    v_mfma_f32_4x4x4_16b_bf16 v[76:79], v[8:9], v[100:101], 0
    v_bitop3_b32 v15, v6, v15, v46 bitop3:0xca
    v_bitop3_b32 v14, v6, v14, v47 bitop3:0xca
    v_cmp_lt_u32 s[84:85], v5, v92
    s_nop 0
    v_pk_mul_f32 v[80:81], v[80:81], v[14:15] op_sel:[0,1] op_sel_hi:[1,1]
    v_pk_mul_f32 v[82:83], v[82:83], v[14:15] op_sel:[0,1] op_sel_hi:[1,1]
    v_pk_mul_f32 v[76:77], v[76:77], v[14:15] op_sel:[0,0] op_sel_hi:[1,0]
    v_pk_mul_f32 v[78:79], v[78:79], v[14:15] op_sel:[0,0] op_sel_hi:[1,0]
    s_waitcnt lgkmcnt(0)
    v_cmp_ne_u64 s[50:51], v[72:73], v[68:69]
    v_cmpx_ne_u64 s[54:55], v[74:75], v[70:71]
    s_and_b64 s[82:83], s[54:55], s[80:81]
    s_cbranch_scc1 L2_c144
L2_d144:
    v_mov_b64 v[84:85], v[70:71]
    v_mov_b32 v7, v95
    v_mov_b64 v[86:87], v[74:75]
    s_or_b64 s[80:81], s[80:81], s[54:55]
    s_mov_b64 exec, s[50:51]
    s_and_b64 s[82:83], s[50:51], s[80:81]
    s_cbranch_scc1 L2_c145
L2_d145:
    v_mov_b64 v[84:85], v[68:69]
    v_mov_b32 v7, v94
    v_mov_b64 v[86:87], v[72:73]
    s_mov_b64 exec, -1
    s_or_b64 s[80:81], s[80:81], s[50:51]
    ds_read_b64 v[70:71], v93 offset:65408
    s_and_b64 exec, s[84:85], s[80:81]
    v_mfma_f32_4x4x4_16b_bf16 v[76:79], v[12:13], v[84:85], 0
    v_mov_b32 v92, v7
    s_andn2_b64 s[80:81], s[80:81], s[84:85]
    v_mfma_f32_4x4x4_16b_bf16 v[76:79], v[10:11], v[86:87], v[76:79]
    s_mov_b64 exec, -1
    ds_read_b64 v[68:69], v92 offset:65408
    v_and_b32 v46, 0x80000000, v33
    v_lshrrev_b32 v47, 14, v31
    v_bitop3_b32 v47, v47, v5, v46 bitop3:0xea
    ds_read_b64 v[106:107], v47
    v_bitop3_b32 v95, v31, v5, v46 bitop3:0xea
    v_and_b32 v46, 0x40000000, v33
    v_lshrrev_b32 v47, 14, v30
    v_bitop3_b32 v47, v47, v5, v46 bitop3:0xea
    ds_read_b64 v[104:105], v47
    v_bitop3_b32 v94, v30, v5, v46 bitop3:0xea
    s_waitcnt lgkmcnt(2)
    v_mfma_f32_4x4x4_16b_bf16 v[80:83], v[10:11], v[70:71], v[80:83]
    v_mfma_f32_4x4x4_16b_bf16 v[76:79], v[10:11], v[68:69], v[76:79]
    v_perm_b32 v15, v31, v32, s47
    v_bitop3_b32 v46, v31, 0.5, -0.5 bitop3:0xa8
    v_perm_b32 v14, v30, v32, s46
    v_bitop3_b32 v47, v30, 0.5, -0.5 bitop3:0xa8
    v_cvt_pk_bf16_f32 v80, v80, v81
    v_cvt_pk_bf16_f32 v81, v82, v83
    ds_wrxchg_rtn_b64 v[74:75], v93, v[80:81] offset:65408
    v_cvt_pk_bf16_f32 v76, v76, v77
    v_cvt_pk_bf16_f32 v77, v78, v79
    ds_wrxchg_rtn_b64 v[72:73], v92, v[76:77] offset:65408
    s_setprio 0
    s_waitcnt lgkmcnt(2)
    v_mfma_f32_4x4x4_16b_bf16 v[80:83], v[8:9], v[106:107], 0
    v_mfma_f32_4x4x4_16b_bf16 v[76:79], v[8:9], v[104:105], 0
    v_bitop3_b32 v15, v6, v15, v46 bitop3:0xca
    v_bitop3_b32 v14, v6, v14, v47 bitop3:0xca
    s_nop 1
    v_pk_mul_f32 v[80:81], v[80:81], v[14:15] op_sel:[0,1] op_sel_hi:[1,1]
    v_pk_mul_f32 v[82:83], v[82:83], v[14:15] op_sel:[0,1] op_sel_hi:[1,1]
    v_pk_mul_f32 v[76:77], v[76:77], v[14:15] op_sel:[0,0] op_sel_hi:[1,0]
    v_pk_mul_f32 v[78:79], v[78:79], v[14:15] op_sel:[0,0] op_sel_hi:[1,0]
    s_waitcnt lgkmcnt(0)
    v_cmp_ne_u64 s[50:51], v[72:73], v[68:69]
    v_cmpx_ne_u64 s[54:55], v[74:75], v[70:71]
    s_and_b64 s[82:83], s[54:55], s[80:81]
    s_cbranch_scc1 L2_c146
L2_d146:
    v_mov_b64 v[84:85], v[70:71]
    v_mov_b32 v7, v93
    v_mov_b64 v[86:87], v[74:75]
    s_or_b64 s[80:81], s[80:81], s[54:55]
    s_mov_b64 exec, s[50:51]
    s_and_b64 s[82:83], s[50:51], s[80:81]
    s_cbranch_scc1 L2_c147
L2_d147:
    v_mov_b64 v[84:85], v[68:69]
    v_mov_b32 v7, v92
    v_mov_b64 v[86:87], v[72:73]
    s_mov_b64 exec, -1
    s_or_b64 s[80:81], s[80:81], s[50:51]
    ds_read_b64 v[70:71], v95 offset:65408
    ds_read_b64 v[68:69], v94 offset:65408
    s_waitcnt vmcnt(7)
    v_and_b32 v46, 0x20000000, v39
    v_lshrrev_b32 v47, 14, v35
    v_bitop3_b32 v47, v47, v5, v46 bitop3:0xea
    ds_read_b64 v[102:103], v47
    v_bitop3_b32 v93, v35, v5, v46 bitop3:0xea
    v_and_b32 v46, 0x10000000, v39
    v_lshrrev_b32 v47, 14, v34
    v_bitop3_b32 v47, v47, v5, v46 bitop3:0xea
    ds_read_b64 v[100:101], v47
    v_bitop3_b32 v92, v34, v5, v46 bitop3:0xea
    v_and_b32 v46, 0x80000000, v39
    v_lshrrev_b32 v47, 14, v37
    v_bitop3_b32 v47, v47, v5, v46 bitop3:0xea
    ds_read_b64 v[106:107], v47
    v_and_b32 v46, 0x40000000, v39
    v_lshrrev_b32 v47, 14, v36
    v_bitop3_b32 v47, v47, v5, v46 bitop3:0xea
    ds_read_b64 v[104:105], v47
    s_waitcnt lgkmcnt(4)
    v_mfma_f32_4x4x4_16b_bf16 v[80:83], v[10:11], v[70:71], v[80:83]
    v_mfma_f32_4x4x4_16b_bf16 v[76:79], v[10:11], v[68:69], v[76:79]
    v_perm_b32 v15, v35, v38, s45
    v_bitop3_b32 v46, v35, 0.5, -0.5 bitop3:0xa8
    v_perm_b32 v14, v34, v38, s44
    v_bitop3_b32 v47, v34, 0.5, -0.5 bitop3:0xa8
    v_cvt_pk_bf16_f32 v80, v80, v81
    v_cvt_pk_bf16_f32 v81, v82, v83
    ds_wrxchg_rtn_b64 v[74:75], v95, v[80:81] offset:65408
    v_cvt_pk_bf16_f32 v76, v76, v77
    v_cvt_pk_bf16_f32 v77, v78, v79
    ds_wrxchg_rtn_b64 v[72:73], v94, v[76:77] offset:65408
    s_waitcnt lgkmcnt(4)
    v_mfma_f32_4x4x4_16b_bf16 v[80:83], v[8:9], v[102:103], 0
    v_mfma_f32_4x4x4_16b_bf16 v[76:79], v[8:9], v[100:101], 0
    v_bitop3_b32 v15, v6, v15, v46 bitop3:0xca
    v_bitop3_b32 v14, v6, v14, v47 bitop3:0xca
    v_cmp_lt_u32 s[84:85], v5, v92
    s_nop 0
    v_pk_mul_f32 v[80:81], v[80:81], v[14:15] op_sel:[0,1] op_sel_hi:[1,1]
    v_pk_mul_f32 v[82:83], v[82:83], v[14:15] op_sel:[0,1] op_sel_hi:[1,1]
    v_pk_mul_f32 v[76:77], v[76:77], v[14:15] op_sel:[0,0] op_sel_hi:[1,0]
    v_pk_mul_f32 v[78:79], v[78:79], v[14:15] op_sel:[0,0] op_sel_hi:[1,0]
    s_waitcnt lgkmcnt(0)
    v_cmp_ne_u64 s[50:51], v[72:73], v[68:69]
    v_cmpx_ne_u64 s[54:55], v[74:75], v[70:71]
    s_and_b64 s[82:83], s[54:55], s[80:81]
    s_cbranch_scc1 L2_c148
L2_d148:
    v_mov_b64 v[84:85], v[70:71]
    v_mov_b32 v7, v95
    v_mov_b64 v[86:87], v[74:75]
    s_or_b64 s[80:81], s[80:81], s[54:55]
    s_mov_b64 exec, s[50:51]
    s_and_b64 s[82:83], s[50:51], s[80:81]
    s_cbranch_scc1 L2_c149
L2_d149:
    v_mov_b64 v[84:85], v[68:69]
    v_mov_b32 v7, v94
    v_mov_b64 v[86:87], v[72:73]
    s_mov_b64 exec, -1
    s_or_b64 s[80:81], s[80:81], s[50:51]
    ds_read_b64 v[70:71], v93 offset:65408
    s_and_b64 exec, s[84:85], s[80:81]
    v_mfma_f32_4x4x4_16b_bf16 v[76:79], v[12:13], v[84:85], 0
    v_mov_b32 v92, v7
    s_andn2_b64 s[80:81], s[80:81], s[84:85]
    v_mfma_f32_4x4x4_16b_bf16 v[76:79], v[10:11], v[86:87], v[76:79]
    s_mov_b64 exec, -1
    ds_read_b64 v[68:69], v92 offset:65408
    s_waitcnt lgkmcnt(0)
    v_mfma_f32_4x4x4_16b_bf16 v[80:83], v[10:11], v[70:71], v[80:83]
    v_mfma_f32_4x4x4_16b_bf16 v[76:79], v[10:11], v[68:69], v[76:79]
    v_and_b32 v46, 0x40000000, v39
    v_bitop3_b32 v94, v36, v5, v46 bitop3:0xea
    v_and_b32 v46, 0x80000000, v39
    v_bitop3_b32 v95, v37, v5, v46 bitop3:0xea
    v_perm_b32 v15, v37, v38, s47
    v_bitop3_b32 v46, v37, 0.5, -0.5 bitop3:0xa8
    v_perm_b32 v14, v36, v38, s46
    v_bitop3_b32 v47, v36, 0.5, -0.5 bitop3:0xa8
    v_cvt_pk_bf16_f32 v80, v80, v81
    v_cvt_pk_bf16_f32 v81, v82, v83
    ds_wrxchg_rtn_b64 v[74:75], v93, v[80:81] offset:65408
    v_cvt_pk_bf16_f32 v76, v76, v77
    v_cvt_pk_bf16_f32 v77, v78, v79
    ds_wrxchg_rtn_b64 v[72:73], v92, v[76:77] offset:65408
    v_mfma_f32_4x4x4_16b_bf16 v[80:83], v[8:9], v[106:107], 0
    v_mfma_f32_4x4x4_16b_bf16 v[76:79], v[8:9], v[104:105], 0
    v_bitop3_b32 v15, v6, v15, v46 bitop3:0xca
    v_bitop3_b32 v14, v6, v14, v47 bitop3:0xca
    s_nop 1
    v_pk_mul_f32 v[80:81], v[80:81], v[14:15] op_sel:[0,1] op_sel_hi:[1,1]
    v_pk_mul_f32 v[82:83], v[82:83], v[14:15] op_sel:[0,1] op_sel_hi:[1,1]
    v_pk_mul_f32 v[76:77], v[76:77], v[14:15] op_sel:[0,0] op_sel_hi:[1,0]
    v_pk_mul_f32 v[78:79], v[78:79], v[14:15] op_sel:[0,0] op_sel_hi:[1,0]
    s_waitcnt lgkmcnt(0)
    v_cmp_ne_u64 s[50:51], v[72:73], v[68:69]
    v_cmpx_ne_u64 s[54:55], v[74:75], v[70:71]
    s_and_b64 s[82:83], s[54:55], s[80:81]
    s_cbranch_scc1 L2_c150
L2_d150:
    v_mov_b64 v[84:85], v[70:71]
    v_mov_b32 v7, v93
    v_mov_b64 v[86:87], v[74:75]
    s_or_b64 s[80:81], s[80:81], s[54:55]
    s_mov_b64 exec, s[50:51]
    s_and_b64 s[82:83], s[50:51], s[80:81]
    s_cbranch_scc1 L2_c151
L2_d151:
    v_mov_b64 v[84:85], v[68:69]
    v_mov_b32 v7, v92
    v_mov_b64 v[86:87], v[72:73]
    s_mov_b64 exec, -1
    s_or_b64 s[80:81], s[80:81], s[50:51]
    ds_read_b64 v[70:71], v95 offset:65408
    ds_read_b64 v[68:69], v94 offset:65408
    s_waitcnt lgkmcnt(0)
    v_mfma_f32_4x4x4_16b_bf16 v[80:83], v[10:11], v[70:71], v[80:83]
    v_mfma_f32_4x4x4_16b_bf16 v[76:79], v[10:11], v[68:69], v[76:79]
    s_nop 3
    v_cvt_pk_bf16_f32 v80, v80, v81
    v_cvt_pk_bf16_f32 v81, v82, v83
    ds_wrxchg_rtn_b64 v[74:75], v95, v[80:81] offset:65408
    v_cvt_pk_bf16_f32 v76, v76, v77
    v_cvt_pk_bf16_f32 v77, v78, v79
    ds_wrxchg_rtn_b64 v[72:73], v94, v[76:77] offset:65408
    s_waitcnt lgkmcnt(0)
    v_cmpx_ne_u64 vcc, v[74:75], v[70:71]
    s_and_b64 s[82:83], vcc, s[80:81]
    s_cbranch_scc1 L2_c152
L2_d152:
    v_mov_b64 v[84:85], v[70:71]
    v_mov_b32 v7, v95
    v_mov_b64 v[86:87], v[74:75]
    s_mov_b64 exec, -1
    s_or_b64 s[80:81], s[80:81], vcc
    v_cmpx_ne_u64 vcc, v[72:73], v[68:69]
    s_and_b64 s[82:83], vcc, s[80:81]
    s_cbranch_scc1 L2_c153
L2_d153:
    v_mov_b64 v[84:85], v[68:69]
    v_mov_b32 v7, v94
    v_mov_b64 v[86:87], v[72:73]
    s_mov_b64 exec, -1
    s_or_b64 s[80:81], s[80:81], vcc
    s_mov_b64 exec, s[80:81]
    ds_read_b64 v[68:69], v7 offset:65408
    v_mfma_f32_4x4x4_16b_bf16 v[76:79], v[12:13], v[84:85], 0
    s_nop 1
    v_mfma_f32_4x4x4_16b_bf16 v[76:79], v[10:11], v[86:87], v[76:79]
    s_waitcnt lgkmcnt(0)
    s_nop 0
    v_mfma_f32_4x4x4_16b_bf16 v[76:79], v[10:11], v[68:69], v[76:79]
    v_mov_b64 v[84:85], v[68:69]
    s_nop 3
    v_cvt_pk_bf16_f32 v76, v76, v77
    v_cvt_pk_bf16_f32 v77, v78, v79
    ds_wrxchg_rtn_b64 v[86:87], v7, v[76:77] offset:65408
    s_waitcnt lgkmcnt(0)
    v_cmp_ne_u64 s[80:81], v[86:87], v[84:85]
    s_mov_b64 exec, s[80:81]
    s_nop 1
    v_mfma_f32_4x4x4_16b_bf16 v[88:91], v[12:13], v[84:85], 0
    s_nop 1
    v_mfma_f32_4x4x4_16b_bf16 v[88:91], v[10:11], v[86:87], v[88:91]
    s_nop 4
    v_cvt_pk_bf16_f32 v88, v88, v89
    v_cvt_pk_bf16_f32 v89, v90, v91
    ds_pk_add_bf16 v7, v88 offset:65408
    ds_pk_add_bf16 v7, v89 offset:65412
    s_mov_b64 exec, -1
    s_load_dwordx2 s[4:5], s[0:1], 88
    v_add_u32 v123, 0x4000, v122
    s_lshl_b32 s50, s96, 16
    s_and_b32 s51, s96, 0xffff0000
    s_lshl_b32 s52, s97, 16
    s_and_b32 s53, s97, 0xffff0000
    s_lshl_b32 s54, s98, 16
    s_and_b32 s55, s98, 0xffff0000
    s_lshl_b32 s56, s99, 16
    s_and_b32 s57, s99, 0xffff0000
    s_waitcnt vmcnt(0) lgkmcnt(0)
    s_barrier
    s_add_u32 s8, s30, 0xec46000
    s_addc_u32 s9, s31, 0
    s_mov_b32 s10, 0x8000
    s_mov_b32 s11, 0x20000
    s_mov_b32 s12, s4
    s_mov_b32 s13, s5
    s_mov_b32 s14, 0x4e2000
    s_mov_b32 s15, 0x20000
    s_add_u32 s20, s30, 0xd845000
    s_addc_u32 s21, s31, 0
    s_mov_b32 s22, 0x1400000
    s_mov_b32 s23, 0x20000
    s_lshl2_add_u32 s4, s34, s33
    s_mul_i32 s4, s4, 81920
    s_add_u32 s3, s33, 1
    s_and_b32 s3, s3, 3
    s_mul_i32 s36, s3, 20000
    s_add_u32 s36, s36, 81920
    s_mul_i32 s40, s3, 20480
    s_add_u32 s40, s40, s4
    s_lshl2_add_u32 s3, s34, s3
    s_mul_i32 s3, s3, 81920
    s_mul_i32 s44, s33, 20480
    s_add_u32 s44, s44, s3
    s_add_u32 s3, s33, 2
    s_and_b32 s3, s3, 3
    s_mul_i32 s37, s3, 20000
    s_add_u32 s37, s37, 81920
    s_mul_i32 s41, s3, 20480
    s_add_u32 s41, s41, s4
    s_lshl2_add_u32 s3, s34, s3
    s_mul_i32 s3, s3, 81920
    s_mul_i32 s45, s33, 20480
    s_add_u32 s45, s45, s3
    s_add_u32 s3, s33, 3
    s_and_b32 s3, s3, 3
    s_mul_i32 s38, s3, 20000
    s_add_u32 s38, s38, 81920
    s_mul_i32 s42, s3, 20480
    s_add_u32 s42, s42, s4
    s_lshl2_add_u32 s3, s34, s3
    s_mul_i32 s3, s3, 81920
    s_mul_i32 s46, s33, 20480
    s_add_u32 s46, s46, s3
    v_add_u32 v104, s36, v122
    ds_read_b128 v[16:19], v104
    v_add_u32 v104, s37, v122
    ds_read_b128 v[20:23], v104
    v_add_u32 v104, s38, v122
    ds_read_b128 v[24:27], v104
    s_waitcnt lgkmcnt(2)
    buffer_store_dwordx4 v[16:19], v122, s[20:23], s40 offen sc1
    s_waitcnt lgkmcnt(1)
    buffer_store_dwordx4 v[20:23], v122, s[20:23], s41 offen sc1
    s_waitcnt lgkmcnt(0)
    buffer_store_dwordx4 v[24:27], v122, s[20:23], s42 offen sc1
    s_cmp_ge_u32 s32, 4
    s_cbranch_scc1 L2_g0
    v_add_u32 v104, s36, v123
    ds_read_b128 v[36:39], v104
    v_add_u32 v104, s37, v123
    ds_read_b128 v[40:43], v104
    v_add_u32 v104, s38, v123
    ds_read_b128 v[44:47], v104
    s_waitcnt lgkmcnt(2)
    buffer_store_dwordx4 v[36:39], v123, s[20:23], s40 offen sc1
    s_waitcnt lgkmcnt(1)
    buffer_store_dwordx4 v[40:43], v123, s[20:23], s41 offen sc1
    s_waitcnt lgkmcnt(0)
    buffer_store_dwordx4 v[44:47], v123, s[20:23], s42 offen sc1
L2_g0:
    v_lshlrev_b32 v80, 16, v116
    v_subrev_f32 v60, s50, v80
    v_subrev_f32 v61, s51, v80
    v_subrev_f32 v62, s52, v80
    v_subrev_f32 v63, s53, v80
    v_subrev_f32 v64, s54, v80
    v_subrev_f32 v65, s55, v80
    v_subrev_f32 v66, s56, v80
    v_subrev_f32 v67, s57, v80
    v_cvt_pk_bf16_f32 v68, v60, v61
    v_cvt_pk_bf16_f32 v69, v62, v63
    v_cvt_pk_bf16_f32 v70, v64, v65
    v_cvt_pk_bf16_f32 v71, v66, v67
    v_lshlrev_b32 v60, 16, v68
    v_and_b32 v61, 0xffff0000, v68
    v_lshlrev_b32 v62, 16, v69
    v_and_b32 v63, 0xffff0000, v69
    v_lshlrev_b32 v64, 16, v70
    v_and_b32 v65, 0xffff0000, v70
    v_lshlrev_b32 v66, 16, v71
    v_and_b32 v67, 0xffff0000, v71
    v_mul_f32 v60, v60, v60
    v_mul_f32 v61, v61, v61
    v_mul_f32 v62, v62, v62
    v_mul_f32 v63, v63, v63
    v_mul_f32 v64, v64, v64
    v_mul_f32 v65, v65, v65
    v_mul_f32 v66, v66, v66
    v_mul_f32 v67, v67, v67
    v_cvt_pk_bf16_f32 v68, v60, v61
    v_cvt_pk_bf16_f32 v69, v62, v63
    v_cvt_pk_bf16_f32 v70, v64, v65
    v_cvt_pk_bf16_f32 v71, v66, v67
    v_lshlrev_b32 v60, 16, v68
    v_and_b32 v61, 0xffff0000, v68
    v_lshlrev_b32 v62, 16, v69
    v_and_b32 v63, 0xffff0000, v69
    v_lshlrev_b32 v64, 16, v70
    v_and_b32 v65, 0xffff0000, v70
    v_lshlrev_b32 v66, 16, v71
    v_and_b32 v67, 0xffff0000, v71
    v_mul_f32 v60, 0xc1200000, v60
    v_mul_f32 v61, 0xc1200000, v61
    v_mul_f32 v62, 0xc1200000, v62
    v_mul_f32 v63, 0xc1200000, v63
    v_mul_f32 v64, 0xc1200000, v64
    v_mul_f32 v65, 0xc1200000, v65
    v_mul_f32 v66, 0xc1200000, v66
    v_mul_f32 v67, 0xc1200000, v67
    v_cvt_pk_bf16_f32 v68, v60, v61
    v_cvt_pk_bf16_f32 v69, v62, v63
    v_cvt_pk_bf16_f32 v70, v64, v65
    v_cvt_pk_bf16_f32 v71, v66, v67
    v_lshlrev_b32 v60, 16, v68
    v_and_b32 v61, 0xffff0000, v68
    v_lshlrev_b32 v62, 16, v69
    v_and_b32 v63, 0xffff0000, v69
    v_lshlrev_b32 v64, 16, v70
    v_and_b32 v65, 0xffff0000, v70
    v_lshlrev_b32 v66, 16, v71
    v_and_b32 v67, 0xffff0000, v71
    v_mul_f32 v60, 0x3fb8aa3b, v60
    v_mul_f32 v61, 0x3fb8aa3b, v61
    v_mul_f32 v62, 0x3fb8aa3b, v62
    v_mul_f32 v63, 0x3fb8aa3b, v63
    v_mul_f32 v64, 0x3fb8aa3b, v64
    v_mul_f32 v65, 0x3fb8aa3b, v65
    v_mul_f32 v66, 0x3fb8aa3b, v66
    v_mul_f32 v67, 0x3fb8aa3b, v67
    v_exp_f32 v60, v60
    v_exp_f32 v61, v61
    v_exp_f32 v62, v62
    v_exp_f32 v63, v63
    v_exp_f32 v64, v64
    v_exp_f32 v65, v65
    v_exp_f32 v66, v66
    v_exp_f32 v67, v67
    v_cvt_pk_bf16_f32 v72, v60, v61
    v_cvt_pk_bf16_f32 v73, v62, v63
    v_cvt_pk_bf16_f32 v74, v64, v65
    v_cvt_pk_bf16_f32 v75, v66, v67
    v_and_b32 v80, 0xffff0000, v116
    v_subrev_f32 v60, s50, v80
    v_subrev_f32 v61, s51, v80
    v_subrev_f32 v62, s52, v80
    v_subrev_f32 v63, s53, v80
    v_subrev_f32 v64, s54, v80
    v_subrev_f32 v65, s55, v80
    v_subrev_f32 v66, s56, v80
    v_subrev_f32 v67, s57, v80
    v_cvt_pk_bf16_f32 v68, v60, v61
    v_cvt_pk_bf16_f32 v69, v62, v63
    v_cvt_pk_bf16_f32 v70, v64, v65
    v_cvt_pk_bf16_f32 v71, v66, v67
    v_lshlrev_b32 v60, 16, v68
    v_and_b32 v61, 0xffff0000, v68
    v_lshlrev_b32 v62, 16, v69
    v_and_b32 v63, 0xffff0000, v69
    v_lshlrev_b32 v64, 16, v70
    v_and_b32 v65, 0xffff0000, v70
    v_lshlrev_b32 v66, 16, v71
    v_and_b32 v67, 0xffff0000, v71
    v_mul_f32 v60, v60, v60
    v_mul_f32 v61, v61, v61
    v_mul_f32 v62, v62, v62
    v_mul_f32 v63, v63, v63
    v_mul_f32 v64, v64, v64
    v_mul_f32 v65, v65, v65
    v_mul_f32 v66, v66, v66
    v_mul_f32 v67, v67, v67
    v_cvt_pk_bf16_f32 v68, v60, v61
    v_cvt_pk_bf16_f32 v69, v62, v63
    v_cvt_pk_bf16_f32 v70, v64, v65
    v_cvt_pk_bf16_f32 v71, v66, v67
    v_lshlrev_b32 v60, 16, v68
    v_and_b32 v61, 0xffff0000, v68
    v_lshlrev_b32 v62, 16, v69
    v_and_b32 v63, 0xffff0000, v69
    v_lshlrev_b32 v64, 16, v70
    v_and_b32 v65, 0xffff0000, v70
    v_lshlrev_b32 v66, 16, v71
    v_and_b32 v67, 0xffff0000, v71
    v_mul_f32 v60, 0xc1200000, v60
    v_mul_f32 v61, 0xc1200000, v61
    v_mul_f32 v62, 0xc1200000, v62
    v_mul_f32 v63, 0xc1200000, v63
    v_mul_f32 v64, 0xc1200000, v64
    v_mul_f32 v65, 0xc1200000, v65
    v_mul_f32 v66, 0xc1200000, v66
    v_mul_f32 v67, 0xc1200000, v67
    v_cvt_pk_bf16_f32 v68, v60, v61
    v_cvt_pk_bf16_f32 v69, v62, v63
    v_cvt_pk_bf16_f32 v70, v64, v65
    v_cvt_pk_bf16_f32 v71, v66, v67
    v_lshlrev_b32 v60, 16, v68
    v_and_b32 v61, 0xffff0000, v68
    v_lshlrev_b32 v62, 16, v69
    v_and_b32 v63, 0xffff0000, v69
    v_lshlrev_b32 v64, 16, v70
    v_and_b32 v65, 0xffff0000, v70
    v_lshlrev_b32 v66, 16, v71
    v_and_b32 v67, 0xffff0000, v71
    v_mul_f32 v60, 0x3fb8aa3b, v60
    v_mul_f32 v61, 0x3fb8aa3b, v61
    v_mul_f32 v62, 0x3fb8aa3b, v62
    v_mul_f32 v63, 0x3fb8aa3b, v63
    v_mul_f32 v64, 0x3fb8aa3b, v64
    v_mul_f32 v65, 0x3fb8aa3b, v65
    v_mul_f32 v66, 0x3fb8aa3b, v66
    v_mul_f32 v67, 0x3fb8aa3b, v67
    v_exp_f32 v60, v60
    v_exp_f32 v61, v61
    v_exp_f32 v62, v62
    v_exp_f32 v63, v63
    v_exp_f32 v64, v64
    v_exp_f32 v65, v65
    v_exp_f32 v66, v66
    v_exp_f32 v67, v67
    v_cvt_pk_bf16_f32 v76, v60, v61
    v_cvt_pk_bf16_f32 v77, v62, v63
    v_cvt_pk_bf16_f32 v78, v64, v65
    v_cvt_pk_bf16_f32 v79, v66, v67
    v_mfma_f32_4x4x4_16b_bf16 v[80:83], v[48:49], v[72:73], 0
    v_mfma_f32_4x4x4_16b_bf16 v[88:91], v[52:53], v[72:73], 0
    v_mfma_f32_4x4x4_16b_bf16 v[84:87], v[48:49], v[76:77], 0
    v_mfma_f32_4x4x4_16b_bf16 v[92:95], v[52:53], v[76:77], 0
    v_mfma_f32_4x4x4_16b_bf16 v[80:83], v[50:51], v[74:75], v[80:83]
    v_mfma_f32_4x4x4_16b_bf16 v[88:91], v[54:55], v[74:75], v[88:91]
    v_mfma_f32_4x4x4_16b_bf16 v[84:87], v[50:51], v[78:79], v[84:87]
    v_mfma_f32_4x4x4_16b_bf16 v[92:95], v[54:55], v[78:79], v[92:95]
    s_lshl_b32 s3, s34, 9
    s_lshl_b32 s4, s33, 7
    s_add_u32 s4, s4, s3
    v_mov_b32 v104, 1
    v_and_b32 v105, 0x3f0, v122
    v_lshlrev_b32 v105, 3, v105
    v_add_u32 v106, 81920, v118
    ds_read_b128 v[32:35], v106
    v_add_u32 v106, 81920, v119
    ds_read_b128 v[60:63], v106
    s_waitcnt vmcnt(0)
    s_barrier
    s_cmp_lg_u32 s32, 0
    s_cbranch_scc1 L2_f2
    s_mov_b64 exec, 1
    buffer_store_dword v104, off, s[8:11], s4 sc1
    s_mov_b64 exec, 15
    s_bitset0_b64 exec, s33
L2_f3:
    buffer_load_dword v104, v105, s[8:11], s3 offen sc1
    s_waitcnt vmcnt(0)
    v_cmp_ne_u32 vcc, 1, v104
    s_cbranch_vccnz L2_f3s
    s_mov_b64 exec, -1
L2_f2:
    s_barrier
    buffer_load_dwordx4 v[36:39], v122, s[20:23], s44 offen sc1
    buffer_load_dwordx4 v[40:43], v122, s[20:23], s45 offen sc1
    buffer_load_dwordx4 v[44:47], v122, s[20:23], s46 offen sc1
    s_cmp_ge_u32 s32, 4
    s_cbranch_scc1 L2_f5
    buffer_load_dwordx4 v[64:67], v123, s[20:23], s44 offen sc1
    buffer_load_dwordx4 v[68:71], v123, s[20:23], s45 offen sc1
    buffer_load_dwordx4 v[72:75], v123, s[20:23], s46 offen sc1
    v_lshlrev_b32 v16, 16, v117
    v_subrev_f32 v96, s50, v16
    v_subrev_f32 v97, s51, v16
    v_subrev_f32 v98, s52, v16
    v_subrev_f32 v99, s53, v16
    v_subrev_f32 v100, s54, v16
    v_subrev_f32 v101, s55, v16
    v_subrev_f32 v102, s56, v16
    v_subrev_f32 v103, s57, v16
    v_cvt_pk_bf16_f32 v0, v96, v97
    v_cvt_pk_bf16_f32 v1, v98, v99
    v_cvt_pk_bf16_f32 v2, v100, v101
    v_cvt_pk_bf16_f32 v3, v102, v103
    v_lshlrev_b32 v96, 16, v0
    v_and_b32 v97, 0xffff0000, v0
    v_lshlrev_b32 v98, 16, v1
    v_and_b32 v99, 0xffff0000, v1
    v_lshlrev_b32 v100, 16, v2
    v_and_b32 v101, 0xffff0000, v2
    v_lshlrev_b32 v102, 16, v3
    v_and_b32 v103, 0xffff0000, v3
    v_mul_f32 v96, v96, v96
    v_mul_f32 v97, v97, v97
    v_mul_f32 v98, v98, v98
    v_mul_f32 v99, v99, v99
    v_mul_f32 v100, v100, v100
    v_mul_f32 v101, v101, v101
    v_mul_f32 v102, v102, v102
    v_mul_f32 v103, v103, v103
    v_cvt_pk_bf16_f32 v0, v96, v97
    v_cvt_pk_bf16_f32 v1, v98, v99
    v_cvt_pk_bf16_f32 v2, v100, v101
    v_cvt_pk_bf16_f32 v3, v102, v103
    v_lshlrev_b32 v96, 16, v0
    v_and_b32 v97, 0xffff0000, v0
    v_lshlrev_b32 v98, 16, v1
    v_and_b32 v99, 0xffff0000, v1
    v_lshlrev_b32 v100, 16, v2
    v_and_b32 v101, 0xffff0000, v2
    v_lshlrev_b32 v102, 16, v3
    v_and_b32 v103, 0xffff0000, v3
    v_mul_f32 v96, 0xc1200000, v96
    v_mul_f32 v97, 0xc1200000, v97
    v_mul_f32 v98, 0xc1200000, v98
    v_mul_f32 v99, 0xc1200000, v99
    v_mul_f32 v100, 0xc1200000, v100
    v_mul_f32 v101, 0xc1200000, v101
    v_mul_f32 v102, 0xc1200000, v102
    v_mul_f32 v103, 0xc1200000, v103
    v_cvt_pk_bf16_f32 v0, v96, v97
    v_cvt_pk_bf16_f32 v1, v98, v99
    v_cvt_pk_bf16_f32 v2, v100, v101
    v_cvt_pk_bf16_f32 v3, v102, v103
    v_lshlrev_b32 v96, 16, v0
    v_and_b32 v97, 0xffff0000, v0
    v_lshlrev_b32 v98, 16, v1
    v_and_b32 v99, 0xffff0000, v1
    v_lshlrev_b32 v100, 16, v2
    v_and_b32 v101, 0xffff0000, v2
    v_lshlrev_b32 v102, 16, v3
    v_and_b32 v103, 0xffff0000, v3
    v_mul_f32 v96, 0x3fb8aa3b, v96
    v_mul_f32 v97, 0x3fb8aa3b, v97
    v_mul_f32 v98, 0x3fb8aa3b, v98
    v_mul_f32 v99, 0x3fb8aa3b, v99
    v_mul_f32 v100, 0x3fb8aa3b, v100
    v_mul_f32 v101, 0x3fb8aa3b, v101
    v_mul_f32 v102, 0x3fb8aa3b, v102
    v_mul_f32 v103, 0x3fb8aa3b, v103
    v_exp_f32 v96, v96
    v_exp_f32 v97, v97
    v_exp_f32 v98, v98
    v_exp_f32 v99, v99
    v_exp_f32 v100, v100
    v_exp_f32 v101, v101
    v_exp_f32 v102, v102
    v_exp_f32 v103, v103
    v_cvt_pk_bf16_f32 v104, v96, v97
    v_cvt_pk_bf16_f32 v105, v98, v99
    v_cvt_pk_bf16_f32 v106, v100, v101
    v_cvt_pk_bf16_f32 v107, v102, v103
    v_and_b32 v16, 0xffff0000, v117
    v_subrev_f32 v96, s50, v16
    v_subrev_f32 v97, s51, v16
    v_subrev_f32 v98, s52, v16
    v_subrev_f32 v99, s53, v16
    v_subrev_f32 v100, s54, v16
    v_subrev_f32 v101, s55, v16
    v_subrev_f32 v102, s56, v16
    v_subrev_f32 v103, s57, v16
    v_cvt_pk_bf16_f32 v0, v96, v97
    v_cvt_pk_bf16_f32 v1, v98, v99
    v_cvt_pk_bf16_f32 v2, v100, v101
    v_cvt_pk_bf16_f32 v3, v102, v103
    v_lshlrev_b32 v96, 16, v0
    v_and_b32 v97, 0xffff0000, v0
    v_lshlrev_b32 v98, 16, v1
    v_and_b32 v99, 0xffff0000, v1
    v_lshlrev_b32 v100, 16, v2
    v_and_b32 v101, 0xffff0000, v2
    v_lshlrev_b32 v102, 16, v3
    v_and_b32 v103, 0xffff0000, v3
    v_mul_f32 v96, v96, v96
    v_mul_f32 v97, v97, v97
    v_mul_f32 v98, v98, v98
    v_mul_f32 v99, v99, v99
    v_mul_f32 v100, v100, v100
    v_mul_f32 v101, v101, v101
    v_mul_f32 v102, v102, v102
    v_mul_f32 v103, v103, v103
    v_cvt_pk_bf16_f32 v0, v96, v97
    v_cvt_pk_bf16_f32 v1, v98, v99
    v_cvt_pk_bf16_f32 v2, v100, v101
    v_cvt_pk_bf16_f32 v3, v102, v103
    v_lshlrev_b32 v96, 16, v0
    v_and_b32 v97, 0xffff0000, v0
    v_lshlrev_b32 v98, 16, v1
    v_and_b32 v99, 0xffff0000, v1
    v_lshlrev_b32 v100, 16, v2
    v_and_b32 v101, 0xffff0000, v2
    v_lshlrev_b32 v102, 16, v3
    v_and_b32 v103, 0xffff0000, v3
    v_mul_f32 v96, 0xc1200000, v96
    v_mul_f32 v97, 0xc1200000, v97
    v_mul_f32 v98, 0xc1200000, v98
    v_mul_f32 v99, 0xc1200000, v99
    v_mul_f32 v100, 0xc1200000, v100
    v_mul_f32 v101, 0xc1200000, v101
    v_mul_f32 v102, 0xc1200000, v102
    v_mul_f32 v103, 0xc1200000, v103
    v_cvt_pk_bf16_f32 v0, v96, v97
    v_cvt_pk_bf16_f32 v1, v98, v99
    v_cvt_pk_bf16_f32 v2, v100, v101
    v_cvt_pk_bf16_f32 v3, v102, v103
    v_lshlrev_b32 v96, 16, v0
    v_and_b32 v97, 0xffff0000, v0
    v_lshlrev_b32 v98, 16, v1
    v_and_b32 v99, 0xffff0000, v1
    v_lshlrev_b32 v100, 16, v2
    v_and_b32 v101, 0xffff0000, v2
    v_lshlrev_b32 v102, 16, v3
    v_and_b32 v103, 0xffff0000, v3
    v_mul_f32 v96, 0x3fb8aa3b, v96
    v_mul_f32 v97, 0x3fb8aa3b, v97
    v_mul_f32 v98, 0x3fb8aa3b, v98
    v_mul_f32 v99, 0x3fb8aa3b, v99
    v_mul_f32 v100, 0x3fb8aa3b, v100
    v_mul_f32 v101, 0x3fb8aa3b, v101
    v_mul_f32 v102, 0x3fb8aa3b, v102
    v_mul_f32 v103, 0x3fb8aa3b, v103
    v_exp_f32 v96, v96
    v_exp_f32 v97, v97
    v_exp_f32 v98, v98
    v_exp_f32 v99, v99
    v_exp_f32 v100, v100
    v_exp_f32 v101, v101
    v_exp_f32 v102, v102
    v_exp_f32 v103, v103
    v_cvt_pk_bf16_f32 v76, v96, v97
    v_cvt_pk_bf16_f32 v77, v98, v99
    v_cvt_pk_bf16_f32 v78, v100, v101
    v_cvt_pk_bf16_f32 v79, v102, v103
    v_mfma_f32_4x4x4_16b_bf16 v[16:19], v[48:49], v[104:105], 0
    v_mfma_f32_4x4x4_16b_bf16 v[24:27], v[52:53], v[104:105], 0
    v_mfma_f32_4x4x4_16b_bf16 v[20:23], v[48:49], v[76:77], 0
    v_mfma_f32_4x4x4_16b_bf16 v[28:31], v[52:53], v[76:77], 0
    v_mfma_f32_4x4x4_16b_bf16 v[16:19], v[50:51], v[106:107], v[16:19]
    v_mfma_f32_4x4x4_16b_bf16 v[24:27], v[54:55], v[106:107], v[24:27]
    v_mfma_f32_4x4x4_16b_bf16 v[20:23], v[50:51], v[78:79], v[20:23]
    v_mfma_f32_4x4x4_16b_bf16 v[28:31], v[54:55], v[78:79], v[28:31]
L2_f5:
    s_waitcnt vmcnt(0) lgkmcnt(0)
    v_mfma_f32_4x4x4_16b_bf16 v[96:99], v[10:11], v[32:33], 0
    v_mfma_f32_4x4x4_16b_bf16 v[100:103], v[10:11], v[34:35], 0
    s_nop 0
    v_mfma_f32_4x4x4_16b_bf16 v[96:99], v[10:11], v[36:37], v[96:99]
    v_mfma_f32_4x4x4_16b_bf16 v[100:103], v[10:11], v[38:39], v[100:103]
    s_nop 0
    v_mfma_f32_4x4x4_16b_bf16 v[96:99], v[10:11], v[40:41], v[96:99]
    v_mfma_f32_4x4x4_16b_bf16 v[100:103], v[10:11], v[42:43], v[100:103]
    s_nop 0
    v_mfma_f32_4x4x4_16b_bf16 v[96:99], v[10:11], v[44:45], v[96:99]
    v_mfma_f32_4x4x4_16b_bf16 v[100:103], v[10:11], v[46:47], v[100:103]
    s_nop 3
    v_mul_f32 v96, v96, v80
    v_mul_f32 v97, v97, v81
    v_mul_f32 v98, v98, v82
    v_mul_f32 v99, v99, v83
    v_cvt_pk_bf16_f32 v32, v96, v97
    v_cvt_pk_bf16_f32 v33, v98, v99
    v_mul_f32 v100, v100, v84
    v_mul_f32 v101, v101, v85
    v_mul_f32 v102, v102, v86
    v_mul_f32 v103, v103, v87
    v_cvt_pk_bf16_f32 v34, v100, v101
    v_cvt_pk_bf16_f32 v35, v102, v103
    v_mfma_f32_4x4x4_16b_bf16 v[80:83], v[56:57], v[32:33], 0
    s_nop 0
    v_mfma_f32_4x4x4_16b_bf16 v[84:87], v[56:57], v[34:35], 0
    s_nop 2
    v_mul_f32 v80, v80, v88
    v_mul_f32 v81, v81, v89
    v_mul_f32 v82, v82, v90
    v_mul_f32 v83, v83, v91
    v_mul_f32 v84, v84, v92
    v_mul_f32 v85, v85, v93
    v_mul_f32 v86, v86, v94
    v_mul_f32 v87, v87, v95
    v_mfma_f32_4x4x4_16b_bf16 v[96:99], v[10:11], v[108:109], v[80:83]
    s_nop 0
    v_mfma_f32_4x4x4_16b_bf16 v[100:103], v[10:11], v[110:111], v[84:87]
    s_nop 2
    v_cvt_pk_bf16_f32 v36, v96, v97
    v_cvt_pk_bf16_f32 v37, v98, v99
    v_cvt_pk_bf16_f32 v38, v100, v101
    v_cvt_pk_bf16_f32 v39, v102, v103
    buffer_store_dwordx4 v[36:39], v120, s[12:15], 0 offen nt
    s_cmp_ge_u32 s32, 4
    s_cbranch_scc1 L2_f6
    v_mfma_f32_4x4x4_16b_bf16 v[96:99], v[10:11], v[60:61], 0
    v_mfma_f32_4x4x4_16b_bf16 v[100:103], v[10:11], v[62:63], 0
    s_nop 0
    v_mfma_f32_4x4x4_16b_bf16 v[96:99], v[10:11], v[64:65], v[96:99]
    v_mfma_f32_4x4x4_16b_bf16 v[100:103], v[10:11], v[66:67], v[100:103]
    s_nop 0
    v_mfma_f32_4x4x4_16b_bf16 v[96:99], v[10:11], v[68:69], v[96:99]
    v_mfma_f32_4x4x4_16b_bf16 v[100:103], v[10:11], v[70:71], v[100:103]
    s_nop 0
    v_mfma_f32_4x4x4_16b_bf16 v[96:99], v[10:11], v[72:73], v[96:99]
    v_mfma_f32_4x4x4_16b_bf16 v[100:103], v[10:11], v[74:75], v[100:103]
    s_nop 3
    v_mul_f32 v96, v96, v16
    v_mul_f32 v97, v97, v17
    v_mul_f32 v98, v98, v18
    v_mul_f32 v99, v99, v19
    v_cvt_pk_bf16_f32 v60, v96, v97
    v_cvt_pk_bf16_f32 v61, v98, v99
    v_mul_f32 v100, v100, v20
    v_mul_f32 v101, v101, v21
    v_mul_f32 v102, v102, v22
    v_mul_f32 v103, v103, v23
    v_cvt_pk_bf16_f32 v62, v100, v101
    v_cvt_pk_bf16_f32 v63, v102, v103
    v_mfma_f32_4x4x4_16b_bf16 v[16:19], v[56:57], v[60:61], 0
    s_nop 0
    v_mfma_f32_4x4x4_16b_bf16 v[20:23], v[56:57], v[62:63], 0
    s_nop 2
    v_mul_f32 v16, v16, v24
    v_mul_f32 v17, v17, v25
    v_mul_f32 v18, v18, v26
    v_mul_f32 v19, v19, v27
    v_mul_f32 v20, v20, v28
    v_mul_f32 v21, v21, v29
    v_mul_f32 v22, v22, v30
    v_mul_f32 v23, v23, v31
    v_mfma_f32_4x4x4_16b_bf16 v[96:99], v[10:11], v[112:113], v[16:19]
    s_nop 0
    v_mfma_f32_4x4x4_16b_bf16 v[100:103], v[10:11], v[114:115], v[20:23]
    s_nop 2
    v_cvt_pk_bf16_f32 v64, v96, v97
    v_cvt_pk_bf16_f32 v65, v98, v99
    v_cvt_pk_bf16_f32 v66, v100, v101
    v_cvt_pk_bf16_f32 v67, v102, v103
    buffer_store_dwordx4 v[64:67], v121, s[12:15], 0 offen nt
L2_f6:
L2_end:
    s_endpgm
L2_slow:
    s_lshr_b32 s35, s42, 2
    s_lshl_b32 s50, s32, 4
    s_and_b32 s3, s42, 3
    s_lshl_b32 s53, s3, 3
    s_add_u32 s53, s53, s39
    s_and_b32 s3, s35, 2
    s_lshl_b32 s3, s3, 1
    s_add_u32 s53, s53, s3
    s_and_b32 s54, s35, 1
    s_lshl_b32 s54, s54, 4
L2_sl_seg:
    s_mul_i32 s55, s50, 173056
    s_and_b32 s3, s50, 3
    s_lshl_b32 s3, s3, 5
    s_add_u32 s3, s3, s55
    s_add_u32 s3, s3, s53
    buffer_load_dword v104, off, s[12:15], s3 sc1
    buffer_load_dword v105, off, s[12:15], s3 offset:32 sc1
    s_waitcnt vmcnt(0)
    v_readfirstlane_b32 s51, v104
    v_readfirstlane_b32 s52, v105
    s_lshr_b32 s51, s51, s54
    s_and_b32 s51, s51, 0xffff
    s_lshr_b32 s52, s52, s54
    s_and_b32 s52, s52, 0xffff
L2_sl_rec:
    s_cmp_ge_u32 s51, s52
    s_cbranch_scc1 L2_sl_next
    v_mbcnt_lo_u32_b32 v102, -1, 0
    v_mbcnt_hi_u32_b32 v102, -1, v102
    v_add_u32 v102, s51, v102
    v_and_b32 v103, -4, v102
    v_lshl_add_u32 v104, v102, 2, v103
    v_lshl_add_u32 v105, v103, 2, v102
    v_cmp_gt_u32 vcc, s52, v102
    s_mov_b64 exec, vcc
    buffer_load_dword v106, v104, s[8:11], s55 offen
    buffer_load_ubyte v107, v105, s[8:11], s55 offen offset:16
    s_waitcnt vmcnt(0)
    v_lshrrev_b32 v98, 14, v106
    v_and_b32 v98, v5, v98
    ds_read_b64 v[100:101], v98
    v_perm_b32 v97, v106, v107, s44
    v_and_b32 v96, v5, v106
    v_bitop3_b32 v103, v106, 0.5, -0.5 bitop3:0xa8
    v_bitop3_b32 v97, v6, v97, v103 bitop3:0xca
    s_waitcnt lgkmcnt(0)
    v_mfma_f32_4x4x4_16b_bf16 v[88:91], v[8:9], v[100:101], 0
    s_nop 4
    v_mul_f32 v88, v97, v88
    v_mul_f32 v89, v97, v89
    v_mul_f32 v90, v97, v90
    v_mul_f32 v91, v97, v91
    v_cvt_pk_bf16_f32 v88, v88, v89
    v_cvt_pk_bf16_f32 v89, v90, v91
    ds_pk_add_bf16 v96, v88 offset:65408
    ds_pk_add_bf16 v96, v89 offset:65412
    s_mov_b64 exec, -1
    s_add_u32 s51, s51, 64
    s_branch L2_sl_rec
L2_sl_next:
    s_add_u32 s50, s50, 1
    s_and_b32 s3, s50, 15
    s_cbranch_scc1 L2_sl_seg
    s_add_u32 s50, s50, 240
    s_cmp_lt_u32 s50, 1280
    s_cbranch_scc1 L2_sl_seg
    s_waitcnt lgkmcnt(0)
    s_cmp_eq_u32 s42, 0
    s_cbranch_scc1 L2_ret0
    s_cmp_eq_u32 s42, 1
    s_cbranch_scc1 L2_ret1
    s_cmp_eq_u32 s42, 14
    s_cbranch_scc1 L2_ret6
    s_cmp_eq_u32 s42, 15
    s_cbranch_scc1 L2_ret7
    s_and_b32 s3, s42, 3
    s_cmp_eq_u32 s3, 2
    s_cbranch_scc1 L2_ret2
    s_cmp_eq_u32 s3, 3
    s_cbranch_scc1 L2_ret3
    s_cmp_eq_u32 s3, 0
    s_cbranch_scc1 L2_ret4
    s_branch L2_ret5
L2_p1s:
    s_sleep 32
    s_branch L2_p1
L2_xo3:
    v_cmp_lt_u32 vcc, 20, v99
    s_mov_b32 s101, 1
    s_cbranch_vccz L2_xp3
    v_cmp_lt_u32 vcc, 32, v99
    v_cmp_lt_u32 s[58:59], 31, v88
    s_mov_b32 s101, 2
    s_or_b64 vcc, vcc, s[58:59]
    s_cbranch_scc0 L2_xp3
    s_mov_b32 s37, 0x10000
    s_branch L2_xp3
L2_xa4:
    s_cmp_eq_u32 s101, 1
    s_cbranch_scc1 L2_xc4
    v_lshlrev_b32 v89, 0, v96
    v_add_u32 v90, 140, v97
    v_bitop3_b32 v90, v89, v45, v90 bitop3:0x6a
    ds_write_b32 v98, v90 offset:28
    v_lshlrev_b32 v89, 4, v96
    v_add_u32 v90, 120, v97
    v_bitop3_b32 v90, v89, v45, v90 bitop3:0x6a
    ds_write_b32 v98, v90 offset:24
    v_lshlrev_b32 v89, 8, v96
    v_add_u32 v90, 100, v97
    v_bitop3_b32 v90, v89, v45, v90 bitop3:0x6a
    ds_write_b32 v98, v90 offset:20
L2_xc4:
    v_lshlrev_b32 v89, 12, v96
    v_add_u32 v90, 80, v97
    v_bitop3_b32 v90, v89, v45, v90 bitop3:0x6a
    ds_write_b32 v98, v90 offset:16
    s_branch L2_xb4
L2_xe4:
    v_cmp_lt_u32 vcc, 32, v99
    v_cmp_lt_u32 s[58:59], 31, v88
    v_lshrrev_b32 v89, 16, v96
    v_add_u32 v97, 80, v97
    s_or_b64 vcc, vcc, s[58:59]
    s_cbranch_scc1 L2_xs4
    v_lshlrev_b32 v89, v1, v89
    v_and_b32 v89, v45, v89
    v_cmp_ne_u32 vcc, 0, v89
    v_xor_b32 v90, v97, v89
    s_add_u32 s3, s37, s38
    v_mbcnt_lo_u32_b32 v98, vcc_lo, 0
    v_mbcnt_hi_u32_b32 v98, vcc_hi, v98
    s_bcnt1_i32_b64 s41, vcc
    v_lshl_add_u32 v98, v98, 2, s3
    s_mov_b64 exec, vcc
    ds_write_b32 v98, v90
    s_mov_b64 exec, -1
    s_lshl2_add_u32 s37, s41, s37
    s_branch L2_xr4
L2_xf4:
    s_waitcnt lgkmcnt(0)
    s_cmp_gt_u32 s37, 1024
    s_cbranch_scc1 L2_xs4
    v_mov_b32 v43, -1
    s_cmp_ge_u32 s37, 512
    s_cbranch_scc1 L2_xg4
    v_mov_b32 v42, -1
    s_cmp_ge_u32 s37, 256
    s_cbranch_scc1 L2_xg4
    v_mov_b32 v41, -1
    s_branch L2_xg4
L2_xs4:
    s_waitcnt lgkmcnt(0)
    v_mov_b32 v40, -1
    v_mov_b32 v41, -1
    v_mov_b32 v42, -1
    v_mov_b32 v43, -1
    s_add_u32 s3, s42, 0
    s_bitset1_b32 s36, s3
    s_branch L2_xg4
L2_xo5:
    v_cmp_lt_u32 vcc, 20, v99
    s_mov_b32 s101, 1
    s_cbranch_vccz L2_xp5
    v_cmp_lt_u32 vcc, 32, v99
    v_cmp_lt_u32 s[58:59], 31, v88
    s_mov_b32 s101, 2
    s_or_b64 vcc, vcc, s[58:59]
    s_cbranch_scc0 L2_xp5
    s_mov_b32 s37, 0x10000
    s_branch L2_xp5
L2_xa6:
    s_cmp_eq_u32 s101, 1
    s_cbranch_scc1 L2_xc6
    v_lshlrev_b32 v89, 0, v96
    v_add_u32 v90, 140, v97
    v_bitop3_b32 v90, v89, v45, v90 bitop3:0x6a
    ds_write_b32 v98, v90 offset:28
    v_lshlrev_b32 v89, 4, v96
    v_add_u32 v90, 120, v97
    v_bitop3_b32 v90, v89, v45, v90 bitop3:0x6a
    ds_write_b32 v98, v90 offset:24
    v_lshlrev_b32 v89, 8, v96
    v_add_u32 v90, 100, v97
    v_bitop3_b32 v90, v89, v45, v90 bitop3:0x6a
    ds_write_b32 v98, v90 offset:20
L2_xc6:
    v_lshlrev_b32 v89, 12, v96
    v_add_u32 v90, 80, v97
    v_bitop3_b32 v90, v89, v45, v90 bitop3:0x6a
    ds_write_b32 v98, v90 offset:16
    s_branch L2_xb6
L2_xe6:
    v_cmp_lt_u32 vcc, 32, v99
    v_cmp_lt_u32 s[58:59], 31, v88
    v_lshrrev_b32 v89, 16, v96
    v_add_u32 v97, 80, v97
    s_or_b64 vcc, vcc, s[58:59]
    s_cbranch_scc1 L2_xs6
    v_lshlrev_b32 v89, v1, v89
    v_and_b32 v89, v45, v89
    v_cmp_ne_u32 vcc, 0, v89
    v_xor_b32 v90, v97, v89
    s_add_u32 s3, s37, s38
    v_mbcnt_lo_u32_b32 v98, vcc_lo, 0
    v_mbcnt_hi_u32_b32 v98, vcc_hi, v98
    s_bcnt1_i32_b64 s41, vcc
    v_lshl_add_u32 v98, v98, 2, s3
    s_mov_b64 exec, vcc
    ds_write_b32 v98, v90
    s_mov_b64 exec, -1
    s_lshl2_add_u32 s37, s41, s37
    s_branch L2_xr6
L2_xf6:
    s_waitcnt lgkmcnt(0)
    s_cmp_gt_u32 s37, 1024
    s_cbranch_scc1 L2_xs6
    v_mov_b32 v43, -1
    s_cmp_ge_u32 s37, 512
    s_cbranch_scc1 L2_xg6
    v_mov_b32 v42, -1
    s_cmp_ge_u32 s37, 256
    s_cbranch_scc1 L2_xg6
    v_mov_b32 v41, -1
    s_branch L2_xg6
L2_xs6:
    s_waitcnt lgkmcnt(0)
    v_mov_b32 v40, -1
    v_mov_b32 v41, -1
    v_mov_b32 v42, -1
    v_mov_b32 v43, -1
    s_add_u32 s3, s42, 1
    s_bitset1_b32 s36, s3
    s_branch L2_xg6
L2_p2s:
    s_sleep 8
    s_branch L2_p2
L2_c7:
    s_lshl_b64 s[52:53], s[82:83], 1
    s_andn2_b64 s[52:53], s[52:53], s[80:81]
    s_andn2_b64 s[52:53], s[52:53], s[54:55]
    s_or_b64 s[80:81], s[80:81], s[52:53]
    s_not_b64 vcc, s[52:53]
    s_mov_b64 exec, -1
    v_cndmask_b32_dpp v84, v84, v84, vcc wave_shr:1 row_mask:0xf bank_mask:0xf
    v_cndmask_b32_dpp v85, v85, v85, vcc wave_shr:1 row_mask:0xf bank_mask:0xf
    s_lshr_b64 s[52:53], s[52:53], 1
    v_cndmask_b32_dpp v86, v86, v86, vcc wave_shr:1 row_mask:0xf bank_mask:0xf
    v_cndmask_b32_dpp v87, v87, v87, vcc wave_shr:1 row_mask:0xf bank_mask:0xf
    s_andn2_b64 s[82:83], s[82:83], s[52:53]
    v_cndmask_b32_dpp v7, v7, v7, vcc wave_shr:1 row_mask:0xf bank_mask:0xf
    s_mov_b64 exec, s[54:55]
    s_cbranch_scc0 L2_d7
    s_mov_b64 exec, s[82:83]
    s_nop 1
    v_mfma_f32_4x4x4_16b_bf16 v[88:91], v[12:13], v[84:85], 0
    s_nop 1
    v_mfma_f32_4x4x4_16b_bf16 v[88:91], v[10:11], v[86:87], v[88:91]
    s_nop 4
    v_cvt_pk_bf16_f32 v88, v88, v89
    v_cvt_pk_bf16_f32 v89, v90, v91
    ds_pk_add_bf16 v7, v88 offset:65408
    ds_pk_add_bf16 v7, v89 offset:65412
    s_mov_b64 exec, s[54:55]
    s_branch L2_d7
L2_c8:
    s_lshl_b64 s[52:53], s[82:83], 1
    s_andn2_b64 s[52:53], s[52:53], s[80:81]
    s_andn2_b64 s[52:53], s[52:53], s[50:51]
    s_or_b64 s[80:81], s[80:81], s[52:53]
    s_not_b64 vcc, s[52:53]
    s_mov_b64 exec, -1
    v_cndmask_b32_dpp v84, v84, v84, vcc wave_shr:1 row_mask:0xf bank_mask:0xf
    v_cndmask_b32_dpp v85, v85, v85, vcc wave_shr:1 row_mask:0xf bank_mask:0xf
    s_lshr_b64 s[52:53], s[52:53], 1
    v_cndmask_b32_dpp v86, v86, v86, vcc wave_shr:1 row_mask:0xf bank_mask:0xf
    v_cndmask_b32_dpp v87, v87, v87, vcc wave_shr:1 row_mask:0xf bank_mask:0xf
    s_andn2_b64 s[82:83], s[82:83], s[52:53]
    v_cndmask_b32_dpp v7, v7, v7, vcc wave_shr:1 row_mask:0xf bank_mask:0xf
    s_mov_b64 exec, s[50:51]
    s_cbranch_scc0 L2_d8
    s_mov_b64 exec, s[82:83]
    s_nop 1
    v_mfma_f32_4x4x4_16b_bf16 v[88:91], v[12:13], v[84:85], 0
    s_nop 1
    v_mfma_f32_4x4x4_16b_bf16 v[88:91], v[10:11], v[86:87], v[88:91]
    s_nop 4
    v_cvt_pk_bf16_f32 v88, v88, v89
    v_cvt_pk_bf16_f32 v89, v90, v91
    ds_pk_add_bf16 v7, v88 offset:65408
    ds_pk_add_bf16 v7, v89 offset:65412
    s_mov_b64 exec, s[50:51]
    s_branch L2_d8
L2_xo9:
    v_cmp_lt_u32 vcc, 20, v99
    s_mov_b32 s101, 1
    s_cbranch_vccz L2_xp9
    v_cmp_lt_u32 vcc, 32, v99
    v_cmp_lt_u32 s[58:59], 31, v88
    s_mov_b32 s101, 2
    s_or_b64 vcc, vcc, s[58:59]
    s_cbranch_scc0 L2_xp9
    s_mov_b32 s37, 0x10000
    s_branch L2_xp9
L2_c12:
    s_lshl_b64 s[52:53], s[82:83], 1
    s_andn2_b64 s[52:53], s[52:53], s[80:81]
    s_andn2_b64 s[52:53], s[52:53], s[54:55]
    s_or_b64 s[80:81], s[80:81], s[52:53]
    s_not_b64 vcc, s[52:53]
    s_mov_b64 exec, -1
    v_cndmask_b32_dpp v84, v84, v84, vcc wave_shr:1 row_mask:0xf bank_mask:0xf
    v_cndmask_b32_dpp v85, v85, v85, vcc wave_shr:1 row_mask:0xf bank_mask:0xf
    s_lshr_b64 s[52:53], s[52:53], 1
    v_cndmask_b32_dpp v86, v86, v86, vcc wave_shr:1 row_mask:0xf bank_mask:0xf
    v_cndmask_b32_dpp v87, v87, v87, vcc wave_shr:1 row_mask:0xf bank_mask:0xf
    s_andn2_b64 s[82:83], s[82:83], s[52:53]
    v_cndmask_b32_dpp v7, v7, v7, vcc wave_shr:1 row_mask:0xf bank_mask:0xf
    s_mov_b64 exec, s[54:55]
    s_cbranch_scc0 L2_d12
    s_mov_b64 exec, s[82:83]
    s_nop 1
    v_mfma_f32_4x4x4_16b_bf16 v[88:91], v[12:13], v[84:85], 0
    s_nop 1
    v_mfma_f32_4x4x4_16b_bf16 v[88:91], v[10:11], v[86:87], v[88:91]
    s_nop 4
    v_cvt_pk_bf16_f32 v88, v88, v89
    v_cvt_pk_bf16_f32 v89, v90, v91
    ds_pk_add_bf16 v7, v88 offset:65408
    ds_pk_add_bf16 v7, v89 offset:65412
    s_mov_b64 exec, s[54:55]
    s_branch L2_d12
L2_c13:
    s_lshl_b64 s[52:53], s[82:83], 1
    s_andn2_b64 s[52:53], s[52:53], s[80:81]
    s_andn2_b64 s[52:53], s[52:53], s[50:51]
    s_or_b64 s[80:81], s[80:81], s[52:53]
    s_not_b64 vcc, s[52:53]
    s_mov_b64 exec, -1
    v_cndmask_b32_dpp v84, v84, v84, vcc wave_shr:1 row_mask:0xf bank_mask:0xf
    v_cndmask_b32_dpp v85, v85, v85, vcc wave_shr:1 row_mask:0xf bank_mask:0xf
    s_lshr_b64 s[52:53], s[52:53], 1
    v_cndmask_b32_dpp v86, v86, v86, vcc wave_shr:1 row_mask:0xf bank_mask:0xf
    v_cndmask_b32_dpp v87, v87, v87, vcc wave_shr:1 row_mask:0xf bank_mask:0xf
    s_andn2_b64 s[82:83], s[82:83], s[52:53]
    v_cndmask_b32_dpp v7, v7, v7, vcc wave_shr:1 row_mask:0xf bank_mask:0xf
    s_mov_b64 exec, s[50:51]
    s_cbranch_scc0 L2_d13
    s_mov_b64 exec, s[82:83]
    s_nop 1
    v_mfma_f32_4x4x4_16b_bf16 v[88:91], v[12:13], v[84:85], 0
    s_nop 1
    v_mfma_f32_4x4x4_16b_bf16 v[88:91], v[10:11], v[86:87], v[88:91]
    s_nop 4
    v_cvt_pk_bf16_f32 v88, v88, v89
    v_cvt_pk_bf16_f32 v89, v90, v91
    ds_pk_add_bf16 v7, v88 offset:65408
    ds_pk_add_bf16 v7, v89 offset:65412
    s_mov_b64 exec, s[50:51]
    s_branch L2_d13
L2_c15:
    s_lshl_b64 s[52:53], s[82:83], 1
    s_andn2_b64 s[52:53], s[52:53], s[80:81]
    s_andn2_b64 s[52:53], s[52:53], s[54:55]
    s_or_b64 s[80:81], s[80:81], s[52:53]
    s_not_b64 vcc, s[52:53]
    s_mov_b64 exec, -1
    v_cndmask_b32_dpp v84, v84, v84, vcc wave_shr:1 row_mask:0xf bank_mask:0xf
    v_cndmask_b32_dpp v85, v85, v85, vcc wave_shr:1 row_mask:0xf bank_mask:0xf
    s_lshr_b64 s[52:53], s[52:53], 1
    v_cndmask_b32_dpp v86, v86, v86, vcc wave_shr:1 row_mask:0xf bank_mask:0xf
    v_cndmask_b32_dpp v87, v87, v87, vcc wave_shr:1 row_mask:0xf bank_mask:0xf
    s_andn2_b64 s[82:83], s[82:83], s[52:53]
    v_cndmask_b32_dpp v7, v7, v7, vcc wave_shr:1 row_mask:0xf bank_mask:0xf
    s_mov_b64 exec, s[54:55]
    s_cbranch_scc0 L2_d15
    s_mov_b64 exec, s[82:83]
    s_nop 1
    v_mfma_f32_4x4x4_16b_bf16 v[88:91], v[12:13], v[84:85], 0
    s_nop 1
    v_mfma_f32_4x4x4_16b_bf16 v[88:91], v[10:11], v[86:87], v[88:91]
    s_nop 4
    v_cvt_pk_bf16_f32 v88, v88, v89
    v_cvt_pk_bf16_f32 v89, v90, v91
    ds_pk_add_bf16 v7, v88 offset:65408
    ds_pk_add_bf16 v7, v89 offset:65412
    s_mov_b64 exec, s[54:55]
    s_branch L2_d15
L2_c16:
    s_lshl_b64 s[52:53], s[82:83], 1
    s_andn2_b64 s[52:53], s[52:53], s[80:81]
    s_andn2_b64 s[52:53], s[52:53], s[50:51]
    s_or_b64 s[80:81], s[80:81], s[52:53]
    s_not_b64 vcc, s[52:53]
    s_mov_b64 exec, -1
    v_cndmask_b32_dpp v84, v84, v84, vcc wave_shr:1 row_mask:0xf bank_mask:0xf
    v_cndmask_b32_dpp v85, v85, v85, vcc wave_shr:1 row_mask:0xf bank_mask:0xf
    s_lshr_b64 s[52:53], s[52:53], 1
    v_cndmask_b32_dpp v86, v86, v86, vcc wave_shr:1 row_mask:0xf bank_mask:0xf
    v_cndmask_b32_dpp v87, v87, v87, vcc wave_shr:1 row_mask:0xf bank_mask:0xf
    s_andn2_b64 s[82:83], s[82:83], s[52:53]
    v_cndmask_b32_dpp v7, v7, v7, vcc wave_shr:1 row_mask:0xf bank_mask:0xf
    s_mov_b64 exec, s[50:51]
    s_cbranch_scc0 L2_d16
    s_mov_b64 exec, s[82:83]
    s_nop 1
    v_mfma_f32_4x4x4_16b_bf16 v[88:91], v[12:13], v[84:85], 0
    s_nop 1
    v_mfma_f32_4x4x4_16b_bf16 v[88:91], v[10:11], v[86:87], v[88:91]
    s_nop 4
    v_cvt_pk_bf16_f32 v88, v88, v89
    v_cvt_pk_bf16_f32 v89, v90, v91
    ds_pk_add_bf16 v7, v88 offset:65408
    ds_pk_add_bf16 v7, v89 offset:65412
    s_mov_b64 exec, s[50:51]
    s_branch L2_d16
L2_c19:
    s_lshl_b64 s[52:53], s[82:83], 1
    s_andn2_b64 s[52:53], s[52:53], s[80:81]
    s_andn2_b64 s[52:53], s[52:53], s[54:55]
    s_or_b64 s[80:81], s[80:81], s[52:53]
    s_not_b64 vcc, s[52:53]
    s_mov_b64 exec, -1
    v_cndmask_b32_dpp v84, v84, v84, vcc wave_shr:1 row_mask:0xf bank_mask:0xf
    v_cndmask_b32_dpp v85, v85, v85, vcc wave_shr:1 row_mask:0xf bank_mask:0xf
    s_lshr_b64 s[52:53], s[52:53], 1
    v_cndmask_b32_dpp v86, v86, v86, vcc wave_shr:1 row_mask:0xf bank_mask:0xf
    v_cndmask_b32_dpp v87, v87, v87, vcc wave_shr:1 row_mask:0xf bank_mask:0xf
    s_andn2_b64 s[82:83], s[82:83], s[52:53]
    v_cndmask_b32_dpp v7, v7, v7, vcc wave_shr:1 row_mask:0xf bank_mask:0xf
    s_mov_b64 exec, s[54:55]
    s_cbranch_scc0 L2_d19
    s_mov_b64 exec, s[82:83]
    s_nop 1
    v_mfma_f32_4x4x4_16b_bf16 v[88:91], v[12:13], v[84:85], 0
    s_nop 1
    v_mfma_f32_4x4x4_16b_bf16 v[88:91], v[10:11], v[86:87], v[88:91]
    s_nop 4
    v_cvt_pk_bf16_f32 v88, v88, v89
    v_cvt_pk_bf16_f32 v89, v90, v91
    ds_pk_add_bf16 v7, v88 offset:65408
    ds_pk_add_bf16 v7, v89 offset:65412
    s_mov_b64 exec, s[54:55]
    s_branch L2_d19
L2_c20:
    s_lshl_b64 s[52:53], s[82:83], 1
    s_andn2_b64 s[52:53], s[52:53], s[80:81]
    s_andn2_b64 s[52:53], s[52:53], s[50:51]
    s_or_b64 s[80:81], s[80:81], s[52:53]
    s_not_b64 vcc, s[52:53]
    s_mov_b64 exec, -1
    v_cndmask_b32_dpp v84, v84, v84, vcc wave_shr:1 row_mask:0xf bank_mask:0xf
    v_cndmask_b32_dpp v85, v85, v85, vcc wave_shr:1 row_mask:0xf bank_mask:0xf
    s_lshr_b64 s[52:53], s[52:53], 1
    v_cndmask_b32_dpp v86, v86, v86, vcc wave_shr:1 row_mask:0xf bank_mask:0xf
    v_cndmask_b32_dpp v87, v87, v87, vcc wave_shr:1 row_mask:0xf bank_mask:0xf
    s_andn2_b64 s[82:83], s[82:83], s[52:53]
    v_cndmask_b32_dpp v7, v7, v7, vcc wave_shr:1 row_mask:0xf bank_mask:0xf
    s_mov_b64 exec, s[50:51]
    s_cbranch_scc0 L2_d20
    s_mov_b64 exec, s[82:83]
    s_nop 1
    v_mfma_f32_4x4x4_16b_bf16 v[88:91], v[12:13], v[84:85], 0
    s_nop 1
    v_mfma_f32_4x4x4_16b_bf16 v[88:91], v[10:11], v[86:87], v[88:91]
    s_nop 4
    v_cvt_pk_bf16_f32 v88, v88, v89
    v_cvt_pk_bf16_f32 v89, v90, v91
    ds_pk_add_bf16 v7, v88 offset:65408
    ds_pk_add_bf16 v7, v89 offset:65412
    s_mov_b64 exec, s[50:51]
    s_branch L2_d20
L2_c21:
    s_lshl_b64 s[52:53], s[82:83], 1
    s_andn2_b64 s[52:53], s[52:53], s[80:81]
    s_andn2_b64 s[52:53], s[52:53], s[54:55]
    s_or_b64 s[80:81], s[80:81], s[52:53]
    s_not_b64 vcc, s[52:53]
    s_mov_b64 exec, -1
    v_cndmask_b32_dpp v84, v84, v84, vcc wave_shr:1 row_mask:0xf bank_mask:0xf
    v_cndmask_b32_dpp v85, v85, v85, vcc wave_shr:1 row_mask:0xf bank_mask:0xf
    s_lshr_b64 s[52:53], s[52:53], 1
    v_cndmask_b32_dpp v86, v86, v86, vcc wave_shr:1 row_mask:0xf bank_mask:0xf
    v_cndmask_b32_dpp v87, v87, v87, vcc wave_shr:1 row_mask:0xf bank_mask:0xf
    s_andn2_b64 s[82:83], s[82:83], s[52:53]
    v_cndmask_b32_dpp v7, v7, v7, vcc wave_shr:1 row_mask:0xf bank_mask:0xf
    s_mov_b64 exec, s[54:55]
    s_cbranch_scc0 L2_d21
    s_mov_b64 exec, s[82:83]
    s_nop 1
    v_mfma_f32_4x4x4_16b_bf16 v[88:91], v[12:13], v[84:85], 0
    s_nop 1
    v_mfma_f32_4x4x4_16b_bf16 v[88:91], v[10:11], v[86:87], v[88:91]
    s_nop 4
    v_cvt_pk_bf16_f32 v88, v88, v89
    v_cvt_pk_bf16_f32 v89, v90, v91
    ds_pk_add_bf16 v7, v88 offset:65408
    ds_pk_add_bf16 v7, v89 offset:65412
    s_mov_b64 exec, s[54:55]
    s_branch L2_d21
L2_c22:
    s_lshl_b64 s[52:53], s[82:83], 1
    s_andn2_b64 s[52:53], s[52:53], s[80:81]
    s_andn2_b64 s[52:53], s[52:53], s[50:51]
    s_or_b64 s[80:81], s[80:81], s[52:53]
    s_not_b64 vcc, s[52:53]
    s_mov_b64 exec, -1
    v_cndmask_b32_dpp v84, v84, v84, vcc wave_shr:1 row_mask:0xf bank_mask:0xf
    v_cndmask_b32_dpp v85, v85, v85, vcc wave_shr:1 row_mask:0xf bank_mask:0xf
    s_lshr_b64 s[52:53], s[52:53], 1
    v_cndmask_b32_dpp v86, v86, v86, vcc wave_shr:1 row_mask:0xf bank_mask:0xf
    v_cndmask_b32_dpp v87, v87, v87, vcc wave_shr:1 row_mask:0xf bank_mask:0xf
    s_andn2_b64 s[82:83], s[82:83], s[52:53]
    v_cndmask_b32_dpp v7, v7, v7, vcc wave_shr:1 row_mask:0xf bank_mask:0xf
    s_mov_b64 exec, s[50:51]
    s_cbranch_scc0 L2_d22
    s_mov_b64 exec, s[82:83]
    s_nop 1
    v_mfma_f32_4x4x4_16b_bf16 v[88:91], v[12:13], v[84:85], 0
    s_nop 1
    v_mfma_f32_4x4x4_16b_bf16 v[88:91], v[10:11], v[86:87], v[88:91]
    s_nop 4
    v_cvt_pk_bf16_f32 v88, v88, v89
    v_cvt_pk_bf16_f32 v89, v90, v91
    ds_pk_add_bf16 v7, v88 offset:65408
    ds_pk_add_bf16 v7, v89 offset:65412
    s_mov_b64 exec, s[50:51]
    s_branch L2_d22
L2_c23:
    s_lshl_b64 s[52:53], s[82:83], 1
    s_andn2_b64 s[52:53], s[52:53], s[80:81]
    s_andn2_b64 s[52:53], s[52:53], s[54:55]
    s_or_b64 s[80:81], s[80:81], s[52:53]
    s_not_b64 vcc, s[52:53]
    s_mov_b64 exec, -1
    v_cndmask_b32_dpp v84, v84, v84, vcc wave_shr:1 row_mask:0xf bank_mask:0xf
    v_cndmask_b32_dpp v85, v85, v85, vcc wave_shr:1 row_mask:0xf bank_mask:0xf
    s_lshr_b64 s[52:53], s[52:53], 1
    v_cndmask_b32_dpp v86, v86, v86, vcc wave_shr:1 row_mask:0xf bank_mask:0xf
    v_cndmask_b32_dpp v87, v87, v87, vcc wave_shr:1 row_mask:0xf bank_mask:0xf
    s_andn2_b64 s[82:83], s[82:83], s[52:53]
    v_cndmask_b32_dpp v7, v7, v7, vcc wave_shr:1 row_mask:0xf bank_mask:0xf
    s_mov_b64 exec, s[54:55]
    s_cbranch_scc0 L2_d23
    s_mov_b64 exec, s[82:83]
    s_nop 1
    v_mfma_f32_4x4x4_16b_bf16 v[88:91], v[12:13], v[84:85], 0
    s_nop 1
    v_mfma_f32_4x4x4_16b_bf16 v[88:91], v[10:11], v[86:87], v[88:91]
    s_nop 4
    v_cvt_pk_bf16_f32 v88, v88, v89
    v_cvt_pk_bf16_f32 v89, v90, v91
    ds_pk_add_bf16 v7, v88 offset:65408
    ds_pk_add_bf16 v7, v89 offset:65412
    s_mov_b64 exec, s[54:55]
    s_branch L2_d23
L2_c24:
    s_lshl_b64 s[52:53], s[82:83], 1
    s_andn2_b64 s[52:53], s[52:53], s[80:81]
    s_andn2_b64 s[52:53], s[52:53], s[50:51]
    s_or_b64 s[80:81], s[80:81], s[52:53]
    s_not_b64 vcc, s[52:53]
    s_mov_b64 exec, -1
    v_cndmask_b32_dpp v84, v84, v84, vcc wave_shr:1 row_mask:0xf bank_mask:0xf
    v_cndmask_b32_dpp v85, v85, v85, vcc wave_shr:1 row_mask:0xf bank_mask:0xf
    s_lshr_b64 s[52:53], s[52:53], 1
    v_cndmask_b32_dpp v86, v86, v86, vcc wave_shr:1 row_mask:0xf bank_mask:0xf
    v_cndmask_b32_dpp v87, v87, v87, vcc wave_shr:1 row_mask:0xf bank_mask:0xf
    s_andn2_b64 s[82:83], s[82:83], s[52:53]
    v_cndmask_b32_dpp v7, v7, v7, vcc wave_shr:1 row_mask:0xf bank_mask:0xf
    s_mov_b64 exec, s[50:51]
    s_cbranch_scc0 L2_d24
    s_mov_b64 exec, s[82:83]
    s_nop 1
    v_mfma_f32_4x4x4_16b_bf16 v[88:91], v[12:13], v[84:85], 0
    s_nop 1
    v_mfma_f32_4x4x4_16b_bf16 v[88:91], v[10:11], v[86:87], v[88:91]
    s_nop 4
    v_cvt_pk_bf16_f32 v88, v88, v89
    v_cvt_pk_bf16_f32 v89, v90, v91
    ds_pk_add_bf16 v7, v88 offset:65408
    ds_pk_add_bf16 v7, v89 offset:65412
    s_mov_b64 exec, s[50:51]
    s_branch L2_d24
L2_xa25:
    s_cmp_eq_u32 s101, 1
    s_cbranch_scc1 L2_xc25
    v_lshlrev_b32 v89, 0, v96
    v_add_u32 v90, 140, v97
    v_bitop3_b32 v90, v89, v45, v90 bitop3:0x6a
    ds_write_b32 v98, v90 offset:28
    v_lshlrev_b32 v89, 4, v96
    v_add_u32 v90, 120, v97
    v_bitop3_b32 v90, v89, v45, v90 bitop3:0x6a
    ds_write_b32 v98, v90 offset:24
    v_lshlrev_b32 v89, 8, v96
    v_add_u32 v90, 100, v97
    v_bitop3_b32 v90, v89, v45, v90 bitop3:0x6a
    ds_write_b32 v98, v90 offset:20
L2_xc25:
    v_lshlrev_b32 v89, 12, v96
    v_add_u32 v90, 80, v97
    v_bitop3_b32 v90, v89, v45, v90 bitop3:0x6a
    ds_write_b32 v98, v90 offset:16
    s_branch L2_xb25
L2_xe25:
    v_cmp_lt_u32 vcc, 32, v99
    v_cmp_lt_u32 s[58:59], 31, v88
    v_lshrrev_b32 v89, 16, v96
    v_add_u32 v97, 80, v97
    s_or_b64 vcc, vcc, s[58:59]
    s_cbranch_scc1 L2_xs25
    v_lshlrev_b32 v89, v1, v89
    v_and_b32 v89, v45, v89
    v_cmp_ne_u32 vcc, 0, v89
    v_xor_b32 v90, v97, v89
    s_add_u32 s3, s37, s38
    v_mbcnt_lo_u32_b32 v98, vcc_lo, 0
    v_mbcnt_hi_u32_b32 v98, vcc_hi, v98
    s_bcnt1_i32_b64 s41, vcc
    v_lshl_add_u32 v98, v98, 2, s3
    s_mov_b64 exec, vcc
    ds_write_b32 v98, v90
    s_mov_b64 exec, -1
    s_lshl2_add_u32 s37, s41, s37
    s_branch L2_xr25
L2_xf25:
    s_waitcnt lgkmcnt(0)
    s_cmp_gt_u32 s37, 1024
    s_cbranch_scc1 L2_xs25
    v_mov_b32 v43, -1
    s_cmp_ge_u32 s37, 512
    s_cbranch_scc1 L2_xg25
    v_mov_b32 v42, -1
    s_cmp_ge_u32 s37, 256
    s_cbranch_scc1 L2_xg25
    v_mov_b32 v41, -1
    s_branch L2_xg25
L2_xs25:
    s_waitcnt lgkmcnt(0)
    v_mov_b32 v40, -1
    v_mov_b32 v41, -1
    v_mov_b32 v42, -1
    v_mov_b32 v43, -1
    s_add_u32 s3, s42, 2
    s_bitset1_b32 s36, s3
    s_branch L2_xg25
L2_c26:
    s_lshl_b64 s[52:53], s[82:83], 1
    s_andn2_b64 s[52:53], s[52:53], s[80:81]
    s_andn2_b64 s[52:53], s[52:53], s[54:55]
    s_or_b64 s[80:81], s[80:81], s[52:53]
    s_not_b64 vcc, s[52:53]
    s_mov_b64 exec, -1
    v_cndmask_b32_dpp v84, v84, v84, vcc wave_shr:1 row_mask:0xf bank_mask:0xf
    v_cndmask_b32_dpp v85, v85, v85, vcc wave_shr:1 row_mask:0xf bank_mask:0xf
    s_lshr_b64 s[52:53], s[52:53], 1
    v_cndmask_b32_dpp v86, v86, v86, vcc wave_shr:1 row_mask:0xf bank_mask:0xf
    v_cndmask_b32_dpp v87, v87, v87, vcc wave_shr:1 row_mask:0xf bank_mask:0xf
    s_andn2_b64 s[82:83], s[82:83], s[52:53]
    v_cndmask_b32_dpp v7, v7, v7, vcc wave_shr:1 row_mask:0xf bank_mask:0xf
    s_mov_b64 exec, s[54:55]
    s_cbranch_scc0 L2_d26
    s_mov_b64 exec, s[82:83]
    s_nop 1
    v_mfma_f32_4x4x4_16b_bf16 v[88:91], v[12:13], v[84:85], 0
    s_nop 1
    v_mfma_f32_4x4x4_16b_bf16 v[88:91], v[10:11], v[86:87], v[88:91]
    s_nop 4
    v_cvt_pk_bf16_f32 v88, v88, v89
    v_cvt_pk_bf16_f32 v89, v90, v91
    ds_pk_add_bf16 v7, v88 offset:65408
    ds_pk_add_bf16 v7, v89 offset:65412
    s_mov_b64 exec, s[54:55]
    s_branch L2_d26
L2_c27:
    s_lshl_b64 s[52:53], s[82:83], 1
    s_andn2_b64 s[52:53], s[52:53], s[80:81]
    s_andn2_b64 s[52:53], s[52:53], s[50:51]
    s_or_b64 s[80:81], s[80:81], s[52:53]
    s_not_b64 vcc, s[52:53]
    s_mov_b64 exec, -1
    v_cndmask_b32_dpp v84, v84, v84, vcc wave_shr:1 row_mask:0xf bank_mask:0xf
    v_cndmask_b32_dpp v85, v85, v85, vcc wave_shr:1 row_mask:0xf bank_mask:0xf
    s_lshr_b64 s[52:53], s[52:53], 1
    v_cndmask_b32_dpp v86, v86, v86, vcc wave_shr:1 row_mask:0xf bank_mask:0xf
    v_cndmask_b32_dpp v87, v87, v87, vcc wave_shr:1 row_mask:0xf bank_mask:0xf
    s_andn2_b64 s[82:83], s[82:83], s[52:53]
    v_cndmask_b32_dpp v7, v7, v7, vcc wave_shr:1 row_mask:0xf bank_mask:0xf
    s_mov_b64 exec, s[50:51]
    s_cbranch_scc0 L2_d27
    s_mov_b64 exec, s[82:83]
    s_nop 1
    v_mfma_f32_4x4x4_16b_bf16 v[88:91], v[12:13], v[84:85], 0
    s_nop 1
    v_mfma_f32_4x4x4_16b_bf16 v[88:91], v[10:11], v[86:87], v[88:91]
    s_nop 4
    v_cvt_pk_bf16_f32 v88, v88, v89
    v_cvt_pk_bf16_f32 v89, v90, v91
    ds_pk_add_bf16 v7, v88 offset:65408
    ds_pk_add_bf16 v7, v89 offset:65412
    s_mov_b64 exec, s[50:51]
    s_branch L2_d27
L2_c28:
    s_lshl_b64 s[52:53], s[82:83], 1
    s_andn2_b64 s[52:53], s[52:53], s[80:81]
    s_andn2_b64 s[52:53], s[52:53], s[54:55]
    s_or_b64 s[80:81], s[80:81], s[52:53]
    s_not_b64 vcc, s[52:53]
    s_mov_b64 exec, -1
    v_cndmask_b32_dpp v84, v84, v84, vcc wave_shr:1 row_mask:0xf bank_mask:0xf
    v_cndmask_b32_dpp v85, v85, v85, vcc wave_shr:1 row_mask:0xf bank_mask:0xf
    s_lshr_b64 s[52:53], s[52:53], 1
    v_cndmask_b32_dpp v86, v86, v86, vcc wave_shr:1 row_mask:0xf bank_mask:0xf
    v_cndmask_b32_dpp v87, v87, v87, vcc wave_shr:1 row_mask:0xf bank_mask:0xf
    s_andn2_b64 s[82:83], s[82:83], s[52:53]
    v_cndmask_b32_dpp v7, v7, v7, vcc wave_shr:1 row_mask:0xf bank_mask:0xf
    s_mov_b64 exec, s[54:55]
    s_cbranch_scc0 L2_d28
    s_mov_b64 exec, s[82:83]
    s_nop 1
    v_mfma_f32_4x4x4_16b_bf16 v[88:91], v[12:13], v[84:85], 0
    s_nop 1
    v_mfma_f32_4x4x4_16b_bf16 v[88:91], v[10:11], v[86:87], v[88:91]
    s_nop 4
    v_cvt_pk_bf16_f32 v88, v88, v89
    v_cvt_pk_bf16_f32 v89, v90, v91
    ds_pk_add_bf16 v7, v88 offset:65408
    ds_pk_add_bf16 v7, v89 offset:65412
    s_mov_b64 exec, s[54:55]
    s_branch L2_d28
L2_c29:
    s_lshl_b64 s[52:53], s[82:83], 1
    s_andn2_b64 s[52:53], s[52:53], s[80:81]
    s_andn2_b64 s[52:53], s[52:53], s[50:51]
    s_or_b64 s[80:81], s[80:81], s[52:53]
    s_not_b64 vcc, s[52:53]
    s_mov_b64 exec, -1
    v_cndmask_b32_dpp v84, v84, v84, vcc wave_shr:1 row_mask:0xf bank_mask:0xf
    v_cndmask_b32_dpp v85, v85, v85, vcc wave_shr:1 row_mask:0xf bank_mask:0xf
    s_lshr_b64 s[52:53], s[52:53], 1
    v_cndmask_b32_dpp v86, v86, v86, vcc wave_shr:1 row_mask:0xf bank_mask:0xf
    v_cndmask_b32_dpp v87, v87, v87, vcc wave_shr:1 row_mask:0xf bank_mask:0xf
    s_andn2_b64 s[82:83], s[82:83], s[52:53]
    v_cndmask_b32_dpp v7, v7, v7, vcc wave_shr:1 row_mask:0xf bank_mask:0xf
    s_mov_b64 exec, s[50:51]
    s_cbranch_scc0 L2_d29
    s_mov_b64 exec, s[82:83]
    s_nop 1
    v_mfma_f32_4x4x4_16b_bf16 v[88:91], v[12:13], v[84:85], 0
    s_nop 1
    v_mfma_f32_4x4x4_16b_bf16 v[88:91], v[10:11], v[86:87], v[88:91]
    s_nop 4
    v_cvt_pk_bf16_f32 v88, v88, v89
    v_cvt_pk_bf16_f32 v89, v90, v91
    ds_pk_add_bf16 v7, v88 offset:65408
    ds_pk_add_bf16 v7, v89 offset:65412
    s_mov_b64 exec, s[50:51]
    s_branch L2_d29
L2_c30:
    s_lshl_b64 s[52:53], s[82:83], 1
    s_andn2_b64 s[52:53], s[52:53], s[80:81]
    s_andn2_b64 s[52:53], s[52:53], s[54:55]
    s_or_b64 s[80:81], s[80:81], s[52:53]
    s_not_b64 vcc, s[52:53]
    s_mov_b64 exec, -1
    v_cndmask_b32_dpp v84, v84, v84, vcc wave_shr:1 row_mask:0xf bank_mask:0xf
    v_cndmask_b32_dpp v85, v85, v85, vcc wave_shr:1 row_mask:0xf bank_mask:0xf
    s_lshr_b64 s[52:53], s[52:53], 1
    v_cndmask_b32_dpp v86, v86, v86, vcc wave_shr:1 row_mask:0xf bank_mask:0xf
    v_cndmask_b32_dpp v87, v87, v87, vcc wave_shr:1 row_mask:0xf bank_mask:0xf
    s_andn2_b64 s[82:83], s[82:83], s[52:53]
    v_cndmask_b32_dpp v7, v7, v7, vcc wave_shr:1 row_mask:0xf bank_mask:0xf
    s_mov_b64 exec, s[54:55]
    s_cbranch_scc0 L2_d30
    s_mov_b64 exec, s[82:83]
    s_nop 1
    v_mfma_f32_4x4x4_16b_bf16 v[88:91], v[12:13], v[84:85], 0
    s_nop 1
    v_mfma_f32_4x4x4_16b_bf16 v[88:91], v[10:11], v[86:87], v[88:91]
    s_nop 4
    v_cvt_pk_bf16_f32 v88, v88, v89
    v_cvt_pk_bf16_f32 v89, v90, v91
    ds_pk_add_bf16 v7, v88 offset:65408
    ds_pk_add_bf16 v7, v89 offset:65412
    s_mov_b64 exec, s[54:55]
    s_branch L2_d30
L2_c31:
    s_lshl_b64 s[52:53], s[82:83], 1
    s_andn2_b64 s[52:53], s[52:53], s[80:81]
    s_andn2_b64 s[52:53], s[52:53], s[50:51]
    s_or_b64 s[80:81], s[80:81], s[52:53]
    s_not_b64 vcc, s[52:53]
    s_mov_b64 exec, -1
    v_cndmask_b32_dpp v84, v84, v84, vcc wave_shr:1 row_mask:0xf bank_mask:0xf
    v_cndmask_b32_dpp v85, v85, v85, vcc wave_shr:1 row_mask:0xf bank_mask:0xf
    s_lshr_b64 s[52:53], s[52:53], 1
    v_cndmask_b32_dpp v86, v86, v86, vcc wave_shr:1 row_mask:0xf bank_mask:0xf
    v_cndmask_b32_dpp v87, v87, v87, vcc wave_shr:1 row_mask:0xf bank_mask:0xf
    s_andn2_b64 s[82:83], s[82:83], s[52:53]
    v_cndmask_b32_dpp v7, v7, v7, vcc wave_shr:1 row_mask:0xf bank_mask:0xf
    s_mov_b64 exec, s[50:51]
    s_cbranch_scc0 L2_d31
    s_mov_b64 exec, s[82:83]
    s_nop 1
    v_mfma_f32_4x4x4_16b_bf16 v[88:91], v[12:13], v[84:85], 0
    s_nop 1
    v_mfma_f32_4x4x4_16b_bf16 v[88:91], v[10:11], v[86:87], v[88:91]
    s_nop 4
    v_cvt_pk_bf16_f32 v88, v88, v89
    v_cvt_pk_bf16_f32 v89, v90, v91
    ds_pk_add_bf16 v7, v88 offset:65408
    ds_pk_add_bf16 v7, v89 offset:65412
    s_mov_b64 exec, s[50:51]
    s_branch L2_d31
L2_xo32:
    v_cmp_lt_u32 vcc, 20, v99
    s_mov_b32 s101, 1
    s_cbranch_vccz L2_xp32
    v_cmp_lt_u32 vcc, 32, v99
    v_cmp_lt_u32 s[58:59], 31, v88
    s_mov_b32 s101, 2
    s_or_b64 vcc, vcc, s[58:59]
    s_cbranch_scc0 L2_xp32
    s_mov_b32 s37, 0x10000
    s_branch L2_xp32
L2_c33:
    s_lshl_b64 s[52:53], s[82:83], 1
    s_andn2_b64 s[52:53], s[52:53], s[80:81]
    s_andn2_b64 s[52:53], s[52:53], s[54:55]
    s_or_b64 s[80:81], s[80:81], s[52:53]
    s_not_b64 vcc, s[52:53]
    s_mov_b64 exec, -1
    v_cndmask_b32_dpp v84, v84, v84, vcc wave_shr:1 row_mask:0xf bank_mask:0xf
    v_cndmask_b32_dpp v85, v85, v85, vcc wave_shr:1 row_mask:0xf bank_mask:0xf
    s_lshr_b64 s[52:53], s[52:53], 1
    v_cndmask_b32_dpp v86, v86, v86, vcc wave_shr:1 row_mask:0xf bank_mask:0xf
    v_cndmask_b32_dpp v87, v87, v87, vcc wave_shr:1 row_mask:0xf bank_mask:0xf
    s_andn2_b64 s[82:83], s[82:83], s[52:53]
    v_cndmask_b32_dpp v7, v7, v7, vcc wave_shr:1 row_mask:0xf bank_mask:0xf
    s_mov_b64 exec, s[54:55]
    s_cbranch_scc0 L2_d33
    s_mov_b64 exec, s[82:83]
    s_nop 1
    v_mfma_f32_4x4x4_16b_bf16 v[88:91], v[12:13], v[84:85], 0
    s_nop 1
    v_mfma_f32_4x4x4_16b_bf16 v[88:91], v[10:11], v[86:87], v[88:91]
    s_nop 4
    v_cvt_pk_bf16_f32 v88, v88, v89
    v_cvt_pk_bf16_f32 v89, v90, v91
    ds_pk_add_bf16 v7, v88 offset:65408
    ds_pk_add_bf16 v7, v89 offset:65412
    s_mov_b64 exec, s[54:55]
    s_branch L2_d33
L2_c34:
    s_lshl_b64 s[52:53], s[82:83], 1
    s_andn2_b64 s[52:53], s[52:53], s[80:81]
    s_andn2_b64 s[52:53], s[52:53], s[50:51]
    s_or_b64 s[80:81], s[80:81], s[52:53]
    s_not_b64 vcc, s[52:53]
    s_mov_b64 exec, -1
    v_cndmask_b32_dpp v84, v84, v84, vcc wave_shr:1 row_mask:0xf bank_mask:0xf
    v_cndmask_b32_dpp v85, v85, v85, vcc wave_shr:1 row_mask:0xf bank_mask:0xf
    s_lshr_b64 s[52:53], s[52:53], 1
    v_cndmask_b32_dpp v86, v86, v86, vcc wave_shr:1 row_mask:0xf bank_mask:0xf
    v_cndmask_b32_dpp v87, v87, v87, vcc wave_shr:1 row_mask:0xf bank_mask:0xf
    s_andn2_b64 s[82:83], s[82:83], s[52:53]
    v_cndmask_b32_dpp v7, v7, v7, vcc wave_shr:1 row_mask:0xf bank_mask:0xf
    s_mov_b64 exec, s[50:51]
    s_cbranch_scc0 L2_d34
    s_mov_b64 exec, s[82:83]
    s_nop 1
    v_mfma_f32_4x4x4_16b_bf16 v[88:91], v[12:13], v[84:85], 0
    s_nop 1
    v_mfma_f32_4x4x4_16b_bf16 v[88:91], v[10:11], v[86:87], v[88:91]
    s_nop 4
    v_cvt_pk_bf16_f32 v88, v88, v89
    v_cvt_pk_bf16_f32 v89, v90, v91
    ds_pk_add_bf16 v7, v88 offset:65408
    ds_pk_add_bf16 v7, v89 offset:65412
    s_mov_b64 exec, s[50:51]
    s_branch L2_d34
L2_c35:
    s_lshl_b64 s[52:53], s[82:83], 1
    s_andn2_b64 s[52:53], s[52:53], s[80:81]
    s_andn2_b64 s[52:53], s[52:53], s[54:55]
    s_or_b64 s[80:81], s[80:81], s[52:53]
    s_not_b64 vcc, s[52:53]
    s_mov_b64 exec, -1
    v_cndmask_b32_dpp v84, v84, v84, vcc wave_shr:1 row_mask:0xf bank_mask:0xf
    v_cndmask_b32_dpp v85, v85, v85, vcc wave_shr:1 row_mask:0xf bank_mask:0xf
    s_lshr_b64 s[52:53], s[52:53], 1
    v_cndmask_b32_dpp v86, v86, v86, vcc wave_shr:1 row_mask:0xf bank_mask:0xf
    v_cndmask_b32_dpp v87, v87, v87, vcc wave_shr:1 row_mask:0xf bank_mask:0xf
    s_andn2_b64 s[82:83], s[82:83], s[52:53]
    v_cndmask_b32_dpp v7, v7, v7, vcc wave_shr:1 row_mask:0xf bank_mask:0xf
    s_mov_b64 exec, s[54:55]
    s_cbranch_scc0 L2_d35
    s_mov_b64 exec, s[82:83]
    s_nop 1
    v_mfma_f32_4x4x4_16b_bf16 v[88:91], v[12:13], v[84:85], 0
    s_nop 1
    v_mfma_f32_4x4x4_16b_bf16 v[88:91], v[10:11], v[86:87], v[88:91]
    s_nop 4
    v_cvt_pk_bf16_f32 v88, v88, v89
    v_cvt_pk_bf16_f32 v89, v90, v91
    ds_pk_add_bf16 v7, v88 offset:65408
    ds_pk_add_bf16 v7, v89 offset:65412
    s_mov_b64 exec, s[54:55]
    s_branch L2_d35
L2_c36:
    s_lshl_b64 s[52:53], s[82:83], 1
    s_andn2_b64 s[52:53], s[52:53], s[80:81]
    s_andn2_b64 s[52:53], s[52:53], s[50:51]
    s_or_b64 s[80:81], s[80:81], s[52:53]
    s_not_b64 vcc, s[52:53]
    s_mov_b64 exec, -1
    v_cndmask_b32_dpp v84, v84, v84, vcc wave_shr:1 row_mask:0xf bank_mask:0xf
    v_cndmask_b32_dpp v85, v85, v85, vcc wave_shr:1 row_mask:0xf bank_mask:0xf
    s_lshr_b64 s[52:53], s[52:53], 1
    v_cndmask_b32_dpp v86, v86, v86, vcc wave_shr:1 row_mask:0xf bank_mask:0xf
    v_cndmask_b32_dpp v87, v87, v87, vcc wave_shr:1 row_mask:0xf bank_mask:0xf
    s_andn2_b64 s[82:83], s[82:83], s[52:53]
    v_cndmask_b32_dpp v7, v7, v7, vcc wave_shr:1 row_mask:0xf bank_mask:0xf
    s_mov_b64 exec, s[50:51]
    s_cbranch_scc0 L2_d36
    s_mov_b64 exec, s[82:83]
    s_nop 1
    v_mfma_f32_4x4x4_16b_bf16 v[88:91], v[12:13], v[84:85], 0
    s_nop 1
    v_mfma_f32_4x4x4_16b_bf16 v[88:91], v[10:11], v[86:87], v[88:91]
    s_nop 4
    v_cvt_pk_bf16_f32 v88, v88, v89
    v_cvt_pk_bf16_f32 v89, v90, v91
    ds_pk_add_bf16 v7, v88 offset:65408
    ds_pk_add_bf16 v7, v89 offset:65412
    s_mov_b64 exec, s[50:51]
    s_branch L2_d36
L2_c37:
    s_lshl_b64 s[52:53], s[82:83], 1
    s_andn2_b64 s[52:53], s[52:53], s[80:81]
    s_andn2_b64 s[52:53], s[52:53], s[54:55]
    s_or_b64 s[80:81], s[80:81], s[52:53]
    s_not_b64 vcc, s[52:53]
    s_mov_b64 exec, -1
    v_cndmask_b32_dpp v84, v84, v84, vcc wave_shr:1 row_mask:0xf bank_mask:0xf
    v_cndmask_b32_dpp v85, v85, v85, vcc wave_shr:1 row_mask:0xf bank_mask:0xf
    s_lshr_b64 s[52:53], s[52:53], 1
    v_cndmask_b32_dpp v86, v86, v86, vcc wave_shr:1 row_mask:0xf bank_mask:0xf
    v_cndmask_b32_dpp v87, v87, v87, vcc wave_shr:1 row_mask:0xf bank_mask:0xf
    s_andn2_b64 s[82:83], s[82:83], s[52:53]
    v_cndmask_b32_dpp v7, v7, v7, vcc wave_shr:1 row_mask:0xf bank_mask:0xf
    s_mov_b64 exec, s[54:55]
    s_cbranch_scc0 L2_d37
    s_mov_b64 exec, s[82:83]
    s_nop 1
    v_mfma_f32_4x4x4_16b_bf16 v[88:91], v[12:13], v[84:85], 0
    s_nop 1
    v_mfma_f32_4x4x4_16b_bf16 v[88:91], v[10:11], v[86:87], v[88:91]
    s_nop 4
    v_cvt_pk_bf16_f32 v88, v88, v89
    v_cvt_pk_bf16_f32 v89, v90, v91
    ds_pk_add_bf16 v7, v88 offset:65408
    ds_pk_add_bf16 v7, v89 offset:65412
    s_mov_b64 exec, s[54:55]
    s_branch L2_d37
L2_c38:
    s_lshl_b64 s[52:53], s[82:83], 1
    s_andn2_b64 s[52:53], s[52:53], s[80:81]
    s_andn2_b64 s[52:53], s[52:53], s[50:51]
    s_or_b64 s[80:81], s[80:81], s[52:53]
    s_not_b64 vcc, s[52:53]
    s_mov_b64 exec, -1
    v_cndmask_b32_dpp v84, v84, v84, vcc wave_shr:1 row_mask:0xf bank_mask:0xf
    v_cndmask_b32_dpp v85, v85, v85, vcc wave_shr:1 row_mask:0xf bank_mask:0xf
    s_lshr_b64 s[52:53], s[52:53], 1
    v_cndmask_b32_dpp v86, v86, v86, vcc wave_shr:1 row_mask:0xf bank_mask:0xf
    v_cndmask_b32_dpp v87, v87, v87, vcc wave_shr:1 row_mask:0xf bank_mask:0xf
    s_andn2_b64 s[82:83], s[82:83], s[52:53]
    v_cndmask_b32_dpp v7, v7, v7, vcc wave_shr:1 row_mask:0xf bank_mask:0xf
    s_mov_b64 exec, s[50:51]
    s_cbranch_scc0 L2_d38
    s_mov_b64 exec, s[82:83]
    s_nop 1
    v_mfma_f32_4x4x4_16b_bf16 v[88:91], v[12:13], v[84:85], 0
    s_nop 1
    v_mfma_f32_4x4x4_16b_bf16 v[88:91], v[10:11], v[86:87], v[88:91]
    s_nop 4
    v_cvt_pk_bf16_f32 v88, v88, v89
    v_cvt_pk_bf16_f32 v89, v90, v91
    ds_pk_add_bf16 v7, v88 offset:65408
    ds_pk_add_bf16 v7, v89 offset:65412
    s_mov_b64 exec, s[50:51]
    s_branch L2_d38
L2_c39:
    s_lshl_b64 s[52:53], s[82:83], 1
    s_andn2_b64 s[52:53], s[52:53], s[80:81]
    s_andn2_b64 s[52:53], s[52:53], s[54:55]
    s_or_b64 s[80:81], s[80:81], s[52:53]
    s_not_b64 vcc, s[52:53]
    s_mov_b64 exec, -1
    v_cndmask_b32_dpp v84, v84, v84, vcc wave_shr:1 row_mask:0xf bank_mask:0xf
    v_cndmask_b32_dpp v85, v85, v85, vcc wave_shr:1 row_mask:0xf bank_mask:0xf
    s_lshr_b64 s[52:53], s[52:53], 1
    v_cndmask_b32_dpp v86, v86, v86, vcc wave_shr:1 row_mask:0xf bank_mask:0xf
    v_cndmask_b32_dpp v87, v87, v87, vcc wave_shr:1 row_mask:0xf bank_mask:0xf
    s_andn2_b64 s[82:83], s[82:83], s[52:53]
    v_cndmask_b32_dpp v7, v7, v7, vcc wave_shr:1 row_mask:0xf bank_mask:0xf
    s_mov_b64 exec, s[54:55]
    s_cbranch_scc0 L2_d39
    s_mov_b64 exec, s[82:83]
    s_nop 1
    v_mfma_f32_4x4x4_16b_bf16 v[88:91], v[12:13], v[84:85], 0
    s_nop 1
    v_mfma_f32_4x4x4_16b_bf16 v[88:91], v[10:11], v[86:87], v[88:91]
    s_nop 4
    v_cvt_pk_bf16_f32 v88, v88, v89
    v_cvt_pk_bf16_f32 v89, v90, v91
    ds_pk_add_bf16 v7, v88 offset:65408
    ds_pk_add_bf16 v7, v89 offset:65412
    s_mov_b64 exec, s[54:55]
    s_branch L2_d39
L2_c40:
    s_lshl_b64 s[52:53], s[82:83], 1
    s_andn2_b64 s[52:53], s[52:53], s[80:81]
    s_andn2_b64 s[52:53], s[52:53], s[50:51]
    s_or_b64 s[80:81], s[80:81], s[52:53]
    s_not_b64 vcc, s[52:53]
    s_mov_b64 exec, -1
    v_cndmask_b32_dpp v84, v84, v84, vcc wave_shr:1 row_mask:0xf bank_mask:0xf
    v_cndmask_b32_dpp v85, v85, v85, vcc wave_shr:1 row_mask:0xf bank_mask:0xf
    s_lshr_b64 s[52:53], s[52:53], 1
    v_cndmask_b32_dpp v86, v86, v86, vcc wave_shr:1 row_mask:0xf bank_mask:0xf
    v_cndmask_b32_dpp v87, v87, v87, vcc wave_shr:1 row_mask:0xf bank_mask:0xf
    s_andn2_b64 s[82:83], s[82:83], s[52:53]
    v_cndmask_b32_dpp v7, v7, v7, vcc wave_shr:1 row_mask:0xf bank_mask:0xf
    s_mov_b64 exec, s[50:51]
    s_cbranch_scc0 L2_d40
    s_mov_b64 exec, s[82:83]
    s_nop 1
    v_mfma_f32_4x4x4_16b_bf16 v[88:91], v[12:13], v[84:85], 0
    s_nop 1
    v_mfma_f32_4x4x4_16b_bf16 v[88:91], v[10:11], v[86:87], v[88:91]
    s_nop 4
    v_cvt_pk_bf16_f32 v88, v88, v89
    v_cvt_pk_bf16_f32 v89, v90, v91
    ds_pk_add_bf16 v7, v88 offset:65408
    ds_pk_add_bf16 v7, v89 offset:65412
    s_mov_b64 exec, s[50:51]
    s_branch L2_d40
L2_c41:
    s_lshl_b64 s[52:53], s[82:83], 1
    s_andn2_b64 s[52:53], s[52:53], s[80:81]
    s_andn2_b64 s[52:53], s[52:53], s[54:55]
    s_or_b64 s[80:81], s[80:81], s[52:53]
    s_not_b64 vcc, s[52:53]
    s_mov_b64 exec, -1
    v_cndmask_b32_dpp v84, v84, v84, vcc wave_shr:1 row_mask:0xf bank_mask:0xf
    v_cndmask_b32_dpp v85, v85, v85, vcc wave_shr:1 row_mask:0xf bank_mask:0xf
    s_lshr_b64 s[52:53], s[52:53], 1
    v_cndmask_b32_dpp v86, v86, v86, vcc wave_shr:1 row_mask:0xf bank_mask:0xf
    v_cndmask_b32_dpp v87, v87, v87, vcc wave_shr:1 row_mask:0xf bank_mask:0xf
    s_andn2_b64 s[82:83], s[82:83], s[52:53]
    v_cndmask_b32_dpp v7, v7, v7, vcc wave_shr:1 row_mask:0xf bank_mask:0xf
    s_mov_b64 exec, s[54:55]
    s_cbranch_scc0 L2_d41
    s_mov_b64 exec, s[82:83]
    s_nop 1
    v_mfma_f32_4x4x4_16b_bf16 v[88:91], v[12:13], v[84:85], 0
    s_nop 1
    v_mfma_f32_4x4x4_16b_bf16 v[88:91], v[10:11], v[86:87], v[88:91]
    s_nop 4
    v_cvt_pk_bf16_f32 v88, v88, v89
    v_cvt_pk_bf16_f32 v89, v90, v91
    ds_pk_add_bf16 v7, v88 offset:65408
    ds_pk_add_bf16 v7, v89 offset:65412
    s_mov_b64 exec, s[54:55]
    s_branch L2_d41
L2_c42:
    s_lshl_b64 s[52:53], s[82:83], 1
    s_andn2_b64 s[52:53], s[52:53], s[80:81]
    s_andn2_b64 s[52:53], s[52:53], s[50:51]
    s_or_b64 s[80:81], s[80:81], s[52:53]
    s_not_b64 vcc, s[52:53]
    s_mov_b64 exec, -1
    v_cndmask_b32_dpp v84, v84, v84, vcc wave_shr:1 row_mask:0xf bank_mask:0xf
    v_cndmask_b32_dpp v85, v85, v85, vcc wave_shr:1 row_mask:0xf bank_mask:0xf
    s_lshr_b64 s[52:53], s[52:53], 1
    v_cndmask_b32_dpp v86, v86, v86, vcc wave_shr:1 row_mask:0xf bank_mask:0xf
    v_cndmask_b32_dpp v87, v87, v87, vcc wave_shr:1 row_mask:0xf bank_mask:0xf
    s_andn2_b64 s[82:83], s[82:83], s[52:53]
    v_cndmask_b32_dpp v7, v7, v7, vcc wave_shr:1 row_mask:0xf bank_mask:0xf
    s_mov_b64 exec, s[50:51]
    s_cbranch_scc0 L2_d42
    s_mov_b64 exec, s[82:83]
    s_nop 1
    v_mfma_f32_4x4x4_16b_bf16 v[88:91], v[12:13], v[84:85], 0
    s_nop 1
    v_mfma_f32_4x4x4_16b_bf16 v[88:91], v[10:11], v[86:87], v[88:91]
    s_nop 4
    v_cvt_pk_bf16_f32 v88, v88, v89
    v_cvt_pk_bf16_f32 v89, v90, v91
    ds_pk_add_bf16 v7, v88 offset:65408
    ds_pk_add_bf16 v7, v89 offset:65412
    s_mov_b64 exec, s[50:51]
    s_branch L2_d42
L2_xa43:
    s_cmp_eq_u32 s101, 1
    s_cbranch_scc1 L2_xc43
    v_lshlrev_b32 v89, 0, v96
    v_add_u32 v90, 140, v97
    v_bitop3_b32 v90, v89, v45, v90 bitop3:0x6a
    ds_write_b32 v98, v90 offset:28
    v_lshlrev_b32 v89, 4, v96
    v_add_u32 v90, 120, v97
    v_bitop3_b32 v90, v89, v45, v90 bitop3:0x6a
    ds_write_b32 v98, v90 offset:24
    v_lshlrev_b32 v89, 8, v96
    v_add_u32 v90, 100, v97
    v_bitop3_b32 v90, v89, v45, v90 bitop3:0x6a
    ds_write_b32 v98, v90 offset:20
L2_xc43:
    v_lshlrev_b32 v89, 12, v96
    v_add_u32 v90, 80, v97
    v_bitop3_b32 v90, v89, v45, v90 bitop3:0x6a
    ds_write_b32 v98, v90 offset:16
    s_branch L2_xb43
L2_xe43:
    v_cmp_lt_u32 vcc, 32, v99
    v_cmp_lt_u32 s[58:59], 31, v88
    v_lshrrev_b32 v89, 16, v96
    v_add_u32 v97, 80, v97
    s_or_b64 vcc, vcc, s[58:59]
    s_cbranch_scc1 L2_xs43
    v_lshlrev_b32 v89, v1, v89
    v_and_b32 v89, v45, v89
    v_cmp_ne_u32 vcc, 0, v89
    v_xor_b32 v90, v97, v89
    s_add_u32 s3, s37, s38
    v_mbcnt_lo_u32_b32 v98, vcc_lo, 0
    v_mbcnt_hi_u32_b32 v98, vcc_hi, v98
    s_bcnt1_i32_b64 s41, vcc
    v_lshl_add_u32 v98, v98, 2, s3
    s_mov_b64 exec, vcc
    ds_write_b32 v98, v90
    s_mov_b64 exec, -1
    s_lshl2_add_u32 s37, s41, s37
    s_branch L2_xr43
L2_xf43:
    s_waitcnt lgkmcnt(0)
    s_cmp_gt_u32 s37, 1024
    s_cbranch_scc1 L2_xs43
    v_mov_b32 v43, -1
    s_cmp_ge_u32 s37, 512
    s_cbranch_scc1 L2_xg43
    v_mov_b32 v42, -1
    s_cmp_ge_u32 s37, 256
    s_cbranch_scc1 L2_xg43
    v_mov_b32 v41, -1
    s_branch L2_xg43
L2_xs43:
    s_waitcnt lgkmcnt(0)
    v_mov_b32 v40, -1
    v_mov_b32 v41, -1
    v_mov_b32 v42, -1
    v_mov_b32 v43, -1
    s_add_u32 s3, s42, 2
    s_bitset1_b32 s36, s3
    s_branch L2_xg43
L2_c44:
    s_lshl_b64 s[52:53], s[82:83], 1
    s_andn2_b64 s[52:53], s[52:53], s[80:81]
    s_andn2_b64 s[52:53], s[52:53], s[54:55]
    s_or_b64 s[80:81], s[80:81], s[52:53]
    s_not_b64 vcc, s[52:53]
    s_mov_b64 exec, -1
    v_cndmask_b32_dpp v84, v84, v84, vcc wave_shr:1 row_mask:0xf bank_mask:0xf
    v_cndmask_b32_dpp v85, v85, v85, vcc wave_shr:1 row_mask:0xf bank_mask:0xf
    s_lshr_b64 s[52:53], s[52:53], 1
    v_cndmask_b32_dpp v86, v86, v86, vcc wave_shr:1 row_mask:0xf bank_mask:0xf
    v_cndmask_b32_dpp v87, v87, v87, vcc wave_shr:1 row_mask:0xf bank_mask:0xf
    s_andn2_b64 s[82:83], s[82:83], s[52:53]
    v_cndmask_b32_dpp v7, v7, v7, vcc wave_shr:1 row_mask:0xf bank_mask:0xf
    s_mov_b64 exec, s[54:55]
    s_cbranch_scc0 L2_d44
    s_mov_b64 exec, s[82:83]
    s_nop 1
    v_mfma_f32_4x4x4_16b_bf16 v[88:91], v[12:13], v[84:85], 0
    s_nop 1
    v_mfma_f32_4x4x4_16b_bf16 v[88:91], v[10:11], v[86:87], v[88:91]
    s_nop 4
    v_cvt_pk_bf16_f32 v88, v88, v89
    v_cvt_pk_bf16_f32 v89, v90, v91
    ds_pk_add_bf16 v7, v88 offset:65408
    ds_pk_add_bf16 v7, v89 offset:65412
    s_mov_b64 exec, s[54:55]
    s_branch L2_d44
L2_c45:
    s_lshl_b64 s[52:53], s[82:83], 1
    s_andn2_b64 s[52:53], s[52:53], s[80:81]
    s_andn2_b64 s[52:53], s[52:53], s[50:51]
    s_or_b64 s[80:81], s[80:81], s[52:53]
    s_not_b64 vcc, s[52:53]
    s_mov_b64 exec, -1
    v_cndmask_b32_dpp v84, v84, v84, vcc wave_shr:1 row_mask:0xf bank_mask:0xf
    v_cndmask_b32_dpp v85, v85, v85, vcc wave_shr:1 row_mask:0xf bank_mask:0xf
    s_lshr_b64 s[52:53], s[52:53], 1
    v_cndmask_b32_dpp v86, v86, v86, vcc wave_shr:1 row_mask:0xf bank_mask:0xf
    v_cndmask_b32_dpp v87, v87, v87, vcc wave_shr:1 row_mask:0xf bank_mask:0xf
    s_andn2_b64 s[82:83], s[82:83], s[52:53]
    v_cndmask_b32_dpp v7, v7, v7, vcc wave_shr:1 row_mask:0xf bank_mask:0xf
    s_mov_b64 exec, s[50:51]
    s_cbranch_scc0 L2_d45
    s_mov_b64 exec, s[82:83]
    s_nop 1
    v_mfma_f32_4x4x4_16b_bf16 v[88:91], v[12:13], v[84:85], 0
    s_nop 1
    v_mfma_f32_4x4x4_16b_bf16 v[88:91], v[10:11], v[86:87], v[88:91]
    s_nop 4
    v_cvt_pk_bf16_f32 v88, v88, v89
    v_cvt_pk_bf16_f32 v89, v90, v91
    ds_pk_add_bf16 v7, v88 offset:65408
    ds_pk_add_bf16 v7, v89 offset:65412
    s_mov_b64 exec, s[50:51]
    s_branch L2_d45
L2_c46:
    s_lshl_b64 s[52:53], s[82:83], 1
    s_andn2_b64 s[52:53], s[52:53], s[80:81]
    s_andn2_b64 s[52:53], s[52:53], s[54:55]
    s_or_b64 s[80:81], s[80:81], s[52:53]
    s_not_b64 vcc, s[52:53]
    s_mov_b64 exec, -1
    v_cndmask_b32_dpp v84, v84, v84, vcc wave_shr:1 row_mask:0xf bank_mask:0xf
    v_cndmask_b32_dpp v85, v85, v85, vcc wave_shr:1 row_mask:0xf bank_mask:0xf
    s_lshr_b64 s[52:53], s[52:53], 1
    v_cndmask_b32_dpp v86, v86, v86, vcc wave_shr:1 row_mask:0xf bank_mask:0xf
    v_cndmask_b32_dpp v87, v87, v87, vcc wave_shr:1 row_mask:0xf bank_mask:0xf
    s_andn2_b64 s[82:83], s[82:83], s[52:53]
    v_cndmask_b32_dpp v7, v7, v7, vcc wave_shr:1 row_mask:0xf bank_mask:0xf
    s_mov_b64 exec, s[54:55]
    s_cbranch_scc0 L2_d46
    s_mov_b64 exec, s[82:83]
    s_nop 1
    v_mfma_f32_4x4x4_16b_bf16 v[88:91], v[12:13], v[84:85], 0
    s_nop 1
    v_mfma_f32_4x4x4_16b_bf16 v[88:91], v[10:11], v[86:87], v[88:91]
    s_nop 4
    v_cvt_pk_bf16_f32 v88, v88, v89
    v_cvt_pk_bf16_f32 v89, v90, v91
    ds_pk_add_bf16 v7, v88 offset:65408
    ds_pk_add_bf16 v7, v89 offset:65412
    s_mov_b64 exec, s[54:55]
    s_branch L2_d46
L2_c47:
    s_lshl_b64 s[52:53], s[82:83], 1
    s_andn2_b64 s[52:53], s[52:53], s[80:81]
    s_andn2_b64 s[52:53], s[52:53], s[50:51]
    s_or_b64 s[80:81], s[80:81], s[52:53]
    s_not_b64 vcc, s[52:53]
    s_mov_b64 exec, -1
    v_cndmask_b32_dpp v84, v84, v84, vcc wave_shr:1 row_mask:0xf bank_mask:0xf
    v_cndmask_b32_dpp v85, v85, v85, vcc wave_shr:1 row_mask:0xf bank_mask:0xf
    s_lshr_b64 s[52:53], s[52:53], 1
    v_cndmask_b32_dpp v86, v86, v86, vcc wave_shr:1 row_mask:0xf bank_mask:0xf
    v_cndmask_b32_dpp v87, v87, v87, vcc wave_shr:1 row_mask:0xf bank_mask:0xf
    s_andn2_b64 s[82:83], s[82:83], s[52:53]
    v_cndmask_b32_dpp v7, v7, v7, vcc wave_shr:1 row_mask:0xf bank_mask:0xf
    s_mov_b64 exec, s[50:51]
    s_cbranch_scc0 L2_d47
    s_mov_b64 exec, s[82:83]
    s_nop 1
    v_mfma_f32_4x4x4_16b_bf16 v[88:91], v[12:13], v[84:85], 0
    s_nop 1
    v_mfma_f32_4x4x4_16b_bf16 v[88:91], v[10:11], v[86:87], v[88:91]
    s_nop 4
    v_cvt_pk_bf16_f32 v88, v88, v89
    v_cvt_pk_bf16_f32 v89, v90, v91
    ds_pk_add_bf16 v7, v88 offset:65408
    ds_pk_add_bf16 v7, v89 offset:65412
    s_mov_b64 exec, s[50:51]
    s_branch L2_d47
L2_c48:
    s_lshl_b64 s[52:53], s[82:83], 1
    s_andn2_b64 s[52:53], s[52:53], s[80:81]
    s_andn2_b64 s[52:53], s[52:53], s[54:55]
    s_or_b64 s[80:81], s[80:81], s[52:53]
    s_not_b64 vcc, s[52:53]
    s_mov_b64 exec, -1
    v_cndmask_b32_dpp v84, v84, v84, vcc wave_shr:1 row_mask:0xf bank_mask:0xf
    v_cndmask_b32_dpp v85, v85, v85, vcc wave_shr:1 row_mask:0xf bank_mask:0xf
    s_lshr_b64 s[52:53], s[52:53], 1
    v_cndmask_b32_dpp v86, v86, v86, vcc wave_shr:1 row_mask:0xf bank_mask:0xf
    v_cndmask_b32_dpp v87, v87, v87, vcc wave_shr:1 row_mask:0xf bank_mask:0xf
    s_andn2_b64 s[82:83], s[82:83], s[52:53]
    v_cndmask_b32_dpp v7, v7, v7, vcc wave_shr:1 row_mask:0xf bank_mask:0xf
    s_mov_b64 exec, s[54:55]
    s_cbranch_scc0 L2_d48
    s_mov_b64 exec, s[82:83]
    s_nop 1
    v_mfma_f32_4x4x4_16b_bf16 v[88:91], v[12:13], v[84:85], 0
    s_nop 1
    v_mfma_f32_4x4x4_16b_bf16 v[88:91], v[10:11], v[86:87], v[88:91]
    s_nop 4
    v_cvt_pk_bf16_f32 v88, v88, v89
    v_cvt_pk_bf16_f32 v89, v90, v91
    ds_pk_add_bf16 v7, v88 offset:65408
    ds_pk_add_bf16 v7, v89 offset:65412
    s_mov_b64 exec, s[54:55]
    s_branch L2_d48
L2_c49:
    s_lshl_b64 s[52:53], s[82:83], 1
    s_andn2_b64 s[52:53], s[52:53], s[80:81]
    s_andn2_b64 s[52:53], s[52:53], s[50:51]
    s_or_b64 s[80:81], s[80:81], s[52:53]
    s_not_b64 vcc, s[52:53]
    s_mov_b64 exec, -1
    v_cndmask_b32_dpp v84, v84, v84, vcc wave_shr:1 row_mask:0xf bank_mask:0xf
    v_cndmask_b32_dpp v85, v85, v85, vcc wave_shr:1 row_mask:0xf bank_mask:0xf
    s_lshr_b64 s[52:53], s[52:53], 1
    v_cndmask_b32_dpp v86, v86, v86, vcc wave_shr:1 row_mask:0xf bank_mask:0xf
    v_cndmask_b32_dpp v87, v87, v87, vcc wave_shr:1 row_mask:0xf bank_mask:0xf
    s_andn2_b64 s[82:83], s[82:83], s[52:53]
    v_cndmask_b32_dpp v7, v7, v7, vcc wave_shr:1 row_mask:0xf bank_mask:0xf
    s_mov_b64 exec, s[50:51]
    s_cbranch_scc0 L2_d49
    s_mov_b64 exec, s[82:83]
    s_nop 1
    v_mfma_f32_4x4x4_16b_bf16 v[88:91], v[12:13], v[84:85], 0
    s_nop 1
    v_mfma_f32_4x4x4_16b_bf16 v[88:91], v[10:11], v[86:87], v[88:91]
    s_nop 4
    v_cvt_pk_bf16_f32 v88, v88, v89
    v_cvt_pk_bf16_f32 v89, v90, v91
    ds_pk_add_bf16 v7, v88 offset:65408
    ds_pk_add_bf16 v7, v89 offset:65412
    s_mov_b64 exec, s[50:51]
    s_branch L2_d49
L2_xo50:
    v_cmp_lt_u32 vcc, 20, v99
    s_mov_b32 s101, 1
    s_cbranch_vccz L2_xp50
    v_cmp_lt_u32 vcc, 32, v99
    v_cmp_lt_u32 s[58:59], 31, v88
    s_mov_b32 s101, 2
    s_or_b64 vcc, vcc, s[58:59]
    s_cbranch_scc0 L2_xp50
    s_mov_b32 s37, 0x10000
    s_branch L2_xp50
L2_c51:
    s_lshl_b64 s[52:53], s[82:83], 1
    s_andn2_b64 s[52:53], s[52:53], s[80:81]
    s_andn2_b64 s[52:53], s[52:53], s[54:55]
    s_or_b64 s[80:81], s[80:81], s[52:53]
    s_not_b64 vcc, s[52:53]
    s_mov_b64 exec, -1
    v_cndmask_b32_dpp v84, v84, v84, vcc wave_shr:1 row_mask:0xf bank_mask:0xf
    v_cndmask_b32_dpp v85, v85, v85, vcc wave_shr:1 row_mask:0xf bank_mask:0xf
    s_lshr_b64 s[52:53], s[52:53], 1
    v_cndmask_b32_dpp v86, v86, v86, vcc wave_shr:1 row_mask:0xf bank_mask:0xf
    v_cndmask_b32_dpp v87, v87, v87, vcc wave_shr:1 row_mask:0xf bank_mask:0xf
    s_andn2_b64 s[82:83], s[82:83], s[52:53]
    v_cndmask_b32_dpp v7, v7, v7, vcc wave_shr:1 row_mask:0xf bank_mask:0xf
    s_mov_b64 exec, s[54:55]
    s_cbranch_scc0 L2_d51
    s_mov_b64 exec, s[82:83]
    s_nop 1
    v_mfma_f32_4x4x4_16b_bf16 v[88:91], v[12:13], v[84:85], 0
    s_nop 1
    v_mfma_f32_4x4x4_16b_bf16 v[88:91], v[10:11], v[86:87], v[88:91]
    s_nop 4
    v_cvt_pk_bf16_f32 v88, v88, v89
    v_cvt_pk_bf16_f32 v89, v90, v91
    ds_pk_add_bf16 v7, v88 offset:65408
    ds_pk_add_bf16 v7, v89 offset:65412
    s_mov_b64 exec, s[54:55]
    s_branch L2_d51
L2_c52:
    s_lshl_b64 s[52:53], s[82:83], 1
    s_andn2_b64 s[52:53], s[52:53], s[80:81]
    s_andn2_b64 s[52:53], s[52:53], s[50:51]
    s_or_b64 s[80:81], s[80:81], s[52:53]
    s_not_b64 vcc, s[52:53]
    s_mov_b64 exec, -1
    v_cndmask_b32_dpp v84, v84, v84, vcc wave_shr:1 row_mask:0xf bank_mask:0xf
    v_cndmask_b32_dpp v85, v85, v85, vcc wave_shr:1 row_mask:0xf bank_mask:0xf
    s_lshr_b64 s[52:53], s[52:53], 1
    v_cndmask_b32_dpp v86, v86, v86, vcc wave_shr:1 row_mask:0xf bank_mask:0xf
    v_cndmask_b32_dpp v87, v87, v87, vcc wave_shr:1 row_mask:0xf bank_mask:0xf
    s_andn2_b64 s[82:83], s[82:83], s[52:53]
    v_cndmask_b32_dpp v7, v7, v7, vcc wave_shr:1 row_mask:0xf bank_mask:0xf
    s_mov_b64 exec, s[50:51]
    s_cbranch_scc0 L2_d52
    s_mov_b64 exec, s[82:83]
    s_nop 1
    v_mfma_f32_4x4x4_16b_bf16 v[88:91], v[12:13], v[84:85], 0
    s_nop 1
    v_mfma_f32_4x4x4_16b_bf16 v[88:91], v[10:11], v[86:87], v[88:91]
    s_nop 4
    v_cvt_pk_bf16_f32 v88, v88, v89
    v_cvt_pk_bf16_f32 v89, v90, v91
    ds_pk_add_bf16 v7, v88 offset:65408
    ds_pk_add_bf16 v7, v89 offset:65412
    s_mov_b64 exec, s[50:51]
    s_branch L2_d52
L2_c53:
    s_lshl_b64 s[52:53], s[82:83], 1
    s_andn2_b64 s[52:53], s[52:53], s[80:81]
    s_andn2_b64 s[52:53], s[52:53], s[54:55]
    s_or_b64 s[80:81], s[80:81], s[52:53]
    s_not_b64 vcc, s[52:53]
    s_mov_b64 exec, -1
    v_cndmask_b32_dpp v84, v84, v84, vcc wave_shr:1 row_mask:0xf bank_mask:0xf
    v_cndmask_b32_dpp v85, v85, v85, vcc wave_shr:1 row_mask:0xf bank_mask:0xf
    s_lshr_b64 s[52:53], s[52:53], 1
    v_cndmask_b32_dpp v86, v86, v86, vcc wave_shr:1 row_mask:0xf bank_mask:0xf
    v_cndmask_b32_dpp v87, v87, v87, vcc wave_shr:1 row_mask:0xf bank_mask:0xf
    s_andn2_b64 s[82:83], s[82:83], s[52:53]
    v_cndmask_b32_dpp v7, v7, v7, vcc wave_shr:1 row_mask:0xf bank_mask:0xf
    s_mov_b64 exec, s[54:55]
    s_cbranch_scc0 L2_d53
    s_mov_b64 exec, s[82:83]
    s_nop 1
    v_mfma_f32_4x4x4_16b_bf16 v[88:91], v[12:13], v[84:85], 0
    s_nop 1
    v_mfma_f32_4x4x4_16b_bf16 v[88:91], v[10:11], v[86:87], v[88:91]
    s_nop 4
    v_cvt_pk_bf16_f32 v88, v88, v89
    v_cvt_pk_bf16_f32 v89, v90, v91
    ds_pk_add_bf16 v7, v88 offset:65408
    ds_pk_add_bf16 v7, v89 offset:65412
    s_mov_b64 exec, s[54:55]
    s_branch L2_d53
L2_c54:
    s_lshl_b64 s[52:53], s[82:83], 1
    s_andn2_b64 s[52:53], s[52:53], s[80:81]
    s_andn2_b64 s[52:53], s[52:53], s[50:51]
    s_or_b64 s[80:81], s[80:81], s[52:53]
    s_not_b64 vcc, s[52:53]
    s_mov_b64 exec, -1
    v_cndmask_b32_dpp v84, v84, v84, vcc wave_shr:1 row_mask:0xf bank_mask:0xf
    v_cndmask_b32_dpp v85, v85, v85, vcc wave_shr:1 row_mask:0xf bank_mask:0xf
    s_lshr_b64 s[52:53], s[52:53], 1
    v_cndmask_b32_dpp v86, v86, v86, vcc wave_shr:1 row_mask:0xf bank_mask:0xf
    v_cndmask_b32_dpp v87, v87, v87, vcc wave_shr:1 row_mask:0xf bank_mask:0xf
    s_andn2_b64 s[82:83], s[82:83], s[52:53]
    v_cndmask_b32_dpp v7, v7, v7, vcc wave_shr:1 row_mask:0xf bank_mask:0xf
    s_mov_b64 exec, s[50:51]
    s_cbranch_scc0 L2_d54
    s_mov_b64 exec, s[82:83]
    s_nop 1
    v_mfma_f32_4x4x4_16b_bf16 v[88:91], v[12:13], v[84:85], 0
    s_nop 1
    v_mfma_f32_4x4x4_16b_bf16 v[88:91], v[10:11], v[86:87], v[88:91]
    s_nop 4
    v_cvt_pk_bf16_f32 v88, v88, v89
    v_cvt_pk_bf16_f32 v89, v90, v91
    ds_pk_add_bf16 v7, v88 offset:65408
    ds_pk_add_bf16 v7, v89 offset:65412
    s_mov_b64 exec, s[50:51]
    s_branch L2_d54
L2_c55:
    s_lshl_b64 s[52:53], s[82:83], 1
    s_andn2_b64 s[52:53], s[52:53], s[80:81]
    s_andn2_b64 s[52:53], s[52:53], s[54:55]
    s_or_b64 s[80:81], s[80:81], s[52:53]
    s_not_b64 vcc, s[52:53]
    s_mov_b64 exec, -1
    v_cndmask_b32_dpp v84, v84, v84, vcc wave_shr:1 row_mask:0xf bank_mask:0xf
    v_cndmask_b32_dpp v85, v85, v85, vcc wave_shr:1 row_mask:0xf bank_mask:0xf
    s_lshr_b64 s[52:53], s[52:53], 1
    v_cndmask_b32_dpp v86, v86, v86, vcc wave_shr:1 row_mask:0xf bank_mask:0xf
    v_cndmask_b32_dpp v87, v87, v87, vcc wave_shr:1 row_mask:0xf bank_mask:0xf
    s_andn2_b64 s[82:83], s[82:83], s[52:53]
    v_cndmask_b32_dpp v7, v7, v7, vcc wave_shr:1 row_mask:0xf bank_mask:0xf
    s_mov_b64 exec, s[54:55]
    s_cbranch_scc0 L2_d55
    s_mov_b64 exec, s[82:83]
    s_nop 1
    v_mfma_f32_4x4x4_16b_bf16 v[88:91], v[12:13], v[84:85], 0
    s_nop 1
    v_mfma_f32_4x4x4_16b_bf16 v[88:91], v[10:11], v[86:87], v[88:91]
    s_nop 4
    v_cvt_pk_bf16_f32 v88, v88, v89
    v_cvt_pk_bf16_f32 v89, v90, v91
    ds_pk_add_bf16 v7, v88 offset:65408
    ds_pk_add_bf16 v7, v89 offset:65412
    s_mov_b64 exec, s[54:55]
    s_branch L2_d55
L2_c56:
    s_lshl_b64 s[52:53], s[82:83], 1
    s_andn2_b64 s[52:53], s[52:53], s[80:81]
    s_andn2_b64 s[52:53], s[52:53], s[50:51]
    s_or_b64 s[80:81], s[80:81], s[52:53]
    s_not_b64 vcc, s[52:53]
    s_mov_b64 exec, -1
    v_cndmask_b32_dpp v84, v84, v84, vcc wave_shr:1 row_mask:0xf bank_mask:0xf
    v_cndmask_b32_dpp v85, v85, v85, vcc wave_shr:1 row_mask:0xf bank_mask:0xf
    s_lshr_b64 s[52:53], s[52:53], 1
    v_cndmask_b32_dpp v86, v86, v86, vcc wave_shr:1 row_mask:0xf bank_mask:0xf
    v_cndmask_b32_dpp v87, v87, v87, vcc wave_shr:1 row_mask:0xf bank_mask:0xf
    s_andn2_b64 s[82:83], s[82:83], s[52:53]
    v_cndmask_b32_dpp v7, v7, v7, vcc wave_shr:1 row_mask:0xf bank_mask:0xf
    s_mov_b64 exec, s[50:51]
    s_cbranch_scc0 L2_d56
    s_mov_b64 exec, s[82:83]
    s_nop 1
    v_mfma_f32_4x4x4_16b_bf16 v[88:91], v[12:13], v[84:85], 0
    s_nop 1
    v_mfma_f32_4x4x4_16b_bf16 v[88:91], v[10:11], v[86:87], v[88:91]
    s_nop 4
    v_cvt_pk_bf16_f32 v88, v88, v89
    v_cvt_pk_bf16_f32 v89, v90, v91
    ds_pk_add_bf16 v7, v88 offset:65408
    ds_pk_add_bf16 v7, v89 offset:65412
    s_mov_b64 exec, s[50:51]
    s_branch L2_d56
L2_c57:
    s_lshl_b64 s[52:53], s[82:83], 1
    s_andn2_b64 s[52:53], s[52:53], s[80:81]
    s_andn2_b64 s[52:53], s[52:53], s[54:55]
    s_or_b64 s[80:81], s[80:81], s[52:53]
    s_not_b64 vcc, s[52:53]
    s_mov_b64 exec, -1
    v_cndmask_b32_dpp v84, v84, v84, vcc wave_shr:1 row_mask:0xf bank_mask:0xf
    v_cndmask_b32_dpp v85, v85, v85, vcc wave_shr:1 row_mask:0xf bank_mask:0xf
    s_lshr_b64 s[52:53], s[52:53], 1
    v_cndmask_b32_dpp v86, v86, v86, vcc wave_shr:1 row_mask:0xf bank_mask:0xf
    v_cndmask_b32_dpp v87, v87, v87, vcc wave_shr:1 row_mask:0xf bank_mask:0xf
    s_andn2_b64 s[82:83], s[82:83], s[52:53]
    v_cndmask_b32_dpp v7, v7, v7, vcc wave_shr:1 row_mask:0xf bank_mask:0xf
    s_mov_b64 exec, s[54:55]
    s_cbranch_scc0 L2_d57
    s_mov_b64 exec, s[82:83]
    s_nop 1
    v_mfma_f32_4x4x4_16b_bf16 v[88:91], v[12:13], v[84:85], 0
    s_nop 1
    v_mfma_f32_4x4x4_16b_bf16 v[88:91], v[10:11], v[86:87], v[88:91]
    s_nop 4
    v_cvt_pk_bf16_f32 v88, v88, v89
    v_cvt_pk_bf16_f32 v89, v90, v91
    ds_pk_add_bf16 v7, v88 offset:65408
    ds_pk_add_bf16 v7, v89 offset:65412
    s_mov_b64 exec, s[54:55]
    s_branch L2_d57
L2_c58:
    s_lshl_b64 s[52:53], s[82:83], 1
    s_andn2_b64 s[52:53], s[52:53], s[80:81]
    s_andn2_b64 s[52:53], s[52:53], s[50:51]
    s_or_b64 s[80:81], s[80:81], s[52:53]
    s_not_b64 vcc, s[52:53]
    s_mov_b64 exec, -1
    v_cndmask_b32_dpp v84, v84, v84, vcc wave_shr:1 row_mask:0xf bank_mask:0xf
    v_cndmask_b32_dpp v85, v85, v85, vcc wave_shr:1 row_mask:0xf bank_mask:0xf
    s_lshr_b64 s[52:53], s[52:53], 1
    v_cndmask_b32_dpp v86, v86, v86, vcc wave_shr:1 row_mask:0xf bank_mask:0xf
    v_cndmask_b32_dpp v87, v87, v87, vcc wave_shr:1 row_mask:0xf bank_mask:0xf
    s_andn2_b64 s[82:83], s[82:83], s[52:53]
    v_cndmask_b32_dpp v7, v7, v7, vcc wave_shr:1 row_mask:0xf bank_mask:0xf
    s_mov_b64 exec, s[50:51]
    s_cbranch_scc0 L2_d58
    s_mov_b64 exec, s[82:83]
    s_nop 1
    v_mfma_f32_4x4x4_16b_bf16 v[88:91], v[12:13], v[84:85], 0
    s_nop 1
    v_mfma_f32_4x4x4_16b_bf16 v[88:91], v[10:11], v[86:87], v[88:91]
    s_nop 4
    v_cvt_pk_bf16_f32 v88, v88, v89
    v_cvt_pk_bf16_f32 v89, v90, v91
    ds_pk_add_bf16 v7, v88 offset:65408
    ds_pk_add_bf16 v7, v89 offset:65412
    s_mov_b64 exec, s[50:51]
    s_branch L2_d58
L2_c59:
    s_lshl_b64 s[52:53], s[82:83], 1
    s_andn2_b64 s[52:53], s[52:53], s[80:81]
    s_andn2_b64 s[52:53], s[52:53], s[54:55]
    s_or_b64 s[80:81], s[80:81], s[52:53]
    s_not_b64 vcc, s[52:53]
    s_mov_b64 exec, -1
    v_cndmask_b32_dpp v84, v84, v84, vcc wave_shr:1 row_mask:0xf bank_mask:0xf
    v_cndmask_b32_dpp v85, v85, v85, vcc wave_shr:1 row_mask:0xf bank_mask:0xf
    s_lshr_b64 s[52:53], s[52:53], 1
    v_cndmask_b32_dpp v86, v86, v86, vcc wave_shr:1 row_mask:0xf bank_mask:0xf
    v_cndmask_b32_dpp v87, v87, v87, vcc wave_shr:1 row_mask:0xf bank_mask:0xf
    s_andn2_b64 s[82:83], s[82:83], s[52:53]
    v_cndmask_b32_dpp v7, v7, v7, vcc wave_shr:1 row_mask:0xf bank_mask:0xf
    s_mov_b64 exec, s[54:55]
    s_cbranch_scc0 L2_d59
    s_mov_b64 exec, s[82:83]
    s_nop 1
    v_mfma_f32_4x4x4_16b_bf16 v[88:91], v[12:13], v[84:85], 0
    s_nop 1
    v_mfma_f32_4x4x4_16b_bf16 v[88:91], v[10:11], v[86:87], v[88:91]
    s_nop 4
    v_cvt_pk_bf16_f32 v88, v88, v89
    v_cvt_pk_bf16_f32 v89, v90, v91
    ds_pk_add_bf16 v7, v88 offset:65408
    ds_pk_add_bf16 v7, v89 offset:65412
    s_mov_b64 exec, s[54:55]
    s_branch L2_d59
L2_c60:
    s_lshl_b64 s[52:53], s[82:83], 1
    s_andn2_b64 s[52:53], s[52:53], s[80:81]
    s_andn2_b64 s[52:53], s[52:53], s[50:51]
    s_or_b64 s[80:81], s[80:81], s[52:53]
    s_not_b64 vcc, s[52:53]
    s_mov_b64 exec, -1
    v_cndmask_b32_dpp v84, v84, v84, vcc wave_shr:1 row_mask:0xf bank_mask:0xf
    v_cndmask_b32_dpp v85, v85, v85, vcc wave_shr:1 row_mask:0xf bank_mask:0xf
    s_lshr_b64 s[52:53], s[52:53], 1
    v_cndmask_b32_dpp v86, v86, v86, vcc wave_shr:1 row_mask:0xf bank_mask:0xf
    v_cndmask_b32_dpp v87, v87, v87, vcc wave_shr:1 row_mask:0xf bank_mask:0xf
    s_andn2_b64 s[82:83], s[82:83], s[52:53]
    v_cndmask_b32_dpp v7, v7, v7, vcc wave_shr:1 row_mask:0xf bank_mask:0xf
    s_mov_b64 exec, s[50:51]
    s_cbranch_scc0 L2_d60
    s_mov_b64 exec, s[82:83]
    s_nop 1
    v_mfma_f32_4x4x4_16b_bf16 v[88:91], v[12:13], v[84:85], 0
    s_nop 1
    v_mfma_f32_4x4x4_16b_bf16 v[88:91], v[10:11], v[86:87], v[88:91]
    s_nop 4
    v_cvt_pk_bf16_f32 v88, v88, v89
    v_cvt_pk_bf16_f32 v89, v90, v91
    ds_pk_add_bf16 v7, v88 offset:65408
    ds_pk_add_bf16 v7, v89 offset:65412
    s_mov_b64 exec, s[50:51]
    s_branch L2_d60
L2_xa61:
    s_cmp_eq_u32 s101, 1
    s_cbranch_scc1 L2_xc61
    v_lshlrev_b32 v89, 0, v96
    v_add_u32 v90, 140, v97
    v_bitop3_b32 v90, v89, v45, v90 bitop3:0x6a
    ds_write_b32 v98, v90 offset:28
    v_lshlrev_b32 v89, 4, v96
    v_add_u32 v90, 120, v97
    v_bitop3_b32 v90, v89, v45, v90 bitop3:0x6a
    ds_write_b32 v98, v90 offset:24
    v_lshlrev_b32 v89, 8, v96
    v_add_u32 v90, 100, v97
    v_bitop3_b32 v90, v89, v45, v90 bitop3:0x6a
    ds_write_b32 v98, v90 offset:20
L2_xc61:
    v_lshlrev_b32 v89, 12, v96
    v_add_u32 v90, 80, v97
    v_bitop3_b32 v90, v89, v45, v90 bitop3:0x6a
    ds_write_b32 v98, v90 offset:16
    s_branch L2_xb61
L2_xe61:
    v_cmp_lt_u32 vcc, 32, v99
    v_cmp_lt_u32 s[58:59], 31, v88
    v_lshrrev_b32 v89, 16, v96
    v_add_u32 v97, 80, v97
    s_or_b64 vcc, vcc, s[58:59]
    s_cbranch_scc1 L2_xs61
    v_lshlrev_b32 v89, v1, v89
    v_and_b32 v89, v45, v89
    v_cmp_ne_u32 vcc, 0, v89
    v_xor_b32 v90, v97, v89
    s_add_u32 s3, s37, s38
    v_mbcnt_lo_u32_b32 v98, vcc_lo, 0
    v_mbcnt_hi_u32_b32 v98, vcc_hi, v98
    s_bcnt1_i32_b64 s41, vcc
    v_lshl_add_u32 v98, v98, 2, s3
    s_mov_b64 exec, vcc
    ds_write_b32 v98, v90
    s_mov_b64 exec, -1
    s_lshl2_add_u32 s37, s41, s37
    s_branch L2_xr61
L2_xf61:
    s_waitcnt lgkmcnt(0)
    s_cmp_gt_u32 s37, 1024
    s_cbranch_scc1 L2_xs61
    v_mov_b32 v43, -1
    s_cmp_ge_u32 s37, 512
    s_cbranch_scc1 L2_xg61
    v_mov_b32 v42, -1
    s_cmp_ge_u32 s37, 256
    s_cbranch_scc1 L2_xg61
    v_mov_b32 v41, -1
    s_branch L2_xg61
L2_xs61:
    s_waitcnt lgkmcnt(0)
    v_mov_b32 v40, -1
    v_mov_b32 v41, -1
    v_mov_b32 v42, -1
    v_mov_b32 v43, -1
    s_add_u32 s3, s42, 2
    s_bitset1_b32 s36, s3
    s_branch L2_xg61
L2_c62:
    s_lshl_b64 s[52:53], s[82:83], 1
    s_andn2_b64 s[52:53], s[52:53], s[80:81]
    s_andn2_b64 s[52:53], s[52:53], s[54:55]
    s_or_b64 s[80:81], s[80:81], s[52:53]
    s_not_b64 vcc, s[52:53]
    s_mov_b64 exec, -1
    v_cndmask_b32_dpp v84, v84, v84, vcc wave_shr:1 row_mask:0xf bank_mask:0xf
    v_cndmask_b32_dpp v85, v85, v85, vcc wave_shr:1 row_mask:0xf bank_mask:0xf
    s_lshr_b64 s[52:53], s[52:53], 1
    v_cndmask_b32_dpp v86, v86, v86, vcc wave_shr:1 row_mask:0xf bank_mask:0xf
    v_cndmask_b32_dpp v87, v87, v87, vcc wave_shr:1 row_mask:0xf bank_mask:0xf
    s_andn2_b64 s[82:83], s[82:83], s[52:53]
    v_cndmask_b32_dpp v7, v7, v7, vcc wave_shr:1 row_mask:0xf bank_mask:0xf
    s_mov_b64 exec, s[54:55]
    s_cbranch_scc0 L2_d62
    s_mov_b64 exec, s[82:83]
    s_nop 1
    v_mfma_f32_4x4x4_16b_bf16 v[88:91], v[12:13], v[84:85], 0
    s_nop 1
    v_mfma_f32_4x4x4_16b_bf16 v[88:91], v[10:11], v[86:87], v[88:91]
    s_nop 4
    v_cvt_pk_bf16_f32 v88, v88, v89
    v_cvt_pk_bf16_f32 v89, v90, v91
    ds_pk_add_bf16 v7, v88 offset:65408
    ds_pk_add_bf16 v7, v89 offset:65412
    s_mov_b64 exec, s[54:55]
    s_branch L2_d62
L2_c63:
    s_lshl_b64 s[52:53], s[82:83], 1
    s_andn2_b64 s[52:53], s[52:53], s[80:81]
    s_andn2_b64 s[52:53], s[52:53], s[50:51]
    s_or_b64 s[80:81], s[80:81], s[52:53]
    s_not_b64 vcc, s[52:53]
    s_mov_b64 exec, -1
    v_cndmask_b32_dpp v84, v84, v84, vcc wave_shr:1 row_mask:0xf bank_mask:0xf
    v_cndmask_b32_dpp v85, v85, v85, vcc wave_shr:1 row_mask:0xf bank_mask:0xf
    s_lshr_b64 s[52:53], s[52:53], 1
    v_cndmask_b32_dpp v86, v86, v86, vcc wave_shr:1 row_mask:0xf bank_mask:0xf
    v_cndmask_b32_dpp v87, v87, v87, vcc wave_shr:1 row_mask:0xf bank_mask:0xf
    s_andn2_b64 s[82:83], s[82:83], s[52:53]
    v_cndmask_b32_dpp v7, v7, v7, vcc wave_shr:1 row_mask:0xf bank_mask:0xf
    s_mov_b64 exec, s[50:51]
    s_cbranch_scc0 L2_d63
    s_mov_b64 exec, s[82:83]
    s_nop 1
    v_mfma_f32_4x4x4_16b_bf16 v[88:91], v[12:13], v[84:85], 0
    s_nop 1
    v_mfma_f32_4x4x4_16b_bf16 v[88:91], v[10:11], v[86:87], v[88:91]
    s_nop 4
    v_cvt_pk_bf16_f32 v88, v88, v89
    v_cvt_pk_bf16_f32 v89, v90, v91
    ds_pk_add_bf16 v7, v88 offset:65408
    ds_pk_add_bf16 v7, v89 offset:65412
    s_mov_b64 exec, s[50:51]
    s_branch L2_d63
L2_c64:
    s_lshl_b64 s[52:53], s[82:83], 1
    s_andn2_b64 s[52:53], s[52:53], s[80:81]
    s_andn2_b64 s[52:53], s[52:53], s[54:55]
    s_or_b64 s[80:81], s[80:81], s[52:53]
    s_not_b64 vcc, s[52:53]
    s_mov_b64 exec, -1
    v_cndmask_b32_dpp v84, v84, v84, vcc wave_shr:1 row_mask:0xf bank_mask:0xf
    v_cndmask_b32_dpp v85, v85, v85, vcc wave_shr:1 row_mask:0xf bank_mask:0xf
    s_lshr_b64 s[52:53], s[52:53], 1
    v_cndmask_b32_dpp v86, v86, v86, vcc wave_shr:1 row_mask:0xf bank_mask:0xf
    v_cndmask_b32_dpp v87, v87, v87, vcc wave_shr:1 row_mask:0xf bank_mask:0xf
    s_andn2_b64 s[82:83], s[82:83], s[52:53]
    v_cndmask_b32_dpp v7, v7, v7, vcc wave_shr:1 row_mask:0xf bank_mask:0xf
    s_mov_b64 exec, s[54:55]
    s_cbranch_scc0 L2_d64
    s_mov_b64 exec, s[82:83]
    s_nop 1
    v_mfma_f32_4x4x4_16b_bf16 v[88:91], v[12:13], v[84:85], 0
    s_nop 1
    v_mfma_f32_4x4x4_16b_bf16 v[88:91], v[10:11], v[86:87], v[88:91]
    s_nop 4
    v_cvt_pk_bf16_f32 v88, v88, v89
    v_cvt_pk_bf16_f32 v89, v90, v91
    ds_pk_add_bf16 v7, v88 offset:65408
    ds_pk_add_bf16 v7, v89 offset:65412
    s_mov_b64 exec, s[54:55]
    s_branch L2_d64
L2_c65:
    s_lshl_b64 s[52:53], s[82:83], 1
    s_andn2_b64 s[52:53], s[52:53], s[80:81]
    s_andn2_b64 s[52:53], s[52:53], s[50:51]
    s_or_b64 s[80:81], s[80:81], s[52:53]
    s_not_b64 vcc, s[52:53]
    s_mov_b64 exec, -1
    v_cndmask_b32_dpp v84, v84, v84, vcc wave_shr:1 row_mask:0xf bank_mask:0xf
    v_cndmask_b32_dpp v85, v85, v85, vcc wave_shr:1 row_mask:0xf bank_mask:0xf
    s_lshr_b64 s[52:53], s[52:53], 1
    v_cndmask_b32_dpp v86, v86, v86, vcc wave_shr:1 row_mask:0xf bank_mask:0xf
    v_cndmask_b32_dpp v87, v87, v87, vcc wave_shr:1 row_mask:0xf bank_mask:0xf
    s_andn2_b64 s[82:83], s[82:83], s[52:53]
    v_cndmask_b32_dpp v7, v7, v7, vcc wave_shr:1 row_mask:0xf bank_mask:0xf
    s_mov_b64 exec, s[50:51]
    s_cbranch_scc0 L2_d65
    s_mov_b64 exec, s[82:83]
    s_nop 1
    v_mfma_f32_4x4x4_16b_bf16 v[88:91], v[12:13], v[84:85], 0
    s_nop 1
    v_mfma_f32_4x4x4_16b_bf16 v[88:91], v[10:11], v[86:87], v[88:91]
    s_nop 4
    v_cvt_pk_bf16_f32 v88, v88, v89
    v_cvt_pk_bf16_f32 v89, v90, v91
    ds_pk_add_bf16 v7, v88 offset:65408
    ds_pk_add_bf16 v7, v89 offset:65412
    s_mov_b64 exec, s[50:51]
    s_branch L2_d65
L2_c66:
    s_lshl_b64 s[52:53], s[82:83], 1
    s_andn2_b64 s[52:53], s[52:53], s[80:81]
    s_andn2_b64 s[52:53], s[52:53], s[54:55]
    s_or_b64 s[80:81], s[80:81], s[52:53]
    s_not_b64 vcc, s[52:53]
    s_mov_b64 exec, -1
    v_cndmask_b32_dpp v84, v84, v84, vcc wave_shr:1 row_mask:0xf bank_mask:0xf
    v_cndmask_b32_dpp v85, v85, v85, vcc wave_shr:1 row_mask:0xf bank_mask:0xf
    s_lshr_b64 s[52:53], s[52:53], 1
    v_cndmask_b32_dpp v86, v86, v86, vcc wave_shr:1 row_mask:0xf bank_mask:0xf
    v_cndmask_b32_dpp v87, v87, v87, vcc wave_shr:1 row_mask:0xf bank_mask:0xf
    s_andn2_b64 s[82:83], s[82:83], s[52:53]
    v_cndmask_b32_dpp v7, v7, v7, vcc wave_shr:1 row_mask:0xf bank_mask:0xf
    s_mov_b64 exec, s[54:55]
    s_cbranch_scc0 L2_d66
    s_mov_b64 exec, s[82:83]
    s_nop 1
    v_mfma_f32_4x4x4_16b_bf16 v[88:91], v[12:13], v[84:85], 0
    s_nop 1
    v_mfma_f32_4x4x4_16b_bf16 v[88:91], v[10:11], v[86:87], v[88:91]
    s_nop 4
    v_cvt_pk_bf16_f32 v88, v88, v89
    v_cvt_pk_bf16_f32 v89, v90, v91
    ds_pk_add_bf16 v7, v88 offset:65408
    ds_pk_add_bf16 v7, v89 offset:65412
    s_mov_b64 exec, s[54:55]
    s_branch L2_d66
L2_c67:
    s_lshl_b64 s[52:53], s[82:83], 1
    s_andn2_b64 s[52:53], s[52:53], s[80:81]
    s_andn2_b64 s[52:53], s[52:53], s[50:51]
    s_or_b64 s[80:81], s[80:81], s[52:53]
    s_not_b64 vcc, s[52:53]
    s_mov_b64 exec, -1
    v_cndmask_b32_dpp v84, v84, v84, vcc wave_shr:1 row_mask:0xf bank_mask:0xf
    v_cndmask_b32_dpp v85, v85, v85, vcc wave_shr:1 row_mask:0xf bank_mask:0xf
    s_lshr_b64 s[52:53], s[52:53], 1
    v_cndmask_b32_dpp v86, v86, v86, vcc wave_shr:1 row_mask:0xf bank_mask:0xf
    v_cndmask_b32_dpp v87, v87, v87, vcc wave_shr:1 row_mask:0xf bank_mask:0xf
    s_andn2_b64 s[82:83], s[82:83], s[52:53]
    v_cndmask_b32_dpp v7, v7, v7, vcc wave_shr:1 row_mask:0xf bank_mask:0xf
    s_mov_b64 exec, s[50:51]
    s_cbranch_scc0 L2_d67
    s_mov_b64 exec, s[82:83]
    s_nop 1
    v_mfma_f32_4x4x4_16b_bf16 v[88:91], v[12:13], v[84:85], 0
    s_nop 1
    v_mfma_f32_4x4x4_16b_bf16 v[88:91], v[10:11], v[86:87], v[88:91]
    s_nop 4
    v_cvt_pk_bf16_f32 v88, v88, v89
    v_cvt_pk_bf16_f32 v89, v90, v91
    ds_pk_add_bf16 v7, v88 offset:65408
    ds_pk_add_bf16 v7, v89 offset:65412
    s_mov_b64 exec, s[50:51]
    s_branch L2_d67
L2_xo68:
    v_cmp_lt_u32 vcc, 20, v99
    s_mov_b32 s101, 1
    s_cbranch_vccz L2_xp68
    v_cmp_lt_u32 vcc, 32, v99
    v_cmp_lt_u32 s[58:59], 31, v88
    s_mov_b32 s101, 2
    s_or_b64 vcc, vcc, s[58:59]
    s_cbranch_scc0 L2_xp68
    s_mov_b32 s37, 0x10000
    s_branch L2_xp68
L2_c69:
    s_lshl_b64 s[52:53], s[82:83], 1
    s_andn2_b64 s[52:53], s[52:53], s[80:81]
    s_andn2_b64 s[52:53], s[52:53], s[54:55]
    s_or_b64 s[80:81], s[80:81], s[52:53]
    s_not_b64 vcc, s[52:53]
    s_mov_b64 exec, -1
    v_cndmask_b32_dpp v84, v84, v84, vcc wave_shr:1 row_mask:0xf bank_mask:0xf
    v_cndmask_b32_dpp v85, v85, v85, vcc wave_shr:1 row_mask:0xf bank_mask:0xf
    s_lshr_b64 s[52:53], s[52:53], 1
    v_cndmask_b32_dpp v86, v86, v86, vcc wave_shr:1 row_mask:0xf bank_mask:0xf
    v_cndmask_b32_dpp v87, v87, v87, vcc wave_shr:1 row_mask:0xf bank_mask:0xf
    s_andn2_b64 s[82:83], s[82:83], s[52:53]
    v_cndmask_b32_dpp v7, v7, v7, vcc wave_shr:1 row_mask:0xf bank_mask:0xf
    s_mov_b64 exec, s[54:55]
    s_cbranch_scc0 L2_d69
    s_mov_b64 exec, s[82:83]
    s_nop 1
    v_mfma_f32_4x4x4_16b_bf16 v[88:91], v[12:13], v[84:85], 0
    s_nop 1
    v_mfma_f32_4x4x4_16b_bf16 v[88:91], v[10:11], v[86:87], v[88:91]
    s_nop 4
    v_cvt_pk_bf16_f32 v88, v88, v89
    v_cvt_pk_bf16_f32 v89, v90, v91
    ds_pk_add_bf16 v7, v88 offset:65408
    ds_pk_add_bf16 v7, v89 offset:65412
    s_mov_b64 exec, s[54:55]
    s_branch L2_d69
L2_c70:
    s_lshl_b64 s[52:53], s[82:83], 1
    s_andn2_b64 s[52:53], s[52:53], s[80:81]
    s_andn2_b64 s[52:53], s[52:53], s[50:51]
    s_or_b64 s[80:81], s[80:81], s[52:53]
    s_not_b64 vcc, s[52:53]
    s_mov_b64 exec, -1
    v_cndmask_b32_dpp v84, v84, v84, vcc wave_shr:1 row_mask:0xf bank_mask:0xf
    v_cndmask_b32_dpp v85, v85, v85, vcc wave_shr:1 row_mask:0xf bank_mask:0xf
    s_lshr_b64 s[52:53], s[52:53], 1
    v_cndmask_b32_dpp v86, v86, v86, vcc wave_shr:1 row_mask:0xf bank_mask:0xf
    v_cndmask_b32_dpp v87, v87, v87, vcc wave_shr:1 row_mask:0xf bank_mask:0xf
    s_andn2_b64 s[82:83], s[82:83], s[52:53]
    v_cndmask_b32_dpp v7, v7, v7, vcc wave_shr:1 row_mask:0xf bank_mask:0xf
    s_mov_b64 exec, s[50:51]
    s_cbranch_scc0 L2_d70
    s_mov_b64 exec, s[82:83]
    s_nop 1
    v_mfma_f32_4x4x4_16b_bf16 v[88:91], v[12:13], v[84:85], 0
    s_nop 1
    v_mfma_f32_4x4x4_16b_bf16 v[88:91], v[10:11], v[86:87], v[88:91]
    s_nop 4
    v_cvt_pk_bf16_f32 v88, v88, v89
    v_cvt_pk_bf16_f32 v89, v90, v91
    ds_pk_add_bf16 v7, v88 offset:65408
    ds_pk_add_bf16 v7, v89 offset:65412
    s_mov_b64 exec, s[50:51]
    s_branch L2_d70
L2_c71:
    s_lshl_b64 s[52:53], s[82:83], 1
    s_andn2_b64 s[52:53], s[52:53], s[80:81]
    s_andn2_b64 s[52:53], s[52:53], s[54:55]
    s_or_b64 s[80:81], s[80:81], s[52:53]
    s_not_b64 vcc, s[52:53]
    s_mov_b64 exec, -1
    v_cndmask_b32_dpp v84, v84, v84, vcc wave_shr:1 row_mask:0xf bank_mask:0xf
    v_cndmask_b32_dpp v85, v85, v85, vcc wave_shr:1 row_mask:0xf bank_mask:0xf
    s_lshr_b64 s[52:53], s[52:53], 1
    v_cndmask_b32_dpp v86, v86, v86, vcc wave_shr:1 row_mask:0xf bank_mask:0xf
    v_cndmask_b32_dpp v87, v87, v87, vcc wave_shr:1 row_mask:0xf bank_mask:0xf
    s_andn2_b64 s[82:83], s[82:83], s[52:53]
    v_cndmask_b32_dpp v7, v7, v7, vcc wave_shr:1 row_mask:0xf bank_mask:0xf
    s_mov_b64 exec, s[54:55]
    s_cbranch_scc0 L2_d71
    s_mov_b64 exec, s[82:83]
    s_nop 1
    v_mfma_f32_4x4x4_16b_bf16 v[88:91], v[12:13], v[84:85], 0
    s_nop 1
    v_mfma_f32_4x4x4_16b_bf16 v[88:91], v[10:11], v[86:87], v[88:91]
    s_nop 4
    v_cvt_pk_bf16_f32 v88, v88, v89
    v_cvt_pk_bf16_f32 v89, v90, v91
    ds_pk_add_bf16 v7, v88 offset:65408
    ds_pk_add_bf16 v7, v89 offset:65412
    s_mov_b64 exec, s[54:55]
    s_branch L2_d71
L2_c72:
    s_lshl_b64 s[52:53], s[82:83], 1
    s_andn2_b64 s[52:53], s[52:53], s[80:81]
    s_andn2_b64 s[52:53], s[52:53], s[50:51]
    s_or_b64 s[80:81], s[80:81], s[52:53]
    s_not_b64 vcc, s[52:53]
    s_mov_b64 exec, -1
    v_cndmask_b32_dpp v84, v84, v84, vcc wave_shr:1 row_mask:0xf bank_mask:0xf
    v_cndmask_b32_dpp v85, v85, v85, vcc wave_shr:1 row_mask:0xf bank_mask:0xf
    s_lshr_b64 s[52:53], s[52:53], 1
    v_cndmask_b32_dpp v86, v86, v86, vcc wave_shr:1 row_mask:0xf bank_mask:0xf
    v_cndmask_b32_dpp v87, v87, v87, vcc wave_shr:1 row_mask:0xf bank_mask:0xf
    s_andn2_b64 s[82:83], s[82:83], s[52:53]
    v_cndmask_b32_dpp v7, v7, v7, vcc wave_shr:1 row_mask:0xf bank_mask:0xf
    s_mov_b64 exec, s[50:51]
    s_cbranch_scc0 L2_d72
    s_mov_b64 exec, s[82:83]
    s_nop 1
    v_mfma_f32_4x4x4_16b_bf16 v[88:91], v[12:13], v[84:85], 0
    s_nop 1
    v_mfma_f32_4x4x4_16b_bf16 v[88:91], v[10:11], v[86:87], v[88:91]
    s_nop 4
    v_cvt_pk_bf16_f32 v88, v88, v89
    v_cvt_pk_bf16_f32 v89, v90, v91
    ds_pk_add_bf16 v7, v88 offset:65408
    ds_pk_add_bf16 v7, v89 offset:65412
    s_mov_b64 exec, s[50:51]
    s_branch L2_d72
L2_c73:
    s_lshl_b64 s[52:53], s[82:83], 1
    s_andn2_b64 s[52:53], s[52:53], s[80:81]
    s_andn2_b64 s[52:53], s[52:53], s[54:55]
    s_or_b64 s[80:81], s[80:81], s[52:53]
    s_not_b64 vcc, s[52:53]
    s_mov_b64 exec, -1
    v_cndmask_b32_dpp v84, v84, v84, vcc wave_shr:1 row_mask:0xf bank_mask:0xf
    v_cndmask_b32_dpp v85, v85, v85, vcc wave_shr:1 row_mask:0xf bank_mask:0xf
    s_lshr_b64 s[52:53], s[52:53], 1
    v_cndmask_b32_dpp v86, v86, v86, vcc wave_shr:1 row_mask:0xf bank_mask:0xf
    v_cndmask_b32_dpp v87, v87, v87, vcc wave_shr:1 row_mask:0xf bank_mask:0xf
    s_andn2_b64 s[82:83], s[82:83], s[52:53]
    v_cndmask_b32_dpp v7, v7, v7, vcc wave_shr:1 row_mask:0xf bank_mask:0xf
    s_mov_b64 exec, s[54:55]
    s_cbranch_scc0 L2_d73
    s_mov_b64 exec, s[82:83]
    s_nop 1
    v_mfma_f32_4x4x4_16b_bf16 v[88:91], v[12:13], v[84:85], 0
    s_nop 1
    v_mfma_f32_4x4x4_16b_bf16 v[88:91], v[10:11], v[86:87], v[88:91]
    s_nop 4
    v_cvt_pk_bf16_f32 v88, v88, v89
    v_cvt_pk_bf16_f32 v89, v90, v91
    ds_pk_add_bf16 v7, v88 offset:65408
    ds_pk_add_bf16 v7, v89 offset:65412
    s_mov_b64 exec, s[54:55]
    s_branch L2_d73
L2_c74:
    s_lshl_b64 s[52:53], s[82:83], 1
    s_andn2_b64 s[52:53], s[52:53], s[80:81]
    s_andn2_b64 s[52:53], s[52:53], s[50:51]
    s_or_b64 s[80:81], s[80:81], s[52:53]
    s_not_b64 vcc, s[52:53]
    s_mov_b64 exec, -1
    v_cndmask_b32_dpp v84, v84, v84, vcc wave_shr:1 row_mask:0xf bank_mask:0xf
    v_cndmask_b32_dpp v85, v85, v85, vcc wave_shr:1 row_mask:0xf bank_mask:0xf
    s_lshr_b64 s[52:53], s[52:53], 1
    v_cndmask_b32_dpp v86, v86, v86, vcc wave_shr:1 row_mask:0xf bank_mask:0xf
    v_cndmask_b32_dpp v87, v87, v87, vcc wave_shr:1 row_mask:0xf bank_mask:0xf
    s_andn2_b64 s[82:83], s[82:83], s[52:53]
    v_cndmask_b32_dpp v7, v7, v7, vcc wave_shr:1 row_mask:0xf bank_mask:0xf
    s_mov_b64 exec, s[50:51]
    s_cbranch_scc0 L2_d74
    s_mov_b64 exec, s[82:83]
    s_nop 1
    v_mfma_f32_4x4x4_16b_bf16 v[88:91], v[12:13], v[84:85], 0
    s_nop 1
    v_mfma_f32_4x4x4_16b_bf16 v[88:91], v[10:11], v[86:87], v[88:91]
    s_nop 4
    v_cvt_pk_bf16_f32 v88, v88, v89
    v_cvt_pk_bf16_f32 v89, v90, v91
    ds_pk_add_bf16 v7, v88 offset:65408
    ds_pk_add_bf16 v7, v89 offset:65412
    s_mov_b64 exec, s[50:51]
    s_branch L2_d74
L2_c75:
    s_lshl_b64 s[52:53], s[82:83], 1
    s_andn2_b64 s[52:53], s[52:53], s[80:81]
    s_andn2_b64 s[52:53], s[52:53], s[54:55]
    s_or_b64 s[80:81], s[80:81], s[52:53]
    s_not_b64 vcc, s[52:53]
    s_mov_b64 exec, -1
    v_cndmask_b32_dpp v84, v84, v84, vcc wave_shr:1 row_mask:0xf bank_mask:0xf
    v_cndmask_b32_dpp v85, v85, v85, vcc wave_shr:1 row_mask:0xf bank_mask:0xf
    s_lshr_b64 s[52:53], s[52:53], 1
    v_cndmask_b32_dpp v86, v86, v86, vcc wave_shr:1 row_mask:0xf bank_mask:0xf
    v_cndmask_b32_dpp v87, v87, v87, vcc wave_shr:1 row_mask:0xf bank_mask:0xf
    s_andn2_b64 s[82:83], s[82:83], s[52:53]
    v_cndmask_b32_dpp v7, v7, v7, vcc wave_shr:1 row_mask:0xf bank_mask:0xf
    s_mov_b64 exec, s[54:55]
    s_cbranch_scc0 L2_d75
    s_mov_b64 exec, s[82:83]
    s_nop 1
    v_mfma_f32_4x4x4_16b_bf16 v[88:91], v[12:13], v[84:85], 0
    s_nop 1
    v_mfma_f32_4x4x4_16b_bf16 v[88:91], v[10:11], v[86:87], v[88:91]
    s_nop 4
    v_cvt_pk_bf16_f32 v88, v88, v89
    v_cvt_pk_bf16_f32 v89, v90, v91
    ds_pk_add_bf16 v7, v88 offset:65408
    ds_pk_add_bf16 v7, v89 offset:65412
    s_mov_b64 exec, s[54:55]
    s_branch L2_d75
L2_c76:
    s_lshl_b64 s[52:53], s[82:83], 1
    s_andn2_b64 s[52:53], s[52:53], s[80:81]
    s_andn2_b64 s[52:53], s[52:53], s[50:51]
    s_or_b64 s[80:81], s[80:81], s[52:53]
    s_not_b64 vcc, s[52:53]
    s_mov_b64 exec, -1
    v_cndmask_b32_dpp v84, v84, v84, vcc wave_shr:1 row_mask:0xf bank_mask:0xf
    v_cndmask_b32_dpp v85, v85, v85, vcc wave_shr:1 row_mask:0xf bank_mask:0xf
    s_lshr_b64 s[52:53], s[52:53], 1
    v_cndmask_b32_dpp v86, v86, v86, vcc wave_shr:1 row_mask:0xf bank_mask:0xf
    v_cndmask_b32_dpp v87, v87, v87, vcc wave_shr:1 row_mask:0xf bank_mask:0xf
    s_andn2_b64 s[82:83], s[82:83], s[52:53]
    v_cndmask_b32_dpp v7, v7, v7, vcc wave_shr:1 row_mask:0xf bank_mask:0xf
    s_mov_b64 exec, s[50:51]
    s_cbranch_scc0 L2_d76
    s_mov_b64 exec, s[82:83]
    s_nop 1
    v_mfma_f32_4x4x4_16b_bf16 v[88:91], v[12:13], v[84:85], 0
    s_nop 1
    v_mfma_f32_4x4x4_16b_bf16 v[88:91], v[10:11], v[86:87], v[88:91]
    s_nop 4
    v_cvt_pk_bf16_f32 v88, v88, v89
    v_cvt_pk_bf16_f32 v89, v90, v91
    ds_pk_add_bf16 v7, v88 offset:65408
    ds_pk_add_bf16 v7, v89 offset:65412
    s_mov_b64 exec, s[50:51]
    s_branch L2_d76
L2_c77:
    s_lshl_b64 s[52:53], s[82:83], 1
    s_andn2_b64 s[52:53], s[52:53], s[80:81]
    s_andn2_b64 s[52:53], s[52:53], s[54:55]
    s_or_b64 s[80:81], s[80:81], s[52:53]
    s_not_b64 vcc, s[52:53]
    s_mov_b64 exec, -1
    v_cndmask_b32_dpp v84, v84, v84, vcc wave_shr:1 row_mask:0xf bank_mask:0xf
    v_cndmask_b32_dpp v85, v85, v85, vcc wave_shr:1 row_mask:0xf bank_mask:0xf
    s_lshr_b64 s[52:53], s[52:53], 1
    v_cndmask_b32_dpp v86, v86, v86, vcc wave_shr:1 row_mask:0xf bank_mask:0xf
    v_cndmask_b32_dpp v87, v87, v87, vcc wave_shr:1 row_mask:0xf bank_mask:0xf
    s_andn2_b64 s[82:83], s[82:83], s[52:53]
    v_cndmask_b32_dpp v7, v7, v7, vcc wave_shr:1 row_mask:0xf bank_mask:0xf
    s_mov_b64 exec, s[54:55]
    s_cbranch_scc0 L2_d77
    s_mov_b64 exec, s[82:83]
    s_nop 1
    v_mfma_f32_4x4x4_16b_bf16 v[88:91], v[12:13], v[84:85], 0
    s_nop 1
    v_mfma_f32_4x4x4_16b_bf16 v[88:91], v[10:11], v[86:87], v[88:91]
    s_nop 4
    v_cvt_pk_bf16_f32 v88, v88, v89
    v_cvt_pk_bf16_f32 v89, v90, v91
    ds_pk_add_bf16 v7, v88 offset:65408
    ds_pk_add_bf16 v7, v89 offset:65412
    s_mov_b64 exec, s[54:55]
    s_branch L2_d77
L2_c78:
    s_lshl_b64 s[52:53], s[82:83], 1
    s_andn2_b64 s[52:53], s[52:53], s[80:81]
    s_andn2_b64 s[52:53], s[52:53], s[50:51]
    s_or_b64 s[80:81], s[80:81], s[52:53]
    s_not_b64 vcc, s[52:53]
    s_mov_b64 exec, -1
    v_cndmask_b32_dpp v84, v84, v84, vcc wave_shr:1 row_mask:0xf bank_mask:0xf
    v_cndmask_b32_dpp v85, v85, v85, vcc wave_shr:1 row_mask:0xf bank_mask:0xf
    s_lshr_b64 s[52:53], s[52:53], 1
    v_cndmask_b32_dpp v86, v86, v86, vcc wave_shr:1 row_mask:0xf bank_mask:0xf
    v_cndmask_b32_dpp v87, v87, v87, vcc wave_shr:1 row_mask:0xf bank_mask:0xf
    s_andn2_b64 s[82:83], s[82:83], s[52:53]
    v_cndmask_b32_dpp v7, v7, v7, vcc wave_shr:1 row_mask:0xf bank_mask:0xf
    s_mov_b64 exec, s[50:51]
    s_cbranch_scc0 L2_d78
    s_mov_b64 exec, s[82:83]
    s_nop 1
    v_mfma_f32_4x4x4_16b_bf16 v[88:91], v[12:13], v[84:85], 0
    s_nop 1
    v_mfma_f32_4x4x4_16b_bf16 v[88:91], v[10:11], v[86:87], v[88:91]
    s_nop 4
    v_cvt_pk_bf16_f32 v88, v88, v89
    v_cvt_pk_bf16_f32 v89, v90, v91
    ds_pk_add_bf16 v7, v88 offset:65408
    ds_pk_add_bf16 v7, v89 offset:65412
    s_mov_b64 exec, s[50:51]
    s_branch L2_d78
L2_xa79:
    s_cmp_eq_u32 s101, 1
    s_cbranch_scc1 L2_xc79
    v_lshlrev_b32 v89, 0, v96
    v_add_u32 v90, 140, v97
    v_bitop3_b32 v90, v89, v45, v90 bitop3:0x6a
    ds_write_b32 v98, v90 offset:28
    v_lshlrev_b32 v89, 4, v96
    v_add_u32 v90, 120, v97
    v_bitop3_b32 v90, v89, v45, v90 bitop3:0x6a
    ds_write_b32 v98, v90 offset:24
    v_lshlrev_b32 v89, 8, v96
    v_add_u32 v90, 100, v97
    v_bitop3_b32 v90, v89, v45, v90 bitop3:0x6a
    ds_write_b32 v98, v90 offset:20
L2_xc79:
    v_lshlrev_b32 v89, 12, v96
    v_add_u32 v90, 80, v97
    v_bitop3_b32 v90, v89, v45, v90 bitop3:0x6a
    ds_write_b32 v98, v90 offset:16
    s_branch L2_xb79
L2_xe79:
    v_cmp_lt_u32 vcc, 32, v99
    v_cmp_lt_u32 s[58:59], 31, v88
    v_lshrrev_b32 v89, 16, v96
    v_add_u32 v97, 80, v97
    s_or_b64 vcc, vcc, s[58:59]
    s_cbranch_scc1 L2_xs79
    v_lshlrev_b32 v89, v1, v89
    v_and_b32 v89, v45, v89
    v_cmp_ne_u32 vcc, 0, v89
    v_xor_b32 v90, v97, v89
    s_add_u32 s3, s37, s38
    v_mbcnt_lo_u32_b32 v98, vcc_lo, 0
    v_mbcnt_hi_u32_b32 v98, vcc_hi, v98
    s_bcnt1_i32_b64 s41, vcc
    v_lshl_add_u32 v98, v98, 2, s3
    s_mov_b64 exec, vcc
    ds_write_b32 v98, v90
    s_mov_b64 exec, -1
    s_lshl2_add_u32 s37, s41, s37
    s_branch L2_xr79
L2_xf79:
    s_waitcnt lgkmcnt(0)
    s_cmp_gt_u32 s37, 1024
    s_cbranch_scc1 L2_xs79
    v_mov_b32 v43, -1
    s_cmp_ge_u32 s37, 512
    s_cbranch_scc1 L2_xg79
    v_mov_b32 v42, -1
    s_cmp_ge_u32 s37, 256
    s_cbranch_scc1 L2_xg79
    v_mov_b32 v41, -1
    s_branch L2_xg79
L2_xs79:
    s_waitcnt lgkmcnt(0)
    v_mov_b32 v40, -1
    v_mov_b32 v41, -1
    v_mov_b32 v42, -1
    v_mov_b32 v43, -1
    s_add_u32 s3, s42, 2
    s_bitset1_b32 s36, s3
    s_branch L2_xg79
L2_c80:
    s_lshl_b64 s[52:53], s[82:83], 1
    s_andn2_b64 s[52:53], s[52:53], s[80:81]
    s_andn2_b64 s[52:53], s[52:53], s[54:55]
    s_or_b64 s[80:81], s[80:81], s[52:53]
    s_not_b64 vcc, s[52:53]
    s_mov_b64 exec, -1
    v_cndmask_b32_dpp v84, v84, v84, vcc wave_shr:1 row_mask:0xf bank_mask:0xf
    v_cndmask_b32_dpp v85, v85, v85, vcc wave_shr:1 row_mask:0xf bank_mask:0xf
    s_lshr_b64 s[52:53], s[52:53], 1
    v_cndmask_b32_dpp v86, v86, v86, vcc wave_shr:1 row_mask:0xf bank_mask:0xf
    v_cndmask_b32_dpp v87, v87, v87, vcc wave_shr:1 row_mask:0xf bank_mask:0xf
    s_andn2_b64 s[82:83], s[82:83], s[52:53]
    v_cndmask_b32_dpp v7, v7, v7, vcc wave_shr:1 row_mask:0xf bank_mask:0xf
    s_mov_b64 exec, s[54:55]
    s_cbranch_scc0 L2_d80
    s_mov_b64 exec, s[82:83]
    s_nop 1
    v_mfma_f32_4x4x4_16b_bf16 v[88:91], v[12:13], v[84:85], 0
    s_nop 1
    v_mfma_f32_4x4x4_16b_bf16 v[88:91], v[10:11], v[86:87], v[88:91]
    s_nop 4
    v_cvt_pk_bf16_f32 v88, v88, v89
    v_cvt_pk_bf16_f32 v89, v90, v91
    ds_pk_add_bf16 v7, v88 offset:65408
    ds_pk_add_bf16 v7, v89 offset:65412
    s_mov_b64 exec, s[54:55]
    s_branch L2_d80
L2_c81:
    s_lshl_b64 s[52:53], s[82:83], 1
    s_andn2_b64 s[52:53], s[52:53], s[80:81]
    s_andn2_b64 s[52:53], s[52:53], s[50:51]
    s_or_b64 s[80:81], s[80:81], s[52:53]
    s_not_b64 vcc, s[52:53]
    s_mov_b64 exec, -1
    v_cndmask_b32_dpp v84, v84, v84, vcc wave_shr:1 row_mask:0xf bank_mask:0xf
    v_cndmask_b32_dpp v85, v85, v85, vcc wave_shr:1 row_mask:0xf bank_mask:0xf
    s_lshr_b64 s[52:53], s[52:53], 1
    v_cndmask_b32_dpp v86, v86, v86, vcc wave_shr:1 row_mask:0xf bank_mask:0xf
    v_cndmask_b32_dpp v87, v87, v87, vcc wave_shr:1 row_mask:0xf bank_mask:0xf
    s_andn2_b64 s[82:83], s[82:83], s[52:53]
    v_cndmask_b32_dpp v7, v7, v7, vcc wave_shr:1 row_mask:0xf bank_mask:0xf
    s_mov_b64 exec, s[50:51]
    s_cbranch_scc0 L2_d81
    s_mov_b64 exec, s[82:83]
    s_nop 1
    v_mfma_f32_4x4x4_16b_bf16 v[88:91], v[12:13], v[84:85], 0
    s_nop 1
    v_mfma_f32_4x4x4_16b_bf16 v[88:91], v[10:11], v[86:87], v[88:91]
    s_nop 4
    v_cvt_pk_bf16_f32 v88, v88, v89
    v_cvt_pk_bf16_f32 v89, v90, v91
    ds_pk_add_bf16 v7, v88 offset:65408
    ds_pk_add_bf16 v7, v89 offset:65412
    s_mov_b64 exec, s[50:51]
    s_branch L2_d81
L2_c82:
    s_lshl_b64 s[52:53], s[82:83], 1
    s_andn2_b64 s[52:53], s[52:53], s[80:81]
    s_andn2_b64 s[52:53], s[52:53], s[54:55]
    s_or_b64 s[80:81], s[80:81], s[52:53]
    s_not_b64 vcc, s[52:53]
    s_mov_b64 exec, -1
    v_cndmask_b32_dpp v84, v84, v84, vcc wave_shr:1 row_mask:0xf bank_mask:0xf
    v_cndmask_b32_dpp v85, v85, v85, vcc wave_shr:1 row_mask:0xf bank_mask:0xf
    s_lshr_b64 s[52:53], s[52:53], 1
    v_cndmask_b32_dpp v86, v86, v86, vcc wave_shr:1 row_mask:0xf bank_mask:0xf
    v_cndmask_b32_dpp v87, v87, v87, vcc wave_shr:1 row_mask:0xf bank_mask:0xf
    s_andn2_b64 s[82:83], s[82:83], s[52:53]
    v_cndmask_b32_dpp v7, v7, v7, vcc wave_shr:1 row_mask:0xf bank_mask:0xf
    s_mov_b64 exec, s[54:55]
    s_cbranch_scc0 L2_d82
    s_mov_b64 exec, s[82:83]
    s_nop 1
    v_mfma_f32_4x4x4_16b_bf16 v[88:91], v[12:13], v[84:85], 0
    s_nop 1
    v_mfma_f32_4x4x4_16b_bf16 v[88:91], v[10:11], v[86:87], v[88:91]
    s_nop 4
    v_cvt_pk_bf16_f32 v88, v88, v89
    v_cvt_pk_bf16_f32 v89, v90, v91
    ds_pk_add_bf16 v7, v88 offset:65408
    ds_pk_add_bf16 v7, v89 offset:65412
    s_mov_b64 exec, s[54:55]
    s_branch L2_d82
L2_c83:
    s_lshl_b64 s[52:53], s[82:83], 1
    s_andn2_b64 s[52:53], s[52:53], s[80:81]
    s_andn2_b64 s[52:53], s[52:53], s[50:51]
    s_or_b64 s[80:81], s[80:81], s[52:53]
    s_not_b64 vcc, s[52:53]
    s_mov_b64 exec, -1
    v_cndmask_b32_dpp v84, v84, v84, vcc wave_shr:1 row_mask:0xf bank_mask:0xf
    v_cndmask_b32_dpp v85, v85, v85, vcc wave_shr:1 row_mask:0xf bank_mask:0xf
    s_lshr_b64 s[52:53], s[52:53], 1
    v_cndmask_b32_dpp v86, v86, v86, vcc wave_shr:1 row_mask:0xf bank_mask:0xf
    v_cndmask_b32_dpp v87, v87, v87, vcc wave_shr:1 row_mask:0xf bank_mask:0xf
    s_andn2_b64 s[82:83], s[82:83], s[52:53]
    v_cndmask_b32_dpp v7, v7, v7, vcc wave_shr:1 row_mask:0xf bank_mask:0xf
    s_mov_b64 exec, s[50:51]
    s_cbranch_scc0 L2_d83
    s_mov_b64 exec, s[82:83]
    s_nop 1
    v_mfma_f32_4x4x4_16b_bf16 v[88:91], v[12:13], v[84:85], 0
    s_nop 1
    v_mfma_f32_4x4x4_16b_bf16 v[88:91], v[10:11], v[86:87], v[88:91]
    s_nop 4
    v_cvt_pk_bf16_f32 v88, v88, v89
    v_cvt_pk_bf16_f32 v89, v90, v91
    ds_pk_add_bf16 v7, v88 offset:65408
    ds_pk_add_bf16 v7, v89 offset:65412
    s_mov_b64 exec, s[50:51]
    s_branch L2_d83
L2_c84:
    s_lshl_b64 s[52:53], s[82:83], 1
    s_andn2_b64 s[52:53], s[52:53], s[80:81]
    s_andn2_b64 s[52:53], s[52:53], s[54:55]
    s_or_b64 s[80:81], s[80:81], s[52:53]
    s_not_b64 vcc, s[52:53]
    s_mov_b64 exec, -1
    v_cndmask_b32_dpp v84, v84, v84, vcc wave_shr:1 row_mask:0xf bank_mask:0xf
    v_cndmask_b32_dpp v85, v85, v85, vcc wave_shr:1 row_mask:0xf bank_mask:0xf
    s_lshr_b64 s[52:53], s[52:53], 1
    v_cndmask_b32_dpp v86, v86, v86, vcc wave_shr:1 row_mask:0xf bank_mask:0xf
    v_cndmask_b32_dpp v87, v87, v87, vcc wave_shr:1 row_mask:0xf bank_mask:0xf
    s_andn2_b64 s[82:83], s[82:83], s[52:53]
    v_cndmask_b32_dpp v7, v7, v7, vcc wave_shr:1 row_mask:0xf bank_mask:0xf
    s_mov_b64 exec, s[54:55]
    s_cbranch_scc0 L2_d84
    s_mov_b64 exec, s[82:83]
    s_nop 1
    v_mfma_f32_4x4x4_16b_bf16 v[88:91], v[12:13], v[84:85], 0
    s_nop 1
    v_mfma_f32_4x4x4_16b_bf16 v[88:91], v[10:11], v[86:87], v[88:91]
    s_nop 4
    v_cvt_pk_bf16_f32 v88, v88, v89
    v_cvt_pk_bf16_f32 v89, v90, v91
    ds_pk_add_bf16 v7, v88 offset:65408
    ds_pk_add_bf16 v7, v89 offset:65412
    s_mov_b64 exec, s[54:55]
    s_branch L2_d84
L2_c85:
    s_lshl_b64 s[52:53], s[82:83], 1
    s_andn2_b64 s[52:53], s[52:53], s[80:81]
    s_andn2_b64 s[52:53], s[52:53], s[50:51]
    s_or_b64 s[80:81], s[80:81], s[52:53]
    s_not_b64 vcc, s[52:53]
    s_mov_b64 exec, -1
    v_cndmask_b32_dpp v84, v84, v84, vcc wave_shr:1 row_mask:0xf bank_mask:0xf
    v_cndmask_b32_dpp v85, v85, v85, vcc wave_shr:1 row_mask:0xf bank_mask:0xf
    s_lshr_b64 s[52:53], s[52:53], 1
    v_cndmask_b32_dpp v86, v86, v86, vcc wave_shr:1 row_mask:0xf bank_mask:0xf
    v_cndmask_b32_dpp v87, v87, v87, vcc wave_shr:1 row_mask:0xf bank_mask:0xf
    s_andn2_b64 s[82:83], s[82:83], s[52:53]
    v_cndmask_b32_dpp v7, v7, v7, vcc wave_shr:1 row_mask:0xf bank_mask:0xf
    s_mov_b64 exec, s[50:51]
    s_cbranch_scc0 L2_d85
    s_mov_b64 exec, s[82:83]
    s_nop 1
    v_mfma_f32_4x4x4_16b_bf16 v[88:91], v[12:13], v[84:85], 0
    s_nop 1
    v_mfma_f32_4x4x4_16b_bf16 v[88:91], v[10:11], v[86:87], v[88:91]
    s_nop 4
    v_cvt_pk_bf16_f32 v88, v88, v89
    v_cvt_pk_bf16_f32 v89, v90, v91
    ds_pk_add_bf16 v7, v88 offset:65408
    ds_pk_add_bf16 v7, v89 offset:65412
    s_mov_b64 exec, s[50:51]
    s_branch L2_d85
L2_xo86:
    v_cmp_lt_u32 vcc, 20, v99
    s_mov_b32 s101, 1
    s_cbranch_vccz L2_xp86
    v_cmp_lt_u32 vcc, 32, v99
    v_cmp_lt_u32 s[58:59], 31, v88
    s_mov_b32 s101, 2
    s_or_b64 vcc, vcc, s[58:59]
    s_cbranch_scc0 L2_xp86
    s_mov_b32 s37, 0x10000
    s_branch L2_xp86
L2_c87:
    s_lshl_b64 s[52:53], s[82:83], 1
    s_andn2_b64 s[52:53], s[52:53], s[80:81]
    s_andn2_b64 s[52:53], s[52:53], s[54:55]
    s_or_b64 s[80:81], s[80:81], s[52:53]
    s_not_b64 vcc, s[52:53]
    s_mov_b64 exec, -1
    v_cndmask_b32_dpp v84, v84, v84, vcc wave_shr:1 row_mask:0xf bank_mask:0xf
    v_cndmask_b32_dpp v85, v85, v85, vcc wave_shr:1 row_mask:0xf bank_mask:0xf
    s_lshr_b64 s[52:53], s[52:53], 1
    v_cndmask_b32_dpp v86, v86, v86, vcc wave_shr:1 row_mask:0xf bank_mask:0xf
    v_cndmask_b32_dpp v87, v87, v87, vcc wave_shr:1 row_mask:0xf bank_mask:0xf
    s_andn2_b64 s[82:83], s[82:83], s[52:53]
    v_cndmask_b32_dpp v7, v7, v7, vcc wave_shr:1 row_mask:0xf bank_mask:0xf
    s_mov_b64 exec, s[54:55]
    s_cbranch_scc0 L2_d87
    s_mov_b64 exec, s[82:83]
    s_nop 1
    v_mfma_f32_4x4x4_16b_bf16 v[88:91], v[12:13], v[84:85], 0
    s_nop 1
    v_mfma_f32_4x4x4_16b_bf16 v[88:91], v[10:11], v[86:87], v[88:91]
    s_nop 4
    v_cvt_pk_bf16_f32 v88, v88, v89
    v_cvt_pk_bf16_f32 v89, v90, v91
    ds_pk_add_bf16 v7, v88 offset:65408
    ds_pk_add_bf16 v7, v89 offset:65412
    s_mov_b64 exec, s[54:55]
    s_branch L2_d87
L2_c88:
    s_lshl_b64 s[52:53], s[82:83], 1
    s_andn2_b64 s[52:53], s[52:53], s[80:81]
    s_andn2_b64 s[52:53], s[52:53], s[50:51]
    s_or_b64 s[80:81], s[80:81], s[52:53]
    s_not_b64 vcc, s[52:53]
    s_mov_b64 exec, -1
    v_cndmask_b32_dpp v84, v84, v84, vcc wave_shr:1 row_mask:0xf bank_mask:0xf
    v_cndmask_b32_dpp v85, v85, v85, vcc wave_shr:1 row_mask:0xf bank_mask:0xf
    s_lshr_b64 s[52:53], s[52:53], 1
    v_cndmask_b32_dpp v86, v86, v86, vcc wave_shr:1 row_mask:0xf bank_mask:0xf
    v_cndmask_b32_dpp v87, v87, v87, vcc wave_shr:1 row_mask:0xf bank_mask:0xf
    s_andn2_b64 s[82:83], s[82:83], s[52:53]
    v_cndmask_b32_dpp v7, v7, v7, vcc wave_shr:1 row_mask:0xf bank_mask:0xf
    s_mov_b64 exec, s[50:51]
    s_cbranch_scc0 L2_d88
    s_mov_b64 exec, s[82:83]
    s_nop 1
    v_mfma_f32_4x4x4_16b_bf16 v[88:91], v[12:13], v[84:85], 0
    s_nop 1
    v_mfma_f32_4x4x4_16b_bf16 v[88:91], v[10:11], v[86:87], v[88:91]
    s_nop 4
    v_cvt_pk_bf16_f32 v88, v88, v89
    v_cvt_pk_bf16_f32 v89, v90, v91
    ds_pk_add_bf16 v7, v88 offset:65408
    ds_pk_add_bf16 v7, v89 offset:65412
    s_mov_b64 exec, s[50:51]
    s_branch L2_d88
L2_c89:
    s_lshl_b64 s[52:53], s[82:83], 1
    s_andn2_b64 s[52:53], s[52:53], s[80:81]
    s_andn2_b64 s[52:53], s[52:53], s[54:55]
    s_or_b64 s[80:81], s[80:81], s[52:53]
    s_not_b64 vcc, s[52:53]
    s_mov_b64 exec, -1
    v_cndmask_b32_dpp v84, v84, v84, vcc wave_shr:1 row_mask:0xf bank_mask:0xf
    v_cndmask_b32_dpp v85, v85, v85, vcc wave_shr:1 row_mask:0xf bank_mask:0xf
    s_lshr_b64 s[52:53], s[52:53], 1
    v_cndmask_b32_dpp v86, v86, v86, vcc wave_shr:1 row_mask:0xf bank_mask:0xf
    v_cndmask_b32_dpp v87, v87, v87, vcc wave_shr:1 row_mask:0xf bank_mask:0xf
    s_andn2_b64 s[82:83], s[82:83], s[52:53]
    v_cndmask_b32_dpp v7, v7, v7, vcc wave_shr:1 row_mask:0xf bank_mask:0xf
    s_mov_b64 exec, s[54:55]
    s_cbranch_scc0 L2_d89
    s_mov_b64 exec, s[82:83]
    s_nop 1
    v_mfma_f32_4x4x4_16b_bf16 v[88:91], v[12:13], v[84:85], 0
    s_nop 1
    v_mfma_f32_4x4x4_16b_bf16 v[88:91], v[10:11], v[86:87], v[88:91]
    s_nop 4
    v_cvt_pk_bf16_f32 v88, v88, v89
    v_cvt_pk_bf16_f32 v89, v90, v91
    ds_pk_add_bf16 v7, v88 offset:65408
    ds_pk_add_bf16 v7, v89 offset:65412
    s_mov_b64 exec, s[54:55]
    s_branch L2_d89
L2_c90:
    s_lshl_b64 s[52:53], s[82:83], 1
    s_andn2_b64 s[52:53], s[52:53], s[80:81]
    s_andn2_b64 s[52:53], s[52:53], s[50:51]
    s_or_b64 s[80:81], s[80:81], s[52:53]
    s_not_b64 vcc, s[52:53]
    s_mov_b64 exec, -1
    v_cndmask_b32_dpp v84, v84, v84, vcc wave_shr:1 row_mask:0xf bank_mask:0xf
    v_cndmask_b32_dpp v85, v85, v85, vcc wave_shr:1 row_mask:0xf bank_mask:0xf
    s_lshr_b64 s[52:53], s[52:53], 1
    v_cndmask_b32_dpp v86, v86, v86, vcc wave_shr:1 row_mask:0xf bank_mask:0xf
    v_cndmask_b32_dpp v87, v87, v87, vcc wave_shr:1 row_mask:0xf bank_mask:0xf
    s_andn2_b64 s[82:83], s[82:83], s[52:53]
    v_cndmask_b32_dpp v7, v7, v7, vcc wave_shr:1 row_mask:0xf bank_mask:0xf
    s_mov_b64 exec, s[50:51]
    s_cbranch_scc0 L2_d90
    s_mov_b64 exec, s[82:83]
    s_nop 1
    v_mfma_f32_4x4x4_16b_bf16 v[88:91], v[12:13], v[84:85], 0
    s_nop 1
    v_mfma_f32_4x4x4_16b_bf16 v[88:91], v[10:11], v[86:87], v[88:91]
    s_nop 4
    v_cvt_pk_bf16_f32 v88, v88, v89
    v_cvt_pk_bf16_f32 v89, v90, v91
    ds_pk_add_bf16 v7, v88 offset:65408
    ds_pk_add_bf16 v7, v89 offset:65412
    s_mov_b64 exec, s[50:51]
    s_branch L2_d90
L2_c91:
    s_lshl_b64 s[52:53], s[82:83], 1
    s_andn2_b64 s[52:53], s[52:53], s[80:81]
    s_andn2_b64 s[52:53], s[52:53], s[54:55]
    s_or_b64 s[80:81], s[80:81], s[52:53]
    s_not_b64 vcc, s[52:53]
    s_mov_b64 exec, -1
    v_cndmask_b32_dpp v84, v84, v84, vcc wave_shr:1 row_mask:0xf bank_mask:0xf
    v_cndmask_b32_dpp v85, v85, v85, vcc wave_shr:1 row_mask:0xf bank_mask:0xf
    s_lshr_b64 s[52:53], s[52:53], 1
    v_cndmask_b32_dpp v86, v86, v86, vcc wave_shr:1 row_mask:0xf bank_mask:0xf
    v_cndmask_b32_dpp v87, v87, v87, vcc wave_shr:1 row_mask:0xf bank_mask:0xf
    s_andn2_b64 s[82:83], s[82:83], s[52:53]
    v_cndmask_b32_dpp v7, v7, v7, vcc wave_shr:1 row_mask:0xf bank_mask:0xf
    s_mov_b64 exec, s[54:55]
    s_cbranch_scc0 L2_d91
    s_mov_b64 exec, s[82:83]
    s_nop 1
    v_mfma_f32_4x4x4_16b_bf16 v[88:91], v[12:13], v[84:85], 0
    s_nop 1
    v_mfma_f32_4x4x4_16b_bf16 v[88:91], v[10:11], v[86:87], v[88:91]
    s_nop 4
    v_cvt_pk_bf16_f32 v88, v88, v89
    v_cvt_pk_bf16_f32 v89, v90, v91
    ds_pk_add_bf16 v7, v88 offset:65408
    ds_pk_add_bf16 v7, v89 offset:65412
    s_mov_b64 exec, s[54:55]
    s_branch L2_d91
L2_c92:
    s_lshl_b64 s[52:53], s[82:83], 1
    s_andn2_b64 s[52:53], s[52:53], s[80:81]
    s_andn2_b64 s[52:53], s[52:53], s[50:51]
    s_or_b64 s[80:81], s[80:81], s[52:53]
    s_not_b64 vcc, s[52:53]
    s_mov_b64 exec, -1
    v_cndmask_b32_dpp v84, v84, v84, vcc wave_shr:1 row_mask:0xf bank_mask:0xf
    v_cndmask_b32_dpp v85, v85, v85, vcc wave_shr:1 row_mask:0xf bank_mask:0xf
    s_lshr_b64 s[52:53], s[52:53], 1
    v_cndmask_b32_dpp v86, v86, v86, vcc wave_shr:1 row_mask:0xf bank_mask:0xf
    v_cndmask_b32_dpp v87, v87, v87, vcc wave_shr:1 row_mask:0xf bank_mask:0xf
    s_andn2_b64 s[82:83], s[82:83], s[52:53]
    v_cndmask_b32_dpp v7, v7, v7, vcc wave_shr:1 row_mask:0xf bank_mask:0xf
    s_mov_b64 exec, s[50:51]
    s_cbranch_scc0 L2_d92
    s_mov_b64 exec, s[82:83]
    s_nop 1
    v_mfma_f32_4x4x4_16b_bf16 v[88:91], v[12:13], v[84:85], 0
    s_nop 1
    v_mfma_f32_4x4x4_16b_bf16 v[88:91], v[10:11], v[86:87], v[88:91]
    s_nop 4
    v_cvt_pk_bf16_f32 v88, v88, v89
    v_cvt_pk_bf16_f32 v89, v90, v91
    ds_pk_add_bf16 v7, v88 offset:65408
    ds_pk_add_bf16 v7, v89 offset:65412
    s_mov_b64 exec, s[50:51]
    s_branch L2_d92
L2_c93:
    s_lshl_b64 s[52:53], s[82:83], 1
    s_andn2_b64 s[52:53], s[52:53], s[80:81]
    s_andn2_b64 s[52:53], s[52:53], s[54:55]
    s_or_b64 s[80:81], s[80:81], s[52:53]
    s_not_b64 vcc, s[52:53]
    s_mov_b64 exec, -1
    v_cndmask_b32_dpp v84, v84, v84, vcc wave_shr:1 row_mask:0xf bank_mask:0xf
    v_cndmask_b32_dpp v85, v85, v85, vcc wave_shr:1 row_mask:0xf bank_mask:0xf
    s_lshr_b64 s[52:53], s[52:53], 1
    v_cndmask_b32_dpp v86, v86, v86, vcc wave_shr:1 row_mask:0xf bank_mask:0xf
    v_cndmask_b32_dpp v87, v87, v87, vcc wave_shr:1 row_mask:0xf bank_mask:0xf
    s_andn2_b64 s[82:83], s[82:83], s[52:53]
    v_cndmask_b32_dpp v7, v7, v7, vcc wave_shr:1 row_mask:0xf bank_mask:0xf
    s_mov_b64 exec, s[54:55]
    s_cbranch_scc0 L2_d93
    s_mov_b64 exec, s[82:83]
    s_nop 1
    v_mfma_f32_4x4x4_16b_bf16 v[88:91], v[12:13], v[84:85], 0
    s_nop 1
    v_mfma_f32_4x4x4_16b_bf16 v[88:91], v[10:11], v[86:87], v[88:91]
    s_nop 4
    v_cvt_pk_bf16_f32 v88, v88, v89
    v_cvt_pk_bf16_f32 v89, v90, v91
    ds_pk_add_bf16 v7, v88 offset:65408
    ds_pk_add_bf16 v7, v89 offset:65412
    s_mov_b64 exec, s[54:55]
    s_branch L2_d93
L2_c94:
    s_lshl_b64 s[52:53], s[82:83], 1
    s_andn2_b64 s[52:53], s[52:53], s[80:81]
    s_andn2_b64 s[52:53], s[52:53], s[50:51]
    s_or_b64 s[80:81], s[80:81], s[52:53]
    s_not_b64 vcc, s[52:53]
    s_mov_b64 exec, -1
    v_cndmask_b32_dpp v84, v84, v84, vcc wave_shr:1 row_mask:0xf bank_mask:0xf
    v_cndmask_b32_dpp v85, v85, v85, vcc wave_shr:1 row_mask:0xf bank_mask:0xf
    s_lshr_b64 s[52:53], s[52:53], 1
    v_cndmask_b32_dpp v86, v86, v86, vcc wave_shr:1 row_mask:0xf bank_mask:0xf
    v_cndmask_b32_dpp v87, v87, v87, vcc wave_shr:1 row_mask:0xf bank_mask:0xf
    s_andn2_b64 s[82:83], s[82:83], s[52:53]
    v_cndmask_b32_dpp v7, v7, v7, vcc wave_shr:1 row_mask:0xf bank_mask:0xf
    s_mov_b64 exec, s[50:51]
    s_cbranch_scc0 L2_d94
    s_mov_b64 exec, s[82:83]
    s_nop 1
    v_mfma_f32_4x4x4_16b_bf16 v[88:91], v[12:13], v[84:85], 0
    s_nop 1
    v_mfma_f32_4x4x4_16b_bf16 v[88:91], v[10:11], v[86:87], v[88:91]
    s_nop 4
    v_cvt_pk_bf16_f32 v88, v88, v89
    v_cvt_pk_bf16_f32 v89, v90, v91
    ds_pk_add_bf16 v7, v88 offset:65408
    ds_pk_add_bf16 v7, v89 offset:65412
    s_mov_b64 exec, s[50:51]
    s_branch L2_d94
L2_c95:
    s_lshl_b64 s[52:53], s[82:83], 1
    s_andn2_b64 s[52:53], s[52:53], s[80:81]
    s_andn2_b64 s[52:53], s[52:53], s[54:55]
    s_or_b64 s[80:81], s[80:81], s[52:53]
    s_not_b64 vcc, s[52:53]
    s_mov_b64 exec, -1
    v_cndmask_b32_dpp v84, v84, v84, vcc wave_shr:1 row_mask:0xf bank_mask:0xf
    v_cndmask_b32_dpp v85, v85, v85, vcc wave_shr:1 row_mask:0xf bank_mask:0xf
    s_lshr_b64 s[52:53], s[52:53], 1
    v_cndmask_b32_dpp v86, v86, v86, vcc wave_shr:1 row_mask:0xf bank_mask:0xf
    v_cndmask_b32_dpp v87, v87, v87, vcc wave_shr:1 row_mask:0xf bank_mask:0xf
    s_andn2_b64 s[82:83], s[82:83], s[52:53]
    v_cndmask_b32_dpp v7, v7, v7, vcc wave_shr:1 row_mask:0xf bank_mask:0xf
    s_mov_b64 exec, s[54:55]
    s_cbranch_scc0 L2_d95
    s_mov_b64 exec, s[82:83]
    s_nop 1
    v_mfma_f32_4x4x4_16b_bf16 v[88:91], v[12:13], v[84:85], 0
    s_nop 1
    v_mfma_f32_4x4x4_16b_bf16 v[88:91], v[10:11], v[86:87], v[88:91]
    s_nop 4
    v_cvt_pk_bf16_f32 v88, v88, v89
    v_cvt_pk_bf16_f32 v89, v90, v91
    ds_pk_add_bf16 v7, v88 offset:65408
    ds_pk_add_bf16 v7, v89 offset:65412
    s_mov_b64 exec, s[54:55]
    s_branch L2_d95
L2_c96:
    s_lshl_b64 s[52:53], s[82:83], 1
    s_andn2_b64 s[52:53], s[52:53], s[80:81]
    s_andn2_b64 s[52:53], s[52:53], s[50:51]
    s_or_b64 s[80:81], s[80:81], s[52:53]
    s_not_b64 vcc, s[52:53]
    s_mov_b64 exec, -1
    v_cndmask_b32_dpp v84, v84, v84, vcc wave_shr:1 row_mask:0xf bank_mask:0xf
    v_cndmask_b32_dpp v85, v85, v85, vcc wave_shr:1 row_mask:0xf bank_mask:0xf
    s_lshr_b64 s[52:53], s[52:53], 1
    v_cndmask_b32_dpp v86, v86, v86, vcc wave_shr:1 row_mask:0xf bank_mask:0xf
    v_cndmask_b32_dpp v87, v87, v87, vcc wave_shr:1 row_mask:0xf bank_mask:0xf
    s_andn2_b64 s[82:83], s[82:83], s[52:53]
    v_cndmask_b32_dpp v7, v7, v7, vcc wave_shr:1 row_mask:0xf bank_mask:0xf
    s_mov_b64 exec, s[50:51]
    s_cbranch_scc0 L2_d96
    s_mov_b64 exec, s[82:83]
    s_nop 1
    v_mfma_f32_4x4x4_16b_bf16 v[88:91], v[12:13], v[84:85], 0
    s_nop 1
    v_mfma_f32_4x4x4_16b_bf16 v[88:91], v[10:11], v[86:87], v[88:91]
    s_nop 4
    v_cvt_pk_bf16_f32 v88, v88, v89
    v_cvt_pk_bf16_f32 v89, v90, v91
    ds_pk_add_bf16 v7, v88 offset:65408
    ds_pk_add_bf16 v7, v89 offset:65412
    s_mov_b64 exec, s[50:51]
    s_branch L2_d96
L2_xa97:
    s_cmp_eq_u32 s101, 1
    s_cbranch_scc1 L2_xc97
    v_lshlrev_b32 v89, 0, v96
    v_add_u32 v90, 140, v97
    v_bitop3_b32 v90, v89, v45, v90 bitop3:0x6a
    ds_write_b32 v98, v90 offset:28
    v_lshlrev_b32 v89, 4, v96
    v_add_u32 v90, 120, v97
    v_bitop3_b32 v90, v89, v45, v90 bitop3:0x6a
    ds_write_b32 v98, v90 offset:24
    v_lshlrev_b32 v89, 8, v96
    v_add_u32 v90, 100, v97
    v_bitop3_b32 v90, v89, v45, v90 bitop3:0x6a
    ds_write_b32 v98, v90 offset:20
L2_xc97:
    v_lshlrev_b32 v89, 12, v96
    v_add_u32 v90, 80, v97
    v_bitop3_b32 v90, v89, v45, v90 bitop3:0x6a
    ds_write_b32 v98, v90 offset:16
    s_branch L2_xb97
L2_xe97:
    v_cmp_lt_u32 vcc, 32, v99
    v_cmp_lt_u32 s[58:59], 31, v88
    v_lshrrev_b32 v89, 16, v96
    v_add_u32 v97, 80, v97
    s_or_b64 vcc, vcc, s[58:59]
    s_cbranch_scc1 L2_xs97
    v_lshlrev_b32 v89, v1, v89
    v_and_b32 v89, v45, v89
    v_cmp_ne_u32 vcc, 0, v89
    v_xor_b32 v90, v97, v89
    s_add_u32 s3, s37, s38
    v_mbcnt_lo_u32_b32 v98, vcc_lo, 0
    v_mbcnt_hi_u32_b32 v98, vcc_hi, v98
    s_bcnt1_i32_b64 s41, vcc
    v_lshl_add_u32 v98, v98, 2, s3
    s_mov_b64 exec, vcc
    ds_write_b32 v98, v90
    s_mov_b64 exec, -1
    s_lshl2_add_u32 s37, s41, s37
    s_branch L2_xr97
L2_xf97:
    s_waitcnt lgkmcnt(0)
    s_cmp_gt_u32 s37, 1024
    s_cbranch_scc1 L2_xs97
    v_mov_b32 v43, -1
    s_cmp_ge_u32 s37, 512
    s_cbranch_scc1 L2_xg97
    v_mov_b32 v42, -1
    s_cmp_ge_u32 s37, 256
    s_cbranch_scc1 L2_xg97
    v_mov_b32 v41, -1
    s_branch L2_xg97
L2_xs97:
    s_waitcnt lgkmcnt(0)
    v_mov_b32 v40, -1
    v_mov_b32 v41, -1
    v_mov_b32 v42, -1
    v_mov_b32 v43, -1
    s_add_u32 s3, s42, 2
    s_bitset1_b32 s36, s3
    s_branch L2_xg97
L2_c98:
    s_lshl_b64 s[52:53], s[82:83], 1
    s_andn2_b64 s[52:53], s[52:53], s[80:81]
    s_andn2_b64 s[52:53], s[52:53], s[54:55]
    s_or_b64 s[80:81], s[80:81], s[52:53]
    s_not_b64 vcc, s[52:53]
    s_mov_b64 exec, -1
    v_cndmask_b32_dpp v84, v84, v84, vcc wave_shr:1 row_mask:0xf bank_mask:0xf
    v_cndmask_b32_dpp v85, v85, v85, vcc wave_shr:1 row_mask:0xf bank_mask:0xf
    s_lshr_b64 s[52:53], s[52:53], 1
    v_cndmask_b32_dpp v86, v86, v86, vcc wave_shr:1 row_mask:0xf bank_mask:0xf
    v_cndmask_b32_dpp v87, v87, v87, vcc wave_shr:1 row_mask:0xf bank_mask:0xf
    s_andn2_b64 s[82:83], s[82:83], s[52:53]
    v_cndmask_b32_dpp v7, v7, v7, vcc wave_shr:1 row_mask:0xf bank_mask:0xf
    s_mov_b64 exec, s[54:55]
    s_cbranch_scc0 L2_d98
    s_mov_b64 exec, s[82:83]
    s_nop 1
    v_mfma_f32_4x4x4_16b_bf16 v[88:91], v[12:13], v[84:85], 0
    s_nop 1
    v_mfma_f32_4x4x4_16b_bf16 v[88:91], v[10:11], v[86:87], v[88:91]
    s_nop 4
    v_cvt_pk_bf16_f32 v88, v88, v89
    v_cvt_pk_bf16_f32 v89, v90, v91
    ds_pk_add_bf16 v7, v88 offset:65408
    ds_pk_add_bf16 v7, v89 offset:65412
    s_mov_b64 exec, s[54:55]
    s_branch L2_d98
L2_c99:
    s_lshl_b64 s[52:53], s[82:83], 1
    s_andn2_b64 s[52:53], s[52:53], s[80:81]
    s_andn2_b64 s[52:53], s[52:53], s[50:51]
    s_or_b64 s[80:81], s[80:81], s[52:53]
    s_not_b64 vcc, s[52:53]
    s_mov_b64 exec, -1
    v_cndmask_b32_dpp v84, v84, v84, vcc wave_shr:1 row_mask:0xf bank_mask:0xf
    v_cndmask_b32_dpp v85, v85, v85, vcc wave_shr:1 row_mask:0xf bank_mask:0xf
    s_lshr_b64 s[52:53], s[52:53], 1
    v_cndmask_b32_dpp v86, v86, v86, vcc wave_shr:1 row_mask:0xf bank_mask:0xf
    v_cndmask_b32_dpp v87, v87, v87, vcc wave_shr:1 row_mask:0xf bank_mask:0xf
    s_andn2_b64 s[82:83], s[82:83], s[52:53]
    v_cndmask_b32_dpp v7, v7, v7, vcc wave_shr:1 row_mask:0xf bank_mask:0xf
    s_mov_b64 exec, s[50:51]
    s_cbranch_scc0 L2_d99
    s_mov_b64 exec, s[82:83]
    s_nop 1
    v_mfma_f32_4x4x4_16b_bf16 v[88:91], v[12:13], v[84:85], 0
    s_nop 1
    v_mfma_f32_4x4x4_16b_bf16 v[88:91], v[10:11], v[86:87], v[88:91]
    s_nop 4
    v_cvt_pk_bf16_f32 v88, v88, v89
    v_cvt_pk_bf16_f32 v89, v90, v91
    ds_pk_add_bf16 v7, v88 offset:65408
    ds_pk_add_bf16 v7, v89 offset:65412
    s_mov_b64 exec, s[50:51]
    s_branch L2_d99
L2_c100:
    s_lshl_b64 s[52:53], s[82:83], 1
    s_andn2_b64 s[52:53], s[52:53], s[80:81]
    s_andn2_b64 s[52:53], s[52:53], s[54:55]
    s_or_b64 s[80:81], s[80:81], s[52:53]
    s_not_b64 vcc, s[52:53]
    s_mov_b64 exec, -1
    v_cndmask_b32_dpp v84, v84, v84, vcc wave_shr:1 row_mask:0xf bank_mask:0xf
    v_cndmask_b32_dpp v85, v85, v85, vcc wave_shr:1 row_mask:0xf bank_mask:0xf
    s_lshr_b64 s[52:53], s[52:53], 1
    v_cndmask_b32_dpp v86, v86, v86, vcc wave_shr:1 row_mask:0xf bank_mask:0xf
    v_cndmask_b32_dpp v87, v87, v87, vcc wave_shr:1 row_mask:0xf bank_mask:0xf
    s_andn2_b64 s[82:83], s[82:83], s[52:53]
    v_cndmask_b32_dpp v7, v7, v7, vcc wave_shr:1 row_mask:0xf bank_mask:0xf
    s_mov_b64 exec, s[54:55]
    s_cbranch_scc0 L2_d100
    s_mov_b64 exec, s[82:83]
    s_nop 1
    v_mfma_f32_4x4x4_16b_bf16 v[88:91], v[12:13], v[84:85], 0
    s_nop 1
    v_mfma_f32_4x4x4_16b_bf16 v[88:91], v[10:11], v[86:87], v[88:91]
    s_nop 4
    v_cvt_pk_bf16_f32 v88, v88, v89
    v_cvt_pk_bf16_f32 v89, v90, v91
    ds_pk_add_bf16 v7, v88 offset:65408
    ds_pk_add_bf16 v7, v89 offset:65412
    s_mov_b64 exec, s[54:55]
    s_branch L2_d100
L2_c101:
    s_lshl_b64 s[52:53], s[82:83], 1
    s_andn2_b64 s[52:53], s[52:53], s[80:81]
    s_andn2_b64 s[52:53], s[52:53], s[50:51]
    s_or_b64 s[80:81], s[80:81], s[52:53]
    s_not_b64 vcc, s[52:53]
    s_mov_b64 exec, -1
    v_cndmask_b32_dpp v84, v84, v84, vcc wave_shr:1 row_mask:0xf bank_mask:0xf
    v_cndmask_b32_dpp v85, v85, v85, vcc wave_shr:1 row_mask:0xf bank_mask:0xf
    s_lshr_b64 s[52:53], s[52:53], 1
    v_cndmask_b32_dpp v86, v86, v86, vcc wave_shr:1 row_mask:0xf bank_mask:0xf
    v_cndmask_b32_dpp v87, v87, v87, vcc wave_shr:1 row_mask:0xf bank_mask:0xf
    s_andn2_b64 s[82:83], s[82:83], s[52:53]
    v_cndmask_b32_dpp v7, v7, v7, vcc wave_shr:1 row_mask:0xf bank_mask:0xf
    s_mov_b64 exec, s[50:51]
    s_cbranch_scc0 L2_d101
    s_mov_b64 exec, s[82:83]
    s_nop 1
    v_mfma_f32_4x4x4_16b_bf16 v[88:91], v[12:13], v[84:85], 0
    s_nop 1
    v_mfma_f32_4x4x4_16b_bf16 v[88:91], v[10:11], v[86:87], v[88:91]
    s_nop 4
    v_cvt_pk_bf16_f32 v88, v88, v89
    v_cvt_pk_bf16_f32 v89, v90, v91
    ds_pk_add_bf16 v7, v88 offset:65408
    ds_pk_add_bf16 v7, v89 offset:65412
    s_mov_b64 exec, s[50:51]
    s_branch L2_d101
L2_c102:
    s_lshl_b64 s[52:53], s[82:83], 1
    s_andn2_b64 s[52:53], s[52:53], s[80:81]
    s_andn2_b64 s[52:53], s[52:53], s[54:55]
    s_or_b64 s[80:81], s[80:81], s[52:53]
    s_not_b64 vcc, s[52:53]
    s_mov_b64 exec, -1
    v_cndmask_b32_dpp v84, v84, v84, vcc wave_shr:1 row_mask:0xf bank_mask:0xf
    v_cndmask_b32_dpp v85, v85, v85, vcc wave_shr:1 row_mask:0xf bank_mask:0xf
    s_lshr_b64 s[52:53], s[52:53], 1
    v_cndmask_b32_dpp v86, v86, v86, vcc wave_shr:1 row_mask:0xf bank_mask:0xf
    v_cndmask_b32_dpp v87, v87, v87, vcc wave_shr:1 row_mask:0xf bank_mask:0xf
    s_andn2_b64 s[82:83], s[82:83], s[52:53]
    v_cndmask_b32_dpp v7, v7, v7, vcc wave_shr:1 row_mask:0xf bank_mask:0xf
    s_mov_b64 exec, s[54:55]
    s_cbranch_scc0 L2_d102
    s_mov_b64 exec, s[82:83]
    s_nop 1
    v_mfma_f32_4x4x4_16b_bf16 v[88:91], v[12:13], v[84:85], 0
    s_nop 1
    v_mfma_f32_4x4x4_16b_bf16 v[88:91], v[10:11], v[86:87], v[88:91]
    s_nop 4
    v_cvt_pk_bf16_f32 v88, v88, v89
    v_cvt_pk_bf16_f32 v89, v90, v91
    ds_pk_add_bf16 v7, v88 offset:65408
    ds_pk_add_bf16 v7, v89 offset:65412
    s_mov_b64 exec, s[54:55]
    s_branch L2_d102
L2_c103:
    s_lshl_b64 s[52:53], s[82:83], 1
    s_andn2_b64 s[52:53], s[52:53], s[80:81]
    s_andn2_b64 s[52:53], s[52:53], s[50:51]
    s_or_b64 s[80:81], s[80:81], s[52:53]
    s_not_b64 vcc, s[52:53]
    s_mov_b64 exec, -1
    v_cndmask_b32_dpp v84, v84, v84, vcc wave_shr:1 row_mask:0xf bank_mask:0xf
    v_cndmask_b32_dpp v85, v85, v85, vcc wave_shr:1 row_mask:0xf bank_mask:0xf
    s_lshr_b64 s[52:53], s[52:53], 1
    v_cndmask_b32_dpp v86, v86, v86, vcc wave_shr:1 row_mask:0xf bank_mask:0xf
    v_cndmask_b32_dpp v87, v87, v87, vcc wave_shr:1 row_mask:0xf bank_mask:0xf
    s_andn2_b64 s[82:83], s[82:83], s[52:53]
    v_cndmask_b32_dpp v7, v7, v7, vcc wave_shr:1 row_mask:0xf bank_mask:0xf
    s_mov_b64 exec, s[50:51]
    s_cbranch_scc0 L2_d103
    s_mov_b64 exec, s[82:83]
    s_nop 1
    v_mfma_f32_4x4x4_16b_bf16 v[88:91], v[12:13], v[84:85], 0
    s_nop 1
    v_mfma_f32_4x4x4_16b_bf16 v[88:91], v[10:11], v[86:87], v[88:91]
    s_nop 4
    v_cvt_pk_bf16_f32 v88, v88, v89
    v_cvt_pk_bf16_f32 v89, v90, v91
    ds_pk_add_bf16 v7, v88 offset:65408
    ds_pk_add_bf16 v7, v89 offset:65412
    s_mov_b64 exec, s[50:51]
    s_branch L2_d103
L2_xo104:
    v_cmp_lt_u32 vcc, 20, v99
    s_mov_b32 s101, 1
    s_cbranch_vccz L2_xp104
    v_cmp_lt_u32 vcc, 32, v99
    v_cmp_lt_u32 s[58:59], 31, v88
    s_mov_b32 s101, 2
    s_or_b64 vcc, vcc, s[58:59]
    s_cbranch_scc0 L2_xp104
    s_mov_b32 s37, 0x10000
    s_branch L2_xp104
L2_c105:
    s_lshl_b64 s[52:53], s[82:83], 1
    s_andn2_b64 s[52:53], s[52:53], s[80:81]
    s_andn2_b64 s[52:53], s[52:53], s[54:55]
    s_or_b64 s[80:81], s[80:81], s[52:53]
    s_not_b64 vcc, s[52:53]
    s_mov_b64 exec, -1
    v_cndmask_b32_dpp v84, v84, v84, vcc wave_shr:1 row_mask:0xf bank_mask:0xf
    v_cndmask_b32_dpp v85, v85, v85, vcc wave_shr:1 row_mask:0xf bank_mask:0xf
    s_lshr_b64 s[52:53], s[52:53], 1
    v_cndmask_b32_dpp v86, v86, v86, vcc wave_shr:1 row_mask:0xf bank_mask:0xf
    v_cndmask_b32_dpp v87, v87, v87, vcc wave_shr:1 row_mask:0xf bank_mask:0xf
    s_andn2_b64 s[82:83], s[82:83], s[52:53]
    v_cndmask_b32_dpp v7, v7, v7, vcc wave_shr:1 row_mask:0xf bank_mask:0xf
    s_mov_b64 exec, s[54:55]
    s_cbranch_scc0 L2_d105
    s_mov_b64 exec, s[82:83]
    s_nop 1
    v_mfma_f32_4x4x4_16b_bf16 v[88:91], v[12:13], v[84:85], 0
    s_nop 1
    v_mfma_f32_4x4x4_16b_bf16 v[88:91], v[10:11], v[86:87], v[88:91]
    s_nop 4
    v_cvt_pk_bf16_f32 v88, v88, v89
    v_cvt_pk_bf16_f32 v89, v90, v91
    ds_pk_add_bf16 v7, v88 offset:65408
    ds_pk_add_bf16 v7, v89 offset:65412
    s_mov_b64 exec, s[54:55]
    s_branch L2_d105
L2_c106:
    s_lshl_b64 s[52:53], s[82:83], 1
    s_andn2_b64 s[52:53], s[52:53], s[80:81]
    s_andn2_b64 s[52:53], s[52:53], s[50:51]
    s_or_b64 s[80:81], s[80:81], s[52:53]
    s_not_b64 vcc, s[52:53]
    s_mov_b64 exec, -1
    v_cndmask_b32_dpp v84, v84, v84, vcc wave_shr:1 row_mask:0xf bank_mask:0xf
    v_cndmask_b32_dpp v85, v85, v85, vcc wave_shr:1 row_mask:0xf bank_mask:0xf
    s_lshr_b64 s[52:53], s[52:53], 1
    v_cndmask_b32_dpp v86, v86, v86, vcc wave_shr:1 row_mask:0xf bank_mask:0xf
    v_cndmask_b32_dpp v87, v87, v87, vcc wave_shr:1 row_mask:0xf bank_mask:0xf
    s_andn2_b64 s[82:83], s[82:83], s[52:53]
    v_cndmask_b32_dpp v7, v7, v7, vcc wave_shr:1 row_mask:0xf bank_mask:0xf
    s_mov_b64 exec, s[50:51]
    s_cbranch_scc0 L2_d106
    s_mov_b64 exec, s[82:83]
    s_nop 1
    v_mfma_f32_4x4x4_16b_bf16 v[88:91], v[12:13], v[84:85], 0
    s_nop 1
    v_mfma_f32_4x4x4_16b_bf16 v[88:91], v[10:11], v[86:87], v[88:91]
    s_nop 4
    v_cvt_pk_bf16_f32 v88, v88, v89
    v_cvt_pk_bf16_f32 v89, v90, v91
    ds_pk_add_bf16 v7, v88 offset:65408
    ds_pk_add_bf16 v7, v89 offset:65412
    s_mov_b64 exec, s[50:51]
    s_branch L2_d106
L2_c107:
    s_lshl_b64 s[52:53], s[82:83], 1
    s_andn2_b64 s[52:53], s[52:53], s[80:81]
    s_andn2_b64 s[52:53], s[52:53], s[54:55]
    s_or_b64 s[80:81], s[80:81], s[52:53]
    s_not_b64 vcc, s[52:53]
    s_mov_b64 exec, -1
    v_cndmask_b32_dpp v84, v84, v84, vcc wave_shr:1 row_mask:0xf bank_mask:0xf
    v_cndmask_b32_dpp v85, v85, v85, vcc wave_shr:1 row_mask:0xf bank_mask:0xf
    s_lshr_b64 s[52:53], s[52:53], 1
    v_cndmask_b32_dpp v86, v86, v86, vcc wave_shr:1 row_mask:0xf bank_mask:0xf
    v_cndmask_b32_dpp v87, v87, v87, vcc wave_shr:1 row_mask:0xf bank_mask:0xf
    s_andn2_b64 s[82:83], s[82:83], s[52:53]
    v_cndmask_b32_dpp v7, v7, v7, vcc wave_shr:1 row_mask:0xf bank_mask:0xf
    s_mov_b64 exec, s[54:55]
    s_cbranch_scc0 L2_d107
    s_mov_b64 exec, s[82:83]
    s_nop 1
    v_mfma_f32_4x4x4_16b_bf16 v[88:91], v[12:13], v[84:85], 0
    s_nop 1
    v_mfma_f32_4x4x4_16b_bf16 v[88:91], v[10:11], v[86:87], v[88:91]
    s_nop 4
    v_cvt_pk_bf16_f32 v88, v88, v89
    v_cvt_pk_bf16_f32 v89, v90, v91
    ds_pk_add_bf16 v7, v88 offset:65408
    ds_pk_add_bf16 v7, v89 offset:65412
    s_mov_b64 exec, s[54:55]
    s_branch L2_d107
L2_c108:
    s_lshl_b64 s[52:53], s[82:83], 1
    s_andn2_b64 s[52:53], s[52:53], s[80:81]
    s_andn2_b64 s[52:53], s[52:53], s[50:51]
    s_or_b64 s[80:81], s[80:81], s[52:53]
    s_not_b64 vcc, s[52:53]
    s_mov_b64 exec, -1
    v_cndmask_b32_dpp v84, v84, v84, vcc wave_shr:1 row_mask:0xf bank_mask:0xf
    v_cndmask_b32_dpp v85, v85, v85, vcc wave_shr:1 row_mask:0xf bank_mask:0xf
    s_lshr_b64 s[52:53], s[52:53], 1
    v_cndmask_b32_dpp v86, v86, v86, vcc wave_shr:1 row_mask:0xf bank_mask:0xf
    v_cndmask_b32_dpp v87, v87, v87, vcc wave_shr:1 row_mask:0xf bank_mask:0xf
    s_andn2_b64 s[82:83], s[82:83], s[52:53]
    v_cndmask_b32_dpp v7, v7, v7, vcc wave_shr:1 row_mask:0xf bank_mask:0xf
    s_mov_b64 exec, s[50:51]
    s_cbranch_scc0 L2_d108
    s_mov_b64 exec, s[82:83]
    s_nop 1
    v_mfma_f32_4x4x4_16b_bf16 v[88:91], v[12:13], v[84:85], 0
    s_nop 1
    v_mfma_f32_4x4x4_16b_bf16 v[88:91], v[10:11], v[86:87], v[88:91]
    s_nop 4
    v_cvt_pk_bf16_f32 v88, v88, v89
    v_cvt_pk_bf16_f32 v89, v90, v91
    ds_pk_add_bf16 v7, v88 offset:65408
    ds_pk_add_bf16 v7, v89 offset:65412
    s_mov_b64 exec, s[50:51]
    s_branch L2_d108
L2_c109:
    s_lshl_b64 s[52:53], s[82:83], 1
    s_andn2_b64 s[52:53], s[52:53], s[80:81]
    s_andn2_b64 s[52:53], s[52:53], s[54:55]
    s_or_b64 s[80:81], s[80:81], s[52:53]
    s_not_b64 vcc, s[52:53]
    s_mov_b64 exec, -1
    v_cndmask_b32_dpp v84, v84, v84, vcc wave_shr:1 row_mask:0xf bank_mask:0xf
    v_cndmask_b32_dpp v85, v85, v85, vcc wave_shr:1 row_mask:0xf bank_mask:0xf
    s_lshr_b64 s[52:53], s[52:53], 1
    v_cndmask_b32_dpp v86, v86, v86, vcc wave_shr:1 row_mask:0xf bank_mask:0xf
    v_cndmask_b32_dpp v87, v87, v87, vcc wave_shr:1 row_mask:0xf bank_mask:0xf
    s_andn2_b64 s[82:83], s[82:83], s[52:53]
    v_cndmask_b32_dpp v7, v7, v7, vcc wave_shr:1 row_mask:0xf bank_mask:0xf
    s_mov_b64 exec, s[54:55]
    s_cbranch_scc0 L2_d109
    s_mov_b64 exec, s[82:83]
    s_nop 1
    v_mfma_f32_4x4x4_16b_bf16 v[88:91], v[12:13], v[84:85], 0
    s_nop 1
    v_mfma_f32_4x4x4_16b_bf16 v[88:91], v[10:11], v[86:87], v[88:91]
    s_nop 4
    v_cvt_pk_bf16_f32 v88, v88, v89
    v_cvt_pk_bf16_f32 v89, v90, v91
    ds_pk_add_bf16 v7, v88 offset:65408
    ds_pk_add_bf16 v7, v89 offset:65412
    s_mov_b64 exec, s[54:55]
    s_branch L2_d109
L2_c110:
    s_lshl_b64 s[52:53], s[82:83], 1
    s_andn2_b64 s[52:53], s[52:53], s[80:81]
    s_andn2_b64 s[52:53], s[52:53], s[50:51]
    s_or_b64 s[80:81], s[80:81], s[52:53]
    s_not_b64 vcc, s[52:53]
    s_mov_b64 exec, -1
    v_cndmask_b32_dpp v84, v84, v84, vcc wave_shr:1 row_mask:0xf bank_mask:0xf
    v_cndmask_b32_dpp v85, v85, v85, vcc wave_shr:1 row_mask:0xf bank_mask:0xf
    s_lshr_b64 s[52:53], s[52:53], 1
    v_cndmask_b32_dpp v86, v86, v86, vcc wave_shr:1 row_mask:0xf bank_mask:0xf
    v_cndmask_b32_dpp v87, v87, v87, vcc wave_shr:1 row_mask:0xf bank_mask:0xf
    s_andn2_b64 s[82:83], s[82:83], s[52:53]
    v_cndmask_b32_dpp v7, v7, v7, vcc wave_shr:1 row_mask:0xf bank_mask:0xf
    s_mov_b64 exec, s[50:51]
    s_cbranch_scc0 L2_d110
    s_mov_b64 exec, s[82:83]
    s_nop 1
    v_mfma_f32_4x4x4_16b_bf16 v[88:91], v[12:13], v[84:85], 0
    s_nop 1
    v_mfma_f32_4x4x4_16b_bf16 v[88:91], v[10:11], v[86:87], v[88:91]
    s_nop 4
    v_cvt_pk_bf16_f32 v88, v88, v89
    v_cvt_pk_bf16_f32 v89, v90, v91
    ds_pk_add_bf16 v7, v88 offset:65408
    ds_pk_add_bf16 v7, v89 offset:65412
    s_mov_b64 exec, s[50:51]
    s_branch L2_d110
L2_c111:
    s_lshl_b64 s[52:53], s[82:83], 1
    s_andn2_b64 s[52:53], s[52:53], s[80:81]
    s_andn2_b64 s[52:53], s[52:53], s[54:55]
    s_or_b64 s[80:81], s[80:81], s[52:53]
    s_not_b64 vcc, s[52:53]
    s_mov_b64 exec, -1
    v_cndmask_b32_dpp v84, v84, v84, vcc wave_shr:1 row_mask:0xf bank_mask:0xf
    v_cndmask_b32_dpp v85, v85, v85, vcc wave_shr:1 row_mask:0xf bank_mask:0xf
    s_lshr_b64 s[52:53], s[52:53], 1
    v_cndmask_b32_dpp v86, v86, v86, vcc wave_shr:1 row_mask:0xf bank_mask:0xf
    v_cndmask_b32_dpp v87, v87, v87, vcc wave_shr:1 row_mask:0xf bank_mask:0xf
    s_andn2_b64 s[82:83], s[82:83], s[52:53]
    v_cndmask_b32_dpp v7, v7, v7, vcc wave_shr:1 row_mask:0xf bank_mask:0xf
    s_mov_b64 exec, s[54:55]
    s_cbranch_scc0 L2_d111
    s_mov_b64 exec, s[82:83]
    s_nop 1
    v_mfma_f32_4x4x4_16b_bf16 v[88:91], v[12:13], v[84:85], 0
    s_nop 1
    v_mfma_f32_4x4x4_16b_bf16 v[88:91], v[10:11], v[86:87], v[88:91]
    s_nop 4
    v_cvt_pk_bf16_f32 v88, v88, v89
    v_cvt_pk_bf16_f32 v89, v90, v91
    ds_pk_add_bf16 v7, v88 offset:65408
    ds_pk_add_bf16 v7, v89 offset:65412
    s_mov_b64 exec, s[54:55]
    s_branch L2_d111
L2_c112:
    s_lshl_b64 s[52:53], s[82:83], 1
    s_andn2_b64 s[52:53], s[52:53], s[80:81]
    s_andn2_b64 s[52:53], s[52:53], s[50:51]
    s_or_b64 s[80:81], s[80:81], s[52:53]
    s_not_b64 vcc, s[52:53]
    s_mov_b64 exec, -1
    v_cndmask_b32_dpp v84, v84, v84, vcc wave_shr:1 row_mask:0xf bank_mask:0xf
    v_cndmask_b32_dpp v85, v85, v85, vcc wave_shr:1 row_mask:0xf bank_mask:0xf
    s_lshr_b64 s[52:53], s[52:53], 1
    v_cndmask_b32_dpp v86, v86, v86, vcc wave_shr:1 row_mask:0xf bank_mask:0xf
    v_cndmask_b32_dpp v87, v87, v87, vcc wave_shr:1 row_mask:0xf bank_mask:0xf
    s_andn2_b64 s[82:83], s[82:83], s[52:53]
    v_cndmask_b32_dpp v7, v7, v7, vcc wave_shr:1 row_mask:0xf bank_mask:0xf
    s_mov_b64 exec, s[50:51]
    s_cbranch_scc0 L2_d112
    s_mov_b64 exec, s[82:83]
    s_nop 1
    v_mfma_f32_4x4x4_16b_bf16 v[88:91], v[12:13], v[84:85], 0
    s_nop 1
    v_mfma_f32_4x4x4_16b_bf16 v[88:91], v[10:11], v[86:87], v[88:91]
    s_nop 4
    v_cvt_pk_bf16_f32 v88, v88, v89
    v_cvt_pk_bf16_f32 v89, v90, v91
    ds_pk_add_bf16 v7, v88 offset:65408
    ds_pk_add_bf16 v7, v89 offset:65412
    s_mov_b64 exec, s[50:51]
    s_branch L2_d112
L2_c113:
    s_lshl_b64 s[52:53], s[82:83], 1
    s_andn2_b64 s[52:53], s[52:53], s[80:81]
    s_andn2_b64 s[52:53], s[52:53], s[54:55]
    s_or_b64 s[80:81], s[80:81], s[52:53]
    s_not_b64 vcc, s[52:53]
    s_mov_b64 exec, -1
    v_cndmask_b32_dpp v84, v84, v84, vcc wave_shr:1 row_mask:0xf bank_mask:0xf
    v_cndmask_b32_dpp v85, v85, v85, vcc wave_shr:1 row_mask:0xf bank_mask:0xf
    s_lshr_b64 s[52:53], s[52:53], 1
    v_cndmask_b32_dpp v86, v86, v86, vcc wave_shr:1 row_mask:0xf bank_mask:0xf
    v_cndmask_b32_dpp v87, v87, v87, vcc wave_shr:1 row_mask:0xf bank_mask:0xf
    s_andn2_b64 s[82:83], s[82:83], s[52:53]
    v_cndmask_b32_dpp v7, v7, v7, vcc wave_shr:1 row_mask:0xf bank_mask:0xf
    s_mov_b64 exec, s[54:55]
    s_cbranch_scc0 L2_d113
    s_mov_b64 exec, s[82:83]
    s_nop 1
    v_mfma_f32_4x4x4_16b_bf16 v[88:91], v[12:13], v[84:85], 0
    s_nop 1
    v_mfma_f32_4x4x4_16b_bf16 v[88:91], v[10:11], v[86:87], v[88:91]
    s_nop 4
    v_cvt_pk_bf16_f32 v88, v88, v89
    v_cvt_pk_bf16_f32 v89, v90, v91
    ds_pk_add_bf16 v7, v88 offset:65408
    ds_pk_add_bf16 v7, v89 offset:65412
    s_mov_b64 exec, s[54:55]
    s_branch L2_d113
L2_c114:
    s_lshl_b64 s[52:53], s[82:83], 1
    s_andn2_b64 s[52:53], s[52:53], s[80:81]
    s_andn2_b64 s[52:53], s[52:53], s[50:51]
    s_or_b64 s[80:81], s[80:81], s[52:53]
    s_not_b64 vcc, s[52:53]
    s_mov_b64 exec, -1
    v_cndmask_b32_dpp v84, v84, v84, vcc wave_shr:1 row_mask:0xf bank_mask:0xf
    v_cndmask_b32_dpp v85, v85, v85, vcc wave_shr:1 row_mask:0xf bank_mask:0xf
    s_lshr_b64 s[52:53], s[52:53], 1
    v_cndmask_b32_dpp v86, v86, v86, vcc wave_shr:1 row_mask:0xf bank_mask:0xf
    v_cndmask_b32_dpp v87, v87, v87, vcc wave_shr:1 row_mask:0xf bank_mask:0xf
    s_andn2_b64 s[82:83], s[82:83], s[52:53]
    v_cndmask_b32_dpp v7, v7, v7, vcc wave_shr:1 row_mask:0xf bank_mask:0xf
    s_mov_b64 exec, s[50:51]
    s_cbranch_scc0 L2_d114
    s_mov_b64 exec, s[82:83]
    s_nop 1
    v_mfma_f32_4x4x4_16b_bf16 v[88:91], v[12:13], v[84:85], 0
    s_nop 1
    v_mfma_f32_4x4x4_16b_bf16 v[88:91], v[10:11], v[86:87], v[88:91]
    s_nop 4
    v_cvt_pk_bf16_f32 v88, v88, v89
    v_cvt_pk_bf16_f32 v89, v90, v91
    ds_pk_add_bf16 v7, v88 offset:65408
    ds_pk_add_bf16 v7, v89 offset:65412
    s_mov_b64 exec, s[50:51]
    s_branch L2_d114
L2_xa115:
    s_cmp_eq_u32 s101, 1
    s_cbranch_scc1 L2_xc115
    v_lshlrev_b32 v89, 0, v96
    v_add_u32 v90, 140, v97
    v_bitop3_b32 v90, v89, v45, v90 bitop3:0x6a
    ds_write_b32 v98, v90 offset:28
    v_lshlrev_b32 v89, 4, v96
    v_add_u32 v90, 120, v97
    v_bitop3_b32 v90, v89, v45, v90 bitop3:0x6a
    ds_write_b32 v98, v90 offset:24
    v_lshlrev_b32 v89, 8, v96
    v_add_u32 v90, 100, v97
    v_bitop3_b32 v90, v89, v45, v90 bitop3:0x6a
    ds_write_b32 v98, v90 offset:20
L2_xc115:
    v_lshlrev_b32 v89, 12, v96
    v_add_u32 v90, 80, v97
    v_bitop3_b32 v90, v89, v45, v90 bitop3:0x6a
    ds_write_b32 v98, v90 offset:16
    s_branch L2_xb115
L2_xe115:
    v_cmp_lt_u32 vcc, 32, v99
    v_cmp_lt_u32 s[58:59], 31, v88
    v_lshrrev_b32 v89, 16, v96
    v_add_u32 v97, 80, v97
    s_or_b64 vcc, vcc, s[58:59]
    s_cbranch_scc1 L2_xs115
    v_lshlrev_b32 v89, v1, v89
    v_and_b32 v89, v45, v89
    v_cmp_ne_u32 vcc, 0, v89
    v_xor_b32 v90, v97, v89
    s_add_u32 s3, s37, s38
    v_mbcnt_lo_u32_b32 v98, vcc_lo, 0
    v_mbcnt_hi_u32_b32 v98, vcc_hi, v98
    s_bcnt1_i32_b64 s41, vcc
    v_lshl_add_u32 v98, v98, 2, s3
    s_mov_b64 exec, vcc
    ds_write_b32 v98, v90
    s_mov_b64 exec, -1
    s_lshl2_add_u32 s37, s41, s37
    s_branch L2_xr115
L2_xf115:
    s_waitcnt lgkmcnt(0)
    s_cmp_gt_u32 s37, 1024
    s_cbranch_scc1 L2_xs115
    v_mov_b32 v43, -1
    s_cmp_ge_u32 s37, 512
    s_cbranch_scc1 L2_xg115
    v_mov_b32 v42, -1
    s_cmp_ge_u32 s37, 256
    s_cbranch_scc1 L2_xg115
    v_mov_b32 v41, -1
    s_branch L2_xg115
L2_xs115:
    s_waitcnt lgkmcnt(0)
    v_mov_b32 v40, -1
    v_mov_b32 v41, -1
    v_mov_b32 v42, -1
    v_mov_b32 v43, -1
    s_add_u32 s3, s42, 2
    s_bitset1_b32 s36, s3
    s_branch L2_xg115
L2_c116:
    s_lshl_b64 s[52:53], s[82:83], 1
    s_andn2_b64 s[52:53], s[52:53], s[80:81]
    s_andn2_b64 s[52:53], s[52:53], s[54:55]
    s_or_b64 s[80:81], s[80:81], s[52:53]
    s_not_b64 vcc, s[52:53]
    s_mov_b64 exec, -1
    v_cndmask_b32_dpp v84, v84, v84, vcc wave_shr:1 row_mask:0xf bank_mask:0xf
    v_cndmask_b32_dpp v85, v85, v85, vcc wave_shr:1 row_mask:0xf bank_mask:0xf
    s_lshr_b64 s[52:53], s[52:53], 1
    v_cndmask_b32_dpp v86, v86, v86, vcc wave_shr:1 row_mask:0xf bank_mask:0xf
    v_cndmask_b32_dpp v87, v87, v87, vcc wave_shr:1 row_mask:0xf bank_mask:0xf
    s_andn2_b64 s[82:83], s[82:83], s[52:53]
    v_cndmask_b32_dpp v7, v7, v7, vcc wave_shr:1 row_mask:0xf bank_mask:0xf
    s_mov_b64 exec, s[54:55]
    s_cbranch_scc0 L2_d116
    s_mov_b64 exec, s[82:83]
    s_nop 1
    v_mfma_f32_4x4x4_16b_bf16 v[88:91], v[12:13], v[84:85], 0
    s_nop 1
    v_mfma_f32_4x4x4_16b_bf16 v[88:91], v[10:11], v[86:87], v[88:91]
    s_nop 4
    v_cvt_pk_bf16_f32 v88, v88, v89
    v_cvt_pk_bf16_f32 v89, v90, v91
    ds_pk_add_bf16 v7, v88 offset:65408
    ds_pk_add_bf16 v7, v89 offset:65412
    s_mov_b64 exec, s[54:55]
    s_branch L2_d116
L2_c117:
    s_lshl_b64 s[52:53], s[82:83], 1
    s_andn2_b64 s[52:53], s[52:53], s[80:81]
    s_andn2_b64 s[52:53], s[52:53], s[50:51]
    s_or_b64 s[80:81], s[80:81], s[52:53]
    s_not_b64 vcc, s[52:53]
    s_mov_b64 exec, -1
    v_cndmask_b32_dpp v84, v84, v84, vcc wave_shr:1 row_mask:0xf bank_mask:0xf
    v_cndmask_b32_dpp v85, v85, v85, vcc wave_shr:1 row_mask:0xf bank_mask:0xf
    s_lshr_b64 s[52:53], s[52:53], 1
    v_cndmask_b32_dpp v86, v86, v86, vcc wave_shr:1 row_mask:0xf bank_mask:0xf
    v_cndmask_b32_dpp v87, v87, v87, vcc wave_shr:1 row_mask:0xf bank_mask:0xf
    s_andn2_b64 s[82:83], s[82:83], s[52:53]
    v_cndmask_b32_dpp v7, v7, v7, vcc wave_shr:1 row_mask:0xf bank_mask:0xf
    s_mov_b64 exec, s[50:51]
    s_cbranch_scc0 L2_d117
    s_mov_b64 exec, s[82:83]
    s_nop 1
    v_mfma_f32_4x4x4_16b_bf16 v[88:91], v[12:13], v[84:85], 0
    s_nop 1
    v_mfma_f32_4x4x4_16b_bf16 v[88:91], v[10:11], v[86:87], v[88:91]
    s_nop 4
    v_cvt_pk_bf16_f32 v88, v88, v89
    v_cvt_pk_bf16_f32 v89, v90, v91
    ds_pk_add_bf16 v7, v88 offset:65408
    ds_pk_add_bf16 v7, v89 offset:65412
    s_mov_b64 exec, s[50:51]
    s_branch L2_d117
L2_c118:
    s_lshl_b64 s[52:53], s[82:83], 1
    s_andn2_b64 s[52:53], s[52:53], s[80:81]
    s_andn2_b64 s[52:53], s[52:53], s[54:55]
    s_or_b64 s[80:81], s[80:81], s[52:53]
    s_not_b64 vcc, s[52:53]
    s_mov_b64 exec, -1
    v_cndmask_b32_dpp v84, v84, v84, vcc wave_shr:1 row_mask:0xf bank_mask:0xf
    v_cndmask_b32_dpp v85, v85, v85, vcc wave_shr:1 row_mask:0xf bank_mask:0xf
    s_lshr_b64 s[52:53], s[52:53], 1
    v_cndmask_b32_dpp v86, v86, v86, vcc wave_shr:1 row_mask:0xf bank_mask:0xf
    v_cndmask_b32_dpp v87, v87, v87, vcc wave_shr:1 row_mask:0xf bank_mask:0xf
    s_andn2_b64 s[82:83], s[82:83], s[52:53]
    v_cndmask_b32_dpp v7, v7, v7, vcc wave_shr:1 row_mask:0xf bank_mask:0xf
    s_mov_b64 exec, s[54:55]
    s_cbranch_scc0 L2_d118
    s_mov_b64 exec, s[82:83]
    s_nop 1
    v_mfma_f32_4x4x4_16b_bf16 v[88:91], v[12:13], v[84:85], 0
    s_nop 1
    v_mfma_f32_4x4x4_16b_bf16 v[88:91], v[10:11], v[86:87], v[88:91]
    s_nop 4
    v_cvt_pk_bf16_f32 v88, v88, v89
    v_cvt_pk_bf16_f32 v89, v90, v91
    ds_pk_add_bf16 v7, v88 offset:65408
    ds_pk_add_bf16 v7, v89 offset:65412
    s_mov_b64 exec, s[54:55]
    s_branch L2_d118
L2_c119:
    s_lshl_b64 s[52:53], s[82:83], 1
    s_andn2_b64 s[52:53], s[52:53], s[80:81]
    s_andn2_b64 s[52:53], s[52:53], s[50:51]
    s_or_b64 s[80:81], s[80:81], s[52:53]
    s_not_b64 vcc, s[52:53]
    s_mov_b64 exec, -1
    v_cndmask_b32_dpp v84, v84, v84, vcc wave_shr:1 row_mask:0xf bank_mask:0xf
    v_cndmask_b32_dpp v85, v85, v85, vcc wave_shr:1 row_mask:0xf bank_mask:0xf
    s_lshr_b64 s[52:53], s[52:53], 1
    v_cndmask_b32_dpp v86, v86, v86, vcc wave_shr:1 row_mask:0xf bank_mask:0xf
    v_cndmask_b32_dpp v87, v87, v87, vcc wave_shr:1 row_mask:0xf bank_mask:0xf
    s_andn2_b64 s[82:83], s[82:83], s[52:53]
    v_cndmask_b32_dpp v7, v7, v7, vcc wave_shr:1 row_mask:0xf bank_mask:0xf
    s_mov_b64 exec, s[50:51]
    s_cbranch_scc0 L2_d119
    s_mov_b64 exec, s[82:83]
    s_nop 1
    v_mfma_f32_4x4x4_16b_bf16 v[88:91], v[12:13], v[84:85], 0
    s_nop 1
    v_mfma_f32_4x4x4_16b_bf16 v[88:91], v[10:11], v[86:87], v[88:91]
    s_nop 4
    v_cvt_pk_bf16_f32 v88, v88, v89
    v_cvt_pk_bf16_f32 v89, v90, v91
    ds_pk_add_bf16 v7, v88 offset:65408
    ds_pk_add_bf16 v7, v89 offset:65412
    s_mov_b64 exec, s[50:51]
    s_branch L2_d119
L2_c120:
    s_lshl_b64 s[52:53], s[82:83], 1
    s_andn2_b64 s[52:53], s[52:53], s[80:81]
    s_andn2_b64 s[52:53], s[52:53], s[54:55]
    s_or_b64 s[80:81], s[80:81], s[52:53]
    s_not_b64 vcc, s[52:53]
    s_mov_b64 exec, -1
    v_cndmask_b32_dpp v84, v84, v84, vcc wave_shr:1 row_mask:0xf bank_mask:0xf
    v_cndmask_b32_dpp v85, v85, v85, vcc wave_shr:1 row_mask:0xf bank_mask:0xf
    s_lshr_b64 s[52:53], s[52:53], 1
    v_cndmask_b32_dpp v86, v86, v86, vcc wave_shr:1 row_mask:0xf bank_mask:0xf
    v_cndmask_b32_dpp v87, v87, v87, vcc wave_shr:1 row_mask:0xf bank_mask:0xf
    s_andn2_b64 s[82:83], s[82:83], s[52:53]
    v_cndmask_b32_dpp v7, v7, v7, vcc wave_shr:1 row_mask:0xf bank_mask:0xf
    s_mov_b64 exec, s[54:55]
    s_cbranch_scc0 L2_d120
    s_mov_b64 exec, s[82:83]
    s_nop 1
    v_mfma_f32_4x4x4_16b_bf16 v[88:91], v[12:13], v[84:85], 0
    s_nop 1
    v_mfma_f32_4x4x4_16b_bf16 v[88:91], v[10:11], v[86:87], v[88:91]
    s_nop 4
    v_cvt_pk_bf16_f32 v88, v88, v89
    v_cvt_pk_bf16_f32 v89, v90, v91
    ds_pk_add_bf16 v7, v88 offset:65408
    ds_pk_add_bf16 v7, v89 offset:65412
    s_mov_b64 exec, s[54:55]
    s_branch L2_d120
L2_c121:
    s_lshl_b64 s[52:53], s[82:83], 1
    s_andn2_b64 s[52:53], s[52:53], s[80:81]
    s_andn2_b64 s[52:53], s[52:53], s[50:51]
    s_or_b64 s[80:81], s[80:81], s[52:53]
    s_not_b64 vcc, s[52:53]
    s_mov_b64 exec, -1
    v_cndmask_b32_dpp v84, v84, v84, vcc wave_shr:1 row_mask:0xf bank_mask:0xf
    v_cndmask_b32_dpp v85, v85, v85, vcc wave_shr:1 row_mask:0xf bank_mask:0xf
    s_lshr_b64 s[52:53], s[52:53], 1
    v_cndmask_b32_dpp v86, v86, v86, vcc wave_shr:1 row_mask:0xf bank_mask:0xf
    v_cndmask_b32_dpp v87, v87, v87, vcc wave_shr:1 row_mask:0xf bank_mask:0xf
    s_andn2_b64 s[82:83], s[82:83], s[52:53]
    v_cndmask_b32_dpp v7, v7, v7, vcc wave_shr:1 row_mask:0xf bank_mask:0xf
    s_mov_b64 exec, s[50:51]
    s_cbranch_scc0 L2_d121
    s_mov_b64 exec, s[82:83]
    s_nop 1
    v_mfma_f32_4x4x4_16b_bf16 v[88:91], v[12:13], v[84:85], 0
    s_nop 1
    v_mfma_f32_4x4x4_16b_bf16 v[88:91], v[10:11], v[86:87], v[88:91]
    s_nop 4
    v_cvt_pk_bf16_f32 v88, v88, v89
    v_cvt_pk_bf16_f32 v89, v90, v91
    ds_pk_add_bf16 v7, v88 offset:65408
    ds_pk_add_bf16 v7, v89 offset:65412
    s_mov_b64 exec, s[50:51]
    s_branch L2_d121
L2_c122:
    s_lshl_b64 s[52:53], s[82:83], 1
    s_andn2_b64 s[52:53], s[52:53], s[80:81]
    s_andn2_b64 s[52:53], s[52:53], s[54:55]
    s_or_b64 s[80:81], s[80:81], s[52:53]
    s_not_b64 vcc, s[52:53]
    s_mov_b64 exec, -1
    v_cndmask_b32_dpp v84, v84, v84, vcc wave_shr:1 row_mask:0xf bank_mask:0xf
    v_cndmask_b32_dpp v85, v85, v85, vcc wave_shr:1 row_mask:0xf bank_mask:0xf
    s_lshr_b64 s[52:53], s[52:53], 1
    v_cndmask_b32_dpp v86, v86, v86, vcc wave_shr:1 row_mask:0xf bank_mask:0xf
    v_cndmask_b32_dpp v87, v87, v87, vcc wave_shr:1 row_mask:0xf bank_mask:0xf
    s_andn2_b64 s[82:83], s[82:83], s[52:53]
    v_cndmask_b32_dpp v7, v7, v7, vcc wave_shr:1 row_mask:0xf bank_mask:0xf
    s_mov_b64 exec, s[54:55]
    s_cbranch_scc0 L2_d122
    s_mov_b64 exec, s[82:83]
    s_nop 1
    v_mfma_f32_4x4x4_16b_bf16 v[88:91], v[12:13], v[84:85], 0
    s_nop 1
    v_mfma_f32_4x4x4_16b_bf16 v[88:91], v[10:11], v[86:87], v[88:91]
    s_nop 4
    v_cvt_pk_bf16_f32 v88, v88, v89
    v_cvt_pk_bf16_f32 v89, v90, v91
    ds_pk_add_bf16 v7, v88 offset:65408
    ds_pk_add_bf16 v7, v89 offset:65412
    s_mov_b64 exec, s[54:55]
    s_branch L2_d122
L2_c123:
    s_lshl_b64 s[52:53], s[82:83], 1
    s_andn2_b64 s[52:53], s[52:53], s[80:81]
    s_andn2_b64 s[52:53], s[52:53], s[50:51]
    s_or_b64 s[80:81], s[80:81], s[52:53]
    s_not_b64 vcc, s[52:53]
    s_mov_b64 exec, -1
    v_cndmask_b32_dpp v84, v84, v84, vcc wave_shr:1 row_mask:0xf bank_mask:0xf
    v_cndmask_b32_dpp v85, v85, v85, vcc wave_shr:1 row_mask:0xf bank_mask:0xf
    s_lshr_b64 s[52:53], s[52:53], 1
    v_cndmask_b32_dpp v86, v86, v86, vcc wave_shr:1 row_mask:0xf bank_mask:0xf
    v_cndmask_b32_dpp v87, v87, v87, vcc wave_shr:1 row_mask:0xf bank_mask:0xf
    s_andn2_b64 s[82:83], s[82:83], s[52:53]
    v_cndmask_b32_dpp v7, v7, v7, vcc wave_shr:1 row_mask:0xf bank_mask:0xf
    s_mov_b64 exec, s[50:51]
    s_cbranch_scc0 L2_d123
    s_mov_b64 exec, s[82:83]
    s_nop 1
    v_mfma_f32_4x4x4_16b_bf16 v[88:91], v[12:13], v[84:85], 0
    s_nop 1
    v_mfma_f32_4x4x4_16b_bf16 v[88:91], v[10:11], v[86:87], v[88:91]
    s_nop 4
    v_cvt_pk_bf16_f32 v88, v88, v89
    v_cvt_pk_bf16_f32 v89, v90, v91
    ds_pk_add_bf16 v7, v88 offset:65408
    ds_pk_add_bf16 v7, v89 offset:65412
    s_mov_b64 exec, s[50:51]
    s_branch L2_d123
L2_c124:
    s_lshl_b64 s[52:53], s[82:83], 1
    s_andn2_b64 s[52:53], s[52:53], s[80:81]
    s_andn2_b64 s[52:53], s[52:53], s[54:55]
    s_or_b64 s[80:81], s[80:81], s[52:53]
    s_not_b64 vcc, s[52:53]
    s_mov_b64 exec, -1
    v_cndmask_b32_dpp v84, v84, v84, vcc wave_shr:1 row_mask:0xf bank_mask:0xf
    v_cndmask_b32_dpp v85, v85, v85, vcc wave_shr:1 row_mask:0xf bank_mask:0xf
    s_lshr_b64 s[52:53], s[52:53], 1
    v_cndmask_b32_dpp v86, v86, v86, vcc wave_shr:1 row_mask:0xf bank_mask:0xf
    v_cndmask_b32_dpp v87, v87, v87, vcc wave_shr:1 row_mask:0xf bank_mask:0xf
    s_andn2_b64 s[82:83], s[82:83], s[52:53]
    v_cndmask_b32_dpp v7, v7, v7, vcc wave_shr:1 row_mask:0xf bank_mask:0xf
    s_mov_b64 exec, s[54:55]
    s_cbranch_scc0 L2_d124
    s_mov_b64 exec, s[82:83]
    s_nop 1
    v_mfma_f32_4x4x4_16b_bf16 v[88:91], v[12:13], v[84:85], 0
    s_nop 1
    v_mfma_f32_4x4x4_16b_bf16 v[88:91], v[10:11], v[86:87], v[88:91]
    s_nop 4
    v_cvt_pk_bf16_f32 v88, v88, v89
    v_cvt_pk_bf16_f32 v89, v90, v91
    ds_pk_add_bf16 v7, v88 offset:65408
    ds_pk_add_bf16 v7, v89 offset:65412
    s_mov_b64 exec, s[54:55]
    s_branch L2_d124
L2_c125:
    s_lshl_b64 s[52:53], s[82:83], 1
    s_andn2_b64 s[52:53], s[52:53], s[80:81]
    s_andn2_b64 s[52:53], s[52:53], s[50:51]
    s_or_b64 s[80:81], s[80:81], s[52:53]
    s_not_b64 vcc, s[52:53]
    s_mov_b64 exec, -1
    v_cndmask_b32_dpp v84, v84, v84, vcc wave_shr:1 row_mask:0xf bank_mask:0xf
    v_cndmask_b32_dpp v85, v85, v85, vcc wave_shr:1 row_mask:0xf bank_mask:0xf
    s_lshr_b64 s[52:53], s[52:53], 1
    v_cndmask_b32_dpp v86, v86, v86, vcc wave_shr:1 row_mask:0xf bank_mask:0xf
    v_cndmask_b32_dpp v87, v87, v87, vcc wave_shr:1 row_mask:0xf bank_mask:0xf
    s_andn2_b64 s[82:83], s[82:83], s[52:53]
    v_cndmask_b32_dpp v7, v7, v7, vcc wave_shr:1 row_mask:0xf bank_mask:0xf
    s_mov_b64 exec, s[50:51]
    s_cbranch_scc0 L2_d125
    s_mov_b64 exec, s[82:83]
    s_nop 1
    v_mfma_f32_4x4x4_16b_bf16 v[88:91], v[12:13], v[84:85], 0
    s_nop 1
    v_mfma_f32_4x4x4_16b_bf16 v[88:91], v[10:11], v[86:87], v[88:91]
    s_nop 4
    v_cvt_pk_bf16_f32 v88, v88, v89
    v_cvt_pk_bf16_f32 v89, v90, v91
    ds_pk_add_bf16 v7, v88 offset:65408
    ds_pk_add_bf16 v7, v89 offset:65412
    s_mov_b64 exec, s[50:51]
    s_branch L2_d125
L2_c126:
    s_lshl_b64 s[52:53], s[82:83], 1
    s_andn2_b64 s[52:53], s[52:53], s[80:81]
    s_andn2_b64 s[52:53], s[52:53], s[54:55]
    s_or_b64 s[80:81], s[80:81], s[52:53]
    s_not_b64 vcc, s[52:53]
    s_mov_b64 exec, -1
    v_cndmask_b32_dpp v84, v84, v84, vcc wave_shr:1 row_mask:0xf bank_mask:0xf
    v_cndmask_b32_dpp v85, v85, v85, vcc wave_shr:1 row_mask:0xf bank_mask:0xf
    s_lshr_b64 s[52:53], s[52:53], 1
    v_cndmask_b32_dpp v86, v86, v86, vcc wave_shr:1 row_mask:0xf bank_mask:0xf
    v_cndmask_b32_dpp v87, v87, v87, vcc wave_shr:1 row_mask:0xf bank_mask:0xf
    s_andn2_b64 s[82:83], s[82:83], s[52:53]
    v_cndmask_b32_dpp v7, v7, v7, vcc wave_shr:1 row_mask:0xf bank_mask:0xf
    s_mov_b64 exec, s[54:55]
    s_cbranch_scc0 L2_d126
    s_mov_b64 exec, s[82:83]
    s_nop 1
    v_mfma_f32_4x4x4_16b_bf16 v[88:91], v[12:13], v[84:85], 0
    s_nop 1
    v_mfma_f32_4x4x4_16b_bf16 v[88:91], v[10:11], v[86:87], v[88:91]
    s_nop 4
    v_cvt_pk_bf16_f32 v88, v88, v89
    v_cvt_pk_bf16_f32 v89, v90, v91
    ds_pk_add_bf16 v7, v88 offset:65408
    ds_pk_add_bf16 v7, v89 offset:65412
    s_mov_b64 exec, s[54:55]
    s_branch L2_d126
L2_c127:
    s_lshl_b64 s[52:53], s[82:83], 1
    s_andn2_b64 s[52:53], s[52:53], s[80:81]
    s_andn2_b64 s[52:53], s[52:53], s[50:51]
    s_or_b64 s[80:81], s[80:81], s[52:53]
    s_not_b64 vcc, s[52:53]
    s_mov_b64 exec, -1
    v_cndmask_b32_dpp v84, v84, v84, vcc wave_shr:1 row_mask:0xf bank_mask:0xf
    v_cndmask_b32_dpp v85, v85, v85, vcc wave_shr:1 row_mask:0xf bank_mask:0xf
    s_lshr_b64 s[52:53], s[52:53], 1
    v_cndmask_b32_dpp v86, v86, v86, vcc wave_shr:1 row_mask:0xf bank_mask:0xf
    v_cndmask_b32_dpp v87, v87, v87, vcc wave_shr:1 row_mask:0xf bank_mask:0xf
    s_andn2_b64 s[82:83], s[82:83], s[52:53]
    v_cndmask_b32_dpp v7, v7, v7, vcc wave_shr:1 row_mask:0xf bank_mask:0xf
    s_mov_b64 exec, s[50:51]
    s_cbranch_scc0 L2_d127
    s_mov_b64 exec, s[82:83]
    s_nop 1
    v_mfma_f32_4x4x4_16b_bf16 v[88:91], v[12:13], v[84:85], 0
    s_nop 1
    v_mfma_f32_4x4x4_16b_bf16 v[88:91], v[10:11], v[86:87], v[88:91]
    s_nop 4
    v_cvt_pk_bf16_f32 v88, v88, v89
    v_cvt_pk_bf16_f32 v89, v90, v91
    ds_pk_add_bf16 v7, v88 offset:65408
    ds_pk_add_bf16 v7, v89 offset:65412
    s_mov_b64 exec, s[50:51]
    s_branch L2_d127
L2_c128:
    s_lshl_b64 s[52:53], s[82:83], 1
    s_andn2_b64 s[52:53], s[52:53], s[80:81]
    s_andn2_b64 s[52:53], s[52:53], s[54:55]
    s_or_b64 s[80:81], s[80:81], s[52:53]
    s_not_b64 vcc, s[52:53]
    s_mov_b64 exec, -1
    v_cndmask_b32_dpp v84, v84, v84, vcc wave_shr:1 row_mask:0xf bank_mask:0xf
    v_cndmask_b32_dpp v85, v85, v85, vcc wave_shr:1 row_mask:0xf bank_mask:0xf
    s_lshr_b64 s[52:53], s[52:53], 1
    v_cndmask_b32_dpp v86, v86, v86, vcc wave_shr:1 row_mask:0xf bank_mask:0xf
    v_cndmask_b32_dpp v87, v87, v87, vcc wave_shr:1 row_mask:0xf bank_mask:0xf
    s_andn2_b64 s[82:83], s[82:83], s[52:53]
    v_cndmask_b32_dpp v7, v7, v7, vcc wave_shr:1 row_mask:0xf bank_mask:0xf
    s_mov_b64 exec, s[54:55]
    s_cbranch_scc0 L2_d128
    s_mov_b64 exec, s[82:83]
    s_nop 1
    v_mfma_f32_4x4x4_16b_bf16 v[88:91], v[12:13], v[84:85], 0
    s_nop 1
    v_mfma_f32_4x4x4_16b_bf16 v[88:91], v[10:11], v[86:87], v[88:91]
    s_nop 4
    v_cvt_pk_bf16_f32 v88, v88, v89
    v_cvt_pk_bf16_f32 v89, v90, v91
    ds_pk_add_bf16 v7, v88 offset:65408
    ds_pk_add_bf16 v7, v89 offset:65412
    s_mov_b64 exec, s[54:55]
    s_branch L2_d128
L2_c129:
    s_lshl_b64 s[52:53], s[82:83], 1
    s_andn2_b64 s[52:53], s[52:53], s[80:81]
    s_andn2_b64 s[52:53], s[52:53], s[50:51]
    s_or_b64 s[80:81], s[80:81], s[52:53]
    s_not_b64 vcc, s[52:53]
    s_mov_b64 exec, -1
    v_cndmask_b32_dpp v84, v84, v84, vcc wave_shr:1 row_mask:0xf bank_mask:0xf
    v_cndmask_b32_dpp v85, v85, v85, vcc wave_shr:1 row_mask:0xf bank_mask:0xf
    s_lshr_b64 s[52:53], s[52:53], 1
    v_cndmask_b32_dpp v86, v86, v86, vcc wave_shr:1 row_mask:0xf bank_mask:0xf
    v_cndmask_b32_dpp v87, v87, v87, vcc wave_shr:1 row_mask:0xf bank_mask:0xf
    s_andn2_b64 s[82:83], s[82:83], s[52:53]
    v_cndmask_b32_dpp v7, v7, v7, vcc wave_shr:1 row_mask:0xf bank_mask:0xf
    s_mov_b64 exec, s[50:51]
    s_cbranch_scc0 L2_d129
    s_mov_b64 exec, s[82:83]
    s_nop 1
    v_mfma_f32_4x4x4_16b_bf16 v[88:91], v[12:13], v[84:85], 0
    s_nop 1
    v_mfma_f32_4x4x4_16b_bf16 v[88:91], v[10:11], v[86:87], v[88:91]
    s_nop 4
    v_cvt_pk_bf16_f32 v88, v88, v89
    v_cvt_pk_bf16_f32 v89, v90, v91
    ds_pk_add_bf16 v7, v88 offset:65408
    ds_pk_add_bf16 v7, v89 offset:65412
    s_mov_b64 exec, s[50:51]
    s_branch L2_d129
L2_c130:
    s_lshl_b64 s[52:53], s[82:83], 1
    s_andn2_b64 s[52:53], s[52:53], s[80:81]
    s_andn2_b64 s[52:53], s[52:53], s[54:55]
    s_or_b64 s[80:81], s[80:81], s[52:53]
    s_not_b64 vcc, s[52:53]
    s_mov_b64 exec, -1
    v_cndmask_b32_dpp v84, v84, v84, vcc wave_shr:1 row_mask:0xf bank_mask:0xf
    v_cndmask_b32_dpp v85, v85, v85, vcc wave_shr:1 row_mask:0xf bank_mask:0xf
    s_lshr_b64 s[52:53], s[52:53], 1
    v_cndmask_b32_dpp v86, v86, v86, vcc wave_shr:1 row_mask:0xf bank_mask:0xf
    v_cndmask_b32_dpp v87, v87, v87, vcc wave_shr:1 row_mask:0xf bank_mask:0xf
    s_andn2_b64 s[82:83], s[82:83], s[52:53]
    v_cndmask_b32_dpp v7, v7, v7, vcc wave_shr:1 row_mask:0xf bank_mask:0xf
    s_mov_b64 exec, s[54:55]
    s_cbranch_scc0 L2_d130
    s_mov_b64 exec, s[82:83]
    s_nop 1
    v_mfma_f32_4x4x4_16b_bf16 v[88:91], v[12:13], v[84:85], 0
    s_nop 1
    v_mfma_f32_4x4x4_16b_bf16 v[88:91], v[10:11], v[86:87], v[88:91]
    s_nop 4
    v_cvt_pk_bf16_f32 v88, v88, v89
    v_cvt_pk_bf16_f32 v89, v90, v91
    ds_pk_add_bf16 v7, v88 offset:65408
    ds_pk_add_bf16 v7, v89 offset:65412
    s_mov_b64 exec, s[54:55]
    s_branch L2_d130
L2_c131:
    s_lshl_b64 s[52:53], s[82:83], 1
    s_andn2_b64 s[52:53], s[52:53], s[80:81]
    s_andn2_b64 s[52:53], s[52:53], s[50:51]
    s_or_b64 s[80:81], s[80:81], s[52:53]
    s_not_b64 vcc, s[52:53]
    s_mov_b64 exec, -1
    v_cndmask_b32_dpp v84, v84, v84, vcc wave_shr:1 row_mask:0xf bank_mask:0xf
    v_cndmask_b32_dpp v85, v85, v85, vcc wave_shr:1 row_mask:0xf bank_mask:0xf
    s_lshr_b64 s[52:53], s[52:53], 1
    v_cndmask_b32_dpp v86, v86, v86, vcc wave_shr:1 row_mask:0xf bank_mask:0xf
    v_cndmask_b32_dpp v87, v87, v87, vcc wave_shr:1 row_mask:0xf bank_mask:0xf
    s_andn2_b64 s[82:83], s[82:83], s[52:53]
    v_cndmask_b32_dpp v7, v7, v7, vcc wave_shr:1 row_mask:0xf bank_mask:0xf
    s_mov_b64 exec, s[50:51]
    s_cbranch_scc0 L2_d131
    s_mov_b64 exec, s[82:83]
    s_nop 1
    v_mfma_f32_4x4x4_16b_bf16 v[88:91], v[12:13], v[84:85], 0
    s_nop 1
    v_mfma_f32_4x4x4_16b_bf16 v[88:91], v[10:11], v[86:87], v[88:91]
    s_nop 4
    v_cvt_pk_bf16_f32 v88, v88, v89
    v_cvt_pk_bf16_f32 v89, v90, v91
    ds_pk_add_bf16 v7, v88 offset:65408
    ds_pk_add_bf16 v7, v89 offset:65412
    s_mov_b64 exec, s[50:51]
    s_branch L2_d131
L2_c132:
    s_lshl_b64 s[52:53], s[82:83], 1
    s_andn2_b64 s[52:53], s[52:53], s[80:81]
    s_andn2_b64 s[52:53], s[52:53], s[54:55]
    s_or_b64 s[80:81], s[80:81], s[52:53]
    s_not_b64 vcc, s[52:53]
    s_mov_b64 exec, -1
    v_cndmask_b32_dpp v84, v84, v84, vcc wave_shr:1 row_mask:0xf bank_mask:0xf
    v_cndmask_b32_dpp v85, v85, v85, vcc wave_shr:1 row_mask:0xf bank_mask:0xf
    s_lshr_b64 s[52:53], s[52:53], 1
    v_cndmask_b32_dpp v86, v86, v86, vcc wave_shr:1 row_mask:0xf bank_mask:0xf
    v_cndmask_b32_dpp v87, v87, v87, vcc wave_shr:1 row_mask:0xf bank_mask:0xf
    s_andn2_b64 s[82:83], s[82:83], s[52:53]
    v_cndmask_b32_dpp v7, v7, v7, vcc wave_shr:1 row_mask:0xf bank_mask:0xf
    s_mov_b64 exec, s[54:55]
    s_cbranch_scc0 L2_d132
    s_mov_b64 exec, s[82:83]
    s_nop 1
    v_mfma_f32_4x4x4_16b_bf16 v[88:91], v[12:13], v[84:85], 0
    s_nop 1
    v_mfma_f32_4x4x4_16b_bf16 v[88:91], v[10:11], v[86:87], v[88:91]
    s_nop 4
    v_cvt_pk_bf16_f32 v88, v88, v89
    v_cvt_pk_bf16_f32 v89, v90, v91
    ds_pk_add_bf16 v7, v88 offset:65408
    ds_pk_add_bf16 v7, v89 offset:65412
    s_mov_b64 exec, s[54:55]
    s_branch L2_d132
L2_c133:
    s_lshl_b64 s[52:53], s[82:83], 1
    s_andn2_b64 s[52:53], s[52:53], s[80:81]
    s_andn2_b64 s[52:53], s[52:53], s[50:51]
    s_or_b64 s[80:81], s[80:81], s[52:53]
    s_not_b64 vcc, s[52:53]
    s_mov_b64 exec, -1
    v_cndmask_b32_dpp v84, v84, v84, vcc wave_shr:1 row_mask:0xf bank_mask:0xf
    v_cndmask_b32_dpp v85, v85, v85, vcc wave_shr:1 row_mask:0xf bank_mask:0xf
    s_lshr_b64 s[52:53], s[52:53], 1
    v_cndmask_b32_dpp v86, v86, v86, vcc wave_shr:1 row_mask:0xf bank_mask:0xf
    v_cndmask_b32_dpp v87, v87, v87, vcc wave_shr:1 row_mask:0xf bank_mask:0xf
    s_andn2_b64 s[82:83], s[82:83], s[52:53]
    v_cndmask_b32_dpp v7, v7, v7, vcc wave_shr:1 row_mask:0xf bank_mask:0xf
    s_mov_b64 exec, s[50:51]
    s_cbranch_scc0 L2_d133
    s_mov_b64 exec, s[82:83]
    s_nop 1
    v_mfma_f32_4x4x4_16b_bf16 v[88:91], v[12:13], v[84:85], 0
    s_nop 1
    v_mfma_f32_4x4x4_16b_bf16 v[88:91], v[10:11], v[86:87], v[88:91]
    s_nop 4
    v_cvt_pk_bf16_f32 v88, v88, v89
    v_cvt_pk_bf16_f32 v89, v90, v91
    ds_pk_add_bf16 v7, v88 offset:65408
    ds_pk_add_bf16 v7, v89 offset:65412
    s_mov_b64 exec, s[50:51]
    s_branch L2_d133
L2_c134:
    s_lshl_b64 s[52:53], s[82:83], 1
    s_andn2_b64 s[52:53], s[52:53], s[80:81]
    s_andn2_b64 s[52:53], s[52:53], s[54:55]
    s_or_b64 s[80:81], s[80:81], s[52:53]
    s_not_b64 vcc, s[52:53]
    s_mov_b64 exec, -1
    v_cndmask_b32_dpp v84, v84, v84, vcc wave_shr:1 row_mask:0xf bank_mask:0xf
    v_cndmask_b32_dpp v85, v85, v85, vcc wave_shr:1 row_mask:0xf bank_mask:0xf
    s_lshr_b64 s[52:53], s[52:53], 1
    v_cndmask_b32_dpp v86, v86, v86, vcc wave_shr:1 row_mask:0xf bank_mask:0xf
    v_cndmask_b32_dpp v87, v87, v87, vcc wave_shr:1 row_mask:0xf bank_mask:0xf
    s_andn2_b64 s[82:83], s[82:83], s[52:53]
    v_cndmask_b32_dpp v7, v7, v7, vcc wave_shr:1 row_mask:0xf bank_mask:0xf
    s_mov_b64 exec, s[54:55]
    s_cbranch_scc0 L2_d134
    s_mov_b64 exec, s[82:83]
    s_nop 1
    v_mfma_f32_4x4x4_16b_bf16 v[88:91], v[12:13], v[84:85], 0
    s_nop 1
    v_mfma_f32_4x4x4_16b_bf16 v[88:91], v[10:11], v[86:87], v[88:91]
    s_nop 4
    v_cvt_pk_bf16_f32 v88, v88, v89
    v_cvt_pk_bf16_f32 v89, v90, v91
    ds_pk_add_bf16 v7, v88 offset:65408
    ds_pk_add_bf16 v7, v89 offset:65412
    s_mov_b64 exec, s[54:55]
    s_branch L2_d134
L2_c135:
    s_lshl_b64 s[52:53], s[82:83], 1
    s_andn2_b64 s[52:53], s[52:53], s[80:81]
    s_andn2_b64 s[52:53], s[52:53], s[50:51]
    s_or_b64 s[80:81], s[80:81], s[52:53]
    s_not_b64 vcc, s[52:53]
    s_mov_b64 exec, -1
    v_cndmask_b32_dpp v84, v84, v84, vcc wave_shr:1 row_mask:0xf bank_mask:0xf
    v_cndmask_b32_dpp v85, v85, v85, vcc wave_shr:1 row_mask:0xf bank_mask:0xf
    s_lshr_b64 s[52:53], s[52:53], 1
    v_cndmask_b32_dpp v86, v86, v86, vcc wave_shr:1 row_mask:0xf bank_mask:0xf
    v_cndmask_b32_dpp v87, v87, v87, vcc wave_shr:1 row_mask:0xf bank_mask:0xf
    s_andn2_b64 s[82:83], s[82:83], s[52:53]
    v_cndmask_b32_dpp v7, v7, v7, vcc wave_shr:1 row_mask:0xf bank_mask:0xf
    s_mov_b64 exec, s[50:51]
    s_cbranch_scc0 L2_d135
    s_mov_b64 exec, s[82:83]
    s_nop 1
    v_mfma_f32_4x4x4_16b_bf16 v[88:91], v[12:13], v[84:85], 0
    s_nop 1
    v_mfma_f32_4x4x4_16b_bf16 v[88:91], v[10:11], v[86:87], v[88:91]
    s_nop 4
    v_cvt_pk_bf16_f32 v88, v88, v89
    v_cvt_pk_bf16_f32 v89, v90, v91
    ds_pk_add_bf16 v7, v88 offset:65408
    ds_pk_add_bf16 v7, v89 offset:65412
    s_mov_b64 exec, s[50:51]
    s_branch L2_d135
L2_c136:
    s_lshl_b64 s[52:53], s[82:83], 1
    s_andn2_b64 s[52:53], s[52:53], s[80:81]
    s_andn2_b64 s[52:53], s[52:53], s[54:55]
    s_or_b64 s[80:81], s[80:81], s[52:53]
    s_not_b64 vcc, s[52:53]
    s_mov_b64 exec, -1
    v_cndmask_b32_dpp v84, v84, v84, vcc wave_shr:1 row_mask:0xf bank_mask:0xf
    v_cndmask_b32_dpp v85, v85, v85, vcc wave_shr:1 row_mask:0xf bank_mask:0xf
    s_lshr_b64 s[52:53], s[52:53], 1
    v_cndmask_b32_dpp v86, v86, v86, vcc wave_shr:1 row_mask:0xf bank_mask:0xf
    v_cndmask_b32_dpp v87, v87, v87, vcc wave_shr:1 row_mask:0xf bank_mask:0xf
    s_andn2_b64 s[82:83], s[82:83], s[52:53]
    v_cndmask_b32_dpp v7, v7, v7, vcc wave_shr:1 row_mask:0xf bank_mask:0xf
    s_mov_b64 exec, s[54:55]
    s_cbranch_scc0 L2_d136
    s_mov_b64 exec, s[82:83]
    s_nop 1
    v_mfma_f32_4x4x4_16b_bf16 v[88:91], v[12:13], v[84:85], 0
    s_nop 1
    v_mfma_f32_4x4x4_16b_bf16 v[88:91], v[10:11], v[86:87], v[88:91]
    s_nop 4
    v_cvt_pk_bf16_f32 v88, v88, v89
    v_cvt_pk_bf16_f32 v89, v90, v91
    ds_pk_add_bf16 v7, v88 offset:65408
    ds_pk_add_bf16 v7, v89 offset:65412
    s_mov_b64 exec, s[54:55]
    s_branch L2_d136
L2_c137:
    s_lshl_b64 s[52:53], s[82:83], 1
    s_andn2_b64 s[52:53], s[52:53], s[80:81]
    s_andn2_b64 s[52:53], s[52:53], s[50:51]
    s_or_b64 s[80:81], s[80:81], s[52:53]
    s_not_b64 vcc, s[52:53]
    s_mov_b64 exec, -1
    v_cndmask_b32_dpp v84, v84, v84, vcc wave_shr:1 row_mask:0xf bank_mask:0xf
    v_cndmask_b32_dpp v85, v85, v85, vcc wave_shr:1 row_mask:0xf bank_mask:0xf
    s_lshr_b64 s[52:53], s[52:53], 1
    v_cndmask_b32_dpp v86, v86, v86, vcc wave_shr:1 row_mask:0xf bank_mask:0xf
    v_cndmask_b32_dpp v87, v87, v87, vcc wave_shr:1 row_mask:0xf bank_mask:0xf
    s_andn2_b64 s[82:83], s[82:83], s[52:53]
    v_cndmask_b32_dpp v7, v7, v7, vcc wave_shr:1 row_mask:0xf bank_mask:0xf
    s_mov_b64 exec, s[50:51]
    s_cbranch_scc0 L2_d137
    s_mov_b64 exec, s[82:83]
    s_nop 1
    v_mfma_f32_4x4x4_16b_bf16 v[88:91], v[12:13], v[84:85], 0
    s_nop 1
    v_mfma_f32_4x4x4_16b_bf16 v[88:91], v[10:11], v[86:87], v[88:91]
    s_nop 4
    v_cvt_pk_bf16_f32 v88, v88, v89
    v_cvt_pk_bf16_f32 v89, v90, v91
    ds_pk_add_bf16 v7, v88 offset:65408
    ds_pk_add_bf16 v7, v89 offset:65412
    s_mov_b64 exec, s[50:51]
    s_branch L2_d137
L2_c138:
    s_lshl_b64 s[52:53], s[82:83], 1
    s_andn2_b64 s[52:53], s[52:53], s[80:81]
    s_andn2_b64 s[52:53], s[52:53], s[54:55]
    s_or_b64 s[80:81], s[80:81], s[52:53]
    s_not_b64 vcc, s[52:53]
    s_mov_b64 exec, -1
    v_cndmask_b32_dpp v84, v84, v84, vcc wave_shr:1 row_mask:0xf bank_mask:0xf
    v_cndmask_b32_dpp v85, v85, v85, vcc wave_shr:1 row_mask:0xf bank_mask:0xf
    s_lshr_b64 s[52:53], s[52:53], 1
    v_cndmask_b32_dpp v86, v86, v86, vcc wave_shr:1 row_mask:0xf bank_mask:0xf
    v_cndmask_b32_dpp v87, v87, v87, vcc wave_shr:1 row_mask:0xf bank_mask:0xf
    s_andn2_b64 s[82:83], s[82:83], s[52:53]
    v_cndmask_b32_dpp v7, v7, v7, vcc wave_shr:1 row_mask:0xf bank_mask:0xf
    s_mov_b64 exec, s[54:55]
    s_cbranch_scc0 L2_d138
    s_mov_b64 exec, s[82:83]
    s_nop 1
    v_mfma_f32_4x4x4_16b_bf16 v[88:91], v[12:13], v[84:85], 0
    s_nop 1
    v_mfma_f32_4x4x4_16b_bf16 v[88:91], v[10:11], v[86:87], v[88:91]
    s_nop 4
    v_cvt_pk_bf16_f32 v88, v88, v89
    v_cvt_pk_bf16_f32 v89, v90, v91
    ds_pk_add_bf16 v7, v88 offset:65408
    ds_pk_add_bf16 v7, v89 offset:65412
    s_mov_b64 exec, s[54:55]
    s_branch L2_d138
L2_c139:
    s_lshl_b64 s[52:53], s[82:83], 1
    s_andn2_b64 s[52:53], s[52:53], s[80:81]
    s_andn2_b64 s[52:53], s[52:53], s[50:51]
    s_or_b64 s[80:81], s[80:81], s[52:53]
    s_not_b64 vcc, s[52:53]
    s_mov_b64 exec, -1
    v_cndmask_b32_dpp v84, v84, v84, vcc wave_shr:1 row_mask:0xf bank_mask:0xf
    v_cndmask_b32_dpp v85, v85, v85, vcc wave_shr:1 row_mask:0xf bank_mask:0xf
    s_lshr_b64 s[52:53], s[52:53], 1
    v_cndmask_b32_dpp v86, v86, v86, vcc wave_shr:1 row_mask:0xf bank_mask:0xf
    v_cndmask_b32_dpp v87, v87, v87, vcc wave_shr:1 row_mask:0xf bank_mask:0xf
    s_andn2_b64 s[82:83], s[82:83], s[52:53]
    v_cndmask_b32_dpp v7, v7, v7, vcc wave_shr:1 row_mask:0xf bank_mask:0xf
    s_mov_b64 exec, s[50:51]
    s_cbranch_scc0 L2_d139
    s_mov_b64 exec, s[82:83]
    s_nop 1
    v_mfma_f32_4x4x4_16b_bf16 v[88:91], v[12:13], v[84:85], 0
    s_nop 1
    v_mfma_f32_4x4x4_16b_bf16 v[88:91], v[10:11], v[86:87], v[88:91]
    s_nop 4
    v_cvt_pk_bf16_f32 v88, v88, v89
    v_cvt_pk_bf16_f32 v89, v90, v91
    ds_pk_add_bf16 v7, v88 offset:65408
    ds_pk_add_bf16 v7, v89 offset:65412
    s_mov_b64 exec, s[50:51]
    s_branch L2_d139
L2_c140:
    s_lshl_b64 s[52:53], s[82:83], 1
    s_andn2_b64 s[52:53], s[52:53], s[80:81]
    s_andn2_b64 s[52:53], s[52:53], s[54:55]
    s_or_b64 s[80:81], s[80:81], s[52:53]
    s_not_b64 vcc, s[52:53]
    s_mov_b64 exec, -1
    v_cndmask_b32_dpp v84, v84, v84, vcc wave_shr:1 row_mask:0xf bank_mask:0xf
    v_cndmask_b32_dpp v85, v85, v85, vcc wave_shr:1 row_mask:0xf bank_mask:0xf
    s_lshr_b64 s[52:53], s[52:53], 1
    v_cndmask_b32_dpp v86, v86, v86, vcc wave_shr:1 row_mask:0xf bank_mask:0xf
    v_cndmask_b32_dpp v87, v87, v87, vcc wave_shr:1 row_mask:0xf bank_mask:0xf
    s_andn2_b64 s[82:83], s[82:83], s[52:53]
    v_cndmask_b32_dpp v7, v7, v7, vcc wave_shr:1 row_mask:0xf bank_mask:0xf
    s_mov_b64 exec, s[54:55]
    s_cbranch_scc0 L2_d140
    s_mov_b64 exec, s[82:83]
    s_nop 1
    v_mfma_f32_4x4x4_16b_bf16 v[88:91], v[12:13], v[84:85], 0
    s_nop 1
    v_mfma_f32_4x4x4_16b_bf16 v[88:91], v[10:11], v[86:87], v[88:91]
    s_nop 4
    v_cvt_pk_bf16_f32 v88, v88, v89
    v_cvt_pk_bf16_f32 v89, v90, v91
    ds_pk_add_bf16 v7, v88 offset:65408
    ds_pk_add_bf16 v7, v89 offset:65412
    s_mov_b64 exec, s[54:55]
    s_branch L2_d140
L2_c141:
    s_lshl_b64 s[52:53], s[82:83], 1
    s_andn2_b64 s[52:53], s[52:53], s[80:81]
    s_andn2_b64 s[52:53], s[52:53], s[50:51]
    s_or_b64 s[80:81], s[80:81], s[52:53]
    s_not_b64 vcc, s[52:53]
    s_mov_b64 exec, -1
    v_cndmask_b32_dpp v84, v84, v84, vcc wave_shr:1 row_mask:0xf bank_mask:0xf
    v_cndmask_b32_dpp v85, v85, v85, vcc wave_shr:1 row_mask:0xf bank_mask:0xf
    s_lshr_b64 s[52:53], s[52:53], 1
    v_cndmask_b32_dpp v86, v86, v86, vcc wave_shr:1 row_mask:0xf bank_mask:0xf
    v_cndmask_b32_dpp v87, v87, v87, vcc wave_shr:1 row_mask:0xf bank_mask:0xf
    s_andn2_b64 s[82:83], s[82:83], s[52:53]
    v_cndmask_b32_dpp v7, v7, v7, vcc wave_shr:1 row_mask:0xf bank_mask:0xf
    s_mov_b64 exec, s[50:51]
    s_cbranch_scc0 L2_d141
    s_mov_b64 exec, s[82:83]
    s_nop 1
    v_mfma_f32_4x4x4_16b_bf16 v[88:91], v[12:13], v[84:85], 0
    s_nop 1
    v_mfma_f32_4x4x4_16b_bf16 v[88:91], v[10:11], v[86:87], v[88:91]
    s_nop 4
    v_cvt_pk_bf16_f32 v88, v88, v89
    v_cvt_pk_bf16_f32 v89, v90, v91
    ds_pk_add_bf16 v7, v88 offset:65408
    ds_pk_add_bf16 v7, v89 offset:65412
    s_mov_b64 exec, s[50:51]
    s_branch L2_d141
L2_c142:
    s_lshl_b64 s[52:53], s[82:83], 1
    s_andn2_b64 s[52:53], s[52:53], s[80:81]
    s_andn2_b64 s[52:53], s[52:53], s[54:55]
    s_or_b64 s[80:81], s[80:81], s[52:53]
    s_not_b64 vcc, s[52:53]
    s_mov_b64 exec, -1
    v_cndmask_b32_dpp v84, v84, v84, vcc wave_shr:1 row_mask:0xf bank_mask:0xf
    v_cndmask_b32_dpp v85, v85, v85, vcc wave_shr:1 row_mask:0xf bank_mask:0xf
    s_lshr_b64 s[52:53], s[52:53], 1
    v_cndmask_b32_dpp v86, v86, v86, vcc wave_shr:1 row_mask:0xf bank_mask:0xf
    v_cndmask_b32_dpp v87, v87, v87, vcc wave_shr:1 row_mask:0xf bank_mask:0xf
    s_andn2_b64 s[82:83], s[82:83], s[52:53]
    v_cndmask_b32_dpp v7, v7, v7, vcc wave_shr:1 row_mask:0xf bank_mask:0xf
    s_mov_b64 exec, s[54:55]
    s_cbranch_scc0 L2_d142
    s_mov_b64 exec, s[82:83]
    s_nop 1
    v_mfma_f32_4x4x4_16b_bf16 v[88:91], v[12:13], v[84:85], 0
    s_nop 1
    v_mfma_f32_4x4x4_16b_bf16 v[88:91], v[10:11], v[86:87], v[88:91]
    s_nop 4
    v_cvt_pk_bf16_f32 v88, v88, v89
    v_cvt_pk_bf16_f32 v89, v90, v91
    ds_pk_add_bf16 v7, v88 offset:65408
    ds_pk_add_bf16 v7, v89 offset:65412
    s_mov_b64 exec, s[54:55]
    s_branch L2_d142
L2_c143:
    s_lshl_b64 s[52:53], s[82:83], 1
    s_andn2_b64 s[52:53], s[52:53], s[80:81]
    s_andn2_b64 s[52:53], s[52:53], s[50:51]
    s_or_b64 s[80:81], s[80:81], s[52:53]
    s_not_b64 vcc, s[52:53]
    s_mov_b64 exec, -1
    v_cndmask_b32_dpp v84, v84, v84, vcc wave_shr:1 row_mask:0xf bank_mask:0xf
    v_cndmask_b32_dpp v85, v85, v85, vcc wave_shr:1 row_mask:0xf bank_mask:0xf
    s_lshr_b64 s[52:53], s[52:53], 1
    v_cndmask_b32_dpp v86, v86, v86, vcc wave_shr:1 row_mask:0xf bank_mask:0xf
    v_cndmask_b32_dpp v87, v87, v87, vcc wave_shr:1 row_mask:0xf bank_mask:0xf
    s_andn2_b64 s[82:83], s[82:83], s[52:53]
    v_cndmask_b32_dpp v7, v7, v7, vcc wave_shr:1 row_mask:0xf bank_mask:0xf
    s_mov_b64 exec, s[50:51]
    s_cbranch_scc0 L2_d143
    s_mov_b64 exec, s[82:83]
    s_nop 1
    v_mfma_f32_4x4x4_16b_bf16 v[88:91], v[12:13], v[84:85], 0
    s_nop 1
    v_mfma_f32_4x4x4_16b_bf16 v[88:91], v[10:11], v[86:87], v[88:91]
    s_nop 4
    v_cvt_pk_bf16_f32 v88, v88, v89
    v_cvt_pk_bf16_f32 v89, v90, v91
    ds_pk_add_bf16 v7, v88 offset:65408
    ds_pk_add_bf16 v7, v89 offset:65412
    s_mov_b64 exec, s[50:51]
    s_branch L2_d143
L2_c144:
    s_lshl_b64 s[52:53], s[82:83], 1
    s_andn2_b64 s[52:53], s[52:53], s[80:81]
    s_andn2_b64 s[52:53], s[52:53], s[54:55]
    s_or_b64 s[80:81], s[80:81], s[52:53]
    s_not_b64 vcc, s[52:53]
    s_mov_b64 exec, -1
    v_cndmask_b32_dpp v84, v84, v84, vcc wave_shr:1 row_mask:0xf bank_mask:0xf
    v_cndmask_b32_dpp v85, v85, v85, vcc wave_shr:1 row_mask:0xf bank_mask:0xf
    s_lshr_b64 s[52:53], s[52:53], 1
    v_cndmask_b32_dpp v86, v86, v86, vcc wave_shr:1 row_mask:0xf bank_mask:0xf
    v_cndmask_b32_dpp v87, v87, v87, vcc wave_shr:1 row_mask:0xf bank_mask:0xf
    s_andn2_b64 s[82:83], s[82:83], s[52:53]
    v_cndmask_b32_dpp v7, v7, v7, vcc wave_shr:1 row_mask:0xf bank_mask:0xf
    s_mov_b64 exec, s[54:55]
    s_cbranch_scc0 L2_d144
    s_mov_b64 exec, s[82:83]
    s_nop 1
    v_mfma_f32_4x4x4_16b_bf16 v[88:91], v[12:13], v[84:85], 0
    s_nop 1
    v_mfma_f32_4x4x4_16b_bf16 v[88:91], v[10:11], v[86:87], v[88:91]
    s_nop 4
    v_cvt_pk_bf16_f32 v88, v88, v89
    v_cvt_pk_bf16_f32 v89, v90, v91
    ds_pk_add_bf16 v7, v88 offset:65408
    ds_pk_add_bf16 v7, v89 offset:65412
    s_mov_b64 exec, s[54:55]
    s_branch L2_d144
L2_c145:
    s_lshl_b64 s[52:53], s[82:83], 1
    s_andn2_b64 s[52:53], s[52:53], s[80:81]
    s_andn2_b64 s[52:53], s[52:53], s[50:51]
    s_or_b64 s[80:81], s[80:81], s[52:53]
    s_not_b64 vcc, s[52:53]
    s_mov_b64 exec, -1
    v_cndmask_b32_dpp v84, v84, v84, vcc wave_shr:1 row_mask:0xf bank_mask:0xf
    v_cndmask_b32_dpp v85, v85, v85, vcc wave_shr:1 row_mask:0xf bank_mask:0xf
    s_lshr_b64 s[52:53], s[52:53], 1
    v_cndmask_b32_dpp v86, v86, v86, vcc wave_shr:1 row_mask:0xf bank_mask:0xf
    v_cndmask_b32_dpp v87, v87, v87, vcc wave_shr:1 row_mask:0xf bank_mask:0xf
    s_andn2_b64 s[82:83], s[82:83], s[52:53]
    v_cndmask_b32_dpp v7, v7, v7, vcc wave_shr:1 row_mask:0xf bank_mask:0xf
    s_mov_b64 exec, s[50:51]
    s_cbranch_scc0 L2_d145
    s_mov_b64 exec, s[82:83]
    s_nop 1
    v_mfma_f32_4x4x4_16b_bf16 v[88:91], v[12:13], v[84:85], 0
    s_nop 1
    v_mfma_f32_4x4x4_16b_bf16 v[88:91], v[10:11], v[86:87], v[88:91]
    s_nop 4
    v_cvt_pk_bf16_f32 v88, v88, v89
    v_cvt_pk_bf16_f32 v89, v90, v91
    ds_pk_add_bf16 v7, v88 offset:65408
    ds_pk_add_bf16 v7, v89 offset:65412
    s_mov_b64 exec, s[50:51]
    s_branch L2_d145
L2_c146:
    s_lshl_b64 s[52:53], s[82:83], 1
    s_andn2_b64 s[52:53], s[52:53], s[80:81]
    s_andn2_b64 s[52:53], s[52:53], s[54:55]
    s_or_b64 s[80:81], s[80:81], s[52:53]
    s_not_b64 vcc, s[52:53]
    s_mov_b64 exec, -1
    v_cndmask_b32_dpp v84, v84, v84, vcc wave_shr:1 row_mask:0xf bank_mask:0xf
    v_cndmask_b32_dpp v85, v85, v85, vcc wave_shr:1 row_mask:0xf bank_mask:0xf
    s_lshr_b64 s[52:53], s[52:53], 1
    v_cndmask_b32_dpp v86, v86, v86, vcc wave_shr:1 row_mask:0xf bank_mask:0xf
    v_cndmask_b32_dpp v87, v87, v87, vcc wave_shr:1 row_mask:0xf bank_mask:0xf
    s_andn2_b64 s[82:83], s[82:83], s[52:53]
    v_cndmask_b32_dpp v7, v7, v7, vcc wave_shr:1 row_mask:0xf bank_mask:0xf
    s_mov_b64 exec, s[54:55]
    s_cbranch_scc0 L2_d146
    s_mov_b64 exec, s[82:83]
    s_nop 1
    v_mfma_f32_4x4x4_16b_bf16 v[88:91], v[12:13], v[84:85], 0
    s_nop 1
    v_mfma_f32_4x4x4_16b_bf16 v[88:91], v[10:11], v[86:87], v[88:91]
    s_nop 4
    v_cvt_pk_bf16_f32 v88, v88, v89
    v_cvt_pk_bf16_f32 v89, v90, v91
    ds_pk_add_bf16 v7, v88 offset:65408
    ds_pk_add_bf16 v7, v89 offset:65412
    s_mov_b64 exec, s[54:55]
    s_branch L2_d146
L2_c147:
    s_lshl_b64 s[52:53], s[82:83], 1
    s_andn2_b64 s[52:53], s[52:53], s[80:81]
    s_andn2_b64 s[52:53], s[52:53], s[50:51]
    s_or_b64 s[80:81], s[80:81], s[52:53]
    s_not_b64 vcc, s[52:53]
    s_mov_b64 exec, -1
    v_cndmask_b32_dpp v84, v84, v84, vcc wave_shr:1 row_mask:0xf bank_mask:0xf
    v_cndmask_b32_dpp v85, v85, v85, vcc wave_shr:1 row_mask:0xf bank_mask:0xf
    s_lshr_b64 s[52:53], s[52:53], 1
    v_cndmask_b32_dpp v86, v86, v86, vcc wave_shr:1 row_mask:0xf bank_mask:0xf
    v_cndmask_b32_dpp v87, v87, v87, vcc wave_shr:1 row_mask:0xf bank_mask:0xf
    s_andn2_b64 s[82:83], s[82:83], s[52:53]
    v_cndmask_b32_dpp v7, v7, v7, vcc wave_shr:1 row_mask:0xf bank_mask:0xf
    s_mov_b64 exec, s[50:51]
    s_cbranch_scc0 L2_d147
    s_mov_b64 exec, s[82:83]
    s_nop 1
    v_mfma_f32_4x4x4_16b_bf16 v[88:91], v[12:13], v[84:85], 0
    s_nop 1
    v_mfma_f32_4x4x4_16b_bf16 v[88:91], v[10:11], v[86:87], v[88:91]
    s_nop 4
    v_cvt_pk_bf16_f32 v88, v88, v89
    v_cvt_pk_bf16_f32 v89, v90, v91
    ds_pk_add_bf16 v7, v88 offset:65408
    ds_pk_add_bf16 v7, v89 offset:65412
    s_mov_b64 exec, s[50:51]
    s_branch L2_d147
L2_c148:
    s_lshl_b64 s[52:53], s[82:83], 1
    s_andn2_b64 s[52:53], s[52:53], s[80:81]
    s_andn2_b64 s[52:53], s[52:53], s[54:55]
    s_or_b64 s[80:81], s[80:81], s[52:53]
    s_not_b64 vcc, s[52:53]
    s_mov_b64 exec, -1
    v_cndmask_b32_dpp v84, v84, v84, vcc wave_shr:1 row_mask:0xf bank_mask:0xf
    v_cndmask_b32_dpp v85, v85, v85, vcc wave_shr:1 row_mask:0xf bank_mask:0xf
    s_lshr_b64 s[52:53], s[52:53], 1
    v_cndmask_b32_dpp v86, v86, v86, vcc wave_shr:1 row_mask:0xf bank_mask:0xf
    v_cndmask_b32_dpp v87, v87, v87, vcc wave_shr:1 row_mask:0xf bank_mask:0xf
    s_andn2_b64 s[82:83], s[82:83], s[52:53]
    v_cndmask_b32_dpp v7, v7, v7, vcc wave_shr:1 row_mask:0xf bank_mask:0xf
    s_mov_b64 exec, s[54:55]
    s_cbranch_scc0 L2_d148
    s_mov_b64 exec, s[82:83]
    s_nop 1
    v_mfma_f32_4x4x4_16b_bf16 v[88:91], v[12:13], v[84:85], 0
    s_nop 1
    v_mfma_f32_4x4x4_16b_bf16 v[88:91], v[10:11], v[86:87], v[88:91]
    s_nop 4
    v_cvt_pk_bf16_f32 v88, v88, v89
    v_cvt_pk_bf16_f32 v89, v90, v91
    ds_pk_add_bf16 v7, v88 offset:65408
    ds_pk_add_bf16 v7, v89 offset:65412
    s_mov_b64 exec, s[54:55]
    s_branch L2_d148
L2_c149:
    s_lshl_b64 s[52:53], s[82:83], 1
    s_andn2_b64 s[52:53], s[52:53], s[80:81]
    s_andn2_b64 s[52:53], s[52:53], s[50:51]
    s_or_b64 s[80:81], s[80:81], s[52:53]
    s_not_b64 vcc, s[52:53]
    s_mov_b64 exec, -1
    v_cndmask_b32_dpp v84, v84, v84, vcc wave_shr:1 row_mask:0xf bank_mask:0xf
    v_cndmask_b32_dpp v85, v85, v85, vcc wave_shr:1 row_mask:0xf bank_mask:0xf
    s_lshr_b64 s[52:53], s[52:53], 1
    v_cndmask_b32_dpp v86, v86, v86, vcc wave_shr:1 row_mask:0xf bank_mask:0xf
    v_cndmask_b32_dpp v87, v87, v87, vcc wave_shr:1 row_mask:0xf bank_mask:0xf
    s_andn2_b64 s[82:83], s[82:83], s[52:53]
    v_cndmask_b32_dpp v7, v7, v7, vcc wave_shr:1 row_mask:0xf bank_mask:0xf
    s_mov_b64 exec, s[50:51]
    s_cbranch_scc0 L2_d149
    s_mov_b64 exec, s[82:83]
    s_nop 1
    v_mfma_f32_4x4x4_16b_bf16 v[88:91], v[12:13], v[84:85], 0
    s_nop 1
    v_mfma_f32_4x4x4_16b_bf16 v[88:91], v[10:11], v[86:87], v[88:91]
    s_nop 4
    v_cvt_pk_bf16_f32 v88, v88, v89
    v_cvt_pk_bf16_f32 v89, v90, v91
    ds_pk_add_bf16 v7, v88 offset:65408
    ds_pk_add_bf16 v7, v89 offset:65412
    s_mov_b64 exec, s[50:51]
    s_branch L2_d149
L2_c150:
    s_lshl_b64 s[52:53], s[82:83], 1
    s_andn2_b64 s[52:53], s[52:53], s[80:81]
    s_andn2_b64 s[52:53], s[52:53], s[54:55]
    s_or_b64 s[80:81], s[80:81], s[52:53]
    s_not_b64 vcc, s[52:53]
    s_mov_b64 exec, -1
    v_cndmask_b32_dpp v84, v84, v84, vcc wave_shr:1 row_mask:0xf bank_mask:0xf
    v_cndmask_b32_dpp v85, v85, v85, vcc wave_shr:1 row_mask:0xf bank_mask:0xf
    s_lshr_b64 s[52:53], s[52:53], 1
    v_cndmask_b32_dpp v86, v86, v86, vcc wave_shr:1 row_mask:0xf bank_mask:0xf
    v_cndmask_b32_dpp v87, v87, v87, vcc wave_shr:1 row_mask:0xf bank_mask:0xf
    s_andn2_b64 s[82:83], s[82:83], s[52:53]
    v_cndmask_b32_dpp v7, v7, v7, vcc wave_shr:1 row_mask:0xf bank_mask:0xf
    s_mov_b64 exec, s[54:55]
    s_cbranch_scc0 L2_d150
    s_mov_b64 exec, s[82:83]
    s_nop 1
    v_mfma_f32_4x4x4_16b_bf16 v[88:91], v[12:13], v[84:85], 0
    s_nop 1
    v_mfma_f32_4x4x4_16b_bf16 v[88:91], v[10:11], v[86:87], v[88:91]
    s_nop 4
    v_cvt_pk_bf16_f32 v88, v88, v89
    v_cvt_pk_bf16_f32 v89, v90, v91
    ds_pk_add_bf16 v7, v88 offset:65408
    ds_pk_add_bf16 v7, v89 offset:65412
    s_mov_b64 exec, s[54:55]
    s_branch L2_d150
L2_c151:
    s_lshl_b64 s[52:53], s[82:83], 1
    s_andn2_b64 s[52:53], s[52:53], s[80:81]
    s_andn2_b64 s[52:53], s[52:53], s[50:51]
    s_or_b64 s[80:81], s[80:81], s[52:53]
    s_not_b64 vcc, s[52:53]
    s_mov_b64 exec, -1
    v_cndmask_b32_dpp v84, v84, v84, vcc wave_shr:1 row_mask:0xf bank_mask:0xf
    v_cndmask_b32_dpp v85, v85, v85, vcc wave_shr:1 row_mask:0xf bank_mask:0xf
    s_lshr_b64 s[52:53], s[52:53], 1
    v_cndmask_b32_dpp v86, v86, v86, vcc wave_shr:1 row_mask:0xf bank_mask:0xf
    v_cndmask_b32_dpp v87, v87, v87, vcc wave_shr:1 row_mask:0xf bank_mask:0xf
    s_andn2_b64 s[82:83], s[82:83], s[52:53]
    v_cndmask_b32_dpp v7, v7, v7, vcc wave_shr:1 row_mask:0xf bank_mask:0xf
    s_mov_b64 exec, s[50:51]
    s_cbranch_scc0 L2_d151
    s_mov_b64 exec, s[82:83]
    s_nop 1
    v_mfma_f32_4x4x4_16b_bf16 v[88:91], v[12:13], v[84:85], 0
    s_nop 1
    v_mfma_f32_4x4x4_16b_bf16 v[88:91], v[10:11], v[86:87], v[88:91]
    s_nop 4
    v_cvt_pk_bf16_f32 v88, v88, v89
    v_cvt_pk_bf16_f32 v89, v90, v91
    ds_pk_add_bf16 v7, v88 offset:65408
    ds_pk_add_bf16 v7, v89 offset:65412
    s_mov_b64 exec, s[50:51]
    s_branch L2_d151
L2_c152:
    s_mov_b64 s[50:51], vcc
    s_lshl_b64 s[52:53], s[82:83], 1
    s_andn2_b64 s[52:53], s[52:53], s[80:81]
    s_andn2_b64 s[52:53], s[52:53], s[50:51]
    s_or_b64 s[80:81], s[80:81], s[52:53]
    s_not_b64 vcc, s[52:53]
    s_mov_b64 exec, -1
    v_cndmask_b32_dpp v84, v84, v84, vcc wave_shr:1 row_mask:0xf bank_mask:0xf
    v_cndmask_b32_dpp v85, v85, v85, vcc wave_shr:1 row_mask:0xf bank_mask:0xf
    s_lshr_b64 s[52:53], s[52:53], 1
    v_cndmask_b32_dpp v86, v86, v86, vcc wave_shr:1 row_mask:0xf bank_mask:0xf
    v_cndmask_b32_dpp v87, v87, v87, vcc wave_shr:1 row_mask:0xf bank_mask:0xf
    s_andn2_b64 s[82:83], s[82:83], s[52:53]
    v_cndmask_b32_dpp v7, v7, v7, vcc wave_shr:1 row_mask:0xf bank_mask:0xf
    s_mov_b64 vcc, s[50:51]
    s_mov_b64 exec, s[50:51]
    s_cbranch_scc0 L2_d152
    s_mov_b64 exec, s[82:83]
    s_nop 1
    v_mfma_f32_4x4x4_16b_bf16 v[88:91], v[12:13], v[84:85], 0
    s_nop 1
    v_mfma_f32_4x4x4_16b_bf16 v[88:91], v[10:11], v[86:87], v[88:91]
    s_nop 4
    v_cvt_pk_bf16_f32 v88, v88, v89
    v_cvt_pk_bf16_f32 v89, v90, v91
    ds_pk_add_bf16 v7, v88 offset:65408
    ds_pk_add_bf16 v7, v89 offset:65412
    s_mov_b64 exec, vcc
    s_branch L2_d152
L2_c153:
    s_mov_b64 s[50:51], vcc
    s_lshl_b64 s[52:53], s[82:83], 1
    s_andn2_b64 s[52:53], s[52:53], s[80:81]
    s_andn2_b64 s[52:53], s[52:53], s[50:51]
    s_or_b64 s[80:81], s[80:81], s[52:53]
    s_not_b64 vcc, s[52:53]
    s_mov_b64 exec, -1
    v_cndmask_b32_dpp v84, v84, v84, vcc wave_shr:1 row_mask:0xf bank_mask:0xf
    v_cndmask_b32_dpp v85, v85, v85, vcc wave_shr:1 row_mask:0xf bank_mask:0xf
    s_lshr_b64 s[52:53], s[52:53], 1
    v_cndmask_b32_dpp v86, v86, v86, vcc wave_shr:1 row_mask:0xf bank_mask:0xf
    v_cndmask_b32_dpp v87, v87, v87, vcc wave_shr:1 row_mask:0xf bank_mask:0xf
    s_andn2_b64 s[82:83], s[82:83], s[52:53]
    v_cndmask_b32_dpp v7, v7, v7, vcc wave_shr:1 row_mask:0xf bank_mask:0xf
    s_mov_b64 vcc, s[50:51]
    s_mov_b64 exec, s[50:51]
    s_cbranch_scc0 L2_d153
    s_mov_b64 exec, s[82:83]
    s_nop 1
    v_mfma_f32_4x4x4_16b_bf16 v[88:91], v[12:13], v[84:85], 0
    s_nop 1
    v_mfma_f32_4x4x4_16b_bf16 v[88:91], v[10:11], v[86:87], v[88:91]
    s_nop 4
    v_cvt_pk_bf16_f32 v88, v88, v89
    v_cvt_pk_bf16_f32 v89, v90, v91
    ds_pk_add_bf16 v7, v88 offset:65408
    ds_pk_add_bf16 v7, v89 offset:65412
    s_mov_b64 exec, vcc
    s_branch L2_d153
L2_f3s:
    s_branch L2_f3
.section .rodata,"a"
.p2align 6
.amdhsa_kernel gather_scatter__molecular_angular_gemnet__graph_kernel
  .amdhsa_next_free_vgpr 128
  .amdhsa_next_free_sgpr 102
  .amdhsa_accum_offset 128
  .amdhsa_group_segment_fixed_size 0
  .amdhsa_kernarg_size 112
  .amdhsa_user_sgpr_count 2
  .amdhsa_user_sgpr_kernarg_segment_ptr 1
  .amdhsa_system_sgpr_workgroup_id_x 1
  .amdhsa_float_denorm_mode_32 3
.end_amdhsa_kernel
```

```asm
; @launch grid=(256,1,1) block=(1024,1,1) lds=163840
.amdgcn_target "amdgcn-amd-amdhsa--gfx950"
.text
.globl gather_scatter__molecular_angular_gemnet__graph_kernel
.p2align 8
.type gather_scatter__molecular_angular_gemnet__graph_kernel,@function
gather_scatter__molecular_angular_gemnet__graph_kernel:
    s_cmp_ge_u32 s2, 256
    s_cbranch_scc0 L1_go
    s_endpgm
L1_go:
    s_load_dwordx4 s[4:7], s[0:1], 8
    s_load_dwordx2 s[28:29], s[0:1], 32
    s_load_dwordx2 s[30:31], s[0:1], 104
    s_load_dwordx2 s[56:57], s[0:1], 96
    s_load_dwordx2 s[86:87], s[0:1], 0
    s_load_dwordx4 s[60:63], s[0:1], 56
    s_load_dwordx4 s[64:67], s[0:1], 72
    v_lshrrev_b32 v7, 6, v0
    v_lshlrev_b32 v1, 3, v0
    v_readfirstlane_b32 s32, v7
    v_lshlrev_b32 v0, 4, v0
    v_and_b32 v1, 0x1f8, v1
    v_lshlrev_b32 v15, 1, v1
    s_lshr_b32 s3, s32, 1
    s_and_b32 s44, s32, 1
    s_lshl_b32 s44, s44, 3
    s_or_b32 s3, s3, s44
    s_lshl_b32 s3, s3, 10
    s_lshl_b32 s96, s2, 14
    s_add_u32 s96, s96, s3
    s_lshr_b32 s3, s32, 1
    s_and_b32 s44, s32, 1
    s_lshl_b32 s44, s44, 3
    s_or_b32 s3, s3, s44
    s_lshl_b32 s3, s3, 10
    s_lshl_b32 s97, s2, 14
    s_add_u32 s97, s97, s3
    s_lshr_b32 s3, s32, 1
    s_and_b32 s44, s32, 1
    s_lshl_b32 s44, s44, 3
    s_or_b32 s3, s3, s44
    s_lshl_b32 s3, s3, 10
    s_lshl_b32 s98, s2, 14
    s_add_u32 s98, s98, s3
    s_lshr_b32 s3, s32, 1
    s_and_b32 s44, s32, 1
    s_lshl_b32 s44, s44, 3
    s_or_b32 s3, s3, s44
    s_lshl_b32 s3, s3, 10
    s_lshl_b32 s99, s2, 14
    s_add_u32 s99, s99, s3
    s_waitcnt lgkmcnt(0)
    s_mov_b32 s8, s4
    s_mov_b32 s9, s5
    s_mov_b32 s10, 0x9c40000
    s_mov_b32 s11, 0x20000
    s_mov_b32 s12, s6
    s_mov_b32 s13, s7
    s_mov_b32 s14, 0x9c40000
    s_mov_b32 s15, 0x20000
    s_mov_b32 s16, s28
    s_mov_b32 s17, s29
    s_mov_b32 s18, 0x4e20000
    s_mov_b32 s19, 0x20000
    s_mov_b32 s68, s62
    s_mov_b32 s69, s63
    s_mov_b32 s70, 0x40
    s_mov_b32 s71, 0x20000
    s_mov_b32 s72, s60
    s_mov_b32 s73, s61
    s_mov_b32 s74, 0x40
    s_mov_b32 s75, 0x20000
    s_mov_b32 s20, s66
    s_mov_b32 s21, s67
    s_mov_b32 s22, 0x20
    s_mov_b32 s23, 0x20000
    s_mov_b32 s80, s64
    s_mov_b32 s81, s65
    s_mov_b32 s82, 0x20
    s_mov_b32 s83, 0x20000
    s_add_u32 s24, s30, 0xec45000
    s_addc_u32 s25, s31, 0
    s_mov_b32 s26, 0x100
    s_mov_b32 s27, 0x20000
    v_lshrrev_b32 v2, 3, v0
    v_and_b32 v2, 6, v2
    v_lshlrev_b32 v3, 2, v0
    s_lshl_b32 s3, s32, 8
    s_add_u32 s3, s3, s2
    s_cmp_lg_u32 s3, 254
    s_cbranch_scc1 L1_wt
    buffer_load_ushort v96, v2, s[68:71], 0 offen offset:0
    buffer_load_ushort v108, v2, s[68:71], 0 offen offset:8
    buffer_load_ushort v97, v2, s[68:71], 0 offen offset:16
    buffer_load_ushort v109, v2, s[68:71], 0 offen offset:24
    buffer_load_ushort v98, v2, s[68:71], 0 offen offset:32
    buffer_load_ushort v110, v2, s[68:71], 0 offen offset:40
    buffer_load_ushort v99, v2, s[68:71], 0 offen offset:48
    buffer_load_ushort v111, v2, s[68:71], 0 offen offset:56
    buffer_load_ushort v100, v2, s[72:75], 0 offen offset:0
    buffer_load_ushort v112, v2, s[72:75], 0 offen offset:8
    buffer_load_ushort v101, v2, s[72:75], 0 offen offset:16
    buffer_load_ushort v113, v2, s[72:75], 0 offen offset:24
    buffer_load_ushort v102, v2, s[72:75], 0 offen offset:32
    buffer_load_ushort v114, v2, s[72:75], 0 offen offset:40
    buffer_load_ushort v103, v2, s[72:75], 0 offen offset:48
    buffer_load_ushort v115, v2, s[72:75], 0 offen offset:56
    buffer_load_ushort v104, v2, s[20:23], 0 offen offset:0
    buffer_load_ushort v116, v2, s[20:23], 0 offen offset:8
    buffer_load_ushort v105, v2, s[20:23], 0 offen offset:16
    buffer_load_ushort v117, v2, s[20:23], 0 offen offset:24
    buffer_load_ushort v106, v2, s[80:83], 0 offen offset:0
    buffer_load_ushort v118, v2, s[80:83], 0 offen offset:8
    buffer_load_ushort v107, v2, s[80:83], 0 offen offset:16
    buffer_load_ushort v119, v2, s[80:83], 0 offen offset:24
    s_waitcnt vmcnt(0)
    v_lshl_or_b32 v96, v108, 16, v96
    v_lshl_or_b32 v97, v109, 16, v97
    v_lshl_or_b32 v98, v110, 16, v98
    v_lshl_or_b32 v99, v111, 16, v99
    v_lshl_or_b32 v100, v112, 16, v100
    v_lshl_or_b32 v101, v113, 16, v101
    v_lshl_or_b32 v102, v114, 16, v102
    v_lshl_or_b32 v103, v115, 16, v103
    v_lshl_or_b32 v104, v116, 16, v104
    v_lshl_or_b32 v105, v117, 16, v105
    v_lshl_or_b32 v106, v118, 16, v106
    v_lshl_or_b32 v107, v119, 16, v107
    buffer_store_dwordx4 v[96:99], v3, s[24:27], 0 offen offset:0 sc1
    buffer_store_dwordx4 v[100:103], v3, s[24:27], 0 offen offset:16 sc1
    buffer_store_dwordx4 v[104:107], v3, s[24:27], 0 offen offset:32 sc1
L1_wt:
    s_nop 1
    s_add_u32 s44, s96, 0x0
    v_lshlrev_b32 v16, 1, v1
    buffer_load_dwordx4 v[16:19], v16, s[8:11], s44 offen nt
    s_add_u32 s45, s96, 0x0
    v_lshlrev_b32 v20, 1, v1
    buffer_load_dwordx4 v[20:23], v20, s[12:15], s45 offen nt
    s_add_u32 s46, s96, 0x0
    s_lshr_b32 s46, s46, 1
    buffer_load_dwordx2 v[24:25], v1, s[16:19], s46 offen nt
    s_add_u32 s47, s97, 0x400000
    s_lshr_b32 s47, s47, 1
    buffer_load_dwordx2 v[26:27], v1, s[16:19], s47 offen nt
    s_add_u32 s44, s97, 0x400000
    v_lshlrev_b32 v28, 1, v1
    buffer_load_dwordx4 v[28:31], v28, s[8:11], s44 offen nt
    s_add_u32 s45, s97, 0x400000
    v_lshlrev_b32 v32, 1, v1
    buffer_load_dwordx4 v[32:35], v32, s[12:15], s45 offen nt
    s_add_u32 s46, s98, 0x800000
    v_lshlrev_b32 v36, 1, v1
    buffer_load_dwordx4 v[36:39], v36, s[8:11], s46 offen nt
    s_add_u32 s47, s98, 0x800000
    v_lshlrev_b32 v40, 1, v1
    buffer_load_dwordx4 v[40:43], v40, s[12:15], s47 offen nt
    s_add_u32 s44, s98, 0x800000
    s_lshr_b32 s44, s44, 1
    buffer_load_dwordx2 v[44:45], v1, s[16:19], s44 offen nt
    s_add_u32 s45, s99, 0xc00000
    s_lshr_b32 s45, s45, 1
    buffer_load_dwordx2 v[46:47], v1, s[16:19], s45 offen nt
    s_mov_b32 s20, s30
    s_mov_b32 s21, s31
    s_mov_b32 s22, 0xd344000
    s_mov_b32 s23, 0x20000
    s_add_u32 s24, s30, 0x2c000
    s_addc_u32 s25, s31, 0
    s_mov_b32 s26, 0xd318000
    s_mov_b32 s27, 0x20000
    s_add_u32 s3, s32, 0
    s_mul_i32 s4, s3, 205
    s_lshr_b32 s4, s4, 10
    s_mul_i32 s5, s4, 5
    s_sub_u32 s5, s3, s5
    s_lshl_b32 s5, s5, 5
    s_add_u32 s4, s4, s5
    s_sub_u32 s4, s4, s32
    s_lshl_b32 s72, s4, 10
    s_add_u32 s3, s32, 16
    s_mul_i32 s4, s3, 205
    s_lshr_b32 s4, s4, 10
    s_mul_i32 s5, s4, 5
    s_sub_u32 s5, s3, s5
    s_lshl_b32 s5, s5, 5
    s_add_u32 s4, s4, s5
    s_sub_u32 s4, s4, s32
    s_lshl_b32 s73, s4, 10
    s_add_u32 s3, s32, 32
    s_mul_i32 s4, s3, 205
    s_lshr_b32 s4, s4, 10
    s_mul_i32 s5, s4, 5
    s_sub_u32 s5, s3, s5
    s_lshl_b32 s5, s5, 5
    s_add_u32 s4, s4, s5
    s_sub_u32 s4, s4, s32
    s_lshl_b32 s85, s4, 10
    s_add_u32 s3, s32, 48
    s_mul_i32 s4, s3, 205
    s_lshr_b32 s4, s4, 10
    s_mul_i32 s5, s4, 5
    s_sub_u32 s5, s3, s5
    s_lshl_b32 s5, s5, 5
    s_add_u32 s4, s4, s5
    s_sub_u32 s4, s4, s32
    s_lshl_b32 s91, s4, 10
    s_add_u32 s3, s32, 64
    s_mul_i32 s4, s3, 205
    s_lshr_b32 s4, s4, 10
    s_mul_i32 s5, s4, 5
    s_sub_u32 s5, s3, s5
    s_lshl_b32 s5, s5, 5
    s_add_u32 s4, s4, s5
    s_sub_u32 s4, s4, s32
    s_lshl_b32 s93, s4, 10
    s_mov_b32 s80, s86
    s_mov_b32 s81, s87
    s_mov_b32 s82, 0x4e2000
    s_mov_b32 s83, 0x20000
    s_mul_i32 s35, s2, 173056
    s_and_b32 s37, s32, 3
    s_lshl_b32 s37, s37, 3
    s_mov_b32 s36, s37
    s_lshr_b32 s37, s32, 2
    s_mul_i32 s37, s37, 2080
    s_add_u32 s36, s36, s37
    s_and_b32 s37, s2, 3
    s_lshl_b32 s37, s37, 5
    s_add_u32 s36, s36, s37
    s_mul_i32 s4, s2, 5
    s_add_u32 s4, s4, 8192
    s_lshl_b32 s38, s4, 14
    s_lshl_b32 s39, s4, 13
    v_mov_b32 v2, 1
    v_mov_b32 v4, 0x80000007
    v_mov_b32 v5, 0xfc
    v_mov_b32 v6, 0x78
    s_mov_b32 s40, 16512
    s_mov_b32 s55, -10000
    s_mov_b32 s41, 0x010c0c01
    s_mov_b32 s42, 0x030c0c03
    v_mov_b32 v8, 0
    v_mov_b32 v9, 0
    v_mov_b32 v10, 0
    v_mov_b32 v11, 0
    ds_write_b128 v0, v[8:11]
    s_add_u32 s60, s30, 0xec4e000
    s_addc_u32 s61, s31, 0
    s_mov_b32 s62, 0x8000
    s_mov_b32 s63, 0x20000
    s_mov_b64 s[66:67], s[56:57]
    s_lshl_b32 s57, s2, 7
    s_add_u32 s68, s30, 0xec46000
    s_addc_u32 s69, s31, 0
    s_mov_b32 s70, 0x80
    s_mov_b32 s71, 0x20000
    s_lshl_b32 s3, s2, 7
    s_add_u32 s68, s68, s3
    s_addc_u32 s69, s69, 0
    s_cmp_lg_u32 s32, 0
    s_cbranch_scc1 L1_fl
    buffer_store_dwordx4 v[8:11], v0, s[68:71], 0 offen sc1
    s_mov_b64 exec, 0xff
    buffer_store_dwordx4 v[8:11], v0, s[60:63], s57 offen sc1
    s_mov_b64 exec, -1
L1_fl:
    s_waitcnt lgkmcnt(0)
    s_barrier
    s_setprio 3
    s_add_u32 s46, s99, 0xc00000
    v_lshlrev_b32 v48, 1, v1
    buffer_load_dwordx4 v[48:51], v48, s[8:11], s46 offen nt
    s_add_u32 s47, s99, 0xc00000
    v_lshlrev_b32 v52, 1, v1
    buffer_load_dwordx4 v[52:55], v52, s[12:15], s47 offen nt
    s_waitcnt vmcnt(8)
    v_lshlrev_b32 v7, 16, v24
    v_and_b32 v8, 0xffff0000, v24
    v_lshlrev_b32 v9, 16, v25
    v_and_b32 v10, 0xffff0000, v25
    v_mul_f32 v7, 0.15915494, v7
    v_mul_f32 v8, 0.15915494, v8
    v_mul_f32 v9, 0.15915494, v9
    v_mul_f32 v10, 0.15915494, v10
    v_mul_hi_u32_u24 v14, 429497, v16
    v_lshrrev_b32 v12, 3, v20
    v_cos_f32 v7, v7
    v_lshlrev_b16 v13, 3, v20
    v_mad_i32_i24 v11, v14, s55, v16
    v_bitop3_b32 v12, v6, v13, v12 bitop3:0xca
    v_lshl_add_u32 v11, v11, 17, s40
    v_lshlrev_b16 v14, 8, v14
    v_lshrrev_b32 v13, 2, v20
    v_add_u32 v16, v12, v11
    v_bitop3_b32 v20, v5, v13, v14 bitop3:0xea
    ds_add_u32 v20, v2
    v_mul_hi_u32_u24 v14, 429497, v17
    v_lshrrev_b32 v12, 3, v21
    v_cos_f32 v8, v8
    v_lshlrev_b16 v13, 3, v21
    v_mad_i32_i24 v11, v14, s55, v17
    v_bitop3_b32 v12, v6, v13, v12 bitop3:0xca
    v_lshl_add_u32 v11, v11, 17, s40
    v_lshlrev_b16 v14, 8, v14
    v_lshrrev_b32 v13, 2, v21
    v_add_u32 v17, v12, v11
    v_bitop3_b32 v21, v5, v13, v14 bitop3:0xea
    ds_add_u32 v21, v2
    v_cvt_pk_bf16_f32 v24, v7, v8
    v_perm_b32 v12, v24, v24, s41
    v_bitop3_b32 v16, v4, v12, v16 bitop3:0xca
    v_perm_b32 v13, v24, v24, s42
    v_bitop3_b32 v17, v4, v13, v17 bitop3:0xca
    v_mul_hi_u32_u24 v14, 429497, v18
    v_lshrrev_b32 v12, 3, v22
    v_cos_f32 v9, v9
    v_lshlrev_b16 v13, 3, v22
    v_mad_i32_i24 v11, v14, s55, v18
    v_bitop3_b32 v12, v6, v13, v12 bitop3:0xca
    v_lshl_add_u32 v11, v11, 17, s40
    v_lshlrev_b16 v14, 8, v14
    v_lshrrev_b32 v13, 2, v22
    v_add_u32 v18, v12, v11
    v_bitop3_b32 v22, v5, v13, v14 bitop3:0xea
    ds_add_u32 v22, v2
    v_mul_hi_u32_u24 v14, 429497, v19
    v_lshrrev_b32 v12, 3, v23
    v_cos_f32 v10, v10
    v_lshlrev_b16 v13, 3, v23
    v_mad_i32_i24 v11, v14, s55, v19
    v_bitop3_b32 v12, v6, v13, v12 bitop3:0xca
    v_lshl_add_u32 v11, v11, 17, s40
    v_lshlrev_b16 v14, 8, v14
    v_lshrrev_b32 v13, 2, v23
    v_add_u32 v19, v12, v11
    v_bitop3_b32 v23, v5, v13, v14 bitop3:0xea
    ds_add_u32 v23, v2
    v_cvt_pk_bf16_f32 v25, v9, v10
    v_perm_b32 v12, v25, v25, s41
    v_bitop3_b32 v18, v4, v12, v18 bitop3:0xca
    v_perm_b32 v13, v25, v25, s42
    v_bitop3_b32 v19, v4, v13, v19 bitop3:0xca
    s_add_u32 s44, s96, 0x1000000
    v_lshlrev_b32 v56, 1, v1
    buffer_load_dwordx4 v[56:59], v56, s[8:11], s44 offen nt
    s_add_u32 s45, s96, 0x1000000
    v_lshlrev_b32 v60, 1, v1
    buffer_load_dwordx4 v[60:63], v60, s[12:15], s45 offen nt
    s_add_u32 s46, s96, 0x1000000
    s_lshr_b32 s46, s46, 1
    buffer_load_dwordx2 v[64:65], v1, s[16:19], s46 offen nt
    s_add_u32 s47, s97, 0x1400000
    s_lshr_b32 s47, s47, 1
    buffer_load_dwordx2 v[66:67], v1, s[16:19], s47 offen nt
    s_waitcnt vmcnt(10)
    v_lshlrev_b32 v7, 16, v26
    v_and_b32 v8, 0xffff0000, v26
    v_lshlrev_b32 v9, 16, v27
    v_and_b32 v10, 0xffff0000, v27
    v_mul_f32 v7, 0.15915494, v7
    v_mul_f32 v8, 0.15915494, v8
    v_mul_f32 v9, 0.15915494, v9
    v_mul_f32 v10, 0.15915494, v10
    v_mul_hi_u32_u24 v14, 429497, v28
    v_lshrrev_b32 v12, 3, v32
    v_cos_f32 v7, v7
    v_lshlrev_b16 v13, 3, v32
    v_mad_i32_i24 v11, v14, s55, v28
    v_bitop3_b32 v12, v6, v13, v12 bitop3:0xca
    v_lshl_add_u32 v11, v11, 17, s40
    v_lshlrev_b16 v14, 8, v14
    v_lshrrev_b32 v13, 2, v32
    v_add_u32 v28, v12, v11
    v_bitop3_b32 v32, v5, v13, v14 bitop3:0xea
    ds_add_u32 v32, v2
    v_mul_hi_u32_u24 v14, 429497, v29
    v_lshrrev_b32 v12, 3, v33
    v_cos_f32 v8, v8
    v_lshlrev_b16 v13, 3, v33
    v_mad_i32_i24 v11, v14, s55, v29
    v_bitop3_b32 v12, v6, v13, v12 bitop3:0xca
    v_lshl_add_u32 v11, v11, 17, s40
    v_lshlrev_b16 v14, 8, v14
    v_lshrrev_b32 v13, 2, v33
    v_add_u32 v29, v12, v11
    v_bitop3_b32 v33, v5, v13, v14 bitop3:0xea
    ds_add_u32 v33, v2
    v_cvt_pk_bf16_f32 v26, v7, v8
    v_perm_b32 v12, v26, v26, s41
    v_bitop3_b32 v28, v4, v12, v28 bitop3:0xca
    v_perm_b32 v13, v26, v26, s42
    v_bitop3_b32 v29, v4, v13, v29 bitop3:0xca
    v_mul_hi_u32_u24 v14, 429497, v30
    v_lshrrev_b32 v12, 3, v34
    v_cos_f32 v9, v9
    v_lshlrev_b16 v13, 3, v34
    v_mad_i32_i24 v11, v14, s55, v30
    v_bitop3_b32 v12, v6, v13, v12 bitop3:0xca
    v_lshl_add_u32 v11, v11, 17, s40
    v_lshlrev_b16 v14, 8, v14
    v_lshrrev_b32 v13, 2, v34
    v_add_u32 v30, v12, v11
    v_bitop3_b32 v34, v5, v13, v14 bitop3:0xea
    ds_add_u32 v34, v2
    v_mul_hi_u32_u24 v14, 429497, v31
    v_lshrrev_b32 v12, 3, v35
    v_cos_f32 v10, v10
    v_lshlrev_b16 v13, 3, v35
    v_mad_i32_i24 v11, v14, s55, v31
    v_bitop3_b32 v12, v6, v13, v12 bitop3:0xca
    v_lshl_add_u32 v11, v11, 17, s40
    v_lshlrev_b16 v14, 8, v14
    v_lshrrev_b32 v13, 2, v35
    v_add_u32 v31, v12, v11
    v_bitop3_b32 v35, v5, v13, v14 bitop3:0xea
    ds_add_u32 v35, v2
    v_cvt_pk_bf16_f32 v27, v9, v10
    v_perm_b32 v12, v27, v27, s41
    v_bitop3_b32 v30, v4, v12, v30 bitop3:0xca
    v_perm_b32 v13, v27, v27, s42
    v_bitop3_b32 v31, v4, v13, v31 bitop3:0xca
    s_setprio 2
    s_add_u32 s44, s97, 0x1400000
    v_lshlrev_b32 v68, 1, v1
    buffer_load_dwordx4 v[68:71], v68, s[8:11], s44 offen nt
    s_add_u32 s45, s97, 0x1400000
    v_lshlrev_b32 v72, 1, v1
    buffer_load_dwordx4 v[72:75], v72, s[12:15], s45 offen nt
    s_waitcnt vmcnt(8)
    v_lshlrev_b32 v7, 16, v44
    v_and_b32 v8, 0xffff0000, v44
    v_lshlrev_b32 v9, 16, v45
    v_and_b32 v10, 0xffff0000, v45
    v_mul_f32 v7, 0.15915494, v7
    v_mul_f32 v8, 0.15915494, v8
    v_mul_f32 v9, 0.15915494, v9
    v_mul_f32 v10, 0.15915494, v10
    v_mul_hi_u32_u24 v14, 429497, v36
    v_lshrrev_b32 v12, 3, v40
    v_cos_f32 v7, v7
    v_lshlrev_b16 v13, 3, v40
    v_mad_i32_i24 v11, v14, s55, v36
    v_bitop3_b32 v12, v6, v13, v12 bitop3:0xca
    v_lshl_add_u32 v11, v11, 17, s40
    v_lshlrev_b16 v14, 8, v14
    v_lshrrev_b32 v13, 2, v40
    v_add_u32 v36, v12, v11
    v_bitop3_b32 v40, v5, v13, v14 bitop3:0xea
    ds_add_u32 v40, v2
    v_mul_hi_u32_u24 v14, 429497, v37
    v_lshrrev_b32 v12, 3, v41
    v_cos_f32 v8, v8
    v_lshlrev_b16 v13, 3, v41
    v_mad_i32_i24 v11, v14, s55, v37
    v_bitop3_b32 v12, v6, v13, v12 bitop3:0xca
    v_lshl_add_u32 v11, v11, 17, s40
    v_lshlrev_b16 v14, 8, v14
    v_lshrrev_b32 v13, 2, v41
    v_add_u32 v37, v12, v11
    v_bitop3_b32 v41, v5, v13, v14 bitop3:0xea
    ds_add_u32 v41, v2
    v_cvt_pk_bf16_f32 v44, v7, v8
    v_perm_b32 v12, v44, v44, s41
    v_bitop3_b32 v36, v4, v12, v36 bitop3:0xca
    v_perm_b32 v13, v44, v44, s42
    v_bitop3_b32 v37, v4, v13, v37 bitop3:0xca
    v_mul_hi_u32_u24 v14, 429497, v38
    v_lshrrev_b32 v12, 3, v42
    v_cos_f32 v9, v9
    v_lshlrev_b16 v13, 3, v42
    v_mad_i32_i24 v11, v14, s55, v38
    v_bitop3_b32 v12, v6, v13, v12 bitop3:0xca
    v_lshl_add_u32 v11, v11, 17, s40
    v_lshlrev_b16 v14, 8, v14
    v_lshrrev_b32 v13, 2, v42
    v_add_u32 v38, v12, v11
    v_bitop3_b32 v42, v5, v13, v14 bitop3:0xea
    ds_add_u32 v42, v2
    v_mul_hi_u32_u24 v14, 429497, v39
    v_lshrrev_b32 v12, 3, v43
    v_cos_f32 v10, v10
    v_lshlrev_b16 v13, 3, v43
    v_mad_i32_i24 v11, v14, s55, v39
    v_bitop3_b32 v12, v6, v13, v12 bitop3:0xca
    v_lshl_add_u32 v11, v11, 17, s40
    v_lshlrev_b16 v14, 8, v14
    v_lshrrev_b32 v13, 2, v43
    v_add_u32 v39, v12, v11
    v_bitop3_b32 v43, v5, v13, v14 bitop3:0xea
    ds_add_u32 v43, v2
    v_cvt_pk_bf16_f32 v45, v9, v10
    v_perm_b32 v12, v45, v45, s41
    v_bitop3_b32 v38, v4, v12, v38 bitop3:0xca
    v_perm_b32 v13, v45, v45, s42
    v_bitop3_b32 v39, v4, v13, v39 bitop3:0xca
    s_add_u32 s46, s98, 0x1800000
    v_lshlrev_b32 v76, 1, v1
    buffer_load_dwordx4 v[76:79], v76, s[8:11], s46 offen nt
    s_add_u32 s47, s98, 0x1800000
    v_lshlrev_b32 v80, 1, v1
    buffer_load_dwordx4 v[80:83], v80, s[12:15], s47 offen nt
    s_add_u32 s44, s98, 0x1800000
    s_lshr_b32 s44, s44, 1
    buffer_load_dwordx2 v[84:85], v1, s[16:19], s44 offen nt
    s_add_u32 s45, s99, 0x1c00000
    s_lshr_b32 s45, s45, 1
    buffer_load_dwordx2 v[86:87], v1, s[16:19], s45 offen nt
    s_waitcnt vmcnt(10)
    v_lshlrev_b32 v7, 16, v46
    v_and_b32 v8, 0xffff0000, v46
    v_lshlrev_b32 v9, 16, v47
    v_and_b32 v10, 0xffff0000, v47
    v_mul_f32 v7, 0.15915494, v7
    v_mul_f32 v8, 0.15915494, v8
    v_mul_f32 v9, 0.15915494, v9
    v_mul_f32 v10, 0.15915494, v10
    v_mul_hi_u32_u24 v14, 429497, v48
    v_lshrrev_b32 v12, 3, v52
    v_cos_f32 v7, v7
    v_lshlrev_b16 v13, 3, v52
    v_mad_i32_i24 v11, v14, s55, v48
    v_bitop3_b32 v12, v6, v13, v12 bitop3:0xca
    v_lshl_add_u32 v11, v11, 17, s40
    v_lshlrev_b16 v14, 8, v14
    v_lshrrev_b32 v13, 2, v52
    v_add_u32 v48, v12, v11
    v_bitop3_b32 v52, v5, v13, v14 bitop3:0xea
    ds_add_u32 v52, v2
    v_mul_hi_u32_u24 v14, 429497, v49
    v_lshrrev_b32 v12, 3, v53
    v_cos_f32 v8, v8
    v_lshlrev_b16 v13, 3, v53
    v_mad_i32_i24 v11, v14, s55, v49
    v_bitop3_b32 v12, v6, v13, v12 bitop3:0xca
    v_lshl_add_u32 v11, v11, 17, s40
    v_lshlrev_b16 v14, 8, v14
    v_lshrrev_b32 v13, 2, v53
    v_add_u32 v49, v12, v11
    v_bitop3_b32 v53, v5, v13, v14 bitop3:0xea
    ds_add_u32 v53, v2
    v_cvt_pk_bf16_f32 v46, v7, v8
    v_perm_b32 v12, v46, v46, s41
    v_bitop3_b32 v48, v4, v12, v48 bitop3:0xca
    v_perm_b32 v13, v46, v46, s42
    v_bitop3_b32 v49, v4, v13, v49 bitop3:0xca
    v_mul_hi_u32_u24 v14, 429497, v50
    v_lshrrev_b32 v12, 3, v54
    v_cos_f32 v9, v9
    v_lshlrev_b16 v13, 3, v54
    v_mad_i32_i24 v11, v14, s55, v50
    v_bitop3_b32 v12, v6, v13, v12 bitop3:0xca
    v_lshl_add_u32 v11, v11, 17, s40
    v_lshlrev_b16 v14, 8, v14
    v_lshrrev_b32 v13, 2, v54
    v_add_u32 v50, v12, v11
    v_bitop3_b32 v54, v5, v13, v14 bitop3:0xea
    ds_add_u32 v54, v2
    v_mul_hi_u32_u24 v14, 429497, v51
    v_lshrrev_b32 v12, 3, v55
    v_cos_f32 v10, v10
    v_lshlrev_b16 v13, 3, v55
    v_mad_i32_i24 v11, v14, s55, v51
    v_bitop3_b32 v12, v6, v13, v12 bitop3:0xca
    v_lshl_add_u32 v11, v11, 17, s40
    v_lshlrev_b16 v14, 8, v14
    v_lshrrev_b32 v13, 2, v55
    v_add_u32 v51, v12, v11
    v_bitop3_b32 v55, v5, v13, v14 bitop3:0xea
    ds_add_u32 v55, v2
    v_cvt_pk_bf16_f32 v47, v9, v10
    v_perm_b32 v12, v47, v47, s41
    v_bitop3_b32 v50, v4, v12, v50 bitop3:0xca
    v_perm_b32 v13, v47, v47, s42
    v_bitop3_b32 v51, v4, v13, v51 bitop3:0xca
    s_setprio 1
    s_add_u32 s46, s99, 0x1c00000
    v_lshlrev_b32 v88, 1, v1
    buffer_load_dwordx4 v[88:91], v88, s[8:11], s46 offen nt
    s_add_u32 s47, s99, 0x1c00000
    v_lshlrev_b32 v92, 1, v1
    buffer_load_dwordx4 v[92:95], v92, s[12:15], s47 offen nt
    s_waitcnt vmcnt(8)
    v_lshlrev_b32 v7, 16, v64
    v_and_b32 v8, 0xffff0000, v64
    v_lshlrev_b32 v9, 16, v65
    v_and_b32 v10, 0xffff0000, v65
    v_mul_f32 v7, 0.15915494, v7
    v_mul_f32 v8, 0.15915494, v8
    v_mul_f32 v9, 0.15915494, v9
    v_mul_f32 v10, 0.15915494, v10
    v_mul_hi_u32_u24 v14, 429497, v56
    v_lshrrev_b32 v12, 3, v60
    v_cos_f32 v7, v7
    v_lshlrev_b16 v13, 3, v60
    v_mad_i32_i24 v11, v14, s55, v56
    v_bitop3_b32 v12, v6, v13, v12 bitop3:0xca
    v_lshl_add_u32 v11, v11, 17, s40
    v_lshlrev_b16 v14, 8, v14
    v_lshrrev_b32 v13, 2, v60
    v_add_u32 v56, v12, v11
    v_bitop3_b32 v60, v5, v13, v14 bitop3:0xea
    ds_add_u32 v60, v2
    v_mul_hi_u32_u24 v14, 429497, v57
    v_lshrrev_b32 v12, 3, v61
    v_cos_f32 v8, v8
    v_lshlrev_b16 v13, 3, v61
    v_mad_i32_i24 v11, v14, s55, v57
    v_bitop3_b32 v12, v6, v13, v12 bitop3:0xca
    v_lshl_add_u32 v11, v11, 17, s40
    v_lshlrev_b16 v14, 8, v14
    v_lshrrev_b32 v13, 2, v61
    v_add_u32 v57, v12, v11
    v_bitop3_b32 v61, v5, v13, v14 bitop3:0xea
    ds_add_u32 v61, v2
    v_cvt_pk_bf16_f32 v64, v7, v8
    v_perm_b32 v12, v64, v64, s41
    v_bitop3_b32 v56, v4, v12, v56 bitop3:0xca
    v_perm_b32 v13, v64, v64, s42
    v_bitop3_b32 v57, v4, v13, v57 bitop3:0xca
    v_mul_hi_u32_u24 v14, 429497, v58
    v_lshrrev_b32 v12, 3, v62
    v_cos_f32 v9, v9
    v_lshlrev_b16 v13, 3, v62
    v_mad_i32_i24 v11, v14, s55, v58
    v_bitop3_b32 v12, v6, v13, v12 bitop3:0xca
    v_lshl_add_u32 v11, v11, 17, s40
    v_lshlrev_b16 v14, 8, v14
    v_lshrrev_b32 v13, 2, v62
    v_add_u32 v58, v12, v11
    v_bitop3_b32 v62, v5, v13, v14 bitop3:0xea
    ds_add_u32 v62, v2
    v_mul_hi_u32_u24 v14, 429497, v59
    v_lshrrev_b32 v12, 3, v63
    v_cos_f32 v10, v10
    v_lshlrev_b16 v13, 3, v63
    v_mad_i32_i24 v11, v14, s55, v59
    v_bitop3_b32 v12, v6, v13, v12 bitop3:0xca
    v_lshl_add_u32 v11, v11, 17, s40
    v_lshlrev_b16 v14, 8, v14
    v_lshrrev_b32 v13, 2, v63
    v_add_u32 v59, v12, v11
    v_bitop3_b32 v63, v5, v13, v14 bitop3:0xea
    ds_add_u32 v63, v2
    v_cvt_pk_bf16_f32 v65, v9, v10
    v_perm_b32 v12, v65, v65, s41
    v_bitop3_b32 v58, v4, v12, v58 bitop3:0xca
    v_perm_b32 v13, v65, v65, s42
    v_bitop3_b32 v59, v4, v13, v59 bitop3:0xca
    s_add_u32 s44, s96, 0x2000000
    v_lshlrev_b32 v96, 1, v1
    buffer_load_dwordx4 v[96:99], v96, s[8:11], s44 offen nt
    s_add_u32 s45, s96, 0x2000000
    v_lshlrev_b32 v104, 1, v1
    buffer_load_dwordx4 v[104:107], v104, s[12:15], s45 offen nt
    s_add_u32 s46, s96, 0x2000000
    s_lshr_b32 s46, s46, 1
    buffer_load_dwordx2 v[108:109], v1, s[16:19], s46 offen nt
    s_add_u32 s47, s97, 0x2400000
    s_lshr_b32 s47, s47, 1
    buffer_load_dwordx2 v[110:111], v1, s[16:19], s47 offen nt
    s_waitcnt vmcnt(10)
    v_lshlrev_b32 v7, 16, v66
    v_and_b32 v8, 0xffff0000, v66
    v_lshlrev_b32 v9, 16, v67
    v_and_b32 v10, 0xffff0000, v67
    v_mul_f32 v7, 0.15915494, v7
    v_mul_f32 v8, 0.15915494, v8
    v_mul_f32 v9, 0.15915494, v9
    v_mul_f32 v10, 0.15915494, v10
    v_mul_hi_u32_u24 v14, 429497, v68
    v_lshrrev_b32 v12, 3, v72
    v_cos_f32 v7, v7
    v_lshlrev_b16 v13, 3, v72
    v_mad_i32_i24 v11, v14, s55, v68
    v_bitop3_b32 v12, v6, v13, v12 bitop3:0xca
    v_lshl_add_u32 v11, v11, 17, s40
    v_lshlrev_b16 v14, 8, v14
    v_lshrrev_b32 v13, 2, v72
    v_add_u32 v68, v12, v11
    v_bitop3_b32 v72, v5, v13, v14 bitop3:0xea
    ds_add_u32 v72, v2
    v_mul_hi_u32_u24 v14, 429497, v69
    v_lshrrev_b32 v12, 3, v73
    v_cos_f32 v8, v8
    v_lshlrev_b16 v13, 3, v73
    v_mad_i32_i24 v11, v14, s55, v69
    v_bitop3_b32 v12, v6, v13, v12 bitop3:0xca
    v_lshl_add_u32 v11, v11, 17, s40
    v_lshlrev_b16 v14, 8, v14
    v_lshrrev_b32 v13, 2, v73
    v_add_u32 v69, v12, v11
    v_bitop3_b32 v73, v5, v13, v14 bitop3:0xea
    ds_add_u32 v73, v2
    v_cvt_pk_bf16_f32 v66, v7, v8
    v_perm_b32 v12, v66, v66, s41
    v_bitop3_b32 v68, v4, v12, v68 bitop3:0xca
    v_perm_b32 v13, v66, v66, s42
    v_bitop3_b32 v69, v4, v13, v69 bitop3:0xca
    v_mul_hi_u32_u24 v14, 429497, v70
    v_lshrrev_b32 v12, 3, v74
    v_cos_f32 v9, v9
    v_lshlrev_b16 v13, 3, v74
    v_mad_i32_i24 v11, v14, s55, v70
    v_bitop3_b32 v12, v6, v13, v12 bitop3:0xca
    v_lshl_add_u32 v11, v11, 17, s40
    v_lshlrev_b16 v14, 8, v14
    v_lshrrev_b32 v13, 2, v74
    v_add_u32 v70, v12, v11
    v_bitop3_b32 v74, v5, v13, v14 bitop3:0xea
    ds_add_u32 v74, v2
    v_mul_hi_u32_u24 v14, 429497, v71
    v_lshrrev_b32 v12, 3, v75
    v_cos_f32 v10, v10
    v_lshlrev_b16 v13, 3, v75
    v_mad_i32_i24 v11, v14, s55, v71
    v_bitop3_b32 v12, v6, v13, v12 bitop3:0xca
    v_lshl_add_u32 v11, v11, 17, s40
    v_lshlrev_b16 v14, 8, v14
    v_lshrrev_b32 v13, 2, v75
    v_add_u32 v71, v12, v11
    v_bitop3_b32 v75, v5, v13, v14 bitop3:0xea
    ds_add_u32 v75, v2
    v_cvt_pk_bf16_f32 v67, v9, v10
    v_perm_b32 v12, v67, v67, s41
    v_bitop3_b32 v70, v4, v12, v70 bitop3:0xca
    v_perm_b32 v13, v67, v67, s42
    v_bitop3_b32 v71, v4, v13, v71 bitop3:0xca
    s_setprio 0
    s_add_u32 s44, s97, 0x2400000
    v_lshlrev_b32 v100, 1, v1
    buffer_load_dwordx4 v[100:103], v100, s[8:11], s44 offen nt
    s_waitcnt vmcnt(7)
    v_lshlrev_b32 v7, 16, v84
    v_and_b32 v8, 0xffff0000, v84
    v_lshlrev_b32 v9, 16, v85
    v_and_b32 v10, 0xffff0000, v85
    v_mul_f32 v7, 0.15915494, v7
    v_mul_f32 v8, 0.15915494, v8
    v_mul_f32 v9, 0.15915494, v9
    v_mul_f32 v10, 0.15915494, v10
    v_mul_hi_u32_u24 v14, 429497, v76
    v_lshrrev_b32 v12, 3, v80
    v_cos_f32 v7, v7
    v_lshlrev_b16 v13, 3, v80
    v_mad_i32_i24 v11, v14, s55, v76
    v_bitop3_b32 v12, v6, v13, v12 bitop3:0xca
    v_lshl_add_u32 v11, v11, 17, s40
    v_lshlrev_b16 v14, 8, v14
    v_lshrrev_b32 v13, 2, v80
    v_add_u32 v76, v12, v11
    v_bitop3_b32 v80, v5, v13, v14 bitop3:0xea
    ds_add_u32 v80, v2
    v_mul_hi_u32_u24 v14, 429497, v77
    v_lshrrev_b32 v12, 3, v81
    v_cos_f32 v8, v8
    v_lshlrev_b16 v13, 3, v81
    v_mad_i32_i24 v11, v14, s55, v77
    v_bitop3_b32 v12, v6, v13, v12 bitop3:0xca
    v_lshl_add_u32 v11, v11, 17, s40
    v_lshlrev_b16 v14, 8, v14
    v_lshrrev_b32 v13, 2, v81
    v_add_u32 v77, v12, v11
    v_bitop3_b32 v81, v5, v13, v14 bitop3:0xea
    ds_add_u32 v81, v2
    v_cvt_pk_bf16_f32 v84, v7, v8
    v_perm_b32 v12, v84, v84, s41
    v_bitop3_b32 v76, v4, v12, v76 bitop3:0xca
    v_perm_b32 v13, v84, v84, s42
    v_bitop3_b32 v77, v4, v13, v77 bitop3:0xca
    v_mul_hi_u32_u24 v14, 429497, v78
    v_lshrrev_b32 v12, 3, v82
    v_cos_f32 v9, v9
    v_lshlrev_b16 v13, 3, v82
    v_mad_i32_i24 v11, v14, s55, v78
    v_bitop3_b32 v12, v6, v13, v12 bitop3:0xca
    v_lshl_add_u32 v11, v11, 17, s40
    v_lshlrev_b16 v14, 8, v14
    v_lshrrev_b32 v13, 2, v82
    v_add_u32 v78, v12, v11
    v_bitop3_b32 v82, v5, v13, v14 bitop3:0xea
    ds_add_u32 v82, v2
    v_mul_hi_u32_u24 v14, 429497, v79
    v_lshrrev_b32 v12, 3, v83
    v_cos_f32 v10, v10
    v_lshlrev_b16 v13, 3, v83
    v_mad_i32_i24 v11, v14, s55, v79
    v_bitop3_b32 v12, v6, v13, v12 bitop3:0xca
    v_lshl_add_u32 v11, v11, 17, s40
    v_lshlrev_b16 v14, 8, v14
    v_lshrrev_b32 v13, 2, v83
    v_add_u32 v79, v12, v11
    v_bitop3_b32 v83, v5, v13, v14 bitop3:0xea
    ds_add_u32 v83, v2
    v_cvt_pk_bf16_f32 v85, v9, v10
    v_perm_b32 v12, v85, v85, s41
    v_bitop3_b32 v78, v4, v12, v78 bitop3:0xca
    v_perm_b32 v13, v85, v85, s42
    v_bitop3_b32 v79, v4, v13, v79 bitop3:0xca
    s_waitcnt vmcnt(5)
    v_lshlrev_b32 v7, 16, v86
    v_and_b32 v8, 0xffff0000, v86
    v_lshlrev_b32 v9, 16, v87
    v_and_b32 v10, 0xffff0000, v87
    v_mul_f32 v7, 0.15915494, v7
    v_mul_f32 v8, 0.15915494, v8
    v_mul_f32 v9, 0.15915494, v9
    v_mul_f32 v10, 0.15915494, v10
    v_mul_hi_u32_u24 v14, 429497, v88
    v_lshrrev_b32 v12, 3, v92
    v_cos_f32 v7, v7
    v_lshlrev_b16 v13, 3, v92
    v_mad_i32_i24 v11, v14, s55, v88
    v_bitop3_b32 v12, v6, v13, v12 bitop3:0xca
    v_lshl_add_u32 v11, v11, 17, s40
    v_lshlrev_b16 v14, 8, v14
    v_lshrrev_b32 v13, 2, v92
    v_add_u32 v88, v12, v11
    v_bitop3_b32 v92, v5, v13, v14 bitop3:0xea
    ds_add_u32 v92, v2
    v_mul_hi_u32_u24 v14, 429497, v89
    v_lshrrev_b32 v12, 3, v93
    v_cos_f32 v8, v8
    v_lshlrev_b16 v13, 3, v93
    v_mad_i32_i24 v11, v14, s55, v89
    v_bitop3_b32 v12, v6, v13, v12 bitop3:0xca
    v_lshl_add_u32 v11, v11, 17, s40
    v_lshlrev_b16 v14, 8, v14
    v_lshrrev_b32 v13, 2, v93
    v_add_u32 v89, v12, v11
    v_bitop3_b32 v93, v5, v13, v14 bitop3:0xea
    ds_add_u32 v93, v2
    v_cvt_pk_bf16_f32 v86, v7, v8
    v_perm_b32 v12, v86, v86, s41
    v_bitop3_b32 v88, v4, v12, v88 bitop3:0xca
    v_perm_b32 v13, v86, v86, s42
    v_bitop3_b32 v89, v4, v13, v89 bitop3:0xca
    v_mul_hi_u32_u24 v14, 429497, v90
    v_lshrrev_b32 v12, 3, v94
    v_cos_f32 v9, v9
    v_lshlrev_b16 v13, 3, v94
    v_mad_i32_i24 v11, v14, s55, v90
    v_bitop3_b32 v12, v6, v13, v12 bitop3:0xca
    v_lshl_add_u32 v11, v11, 17, s40
    v_lshlrev_b16 v14, 8, v14
    v_lshrrev_b32 v13, 2, v94
    v_add_u32 v90, v12, v11
    v_bitop3_b32 v94, v5, v13, v14 bitop3:0xea
    ds_add_u32 v94, v2
    v_mul_hi_u32_u24 v14, 429497, v91
    v_lshrrev_b32 v12, 3, v95
    v_cos_f32 v10, v10
    v_lshlrev_b16 v13, 3, v95
    v_mad_i32_i24 v11, v14, s55, v91
    v_bitop3_b32 v12, v6, v13, v12 bitop3:0xca
    v_lshl_add_u32 v11, v11, 17, s40
    v_lshlrev_b16 v14, 8, v14
    v_lshrrev_b32 v13, 2, v95
    v_add_u32 v91, v12, v11
    v_bitop3_b32 v95, v5, v13, v14 bitop3:0xea
    ds_add_u32 v95, v2
    v_cvt_pk_bf16_f32 v87, v9, v10
    v_perm_b32 v12, v87, v87, s41
    v_bitop3_b32 v90, v4, v12, v90 bitop3:0xca
    v_perm_b32 v13, v87, v87, s42
    v_bitop3_b32 v91, v4, v13, v91 bitop3:0xca
    v_lshrrev_b32 v8, 2, v0
    v_and_b32 v7, 0x3c00, v0
    v_bitop3_b32 v7, v5, v8, v7 bitop3:0xea
    s_waitcnt lgkmcnt(0)
    s_barrier
    ds_read2st64_b32 v[8:9], v7 offset0:0 offset1:1
    ds_read2st64_b32 v[10:11], v7 offset0:2 offset1:3
    s_add_u32 s45, s97, 0x2400000
    v_lshlrev_b32 v112, 1, v1
    buffer_load_dwordx4 v[112:115], v112, s[12:15], s45 offen nt
    s_waitcnt lgkmcnt(0)
    v_lshl_or_b32 v12, v9, 16, v8
    v_lshl_or_b32 v13, v11, 16, v10
    v_mov_b32 v14, v12
    v_mov_b32 v15, v13
    s_nop 0
    v_add_u32_dpp v14, v14, v14 row_shr:1 row_mask:0xf bank_mask:0xf bound_ctrl:1
    v_add_u32_dpp v15, v15, v15 row_shr:1 row_mask:0xf bank_mask:0xf bound_ctrl:1
    s_nop 0
    v_add_u32_dpp v14, v14, v14 row_shr:2 row_mask:0xf bank_mask:0xf bound_ctrl:1
    v_add_u32_dpp v15, v15, v15 row_shr:2 row_mask:0xf bank_mask:0xf bound_ctrl:1
    s_nop 0
    v_add_u32_dpp v14, v14, v14 row_shr:4 row_mask:0xf bank_mask:0xf bound_ctrl:1
    v_add_u32_dpp v15, v15, v15 row_shr:4 row_mask:0xf bank_mask:0xf bound_ctrl:1
    s_nop 0
    v_add_u32_dpp v14, v14, v14 row_shr:8 row_mask:0xf bank_mask:0xf bound_ctrl:1
    v_add_u32_dpp v15, v15, v15 row_shr:8 row_mask:0xf bank_mask:0xf bound_ctrl:1
    s_nop 0
    v_add_u32_dpp v14, v14, v14 row_bcast:15 row_mask:0xa bank_mask:0xf
    v_add_u32_dpp v15, v15, v15 row_bcast:15 row_mask:0xa bank_mask:0xf
    s_nop 0
    v_add_u32_dpp v14, v14, v14 row_bcast:31 row_mask:0xc bank_mask:0xf
    v_add_u32_dpp v15, v15, v15 row_bcast:31 row_mask:0xc bank_mask:0xf
    v_readlane_b32 s48, v14, 63
    v_readlane_b32 s49, v15, 63
    s_lshl_b32 s54, s32, 2
    v_mov_b32 v8, s54
    s_and_b32 s50, s48, 0xffff
    s_lshr_b32 s51, s48, 16
    s_and_b32 s52, s49, 0xffff
    s_lshr_b32 s53, s49, 16
    s_add_u32 s51, s51, s50
    s_add_u32 s52, s52, s51
    s_add_u32 s53, s53, s52
    v_mov_b32 v9, s53
    s_mov_b64 exec, 1
    ds_write_b32 v8, v9 offset:16384
    s_mov_b64 exec, -1
    v_and_b32 v8, 60, v7
    s_waitcnt lgkmcnt(0)
    s_barrier
    ds_read_b32 v9, v8 offset:16384
    s_waitcnt lgkmcnt(0)
    v_add_u32_dpp v9, v9, v9 row_shr:1 row_mask:0xf bank_mask:0xf bound_ctrl:1
    s_nop 1
    v_add_u32_dpp v9, v9, v9 row_shr:2 row_mask:0xf bank_mask:0xf bound_ctrl:1
    s_nop 1
    v_add_u32_dpp v9, v9, v9 row_shr:4 row_mask:0xf bank_mask:0xf bound_ctrl:1
    s_nop 1
    v_add_u32_dpp v9, v9, v9 row_shr:8 row_mask:0xf bank_mask:0xf bound_ctrl:1
    s_nop 0
    v_readlane_b32 s54, v9, s32
    s_sub_u32 s54, s54, s53
    s_add_u32 s50, s50, s54
    s_add_u32 s51, s51, s54
    s_add_u32 s52, s52, s54
    s_pack_ll_b32_b16 s48, s54, s50
    s_pack_ll_b32_b16 s49, s51, s52
    v_add_u32 v14, s48, v14
    v_add_u32 v15, s49, v15
    v_sub_u32 v12, v14, v12
    v_sub_u32 v13, v15, v13
    v_and_b32 v8, 0xffff, v12
    v_lshrrev_b32 v9, 16, v12
    v_and_b32 v10, 0xffff, v13
    v_lshrrev_b32 v11, 16, v13
    ds_write2st64_b32 v7, v8, v9 offset0:0 offset1:1
    ds_write2st64_b32 v7, v10, v11 offset0:2 offset1:3
    v_and_b32 v8, 0x3f0, v0
    v_lshl_add_u32 v8, v8, 1, s36
    ds_write_b64 v8, v[12:13] offset:20480
    s_bitset0_b64 exec, 63
    s_not_b64 exec, exec
    ds_write_b64 v8, v[14:15] offset:20512
    s_mov_b64 exec, -1
    s_waitcnt lgkmcnt(0)
    s_barrier
    s_setprio 3
    ds_add_rtn_u32 v20, v20, v2
    ds_add_rtn_u32 v21, v21, v2
    ds_add_rtn_u32 v22, v22, v2
    ds_add_rtn_u32 v23, v23, v2
    ds_read_b128 v[12:15], v0 offset:20480
    v_cmp_gt_u32 vcc, 8448, v0
    ds_add_rtn_u32 v32, v32, v2
    ds_add_rtn_u32 v33, v33, v2
    ds_add_rtn_u32 v34, v34, v2
    ds_add_rtn_u32 v35, v35, v2
    s_setprio 2
    ds_add_rtn_u32 v40, v40, v2
    ds_add_rtn_u32 v41, v41, v2
    ds_add_rtn_u32 v42, v42, v2
    ds_add_rtn_u32 v43, v43, v2
    s_waitcnt lgkmcnt(8)
    s_cbranch_vccz L1_p1
    s_add_u32 s46, s35, 0x0
    s_mov_b64 exec, vcc
    buffer_store_dwordx4 v[12:15], v0, s[24:27], s46 offen sc1
    s_mov_b64 exec, -1
L1_p1:
    s_add_u32 s47, s98, 0x2800000
    v_lshlrev_b32 v116, 1, v1
    buffer_load_dwordx4 v[116:119], v116, s[8:11], s47 offen nt
    ds_add_rtn_u32 v52, v52, v2
    ds_add_rtn_u32 v53, v53, v2
    ds_add_rtn_u32 v54, v54, v2
    ds_add_rtn_u32 v55, v55, v2
    s_setprio 1
    ds_add_rtn_u32 v60, v60, v2
    ds_add_rtn_u32 v61, v61, v2
    ds_add_rtn_u32 v62, v62, v2
    ds_add_rtn_u32 v63, v63, v2
    ds_add_rtn_u32 v72, v72, v2
    ds_add_rtn_u32 v73, v73, v2
    ds_add_rtn_u32 v74, v74, v2
    ds_add_rtn_u32 v75, v75, v2
    s_add_u32 s44, s98, 0x2800000
    v_lshlrev_b32 v120, 1, v1
    buffer_load_dwordx4 v[120:123], v120, s[12:15], s44 offen nt
    s_setprio 0
    ds_add_rtn_u32 v80, v80, v2
    ds_add_rtn_u32 v81, v81, v2
    ds_add_rtn_u32 v82, v82, v2
    ds_add_rtn_u32 v83, v83, v2
    ds_add_rtn_u32 v92, v92, v2
    ds_add_rtn_u32 v93, v93, v2
    ds_add_rtn_u32 v94, v94, v2
    ds_add_rtn_u32 v95, v95, v2
    s_waitcnt lgkmcnt(0)
    s_barrier
    s_setprio 3
    v_and_b32 v7, -4, v20
    v_lshl_add_u32 v8, v20, 2, v7
    ds_write_b32 v8, v16
    v_lshl_add_u32 v7, v7, 2, v20
    ds_write_b8 v7, v24 offset:16
    v_and_b32 v9, -4, v21
    v_lshl_add_u32 v10, v21, 2, v9
    ds_write_b32 v10, v17
    v_lshl_add_u32 v9, v9, 2, v21
    ds_write_b8_d16_hi v9, v24 offset:16
    v_and_b32 v7, -4, v22
    v_lshl_add_u32 v8, v22, 2, v7
    ds_write_b32 v8, v18
    v_lshl_add_u32 v7, v7, 2, v22
    ds_write_b8 v7, v25 offset:16
    v_and_b32 v9, -4, v23
    v_lshl_add_u32 v10, v23, 2, v9
    ds_write_b32 v10, v19
    v_lshl_add_u32 v9, v9, 2, v23
    ds_write_b8_d16_hi v9, v25 offset:16
    s_add_u32 s45, s98, 0x2800000
    s_lshr_b32 s45, s45, 1
    buffer_load_dwordx2 v[124:125], v1, s[16:19], s45 offen nt
    s_add_u32 s46, s99, 0x2c00000
    s_lshr_b32 s46, s46, 1
    buffer_load_dwordx2 v[126:127], v1, s[16:19], s46 offen nt
    s_add_u32 s47, s99, 0x2c00000
    v_lshlrev_b32 v16, 1, v1
    buffer_load_dwordx4 v[16:19], v16, s[8:11], s47 offen nt
    v_and_b32 v7, -4, v32
    v_lshl_add_u32 v8, v32, 2, v7
    ds_write_b32 v8, v28
    v_lshl_add_u32 v7, v7, 2, v32
    ds_write_b8 v7, v26 offset:16
    v_and_b32 v9, -4, v33
    v_lshl_add_u32 v10, v33, 2, v9
    ds_write_b32 v10, v29
    v_lshl_add_u32 v9, v9, 2, v33
    ds_write_b8_d16_hi v9, v26 offset:16
    v_and_b32 v7, -4, v34
    v_lshl_add_u32 v8, v34, 2, v7
    ds_write_b32 v8, v30
    v_lshl_add_u32 v7, v7, 2, v34
    ds_write_b8 v7, v27 offset:16
    v_and_b32 v9, -4, v35
    v_lshl_add_u32 v10, v35, 2, v9
    ds_write_b32 v10, v31
    v_lshl_add_u32 v9, v9, 2, v35
    ds_write_b8_d16_hi v9, v27 offset:16
    s_add_u32 s44, s99, 0x2c00000
    v_lshlrev_b32 v20, 1, v1
    buffer_load_dwordx4 v[20:23], v20, s[12:15], s44 offen nt
    s_setprio 2
    v_and_b32 v7, -4, v40
    v_lshl_add_u32 v8, v40, 2, v7
    ds_write_b32 v8, v36
    v_lshl_add_u32 v7, v7, 2, v40
    ds_write_b8 v7, v44 offset:16
    v_and_b32 v9, -4, v41
    v_lshl_add_u32 v10, v41, 2, v9
    ds_write_b32 v10, v37
    v_lshl_add_u32 v9, v9, 2, v41
    ds_write_b8_d16_hi v9, v44 offset:16
    v_and_b32 v7, -4, v42
    v_lshl_add_u32 v8, v42, 2, v7
    ds_write_b32 v8, v38
    v_lshl_add_u32 v7, v7, 2, v42
    ds_write_b8 v7, v45 offset:16
    v_and_b32 v9, -4, v43
    v_lshl_add_u32 v10, v43, 2, v9
    ds_write_b32 v10, v39
    v_lshl_add_u32 v9, v9, 2, v43
    ds_write_b8_d16_hi v9, v45 offset:16
    s_add_u32 s45, s96, 0x3000000
    v_lshlrev_b32 v28, 1, v1
    buffer_load_dwordx4 v[28:31], v28, s[8:11], s45 offen nt
    s_add_u32 s46, s96, 0x3000000
    v_lshlrev_b32 v32, 1, v1
    buffer_load_dwordx4 v[32:35], v32, s[12:15], s46 offen nt
    v_and_b32 v7, -4, v52
    v_lshl_add_u32 v8, v52, 2, v7
    ds_write_b32 v8, v48
    v_lshl_add_u32 v7, v7, 2, v52
    ds_write_b8 v7, v46 offset:16
    v_and_b32 v9, -4, v53
    v_lshl_add_u32 v10, v53, 2, v9
    ds_write_b32 v10, v49
    v_lshl_add_u32 v9, v9, 2, v53
    ds_write_b8_d16_hi v9, v46 offset:16
    v_and_b32 v7, -4, v54
    v_lshl_add_u32 v8, v54, 2, v7
    ds_write_b32 v8, v50
    v_lshl_add_u32 v7, v7, 2, v54
    ds_write_b8 v7, v47 offset:16
    v_and_b32 v9, -4, v55
    v_lshl_add_u32 v10, v55, 2, v9
    ds_write_b32 v10, v51
    v_lshl_add_u32 v9, v9, 2, v55
    ds_write_b8_d16_hi v9, v47 offset:16
    s_add_u32 s47, s96, 0x3000000
    s_lshr_b32 s47, s47, 1
    buffer_load_dwordx2 v[24:25], v1, s[16:19], s47 offen nt
    s_add_u32 s44, s97, 0x3400000
    s_lshr_b32 s44, s44, 1
    buffer_load_dwordx2 v[26:27], v1, s[16:19], s44 offen nt
    s_setprio 1
    v_and_b32 v7, -4, v60
    v_lshl_add_u32 v8, v60, 2, v7
    ds_write_b32 v8, v56
    v_lshl_add_u32 v7, v7, 2, v60
    ds_write_b8 v7, v64 offset:16
    v_and_b32 v9, -4, v61
    v_lshl_add_u32 v10, v61, 2, v9
    ds_write_b32 v10, v57
    v_lshl_add_u32 v9, v9, 2, v61
    ds_write_b8_d16_hi v9, v64 offset:16
    v_and_b32 v7, -4, v62
    v_lshl_add_u32 v8, v62, 2, v7
    ds_write_b32 v8, v58
    v_lshl_add_u32 v7, v7, 2, v62
    ds_write_b8 v7, v65 offset:16
    v_and_b32 v9, -4, v63
    v_lshl_add_u32 v10, v63, 2, v9
    ds_write_b32 v10, v59
    v_lshl_add_u32 v9, v9, 2, v63
    ds_write_b8_d16_hi v9, v65 offset:16
    s_add_u32 s45, s97, 0x3400000
    v_lshlrev_b32 v36, 1, v1
    buffer_load_dwordx4 v[36:39], v36, s[8:11], s45 offen nt
    v_and_b32 v7, -4, v72
    v_lshl_add_u32 v8, v72, 2, v7
    ds_write_b32 v8, v68
    v_lshl_add_u32 v7, v7, 2, v72
    ds_write_b8 v7, v66 offset:16
    v_and_b32 v9, -4, v73
    v_lshl_add_u32 v10, v73, 2, v9
    ds_write_b32 v10, v69
    v_lshl_add_u32 v9, v9, 2, v73
    ds_write_b8_d16_hi v9, v66 offset:16
    v_and_b32 v7, -4, v74
    v_lshl_add_u32 v8, v74, 2, v7
    ds_write_b32 v8, v70
    v_lshl_add_u32 v7, v7, 2, v74
    ds_write_b8 v7, v67 offset:16
    v_and_b32 v9, -4, v75
    v_lshl_add_u32 v10, v75, 2, v9
    ds_write_b32 v10, v71
    v_lshl_add_u32 v9, v9, 2, v75
    ds_write_b8_d16_hi v9, v67 offset:16
    s_add_u32 s46, s97, 0x3400000
    v_lshlrev_b32 v40, 1, v1
    buffer_load_dwordx4 v[40:43], v40, s[12:15], s46 offen nt
    s_add_u32 s47, s98, 0x3800000
    v_lshlrev_b32 v48, 1, v1
    buffer_load_dwordx4 v[48:51], v48, s[8:11], s47 offen nt
    s_setprio 0
    v_and_b32 v7, -4, v80
    v_lshl_add_u32 v8, v80, 2, v7
    ds_write_b32 v8, v76
    v_lshl_add_u32 v7, v7, 2, v80
    ds_write_b8 v7, v84 offset:16
    v_and_b32 v9, -4, v81
    v_lshl_add_u32 v10, v81, 2, v9
    ds_write_b32 v10, v77
    v_lshl_add_u32 v9, v9, 2, v81
    ds_write_b8_d16_hi v9, v84 offset:16
    v_and_b32 v7, -4, v82
    v_lshl_add_u32 v8, v82, 2, v7
    ds_write_b32 v8, v78
    v_lshl_add_u32 v7, v7, 2, v82
    ds_write_b8 v7, v85 offset:16
    v_and_b32 v9, -4, v83
    v_lshl_add_u32 v10, v83, 2, v9
    ds_write_b32 v10, v79
    v_lshl_add_u32 v9, v9, 2, v83
    ds_write_b8_d16_hi v9, v85 offset:16
    s_add_u32 s44, s98, 0x3800000
    v_lshlrev_b32 v52, 1, v1
    buffer_load_dwordx4 v[52:55], v52, s[12:15], s44 offen nt
    v_and_b32 v7, -4, v92
    v_lshl_add_u32 v8, v92, 2, v7
    ds_write_b32 v8, v88
    v_lshl_add_u32 v7, v7, 2, v92
    ds_write_b8 v7, v86 offset:16
    v_and_b32 v9, -4, v93
    v_lshl_add_u32 v10, v93, 2, v9
    ds_write_b32 v10, v89
    v_lshl_add_u32 v9, v9, 2, v93
    ds_write_b8_d16_hi v9, v86 offset:16
    v_and_b32 v7, -4, v94
    v_lshl_add_u32 v8, v94, 2, v7
    ds_write_b32 v8, v90
    v_lshl_add_u32 v7, v7, 2, v94
    ds_write_b8 v7, v87 offset:16
    v_and_b32 v9, -4, v95
    v_lshl_add_u32 v10, v95, 2, v9
    ds_write_b32 v10, v91
    v_lshl_add_u32 v9, v9, 2, v95
    ds_write_b8_d16_hi v9, v87 offset:16
    s_add_u32 s45, s98, 0x3800000
    s_lshr_b32 s45, s45, 1
    buffer_load_dwordx2 v[44:45], v1, s[16:19], s45 offen nt
    s_add_u32 s46, s99, 0x3c00000
    s_lshr_b32 s46, s46, 1
    buffer_load_dwordx2 v[46:47], v1, s[16:19], s46 offen nt
    v_add_u32 v7, s72, v0
    v_add_u32 v12, s73, v0
    v_add_u32 v13, s85, v0
    v_add_u32 v14, s91, v0
    v_add_u32 v15, s93, v0
    s_min_i32 s3, s72, s73
    s_min_i32 s3, s3, s85
    s_min_i32 s3, s3, s91
    s_min_i32 s3, s3, s93
    v_add_u32 v3, s3, v0
    v_mov_b32 v8, 0
    v_mov_b32 v9, 0
    v_mov_b32 v10, 0
    v_mov_b32 v11, 0
    s_waitcnt lgkmcnt(0)
    s_barrier
    ds_read_b128 v[56:59], v7 offset:0
    ds_read_b128 v[60:63], v12 offset:0
    ds_read_b128 v[68:71], v13 offset:0
    ds_read_b128 v[72:75], v14 offset:0
    ds_read_b128 v[64:67], v15 offset:0
    ds_write_b128 v3, v[8:11]
    ds_read_b128 v[76:79], v7 offset:16384
    ds_read_b128 v[80:83], v12 offset:16384
    ds_read_b128 v[88:91], v13 offset:16384
    ds_read_b128 v[92:95], v14 offset:16384
    ds_read_b128 v[84:87], v15 offset:16384
    s_waitcnt lgkmcnt(0)
    s_barrier
    s_setprio 3
    s_add_u32 s47, s35, 0x4000
    s_add_u32 s47, s47, s72
    buffer_store_dwordx4 v[56:59], v0, s[20:23], s47 offen sc1
    s_add_u32 s44, s99, 0x3c00000
    s_nop 0
    v_lshlrev_b32 v56, 1, v1
    buffer_load_dwordx4 v[56:59], v56, s[8:11], s44 offen nt
    s_add_u32 s45, s35, 0x4000
    s_add_u32 s45, s45, s73
    buffer_store_dwordx4 v[60:63], v0, s[20:23], s45 offen sc1
    s_add_u32 s46, s99, 0x3c00000
    s_nop 0
    v_lshlrev_b32 v60, 1, v1
    buffer_load_dwordx4 v[60:63], v60, s[12:15], s46 offen nt
    s_waitcnt vmcnt(22)
    v_lshlrev_b32 v7, 16, v108
    v_and_b32 v8, 0xffff0000, v108
    v_lshlrev_b32 v9, 16, v109
    v_and_b32 v10, 0xffff0000, v109
    v_mul_f32 v7, 0.15915494, v7
    v_mul_f32 v8, 0.15915494, v8
    v_mul_f32 v9, 0.15915494, v9
    v_mul_f32 v10, 0.15915494, v10
    v_mul_hi_u32_u24 v14, 429497, v96
    v_lshrrev_b32 v12, 3, v104
    v_cos_f32 v7, v7
    v_lshlrev_b16 v13, 3, v104
    v_mad_i32_i24 v11, v14, s55, v96
    v_bitop3_b32 v12, v6, v13, v12 bitop3:0xca
    v_lshl_add_u32 v11, v11, 17, s40
    v_lshlrev_b16 v14, 8, v14
    v_lshrrev_b32 v13, 2, v104
    v_add_u32 v96, v12, v11
    v_bitop3_b32 v104, v5, v13, v14 bitop3:0xea
    ds_add_u32 v104, v2
    v_mul_hi_u32_u24 v14, 429497, v97
    v_lshrrev_b32 v12, 3, v105
    v_cos_f32 v8, v8
    v_lshlrev_b16 v13, 3, v105
    v_mad_i32_i24 v11, v14, s55, v97
    v_bitop3_b32 v12, v6, v13, v12 bitop3:0xca
    v_lshl_add_u32 v11, v11, 17, s40
    v_lshlrev_b16 v14, 8, v14
    v_lshrrev_b32 v13, 2, v105
    v_add_u32 v97, v12, v11
    v_bitop3_b32 v105, v5, v13, v14 bitop3:0xea
    ds_add_u32 v105, v2
    v_cvt_pk_bf16_f32 v108, v7, v8
    v_perm_b32 v12, v108, v108, s41
    v_bitop3_b32 v96, v4, v12, v96 bitop3:0xca
    v_perm_b32 v13, v108, v108, s42
    v_bitop3_b32 v97, v4, v13, v97 bitop3:0xca
    v_mul_hi_u32_u24 v14, 429497, v98
    v_lshrrev_b32 v12, 3, v106
    v_cos_f32 v9, v9
    v_lshlrev_b16 v13, 3, v106
    v_mad_i32_i24 v11, v14, s55, v98
    v_bitop3_b32 v12, v6, v13, v12 bitop3:0xca
    v_lshl_add_u32 v11, v11, 17, s40
    v_lshlrev_b16 v14, 8, v14
    v_lshrrev_b32 v13, 2, v106
    v_add_u32 v98, v12, v11
    v_bitop3_b32 v106, v5, v13, v14 bitop3:0xea
    ds_add_u32 v106, v2
    v_mul_hi_u32_u24 v14, 429497, v99
    v_lshrrev_b32 v12, 3, v107
    v_cos_f32 v10, v10
    v_lshlrev_b16 v13, 3, v107
    v_mad_i32_i24 v11, v14, s55, v99
    v_bitop3_b32 v12, v6, v13, v12 bitop3:0xca
    v_lshl_add_u32 v11, v11, 17, s40
    v_lshlrev_b16 v14, 8, v14
    v_lshrrev_b32 v13, 2, v107
    v_add_u32 v99, v12, v11
    v_bitop3_b32 v107, v5, v13, v14 bitop3:0xea
    ds_add_u32 v107, v2
    v_cvt_pk_bf16_f32 v109, v9, v10
    v_perm_b32 v12, v109, v109, s41
    v_bitop3_b32 v98, v4, v12, v98 bitop3:0xca
    v_perm_b32 v13, v109, v109, s42
    v_bitop3_b32 v99, v4, v13, v99 bitop3:0xca
    s_waitcnt vmcnt(20)
    v_lshlrev_b32 v7, 16, v110
    v_and_b32 v8, 0xffff0000, v110
    v_lshlrev_b32 v9, 16, v111
    v_and_b32 v10, 0xffff0000, v111
    v_mul_f32 v7, 0.15915494, v7
    v_mul_f32 v8, 0.15915494, v8
    v_mul_f32 v9, 0.15915494, v9
    v_mul_f32 v10, 0.15915494, v10
    v_mul_hi_u32_u24 v14, 429497, v100
    v_lshrrev_b32 v12, 3, v112
    v_cos_f32 v7, v7
    v_lshlrev_b16 v13, 3, v112
    v_mad_i32_i24 v11, v14, s55, v100
    v_bitop3_b32 v12, v6, v13, v12 bitop3:0xca
    v_lshl_add_u32 v11, v11, 17, s40
    v_lshlrev_b16 v14, 8, v14
    v_lshrrev_b32 v13, 2, v112
    v_add_u32 v100, v12, v11
    v_bitop3_b32 v112, v5, v13, v14 bitop3:0xea
    ds_add_u32 v112, v2
    v_mul_hi_u32_u24 v14, 429497, v101
    v_lshrrev_b32 v12, 3, v113
    v_cos_f32 v8, v8
    v_lshlrev_b16 v13, 3, v113
    v_mad_i32_i24 v11, v14, s55, v101
    v_bitop3_b32 v12, v6, v13, v12 bitop3:0xca
    v_lshl_add_u32 v11, v11, 17, s40
    v_lshlrev_b16 v14, 8, v14
    v_lshrrev_b32 v13, 2, v113
    v_add_u32 v101, v12, v11
    v_bitop3_b32 v113, v5, v13, v14 bitop3:0xea
    ds_add_u32 v113, v2
    v_cvt_pk_bf16_f32 v110, v7, v8
    v_perm_b32 v12, v110, v110, s41
    v_bitop3_b32 v100, v4, v12, v100 bitop3:0xca
    v_perm_b32 v13, v110, v110, s42
    v_bitop3_b32 v101, v4, v13, v101 bitop3:0xca
    v_mul_hi_u32_u24 v14, 429497, v102
    v_lshrrev_b32 v12, 3, v114
    v_cos_f32 v9, v9
    v_lshlrev_b16 v13, 3, v114
    v_mad_i32_i24 v11, v14, s55, v102
    v_bitop3_b32 v12, v6, v13, v12 bitop3:0xca
    v_lshl_add_u32 v11, v11, 17, s40
    v_lshlrev_b16 v14, 8, v14
    v_lshrrev_b32 v13, 2, v114
    v_add_u32 v102, v12, v11
    v_bitop3_b32 v114, v5, v13, v14 bitop3:0xea
    ds_add_u32 v114, v2
    v_mul_hi_u32_u24 v14, 429497, v103
    v_lshrrev_b32 v12, 3, v115
    v_cos_f32 v10, v10
    v_lshlrev_b16 v13, 3, v115
    v_mad_i32_i24 v11, v14, s55, v103
    v_bitop3_b32 v12, v6, v13, v12 bitop3:0xca
    v_lshl_add_u32 v11, v11, 17, s40
    v_lshlrev_b16 v14, 8, v14
    v_lshrrev_b32 v13, 2, v115
    v_add_u32 v103, v12, v11
    v_bitop3_b32 v115, v5, v13, v14 bitop3:0xea
    ds_add_u32 v115, v2
    v_cvt_pk_bf16_f32 v111, v9, v10
    v_perm_b32 v12, v111, v111, s41
    v_bitop3_b32 v102, v4, v12, v102 bitop3:0xca
    v_perm_b32 v13, v111, v111, s42
    v_bitop3_b32 v103, v4, v13, v103 bitop3:0xca
    s_setprio 2
    s_waitcnt vmcnt(16)
    v_lshlrev_b32 v7, 16, v124
    v_and_b32 v8, 0xffff0000, v124
    v_lshlrev_b32 v9, 16, v125
    v_and_b32 v10, 0xffff0000, v125
    v_mul_f32 v7, 0.15915494, v7
    v_mul_f32 v8, 0.15915494, v8
    v_mul_f32 v9, 0.15915494, v9
    v_mul_f32 v10, 0.15915494, v10
    v_mul_hi_u32_u24 v14, 429497, v116
    v_lshrrev_b32 v12, 3, v120
    v_cos_f32 v7, v7
    v_lshlrev_b16 v13, 3, v120
    v_mad_i32_i24 v11, v14, s55, v116
    v_bitop3_b32 v12, v6, v13, v12 bitop3:0xca
    v_lshl_add_u32 v11, v11, 17, s40
    v_lshlrev_b16 v14, 8, v14
    v_lshrrev_b32 v13, 2, v120
    v_add_u32 v116, v12, v11
    v_bitop3_b32 v120, v5, v13, v14 bitop3:0xea
    ds_add_u32 v120, v2
    v_mul_hi_u32_u24 v14, 429497, v117
    v_lshrrev_b32 v12, 3, v121
    v_cos_f32 v8, v8
    v_lshlrev_b16 v13, 3, v121
    v_mad_i32_i24 v11, v14, s55, v117
    v_bitop3_b32 v12, v6, v13, v12 bitop3:0xca
    v_lshl_add_u32 v11, v11, 17, s40
    v_lshlrev_b16 v14, 8, v14
    v_lshrrev_b32 v13, 2, v121
    v_add_u32 v117, v12, v11
    v_bitop3_b32 v121, v5, v13, v14 bitop3:0xea
    ds_add_u32 v121, v2
    v_cvt_pk_bf16_f32 v124, v7, v8
    v_perm_b32 v12, v124, v124, s41
    v_bitop3_b32 v116, v4, v12, v116 bitop3:0xca
    v_perm_b32 v13, v124, v124, s42
    v_bitop3_b32 v117, v4, v13, v117 bitop3:0xca
    v_mul_hi_u32_u24 v14, 429497, v118
    v_lshrrev_b32 v12, 3, v122
    v_cos_f32 v9, v9
    v_lshlrev_b16 v13, 3, v122
    v_mad_i32_i24 v11, v14, s55, v118
    v_bitop3_b32 v12, v6, v13, v12 bitop3:0xca
    v_lshl_add_u32 v11, v11, 17, s40
    v_lshlrev_b16 v14, 8, v14
    v_lshrrev_b32 v13, 2, v122
    v_add_u32 v118, v12, v11
    v_bitop3_b32 v122, v5, v13, v14 bitop3:0xea
    ds_add_u32 v122, v2
    v_mul_hi_u32_u24 v14, 429497, v119
    v_lshrrev_b32 v12, 3, v123
    v_cos_f32 v10, v10
    v_lshlrev_b16 v13, 3, v123
    v_mad_i32_i24 v11, v14, s55, v119
    v_bitop3_b32 v12, v6, v13, v12 bitop3:0xca
    v_lshl_add_u32 v11, v11, 17, s40
    v_lshlrev_b16 v14, 8, v14
    v_lshrrev_b32 v13, 2, v123
    v_add_u32 v119, v12, v11
    v_bitop3_b32 v123, v5, v13, v14 bitop3:0xea
    ds_add_u32 v123, v2
    v_cvt_pk_bf16_f32 v125, v9, v10
    v_perm_b32 v12, v125, v125, s41
    v_bitop3_b32 v118, v4, v12, v118 bitop3:0xca
    v_perm_b32 v13, v125, v125, s42
    v_bitop3_b32 v119, v4, v13, v119 bitop3:0xca
    s_add_u32 s47, s35, 0x4000
    s_add_u32 s47, s47, s85
    buffer_store_dwordx4 v[68:71], v0, s[20:23], s47 offen sc1
    s_add_u32 s44, s96, 0x4000000
    s_nop 0
    v_lshlrev_b32 v68, 1, v1
    buffer_load_dwordx4 v[68:71], v68, s[8:11], s44 offen nt
    s_waitcnt vmcnt(16)
    v_lshlrev_b32 v7, 16, v126
    v_and_b32 v8, 0xffff0000, v126
    v_lshlrev_b32 v9, 16, v127
    v_and_b32 v10, 0xffff0000, v127
    v_mul_f32 v7, 0.15915494, v7
    v_mul_f32 v8, 0.15915494, v8
    v_mul_f32 v9, 0.15915494, v9
    v_mul_f32 v10, 0.15915494, v10
    v_mul_hi_u32_u24 v14, 429497, v16
    v_lshrrev_b32 v12, 3, v20
    v_cos_f32 v7, v7
    v_lshlrev_b16 v13, 3, v20
    v_mad_i32_i24 v11, v14, s55, v16
    v_bitop3_b32 v12, v6, v13, v12 bitop3:0xca
    v_lshl_add_u32 v11, v11, 17, s40
    v_lshlrev_b16 v14, 8, v14
    v_lshrrev_b32 v13, 2, v20
    v_add_u32 v16, v12, v11
    v_bitop3_b32 v20, v5, v13, v14 bitop3:0xea
    ds_add_u32 v20, v2
    v_mul_hi_u32_u24 v14, 429497, v17
    v_lshrrev_b32 v12, 3, v21
    v_cos_f32 v8, v8
    v_lshlrev_b16 v13, 3, v21
    v_mad_i32_i24 v11, v14, s55, v17
    v_bitop3_b32 v12, v6, v13, v12 bitop3:0xca
    v_lshl_add_u32 v11, v11, 17, s40
    v_lshlrev_b16 v14, 8, v14
    v_lshrrev_b32 v13, 2, v21
    v_add_u32 v17, v12, v11
    v_bitop3_b32 v21, v5, v13, v14 bitop3:0xea
    ds_add_u32 v21, v2
    v_cvt_pk_bf16_f32 v126, v7, v8
    v_perm_b32 v12, v126, v126, s41
    v_bitop3_b32 v16, v4, v12, v16 bitop3:0xca
    v_perm_b32 v13, v126, v126, s42
    v_bitop3_b32 v17, v4, v13, v17 bitop3:0xca
    v_mul_hi_u32_u24 v14, 429497, v18
    v_lshrrev_b32 v12, 3, v22
    v_cos_f32 v9, v9
    v_lshlrev_b16 v13, 3, v22
    v_mad_i32_i24 v11, v14, s55, v18
    v_bitop3_b32 v12, v6, v13, v12 bitop3:0xca
    v_lshl_add_u32 v11, v11, 17, s40
    v_lshlrev_b16 v14, 8, v14
    v_lshrrev_b32 v13, 2, v22
    v_add_u32 v18, v12, v11
    v_bitop3_b32 v22, v5, v13, v14 bitop3:0xea
    ds_add_u32 v22, v2
    v_mul_hi_u32_u24 v14, 429497, v19
    v_lshrrev_b32 v12, 3, v23
    v_cos_f32 v10, v10
    v_lshlrev_b16 v13, 3, v23
    v_mad_i32_i24 v11, v14, s55, v19
    v_bitop3_b32 v12, v6, v13, v12 bitop3:0xca
    v_lshl_add_u32 v11, v11, 17, s40
    v_lshlrev_b16 v14, 8, v14
    v_lshrrev_b32 v13, 2, v23
    v_add_u32 v19, v12, v11
    v_bitop3_b32 v23, v5, v13, v14 bitop3:0xea
    ds_add_u32 v23, v2
    v_cvt_pk_bf16_f32 v127, v9, v10
    v_perm_b32 v12, v127, v127, s41
    v_bitop3_b32 v18, v4, v12, v18 bitop3:0xca
    v_perm_b32 v13, v127, v127, s42
    v_bitop3_b32 v19, v4, v13, v19 bitop3:0xca
    s_setprio 1
    s_waitcnt vmcnt(12)
    v_lshlrev_b32 v7, 16, v24
    v_and_b32 v8, 0xffff0000, v24
    v_lshlrev_b32 v9, 16, v25
    v_and_b32 v10, 0xffff0000, v25
    v_mul_f32 v7, 0.15915494, v7
    v_mul_f32 v8, 0.15915494, v8
    v_mul_f32 v9, 0.15915494, v9
    v_mul_f32 v10, 0.15915494, v10
    v_mul_hi_u32_u24 v14, 429497, v28
    v_lshrrev_b32 v12, 3, v32
    v_cos_f32 v7, v7
    v_lshlrev_b16 v13, 3, v32
    v_mad_i32_i24 v11, v14, s55, v28
    v_bitop3_b32 v12, v6, v13, v12 bitop3:0xca
    v_lshl_add_u32 v11, v11, 17, s40
    v_lshlrev_b16 v14, 8, v14
    v_lshrrev_b32 v13, 2, v32
    v_add_u32 v28, v12, v11
    v_bitop3_b32 v32, v5, v13, v14 bitop3:0xea
    ds_add_u32 v32, v2
    v_mul_hi_u32_u24 v14, 429497, v29
    v_lshrrev_b32 v12, 3, v33
    v_cos_f32 v8, v8
    v_lshlrev_b16 v13, 3, v33
    v_mad_i32_i24 v11, v14, s55, v29
    v_bitop3_b32 v12, v6, v13, v12 bitop3:0xca
    v_lshl_add_u32 v11, v11, 17, s40
    v_lshlrev_b16 v14, 8, v14
    v_lshrrev_b32 v13, 2, v33
    v_add_u32 v29, v12, v11
    v_bitop3_b32 v33, v5, v13, v14 bitop3:0xea
    ds_add_u32 v33, v2
    v_cvt_pk_bf16_f32 v24, v7, v8
    v_perm_b32 v12, v24, v24, s41
    v_bitop3_b32 v28, v4, v12, v28 bitop3:0xca
    v_perm_b32 v13, v24, v24, s42
    v_bitop3_b32 v29, v4, v13, v29 bitop3:0xca
    v_mul_hi_u32_u24 v14, 429497, v30
    v_lshrrev_b32 v12, 3, v34
    v_cos_f32 v9, v9
    v_lshlrev_b16 v13, 3, v34
    v_mad_i32_i24 v11, v14, s55, v30
    v_bitop3_b32 v12, v6, v13, v12 bitop3:0xca
    v_lshl_add_u32 v11, v11, 17, s40
    v_lshlrev_b16 v14, 8, v14
    v_lshrrev_b32 v13, 2, v34
    v_add_u32 v30, v12, v11
    v_bitop3_b32 v34, v5, v13, v14 bitop3:0xea
    ds_add_u32 v34, v2
    v_mul_hi_u32_u24 v14, 429497, v31
    v_lshrrev_b32 v12, 3, v35
    v_cos_f32 v10, v10
    v_lshlrev_b16 v13, 3, v35
    v_mad_i32_i24 v11, v14, s55, v31
    v_bitop3_b32 v12, v6, v13, v12 bitop3:0xca
    v_lshl_add_u32 v11, v11, 17, s40
    v_lshlrev_b16 v14, 8, v14
    v_lshrrev_b32 v13, 2, v35
    v_add_u32 v31, v12, v11
    v_bitop3_b32 v35, v5, v13, v14 bitop3:0xea
    ds_add_u32 v35, v2
    v_cvt_pk_bf16_f32 v25, v9, v10
    v_perm_b32 v12, v25, v25, s41
    v_bitop3_b32 v30, v4, v12, v30 bitop3:0xca
    v_perm_b32 v13, v25, v25, s42
    v_bitop3_b32 v31, v4, v13, v31 bitop3:0xca
    s_waitcnt vmcnt(10)
    v_lshlrev_b32 v7, 16, v26
    v_and_b32 v8, 0xffff0000, v26
    v_lshlrev_b32 v9, 16, v27
    v_and_b32 v10, 0xffff0000, v27
    v_mul_f32 v7, 0.15915494, v7
    v_mul_f32 v8, 0.15915494, v8
    v_mul_f32 v9, 0.15915494, v9
    v_mul_f32 v10, 0.15915494, v10
    v_mul_hi_u32_u24 v14, 429497, v36
    v_lshrrev_b32 v12, 3, v40
    v_cos_f32 v7, v7
    v_lshlrev_b16 v13, 3, v40
    v_mad_i32_i24 v11, v14, s55, v36
    v_bitop3_b32 v12, v6, v13, v12 bitop3:0xca
    v_lshl_add_u32 v11, v11, 17, s40
    v_lshlrev_b16 v14, 8, v14
    v_lshrrev_b32 v13, 2, v40
    v_add_u32 v36, v12, v11
    v_bitop3_b32 v40, v5, v13, v14 bitop3:0xea
    ds_add_u32 v40, v2
    v_mul_hi_u32_u24 v14, 429497, v37
    v_lshrrev_b32 v12, 3, v41
    v_cos_f32 v8, v8
    v_lshlrev_b16 v13, 3, v41
    v_mad_i32_i24 v11, v14, s55, v37
    v_bitop3_b32 v12, v6, v13, v12 bitop3:0xca
    v_lshl_add_u32 v11, v11, 17, s40
    v_lshlrev_b16 v14, 8, v14
    v_lshrrev_b32 v13, 2, v41
    v_add_u32 v37, v12, v11
    v_bitop3_b32 v41, v5, v13, v14 bitop3:0xea
    ds_add_u32 v41, v2
    v_cvt_pk_bf16_f32 v26, v7, v8
    v_perm_b32 v12, v26, v26, s41
    v_bitop3_b32 v36, v4, v12, v36 bitop3:0xca
    v_perm_b32 v13, v26, v26, s42
    v_bitop3_b32 v37, v4, v13, v37 bitop3:0xca
    v_mul_hi_u32_u24 v14, 429497, v38
    v_lshrrev_b32 v12, 3, v42
    v_cos_f32 v9, v9
    v_lshlrev_b16 v13, 3, v42
    v_mad_i32_i24 v11, v14, s55, v38
    v_bitop3_b32 v12, v6, v13, v12 bitop3:0xca
    v_lshl_add_u32 v11, v11, 17, s40
    v_lshlrev_b16 v14, 8, v14
    v_lshrrev_b32 v13, 2, v42
    v_add_u32 v38, v12, v11
    v_bitop3_b32 v42, v5, v13, v14 bitop3:0xea
    ds_add_u32 v42, v2
    v_mul_hi_u32_u24 v14, 429497, v39
    v_lshrrev_b32 v12, 3, v43
    v_cos_f32 v10, v10
    v_lshlrev_b16 v13, 3, v43
    v_mad_i32_i24 v11, v14, s55, v39
    v_bitop3_b32 v12, v6, v13, v12 bitop3:0xca
    v_lshl_add_u32 v11, v11, 17, s40
    v_lshlrev_b16 v14, 8, v14
    v_lshrrev_b32 v13, 2, v43
    v_add_u32 v39, v12, v11
    v_bitop3_b32 v43, v5, v13, v14 bitop3:0xea
    ds_add_u32 v43, v2
    v_cvt_pk_bf16_f32 v27, v9, v10
    v_perm_b32 v12, v27, v27, s41
    v_bitop3_b32 v38, v4, v12, v38 bitop3:0xca
    v_perm_b32 v13, v27, v27, s42
    v_bitop3_b32 v39, v4, v13, v39 bitop3:0xca
    s_setprio 0
    s_add_u32 s45, s35, 0x4000
    s_add_u32 s45, s45, s91
    buffer_store_dwordx4 v[72:75], v0, s[20:23], s45 offen sc1
    s_add_u32 s46, s96, 0x4000000
    s_nop 0
    v_lshlrev_b32 v72, 1, v1
    buffer_load_dwordx4 v[72:75], v72, s[12:15], s46 offen nt
    s_waitcnt vmcnt(8)
    v_lshlrev_b32 v7, 16, v44
    v_and_b32 v8, 0xffff0000, v44
    v_lshlrev_b32 v9, 16, v45
    v_and_b32 v10, 0xffff0000, v45
    v_mul_f32 v7, 0.15915494, v7
    v_mul_f32 v8, 0.15915494, v8
    v_mul_f32 v9, 0.15915494, v9
    v_mul_f32 v10, 0.15915494, v10
    v_mul_hi_u32_u24 v14, 429497, v48
    v_lshrrev_b32 v12, 3, v52
    v_cos_f32 v7, v7
    v_lshlrev_b16 v13, 3, v52
    v_mad_i32_i24 v11, v14, s55, v48
    v_bitop3_b32 v12, v6, v13, v12 bitop3:0xca
    v_lshl_add_u32 v11, v11, 17, s40
    v_lshlrev_b16 v14, 8, v14
    v_lshrrev_b32 v13, 2, v52
    v_add_u32 v48, v12, v11
    v_bitop3_b32 v52, v5, v13, v14 bitop3:0xea
    ds_add_u32 v52, v2
    v_mul_hi_u32_u24 v14, 429497, v49
    v_lshrrev_b32 v12, 3, v53
    v_cos_f32 v8, v8
    v_lshlrev_b16 v13, 3, v53
    v_mad_i32_i24 v11, v14, s55, v49
    v_bitop3_b32 v12, v6, v13, v12 bitop3:0xca
    v_lshl_add_u32 v11, v11, 17, s40
    v_lshlrev_b16 v14, 8, v14
    v_lshrrev_b32 v13, 2, v53
    v_add_u32 v49, v12, v11
    v_bitop3_b32 v53, v5, v13, v14 bitop3:0xea
    ds_add_u32 v53, v2
    v_cvt_pk_bf16_f32 v44, v7, v8
    v_perm_b32 v12, v44, v44, s41
    v_bitop3_b32 v48, v4, v12, v48 bitop3:0xca
    v_perm_b32 v13, v44, v44, s42
    v_bitop3_b32 v49, v4, v13, v49 bitop3:0xca
    v_mul_hi_u32_u24 v14, 429497, v50
    v_lshrrev_b32 v12, 3, v54
    v_cos_f32 v9, v9
    v_lshlrev_b16 v13, 3, v54
    v_mad_i32_i24 v11, v14, s55, v50
    v_bitop3_b32 v12, v6, v13, v12 bitop3:0xca
    v_lshl_add_u32 v11, v11, 17, s40
    v_lshlrev_b16 v14, 8, v14
    v_lshrrev_b32 v13, 2, v54
    v_add_u32 v50, v12, v11
    v_bitop3_b32 v54, v5, v13, v14 bitop3:0xea
    ds_add_u32 v54, v2
    v_mul_hi_u32_u24 v14, 429497, v51
    v_lshrrev_b32 v12, 3, v55
    v_cos_f32 v10, v10
    v_lshlrev_b16 v13, 3, v55
    v_mad_i32_i24 v11, v14, s55, v51
    v_bitop3_b32 v12, v6, v13, v12 bitop3:0xca
    v_lshl_add_u32 v11, v11, 17, s40
    v_lshlrev_b16 v14, 8, v14
    v_lshrrev_b32 v13, 2, v55
    v_add_u32 v51, v12, v11
    v_bitop3_b32 v55, v5, v13, v14 bitop3:0xea
    ds_add_u32 v55, v2
    v_cvt_pk_bf16_f32 v45, v9, v10
    v_perm_b32 v12, v45, v45, s41
    v_bitop3_b32 v50, v4, v12, v50 bitop3:0xca
    v_perm_b32 v13, v45, v45, s42
    v_bitop3_b32 v51, v4, v13, v51 bitop3:0xca
    s_waitcnt vmcnt(4)
    v_lshlrev_b32 v7, 16, v46
    v_and_b32 v8, 0xffff0000, v46
    v_lshlrev_b32 v9, 16, v47
    v_and_b32 v10, 0xffff0000, v47
    v_mul_f32 v7, 0.15915494, v7
    v_mul_f32 v8, 0.15915494, v8
    v_mul_f32 v9, 0.15915494, v9
    v_mul_f32 v10, 0.15915494, v10
    v_mul_hi_u32_u24 v14, 429497, v56
    v_lshrrev_b32 v12, 3, v60
    v_cos_f32 v7, v7
    v_lshlrev_b16 v13, 3, v60
    v_mad_i32_i24 v11, v14, s55, v56
    v_bitop3_b32 v12, v6, v13, v12 bitop3:0xca
    v_lshl_add_u32 v11, v11, 17, s40
    v_lshlrev_b16 v14, 8, v14
    v_lshrrev_b32 v13, 2, v60
    v_add_u32 v56, v12, v11
    v_bitop3_b32 v60, v5, v13, v14 bitop3:0xea
    ds_add_u32 v60, v2
    v_mul_hi_u32_u24 v14, 429497, v57
    v_lshrrev_b32 v12, 3, v61
    v_cos_f32 v8, v8
    v_lshlrev_b16 v13, 3, v61
    v_mad_i32_i24 v11, v14, s55, v57
    v_bitop3_b32 v12, v6, v13, v12 bitop3:0xca
    v_lshl_add_u32 v11, v11, 17, s40
    v_lshlrev_b16 v14, 8, v14
    v_lshrrev_b32 v13, 2, v61
    v_add_u32 v57, v12, v11
    v_bitop3_b32 v61, v5, v13, v14 bitop3:0xea
    ds_add_u32 v61, v2
    v_cvt_pk_bf16_f32 v46, v7, v8
    v_perm_b32 v12, v46, v46, s41
    v_bitop3_b32 v56, v4, v12, v56 bitop3:0xca
    v_perm_b32 v13, v46, v46, s42
    v_bitop3_b32 v57, v4, v13, v57 bitop3:0xca
    v_mul_hi_u32_u24 v14, 429497, v58
    v_lshrrev_b32 v12, 3, v62
    v_cos_f32 v9, v9
    v_lshlrev_b16 v13, 3, v62
    v_mad_i32_i24 v11, v14, s55, v58
    v_bitop3_b32 v12, v6, v13, v12 bitop3:0xca
    v_lshl_add_u32 v11, v11, 17, s40
    v_lshlrev_b16 v14, 8, v14
    v_lshrrev_b32 v13, 2, v62
    v_add_u32 v58, v12, v11
    v_bitop3_b32 v62, v5, v13, v14 bitop3:0xea
    ds_add_u32 v62, v2
    v_mul_hi_u32_u24 v14, 429497, v59
    v_lshrrev_b32 v12, 3, v63
    v_cos_f32 v10, v10
    v_lshlrev_b16 v13, 3, v63
    v_mad_i32_i24 v11, v14, s55, v59
    v_bitop3_b32 v12, v6, v13, v12 bitop3:0xca
    v_lshl_add_u32 v11, v11, 17, s40
    v_lshlrev_b16 v14, 8, v14
    v_lshrrev_b32 v13, 2, v63
    v_add_u32 v59, v12, v11
    v_bitop3_b32 v63, v5, v13, v14 bitop3:0xea
    ds_add_u32 v63, v2
    v_cvt_pk_bf16_f32 v47, v9, v10
    v_perm_b32 v12, v47, v47, s41
    v_bitop3_b32 v58, v4, v12, v58 bitop3:0xca
    v_perm_b32 v13, v47, v47, s42
    v_bitop3_b32 v59, v4, v13, v59 bitop3:0xca
    v_lshrrev_b32 v8, 2, v0
    v_and_b32 v7, 0x3c00, v0
    v_bitop3_b32 v7, v5, v8, v7 bitop3:0xea
    s_waitcnt lgkmcnt(0)
    s_barrier
    ds_read2st64_b32 v[8:9], v7 offset0:0 offset1:1
    ds_read2st64_b32 v[10:11], v7 offset0:2 offset1:3
    s_add_u32 s47, s35, 0x4000
    s_add_u32 s47, s47, s93
    buffer_store_dwordx4 v[64:67], v0, s[20:23], s47 offen sc1
    s_add_u32 s44, s96, 0x4000000
    s_lshr_b32 s44, s44, 1
    buffer_load_dwordx2 v[64:65], v1, s[16:19], s44 offen nt
    s_add_u32 s45, s97, 0x4400000
    s_lshr_b32 s45, s45, 1
    buffer_load_dwordx2 v[66:67], v1, s[16:19], s45 offen nt
    s_waitcnt lgkmcnt(0)
    v_lshl_or_b32 v12, v9, 16, v8
    v_lshl_or_b32 v13, v11, 16, v10
    v_mov_b32 v14, v12
    v_mov_b32 v15, v13
    s_nop 0
    v_add_u32_dpp v14, v14, v14 row_shr:1 row_mask:0xf bank_mask:0xf bound_ctrl:1
    v_add_u32_dpp v15, v15, v15 row_shr:1 row_mask:0xf bank_mask:0xf bound_ctrl:1
    s_nop 0
    v_add_u32_dpp v14, v14, v14 row_shr:2 row_mask:0xf bank_mask:0xf bound_ctrl:1
    v_add_u32_dpp v15, v15, v15 row_shr:2 row_mask:0xf bank_mask:0xf bound_ctrl:1
    s_nop 0
    v_add_u32_dpp v14, v14, v14 row_shr:4 row_mask:0xf bank_mask:0xf bound_ctrl:1
    v_add_u32_dpp v15, v15, v15 row_shr:4 row_mask:0xf bank_mask:0xf bound_ctrl:1
    s_nop 0
    v_add_u32_dpp v14, v14, v14 row_shr:8 row_mask:0xf bank_mask:0xf bound_ctrl:1
    v_add_u32_dpp v15, v15, v15 row_shr:8 row_mask:0xf bank_mask:0xf bound_ctrl:1
    s_nop 0
    v_add_u32_dpp v14, v14, v14 row_bcast:15 row_mask:0xa bank_mask:0xf
    v_add_u32_dpp v15, v15, v15 row_bcast:15 row_mask:0xa bank_mask:0xf
    s_nop 0
    v_add_u32_dpp v14, v14, v14 row_bcast:31 row_mask:0xc bank_mask:0xf
    v_add_u32_dpp v15, v15, v15 row_bcast:31 row_mask:0xc bank_mask:0xf
    v_readlane_b32 s48, v14, 63
    v_readlane_b32 s49, v15, 63
    s_lshl_b32 s54, s32, 2
    v_mov_b32 v8, s54
    s_and_b32 s50, s48, 0xffff
    s_lshr_b32 s51, s48, 16
    s_and_b32 s52, s49, 0xffff
    s_lshr_b32 s53, s49, 16
    s_add_u32 s51, s51, s50
    s_add_u32 s52, s52, s51
    s_add_u32 s53, s53, s52
    v_mov_b32 v9, s53
    s_mov_b64 exec, 1
    ds_write_b32 v8, v9 offset:16384
    s_mov_b64 exec, -1
    v_and_b32 v8, 60, v7
    s_waitcnt lgkmcnt(0)
    s_barrier
    ds_read_b32 v9, v8 offset:16384
    s_waitcnt lgkmcnt(0)
    v_add_u32_dpp v9, v9, v9 row_shr:1 row_mask:0xf bank_mask:0xf bound_ctrl:1
    s_nop 1
    v_add_u32_dpp v9, v9, v9 row_shr:2 row_mask:0xf bank_mask:0xf bound_ctrl:1
    s_nop 1
    v_add_u32_dpp v9, v9, v9 row_shr:4 row_mask:0xf bank_mask:0xf bound_ctrl:1
    s_nop 1
    v_add_u32_dpp v9, v9, v9 row_shr:8 row_mask:0xf bank_mask:0xf bound_ctrl:1
    s_nop 0
    v_readlane_b32 s54, v9, s32
    s_sub_u32 s54, s54, s53
    s_add_u32 s50, s50, s54
    s_add_u32 s51, s51, s54
    s_add_u32 s52, s52, s54
    s_pack_ll_b32_b16 s48, s54, s50
    s_pack_ll_b32_b16 s49, s51, s52
    v_add_u32 v14, s48, v14
    v_add_u32 v15, s49, v15
    v_sub_u32 v12, v14, v12
    v_sub_u32 v13, v15, v13
    v_and_b32 v8, 0xffff, v12
    v_lshrrev_b32 v9, 16, v12
    v_and_b32 v10, 0xffff, v13
    v_lshrrev_b32 v11, 16, v13
    ds_write2st64_b32 v7, v8, v9 offset0:0 offset1:1
    ds_write2st64_b32 v7, v10, v11 offset0:2 offset1:3
    v_and_b32 v8, 0x3f0, v0
    v_lshl_add_u32 v8, v8, 1, s36
    ds_write_b64 v8, v[12:13] offset:20480
    s_bitset0_b64 exec, 63
    s_not_b64 exec, exec
    ds_write_b64 v8, v[14:15] offset:20512
    s_mov_b64 exec, -1
    s_waitcnt lgkmcnt(0)
    s_barrier
    s_setprio 3
    ds_add_rtn_u32 v104, v104, v2
    ds_add_rtn_u32 v105, v105, v2
    ds_add_rtn_u32 v106, v106, v2
    ds_add_rtn_u32 v107, v107, v2
    ds_read_b128 v[12:15], v0 offset:20480
    v_cmp_gt_u32 vcc, 8448, v0
    ds_add_rtn_u32 v112, v112, v2
    ds_add_rtn_u32 v113, v113, v2
    ds_add_rtn_u32 v114, v114, v2
    ds_add_rtn_u32 v115, v115, v2
    s_setprio 2
    ds_add_rtn_u32 v120, v120, v2
    ds_add_rtn_u32 v121, v121, v2
    ds_add_rtn_u32 v122, v122, v2
    ds_add_rtn_u32 v123, v123, v2
    s_waitcnt lgkmcnt(8)
    s_cbranch_vccz L1_p2
    s_add_u32 s46, s35, 0x2a40000
    s_mov_b64 exec, vcc
    buffer_store_dwordx4 v[12:15], v0, s[24:27], s46 offen sc1
    s_mov_b64 exec, -1
L1_p2:
    s_add_u32 s47, s35, 0x8000
    s_add_u32 s47, s47, s72
    buffer_store_dwordx4 v[76:79], v0, s[20:23], s47 offen sc1
    s_add_u32 s44, s97, 0x4400000
    s_nop 0
    v_lshlrev_b32 v76, 1, v1
    buffer_load_dwordx4 v[76:79], v76, s[8:11], s44 offen nt
    ds_add_rtn_u32 v20, v20, v2
    ds_add_rtn_u32 v21, v21, v2
    ds_add_rtn_u32 v22, v22, v2
    ds_add_rtn_u32 v23, v23, v2
    s_setprio 1
    ds_add_rtn_u32 v32, v32, v2
    ds_add_rtn_u32 v33, v33, v2
    ds_add_rtn_u32 v34, v34, v2
    ds_add_rtn_u32 v35, v35, v2
    ds_add_rtn_u32 v40, v40, v2
    ds_add_rtn_u32 v41, v41, v2
    ds_add_rtn_u32 v42, v42, v2
    ds_add_rtn_u32 v43, v43, v2
    s_add_u32 s45, s35, 0x8000
    s_add_u32 s45, s45, s73
    buffer_store_dwordx4 v[80:83], v0, s[20:23], s45 offen sc1
    s_add_u32 s46, s97, 0x4400000
    s_nop 0
    v_lshlrev_b32 v80, 1, v1
    buffer_load_dwordx4 v[80:83], v80, s[12:15], s46 offen nt
    s_setprio 0
    ds_add_rtn_u32 v52, v52, v2
    ds_add_rtn_u32 v53, v53, v2
    ds_add_rtn_u32 v54, v54, v2
    ds_add_rtn_u32 v55, v55, v2
    ds_add_rtn_u32 v60, v60, v2
    ds_add_rtn_u32 v61, v61, v2
    ds_add_rtn_u32 v62, v62, v2
    ds_add_rtn_u32 v63, v63, v2
    s_waitcnt lgkmcnt(0)
    s_barrier
    s_setprio 3
    v_and_b32 v7, -4, v104
    v_lshl_add_u32 v8, v104, 2, v7
    ds_write_b32 v8, v96
    v_lshl_add_u32 v7, v7, 2, v104
    ds_write_b8 v7, v108 offset:16
    v_and_b32 v9, -4, v105
    v_lshl_add_u32 v10, v105, 2, v9
    ds_write_b32 v10, v97
    v_lshl_add_u32 v9, v9, 2, v105
    ds_write_b8_d16_hi v9, v108 offset:16
    v_and_b32 v7, -4, v106
    v_lshl_add_u32 v8, v106, 2, v7
    ds_write_b32 v8, v98
    v_lshl_add_u32 v7, v7, 2, v106
    ds_write_b8 v7, v109 offset:16
    v_and_b32 v9, -4, v107
    v_lshl_add_u32 v10, v107, 2, v9
    ds_write_b32 v10, v99
    v_lshl_add_u32 v9, v9, 2, v107
    ds_write_b8_d16_hi v9, v109 offset:16
    s_add_u32 s47, s35, 0x8000
    s_add_u32 s47, s47, s85
    buffer_store_dwordx4 v[88:91], v0, s[20:23], s47 offen sc1
    s_add_u32 s44, s98, 0x4800000
    v_lshlrev_b32 v96, 1, v1
    buffer_load_dwordx4 v[96:99], v96, s[8:11], s44 offen nt
    s_add_u32 s45, s98, 0x4800000
    v_lshlrev_b32 v104, 1, v1
    buffer_load_dwordx4 v[104:107], v104, s[12:15], s45 offen nt
    v_and_b32 v7, -4, v112
    v_lshl_add_u32 v8, v112, 2, v7
    ds_write_b32 v8, v100
    v_lshl_add_u32 v7, v7, 2, v112
    ds_write_b8 v7, v110 offset:16
    v_and_b32 v9, -4, v113
    v_lshl_add_u32 v10, v113, 2, v9
    ds_write_b32 v10, v101
    v_lshl_add_u32 v9, v9, 2, v113
    ds_write_b8_d16_hi v9, v110 offset:16
    v_and_b32 v7, -4, v114
    v_lshl_add_u32 v8, v114, 2, v7
    ds_write_b32 v8, v102
    v_lshl_add_u32 v7, v7, 2, v114
    ds_write_b8 v7, v111 offset:16
    v_and_b32 v9, -4, v115
    v_lshl_add_u32 v10, v115, 2, v9
    ds_write_b32 v10, v103
    v_lshl_add_u32 v9, v9, 2, v115
    ds_write_b8_d16_hi v9, v111 offset:16
    s_add_u32 s46, s98, 0x4800000
    s_lshr_b32 s46, s46, 1
    buffer_load_dwordx2 v[88:89], v1, s[16:19], s46 offen nt
    s_add_u32 s47, s99, 0x4c00000
    s_lshr_b32 s47, s47, 1
    buffer_load_dwordx2 v[90:91], v1, s[16:19], s47 offen nt
    s_add_u32 s44, s99, 0x4c00000
    v_lshlrev_b32 v100, 1, v1
    buffer_load_dwordx4 v[100:103], v100, s[8:11], s44 offen nt
    s_setprio 2
    v_and_b32 v7, -4, v120
    v_lshl_add_u32 v8, v120, 2, v7
    ds_write_b32 v8, v116
    v_lshl_add_u32 v7, v7, 2, v120
    ds_write_b8 v7, v124 offset:16
    v_and_b32 v9, -4, v121
    v_lshl_add_u32 v10, v121, 2, v9
    ds_write_b32 v10, v117
    v_lshl_add_u32 v9, v9, 2, v121
    ds_write_b8_d16_hi v9, v124 offset:16
    v_and_b32 v7, -4, v122
    v_lshl_add_u32 v8, v122, 2, v7
    ds_write_b32 v8, v118
    v_lshl_add_u32 v7, v7, 2, v122
    ds_write_b8 v7, v125 offset:16
    v_and_b32 v9, -4, v123
    v_lshl_add_u32 v10, v123, 2, v9
    ds_write_b32 v10, v119
    v_lshl_add_u32 v9, v9, 2, v123
    ds_write_b8_d16_hi v9, v125 offset:16
    s_add_u32 s45, s35, 0x8000
    s_add_u32 s45, s45, s91
    buffer_store_dwordx4 v[92:95], v0, s[20:23], s45 offen sc1
    s_add_u32 s46, s99, 0x4c00000
    v_lshlrev_b32 v112, 1, v1
    buffer_load_dwordx4 v[112:115], v112, s[12:15], s46 offen nt
    v_and_b32 v7, -4, v20
    v_lshl_add_u32 v8, v20, 2, v7
    ds_write_b32 v8, v16
    v_lshl_add_u32 v7, v7, 2, v20
    ds_write_b8 v7, v126 offset:16
    v_and_b32 v9, -4, v21
    v_lshl_add_u32 v10, v21, 2, v9
    ds_write_b32 v10, v17
    v_lshl_add_u32 v9, v9, 2, v21
    ds_write_b8_d16_hi v9, v126 offset:16
    v_and_b32 v7, -4, v22
    v_lshl_add_u32 v8, v22, 2, v7
    ds_write_b32 v8, v18
    v_lshl_add_u32 v7, v7, 2, v22
    ds_write_b8 v7, v127 offset:16
    v_and_b32 v9, -4, v23
    v_lshl_add_u32 v10, v23, 2, v9
    ds_write_b32 v10, v19
    v_lshl_add_u32 v9, v9, 2, v23
    ds_write_b8_d16_hi v9, v127 offset:16
    s_add_u32 s47, s96, 0x5000000
    v_lshlrev_b32 v108, 1, v1
    buffer_load_dwordx4 v[108:111], v108, s[8:11], s47 offen nt
    s_add_u32 s44, s96, 0x5000000
    v_lshlrev_b32 v116, 1, v1
    buffer_load_dwordx4 v[116:119], v116, s[12:15], s44 offen nt
    s_setprio 1
    v_and_b32 v7, -4, v32
    v_lshl_add_u32 v8, v32, 2, v7
    ds_write_b32 v8, v28
    v_lshl_add_u32 v7, v7, 2, v32
    ds_write_b8 v7, v24 offset:16
    v_and_b32 v9, -4, v33
    v_lshl_add_u32 v10, v33, 2, v9
    ds_write_b32 v10, v29
    v_lshl_add_u32 v9, v9, 2, v33
    ds_write_b8_d16_hi v9, v24 offset:16
    v_and_b32 v7, -4, v34
    v_lshl_add_u32 v8, v34, 2, v7
    ds_write_b32 v8, v30
    v_lshl_add_u32 v7, v7, 2, v34
    ds_write_b8 v7, v25 offset:16
    v_and_b32 v9, -4, v35
    v_lshl_add_u32 v10, v35, 2, v9
    ds_write_b32 v10, v31
    v_lshl_add_u32 v9, v9, 2, v35
    ds_write_b8_d16_hi v9, v25 offset:16
    s_add_u32 s45, s96, 0x5000000
    s_lshr_b32 s45, s45, 1
    buffer_load_dwordx2 v[120:121], v1, s[16:19], s45 offen nt
    s_add_u32 s46, s97, 0x5400000
    s_lshr_b32 s46, s46, 1
    buffer_load_dwordx2 v[122:123], v1, s[16:19], s46 offen nt
    s_add_u32 s47, s97, 0x5400000
    v_lshlrev_b32 v92, 1, v1
    buffer_load_dwordx4 v[92:95], v92, s[8:11], s47 offen nt
    v_and_b32 v7, -4, v40
    v_lshl_add_u32 v8, v40, 2, v7
    ds_write_b32 v8, v36
    v_lshl_add_u32 v7, v7, 2, v40
    ds_write_b8 v7, v26 offset:16
    v_and_b32 v9, -4, v41
    v_lshl_add_u32 v10, v41, 2, v9
    ds_write_b32 v10, v37
    v_lshl_add_u32 v9, v9, 2, v41
    ds_write_b8_d16_hi v9, v26 offset:16
    v_and_b32 v7, -4, v42
    v_lshl_add_u32 v8, v42, 2, v7
    ds_write_b32 v8, v38
    v_lshl_add_u32 v7, v7, 2, v42
    ds_write_b8 v7, v27 offset:16
    v_and_b32 v9, -4, v43
    v_lshl_add_u32 v10, v43, 2, v9
    ds_write_b32 v10, v39
    v_lshl_add_u32 v9, v9, 2, v43
    ds_write_b8_d16_hi v9, v27 offset:16
    s_add_u32 s44, s35, 0x8000
    s_add_u32 s44, s44, s93
    buffer_store_dwordx4 v[84:87], v0, s[20:23], s44 offen sc1
    s_add_u32 s45, s97, 0x5400000
    v_lshlrev_b32 v16, 1, v1
    buffer_load_dwordx4 v[16:19], v16, s[12:15], s45 offen nt
    s_setprio 0
    v_and_b32 v7, -4, v52
    v_lshl_add_u32 v8, v52, 2, v7
    ds_write_b32 v8, v48
    v_lshl_add_u32 v7, v7, 2, v52
    ds_write_b8 v7, v44 offset:16
    v_and_b32 v9, -4, v53
    v_lshl_add_u32 v10, v53, 2, v9
    ds_write_b32 v10, v49
    v_lshl_add_u32 v9, v9, 2, v53
    ds_write_b8_d16_hi v9, v44 offset:16
    v_and_b32 v7, -4, v54
    v_lshl_add_u32 v8, v54, 2, v7
    ds_write_b32 v8, v50
    v_lshl_add_u32 v7, v7, 2, v54
    ds_write_b8 v7, v45 offset:16
    v_and_b32 v9, -4, v55
    v_lshl_add_u32 v10, v55, 2, v9
    ds_write_b32 v10, v51
    v_lshl_add_u32 v9, v9, 2, v55
    ds_write_b8_d16_hi v9, v45 offset:16
    s_add_u32 s46, s98, 0x5800000
    v_lshlrev_b32 v20, 1, v1
    buffer_load_dwordx4 v[20:23], v20, s[8:11], s46 offen nt
    s_add_u32 s47, s98, 0x5800000
    v_lshlrev_b32 v124, 1, v1
    buffer_load_dwordx4 v[124:127], v124, s[12:15], s47 offen nt
    v_and_b32 v7, -4, v60
    v_lshl_add_u32 v8, v60, 2, v7
    ds_write_b32 v8, v56
    v_lshl_add_u32 v7, v7, 2, v60
    ds_write_b8 v7, v46 offset:16
    v_and_b32 v9, -4, v61
    v_lshl_add_u32 v10, v61, 2, v9
    ds_write_b32 v10, v57
    v_lshl_add_u32 v9, v9, 2, v61
    ds_write_b8_d16_hi v9, v46 offset:16
    v_and_b32 v7, -4, v62
    v_lshl_add_u32 v8, v62, 2, v7
    ds_write_b32 v8, v58
    v_lshl_add_u32 v7, v7, 2, v62
    ds_write_b8 v7, v47 offset:16
    v_and_b32 v9, -4, v63
    v_lshl_add_u32 v10, v63, 2, v9
    ds_write_b32 v10, v59
    v_lshl_add_u32 v9, v9, 2, v63
    ds_write_b8_d16_hi v9, v47 offset:16
    s_add_u32 s44, s98, 0x5800000
    s_lshr_b32 s44, s44, 1
    buffer_load_dwordx2 v[28:29], v1, s[16:19], s44 offen nt
    s_add_u32 s45, s99, 0x5c00000
    s_lshr_b32 s45, s45, 1
    buffer_load_dwordx2 v[30:31], v1, s[16:19], s45 offen nt
    v_add_u32 v7, s72, v0
    v_add_u32 v12, s73, v0
    v_add_u32 v13, s85, v0
    v_add_u32 v14, s91, v0
    v_add_u32 v15, s93, v0
    s_min_i32 s3, s72, s73
    s_min_i32 s3, s3, s85
    s_min_i32 s3, s3, s91
    s_min_i32 s3, s3, s93
    v_add_u32 v3, s3, v0
    v_mov_b32 v8, 0
    v_mov_b32 v9, 0
    v_mov_b32 v10, 0
    v_mov_b32 v11, 0
    s_waitcnt lgkmcnt(0)
    s_barrier
    ds_read_b128 v[32:35], v7 offset:0
    ds_read_b128 v[36:39], v12 offset:0
    ds_read_b128 v[40:43], v13 offset:0
    ds_read_b128 v[24:27], v14 offset:0
    ds_read_b128 v[84:87], v15 offset:0
    ds_write_b128 v3, v[8:11]
    ds_read_b128 v[48:51], v7 offset:16384
    ds_read_b128 v[52:55], v12 offset:16384
    ds_read_b128 v[56:59], v13 offset:16384
    ds_read_b128 v[60:63], v14 offset:16384
    ds_read_b128 v[44:47], v15 offset:16384
    s_waitcnt lgkmcnt(0)
    s_barrier
    s_setprio 3
    s_add_u32 s46, s35, 0x2a44000
    s_add_u32 s46, s46, s72
    buffer_store_dwordx4 v[32:35], v0, s[20:23], s46 offen sc1
    s_add_u32 s47, s99, 0x5c00000
    s_nop 0
    v_lshlrev_b32 v32, 1, v1
    buffer_load_dwordx4 v[32:35], v32, s[8:11], s47 offen nt
    s_add_u32 s44, s35, 0x2a44000
    s_add_u32 s44, s44, s73
    buffer_store_dwordx4 v[36:39], v0, s[20:23], s44 offen sc1
    s_add_u32 s45, s99, 0x5c00000
    s_nop 0
    v_lshlrev_b32 v36, 1, v1
    buffer_load_dwordx4 v[36:39], v36, s[12:15], s45 offen nt
    s_waitcnt vmcnt(27)
    v_lshlrev_b32 v7, 16, v64
    v_and_b32 v8, 0xffff0000, v64
    v_lshlrev_b32 v9, 16, v65
    v_and_b32 v10, 0xffff0000, v65
    v_mul_f32 v7, 0.15915494, v7
    v_mul_f32 v8, 0.15915494, v8
    v_mul_f32 v9, 0.15915494, v9
    v_mul_f32 v10, 0.15915494, v10
    v_mul_hi_u32_u24 v14, 429497, v68
    v_lshrrev_b32 v12, 3, v72
    v_cos_f32 v7, v7
    v_lshlrev_b16 v13, 3, v72
    v_mad_i32_i24 v11, v14, s55, v68
    v_bitop3_b32 v12, v6, v13, v12 bitop3:0xca
    v_lshl_add_u32 v11, v11, 17, s40
    v_lshlrev_b16 v14, 8, v14
    v_lshrrev_b32 v13, 2, v72
    v_add_u32 v68, v12, v11
    v_bitop3_b32 v72, v5, v13, v14 bitop3:0xea
    ds_add_u32 v72, v2
    v_mul_hi_u32_u24 v14, 429497, v69
    v_lshrrev_b32 v12, 3, v73
    v_cos_f32 v8, v8
    v_lshlrev_b16 v13, 3, v73
    v_mad_i32_i24 v11, v14, s55, v69
    v_bitop3_b32 v12, v6, v13, v12 bitop3:0xca
    v_lshl_add_u32 v11, v11, 17, s40
    v_lshlrev_b16 v14, 8, v14
    v_lshrrev_b32 v13, 2, v73
    v_add_u32 v69, v12, v11
    v_bitop3_b32 v73, v5, v13, v14 bitop3:0xea
    ds_add_u32 v73, v2
    v_cvt_pk_bf16_f32 v64, v7, v8
    v_perm_b32 v12, v64, v64, s41
    v_bitop3_b32 v68, v4, v12, v68 bitop3:0xca
    v_perm_b32 v13, v64, v64, s42
    v_bitop3_b32 v69, v4, v13, v69 bitop3:0xca
    v_mul_hi_u32_u24 v14, 429497, v70
    v_lshrrev_b32 v12, 3, v74
    v_cos_f32 v9, v9
    v_lshlrev_b16 v13, 3, v74
    v_mad_i32_i24 v11, v14, s55, v70
    v_bitop3_b32 v12, v6, v13, v12 bitop3:0xca
    v_lshl_add_u32 v11, v11, 17, s40
    v_lshlrev_b16 v14, 8, v14
    v_lshrrev_b32 v13, 2, v74
    v_add_u32 v70, v12, v11
    v_bitop3_b32 v74, v5, v13, v14 bitop3:0xea
    ds_add_u32 v74, v2
    v_mul_hi_u32_u24 v14, 429497, v71
    v_lshrrev_b32 v12, 3, v75
    v_cos_f32 v10, v10
    v_lshlrev_b16 v13, 3, v75
    v_mad_i32_i24 v11, v14, s55, v71
    v_bitop3_b32 v12, v6, v13, v12 bitop3:0xca
    v_lshl_add_u32 v11, v11, 17, s40
    v_lshlrev_b16 v14, 8, v14
    v_lshrrev_b32 v13, 2, v75
    v_add_u32 v71, v12, v11
    v_bitop3_b32 v75, v5, v13, v14 bitop3:0xea
    ds_add_u32 v75, v2
    v_cvt_pk_bf16_f32 v65, v9, v10
    v_perm_b32 v12, v65, v65, s41
    v_bitop3_b32 v70, v4, v12, v70 bitop3:0xca
    v_perm_b32 v13, v65, v65, s42
    v_bitop3_b32 v71, v4, v13, v71 bitop3:0xca
    s_waitcnt vmcnt(23)
    v_lshlrev_b32 v7, 16, v66
    v_and_b32 v8, 0xffff0000, v66
    v_lshlrev_b32 v9, 16, v67
    v_and_b32 v10, 0xffff0000, v67
    v_mul_f32 v7, 0.15915494, v7
    v_mul_f32 v8, 0.15915494, v8
    v_mul_f32 v9, 0.15915494, v9
    v_mul_f32 v10, 0.15915494, v10
    v_mul_hi_u32_u24 v14, 429497, v76
    v_lshrrev_b32 v12, 3, v80
    v_cos_f32 v7, v7
    v_lshlrev_b16 v13, 3, v80
    v_mad_i32_i24 v11, v14, s55, v76
    v_bitop3_b32 v12, v6, v13, v12 bitop3:0xca
    v_lshl_add_u32 v11, v11, 17, s40
    v_lshlrev_b16 v14, 8, v14
    v_lshrrev_b32 v13, 2, v80
    v_add_u32 v76, v12, v11
    v_bitop3_b32 v80, v5, v13, v14 bitop3:0xea
    ds_add_u32 v80, v2
    v_mul_hi_u32_u24 v14, 429497, v77
    v_lshrrev_b32 v12, 3, v81
    v_cos_f32 v8, v8
    v_lshlrev_b16 v13, 3, v81
    v_mad_i32_i24 v11, v14, s55, v77
    v_bitop3_b32 v12, v6, v13, v12 bitop3:0xca
    v_lshl_add_u32 v11, v11, 17, s40
    v_lshlrev_b16 v14, 8, v14
    v_lshrrev_b32 v13, 2, v81
    v_add_u32 v77, v12, v11
    v_bitop3_b32 v81, v5, v13, v14 bitop3:0xea
    ds_add_u32 v81, v2
    v_cvt_pk_bf16_f32 v66, v7, v8
    v_perm_b32 v12, v66, v66, s41
    v_bitop3_b32 v76, v4, v12, v76 bitop3:0xca
    v_perm_b32 v13, v66, v66, s42
    v_bitop3_b32 v77, v4, v13, v77 bitop3:0xca
    v_mul_hi_u32_u24 v14, 429497, v78
    v_lshrrev_b32 v12, 3, v82
    v_cos_f32 v9, v9
    v_lshlrev_b16 v13, 3, v82
    v_mad_i32_i24 v11, v14, s55, v78
    v_bitop3_b32 v12, v6, v13, v12 bitop3:0xca
    v_lshl_add_u32 v11, v11, 17, s40
    v_lshlrev_b16 v14, 8, v14
    v_lshrrev_b32 v13, 2, v82
    v_add_u32 v78, v12, v11
    v_bitop3_b32 v82, v5, v13, v14 bitop3:0xea
    ds_add_u32 v82, v2
    v_mul_hi_u32_u24 v14, 429497, v79
    v_lshrrev_b32 v12, 3, v83
    v_cos_f32 v10, v10
    v_lshlrev_b16 v13, 3, v83
    v_mad_i32_i24 v11, v14, s55, v79
    v_bitop3_b32 v12, v6, v13, v12 bitop3:0xca
    v_lshl_add_u32 v11, v11, 17, s40
    v_lshlrev_b16 v14, 8, v14
    v_lshrrev_b32 v13, 2, v83
    v_add_u32 v79, v12, v11
    v_bitop3_b32 v83, v5, v13, v14 bitop3:0xea
    ds_add_u32 v83, v2
    v_cvt_pk_bf16_f32 v67, v9, v10
    v_perm_b32 v12, v67, v67, s41
    v_bitop3_b32 v78, v4, v12, v78 bitop3:0xca
    v_perm_b32 v13, v67, v67, s42
    v_bitop3_b32 v79, v4, v13, v79 bitop3:0xca
    s_setprio 2
    s_waitcnt vmcnt(18)
    v_lshlrev_b32 v7, 16, v88
    v_and_b32 v8, 0xffff0000, v88
    v_lshlrev_b32 v9, 16, v89
    v_and_b32 v10, 0xffff0000, v89
    v_mul_f32 v7, 0.15915494, v7
    v_mul_f32 v8, 0.15915494, v8
    v_mul_f32 v9, 0.15915494, v9
    v_mul_f32 v10, 0.15915494, v10
    v_mul_hi_u32_u24 v14, 429497, v96
    v_lshrrev_b32 v12, 3, v104
    v_cos_f32 v7, v7
    v_lshlrev_b16 v13, 3, v104
    v_mad_i32_i24 v11, v14, s55, v96
    v_bitop3_b32 v12, v6, v13, v12 bitop3:0xca
    v_lshl_add_u32 v11, v11, 17, s40
    v_lshlrev_b16 v14, 8, v14
    v_lshrrev_b32 v13, 2, v104
    v_add_u32 v96, v12, v11
    v_bitop3_b32 v104, v5, v13, v14 bitop3:0xea
    ds_add_u32 v104, v2
    v_mul_hi_u32_u24 v14, 429497, v97
    v_lshrrev_b32 v12, 3, v105
    v_cos_f32 v8, v8
    v_lshlrev_b16 v13, 3, v105
    v_mad_i32_i24 v11, v14, s55, v97
    v_bitop3_b32 v12, v6, v13, v12 bitop3:0xca
    v_lshl_add_u32 v11, v11, 17, s40
    v_lshlrev_b16 v14, 8, v14
    v_lshrrev_b32 v13, 2, v105
    v_add_u32 v97, v12, v11
    v_bitop3_b32 v105, v5, v13, v14 bitop3:0xea
    ds_add_u32 v105, v2
    v_cvt_pk_bf16_f32 v88, v7, v8
    v_perm_b32 v12, v88, v88, s41
    v_bitop3_b32 v96, v4, v12, v96 bitop3:0xca
    v_perm_b32 v13, v88, v88, s42
    v_bitop3_b32 v97, v4, v13, v97 bitop3:0xca
    v_mul_hi_u32_u24 v14, 429497, v98
    v_lshrrev_b32 v12, 3, v106
    v_cos_f32 v9, v9
    v_lshlrev_b16 v13, 3, v106
    v_mad_i32_i24 v11, v14, s55, v98
    v_bitop3_b32 v12, v6, v13, v12 bitop3:0xca
    v_lshl_add_u32 v11, v11, 17, s40
    v_lshlrev_b16 v14, 8, v14
    v_lshrrev_b32 v13, 2, v106
    v_add_u32 v98, v12, v11
    v_bitop3_b32 v106, v5, v13, v14 bitop3:0xea
    ds_add_u32 v106, v2
    v_mul_hi_u32_u24 v14, 429497, v99
    v_lshrrev_b32 v12, 3, v107
    v_cos_f32 v10, v10
    v_lshlrev_b16 v13, 3, v107
    v_mad_i32_i24 v11, v14, s55, v99
    v_bitop3_b32 v12, v6, v13, v12 bitop3:0xca
    v_lshl_add_u32 v11, v11, 17, s40
    v_lshlrev_b16 v14, 8, v14
    v_lshrrev_b32 v13, 2, v107
    v_add_u32 v99, v12, v11
    v_bitop3_b32 v107, v5, v13, v14 bitop3:0xea
    ds_add_u32 v107, v2
    v_cvt_pk_bf16_f32 v89, v9, v10
    v_perm_b32 v12, v89, v89, s41
    v_bitop3_b32 v98, v4, v12, v98 bitop3:0xca
    v_perm_b32 v13, v89, v89, s42
    v_bitop3_b32 v99, v4, v13, v99 bitop3:0xca
    s_add_u32 s46, s35, 0x2a44000
    s_add_u32 s46, s46, s85
    buffer_store_dwordx4 v[40:43], v0, s[20:23], s46 offen sc1
    s_add_u32 s47, s96, 0x6000000
    s_nop 0
    v_lshlrev_b32 v40, 1, v1
    buffer_load_dwordx4 v[40:43], v40, s[8:11], s47 offen nt
    s_waitcnt vmcnt(17)
    v_lshlrev_b32 v7, 16, v90
    v_and_b32 v8, 0xffff0000, v90
    v_lshlrev_b32 v9, 16, v91
    v_and_b32 v10, 0xffff0000, v91
    v_mul_f32 v7, 0.15915494, v7
    v_mul_f32 v8, 0.15915494, v8
    v_mul_f32 v9, 0.15915494, v9
    v_mul_f32 v10, 0.15915494, v10
    v_mul_hi_u32_u24 v14, 429497, v100
    v_lshrrev_b32 v12, 3, v112
    v_cos_f32 v7, v7
    v_lshlrev_b16 v13, 3, v112
    v_mad_i32_i24 v11, v14, s55, v100
    v_bitop3_b32 v12, v6, v13, v12 bitop3:0xca
    v_lshl_add_u32 v11, v11, 17, s40
    v_lshlrev_b16 v14, 8, v14
    v_lshrrev_b32 v13, 2, v112
    v_add_u32 v100, v12, v11
    v_bitop3_b32 v112, v5, v13, v14 bitop3:0xea
    ds_add_u32 v112, v2
    v_mul_hi_u32_u24 v14, 429497, v101
    v_lshrrev_b32 v12, 3, v113
    v_cos_f32 v8, v8
    v_lshlrev_b16 v13, 3, v113
    v_mad_i32_i24 v11, v14, s55, v101
    v_bitop3_b32 v12, v6, v13, v12 bitop3:0xca
    v_lshl_add_u32 v11, v11, 17, s40
    v_lshlrev_b16 v14, 8, v14
    v_lshrrev_b32 v13, 2, v113
    v_add_u32 v101, v12, v11
    v_bitop3_b32 v113, v5, v13, v14 bitop3:0xea
    ds_add_u32 v113, v2
    v_cvt_pk_bf16_f32 v90, v7, v8
    v_perm_b32 v12, v90, v90, s41
    v_bitop3_b32 v100, v4, v12, v100 bitop3:0xca
    v_perm_b32 v13, v90, v90, s42
    v_bitop3_b32 v101, v4, v13, v101 bitop3:0xca
    v_mul_hi_u32_u24 v14, 429497, v102
    v_lshrrev_b32 v12, 3, v114
    v_cos_f32 v9, v9
    v_lshlrev_b16 v13, 3, v114
    v_mad_i32_i24 v11, v14, s55, v102
    v_bitop3_b32 v12, v6, v13, v12 bitop3:0xca
    v_lshl_add_u32 v11, v11, 17, s40
    v_lshlrev_b16 v14, 8, v14
    v_lshrrev_b32 v13, 2, v114
    v_add_u32 v102, v12, v11
    v_bitop3_b32 v114, v5, v13, v14 bitop3:0xea
    ds_add_u32 v114, v2
    v_mul_hi_u32_u24 v14, 429497, v103
    v_lshrrev_b32 v12, 3, v115
    v_cos_f32 v10, v10
    v_lshlrev_b16 v13, 3, v115
    v_mad_i32_i24 v11, v14, s55, v103
    v_bitop3_b32 v12, v6, v13, v12 bitop3:0xca
    v_lshl_add_u32 v11, v11, 17, s40
    v_lshlrev_b16 v14, 8, v14
    v_lshrrev_b32 v13, 2, v115
    v_add_u32 v103, v12, v11
    v_bitop3_b32 v115, v5, v13, v14 bitop3:0xea
    ds_add_u32 v115, v2
    v_cvt_pk_bf16_f32 v91, v9, v10
    v_perm_b32 v12, v91, v91, s41
    v_bitop3_b32 v102, v4, v12, v102 bitop3:0xca
    v_perm_b32 v13, v91, v91, s42
    v_bitop3_b32 v103, v4, v13, v103 bitop3:0xca
    s_setprio 1
    s_waitcnt vmcnt(13)
    v_lshlrev_b32 v7, 16, v120
    v_and_b32 v8, 0xffff0000, v120
    v_lshlrev_b32 v9, 16, v121
    v_and_b32 v10, 0xffff0000, v121
    v_mul_f32 v7, 0.15915494, v7
    v_mul_f32 v8, 0.15915494, v8
    v_mul_f32 v9, 0.15915494, v9
    v_mul_f32 v10, 0.15915494, v10
    v_mul_hi_u32_u24 v14, 429497, v108
    v_lshrrev_b32 v12, 3, v116
    v_cos_f32 v7, v7
    v_lshlrev_b16 v13, 3, v116
    v_mad_i32_i24 v11, v14, s55, v108
    v_bitop3_b32 v12, v6, v13, v12 bitop3:0xca
    v_lshl_add_u32 v11, v11, 17, s40
    v_lshlrev_b16 v14, 8, v14
    v_lshrrev_b32 v13, 2, v116
    v_add_u32 v108, v12, v11
    v_bitop3_b32 v116, v5, v13, v14 bitop3:0xea
    ds_add_u32 v116, v2
    v_mul_hi_u32_u24 v14, 429497, v109
    v_lshrrev_b32 v12, 3, v117
    v_cos_f32 v8, v8
    v_lshlrev_b16 v13, 3, v117
    v_mad_i32_i24 v11, v14, s55, v109
    v_bitop3_b32 v12, v6, v13, v12 bitop3:0xca
    v_lshl_add_u32 v11, v11, 17, s40
    v_lshlrev_b16 v14, 8, v14
    v_lshrrev_b32 v13, 2, v117
    v_add_u32 v109, v12, v11
    v_bitop3_b32 v117, v5, v13, v14 bitop3:0xea
    ds_add_u32 v117, v2
    v_cvt_pk_bf16_f32 v120, v7, v8
    v_perm_b32 v12, v120, v120, s41
    v_bitop3_b32 v108, v4, v12, v108 bitop3:0xca
    v_perm_b32 v13, v120, v120, s42
    v_bitop3_b32 v109, v4, v13, v109 bitop3:0xca
    v_mul_hi_u32_u24 v14, 429497, v110
    v_lshrrev_b32 v12, 3, v118
    v_cos_f32 v9, v9
    v_lshlrev_b16 v13, 3, v118
    v_mad_i32_i24 v11, v14, s55, v110
    v_bitop3_b32 v12, v6, v13, v12 bitop3:0xca
    v_lshl_add_u32 v11, v11, 17, s40
    v_lshlrev_b16 v14, 8, v14
    v_lshrrev_b32 v13, 2, v118
    v_add_u32 v110, v12, v11
    v_bitop3_b32 v118, v5, v13, v14 bitop3:0xea
    ds_add_u32 v118, v2
    v_mul_hi_u32_u24 v14, 429497, v111
    v_lshrrev_b32 v12, 3, v119
    v_cos_f32 v10, v10
    v_lshlrev_b16 v13, 3, v119
    v_mad_i32_i24 v11, v14, s55, v111
    v_bitop3_b32 v12, v6, v13, v12 bitop3:0xca
    v_lshl_add_u32 v11, v11, 17, s40
    v_lshlrev_b16 v14, 8, v14
    v_lshrrev_b32 v13, 2, v119
    v_add_u32 v111, v12, v11
    v_bitop3_b32 v119, v5, v13, v14 bitop3:0xea
    ds_add_u32 v119, v2
    v_cvt_pk_bf16_f32 v121, v9, v10
    v_perm_b32 v12, v121, v121, s41
    v_bitop3_b32 v110, v4, v12, v110 bitop3:0xca
    v_perm_b32 v13, v121, v121, s42
    v_bitop3_b32 v111, v4, v13, v111 bitop3:0xca
    s_waitcnt vmcnt(10)
    v_lshlrev_b32 v7, 16, v122
    v_and_b32 v8, 0xffff0000, v122
    v_lshlrev_b32 v9, 16, v123
    v_and_b32 v10, 0xffff0000, v123
    v_mul_f32 v7, 0.15915494, v7
    v_mul_f32 v8, 0.15915494, v8
    v_mul_f32 v9, 0.15915494, v9
    v_mul_f32 v10, 0.15915494, v10
    v_mul_hi_u32_u24 v14, 429497, v92
    v_lshrrev_b32 v12, 3, v16
    v_cos_f32 v7, v7
    v_lshlrev_b16 v13, 3, v16
    v_mad_i32_i24 v11, v14, s55, v92
    v_bitop3_b32 v12, v6, v13, v12 bitop3:0xca
    v_lshl_add_u32 v11, v11, 17, s40
    v_lshlrev_b16 v14, 8, v14
    v_lshrrev_b32 v13, 2, v16
    v_add_u32 v92, v12, v11
    v_bitop3_b32 v16, v5, v13, v14 bitop3:0xea
    ds_add_u32 v16, v2
    v_mul_hi_u32_u24 v14, 429497, v93
    v_lshrrev_b32 v12, 3, v17
    v_cos_f32 v8, v8
    v_lshlrev_b16 v13, 3, v17
    v_mad_i32_i24 v11, v14, s55, v93
    v_bitop3_b32 v12, v6, v13, v12 bitop3:0xca
    v_lshl_add_u32 v11, v11, 17, s40
    v_lshlrev_b16 v14, 8, v14
    v_lshrrev_b32 v13, 2, v17
    v_add_u32 v93, v12, v11
    v_bitop3_b32 v17, v5, v13, v14 bitop3:0xea
    ds_add_u32 v17, v2
    v_cvt_pk_bf16_f32 v122, v7, v8
    v_perm_b32 v12, v122, v122, s41
    v_bitop3_b32 v92, v4, v12, v92 bitop3:0xca
    v_perm_b32 v13, v122, v122, s42
    v_bitop3_b32 v93, v4, v13, v93 bitop3:0xca
    v_mul_hi_u32_u24 v14, 429497, v94
    v_lshrrev_b32 v12, 3, v18
    v_cos_f32 v9, v9
    v_lshlrev_b16 v13, 3, v18
    v_mad_i32_i24 v11, v14, s55, v94
    v_bitop3_b32 v12, v6, v13, v12 bitop3:0xca
    v_lshl_add_u32 v11, v11, 17, s40
    v_lshlrev_b16 v14, 8, v14
    v_lshrrev_b32 v13, 2, v18
    v_add_u32 v94, v12, v11
    v_bitop3_b32 v18, v5, v13, v14 bitop3:0xea
    ds_add_u32 v18, v2
    v_mul_hi_u32_u24 v14, 429497, v95
    v_lshrrev_b32 v12, 3, v19
    v_cos_f32 v10, v10
    v_lshlrev_b16 v13, 3, v19
    v_mad_i32_i24 v11, v14, s55, v95
    v_bitop3_b32 v12, v6, v13, v12 bitop3:0xca
    v_lshl_add_u32 v11, v11, 17, s40
    v_lshlrev_b16 v14, 8, v14
    v_lshrrev_b32 v13, 2, v19
    v_add_u32 v95, v12, v11
    v_bitop3_b32 v19, v5, v13, v14 bitop3:0xea
    ds_add_u32 v19, v2
    v_cvt_pk_bf16_f32 v123, v9, v10
    v_perm_b32 v12, v123, v123, s41
    v_bitop3_b32 v94, v4, v12, v94 bitop3:0xca
    v_perm_b32 v13, v123, v123, s42
    v_bitop3_b32 v95, v4, v13, v95 bitop3:0xca
    s_setprio 0
    s_add_u32 s44, s35, 0x2a44000
    s_add_u32 s44, s44, s91
    buffer_store_dwordx4 v[24:27], v0, s[20:23], s44 offen sc1
    s_add_u32 s45, s96, 0x6000000
    s_nop 0
    v_lshlrev_b32 v24, 1, v1
    buffer_load_dwordx4 v[24:27], v24, s[12:15], s45 offen nt
    s_waitcnt vmcnt(8)
    v_lshlrev_b32 v7, 16, v28
    v_and_b32 v8, 0xffff0000, v28
    v_lshlrev_b32 v9, 16, v29
    v_and_b32 v10, 0xffff0000, v29
    v_mul_f32 v7, 0.15915494, v7
    v_mul_f32 v8, 0.15915494, v8
    v_mul_f32 v9, 0.15915494, v9
    v_mul_f32 v10, 0.15915494, v10
    v_mul_hi_u32_u24 v14, 429497, v20
    v_lshrrev_b32 v12, 3, v124
    v_cos_f32 v7, v7
    v_lshlrev_b16 v13, 3, v124
    v_mad_i32_i24 v11, v14, s55, v20
    v_bitop3_b32 v12, v6, v13, v12 bitop3:0xca
    v_lshl_add_u32 v11, v11, 17, s40
    v_lshlrev_b16 v14, 8, v14
    v_lshrrev_b32 v13, 2, v124
    v_add_u32 v20, v12, v11
    v_bitop3_b32 v124, v5, v13, v14 bitop3:0xea
    ds_add_u32 v124, v2
    v_mul_hi_u32_u24 v14, 429497, v21
    v_lshrrev_b32 v12, 3, v125
    v_cos_f32 v8, v8
    v_lshlrev_b16 v13, 3, v125
    v_mad_i32_i24 v11, v14, s55, v21
    v_bitop3_b32 v12, v6, v13, v12 bitop3:0xca
    v_lshl_add_u32 v11, v11, 17, s40
    v_lshlrev_b16 v14, 8, v14
    v_lshrrev_b32 v13, 2, v125
    v_add_u32 v21, v12, v11
    v_bitop3_b32 v125, v5, v13, v14 bitop3:0xea
    ds_add_u32 v125, v2
    v_cvt_pk_bf16_f32 v28, v7, v8
    v_perm_b32 v12, v28, v28, s41
    v_bitop3_b32 v20, v4, v12, v20 bitop3:0xca
    v_perm_b32 v13, v28, v28, s42
    v_bitop3_b32 v21, v4, v13, v21 bitop3:0xca
    v_mul_hi_u32_u24 v14, 429497, v22
    v_lshrrev_b32 v12, 3, v126
    v_cos_f32 v9, v9
    v_lshlrev_b16 v13, 3, v126
    v_mad_i32_i24 v11, v14, s55, v22
    v_bitop3_b32 v12, v6, v13, v12 bitop3:0xca
    v_lshl_add_u32 v11, v11, 17, s40
    v_lshlrev_b16 v14, 8, v14
    v_lshrrev_b32 v13, 2, v126
    v_add_u32 v22, v12, v11
    v_bitop3_b32 v126, v5, v13, v14 bitop3:0xea
    ds_add_u32 v126, v2
    v_mul_hi_u32_u24 v14, 429497, v23
    v_lshrrev_b32 v12, 3, v127
    v_cos_f32 v10, v10
    v_lshlrev_b16 v13, 3, v127
    v_mad_i32_i24 v11, v14, s55, v23
    v_bitop3_b32 v12, v6, v13, v12 bitop3:0xca
    v_lshl_add_u32 v11, v11, 17, s40
    v_lshlrev_b16 v14, 8, v14
    v_lshrrev_b32 v13, 2, v127
    v_add_u32 v23, v12, v11
    v_bitop3_b32 v127, v5, v13, v14 bitop3:0xea
    ds_add_u32 v127, v2
    v_cvt_pk_bf16_f32 v29, v9, v10
    v_perm_b32 v12, v29, v29, s41
    v_bitop3_b32 v22, v4, v12, v22 bitop3:0xca
    v_perm_b32 v13, v29, v29, s42
    v_bitop3_b32 v23, v4, v13, v23 bitop3:0xca
    s_waitcnt vmcnt(4)
    v_lshlrev_b32 v7, 16, v30
    v_and_b32 v8, 0xffff0000, v30
    v_lshlrev_b32 v9, 16, v31
    v_and_b32 v10, 0xffff0000, v31
    v_mul_f32 v7, 0.15915494, v7
    v_mul_f32 v8, 0.15915494, v8
    v_mul_f32 v9, 0.15915494, v9
    v_mul_f32 v10, 0.15915494, v10
    v_mul_hi_u32_u24 v14, 429497, v32
    v_lshrrev_b32 v12, 3, v36
    v_cos_f32 v7, v7
    v_lshlrev_b16 v13, 3, v36
    v_mad_i32_i24 v11, v14, s55, v32
    v_bitop3_b32 v12, v6, v13, v12 bitop3:0xca
    v_lshl_add_u32 v11, v11, 17, s40
    v_lshlrev_b16 v14, 8, v14
    v_lshrrev_b32 v13, 2, v36
    v_add_u32 v32, v12, v11
    v_bitop3_b32 v36, v5, v13, v14 bitop3:0xea
    ds_add_u32 v36, v2
    v_mul_hi_u32_u24 v14, 429497, v33
    v_lshrrev_b32 v12, 3, v37
    v_cos_f32 v8, v8
    v_lshlrev_b16 v13, 3, v37
    v_mad_i32_i24 v11, v14, s55, v33
    v_bitop3_b32 v12, v6, v13, v12 bitop3:0xca
    v_lshl_add_u32 v11, v11, 17, s40
    v_lshlrev_b16 v14, 8, v14
    v_lshrrev_b32 v13, 2, v37
    v_add_u32 v33, v12, v11
    v_bitop3_b32 v37, v5, v13, v14 bitop3:0xea
    ds_add_u32 v37, v2
    v_cvt_pk_bf16_f32 v30, v7, v8
    v_perm_b32 v12, v30, v30, s41
    v_bitop3_b32 v32, v4, v12, v32 bitop3:0xca
    v_perm_b32 v13, v30, v30, s42
    v_bitop3_b32 v33, v4, v13, v33 bitop3:0xca
    v_mul_hi_u32_u24 v14, 429497, v34
    v_lshrrev_b32 v12, 3, v38
    v_cos_f32 v9, v9
    v_lshlrev_b16 v13, 3, v38
    v_mad_i32_i24 v11, v14, s55, v34
    v_bitop3_b32 v12, v6, v13, v12 bitop3:0xca
    v_lshl_add_u32 v11, v11, 17, s40
    v_lshlrev_b16 v14, 8, v14
    v_lshrrev_b32 v13, 2, v38
    v_add_u32 v34, v12, v11
    v_bitop3_b32 v38, v5, v13, v14 bitop3:0xea
    ds_add_u32 v38, v2
    v_mul_hi_u32_u24 v14, 429497, v35
    v_lshrrev_b32 v12, 3, v39
    v_cos_f32 v10, v10
    v_lshlrev_b16 v13, 3, v39
    v_mad_i32_i24 v11, v14, s55, v35
    v_bitop3_b32 v12, v6, v13, v12 bitop3:0xca
    v_lshl_add_u32 v11, v11, 17, s40
    v_lshlrev_b16 v14, 8, v14
    v_lshrrev_b32 v13, 2, v39
    v_add_u32 v35, v12, v11
    v_bitop3_b32 v39, v5, v13, v14 bitop3:0xea
    ds_add_u32 v39, v2
    v_cvt_pk_bf16_f32 v31, v9, v10
    v_perm_b32 v12, v31, v31, s41
    v_bitop3_b32 v34, v4, v12, v34 bitop3:0xca
    v_perm_b32 v13, v31, v31, s42
    v_bitop3_b32 v35, v4, v13, v35 bitop3:0xca
    v_lshrrev_b32 v8, 2, v0
    v_and_b32 v7, 0x3c00, v0
    v_bitop3_b32 v7, v5, v8, v7 bitop3:0xea
    s_waitcnt lgkmcnt(0)
    s_barrier
    ds_read2st64_b32 v[8:9], v7 offset0:0 offset1:1
    ds_read2st64_b32 v[10:11], v7 offset0:2 offset1:3
    s_add_u32 s46, s35, 0x2a44000
    s_add_u32 s46, s46, s93
    buffer_store_dwordx4 v[84:87], v0, s[20:23], s46 offen sc1
    s_add_u32 s47, s96, 0x6000000
    s_lshr_b32 s47, s47, 1
    buffer_load_dwordx2 v[84:85], v1, s[16:19], s47 offen nt
    s_add_u32 s44, s97, 0x6400000
    s_lshr_b32 s44, s44, 1
    buffer_load_dwordx2 v[86:87], v1, s[16:19], s44 offen nt
    s_waitcnt lgkmcnt(0)
    v_lshl_or_b32 v12, v9, 16, v8
    v_lshl_or_b32 v13, v11, 16, v10
    v_mov_b32 v14, v12
    v_mov_b32 v15, v13
    s_nop 0
    v_add_u32_dpp v14, v14, v14 row_shr:1 row_mask:0xf bank_mask:0xf bound_ctrl:1
    v_add_u32_dpp v15, v15, v15 row_shr:1 row_mask:0xf bank_mask:0xf bound_ctrl:1
    s_nop 0
    v_add_u32_dpp v14, v14, v14 row_shr:2 row_mask:0xf bank_mask:0xf bound_ctrl:1
    v_add_u32_dpp v15, v15, v15 row_shr:2 row_mask:0xf bank_mask:0xf bound_ctrl:1
    s_nop 0
    v_add_u32_dpp v14, v14, v14 row_shr:4 row_mask:0xf bank_mask:0xf bound_ctrl:1
    v_add_u32_dpp v15, v15, v15 row_shr:4 row_mask:0xf bank_mask:0xf bound_ctrl:1
    s_nop 0
    v_add_u32_dpp v14, v14, v14 row_shr:8 row_mask:0xf bank_mask:0xf bound_ctrl:1
    v_add_u32_dpp v15, v15, v15 row_shr:8 row_mask:0xf bank_mask:0xf bound_ctrl:1
    s_nop 0
    v_add_u32_dpp v14, v14, v14 row_bcast:15 row_mask:0xa bank_mask:0xf
    v_add_u32_dpp v15, v15, v15 row_bcast:15 row_mask:0xa bank_mask:0xf
    s_nop 0
    v_add_u32_dpp v14, v14, v14 row_bcast:31 row_mask:0xc bank_mask:0xf
    v_add_u32_dpp v15, v15, v15 row_bcast:31 row_mask:0xc bank_mask:0xf
    v_readlane_b32 s48, v14, 63
    v_readlane_b32 s49, v15, 63
    s_lshl_b32 s54, s32, 2
    v_mov_b32 v8, s54
    s_and_b32 s50, s48, 0xffff
    s_lshr_b32 s51, s48, 16
    s_and_b32 s52, s49, 0xffff
    s_lshr_b32 s53, s49, 16
    s_add_u32 s51, s51, s50
    s_add_u32 s52, s52, s51
    s_add_u32 s53, s53, s52
    v_mov_b32 v9, s53
    s_mov_b64 exec, 1
    ds_write_b32 v8, v9 offset:16384
    s_mov_b64 exec, -1
    v_and_b32 v8, 60, v7
    s_waitcnt lgkmcnt(0)
    s_barrier
    ds_read_b32 v9, v8 offset:16384
    s_waitcnt lgkmcnt(0)
    v_add_u32_dpp v9, v9, v9 row_shr:1 row_mask:0xf bank_mask:0xf bound_ctrl:1
    s_nop 1
    v_add_u32_dpp v9, v9, v9 row_shr:2 row_mask:0xf bank_mask:0xf bound_ctrl:1
    s_nop 1
    v_add_u32_dpp v9, v9, v9 row_shr:4 row_mask:0xf bank_mask:0xf bound_ctrl:1
    s_nop 1
    v_add_u32_dpp v9, v9, v9 row_shr:8 row_mask:0xf bank_mask:0xf bound_ctrl:1
    s_nop 0
    v_readlane_b32 s54, v9, s32
    s_sub_u32 s54, s54, s53
    s_add_u32 s50, s50, s54
    s_add_u32 s51, s51, s54
    s_add_u32 s52, s52, s54
    s_pack_ll_b32_b16 s48, s54, s50
    s_pack_ll_b32_b16 s49, s51, s52
    v_add_u32 v14, s48, v14
    v_add_u32 v15, s49, v15
    v_sub_u32 v12, v14, v12
    v_sub_u32 v13, v15, v13
    v_and_b32 v8, 0xffff, v12
    v_lshrrev_b32 v9, 16, v12
    v_and_b32 v10, 0xffff, v13
    v_lshrrev_b32 v11, 16, v13
    ds_write2st64_b32 v7, v8, v9 offset0:0 offset1:1
    ds_write2st64_b32 v7, v10, v11 offset0:2 offset1:3
    v_and_b32 v8, 0x3f0, v0
    v_lshl_add_u32 v8, v8, 1, s36
    ds_write_b64 v8, v[12:13] offset:20480
    s_bitset0_b64 exec, 63
    s_not_b64 exec, exec
    ds_write_b64 v8, v[14:15] offset:20512
    s_mov_b64 exec, -1
    s_waitcnt lgkmcnt(0)
    s_barrier
    s_setprio 3
    ds_add_rtn_u32 v72, v72, v2
    ds_add_rtn_u32 v73, v73, v2
    ds_add_rtn_u32 v74, v74, v2
    ds_add_rtn_u32 v75, v75, v2
    ds_read_b128 v[12:15], v0 offset:20480
    v_cmp_gt_u32 vcc, 8448, v0
    ds_add_rtn_u32 v80, v80, v2
    ds_add_rtn_u32 v81, v81, v2
    ds_add_rtn_u32 v82, v82, v2
    ds_add_rtn_u32 v83, v83, v2
    s_setprio 2
    ds_add_rtn_u32 v104, v104, v2
    ds_add_rtn_u32 v105, v105, v2
    ds_add_rtn_u32 v106, v106, v2
    ds_add_rtn_u32 v107, v107, v2
    s_waitcnt lgkmcnt(8)
    s_cbranch_vccz L1_p3
    s_add_u32 s45, s35, 0x5480000
    s_mov_b64 exec, vcc
    buffer_store_dwordx4 v[12:15], v0, s[24:27], s45 offen sc1
    s_mov_b64 exec, -1
L1_p3:
    s_add_u32 s46, s35, 0x2a48000
    s_add_u32 s46, s46, s72
    buffer_store_dwordx4 v[48:51], v0, s[20:23], s46 offen sc1
    s_add_u32 s47, s97, 0x6400000
    s_nop 0
    v_lshlrev_b32 v48, 1, v1
    buffer_load_dwordx4 v[48:51], v48, s[8:11], s47 offen nt
    ds_add_rtn_u32 v112, v112, v2
    ds_add_rtn_u32 v113, v113, v2
    ds_add_rtn_u32 v114, v114, v2
    ds_add_rtn_u32 v115, v115, v2
    s_setprio 1
    ds_add_rtn_u32 v116, v116, v2
    ds_add_rtn_u32 v117, v117, v2
    ds_add_rtn_u32 v118, v118, v2
    ds_add_rtn_u32 v119, v119, v2
    ds_add_rtn_u32 v16, v16, v2
    ds_add_rtn_u32 v17, v17, v2
    ds_add_rtn_u32 v18, v18, v2
    ds_add_rtn_u32 v19, v19, v2
    s_add_u32 s44, s35, 0x2a48000
    s_add_u32 s44, s44, s73
    buffer_store_dwordx4 v[52:55], v0, s[20:23], s44 offen sc1
    s_add_u32 s45, s97, 0x6400000
    s_nop 0
    v_lshlrev_b32 v52, 1, v1
    buffer_load_dwordx4 v[52:55], v52, s[12:15], s45 offen nt
    s_setprio 0
    ds_add_rtn_u32 v124, v124, v2
    ds_add_rtn_u32 v125, v125, v2
    ds_add_rtn_u32 v126, v126, v2
    ds_add_rtn_u32 v127, v127, v2
    ds_add_rtn_u32 v36, v36, v2
    ds_add_rtn_u32 v37, v37, v2
    ds_add_rtn_u32 v38, v38, v2
    ds_add_rtn_u32 v39, v39, v2
    s_waitcnt lgkmcnt(0)
    s_barrier
    s_setprio 3
    v_and_b32 v7, -4, v72
    v_lshl_add_u32 v8, v72, 2, v7
    ds_write_b32 v8, v68
    v_lshl_add_u32 v7, v7, 2, v72
    ds_write_b8 v7, v64 offset:16
    v_and_b32 v9, -4, v73
    v_lshl_add_u32 v10, v73, 2, v9
    ds_write_b32 v10, v69
    v_lshl_add_u32 v9, v9, 2, v73
    ds_write_b8_d16_hi v9, v64 offset:16
    v_and_b32 v7, -4, v74
    v_lshl_add_u32 v8, v74, 2, v7
    ds_write_b32 v8, v70
    v_lshl_add_u32 v7, v7, 2, v74
    ds_write_b8 v7, v65 offset:16
    v_and_b32 v9, -4, v75
    v_lshl_add_u32 v10, v75, 2, v9
    ds_write_b32 v10, v71
    v_lshl_add_u32 v9, v9, 2, v75
    ds_write_b8_d16_hi v9, v65 offset:16
    s_add_u32 s46, s35, 0x2a48000
    s_add_u32 s46, s46, s85
    buffer_store_dwordx4 v[56:59], v0, s[20:23], s46 offen sc1
    s_add_u32 s47, s98, 0x6800000
    v_lshlrev_b32 v68, 1, v1
    buffer_load_dwordx4 v[68:71], v68, s[8:11], s47 offen nt
    s_add_u32 s44, s98, 0x6800000
    v_lshlrev_b32 v72, 1, v1
    buffer_load_dwordx4 v[72:75], v72, s[12:15], s44 offen nt
    v_and_b32 v7, -4, v80
    v_lshl_add_u32 v8, v80, 2, v7
    ds_write_b32 v8, v76
    v_lshl_add_u32 v7, v7, 2, v80
    ds_write_b8 v7, v66 offset:16
    v_and_b32 v9, -4, v81
    v_lshl_add_u32 v10, v81, 2, v9
    ds_write_b32 v10, v77
    v_lshl_add_u32 v9, v9, 2, v81
    ds_write_b8_d16_hi v9, v66 offset:16
    v_and_b32 v7, -4, v82
    v_lshl_add_u32 v8, v82, 2, v7
    ds_write_b32 v8, v78
    v_lshl_add_u32 v7, v7, 2, v82
    ds_write_b8 v7, v67 offset:16
    v_and_b32 v9, -4, v83
    v_lshl_add_u32 v10, v83, 2, v9
    ds_write_b32 v10, v79
    v_lshl_add_u32 v9, v9, 2, v83
    ds_write_b8_d16_hi v9, v67 offset:16
    s_add_u32 s45, s98, 0x6800000
    s_lshr_b32 s45, s45, 1
    buffer_load_dwordx2 v[56:57], v1, s[16:19], s45 offen nt
    s_add_u32 s46, s99, 0x6c00000
    s_lshr_b32 s46, s46, 1
    buffer_load_dwordx2 v[58:59], v1, s[16:19], s46 offen nt
    s_add_u32 s47, s99, 0x6c00000
    v_lshlrev_b32 v76, 1, v1
    buffer_load_dwordx4 v[76:79], v76, s[8:11], s47 offen nt
    s_setprio 2
    v_and_b32 v7, -4, v104
    v_lshl_add_u32 v8, v104, 2, v7
    ds_write_b32 v8, v96
    v_lshl_add_u32 v7, v7, 2, v104
    ds_write_b8 v7, v88 offset:16
    v_and_b32 v9, -4, v105
    v_lshl_add_u32 v10, v105, 2, v9
    ds_write_b32 v10, v97
    v_lshl_add_u32 v9, v9, 2, v105
    ds_write_b8_d16_hi v9, v88 offset:16
    v_and_b32 v7, -4, v106
    v_lshl_add_u32 v8, v106, 2, v7
    ds_write_b32 v8, v98
    v_lshl_add_u32 v7, v7, 2, v106
    ds_write_b8 v7, v89 offset:16
    v_and_b32 v9, -4, v107
    v_lshl_add_u32 v10, v107, 2, v9
    ds_write_b32 v10, v99
    v_lshl_add_u32 v9, v9, 2, v107
    ds_write_b8_d16_hi v9, v89 offset:16
    s_add_u32 s44, s35, 0x2a48000
    s_add_u32 s44, s44, s91
    buffer_store_dwordx4 v[60:63], v0, s[20:23], s44 offen sc1
    s_add_u32 s45, s99, 0x6c00000
    v_lshlrev_b32 v80, 1, v1
    buffer_load_dwordx4 v[80:83], v80, s[12:15], s45 offen nt
    v_and_b32 v7, -4, v112
    v_lshl_add_u32 v8, v112, 2, v7
    ds_write_b32 v8, v100
    v_lshl_add_u32 v7, v7, 2, v112
    ds_write_b8 v7, v90 offset:16
    v_and_b32 v9, -4, v113
    v_lshl_add_u32 v10, v113, 2, v9
    ds_write_b32 v10, v101
    v_lshl_add_u32 v9, v9, 2, v113
    ds_write_b8_d16_hi v9, v90 offset:16
    v_and_b32 v7, -4, v114
    v_lshl_add_u32 v8, v114, 2, v7
    ds_write_b32 v8, v102
    v_lshl_add_u32 v7, v7, 2, v114
    ds_write_b8 v7, v91 offset:16
    v_and_b32 v9, -4, v115
    v_lshl_add_u32 v10, v115, 2, v9
    ds_write_b32 v10, v103
    v_lshl_add_u32 v9, v9, 2, v115
    ds_write_b8_d16_hi v9, v91 offset:16
    s_add_u32 s46, s96, 0x7000000
    v_lshlrev_b32 v64, 1, v1
    buffer_load_dwordx4 v[64:67], v64, s[8:11], s46 offen nt
    s_add_u32 s47, s96, 0x7000000
    v_lshlrev_b32 v96, 1, v1
    buffer_load_dwordx4 v[96:99], v96, s[12:15], s47 offen nt
    s_setprio 1
    v_and_b32 v7, -4, v116
    v_lshl_add_u32 v8, v116, 2, v7
    ds_write_b32 v8, v108
    v_lshl_add_u32 v7, v7, 2, v116
    ds_write_b8 v7, v120 offset:16
    v_and_b32 v9, -4, v117
    v_lshl_add_u32 v10, v117, 2, v9
    ds_write_b32 v10, v109
    v_lshl_add_u32 v9, v9, 2, v117
    ds_write_b8_d16_hi v9, v120 offset:16
    v_and_b32 v7, -4, v118
    v_lshl_add_u32 v8, v118, 2, v7
    ds_write_b32 v8, v110
    v_lshl_add_u32 v7, v7, 2, v118
    ds_write_b8 v7, v121 offset:16
    v_and_b32 v9, -4, v119
    v_lshl_add_u32 v10, v119, 2, v9
    ds_write_b32 v10, v111
    v_lshl_add_u32 v9, v9, 2, v119
    ds_write_b8_d16_hi v9, v121 offset:16
    s_add_u32 s44, s96, 0x7000000
    s_lshr_b32 s44, s44, 1
    buffer_load_dwordx2 v[104:105], v1, s[16:19], s44 offen nt
    s_add_u32 s45, s97, 0x7400000
    s_lshr_b32 s45, s45, 1
    buffer_load_dwordx2 v[106:107], v1, s[16:19], s45 offen nt
    s_add_u32 s46, s97, 0x7400000
    v_lshlrev_b32 v60, 1, v1
    buffer_load_dwordx4 v[60:63], v60, s[8:11], s46 offen nt
    v_and_b32 v7, -4, v16
    v_lshl_add_u32 v8, v16, 2, v7
    ds_write_b32 v8, v92
    v_lshl_add_u32 v7, v7, 2, v16
    ds_write_b8 v7, v122 offset:16
    v_and_b32 v9, -4, v17
    v_lshl_add_u32 v10, v17, 2, v9
    ds_write_b32 v10, v93
    v_lshl_add_u32 v9, v9, 2, v17
    ds_write_b8_d16_hi v9, v122 offset:16
    v_and_b32 v7, -4, v18
    v_lshl_add_u32 v8, v18, 2, v7
    ds_write_b32 v8, v94
    v_lshl_add_u32 v7, v7, 2, v18
    ds_write_b8 v7, v123 offset:16
    v_and_b32 v9, -4, v19
    v_lshl_add_u32 v10, v19, 2, v9
    ds_write_b32 v10, v95
    v_lshl_add_u32 v9, v9, 2, v19
    ds_write_b8_d16_hi v9, v123 offset:16
    s_add_u32 s47, s35, 0x2a48000
    s_add_u32 s47, s47, s93
    buffer_store_dwordx4 v[44:47], v0, s[20:23], s47 offen sc1
    s_add_u32 s44, s97, 0x7400000
    v_lshlrev_b32 v100, 1, v1
    buffer_load_dwordx4 v[100:103], v100, s[12:15], s44 offen nt
    s_setprio 0
    v_and_b32 v7, -4, v124
    v_lshl_add_u32 v8, v124, 2, v7
    ds_write_b32 v8, v20
    v_lshl_add_u32 v7, v7, 2, v124
    ds_write_b8 v7, v28 offset:16
    v_and_b32 v9, -4, v125
    v_lshl_add_u32 v10, v125, 2, v9
    ds_write_b32 v10, v21
    v_lshl_add_u32 v9, v9, 2, v125
    ds_write_b8_d16_hi v9, v28 offset:16
    v_and_b32 v7, -4, v126
    v_lshl_add_u32 v8, v126, 2, v7
    ds_write_b32 v8, v22
    v_lshl_add_u32 v7, v7, 2, v126
    ds_write_b8 v7, v29 offset:16
    v_and_b32 v9, -4, v127
    v_lshl_add_u32 v10, v127, 2, v9
    ds_write_b32 v10, v23
    v_lshl_add_u32 v9, v9, 2, v127
    ds_write_b8_d16_hi v9, v29 offset:16
    s_add_u32 s45, s98, 0x7800000
    v_lshlrev_b32 v112, 1, v1
    buffer_load_dwordx4 v[112:115], v112, s[8:11], s45 offen nt
    s_add_u32 s46, s98, 0x7800000
    v_lshlrev_b32 v88, 1, v1
    buffer_load_dwordx4 v[88:91], v88, s[12:15], s46 offen nt
    v_and_b32 v7, -4, v36
    v_lshl_add_u32 v8, v36, 2, v7
    ds_write_b32 v8, v32
    v_lshl_add_u32 v7, v7, 2, v36
    ds_write_b8 v7, v30 offset:16
    v_and_b32 v9, -4, v37
    v_lshl_add_u32 v10, v37, 2, v9
    ds_write_b32 v10, v33
    v_lshl_add_u32 v9, v9, 2, v37
    ds_write_b8_d16_hi v9, v30 offset:16
    v_and_b32 v7, -4, v38
    v_lshl_add_u32 v8, v38, 2, v7
    ds_write_b32 v8, v34
    v_lshl_add_u32 v7, v7, 2, v38
    ds_write_b8 v7, v31 offset:16
    v_and_b32 v9, -4, v39
    v_lshl_add_u32 v10, v39, 2, v9
    ds_write_b32 v10, v35
    v_lshl_add_u32 v9, v9, 2, v39
    ds_write_b8_d16_hi v9, v31 offset:16
    s_add_u32 s47, s98, 0x7800000
    s_lshr_b32 s47, s47, 1
    buffer_load_dwordx2 v[108:109], v1, s[16:19], s47 offen nt
    s_add_u32 s44, s99, 0x7c00000
    s_lshr_b32 s44, s44, 1
    buffer_load_dwordx2 v[110:111], v1, s[16:19], s44 offen nt
    v_add_u32 v7, s72, v0
    v_add_u32 v12, s73, v0
    v_add_u32 v13, s85, v0
    v_add_u32 v14, s91, v0
    v_add_u32 v15, s93, v0
    s_min_i32 s3, s72, s73
    s_min_i32 s3, s3, s85
    s_min_i32 s3, s3, s91
    s_min_i32 s3, s3, s93
    v_add_u32 v3, s3, v0
    v_mov_b32 v8, 0
    v_mov_b32 v9, 0
    v_mov_b32 v10, 0
    v_mov_b32 v11, 0
    s_waitcnt lgkmcnt(0)
    s_barrier
    ds_read_b128 v[116:119], v7 offset:0
    ds_read_b128 v[92:95], v12 offset:0
    ds_read_b128 v[16:19], v13 offset:0
    ds_read_b128 v[120:123], v14 offset:0
    ds_read_b128 v[44:47], v15 offset:0
    ds_write_b128 v3, v[8:11]
    ds_read_b128 v[20:23], v7 offset:16384
    ds_read_b128 v[124:127], v12 offset:16384
    ds_read_b128 v[32:35], v13 offset:16384
    ds_read_b128 v[36:39], v14 offset:16384
    ds_read_b128 v[28:31], v15 offset:16384
    s_waitcnt lgkmcnt(0)
    s_barrier
    s_setprio 3
    s_add_u32 s45, s35, 0x5484000
    s_add_u32 s45, s45, s72
    buffer_store_dwordx4 v[116:119], v0, s[20:23], s45 offen sc1
    s_add_u32 s46, s99, 0x7c00000
    s_nop 0
    v_lshlrev_b32 v116, 1, v1
    buffer_load_dwordx4 v[116:119], v116, s[8:11], s46 offen nt
    s_add_u32 s47, s35, 0x5484000
    s_add_u32 s47, s47, s73
    buffer_store_dwordx4 v[92:95], v0, s[20:23], s47 offen sc1
    s_add_u32 s44, s99, 0x7c00000
    s_nop 0
    v_lshlrev_b32 v92, 1, v1
    buffer_load_dwordx4 v[92:95], v92, s[12:15], s44 offen nt
    s_waitcnt vmcnt(27)
    v_lshlrev_b32 v7, 16, v84
    v_and_b32 v8, 0xffff0000, v84
    v_lshlrev_b32 v9, 16, v85
    v_and_b32 v10, 0xffff0000, v85
    v_mul_f32 v7, 0.15915494, v7
    v_mul_f32 v8, 0.15915494, v8
    v_mul_f32 v9, 0.15915494, v9
    v_mul_f32 v10, 0.15915494, v10
    v_mul_hi_u32_u24 v14, 429497, v40
    v_lshrrev_b32 v12, 3, v24
    v_cos_f32 v7, v7
    v_lshlrev_b16 v13, 3, v24
    v_mad_i32_i24 v11, v14, s55, v40
    v_bitop3_b32 v12, v6, v13, v12 bitop3:0xca
    v_lshl_add_u32 v11, v11, 17, s40
    v_lshlrev_b16 v14, 8, v14
    v_lshrrev_b32 v13, 2, v24
    v_add_u32 v40, v12, v11
    v_bitop3_b32 v24, v5, v13, v14 bitop3:0xea
    ds_add_u32 v24, v2
    v_mul_hi_u32_u24 v14, 429497, v41
    v_lshrrev_b32 v12, 3, v25
    v_cos_f32 v8, v8
    v_lshlrev_b16 v13, 3, v25
    v_mad_i32_i24 v11, v14, s55, v41
    v_bitop3_b32 v12, v6, v13, v12 bitop3:0xca
    v_lshl_add_u32 v11, v11, 17, s40
    v_lshlrev_b16 v14, 8, v14
    v_lshrrev_b32 v13, 2, v25
    v_add_u32 v41, v12, v11
    v_bitop3_b32 v25, v5, v13, v14 bitop3:0xea
    ds_add_u32 v25, v2
    v_cvt_pk_bf16_f32 v84, v7, v8
    v_perm_b32 v12, v84, v84, s41
    v_bitop3_b32 v40, v4, v12, v40 bitop3:0xca
    v_perm_b32 v13, v84, v84, s42
    v_bitop3_b32 v41, v4, v13, v41 bitop3:0xca
    v_mul_hi_u32_u24 v14, 429497, v42
    v_lshrrev_b32 v12, 3, v26
    v_cos_f32 v9, v9
    v_lshlrev_b16 v13, 3, v26
    v_mad_i32_i24 v11, v14, s55, v42
    v_bitop3_b32 v12, v6, v13, v12 bitop3:0xca
    v_lshl_add_u32 v11, v11, 17, s40
    v_lshlrev_b16 v14, 8, v14
    v_lshrrev_b32 v13, 2, v26
    v_add_u32 v42, v12, v11
    v_bitop3_b32 v26, v5, v13, v14 bitop3:0xea
    ds_add_u32 v26, v2
    v_mul_hi_u32_u24 v14, 429497, v43
    v_lshrrev_b32 v12, 3, v27
    v_cos_f32 v10, v10
    v_lshlrev_b16 v13, 3, v27
    v_mad_i32_i24 v11, v14, s55, v43
    v_bitop3_b32 v12, v6, v13, v12 bitop3:0xca
    v_lshl_add_u32 v11, v11, 17, s40
    v_lshlrev_b16 v14, 8, v14
    v_lshrrev_b32 v13, 2, v27
    v_add_u32 v43, v12, v11
    v_bitop3_b32 v27, v5, v13, v14 bitop3:0xea
    ds_add_u32 v27, v2
    v_cvt_pk_bf16_f32 v85, v9, v10
    v_perm_b32 v12, v85, v85, s41
    v_bitop3_b32 v42, v4, v12, v42 bitop3:0xca
    v_perm_b32 v13, v85, v85, s42
    v_bitop3_b32 v43, v4, v13, v43 bitop3:0xca
    s_waitcnt vmcnt(23)
    v_lshlrev_b32 v7, 16, v86
    v_and_b32 v8, 0xffff0000, v86
    v_lshlrev_b32 v9, 16, v87
    v_and_b32 v10, 0xffff0000, v87
    v_mul_f32 v7, 0.15915494, v7
    v_mul_f32 v8, 0.15915494, v8
    v_mul_f32 v9, 0.15915494, v9
    v_mul_f32 v10, 0.15915494, v10
    v_mul_hi_u32_u24 v14, 429497, v48
    v_lshrrev_b32 v12, 3, v52
    v_cos_f32 v7, v7
    v_lshlrev_b16 v13, 3, v52
    v_mad_i32_i24 v11, v14, s55, v48
    v_bitop3_b32 v12, v6, v13, v12 bitop3:0xca
    v_lshl_add_u32 v11, v11, 17, s40
    v_lshlrev_b16 v14, 8, v14
    v_lshrrev_b32 v13, 2, v52
    v_add_u32 v48, v12, v11
    v_bitop3_b32 v52, v5, v13, v14 bitop3:0xea
    ds_add_u32 v52, v2
    v_mul_hi_u32_u24 v14, 429497, v49
    v_lshrrev_b32 v12, 3, v53
    v_cos_f32 v8, v8
    v_lshlrev_b16 v13, 3, v53
    v_mad_i32_i24 v11, v14, s55, v49
    v_bitop3_b32 v12, v6, v13, v12 bitop3:0xca
    v_lshl_add_u32 v11, v11, 17, s40
    v_lshlrev_b16 v14, 8, v14
    v_lshrrev_b32 v13, 2, v53
    v_add_u32 v49, v12, v11
    v_bitop3_b32 v53, v5, v13, v14 bitop3:0xea
    ds_add_u32 v53, v2
    v_cvt_pk_bf16_f32 v86, v7, v8
    v_perm_b32 v12, v86, v86, s41
    v_bitop3_b32 v48, v4, v12, v48 bitop3:0xca
    v_perm_b32 v13, v86, v86, s42
    v_bitop3_b32 v49, v4, v13, v49 bitop3:0xca
    v_mul_hi_u32_u24 v14, 429497, v50
    v_lshrrev_b32 v12, 3, v54
    v_cos_f32 v9, v9
    v_lshlrev_b16 v13, 3, v54
    v_mad_i32_i24 v11, v14, s55, v50
    v_bitop3_b32 v12, v6, v13, v12 bitop3:0xca
    v_lshl_add_u32 v11, v11, 17, s40
    v_lshlrev_b16 v14, 8, v14
    v_lshrrev_b32 v13, 2, v54
    v_add_u32 v50, v12, v11
    v_bitop3_b32 v54, v5, v13, v14 bitop3:0xea
    ds_add_u32 v54, v2
    v_mul_hi_u32_u24 v14, 429497, v51
    v_lshrrev_b32 v12, 3, v55
    v_cos_f32 v10, v10
    v_lshlrev_b16 v13, 3, v55
    v_mad_i32_i24 v11, v14, s55, v51
    v_bitop3_b32 v12, v6, v13, v12 bitop3:0xca
    v_lshl_add_u32 v11, v11, 17, s40
    v_lshlrev_b16 v14, 8, v14
    v_lshrrev_b32 v13, 2, v55
    v_add_u32 v51, v12, v11
    v_bitop3_b32 v55, v5, v13, v14 bitop3:0xea
    ds_add_u32 v55, v2
    v_cvt_pk_bf16_f32 v87, v9, v10
    v_perm_b32 v12, v87, v87, s41
    v_bitop3_b32 v50, v4, v12, v50 bitop3:0xca
    v_perm_b32 v13, v87, v87, s42
    v_bitop3_b32 v51, v4, v13, v51 bitop3:0xca
    s_setprio 2
    s_waitcnt vmcnt(18)
    v_lshlrev_b32 v7, 16, v56
    v_and_b32 v8, 0xffff0000, v56
    v_lshlrev_b32 v9, 16, v57
    v_and_b32 v10, 0xffff0000, v57
    v_mul_f32 v7, 0.15915494, v7
    v_mul_f32 v8, 0.15915494, v8
    v_mul_f32 v9, 0.15915494, v9
    v_mul_f32 v10, 0.15915494, v10
    v_mul_hi_u32_u24 v14, 429497, v68
    v_lshrrev_b32 v12, 3, v72
    v_cos_f32 v7, v7
    v_lshlrev_b16 v13, 3, v72
    v_mad_i32_i24 v11, v14, s55, v68
    v_bitop3_b32 v12, v6, v13, v12 bitop3:0xca
    v_lshl_add_u32 v11, v11, 17, s40
    v_lshlrev_b16 v14, 8, v14
    v_lshrrev_b32 v13, 2, v72
    v_add_u32 v68, v12, v11
    v_bitop3_b32 v72, v5, v13, v14 bitop3:0xea
    ds_add_u32 v72, v2
    v_mul_hi_u32_u24 v14, 429497, v69
    v_lshrrev_b32 v12, 3, v73
    v_cos_f32 v8, v8
    v_lshlrev_b16 v13, 3, v73
    v_mad_i32_i24 v11, v14, s55, v69
    v_bitop3_b32 v12, v6, v13, v12 bitop3:0xca
    v_lshl_add_u32 v11, v11, 17, s40
    v_lshlrev_b16 v14, 8, v14
    v_lshrrev_b32 v13, 2, v73
    v_add_u32 v69, v12, v11
    v_bitop3_b32 v73, v5, v13, v14 bitop3:0xea
    ds_add_u32 v73, v2
    v_cvt_pk_bf16_f32 v56, v7, v8
    v_perm_b32 v12, v56, v56, s41
    v_bitop3_b32 v68, v4, v12, v68 bitop3:0xca
    v_perm_b32 v13, v56, v56, s42
    v_bitop3_b32 v69, v4, v13, v69 bitop3:0xca
    v_mul_hi_u32_u24 v14, 429497, v70
    v_lshrrev_b32 v12, 3, v74
    v_cos_f32 v9, v9
    v_lshlrev_b16 v13, 3, v74
    v_mad_i32_i24 v11, v14, s55, v70
    v_bitop3_b32 v12, v6, v13, v12 bitop3:0xca
    v_lshl_add_u32 v11, v11, 17, s40
    v_lshlrev_b16 v14, 8, v14
    v_lshrrev_b32 v13, 2, v74
    v_add_u32 v70, v12, v11
    v_bitop3_b32 v74, v5, v13, v14 bitop3:0xea
    ds_add_u32 v74, v2
    v_mul_hi_u32_u24 v14, 429497, v71
    v_lshrrev_b32 v12, 3, v75
    v_cos_f32 v10, v10
    v_lshlrev_b16 v13, 3, v75
    v_mad_i32_i24 v11, v14, s55, v71
    v_bitop3_b32 v12, v6, v13, v12 bitop3:0xca
    v_lshl_add_u32 v11, v11, 17, s40
    v_lshlrev_b16 v14, 8, v14
    v_lshrrev_b32 v13, 2, v75
    v_add_u32 v71, v12, v11
    v_bitop3_b32 v75, v5, v13, v14 bitop3:0xea
    ds_add_u32 v75, v2
    v_cvt_pk_bf16_f32 v57, v9, v10
    v_perm_b32 v12, v57, v57, s41
    v_bitop3_b32 v70, v4, v12, v70 bitop3:0xca
    v_perm_b32 v13, v57, v57, s42
    v_bitop3_b32 v71, v4, v13, v71 bitop3:0xca
    s_add_u32 s45, s35, 0x5484000
    s_add_u32 s45, s45, s85
    buffer_store_dwordx4 v[16:19], v0, s[20:23], s45 offen sc1
    s_add_u32 s46, s96, 0x8000000
    s_nop 0
    v_lshlrev_b32 v16, 1, v1
    buffer_load_dwordx4 v[16:19], v16, s[8:11], s46 offen nt
    s_waitcnt vmcnt(17)
    v_lshlrev_b32 v7, 16, v58
    v_and_b32 v8, 0xffff0000, v58
    v_lshlrev_b32 v9, 16, v59
    v_and_b32 v10, 0xffff0000, v59
    v_mul_f32 v7, 0.15915494, v7
    v_mul_f32 v8, 0.15915494, v8
    v_mul_f32 v9, 0.15915494, v9
    v_mul_f32 v10, 0.15915494, v10
    v_mul_hi_u32_u24 v14, 429497, v76
    v_lshrrev_b32 v12, 3, v80
    v_cos_f32 v7, v7
    v_lshlrev_b16 v13, 3, v80
    v_mad_i32_i24 v11, v14, s55, v76
    v_bitop3_b32 v12, v6, v13, v12 bitop3:0xca
    v_lshl_add_u32 v11, v11, 17, s40
    v_lshlrev_b16 v14, 8, v14
    v_lshrrev_b32 v13, 2, v80
    v_add_u32 v76, v12, v11
    v_bitop3_b32 v80, v5, v13, v14 bitop3:0xea
    ds_add_u32 v80, v2
    v_mul_hi_u32_u24 v14, 429497, v77
    v_lshrrev_b32 v12, 3, v81
    v_cos_f32 v8, v8
    v_lshlrev_b16 v13, 3, v81
    v_mad_i32_i24 v11, v14, s55, v77
    v_bitop3_b32 v12, v6, v13, v12 bitop3:0xca
    v_lshl_add_u32 v11, v11, 17, s40
    v_lshlrev_b16 v14, 8, v14
    v_lshrrev_b32 v13, 2, v81
    v_add_u32 v77, v12, v11
    v_bitop3_b32 v81, v5, v13, v14 bitop3:0xea
    ds_add_u32 v81, v2
    v_cvt_pk_bf16_f32 v58, v7, v8
    v_perm_b32 v12, v58, v58, s41
    v_bitop3_b32 v76, v4, v12, v76 bitop3:0xca
    v_perm_b32 v13, v58, v58, s42
    v_bitop3_b32 v77, v4, v13, v77 bitop3:0xca
    v_mul_hi_u32_u24 v14, 429497, v78
    v_lshrrev_b32 v12, 3, v82
    v_cos_f32 v9, v9
    v_lshlrev_b16 v13, 3, v82
    v_mad_i32_i24 v11, v14, s55, v78
    v_bitop3_b32 v12, v6, v13, v12 bitop3:0xca
    v_lshl_add_u32 v11, v11, 17, s40
    v_lshlrev_b16 v14, 8, v14
    v_lshrrev_b32 v13, 2, v82
    v_add_u32 v78, v12, v11
    v_bitop3_b32 v82, v5, v13, v14 bitop3:0xea
    ds_add_u32 v82, v2
    v_mul_hi_u32_u24 v14, 429497, v79
    v_lshrrev_b32 v12, 3, v83
    v_cos_f32 v10, v10
    v_lshlrev_b16 v13, 3, v83
    v_mad_i32_i24 v11, v14, s55, v79
    v_bitop3_b32 v12, v6, v13, v12 bitop3:0xca
    v_lshl_add_u32 v11, v11, 17, s40
    v_lshlrev_b16 v14, 8, v14
    v_lshrrev_b32 v13, 2, v83
    v_add_u32 v79, v12, v11
    v_bitop3_b32 v83, v5, v13, v14 bitop3:0xea
    ds_add_u32 v83, v2
    v_cvt_pk_bf16_f32 v59, v9, v10
    v_perm_b32 v12, v59, v59, s41
    v_bitop3_b32 v78, v4, v12, v78 bitop3:0xca
    v_perm_b32 v13, v59, v59, s42
    v_bitop3_b32 v79, v4, v13, v79 bitop3:0xca
    s_setprio 1
    s_waitcnt vmcnt(13)
    v_lshlrev_b32 v7, 16, v104
    v_and_b32 v8, 0xffff0000, v104
    v_lshlrev_b32 v9, 16, v105
    v_and_b32 v10, 0xffff0000, v105
    v_mul_f32 v7, 0.15915494, v7
    v_mul_f32 v8, 0.15915494, v8
    v_mul_f32 v9, 0.15915494, v9
    v_mul_f32 v10, 0.15915494, v10
    v_mul_hi_u32_u24 v14, 429497, v64
    v_lshrrev_b32 v12, 3, v96
    v_cos_f32 v7, v7
    v_lshlrev_b16 v13, 3, v96
    v_mad_i32_i24 v11, v14, s55, v64
    v_bitop3_b32 v12, v6, v13, v12 bitop3:0xca
    v_lshl_add_u32 v11, v11, 17, s40
    v_lshlrev_b16 v14, 8, v14
    v_lshrrev_b32 v13, 2, v96
    v_add_u32 v64, v12, v11
    v_bitop3_b32 v96, v5, v13, v14 bitop3:0xea
    ds_add_u32 v96, v2
    v_mul_hi_u32_u24 v14, 429497, v65
    v_lshrrev_b32 v12, 3, v97
    v_cos_f32 v8, v8
    v_lshlrev_b16 v13, 3, v97
    v_mad_i32_i24 v11, v14, s55, v65
    v_bitop3_b32 v12, v6, v13, v12 bitop3:0xca
    v_lshl_add_u32 v11, v11, 17, s40
    v_lshlrev_b16 v14, 8, v14
    v_lshrrev_b32 v13, 2, v97
    v_add_u32 v65, v12, v11
    v_bitop3_b32 v97, v5, v13, v14 bitop3:0xea
    ds_add_u32 v97, v2
    v_cvt_pk_bf16_f32 v104, v7, v8
    v_perm_b32 v12, v104, v104, s41
    v_bitop3_b32 v64, v4, v12, v64 bitop3:0xca
    v_perm_b32 v13, v104, v104, s42
    v_bitop3_b32 v65, v4, v13, v65 bitop3:0xca
    v_mul_hi_u32_u24 v14, 429497, v66
    v_lshrrev_b32 v12, 3, v98
    v_cos_f32 v9, v9
    v_lshlrev_b16 v13, 3, v98
    v_mad_i32_i24 v11, v14, s55, v66
    v_bitop3_b32 v12, v6, v13, v12 bitop3:0xca
    v_lshl_add_u32 v11, v11, 17, s40
    v_lshlrev_b16 v14, 8, v14
    v_lshrrev_b32 v13, 2, v98
    v_add_u32 v66, v12, v11
    v_bitop3_b32 v98, v5, v13, v14 bitop3:0xea
    ds_add_u32 v98, v2
    v_mul_hi_u32_u24 v14, 429497, v67
    v_lshrrev_b32 v12, 3, v99
    v_cos_f32 v10, v10
    v_lshlrev_b16 v13, 3, v99
    v_mad_i32_i24 v11, v14, s55, v67
    v_bitop3_b32 v12, v6, v13, v12 bitop3:0xca
    v_lshl_add_u32 v11, v11, 17, s40
    v_lshlrev_b16 v14, 8, v14
    v_lshrrev_b32 v13, 2, v99
    v_add_u32 v67, v12, v11
    v_bitop3_b32 v99, v5, v13, v14 bitop3:0xea
    ds_add_u32 v99, v2
    v_cvt_pk_bf16_f32 v105, v9, v10
    v_perm_b32 v12, v105, v105, s41
    v_bitop3_b32 v66, v4, v12, v66 bitop3:0xca
    v_perm_b32 v13, v105, v105, s42
    v_bitop3_b32 v67, v4, v13, v67 bitop3:0xca
    s_mov_b32 s68, s66
    s_mov_b32 s69, s67
    s_mov_b32 s70, 0x100
    s_mov_b32 s71, 0x20000
    v_mov_b32 v3, 1
    s_cmp_lg_u32 s32, 15
    s_cbranch_scc1 L1_tk
    s_mov_b64 exec, 1
    s_and_b32 s3, s2, 1
    s_lshl_b32 s3, s3, 7
    buffer_atomic_add v3, off, s[68:71], s3 sc0
    s_mov_b64 exec, -1
L1_tk:
    s_waitcnt vmcnt(10)
    v_lshlrev_b32 v7, 16, v106
    v_and_b32 v8, 0xffff0000, v106
    v_lshlrev_b32 v9, 16, v107
    v_and_b32 v10, 0xffff0000, v107
    v_mul_f32 v7, 0.15915494, v7
    v_mul_f32 v8, 0.15915494, v8
    v_mul_f32 v9, 0.15915494, v9
    v_mul_f32 v10, 0.15915494, v10
    v_mul_hi_u32_u24 v14, 429497, v60
    v_lshrrev_b32 v12, 3, v100
    v_cos_f32 v7, v7
    v_lshlrev_b16 v13, 3, v100
    v_mad_i32_i24 v11, v14, s55, v60
    v_bitop3_b32 v12, v6, v13, v12 bitop3:0xca
    v_lshl_add_u32 v11, v11, 17, s40
    v_lshlrev_b16 v14, 8, v14
    v_lshrrev_b32 v13, 2, v100
    v_add_u32 v60, v12, v11
    v_bitop3_b32 v100, v5, v13, v14 bitop3:0xea
    ds_add_u32 v100, v2
    v_mul_hi_u32_u24 v14, 429497, v61
    v_lshrrev_b32 v12, 3, v101
    v_cos_f32 v8, v8
    v_lshlrev_b16 v13, 3, v101
    v_mad_i32_i24 v11, v14, s55, v61
    v_bitop3_b32 v12, v6, v13, v12 bitop3:0xca
    v_lshl_add_u32 v11, v11, 17, s40
    v_lshlrev_b16 v14, 8, v14
    v_lshrrev_b32 v13, 2, v101
    v_add_u32 v61, v12, v11
    v_bitop3_b32 v101, v5, v13, v14 bitop3:0xea
    ds_add_u32 v101, v2
    v_cvt_pk_bf16_f32 v106, v7, v8
    v_perm_b32 v12, v106, v106, s41
    v_bitop3_b32 v60, v4, v12, v60 bitop3:0xca
    v_perm_b32 v13, v106, v106, s42
    v_bitop3_b32 v61, v4, v13, v61 bitop3:0xca
    v_mul_hi_u32_u24 v14, 429497, v62
    v_lshrrev_b32 v12, 3, v102
    v_cos_f32 v9, v9
    v_lshlrev_b16 v13, 3, v102
    v_mad_i32_i24 v11, v14, s55, v62
    v_bitop3_b32 v12, v6, v13, v12 bitop3:0xca
    v_lshl_add_u32 v11, v11, 17, s40
    v_lshlrev_b16 v14, 8, v14
    v_lshrrev_b32 v13, 2, v102
    v_add_u32 v62, v12, v11
    v_bitop3_b32 v102, v5, v13, v14 bitop3:0xea
    ds_add_u32 v102, v2
    v_mul_hi_u32_u24 v14, 429497, v63
    v_lshrrev_b32 v12, 3, v103
    v_cos_f32 v10, v10
    v_lshlrev_b16 v13, 3, v103
    v_mad_i32_i24 v11, v14, s55, v63
    v_bitop3_b32 v12, v6, v13, v12 bitop3:0xca
    v_lshl_add_u32 v11, v11, 17, s40
    v_lshlrev_b16 v14, 8, v14
    v_lshrrev_b32 v13, 2, v103
    v_add_u32 v63, v12, v11
    v_bitop3_b32 v103, v5, v13, v14 bitop3:0xea
    ds_add_u32 v103, v2
    v_cvt_pk_bf16_f32 v107, v9, v10
    v_perm_b32 v12, v107, v107, s41
    v_bitop3_b32 v62, v4, v12, v62 bitop3:0xca
    v_perm_b32 v13, v107, v107, s42
    v_bitop3_b32 v63, v4, v13, v63 bitop3:0xca
    s_setprio 0
    s_add_u32 s47, s35, 0x5484000
    s_add_u32 s47, s47, s91
    buffer_store_dwordx4 v[120:123], v0, s[20:23], s47 offen sc1
    s_add_u32 s44, s96, 0x8000000
    s_nop 0
    v_lshlrev_b32 v120, 1, v1
    buffer_load_dwordx4 v[120:123], v120, s[12:15], s44 offen nt
    s_waitcnt vmcnt(8)
    v_lshlrev_b32 v7, 16, v108
    v_and_b32 v8, 0xffff0000, v108
    v_lshlrev_b32 v9, 16, v109
    v_and_b32 v10, 0xffff0000, v109
    v_mul_f32 v7, 0.15915494, v7
    v_mul_f32 v8, 0.15915494, v8
    v_mul_f32 v9, 0.15915494, v9
    v_mul_f32 v10, 0.15915494, v10
    v_mul_hi_u32_u24 v14, 429497, v112
    v_lshrrev_b32 v12, 3, v88
    v_cos_f32 v7, v7
    v_lshlrev_b16 v13, 3, v88
    v_mad_i32_i24 v11, v14, s55, v112
    v_bitop3_b32 v12, v6, v13, v12 bitop3:0xca
    v_lshl_add_u32 v11, v11, 17, s40
    v_lshlrev_b16 v14, 8, v14
    v_lshrrev_b32 v13, 2, v88
    v_add_u32 v112, v12, v11
    v_bitop3_b32 v88, v5, v13, v14 bitop3:0xea
    ds_add_u32 v88, v2
    v_mul_hi_u32_u24 v14, 429497, v113
    v_lshrrev_b32 v12, 3, v89
    v_cos_f32 v8, v8
    v_lshlrev_b16 v13, 3, v89
    v_mad_i32_i24 v11, v14, s55, v113
    v_bitop3_b32 v12, v6, v13, v12 bitop3:0xca
    v_lshl_add_u32 v11, v11, 17, s40
    v_lshlrev_b16 v14, 8, v14
    v_lshrrev_b32 v13, 2, v89
    v_add_u32 v113, v12, v11
    v_bitop3_b32 v89, v5, v13, v14 bitop3:0xea
    ds_add_u32 v89, v2
    v_cvt_pk_bf16_f32 v108, v7, v8
    v_perm_b32 v12, v108, v108, s41
    v_bitop3_b32 v112, v4, v12, v112 bitop3:0xca
    v_perm_b32 v13, v108, v108, s42
    v_bitop3_b32 v113, v4, v13, v113 bitop3:0xca
    v_mul_hi_u32_u24 v14, 429497, v114
    v_lshrrev_b32 v12, 3, v90
    v_cos_f32 v9, v9
    v_lshlrev_b16 v13, 3, v90
    v_mad_i32_i24 v11, v14, s55, v114
    v_bitop3_b32 v12, v6, v13, v12 bitop3:0xca
    v_lshl_add_u32 v11, v11, 17, s40
    v_lshlrev_b16 v14, 8, v14
    v_lshrrev_b32 v13, 2, v90
    v_add_u32 v114, v12, v11
    v_bitop3_b32 v90, v5, v13, v14 bitop3:0xea
    ds_add_u32 v90, v2
    v_mul_hi_u32_u24 v14, 429497, v115
    v_lshrrev_b32 v12, 3, v91
    v_cos_f32 v10, v10
    v_lshlrev_b16 v13, 3, v91
    v_mad_i32_i24 v11, v14, s55, v115
    v_bitop3_b32 v12, v6, v13, v12 bitop3:0xca
    v_lshl_add_u32 v11, v11, 17, s40
    v_lshlrev_b16 v14, 8, v14
    v_lshrrev_b32 v13, 2, v91
    v_add_u32 v115, v12, v11
    v_bitop3_b32 v91, v5, v13, v14 bitop3:0xea
    ds_add_u32 v91, v2
    v_cvt_pk_bf16_f32 v109, v9, v10
    v_perm_b32 v12, v109, v109, s41
    v_bitop3_b32 v114, v4, v12, v114 bitop3:0xca
    v_perm_b32 v13, v109, v109, s42
    v_bitop3_b32 v115, v4, v13, v115 bitop3:0xca
    s_waitcnt vmcnt(4)
    v_lshlrev_b32 v7, 16, v110
    v_and_b32 v8, 0xffff0000, v110
    v_lshlrev_b32 v9, 16, v111
    v_and_b32 v10, 0xffff0000, v111
    v_mul_f32 v7, 0.15915494, v7
    v_mul_f32 v8, 0.15915494, v8
    v_mul_f32 v9, 0.15915494, v9
    v_mul_f32 v10, 0.15915494, v10
    v_mul_hi_u32_u24 v14, 429497, v116
    v_lshrrev_b32 v12, 3, v92
    v_cos_f32 v7, v7
    v_lshlrev_b16 v13, 3, v92
    v_mad_i32_i24 v11, v14, s55, v116
    v_bitop3_b32 v12, v6, v13, v12 bitop3:0xca
    v_lshl_add_u32 v11, v11, 17, s40
    v_lshlrev_b16 v14, 8, v14
    v_lshrrev_b32 v13, 2, v92
    v_add_u32 v116, v12, v11
    v_bitop3_b32 v92, v5, v13, v14 bitop3:0xea
    ds_add_u32 v92, v2
    v_mul_hi_u32_u24 v14, 429497, v117
    v_lshrrev_b32 v12, 3, v93
    v_cos_f32 v8, v8
    v_lshlrev_b16 v13, 3, v93
    v_mad_i32_i24 v11, v14, s55, v117
    v_bitop3_b32 v12, v6, v13, v12 bitop3:0xca
    v_lshl_add_u32 v11, v11, 17, s40
    v_lshlrev_b16 v14, 8, v14
    v_lshrrev_b32 v13, 2, v93
    v_add_u32 v117, v12, v11
    v_bitop3_b32 v93, v5, v13, v14 bitop3:0xea
    ds_add_u32 v93, v2
    v_cvt_pk_bf16_f32 v110, v7, v8
    v_perm_b32 v12, v110, v110, s41
    v_bitop3_b32 v116, v4, v12, v116 bitop3:0xca
    v_perm_b32 v13, v110, v110, s42
    v_bitop3_b32 v117, v4, v13, v117 bitop3:0xca
    v_mul_hi_u32_u24 v14, 429497, v118
    v_lshrrev_b32 v12, 3, v94
    v_cos_f32 v9, v9
    v_lshlrev_b16 v13, 3, v94
    v_mad_i32_i24 v11, v14, s55, v118
    v_bitop3_b32 v12, v6, v13, v12 bitop3:0xca
    v_lshl_add_u32 v11, v11, 17, s40
    v_lshlrev_b16 v14, 8, v14
    v_lshrrev_b32 v13, 2, v94
    v_add_u32 v118, v12, v11
    v_bitop3_b32 v94, v5, v13, v14 bitop3:0xea
    ds_add_u32 v94, v2
    v_mul_hi_u32_u24 v14, 429497, v119
    v_lshrrev_b32 v12, 3, v95
    v_cos_f32 v10, v10
    v_lshlrev_b16 v13, 3, v95
    v_mad_i32_i24 v11, v14, s55, v119
    v_bitop3_b32 v12, v6, v13, v12 bitop3:0xca
    v_lshl_add_u32 v11, v11, 17, s40
    v_lshlrev_b16 v14, 8, v14
    v_lshrrev_b32 v13, 2, v95
    v_add_u32 v119, v12, v11
    v_bitop3_b32 v95, v5, v13, v14 bitop3:0xea
    ds_add_u32 v95, v2
    v_cvt_pk_bf16_f32 v111, v9, v10
    v_perm_b32 v12, v111, v111, s41
    v_bitop3_b32 v118, v4, v12, v118 bitop3:0xca
    v_perm_b32 v13, v111, v111, s42
    v_bitop3_b32 v119, v4, v13, v119 bitop3:0xca
    v_lshrrev_b32 v8, 2, v0
    v_and_b32 v7, 0x3c00, v0
    v_bitop3_b32 v7, v5, v8, v7 bitop3:0xea
    s_waitcnt lgkmcnt(0)
    s_barrier
    ds_read2st64_b32 v[8:9], v7 offset0:0 offset1:1
    ds_read2st64_b32 v[10:11], v7 offset0:2 offset1:3
    s_add_u32 s45, s35, 0x5484000
    s_add_u32 s45, s45, s93
    buffer_store_dwordx4 v[44:47], v0, s[20:23], s45 offen sc1
    s_add_u32 s46, s96, 0x8000000
    s_lshr_b32 s46, s46, 1
    buffer_load_dwordx2 v[44:45], v1, s[16:19], s46 offen nt
    s_add_u32 s47, s97, 0x8400000
    s_lshr_b32 s47, s47, 1
    buffer_load_dwordx2 v[46:47], v1, s[16:19], s47 offen nt
    s_waitcnt lgkmcnt(0)
    v_lshl_or_b32 v12, v9, 16, v8
    v_lshl_or_b32 v13, v11, 16, v10
    v_mov_b32 v14, v12
    v_mov_b32 v15, v13
    s_nop 0
    v_add_u32_dpp v14, v14, v14 row_shr:1 row_mask:0xf bank_mask:0xf bound_ctrl:1
    v_add_u32_dpp v15, v15, v15 row_shr:1 row_mask:0xf bank_mask:0xf bound_ctrl:1
    s_nop 0
    v_add_u32_dpp v14, v14, v14 row_shr:2 row_mask:0xf bank_mask:0xf bound_ctrl:1
    v_add_u32_dpp v15, v15, v15 row_shr:2 row_mask:0xf bank_mask:0xf bound_ctrl:1
    s_nop 0
    v_add_u32_dpp v14, v14, v14 row_shr:4 row_mask:0xf bank_mask:0xf bound_ctrl:1
    v_add_u32_dpp v15, v15, v15 row_shr:4 row_mask:0xf bank_mask:0xf bound_ctrl:1
    s_nop 0
    v_add_u32_dpp v14, v14, v14 row_shr:8 row_mask:0xf bank_mask:0xf bound_ctrl:1
    v_add_u32_dpp v15, v15, v15 row_shr:8 row_mask:0xf bank_mask:0xf bound_ctrl:1
    s_nop 0
    v_add_u32_dpp v14, v14, v14 row_bcast:15 row_mask:0xa bank_mask:0xf
    v_add_u32_dpp v15, v15, v15 row_bcast:15 row_mask:0xa bank_mask:0xf
    s_nop 0
    v_add_u32_dpp v14, v14, v14 row_bcast:31 row_mask:0xc bank_mask:0xf
    v_add_u32_dpp v15, v15, v15 row_bcast:31 row_mask:0xc bank_mask:0xf
    v_readlane_b32 s48, v14, 63
    v_readlane_b32 s49, v15, 63
    s_lshl_b32 s54, s32, 2
    v_mov_b32 v8, s54
    s_and_b32 s50, s48, 0xffff
    s_lshr_b32 s51, s48, 16
    s_and_b32 s52, s49, 0xffff
    s_lshr_b32 s53, s49, 16
    s_add_u32 s51, s51, s50
    s_add_u32 s52, s52, s51
    s_add_u32 s53, s53, s52
    v_mov_b32 v9, s53
    s_mov_b64 exec, 1
    ds_write_b32 v8, v9 offset:16384
    s_cmp_lg_u32 s32, 15
    s_cbranch_scc1 L1_tk2
    s_waitcnt vmcnt(3)
L1_tk2:
    ds_write_b32 v8, v3 offset:16448
    s_mov_b64 exec, -1
    v_and_b32 v8, 60, v7
    s_waitcnt lgkmcnt(0)
    s_barrier
    ds_read_b32 v9, v8 offset:16384
    ds_read_b32 v10, v8 offset:16448
    s_waitcnt lgkmcnt(0)
    v_readlane_b32 s84, v10, 15
    s_and_b32 s3, s2, 1
    s_lshl_b32 s3, s3, 7
    s_add_u32 s84, s84, s3
    s_min_u32 s4, s84, 72
    s_min_u32 s5, s84, 216
    s_min_u32 s6, s84, 240
    s_add_u32 s4, s4, s5
    s_add_u32 s4, s4, s6
    s_add_u32 s4, s4, 9467
    s_mov_b32 s4, s84
    s_lshl_b32 s58, s4, 14
    s_lshl_b32 s5, s32, 10
    s_add_u32 s58, s58, s5
    s_lshr_b32 s59, s58, 1
    s_mov_b32 s43, 5
    s_cmp_lt_u32 s84, 72
    s_addc_u32 s43, s43, 0
    s_cmp_lt_u32 s84, 216
    s_addc_u32 s43, s43, 0
    s_cmp_lt_u32 s84, 240
    s_addc_u32 s43, s43, 0
    v_add_u32_dpp v9, v9, v9 row_shr:1 row_mask:0xf bank_mask:0xf bound_ctrl:1
    s_nop 1
    v_add_u32_dpp v9, v9, v9 row_shr:2 row_mask:0xf bank_mask:0xf bound_ctrl:1
    s_nop 1
    v_add_u32_dpp v9, v9, v9 row_shr:4 row_mask:0xf bank_mask:0xf bound_ctrl:1
    s_nop 1
    v_add_u32_dpp v9, v9, v9 row_shr:8 row_mask:0xf bank_mask:0xf bound_ctrl:1
    s_nop 0
    v_readlane_b32 s54, v9, s32
    s_sub_u32 s54, s54, s53
    s_add_u32 s50, s50, s54
    s_add_u32 s51, s51, s54
    s_add_u32 s52, s52, s54
    s_pack_ll_b32_b16 s48, s54, s50
    s_pack_ll_b32_b16 s49, s51, s52
    v_add_u32 v14, s48, v14
    v_add_u32 v15, s49, v15
    v_sub_u32 v12, v14, v12
    v_sub_u32 v13, v15, v13
    v_and_b32 v8, 0xffff, v12
    v_lshrrev_b32 v9, 16, v12
    v_and_b32 v10, 0xffff, v13
    v_lshrrev_b32 v11, 16, v13
    ds_write2st64_b32 v7, v8, v9 offset0:0 offset1:1
    ds_write2st64_b32 v7, v10, v11 offset0:2 offset1:3
    v_and_b32 v8, 0x3f0, v0
    v_lshl_add_u32 v8, v8, 1, s36
    ds_write_b64 v8, v[12:13] offset:20480
    s_bitset0_b64 exec, 63
    s_not_b64 exec, exec
    ds_write_b64 v8, v[14:15] offset:20512
    s_mov_b64 exec, -1
    s_waitcnt lgkmcnt(0)
    s_barrier
    s_setprio 3
    ds_add_rtn_u32 v24, v24, v2
    ds_add_rtn_u32 v25, v25, v2
    ds_add_rtn_u32 v26, v26, v2
    ds_add_rtn_u32 v27, v27, v2
    ds_read_b128 v[12:15], v0 offset:20480
    v_cmp_gt_u32 vcc, 8448, v0
    ds_add_rtn_u32 v52, v52, v2
    ds_add_rtn_u32 v53, v53, v2
    ds_add_rtn_u32 v54, v54, v2
    ds_add_rtn_u32 v55, v55, v2
    s_setprio 2
    ds_add_rtn_u32 v72, v72, v2
    ds_add_rtn_u32 v73, v73, v2
    ds_add_rtn_u32 v74, v74, v2
    ds_add_rtn_u32 v75, v75, v2
    s_waitcnt lgkmcnt(8)
    s_cbranch_vccz L1_p4
    s_add_u32 s44, s35, 0x7ec0000
    s_mov_b64 exec, vcc
    buffer_store_dwordx4 v[12:15], v0, s[24:27], s44 offen sc1
    s_mov_b64 exec, -1
L1_p4:
    s_add_u32 s45, s35, 0x5488000
    s_add_u32 s45, s45, s72
    buffer_store_dwordx4 v[20:23], v0, s[20:23], s45 offen sc1
    s_add_u32 s46, s97, 0x8400000
    s_nop 0
    v_lshlrev_b32 v20, 1, v1
    buffer_load_dwordx4 v[20:23], v20, s[8:11], s46 offen nt
    ds_add_rtn_u32 v80, v80, v2
    ds_add_rtn_u32 v81, v81, v2
    ds_add_rtn_u32 v82, v82, v2
    ds_add_rtn_u32 v83, v83, v2
    s_setprio 1
    ds_add_rtn_u32 v96, v96, v2
    ds_add_rtn_u32 v97, v97, v2
    ds_add_rtn_u32 v98, v98, v2
    ds_add_rtn_u32 v99, v99, v2
    ds_add_rtn_u32 v100, v100, v2
    ds_add_rtn_u32 v101, v101, v2
    ds_add_rtn_u32 v102, v102, v2
    ds_add_rtn_u32 v103, v103, v2
    s_add_u32 s47, s35, 0x5488000
    s_add_u32 s47, s47, s73
    buffer_store_dwordx4 v[124:127], v0, s[20:23], s47 offen sc1
    s_add_u32 s44, s97, 0x8400000
    s_nop 0
    v_lshlrev_b32 v124, 1, v1
    buffer_load_dwordx4 v[124:127], v124, s[12:15], s44 offen nt
    s_setprio 0
    ds_add_rtn_u32 v88, v88, v2
    ds_add_rtn_u32 v89, v89, v2
    ds_add_rtn_u32 v90, v90, v2
    ds_add_rtn_u32 v91, v91, v2
    ds_add_rtn_u32 v92, v92, v2
    ds_add_rtn_u32 v93, v93, v2
    ds_add_rtn_u32 v94, v94, v2
    ds_add_rtn_u32 v95, v95, v2
    s_waitcnt lgkmcnt(0)
    s_barrier
    s_setprio 3
    v_and_b32 v7, -4, v24
    v_lshl_add_u32 v8, v24, 2, v7
    ds_write_b32 v8, v40
    v_lshl_add_u32 v7, v7, 2, v24
    ds_write_b8 v7, v84 offset:16
    v_and_b32 v9, -4, v25
    v_lshl_add_u32 v10, v25, 2, v9
    ds_write_b32 v10, v41
    v_lshl_add_u32 v9, v9, 2, v25
    ds_write_b8_d16_hi v9, v84 offset:16
    v_and_b32 v7, -4, v26
    v_lshl_add_u32 v8, v26, 2, v7
    ds_write_b32 v8, v42
    v_lshl_add_u32 v7, v7, 2, v26
    ds_write_b8 v7, v85 offset:16
    v_and_b32 v9, -4, v27
    v_lshl_add_u32 v10, v27, 2, v9
    ds_write_b32 v10, v43
    v_lshl_add_u32 v9, v9, 2, v27
    ds_write_b8_d16_hi v9, v85 offset:16
    s_add_u32 s45, s35, 0x5488000
    s_add_u32 s45, s45, s85
    buffer_store_dwordx4 v[32:35], v0, s[20:23], s45 offen sc1
    s_add_u32 s46, s98, 0x8800000
    v_lshlrev_b32 v40, 1, v1
    buffer_load_dwordx4 v[40:43], v40, s[8:11], s46 offen nt
    s_add_u32 s47, s98, 0x8800000
    v_lshlrev_b32 v24, 1, v1
    buffer_load_dwordx4 v[24:27], v24, s[12:15], s47 offen nt
    v_and_b32 v7, -4, v52
    v_lshl_add_u32 v8, v52, 2, v7
    ds_write_b32 v8, v48
    v_lshl_add_u32 v7, v7, 2, v52
    ds_write_b8 v7, v86 offset:16
    v_and_b32 v9, -4, v53
    v_lshl_add_u32 v10, v53, 2, v9
    ds_write_b32 v10, v49
    v_lshl_add_u32 v9, v9, 2, v53
    ds_write_b8_d16_hi v9, v86 offset:16
    v_and_b32 v7, -4, v54
    v_lshl_add_u32 v8, v54, 2, v7
    ds_write_b32 v8, v50
    v_lshl_add_u32 v7, v7, 2, v54
    ds_write_b8 v7, v87 offset:16
    v_and_b32 v9, -4, v55
    v_lshl_add_u32 v10, v55, 2, v9
    ds_write_b32 v10, v51
    v_lshl_add_u32 v9, v9, 2, v55
    ds_write_b8_d16_hi v9, v87 offset:16
    s_add_u32 s44, s98, 0x8800000
    s_lshr_b32 s44, s44, 1
    buffer_load_dwordx2 v[32:33], v1, s[16:19], s44 offen nt
    s_add_u32 s45, s99, 0x8c00000
    s_lshr_b32 s45, s45, 1
    buffer_load_dwordx2 v[34:35], v1, s[16:19], s45 offen nt
    s_add_u32 s46, s99, 0x8c00000
    v_lshlrev_b32 v48, 1, v1
    buffer_load_dwordx4 v[48:51], v48, s[8:11], s46 offen nt
    s_setprio 2
    v_and_b32 v7, -4, v72
    v_lshl_add_u32 v8, v72, 2, v7
    ds_write_b32 v8, v68
    v_lshl_add_u32 v7, v7, 2, v72
    ds_write_b8 v7, v56 offset:16
    v_and_b32 v9, -4, v73
    v_lshl_add_u32 v10, v73, 2, v9
    ds_write_b32 v10, v69
    v_lshl_add_u32 v9, v9, 2, v73
    ds_write_b8_d16_hi v9, v56 offset:16
    v_and_b32 v7, -4, v74
    v_lshl_add_u32 v8, v74, 2, v7
    ds_write_b32 v8, v70
    v_lshl_add_u32 v7, v7, 2, v74
    ds_write_b8 v7, v57 offset:16
    v_and_b32 v9, -4, v75
    v_lshl_add_u32 v10, v75, 2, v9
    ds_write_b32 v10, v71
    v_lshl_add_u32 v9, v9, 2, v75
    ds_write_b8_d16_hi v9, v57 offset:16
    s_add_u32 s47, s35, 0x5488000
    s_add_u32 s47, s47, s91
    buffer_store_dwordx4 v[36:39], v0, s[20:23], s47 offen sc1
    s_add_u32 s44, s99, 0x8c00000
    v_lshlrev_b32 v52, 1, v1
    buffer_load_dwordx4 v[52:55], v52, s[12:15], s44 offen nt
    v_and_b32 v7, -4, v80
    v_lshl_add_u32 v8, v80, 2, v7
    ds_write_b32 v8, v76
    v_lshl_add_u32 v7, v7, 2, v80
    ds_write_b8 v7, v58 offset:16
    v_and_b32 v9, -4, v81
    v_lshl_add_u32 v10, v81, 2, v9
    ds_write_b32 v10, v77
    v_lshl_add_u32 v9, v9, 2, v81
    ds_write_b8_d16_hi v9, v58 offset:16
    v_and_b32 v7, -4, v82
    v_lshl_add_u32 v8, v82, 2, v7
    ds_write_b32 v8, v78
    v_lshl_add_u32 v7, v7, 2, v82
    ds_write_b8 v7, v59 offset:16
    v_and_b32 v9, -4, v83
    v_lshl_add_u32 v10, v83, 2, v9
    ds_write_b32 v10, v79
    v_lshl_add_u32 v9, v9, 2, v83
    ds_write_b8_d16_hi v9, v59 offset:16
    s_add_u32 s45, s96, 0x9000000
    v_lshlrev_b32 v84, 1, v1
    buffer_load_dwordx4 v[84:87], v84, s[8:11], s45 offen nt
    s_add_u32 s46, s96, 0x9000000
    v_lshlrev_b32 v68, 1, v1
    buffer_load_dwordx4 v[68:71], v68, s[12:15], s46 offen nt
    s_setprio 1
    v_and_b32 v7, -4, v96
    v_lshl_add_u32 v8, v96, 2, v7
    ds_write_b32 v8, v64
    v_lshl_add_u32 v7, v7, 2, v96
    ds_write_b8 v7, v104 offset:16
    v_and_b32 v9, -4, v97
    v_lshl_add_u32 v10, v97, 2, v9
    ds_write_b32 v10, v65
    v_lshl_add_u32 v9, v9, 2, v97
    ds_write_b8_d16_hi v9, v104 offset:16
    v_and_b32 v7, -4, v98
    v_lshl_add_u32 v8, v98, 2, v7
    ds_write_b32 v8, v66
    v_lshl_add_u32 v7, v7, 2, v98
    ds_write_b8 v7, v105 offset:16
    v_and_b32 v9, -4, v99
    v_lshl_add_u32 v10, v99, 2, v9
    ds_write_b32 v10, v67
    v_lshl_add_u32 v9, v9, 2, v99
    ds_write_b8_d16_hi v9, v105 offset:16
    s_add_u32 s47, s96, 0x9000000
    s_lshr_b32 s47, s47, 1
    buffer_load_dwordx2 v[72:73], v1, s[16:19], s47 offen nt
    s_cmp_le_u32 s43, 5
    s_cselect_b32 s18, 0, s18
    s_add_u32 s44, s59, 0x4a00000
    buffer_load_dwordx2 v[74:75], v1, s[16:19], s44 offen nt
    s_cmp_le_u32 s43, 5
    s_cselect_b32 s10, 0, s10
    s_add_u32 s45, s58, 0x9400000
    v_lshlrev_b32 v36, 1, v1
    buffer_load_dwordx4 v[36:39], v36, s[8:11], s45 offen nt
    v_and_b32 v7, -4, v100
    v_lshl_add_u32 v8, v100, 2, v7
    ds_write_b32 v8, v60
    v_lshl_add_u32 v7, v7, 2, v100
    ds_write_b8 v7, v106 offset:16
    v_and_b32 v9, -4, v101
    v_lshl_add_u32 v10, v101, 2, v9
    ds_write_b32 v10, v61
    v_lshl_add_u32 v9, v9, 2, v101
    ds_write_b8_d16_hi v9, v106 offset:16
    v_and_b32 v7, -4, v102
    v_lshl_add_u32 v8, v102, 2, v7
    ds_write_b32 v8, v62
    v_lshl_add_u32 v7, v7, 2, v102
    ds_write_b8 v7, v107 offset:16
    v_and_b32 v9, -4, v103
    v_lshl_add_u32 v10, v103, 2, v9
    ds_write_b32 v10, v63
    v_lshl_add_u32 v9, v9, 2, v103
    ds_write_b8_d16_hi v9, v107 offset:16
    s_add_u32 s46, s35, 0x5488000
    s_add_u32 s46, s46, s93
    buffer_store_dwordx4 v[28:31], v0, s[20:23], s46 offen sc1
    s_cmp_le_u32 s43, 5
    s_cselect_b32 s14, 0, s14
    s_add_u32 s47, s58, 0x9400000
    v_lshlrev_b32 v76, 1, v1
    buffer_load_dwordx4 v[76:79], v76, s[12:15], s47 offen nt
    s_setprio 0
    v_and_b32 v7, -4, v88
    v_lshl_add_u32 v8, v88, 2, v7
    ds_write_b32 v8, v112
    v_lshl_add_u32 v7, v7, 2, v88
    ds_write_b8 v7, v108 offset:16
    v_and_b32 v9, -4, v89
    v_lshl_add_u32 v10, v89, 2, v9
    ds_write_b32 v10, v113
    v_lshl_add_u32 v9, v9, 2, v89
    ds_write_b8_d16_hi v9, v108 offset:16
    v_and_b32 v7, -4, v90
    v_lshl_add_u32 v8, v90, 2, v7
    ds_write_b32 v8, v114
    v_lshl_add_u32 v7, v7, 2, v90
    ds_write_b8 v7, v109 offset:16
    v_and_b32 v9, -4, v91
    v_lshl_add_u32 v10, v91, 2, v9
    ds_write_b32 v10, v115
    v_lshl_add_u32 v9, v9, 2, v91
    ds_write_b8_d16_hi v9, v109 offset:16
    s_cmp_le_u32 s43, 6
    s_cselect_b32 s10, 0, s10
    s_add_u32 s44, s58, 0x97c0000
    v_lshlrev_b32 v80, 1, v1
    buffer_load_dwordx4 v[80:83], v80, s[8:11], s44 offen nt
    s_cmp_le_u32 s43, 6
    s_cselect_b32 s14, 0, s14
    s_add_u32 s45, s58, 0x97c0000
    v_lshlrev_b32 v56, 1, v1
    buffer_load_dwordx4 v[56:59], v56, s[12:15], s45 offen nt
    v_and_b32 v7, -4, v92
    v_lshl_add_u32 v8, v92, 2, v7
    ds_write_b32 v8, v116
    v_lshl_add_u32 v7, v7, 2, v92
    ds_write_b8 v7, v110 offset:16
    v_and_b32 v9, -4, v93
    v_lshl_add_u32 v10, v93, 2, v9
    ds_write_b32 v10, v117
    v_lshl_add_u32 v9, v9, 2, v93
    ds_write_b8_d16_hi v9, v110 offset:16
    v_and_b32 v7, -4, v94
    v_lshl_add_u32 v8, v94, 2, v7
    ds_write_b32 v8, v118
    v_lshl_add_u32 v7, v7, 2, v94
    ds_write_b8 v7, v111 offset:16
    v_and_b32 v9, -4, v95
    v_lshl_add_u32 v10, v95, 2, v9
    ds_write_b32 v10, v119
    v_lshl_add_u32 v9, v9, 2, v95
    ds_write_b8_d16_hi v9, v111 offset:16
    s_cmp_le_u32 s43, 6
    s_cselect_b32 s18, 0, s18
    s_add_u32 s46, s59, 0x4be0000
    buffer_load_dwordx2 v[64:65], v1, s[16:19], s46 offen nt
    s_cmp_le_u32 s43, 7
    s_cselect_b32 s18, 0, s18
    s_add_u32 s47, s59, 0x4d90000
    buffer_load_dwordx2 v[66:67], v1, s[16:19], s47 offen nt
    v_add_u32 v7, s72, v0
    v_add_u32 v12, s73, v0
    v_add_u32 v13, s85, v0
    v_add_u32 v14, s91, v0
    v_add_u32 v15, s93, v0
    s_min_i32 s3, s72, s73
    s_min_i32 s3, s3, s85
    s_min_i32 s3, s3, s91
    s_min_i32 s3, s3, s93
    v_add_u32 v3, s3, v0
    v_mov_b32 v8, 0
    v_mov_b32 v9, 0
    v_mov_b32 v10, 0
    v_mov_b32 v11, 0
    s_waitcnt lgkmcnt(0)
    s_barrier
    ds_read_b128 v[96:99], v7 offset:0
    ds_read_b128 v[60:63], v12 offset:0
    ds_read_b128 v[100:103], v13 offset:0
    ds_read_b128 v[104:107], v14 offset:0
    ds_read_b128 v[28:31], v15 offset:0
    ds_write_b128 v3, v[8:11]
    ds_read_b128 v[112:115], v7 offset:16384
    ds_read_b128 v[88:91], v12 offset:16384
    ds_read_b128 v[116:119], v13 offset:16384
    ds_read_b128 v[92:95], v14 offset:16384
    ds_read_b128 v[108:111], v15 offset:16384
    s_waitcnt lgkmcnt(0)
    s_barrier
    v_lshlrev_b32 v3, 3, v0
    v_and_b32 v3, 0x80, v3
    s_cmp_lg_u32 s32, 15
    s_cbranch_scc1 L2_k0
    s_mov_b64 exec, 3
    buffer_load_dword v3, v3, s[68:71], 0 offen sc1
    s_mov_b64 exec, -1
L2_k0:
    s_add_u32 s44, s35, 0x7ec4000
    s_add_u32 s44, s44, s72
    buffer_store_dwordx4 v[96:99], v0, s[20:23], s44 offen sc1
    s_cmp_le_u32 s43, 7
    s_cselect_b32 s10, 0, s10
    s_add_u32 s45, s58, 0x9b20000
    v_lshlrev_b32 v96, 1, v1
    buffer_load_dwordx4 v[96:99], v96, s[8:11], s45 offen nt
    s_add_u32 s46, s35, 0x7ec4000
    s_add_u32 s46, s46, s73
    buffer_store_dwordx4 v[60:63], v0, s[20:23], s46 offen sc1
    s_cmp_le_u32 s43, 7
    s_cselect_b32 s14, 0, s14
    s_add_u32 s47, s58, 0x9b20000
    v_lshlrev_b32 v60, 1, v1
    buffer_load_dwordx4 v[60:63], v60, s[12:15], s47 offen nt
    s_setprio 3
    s_waitcnt vmcnt(27)
    v_lshlrev_b32 v7, 16, v44
    v_and_b32 v8, 0xffff0000, v44
    v_lshlrev_b32 v9, 16, v45
    v_and_b32 v10, 0xffff0000, v45
    v_mul_f32 v7, 0.15915494, v7
    v_mul_f32 v8, 0.15915494, v8
    v_mul_f32 v9, 0.15915494, v9
    v_mul_f32 v10, 0.15915494, v10
    v_mul_hi_u32_u24 v14, 429497, v16
    v_lshrrev_b32 v12, 3, v120
    v_cos_f32 v7, v7
    v_lshlrev_b16 v13, 3, v120
    v_mad_i32_i24 v11, v14, s55, v16
    v_bitop3_b32 v12, v6, v13, v12 bitop3:0xca
    v_lshl_add_u32 v11, v11, 17, s40
    v_lshlrev_b16 v14, 8, v14
    v_lshrrev_b32 v13, 2, v120
    v_add_u32 v16, v12, v11
    v_bitop3_b32 v120, v5, v13, v14 bitop3:0xea
    ds_add_u32 v120, v2
    v_mul_hi_u32_u24 v14, 429497, v17
    v_lshrrev_b32 v12, 3, v121
    v_cos_f32 v8, v8
    v_lshlrev_b16 v13, 3, v121
    v_mad_i32_i24 v11, v14, s55, v17
    v_bitop3_b32 v12, v6, v13, v12 bitop3:0xca
    v_lshl_add_u32 v11, v11, 17, s40
    v_lshlrev_b16 v14, 8, v14
    v_lshrrev_b32 v13, 2, v121
    v_add_u32 v17, v12, v11
    v_bitop3_b32 v121, v5, v13, v14 bitop3:0xea
    ds_add_u32 v121, v2
    v_cvt_pk_bf16_f32 v44, v7, v8
    v_perm_b32 v12, v44, v44, s41
    v_bitop3_b32 v16, v4, v12, v16 bitop3:0xca
    v_perm_b32 v13, v44, v44, s42
    v_bitop3_b32 v17, v4, v13, v17 bitop3:0xca
    v_mul_hi_u32_u24 v14, 429497, v18
    v_lshrrev_b32 v12, 3, v122
    v_cos_f32 v9, v9
    v_lshlrev_b16 v13, 3, v122
    v_mad_i32_i24 v11, v14, s55, v18
    v_bitop3_b32 v12, v6, v13, v12 bitop3:0xca
    v_lshl_add_u32 v11, v11, 17, s40
    v_lshlrev_b16 v14, 8, v14
    v_lshrrev_b32 v13, 2, v122
    v_add_u32 v18, v12, v11
    v_bitop3_b32 v122, v5, v13, v14 bitop3:0xea
    ds_add_u32 v122, v2
    v_mul_hi_u32_u24 v14, 429497, v19
    v_lshrrev_b32 v12, 3, v123
    v_cos_f32 v10, v10
    v_lshlrev_b16 v13, 3, v123
    v_mad_i32_i24 v11, v14, s55, v19
    v_bitop3_b32 v12, v6, v13, v12 bitop3:0xca
    v_lshl_add_u32 v11, v11, 17, s40
    v_lshlrev_b16 v14, 8, v14
    v_lshrrev_b32 v13, 2, v123
    v_add_u32 v19, v12, v11
    v_bitop3_b32 v123, v5, v13, v14 bitop3:0xea
    ds_add_u32 v123, v2
    v_cvt_pk_bf16_f32 v45, v9, v10
    v_perm_b32 v12, v45, v45, s41
    v_bitop3_b32 v18, v4, v12, v18 bitop3:0xca
    v_perm_b32 v13, v45, v45, s42
    v_bitop3_b32 v19, v4, v13, v19 bitop3:0xca
    s_waitcnt vmcnt(23)
    v_lshlrev_b32 v7, 16, v46
    v_and_b32 v8, 0xffff0000, v46
    v_lshlrev_b32 v9, 16, v47
    v_and_b32 v10, 0xffff0000, v47
    v_mul_f32 v7, 0.15915494, v7
    v_mul_f32 v8, 0.15915494, v8
    v_mul_f32 v9, 0.15915494, v9
    v_mul_f32 v10, 0.15915494, v10
    v_mul_hi_u32_u24 v14, 429497, v20
    v_lshrrev_b32 v12, 3, v124
    v_cos_f32 v7, v7
    v_lshlrev_b16 v13, 3, v124
    v_mad_i32_i24 v11, v14, s55, v20
    v_bitop3_b32 v12, v6, v13, v12 bitop3:0xca
    v_lshl_add_u32 v11, v11, 17, s40
    v_lshlrev_b16 v14, 8, v14
    v_lshrrev_b32 v13, 2, v124
    v_add_u32 v20, v12, v11
    v_bitop3_b32 v124, v5, v13, v14 bitop3:0xea
    ds_add_u32 v124, v2
    v_mul_hi_u32_u24 v14, 429497, v21
    v_lshrrev_b32 v12, 3, v125
    v_cos_f32 v8, v8
    v_lshlrev_b16 v13, 3, v125
    v_mad_i32_i24 v11, v14, s55, v21
    v_bitop3_b32 v12, v6, v13, v12 bitop3:0xca
    v_lshl_add_u32 v11, v11, 17, s40
    v_lshlrev_b16 v14, 8, v14
    v_lshrrev_b32 v13, 2, v125
    v_add_u32 v21, v12, v11
    v_bitop3_b32 v125, v5, v13, v14 bitop3:0xea
    ds_add_u32 v125, v2
    v_cvt_pk_bf16_f32 v46, v7, v8
    v_perm_b32 v12, v46, v46, s41
    v_bitop3_b32 v20, v4, v12, v20 bitop3:0xca
    v_perm_b32 v13, v46, v46, s42
    v_bitop3_b32 v21, v4, v13, v21 bitop3:0xca
    v_mul_hi_u32_u24 v14, 429497, v22
    v_lshrrev_b32 v12, 3, v126
    v_cos_f32 v9, v9
    v_lshlrev_b16 v13, 3, v126
    v_mad_i32_i24 v11, v14, s55, v22
    v_bitop3_b32 v12, v6, v13, v12 bitop3:0xca
    v_lshl_add_u32 v11, v11, 17, s40
    v_lshlrev_b16 v14, 8, v14
    v_lshrrev_b32 v13, 2, v126
    v_add_u32 v22, v12, v11
    v_bitop3_b32 v126, v5, v13, v14 bitop3:0xea
    ds_add_u32 v126, v2
    v_mul_hi_u32_u24 v14, 429497, v23
    v_lshrrev_b32 v12, 3, v127
    v_cos_f32 v10, v10
    v_lshlrev_b16 v13, 3, v127
    v_mad_i32_i24 v11, v14, s55, v23
    v_bitop3_b32 v12, v6, v13, v12 bitop3:0xca
    v_lshl_add_u32 v11, v11, 17, s40
    v_lshlrev_b16 v14, 8, v14
    v_lshrrev_b32 v13, 2, v127
    v_add_u32 v23, v12, v11
    v_bitop3_b32 v127, v5, v13, v14 bitop3:0xea
    ds_add_u32 v127, v2
    v_cvt_pk_bf16_f32 v47, v9, v10
    v_perm_b32 v12, v47, v47, s41
    v_bitop3_b32 v22, v4, v12, v22 bitop3:0xca
    v_perm_b32 v13, v47, v47, s42
    v_bitop3_b32 v23, v4, v13, v23 bitop3:0xca
    s_setprio 2
    s_add_u32 s44, s35, 0x7ec4000
    s_add_u32 s44, s44, s85
    buffer_store_dwordx4 v[100:103], v0, s[20:23], s44 offen sc1
    s_waitcnt vmcnt(19)
    v_lshlrev_b32 v7, 16, v32
    v_and_b32 v8, 0xffff0000, v32
    v_lshlrev_b32 v9, 16, v33
    v_and_b32 v10, 0xffff0000, v33
    v_mul_f32 v7, 0.15915494, v7
    v_mul_f32 v8, 0.15915494, v8
    v_mul_f32 v9, 0.15915494, v9
    v_mul_f32 v10, 0.15915494, v10
    v_mul_hi_u32_u24 v14, 429497, v40
    v_lshrrev_b32 v12, 3, v24
    v_cos_f32 v7, v7
    v_lshlrev_b16 v13, 3, v24
    v_mad_i32_i24 v11, v14, s55, v40
    v_bitop3_b32 v12, v6, v13, v12 bitop3:0xca
    v_lshl_add_u32 v11, v11, 17, s40
    v_lshlrev_b16 v14, 8, v14
    v_lshrrev_b32 v13, 2, v24
    v_add_u32 v40, v12, v11
    v_bitop3_b32 v24, v5, v13, v14 bitop3:0xea
    ds_add_u32 v24, v2
    v_mul_hi_u32_u24 v14, 429497, v41
    v_lshrrev_b32 v12, 3, v25
    v_cos_f32 v8, v8
    v_lshlrev_b16 v13, 3, v25
    v_mad_i32_i24 v11, v14, s55, v41
    v_bitop3_b32 v12, v6, v13, v12 bitop3:0xca
    v_lshl_add_u32 v11, v11, 17, s40
    v_lshlrev_b16 v14, 8, v14
    v_lshrrev_b32 v13, 2, v25
    v_add_u32 v41, v12, v11
    v_bitop3_b32 v25, v5, v13, v14 bitop3:0xea
    ds_add_u32 v25, v2
    v_cvt_pk_bf16_f32 v32, v7, v8
    v_perm_b32 v12, v32, v32, s41
    v_bitop3_b32 v40, v4, v12, v40 bitop3:0xca
    v_perm_b32 v13, v32, v32, s42
    v_bitop3_b32 v41, v4, v13, v41 bitop3:0xca
    v_mul_hi_u32_u24 v14, 429497, v42
    v_lshrrev_b32 v12, 3, v26
    v_cos_f32 v9, v9
    v_lshlrev_b16 v13, 3, v26
    v_mad_i32_i24 v11, v14, s55, v42
    v_bitop3_b32 v12, v6, v13, v12 bitop3:0xca
    v_lshl_add_u32 v11, v11, 17, s40
    v_lshlrev_b16 v14, 8, v14
    v_lshrrev_b32 v13, 2, v26
    v_add_u32 v42, v12, v11
    v_bitop3_b32 v26, v5, v13, v14 bitop3:0xea
    ds_add_u32 v26, v2
    v_mul_hi_u32_u24 v14, 429497, v43
    v_lshrrev_b32 v12, 3, v27
    v_cos_f32 v10, v10
    v_lshlrev_b16 v13, 3, v27
    v_mad_i32_i24 v11, v14, s55, v43
    v_bitop3_b32 v12, v6, v13, v12 bitop3:0xca
    v_lshl_add_u32 v11, v11, 17, s40
    v_lshlrev_b16 v14, 8, v14
    v_lshrrev_b32 v13, 2, v27
    v_add_u32 v43, v12, v11
    v_bitop3_b32 v27, v5, v13, v14 bitop3:0xea
    ds_add_u32 v27, v2
    v_cvt_pk_bf16_f32 v33, v9, v10
    v_perm_b32 v12, v33, v33, s41
    v_bitop3_b32 v42, v4, v12, v42 bitop3:0xca
    v_perm_b32 v13, v33, v33, s42
    v_bitop3_b32 v43, v4, v13, v43 bitop3:0xca
    s_waitcnt vmcnt(16)
    v_lshlrev_b32 v7, 16, v34
    v_and_b32 v8, 0xffff0000, v34
    v_lshlrev_b32 v9, 16, v35
    v_and_b32 v10, 0xffff0000, v35
    v_mul_f32 v7, 0.15915494, v7
    v_mul_f32 v8, 0.15915494, v8
    v_mul_f32 v9, 0.15915494, v9
    v_mul_f32 v10, 0.15915494, v10
    v_mul_hi_u32_u24 v14, 429497, v48
    v_lshrrev_b32 v12, 3, v52
    v_cos_f32 v7, v7
    v_lshlrev_b16 v13, 3, v52
    v_mad_i32_i24 v11, v14, s55, v48
    v_bitop3_b32 v12, v6, v13, v12 bitop3:0xca
    v_lshl_add_u32 v11, v11, 17, s40
    v_lshlrev_b16 v14, 8, v14
    v_lshrrev_b32 v13, 2, v52
    v_add_u32 v48, v12, v11
    v_bitop3_b32 v52, v5, v13, v14 bitop3:0xea
    ds_add_u32 v52, v2
    v_mul_hi_u32_u24 v14, 429497, v49
    v_lshrrev_b32 v12, 3, v53
    v_cos_f32 v8, v8
    v_lshlrev_b16 v13, 3, v53
    v_mad_i32_i24 v11, v14, s55, v49
    v_bitop3_b32 v12, v6, v13, v12 bitop3:0xca
    v_lshl_add_u32 v11, v11, 17, s40
    v_lshlrev_b16 v14, 8, v14
    v_lshrrev_b32 v13, 2, v53
    v_add_u32 v49, v12, v11
    v_bitop3_b32 v53, v5, v13, v14 bitop3:0xea
    ds_add_u32 v53, v2
    v_cvt_pk_bf16_f32 v34, v7, v8
    v_perm_b32 v12, v34, v34, s41
    v_bitop3_b32 v48, v4, v12, v48 bitop3:0xca
    v_perm_b32 v13, v34, v34, s42
    v_bitop3_b32 v49, v4, v13, v49 bitop3:0xca
    v_mul_hi_u32_u24 v14, 429497, v50
    v_lshrrev_b32 v12, 3, v54
    v_cos_f32 v9, v9
    v_lshlrev_b16 v13, 3, v54
    v_mad_i32_i24 v11, v14, s55, v50
    v_bitop3_b32 v12, v6, v13, v12 bitop3:0xca
    v_lshl_add_u32 v11, v11, 17, s40
    v_lshlrev_b16 v14, 8, v14
    v_lshrrev_b32 v13, 2, v54
    v_add_u32 v50, v12, v11
    v_bitop3_b32 v54, v5, v13, v14 bitop3:0xea
    ds_add_u32 v54, v2
    v_mul_hi_u32_u24 v14, 429497, v51
    v_lshrrev_b32 v12, 3, v55
    v_cos_f32 v10, v10
    v_lshlrev_b16 v13, 3, v55
    v_mad_i32_i24 v11, v14, s55, v51
    v_bitop3_b32 v12, v6, v13, v12 bitop3:0xca
    v_lshl_add_u32 v11, v11, 17, s40
    v_lshlrev_b16 v14, 8, v14
    v_lshrrev_b32 v13, 2, v55
    v_add_u32 v51, v12, v11
    v_bitop3_b32 v55, v5, v13, v14 bitop3:0xea
    ds_add_u32 v55, v2
    v_cvt_pk_bf16_f32 v35, v9, v10
    v_perm_b32 v12, v35, v35, s41
    v_bitop3_b32 v50, v4, v12, v50 bitop3:0xca
    v_perm_b32 v13, v35, v35, s42
    v_bitop3_b32 v51, v4, v13, v51 bitop3:0xca
    s_setprio 1
    s_waitcnt vmcnt(12)
    v_lshlrev_b32 v7, 16, v72
    v_and_b32 v8, 0xffff0000, v72
    v_lshlrev_b32 v9, 16, v73
    v_and_b32 v10, 0xffff0000, v73
    v_mul_f32 v7, 0.15915494, v7
    v_mul_f32 v8, 0.15915494, v8
    v_mul_f32 v9, 0.15915494, v9
    v_mul_f32 v10, 0.15915494, v10
    v_mul_hi_u32_u24 v14, 429497, v84
    v_lshrrev_b32 v12, 3, v68
    v_cos_f32 v7, v7
    v_lshlrev_b16 v13, 3, v68
    v_mad_i32_i24 v11, v14, s55, v84
    v_bitop3_b32 v12, v6, v13, v12 bitop3:0xca
    v_lshl_add_u32 v11, v11, 17, s40
    v_lshlrev_b16 v14, 8, v14
    v_lshrrev_b32 v13, 2, v68
    v_add_u32 v84, v12, v11
    v_bitop3_b32 v68, v5, v13, v14 bitop3:0xea
    ds_add_u32 v68, v2
    v_mul_hi_u32_u24 v14, 429497, v85
    v_lshrrev_b32 v12, 3, v69
    v_cos_f32 v8, v8
    v_lshlrev_b16 v13, 3, v69
    v_mad_i32_i24 v11, v14, s55, v85
    v_bitop3_b32 v12, v6, v13, v12 bitop3:0xca
    v_lshl_add_u32 v11, v11, 17, s40
    v_lshlrev_b16 v14, 8, v14
    v_lshrrev_b32 v13, 2, v69
    v_add_u32 v85, v12, v11
    v_bitop3_b32 v69, v5, v13, v14 bitop3:0xea
    ds_add_u32 v69, v2
    v_cvt_pk_bf16_f32 v72, v7, v8
    v_perm_b32 v12, v72, v72, s41
    v_bitop3_b32 v84, v4, v12, v84 bitop3:0xca
    v_perm_b32 v13, v72, v72, s42
    v_bitop3_b32 v85, v4, v13, v85 bitop3:0xca
    v_mul_hi_u32_u24 v14, 429497, v86
    v_lshrrev_b32 v12, 3, v70
    v_cos_f32 v9, v9
    v_lshlrev_b16 v13, 3, v70
    v_mad_i32_i24 v11, v14, s55, v86
    v_bitop3_b32 v12, v6, v13, v12 bitop3:0xca
    v_lshl_add_u32 v11, v11, 17, s40
    v_lshlrev_b16 v14, 8, v14
    v_lshrrev_b32 v13, 2, v70
    v_add_u32 v86, v12, v11
    v_bitop3_b32 v70, v5, v13, v14 bitop3:0xea
    ds_add_u32 v70, v2
    v_mul_hi_u32_u24 v14, 429497, v87
    v_lshrrev_b32 v12, 3, v71
    v_cos_f32 v10, v10
    v_lshlrev_b16 v13, 3, v71
    v_mad_i32_i24 v11, v14, s55, v87
    v_bitop3_b32 v12, v6, v13, v12 bitop3:0xca
    v_lshl_add_u32 v11, v11, 17, s40
    v_lshlrev_b16 v14, 8, v14
    v_lshrrev_b32 v13, 2, v71
    v_add_u32 v87, v12, v11
    v_bitop3_b32 v71, v5, v13, v14 bitop3:0xea
    ds_add_u32 v71, v2
    v_cvt_pk_bf16_f32 v73, v9, v10
    v_perm_b32 v12, v73, v73, s41
    v_bitop3_b32 v86, v4, v12, v86 bitop3:0xca
    v_perm_b32 v13, v73, v73, s42
    v_bitop3_b32 v87, v4, v13, v87 bitop3:0xca
    s_add_u32 s45, s35, 0x7ec4000
    s_add_u32 s45, s45, s91
    buffer_store_dwordx4 v[104:107], v0, s[20:23], s45 offen sc1
    s_waitcnt vmcnt(10)
    s_cmp_le_u32 s43, 5
    s_cbranch_scc1 L1_s5
    v_lshlrev_b32 v7, 16, v74
    v_and_b32 v8, 0xffff0000, v74
    v_lshlrev_b32 v9, 16, v75
    v_and_b32 v10, 0xffff0000, v75
    v_mul_f32 v7, 0.15915494, v7
    v_mul_f32 v8, 0.15915494, v8
    v_mul_f32 v9, 0.15915494, v9
    v_mul_f32 v10, 0.15915494, v10
    v_mul_hi_u32_u24 v14, 429497, v36
    v_lshrrev_b32 v12, 3, v76
    v_cos_f32 v7, v7
    v_lshlrev_b16 v13, 3, v76
    v_mad_i32_i24 v11, v14, s55, v36
    v_bitop3_b32 v12, v6, v13, v12 bitop3:0xca
    v_lshl_add_u32 v11, v11, 17, s40
    v_lshlrev_b16 v14, 8, v14
    v_lshrrev_b32 v13, 2, v76
    v_add_u32 v36, v12, v11
    v_bitop3_b32 v76, v5, v13, v14 bitop3:0xea
    ds_add_u32 v76, v2
    v_mul_hi_u32_u24 v14, 429497, v37
    v_lshrrev_b32 v12, 3, v77
    v_cos_f32 v8, v8
    v_lshlrev_b16 v13, 3, v77
    v_mad_i32_i24 v11, v14, s55, v37
    v_bitop3_b32 v12, v6, v13, v12 bitop3:0xca
    v_lshl_add_u32 v11, v11, 17, s40
    v_lshlrev_b16 v14, 8, v14
    v_lshrrev_b32 v13, 2, v77
    v_add_u32 v37, v12, v11
    v_bitop3_b32 v77, v5, v13, v14 bitop3:0xea
    ds_add_u32 v77, v2
    v_cvt_pk_bf16_f32 v74, v7, v8
    v_perm_b32 v12, v74, v74, s41
    v_bitop3_b32 v36, v4, v12, v36 bitop3:0xca
    v_perm_b32 v13, v74, v74, s42
    v_bitop3_b32 v37, v4, v13, v37 bitop3:0xca
    v_mul_hi_u32_u24 v14, 429497, v38
    v_lshrrev_b32 v12, 3, v78
    v_cos_f32 v9, v9
    v_lshlrev_b16 v13, 3, v78
    v_mad_i32_i24 v11, v14, s55, v38
    v_bitop3_b32 v12, v6, v13, v12 bitop3:0xca
    v_lshl_add_u32 v11, v11, 17, s40
    v_lshlrev_b16 v14, 8, v14
    v_lshrrev_b32 v13, 2, v78
    v_add_u32 v38, v12, v11
    v_bitop3_b32 v78, v5, v13, v14 bitop3:0xea
    ds_add_u32 v78, v2
    v_mul_hi_u32_u24 v14, 429497, v39
    v_lshrrev_b32 v12, 3, v79
    v_cos_f32 v10, v10
    v_lshlrev_b16 v13, 3, v79
    v_mad_i32_i24 v11, v14, s55, v39
    v_bitop3_b32 v12, v6, v13, v12 bitop3:0xca
    v_lshl_add_u32 v11, v11, 17, s40
    v_lshlrev_b16 v14, 8, v14
    v_lshrrev_b32 v13, 2, v79
    v_add_u32 v39, v12, v11
    v_bitop3_b32 v79, v5, v13, v14 bitop3:0xea
    ds_add_u32 v79, v2
    v_cvt_pk_bf16_f32 v75, v9, v10
    v_perm_b32 v12, v75, v75, s41
    v_bitop3_b32 v38, v4, v12, v38 bitop3:0xca
    v_perm_b32 v13, v75, v75, s42
    v_bitop3_b32 v39, v4, v13, v39 bitop3:0xca
L1_s5:
    s_setprio 0
    s_waitcnt vmcnt(6)
    s_cmp_le_u32 s43, 6
    s_cbranch_scc1 L1_s6
    v_lshlrev_b32 v7, 16, v64
    v_and_b32 v8, 0xffff0000, v64
    v_lshlrev_b32 v9, 16, v65
    v_and_b32 v10, 0xffff0000, v65
    v_mul_f32 v7, 0.15915494, v7
    v_mul_f32 v8, 0.15915494, v8
    v_mul_f32 v9, 0.15915494, v9
    v_mul_f32 v10, 0.15915494, v10
    v_mul_hi_u32_u24 v14, 429497, v80
    v_lshrrev_b32 v12, 3, v56
    v_cos_f32 v7, v7
    v_lshlrev_b16 v13, 3, v56
    v_mad_i32_i24 v11, v14, s55, v80
    v_bitop3_b32 v12, v6, v13, v12 bitop3:0xca
    v_lshl_add_u32 v11, v11, 17, s40
    v_lshlrev_b16 v14, 8, v14
    v_lshrrev_b32 v13, 2, v56
    v_add_u32 v80, v12, v11
    v_bitop3_b32 v56, v5, v13, v14 bitop3:0xea
    ds_add_u32 v56, v2
    v_mul_hi_u32_u24 v14, 429497, v81
    v_lshrrev_b32 v12, 3, v57
    v_cos_f32 v8, v8
    v_lshlrev_b16 v13, 3, v57
    v_mad_i32_i24 v11, v14, s55, v81
    v_bitop3_b32 v12, v6, v13, v12 bitop3:0xca
    v_lshl_add_u32 v11, v11, 17, s40
    v_lshlrev_b16 v14, 8, v14
    v_lshrrev_b32 v13, 2, v57
    v_add_u32 v81, v12, v11
    v_bitop3_b32 v57, v5, v13, v14 bitop3:0xea
    ds_add_u32 v57, v2
    v_cvt_pk_bf16_f32 v64, v7, v8
    v_perm_b32 v12, v64, v64, s41
    v_bitop3_b32 v80, v4, v12, v80 bitop3:0xca
    v_perm_b32 v13, v64, v64, s42
    v_bitop3_b32 v81, v4, v13, v81 bitop3:0xca
    v_mul_hi_u32_u24 v14, 429497, v82
    v_lshrrev_b32 v12, 3, v58
    v_cos_f32 v9, v9
    v_lshlrev_b16 v13, 3, v58
    v_mad_i32_i24 v11, v14, s55, v82
    v_bitop3_b32 v12, v6, v13, v12 bitop3:0xca
    v_lshl_add_u32 v11, v11, 17, s40
    v_lshlrev_b16 v14, 8, v14
    v_lshrrev_b32 v13, 2, v58
    v_add_u32 v82, v12, v11
    v_bitop3_b32 v58, v5, v13, v14 bitop3:0xea
    ds_add_u32 v58, v2
    v_mul_hi_u32_u24 v14, 429497, v83
    v_lshrrev_b32 v12, 3, v59
    v_cos_f32 v10, v10
    v_lshlrev_b16 v13, 3, v59
    v_mad_i32_i24 v11, v14, s55, v83
    v_bitop3_b32 v12, v6, v13, v12 bitop3:0xca
    v_lshl_add_u32 v11, v11, 17, s40
    v_lshlrev_b16 v14, 8, v14
    v_lshrrev_b32 v13, 2, v59
    v_add_u32 v83, v12, v11
    v_bitop3_b32 v59, v5, v13, v14 bitop3:0xea
    ds_add_u32 v59, v2
    v_cvt_pk_bf16_f32 v65, v9, v10
    v_perm_b32 v12, v65, v65, s41
    v_bitop3_b32 v82, v4, v12, v82 bitop3:0xca
    v_perm_b32 v13, v65, v65, s42
    v_bitop3_b32 v83, v4, v13, v83 bitop3:0xca
L1_s6:
    s_waitcnt vmcnt(2)
    s_cmp_le_u32 s43, 7
    s_cbranch_scc1 L1_s7
    v_lshlrev_b32 v7, 16, v66
    v_and_b32 v8, 0xffff0000, v66
    v_lshlrev_b32 v9, 16, v67
    v_and_b32 v10, 0xffff0000, v67
    v_mul_f32 v7, 0.15915494, v7
    v_mul_f32 v8, 0.15915494, v8
    v_mul_f32 v9, 0.15915494, v9
    v_mul_f32 v10, 0.15915494, v10
    v_mul_hi_u32_u24 v14, 429497, v96
    v_lshrrev_b32 v12, 3, v60
    v_cos_f32 v7, v7
    v_lshlrev_b16 v13, 3, v60
    v_mad_i32_i24 v11, v14, s55, v96
    v_bitop3_b32 v12, v6, v13, v12 bitop3:0xca
    v_lshl_add_u32 v11, v11, 17, s40
    v_lshlrev_b16 v14, 8, v14
    v_lshrrev_b32 v13, 2, v60
    v_add_u32 v96, v12, v11
    v_bitop3_b32 v60, v5, v13, v14 bitop3:0xea
    ds_add_u32 v60, v2
    v_mul_hi_u32_u24 v14, 429497, v97
    v_lshrrev_b32 v12, 3, v61
    v_cos_f32 v8, v8
    v_lshlrev_b16 v13, 3, v61
    v_mad_i32_i24 v11, v14, s55, v97
    v_bitop3_b32 v12, v6, v13, v12 bitop3:0xca
    v_lshl_add_u32 v11, v11, 17, s40
    v_lshlrev_b16 v14, 8, v14
    v_lshrrev_b32 v13, 2, v61
    v_add_u32 v97, v12, v11
    v_bitop3_b32 v61, v5, v13, v14 bitop3:0xea
    ds_add_u32 v61, v2
    v_cvt_pk_bf16_f32 v66, v7, v8
    v_perm_b32 v12, v66, v66, s41
    v_bitop3_b32 v96, v4, v12, v96 bitop3:0xca
    v_perm_b32 v13, v66, v66, s42
    v_bitop3_b32 v97, v4, v13, v97 bitop3:0xca
    v_mul_hi_u32_u24 v14, 429497, v98
    v_lshrrev_b32 v12, 3, v62
    v_cos_f32 v9, v9
    v_lshlrev_b16 v13, 3, v62
    v_mad_i32_i24 v11, v14, s55, v98
    v_bitop3_b32 v12, v6, v13, v12 bitop3:0xca
    v_lshl_add_u32 v11, v11, 17, s40
    v_lshlrev_b16 v14, 8, v14
    v_lshrrev_b32 v13, 2, v62
    v_add_u32 v98, v12, v11
    v_bitop3_b32 v62, v5, v13, v14 bitop3:0xea
    ds_add_u32 v62, v2
    v_mul_hi_u32_u24 v14, 429497, v99
    v_lshrrev_b32 v12, 3, v63
    v_cos_f32 v10, v10
    v_lshlrev_b16 v13, 3, v63
    v_mad_i32_i24 v11, v14, s55, v99
    v_bitop3_b32 v12, v6, v13, v12 bitop3:0xca
    v_lshl_add_u32 v11, v11, 17, s40
    v_lshlrev_b16 v14, 8, v14
    v_lshrrev_b32 v13, 2, v63
    v_add_u32 v99, v12, v11
    v_bitop3_b32 v63, v5, v13, v14 bitop3:0xea
    ds_add_u32 v63, v2
    v_cvt_pk_bf16_f32 v67, v9, v10
    v_perm_b32 v12, v67, v67, s41
    v_bitop3_b32 v98, v4, v12, v98 bitop3:0xca
    v_perm_b32 v13, v67, v67, s42
    v_bitop3_b32 v99, v4, v13, v99 bitop3:0xca
L1_s7:
    v_lshrrev_b32 v8, 2, v0
    v_and_b32 v7, 0x3c00, v0
    v_bitop3_b32 v7, v5, v8, v7 bitop3:0xea
    s_waitcnt lgkmcnt(0)
    s_barrier
    ds_read2st64_b32 v[8:9], v7 offset0:0 offset1:1
    ds_read2st64_b32 v[10:11], v7 offset0:2 offset1:3
    s_add_u32 s46, s35, 0x7ec4000
    s_add_u32 s46, s46, s93
    buffer_store_dwordx4 v[28:31], v0, s[20:23], s46 offen sc1
    s_waitcnt lgkmcnt(0)
    v_lshl_or_b32 v12, v9, 16, v8
    v_lshl_or_b32 v13, v11, 16, v10
    v_mov_b32 v14, v12
    v_mov_b32 v15, v13
    s_nop 0
    v_add_u32_dpp v14, v14, v14 row_shr:1 row_mask:0xf bank_mask:0xf bound_ctrl:1
    v_add_u32_dpp v15, v15, v15 row_shr:1 row_mask:0xf bank_mask:0xf bound_ctrl:1
    s_nop 0
    v_add_u32_dpp v14, v14, v14 row_shr:2 row_mask:0xf bank_mask:0xf bound_ctrl:1
    v_add_u32_dpp v15, v15, v15 row_shr:2 row_mask:0xf bank_mask:0xf bound_ctrl:1
    s_nop 0
    v_add_u32_dpp v14, v14, v14 row_shr:4 row_mask:0xf bank_mask:0xf bound_ctrl:1
    v_add_u32_dpp v15, v15, v15 row_shr:4 row_mask:0xf bank_mask:0xf bound_ctrl:1
    s_nop 0
    v_add_u32_dpp v14, v14, v14 row_shr:8 row_mask:0xf bank_mask:0xf bound_ctrl:1
    v_add_u32_dpp v15, v15, v15 row_shr:8 row_mask:0xf bank_mask:0xf bound_ctrl:1
    s_nop 0
    v_add_u32_dpp v14, v14, v14 row_bcast:15 row_mask:0xa bank_mask:0xf
    v_add_u32_dpp v15, v15, v15 row_bcast:15 row_mask:0xa bank_mask:0xf
    s_nop 0
    v_add_u32_dpp v14, v14, v14 row_bcast:31 row_mask:0xc bank_mask:0xf
    v_add_u32_dpp v15, v15, v15 row_bcast:31 row_mask:0xc bank_mask:0xf
    v_readlane_b32 s48, v14, 63
    v_readlane_b32 s49, v15, 63
    s_lshl_b32 s54, s32, 2
    v_mov_b32 v8, s54
    s_and_b32 s50, s48, 0xffff
    s_lshr_b32 s51, s48, 16
    s_and_b32 s52, s49, 0xffff
    s_lshr_b32 s53, s49, 16
    s_add_u32 s51, s51, s50
    s_add_u32 s52, s52, s51
    s_add_u32 s53, s53, s52
    v_mov_b32 v9, s53
    v_and_b32_dpp v3, v3, v3 quad_perm:[1,0,3,2] row_mask:0xf bank_mask:0xf
    s_mov_b64 exec, 1
    ds_write_b32 v8, v9 offset:16384
    ds_write_b32 v8, v3 offset:16448
    s_mov_b64 exec, -1
    v_and_b32 v8, 60, v7
    s_waitcnt lgkmcnt(0)
    s_barrier
    ds_read_b32 v9, v8 offset:16384
    ds_read_b32 v10, v8 offset:16448
    s_waitcnt lgkmcnt(0)
    v_readlane_b32 s56, v10, 15
    s_xor_b32 s56, s56, 0x80
    v_add_u32_dpp v9, v9, v9 row_shr:1 row_mask:0xf bank_mask:0xf bound_ctrl:1
    s_nop 1
    v_add_u32_dpp v9, v9, v9 row_shr:2 row_mask:0xf bank_mask:0xf bound_ctrl:1
    s_nop 1
    v_add_u32_dpp v9, v9, v9 row_shr:4 row_mask:0xf bank_mask:0xf bound_ctrl:1
    s_nop 1
    v_add_u32_dpp v9, v9, v9 row_shr:8 row_mask:0xf bank_mask:0xf bound_ctrl:1
    s_nop 0
    v_readlane_b32 s54, v9, s32
    s_sub_u32 s54, s54, s53
    s_add_u32 s50, s50, s54
    s_add_u32 s51, s51, s54
    s_add_u32 s52, s52, s54
    s_pack_ll_b32_b16 s48, s54, s50
    s_pack_ll_b32_b16 s49, s51, s52
    v_add_u32 v14, s48, v14
    v_add_u32 v15, s49, v15
    v_sub_u32 v12, v14, v12
    v_sub_u32 v13, v15, v13
    v_and_b32 v8, 0xffff, v12
    v_lshrrev_b32 v9, 16, v12
    v_and_b32 v10, 0xffff, v13
    v_lshrrev_b32 v11, 16, v13
    ds_write2st64_b32 v7, v8, v9 offset0:0 offset1:1
    ds_write2st64_b32 v7, v10, v11 offset0:2 offset1:3
    v_and_b32 v8, 0x3f0, v0
    v_lshl_add_u32 v8, v8, 1, s36
    ds_write_b64 v8, v[12:13] offset:20480
    s_bitset0_b64 exec, 63
    s_not_b64 exec, exec
    ds_write_b64 v8, v[14:15] offset:20512
    s_mov_b64 exec, -1
    s_waitcnt lgkmcnt(0)
    s_barrier
    s_setprio 3
    ds_add_rtn_u32 v120, v120, v2
    ds_add_rtn_u32 v121, v121, v2
    ds_add_rtn_u32 v122, v122, v2
    ds_add_rtn_u32 v123, v123, v2
    ds_read_b128 v[12:15], v0 offset:20480
    v_cmp_gt_u32 vcc, 8448, v0
    ds_add_rtn_u32 v124, v124, v2
    ds_add_rtn_u32 v125, v125, v2
    ds_add_rtn_u32 v126, v126, v2
    ds_add_rtn_u32 v127, v127, v2
    s_setprio 2
    ds_add_rtn_u32 v24, v24, v2
    ds_add_rtn_u32 v25, v25, v2
    ds_add_rtn_u32 v26, v26, v2
    ds_add_rtn_u32 v27, v27, v2
    s_waitcnt lgkmcnt(8)
    s_cbranch_vccz L1_p8
    s_add_u32 s47, s35, 0xa900000
    s_mov_b64 exec, vcc
    buffer_store_dwordx4 v[12:15], v0, s[24:27], s47 offen sc1
    s_mov_b64 exec, -1
L1_p8:
    s_add_u32 s44, s35, 0x7ec8000
    s_add_u32 s44, s44, s72
    buffer_store_dwordx4 v[112:115], v0, s[20:23], s44 offen sc1
    ds_add_rtn_u32 v52, v52, v2
    ds_add_rtn_u32 v53, v53, v2
    ds_add_rtn_u32 v54, v54, v2
    ds_add_rtn_u32 v55, v55, v2
    s_load_dwordx2 s[28:29], s[0:1], 0
    s_load_dwordx2 s[50:51], s[0:1], 40
    s_load_dwordx2 s[52:53], s[0:1], 24
    s_setprio 1
    ds_add_rtn_u32 v68, v68, v2
    ds_add_rtn_u32 v69, v69, v2
    ds_add_rtn_u32 v70, v70, v2
    ds_add_rtn_u32 v71, v71, v2
    s_cmp_le_u32 s43, 5
    s_cbranch_scc1 L1_s9
    ds_add_rtn_u32 v76, v76, v2
    ds_add_rtn_u32 v77, v77, v2
    ds_add_rtn_u32 v78, v78, v2
    ds_add_rtn_u32 v79, v79, v2
L1_s9:
    s_add_u32 s45, s35, 0x7ec8000
    s_add_u32 s45, s45, s73
    buffer_store_dwordx4 v[88:91], v0, s[20:23], s45 offen sc1
    s_setprio 0
    s_cmp_le_u32 s43, 6
    s_cbranch_scc1 L1_s10
    ds_add_rtn_u32 v56, v56, v2
    ds_add_rtn_u32 v57, v57, v2
    ds_add_rtn_u32 v58, v58, v2
    ds_add_rtn_u32 v59, v59, v2
L1_s10:
    s_cmp_le_u32 s43, 7
    s_cbranch_scc1 L1_s11
    ds_add_rtn_u32 v60, v60, v2
    ds_add_rtn_u32 v61, v61, v2
    ds_add_rtn_u32 v62, v62, v2
    ds_add_rtn_u32 v63, v63, v2
L1_s11:
    s_waitcnt lgkmcnt(0)
    s_barrier
    s_load_dwordx4 s[96:99], s[50:51], 0
    s_mov_b64 s[4:5], s[52:53]
    s_bfe_u32 s33, s2, 0x20001
    s_and_b32 s34, s2, 1
    s_lshl_b32 s34, s34, 5
    s_lshr_b32 s3, s2, 3
    s_add_u32 s34, s34, s3
    s_mul_i32 s39, s33, 2080
    s_lshl_b32 s3, s34, 5
    s_add_u32 s39, s39, s3
    s_mul_i32 s40, s33, 1310720
    s_add_u32 s40, s40, 0x50000
    s_lshl_b32 s38, s32, 11
    s_mul_i32 s100, s32, 3072
    s_add_u32 s8, s30, 0x4000
    s_addc_u32 s9, s31, 0
    s_mov_b32 s10, 0xd340000
    s_mov_b32 s11, 0x20000
    s_add_u32 s12, s30, 0x2c000
    s_addc_u32 s13, s31, 0
    s_mov_b32 s14, 0xd318000
    s_mov_b32 s15, 0x20000
    s_mov_b32 s16, s64
    s_mov_b32 s17, s65
    s_mov_b32 s18, 0x20
    s_mov_b32 s19, 0x20000
    s_mov_b32 s24, s28
    s_mov_b32 s25, s29
    s_mov_b32 s26, 0x4e2000
    s_mov_b32 s27, 0x20000
    s_setprio 3
    v_and_b32 v7, -4, v120
    v_lshl_add_u32 v8, v120, 2, v7
    ds_write_b32 v8, v16
    v_lshl_add_u32 v7, v7, 2, v120
    ds_write_b8 v7, v44 offset:16
    v_and_b32 v9, -4, v121
    v_lshl_add_u32 v10, v121, 2, v9
    ds_write_b32 v10, v17
    v_lshl_add_u32 v9, v9, 2, v121
    ds_write_b8_d16_hi v9, v44 offset:16
    v_and_b32 v7, -4, v122
    v_lshl_add_u32 v8, v122, 2, v7
    ds_write_b32 v8, v18
    v_lshl_add_u32 v7, v7, 2, v122
    ds_write_b8 v7, v45 offset:16
    v_and_b32 v9, -4, v123
    v_lshl_add_u32 v10, v123, 2, v9
    ds_write_b32 v10, v19
    v_lshl_add_u32 v9, v9, 2, v123
    ds_write_b8_d16_hi v9, v45 offset:16
    s_add_u32 s46, s35, 0x7ec8000
    s_add_u32 s46, s46, s85
    buffer_store_dwordx4 v[116:119], v0, s[20:23], s46 offen sc1
    v_and_b32 v13, 0x3f0, v0
    v_and_b32 v14, 0x300, v13
    v_bfe_u32 v15, v13, 4, 4
    s_lshl_b32 s3, s32, 4
    v_add3_u32 v14, v14, v15, s3
    v_mul_u32_u24 v2, 173056, v14
    v_lshrrev_b32 v14, 6, v13
    s_add_u32 s3, s3, 0x400
    v_add_u32 v14, s3, v14
    v_mul_u32_u24 v4, 173056, v14
    v_and_b32 v14, 3, v14
    v_and_b32 v15, 0x30, v13
    v_lshl_add_u32 v14, v14, 5, v15
    v_add_u32 v6, v14, v4
    v_lshl_add_u32 v5, v15, 1, v2
    v_lshrrev_b32 v14, 3, v15
    buffer_load_ushort v100, v14, s[16:19], 0 offen offset:0
    buffer_load_ushort v101, v14, s[16:19], 0 offen offset:8
    buffer_load_ushort v102, v14, s[16:19], 0 offen offset:16
    buffer_load_ushort v103, v14, s[16:19], 0 offen offset:24
    s_mul_i32 s3, s32, 5120
    v_add_u32 v3, s3, v13
    v_lshrrev_b32 v14, 2, v13
    v_add_u32 v14, s38, v14
    v_and_b32 v7, -4, v124
    v_lshl_add_u32 v8, v124, 2, v7
    ds_write_b32 v8, v20
    v_lshl_add_u32 v7, v7, 2, v124
    ds_write_b8 v7, v46 offset:16
    v_and_b32 v9, -4, v125
    v_lshl_add_u32 v10, v125, 2, v9
    ds_write_b32 v10, v21
    v_lshl_add_u32 v9, v9, 2, v125
    ds_write_b8_d16_hi v9, v46 offset:16
    v_and_b32 v7, -4, v126
    v_lshl_add_u32 v8, v126, 2, v7
    ds_write_b32 v8, v22
    v_lshl_add_u32 v7, v7, 2, v126
    ds_write_b8 v7, v47 offset:16
    v_and_b32 v9, -4, v127
    v_lshl_add_u32 v10, v127, 2, v9
    ds_write_b32 v10, v23
    v_lshl_add_u32 v9, v9, 2, v127
    ds_write_b8_d16_hi v9, v47 offset:16
    v_lshrrev_b32 v11, 2, v0
    v_and_b32 v11, 0xfc, v11
    s_cmp_ge_u32 s84, 128
    s_cselect_b32 s82, 0, s82
    s_and_b32 s3, s84, 1
    s_mul_i32 s3, s3, 40
    s_add_u32 s3, s3, s32
    s_mul_i32 s74, s3, 205
    s_lshr_b32 s74, s74, 10
    s_mul_i32 s75, s74, 5
    s_sub_u32 s75, s3, s75
    s_lshl_b32 s48, s74, 1
    s_add_u32 s48, s48, s75
    s_add_u32 s49, s48, s74
    s_add_u32 s49, s49, 30
    s_cmp_lt_u32 s75, 2
    s_cselect_b32 s48, s48, s49
    s_lshl_b32 s48, s48, 10
    s_lshr_b32 s49, s84, 1
    s_mul_i32 s49, s49, 80000
    s_add_u32 s48, s48, s49
    buffer_load_dword v104, v11, s[80:83], s48 offen offset:0
    buffer_load_dword v105, v11, s[80:83], s48 offen offset:256
    buffer_load_dword v106, v11, s[80:83], s48 offen offset:512
    buffer_load_dword v107, v11, s[80:83], s48 offen offset:768
    s_and_b32 s3, s84, 1
    s_mul_i32 s3, s3, 40
    s_add_u32 s3, s3, s32
    s_add_u32 s3, s3, 16
    s_mul_i32 s74, s3, 205
    s_lshr_b32 s74, s74, 10
    s_mul_i32 s75, s74, 5
    s_sub_u32 s75, s3, s75
    s_lshl_b32 s48, s74, 1
    s_add_u32 s48, s48, s75
    s_add_u32 s49, s48, s74
    s_add_u32 s49, s49, 30
    s_cmp_lt_u32 s75, 2
    s_cselect_b32 s48, s48, s49
    s_lshl_b32 s48, s48, 10
    s_lshr_b32 s49, s84, 1
    s_mul_i32 s49, s49, 80000
    s_add_u32 s48, s48, s49
    buffer_load_dword v28, v11, s[80:83], s48 offen offset:0
    buffer_load_dword v29, v11, s[80:83], s48 offen offset:256
    buffer_load_dword v30, v11, s[80:83], s48 offen offset:512
    buffer_load_dword v31, v11, s[80:83], s48 offen offset:768
    s_and_b32 s3, s84, 1
    s_mul_i32 s3, s3, 40
    s_add_u32 s3, s3, s32
    s_add_u32 s3, s3, 32
    s_cmp_ge_u32 s32, 8
    s_cselect_b32 s82, 0, s82
    s_mul_i32 s74, s3, 205
    s_lshr_b32 s74, s74, 10
    s_mul_i32 s75, s74, 5
    s_sub_u32 s75, s3, s75
    s_lshl_b32 s48, s74, 1
    s_add_u32 s48, s48, s75
    s_add_u32 s49, s48, s74
    s_add_u32 s49, s49, 30
    s_cmp_lt_u32 s75, 2
    s_cselect_b32 s48, s48, s49
    s_lshl_b32 s48, s48, 10
    s_lshr_b32 s49, s84, 1
    s_mul_i32 s49, s49, 80000
    s_add_u32 s48, s48, s49
    buffer_load_dword v112, v11, s[80:83], s48 offen offset:0
    buffer_load_dword v113, v11, s[80:83], s48 offen offset:256
    buffer_load_dword v114, v11, s[80:83], s48 offen offset:512
    buffer_load_dword v115, v11, s[80:83], s48 offen offset:768
    s_setprio 2
    v_and_b32 v7, -4, v24
    v_lshl_add_u32 v8, v24, 2, v7
    ds_write_b32 v8, v40
    v_lshl_add_u32 v7, v7, 2, v24
    ds_write_b8 v7, v32 offset:16
    v_and_b32 v9, -4, v25
    v_lshl_add_u32 v10, v25, 2, v9
    ds_write_b32 v10, v41
    v_lshl_add_u32 v9, v9, 2, v25
    ds_write_b8_d16_hi v9, v32 offset:16
    v_and_b32 v7, -4, v26
    v_lshl_add_u32 v8, v26, 2, v7
    ds_write_b32 v8, v42
    v_lshl_add_u32 v7, v7, 2, v26
    ds_write_b8 v7, v33 offset:16
    v_and_b32 v9, -4, v27
    v_lshl_add_u32 v10, v27, 2, v9
    ds_write_b32 v10, v43
    v_lshl_add_u32 v9, v9, 2, v27
    ds_write_b8_d16_hi v9, v33 offset:16
    s_add_u32 s47, s35, 0x7ec8000
    s_add_u32 s47, s47, s91
    buffer_store_dwordx4 v[92:95], v0, s[20:23], s47 offen sc1
    v_and_b32 v7, -4, v52
    v_lshl_add_u32 v8, v52, 2, v7
    ds_write_b32 v8, v48
    v_lshl_add_u32 v7, v7, 2, v52
    ds_write_b8 v7, v34 offset:16
    v_and_b32 v9, -4, v53
    v_lshl_add_u32 v10, v53, 2, v9
    ds_write_b32 v10, v49
    v_lshl_add_u32 v9, v9, 2, v53
    ds_write_b8_d16_hi v9, v34 offset:16
    v_and_b32 v7, -4, v54
    v_lshl_add_u32 v8, v54, 2, v7
    ds_write_b32 v8, v50
    v_lshl_add_u32 v7, v7, 2, v54
    ds_write_b8 v7, v35 offset:16
    v_and_b32 v9, -4, v55
    v_lshl_add_u32 v10, v55, 2, v9
    ds_write_b32 v10, v51
    v_lshl_add_u32 v9, v9, 2, v55
    ds_write_b8_d16_hi v9, v35 offset:16
    s_setprio 1
    v_and_b32 v7, -4, v68
    v_lshl_add_u32 v8, v68, 2, v7
    ds_write_b32 v8, v84
    v_lshl_add_u32 v7, v7, 2, v68
    ds_write_b8 v7, v72 offset:16
    v_and_b32 v9, -4, v69
    v_lshl_add_u32 v10, v69, 2, v9
    ds_write_b32 v10, v85
    v_lshl_add_u32 v9, v9, 2, v69
    ds_write_b8_d16_hi v9, v72 offset:16
    v_and_b32 v7, -4, v70
    v_lshl_add_u32 v8, v70, 2, v7
    ds_write_b32 v8, v86
    v_lshl_add_u32 v7, v7, 2, v70
    ds_write_b8 v7, v73 offset:16
    v_and_b32 v9, -4, v71
    v_lshl_add_u32 v10, v71, 2, v9
    ds_write_b32 v10, v87
    v_lshl_add_u32 v9, v9, 2, v71
    ds_write_b8_d16_hi v9, v73 offset:16
    s_cmp_le_u32 s43, 5
    s_cbranch_scc1 L1_s12
    v_and_b32 v7, -4, v76
    v_lshl_add_u32 v8, v76, 2, v7
    ds_write_b32 v8, v36
    v_lshl_add_u32 v7, v7, 2, v76
    ds_write_b8 v7, v74 offset:16
    v_and_b32 v9, -4, v77
    v_lshl_add_u32 v10, v77, 2, v9
    ds_write_b32 v10, v37
    v_lshl_add_u32 v9, v9, 2, v77
    ds_write_b8_d16_hi v9, v74 offset:16
    v_and_b32 v7, -4, v78
    v_lshl_add_u32 v8, v78, 2, v7
    ds_write_b32 v8, v38
    v_lshl_add_u32 v7, v7, 2, v78
    ds_write_b8 v7, v75 offset:16
    v_and_b32 v9, -4, v79
    v_lshl_add_u32 v10, v79, 2, v9
    ds_write_b32 v10, v39
    v_lshl_add_u32 v9, v9, 2, v79
    ds_write_b8_d16_hi v9, v75 offset:16
L1_s12:
    s_add_u32 s44, s35, 0x7ec8000
    s_add_u32 s44, s44, s93
    buffer_store_dwordx4 v[108:111], v0, s[20:23], s44 offen sc1
    s_setprio 0
    s_cmp_le_u32 s43, 6
    s_cbranch_scc1 L1_s13
    v_and_b32 v7, -4, v56
    v_lshl_add_u32 v8, v56, 2, v7
    ds_write_b32 v8, v80
    v_lshl_add_u32 v7, v7, 2, v56
    ds_write_b8 v7, v64 offset:16
    v_and_b32 v9, -4, v57
    v_lshl_add_u32 v10, v57, 2, v9
    ds_write_b32 v10, v81
    v_lshl_add_u32 v9, v9, 2, v57
    ds_write_b8_d16_hi v9, v64 offset:16
    v_and_b32 v7, -4, v58
    v_lshl_add_u32 v8, v58, 2, v7
    ds_write_b32 v8, v82
    v_lshl_add_u32 v7, v7, 2, v58
    ds_write_b8 v7, v65 offset:16
    v_and_b32 v9, -4, v59
    v_lshl_add_u32 v10, v59, 2, v9
    ds_write_b32 v10, v83
    v_lshl_add_u32 v9, v9, 2, v59
    ds_write_b8_d16_hi v9, v65 offset:16
L1_s13:
    s_add_u32 s80, s30, 0xd344000
    s_addc_u32 s81, s31, 0
    s_mov_b32 s82, 0xa000
    s_mov_b32 s83, 0x20000
    s_min_u32 s3, s84, 127
    s_mul_i32 s3, s3, 40960
    s_add_u32 s80, s80, s3
    s_addc_u32 s81, s81, 0
    s_cmp_ge_u32 s84, 128
    s_cselect_b32 s82, 0, s82
    s_waitcnt vmcnt(2)
    v_add_u32 v11, 0, v0
    buffer_store_dwordx4 v[104:107], v11, s[80:83], 0 offen sc1
    v_add_u32 v11, 16384, v0
    buffer_store_dwordx4 v[28:31], v11, s[80:83], 0 offen sc1
    v_add_u32 v11, 32768, v0
    buffer_store_dwordx4 v[112:115], v11, s[80:83], 0 offen sc1
    s_cmp_le_u32 s43, 7
    s_cbranch_scc1 L1_s14
    v_and_b32 v7, -4, v60
    v_lshl_add_u32 v8, v60, 2, v7
    ds_write_b32 v8, v96
    v_lshl_add_u32 v7, v7, 2, v60
    ds_write_b8 v7, v66 offset:16
    v_and_b32 v9, -4, v61
    v_lshl_add_u32 v10, v61, 2, v9
    ds_write_b32 v10, v97
    v_lshl_add_u32 v9, v9, 2, v61
    ds_write_b8_d16_hi v9, v66 offset:16
    v_and_b32 v7, -4, v62
    v_lshl_add_u32 v8, v62, 2, v7
    ds_write_b32 v8, v98
    v_lshl_add_u32 v7, v7, 2, v62
    ds_write_b8 v7, v67 offset:16
    v_and_b32 v9, -4, v63
    v_lshl_add_u32 v10, v63, 2, v9
    ds_write_b32 v10, v99
    v_lshl_add_u32 v9, v9, 2, v63
    ds_write_b8_d16_hi v9, v67 offset:16
L1_s14:
    v_add_u32 v7, 0x10000, v0
    v_add_u32 v12, 0x20000, v0
    s_waitcnt lgkmcnt(0)
    s_barrier
    ds_read_b128 v[24:27], v0 offset:0
    ds_read_b128 v[28:31], v0 offset:16384
    ds_read_b128 v[32:35], v0 offset:32768
    ds_read_b128 v[36:39], v0 offset:49152
    ds_read_b128 v[76:79], v7 offset:0
    ds_read_b128 v[80:83], v7 offset:16384
    ds_read_b128 v[84:87], v7 offset:32768
    ds_read_b128 v[104:107], v7 offset:49152
    ds_read_b128 v[68:71], v12 offset:0
    ds_read_b128 v[72:75], v12 offset:16384
    s_cmp_lg_u32 s32, 0
    s_cbranch_scc1 L2_sg1
    s_mov_b32 exec_hi, 0
    v_mov_b32 v11, 1
    buffer_store_dword v11, v14, s[60:63], s57 offen sc1
    s_mov_b64 exec, -1
L2_sg1:
    s_waitcnt lgkmcnt(9)
    s_add_u32 s45, s35, 0xa904000
    buffer_store_dwordx4 v[24:27], v0, s[20:23], s45 offen sc1
    s_waitcnt lgkmcnt(8)
    s_add_u32 s46, s35, 0xa908000
    buffer_store_dwordx4 v[28:31], v0, s[20:23], s46 offen sc1
    s_waitcnt lgkmcnt(7)
    s_add_u32 s47, s35, 0xa90c000
    buffer_store_dwordx4 v[32:35], v0, s[20:23], s47 offen sc1
    s_waitcnt lgkmcnt(6)
    s_add_u32 s44, s35, 0xa910000
    buffer_store_dwordx4 v[36:39], v0, s[20:23], s44 offen sc1
    s_waitcnt lgkmcnt(5)
    s_add_u32 s45, s35, 0xa914000
    buffer_store_dwordx4 v[76:79], v0, s[20:23], s45 offen sc1
    s_waitcnt lgkmcnt(4)
    s_add_u32 s46, s35, 0xa918000
    buffer_store_dwordx4 v[80:83], v0, s[20:23], s46 offen sc1
    s_waitcnt lgkmcnt(3)
    s_add_u32 s47, s35, 0xa91c000
    buffer_store_dwordx4 v[84:87], v0, s[20:23], s47 offen sc1
    s_waitcnt lgkmcnt(2)
    s_cmp_le_u32 s43, 5
    s_cbranch_scc1 L1_q15
    s_add_u32 s44, s35, 0xa920000
    buffer_store_dwordx4 v[104:107], v0, s[20:23], s44 offen sc1
L1_q15:
    s_waitcnt lgkmcnt(1)
    s_cmp_le_u32 s43, 6
    s_cbranch_scc1 L1_q16
    s_add_u32 s45, s35, 0xa924000
    buffer_store_dwordx4 v[68:71], v0, s[20:23], s45 offen sc1
L1_q16:
    s_waitcnt lgkmcnt(0)
    s_cmp_le_u32 s43, 7
    s_cbranch_scc1 L1_q17
    s_add_u32 s46, s35, 0xa928000
    buffer_store_dwordx4 v[72:75], v0, s[20:23], s46 offen sc1
L1_q17:
    s_waitcnt lgkmcnt(0)
    s_setprio 3
    v_mov_b32 v92, v0
    v_mov_b32 v93, v6
    v_mov_b32 v94, v13
    v_mov_b32 v95, v5
    v_mov_b32 v0, v14
    v_lshl_add_u32 v7, v13, 3, s38
    v_lshrrev_b32 v16, 2, v15
    v_mad_u32_u24 v4, v16, 5, v4
    v_or_b32 v4, 0xf0000000, v4
    v_or_b32 v2, 0xf0000000, v2
    v_sub_u32 v1, 28, v16
    v_lshrrev_b32 v17, 2, v16
    v_and_b32 v18, 3, v17
    v_lshlrev_b32 v18, 4, v18
    v_mov_b32 v10, 0x3f80
    v_mov_b32 v11, 0
    v_lshlrev_b64 v[10:11], v18, v[10:11]
    v_and_b32 v18, 3, v17
    v_lshlrev_b32 v18, 4, v18
    v_mov_b32 v12, 0xbf80
    v_mov_b32 v13, 0
    v_lshlrev_b64 v[12:13], v18, v[12:13]
    v_mov_b32 v45, 0xf0000000
    v_mov_b32 v5, 0x1fff8
    v_mov_b32 v6, 0x07ff0000
    v_mov_b32 v16, 0
    v_mov_b32 v17, 0
    v_mov_b32 v18, 0
    v_mov_b32 v19, 0
    v_add_u32 v20, 81920, v92
    v_add_u32 v21, 0x10000, v20
    s_setprio 1
    s_setprio 2
    s_mov_b32 s44, 0x4000c0c
    s_mov_b32 s45, 0x4010c0c
    s_mov_b32 s46, 0x4020c0c
    s_mov_b32 s47, 0x4030c0c
    s_mov_b32 s36, 0
    s_mov_b32 s43, 0
    s_mov_b32 s42, 0
    s_mov_b64 s[80:81], 0
    s_mov_b64 s[48:49], 0
    s_add_u32 s16, s30, 0xd344000
    s_addc_u32 s17, s31, 0
    s_mov_b32 s18, 0x500000
    s_mov_b32 s19, 0x20000
    v_mov_b32 v68, 0
    v_mov_b32 v69, 0
    v_mov_b32 v70, 0
    v_mov_b32 v71, 0
    v_mov_b32 v72, 0
    v_mov_b32 v73, 0
    v_mov_b32 v74, 0
    v_mov_b32 v75, 0
    s_waitcnt vmcnt(0)
    v_lshl_or_b32 v8, v101, 16, v100
    v_lshl_or_b32 v9, v103, 16, v102
    s_barrier
    s_cmp_lg_u32 s32, 0
    s_cbranch_scc1 L2_sg2
    s_mov_b32 exec_hi, 0
    v_mov_b32 v88, 2
    buffer_store_dword v88, v0, s[60:63], s57 offen sc1
    s_mov_b64 exec, -1
L2_sg2:
    s_mov_b64 s[84:85], 0
    s_mul_i32 s3, s33, 1280000
    s_add_u32 s3, s3, s100
    s_add_u32 s3, s3, 32768
    buffer_load_dwordx4 v[124:127], v94, s[24:27], s3 offen offset:2048
    s_mul_i32 s3, s33, 1280000
    s_add_u32 s3, s3, s100
    s_add_u32 s3, s3, 32768
    buffer_load_dwordx4 v[116:119], v94, s[24:27], s3 offen offset:0
    s_mul_i32 s3, s33, 1280000
    s_add_u32 s3, s3, s100
    s_add_u32 s3, s3, 32768
    buffer_load_dwordx4 v[120:123], v94, s[24:27], s3 offen offset:1024
    s_mul_i32 s3, s33, 1280000
    s_add_u32 s3, s3, s38
    s_add_u32 s3, s3, 0
    buffer_load_dwordx4 v[108:111], v94, s[24:27], s3 offen offset:0
    s_mul_i32 s3, s33, 1280000
    s_add_u32 s3, s3, s38
    s_add_u32 s3, s3, 0
    buffer_load_dwordx4 v[112:115], v94, s[24:27], s3 offen offset:1024
    ds_write_b128 v20, v[16:19] offset:0
    ds_write_b128 v20, v[16:19] offset:16384
    ds_write_b128 v20, v[16:19] offset:32768
    ds_write_b128 v20, v[16:19] offset:49152
    ds_write_b128 v21, v[16:19]
    s_cmp_eq_u32 s56, 0
    s_cbranch_scc1 L2_e3
    v_lshlrev_b32 v16, 3, v94
    v_and_b32 v16, 0x80, v16
L2_e4:
    buffer_load_dword v88, v16, s[68:71], 0 offen sc1
    s_waitcnt vmcnt(0)
    v_cmp_gt_u32 vcc, 0x80, v88
    s_cbranch_vccnz L2_e4
L2_e3:
    s_mov_b64 exec, 0xffff
L2_p1:
    buffer_load_dword v88, v7, s[60:63], 0 offen sc1
    s_waitcnt vmcnt(0)
    v_cmpx_gt_u32 vcc, 1, v88
    s_cbranch_vccnz L2_p1s
    s_mov_b64 exec, -1
    v_cmp_gt_u32 vcc, 2, v88
    s_and_b32 s56, vcc_lo, 0xffff
    buffer_load_dwordx4 v[48:51], v95, s[12:15], s39 offen offset:0
    buffer_load_dwordx4 v[56:59], v95, s[12:15], s39 offen offset:32
    buffer_load_dwordx4 v[52:55], v95, s[12:15], s39 offen offset:16
    buffer_load_dwordx4 v[60:63], v95, s[12:15], s39 offen offset:48
    buffer_load_dwordx4 v[64:67], v93, s[12:15], s39 offen
    s_waitcnt vmcnt(0)
    v_sub_u16 v88, v56, v48
    v_and_b32 v89, 3, v48
    v_add3_u32 v99, v88, v89, 3
    v_and_b32 v99, -4, v99
    v_max_u32 v99, 4, v99
    v_and_b32 v97, 0xfffc, v48
    v_bfm_b32 v96, v88, v89
    v_add_u32_dpp v91, v99, v99 row_shr:1 row_mask:0xf bank_mask:0xf bound_ctrl:1
    v_mad_u32_u24 v97, v97, 5, v2
    v_cmp_lt_u32 vcc, 16, v99
    v_add_u32_dpp v91, v91, v91 row_shr:2 row_mask:0xf bank_mask:0xf bound_ctrl:1
    v_sub_u32 v98, s38, v99
    v_lshrrev_b64 v[48:49], 16, v[48:49]
    v_add_u32_dpp v91, v91, v91 row_shr:4 row_mask:0xf bank_mask:0xf bound_ctrl:1
    v_lshrrev_b64 v[56:57], 16, v[56:57]
    s_mov_b32 s101, 0
    v_add_u32_dpp v91, v91, v91 row_shr:8 row_mask:0xf bank_mask:0xf bound_ctrl:1
    s_nop 1
    v_add_u32_dpp v91, v91, v91 row_bcast:15 row_mask:0xa bank_mask:0xf
    s_nop 1
    v_add_u32_dpp v91, v91, v91 row_bcast:31 row_mask:0xc bank_mask:0xf
    v_add_u32 v98, v98, v91
    v_readlane_b32 s37, v91, 63
    s_cbranch_vccnz L2_xo3
L2_xp3:
    v_mov_b32 v44, v43
    s_cmp_gt_u32 s37, 1024
    s_cbranch_scc1 L2_xs4
    s_cmp_lg_u32 s101, 0
    s_cbranch_scc1 L2_xa4
L2_xb4:
    v_lshlrev_b32 v89, 16, v96
    v_add_u32 v90, 60, v97
    v_bitop3_b32 v90, v89, v45, v90 bitop3:0x6a
    ds_write_b32 v98, v90 offset:12
    v_lshlrev_b32 v89, 20, v96
    v_add_u32 v90, 40, v97
    v_bitop3_b32 v90, v89, v45, v90 bitop3:0x6a
    ds_write_b32 v98, v90 offset:8
    v_lshlrev_b32 v89, 24, v96
    v_add_u32 v90, 20, v97
    v_bitop3_b32 v90, v89, v45, v90 bitop3:0x6a
    ds_write_b32 v98, v90 offset:4
    v_lshlrev_b32 v89, 28, v96
    v_bitop3_b32 v90, v89, v45, v97 bitop3:0x6a
    ds_write_b32 v98, v90 offset:0
    v_mov_b32_dpp v91, v64 quad_perm:[0,0,0,0] row_mask:0xf bank_mask:0xf
    v_and_b32 v89, 3, v91
    v_and_b32 v97, 0xfffc, v91
    v_sub_u16_dpp v88, v64, v91 quad_perm:[2,2,2,2] row_mask:0xf bank_mask:0xf
    v_mad_u32_u24 v97, v97, 5, v4
    v_add_u32 v99, v88, v89
    v_bfm_b32 v96, v88, v89
    v_cmp_lt_u32 s[58:59], 16, v99
    v_lshlrev_b32 v89, v1, v96
    v_and_b32 v89, v45, v89
    v_cmp_ne_u32 vcc, 0, v89
    v_xor_b32 v90, v97, v89
    s_add_u32 s3, s37, s38
    v_mbcnt_lo_u32_b32 v98, vcc_lo, 0
    v_mbcnt_hi_u32_b32 v98, vcc_hi, v98
    s_bcnt1_i32_b64 s41, vcc
    v_lshl_add_u32 v98, v98, 2, s3
    s_mov_b64 exec, vcc
    ds_write_b32 v98, v90
    s_mov_b64 exec, -1
    s_lshl2_add_u32 s37, s41, s37
    s_cmp_lg_u64 s[58:59], 0
    s_cbranch_scc1 L2_xe4
L2_xr4:
    v_add_u32 v98, s37, v0
    v_mov_b32 v90, -1
    ds_write_b32 v98, v90
    v_add_u32 v98, s38, v0
    ds_read2st64_b32 v[40:41], v0 offset0:0 offset1:1
    ds_read_b32 v43, v0 offset:512
    v_lshrrev_b32 v98, 1, v98
    v_and_b32 v98, -4, v98
    ds_read_b32 v42, v98 offset:768
    s_sub_u32 s3, s37, 768
    s_cmp_gt_u32 s3, 128
    s_cbranch_scc1 L2_xf4
L2_xg4:
    v_sub_u16 v88, v58, v50
    v_and_b32 v89, 3, v50
    v_add3_u32 v99, v88, v89, 3
    v_and_b32 v99, -4, v99
    v_max_u32 v99, 4, v99
    v_and_b32 v97, 0xfffc, v50
    v_bfm_b32 v96, v88, v89
    v_add_u32_dpp v91, v99, v99 row_shr:1 row_mask:0xf bank_mask:0xf bound_ctrl:1
    v_mad_u32_u24 v97, v97, 5, v2
    v_cmp_lt_u32 vcc, 16, v99
    v_add_u32_dpp v91, v91, v91 row_shr:2 row_mask:0xf bank_mask:0xf bound_ctrl:1
    v_sub_u32 v98, s38, v99
    v_lshrrev_b64 v[50:51], 16, v[50:51]
    v_add_u32_dpp v91, v91, v91 row_shr:4 row_mask:0xf bank_mask:0xf bound_ctrl:1
    v_lshrrev_b64 v[58:59], 16, v[58:59]
    s_mov_b32 s101, 0
    v_add_u32_dpp v91, v91, v91 row_shr:8 row_mask:0xf bank_mask:0xf bound_ctrl:1
    s_nop 1
    v_add_u32_dpp v91, v91, v91 row_bcast:15 row_mask:0xa bank_mask:0xf
    s_nop 1
    v_add_u32_dpp v91, v91, v91 row_bcast:31 row_mask:0xc bank_mask:0xf
    v_add_u32 v98, v98, v91
    v_readlane_b32 s37, v91, 63
    s_cbranch_vccnz L2_xo5
L2_xp5:
    s_waitcnt lgkmcnt(0)
    v_mov_b32 v21, v40
    v_mov_b32 v27, v41
    v_mov_b32 v31, v42
    v_mov_b32 v39, v43
    v_mov_b32 v44, v43
    s_cmp_gt_u32 s37, 1024
    s_cbranch_scc1 L2_xs6
    s_cmp_lg_u32 s101, 0
    s_cbranch_scc1 L2_xa6
L2_xb6:
    v_lshlrev_b32 v89, 16, v96
    v_add_u32 v90, 60, v97
    v_bitop3_b32 v90, v89, v45, v90 bitop3:0x6a
    ds_write_b32 v98, v90 offset:12
    v_lshlrev_b32 v89, 20, v96
    v_add_u32 v90, 40, v97
    v_bitop3_b32 v90, v89, v45, v90 bitop3:0x6a
    ds_write_b32 v98, v90 offset:8
    v_lshlrev_b32 v89, 24, v96
    v_add_u32 v90, 20, v97
    v_bitop3_b32 v90, v89, v45, v90 bitop3:0x6a
    ds_write_b32 v98, v90 offset:4
    v_lshlrev_b32 v89, 28, v96
    v_bitop3_b32 v90, v89, v45, v97 bitop3:0x6a
    ds_write_b32 v98, v90 offset:0
    v_mov_b32_dpp v91, v66 quad_perm:[0,0,0,0] row_mask:0xf bank_mask:0xf
    v_and_b32 v89, 3, v91
    v_and_b32 v97, 0xfffc, v91
    v_sub_u16_dpp v88, v66, v91 quad_perm:[2,2,2,2] row_mask:0xf bank_mask:0xf
    v_mad_u32_u24 v97, v97, 5, v4
    v_add_u32 v99, v88, v89
    v_bfm_b32 v96, v88, v89
    v_cmp_lt_u32 s[58:59], 16, v99
    v_lshlrev_b32 v89, v1, v96
    v_and_b32 v89, v45, v89
    v_cmp_ne_u32 vcc, 0, v89
    v_xor_b32 v90, v97, v89
    s_add_u32 s3, s37, s38
    v_mbcnt_lo_u32_b32 v98, vcc_lo, 0
    v_mbcnt_hi_u32_b32 v98, vcc_hi, v98
    s_bcnt1_i32_b64 s41, vcc
    v_lshl_add_u32 v98, v98, 2, s3
    s_mov_b64 exec, vcc
    ds_write_b32 v98, v90
    s_mov_b64 exec, -1
    s_lshl2_add_u32 s37, s41, s37
    s_cmp_lg_u64 s[58:59], 0
    s_cbranch_scc1 L2_xe6
L2_xr6:
    v_add_u32 v98, s37, v0
    v_mov_b32 v90, -1
    ds_write_b32 v98, v90
    v_add_u32 v98, s38, v0
    ds_read2st64_b32 v[40:41], v0 offset0:0 offset1:1
    ds_read_b32 v43, v0 offset:512
    v_lshrrev_b32 v98, 1, v98
    v_and_b32 v98, -4, v98
    ds_read_b32 v42, v98 offset:768
    s_sub_u32 s3, s37, 768
    s_cmp_gt_u32 s3, 128
    s_cbranch_scc1 L2_xf6
L2_xg6:
    v_subrev_u32 v88, s38, v3
    ds_write_b128 v88, v[124:127] offset:34816
    v_subrev_u32 v88, s38, v3
    ds_write_b128 v88, v[116:119] offset:32768
    v_subrev_u32 v88, s38, v3
    ds_write_b128 v88, v[120:123] offset:33792
    v_subrev_u32 v88, s100, v3
    ds_write_b128 v88, v[108:111] offset:0
    v_subrev_u32 v88, s100, v3
    ds_write_b128 v88, v[112:115] offset:1024
    s_cmp_eq_u32 s56, 0
    s_cbranch_scc1 L2_e2
    s_mov_b32 exec_lo, s56
    s_mov_b32 exec_hi, 0
    buffer_load_dword v88, v7, s[60:63], 0 offen sc1
    s_mov_b64 exec, -1
    s_waitcnt vmcnt(0)
    v_cmp_gt_u32 vcc, 2, v88
    s_and_b32 s56, vcc_lo, s56
    s_cbranch_scc0 L2_e2
    s_mul_i32 s3, s33, 1280000
    s_add_u32 s3, s3, s100
    s_add_u32 s3, s3, 352768
    buffer_load_dwordx4 v[124:127], v94, s[24:27], s3 offen offset:2048
    s_mul_i32 s3, s33, 1280000
    s_add_u32 s3, s3, s100
    s_add_u32 s3, s3, 352768
    buffer_load_dwordx4 v[116:119], v94, s[24:27], s3 offen offset:0
    s_mul_i32 s3, s33, 1280000
    s_add_u32 s3, s3, s100
    s_add_u32 s3, s3, 352768
    buffer_load_dwordx4 v[120:123], v94, s[24:27], s3 offen offset:1024
    s_mul_i32 s3, s33, 1280000
    s_add_u32 s3, s3, s38
    s_add_u32 s3, s3, 320000
    buffer_load_dwordx4 v[108:111], v94, s[24:27], s3 offen offset:0
    s_mul_i32 s3, s33, 1280000
    s_add_u32 s3, s3, s38
    s_add_u32 s3, s3, 320000
    buffer_load_dwordx4 v[112:115], v94, s[24:27], s3 offen offset:1024
    s_mov_b32 exec_lo, s56
    s_mov_b32 exec_hi, 0
L2_p2:
    buffer_load_dword v88, v7, s[60:63], 0 offen sc1
    s_waitcnt vmcnt(0)
    v_cmpx_gt_u32 vcc, 2, v88
    s_cbranch_vccnz L2_p2s
    s_mov_b64 exec, -1
L2_e2:
    s_mov_b32 s6, 0xaaaaaaaa
    s_mov_b32 s7, 0xaaaaaaaa
    v_and_b32 v47, 0x0fffffff, v21
    buffer_load_dwordx2 v[16:17], v47, s[8:11], 0 offen
    buffer_load_dwordx3 v[18:20], v47, s[8:11], 0 offen offset:8
    s_setprio 1
    v_and_b32 v47, 0x0fffffff, v27
    buffer_load_dwordx2 v[22:23], v47, s[8:11], 0 offen
    buffer_load_dwordx3 v[24:26], v47, s[8:11], 0 offen offset:8
    s_waitcnt lgkmcnt(0)
    s_barrier
    s_bitcmp1_b32 s36, s42
    s_cbranch_scc1 L2_slow
L2_ret0:
    s_setprio 3
    s_bitcmp1_b32 s43, s42
    s_cbranch_scc1 L2_oa7
L2_ob7:
    s_bitcmp1_b32 s43, s42
    s_cbranch_scc1 L2_oa8
L2_ob8:
    s_waitcnt vmcnt(2)
    v_and_b32 v46, 0x20000000, v21
    v_lshrrev_b32 v47, 14, v17
    v_bitop3_b32 v47, v47, v5, v46 bitop3:0xea
    ds_read_b64 v[102:103], v47
    v_bitop3_b32 v93, v17, v5, v46 bitop3:0xea
    v_and_b32 v46, 0x10000000, v21
    v_lshrrev_b32 v47, 14, v16
    v_bitop3_b32 v47, v47, v5, v46 bitop3:0xea
    ds_read_b64 v[100:101], v47
    v_bitop3_b32 v92, v16, v5, v46 bitop3:0xea
    v_perm_b32 v15, v17, v20, s45
    v_bitop3_b32 v46, v17, 0.5, -0.5 bitop3:0xa8
    v_perm_b32 v14, v16, v20, s44
    v_bitop3_b32 v47, v16, 0.5, -0.5 bitop3:0xa8
    v_bitop3_b32 v15, v6, v15, v46 bitop3:0xca
    v_bitop3_b32 v14, v6, v14, v47 bitop3:0xca
    s_waitcnt lgkmcnt(0)
    v_mfma_f32_4x4x4_16b_bf16 v[80:83], v[8:9], v[102:103], 0
    v_mfma_f32_4x4x4_16b_bf16 v[76:79], v[8:9], v[100:101], 0
    v_cmp_lt_u32 s[84:85], v5, v92
    s_nop 2
    v_pk_mul_f32 v[80:81], v[80:81], v[14:15] op_sel:[0,1] op_sel_hi:[1,1]
    v_pk_mul_f32 v[82:83], v[82:83], v[14:15] op_sel:[0,1] op_sel_hi:[1,1]
    v_pk_mul_f32 v[76:77], v[76:77], v[14:15] op_sel:[0,0] op_sel_hi:[1,0]
    v_pk_mul_f32 v[78:79], v[78:79], v[14:15] op_sel:[0,0] op_sel_hi:[1,0]
    v_and_b32 v47, 0x0fffffff, v39
    buffer_load_dwordx2 v[34:35], v47, s[8:11], 0 offen
    buffer_load_dwordx3 v[36:38], v47, s[8:11], 0 offen offset:8
    v_and_b32 v46, 0x80000000, v21
    v_lshrrev_b32 v47, 14, v19
    v_bitop3_b32 v47, v47, v5, v46 bitop3:0xea
    ds_read_b64 v[106:107], v47
    v_and_b32 v99, 0x40000000, v21
    v_lshrrev_b32 v47, 14, v18
    v_bitop3_b32 v47, v47, v5, v99 bitop3:0xea
    ds_read_b64 v[104:105], v47
    v_cmp_ne_u64 s[50:51], v[72:73], v[68:69]
    v_cmpx_ne_u64 s[54:55], v[74:75], v[70:71]
    s_and_b64 s[82:83], s[54:55], s[80:81]
    s_cbranch_scc1 L2_c9
L2_d9:
    v_mov_b64 v[84:85], v[70:71]
    v_mov_b32 v7, v95
    v_mov_b64 v[86:87], v[74:75]
    s_or_b64 s[80:81], s[80:81], s[54:55]
    s_mov_b64 exec, s[50:51]
    s_and_b64 s[82:83], s[50:51], s[80:81]
    s_cbranch_scc1 L2_c10
L2_d10:
    v_mov_b64 v[84:85], v[68:69]
    v_mov_b32 v7, v94
    v_mov_b64 v[86:87], v[72:73]
    s_mov_b64 exec, -1
    s_or_b64 s[80:81], s[80:81], s[50:51]
    s_and_b64 exec, s[84:85], s[80:81]
    v_mfma_f32_4x4x4_16b_bf16 v[76:79], v[12:13], v[84:85], 0
    v_mov_b32 v92, v7
    s_andn2_b64 s[80:81], s[80:81], s[84:85]
    v_mfma_f32_4x4x4_16b_bf16 v[76:79], v[10:11], v[86:87], v[76:79]
    s_mov_b64 exec, -1
    ds_read_b64 v[70:71], v93 offset:65408
    ds_read_b64 v[68:69], v92 offset:65408
    v_bitop3_b32 v94, v18, v5, v99 bitop3:0xea
    v_bitop3_b32 v95, v19, v5, v46 bitop3:0xea
    v_perm_b32 v15, v19, v20, s47
    v_bitop3_b32 v46, v19, 0.5, -0.5 bitop3:0xa8
    v_perm_b32 v14, v18, v20, s46
    v_bitop3_b32 v47, v18, 0.5, -0.5 bitop3:0xa8
    v_bitop3_b32 v15, v6, v15, v46 bitop3:0xca
    v_bitop3_b32 v14, v6, v14, v47 bitop3:0xca
    s_waitcnt lgkmcnt(1)
    v_mfma_f32_4x4x4_16b_bf16 v[80:83], v[10:11], v[70:71], v[80:83]
    s_waitcnt lgkmcnt(0)
    v_mfma_f32_4x4x4_16b_bf16 v[76:79], v[10:11], v[68:69], v[76:79]
    s_nop 2
    v_cvt_pk_bf16_f32 v80, v80, v81
    v_cvt_pk_bf16_f32 v81, v82, v83
    ds_wrxchg_rtn_b64 v[74:75], v93, v[80:81] offset:65408
    v_cvt_pk_bf16_f32 v76, v76, v77
    v_cvt_pk_bf16_f32 v77, v78, v79
    ds_wrxchg_rtn_b64 v[72:73], v92, v[76:77] offset:65408
    s_setprio 2
    v_mfma_f32_4x4x4_16b_bf16 v[80:83], v[8:9], v[106:107], 0
    v_mfma_f32_4x4x4_16b_bf16 v[76:79], v[8:9], v[104:105], 0
    v_cmp_lt_u32 s[48:49], v5, v95
    s_nop 2
    v_pk_mul_f32 v[80:81], v[80:81], v[14:15] op_sel:[0,1] op_sel_hi:[1,1]
    v_pk_mul_f32 v[82:83], v[82:83], v[14:15] op_sel:[0,1] op_sel_hi:[1,1]
    v_pk_mul_f32 v[76:77], v[76:77], v[14:15] op_sel:[0,0] op_sel_hi:[1,0]
    v_pk_mul_f32 v[78:79], v[78:79], v[14:15] op_sel:[0,0] op_sel_hi:[1,0]
    v_and_b32 v47, 0x0fffffff, v31
    buffer_load_dword v30, v47, s[8:11], 0 offen offset:16
    s_mov_b64 exec, s[6:7]
    v_add_u32 v47, 8, v47
    v_lshrrev_b32 v31, 2, v31
    s_mov_b64 exec, -1
    buffer_load_dwordx2 v[28:29], v47, s[8:11], 0 offen
    v_and_b32 v47, 0x3f0, v3
    s_cmp_lg_u32 s56, 0
    s_cbranch_scc1 L2_m11
    s_mul_i32 s3, s33, 1280000
    s_add_u32 s3, s3, s100
    s_add_u32 s3, s3, 352768
    buffer_load_dwordx4 v[124:127], v47, s[24:27], s3 offen offset:2048
L2_m11:
    v_and_b32 v47, 0x3f0, v3
    s_cmp_lg_u32 s56, 0
    s_cbranch_scc1 L2_m12
    s_mul_i32 s3, s33, 1280000
    s_add_u32 s3, s3, s100
    s_add_u32 s3, s3, 352768
    buffer_load_dwordx4 v[116:119], v47, s[24:27], s3 offen offset:0
L2_m12:
    s_waitcnt vmcnt(4)
    v_and_b32 v46, 0x20000000, v27
    v_lshrrev_b32 v47, 14, v23
    v_bitop3_b32 v47, v47, v5, v46 bitop3:0xea
    ds_read_b64 v[102:103], v47
    v_and_b32 v99, 0x10000000, v27
    v_lshrrev_b32 v47, 14, v22
    v_bitop3_b32 v47, v47, v5, v99 bitop3:0xea
    ds_read_b64 v[100:101], v47
    s_waitcnt lgkmcnt(2)
    v_cmp_ne_u64 s[50:51], v[72:73], v[68:69]
    v_cmpx_ne_u64 s[54:55], v[74:75], v[70:71]
    s_and_b64 s[82:83], s[54:55], s[80:81]
    s_cbranch_scc1 L2_c13
L2_d13:
    v_mov_b64 v[84:85], v[70:71]
    v_mov_b32 v7, v93
    v_mov_b64 v[86:87], v[74:75]
    s_or_b64 s[80:81], s[80:81], s[54:55]
    s_mov_b64 exec, s[50:51]
    s_and_b64 s[82:83], s[50:51], s[80:81]
    s_cbranch_scc1 L2_c14
L2_d14:
    v_mov_b64 v[84:85], v[68:69]
    v_mov_b32 v7, v92
    v_mov_b64 v[86:87], v[72:73]
    s_mov_b64 exec, -1
    s_or_b64 s[80:81], s[80:81], s[50:51]
    s_and_b64 exec, s[48:49], s[80:81]
    v_mfma_f32_4x4x4_16b_bf16 v[80:83], v[12:13], v[84:85], 0
    v_mov_b32 v95, v7
    s_andn2_b64 s[80:81], s[80:81], s[48:49]
    v_mfma_f32_4x4x4_16b_bf16 v[80:83], v[10:11], v[86:87], v[80:83]
    s_mov_b64 exec, -1
    ds_read_b64 v[70:71], v95 offset:65408
    ds_read_b64 v[68:69], v94 offset:65408
    v_bitop3_b32 v92, v22, v5, v99 bitop3:0xea
    v_bitop3_b32 v93, v23, v5, v46 bitop3:0xea
    v_perm_b32 v15, v23, v26, s45
    v_bitop3_b32 v46, v23, 0.5, -0.5 bitop3:0xa8
    v_perm_b32 v14, v22, v26, s44
    v_bitop3_b32 v47, v22, 0.5, -0.5 bitop3:0xa8
    v_bitop3_b32 v15, v6, v15, v46 bitop3:0xca
    v_bitop3_b32 v14, v6, v14, v47 bitop3:0xca
    s_waitcnt lgkmcnt(1)
    v_mfma_f32_4x4x4_16b_bf16 v[80:83], v[10:11], v[70:71], v[80:83]
    s_waitcnt lgkmcnt(0)
    v_mfma_f32_4x4x4_16b_bf16 v[76:79], v[10:11], v[68:69], v[76:79]
    s_nop 2
    v_cvt_pk_bf16_f32 v80, v80, v81
    v_cvt_pk_bf16_f32 v81, v82, v83
    ds_wrxchg_rtn_b64 v[74:75], v95, v[80:81] offset:65408
    v_cvt_pk_bf16_f32 v76, v76, v77
    v_cvt_pk_bf16_f32 v77, v78, v79
    ds_wrxchg_rtn_b64 v[72:73], v94, v[76:77] offset:65408
    s_setprio 1
    v_mfma_f32_4x4x4_16b_bf16 v[80:83], v[8:9], v[102:103], 0
    v_mfma_f32_4x4x4_16b_bf16 v[76:79], v[8:9], v[100:101], 0
    s_nop 3
    v_pk_mul_f32 v[80:81], v[80:81], v[14:15] op_sel:[0,1] op_sel_hi:[1,1]
    v_pk_mul_f32 v[82:83], v[82:83], v[14:15] op_sel:[0,1] op_sel_hi:[1,1]
    v_pk_mul_f32 v[76:77], v[76:77], v[14:15] op_sel:[0,0] op_sel_hi:[1,0]
    v_pk_mul_f32 v[78:79], v[78:79], v[14:15] op_sel:[0,0] op_sel_hi:[1,0]
    v_and_b32 v47, 0x3f0, v3
    s_cmp_lg_u32 s56, 0
    s_cbranch_scc1 L2_m15
    s_mul_i32 s3, s33, 1280000
    s_add_u32 s3, s3, s100
    s_add_u32 s3, s3, 352768
    buffer_load_dwordx4 v[120:123], v47, s[24:27], s3 offen offset:1024
L2_m15:
    v_sub_u16 v88, v60, v52
    v_and_b32 v89, 3, v52
    v_add3_u32 v99, v88, v89, 3
    v_and_b32 v99, -4, v99
    v_max_u32 v99, 4, v99
    v_and_b32 v97, 0xfffc, v52
    v_bfm_b32 v96, v88, v89
    v_add_u32_dpp v91, v99, v99 row_shr:1 row_mask:0xf bank_mask:0xf bound_ctrl:1
    v_mad_u32_u24 v97, v97, 5, v2
    v_cmp_lt_u32 vcc, 16, v99
    v_add_u32_dpp v91, v91, v91 row_shr:2 row_mask:0xf bank_mask:0xf bound_ctrl:1
    v_sub_u32 v98, s38, v99
    v_lshrrev_b64 v[52:53], 16, v[52:53]
    v_add_u32_dpp v91, v91, v91 row_shr:4 row_mask:0xf bank_mask:0xf bound_ctrl:1
    v_lshrrev_b64 v[60:61], 16, v[60:61]
    s_mov_b32 s101, 0
    v_add_u32_dpp v91, v91, v91 row_shr:8 row_mask:0xf bank_mask:0xf bound_ctrl:1
    s_nop 1
    v_add_u32_dpp v91, v91, v91 row_bcast:15 row_mask:0xa bank_mask:0xf
    s_nop 1
    v_add_u32_dpp v91, v91, v91 row_bcast:31 row_mask:0xc bank_mask:0xf
    v_add_u32 v98, v98, v91
    v_readlane_b32 s37, v91, 63
    s_cbranch_vccnz L2_xo16
L2_xp16:
    v_and_b32 v46, 0x80000000, v27
    v_lshrrev_b32 v47, 14, v25
    v_bitop3_b32 v47, v47, v5, v46 bitop3:0xea
    ds_read_b64 v[106:107], v47
    v_and_b32 v99, 0x40000000, v27
    v_lshrrev_b32 v47, 14, v24
    v_bitop3_b32 v47, v47, v5, v99 bitop3:0xea
    ds_read_b64 v[104:105], v47
    s_waitcnt lgkmcnt(2)
    v_cmp_ne_u64 s[50:51], v[72:73], v[68:69]
    v_cmpx_ne_u64 s[54:55], v[74:75], v[70:71]
    s_and_b64 s[82:83], s[54:55], s[80:81]
    s_cbranch_scc1 L2_c17
L2_d17:
    v_mov_b64 v[84:85], v[70:71]
    v_mov_b32 v7, v95
    v_mov_b64 v[86:87], v[74:75]
    s_or_b64 s[80:81], s[80:81], s[54:55]
    s_mov_b64 exec, s[50:51]
    s_and_b64 s[82:83], s[50:51], s[80:81]
    s_cbranch_scc1 L2_c18
L2_d18:
    v_mov_b64 v[84:85], v[68:69]
    v_mov_b32 v7, v94
    v_mov_b64 v[86:87], v[72:73]
    s_mov_b64 exec, -1
    s_or_b64 s[80:81], s[80:81], s[50:51]
    ds_read_b64 v[70:71], v93 offset:65408
    ds_read_b64 v[68:69], v92 offset:65408
    v_bitop3_b32 v94, v24, v5, v99 bitop3:0xea
    v_bitop3_b32 v95, v25, v5, v46 bitop3:0xea
    v_perm_b32 v15, v25, v26, s47
    v_bitop3_b32 v46, v25, 0.5, -0.5 bitop3:0xa8
    v_perm_b32 v14, v24, v26, s46
    v_bitop3_b32 v47, v24, 0.5, -0.5 bitop3:0xa8
    v_bitop3_b32 v15, v6, v15, v46 bitop3:0xca
    v_bitop3_b32 v14, v6, v14, v47 bitop3:0xca
    s_waitcnt lgkmcnt(1)
    v_mfma_f32_4x4x4_16b_bf16 v[80:83], v[10:11], v[70:71], v[80:83]
    s_waitcnt lgkmcnt(0)
    v_mfma_f32_4x4x4_16b_bf16 v[76:79], v[10:11], v[68:69], v[76:79]
    s_nop 2
    v_cvt_pk_bf16_f32 v80, v80, v81
    v_cvt_pk_bf16_f32 v81, v82, v83
    ds_wrxchg_rtn_b64 v[74:75], v93, v[80:81] offset:65408
    v_cvt_pk_bf16_f32 v76, v76, v77
    v_cvt_pk_bf16_f32 v77, v78, v79
    ds_wrxchg_rtn_b64 v[72:73], v92, v[76:77] offset:65408
    v_mfma_f32_4x4x4_16b_bf16 v[80:83], v[8:9], v[106:107], 0
    v_mfma_f32_4x4x4_16b_bf16 v[76:79], v[8:9], v[104:105], 0
    v_cmp_lt_u32 s[84:85], v5, v94
    s_nop 2
    v_pk_mul_f32 v[80:81], v[80:81], v[14:15] op_sel:[0,1] op_sel_hi:[1,1]
    v_pk_mul_f32 v[82:83], v[82:83], v[14:15] op_sel:[0,1] op_sel_hi:[1,1]
    v_pk_mul_f32 v[76:77], v[76:77], v[14:15] op_sel:[0,0] op_sel_hi:[1,0]
    v_pk_mul_f32 v[78:79], v[78:79], v[14:15] op_sel:[0,0] op_sel_hi:[1,0]
    v_and_b32 v47, 0x3f0, v3
    s_cmp_lg_u32 s56, 0
    s_cbranch_scc1 L2_m19
    s_mul_i32 s3, s33, 1280000
    s_add_u32 s3, s3, s38
    s_add_u32 s3, s3, 320000
    buffer_load_dwordx4 v[108:111], v47, s[24:27], s3 offen offset:0
L2_m19:
    v_and_b32 v47, 0x3f0, v3
    s_cmp_lg_u32 s56, 0
    s_cbranch_scc1 L2_m20
    s_mul_i32 s3, s33, 1280000
    s_add_u32 s3, s3, s38
    s_add_u32 s3, s3, 320000
    buffer_load_dwordx4 v[112:115], v47, s[24:27], s3 offen offset:1024
L2_m20:
    v_and_b32 v47, 0x0fffffff, v40
    v_mov_b32 v21, v40
    buffer_load_dwordx2 v[16:17], v47, s[8:11], 0 offen
    buffer_load_dwordx3 v[18:20], v47, s[8:11], 0 offen offset:8
    s_waitcnt vmcnt(2)
    s_mov_b64 exec, s[6:7]
    v_lshrrev_b32 v30, 16, v30
    s_mov_b64 exec, -1
    v_and_b32 v46, 0x20000000, v31
    v_lshrrev_b32 v47, 14, v29
    v_bitop3_b32 v47, v47, v5, v46 bitop3:0xea
    ds_read_b64 v[102:103], v47
    v_and_b32 v99, 0x10000000, v31
    v_lshrrev_b32 v47, 14, v28
    v_bitop3_b32 v47, v47, v5, v99 bitop3:0xea
    ds_read_b64 v[100:101], v47
    s_waitcnt lgkmcnt(2)
    v_cmp_ne_u64 s[50:51], v[72:73], v[68:69]
    v_cmpx_ne_u64 s[54:55], v[74:75], v[70:71]
    s_and_b64 s[82:83], s[54:55], s[80:81]
    s_cbranch_scc1 L2_c21
L2_d21:
    v_mov_b64 v[84:85], v[70:71]
    v_mov_b32 v7, v93
    v_mov_b64 v[86:87], v[74:75]
    s_or_b64 s[80:81], s[80:81], s[54:55]
    s_mov_b64 exec, s[50:51]
    s_and_b64 s[82:83], s[50:51], s[80:81]
    s_cbranch_scc1 L2_c22
L2_d22:
    v_mov_b64 v[84:85], v[68:69]
    v_mov_b32 v7, v92
    v_mov_b64 v[86:87], v[72:73]
    s_mov_b64 exec, -1
    s_or_b64 s[80:81], s[80:81], s[50:51]
    s_and_b64 exec, s[84:85], s[80:81]
    v_mfma_f32_4x4x4_16b_bf16 v[76:79], v[12:13], v[84:85], 0
    v_mov_b32 v94, v7
    s_andn2_b64 s[80:81], s[80:81], s[84:85]
    v_mfma_f32_4x4x4_16b_bf16 v[76:79], v[10:11], v[86:87], v[76:79]
    s_mov_b64 exec, -1
    ds_read_b64 v[70:71], v95 offset:65408
    ds_read_b64 v[68:69], v94 offset:65408
    v_bitop3_b32 v92, v28, v5, v99 bitop3:0xea
    v_bitop3_b32 v93, v29, v5, v46 bitop3:0xea
    v_perm_b32 v15, v29, v30, s45
    v_bitop3_b32 v46, v29, 0.5, -0.5 bitop3:0xa8
    v_perm_b32 v14, v28, v30, s44
    v_bitop3_b32 v47, v28, 0.5, -0.5 bitop3:0xa8
    v_bitop3_b32 v15, v6, v15, v46 bitop3:0xca
    v_bitop3_b32 v14, v6, v14, v47 bitop3:0xca
    s_waitcnt lgkmcnt(1)
    v_mfma_f32_4x4x4_16b_bf16 v[80:83], v[10:11], v[70:71], v[80:83]
    s_waitcnt lgkmcnt(0)
    v_mfma_f32_4x4x4_16b_bf16 v[76:79], v[10:11], v[68:69], v[76:79]
    s_nop 2
    v_cvt_pk_bf16_f32 v80, v80, v81
    v_cvt_pk_bf16_f32 v81, v82, v83
    ds_wrxchg_rtn_b64 v[74:75], v95, v[80:81] offset:65408
    v_cvt_pk_bf16_f32 v76, v76, v77
    v_cvt_pk_bf16_f32 v77, v78, v79
    ds_wrxchg_rtn_b64 v[72:73], v94, v[76:77] offset:65408
    s_setprio 0
    v_mfma_f32_4x4x4_16b_bf16 v[80:83], v[8:9], v[102:103], 0
    v_mfma_f32_4x4x4_16b_bf16 v[76:79], v[8:9], v[100:101], 0
    v_cmp_lt_u32 s[48:49], v5, v93
    s_nop 2
    v_pk_mul_f32 v[80:81], v[80:81], v[14:15] op_sel:[0,1] op_sel_hi:[1,1]
    v_pk_mul_f32 v[82:83], v[82:83], v[14:15] op_sel:[0,1] op_sel_hi:[1,1]
    v_pk_mul_f32 v[76:77], v[76:77], v[14:15] op_sel:[0,0] op_sel_hi:[1,0]
    v_pk_mul_f32 v[78:79], v[78:79], v[14:15] op_sel:[0,0] op_sel_hi:[1,0]
    s_add_u32 s40, s40, 0x50000
    v_and_b32 v47, 0x0fffffff, v41
    v_mov_b32 v27, v41
    buffer_load_dwordx2 v[22:23], v47, s[8:11], 0 offen
    buffer_load_dwordx3 v[24:26], v47, s[8:11], 0 offen offset:8
    v_and_b32 v46, 0x80000000, v39
    v_lshrrev_b32 v47, 14, v37
    v_bitop3_b32 v47, v47, v5, v46 bitop3:0xea
    ds_read_b64 v[102:103], v47
    v_and_b32 v99, 0x40000000, v39
    v_lshrrev_b32 v47, 14, v36
    v_bitop3_b32 v47, v47, v5, v99 bitop3:0xea
    ds_read_b64 v[100:101], v47
    v_and_b32 v46, 0x20000000, v39
    v_lshrrev_b32 v47, 14, v35
    v_bitop3_b32 v47, v47, v5, v46 bitop3:0xea
    ds_read_b64 v[106:107], v47
    v_and_b32 v99, 0x10000000, v39
    v_lshrrev_b32 v47, 14, v34
    v_bitop3_b32 v47, v47, v5, v99 bitop3:0xea
    ds_read_b64 v[104:105], v47
    s_waitcnt lgkmcnt(4)
    v_cmp_ne_u64 s[50:51], v[72:73], v[68:69]
    v_cmpx_ne_u64 s[54:55], v[74:75], v[70:71]
    s_and_b64 s[82:83], s[54:55], s[80:81]
    s_cbranch_scc1 L2_c23
L2_d23:
    v_mov_b64 v[84:85], v[70:71]
    v_mov_b32 v7, v95
    v_mov_b64 v[86:87], v[74:75]
    s_or_b64 s[80:81], s[80:81], s[54:55]
    s_mov_b64 exec, s[50:51]
    s_and_b64 s[82:83], s[50:51], s[80:81]
    s_cbranch_scc1 L2_c24
L2_d24:
    v_mov_b64 v[84:85], v[68:69]
    v_mov_b32 v7, v94
    v_mov_b64 v[86:87], v[72:73]
    s_mov_b64 exec, -1
    s_or_b64 s[80:81], s[80:81], s[50:51]
    s_and_b64 exec, s[48:49], s[80:81]
    v_mfma_f32_4x4x4_16b_bf16 v[80:83], v[12:13], v[84:85], 0
    v_mov_b32 v93, v7
    s_andn2_b64 s[80:81], s[80:81], s[48:49]
    v_mfma_f32_4x4x4_16b_bf16 v[80:83], v[10:11], v[86:87], v[80:83]
    s_mov_b64 exec, -1
    ds_read_b64 v[70:71], v93 offset:65408
    ds_read_b64 v[68:69], v92 offset:65408
    v_bitop3_b32 v94, v34, v5, v99 bitop3:0xea
    v_bitop3_b32 v95, v35, v5, v46 bitop3:0xea
    v_perm_b32 v15, v35, v38, s45
    v_bitop3_b32 v46, v35, 0.5, -0.5 bitop3:0xa8
    v_perm_b32 v14, v34, v38, s44
    v_bitop3_b32 v47, v34, 0.5, -0.5 bitop3:0xa8
    v_bitop3_b32 v15, v6, v15, v46 bitop3:0xca
    v_bitop3_b32 v14, v6, v14, v47 bitop3:0xca
    s_waitcnt lgkmcnt(1)
    v_mfma_f32_4x4x4_16b_bf16 v[80:83], v[10:11], v[70:71], v[80:83]
    s_waitcnt lgkmcnt(0)
    v_mfma_f32_4x4x4_16b_bf16 v[76:79], v[10:11], v[68:69], v[76:79]
    s_nop 2
    v_cvt_pk_bf16_f32 v80, v80, v81
    v_cvt_pk_bf16_f32 v81, v82, v83
    ds_wrxchg_rtn_b64 v[74:75], v93, v[80:81] offset:65408
    v_cvt_pk_bf16_f32 v76, v76, v77
    v_cvt_pk_bf16_f32 v77, v78, v79
    ds_wrxchg_rtn_b64 v[72:73], v92, v[76:77] offset:65408
    s_barrier
    s_setprio 3
    s_waitcnt vmcnt(4)
    v_subrev_u32 v88, s38, v3
    ds_write_b128 v88, v[116:119] offset:32768
    buffer_load_dwordx4 v[116:119], v3, s[16:19], s40 offen offset:2048
    s_waitcnt vmcnt(5)
    v_subrev_u32 v88, s38, v3
    ds_write_b128 v88, v[120:123] offset:33792
    buffer_load_dwordx4 v[120:123], v3, s[16:19], s40 offen offset:3072
    v_mfma_f32_4x4x4_16b_bf16 v[80:83], v[8:9], v[106:107], 0
    v_mfma_f32_4x4x4_16b_bf16 v[76:79], v[8:9], v[104:105], 0
    s_nop 3
    v_pk_mul_f32 v[80:81], v[80:81], v[14:15] op_sel:[0,1] op_sel_hi:[1,1]
    v_pk_mul_f32 v[82:83], v[82:83], v[14:15] op_sel:[0,1] op_sel_hi:[1,1]
    v_pk_mul_f32 v[76:77], v[76:77], v[14:15] op_sel:[0,0] op_sel_hi:[1,0]
    v_pk_mul_f32 v[78:79], v[78:79], v[14:15] op_sel:[0,0] op_sel_hi:[1,0]
    v_and_b32 v47, 0x0fffffff, v42
    v_mov_b32 v31, v42
    buffer_load_dword v30, v47, s[8:11], 0 offen offset:16
    s_mov_b64 exec, s[6:7]
    v_add_u32 v47, 8, v47
    v_lshrrev_b32 v31, 2, v31
    s_mov_b64 exec, -1
    buffer_load_dwordx2 v[28:29], v47, s[8:11], 0 offen
    v_mov_b32 v44, v43
    s_cmp_gt_u32 s37, 1024
    s_cbranch_scc1 L2_xs25
    s_cmp_lg_u32 s101, 0
    s_cbranch_scc1 L2_xa25
L2_xb25:
    v_lshlrev_b32 v89, 16, v96
    v_add_u32 v90, 60, v97
    v_bitop3_b32 v90, v89, v45, v90 bitop3:0x6a
    ds_write_b32 v98, v90 offset:12
    v_lshlrev_b32 v89, 20, v96
    v_add_u32 v90, 40, v97
    v_bitop3_b32 v90, v89, v45, v90 bitop3:0x6a
    ds_write_b32 v98, v90 offset:8
    v_lshlrev_b32 v89, 24, v96
    v_add_u32 v90, 20, v97
    v_bitop3_b32 v90, v89, v45, v90 bitop3:0x6a
    ds_write_b32 v98, v90 offset:4
    v_lshlrev_b32 v89, 28, v96
    v_bitop3_b32 v90, v89, v45, v97 bitop3:0x6a
    ds_write_b32 v98, v90 offset:0
    v_mov_b32_dpp v91, v64 quad_perm:[1,1,1,1] row_mask:0xf bank_mask:0xf
    v_and_b32 v89, 3, v91
    v_and_b32 v97, 0xfffc, v91
    v_sub_u16_dpp v88, v64, v91 quad_perm:[3,3,3,3] row_mask:0xf bank_mask:0xf
    v_mad_u32_u24 v97, v97, 5, v4
    v_add_u32 v99, v88, v89
    v_bfm_b32 v96, v88, v89
    v_cmp_lt_u32 s[58:59], 16, v99
    v_lshlrev_b32 v89, v1, v96
    v_and_b32 v89, v45, v89
    v_cmp_ne_u32 vcc, 0, v89
    v_xor_b32 v90, v97, v89
    s_add_u32 s3, s37, s38
    v_mbcnt_lo_u32_b32 v98, vcc_lo, 0
    v_mbcnt_hi_u32_b32 v98, vcc_hi, v98
    s_bcnt1_i32_b64 s41, vcc
    v_lshl_add_u32 v98, v98, 2, s3
    s_mov_b64 exec, vcc
    ds_write_b32 v98, v90
    s_mov_b64 exec, -1
    s_lshl2_add_u32 s37, s41, s37
    s_cmp_lg_u64 s[58:59], 0
    s_cbranch_scc1 L2_xe25
L2_xr25:
    v_add_u32 v98, s37, v0
    v_mov_b32 v90, -1
    ds_write_b32 v98, v90
    v_add_u32 v98, s38, v0
    ds_read2st64_b32 v[40:41], v0 offset0:0 offset1:1
    ds_read_b32 v43, v0 offset:512
    v_lshrrev_b32 v98, 1, v98
    v_and_b32 v98, -4, v98
    ds_read_b32 v42, v98 offset:768
    s_sub_u32 s3, s37, 768
    s_cmp_gt_u32 s3, 128
    s_cbranch_scc1 L2_xf25
L2_xg25:
    s_setprio 2
    s_waitcnt vmcnt(8)
    v_subrev_u32 v88, s38, v3
    ds_write_b128 v88, v[124:127] offset:34816
    s_add_u32 s3, s40, 4096
    buffer_load_dwordx4 v[124:127], v3, s[16:19], s3 offen
    s_waitcnt lgkmcnt(12)
    v_cmp_ne_u64 s[50:51], v[72:73], v[68:69]
    v_cmpx_ne_u64 s[54:55], v[74:75], v[70:71]
    s_and_b64 s[82:83], s[54:55], s[80:81]
    s_cbranch_scc1 L2_c26
L2_d26:
    v_mov_b64 v[84:85], v[70:71]
    v_mov_b32 v7, v93
    v_mov_b64 v[86:87], v[74:75]
    s_or_b64 s[80:81], s[80:81], s[54:55]
    s_mov_b64 exec, s[50:51]
    s_and_b64 s[82:83], s[50:51], s[80:81]
    s_cbranch_scc1 L2_c27
L2_d27:
    v_mov_b64 v[84:85], v[68:69]
    v_mov_b32 v7, v92
    v_mov_b64 v[86:87], v[72:73]
    s_mov_b64 exec, -1
    s_or_b64 s[80:81], s[80:81], s[50:51]
    ds_read_b64 v[70:71], v95 offset:65408
    ds_read_b64 v[68:69], v94 offset:65408
    v_and_b32 v46, 0x40000000, v39
    v_bitop3_b32 v92, v36, v5, v46 bitop3:0xea
    v_and_b32 v46, 0x80000000, v39
    v_bitop3_b32 v93, v37, v5, v46 bitop3:0xea
    v_perm_b32 v15, v37, v38, s47
    v_bitop3_b32 v46, v37, 0.5, -0.5 bitop3:0xa8
    v_perm_b32 v14, v36, v38, s46
    v_bitop3_b32 v47, v36, 0.5, -0.5 bitop3:0xa8
    v_bitop3_b32 v15, v6, v15, v46 bitop3:0xca
    v_bitop3_b32 v14, v6, v14, v47 bitop3:0xca
    s_setprio 1
    s_waitcnt lgkmcnt(1)
    v_mfma_f32_4x4x4_16b_bf16 v[80:83], v[10:11], v[70:71], v[80:83]
    s_waitcnt lgkmcnt(0)
    v_mfma_f32_4x4x4_16b_bf16 v[76:79], v[10:11], v[68:69], v[76:79]
    s_nop 2
    v_cvt_pk_bf16_f32 v80, v80, v81
    v_cvt_pk_bf16_f32 v81, v82, v83
    ds_wrxchg_rtn_b64 v[74:75], v95, v[80:81] offset:65408
    v_cvt_pk_bf16_f32 v76, v76, v77
    v_cvt_pk_bf16_f32 v77, v78, v79
    ds_wrxchg_rtn_b64 v[72:73], v94, v[76:77] offset:65408
    s_setprio 0
    s_waitcnt vmcnt(9)
    v_subrev_u32 v88, s100, v3
    ds_write_b128 v88, v[108:111] offset:0
    s_waitcnt vmcnt(9)
    v_subrev_u32 v88, s100, v3
    ds_write_b128 v88, v[112:115] offset:1024
    v_mfma_f32_4x4x4_16b_bf16 v[80:83], v[8:9], v[102:103], 0
    v_mfma_f32_4x4x4_16b_bf16 v[76:79], v[8:9], v[100:101], 0
    v_cmp_lt_u32 s[84:85], v5, v92
    s_nop 2
    v_pk_mul_f32 v[80:81], v[80:81], v[14:15] op_sel:[0,1] op_sel_hi:[1,1]
    v_pk_mul_f32 v[82:83], v[82:83], v[14:15] op_sel:[0,1] op_sel_hi:[1,1]
    v_pk_mul_f32 v[76:77], v[76:77], v[14:15] op_sel:[0,0] op_sel_hi:[1,0]
    v_pk_mul_f32 v[78:79], v[78:79], v[14:15] op_sel:[0,0] op_sel_hi:[1,0]
    s_add_u32 s42, s42, 1
    s_waitcnt lgkmcnt(0)
    s_add_u32 s24, s30, 0xec45000
    s_addc_u32 s25, s31, 0
    s_mov_b32 s26, 0x100
    s_mov_b32 s27, 0x20000
    s_barrier
    s_bitcmp1_b32 s36, s42
    s_cbranch_scc1 L2_slow
L2_ret1:
    s_setprio 3
    s_bitcmp1_b32 s43, s42
    s_cbranch_scc1 L2_oa28
L2_ob28:
    v_and_b32 v47, 0x0fffffff, v44
    v_mov_b32 v39, v44
    buffer_load_dwordx2 v[34:35], v47, s[8:11], 0 offen
    buffer_load_dwordx3 v[36:38], v47, s[8:11], 0 offen offset:8
    s_waitcnt vmcnt(9)
    v_and_b32 v46, 0x20000000, v21
    v_lshrrev_b32 v47, 14, v17
    v_bitop3_b32 v47, v47, v5, v46 bitop3:0xea
    ds_read_b64 v[106:107], v47
    v_and_b32 v99, 0x10000000, v21
    v_lshrrev_b32 v47, 14, v16
    v_bitop3_b32 v47, v47, v5, v99 bitop3:0xea
    ds_read_b64 v[104:105], v47
    v_cmp_ne_u64 s[50:51], v[72:73], v[68:69]
    v_cmpx_ne_u64 s[54:55], v[74:75], v[70:71]
    s_and_b64 s[82:83], s[54:55], s[80:81]
    s_cbranch_scc1 L2_c29
L2_d29:
    v_mov_b64 v[84:85], v[70:71]
    v_mov_b32 v7, v95
    v_mov_b64 v[86:87], v[74:75]
    s_or_b64 s[80:81], s[80:81], s[54:55]
    s_mov_b64 exec, s[50:51]
    s_and_b64 s[82:83], s[50:51], s[80:81]
    s_cbranch_scc1 L2_c30
L2_d30:
    v_mov_b64 v[84:85], v[68:69]
    v_mov_b32 v7, v94
    v_mov_b64 v[86:87], v[72:73]
    s_mov_b64 exec, -1
    s_or_b64 s[80:81], s[80:81], s[50:51]
    s_and_b64 exec, s[84:85], s[80:81]
    v_mfma_f32_4x4x4_16b_bf16 v[76:79], v[12:13], v[84:85], 0
    v_mov_b32 v92, v7
    s_andn2_b64 s[80:81], s[80:81], s[84:85]
    v_mfma_f32_4x4x4_16b_bf16 v[76:79], v[10:11], v[86:87], v[76:79]
    s_mov_b64 exec, -1
    ds_read_b64 v[70:71], v93 offset:65408
    ds_read_b64 v[68:69], v92 offset:65408
    v_bitop3_b32 v94, v16, v5, v99 bitop3:0xea
    v_bitop3_b32 v95, v17, v5, v46 bitop3:0xea
    v_perm_b32 v15, v17, v20, s45
    v_bitop3_b32 v46, v17, 0.5, -0.5 bitop3:0xa8
    v_perm_b32 v14, v16, v20, s44
    v_bitop3_b32 v47, v16, 0.5, -0.5 bitop3:0xa8
    v_bitop3_b32 v15, v6, v15, v46 bitop3:0xca
    v_bitop3_b32 v14, v6, v14, v47 bitop3:0xca
    s_waitcnt lgkmcnt(1)
    v_mfma_f32_4x4x4_16b_bf16 v[80:83], v[10:11], v[70:71], v[80:83]
    s_waitcnt lgkmcnt(0)
    v_mfma_f32_4x4x4_16b_bf16 v[76:79], v[10:11], v[68:69], v[76:79]
    s_nop 2
    v_cvt_pk_bf16_f32 v80, v80, v81
    v_cvt_pk_bf16_f32 v81, v82, v83
    ds_wrxchg_rtn_b64 v[74:75], v93, v[80:81] offset:65408
    v_cvt_pk_bf16_f32 v76, v76, v77
    v_cvt_pk_bf16_f32 v77, v78, v79
    ds_wrxchg_rtn_b64 v[72:73], v92, v[76:77] offset:65408
    v_mfma_f32_4x4x4_16b_bf16 v[80:83], v[8:9], v[106:107], 0
    v_mfma_f32_4x4x4_16b_bf16 v[76:79], v[8:9], v[104:105], 0
    v_cmp_lt_u32 s[84:85], v5, v94
    s_nop 2
    v_pk_mul_f32 v[80:81], v[80:81], v[14:15] op_sel:[0,1] op_sel_hi:[1,1]
    v_pk_mul_f32 v[82:83], v[82:83], v[14:15] op_sel:[0,1] op_sel_hi:[1,1]
    v_pk_mul_f32 v[76:77], v[76:77], v[14:15] op_sel:[0,0] op_sel_hi:[1,0]
    v_pk_mul_f32 v[78:79], v[78:79], v[14:15] op_sel:[0,0] op_sel_hi:[1,0]
    buffer_load_dwordx4 v[108:111], v3, s[16:19], s40 offen offset:0
    v_and_b32 v46, 0x80000000, v21
    v_lshrrev_b32 v47, 14, v19
    v_bitop3_b32 v47, v47, v5, v46 bitop3:0xea
    ds_read_b64 v[102:103], v47
    v_and_b32 v99, 0x40000000, v21
    v_lshrrev_b32 v47, 14, v18
    v_bitop3_b32 v47, v47, v5, v99 bitop3:0xea
    ds_read_b64 v[100:101], v47
    s_waitcnt lgkmcnt(2)
    v_cmp_ne_u64 s[50:51], v[72:73], v[68:69]
    v_cmpx_ne_u64 s[54:55], v[74:75], v[70:71]
    s_and_b64 s[82:83], s[54:55], s[80:81]
    s_cbranch_scc1 L2_c31
L2_d31:
    v_mov_b64 v[84:85], v[70:71]
    v_mov_b32 v7, v93
    v_mov_b64 v[86:87], v[74:75]
    s_or_b64 s[80:81], s[80:81], s[54:55]
    s_mov_b64 exec, s[50:51]
    s_and_b64 s[82:83], s[50:51], s[80:81]
    s_cbranch_scc1 L2_c32
L2_d32:
    v_mov_b64 v[84:85], v[68:69]
    v_mov_b32 v7, v92
    v_mov_b64 v[86:87], v[72:73]
    s_mov_b64 exec, -1
    s_or_b64 s[80:81], s[80:81], s[50:51]
    s_and_b64 exec, s[84:85], s[80:81]
    v_mfma_f32_4x4x4_16b_bf16 v[76:79], v[12:13], v[84:85], 0
    v_mov_b32 v94, v7
    s_andn2_b64 s[80:81], s[80:81], s[84:85]
    v_mfma_f32_4x4x4_16b_bf16 v[76:79], v[10:11], v[86:87], v[76:79]
    s_mov_b64 exec, -1
    ds_read_b64 v[70:71], v95 offset:65408
    ds_read_b64 v[68:69], v94 offset:65408
    v_bitop3_b32 v92, v18, v5, v99 bitop3:0xea
    v_bitop3_b32 v93, v19, v5, v46 bitop3:0xea
    v_perm_b32 v15, v19, v20, s47
    v_bitop3_b32 v46, v19, 0.5, -0.5 bitop3:0xa8
    v_perm_b32 v14, v18, v20, s46
    v_bitop3_b32 v47, v18, 0.5, -0.5 bitop3:0xa8
    v_bitop3_b32 v15, v6, v15, v46 bitop3:0xca
    v_bitop3_b32 v14, v6, v14, v47 bitop3:0xca
    s_waitcnt lgkmcnt(1)
    v_mfma_f32_4x4x4_16b_bf16 v[80:83], v[10:11], v[70:71], v[80:83]
    s_waitcnt lgkmcnt(0)
    v_mfma_f32_4x4x4_16b_bf16 v[76:79], v[10:11], v[68:69], v[76:79]
    s_nop 2
    v_cvt_pk_bf16_f32 v80, v80, v81
    v_cvt_pk_bf16_f32 v81, v82, v83
    ds_wrxchg_rtn_b64 v[74:75], v95, v[80:81] offset:65408
    v_cvt_pk_bf16_f32 v76, v76, v77
    v_cvt_pk_bf16_f32 v77, v78, v79
    ds_wrxchg_rtn_b64 v[72:73], v94, v[76:77] offset:65408
    s_setprio 2
    v_mfma_f32_4x4x4_16b_bf16 v[80:83], v[8:9], v[102:103], 0
    v_mfma_f32_4x4x4_16b_bf16 v[76:79], v[8:9], v[100:101], 0
    v_cmp_lt_u32 s[48:49], v5, v93
    s_nop 2
    v_pk_mul_f32 v[80:81], v[80:81], v[14:15] op_sel:[0,1] op_sel_hi:[1,1]
    v_pk_mul_f32 v[82:83], v[82:83], v[14:15] op_sel:[0,1] op_sel_hi:[1,1]
    v_pk_mul_f32 v[76:77], v[76:77], v[14:15] op_sel:[0,0] op_sel_hi:[1,0]
    v_pk_mul_f32 v[78:79], v[78:79], v[14:15] op_sel:[0,0] op_sel_hi:[1,0]
    v_and_b32 v47, 0x0fffffff, v40
    v_mov_b32 v21, v40
    buffer_load_dwordx2 v[16:17], v47, s[8:11], 0 offen
    buffer_load_dwordx3 v[18:20], v47, s[8:11], 0 offen offset:8
    s_waitcnt vmcnt(10)
    v_and_b32 v46, 0x20000000, v27
    v_lshrrev_b32 v47, 14, v23
    v_bitop3_b32 v47, v47, v5, v46 bitop3:0xea
    ds_read_b64 v[106:107], v47
    v_and_b32 v99, 0x10000000, v27
    v_lshrrev_b32 v47, 14, v22
    v_bitop3_b32 v47, v47, v5, v99 bitop3:0xea
    ds_read_b64 v[104:105], v47
    s_waitcnt lgkmcnt(2)
    v_cmp_ne_u64 s[50:51], v[72:73], v[68:69]
    v_cmpx_ne_u64 s[54:55], v[74:75], v[70:71]
    s_and_b64 s[82:83], s[54:55], s[80:81]
    s_cbranch_scc1 L2_c33
L2_d33:
    v_mov_b64 v[84:85], v[70:71]
    v_mov_b32 v7, v95
    v_mov_b64 v[86:87], v[74:75]
    s_or_b64 s[80:81], s[80:81], s[54:55]
    s_mov_b64 exec, s[50:51]
    s_and_b64 s[82:83], s[50:51], s[80:81]
    s_cbranch_scc1 L2_c34
L2_d34:
    v_mov_b64 v[84:85], v[68:69]
    v_mov_b32 v7, v94
    v_mov_b64 v[86:87], v[72:73]
    s_mov_b64 exec, -1
    s_or_b64 s[80:81], s[80:81], s[50:51]
    s_and_b64 exec, s[48:49], s[80:81]
    v_mfma_f32_4x4x4_16b_bf16 v[80:83], v[12:13], v[84:85], 0
    v_mov_b32 v93, v7
    s_andn2_b64 s[80:81], s[80:81], s[48:49]
    v_mfma_f32_4x4x4_16b_bf16 v[80:83], v[10:11], v[86:87], v[80:83]
    s_mov_b64 exec, -1
    ds_read_b64 v[70:71], v93 offset:65408
    ds_read_b64 v[68:69], v92 offset:65408
    v_bitop3_b32 v94, v22, v5, v99 bitop3:0xea
    v_bitop3_b32 v95, v23, v5, v46 bitop3:0xea
    v_perm_b32 v15, v23, v26, s45
    v_bitop3_b32 v46, v23, 0.5, -0.5 bitop3:0xa8
    v_perm_b32 v14, v22, v26, s44
    v_bitop3_b32 v47, v22, 0.5, -0.5 bitop3:0xa8
    v_bitop3_b32 v15, v6, v15, v46 bitop3:0xca
    v_bitop3_b32 v14, v6, v14, v47 bitop3:0xca
    s_waitcnt lgkmcnt(1)
    v_mfma_f32_4x4x4_16b_bf16 v[80:83], v[10:11], v[70:71], v[80:83]
    s_waitcnt lgkmcnt(0)
    v_mfma_f32_4x4x4_16b_bf16 v[76:79], v[10:11], v[68:69], v[76:79]
    s_nop 2
    v_cvt_pk_bf16_f32 v80, v80, v81
    v_cvt_pk_bf16_f32 v81, v82, v83
    ds_wrxchg_rtn_b64 v[74:75], v93, v[80:81] offset:65408
    v_cvt_pk_bf16_f32 v76, v76, v77
    v_cvt_pk_bf16_f32 v77, v78, v79
    ds_wrxchg_rtn_b64 v[72:73], v92, v[76:77] offset:65408
    s_setprio 1
    v_mfma_f32_4x4x4_16b_bf16 v[80:83], v[8:9], v[106:107], 0
    v_mfma_f32_4x4x4_16b_bf16 v[76:79], v[8:9], v[104:105], 0
    s_nop 3
    v_pk_mul_f32 v[80:81], v[80:81], v[14:15] op_sel:[0,1] op_sel_hi:[1,1]
    v_pk_mul_f32 v[82:83], v[82:83], v[14:15] op_sel:[0,1] op_sel_hi:[1,1]
    v_pk_mul_f32 v[76:77], v[76:77], v[14:15] op_sel:[0,0] op_sel_hi:[1,0]
    v_pk_mul_f32 v[78:79], v[78:79], v[14:15] op_sel:[0,0] op_sel_hi:[1,0]
    s_bitcmp1_b32 s43, s42
    s_cbranch_scc1 L2_oa35
L2_ob35:
    buffer_load_dwordx4 v[112:115], v3, s[16:19], s40 offen offset:1024
    v_sub_u16 v88, v62, v54
    v_and_b32 v89, 3, v54
    v_add3_u32 v99, v88, v89, 3
    v_and_b32 v99, -4, v99
    v_max_u32 v99, 4, v99
    v_and_b32 v97, 0xfffc, v54
    v_bfm_b32 v96, v88, v89
    v_add_u32_dpp v91, v99, v99 row_shr:1 row_mask:0xf bank_mask:0xf bound_ctrl:1
    v_mad_u32_u24 v97, v97, 5, v2
    v_cmp_lt_u32 vcc, 16, v99
    v_add_u32_dpp v91, v91, v91 row_shr:2 row_mask:0xf bank_mask:0xf bound_ctrl:1
    v_sub_u32 v98, s38, v99
    v_lshrrev_b64 v[54:55], 16, v[54:55]
    v_add_u32_dpp v91, v91, v91 row_shr:4 row_mask:0xf bank_mask:0xf bound_ctrl:1
    v_lshrrev_b64 v[62:63], 16, v[62:63]
    s_mov_b32 s101, 0
    v_add_u32_dpp v91, v91, v91 row_shr:8 row_mask:0xf bank_mask:0xf bound_ctrl:1
    s_nop 1
    v_add_u32_dpp v91, v91, v91 row_bcast:15 row_mask:0xa bank_mask:0xf
    s_nop 1
    v_add_u32_dpp v91, v91, v91 row_bcast:31 row_mask:0xc bank_mask:0xf
    v_add_u32 v98, v98, v91
    v_readlane_b32 s37, v91, 63
    s_cbranch_vccnz L2_xo36
L2_xp36:
    v_and_b32 v46, 0x80000000, v27
    v_lshrrev_b32 v47, 14, v25
    v_bitop3_b32 v47, v47, v5, v46 bitop3:0xea
    ds_read_b64 v[102:103], v47
    v_and_b32 v99, 0x40000000, v27
    v_lshrrev_b32 v47, 14, v24
    v_bitop3_b32 v47, v47, v5, v99 bitop3:0xea
    ds_read_b64 v[100:101], v47
    s_waitcnt lgkmcnt(2)
    v_cmp_ne_u64 s[50:51], v[72:73], v[68:69]
    v_cmpx_ne_u64 s[54:55], v[74:75], v[70:71]
    s_and_b64 s[82:83], s[54:55], s[80:81]
    s_cbranch_scc1 L2_c37
L2_d37:
    v_mov_b64 v[84:85], v[70:71]
    v_mov_b32 v7, v93
    v_mov_b64 v[86:87], v[74:75]
    s_or_b64 s[80:81], s[80:81], s[54:55]
    s_mov_b64 exec, s[50:51]
    s_and_b64 s[82:83], s[50:51], s[80:81]
    s_cbranch_scc1 L2_c38
L2_d38:
    v_mov_b64 v[84:85], v[68:69]
    v_mov_b32 v7, v92
    v_mov_b64 v[86:87], v[72:73]
    s_mov_b64 exec, -1
    s_or_b64 s[80:81], s[80:81], s[50:51]
    ds_read_b64 v[70:71], v95 offset:65408
    ds_read_b64 v[68:69], v94 offset:65408
    v_bitop3_b32 v92, v24, v5, v99 bitop3:0xea
    v_bitop3_b32 v93, v25, v5, v46 bitop3:0xea
    v_perm_b32 v15, v25, v26, s47
    v_bitop3_b32 v46, v25, 0.5, -0.5 bitop3:0xa8
    v_perm_b32 v14, v24, v26, s46
    v_bitop3_b32 v47, v24, 0.5, -0.5 bitop3:0xa8
    v_bitop3_b32 v15, v6, v15, v46 bitop3:0xca
    v_bitop3_b32 v14, v6, v14, v47 bitop3:0xca
    s_waitcnt lgkmcnt(1)
    v_mfma_f32_4x4x4_16b_bf16 v[80:83], v[10:11], v[70:71], v[80:83]
    s_waitcnt lgkmcnt(0)
    v_mfma_f32_4x4x4_16b_bf16 v[76:79], v[10:11], v[68:69], v[76:79]
    s_nop 2
    v_cvt_pk_bf16_f32 v80, v80, v81
    v_cvt_pk_bf16_f32 v81, v82, v83
    ds_wrxchg_rtn_b64 v[74:75], v95, v[80:81] offset:65408
    v_cvt_pk_bf16_f32 v76, v76, v77
    v_cvt_pk_bf16_f32 v77, v78, v79
    ds_wrxchg_rtn_b64 v[72:73], v94, v[76:77] offset:65408
    v_mfma_f32_4x4x4_16b_bf16 v[80:83], v[8:9], v[102:103], 0
    v_mfma_f32_4x4x4_16b_bf16 v[76:79], v[8:9], v[100:101], 0
    v_cmp_lt_u32 s[84:85], v5, v92
    s_nop 2
    v_pk_mul_f32 v[80:81], v[80:81], v[14:15] op_sel:[0,1] op_sel_hi:[1,1]
    v_pk_mul_f32 v[82:83], v[82:83], v[14:15] op_sel:[0,1] op_sel_hi:[1,1]
    v_pk_mul_f32 v[76:77], v[76:77], v[14:15] op_sel:[0,0] op_sel_hi:[1,0]
    v_pk_mul_f32 v[78:79], v[78:79], v[14:15] op_sel:[0,0] op_sel_hi:[1,0]
    v_and_b32 v47, 0x0fffffff, v41
    v_mov_b32 v27, v41
    buffer_load_dwordx2 v[22:23], v47, s[8:11], 0 offen
    buffer_load_dwordx3 v[24:26], v47, s[8:11], 0 offen offset:8
    s_waitcnt vmcnt(9)
    s_mov_b64 exec, s[6:7]
    v_lshrrev_b32 v30, 16, v30
    s_mov_b64 exec, -1
    v_and_b32 v46, 0x20000000, v31
    v_lshrrev_b32 v47, 14, v29
    v_bitop3_b32 v47, v47, v5, v46 bitop3:0xea
    ds_read_b64 v[106:107], v47
    v_and_b32 v99, 0x10000000, v31
    v_lshrrev_b32 v47, 14, v28
    v_bitop3_b32 v47, v47, v5, v99 bitop3:0xea
    ds_read_b64 v[104:105], v47
    s_waitcnt lgkmcnt(2)
    v_cmp_ne_u64 s[50:51], v[72:73], v[68:69]
    v_cmpx_ne_u64 s[54:55], v[74:75], v[70:71]
    s_and_b64 s[82:83], s[54:55], s[80:81]
    s_cbranch_scc1 L2_c39
L2_d39:
    v_mov_b64 v[84:85], v[70:71]
    v_mov_b32 v7, v95
    v_mov_b64 v[86:87], v[74:75]
    s_or_b64 s[80:81], s[80:81], s[54:55]
    s_mov_b64 exec, s[50:51]
    s_and_b64 s[82:83], s[50:51], s[80:81]
    s_cbranch_scc1 L2_c40
L2_d40:
    v_mov_b64 v[84:85], v[68:69]
    v_mov_b32 v7, v94
    v_mov_b64 v[86:87], v[72:73]
    s_mov_b64 exec, -1
    s_or_b64 s[80:81], s[80:81], s[50:51]
    s_and_b64 exec, s[84:85], s[80:81]
    v_mfma_f32_4x4x4_16b_bf16 v[76:79], v[12:13], v[84:85], 0
    v_mov_b32 v92, v7
    s_andn2_b64 s[80:81], s[80:81], s[84:85]
    v_mfma_f32_4x4x4_16b_bf16 v[76:79], v[10:11], v[86:87], v[76:79]
    s_mov_b64 exec, -1
    ds_read_b64 v[70:71], v93 offset:65408
    ds_read_b64 v[68:69], v92 offset:65408
    v_bitop3_b32 v94, v28, v5, v99 bitop3:0xea
    v_bitop3_b32 v95, v29, v5, v46 bitop3:0xea
    v_perm_b32 v15, v29, v30, s45
    v_bitop3_b32 v46, v29, 0.5, -0.5 bitop3:0xa8
    v_perm_b32 v14, v28, v30, s44
    v_bitop3_b32 v47, v28, 0.5, -0.5 bitop3:0xa8
    v_bitop3_b32 v15, v6, v15, v46 bitop3:0xca
    v_bitop3_b32 v14, v6, v14, v47 bitop3:0xca
    s_waitcnt lgkmcnt(1)
    v_mfma_f32_4x4x4_16b_bf16 v[80:83], v[10:11], v[70:71], v[80:83]
    s_waitcnt lgkmcnt(0)
    v_mfma_f32_4x4x4_16b_bf16 v[76:79], v[10:11], v[68:69], v[76:79]
    s_nop 2
    v_cvt_pk_bf16_f32 v80, v80, v81
    v_cvt_pk_bf16_f32 v81, v82, v83
    ds_wrxchg_rtn_b64 v[74:75], v93, v[80:81] offset:65408
    v_cvt_pk_bf16_f32 v76, v76, v77
    v_cvt_pk_bf16_f32 v77, v78, v79
    ds_wrxchg_rtn_b64 v[72:73], v92, v[76:77] offset:65408
    s_setprio 0
    v_mfma_f32_4x4x4_16b_bf16 v[80:83], v[8:9], v[106:107], 0
    v_mfma_f32_4x4x4_16b_bf16 v[76:79], v[8:9], v[104:105], 0
    v_cmp_lt_u32 s[48:49], v5, v95
    s_nop 2
    v_pk_mul_f32 v[80:81], v[80:81], v[14:15] op_sel:[0,1] op_sel_hi:[1,1]
    v_pk_mul_f32 v[82:83], v[82:83], v[14:15] op_sel:[0,1] op_sel_hi:[1,1]
    v_pk_mul_f32 v[76:77], v[76:77], v[14:15] op_sel:[0,0] op_sel_hi:[1,0]
    v_pk_mul_f32 v[78:79], v[78:79], v[14:15] op_sel:[0,0] op_sel_hi:[1,0]
    s_add_u32 s40, s40, 0x50000
    s_waitcnt vmcnt(6)
    v_and_b32 v46, 0x80000000, v39
    v_lshrrev_b32 v47, 14, v37
    v_bitop3_b32 v47, v47, v5, v46 bitop3:0xea
    ds_read_b64 v[106:107], v47
    v_and_b32 v99, 0x40000000, v39
    v_lshrrev_b32 v47, 14, v36
    v_bitop3_b32 v47, v47, v5, v99 bitop3:0xea
    ds_read_b64 v[104:105], v47
    v_and_b32 v46, 0x20000000, v39
    v_lshrrev_b32 v47, 14, v35
    v_bitop3_b32 v47, v47, v5, v46 bitop3:0xea
    ds_read_b64 v[102:103], v47
    v_and_b32 v99, 0x10000000, v39
    v_lshrrev_b32 v47, 14, v34
    v_bitop3_b32 v47, v47, v5, v99 bitop3:0xea
    ds_read_b64 v[100:101], v47
    s_waitcnt lgkmcnt(4)
    v_cmp_ne_u64 s[50:51], v[72:73], v[68:69]
    v_cmpx_ne_u64 s[54:55], v[74:75], v[70:71]
    s_and_b64 s[82:83], s[54:55], s[80:81]
    s_cbranch_scc1 L2_c41
L2_d41:
    v_mov_b64 v[84:85], v[70:71]
    v_mov_b32 v7, v93
    v_mov_b64 v[86:87], v[74:75]
    s_or_b64 s[80:81], s[80:81], s[54:55]
    s_mov_b64 exec, s[50:51]
    s_and_b64 s[82:83], s[50:51], s[80:81]
    s_cbranch_scc1 L2_c42
L2_d42:
    v_mov_b64 v[84:85], v[68:69]
    v_mov_b32 v7, v92
    v_mov_b64 v[86:87], v[72:73]
    s_mov_b64 exec, -1
    s_or_b64 s[80:81], s[80:81], s[50:51]
    s_and_b64 exec, s[48:49], s[80:81]
    v_mfma_f32_4x4x4_16b_bf16 v[80:83], v[12:13], v[84:85], 0
    v_mov_b32 v95, v7
    s_andn2_b64 s[80:81], s[80:81], s[48:49]
    v_mfma_f32_4x4x4_16b_bf16 v[80:83], v[10:11], v[86:87], v[80:83]
    s_mov_b64 exec, -1
    ds_read_b64 v[70:71], v95 offset:65408
    ds_read_b64 v[68:69], v94 offset:65408
    v_bitop3_b32 v92, v34, v5, v99 bitop3:0xea
    v_bitop3_b32 v93, v35, v5, v46 bitop3:0xea
    v_perm_b32 v15, v35, v38, s45
    v_bitop3_b32 v46, v35, 0.5, -0.5 bitop3:0xa8
    v_perm_b32 v14, v34, v38, s44
    v_bitop3_b32 v47, v34, 0.5, -0.5 bitop3:0xa8
    v_bitop3_b32 v15, v6, v15, v46 bitop3:0xca
    v_bitop3_b32 v14, v6, v14, v47 bitop3:0xca
    s_waitcnt lgkmcnt(1)
    v_mfma_f32_4x4x4_16b_bf16 v[80:83], v[10:11], v[70:71], v[80:83]
    s_waitcnt lgkmcnt(0)
    v_mfma_f32_4x4x4_16b_bf16 v[76:79], v[10:11], v[68:69], v[76:79]
    s_nop 2
    v_cvt_pk_bf16_f32 v80, v80, v81
    v_cvt_pk_bf16_f32 v81, v82, v83
    ds_wrxchg_rtn_b64 v[74:75], v95, v[80:81] offset:65408
    v_cvt_pk_bf16_f32 v76, v76, v77
    v_cvt_pk_bf16_f32 v77, v78, v79
    ds_wrxchg_rtn_b64 v[72:73], v94, v[76:77] offset:65408
    s_barrier
    s_setprio 3
    s_mov_b32 m0, s100
    s_nop 0
    ds_write_addtid_b32 v116 offset:32768
    ds_write_addtid_b32 v117 offset:33024
    ds_write_addtid_b32 v118 offset:33280
    ds_write_addtid_b32 v119 offset:33536
    buffer_load_dwordx4 v[116:119], v3, s[16:19], s40 offen offset:2048
    ds_write_addtid_b32 v120 offset:33792
    ds_write_addtid_b32 v121 offset:34048
    ds_write_addtid_b32 v122 offset:34304
    ds_write_addtid_b32 v123 offset:34560
    buffer_load_dwordx4 v[120:123], v3, s[16:19], s40 offen offset:3072
    v_mfma_f32_4x4x4_16b_bf16 v[80:83], v[8:9], v[102:103], 0
    v_mfma_f32_4x4x4_16b_bf16 v[76:79], v[8:9], v[100:101], 0
    s_nop 3
    v_pk_mul_f32 v[80:81], v[80:81], v[14:15] op_sel:[0,1] op_sel_hi:[1,1]
    v_pk_mul_f32 v[82:83], v[82:83], v[14:15] op_sel:[0,1] op_sel_hi:[1,1]
    v_pk_mul_f32 v[76:77], v[76:77], v[14:15] op_sel:[0,0] op_sel_hi:[1,0]
    v_pk_mul_f32 v[78:79], v[78:79], v[14:15] op_sel:[0,0] op_sel_hi:[1,0]
    v_and_b32 v47, 0x0fffffff, v42
    v_mov_b32 v31, v42
    buffer_load_dword v30, v47, s[8:11], 0 offen offset:16
    s_mov_b64 exec, s[6:7]
    v_add_u32 v47, 8, v47
    v_lshrrev_b32 v31, 2, v31
    s_mov_b64 exec, -1
    buffer_load_dwordx2 v[28:29], v47, s[8:11], 0 offen
    v_mov_b32 v44, v43
    s_cmp_gt_u32 s37, 1024
    s_cbranch_scc1 L2_xs43
    s_cmp_lg_u32 s101, 0
    s_cbranch_scc1 L2_xa43
L2_xb43:
    v_lshlrev_b32 v89, 16, v96
    v_add_u32 v90, 60, v97
    v_bitop3_b32 v90, v89, v45, v90 bitop3:0x6a
    ds_write_b32 v98, v90 offset:12
    v_lshlrev_b32 v89, 20, v96
    v_add_u32 v90, 40, v97
    v_bitop3_b32 v90, v89, v45, v90 bitop3:0x6a
    ds_write_b32 v98, v90 offset:8
    v_lshlrev_b32 v89, 24, v96
    v_add_u32 v90, 20, v97
    v_bitop3_b32 v90, v89, v45, v90 bitop3:0x6a
    ds_write_b32 v98, v90 offset:4
    v_lshlrev_b32 v89, 28, v96
    v_bitop3_b32 v90, v89, v45, v97 bitop3:0x6a
    ds_write_b32 v98, v90 offset:0
    v_mov_b32_dpp v91, v66 quad_perm:[1,1,1,1] row_mask:0xf bank_mask:0xf
    v_and_b32 v89, 3, v91
    v_and_b32 v97, 0xfffc, v91
    v_sub_u16_dpp v88, v66, v91 quad_perm:[3,3,3,3] row_mask:0xf bank_mask:0xf
    v_mad_u32_u24 v97, v97, 5, v4
    v_add_u32 v99, v88, v89
    v_bfm_b32 v96, v88, v89
    v_cmp_lt_u32 s[58:59], 16, v99
    v_lshlrev_b32 v89, v1, v96
    v_and_b32 v89, v45, v89
    v_cmp_ne_u32 vcc, 0, v89
    v_xor_b32 v90, v97, v89
    s_add_u32 s3, s37, s38
    v_mbcnt_lo_u32_b32 v98, vcc_lo, 0
    v_mbcnt_hi_u32_b32 v98, vcc_hi, v98
    s_bcnt1_i32_b64 s41, vcc
    v_lshl_add_u32 v98, v98, 2, s3
    s_mov_b64 exec, vcc
    ds_write_b32 v98, v90
    s_mov_b64 exec, -1
    s_lshl2_add_u32 s37, s41, s37
    s_cmp_lg_u64 s[58:59], 0
    s_cbranch_scc1 L2_xe43
L2_xr43:
    v_add_u32 v98, s37, v0
    v_mov_b32 v90, -1
    ds_write_b32 v98, v90
    v_add_u32 v98, s38, v0
    ds_read2st64_b32 v[40:41], v0 offset0:0 offset1:1
    ds_read_b32 v43, v0 offset:512
    v_lshrrev_b32 v98, 1, v98
    v_and_b32 v98, -4, v98
    ds_read_b32 v42, v98 offset:768
    s_sub_u32 s3, s37, 768
    s_cmp_gt_u32 s3, 128
    s_cbranch_scc1 L2_xf43
L2_xg43:
    v_lshrrev_b64 v[64:65], 16, v[64:65]
    v_lshrrev_b64 v[66:67], 16, v[66:67]
    s_setprio 2
    ds_write_addtid_b32 v124 offset:34816
    ds_write_addtid_b32 v125 offset:35072
    ds_write_addtid_b32 v126 offset:35328
    ds_write_addtid_b32 v127 offset:35584
    s_add_u32 s3, s40, 4096
    buffer_load_dwordx4 v[124:127], v3, s[16:19], s3 offen
    s_waitcnt lgkmcnt(14)
    v_cmp_ne_u64 s[50:51], v[72:73], v[68:69]
    v_cmpx_ne_u64 s[54:55], v[74:75], v[70:71]
    s_and_b64 s[82:83], s[54:55], s[80:81]
    s_cbranch_scc1 L2_c44
L2_d44:
    v_mov_b64 v[84:85], v[70:71]
    v_mov_b32 v7, v95
    v_mov_b64 v[86:87], v[74:75]
    s_or_b64 s[80:81], s[80:81], s[54:55]
    s_mov_b64 exec, s[50:51]
    s_and_b64 s[82:83], s[50:51], s[80:81]
    s_cbranch_scc1 L2_c45
L2_d45:
    v_mov_b64 v[84:85], v[68:69]
    v_mov_b32 v7, v94
    v_mov_b64 v[86:87], v[72:73]
    s_mov_b64 exec, -1
    s_or_b64 s[80:81], s[80:81], s[50:51]
    ds_read_b64 v[70:71], v93 offset:65408
    ds_read_b64 v[68:69], v92 offset:65408
    v_and_b32 v46, 0x40000000, v39
    v_bitop3_b32 v94, v36, v5, v46 bitop3:0xea
    v_and_b32 v46, 0x80000000, v39
    v_bitop3_b32 v95, v37, v5, v46 bitop3:0xea
    v_perm_b32 v15, v37, v38, s47
    v_bitop3_b32 v46, v37, 0.5, -0.5 bitop3:0xa8
    v_perm_b32 v14, v36, v38, s46
    v_bitop3_b32 v47, v36, 0.5, -0.5 bitop3:0xa8
    v_bitop3_b32 v15, v6, v15, v46 bitop3:0xca
    v_bitop3_b32 v14, v6, v14, v47 bitop3:0xca
    s_setprio 1
    s_waitcnt lgkmcnt(1)
    v_mfma_f32_4x4x4_16b_bf16 v[80:83], v[10:11], v[70:71], v[80:83]
    s_waitcnt lgkmcnt(0)
    v_mfma_f32_4x4x4_16b_bf16 v[76:79], v[10:11], v[68:69], v[76:79]
    s_nop 2
    v_cvt_pk_bf16_f32 v80, v80, v81
    v_cvt_pk_bf16_f32 v81, v82, v83
    ds_wrxchg_rtn_b64 v[74:75], v93, v[80:81] offset:65408
    v_cvt_pk_bf16_f32 v76, v76, v77
    v_cvt_pk_bf16_f32 v77, v78, v79
    ds_wrxchg_rtn_b64 v[72:73], v92, v[76:77] offset:65408
    v_and_b32 v88, 0x0fffffff, v44
    v_mov_b32 v39, v44
    buffer_load_dwordx2 v[34:35], v88, s[8:11], 0 offen
    buffer_load_dwordx3 v[36:38], v88, s[8:11], 0 offen offset:8
    s_setprio 0
    s_waitcnt vmcnt(12)
    s_mov_b32 m0, s38
    s_nop 0
    ds_write_addtid_b32 v108 offset:0
    ds_write_addtid_b32 v109 offset:256
    ds_write_addtid_b32 v110 offset:512
    ds_write_addtid_b32 v111 offset:768
    s_waitcnt vmcnt(9)
    ds_write_addtid_b32 v112 offset:1024
    ds_write_addtid_b32 v113 offset:1280
    ds_write_addtid_b32 v114 offset:1536
    ds_write_addtid_b32 v115 offset:1792
    v_mfma_f32_4x4x4_16b_bf16 v[80:83], v[8:9], v[106:107], 0
    v_mfma_f32_4x4x4_16b_bf16 v[76:79], v[8:9], v[104:105], 0
    v_cmp_lt_u32 s[84:85], v5, v94
    s_nop 2
    v_pk_mul_f32 v[80:81], v[80:81], v[14:15] op_sel:[0,1] op_sel_hi:[1,1]
    v_pk_mul_f32 v[82:83], v[82:83], v[14:15] op_sel:[0,1] op_sel_hi:[1,1]
    v_pk_mul_f32 v[76:77], v[76:77], v[14:15] op_sel:[0,0] op_sel_hi:[1,0]
    v_pk_mul_f32 v[78:79], v[78:79], v[14:15] op_sel:[0,0] op_sel_hi:[1,0]
    s_add_u32 s42, s42, 1
    s_waitcnt lgkmcnt(0)
L2_loop:
    s_barrier
    s_bitcmp1_b32 s36, s42
    s_cbranch_scc1 L2_slow
L2_ret2:
    s_setprio 3
    s_bitcmp1_b32 s43, s42
    s_cbranch_scc1 L2_oa46
L2_ob46:
    v_and_b32 v46, 0x20000000, v21
    v_lshrrev_b32 v47, 14, v17
    v_bitop3_b32 v47, v47, v5, v46 bitop3:0xea
    ds_read_b64 v[102:103], v47
    v_and_b32 v99, 0x10000000, v21
    v_lshrrev_b32 v47, 14, v16
    v_bitop3_b32 v47, v47, v5, v99 bitop3:0xea
    ds_read_b64 v[100:101], v47
    v_cmp_ne_u64 s[50:51], v[72:73], v[68:69]
    v_cmpx_ne_u64 s[54:55], v[74:75], v[70:71]
    s_and_b64 s[82:83], s[54:55], s[80:81]
    s_cbranch_scc1 L2_c47
L2_d47:
    v_mov_b64 v[84:85], v[70:71]
    v_mov_b32 v7, v93
    v_mov_b64 v[86:87], v[74:75]
    s_or_b64 s[80:81], s[80:81], s[54:55]
    s_mov_b64 exec, s[50:51]
    s_and_b64 s[82:83], s[50:51], s[80:81]
    s_cbranch_scc1 L2_c48
L2_d48:
    v_mov_b64 v[84:85], v[68:69]
    v_mov_b32 v7, v92
    v_mov_b64 v[86:87], v[72:73]
    s_mov_b64 exec, -1
    s_or_b64 s[80:81], s[80:81], s[50:51]
    s_and_b64 exec, s[84:85], s[80:81]
    v_mfma_f32_4x4x4_16b_bf16 v[76:79], v[12:13], v[84:85], 0
    v_mov_b32 v94, v7
    s_andn2_b64 s[80:81], s[80:81], s[84:85]
    v_mfma_f32_4x4x4_16b_bf16 v[76:79], v[10:11], v[86:87], v[76:79]
    s_mov_b64 exec, -1
    ds_read_b64 v[70:71], v95 offset:65408
    ds_read_b64 v[68:69], v94 offset:65408
    v_bitop3_b32 v92, v16, v5, v99 bitop3:0xea
    v_bitop3_b32 v93, v17, v5, v46 bitop3:0xea
    v_perm_b32 v15, v17, v20, s45
    v_bitop3_b32 v46, v17, 0.5, -0.5 bitop3:0xa8
    v_perm_b32 v14, v16, v20, s44
    v_bitop3_b32 v47, v16, 0.5, -0.5 bitop3:0xa8
    v_bitop3_b32 v15, v6, v15, v46 bitop3:0xca
    v_bitop3_b32 v14, v6, v14, v47 bitop3:0xca
    s_waitcnt lgkmcnt(1)
    v_mfma_f32_4x4x4_16b_bf16 v[80:83], v[10:11], v[70:71], v[80:83]
    s_waitcnt lgkmcnt(0)
    v_mfma_f32_4x4x4_16b_bf16 v[76:79], v[10:11], v[68:69], v[76:79]
    s_nop 2
    v_cvt_pk_bf16_f32 v80, v80, v81
    v_cvt_pk_bf16_f32 v81, v82, v83
    ds_wrxchg_rtn_b64 v[74:75], v95, v[80:81] offset:65408
    v_cvt_pk_bf16_f32 v76, v76, v77
    v_cvt_pk_bf16_f32 v77, v78, v79
    ds_wrxchg_rtn_b64 v[72:73], v94, v[76:77] offset:65408
    v_mfma_f32_4x4x4_16b_bf16 v[80:83], v[8:9], v[102:103], 0
    v_mfma_f32_4x4x4_16b_bf16 v[76:79], v[8:9], v[100:101], 0
    v_cmp_lt_u32 s[84:85], v5, v92
    s_nop 2
    v_pk_mul_f32 v[80:81], v[80:81], v[14:15] op_sel:[0,1] op_sel_hi:[1,1]
    v_pk_mul_f32 v[82:83], v[82:83], v[14:15] op_sel:[0,1] op_sel_hi:[1,1]
    v_pk_mul_f32 v[76:77], v[76:77], v[14:15] op_sel:[0,0] op_sel_hi:[1,0]
    v_pk_mul_f32 v[78:79], v[78:79], v[14:15] op_sel:[0,0] op_sel_hi:[1,0]
    buffer_load_dwordx4 v[108:111], v3, s[16:19], s40 offen offset:0
    v_and_b32 v46, 0x80000000, v21
    v_lshrrev_b32 v47, 14, v19
    v_bitop3_b32 v47, v47, v5, v46 bitop3:0xea
    ds_read_b64 v[106:107], v47
    v_and_b32 v99, 0x40000000, v21
    v_lshrrev_b32 v47, 14, v18
    v_bitop3_b32 v47, v47, v5, v99 bitop3:0xea
    ds_read_b64 v[104:105], v47
    s_waitcnt lgkmcnt(2)
    v_cmp_ne_u64 s[50:51], v[72:73], v[68:69]
    v_cmpx_ne_u64 s[54:55], v[74:75], v[70:71]
    s_and_b64 s[82:83], s[54:55], s[80:81]
    s_cbranch_scc1 L2_c49
L2_d49:
    v_mov_b64 v[84:85], v[70:71]
    v_mov_b32 v7, v95
    v_mov_b64 v[86:87], v[74:75]
    s_or_b64 s[80:81], s[80:81], s[54:55]
    s_mov_b64 exec, s[50:51]
    s_and_b64 s[82:83], s[50:51], s[80:81]
    s_cbranch_scc1 L2_c50
L2_d50:
    v_mov_b64 v[84:85], v[68:69]
    v_mov_b32 v7, v94
    v_mov_b64 v[86:87], v[72:73]
    s_mov_b64 exec, -1
    s_or_b64 s[80:81], s[80:81], s[50:51]
    s_and_b64 exec, s[84:85], s[80:81]
    v_mfma_f32_4x4x4_16b_bf16 v[76:79], v[12:13], v[84:85], 0
    v_mov_b32 v92, v7
    s_andn2_b64 s[80:81], s[80:81], s[84:85]
    v_mfma_f32_4x4x4_16b_bf16 v[76:79], v[10:11], v[86:87], v[76:79]
    s_mov_b64 exec, -1
    ds_read_b64 v[70:71], v93 offset:65408
    ds_read_b64 v[68:69], v92 offset:65408
    v_bitop3_b32 v94, v18, v5, v99 bitop3:0xea
    v_bitop3_b32 v95, v19, v5, v46 bitop3:0xea
    v_perm_b32 v15, v19, v20, s47
    v_bitop3_b32 v46, v19, 0.5, -0.5 bitop3:0xa8
    v_perm_b32 v14, v18, v20, s46
    v_bitop3_b32 v47, v18, 0.5, -0.5 bitop3:0xa8
    v_bitop3_b32 v15, v6, v15, v46 bitop3:0xca
    v_bitop3_b32 v14, v6, v14, v47 bitop3:0xca
    s_waitcnt lgkmcnt(1)
    v_mfma_f32_4x4x4_16b_bf16 v[80:83], v[10:11], v[70:71], v[80:83]
    s_waitcnt lgkmcnt(0)
    v_mfma_f32_4x4x4_16b_bf16 v[76:79], v[10:11], v[68:69], v[76:79]
    s_nop 2
    v_cvt_pk_bf16_f32 v80, v80, v81
    v_cvt_pk_bf16_f32 v81, v82, v83
    ds_wrxchg_rtn_b64 v[74:75], v93, v[80:81] offset:65408
    v_cvt_pk_bf16_f32 v76, v76, v77
    v_cvt_pk_bf16_f32 v77, v78, v79
    ds_wrxchg_rtn_b64 v[72:73], v92, v[76:77] offset:65408
    v_and_b32 v88, 0x0fffffff, v40
    v_mov_b32 v21, v40
    buffer_load_dwordx2 v[16:17], v88, s[8:11], 0 offen
    buffer_load_dwordx3 v[18:20], v88, s[8:11], 0 offen offset:8
    s_setprio 2
    v_mfma_f32_4x4x4_16b_bf16 v[80:83], v[8:9], v[106:107], 0
    v_mfma_f32_4x4x4_16b_bf16 v[76:79], v[8:9], v[104:105], 0
    v_cmp_lt_u32 s[48:49], v5, v95
    s_nop 2
    v_pk_mul_f32 v[80:81], v[80:81], v[14:15] op_sel:[0,1] op_sel_hi:[1,1]
    v_pk_mul_f32 v[82:83], v[82:83], v[14:15] op_sel:[0,1] op_sel_hi:[1,1]
    v_pk_mul_f32 v[76:77], v[76:77], v[14:15] op_sel:[0,0] op_sel_hi:[1,0]
    v_pk_mul_f32 v[78:79], v[78:79], v[14:15] op_sel:[0,0] op_sel_hi:[1,0]
    s_waitcnt vmcnt(10)
    v_and_b32 v46, 0x20000000, v27
    v_lshrrev_b32 v47, 14, v23
    v_bitop3_b32 v47, v47, v5, v46 bitop3:0xea
    ds_read_b64 v[102:103], v47
    v_and_b32 v99, 0x10000000, v27
    v_lshrrev_b32 v47, 14, v22
    v_bitop3_b32 v47, v47, v5, v99 bitop3:0xea
    ds_read_b64 v[100:101], v47
    s_waitcnt lgkmcnt(2)
    v_cmp_ne_u64 s[50:51], v[72:73], v[68:69]
    v_cmpx_ne_u64 s[54:55], v[74:75], v[70:71]
    s_and_b64 s[82:83], s[54:55], s[80:81]
    s_cbranch_scc1 L2_c51
L2_d51:
    v_mov_b64 v[84:85], v[70:71]
    v_mov_b32 v7, v93
    v_mov_b64 v[86:87], v[74:75]
    s_or_b64 s[80:81], s[80:81], s[54:55]
    s_mov_b64 exec, s[50:51]
    s_and_b64 s[82:83], s[50:51], s[80:81]
    s_cbranch_scc1 L2_c52
L2_d52:
    v_mov_b64 v[84:85], v[68:69]
    v_mov_b32 v7, v92
    v_mov_b64 v[86:87], v[72:73]
    s_mov_b64 exec, -1
    s_or_b64 s[80:81], s[80:81], s[50:51]
    s_and_b64 exec, s[48:49], s[80:81]
    v_mfma_f32_4x4x4_16b_bf16 v[80:83], v[12:13], v[84:85], 0
    v_mov_b32 v95, v7
    s_andn2_b64 s[80:81], s[80:81], s[48:49]
    v_mfma_f32_4x4x4_16b_bf16 v[80:83], v[10:11], v[86:87], v[80:83]
    s_mov_b64 exec, -1
    ds_read_b64 v[70:71], v95 offset:65408
    ds_read_b64 v[68:69], v94 offset:65408
    v_bitop3_b32 v92, v22, v5, v99 bitop3:0xea
    v_bitop3_b32 v93, v23, v5, v46 bitop3:0xea
    v_perm_b32 v15, v23, v26, s45
    v_bitop3_b32 v46, v23, 0.5, -0.5 bitop3:0xa8
    v_perm_b32 v14, v22, v26, s44
    v_bitop3_b32 v47, v22, 0.5, -0.5 bitop3:0xa8
    v_bitop3_b32 v15, v6, v15, v46 bitop3:0xca
    v_bitop3_b32 v14, v6, v14, v47 bitop3:0xca
    s_waitcnt lgkmcnt(1)
    v_mfma_f32_4x4x4_16b_bf16 v[80:83], v[10:11], v[70:71], v[80:83]
    s_waitcnt lgkmcnt(0)
    v_mfma_f32_4x4x4_16b_bf16 v[76:79], v[10:11], v[68:69], v[76:79]
    s_nop 2
    v_cvt_pk_bf16_f32 v80, v80, v81
    v_cvt_pk_bf16_f32 v81, v82, v83
    ds_wrxchg_rtn_b64 v[74:75], v95, v[80:81] offset:65408
    v_cvt_pk_bf16_f32 v76, v76, v77
    v_cvt_pk_bf16_f32 v77, v78, v79
    ds_wrxchg_rtn_b64 v[72:73], v94, v[76:77] offset:65408
    s_setprio 1
    v_mfma_f32_4x4x4_16b_bf16 v[80:83], v[8:9], v[102:103], 0
    v_mfma_f32_4x4x4_16b_bf16 v[76:79], v[8:9], v[100:101], 0
    s_nop 3
    v_pk_mul_f32 v[80:81], v[80:81], v[14:15] op_sel:[0,1] op_sel_hi:[1,1]
    v_pk_mul_f32 v[82:83], v[82:83], v[14:15] op_sel:[0,1] op_sel_hi:[1,1]
    v_pk_mul_f32 v[76:77], v[76:77], v[14:15] op_sel:[0,0] op_sel_hi:[1,0]
    v_pk_mul_f32 v[78:79], v[78:79], v[14:15] op_sel:[0,0] op_sel_hi:[1,0]
    s_bitcmp1_b32 s43, s42
    s_cbranch_scc1 L2_oa53
L2_ob53:
    buffer_load_dwordx4 v[112:115], v3, s[16:19], s40 offen offset:1024
    v_sub_u16 v88, v56, v48
    v_and_b32 v89, 3, v48
    v_add3_u32 v99, v88, v89, 3
    v_and_b32 v99, -4, v99
    v_max_u32 v99, 4, v99
    v_and_b32 v97, 0xfffc, v48
    v_bfm_b32 v96, v88, v89
    v_add_u32_dpp v91, v99, v99 row_shr:1 row_mask:0xf bank_mask:0xf bound_ctrl:1
    v_mad_u32_u24 v97, v97, 5, v2
    v_cmp_lt_u32 vcc, 16, v99
    v_add_u32_dpp v91, v91, v91 row_shr:2 row_mask:0xf bank_mask:0xf bound_ctrl:1
    v_sub_u32 v98, s38, v99
    v_lshrrev_b64 v[48:49], 16, v[48:49]
    v_add_u32_dpp v91, v91, v91 row_shr:4 row_mask:0xf bank_mask:0xf bound_ctrl:1
    v_lshrrev_b64 v[56:57], 16, v[56:57]
    s_mov_b32 s101, 0
    v_add_u32_dpp v91, v91, v91 row_shr:8 row_mask:0xf bank_mask:0xf bound_ctrl:1
    s_nop 1
    v_add_u32_dpp v91, v91, v91 row_bcast:15 row_mask:0xa bank_mask:0xf
    s_nop 1
    v_add_u32_dpp v91, v91, v91 row_bcast:31 row_mask:0xc bank_mask:0xf
    v_add_u32 v98, v98, v91
    v_readlane_b32 s37, v91, 63
    s_cbranch_vccnz L2_xo54
L2_xp54:
    v_and_b32 v46, 0x80000000, v27
    v_lshrrev_b32 v47, 14, v25
    v_bitop3_b32 v47, v47, v5, v46 bitop3:0xea
    ds_read_b64 v[106:107], v47
    v_and_b32 v99, 0x40000000, v27
    v_lshrrev_b32 v47, 14, v24
    v_bitop3_b32 v47, v47, v5, v99 bitop3:0xea
    ds_read_b64 v[104:105], v47
    s_waitcnt lgkmcnt(2)
    v_cmp_ne_u64 s[50:51], v[72:73], v[68:69]
    v_cmpx_ne_u64 s[54:55], v[74:75], v[70:71]
    s_and_b64 s[82:83], s[54:55], s[80:81]
    s_cbranch_scc1 L2_c55
L2_d55:
    v_mov_b64 v[84:85], v[70:71]
    v_mov_b32 v7, v95
    v_mov_b64 v[86:87], v[74:75]
    s_or_b64 s[80:81], s[80:81], s[54:55]
    s_mov_b64 exec, s[50:51]
    s_and_b64 s[82:83], s[50:51], s[80:81]
    s_cbranch_scc1 L2_c56
L2_d56:
    v_mov_b64 v[84:85], v[68:69]
    v_mov_b32 v7, v94
    v_mov_b64 v[86:87], v[72:73]
    s_mov_b64 exec, -1
    s_or_b64 s[80:81], s[80:81], s[50:51]
    ds_read_b64 v[70:71], v93 offset:65408
    ds_read_b64 v[68:69], v92 offset:65408
    v_bitop3_b32 v94, v24, v5, v99 bitop3:0xea
    v_bitop3_b32 v95, v25, v5, v46 bitop3:0xea
    v_perm_b32 v15, v25, v26, s47
    v_bitop3_b32 v46, v25, 0.5, -0.5 bitop3:0xa8
    v_perm_b32 v14, v24, v26, s46
    v_bitop3_b32 v47, v24, 0.5, -0.5 bitop3:0xa8
    v_bitop3_b32 v15, v6, v15, v46 bitop3:0xca
    v_bitop3_b32 v14, v6, v14, v47 bitop3:0xca
    s_waitcnt lgkmcnt(1)
    v_mfma_f32_4x4x4_16b_bf16 v[80:83], v[10:11], v[70:71], v[80:83]
    s_waitcnt lgkmcnt(0)
    v_mfma_f32_4x4x4_16b_bf16 v[76:79], v[10:11], v[68:69], v[76:79]
    s_nop 2
    v_cvt_pk_bf16_f32 v80, v80, v81
    v_cvt_pk_bf16_f32 v81, v82, v83
    ds_wrxchg_rtn_b64 v[74:75], v93, v[80:81] offset:65408
    v_cvt_pk_bf16_f32 v76, v76, v77
    v_cvt_pk_bf16_f32 v77, v78, v79
    ds_wrxchg_rtn_b64 v[72:73], v92, v[76:77] offset:65408
    v_and_b32 v88, 0x0fffffff, v41
    v_mov_b32 v27, v41
    buffer_load_dwordx2 v[22:23], v88, s[8:11], 0 offen
    buffer_load_dwordx3 v[24:26], v88, s[8:11], 0 offen offset:8
    v_mfma_f32_4x4x4_16b_bf16 v[80:83], v[8:9], v[106:107], 0
    v_mfma_f32_4x4x4_16b_bf16 v[76:79], v[8:9], v[104:105], 0
    v_cmp_lt_u32 s[84:85], v5, v94
    s_nop 2
    v_pk_mul_f32 v[80:81], v[80:81], v[14:15] op_sel:[0,1] op_sel_hi:[1,1]
    v_pk_mul_f32 v[82:83], v[82:83], v[14:15] op_sel:[0,1] op_sel_hi:[1,1]
    v_pk_mul_f32 v[76:77], v[76:77], v[14:15] op_sel:[0,0] op_sel_hi:[1,0]
    v_pk_mul_f32 v[78:79], v[78:79], v[14:15] op_sel:[0,0] op_sel_hi:[1,0]
    s_waitcnt vmcnt(9)
    s_mov_b64 exec, s[6:7]
    v_lshrrev_b32 v30, 16, v30
    s_mov_b64 exec, -1
    v_and_b32 v46, 0x20000000, v31
    v_lshrrev_b32 v47, 14, v29
    v_bitop3_b32 v47, v47, v5, v46 bitop3:0xea
    ds_read_b64 v[102:103], v47
    v_and_b32 v99, 0x10000000, v31
    v_lshrrev_b32 v47, 14, v28
    v_bitop3_b32 v47, v47, v5, v99 bitop3:0xea
    ds_read_b64 v[100:101], v47
    s_waitcnt lgkmcnt(2)
    v_cmp_ne_u64 s[50:51], v[72:73], v[68:69]
    v_cmpx_ne_u64 s[54:55], v[74:75], v[70:71]
    s_and_b64 s[82:83], s[54:55], s[80:81]
    s_cbranch_scc1 L2_c57
L2_d57:
    v_mov_b64 v[84:85], v[70:71]
    v_mov_b32 v7, v93
    v_mov_b64 v[86:87], v[74:75]
    s_or_b64 s[80:81], s[80:81], s[54:55]
    s_mov_b64 exec, s[50:51]
    s_and_b64 s[82:83], s[50:51], s[80:81]
    s_cbranch_scc1 L2_c58
L2_d58:
    v_mov_b64 v[84:85], v[68:69]
    v_mov_b32 v7, v92
    v_mov_b64 v[86:87], v[72:73]
    s_mov_b64 exec, -1
    s_or_b64 s[80:81], s[80:81], s[50:51]
    s_and_b64 exec, s[84:85], s[80:81]
    v_mfma_f32_4x4x4_16b_bf16 v[76:79], v[12:13], v[84:85], 0
    v_mov_b32 v94, v7
    s_andn2_b64 s[80:81], s[80:81], s[84:85]
    v_mfma_f32_4x4x4_16b_bf16 v[76:79], v[10:11], v[86:87], v[76:79]
    s_mov_b64 exec, -1
    ds_read_b64 v[70:71], v95 offset:65408
    ds_read_b64 v[68:69], v94 offset:65408
    v_bitop3_b32 v92, v28, v5, v99 bitop3:0xea
    v_bitop3_b32 v93, v29, v5, v46 bitop3:0xea
    v_perm_b32 v15, v29, v30, s45
    v_bitop3_b32 v46, v29, 0.5, -0.5 bitop3:0xa8
    v_perm_b32 v14, v28, v30, s44
    v_bitop3_b32 v47, v28, 0.5, -0.5 bitop3:0xa8
    v_bitop3_b32 v15, v6, v15, v46 bitop3:0xca
    v_bitop3_b32 v14, v6, v14, v47 bitop3:0xca
    s_waitcnt lgkmcnt(1)
    v_mfma_f32_4x4x4_16b_bf16 v[80:83], v[10:11], v[70:71], v[80:83]
    s_waitcnt lgkmcnt(0)
    v_mfma_f32_4x4x4_16b_bf16 v[76:79], v[10:11], v[68:69], v[76:79]
    s_nop 2
    v_cvt_pk_bf16_f32 v80, v80, v81
    v_cvt_pk_bf16_f32 v81, v82, v83
    ds_wrxchg_rtn_b64 v[74:75], v95, v[80:81] offset:65408
    v_cvt_pk_bf16_f32 v76, v76, v77
    v_cvt_pk_bf16_f32 v77, v78, v79
    ds_wrxchg_rtn_b64 v[72:73], v94, v[76:77] offset:65408
    s_setprio 0
    v_mfma_f32_4x4x4_16b_bf16 v[80:83], v[8:9], v[102:103], 0
    v_mfma_f32_4x4x4_16b_bf16 v[76:79], v[8:9], v[100:101], 0
    v_cmp_lt_u32 s[48:49], v5, v93
    s_nop 2
    v_pk_mul_f32 v[80:81], v[80:81], v[14:15] op_sel:[0,1] op_sel_hi:[1,1]
    v_pk_mul_f32 v[82:83], v[82:83], v[14:15] op_sel:[0,1] op_sel_hi:[1,1]
    v_pk_mul_f32 v[76:77], v[76:77], v[14:15] op_sel:[0,0] op_sel_hi:[1,0]
    v_pk_mul_f32 v[78:79], v[78:79], v[14:15] op_sel:[0,0] op_sel_hi:[1,0]
    s_add_u32 s40, s40, 0xfff24000
    v_and_b32 v47, 0x0fffffff, v42
    v_mov_b32 v31, v42
    buffer_load_dword v30, v47, s[8:11], 0 offen offset:16
    s_mov_b64 exec, s[6:7]
    v_add_u32 v47, 8, v47
    v_lshrrev_b32 v31, 2, v31
    s_mov_b64 exec, -1
    buffer_load_dwordx2 v[28:29], v47, s[8:11], 0 offen
    s_waitcnt vmcnt(8)
    v_and_b32 v46, 0x80000000, v39
    v_lshrrev_b32 v47, 14, v37
    v_bitop3_b32 v47, v47, v5, v46 bitop3:0xea
    ds_read_b64 v[102:103], v47
    v_and_b32 v99, 0x40000000, v39
    v_lshrrev_b32 v47, 14, v36
    v_bitop3_b32 v47, v47, v5, v99 bitop3:0xea
    ds_read_b64 v[100:101], v47
    v_and_b32 v46, 0x20000000, v39
    v_lshrrev_b32 v47, 14, v35
    v_bitop3_b32 v47, v47, v5, v46 bitop3:0xea
    ds_read_b64 v[106:107], v47
    v_and_b32 v99, 0x10000000, v39
    v_lshrrev_b32 v47, 14, v34
    v_bitop3_b32 v47, v47, v5, v99 bitop3:0xea
    ds_read_b64 v[104:105], v47
    s_waitcnt lgkmcnt(4)
    v_cmp_ne_u64 s[50:51], v[72:73], v[68:69]
    v_cmpx_ne_u64 s[54:55], v[74:75], v[70:71]
    s_and_b64 s[82:83], s[54:55], s[80:81]
    s_cbranch_scc1 L2_c59
L2_d59:
    v_mov_b64 v[84:85], v[70:71]
    v_mov_b32 v7, v95
    v_mov_b64 v[86:87], v[74:75]
    s_or_b64 s[80:81], s[80:81], s[54:55]
    s_mov_b64 exec, s[50:51]
    s_and_b64 s[82:83], s[50:51], s[80:81]
    s_cbranch_scc1 L2_c60
L2_d60:
    v_mov_b64 v[84:85], v[68:69]
    v_mov_b32 v7, v94
    v_mov_b64 v[86:87], v[72:73]
    s_mov_b64 exec, -1
    s_or_b64 s[80:81], s[80:81], s[50:51]
    s_and_b64 exec, s[48:49], s[80:81]
    v_mfma_f32_4x4x4_16b_bf16 v[80:83], v[12:13], v[84:85], 0
    v_mov_b32 v93, v7
    s_andn2_b64 s[80:81], s[80:81], s[48:49]
    v_mfma_f32_4x4x4_16b_bf16 v[80:83], v[10:11], v[86:87], v[80:83]
    s_mov_b64 exec, -1
    ds_read_b64 v[70:71], v93 offset:65408
    ds_read_b64 v[68:69], v92 offset:65408
    v_bitop3_b32 v94, v34, v5, v99 bitop3:0xea
    v_bitop3_b32 v95, v35, v5, v46 bitop3:0xea
    v_perm_b32 v15, v35, v38, s45
    v_bitop3_b32 v46, v35, 0.5, -0.5 bitop3:0xa8
    v_perm_b32 v14, v34, v38, s44
    v_bitop3_b32 v47, v34, 0.5, -0.5 bitop3:0xa8
    v_bitop3_b32 v15, v6, v15, v46 bitop3:0xca
    v_bitop3_b32 v14, v6, v14, v47 bitop3:0xca
    s_waitcnt lgkmcnt(1)
    v_mfma_f32_4x4x4_16b_bf16 v[80:83], v[10:11], v[70:71], v[80:83]
    s_waitcnt lgkmcnt(0)
    v_mfma_f32_4x4x4_16b_bf16 v[76:79], v[10:11], v[68:69], v[76:79]
    s_nop 2
    v_cvt_pk_bf16_f32 v80, v80, v81
    v_cvt_pk_bf16_f32 v81, v82, v83
    ds_wrxchg_rtn_b64 v[74:75], v93, v[80:81] offset:65408
    v_cvt_pk_bf16_f32 v76, v76, v77
    v_cvt_pk_bf16_f32 v77, v78, v79
    ds_wrxchg_rtn_b64 v[72:73], v92, v[76:77] offset:65408
    s_barrier
    s_setprio 3
    s_mov_b32 m0, s100
    s_nop 0
    ds_write_addtid_b32 v116 offset:32768
    ds_write_addtid_b32 v117 offset:33024
    ds_write_addtid_b32 v118 offset:33280
    ds_write_addtid_b32 v119 offset:33536
    buffer_load_dwordx4 v[116:119], v3, s[16:19], s40 offen offset:2048
    ds_write_addtid_b32 v120 offset:33792
    ds_write_addtid_b32 v121 offset:34048
    ds_write_addtid_b32 v122 offset:34304
    ds_write_addtid_b32 v123 offset:34560
    buffer_load_dwordx4 v[120:123], v3, s[16:19], s40 offen offset:3072
    v_mfma_f32_4x4x4_16b_bf16 v[80:83], v[8:9], v[106:107], 0
    v_mfma_f32_4x4x4_16b_bf16 v[76:79], v[8:9], v[104:105], 0
    s_nop 3
    v_pk_mul_f32 v[80:81], v[80:81], v[14:15] op_sel:[0,1] op_sel_hi:[1,1]
    v_pk_mul_f32 v[82:83], v[82:83], v[14:15] op_sel:[0,1] op_sel_hi:[1,1]
    v_pk_mul_f32 v[76:77], v[76:77], v[14:15] op_sel:[0,0] op_sel_hi:[1,0]
    v_pk_mul_f32 v[78:79], v[78:79], v[14:15] op_sel:[0,0] op_sel_hi:[1,0]
    v_mov_b32 v44, v43
    s_cmp_gt_u32 s37, 1024
    s_cbranch_scc1 L2_xs61
    s_cmp_lg_u32 s101, 0
    s_cbranch_scc1 L2_xa61
L2_xb61:
    v_lshlrev_b32 v89, 16, v96
    v_add_u32 v90, 60, v97
    v_bitop3_b32 v90, v89, v45, v90 bitop3:0x6a
    ds_write_b32 v98, v90 offset:12
    v_lshlrev_b32 v89, 20, v96
    v_add_u32 v90, 40, v97
    v_bitop3_b32 v90, v89, v45, v90 bitop3:0x6a
    ds_write_b32 v98, v90 offset:8
    v_lshlrev_b32 v89, 24, v96
    v_add_u32 v90, 20, v97
    v_bitop3_b32 v90, v89, v45, v90 bitop3:0x6a
    ds_write_b32 v98, v90 offset:4
    v_lshlrev_b32 v89, 28, v96
    v_bitop3_b32 v90, v89, v45, v97 bitop3:0x6a
    ds_write_b32 v98, v90 offset:0
    v_mov_b32_dpp v91, v64 quad_perm:[0,0,0,0] row_mask:0xf bank_mask:0xf
    v_and_b32 v89, 3, v91
    v_and_b32 v97, 0xfffc, v91
    v_sub_u16_dpp v88, v64, v91 quad_perm:[2,2,2,2] row_mask:0xf bank_mask:0xf
    v_mad_u32_u24 v97, v97, 5, v4
    v_add_u32 v99, v88, v89
    v_bfm_b32 v96, v88, v89
    v_cmp_lt_u32 s[58:59], 16, v99
    v_lshlrev_b32 v89, v1, v96
    v_and_b32 v89, v45, v89
    v_cmp_ne_u32 vcc, 0, v89
    v_xor_b32 v90, v97, v89
    s_add_u32 s3, s37, s38
    v_mbcnt_lo_u32_b32 v98, vcc_lo, 0
    v_mbcnt_hi_u32_b32 v98, vcc_hi, v98
    s_bcnt1_i32_b64 s41, vcc
    v_lshl_add_u32 v98, v98, 2, s3
    s_mov_b64 exec, vcc
    ds_write_b32 v98, v90
    s_mov_b64 exec, -1
    s_lshl2_add_u32 s37, s41, s37
    s_cmp_lg_u64 s[58:59], 0
    s_cbranch_scc1 L2_xe61
L2_xr61:
    v_add_u32 v98, s37, v0
    v_mov_b32 v90, -1
    ds_write_b32 v98, v90
    v_add_u32 v98, s38, v0
    ds_read2st64_b32 v[40:41], v0 offset0:0 offset1:1
    ds_read_b32 v43, v0 offset:512
    v_lshrrev_b32 v98, 1, v98
    v_and_b32 v98, -4, v98
    ds_read_b32 v42, v98 offset:768
    s_sub_u32 s3, s37, 768
    s_cmp_gt_u32 s3, 128
    s_cbranch_scc1 L2_xf61
L2_xg61:
    s_setprio 2
    ds_write_addtid_b32 v124 offset:34816
    ds_write_addtid_b32 v125 offset:35072
    ds_write_addtid_b32 v126 offset:35328
    ds_write_addtid_b32 v127 offset:35584
    s_add_u32 s3, s40, 4096
    buffer_load_dwordx4 v[124:127], v3, s[16:19], s3 offen
    s_waitcnt lgkmcnt(14)
    v_cmp_ne_u64 s[50:51], v[72:73], v[68:69]
    v_cmpx_ne_u64 s[54:55], v[74:75], v[70:71]
    s_and_b64 s[82:83], s[54:55], s[80:81]
    s_cbranch_scc1 L2_c62
L2_d62:
    v_mov_b64 v[84:85], v[70:71]
    v_mov_b32 v7, v93
    v_mov_b64 v[86:87], v[74:75]
    s_or_b64 s[80:81], s[80:81], s[54:55]
    s_mov_b64 exec, s[50:51]
    s_and_b64 s[82:83], s[50:51], s[80:81]
    s_cbranch_scc1 L2_c63
L2_d63:
    v_mov_b64 v[84:85], v[68:69]
    v_mov_b32 v7, v92
    v_mov_b64 v[86:87], v[72:73]
    s_mov_b64 exec, -1
    s_or_b64 s[80:81], s[80:81], s[50:51]
    ds_read_b64 v[70:71], v95 offset:65408
    ds_read_b64 v[68:69], v94 offset:65408
    v_and_b32 v46, 0x40000000, v39
    v_bitop3_b32 v92, v36, v5, v46 bitop3:0xea
    v_and_b32 v46, 0x80000000, v39
    v_bitop3_b32 v93, v37, v5, v46 bitop3:0xea
    v_perm_b32 v15, v37, v38, s47
    v_bitop3_b32 v46, v37, 0.5, -0.5 bitop3:0xa8
    v_perm_b32 v14, v36, v38, s46
    v_bitop3_b32 v47, v36, 0.5, -0.5 bitop3:0xa8
    v_bitop3_b32 v15, v6, v15, v46 bitop3:0xca
    v_bitop3_b32 v14, v6, v14, v47 bitop3:0xca
    s_setprio 1
    s_waitcnt lgkmcnt(1)
    v_mfma_f32_4x4x4_16b_bf16 v[80:83], v[10:11], v[70:71], v[80:83]
    s_waitcnt lgkmcnt(0)
    v_mfma_f32_4x4x4_16b_bf16 v[76:79], v[10:11], v[68:69], v[76:79]
    s_nop 2
    v_cvt_pk_bf16_f32 v80, v80, v81
    v_cvt_pk_bf16_f32 v81, v82, v83
    ds_wrxchg_rtn_b64 v[74:75], v95, v[80:81] offset:65408
    v_cvt_pk_bf16_f32 v76, v76, v77
    v_cvt_pk_bf16_f32 v77, v78, v79
    ds_wrxchg_rtn_b64 v[72:73], v94, v[76:77] offset:65408
    v_and_b32 v88, 0x0fffffff, v44
    v_mov_b32 v39, v44
    buffer_load_dwordx2 v[34:35], v88, s[8:11], 0 offen
    buffer_load_dwordx3 v[36:38], v88, s[8:11], 0 offen offset:8
    s_setprio 0
    s_waitcnt vmcnt(12)
    s_mov_b32 m0, s38
    s_nop 0
    ds_write_addtid_b32 v108 offset:0
    ds_write_addtid_b32 v109 offset:256
    ds_write_addtid_b32 v110 offset:512
    ds_write_addtid_b32 v111 offset:768
    s_waitcnt vmcnt(9)
    ds_write_addtid_b32 v112 offset:1024
    ds_write_addtid_b32 v113 offset:1280
    ds_write_addtid_b32 v114 offset:1536
    ds_write_addtid_b32 v115 offset:1792
    v_mfma_f32_4x4x4_16b_bf16 v[80:83], v[8:9], v[102:103], 0
    v_mfma_f32_4x4x4_16b_bf16 v[76:79], v[8:9], v[100:101], 0
    v_cmp_lt_u32 s[84:85], v5, v92
    s_nop 2
    v_pk_mul_f32 v[80:81], v[80:81], v[14:15] op_sel:[0,1] op_sel_hi:[1,1]
    v_pk_mul_f32 v[82:83], v[82:83], v[14:15] op_sel:[0,1] op_sel_hi:[1,1]
    v_pk_mul_f32 v[76:77], v[76:77], v[14:15] op_sel:[0,0] op_sel_hi:[1,0]
    v_pk_mul_f32 v[78:79], v[78:79], v[14:15] op_sel:[0,0] op_sel_hi:[1,0]
    s_add_u32 s42, s42, 1
    s_waitcnt lgkmcnt(0)
    s_barrier
    s_bitcmp1_b32 s36, s42
    s_cbranch_scc1 L2_slow
L2_ret3:
    s_setprio 3
    s_bitcmp1_b32 s43, s42
    s_cbranch_scc1 L2_oa64
L2_ob64:
    v_and_b32 v46, 0x20000000, v21
    v_lshrrev_b32 v47, 14, v17
    v_bitop3_b32 v47, v47, v5, v46 bitop3:0xea
    ds_read_b64 v[106:107], v47
    v_and_b32 v99, 0x10000000, v21
    v_lshrrev_b32 v47, 14, v16
    v_bitop3_b32 v47, v47, v5, v99 bitop3:0xea
    ds_read_b64 v[104:105], v47
    v_cmp_ne_u64 s[50:51], v[72:73], v[68:69]
    v_cmpx_ne_u64 s[54:55], v[74:75], v[70:71]
    s_and_b64 s[82:83], s[54:55], s[80:81]
    s_cbranch_scc1 L2_c65
L2_d65:
    v_mov_b64 v[84:85], v[70:71]
    v_mov_b32 v7, v95
    v_mov_b64 v[86:87], v[74:75]
    s_or_b64 s[80:81], s[80:81], s[54:55]
    s_mov_b64 exec, s[50:51]
    s_and_b64 s[82:83], s[50:51], s[80:81]
    s_cbranch_scc1 L2_c66
L2_d66:
    v_mov_b64 v[84:85], v[68:69]
    v_mov_b32 v7, v94
    v_mov_b64 v[86:87], v[72:73]
    s_mov_b64 exec, -1
    s_or_b64 s[80:81], s[80:81], s[50:51]
    s_and_b64 exec, s[84:85], s[80:81]
    v_mfma_f32_4x4x4_16b_bf16 v[76:79], v[12:13], v[84:85], 0
    v_mov_b32 v92, v7
    s_andn2_b64 s[80:81], s[80:81], s[84:85]
    v_mfma_f32_4x4x4_16b_bf16 v[76:79], v[10:11], v[86:87], v[76:79]
    s_mov_b64 exec, -1
    ds_read_b64 v[70:71], v93 offset:65408
    ds_read_b64 v[68:69], v92 offset:65408
    v_bitop3_b32 v94, v16, v5, v99 bitop3:0xea
    v_bitop3_b32 v95, v17, v5, v46 bitop3:0xea
    v_perm_b32 v15, v17, v20, s45
    v_bitop3_b32 v46, v17, 0.5, -0.5 bitop3:0xa8
    v_perm_b32 v14, v16, v20, s44
    v_bitop3_b32 v47, v16, 0.5, -0.5 bitop3:0xa8
    v_bitop3_b32 v15, v6, v15, v46 bitop3:0xca
    v_bitop3_b32 v14, v6, v14, v47 bitop3:0xca
    s_waitcnt lgkmcnt(1)
    v_mfma_f32_4x4x4_16b_bf16 v[80:83], v[10:11], v[70:71], v[80:83]
    s_waitcnt lgkmcnt(0)
    v_mfma_f32_4x4x4_16b_bf16 v[76:79], v[10:11], v[68:69], v[76:79]
    s_nop 2
    v_cvt_pk_bf16_f32 v80, v80, v81
    v_cvt_pk_bf16_f32 v81, v82, v83
    ds_wrxchg_rtn_b64 v[74:75], v93, v[80:81] offset:65408
    v_cvt_pk_bf16_f32 v76, v76, v77
    v_cvt_pk_bf16_f32 v77, v78, v79
    ds_wrxchg_rtn_b64 v[72:73], v92, v[76:77] offset:65408
    v_mfma_f32_4x4x4_16b_bf16 v[80:83], v[8:9], v[106:107], 0
    v_mfma_f32_4x4x4_16b_bf16 v[76:79], v[8:9], v[104:105], 0
    v_cmp_lt_u32 s[84:85], v5, v94
    s_nop 2
    v_pk_mul_f32 v[80:81], v[80:81], v[14:15] op_sel:[0,1] op_sel_hi:[1,1]
    v_pk_mul_f32 v[82:83], v[82:83], v[14:15] op_sel:[0,1] op_sel_hi:[1,1]
    v_pk_mul_f32 v[76:77], v[76:77], v[14:15] op_sel:[0,0] op_sel_hi:[1,0]
    v_pk_mul_f32 v[78:79], v[78:79], v[14:15] op_sel:[0,0] op_sel_hi:[1,0]
    buffer_load_dwordx4 v[108:111], v3, s[16:19], s40 offen offset:0
    v_and_b32 v46, 0x80000000, v21
    v_lshrrev_b32 v47, 14, v19
    v_bitop3_b32 v47, v47, v5, v46 bitop3:0xea
    ds_read_b64 v[102:103], v47
    v_and_b32 v99, 0x40000000, v21
    v_lshrrev_b32 v47, 14, v18
    v_bitop3_b32 v47, v47, v5, v99 bitop3:0xea
    ds_read_b64 v[100:101], v47
    s_waitcnt lgkmcnt(2)
    v_cmp_ne_u64 s[50:51], v[72:73], v[68:69]
    v_cmpx_ne_u64 s[54:55], v[74:75], v[70:71]
    s_and_b64 s[82:83], s[54:55], s[80:81]
    s_cbranch_scc1 L2_c67
L2_d67:
    v_mov_b64 v[84:85], v[70:71]
    v_mov_b32 v7, v93
    v_mov_b64 v[86:87], v[74:75]
    s_or_b64 s[80:81], s[80:81], s[54:55]
    s_mov_b64 exec, s[50:51]
    s_and_b64 s[82:83], s[50:51], s[80:81]
    s_cbranch_scc1 L2_c68
L2_d68:
    v_mov_b64 v[84:85], v[68:69]
    v_mov_b32 v7, v92
    v_mov_b64 v[86:87], v[72:73]
    s_mov_b64 exec, -1
    s_or_b64 s[80:81], s[80:81], s[50:51]
    s_and_b64 exec, s[84:85], s[80:81]
    v_mfma_f32_4x4x4_16b_bf16 v[76:79], v[12:13], v[84:85], 0
    v_mov_b32 v94, v7
    s_andn2_b64 s[80:81], s[80:81], s[84:85]
    v_mfma_f32_4x4x4_16b_bf16 v[76:79], v[10:11], v[86:87], v[76:79]
    s_mov_b64 exec, -1
    ds_read_b64 v[70:71], v95 offset:65408
    ds_read_b64 v[68:69], v94 offset:65408
    v_bitop3_b32 v92, v18, v5, v99 bitop3:0xea
    v_bitop3_b32 v93, v19, v5, v46 bitop3:0xea
    v_perm_b32 v15, v19, v20, s47
    v_bitop3_b32 v46, v19, 0.5, -0.5 bitop3:0xa8
    v_perm_b32 v14, v18, v20, s46
    v_bitop3_b32 v47, v18, 0.5, -0.5 bitop3:0xa8
    v_bitop3_b32 v15, v6, v15, v46 bitop3:0xca
    v_bitop3_b32 v14, v6, v14, v47 bitop3:0xca
    s_waitcnt lgkmcnt(1)
    v_mfma_f32_4x4x4_16b_bf16 v[80:83], v[10:11], v[70:71], v[80:83]
    s_waitcnt lgkmcnt(0)
    v_mfma_f32_4x4x4_16b_bf16 v[76:79], v[10:11], v[68:69], v[76:79]
    s_nop 2
    v_cvt_pk_bf16_f32 v80, v80, v81
    v_cvt_pk_bf16_f32 v81, v82, v83
    ds_wrxchg_rtn_b64 v[74:75], v95, v[80:81] offset:65408
    v_cvt_pk_bf16_f32 v76, v76, v77
    v_cvt_pk_bf16_f32 v77, v78, v79
    ds_wrxchg_rtn_b64 v[72:73], v94, v[76:77] offset:65408
    v_and_b32 v88, 0x0fffffff, v40
    v_mov_b32 v21, v40
    buffer_load_dwordx2 v[16:17], v88, s[8:11], 0 offen
    buffer_load_dwordx3 v[18:20], v88, s[8:11], 0 offen offset:8
    s_setprio 2
    v_mfma_f32_4x4x4_16b_bf16 v[80:83], v[8:9], v[102:103], 0
    v_mfma_f32_4x4x4_16b_bf16 v[76:79], v[8:9], v[100:101], 0
    v_cmp_lt_u32 s[48:49], v5, v93
    s_nop 2
    v_pk_mul_f32 v[80:81], v[80:81], v[14:15] op_sel:[0,1] op_sel_hi:[1,1]
    v_pk_mul_f32 v[82:83], v[82:83], v[14:15] op_sel:[0,1] op_sel_hi:[1,1]
    v_pk_mul_f32 v[76:77], v[76:77], v[14:15] op_sel:[0,0] op_sel_hi:[1,0]
    v_pk_mul_f32 v[78:79], v[78:79], v[14:15] op_sel:[0,0] op_sel_hi:[1,0]
    s_waitcnt vmcnt(10)
    v_and_b32 v46, 0x20000000, v27
    v_lshrrev_b32 v47, 14, v23
    v_bitop3_b32 v47, v47, v5, v46 bitop3:0xea
    ds_read_b64 v[106:107], v47
    v_and_b32 v99, 0x10000000, v27
    v_lshrrev_b32 v47, 14, v22
    v_bitop3_b32 v47, v47, v5, v99 bitop3:0xea
    ds_read_b64 v[104:105], v47
    s_waitcnt lgkmcnt(2)
    v_cmp_ne_u64 s[50:51], v[72:73], v[68:69]
    v_cmpx_ne_u64 s[54:55], v[74:75], v[70:71]
    s_and_b64 s[82:83], s[54:55], s[80:81]
    s_cbranch_scc1 L2_c69
L2_d69:
    v_mov_b64 v[84:85], v[70:71]
    v_mov_b32 v7, v95
    v_mov_b64 v[86:87], v[74:75]
    s_or_b64 s[80:81], s[80:81], s[54:55]
    s_mov_b64 exec, s[50:51]
    s_and_b64 s[82:83], s[50:51], s[80:81]
    s_cbranch_scc1 L2_c70
L2_d70:
    v_mov_b64 v[84:85], v[68:69]
    v_mov_b32 v7, v94
    v_mov_b64 v[86:87], v[72:73]
    s_mov_b64 exec, -1
    s_or_b64 s[80:81], s[80:81], s[50:51]
    s_and_b64 exec, s[48:49], s[80:81]
    v_mfma_f32_4x4x4_16b_bf16 v[80:83], v[12:13], v[84:85], 0
    v_mov_b32 v93, v7
    s_andn2_b64 s[80:81], s[80:81], s[48:49]
    v_mfma_f32_4x4x4_16b_bf16 v[80:83], v[10:11], v[86:87], v[80:83]
    s_mov_b64 exec, -1
    ds_read_b64 v[70:71], v93 offset:65408
    ds_read_b64 v[68:69], v92 offset:65408
    v_bitop3_b32 v94, v22, v5, v99 bitop3:0xea
    v_bitop3_b32 v95, v23, v5, v46 bitop3:0xea
    v_perm_b32 v15, v23, v26, s45
    v_bitop3_b32 v46, v23, 0.5, -0.5 bitop3:0xa8
    v_perm_b32 v14, v22, v26, s44
    v_bitop3_b32 v47, v22, 0.5, -0.5 bitop3:0xa8
    v_bitop3_b32 v15, v6, v15, v46 bitop3:0xca
    v_bitop3_b32 v14, v6, v14, v47 bitop3:0xca
    s_waitcnt lgkmcnt(1)
    v_mfma_f32_4x4x4_16b_bf16 v[80:83], v[10:11], v[70:71], v[80:83]
    s_waitcnt lgkmcnt(0)
    v_mfma_f32_4x4x4_16b_bf16 v[76:79], v[10:11], v[68:69], v[76:79]
    s_nop 2
    v_cvt_pk_bf16_f32 v80, v80, v81
    v_cvt_pk_bf16_f32 v81, v82, v83
    ds_wrxchg_rtn_b64 v[74:75], v93, v[80:81] offset:65408
    v_cvt_pk_bf16_f32 v76, v76, v77
    v_cvt_pk_bf16_f32 v77, v78, v79
    ds_wrxchg_rtn_b64 v[72:73], v92, v[76:77] offset:65408
    s_setprio 1
    v_mfma_f32_4x4x4_16b_bf16 v[80:83], v[8:9], v[106:107], 0
    v_mfma_f32_4x4x4_16b_bf16 v[76:79], v[8:9], v[104:105], 0
    s_nop 3
    v_pk_mul_f32 v[80:81], v[80:81], v[14:15] op_sel:[0,1] op_sel_hi:[1,1]
    v_pk_mul_f32 v[82:83], v[82:83], v[14:15] op_sel:[0,1] op_sel_hi:[1,1]
    v_pk_mul_f32 v[76:77], v[76:77], v[14:15] op_sel:[0,0] op_sel_hi:[1,0]
    v_pk_mul_f32 v[78:79], v[78:79], v[14:15] op_sel:[0,0] op_sel_hi:[1,0]
    s_bitcmp1_b32 s43, s42
    s_cbranch_scc1 L2_oa71
L2_ob71:
    buffer_load_dwordx4 v[112:115], v3, s[16:19], s40 offen offset:1024
    v_sub_u16 v88, v58, v50
    v_and_b32 v89, 3, v50
    v_add3_u32 v99, v88, v89, 3
    v_and_b32 v99, -4, v99
    v_max_u32 v99, 4, v99
    v_and_b32 v97, 0xfffc, v50
    v_bfm_b32 v96, v88, v89
    v_add_u32_dpp v91, v99, v99 row_shr:1 row_mask:0xf bank_mask:0xf bound_ctrl:1
    v_mad_u32_u24 v97, v97, 5, v2
    v_cmp_lt_u32 vcc, 16, v99
    v_add_u32_dpp v91, v91, v91 row_shr:2 row_mask:0xf bank_mask:0xf bound_ctrl:1
    v_sub_u32 v98, s38, v99
    v_lshrrev_b64 v[50:51], 16, v[50:51]
    v_add_u32_dpp v91, v91, v91 row_shr:4 row_mask:0xf bank_mask:0xf bound_ctrl:1
    v_lshrrev_b64 v[58:59], 16, v[58:59]
    s_mov_b32 s101, 0
    v_add_u32_dpp v91, v91, v91 row_shr:8 row_mask:0xf bank_mask:0xf bound_ctrl:1
    s_nop 1
    v_add_u32_dpp v91, v91, v91 row_bcast:15 row_mask:0xa bank_mask:0xf
    s_nop 1
    v_add_u32_dpp v91, v91, v91 row_bcast:31 row_mask:0xc bank_mask:0xf
    v_add_u32 v98, v98, v91
    v_readlane_b32 s37, v91, 63
    s_cbranch_vccnz L2_xo72
L2_xp72:
    v_and_b32 v46, 0x80000000, v27
    v_lshrrev_b32 v47, 14, v25
    v_bitop3_b32 v47, v47, v5, v46 bitop3:0xea
    ds_read_b64 v[102:103], v47
    v_and_b32 v99, 0x40000000, v27
    v_lshrrev_b32 v47, 14, v24
    v_bitop3_b32 v47, v47, v5, v99 bitop3:0xea
    ds_read_b64 v[100:101], v47
    s_waitcnt lgkmcnt(2)
    v_cmp_ne_u64 s[50:51], v[72:73], v[68:69]
    v_cmpx_ne_u64 s[54:55], v[74:75], v[70:71]
    s_and_b64 s[82:83], s[54:55], s[80:81]
    s_cbranch_scc1 L2_c73
L2_d73:
    v_mov_b64 v[84:85], v[70:71]
    v_mov_b32 v7, v93
    v_mov_b64 v[86:87], v[74:75]
    s_or_b64 s[80:81], s[80:81], s[54:55]
    s_mov_b64 exec, s[50:51]
    s_and_b64 s[82:83], s[50:51], s[80:81]
    s_cbranch_scc1 L2_c74
L2_d74:
    v_mov_b64 v[84:85], v[68:69]
    v_mov_b32 v7, v92
    v_mov_b64 v[86:87], v[72:73]
    s_mov_b64 exec, -1
    s_or_b64 s[80:81], s[80:81], s[50:51]
    ds_read_b64 v[70:71], v95 offset:65408
    ds_read_b64 v[68:69], v94 offset:65408
    v_bitop3_b32 v92, v24, v5, v99 bitop3:0xea
    v_bitop3_b32 v93, v25, v5, v46 bitop3:0xea
    v_perm_b32 v15, v25, v26, s47
    v_bitop3_b32 v46, v25, 0.5, -0.5 bitop3:0xa8
    v_perm_b32 v14, v24, v26, s46
    v_bitop3_b32 v47, v24, 0.5, -0.5 bitop3:0xa8
    v_bitop3_b32 v15, v6, v15, v46 bitop3:0xca
    v_bitop3_b32 v14, v6, v14, v47 bitop3:0xca
    s_waitcnt lgkmcnt(1)
    v_mfma_f32_4x4x4_16b_bf16 v[80:83], v[10:11], v[70:71], v[80:83]
    s_waitcnt lgkmcnt(0)
    v_mfma_f32_4x4x4_16b_bf16 v[76:79], v[10:11], v[68:69], v[76:79]
    s_nop 2
    v_cvt_pk_bf16_f32 v80, v80, v81
    v_cvt_pk_bf16_f32 v81, v82, v83
    ds_wrxchg_rtn_b64 v[74:75], v95, v[80:81] offset:65408
    v_cvt_pk_bf16_f32 v76, v76, v77
    v_cvt_pk_bf16_f32 v77, v78, v79
    ds_wrxchg_rtn_b64 v[72:73], v94, v[76:77] offset:65408
    v_and_b32 v88, 0x0fffffff, v41
    v_mov_b32 v27, v41
    buffer_load_dwordx2 v[22:23], v88, s[8:11], 0 offen
    buffer_load_dwordx3 v[24:26], v88, s[8:11], 0 offen offset:8
    v_mfma_f32_4x4x4_16b_bf16 v[80:83], v[8:9], v[102:103], 0
    v_mfma_f32_4x4x4_16b_bf16 v[76:79], v[8:9], v[100:101], 0
    v_cmp_lt_u32 s[84:85], v5, v92
    s_nop 2
    v_pk_mul_f32 v[80:81], v[80:81], v[14:15] op_sel:[0,1] op_sel_hi:[1,1]
    v_pk_mul_f32 v[82:83], v[82:83], v[14:15] op_sel:[0,1] op_sel_hi:[1,1]
    v_pk_mul_f32 v[76:77], v[76:77], v[14:15] op_sel:[0,0] op_sel_hi:[1,0]
    v_pk_mul_f32 v[78:79], v[78:79], v[14:15] op_sel:[0,0] op_sel_hi:[1,0]
    s_waitcnt vmcnt(11)
    s_mov_b64 exec, s[6:7]
    v_lshrrev_b32 v30, 16, v30
    s_mov_b64 exec, -1
    v_and_b32 v46, 0x20000000, v31
    v_lshrrev_b32 v47, 14, v29
    v_bitop3_b32 v47, v47, v5, v46 bitop3:0xea
    ds_read_b64 v[106:107], v47
    v_and_b32 v99, 0x10000000, v31
    v_lshrrev_b32 v47, 14, v28
    v_bitop3_b32 v47, v47, v5, v99 bitop3:0xea
    ds_read_b64 v[104:105], v47
    s_waitcnt lgkmcnt(2)
    v_cmp_ne_u64 s[50:51], v[72:73], v[68:69]
    v_cmpx_ne_u64 s[54:55], v[74:75], v[70:71]
    s_and_b64 s[82:83], s[54:55], s[80:81]
    s_cbranch_scc1 L2_c75
L2_d75:
    v_mov_b64 v[84:85], v[70:71]
    v_mov_b32 v7, v95
    v_mov_b64 v[86:87], v[74:75]
    s_or_b64 s[80:81], s[80:81], s[54:55]
    s_mov_b64 exec, s[50:51]
    s_and_b64 s[82:83], s[50:51], s[80:81]
    s_cbranch_scc1 L2_c76
L2_d76:
    v_mov_b64 v[84:85], v[68:69]
    v_mov_b32 v7, v94
    v_mov_b64 v[86:87], v[72:73]
    s_mov_b64 exec, -1
    s_or_b64 s[80:81], s[80:81], s[50:51]
    s_and_b64 exec, s[84:85], s[80:81]
    v_mfma_f32_4x4x4_16b_bf16 v[76:79], v[12:13], v[84:85], 0
    v_mov_b32 v92, v7
    s_andn2_b64 s[80:81], s[80:81], s[84:85]
    v_mfma_f32_4x4x4_16b_bf16 v[76:79], v[10:11], v[86:87], v[76:79]
    s_mov_b64 exec, -1
    ds_read_b64 v[70:71], v93 offset:65408
    ds_read_b64 v[68:69], v92 offset:65408
    v_bitop3_b32 v94, v28, v5, v99 bitop3:0xea
    v_bitop3_b32 v95, v29, v5, v46 bitop3:0xea
    v_perm_b32 v15, v29, v30, s45
    v_bitop3_b32 v46, v29, 0.5, -0.5 bitop3:0xa8
    v_perm_b32 v14, v28, v30, s44
    v_bitop3_b32 v47, v28, 0.5, -0.5 bitop3:0xa8
    v_bitop3_b32 v15, v6, v15, v46 bitop3:0xca
    v_bitop3_b32 v14, v6, v14, v47 bitop3:0xca
    s_waitcnt lgkmcnt(1)
    v_mfma_f32_4x4x4_16b_bf16 v[80:83], v[10:11], v[70:71], v[80:83]
    s_waitcnt lgkmcnt(0)
    v_mfma_f32_4x4x4_16b_bf16 v[76:79], v[10:11], v[68:69], v[76:79]
    s_nop 2
    v_cvt_pk_bf16_f32 v80, v80, v81
    v_cvt_pk_bf16_f32 v81, v82, v83
    ds_wrxchg_rtn_b64 v[74:75], v93, v[80:81] offset:65408
    v_cvt_pk_bf16_f32 v76, v76, v77
    v_cvt_pk_bf16_f32 v77, v78, v79
    ds_wrxchg_rtn_b64 v[72:73], v92, v[76:77] offset:65408
    s_setprio 0
    v_mfma_f32_4x4x4_16b_bf16 v[80:83], v[8:9], v[106:107], 0
    v_mfma_f32_4x4x4_16b_bf16 v[76:79], v[8:9], v[104:105], 0
    v_cmp_lt_u32 s[48:49], v5, v95
    s_nop 2
    v_pk_mul_f32 v[80:81], v[80:81], v[14:15] op_sel:[0,1] op_sel_hi:[1,1]
    v_pk_mul_f32 v[82:83], v[82:83], v[14:15] op_sel:[0,1] op_sel_hi:[1,1]
    v_pk_mul_f32 v[76:77], v[76:77], v[14:15] op_sel:[0,0] op_sel_hi:[1,0]
    v_pk_mul_f32 v[78:79], v[78:79], v[14:15] op_sel:[0,0] op_sel_hi:[1,0]
    s_add_u32 s40, s40, 0x50000
    v_and_b32 v47, 0x0fffffff, v42
    v_mov_b32 v31, v42
    buffer_load_dword v30, v47, s[8:11], 0 offen offset:16
    s_mov_b64 exec, s[6:7]
    v_add_u32 v47, 8, v47
    v_lshrrev_b32 v31, 2, v31
    s_mov_b64 exec, -1
    buffer_load_dwordx2 v[28:29], v47, s[8:11], 0 offen
    s_waitcnt vmcnt(8)
    v_and_b32 v46, 0x80000000, v39
    v_lshrrev_b32 v47, 14, v37
    v_bitop3_b32 v47, v47, v5, v46 bitop3:0xea
    ds_read_b64 v[106:107], v47
    v_and_b32 v99, 0x40000000, v39
    v_lshrrev_b32 v47, 14, v36
    v_bitop3_b32 v47, v47, v5, v99 bitop3:0xea
    ds_read_b64 v[104:105], v47
    v_and_b32 v46, 0x20000000, v39
    v_lshrrev_b32 v47, 14, v35
    v_bitop3_b32 v47, v47, v5, v46 bitop3:0xea
    ds_read_b64 v[102:103], v47
    v_and_b32 v99, 0x10000000, v39
    v_lshrrev_b32 v47, 14, v34
    v_bitop3_b32 v47, v47, v5, v99 bitop3:0xea
    ds_read_b64 v[100:101], v47
    s_waitcnt lgkmcnt(4)
    v_cmp_ne_u64 s[50:51], v[72:73], v[68:69]
    v_cmpx_ne_u64 s[54:55], v[74:75], v[70:71]
    s_and_b64 s[82:83], s[54:55], s[80:81]
    s_cbranch_scc1 L2_c77
L2_d77:
    v_mov_b64 v[84:85], v[70:71]
    v_mov_b32 v7, v93
    v_mov_b64 v[86:87], v[74:75]
    s_or_b64 s[80:81], s[80:81], s[54:55]
    s_mov_b64 exec, s[50:51]
    s_and_b64 s[82:83], s[50:51], s[80:81]
    s_cbranch_scc1 L2_c78
L2_d78:
    v_mov_b64 v[84:85], v[68:69]
    v_mov_b32 v7, v92
    v_mov_b64 v[86:87], v[72:73]
    s_mov_b64 exec, -1
    s_or_b64 s[80:81], s[80:81], s[50:51]
    s_and_b64 exec, s[48:49], s[80:81]
    v_mfma_f32_4x4x4_16b_bf16 v[80:83], v[12:13], v[84:85], 0
    v_mov_b32 v95, v7
    s_andn2_b64 s[80:81], s[80:81], s[48:49]
    v_mfma_f32_4x4x4_16b_bf16 v[80:83], v[10:11], v[86:87], v[80:83]
    s_mov_b64 exec, -1
    ds_read_b64 v[70:71], v95 offset:65408
    ds_read_b64 v[68:69], v94 offset:65408
    v_bitop3_b32 v92, v34, v5, v99 bitop3:0xea
    v_bitop3_b32 v93, v35, v5, v46 bitop3:0xea
    v_perm_b32 v15, v35, v38, s45
    v_bitop3_b32 v46, v35, 0.5, -0.5 bitop3:0xa8
    v_perm_b32 v14, v34, v38, s44
    v_bitop3_b32 v47, v34, 0.5, -0.5 bitop3:0xa8
    v_bitop3_b32 v15, v6, v15, v46 bitop3:0xca
    v_bitop3_b32 v14, v6, v14, v47 bitop3:0xca
    s_waitcnt lgkmcnt(1)
    v_mfma_f32_4x4x4_16b_bf16 v[80:83], v[10:11], v[70:71], v[80:83]
    s_waitcnt lgkmcnt(0)
    v_mfma_f32_4x4x4_16b_bf16 v[76:79], v[10:11], v[68:69], v[76:79]
    s_nop 2
    v_cvt_pk_bf16_f32 v80, v80, v81
    v_cvt_pk_bf16_f32 v81, v82, v83
    ds_wrxchg_rtn_b64 v[74:75], v95, v[80:81] offset:65408
    v_cvt_pk_bf16_f32 v76, v76, v77
    v_cvt_pk_bf16_f32 v77, v78, v79
    ds_wrxchg_rtn_b64 v[72:73], v94, v[76:77] offset:65408
    s_barrier
    s_setprio 3
    s_mov_b32 m0, s100
    s_nop 0
    ds_write_addtid_b32 v116 offset:32768
    ds_write_addtid_b32 v117 offset:33024
    ds_write_addtid_b32 v118 offset:33280
    ds_write_addtid_b32 v119 offset:33536
    buffer_load_dwordx4 v[116:119], v3, s[16:19], s40 offen offset:2048
    ds_write_addtid_b32 v120 offset:33792
    ds_write_addtid_b32 v121 offset:34048
    ds_write_addtid_b32 v122 offset:34304
    ds_write_addtid_b32 v123 offset:34560
    buffer_load_dwordx4 v[120:123], v3, s[16:19], s40 offen offset:3072
    v_mfma_f32_4x4x4_16b_bf16 v[80:83], v[8:9], v[102:103], 0
    v_mfma_f32_4x4x4_16b_bf16 v[76:79], v[8:9], v[100:101], 0
    s_nop 3
    v_pk_mul_f32 v[80:81], v[80:81], v[14:15] op_sel:[0,1] op_sel_hi:[1,1]
    v_pk_mul_f32 v[82:83], v[82:83], v[14:15] op_sel:[0,1] op_sel_hi:[1,1]
    v_pk_mul_f32 v[76:77], v[76:77], v[14:15] op_sel:[0,0] op_sel_hi:[1,0]
    v_pk_mul_f32 v[78:79], v[78:79], v[14:15] op_sel:[0,0] op_sel_hi:[1,0]
    v_mov_b32 v44, v43
    s_cmp_gt_u32 s37, 1024
    s_cbranch_scc1 L2_xs79
    s_cmp_lg_u32 s101, 0
    s_cbranch_scc1 L2_xa79
L2_xb79:
    v_lshlrev_b32 v89, 16, v96
    v_add_u32 v90, 60, v97
    v_bitop3_b32 v90, v89, v45, v90 bitop3:0x6a
    ds_write_b32 v98, v90 offset:12
    v_lshlrev_b32 v89, 20, v96
    v_add_u32 v90, 40, v97
    v_bitop3_b32 v90, v89, v45, v90 bitop3:0x6a
    ds_write_b32 v98, v90 offset:8
    v_lshlrev_b32 v89, 24, v96
    v_add_u32 v90, 20, v97
    v_bitop3_b32 v90, v89, v45, v90 bitop3:0x6a
    ds_write_b32 v98, v90 offset:4
    v_lshlrev_b32 v89, 28, v96
    v_bitop3_b32 v90, v89, v45, v97 bitop3:0x6a
    ds_write_b32 v98, v90 offset:0
    v_mov_b32_dpp v91, v66 quad_perm:[0,0,0,0] row_mask:0xf bank_mask:0xf
    v_and_b32 v89, 3, v91
    v_and_b32 v97, 0xfffc, v91
    v_sub_u16_dpp v88, v66, v91 quad_perm:[2,2,2,2] row_mask:0xf bank_mask:0xf
    v_mad_u32_u24 v97, v97, 5, v4
    v_add_u32 v99, v88, v89
    v_bfm_b32 v96, v88, v89
    v_cmp_lt_u32 s[58:59], 16, v99
    v_lshlrev_b32 v89, v1, v96
    v_and_b32 v89, v45, v89
    v_cmp_ne_u32 vcc, 0, v89
    v_xor_b32 v90, v97, v89
    s_add_u32 s3, s37, s38
    v_mbcnt_lo_u32_b32 v98, vcc_lo, 0
    v_mbcnt_hi_u32_b32 v98, vcc_hi, v98
    s_bcnt1_i32_b64 s41, vcc
    v_lshl_add_u32 v98, v98, 2, s3
    s_mov_b64 exec, vcc
    ds_write_b32 v98, v90
    s_mov_b64 exec, -1
    s_lshl2_add_u32 s37, s41, s37
    s_cmp_lg_u64 s[58:59], 0
    s_cbranch_scc1 L2_xe79
L2_xr79:
    v_add_u32 v98, s37, v0
    v_mov_b32 v90, -1
    ds_write_b32 v98, v90
    v_add_u32 v98, s38, v0
    ds_read2st64_b32 v[40:41], v0 offset0:0 offset1:1
    ds_read_b32 v43, v0 offset:512
    v_lshrrev_b32 v98, 1, v98
    v_and_b32 v98, -4, v98
    ds_read_b32 v42, v98 offset:768
    s_sub_u32 s3, s37, 768
    s_cmp_gt_u32 s3, 128
    s_cbranch_scc1 L2_xf79
L2_xg79:
    s_setprio 2
    ds_write_addtid_b32 v124 offset:34816
    ds_write_addtid_b32 v125 offset:35072
    ds_write_addtid_b32 v126 offset:35328
    ds_write_addtid_b32 v127 offset:35584
    s_add_u32 s3, s40, 4096
    buffer_load_dwordx4 v[124:127], v3, s[16:19], s3 offen
    s_waitcnt lgkmcnt(14)
    v_cmp_ne_u64 s[50:51], v[72:73], v[68:69]
    v_cmpx_ne_u64 s[54:55], v[74:75], v[70:71]
    s_and_b64 s[82:83], s[54:55], s[80:81]
    s_cbranch_scc1 L2_c80
L2_d80:
    v_mov_b64 v[84:85], v[70:71]
    v_mov_b32 v7, v95
    v_mov_b64 v[86:87], v[74:75]
    s_or_b64 s[80:81], s[80:81], s[54:55]
    s_mov_b64 exec, s[50:51]
    s_and_b64 s[82:83], s[50:51], s[80:81]
    s_cbranch_scc1 L2_c81
L2_d81:
    v_mov_b64 v[84:85], v[68:69]
    v_mov_b32 v7, v94
    v_mov_b64 v[86:87], v[72:73]
    s_mov_b64 exec, -1
    s_or_b64 s[80:81], s[80:81], s[50:51]
    ds_read_b64 v[70:71], v93 offset:65408
    ds_read_b64 v[68:69], v92 offset:65408
    v_and_b32 v46, 0x40000000, v39
    v_bitop3_b32 v94, v36, v5, v46 bitop3:0xea
    v_and_b32 v46, 0x80000000, v39
    v_bitop3_b32 v95, v37, v5, v46 bitop3:0xea
    v_perm_b32 v15, v37, v38, s47
    v_bitop3_b32 v46, v37, 0.5, -0.5 bitop3:0xa8
    v_perm_b32 v14, v36, v38, s46
    v_bitop3_b32 v47, v36, 0.5, -0.5 bitop3:0xa8
    v_bitop3_b32 v15, v6, v15, v46 bitop3:0xca
    v_bitop3_b32 v14, v6, v14, v47 bitop3:0xca
    s_setprio 1
    s_waitcnt lgkmcnt(1)
    v_mfma_f32_4x4x4_16b_bf16 v[80:83], v[10:11], v[70:71], v[80:83]
    s_waitcnt lgkmcnt(0)
    v_mfma_f32_4x4x4_16b_bf16 v[76:79], v[10:11], v[68:69], v[76:79]
    s_nop 2
    v_cvt_pk_bf16_f32 v80, v80, v81
    v_cvt_pk_bf16_f32 v81, v82, v83
    ds_wrxchg_rtn_b64 v[74:75], v93, v[80:81] offset:65408
    v_cvt_pk_bf16_f32 v76, v76, v77
    v_cvt_pk_bf16_f32 v77, v78, v79
    ds_wrxchg_rtn_b64 v[72:73], v92, v[76:77] offset:65408
    v_and_b32 v88, 0x0fffffff, v44
    v_mov_b32 v39, v44
    buffer_load_dwordx2 v[34:35], v88, s[8:11], 0 offen
    buffer_load_dwordx3 v[36:38], v88, s[8:11], 0 offen offset:8
    s_setprio 0
    s_waitcnt vmcnt(12)
    s_mov_b32 m0, s38
    s_nop 0
    ds_write_addtid_b32 v108 offset:0
    ds_write_addtid_b32 v109 offset:256
    ds_write_addtid_b32 v110 offset:512
    ds_write_addtid_b32 v111 offset:768
    s_waitcnt vmcnt(9)
    ds_write_addtid_b32 v112 offset:1024
    ds_write_addtid_b32 v113 offset:1280
    ds_write_addtid_b32 v114 offset:1536
    ds_write_addtid_b32 v115 offset:1792
    v_mfma_f32_4x4x4_16b_bf16 v[80:83], v[8:9], v[106:107], 0
    v_mfma_f32_4x4x4_16b_bf16 v[76:79], v[8:9], v[104:105], 0
    v_cmp_lt_u32 s[84:85], v5, v94
    s_nop 2
    v_pk_mul_f32 v[80:81], v[80:81], v[14:15] op_sel:[0,1] op_sel_hi:[1,1]
    v_pk_mul_f32 v[82:83], v[82:83], v[14:15] op_sel:[0,1] op_sel_hi:[1,1]
    v_pk_mul_f32 v[76:77], v[76:77], v[14:15] op_sel:[0,0] op_sel_hi:[1,0]
    v_pk_mul_f32 v[78:79], v[78:79], v[14:15] op_sel:[0,0] op_sel_hi:[1,0]
    s_add_u32 s42, s42, 1
    s_waitcnt lgkmcnt(0)
    s_barrier
    s_bitcmp1_b32 s36, s42
    s_cbranch_scc1 L2_slow
L2_ret4:
    s_setprio 3
    s_bitcmp1_b32 s43, s42
    s_cbranch_scc1 L2_oa82
L2_ob82:
    v_and_b32 v46, 0x20000000, v21
    v_lshrrev_b32 v47, 14, v17
    v_bitop3_b32 v47, v47, v5, v46 bitop3:0xea
    ds_read_b64 v[102:103], v47
    v_and_b32 v99, 0x10000000, v21
    v_lshrrev_b32 v47, 14, v16
    v_bitop3_b32 v47, v47, v5, v99 bitop3:0xea
    ds_read_b64 v[100:101], v47
    v_cmp_ne_u64 s[50:51], v[72:73], v[68:69]
    v_cmpx_ne_u64 s[54:55], v[74:75], v[70:71]
    s_and_b64 s[82:83], s[54:55], s[80:81]
    s_cbranch_scc1 L2_c83
L2_d83:
    v_mov_b64 v[84:85], v[70:71]
    v_mov_b32 v7, v93
    v_mov_b64 v[86:87], v[74:75]
    s_or_b64 s[80:81], s[80:81], s[54:55]
    s_mov_b64 exec, s[50:51]
    s_and_b64 s[82:83], s[50:51], s[80:81]
    s_cbranch_scc1 L2_c84
L2_d84:
    v_mov_b64 v[84:85], v[68:69]
    v_mov_b32 v7, v92
    v_mov_b64 v[86:87], v[72:73]
    s_mov_b64 exec, -1
    s_or_b64 s[80:81], s[80:81], s[50:51]
    s_and_b64 exec, s[84:85], s[80:81]
    v_mfma_f32_4x4x4_16b_bf16 v[76:79], v[12:13], v[84:85], 0
    v_mov_b32 v94, v7
    s_andn2_b64 s[80:81], s[80:81], s[84:85]
    v_mfma_f32_4x4x4_16b_bf16 v[76:79], v[10:11], v[86:87], v[76:79]
    s_mov_b64 exec, -1
    ds_read_b64 v[70:71], v95 offset:65408
    ds_read_b64 v[68:69], v94 offset:65408
    v_bitop3_b32 v92, v16, v5, v99 bitop3:0xea
    v_bitop3_b32 v93, v17, v5, v46 bitop3:0xea
    v_perm_b32 v15, v17, v20, s45
    v_bitop3_b32 v46, v17, 0.5, -0.5 bitop3:0xa8
    v_perm_b32 v14, v16, v20, s44
    v_bitop3_b32 v47, v16, 0.5, -0.5 bitop3:0xa8
    v_bitop3_b32 v15, v6, v15, v46 bitop3:0xca
    v_bitop3_b32 v14, v6, v14, v47 bitop3:0xca
    s_waitcnt lgkmcnt(1)
    v_mfma_f32_4x4x4_16b_bf16 v[80:83], v[10:11], v[70:71], v[80:83]
    s_waitcnt lgkmcnt(0)
    v_mfma_f32_4x4x4_16b_bf16 v[76:79], v[10:11], v[68:69], v[76:79]
    s_nop 2
    v_cvt_pk_bf16_f32 v80, v80, v81
    v_cvt_pk_bf16_f32 v81, v82, v83
    ds_wrxchg_rtn_b64 v[74:75], v95, v[80:81] offset:65408
    v_cvt_pk_bf16_f32 v76, v76, v77
    v_cvt_pk_bf16_f32 v77, v78, v79
    ds_wrxchg_rtn_b64 v[72:73], v94, v[76:77] offset:65408
    v_mfma_f32_4x4x4_16b_bf16 v[80:83], v[8:9], v[102:103], 0
    v_mfma_f32_4x4x4_16b_bf16 v[76:79], v[8:9], v[100:101], 0
    v_cmp_lt_u32 s[84:85], v5, v92
    s_nop 2
    v_pk_mul_f32 v[80:81], v[80:81], v[14:15] op_sel:[0,1] op_sel_hi:[1,1]
    v_pk_mul_f32 v[82:83], v[82:83], v[14:15] op_sel:[0,1] op_sel_hi:[1,1]
    v_pk_mul_f32 v[76:77], v[76:77], v[14:15] op_sel:[0,0] op_sel_hi:[1,0]
    v_pk_mul_f32 v[78:79], v[78:79], v[14:15] op_sel:[0,0] op_sel_hi:[1,0]
    buffer_load_dwordx4 v[108:111], v3, s[16:19], s40 offen offset:0
    v_and_b32 v46, 0x80000000, v21
    v_lshrrev_b32 v47, 14, v19
    v_bitop3_b32 v47, v47, v5, v46 bitop3:0xea
    ds_read_b64 v[106:107], v47
    v_and_b32 v99, 0x40000000, v21
    v_lshrrev_b32 v47, 14, v18
    v_bitop3_b32 v47, v47, v5, v99 bitop3:0xea
    ds_read_b64 v[104:105], v47
    s_waitcnt lgkmcnt(2)
    v_cmp_ne_u64 s[50:51], v[72:73], v[68:69]
    v_cmpx_ne_u64 s[54:55], v[74:75], v[70:71]
    s_and_b64 s[82:83], s[54:55], s[80:81]
    s_cbranch_scc1 L2_c85
L2_d85:
    v_mov_b64 v[84:85], v[70:71]
    v_mov_b32 v7, v95
    v_mov_b64 v[86:87], v[74:75]
    s_or_b64 s[80:81], s[80:81], s[54:55]
    s_mov_b64 exec, s[50:51]
    s_and_b64 s[82:83], s[50:51], s[80:81]
    s_cbranch_scc1 L2_c86
L2_d86:
    v_mov_b64 v[84:85], v[68:69]
    v_mov_b32 v7, v94
    v_mov_b64 v[86:87], v[72:73]
    s_mov_b64 exec, -1
    s_or_b64 s[80:81], s[80:81], s[50:51]
    s_and_b64 exec, s[84:85], s[80:81]
    v_mfma_f32_4x4x4_16b_bf16 v[76:79], v[12:13], v[84:85], 0
    v_mov_b32 v92, v7
    s_andn2_b64 s[80:81], s[80:81], s[84:85]
    v_mfma_f32_4x4x4_16b_bf16 v[76:79], v[10:11], v[86:87], v[76:79]
    s_mov_b64 exec, -1
    ds_read_b64 v[70:71], v93 offset:65408
    ds_read_b64 v[68:69], v92 offset:65408
    v_bitop3_b32 v94, v18, v5, v99 bitop3:0xea
    v_bitop3_b32 v95, v19, v5, v46 bitop3:0xea
    v_perm_b32 v15, v19, v20, s47
    v_bitop3_b32 v46, v19, 0.5, -0.5 bitop3:0xa8
    v_perm_b32 v14, v18, v20, s46
    v_bitop3_b32 v47, v18, 0.5, -0.5 bitop3:0xa8
    v_bitop3_b32 v15, v6, v15, v46 bitop3:0xca
    v_bitop3_b32 v14, v6, v14, v47 bitop3:0xca
    s_waitcnt lgkmcnt(1)
    v_mfma_f32_4x4x4_16b_bf16 v[80:83], v[10:11], v[70:71], v[80:83]
    s_waitcnt lgkmcnt(0)
    v_mfma_f32_4x4x4_16b_bf16 v[76:79], v[10:11], v[68:69], v[76:79]
    s_nop 2
    v_cvt_pk_bf16_f32 v80, v80, v81
    v_cvt_pk_bf16_f32 v81, v82, v83
    ds_wrxchg_rtn_b64 v[74:75], v93, v[80:81] offset:65408
    v_cvt_pk_bf16_f32 v76, v76, v77
    v_cvt_pk_bf16_f32 v77, v78, v79
    ds_wrxchg_rtn_b64 v[72:73], v92, v[76:77] offset:65408
    v_and_b32 v88, 0x0fffffff, v40
    v_mov_b32 v21, v40
    buffer_load_dwordx2 v[16:17], v88, s[8:11], 0 offen
    buffer_load_dwordx3 v[18:20], v88, s[8:11], 0 offen offset:8
    s_setprio 2
    v_mfma_f32_4x4x4_16b_bf16 v[80:83], v[8:9], v[106:107], 0
    v_mfma_f32_4x4x4_16b_bf16 v[76:79], v[8:9], v[104:105], 0
    v_cmp_lt_u32 s[48:49], v5, v95
    s_nop 2
    v_pk_mul_f32 v[80:81], v[80:81], v[14:15] op_sel:[0,1] op_sel_hi:[1,1]
    v_pk_mul_f32 v[82:83], v[82:83], v[14:15] op_sel:[0,1] op_sel_hi:[1,1]
    v_pk_mul_f32 v[76:77], v[76:77], v[14:15] op_sel:[0,0] op_sel_hi:[1,0]
    v_pk_mul_f32 v[78:79], v[78:79], v[14:15] op_sel:[0,0] op_sel_hi:[1,0]
    s_waitcnt vmcnt(10)
    v_and_b32 v46, 0x20000000, v27
    v_lshrrev_b32 v47, 14, v23
    v_bitop3_b32 v47, v47, v5, v46 bitop3:0xea
    ds_read_b64 v[102:103], v47
    v_and_b32 v99, 0x10000000, v27
    v_lshrrev_b32 v47, 14, v22
    v_bitop3_b32 v47, v47, v5, v99 bitop3:0xea
    ds_read_b64 v[100:101], v47
    s_waitcnt lgkmcnt(2)
    v_cmp_ne_u64 s[50:51], v[72:73], v[68:69]
    v_cmpx_ne_u64 s[54:55], v[74:75], v[70:71]
    s_and_b64 s[82:83], s[54:55], s[80:81]
    s_cbranch_scc1 L2_c87
L2_d87:
    v_mov_b64 v[84:85], v[70:71]
    v_mov_b32 v7, v93
    v_mov_b64 v[86:87], v[74:75]
    s_or_b64 s[80:81], s[80:81], s[54:55]
    s_mov_b64 exec, s[50:51]
    s_and_b64 s[82:83], s[50:51], s[80:81]
    s_cbranch_scc1 L2_c88
L2_d88:
    v_mov_b64 v[84:85], v[68:69]
    v_mov_b32 v7, v92
    v_mov_b64 v[86:87], v[72:73]
    s_mov_b64 exec, -1
    s_or_b64 s[80:81], s[80:81], s[50:51]
    s_and_b64 exec, s[48:49], s[80:81]
    v_mfma_f32_4x4x4_16b_bf16 v[80:83], v[12:13], v[84:85], 0
    v_mov_b32 v95, v7
    s_andn2_b64 s[80:81], s[80:81], s[48:49]
    v_mfma_f32_4x4x4_16b_bf16 v[80:83], v[10:11], v[86:87], v[80:83]
    s_mov_b64 exec, -1
    ds_read_b64 v[70:71], v95 offset:65408
    ds_read_b64 v[68:69], v94 offset:65408
    v_bitop3_b32 v92, v22, v5, v99 bitop3:0xea
    v_bitop3_b32 v93, v23, v5, v46 bitop3:0xea
    v_perm_b32 v15, v23, v26, s45
    v_bitop3_b32 v46, v23, 0.5, -0.5 bitop3:0xa8
    v_perm_b32 v14, v22, v26, s44
    v_bitop3_b32 v47, v22, 0.5, -0.5 bitop3:0xa8
    v_bitop3_b32 v15, v6, v15, v46 bitop3:0xca
    v_bitop3_b32 v14, v6, v14, v47 bitop3:0xca
    s_waitcnt lgkmcnt(1)
    v_mfma_f32_4x4x4_16b_bf16 v[80:83], v[10:11], v[70:71], v[80:83]
    s_waitcnt lgkmcnt(0)
    v_mfma_f32_4x4x4_16b_bf16 v[76:79], v[10:11], v[68:69], v[76:79]
    s_nop 2
    v_cvt_pk_bf16_f32 v80, v80, v81
    v_cvt_pk_bf16_f32 v81, v82, v83
    ds_wrxchg_rtn_b64 v[74:75], v95, v[80:81] offset:65408
    v_cvt_pk_bf16_f32 v76, v76, v77
    v_cvt_pk_bf16_f32 v77, v78, v79
    ds_wrxchg_rtn_b64 v[72:73], v94, v[76:77] offset:65408
    s_setprio 1
    v_mfma_f32_4x4x4_16b_bf16 v[80:83], v[8:9], v[102:103], 0
    v_mfma_f32_4x4x4_16b_bf16 v[76:79], v[8:9], v[100:101], 0
    s_nop 3
    v_pk_mul_f32 v[80:81], v[80:81], v[14:15] op_sel:[0,1] op_sel_hi:[1,1]
    v_pk_mul_f32 v[82:83], v[82:83], v[14:15] op_sel:[0,1] op_sel_hi:[1,1]
    v_pk_mul_f32 v[76:77], v[76:77], v[14:15] op_sel:[0,0] op_sel_hi:[1,0]
    v_pk_mul_f32 v[78:79], v[78:79], v[14:15] op_sel:[0,0] op_sel_hi:[1,0]
    s_bitcmp1_b32 s43, s42
    s_cbranch_scc1 L2_oa89
L2_ob89:
    buffer_load_dwordx4 v[112:115], v3, s[16:19], s40 offen offset:1024
    v_sub_u16 v88, v60, v52
    v_and_b32 v89, 3, v52
    v_add3_u32 v99, v88, v89, 3
    v_and_b32 v99, -4, v99
    v_max_u32 v99, 4, v99
    v_and_b32 v97, 0xfffc, v52
    v_bfm_b32 v96, v88, v89
    v_add_u32_dpp v91, v99, v99 row_shr:1 row_mask:0xf bank_mask:0xf bound_ctrl:1
    v_mad_u32_u24 v97, v97, 5, v2
    v_cmp_lt_u32 vcc, 16, v99
    v_add_u32_dpp v91, v91, v91 row_shr:2 row_mask:0xf bank_mask:0xf bound_ctrl:1
    v_sub_u32 v98, s38, v99
    v_lshrrev_b64 v[52:53], 16, v[52:53]
    v_add_u32_dpp v91, v91, v91 row_shr:4 row_mask:0xf bank_mask:0xf bound_ctrl:1
    v_lshrrev_b64 v[60:61], 16, v[60:61]
    s_mov_b32 s101, 0
    v_add_u32_dpp v91, v91, v91 row_shr:8 row_mask:0xf bank_mask:0xf bound_ctrl:1
    s_nop 1
    v_add_u32_dpp v91, v91, v91 row_bcast:15 row_mask:0xa bank_mask:0xf
    s_nop 1
    v_add_u32_dpp v91, v91, v91 row_bcast:31 row_mask:0xc bank_mask:0xf
    v_add_u32 v98, v98, v91
    v_readlane_b32 s37, v91, 63
    s_cbranch_vccnz L2_xo90
L2_xp90:
    v_and_b32 v46, 0x80000000, v27
    v_lshrrev_b32 v47, 14, v25
    v_bitop3_b32 v47, v47, v5, v46 bitop3:0xea
    ds_read_b64 v[106:107], v47
    v_and_b32 v99, 0x40000000, v27
    v_lshrrev_b32 v47, 14, v24
    v_bitop3_b32 v47, v47, v5, v99 bitop3:0xea
    ds_read_b64 v[104:105], v47
    s_waitcnt lgkmcnt(2)
    v_cmp_ne_u64 s[50:51], v[72:73], v[68:69]
    v_cmpx_ne_u64 s[54:55], v[74:75], v[70:71]
    s_and_b64 s[82:83], s[54:55], s[80:81]
    s_cbranch_scc1 L2_c91
L2_d91:
    v_mov_b64 v[84:85], v[70:71]
    v_mov_b32 v7, v95
    v_mov_b64 v[86:87], v[74:75]
    s_or_b64 s[80:81], s[80:81], s[54:55]
    s_mov_b64 exec, s[50:51]
    s_and_b64 s[82:83], s[50:51], s[80:81]
    s_cbranch_scc1 L2_c92
L2_d92:
    v_mov_b64 v[84:85], v[68:69]
    v_mov_b32 v7, v94
    v_mov_b64 v[86:87], v[72:73]
    s_mov_b64 exec, -1
    s_or_b64 s[80:81], s[80:81], s[50:51]
    ds_read_b64 v[70:71], v93 offset:65408
    ds_read_b64 v[68:69], v92 offset:65408
    v_bitop3_b32 v94, v24, v5, v99 bitop3:0xea
    v_bitop3_b32 v95, v25, v5, v46 bitop3:0xea
    v_perm_b32 v15, v25, v26, s47
    v_bitop3_b32 v46, v25, 0.5, -0.5 bitop3:0xa8
    v_perm_b32 v14, v24, v26, s46
    v_bitop3_b32 v47, v24, 0.5, -0.5 bitop3:0xa8
    v_bitop3_b32 v15, v6, v15, v46 bitop3:0xca
    v_bitop3_b32 v14, v6, v14, v47 bitop3:0xca
    s_waitcnt lgkmcnt(1)
    v_mfma_f32_4x4x4_16b_bf16 v[80:83], v[10:11], v[70:71], v[80:83]
    s_waitcnt lgkmcnt(0)
    v_mfma_f32_4x4x4_16b_bf16 v[76:79], v[10:11], v[68:69], v[76:79]
    s_nop 2
    v_cvt_pk_bf16_f32 v80, v80, v81
    v_cvt_pk_bf16_f32 v81, v82, v83
    ds_wrxchg_rtn_b64 v[74:75], v93, v[80:81] offset:65408
    v_cvt_pk_bf16_f32 v76, v76, v77
    v_cvt_pk_bf16_f32 v77, v78, v79
    ds_wrxchg_rtn_b64 v[72:73], v92, v[76:77] offset:65408
    v_and_b32 v88, 0x0fffffff, v41
    v_mov_b32 v27, v41
    buffer_load_dwordx2 v[22:23], v88, s[8:11], 0 offen
    buffer_load_dwordx3 v[24:26], v88, s[8:11], 0 offen offset:8
    v_mfma_f32_4x4x4_16b_bf16 v[80:83], v[8:9], v[106:107], 0
    v_mfma_f32_4x4x4_16b_bf16 v[76:79], v[8:9], v[104:105], 0
    v_cmp_lt_u32 s[84:85], v5, v94
    s_nop 2
    v_pk_mul_f32 v[80:81], v[80:81], v[14:15] op_sel:[0,1] op_sel_hi:[1,1]
    v_pk_mul_f32 v[82:83], v[82:83], v[14:15] op_sel:[0,1] op_sel_hi:[1,1]
    v_pk_mul_f32 v[76:77], v[76:77], v[14:15] op_sel:[0,0] op_sel_hi:[1,0]
    v_pk_mul_f32 v[78:79], v[78:79], v[14:15] op_sel:[0,0] op_sel_hi:[1,0]
    s_waitcnt vmcnt(11)
    s_mov_b64 exec, s[6:7]
    v_lshrrev_b32 v30, 16, v30
    s_mov_b64 exec, -1
    v_and_b32 v46, 0x20000000, v31
    v_lshrrev_b32 v47, 14, v29
    v_bitop3_b32 v47, v47, v5, v46 bitop3:0xea
    ds_read_b64 v[102:103], v47
    v_and_b32 v99, 0x10000000, v31
    v_lshrrev_b32 v47, 14, v28
    v_bitop3_b32 v47, v47, v5, v99 bitop3:0xea
    ds_read_b64 v[100:101], v47
    s_waitcnt lgkmcnt(2)
    v_cmp_ne_u64 s[50:51], v[72:73], v[68:69]
    v_cmpx_ne_u64 s[54:55], v[74:75], v[70:71]
    s_and_b64 s[82:83], s[54:55], s[80:81]
    s_cbranch_scc1 L2_c93
L2_d93:
    v_mov_b64 v[84:85], v[70:71]
    v_mov_b32 v7, v93
    v_mov_b64 v[86:87], v[74:75]
    s_or_b64 s[80:81], s[80:81], s[54:55]
    s_mov_b64 exec, s[50:51]
    s_and_b64 s[82:83], s[50:51], s[80:81]
    s_cbranch_scc1 L2_c94
L2_d94:
    v_mov_b64 v[84:85], v[68:69]
    v_mov_b32 v7, v92
    v_mov_b64 v[86:87], v[72:73]
    s_mov_b64 exec, -1
    s_or_b64 s[80:81], s[80:81], s[50:51]
    s_and_b64 exec, s[84:85], s[80:81]
    v_mfma_f32_4x4x4_16b_bf16 v[76:79], v[12:13], v[84:85], 0
    v_mov_b32 v94, v7
    s_andn2_b64 s[80:81], s[80:81], s[84:85]
    v_mfma_f32_4x4x4_16b_bf16 v[76:79], v[10:11], v[86:87], v[76:79]
    s_mov_b64 exec, -1
    ds_read_b64 v[70:71], v95 offset:65408
    ds_read_b64 v[68:69], v94 offset:65408
    v_bitop3_b32 v92, v28, v5, v99 bitop3:0xea
    v_bitop3_b32 v93, v29, v5, v46 bitop3:0xea
    v_perm_b32 v15, v29, v30, s45
    v_bitop3_b32 v46, v29, 0.5, -0.5 bitop3:0xa8
    v_perm_b32 v14, v28, v30, s44
    v_bitop3_b32 v47, v28, 0.5, -0.5 bitop3:0xa8
    v_bitop3_b32 v15, v6, v15, v46 bitop3:0xca
    v_bitop3_b32 v14, v6, v14, v47 bitop3:0xca
    s_waitcnt lgkmcnt(1)
    v_mfma_f32_4x4x4_16b_bf16 v[80:83], v[10:11], v[70:71], v[80:83]
    s_waitcnt lgkmcnt(0)
    v_mfma_f32_4x4x4_16b_bf16 v[76:79], v[10:11], v[68:69], v[76:79]
    s_nop 2
    v_cvt_pk_bf16_f32 v80, v80, v81
    v_cvt_pk_bf16_f32 v81, v82, v83
    ds_wrxchg_rtn_b64 v[74:75], v95, v[80:81] offset:65408
    v_cvt_pk_bf16_f32 v76, v76, v77
    v_cvt_pk_bf16_f32 v77, v78, v79
    ds_wrxchg_rtn_b64 v[72:73], v94, v[76:77] offset:65408
    s_setprio 0
    v_mfma_f32_4x4x4_16b_bf16 v[80:83], v[8:9], v[102:103], 0
    v_mfma_f32_4x4x4_16b_bf16 v[76:79], v[8:9], v[100:101], 0
    v_cmp_lt_u32 s[48:49], v5, v93
    s_nop 2
    v_pk_mul_f32 v[80:81], v[80:81], v[14:15] op_sel:[0,1] op_sel_hi:[1,1]
    v_pk_mul_f32 v[82:83], v[82:83], v[14:15] op_sel:[0,1] op_sel_hi:[1,1]
    v_pk_mul_f32 v[76:77], v[76:77], v[14:15] op_sel:[0,0] op_sel_hi:[1,0]
    v_pk_mul_f32 v[78:79], v[78:79], v[14:15] op_sel:[0,0] op_sel_hi:[1,0]
    s_add_u32 s40, s40, 0x50000
    v_and_b32 v47, 0x0fffffff, v42
    v_mov_b32 v31, v42
    buffer_load_dword v30, v47, s[8:11], 0 offen offset:16
    s_mov_b64 exec, s[6:7]
    v_add_u32 v47, 8, v47
    v_lshrrev_b32 v31, 2, v31
    s_mov_b64 exec, -1
    buffer_load_dwordx2 v[28:29], v47, s[8:11], 0 offen
    s_waitcnt vmcnt(8)
    v_and_b32 v46, 0x80000000, v39
    v_lshrrev_b32 v47, 14, v37
    v_bitop3_b32 v47, v47, v5, v46 bitop3:0xea
    ds_read_b64 v[102:103], v47
    v_and_b32 v99, 0x40000000, v39
    v_lshrrev_b32 v47, 14, v36
    v_bitop3_b32 v47, v47, v5, v99 bitop3:0xea
    ds_read_b64 v[100:101], v47
    v_and_b32 v46, 0x20000000, v39
    v_lshrrev_b32 v47, 14, v35
    v_bitop3_b32 v47, v47, v5, v46 bitop3:0xea
    ds_read_b64 v[106:107], v47
    v_and_b32 v99, 0x10000000, v39
    v_lshrrev_b32 v47, 14, v34
    v_bitop3_b32 v47, v47, v5, v99 bitop3:0xea
    ds_read_b64 v[104:105], v47
    s_waitcnt lgkmcnt(4)
    v_cmp_ne_u64 s[50:51], v[72:73], v[68:69]
    v_cmpx_ne_u64 s[54:55], v[74:75], v[70:71]
    s_and_b64 s[82:83], s[54:55], s[80:81]
    s_cbranch_scc1 L2_c95
L2_d95:
    v_mov_b64 v[84:85], v[70:71]
    v_mov_b32 v7, v95
    v_mov_b64 v[86:87], v[74:75]
    s_or_b64 s[80:81], s[80:81], s[54:55]
    s_mov_b64 exec, s[50:51]
    s_and_b64 s[82:83], s[50:51], s[80:81]
    s_cbranch_scc1 L2_c96
L2_d96:
    v_mov_b64 v[84:85], v[68:69]
    v_mov_b32 v7, v94
    v_mov_b64 v[86:87], v[72:73]
    s_mov_b64 exec, -1
    s_or_b64 s[80:81], s[80:81], s[50:51]
    s_and_b64 exec, s[48:49], s[80:81]
    v_mfma_f32_4x4x4_16b_bf16 v[80:83], v[12:13], v[84:85], 0
    v_mov_b32 v93, v7
    s_andn2_b64 s[80:81], s[80:81], s[48:49]
    v_mfma_f32_4x4x4_16b_bf16 v[80:83], v[10:11], v[86:87], v[80:83]
    s_mov_b64 exec, -1
    ds_read_b64 v[70:71], v93 offset:65408
    ds_read_b64 v[68:69], v92 offset:65408
    v_bitop3_b32 v94, v34, v5, v99 bitop3:0xea
    v_bitop3_b32 v95, v35, v5, v46 bitop3:0xea
    v_perm_b32 v15, v35, v38, s45
    v_bitop3_b32 v46, v35, 0.5, -0.5 bitop3:0xa8
    v_perm_b32 v14, v34, v38, s44
    v_bitop3_b32 v47, v34, 0.5, -0.5 bitop3:0xa8
    v_bitop3_b32 v15, v6, v15, v46 bitop3:0xca
    v_bitop3_b32 v14, v6, v14, v47 bitop3:0xca
    s_waitcnt lgkmcnt(1)
    v_mfma_f32_4x4x4_16b_bf16 v[80:83], v[10:11], v[70:71], v[80:83]
    s_waitcnt lgkmcnt(0)
    v_mfma_f32_4x4x4_16b_bf16 v[76:79], v[10:11], v[68:69], v[76:79]
    s_nop 2
    v_cvt_pk_bf16_f32 v80, v80, v81
    v_cvt_pk_bf16_f32 v81, v82, v83
    ds_wrxchg_rtn_b64 v[74:75], v93, v[80:81] offset:65408
    v_cvt_pk_bf16_f32 v76, v76, v77
    v_cvt_pk_bf16_f32 v77, v78, v79
    ds_wrxchg_rtn_b64 v[72:73], v92, v[76:77] offset:65408
    s_barrier
    s_setprio 3
    s_mov_b32 m0, s100
    s_nop 0
    ds_write_addtid_b32 v116 offset:32768
    ds_write_addtid_b32 v117 offset:33024
    ds_write_addtid_b32 v118 offset:33280
    ds_write_addtid_b32 v119 offset:33536
    buffer_load_dwordx4 v[116:119], v3, s[16:19], s40 offen offset:2048
    ds_write_addtid_b32 v120 offset:33792
    ds_write_addtid_b32 v121 offset:34048
    ds_write_addtid_b32 v122 offset:34304
    ds_write_addtid_b32 v123 offset:34560
    buffer_load_dwordx4 v[120:123], v3, s[16:19], s40 offen offset:3072
    v_mfma_f32_4x4x4_16b_bf16 v[80:83], v[8:9], v[106:107], 0
    v_mfma_f32_4x4x4_16b_bf16 v[76:79], v[8:9], v[104:105], 0
    s_nop 3
    v_pk_mul_f32 v[80:81], v[80:81], v[14:15] op_sel:[0,1] op_sel_hi:[1,1]
    v_pk_mul_f32 v[82:83], v[82:83], v[14:15] op_sel:[0,1] op_sel_hi:[1,1]
    v_pk_mul_f32 v[76:77], v[76:77], v[14:15] op_sel:[0,0] op_sel_hi:[1,0]
    v_pk_mul_f32 v[78:79], v[78:79], v[14:15] op_sel:[0,0] op_sel_hi:[1,0]
    v_mov_b32 v44, v43
    s_cmp_gt_u32 s37, 1024
    s_cbranch_scc1 L2_xs97
    s_cmp_lg_u32 s101, 0
    s_cbranch_scc1 L2_xa97
L2_xb97:
    v_lshlrev_b32 v89, 16, v96
    v_add_u32 v90, 60, v97
    v_bitop3_b32 v90, v89, v45, v90 bitop3:0x6a
    ds_write_b32 v98, v90 offset:12
    v_lshlrev_b32 v89, 20, v96
    v_add_u32 v90, 40, v97
    v_bitop3_b32 v90, v89, v45, v90 bitop3:0x6a
    ds_write_b32 v98, v90 offset:8
    v_lshlrev_b32 v89, 24, v96
    v_add_u32 v90, 20, v97
    v_bitop3_b32 v90, v89, v45, v90 bitop3:0x6a
    ds_write_b32 v98, v90 offset:4
    v_lshlrev_b32 v89, 28, v96
    v_bitop3_b32 v90, v89, v45, v97 bitop3:0x6a
    ds_write_b32 v98, v90 offset:0
    v_mov_b32_dpp v91, v64 quad_perm:[1,1,1,1] row_mask:0xf bank_mask:0xf
    v_and_b32 v89, 3, v91
    v_and_b32 v97, 0xfffc, v91
    v_sub_u16_dpp v88, v64, v91 quad_perm:[3,3,3,3] row_mask:0xf bank_mask:0xf
    v_mad_u32_u24 v97, v97, 5, v4
    v_add_u32 v99, v88, v89
    v_bfm_b32 v96, v88, v89
    v_cmp_lt_u32 s[58:59], 16, v99
    v_lshlrev_b32 v89, v1, v96
    v_and_b32 v89, v45, v89
    v_cmp_ne_u32 vcc, 0, v89
    v_xor_b32 v90, v97, v89
    s_add_u32 s3, s37, s38
    v_mbcnt_lo_u32_b32 v98, vcc_lo, 0
    v_mbcnt_hi_u32_b32 v98, vcc_hi, v98
    s_bcnt1_i32_b64 s41, vcc
    v_lshl_add_u32 v98, v98, 2, s3
    s_mov_b64 exec, vcc
    ds_write_b32 v98, v90
    s_mov_b64 exec, -1
    s_lshl2_add_u32 s37, s41, s37
    s_cmp_lg_u64 s[58:59], 0
    s_cbranch_scc1 L2_xe97
L2_xr97:
    v_add_u32 v98, s37, v0
    v_mov_b32 v90, -1
    ds_write_b32 v98, v90
    v_add_u32 v98, s38, v0
    ds_read2st64_b32 v[40:41], v0 offset0:0 offset1:1
    ds_read_b32 v43, v0 offset:512
    v_lshrrev_b32 v98, 1, v98
    v_and_b32 v98, -4, v98
    ds_read_b32 v42, v98 offset:768
    s_sub_u32 s3, s37, 768
    s_cmp_gt_u32 s3, 128
    s_cbranch_scc1 L2_xf97
L2_xg97:
    s_setprio 2
    ds_write_addtid_b32 v124 offset:34816
    ds_write_addtid_b32 v125 offset:35072
    ds_write_addtid_b32 v126 offset:35328
    ds_write_addtid_b32 v127 offset:35584
    s_add_u32 s3, s40, 4096
    buffer_load_dwordx4 v[124:127], v3, s[16:19], s3 offen
    s_waitcnt lgkmcnt(14)
    v_cmp_ne_u64 s[50:51], v[72:73], v[68:69]
    v_cmpx_ne_u64 s[54:55], v[74:75], v[70:71]
    s_and_b64 s[82:83], s[54:55], s[80:81]
    s_cbranch_scc1 L2_c98
L2_d98:
    v_mov_b64 v[84:85], v[70:71]
    v_mov_b32 v7, v93
    v_mov_b64 v[86:87], v[74:75]
    s_or_b64 s[80:81], s[80:81], s[54:55]
    s_mov_b64 exec, s[50:51]
    s_and_b64 s[82:83], s[50:51], s[80:81]
    s_cbranch_scc1 L2_c99
L2_d99:
    v_mov_b64 v[84:85], v[68:69]
    v_mov_b32 v7, v92
    v_mov_b64 v[86:87], v[72:73]
    s_mov_b64 exec, -1
    s_or_b64 s[80:81], s[80:81], s[50:51]
    ds_read_b64 v[70:71], v95 offset:65408
    ds_read_b64 v[68:69], v94 offset:65408
    v_and_b32 v46, 0x40000000, v39
    v_bitop3_b32 v92, v36, v5, v46 bitop3:0xea
    v_and_b32 v46, 0x80000000, v39
    v_bitop3_b32 v93, v37, v5, v46 bitop3:0xea
    v_perm_b32 v15, v37, v38, s47
    v_bitop3_b32 v46, v37, 0.5, -0.5 bitop3:0xa8
    v_perm_b32 v14, v36, v38, s46
    v_bitop3_b32 v47, v36, 0.5, -0.5 bitop3:0xa8
    v_bitop3_b32 v15, v6, v15, v46 bitop3:0xca
    v_bitop3_b32 v14, v6, v14, v47 bitop3:0xca
    s_setprio 1
    s_waitcnt lgkmcnt(1)
    v_mfma_f32_4x4x4_16b_bf16 v[80:83], v[10:11], v[70:71], v[80:83]
    s_waitcnt lgkmcnt(0)
    v_mfma_f32_4x4x4_16b_bf16 v[76:79], v[10:11], v[68:69], v[76:79]
    s_nop 2
    v_cvt_pk_bf16_f32 v80, v80, v81
    v_cvt_pk_bf16_f32 v81, v82, v83
    ds_wrxchg_rtn_b64 v[74:75], v95, v[80:81] offset:65408
    v_cvt_pk_bf16_f32 v76, v76, v77
    v_cvt_pk_bf16_f32 v77, v78, v79
    ds_wrxchg_rtn_b64 v[72:73], v94, v[76:77] offset:65408
    v_and_b32 v88, 0x0fffffff, v44
    v_mov_b32 v39, v44
    buffer_load_dwordx2 v[34:35], v88, s[8:11], 0 offen
    buffer_load_dwordx3 v[36:38], v88, s[8:11], 0 offen offset:8
    s_setprio 0
    s_waitcnt vmcnt(12)
    s_mov_b32 m0, s38
    s_nop 0
    ds_write_addtid_b32 v108 offset:0
    ds_write_addtid_b32 v109 offset:256
    ds_write_addtid_b32 v110 offset:512
    ds_write_addtid_b32 v111 offset:768
    s_waitcnt vmcnt(9)
    ds_write_addtid_b32 v112 offset:1024
    ds_write_addtid_b32 v113 offset:1280
    ds_write_addtid_b32 v114 offset:1536
    ds_write_addtid_b32 v115 offset:1792
    v_mfma_f32_4x4x4_16b_bf16 v[80:83], v[8:9], v[102:103], 0
    v_mfma_f32_4x4x4_16b_bf16 v[76:79], v[8:9], v[100:101], 0
    v_cmp_lt_u32 s[84:85], v5, v92
    s_nop 2
    v_pk_mul_f32 v[80:81], v[80:81], v[14:15] op_sel:[0,1] op_sel_hi:[1,1]
    v_pk_mul_f32 v[82:83], v[82:83], v[14:15] op_sel:[0,1] op_sel_hi:[1,1]
    v_pk_mul_f32 v[76:77], v[76:77], v[14:15] op_sel:[0,0] op_sel_hi:[1,0]
    v_pk_mul_f32 v[78:79], v[78:79], v[14:15] op_sel:[0,0] op_sel_hi:[1,0]
    s_add_u32 s42, s42, 1
    s_waitcnt lgkmcnt(0)
    s_barrier
    s_bitcmp1_b32 s36, s42
    s_cbranch_scc1 L2_slow
L2_ret5:
    s_setprio 3
    s_bitcmp1_b32 s43, s42
    s_cbranch_scc1 L2_oa100
L2_ob100:
    v_and_b32 v46, 0x20000000, v21
    v_lshrrev_b32 v47, 14, v17
    v_bitop3_b32 v47, v47, v5, v46 bitop3:0xea
    ds_read_b64 v[106:107], v47
    v_and_b32 v99, 0x10000000, v21
    v_lshrrev_b32 v47, 14, v16
    v_bitop3_b32 v47, v47, v5, v99 bitop3:0xea
    ds_read_b64 v[104:105], v47
    v_cmp_ne_u64 s[50:51], v[72:73], v[68:69]
    v_cmpx_ne_u64 s[54:55], v[74:75], v[70:71]
    s_and_b64 s[82:83], s[54:55], s[80:81]
    s_cbranch_scc1 L2_c101
L2_d101:
    v_mov_b64 v[84:85], v[70:71]
    v_mov_b32 v7, v95
    v_mov_b64 v[86:87], v[74:75]
    s_or_b64 s[80:81], s[80:81], s[54:55]
    s_mov_b64 exec, s[50:51]
    s_and_b64 s[82:83], s[50:51], s[80:81]
    s_cbranch_scc1 L2_c102
L2_d102:
    v_mov_b64 v[84:85], v[68:69]
    v_mov_b32 v7, v94
    v_mov_b64 v[86:87], v[72:73]
    s_mov_b64 exec, -1
    s_or_b64 s[80:81], s[80:81], s[50:51]
    s_and_b64 exec, s[84:85], s[80:81]
    v_mfma_f32_4x4x4_16b_bf16 v[76:79], v[12:13], v[84:85], 0
    v_mov_b32 v92, v7
    s_andn2_b64 s[80:81], s[80:81], s[84:85]
    v_mfma_f32_4x4x4_16b_bf16 v[76:79], v[10:11], v[86:87], v[76:79]
    s_mov_b64 exec, -1
    ds_read_b64 v[70:71], v93 offset:65408
    ds_read_b64 v[68:69], v92 offset:65408
    v_bitop3_b32 v94, v16, v5, v99 bitop3:0xea
    v_bitop3_b32 v95, v17, v5, v46 bitop3:0xea
    v_perm_b32 v15, v17, v20, s45
    v_bitop3_b32 v46, v17, 0.5, -0.5 bitop3:0xa8
    v_perm_b32 v14, v16, v20, s44
    v_bitop3_b32 v47, v16, 0.5, -0.5 bitop3:0xa8
    v_bitop3_b32 v15, v6, v15, v46 bitop3:0xca
    v_bitop3_b32 v14, v6, v14, v47 bitop3:0xca
    s_waitcnt lgkmcnt(1)
    v_mfma_f32_4x4x4_16b_bf16 v[80:83], v[10:11], v[70:71], v[80:83]
    s_waitcnt lgkmcnt(0)
    v_mfma_f32_4x4x4_16b_bf16 v[76:79], v[10:11], v[68:69], v[76:79]
    s_nop 2
    v_cvt_pk_bf16_f32 v80, v80, v81
    v_cvt_pk_bf16_f32 v81, v82, v83
    ds_wrxchg_rtn_b64 v[74:75], v93, v[80:81] offset:65408
    v_cvt_pk_bf16_f32 v76, v76, v77
    v_cvt_pk_bf16_f32 v77, v78, v79
    ds_wrxchg_rtn_b64 v[72:73], v92, v[76:77] offset:65408
    v_mfma_f32_4x4x4_16b_bf16 v[80:83], v[8:9], v[106:107], 0
    v_mfma_f32_4x4x4_16b_bf16 v[76:79], v[8:9], v[104:105], 0
    v_cmp_lt_u32 s[84:85], v5, v94
    s_nop 2
    v_pk_mul_f32 v[80:81], v[80:81], v[14:15] op_sel:[0,1] op_sel_hi:[1,1]
    v_pk_mul_f32 v[82:83], v[82:83], v[14:15] op_sel:[0,1] op_sel_hi:[1,1]
    v_pk_mul_f32 v[76:77], v[76:77], v[14:15] op_sel:[0,0] op_sel_hi:[1,0]
    v_pk_mul_f32 v[78:79], v[78:79], v[14:15] op_sel:[0,0] op_sel_hi:[1,0]
    buffer_load_dwordx4 v[108:111], v3, s[16:19], s40 offen offset:0
    v_and_b32 v46, 0x80000000, v21
    v_lshrrev_b32 v47, 14, v19
    v_bitop3_b32 v47, v47, v5, v46 bitop3:0xea
    ds_read_b64 v[102:103], v47
    v_and_b32 v99, 0x40000000, v21
    v_lshrrev_b32 v47, 14, v18
    v_bitop3_b32 v47, v47, v5, v99 bitop3:0xea
    ds_read_b64 v[100:101], v47
    s_waitcnt lgkmcnt(2)
    v_cmp_ne_u64 s[50:51], v[72:73], v[68:69]
    v_cmpx_ne_u64 s[54:55], v[74:75], v[70:71]
    s_and_b64 s[82:83], s[54:55], s[80:81]
    s_cbranch_scc1 L2_c103
L2_d103:
    v_mov_b64 v[84:85], v[70:71]
    v_mov_b32 v7, v93
    v_mov_b64 v[86:87], v[74:75]
    s_or_b64 s[80:81], s[80:81], s[54:55]
    s_mov_b64 exec, s[50:51]
    s_and_b64 s[82:83], s[50:51], s[80:81]
    s_cbranch_scc1 L2_c104
L2_d104:
    v_mov_b64 v[84:85], v[68:69]
    v_mov_b32 v7, v92
    v_mov_b64 v[86:87], v[72:73]
    s_mov_b64 exec, -1
    s_or_b64 s[80:81], s[80:81], s[50:51]
    s_and_b64 exec, s[84:85], s[80:81]
    v_mfma_f32_4x4x4_16b_bf16 v[76:79], v[12:13], v[84:85], 0
    v_mov_b32 v94, v7
    s_andn2_b64 s[80:81], s[80:81], s[84:85]
    v_mfma_f32_4x4x4_16b_bf16 v[76:79], v[10:11], v[86:87], v[76:79]
    s_mov_b64 exec, -1
    ds_read_b64 v[70:71], v95 offset:65408
    ds_read_b64 v[68:69], v94 offset:65408
    v_bitop3_b32 v92, v18, v5, v99 bitop3:0xea
    v_bitop3_b32 v93, v19, v5, v46 bitop3:0xea
    v_perm_b32 v15, v19, v20, s47
    v_bitop3_b32 v46, v19, 0.5, -0.5 bitop3:0xa8
    v_perm_b32 v14, v18, v20, s46
    v_bitop3_b32 v47, v18, 0.5, -0.5 bitop3:0xa8
    v_bitop3_b32 v15, v6, v15, v46 bitop3:0xca
    v_bitop3_b32 v14, v6, v14, v47 bitop3:0xca
    s_waitcnt lgkmcnt(1)
    v_mfma_f32_4x4x4_16b_bf16 v[80:83], v[10:11], v[70:71], v[80:83]
    s_waitcnt lgkmcnt(0)
    v_mfma_f32_4x4x4_16b_bf16 v[76:79], v[10:11], v[68:69], v[76:79]
    s_nop 2
    v_cvt_pk_bf16_f32 v80, v80, v81
    v_cvt_pk_bf16_f32 v81, v82, v83
    ds_wrxchg_rtn_b64 v[74:75], v95, v[80:81] offset:65408
    v_cvt_pk_bf16_f32 v76, v76, v77
    v_cvt_pk_bf16_f32 v77, v78, v79
    ds_wrxchg_rtn_b64 v[72:73], v94, v[76:77] offset:65408
    v_and_b32 v88, 0x0fffffff, v40
    v_mov_b32 v21, v40
    buffer_load_dwordx2 v[16:17], v88, s[8:11], 0 offen
    buffer_load_dwordx3 v[18:20], v88, s[8:11], 0 offen offset:8
    s_setprio 2
    v_mfma_f32_4x4x4_16b_bf16 v[80:83], v[8:9], v[102:103], 0
    v_mfma_f32_4x4x4_16b_bf16 v[76:79], v[8:9], v[100:101], 0
    v_cmp_lt_u32 s[48:49], v5, v93
    s_nop 2
    v_pk_mul_f32 v[80:81], v[80:81], v[14:15] op_sel:[0,1] op_sel_hi:[1,1]
    v_pk_mul_f32 v[82:83], v[82:83], v[14:15] op_sel:[0,1] op_sel_hi:[1,1]
    v_pk_mul_f32 v[76:77], v[76:77], v[14:15] op_sel:[0,0] op_sel_hi:[1,0]
    v_pk_mul_f32 v[78:79], v[78:79], v[14:15] op_sel:[0,0] op_sel_hi:[1,0]
    s_waitcnt vmcnt(10)
    v_and_b32 v46, 0x20000000, v27
    v_lshrrev_b32 v47, 14, v23
    v_bitop3_b32 v47, v47, v5, v46 bitop3:0xea
    ds_read_b64 v[106:107], v47
    v_and_b32 v99, 0x10000000, v27
    v_lshrrev_b32 v47, 14, v22
    v_bitop3_b32 v47, v47, v5, v99 bitop3:0xea
    ds_read_b64 v[104:105], v47
    s_waitcnt lgkmcnt(2)
    v_cmp_ne_u64 s[50:51], v[72:73], v[68:69]
    v_cmpx_ne_u64 s[54:55], v[74:75], v[70:71]
    s_and_b64 s[82:83], s[54:55], s[80:81]
    s_cbranch_scc1 L2_c105
L2_d105:
    v_mov_b64 v[84:85], v[70:71]
    v_mov_b32 v7, v95
    v_mov_b64 v[86:87], v[74:75]
    s_or_b64 s[80:81], s[80:81], s[54:55]
    s_mov_b64 exec, s[50:51]
    s_and_b64 s[82:83], s[50:51], s[80:81]
    s_cbranch_scc1 L2_c106
L2_d106:
    v_mov_b64 v[84:85], v[68:69]
    v_mov_b32 v7, v94
    v_mov_b64 v[86:87], v[72:73]
    s_mov_b64 exec, -1
    s_or_b64 s[80:81], s[80:81], s[50:51]
    s_and_b64 exec, s[48:49], s[80:81]
    v_mfma_f32_4x4x4_16b_bf16 v[80:83], v[12:13], v[84:85], 0
    v_mov_b32 v93, v7
    s_andn2_b64 s[80:81], s[80:81], s[48:49]
    v_mfma_f32_4x4x4_16b_bf16 v[80:83], v[10:11], v[86:87], v[80:83]
    s_mov_b64 exec, -1
    ds_read_b64 v[70:71], v93 offset:65408
    ds_read_b64 v[68:69], v92 offset:65408
    v_bitop3_b32 v94, v22, v5, v99 bitop3:0xea
    v_bitop3_b32 v95, v23, v5, v46 bitop3:0xea
    v_perm_b32 v15, v23, v26, s45
    v_bitop3_b32 v46, v23, 0.5, -0.5 bitop3:0xa8
    v_perm_b32 v14, v22, v26, s44
    v_bitop3_b32 v47, v22, 0.5, -0.5 bitop3:0xa8
    v_bitop3_b32 v15, v6, v15, v46 bitop3:0xca
    v_bitop3_b32 v14, v6, v14, v47 bitop3:0xca
    s_waitcnt lgkmcnt(1)
    v_mfma_f32_4x4x4_16b_bf16 v[80:83], v[10:11], v[70:71], v[80:83]
    s_waitcnt lgkmcnt(0)
    v_mfma_f32_4x4x4_16b_bf16 v[76:79], v[10:11], v[68:69], v[76:79]
    s_nop 2
    v_cvt_pk_bf16_f32 v80, v80, v81
    v_cvt_pk_bf16_f32 v81, v82, v83
    ds_wrxchg_rtn_b64 v[74:75], v93, v[80:81] offset:65408
    v_cvt_pk_bf16_f32 v76, v76, v77
    v_cvt_pk_bf16_f32 v77, v78, v79
    ds_wrxchg_rtn_b64 v[72:73], v92, v[76:77] offset:65408
    s_setprio 1
    v_mfma_f32_4x4x4_16b_bf16 v[80:83], v[8:9], v[106:107], 0
    v_mfma_f32_4x4x4_16b_bf16 v[76:79], v[8:9], v[104:105], 0
    s_nop 3
    v_pk_mul_f32 v[80:81], v[80:81], v[14:15] op_sel:[0,1] op_sel_hi:[1,1]
    v_pk_mul_f32 v[82:83], v[82:83], v[14:15] op_sel:[0,1] op_sel_hi:[1,1]
    v_pk_mul_f32 v[76:77], v[76:77], v[14:15] op_sel:[0,0] op_sel_hi:[1,0]
    v_pk_mul_f32 v[78:79], v[78:79], v[14:15] op_sel:[0,0] op_sel_hi:[1,0]
    s_bitcmp1_b32 s43, s42
    s_cbranch_scc1 L2_oa107
L2_ob107:
    buffer_load_dwordx4 v[112:115], v3, s[16:19], s40 offen offset:1024
    v_sub_u16 v88, v62, v54
    v_and_b32 v89, 3, v54
    v_add3_u32 v99, v88, v89, 3
    v_and_b32 v99, -4, v99
    v_max_u32 v99, 4, v99
    v_and_b32 v97, 0xfffc, v54
    v_bfm_b32 v96, v88, v89
    v_add_u32_dpp v91, v99, v99 row_shr:1 row_mask:0xf bank_mask:0xf bound_ctrl:1
    v_mad_u32_u24 v97, v97, 5, v2
    v_cmp_lt_u32 vcc, 16, v99
    v_add_u32_dpp v91, v91, v91 row_shr:2 row_mask:0xf bank_mask:0xf bound_ctrl:1
    v_sub_u32 v98, s38, v99
    v_lshrrev_b64 v[54:55], 16, v[54:55]
    v_add_u32_dpp v91, v91, v91 row_shr:4 row_mask:0xf bank_mask:0xf bound_ctrl:1
    v_lshrrev_b64 v[62:63], 16, v[62:63]
    s_mov_b32 s101, 0
    v_add_u32_dpp v91, v91, v91 row_shr:8 row_mask:0xf bank_mask:0xf bound_ctrl:1
    s_nop 1
    v_add_u32_dpp v91, v91, v91 row_bcast:15 row_mask:0xa bank_mask:0xf
    s_nop 1
    v_add_u32_dpp v91, v91, v91 row_bcast:31 row_mask:0xc bank_mask:0xf
    v_add_u32 v98, v98, v91
    v_readlane_b32 s37, v91, 63
    s_cbranch_vccnz L2_xo108
L2_xp108:
    v_and_b32 v46, 0x80000000, v27
    v_lshrrev_b32 v47, 14, v25
    v_bitop3_b32 v47, v47, v5, v46 bitop3:0xea
    ds_read_b64 v[102:103], v47
    v_and_b32 v99, 0x40000000, v27
    v_lshrrev_b32 v47, 14, v24
    v_bitop3_b32 v47, v47, v5, v99 bitop3:0xea
    ds_read_b64 v[100:101], v47
    s_waitcnt lgkmcnt(2)
    v_cmp_ne_u64 s[50:51], v[72:73], v[68:69]
    v_cmpx_ne_u64 s[54:55], v[74:75], v[70:71]
    s_and_b64 s[82:83], s[54:55], s[80:81]
    s_cbranch_scc1 L2_c109
L2_d109:
    v_mov_b64 v[84:85], v[70:71]
    v_mov_b32 v7, v93
    v_mov_b64 v[86:87], v[74:75]
    s_or_b64 s[80:81], s[80:81], s[54:55]
    s_mov_b64 exec, s[50:51]
    s_and_b64 s[82:83], s[50:51], s[80:81]
    s_cbranch_scc1 L2_c110
L2_d110:
    v_mov_b64 v[84:85], v[68:69]
    v_mov_b32 v7, v92
    v_mov_b64 v[86:87], v[72:73]
    s_mov_b64 exec, -1
    s_or_b64 s[80:81], s[80:81], s[50:51]
    ds_read_b64 v[70:71], v95 offset:65408
    ds_read_b64 v[68:69], v94 offset:65408
    v_bitop3_b32 v92, v24, v5, v99 bitop3:0xea
    v_bitop3_b32 v93, v25, v5, v46 bitop3:0xea
    v_perm_b32 v15, v25, v26, s47
    v_bitop3_b32 v46, v25, 0.5, -0.5 bitop3:0xa8
    v_perm_b32 v14, v24, v26, s46
    v_bitop3_b32 v47, v24, 0.5, -0.5 bitop3:0xa8
    v_bitop3_b32 v15, v6, v15, v46 bitop3:0xca
    v_bitop3_b32 v14, v6, v14, v47 bitop3:0xca
    s_waitcnt lgkmcnt(1)
    v_mfma_f32_4x4x4_16b_bf16 v[80:83], v[10:11], v[70:71], v[80:83]
    s_waitcnt lgkmcnt(0)
    v_mfma_f32_4x4x4_16b_bf16 v[76:79], v[10:11], v[68:69], v[76:79]
    s_nop 2
    v_cvt_pk_bf16_f32 v80, v80, v81
    v_cvt_pk_bf16_f32 v81, v82, v83
    ds_wrxchg_rtn_b64 v[74:75], v95, v[80:81] offset:65408
    v_cvt_pk_bf16_f32 v76, v76, v77
    v_cvt_pk_bf16_f32 v77, v78, v79
    ds_wrxchg_rtn_b64 v[72:73], v94, v[76:77] offset:65408
    v_and_b32 v88, 0x0fffffff, v41
    v_mov_b32 v27, v41
    buffer_load_dwordx2 v[22:23], v88, s[8:11], 0 offen
    buffer_load_dwordx3 v[24:26], v88, s[8:11], 0 offen offset:8
    v_mfma_f32_4x4x4_16b_bf16 v[80:83], v[8:9], v[102:103], 0
    v_mfma_f32_4x4x4_16b_bf16 v[76:79], v[8:9], v[100:101], 0
    v_cmp_lt_u32 s[84:85], v5, v92
    s_nop 2
    v_pk_mul_f32 v[80:81], v[80:81], v[14:15] op_sel:[0,1] op_sel_hi:[1,1]
    v_pk_mul_f32 v[82:83], v[82:83], v[14:15] op_sel:[0,1] op_sel_hi:[1,1]
    v_pk_mul_f32 v[76:77], v[76:77], v[14:15] op_sel:[0,0] op_sel_hi:[1,0]
    v_pk_mul_f32 v[78:79], v[78:79], v[14:15] op_sel:[0,0] op_sel_hi:[1,0]
    s_waitcnt vmcnt(11)
    s_mov_b64 exec, s[6:7]
    v_lshrrev_b32 v30, 16, v30
    s_mov_b64 exec, -1
    v_and_b32 v46, 0x20000000, v31
    v_lshrrev_b32 v47, 14, v29
    v_bitop3_b32 v47, v47, v5, v46 bitop3:0xea
    ds_read_b64 v[106:107], v47
    v_and_b32 v99, 0x10000000, v31
    v_lshrrev_b32 v47, 14, v28
    v_bitop3_b32 v47, v47, v5, v99 bitop3:0xea
    ds_read_b64 v[104:105], v47
    s_waitcnt lgkmcnt(2)
    v_cmp_ne_u64 s[50:51], v[72:73], v[68:69]
    v_cmpx_ne_u64 s[54:55], v[74:75], v[70:71]
    s_and_b64 s[82:83], s[54:55], s[80:81]
    s_cbranch_scc1 L2_c111
L2_d111:
    v_mov_b64 v[84:85], v[70:71]
    v_mov_b32 v7, v95
    v_mov_b64 v[86:87], v[74:75]
    s_or_b64 s[80:81], s[80:81], s[54:55]
    s_mov_b64 exec, s[50:51]
    s_and_b64 s[82:83], s[50:51], s[80:81]
    s_cbranch_scc1 L2_c112
L2_d112:
    v_mov_b64 v[84:85], v[68:69]
    v_mov_b32 v7, v94
    v_mov_b64 v[86:87], v[72:73]
    s_mov_b64 exec, -1
    s_or_b64 s[80:81], s[80:81], s[50:51]
    s_and_b64 exec, s[84:85], s[80:81]
    v_mfma_f32_4x4x4_16b_bf16 v[76:79], v[12:13], v[84:85], 0
    v_mov_b32 v92, v7
    s_andn2_b64 s[80:81], s[80:81], s[84:85]
    v_mfma_f32_4x4x4_16b_bf16 v[76:79], v[10:11], v[86:87], v[76:79]
    s_mov_b64 exec, -1
    ds_read_b64 v[70:71], v93 offset:65408
    ds_read_b64 v[68:69], v92 offset:65408
    v_bitop3_b32 v94, v28, v5, v99 bitop3:0xea
    v_bitop3_b32 v95, v29, v5, v46 bitop3:0xea
    v_perm_b32 v15, v29, v30, s45
    v_bitop3_b32 v46, v29, 0.5, -0.5 bitop3:0xa8
    v_perm_b32 v14, v28, v30, s44
    v_bitop3_b32 v47, v28, 0.5, -0.5 bitop3:0xa8
    v_bitop3_b32 v15, v6, v15, v46 bitop3:0xca
    v_bitop3_b32 v14, v6, v14, v47 bitop3:0xca
    s_waitcnt lgkmcnt(1)
    v_mfma_f32_4x4x4_16b_bf16 v[80:83], v[10:11], v[70:71], v[80:83]
    s_waitcnt lgkmcnt(0)
    v_mfma_f32_4x4x4_16b_bf16 v[76:79], v[10:11], v[68:69], v[76:79]
    s_nop 2
    v_cvt_pk_bf16_f32 v80, v80, v81
    v_cvt_pk_bf16_f32 v81, v82, v83
    ds_wrxchg_rtn_b64 v[74:75], v93, v[80:81] offset:65408
    v_cvt_pk_bf16_f32 v76, v76, v77
    v_cvt_pk_bf16_f32 v77, v78, v79
    ds_wrxchg_rtn_b64 v[72:73], v92, v[76:77] offset:65408
    s_setprio 0
    v_mfma_f32_4x4x4_16b_bf16 v[80:83], v[8:9], v[106:107], 0
    v_mfma_f32_4x4x4_16b_bf16 v[76:79], v[8:9], v[104:105], 0
    v_cmp_lt_u32 s[48:49], v5, v95
    s_nop 2
    v_pk_mul_f32 v[80:81], v[80:81], v[14:15] op_sel:[0,1] op_sel_hi:[1,1]
    v_pk_mul_f32 v[82:83], v[82:83], v[14:15] op_sel:[0,1] op_sel_hi:[1,1]
    v_pk_mul_f32 v[76:77], v[76:77], v[14:15] op_sel:[0,0] op_sel_hi:[1,0]
    v_pk_mul_f32 v[78:79], v[78:79], v[14:15] op_sel:[0,0] op_sel_hi:[1,0]
    s_add_u32 s40, s40, 0x50000
    v_and_b32 v47, 0x0fffffff, v42
    v_mov_b32 v31, v42
    buffer_load_dword v30, v47, s[8:11], 0 offen offset:16
    s_mov_b64 exec, s[6:7]
    v_add_u32 v47, 8, v47
    v_lshrrev_b32 v31, 2, v31
    s_mov_b64 exec, -1
    buffer_load_dwordx2 v[28:29], v47, s[8:11], 0 offen
    s_waitcnt vmcnt(8)
    v_and_b32 v46, 0x80000000, v39
    v_lshrrev_b32 v47, 14, v37
    v_bitop3_b32 v47, v47, v5, v46 bitop3:0xea
    ds_read_b64 v[106:107], v47
    v_and_b32 v99, 0x40000000, v39
    v_lshrrev_b32 v47, 14, v36
    v_bitop3_b32 v47, v47, v5, v99 bitop3:0xea
    ds_read_b64 v[104:105], v47
    v_and_b32 v46, 0x20000000, v39
    v_lshrrev_b32 v47, 14, v35
    v_bitop3_b32 v47, v47, v5, v46 bitop3:0xea
    ds_read_b64 v[102:103], v47
    v_and_b32 v99, 0x10000000, v39
    v_lshrrev_b32 v47, 14, v34
    v_bitop3_b32 v47, v47, v5, v99 bitop3:0xea
    ds_read_b64 v[100:101], v47
    s_waitcnt lgkmcnt(4)
    v_cmp_ne_u64 s[50:51], v[72:73], v[68:69]
    v_cmpx_ne_u64 s[54:55], v[74:75], v[70:71]
    s_and_b64 s[82:83], s[54:55], s[80:81]
    s_cbranch_scc1 L2_c113
L2_d113:
    v_mov_b64 v[84:85], v[70:71]
    v_mov_b32 v7, v93
    v_mov_b64 v[86:87], v[74:75]
    s_or_b64 s[80:81], s[80:81], s[54:55]
    s_mov_b64 exec, s[50:51]
    s_and_b64 s[82:83], s[50:51], s[80:81]
    s_cbranch_scc1 L2_c114
L2_d114:
    v_mov_b64 v[84:85], v[68:69]
    v_mov_b32 v7, v92
    v_mov_b64 v[86:87], v[72:73]
    s_mov_b64 exec, -1
    s_or_b64 s[80:81], s[80:81], s[50:51]
    s_and_b64 exec, s[48:49], s[80:81]
    v_mfma_f32_4x4x4_16b_bf16 v[80:83], v[12:13], v[84:85], 0
    v_mov_b32 v95, v7
    s_andn2_b64 s[80:81], s[80:81], s[48:49]
    v_mfma_f32_4x4x4_16b_bf16 v[80:83], v[10:11], v[86:87], v[80:83]
    s_mov_b64 exec, -1
    ds_read_b64 v[70:71], v95 offset:65408
    ds_read_b64 v[68:69], v94 offset:65408
    v_bitop3_b32 v92, v34, v5, v99 bitop3:0xea
    v_bitop3_b32 v93, v35, v5, v46 bitop3:0xea
    v_perm_b32 v15, v35, v38, s45
    v_bitop3_b32 v46, v35, 0.5, -0.5 bitop3:0xa8
    v_perm_b32 v14, v34, v38, s44
    v_bitop3_b32 v47, v34, 0.5, -0.5 bitop3:0xa8
    v_bitop3_b32 v15, v6, v15, v46 bitop3:0xca
    v_bitop3_b32 v14, v6, v14, v47 bitop3:0xca
    s_waitcnt lgkmcnt(1)
    v_mfma_f32_4x4x4_16b_bf16 v[80:83], v[10:11], v[70:71], v[80:83]
    s_waitcnt lgkmcnt(0)
    v_mfma_f32_4x4x4_16b_bf16 v[76:79], v[10:11], v[68:69], v[76:79]
    s_nop 2
    v_cvt_pk_bf16_f32 v80, v80, v81
    v_cvt_pk_bf16_f32 v81, v82, v83
    ds_wrxchg_rtn_b64 v[74:75], v95, v[80:81] offset:65408
    v_cvt_pk_bf16_f32 v76, v76, v77
    v_cvt_pk_bf16_f32 v77, v78, v79
    ds_wrxchg_rtn_b64 v[72:73], v94, v[76:77] offset:65408
    s_barrier
    s_setprio 3
    s_mov_b32 m0, s100
    s_nop 0
    ds_write_addtid_b32 v116 offset:32768
    ds_write_addtid_b32 v117 offset:33024
    ds_write_addtid_b32 v118 offset:33280
    ds_write_addtid_b32 v119 offset:33536
    buffer_load_dwordx4 v[116:119], v3, s[16:19], s40 offen offset:2048
    ds_write_addtid_b32 v120 offset:33792
    ds_write_addtid_b32 v121 offset:34048
    ds_write_addtid_b32 v122 offset:34304
    ds_write_addtid_b32 v123 offset:34560
    buffer_load_dwordx4 v[120:123], v3, s[16:19], s40 offen offset:3072
    v_mfma_f32_4x4x4_16b_bf16 v[80:83], v[8:9], v[102:103], 0
    v_mfma_f32_4x4x4_16b_bf16 v[76:79], v[8:9], v[100:101], 0
    s_nop 3
    v_pk_mul_f32 v[80:81], v[80:81], v[14:15] op_sel:[0,1] op_sel_hi:[1,1]
    v_pk_mul_f32 v[82:83], v[82:83], v[14:15] op_sel:[0,1] op_sel_hi:[1,1]
    v_pk_mul_f32 v[76:77], v[76:77], v[14:15] op_sel:[0,0] op_sel_hi:[1,0]
    v_pk_mul_f32 v[78:79], v[78:79], v[14:15] op_sel:[0,0] op_sel_hi:[1,0]
    v_mov_b32 v44, v43
    s_cmp_gt_u32 s37, 1024
    s_cbranch_scc1 L2_xs115
    s_cmp_lg_u32 s101, 0
    s_cbranch_scc1 L2_xa115
L2_xb115:
    v_lshlrev_b32 v89, 16, v96
    v_add_u32 v90, 60, v97
    v_bitop3_b32 v90, v89, v45, v90 bitop3:0x6a
    ds_write_b32 v98, v90 offset:12
    v_lshlrev_b32 v89, 20, v96
    v_add_u32 v90, 40, v97
    v_bitop3_b32 v90, v89, v45, v90 bitop3:0x6a
    ds_write_b32 v98, v90 offset:8
    v_lshlrev_b32 v89, 24, v96
    v_add_u32 v90, 20, v97
    v_bitop3_b32 v90, v89, v45, v90 bitop3:0x6a
    ds_write_b32 v98, v90 offset:4
    v_lshlrev_b32 v89, 28, v96
    v_bitop3_b32 v90, v89, v45, v97 bitop3:0x6a
    ds_write_b32 v98, v90 offset:0
    v_mov_b32_dpp v91, v66 quad_perm:[1,1,1,1] row_mask:0xf bank_mask:0xf
    v_and_b32 v89, 3, v91
    v_and_b32 v97, 0xfffc, v91
    v_sub_u16_dpp v88, v66, v91 quad_perm:[3,3,3,3] row_mask:0xf bank_mask:0xf
    v_mad_u32_u24 v97, v97, 5, v4
    v_add_u32 v99, v88, v89
    v_bfm_b32 v96, v88, v89
    v_cmp_lt_u32 s[58:59], 16, v99
    v_lshlrev_b32 v89, v1, v96
    v_and_b32 v89, v45, v89
    v_cmp_ne_u32 vcc, 0, v89
    v_xor_b32 v90, v97, v89
    s_add_u32 s3, s37, s38
    v_mbcnt_lo_u32_b32 v98, vcc_lo, 0
    v_mbcnt_hi_u32_b32 v98, vcc_hi, v98
    s_bcnt1_i32_b64 s41, vcc
    v_lshl_add_u32 v98, v98, 2, s3
    s_mov_b64 exec, vcc
    ds_write_b32 v98, v90
    s_mov_b64 exec, -1
    s_lshl2_add_u32 s37, s41, s37
    s_cmp_lg_u64 s[58:59], 0
    s_cbranch_scc1 L2_xe115
L2_xr115:
    v_add_u32 v98, s37, v0
    v_mov_b32 v90, -1
    ds_write_b32 v98, v90
    v_add_u32 v98, s38, v0
    ds_read2st64_b32 v[40:41], v0 offset0:0 offset1:1
    ds_read_b32 v43, v0 offset:512
    v_lshrrev_b32 v98, 1, v98
    v_and_b32 v98, -4, v98
    ds_read_b32 v42, v98 offset:768
    s_sub_u32 s3, s37, 768
    s_cmp_gt_u32 s3, 128
    s_cbranch_scc1 L2_xf115
L2_xg115:
    v_lshrrev_b64 v[64:65], 16, v[64:65]
    v_lshrrev_b64 v[66:67], 16, v[66:67]
    s_setprio 2
    ds_write_addtid_b32 v124 offset:34816
    ds_write_addtid_b32 v125 offset:35072
    ds_write_addtid_b32 v126 offset:35328
    ds_write_addtid_b32 v127 offset:35584
    s_add_u32 s3, s40, 4096
    buffer_load_dwordx4 v[124:127], v3, s[16:19], s3 offen
    s_waitcnt lgkmcnt(14)
    v_cmp_ne_u64 s[50:51], v[72:73], v[68:69]
    v_cmpx_ne_u64 s[54:55], v[74:75], v[70:71]
    s_and_b64 s[82:83], s[54:55], s[80:81]
    s_cbranch_scc1 L2_c116
L2_d116:
    v_mov_b64 v[84:85], v[70:71]
    v_mov_b32 v7, v95
    v_mov_b64 v[86:87], v[74:75]
    s_or_b64 s[80:81], s[80:81], s[54:55]
    s_mov_b64 exec, s[50:51]
    s_and_b64 s[82:83], s[50:51], s[80:81]
    s_cbranch_scc1 L2_c117
L2_d117:
    v_mov_b64 v[84:85], v[68:69]
    v_mov_b32 v7, v94
    v_mov_b64 v[86:87], v[72:73]
    s_mov_b64 exec, -1
    s_or_b64 s[80:81], s[80:81], s[50:51]
    ds_read_b64 v[70:71], v93 offset:65408
    ds_read_b64 v[68:69], v92 offset:65408
    v_and_b32 v46, 0x40000000, v39
    v_bitop3_b32 v94, v36, v5, v46 bitop3:0xea
    v_and_b32 v46, 0x80000000, v39
    v_bitop3_b32 v95, v37, v5, v46 bitop3:0xea
    v_perm_b32 v15, v37, v38, s47
    v_bitop3_b32 v46, v37, 0.5, -0.5 bitop3:0xa8
    v_perm_b32 v14, v36, v38, s46
    v_bitop3_b32 v47, v36, 0.5, -0.5 bitop3:0xa8
    v_bitop3_b32 v15, v6, v15, v46 bitop3:0xca
    v_bitop3_b32 v14, v6, v14, v47 bitop3:0xca
    s_setprio 1
    s_waitcnt lgkmcnt(1)
    v_mfma_f32_4x4x4_16b_bf16 v[80:83], v[10:11], v[70:71], v[80:83]
    s_waitcnt lgkmcnt(0)
    v_mfma_f32_4x4x4_16b_bf16 v[76:79], v[10:11], v[68:69], v[76:79]
    s_nop 2
    v_cvt_pk_bf16_f32 v80, v80, v81
    v_cvt_pk_bf16_f32 v81, v82, v83
    ds_wrxchg_rtn_b64 v[74:75], v93, v[80:81] offset:65408
    v_cvt_pk_bf16_f32 v76, v76, v77
    v_cvt_pk_bf16_f32 v77, v78, v79
    ds_wrxchg_rtn_b64 v[72:73], v92, v[76:77] offset:65408
    v_and_b32 v88, 0x0fffffff, v44
    v_mov_b32 v39, v44
    buffer_load_dwordx2 v[34:35], v88, s[8:11], 0 offen
    buffer_load_dwordx3 v[36:38], v88, s[8:11], 0 offen offset:8
    s_setprio 0
    s_waitcnt vmcnt(12)
    s_mov_b32 m0, s38
    s_nop 0
    ds_write_addtid_b32 v108 offset:0
    ds_write_addtid_b32 v109 offset:256
    ds_write_addtid_b32 v110 offset:512
    ds_write_addtid_b32 v111 offset:768
    s_waitcnt vmcnt(9)
    ds_write_addtid_b32 v112 offset:1024
    ds_write_addtid_b32 v113 offset:1280
    ds_write_addtid_b32 v114 offset:1536
    ds_write_addtid_b32 v115 offset:1792
    v_mfma_f32_4x4x4_16b_bf16 v[80:83], v[8:9], v[106:107], 0
    v_mfma_f32_4x4x4_16b_bf16 v[76:79], v[8:9], v[104:105], 0
    v_cmp_lt_u32 s[84:85], v5, v94
    s_nop 2
    v_pk_mul_f32 v[80:81], v[80:81], v[14:15] op_sel:[0,1] op_sel_hi:[1,1]
    v_pk_mul_f32 v[82:83], v[82:83], v[14:15] op_sel:[0,1] op_sel_hi:[1,1]
    v_pk_mul_f32 v[76:77], v[76:77], v[14:15] op_sel:[0,0] op_sel_hi:[1,0]
    v_pk_mul_f32 v[78:79], v[78:79], v[14:15] op_sel:[0,0] op_sel_hi:[1,0]
    s_add_u32 s42, s42, 1
    s_waitcnt lgkmcnt(0)
    s_cmp_lg_u32 s42, 14
    s_cbranch_scc1 L2_loop
    s_barrier
    s_bitcmp1_b32 s36, s42
    s_cbranch_scc1 L2_slow
L2_ret6:
    s_setprio 3
    s_bitcmp1_b32 s43, s42
    s_cbranch_scc1 L2_oa118
L2_ob118:
    v_and_b32 v46, 0x20000000, v21
    v_lshrrev_b32 v47, 14, v17
    v_bitop3_b32 v47, v47, v5, v46 bitop3:0xea
    ds_read_b64 v[102:103], v47
    v_and_b32 v99, 0x10000000, v21
    v_lshrrev_b32 v47, 14, v16
    v_bitop3_b32 v47, v47, v5, v99 bitop3:0xea
    ds_read_b64 v[100:101], v47
    v_cmp_ne_u64 s[50:51], v[72:73], v[68:69]
    v_cmpx_ne_u64 s[54:55], v[74:75], v[70:71]
    s_and_b64 s[82:83], s[54:55], s[80:81]
    s_cbranch_scc1 L2_c119
L2_d119:
    v_mov_b64 v[84:85], v[70:71]
    v_mov_b32 v7, v93
    v_mov_b64 v[86:87], v[74:75]
    s_or_b64 s[80:81], s[80:81], s[54:55]
    s_mov_b64 exec, s[50:51]
    s_and_b64 s[82:83], s[50:51], s[80:81]
    s_cbranch_scc1 L2_c120
L2_d120:
    v_mov_b64 v[84:85], v[68:69]
    v_mov_b32 v7, v92
    v_mov_b64 v[86:87], v[72:73]
    s_mov_b64 exec, -1
    s_or_b64 s[80:81], s[80:81], s[50:51]
    s_and_b64 exec, s[84:85], s[80:81]
    v_mfma_f32_4x4x4_16b_bf16 v[76:79], v[12:13], v[84:85], 0
    v_mov_b32 v94, v7
    s_andn2_b64 s[80:81], s[80:81], s[84:85]
    v_mfma_f32_4x4x4_16b_bf16 v[76:79], v[10:11], v[86:87], v[76:79]
    s_mov_b64 exec, -1
    ds_read_b64 v[70:71], v95 offset:65408
    ds_read_b64 v[68:69], v94 offset:65408
    v_bitop3_b32 v92, v16, v5, v99 bitop3:0xea
    v_bitop3_b32 v93, v17, v5, v46 bitop3:0xea
    v_perm_b32 v15, v17, v20, s45
    v_bitop3_b32 v46, v17, 0.5, -0.5 bitop3:0xa8
    v_perm_b32 v14, v16, v20, s44
    v_bitop3_b32 v47, v16, 0.5, -0.5 bitop3:0xa8
    v_bitop3_b32 v15, v6, v15, v46 bitop3:0xca
    v_bitop3_b32 v14, v6, v14, v47 bitop3:0xca
    s_waitcnt lgkmcnt(1)
    v_mfma_f32_4x4x4_16b_bf16 v[80:83], v[10:11], v[70:71], v[80:83]
    s_waitcnt lgkmcnt(0)
    v_mfma_f32_4x4x4_16b_bf16 v[76:79], v[10:11], v[68:69], v[76:79]
    s_nop 2
    v_cvt_pk_bf16_f32 v80, v80, v81
    v_cvt_pk_bf16_f32 v81, v82, v83
    ds_wrxchg_rtn_b64 v[74:75], v95, v[80:81] offset:65408
    v_cvt_pk_bf16_f32 v76, v76, v77
    v_cvt_pk_bf16_f32 v77, v78, v79
    ds_wrxchg_rtn_b64 v[72:73], v94, v[76:77] offset:65408
    v_mfma_f32_4x4x4_16b_bf16 v[80:83], v[8:9], v[102:103], 0
    v_mfma_f32_4x4x4_16b_bf16 v[76:79], v[8:9], v[100:101], 0
    v_cmp_lt_u32 s[84:85], v5, v92
    s_nop 2
    v_pk_mul_f32 v[80:81], v[80:81], v[14:15] op_sel:[0,1] op_sel_hi:[1,1]
    v_pk_mul_f32 v[82:83], v[82:83], v[14:15] op_sel:[0,1] op_sel_hi:[1,1]
    v_pk_mul_f32 v[76:77], v[76:77], v[14:15] op_sel:[0,0] op_sel_hi:[1,0]
    v_pk_mul_f32 v[78:79], v[78:79], v[14:15] op_sel:[0,0] op_sel_hi:[1,0]
    buffer_load_dwordx4 v[108:111], v3, s[16:19], s40 offen offset:0
    v_and_b32 v46, 0x80000000, v21
    v_lshrrev_b32 v47, 14, v19
    v_bitop3_b32 v47, v47, v5, v46 bitop3:0xea
    ds_read_b64 v[106:107], v47
    v_and_b32 v99, 0x40000000, v21
    v_lshrrev_b32 v47, 14, v18
    v_bitop3_b32 v47, v47, v5, v99 bitop3:0xea
    ds_read_b64 v[104:105], v47
    s_waitcnt lgkmcnt(2)
    v_cmp_ne_u64 s[50:51], v[72:73], v[68:69]
    v_cmpx_ne_u64 s[54:55], v[74:75], v[70:71]
    s_and_b64 s[82:83], s[54:55], s[80:81]
    s_cbranch_scc1 L2_c121
L2_d121:
    v_mov_b64 v[84:85], v[70:71]
    v_mov_b32 v7, v95
    v_mov_b64 v[86:87], v[74:75]
    s_or_b64 s[80:81], s[80:81], s[54:55]
    s_mov_b64 exec, s[50:51]
    s_and_b64 s[82:83], s[50:51], s[80:81]
    s_cbranch_scc1 L2_c122
L2_d122:
    v_mov_b64 v[84:85], v[68:69]
    v_mov_b32 v7, v94
    v_mov_b64 v[86:87], v[72:73]
    s_mov_b64 exec, -1
    s_or_b64 s[80:81], s[80:81], s[50:51]
    s_and_b64 exec, s[84:85], s[80:81]
    v_mfma_f32_4x4x4_16b_bf16 v[76:79], v[12:13], v[84:85], 0
    v_mov_b32 v92, v7
    s_andn2_b64 s[80:81], s[80:81], s[84:85]
    v_mfma_f32_4x4x4_16b_bf16 v[76:79], v[10:11], v[86:87], v[76:79]
    s_mov_b64 exec, -1
    ds_read_b64 v[70:71], v93 offset:65408
    ds_read_b64 v[68:69], v92 offset:65408
    v_bitop3_b32 v94, v18, v5, v99 bitop3:0xea
    v_bitop3_b32 v95, v19, v5, v46 bitop3:0xea
    v_perm_b32 v15, v19, v20, s47
    v_bitop3_b32 v46, v19, 0.5, -0.5 bitop3:0xa8
    v_perm_b32 v14, v18, v20, s46
    v_bitop3_b32 v47, v18, 0.5, -0.5 bitop3:0xa8
    v_bitop3_b32 v15, v6, v15, v46 bitop3:0xca
    v_bitop3_b32 v14, v6, v14, v47 bitop3:0xca
    s_waitcnt lgkmcnt(1)
    v_mfma_f32_4x4x4_16b_bf16 v[80:83], v[10:11], v[70:71], v[80:83]
    s_waitcnt lgkmcnt(0)
    v_mfma_f32_4x4x4_16b_bf16 v[76:79], v[10:11], v[68:69], v[76:79]
    s_nop 2
    v_cvt_pk_bf16_f32 v80, v80, v81
    v_cvt_pk_bf16_f32 v81, v82, v83
    ds_wrxchg_rtn_b64 v[74:75], v93, v[80:81] offset:65408
    v_cvt_pk_bf16_f32 v76, v76, v77
    v_cvt_pk_bf16_f32 v77, v78, v79
    ds_wrxchg_rtn_b64 v[72:73], v92, v[76:77] offset:65408
    v_and_b32 v88, 0x0fffffff, v40
    v_mov_b32 v21, v40
    buffer_load_dwordx2 v[16:17], v88, s[8:11], 0 offen
    buffer_load_dwordx3 v[18:20], v88, s[8:11], 0 offen offset:8
    s_setprio 2
    v_mfma_f32_4x4x4_16b_bf16 v[80:83], v[8:9], v[106:107], 0
    v_mfma_f32_4x4x4_16b_bf16 v[76:79], v[8:9], v[104:105], 0
    v_cmp_lt_u32 s[48:49], v5, v95
    s_nop 2
    v_pk_mul_f32 v[80:81], v[80:81], v[14:15] op_sel:[0,1] op_sel_hi:[1,1]
    v_pk_mul_f32 v[82:83], v[82:83], v[14:15] op_sel:[0,1] op_sel_hi:[1,1]
    v_pk_mul_f32 v[76:77], v[76:77], v[14:15] op_sel:[0,0] op_sel_hi:[1,0]
    v_pk_mul_f32 v[78:79], v[78:79], v[14:15] op_sel:[0,0] op_sel_hi:[1,0]
    s_waitcnt vmcnt(10)
    v_and_b32 v46, 0x20000000, v27
    v_lshrrev_b32 v47, 14, v23
    v_bitop3_b32 v47, v47, v5, v46 bitop3:0xea
    ds_read_b64 v[102:103], v47
    v_and_b32 v99, 0x10000000, v27
    v_lshrrev_b32 v47, 14, v22
    v_bitop3_b32 v47, v47, v5, v99 bitop3:0xea
    ds_read_b64 v[100:101], v47
    s_waitcnt lgkmcnt(2)
    v_cmp_ne_u64 s[50:51], v[72:73], v[68:69]
    v_cmpx_ne_u64 s[54:55], v[74:75], v[70:71]
    s_and_b64 s[82:83], s[54:55], s[80:81]
    s_cbranch_scc1 L2_c123
L2_d123:
    v_mov_b64 v[84:85], v[70:71]
    v_mov_b32 v7, v93
    v_mov_b64 v[86:87], v[74:75]
    s_or_b64 s[80:81], s[80:81], s[54:55]
    s_mov_b64 exec, s[50:51]
    s_and_b64 s[82:83], s[50:51], s[80:81]
    s_cbranch_scc1 L2_c124
L2_d124:
    v_mov_b64 v[84:85], v[68:69]
    v_mov_b32 v7, v92
    v_mov_b64 v[86:87], v[72:73]
    s_mov_b64 exec, -1
    s_or_b64 s[80:81], s[80:81], s[50:51]
    s_and_b64 exec, s[48:49], s[80:81]
    v_mfma_f32_4x4x4_16b_bf16 v[80:83], v[12:13], v[84:85], 0
    v_mov_b32 v95, v7
    s_andn2_b64 s[80:81], s[80:81], s[48:49]
    v_mfma_f32_4x4x4_16b_bf16 v[80:83], v[10:11], v[86:87], v[80:83]
    s_mov_b64 exec, -1
    ds_read_b64 v[70:71], v95 offset:65408
    ds_read_b64 v[68:69], v94 offset:65408
    v_bitop3_b32 v92, v22, v5, v99 bitop3:0xea
    v_bitop3_b32 v93, v23, v5, v46 bitop3:0xea
    v_perm_b32 v15, v23, v26, s45
    v_bitop3_b32 v46, v23, 0.5, -0.5 bitop3:0xa8
    v_perm_b32 v14, v22, v26, s44
    v_bitop3_b32 v47, v22, 0.5, -0.5 bitop3:0xa8
    v_bitop3_b32 v15, v6, v15, v46 bitop3:0xca
    v_bitop3_b32 v14, v6, v14, v47 bitop3:0xca
    s_waitcnt lgkmcnt(1)
    v_mfma_f32_4x4x4_16b_bf16 v[80:83], v[10:11], v[70:71], v[80:83]
    s_waitcnt lgkmcnt(0)
    v_mfma_f32_4x4x4_16b_bf16 v[76:79], v[10:11], v[68:69], v[76:79]
    s_nop 2
    v_cvt_pk_bf16_f32 v80, v80, v81
    v_cvt_pk_bf16_f32 v81, v82, v83
    ds_wrxchg_rtn_b64 v[74:75], v95, v[80:81] offset:65408
    v_cvt_pk_bf16_f32 v76, v76, v77
    v_cvt_pk_bf16_f32 v77, v78, v79
    ds_wrxchg_rtn_b64 v[72:73], v94, v[76:77] offset:65408
    s_setprio 1
    v_mfma_f32_4x4x4_16b_bf16 v[80:83], v[8:9], v[102:103], 0
    v_mfma_f32_4x4x4_16b_bf16 v[76:79], v[8:9], v[100:101], 0
    s_nop 3
    v_pk_mul_f32 v[80:81], v[80:81], v[14:15] op_sel:[0,1] op_sel_hi:[1,1]
    v_pk_mul_f32 v[82:83], v[82:83], v[14:15] op_sel:[0,1] op_sel_hi:[1,1]
    v_pk_mul_f32 v[76:77], v[76:77], v[14:15] op_sel:[0,0] op_sel_hi:[1,0]
    v_pk_mul_f32 v[78:79], v[78:79], v[14:15] op_sel:[0,0] op_sel_hi:[1,0]
    s_bitcmp1_b32 s43, s42
    s_cbranch_scc1 L2_oa125
L2_ob125:
    buffer_load_dwordx4 v[112:115], v3, s[16:19], s40 offen offset:1024
    v_and_b32 v46, 0x80000000, v27
    v_lshrrev_b32 v47, 14, v25
    v_bitop3_b32 v47, v47, v5, v46 bitop3:0xea
    ds_read_b64 v[106:107], v47
    v_and_b32 v99, 0x40000000, v27
    v_lshrrev_b32 v47, 14, v24
    v_bitop3_b32 v47, v47, v5, v99 bitop3:0xea
    ds_read_b64 v[104:105], v47
    s_waitcnt lgkmcnt(2)
    v_cmp_ne_u64 s[50:51], v[72:73], v[68:69]
    v_cmpx_ne_u64 s[54:55], v[74:75], v[70:71]
    s_and_b64 s[82:83], s[54:55], s[80:81]
    s_cbranch_scc1 L2_c126
L2_d126:
    v_mov_b64 v[84:85], v[70:71]
    v_mov_b32 v7, v95
    v_mov_b64 v[86:87], v[74:75]
    s_or_b64 s[80:81], s[80:81], s[54:55]
    s_mov_b64 exec, s[50:51]
    s_and_b64 s[82:83], s[50:51], s[80:81]
    s_cbranch_scc1 L2_c127
L2_d127:
    v_mov_b64 v[84:85], v[68:69]
    v_mov_b32 v7, v94
    v_mov_b64 v[86:87], v[72:73]
    s_mov_b64 exec, -1
    s_or_b64 s[80:81], s[80:81], s[50:51]
    ds_read_b64 v[70:71], v93 offset:65408
    ds_read_b64 v[68:69], v92 offset:65408
    v_bitop3_b32 v94, v24, v5, v99 bitop3:0xea
    v_bitop3_b32 v95, v25, v5, v46 bitop3:0xea
    v_perm_b32 v15, v25, v26, s47
    v_bitop3_b32 v46, v25, 0.5, -0.5 bitop3:0xa8
    v_perm_b32 v14, v24, v26, s46
    v_bitop3_b32 v47, v24, 0.5, -0.5 bitop3:0xa8
    v_bitop3_b32 v15, v6, v15, v46 bitop3:0xca
    v_bitop3_b32 v14, v6, v14, v47 bitop3:0xca
    s_waitcnt lgkmcnt(1)
    v_mfma_f32_4x4x4_16b_bf16 v[80:83], v[10:11], v[70:71], v[80:83]
    s_waitcnt lgkmcnt(0)
    v_mfma_f32_4x4x4_16b_bf16 v[76:79], v[10:11], v[68:69], v[76:79]
    s_nop 2
    v_cvt_pk_bf16_f32 v80, v80, v81
    v_cvt_pk_bf16_f32 v81, v82, v83
    ds_wrxchg_rtn_b64 v[74:75], v93, v[80:81] offset:65408
    v_cvt_pk_bf16_f32 v76, v76, v77
    v_cvt_pk_bf16_f32 v77, v78, v79
    ds_wrxchg_rtn_b64 v[72:73], v92, v[76:77] offset:65408
    v_and_b32 v88, 0x0fffffff, v41
    v_mov_b32 v27, v41
    buffer_load_dwordx2 v[22:23], v88, s[8:11], 0 offen
    buffer_load_dwordx3 v[24:26], v88, s[8:11], 0 offen offset:8
    v_mfma_f32_4x4x4_16b_bf16 v[80:83], v[8:9], v[106:107], 0
    v_mfma_f32_4x4x4_16b_bf16 v[76:79], v[8:9], v[104:105], 0
    v_cmp_lt_u32 s[84:85], v5, v94
    s_nop 2
    v_pk_mul_f32 v[80:81], v[80:81], v[14:15] op_sel:[0,1] op_sel_hi:[1,1]
    v_pk_mul_f32 v[82:83], v[82:83], v[14:15] op_sel:[0,1] op_sel_hi:[1,1]
    v_pk_mul_f32 v[76:77], v[76:77], v[14:15] op_sel:[0,0] op_sel_hi:[1,0]
    v_pk_mul_f32 v[78:79], v[78:79], v[14:15] op_sel:[0,0] op_sel_hi:[1,0]
    s_waitcnt vmcnt(11)
    s_mov_b64 exec, s[6:7]
    v_lshrrev_b32 v30, 16, v30
    s_mov_b64 exec, -1
    v_and_b32 v46, 0x20000000, v31
    v_lshrrev_b32 v47, 14, v29
    v_bitop3_b32 v47, v47, v5, v46 bitop3:0xea
    ds_read_b64 v[102:103], v47
    v_and_b32 v99, 0x10000000, v31
    v_lshrrev_b32 v47, 14, v28
    v_bitop3_b32 v47, v47, v5, v99 bitop3:0xea
    ds_read_b64 v[100:101], v47
    s_waitcnt lgkmcnt(2)
    v_cmp_ne_u64 s[50:51], v[72:73], v[68:69]
    v_cmpx_ne_u64 s[54:55], v[74:75], v[70:71]
    s_and_b64 s[82:83], s[54:55], s[80:81]
    s_cbranch_scc1 L2_c128
L2_d128:
    v_mov_b64 v[84:85], v[70:71]
    v_mov_b32 v7, v93
    v_mov_b64 v[86:87], v[74:75]
    s_or_b64 s[80:81], s[80:81], s[54:55]
    s_mov_b64 exec, s[50:51]
    s_and_b64 s[82:83], s[50:51], s[80:81]
    s_cbranch_scc1 L2_c129
L2_d129:
    v_mov_b64 v[84:85], v[68:69]
    v_mov_b32 v7, v92
    v_mov_b64 v[86:87], v[72:73]
    s_mov_b64 exec, -1
    s_or_b64 s[80:81], s[80:81], s[50:51]
    s_and_b64 exec, s[84:85], s[80:81]
    v_mfma_f32_4x4x4_16b_bf16 v[76:79], v[12:13], v[84:85], 0
    v_mov_b32 v94, v7
    s_andn2_b64 s[80:81], s[80:81], s[84:85]
    v_mfma_f32_4x4x4_16b_bf16 v[76:79], v[10:11], v[86:87], v[76:79]
    s_mov_b64 exec, -1
    ds_read_b64 v[70:71], v95 offset:65408
    ds_read_b64 v[68:69], v94 offset:65408
    v_bitop3_b32 v92, v28, v5, v99 bitop3:0xea
    v_bitop3_b32 v93, v29, v5, v46 bitop3:0xea
    v_perm_b32 v15, v29, v30, s45
    v_bitop3_b32 v46, v29, 0.5, -0.5 bitop3:0xa8
    v_perm_b32 v14, v28, v30, s44
    v_bitop3_b32 v47, v28, 0.5, -0.5 bitop3:0xa8
    v_bitop3_b32 v15, v6, v15, v46 bitop3:0xca
    v_bitop3_b32 v14, v6, v14, v47 bitop3:0xca
    s_waitcnt lgkmcnt(1)
    v_mfma_f32_4x4x4_16b_bf16 v[80:83], v[10:11], v[70:71], v[80:83]
    s_waitcnt lgkmcnt(0)
    v_mfma_f32_4x4x4_16b_bf16 v[76:79], v[10:11], v[68:69], v[76:79]
    s_nop 2
    v_cvt_pk_bf16_f32 v80, v80, v81
    v_cvt_pk_bf16_f32 v81, v82, v83
    ds_wrxchg_rtn_b64 v[74:75], v95, v[80:81] offset:65408
    v_cvt_pk_bf16_f32 v76, v76, v77
    v_cvt_pk_bf16_f32 v77, v78, v79
    ds_wrxchg_rtn_b64 v[72:73], v94, v[76:77] offset:65408
    s_setprio 0
    v_mfma_f32_4x4x4_16b_bf16 v[80:83], v[8:9], v[102:103], 0
    v_mfma_f32_4x4x4_16b_bf16 v[76:79], v[8:9], v[100:101], 0
    v_cmp_lt_u32 s[48:49], v5, v93
    s_nop 2
    v_pk_mul_f32 v[80:81], v[80:81], v[14:15] op_sel:[0,1] op_sel_hi:[1,1]
    v_pk_mul_f32 v[82:83], v[82:83], v[14:15] op_sel:[0,1] op_sel_hi:[1,1]
    v_pk_mul_f32 v[76:77], v[76:77], v[14:15] op_sel:[0,0] op_sel_hi:[1,0]
    v_pk_mul_f32 v[78:79], v[78:79], v[14:15] op_sel:[0,0] op_sel_hi:[1,0]
    s_add_u32 s40, s40, 0xfff24000
    v_and_b32 v47, 0x0fffffff, v42
    v_mov_b32 v31, v42
    buffer_load_dword v30, v47, s[8:11], 0 offen offset:16
    s_mov_b64 exec, s[6:7]
    v_add_u32 v47, 8, v47
    v_lshrrev_b32 v31, 2, v31
    s_mov_b64 exec, -1
    buffer_load_dwordx2 v[28:29], v47, s[8:11], 0 offen
    s_waitcnt vmcnt(8)
    v_and_b32 v46, 0x80000000, v39
    v_lshrrev_b32 v47, 14, v37
    v_bitop3_b32 v47, v47, v5, v46 bitop3:0xea
    ds_read_b64 v[102:103], v47
    v_and_b32 v99, 0x40000000, v39
    v_lshrrev_b32 v47, 14, v36
    v_bitop3_b32 v47, v47, v5, v99 bitop3:0xea
    ds_read_b64 v[100:101], v47
    v_and_b32 v46, 0x20000000, v39
    v_lshrrev_b32 v47, 14, v35
    v_bitop3_b32 v47, v47, v5, v46 bitop3:0xea
    ds_read_b64 v[106:107], v47
    v_and_b32 v99, 0x10000000, v39
    v_lshrrev_b32 v47, 14, v34
    v_bitop3_b32 v47, v47, v5, v99 bitop3:0xea
    ds_read_b64 v[104:105], v47
    s_waitcnt lgkmcnt(4)
    v_cmp_ne_u64 s[50:51], v[72:73], v[68:69]
    v_cmpx_ne_u64 s[54:55], v[74:75], v[70:71]
    s_and_b64 s[82:83], s[54:55], s[80:81]
    s_cbranch_scc1 L2_c130
L2_d130:
    v_mov_b64 v[84:85], v[70:71]
    v_mov_b32 v7, v95
    v_mov_b64 v[86:87], v[74:75]
    s_or_b64 s[80:81], s[80:81], s[54:55]
    s_mov_b64 exec, s[50:51]
    s_and_b64 s[82:83], s[50:51], s[80:81]
    s_cbranch_scc1 L2_c131
L2_d131:
    v_mov_b64 v[84:85], v[68:69]
    v_mov_b32 v7, v94
    v_mov_b64 v[86:87], v[72:73]
    s_mov_b64 exec, -1
    s_or_b64 s[80:81], s[80:81], s[50:51]
    s_and_b64 exec, s[48:49], s[80:81]
    v_mfma_f32_4x4x4_16b_bf16 v[80:83], v[12:13], v[84:85], 0
    v_mov_b32 v93, v7
    s_andn2_b64 s[80:81], s[80:81], s[48:49]
    v_mfma_f32_4x4x4_16b_bf16 v[80:83], v[10:11], v[86:87], v[80:83]
    s_mov_b64 exec, -1
    ds_read_b64 v[70:71], v93 offset:65408
    ds_read_b64 v[68:69], v92 offset:65408
    v_bitop3_b32 v94, v34, v5, v99 bitop3:0xea
    v_bitop3_b32 v95, v35, v5, v46 bitop3:0xea
    v_perm_b32 v15, v35, v38, s45
    v_bitop3_b32 v46, v35, 0.5, -0.5 bitop3:0xa8
    v_perm_b32 v14, v34, v38, s44
    v_bitop3_b32 v47, v34, 0.5, -0.5 bitop3:0xa8
    v_bitop3_b32 v15, v6, v15, v46 bitop3:0xca
    v_bitop3_b32 v14, v6, v14, v47 bitop3:0xca
    s_waitcnt lgkmcnt(1)
    v_mfma_f32_4x4x4_16b_bf16 v[80:83], v[10:11], v[70:71], v[80:83]
    s_waitcnt lgkmcnt(0)
    v_mfma_f32_4x4x4_16b_bf16 v[76:79], v[10:11], v[68:69], v[76:79]
    s_nop 2
    v_cvt_pk_bf16_f32 v80, v80, v81
    v_cvt_pk_bf16_f32 v81, v82, v83
    ds_wrxchg_rtn_b64 v[74:75], v93, v[80:81] offset:65408
    v_cvt_pk_bf16_f32 v76, v76, v77
    v_cvt_pk_bf16_f32 v77, v78, v79
    ds_wrxchg_rtn_b64 v[72:73], v92, v[76:77] offset:65408
    s_barrier
    s_setprio 3
    s_mov_b32 m0, s100
    s_nop 0
    ds_write_addtid_b32 v116 offset:32768
    ds_write_addtid_b32 v117 offset:33024
    ds_write_addtid_b32 v118 offset:33280
    ds_write_addtid_b32 v119 offset:33536
    ds_write_addtid_b32 v120 offset:33792
    ds_write_addtid_b32 v121 offset:34048
    ds_write_addtid_b32 v122 offset:34304
    ds_write_addtid_b32 v123 offset:34560
    v_mfma_f32_4x4x4_16b_bf16 v[80:83], v[8:9], v[106:107], 0
    v_mfma_f32_4x4x4_16b_bf16 v[76:79], v[8:9], v[104:105], 0
    s_nop 3
    v_pk_mul_f32 v[80:81], v[80:81], v[14:15] op_sel:[0,1] op_sel_hi:[1,1]
    v_pk_mul_f32 v[82:83], v[82:83], v[14:15] op_sel:[0,1] op_sel_hi:[1,1]
    v_pk_mul_f32 v[76:77], v[76:77], v[14:15] op_sel:[0,0] op_sel_hi:[1,0]
    v_pk_mul_f32 v[78:79], v[78:79], v[14:15] op_sel:[0,0] op_sel_hi:[1,0]
    v_mov_b32 v44, v43
    s_setprio 2
    ds_write_addtid_b32 v124 offset:34816
    ds_write_addtid_b32 v125 offset:35072
    ds_write_addtid_b32 v126 offset:35328
    ds_write_addtid_b32 v127 offset:35584
    s_waitcnt lgkmcnt(12)
    v_cmp_ne_u64 s[50:51], v[72:73], v[68:69]
    v_cmpx_ne_u64 s[54:55], v[74:75], v[70:71]
    s_and_b64 s[82:83], s[54:55], s[80:81]
    s_cbranch_scc1 L2_c132
L2_d132:
    v_mov_b64 v[84:85], v[70:71]
    v_mov_b32 v7, v93
    v_mov_b64 v[86:87], v[74:75]
    s_or_b64 s[80:81], s[80:81], s[54:55]
    s_mov_b64 exec, s[50:51]
    s_and_b64 s[82:83], s[50:51], s[80:81]
    s_cbranch_scc1 L2_c133
L2_d133:
    v_mov_b64 v[84:85], v[68:69]
    v_mov_b32 v7, v92
    v_mov_b64 v[86:87], v[72:73]
    s_mov_b64 exec, -1
    s_or_b64 s[80:81], s[80:81], s[50:51]
    ds_read_b64 v[70:71], v95 offset:65408
    ds_read_b64 v[68:69], v94 offset:65408
    v_and_b32 v46, 0x40000000, v39
    v_bitop3_b32 v92, v36, v5, v46 bitop3:0xea
    v_and_b32 v46, 0x80000000, v39
    v_bitop3_b32 v93, v37, v5, v46 bitop3:0xea
    v_perm_b32 v15, v37, v38, s47
    v_bitop3_b32 v46, v37, 0.5, -0.5 bitop3:0xa8
    v_perm_b32 v14, v36, v38, s46
    v_bitop3_b32 v47, v36, 0.5, -0.5 bitop3:0xa8
    v_bitop3_b32 v15, v6, v15, v46 bitop3:0xca
    v_bitop3_b32 v14, v6, v14, v47 bitop3:0xca
    s_setprio 1
    s_waitcnt lgkmcnt(1)
    v_mfma_f32_4x4x4_16b_bf16 v[80:83], v[10:11], v[70:71], v[80:83]
    s_waitcnt lgkmcnt(0)
    v_mfma_f32_4x4x4_16b_bf16 v[76:79], v[10:11], v[68:69], v[76:79]
    s_nop 2
    v_cvt_pk_bf16_f32 v80, v80, v81
    v_cvt_pk_bf16_f32 v81, v82, v83
    ds_wrxchg_rtn_b64 v[74:75], v95, v[80:81] offset:65408
    v_cvt_pk_bf16_f32 v76, v76, v77
    v_cvt_pk_bf16_f32 v77, v78, v79
    ds_wrxchg_rtn_b64 v[72:73], v94, v[76:77] offset:65408
    v_and_b32 v88, 0x0fffffff, v44
    v_mov_b32 v39, v44
    buffer_load_dwordx2 v[34:35], v88, s[8:11], 0 offen
    buffer_load_dwordx3 v[36:38], v88, s[8:11], 0 offen offset:8
    s_setprio 0
    s_waitcnt vmcnt(9)
    s_mov_b32 m0, s38
    s_nop 0
    ds_write_addtid_b32 v108 offset:0
    ds_write_addtid_b32 v109 offset:256
    ds_write_addtid_b32 v110 offset:512
    ds_write_addtid_b32 v111 offset:768
    s_waitcnt vmcnt(6)
    ds_write_addtid_b32 v112 offset:1024
    ds_write_addtid_b32 v113 offset:1280
    ds_write_addtid_b32 v114 offset:1536
    ds_write_addtid_b32 v115 offset:1792
    v_mfma_f32_4x4x4_16b_bf16 v[80:83], v[8:9], v[102:103], 0
    v_mfma_f32_4x4x4_16b_bf16 v[76:79], v[8:9], v[100:101], 0
    v_cmp_lt_u32 s[84:85], v5, v92
    s_nop 2
    v_pk_mul_f32 v[80:81], v[80:81], v[14:15] op_sel:[0,1] op_sel_hi:[1,1]
    v_pk_mul_f32 v[82:83], v[82:83], v[14:15] op_sel:[0,1] op_sel_hi:[1,1]
    v_pk_mul_f32 v[76:77], v[76:77], v[14:15] op_sel:[0,0] op_sel_hi:[1,0]
    v_pk_mul_f32 v[78:79], v[78:79], v[14:15] op_sel:[0,0] op_sel_hi:[1,0]
    s_add_u32 s42, s42, 1
    s_waitcnt lgkmcnt(0)
    s_barrier
    s_bitcmp1_b32 s36, s42
    s_cbranch_scc1 L2_slow
L2_ret7:
    s_setprio 3
    s_bitcmp1_b32 s43, s42
    s_cbranch_scc1 L2_oa134
L2_ob134:
    v_and_b32 v46, 0x20000000, v21
    v_lshrrev_b32 v47, 14, v17
    v_bitop3_b32 v47, v47, v5, v46 bitop3:0xea
    ds_read_b64 v[106:107], v47
    v_and_b32 v99, 0x10000000, v21
    v_lshrrev_b32 v47, 14, v16
    v_bitop3_b32 v47, v47, v5, v99 bitop3:0xea
    ds_read_b64 v[104:105], v47
    v_cmp_ne_u64 s[50:51], v[72:73], v[68:69]
    v_cmpx_ne_u64 s[54:55], v[74:75], v[70:71]
    s_and_b64 s[82:83], s[54:55], s[80:81]
    s_cbranch_scc1 L2_c135
L2_d135:
    v_mov_b64 v[84:85], v[70:71]
    v_mov_b32 v7, v95
    v_mov_b64 v[86:87], v[74:75]
    s_or_b64 s[80:81], s[80:81], s[54:55]
    s_mov_b64 exec, s[50:51]
    s_and_b64 s[82:83], s[50:51], s[80:81]
    s_cbranch_scc1 L2_c136
L2_d136:
    v_mov_b64 v[84:85], v[68:69]
    v_mov_b32 v7, v94
    v_mov_b64 v[86:87], v[72:73]
    s_mov_b64 exec, -1
    s_or_b64 s[80:81], s[80:81], s[50:51]
    s_and_b64 exec, s[84:85], s[80:81]
    v_mfma_f32_4x4x4_16b_bf16 v[76:79], v[12:13], v[84:85], 0
    v_mov_b32 v92, v7
    s_andn2_b64 s[80:81], s[80:81], s[84:85]
    v_mfma_f32_4x4x4_16b_bf16 v[76:79], v[10:11], v[86:87], v[76:79]
    s_mov_b64 exec, -1
    ds_read_b64 v[70:71], v93 offset:65408
    ds_read_b64 v[68:69], v92 offset:65408
    v_bitop3_b32 v94, v16, v5, v99 bitop3:0xea
    v_bitop3_b32 v95, v17, v5, v46 bitop3:0xea
    v_perm_b32 v15, v17, v20, s45
    v_bitop3_b32 v46, v17, 0.5, -0.5 bitop3:0xa8
    v_perm_b32 v14, v16, v20, s44
    v_bitop3_b32 v47, v16, 0.5, -0.5 bitop3:0xa8
    v_bitop3_b32 v15, v6, v15, v46 bitop3:0xca
    v_bitop3_b32 v14, v6, v14, v47 bitop3:0xca
    s_waitcnt lgkmcnt(1)
    v_mfma_f32_4x4x4_16b_bf16 v[80:83], v[10:11], v[70:71], v[80:83]
    s_waitcnt lgkmcnt(0)
    v_mfma_f32_4x4x4_16b_bf16 v[76:79], v[10:11], v[68:69], v[76:79]
    s_nop 2
    v_cvt_pk_bf16_f32 v80, v80, v81
    v_cvt_pk_bf16_f32 v81, v82, v83
    ds_wrxchg_rtn_b64 v[74:75], v93, v[80:81] offset:65408
    v_cvt_pk_bf16_f32 v76, v76, v77
    v_cvt_pk_bf16_f32 v77, v78, v79
    ds_wrxchg_rtn_b64 v[72:73], v92, v[76:77] offset:65408
    v_mfma_f32_4x4x4_16b_bf16 v[80:83], v[8:9], v[106:107], 0
    v_mfma_f32_4x4x4_16b_bf16 v[76:79], v[8:9], v[104:105], 0
    v_cmp_lt_u32 s[84:85], v5, v94
    s_nop 2
    v_pk_mul_f32 v[80:81], v[80:81], v[14:15] op_sel:[0,1] op_sel_hi:[1,1]
    v_pk_mul_f32 v[82:83], v[82:83], v[14:15] op_sel:[0,1] op_sel_hi:[1,1]
    v_pk_mul_f32 v[76:77], v[76:77], v[14:15] op_sel:[0,0] op_sel_hi:[1,0]
    v_pk_mul_f32 v[78:79], v[78:79], v[14:15] op_sel:[0,0] op_sel_hi:[1,0]
    v_and_b32 v46, 0x80000000, v21
    v_lshrrev_b32 v47, 14, v19
    v_bitop3_b32 v47, v47, v5, v46 bitop3:0xea
    ds_read_b64 v[102:103], v47
    v_and_b32 v99, 0x40000000, v21
    v_lshrrev_b32 v47, 14, v18
    v_bitop3_b32 v47, v47, v5, v99 bitop3:0xea
    ds_read_b64 v[100:101], v47
    s_waitcnt lgkmcnt(2)
    v_cmp_ne_u64 s[50:51], v[72:73], v[68:69]
    v_cmpx_ne_u64 s[54:55], v[74:75], v[70:71]
    s_and_b64 s[82:83], s[54:55], s[80:81]
    s_cbranch_scc1 L2_c137
L2_d137:
    v_mov_b64 v[84:85], v[70:71]
    v_mov_b32 v7, v93
    v_mov_b64 v[86:87], v[74:75]
    s_or_b64 s[80:81], s[80:81], s[54:55]
    s_mov_b64 exec, s[50:51]
    s_and_b64 s[82:83], s[50:51], s[80:81]
    s_cbranch_scc1 L2_c138
L2_d138:
    v_mov_b64 v[84:85], v[68:69]
    v_mov_b32 v7, v92
    v_mov_b64 v[86:87], v[72:73]
    s_mov_b64 exec, -1
    s_or_b64 s[80:81], s[80:81], s[50:51]
    s_and_b64 exec, s[84:85], s[80:81]
    v_mfma_f32_4x4x4_16b_bf16 v[76:79], v[12:13], v[84:85], 0
    v_mov_b32 v94, v7
    s_andn2_b64 s[80:81], s[80:81], s[84:85]
    v_mfma_f32_4x4x4_16b_bf16 v[76:79], v[10:11], v[86:87], v[76:79]
    s_mov_b64 exec, -1
    ds_read_b64 v[70:71], v95 offset:65408
    ds_read_b64 v[68:69], v94 offset:65408
    v_bitop3_b32 v92, v18, v5, v99 bitop3:0xea
    v_bitop3_b32 v93, v19, v5, v46 bitop3:0xea
    v_perm_b32 v15, v19, v20, s47
    v_bitop3_b32 v46, v19, 0.5, -0.5 bitop3:0xa8
    v_perm_b32 v14, v18, v20, s46
    v_bitop3_b32 v47, v18, 0.5, -0.5 bitop3:0xa8
    v_bitop3_b32 v15, v6, v15, v46 bitop3:0xca
    v_bitop3_b32 v14, v6, v14, v47 bitop3:0xca
    s_waitcnt lgkmcnt(1)
    v_mfma_f32_4x4x4_16b_bf16 v[80:83], v[10:11], v[70:71], v[80:83]
    s_waitcnt lgkmcnt(0)
    v_mfma_f32_4x4x4_16b_bf16 v[76:79], v[10:11], v[68:69], v[76:79]
    s_nop 2
    v_cvt_pk_bf16_f32 v80, v80, v81
    v_cvt_pk_bf16_f32 v81, v82, v83
    ds_wrxchg_rtn_b64 v[74:75], v95, v[80:81] offset:65408
    v_cvt_pk_bf16_f32 v76, v76, v77
    v_cvt_pk_bf16_f32 v77, v78, v79
    ds_wrxchg_rtn_b64 v[72:73], v94, v[76:77] offset:65408
    s_setprio 2
    v_mfma_f32_4x4x4_16b_bf16 v[80:83], v[8:9], v[102:103], 0
    v_mfma_f32_4x4x4_16b_bf16 v[76:79], v[8:9], v[100:101], 0
    v_cmp_lt_u32 s[48:49], v5, v93
    s_nop 2
    v_pk_mul_f32 v[80:81], v[80:81], v[14:15] op_sel:[0,1] op_sel_hi:[1,1]
    v_pk_mul_f32 v[82:83], v[82:83], v[14:15] op_sel:[0,1] op_sel_hi:[1,1]
    v_pk_mul_f32 v[76:77], v[76:77], v[14:15] op_sel:[0,0] op_sel_hi:[1,0]
    v_pk_mul_f32 v[78:79], v[78:79], v[14:15] op_sel:[0,0] op_sel_hi:[1,0]
    s_waitcnt vmcnt(4)
    v_and_b32 v46, 0x20000000, v27
    v_lshrrev_b32 v47, 14, v23
    v_bitop3_b32 v47, v47, v5, v46 bitop3:0xea
    ds_read_b64 v[106:107], v47
    v_and_b32 v99, 0x10000000, v27
    v_lshrrev_b32 v47, 14, v22
    v_bitop3_b32 v47, v47, v5, v99 bitop3:0xea
    ds_read_b64 v[104:105], v47
    s_waitcnt lgkmcnt(2)
    v_cmp_ne_u64 s[50:51], v[72:73], v[68:69]
    v_cmpx_ne_u64 s[54:55], v[74:75], v[70:71]
    s_and_b64 s[82:83], s[54:55], s[80:81]
    s_cbranch_scc1 L2_c139
L2_d139:
    v_mov_b64 v[84:85], v[70:71]
    v_mov_b32 v7, v95
    v_mov_b64 v[86:87], v[74:75]
    s_or_b64 s[80:81], s[80:81], s[54:55]
    s_mov_b64 exec, s[50:51]
    s_and_b64 s[82:83], s[50:51], s[80:81]
    s_cbranch_scc1 L2_c140
L2_d140:
    v_mov_b64 v[84:85], v[68:69]
    v_mov_b32 v7, v94
    v_mov_b64 v[86:87], v[72:73]
    s_mov_b64 exec, -1
    s_or_b64 s[80:81], s[80:81], s[50:51]
    s_and_b64 exec, s[48:49], s[80:81]
    v_mfma_f32_4x4x4_16b_bf16 v[80:83], v[12:13], v[84:85], 0
    v_mov_b32 v93, v7
    s_andn2_b64 s[80:81], s[80:81], s[48:49]
    v_mfma_f32_4x4x4_16b_bf16 v[80:83], v[10:11], v[86:87], v[80:83]
    s_mov_b64 exec, -1
    ds_read_b64 v[70:71], v93 offset:65408
    ds_read_b64 v[68:69], v92 offset:65408
    v_bitop3_b32 v94, v22, v5, v99 bitop3:0xea
    v_bitop3_b32 v95, v23, v5, v46 bitop3:0xea
    v_perm_b32 v15, v23, v26, s45
    v_bitop3_b32 v46, v23, 0.5, -0.5 bitop3:0xa8
    v_perm_b32 v14, v22, v26, s44
    v_bitop3_b32 v47, v22, 0.5, -0.5 bitop3:0xa8
    v_bitop3_b32 v15, v6, v15, v46 bitop3:0xca
    v_bitop3_b32 v14, v6, v14, v47 bitop3:0xca
    s_waitcnt lgkmcnt(1)
    v_mfma_f32_4x4x4_16b_bf16 v[80:83], v[10:11], v[70:71], v[80:83]
    s_waitcnt lgkmcnt(0)
    v_mfma_f32_4x4x4_16b_bf16 v[76:79], v[10:11], v[68:69], v[76:79]
    s_nop 2
    v_cvt_pk_bf16_f32 v80, v80, v81
    v_cvt_pk_bf16_f32 v81, v82, v83
    ds_wrxchg_rtn_b64 v[74:75], v93, v[80:81] offset:65408
    v_cvt_pk_bf16_f32 v76, v76, v77
    v_cvt_pk_bf16_f32 v77, v78, v79
    ds_wrxchg_rtn_b64 v[72:73], v92, v[76:77] offset:65408
    s_setprio 1
    v_mfma_f32_4x4x4_16b_bf16 v[80:83], v[8:9], v[106:107], 0
    v_mfma_f32_4x4x4_16b_bf16 v[76:79], v[8:9], v[104:105], 0
    s_nop 3
    v_pk_mul_f32 v[80:81], v[80:81], v[14:15] op_sel:[0,1] op_sel_hi:[1,1]
    v_pk_mul_f32 v[82:83], v[82:83], v[14:15] op_sel:[0,1] op_sel_hi:[1,1]
    v_pk_mul_f32 v[76:77], v[76:77], v[14:15] op_sel:[0,0] op_sel_hi:[1,0]
    v_pk_mul_f32 v[78:79], v[78:79], v[14:15] op_sel:[0,0] op_sel_hi:[1,0]
    s_bitcmp1_b32 s43, s42
    s_cbranch_scc1 L2_oa141
L2_ob141:
    v_and_b32 v46, 0x80000000, v27
    v_lshrrev_b32 v47, 14, v25
    v_bitop3_b32 v47, v47, v5, v46 bitop3:0xea
    ds_read_b64 v[102:103], v47
    v_and_b32 v99, 0x40000000, v27
    v_lshrrev_b32 v47, 14, v24
    v_bitop3_b32 v47, v47, v5, v99 bitop3:0xea
    ds_read_b64 v[100:101], v47
    s_waitcnt lgkmcnt(2)
    v_cmp_ne_u64 s[50:51], v[72:73], v[68:69]
    v_cmpx_ne_u64 s[54:55], v[74:75], v[70:71]
    s_and_b64 s[82:83], s[54:55], s[80:81]
    s_cbranch_scc1 L2_c142
L2_d142:
    v_mov_b64 v[84:85], v[70:71]
    v_mov_b32 v7, v93
    v_mov_b64 v[86:87], v[74:75]
    s_or_b64 s[80:81], s[80:81], s[54:55]
    s_mov_b64 exec, s[50:51]
    s_and_b64 s[82:83], s[50:51], s[80:81]
    s_cbranch_scc1 L2_c143
L2_d143:
    v_mov_b64 v[84:85], v[68:69]
    v_mov_b32 v7, v92
    v_mov_b64 v[86:87], v[72:73]
    s_mov_b64 exec, -1
    s_or_b64 s[80:81], s[80:81], s[50:51]
    ds_read_b64 v[70:71], v95 offset:65408
    ds_read_b64 v[68:69], v94 offset:65408
    v_bitop3_b32 v92, v24, v5, v99 bitop3:0xea
    v_bitop3_b32 v93, v25, v5, v46 bitop3:0xea
    v_perm_b32 v15, v25, v26, s47
    v_bitop3_b32 v46, v25, 0.5, -0.5 bitop3:0xa8
    v_perm_b32 v14, v24, v26, s46
    v_bitop3_b32 v47, v24, 0.5, -0.5 bitop3:0xa8
    v_bitop3_b32 v15, v6, v15, v46 bitop3:0xca
    v_bitop3_b32 v14, v6, v14, v47 bitop3:0xca
    s_waitcnt lgkmcnt(1)
    v_mfma_f32_4x4x4_16b_bf16 v[80:83], v[10:11], v[70:71], v[80:83]
    s_waitcnt lgkmcnt(0)
    v_mfma_f32_4x4x4_16b_bf16 v[76:79], v[10:11], v[68:69], v[76:79]
    s_nop 2
    v_cvt_pk_bf16_f32 v80, v80, v81
    v_cvt_pk_bf16_f32 v81, v82, v83
    ds_wrxchg_rtn_b64 v[74:75], v95, v[80:81] offset:65408
    v_cvt_pk_bf16_f32 v76, v76, v77
    v_cvt_pk_bf16_f32 v77, v78, v79
    ds_wrxchg_rtn_b64 v[72:73], v94, v[76:77] offset:65408
    v_mfma_f32_4x4x4_16b_bf16 v[80:83], v[8:9], v[102:103], 0
    v_mfma_f32_4x4x4_16b_bf16 v[76:79], v[8:9], v[100:101], 0
    v_cmp_lt_u32 s[84:85], v5, v92
    s_nop 2
    v_pk_mul_f32 v[80:81], v[80:81], v[14:15] op_sel:[0,1] op_sel_hi:[1,1]
    v_pk_mul_f32 v[82:83], v[82:83], v[14:15] op_sel:[0,1] op_sel_hi:[1,1]
    v_pk_mul_f32 v[76:77], v[76:77], v[14:15] op_sel:[0,0] op_sel_hi:[1,0]
    v_pk_mul_f32 v[78:79], v[78:79], v[14:15] op_sel:[0,0] op_sel_hi:[1,0]
    s_lshl_b32 s3, s32, 12
    v_subrev_u32 v122, s3, v3
    s_mul_i32 s3, s33, 20000
    v_add_u32 v118, s3, v122
    v_add_u32 v119, 0x4000, v118
    s_lshl_b32 s3, s34, 7
    v_lshrrev_b32 v123, 7, v118
    v_and_b32 v120, 0x70, v118
    v_lshl_add_u32 v120, v123, 13, v120
    v_add_u32 v120, s3, v120
    v_lshrrev_b32 v123, 7, v119
    v_and_b32 v121, 0x70, v119
    v_lshl_add_u32 v121, v123, 13, v121
    v_add_u32 v121, s3, v121
    v_cmp_le_u32 vcc, 3616, v122
    s_mov_b64 exec, vcc
    v_mov_b32 v119, 2.0
    v_mov_b32 v121, 2.0
    s_mov_b64 exec, -1
    v_and_b32 v123, 0x30, v122
    v_lshlrev_b32 v123, 2, v123
    buffer_load_dwordx4 v[48:51], v123, s[24:27], 0 offen
    buffer_load_dwordx4 v[52:55], v123, s[24:27], 0 offen offset:16
    buffer_load_dwordx2 v[56:57], v123, s[24:27], 0 offen offset:32
    s_mov_b32 s12, s4
    s_mov_b32 s13, s5
    s_mov_b32 s14, 0x138800
    s_mov_b32 s15, 0x20000
    s_mov_b32 s16, s28
    s_mov_b32 s17, s29
    s_mov_b32 s18, 0x4e2000
    s_mov_b32 s19, 0x20000
    v_lshrrev_b32 v123, 2, v120
    buffer_load_dword v116, v123, s[12:15], 0 offen
    buffer_load_dwordx4 v[108:111], v120, s[16:19], 0 offen
    v_lshrrev_b32 v123, 2, v121
    buffer_load_dword v117, v123, s[12:15], 0 offen
    buffer_load_dwordx4 v[112:115], v121, s[16:19], 0 offen
    s_waitcnt vmcnt(9)
    s_mov_b64 exec, s[6:7]
    v_lshrrev_b32 v30, 16, v30
    s_mov_b64 exec, -1
    v_and_b32 v46, 0x20000000, v31
    v_lshrrev_b32 v47, 14, v29
    v_bitop3_b32 v47, v47, v5, v46 bitop3:0xea
    ds_read_b64 v[106:107], v47
    v_and_b32 v99, 0x10000000, v31
    v_lshrrev_b32 v47, 14, v28
    v_bitop3_b32 v47, v47, v5, v99 bitop3:0xea
    ds_read_b64 v[104:105], v47
    s_waitcnt lgkmcnt(2)
    v_cmp_ne_u64 s[50:51], v[72:73], v[68:69]
    v_cmpx_ne_u64 s[54:55], v[74:75], v[70:71]
    s_and_b64 s[82:83], s[54:55], s[80:81]
    s_cbranch_scc1 L2_c144
L2_d144:
    v_mov_b64 v[84:85], v[70:71]
    v_mov_b32 v7, v95
    v_mov_b64 v[86:87], v[74:75]
    s_or_b64 s[80:81], s[80:81], s[54:55]
    s_mov_b64 exec, s[50:51]
    s_and_b64 s[82:83], s[50:51], s[80:81]
    s_cbranch_scc1 L2_c145
L2_d145:
    v_mov_b64 v[84:85], v[68:69]
    v_mov_b32 v7, v94
    v_mov_b64 v[86:87], v[72:73]
    s_mov_b64 exec, -1
    s_or_b64 s[80:81], s[80:81], s[50:51]
    s_and_b64 exec, s[84:85], s[80:81]
    v_mfma_f32_4x4x4_16b_bf16 v[76:79], v[12:13], v[84:85], 0
    v_mov_b32 v92, v7
    s_andn2_b64 s[80:81], s[80:81], s[84:85]
    v_mfma_f32_4x4x4_16b_bf16 v[76:79], v[10:11], v[86:87], v[76:79]
    s_mov_b64 exec, -1
    ds_read_b64 v[70:71], v93 offset:65408
    ds_read_b64 v[68:69], v92 offset:65408
    v_bitop3_b32 v94, v28, v5, v99 bitop3:0xea
    v_bitop3_b32 v95, v29, v5, v46 bitop3:0xea
    v_perm_b32 v15, v29, v30, s45
    v_bitop3_b32 v46, v29, 0.5, -0.5 bitop3:0xa8
    v_perm_b32 v14, v28, v30, s44
    v_bitop3_b32 v47, v28, 0.5, -0.5 bitop3:0xa8
    v_bitop3_b32 v15, v6, v15, v46 bitop3:0xca
    v_bitop3_b32 v14, v6, v14, v47 bitop3:0xca
    s_waitcnt lgkmcnt(1)
    v_mfma_f32_4x4x4_16b_bf16 v[80:83], v[10:11], v[70:71], v[80:83]
    s_waitcnt lgkmcnt(0)
    v_mfma_f32_4x4x4_16b_bf16 v[76:79], v[10:11], v[68:69], v[76:79]
    s_nop 2
    v_cvt_pk_bf16_f32 v80, v80, v81
    v_cvt_pk_bf16_f32 v81, v82, v83
    ds_wrxchg_rtn_b64 v[74:75], v93, v[80:81] offset:65408
    v_cvt_pk_bf16_f32 v76, v76, v77
    v_cvt_pk_bf16_f32 v77, v78, v79
    ds_wrxchg_rtn_b64 v[72:73], v92, v[76:77] offset:65408
    s_setprio 0
    v_mfma_f32_4x4x4_16b_bf16 v[80:83], v[8:9], v[106:107], 0
    v_mfma_f32_4x4x4_16b_bf16 v[76:79], v[8:9], v[104:105], 0
    v_cmp_lt_u32 s[48:49], v5, v95
    s_nop 2
    v_pk_mul_f32 v[80:81], v[80:81], v[14:15] op_sel:[0,1] op_sel_hi:[1,1]
    v_pk_mul_f32 v[82:83], v[82:83], v[14:15] op_sel:[0,1] op_sel_hi:[1,1]
    v_pk_mul_f32 v[76:77], v[76:77], v[14:15] op_sel:[0,0] op_sel_hi:[1,0]
    v_pk_mul_f32 v[78:79], v[78:79], v[14:15] op_sel:[0,0] op_sel_hi:[1,0]
    s_waitcnt vmcnt(7)
    v_and_b32 v46, 0x80000000, v39
    v_lshrrev_b32 v47, 14, v37
    v_bitop3_b32 v47, v47, v5, v46 bitop3:0xea
    ds_read_b64 v[106:107], v47
    v_and_b32 v99, 0x40000000, v39
    v_lshrrev_b32 v47, 14, v36
    v_bitop3_b32 v47, v47, v5, v99 bitop3:0xea
    ds_read_b64 v[104:105], v47
    v_and_b32 v46, 0x20000000, v39
    v_lshrrev_b32 v47, 14, v35
    v_bitop3_b32 v47, v47, v5, v46 bitop3:0xea
    ds_read_b64 v[102:103], v47
    v_and_b32 v99, 0x10000000, v39
    v_lshrrev_b32 v47, 14, v34
    v_bitop3_b32 v47, v47, v5, v99 bitop3:0xea
    ds_read_b64 v[100:101], v47
    s_waitcnt lgkmcnt(4)
    v_cmp_ne_u64 s[50:51], v[72:73], v[68:69]
    v_cmpx_ne_u64 s[54:55], v[74:75], v[70:71]
    s_and_b64 s[82:83], s[54:55], s[80:81]
    s_cbranch_scc1 L2_c146
L2_d146:
    v_mov_b64 v[84:85], v[70:71]
    v_mov_b32 v7, v93
    v_mov_b64 v[86:87], v[74:75]
    s_or_b64 s[80:81], s[80:81], s[54:55]
    s_mov_b64 exec, s[50:51]
    s_and_b64 s[82:83], s[50:51], s[80:81]
    s_cbranch_scc1 L2_c147
L2_d147:
    v_mov_b64 v[84:85], v[68:69]
    v_mov_b32 v7, v92
    v_mov_b64 v[86:87], v[72:73]
    s_mov_b64 exec, -1
    s_or_b64 s[80:81], s[80:81], s[50:51]
    s_and_b64 exec, s[48:49], s[80:81]
    v_mfma_f32_4x4x4_16b_bf16 v[80:83], v[12:13], v[84:85], 0
    v_mov_b32 v95, v7
    s_andn2_b64 s[80:81], s[80:81], s[48:49]
    v_mfma_f32_4x4x4_16b_bf16 v[80:83], v[10:11], v[86:87], v[80:83]
    s_mov_b64 exec, -1
    ds_read_b64 v[70:71], v95 offset:65408
    ds_read_b64 v[68:69], v94 offset:65408
    v_bitop3_b32 v92, v34, v5, v99 bitop3:0xea
    v_bitop3_b32 v93, v35, v5, v46 bitop3:0xea
    v_perm_b32 v15, v35, v38, s45
    v_bitop3_b32 v46, v35, 0.5, -0.5 bitop3:0xa8
    v_perm_b32 v14, v34, v38, s44
    v_bitop3_b32 v47, v34, 0.5, -0.5 bitop3:0xa8
    v_bitop3_b32 v15, v6, v15, v46 bitop3:0xca
    v_bitop3_b32 v14, v6, v14, v47 bitop3:0xca
    s_waitcnt lgkmcnt(1)
    v_mfma_f32_4x4x4_16b_bf16 v[80:83], v[10:11], v[70:71], v[80:83]
    s_waitcnt lgkmcnt(0)
    v_mfma_f32_4x4x4_16b_bf16 v[76:79], v[10:11], v[68:69], v[76:79]
    s_nop 2
    v_cvt_pk_bf16_f32 v80, v80, v81
    v_cvt_pk_bf16_f32 v81, v82, v83
    ds_wrxchg_rtn_b64 v[74:75], v95, v[80:81] offset:65408
    v_cvt_pk_bf16_f32 v76, v76, v77
    v_cvt_pk_bf16_f32 v77, v78, v79
    ds_wrxchg_rtn_b64 v[72:73], v94, v[76:77] offset:65408
    v_mfma_f32_4x4x4_16b_bf16 v[80:83], v[8:9], v[102:103], 0
    v_mfma_f32_4x4x4_16b_bf16 v[76:79], v[8:9], v[100:101], 0
    s_nop 3
    v_pk_mul_f32 v[80:81], v[80:81], v[14:15] op_sel:[0,1] op_sel_hi:[1,1]
    v_pk_mul_f32 v[82:83], v[82:83], v[14:15] op_sel:[0,1] op_sel_hi:[1,1]
    v_pk_mul_f32 v[76:77], v[76:77], v[14:15] op_sel:[0,0] op_sel_hi:[1,0]
    v_pk_mul_f32 v[78:79], v[78:79], v[14:15] op_sel:[0,0] op_sel_hi:[1,0]
    s_waitcnt lgkmcnt(0)
    v_cmp_ne_u64 s[50:51], v[72:73], v[68:69]
    v_cmpx_ne_u64 s[54:55], v[74:75], v[70:71]
    s_and_b64 s[82:83], s[54:55], s[80:81]
    s_cbranch_scc1 L2_c148
L2_d148:
    v_mov_b64 v[84:85], v[70:71]
    v_mov_b32 v7, v95
    v_mov_b64 v[86:87], v[74:75]
    s_or_b64 s[80:81], s[80:81], s[54:55]
    s_mov_b64 exec, s[50:51]
    s_and_b64 s[82:83], s[50:51], s[80:81]
    s_cbranch_scc1 L2_c149
L2_d149:
    v_mov_b64 v[84:85], v[68:69]
    v_mov_b32 v7, v94
    v_mov_b64 v[86:87], v[72:73]
    s_mov_b64 exec, -1
    s_or_b64 s[80:81], s[80:81], s[50:51]
    ds_read_b64 v[70:71], v93 offset:65408
    ds_read_b64 v[68:69], v92 offset:65408
    v_and_b32 v46, 0x40000000, v39
    v_bitop3_b32 v94, v36, v5, v46 bitop3:0xea
    v_and_b32 v46, 0x80000000, v39
    v_bitop3_b32 v95, v37, v5, v46 bitop3:0xea
    v_perm_b32 v15, v37, v38, s47
    v_bitop3_b32 v46, v37, 0.5, -0.5 bitop3:0xa8
    v_perm_b32 v14, v36, v38, s46
    v_bitop3_b32 v47, v36, 0.5, -0.5 bitop3:0xa8
    v_bitop3_b32 v15, v6, v15, v46 bitop3:0xca
    v_bitop3_b32 v14, v6, v14, v47 bitop3:0xca
    s_waitcnt lgkmcnt(1)
    v_mfma_f32_4x4x4_16b_bf16 v[80:83], v[10:11], v[70:71], v[80:83]
    s_waitcnt lgkmcnt(0)
    v_mfma_f32_4x4x4_16b_bf16 v[76:79], v[10:11], v[68:69], v[76:79]
    s_nop 2
    v_cvt_pk_bf16_f32 v80, v80, v81
    v_cvt_pk_bf16_f32 v81, v82, v83
    ds_wrxchg_rtn_b64 v[74:75], v93, v[80:81] offset:65408
    v_cvt_pk_bf16_f32 v76, v76, v77
    v_cvt_pk_bf16_f32 v77, v78, v79
    ds_wrxchg_rtn_b64 v[72:73], v92, v[76:77] offset:65408
    v_mfma_f32_4x4x4_16b_bf16 v[80:83], v[8:9], v[106:107], 0
    v_mfma_f32_4x4x4_16b_bf16 v[76:79], v[8:9], v[104:105], 0
    v_cmp_lt_u32 s[84:85], v5, v94
    s_nop 2
    v_pk_mul_f32 v[80:81], v[80:81], v[14:15] op_sel:[0,1] op_sel_hi:[1,1]
    v_pk_mul_f32 v[82:83], v[82:83], v[14:15] op_sel:[0,1] op_sel_hi:[1,1]
    v_pk_mul_f32 v[76:77], v[76:77], v[14:15] op_sel:[0,0] op_sel_hi:[1,0]
    v_pk_mul_f32 v[78:79], v[78:79], v[14:15] op_sel:[0,0] op_sel_hi:[1,0]
    s_waitcnt lgkmcnt(0)
    v_cmp_ne_u64 s[50:51], v[72:73], v[68:69]
    v_cmpx_ne_u64 s[54:55], v[74:75], v[70:71]
    s_and_b64 s[82:83], s[54:55], s[80:81]
    s_cbranch_scc1 L2_c150
L2_d150:
    v_mov_b64 v[84:85], v[70:71]
    v_mov_b32 v7, v93
    v_mov_b64 v[86:87], v[74:75]
    s_or_b64 s[80:81], s[80:81], s[54:55]
    s_mov_b64 exec, s[50:51]
    s_and_b64 s[82:83], s[50:51], s[80:81]
    s_cbranch_scc1 L2_c151
L2_d151:
    v_mov_b64 v[84:85], v[68:69]
    v_mov_b32 v7, v92
    v_mov_b64 v[86:87], v[72:73]
    s_mov_b64 exec, -1
    s_or_b64 s[80:81], s[80:81], s[50:51]
    s_and_b64 exec, s[84:85], s[80:81]
    v_mfma_f32_4x4x4_16b_bf16 v[76:79], v[12:13], v[84:85], 0
    v_mov_b32 v94, v7
    s_andn2_b64 s[80:81], s[80:81], s[84:85]
    v_mfma_f32_4x4x4_16b_bf16 v[76:79], v[10:11], v[86:87], v[76:79]
    s_mov_b64 exec, -1
    ds_read_b64 v[70:71], v95 offset:65408
    ds_read_b64 v[68:69], v94 offset:65408
    s_waitcnt lgkmcnt(1)
    v_mfma_f32_4x4x4_16b_bf16 v[80:83], v[10:11], v[70:71], v[80:83]
    s_waitcnt lgkmcnt(0)
    v_mfma_f32_4x4x4_16b_bf16 v[76:79], v[10:11], v[68:69], v[76:79]
    s_nop 2
    v_cvt_pk_bf16_f32 v80, v80, v81
    v_cvt_pk_bf16_f32 v81, v82, v83
    ds_wrxchg_rtn_b64 v[74:75], v95, v[80:81] offset:65408
    v_cvt_pk_bf16_f32 v76, v76, v77
    v_cvt_pk_bf16_f32 v77, v78, v79
    ds_wrxchg_rtn_b64 v[72:73], v94, v[76:77] offset:65408
    s_waitcnt lgkmcnt(0)
    v_cmpx_ne_u64 vcc, v[74:75], v[70:71]
    s_and_b64 s[82:83], vcc, s[80:81]
    s_cbranch_scc1 L2_c152
L2_d152:
    v_mov_b64 v[84:85], v[70:71]
    v_mov_b32 v7, v95
    v_mov_b64 v[86:87], v[74:75]
    s_mov_b64 exec, -1
    s_or_b64 s[80:81], s[80:81], vcc
    v_cmpx_ne_u64 vcc, v[72:73], v[68:69]
    s_and_b64 s[82:83], vcc, s[80:81]
    s_cbranch_scc1 L2_c153
L2_d153:
    v_mov_b64 v[84:85], v[68:69]
    v_mov_b32 v7, v94
    v_mov_b64 v[86:87], v[72:73]
    s_mov_b64 exec, -1
    s_or_b64 s[80:81], s[80:81], vcc
    s_mov_b64 exec, s[80:81]
    ds_read_b64 v[68:69], v7 offset:65408
    v_mfma_f32_4x4x4_16b_bf16 v[76:79], v[12:13], v[84:85], 0
    s_nop 1
    v_mfma_f32_4x4x4_16b_bf16 v[76:79], v[10:11], v[86:87], v[76:79]
    s_waitcnt lgkmcnt(0)
    s_nop 0
    v_mfma_f32_4x4x4_16b_bf16 v[76:79], v[10:11], v[68:69], v[76:79]
    v_mov_b64 v[84:85], v[68:69]
    s_nop 3
    v_cvt_pk_bf16_f32 v76, v76, v77
    v_cvt_pk_bf16_f32 v77, v78, v79
    ds_wrxchg_rtn_b64 v[86:87], v7, v[76:77] offset:65408
    s_waitcnt lgkmcnt(0)
    v_cmp_ne_u64 s[80:81], v[86:87], v[84:85]
    s_mov_b64 exec, s[80:81]
    s_nop 1
    v_mfma_f32_4x4x4_16b_bf16 v[88:91], v[12:13], v[84:85], 0
    s_nop 1
    v_mfma_f32_4x4x4_16b_bf16 v[88:91], v[10:11], v[86:87], v[88:91]
    s_nop 4
    v_cvt_pk_bf16_f32 v88, v88, v89
    v_cvt_pk_bf16_f32 v89, v90, v91
    ds_pk_add_bf16 v7, v88 offset:65408
    ds_pk_add_bf16 v7, v89 offset:65412
    s_mov_b64 exec, -1
    s_load_dwordx2 s[4:5], s[0:1], 88
    v_add_u32 v123, 0x4000, v122
    s_lshl_b32 s50, s96, 16
    s_and_b32 s51, s96, 0xffff0000
    s_lshl_b32 s52, s97, 16
    s_and_b32 s53, s97, 0xffff0000
    s_lshl_b32 s54, s98, 16
    s_and_b32 s55, s98, 0xffff0000
    s_lshl_b32 s56, s99, 16
    s_and_b32 s57, s99, 0xffff0000
    s_waitcnt vmcnt(0) lgkmcnt(0)
    s_barrier
    s_add_u32 s8, s30, 0xec46000
    s_addc_u32 s9, s31, 0
    s_mov_b32 s10, 0x8000
    s_mov_b32 s11, 0x20000
    s_mov_b32 s12, s4
    s_mov_b32 s13, s5
    s_mov_b32 s14, 0x4e2000
    s_mov_b32 s15, 0x20000
    s_add_u32 s20, s30, 0xd845000
    s_addc_u32 s21, s31, 0
    s_mov_b32 s22, 0x1400000
    s_mov_b32 s23, 0x20000
    s_lshl2_add_u32 s4, s34, s33
    s_mul_i32 s4, s4, 81920
    s_add_u32 s3, s33, 1
    s_and_b32 s3, s3, 3
    s_mul_i32 s36, s3, 20000
    s_add_u32 s36, s36, 81920
    s_mul_i32 s40, s3, 20480
    s_add_u32 s40, s40, s4
    s_lshl2_add_u32 s3, s34, s3
    s_mul_i32 s3, s3, 81920
    s_mul_i32 s44, s33, 20480
    s_add_u32 s44, s44, s3
    s_add_u32 s3, s33, 2
    s_and_b32 s3, s3, 3
    s_mul_i32 s37, s3, 20000
    s_add_u32 s37, s37, 81920
    s_mul_i32 s41, s3, 20480
    s_add_u32 s41, s41, s4
    s_lshl2_add_u32 s3, s34, s3
    s_mul_i32 s3, s3, 81920
    s_mul_i32 s45, s33, 20480
    s_add_u32 s45, s45, s3
    s_add_u32 s3, s33, 3
    s_and_b32 s3, s3, 3
    s_mul_i32 s38, s3, 20000
    s_add_u32 s38, s38, 81920
    s_mul_i32 s42, s3, 20480
    s_add_u32 s42, s42, s4
    s_lshl2_add_u32 s3, s34, s3
    s_mul_i32 s3, s3, 81920
    s_mul_i32 s46, s33, 20480
    s_add_u32 s46, s46, s3
    v_add_u32 v104, s36, v122
    ds_read_b128 v[16:19], v104
    v_add_u32 v104, s37, v122
    ds_read_b128 v[20:23], v104
    v_add_u32 v104, s38, v122
    ds_read_b128 v[24:27], v104
    s_waitcnt lgkmcnt(2)
    buffer_store_dwordx4 v[16:19], v122, s[20:23], s40 offen sc1
    s_waitcnt lgkmcnt(1)
    buffer_store_dwordx4 v[20:23], v122, s[20:23], s41 offen sc1
    s_waitcnt lgkmcnt(0)
    buffer_store_dwordx4 v[24:27], v122, s[20:23], s42 offen sc1
    s_cmp_ge_u32 s32, 4
    s_cbranch_scc1 L2_g0
    v_add_u32 v104, s36, v123
    ds_read_b128 v[36:39], v104
    v_add_u32 v104, s37, v123
    ds_read_b128 v[40:43], v104
    v_add_u32 v104, s38, v123
    ds_read_b128 v[44:47], v104
    s_waitcnt lgkmcnt(2)
    buffer_store_dwordx4 v[36:39], v123, s[20:23], s40 offen sc1
    s_waitcnt lgkmcnt(1)
    buffer_store_dwordx4 v[40:43], v123, s[20:23], s41 offen sc1
    s_waitcnt lgkmcnt(0)
    buffer_store_dwordx4 v[44:47], v123, s[20:23], s42 offen sc1
L2_g0:
    v_lshlrev_b32 v80, 16, v116
    v_subrev_f32 v60, s50, v80
    v_subrev_f32 v61, s51, v80
    v_subrev_f32 v62, s52, v80
    v_subrev_f32 v63, s53, v80
    v_subrev_f32 v64, s54, v80
    v_subrev_f32 v65, s55, v80
    v_subrev_f32 v66, s56, v80
    v_subrev_f32 v67, s57, v80
    v_cvt_pk_bf16_f32 v68, v60, v61
    v_cvt_pk_bf16_f32 v69, v62, v63
    v_cvt_pk_bf16_f32 v70, v64, v65
    v_cvt_pk_bf16_f32 v71, v66, v67
    v_lshlrev_b32 v60, 16, v68
    v_and_b32 v61, 0xffff0000, v68
    v_lshlrev_b32 v62, 16, v69
    v_and_b32 v63, 0xffff0000, v69
    v_lshlrev_b32 v64, 16, v70
    v_and_b32 v65, 0xffff0000, v70
    v_lshlrev_b32 v66, 16, v71
    v_and_b32 v67, 0xffff0000, v71
    v_mul_f32 v60, v60, v60
    v_mul_f32 v61, v61, v61
    v_mul_f32 v62, v62, v62
    v_mul_f32 v63, v63, v63
    v_mul_f32 v64, v64, v64
    v_mul_f32 v65, v65, v65
    v_mul_f32 v66, v66, v66
    v_mul_f32 v67, v67, v67
    v_cvt_pk_bf16_f32 v68, v60, v61
    v_cvt_pk_bf16_f32 v69, v62, v63
    v_cvt_pk_bf16_f32 v70, v64, v65
    v_cvt_pk_bf16_f32 v71, v66, v67
    v_lshlrev_b32 v60, 16, v68
    v_and_b32 v61, 0xffff0000, v68
    v_lshlrev_b32 v62, 16, v69
    v_and_b32 v63, 0xffff0000, v69
    v_lshlrev_b32 v64, 16, v70
    v_and_b32 v65, 0xffff0000, v70
    v_lshlrev_b32 v66, 16, v71
    v_and_b32 v67, 0xffff0000, v71
    v_mul_f32 v60, 0xc1200000, v60
    v_mul_f32 v61, 0xc1200000, v61
    v_mul_f32 v62, 0xc1200000, v62
    v_mul_f32 v63, 0xc1200000, v63
    v_mul_f32 v64, 0xc1200000, v64
    v_mul_f32 v65, 0xc1200000, v65
    v_mul_f32 v66, 0xc1200000, v66
    v_mul_f32 v67, 0xc1200000, v67
    v_cvt_pk_bf16_f32 v68, v60, v61
    v_cvt_pk_bf16_f32 v69, v62, v63
    v_cvt_pk_bf16_f32 v70, v64, v65
    v_cvt_pk_bf16_f32 v71, v66, v67
    v_lshlrev_b32 v60, 16, v68
    v_and_b32 v61, 0xffff0000, v68
    v_lshlrev_b32 v62, 16, v69
    v_and_b32 v63, 0xffff0000, v69
    v_lshlrev_b32 v64, 16, v70
    v_and_b32 v65, 0xffff0000, v70
    v_lshlrev_b32 v66, 16, v71
    v_and_b32 v67, 0xffff0000, v71
    v_mul_f32 v60, 0x3fb8aa3b, v60
    v_mul_f32 v61, 0x3fb8aa3b, v61
    v_mul_f32 v62, 0x3fb8aa3b, v62
    v_mul_f32 v63, 0x3fb8aa3b, v63
    v_mul_f32 v64, 0x3fb8aa3b, v64
    v_mul_f32 v65, 0x3fb8aa3b, v65
    v_mul_f32 v66, 0x3fb8aa3b, v66
    v_mul_f32 v67, 0x3fb8aa3b, v67
    v_exp_f32 v60, v60
    v_exp_f32 v61, v61
    v_exp_f32 v62, v62
    v_exp_f32 v63, v63
    v_exp_f32 v64, v64
    v_exp_f32 v65, v65
    v_exp_f32 v66, v66
    v_exp_f32 v67, v67
    v_cvt_pk_bf16_f32 v72, v60, v61
    v_cvt_pk_bf16_f32 v73, v62, v63
    v_cvt_pk_bf16_f32 v74, v64, v65
    v_cvt_pk_bf16_f32 v75, v66, v67
    v_and_b32 v80, 0xffff0000, v116
    v_subrev_f32 v60, s50, v80
    v_subrev_f32 v61, s51, v80
    v_subrev_f32 v62, s52, v80
    v_subrev_f32 v63, s53, v80
    v_subrev_f32 v64, s54, v80
    v_subrev_f32 v65, s55, v80
    v_subrev_f32 v66, s56, v80
    v_subrev_f32 v67, s57, v80
    v_cvt_pk_bf16_f32 v68, v60, v61
    v_cvt_pk_bf16_f32 v69, v62, v63
    v_cvt_pk_bf16_f32 v70, v64, v65
    v_cvt_pk_bf16_f32 v71, v66, v67
    v_lshlrev_b32 v60, 16, v68
    v_and_b32 v61, 0xffff0000, v68
    v_lshlrev_b32 v62, 16, v69
    v_and_b32 v63, 0xffff0000, v69
    v_lshlrev_b32 v64, 16, v70
    v_and_b32 v65, 0xffff0000, v70
    v_lshlrev_b32 v66, 16, v71
    v_and_b32 v67, 0xffff0000, v71
    v_mul_f32 v60, v60, v60
    v_mul_f32 v61, v61, v61
    v_mul_f32 v62, v62, v62
    v_mul_f32 v63, v63, v63
    v_mul_f32 v64, v64, v64
    v_mul_f32 v65, v65, v65
    v_mul_f32 v66, v66, v66
    v_mul_f32 v67, v67, v67
    v_cvt_pk_bf16_f32 v68, v60, v61
    v_cvt_pk_bf16_f32 v69, v62, v63
    v_cvt_pk_bf16_f32 v70, v64, v65
    v_cvt_pk_bf16_f32 v71, v66, v67
    v_lshlrev_b32 v60, 16, v68
    v_and_b32 v61, 0xffff0000, v68
    v_lshlrev_b32 v62, 16, v69
    v_and_b32 v63, 0xffff0000, v69
    v_lshlrev_b32 v64, 16, v70
    v_and_b32 v65, 0xffff0000, v70
    v_lshlrev_b32 v66, 16, v71
    v_and_b32 v67, 0xffff0000, v71
    v_mul_f32 v60, 0xc1200000, v60
    v_mul_f32 v61, 0xc1200000, v61
    v_mul_f32 v62, 0xc1200000, v62
    v_mul_f32 v63, 0xc1200000, v63
    v_mul_f32 v64, 0xc1200000, v64
    v_mul_f32 v65, 0xc1200000, v65
    v_mul_f32 v66, 0xc1200000, v66
    v_mul_f32 v67, 0xc1200000, v67
    v_cvt_pk_bf16_f32 v68, v60, v61
    v_cvt_pk_bf16_f32 v69, v62, v63
    v_cvt_pk_bf16_f32 v70, v64, v65
    v_cvt_pk_bf16_f32 v71, v66, v67
    v_lshlrev_b32 v60, 16, v68
    v_and_b32 v61, 0xffff0000, v68
    v_lshlrev_b32 v62, 16, v69
    v_and_b32 v63, 0xffff0000, v69
    v_lshlrev_b32 v64, 16, v70
    v_and_b32 v65, 0xffff0000, v70
    v_lshlrev_b32 v66, 16, v71
    v_and_b32 v67, 0xffff0000, v71
    v_mul_f32 v60, 0x3fb8aa3b, v60
    v_mul_f32 v61, 0x3fb8aa3b, v61
    v_mul_f32 v62, 0x3fb8aa3b, v62
    v_mul_f32 v63, 0x3fb8aa3b, v63
    v_mul_f32 v64, 0x3fb8aa3b, v64
    v_mul_f32 v65, 0x3fb8aa3b, v65
    v_mul_f32 v66, 0x3fb8aa3b, v66
    v_mul_f32 v67, 0x3fb8aa3b, v67
    v_exp_f32 v60, v60
    v_exp_f32 v61, v61
    v_exp_f32 v62, v62
    v_exp_f32 v63, v63
    v_exp_f32 v64, v64
    v_exp_f32 v65, v65
    v_exp_f32 v66, v66
    v_exp_f32 v67, v67
    v_cvt_pk_bf16_f32 v76, v60, v61
    v_cvt_pk_bf16_f32 v77, v62, v63
    v_cvt_pk_bf16_f32 v78, v64, v65
    v_cvt_pk_bf16_f32 v79, v66, v67
    v_mfma_f32_4x4x4_16b_bf16 v[80:83], v[48:49], v[72:73], 0
    v_mfma_f32_4x4x4_16b_bf16 v[88:91], v[52:53], v[72:73], 0
    v_mfma_f32_4x4x4_16b_bf16 v[84:87], v[48:49], v[76:77], 0
    v_mfma_f32_4x4x4_16b_bf16 v[92:95], v[52:53], v[76:77], 0
    v_mfma_f32_4x4x4_16b_bf16 v[80:83], v[50:51], v[74:75], v[80:83]
    v_mfma_f32_4x4x4_16b_bf16 v[88:91], v[54:55], v[74:75], v[88:91]
    v_mfma_f32_4x4x4_16b_bf16 v[84:87], v[50:51], v[78:79], v[84:87]
    v_mfma_f32_4x4x4_16b_bf16 v[92:95], v[54:55], v[78:79], v[92:95]
    s_lshl_b32 s3, s34, 9
    s_lshl_b32 s4, s33, 7
    s_add_u32 s4, s4, s3
    v_mov_b32 v104, 1
    v_and_b32 v105, 0x3f0, v122
    v_lshlrev_b32 v105, 3, v105
    v_add_u32 v106, 81920, v118
    ds_read_b128 v[32:35], v106
    v_add_u32 v106, 81920, v119
    ds_read_b128 v[60:63], v106
    s_waitcnt vmcnt(0)
    s_barrier
    s_cmp_lg_u32 s32, 0
    s_cbranch_scc1 L2_f2
    s_mov_b64 exec, 1
    buffer_store_dword v104, off, s[8:11], s4 sc1
    s_mov_b64 exec, 15
    s_bitset0_b64 exec, s33
L2_f3:
    buffer_load_dword v104, v105, s[8:11], s3 offen sc1
    s_waitcnt vmcnt(0)
    v_cmp_ne_u32 vcc, 1, v104
    s_cbranch_vccnz L2_f3s
    s_mov_b64 exec, -1
L2_f2:
    s_barrier
    buffer_load_dwordx4 v[36:39], v122, s[20:23], s44 offen sc1
    buffer_load_dwordx4 v[40:43], v122, s[20:23], s45 offen sc1
    buffer_load_dwordx4 v[44:47], v122, s[20:23], s46 offen sc1
    s_cmp_ge_u32 s32, 4
    s_cbranch_scc1 L2_f5
    buffer_load_dwordx4 v[64:67], v123, s[20:23], s44 offen sc1
    buffer_load_dwordx4 v[68:71], v123, s[20:23], s45 offen sc1
    buffer_load_dwordx4 v[72:75], v123, s[20:23], s46 offen sc1
    v_lshlrev_b32 v16, 16, v117
    v_subrev_f32 v96, s50, v16
    v_subrev_f32 v97, s51, v16
    v_subrev_f32 v98, s52, v16
    v_subrev_f32 v99, s53, v16
    v_subrev_f32 v100, s54, v16
    v_subrev_f32 v101, s55, v16
    v_subrev_f32 v102, s56, v16
    v_subrev_f32 v103, s57, v16
    v_cvt_pk_bf16_f32 v0, v96, v97
    v_cvt_pk_bf16_f32 v1, v98, v99
    v_cvt_pk_bf16_f32 v2, v100, v101
    v_cvt_pk_bf16_f32 v3, v102, v103
    v_lshlrev_b32 v96, 16, v0
    v_and_b32 v97, 0xffff0000, v0
    v_lshlrev_b32 v98, 16, v1
    v_and_b32 v99, 0xffff0000, v1
    v_lshlrev_b32 v100, 16, v2
    v_and_b32 v101, 0xffff0000, v2
    v_lshlrev_b32 v102, 16, v3
    v_and_b32 v103, 0xffff0000, v3
    v_mul_f32 v96, v96, v96
    v_mul_f32 v97, v97, v97
    v_mul_f32 v98, v98, v98
    v_mul_f32 v99, v99, v99
    v_mul_f32 v100, v100, v100
    v_mul_f32 v101, v101, v101
    v_mul_f32 v102, v102, v102
    v_mul_f32 v103, v103, v103
    v_cvt_pk_bf16_f32 v0, v96, v97
    v_cvt_pk_bf16_f32 v1, v98, v99
    v_cvt_pk_bf16_f32 v2, v100, v101
    v_cvt_pk_bf16_f32 v3, v102, v103
    v_lshlrev_b32 v96, 16, v0
    v_and_b32 v97, 0xffff0000, v0
    v_lshlrev_b32 v98, 16, v1
    v_and_b32 v99, 0xffff0000, v1
    v_lshlrev_b32 v100, 16, v2
    v_and_b32 v101, 0xffff0000, v2
    v_lshlrev_b32 v102, 16, v3
    v_and_b32 v103, 0xffff0000, v3
    v_mul_f32 v96, 0xc1200000, v96
    v_mul_f32 v97, 0xc1200000, v97
    v_mul_f32 v98, 0xc1200000, v98
    v_mul_f32 v99, 0xc1200000, v99
    v_mul_f32 v100, 0xc1200000, v100
    v_mul_f32 v101, 0xc1200000, v101
    v_mul_f32 v102, 0xc1200000, v102
    v_mul_f32 v103, 0xc1200000, v103
    v_cvt_pk_bf16_f32 v0, v96, v97
    v_cvt_pk_bf16_f32 v1, v98, v99
    v_cvt_pk_bf16_f32 v2, v100, v101
    v_cvt_pk_bf16_f32 v3, v102, v103
    v_lshlrev_b32 v96, 16, v0
    v_and_b32 v97, 0xffff0000, v0
    v_lshlrev_b32 v98, 16, v1
    v_and_b32 v99, 0xffff0000, v1
    v_lshlrev_b32 v100, 16, v2
    v_and_b32 v101, 0xffff0000, v2
    v_lshlrev_b32 v102, 16, v3
    v_and_b32 v103, 0xffff0000, v3
    v_mul_f32 v96, 0x3fb8aa3b, v96
    v_mul_f32 v97, 0x3fb8aa3b, v97
    v_mul_f32 v98, 0x3fb8aa3b, v98
    v_mul_f32 v99, 0x3fb8aa3b, v99
    v_mul_f32 v100, 0x3fb8aa3b, v100
    v_mul_f32 v101, 0x3fb8aa3b, v101
    v_mul_f32 v102, 0x3fb8aa3b, v102
    v_mul_f32 v103, 0x3fb8aa3b, v103
    v_exp_f32 v96, v96
    v_exp_f32 v97, v97
    v_exp_f32 v98, v98
    v_exp_f32 v99, v99
    v_exp_f32 v100, v100
    v_exp_f32 v101, v101
    v_exp_f32 v102, v102
    v_exp_f32 v103, v103
    v_cvt_pk_bf16_f32 v104, v96, v97
    v_cvt_pk_bf16_f32 v105, v98, v99
    v_cvt_pk_bf16_f32 v106, v100, v101
    v_cvt_pk_bf16_f32 v107, v102, v103
    v_and_b32 v16, 0xffff0000, v117
    v_subrev_f32 v96, s50, v16
    v_subrev_f32 v97, s51, v16
    v_subrev_f32 v98, s52, v16
    v_subrev_f32 v99, s53, v16
    v_subrev_f32 v100, s54, v16
    v_subrev_f32 v101, s55, v16
    v_subrev_f32 v102, s56, v16
    v_subrev_f32 v103, s57, v16
    v_cvt_pk_bf16_f32 v0, v96, v97
    v_cvt_pk_bf16_f32 v1, v98, v99
    v_cvt_pk_bf16_f32 v2, v100, v101
    v_cvt_pk_bf16_f32 v3, v102, v103
    v_lshlrev_b32 v96, 16, v0
    v_and_b32 v97, 0xffff0000, v0
    v_lshlrev_b32 v98, 16, v1
    v_and_b32 v99, 0xffff0000, v1
    v_lshlrev_b32 v100, 16, v2
    v_and_b32 v101, 0xffff0000, v2
    v_lshlrev_b32 v102, 16, v3
    v_and_b32 v103, 0xffff0000, v3
    v_mul_f32 v96, v96, v96
    v_mul_f32 v97, v97, v97
    v_mul_f32 v98, v98, v98
    v_mul_f32 v99, v99, v99
    v_mul_f32 v100, v100, v100
    v_mul_f32 v101, v101, v101
    v_mul_f32 v102, v102, v102
    v_mul_f32 v103, v103, v103
    v_cvt_pk_bf16_f32 v0, v96, v97
    v_cvt_pk_bf16_f32 v1, v98, v99
    v_cvt_pk_bf16_f32 v2, v100, v101
    v_cvt_pk_bf16_f32 v3, v102, v103
    v_lshlrev_b32 v96, 16, v0
    v_and_b32 v97, 0xffff0000, v0
    v_lshlrev_b32 v98, 16, v1
    v_and_b32 v99, 0xffff0000, v1
    v_lshlrev_b32 v100, 16, v2
    v_and_b32 v101, 0xffff0000, v2
    v_lshlrev_b32 v102, 16, v3
    v_and_b32 v103, 0xffff0000, v3
    v_mul_f32 v96, 0xc1200000, v96
    v_mul_f32 v97, 0xc1200000, v97
    v_mul_f32 v98, 0xc1200000, v98
    v_mul_f32 v99, 0xc1200000, v99
    v_mul_f32 v100, 0xc1200000, v100
    v_mul_f32 v101, 0xc1200000, v101
    v_mul_f32 v102, 0xc1200000, v102
    v_mul_f32 v103, 0xc1200000, v103
    v_cvt_pk_bf16_f32 v0, v96, v97
    v_cvt_pk_bf16_f32 v1, v98, v99
    v_cvt_pk_bf16_f32 v2, v100, v101
    v_cvt_pk_bf16_f32 v3, v102, v103
    v_lshlrev_b32 v96, 16, v0
    v_and_b32 v97, 0xffff0000, v0
    v_lshlrev_b32 v98, 16, v1
    v_and_b32 v99, 0xffff0000, v1
    v_lshlrev_b32 v100, 16, v2
    v_and_b32 v101, 0xffff0000, v2
    v_lshlrev_b32 v102, 16, v3
    v_and_b32 v103, 0xffff0000, v3
    v_mul_f32 v96, 0x3fb8aa3b, v96
    v_mul_f32 v97, 0x3fb8aa3b, v97
    v_mul_f32 v98, 0x3fb8aa3b, v98
    v_mul_f32 v99, 0x3fb8aa3b, v99
    v_mul_f32 v100, 0x3fb8aa3b, v100
    v_mul_f32 v101, 0x3fb8aa3b, v101
    v_mul_f32 v102, 0x3fb8aa3b, v102
    v_mul_f32 v103, 0x3fb8aa3b, v103
    v_exp_f32 v96, v96
    v_exp_f32 v97, v97
    v_exp_f32 v98, v98
    v_exp_f32 v99, v99
    v_exp_f32 v100, v100
    v_exp_f32 v101, v101
    v_exp_f32 v102, v102
    v_exp_f32 v103, v103
    v_cvt_pk_bf16_f32 v76, v96, v97
    v_cvt_pk_bf16_f32 v77, v98, v99
    v_cvt_pk_bf16_f32 v78, v100, v101
    v_cvt_pk_bf16_f32 v79, v102, v103
    v_mfma_f32_4x4x4_16b_bf16 v[16:19], v[48:49], v[104:105], 0
    v_mfma_f32_4x4x4_16b_bf16 v[24:27], v[52:53], v[104:105], 0
    v_mfma_f32_4x4x4_16b_bf16 v[20:23], v[48:49], v[76:77], 0
    v_mfma_f32_4x4x4_16b_bf16 v[28:31], v[52:53], v[76:77], 0
    v_mfma_f32_4x4x4_16b_bf16 v[16:19], v[50:51], v[106:107], v[16:19]
    v_mfma_f32_4x4x4_16b_bf16 v[24:27], v[54:55], v[106:107], v[24:27]
    v_mfma_f32_4x4x4_16b_bf16 v[20:23], v[50:51], v[78:79], v[20:23]
    v_mfma_f32_4x4x4_16b_bf16 v[28:31], v[54:55], v[78:79], v[28:31]
L2_f5:
    s_waitcnt vmcnt(0) lgkmcnt(0)
    v_mfma_f32_4x4x4_16b_bf16 v[96:99], v[10:11], v[32:33], 0
    v_mfma_f32_4x4x4_16b_bf16 v[100:103], v[10:11], v[34:35], 0
    s_nop 0
    v_mfma_f32_4x4x4_16b_bf16 v[96:99], v[10:11], v[36:37], v[96:99]
    v_mfma_f32_4x4x4_16b_bf16 v[100:103], v[10:11], v[38:39], v[100:103]
    s_nop 0
    v_mfma_f32_4x4x4_16b_bf16 v[96:99], v[10:11], v[40:41], v[96:99]
    v_mfma_f32_4x4x4_16b_bf16 v[100:103], v[10:11], v[42:43], v[100:103]
    s_nop 0
    v_mfma_f32_4x4x4_16b_bf16 v[96:99], v[10:11], v[44:45], v[96:99]
    v_mfma_f32_4x4x4_16b_bf16 v[100:103], v[10:11], v[46:47], v[100:103]
    s_nop 3
    v_mul_f32 v96, v96, v80
    v_mul_f32 v97, v97, v81
    v_mul_f32 v98, v98, v82
    v_mul_f32 v99, v99, v83
    v_cvt_pk_bf16_f32 v32, v96, v97
    v_cvt_pk_bf16_f32 v33, v98, v99
    v_mul_f32 v100, v100, v84
    v_mul_f32 v101, v101, v85
    v_mul_f32 v102, v102, v86
    v_mul_f32 v103, v103, v87
    v_cvt_pk_bf16_f32 v34, v100, v101
    v_cvt_pk_bf16_f32 v35, v102, v103
    v_mfma_f32_4x4x4_16b_bf16 v[80:83], v[56:57], v[32:33], 0
    s_nop 0
    v_mfma_f32_4x4x4_16b_bf16 v[84:87], v[56:57], v[34:35], 0
    s_nop 2
    v_mul_f32 v80, v80, v88
    v_mul_f32 v81, v81, v89
    v_mul_f32 v82, v82, v90
    v_mul_f32 v83, v83, v91
    v_mul_f32 v84, v84, v92
    v_mul_f32 v85, v85, v93
    v_mul_f32 v86, v86, v94
    v_mul_f32 v87, v87, v95
    v_mfma_f32_4x4x4_16b_bf16 v[96:99], v[10:11], v[108:109], v[80:83]
    s_nop 0
    v_mfma_f32_4x4x4_16b_bf16 v[100:103], v[10:11], v[110:111], v[84:87]
    s_nop 2
    v_cvt_pk_bf16_f32 v36, v96, v97
    v_cvt_pk_bf16_f32 v37, v98, v99
    v_cvt_pk_bf16_f32 v38, v100, v101
    v_cvt_pk_bf16_f32 v39, v102, v103
    buffer_store_dwordx4 v[36:39], v120, s[12:15], 0 offen nt
    s_cmp_ge_u32 s32, 4
    s_cbranch_scc1 L2_f6
    v_mfma_f32_4x4x4_16b_bf16 v[96:99], v[10:11], v[60:61], 0
    v_mfma_f32_4x4x4_16b_bf16 v[100:103], v[10:11], v[62:63], 0
    s_nop 0
    v_mfma_f32_4x4x4_16b_bf16 v[96:99], v[10:11], v[64:65], v[96:99]
    v_mfma_f32_4x4x4_16b_bf16 v[100:103], v[10:11], v[66:67], v[100:103]
    s_nop 0
    v_mfma_f32_4x4x4_16b_bf16 v[96:99], v[10:11], v[68:69], v[96:99]
    v_mfma_f32_4x4x4_16b_bf16 v[100:103], v[10:11], v[70:71], v[100:103]
    s_nop 0
    v_mfma_f32_4x4x4_16b_bf16 v[96:99], v[10:11], v[72:73], v[96:99]
    v_mfma_f32_4x4x4_16b_bf16 v[100:103], v[10:11], v[74:75], v[100:103]
    s_nop 3
    v_mul_f32 v96, v96, v16
    v_mul_f32 v97, v97, v17
    v_mul_f32 v98, v98, v18
    v_mul_f32 v99, v99, v19
    v_cvt_pk_bf16_f32 v60, v96, v97
    v_cvt_pk_bf16_f32 v61, v98, v99
    v_mul_f32 v100, v100, v20
    v_mul_f32 v101, v101, v21
    v_mul_f32 v102, v102, v22
    v_mul_f32 v103, v103, v23
    v_cvt_pk_bf16_f32 v62, v100, v101
    v_cvt_pk_bf16_f32 v63, v102, v103
    v_mfma_f32_4x4x4_16b_bf16 v[16:19], v[56:57], v[60:61], 0
    s_nop 0
    v_mfma_f32_4x4x4_16b_bf16 v[20:23], v[56:57], v[62:63], 0
    s_nop 2
    v_mul_f32 v16, v16, v24
    v_mul_f32 v17, v17, v25
    v_mul_f32 v18, v18, v26
    v_mul_f32 v19, v19, v27
    v_mul_f32 v20, v20, v28
    v_mul_f32 v21, v21, v29
    v_mul_f32 v22, v22, v30
    v_mul_f32 v23, v23, v31
    v_mfma_f32_4x4x4_16b_bf16 v[96:99], v[10:11], v[112:113], v[16:19]
    s_nop 0
    v_mfma_f32_4x4x4_16b_bf16 v[100:103], v[10:11], v[114:115], v[20:23]
    s_nop 2
    v_cvt_pk_bf16_f32 v64, v96, v97
    v_cvt_pk_bf16_f32 v65, v98, v99
    v_cvt_pk_bf16_f32 v66, v100, v101
    v_cvt_pk_bf16_f32 v67, v102, v103
    buffer_store_dwordx4 v[64:67], v121, s[12:15], 0 offen nt
L2_f6:
L2_end:
    s_endpgm
L2_slow:
    s_lshr_b32 s35, s42, 2
    s_lshl_b32 s50, s32, 4
    s_and_b32 s3, s42, 3
    s_lshl_b32 s53, s3, 3
    s_add_u32 s53, s53, s39
    s_and_b32 s3, s35, 2
    s_lshl_b32 s3, s3, 1
    s_add_u32 s53, s53, s3
    s_and_b32 s54, s35, 1
    s_lshl_b32 s54, s54, 4
L2_sl_seg:
    s_mul_i32 s55, s50, 173056
    s_and_b32 s3, s50, 3
    s_lshl_b32 s3, s3, 5
    s_add_u32 s3, s3, s55
    s_add_u32 s3, s3, s53
    buffer_load_dword v104, off, s[12:15], s3 sc1
    buffer_load_dword v105, off, s[12:15], s3 offset:32 sc1
    s_waitcnt vmcnt(0)
    v_readfirstlane_b32 s51, v104
    v_readfirstlane_b32 s52, v105
    s_lshr_b32 s51, s51, s54
    s_and_b32 s51, s51, 0xffff
    s_lshr_b32 s52, s52, s54
    s_and_b32 s52, s52, 0xffff
L2_sl_rec:
    s_cmp_ge_u32 s51, s52
    s_cbranch_scc1 L2_sl_next
    v_mbcnt_lo_u32_b32 v102, -1, 0
    v_mbcnt_hi_u32_b32 v102, -1, v102
    v_add_u32 v102, s51, v102
    v_and_b32 v103, -4, v102
    v_lshl_add_u32 v104, v102, 2, v103
    v_lshl_add_u32 v105, v103, 2, v102
    v_cmp_gt_u32 vcc, s52, v102
    s_mov_b64 exec, vcc
    buffer_load_dword v106, v104, s[8:11], s55 offen
    buffer_load_ubyte v107, v105, s[8:11], s55 offen offset:16
    s_waitcnt vmcnt(0)
    v_lshrrev_b32 v98, 14, v106
    v_and_b32 v98, v5, v98
    ds_read_b64 v[100:101], v98
    v_perm_b32 v97, v106, v107, s44
    v_and_b32 v96, v5, v106
    v_bitop3_b32 v103, v106, 0.5, -0.5 bitop3:0xa8
    v_bitop3_b32 v97, v6, v97, v103 bitop3:0xca
    s_waitcnt lgkmcnt(0)
    v_mfma_f32_4x4x4_16b_bf16 v[88:91], v[8:9], v[100:101], 0
    s_nop 4
    v_mul_f32 v88, v97, v88
    v_mul_f32 v89, v97, v89
    v_mul_f32 v90, v97, v90
    v_mul_f32 v91, v97, v91
    v_cvt_pk_bf16_f32 v88, v88, v89
    v_cvt_pk_bf16_f32 v89, v90, v91
    ds_pk_add_bf16 v96, v88 offset:65408
    ds_pk_add_bf16 v96, v89 offset:65412
    s_mov_b64 exec, -1
    s_add_u32 s51, s51, 64
    s_branch L2_sl_rec
L2_sl_next:
    s_add_u32 s50, s50, 1
    s_and_b32 s3, s50, 15
    s_cbranch_scc1 L2_sl_seg
    s_add_u32 s50, s50, 240
    s_cmp_lt_u32 s50, 1280
    s_cbranch_scc1 L2_sl_seg
    s_waitcnt lgkmcnt(0)
    s_cmp_eq_u32 s42, 0
    s_cbranch_scc1 L2_ret0
    s_cmp_eq_u32 s42, 1
    s_cbranch_scc1 L2_ret1
    s_cmp_eq_u32 s42, 14
    s_cbranch_scc1 L2_ret6
    s_cmp_eq_u32 s42, 15
    s_cbranch_scc1 L2_ret7
    s_and_b32 s3, s42, 3
    s_cmp_eq_u32 s3, 2
    s_cbranch_scc1 L2_ret2
    s_cmp_eq_u32 s3, 3
    s_cbranch_scc1 L2_ret3
    s_cmp_eq_u32 s3, 0
    s_cbranch_scc1 L2_ret4
    s_branch L2_ret5
L2_p1s:
    s_sleep 32
    s_branch L2_p1
L2_xo3:
    v_cmp_lt_u32 vcc, 20, v99
    s_mov_b32 s101, 1
    s_cbranch_vccz L2_xp3
    v_cmp_lt_u32 vcc, 32, v99
    v_cmp_lt_u32 s[58:59], 31, v88
    s_mov_b32 s101, 2
    s_or_b64 vcc, vcc, s[58:59]
    s_cbranch_scc0 L2_xp3
    s_mov_b32 s37, 0x10000
    s_branch L2_xp3
L2_xa4:
    s_cmp_eq_u32 s101, 1
    s_cbranch_scc1 L2_xc4
    v_lshlrev_b32 v89, 0, v96
    v_add_u32 v90, 140, v97
    v_bitop3_b32 v90, v89, v45, v90 bitop3:0x6a
    ds_write_b32 v98, v90 offset:28
    v_lshlrev_b32 v89, 4, v96
    v_add_u32 v90, 120, v97
    v_bitop3_b32 v90, v89, v45, v90 bitop3:0x6a
    ds_write_b32 v98, v90 offset:24
    v_lshlrev_b32 v89, 8, v96
    v_add_u32 v90, 100, v97
    v_bitop3_b32 v90, v89, v45, v90 bitop3:0x6a
    ds_write_b32 v98, v90 offset:20
L2_xc4:
    v_lshlrev_b32 v89, 12, v96
    v_add_u32 v90, 80, v97
    v_bitop3_b32 v90, v89, v45, v90 bitop3:0x6a
    ds_write_b32 v98, v90 offset:16
    s_branch L2_xb4
L2_xe4:
    v_cmp_lt_u32 vcc, 32, v99
    v_cmp_lt_u32 s[58:59], 31, v88
    v_lshrrev_b32 v89, 16, v96
    v_add_u32 v97, 80, v97
    s_or_b64 vcc, vcc, s[58:59]
    s_cbranch_scc1 L2_xs4
    v_lshlrev_b32 v89, v1, v89
    v_and_b32 v89, v45, v89
    v_cmp_ne_u32 vcc, 0, v89
    v_xor_b32 v90, v97, v89
    s_add_u32 s3, s37, s38
    v_mbcnt_lo_u32_b32 v98, vcc_lo, 0
    v_mbcnt_hi_u32_b32 v98, vcc_hi, v98
    s_bcnt1_i32_b64 s41, vcc
    v_lshl_add_u32 v98, v98, 2, s3
    s_mov_b64 exec, vcc
    ds_write_b32 v98, v90
    s_mov_b64 exec, -1
    s_lshl2_add_u32 s37, s41, s37
    s_branch L2_xr4
L2_xf4:
    s_waitcnt lgkmcnt(0)
    s_cmp_gt_u32 s37, 1024
    s_cbranch_scc1 L2_xs4
    s_cmp_lt_u32 s37, 768
    s_cbranch_scc1 L2_xl4
    ds_read_b32 v32, v98 offset:896
    s_add_u32 s3, s42, 0
    s_bitset1_b32 s43, s3
    s_branch L2_xg4
L2_xl4:
    v_mov_b32 v42, -1
    s_cmp_ge_u32 s37, 512
    s_cbranch_scc1 L2_xg4
    v_mov_b32 v43, -1
    s_cmp_ge_u32 s37, 256
    s_cbranch_scc1 L2_xg4
    v_mov_b32 v41, -1
    s_branch L2_xg4
L2_xs4:
    s_waitcnt lgkmcnt(0)
    v_mov_b32 v40, -1
    v_mov_b32 v41, -1
    v_mov_b32 v43, -1
    v_mov_b32 v42, -1
    s_add_u32 s3, s42, 0
    s_bitset1_b32 s36, s3
    s_branch L2_xg4
L2_xo5:
    v_cmp_lt_u32 vcc, 20, v99
    s_mov_b32 s101, 1
    s_cbranch_vccz L2_xp5
    v_cmp_lt_u32 vcc, 32, v99
    v_cmp_lt_u32 s[58:59], 31, v88
    s_mov_b32 s101, 2
    s_or_b64 vcc, vcc, s[58:59]
    s_cbranch_scc0 L2_xp5
    s_mov_b32 s37, 0x10000
    s_branch L2_xp5
L2_xa6:
    s_cmp_eq_u32 s101, 1
    s_cbranch_scc1 L2_xc6
    v_lshlrev_b32 v89, 0, v96
    v_add_u32 v90, 140, v97
    v_bitop3_b32 v90, v89, v45, v90 bitop3:0x6a
    ds_write_b32 v98, v90 offset:28
    v_lshlrev_b32 v89, 4, v96
    v_add_u32 v90, 120, v97
    v_bitop3_b32 v90, v89, v45, v90 bitop3:0x6a
    ds_write_b32 v98, v90 offset:24
    v_lshlrev_b32 v89, 8, v96
    v_add_u32 v90, 100, v97
    v_bitop3_b32 v90, v89, v45, v90 bitop3:0x6a
    ds_write_b32 v98, v90 offset:20
L2_xc6:
    v_lshlrev_b32 v89, 12, v96
    v_add_u32 v90, 80, v97
    v_bitop3_b32 v90, v89, v45, v90 bitop3:0x6a
    ds_write_b32 v98, v90 offset:16
    s_branch L2_xb6
L2_xe6:
    v_cmp_lt_u32 vcc, 32, v99
    v_cmp_lt_u32 s[58:59], 31, v88
    v_lshrrev_b32 v89, 16, v96
    v_add_u32 v97, 80, v97
    s_or_b64 vcc, vcc, s[58:59]
    s_cbranch_scc1 L2_xs6
    v_lshlrev_b32 v89, v1, v89
    v_and_b32 v89, v45, v89
    v_cmp_ne_u32 vcc, 0, v89
    v_xor_b32 v90, v97, v89
    s_add_u32 s3, s37, s38
    v_mbcnt_lo_u32_b32 v98, vcc_lo, 0
    v_mbcnt_hi_u32_b32 v98, vcc_hi, v98
    s_bcnt1_i32_b64 s41, vcc
    v_lshl_add_u32 v98, v98, 2, s3
    s_mov_b64 exec, vcc
    ds_write_b32 v98, v90
    s_mov_b64 exec, -1
    s_lshl2_add_u32 s37, s41, s37
    s_branch L2_xr6
L2_xf6:
    s_waitcnt lgkmcnt(0)
    s_cmp_gt_u32 s37, 1024
    s_cbranch_scc1 L2_xs6
    s_cmp_lt_u32 s37, 768
    s_cbranch_scc1 L2_xl6
    ds_read_b32 v33, v98 offset:896
    s_add_u32 s3, s42, 1
    s_bitset1_b32 s43, s3
    s_branch L2_xg6
L2_xl6:
    v_mov_b32 v42, -1
    s_cmp_ge_u32 s37, 512
    s_cbranch_scc1 L2_xg6
    v_mov_b32 v43, -1
    s_cmp_ge_u32 s37, 256
    s_cbranch_scc1 L2_xg6
    v_mov_b32 v41, -1
    s_branch L2_xg6
L2_xs6:
    s_waitcnt lgkmcnt(0)
    v_mov_b32 v40, -1
    v_mov_b32 v41, -1
    v_mov_b32 v43, -1
    v_mov_b32 v42, -1
    s_add_u32 s3, s42, 1
    s_bitset1_b32 s36, s3
    s_branch L2_xg6
L2_p2s:
    s_sleep 8
    s_branch L2_p2
L2_oa7:
    v_and_b32 v47, 0x0fffffff, v32
    buffer_load_dword v78, v47, s[8:11], 0 offen offset:16
    s_mov_b64 exec, s[6:7]
    v_add_u32 v47, 8, v47
    v_lshrrev_b32 v32, 2, v32
    s_mov_b64 exec, -1
    buffer_load_dwordx2 v[76:77], v47, s[8:11], 0 offen
    s_branch L2_ob7
L2_oa8:
    s_waitcnt vmcnt(0)
    s_mov_b64 exec, s[6:7]
    v_lshrrev_b32 v78, 16, v78
    s_mov_b64 exec, -1
    v_and_b32 v46, 0x10000000, v32
    v_cmpx_eq_u32 vcc, 0, v46
    v_lshrrev_b32 v47, 14, v76
    v_and_b32 v47, v5, v47
    ds_read_b64 v[96:97], v47
    v_perm_b32 v98, v76, v78, s44
    v_bitop3_b32 v99, v76, 0.5, -0.5 bitop3:0xa8
    v_bitop3_b32 v98, v6, v98, v99 bitop3:0xca
    v_and_b32 v47, v5, v76
    s_waitcnt lgkmcnt(0)
    v_mfma_f32_4x4x4_16b_bf16 v[88:91], v[8:9], v[96:97], 0
    s_nop 4
    v_mul_f32 v88, v98, v88
    v_mul_f32 v89, v98, v89
    v_mul_f32 v90, v98, v90
    v_mul_f32 v91, v98, v91
    v_cvt_pk_bf16_f32 v88, v88, v89
    v_cvt_pk_bf16_f32 v89, v90, v91
    ds_pk_add_bf16 v47, v88 offset:65408
    ds_pk_add_bf16 v47, v89 offset:65412
    s_mov_b64 exec, -1
    v_and_b32 v46, 0x20000000, v32
    v_cmpx_eq_u32 vcc, 0, v46
    v_lshrrev_b32 v47, 14, v77
    v_and_b32 v47, v5, v47
    ds_read_b64 v[96:97], v47
    v_perm_b32 v98, v77, v78, s45
    v_bitop3_b32 v99, v77, 0.5, -0.5 bitop3:0xa8
    v_bitop3_b32 v98, v6, v98, v99 bitop3:0xca
    v_and_b32 v47, v5, v77
    s_waitcnt lgkmcnt(0)
    v_mfma_f32_4x4x4_16b_bf16 v[88:91], v[8:9], v[96:97], 0
    s_nop 4
    v_mul_f32 v88, v98, v88
    v_mul_f32 v89, v98, v89
    v_mul_f32 v90, v98, v90
    v_mul_f32 v91, v98, v91
    v_cvt_pk_bf16_f32 v88, v88, v89
    v_cvt_pk_bf16_f32 v89, v90, v91
    ds_pk_add_bf16 v47, v88 offset:65408
    ds_pk_add_bf16 v47, v89 offset:65412
    s_mov_b64 exec, -1
    s_branch L2_ob8
L2_c9:
    s_lshl_b64 s[52:53], s[82:83], 1
    s_andn2_b64 s[52:53], s[52:53], s[80:81]
    s_andn2_b64 s[52:53], s[52:53], s[54:55]
    s_or_b64 s[80:81], s[80:81], s[52:53]
    s_not_b64 vcc, s[52:53]
    s_mov_b64 exec, -1
    v_cndmask_b32_dpp v84, v84, v84, vcc wave_shr:1 row_mask:0xf bank_mask:0xf
    v_cndmask_b32_dpp v85, v85, v85, vcc wave_shr:1 row_mask:0xf bank_mask:0xf
    s_lshr_b64 s[52:53], s[52:53], 1
    v_cndmask_b32_dpp v86, v86, v86, vcc wave_shr:1 row_mask:0xf bank_mask:0xf
    v_cndmask_b32_dpp v87, v87, v87, vcc wave_shr:1 row_mask:0xf bank_mask:0xf
    s_andn2_b64 s[82:83], s[82:83], s[52:53]
    v_cndmask_b32_dpp v7, v7, v7, vcc wave_shr:1 row_mask:0xf bank_mask:0xf
    s_mov_b64 exec, s[54:55]
    s_cbranch_scc0 L2_d9
    s_mov_b64 exec, s[82:83]
    s_nop 1
    v_mfma_f32_4x4x4_16b_bf16 v[88:91], v[12:13], v[84:85], 0
    s_nop 1
    v_mfma_f32_4x4x4_16b_bf16 v[88:91], v[10:11], v[86:87], v[88:91]
    s_nop 4
    v_cvt_pk_bf16_f32 v88, v88, v89
    v_cvt_pk_bf16_f32 v89, v90, v91
    ds_pk_add_bf16 v7, v88 offset:65408
    ds_pk_add_bf16 v7, v89 offset:65412
    s_mov_b64 exec, s[54:55]
    s_branch L2_d9
L2_c10:
    s_lshl_b64 s[52:53], s[82:83], 1
    s_andn2_b64 s[52:53], s[52:53], s[80:81]
    s_andn2_b64 s[52:53], s[52:53], s[50:51]
    s_or_b64 s[80:81], s[80:81], s[52:53]
    s_not_b64 vcc, s[52:53]
    s_mov_b64 exec, -1
    v_cndmask_b32_dpp v84, v84, v84, vcc wave_shr:1 row_mask:0xf bank_mask:0xf
    v_cndmask_b32_dpp v85, v85, v85, vcc wave_shr:1 row_mask:0xf bank_mask:0xf
    s_lshr_b64 s[52:53], s[52:53], 1
    v_cndmask_b32_dpp v86, v86, v86, vcc wave_shr:1 row_mask:0xf bank_mask:0xf
    v_cndmask_b32_dpp v87, v87, v87, vcc wave_shr:1 row_mask:0xf bank_mask:0xf
    s_andn2_b64 s[82:83], s[82:83], s[52:53]
    v_cndmask_b32_dpp v7, v7, v7, vcc wave_shr:1 row_mask:0xf bank_mask:0xf
    s_mov_b64 exec, s[50:51]
    s_cbranch_scc0 L2_d10
    s_mov_b64 exec, s[82:83]
    s_nop 1
    v_mfma_f32_4x4x4_16b_bf16 v[88:91], v[12:13], v[84:85], 0
    s_nop 1
    v_mfma_f32_4x4x4_16b_bf16 v[88:91], v[10:11], v[86:87], v[88:91]
    s_nop 4
    v_cvt_pk_bf16_f32 v88, v88, v89
    v_cvt_pk_bf16_f32 v89, v90, v91
    ds_pk_add_bf16 v7, v88 offset:65408
    ds_pk_add_bf16 v7, v89 offset:65412
    s_mov_b64 exec, s[50:51]
    s_branch L2_d10
L2_c13:
    s_lshl_b64 s[52:53], s[82:83], 1
    s_andn2_b64 s[52:53], s[52:53], s[80:81]
    s_andn2_b64 s[52:53], s[52:53], s[54:55]
    s_or_b64 s[80:81], s[80:81], s[52:53]
    s_not_b64 vcc, s[52:53]
    s_mov_b64 exec, -1
    v_cndmask_b32_dpp v84, v84, v84, vcc wave_shr:1 row_mask:0xf bank_mask:0xf
    v_cndmask_b32_dpp v85, v85, v85, vcc wave_shr:1 row_mask:0xf bank_mask:0xf
    s_lshr_b64 s[52:53], s[52:53], 1
    v_cndmask_b32_dpp v86, v86, v86, vcc wave_shr:1 row_mask:0xf bank_mask:0xf
    v_cndmask_b32_dpp v87, v87, v87, vcc wave_shr:1 row_mask:0xf bank_mask:0xf
    s_andn2_b64 s[82:83], s[82:83], s[52:53]
    v_cndmask_b32_dpp v7, v7, v7, vcc wave_shr:1 row_mask:0xf bank_mask:0xf
    s_mov_b64 exec, s[54:55]
    s_cbranch_scc0 L2_d13
    s_mov_b64 exec, s[82:83]
    s_nop 1
    v_mfma_f32_4x4x4_16b_bf16 v[88:91], v[12:13], v[84:85], 0
    s_nop 1
    v_mfma_f32_4x4x4_16b_bf16 v[88:91], v[10:11], v[86:87], v[88:91]
    s_nop 4
    v_cvt_pk_bf16_f32 v88, v88, v89
    v_cvt_pk_bf16_f32 v89, v90, v91
    ds_pk_add_bf16 v7, v88 offset:65408
    ds_pk_add_bf16 v7, v89 offset:65412
    s_mov_b64 exec, s[54:55]
    s_branch L2_d13
L2_c14:
    s_lshl_b64 s[52:53], s[82:83], 1
    s_andn2_b64 s[52:53], s[52:53], s[80:81]
    s_andn2_b64 s[52:53], s[52:53], s[50:51]
    s_or_b64 s[80:81], s[80:81], s[52:53]
    s_not_b64 vcc, s[52:53]
    s_mov_b64 exec, -1
    v_cndmask_b32_dpp v84, v84, v84, vcc wave_shr:1 row_mask:0xf bank_mask:0xf
    v_cndmask_b32_dpp v85, v85, v85, vcc wave_shr:1 row_mask:0xf bank_mask:0xf
    s_lshr_b64 s[52:53], s[52:53], 1
    v_cndmask_b32_dpp v86, v86, v86, vcc wave_shr:1 row_mask:0xf bank_mask:0xf
    v_cndmask_b32_dpp v87, v87, v87, vcc wave_shr:1 row_mask:0xf bank_mask:0xf
    s_andn2_b64 s[82:83], s[82:83], s[52:53]
    v_cndmask_b32_dpp v7, v7, v7, vcc wave_shr:1 row_mask:0xf bank_mask:0xf
    s_mov_b64 exec, s[50:51]
    s_cbranch_scc0 L2_d14
    s_mov_b64 exec, s[82:83]
    s_nop 1
    v_mfma_f32_4x4x4_16b_bf16 v[88:91], v[12:13], v[84:85], 0
    s_nop 1
    v_mfma_f32_4x4x4_16b_bf16 v[88:91], v[10:11], v[86:87], v[88:91]
    s_nop 4
    v_cvt_pk_bf16_f32 v88, v88, v89
    v_cvt_pk_bf16_f32 v89, v90, v91
    ds_pk_add_bf16 v7, v88 offset:65408
    ds_pk_add_bf16 v7, v89 offset:65412
    s_mov_b64 exec, s[50:51]
    s_branch L2_d14
L2_xo16:
    v_cmp_lt_u32 vcc, 20, v99
    s_mov_b32 s101, 1
    s_cbranch_vccz L2_xp16
    v_cmp_lt_u32 vcc, 32, v99
    v_cmp_lt_u32 s[58:59], 31, v88
    s_mov_b32 s101, 2
    s_or_b64 vcc, vcc, s[58:59]
    s_cbranch_scc0 L2_xp16
    s_mov_b32 s37, 0x10000
    s_branch L2_xp16
L2_c17:
    s_lshl_b64 s[52:53], s[82:83], 1
    s_andn2_b64 s[52:53], s[52:53], s[80:81]
    s_andn2_b64 s[52:53], s[52:53], s[54:55]
    s_or_b64 s[80:81], s[80:81], s[52:53]
    s_not_b64 vcc, s[52:53]
    s_mov_b64 exec, -1
    v_cndmask_b32_dpp v84, v84, v84, vcc wave_shr:1 row_mask:0xf bank_mask:0xf
    v_cndmask_b32_dpp v85, v85, v85, vcc wave_shr:1 row_mask:0xf bank_mask:0xf
    s_lshr_b64 s[52:53], s[52:53], 1
    v_cndmask_b32_dpp v86, v86, v86, vcc wave_shr:1 row_mask:0xf bank_mask:0xf
    v_cndmask_b32_dpp v87, v87, v87, vcc wave_shr:1 row_mask:0xf bank_mask:0xf
    s_andn2_b64 s[82:83], s[82:83], s[52:53]
    v_cndmask_b32_dpp v7, v7, v7, vcc wave_shr:1 row_mask:0xf bank_mask:0xf
    s_mov_b64 exec, s[54:55]
    s_cbranch_scc0 L2_d17
    s_mov_b64 exec, s[82:83]
    s_nop 1
    v_mfma_f32_4x4x4_16b_bf16 v[88:91], v[12:13], v[84:85], 0
    s_nop 1
    v_mfma_f32_4x4x4_16b_bf16 v[88:91], v[10:11], v[86:87], v[88:91]
    s_nop 4
    v_cvt_pk_bf16_f32 v88, v88, v89
    v_cvt_pk_bf16_f32 v89, v90, v91
    ds_pk_add_bf16 v7, v88 offset:65408
    ds_pk_add_bf16 v7, v89 offset:65412
    s_mov_b64 exec, s[54:55]
    s_branch L2_d17
L2_c18:
    s_lshl_b64 s[52:53], s[82:83], 1
    s_andn2_b64 s[52:53], s[52:53], s[80:81]
    s_andn2_b64 s[52:53], s[52:53], s[50:51]
    s_or_b64 s[80:81], s[80:81], s[52:53]
    s_not_b64 vcc, s[52:53]
    s_mov_b64 exec, -1
    v_cndmask_b32_dpp v84, v84, v84, vcc wave_shr:1 row_mask:0xf bank_mask:0xf
    v_cndmask_b32_dpp v85, v85, v85, vcc wave_shr:1 row_mask:0xf bank_mask:0xf
    s_lshr_b64 s[52:53], s[52:53], 1
    v_cndmask_b32_dpp v86, v86, v86, vcc wave_shr:1 row_mask:0xf bank_mask:0xf
    v_cndmask_b32_dpp v87, v87, v87, vcc wave_shr:1 row_mask:0xf bank_mask:0xf
    s_andn2_b64 s[82:83], s[82:83], s[52:53]
    v_cndmask_b32_dpp v7, v7, v7, vcc wave_shr:1 row_mask:0xf bank_mask:0xf
    s_mov_b64 exec, s[50:51]
    s_cbranch_scc0 L2_d18
    s_mov_b64 exec, s[82:83]
    s_nop 1
    v_mfma_f32_4x4x4_16b_bf16 v[88:91], v[12:13], v[84:85], 0
    s_nop 1
    v_mfma_f32_4x4x4_16b_bf16 v[88:91], v[10:11], v[86:87], v[88:91]
    s_nop 4
    v_cvt_pk_bf16_f32 v88, v88, v89
    v_cvt_pk_bf16_f32 v89, v90, v91
    ds_pk_add_bf16 v7, v88 offset:65408
    ds_pk_add_bf16 v7, v89 offset:65412
    s_mov_b64 exec, s[50:51]
    s_branch L2_d18
L2_c21:
    s_lshl_b64 s[52:53], s[82:83], 1
    s_andn2_b64 s[52:53], s[52:53], s[80:81]
    s_andn2_b64 s[52:53], s[52:53], s[54:55]
    s_or_b64 s[80:81], s[80:81], s[52:53]
    s_not_b64 vcc, s[52:53]
    s_mov_b64 exec, -1
    v_cndmask_b32_dpp v84, v84, v84, vcc wave_shr:1 row_mask:0xf bank_mask:0xf
    v_cndmask_b32_dpp v85, v85, v85, vcc wave_shr:1 row_mask:0xf bank_mask:0xf
    s_lshr_b64 s[52:53], s[52:53], 1
    v_cndmask_b32_dpp v86, v86, v86, vcc wave_shr:1 row_mask:0xf bank_mask:0xf
    v_cndmask_b32_dpp v87, v87, v87, vcc wave_shr:1 row_mask:0xf bank_mask:0xf
    s_andn2_b64 s[82:83], s[82:83], s[52:53]
    v_cndmask_b32_dpp v7, v7, v7, vcc wave_shr:1 row_mask:0xf bank_mask:0xf
    s_mov_b64 exec, s[54:55]
    s_cbranch_scc0 L2_d21
    s_mov_b64 exec, s[82:83]
    s_nop 1
    v_mfma_f32_4x4x4_16b_bf16 v[88:91], v[12:13], v[84:85], 0
    s_nop 1
    v_mfma_f32_4x4x4_16b_bf16 v[88:91], v[10:11], v[86:87], v[88:91]
    s_nop 4
    v_cvt_pk_bf16_f32 v88, v88, v89
    v_cvt_pk_bf16_f32 v89, v90, v91
    ds_pk_add_bf16 v7, v88 offset:65408
    ds_pk_add_bf16 v7, v89 offset:65412
    s_mov_b64 exec, s[54:55]
    s_branch L2_d21
L2_c22:
    s_lshl_b64 s[52:53], s[82:83], 1
    s_andn2_b64 s[52:53], s[52:53], s[80:81]
    s_andn2_b64 s[52:53], s[52:53], s[50:51]
    s_or_b64 s[80:81], s[80:81], s[52:53]
    s_not_b64 vcc, s[52:53]
    s_mov_b64 exec, -1
    v_cndmask_b32_dpp v84, v84, v84, vcc wave_shr:1 row_mask:0xf bank_mask:0xf
    v_cndmask_b32_dpp v85, v85, v85, vcc wave_shr:1 row_mask:0xf bank_mask:0xf
    s_lshr_b64 s[52:53], s[52:53], 1
    v_cndmask_b32_dpp v86, v86, v86, vcc wave_shr:1 row_mask:0xf bank_mask:0xf
    v_cndmask_b32_dpp v87, v87, v87, vcc wave_shr:1 row_mask:0xf bank_mask:0xf
    s_andn2_b64 s[82:83], s[82:83], s[52:53]
    v_cndmask_b32_dpp v7, v7, v7, vcc wave_shr:1 row_mask:0xf bank_mask:0xf
    s_mov_b64 exec, s[50:51]
    s_cbranch_scc0 L2_d22
    s_mov_b64 exec, s[82:83]
    s_nop 1
    v_mfma_f32_4x4x4_16b_bf16 v[88:91], v[12:13], v[84:85], 0
    s_nop 1
    v_mfma_f32_4x4x4_16b_bf16 v[88:91], v[10:11], v[86:87], v[88:91]
    s_nop 4
    v_cvt_pk_bf16_f32 v88, v88, v89
    v_cvt_pk_bf16_f32 v89, v90, v91
    ds_pk_add_bf16 v7, v88 offset:65408
    ds_pk_add_bf16 v7, v89 offset:65412
    s_mov_b64 exec, s[50:51]
    s_branch L2_d22
L2_c23:
    s_lshl_b64 s[52:53], s[82:83], 1
    s_andn2_b64 s[52:53], s[52:53], s[80:81]
    s_andn2_b64 s[52:53], s[52:53], s[54:55]
    s_or_b64 s[80:81], s[80:81], s[52:53]
    s_not_b64 vcc, s[52:53]
    s_mov_b64 exec, -1
    v_cndmask_b32_dpp v84, v84, v84, vcc wave_shr:1 row_mask:0xf bank_mask:0xf
    v_cndmask_b32_dpp v85, v85, v85, vcc wave_shr:1 row_mask:0xf bank_mask:0xf
    s_lshr_b64 s[52:53], s[52:53], 1
    v_cndmask_b32_dpp v86, v86, v86, vcc wave_shr:1 row_mask:0xf bank_mask:0xf
    v_cndmask_b32_dpp v87, v87, v87, vcc wave_shr:1 row_mask:0xf bank_mask:0xf
    s_andn2_b64 s[82:83], s[82:83], s[52:53]
    v_cndmask_b32_dpp v7, v7, v7, vcc wave_shr:1 row_mask:0xf bank_mask:0xf
    s_mov_b64 exec, s[54:55]
    s_cbranch_scc0 L2_d23
    s_mov_b64 exec, s[82:83]
    s_nop 1
    v_mfma_f32_4x4x4_16b_bf16 v[88:91], v[12:13], v[84:85], 0
    s_nop 1
    v_mfma_f32_4x4x4_16b_bf16 v[88:91], v[10:11], v[86:87], v[88:91]
    s_nop 4
    v_cvt_pk_bf16_f32 v88, v88, v89
    v_cvt_pk_bf16_f32 v89, v90, v91
    ds_pk_add_bf16 v7, v88 offset:65408
    ds_pk_add_bf16 v7, v89 offset:65412
    s_mov_b64 exec, s[54:55]
    s_branch L2_d23
L2_c24:
    s_lshl_b64 s[52:53], s[82:83], 1
    s_andn2_b64 s[52:53], s[52:53], s[80:81]
    s_andn2_b64 s[52:53], s[52:53], s[50:51]
    s_or_b64 s[80:81], s[80:81], s[52:53]
    s_not_b64 vcc, s[52:53]
    s_mov_b64 exec, -1
    v_cndmask_b32_dpp v84, v84, v84, vcc wave_shr:1 row_mask:0xf bank_mask:0xf
    v_cndmask_b32_dpp v85, v85, v85, vcc wave_shr:1 row_mask:0xf bank_mask:0xf
    s_lshr_b64 s[52:53], s[52:53], 1
    v_cndmask_b32_dpp v86, v86, v86, vcc wave_shr:1 row_mask:0xf bank_mask:0xf
    v_cndmask_b32_dpp v87, v87, v87, vcc wave_shr:1 row_mask:0xf bank_mask:0xf
    s_andn2_b64 s[82:83], s[82:83], s[52:53]
    v_cndmask_b32_dpp v7, v7, v7, vcc wave_shr:1 row_mask:0xf bank_mask:0xf
    s_mov_b64 exec, s[50:51]
    s_cbranch_scc0 L2_d24
    s_mov_b64 exec, s[82:83]
    s_nop 1
    v_mfma_f32_4x4x4_16b_bf16 v[88:91], v[12:13], v[84:85], 0
    s_nop 1
    v_mfma_f32_4x4x4_16b_bf16 v[88:91], v[10:11], v[86:87], v[88:91]
    s_nop 4
    v_cvt_pk_bf16_f32 v88, v88, v89
    v_cvt_pk_bf16_f32 v89, v90, v91
    ds_pk_add_bf16 v7, v88 offset:65408
    ds_pk_add_bf16 v7, v89 offset:65412
    s_mov_b64 exec, s[50:51]
    s_branch L2_d24
L2_xa25:
    s_cmp_eq_u32 s101, 1
    s_cbranch_scc1 L2_xc25
    v_lshlrev_b32 v89, 0, v96
    v_add_u32 v90, 140, v97
    v_bitop3_b32 v90, v89, v45, v90 bitop3:0x6a
    ds_write_b32 v98, v90 offset:28
    v_lshlrev_b32 v89, 4, v96
    v_add_u32 v90, 120, v97
    v_bitop3_b32 v90, v89, v45, v90 bitop3:0x6a
    ds_write_b32 v98, v90 offset:24
    v_lshlrev_b32 v89, 8, v96
    v_add_u32 v90, 100, v97
    v_bitop3_b32 v90, v89, v45, v90 bitop3:0x6a
    ds_write_b32 v98, v90 offset:20
L2_xc25:
    v_lshlrev_b32 v89, 12, v96
    v_add_u32 v90, 80, v97
    v_bitop3_b32 v90, v89, v45, v90 bitop3:0x6a
    ds_write_b32 v98, v90 offset:16
    s_branch L2_xb25
L2_xe25:
    v_cmp_lt_u32 vcc, 32, v99
    v_cmp_lt_u32 s[58:59], 31, v88
    v_lshrrev_b32 v89, 16, v96
    v_add_u32 v97, 80, v97
    s_or_b64 vcc, vcc, s[58:59]
    s_cbranch_scc1 L2_xs25
    v_lshlrev_b32 v89, v1, v89
    v_and_b32 v89, v45, v89
    v_cmp_ne_u32 vcc, 0, v89
    v_xor_b32 v90, v97, v89
    s_add_u32 s3, s37, s38
    v_mbcnt_lo_u32_b32 v98, vcc_lo, 0
    v_mbcnt_hi_u32_b32 v98, vcc_hi, v98
    s_bcnt1_i32_b64 s41, vcc
    v_lshl_add_u32 v98, v98, 2, s3
    s_mov_b64 exec, vcc
    ds_write_b32 v98, v90
    s_mov_b64 exec, -1
    s_lshl2_add_u32 s37, s41, s37
    s_branch L2_xr25
L2_xf25:
    s_waitcnt lgkmcnt(0)
    s_cmp_gt_u32 s37, 1024
    s_cbranch_scc1 L2_xs25
    s_cmp_lt_u32 s37, 768
    s_cbranch_scc1 L2_xl25
    ds_read_b32 v32, v98 offset:896
    s_add_u32 s3, s42, 2
    s_bitset1_b32 s43, s3
    s_branch L2_xg25
L2_xl25:
    v_mov_b32 v42, -1
    s_cmp_ge_u32 s37, 512
    s_cbranch_scc1 L2_xg25
    v_mov_b32 v43, -1
    s_cmp_ge_u32 s37, 256
    s_cbranch_scc1 L2_xg25
    v_mov_b32 v41, -1
    s_branch L2_xg25
L2_xs25:
    s_waitcnt lgkmcnt(0)
    v_mov_b32 v40, -1
    v_mov_b32 v41, -1
    v_mov_b32 v43, -1
    v_mov_b32 v42, -1
    s_add_u32 s3, s42, 2
    s_bitset1_b32 s36, s3
    s_branch L2_xg25
L2_c26:
    s_lshl_b64 s[52:53], s[82:83], 1
    s_andn2_b64 s[52:53], s[52:53], s[80:81]
    s_andn2_b64 s[52:53], s[52:53], s[54:55]
    s_or_b64 s[80:81], s[80:81], s[52:53]
    s_not_b64 vcc, s[52:53]
    s_mov_b64 exec, -1
    v_cndmask_b32_dpp v84, v84, v84, vcc wave_shr:1 row_mask:0xf bank_mask:0xf
    v_cndmask_b32_dpp v85, v85, v85, vcc wave_shr:1 row_mask:0xf bank_mask:0xf
    s_lshr_b64 s[52:53], s[52:53], 1
    v_cndmask_b32_dpp v86, v86, v86, vcc wave_shr:1 row_mask:0xf bank_mask:0xf
    v_cndmask_b32_dpp v87, v87, v87, vcc wave_shr:1 row_mask:0xf bank_mask:0xf
    s_andn2_b64 s[82:83], s[82:83], s[52:53]
    v_cndmask_b32_dpp v7, v7, v7, vcc wave_shr:1 row_mask:0xf bank_mask:0xf
    s_mov_b64 exec, s[54:55]
    s_cbranch_scc0 L2_d26
    s_mov_b64 exec, s[82:83]
    s_nop 1
    v_mfma_f32_4x4x4_16b_bf16 v[88:91], v[12:13], v[84:85], 0
    s_nop 1
    v_mfma_f32_4x4x4_16b_bf16 v[88:91], v[10:11], v[86:87], v[88:91]
    s_nop 4
    v_cvt_pk_bf16_f32 v88, v88, v89
    v_cvt_pk_bf16_f32 v89, v90, v91
    ds_pk_add_bf16 v7, v88 offset:65408
    ds_pk_add_bf16 v7, v89 offset:65412
    s_mov_b64 exec, s[54:55]
    s_branch L2_d26
L2_c27:
    s_lshl_b64 s[52:53], s[82:83], 1
    s_andn2_b64 s[52:53], s[52:53], s[80:81]
    s_andn2_b64 s[52:53], s[52:53], s[50:51]
    s_or_b64 s[80:81], s[80:81], s[52:53]
    s_not_b64 vcc, s[52:53]
    s_mov_b64 exec, -1
    v_cndmask_b32_dpp v84, v84, v84, vcc wave_shr:1 row_mask:0xf bank_mask:0xf
    v_cndmask_b32_dpp v85, v85, v85, vcc wave_shr:1 row_mask:0xf bank_mask:0xf
    s_lshr_b64 s[52:53], s[52:53], 1
    v_cndmask_b32_dpp v86, v86, v86, vcc wave_shr:1 row_mask:0xf bank_mask:0xf
    v_cndmask_b32_dpp v87, v87, v87, vcc wave_shr:1 row_mask:0xf bank_mask:0xf
    s_andn2_b64 s[82:83], s[82:83], s[52:53]
    v_cndmask_b32_dpp v7, v7, v7, vcc wave_shr:1 row_mask:0xf bank_mask:0xf
    s_mov_b64 exec, s[50:51]
    s_cbranch_scc0 L2_d27
    s_mov_b64 exec, s[82:83]
    s_nop 1
    v_mfma_f32_4x4x4_16b_bf16 v[88:91], v[12:13], v[84:85], 0
    s_nop 1
    v_mfma_f32_4x4x4_16b_bf16 v[88:91], v[10:11], v[86:87], v[88:91]
    s_nop 4
    v_cvt_pk_bf16_f32 v88, v88, v89
    v_cvt_pk_bf16_f32 v89, v90, v91
    ds_pk_add_bf16 v7, v88 offset:65408
    ds_pk_add_bf16 v7, v89 offset:65412
    s_mov_b64 exec, s[50:51]
    s_branch L2_d27
L2_oa28:
    v_and_b32 v47, 0x0fffffff, v33
    buffer_load_dword v114, v47, s[8:11], 0 offen offset:16
    s_mov_b64 exec, s[6:7]
    v_add_u32 v47, 8, v47
    v_lshrrev_b32 v33, 2, v33
    s_mov_b64 exec, -1
    buffer_load_dwordx2 v[112:113], v47, s[8:11], 0 offen
    s_branch L2_ob28
L2_c29:
    s_lshl_b64 s[52:53], s[82:83], 1
    s_andn2_b64 s[52:53], s[52:53], s[80:81]
    s_andn2_b64 s[52:53], s[52:53], s[54:55]
    s_or_b64 s[80:81], s[80:81], s[52:53]
    s_not_b64 vcc, s[52:53]
    s_mov_b64 exec, -1
    v_cndmask_b32_dpp v84, v84, v84, vcc wave_shr:1 row_mask:0xf bank_mask:0xf
    v_cndmask_b32_dpp v85, v85, v85, vcc wave_shr:1 row_mask:0xf bank_mask:0xf
    s_lshr_b64 s[52:53], s[52:53], 1
    v_cndmask_b32_dpp v86, v86, v86, vcc wave_shr:1 row_mask:0xf bank_mask:0xf
    v_cndmask_b32_dpp v87, v87, v87, vcc wave_shr:1 row_mask:0xf bank_mask:0xf
    s_andn2_b64 s[82:83], s[82:83], s[52:53]
    v_cndmask_b32_dpp v7, v7, v7, vcc wave_shr:1 row_mask:0xf bank_mask:0xf
    s_mov_b64 exec, s[54:55]
    s_cbranch_scc0 L2_d29
    s_mov_b64 exec, s[82:83]
    s_nop 1
    v_mfma_f32_4x4x4_16b_bf16 v[88:91], v[12:13], v[84:85], 0
    s_nop 1
    v_mfma_f32_4x4x4_16b_bf16 v[88:91], v[10:11], v[86:87], v[88:91]
    s_nop 4
    v_cvt_pk_bf16_f32 v88, v88, v89
    v_cvt_pk_bf16_f32 v89, v90, v91
    ds_pk_add_bf16 v7, v88 offset:65408
    ds_pk_add_bf16 v7, v89 offset:65412
    s_mov_b64 exec, s[54:55]
    s_branch L2_d29
L2_c30:
    s_lshl_b64 s[52:53], s[82:83], 1
    s_andn2_b64 s[52:53], s[52:53], s[80:81]
    s_andn2_b64 s[52:53], s[52:53], s[50:51]
    s_or_b64 s[80:81], s[80:81], s[52:53]
    s_not_b64 vcc, s[52:53]
    s_mov_b64 exec, -1
    v_cndmask_b32_dpp v84, v84, v84, vcc wave_shr:1 row_mask:0xf bank_mask:0xf
    v_cndmask_b32_dpp v85, v85, v85, vcc wave_shr:1 row_mask:0xf bank_mask:0xf
    s_lshr_b64 s[52:53], s[52:53], 1
    v_cndmask_b32_dpp v86, v86, v86, vcc wave_shr:1 row_mask:0xf bank_mask:0xf
    v_cndmask_b32_dpp v87, v87, v87, vcc wave_shr:1 row_mask:0xf bank_mask:0xf
    s_andn2_b64 s[82:83], s[82:83], s[52:53]
    v_cndmask_b32_dpp v7, v7, v7, vcc wave_shr:1 row_mask:0xf bank_mask:0xf
    s_mov_b64 exec, s[50:51]
    s_cbranch_scc0 L2_d30
    s_mov_b64 exec, s[82:83]
    s_nop 1
    v_mfma_f32_4x4x4_16b_bf16 v[88:91], v[12:13], v[84:85], 0
    s_nop 1
    v_mfma_f32_4x4x4_16b_bf16 v[88:91], v[10:11], v[86:87], v[88:91]
    s_nop 4
    v_cvt_pk_bf16_f32 v88, v88, v89
    v_cvt_pk_bf16_f32 v89, v90, v91
    ds_pk_add_bf16 v7, v88 offset:65408
    ds_pk_add_bf16 v7, v89 offset:65412
    s_mov_b64 exec, s[50:51]
    s_branch L2_d30
L2_c31:
    s_lshl_b64 s[52:53], s[82:83], 1
    s_andn2_b64 s[52:53], s[52:53], s[80:81]
    s_andn2_b64 s[52:53], s[52:53], s[54:55]
    s_or_b64 s[80:81], s[80:81], s[52:53]
    s_not_b64 vcc, s[52:53]
    s_mov_b64 exec, -1
    v_cndmask_b32_dpp v84, v84, v84, vcc wave_shr:1 row_mask:0xf bank_mask:0xf
    v_cndmask_b32_dpp v85, v85, v85, vcc wave_shr:1 row_mask:0xf bank_mask:0xf
    s_lshr_b64 s[52:53], s[52:53], 1
    v_cndmask_b32_dpp v86, v86, v86, vcc wave_shr:1 row_mask:0xf bank_mask:0xf
    v_cndmask_b32_dpp v87, v87, v87, vcc wave_shr:1 row_mask:0xf bank_mask:0xf
    s_andn2_b64 s[82:83], s[82:83], s[52:53]
    v_cndmask_b32_dpp v7, v7, v7, vcc wave_shr:1 row_mask:0xf bank_mask:0xf
    s_mov_b64 exec, s[54:55]
    s_cbranch_scc0 L2_d31
    s_mov_b64 exec, s[82:83]
    s_nop 1
    v_mfma_f32_4x4x4_16b_bf16 v[88:91], v[12:13], v[84:85], 0
    s_nop 1
    v_mfma_f32_4x4x4_16b_bf16 v[88:91], v[10:11], v[86:87], v[88:91]
    s_nop 4
    v_cvt_pk_bf16_f32 v88, v88, v89
    v_cvt_pk_bf16_f32 v89, v90, v91
    ds_pk_add_bf16 v7, v88 offset:65408
    ds_pk_add_bf16 v7, v89 offset:65412
    s_mov_b64 exec, s[54:55]
    s_branch L2_d31
L2_c32:
    s_lshl_b64 s[52:53], s[82:83], 1
    s_andn2_b64 s[52:53], s[52:53], s[80:81]
    s_andn2_b64 s[52:53], s[52:53], s[50:51]
    s_or_b64 s[80:81], s[80:81], s[52:53]
    s_not_b64 vcc, s[52:53]
    s_mov_b64 exec, -1
    v_cndmask_b32_dpp v84, v84, v84, vcc wave_shr:1 row_mask:0xf bank_mask:0xf
    v_cndmask_b32_dpp v85, v85, v85, vcc wave_shr:1 row_mask:0xf bank_mask:0xf
    s_lshr_b64 s[52:53], s[52:53], 1
    v_cndmask_b32_dpp v86, v86, v86, vcc wave_shr:1 row_mask:0xf bank_mask:0xf
    v_cndmask_b32_dpp v87, v87, v87, vcc wave_shr:1 row_mask:0xf bank_mask:0xf
    s_andn2_b64 s[82:83], s[82:83], s[52:53]
    v_cndmask_b32_dpp v7, v7, v7, vcc wave_shr:1 row_mask:0xf bank_mask:0xf
    s_mov_b64 exec, s[50:51]
    s_cbranch_scc0 L2_d32
    s_mov_b64 exec, s[82:83]
    s_nop 1
    v_mfma_f32_4x4x4_16b_bf16 v[88:91], v[12:13], v[84:85], 0
    s_nop 1
    v_mfma_f32_4x4x4_16b_bf16 v[88:91], v[10:11], v[86:87], v[88:91]
    s_nop 4
    v_cvt_pk_bf16_f32 v88, v88, v89
    v_cvt_pk_bf16_f32 v89, v90, v91
    ds_pk_add_bf16 v7, v88 offset:65408
    ds_pk_add_bf16 v7, v89 offset:65412
    s_mov_b64 exec, s[50:51]
    s_branch L2_d32
L2_c33:
    s_lshl_b64 s[52:53], s[82:83], 1
    s_andn2_b64 s[52:53], s[52:53], s[80:81]
    s_andn2_b64 s[52:53], s[52:53], s[54:55]
    s_or_b64 s[80:81], s[80:81], s[52:53]
    s_not_b64 vcc, s[52:53]
    s_mov_b64 exec, -1
    v_cndmask_b32_dpp v84, v84, v84, vcc wave_shr:1 row_mask:0xf bank_mask:0xf
    v_cndmask_b32_dpp v85, v85, v85, vcc wave_shr:1 row_mask:0xf bank_mask:0xf
    s_lshr_b64 s[52:53], s[52:53], 1
    v_cndmask_b32_dpp v86, v86, v86, vcc wave_shr:1 row_mask:0xf bank_mask:0xf
    v_cndmask_b32_dpp v87, v87, v87, vcc wave_shr:1 row_mask:0xf bank_mask:0xf
    s_andn2_b64 s[82:83], s[82:83], s[52:53]
    v_cndmask_b32_dpp v7, v7, v7, vcc wave_shr:1 row_mask:0xf bank_mask:0xf
    s_mov_b64 exec, s[54:55]
    s_cbranch_scc0 L2_d33
    s_mov_b64 exec, s[82:83]
    s_nop 1
    v_mfma_f32_4x4x4_16b_bf16 v[88:91], v[12:13], v[84:85], 0
    s_nop 1
    v_mfma_f32_4x4x4_16b_bf16 v[88:91], v[10:11], v[86:87], v[88:91]
    s_nop 4
    v_cvt_pk_bf16_f32 v88, v88, v89
    v_cvt_pk_bf16_f32 v89, v90, v91
    ds_pk_add_bf16 v7, v88 offset:65408
    ds_pk_add_bf16 v7, v89 offset:65412
    s_mov_b64 exec, s[54:55]
    s_branch L2_d33
L2_c34:
    s_lshl_b64 s[52:53], s[82:83], 1
    s_andn2_b64 s[52:53], s[52:53], s[80:81]
    s_andn2_b64 s[52:53], s[52:53], s[50:51]
    s_or_b64 s[80:81], s[80:81], s[52:53]
    s_not_b64 vcc, s[52:53]
    s_mov_b64 exec, -1
    v_cndmask_b32_dpp v84, v84, v84, vcc wave_shr:1 row_mask:0xf bank_mask:0xf
    v_cndmask_b32_dpp v85, v85, v85, vcc wave_shr:1 row_mask:0xf bank_mask:0xf
    s_lshr_b64 s[52:53], s[52:53], 1
    v_cndmask_b32_dpp v86, v86, v86, vcc wave_shr:1 row_mask:0xf bank_mask:0xf
    v_cndmask_b32_dpp v87, v87, v87, vcc wave_shr:1 row_mask:0xf bank_mask:0xf
    s_andn2_b64 s[82:83], s[82:83], s[52:53]
    v_cndmask_b32_dpp v7, v7, v7, vcc wave_shr:1 row_mask:0xf bank_mask:0xf
    s_mov_b64 exec, s[50:51]
    s_cbranch_scc0 L2_d34
    s_mov_b64 exec, s[82:83]
    s_nop 1
    v_mfma_f32_4x4x4_16b_bf16 v[88:91], v[12:13], v[84:85], 0
    s_nop 1
    v_mfma_f32_4x4x4_16b_bf16 v[88:91], v[10:11], v[86:87], v[88:91]
    s_nop 4
    v_cvt_pk_bf16_f32 v88, v88, v89
    v_cvt_pk_bf16_f32 v89, v90, v91
    ds_pk_add_bf16 v7, v88 offset:65408
    ds_pk_add_bf16 v7, v89 offset:65412
    s_mov_b64 exec, s[50:51]
    s_branch L2_d34
L2_oa35:
    s_waitcnt vmcnt(5)
    s_mov_b64 exec, s[6:7]
    v_lshrrev_b32 v114, 16, v114
    s_mov_b64 exec, -1
    v_and_b32 v46, 0x10000000, v33
    v_cmpx_eq_u32 vcc, 0, v46
    v_lshrrev_b32 v47, 14, v112
    v_and_b32 v47, v5, v47
    ds_read_b64 v[96:97], v47
    v_perm_b32 v98, v112, v114, s44
    v_bitop3_b32 v99, v112, 0.5, -0.5 bitop3:0xa8
    v_bitop3_b32 v98, v6, v98, v99 bitop3:0xca
    v_and_b32 v47, v5, v112
    s_waitcnt lgkmcnt(0)
    v_mfma_f32_4x4x4_16b_bf16 v[88:91], v[8:9], v[96:97], 0
    s_nop 4
    v_mul_f32 v88, v98, v88
    v_mul_f32 v89, v98, v89
    v_mul_f32 v90, v98, v90
    v_mul_f32 v91, v98, v91
    v_cvt_pk_bf16_f32 v88, v88, v89
    v_cvt_pk_bf16_f32 v89, v90, v91
    ds_pk_add_bf16 v47, v88 offset:65408
    ds_pk_add_bf16 v47, v89 offset:65412
    s_mov_b64 exec, -1
    v_and_b32 v46, 0x20000000, v33
    v_cmpx_eq_u32 vcc, 0, v46
    v_lshrrev_b32 v47, 14, v113
    v_and_b32 v47, v5, v47
    ds_read_b64 v[96:97], v47
    v_perm_b32 v98, v113, v114, s45
    v_bitop3_b32 v99, v113, 0.5, -0.5 bitop3:0xa8
    v_bitop3_b32 v98, v6, v98, v99 bitop3:0xca
    v_and_b32 v47, v5, v113
    s_waitcnt lgkmcnt(0)
    v_mfma_f32_4x4x4_16b_bf16 v[88:91], v[8:9], v[96:97], 0
    s_nop 4
    v_mul_f32 v88, v98, v88
    v_mul_f32 v89, v98, v89
    v_mul_f32 v90, v98, v90
    v_mul_f32 v91, v98, v91
    v_cvt_pk_bf16_f32 v88, v88, v89
    v_cvt_pk_bf16_f32 v89, v90, v91
    ds_pk_add_bf16 v47, v88 offset:65408
    ds_pk_add_bf16 v47, v89 offset:65412
    s_mov_b64 exec, -1
    s_branch L2_ob35
L2_xo36:
    v_cmp_lt_u32 vcc, 20, v99
    s_mov_b32 s101, 1
    s_cbranch_vccz L2_xp36
    v_cmp_lt_u32 vcc, 32, v99
    v_cmp_lt_u32 s[58:59], 31, v88
    s_mov_b32 s101, 2
    s_or_b64 vcc, vcc, s[58:59]
    s_cbranch_scc0 L2_xp36
    s_mov_b32 s37, 0x10000
    s_branch L2_xp36
L2_c37:
    s_lshl_b64 s[52:53], s[82:83], 1
    s_andn2_b64 s[52:53], s[52:53], s[80:81]
    s_andn2_b64 s[52:53], s[52:53], s[54:55]
    s_or_b64 s[80:81], s[80:81], s[52:53]
    s_not_b64 vcc, s[52:53]
    s_mov_b64 exec, -1
    v_cndmask_b32_dpp v84, v84, v84, vcc wave_shr:1 row_mask:0xf bank_mask:0xf
    v_cndmask_b32_dpp v85, v85, v85, vcc wave_shr:1 row_mask:0xf bank_mask:0xf
    s_lshr_b64 s[52:53], s[52:53], 1
    v_cndmask_b32_dpp v86, v86, v86, vcc wave_shr:1 row_mask:0xf bank_mask:0xf
    v_cndmask_b32_dpp v87, v87, v87, vcc wave_shr:1 row_mask:0xf bank_mask:0xf
    s_andn2_b64 s[82:83], s[82:83], s[52:53]
    v_cndmask_b32_dpp v7, v7, v7, vcc wave_shr:1 row_mask:0xf bank_mask:0xf
    s_mov_b64 exec, s[54:55]
    s_cbranch_scc0 L2_d37
    s_mov_b64 exec, s[82:83]
    s_nop 1
    v_mfma_f32_4x4x4_16b_bf16 v[88:91], v[12:13], v[84:85], 0
    s_nop 1
    v_mfma_f32_4x4x4_16b_bf16 v[88:91], v[10:11], v[86:87], v[88:91]
    s_nop 4
    v_cvt_pk_bf16_f32 v88, v88, v89
    v_cvt_pk_bf16_f32 v89, v90, v91
    ds_pk_add_bf16 v7, v88 offset:65408
    ds_pk_add_bf16 v7, v89 offset:65412
    s_mov_b64 exec, s[54:55]
    s_branch L2_d37
L2_c38:
    s_lshl_b64 s[52:53], s[82:83], 1
    s_andn2_b64 s[52:53], s[52:53], s[80:81]
    s_andn2_b64 s[52:53], s[52:53], s[50:51]
    s_or_b64 s[80:81], s[80:81], s[52:53]
    s_not_b64 vcc, s[52:53]
    s_mov_b64 exec, -1
    v_cndmask_b32_dpp v84, v84, v84, vcc wave_shr:1 row_mask:0xf bank_mask:0xf
    v_cndmask_b32_dpp v85, v85, v85, vcc wave_shr:1 row_mask:0xf bank_mask:0xf
    s_lshr_b64 s[52:53], s[52:53], 1
    v_cndmask_b32_dpp v86, v86, v86, vcc wave_shr:1 row_mask:0xf bank_mask:0xf
    v_cndmask_b32_dpp v87, v87, v87, vcc wave_shr:1 row_mask:0xf bank_mask:0xf
    s_andn2_b64 s[82:83], s[82:83], s[52:53]
    v_cndmask_b32_dpp v7, v7, v7, vcc wave_shr:1 row_mask:0xf bank_mask:0xf
    s_mov_b64 exec, s[50:51]
    s_cbranch_scc0 L2_d38
    s_mov_b64 exec, s[82:83]
    s_nop 1
    v_mfma_f32_4x4x4_16b_bf16 v[88:91], v[12:13], v[84:85], 0
    s_nop 1
    v_mfma_f32_4x4x4_16b_bf16 v[88:91], v[10:11], v[86:87], v[88:91]
    s_nop 4
    v_cvt_pk_bf16_f32 v88, v88, v89
    v_cvt_pk_bf16_f32 v89, v90, v91
    ds_pk_add_bf16 v7, v88 offset:65408
    ds_pk_add_bf16 v7, v89 offset:65412
    s_mov_b64 exec, s[50:51]
    s_branch L2_d38
L2_c39:
    s_lshl_b64 s[52:53], s[82:83], 1
    s_andn2_b64 s[52:53], s[52:53], s[80:81]
    s_andn2_b64 s[52:53], s[52:53], s[54:55]
    s_or_b64 s[80:81], s[80:81], s[52:53]
    s_not_b64 vcc, s[52:53]
    s_mov_b64 exec, -1
    v_cndmask_b32_dpp v84, v84, v84, vcc wave_shr:1 row_mask:0xf bank_mask:0xf
    v_cndmask_b32_dpp v85, v85, v85, vcc wave_shr:1 row_mask:0xf bank_mask:0xf
    s_lshr_b64 s[52:53], s[52:53], 1
    v_cndmask_b32_dpp v86, v86, v86, vcc wave_shr:1 row_mask:0xf bank_mask:0xf
    v_cndmask_b32_dpp v87, v87, v87, vcc wave_shr:1 row_mask:0xf bank_mask:0xf
    s_andn2_b64 s[82:83], s[82:83], s[52:53]
    v_cndmask_b32_dpp v7, v7, v7, vcc wave_shr:1 row_mask:0xf bank_mask:0xf
    s_mov_b64 exec, s[54:55]
    s_cbranch_scc0 L2_d39
    s_mov_b64 exec, s[82:83]
    s_nop 1
    v_mfma_f32_4x4x4_16b_bf16 v[88:91], v[12:13], v[84:85], 0
    s_nop 1
    v_mfma_f32_4x4x4_16b_bf16 v[88:91], v[10:11], v[86:87], v[88:91]
    s_nop 4
    v_cvt_pk_bf16_f32 v88, v88, v89
    v_cvt_pk_bf16_f32 v89, v90, v91
    ds_pk_add_bf16 v7, v88 offset:65408
    ds_pk_add_bf16 v7, v89 offset:65412
    s_mov_b64 exec, s[54:55]
    s_branch L2_d39
L2_c40:
    s_lshl_b64 s[52:53], s[82:83], 1
    s_andn2_b64 s[52:53], s[52:53], s[80:81]
    s_andn2_b64 s[52:53], s[52:53], s[50:51]
    s_or_b64 s[80:81], s[80:81], s[52:53]
    s_not_b64 vcc, s[52:53]
    s_mov_b64 exec, -1
    v_cndmask_b32_dpp v84, v84, v84, vcc wave_shr:1 row_mask:0xf bank_mask:0xf
    v_cndmask_b32_dpp v85, v85, v85, vcc wave_shr:1 row_mask:0xf bank_mask:0xf
    s_lshr_b64 s[52:53], s[52:53], 1
    v_cndmask_b32_dpp v86, v86, v86, vcc wave_shr:1 row_mask:0xf bank_mask:0xf
    v_cndmask_b32_dpp v87, v87, v87, vcc wave_shr:1 row_mask:0xf bank_mask:0xf
    s_andn2_b64 s[82:83], s[82:83], s[52:53]
    v_cndmask_b32_dpp v7, v7, v7, vcc wave_shr:1 row_mask:0xf bank_mask:0xf
    s_mov_b64 exec, s[50:51]
    s_cbranch_scc0 L2_d40
    s_mov_b64 exec, s[82:83]
    s_nop 1
    v_mfma_f32_4x4x4_16b_bf16 v[88:91], v[12:13], v[84:85], 0
    s_nop 1
    v_mfma_f32_4x4x4_16b_bf16 v[88:91], v[10:11], v[86:87], v[88:91]
    s_nop 4
    v_cvt_pk_bf16_f32 v88, v88, v89
    v_cvt_pk_bf16_f32 v89, v90, v91
    ds_pk_add_bf16 v7, v88 offset:65408
    ds_pk_add_bf16 v7, v89 offset:65412
    s_mov_b64 exec, s[50:51]
    s_branch L2_d40
L2_c41:
    s_lshl_b64 s[52:53], s[82:83], 1
    s_andn2_b64 s[52:53], s[52:53], s[80:81]
    s_andn2_b64 s[52:53], s[52:53], s[54:55]
    s_or_b64 s[80:81], s[80:81], s[52:53]
    s_not_b64 vcc, s[52:53]
    s_mov_b64 exec, -1
    v_cndmask_b32_dpp v84, v84, v84, vcc wave_shr:1 row_mask:0xf bank_mask:0xf
    v_cndmask_b32_dpp v85, v85, v85, vcc wave_shr:1 row_mask:0xf bank_mask:0xf
    s_lshr_b64 s[52:53], s[52:53], 1
    v_cndmask_b32_dpp v86, v86, v86, vcc wave_shr:1 row_mask:0xf bank_mask:0xf
    v_cndmask_b32_dpp v87, v87, v87, vcc wave_shr:1 row_mask:0xf bank_mask:0xf
    s_andn2_b64 s[82:83], s[82:83], s[52:53]
    v_cndmask_b32_dpp v7, v7, v7, vcc wave_shr:1 row_mask:0xf bank_mask:0xf
    s_mov_b64 exec, s[54:55]
    s_cbranch_scc0 L2_d41
    s_mov_b64 exec, s[82:83]
    s_nop 1
    v_mfma_f32_4x4x4_16b_bf16 v[88:91], v[12:13], v[84:85], 0
    s_nop 1
    v_mfma_f32_4x4x4_16b_bf16 v[88:91], v[10:11], v[86:87], v[88:91]
    s_nop 4
    v_cvt_pk_bf16_f32 v88, v88, v89
    v_cvt_pk_bf16_f32 v89, v90, v91
    ds_pk_add_bf16 v7, v88 offset:65408
    ds_pk_add_bf16 v7, v89 offset:65412
    s_mov_b64 exec, s[54:55]
    s_branch L2_d41
L2_c42:
    s_lshl_b64 s[52:53], s[82:83], 1
    s_andn2_b64 s[52:53], s[52:53], s[80:81]
    s_andn2_b64 s[52:53], s[52:53], s[50:51]
    s_or_b64 s[80:81], s[80:81], s[52:53]
    s_not_b64 vcc, s[52:53]
    s_mov_b64 exec, -1
    v_cndmask_b32_dpp v84, v84, v84, vcc wave_shr:1 row_mask:0xf bank_mask:0xf
    v_cndmask_b32_dpp v85, v85, v85, vcc wave_shr:1 row_mask:0xf bank_mask:0xf
    s_lshr_b64 s[52:53], s[52:53], 1
    v_cndmask_b32_dpp v86, v86, v86, vcc wave_shr:1 row_mask:0xf bank_mask:0xf
    v_cndmask_b32_dpp v87, v87, v87, vcc wave_shr:1 row_mask:0xf bank_mask:0xf
    s_andn2_b64 s[82:83], s[82:83], s[52:53]
    v_cndmask_b32_dpp v7, v7, v7, vcc wave_shr:1 row_mask:0xf bank_mask:0xf
    s_mov_b64 exec, s[50:51]
    s_cbranch_scc0 L2_d42
    s_mov_b64 exec, s[82:83]
    s_nop 1
    v_mfma_f32_4x4x4_16b_bf16 v[88:91], v[12:13], v[84:85], 0
    s_nop 1
    v_mfma_f32_4x4x4_16b_bf16 v[88:91], v[10:11], v[86:87], v[88:91]
    s_nop 4
    v_cvt_pk_bf16_f32 v88, v88, v89
    v_cvt_pk_bf16_f32 v89, v90, v91
    ds_pk_add_bf16 v7, v88 offset:65408
    ds_pk_add_bf16 v7, v89 offset:65412
    s_mov_b64 exec, s[50:51]
    s_branch L2_d42
L2_xa43:
    s_cmp_eq_u32 s101, 1
    s_cbranch_scc1 L2_xc43
    v_lshlrev_b32 v89, 0, v96
    v_add_u32 v90, 140, v97
    v_bitop3_b32 v90, v89, v45, v90 bitop3:0x6a
    ds_write_b32 v98, v90 offset:28
    v_lshlrev_b32 v89, 4, v96
    v_add_u32 v90, 120, v97
    v_bitop3_b32 v90, v89, v45, v90 bitop3:0x6a
    ds_write_b32 v98, v90 offset:24
    v_lshlrev_b32 v89, 8, v96
    v_add_u32 v90, 100, v97
    v_bitop3_b32 v90, v89, v45, v90 bitop3:0x6a
    ds_write_b32 v98, v90 offset:20
L2_xc43:
    v_lshlrev_b32 v89, 12, v96
    v_add_u32 v90, 80, v97
    v_bitop3_b32 v90, v89, v45, v90 bitop3:0x6a
    ds_write_b32 v98, v90 offset:16
    s_branch L2_xb43
L2_xe43:
    v_cmp_lt_u32 vcc, 32, v99
    v_cmp_lt_u32 s[58:59], 31, v88
    v_lshrrev_b32 v89, 16, v96
    v_add_u32 v97, 80, v97
    s_or_b64 vcc, vcc, s[58:59]
    s_cbranch_scc1 L2_xs43
    v_lshlrev_b32 v89, v1, v89
    v_and_b32 v89, v45, v89
    v_cmp_ne_u32 vcc, 0, v89
    v_xor_b32 v90, v97, v89
    s_add_u32 s3, s37, s38
    v_mbcnt_lo_u32_b32 v98, vcc_lo, 0
    v_mbcnt_hi_u32_b32 v98, vcc_hi, v98
    s_bcnt1_i32_b64 s41, vcc
    v_lshl_add_u32 v98, v98, 2, s3
    s_mov_b64 exec, vcc
    ds_write_b32 v98, v90
    s_mov_b64 exec, -1
    s_lshl2_add_u32 s37, s41, s37
    s_branch L2_xr43
L2_xf43:
    s_waitcnt lgkmcnt(0)
    s_cmp_gt_u32 s37, 1024
    s_cbranch_scc1 L2_xs43
    s_cmp_lt_u32 s37, 768
    s_cbranch_scc1 L2_xl43
    ds_read_b32 v33, v98 offset:896
    s_add_u32 s3, s42, 2
    s_bitset1_b32 s43, s3
    s_branch L2_xg43
L2_xl43:
    v_mov_b32 v42, -1
    s_cmp_ge_u32 s37, 512
    s_cbranch_scc1 L2_xg43
    v_mov_b32 v43, -1
    s_cmp_ge_u32 s37, 256
    s_cbranch_scc1 L2_xg43
    v_mov_b32 v41, -1
    s_branch L2_xg43
L2_xs43:
    s_waitcnt lgkmcnt(0)
    v_mov_b32 v40, -1
    v_mov_b32 v41, -1
    v_mov_b32 v43, -1
    v_mov_b32 v42, -1
    s_add_u32 s3, s42, 2
    s_bitset1_b32 s36, s3
    s_branch L2_xg43
L2_c44:
    s_lshl_b64 s[52:53], s[82:83], 1
    s_andn2_b64 s[52:53], s[52:53], s[80:81]
    s_andn2_b64 s[52:53], s[52:53], s[54:55]
    s_or_b64 s[80:81], s[80:81], s[52:53]
    s_not_b64 vcc, s[52:53]
    s_mov_b64 exec, -1
    v_cndmask_b32_dpp v84, v84, v84, vcc wave_shr:1 row_mask:0xf bank_mask:0xf
    v_cndmask_b32_dpp v85, v85, v85, vcc wave_shr:1 row_mask:0xf bank_mask:0xf
    s_lshr_b64 s[52:53], s[52:53], 1
    v_cndmask_b32_dpp v86, v86, v86, vcc wave_shr:1 row_mask:0xf bank_mask:0xf
    v_cndmask_b32_dpp v87, v87, v87, vcc wave_shr:1 row_mask:0xf bank_mask:0xf
    s_andn2_b64 s[82:83], s[82:83], s[52:53]
    v_cndmask_b32_dpp v7, v7, v7, vcc wave_shr:1 row_mask:0xf bank_mask:0xf
    s_mov_b64 exec, s[54:55]
    s_cbranch_scc0 L2_d44
    s_mov_b64 exec, s[82:83]
    s_nop 1
    v_mfma_f32_4x4x4_16b_bf16 v[88:91], v[12:13], v[84:85], 0
    s_nop 1
    v_mfma_f32_4x4x4_16b_bf16 v[88:91], v[10:11], v[86:87], v[88:91]
    s_nop 4
    v_cvt_pk_bf16_f32 v88, v88, v89
    v_cvt_pk_bf16_f32 v89, v90, v91
    ds_pk_add_bf16 v7, v88 offset:65408
    ds_pk_add_bf16 v7, v89 offset:65412
    s_mov_b64 exec, s[54:55]
    s_branch L2_d44
L2_c45:
    s_lshl_b64 s[52:53], s[82:83], 1
    s_andn2_b64 s[52:53], s[52:53], s[80:81]
    s_andn2_b64 s[52:53], s[52:53], s[50:51]
    s_or_b64 s[80:81], s[80:81], s[52:53]
    s_not_b64 vcc, s[52:53]
    s_mov_b64 exec, -1
    v_cndmask_b32_dpp v84, v84, v84, vcc wave_shr:1 row_mask:0xf bank_mask:0xf
    v_cndmask_b32_dpp v85, v85, v85, vcc wave_shr:1 row_mask:0xf bank_mask:0xf
    s_lshr_b64 s[52:53], s[52:53], 1
    v_cndmask_b32_dpp v86, v86, v86, vcc wave_shr:1 row_mask:0xf bank_mask:0xf
    v_cndmask_b32_dpp v87, v87, v87, vcc wave_shr:1 row_mask:0xf bank_mask:0xf
    s_andn2_b64 s[82:83], s[82:83], s[52:53]
    v_cndmask_b32_dpp v7, v7, v7, vcc wave_shr:1 row_mask:0xf bank_mask:0xf
    s_mov_b64 exec, s[50:51]
    s_cbranch_scc0 L2_d45
    s_mov_b64 exec, s[82:83]
    s_nop 1
    v_mfma_f32_4x4x4_16b_bf16 v[88:91], v[12:13], v[84:85], 0
    s_nop 1
    v_mfma_f32_4x4x4_16b_bf16 v[88:91], v[10:11], v[86:87], v[88:91]
    s_nop 4
    v_cvt_pk_bf16_f32 v88, v88, v89
    v_cvt_pk_bf16_f32 v89, v90, v91
    ds_pk_add_bf16 v7, v88 offset:65408
    ds_pk_add_bf16 v7, v89 offset:65412
    s_mov_b64 exec, s[50:51]
    s_branch L2_d45
L2_oa46:
    v_and_b32 v47, 0x0fffffff, v32
    buffer_load_dword v114, v47, s[8:11], 0 offen offset:16
    s_mov_b64 exec, s[6:7]
    v_add_u32 v47, 8, v47
    v_lshrrev_b32 v32, 2, v32
    s_mov_b64 exec, -1
    buffer_load_dwordx2 v[112:113], v47, s[8:11], 0 offen
    s_branch L2_ob46
L2_c47:
    s_lshl_b64 s[52:53], s[82:83], 1
    s_andn2_b64 s[52:53], s[52:53], s[80:81]
    s_andn2_b64 s[52:53], s[52:53], s[54:55]
    s_or_b64 s[80:81], s[80:81], s[52:53]
    s_not_b64 vcc, s[52:53]
    s_mov_b64 exec, -1
    v_cndmask_b32_dpp v84, v84, v84, vcc wave_shr:1 row_mask:0xf bank_mask:0xf
    v_cndmask_b32_dpp v85, v85, v85, vcc wave_shr:1 row_mask:0xf bank_mask:0xf
    s_lshr_b64 s[52:53], s[52:53], 1
    v_cndmask_b32_dpp v86, v86, v86, vcc wave_shr:1 row_mask:0xf bank_mask:0xf
    v_cndmask_b32_dpp v87, v87, v87, vcc wave_shr:1 row_mask:0xf bank_mask:0xf
    s_andn2_b64 s[82:83], s[82:83], s[52:53]
    v_cndmask_b32_dpp v7, v7, v7, vcc wave_shr:1 row_mask:0xf bank_mask:0xf
    s_mov_b64 exec, s[54:55]
    s_cbranch_scc0 L2_d47
    s_mov_b64 exec, s[82:83]
    s_nop 1
    v_mfma_f32_4x4x4_16b_bf16 v[88:91], v[12:13], v[84:85], 0
    s_nop 1
    v_mfma_f32_4x4x4_16b_bf16 v[88:91], v[10:11], v[86:87], v[88:91]
    s_nop 4
    v_cvt_pk_bf16_f32 v88, v88, v89
    v_cvt_pk_bf16_f32 v89, v90, v91
    ds_pk_add_bf16 v7, v88 offset:65408
    ds_pk_add_bf16 v7, v89 offset:65412
    s_mov_b64 exec, s[54:55]
    s_branch L2_d47
L2_c48:
    s_lshl_b64 s[52:53], s[82:83], 1
    s_andn2_b64 s[52:53], s[52:53], s[80:81]
    s_andn2_b64 s[52:53], s[52:53], s[50:51]
    s_or_b64 s[80:81], s[80:81], s[52:53]
    s_not_b64 vcc, s[52:53]
    s_mov_b64 exec, -1
    v_cndmask_b32_dpp v84, v84, v84, vcc wave_shr:1 row_mask:0xf bank_mask:0xf
    v_cndmask_b32_dpp v85, v85, v85, vcc wave_shr:1 row_mask:0xf bank_mask:0xf
    s_lshr_b64 s[52:53], s[52:53], 1
    v_cndmask_b32_dpp v86, v86, v86, vcc wave_shr:1 row_mask:0xf bank_mask:0xf
    v_cndmask_b32_dpp v87, v87, v87, vcc wave_shr:1 row_mask:0xf bank_mask:0xf
    s_andn2_b64 s[82:83], s[82:83], s[52:53]
    v_cndmask_b32_dpp v7, v7, v7, vcc wave_shr:1 row_mask:0xf bank_mask:0xf
    s_mov_b64 exec, s[50:51]
    s_cbranch_scc0 L2_d48
    s_mov_b64 exec, s[82:83]
    s_nop 1
    v_mfma_f32_4x4x4_16b_bf16 v[88:91], v[12:13], v[84:85], 0
    s_nop 1
    v_mfma_f32_4x4x4_16b_bf16 v[88:91], v[10:11], v[86:87], v[88:91]
    s_nop 4
    v_cvt_pk_bf16_f32 v88, v88, v89
    v_cvt_pk_bf16_f32 v89, v90, v91
    ds_pk_add_bf16 v7, v88 offset:65408
    ds_pk_add_bf16 v7, v89 offset:65412
    s_mov_b64 exec, s[50:51]
    s_branch L2_d48
L2_c49:
    s_lshl_b64 s[52:53], s[82:83], 1
    s_andn2_b64 s[52:53], s[52:53], s[80:81]
    s_andn2_b64 s[52:53], s[52:53], s[54:55]
    s_or_b64 s[80:81], s[80:81], s[52:53]
    s_not_b64 vcc, s[52:53]
    s_mov_b64 exec, -1
    v_cndmask_b32_dpp v84, v84, v84, vcc wave_shr:1 row_mask:0xf bank_mask:0xf
    v_cndmask_b32_dpp v85, v85, v85, vcc wave_shr:1 row_mask:0xf bank_mask:0xf
    s_lshr_b64 s[52:53], s[52:53], 1
    v_cndmask_b32_dpp v86, v86, v86, vcc wave_shr:1 row_mask:0xf bank_mask:0xf
    v_cndmask_b32_dpp v87, v87, v87, vcc wave_shr:1 row_mask:0xf bank_mask:0xf
    s_andn2_b64 s[82:83], s[82:83], s[52:53]
    v_cndmask_b32_dpp v7, v7, v7, vcc wave_shr:1 row_mask:0xf bank_mask:0xf
    s_mov_b64 exec, s[54:55]
    s_cbranch_scc0 L2_d49
    s_mov_b64 exec, s[82:83]
    s_nop 1
    v_mfma_f32_4x4x4_16b_bf16 v[88:91], v[12:13], v[84:85], 0
    s_nop 1
    v_mfma_f32_4x4x4_16b_bf16 v[88:91], v[10:11], v[86:87], v[88:91]
    s_nop 4
    v_cvt_pk_bf16_f32 v88, v88, v89
    v_cvt_pk_bf16_f32 v89, v90, v91
    ds_pk_add_bf16 v7, v88 offset:65408
    ds_pk_add_bf16 v7, v89 offset:65412
    s_mov_b64 exec, s[54:55]
    s_branch L2_d49
L2_c50:
    s_lshl_b64 s[52:53], s[82:83], 1
    s_andn2_b64 s[52:53], s[52:53], s[80:81]
    s_andn2_b64 s[52:53], s[52:53], s[50:51]
    s_or_b64 s[80:81], s[80:81], s[52:53]
    s_not_b64 vcc, s[52:53]
    s_mov_b64 exec, -1
    v_cndmask_b32_dpp v84, v84, v84, vcc wave_shr:1 row_mask:0xf bank_mask:0xf
    v_cndmask_b32_dpp v85, v85, v85, vcc wave_shr:1 row_mask:0xf bank_mask:0xf
    s_lshr_b64 s[52:53], s[52:53], 1
    v_cndmask_b32_dpp v86, v86, v86, vcc wave_shr:1 row_mask:0xf bank_mask:0xf
    v_cndmask_b32_dpp v87, v87, v87, vcc wave_shr:1 row_mask:0xf bank_mask:0xf
    s_andn2_b64 s[82:83], s[82:83], s[52:53]
    v_cndmask_b32_dpp v7, v7, v7, vcc wave_shr:1 row_mask:0xf bank_mask:0xf
    s_mov_b64 exec, s[50:51]
    s_cbranch_scc0 L2_d50
    s_mov_b64 exec, s[82:83]
    s_nop 1
    v_mfma_f32_4x4x4_16b_bf16 v[88:91], v[12:13], v[84:85], 0
    s_nop 1
    v_mfma_f32_4x4x4_16b_bf16 v[88:91], v[10:11], v[86:87], v[88:91]
    s_nop 4
    v_cvt_pk_bf16_f32 v88, v88, v89
    v_cvt_pk_bf16_f32 v89, v90, v91
    ds_pk_add_bf16 v7, v88 offset:65408
    ds_pk_add_bf16 v7, v89 offset:65412
    s_mov_b64 exec, s[50:51]
    s_branch L2_d50
L2_c51:
    s_lshl_b64 s[52:53], s[82:83], 1
    s_andn2_b64 s[52:53], s[52:53], s[80:81]
    s_andn2_b64 s[52:53], s[52:53], s[54:55]
    s_or_b64 s[80:81], s[80:81], s[52:53]
    s_not_b64 vcc, s[52:53]
    s_mov_b64 exec, -1
    v_cndmask_b32_dpp v84, v84, v84, vcc wave_shr:1 row_mask:0xf bank_mask:0xf
    v_cndmask_b32_dpp v85, v85, v85, vcc wave_shr:1 row_mask:0xf bank_mask:0xf
    s_lshr_b64 s[52:53], s[52:53], 1
    v_cndmask_b32_dpp v86, v86, v86, vcc wave_shr:1 row_mask:0xf bank_mask:0xf
    v_cndmask_b32_dpp v87, v87, v87, vcc wave_shr:1 row_mask:0xf bank_mask:0xf
    s_andn2_b64 s[82:83], s[82:83], s[52:53]
    v_cndmask_b32_dpp v7, v7, v7, vcc wave_shr:1 row_mask:0xf bank_mask:0xf
    s_mov_b64 exec, s[54:55]
    s_cbranch_scc0 L2_d51
    s_mov_b64 exec, s[82:83]
    s_nop 1
    v_mfma_f32_4x4x4_16b_bf16 v[88:91], v[12:13], v[84:85], 0
    s_nop 1
    v_mfma_f32_4x4x4_16b_bf16 v[88:91], v[10:11], v[86:87], v[88:91]
    s_nop 4
    v_cvt_pk_bf16_f32 v88, v88, v89
    v_cvt_pk_bf16_f32 v89, v90, v91
    ds_pk_add_bf16 v7, v88 offset:65408
    ds_pk_add_bf16 v7, v89 offset:65412
    s_mov_b64 exec, s[54:55]
    s_branch L2_d51
L2_c52:
    s_lshl_b64 s[52:53], s[82:83], 1
    s_andn2_b64 s[52:53], s[52:53], s[80:81]
    s_andn2_b64 s[52:53], s[52:53], s[50:51]
    s_or_b64 s[80:81], s[80:81], s[52:53]
    s_not_b64 vcc, s[52:53]
    s_mov_b64 exec, -1
    v_cndmask_b32_dpp v84, v84, v84, vcc wave_shr:1 row_mask:0xf bank_mask:0xf
    v_cndmask_b32_dpp v85, v85, v85, vcc wave_shr:1 row_mask:0xf bank_mask:0xf
    s_lshr_b64 s[52:53], s[52:53], 1
    v_cndmask_b32_dpp v86, v86, v86, vcc wave_shr:1 row_mask:0xf bank_mask:0xf
    v_cndmask_b32_dpp v87, v87, v87, vcc wave_shr:1 row_mask:0xf bank_mask:0xf
    s_andn2_b64 s[82:83], s[82:83], s[52:53]
    v_cndmask_b32_dpp v7, v7, v7, vcc wave_shr:1 row_mask:0xf bank_mask:0xf
    s_mov_b64 exec, s[50:51]
    s_cbranch_scc0 L2_d52
    s_mov_b64 exec, s[82:83]
    s_nop 1
    v_mfma_f32_4x4x4_16b_bf16 v[88:91], v[12:13], v[84:85], 0
    s_nop 1
    v_mfma_f32_4x4x4_16b_bf16 v[88:91], v[10:11], v[86:87], v[88:91]
    s_nop 4
    v_cvt_pk_bf16_f32 v88, v88, v89
    v_cvt_pk_bf16_f32 v89, v90, v91
    ds_pk_add_bf16 v7, v88 offset:65408
    ds_pk_add_bf16 v7, v89 offset:65412
    s_mov_b64 exec, s[50:51]
    s_branch L2_d52
L2_oa53:
    s_waitcnt vmcnt(3)
    s_mov_b64 exec, s[6:7]
    v_lshrrev_b32 v114, 16, v114
    s_mov_b64 exec, -1
    v_and_b32 v46, 0x10000000, v32
    v_cmpx_eq_u32 vcc, 0, v46
    v_lshrrev_b32 v47, 14, v112
    v_and_b32 v47, v5, v47
    ds_read_b64 v[96:97], v47
    v_perm_b32 v98, v112, v114, s44
    v_bitop3_b32 v99, v112, 0.5, -0.5 bitop3:0xa8
    v_bitop3_b32 v98, v6, v98, v99 bitop3:0xca
    v_and_b32 v47, v5, v112
    s_waitcnt lgkmcnt(0)
    v_mfma_f32_4x4x4_16b_bf16 v[88:91], v[8:9], v[96:97], 0
    s_nop 4
    v_mul_f32 v88, v98, v88
    v_mul_f32 v89, v98, v89
    v_mul_f32 v90, v98, v90
    v_mul_f32 v91, v98, v91
    v_cvt_pk_bf16_f32 v88, v88, v89
    v_cvt_pk_bf16_f32 v89, v90, v91
    ds_pk_add_bf16 v47, v88 offset:65408
    ds_pk_add_bf16 v47, v89 offset:65412
    s_mov_b64 exec, -1
    v_and_b32 v46, 0x20000000, v32
    v_cmpx_eq_u32 vcc, 0, v46
    v_lshrrev_b32 v47, 14, v113
    v_and_b32 v47, v5, v47
    ds_read_b64 v[96:97], v47
    v_perm_b32 v98, v113, v114, s45
    v_bitop3_b32 v99, v113, 0.5, -0.5 bitop3:0xa8
    v_bitop3_b32 v98, v6, v98, v99 bitop3:0xca
    v_and_b32 v47, v5, v113
    s_waitcnt lgkmcnt(0)
    v_mfma_f32_4x4x4_16b_bf16 v[88:91], v[8:9], v[96:97], 0
    s_nop 4
    v_mul_f32 v88, v98, v88
    v_mul_f32 v89, v98, v89
    v_mul_f32 v90, v98, v90
    v_mul_f32 v91, v98, v91
    v_cvt_pk_bf16_f32 v88, v88, v89
    v_cvt_pk_bf16_f32 v89, v90, v91
    ds_pk_add_bf16 v47, v88 offset:65408
    ds_pk_add_bf16 v47, v89 offset:65412
    s_mov_b64 exec, -1
    s_branch L2_ob53
L2_xo54:
    v_cmp_lt_u32 vcc, 20, v99
    s_mov_b32 s101, 1
    s_cbranch_vccz L2_xp54
    v_cmp_lt_u32 vcc, 32, v99
    v_cmp_lt_u32 s[58:59], 31, v88
    s_mov_b32 s101, 2
    s_or_b64 vcc, vcc, s[58:59]
    s_cbranch_scc0 L2_xp54
    s_mov_b32 s37, 0x10000
    s_branch L2_xp54
L2_c55:
    s_lshl_b64 s[52:53], s[82:83], 1
    s_andn2_b64 s[52:53], s[52:53], s[80:81]
    s_andn2_b64 s[52:53], s[52:53], s[54:55]
    s_or_b64 s[80:81], s[80:81], s[52:53]
    s_not_b64 vcc, s[52:53]
    s_mov_b64 exec, -1
    v_cndmask_b32_dpp v84, v84, v84, vcc wave_shr:1 row_mask:0xf bank_mask:0xf
    v_cndmask_b32_dpp v85, v85, v85, vcc wave_shr:1 row_mask:0xf bank_mask:0xf
    s_lshr_b64 s[52:53], s[52:53], 1
    v_cndmask_b32_dpp v86, v86, v86, vcc wave_shr:1 row_mask:0xf bank_mask:0xf
    v_cndmask_b32_dpp v87, v87, v87, vcc wave_shr:1 row_mask:0xf bank_mask:0xf
    s_andn2_b64 s[82:83], s[82:83], s[52:53]
    v_cndmask_b32_dpp v7, v7, v7, vcc wave_shr:1 row_mask:0xf bank_mask:0xf
    s_mov_b64 exec, s[54:55]
    s_cbranch_scc0 L2_d55
    s_mov_b64 exec, s[82:83]
    s_nop 1
    v_mfma_f32_4x4x4_16b_bf16 v[88:91], v[12:13], v[84:85], 0
    s_nop 1
    v_mfma_f32_4x4x4_16b_bf16 v[88:91], v[10:11], v[86:87], v[88:91]
    s_nop 4
    v_cvt_pk_bf16_f32 v88, v88, v89
    v_cvt_pk_bf16_f32 v89, v90, v91
    ds_pk_add_bf16 v7, v88 offset:65408
    ds_pk_add_bf16 v7, v89 offset:65412
    s_mov_b64 exec, s[54:55]
    s_branch L2_d55
L2_c56:
    s_lshl_b64 s[52:53], s[82:83], 1
    s_andn2_b64 s[52:53], s[52:53], s[80:81]
    s_andn2_b64 s[52:53], s[52:53], s[50:51]
    s_or_b64 s[80:81], s[80:81], s[52:53]
    s_not_b64 vcc, s[52:53]
    s_mov_b64 exec, -1
    v_cndmask_b32_dpp v84, v84, v84, vcc wave_shr:1 row_mask:0xf bank_mask:0xf
    v_cndmask_b32_dpp v85, v85, v85, vcc wave_shr:1 row_mask:0xf bank_mask:0xf
    s_lshr_b64 s[52:53], s[52:53], 1
    v_cndmask_b32_dpp v86, v86, v86, vcc wave_shr:1 row_mask:0xf bank_mask:0xf
    v_cndmask_b32_dpp v87, v87, v87, vcc wave_shr:1 row_mask:0xf bank_mask:0xf
    s_andn2_b64 s[82:83], s[82:83], s[52:53]
    v_cndmask_b32_dpp v7, v7, v7, vcc wave_shr:1 row_mask:0xf bank_mask:0xf
    s_mov_b64 exec, s[50:51]
    s_cbranch_scc0 L2_d56
    s_mov_b64 exec, s[82:83]
    s_nop 1
    v_mfma_f32_4x4x4_16b_bf16 v[88:91], v[12:13], v[84:85], 0
    s_nop 1
    v_mfma_f32_4x4x4_16b_bf16 v[88:91], v[10:11], v[86:87], v[88:91]
    s_nop 4
    v_cvt_pk_bf16_f32 v88, v88, v89
    v_cvt_pk_bf16_f32 v89, v90, v91
    ds_pk_add_bf16 v7, v88 offset:65408
    ds_pk_add_bf16 v7, v89 offset:65412
    s_mov_b64 exec, s[50:51]
    s_branch L2_d56
L2_c57:
    s_lshl_b64 s[52:53], s[82:83], 1
    s_andn2_b64 s[52:53], s[52:53], s[80:81]
    s_andn2_b64 s[52:53], s[52:53], s[54:55]
    s_or_b64 s[80:81], s[80:81], s[52:53]
    s_not_b64 vcc, s[52:53]
    s_mov_b64 exec, -1
    v_cndmask_b32_dpp v84, v84, v84, vcc wave_shr:1 row_mask:0xf bank_mask:0xf
    v_cndmask_b32_dpp v85, v85, v85, vcc wave_shr:1 row_mask:0xf bank_mask:0xf
    s_lshr_b64 s[52:53], s[52:53], 1
    v_cndmask_b32_dpp v86, v86, v86, vcc wave_shr:1 row_mask:0xf bank_mask:0xf
    v_cndmask_b32_dpp v87, v87, v87, vcc wave_shr:1 row_mask:0xf bank_mask:0xf
    s_andn2_b64 s[82:83], s[82:83], s[52:53]
    v_cndmask_b32_dpp v7, v7, v7, vcc wave_shr:1 row_mask:0xf bank_mask:0xf
    s_mov_b64 exec, s[54:55]
    s_cbranch_scc0 L2_d57
    s_mov_b64 exec, s[82:83]
    s_nop 1
    v_mfma_f32_4x4x4_16b_bf16 v[88:91], v[12:13], v[84:85], 0
    s_nop 1
    v_mfma_f32_4x4x4_16b_bf16 v[88:91], v[10:11], v[86:87], v[88:91]
    s_nop 4
    v_cvt_pk_bf16_f32 v88, v88, v89
    v_cvt_pk_bf16_f32 v89, v90, v91
    ds_pk_add_bf16 v7, v88 offset:65408
    ds_pk_add_bf16 v7, v89 offset:65412
    s_mov_b64 exec, s[54:55]
    s_branch L2_d57
L2_c58:
    s_lshl_b64 s[52:53], s[82:83], 1
    s_andn2_b64 s[52:53], s[52:53], s[80:81]
    s_andn2_b64 s[52:53], s[52:53], s[50:51]
    s_or_b64 s[80:81], s[80:81], s[52:53]
    s_not_b64 vcc, s[52:53]
    s_mov_b64 exec, -1
    v_cndmask_b32_dpp v84, v84, v84, vcc wave_shr:1 row_mask:0xf bank_mask:0xf
    v_cndmask_b32_dpp v85, v85, v85, vcc wave_shr:1 row_mask:0xf bank_mask:0xf
    s_lshr_b64 s[52:53], s[52:53], 1
    v_cndmask_b32_dpp v86, v86, v86, vcc wave_shr:1 row_mask:0xf bank_mask:0xf
    v_cndmask_b32_dpp v87, v87, v87, vcc wave_shr:1 row_mask:0xf bank_mask:0xf
    s_andn2_b64 s[82:83], s[82:83], s[52:53]
    v_cndmask_b32_dpp v7, v7, v7, vcc wave_shr:1 row_mask:0xf bank_mask:0xf
    s_mov_b64 exec, s[50:51]
    s_cbranch_scc0 L2_d58
    s_mov_b64 exec, s[82:83]
    s_nop 1
    v_mfma_f32_4x4x4_16b_bf16 v[88:91], v[12:13], v[84:85], 0
    s_nop 1
    v_mfma_f32_4x4x4_16b_bf16 v[88:91], v[10:11], v[86:87], v[88:91]
    s_nop 4
    v_cvt_pk_bf16_f32 v88, v88, v89
    v_cvt_pk_bf16_f32 v89, v90, v91
    ds_pk_add_bf16 v7, v88 offset:65408
    ds_pk_add_bf16 v7, v89 offset:65412
    s_mov_b64 exec, s[50:51]
    s_branch L2_d58
L2_c59:
    s_lshl_b64 s[52:53], s[82:83], 1
    s_andn2_b64 s[52:53], s[52:53], s[80:81]
    s_andn2_b64 s[52:53], s[52:53], s[54:55]
    s_or_b64 s[80:81], s[80:81], s[52:53]
    s_not_b64 vcc, s[52:53]
    s_mov_b64 exec, -1
    v_cndmask_b32_dpp v84, v84, v84, vcc wave_shr:1 row_mask:0xf bank_mask:0xf
    v_cndmask_b32_dpp v85, v85, v85, vcc wave_shr:1 row_mask:0xf bank_mask:0xf
    s_lshr_b64 s[52:53], s[52:53], 1
    v_cndmask_b32_dpp v86, v86, v86, vcc wave_shr:1 row_mask:0xf bank_mask:0xf
    v_cndmask_b32_dpp v87, v87, v87, vcc wave_shr:1 row_mask:0xf bank_mask:0xf
    s_andn2_b64 s[82:83], s[82:83], s[52:53]
    v_cndmask_b32_dpp v7, v7, v7, vcc wave_shr:1 row_mask:0xf bank_mask:0xf
    s_mov_b64 exec, s[54:55]
    s_cbranch_scc0 L2_d59
    s_mov_b64 exec, s[82:83]
    s_nop 1
    v_mfma_f32_4x4x4_16b_bf16 v[88:91], v[12:13], v[84:85], 0
    s_nop 1
    v_mfma_f32_4x4x4_16b_bf16 v[88:91], v[10:11], v[86:87], v[88:91]
    s_nop 4
    v_cvt_pk_bf16_f32 v88, v88, v89
    v_cvt_pk_bf16_f32 v89, v90, v91
    ds_pk_add_bf16 v7, v88 offset:65408
    ds_pk_add_bf16 v7, v89 offset:65412
    s_mov_b64 exec, s[54:55]
    s_branch L2_d59
L2_c60:
    s_lshl_b64 s[52:53], s[82:83], 1
    s_andn2_b64 s[52:53], s[52:53], s[80:81]
    s_andn2_b64 s[52:53], s[52:53], s[50:51]
    s_or_b64 s[80:81], s[80:81], s[52:53]
    s_not_b64 vcc, s[52:53]
    s_mov_b64 exec, -1
    v_cndmask_b32_dpp v84, v84, v84, vcc wave_shr:1 row_mask:0xf bank_mask:0xf
    v_cndmask_b32_dpp v85, v85, v85, vcc wave_shr:1 row_mask:0xf bank_mask:0xf
    s_lshr_b64 s[52:53], s[52:53], 1
    v_cndmask_b32_dpp v86, v86, v86, vcc wave_shr:1 row_mask:0xf bank_mask:0xf
    v_cndmask_b32_dpp v87, v87, v87, vcc wave_shr:1 row_mask:0xf bank_mask:0xf
    s_andn2_b64 s[82:83], s[82:83], s[52:53]
    v_cndmask_b32_dpp v7, v7, v7, vcc wave_shr:1 row_mask:0xf bank_mask:0xf
    s_mov_b64 exec, s[50:51]
    s_cbranch_scc0 L2_d60
    s_mov_b64 exec, s[82:83]
    s_nop 1
    v_mfma_f32_4x4x4_16b_bf16 v[88:91], v[12:13], v[84:85], 0
    s_nop 1
    v_mfma_f32_4x4x4_16b_bf16 v[88:91], v[10:11], v[86:87], v[88:91]
    s_nop 4
    v_cvt_pk_bf16_f32 v88, v88, v89
    v_cvt_pk_bf16_f32 v89, v90, v91
    ds_pk_add_bf16 v7, v88 offset:65408
    ds_pk_add_bf16 v7, v89 offset:65412
    s_mov_b64 exec, s[50:51]
    s_branch L2_d60
L2_xa61:
    s_cmp_eq_u32 s101, 1
    s_cbranch_scc1 L2_xc61
    v_lshlrev_b32 v89, 0, v96
    v_add_u32 v90, 140, v97
    v_bitop3_b32 v90, v89, v45, v90 bitop3:0x6a
    ds_write_b32 v98, v90 offset:28
    v_lshlrev_b32 v89, 4, v96
    v_add_u32 v90, 120, v97
    v_bitop3_b32 v90, v89, v45, v90 bitop3:0x6a
    ds_write_b32 v98, v90 offset:24
    v_lshlrev_b32 v89, 8, v96
    v_add_u32 v90, 100, v97
    v_bitop3_b32 v90, v89, v45, v90 bitop3:0x6a
    ds_write_b32 v98, v90 offset:20
L2_xc61:
    v_lshlrev_b32 v89, 12, v96
    v_add_u32 v90, 80, v97
    v_bitop3_b32 v90, v89, v45, v90 bitop3:0x6a
    ds_write_b32 v98, v90 offset:16
    s_branch L2_xb61
L2_xe61:
    v_cmp_lt_u32 vcc, 32, v99
    v_cmp_lt_u32 s[58:59], 31, v88
    v_lshrrev_b32 v89, 16, v96
    v_add_u32 v97, 80, v97
    s_or_b64 vcc, vcc, s[58:59]
    s_cbranch_scc1 L2_xs61
    v_lshlrev_b32 v89, v1, v89
    v_and_b32 v89, v45, v89
    v_cmp_ne_u32 vcc, 0, v89
    v_xor_b32 v90, v97, v89
    s_add_u32 s3, s37, s38
    v_mbcnt_lo_u32_b32 v98, vcc_lo, 0
    v_mbcnt_hi_u32_b32 v98, vcc_hi, v98
    s_bcnt1_i32_b64 s41, vcc
    v_lshl_add_u32 v98, v98, 2, s3
    s_mov_b64 exec, vcc
    ds_write_b32 v98, v90
    s_mov_b64 exec, -1
    s_lshl2_add_u32 s37, s41, s37
    s_branch L2_xr61
L2_xf61:
    s_waitcnt lgkmcnt(0)
    s_cmp_gt_u32 s37, 1024
    s_cbranch_scc1 L2_xs61
    s_cmp_lt_u32 s37, 768
    s_cbranch_scc1 L2_xl61
    ds_read_b32 v32, v98 offset:896
    s_add_u32 s3, s42, 2
    s_bitset1_b32 s43, s3
    s_branch L2_xg61
L2_xl61:
    v_mov_b32 v42, -1
    s_cmp_ge_u32 s37, 512
    s_cbranch_scc1 L2_xg61
    v_mov_b32 v43, -1
    s_cmp_ge_u32 s37, 256
    s_cbranch_scc1 L2_xg61
    v_mov_b32 v41, -1
    s_branch L2_xg61
L2_xs61:
    s_waitcnt lgkmcnt(0)
    v_mov_b32 v40, -1
    v_mov_b32 v41, -1
    v_mov_b32 v43, -1
    v_mov_b32 v42, -1
    s_add_u32 s3, s42, 2
    s_bitset1_b32 s36, s3
    s_branch L2_xg61
L2_c62:
    s_lshl_b64 s[52:53], s[82:83], 1
    s_andn2_b64 s[52:53], s[52:53], s[80:81]
    s_andn2_b64 s[52:53], s[52:53], s[54:55]
    s_or_b64 s[80:81], s[80:81], s[52:53]
    s_not_b64 vcc, s[52:53]
    s_mov_b64 exec, -1
    v_cndmask_b32_dpp v84, v84, v84, vcc wave_shr:1 row_mask:0xf bank_mask:0xf
    v_cndmask_b32_dpp v85, v85, v85, vcc wave_shr:1 row_mask:0xf bank_mask:0xf
    s_lshr_b64 s[52:53], s[52:53], 1
    v_cndmask_b32_dpp v86, v86, v86, vcc wave_shr:1 row_mask:0xf bank_mask:0xf
    v_cndmask_b32_dpp v87, v87, v87, vcc wave_shr:1 row_mask:0xf bank_mask:0xf
    s_andn2_b64 s[82:83], s[82:83], s[52:53]
    v_cndmask_b32_dpp v7, v7, v7, vcc wave_shr:1 row_mask:0xf bank_mask:0xf
    s_mov_b64 exec, s[54:55]
    s_cbranch_scc0 L2_d62
    s_mov_b64 exec, s[82:83]
    s_nop 1
    v_mfma_f32_4x4x4_16b_bf16 v[88:91], v[12:13], v[84:85], 0
    s_nop 1
    v_mfma_f32_4x4x4_16b_bf16 v[88:91], v[10:11], v[86:87], v[88:91]
    s_nop 4
    v_cvt_pk_bf16_f32 v88, v88, v89
    v_cvt_pk_bf16_f32 v89, v90, v91
    ds_pk_add_bf16 v7, v88 offset:65408
    ds_pk_add_bf16 v7, v89 offset:65412
    s_mov_b64 exec, s[54:55]
    s_branch L2_d62
L2_c63:
    s_lshl_b64 s[52:53], s[82:83], 1
    s_andn2_b64 s[52:53], s[52:53], s[80:81]
    s_andn2_b64 s[52:53], s[52:53], s[50:51]
    s_or_b64 s[80:81], s[80:81], s[52:53]
    s_not_b64 vcc, s[52:53]
    s_mov_b64 exec, -1
    v_cndmask_b32_dpp v84, v84, v84, vcc wave_shr:1 row_mask:0xf bank_mask:0xf
    v_cndmask_b32_dpp v85, v85, v85, vcc wave_shr:1 row_mask:0xf bank_mask:0xf
    s_lshr_b64 s[52:53], s[52:53], 1
    v_cndmask_b32_dpp v86, v86, v86, vcc wave_shr:1 row_mask:0xf bank_mask:0xf
    v_cndmask_b32_dpp v87, v87, v87, vcc wave_shr:1 row_mask:0xf bank_mask:0xf
    s_andn2_b64 s[82:83], s[82:83], s[52:53]
    v_cndmask_b32_dpp v7, v7, v7, vcc wave_shr:1 row_mask:0xf bank_mask:0xf
    s_mov_b64 exec, s[50:51]
    s_cbranch_scc0 L2_d63
    s_mov_b64 exec, s[82:83]
    s_nop 1
    v_mfma_f32_4x4x4_16b_bf16 v[88:91], v[12:13], v[84:85], 0
    s_nop 1
    v_mfma_f32_4x4x4_16b_bf16 v[88:91], v[10:11], v[86:87], v[88:91]
    s_nop 4
    v_cvt_pk_bf16_f32 v88, v88, v89
    v_cvt_pk_bf16_f32 v89, v90, v91
    ds_pk_add_bf16 v7, v88 offset:65408
    ds_pk_add_bf16 v7, v89 offset:65412
    s_mov_b64 exec, s[50:51]
    s_branch L2_d63
L2_oa64:
    v_and_b32 v47, 0x0fffffff, v33
    buffer_load_dword v114, v47, s[8:11], 0 offen offset:16
    s_mov_b64 exec, s[6:7]
    v_add_u32 v47, 8, v47
    v_lshrrev_b32 v33, 2, v33
    s_mov_b64 exec, -1
    buffer_load_dwordx2 v[112:113], v47, s[8:11], 0 offen
    s_branch L2_ob64
L2_c65:
    s_lshl_b64 s[52:53], s[82:83], 1
    s_andn2_b64 s[52:53], s[52:53], s[80:81]
    s_andn2_b64 s[52:53], s[52:53], s[54:55]
    s_or_b64 s[80:81], s[80:81], s[52:53]
    s_not_b64 vcc, s[52:53]
    s_mov_b64 exec, -1
    v_cndmask_b32_dpp v84, v84, v84, vcc wave_shr:1 row_mask:0xf bank_mask:0xf
    v_cndmask_b32_dpp v85, v85, v85, vcc wave_shr:1 row_mask:0xf bank_mask:0xf
    s_lshr_b64 s[52:53], s[52:53], 1
    v_cndmask_b32_dpp v86, v86, v86, vcc wave_shr:1 row_mask:0xf bank_mask:0xf
    v_cndmask_b32_dpp v87, v87, v87, vcc wave_shr:1 row_mask:0xf bank_mask:0xf
    s_andn2_b64 s[82:83], s[82:83], s[52:53]
    v_cndmask_b32_dpp v7, v7, v7, vcc wave_shr:1 row_mask:0xf bank_mask:0xf
    s_mov_b64 exec, s[54:55]
    s_cbranch_scc0 L2_d65
    s_mov_b64 exec, s[82:83]
    s_nop 1
    v_mfma_f32_4x4x4_16b_bf16 v[88:91], v[12:13], v[84:85], 0
    s_nop 1
    v_mfma_f32_4x4x4_16b_bf16 v[88:91], v[10:11], v[86:87], v[88:91]
    s_nop 4
    v_cvt_pk_bf16_f32 v88, v88, v89
    v_cvt_pk_bf16_f32 v89, v90, v91
    ds_pk_add_bf16 v7, v88 offset:65408
    ds_pk_add_bf16 v7, v89 offset:65412
    s_mov_b64 exec, s[54:55]
    s_branch L2_d65
L2_c66:
    s_lshl_b64 s[52:53], s[82:83], 1
    s_andn2_b64 s[52:53], s[52:53], s[80:81]
    s_andn2_b64 s[52:53], s[52:53], s[50:51]
    s_or_b64 s[80:81], s[80:81], s[52:53]
    s_not_b64 vcc, s[52:53]
    s_mov_b64 exec, -1
    v_cndmask_b32_dpp v84, v84, v84, vcc wave_shr:1 row_mask:0xf bank_mask:0xf
    v_cndmask_b32_dpp v85, v85, v85, vcc wave_shr:1 row_mask:0xf bank_mask:0xf
    s_lshr_b64 s[52:53], s[52:53], 1
    v_cndmask_b32_dpp v86, v86, v86, vcc wave_shr:1 row_mask:0xf bank_mask:0xf
    v_cndmask_b32_dpp v87, v87, v87, vcc wave_shr:1 row_mask:0xf bank_mask:0xf
    s_andn2_b64 s[82:83], s[82:83], s[52:53]
    v_cndmask_b32_dpp v7, v7, v7, vcc wave_shr:1 row_mask:0xf bank_mask:0xf
    s_mov_b64 exec, s[50:51]
    s_cbranch_scc0 L2_d66
    s_mov_b64 exec, s[82:83]
    s_nop 1
    v_mfma_f32_4x4x4_16b_bf16 v[88:91], v[12:13], v[84:85], 0
    s_nop 1
    v_mfma_f32_4x4x4_16b_bf16 v[88:91], v[10:11], v[86:87], v[88:91]
    s_nop 4
    v_cvt_pk_bf16_f32 v88, v88, v89
    v_cvt_pk_bf16_f32 v89, v90, v91
    ds_pk_add_bf16 v7, v88 offset:65408
    ds_pk_add_bf16 v7, v89 offset:65412
    s_mov_b64 exec, s[50:51]
    s_branch L2_d66
L2_c67:
    s_lshl_b64 s[52:53], s[82:83], 1
    s_andn2_b64 s[52:53], s[52:53], s[80:81]
    s_andn2_b64 s[52:53], s[52:53], s[54:55]
    s_or_b64 s[80:81], s[80:81], s[52:53]
    s_not_b64 vcc, s[52:53]
    s_mov_b64 exec, -1
    v_cndmask_b32_dpp v84, v84, v84, vcc wave_shr:1 row_mask:0xf bank_mask:0xf
    v_cndmask_b32_dpp v85, v85, v85, vcc wave_shr:1 row_mask:0xf bank_mask:0xf
    s_lshr_b64 s[52:53], s[52:53], 1
    v_cndmask_b32_dpp v86, v86, v86, vcc wave_shr:1 row_mask:0xf bank_mask:0xf
    v_cndmask_b32_dpp v87, v87, v87, vcc wave_shr:1 row_mask:0xf bank_mask:0xf
    s_andn2_b64 s[82:83], s[82:83], s[52:53]
    v_cndmask_b32_dpp v7, v7, v7, vcc wave_shr:1 row_mask:0xf bank_mask:0xf
    s_mov_b64 exec, s[54:55]
    s_cbranch_scc0 L2_d67
    s_mov_b64 exec, s[82:83]
    s_nop 1
    v_mfma_f32_4x4x4_16b_bf16 v[88:91], v[12:13], v[84:85], 0
    s_nop 1
    v_mfma_f32_4x4x4_16b_bf16 v[88:91], v[10:11], v[86:87], v[88:91]
    s_nop 4
    v_cvt_pk_bf16_f32 v88, v88, v89
    v_cvt_pk_bf16_f32 v89, v90, v91
    ds_pk_add_bf16 v7, v88 offset:65408
    ds_pk_add_bf16 v7, v89 offset:65412
    s_mov_b64 exec, s[54:55]
    s_branch L2_d67
L2_c68:
    s_lshl_b64 s[52:53], s[82:83], 1
    s_andn2_b64 s[52:53], s[52:53], s[80:81]
    s_andn2_b64 s[52:53], s[52:53], s[50:51]
    s_or_b64 s[80:81], s[80:81], s[52:53]
    s_not_b64 vcc, s[52:53]
    s_mov_b64 exec, -1
    v_cndmask_b32_dpp v84, v84, v84, vcc wave_shr:1 row_mask:0xf bank_mask:0xf
    v_cndmask_b32_dpp v85, v85, v85, vcc wave_shr:1 row_mask:0xf bank_mask:0xf
    s_lshr_b64 s[52:53], s[52:53], 1
    v_cndmask_b32_dpp v86, v86, v86, vcc wave_shr:1 row_mask:0xf bank_mask:0xf
    v_cndmask_b32_dpp v87, v87, v87, vcc wave_shr:1 row_mask:0xf bank_mask:0xf
    s_andn2_b64 s[82:83], s[82:83], s[52:53]
    v_cndmask_b32_dpp v7, v7, v7, vcc wave_shr:1 row_mask:0xf bank_mask:0xf
    s_mov_b64 exec, s[50:51]
    s_cbranch_scc0 L2_d68
    s_mov_b64 exec, s[82:83]
    s_nop 1
    v_mfma_f32_4x4x4_16b_bf16 v[88:91], v[12:13], v[84:85], 0
    s_nop 1
    v_mfma_f32_4x4x4_16b_bf16 v[88:91], v[10:11], v[86:87], v[88:91]
    s_nop 4
    v_cvt_pk_bf16_f32 v88, v88, v89
    v_cvt_pk_bf16_f32 v89, v90, v91
    ds_pk_add_bf16 v7, v88 offset:65408
    ds_pk_add_bf16 v7, v89 offset:65412
    s_mov_b64 exec, s[50:51]
    s_branch L2_d68
L2_c69:
    s_lshl_b64 s[52:53], s[82:83], 1
    s_andn2_b64 s[52:53], s[52:53], s[80:81]
    s_andn2_b64 s[52:53], s[52:53], s[54:55]
    s_or_b64 s[80:81], s[80:81], s[52:53]
    s_not_b64 vcc, s[52:53]
    s_mov_b64 exec, -1
    v_cndmask_b32_dpp v84, v84, v84, vcc wave_shr:1 row_mask:0xf bank_mask:0xf
    v_cndmask_b32_dpp v85, v85, v85, vcc wave_shr:1 row_mask:0xf bank_mask:0xf
    s_lshr_b64 s[52:53], s[52:53], 1
    v_cndmask_b32_dpp v86, v86, v86, vcc wave_shr:1 row_mask:0xf bank_mask:0xf
    v_cndmask_b32_dpp v87, v87, v87, vcc wave_shr:1 row_mask:0xf bank_mask:0xf
    s_andn2_b64 s[82:83], s[82:83], s[52:53]
    v_cndmask_b32_dpp v7, v7, v7, vcc wave_shr:1 row_mask:0xf bank_mask:0xf
    s_mov_b64 exec, s[54:55]
    s_cbranch_scc0 L2_d69
    s_mov_b64 exec, s[82:83]
    s_nop 1
    v_mfma_f32_4x4x4_16b_bf16 v[88:91], v[12:13], v[84:85], 0
    s_nop 1
    v_mfma_f32_4x4x4_16b_bf16 v[88:91], v[10:11], v[86:87], v[88:91]
    s_nop 4
    v_cvt_pk_bf16_f32 v88, v88, v89
    v_cvt_pk_bf16_f32 v89, v90, v91
    ds_pk_add_bf16 v7, v88 offset:65408
    ds_pk_add_bf16 v7, v89 offset:65412
    s_mov_b64 exec, s[54:55]
    s_branch L2_d69
L2_c70:
    s_lshl_b64 s[52:53], s[82:83], 1
    s_andn2_b64 s[52:53], s[52:53], s[80:81]
    s_andn2_b64 s[52:53], s[52:53], s[50:51]
    s_or_b64 s[80:81], s[80:81], s[52:53]
    s_not_b64 vcc, s[52:53]
    s_mov_b64 exec, -1
    v_cndmask_b32_dpp v84, v84, v84, vcc wave_shr:1 row_mask:0xf bank_mask:0xf
    v_cndmask_b32_dpp v85, v85, v85, vcc wave_shr:1 row_mask:0xf bank_mask:0xf
    s_lshr_b64 s[52:53], s[52:53], 1
    v_cndmask_b32_dpp v86, v86, v86, vcc wave_shr:1 row_mask:0xf bank_mask:0xf
    v_cndmask_b32_dpp v87, v87, v87, vcc wave_shr:1 row_mask:0xf bank_mask:0xf
    s_andn2_b64 s[82:83], s[82:83], s[52:53]
    v_cndmask_b32_dpp v7, v7, v7, vcc wave_shr:1 row_mask:0xf bank_mask:0xf
    s_mov_b64 exec, s[50:51]
    s_cbranch_scc0 L2_d70
    s_mov_b64 exec, s[82:83]
    s_nop 1
    v_mfma_f32_4x4x4_16b_bf16 v[88:91], v[12:13], v[84:85], 0
    s_nop 1
    v_mfma_f32_4x4x4_16b_bf16 v[88:91], v[10:11], v[86:87], v[88:91]
    s_nop 4
    v_cvt_pk_bf16_f32 v88, v88, v89
    v_cvt_pk_bf16_f32 v89, v90, v91
    ds_pk_add_bf16 v7, v88 offset:65408
    ds_pk_add_bf16 v7, v89 offset:65412
    s_mov_b64 exec, s[50:51]
    s_branch L2_d70
L2_oa71:
    s_waitcnt vmcnt(3)
    s_mov_b64 exec, s[6:7]
    v_lshrrev_b32 v114, 16, v114
    s_mov_b64 exec, -1
    v_and_b32 v46, 0x10000000, v33
    v_cmpx_eq_u32 vcc, 0, v46
    v_lshrrev_b32 v47, 14, v112
    v_and_b32 v47, v5, v47
    ds_read_b64 v[96:97], v47
    v_perm_b32 v98, v112, v114, s44
    v_bitop3_b32 v99, v112, 0.5, -0.5 bitop3:0xa8
    v_bitop3_b32 v98, v6, v98, v99 bitop3:0xca
    v_and_b32 v47, v5, v112
    s_waitcnt lgkmcnt(0)
    v_mfma_f32_4x4x4_16b_bf16 v[88:91], v[8:9], v[96:97], 0
    s_nop 4
    v_mul_f32 v88, v98, v88
    v_mul_f32 v89, v98, v89
    v_mul_f32 v90, v98, v90
    v_mul_f32 v91, v98, v91
    v_cvt_pk_bf16_f32 v88, v88, v89
    v_cvt_pk_bf16_f32 v89, v90, v91
    ds_pk_add_bf16 v47, v88 offset:65408
    ds_pk_add_bf16 v47, v89 offset:65412
    s_mov_b64 exec, -1
    v_and_b32 v46, 0x20000000, v33
    v_cmpx_eq_u32 vcc, 0, v46
    v_lshrrev_b32 v47, 14, v113
    v_and_b32 v47, v5, v47
    ds_read_b64 v[96:97], v47
    v_perm_b32 v98, v113, v114, s45
    v_bitop3_b32 v99, v113, 0.5, -0.5 bitop3:0xa8
    v_bitop3_b32 v98, v6, v98, v99 bitop3:0xca
    v_and_b32 v47, v5, v113
    s_waitcnt lgkmcnt(0)
    v_mfma_f32_4x4x4_16b_bf16 v[88:91], v[8:9], v[96:97], 0
    s_nop 4
    v_mul_f32 v88, v98, v88
    v_mul_f32 v89, v98, v89
    v_mul_f32 v90, v98, v90
    v_mul_f32 v91, v98, v91
    v_cvt_pk_bf16_f32 v88, v88, v89
    v_cvt_pk_bf16_f32 v89, v90, v91
    ds_pk_add_bf16 v47, v88 offset:65408
    ds_pk_add_bf16 v47, v89 offset:65412
    s_mov_b64 exec, -1
    s_branch L2_ob71
L2_xo72:
    v_cmp_lt_u32 vcc, 20, v99
    s_mov_b32 s101, 1
    s_cbranch_vccz L2_xp72
    v_cmp_lt_u32 vcc, 32, v99
    v_cmp_lt_u32 s[58:59], 31, v88
    s_mov_b32 s101, 2
    s_or_b64 vcc, vcc, s[58:59]
    s_cbranch_scc0 L2_xp72
    s_mov_b32 s37, 0x10000
    s_branch L2_xp72
L2_c73:
    s_lshl_b64 s[52:53], s[82:83], 1
    s_andn2_b64 s[52:53], s[52:53], s[80:81]
    s_andn2_b64 s[52:53], s[52:53], s[54:55]
    s_or_b64 s[80:81], s[80:81], s[52:53]
    s_not_b64 vcc, s[52:53]
    s_mov_b64 exec, -1
    v_cndmask_b32_dpp v84, v84, v84, vcc wave_shr:1 row_mask:0xf bank_mask:0xf
    v_cndmask_b32_dpp v85, v85, v85, vcc wave_shr:1 row_mask:0xf bank_mask:0xf
    s_lshr_b64 s[52:53], s[52:53], 1
    v_cndmask_b32_dpp v86, v86, v86, vcc wave_shr:1 row_mask:0xf bank_mask:0xf
    v_cndmask_b32_dpp v87, v87, v87, vcc wave_shr:1 row_mask:0xf bank_mask:0xf
    s_andn2_b64 s[82:83], s[82:83], s[52:53]
    v_cndmask_b32_dpp v7, v7, v7, vcc wave_shr:1 row_mask:0xf bank_mask:0xf
    s_mov_b64 exec, s[54:55]
    s_cbranch_scc0 L2_d73
    s_mov_b64 exec, s[82:83]
    s_nop 1
    v_mfma_f32_4x4x4_16b_bf16 v[88:91], v[12:13], v[84:85], 0
    s_nop 1
    v_mfma_f32_4x4x4_16b_bf16 v[88:91], v[10:11], v[86:87], v[88:91]
    s_nop 4
    v_cvt_pk_bf16_f32 v88, v88, v89
    v_cvt_pk_bf16_f32 v89, v90, v91
    ds_pk_add_bf16 v7, v88 offset:65408
    ds_pk_add_bf16 v7, v89 offset:65412
    s_mov_b64 exec, s[54:55]
    s_branch L2_d73
L2_c74:
    s_lshl_b64 s[52:53], s[82:83], 1
    s_andn2_b64 s[52:53], s[52:53], s[80:81]
    s_andn2_b64 s[52:53], s[52:53], s[50:51]
    s_or_b64 s[80:81], s[80:81], s[52:53]
    s_not_b64 vcc, s[52:53]
    s_mov_b64 exec, -1
    v_cndmask_b32_dpp v84, v84, v84, vcc wave_shr:1 row_mask:0xf bank_mask:0xf
    v_cndmask_b32_dpp v85, v85, v85, vcc wave_shr:1 row_mask:0xf bank_mask:0xf
    s_lshr_b64 s[52:53], s[52:53], 1
    v_cndmask_b32_dpp v86, v86, v86, vcc wave_shr:1 row_mask:0xf bank_mask:0xf
    v_cndmask_b32_dpp v87, v87, v87, vcc wave_shr:1 row_mask:0xf bank_mask:0xf
    s_andn2_b64 s[82:83], s[82:83], s[52:53]
    v_cndmask_b32_dpp v7, v7, v7, vcc wave_shr:1 row_mask:0xf bank_mask:0xf
    s_mov_b64 exec, s[50:51]
    s_cbranch_scc0 L2_d74
    s_mov_b64 exec, s[82:83]
    s_nop 1
    v_mfma_f32_4x4x4_16b_bf16 v[88:91], v[12:13], v[84:85], 0
    s_nop 1
    v_mfma_f32_4x4x4_16b_bf16 v[88:91], v[10:11], v[86:87], v[88:91]
    s_nop 4
    v_cvt_pk_bf16_f32 v88, v88, v89
    v_cvt_pk_bf16_f32 v89, v90, v91
    ds_pk_add_bf16 v7, v88 offset:65408
    ds_pk_add_bf16 v7, v89 offset:65412
    s_mov_b64 exec, s[50:51]
    s_branch L2_d74
L2_c75:
    s_lshl_b64 s[52:53], s[82:83], 1
    s_andn2_b64 s[52:53], s[52:53], s[80:81]
    s_andn2_b64 s[52:53], s[52:53], s[54:55]
    s_or_b64 s[80:81], s[80:81], s[52:53]
    s_not_b64 vcc, s[52:53]
    s_mov_b64 exec, -1
    v_cndmask_b32_dpp v84, v84, v84, vcc wave_shr:1 row_mask:0xf bank_mask:0xf
    v_cndmask_b32_dpp v85, v85, v85, vcc wave_shr:1 row_mask:0xf bank_mask:0xf
    s_lshr_b64 s[52:53], s[52:53], 1
    v_cndmask_b32_dpp v86, v86, v86, vcc wave_shr:1 row_mask:0xf bank_mask:0xf
    v_cndmask_b32_dpp v87, v87, v87, vcc wave_shr:1 row_mask:0xf bank_mask:0xf
    s_andn2_b64 s[82:83], s[82:83], s[52:53]
    v_cndmask_b32_dpp v7, v7, v7, vcc wave_shr:1 row_mask:0xf bank_mask:0xf
    s_mov_b64 exec, s[54:55]
    s_cbranch_scc0 L2_d75
    s_mov_b64 exec, s[82:83]
    s_nop 1
    v_mfma_f32_4x4x4_16b_bf16 v[88:91], v[12:13], v[84:85], 0
    s_nop 1
    v_mfma_f32_4x4x4_16b_bf16 v[88:91], v[10:11], v[86:87], v[88:91]
    s_nop 4
    v_cvt_pk_bf16_f32 v88, v88, v89
    v_cvt_pk_bf16_f32 v89, v90, v91
    ds_pk_add_bf16 v7, v88 offset:65408
    ds_pk_add_bf16 v7, v89 offset:65412
    s_mov_b64 exec, s[54:55]
    s_branch L2_d75
L2_c76:
    s_lshl_b64 s[52:53], s[82:83], 1
    s_andn2_b64 s[52:53], s[52:53], s[80:81]
    s_andn2_b64 s[52:53], s[52:53], s[50:51]
    s_or_b64 s[80:81], s[80:81], s[52:53]
    s_not_b64 vcc, s[52:53]
    s_mov_b64 exec, -1
    v_cndmask_b32_dpp v84, v84, v84, vcc wave_shr:1 row_mask:0xf bank_mask:0xf
    v_cndmask_b32_dpp v85, v85, v85, vcc wave_shr:1 row_mask:0xf bank_mask:0xf
    s_lshr_b64 s[52:53], s[52:53], 1
    v_cndmask_b32_dpp v86, v86, v86, vcc wave_shr:1 row_mask:0xf bank_mask:0xf
    v_cndmask_b32_dpp v87, v87, v87, vcc wave_shr:1 row_mask:0xf bank_mask:0xf
    s_andn2_b64 s[82:83], s[82:83], s[52:53]
    v_cndmask_b32_dpp v7, v7, v7, vcc wave_shr:1 row_mask:0xf bank_mask:0xf
    s_mov_b64 exec, s[50:51]
    s_cbranch_scc0 L2_d76
    s_mov_b64 exec, s[82:83]
    s_nop 1
    v_mfma_f32_4x4x4_16b_bf16 v[88:91], v[12:13], v[84:85], 0
    s_nop 1
    v_mfma_f32_4x4x4_16b_bf16 v[88:91], v[10:11], v[86:87], v[88:91]
    s_nop 4
    v_cvt_pk_bf16_f32 v88, v88, v89
    v_cvt_pk_bf16_f32 v89, v90, v91
    ds_pk_add_bf16 v7, v88 offset:65408
    ds_pk_add_bf16 v7, v89 offset:65412
    s_mov_b64 exec, s[50:51]
    s_branch L2_d76
L2_c77:
    s_lshl_b64 s[52:53], s[82:83], 1
    s_andn2_b64 s[52:53], s[52:53], s[80:81]
    s_andn2_b64 s[52:53], s[52:53], s[54:55]
    s_or_b64 s[80:81], s[80:81], s[52:53]
    s_not_b64 vcc, s[52:53]
    s_mov_b64 exec, -1
    v_cndmask_b32_dpp v84, v84, v84, vcc wave_shr:1 row_mask:0xf bank_mask:0xf
    v_cndmask_b32_dpp v85, v85, v85, vcc wave_shr:1 row_mask:0xf bank_mask:0xf
    s_lshr_b64 s[52:53], s[52:53], 1
    v_cndmask_b32_dpp v86, v86, v86, vcc wave_shr:1 row_mask:0xf bank_mask:0xf
    v_cndmask_b32_dpp v87, v87, v87, vcc wave_shr:1 row_mask:0xf bank_mask:0xf
    s_andn2_b64 s[82:83], s[82:83], s[52:53]
    v_cndmask_b32_dpp v7, v7, v7, vcc wave_shr:1 row_mask:0xf bank_mask:0xf
    s_mov_b64 exec, s[54:55]
    s_cbranch_scc0 L2_d77
    s_mov_b64 exec, s[82:83]
    s_nop 1
    v_mfma_f32_4x4x4_16b_bf16 v[88:91], v[12:13], v[84:85], 0
    s_nop 1
    v_mfma_f32_4x4x4_16b_bf16 v[88:91], v[10:11], v[86:87], v[88:91]
    s_nop 4
    v_cvt_pk_bf16_f32 v88, v88, v89
    v_cvt_pk_bf16_f32 v89, v90, v91
    ds_pk_add_bf16 v7, v88 offset:65408
    ds_pk_add_bf16 v7, v89 offset:65412
    s_mov_b64 exec, s[54:55]
    s_branch L2_d77
L2_c78:
    s_lshl_b64 s[52:53], s[82:83], 1
    s_andn2_b64 s[52:53], s[52:53], s[80:81]
    s_andn2_b64 s[52:53], s[52:53], s[50:51]
    s_or_b64 s[80:81], s[80:81], s[52:53]
    s_not_b64 vcc, s[52:53]
    s_mov_b64 exec, -1
    v_cndmask_b32_dpp v84, v84, v84, vcc wave_shr:1 row_mask:0xf bank_mask:0xf
    v_cndmask_b32_dpp v85, v85, v85, vcc wave_shr:1 row_mask:0xf bank_mask:0xf
    s_lshr_b64 s[52:53], s[52:53], 1
    v_cndmask_b32_dpp v86, v86, v86, vcc wave_shr:1 row_mask:0xf bank_mask:0xf
    v_cndmask_b32_dpp v87, v87, v87, vcc wave_shr:1 row_mask:0xf bank_mask:0xf
    s_andn2_b64 s[82:83], s[82:83], s[52:53]
    v_cndmask_b32_dpp v7, v7, v7, vcc wave_shr:1 row_mask:0xf bank_mask:0xf
    s_mov_b64 exec, s[50:51]
    s_cbranch_scc0 L2_d78
    s_mov_b64 exec, s[82:83]
    s_nop 1
    v_mfma_f32_4x4x4_16b_bf16 v[88:91], v[12:13], v[84:85], 0
    s_nop 1
    v_mfma_f32_4x4x4_16b_bf16 v[88:91], v[10:11], v[86:87], v[88:91]
    s_nop 4
    v_cvt_pk_bf16_f32 v88, v88, v89
    v_cvt_pk_bf16_f32 v89, v90, v91
    ds_pk_add_bf16 v7, v88 offset:65408
    ds_pk_add_bf16 v7, v89 offset:65412
    s_mov_b64 exec, s[50:51]
    s_branch L2_d78
L2_xa79:
    s_cmp_eq_u32 s101, 1
    s_cbranch_scc1 L2_xc79
    v_lshlrev_b32 v89, 0, v96
    v_add_u32 v90, 140, v97
    v_bitop3_b32 v90, v89, v45, v90 bitop3:0x6a
    ds_write_b32 v98, v90 offset:28
    v_lshlrev_b32 v89, 4, v96
    v_add_u32 v90, 120, v97
    v_bitop3_b32 v90, v89, v45, v90 bitop3:0x6a
    ds_write_b32 v98, v90 offset:24
    v_lshlrev_b32 v89, 8, v96
    v_add_u32 v90, 100, v97
    v_bitop3_b32 v90, v89, v45, v90 bitop3:0x6a
    ds_write_b32 v98, v90 offset:20
L2_xc79:
    v_lshlrev_b32 v89, 12, v96
    v_add_u32 v90, 80, v97
    v_bitop3_b32 v90, v89, v45, v90 bitop3:0x6a
    ds_write_b32 v98, v90 offset:16
    s_branch L2_xb79
L2_xe79:
    v_cmp_lt_u32 vcc, 32, v99
    v_cmp_lt_u32 s[58:59], 31, v88
    v_lshrrev_b32 v89, 16, v96
    v_add_u32 v97, 80, v97
    s_or_b64 vcc, vcc, s[58:59]
    s_cbranch_scc1 L2_xs79
    v_lshlrev_b32 v89, v1, v89
    v_and_b32 v89, v45, v89
    v_cmp_ne_u32 vcc, 0, v89
    v_xor_b32 v90, v97, v89
    s_add_u32 s3, s37, s38
    v_mbcnt_lo_u32_b32 v98, vcc_lo, 0
    v_mbcnt_hi_u32_b32 v98, vcc_hi, v98
    s_bcnt1_i32_b64 s41, vcc
    v_lshl_add_u32 v98, v98, 2, s3
    s_mov_b64 exec, vcc
    ds_write_b32 v98, v90
    s_mov_b64 exec, -1
    s_lshl2_add_u32 s37, s41, s37
    s_branch L2_xr79
L2_xf79:
    s_waitcnt lgkmcnt(0)
    s_cmp_gt_u32 s37, 1024
    s_cbranch_scc1 L2_xs79
    s_cmp_lt_u32 s37, 768
    s_cbranch_scc1 L2_xl79
    ds_read_b32 v33, v98 offset:896
    s_add_u32 s3, s42, 2
    s_bitset1_b32 s43, s3
    s_branch L2_xg79
L2_xl79:
    v_mov_b32 v42, -1
    s_cmp_ge_u32 s37, 512
    s_cbranch_scc1 L2_xg79
    v_mov_b32 v43, -1
    s_cmp_ge_u32 s37, 256
    s_cbranch_scc1 L2_xg79
    v_mov_b32 v41, -1
    s_branch L2_xg79
L2_xs79:
    s_waitcnt lgkmcnt(0)
    v_mov_b32 v40, -1
    v_mov_b32 v41, -1
    v_mov_b32 v43, -1
    v_mov_b32 v42, -1
    s_add_u32 s3, s42, 2
    s_bitset1_b32 s36, s3
    s_branch L2_xg79
L2_c80:
    s_lshl_b64 s[52:53], s[82:83], 1
    s_andn2_b64 s[52:53], s[52:53], s[80:81]
    s_andn2_b64 s[52:53], s[52:53], s[54:55]
    s_or_b64 s[80:81], s[80:81], s[52:53]
    s_not_b64 vcc, s[52:53]
    s_mov_b64 exec, -1
    v_cndmask_b32_dpp v84, v84, v84, vcc wave_shr:1 row_mask:0xf bank_mask:0xf
    v_cndmask_b32_dpp v85, v85, v85, vcc wave_shr:1 row_mask:0xf bank_mask:0xf
    s_lshr_b64 s[52:53], s[52:53], 1
    v_cndmask_b32_dpp v86, v86, v86, vcc wave_shr:1 row_mask:0xf bank_mask:0xf
    v_cndmask_b32_dpp v87, v87, v87, vcc wave_shr:1 row_mask:0xf bank_mask:0xf
    s_andn2_b64 s[82:83], s[82:83], s[52:53]
    v_cndmask_b32_dpp v7, v7, v7, vcc wave_shr:1 row_mask:0xf bank_mask:0xf
    s_mov_b64 exec, s[54:55]
    s_cbranch_scc0 L2_d80
    s_mov_b64 exec, s[82:83]
    s_nop 1
    v_mfma_f32_4x4x4_16b_bf16 v[88:91], v[12:13], v[84:85], 0
    s_nop 1
    v_mfma_f32_4x4x4_16b_bf16 v[88:91], v[10:11], v[86:87], v[88:91]
    s_nop 4
    v_cvt_pk_bf16_f32 v88, v88, v89
    v_cvt_pk_bf16_f32 v89, v90, v91
    ds_pk_add_bf16 v7, v88 offset:65408
    ds_pk_add_bf16 v7, v89 offset:65412
    s_mov_b64 exec, s[54:55]
    s_branch L2_d80
L2_c81:
    s_lshl_b64 s[52:53], s[82:83], 1
    s_andn2_b64 s[52:53], s[52:53], s[80:81]
    s_andn2_b64 s[52:53], s[52:53], s[50:51]
    s_or_b64 s[80:81], s[80:81], s[52:53]
    s_not_b64 vcc, s[52:53]
    s_mov_b64 exec, -1
    v_cndmask_b32_dpp v84, v84, v84, vcc wave_shr:1 row_mask:0xf bank_mask:0xf
    v_cndmask_b32_dpp v85, v85, v85, vcc wave_shr:1 row_mask:0xf bank_mask:0xf
    s_lshr_b64 s[52:53], s[52:53], 1
    v_cndmask_b32_dpp v86, v86, v86, vcc wave_shr:1 row_mask:0xf bank_mask:0xf
    v_cndmask_b32_dpp v87, v87, v87, vcc wave_shr:1 row_mask:0xf bank_mask:0xf
    s_andn2_b64 s[82:83], s[82:83], s[52:53]
    v_cndmask_b32_dpp v7, v7, v7, vcc wave_shr:1 row_mask:0xf bank_mask:0xf
    s_mov_b64 exec, s[50:51]
    s_cbranch_scc0 L2_d81
    s_mov_b64 exec, s[82:83]
    s_nop 1
    v_mfma_f32_4x4x4_16b_bf16 v[88:91], v[12:13], v[84:85], 0
    s_nop 1
    v_mfma_f32_4x4x4_16b_bf16 v[88:91], v[10:11], v[86:87], v[88:91]
    s_nop 4
    v_cvt_pk_bf16_f32 v88, v88, v89
    v_cvt_pk_bf16_f32 v89, v90, v91
    ds_pk_add_bf16 v7, v88 offset:65408
    ds_pk_add_bf16 v7, v89 offset:65412
    s_mov_b64 exec, s[50:51]
    s_branch L2_d81
L2_oa82:
    v_and_b32 v47, 0x0fffffff, v32
    buffer_load_dword v114, v47, s[8:11], 0 offen offset:16
    s_mov_b64 exec, s[6:7]
    v_add_u32 v47, 8, v47
    v_lshrrev_b32 v32, 2, v32
    s_mov_b64 exec, -1
    buffer_load_dwordx2 v[112:113], v47, s[8:11], 0 offen
    s_branch L2_ob82
L2_c83:
    s_lshl_b64 s[52:53], s[82:83], 1
    s_andn2_b64 s[52:53], s[52:53], s[80:81]
    s_andn2_b64 s[52:53], s[52:53], s[54:55]
    s_or_b64 s[80:81], s[80:81], s[52:53]
    s_not_b64 vcc, s[52:53]
    s_mov_b64 exec, -1
    v_cndmask_b32_dpp v84, v84, v84, vcc wave_shr:1 row_mask:0xf bank_mask:0xf
    v_cndmask_b32_dpp v85, v85, v85, vcc wave_shr:1 row_mask:0xf bank_mask:0xf
    s_lshr_b64 s[52:53], s[52:53], 1
    v_cndmask_b32_dpp v86, v86, v86, vcc wave_shr:1 row_mask:0xf bank_mask:0xf
    v_cndmask_b32_dpp v87, v87, v87, vcc wave_shr:1 row_mask:0xf bank_mask:0xf
    s_andn2_b64 s[82:83], s[82:83], s[52:53]
    v_cndmask_b32_dpp v7, v7, v7, vcc wave_shr:1 row_mask:0xf bank_mask:0xf
    s_mov_b64 exec, s[54:55]
    s_cbranch_scc0 L2_d83
    s_mov_b64 exec, s[82:83]
    s_nop 1
    v_mfma_f32_4x4x4_16b_bf16 v[88:91], v[12:13], v[84:85], 0
    s_nop 1
    v_mfma_f32_4x4x4_16b_bf16 v[88:91], v[10:11], v[86:87], v[88:91]
    s_nop 4
    v_cvt_pk_bf16_f32 v88, v88, v89
    v_cvt_pk_bf16_f32 v89, v90, v91
    ds_pk_add_bf16 v7, v88 offset:65408
    ds_pk_add_bf16 v7, v89 offset:65412
    s_mov_b64 exec, s[54:55]
    s_branch L2_d83
L2_c84:
    s_lshl_b64 s[52:53], s[82:83], 1
    s_andn2_b64 s[52:53], s[52:53], s[80:81]
    s_andn2_b64 s[52:53], s[52:53], s[50:51]
    s_or_b64 s[80:81], s[80:81], s[52:53]
    s_not_b64 vcc, s[52:53]
    s_mov_b64 exec, -1
    v_cndmask_b32_dpp v84, v84, v84, vcc wave_shr:1 row_mask:0xf bank_mask:0xf
    v_cndmask_b32_dpp v85, v85, v85, vcc wave_shr:1 row_mask:0xf bank_mask:0xf
    s_lshr_b64 s[52:53], s[52:53], 1
    v_cndmask_b32_dpp v86, v86, v86, vcc wave_shr:1 row_mask:0xf bank_mask:0xf
    v_cndmask_b32_dpp v87, v87, v87, vcc wave_shr:1 row_mask:0xf bank_mask:0xf
    s_andn2_b64 s[82:83], s[82:83], s[52:53]
    v_cndmask_b32_dpp v7, v7, v7, vcc wave_shr:1 row_mask:0xf bank_mask:0xf
    s_mov_b64 exec, s[50:51]
    s_cbranch_scc0 L2_d84
    s_mov_b64 exec, s[82:83]
    s_nop 1
    v_mfma_f32_4x4x4_16b_bf16 v[88:91], v[12:13], v[84:85], 0
    s_nop 1
    v_mfma_f32_4x4x4_16b_bf16 v[88:91], v[10:11], v[86:87], v[88:91]
    s_nop 4
    v_cvt_pk_bf16_f32 v88, v88, v89
    v_cvt_pk_bf16_f32 v89, v90, v91
    ds_pk_add_bf16 v7, v88 offset:65408
    ds_pk_add_bf16 v7, v89 offset:65412
    s_mov_b64 exec, s[50:51]
    s_branch L2_d84
L2_c85:
    s_lshl_b64 s[52:53], s[82:83], 1
    s_andn2_b64 s[52:53], s[52:53], s[80:81]
    s_andn2_b64 s[52:53], s[52:53], s[54:55]
    s_or_b64 s[80:81], s[80:81], s[52:53]
    s_not_b64 vcc, s[52:53]
    s_mov_b64 exec, -1
    v_cndmask_b32_dpp v84, v84, v84, vcc wave_shr:1 row_mask:0xf bank_mask:0xf
    v_cndmask_b32_dpp v85, v85, v85, vcc wave_shr:1 row_mask:0xf bank_mask:0xf
    s_lshr_b64 s[52:53], s[52:53], 1
    v_cndmask_b32_dpp v86, v86, v86, vcc wave_shr:1 row_mask:0xf bank_mask:0xf
    v_cndmask_b32_dpp v87, v87, v87, vcc wave_shr:1 row_mask:0xf bank_mask:0xf
    s_andn2_b64 s[82:83], s[82:83], s[52:53]
    v_cndmask_b32_dpp v7, v7, v7, vcc wave_shr:1 row_mask:0xf bank_mask:0xf
    s_mov_b64 exec, s[54:55]
    s_cbranch_scc0 L2_d85
    s_mov_b64 exec, s[82:83]
    s_nop 1
    v_mfma_f32_4x4x4_16b_bf16 v[88:91], v[12:13], v[84:85], 0
    s_nop 1
    v_mfma_f32_4x4x4_16b_bf16 v[88:91], v[10:11], v[86:87], v[88:91]
    s_nop 4
    v_cvt_pk_bf16_f32 v88, v88, v89
    v_cvt_pk_bf16_f32 v89, v90, v91
    ds_pk_add_bf16 v7, v88 offset:65408
    ds_pk_add_bf16 v7, v89 offset:65412
    s_mov_b64 exec, s[54:55]
    s_branch L2_d85
L2_c86:
    s_lshl_b64 s[52:53], s[82:83], 1
    s_andn2_b64 s[52:53], s[52:53], s[80:81]
    s_andn2_b64 s[52:53], s[52:53], s[50:51]
    s_or_b64 s[80:81], s[80:81], s[52:53]
    s_not_b64 vcc, s[52:53]
    s_mov_b64 exec, -1
    v_cndmask_b32_dpp v84, v84, v84, vcc wave_shr:1 row_mask:0xf bank_mask:0xf
    v_cndmask_b32_dpp v85, v85, v85, vcc wave_shr:1 row_mask:0xf bank_mask:0xf
    s_lshr_b64 s[52:53], s[52:53], 1
    v_cndmask_b32_dpp v86, v86, v86, vcc wave_shr:1 row_mask:0xf bank_mask:0xf
    v_cndmask_b32_dpp v87, v87, v87, vcc wave_shr:1 row_mask:0xf bank_mask:0xf
    s_andn2_b64 s[82:83], s[82:83], s[52:53]
    v_cndmask_b32_dpp v7, v7, v7, vcc wave_shr:1 row_mask:0xf bank_mask:0xf
    s_mov_b64 exec, s[50:51]
    s_cbranch_scc0 L2_d86
    s_mov_b64 exec, s[82:83]
    s_nop 1
    v_mfma_f32_4x4x4_16b_bf16 v[88:91], v[12:13], v[84:85], 0
    s_nop 1
    v_mfma_f32_4x4x4_16b_bf16 v[88:91], v[10:11], v[86:87], v[88:91]
    s_nop 4
    v_cvt_pk_bf16_f32 v88, v88, v89
    v_cvt_pk_bf16_f32 v89, v90, v91
    ds_pk_add_bf16 v7, v88 offset:65408
    ds_pk_add_bf16 v7, v89 offset:65412
    s_mov_b64 exec, s[50:51]
    s_branch L2_d86
L2_c87:
    s_lshl_b64 s[52:53], s[82:83], 1
    s_andn2_b64 s[52:53], s[52:53], s[80:81]
    s_andn2_b64 s[52:53], s[52:53], s[54:55]
    s_or_b64 s[80:81], s[80:81], s[52:53]
    s_not_b64 vcc, s[52:53]
    s_mov_b64 exec, -1
    v_cndmask_b32_dpp v84, v84, v84, vcc wave_shr:1 row_mask:0xf bank_mask:0xf
    v_cndmask_b32_dpp v85, v85, v85, vcc wave_shr:1 row_mask:0xf bank_mask:0xf
    s_lshr_b64 s[52:53], s[52:53], 1
    v_cndmask_b32_dpp v86, v86, v86, vcc wave_shr:1 row_mask:0xf bank_mask:0xf
    v_cndmask_b32_dpp v87, v87, v87, vcc wave_shr:1 row_mask:0xf bank_mask:0xf
    s_andn2_b64 s[82:83], s[82:83], s[52:53]
    v_cndmask_b32_dpp v7, v7, v7, vcc wave_shr:1 row_mask:0xf bank_mask:0xf
    s_mov_b64 exec, s[54:55]
    s_cbranch_scc0 L2_d87
    s_mov_b64 exec, s[82:83]
    s_nop 1
    v_mfma_f32_4x4x4_16b_bf16 v[88:91], v[12:13], v[84:85], 0
    s_nop 1
    v_mfma_f32_4x4x4_16b_bf16 v[88:91], v[10:11], v[86:87], v[88:91]
    s_nop 4
    v_cvt_pk_bf16_f32 v88, v88, v89
    v_cvt_pk_bf16_f32 v89, v90, v91
    ds_pk_add_bf16 v7, v88 offset:65408
    ds_pk_add_bf16 v7, v89 offset:65412
    s_mov_b64 exec, s[54:55]
    s_branch L2_d87
L2_c88:
    s_lshl_b64 s[52:53], s[82:83], 1
    s_andn2_b64 s[52:53], s[52:53], s[80:81]
    s_andn2_b64 s[52:53], s[52:53], s[50:51]
    s_or_b64 s[80:81], s[80:81], s[52:53]
    s_not_b64 vcc, s[52:53]
    s_mov_b64 exec, -1
    v_cndmask_b32_dpp v84, v84, v84, vcc wave_shr:1 row_mask:0xf bank_mask:0xf
    v_cndmask_b32_dpp v85, v85, v85, vcc wave_shr:1 row_mask:0xf bank_mask:0xf
    s_lshr_b64 s[52:53], s[52:53], 1
    v_cndmask_b32_dpp v86, v86, v86, vcc wave_shr:1 row_mask:0xf bank_mask:0xf
    v_cndmask_b32_dpp v87, v87, v87, vcc wave_shr:1 row_mask:0xf bank_mask:0xf
    s_andn2_b64 s[82:83], s[82:83], s[52:53]
    v_cndmask_b32_dpp v7, v7, v7, vcc wave_shr:1 row_mask:0xf bank_mask:0xf
    s_mov_b64 exec, s[50:51]
    s_cbranch_scc0 L2_d88
    s_mov_b64 exec, s[82:83]
    s_nop 1
    v_mfma_f32_4x4x4_16b_bf16 v[88:91], v[12:13], v[84:85], 0
    s_nop 1
    v_mfma_f32_4x4x4_16b_bf16 v[88:91], v[10:11], v[86:87], v[88:91]
    s_nop 4
    v_cvt_pk_bf16_f32 v88, v88, v89
    v_cvt_pk_bf16_f32 v89, v90, v91
    ds_pk_add_bf16 v7, v88 offset:65408
    ds_pk_add_bf16 v7, v89 offset:65412
    s_mov_b64 exec, s[50:51]
    s_branch L2_d88
L2_oa89:
    s_waitcnt vmcnt(3)
    s_mov_b64 exec, s[6:7]
    v_lshrrev_b32 v114, 16, v114
    s_mov_b64 exec, -1
    v_and_b32 v46, 0x10000000, v32
    v_cmpx_eq_u32 vcc, 0, v46
    v_lshrrev_b32 v47, 14, v112
    v_and_b32 v47, v5, v47
    ds_read_b64 v[96:97], v47
    v_perm_b32 v98, v112, v114, s44
    v_bitop3_b32 v99, v112, 0.5, -0.5 bitop3:0xa8
    v_bitop3_b32 v98, v6, v98, v99 bitop3:0xca
    v_and_b32 v47, v5, v112
    s_waitcnt lgkmcnt(0)
    v_mfma_f32_4x4x4_16b_bf16 v[88:91], v[8:9], v[96:97], 0
    s_nop 4
    v_mul_f32 v88, v98, v88
    v_mul_f32 v89, v98, v89
    v_mul_f32 v90, v98, v90
    v_mul_f32 v91, v98, v91
    v_cvt_pk_bf16_f32 v88, v88, v89
    v_cvt_pk_bf16_f32 v89, v90, v91
    ds_pk_add_bf16 v47, v88 offset:65408
    ds_pk_add_bf16 v47, v89 offset:65412
    s_mov_b64 exec, -1
    v_and_b32 v46, 0x20000000, v32
    v_cmpx_eq_u32 vcc, 0, v46
    v_lshrrev_b32 v47, 14, v113
    v_and_b32 v47, v5, v47
    ds_read_b64 v[96:97], v47
    v_perm_b32 v98, v113, v114, s45
    v_bitop3_b32 v99, v113, 0.5, -0.5 bitop3:0xa8
    v_bitop3_b32 v98, v6, v98, v99 bitop3:0xca
    v_and_b32 v47, v5, v113
    s_waitcnt lgkmcnt(0)
    v_mfma_f32_4x4x4_16b_bf16 v[88:91], v[8:9], v[96:97], 0
    s_nop 4
    v_mul_f32 v88, v98, v88
    v_mul_f32 v89, v98, v89
    v_mul_f32 v90, v98, v90
    v_mul_f32 v91, v98, v91
    v_cvt_pk_bf16_f32 v88, v88, v89
    v_cvt_pk_bf16_f32 v89, v90, v91
    ds_pk_add_bf16 v47, v88 offset:65408
    ds_pk_add_bf16 v47, v89 offset:65412
    s_mov_b64 exec, -1
    s_branch L2_ob89
L2_xo90:
    v_cmp_lt_u32 vcc, 20, v99
    s_mov_b32 s101, 1
    s_cbranch_vccz L2_xp90
    v_cmp_lt_u32 vcc, 32, v99
    v_cmp_lt_u32 s[58:59], 31, v88
    s_mov_b32 s101, 2
    s_or_b64 vcc, vcc, s[58:59]
    s_cbranch_scc0 L2_xp90
    s_mov_b32 s37, 0x10000
    s_branch L2_xp90
L2_c91:
    s_lshl_b64 s[52:53], s[82:83], 1
    s_andn2_b64 s[52:53], s[52:53], s[80:81]
    s_andn2_b64 s[52:53], s[52:53], s[54:55]
    s_or_b64 s[80:81], s[80:81], s[52:53]
    s_not_b64 vcc, s[52:53]
    s_mov_b64 exec, -1
    v_cndmask_b32_dpp v84, v84, v84, vcc wave_shr:1 row_mask:0xf bank_mask:0xf
    v_cndmask_b32_dpp v85, v85, v85, vcc wave_shr:1 row_mask:0xf bank_mask:0xf
    s_lshr_b64 s[52:53], s[52:53], 1
    v_cndmask_b32_dpp v86, v86, v86, vcc wave_shr:1 row_mask:0xf bank_mask:0xf
    v_cndmask_b32_dpp v87, v87, v87, vcc wave_shr:1 row_mask:0xf bank_mask:0xf
    s_andn2_b64 s[82:83], s[82:83], s[52:53]
    v_cndmask_b32_dpp v7, v7, v7, vcc wave_shr:1 row_mask:0xf bank_mask:0xf
    s_mov_b64 exec, s[54:55]
    s_cbranch_scc0 L2_d91
    s_mov_b64 exec, s[82:83]
    s_nop 1
    v_mfma_f32_4x4x4_16b_bf16 v[88:91], v[12:13], v[84:85], 0
    s_nop 1
    v_mfma_f32_4x4x4_16b_bf16 v[88:91], v[10:11], v[86:87], v[88:91]
    s_nop 4
    v_cvt_pk_bf16_f32 v88, v88, v89
    v_cvt_pk_bf16_f32 v89, v90, v91
    ds_pk_add_bf16 v7, v88 offset:65408
    ds_pk_add_bf16 v7, v89 offset:65412
    s_mov_b64 exec, s[54:55]
    s_branch L2_d91
L2_c92:
    s_lshl_b64 s[52:53], s[82:83], 1
    s_andn2_b64 s[52:53], s[52:53], s[80:81]
    s_andn2_b64 s[52:53], s[52:53], s[50:51]
    s_or_b64 s[80:81], s[80:81], s[52:53]
    s_not_b64 vcc, s[52:53]
    s_mov_b64 exec, -1
    v_cndmask_b32_dpp v84, v84, v84, vcc wave_shr:1 row_mask:0xf bank_mask:0xf
    v_cndmask_b32_dpp v85, v85, v85, vcc wave_shr:1 row_mask:0xf bank_mask:0xf
    s_lshr_b64 s[52:53], s[52:53], 1
    v_cndmask_b32_dpp v86, v86, v86, vcc wave_shr:1 row_mask:0xf bank_mask:0xf
    v_cndmask_b32_dpp v87, v87, v87, vcc wave_shr:1 row_mask:0xf bank_mask:0xf
    s_andn2_b64 s[82:83], s[82:83], s[52:53]
    v_cndmask_b32_dpp v7, v7, v7, vcc wave_shr:1 row_mask:0xf bank_mask:0xf
    s_mov_b64 exec, s[50:51]
    s_cbranch_scc0 L2_d92
    s_mov_b64 exec, s[82:83]
    s_nop 1
    v_mfma_f32_4x4x4_16b_bf16 v[88:91], v[12:13], v[84:85], 0
    s_nop 1
    v_mfma_f32_4x4x4_16b_bf16 v[88:91], v[10:11], v[86:87], v[88:91]
    s_nop 4
    v_cvt_pk_bf16_f32 v88, v88, v89
    v_cvt_pk_bf16_f32 v89, v90, v91
    ds_pk_add_bf16 v7, v88 offset:65408
    ds_pk_add_bf16 v7, v89 offset:65412
    s_mov_b64 exec, s[50:51]
    s_branch L2_d92
L2_c93:
    s_lshl_b64 s[52:53], s[82:83], 1
    s_andn2_b64 s[52:53], s[52:53], s[80:81]
    s_andn2_b64 s[52:53], s[52:53], s[54:55]
    s_or_b64 s[80:81], s[80:81], s[52:53]
    s_not_b64 vcc, s[52:53]
    s_mov_b64 exec, -1
    v_cndmask_b32_dpp v84, v84, v84, vcc wave_shr:1 row_mask:0xf bank_mask:0xf
    v_cndmask_b32_dpp v85, v85, v85, vcc wave_shr:1 row_mask:0xf bank_mask:0xf
    s_lshr_b64 s[52:53], s[52:53], 1
    v_cndmask_b32_dpp v86, v86, v86, vcc wave_shr:1 row_mask:0xf bank_mask:0xf
    v_cndmask_b32_dpp v87, v87, v87, vcc wave_shr:1 row_mask:0xf bank_mask:0xf
    s_andn2_b64 s[82:83], s[82:83], s[52:53]
    v_cndmask_b32_dpp v7, v7, v7, vcc wave_shr:1 row_mask:0xf bank_mask:0xf
    s_mov_b64 exec, s[54:55]
    s_cbranch_scc0 L2_d93
    s_mov_b64 exec, s[82:83]
    s_nop 1
    v_mfma_f32_4x4x4_16b_bf16 v[88:91], v[12:13], v[84:85], 0
    s_nop 1
    v_mfma_f32_4x4x4_16b_bf16 v[88:91], v[10:11], v[86:87], v[88:91]
    s_nop 4
    v_cvt_pk_bf16_f32 v88, v88, v89
    v_cvt_pk_bf16_f32 v89, v90, v91
    ds_pk_add_bf16 v7, v88 offset:65408
    ds_pk_add_bf16 v7, v89 offset:65412
    s_mov_b64 exec, s[54:55]
    s_branch L2_d93
L2_c94:
    s_lshl_b64 s[52:53], s[82:83], 1
    s_andn2_b64 s[52:53], s[52:53], s[80:81]
    s_andn2_b64 s[52:53], s[52:53], s[50:51]
    s_or_b64 s[80:81], s[80:81], s[52:53]
    s_not_b64 vcc, s[52:53]
    s_mov_b64 exec, -1
    v_cndmask_b32_dpp v84, v84, v84, vcc wave_shr:1 row_mask:0xf bank_mask:0xf
    v_cndmask_b32_dpp v85, v85, v85, vcc wave_shr:1 row_mask:0xf bank_mask:0xf
    s_lshr_b64 s[52:53], s[52:53], 1
    v_cndmask_b32_dpp v86, v86, v86, vcc wave_shr:1 row_mask:0xf bank_mask:0xf
    v_cndmask_b32_dpp v87, v87, v87, vcc wave_shr:1 row_mask:0xf bank_mask:0xf
    s_andn2_b64 s[82:83], s[82:83], s[52:53]
    v_cndmask_b32_dpp v7, v7, v7, vcc wave_shr:1 row_mask:0xf bank_mask:0xf
    s_mov_b64 exec, s[50:51]
    s_cbranch_scc0 L2_d94
    s_mov_b64 exec, s[82:83]
    s_nop 1
    v_mfma_f32_4x4x4_16b_bf16 v[88:91], v[12:13], v[84:85], 0
    s_nop 1
    v_mfma_f32_4x4x4_16b_bf16 v[88:91], v[10:11], v[86:87], v[88:91]
    s_nop 4
    v_cvt_pk_bf16_f32 v88, v88, v89
    v_cvt_pk_bf16_f32 v89, v90, v91
    ds_pk_add_bf16 v7, v88 offset:65408
    ds_pk_add_bf16 v7, v89 offset:65412
    s_mov_b64 exec, s[50:51]
    s_branch L2_d94
L2_c95:
    s_lshl_b64 s[52:53], s[82:83], 1
    s_andn2_b64 s[52:53], s[52:53], s[80:81]
    s_andn2_b64 s[52:53], s[52:53], s[54:55]
    s_or_b64 s[80:81], s[80:81], s[52:53]
    s_not_b64 vcc, s[52:53]
    s_mov_b64 exec, -1
    v_cndmask_b32_dpp v84, v84, v84, vcc wave_shr:1 row_mask:0xf bank_mask:0xf
    v_cndmask_b32_dpp v85, v85, v85, vcc wave_shr:1 row_mask:0xf bank_mask:0xf
    s_lshr_b64 s[52:53], s[52:53], 1
    v_cndmask_b32_dpp v86, v86, v86, vcc wave_shr:1 row_mask:0xf bank_mask:0xf
    v_cndmask_b32_dpp v87, v87, v87, vcc wave_shr:1 row_mask:0xf bank_mask:0xf
    s_andn2_b64 s[82:83], s[82:83], s[52:53]
    v_cndmask_b32_dpp v7, v7, v7, vcc wave_shr:1 row_mask:0xf bank_mask:0xf
    s_mov_b64 exec, s[54:55]
    s_cbranch_scc0 L2_d95
    s_mov_b64 exec, s[82:83]
    s_nop 1
    v_mfma_f32_4x4x4_16b_bf16 v[88:91], v[12:13], v[84:85], 0
    s_nop 1
    v_mfma_f32_4x4x4_16b_bf16 v[88:91], v[10:11], v[86:87], v[88:91]
    s_nop 4
    v_cvt_pk_bf16_f32 v88, v88, v89
    v_cvt_pk_bf16_f32 v89, v90, v91
    ds_pk_add_bf16 v7, v88 offset:65408
    ds_pk_add_bf16 v7, v89 offset:65412
    s_mov_b64 exec, s[54:55]
    s_branch L2_d95
L2_c96:
    s_lshl_b64 s[52:53], s[82:83], 1
    s_andn2_b64 s[52:53], s[52:53], s[80:81]
    s_andn2_b64 s[52:53], s[52:53], s[50:51]
    s_or_b64 s[80:81], s[80:81], s[52:53]
    s_not_b64 vcc, s[52:53]
    s_mov_b64 exec, -1
    v_cndmask_b32_dpp v84, v84, v84, vcc wave_shr:1 row_mask:0xf bank_mask:0xf
    v_cndmask_b32_dpp v85, v85, v85, vcc wave_shr:1 row_mask:0xf bank_mask:0xf
    s_lshr_b64 s[52:53], s[52:53], 1
    v_cndmask_b32_dpp v86, v86, v86, vcc wave_shr:1 row_mask:0xf bank_mask:0xf
    v_cndmask_b32_dpp v87, v87, v87, vcc wave_shr:1 row_mask:0xf bank_mask:0xf
    s_andn2_b64 s[82:83], s[82:83], s[52:53]
    v_cndmask_b32_dpp v7, v7, v7, vcc wave_shr:1 row_mask:0xf bank_mask:0xf
    s_mov_b64 exec, s[50:51]
    s_cbranch_scc0 L2_d96
    s_mov_b64 exec, s[82:83]
    s_nop 1
    v_mfma_f32_4x4x4_16b_bf16 v[88:91], v[12:13], v[84:85], 0
    s_nop 1
    v_mfma_f32_4x4x4_16b_bf16 v[88:91], v[10:11], v[86:87], v[88:91]
    s_nop 4
    v_cvt_pk_bf16_f32 v88, v88, v89
    v_cvt_pk_bf16_f32 v89, v90, v91
    ds_pk_add_bf16 v7, v88 offset:65408
    ds_pk_add_bf16 v7, v89 offset:65412
    s_mov_b64 exec, s[50:51]
    s_branch L2_d96
L2_xa97:
    s_cmp_eq_u32 s101, 1
    s_cbranch_scc1 L2_xc97
    v_lshlrev_b32 v89, 0, v96
    v_add_u32 v90, 140, v97
    v_bitop3_b32 v90, v89, v45, v90 bitop3:0x6a
    ds_write_b32 v98, v90 offset:28
    v_lshlrev_b32 v89, 4, v96
    v_add_u32 v90, 120, v97
    v_bitop3_b32 v90, v89, v45, v90 bitop3:0x6a
    ds_write_b32 v98, v90 offset:24
    v_lshlrev_b32 v89, 8, v96
    v_add_u32 v90, 100, v97
    v_bitop3_b32 v90, v89, v45, v90 bitop3:0x6a
    ds_write_b32 v98, v90 offset:20
L2_xc97:
    v_lshlrev_b32 v89, 12, v96
    v_add_u32 v90, 80, v97
    v_bitop3_b32 v90, v89, v45, v90 bitop3:0x6a
    ds_write_b32 v98, v90 offset:16
    s_branch L2_xb97
L2_xe97:
    v_cmp_lt_u32 vcc, 32, v99
    v_cmp_lt_u32 s[58:59], 31, v88
    v_lshrrev_b32 v89, 16, v96
    v_add_u32 v97, 80, v97
    s_or_b64 vcc, vcc, s[58:59]
    s_cbranch_scc1 L2_xs97
    v_lshlrev_b32 v89, v1, v89
    v_and_b32 v89, v45, v89
    v_cmp_ne_u32 vcc, 0, v89
    v_xor_b32 v90, v97, v89
    s_add_u32 s3, s37, s38
    v_mbcnt_lo_u32_b32 v98, vcc_lo, 0
    v_mbcnt_hi_u32_b32 v98, vcc_hi, v98
    s_bcnt1_i32_b64 s41, vcc
    v_lshl_add_u32 v98, v98, 2, s3
    s_mov_b64 exec, vcc
    ds_write_b32 v98, v90
    s_mov_b64 exec, -1
    s_lshl2_add_u32 s37, s41, s37
    s_branch L2_xr97
L2_xf97:
    s_waitcnt lgkmcnt(0)
    s_cmp_gt_u32 s37, 1024
    s_cbranch_scc1 L2_xs97
    s_cmp_lt_u32 s37, 768
    s_cbranch_scc1 L2_xl97
    ds_read_b32 v32, v98 offset:896
    s_add_u32 s3, s42, 2
    s_bitset1_b32 s43, s3
    s_branch L2_xg97
L2_xl97:
    v_mov_b32 v42, -1
    s_cmp_ge_u32 s37, 512
    s_cbranch_scc1 L2_xg97
    v_mov_b32 v43, -1
    s_cmp_ge_u32 s37, 256
    s_cbranch_scc1 L2_xg97
    v_mov_b32 v41, -1
    s_branch L2_xg97
L2_xs97:
    s_waitcnt lgkmcnt(0)
    v_mov_b32 v40, -1
    v_mov_b32 v41, -1
    v_mov_b32 v43, -1
    v_mov_b32 v42, -1
    s_add_u32 s3, s42, 2
    s_bitset1_b32 s36, s3
    s_branch L2_xg97
L2_c98:
    s_lshl_b64 s[52:53], s[82:83], 1
    s_andn2_b64 s[52:53], s[52:53], s[80:81]
    s_andn2_b64 s[52:53], s[52:53], s[54:55]
    s_or_b64 s[80:81], s[80:81], s[52:53]
    s_not_b64 vcc, s[52:53]
    s_mov_b64 exec, -1
    v_cndmask_b32_dpp v84, v84, v84, vcc wave_shr:1 row_mask:0xf bank_mask:0xf
    v_cndmask_b32_dpp v85, v85, v85, vcc wave_shr:1 row_mask:0xf bank_mask:0xf
    s_lshr_b64 s[52:53], s[52:53], 1
    v_cndmask_b32_dpp v86, v86, v86, vcc wave_shr:1 row_mask:0xf bank_mask:0xf
    v_cndmask_b32_dpp v87, v87, v87, vcc wave_shr:1 row_mask:0xf bank_mask:0xf
    s_andn2_b64 s[82:83], s[82:83], s[52:53]
    v_cndmask_b32_dpp v7, v7, v7, vcc wave_shr:1 row_mask:0xf bank_mask:0xf
    s_mov_b64 exec, s[54:55]
    s_cbranch_scc0 L2_d98
    s_mov_b64 exec, s[82:83]
    s_nop 1
    v_mfma_f32_4x4x4_16b_bf16 v[88:91], v[12:13], v[84:85], 0
    s_nop 1
    v_mfma_f32_4x4x4_16b_bf16 v[88:91], v[10:11], v[86:87], v[88:91]
    s_nop 4
    v_cvt_pk_bf16_f32 v88, v88, v89
    v_cvt_pk_bf16_f32 v89, v90, v91
    ds_pk_add_bf16 v7, v88 offset:65408
    ds_pk_add_bf16 v7, v89 offset:65412
    s_mov_b64 exec, s[54:55]
    s_branch L2_d98
L2_c99:
    s_lshl_b64 s[52:53], s[82:83], 1
    s_andn2_b64 s[52:53], s[52:53], s[80:81]
    s_andn2_b64 s[52:53], s[52:53], s[50:51]
    s_or_b64 s[80:81], s[80:81], s[52:53]
    s_not_b64 vcc, s[52:53]
    s_mov_b64 exec, -1
    v_cndmask_b32_dpp v84, v84, v84, vcc wave_shr:1 row_mask:0xf bank_mask:0xf
    v_cndmask_b32_dpp v85, v85, v85, vcc wave_shr:1 row_mask:0xf bank_mask:0xf
    s_lshr_b64 s[52:53], s[52:53], 1
    v_cndmask_b32_dpp v86, v86, v86, vcc wave_shr:1 row_mask:0xf bank_mask:0xf
    v_cndmask_b32_dpp v87, v87, v87, vcc wave_shr:1 row_mask:0xf bank_mask:0xf
    s_andn2_b64 s[82:83], s[82:83], s[52:53]
    v_cndmask_b32_dpp v7, v7, v7, vcc wave_shr:1 row_mask:0xf bank_mask:0xf
    s_mov_b64 exec, s[50:51]
    s_cbranch_scc0 L2_d99
    s_mov_b64 exec, s[82:83]
    s_nop 1
    v_mfma_f32_4x4x4_16b_bf16 v[88:91], v[12:13], v[84:85], 0
    s_nop 1
    v_mfma_f32_4x4x4_16b_bf16 v[88:91], v[10:11], v[86:87], v[88:91]
    s_nop 4
    v_cvt_pk_bf16_f32 v88, v88, v89
    v_cvt_pk_bf16_f32 v89, v90, v91
    ds_pk_add_bf16 v7, v88 offset:65408
    ds_pk_add_bf16 v7, v89 offset:65412
    s_mov_b64 exec, s[50:51]
    s_branch L2_d99
L2_oa100:
    v_and_b32 v47, 0x0fffffff, v33
    buffer_load_dword v114, v47, s[8:11], 0 offen offset:16
    s_mov_b64 exec, s[6:7]
    v_add_u32 v47, 8, v47
    v_lshrrev_b32 v33, 2, v33
    s_mov_b64 exec, -1
    buffer_load_dwordx2 v[112:113], v47, s[8:11], 0 offen
    s_branch L2_ob100
L2_c101:
    s_lshl_b64 s[52:53], s[82:83], 1
    s_andn2_b64 s[52:53], s[52:53], s[80:81]
    s_andn2_b64 s[52:53], s[52:53], s[54:55]
    s_or_b64 s[80:81], s[80:81], s[52:53]
    s_not_b64 vcc, s[52:53]
    s_mov_b64 exec, -1
    v_cndmask_b32_dpp v84, v84, v84, vcc wave_shr:1 row_mask:0xf bank_mask:0xf
    v_cndmask_b32_dpp v85, v85, v85, vcc wave_shr:1 row_mask:0xf bank_mask:0xf
    s_lshr_b64 s[52:53], s[52:53], 1
    v_cndmask_b32_dpp v86, v86, v86, vcc wave_shr:1 row_mask:0xf bank_mask:0xf
    v_cndmask_b32_dpp v87, v87, v87, vcc wave_shr:1 row_mask:0xf bank_mask:0xf
    s_andn2_b64 s[82:83], s[82:83], s[52:53]
    v_cndmask_b32_dpp v7, v7, v7, vcc wave_shr:1 row_mask:0xf bank_mask:0xf
    s_mov_b64 exec, s[54:55]
    s_cbranch_scc0 L2_d101
    s_mov_b64 exec, s[82:83]
    s_nop 1
    v_mfma_f32_4x4x4_16b_bf16 v[88:91], v[12:13], v[84:85], 0
    s_nop 1
    v_mfma_f32_4x4x4_16b_bf16 v[88:91], v[10:11], v[86:87], v[88:91]
    s_nop 4
    v_cvt_pk_bf16_f32 v88, v88, v89
    v_cvt_pk_bf16_f32 v89, v90, v91
    ds_pk_add_bf16 v7, v88 offset:65408
    ds_pk_add_bf16 v7, v89 offset:65412
    s_mov_b64 exec, s[54:55]
    s_branch L2_d101
L2_c102:
    s_lshl_b64 s[52:53], s[82:83], 1
    s_andn2_b64 s[52:53], s[52:53], s[80:81]
    s_andn2_b64 s[52:53], s[52:53], s[50:51]
    s_or_b64 s[80:81], s[80:81], s[52:53]
    s_not_b64 vcc, s[52:53]
    s_mov_b64 exec, -1
    v_cndmask_b32_dpp v84, v84, v84, vcc wave_shr:1 row_mask:0xf bank_mask:0xf
    v_cndmask_b32_dpp v85, v85, v85, vcc wave_shr:1 row_mask:0xf bank_mask:0xf
    s_lshr_b64 s[52:53], s[52:53], 1
    v_cndmask_b32_dpp v86, v86, v86, vcc wave_shr:1 row_mask:0xf bank_mask:0xf
    v_cndmask_b32_dpp v87, v87, v87, vcc wave_shr:1 row_mask:0xf bank_mask:0xf
    s_andn2_b64 s[82:83], s[82:83], s[52:53]
    v_cndmask_b32_dpp v7, v7, v7, vcc wave_shr:1 row_mask:0xf bank_mask:0xf
    s_mov_b64 exec, s[50:51]
    s_cbranch_scc0 L2_d102
    s_mov_b64 exec, s[82:83]
    s_nop 1
    v_mfma_f32_4x4x4_16b_bf16 v[88:91], v[12:13], v[84:85], 0
    s_nop 1
    v_mfma_f32_4x4x4_16b_bf16 v[88:91], v[10:11], v[86:87], v[88:91]
    s_nop 4
    v_cvt_pk_bf16_f32 v88, v88, v89
    v_cvt_pk_bf16_f32 v89, v90, v91
    ds_pk_add_bf16 v7, v88 offset:65408
    ds_pk_add_bf16 v7, v89 offset:65412
    s_mov_b64 exec, s[50:51]
    s_branch L2_d102
L2_c103:
    s_lshl_b64 s[52:53], s[82:83], 1
    s_andn2_b64 s[52:53], s[52:53], s[80:81]
    s_andn2_b64 s[52:53], s[52:53], s[54:55]
    s_or_b64 s[80:81], s[80:81], s[52:53]
    s_not_b64 vcc, s[52:53]
    s_mov_b64 exec, -1
    v_cndmask_b32_dpp v84, v84, v84, vcc wave_shr:1 row_mask:0xf bank_mask:0xf
    v_cndmask_b32_dpp v85, v85, v85, vcc wave_shr:1 row_mask:0xf bank_mask:0xf
    s_lshr_b64 s[52:53], s[52:53], 1
    v_cndmask_b32_dpp v86, v86, v86, vcc wave_shr:1 row_mask:0xf bank_mask:0xf
    v_cndmask_b32_dpp v87, v87, v87, vcc wave_shr:1 row_mask:0xf bank_mask:0xf
    s_andn2_b64 s[82:83], s[82:83], s[52:53]
    v_cndmask_b32_dpp v7, v7, v7, vcc wave_shr:1 row_mask:0xf bank_mask:0xf
    s_mov_b64 exec, s[54:55]
    s_cbranch_scc0 L2_d103
    s_mov_b64 exec, s[82:83]
    s_nop 1
    v_mfma_f32_4x4x4_16b_bf16 v[88:91], v[12:13], v[84:85], 0
    s_nop 1
    v_mfma_f32_4x4x4_16b_bf16 v[88:91], v[10:11], v[86:87], v[88:91]
    s_nop 4
    v_cvt_pk_bf16_f32 v88, v88, v89
    v_cvt_pk_bf16_f32 v89, v90, v91
    ds_pk_add_bf16 v7, v88 offset:65408
    ds_pk_add_bf16 v7, v89 offset:65412
    s_mov_b64 exec, s[54:55]
    s_branch L2_d103
L2_c104:
    s_lshl_b64 s[52:53], s[82:83], 1
    s_andn2_b64 s[52:53], s[52:53], s[80:81]
    s_andn2_b64 s[52:53], s[52:53], s[50:51]
    s_or_b64 s[80:81], s[80:81], s[52:53]
    s_not_b64 vcc, s[52:53]
    s_mov_b64 exec, -1
    v_cndmask_b32_dpp v84, v84, v84, vcc wave_shr:1 row_mask:0xf bank_mask:0xf
    v_cndmask_b32_dpp v85, v85, v85, vcc wave_shr:1 row_mask:0xf bank_mask:0xf
    s_lshr_b64 s[52:53], s[52:53], 1
    v_cndmask_b32_dpp v86, v86, v86, vcc wave_shr:1 row_mask:0xf bank_mask:0xf
    v_cndmask_b32_dpp v87, v87, v87, vcc wave_shr:1 row_mask:0xf bank_mask:0xf
    s_andn2_b64 s[82:83], s[82:83], s[52:53]
    v_cndmask_b32_dpp v7, v7, v7, vcc wave_shr:1 row_mask:0xf bank_mask:0xf
    s_mov_b64 exec, s[50:51]
    s_cbranch_scc0 L2_d104
    s_mov_b64 exec, s[82:83]
    s_nop 1
    v_mfma_f32_4x4x4_16b_bf16 v[88:91], v[12:13], v[84:85], 0
    s_nop 1
    v_mfma_f32_4x4x4_16b_bf16 v[88:91], v[10:11], v[86:87], v[88:91]
    s_nop 4
    v_cvt_pk_bf16_f32 v88, v88, v89
    v_cvt_pk_bf16_f32 v89, v90, v91
    ds_pk_add_bf16 v7, v88 offset:65408
    ds_pk_add_bf16 v7, v89 offset:65412
    s_mov_b64 exec, s[50:51]
    s_branch L2_d104
L2_c105:
    s_lshl_b64 s[52:53], s[82:83], 1
    s_andn2_b64 s[52:53], s[52:53], s[80:81]
    s_andn2_b64 s[52:53], s[52:53], s[54:55]
    s_or_b64 s[80:81], s[80:81], s[52:53]
    s_not_b64 vcc, s[52:53]
    s_mov_b64 exec, -1
    v_cndmask_b32_dpp v84, v84, v84, vcc wave_shr:1 row_mask:0xf bank_mask:0xf
    v_cndmask_b32_dpp v85, v85, v85, vcc wave_shr:1 row_mask:0xf bank_mask:0xf
    s_lshr_b64 s[52:53], s[52:53], 1
    v_cndmask_b32_dpp v86, v86, v86, vcc wave_shr:1 row_mask:0xf bank_mask:0xf
    v_cndmask_b32_dpp v87, v87, v87, vcc wave_shr:1 row_mask:0xf bank_mask:0xf
    s_andn2_b64 s[82:83], s[82:83], s[52:53]
    v_cndmask_b32_dpp v7, v7, v7, vcc wave_shr:1 row_mask:0xf bank_mask:0xf
    s_mov_b64 exec, s[54:55]
    s_cbranch_scc0 L2_d105
    s_mov_b64 exec, s[82:83]
    s_nop 1
    v_mfma_f32_4x4x4_16b_bf16 v[88:91], v[12:13], v[84:85], 0
    s_nop 1
    v_mfma_f32_4x4x4_16b_bf16 v[88:91], v[10:11], v[86:87], v[88:91]
    s_nop 4
    v_cvt_pk_bf16_f32 v88, v88, v89
    v_cvt_pk_bf16_f32 v89, v90, v91
    ds_pk_add_bf16 v7, v88 offset:65408
    ds_pk_add_bf16 v7, v89 offset:65412
    s_mov_b64 exec, s[54:55]
    s_branch L2_d105
L2_c106:
    s_lshl_b64 s[52:53], s[82:83], 1
    s_andn2_b64 s[52:53], s[52:53], s[80:81]
    s_andn2_b64 s[52:53], s[52:53], s[50:51]
    s_or_b64 s[80:81], s[80:81], s[52:53]
    s_not_b64 vcc, s[52:53]
    s_mov_b64 exec, -1
    v_cndmask_b32_dpp v84, v84, v84, vcc wave_shr:1 row_mask:0xf bank_mask:0xf
    v_cndmask_b32_dpp v85, v85, v85, vcc wave_shr:1 row_mask:0xf bank_mask:0xf
    s_lshr_b64 s[52:53], s[52:53], 1
    v_cndmask_b32_dpp v86, v86, v86, vcc wave_shr:1 row_mask:0xf bank_mask:0xf
    v_cndmask_b32_dpp v87, v87, v87, vcc wave_shr:1 row_mask:0xf bank_mask:0xf
    s_andn2_b64 s[82:83], s[82:83], s[52:53]
    v_cndmask_b32_dpp v7, v7, v7, vcc wave_shr:1 row_mask:0xf bank_mask:0xf
    s_mov_b64 exec, s[50:51]
    s_cbranch_scc0 L2_d106
    s_mov_b64 exec, s[82:83]
    s_nop 1
    v_mfma_f32_4x4x4_16b_bf16 v[88:91], v[12:13], v[84:85], 0
    s_nop 1
    v_mfma_f32_4x4x4_16b_bf16 v[88:91], v[10:11], v[86:87], v[88:91]
    s_nop 4
    v_cvt_pk_bf16_f32 v88, v88, v89
    v_cvt_pk_bf16_f32 v89, v90, v91
    ds_pk_add_bf16 v7, v88 offset:65408
    ds_pk_add_bf16 v7, v89 offset:65412
    s_mov_b64 exec, s[50:51]
    s_branch L2_d106
L2_oa107:
    s_waitcnt vmcnt(3)
    s_mov_b64 exec, s[6:7]
    v_lshrrev_b32 v114, 16, v114
    s_mov_b64 exec, -1
    v_and_b32 v46, 0x10000000, v33
    v_cmpx_eq_u32 vcc, 0, v46
    v_lshrrev_b32 v47, 14, v112
    v_and_b32 v47, v5, v47
    ds_read_b64 v[96:97], v47
    v_perm_b32 v98, v112, v114, s44
    v_bitop3_b32 v99, v112, 0.5, -0.5 bitop3:0xa8
    v_bitop3_b32 v98, v6, v98, v99 bitop3:0xca
    v_and_b32 v47, v5, v112
    s_waitcnt lgkmcnt(0)
    v_mfma_f32_4x4x4_16b_bf16 v[88:91], v[8:9], v[96:97], 0
    s_nop 4
    v_mul_f32 v88, v98, v88
    v_mul_f32 v89, v98, v89
    v_mul_f32 v90, v98, v90
    v_mul_f32 v91, v98, v91
    v_cvt_pk_bf16_f32 v88, v88, v89
    v_cvt_pk_bf16_f32 v89, v90, v91
    ds_pk_add_bf16 v47, v88 offset:65408
    ds_pk_add_bf16 v47, v89 offset:65412
    s_mov_b64 exec, -1
    v_and_b32 v46, 0x20000000, v33
    v_cmpx_eq_u32 vcc, 0, v46
    v_lshrrev_b32 v47, 14, v113
    v_and_b32 v47, v5, v47
    ds_read_b64 v[96:97], v47
    v_perm_b32 v98, v113, v114, s45
    v_bitop3_b32 v99, v113, 0.5, -0.5 bitop3:0xa8
    v_bitop3_b32 v98, v6, v98, v99 bitop3:0xca
    v_and_b32 v47, v5, v113
    s_waitcnt lgkmcnt(0)
    v_mfma_f32_4x4x4_16b_bf16 v[88:91], v[8:9], v[96:97], 0
    s_nop 4
    v_mul_f32 v88, v98, v88
    v_mul_f32 v89, v98, v89
    v_mul_f32 v90, v98, v90
    v_mul_f32 v91, v98, v91
    v_cvt_pk_bf16_f32 v88, v88, v89
    v_cvt_pk_bf16_f32 v89, v90, v91
    ds_pk_add_bf16 v47, v88 offset:65408
    ds_pk_add_bf16 v47, v89 offset:65412
    s_mov_b64 exec, -1
    s_branch L2_ob107
L2_xo108:
    v_cmp_lt_u32 vcc, 20, v99
    s_mov_b32 s101, 1
    s_cbranch_vccz L2_xp108
    v_cmp_lt_u32 vcc, 32, v99
    v_cmp_lt_u32 s[58:59], 31, v88
    s_mov_b32 s101, 2
    s_or_b64 vcc, vcc, s[58:59]
    s_cbranch_scc0 L2_xp108
    s_mov_b32 s37, 0x10000
    s_branch L2_xp108
L2_c109:
    s_lshl_b64 s[52:53], s[82:83], 1
    s_andn2_b64 s[52:53], s[52:53], s[80:81]
    s_andn2_b64 s[52:53], s[52:53], s[54:55]
    s_or_b64 s[80:81], s[80:81], s[52:53]
    s_not_b64 vcc, s[52:53]
    s_mov_b64 exec, -1
    v_cndmask_b32_dpp v84, v84, v84, vcc wave_shr:1 row_mask:0xf bank_mask:0xf
    v_cndmask_b32_dpp v85, v85, v85, vcc wave_shr:1 row_mask:0xf bank_mask:0xf
    s_lshr_b64 s[52:53], s[52:53], 1
    v_cndmask_b32_dpp v86, v86, v86, vcc wave_shr:1 row_mask:0xf bank_mask:0xf
    v_cndmask_b32_dpp v87, v87, v87, vcc wave_shr:1 row_mask:0xf bank_mask:0xf
    s_andn2_b64 s[82:83], s[82:83], s[52:53]
    v_cndmask_b32_dpp v7, v7, v7, vcc wave_shr:1 row_mask:0xf bank_mask:0xf
    s_mov_b64 exec, s[54:55]
    s_cbranch_scc0 L2_d109
    s_mov_b64 exec, s[82:83]
    s_nop 1
    v_mfma_f32_4x4x4_16b_bf16 v[88:91], v[12:13], v[84:85], 0
    s_nop 1
    v_mfma_f32_4x4x4_16b_bf16 v[88:91], v[10:11], v[86:87], v[88:91]
    s_nop 4
    v_cvt_pk_bf16_f32 v88, v88, v89
    v_cvt_pk_bf16_f32 v89, v90, v91
    ds_pk_add_bf16 v7, v88 offset:65408
    ds_pk_add_bf16 v7, v89 offset:65412
    s_mov_b64 exec, s[54:55]
    s_branch L2_d109
L2_c110:
    s_lshl_b64 s[52:53], s[82:83], 1
    s_andn2_b64 s[52:53], s[52:53], s[80:81]
    s_andn2_b64 s[52:53], s[52:53], s[50:51]
    s_or_b64 s[80:81], s[80:81], s[52:53]
    s_not_b64 vcc, s[52:53]
    s_mov_b64 exec, -1
    v_cndmask_b32_dpp v84, v84, v84, vcc wave_shr:1 row_mask:0xf bank_mask:0xf
    v_cndmask_b32_dpp v85, v85, v85, vcc wave_shr:1 row_mask:0xf bank_mask:0xf
    s_lshr_b64 s[52:53], s[52:53], 1
    v_cndmask_b32_dpp v86, v86, v86, vcc wave_shr:1 row_mask:0xf bank_mask:0xf
    v_cndmask_b32_dpp v87, v87, v87, vcc wave_shr:1 row_mask:0xf bank_mask:0xf
    s_andn2_b64 s[82:83], s[82:83], s[52:53]
    v_cndmask_b32_dpp v7, v7, v7, vcc wave_shr:1 row_mask:0xf bank_mask:0xf
    s_mov_b64 exec, s[50:51]
    s_cbranch_scc0 L2_d110
    s_mov_b64 exec, s[82:83]
    s_nop 1
    v_mfma_f32_4x4x4_16b_bf16 v[88:91], v[12:13], v[84:85], 0
    s_nop 1
    v_mfma_f32_4x4x4_16b_bf16 v[88:91], v[10:11], v[86:87], v[88:91]
    s_nop 4
    v_cvt_pk_bf16_f32 v88, v88, v89
    v_cvt_pk_bf16_f32 v89, v90, v91
    ds_pk_add_bf16 v7, v88 offset:65408
    ds_pk_add_bf16 v7, v89 offset:65412
    s_mov_b64 exec, s[50:51]
    s_branch L2_d110
L2_c111:
    s_lshl_b64 s[52:53], s[82:83], 1
    s_andn2_b64 s[52:53], s[52:53], s[80:81]
    s_andn2_b64 s[52:53], s[52:53], s[54:55]
    s_or_b64 s[80:81], s[80:81], s[52:53]
    s_not_b64 vcc, s[52:53]
    s_mov_b64 exec, -1
    v_cndmask_b32_dpp v84, v84, v84, vcc wave_shr:1 row_mask:0xf bank_mask:0xf
    v_cndmask_b32_dpp v85, v85, v85, vcc wave_shr:1 row_mask:0xf bank_mask:0xf
    s_lshr_b64 s[52:53], s[52:53], 1
    v_cndmask_b32_dpp v86, v86, v86, vcc wave_shr:1 row_mask:0xf bank_mask:0xf
    v_cndmask_b32_dpp v87, v87, v87, vcc wave_shr:1 row_mask:0xf bank_mask:0xf
    s_andn2_b64 s[82:83], s[82:83], s[52:53]
    v_cndmask_b32_dpp v7, v7, v7, vcc wave_shr:1 row_mask:0xf bank_mask:0xf
    s_mov_b64 exec, s[54:55]
    s_cbranch_scc0 L2_d111
    s_mov_b64 exec, s[82:83]
    s_nop 1
    v_mfma_f32_4x4x4_16b_bf16 v[88:91], v[12:13], v[84:85], 0
    s_nop 1
    v_mfma_f32_4x4x4_16b_bf16 v[88:91], v[10:11], v[86:87], v[88:91]
    s_nop 4
    v_cvt_pk_bf16_f32 v88, v88, v89
    v_cvt_pk_bf16_f32 v89, v90, v91
    ds_pk_add_bf16 v7, v88 offset:65408
    ds_pk_add_bf16 v7, v89 offset:65412
    s_mov_b64 exec, s[54:55]
    s_branch L2_d111
L2_c112:
    s_lshl_b64 s[52:53], s[82:83], 1
    s_andn2_b64 s[52:53], s[52:53], s[80:81]
    s_andn2_b64 s[52:53], s[52:53], s[50:51]
    s_or_b64 s[80:81], s[80:81], s[52:53]
    s_not_b64 vcc, s[52:53]
    s_mov_b64 exec, -1
    v_cndmask_b32_dpp v84, v84, v84, vcc wave_shr:1 row_mask:0xf bank_mask:0xf
    v_cndmask_b32_dpp v85, v85, v85, vcc wave_shr:1 row_mask:0xf bank_mask:0xf
    s_lshr_b64 s[52:53], s[52:53], 1
    v_cndmask_b32_dpp v86, v86, v86, vcc wave_shr:1 row_mask:0xf bank_mask:0xf
    v_cndmask_b32_dpp v87, v87, v87, vcc wave_shr:1 row_mask:0xf bank_mask:0xf
    s_andn2_b64 s[82:83], s[82:83], s[52:53]
    v_cndmask_b32_dpp v7, v7, v7, vcc wave_shr:1 row_mask:0xf bank_mask:0xf
    s_mov_b64 exec, s[50:51]
    s_cbranch_scc0 L2_d112
    s_mov_b64 exec, s[82:83]
    s_nop 1
    v_mfma_f32_4x4x4_16b_bf16 v[88:91], v[12:13], v[84:85], 0
    s_nop 1
    v_mfma_f32_4x4x4_16b_bf16 v[88:91], v[10:11], v[86:87], v[88:91]
    s_nop 4
    v_cvt_pk_bf16_f32 v88, v88, v89
    v_cvt_pk_bf16_f32 v89, v90, v91
    ds_pk_add_bf16 v7, v88 offset:65408
    ds_pk_add_bf16 v7, v89 offset:65412
    s_mov_b64 exec, s[50:51]
    s_branch L2_d112
L2_c113:
    s_lshl_b64 s[52:53], s[82:83], 1
    s_andn2_b64 s[52:53], s[52:53], s[80:81]
    s_andn2_b64 s[52:53], s[52:53], s[54:55]
    s_or_b64 s[80:81], s[80:81], s[52:53]
    s_not_b64 vcc, s[52:53]
    s_mov_b64 exec, -1
    v_cndmask_b32_dpp v84, v84, v84, vcc wave_shr:1 row_mask:0xf bank_mask:0xf
    v_cndmask_b32_dpp v85, v85, v85, vcc wave_shr:1 row_mask:0xf bank_mask:0xf
    s_lshr_b64 s[52:53], s[52:53], 1
    v_cndmask_b32_dpp v86, v86, v86, vcc wave_shr:1 row_mask:0xf bank_mask:0xf
    v_cndmask_b32_dpp v87, v87, v87, vcc wave_shr:1 row_mask:0xf bank_mask:0xf
    s_andn2_b64 s[82:83], s[82:83], s[52:53]
    v_cndmask_b32_dpp v7, v7, v7, vcc wave_shr:1 row_mask:0xf bank_mask:0xf
    s_mov_b64 exec, s[54:55]
    s_cbranch_scc0 L2_d113
    s_mov_b64 exec, s[82:83]
    s_nop 1
    v_mfma_f32_4x4x4_16b_bf16 v[88:91], v[12:13], v[84:85], 0
    s_nop 1
    v_mfma_f32_4x4x4_16b_bf16 v[88:91], v[10:11], v[86:87], v[88:91]
    s_nop 4
    v_cvt_pk_bf16_f32 v88, v88, v89
    v_cvt_pk_bf16_f32 v89, v90, v91
    ds_pk_add_bf16 v7, v88 offset:65408
    ds_pk_add_bf16 v7, v89 offset:65412
    s_mov_b64 exec, s[54:55]
    s_branch L2_d113
L2_c114:
    s_lshl_b64 s[52:53], s[82:83], 1
    s_andn2_b64 s[52:53], s[52:53], s[80:81]
    s_andn2_b64 s[52:53], s[52:53], s[50:51]
    s_or_b64 s[80:81], s[80:81], s[52:53]
    s_not_b64 vcc, s[52:53]
    s_mov_b64 exec, -1
    v_cndmask_b32_dpp v84, v84, v84, vcc wave_shr:1 row_mask:0xf bank_mask:0xf
    v_cndmask_b32_dpp v85, v85, v85, vcc wave_shr:1 row_mask:0xf bank_mask:0xf
    s_lshr_b64 s[52:53], s[52:53], 1
    v_cndmask_b32_dpp v86, v86, v86, vcc wave_shr:1 row_mask:0xf bank_mask:0xf
    v_cndmask_b32_dpp v87, v87, v87, vcc wave_shr:1 row_mask:0xf bank_mask:0xf
    s_andn2_b64 s[82:83], s[82:83], s[52:53]
    v_cndmask_b32_dpp v7, v7, v7, vcc wave_shr:1 row_mask:0xf bank_mask:0xf
    s_mov_b64 exec, s[50:51]
    s_cbranch_scc0 L2_d114
    s_mov_b64 exec, s[82:83]
    s_nop 1
    v_mfma_f32_4x4x4_16b_bf16 v[88:91], v[12:13], v[84:85], 0
    s_nop 1
    v_mfma_f32_4x4x4_16b_bf16 v[88:91], v[10:11], v[86:87], v[88:91]
    s_nop 4
    v_cvt_pk_bf16_f32 v88, v88, v89
    v_cvt_pk_bf16_f32 v89, v90, v91
    ds_pk_add_bf16 v7, v88 offset:65408
    ds_pk_add_bf16 v7, v89 offset:65412
    s_mov_b64 exec, s[50:51]
    s_branch L2_d114
L2_xa115:
    s_cmp_eq_u32 s101, 1
    s_cbranch_scc1 L2_xc115
    v_lshlrev_b32 v89, 0, v96
    v_add_u32 v90, 140, v97
    v_bitop3_b32 v90, v89, v45, v90 bitop3:0x6a
    ds_write_b32 v98, v90 offset:28
    v_lshlrev_b32 v89, 4, v96
    v_add_u32 v90, 120, v97
    v_bitop3_b32 v90, v89, v45, v90 bitop3:0x6a
    ds_write_b32 v98, v90 offset:24
    v_lshlrev_b32 v89, 8, v96
    v_add_u32 v90, 100, v97
    v_bitop3_b32 v90, v89, v45, v90 bitop3:0x6a
    ds_write_b32 v98, v90 offset:20
L2_xc115:
    v_lshlrev_b32 v89, 12, v96
    v_add_u32 v90, 80, v97
    v_bitop3_b32 v90, v89, v45, v90 bitop3:0x6a
    ds_write_b32 v98, v90 offset:16
    s_branch L2_xb115
L2_xe115:
    v_cmp_lt_u32 vcc, 32, v99
    v_cmp_lt_u32 s[58:59], 31, v88
    v_lshrrev_b32 v89, 16, v96
    v_add_u32 v97, 80, v97
    s_or_b64 vcc, vcc, s[58:59]
    s_cbranch_scc1 L2_xs115
    v_lshlrev_b32 v89, v1, v89
    v_and_b32 v89, v45, v89
    v_cmp_ne_u32 vcc, 0, v89
    v_xor_b32 v90, v97, v89
    s_add_u32 s3, s37, s38
    v_mbcnt_lo_u32_b32 v98, vcc_lo, 0
    v_mbcnt_hi_u32_b32 v98, vcc_hi, v98
    s_bcnt1_i32_b64 s41, vcc
    v_lshl_add_u32 v98, v98, 2, s3
    s_mov_b64 exec, vcc
    ds_write_b32 v98, v90
    s_mov_b64 exec, -1
    s_lshl2_add_u32 s37, s41, s37
    s_branch L2_xr115
L2_xf115:
    s_waitcnt lgkmcnt(0)
    s_cmp_gt_u32 s37, 1024
    s_cbranch_scc1 L2_xs115
    s_cmp_lt_u32 s37, 768
    s_cbranch_scc1 L2_xl115
    ds_read_b32 v33, v98 offset:896
    s_add_u32 s3, s42, 2
    s_bitset1_b32 s43, s3
    s_branch L2_xg115
L2_xl115:
    v_mov_b32 v42, -1
    s_cmp_ge_u32 s37, 512
    s_cbranch_scc1 L2_xg115
    v_mov_b32 v43, -1
    s_cmp_ge_u32 s37, 256
    s_cbranch_scc1 L2_xg115
    v_mov_b32 v41, -1
    s_branch L2_xg115
L2_xs115:
    s_waitcnt lgkmcnt(0)
    v_mov_b32 v40, -1
    v_mov_b32 v41, -1
    v_mov_b32 v43, -1
    v_mov_b32 v42, -1
    s_add_u32 s3, s42, 2
    s_bitset1_b32 s36, s3
    s_branch L2_xg115
L2_c116:
    s_lshl_b64 s[52:53], s[82:83], 1
    s_andn2_b64 s[52:53], s[52:53], s[80:81]
    s_andn2_b64 s[52:53], s[52:53], s[54:55]
    s_or_b64 s[80:81], s[80:81], s[52:53]
    s_not_b64 vcc, s[52:53]
    s_mov_b64 exec, -1
    v_cndmask_b32_dpp v84, v84, v84, vcc wave_shr:1 row_mask:0xf bank_mask:0xf
    v_cndmask_b32_dpp v85, v85, v85, vcc wave_shr:1 row_mask:0xf bank_mask:0xf
    s_lshr_b64 s[52:53], s[52:53], 1
    v_cndmask_b32_dpp v86, v86, v86, vcc wave_shr:1 row_mask:0xf bank_mask:0xf
    v_cndmask_b32_dpp v87, v87, v87, vcc wave_shr:1 row_mask:0xf bank_mask:0xf
    s_andn2_b64 s[82:83], s[82:83], s[52:53]
    v_cndmask_b32_dpp v7, v7, v7, vcc wave_shr:1 row_mask:0xf bank_mask:0xf
    s_mov_b64 exec, s[54:55]
    s_cbranch_scc0 L2_d116
    s_mov_b64 exec, s[82:83]
    s_nop 1
    v_mfma_f32_4x4x4_16b_bf16 v[88:91], v[12:13], v[84:85], 0
    s_nop 1
    v_mfma_f32_4x4x4_16b_bf16 v[88:91], v[10:11], v[86:87], v[88:91]
    s_nop 4
    v_cvt_pk_bf16_f32 v88, v88, v89
    v_cvt_pk_bf16_f32 v89, v90, v91
    ds_pk_add_bf16 v7, v88 offset:65408
    ds_pk_add_bf16 v7, v89 offset:65412
    s_mov_b64 exec, s[54:55]
    s_branch L2_d116
L2_c117:
    s_lshl_b64 s[52:53], s[82:83], 1
    s_andn2_b64 s[52:53], s[52:53], s[80:81]
    s_andn2_b64 s[52:53], s[52:53], s[50:51]
    s_or_b64 s[80:81], s[80:81], s[52:53]
    s_not_b64 vcc, s[52:53]
    s_mov_b64 exec, -1
    v_cndmask_b32_dpp v84, v84, v84, vcc wave_shr:1 row_mask:0xf bank_mask:0xf
    v_cndmask_b32_dpp v85, v85, v85, vcc wave_shr:1 row_mask:0xf bank_mask:0xf
    s_lshr_b64 s[52:53], s[52:53], 1
    v_cndmask_b32_dpp v86, v86, v86, vcc wave_shr:1 row_mask:0xf bank_mask:0xf
    v_cndmask_b32_dpp v87, v87, v87, vcc wave_shr:1 row_mask:0xf bank_mask:0xf
    s_andn2_b64 s[82:83], s[82:83], s[52:53]
    v_cndmask_b32_dpp v7, v7, v7, vcc wave_shr:1 row_mask:0xf bank_mask:0xf
    s_mov_b64 exec, s[50:51]
    s_cbranch_scc0 L2_d117
    s_mov_b64 exec, s[82:83]
    s_nop 1
    v_mfma_f32_4x4x4_16b_bf16 v[88:91], v[12:13], v[84:85], 0
    s_nop 1
    v_mfma_f32_4x4x4_16b_bf16 v[88:91], v[10:11], v[86:87], v[88:91]
    s_nop 4
    v_cvt_pk_bf16_f32 v88, v88, v89
    v_cvt_pk_bf16_f32 v89, v90, v91
    ds_pk_add_bf16 v7, v88 offset:65408
    ds_pk_add_bf16 v7, v89 offset:65412
    s_mov_b64 exec, s[50:51]
    s_branch L2_d117
L2_oa118:
    v_and_b32 v47, 0x0fffffff, v32
    buffer_load_dword v114, v47, s[8:11], 0 offen offset:16
    s_mov_b64 exec, s[6:7]
    v_add_u32 v47, 8, v47
    v_lshrrev_b32 v32, 2, v32
    s_mov_b64 exec, -1
    buffer_load_dwordx2 v[112:113], v47, s[8:11], 0 offen
    s_branch L2_ob118
L2_c119:
    s_lshl_b64 s[52:53], s[82:83], 1
    s_andn2_b64 s[52:53], s[52:53], s[80:81]
    s_andn2_b64 s[52:53], s[52:53], s[54:55]
    s_or_b64 s[80:81], s[80:81], s[52:53]
    s_not_b64 vcc, s[52:53]
    s_mov_b64 exec, -1
    v_cndmask_b32_dpp v84, v84, v84, vcc wave_shr:1 row_mask:0xf bank_mask:0xf
    v_cndmask_b32_dpp v85, v85, v85, vcc wave_shr:1 row_mask:0xf bank_mask:0xf
    s_lshr_b64 s[52:53], s[52:53], 1
    v_cndmask_b32_dpp v86, v86, v86, vcc wave_shr:1 row_mask:0xf bank_mask:0xf
    v_cndmask_b32_dpp v87, v87, v87, vcc wave_shr:1 row_mask:0xf bank_mask:0xf
    s_andn2_b64 s[82:83], s[82:83], s[52:53]
    v_cndmask_b32_dpp v7, v7, v7, vcc wave_shr:1 row_mask:0xf bank_mask:0xf
    s_mov_b64 exec, s[54:55]
    s_cbranch_scc0 L2_d119
    s_mov_b64 exec, s[82:83]
    s_nop 1
    v_mfma_f32_4x4x4_16b_bf16 v[88:91], v[12:13], v[84:85], 0
    s_nop 1
    v_mfma_f32_4x4x4_16b_bf16 v[88:91], v[10:11], v[86:87], v[88:91]
    s_nop 4
    v_cvt_pk_bf16_f32 v88, v88, v89
    v_cvt_pk_bf16_f32 v89, v90, v91
    ds_pk_add_bf16 v7, v88 offset:65408
    ds_pk_add_bf16 v7, v89 offset:65412
    s_mov_b64 exec, s[54:55]
    s_branch L2_d119
L2_c120:
    s_lshl_b64 s[52:53], s[82:83], 1
    s_andn2_b64 s[52:53], s[52:53], s[80:81]
    s_andn2_b64 s[52:53], s[52:53], s[50:51]
    s_or_b64 s[80:81], s[80:81], s[52:53]
    s_not_b64 vcc, s[52:53]
    s_mov_b64 exec, -1
    v_cndmask_b32_dpp v84, v84, v84, vcc wave_shr:1 row_mask:0xf bank_mask:0xf
    v_cndmask_b32_dpp v85, v85, v85, vcc wave_shr:1 row_mask:0xf bank_mask:0xf
    s_lshr_b64 s[52:53], s[52:53], 1
    v_cndmask_b32_dpp v86, v86, v86, vcc wave_shr:1 row_mask:0xf bank_mask:0xf
    v_cndmask_b32_dpp v87, v87, v87, vcc wave_shr:1 row_mask:0xf bank_mask:0xf
    s_andn2_b64 s[82:83], s[82:83], s[52:53]
    v_cndmask_b32_dpp v7, v7, v7, vcc wave_shr:1 row_mask:0xf bank_mask:0xf
    s_mov_b64 exec, s[50:51]
    s_cbranch_scc0 L2_d120
    s_mov_b64 exec, s[82:83]
    s_nop 1
    v_mfma_f32_4x4x4_16b_bf16 v[88:91], v[12:13], v[84:85], 0
    s_nop 1
    v_mfma_f32_4x4x4_16b_bf16 v[88:91], v[10:11], v[86:87], v[88:91]
    s_nop 4
    v_cvt_pk_bf16_f32 v88, v88, v89
    v_cvt_pk_bf16_f32 v89, v90, v91
    ds_pk_add_bf16 v7, v88 offset:65408
    ds_pk_add_bf16 v7, v89 offset:65412
    s_mov_b64 exec, s[50:51]
    s_branch L2_d120
L2_c121:
    s_lshl_b64 s[52:53], s[82:83], 1
    s_andn2_b64 s[52:53], s[52:53], s[80:81]
    s_andn2_b64 s[52:53], s[52:53], s[54:55]
    s_or_b64 s[80:81], s[80:81], s[52:53]
    s_not_b64 vcc, s[52:53]
    s_mov_b64 exec, -1
    v_cndmask_b32_dpp v84, v84, v84, vcc wave_shr:1 row_mask:0xf bank_mask:0xf
    v_cndmask_b32_dpp v85, v85, v85, vcc wave_shr:1 row_mask:0xf bank_mask:0xf
    s_lshr_b64 s[52:53], s[52:53], 1
    v_cndmask_b32_dpp v86, v86, v86, vcc wave_shr:1 row_mask:0xf bank_mask:0xf
    v_cndmask_b32_dpp v87, v87, v87, vcc wave_shr:1 row_mask:0xf bank_mask:0xf
    s_andn2_b64 s[82:83], s[82:83], s[52:53]
    v_cndmask_b32_dpp v7, v7, v7, vcc wave_shr:1 row_mask:0xf bank_mask:0xf
    s_mov_b64 exec, s[54:55]
    s_cbranch_scc0 L2_d121
    s_mov_b64 exec, s[82:83]
    s_nop 1
    v_mfma_f32_4x4x4_16b_bf16 v[88:91], v[12:13], v[84:85], 0
    s_nop 1
    v_mfma_f32_4x4x4_16b_bf16 v[88:91], v[10:11], v[86:87], v[88:91]
    s_nop 4
    v_cvt_pk_bf16_f32 v88, v88, v89
    v_cvt_pk_bf16_f32 v89, v90, v91
    ds_pk_add_bf16 v7, v88 offset:65408
    ds_pk_add_bf16 v7, v89 offset:65412
    s_mov_b64 exec, s[54:55]
    s_branch L2_d121
L2_c122:
    s_lshl_b64 s[52:53], s[82:83], 1
    s_andn2_b64 s[52:53], s[52:53], s[80:81]
    s_andn2_b64 s[52:53], s[52:53], s[50:51]
    s_or_b64 s[80:81], s[80:81], s[52:53]
    s_not_b64 vcc, s[52:53]
    s_mov_b64 exec, -1
    v_cndmask_b32_dpp v84, v84, v84, vcc wave_shr:1 row_mask:0xf bank_mask:0xf
    v_cndmask_b32_dpp v85, v85, v85, vcc wave_shr:1 row_mask:0xf bank_mask:0xf
    s_lshr_b64 s[52:53], s[52:53], 1
    v_cndmask_b32_dpp v86, v86, v86, vcc wave_shr:1 row_mask:0xf bank_mask:0xf
    v_cndmask_b32_dpp v87, v87, v87, vcc wave_shr:1 row_mask:0xf bank_mask:0xf
    s_andn2_b64 s[82:83], s[82:83], s[52:53]
    v_cndmask_b32_dpp v7, v7, v7, vcc wave_shr:1 row_mask:0xf bank_mask:0xf
    s_mov_b64 exec, s[50:51]
    s_cbranch_scc0 L2_d122
    s_mov_b64 exec, s[82:83]
    s_nop 1
    v_mfma_f32_4x4x4_16b_bf16 v[88:91], v[12:13], v[84:85], 0
    s_nop 1
    v_mfma_f32_4x4x4_16b_bf16 v[88:91], v[10:11], v[86:87], v[88:91]
    s_nop 4
    v_cvt_pk_bf16_f32 v88, v88, v89
    v_cvt_pk_bf16_f32 v89, v90, v91
    ds_pk_add_bf16 v7, v88 offset:65408
    ds_pk_add_bf16 v7, v89 offset:65412
    s_mov_b64 exec, s[50:51]
    s_branch L2_d122
L2_c123:
    s_lshl_b64 s[52:53], s[82:83], 1
    s_andn2_b64 s[52:53], s[52:53], s[80:81]
    s_andn2_b64 s[52:53], s[52:53], s[54:55]
    s_or_b64 s[80:81], s[80:81], s[52:53]
    s_not_b64 vcc, s[52:53]
    s_mov_b64 exec, -1
    v_cndmask_b32_dpp v84, v84, v84, vcc wave_shr:1 row_mask:0xf bank_mask:0xf
    v_cndmask_b32_dpp v85, v85, v85, vcc wave_shr:1 row_mask:0xf bank_mask:0xf
    s_lshr_b64 s[52:53], s[52:53], 1
    v_cndmask_b32_dpp v86, v86, v86, vcc wave_shr:1 row_mask:0xf bank_mask:0xf
    v_cndmask_b32_dpp v87, v87, v87, vcc wave_shr:1 row_mask:0xf bank_mask:0xf
    s_andn2_b64 s[82:83], s[82:83], s[52:53]
    v_cndmask_b32_dpp v7, v7, v7, vcc wave_shr:1 row_mask:0xf bank_mask:0xf
    s_mov_b64 exec, s[54:55]
    s_cbranch_scc0 L2_d123
    s_mov_b64 exec, s[82:83]
    s_nop 1
    v_mfma_f32_4x4x4_16b_bf16 v[88:91], v[12:13], v[84:85], 0
    s_nop 1
    v_mfma_f32_4x4x4_16b_bf16 v[88:91], v[10:11], v[86:87], v[88:91]
    s_nop 4
    v_cvt_pk_bf16_f32 v88, v88, v89
    v_cvt_pk_bf16_f32 v89, v90, v91
    ds_pk_add_bf16 v7, v88 offset:65408
    ds_pk_add_bf16 v7, v89 offset:65412
    s_mov_b64 exec, s[54:55]
    s_branch L2_d123
L2_c124:
    s_lshl_b64 s[52:53], s[82:83], 1
    s_andn2_b64 s[52:53], s[52:53], s[80:81]
    s_andn2_b64 s[52:53], s[52:53], s[50:51]
    s_or_b64 s[80:81], s[80:81], s[52:53]
    s_not_b64 vcc, s[52:53]
    s_mov_b64 exec, -1
    v_cndmask_b32_dpp v84, v84, v84, vcc wave_shr:1 row_mask:0xf bank_mask:0xf
    v_cndmask_b32_dpp v85, v85, v85, vcc wave_shr:1 row_mask:0xf bank_mask:0xf
    s_lshr_b64 s[52:53], s[52:53], 1
    v_cndmask_b32_dpp v86, v86, v86, vcc wave_shr:1 row_mask:0xf bank_mask:0xf
    v_cndmask_b32_dpp v87, v87, v87, vcc wave_shr:1 row_mask:0xf bank_mask:0xf
    s_andn2_b64 s[82:83], s[82:83], s[52:53]
    v_cndmask_b32_dpp v7, v7, v7, vcc wave_shr:1 row_mask:0xf bank_mask:0xf
    s_mov_b64 exec, s[50:51]
    s_cbranch_scc0 L2_d124
    s_mov_b64 exec, s[82:83]
    s_nop 1
    v_mfma_f32_4x4x4_16b_bf16 v[88:91], v[12:13], v[84:85], 0
    s_nop 1
    v_mfma_f32_4x4x4_16b_bf16 v[88:91], v[10:11], v[86:87], v[88:91]
    s_nop 4
    v_cvt_pk_bf16_f32 v88, v88, v89
    v_cvt_pk_bf16_f32 v89, v90, v91
    ds_pk_add_bf16 v7, v88 offset:65408
    ds_pk_add_bf16 v7, v89 offset:65412
    s_mov_b64 exec, s[50:51]
    s_branch L2_d124
L2_oa125:
    s_waitcnt vmcnt(3)
    s_mov_b64 exec, s[6:7]
    v_lshrrev_b32 v114, 16, v114
    s_mov_b64 exec, -1
    v_and_b32 v46, 0x10000000, v32
    v_cmpx_eq_u32 vcc, 0, v46
    v_lshrrev_b32 v47, 14, v112
    v_and_b32 v47, v5, v47
    ds_read_b64 v[96:97], v47
    v_perm_b32 v98, v112, v114, s44
    v_bitop3_b32 v99, v112, 0.5, -0.5 bitop3:0xa8
    v_bitop3_b32 v98, v6, v98, v99 bitop3:0xca
    v_and_b32 v47, v5, v112
    s_waitcnt lgkmcnt(0)
    v_mfma_f32_4x4x4_16b_bf16 v[88:91], v[8:9], v[96:97], 0
    s_nop 4
    v_mul_f32 v88, v98, v88
    v_mul_f32 v89, v98, v89
    v_mul_f32 v90, v98, v90
    v_mul_f32 v91, v98, v91
    v_cvt_pk_bf16_f32 v88, v88, v89
    v_cvt_pk_bf16_f32 v89, v90, v91
    ds_pk_add_bf16 v47, v88 offset:65408
    ds_pk_add_bf16 v47, v89 offset:65412
    s_mov_b64 exec, -1
    v_and_b32 v46, 0x20000000, v32
    v_cmpx_eq_u32 vcc, 0, v46
    v_lshrrev_b32 v47, 14, v113
    v_and_b32 v47, v5, v47
    ds_read_b64 v[96:97], v47
    v_perm_b32 v98, v113, v114, s45
    v_bitop3_b32 v99, v113, 0.5, -0.5 bitop3:0xa8
    v_bitop3_b32 v98, v6, v98, v99 bitop3:0xca
    v_and_b32 v47, v5, v113
    s_waitcnt lgkmcnt(0)
    v_mfma_f32_4x4x4_16b_bf16 v[88:91], v[8:9], v[96:97], 0
    s_nop 4
    v_mul_f32 v88, v98, v88
    v_mul_f32 v89, v98, v89
    v_mul_f32 v90, v98, v90
    v_mul_f32 v91, v98, v91
    v_cvt_pk_bf16_f32 v88, v88, v89
    v_cvt_pk_bf16_f32 v89, v90, v91
    ds_pk_add_bf16 v47, v88 offset:65408
    ds_pk_add_bf16 v47, v89 offset:65412
    s_mov_b64 exec, -1
    s_branch L2_ob125
L2_c126:
    s_lshl_b64 s[52:53], s[82:83], 1
    s_andn2_b64 s[52:53], s[52:53], s[80:81]
    s_andn2_b64 s[52:53], s[52:53], s[54:55]
    s_or_b64 s[80:81], s[80:81], s[52:53]
    s_not_b64 vcc, s[52:53]
    s_mov_b64 exec, -1
    v_cndmask_b32_dpp v84, v84, v84, vcc wave_shr:1 row_mask:0xf bank_mask:0xf
    v_cndmask_b32_dpp v85, v85, v85, vcc wave_shr:1 row_mask:0xf bank_mask:0xf
    s_lshr_b64 s[52:53], s[52:53], 1
    v_cndmask_b32_dpp v86, v86, v86, vcc wave_shr:1 row_mask:0xf bank_mask:0xf
    v_cndmask_b32_dpp v87, v87, v87, vcc wave_shr:1 row_mask:0xf bank_mask:0xf
    s_andn2_b64 s[82:83], s[82:83], s[52:53]
    v_cndmask_b32_dpp v7, v7, v7, vcc wave_shr:1 row_mask:0xf bank_mask:0xf
    s_mov_b64 exec, s[54:55]
    s_cbranch_scc0 L2_d126
    s_mov_b64 exec, s[82:83]
    s_nop 1
    v_mfma_f32_4x4x4_16b_bf16 v[88:91], v[12:13], v[84:85], 0
    s_nop 1
    v_mfma_f32_4x4x4_16b_bf16 v[88:91], v[10:11], v[86:87], v[88:91]
    s_nop 4
    v_cvt_pk_bf16_f32 v88, v88, v89
    v_cvt_pk_bf16_f32 v89, v90, v91
    ds_pk_add_bf16 v7, v88 offset:65408
    ds_pk_add_bf16 v7, v89 offset:65412
    s_mov_b64 exec, s[54:55]
    s_branch L2_d126
L2_c127:
    s_lshl_b64 s[52:53], s[82:83], 1
    s_andn2_b64 s[52:53], s[52:53], s[80:81]
    s_andn2_b64 s[52:53], s[52:53], s[50:51]
    s_or_b64 s[80:81], s[80:81], s[52:53]
    s_not_b64 vcc, s[52:53]
    s_mov_b64 exec, -1
    v_cndmask_b32_dpp v84, v84, v84, vcc wave_shr:1 row_mask:0xf bank_mask:0xf
    v_cndmask_b32_dpp v85, v85, v85, vcc wave_shr:1 row_mask:0xf bank_mask:0xf
    s_lshr_b64 s[52:53], s[52:53], 1
    v_cndmask_b32_dpp v86, v86, v86, vcc wave_shr:1 row_mask:0xf bank_mask:0xf
    v_cndmask_b32_dpp v87, v87, v87, vcc wave_shr:1 row_mask:0xf bank_mask:0xf
    s_andn2_b64 s[82:83], s[82:83], s[52:53]
    v_cndmask_b32_dpp v7, v7, v7, vcc wave_shr:1 row_mask:0xf bank_mask:0xf
    s_mov_b64 exec, s[50:51]
    s_cbranch_scc0 L2_d127
    s_mov_b64 exec, s[82:83]
    s_nop 1
    v_mfma_f32_4x4x4_16b_bf16 v[88:91], v[12:13], v[84:85], 0
    s_nop 1
    v_mfma_f32_4x4x4_16b_bf16 v[88:91], v[10:11], v[86:87], v[88:91]
    s_nop 4
    v_cvt_pk_bf16_f32 v88, v88, v89
    v_cvt_pk_bf16_f32 v89, v90, v91
    ds_pk_add_bf16 v7, v88 offset:65408
    ds_pk_add_bf16 v7, v89 offset:65412
    s_mov_b64 exec, s[50:51]
    s_branch L2_d127
L2_c128:
    s_lshl_b64 s[52:53], s[82:83], 1
    s_andn2_b64 s[52:53], s[52:53], s[80:81]
    s_andn2_b64 s[52:53], s[52:53], s[54:55]
    s_or_b64 s[80:81], s[80:81], s[52:53]
    s_not_b64 vcc, s[52:53]
    s_mov_b64 exec, -1
    v_cndmask_b32_dpp v84, v84, v84, vcc wave_shr:1 row_mask:0xf bank_mask:0xf
    v_cndmask_b32_dpp v85, v85, v85, vcc wave_shr:1 row_mask:0xf bank_mask:0xf
    s_lshr_b64 s[52:53], s[52:53], 1
    v_cndmask_b32_dpp v86, v86, v86, vcc wave_shr:1 row_mask:0xf bank_mask:0xf
    v_cndmask_b32_dpp v87, v87, v87, vcc wave_shr:1 row_mask:0xf bank_mask:0xf
    s_andn2_b64 s[82:83], s[82:83], s[52:53]
    v_cndmask_b32_dpp v7, v7, v7, vcc wave_shr:1 row_mask:0xf bank_mask:0xf
    s_mov_b64 exec, s[54:55]
    s_cbranch_scc0 L2_d128
    s_mov_b64 exec, s[82:83]
    s_nop 1
    v_mfma_f32_4x4x4_16b_bf16 v[88:91], v[12:13], v[84:85], 0
    s_nop 1
    v_mfma_f32_4x4x4_16b_bf16 v[88:91], v[10:11], v[86:87], v[88:91]
    s_nop 4
    v_cvt_pk_bf16_f32 v88, v88, v89
    v_cvt_pk_bf16_f32 v89, v90, v91
    ds_pk_add_bf16 v7, v88 offset:65408
    ds_pk_add_bf16 v7, v89 offset:65412
    s_mov_b64 exec, s[54:55]
    s_branch L2_d128
L2_c129:
    s_lshl_b64 s[52:53], s[82:83], 1
    s_andn2_b64 s[52:53], s[52:53], s[80:81]
    s_andn2_b64 s[52:53], s[52:53], s[50:51]
    s_or_b64 s[80:81], s[80:81], s[52:53]
    s_not_b64 vcc, s[52:53]
    s_mov_b64 exec, -1
    v_cndmask_b32_dpp v84, v84, v84, vcc wave_shr:1 row_mask:0xf bank_mask:0xf
    v_cndmask_b32_dpp v85, v85, v85, vcc wave_shr:1 row_mask:0xf bank_mask:0xf
    s_lshr_b64 s[52:53], s[52:53], 1
    v_cndmask_b32_dpp v86, v86, v86, vcc wave_shr:1 row_mask:0xf bank_mask:0xf
    v_cndmask_b32_dpp v87, v87, v87, vcc wave_shr:1 row_mask:0xf bank_mask:0xf
    s_andn2_b64 s[82:83], s[82:83], s[52:53]
    v_cndmask_b32_dpp v7, v7, v7, vcc wave_shr:1 row_mask:0xf bank_mask:0xf
    s_mov_b64 exec, s[50:51]
    s_cbranch_scc0 L2_d129
    s_mov_b64 exec, s[82:83]
    s_nop 1
    v_mfma_f32_4x4x4_16b_bf16 v[88:91], v[12:13], v[84:85], 0
    s_nop 1
    v_mfma_f32_4x4x4_16b_bf16 v[88:91], v[10:11], v[86:87], v[88:91]
    s_nop 4
    v_cvt_pk_bf16_f32 v88, v88, v89
    v_cvt_pk_bf16_f32 v89, v90, v91
    ds_pk_add_bf16 v7, v88 offset:65408
    ds_pk_add_bf16 v7, v89 offset:65412
    s_mov_b64 exec, s[50:51]
    s_branch L2_d129
L2_c130:
    s_lshl_b64 s[52:53], s[82:83], 1
    s_andn2_b64 s[52:53], s[52:53], s[80:81]
    s_andn2_b64 s[52:53], s[52:53], s[54:55]
    s_or_b64 s[80:81], s[80:81], s[52:53]
    s_not_b64 vcc, s[52:53]
    s_mov_b64 exec, -1
    v_cndmask_b32_dpp v84, v84, v84, vcc wave_shr:1 row_mask:0xf bank_mask:0xf
    v_cndmask_b32_dpp v85, v85, v85, vcc wave_shr:1 row_mask:0xf bank_mask:0xf
    s_lshr_b64 s[52:53], s[52:53], 1
    v_cndmask_b32_dpp v86, v86, v86, vcc wave_shr:1 row_mask:0xf bank_mask:0xf
    v_cndmask_b32_dpp v87, v87, v87, vcc wave_shr:1 row_mask:0xf bank_mask:0xf
    s_andn2_b64 s[82:83], s[82:83], s[52:53]
    v_cndmask_b32_dpp v7, v7, v7, vcc wave_shr:1 row_mask:0xf bank_mask:0xf
    s_mov_b64 exec, s[54:55]
    s_cbranch_scc0 L2_d130
    s_mov_b64 exec, s[82:83]
    s_nop 1
    v_mfma_f32_4x4x4_16b_bf16 v[88:91], v[12:13], v[84:85], 0
    s_nop 1
    v_mfma_f32_4x4x4_16b_bf16 v[88:91], v[10:11], v[86:87], v[88:91]
    s_nop 4
    v_cvt_pk_bf16_f32 v88, v88, v89
    v_cvt_pk_bf16_f32 v89, v90, v91
    ds_pk_add_bf16 v7, v88 offset:65408
    ds_pk_add_bf16 v7, v89 offset:65412
    s_mov_b64 exec, s[54:55]
    s_branch L2_d130
L2_c131:
    s_lshl_b64 s[52:53], s[82:83], 1
    s_andn2_b64 s[52:53], s[52:53], s[80:81]
    s_andn2_b64 s[52:53], s[52:53], s[50:51]
    s_or_b64 s[80:81], s[80:81], s[52:53]
    s_not_b64 vcc, s[52:53]
    s_mov_b64 exec, -1
    v_cndmask_b32_dpp v84, v84, v84, vcc wave_shr:1 row_mask:0xf bank_mask:0xf
    v_cndmask_b32_dpp v85, v85, v85, vcc wave_shr:1 row_mask:0xf bank_mask:0xf
    s_lshr_b64 s[52:53], s[52:53], 1
    v_cndmask_b32_dpp v86, v86, v86, vcc wave_shr:1 row_mask:0xf bank_mask:0xf
    v_cndmask_b32_dpp v87, v87, v87, vcc wave_shr:1 row_mask:0xf bank_mask:0xf
    s_andn2_b64 s[82:83], s[82:83], s[52:53]
    v_cndmask_b32_dpp v7, v7, v7, vcc wave_shr:1 row_mask:0xf bank_mask:0xf
    s_mov_b64 exec, s[50:51]
    s_cbranch_scc0 L2_d131
    s_mov_b64 exec, s[82:83]
    s_nop 1
    v_mfma_f32_4x4x4_16b_bf16 v[88:91], v[12:13], v[84:85], 0
    s_nop 1
    v_mfma_f32_4x4x4_16b_bf16 v[88:91], v[10:11], v[86:87], v[88:91]
    s_nop 4
    v_cvt_pk_bf16_f32 v88, v88, v89
    v_cvt_pk_bf16_f32 v89, v90, v91
    ds_pk_add_bf16 v7, v88 offset:65408
    ds_pk_add_bf16 v7, v89 offset:65412
    s_mov_b64 exec, s[50:51]
    s_branch L2_d131
L2_c132:
    s_lshl_b64 s[52:53], s[82:83], 1
    s_andn2_b64 s[52:53], s[52:53], s[80:81]
    s_andn2_b64 s[52:53], s[52:53], s[54:55]
    s_or_b64 s[80:81], s[80:81], s[52:53]
    s_not_b64 vcc, s[52:53]
    s_mov_b64 exec, -1
    v_cndmask_b32_dpp v84, v84, v84, vcc wave_shr:1 row_mask:0xf bank_mask:0xf
    v_cndmask_b32_dpp v85, v85, v85, vcc wave_shr:1 row_mask:0xf bank_mask:0xf
    s_lshr_b64 s[52:53], s[52:53], 1
    v_cndmask_b32_dpp v86, v86, v86, vcc wave_shr:1 row_mask:0xf bank_mask:0xf
    v_cndmask_b32_dpp v87, v87, v87, vcc wave_shr:1 row_mask:0xf bank_mask:0xf
    s_andn2_b64 s[82:83], s[82:83], s[52:53]
    v_cndmask_b32_dpp v7, v7, v7, vcc wave_shr:1 row_mask:0xf bank_mask:0xf
    s_mov_b64 exec, s[54:55]
    s_cbranch_scc0 L2_d132
    s_mov_b64 exec, s[82:83]
    s_nop 1
    v_mfma_f32_4x4x4_16b_bf16 v[88:91], v[12:13], v[84:85], 0
    s_nop 1
    v_mfma_f32_4x4x4_16b_bf16 v[88:91], v[10:11], v[86:87], v[88:91]
    s_nop 4
    v_cvt_pk_bf16_f32 v88, v88, v89
    v_cvt_pk_bf16_f32 v89, v90, v91
    ds_pk_add_bf16 v7, v88 offset:65408
    ds_pk_add_bf16 v7, v89 offset:65412
    s_mov_b64 exec, s[54:55]
    s_branch L2_d132
L2_c133:
    s_lshl_b64 s[52:53], s[82:83], 1
    s_andn2_b64 s[52:53], s[52:53], s[80:81]
    s_andn2_b64 s[52:53], s[52:53], s[50:51]
    s_or_b64 s[80:81], s[80:81], s[52:53]
    s_not_b64 vcc, s[52:53]
    s_mov_b64 exec, -1
    v_cndmask_b32_dpp v84, v84, v84, vcc wave_shr:1 row_mask:0xf bank_mask:0xf
    v_cndmask_b32_dpp v85, v85, v85, vcc wave_shr:1 row_mask:0xf bank_mask:0xf
    s_lshr_b64 s[52:53], s[52:53], 1
    v_cndmask_b32_dpp v86, v86, v86, vcc wave_shr:1 row_mask:0xf bank_mask:0xf
    v_cndmask_b32_dpp v87, v87, v87, vcc wave_shr:1 row_mask:0xf bank_mask:0xf
    s_andn2_b64 s[82:83], s[82:83], s[52:53]
    v_cndmask_b32_dpp v7, v7, v7, vcc wave_shr:1 row_mask:0xf bank_mask:0xf
    s_mov_b64 exec, s[50:51]
    s_cbranch_scc0 L2_d133
    s_mov_b64 exec, s[82:83]
    s_nop 1
    v_mfma_f32_4x4x4_16b_bf16 v[88:91], v[12:13], v[84:85], 0
    s_nop 1
    v_mfma_f32_4x4x4_16b_bf16 v[88:91], v[10:11], v[86:87], v[88:91]
    s_nop 4
    v_cvt_pk_bf16_f32 v88, v88, v89
    v_cvt_pk_bf16_f32 v89, v90, v91
    ds_pk_add_bf16 v7, v88 offset:65408
    ds_pk_add_bf16 v7, v89 offset:65412
    s_mov_b64 exec, s[50:51]
    s_branch L2_d133
L2_oa134:
    v_and_b32 v47, 0x0fffffff, v33
    buffer_load_dword v114, v47, s[8:11], 0 offen offset:16
    s_mov_b64 exec, s[6:7]
    v_add_u32 v47, 8, v47
    v_lshrrev_b32 v33, 2, v33
    s_mov_b64 exec, -1
    buffer_load_dwordx2 v[112:113], v47, s[8:11], 0 offen
    s_branch L2_ob134
L2_c135:
    s_lshl_b64 s[52:53], s[82:83], 1
    s_andn2_b64 s[52:53], s[52:53], s[80:81]
    s_andn2_b64 s[52:53], s[52:53], s[54:55]
    s_or_b64 s[80:81], s[80:81], s[52:53]
    s_not_b64 vcc, s[52:53]
    s_mov_b64 exec, -1
    v_cndmask_b32_dpp v84, v84, v84, vcc wave_shr:1 row_mask:0xf bank_mask:0xf
    v_cndmask_b32_dpp v85, v85, v85, vcc wave_shr:1 row_mask:0xf bank_mask:0xf
    s_lshr_b64 s[52:53], s[52:53], 1
    v_cndmask_b32_dpp v86, v86, v86, vcc wave_shr:1 row_mask:0xf bank_mask:0xf
    v_cndmask_b32_dpp v87, v87, v87, vcc wave_shr:1 row_mask:0xf bank_mask:0xf
    s_andn2_b64 s[82:83], s[82:83], s[52:53]
    v_cndmask_b32_dpp v7, v7, v7, vcc wave_shr:1 row_mask:0xf bank_mask:0xf
    s_mov_b64 exec, s[54:55]
    s_cbranch_scc0 L2_d135
    s_mov_b64 exec, s[82:83]
    s_nop 1
    v_mfma_f32_4x4x4_16b_bf16 v[88:91], v[12:13], v[84:85], 0
    s_nop 1
    v_mfma_f32_4x4x4_16b_bf16 v[88:91], v[10:11], v[86:87], v[88:91]
    s_nop 4
    v_cvt_pk_bf16_f32 v88, v88, v89
    v_cvt_pk_bf16_f32 v89, v90, v91
    ds_pk_add_bf16 v7, v88 offset:65408
    ds_pk_add_bf16 v7, v89 offset:65412
    s_mov_b64 exec, s[54:55]
    s_branch L2_d135
L2_c136:
    s_lshl_b64 s[52:53], s[82:83], 1
    s_andn2_b64 s[52:53], s[52:53], s[80:81]
    s_andn2_b64 s[52:53], s[52:53], s[50:51]
    s_or_b64 s[80:81], s[80:81], s[52:53]
    s_not_b64 vcc, s[52:53]
    s_mov_b64 exec, -1
    v_cndmask_b32_dpp v84, v84, v84, vcc wave_shr:1 row_mask:0xf bank_mask:0xf
    v_cndmask_b32_dpp v85, v85, v85, vcc wave_shr:1 row_mask:0xf bank_mask:0xf
    s_lshr_b64 s[52:53], s[52:53], 1
    v_cndmask_b32_dpp v86, v86, v86, vcc wave_shr:1 row_mask:0xf bank_mask:0xf
    v_cndmask_b32_dpp v87, v87, v87, vcc wave_shr:1 row_mask:0xf bank_mask:0xf
    s_andn2_b64 s[82:83], s[82:83], s[52:53]
    v_cndmask_b32_dpp v7, v7, v7, vcc wave_shr:1 row_mask:0xf bank_mask:0xf
    s_mov_b64 exec, s[50:51]
    s_cbranch_scc0 L2_d136
    s_mov_b64 exec, s[82:83]
    s_nop 1
    v_mfma_f32_4x4x4_16b_bf16 v[88:91], v[12:13], v[84:85], 0
    s_nop 1
    v_mfma_f32_4x4x4_16b_bf16 v[88:91], v[10:11], v[86:87], v[88:91]
    s_nop 4
    v_cvt_pk_bf16_f32 v88, v88, v89
    v_cvt_pk_bf16_f32 v89, v90, v91
    ds_pk_add_bf16 v7, v88 offset:65408
    ds_pk_add_bf16 v7, v89 offset:65412
    s_mov_b64 exec, s[50:51]
    s_branch L2_d136
L2_c137:
    s_lshl_b64 s[52:53], s[82:83], 1
    s_andn2_b64 s[52:53], s[52:53], s[80:81]
    s_andn2_b64 s[52:53], s[52:53], s[54:55]
    s_or_b64 s[80:81], s[80:81], s[52:53]
    s_not_b64 vcc, s[52:53]
    s_mov_b64 exec, -1
    v_cndmask_b32_dpp v84, v84, v84, vcc wave_shr:1 row_mask:0xf bank_mask:0xf
    v_cndmask_b32_dpp v85, v85, v85, vcc wave_shr:1 row_mask:0xf bank_mask:0xf
    s_lshr_b64 s[52:53], s[52:53], 1
    v_cndmask_b32_dpp v86, v86, v86, vcc wave_shr:1 row_mask:0xf bank_mask:0xf
    v_cndmask_b32_dpp v87, v87, v87, vcc wave_shr:1 row_mask:0xf bank_mask:0xf
    s_andn2_b64 s[82:83], s[82:83], s[52:53]
    v_cndmask_b32_dpp v7, v7, v7, vcc wave_shr:1 row_mask:0xf bank_mask:0xf
    s_mov_b64 exec, s[54:55]
    s_cbranch_scc0 L2_d137
    s_mov_b64 exec, s[82:83]
    s_nop 1
    v_mfma_f32_4x4x4_16b_bf16 v[88:91], v[12:13], v[84:85], 0
    s_nop 1
    v_mfma_f32_4x4x4_16b_bf16 v[88:91], v[10:11], v[86:87], v[88:91]
    s_nop 4
    v_cvt_pk_bf16_f32 v88, v88, v89
    v_cvt_pk_bf16_f32 v89, v90, v91
    ds_pk_add_bf16 v7, v88 offset:65408
    ds_pk_add_bf16 v7, v89 offset:65412
    s_mov_b64 exec, s[54:55]
    s_branch L2_d137
L2_c138:
    s_lshl_b64 s[52:53], s[82:83], 1
    s_andn2_b64 s[52:53], s[52:53], s[80:81]
    s_andn2_b64 s[52:53], s[52:53], s[50:51]
    s_or_b64 s[80:81], s[80:81], s[52:53]
    s_not_b64 vcc, s[52:53]
    s_mov_b64 exec, -1
    v_cndmask_b32_dpp v84, v84, v84, vcc wave_shr:1 row_mask:0xf bank_mask:0xf
    v_cndmask_b32_dpp v85, v85, v85, vcc wave_shr:1 row_mask:0xf bank_mask:0xf
    s_lshr_b64 s[52:53], s[52:53], 1
    v_cndmask_b32_dpp v86, v86, v86, vcc wave_shr:1 row_mask:0xf bank_mask:0xf
    v_cndmask_b32_dpp v87, v87, v87, vcc wave_shr:1 row_mask:0xf bank_mask:0xf
    s_andn2_b64 s[82:83], s[82:83], s[52:53]
    v_cndmask_b32_dpp v7, v7, v7, vcc wave_shr:1 row_mask:0xf bank_mask:0xf
    s_mov_b64 exec, s[50:51]
    s_cbranch_scc0 L2_d138
    s_mov_b64 exec, s[82:83]
    s_nop 1
    v_mfma_f32_4x4x4_16b_bf16 v[88:91], v[12:13], v[84:85], 0
    s_nop 1
    v_mfma_f32_4x4x4_16b_bf16 v[88:91], v[10:11], v[86:87], v[88:91]
    s_nop 4
    v_cvt_pk_bf16_f32 v88, v88, v89
    v_cvt_pk_bf16_f32 v89, v90, v91
    ds_pk_add_bf16 v7, v88 offset:65408
    ds_pk_add_bf16 v7, v89 offset:65412
    s_mov_b64 exec, s[50:51]
    s_branch L2_d138
L2_c139:
    s_lshl_b64 s[52:53], s[82:83], 1
    s_andn2_b64 s[52:53], s[52:53], s[80:81]
    s_andn2_b64 s[52:53], s[52:53], s[54:55]
    s_or_b64 s[80:81], s[80:81], s[52:53]
    s_not_b64 vcc, s[52:53]
    s_mov_b64 exec, -1
    v_cndmask_b32_dpp v84, v84, v84, vcc wave_shr:1 row_mask:0xf bank_mask:0xf
    v_cndmask_b32_dpp v85, v85, v85, vcc wave_shr:1 row_mask:0xf bank_mask:0xf
    s_lshr_b64 s[52:53], s[52:53], 1
    v_cndmask_b32_dpp v86, v86, v86, vcc wave_shr:1 row_mask:0xf bank_mask:0xf
    v_cndmask_b32_dpp v87, v87, v87, vcc wave_shr:1 row_mask:0xf bank_mask:0xf
    s_andn2_b64 s[82:83], s[82:83], s[52:53]
    v_cndmask_b32_dpp v7, v7, v7, vcc wave_shr:1 row_mask:0xf bank_mask:0xf
    s_mov_b64 exec, s[54:55]
    s_cbranch_scc0 L2_d139
    s_mov_b64 exec, s[82:83]
    s_nop 1
    v_mfma_f32_4x4x4_16b_bf16 v[88:91], v[12:13], v[84:85], 0
    s_nop 1
    v_mfma_f32_4x4x4_16b_bf16 v[88:91], v[10:11], v[86:87], v[88:91]
    s_nop 4
    v_cvt_pk_bf16_f32 v88, v88, v89
    v_cvt_pk_bf16_f32 v89, v90, v91
    ds_pk_add_bf16 v7, v88 offset:65408
    ds_pk_add_bf16 v7, v89 offset:65412
    s_mov_b64 exec, s[54:55]
    s_branch L2_d139
L2_c140:
    s_lshl_b64 s[52:53], s[82:83], 1
    s_andn2_b64 s[52:53], s[52:53], s[80:81]
    s_andn2_b64 s[52:53], s[52:53], s[50:51]
    s_or_b64 s[80:81], s[80:81], s[52:53]
    s_not_b64 vcc, s[52:53]
    s_mov_b64 exec, -1
    v_cndmask_b32_dpp v84, v84, v84, vcc wave_shr:1 row_mask:0xf bank_mask:0xf
    v_cndmask_b32_dpp v85, v85, v85, vcc wave_shr:1 row_mask:0xf bank_mask:0xf
    s_lshr_b64 s[52:53], s[52:53], 1
    v_cndmask_b32_dpp v86, v86, v86, vcc wave_shr:1 row_mask:0xf bank_mask:0xf
    v_cndmask_b32_dpp v87, v87, v87, vcc wave_shr:1 row_mask:0xf bank_mask:0xf
    s_andn2_b64 s[82:83], s[82:83], s[52:53]
    v_cndmask_b32_dpp v7, v7, v7, vcc wave_shr:1 row_mask:0xf bank_mask:0xf
    s_mov_b64 exec, s[50:51]
    s_cbranch_scc0 L2_d140
    s_mov_b64 exec, s[82:83]
    s_nop 1
    v_mfma_f32_4x4x4_16b_bf16 v[88:91], v[12:13], v[84:85], 0
    s_nop 1
    v_mfma_f32_4x4x4_16b_bf16 v[88:91], v[10:11], v[86:87], v[88:91]
    s_nop 4
    v_cvt_pk_bf16_f32 v88, v88, v89
    v_cvt_pk_bf16_f32 v89, v90, v91
    ds_pk_add_bf16 v7, v88 offset:65408
    ds_pk_add_bf16 v7, v89 offset:65412
    s_mov_b64 exec, s[50:51]
    s_branch L2_d140
L2_oa141:
    s_waitcnt vmcnt(0)
    s_mov_b64 exec, s[6:7]
    v_lshrrev_b32 v114, 16, v114
    s_mov_b64 exec, -1
    v_and_b32 v46, 0x10000000, v33
    v_cmpx_eq_u32 vcc, 0, v46
    v_lshrrev_b32 v47, 14, v112
    v_and_b32 v47, v5, v47
    ds_read_b64 v[96:97], v47
    v_perm_b32 v98, v112, v114, s44
    v_bitop3_b32 v99, v112, 0.5, -0.5 bitop3:0xa8
    v_bitop3_b32 v98, v6, v98, v99 bitop3:0xca
    v_and_b32 v47, v5, v112
    s_waitcnt lgkmcnt(0)
    v_mfma_f32_4x4x4_16b_bf16 v[88:91], v[8:9], v[96:97], 0
    s_nop 4
    v_mul_f32 v88, v98, v88
    v_mul_f32 v89, v98, v89
    v_mul_f32 v90, v98, v90
    v_mul_f32 v91, v98, v91
    v_cvt_pk_bf16_f32 v88, v88, v89
    v_cvt_pk_bf16_f32 v89, v90, v91
    ds_pk_add_bf16 v47, v88 offset:65408
    ds_pk_add_bf16 v47, v89 offset:65412
    s_mov_b64 exec, -1
    v_and_b32 v46, 0x20000000, v33
    v_cmpx_eq_u32 vcc, 0, v46
    v_lshrrev_b32 v47, 14, v113
    v_and_b32 v47, v5, v47
    ds_read_b64 v[96:97], v47
    v_perm_b32 v98, v113, v114, s45
    v_bitop3_b32 v99, v113, 0.5, -0.5 bitop3:0xa8
    v_bitop3_b32 v98, v6, v98, v99 bitop3:0xca
    v_and_b32 v47, v5, v113
    s_waitcnt lgkmcnt(0)
    v_mfma_f32_4x4x4_16b_bf16 v[88:91], v[8:9], v[96:97], 0
    s_nop 4
    v_mul_f32 v88, v98, v88
    v_mul_f32 v89, v98, v89
    v_mul_f32 v90, v98, v90
    v_mul_f32 v91, v98, v91
    v_cvt_pk_bf16_f32 v88, v88, v89
    v_cvt_pk_bf16_f32 v89, v90, v91
    ds_pk_add_bf16 v47, v88 offset:65408
    ds_pk_add_bf16 v47, v89 offset:65412
    s_mov_b64 exec, -1
    s_branch L2_ob141
L2_c142:
    s_lshl_b64 s[52:53], s[82:83], 1
    s_andn2_b64 s[52:53], s[52:53], s[80:81]
    s_andn2_b64 s[52:53], s[52:53], s[54:55]
    s_or_b64 s[80:81], s[80:81], s[52:53]
    s_not_b64 vcc, s[52:53]
    s_mov_b64 exec, -1
    v_cndmask_b32_dpp v84, v84, v84, vcc wave_shr:1 row_mask:0xf bank_mask:0xf
    v_cndmask_b32_dpp v85, v85, v85, vcc wave_shr:1 row_mask:0xf bank_mask:0xf
    s_lshr_b64 s[52:53], s[52:53], 1
    v_cndmask_b32_dpp v86, v86, v86, vcc wave_shr:1 row_mask:0xf bank_mask:0xf
    v_cndmask_b32_dpp v87, v87, v87, vcc wave_shr:1 row_mask:0xf bank_mask:0xf
    s_andn2_b64 s[82:83], s[82:83], s[52:53]
    v_cndmask_b32_dpp v7, v7, v7, vcc wave_shr:1 row_mask:0xf bank_mask:0xf
    s_mov_b64 exec, s[54:55]
    s_cbranch_scc0 L2_d142
    s_mov_b64 exec, s[82:83]
    s_nop 1
    v_mfma_f32_4x4x4_16b_bf16 v[88:91], v[12:13], v[84:85], 0
    s_nop 1
    v_mfma_f32_4x4x4_16b_bf16 v[88:91], v[10:11], v[86:87], v[88:91]
    s_nop 4
    v_cvt_pk_bf16_f32 v88, v88, v89
    v_cvt_pk_bf16_f32 v89, v90, v91
    ds_pk_add_bf16 v7, v88 offset:65408
    ds_pk_add_bf16 v7, v89 offset:65412
    s_mov_b64 exec, s[54:55]
    s_branch L2_d142
L2_c143:
    s_lshl_b64 s[52:53], s[82:83], 1
    s_andn2_b64 s[52:53], s[52:53], s[80:81]
    s_andn2_b64 s[52:53], s[52:53], s[50:51]
    s_or_b64 s[80:81], s[80:81], s[52:53]
    s_not_b64 vcc, s[52:53]
    s_mov_b64 exec, -1
    v_cndmask_b32_dpp v84, v84, v84, vcc wave_shr:1 row_mask:0xf bank_mask:0xf
    v_cndmask_b32_dpp v85, v85, v85, vcc wave_shr:1 row_mask:0xf bank_mask:0xf
    s_lshr_b64 s[52:53], s[52:53], 1
    v_cndmask_b32_dpp v86, v86, v86, vcc wave_shr:1 row_mask:0xf bank_mask:0xf
    v_cndmask_b32_dpp v87, v87, v87, vcc wave_shr:1 row_mask:0xf bank_mask:0xf
    s_andn2_b64 s[82:83], s[82:83], s[52:53]
    v_cndmask_b32_dpp v7, v7, v7, vcc wave_shr:1 row_mask:0xf bank_mask:0xf
    s_mov_b64 exec, s[50:51]
    s_cbranch_scc0 L2_d143
    s_mov_b64 exec, s[82:83]
    s_nop 1
    v_mfma_f32_4x4x4_16b_bf16 v[88:91], v[12:13], v[84:85], 0
    s_nop 1
    v_mfma_f32_4x4x4_16b_bf16 v[88:91], v[10:11], v[86:87], v[88:91]
    s_nop 4
    v_cvt_pk_bf16_f32 v88, v88, v89
    v_cvt_pk_bf16_f32 v89, v90, v91
    ds_pk_add_bf16 v7, v88 offset:65408
    ds_pk_add_bf16 v7, v89 offset:65412
    s_mov_b64 exec, s[50:51]
    s_branch L2_d143
L2_c144:
    s_lshl_b64 s[52:53], s[82:83], 1
    s_andn2_b64 s[52:53], s[52:53], s[80:81]
    s_andn2_b64 s[52:53], s[52:53], s[54:55]
    s_or_b64 s[80:81], s[80:81], s[52:53]
    s_not_b64 vcc, s[52:53]
    s_mov_b64 exec, -1
    v_cndmask_b32_dpp v84, v84, v84, vcc wave_shr:1 row_mask:0xf bank_mask:0xf
    v_cndmask_b32_dpp v85, v85, v85, vcc wave_shr:1 row_mask:0xf bank_mask:0xf
    s_lshr_b64 s[52:53], s[52:53], 1
    v_cndmask_b32_dpp v86, v86, v86, vcc wave_shr:1 row_mask:0xf bank_mask:0xf
    v_cndmask_b32_dpp v87, v87, v87, vcc wave_shr:1 row_mask:0xf bank_mask:0xf
    s_andn2_b64 s[82:83], s[82:83], s[52:53]
    v_cndmask_b32_dpp v7, v7, v7, vcc wave_shr:1 row_mask:0xf bank_mask:0xf
    s_mov_b64 exec, s[54:55]
    s_cbranch_scc0 L2_d144
    s_mov_b64 exec, s[82:83]
    s_nop 1
    v_mfma_f32_4x4x4_16b_bf16 v[88:91], v[12:13], v[84:85], 0
    s_nop 1
    v_mfma_f32_4x4x4_16b_bf16 v[88:91], v[10:11], v[86:87], v[88:91]
    s_nop 4
    v_cvt_pk_bf16_f32 v88, v88, v89
    v_cvt_pk_bf16_f32 v89, v90, v91
    ds_pk_add_bf16 v7, v88 offset:65408
    ds_pk_add_bf16 v7, v89 offset:65412
    s_mov_b64 exec, s[54:55]
    s_branch L2_d144
L2_c145:
    s_lshl_b64 s[52:53], s[82:83], 1
    s_andn2_b64 s[52:53], s[52:53], s[80:81]
    s_andn2_b64 s[52:53], s[52:53], s[50:51]
    s_or_b64 s[80:81], s[80:81], s[52:53]
    s_not_b64 vcc, s[52:53]
    s_mov_b64 exec, -1
    v_cndmask_b32_dpp v84, v84, v84, vcc wave_shr:1 row_mask:0xf bank_mask:0xf
    v_cndmask_b32_dpp v85, v85, v85, vcc wave_shr:1 row_mask:0xf bank_mask:0xf
    s_lshr_b64 s[52:53], s[52:53], 1
    v_cndmask_b32_dpp v86, v86, v86, vcc wave_shr:1 row_mask:0xf bank_mask:0xf
    v_cndmask_b32_dpp v87, v87, v87, vcc wave_shr:1 row_mask:0xf bank_mask:0xf
    s_andn2_b64 s[82:83], s[82:83], s[52:53]
    v_cndmask_b32_dpp v7, v7, v7, vcc wave_shr:1 row_mask:0xf bank_mask:0xf
    s_mov_b64 exec, s[50:51]
    s_cbranch_scc0 L2_d145
    s_mov_b64 exec, s[82:83]
    s_nop 1
    v_mfma_f32_4x4x4_16b_bf16 v[88:91], v[12:13], v[84:85], 0
    s_nop 1
    v_mfma_f32_4x4x4_16b_bf16 v[88:91], v[10:11], v[86:87], v[88:91]
    s_nop 4
    v_cvt_pk_bf16_f32 v88, v88, v89
    v_cvt_pk_bf16_f32 v89, v90, v91
    ds_pk_add_bf16 v7, v88 offset:65408
    ds_pk_add_bf16 v7, v89 offset:65412
    s_mov_b64 exec, s[50:51]
    s_branch L2_d145
L2_c146:
    s_lshl_b64 s[52:53], s[82:83], 1
    s_andn2_b64 s[52:53], s[52:53], s[80:81]
    s_andn2_b64 s[52:53], s[52:53], s[54:55]
    s_or_b64 s[80:81], s[80:81], s[52:53]
    s_not_b64 vcc, s[52:53]
    s_mov_b64 exec, -1
    v_cndmask_b32_dpp v84, v84, v84, vcc wave_shr:1 row_mask:0xf bank_mask:0xf
    v_cndmask_b32_dpp v85, v85, v85, vcc wave_shr:1 row_mask:0xf bank_mask:0xf
    s_lshr_b64 s[52:53], s[52:53], 1
    v_cndmask_b32_dpp v86, v86, v86, vcc wave_shr:1 row_mask:0xf bank_mask:0xf
    v_cndmask_b32_dpp v87, v87, v87, vcc wave_shr:1 row_mask:0xf bank_mask:0xf
    s_andn2_b64 s[82:83], s[82:83], s[52:53]
    v_cndmask_b32_dpp v7, v7, v7, vcc wave_shr:1 row_mask:0xf bank_mask:0xf
    s_mov_b64 exec, s[54:55]
    s_cbranch_scc0 L2_d146
    s_mov_b64 exec, s[82:83]
    s_nop 1
    v_mfma_f32_4x4x4_16b_bf16 v[88:91], v[12:13], v[84:85], 0
    s_nop 1
    v_mfma_f32_4x4x4_16b_bf16 v[88:91], v[10:11], v[86:87], v[88:91]
    s_nop 4
    v_cvt_pk_bf16_f32 v88, v88, v89
    v_cvt_pk_bf16_f32 v89, v90, v91
    ds_pk_add_bf16 v7, v88 offset:65408
    ds_pk_add_bf16 v7, v89 offset:65412
    s_mov_b64 exec, s[54:55]
    s_branch L2_d146
L2_c147:
    s_lshl_b64 s[52:53], s[82:83], 1
    s_andn2_b64 s[52:53], s[52:53], s[80:81]
    s_andn2_b64 s[52:53], s[52:53], s[50:51]
    s_or_b64 s[80:81], s[80:81], s[52:53]
    s_not_b64 vcc, s[52:53]
    s_mov_b64 exec, -1
    v_cndmask_b32_dpp v84, v84, v84, vcc wave_shr:1 row_mask:0xf bank_mask:0xf
    v_cndmask_b32_dpp v85, v85, v85, vcc wave_shr:1 row_mask:0xf bank_mask:0xf
    s_lshr_b64 s[52:53], s[52:53], 1
    v_cndmask_b32_dpp v86, v86, v86, vcc wave_shr:1 row_mask:0xf bank_mask:0xf
    v_cndmask_b32_dpp v87, v87, v87, vcc wave_shr:1 row_mask:0xf bank_mask:0xf
    s_andn2_b64 s[82:83], s[82:83], s[52:53]
    v_cndmask_b32_dpp v7, v7, v7, vcc wave_shr:1 row_mask:0xf bank_mask:0xf
    s_mov_b64 exec, s[50:51]
    s_cbranch_scc0 L2_d147
    s_mov_b64 exec, s[82:83]
    s_nop 1
    v_mfma_f32_4x4x4_16b_bf16 v[88:91], v[12:13], v[84:85], 0
    s_nop 1
    v_mfma_f32_4x4x4_16b_bf16 v[88:91], v[10:11], v[86:87], v[88:91]
    s_nop 4
    v_cvt_pk_bf16_f32 v88, v88, v89
    v_cvt_pk_bf16_f32 v89, v90, v91
    ds_pk_add_bf16 v7, v88 offset:65408
    ds_pk_add_bf16 v7, v89 offset:65412
    s_mov_b64 exec, s[50:51]
    s_branch L2_d147
L2_c148:
    s_lshl_b64 s[52:53], s[82:83], 1
    s_andn2_b64 s[52:53], s[52:53], s[80:81]
    s_andn2_b64 s[52:53], s[52:53], s[54:55]
    s_or_b64 s[80:81], s[80:81], s[52:53]
    s_not_b64 vcc, s[52:53]
    s_mov_b64 exec, -1
    v_cndmask_b32_dpp v84, v84, v84, vcc wave_shr:1 row_mask:0xf bank_mask:0xf
    v_cndmask_b32_dpp v85, v85, v85, vcc wave_shr:1 row_mask:0xf bank_mask:0xf
    s_lshr_b64 s[52:53], s[52:53], 1
    v_cndmask_b32_dpp v86, v86, v86, vcc wave_shr:1 row_mask:0xf bank_mask:0xf
    v_cndmask_b32_dpp v87, v87, v87, vcc wave_shr:1 row_mask:0xf bank_mask:0xf
    s_andn2_b64 s[82:83], s[82:83], s[52:53]
    v_cndmask_b32_dpp v7, v7, v7, vcc wave_shr:1 row_mask:0xf bank_mask:0xf
    s_mov_b64 exec, s[54:55]
    s_cbranch_scc0 L2_d148
    s_mov_b64 exec, s[82:83]
    s_nop 1
    v_mfma_f32_4x4x4_16b_bf16 v[88:91], v[12:13], v[84:85], 0
    s_nop 1
    v_mfma_f32_4x4x4_16b_bf16 v[88:91], v[10:11], v[86:87], v[88:91]
    s_nop 4
    v_cvt_pk_bf16_f32 v88, v88, v89
    v_cvt_pk_bf16_f32 v89, v90, v91
    ds_pk_add_bf16 v7, v88 offset:65408
    ds_pk_add_bf16 v7, v89 offset:65412
    s_mov_b64 exec, s[54:55]
    s_branch L2_d148
L2_c149:
    s_lshl_b64 s[52:53], s[82:83], 1
    s_andn2_b64 s[52:53], s[52:53], s[80:81]
    s_andn2_b64 s[52:53], s[52:53], s[50:51]
    s_or_b64 s[80:81], s[80:81], s[52:53]
    s_not_b64 vcc, s[52:53]
    s_mov_b64 exec, -1
    v_cndmask_b32_dpp v84, v84, v84, vcc wave_shr:1 row_mask:0xf bank_mask:0xf
    v_cndmask_b32_dpp v85, v85, v85, vcc wave_shr:1 row_mask:0xf bank_mask:0xf
    s_lshr_b64 s[52:53], s[52:53], 1
    v_cndmask_b32_dpp v86, v86, v86, vcc wave_shr:1 row_mask:0xf bank_mask:0xf
    v_cndmask_b32_dpp v87, v87, v87, vcc wave_shr:1 row_mask:0xf bank_mask:0xf
    s_andn2_b64 s[82:83], s[82:83], s[52:53]
    v_cndmask_b32_dpp v7, v7, v7, vcc wave_shr:1 row_mask:0xf bank_mask:0xf
    s_mov_b64 exec, s[50:51]
    s_cbranch_scc0 L2_d149
    s_mov_b64 exec, s[82:83]
    s_nop 1
    v_mfma_f32_4x4x4_16b_bf16 v[88:91], v[12:13], v[84:85], 0
    s_nop 1
    v_mfma_f32_4x4x4_16b_bf16 v[88:91], v[10:11], v[86:87], v[88:91]
    s_nop 4
    v_cvt_pk_bf16_f32 v88, v88, v89
    v_cvt_pk_bf16_f32 v89, v90, v91
    ds_pk_add_bf16 v7, v88 offset:65408
    ds_pk_add_bf16 v7, v89 offset:65412
    s_mov_b64 exec, s[50:51]
    s_branch L2_d149
L2_c150:
    s_lshl_b64 s[52:53], s[82:83], 1
    s_andn2_b64 s[52:53], s[52:53], s[80:81]
    s_andn2_b64 s[52:53], s[52:53], s[54:55]
    s_or_b64 s[80:81], s[80:81], s[52:53]
    s_not_b64 vcc, s[52:53]
    s_mov_b64 exec, -1
    v_cndmask_b32_dpp v84, v84, v84, vcc wave_shr:1 row_mask:0xf bank_mask:0xf
    v_cndmask_b32_dpp v85, v85, v85, vcc wave_shr:1 row_mask:0xf bank_mask:0xf
    s_lshr_b64 s[52:53], s[52:53], 1
    v_cndmask_b32_dpp v86, v86, v86, vcc wave_shr:1 row_mask:0xf bank_mask:0xf
    v_cndmask_b32_dpp v87, v87, v87, vcc wave_shr:1 row_mask:0xf bank_mask:0xf
    s_andn2_b64 s[82:83], s[82:83], s[52:53]
    v_cndmask_b32_dpp v7, v7, v7, vcc wave_shr:1 row_mask:0xf bank_mask:0xf
    s_mov_b64 exec, s[54:55]
    s_cbranch_scc0 L2_d150
    s_mov_b64 exec, s[82:83]
    s_nop 1
    v_mfma_f32_4x4x4_16b_bf16 v[88:91], v[12:13], v[84:85], 0
    s_nop 1
    v_mfma_f32_4x4x4_16b_bf16 v[88:91], v[10:11], v[86:87], v[88:91]
    s_nop 4
    v_cvt_pk_bf16_f32 v88, v88, v89
    v_cvt_pk_bf16_f32 v89, v90, v91
    ds_pk_add_bf16 v7, v88 offset:65408
    ds_pk_add_bf16 v7, v89 offset:65412
    s_mov_b64 exec, s[54:55]
    s_branch L2_d150
L2_c151:
    s_lshl_b64 s[52:53], s[82:83], 1
    s_andn2_b64 s[52:53], s[52:53], s[80:81]
    s_andn2_b64 s[52:53], s[52:53], s[50:51]
    s_or_b64 s[80:81], s[80:81], s[52:53]
    s_not_b64 vcc, s[52:53]
    s_mov_b64 exec, -1
    v_cndmask_b32_dpp v84, v84, v84, vcc wave_shr:1 row_mask:0xf bank_mask:0xf
    v_cndmask_b32_dpp v85, v85, v85, vcc wave_shr:1 row_mask:0xf bank_mask:0xf
    s_lshr_b64 s[52:53], s[52:53], 1
    v_cndmask_b32_dpp v86, v86, v86, vcc wave_shr:1 row_mask:0xf bank_mask:0xf
    v_cndmask_b32_dpp v87, v87, v87, vcc wave_shr:1 row_mask:0xf bank_mask:0xf
    s_andn2_b64 s[82:83], s[82:83], s[52:53]
    v_cndmask_b32_dpp v7, v7, v7, vcc wave_shr:1 row_mask:0xf bank_mask:0xf
    s_mov_b64 exec, s[50:51]
    s_cbranch_scc0 L2_d151
    s_mov_b64 exec, s[82:83]
    s_nop 1
    v_mfma_f32_4x4x4_16b_bf16 v[88:91], v[12:13], v[84:85], 0
    s_nop 1
    v_mfma_f32_4x4x4_16b_bf16 v[88:91], v[10:11], v[86:87], v[88:91]
    s_nop 4
    v_cvt_pk_bf16_f32 v88, v88, v89
    v_cvt_pk_bf16_f32 v89, v90, v91
    ds_pk_add_bf16 v7, v88 offset:65408
    ds_pk_add_bf16 v7, v89 offset:65412
    s_mov_b64 exec, s[50:51]
    s_branch L2_d151
L2_c152:
    s_mov_b64 s[50:51], vcc
    s_lshl_b64 s[52:53], s[82:83], 1
    s_andn2_b64 s[52:53], s[52:53], s[80:81]
    s_andn2_b64 s[52:53], s[52:53], s[50:51]
    s_or_b64 s[80:81], s[80:81], s[52:53]
    s_not_b64 vcc, s[52:53]
    s_mov_b64 exec, -1
    v_cndmask_b32_dpp v84, v84, v84, vcc wave_shr:1 row_mask:0xf bank_mask:0xf
    v_cndmask_b32_dpp v85, v85, v85, vcc wave_shr:1 row_mask:0xf bank_mask:0xf
    s_lshr_b64 s[52:53], s[52:53], 1
    v_cndmask_b32_dpp v86, v86, v86, vcc wave_shr:1 row_mask:0xf bank_mask:0xf
    v_cndmask_b32_dpp v87, v87, v87, vcc wave_shr:1 row_mask:0xf bank_mask:0xf
    s_andn2_b64 s[82:83], s[82:83], s[52:53]
    v_cndmask_b32_dpp v7, v7, v7, vcc wave_shr:1 row_mask:0xf bank_mask:0xf
    s_mov_b64 vcc, s[50:51]
    s_mov_b64 exec, s[50:51]
    s_cbranch_scc0 L2_d152
    s_mov_b64 exec, s[82:83]
    s_nop 1
    v_mfma_f32_4x4x4_16b_bf16 v[88:91], v[12:13], v[84:85], 0
    s_nop 1
    v_mfma_f32_4x4x4_16b_bf16 v[88:91], v[10:11], v[86:87], v[88:91]
    s_nop 4
    v_cvt_pk_bf16_f32 v88, v88, v89
    v_cvt_pk_bf16_f32 v89, v90, v91
    ds_pk_add_bf16 v7, v88 offset:65408
    ds_pk_add_bf16 v7, v89 offset:65412
    s_mov_b64 exec, vcc
    s_branch L2_d152
L2_c153:
    s_mov_b64 s[50:51], vcc
    s_lshl_b64 s[52:53], s[82:83], 1
    s_andn2_b64 s[52:53], s[52:53], s[80:81]
    s_andn2_b64 s[52:53], s[52:53], s[50:51]
    s_or_b64 s[80:81], s[80:81], s[52:53]
    s_not_b64 vcc, s[52:53]
    s_mov_b64 exec, -1
    v_cndmask_b32_dpp v84, v84, v84, vcc wave_shr:1 row_mask:0xf bank_mask:0xf
    v_cndmask_b32_dpp v85, v85, v85, vcc wave_shr:1 row_mask:0xf bank_mask:0xf
    s_lshr_b64 s[52:53], s[52:53], 1
    v_cndmask_b32_dpp v86, v86, v86, vcc wave_shr:1 row_mask:0xf bank_mask:0xf
    v_cndmask_b32_dpp v87, v87, v87, vcc wave_shr:1 row_mask:0xf bank_mask:0xf
    s_andn2_b64 s[82:83], s[82:83], s[52:53]
    v_cndmask_b32_dpp v7, v7, v7, vcc wave_shr:1 row_mask:0xf bank_mask:0xf
    s_mov_b64 vcc, s[50:51]
    s_mov_b64 exec, s[50:51]
    s_cbranch_scc0 L2_d153
    s_mov_b64 exec, s[82:83]
    s_nop 1
    v_mfma_f32_4x4x4_16b_bf16 v[88:91], v[12:13], v[84:85], 0
    s_nop 1
    v_mfma_f32_4x4x4_16b_bf16 v[88:91], v[10:11], v[86:87], v[88:91]
    s_nop 4
    v_cvt_pk_bf16_f32 v88, v88, v89
    v_cvt_pk_bf16_f32 v89, v90, v91
    ds_pk_add_bf16 v7, v88 offset:65408
    ds_pk_add_bf16 v7, v89 offset:65412
    s_mov_b64 exec, vcc
    s_branch L2_d153
L2_f3s:
    s_branch L2_f3
.section .rodata,"a"
.p2align 6
.amdhsa_kernel gather_scatter__molecular_angular_gemnet__graph_kernel
  .amdhsa_next_free_vgpr 128
  .amdhsa_next_free_sgpr 102
  .amdhsa_accum_offset 128
  .amdhsa_group_segment_fixed_size 0
  .amdhsa_kernarg_size 112
  .amdhsa_user_sgpr_count 2
  .amdhsa_user_sgpr_kernarg_segment_ptr 1
  .amdhsa_system_sgpr_workgroup_id_x 1
  .amdhsa_float_denorm_mode_32 3
.end_amdhsa_kernel
```

```asm
; @launch grid=(256,1,1) block=(1024,1,1) lds=163840
.amdgcn_target "amdgcn-amd-amdhsa--gfx950"
.text
.globl gather_scatter__molecular_angular_gemnet__graph_kernel
.p2align 8
.type gather_scatter__molecular_angular_gemnet__graph_kernel,@function
gather_scatter__molecular_angular_gemnet__graph_kernel:
    s_cmp_ge_u32 s2, 256
    s_cbranch_scc0 L1_go
    s_endpgm
L1_go:
    s_load_dwordx4 s[4:7], s[0:1], 8
    s_load_dwordx2 s[28:29], s[0:1], 32
    s_load_dwordx2 s[30:31], s[0:1], 104
    s_load_dwordx2 s[56:57], s[0:1], 96
    s_load_dwordx2 s[86:87], s[0:1], 0
    s_load_dwordx4 s[60:63], s[0:1], 56
    s_load_dwordx4 s[64:67], s[0:1], 72
    v_lshrrev_b32 v7, 6, v0
    v_lshlrev_b32 v1, 3, v0
    v_readfirstlane_b32 s32, v7
    v_lshlrev_b32 v0, 4, v0
    v_and_b32 v1, 0x1f8, v1
    v_lshlrev_b32 v15, 1, v1
    s_lshr_b32 s3, s32, 1
    s_and_b32 s44, s32, 1
    s_lshl_b32 s44, s44, 3
    s_or_b32 s3, s3, s44
    s_lshl_b32 s3, s3, 10
    s_lshl_b32 s96, s2, 14
    s_add_u32 s96, s96, s3
    s_lshr_b32 s3, s32, 1
    s_and_b32 s44, s32, 1
    s_lshl_b32 s44, s44, 3
    s_or_b32 s3, s3, s44
    s_lshl_b32 s3, s3, 10
    s_lshl_b32 s97, s2, 14
    s_add_u32 s97, s97, s3
    s_lshr_b32 s3, s32, 1
    s_and_b32 s44, s32, 1
    s_lshl_b32 s44, s44, 3
    s_or_b32 s3, s3, s44
    s_lshl_b32 s3, s3, 10
    s_lshl_b32 s98, s2, 14
    s_add_u32 s98, s98, s3
    s_lshr_b32 s3, s32, 1
    s_and_b32 s44, s32, 1
    s_lshl_b32 s44, s44, 3
    s_or_b32 s3, s3, s44
    s_lshl_b32 s3, s3, 10
    s_lshl_b32 s99, s2, 14
    s_add_u32 s99, s99, s3
    s_waitcnt lgkmcnt(0)
    s_mov_b32 s8, s4
    s_mov_b32 s9, s5
    s_mov_b32 s10, 0x9c40000
    s_mov_b32 s11, 0x20000
    s_mov_b32 s12, s6
    s_mov_b32 s13, s7
    s_mov_b32 s14, 0x9c40000
    s_mov_b32 s15, 0x20000
    s_mov_b32 s16, s28
    s_mov_b32 s17, s29
    s_mov_b32 s18, 0x4e20000
    s_mov_b32 s19, 0x20000
    s_mov_b32 s68, s62
    s_mov_b32 s69, s63
    s_mov_b32 s70, 0x40
    s_mov_b32 s71, 0x20000
    s_mov_b32 s72, s60
    s_mov_b32 s73, s61
    s_mov_b32 s74, 0x40
    s_mov_b32 s75, 0x20000
    s_mov_b32 s20, s66
    s_mov_b32 s21, s67
    s_mov_b32 s22, 0x20
    s_mov_b32 s23, 0x20000
    s_mov_b32 s80, s64
    s_mov_b32 s81, s65
    s_mov_b32 s82, 0x20
    s_mov_b32 s83, 0x20000
    s_add_u32 s24, s30, 0xec45000
    s_addc_u32 s25, s31, 0
    s_mov_b32 s26, 0x100
    s_mov_b32 s27, 0x20000
    v_lshrrev_b32 v2, 3, v0
    v_and_b32 v2, 6, v2
    v_lshlrev_b32 v3, 2, v0
    s_lshl_b32 s3, s32, 8
    s_add_u32 s3, s3, s2
    s_cmp_lg_u32 s3, 254
    s_cbranch_scc1 L1_wt
    buffer_load_ushort v96, v2, s[68:71], 0 offen offset:0
    buffer_load_ushort v108, v2, s[68:71], 0 offen offset:8
    buffer_load_ushort v97, v2, s[68:71], 0 offen offset:16
    buffer_load_ushort v109, v2, s[68:71], 0 offen offset:24
    buffer_load_ushort v98, v2, s[68:71], 0 offen offset:32
    buffer_load_ushort v110, v2, s[68:71], 0 offen offset:40
    buffer_load_ushort v99, v2, s[68:71], 0 offen offset:48
    buffer_load_ushort v111, v2, s[68:71], 0 offen offset:56
    buffer_load_ushort v100, v2, s[72:75], 0 offen offset:0
    buffer_load_ushort v112, v2, s[72:75], 0 offen offset:8
    buffer_load_ushort v101, v2, s[72:75], 0 offen offset:16
    buffer_load_ushort v113, v2, s[72:75], 0 offen offset:24
    buffer_load_ushort v102, v2, s[72:75], 0 offen offset:32
    buffer_load_ushort v114, v2, s[72:75], 0 offen offset:40
    buffer_load_ushort v103, v2, s[72:75], 0 offen offset:48
    buffer_load_ushort v115, v2, s[72:75], 0 offen offset:56
    buffer_load_ushort v104, v2, s[20:23], 0 offen offset:0
    buffer_load_ushort v116, v2, s[20:23], 0 offen offset:8
    buffer_load_ushort v105, v2, s[20:23], 0 offen offset:16
    buffer_load_ushort v117, v2, s[20:23], 0 offen offset:24
    buffer_load_ushort v106, v2, s[80:83], 0 offen offset:0
    buffer_load_ushort v118, v2, s[80:83], 0 offen offset:8
    buffer_load_ushort v107, v2, s[80:83], 0 offen offset:16
    buffer_load_ushort v119, v2, s[80:83], 0 offen offset:24
    s_waitcnt vmcnt(0)
    v_lshl_or_b32 v96, v108, 16, v96
    v_lshl_or_b32 v97, v109, 16, v97
    v_lshl_or_b32 v98, v110, 16, v98
    v_lshl_or_b32 v99, v111, 16, v99
    v_lshl_or_b32 v100, v112, 16, v100
    v_lshl_or_b32 v101, v113, 16, v101
    v_lshl_or_b32 v102, v114, 16, v102
    v_lshl_or_b32 v103, v115, 16, v103
    v_lshl_or_b32 v104, v116, 16, v104
    v_lshl_or_b32 v105, v117, 16, v105
    v_lshl_or_b32 v106, v118, 16, v106
    v_lshl_or_b32 v107, v119, 16, v107
    buffer_store_dwordx4 v[96:99], v3, s[24:27], 0 offen offset:0 sc1
    buffer_store_dwordx4 v[100:103], v3, s[24:27], 0 offen offset:16 sc1
    buffer_store_dwordx4 v[104:107], v3, s[24:27], 0 offen offset:32 sc1
L1_wt:
    s_nop 1
    s_add_u32 s44, s96, 0x0
    v_lshlrev_b32 v16, 1, v1
    buffer_load_dwordx4 v[16:19], v16, s[8:11], s44 offen nt
    s_add_u32 s45, s96, 0x0
    v_lshlrev_b32 v20, 1, v1
    buffer_load_dwordx4 v[20:23], v20, s[12:15], s45 offen nt
    s_add_u32 s46, s96, 0x0
    s_lshr_b32 s46, s46, 1
    buffer_load_dwordx2 v[24:25], v1, s[16:19], s46 offen nt
    s_add_u32 s47, s97, 0x400000
    s_lshr_b32 s47, s47, 1
    buffer_load_dwordx2 v[26:27], v1, s[16:19], s47 offen nt
    s_add_u32 s44, s97, 0x400000
    v_lshlrev_b32 v28, 1, v1
    buffer_load_dwordx4 v[28:31], v28, s[8:11], s44 offen nt
    s_add_u32 s45, s97, 0x400000
    v_lshlrev_b32 v32, 1, v1
    buffer_load_dwordx4 v[32:35], v32, s[12:15], s45 offen nt
    s_add_u32 s46, s98, 0x800000
    v_lshlrev_b32 v36, 1, v1
    buffer_load_dwordx4 v[36:39], v36, s[8:11], s46 offen nt
    s_add_u32 s47, s98, 0x800000
    v_lshlrev_b32 v40, 1, v1
    buffer_load_dwordx4 v[40:43], v40, s[12:15], s47 offen nt
    s_add_u32 s44, s98, 0x800000
    s_lshr_b32 s44, s44, 1
    buffer_load_dwordx2 v[44:45], v1, s[16:19], s44 offen nt
    s_add_u32 s45, s99, 0xc00000
    s_lshr_b32 s45, s45, 1
    buffer_load_dwordx2 v[46:47], v1, s[16:19], s45 offen nt
    s_mov_b32 s20, s30
    s_mov_b32 s21, s31
    s_mov_b32 s22, 0xd344000
    s_mov_b32 s23, 0x20000
    s_add_u32 s24, s30, 0x2c000
    s_addc_u32 s25, s31, 0
    s_mov_b32 s26, 0xd318000
    s_mov_b32 s27, 0x20000
    s_add_u32 s3, s32, 0
    s_mul_i32 s4, s3, 205
    s_lshr_b32 s4, s4, 10
    s_mul_i32 s5, s4, 5
    s_sub_u32 s5, s3, s5
    s_lshl_b32 s5, s5, 5
    s_add_u32 s4, s4, s5
    s_sub_u32 s4, s4, s32
    s_lshl_b32 s72, s4, 10
    s_add_u32 s3, s32, 16
    s_mul_i32 s4, s3, 205
    s_lshr_b32 s4, s4, 10
    s_mul_i32 s5, s4, 5
    s_sub_u32 s5, s3, s5
    s_lshl_b32 s5, s5, 5
    s_add_u32 s4, s4, s5
    s_sub_u32 s4, s4, s32
    s_lshl_b32 s73, s4, 10
    s_add_u32 s3, s32, 32
    s_mul_i32 s4, s3, 205
    s_lshr_b32 s4, s4, 10
    s_mul_i32 s5, s4, 5
    s_sub_u32 s5, s3, s5
    s_lshl_b32 s5, s5, 5
    s_add_u32 s4, s4, s5
    s_sub_u32 s4, s4, s32
    s_lshl_b32 s85, s4, 10
    s_add_u32 s3, s32, 48
    s_mul_i32 s4, s3, 205
    s_lshr_b32 s4, s4, 10
    s_mul_i32 s5, s4, 5
    s_sub_u32 s5, s3, s5
    s_lshl_b32 s5, s5, 5
    s_add_u32 s4, s4, s5
    s_sub_u32 s4, s4, s32
    s_lshl_b32 s91, s4, 10
    s_add_u32 s3, s32, 64
    s_mul_i32 s4, s3, 205
    s_lshr_b32 s4, s4, 10
    s_mul_i32 s5, s4, 5
    s_sub_u32 s5, s3, s5
    s_lshl_b32 s5, s5, 5
    s_add_u32 s4, s4, s5
    s_sub_u32 s4, s4, s32
    s_lshl_b32 s93, s4, 10
    s_mov_b32 s80, s86
    s_mov_b32 s81, s87
    s_mov_b32 s82, 0x4e2000
    s_mov_b32 s83, 0x20000
    s_mul_i32 s35, s2, 173056
    s_and_b32 s37, s32, 3
    s_lshl_b32 s37, s37, 3
    s_mov_b32 s36, s37
    s_lshr_b32 s37, s32, 2
    s_mul_i32 s37, s37, 2080
    s_add_u32 s36, s36, s37
    s_and_b32 s37, s2, 3
    s_lshl_b32 s37, s37, 5
    s_add_u32 s36, s36, s37
    s_mul_i32 s4, s2, 5
    s_add_u32 s4, s4, 8192
    s_lshl_b32 s38, s4, 14
    s_lshl_b32 s39, s4, 13
    v_mov_b32 v2, 1
    v_mov_b32 v4, 0x80000007
    v_mov_b32 v5, 0xfc
    v_mov_b32 v6, 0x78
    s_mov_b32 s40, 16512
    s_mov_b32 s55, -10000
    s_mov_b32 s41, 0x010c0c01
    s_mov_b32 s42, 0x030c0c03
    v_mov_b32 v8, 0
    v_mov_b32 v9, 0
    v_mov_b32 v10, 0
    v_mov_b32 v11, 0
    ds_write_b128 v0, v[8:11]
    s_add_u32 s60, s30, 0xec4e000
    s_addc_u32 s61, s31, 0
    s_mov_b32 s62, 0x8000
    s_mov_b32 s63, 0x20000
    s_mov_b64 s[66:67], s[56:57]
    s_lshl_b32 s57, s2, 7
    s_add_u32 s68, s30, 0xec46000
    s_addc_u32 s69, s31, 0
    s_mov_b32 s70, 0x80
    s_mov_b32 s71, 0x20000
    s_lshl_b32 s3, s2, 7
    s_add_u32 s68, s68, s3
    s_addc_u32 s69, s69, 0
    s_cmp_lg_u32 s32, 0
    s_cbranch_scc1 L1_fl
    buffer_store_dwordx4 v[8:11], v0, s[68:71], 0 offen sc1
    s_mov_b64 exec, 0xff
    buffer_store_dwordx4 v[8:11], v0, s[60:63], s57 offen sc1
    s_mov_b64 exec, -1
L1_fl:
    s_waitcnt lgkmcnt(0)
    s_barrier
    s_setprio 3
    s_add_u32 s46, s99, 0xc00000
    v_lshlrev_b32 v48, 1, v1
    buffer_load_dwordx4 v[48:51], v48, s[8:11], s46 offen nt
    s_add_u32 s47, s99, 0xc00000
    v_lshlrev_b32 v52, 1, v1
    buffer_load_dwordx4 v[52:55], v52, s[12:15], s47 offen nt
    s_waitcnt vmcnt(8)
    v_lshlrev_b32 v7, 16, v24
    v_and_b32 v8, 0xffff0000, v24
    v_lshlrev_b32 v9, 16, v25
    v_and_b32 v10, 0xffff0000, v25
    v_mul_f32 v7, 0.15915494, v7
    v_mul_f32 v8, 0.15915494, v8
    v_mul_f32 v9, 0.15915494, v9
    v_mul_f32 v10, 0.15915494, v10
    v_mul_hi_u32_u24 v14, 429497, v16
    v_lshrrev_b32 v12, 3, v20
    v_cos_f32 v7, v7
    v_lshlrev_b16 v13, 3, v20
    v_mad_i32_i24 v11, v14, s55, v16
    v_bitop3_b32 v12, v6, v13, v12 bitop3:0xca
    v_lshl_add_u32 v11, v11, 17, s40
    v_lshlrev_b16 v14, 8, v14
    v_lshrrev_b32 v13, 2, v20
    v_add_u32 v16, v12, v11
    v_bitop3_b32 v20, v5, v13, v14 bitop3:0xea
    ds_add_u32 v20, v2
    v_mul_hi_u32_u24 v14, 429497, v17
    v_lshrrev_b32 v12, 3, v21
    v_cos_f32 v8, v8
    v_lshlrev_b16 v13, 3, v21
    v_mad_i32_i24 v11, v14, s55, v17
    v_bitop3_b32 v12, v6, v13, v12 bitop3:0xca
    v_lshl_add_u32 v11, v11, 17, s40
    v_lshlrev_b16 v14, 8, v14
    v_lshrrev_b32 v13, 2, v21
    v_add_u32 v17, v12, v11
    v_bitop3_b32 v21, v5, v13, v14 bitop3:0xea
    ds_add_u32 v21, v2
    v_cvt_pk_bf16_f32 v24, v7, v8
    v_perm_b32 v12, v24, v24, s41
    v_bitop3_b32 v16, v4, v12, v16 bitop3:0xca
    v_perm_b32 v13, v24, v24, s42
    v_bitop3_b32 v17, v4, v13, v17 bitop3:0xca
    v_mul_hi_u32_u24 v14, 429497, v18
    v_lshrrev_b32 v12, 3, v22
    v_cos_f32 v9, v9
    v_lshlrev_b16 v13, 3, v22
    v_mad_i32_i24 v11, v14, s55, v18
    v_bitop3_b32 v12, v6, v13, v12 bitop3:0xca
    v_lshl_add_u32 v11, v11, 17, s40
    v_lshlrev_b16 v14, 8, v14
    v_lshrrev_b32 v13, 2, v22
    v_add_u32 v18, v12, v11
    v_bitop3_b32 v22, v5, v13, v14 bitop3:0xea
    ds_add_u32 v22, v2
    v_mul_hi_u32_u24 v14, 429497, v19
    v_lshrrev_b32 v12, 3, v23
    v_cos_f32 v10, v10
    v_lshlrev_b16 v13, 3, v23
    v_mad_i32_i24 v11, v14, s55, v19
    v_bitop3_b32 v12, v6, v13, v12 bitop3:0xca
    v_lshl_add_u32 v11, v11, 17, s40
    v_lshlrev_b16 v14, 8, v14
    v_lshrrev_b32 v13, 2, v23
    v_add_u32 v19, v12, v11
    v_bitop3_b32 v23, v5, v13, v14 bitop3:0xea
    ds_add_u32 v23, v2
    v_cvt_pk_bf16_f32 v25, v9, v10
    v_perm_b32 v12, v25, v25, s41
    v_bitop3_b32 v18, v4, v12, v18 bitop3:0xca
    v_perm_b32 v13, v25, v25, s42
    v_bitop3_b32 v19, v4, v13, v19 bitop3:0xca
    s_add_u32 s44, s96, 0x1000000
    v_lshlrev_b32 v56, 1, v1
    buffer_load_dwordx4 v[56:59], v56, s[8:11], s44 offen nt
    s_add_u32 s45, s96, 0x1000000
    v_lshlrev_b32 v60, 1, v1
    buffer_load_dwordx4 v[60:63], v60, s[12:15], s45 offen nt
    s_add_u32 s46, s96, 0x1000000
    s_lshr_b32 s46, s46, 1
    buffer_load_dwordx2 v[64:65], v1, s[16:19], s46 offen nt
    s_add_u32 s47, s97, 0x1400000
    s_lshr_b32 s47, s47, 1
    buffer_load_dwordx2 v[66:67], v1, s[16:19], s47 offen nt
    s_waitcnt vmcnt(10)
    v_lshlrev_b32 v7, 16, v26
    v_and_b32 v8, 0xffff0000, v26
    v_lshlrev_b32 v9, 16, v27
    v_and_b32 v10, 0xffff0000, v27
    v_mul_f32 v7, 0.15915494, v7
    v_mul_f32 v8, 0.15915494, v8
    v_mul_f32 v9, 0.15915494, v9
    v_mul_f32 v10, 0.15915494, v10
    v_mul_hi_u32_u24 v14, 429497, v28
    v_lshrrev_b32 v12, 3, v32
    v_cos_f32 v7, v7
    v_lshlrev_b16 v13, 3, v32
    v_mad_i32_i24 v11, v14, s55, v28
    v_bitop3_b32 v12, v6, v13, v12 bitop3:0xca
    v_lshl_add_u32 v11, v11, 17, s40
    v_lshlrev_b16 v14, 8, v14
    v_lshrrev_b32 v13, 2, v32
    v_add_u32 v28, v12, v11
    v_bitop3_b32 v32, v5, v13, v14 bitop3:0xea
    ds_add_u32 v32, v2
    v_mul_hi_u32_u24 v14, 429497, v29
    v_lshrrev_b32 v12, 3, v33
    v_cos_f32 v8, v8
    v_lshlrev_b16 v13, 3, v33
    v_mad_i32_i24 v11, v14, s55, v29
    v_bitop3_b32 v12, v6, v13, v12 bitop3:0xca
    v_lshl_add_u32 v11, v11, 17, s40
    v_lshlrev_b16 v14, 8, v14
    v_lshrrev_b32 v13, 2, v33
    v_add_u32 v29, v12, v11
    v_bitop3_b32 v33, v5, v13, v14 bitop3:0xea
    ds_add_u32 v33, v2
    v_cvt_pk_bf16_f32 v26, v7, v8
    v_perm_b32 v12, v26, v26, s41
    v_bitop3_b32 v28, v4, v12, v28 bitop3:0xca
    v_perm_b32 v13, v26, v26, s42
    v_bitop3_b32 v29, v4, v13, v29 bitop3:0xca
    v_mul_hi_u32_u24 v14, 429497, v30
    v_lshrrev_b32 v12, 3, v34
    v_cos_f32 v9, v9
    v_lshlrev_b16 v13, 3, v34
    v_mad_i32_i24 v11, v14, s55, v30
    v_bitop3_b32 v12, v6, v13, v12 bitop3:0xca
    v_lshl_add_u32 v11, v11, 17, s40
    v_lshlrev_b16 v14, 8, v14
    v_lshrrev_b32 v13, 2, v34
    v_add_u32 v30, v12, v11
    v_bitop3_b32 v34, v5, v13, v14 bitop3:0xea
    ds_add_u32 v34, v2
    v_mul_hi_u32_u24 v14, 429497, v31
    v_lshrrev_b32 v12, 3, v35
    v_cos_f32 v10, v10
    v_lshlrev_b16 v13, 3, v35
    v_mad_i32_i24 v11, v14, s55, v31
    v_bitop3_b32 v12, v6, v13, v12 bitop3:0xca
    v_lshl_add_u32 v11, v11, 17, s40
    v_lshlrev_b16 v14, 8, v14
    v_lshrrev_b32 v13, 2, v35
    v_add_u32 v31, v12, v11
    v_bitop3_b32 v35, v5, v13, v14 bitop3:0xea
    ds_add_u32 v35, v2
    v_cvt_pk_bf16_f32 v27, v9, v10
    v_perm_b32 v12, v27, v27, s41
    v_bitop3_b32 v30, v4, v12, v30 bitop3:0xca
    v_perm_b32 v13, v27, v27, s42
    v_bitop3_b32 v31, v4, v13, v31 bitop3:0xca
    s_setprio 2
    s_add_u32 s44, s97, 0x1400000
    v_lshlrev_b32 v68, 1, v1
    buffer_load_dwordx4 v[68:71], v68, s[8:11], s44 offen nt
    s_add_u32 s45, s97, 0x1400000
    v_lshlrev_b32 v72, 1, v1
    buffer_load_dwordx4 v[72:75], v72, s[12:15], s45 offen nt
    s_waitcnt vmcnt(8)
    v_lshlrev_b32 v7, 16, v44
    v_and_b32 v8, 0xffff0000, v44
    v_lshlrev_b32 v9, 16, v45
    v_and_b32 v10, 0xffff0000, v45
    v_mul_f32 v7, 0.15915494, v7
    v_mul_f32 v8, 0.15915494, v8
    v_mul_f32 v9, 0.15915494, v9
    v_mul_f32 v10, 0.15915494, v10
    v_mul_hi_u32_u24 v14, 429497, v36
    v_lshrrev_b32 v12, 3, v40
    v_cos_f32 v7, v7
    v_lshlrev_b16 v13, 3, v40
    v_mad_i32_i24 v11, v14, s55, v36
    v_bitop3_b32 v12, v6, v13, v12 bitop3:0xca
    v_lshl_add_u32 v11, v11, 17, s40
    v_lshlrev_b16 v14, 8, v14
    v_lshrrev_b32 v13, 2, v40
    v_add_u32 v36, v12, v11
    v_bitop3_b32 v40, v5, v13, v14 bitop3:0xea
    ds_add_u32 v40, v2
    v_mul_hi_u32_u24 v14, 429497, v37
    v_lshrrev_b32 v12, 3, v41
    v_cos_f32 v8, v8
    v_lshlrev_b16 v13, 3, v41
    v_mad_i32_i24 v11, v14, s55, v37
    v_bitop3_b32 v12, v6, v13, v12 bitop3:0xca
    v_lshl_add_u32 v11, v11, 17, s40
    v_lshlrev_b16 v14, 8, v14
    v_lshrrev_b32 v13, 2, v41
    v_add_u32 v37, v12, v11
    v_bitop3_b32 v41, v5, v13, v14 bitop3:0xea
    ds_add_u32 v41, v2
    v_cvt_pk_bf16_f32 v44, v7, v8
    v_perm_b32 v12, v44, v44, s41
    v_bitop3_b32 v36, v4, v12, v36 bitop3:0xca
    v_perm_b32 v13, v44, v44, s42
    v_bitop3_b32 v37, v4, v13, v37 bitop3:0xca
    v_mul_hi_u32_u24 v14, 429497, v38
    v_lshrrev_b32 v12, 3, v42
    v_cos_f32 v9, v9
    v_lshlrev_b16 v13, 3, v42
    v_mad_i32_i24 v11, v14, s55, v38
    v_bitop3_b32 v12, v6, v13, v12 bitop3:0xca
    v_lshl_add_u32 v11, v11, 17, s40
    v_lshlrev_b16 v14, 8, v14
    v_lshrrev_b32 v13, 2, v42
    v_add_u32 v38, v12, v11
    v_bitop3_b32 v42, v5, v13, v14 bitop3:0xea
    ds_add_u32 v42, v2
    v_mul_hi_u32_u24 v14, 429497, v39
    v_lshrrev_b32 v12, 3, v43
    v_cos_f32 v10, v10
    v_lshlrev_b16 v13, 3, v43
    v_mad_i32_i24 v11, v14, s55, v39
    v_bitop3_b32 v12, v6, v13, v12 bitop3:0xca
    v_lshl_add_u32 v11, v11, 17, s40
    v_lshlrev_b16 v14, 8, v14
    v_lshrrev_b32 v13, 2, v43
    v_add_u32 v39, v12, v11
    v_bitop3_b32 v43, v5, v13, v14 bitop3:0xea
    ds_add_u32 v43, v2
    v_cvt_pk_bf16_f32 v45, v9, v10
    v_perm_b32 v12, v45, v45, s41
    v_bitop3_b32 v38, v4, v12, v38 bitop3:0xca
    v_perm_b32 v13, v45, v45, s42
    v_bitop3_b32 v39, v4, v13, v39 bitop3:0xca
    s_add_u32 s46, s98, 0x1800000
    v_lshlrev_b32 v76, 1, v1
    buffer_load_dwordx4 v[76:79], v76, s[8:11], s46 offen nt
    s_add_u32 s47, s98, 0x1800000
    v_lshlrev_b32 v80, 1, v1
    buffer_load_dwordx4 v[80:83], v80, s[12:15], s47 offen nt
    s_add_u32 s44, s98, 0x1800000
    s_lshr_b32 s44, s44, 1
    buffer_load_dwordx2 v[84:85], v1, s[16:19], s44 offen nt
    s_add_u32 s45, s99, 0x1c00000
    s_lshr_b32 s45, s45, 1
    buffer_load_dwordx2 v[86:87], v1, s[16:19], s45 offen nt
    s_waitcnt vmcnt(10)
    v_lshlrev_b32 v7, 16, v46
    v_and_b32 v8, 0xffff0000, v46
    v_lshlrev_b32 v9, 16, v47
    v_and_b32 v10, 0xffff0000, v47
    v_mul_f32 v7, 0.15915494, v7
    v_mul_f32 v8, 0.15915494, v8
    v_mul_f32 v9, 0.15915494, v9
    v_mul_f32 v10, 0.15915494, v10
    v_mul_hi_u32_u24 v14, 429497, v48
    v_lshrrev_b32 v12, 3, v52
    v_cos_f32 v7, v7
    v_lshlrev_b16 v13, 3, v52
    v_mad_i32_i24 v11, v14, s55, v48
    v_bitop3_b32 v12, v6, v13, v12 bitop3:0xca
    v_lshl_add_u32 v11, v11, 17, s40
    v_lshlrev_b16 v14, 8, v14
    v_lshrrev_b32 v13, 2, v52
    v_add_u32 v48, v12, v11
    v_bitop3_b32 v52, v5, v13, v14 bitop3:0xea
    ds_add_u32 v52, v2
    v_mul_hi_u32_u24 v14, 429497, v49
    v_lshrrev_b32 v12, 3, v53
    v_cos_f32 v8, v8
    v_lshlrev_b16 v13, 3, v53
    v_mad_i32_i24 v11, v14, s55, v49
    v_bitop3_b32 v12, v6, v13, v12 bitop3:0xca
    v_lshl_add_u32 v11, v11, 17, s40
    v_lshlrev_b16 v14, 8, v14
    v_lshrrev_b32 v13, 2, v53
    v_add_u32 v49, v12, v11
    v_bitop3_b32 v53, v5, v13, v14 bitop3:0xea
    ds_add_u32 v53, v2
    v_cvt_pk_bf16_f32 v46, v7, v8
    v_perm_b32 v12, v46, v46, s41
    v_bitop3_b32 v48, v4, v12, v48 bitop3:0xca
    v_perm_b32 v13, v46, v46, s42
    v_bitop3_b32 v49, v4, v13, v49 bitop3:0xca
    v_mul_hi_u32_u24 v14, 429497, v50
    v_lshrrev_b32 v12, 3, v54
    v_cos_f32 v9, v9
    v_lshlrev_b16 v13, 3, v54
    v_mad_i32_i24 v11, v14, s55, v50
    v_bitop3_b32 v12, v6, v13, v12 bitop3:0xca
    v_lshl_add_u32 v11, v11, 17, s40
    v_lshlrev_b16 v14, 8, v14
    v_lshrrev_b32 v13, 2, v54
    v_add_u32 v50, v12, v11
    v_bitop3_b32 v54, v5, v13, v14 bitop3:0xea
    ds_add_u32 v54, v2
    v_mul_hi_u32_u24 v14, 429497, v51
    v_lshrrev_b32 v12, 3, v55
    v_cos_f32 v10, v10
    v_lshlrev_b16 v13, 3, v55
    v_mad_i32_i24 v11, v14, s55, v51
    v_bitop3_b32 v12, v6, v13, v12 bitop3:0xca
    v_lshl_add_u32 v11, v11, 17, s40
    v_lshlrev_b16 v14, 8, v14
    v_lshrrev_b32 v13, 2, v55
    v_add_u32 v51, v12, v11
    v_bitop3_b32 v55, v5, v13, v14 bitop3:0xea
    ds_add_u32 v55, v2
    v_cvt_pk_bf16_f32 v47, v9, v10
    v_perm_b32 v12, v47, v47, s41
    v_bitop3_b32 v50, v4, v12, v50 bitop3:0xca
    v_perm_b32 v13, v47, v47, s42
    v_bitop3_b32 v51, v4, v13, v51 bitop3:0xca
    s_setprio 1
    s_add_u32 s46, s99, 0x1c00000
    v_lshlrev_b32 v88, 1, v1
    buffer_load_dwordx4 v[88:91], v88, s[8:11], s46 offen nt
    s_add_u32 s47, s99, 0x1c00000
    v_lshlrev_b32 v92, 1, v1
    buffer_load_dwordx4 v[92:95], v92, s[12:15], s47 offen nt
    s_waitcnt vmcnt(8)
    v_lshlrev_b32 v7, 16, v64
    v_and_b32 v8, 0xffff0000, v64
    v_lshlrev_b32 v9, 16, v65
    v_and_b32 v10, 0xffff0000, v65
    v_mul_f32 v7, 0.15915494, v7
    v_mul_f32 v8, 0.15915494, v8
    v_mul_f32 v9, 0.15915494, v9
    v_mul_f32 v10, 0.15915494, v10
    v_mul_hi_u32_u24 v14, 429497, v56
    v_lshrrev_b32 v12, 3, v60
    v_cos_f32 v7, v7
    v_lshlrev_b16 v13, 3, v60
    v_mad_i32_i24 v11, v14, s55, v56
    v_bitop3_b32 v12, v6, v13, v12 bitop3:0xca
    v_lshl_add_u32 v11, v11, 17, s40
    v_lshlrev_b16 v14, 8, v14
    v_lshrrev_b32 v13, 2, v60
    v_add_u32 v56, v12, v11
    v_bitop3_b32 v60, v5, v13, v14 bitop3:0xea
    ds_add_u32 v60, v2
    v_mul_hi_u32_u24 v14, 429497, v57
    v_lshrrev_b32 v12, 3, v61
    v_cos_f32 v8, v8
    v_lshlrev_b16 v13, 3, v61
    v_mad_i32_i24 v11, v14, s55, v57
    v_bitop3_b32 v12, v6, v13, v12 bitop3:0xca
    v_lshl_add_u32 v11, v11, 17, s40
    v_lshlrev_b16 v14, 8, v14
    v_lshrrev_b32 v13, 2, v61
    v_add_u32 v57, v12, v11
    v_bitop3_b32 v61, v5, v13, v14 bitop3:0xea
    ds_add_u32 v61, v2
    v_cvt_pk_bf16_f32 v64, v7, v8
    v_perm_b32 v12, v64, v64, s41
    v_bitop3_b32 v56, v4, v12, v56 bitop3:0xca
    v_perm_b32 v13, v64, v64, s42
    v_bitop3_b32 v57, v4, v13, v57 bitop3:0xca
    v_mul_hi_u32_u24 v14, 429497, v58
    v_lshrrev_b32 v12, 3, v62
    v_cos_f32 v9, v9
    v_lshlrev_b16 v13, 3, v62
    v_mad_i32_i24 v11, v14, s55, v58
    v_bitop3_b32 v12, v6, v13, v12 bitop3:0xca
    v_lshl_add_u32 v11, v11, 17, s40
    v_lshlrev_b16 v14, 8, v14
    v_lshrrev_b32 v13, 2, v62
    v_add_u32 v58, v12, v11
    v_bitop3_b32 v62, v5, v13, v14 bitop3:0xea
    ds_add_u32 v62, v2
    v_mul_hi_u32_u24 v14, 429497, v59
    v_lshrrev_b32 v12, 3, v63
    v_cos_f32 v10, v10
    v_lshlrev_b16 v13, 3, v63
    v_mad_i32_i24 v11, v14, s55, v59
    v_bitop3_b32 v12, v6, v13, v12 bitop3:0xca
    v_lshl_add_u32 v11, v11, 17, s40
    v_lshlrev_b16 v14, 8, v14
    v_lshrrev_b32 v13, 2, v63
    v_add_u32 v59, v12, v11
    v_bitop3_b32 v63, v5, v13, v14 bitop3:0xea
    ds_add_u32 v63, v2
    v_cvt_pk_bf16_f32 v65, v9, v10
    v_perm_b32 v12, v65, v65, s41
    v_bitop3_b32 v58, v4, v12, v58 bitop3:0xca
    v_perm_b32 v13, v65, v65, s42
    v_bitop3_b32 v59, v4, v13, v59 bitop3:0xca
    s_add_u32 s44, s96, 0x2000000
    v_lshlrev_b32 v96, 1, v1
    buffer_load_dwordx4 v[96:99], v96, s[8:11], s44 offen nt
    s_add_u32 s45, s96, 0x2000000
    v_lshlrev_b32 v104, 1, v1
    buffer_load_dwordx4 v[104:107], v104, s[12:15], s45 offen nt
    s_add_u32 s46, s96, 0x2000000
    s_lshr_b32 s46, s46, 1
    buffer_load_dwordx2 v[108:109], v1, s[16:19], s46 offen nt
    s_add_u32 s47, s97, 0x2400000
    s_lshr_b32 s47, s47, 1
    buffer_load_dwordx2 v[110:111], v1, s[16:19], s47 offen nt
    s_waitcnt vmcnt(10)
    v_lshlrev_b32 v7, 16, v66
    v_and_b32 v8, 0xffff0000, v66
    v_lshlrev_b32 v9, 16, v67
    v_and_b32 v10, 0xffff0000, v67
    v_mul_f32 v7, 0.15915494, v7
    v_mul_f32 v8, 0.15915494, v8
    v_mul_f32 v9, 0.15915494, v9
    v_mul_f32 v10, 0.15915494, v10
    v_mul_hi_u32_u24 v14, 429497, v68
    v_lshrrev_b32 v12, 3, v72
    v_cos_f32 v7, v7
    v_lshlrev_b16 v13, 3, v72
    v_mad_i32_i24 v11, v14, s55, v68
    v_bitop3_b32 v12, v6, v13, v12 bitop3:0xca
    v_lshl_add_u32 v11, v11, 17, s40
    v_lshlrev_b16 v14, 8, v14
    v_lshrrev_b32 v13, 2, v72
    v_add_u32 v68, v12, v11
    v_bitop3_b32 v72, v5, v13, v14 bitop3:0xea
    ds_add_u32 v72, v2
    v_mul_hi_u32_u24 v14, 429497, v69
    v_lshrrev_b32 v12, 3, v73
    v_cos_f32 v8, v8
    v_lshlrev_b16 v13, 3, v73
    v_mad_i32_i24 v11, v14, s55, v69
    v_bitop3_b32 v12, v6, v13, v12 bitop3:0xca
    v_lshl_add_u32 v11, v11, 17, s40
    v_lshlrev_b16 v14, 8, v14
    v_lshrrev_b32 v13, 2, v73
    v_add_u32 v69, v12, v11
    v_bitop3_b32 v73, v5, v13, v14 bitop3:0xea
    ds_add_u32 v73, v2
    v_cvt_pk_bf16_f32 v66, v7, v8
    v_perm_b32 v12, v66, v66, s41
    v_bitop3_b32 v68, v4, v12, v68 bitop3:0xca
    v_perm_b32 v13, v66, v66, s42
    v_bitop3_b32 v69, v4, v13, v69 bitop3:0xca
    v_mul_hi_u32_u24 v14, 429497, v70
    v_lshrrev_b32 v12, 3, v74
    v_cos_f32 v9, v9
    v_lshlrev_b16 v13, 3, v74
    v_mad_i32_i24 v11, v14, s55, v70
    v_bitop3_b32 v12, v6, v13, v12 bitop3:0xca
    v_lshl_add_u32 v11, v11, 17, s40
    v_lshlrev_b16 v14, 8, v14
    v_lshrrev_b32 v13, 2, v74
    v_add_u32 v70, v12, v11
    v_bitop3_b32 v74, v5, v13, v14 bitop3:0xea
    ds_add_u32 v74, v2
    v_mul_hi_u32_u24 v14, 429497, v71
    v_lshrrev_b32 v12, 3, v75
    v_cos_f32 v10, v10
    v_lshlrev_b16 v13, 3, v75
    v_mad_i32_i24 v11, v14, s55, v71
    v_bitop3_b32 v12, v6, v13, v12 bitop3:0xca
    v_lshl_add_u32 v11, v11, 17, s40
    v_lshlrev_b16 v14, 8, v14
    v_lshrrev_b32 v13, 2, v75
    v_add_u32 v71, v12, v11
    v_bitop3_b32 v75, v5, v13, v14 bitop3:0xea
    ds_add_u32 v75, v2
    v_cvt_pk_bf16_f32 v67, v9, v10
    v_perm_b32 v12, v67, v67, s41
    v_bitop3_b32 v70, v4, v12, v70 bitop3:0xca
    v_perm_b32 v13, v67, v67, s42
    v_bitop3_b32 v71, v4, v13, v71 bitop3:0xca
    s_setprio 0
    s_add_u32 s44, s97, 0x2400000
    v_lshlrev_b32 v100, 1, v1
    buffer_load_dwordx4 v[100:103], v100, s[8:11], s44 offen nt
    s_waitcnt vmcnt(7)
    v_lshlrev_b32 v7, 16, v84
    v_and_b32 v8, 0xffff0000, v84
    v_lshlrev_b32 v9, 16, v85
    v_and_b32 v10, 0xffff0000, v85
    v_mul_f32 v7, 0.15915494, v7
    v_mul_f32 v8, 0.15915494, v8
    v_mul_f32 v9, 0.15915494, v9
    v_mul_f32 v10, 0.15915494, v10
    v_mul_hi_u32_u24 v14, 429497, v76
    v_lshrrev_b32 v12, 3, v80
    v_cos_f32 v7, v7
    v_lshlrev_b16 v13, 3, v80
    v_mad_i32_i24 v11, v14, s55, v76
    v_bitop3_b32 v12, v6, v13, v12 bitop3:0xca
    v_lshl_add_u32 v11, v11, 17, s40
    v_lshlrev_b16 v14, 8, v14
    v_lshrrev_b32 v13, 2, v80
    v_add_u32 v76, v12, v11
    v_bitop3_b32 v80, v5, v13, v14 bitop3:0xea
    ds_add_u32 v80, v2
    v_mul_hi_u32_u24 v14, 429497, v77
    v_lshrrev_b32 v12, 3, v81
    v_cos_f32 v8, v8
    v_lshlrev_b16 v13, 3, v81
    v_mad_i32_i24 v11, v14, s55, v77
    v_bitop3_b32 v12, v6, v13, v12 bitop3:0xca
    v_lshl_add_u32 v11, v11, 17, s40
    v_lshlrev_b16 v14, 8, v14
    v_lshrrev_b32 v13, 2, v81
    v_add_u32 v77, v12, v11
    v_bitop3_b32 v81, v5, v13, v14 bitop3:0xea
    ds_add_u32 v81, v2
    v_cvt_pk_bf16_f32 v84, v7, v8
    v_perm_b32 v12, v84, v84, s41
    v_bitop3_b32 v76, v4, v12, v76 bitop3:0xca
    v_perm_b32 v13, v84, v84, s42
    v_bitop3_b32 v77, v4, v13, v77 bitop3:0xca
    v_mul_hi_u32_u24 v14, 429497, v78
    v_lshrrev_b32 v12, 3, v82
    v_cos_f32 v9, v9
    v_lshlrev_b16 v13, 3, v82
    v_mad_i32_i24 v11, v14, s55, v78
    v_bitop3_b32 v12, v6, v13, v12 bitop3:0xca
    v_lshl_add_u32 v11, v11, 17, s40
    v_lshlrev_b16 v14, 8, v14
    v_lshrrev_b32 v13, 2, v82
    v_add_u32 v78, v12, v11
    v_bitop3_b32 v82, v5, v13, v14 bitop3:0xea
    ds_add_u32 v82, v2
    v_mul_hi_u32_u24 v14, 429497, v79
    v_lshrrev_b32 v12, 3, v83
    v_cos_f32 v10, v10
    v_lshlrev_b16 v13, 3, v83
    v_mad_i32_i24 v11, v14, s55, v79
    v_bitop3_b32 v12, v6, v13, v12 bitop3:0xca
    v_lshl_add_u32 v11, v11, 17, s40
    v_lshlrev_b16 v14, 8, v14
    v_lshrrev_b32 v13, 2, v83
    v_add_u32 v79, v12, v11
    v_bitop3_b32 v83, v5, v13, v14 bitop3:0xea
    ds_add_u32 v83, v2
    v_cvt_pk_bf16_f32 v85, v9, v10
    v_perm_b32 v12, v85, v85, s41
    v_bitop3_b32 v78, v4, v12, v78 bitop3:0xca
    v_perm_b32 v13, v85, v85, s42
    v_bitop3_b32 v79, v4, v13, v79 bitop3:0xca
    s_waitcnt vmcnt(5)
    v_lshlrev_b32 v7, 16, v86
    v_and_b32 v8, 0xffff0000, v86
    v_lshlrev_b32 v9, 16, v87
    v_and_b32 v10, 0xffff0000, v87
    v_mul_f32 v7, 0.15915494, v7
    v_mul_f32 v8, 0.15915494, v8
    v_mul_f32 v9, 0.15915494, v9
    v_mul_f32 v10, 0.15915494, v10
    v_mul_hi_u32_u24 v14, 429497, v88
    v_lshrrev_b32 v12, 3, v92
    v_cos_f32 v7, v7
    v_lshlrev_b16 v13, 3, v92
    v_mad_i32_i24 v11, v14, s55, v88
    v_bitop3_b32 v12, v6, v13, v12 bitop3:0xca
    v_lshl_add_u32 v11, v11, 17, s40
    v_lshlrev_b16 v14, 8, v14
    v_lshrrev_b32 v13, 2, v92
    v_add_u32 v88, v12, v11
    v_bitop3_b32 v92, v5, v13, v14 bitop3:0xea
    ds_add_u32 v92, v2
    v_mul_hi_u32_u24 v14, 429497, v89
    v_lshrrev_b32 v12, 3, v93
    v_cos_f32 v8, v8
    v_lshlrev_b16 v13, 3, v93
    v_mad_i32_i24 v11, v14, s55, v89
    v_bitop3_b32 v12, v6, v13, v12 bitop3:0xca
    v_lshl_add_u32 v11, v11, 17, s40
    v_lshlrev_b16 v14, 8, v14
    v_lshrrev_b32 v13, 2, v93
    v_add_u32 v89, v12, v11
    v_bitop3_b32 v93, v5, v13, v14 bitop3:0xea
    ds_add_u32 v93, v2
    v_cvt_pk_bf16_f32 v86, v7, v8
    v_perm_b32 v12, v86, v86, s41
    v_bitop3_b32 v88, v4, v12, v88 bitop3:0xca
    v_perm_b32 v13, v86, v86, s42
    v_bitop3_b32 v89, v4, v13, v89 bitop3:0xca
    v_mul_hi_u32_u24 v14, 429497, v90
    v_lshrrev_b32 v12, 3, v94
    v_cos_f32 v9, v9
    v_lshlrev_b16 v13, 3, v94
    v_mad_i32_i24 v11, v14, s55, v90
    v_bitop3_b32 v12, v6, v13, v12 bitop3:0xca
    v_lshl_add_u32 v11, v11, 17, s40
    v_lshlrev_b16 v14, 8, v14
    v_lshrrev_b32 v13, 2, v94
    v_add_u32 v90, v12, v11
    v_bitop3_b32 v94, v5, v13, v14 bitop3:0xea
    ds_add_u32 v94, v2
    v_mul_hi_u32_u24 v14, 429497, v91
    v_lshrrev_b32 v12, 3, v95
    v_cos_f32 v10, v10
    v_lshlrev_b16 v13, 3, v95
    v_mad_i32_i24 v11, v14, s55, v91
    v_bitop3_b32 v12, v6, v13, v12 bitop3:0xca
    v_lshl_add_u32 v11, v11, 17, s40
    v_lshlrev_b16 v14, 8, v14
    v_lshrrev_b32 v13, 2, v95
    v_add_u32 v91, v12, v11
    v_bitop3_b32 v95, v5, v13, v14 bitop3:0xea
    ds_add_u32 v95, v2
    v_cvt_pk_bf16_f32 v87, v9, v10
    v_perm_b32 v12, v87, v87, s41
    v_bitop3_b32 v90, v4, v12, v90 bitop3:0xca
    v_perm_b32 v13, v87, v87, s42
    v_bitop3_b32 v91, v4, v13, v91 bitop3:0xca
    v_lshrrev_b32 v8, 2, v0
    v_and_b32 v7, 0x3c00, v0
    v_bitop3_b32 v7, v5, v8, v7 bitop3:0xea
    s_waitcnt lgkmcnt(0)
    s_barrier
    ds_read2st64_b32 v[8:9], v7 offset0:0 offset1:1
    ds_read2st64_b32 v[10:11], v7 offset0:2 offset1:3
    s_add_u32 s45, s97, 0x2400000
    v_lshlrev_b32 v112, 1, v1
    buffer_load_dwordx4 v[112:115], v112, s[12:15], s45 offen nt
    s_waitcnt lgkmcnt(0)
    v_lshl_or_b32 v12, v9, 16, v8
    v_lshl_or_b32 v13, v11, 16, v10
    v_mov_b32 v14, v12
    v_mov_b32 v15, v13
    s_nop 0
    v_add_u32_dpp v14, v14, v14 row_shr:1 row_mask:0xf bank_mask:0xf bound_ctrl:1
    v_add_u32_dpp v15, v15, v15 row_shr:1 row_mask:0xf bank_mask:0xf bound_ctrl:1
    s_nop 0
    v_add_u32_dpp v14, v14, v14 row_shr:2 row_mask:0xf bank_mask:0xf bound_ctrl:1
    v_add_u32_dpp v15, v15, v15 row_shr:2 row_mask:0xf bank_mask:0xf bound_ctrl:1
    s_nop 0
    v_add_u32_dpp v14, v14, v14 row_shr:4 row_mask:0xf bank_mask:0xf bound_ctrl:1
    v_add_u32_dpp v15, v15, v15 row_shr:4 row_mask:0xf bank_mask:0xf bound_ctrl:1
    s_nop 0
    v_add_u32_dpp v14, v14, v14 row_shr:8 row_mask:0xf bank_mask:0xf bound_ctrl:1
    v_add_u32_dpp v15, v15, v15 row_shr:8 row_mask:0xf bank_mask:0xf bound_ctrl:1
    s_nop 0
    v_add_u32_dpp v14, v14, v14 row_bcast:15 row_mask:0xa bank_mask:0xf
    v_add_u32_dpp v15, v15, v15 row_bcast:15 row_mask:0xa bank_mask:0xf
    s_nop 0
    v_add_u32_dpp v14, v14, v14 row_bcast:31 row_mask:0xc bank_mask:0xf
    v_add_u32_dpp v15, v15, v15 row_bcast:31 row_mask:0xc bank_mask:0xf
    v_readlane_b32 s48, v14, 63
    v_readlane_b32 s49, v15, 63
    s_lshl_b32 s54, s32, 2
    v_mov_b32 v8, s54
    s_and_b32 s50, s48, 0xffff
    s_lshr_b32 s51, s48, 16
    s_and_b32 s52, s49, 0xffff
    s_lshr_b32 s53, s49, 16
    s_add_u32 s51, s51, s50
    s_add_u32 s52, s52, s51
    s_add_u32 s53, s53, s52
    v_mov_b32 v9, s53
    s_mov_b64 exec, 1
    ds_write_b32 v8, v9 offset:16384
    s_mov_b64 exec, -1
    v_and_b32 v8, 60, v7
    s_waitcnt lgkmcnt(0)
    s_barrier
    ds_read_b32 v9, v8 offset:16384
    s_waitcnt lgkmcnt(0)
    v_add_u32_dpp v9, v9, v9 row_shr:1 row_mask:0xf bank_mask:0xf bound_ctrl:1
    s_nop 1
    v_add_u32_dpp v9, v9, v9 row_shr:2 row_mask:0xf bank_mask:0xf bound_ctrl:1
    s_nop 1
    v_add_u32_dpp v9, v9, v9 row_shr:4 row_mask:0xf bank_mask:0xf bound_ctrl:1
    s_nop 1
    v_add_u32_dpp v9, v9, v9 row_shr:8 row_mask:0xf bank_mask:0xf bound_ctrl:1
    s_nop 0
    v_readlane_b32 s54, v9, s32
    s_sub_u32 s54, s54, s53
    s_add_u32 s50, s50, s54
    s_add_u32 s51, s51, s54
    s_add_u32 s52, s52, s54
    s_pack_ll_b32_b16 s48, s54, s50
    s_pack_ll_b32_b16 s49, s51, s52
    v_add_u32 v14, s48, v14
    v_add_u32 v15, s49, v15
    v_sub_u32 v12, v14, v12
    v_sub_u32 v13, v15, v13
    v_and_b32 v8, 0xffff, v12
    v_lshrrev_b32 v9, 16, v12
    v_and_b32 v10, 0xffff, v13
    v_lshrrev_b32 v11, 16, v13
    ds_write2st64_b32 v7, v8, v9 offset0:0 offset1:1
    ds_write2st64_b32 v7, v10, v11 offset0:2 offset1:3
    v_and_b32 v8, 0x3f0, v0
    v_lshl_add_u32 v8, v8, 1, s36
    ds_write_b64 v8, v[12:13] offset:20480
    s_bitset0_b64 exec, 63
    s_not_b64 exec, exec
    ds_write_b64 v8, v[14:15] offset:20512
    s_mov_b64 exec, -1
    s_waitcnt lgkmcnt(0)
    s_barrier
    s_setprio 3
    ds_add_rtn_u32 v20, v20, v2
    ds_add_rtn_u32 v21, v21, v2
    ds_add_rtn_u32 v22, v22, v2
    ds_add_rtn_u32 v23, v23, v2
    ds_read_b128 v[12:15], v0 offset:20480
    v_cmp_gt_u32 vcc, 8448, v0
    ds_add_rtn_u32 v32, v32, v2
    ds_add_rtn_u32 v33, v33, v2
    ds_add_rtn_u32 v34, v34, v2
    ds_add_rtn_u32 v35, v35, v2
    s_setprio 2
    ds_add_rtn_u32 v40, v40, v2
    ds_add_rtn_u32 v41, v41, v2
    ds_add_rtn_u32 v42, v42, v2
    ds_add_rtn_u32 v43, v43, v2
    s_waitcnt lgkmcnt(8)
    s_cbranch_vccz L1_p1
    s_add_u32 s46, s35, 0x0
    s_mov_b64 exec, vcc
    buffer_store_dwordx4 v[12:15], v0, s[24:27], s46 offen sc1
    s_mov_b64 exec, -1
L1_p1:
    s_add_u32 s47, s98, 0x2800000
    v_lshlrev_b32 v116, 1, v1
    buffer_load_dwordx4 v[116:119], v116, s[8:11], s47 offen nt
    ds_add_rtn_u32 v52, v52, v2
    ds_add_rtn_u32 v53, v53, v2
    ds_add_rtn_u32 v54, v54, v2
    ds_add_rtn_u32 v55, v55, v2
    s_setprio 1
    ds_add_rtn_u32 v60, v60, v2
    ds_add_rtn_u32 v61, v61, v2
    ds_add_rtn_u32 v62, v62, v2
    ds_add_rtn_u32 v63, v63, v2
    ds_add_rtn_u32 v72, v72, v2
    ds_add_rtn_u32 v73, v73, v2
    ds_add_rtn_u32 v74, v74, v2
    ds_add_rtn_u32 v75, v75, v2
    s_add_u32 s44, s98, 0x2800000
    v_lshlrev_b32 v120, 1, v1
    buffer_load_dwordx4 v[120:123], v120, s[12:15], s44 offen nt
    s_setprio 0
    ds_add_rtn_u32 v80, v80, v2
    ds_add_rtn_u32 v81, v81, v2
    ds_add_rtn_u32 v82, v82, v2
    ds_add_rtn_u32 v83, v83, v2
    ds_add_rtn_u32 v92, v92, v2
    ds_add_rtn_u32 v93, v93, v2
    ds_add_rtn_u32 v94, v94, v2
    ds_add_rtn_u32 v95, v95, v2
    s_waitcnt lgkmcnt(0)
    s_barrier
    s_setprio 3
    v_and_b32 v7, -4, v20
    v_lshl_add_u32 v8, v20, 2, v7
    ds_write_b32 v8, v16
    v_lshl_add_u32 v7, v7, 2, v20
    ds_write_b8 v7, v24 offset:16
    v_and_b32 v9, -4, v21
    v_lshl_add_u32 v10, v21, 2, v9
    ds_write_b32 v10, v17
    v_lshl_add_u32 v9, v9, 2, v21
    ds_write_b8_d16_hi v9, v24 offset:16
    v_and_b32 v7, -4, v22
    v_lshl_add_u32 v8, v22, 2, v7
    ds_write_b32 v8, v18
    v_lshl_add_u32 v7, v7, 2, v22
    ds_write_b8 v7, v25 offset:16
    v_and_b32 v9, -4, v23
    v_lshl_add_u32 v10, v23, 2, v9
    ds_write_b32 v10, v19
    v_lshl_add_u32 v9, v9, 2, v23
    ds_write_b8_d16_hi v9, v25 offset:16
    s_add_u32 s45, s98, 0x2800000
    s_lshr_b32 s45, s45, 1
    buffer_load_dwordx2 v[124:125], v1, s[16:19], s45 offen nt
    s_add_u32 s46, s99, 0x2c00000
    s_lshr_b32 s46, s46, 1
    buffer_load_dwordx2 v[126:127], v1, s[16:19], s46 offen nt
    s_add_u32 s47, s99, 0x2c00000
    v_lshlrev_b32 v16, 1, v1
    buffer_load_dwordx4 v[16:19], v16, s[8:11], s47 offen nt
    v_and_b32 v7, -4, v32
    v_lshl_add_u32 v8, v32, 2, v7
    ds_write_b32 v8, v28
    v_lshl_add_u32 v7, v7, 2, v32
    ds_write_b8 v7, v26 offset:16
    v_and_b32 v9, -4, v33
    v_lshl_add_u32 v10, v33, 2, v9
    ds_write_b32 v10, v29
    v_lshl_add_u32 v9, v9, 2, v33
    ds_write_b8_d16_hi v9, v26 offset:16
    v_and_b32 v7, -4, v34
    v_lshl_add_u32 v8, v34, 2, v7
    ds_write_b32 v8, v30
    v_lshl_add_u32 v7, v7, 2, v34
    ds_write_b8 v7, v27 offset:16
    v_and_b32 v9, -4, v35
    v_lshl_add_u32 v10, v35, 2, v9
    ds_write_b32 v10, v31
    v_lshl_add_u32 v9, v9, 2, v35
    ds_write_b8_d16_hi v9, v27 offset:16
    s_add_u32 s44, s99, 0x2c00000
    v_lshlrev_b32 v20, 1, v1
    buffer_load_dwordx4 v[20:23], v20, s[12:15], s44 offen nt
    s_setprio 2
    v_and_b32 v7, -4, v40
    v_lshl_add_u32 v8, v40, 2, v7
    ds_write_b32 v8, v36
    v_lshl_add_u32 v7, v7, 2, v40
    ds_write_b8 v7, v44 offset:16
    v_and_b32 v9, -4, v41
    v_lshl_add_u32 v10, v41, 2, v9
    ds_write_b32 v10, v37
    v_lshl_add_u32 v9, v9, 2, v41
    ds_write_b8_d16_hi v9, v44 offset:16
    v_and_b32 v7, -4, v42
    v_lshl_add_u32 v8, v42, 2, v7
    ds_write_b32 v8, v38
    v_lshl_add_u32 v7, v7, 2, v42
    ds_write_b8 v7, v45 offset:16
    v_and_b32 v9, -4, v43
    v_lshl_add_u32 v10, v43, 2, v9
    ds_write_b32 v10, v39
    v_lshl_add_u32 v9, v9, 2, v43
    ds_write_b8_d16_hi v9, v45 offset:16
    s_add_u32 s45, s96, 0x3000000
    v_lshlrev_b32 v28, 1, v1
    buffer_load_dwordx4 v[28:31], v28, s[8:11], s45 offen nt
    s_add_u32 s46, s96, 0x3000000
    v_lshlrev_b32 v32, 1, v1
    buffer_load_dwordx4 v[32:35], v32, s[12:15], s46 offen nt
    v_and_b32 v7, -4, v52
    v_lshl_add_u32 v8, v52, 2, v7
    ds_write_b32 v8, v48
    v_lshl_add_u32 v7, v7, 2, v52
    ds_write_b8 v7, v46 offset:16
    v_and_b32 v9, -4, v53
    v_lshl_add_u32 v10, v53, 2, v9
    ds_write_b32 v10, v49
    v_lshl_add_u32 v9, v9, 2, v53
    ds_write_b8_d16_hi v9, v46 offset:16
    v_and_b32 v7, -4, v54
    v_lshl_add_u32 v8, v54, 2, v7
    ds_write_b32 v8, v50
    v_lshl_add_u32 v7, v7, 2, v54
    ds_write_b8 v7, v47 offset:16
    v_and_b32 v9, -4, v55
    v_lshl_add_u32 v10, v55, 2, v9
    ds_write_b32 v10, v51
    v_lshl_add_u32 v9, v9, 2, v55
    ds_write_b8_d16_hi v9, v47 offset:16
    s_add_u32 s47, s96, 0x3000000
    s_lshr_b32 s47, s47, 1
    buffer_load_dwordx2 v[24:25], v1, s[16:19], s47 offen nt
    s_add_u32 s44, s97, 0x3400000
    s_lshr_b32 s44, s44, 1
    buffer_load_dwordx2 v[26:27], v1, s[16:19], s44 offen nt
    s_setprio 1
    v_and_b32 v7, -4, v60
    v_lshl_add_u32 v8, v60, 2, v7
    ds_write_b32 v8, v56
    v_lshl_add_u32 v7, v7, 2, v60
    ds_write_b8 v7, v64 offset:16
    v_and_b32 v9, -4, v61
    v_lshl_add_u32 v10, v61, 2, v9
    ds_write_b32 v10, v57
    v_lshl_add_u32 v9, v9, 2, v61
    ds_write_b8_d16_hi v9, v64 offset:16
    v_and_b32 v7, -4, v62
    v_lshl_add_u32 v8, v62, 2, v7
    ds_write_b32 v8, v58
    v_lshl_add_u32 v7, v7, 2, v62
    ds_write_b8 v7, v65 offset:16
    v_and_b32 v9, -4, v63
    v_lshl_add_u32 v10, v63, 2, v9
    ds_write_b32 v10, v59
    v_lshl_add_u32 v9, v9, 2, v63
    ds_write_b8_d16_hi v9, v65 offset:16
    s_add_u32 s45, s97, 0x3400000
    v_lshlrev_b32 v36, 1, v1
    buffer_load_dwordx4 v[36:39], v36, s[8:11], s45 offen nt
    v_and_b32 v7, -4, v72
    v_lshl_add_u32 v8, v72, 2, v7
    ds_write_b32 v8, v68
    v_lshl_add_u32 v7, v7, 2, v72
    ds_write_b8 v7, v66 offset:16
    v_and_b32 v9, -4, v73
    v_lshl_add_u32 v10, v73, 2, v9
    ds_write_b32 v10, v69
    v_lshl_add_u32 v9, v9, 2, v73
    ds_write_b8_d16_hi v9, v66 offset:16
    v_and_b32 v7, -4, v74
    v_lshl_add_u32 v8, v74, 2, v7
    ds_write_b32 v8, v70
    v_lshl_add_u32 v7, v7, 2, v74
    ds_write_b8 v7, v67 offset:16
    v_and_b32 v9, -4, v75
    v_lshl_add_u32 v10, v75, 2, v9
    ds_write_b32 v10, v71
    v_lshl_add_u32 v9, v9, 2, v75
    ds_write_b8_d16_hi v9, v67 offset:16
    s_add_u32 s46, s97, 0x3400000
    v_lshlrev_b32 v40, 1, v1
    buffer_load_dwordx4 v[40:43], v40, s[12:15], s46 offen nt
    s_add_u32 s47, s98, 0x3800000
    v_lshlrev_b32 v48, 1, v1
    buffer_load_dwordx4 v[48:51], v48, s[8:11], s47 offen nt
    s_setprio 0
    v_and_b32 v7, -4, v80
    v_lshl_add_u32 v8, v80, 2, v7
    ds_write_b32 v8, v76
    v_lshl_add_u32 v7, v7, 2, v80
    ds_write_b8 v7, v84 offset:16
    v_and_b32 v9, -4, v81
    v_lshl_add_u32 v10, v81, 2, v9
    ds_write_b32 v10, v77
    v_lshl_add_u32 v9, v9, 2, v81
    ds_write_b8_d16_hi v9, v84 offset:16
    v_and_b32 v7, -4, v82
    v_lshl_add_u32 v8, v82, 2, v7
    ds_write_b32 v8, v78
    v_lshl_add_u32 v7, v7, 2, v82
    ds_write_b8 v7, v85 offset:16
    v_and_b32 v9, -4, v83
    v_lshl_add_u32 v10, v83, 2, v9
    ds_write_b32 v10, v79
    v_lshl_add_u32 v9, v9, 2, v83
    ds_write_b8_d16_hi v9, v85 offset:16
    s_add_u32 s44, s98, 0x3800000
    v_lshlrev_b32 v52, 1, v1
    buffer_load_dwordx4 v[52:55], v52, s[12:15], s44 offen nt
    v_and_b32 v7, -4, v92
    v_lshl_add_u32 v8, v92, 2, v7
    ds_write_b32 v8, v88
    v_lshl_add_u32 v7, v7, 2, v92
    ds_write_b8 v7, v86 offset:16
    v_and_b32 v9, -4, v93
    v_lshl_add_u32 v10, v93, 2, v9
    ds_write_b32 v10, v89
    v_lshl_add_u32 v9, v9, 2, v93
    ds_write_b8_d16_hi v9, v86 offset:16
    v_and_b32 v7, -4, v94
    v_lshl_add_u32 v8, v94, 2, v7
    ds_write_b32 v8, v90
    v_lshl_add_u32 v7, v7, 2, v94
    ds_write_b8 v7, v87 offset:16
    v_and_b32 v9, -4, v95
    v_lshl_add_u32 v10, v95, 2, v9
    ds_write_b32 v10, v91
    v_lshl_add_u32 v9, v9, 2, v95
    ds_write_b8_d16_hi v9, v87 offset:16
    s_add_u32 s45, s98, 0x3800000
    s_lshr_b32 s45, s45, 1
    buffer_load_dwordx2 v[44:45], v1, s[16:19], s45 offen nt
    s_add_u32 s46, s99, 0x3c00000
    s_lshr_b32 s46, s46, 1
    buffer_load_dwordx2 v[46:47], v1, s[16:19], s46 offen nt
    v_add_u32 v7, s72, v0
    v_add_u32 v12, s73, v0
    v_add_u32 v13, s85, v0
    v_add_u32 v14, s91, v0
    v_add_u32 v15, s93, v0
    s_min_i32 s3, s72, s73
    s_min_i32 s3, s3, s85
    s_min_i32 s3, s3, s91
    s_min_i32 s3, s3, s93
    v_add_u32 v3, s3, v0
    v_mov_b32 v8, 0
    v_mov_b32 v9, 0
    v_mov_b32 v10, 0
    v_mov_b32 v11, 0
    s_waitcnt lgkmcnt(0)
    s_barrier
    ds_read_b128 v[56:59], v7 offset:0
    ds_read_b128 v[60:63], v12 offset:0
    ds_read_b128 v[68:71], v13 offset:0
    ds_read_b128 v[72:75], v14 offset:0
    ds_read_b128 v[64:67], v15 offset:0
    ds_write_b128 v3, v[8:11]
    ds_read_b128 v[76:79], v7 offset:16384
    ds_read_b128 v[80:83], v12 offset:16384
    ds_read_b128 v[88:91], v13 offset:16384
    ds_read_b128 v[92:95], v14 offset:16384
    ds_read_b128 v[84:87], v15 offset:16384
    s_waitcnt lgkmcnt(0)
    s_barrier
    s_setprio 3
    s_add_u32 s47, s35, 0x4000
    s_add_u32 s47, s47, s72
    buffer_store_dwordx4 v[56:59], v0, s[20:23], s47 offen sc1
    s_add_u32 s44, s99, 0x3c00000
    s_nop 0
    v_lshlrev_b32 v56, 1, v1
    buffer_load_dwordx4 v[56:59], v56, s[8:11], s44 offen nt
    s_add_u32 s45, s35, 0x4000
    s_add_u32 s45, s45, s73
    buffer_store_dwordx4 v[60:63], v0, s[20:23], s45 offen sc1
    s_add_u32 s46, s99, 0x3c00000
    s_nop 0
    v_lshlrev_b32 v60, 1, v1
    buffer_load_dwordx4 v[60:63], v60, s[12:15], s46 offen nt
    s_waitcnt vmcnt(22)
    v_lshlrev_b32 v7, 16, v108
    v_and_b32 v8, 0xffff0000, v108
    v_lshlrev_b32 v9, 16, v109
    v_and_b32 v10, 0xffff0000, v109
    v_mul_f32 v7, 0.15915494, v7
    v_mul_f32 v8, 0.15915494, v8
    v_mul_f32 v9, 0.15915494, v9
    v_mul_f32 v10, 0.15915494, v10
    v_mul_hi_u32_u24 v14, 429497, v96
    v_lshrrev_b32 v12, 3, v104
    v_cos_f32 v7, v7
    v_lshlrev_b16 v13, 3, v104
    v_mad_i32_i24 v11, v14, s55, v96
    v_bitop3_b32 v12, v6, v13, v12 bitop3:0xca
    v_lshl_add_u32 v11, v11, 17, s40
    v_lshlrev_b16 v14, 8, v14
    v_lshrrev_b32 v13, 2, v104
    v_add_u32 v96, v12, v11
    v_bitop3_b32 v104, v5, v13, v14 bitop3:0xea
    ds_add_u32 v104, v2
    v_mul_hi_u32_u24 v14, 429497, v97
    v_lshrrev_b32 v12, 3, v105
    v_cos_f32 v8, v8
    v_lshlrev_b16 v13, 3, v105
    v_mad_i32_i24 v11, v14, s55, v97
    v_bitop3_b32 v12, v6, v13, v12 bitop3:0xca
    v_lshl_add_u32 v11, v11, 17, s40
    v_lshlrev_b16 v14, 8, v14
    v_lshrrev_b32 v13, 2, v105
    v_add_u32 v97, v12, v11
    v_bitop3_b32 v105, v5, v13, v14 bitop3:0xea
    ds_add_u32 v105, v2
    v_cvt_pk_bf16_f32 v108, v7, v8
    v_perm_b32 v12, v108, v108, s41
    v_bitop3_b32 v96, v4, v12, v96 bitop3:0xca
    v_perm_b32 v13, v108, v108, s42
    v_bitop3_b32 v97, v4, v13, v97 bitop3:0xca
    v_mul_hi_u32_u24 v14, 429497, v98
    v_lshrrev_b32 v12, 3, v106
    v_cos_f32 v9, v9
    v_lshlrev_b16 v13, 3, v106
    v_mad_i32_i24 v11, v14, s55, v98
    v_bitop3_b32 v12, v6, v13, v12 bitop3:0xca
    v_lshl_add_u32 v11, v11, 17, s40
    v_lshlrev_b16 v14, 8, v14
    v_lshrrev_b32 v13, 2, v106
    v_add_u32 v98, v12, v11
    v_bitop3_b32 v106, v5, v13, v14 bitop3:0xea
    ds_add_u32 v106, v2
    v_mul_hi_u32_u24 v14, 429497, v99
    v_lshrrev_b32 v12, 3, v107
    v_cos_f32 v10, v10
    v_lshlrev_b16 v13, 3, v107
    v_mad_i32_i24 v11, v14, s55, v99
    v_bitop3_b32 v12, v6, v13, v12 bitop3:0xca
    v_lshl_add_u32 v11, v11, 17, s40
    v_lshlrev_b16 v14, 8, v14
    v_lshrrev_b32 v13, 2, v107
    v_add_u32 v99, v12, v11
    v_bitop3_b32 v107, v5, v13, v14 bitop3:0xea
    ds_add_u32 v107, v2
    v_cvt_pk_bf16_f32 v109, v9, v10
    v_perm_b32 v12, v109, v109, s41
    v_bitop3_b32 v98, v4, v12, v98 bitop3:0xca
    v_perm_b32 v13, v109, v109, s42
    v_bitop3_b32 v99, v4, v13, v99 bitop3:0xca
    s_waitcnt vmcnt(20)
    v_lshlrev_b32 v7, 16, v110
    v_and_b32 v8, 0xffff0000, v110
    v_lshlrev_b32 v9, 16, v111
    v_and_b32 v10, 0xffff0000, v111
    v_mul_f32 v7, 0.15915494, v7
    v_mul_f32 v8, 0.15915494, v8
    v_mul_f32 v9, 0.15915494, v9
    v_mul_f32 v10, 0.15915494, v10
    v_mul_hi_u32_u24 v14, 429497, v100
    v_lshrrev_b32 v12, 3, v112
    v_cos_f32 v7, v7
    v_lshlrev_b16 v13, 3, v112
    v_mad_i32_i24 v11, v14, s55, v100
    v_bitop3_b32 v12, v6, v13, v12 bitop3:0xca
    v_lshl_add_u32 v11, v11, 17, s40
    v_lshlrev_b16 v14, 8, v14
    v_lshrrev_b32 v13, 2, v112
    v_add_u32 v100, v12, v11
    v_bitop3_b32 v112, v5, v13, v14 bitop3:0xea
    ds_add_u32 v112, v2
    v_mul_hi_u32_u24 v14, 429497, v101
    v_lshrrev_b32 v12, 3, v113
    v_cos_f32 v8, v8
    v_lshlrev_b16 v13, 3, v113
    v_mad_i32_i24 v11, v14, s55, v101
    v_bitop3_b32 v12, v6, v13, v12 bitop3:0xca
    v_lshl_add_u32 v11, v11, 17, s40
    v_lshlrev_b16 v14, 8, v14
    v_lshrrev_b32 v13, 2, v113
    v_add_u32 v101, v12, v11
    v_bitop3_b32 v113, v5, v13, v14 bitop3:0xea
    ds_add_u32 v113, v2
    v_cvt_pk_bf16_f32 v110, v7, v8
    v_perm_b32 v12, v110, v110, s41
    v_bitop3_b32 v100, v4, v12, v100 bitop3:0xca
    v_perm_b32 v13, v110, v110, s42
    v_bitop3_b32 v101, v4, v13, v101 bitop3:0xca
    v_mul_hi_u32_u24 v14, 429497, v102
    v_lshrrev_b32 v12, 3, v114
    v_cos_f32 v9, v9
    v_lshlrev_b16 v13, 3, v114
    v_mad_i32_i24 v11, v14, s55, v102
    v_bitop3_b32 v12, v6, v13, v12 bitop3:0xca
    v_lshl_add_u32 v11, v11, 17, s40
    v_lshlrev_b16 v14, 8, v14
    v_lshrrev_b32 v13, 2, v114
    v_add_u32 v102, v12, v11
    v_bitop3_b32 v114, v5, v13, v14 bitop3:0xea
    ds_add_u32 v114, v2
    v_mul_hi_u32_u24 v14, 429497, v103
    v_lshrrev_b32 v12, 3, v115
    v_cos_f32 v10, v10
    v_lshlrev_b16 v13, 3, v115
    v_mad_i32_i24 v11, v14, s55, v103
    v_bitop3_b32 v12, v6, v13, v12 bitop3:0xca
    v_lshl_add_u32 v11, v11, 17, s40
    v_lshlrev_b16 v14, 8, v14
    v_lshrrev_b32 v13, 2, v115
    v_add_u32 v103, v12, v11
    v_bitop3_b32 v115, v5, v13, v14 bitop3:0xea
    ds_add_u32 v115, v2
    v_cvt_pk_bf16_f32 v111, v9, v10
    v_perm_b32 v12, v111, v111, s41
    v_bitop3_b32 v102, v4, v12, v102 bitop3:0xca
    v_perm_b32 v13, v111, v111, s42
    v_bitop3_b32 v103, v4, v13, v103 bitop3:0xca
    s_setprio 2
    s_waitcnt vmcnt(16)
    v_lshlrev_b32 v7, 16, v124
    v_and_b32 v8, 0xffff0000, v124
    v_lshlrev_b32 v9, 16, v125
    v_and_b32 v10, 0xffff0000, v125
    v_mul_f32 v7, 0.15915494, v7
    v_mul_f32 v8, 0.15915494, v8
    v_mul_f32 v9, 0.15915494, v9
    v_mul_f32 v10, 0.15915494, v10
    v_mul_hi_u32_u24 v14, 429497, v116
    v_lshrrev_b32 v12, 3, v120
    v_cos_f32 v7, v7
    v_lshlrev_b16 v13, 3, v120
    v_mad_i32_i24 v11, v14, s55, v116
    v_bitop3_b32 v12, v6, v13, v12 bitop3:0xca
    v_lshl_add_u32 v11, v11, 17, s40
    v_lshlrev_b16 v14, 8, v14
    v_lshrrev_b32 v13, 2, v120
    v_add_u32 v116, v12, v11
    v_bitop3_b32 v120, v5, v13, v14 bitop3:0xea
    ds_add_u32 v120, v2
    v_mul_hi_u32_u24 v14, 429497, v117
    v_lshrrev_b32 v12, 3, v121
    v_cos_f32 v8, v8
    v_lshlrev_b16 v13, 3, v121
    v_mad_i32_i24 v11, v14, s55, v117
    v_bitop3_b32 v12, v6, v13, v12 bitop3:0xca
    v_lshl_add_u32 v11, v11, 17, s40
    v_lshlrev_b16 v14, 8, v14
    v_lshrrev_b32 v13, 2, v121
    v_add_u32 v117, v12, v11
    v_bitop3_b32 v121, v5, v13, v14 bitop3:0xea
    ds_add_u32 v121, v2
    v_cvt_pk_bf16_f32 v124, v7, v8
    v_perm_b32 v12, v124, v124, s41
    v_bitop3_b32 v116, v4, v12, v116 bitop3:0xca
    v_perm_b32 v13, v124, v124, s42
    v_bitop3_b32 v117, v4, v13, v117 bitop3:0xca
    v_mul_hi_u32_u24 v14, 429497, v118
    v_lshrrev_b32 v12, 3, v122
    v_cos_f32 v9, v9
    v_lshlrev_b16 v13, 3, v122
    v_mad_i32_i24 v11, v14, s55, v118
    v_bitop3_b32 v12, v6, v13, v12 bitop3:0xca
    v_lshl_add_u32 v11, v11, 17, s40
    v_lshlrev_b16 v14, 8, v14
    v_lshrrev_b32 v13, 2, v122
    v_add_u32 v118, v12, v11
    v_bitop3_b32 v122, v5, v13, v14 bitop3:0xea
    ds_add_u32 v122, v2
    v_mul_hi_u32_u24 v14, 429497, v119
    v_lshrrev_b32 v12, 3, v123
    v_cos_f32 v10, v10
    v_lshlrev_b16 v13, 3, v123
    v_mad_i32_i24 v11, v14, s55, v119
    v_bitop3_b32 v12, v6, v13, v12 bitop3:0xca
    v_lshl_add_u32 v11, v11, 17, s40
    v_lshlrev_b16 v14, 8, v14
    v_lshrrev_b32 v13, 2, v123
    v_add_u32 v119, v12, v11
    v_bitop3_b32 v123, v5, v13, v14 bitop3:0xea
    ds_add_u32 v123, v2
    v_cvt_pk_bf16_f32 v125, v9, v10
    v_perm_b32 v12, v125, v125, s41
    v_bitop3_b32 v118, v4, v12, v118 bitop3:0xca
    v_perm_b32 v13, v125, v125, s42
    v_bitop3_b32 v119, v4, v13, v119 bitop3:0xca
    s_add_u32 s47, s35, 0x4000
    s_add_u32 s47, s47, s85
    buffer_store_dwordx4 v[68:71], v0, s[20:23], s47 offen sc1
    s_add_u32 s44, s96, 0x4000000
    s_nop 0
    v_lshlrev_b32 v68, 1, v1
    buffer_load_dwordx4 v[68:71], v68, s[8:11], s44 offen nt
    s_waitcnt vmcnt(16)
    v_lshlrev_b32 v7, 16, v126
    v_and_b32 v8, 0xffff0000, v126
    v_lshlrev_b32 v9, 16, v127
    v_and_b32 v10, 0xffff0000, v127
    v_mul_f32 v7, 0.15915494, v7
    v_mul_f32 v8, 0.15915494, v8
    v_mul_f32 v9, 0.15915494, v9
    v_mul_f32 v10, 0.15915494, v10
    v_mul_hi_u32_u24 v14, 429497, v16
    v_lshrrev_b32 v12, 3, v20
    v_cos_f32 v7, v7
    v_lshlrev_b16 v13, 3, v20
    v_mad_i32_i24 v11, v14, s55, v16
    v_bitop3_b32 v12, v6, v13, v12 bitop3:0xca
    v_lshl_add_u32 v11, v11, 17, s40
    v_lshlrev_b16 v14, 8, v14
    v_lshrrev_b32 v13, 2, v20
    v_add_u32 v16, v12, v11
    v_bitop3_b32 v20, v5, v13, v14 bitop3:0xea
    ds_add_u32 v20, v2
    v_mul_hi_u32_u24 v14, 429497, v17
    v_lshrrev_b32 v12, 3, v21
    v_cos_f32 v8, v8
    v_lshlrev_b16 v13, 3, v21
    v_mad_i32_i24 v11, v14, s55, v17
    v_bitop3_b32 v12, v6, v13, v12 bitop3:0xca
    v_lshl_add_u32 v11, v11, 17, s40
    v_lshlrev_b16 v14, 8, v14
    v_lshrrev_b32 v13, 2, v21
    v_add_u32 v17, v12, v11
    v_bitop3_b32 v21, v5, v13, v14 bitop3:0xea
    ds_add_u32 v21, v2
    v_cvt_pk_bf16_f32 v126, v7, v8
    v_perm_b32 v12, v126, v126, s41
    v_bitop3_b32 v16, v4, v12, v16 bitop3:0xca
    v_perm_b32 v13, v126, v126, s42
    v_bitop3_b32 v17, v4, v13, v17 bitop3:0xca
    v_mul_hi_u32_u24 v14, 429497, v18
    v_lshrrev_b32 v12, 3, v22
    v_cos_f32 v9, v9
    v_lshlrev_b16 v13, 3, v22
    v_mad_i32_i24 v11, v14, s55, v18
    v_bitop3_b32 v12, v6, v13, v12 bitop3:0xca
    v_lshl_add_u32 v11, v11, 17, s40
    v_lshlrev_b16 v14, 8, v14
    v_lshrrev_b32 v13, 2, v22
    v_add_u32 v18, v12, v11
    v_bitop3_b32 v22, v5, v13, v14 bitop3:0xea
    ds_add_u32 v22, v2
    v_mul_hi_u32_u24 v14, 429497, v19
    v_lshrrev_b32 v12, 3, v23
    v_cos_f32 v10, v10
    v_lshlrev_b16 v13, 3, v23
    v_mad_i32_i24 v11, v14, s55, v19
    v_bitop3_b32 v12, v6, v13, v12 bitop3:0xca
    v_lshl_add_u32 v11, v11, 17, s40
    v_lshlrev_b16 v14, 8, v14
    v_lshrrev_b32 v13, 2, v23
    v_add_u32 v19, v12, v11
    v_bitop3_b32 v23, v5, v13, v14 bitop3:0xea
    ds_add_u32 v23, v2
    v_cvt_pk_bf16_f32 v127, v9, v10
    v_perm_b32 v12, v127, v127, s41
    v_bitop3_b32 v18, v4, v12, v18 bitop3:0xca
    v_perm_b32 v13, v127, v127, s42
    v_bitop3_b32 v19, v4, v13, v19 bitop3:0xca
    s_setprio 1
    s_waitcnt vmcnt(12)
    v_lshlrev_b32 v7, 16, v24
    v_and_b32 v8, 0xffff0000, v24
    v_lshlrev_b32 v9, 16, v25
    v_and_b32 v10, 0xffff0000, v25
    v_mul_f32 v7, 0.15915494, v7
    v_mul_f32 v8, 0.15915494, v8
    v_mul_f32 v9, 0.15915494, v9
    v_mul_f32 v10, 0.15915494, v10
    v_mul_hi_u32_u24 v14, 429497, v28
    v_lshrrev_b32 v12, 3, v32
    v_cos_f32 v7, v7
    v_lshlrev_b16 v13, 3, v32
    v_mad_i32_i24 v11, v14, s55, v28
    v_bitop3_b32 v12, v6, v13, v12 bitop3:0xca
    v_lshl_add_u32 v11, v11, 17, s40
    v_lshlrev_b16 v14, 8, v14
    v_lshrrev_b32 v13, 2, v32
    v_add_u32 v28, v12, v11
    v_bitop3_b32 v32, v5, v13, v14 bitop3:0xea
    ds_add_u32 v32, v2
    v_mul_hi_u32_u24 v14, 429497, v29
    v_lshrrev_b32 v12, 3, v33
    v_cos_f32 v8, v8
    v_lshlrev_b16 v13, 3, v33
    v_mad_i32_i24 v11, v14, s55, v29
    v_bitop3_b32 v12, v6, v13, v12 bitop3:0xca
    v_lshl_add_u32 v11, v11, 17, s40
    v_lshlrev_b16 v14, 8, v14
    v_lshrrev_b32 v13, 2, v33
    v_add_u32 v29, v12, v11
    v_bitop3_b32 v33, v5, v13, v14 bitop3:0xea
    ds_add_u32 v33, v2
    v_cvt_pk_bf16_f32 v24, v7, v8
    v_perm_b32 v12, v24, v24, s41
    v_bitop3_b32 v28, v4, v12, v28 bitop3:0xca
    v_perm_b32 v13, v24, v24, s42
    v_bitop3_b32 v29, v4, v13, v29 bitop3:0xca
    v_mul_hi_u32_u24 v14, 429497, v30
    v_lshrrev_b32 v12, 3, v34
    v_cos_f32 v9, v9
    v_lshlrev_b16 v13, 3, v34
    v_mad_i32_i24 v11, v14, s55, v30
    v_bitop3_b32 v12, v6, v13, v12 bitop3:0xca
    v_lshl_add_u32 v11, v11, 17, s40
    v_lshlrev_b16 v14, 8, v14
    v_lshrrev_b32 v13, 2, v34
    v_add_u32 v30, v12, v11
    v_bitop3_b32 v34, v5, v13, v14 bitop3:0xea
    ds_add_u32 v34, v2
    v_mul_hi_u32_u24 v14, 429497, v31
    v_lshrrev_b32 v12, 3, v35
    v_cos_f32 v10, v10
    v_lshlrev_b16 v13, 3, v35
    v_mad_i32_i24 v11, v14, s55, v31
    v_bitop3_b32 v12, v6, v13, v12 bitop3:0xca
    v_lshl_add_u32 v11, v11, 17, s40
    v_lshlrev_b16 v14, 8, v14
    v_lshrrev_b32 v13, 2, v35
    v_add_u32 v31, v12, v11
    v_bitop3_b32 v35, v5, v13, v14 bitop3:0xea
    ds_add_u32 v35, v2
    v_cvt_pk_bf16_f32 v25, v9, v10
    v_perm_b32 v12, v25, v25, s41
    v_bitop3_b32 v30, v4, v12, v30 bitop3:0xca
    v_perm_b32 v13, v25, v25, s42
    v_bitop3_b32 v31, v4, v13, v31 bitop3:0xca
    s_waitcnt vmcnt(10)
    v_lshlrev_b32 v7, 16, v26
    v_and_b32 v8, 0xffff0000, v26
    v_lshlrev_b32 v9, 16, v27
    v_and_b32 v10, 0xffff0000, v27
    v_mul_f32 v7, 0.15915494, v7
    v_mul_f32 v8, 0.15915494, v8
    v_mul_f32 v9, 0.15915494, v9
    v_mul_f32 v10, 0.15915494, v10
    v_mul_hi_u32_u24 v14, 429497, v36
    v_lshrrev_b32 v12, 3, v40
    v_cos_f32 v7, v7
    v_lshlrev_b16 v13, 3, v40
    v_mad_i32_i24 v11, v14, s55, v36
    v_bitop3_b32 v12, v6, v13, v12 bitop3:0xca
    v_lshl_add_u32 v11, v11, 17, s40
    v_lshlrev_b16 v14, 8, v14
    v_lshrrev_b32 v13, 2, v40
    v_add_u32 v36, v12, v11
    v_bitop3_b32 v40, v5, v13, v14 bitop3:0xea
    ds_add_u32 v40, v2
    v_mul_hi_u32_u24 v14, 429497, v37
    v_lshrrev_b32 v12, 3, v41
    v_cos_f32 v8, v8
    v_lshlrev_b16 v13, 3, v41
    v_mad_i32_i24 v11, v14, s55, v37
    v_bitop3_b32 v12, v6, v13, v12 bitop3:0xca
    v_lshl_add_u32 v11, v11, 17, s40
    v_lshlrev_b16 v14, 8, v14
    v_lshrrev_b32 v13, 2, v41
    v_add_u32 v37, v12, v11
    v_bitop3_b32 v41, v5, v13, v14 bitop3:0xea
    ds_add_u32 v41, v2
    v_cvt_pk_bf16_f32 v26, v7, v8
    v_perm_b32 v12, v26, v26, s41
    v_bitop3_b32 v36, v4, v12, v36 bitop3:0xca
    v_perm_b32 v13, v26, v26, s42
    v_bitop3_b32 v37, v4, v13, v37 bitop3:0xca
    v_mul_hi_u32_u24 v14, 429497, v38
    v_lshrrev_b32 v12, 3, v42
    v_cos_f32 v9, v9
    v_lshlrev_b16 v13, 3, v42
    v_mad_i32_i24 v11, v14, s55, v38
    v_bitop3_b32 v12, v6, v13, v12 bitop3:0xca
    v_lshl_add_u32 v11, v11, 17, s40
    v_lshlrev_b16 v14, 8, v14
    v_lshrrev_b32 v13, 2, v42
    v_add_u32 v38, v12, v11
    v_bitop3_b32 v42, v5, v13, v14 bitop3:0xea
    ds_add_u32 v42, v2
    v_mul_hi_u32_u24 v14, 429497, v39
    v_lshrrev_b32 v12, 3, v43
    v_cos_f32 v10, v10
    v_lshlrev_b16 v13, 3, v43
    v_mad_i32_i24 v11, v14, s55, v39
    v_bitop3_b32 v12, v6, v13, v12 bitop3:0xca
    v_lshl_add_u32 v11, v11, 17, s40
    v_lshlrev_b16 v14, 8, v14
    v_lshrrev_b32 v13, 2, v43
    v_add_u32 v39, v12, v11
    v_bitop3_b32 v43, v5, v13, v14 bitop3:0xea
    ds_add_u32 v43, v2
    v_cvt_pk_bf16_f32 v27, v9, v10
    v_perm_b32 v12, v27, v27, s41
    v_bitop3_b32 v38, v4, v12, v38 bitop3:0xca
    v_perm_b32 v13, v27, v27, s42
    v_bitop3_b32 v39, v4, v13, v39 bitop3:0xca
    s_setprio 0
    s_add_u32 s45, s35, 0x4000
    s_add_u32 s45, s45, s91
    buffer_store_dwordx4 v[72:75], v0, s[20:23], s45 offen sc1
    s_add_u32 s46, s96, 0x4000000
    s_nop 0
    v_lshlrev_b32 v72, 1, v1
    buffer_load_dwordx4 v[72:75], v72, s[12:15], s46 offen nt
    s_waitcnt vmcnt(8)
    v_lshlrev_b32 v7, 16, v44
    v_and_b32 v8, 0xffff0000, v44
    v_lshlrev_b32 v9, 16, v45
    v_and_b32 v10, 0xffff0000, v45
    v_mul_f32 v7, 0.15915494, v7
    v_mul_f32 v8, 0.15915494, v8
    v_mul_f32 v9, 0.15915494, v9
    v_mul_f32 v10, 0.15915494, v10
    v_mul_hi_u32_u24 v14, 429497, v48
    v_lshrrev_b32 v12, 3, v52
    v_cos_f32 v7, v7
    v_lshlrev_b16 v13, 3, v52
    v_mad_i32_i24 v11, v14, s55, v48
    v_bitop3_b32 v12, v6, v13, v12 bitop3:0xca
    v_lshl_add_u32 v11, v11, 17, s40
    v_lshlrev_b16 v14, 8, v14
    v_lshrrev_b32 v13, 2, v52
    v_add_u32 v48, v12, v11
    v_bitop3_b32 v52, v5, v13, v14 bitop3:0xea
    ds_add_u32 v52, v2
    v_mul_hi_u32_u24 v14, 429497, v49
    v_lshrrev_b32 v12, 3, v53
    v_cos_f32 v8, v8
    v_lshlrev_b16 v13, 3, v53
    v_mad_i32_i24 v11, v14, s55, v49
    v_bitop3_b32 v12, v6, v13, v12 bitop3:0xca
    v_lshl_add_u32 v11, v11, 17, s40
    v_lshlrev_b16 v14, 8, v14
    v_lshrrev_b32 v13, 2, v53
    v_add_u32 v49, v12, v11
    v_bitop3_b32 v53, v5, v13, v14 bitop3:0xea
    ds_add_u32 v53, v2
    v_cvt_pk_bf16_f32 v44, v7, v8
    v_perm_b32 v12, v44, v44, s41
    v_bitop3_b32 v48, v4, v12, v48 bitop3:0xca
    v_perm_b32 v13, v44, v44, s42
    v_bitop3_b32 v49, v4, v13, v49 bitop3:0xca
    v_mul_hi_u32_u24 v14, 429497, v50
    v_lshrrev_b32 v12, 3, v54
    v_cos_f32 v9, v9
    v_lshlrev_b16 v13, 3, v54
    v_mad_i32_i24 v11, v14, s55, v50
    v_bitop3_b32 v12, v6, v13, v12 bitop3:0xca
    v_lshl_add_u32 v11, v11, 17, s40
    v_lshlrev_b16 v14, 8, v14
    v_lshrrev_b32 v13, 2, v54
    v_add_u32 v50, v12, v11
    v_bitop3_b32 v54, v5, v13, v14 bitop3:0xea
    ds_add_u32 v54, v2
    v_mul_hi_u32_u24 v14, 429497, v51
    v_lshrrev_b32 v12, 3, v55
    v_cos_f32 v10, v10
    v_lshlrev_b16 v13, 3, v55
    v_mad_i32_i24 v11, v14, s55, v51
    v_bitop3_b32 v12, v6, v13, v12 bitop3:0xca
    v_lshl_add_u32 v11, v11, 17, s40
    v_lshlrev_b16 v14, 8, v14
    v_lshrrev_b32 v13, 2, v55
    v_add_u32 v51, v12, v11
    v_bitop3_b32 v55, v5, v13, v14 bitop3:0xea
    ds_add_u32 v55, v2
    v_cvt_pk_bf16_f32 v45, v9, v10
    v_perm_b32 v12, v45, v45, s41
    v_bitop3_b32 v50, v4, v12, v50 bitop3:0xca
    v_perm_b32 v13, v45, v45, s42
    v_bitop3_b32 v51, v4, v13, v51 bitop3:0xca
    s_waitcnt vmcnt(4)
    v_lshlrev_b32 v7, 16, v46
    v_and_b32 v8, 0xffff0000, v46
    v_lshlrev_b32 v9, 16, v47
    v_and_b32 v10, 0xffff0000, v47
    v_mul_f32 v7, 0.15915494, v7
    v_mul_f32 v8, 0.15915494, v8
    v_mul_f32 v9, 0.15915494, v9
    v_mul_f32 v10, 0.15915494, v10
    v_mul_hi_u32_u24 v14, 429497, v56
    v_lshrrev_b32 v12, 3, v60
    v_cos_f32 v7, v7
    v_lshlrev_b16 v13, 3, v60
    v_mad_i32_i24 v11, v14, s55, v56
    v_bitop3_b32 v12, v6, v13, v12 bitop3:0xca
    v_lshl_add_u32 v11, v11, 17, s40
    v_lshlrev_b16 v14, 8, v14
    v_lshrrev_b32 v13, 2, v60
    v_add_u32 v56, v12, v11
    v_bitop3_b32 v60, v5, v13, v14 bitop3:0xea
    ds_add_u32 v60, v2
    v_mul_hi_u32_u24 v14, 429497, v57
    v_lshrrev_b32 v12, 3, v61
    v_cos_f32 v8, v8
    v_lshlrev_b16 v13, 3, v61
    v_mad_i32_i24 v11, v14, s55, v57
    v_bitop3_b32 v12, v6, v13, v12 bitop3:0xca
    v_lshl_add_u32 v11, v11, 17, s40
    v_lshlrev_b16 v14, 8, v14
    v_lshrrev_b32 v13, 2, v61
    v_add_u32 v57, v12, v11
    v_bitop3_b32 v61, v5, v13, v14 bitop3:0xea
    ds_add_u32 v61, v2
    v_cvt_pk_bf16_f32 v46, v7, v8
    v_perm_b32 v12, v46, v46, s41
    v_bitop3_b32 v56, v4, v12, v56 bitop3:0xca
    v_perm_b32 v13, v46, v46, s42
    v_bitop3_b32 v57, v4, v13, v57 bitop3:0xca
    v_mul_hi_u32_u24 v14, 429497, v58
    v_lshrrev_b32 v12, 3, v62
    v_cos_f32 v9, v9
    v_lshlrev_b16 v13, 3, v62
    v_mad_i32_i24 v11, v14, s55, v58
    v_bitop3_b32 v12, v6, v13, v12 bitop3:0xca
    v_lshl_add_u32 v11, v11, 17, s40
    v_lshlrev_b16 v14, 8, v14
    v_lshrrev_b32 v13, 2, v62
    v_add_u32 v58, v12, v11
    v_bitop3_b32 v62, v5, v13, v14 bitop3:0xea
    ds_add_u32 v62, v2
    v_mul_hi_u32_u24 v14, 429497, v59
    v_lshrrev_b32 v12, 3, v63
    v_cos_f32 v10, v10
    v_lshlrev_b16 v13, 3, v63
    v_mad_i32_i24 v11, v14, s55, v59
    v_bitop3_b32 v12, v6, v13, v12 bitop3:0xca
    v_lshl_add_u32 v11, v11, 17, s40
    v_lshlrev_b16 v14, 8, v14
    v_lshrrev_b32 v13, 2, v63
    v_add_u32 v59, v12, v11
    v_bitop3_b32 v63, v5, v13, v14 bitop3:0xea
    ds_add_u32 v63, v2
    v_cvt_pk_bf16_f32 v47, v9, v10
    v_perm_b32 v12, v47, v47, s41
    v_bitop3_b32 v58, v4, v12, v58 bitop3:0xca
    v_perm_b32 v13, v47, v47, s42
    v_bitop3_b32 v59, v4, v13, v59 bitop3:0xca
    v_lshrrev_b32 v8, 2, v0
    v_and_b32 v7, 0x3c00, v0
    v_bitop3_b32 v7, v5, v8, v7 bitop3:0xea
    s_waitcnt lgkmcnt(0)
    s_barrier
    ds_read2st64_b32 v[8:9], v7 offset0:0 offset1:1
    ds_read2st64_b32 v[10:11], v7 offset0:2 offset1:3
    s_add_u32 s47, s35, 0x4000
    s_add_u32 s47, s47, s93
    buffer_store_dwordx4 v[64:67], v0, s[20:23], s47 offen sc1
    s_add_u32 s44, s96, 0x4000000
    s_lshr_b32 s44, s44, 1
    buffer_load_dwordx2 v[64:65], v1, s[16:19], s44 offen nt
    s_add_u32 s45, s97, 0x4400000
    s_lshr_b32 s45, s45, 1
    buffer_load_dwordx2 v[66:67], v1, s[16:19], s45 offen nt
    s_waitcnt lgkmcnt(0)
    v_lshl_or_b32 v12, v9, 16, v8
    v_lshl_or_b32 v13, v11, 16, v10
    v_mov_b32 v14, v12
    v_mov_b32 v15, v13
    s_nop 0
    v_add_u32_dpp v14, v14, v14 row_shr:1 row_mask:0xf bank_mask:0xf bound_ctrl:1
    v_add_u32_dpp v15, v15, v15 row_shr:1 row_mask:0xf bank_mask:0xf bound_ctrl:1
    s_nop 0
    v_add_u32_dpp v14, v14, v14 row_shr:2 row_mask:0xf bank_mask:0xf bound_ctrl:1
    v_add_u32_dpp v15, v15, v15 row_shr:2 row_mask:0xf bank_mask:0xf bound_ctrl:1
    s_nop 0
    v_add_u32_dpp v14, v14, v14 row_shr:4 row_mask:0xf bank_mask:0xf bound_ctrl:1
    v_add_u32_dpp v15, v15, v15 row_shr:4 row_mask:0xf bank_mask:0xf bound_ctrl:1
    s_nop 0
    v_add_u32_dpp v14, v14, v14 row_shr:8 row_mask:0xf bank_mask:0xf bound_ctrl:1
    v_add_u32_dpp v15, v15, v15 row_shr:8 row_mask:0xf bank_mask:0xf bound_ctrl:1
    s_nop 0
    v_add_u32_dpp v14, v14, v14 row_bcast:15 row_mask:0xa bank_mask:0xf
    v_add_u32_dpp v15, v15, v15 row_bcast:15 row_mask:0xa bank_mask:0xf
    s_nop 0
    v_add_u32_dpp v14, v14, v14 row_bcast:31 row_mask:0xc bank_mask:0xf
    v_add_u32_dpp v15, v15, v15 row_bcast:31 row_mask:0xc bank_mask:0xf
    v_readlane_b32 s48, v14, 63
    v_readlane_b32 s49, v15, 63
    s_lshl_b32 s54, s32, 2
    v_mov_b32 v8, s54
    s_and_b32 s50, s48, 0xffff
    s_lshr_b32 s51, s48, 16
    s_and_b32 s52, s49, 0xffff
    s_lshr_b32 s53, s49, 16
    s_add_u32 s51, s51, s50
    s_add_u32 s52, s52, s51
    s_add_u32 s53, s53, s52
    v_mov_b32 v9, s53
    s_mov_b64 exec, 1
    ds_write_b32 v8, v9 offset:16384
    s_mov_b64 exec, -1
    v_and_b32 v8, 60, v7
    s_waitcnt lgkmcnt(0)
    s_barrier
    ds_read_b32 v9, v8 offset:16384
    s_waitcnt lgkmcnt(0)
    v_add_u32_dpp v9, v9, v9 row_shr:1 row_mask:0xf bank_mask:0xf bound_ctrl:1
    s_nop 1
    v_add_u32_dpp v9, v9, v9 row_shr:2 row_mask:0xf bank_mask:0xf bound_ctrl:1
    s_nop 1
    v_add_u32_dpp v9, v9, v9 row_shr:4 row_mask:0xf bank_mask:0xf bound_ctrl:1
    s_nop 1
    v_add_u32_dpp v9, v9, v9 row_shr:8 row_mask:0xf bank_mask:0xf bound_ctrl:1
    s_nop 0
    v_readlane_b32 s54, v9, s32
    s_sub_u32 s54, s54, s53
    s_add_u32 s50, s50, s54
    s_add_u32 s51, s51, s54
    s_add_u32 s52, s52, s54
    s_pack_ll_b32_b16 s48, s54, s50
    s_pack_ll_b32_b16 s49, s51, s52
    v_add_u32 v14, s48, v14
    v_add_u32 v15, s49, v15
    v_sub_u32 v12, v14, v12
    v_sub_u32 v13, v15, v13
    v_and_b32 v8, 0xffff, v12
    v_lshrrev_b32 v9, 16, v12
    v_and_b32 v10, 0xffff, v13
    v_lshrrev_b32 v11, 16, v13
    ds_write2st64_b32 v7, v8, v9 offset0:0 offset1:1
    ds_write2st64_b32 v7, v10, v11 offset0:2 offset1:3
    v_and_b32 v8, 0x3f0, v0
    v_lshl_add_u32 v8, v8, 1, s36
    ds_write_b64 v8, v[12:13] offset:20480
    s_bitset0_b64 exec, 63
    s_not_b64 exec, exec
    ds_write_b64 v8, v[14:15] offset:20512
    s_mov_b64 exec, -1
    s_waitcnt lgkmcnt(0)
    s_barrier
    s_setprio 3
    ds_add_rtn_u32 v104, v104, v2
    ds_add_rtn_u32 v105, v105, v2
    ds_add_rtn_u32 v106, v106, v2
    ds_add_rtn_u32 v107, v107, v2
    ds_read_b128 v[12:15], v0 offset:20480
    v_cmp_gt_u32 vcc, 8448, v0
    ds_add_rtn_u32 v112, v112, v2
    ds_add_rtn_u32 v113, v113, v2
    ds_add_rtn_u32 v114, v114, v2
    ds_add_rtn_u32 v115, v115, v2
    s_setprio 2
    ds_add_rtn_u32 v120, v120, v2
    ds_add_rtn_u32 v121, v121, v2
    ds_add_rtn_u32 v122, v122, v2
    ds_add_rtn_u32 v123, v123, v2
    s_waitcnt lgkmcnt(8)
    s_cbranch_vccz L1_p2
    s_add_u32 s46, s35, 0x2a40000
    s_mov_b64 exec, vcc
    buffer_store_dwordx4 v[12:15], v0, s[24:27], s46 offen sc1
    s_mov_b64 exec, -1
L1_p2:
    s_add_u32 s47, s35, 0x8000
    s_add_u32 s47, s47, s72
    buffer_store_dwordx4 v[76:79], v0, s[20:23], s47 offen sc1
    s_add_u32 s44, s97, 0x4400000
    s_nop 0
    v_lshlrev_b32 v76, 1, v1
    buffer_load_dwordx4 v[76:79], v76, s[8:11], s44 offen nt
    ds_add_rtn_u32 v20, v20, v2
    ds_add_rtn_u32 v21, v21, v2
    ds_add_rtn_u32 v22, v22, v2
    ds_add_rtn_u32 v23, v23, v2
    s_setprio 1
    ds_add_rtn_u32 v32, v32, v2
    ds_add_rtn_u32 v33, v33, v2
    ds_add_rtn_u32 v34, v34, v2
    ds_add_rtn_u32 v35, v35, v2
    ds_add_rtn_u32 v40, v40, v2
    ds_add_rtn_u32 v41, v41, v2
    ds_add_rtn_u32 v42, v42, v2
    ds_add_rtn_u32 v43, v43, v2
    s_add_u32 s45, s35, 0x8000
    s_add_u32 s45, s45, s73
    buffer_store_dwordx4 v[80:83], v0, s[20:23], s45 offen sc1
    s_add_u32 s46, s97, 0x4400000
    s_nop 0
    v_lshlrev_b32 v80, 1, v1
    buffer_load_dwordx4 v[80:83], v80, s[12:15], s46 offen nt
    s_setprio 0
    ds_add_rtn_u32 v52, v52, v2
    ds_add_rtn_u32 v53, v53, v2
    ds_add_rtn_u32 v54, v54, v2
    ds_add_rtn_u32 v55, v55, v2
    ds_add_rtn_u32 v60, v60, v2
    ds_add_rtn_u32 v61, v61, v2
    ds_add_rtn_u32 v62, v62, v2
    ds_add_rtn_u32 v63, v63, v2
    s_waitcnt lgkmcnt(0)
    s_barrier
    s_setprio 3
    v_and_b32 v7, -4, v104
    v_lshl_add_u32 v8, v104, 2, v7
    ds_write_b32 v8, v96
    v_lshl_add_u32 v7, v7, 2, v104
    ds_write_b8 v7, v108 offset:16
    v_and_b32 v9, -4, v105
    v_lshl_add_u32 v10, v105, 2, v9
    ds_write_b32 v10, v97
    v_lshl_add_u32 v9, v9, 2, v105
    ds_write_b8_d16_hi v9, v108 offset:16
    v_and_b32 v7, -4, v106
    v_lshl_add_u32 v8, v106, 2, v7
    ds_write_b32 v8, v98
    v_lshl_add_u32 v7, v7, 2, v106
    ds_write_b8 v7, v109 offset:16
    v_and_b32 v9, -4, v107
    v_lshl_add_u32 v10, v107, 2, v9
    ds_write_b32 v10, v99
    v_lshl_add_u32 v9, v9, 2, v107
    ds_write_b8_d16_hi v9, v109 offset:16
    s_add_u32 s47, s35, 0x8000
    s_add_u32 s47, s47, s85
    buffer_store_dwordx4 v[88:91], v0, s[20:23], s47 offen sc1
    s_add_u32 s44, s98, 0x4800000
    v_lshlrev_b32 v96, 1, v1
    buffer_load_dwordx4 v[96:99], v96, s[8:11], s44 offen nt
    s_add_u32 s45, s98, 0x4800000
    v_lshlrev_b32 v104, 1, v1
    buffer_load_dwordx4 v[104:107], v104, s[12:15], s45 offen nt
    v_and_b32 v7, -4, v112
    v_lshl_add_u32 v8, v112, 2, v7
    ds_write_b32 v8, v100
    v_lshl_add_u32 v7, v7, 2, v112
    ds_write_b8 v7, v110 offset:16
    v_and_b32 v9, -4, v113
    v_lshl_add_u32 v10, v113, 2, v9
    ds_write_b32 v10, v101
    v_lshl_add_u32 v9, v9, 2, v113
    ds_write_b8_d16_hi v9, v110 offset:16
    v_and_b32 v7, -4, v114
    v_lshl_add_u32 v8, v114, 2, v7
    ds_write_b32 v8, v102
    v_lshl_add_u32 v7, v7, 2, v114
    ds_write_b8 v7, v111 offset:16
    v_and_b32 v9, -4, v115
    v_lshl_add_u32 v10, v115, 2, v9
    ds_write_b32 v10, v103
    v_lshl_add_u32 v9, v9, 2, v115
    ds_write_b8_d16_hi v9, v111 offset:16
    s_add_u32 s46, s98, 0x4800000
    s_lshr_b32 s46, s46, 1
    buffer_load_dwordx2 v[88:89], v1, s[16:19], s46 offen nt
    s_add_u32 s47, s99, 0x4c00000
    s_lshr_b32 s47, s47, 1
    buffer_load_dwordx2 v[90:91], v1, s[16:19], s47 offen nt
    s_add_u32 s44, s99, 0x4c00000
    v_lshlrev_b32 v100, 1, v1
    buffer_load_dwordx4 v[100:103], v100, s[8:11], s44 offen nt
    s_setprio 2
    v_and_b32 v7, -4, v120
    v_lshl_add_u32 v8, v120, 2, v7
    ds_write_b32 v8, v116
    v_lshl_add_u32 v7, v7, 2, v120
    ds_write_b8 v7, v124 offset:16
    v_and_b32 v9, -4, v121
    v_lshl_add_u32 v10, v121, 2, v9
    ds_write_b32 v10, v117
    v_lshl_add_u32 v9, v9, 2, v121
    ds_write_b8_d16_hi v9, v124 offset:16
    v_and_b32 v7, -4, v122
    v_lshl_add_u32 v8, v122, 2, v7
    ds_write_b32 v8, v118
    v_lshl_add_u32 v7, v7, 2, v122
    ds_write_b8 v7, v125 offset:16
    v_and_b32 v9, -4, v123
    v_lshl_add_u32 v10, v123, 2, v9
    ds_write_b32 v10, v119
    v_lshl_add_u32 v9, v9, 2, v123
    ds_write_b8_d16_hi v9, v125 offset:16
    s_add_u32 s45, s35, 0x8000
    s_add_u32 s45, s45, s91
    buffer_store_dwordx4 v[92:95], v0, s[20:23], s45 offen sc1
    s_add_u32 s46, s99, 0x4c00000
    v_lshlrev_b32 v112, 1, v1
    buffer_load_dwordx4 v[112:115], v112, s[12:15], s46 offen nt
    v_and_b32 v7, -4, v20
    v_lshl_add_u32 v8, v20, 2, v7
    ds_write_b32 v8, v16
    v_lshl_add_u32 v7, v7, 2, v20
    ds_write_b8 v7, v126 offset:16
    v_and_b32 v9, -4, v21
    v_lshl_add_u32 v10, v21, 2, v9
    ds_write_b32 v10, v17
    v_lshl_add_u32 v9, v9, 2, v21
    ds_write_b8_d16_hi v9, v126 offset:16
    v_and_b32 v7, -4, v22
    v_lshl_add_u32 v8, v22, 2, v7
    ds_write_b32 v8, v18
    v_lshl_add_u32 v7, v7, 2, v22
    ds_write_b8 v7, v127 offset:16
    v_and_b32 v9, -4, v23
    v_lshl_add_u32 v10, v23, 2, v9
    ds_write_b32 v10, v19
    v_lshl_add_u32 v9, v9, 2, v23
    ds_write_b8_d16_hi v9, v127 offset:16
    s_add_u32 s47, s96, 0x5000000
    v_lshlrev_b32 v108, 1, v1
    buffer_load_dwordx4 v[108:111], v108, s[8:11], s47 offen nt
    s_add_u32 s44, s96, 0x5000000
    v_lshlrev_b32 v116, 1, v1
    buffer_load_dwordx4 v[116:119], v116, s[12:15], s44 offen nt
    s_setprio 1
    v_and_b32 v7, -4, v32
    v_lshl_add_u32 v8, v32, 2, v7
    ds_write_b32 v8, v28
    v_lshl_add_u32 v7, v7, 2, v32
    ds_write_b8 v7, v24 offset:16
    v_and_b32 v9, -4, v33
    v_lshl_add_u32 v10, v33, 2, v9
    ds_write_b32 v10, v29
    v_lshl_add_u32 v9, v9, 2, v33
    ds_write_b8_d16_hi v9, v24 offset:16
    v_and_b32 v7, -4, v34
    v_lshl_add_u32 v8, v34, 2, v7
    ds_write_b32 v8, v30
    v_lshl_add_u32 v7, v7, 2, v34
    ds_write_b8 v7, v25 offset:16
    v_and_b32 v9, -4, v35
    v_lshl_add_u32 v10, v35, 2, v9
    ds_write_b32 v10, v31
    v_lshl_add_u32 v9, v9, 2, v35
    ds_write_b8_d16_hi v9, v25 offset:16
    s_add_u32 s45, s96, 0x5000000
    s_lshr_b32 s45, s45, 1
    buffer_load_dwordx2 v[120:121], v1, s[16:19], s45 offen nt
    s_add_u32 s46, s97, 0x5400000
    s_lshr_b32 s46, s46, 1
    buffer_load_dwordx2 v[122:123], v1, s[16:19], s46 offen nt
    s_add_u32 s47, s97, 0x5400000
    v_lshlrev_b32 v92, 1, v1
    buffer_load_dwordx4 v[92:95], v92, s[8:11], s47 offen nt
    v_and_b32 v7, -4, v40
    v_lshl_add_u32 v8, v40, 2, v7
    ds_write_b32 v8, v36
    v_lshl_add_u32 v7, v7, 2, v40
    ds_write_b8 v7, v26 offset:16
    v_and_b32 v9, -4, v41
    v_lshl_add_u32 v10, v41, 2, v9
    ds_write_b32 v10, v37
    v_lshl_add_u32 v9, v9, 2, v41
    ds_write_b8_d16_hi v9, v26 offset:16
    v_and_b32 v7, -4, v42
    v_lshl_add_u32 v8, v42, 2, v7
    ds_write_b32 v8, v38
    v_lshl_add_u32 v7, v7, 2, v42
    ds_write_b8 v7, v27 offset:16
    v_and_b32 v9, -4, v43
    v_lshl_add_u32 v10, v43, 2, v9
    ds_write_b32 v10, v39
    v_lshl_add_u32 v9, v9, 2, v43
    ds_write_b8_d16_hi v9, v27 offset:16
    s_add_u32 s44, s35, 0x8000
    s_add_u32 s44, s44, s93
    buffer_store_dwordx4 v[84:87], v0, s[20:23], s44 offen sc1
    s_add_u32 s45, s97, 0x5400000
    v_lshlrev_b32 v16, 1, v1
    buffer_load_dwordx4 v[16:19], v16, s[12:15], s45 offen nt
    s_setprio 0
    v_and_b32 v7, -4, v52
    v_lshl_add_u32 v8, v52, 2, v7
    ds_write_b32 v8, v48
    v_lshl_add_u32 v7, v7, 2, v52
    ds_write_b8 v7, v44 offset:16
    v_and_b32 v9, -4, v53
    v_lshl_add_u32 v10, v53, 2, v9
    ds_write_b32 v10, v49
    v_lshl_add_u32 v9, v9, 2, v53
    ds_write_b8_d16_hi v9, v44 offset:16
    v_and_b32 v7, -4, v54
    v_lshl_add_u32 v8, v54, 2, v7
    ds_write_b32 v8, v50
    v_lshl_add_u32 v7, v7, 2, v54
    ds_write_b8 v7, v45 offset:16
    v_and_b32 v9, -4, v55
    v_lshl_add_u32 v10, v55, 2, v9
    ds_write_b32 v10, v51
    v_lshl_add_u32 v9, v9, 2, v55
    ds_write_b8_d16_hi v9, v45 offset:16
    s_add_u32 s46, s98, 0x5800000
    v_lshlrev_b32 v20, 1, v1
    buffer_load_dwordx4 v[20:23], v20, s[8:11], s46 offen nt
    s_add_u32 s47, s98, 0x5800000
    v_lshlrev_b32 v124, 1, v1
    buffer_load_dwordx4 v[124:127], v124, s[12:15], s47 offen nt
    v_and_b32 v7, -4, v60
    v_lshl_add_u32 v8, v60, 2, v7
    ds_write_b32 v8, v56
    v_lshl_add_u32 v7, v7, 2, v60
    ds_write_b8 v7, v46 offset:16
    v_and_b32 v9, -4, v61
    v_lshl_add_u32 v10, v61, 2, v9
    ds_write_b32 v10, v57
    v_lshl_add_u32 v9, v9, 2, v61
    ds_write_b8_d16_hi v9, v46 offset:16
    v_and_b32 v7, -4, v62
    v_lshl_add_u32 v8, v62, 2, v7
    ds_write_b32 v8, v58
    v_lshl_add_u32 v7, v7, 2, v62
    ds_write_b8 v7, v47 offset:16
    v_and_b32 v9, -4, v63
    v_lshl_add_u32 v10, v63, 2, v9
    ds_write_b32 v10, v59
    v_lshl_add_u32 v9, v9, 2, v63
    ds_write_b8_d16_hi v9, v47 offset:16
    s_add_u32 s44, s98, 0x5800000
    s_lshr_b32 s44, s44, 1
    buffer_load_dwordx2 v[28:29], v1, s[16:19], s44 offen nt
    s_add_u32 s45, s99, 0x5c00000
    s_lshr_b32 s45, s45, 1
    buffer_load_dwordx2 v[30:31], v1, s[16:19], s45 offen nt
    v_add_u32 v7, s72, v0
    v_add_u32 v12, s73, v0
    v_add_u32 v13, s85, v0
    v_add_u32 v14, s91, v0
    v_add_u32 v15, s93, v0
    s_min_i32 s3, s72, s73
    s_min_i32 s3, s3, s85
    s_min_i32 s3, s3, s91
    s_min_i32 s3, s3, s93
    v_add_u32 v3, s3, v0
    v_mov_b32 v8, 0
    v_mov_b32 v9, 0
    v_mov_b32 v10, 0
    v_mov_b32 v11, 0
    s_waitcnt lgkmcnt(0)
    s_barrier
    ds_read_b128 v[32:35], v7 offset:0
    ds_read_b128 v[36:39], v12 offset:0
    ds_read_b128 v[40:43], v13 offset:0
    ds_read_b128 v[24:27], v14 offset:0
    ds_read_b128 v[84:87], v15 offset:0
    ds_write_b128 v3, v[8:11]
    ds_read_b128 v[48:51], v7 offset:16384
    ds_read_b128 v[52:55], v12 offset:16384
    ds_read_b128 v[56:59], v13 offset:16384
    ds_read_b128 v[60:63], v14 offset:16384
    ds_read_b128 v[44:47], v15 offset:16384
    s_waitcnt lgkmcnt(0)
    s_barrier
    s_setprio 3
    s_add_u32 s46, s35, 0x2a44000
    s_add_u32 s46, s46, s72
    buffer_store_dwordx4 v[32:35], v0, s[20:23], s46 offen sc1
    s_add_u32 s47, s99, 0x5c00000
    s_nop 0
    v_lshlrev_b32 v32, 1, v1
    buffer_load_dwordx4 v[32:35], v32, s[8:11], s47 offen nt
    s_add_u32 s44, s35, 0x2a44000
    s_add_u32 s44, s44, s73
    buffer_store_dwordx4 v[36:39], v0, s[20:23], s44 offen sc1
    s_add_u32 s45, s99, 0x5c00000
    s_nop 0
    v_lshlrev_b32 v36, 1, v1
    buffer_load_dwordx4 v[36:39], v36, s[12:15], s45 offen nt
    s_waitcnt vmcnt(27)
    v_lshlrev_b32 v7, 16, v64
    v_and_b32 v8, 0xffff0000, v64
    v_lshlrev_b32 v9, 16, v65
    v_and_b32 v10, 0xffff0000, v65
    v_mul_f32 v7, 0.15915494, v7
    v_mul_f32 v8, 0.15915494, v8
    v_mul_f32 v9, 0.15915494, v9
    v_mul_f32 v10, 0.15915494, v10
    v_mul_hi_u32_u24 v14, 429497, v68
    v_lshrrev_b32 v12, 3, v72
    v_cos_f32 v7, v7
    v_lshlrev_b16 v13, 3, v72
    v_mad_i32_i24 v11, v14, s55, v68
    v_bitop3_b32 v12, v6, v13, v12 bitop3:0xca
    v_lshl_add_u32 v11, v11, 17, s40
    v_lshlrev_b16 v14, 8, v14
    v_lshrrev_b32 v13, 2, v72
    v_add_u32 v68, v12, v11
    v_bitop3_b32 v72, v5, v13, v14 bitop3:0xea
    ds_add_u32 v72, v2
    v_mul_hi_u32_u24 v14, 429497, v69
    v_lshrrev_b32 v12, 3, v73
    v_cos_f32 v8, v8
    v_lshlrev_b16 v13, 3, v73
    v_mad_i32_i24 v11, v14, s55, v69
    v_bitop3_b32 v12, v6, v13, v12 bitop3:0xca
    v_lshl_add_u32 v11, v11, 17, s40
    v_lshlrev_b16 v14, 8, v14
    v_lshrrev_b32 v13, 2, v73
    v_add_u32 v69, v12, v11
    v_bitop3_b32 v73, v5, v13, v14 bitop3:0xea
    ds_add_u32 v73, v2
    v_cvt_pk_bf16_f32 v64, v7, v8
    v_perm_b32 v12, v64, v64, s41
    v_bitop3_b32 v68, v4, v12, v68 bitop3:0xca
    v_perm_b32 v13, v64, v64, s42
    v_bitop3_b32 v69, v4, v13, v69 bitop3:0xca
    v_mul_hi_u32_u24 v14, 429497, v70
    v_lshrrev_b32 v12, 3, v74
    v_cos_f32 v9, v9
    v_lshlrev_b16 v13, 3, v74
    v_mad_i32_i24 v11, v14, s55, v70
    v_bitop3_b32 v12, v6, v13, v12 bitop3:0xca
    v_lshl_add_u32 v11, v11, 17, s40
    v_lshlrev_b16 v14, 8, v14
    v_lshrrev_b32 v13, 2, v74
    v_add_u32 v70, v12, v11
    v_bitop3_b32 v74, v5, v13, v14 bitop3:0xea
    ds_add_u32 v74, v2
    v_mul_hi_u32_u24 v14, 429497, v71
    v_lshrrev_b32 v12, 3, v75
    v_cos_f32 v10, v10
    v_lshlrev_b16 v13, 3, v75
    v_mad_i32_i24 v11, v14, s55, v71
    v_bitop3_b32 v12, v6, v13, v12 bitop3:0xca
    v_lshl_add_u32 v11, v11, 17, s40
    v_lshlrev_b16 v14, 8, v14
    v_lshrrev_b32 v13, 2, v75
    v_add_u32 v71, v12, v11
    v_bitop3_b32 v75, v5, v13, v14 bitop3:0xea
    ds_add_u32 v75, v2
    v_cvt_pk_bf16_f32 v65, v9, v10
    v_perm_b32 v12, v65, v65, s41
    v_bitop3_b32 v70, v4, v12, v70 bitop3:0xca
    v_perm_b32 v13, v65, v65, s42
    v_bitop3_b32 v71, v4, v13, v71 bitop3:0xca
    s_waitcnt vmcnt(23)
    v_lshlrev_b32 v7, 16, v66
    v_and_b32 v8, 0xffff0000, v66
    v_lshlrev_b32 v9, 16, v67
    v_and_b32 v10, 0xffff0000, v67
    v_mul_f32 v7, 0.15915494, v7
    v_mul_f32 v8, 0.15915494, v8
    v_mul_f32 v9, 0.15915494, v9
    v_mul_f32 v10, 0.15915494, v10
    v_mul_hi_u32_u24 v14, 429497, v76
    v_lshrrev_b32 v12, 3, v80
    v_cos_f32 v7, v7
    v_lshlrev_b16 v13, 3, v80
    v_mad_i32_i24 v11, v14, s55, v76
    v_bitop3_b32 v12, v6, v13, v12 bitop3:0xca
    v_lshl_add_u32 v11, v11, 17, s40
    v_lshlrev_b16 v14, 8, v14
    v_lshrrev_b32 v13, 2, v80
    v_add_u32 v76, v12, v11
    v_bitop3_b32 v80, v5, v13, v14 bitop3:0xea
    ds_add_u32 v80, v2
    v_mul_hi_u32_u24 v14, 429497, v77
    v_lshrrev_b32 v12, 3, v81
    v_cos_f32 v8, v8
    v_lshlrev_b16 v13, 3, v81
    v_mad_i32_i24 v11, v14, s55, v77
    v_bitop3_b32 v12, v6, v13, v12 bitop3:0xca
    v_lshl_add_u32 v11, v11, 17, s40
    v_lshlrev_b16 v14, 8, v14
    v_lshrrev_b32 v13, 2, v81
    v_add_u32 v77, v12, v11
    v_bitop3_b32 v81, v5, v13, v14 bitop3:0xea
    ds_add_u32 v81, v2
    v_cvt_pk_bf16_f32 v66, v7, v8
    v_perm_b32 v12, v66, v66, s41
    v_bitop3_b32 v76, v4, v12, v76 bitop3:0xca
    v_perm_b32 v13, v66, v66, s42
    v_bitop3_b32 v77, v4, v13, v77 bitop3:0xca
    v_mul_hi_u32_u24 v14, 429497, v78
    v_lshrrev_b32 v12, 3, v82
    v_cos_f32 v9, v9
    v_lshlrev_b16 v13, 3, v82
    v_mad_i32_i24 v11, v14, s55, v78
    v_bitop3_b32 v12, v6, v13, v12 bitop3:0xca
    v_lshl_add_u32 v11, v11, 17, s40
    v_lshlrev_b16 v14, 8, v14
    v_lshrrev_b32 v13, 2, v82
    v_add_u32 v78, v12, v11
    v_bitop3_b32 v82, v5, v13, v14 bitop3:0xea
    ds_add_u32 v82, v2
    v_mul_hi_u32_u24 v14, 429497, v79
    v_lshrrev_b32 v12, 3, v83
    v_cos_f32 v10, v10
    v_lshlrev_b16 v13, 3, v83
    v_mad_i32_i24 v11, v14, s55, v79
    v_bitop3_b32 v12, v6, v13, v12 bitop3:0xca
    v_lshl_add_u32 v11, v11, 17, s40
    v_lshlrev_b16 v14, 8, v14
    v_lshrrev_b32 v13, 2, v83
    v_add_u32 v79, v12, v11
    v_bitop3_b32 v83, v5, v13, v14 bitop3:0xea
    ds_add_u32 v83, v2
    v_cvt_pk_bf16_f32 v67, v9, v10
    v_perm_b32 v12, v67, v67, s41
    v_bitop3_b32 v78, v4, v12, v78 bitop3:0xca
    v_perm_b32 v13, v67, v67, s42
    v_bitop3_b32 v79, v4, v13, v79 bitop3:0xca
    s_setprio 2
    s_waitcnt vmcnt(18)
    v_lshlrev_b32 v7, 16, v88
    v_and_b32 v8, 0xffff0000, v88
    v_lshlrev_b32 v9, 16, v89
    v_and_b32 v10, 0xffff0000, v89
    v_mul_f32 v7, 0.15915494, v7
    v_mul_f32 v8, 0.15915494, v8
    v_mul_f32 v9, 0.15915494, v9
    v_mul_f32 v10, 0.15915494, v10
    v_mul_hi_u32_u24 v14, 429497, v96
    v_lshrrev_b32 v12, 3, v104
    v_cos_f32 v7, v7
    v_lshlrev_b16 v13, 3, v104
    v_mad_i32_i24 v11, v14, s55, v96
    v_bitop3_b32 v12, v6, v13, v12 bitop3:0xca
    v_lshl_add_u32 v11, v11, 17, s40
    v_lshlrev_b16 v14, 8, v14
    v_lshrrev_b32 v13, 2, v104
    v_add_u32 v96, v12, v11
    v_bitop3_b32 v104, v5, v13, v14 bitop3:0xea
    ds_add_u32 v104, v2
    v_mul_hi_u32_u24 v14, 429497, v97
    v_lshrrev_b32 v12, 3, v105
    v_cos_f32 v8, v8
    v_lshlrev_b16 v13, 3, v105
    v_mad_i32_i24 v11, v14, s55, v97
    v_bitop3_b32 v12, v6, v13, v12 bitop3:0xca
    v_lshl_add_u32 v11, v11, 17, s40
    v_lshlrev_b16 v14, 8, v14
    v_lshrrev_b32 v13, 2, v105
    v_add_u32 v97, v12, v11
    v_bitop3_b32 v105, v5, v13, v14 bitop3:0xea
    ds_add_u32 v105, v2
    v_cvt_pk_bf16_f32 v88, v7, v8
    v_perm_b32 v12, v88, v88, s41
    v_bitop3_b32 v96, v4, v12, v96 bitop3:0xca
    v_perm_b32 v13, v88, v88, s42
    v_bitop3_b32 v97, v4, v13, v97 bitop3:0xca
    v_mul_hi_u32_u24 v14, 429497, v98
    v_lshrrev_b32 v12, 3, v106
    v_cos_f32 v9, v9
    v_lshlrev_b16 v13, 3, v106
    v_mad_i32_i24 v11, v14, s55, v98
    v_bitop3_b32 v12, v6, v13, v12 bitop3:0xca
    v_lshl_add_u32 v11, v11, 17, s40
    v_lshlrev_b16 v14, 8, v14
    v_lshrrev_b32 v13, 2, v106
    v_add_u32 v98, v12, v11
    v_bitop3_b32 v106, v5, v13, v14 bitop3:0xea
    ds_add_u32 v106, v2
    v_mul_hi_u32_u24 v14, 429497, v99
    v_lshrrev_b32 v12, 3, v107
    v_cos_f32 v10, v10
    v_lshlrev_b16 v13, 3, v107
    v_mad_i32_i24 v11, v14, s55, v99
    v_bitop3_b32 v12, v6, v13, v12 bitop3:0xca
    v_lshl_add_u32 v11, v11, 17, s40
    v_lshlrev_b16 v14, 8, v14
    v_lshrrev_b32 v13, 2, v107
    v_add_u32 v99, v12, v11
    v_bitop3_b32 v107, v5, v13, v14 bitop3:0xea
    ds_add_u32 v107, v2
    v_cvt_pk_bf16_f32 v89, v9, v10
    v_perm_b32 v12, v89, v89, s41
    v_bitop3_b32 v98, v4, v12, v98 bitop3:0xca
    v_perm_b32 v13, v89, v89, s42
    v_bitop3_b32 v99, v4, v13, v99 bitop3:0xca
    s_add_u32 s46, s35, 0x2a44000
    s_add_u32 s46, s46, s85
    buffer_store_dwordx4 v[40:43], v0, s[20:23], s46 offen sc1
    s_add_u32 s47, s96, 0x6000000
    s_nop 0
    v_lshlrev_b32 v40, 1, v1
    buffer_load_dwordx4 v[40:43], v40, s[8:11], s47 offen nt
    s_waitcnt vmcnt(17)
    v_lshlrev_b32 v7, 16, v90
    v_and_b32 v8, 0xffff0000, v90
    v_lshlrev_b32 v9, 16, v91
    v_and_b32 v10, 0xffff0000, v91
    v_mul_f32 v7, 0.15915494, v7
    v_mul_f32 v8, 0.15915494, v8
    v_mul_f32 v9, 0.15915494, v9
    v_mul_f32 v10, 0.15915494, v10
    v_mul_hi_u32_u24 v14, 429497, v100
    v_lshrrev_b32 v12, 3, v112
    v_cos_f32 v7, v7
    v_lshlrev_b16 v13, 3, v112
    v_mad_i32_i24 v11, v14, s55, v100
    v_bitop3_b32 v12, v6, v13, v12 bitop3:0xca
    v_lshl_add_u32 v11, v11, 17, s40
    v_lshlrev_b16 v14, 8, v14
    v_lshrrev_b32 v13, 2, v112
    v_add_u32 v100, v12, v11
    v_bitop3_b32 v112, v5, v13, v14 bitop3:0xea
    ds_add_u32 v112, v2
    v_mul_hi_u32_u24 v14, 429497, v101
    v_lshrrev_b32 v12, 3, v113
    v_cos_f32 v8, v8
    v_lshlrev_b16 v13, 3, v113
    v_mad_i32_i24 v11, v14, s55, v101
    v_bitop3_b32 v12, v6, v13, v12 bitop3:0xca
    v_lshl_add_u32 v11, v11, 17, s40
    v_lshlrev_b16 v14, 8, v14
    v_lshrrev_b32 v13, 2, v113
    v_add_u32 v101, v12, v11
    v_bitop3_b32 v113, v5, v13, v14 bitop3:0xea
    ds_add_u32 v113, v2
    v_cvt_pk_bf16_f32 v90, v7, v8
    v_perm_b32 v12, v90, v90, s41
    v_bitop3_b32 v100, v4, v12, v100 bitop3:0xca
    v_perm_b32 v13, v90, v90, s42
    v_bitop3_b32 v101, v4, v13, v101 bitop3:0xca
    v_mul_hi_u32_u24 v14, 429497, v102
    v_lshrrev_b32 v12, 3, v114
    v_cos_f32 v9, v9
    v_lshlrev_b16 v13, 3, v114
    v_mad_i32_i24 v11, v14, s55, v102
    v_bitop3_b32 v12, v6, v13, v12 bitop3:0xca
    v_lshl_add_u32 v11, v11, 17, s40
    v_lshlrev_b16 v14, 8, v14
    v_lshrrev_b32 v13, 2, v114
    v_add_u32 v102, v12, v11
    v_bitop3_b32 v114, v5, v13, v14 bitop3:0xea
    ds_add_u32 v114, v2
    v_mul_hi_u32_u24 v14, 429497, v103
    v_lshrrev_b32 v12, 3, v115
    v_cos_f32 v10, v10
    v_lshlrev_b16 v13, 3, v115
    v_mad_i32_i24 v11, v14, s55, v103
    v_bitop3_b32 v12, v6, v13, v12 bitop3:0xca
    v_lshl_add_u32 v11, v11, 17, s40
    v_lshlrev_b16 v14, 8, v14
    v_lshrrev_b32 v13, 2, v115
    v_add_u32 v103, v12, v11
    v_bitop3_b32 v115, v5, v13, v14 bitop3:0xea
    ds_add_u32 v115, v2
    v_cvt_pk_bf16_f32 v91, v9, v10
    v_perm_b32 v12, v91, v91, s41
    v_bitop3_b32 v102, v4, v12, v102 bitop3:0xca
    v_perm_b32 v13, v91, v91, s42
    v_bitop3_b32 v103, v4, v13, v103 bitop3:0xca
    s_setprio 1
    s_waitcnt vmcnt(13)
    v_lshlrev_b32 v7, 16, v120
    v_and_b32 v8, 0xffff0000, v120
    v_lshlrev_b32 v9, 16, v121
    v_and_b32 v10, 0xffff0000, v121
    v_mul_f32 v7, 0.15915494, v7
    v_mul_f32 v8, 0.15915494, v8
    v_mul_f32 v9, 0.15915494, v9
    v_mul_f32 v10, 0.15915494, v10
    v_mul_hi_u32_u24 v14, 429497, v108
    v_lshrrev_b32 v12, 3, v116
    v_cos_f32 v7, v7
    v_lshlrev_b16 v13, 3, v116
    v_mad_i32_i24 v11, v14, s55, v108
    v_bitop3_b32 v12, v6, v13, v12 bitop3:0xca
    v_lshl_add_u32 v11, v11, 17, s40
    v_lshlrev_b16 v14, 8, v14
    v_lshrrev_b32 v13, 2, v116
    v_add_u32 v108, v12, v11
    v_bitop3_b32 v116, v5, v13, v14 bitop3:0xea
    ds_add_u32 v116, v2
    v_mul_hi_u32_u24 v14, 429497, v109
    v_lshrrev_b32 v12, 3, v117
    v_cos_f32 v8, v8
    v_lshlrev_b16 v13, 3, v117
    v_mad_i32_i24 v11, v14, s55, v109
    v_bitop3_b32 v12, v6, v13, v12 bitop3:0xca
    v_lshl_add_u32 v11, v11, 17, s40
    v_lshlrev_b16 v14, 8, v14
    v_lshrrev_b32 v13, 2, v117
    v_add_u32 v109, v12, v11
    v_bitop3_b32 v117, v5, v13, v14 bitop3:0xea
    ds_add_u32 v117, v2
    v_cvt_pk_bf16_f32 v120, v7, v8
    v_perm_b32 v12, v120, v120, s41
    v_bitop3_b32 v108, v4, v12, v108 bitop3:0xca
    v_perm_b32 v13, v120, v120, s42
    v_bitop3_b32 v109, v4, v13, v109 bitop3:0xca
    v_mul_hi_u32_u24 v14, 429497, v110
    v_lshrrev_b32 v12, 3, v118
    v_cos_f32 v9, v9
    v_lshlrev_b16 v13, 3, v118
    v_mad_i32_i24 v11, v14, s55, v110
    v_bitop3_b32 v12, v6, v13, v12 bitop3:0xca
    v_lshl_add_u32 v11, v11, 17, s40
    v_lshlrev_b16 v14, 8, v14
    v_lshrrev_b32 v13, 2, v118
    v_add_u32 v110, v12, v11
    v_bitop3_b32 v118, v5, v13, v14 bitop3:0xea
    ds_add_u32 v118, v2
    v_mul_hi_u32_u24 v14, 429497, v111
    v_lshrrev_b32 v12, 3, v119
    v_cos_f32 v10, v10
    v_lshlrev_b16 v13, 3, v119
    v_mad_i32_i24 v11, v14, s55, v111
    v_bitop3_b32 v12, v6, v13, v12 bitop3:0xca
    v_lshl_add_u32 v11, v11, 17, s40
    v_lshlrev_b16 v14, 8, v14
    v_lshrrev_b32 v13, 2, v119
    v_add_u32 v111, v12, v11
    v_bitop3_b32 v119, v5, v13, v14 bitop3:0xea
    ds_add_u32 v119, v2
    v_cvt_pk_bf16_f32 v121, v9, v10
    v_perm_b32 v12, v121, v121, s41
    v_bitop3_b32 v110, v4, v12, v110 bitop3:0xca
    v_perm_b32 v13, v121, v121, s42
    v_bitop3_b32 v111, v4, v13, v111 bitop3:0xca
    s_waitcnt vmcnt(10)
    v_lshlrev_b32 v7, 16, v122
    v_and_b32 v8, 0xffff0000, v122
    v_lshlrev_b32 v9, 16, v123
    v_and_b32 v10, 0xffff0000, v123
    v_mul_f32 v7, 0.15915494, v7
    v_mul_f32 v8, 0.15915494, v8
    v_mul_f32 v9, 0.15915494, v9
    v_mul_f32 v10, 0.15915494, v10
    v_mul_hi_u32_u24 v14, 429497, v92
    v_lshrrev_b32 v12, 3, v16
    v_cos_f32 v7, v7
    v_lshlrev_b16 v13, 3, v16
    v_mad_i32_i24 v11, v14, s55, v92
    v_bitop3_b32 v12, v6, v13, v12 bitop3:0xca
    v_lshl_add_u32 v11, v11, 17, s40
    v_lshlrev_b16 v14, 8, v14
    v_lshrrev_b32 v13, 2, v16
    v_add_u32 v92, v12, v11
    v_bitop3_b32 v16, v5, v13, v14 bitop3:0xea
    ds_add_u32 v16, v2
    v_mul_hi_u32_u24 v14, 429497, v93
    v_lshrrev_b32 v12, 3, v17
    v_cos_f32 v8, v8
    v_lshlrev_b16 v13, 3, v17
    v_mad_i32_i24 v11, v14, s55, v93
    v_bitop3_b32 v12, v6, v13, v12 bitop3:0xca
    v_lshl_add_u32 v11, v11, 17, s40
    v_lshlrev_b16 v14, 8, v14
    v_lshrrev_b32 v13, 2, v17
    v_add_u32 v93, v12, v11
    v_bitop3_b32 v17, v5, v13, v14 bitop3:0xea
    ds_add_u32 v17, v2
    v_cvt_pk_bf16_f32 v122, v7, v8
    v_perm_b32 v12, v122, v122, s41
    v_bitop3_b32 v92, v4, v12, v92 bitop3:0xca
    v_perm_b32 v13, v122, v122, s42
    v_bitop3_b32 v93, v4, v13, v93 bitop3:0xca
    v_mul_hi_u32_u24 v14, 429497, v94
    v_lshrrev_b32 v12, 3, v18
    v_cos_f32 v9, v9
    v_lshlrev_b16 v13, 3, v18
    v_mad_i32_i24 v11, v14, s55, v94
    v_bitop3_b32 v12, v6, v13, v12 bitop3:0xca
    v_lshl_add_u32 v11, v11, 17, s40
    v_lshlrev_b16 v14, 8, v14
    v_lshrrev_b32 v13, 2, v18
    v_add_u32 v94, v12, v11
    v_bitop3_b32 v18, v5, v13, v14 bitop3:0xea
    ds_add_u32 v18, v2
    v_mul_hi_u32_u24 v14, 429497, v95
    v_lshrrev_b32 v12, 3, v19
    v_cos_f32 v10, v10
    v_lshlrev_b16 v13, 3, v19
    v_mad_i32_i24 v11, v14, s55, v95
    v_bitop3_b32 v12, v6, v13, v12 bitop3:0xca
    v_lshl_add_u32 v11, v11, 17, s40
    v_lshlrev_b16 v14, 8, v14
    v_lshrrev_b32 v13, 2, v19
    v_add_u32 v95, v12, v11
    v_bitop3_b32 v19, v5, v13, v14 bitop3:0xea
    ds_add_u32 v19, v2
    v_cvt_pk_bf16_f32 v123, v9, v10
    v_perm_b32 v12, v123, v123, s41
    v_bitop3_b32 v94, v4, v12, v94 bitop3:0xca
    v_perm_b32 v13, v123, v123, s42
    v_bitop3_b32 v95, v4, v13, v95 bitop3:0xca
    s_setprio 0
    s_add_u32 s44, s35, 0x2a44000
    s_add_u32 s44, s44, s91
    buffer_store_dwordx4 v[24:27], v0, s[20:23], s44 offen sc1
    s_add_u32 s45, s96, 0x6000000
    s_nop 0
    v_lshlrev_b32 v24, 1, v1
    buffer_load_dwordx4 v[24:27], v24, s[12:15], s45 offen nt
    s_waitcnt vmcnt(8)
    v_lshlrev_b32 v7, 16, v28
    v_and_b32 v8, 0xffff0000, v28
    v_lshlrev_b32 v9, 16, v29
    v_and_b32 v10, 0xffff0000, v29
    v_mul_f32 v7, 0.15915494, v7
    v_mul_f32 v8, 0.15915494, v8
    v_mul_f32 v9, 0.15915494, v9
    v_mul_f32 v10, 0.15915494, v10
    v_mul_hi_u32_u24 v14, 429497, v20
    v_lshrrev_b32 v12, 3, v124
    v_cos_f32 v7, v7
    v_lshlrev_b16 v13, 3, v124
    v_mad_i32_i24 v11, v14, s55, v20
    v_bitop3_b32 v12, v6, v13, v12 bitop3:0xca
    v_lshl_add_u32 v11, v11, 17, s40
    v_lshlrev_b16 v14, 8, v14
    v_lshrrev_b32 v13, 2, v124
    v_add_u32 v20, v12, v11
    v_bitop3_b32 v124, v5, v13, v14 bitop3:0xea
    ds_add_u32 v124, v2
    v_mul_hi_u32_u24 v14, 429497, v21
    v_lshrrev_b32 v12, 3, v125
    v_cos_f32 v8, v8
    v_lshlrev_b16 v13, 3, v125
    v_mad_i32_i24 v11, v14, s55, v21
    v_bitop3_b32 v12, v6, v13, v12 bitop3:0xca
    v_lshl_add_u32 v11, v11, 17, s40
    v_lshlrev_b16 v14, 8, v14
    v_lshrrev_b32 v13, 2, v125
    v_add_u32 v21, v12, v11
    v_bitop3_b32 v125, v5, v13, v14 bitop3:0xea
    ds_add_u32 v125, v2
    v_cvt_pk_bf16_f32 v28, v7, v8
    v_perm_b32 v12, v28, v28, s41
    v_bitop3_b32 v20, v4, v12, v20 bitop3:0xca
    v_perm_b32 v13, v28, v28, s42
    v_bitop3_b32 v21, v4, v13, v21 bitop3:0xca
    v_mul_hi_u32_u24 v14, 429497, v22
    v_lshrrev_b32 v12, 3, v126
    v_cos_f32 v9, v9
    v_lshlrev_b16 v13, 3, v126
    v_mad_i32_i24 v11, v14, s55, v22
    v_bitop3_b32 v12, v6, v13, v12 bitop3:0xca
    v_lshl_add_u32 v11, v11, 17, s40
    v_lshlrev_b16 v14, 8, v14
    v_lshrrev_b32 v13, 2, v126
    v_add_u32 v22, v12, v11
    v_bitop3_b32 v126, v5, v13, v14 bitop3:0xea
    ds_add_u32 v126, v2
    v_mul_hi_u32_u24 v14, 429497, v23
    v_lshrrev_b32 v12, 3, v127
    v_cos_f32 v10, v10
    v_lshlrev_b16 v13, 3, v127
    v_mad_i32_i24 v11, v14, s55, v23
    v_bitop3_b32 v12, v6, v13, v12 bitop3:0xca
    v_lshl_add_u32 v11, v11, 17, s40
    v_lshlrev_b16 v14, 8, v14
    v_lshrrev_b32 v13, 2, v127
    v_add_u32 v23, v12, v11
    v_bitop3_b32 v127, v5, v13, v14 bitop3:0xea
    ds_add_u32 v127, v2
    v_cvt_pk_bf16_f32 v29, v9, v10
    v_perm_b32 v12, v29, v29, s41
    v_bitop3_b32 v22, v4, v12, v22 bitop3:0xca
    v_perm_b32 v13, v29, v29, s42
    v_bitop3_b32 v23, v4, v13, v23 bitop3:0xca
    s_waitcnt vmcnt(4)
    v_lshlrev_b32 v7, 16, v30
    v_and_b32 v8, 0xffff0000, v30
    v_lshlrev_b32 v9, 16, v31
    v_and_b32 v10, 0xffff0000, v31
    v_mul_f32 v7, 0.15915494, v7
    v_mul_f32 v8, 0.15915494, v8
    v_mul_f32 v9, 0.15915494, v9
    v_mul_f32 v10, 0.15915494, v10
    v_mul_hi_u32_u24 v14, 429497, v32
    v_lshrrev_b32 v12, 3, v36
    v_cos_f32 v7, v7
    v_lshlrev_b16 v13, 3, v36
    v_mad_i32_i24 v11, v14, s55, v32
    v_bitop3_b32 v12, v6, v13, v12 bitop3:0xca
    v_lshl_add_u32 v11, v11, 17, s40
    v_lshlrev_b16 v14, 8, v14
    v_lshrrev_b32 v13, 2, v36
    v_add_u32 v32, v12, v11
    v_bitop3_b32 v36, v5, v13, v14 bitop3:0xea
    ds_add_u32 v36, v2
    v_mul_hi_u32_u24 v14, 429497, v33
    v_lshrrev_b32 v12, 3, v37
    v_cos_f32 v8, v8
    v_lshlrev_b16 v13, 3, v37
    v_mad_i32_i24 v11, v14, s55, v33
    v_bitop3_b32 v12, v6, v13, v12 bitop3:0xca
    v_lshl_add_u32 v11, v11, 17, s40
    v_lshlrev_b16 v14, 8, v14
    v_lshrrev_b32 v13, 2, v37
    v_add_u32 v33, v12, v11
    v_bitop3_b32 v37, v5, v13, v14 bitop3:0xea
    ds_add_u32 v37, v2
    v_cvt_pk_bf16_f32 v30, v7, v8
    v_perm_b32 v12, v30, v30, s41
    v_bitop3_b32 v32, v4, v12, v32 bitop3:0xca
    v_perm_b32 v13, v30, v30, s42
    v_bitop3_b32 v33, v4, v13, v33 bitop3:0xca
    v_mul_hi_u32_u24 v14, 429497, v34
    v_lshrrev_b32 v12, 3, v38
    v_cos_f32 v9, v9
    v_lshlrev_b16 v13, 3, v38
    v_mad_i32_i24 v11, v14, s55, v34
    v_bitop3_b32 v12, v6, v13, v12 bitop3:0xca
    v_lshl_add_u32 v11, v11, 17, s40
    v_lshlrev_b16 v14, 8, v14
    v_lshrrev_b32 v13, 2, v38
    v_add_u32 v34, v12, v11
    v_bitop3_b32 v38, v5, v13, v14 bitop3:0xea
    ds_add_u32 v38, v2
    v_mul_hi_u32_u24 v14, 429497, v35
    v_lshrrev_b32 v12, 3, v39
    v_cos_f32 v10, v10
    v_lshlrev_b16 v13, 3, v39
    v_mad_i32_i24 v11, v14, s55, v35
    v_bitop3_b32 v12, v6, v13, v12 bitop3:0xca
    v_lshl_add_u32 v11, v11, 17, s40
    v_lshlrev_b16 v14, 8, v14
    v_lshrrev_b32 v13, 2, v39
    v_add_u32 v35, v12, v11
    v_bitop3_b32 v39, v5, v13, v14 bitop3:0xea
    ds_add_u32 v39, v2
    v_cvt_pk_bf16_f32 v31, v9, v10
    v_perm_b32 v12, v31, v31, s41
    v_bitop3_b32 v34, v4, v12, v34 bitop3:0xca
    v_perm_b32 v13, v31, v31, s42
    v_bitop3_b32 v35, v4, v13, v35 bitop3:0xca
    v_lshrrev_b32 v8, 2, v0
    v_and_b32 v7, 0x3c00, v0
    v_bitop3_b32 v7, v5, v8, v7 bitop3:0xea
    s_waitcnt lgkmcnt(0)
    s_barrier
    ds_read2st64_b32 v[8:9], v7 offset0:0 offset1:1
    ds_read2st64_b32 v[10:11], v7 offset0:2 offset1:3
    s_add_u32 s46, s35, 0x2a44000
    s_add_u32 s46, s46, s93
    buffer_store_dwordx4 v[84:87], v0, s[20:23], s46 offen sc1
    s_add_u32 s47, s96, 0x6000000
    s_lshr_b32 s47, s47, 1
    buffer_load_dwordx2 v[84:85], v1, s[16:19], s47 offen nt
    s_add_u32 s44, s97, 0x6400000
    s_lshr_b32 s44, s44, 1
    buffer_load_dwordx2 v[86:87], v1, s[16:19], s44 offen nt
    s_waitcnt lgkmcnt(0)
    v_lshl_or_b32 v12, v9, 16, v8
    v_lshl_or_b32 v13, v11, 16, v10
    v_mov_b32 v14, v12
    v_mov_b32 v15, v13
    s_nop 0
    v_add_u32_dpp v14, v14, v14 row_shr:1 row_mask:0xf bank_mask:0xf bound_ctrl:1
    v_add_u32_dpp v15, v15, v15 row_shr:1 row_mask:0xf bank_mask:0xf bound_ctrl:1
    s_nop 0
    v_add_u32_dpp v14, v14, v14 row_shr:2 row_mask:0xf bank_mask:0xf bound_ctrl:1
    v_add_u32_dpp v15, v15, v15 row_shr:2 row_mask:0xf bank_mask:0xf bound_ctrl:1
    s_nop 0
    v_add_u32_dpp v14, v14, v14 row_shr:4 row_mask:0xf bank_mask:0xf bound_ctrl:1
    v_add_u32_dpp v15, v15, v15 row_shr:4 row_mask:0xf bank_mask:0xf bound_ctrl:1
    s_nop 0
    v_add_u32_dpp v14, v14, v14 row_shr:8 row_mask:0xf bank_mask:0xf bound_ctrl:1
    v_add_u32_dpp v15, v15, v15 row_shr:8 row_mask:0xf bank_mask:0xf bound_ctrl:1
    s_nop 0
    v_add_u32_dpp v14, v14, v14 row_bcast:15 row_mask:0xa bank_mask:0xf
    v_add_u32_dpp v15, v15, v15 row_bcast:15 row_mask:0xa bank_mask:0xf
    s_nop 0
    v_add_u32_dpp v14, v14, v14 row_bcast:31 row_mask:0xc bank_mask:0xf
    v_add_u32_dpp v15, v15, v15 row_bcast:31 row_mask:0xc bank_mask:0xf
    v_readlane_b32 s48, v14, 63
    v_readlane_b32 s49, v15, 63
    s_lshl_b32 s54, s32, 2
    v_mov_b32 v8, s54
    s_and_b32 s50, s48, 0xffff
    s_lshr_b32 s51, s48, 16
    s_and_b32 s52, s49, 0xffff
    s_lshr_b32 s53, s49, 16
    s_add_u32 s51, s51, s50
    s_add_u32 s52, s52, s51
    s_add_u32 s53, s53, s52
    v_mov_b32 v9, s53
    s_mov_b64 exec, 1
    ds_write_b32 v8, v9 offset:16384
    s_mov_b64 exec, -1
    v_and_b32 v8, 60, v7
    s_waitcnt lgkmcnt(0)
    s_barrier
    ds_read_b32 v9, v8 offset:16384
    s_waitcnt lgkmcnt(0)
    v_add_u32_dpp v9, v9, v9 row_shr:1 row_mask:0xf bank_mask:0xf bound_ctrl:1
    s_nop 1
    v_add_u32_dpp v9, v9, v9 row_shr:2 row_mask:0xf bank_mask:0xf bound_ctrl:1
    s_nop 1
    v_add_u32_dpp v9, v9, v9 row_shr:4 row_mask:0xf bank_mask:0xf bound_ctrl:1
    s_nop 1
    v_add_u32_dpp v9, v9, v9 row_shr:8 row_mask:0xf bank_mask:0xf bound_ctrl:1
    s_nop 0
    v_readlane_b32 s54, v9, s32
    s_sub_u32 s54, s54, s53
    s_add_u32 s50, s50, s54
    s_add_u32 s51, s51, s54
    s_add_u32 s52, s52, s54
    s_pack_ll_b32_b16 s48, s54, s50
    s_pack_ll_b32_b16 s49, s51, s52
    v_add_u32 v14, s48, v14
    v_add_u32 v15, s49, v15
    v_sub_u32 v12, v14, v12
    v_sub_u32 v13, v15, v13
    v_and_b32 v8, 0xffff, v12
    v_lshrrev_b32 v9, 16, v12
    v_and_b32 v10, 0xffff, v13
    v_lshrrev_b32 v11, 16, v13
    ds_write2st64_b32 v7, v8, v9 offset0:0 offset1:1
    ds_write2st64_b32 v7, v10, v11 offset0:2 offset1:3
    v_and_b32 v8, 0x3f0, v0
    v_lshl_add_u32 v8, v8, 1, s36
    ds_write_b64 v8, v[12:13] offset:20480
    s_bitset0_b64 exec, 63
    s_not_b64 exec, exec
    ds_write_b64 v8, v[14:15] offset:20512
    s_mov_b64 exec, -1
    s_waitcnt lgkmcnt(0)
    s_barrier
    s_setprio 3
    ds_add_rtn_u32 v72, v72, v2
    ds_add_rtn_u32 v73, v73, v2
    ds_add_rtn_u32 v74, v74, v2
    ds_add_rtn_u32 v75, v75, v2
    ds_read_b128 v[12:15], v0 offset:20480
    v_cmp_gt_u32 vcc, 8448, v0
    ds_add_rtn_u32 v80, v80, v2
    ds_add_rtn_u32 v81, v81, v2
    ds_add_rtn_u32 v82, v82, v2
    ds_add_rtn_u32 v83, v83, v2
    s_setprio 2
    ds_add_rtn_u32 v104, v104, v2
    ds_add_rtn_u32 v105, v105, v2
    ds_add_rtn_u32 v106, v106, v2
    ds_add_rtn_u32 v107, v107, v2
    s_waitcnt lgkmcnt(8)
    s_cbranch_vccz L1_p3
    s_add_u32 s45, s35, 0x5480000
    s_mov_b64 exec, vcc
    buffer_store_dwordx4 v[12:15], v0, s[24:27], s45 offen sc1
    s_mov_b64 exec, -1
L1_p3:
    s_add_u32 s46, s35, 0x2a48000
    s_add_u32 s46, s46, s72
    buffer_store_dwordx4 v[48:51], v0, s[20:23], s46 offen sc1
    s_add_u32 s47, s97, 0x6400000
    s_nop 0
    v_lshlrev_b32 v48, 1, v1
    buffer_load_dwordx4 v[48:51], v48, s[8:11], s47 offen nt
    ds_add_rtn_u32 v112, v112, v2
    ds_add_rtn_u32 v113, v113, v2
    ds_add_rtn_u32 v114, v114, v2
    ds_add_rtn_u32 v115, v115, v2
    s_setprio 1
    ds_add_rtn_u32 v116, v116, v2
    ds_add_rtn_u32 v117, v117, v2
    ds_add_rtn_u32 v118, v118, v2
    ds_add_rtn_u32 v119, v119, v2
    ds_add_rtn_u32 v16, v16, v2
    ds_add_rtn_u32 v17, v17, v2
    ds_add_rtn_u32 v18, v18, v2
    ds_add_rtn_u32 v19, v19, v2
    s_add_u32 s44, s35, 0x2a48000
    s_add_u32 s44, s44, s73
    buffer_store_dwordx4 v[52:55], v0, s[20:23], s44 offen sc1
    s_add_u32 s45, s97, 0x6400000
    s_nop 0
    v_lshlrev_b32 v52, 1, v1
    buffer_load_dwordx4 v[52:55], v52, s[12:15], s45 offen nt
    s_setprio 0
    ds_add_rtn_u32 v124, v124, v2
    ds_add_rtn_u32 v125, v125, v2
    ds_add_rtn_u32 v126, v126, v2
    ds_add_rtn_u32 v127, v127, v2
    ds_add_rtn_u32 v36, v36, v2
    ds_add_rtn_u32 v37, v37, v2
    ds_add_rtn_u32 v38, v38, v2
    ds_add_rtn_u32 v39, v39, v2
    s_waitcnt lgkmcnt(0)
    s_barrier
    s_setprio 3
    v_and_b32 v7, -4, v72
    v_lshl_add_u32 v8, v72, 2, v7
    ds_write_b32 v8, v68
    v_lshl_add_u32 v7, v7, 2, v72
    ds_write_b8 v7, v64 offset:16
    v_and_b32 v9, -4, v73
    v_lshl_add_u32 v10, v73, 2, v9
    ds_write_b32 v10, v69
    v_lshl_add_u32 v9, v9, 2, v73
    ds_write_b8_d16_hi v9, v64 offset:16
    v_and_b32 v7, -4, v74
    v_lshl_add_u32 v8, v74, 2, v7
    ds_write_b32 v8, v70
    v_lshl_add_u32 v7, v7, 2, v74
    ds_write_b8 v7, v65 offset:16
    v_and_b32 v9, -4, v75
    v_lshl_add_u32 v10, v75, 2, v9
    ds_write_b32 v10, v71
    v_lshl_add_u32 v9, v9, 2, v75
    ds_write_b8_d16_hi v9, v65 offset:16
    s_add_u32 s46, s35, 0x2a48000
    s_add_u32 s46, s46, s85
    buffer_store_dwordx4 v[56:59], v0, s[20:23], s46 offen sc1
    s_add_u32 s47, s98, 0x6800000
    v_lshlrev_b32 v68, 1, v1
    buffer_load_dwordx4 v[68:71], v68, s[8:11], s47 offen nt
    s_add_u32 s44, s98, 0x6800000
    v_lshlrev_b32 v72, 1, v1
    buffer_load_dwordx4 v[72:75], v72, s[12:15], s44 offen nt
    v_and_b32 v7, -4, v80
    v_lshl_add_u32 v8, v80, 2, v7
    ds_write_b32 v8, v76
    v_lshl_add_u32 v7, v7, 2, v80
    ds_write_b8 v7, v66 offset:16
    v_and_b32 v9, -4, v81
    v_lshl_add_u32 v10, v81, 2, v9
    ds_write_b32 v10, v77
    v_lshl_add_u32 v9, v9, 2, v81
    ds_write_b8_d16_hi v9, v66 offset:16
    v_and_b32 v7, -4, v82
    v_lshl_add_u32 v8, v82, 2, v7
    ds_write_b32 v8, v78
    v_lshl_add_u32 v7, v7, 2, v82
    ds_write_b8 v7, v67 offset:16
    v_and_b32 v9, -4, v83
    v_lshl_add_u32 v10, v83, 2, v9
    ds_write_b32 v10, v79
    v_lshl_add_u32 v9, v9, 2, v83
    ds_write_b8_d16_hi v9, v67 offset:16
    s_add_u32 s45, s98, 0x6800000
    s_lshr_b32 s45, s45, 1
    buffer_load_dwordx2 v[56:57], v1, s[16:19], s45 offen nt
    s_add_u32 s46, s99, 0x6c00000
    s_lshr_b32 s46, s46, 1
    buffer_load_dwordx2 v[58:59], v1, s[16:19], s46 offen nt
    s_add_u32 s47, s99, 0x6c00000
    v_lshlrev_b32 v76, 1, v1
    buffer_load_dwordx4 v[76:79], v76, s[8:11], s47 offen nt
    s_setprio 2
    v_and_b32 v7, -4, v104
    v_lshl_add_u32 v8, v104, 2, v7
    ds_write_b32 v8, v96
    v_lshl_add_u32 v7, v7, 2, v104
    ds_write_b8 v7, v88 offset:16
    v_and_b32 v9, -4, v105
    v_lshl_add_u32 v10, v105, 2, v9
    ds_write_b32 v10, v97
    v_lshl_add_u32 v9, v9, 2, v105
    ds_write_b8_d16_hi v9, v88 offset:16
    v_and_b32 v7, -4, v106
    v_lshl_add_u32 v8, v106, 2, v7
    ds_write_b32 v8, v98
    v_lshl_add_u32 v7, v7, 2, v106
    ds_write_b8 v7, v89 offset:16
    v_and_b32 v9, -4, v107
    v_lshl_add_u32 v10, v107, 2, v9
    ds_write_b32 v10, v99
    v_lshl_add_u32 v9, v9, 2, v107
    ds_write_b8_d16_hi v9, v89 offset:16
    s_add_u32 s44, s35, 0x2a48000
    s_add_u32 s44, s44, s91
    buffer_store_dwordx4 v[60:63], v0, s[20:23], s44 offen sc1
    s_add_u32 s45, s99, 0x6c00000
    v_lshlrev_b32 v80, 1, v1
    buffer_load_dwordx4 v[80:83], v80, s[12:15], s45 offen nt
    v_and_b32 v7, -4, v112
    v_lshl_add_u32 v8, v112, 2, v7
    ds_write_b32 v8, v100
    v_lshl_add_u32 v7, v7, 2, v112
    ds_write_b8 v7, v90 offset:16
    v_and_b32 v9, -4, v113
    v_lshl_add_u32 v10, v113, 2, v9
    ds_write_b32 v10, v101
    v_lshl_add_u32 v9, v9, 2, v113
    ds_write_b8_d16_hi v9, v90 offset:16
    v_and_b32 v7, -4, v114
    v_lshl_add_u32 v8, v114, 2, v7
    ds_write_b32 v8, v102
    v_lshl_add_u32 v7, v7, 2, v114
    ds_write_b8 v7, v91 offset:16
    v_and_b32 v9, -4, v115
    v_lshl_add_u32 v10, v115, 2, v9
    ds_write_b32 v10, v103
    v_lshl_add_u32 v9, v9, 2, v115
    ds_write_b8_d16_hi v9, v91 offset:16
    s_add_u32 s46, s96, 0x7000000
    v_lshlrev_b32 v64, 1, v1
    buffer_load_dwordx4 v[64:67], v64, s[8:11], s46 offen nt
    s_add_u32 s47, s96, 0x7000000
    v_lshlrev_b32 v96, 1, v1
    buffer_load_dwordx4 v[96:99], v96, s[12:15], s47 offen nt
    s_setprio 1
    v_and_b32 v7, -4, v116
    v_lshl_add_u32 v8, v116, 2, v7
    ds_write_b32 v8, v108
    v_lshl_add_u32 v7, v7, 2, v116
    ds_write_b8 v7, v120 offset:16
    v_and_b32 v9, -4, v117
    v_lshl_add_u32 v10, v117, 2, v9
    ds_write_b32 v10, v109
    v_lshl_add_u32 v9, v9, 2, v117
    ds_write_b8_d16_hi v9, v120 offset:16
    v_and_b32 v7, -4, v118
    v_lshl_add_u32 v8, v118, 2, v7
    ds_write_b32 v8, v110
    v_lshl_add_u32 v7, v7, 2, v118
    ds_write_b8 v7, v121 offset:16
    v_and_b32 v9, -4, v119
    v_lshl_add_u32 v10, v119, 2, v9
    ds_write_b32 v10, v111
    v_lshl_add_u32 v9, v9, 2, v119
    ds_write_b8_d16_hi v9, v121 offset:16
    s_add_u32 s44, s96, 0x7000000
    s_lshr_b32 s44, s44, 1
    buffer_load_dwordx2 v[104:105], v1, s[16:19], s44 offen nt
    s_add_u32 s45, s97, 0x7400000
    s_lshr_b32 s45, s45, 1
    buffer_load_dwordx2 v[106:107], v1, s[16:19], s45 offen nt
    s_add_u32 s46, s97, 0x7400000
    v_lshlrev_b32 v60, 1, v1
    buffer_load_dwordx4 v[60:63], v60, s[8:11], s46 offen nt
    v_and_b32 v7, -4, v16
    v_lshl_add_u32 v8, v16, 2, v7
    ds_write_b32 v8, v92
    v_lshl_add_u32 v7, v7, 2, v16
    ds_write_b8 v7, v122 offset:16
    v_and_b32 v9, -4, v17
    v_lshl_add_u32 v10, v17, 2, v9
    ds_write_b32 v10, v93
    v_lshl_add_u32 v9, v9, 2, v17
    ds_write_b8_d16_hi v9, v122 offset:16
    v_and_b32 v7, -4, v18
    v_lshl_add_u32 v8, v18, 2, v7
    ds_write_b32 v8, v94
    v_lshl_add_u32 v7, v7, 2, v18
    ds_write_b8 v7, v123 offset:16
    v_and_b32 v9, -4, v19
    v_lshl_add_u32 v10, v19, 2, v9
    ds_write_b32 v10, v95
    v_lshl_add_u32 v9, v9, 2, v19
    ds_write_b8_d16_hi v9, v123 offset:16
    s_add_u32 s47, s35, 0x2a48000
    s_add_u32 s47, s47, s93
    buffer_store_dwordx4 v[44:47], v0, s[20:23], s47 offen sc1
    s_add_u32 s44, s97, 0x7400000
    v_lshlrev_b32 v100, 1, v1
    buffer_load_dwordx4 v[100:103], v100, s[12:15], s44 offen nt
    s_setprio 0
    v_and_b32 v7, -4, v124
    v_lshl_add_u32 v8, v124, 2, v7
    ds_write_b32 v8, v20
    v_lshl_add_u32 v7, v7, 2, v124
    ds_write_b8 v7, v28 offset:16
    v_and_b32 v9, -4, v125
    v_lshl_add_u32 v10, v125, 2, v9
    ds_write_b32 v10, v21
    v_lshl_add_u32 v9, v9, 2, v125
    ds_write_b8_d16_hi v9, v28 offset:16
    v_and_b32 v7, -4, v126
    v_lshl_add_u32 v8, v126, 2, v7
    ds_write_b32 v8, v22
    v_lshl_add_u32 v7, v7, 2, v126
    ds_write_b8 v7, v29 offset:16
    v_and_b32 v9, -4, v127
    v_lshl_add_u32 v10, v127, 2, v9
    ds_write_b32 v10, v23
    v_lshl_add_u32 v9, v9, 2, v127
    ds_write_b8_d16_hi v9, v29 offset:16
    s_add_u32 s45, s98, 0x7800000
    v_lshlrev_b32 v112, 1, v1
    buffer_load_dwordx4 v[112:115], v112, s[8:11], s45 offen nt
    s_add_u32 s46, s98, 0x7800000
    v_lshlrev_b32 v88, 1, v1
    buffer_load_dwordx4 v[88:91], v88, s[12:15], s46 offen nt
    v_and_b32 v7, -4, v36
    v_lshl_add_u32 v8, v36, 2, v7
    ds_write_b32 v8, v32
    v_lshl_add_u32 v7, v7, 2, v36
    ds_write_b8 v7, v30 offset:16
    v_and_b32 v9, -4, v37
    v_lshl_add_u32 v10, v37, 2, v9
    ds_write_b32 v10, v33
    v_lshl_add_u32 v9, v9, 2, v37
    ds_write_b8_d16_hi v9, v30 offset:16
    v_and_b32 v7, -4, v38
    v_lshl_add_u32 v8, v38, 2, v7
    ds_write_b32 v8, v34
    v_lshl_add_u32 v7, v7, 2, v38
    ds_write_b8 v7, v31 offset:16
    v_and_b32 v9, -4, v39
    v_lshl_add_u32 v10, v39, 2, v9
    ds_write_b32 v10, v35
    v_lshl_add_u32 v9, v9, 2, v39
    ds_write_b8_d16_hi v9, v31 offset:16
    s_add_u32 s47, s98, 0x7800000
    s_lshr_b32 s47, s47, 1
    buffer_load_dwordx2 v[108:109], v1, s[16:19], s47 offen nt
    s_add_u32 s44, s99, 0x7c00000
    s_lshr_b32 s44, s44, 1
    buffer_load_dwordx2 v[110:111], v1, s[16:19], s44 offen nt
    v_add_u32 v7, s72, v0
    v_add_u32 v12, s73, v0
    v_add_u32 v13, s85, v0
    v_add_u32 v14, s91, v0
    v_add_u32 v15, s93, v0
    s_min_i32 s3, s72, s73
    s_min_i32 s3, s3, s85
    s_min_i32 s3, s3, s91
    s_min_i32 s3, s3, s93
    v_add_u32 v3, s3, v0
    v_mov_b32 v8, 0
    v_mov_b32 v9, 0
    v_mov_b32 v10, 0
    v_mov_b32 v11, 0
    s_waitcnt lgkmcnt(0)
    s_barrier
    ds_read_b128 v[116:119], v7 offset:0
    ds_read_b128 v[92:95], v12 offset:0
    ds_read_b128 v[16:19], v13 offset:0
    ds_read_b128 v[120:123], v14 offset:0
    ds_read_b128 v[44:47], v15 offset:0
    ds_write_b128 v3, v[8:11]
    ds_read_b128 v[20:23], v7 offset:16384
    ds_read_b128 v[124:127], v12 offset:16384
    ds_read_b128 v[32:35], v13 offset:16384
    ds_read_b128 v[36:39], v14 offset:16384
    ds_read_b128 v[28:31], v15 offset:16384
    s_waitcnt lgkmcnt(0)
    s_barrier
    s_setprio 3
    s_add_u32 s45, s35, 0x5484000
    s_add_u32 s45, s45, s72
    buffer_store_dwordx4 v[116:119], v0, s[20:23], s45 offen sc1
    s_add_u32 s46, s99, 0x7c00000
    s_nop 0
    v_lshlrev_b32 v116, 1, v1
    buffer_load_dwordx4 v[116:119], v116, s[8:11], s46 offen nt
    s_add_u32 s47, s35, 0x5484000
    s_add_u32 s47, s47, s73
    buffer_store_dwordx4 v[92:95], v0, s[20:23], s47 offen sc1
    s_add_u32 s44, s99, 0x7c00000
    s_nop 0
    v_lshlrev_b32 v92, 1, v1
    buffer_load_dwordx4 v[92:95], v92, s[12:15], s44 offen nt
    s_waitcnt vmcnt(27)
    v_lshlrev_b32 v7, 16, v84
    v_and_b32 v8, 0xffff0000, v84
    v_lshlrev_b32 v9, 16, v85
    v_and_b32 v10, 0xffff0000, v85
    v_mul_f32 v7, 0.15915494, v7
    v_mul_f32 v8, 0.15915494, v8
    v_mul_f32 v9, 0.15915494, v9
    v_mul_f32 v10, 0.15915494, v10
    v_mul_hi_u32_u24 v14, 429497, v40
    v_lshrrev_b32 v12, 3, v24
    v_cos_f32 v7, v7
    v_lshlrev_b16 v13, 3, v24
    v_mad_i32_i24 v11, v14, s55, v40
    v_bitop3_b32 v12, v6, v13, v12 bitop3:0xca
    v_lshl_add_u32 v11, v11, 17, s40
    v_lshlrev_b16 v14, 8, v14
    v_lshrrev_b32 v13, 2, v24
    v_add_u32 v40, v12, v11
    v_bitop3_b32 v24, v5, v13, v14 bitop3:0xea
    ds_add_u32 v24, v2
    v_mul_hi_u32_u24 v14, 429497, v41
    v_lshrrev_b32 v12, 3, v25
    v_cos_f32 v8, v8
    v_lshlrev_b16 v13, 3, v25
    v_mad_i32_i24 v11, v14, s55, v41
    v_bitop3_b32 v12, v6, v13, v12 bitop3:0xca
    v_lshl_add_u32 v11, v11, 17, s40
    v_lshlrev_b16 v14, 8, v14
    v_lshrrev_b32 v13, 2, v25
    v_add_u32 v41, v12, v11
    v_bitop3_b32 v25, v5, v13, v14 bitop3:0xea
    ds_add_u32 v25, v2
    v_cvt_pk_bf16_f32 v84, v7, v8
    v_perm_b32 v12, v84, v84, s41
    v_bitop3_b32 v40, v4, v12, v40 bitop3:0xca
    v_perm_b32 v13, v84, v84, s42
    v_bitop3_b32 v41, v4, v13, v41 bitop3:0xca
    v_mul_hi_u32_u24 v14, 429497, v42
    v_lshrrev_b32 v12, 3, v26
    v_cos_f32 v9, v9
    v_lshlrev_b16 v13, 3, v26
    v_mad_i32_i24 v11, v14, s55, v42
    v_bitop3_b32 v12, v6, v13, v12 bitop3:0xca
    v_lshl_add_u32 v11, v11, 17, s40
    v_lshlrev_b16 v14, 8, v14
    v_lshrrev_b32 v13, 2, v26
    v_add_u32 v42, v12, v11
    v_bitop3_b32 v26, v5, v13, v14 bitop3:0xea
    ds_add_u32 v26, v2
    v_mul_hi_u32_u24 v14, 429497, v43
    v_lshrrev_b32 v12, 3, v27
    v_cos_f32 v10, v10
    v_lshlrev_b16 v13, 3, v27
    v_mad_i32_i24 v11, v14, s55, v43
    v_bitop3_b32 v12, v6, v13, v12 bitop3:0xca
    v_lshl_add_u32 v11, v11, 17, s40
    v_lshlrev_b16 v14, 8, v14
    v_lshrrev_b32 v13, 2, v27
    v_add_u32 v43, v12, v11
    v_bitop3_b32 v27, v5, v13, v14 bitop3:0xea
    ds_add_u32 v27, v2
    v_cvt_pk_bf16_f32 v85, v9, v10
    v_perm_b32 v12, v85, v85, s41
    v_bitop3_b32 v42, v4, v12, v42 bitop3:0xca
    v_perm_b32 v13, v85, v85, s42
    v_bitop3_b32 v43, v4, v13, v43 bitop3:0xca
    s_waitcnt vmcnt(23)
    v_lshlrev_b32 v7, 16, v86
    v_and_b32 v8, 0xffff0000, v86
    v_lshlrev_b32 v9, 16, v87
    v_and_b32 v10, 0xffff0000, v87
    v_mul_f32 v7, 0.15915494, v7
    v_mul_f32 v8, 0.15915494, v8
    v_mul_f32 v9, 0.15915494, v9
    v_mul_f32 v10, 0.15915494, v10
    v_mul_hi_u32_u24 v14, 429497, v48
    v_lshrrev_b32 v12, 3, v52
    v_cos_f32 v7, v7
    v_lshlrev_b16 v13, 3, v52
    v_mad_i32_i24 v11, v14, s55, v48
    v_bitop3_b32 v12, v6, v13, v12 bitop3:0xca
    v_lshl_add_u32 v11, v11, 17, s40
    v_lshlrev_b16 v14, 8, v14
    v_lshrrev_b32 v13, 2, v52
    v_add_u32 v48, v12, v11
    v_bitop3_b32 v52, v5, v13, v14 bitop3:0xea
    ds_add_u32 v52, v2
    v_mul_hi_u32_u24 v14, 429497, v49
    v_lshrrev_b32 v12, 3, v53
    v_cos_f32 v8, v8
    v_lshlrev_b16 v13, 3, v53
    v_mad_i32_i24 v11, v14, s55, v49
    v_bitop3_b32 v12, v6, v13, v12 bitop3:0xca
    v_lshl_add_u32 v11, v11, 17, s40
    v_lshlrev_b16 v14, 8, v14
    v_lshrrev_b32 v13, 2, v53
    v_add_u32 v49, v12, v11
    v_bitop3_b32 v53, v5, v13, v14 bitop3:0xea
    ds_add_u32 v53, v2
    v_cvt_pk_bf16_f32 v86, v7, v8
    v_perm_b32 v12, v86, v86, s41
    v_bitop3_b32 v48, v4, v12, v48 bitop3:0xca
    v_perm_b32 v13, v86, v86, s42
    v_bitop3_b32 v49, v4, v13, v49 bitop3:0xca
    v_mul_hi_u32_u24 v14, 429497, v50
    v_lshrrev_b32 v12, 3, v54
    v_cos_f32 v9, v9
    v_lshlrev_b16 v13, 3, v54
    v_mad_i32_i24 v11, v14, s55, v50
    v_bitop3_b32 v12, v6, v13, v12 bitop3:0xca
    v_lshl_add_u32 v11, v11, 17, s40
    v_lshlrev_b16 v14, 8, v14
    v_lshrrev_b32 v13, 2, v54
    v_add_u32 v50, v12, v11
    v_bitop3_b32 v54, v5, v13, v14 bitop3:0xea
    ds_add_u32 v54, v2
    v_mul_hi_u32_u24 v14, 429497, v51
    v_lshrrev_b32 v12, 3, v55
    v_cos_f32 v10, v10
    v_lshlrev_b16 v13, 3, v55
    v_mad_i32_i24 v11, v14, s55, v51
    v_bitop3_b32 v12, v6, v13, v12 bitop3:0xca
    v_lshl_add_u32 v11, v11, 17, s40
    v_lshlrev_b16 v14, 8, v14
    v_lshrrev_b32 v13, 2, v55
    v_add_u32 v51, v12, v11
    v_bitop3_b32 v55, v5, v13, v14 bitop3:0xea
    ds_add_u32 v55, v2
    v_cvt_pk_bf16_f32 v87, v9, v10
    v_perm_b32 v12, v87, v87, s41
    v_bitop3_b32 v50, v4, v12, v50 bitop3:0xca
    v_perm_b32 v13, v87, v87, s42
    v_bitop3_b32 v51, v4, v13, v51 bitop3:0xca
    s_setprio 2
    s_waitcnt vmcnt(18)
    v_lshlrev_b32 v7, 16, v56
    v_and_b32 v8, 0xffff0000, v56
    v_lshlrev_b32 v9, 16, v57
    v_and_b32 v10, 0xffff0000, v57
    v_mul_f32 v7, 0.15915494, v7
    v_mul_f32 v8, 0.15915494, v8
    v_mul_f32 v9, 0.15915494, v9
    v_mul_f32 v10, 0.15915494, v10
    v_mul_hi_u32_u24 v14, 429497, v68
    v_lshrrev_b32 v12, 3, v72
    v_cos_f32 v7, v7
    v_lshlrev_b16 v13, 3, v72
    v_mad_i32_i24 v11, v14, s55, v68
    v_bitop3_b32 v12, v6, v13, v12 bitop3:0xca
    v_lshl_add_u32 v11, v11, 17, s40
    v_lshlrev_b16 v14, 8, v14
    v_lshrrev_b32 v13, 2, v72
    v_add_u32 v68, v12, v11
    v_bitop3_b32 v72, v5, v13, v14 bitop3:0xea
    ds_add_u32 v72, v2
    v_mul_hi_u32_u24 v14, 429497, v69
    v_lshrrev_b32 v12, 3, v73
    v_cos_f32 v8, v8
    v_lshlrev_b16 v13, 3, v73
    v_mad_i32_i24 v11, v14, s55, v69
    v_bitop3_b32 v12, v6, v13, v12 bitop3:0xca
    v_lshl_add_u32 v11, v11, 17, s40
    v_lshlrev_b16 v14, 8, v14
    v_lshrrev_b32 v13, 2, v73
    v_add_u32 v69, v12, v11
    v_bitop3_b32 v73, v5, v13, v14 bitop3:0xea
    ds_add_u32 v73, v2
    v_cvt_pk_bf16_f32 v56, v7, v8
    v_perm_b32 v12, v56, v56, s41
    v_bitop3_b32 v68, v4, v12, v68 bitop3:0xca
    v_perm_b32 v13, v56, v56, s42
    v_bitop3_b32 v69, v4, v13, v69 bitop3:0xca
    v_mul_hi_u32_u24 v14, 429497, v70
    v_lshrrev_b32 v12, 3, v74
    v_cos_f32 v9, v9
    v_lshlrev_b16 v13, 3, v74
    v_mad_i32_i24 v11, v14, s55, v70
    v_bitop3_b32 v12, v6, v13, v12 bitop3:0xca
    v_lshl_add_u32 v11, v11, 17, s40
    v_lshlrev_b16 v14, 8, v14
    v_lshrrev_b32 v13, 2, v74
    v_add_u32 v70, v12, v11
    v_bitop3_b32 v74, v5, v13, v14 bitop3:0xea
    ds_add_u32 v74, v2
    v_mul_hi_u32_u24 v14, 429497, v71
    v_lshrrev_b32 v12, 3, v75
    v_cos_f32 v10, v10
    v_lshlrev_b16 v13, 3, v75
    v_mad_i32_i24 v11, v14, s55, v71
    v_bitop3_b32 v12, v6, v13, v12 bitop3:0xca
    v_lshl_add_u32 v11, v11, 17, s40
    v_lshlrev_b16 v14, 8, v14
    v_lshrrev_b32 v13, 2, v75
    v_add_u32 v71, v12, v11
    v_bitop3_b32 v75, v5, v13, v14 bitop3:0xea
    ds_add_u32 v75, v2
    v_cvt_pk_bf16_f32 v57, v9, v10
    v_perm_b32 v12, v57, v57, s41
    v_bitop3_b32 v70, v4, v12, v70 bitop3:0xca
    v_perm_b32 v13, v57, v57, s42
    v_bitop3_b32 v71, v4, v13, v71 bitop3:0xca
    s_add_u32 s45, s35, 0x5484000
    s_add_u32 s45, s45, s85
    buffer_store_dwordx4 v[16:19], v0, s[20:23], s45 offen sc1
    s_add_u32 s46, s96, 0x8000000
    s_nop 0
    v_lshlrev_b32 v16, 1, v1
    buffer_load_dwordx4 v[16:19], v16, s[8:11], s46 offen nt
    s_waitcnt vmcnt(17)
    v_lshlrev_b32 v7, 16, v58
    v_and_b32 v8, 0xffff0000, v58
    v_lshlrev_b32 v9, 16, v59
    v_and_b32 v10, 0xffff0000, v59
    v_mul_f32 v7, 0.15915494, v7
    v_mul_f32 v8, 0.15915494, v8
    v_mul_f32 v9, 0.15915494, v9
    v_mul_f32 v10, 0.15915494, v10
    v_mul_hi_u32_u24 v14, 429497, v76
    v_lshrrev_b32 v12, 3, v80
    v_cos_f32 v7, v7
    v_lshlrev_b16 v13, 3, v80
    v_mad_i32_i24 v11, v14, s55, v76
    v_bitop3_b32 v12, v6, v13, v12 bitop3:0xca
    v_lshl_add_u32 v11, v11, 17, s40
    v_lshlrev_b16 v14, 8, v14
    v_lshrrev_b32 v13, 2, v80
    v_add_u32 v76, v12, v11
    v_bitop3_b32 v80, v5, v13, v14 bitop3:0xea
    ds_add_u32 v80, v2
    v_mul_hi_u32_u24 v14, 429497, v77
    v_lshrrev_b32 v12, 3, v81
    v_cos_f32 v8, v8
    v_lshlrev_b16 v13, 3, v81
    v_mad_i32_i24 v11, v14, s55, v77
    v_bitop3_b32 v12, v6, v13, v12 bitop3:0xca
    v_lshl_add_u32 v11, v11, 17, s40
    v_lshlrev_b16 v14, 8, v14
    v_lshrrev_b32 v13, 2, v81
    v_add_u32 v77, v12, v11
    v_bitop3_b32 v81, v5, v13, v14 bitop3:0xea
    ds_add_u32 v81, v2
    v_cvt_pk_bf16_f32 v58, v7, v8
    v_perm_b32 v12, v58, v58, s41
    v_bitop3_b32 v76, v4, v12, v76 bitop3:0xca
    v_perm_b32 v13, v58, v58, s42
    v_bitop3_b32 v77, v4, v13, v77 bitop3:0xca
    v_mul_hi_u32_u24 v14, 429497, v78
    v_lshrrev_b32 v12, 3, v82
    v_cos_f32 v9, v9
    v_lshlrev_b16 v13, 3, v82
    v_mad_i32_i24 v11, v14, s55, v78
    v_bitop3_b32 v12, v6, v13, v12 bitop3:0xca
    v_lshl_add_u32 v11, v11, 17, s40
    v_lshlrev_b16 v14, 8, v14
    v_lshrrev_b32 v13, 2, v82
    v_add_u32 v78, v12, v11
    v_bitop3_b32 v82, v5, v13, v14 bitop3:0xea
    ds_add_u32 v82, v2
    v_mul_hi_u32_u24 v14, 429497, v79
    v_lshrrev_b32 v12, 3, v83
    v_cos_f32 v10, v10
    v_lshlrev_b16 v13, 3, v83
    v_mad_i32_i24 v11, v14, s55, v79
    v_bitop3_b32 v12, v6, v13, v12 bitop3:0xca
    v_lshl_add_u32 v11, v11, 17, s40
    v_lshlrev_b16 v14, 8, v14
    v_lshrrev_b32 v13, 2, v83
    v_add_u32 v79, v12, v11
    v_bitop3_b32 v83, v5, v13, v14 bitop3:0xea
    ds_add_u32 v83, v2
    v_cvt_pk_bf16_f32 v59, v9, v10
    v_perm_b32 v12, v59, v59, s41
    v_bitop3_b32 v78, v4, v12, v78 bitop3:0xca
    v_perm_b32 v13, v59, v59, s42
    v_bitop3_b32 v79, v4, v13, v79 bitop3:0xca
    s_setprio 1
    s_waitcnt vmcnt(13)
    v_lshlrev_b32 v7, 16, v104
    v_and_b32 v8, 0xffff0000, v104
    v_lshlrev_b32 v9, 16, v105
    v_and_b32 v10, 0xffff0000, v105
    v_mul_f32 v7, 0.15915494, v7
    v_mul_f32 v8, 0.15915494, v8
    v_mul_f32 v9, 0.15915494, v9
    v_mul_f32 v10, 0.15915494, v10
    v_mul_hi_u32_u24 v14, 429497, v64
    v_lshrrev_b32 v12, 3, v96
    v_cos_f32 v7, v7
    v_lshlrev_b16 v13, 3, v96
    v_mad_i32_i24 v11, v14, s55, v64
    v_bitop3_b32 v12, v6, v13, v12 bitop3:0xca
    v_lshl_add_u32 v11, v11, 17, s40
    v_lshlrev_b16 v14, 8, v14
    v_lshrrev_b32 v13, 2, v96
    v_add_u32 v64, v12, v11
    v_bitop3_b32 v96, v5, v13, v14 bitop3:0xea
    ds_add_u32 v96, v2
    v_mul_hi_u32_u24 v14, 429497, v65
    v_lshrrev_b32 v12, 3, v97
    v_cos_f32 v8, v8
    v_lshlrev_b16 v13, 3, v97
    v_mad_i32_i24 v11, v14, s55, v65
    v_bitop3_b32 v12, v6, v13, v12 bitop3:0xca
    v_lshl_add_u32 v11, v11, 17, s40
    v_lshlrev_b16 v14, 8, v14
    v_lshrrev_b32 v13, 2, v97
    v_add_u32 v65, v12, v11
    v_bitop3_b32 v97, v5, v13, v14 bitop3:0xea
    ds_add_u32 v97, v2
    v_cvt_pk_bf16_f32 v104, v7, v8
    v_perm_b32 v12, v104, v104, s41
    v_bitop3_b32 v64, v4, v12, v64 bitop3:0xca
    v_perm_b32 v13, v104, v104, s42
    v_bitop3_b32 v65, v4, v13, v65 bitop3:0xca
    v_mul_hi_u32_u24 v14, 429497, v66
    v_lshrrev_b32 v12, 3, v98
    v_cos_f32 v9, v9
    v_lshlrev_b16 v13, 3, v98
    v_mad_i32_i24 v11, v14, s55, v66
    v_bitop3_b32 v12, v6, v13, v12 bitop3:0xca
    v_lshl_add_u32 v11, v11, 17, s40
    v_lshlrev_b16 v14, 8, v14
    v_lshrrev_b32 v13, 2, v98
    v_add_u32 v66, v12, v11
    v_bitop3_b32 v98, v5, v13, v14 bitop3:0xea
    ds_add_u32 v98, v2
    v_mul_hi_u32_u24 v14, 429497, v67
    v_lshrrev_b32 v12, 3, v99
    v_cos_f32 v10, v10
    v_lshlrev_b16 v13, 3, v99
    v_mad_i32_i24 v11, v14, s55, v67
    v_bitop3_b32 v12, v6, v13, v12 bitop3:0xca
    v_lshl_add_u32 v11, v11, 17, s40
    v_lshlrev_b16 v14, 8, v14
    v_lshrrev_b32 v13, 2, v99
    v_add_u32 v67, v12, v11
    v_bitop3_b32 v99, v5, v13, v14 bitop3:0xea
    ds_add_u32 v99, v2
    v_cvt_pk_bf16_f32 v105, v9, v10
    v_perm_b32 v12, v105, v105, s41
    v_bitop3_b32 v66, v4, v12, v66 bitop3:0xca
    v_perm_b32 v13, v105, v105, s42
    v_bitop3_b32 v67, v4, v13, v67 bitop3:0xca
    s_mov_b32 s68, s66
    s_mov_b32 s69, s67
    s_mov_b32 s70, 0x100
    s_mov_b32 s71, 0x20000
    v_mov_b32 v3, 1
    s_cmp_lg_u32 s32, 15
    s_cbranch_scc1 L1_tk
    s_mov_b64 exec, 1
    s_and_b32 s3, s2, 1
    s_lshl_b32 s3, s3, 7
    buffer_atomic_add v3, off, s[68:71], s3 sc0
    s_mov_b64 exec, -1
L1_tk:
    s_waitcnt vmcnt(10)
    v_lshlrev_b32 v7, 16, v106
    v_and_b32 v8, 0xffff0000, v106
    v_lshlrev_b32 v9, 16, v107
    v_and_b32 v10, 0xffff0000, v107
    v_mul_f32 v7, 0.15915494, v7
    v_mul_f32 v8, 0.15915494, v8
    v_mul_f32 v9, 0.15915494, v9
    v_mul_f32 v10, 0.15915494, v10
    v_mul_hi_u32_u24 v14, 429497, v60
    v_lshrrev_b32 v12, 3, v100
    v_cos_f32 v7, v7
    v_lshlrev_b16 v13, 3, v100
    v_mad_i32_i24 v11, v14, s55, v60
    v_bitop3_b32 v12, v6, v13, v12 bitop3:0xca
    v_lshl_add_u32 v11, v11, 17, s40
    v_lshlrev_b16 v14, 8, v14
    v_lshrrev_b32 v13, 2, v100
    v_add_u32 v60, v12, v11
    v_bitop3_b32 v100, v5, v13, v14 bitop3:0xea
    ds_add_u32 v100, v2
    v_mul_hi_u32_u24 v14, 429497, v61
    v_lshrrev_b32 v12, 3, v101
    v_cos_f32 v8, v8
    v_lshlrev_b16 v13, 3, v101
    v_mad_i32_i24 v11, v14, s55, v61
    v_bitop3_b32 v12, v6, v13, v12 bitop3:0xca
    v_lshl_add_u32 v11, v11, 17, s40
    v_lshlrev_b16 v14, 8, v14
    v_lshrrev_b32 v13, 2, v101
    v_add_u32 v61, v12, v11
    v_bitop3_b32 v101, v5, v13, v14 bitop3:0xea
    ds_add_u32 v101, v2
    v_cvt_pk_bf16_f32 v106, v7, v8
    v_perm_b32 v12, v106, v106, s41
    v_bitop3_b32 v60, v4, v12, v60 bitop3:0xca
    v_perm_b32 v13, v106, v106, s42
    v_bitop3_b32 v61, v4, v13, v61 bitop3:0xca
    v_mul_hi_u32_u24 v14, 429497, v62
    v_lshrrev_b32 v12, 3, v102
    v_cos_f32 v9, v9
    v_lshlrev_b16 v13, 3, v102
    v_mad_i32_i24 v11, v14, s55, v62
    v_bitop3_b32 v12, v6, v13, v12 bitop3:0xca
    v_lshl_add_u32 v11, v11, 17, s40
    v_lshlrev_b16 v14, 8, v14
    v_lshrrev_b32 v13, 2, v102
    v_add_u32 v62, v12, v11
    v_bitop3_b32 v102, v5, v13, v14 bitop3:0xea
    ds_add_u32 v102, v2
    v_mul_hi_u32_u24 v14, 429497, v63
    v_lshrrev_b32 v12, 3, v103
    v_cos_f32 v10, v10
    v_lshlrev_b16 v13, 3, v103
    v_mad_i32_i24 v11, v14, s55, v63
    v_bitop3_b32 v12, v6, v13, v12 bitop3:0xca
    v_lshl_add_u32 v11, v11, 17, s40
    v_lshlrev_b16 v14, 8, v14
    v_lshrrev_b32 v13, 2, v103
    v_add_u32 v63, v12, v11
    v_bitop3_b32 v103, v5, v13, v14 bitop3:0xea
    ds_add_u32 v103, v2
    v_cvt_pk_bf16_f32 v107, v9, v10
    v_perm_b32 v12, v107, v107, s41
    v_bitop3_b32 v62, v4, v12, v62 bitop3:0xca
    v_perm_b32 v13, v107, v107, s42
    v_bitop3_b32 v63, v4, v13, v63 bitop3:0xca
    s_setprio 0
    s_add_u32 s47, s35, 0x5484000
    s_add_u32 s47, s47, s91
    buffer_store_dwordx4 v[120:123], v0, s[20:23], s47 offen sc1
    s_add_u32 s44, s96, 0x8000000
    s_nop 0
    v_lshlrev_b32 v120, 1, v1
    buffer_load_dwordx4 v[120:123], v120, s[12:15], s44 offen nt
    s_waitcnt vmcnt(8)
    v_lshlrev_b32 v7, 16, v108
    v_and_b32 v8, 0xffff0000, v108
    v_lshlrev_b32 v9, 16, v109
    v_and_b32 v10, 0xffff0000, v109
    v_mul_f32 v7, 0.15915494, v7
    v_mul_f32 v8, 0.15915494, v8
    v_mul_f32 v9, 0.15915494, v9
    v_mul_f32 v10, 0.15915494, v10
    v_mul_hi_u32_u24 v14, 429497, v112
    v_lshrrev_b32 v12, 3, v88
    v_cos_f32 v7, v7
    v_lshlrev_b16 v13, 3, v88
    v_mad_i32_i24 v11, v14, s55, v112
    v_bitop3_b32 v12, v6, v13, v12 bitop3:0xca
    v_lshl_add_u32 v11, v11, 17, s40
    v_lshlrev_b16 v14, 8, v14
    v_lshrrev_b32 v13, 2, v88
    v_add_u32 v112, v12, v11
    v_bitop3_b32 v88, v5, v13, v14 bitop3:0xea
    ds_add_u32 v88, v2
    v_mul_hi_u32_u24 v14, 429497, v113
    v_lshrrev_b32 v12, 3, v89
    v_cos_f32 v8, v8
    v_lshlrev_b16 v13, 3, v89
    v_mad_i32_i24 v11, v14, s55, v113
    v_bitop3_b32 v12, v6, v13, v12 bitop3:0xca
    v_lshl_add_u32 v11, v11, 17, s40
    v_lshlrev_b16 v14, 8, v14
    v_lshrrev_b32 v13, 2, v89
    v_add_u32 v113, v12, v11
    v_bitop3_b32 v89, v5, v13, v14 bitop3:0xea
    ds_add_u32 v89, v2
    v_cvt_pk_bf16_f32 v108, v7, v8
    v_perm_b32 v12, v108, v108, s41
    v_bitop3_b32 v112, v4, v12, v112 bitop3:0xca
    v_perm_b32 v13, v108, v108, s42
    v_bitop3_b32 v113, v4, v13, v113 bitop3:0xca
    v_mul_hi_u32_u24 v14, 429497, v114
    v_lshrrev_b32 v12, 3, v90
    v_cos_f32 v9, v9
    v_lshlrev_b16 v13, 3, v90
    v_mad_i32_i24 v11, v14, s55, v114
    v_bitop3_b32 v12, v6, v13, v12 bitop3:0xca
    v_lshl_add_u32 v11, v11, 17, s40
    v_lshlrev_b16 v14, 8, v14
    v_lshrrev_b32 v13, 2, v90
    v_add_u32 v114, v12, v11
    v_bitop3_b32 v90, v5, v13, v14 bitop3:0xea
    ds_add_u32 v90, v2
    v_mul_hi_u32_u24 v14, 429497, v115
    v_lshrrev_b32 v12, 3, v91
    v_cos_f32 v10, v10
    v_lshlrev_b16 v13, 3, v91
    v_mad_i32_i24 v11, v14, s55, v115
    v_bitop3_b32 v12, v6, v13, v12 bitop3:0xca
    v_lshl_add_u32 v11, v11, 17, s40
    v_lshlrev_b16 v14, 8, v14
    v_lshrrev_b32 v13, 2, v91
    v_add_u32 v115, v12, v11
    v_bitop3_b32 v91, v5, v13, v14 bitop3:0xea
    ds_add_u32 v91, v2
    v_cvt_pk_bf16_f32 v109, v9, v10
    v_perm_b32 v12, v109, v109, s41
    v_bitop3_b32 v114, v4, v12, v114 bitop3:0xca
    v_perm_b32 v13, v109, v109, s42
    v_bitop3_b32 v115, v4, v13, v115 bitop3:0xca
    s_waitcnt vmcnt(4)
    v_lshlrev_b32 v7, 16, v110
    v_and_b32 v8, 0xffff0000, v110
    v_lshlrev_b32 v9, 16, v111
    v_and_b32 v10, 0xffff0000, v111
    v_mul_f32 v7, 0.15915494, v7
    v_mul_f32 v8, 0.15915494, v8
    v_mul_f32 v9, 0.15915494, v9
    v_mul_f32 v10, 0.15915494, v10
    v_mul_hi_u32_u24 v14, 429497, v116
    v_lshrrev_b32 v12, 3, v92
    v_cos_f32 v7, v7
    v_lshlrev_b16 v13, 3, v92
    v_mad_i32_i24 v11, v14, s55, v116
    v_bitop3_b32 v12, v6, v13, v12 bitop3:0xca
    v_lshl_add_u32 v11, v11, 17, s40
    v_lshlrev_b16 v14, 8, v14
    v_lshrrev_b32 v13, 2, v92
    v_add_u32 v116, v12, v11
    v_bitop3_b32 v92, v5, v13, v14 bitop3:0xea
    ds_add_u32 v92, v2
    v_mul_hi_u32_u24 v14, 429497, v117
    v_lshrrev_b32 v12, 3, v93
    v_cos_f32 v8, v8
    v_lshlrev_b16 v13, 3, v93
    v_mad_i32_i24 v11, v14, s55, v117
    v_bitop3_b32 v12, v6, v13, v12 bitop3:0xca
    v_lshl_add_u32 v11, v11, 17, s40
    v_lshlrev_b16 v14, 8, v14
    v_lshrrev_b32 v13, 2, v93
    v_add_u32 v117, v12, v11
    v_bitop3_b32 v93, v5, v13, v14 bitop3:0xea
    ds_add_u32 v93, v2
    v_cvt_pk_bf16_f32 v110, v7, v8
    v_perm_b32 v12, v110, v110, s41
    v_bitop3_b32 v116, v4, v12, v116 bitop3:0xca
    v_perm_b32 v13, v110, v110, s42
    v_bitop3_b32 v117, v4, v13, v117 bitop3:0xca
    v_mul_hi_u32_u24 v14, 429497, v118
    v_lshrrev_b32 v12, 3, v94
    v_cos_f32 v9, v9
    v_lshlrev_b16 v13, 3, v94
    v_mad_i32_i24 v11, v14, s55, v118
    v_bitop3_b32 v12, v6, v13, v12 bitop3:0xca
    v_lshl_add_u32 v11, v11, 17, s40
    v_lshlrev_b16 v14, 8, v14
    v_lshrrev_b32 v13, 2, v94
    v_add_u32 v118, v12, v11
    v_bitop3_b32 v94, v5, v13, v14 bitop3:0xea
    ds_add_u32 v94, v2
    v_mul_hi_u32_u24 v14, 429497, v119
    v_lshrrev_b32 v12, 3, v95
    v_cos_f32 v10, v10
    v_lshlrev_b16 v13, 3, v95
    v_mad_i32_i24 v11, v14, s55, v119
    v_bitop3_b32 v12, v6, v13, v12 bitop3:0xca
    v_lshl_add_u32 v11, v11, 17, s40
    v_lshlrev_b16 v14, 8, v14
    v_lshrrev_b32 v13, 2, v95
    v_add_u32 v119, v12, v11
    v_bitop3_b32 v95, v5, v13, v14 bitop3:0xea
    ds_add_u32 v95, v2
    v_cvt_pk_bf16_f32 v111, v9, v10
    v_perm_b32 v12, v111, v111, s41
    v_bitop3_b32 v118, v4, v12, v118 bitop3:0xca
    v_perm_b32 v13, v111, v111, s42
    v_bitop3_b32 v119, v4, v13, v119 bitop3:0xca
    v_lshrrev_b32 v8, 2, v0
    v_and_b32 v7, 0x3c00, v0
    v_bitop3_b32 v7, v5, v8, v7 bitop3:0xea
    s_waitcnt lgkmcnt(0)
    s_barrier
    ds_read2st64_b32 v[8:9], v7 offset0:0 offset1:1
    ds_read2st64_b32 v[10:11], v7 offset0:2 offset1:3
    s_add_u32 s45, s35, 0x5484000
    s_add_u32 s45, s45, s93
    buffer_store_dwordx4 v[44:47], v0, s[20:23], s45 offen sc1
    s_add_u32 s46, s96, 0x8000000
    s_lshr_b32 s46, s46, 1
    buffer_load_dwordx2 v[44:45], v1, s[16:19], s46 offen nt
    s_add_u32 s47, s97, 0x8400000
    s_lshr_b32 s47, s47, 1
    buffer_load_dwordx2 v[46:47], v1, s[16:19], s47 offen nt
    s_waitcnt lgkmcnt(0)
    v_lshl_or_b32 v12, v9, 16, v8
    v_lshl_or_b32 v13, v11, 16, v10
    v_mov_b32 v14, v12
    v_mov_b32 v15, v13
    s_nop 0
    v_add_u32_dpp v14, v14, v14 row_shr:1 row_mask:0xf bank_mask:0xf bound_ctrl:1
    v_add_u32_dpp v15, v15, v15 row_shr:1 row_mask:0xf bank_mask:0xf bound_ctrl:1
    s_nop 0
    v_add_u32_dpp v14, v14, v14 row_shr:2 row_mask:0xf bank_mask:0xf bound_ctrl:1
    v_add_u32_dpp v15, v15, v15 row_shr:2 row_mask:0xf bank_mask:0xf bound_ctrl:1
    s_nop 0
    v_add_u32_dpp v14, v14, v14 row_shr:4 row_mask:0xf bank_mask:0xf bound_ctrl:1
    v_add_u32_dpp v15, v15, v15 row_shr:4 row_mask:0xf bank_mask:0xf bound_ctrl:1
    s_nop 0
    v_add_u32_dpp v14, v14, v14 row_shr:8 row_mask:0xf bank_mask:0xf bound_ctrl:1
    v_add_u32_dpp v15, v15, v15 row_shr:8 row_mask:0xf bank_mask:0xf bound_ctrl:1
    s_nop 0
    v_add_u32_dpp v14, v14, v14 row_bcast:15 row_mask:0xa bank_mask:0xf
    v_add_u32_dpp v15, v15, v15 row_bcast:15 row_mask:0xa bank_mask:0xf
    s_nop 0
    v_add_u32_dpp v14, v14, v14 row_bcast:31 row_mask:0xc bank_mask:0xf
    v_add_u32_dpp v15, v15, v15 row_bcast:31 row_mask:0xc bank_mask:0xf
    v_readlane_b32 s48, v14, 63
    v_readlane_b32 s49, v15, 63
    s_lshl_b32 s54, s32, 2
    v_mov_b32 v8, s54
    s_and_b32 s50, s48, 0xffff
    s_lshr_b32 s51, s48, 16
    s_and_b32 s52, s49, 0xffff
    s_lshr_b32 s53, s49, 16
    s_add_u32 s51, s51, s50
    s_add_u32 s52, s52, s51
    s_add_u32 s53, s53, s52
    v_mov_b32 v9, s53
    s_mov_b64 exec, 1
    ds_write_b32 v8, v9 offset:16384
    s_cmp_lg_u32 s32, 15
    s_cbranch_scc1 L1_tk2
    s_waitcnt vmcnt(3)
L1_tk2:
    ds_write_b32 v8, v3 offset:16448
    s_mov_b64 exec, -1
    v_and_b32 v8, 60, v7
    s_waitcnt lgkmcnt(0)
    s_barrier
    ds_read_b32 v9, v8 offset:16384
    ds_read_b32 v10, v8 offset:16448
    s_waitcnt lgkmcnt(0)
    v_readlane_b32 s84, v10, 15
    s_and_b32 s3, s2, 1
    s_lshl_b32 s3, s3, 7
    s_add_u32 s84, s84, s3
    s_min_u32 s4, s84, 72
    s_min_u32 s5, s84, 216
    s_min_u32 s6, s84, 240
    s_add_u32 s4, s4, s5
    s_add_u32 s4, s4, s6
    s_add_u32 s4, s4, 9467
    s_mov_b32 s4, s84
    s_lshl_b32 s58, s4, 14
    s_lshl_b32 s5, s32, 10
    s_add_u32 s58, s58, s5
    s_lshr_b32 s59, s58, 1
    s_mov_b32 s43, 5
    s_cmp_lt_u32 s84, 72
    s_addc_u32 s43, s43, 0
    s_cmp_lt_u32 s84, 216
    s_addc_u32 s43, s43, 0
    s_cmp_lt_u32 s84, 240
    s_addc_u32 s43, s43, 0
    v_add_u32_dpp v9, v9, v9 row_shr:1 row_mask:0xf bank_mask:0xf bound_ctrl:1
    s_nop 1
    v_add_u32_dpp v9, v9, v9 row_shr:2 row_mask:0xf bank_mask:0xf bound_ctrl:1
    s_nop 1
    v_add_u32_dpp v9, v9, v9 row_shr:4 row_mask:0xf bank_mask:0xf bound_ctrl:1
    s_nop 1
    v_add_u32_dpp v9, v9, v9 row_shr:8 row_mask:0xf bank_mask:0xf bound_ctrl:1
    s_nop 0
    v_readlane_b32 s54, v9, s32
    s_sub_u32 s54, s54, s53
    s_add_u32 s50, s50, s54
    s_add_u32 s51, s51, s54
    s_add_u32 s52, s52, s54
    s_pack_ll_b32_b16 s48, s54, s50
    s_pack_ll_b32_b16 s49, s51, s52
    v_add_u32 v14, s48, v14
    v_add_u32 v15, s49, v15
    v_sub_u32 v12, v14, v12
    v_sub_u32 v13, v15, v13
    v_and_b32 v8, 0xffff, v12
    v_lshrrev_b32 v9, 16, v12
    v_and_b32 v10, 0xffff, v13
    v_lshrrev_b32 v11, 16, v13
    ds_write2st64_b32 v7, v8, v9 offset0:0 offset1:1
    ds_write2st64_b32 v7, v10, v11 offset0:2 offset1:3
    v_and_b32 v8, 0x3f0, v0
    v_lshl_add_u32 v8, v8, 1, s36
    ds_write_b64 v8, v[12:13] offset:20480
    s_bitset0_b64 exec, 63
    s_not_b64 exec, exec
    ds_write_b64 v8, v[14:15] offset:20512
    s_mov_b64 exec, -1
    s_waitcnt lgkmcnt(0)
    s_barrier
    s_setprio 3
    ds_add_rtn_u32 v24, v24, v2
    ds_add_rtn_u32 v25, v25, v2
    ds_add_rtn_u32 v26, v26, v2
    ds_add_rtn_u32 v27, v27, v2
    ds_read_b128 v[12:15], v0 offset:20480
    v_cmp_gt_u32 vcc, 8448, v0
    ds_add_rtn_u32 v52, v52, v2
    ds_add_rtn_u32 v53, v53, v2
    ds_add_rtn_u32 v54, v54, v2
    ds_add_rtn_u32 v55, v55, v2
    s_setprio 2
    ds_add_rtn_u32 v72, v72, v2
    ds_add_rtn_u32 v73, v73, v2
    ds_add_rtn_u32 v74, v74, v2
    ds_add_rtn_u32 v75, v75, v2
    s_waitcnt lgkmcnt(8)
    s_cbranch_vccz L1_p4
    s_add_u32 s44, s35, 0x7ec0000
    s_mov_b64 exec, vcc
    buffer_store_dwordx4 v[12:15], v0, s[24:27], s44 offen sc1
    s_mov_b64 exec, -1
L1_p4:
    s_add_u32 s45, s35, 0x5488000
    s_add_u32 s45, s45, s72
    buffer_store_dwordx4 v[20:23], v0, s[20:23], s45 offen sc1
    s_add_u32 s46, s97, 0x8400000
    s_nop 0
    v_lshlrev_b32 v20, 1, v1
    buffer_load_dwordx4 v[20:23], v20, s[8:11], s46 offen nt
    ds_add_rtn_u32 v80, v80, v2
    ds_add_rtn_u32 v81, v81, v2
    ds_add_rtn_u32 v82, v82, v2
    ds_add_rtn_u32 v83, v83, v2
    s_setprio 1
    ds_add_rtn_u32 v96, v96, v2
    ds_add_rtn_u32 v97, v97, v2
    ds_add_rtn_u32 v98, v98, v2
    ds_add_rtn_u32 v99, v99, v2
    ds_add_rtn_u32 v100, v100, v2
    ds_add_rtn_u32 v101, v101, v2
    ds_add_rtn_u32 v102, v102, v2
    ds_add_rtn_u32 v103, v103, v2
    s_add_u32 s47, s35, 0x5488000
    s_add_u32 s47, s47, s73
    buffer_store_dwordx4 v[124:127], v0, s[20:23], s47 offen sc1
    s_add_u32 s44, s97, 0x8400000
    s_nop 0
    v_lshlrev_b32 v124, 1, v1
    buffer_load_dwordx4 v[124:127], v124, s[12:15], s44 offen nt
    s_setprio 0
    ds_add_rtn_u32 v88, v88, v2
    ds_add_rtn_u32 v89, v89, v2
    ds_add_rtn_u32 v90, v90, v2
    ds_add_rtn_u32 v91, v91, v2
    ds_add_rtn_u32 v92, v92, v2
    ds_add_rtn_u32 v93, v93, v2
    ds_add_rtn_u32 v94, v94, v2
    ds_add_rtn_u32 v95, v95, v2
    s_waitcnt lgkmcnt(0)
    s_barrier
    s_setprio 3
    v_and_b32 v7, -4, v24
    v_lshl_add_u32 v8, v24, 2, v7
    ds_write_b32 v8, v40
    v_lshl_add_u32 v7, v7, 2, v24
    ds_write_b8 v7, v84 offset:16
    v_and_b32 v9, -4, v25
    v_lshl_add_u32 v10, v25, 2, v9
    ds_write_b32 v10, v41
    v_lshl_add_u32 v9, v9, 2, v25
    ds_write_b8_d16_hi v9, v84 offset:16
    v_and_b32 v7, -4, v26
    v_lshl_add_u32 v8, v26, 2, v7
    ds_write_b32 v8, v42
    v_lshl_add_u32 v7, v7, 2, v26
    ds_write_b8 v7, v85 offset:16
    v_and_b32 v9, -4, v27
    v_lshl_add_u32 v10, v27, 2, v9
    ds_write_b32 v10, v43
    v_lshl_add_u32 v9, v9, 2, v27
    ds_write_b8_d16_hi v9, v85 offset:16
    s_add_u32 s45, s35, 0x5488000
    s_add_u32 s45, s45, s85
    buffer_store_dwordx4 v[32:35], v0, s[20:23], s45 offen sc1
    s_add_u32 s46, s98, 0x8800000
    v_lshlrev_b32 v40, 1, v1
    buffer_load_dwordx4 v[40:43], v40, s[8:11], s46 offen nt
    s_add_u32 s47, s98, 0x8800000
    v_lshlrev_b32 v24, 1, v1
    buffer_load_dwordx4 v[24:27], v24, s[12:15], s47 offen nt
    v_and_b32 v7, -4, v52
    v_lshl_add_u32 v8, v52, 2, v7
    ds_write_b32 v8, v48
    v_lshl_add_u32 v7, v7, 2, v52
    ds_write_b8 v7, v86 offset:16
    v_and_b32 v9, -4, v53
    v_lshl_add_u32 v10, v53, 2, v9
    ds_write_b32 v10, v49
    v_lshl_add_u32 v9, v9, 2, v53
    ds_write_b8_d16_hi v9, v86 offset:16
    v_and_b32 v7, -4, v54
    v_lshl_add_u32 v8, v54, 2, v7
    ds_write_b32 v8, v50
    v_lshl_add_u32 v7, v7, 2, v54
    ds_write_b8 v7, v87 offset:16
    v_and_b32 v9, -4, v55
    v_lshl_add_u32 v10, v55, 2, v9
    ds_write_b32 v10, v51
    v_lshl_add_u32 v9, v9, 2, v55
    ds_write_b8_d16_hi v9, v87 offset:16
    s_add_u32 s44, s98, 0x8800000
    s_lshr_b32 s44, s44, 1
    buffer_load_dwordx2 v[32:33], v1, s[16:19], s44 offen nt
    s_add_u32 s45, s99, 0x8c00000
    s_lshr_b32 s45, s45, 1
    buffer_load_dwordx2 v[34:35], v1, s[16:19], s45 offen nt
    s_add_u32 s46, s99, 0x8c00000
    v_lshlrev_b32 v48, 1, v1
    buffer_load_dwordx4 v[48:51], v48, s[8:11], s46 offen nt
    s_setprio 2
    v_and_b32 v7, -4, v72
    v_lshl_add_u32 v8, v72, 2, v7
    ds_write_b32 v8, v68
    v_lshl_add_u32 v7, v7, 2, v72
    ds_write_b8 v7, v56 offset:16
    v_and_b32 v9, -4, v73
    v_lshl_add_u32 v10, v73, 2, v9
    ds_write_b32 v10, v69
    v_lshl_add_u32 v9, v9, 2, v73
    ds_write_b8_d16_hi v9, v56 offset:16
    v_and_b32 v7, -4, v74
    v_lshl_add_u32 v8, v74, 2, v7
    ds_write_b32 v8, v70
    v_lshl_add_u32 v7, v7, 2, v74
    ds_write_b8 v7, v57 offset:16
    v_and_b32 v9, -4, v75
    v_lshl_add_u32 v10, v75, 2, v9
    ds_write_b32 v10, v71
    v_lshl_add_u32 v9, v9, 2, v75
    ds_write_b8_d16_hi v9, v57 offset:16
    s_add_u32 s47, s35, 0x5488000
    s_add_u32 s47, s47, s91
    buffer_store_dwordx4 v[36:39], v0, s[20:23], s47 offen sc1
    s_add_u32 s44, s99, 0x8c00000
    v_lshlrev_b32 v52, 1, v1
    buffer_load_dwordx4 v[52:55], v52, s[12:15], s44 offen nt
    v_and_b32 v7, -4, v80
    v_lshl_add_u32 v8, v80, 2, v7
    ds_write_b32 v8, v76
    v_lshl_add_u32 v7, v7, 2, v80
    ds_write_b8 v7, v58 offset:16
    v_and_b32 v9, -4, v81
    v_lshl_add_u32 v10, v81, 2, v9
    ds_write_b32 v10, v77
    v_lshl_add_u32 v9, v9, 2, v81
    ds_write_b8_d16_hi v9, v58 offset:16
    v_and_b32 v7, -4, v82
    v_lshl_add_u32 v8, v82, 2, v7
    ds_write_b32 v8, v78
    v_lshl_add_u32 v7, v7, 2, v82
    ds_write_b8 v7, v59 offset:16
    v_and_b32 v9, -4, v83
    v_lshl_add_u32 v10, v83, 2, v9
    ds_write_b32 v10, v79
    v_lshl_add_u32 v9, v9, 2, v83
    ds_write_b8_d16_hi v9, v59 offset:16
    s_add_u32 s45, s96, 0x9000000
    v_lshlrev_b32 v84, 1, v1
    buffer_load_dwordx4 v[84:87], v84, s[8:11], s45 offen nt
    s_add_u32 s46, s96, 0x9000000
    v_lshlrev_b32 v68, 1, v1
    buffer_load_dwordx4 v[68:71], v68, s[12:15], s46 offen nt
    s_setprio 1
    v_and_b32 v7, -4, v96
    v_lshl_add_u32 v8, v96, 2, v7
    ds_write_b32 v8, v64
    v_lshl_add_u32 v7, v7, 2, v96
    ds_write_b8 v7, v104 offset:16
    v_and_b32 v9, -4, v97
    v_lshl_add_u32 v10, v97, 2, v9
    ds_write_b32 v10, v65
    v_lshl_add_u32 v9, v9, 2, v97
    ds_write_b8_d16_hi v9, v104 offset:16
    v_and_b32 v7, -4, v98
    v_lshl_add_u32 v8, v98, 2, v7
    ds_write_b32 v8, v66
    v_lshl_add_u32 v7, v7, 2, v98
    ds_write_b8 v7, v105 offset:16
    v_and_b32 v9, -4, v99
    v_lshl_add_u32 v10, v99, 2, v9
    ds_write_b32 v10, v67
    v_lshl_add_u32 v9, v9, 2, v99
    ds_write_b8_d16_hi v9, v105 offset:16
    s_add_u32 s47, s96, 0x9000000
    s_lshr_b32 s47, s47, 1
    buffer_load_dwordx2 v[72:73], v1, s[16:19], s47 offen nt
    s_cmp_le_u32 s43, 5
    s_cselect_b32 s18, 0, s18
    s_add_u32 s44, s59, 0x4a00000
    buffer_load_dwordx2 v[74:75], v1, s[16:19], s44 offen nt
    s_cmp_le_u32 s43, 5
    s_cselect_b32 s10, 0, s10
    s_add_u32 s45, s58, 0x9400000
    v_lshlrev_b32 v36, 1, v1
    buffer_load_dwordx4 v[36:39], v36, s[8:11], s45 offen nt
    v_and_b32 v7, -4, v100
    v_lshl_add_u32 v8, v100, 2, v7
    ds_write_b32 v8, v60
    v_lshl_add_u32 v7, v7, 2, v100
    ds_write_b8 v7, v106 offset:16
    v_and_b32 v9, -4, v101
    v_lshl_add_u32 v10, v101, 2, v9
    ds_write_b32 v10, v61
    v_lshl_add_u32 v9, v9, 2, v101
    ds_write_b8_d16_hi v9, v106 offset:16
    v_and_b32 v7, -4, v102
    v_lshl_add_u32 v8, v102, 2, v7
    ds_write_b32 v8, v62
    v_lshl_add_u32 v7, v7, 2, v102
    ds_write_b8 v7, v107 offset:16
    v_and_b32 v9, -4, v103
    v_lshl_add_u32 v10, v103, 2, v9
    ds_write_b32 v10, v63
    v_lshl_add_u32 v9, v9, 2, v103
    ds_write_b8_d16_hi v9, v107 offset:16
    s_add_u32 s46, s35, 0x5488000
    s_add_u32 s46, s46, s93
    buffer_store_dwordx4 v[28:31], v0, s[20:23], s46 offen sc1
    s_cmp_le_u32 s43, 5
    s_cselect_b32 s14, 0, s14
    s_add_u32 s47, s58, 0x9400000
    v_lshlrev_b32 v76, 1, v1
    buffer_load_dwordx4 v[76:79], v76, s[12:15], s47 offen nt
    s_setprio 0
    v_and_b32 v7, -4, v88
    v_lshl_add_u32 v8, v88, 2, v7
    ds_write_b32 v8, v112
    v_lshl_add_u32 v7, v7, 2, v88
    ds_write_b8 v7, v108 offset:16
    v_and_b32 v9, -4, v89
    v_lshl_add_u32 v10, v89, 2, v9
    ds_write_b32 v10, v113
    v_lshl_add_u32 v9, v9, 2, v89
    ds_write_b8_d16_hi v9, v108 offset:16
    v_and_b32 v7, -4, v90
    v_lshl_add_u32 v8, v90, 2, v7
    ds_write_b32 v8, v114
    v_lshl_add_u32 v7, v7, 2, v90
    ds_write_b8 v7, v109 offset:16
    v_and_b32 v9, -4, v91
    v_lshl_add_u32 v10, v91, 2, v9
    ds_write_b32 v10, v115
    v_lshl_add_u32 v9, v9, 2, v91
    ds_write_b8_d16_hi v9, v109 offset:16
    s_cmp_le_u32 s43, 6
    s_cselect_b32 s10, 0, s10
    s_add_u32 s44, s58, 0x97c0000
    v_lshlrev_b32 v80, 1, v1
    buffer_load_dwordx4 v[80:83], v80, s[8:11], s44 offen nt
    s_cmp_le_u32 s43, 6
    s_cselect_b32 s14, 0, s14
    s_add_u32 s45, s58, 0x97c0000
    v_lshlrev_b32 v56, 1, v1
    buffer_load_dwordx4 v[56:59], v56, s[12:15], s45 offen nt
    v_and_b32 v7, -4, v92
    v_lshl_add_u32 v8, v92, 2, v7
    ds_write_b32 v8, v116
    v_lshl_add_u32 v7, v7, 2, v92
    ds_write_b8 v7, v110 offset:16
    v_and_b32 v9, -4, v93
    v_lshl_add_u32 v10, v93, 2, v9
    ds_write_b32 v10, v117
    v_lshl_add_u32 v9, v9, 2, v93
    ds_write_b8_d16_hi v9, v110 offset:16
    v_and_b32 v7, -4, v94
    v_lshl_add_u32 v8, v94, 2, v7
    ds_write_b32 v8, v118
    v_lshl_add_u32 v7, v7, 2, v94
    ds_write_b8 v7, v111 offset:16
    v_and_b32 v9, -4, v95
    v_lshl_add_u32 v10, v95, 2, v9
    ds_write_b32 v10, v119
    v_lshl_add_u32 v9, v9, 2, v95
    ds_write_b8_d16_hi v9, v111 offset:16
    s_cmp_le_u32 s43, 6
    s_cselect_b32 s18, 0, s18
    s_add_u32 s46, s59, 0x4be0000
    buffer_load_dwordx2 v[64:65], v1, s[16:19], s46 offen nt
    s_cmp_le_u32 s43, 7
    s_cselect_b32 s18, 0, s18
    s_add_u32 s47, s59, 0x4d90000
    buffer_load_dwordx2 v[66:67], v1, s[16:19], s47 offen nt
    v_add_u32 v7, s72, v0
    v_add_u32 v12, s73, v0
    v_add_u32 v13, s85, v0
    v_add_u32 v14, s91, v0
    v_add_u32 v15, s93, v0
    s_min_i32 s3, s72, s73
    s_min_i32 s3, s3, s85
    s_min_i32 s3, s3, s91
    s_min_i32 s3, s3, s93
    v_add_u32 v3, s3, v0
    v_mov_b32 v8, 0
    v_mov_b32 v9, 0
    v_mov_b32 v10, 0
    v_mov_b32 v11, 0
    s_waitcnt lgkmcnt(0)
    s_barrier
    ds_read_b128 v[96:99], v7 offset:0
    ds_read_b128 v[60:63], v12 offset:0
    ds_read_b128 v[100:103], v13 offset:0
    ds_read_b128 v[104:107], v14 offset:0
    ds_read_b128 v[28:31], v15 offset:0
    ds_write_b128 v3, v[8:11]
    ds_read_b128 v[112:115], v7 offset:16384
    ds_read_b128 v[88:91], v12 offset:16384
    ds_read_b128 v[116:119], v13 offset:16384
    ds_read_b128 v[92:95], v14 offset:16384
    ds_read_b128 v[108:111], v15 offset:16384
    s_waitcnt lgkmcnt(0)
    s_barrier
    v_lshlrev_b32 v3, 3, v0
    v_and_b32 v3, 0x80, v3
    s_cmp_lg_u32 s32, 15
    s_cbranch_scc1 L2_k0
    s_mov_b64 exec, 3
    buffer_load_dword v3, v3, s[68:71], 0 offen sc1
    s_mov_b64 exec, -1
L2_k0:
    s_add_u32 s44, s35, 0x7ec4000
    s_add_u32 s44, s44, s72
    buffer_store_dwordx4 v[96:99], v0, s[20:23], s44 offen sc1
    s_cmp_le_u32 s43, 7
    s_cselect_b32 s10, 0, s10
    s_add_u32 s45, s58, 0x9b20000
    v_lshlrev_b32 v96, 1, v1
    buffer_load_dwordx4 v[96:99], v96, s[8:11], s45 offen nt
    s_add_u32 s46, s35, 0x7ec4000
    s_add_u32 s46, s46, s73
    buffer_store_dwordx4 v[60:63], v0, s[20:23], s46 offen sc1
    s_cmp_le_u32 s43, 7
    s_cselect_b32 s14, 0, s14
    s_add_u32 s47, s58, 0x9b20000
    v_lshlrev_b32 v60, 1, v1
    buffer_load_dwordx4 v[60:63], v60, s[12:15], s47 offen nt
    s_setprio 3
    s_waitcnt vmcnt(27)
    v_lshlrev_b32 v7, 16, v44
    v_and_b32 v8, 0xffff0000, v44
    v_lshlrev_b32 v9, 16, v45
    v_and_b32 v10, 0xffff0000, v45
    v_mul_f32 v7, 0.15915494, v7
    v_mul_f32 v8, 0.15915494, v8
    v_mul_f32 v9, 0.15915494, v9
    v_mul_f32 v10, 0.15915494, v10
    v_mul_hi_u32_u24 v14, 429497, v16
    v_lshrrev_b32 v12, 3, v120
    v_cos_f32 v7, v7
    v_lshlrev_b16 v13, 3, v120
    v_mad_i32_i24 v11, v14, s55, v16
    v_bitop3_b32 v12, v6, v13, v12 bitop3:0xca
    v_lshl_add_u32 v11, v11, 17, s40
    v_lshlrev_b16 v14, 8, v14
    v_lshrrev_b32 v13, 2, v120
    v_add_u32 v16, v12, v11
    v_bitop3_b32 v120, v5, v13, v14 bitop3:0xea
    ds_add_u32 v120, v2
    v_mul_hi_u32_u24 v14, 429497, v17
    v_lshrrev_b32 v12, 3, v121
    v_cos_f32 v8, v8
    v_lshlrev_b16 v13, 3, v121
    v_mad_i32_i24 v11, v14, s55, v17
    v_bitop3_b32 v12, v6, v13, v12 bitop3:0xca
    v_lshl_add_u32 v11, v11, 17, s40
    v_lshlrev_b16 v14, 8, v14
    v_lshrrev_b32 v13, 2, v121
    v_add_u32 v17, v12, v11
    v_bitop3_b32 v121, v5, v13, v14 bitop3:0xea
    ds_add_u32 v121, v2
    v_cvt_pk_bf16_f32 v44, v7, v8
    v_perm_b32 v12, v44, v44, s41
    v_bitop3_b32 v16, v4, v12, v16 bitop3:0xca
    v_perm_b32 v13, v44, v44, s42
    v_bitop3_b32 v17, v4, v13, v17 bitop3:0xca
    v_mul_hi_u32_u24 v14, 429497, v18
    v_lshrrev_b32 v12, 3, v122
    v_cos_f32 v9, v9
    v_lshlrev_b16 v13, 3, v122
    v_mad_i32_i24 v11, v14, s55, v18
    v_bitop3_b32 v12, v6, v13, v12 bitop3:0xca
    v_lshl_add_u32 v11, v11, 17, s40
    v_lshlrev_b16 v14, 8, v14
    v_lshrrev_b32 v13, 2, v122
    v_add_u32 v18, v12, v11
    v_bitop3_b32 v122, v5, v13, v14 bitop3:0xea
    ds_add_u32 v122, v2
    v_mul_hi_u32_u24 v14, 429497, v19
    v_lshrrev_b32 v12, 3, v123
    v_cos_f32 v10, v10
    v_lshlrev_b16 v13, 3, v123
    v_mad_i32_i24 v11, v14, s55, v19
    v_bitop3_b32 v12, v6, v13, v12 bitop3:0xca
    v_lshl_add_u32 v11, v11, 17, s40
    v_lshlrev_b16 v14, 8, v14
    v_lshrrev_b32 v13, 2, v123
    v_add_u32 v19, v12, v11
    v_bitop3_b32 v123, v5, v13, v14 bitop3:0xea
    ds_add_u32 v123, v2
    v_cvt_pk_bf16_f32 v45, v9, v10
    v_perm_b32 v12, v45, v45, s41
    v_bitop3_b32 v18, v4, v12, v18 bitop3:0xca
    v_perm_b32 v13, v45, v45, s42
    v_bitop3_b32 v19, v4, v13, v19 bitop3:0xca
    s_waitcnt vmcnt(23)
    v_lshlrev_b32 v7, 16, v46
    v_and_b32 v8, 0xffff0000, v46
    v_lshlrev_b32 v9, 16, v47
    v_and_b32 v10, 0xffff0000, v47
    v_mul_f32 v7, 0.15915494, v7
    v_mul_f32 v8, 0.15915494, v8
    v_mul_f32 v9, 0.15915494, v9
    v_mul_f32 v10, 0.15915494, v10
    v_mul_hi_u32_u24 v14, 429497, v20
    v_lshrrev_b32 v12, 3, v124
    v_cos_f32 v7, v7
    v_lshlrev_b16 v13, 3, v124
    v_mad_i32_i24 v11, v14, s55, v20
    v_bitop3_b32 v12, v6, v13, v12 bitop3:0xca
    v_lshl_add_u32 v11, v11, 17, s40
    v_lshlrev_b16 v14, 8, v14
    v_lshrrev_b32 v13, 2, v124
    v_add_u32 v20, v12, v11
    v_bitop3_b32 v124, v5, v13, v14 bitop3:0xea
    ds_add_u32 v124, v2
    v_mul_hi_u32_u24 v14, 429497, v21
    v_lshrrev_b32 v12, 3, v125
    v_cos_f32 v8, v8
    v_lshlrev_b16 v13, 3, v125
    v_mad_i32_i24 v11, v14, s55, v21
    v_bitop3_b32 v12, v6, v13, v12 bitop3:0xca
    v_lshl_add_u32 v11, v11, 17, s40
    v_lshlrev_b16 v14, 8, v14
    v_lshrrev_b32 v13, 2, v125
    v_add_u32 v21, v12, v11
    v_bitop3_b32 v125, v5, v13, v14 bitop3:0xea
    ds_add_u32 v125, v2
    v_cvt_pk_bf16_f32 v46, v7, v8
    v_perm_b32 v12, v46, v46, s41
    v_bitop3_b32 v20, v4, v12, v20 bitop3:0xca
    v_perm_b32 v13, v46, v46, s42
    v_bitop3_b32 v21, v4, v13, v21 bitop3:0xca
    v_mul_hi_u32_u24 v14, 429497, v22
    v_lshrrev_b32 v12, 3, v126
    v_cos_f32 v9, v9
    v_lshlrev_b16 v13, 3, v126
    v_mad_i32_i24 v11, v14, s55, v22
    v_bitop3_b32 v12, v6, v13, v12 bitop3:0xca
    v_lshl_add_u32 v11, v11, 17, s40
    v_lshlrev_b16 v14, 8, v14
    v_lshrrev_b32 v13, 2, v126
    v_add_u32 v22, v12, v11
    v_bitop3_b32 v126, v5, v13, v14 bitop3:0xea
    ds_add_u32 v126, v2
    v_mul_hi_u32_u24 v14, 429497, v23
    v_lshrrev_b32 v12, 3, v127
    v_cos_f32 v10, v10
    v_lshlrev_b16 v13, 3, v127
    v_mad_i32_i24 v11, v14, s55, v23
    v_bitop3_b32 v12, v6, v13, v12 bitop3:0xca
    v_lshl_add_u32 v11, v11, 17, s40
    v_lshlrev_b16 v14, 8, v14
    v_lshrrev_b32 v13, 2, v127
    v_add_u32 v23, v12, v11
    v_bitop3_b32 v127, v5, v13, v14 bitop3:0xea
    ds_add_u32 v127, v2
    v_cvt_pk_bf16_f32 v47, v9, v10
    v_perm_b32 v12, v47, v47, s41
    v_bitop3_b32 v22, v4, v12, v22 bitop3:0xca
    v_perm_b32 v13, v47, v47, s42
    v_bitop3_b32 v23, v4, v13, v23 bitop3:0xca
    s_setprio 2
    s_add_u32 s44, s35, 0x7ec4000
    s_add_u32 s44, s44, s85
    buffer_store_dwordx4 v[100:103], v0, s[20:23], s44 offen sc1
    s_waitcnt vmcnt(19)
    v_lshlrev_b32 v7, 16, v32
    v_and_b32 v8, 0xffff0000, v32
    v_lshlrev_b32 v9, 16, v33
    v_and_b32 v10, 0xffff0000, v33
    v_mul_f32 v7, 0.15915494, v7
    v_mul_f32 v8, 0.15915494, v8
    v_mul_f32 v9, 0.15915494, v9
    v_mul_f32 v10, 0.15915494, v10
    v_mul_hi_u32_u24 v14, 429497, v40
    v_lshrrev_b32 v12, 3, v24
    v_cos_f32 v7, v7
    v_lshlrev_b16 v13, 3, v24
    v_mad_i32_i24 v11, v14, s55, v40
    v_bitop3_b32 v12, v6, v13, v12 bitop3:0xca
    v_lshl_add_u32 v11, v11, 17, s40
    v_lshlrev_b16 v14, 8, v14
    v_lshrrev_b32 v13, 2, v24
    v_add_u32 v40, v12, v11
    v_bitop3_b32 v24, v5, v13, v14 bitop3:0xea
    ds_add_u32 v24, v2
    v_mul_hi_u32_u24 v14, 429497, v41
    v_lshrrev_b32 v12, 3, v25
    v_cos_f32 v8, v8
    v_lshlrev_b16 v13, 3, v25
    v_mad_i32_i24 v11, v14, s55, v41
    v_bitop3_b32 v12, v6, v13, v12 bitop3:0xca
    v_lshl_add_u32 v11, v11, 17, s40
    v_lshlrev_b16 v14, 8, v14
    v_lshrrev_b32 v13, 2, v25
    v_add_u32 v41, v12, v11
    v_bitop3_b32 v25, v5, v13, v14 bitop3:0xea
    ds_add_u32 v25, v2
    v_cvt_pk_bf16_f32 v32, v7, v8
    v_perm_b32 v12, v32, v32, s41
    v_bitop3_b32 v40, v4, v12, v40 bitop3:0xca
    v_perm_b32 v13, v32, v32, s42
    v_bitop3_b32 v41, v4, v13, v41 bitop3:0xca
    v_mul_hi_u32_u24 v14, 429497, v42
    v_lshrrev_b32 v12, 3, v26
    v_cos_f32 v9, v9
    v_lshlrev_b16 v13, 3, v26
    v_mad_i32_i24 v11, v14, s55, v42
    v_bitop3_b32 v12, v6, v13, v12 bitop3:0xca
    v_lshl_add_u32 v11, v11, 17, s40
    v_lshlrev_b16 v14, 8, v14
    v_lshrrev_b32 v13, 2, v26
    v_add_u32 v42, v12, v11
    v_bitop3_b32 v26, v5, v13, v14 bitop3:0xea
    ds_add_u32 v26, v2
    v_mul_hi_u32_u24 v14, 429497, v43
    v_lshrrev_b32 v12, 3, v27
    v_cos_f32 v10, v10
    v_lshlrev_b16 v13, 3, v27
    v_mad_i32_i24 v11, v14, s55, v43
    v_bitop3_b32 v12, v6, v13, v12 bitop3:0xca
    v_lshl_add_u32 v11, v11, 17, s40
    v_lshlrev_b16 v14, 8, v14
    v_lshrrev_b32 v13, 2, v27
    v_add_u32 v43, v12, v11
    v_bitop3_b32 v27, v5, v13, v14 bitop3:0xea
    ds_add_u32 v27, v2
    v_cvt_pk_bf16_f32 v33, v9, v10
    v_perm_b32 v12, v33, v33, s41
    v_bitop3_b32 v42, v4, v12, v42 bitop3:0xca
    v_perm_b32 v13, v33, v33, s42
    v_bitop3_b32 v43, v4, v13, v43 bitop3:0xca
    s_waitcnt vmcnt(16)
    v_lshlrev_b32 v7, 16, v34
    v_and_b32 v8, 0xffff0000, v34
    v_lshlrev_b32 v9, 16, v35
    v_and_b32 v10, 0xffff0000, v35
    v_mul_f32 v7, 0.15915494, v7
    v_mul_f32 v8, 0.15915494, v8
    v_mul_f32 v9, 0.15915494, v9
    v_mul_f32 v10, 0.15915494, v10
    v_mul_hi_u32_u24 v14, 429497, v48
    v_lshrrev_b32 v12, 3, v52
    v_cos_f32 v7, v7
    v_lshlrev_b16 v13, 3, v52
    v_mad_i32_i24 v11, v14, s55, v48
    v_bitop3_b32 v12, v6, v13, v12 bitop3:0xca
    v_lshl_add_u32 v11, v11, 17, s40
    v_lshlrev_b16 v14, 8, v14
    v_lshrrev_b32 v13, 2, v52
    v_add_u32 v48, v12, v11
    v_bitop3_b32 v52, v5, v13, v14 bitop3:0xea
    ds_add_u32 v52, v2
    v_mul_hi_u32_u24 v14, 429497, v49
    v_lshrrev_b32 v12, 3, v53
    v_cos_f32 v8, v8
    v_lshlrev_b16 v13, 3, v53
    v_mad_i32_i24 v11, v14, s55, v49
    v_bitop3_b32 v12, v6, v13, v12 bitop3:0xca
    v_lshl_add_u32 v11, v11, 17, s40
    v_lshlrev_b16 v14, 8, v14
    v_lshrrev_b32 v13, 2, v53
    v_add_u32 v49, v12, v11
    v_bitop3_b32 v53, v5, v13, v14 bitop3:0xea
    ds_add_u32 v53, v2
    v_cvt_pk_bf16_f32 v34, v7, v8
    v_perm_b32 v12, v34, v34, s41
    v_bitop3_b32 v48, v4, v12, v48 bitop3:0xca
    v_perm_b32 v13, v34, v34, s42
    v_bitop3_b32 v49, v4, v13, v49 bitop3:0xca
    v_mul_hi_u32_u24 v14, 429497, v50
    v_lshrrev_b32 v12, 3, v54
    v_cos_f32 v9, v9
    v_lshlrev_b16 v13, 3, v54
    v_mad_i32_i24 v11, v14, s55, v50
    v_bitop3_b32 v12, v6, v13, v12 bitop3:0xca
    v_lshl_add_u32 v11, v11, 17, s40
    v_lshlrev_b16 v14, 8, v14
    v_lshrrev_b32 v13, 2, v54
    v_add_u32 v50, v12, v11
    v_bitop3_b32 v54, v5, v13, v14 bitop3:0xea
    ds_add_u32 v54, v2
    v_mul_hi_u32_u24 v14, 429497, v51
    v_lshrrev_b32 v12, 3, v55
    v_cos_f32 v10, v10
    v_lshlrev_b16 v13, 3, v55
    v_mad_i32_i24 v11, v14, s55, v51
    v_bitop3_b32 v12, v6, v13, v12 bitop3:0xca
    v_lshl_add_u32 v11, v11, 17, s40
    v_lshlrev_b16 v14, 8, v14
    v_lshrrev_b32 v13, 2, v55
    v_add_u32 v51, v12, v11
    v_bitop3_b32 v55, v5, v13, v14 bitop3:0xea
    ds_add_u32 v55, v2
    v_cvt_pk_bf16_f32 v35, v9, v10
    v_perm_b32 v12, v35, v35, s41
    v_bitop3_b32 v50, v4, v12, v50 bitop3:0xca
    v_perm_b32 v13, v35, v35, s42
    v_bitop3_b32 v51, v4, v13, v51 bitop3:0xca
    s_setprio 1
    s_waitcnt vmcnt(12)
    v_lshlrev_b32 v7, 16, v72
    v_and_b32 v8, 0xffff0000, v72
    v_lshlrev_b32 v9, 16, v73
    v_and_b32 v10, 0xffff0000, v73
    v_mul_f32 v7, 0.15915494, v7
    v_mul_f32 v8, 0.15915494, v8
    v_mul_f32 v9, 0.15915494, v9
    v_mul_f32 v10, 0.15915494, v10
    v_mul_hi_u32_u24 v14, 429497, v84
    v_lshrrev_b32 v12, 3, v68
    v_cos_f32 v7, v7
    v_lshlrev_b16 v13, 3, v68
    v_mad_i32_i24 v11, v14, s55, v84
    v_bitop3_b32 v12, v6, v13, v12 bitop3:0xca
    v_lshl_add_u32 v11, v11, 17, s40
    v_lshlrev_b16 v14, 8, v14
    v_lshrrev_b32 v13, 2, v68
    v_add_u32 v84, v12, v11
    v_bitop3_b32 v68, v5, v13, v14 bitop3:0xea
    ds_add_u32 v68, v2
    v_mul_hi_u32_u24 v14, 429497, v85
    v_lshrrev_b32 v12, 3, v69
    v_cos_f32 v8, v8
    v_lshlrev_b16 v13, 3, v69
    v_mad_i32_i24 v11, v14, s55, v85
    v_bitop3_b32 v12, v6, v13, v12 bitop3:0xca
    v_lshl_add_u32 v11, v11, 17, s40
    v_lshlrev_b16 v14, 8, v14
    v_lshrrev_b32 v13, 2, v69
    v_add_u32 v85, v12, v11
    v_bitop3_b32 v69, v5, v13, v14 bitop3:0xea
    ds_add_u32 v69, v2
    v_cvt_pk_bf16_f32 v72, v7, v8
    v_perm_b32 v12, v72, v72, s41
    v_bitop3_b32 v84, v4, v12, v84 bitop3:0xca
    v_perm_b32 v13, v72, v72, s42
    v_bitop3_b32 v85, v4, v13, v85 bitop3:0xca
    v_mul_hi_u32_u24 v14, 429497, v86
    v_lshrrev_b32 v12, 3, v70
    v_cos_f32 v9, v9
    v_lshlrev_b16 v13, 3, v70
    v_mad_i32_i24 v11, v14, s55, v86
    v_bitop3_b32 v12, v6, v13, v12 bitop3:0xca
    v_lshl_add_u32 v11, v11, 17, s40
    v_lshlrev_b16 v14, 8, v14
    v_lshrrev_b32 v13, 2, v70
    v_add_u32 v86, v12, v11
    v_bitop3_b32 v70, v5, v13, v14 bitop3:0xea
    ds_add_u32 v70, v2
    v_mul_hi_u32_u24 v14, 429497, v87
    v_lshrrev_b32 v12, 3, v71
    v_cos_f32 v10, v10
    v_lshlrev_b16 v13, 3, v71
    v_mad_i32_i24 v11, v14, s55, v87
    v_bitop3_b32 v12, v6, v13, v12 bitop3:0xca
    v_lshl_add_u32 v11, v11, 17, s40
    v_lshlrev_b16 v14, 8, v14
    v_lshrrev_b32 v13, 2, v71
    v_add_u32 v87, v12, v11
    v_bitop3_b32 v71, v5, v13, v14 bitop3:0xea
    ds_add_u32 v71, v2
    v_cvt_pk_bf16_f32 v73, v9, v10
    v_perm_b32 v12, v73, v73, s41
    v_bitop3_b32 v86, v4, v12, v86 bitop3:0xca
    v_perm_b32 v13, v73, v73, s42
    v_bitop3_b32 v87, v4, v13, v87 bitop3:0xca
    s_add_u32 s45, s35, 0x7ec4000
    s_add_u32 s45, s45, s91
    buffer_store_dwordx4 v[104:107], v0, s[20:23], s45 offen sc1
    s_waitcnt vmcnt(10)
    s_cmp_le_u32 s43, 5
    s_cbranch_scc1 L1_s5
    v_lshlrev_b32 v7, 16, v74
    v_and_b32 v8, 0xffff0000, v74
    v_lshlrev_b32 v9, 16, v75
    v_and_b32 v10, 0xffff0000, v75
    v_mul_f32 v7, 0.15915494, v7
    v_mul_f32 v8, 0.15915494, v8
    v_mul_f32 v9, 0.15915494, v9
    v_mul_f32 v10, 0.15915494, v10
    v_mul_hi_u32_u24 v14, 429497, v36
    v_lshrrev_b32 v12, 3, v76
    v_cos_f32 v7, v7
    v_lshlrev_b16 v13, 3, v76
    v_mad_i32_i24 v11, v14, s55, v36
    v_bitop3_b32 v12, v6, v13, v12 bitop3:0xca
    v_lshl_add_u32 v11, v11, 17, s40
    v_lshlrev_b16 v14, 8, v14
    v_lshrrev_b32 v13, 2, v76
    v_add_u32 v36, v12, v11
    v_bitop3_b32 v76, v5, v13, v14 bitop3:0xea
    ds_add_u32 v76, v2
    v_mul_hi_u32_u24 v14, 429497, v37
    v_lshrrev_b32 v12, 3, v77
    v_cos_f32 v8, v8
    v_lshlrev_b16 v13, 3, v77
    v_mad_i32_i24 v11, v14, s55, v37
    v_bitop3_b32 v12, v6, v13, v12 bitop3:0xca
    v_lshl_add_u32 v11, v11, 17, s40
    v_lshlrev_b16 v14, 8, v14
    v_lshrrev_b32 v13, 2, v77
    v_add_u32 v37, v12, v11
    v_bitop3_b32 v77, v5, v13, v14 bitop3:0xea
    ds_add_u32 v77, v2
    v_cvt_pk_bf16_f32 v74, v7, v8
    v_perm_b32 v12, v74, v74, s41
    v_bitop3_b32 v36, v4, v12, v36 bitop3:0xca
    v_perm_b32 v13, v74, v74, s42
    v_bitop3_b32 v37, v4, v13, v37 bitop3:0xca
    v_mul_hi_u32_u24 v14, 429497, v38
    v_lshrrev_b32 v12, 3, v78
    v_cos_f32 v9, v9
    v_lshlrev_b16 v13, 3, v78
    v_mad_i32_i24 v11, v14, s55, v38
    v_bitop3_b32 v12, v6, v13, v12 bitop3:0xca
    v_lshl_add_u32 v11, v11, 17, s40
    v_lshlrev_b16 v14, 8, v14
    v_lshrrev_b32 v13, 2, v78
    v_add_u32 v38, v12, v11
    v_bitop3_b32 v78, v5, v13, v14 bitop3:0xea
    ds_add_u32 v78, v2
    v_mul_hi_u32_u24 v14, 429497, v39
    v_lshrrev_b32 v12, 3, v79
    v_cos_f32 v10, v10
    v_lshlrev_b16 v13, 3, v79
    v_mad_i32_i24 v11, v14, s55, v39
    v_bitop3_b32 v12, v6, v13, v12 bitop3:0xca
    v_lshl_add_u32 v11, v11, 17, s40
    v_lshlrev_b16 v14, 8, v14
    v_lshrrev_b32 v13, 2, v79
    v_add_u32 v39, v12, v11
    v_bitop3_b32 v79, v5, v13, v14 bitop3:0xea
    ds_add_u32 v79, v2
    v_cvt_pk_bf16_f32 v75, v9, v10
    v_perm_b32 v12, v75, v75, s41
    v_bitop3_b32 v38, v4, v12, v38 bitop3:0xca
    v_perm_b32 v13, v75, v75, s42
    v_bitop3_b32 v39, v4, v13, v39 bitop3:0xca
L1_s5:
    s_setprio 0
    s_waitcnt vmcnt(6)
    s_cmp_le_u32 s43, 6
    s_cbranch_scc1 L1_s6
    v_lshlrev_b32 v7, 16, v64
    v_and_b32 v8, 0xffff0000, v64
    v_lshlrev_b32 v9, 16, v65
    v_and_b32 v10, 0xffff0000, v65
    v_mul_f32 v7, 0.15915494, v7
    v_mul_f32 v8, 0.15915494, v8
    v_mul_f32 v9, 0.15915494, v9
    v_mul_f32 v10, 0.15915494, v10
    v_mul_hi_u32_u24 v14, 429497, v80
    v_lshrrev_b32 v12, 3, v56
    v_cos_f32 v7, v7
    v_lshlrev_b16 v13, 3, v56
    v_mad_i32_i24 v11, v14, s55, v80
    v_bitop3_b32 v12, v6, v13, v12 bitop3:0xca
    v_lshl_add_u32 v11, v11, 17, s40
    v_lshlrev_b16 v14, 8, v14
    v_lshrrev_b32 v13, 2, v56
    v_add_u32 v80, v12, v11
    v_bitop3_b32 v56, v5, v13, v14 bitop3:0xea
    ds_add_u32 v56, v2
    v_mul_hi_u32_u24 v14, 429497, v81
    v_lshrrev_b32 v12, 3, v57
    v_cos_f32 v8, v8
    v_lshlrev_b16 v13, 3, v57
    v_mad_i32_i24 v11, v14, s55, v81
    v_bitop3_b32 v12, v6, v13, v12 bitop3:0xca
    v_lshl_add_u32 v11, v11, 17, s40
    v_lshlrev_b16 v14, 8, v14
    v_lshrrev_b32 v13, 2, v57
    v_add_u32 v81, v12, v11
    v_bitop3_b32 v57, v5, v13, v14 bitop3:0xea
    ds_add_u32 v57, v2
    v_cvt_pk_bf16_f32 v64, v7, v8
    v_perm_b32 v12, v64, v64, s41
    v_bitop3_b32 v80, v4, v12, v80 bitop3:0xca
    v_perm_b32 v13, v64, v64, s42
    v_bitop3_b32 v81, v4, v13, v81 bitop3:0xca
    v_mul_hi_u32_u24 v14, 429497, v82
    v_lshrrev_b32 v12, 3, v58
    v_cos_f32 v9, v9
    v_lshlrev_b16 v13, 3, v58
    v_mad_i32_i24 v11, v14, s55, v82
    v_bitop3_b32 v12, v6, v13, v12 bitop3:0xca
    v_lshl_add_u32 v11, v11, 17, s40
    v_lshlrev_b16 v14, 8, v14
    v_lshrrev_b32 v13, 2, v58
    v_add_u32 v82, v12, v11
    v_bitop3_b32 v58, v5, v13, v14 bitop3:0xea
    ds_add_u32 v58, v2
    v_mul_hi_u32_u24 v14, 429497, v83
    v_lshrrev_b32 v12, 3, v59
    v_cos_f32 v10, v10
    v_lshlrev_b16 v13, 3, v59
    v_mad_i32_i24 v11, v14, s55, v83
    v_bitop3_b32 v12, v6, v13, v12 bitop3:0xca
    v_lshl_add_u32 v11, v11, 17, s40
    v_lshlrev_b16 v14, 8, v14
    v_lshrrev_b32 v13, 2, v59
    v_add_u32 v83, v12, v11
    v_bitop3_b32 v59, v5, v13, v14 bitop3:0xea
    ds_add_u32 v59, v2
    v_cvt_pk_bf16_f32 v65, v9, v10
    v_perm_b32 v12, v65, v65, s41
    v_bitop3_b32 v82, v4, v12, v82 bitop3:0xca
    v_perm_b32 v13, v65, v65, s42
    v_bitop3_b32 v83, v4, v13, v83 bitop3:0xca
L1_s6:
    s_waitcnt vmcnt(2)
    s_cmp_le_u32 s43, 7
    s_cbranch_scc1 L1_s7
    v_lshlrev_b32 v7, 16, v66
    v_and_b32 v8, 0xffff0000, v66
    v_lshlrev_b32 v9, 16, v67
    v_and_b32 v10, 0xffff0000, v67
    v_mul_f32 v7, 0.15915494, v7
    v_mul_f32 v8, 0.15915494, v8
    v_mul_f32 v9, 0.15915494, v9
    v_mul_f32 v10, 0.15915494, v10
    v_mul_hi_u32_u24 v14, 429497, v96
    v_lshrrev_b32 v12, 3, v60
    v_cos_f32 v7, v7
    v_lshlrev_b16 v13, 3, v60
    v_mad_i32_i24 v11, v14, s55, v96
    v_bitop3_b32 v12, v6, v13, v12 bitop3:0xca
    v_lshl_add_u32 v11, v11, 17, s40
    v_lshlrev_b16 v14, 8, v14
    v_lshrrev_b32 v13, 2, v60
    v_add_u32 v96, v12, v11
    v_bitop3_b32 v60, v5, v13, v14 bitop3:0xea
    ds_add_u32 v60, v2
    v_mul_hi_u32_u24 v14, 429497, v97
    v_lshrrev_b32 v12, 3, v61
    v_cos_f32 v8, v8
    v_lshlrev_b16 v13, 3, v61
    v_mad_i32_i24 v11, v14, s55, v97
    v_bitop3_b32 v12, v6, v13, v12 bitop3:0xca
    v_lshl_add_u32 v11, v11, 17, s40
    v_lshlrev_b16 v14, 8, v14
    v_lshrrev_b32 v13, 2, v61
    v_add_u32 v97, v12, v11
    v_bitop3_b32 v61, v5, v13, v14 bitop3:0xea
    ds_add_u32 v61, v2
    v_cvt_pk_bf16_f32 v66, v7, v8
    v_perm_b32 v12, v66, v66, s41
    v_bitop3_b32 v96, v4, v12, v96 bitop3:0xca
    v_perm_b32 v13, v66, v66, s42
    v_bitop3_b32 v97, v4, v13, v97 bitop3:0xca
    v_mul_hi_u32_u24 v14, 429497, v98
    v_lshrrev_b32 v12, 3, v62
    v_cos_f32 v9, v9
    v_lshlrev_b16 v13, 3, v62
    v_mad_i32_i24 v11, v14, s55, v98
    v_bitop3_b32 v12, v6, v13, v12 bitop3:0xca
    v_lshl_add_u32 v11, v11, 17, s40
    v_lshlrev_b16 v14, 8, v14
    v_lshrrev_b32 v13, 2, v62
    v_add_u32 v98, v12, v11
    v_bitop3_b32 v62, v5, v13, v14 bitop3:0xea
    ds_add_u32 v62, v2
    v_mul_hi_u32_u24 v14, 429497, v99
    v_lshrrev_b32 v12, 3, v63
    v_cos_f32 v10, v10
    v_lshlrev_b16 v13, 3, v63
    v_mad_i32_i24 v11, v14, s55, v99
    v_bitop3_b32 v12, v6, v13, v12 bitop3:0xca
    v_lshl_add_u32 v11, v11, 17, s40
    v_lshlrev_b16 v14, 8, v14
    v_lshrrev_b32 v13, 2, v63
    v_add_u32 v99, v12, v11
    v_bitop3_b32 v63, v5, v13, v14 bitop3:0xea
    ds_add_u32 v63, v2
    v_cvt_pk_bf16_f32 v67, v9, v10
    v_perm_b32 v12, v67, v67, s41
    v_bitop3_b32 v98, v4, v12, v98 bitop3:0xca
    v_perm_b32 v13, v67, v67, s42
    v_bitop3_b32 v99, v4, v13, v99 bitop3:0xca
L1_s7:
    v_lshrrev_b32 v8, 2, v0
    v_and_b32 v7, 0x3c00, v0
    v_bitop3_b32 v7, v5, v8, v7 bitop3:0xea
    s_waitcnt lgkmcnt(0)
    s_barrier
    ds_read2st64_b32 v[8:9], v7 offset0:0 offset1:1
    ds_read2st64_b32 v[10:11], v7 offset0:2 offset1:3
    s_add_u32 s46, s35, 0x7ec4000
    s_add_u32 s46, s46, s93
    buffer_store_dwordx4 v[28:31], v0, s[20:23], s46 offen sc1
    s_waitcnt lgkmcnt(0)
    v_lshl_or_b32 v12, v9, 16, v8
    v_lshl_or_b32 v13, v11, 16, v10
    v_mov_b32 v14, v12
    v_mov_b32 v15, v13
    s_nop 0
    v_add_u32_dpp v14, v14, v14 row_shr:1 row_mask:0xf bank_mask:0xf bound_ctrl:1
    v_add_u32_dpp v15, v15, v15 row_shr:1 row_mask:0xf bank_mask:0xf bound_ctrl:1
    s_nop 0
    v_add_u32_dpp v14, v14, v14 row_shr:2 row_mask:0xf bank_mask:0xf bound_ctrl:1
    v_add_u32_dpp v15, v15, v15 row_shr:2 row_mask:0xf bank_mask:0xf bound_ctrl:1
    s_nop 0
    v_add_u32_dpp v14, v14, v14 row_shr:4 row_mask:0xf bank_mask:0xf bound_ctrl:1
    v_add_u32_dpp v15, v15, v15 row_shr:4 row_mask:0xf bank_mask:0xf bound_ctrl:1
    s_nop 0
    v_add_u32_dpp v14, v14, v14 row_shr:8 row_mask:0xf bank_mask:0xf bound_ctrl:1
    v_add_u32_dpp v15, v15, v15 row_shr:8 row_mask:0xf bank_mask:0xf bound_ctrl:1
    s_nop 0
    v_add_u32_dpp v14, v14, v14 row_bcast:15 row_mask:0xa bank_mask:0xf
    v_add_u32_dpp v15, v15, v15 row_bcast:15 row_mask:0xa bank_mask:0xf
    s_nop 0
    v_add_u32_dpp v14, v14, v14 row_bcast:31 row_mask:0xc bank_mask:0xf
    v_add_u32_dpp v15, v15, v15 row_bcast:31 row_mask:0xc bank_mask:0xf
    v_readlane_b32 s48, v14, 63
    v_readlane_b32 s49, v15, 63
    s_lshl_b32 s54, s32, 2
    v_mov_b32 v8, s54
    s_and_b32 s50, s48, 0xffff
    s_lshr_b32 s51, s48, 16
    s_and_b32 s52, s49, 0xffff
    s_lshr_b32 s53, s49, 16
    s_add_u32 s51, s51, s50
    s_add_u32 s52, s52, s51
    s_add_u32 s53, s53, s52
    v_mov_b32 v9, s53
    v_and_b32_dpp v3, v3, v3 quad_perm:[1,0,3,2] row_mask:0xf bank_mask:0xf
    s_mov_b64 exec, 1
    ds_write_b32 v8, v9 offset:16384
    ds_write_b32 v8, v3 offset:16448
    s_mov_b64 exec, -1
    v_and_b32 v8, 60, v7
    s_waitcnt lgkmcnt(0)
    s_barrier
    ds_read_b32 v9, v8 offset:16384
    ds_read_b32 v10, v8 offset:16448
    s_waitcnt lgkmcnt(0)
    v_readlane_b32 s56, v10, 15
    s_xor_b32 s56, s56, 0x80
    v_add_u32_dpp v9, v9, v9 row_shr:1 row_mask:0xf bank_mask:0xf bound_ctrl:1
    s_nop 1
    v_add_u32_dpp v9, v9, v9 row_shr:2 row_mask:0xf bank_mask:0xf bound_ctrl:1
    s_nop 1
    v_add_u32_dpp v9, v9, v9 row_shr:4 row_mask:0xf bank_mask:0xf bound_ctrl:1
    s_nop 1
    v_add_u32_dpp v9, v9, v9 row_shr:8 row_mask:0xf bank_mask:0xf bound_ctrl:1
    s_nop 0
    v_readlane_b32 s54, v9, s32
    s_sub_u32 s54, s54, s53
    s_add_u32 s50, s50, s54
    s_add_u32 s51, s51, s54
    s_add_u32 s52, s52, s54
    s_pack_ll_b32_b16 s48, s54, s50
    s_pack_ll_b32_b16 s49, s51, s52
    v_add_u32 v14, s48, v14
    v_add_u32 v15, s49, v15
    v_sub_u32 v12, v14, v12
    v_sub_u32 v13, v15, v13
    v_and_b32 v8, 0xffff, v12
    v_lshrrev_b32 v9, 16, v12
    v_and_b32 v10, 0xffff, v13
    v_lshrrev_b32 v11, 16, v13
    ds_write2st64_b32 v7, v8, v9 offset0:0 offset1:1
    ds_write2st64_b32 v7, v10, v11 offset0:2 offset1:3
    v_and_b32 v8, 0x3f0, v0
    v_lshl_add_u32 v8, v8, 1, s36
    ds_write_b64 v8, v[12:13] offset:20480
    s_bitset0_b64 exec, 63
    s_not_b64 exec, exec
    ds_write_b64 v8, v[14:15] offset:20512
    s_mov_b64 exec, -1
    s_waitcnt lgkmcnt(0)
    s_barrier
    s_setprio 3
    ds_add_rtn_u32 v120, v120, v2
    ds_add_rtn_u32 v121, v121, v2
    ds_add_rtn_u32 v122, v122, v2
    ds_add_rtn_u32 v123, v123, v2
    ds_read_b128 v[12:15], v0 offset:20480
    v_cmp_gt_u32 vcc, 8448, v0
    ds_add_rtn_u32 v124, v124, v2
    ds_add_rtn_u32 v125, v125, v2
    ds_add_rtn_u32 v126, v126, v2
    ds_add_rtn_u32 v127, v127, v2
    s_setprio 2
    ds_add_rtn_u32 v24, v24, v2
    ds_add_rtn_u32 v25, v25, v2
    ds_add_rtn_u32 v26, v26, v2
    ds_add_rtn_u32 v27, v27, v2
    s_waitcnt lgkmcnt(8)
    s_cbranch_vccz L1_p8
    s_add_u32 s47, s35, 0xa900000
    s_mov_b64 exec, vcc
    buffer_store_dwordx4 v[12:15], v0, s[24:27], s47 offen sc1
    s_mov_b64 exec, -1
L1_p8:
    s_add_u32 s44, s35, 0x7ec8000
    s_add_u32 s44, s44, s72
    buffer_store_dwordx4 v[112:115], v0, s[20:23], s44 offen sc1
    ds_add_rtn_u32 v52, v52, v2
    ds_add_rtn_u32 v53, v53, v2
    ds_add_rtn_u32 v54, v54, v2
    ds_add_rtn_u32 v55, v55, v2
    s_load_dwordx2 s[28:29], s[0:1], 0
    s_load_dwordx2 s[50:51], s[0:1], 40
    s_load_dwordx2 s[52:53], s[0:1], 24
    s_setprio 1
    ds_add_rtn_u32 v68, v68, v2
    ds_add_rtn_u32 v69, v69, v2
    ds_add_rtn_u32 v70, v70, v2
    ds_add_rtn_u32 v71, v71, v2
    s_cmp_le_u32 s43, 5
    s_cbranch_scc1 L1_s9
    ds_add_rtn_u32 v76, v76, v2
    ds_add_rtn_u32 v77, v77, v2
    ds_add_rtn_u32 v78, v78, v2
    ds_add_rtn_u32 v79, v79, v2
L1_s9:
    s_add_u32 s45, s35, 0x7ec8000
    s_add_u32 s45, s45, s73
    buffer_store_dwordx4 v[88:91], v0, s[20:23], s45 offen sc1
    s_setprio 0
    s_cmp_le_u32 s43, 6
    s_cbranch_scc1 L1_s10
    ds_add_rtn_u32 v56, v56, v2
    ds_add_rtn_u32 v57, v57, v2
    ds_add_rtn_u32 v58, v58, v2
    ds_add_rtn_u32 v59, v59, v2
L1_s10:
    s_cmp_le_u32 s43, 7
    s_cbranch_scc1 L1_s11
    ds_add_rtn_u32 v60, v60, v2
    ds_add_rtn_u32 v61, v61, v2
    ds_add_rtn_u32 v62, v62, v2
    ds_add_rtn_u32 v63, v63, v2
L1_s11:
    s_waitcnt lgkmcnt(0)
    s_barrier
    s_load_dwordx4 s[96:99], s[50:51], 0
    s_mov_b64 s[4:5], s[52:53]
    s_bfe_u32 s33, s2, 0x20001
    s_and_b32 s34, s2, 1
    s_lshl_b32 s34, s34, 5
    s_lshr_b32 s3, s2, 3
    s_add_u32 s34, s34, s3
    s_mul_i32 s39, s33, 2080
    s_lshl_b32 s3, s34, 5
    s_add_u32 s39, s39, s3
    s_mul_i32 s40, s33, 1310720
    s_add_u32 s40, s40, 0x50000
    s_lshl_b32 s38, s32, 11
    s_mul_i32 s100, s32, 3072
    s_add_u32 s8, s30, 0x4000
    s_addc_u32 s9, s31, 0
    s_mov_b32 s10, 0xd340000
    s_mov_b32 s11, 0x20000
    s_add_u32 s12, s30, 0x2c000
    s_addc_u32 s13, s31, 0
    s_mov_b32 s14, 0xd318000
    s_mov_b32 s15, 0x20000
    s_mov_b32 s16, s64
    s_mov_b32 s17, s65
    s_mov_b32 s18, 0x20
    s_mov_b32 s19, 0x20000
    s_mov_b32 s24, s28
    s_mov_b32 s25, s29
    s_mov_b32 s26, 0x4e2000
    s_mov_b32 s27, 0x20000
    s_setprio 3
    v_and_b32 v7, -4, v120
    v_lshl_add_u32 v8, v120, 2, v7
    ds_write_b32 v8, v16
    v_lshl_add_u32 v7, v7, 2, v120
    ds_write_b8 v7, v44 offset:16
    v_and_b32 v9, -4, v121
    v_lshl_add_u32 v10, v121, 2, v9
    ds_write_b32 v10, v17
    v_lshl_add_u32 v9, v9, 2, v121
    ds_write_b8_d16_hi v9, v44 offset:16
    v_and_b32 v7, -4, v122
    v_lshl_add_u32 v8, v122, 2, v7
    ds_write_b32 v8, v18
    v_lshl_add_u32 v7, v7, 2, v122
    ds_write_b8 v7, v45 offset:16
    v_and_b32 v9, -4, v123
    v_lshl_add_u32 v10, v123, 2, v9
    ds_write_b32 v10, v19
    v_lshl_add_u32 v9, v9, 2, v123
    ds_write_b8_d16_hi v9, v45 offset:16
    s_add_u32 s46, s35, 0x7ec8000
    s_add_u32 s46, s46, s85
    buffer_store_dwordx4 v[116:119], v0, s[20:23], s46 offen sc1
    v_and_b32 v13, 0x3f0, v0
    v_and_b32 v14, 0x300, v13
    v_bfe_u32 v15, v13, 4, 4
    s_lshl_b32 s3, s32, 4
    v_add3_u32 v14, v14, v15, s3
    v_mul_u32_u24 v2, 173056, v14
    v_lshrrev_b32 v14, 6, v13
    s_add_u32 s3, s3, 0x400
    v_add_u32 v14, s3, v14
    v_mul_u32_u24 v4, 173056, v14
    v_and_b32 v14, 3, v14
    v_and_b32 v15, 0x30, v13
    v_lshl_add_u32 v14, v14, 5, v15
    v_add_u32 v6, v14, v4
    v_lshl_add_u32 v5, v15, 1, v2
    v_lshrrev_b32 v14, 3, v15
    buffer_load_ushort v100, v14, s[16:19], 0 offen offset:0
    buffer_load_ushort v101, v14, s[16:19], 0 offen offset:8
    buffer_load_ushort v102, v14, s[16:19], 0 offen offset:16
    buffer_load_ushort v103, v14, s[16:19], 0 offen offset:24
    s_mul_i32 s3, s32, 5120
    v_add_u32 v3, s3, v13
    v_lshrrev_b32 v14, 2, v13
    v_add_u32 v14, s38, v14
    v_and_b32 v7, -4, v124
    v_lshl_add_u32 v8, v124, 2, v7
    ds_write_b32 v8, v20
    v_lshl_add_u32 v7, v7, 2, v124
    ds_write_b8 v7, v46 offset:16
    v_and_b32 v9, -4, v125
    v_lshl_add_u32 v10, v125, 2, v9
    ds_write_b32 v10, v21
    v_lshl_add_u32 v9, v9, 2, v125
    ds_write_b8_d16_hi v9, v46 offset:16
    v_and_b32 v7, -4, v126
    v_lshl_add_u32 v8, v126, 2, v7
    ds_write_b32 v8, v22
    v_lshl_add_u32 v7, v7, 2, v126
    ds_write_b8 v7, v47 offset:16
    v_and_b32 v9, -4, v127
    v_lshl_add_u32 v10, v127, 2, v9
    ds_write_b32 v10, v23
    v_lshl_add_u32 v9, v9, 2, v127
    ds_write_b8_d16_hi v9, v47 offset:16
    v_lshrrev_b32 v11, 2, v0
    v_and_b32 v11, 0xfc, v11
    s_cmp_ge_u32 s84, 128
    s_cselect_b32 s82, 0, s82
    s_and_b32 s3, s84, 1
    s_mul_i32 s3, s3, 40
    s_add_u32 s3, s3, s32
    s_mul_i32 s74, s3, 205
    s_lshr_b32 s74, s74, 10
    s_mul_i32 s75, s74, 5
    s_sub_u32 s75, s3, s75
    s_lshl_b32 s48, s74, 1
    s_add_u32 s48, s48, s75
    s_add_u32 s49, s48, s74
    s_add_u32 s49, s49, 30
    s_cmp_lt_u32 s75, 2
    s_cselect_b32 s48, s48, s49
    s_lshl_b32 s48, s48, 10
    s_lshr_b32 s49, s84, 1
    s_mul_i32 s49, s49, 80000
    s_add_u32 s48, s48, s49
    buffer_load_dword v104, v11, s[80:83], s48 offen offset:0
    buffer_load_dword v105, v11, s[80:83], s48 offen offset:256
    buffer_load_dword v106, v11, s[80:83], s48 offen offset:512
    buffer_load_dword v107, v11, s[80:83], s48 offen offset:768
    s_and_b32 s3, s84, 1
    s_mul_i32 s3, s3, 40
    s_add_u32 s3, s3, s32
    s_add_u32 s3, s3, 16
    s_mul_i32 s74, s3, 205
    s_lshr_b32 s74, s74, 10
    s_mul_i32 s75, s74, 5
    s_sub_u32 s75, s3, s75
    s_lshl_b32 s48, s74, 1
    s_add_u32 s48, s48, s75
    s_add_u32 s49, s48, s74
    s_add_u32 s49, s49, 30
    s_cmp_lt_u32 s75, 2
    s_cselect_b32 s48, s48, s49
    s_lshl_b32 s48, s48, 10
    s_lshr_b32 s49, s84, 1
    s_mul_i32 s49, s49, 80000
    s_add_u32 s48, s48, s49
    buffer_load_dword v28, v11, s[80:83], s48 offen offset:0
    buffer_load_dword v29, v11, s[80:83], s48 offen offset:256
    buffer_load_dword v30, v11, s[80:83], s48 offen offset:512
    buffer_load_dword v31, v11, s[80:83], s48 offen offset:768
    s_and_b32 s3, s84, 1
    s_mul_i32 s3, s3, 40
    s_add_u32 s3, s3, s32
    s_add_u32 s3, s3, 32
    s_cmp_ge_u32 s32, 8
    s_cselect_b32 s82, 0, s82
    s_mul_i32 s74, s3, 205
    s_lshr_b32 s74, s74, 10
    s_mul_i32 s75, s74, 5
    s_sub_u32 s75, s3, s75
    s_lshl_b32 s48, s74, 1
    s_add_u32 s48, s48, s75
    s_add_u32 s49, s48, s74
    s_add_u32 s49, s49, 30
    s_cmp_lt_u32 s75, 2
    s_cselect_b32 s48, s48, s49
    s_lshl_b32 s48, s48, 10
    s_lshr_b32 s49, s84, 1
    s_mul_i32 s49, s49, 80000
    s_add_u32 s48, s48, s49
    buffer_load_dword v112, v11, s[80:83], s48 offen offset:0
    buffer_load_dword v113, v11, s[80:83], s48 offen offset:256
    buffer_load_dword v114, v11, s[80:83], s48 offen offset:512
    buffer_load_dword v115, v11, s[80:83], s48 offen offset:768
    s_setprio 2
    v_and_b32 v7, -4, v24
    v_lshl_add_u32 v8, v24, 2, v7
    ds_write_b32 v8, v40
    v_lshl_add_u32 v7, v7, 2, v24
    ds_write_b8 v7, v32 offset:16
    v_and_b32 v9, -4, v25
    v_lshl_add_u32 v10, v25, 2, v9
    ds_write_b32 v10, v41
    v_lshl_add_u32 v9, v9, 2, v25
    ds_write_b8_d16_hi v9, v32 offset:16
    v_and_b32 v7, -4, v26
    v_lshl_add_u32 v8, v26, 2, v7
    ds_write_b32 v8, v42
    v_lshl_add_u32 v7, v7, 2, v26
    ds_write_b8 v7, v33 offset:16
    v_and_b32 v9, -4, v27
    v_lshl_add_u32 v10, v27, 2, v9
    ds_write_b32 v10, v43
    v_lshl_add_u32 v9, v9, 2, v27
    ds_write_b8_d16_hi v9, v33 offset:16
    s_add_u32 s47, s35, 0x7ec8000
    s_add_u32 s47, s47, s91
    buffer_store_dwordx4 v[92:95], v0, s[20:23], s47 offen sc1
    v_and_b32 v7, -4, v52
    v_lshl_add_u32 v8, v52, 2, v7
    ds_write_b32 v8, v48
    v_lshl_add_u32 v7, v7, 2, v52
    ds_write_b8 v7, v34 offset:16
    v_and_b32 v9, -4, v53
    v_lshl_add_u32 v10, v53, 2, v9
    ds_write_b32 v10, v49
    v_lshl_add_u32 v9, v9, 2, v53
    ds_write_b8_d16_hi v9, v34 offset:16
    v_and_b32 v7, -4, v54
    v_lshl_add_u32 v8, v54, 2, v7
    ds_write_b32 v8, v50
    v_lshl_add_u32 v7, v7, 2, v54
    ds_write_b8 v7, v35 offset:16
    v_and_b32 v9, -4, v55
    v_lshl_add_u32 v10, v55, 2, v9
    ds_write_b32 v10, v51
    v_lshl_add_u32 v9, v9, 2, v55
    ds_write_b8_d16_hi v9, v35 offset:16
    s_setprio 1
    v_and_b32 v7, -4, v68
    v_lshl_add_u32 v8, v68, 2, v7
    ds_write_b32 v8, v84
    v_lshl_add_u32 v7, v7, 2, v68
    ds_write_b8 v7, v72 offset:16
    v_and_b32 v9, -4, v69
    v_lshl_add_u32 v10, v69, 2, v9
    ds_write_b32 v10, v85
    v_lshl_add_u32 v9, v9, 2, v69
    ds_write_b8_d16_hi v9, v72 offset:16
    v_and_b32 v7, -4, v70
    v_lshl_add_u32 v8, v70, 2, v7
    ds_write_b32 v8, v86
    v_lshl_add_u32 v7, v7, 2, v70
    ds_write_b8 v7, v73 offset:16
    v_and_b32 v9, -4, v71
    v_lshl_add_u32 v10, v71, 2, v9
    ds_write_b32 v10, v87
    v_lshl_add_u32 v9, v9, 2, v71
    ds_write_b8_d16_hi v9, v73 offset:16
    s_cmp_le_u32 s43, 5
    s_cbranch_scc1 L1_s12
    v_and_b32 v7, -4, v76
    v_lshl_add_u32 v8, v76, 2, v7
    ds_write_b32 v8, v36
    v_lshl_add_u32 v7, v7, 2, v76
    ds_write_b8 v7, v74 offset:16
    v_and_b32 v9, -4, v77
    v_lshl_add_u32 v10, v77, 2, v9
    ds_write_b32 v10, v37
    v_lshl_add_u32 v9, v9, 2, v77
    ds_write_b8_d16_hi v9, v74 offset:16
    v_and_b32 v7, -4, v78
    v_lshl_add_u32 v8, v78, 2, v7
    ds_write_b32 v8, v38
    v_lshl_add_u32 v7, v7, 2, v78
    ds_write_b8 v7, v75 offset:16
    v_and_b32 v9, -4, v79
    v_lshl_add_u32 v10, v79, 2, v9
    ds_write_b32 v10, v39
    v_lshl_add_u32 v9, v9, 2, v79
    ds_write_b8_d16_hi v9, v75 offset:16
L1_s12:
    s_add_u32 s44, s35, 0x7ec8000
    s_add_u32 s44, s44, s93
    buffer_store_dwordx4 v[108:111], v0, s[20:23], s44 offen sc1
    s_setprio 0
    s_cmp_le_u32 s43, 6
    s_cbranch_scc1 L1_s13
    v_and_b32 v7, -4, v56
    v_lshl_add_u32 v8, v56, 2, v7
    ds_write_b32 v8, v80
    v_lshl_add_u32 v7, v7, 2, v56
    ds_write_b8 v7, v64 offset:16
    v_and_b32 v9, -4, v57
    v_lshl_add_u32 v10, v57, 2, v9
    ds_write_b32 v10, v81
    v_lshl_add_u32 v9, v9, 2, v57
    ds_write_b8_d16_hi v9, v64 offset:16
    v_and_b32 v7, -4, v58
    v_lshl_add_u32 v8, v58, 2, v7
    ds_write_b32 v8, v82
    v_lshl_add_u32 v7, v7, 2, v58
    ds_write_b8 v7, v65 offset:16
    v_and_b32 v9, -4, v59
    v_lshl_add_u32 v10, v59, 2, v9
    ds_write_b32 v10, v83
    v_lshl_add_u32 v9, v9, 2, v59
    ds_write_b8_d16_hi v9, v65 offset:16
L1_s13:
    s_add_u32 s80, s30, 0xd344000
    s_addc_u32 s81, s31, 0
    s_mov_b32 s82, 0xa000
    s_mov_b32 s83, 0x20000
    s_min_u32 s3, s84, 127
    s_mul_i32 s3, s3, 40960
    s_add_u32 s80, s80, s3
    s_addc_u32 s81, s81, 0
    s_cmp_ge_u32 s84, 128
    s_cselect_b32 s82, 0, s82
    s_waitcnt vmcnt(2)
    v_add_u32 v11, 0, v0
    buffer_store_dwordx4 v[104:107], v11, s[80:83], 0 offen sc1
    v_add_u32 v11, 16384, v0
    buffer_store_dwordx4 v[28:31], v11, s[80:83], 0 offen sc1
    v_add_u32 v11, 32768, v0
    buffer_store_dwordx4 v[112:115], v11, s[80:83], 0 offen sc1
    s_cmp_le_u32 s43, 7
    s_cbranch_scc1 L1_s14
    v_and_b32 v7, -4, v60
    v_lshl_add_u32 v8, v60, 2, v7
    ds_write_b32 v8, v96
    v_lshl_add_u32 v7, v7, 2, v60
    ds_write_b8 v7, v66 offset:16
    v_and_b32 v9, -4, v61
    v_lshl_add_u32 v10, v61, 2, v9
    ds_write_b32 v10, v97
    v_lshl_add_u32 v9, v9, 2, v61
    ds_write_b8_d16_hi v9, v66 offset:16
    v_and_b32 v7, -4, v62
    v_lshl_add_u32 v8, v62, 2, v7
    ds_write_b32 v8, v98
    v_lshl_add_u32 v7, v7, 2, v62
    ds_write_b8 v7, v67 offset:16
    v_and_b32 v9, -4, v63
    v_lshl_add_u32 v10, v63, 2, v9
    ds_write_b32 v10, v99
    v_lshl_add_u32 v9, v9, 2, v63
    ds_write_b8_d16_hi v9, v67 offset:16
L1_s14:
    v_add_u32 v7, 0x10000, v0
    v_add_u32 v12, 0x20000, v0
    s_waitcnt lgkmcnt(0)
    s_barrier
    ds_read_b128 v[24:27], v0 offset:0
    ds_read_b128 v[28:31], v0 offset:16384
    ds_read_b128 v[32:35], v0 offset:32768
    ds_read_b128 v[36:39], v0 offset:49152
    ds_read_b128 v[76:79], v7 offset:0
    ds_read_b128 v[80:83], v7 offset:16384
    ds_read_b128 v[84:87], v7 offset:32768
    ds_read_b128 v[104:107], v7 offset:49152
    ds_read_b128 v[68:71], v12 offset:0
    ds_read_b128 v[72:75], v12 offset:16384
    s_cmp_lg_u32 s32, 0
    s_cbranch_scc1 L2_sg1
    s_mov_b32 exec_hi, 0
    v_mov_b32 v11, 1
    buffer_store_dword v11, v14, s[60:63], s57 offen sc1
    s_mov_b64 exec, -1
L2_sg1:
    s_waitcnt lgkmcnt(9)
    s_add_u32 s45, s35, 0xa904000
    buffer_store_dwordx4 v[24:27], v0, s[20:23], s45 offen sc1
    s_waitcnt lgkmcnt(8)
    s_add_u32 s46, s35, 0xa908000
    buffer_store_dwordx4 v[28:31], v0, s[20:23], s46 offen sc1
    s_waitcnt lgkmcnt(7)
    s_add_u32 s47, s35, 0xa90c000
    buffer_store_dwordx4 v[32:35], v0, s[20:23], s47 offen sc1
    s_waitcnt lgkmcnt(6)
    s_add_u32 s44, s35, 0xa910000
    buffer_store_dwordx4 v[36:39], v0, s[20:23], s44 offen sc1
    s_waitcnt lgkmcnt(5)
    s_add_u32 s45, s35, 0xa914000
    buffer_store_dwordx4 v[76:79], v0, s[20:23], s45 offen sc1
    s_waitcnt lgkmcnt(4)
    s_add_u32 s46, s35, 0xa918000
    buffer_store_dwordx4 v[80:83], v0, s[20:23], s46 offen sc1
    s_waitcnt lgkmcnt(3)
    s_add_u32 s47, s35, 0xa91c000
    buffer_store_dwordx4 v[84:87], v0, s[20:23], s47 offen sc1
    s_waitcnt lgkmcnt(2)
    s_cmp_le_u32 s43, 5
    s_cbranch_scc1 L1_q15
    s_add_u32 s44, s35, 0xa920000
    buffer_store_dwordx4 v[104:107], v0, s[20:23], s44 offen sc1
L1_q15:
    s_waitcnt lgkmcnt(1)
    s_cmp_le_u32 s43, 6
    s_cbranch_scc1 L1_q16
    s_add_u32 s45, s35, 0xa924000
    buffer_store_dwordx4 v[68:71], v0, s[20:23], s45 offen sc1
L1_q16:
    s_waitcnt lgkmcnt(0)
    s_cmp_le_u32 s43, 7
    s_cbranch_scc1 L1_q17
    s_add_u32 s46, s35, 0xa928000
    buffer_store_dwordx4 v[72:75], v0, s[20:23], s46 offen sc1
L1_q17:
    s_waitcnt lgkmcnt(0)
    s_setprio 3
    v_mov_b32 v92, v0
    v_mov_b32 v93, v6
    v_mov_b32 v94, v13
    v_mov_b32 v95, v5
    v_mov_b32 v0, v14
    v_lshl_add_u32 v7, v13, 3, s38
    v_lshrrev_b32 v16, 2, v15
    v_mad_u32_u24 v4, v16, 5, v4
    v_or_b32 v4, 0xf0000000, v4
    v_or_b32 v2, 0xf0000000, v2
    v_sub_u32 v1, 28, v16
    v_lshrrev_b32 v17, 2, v16
    v_and_b32 v18, 3, v17
    v_lshlrev_b32 v18, 4, v18
    v_mov_b32 v10, 0x3f80
    v_mov_b32 v11, 0
    v_lshlrev_b64 v[10:11], v18, v[10:11]
    v_and_b32 v18, 3, v17
    v_lshlrev_b32 v18, 4, v18
    v_mov_b32 v12, 0xbf80
    v_mov_b32 v13, 0
    v_lshlrev_b64 v[12:13], v18, v[12:13]
    v_mov_b32 v45, 0xf0000000
    v_mov_b32 v5, 0x1fff8
    v_mov_b32 v6, 0x07ff0000
    v_mov_b32 v16, 0
    v_mov_b32 v17, 0
    v_mov_b32 v18, 0
    v_mov_b32 v19, 0
    v_add_u32 v20, 81920, v92
    v_add_u32 v21, 0x10000, v20
    s_setprio 1
    s_setprio 2
    s_mov_b32 s44, 0x4000c0c
    s_mov_b32 s45, 0x4010c0c
    s_mov_b32 s46, 0x4020c0c
    s_mov_b32 s47, 0x4030c0c
    s_mov_b32 s36, 0
    s_mov_b32 s43, 0
    s_mov_b32 s42, 0
    s_mov_b64 s[80:81], 0
    s_mov_b64 s[48:49], 0
    s_add_u32 s16, s30, 0xd344000
    s_addc_u32 s17, s31, 0
    s_mov_b32 s18, 0x500000
    s_mov_b32 s19, 0x20000
    v_mov_b32 v68, 0
    v_mov_b32 v69, 0
    v_mov_b32 v70, 0
    v_mov_b32 v71, 0
    v_mov_b32 v72, 0
    v_mov_b32 v73, 0
    v_mov_b32 v74, 0
    v_mov_b32 v75, 0
    s_waitcnt vmcnt(0)
    v_lshl_or_b32 v8, v101, 16, v100
    v_lshl_or_b32 v9, v103, 16, v102
    s_barrier
    s_cmp_lg_u32 s32, 0
    s_cbranch_scc1 L2_sg2
    s_mov_b32 exec_hi, 0
    v_mov_b32 v88, 2
    buffer_store_dword v88, v0, s[60:63], s57 offen sc1
    s_mov_b64 exec, -1
L2_sg2:
    s_mov_b64 s[84:85], 0
    s_mul_i32 s3, s33, 1280000
    s_add_u32 s3, s3, s100
    s_add_u32 s3, s3, 32768
    buffer_load_dwordx4 v[124:127], v94, s[24:27], s3 offen offset:2048
    s_mul_i32 s3, s33, 1280000
    s_add_u32 s3, s3, s100
    s_add_u32 s3, s3, 32768
    buffer_load_dwordx4 v[116:119], v94, s[24:27], s3 offen offset:0
    s_mul_i32 s3, s33, 1280000
    s_add_u32 s3, s3, s100
    s_add_u32 s3, s3, 32768
    buffer_load_dwordx4 v[120:123], v94, s[24:27], s3 offen offset:1024
    s_mul_i32 s3, s33, 1280000
    s_add_u32 s3, s3, s38
    s_add_u32 s3, s3, 0
    buffer_load_dwordx4 v[108:111], v94, s[24:27], s3 offen offset:0
    s_mul_i32 s3, s33, 1280000
    s_add_u32 s3, s3, s38
    s_add_u32 s3, s3, 0
    buffer_load_dwordx4 v[112:115], v94, s[24:27], s3 offen offset:1024
    ds_write_b128 v20, v[16:19] offset:0
    ds_write_b128 v20, v[16:19] offset:16384
    ds_write_b128 v20, v[16:19] offset:32768
    ds_write_b128 v20, v[16:19] offset:49152
    ds_write_b128 v21, v[16:19]
    s_cmp_eq_u32 s56, 0
    s_cbranch_scc1 L2_e3
    v_lshlrev_b32 v16, 3, v94
    v_and_b32 v16, 0x80, v16
L2_e4:
    buffer_load_dword v88, v16, s[68:71], 0 offen sc1
    s_waitcnt vmcnt(0)
    v_cmp_gt_u32 vcc, 0x80, v88
    s_cbranch_vccnz L2_e4
L2_e3:
    s_mov_b64 exec, 0xffff
L2_p1:
    buffer_load_dword v88, v7, s[60:63], 0 offen sc1
    s_waitcnt vmcnt(0)
    v_cmpx_gt_u32 vcc, 1, v88
    s_cbranch_vccnz L2_p1s
    s_mov_b64 exec, -1
    v_cmp_gt_u32 vcc, 2, v88
    s_and_b32 s56, vcc_lo, 0xffff
    buffer_load_dwordx4 v[48:51], v95, s[12:15], s39 offen offset:0
    buffer_load_dwordx4 v[56:59], v95, s[12:15], s39 offen offset:32
    buffer_load_dwordx4 v[52:55], v95, s[12:15], s39 offen offset:16
    buffer_load_dwordx4 v[60:63], v95, s[12:15], s39 offen offset:48
    buffer_load_dwordx4 v[64:67], v93, s[12:15], s39 offen
    s_waitcnt vmcnt(0)
    v_sub_u16 v88, v56, v48
    v_and_b32 v89, 3, v48
    v_add3_u32 v99, v88, v89, 3
    v_and_b32 v99, -4, v99
    v_max_u32 v99, 4, v99
    v_and_b32 v97, 0xfffc, v48
    v_bfm_b32 v96, v88, v89
    v_add_u32_dpp v91, v99, v99 row_shr:1 row_mask:0xf bank_mask:0xf bound_ctrl:1
    v_mad_u32_u24 v97, v97, 5, v2
    v_cmp_lt_u32 vcc, 16, v99
    v_add_u32_dpp v91, v91, v91 row_shr:2 row_mask:0xf bank_mask:0xf bound_ctrl:1
    v_sub_u32 v98, s38, v99
    v_lshrrev_b64 v[48:49], 16, v[48:49]
    v_add_u32_dpp v91, v91, v91 row_shr:4 row_mask:0xf bank_mask:0xf bound_ctrl:1
    v_lshrrev_b64 v[56:57], 16, v[56:57]
    s_mov_b32 s101, 0
    v_add_u32_dpp v91, v91, v91 row_shr:8 row_mask:0xf bank_mask:0xf bound_ctrl:1
    s_nop 1
    v_add_u32_dpp v91, v91, v91 row_bcast:15 row_mask:0xa bank_mask:0xf
    s_nop 1
    v_add_u32_dpp v91, v91, v91 row_bcast:31 row_mask:0xc bank_mask:0xf
    v_add_u32 v98, v98, v91
    v_readlane_b32 s37, v91, 63
    s_cbranch_vccnz L2_xo3
L2_xp3:
    v_mov_b32 v44, v43
    s_cmp_gt_u32 s37, 1024
    s_cbranch_scc1 L2_xs4
    s_cmp_lg_u32 s101, 0
    s_cbranch_scc1 L2_xa4
L2_xb4:
    v_lshlrev_b32 v89, 16, v96
    v_add_u32 v90, 60, v97
    v_bitop3_b32 v90, v89, v45, v90 bitop3:0x6a
    ds_write_b32 v98, v90 offset:12
    v_lshlrev_b32 v89, 20, v96
    v_add_u32 v90, 40, v97
    v_bitop3_b32 v90, v89, v45, v90 bitop3:0x6a
    ds_write_b32 v98, v90 offset:8
    v_lshlrev_b32 v89, 24, v96
    v_add_u32 v90, 20, v97
    v_bitop3_b32 v90, v89, v45, v90 bitop3:0x6a
    ds_write_b32 v98, v90 offset:4
    v_lshlrev_b32 v89, 28, v96
    v_bitop3_b32 v90, v89, v45, v97 bitop3:0x6a
    ds_write_b32 v98, v90 offset:0
    v_mov_b32_dpp v91, v64 quad_perm:[0,0,0,0] row_mask:0xf bank_mask:0xf
    v_and_b32 v89, 3, v91
    v_and_b32 v97, 0xfffc, v91
    v_sub_u16_dpp v88, v64, v91 quad_perm:[2,2,2,2] row_mask:0xf bank_mask:0xf
    v_mad_u32_u24 v97, v97, 5, v4
    v_add_u32 v99, v88, v89
    v_bfm_b32 v96, v88, v89
    v_cmp_lt_u32 s[58:59], 16, v99
    v_lshlrev_b32 v89, v1, v96
    v_and_b32 v89, v45, v89
    v_cmp_ne_u32 vcc, 0, v89
    v_xor_b32 v90, v97, v89
    s_add_u32 s3, s37, s38
    v_mbcnt_lo_u32_b32 v98, vcc_lo, 0
    v_mbcnt_hi_u32_b32 v98, vcc_hi, v98
    s_bcnt1_i32_b64 s41, vcc
    v_lshl_add_u32 v98, v98, 2, s3
    s_lshl2_add_u32 s37, s41, s37
    s_mov_b64 exec, vcc
    ds_write_b32 v98, v90
    s_mov_b64 exec, -1
    s_cmp_lg_u64 s[58:59], 0
    s_cbranch_scc1 L2_xe4
L2_xr4:
    v_add_u32 v98, s37, v0
    v_mov_b32 v90, -1
    ds_write_b32 v98, v90
    v_add_u32 v98, s38, v0
    ds_read2st64_b32 v[40:41], v0 offset0:0 offset1:1
    ds_read_b32 v43, v0 offset:512
    v_lshrrev_b32 v98, 1, v98
    v_and_b32 v98, -4, v98
    ds_read_b32 v42, v98 offset:768
    s_sub_u32 s3, s37, 768
    s_cmp_gt_u32 s3, 128
    s_cbranch_scc1 L2_xf4
L2_xg4:
    v_sub_u16 v88, v58, v50
    v_and_b32 v89, 3, v50
    v_add3_u32 v99, v88, v89, 3
    v_and_b32 v99, -4, v99
    v_max_u32 v99, 4, v99
    v_and_b32 v97, 0xfffc, v50
    v_bfm_b32 v96, v88, v89
    v_add_u32_dpp v91, v99, v99 row_shr:1 row_mask:0xf bank_mask:0xf bound_ctrl:1
    v_mad_u32_u24 v97, v97, 5, v2
    v_cmp_lt_u32 vcc, 16, v99
    v_add_u32_dpp v91, v91, v91 row_shr:2 row_mask:0xf bank_mask:0xf bound_ctrl:1
    v_sub_u32 v98, s38, v99
    v_lshrrev_b64 v[50:51], 16, v[50:51]
    v_add_u32_dpp v91, v91, v91 row_shr:4 row_mask:0xf bank_mask:0xf bound_ctrl:1
    v_lshrrev_b64 v[58:59], 16, v[58:59]
    s_mov_b32 s101, 0
    v_add_u32_dpp v91, v91, v91 row_shr:8 row_mask:0xf bank_mask:0xf bound_ctrl:1
    s_nop 1
    v_add_u32_dpp v91, v91, v91 row_bcast:15 row_mask:0xa bank_mask:0xf
    s_nop 1
    v_add_u32_dpp v91, v91, v91 row_bcast:31 row_mask:0xc bank_mask:0xf
    v_add_u32 v98, v98, v91
    v_readlane_b32 s37, v91, 63
    s_cbranch_vccnz L2_xo5
L2_xp5:
    s_waitcnt lgkmcnt(0)
    v_mov_b32 v21, v40
    v_mov_b32 v27, v41
    v_mov_b32 v31, v42
    v_mov_b32 v39, v43
    v_mov_b32 v44, v43
    s_cmp_gt_u32 s37, 1024
    s_cbranch_scc1 L2_xs6
    s_cmp_lg_u32 s101, 0
    s_cbranch_scc1 L2_xa6
L2_xb6:
    v_lshlrev_b32 v89, 16, v96
    v_add_u32 v90, 60, v97
    v_bitop3_b32 v90, v89, v45, v90 bitop3:0x6a
    ds_write_b32 v98, v90 offset:12
    v_lshlrev_b32 v89, 20, v96
    v_add_u32 v90, 40, v97
    v_bitop3_b32 v90, v89, v45, v90 bitop3:0x6a
    ds_write_b32 v98, v90 offset:8
    v_lshlrev_b32 v89, 24, v96
    v_add_u32 v90, 20, v97
    v_bitop3_b32 v90, v89, v45, v90 bitop3:0x6a
    ds_write_b32 v98, v90 offset:4
    v_lshlrev_b32 v89, 28, v96
    v_bitop3_b32 v90, v89, v45, v97 bitop3:0x6a
    ds_write_b32 v98, v90 offset:0
    v_mov_b32_dpp v91, v66 quad_perm:[0,0,0,0] row_mask:0xf bank_mask:0xf
    v_and_b32 v89, 3, v91
    v_and_b32 v97, 0xfffc, v91
    v_sub_u16_dpp v88, v66, v91 quad_perm:[2,2,2,2] row_mask:0xf bank_mask:0xf
    v_mad_u32_u24 v97, v97, 5, v4
    v_add_u32 v99, v88, v89
    v_bfm_b32 v96, v88, v89
    v_cmp_lt_u32 s[58:59], 16, v99
    v_lshlrev_b32 v89, v1, v96
    v_and_b32 v89, v45, v89
    v_cmp_ne_u32 vcc, 0, v89
    v_xor_b32 v90, v97, v89
    s_add_u32 s3, s37, s38
    v_mbcnt_lo_u32_b32 v98, vcc_lo, 0
    v_mbcnt_hi_u32_b32 v98, vcc_hi, v98
    s_bcnt1_i32_b64 s41, vcc
    v_lshl_add_u32 v98, v98, 2, s3
    s_lshl2_add_u32 s37, s41, s37
    s_mov_b64 exec, vcc
    ds_write_b32 v98, v90
    s_mov_b64 exec, -1
    s_cmp_lg_u64 s[58:59], 0
    s_cbranch_scc1 L2_xe6
L2_xr6:
    v_add_u32 v98, s37, v0
    v_mov_b32 v90, -1
    ds_write_b32 v98, v90
    v_add_u32 v98, s38, v0
    ds_read2st64_b32 v[40:41], v0 offset0:0 offset1:1
    ds_read_b32 v43, v0 offset:512
    v_lshrrev_b32 v98, 1, v98
    v_and_b32 v98, -4, v98
    ds_read_b32 v42, v98 offset:768
    s_sub_u32 s3, s37, 768
    s_cmp_gt_u32 s3, 128
    s_cbranch_scc1 L2_xf6
L2_xg6:
    v_subrev_u32 v88, s38, v3
    ds_write_b128 v88, v[124:127] offset:34816
    v_subrev_u32 v88, s38, v3
    ds_write_b128 v88, v[116:119] offset:32768
    v_subrev_u32 v88, s38, v3
    ds_write_b128 v88, v[120:123] offset:33792
    v_subrev_u32 v88, s100, v3
    ds_write_b128 v88, v[108:111] offset:0
    v_subrev_u32 v88, s100, v3
    ds_write_b128 v88, v[112:115] offset:1024
    s_cmp_eq_u32 s56, 0
    s_cbranch_scc1 L2_e2
    s_mov_b32 exec_lo, s56
    s_mov_b32 exec_hi, 0
    buffer_load_dword v88, v7, s[60:63], 0 offen sc1
    s_mov_b64 exec, -1
    s_waitcnt vmcnt(0)
    v_cmp_gt_u32 vcc, 2, v88
    s_and_b32 s56, vcc_lo, s56
    s_cbranch_scc0 L2_e2
    s_mul_i32 s3, s33, 1280000
    s_add_u32 s3, s3, s100
    s_add_u32 s3, s3, 352768
    buffer_load_dwordx4 v[124:127], v94, s[24:27], s3 offen offset:2048
    s_mul_i32 s3, s33, 1280000
    s_add_u32 s3, s3, s100
    s_add_u32 s3, s3, 352768
    buffer_load_dwordx4 v[116:119], v94, s[24:27], s3 offen offset:0
    s_mul_i32 s3, s33, 1280000
    s_add_u32 s3, s3, s100
    s_add_u32 s3, s3, 352768
    buffer_load_dwordx4 v[120:123], v94, s[24:27], s3 offen offset:1024
    s_mul_i32 s3, s33, 1280000
    s_add_u32 s3, s3, s38
    s_add_u32 s3, s3, 320000
    buffer_load_dwordx4 v[108:111], v94, s[24:27], s3 offen offset:0
    s_mul_i32 s3, s33, 1280000
    s_add_u32 s3, s3, s38
    s_add_u32 s3, s3, 320000
    buffer_load_dwordx4 v[112:115], v94, s[24:27], s3 offen offset:1024
    s_mov_b32 exec_lo, s56
    s_mov_b32 exec_hi, 0
L2_p2:
    buffer_load_dword v88, v7, s[60:63], 0 offen sc1
    s_waitcnt vmcnt(0)
    v_cmpx_gt_u32 vcc, 2, v88
    s_cbranch_vccnz L2_p2s
    s_mov_b64 exec, -1
L2_e2:
    s_mov_b32 s6, 0xaaaaaaaa
    s_mov_b32 s7, 0xaaaaaaaa
    v_and_b32 v47, 0x0fffffff, v21
    buffer_load_dwordx2 v[16:17], v47, s[8:11], 0 offen
    buffer_load_dwordx3 v[18:20], v47, s[8:11], 0 offen offset:8
    s_setprio 1
    v_and_b32 v47, 0x0fffffff, v27
    buffer_load_dwordx2 v[22:23], v47, s[8:11], 0 offen
    buffer_load_dwordx3 v[24:26], v47, s[8:11], 0 offen offset:8
    s_waitcnt lgkmcnt(0)
    s_barrier
    s_bitcmp1_b32 s36, s42
    s_cbranch_scc1 L2_slow
L2_ret0:
    s_setprio 3
    s_bitcmp1_b32 s43, s42
    s_cbranch_scc1 L2_oa7
L2_ob7:
    s_bitcmp1_b32 s43, s42
    s_cbranch_scc1 L2_oa8
L2_ob8:
    s_waitcnt vmcnt(2)
    v_and_b32 v46, 0x20000000, v21
    v_lshrrev_b32 v47, 14, v17
    v_bitop3_b32 v47, v47, v5, v46 bitop3:0xea
    ds_read_b64 v[102:103], v47
    v_bitop3_b32 v93, v17, v5, v46 bitop3:0xea
    v_and_b32 v46, 0x10000000, v21
    v_lshrrev_b32 v47, 14, v16
    v_bitop3_b32 v47, v47, v5, v46 bitop3:0xea
    ds_read_b64 v[100:101], v47
    v_bitop3_b32 v92, v16, v5, v46 bitop3:0xea
    v_perm_b32 v15, v17, v20, s45
    v_bitop3_b32 v46, v17, 0.5, -0.5 bitop3:0xa8
    v_perm_b32 v14, v16, v20, s44
    v_bitop3_b32 v47, v16, 0.5, -0.5 bitop3:0xa8
    v_bitop3_b32 v15, v6, v15, v46 bitop3:0xca
    v_bitop3_b32 v14, v6, v14, v47 bitop3:0xca
    s_waitcnt lgkmcnt(0)
    v_mfma_f32_4x4x4_16b_bf16 v[80:83], v[8:9], v[102:103], 0
    v_mfma_f32_4x4x4_16b_bf16 v[76:79], v[8:9], v[100:101], 0
    v_cmp_lt_u32 s[84:85], v5, v92
    s_nop 2
    v_pk_mul_f32 v[80:81], v[80:81], v[14:15] op_sel:[0,1] op_sel_hi:[1,1]
    v_pk_mul_f32 v[82:83], v[82:83], v[14:15] op_sel:[0,1] op_sel_hi:[1,1]
    v_pk_mul_f32 v[76:77], v[76:77], v[14:15] op_sel:[0,0] op_sel_hi:[1,0]
    v_pk_mul_f32 v[78:79], v[78:79], v[14:15] op_sel:[0,0] op_sel_hi:[1,0]
    v_and_b32 v47, 0x0fffffff, v39
    buffer_load_dwordx2 v[34:35], v47, s[8:11], 0 offen
    buffer_load_dwordx3 v[36:38], v47, s[8:11], 0 offen offset:8
    v_and_b32 v46, 0x80000000, v21
    v_lshrrev_b32 v47, 14, v19
    v_bitop3_b32 v47, v47, v5, v46 bitop3:0xea
    ds_read_b64 v[106:107], v47
    v_and_b32 v99, 0x40000000, v21
    v_lshrrev_b32 v47, 14, v18
    v_bitop3_b32 v47, v47, v5, v99 bitop3:0xea
    ds_read_b64 v[104:105], v47
    v_cmp_ne_u64 s[50:51], v[72:73], v[68:69]
    v_cmpx_ne_u64 s[54:55], v[74:75], v[70:71]
    s_and_b64 s[82:83], s[54:55], s[80:81]
    s_cbranch_scc1 L2_c9
L2_d9:
    v_mov_b64 v[84:85], v[70:71]
    v_mov_b32 v7, v95
    v_mov_b64 v[86:87], v[74:75]
    s_or_b64 s[80:81], s[80:81], s[54:55]
    s_mov_b64 exec, s[50:51]
    s_and_b64 s[82:83], s[50:51], s[80:81]
    s_cbranch_scc1 L2_c10
L2_d10:
    v_mov_b64 v[84:85], v[68:69]
    v_mov_b32 v7, v94
    v_mov_b64 v[86:87], v[72:73]
    s_mov_b64 exec, -1
    s_or_b64 s[80:81], s[80:81], s[50:51]
    s_and_b64 exec, s[84:85], s[80:81]
    v_mfma_f32_4x4x4_16b_bf16 v[76:79], v[12:13], v[84:85], 0
    v_mov_b32 v92, v7
    s_andn2_b64 s[80:81], s[80:81], s[84:85]
    v_mfma_f32_4x4x4_16b_bf16 v[76:79], v[10:11], v[86:87], v[76:79]
    s_mov_b64 exec, -1
    ds_read_b64 v[70:71], v93 offset:65408
    ds_read_b64 v[68:69], v92 offset:65408
    v_bitop3_b32 v94, v18, v5, v99 bitop3:0xea
    v_bitop3_b32 v95, v19, v5, v46 bitop3:0xea
    v_perm_b32 v15, v19, v20, s47
    v_bitop3_b32 v46, v19, 0.5, -0.5 bitop3:0xa8
    v_perm_b32 v14, v18, v20, s46
    v_bitop3_b32 v47, v18, 0.5, -0.5 bitop3:0xa8
    v_bitop3_b32 v15, v6, v15, v46 bitop3:0xca
    v_bitop3_b32 v14, v6, v14, v47 bitop3:0xca
    s_waitcnt lgkmcnt(1)
    v_mfma_f32_4x4x4_16b_bf16 v[80:83], v[10:11], v[70:71], v[80:83]
    s_waitcnt lgkmcnt(0)
    v_mfma_f32_4x4x4_16b_bf16 v[76:79], v[10:11], v[68:69], v[76:79]
    s_nop 2
    v_cvt_pk_bf16_f32 v80, v80, v81
    v_cvt_pk_bf16_f32 v81, v82, v83
    ds_wrxchg_rtn_b64 v[74:75], v93, v[80:81] offset:65408
    v_cvt_pk_bf16_f32 v76, v76, v77
    v_cvt_pk_bf16_f32 v77, v78, v79
    ds_wrxchg_rtn_b64 v[72:73], v92, v[76:77] offset:65408
    s_setprio 2
    v_mfma_f32_4x4x4_16b_bf16 v[80:83], v[8:9], v[106:107], 0
    v_mfma_f32_4x4x4_16b_bf16 v[76:79], v[8:9], v[104:105], 0
    v_cmp_lt_u32 s[48:49], v5, v95
    s_nop 2
    v_pk_mul_f32 v[80:81], v[80:81], v[14:15] op_sel:[0,1] op_sel_hi:[1,1]
    v_pk_mul_f32 v[82:83], v[82:83], v[14:15] op_sel:[0,1] op_sel_hi:[1,1]
    v_pk_mul_f32 v[76:77], v[76:77], v[14:15] op_sel:[0,0] op_sel_hi:[1,0]
    v_pk_mul_f32 v[78:79], v[78:79], v[14:15] op_sel:[0,0] op_sel_hi:[1,0]
    v_and_b32 v47, 0x0fffffff, v31
    buffer_load_dword v30, v47, s[8:11], 0 offen offset:16
    s_mov_b64 exec, s[6:7]
    v_add_u32 v47, 8, v47
    v_lshrrev_b32 v31, 2, v31
    s_mov_b64 exec, -1
    buffer_load_dwordx2 v[28:29], v47, s[8:11], 0 offen
    v_and_b32 v47, 0x3f0, v3
    s_cmp_lg_u32 s56, 0
    s_cbranch_scc1 L2_m11
    s_mul_i32 s3, s33, 1280000
    s_add_u32 s3, s3, s100
    s_add_u32 s3, s3, 352768
    buffer_load_dwordx4 v[124:127], v47, s[24:27], s3 offen offset:2048
L2_m11:
    v_and_b32 v47, 0x3f0, v3
    s_cmp_lg_u32 s56, 0
    s_cbranch_scc1 L2_m12
    s_mul_i32 s3, s33, 1280000
    s_add_u32 s3, s3, s100
    s_add_u32 s3, s3, 352768
    buffer_load_dwordx4 v[116:119], v47, s[24:27], s3 offen offset:0
L2_m12:
    s_waitcnt vmcnt(4)
    v_and_b32 v46, 0x20000000, v27
    v_lshrrev_b32 v47, 14, v23
    v_bitop3_b32 v47, v47, v5, v46 bitop3:0xea
    ds_read_b64 v[102:103], v47
    v_and_b32 v99, 0x10000000, v27
    v_lshrrev_b32 v47, 14, v22
    v_bitop3_b32 v47, v47, v5, v99 bitop3:0xea
    ds_read_b64 v[100:101], v47
    s_waitcnt lgkmcnt(2)
    v_cmp_ne_u64 s[50:51], v[72:73], v[68:69]
    v_cmpx_ne_u64 s[54:55], v[74:75], v[70:71]
    s_and_b64 s[82:83], s[54:55], s[80:81]
    s_cbranch_scc1 L2_c13
L2_d13:
    v_mov_b64 v[84:85], v[70:71]
    v_mov_b32 v7, v93
    v_mov_b64 v[86:87], v[74:75]
    s_or_b64 s[80:81], s[80:81], s[54:55]
    s_mov_b64 exec, s[50:51]
    s_and_b64 s[82:83], s[50:51], s[80:81]
    s_cbranch_scc1 L2_c14
L2_d14:
    v_mov_b64 v[84:85], v[68:69]
    v_mov_b32 v7, v92
    v_mov_b64 v[86:87], v[72:73]
    s_mov_b64 exec, -1
    s_or_b64 s[80:81], s[80:81], s[50:51]
    s_and_b64 exec, s[48:49], s[80:81]
    v_mfma_f32_4x4x4_16b_bf16 v[80:83], v[12:13], v[84:85], 0
    v_mov_b32 v95, v7
    s_andn2_b64 s[80:81], s[80:81], s[48:49]
    v_mfma_f32_4x4x4_16b_bf16 v[80:83], v[10:11], v[86:87], v[80:83]
    s_mov_b64 exec, -1
    ds_read_b64 v[70:71], v95 offset:65408
    ds_read_b64 v[68:69], v94 offset:65408
    v_bitop3_b32 v92, v22, v5, v99 bitop3:0xea
    v_bitop3_b32 v93, v23, v5, v46 bitop3:0xea
    v_perm_b32 v15, v23, v26, s45
    v_bitop3_b32 v46, v23, 0.5, -0.5 bitop3:0xa8
    v_perm_b32 v14, v22, v26, s44
    v_bitop3_b32 v47, v22, 0.5, -0.5 bitop3:0xa8
    v_bitop3_b32 v15, v6, v15, v46 bitop3:0xca
    v_bitop3_b32 v14, v6, v14, v47 bitop3:0xca
    s_waitcnt lgkmcnt(1)
    v_mfma_f32_4x4x4_16b_bf16 v[80:83], v[10:11], v[70:71], v[80:83]
    s_waitcnt lgkmcnt(0)
    v_mfma_f32_4x4x4_16b_bf16 v[76:79], v[10:11], v[68:69], v[76:79]
    s_nop 2
    v_cvt_pk_bf16_f32 v80, v80, v81
    v_cvt_pk_bf16_f32 v81, v82, v83
    ds_wrxchg_rtn_b64 v[74:75], v95, v[80:81] offset:65408
    v_cvt_pk_bf16_f32 v76, v76, v77
    v_cvt_pk_bf16_f32 v77, v78, v79
    ds_wrxchg_rtn_b64 v[72:73], v94, v[76:77] offset:65408
    s_setprio 1
    v_mfma_f32_4x4x4_16b_bf16 v[80:83], v[8:9], v[102:103], 0
    v_mfma_f32_4x4x4_16b_bf16 v[76:79], v[8:9], v[100:101], 0
    s_nop 3
    v_pk_mul_f32 v[80:81], v[80:81], v[14:15] op_sel:[0,1] op_sel_hi:[1,1]
    v_pk_mul_f32 v[82:83], v[82:83], v[14:15] op_sel:[0,1] op_sel_hi:[1,1]
    v_pk_mul_f32 v[76:77], v[76:77], v[14:15] op_sel:[0,0] op_sel_hi:[1,0]
    v_pk_mul_f32 v[78:79], v[78:79], v[14:15] op_sel:[0,0] op_sel_hi:[1,0]
    v_and_b32 v47, 0x3f0, v3
    s_cmp_lg_u32 s56, 0
    s_cbranch_scc1 L2_m15
    s_mul_i32 s3, s33, 1280000
    s_add_u32 s3, s3, s100
    s_add_u32 s3, s3, 352768
    buffer_load_dwordx4 v[120:123], v47, s[24:27], s3 offen offset:1024
L2_m15:
    v_sub_u16 v88, v60, v52
    v_and_b32 v89, 3, v52
    v_add3_u32 v99, v88, v89, 3
    v_and_b32 v99, -4, v99
    v_max_u32 v99, 4, v99
    v_and_b32 v97, 0xfffc, v52
    v_bfm_b32 v96, v88, v89
    v_add_u32_dpp v91, v99, v99 row_shr:1 row_mask:0xf bank_mask:0xf bound_ctrl:1
    v_mad_u32_u24 v97, v97, 5, v2
    v_cmp_lt_u32 vcc, 16, v99
    v_add_u32_dpp v91, v91, v91 row_shr:2 row_mask:0xf bank_mask:0xf bound_ctrl:1
    v_sub_u32 v98, s38, v99
    v_lshrrev_b64 v[52:53], 16, v[52:53]
    v_add_u32_dpp v91, v91, v91 row_shr:4 row_mask:0xf bank_mask:0xf bound_ctrl:1
    v_lshrrev_b64 v[60:61], 16, v[60:61]
    s_mov_b32 s101, 0
    v_add_u32_dpp v91, v91, v91 row_shr:8 row_mask:0xf bank_mask:0xf bound_ctrl:1
    s_nop 1
    v_add_u32_dpp v91, v91, v91 row_bcast:15 row_mask:0xa bank_mask:0xf
    s_nop 1
    v_add_u32_dpp v91, v91, v91 row_bcast:31 row_mask:0xc bank_mask:0xf
    v_add_u32 v98, v98, v91
    v_readlane_b32 s37, v91, 63
    s_cbranch_vccnz L2_xo16
L2_xp16:
    v_and_b32 v46, 0x80000000, v27
    v_lshrrev_b32 v47, 14, v25
    v_bitop3_b32 v47, v47, v5, v46 bitop3:0xea
    ds_read_b64 v[106:107], v47
    v_and_b32 v99, 0x40000000, v27
    v_lshrrev_b32 v47, 14, v24
    v_bitop3_b32 v47, v47, v5, v99 bitop3:0xea
    ds_read_b64 v[104:105], v47
    s_waitcnt lgkmcnt(2)
    v_cmp_ne_u64 s[50:51], v[72:73], v[68:69]
    v_cmpx_ne_u64 s[54:55], v[74:75], v[70:71]
    s_and_b64 s[82:83], s[54:55], s[80:81]
    s_cbranch_scc1 L2_c17
L2_d17:
    v_mov_b64 v[84:85], v[70:71]
    v_mov_b32 v7, v95
    v_mov_b64 v[86:87], v[74:75]
    s_or_b64 s[80:81], s[80:81], s[54:55]
    s_mov_b64 exec, s[50:51]
    s_and_b64 s[82:83], s[50:51], s[80:81]
    s_cbranch_scc1 L2_c18
L2_d18:
    v_mov_b64 v[84:85], v[68:69]
    v_mov_b32 v7, v94
    v_mov_b64 v[86:87], v[72:73]
    s_mov_b64 exec, -1
    s_or_b64 s[80:81], s[80:81], s[50:51]
    ds_read_b64 v[70:71], v93 offset:65408
    ds_read_b64 v[68:69], v92 offset:65408
    v_bitop3_b32 v94, v24, v5, v99 bitop3:0xea
    v_bitop3_b32 v95, v25, v5, v46 bitop3:0xea
    v_perm_b32 v15, v25, v26, s47
    v_bitop3_b32 v46, v25, 0.5, -0.5 bitop3:0xa8
    v_perm_b32 v14, v24, v26, s46
    v_bitop3_b32 v47, v24, 0.5, -0.5 bitop3:0xa8
    v_bitop3_b32 v15, v6, v15, v46 bitop3:0xca
    v_bitop3_b32 v14, v6, v14, v47 bitop3:0xca
    s_waitcnt lgkmcnt(1)
    v_mfma_f32_4x4x4_16b_bf16 v[80:83], v[10:11], v[70:71], v[80:83]
    s_waitcnt lgkmcnt(0)
    v_mfma_f32_4x4x4_16b_bf16 v[76:79], v[10:11], v[68:69], v[76:79]
    s_nop 2
    v_cvt_pk_bf16_f32 v80, v80, v81
    v_cvt_pk_bf16_f32 v81, v82, v83
    ds_wrxchg_rtn_b64 v[74:75], v93, v[80:81] offset:65408
    v_cvt_pk_bf16_f32 v76, v76, v77
    v_cvt_pk_bf16_f32 v77, v78, v79
    ds_wrxchg_rtn_b64 v[72:73], v92, v[76:77] offset:65408
    v_mfma_f32_4x4x4_16b_bf16 v[80:83], v[8:9], v[106:107], 0
    v_mfma_f32_4x4x4_16b_bf16 v[76:79], v[8:9], v[104:105], 0
    v_cmp_lt_u32 s[84:85], v5, v94
    s_nop 2
    v_pk_mul_f32 v[80:81], v[80:81], v[14:15] op_sel:[0,1] op_sel_hi:[1,1]
    v_pk_mul_f32 v[82:83], v[82:83], v[14:15] op_sel:[0,1] op_sel_hi:[1,1]
    v_pk_mul_f32 v[76:77], v[76:77], v[14:15] op_sel:[0,0] op_sel_hi:[1,0]
    v_pk_mul_f32 v[78:79], v[78:79], v[14:15] op_sel:[0,0] op_sel_hi:[1,0]
    v_and_b32 v47, 0x3f0, v3
    s_cmp_lg_u32 s56, 0
    s_cbranch_scc1 L2_m19
    s_mul_i32 s3, s33, 1280000
    s_add_u32 s3, s3, s38
    s_add_u32 s3, s3, 320000
    buffer_load_dwordx4 v[108:111], v47, s[24:27], s3 offen offset:0
L2_m19:
    v_and_b32 v47, 0x3f0, v3
    s_cmp_lg_u32 s56, 0
    s_cbranch_scc1 L2_m20
    s_mul_i32 s3, s33, 1280000
    s_add_u32 s3, s3, s38
    s_add_u32 s3, s3, 320000
    buffer_load_dwordx4 v[112:115], v47, s[24:27], s3 offen offset:1024
L2_m20:
    v_and_b32 v47, 0x0fffffff, v40
    v_mov_b32 v21, v40
    buffer_load_dwordx2 v[16:17], v47, s[8:11], 0 offen
    buffer_load_dwordx3 v[18:20], v47, s[8:11], 0 offen offset:8
    s_waitcnt vmcnt(2)
    s_mov_b64 exec, s[6:7]
    v_lshrrev_b32 v30, 16, v30
    s_mov_b64 exec, -1
    v_and_b32 v46, 0x20000000, v31
    v_lshrrev_b32 v47, 14, v29
    v_bitop3_b32 v47, v47, v5, v46 bitop3:0xea
    ds_read_b64 v[102:103], v47
    v_and_b32 v99, 0x10000000, v31
    v_lshrrev_b32 v47, 14, v28
    v_bitop3_b32 v47, v47, v5, v99 bitop3:0xea
    ds_read_b64 v[100:101], v47
    s_waitcnt lgkmcnt(2)
    v_cmp_ne_u64 s[50:51], v[72:73], v[68:69]
    v_cmpx_ne_u64 s[54:55], v[74:75], v[70:71]
    s_and_b64 s[82:83], s[54:55], s[80:81]
    s_cbranch_scc1 L2_c21
L2_d21:
    v_mov_b64 v[84:85], v[70:71]
    v_mov_b32 v7, v93
    v_mov_b64 v[86:87], v[74:75]
    s_or_b64 s[80:81], s[80:81], s[54:55]
    s_mov_b64 exec, s[50:51]
    s_and_b64 s[82:83], s[50:51], s[80:81]
    s_cbranch_scc1 L2_c22
L2_d22:
    v_mov_b64 v[84:85], v[68:69]
    v_mov_b32 v7, v92
    v_mov_b64 v[86:87], v[72:73]
    s_mov_b64 exec, -1
    s_or_b64 s[80:81], s[80:81], s[50:51]
    s_and_b64 exec, s[84:85], s[80:81]
    v_mfma_f32_4x4x4_16b_bf16 v[76:79], v[12:13], v[84:85], 0
    v_mov_b32 v94, v7
    s_andn2_b64 s[80:81], s[80:81], s[84:85]
    v_mfma_f32_4x4x4_16b_bf16 v[76:79], v[10:11], v[86:87], v[76:79]
    s_mov_b64 exec, -1
    ds_read_b64 v[70:71], v95 offset:65408
    ds_read_b64 v[68:69], v94 offset:65408
    v_bitop3_b32 v92, v28, v5, v99 bitop3:0xea
    v_bitop3_b32 v93, v29, v5, v46 bitop3:0xea
    v_perm_b32 v15, v29, v30, s45
    v_bitop3_b32 v46, v29, 0.5, -0.5 bitop3:0xa8
    v_perm_b32 v14, v28, v30, s44
    v_bitop3_b32 v47, v28, 0.5, -0.5 bitop3:0xa8
    v_bitop3_b32 v15, v6, v15, v46 bitop3:0xca
    v_bitop3_b32 v14, v6, v14, v47 bitop3:0xca
    s_waitcnt lgkmcnt(1)
    v_mfma_f32_4x4x4_16b_bf16 v[80:83], v[10:11], v[70:71], v[80:83]
    s_waitcnt lgkmcnt(0)
    v_mfma_f32_4x4x4_16b_bf16 v[76:79], v[10:11], v[68:69], v[76:79]
    s_nop 2
    v_cvt_pk_bf16_f32 v80, v80, v81
    v_cvt_pk_bf16_f32 v81, v82, v83
    ds_wrxchg_rtn_b64 v[74:75], v95, v[80:81] offset:65408
    v_cvt_pk_bf16_f32 v76, v76, v77
    v_cvt_pk_bf16_f32 v77, v78, v79
    ds_wrxchg_rtn_b64 v[72:73], v94, v[76:77] offset:65408
    s_setprio 0
    v_mfma_f32_4x4x4_16b_bf16 v[80:83], v[8:9], v[102:103], 0
    v_mfma_f32_4x4x4_16b_bf16 v[76:79], v[8:9], v[100:101], 0
    v_cmp_lt_u32 s[48:49], v5, v93
    s_nop 2
    v_pk_mul_f32 v[80:81], v[80:81], v[14:15] op_sel:[0,1] op_sel_hi:[1,1]
    v_pk_mul_f32 v[82:83], v[82:83], v[14:15] op_sel:[0,1] op_sel_hi:[1,1]
    v_pk_mul_f32 v[76:77], v[76:77], v[14:15] op_sel:[0,0] op_sel_hi:[1,0]
    v_pk_mul_f32 v[78:79], v[78:79], v[14:15] op_sel:[0,0] op_sel_hi:[1,0]
    s_add_u32 s40, s40, 0x50000
    v_and_b32 v47, 0x0fffffff, v41
    v_mov_b32 v27, v41
    buffer_load_dwordx2 v[22:23], v47, s[8:11], 0 offen
    buffer_load_dwordx3 v[24:26], v47, s[8:11], 0 offen offset:8
    v_and_b32 v46, 0x80000000, v39
    v_lshrrev_b32 v47, 14, v37
    v_bitop3_b32 v47, v47, v5, v46 bitop3:0xea
    ds_read_b64 v[102:103], v47
    v_and_b32 v99, 0x40000000, v39
    v_lshrrev_b32 v47, 14, v36
    v_bitop3_b32 v47, v47, v5, v99 bitop3:0xea
    ds_read_b64 v[100:101], v47
    v_and_b32 v46, 0x20000000, v39
    v_lshrrev_b32 v47, 14, v35
    v_bitop3_b32 v47, v47, v5, v46 bitop3:0xea
    ds_read_b64 v[106:107], v47
    v_and_b32 v99, 0x10000000, v39
    v_lshrrev_b32 v47, 14, v34
    v_bitop3_b32 v47, v47, v5, v99 bitop3:0xea
    ds_read_b64 v[104:105], v47
    s_waitcnt lgkmcnt(4)
    v_cmp_ne_u64 s[50:51], v[72:73], v[68:69]
    v_cmpx_ne_u64 s[54:55], v[74:75], v[70:71]
    s_and_b64 s[82:83], s[54:55], s[80:81]
    s_cbranch_scc1 L2_c23
L2_d23:
    v_mov_b64 v[84:85], v[70:71]
    v_mov_b32 v7, v95
    v_mov_b64 v[86:87], v[74:75]
    s_or_b64 s[80:81], s[80:81], s[54:55]
    s_mov_b64 exec, s[50:51]
    s_and_b64 s[82:83], s[50:51], s[80:81]
    s_cbranch_scc1 L2_c24
L2_d24:
    v_mov_b64 v[84:85], v[68:69]
    v_mov_b32 v7, v94
    v_mov_b64 v[86:87], v[72:73]
    s_mov_b64 exec, -1
    s_or_b64 s[80:81], s[80:81], s[50:51]
    s_and_b64 exec, s[48:49], s[80:81]
    v_mfma_f32_4x4x4_16b_bf16 v[80:83], v[12:13], v[84:85], 0
    v_mov_b32 v93, v7
    s_andn2_b64 s[80:81], s[80:81], s[48:49]
    v_mfma_f32_4x4x4_16b_bf16 v[80:83], v[10:11], v[86:87], v[80:83]
    s_mov_b64 exec, -1
    ds_read_b64 v[70:71], v93 offset:65408
    ds_read_b64 v[68:69], v92 offset:65408
    v_bitop3_b32 v94, v34, v5, v99 bitop3:0xea
    v_bitop3_b32 v95, v35, v5, v46 bitop3:0xea
    v_perm_b32 v15, v35, v38, s45
    v_bitop3_b32 v46, v35, 0.5, -0.5 bitop3:0xa8
    v_perm_b32 v14, v34, v38, s44
    v_bitop3_b32 v47, v34, 0.5, -0.5 bitop3:0xa8
    v_bitop3_b32 v15, v6, v15, v46 bitop3:0xca
    v_bitop3_b32 v14, v6, v14, v47 bitop3:0xca
    s_waitcnt lgkmcnt(1)
    v_mfma_f32_4x4x4_16b_bf16 v[80:83], v[10:11], v[70:71], v[80:83]
    s_waitcnt lgkmcnt(0)
    v_mfma_f32_4x4x4_16b_bf16 v[76:79], v[10:11], v[68:69], v[76:79]
    s_nop 2
    v_cvt_pk_bf16_f32 v80, v80, v81
    v_cvt_pk_bf16_f32 v81, v82, v83
    ds_wrxchg_rtn_b64 v[74:75], v93, v[80:81] offset:65408
    v_cvt_pk_bf16_f32 v76, v76, v77
    v_cvt_pk_bf16_f32 v77, v78, v79
    ds_wrxchg_rtn_b64 v[72:73], v92, v[76:77] offset:65408
    s_barrier
    s_setprio 3
    s_waitcnt vmcnt(4)
    v_subrev_u32 v88, s38, v3
    ds_write_b128 v88, v[124:127] offset:34816
    s_add_u32 s3, s40, 4096
    buffer_load_dwordx4 v[124:127], v3, s[16:19], s3 offen
    s_waitcnt vmcnt(5)
    v_subrev_u32 v88, s38, v3
    ds_write_b128 v88, v[116:119] offset:32768
    buffer_load_dwordx4 v[116:119], v3, s[16:19], s40 offen offset:2048
    s_waitcnt vmcnt(6)
    v_subrev_u32 v88, s38, v3
    ds_write_b128 v88, v[120:123] offset:33792
    buffer_load_dwordx4 v[120:123], v3, s[16:19], s40 offen offset:3072
    v_mfma_f32_4x4x4_16b_bf16 v[80:83], v[8:9], v[106:107], 0
    v_mfma_f32_4x4x4_16b_bf16 v[76:79], v[8:9], v[104:105], 0
    s_nop 3
    v_pk_mul_f32 v[80:81], v[80:81], v[14:15] op_sel:[0,1] op_sel_hi:[1,1]
    v_pk_mul_f32 v[82:83], v[82:83], v[14:15] op_sel:[0,1] op_sel_hi:[1,1]
    v_pk_mul_f32 v[76:77], v[76:77], v[14:15] op_sel:[0,0] op_sel_hi:[1,0]
    v_pk_mul_f32 v[78:79], v[78:79], v[14:15] op_sel:[0,0] op_sel_hi:[1,0]
    v_and_b32 v47, 0x0fffffff, v42
    v_mov_b32 v31, v42
    buffer_load_dword v30, v47, s[8:11], 0 offen offset:16
    s_mov_b64 exec, s[6:7]
    v_add_u32 v47, 8, v47
    v_lshrrev_b32 v31, 2, v31
    s_mov_b64 exec, -1
    buffer_load_dwordx2 v[28:29], v47, s[8:11], 0 offen
    v_mov_b32 v44, v43
    s_cmp_gt_u32 s37, 1024
    s_cbranch_scc1 L2_xs25
    s_cmp_lg_u32 s101, 0
    s_cbranch_scc1 L2_xa25
L2_xb25:
    v_lshlrev_b32 v89, 16, v96
    v_add_u32 v90, 60, v97
    v_bitop3_b32 v90, v89, v45, v90 bitop3:0x6a
    ds_write_b32 v98, v90 offset:12
    v_lshlrev_b32 v89, 20, v96
    v_add_u32 v90, 40, v97
    v_bitop3_b32 v90, v89, v45, v90 bitop3:0x6a
    ds_write_b32 v98, v90 offset:8
    v_lshlrev_b32 v89, 24, v96
    v_add_u32 v90, 20, v97
    v_bitop3_b32 v90, v89, v45, v90 bitop3:0x6a
    ds_write_b32 v98, v90 offset:4
    v_lshlrev_b32 v89, 28, v96
    v_bitop3_b32 v90, v89, v45, v97 bitop3:0x6a
    ds_write_b32 v98, v90 offset:0
    v_mov_b32_dpp v91, v64 quad_perm:[1,1,1,1] row_mask:0xf bank_mask:0xf
    v_and_b32 v89, 3, v91
    v_and_b32 v97, 0xfffc, v91
    v_sub_u16_dpp v88, v64, v91 quad_perm:[3,3,3,3] row_mask:0xf bank_mask:0xf
    v_mad_u32_u24 v97, v97, 5, v4
    v_add_u32 v99, v88, v89
    v_bfm_b32 v96, v88, v89
    v_cmp_lt_u32 s[58:59], 16, v99
    v_lshlrev_b32 v89, v1, v96
    v_and_b32 v89, v45, v89
    v_cmp_ne_u32 vcc, 0, v89
    v_xor_b32 v90, v97, v89
    s_add_u32 s3, s37, s38
    v_mbcnt_lo_u32_b32 v98, vcc_lo, 0
    v_mbcnt_hi_u32_b32 v98, vcc_hi, v98
    s_bcnt1_i32_b64 s41, vcc
    v_lshl_add_u32 v98, v98, 2, s3
    s_lshl2_add_u32 s37, s41, s37
    s_mov_b64 exec, vcc
    ds_write_b32 v98, v90
    s_mov_b64 exec, -1
    s_cmp_lg_u64 s[58:59], 0
    s_cbranch_scc1 L2_xe25
L2_xr25:
    v_add_u32 v98, s37, v0
    v_mov_b32 v90, -1
    ds_write_b32 v98, v90
    v_add_u32 v98, s38, v0
    ds_read2st64_b32 v[40:41], v0 offset0:0 offset1:1
    ds_read_b32 v43, v0 offset:512
    v_lshrrev_b32 v98, 1, v98
    v_and_b32 v98, -4, v98
    ds_read_b32 v42, v98 offset:768
    s_sub_u32 s3, s37, 768
    s_cmp_gt_u32 s3, 128
    s_cbranch_scc1 L2_xf25
L2_xg25:
    s_setprio 2
    s_waitcnt lgkmcnt(12)
    v_cmp_ne_u64 s[50:51], v[72:73], v[68:69]
    v_cmpx_ne_u64 s[54:55], v[74:75], v[70:71]
    s_and_b64 s[82:83], s[54:55], s[80:81]
    s_cbranch_scc1 L2_c26
L2_d26:
    v_mov_b64 v[84:85], v[70:71]
    v_mov_b32 v7, v93
    v_mov_b64 v[86:87], v[74:75]
    s_or_b64 s[80:81], s[80:81], s[54:55]
    s_mov_b64 exec, s[50:51]
    s_and_b64 s[82:83], s[50:51], s[80:81]
    s_cbranch_scc1 L2_c27
L2_d27:
    v_mov_b64 v[84:85], v[68:69]
    v_mov_b32 v7, v92
    v_mov_b64 v[86:87], v[72:73]
    s_mov_b64 exec, -1
    s_or_b64 s[80:81], s[80:81], s[50:51]
    ds_read_b64 v[70:71], v95 offset:65408
    ds_read_b64 v[68:69], v94 offset:65408
    v_and_b32 v46, 0x40000000, v39
    v_bitop3_b32 v92, v36, v5, v46 bitop3:0xea
    v_and_b32 v46, 0x80000000, v39
    v_bitop3_b32 v93, v37, v5, v46 bitop3:0xea
    v_perm_b32 v15, v37, v38, s47
    v_bitop3_b32 v46, v37, 0.5, -0.5 bitop3:0xa8
    v_perm_b32 v14, v36, v38, s46
    v_bitop3_b32 v47, v36, 0.5, -0.5 bitop3:0xa8
    v_bitop3_b32 v15, v6, v15, v46 bitop3:0xca
    v_bitop3_b32 v14, v6, v14, v47 bitop3:0xca
    s_setprio 1
    s_waitcnt lgkmcnt(1)
    v_mfma_f32_4x4x4_16b_bf16 v[80:83], v[10:11], v[70:71], v[80:83]
    s_waitcnt lgkmcnt(0)
    v_mfma_f32_4x4x4_16b_bf16 v[76:79], v[10:11], v[68:69], v[76:79]
    s_nop 2
    v_cvt_pk_bf16_f32 v80, v80, v81
    v_cvt_pk_bf16_f32 v81, v82, v83
    ds_wrxchg_rtn_b64 v[74:75], v95, v[80:81] offset:65408
    v_cvt_pk_bf16_f32 v76, v76, v77
    v_cvt_pk_bf16_f32 v77, v78, v79
    ds_wrxchg_rtn_b64 v[72:73], v94, v[76:77] offset:65408
    s_setprio 0
    s_waitcnt vmcnt(9)
    v_subrev_u32 v88, s100, v3
    ds_write_b128 v88, v[108:111] offset:0
    s_waitcnt vmcnt(9)
    v_subrev_u32 v88, s100, v3
    ds_write_b128 v88, v[112:115] offset:1024
    v_mfma_f32_4x4x4_16b_bf16 v[80:83], v[8:9], v[102:103], 0
    v_mfma_f32_4x4x4_16b_bf16 v[76:79], v[8:9], v[100:101], 0
    v_cmp_lt_u32 s[84:85], v5, v92
    s_nop 2
    v_pk_mul_f32 v[80:81], v[80:81], v[14:15] op_sel:[0,1] op_sel_hi:[1,1]
    v_pk_mul_f32 v[82:83], v[82:83], v[14:15] op_sel:[0,1] op_sel_hi:[1,1]
    v_pk_mul_f32 v[76:77], v[76:77], v[14:15] op_sel:[0,0] op_sel_hi:[1,0]
    v_pk_mul_f32 v[78:79], v[78:79], v[14:15] op_sel:[0,0] op_sel_hi:[1,0]
    s_add_u32 s42, s42, 1
    s_waitcnt lgkmcnt(0)
    s_add_u32 s24, s30, 0xec45000
    s_addc_u32 s25, s31, 0
    s_mov_b32 s26, 0x100
    s_mov_b32 s27, 0x20000
    s_barrier
    s_bitcmp1_b32 s36, s42
    s_cbranch_scc1 L2_slow
L2_ret1:
    s_setprio 3
    s_bitcmp1_b32 s43, s42
    s_cbranch_scc1 L2_oa28
L2_ob28:
    v_and_b32 v47, 0x0fffffff, v44
    v_mov_b32 v39, v44
    buffer_load_dwordx2 v[34:35], v47, s[8:11], 0 offen
    buffer_load_dwordx3 v[36:38], v47, s[8:11], 0 offen offset:8
    s_waitcnt vmcnt(9)
    v_and_b32 v46, 0x20000000, v21
    v_lshrrev_b32 v47, 14, v17
    v_bitop3_b32 v47, v47, v5, v46 bitop3:0xea
    ds_read_b64 v[106:107], v47
    v_and_b32 v99, 0x10000000, v21
    v_lshrrev_b32 v47, 14, v16
    v_bitop3_b32 v47, v47, v5, v99 bitop3:0xea
    ds_read_b64 v[104:105], v47
    v_cmp_ne_u64 s[50:51], v[72:73], v[68:69]
    v_cmpx_ne_u64 s[54:55], v[74:75], v[70:71]
    s_and_b64 s[82:83], s[54:55], s[80:81]
    s_cbranch_scc1 L2_c29
L2_d29:
    v_mov_b64 v[84:85], v[70:71]
    v_mov_b32 v7, v95
    v_mov_b64 v[86:87], v[74:75]
    s_or_b64 s[80:81], s[80:81], s[54:55]
    s_mov_b64 exec, s[50:51]
    s_and_b64 s[82:83], s[50:51], s[80:81]
    s_cbranch_scc1 L2_c30
L2_d30:
    v_mov_b64 v[84:85], v[68:69]
    v_mov_b32 v7, v94
    v_mov_b64 v[86:87], v[72:73]
    s_mov_b64 exec, -1
    s_or_b64 s[80:81], s[80:81], s[50:51]
    s_and_b64 exec, s[84:85], s[80:81]
    v_mfma_f32_4x4x4_16b_bf16 v[76:79], v[12:13], v[84:85], 0
    v_mov_b32 v92, v7
    s_andn2_b64 s[80:81], s[80:81], s[84:85]
    v_mfma_f32_4x4x4_16b_bf16 v[76:79], v[10:11], v[86:87], v[76:79]
    s_mov_b64 exec, -1
    ds_read_b64 v[70:71], v93 offset:65408
    ds_read_b64 v[68:69], v92 offset:65408
    v_bitop3_b32 v94, v16, v5, v99 bitop3:0xea
    v_bitop3_b32 v95, v17, v5, v46 bitop3:0xea
    v_perm_b32 v15, v17, v20, s45
    v_bitop3_b32 v46, v17, 0.5, -0.5 bitop3:0xa8
    v_perm_b32 v14, v16, v20, s44
    v_bitop3_b32 v47, v16, 0.5, -0.5 bitop3:0xa8
    v_bitop3_b32 v15, v6, v15, v46 bitop3:0xca
    v_bitop3_b32 v14, v6, v14, v47 bitop3:0xca
    s_waitcnt lgkmcnt(1)
    v_mfma_f32_4x4x4_16b_bf16 v[80:83], v[10:11], v[70:71], v[80:83]
    s_waitcnt lgkmcnt(0)
    v_mfma_f32_4x4x4_16b_bf16 v[76:79], v[10:11], v[68:69], v[76:79]
    s_nop 2
    v_cvt_pk_bf16_f32 v80, v80, v81
    v_cvt_pk_bf16_f32 v81, v82, v83
    ds_wrxchg_rtn_b64 v[74:75], v93, v[80:81] offset:65408
    v_cvt_pk_bf16_f32 v76, v76, v77
    v_cvt_pk_bf16_f32 v77, v78, v79
    ds_wrxchg_rtn_b64 v[72:73], v92, v[76:77] offset:65408
    v_mfma_f32_4x4x4_16b_bf16 v[80:83], v[8:9], v[106:107], 0
    v_mfma_f32_4x4x4_16b_bf16 v[76:79], v[8:9], v[104:105], 0
    v_cmp_lt_u32 s[84:85], v5, v94
    s_nop 2
    v_pk_mul_f32 v[80:81], v[80:81], v[14:15] op_sel:[0,1] op_sel_hi:[1,1]
    v_pk_mul_f32 v[82:83], v[82:83], v[14:15] op_sel:[0,1] op_sel_hi:[1,1]
    v_pk_mul_f32 v[76:77], v[76:77], v[14:15] op_sel:[0,0] op_sel_hi:[1,0]
    v_pk_mul_f32 v[78:79], v[78:79], v[14:15] op_sel:[0,0] op_sel_hi:[1,0]
    buffer_load_dwordx4 v[108:111], v3, s[16:19], s40 offen offset:0
    v_and_b32 v46, 0x80000000, v21
    v_lshrrev_b32 v47, 14, v19
    v_bitop3_b32 v47, v47, v5, v46 bitop3:0xea
    ds_read_b64 v[102:103], v47
    v_and_b32 v99, 0x40000000, v21
    v_lshrrev_b32 v47, 14, v18
    v_bitop3_b32 v47, v47, v5, v99 bitop3:0xea
    ds_read_b64 v[100:101], v47
    s_waitcnt lgkmcnt(2)
    v_cmp_ne_u64 s[50:51], v[72:73], v[68:69]
    v_cmpx_ne_u64 s[54:55], v[74:75], v[70:71]
    s_and_b64 s[82:83], s[54:55], s[80:81]
    s_cbranch_scc1 L2_c31
L2_d31:
    v_mov_b64 v[84:85], v[70:71]
    v_mov_b32 v7, v93
    v_mov_b64 v[86:87], v[74:75]
    s_or_b64 s[80:81], s[80:81], s[54:55]
    s_mov_b64 exec, s[50:51]
    s_and_b64 s[82:83], s[50:51], s[80:81]
    s_cbranch_scc1 L2_c32
L2_d32:
    v_mov_b64 v[84:85], v[68:69]
    v_mov_b32 v7, v92
    v_mov_b64 v[86:87], v[72:73]
    s_mov_b64 exec, -1
    s_or_b64 s[80:81], s[80:81], s[50:51]
    s_and_b64 exec, s[84:85], s[80:81]
    v_mfma_f32_4x4x4_16b_bf16 v[76:79], v[12:13], v[84:85], 0
    v_mov_b32 v94, v7
    s_andn2_b64 s[80:81], s[80:81], s[84:85]
    v_mfma_f32_4x4x4_16b_bf16 v[76:79], v[10:11], v[86:87], v[76:79]
    s_mov_b64 exec, -1
    ds_read_b64 v[70:71], v95 offset:65408
    ds_read_b64 v[68:69], v94 offset:65408
    v_bitop3_b32 v92, v18, v5, v99 bitop3:0xea
    v_bitop3_b32 v93, v19, v5, v46 bitop3:0xea
    v_perm_b32 v15, v19, v20, s47
    v_bitop3_b32 v46, v19, 0.5, -0.5 bitop3:0xa8
    v_perm_b32 v14, v18, v20, s46
    v_bitop3_b32 v47, v18, 0.5, -0.5 bitop3:0xa8
    v_bitop3_b32 v15, v6, v15, v46 bitop3:0xca
    v_bitop3_b32 v14, v6, v14, v47 bitop3:0xca
    s_waitcnt lgkmcnt(1)
    v_mfma_f32_4x4x4_16b_bf16 v[80:83], v[10:11], v[70:71], v[80:83]
    s_waitcnt lgkmcnt(0)
    v_mfma_f32_4x4x4_16b_bf16 v[76:79], v[10:11], v[68:69], v[76:79]
    s_nop 2
    v_cvt_pk_bf16_f32 v80, v80, v81
    v_cvt_pk_bf16_f32 v81, v82, v83
    ds_wrxchg_rtn_b64 v[74:75], v95, v[80:81] offset:65408
    v_cvt_pk_bf16_f32 v76, v76, v77
    v_cvt_pk_bf16_f32 v77, v78, v79
    ds_wrxchg_rtn_b64 v[72:73], v94, v[76:77] offset:65408
    s_setprio 2
    v_mfma_f32_4x4x4_16b_bf16 v[80:83], v[8:9], v[102:103], 0
    v_mfma_f32_4x4x4_16b_bf16 v[76:79], v[8:9], v[100:101], 0
    v_cmp_lt_u32 s[48:49], v5, v93
    s_nop 2
    v_pk_mul_f32 v[80:81], v[80:81], v[14:15] op_sel:[0,1] op_sel_hi:[1,1]
    v_pk_mul_f32 v[82:83], v[82:83], v[14:15] op_sel:[0,1] op_sel_hi:[1,1]
    v_pk_mul_f32 v[76:77], v[76:77], v[14:15] op_sel:[0,0] op_sel_hi:[1,0]
    v_pk_mul_f32 v[78:79], v[78:79], v[14:15] op_sel:[0,0] op_sel_hi:[1,0]
    v_and_b32 v47, 0x0fffffff, v40
    v_mov_b32 v21, v40
    buffer_load_dwordx2 v[16:17], v47, s[8:11], 0 offen
    buffer_load_dwordx3 v[18:20], v47, s[8:11], 0 offen offset:8
    s_waitcnt vmcnt(10)
    v_and_b32 v46, 0x20000000, v27
    v_lshrrev_b32 v47, 14, v23
    v_bitop3_b32 v47, v47, v5, v46 bitop3:0xea
    ds_read_b64 v[106:107], v47
    v_and_b32 v99, 0x10000000, v27
    v_lshrrev_b32 v47, 14, v22
    v_bitop3_b32 v47, v47, v5, v99 bitop3:0xea
    ds_read_b64 v[104:105], v47
    s_waitcnt lgkmcnt(2)
    v_cmp_ne_u64 s[50:51], v[72:73], v[68:69]
    v_cmpx_ne_u64 s[54:55], v[74:75], v[70:71]
    s_and_b64 s[82:83], s[54:55], s[80:81]
    s_cbranch_scc1 L2_c33
L2_d33:
    v_mov_b64 v[84:85], v[70:71]
    v_mov_b32 v7, v95
    v_mov_b64 v[86:87], v[74:75]
    s_or_b64 s[80:81], s[80:81], s[54:55]
    s_mov_b64 exec, s[50:51]
    s_and_b64 s[82:83], s[50:51], s[80:81]
    s_cbranch_scc1 L2_c34
L2_d34:
    v_mov_b64 v[84:85], v[68:69]
    v_mov_b32 v7, v94
    v_mov_b64 v[86:87], v[72:73]
    s_mov_b64 exec, -1
    s_or_b64 s[80:81], s[80:81], s[50:51]
    s_and_b64 exec, s[48:49], s[80:81]
    v_mfma_f32_4x4x4_16b_bf16 v[80:83], v[12:13], v[84:85], 0
    v_mov_b32 v93, v7
    s_andn2_b64 s[80:81], s[80:81], s[48:49]
    v_mfma_f32_4x4x4_16b_bf16 v[80:83], v[10:11], v[86:87], v[80:83]
    s_mov_b64 exec, -1
    ds_read_b64 v[70:71], v93 offset:65408
    ds_read_b64 v[68:69], v92 offset:65408
    v_bitop3_b32 v94, v22, v5, v99 bitop3:0xea
    v_bitop3_b32 v95, v23, v5, v46 bitop3:0xea
    v_perm_b32 v15, v23, v26, s45
    v_bitop3_b32 v46, v23, 0.5, -0.5 bitop3:0xa8
    v_perm_b32 v14, v22, v26, s44
    v_bitop3_b32 v47, v22, 0.5, -0.5 bitop3:0xa8
    v_bitop3_b32 v15, v6, v15, v46 bitop3:0xca
    v_bitop3_b32 v14, v6, v14, v47 bitop3:0xca
    s_waitcnt lgkmcnt(1)
    v_mfma_f32_4x4x4_16b_bf16 v[80:83], v[10:11], v[70:71], v[80:83]
    s_waitcnt lgkmcnt(0)
    v_mfma_f32_4x4x4_16b_bf16 v[76:79], v[10:11], v[68:69], v[76:79]
    s_nop 2
    v_cvt_pk_bf16_f32 v80, v80, v81
    v_cvt_pk_bf16_f32 v81, v82, v83
    ds_wrxchg_rtn_b64 v[74:75], v93, v[80:81] offset:65408
    v_cvt_pk_bf16_f32 v76, v76, v77
    v_cvt_pk_bf16_f32 v77, v78, v79
    ds_wrxchg_rtn_b64 v[72:73], v92, v[76:77] offset:65408
    s_setprio 1
    v_mfma_f32_4x4x4_16b_bf16 v[80:83], v[8:9], v[106:107], 0
    v_mfma_f32_4x4x4_16b_bf16 v[76:79], v[8:9], v[104:105], 0
    s_nop 3
    v_pk_mul_f32 v[80:81], v[80:81], v[14:15] op_sel:[0,1] op_sel_hi:[1,1]
    v_pk_mul_f32 v[82:83], v[82:83], v[14:15] op_sel:[0,1] op_sel_hi:[1,1]
    v_pk_mul_f32 v[76:77], v[76:77], v[14:15] op_sel:[0,0] op_sel_hi:[1,0]
    v_pk_mul_f32 v[78:79], v[78:79], v[14:15] op_sel:[0,0] op_sel_hi:[1,0]
    s_bitcmp1_b32 s43, s42
    s_cbranch_scc1 L2_oa35
L2_ob35:
    buffer_load_dwordx4 v[112:115], v3, s[16:19], s40 offen offset:1024
    v_sub_u16 v88, v62, v54
    v_and_b32 v89, 3, v54
    v_add3_u32 v99, v88, v89, 3
    v_and_b32 v99, -4, v99
    v_max_u32 v99, 4, v99
    v_and_b32 v97, 0xfffc, v54
    v_bfm_b32 v96, v88, v89
    v_add_u32_dpp v91, v99, v99 row_shr:1 row_mask:0xf bank_mask:0xf bound_ctrl:1
    v_mad_u32_u24 v97, v97, 5, v2
    v_cmp_lt_u32 vcc, 16, v99
    v_add_u32_dpp v91, v91, v91 row_shr:2 row_mask:0xf bank_mask:0xf bound_ctrl:1
    v_sub_u32 v98, s38, v99
    v_lshrrev_b64 v[54:55], 16, v[54:55]
    v_add_u32_dpp v91, v91, v91 row_shr:4 row_mask:0xf bank_mask:0xf bound_ctrl:1
    v_lshrrev_b64 v[62:63], 16, v[62:63]
    s_mov_b32 s101, 0
    v_add_u32_dpp v91, v91, v91 row_shr:8 row_mask:0xf bank_mask:0xf bound_ctrl:1
    s_nop 1
    v_add_u32_dpp v91, v91, v91 row_bcast:15 row_mask:0xa bank_mask:0xf
    s_nop 1
    v_add_u32_dpp v91, v91, v91 row_bcast:31 row_mask:0xc bank_mask:0xf
    v_add_u32 v98, v98, v91
    v_readlane_b32 s37, v91, 63
    s_cbranch_vccnz L2_xo36
L2_xp36:
    v_and_b32 v46, 0x80000000, v27
    v_lshrrev_b32 v47, 14, v25
    v_bitop3_b32 v47, v47, v5, v46 bitop3:0xea
    ds_read_b64 v[102:103], v47
    v_and_b32 v99, 0x40000000, v27
    v_lshrrev_b32 v47, 14, v24
    v_bitop3_b32 v47, v47, v5, v99 bitop3:0xea
    ds_read_b64 v[100:101], v47
    s_waitcnt lgkmcnt(2)
    v_cmp_ne_u64 s[50:51], v[72:73], v[68:69]
    v_cmpx_ne_u64 s[54:55], v[74:75], v[70:71]
    s_and_b64 s[82:83], s[54:55], s[80:81]
    s_cbranch_scc1 L2_c37
L2_d37:
    v_mov_b64 v[84:85], v[70:71]
    v_mov_b32 v7, v93
    v_mov_b64 v[86:87], v[74:75]
    s_or_b64 s[80:81], s[80:81], s[54:55]
    s_mov_b64 exec, s[50:51]
    s_and_b64 s[82:83], s[50:51], s[80:81]
    s_cbranch_scc1 L2_c38
L2_d38:
    v_mov_b64 v[84:85], v[68:69]
    v_mov_b32 v7, v92
    v_mov_b64 v[86:87], v[72:73]
    s_mov_b64 exec, -1
    s_or_b64 s[80:81], s[80:81], s[50:51]
    ds_read_b64 v[70:71], v95 offset:65408
    ds_read_b64 v[68:69], v94 offset:65408
    v_bitop3_b32 v92, v24, v5, v99 bitop3:0xea
    v_bitop3_b32 v93, v25, v5, v46 bitop3:0xea
    v_perm_b32 v15, v25, v26, s47
    v_bitop3_b32 v46, v25, 0.5, -0.5 bitop3:0xa8
    v_perm_b32 v14, v24, v26, s46
    v_bitop3_b32 v47, v24, 0.5, -0.5 bitop3:0xa8
    v_bitop3_b32 v15, v6, v15, v46 bitop3:0xca
    v_bitop3_b32 v14, v6, v14, v47 bitop3:0xca
    s_waitcnt lgkmcnt(1)
    v_mfma_f32_4x4x4_16b_bf16 v[80:83], v[10:11], v[70:71], v[80:83]
    s_waitcnt lgkmcnt(0)
    v_mfma_f32_4x4x4_16b_bf16 v[76:79], v[10:11], v[68:69], v[76:79]
    s_nop 2
    v_cvt_pk_bf16_f32 v80, v80, v81
    v_cvt_pk_bf16_f32 v81, v82, v83
    ds_wrxchg_rtn_b64 v[74:75], v95, v[80:81] offset:65408
    v_cvt_pk_bf16_f32 v76, v76, v77
    v_cvt_pk_bf16_f32 v77, v78, v79
    ds_wrxchg_rtn_b64 v[72:73], v94, v[76:77] offset:65408
    v_mfma_f32_4x4x4_16b_bf16 v[80:83], v[8:9], v[102:103], 0
    v_mfma_f32_4x4x4_16b_bf16 v[76:79], v[8:9], v[100:101], 0
    v_cmp_lt_u32 s[84:85], v5, v92
    s_nop 2
    v_pk_mul_f32 v[80:81], v[80:81], v[14:15] op_sel:[0,1] op_sel_hi:[1,1]
    v_pk_mul_f32 v[82:83], v[82:83], v[14:15] op_sel:[0,1] op_sel_hi:[1,1]
    v_pk_mul_f32 v[76:77], v[76:77], v[14:15] op_sel:[0,0] op_sel_hi:[1,0]
    v_pk_mul_f32 v[78:79], v[78:79], v[14:15] op_sel:[0,0] op_sel_hi:[1,0]
    v_and_b32 v47, 0x0fffffff, v41
    v_mov_b32 v27, v41
    buffer_load_dwordx2 v[22:23], v47, s[8:11], 0 offen
    buffer_load_dwordx3 v[24:26], v47, s[8:11], 0 offen offset:8
    s_waitcnt vmcnt(8)
    s_mov_b64 exec, s[6:7]
    v_lshrrev_b32 v30, 16, v30
    s_mov_b64 exec, -1
    v_and_b32 v46, 0x20000000, v31
    v_lshrrev_b32 v47, 14, v29
    v_bitop3_b32 v47, v47, v5, v46 bitop3:0xea
    ds_read_b64 v[106:107], v47
    v_and_b32 v99, 0x10000000, v31
    v_lshrrev_b32 v47, 14, v28
    v_bitop3_b32 v47, v47, v5, v99 bitop3:0xea
    ds_read_b64 v[104:105], v47
    s_waitcnt lgkmcnt(2)
    v_cmp_ne_u64 s[50:51], v[72:73], v[68:69]
    v_cmpx_ne_u64 s[54:55], v[74:75], v[70:71]
    s_and_b64 s[82:83], s[54:55], s[80:81]
    s_cbranch_scc1 L2_c39
L2_d39:
    v_mov_b64 v[84:85], v[70:71]
    v_mov_b32 v7, v95
    v_mov_b64 v[86:87], v[74:75]
    s_or_b64 s[80:81], s[80:81], s[54:55]
    s_mov_b64 exec, s[50:51]
    s_and_b64 s[82:83], s[50:51], s[80:81]
    s_cbranch_scc1 L2_c40
L2_d40:
    v_mov_b64 v[84:85], v[68:69]
    v_mov_b32 v7, v94
    v_mov_b64 v[86:87], v[72:73]
    s_mov_b64 exec, -1
    s_or_b64 s[80:81], s[80:81], s[50:51]
    s_and_b64 exec, s[84:85], s[80:81]
    v_mfma_f32_4x4x4_16b_bf16 v[76:79], v[12:13], v[84:85], 0
    v_mov_b32 v92, v7
    s_andn2_b64 s[80:81], s[80:81], s[84:85]
    v_mfma_f32_4x4x4_16b_bf16 v[76:79], v[10:11], v[86:87], v[76:79]
    s_mov_b64 exec, -1
    ds_read_b64 v[70:71], v93 offset:65408
    ds_read_b64 v[68:69], v92 offset:65408
    v_bitop3_b32 v94, v28, v5, v99 bitop3:0xea
    v_bitop3_b32 v95, v29, v5, v46 bitop3:0xea
    v_perm_b32 v15, v29, v30, s45
    v_bitop3_b32 v46, v29, 0.5, -0.5 bitop3:0xa8
    v_perm_b32 v14, v28, v30, s44
    v_bitop3_b32 v47, v28, 0.5, -0.5 bitop3:0xa8
    v_bitop3_b32 v15, v6, v15, v46 bitop3:0xca
    v_bitop3_b32 v14, v6, v14, v47 bitop3:0xca
    s_waitcnt lgkmcnt(1)
    v_mfma_f32_4x4x4_16b_bf16 v[80:83], v[10:11], v[70:71], v[80:83]
    s_waitcnt lgkmcnt(0)
    v_mfma_f32_4x4x4_16b_bf16 v[76:79], v[10:11], v[68:69], v[76:79]
    s_nop 2
    v_cvt_pk_bf16_f32 v80, v80, v81
    v_cvt_pk_bf16_f32 v81, v82, v83
    ds_wrxchg_rtn_b64 v[74:75], v93, v[80:81] offset:65408
    v_cvt_pk_bf16_f32 v76, v76, v77
    v_cvt_pk_bf16_f32 v77, v78, v79
    ds_wrxchg_rtn_b64 v[72:73], v92, v[76:77] offset:65408
    s_setprio 0
    v_mfma_f32_4x4x4_16b_bf16 v[80:83], v[8:9], v[106:107], 0
    v_mfma_f32_4x4x4_16b_bf16 v[76:79], v[8:9], v[104:105], 0
    v_cmp_lt_u32 s[48:49], v5, v95
    s_nop 2
    v_pk_mul_f32 v[80:81], v[80:81], v[14:15] op_sel:[0,1] op_sel_hi:[1,1]
    v_pk_mul_f32 v[82:83], v[82:83], v[14:15] op_sel:[0,1] op_sel_hi:[1,1]
    v_pk_mul_f32 v[76:77], v[76:77], v[14:15] op_sel:[0,0] op_sel_hi:[1,0]
    v_pk_mul_f32 v[78:79], v[78:79], v[14:15] op_sel:[0,0] op_sel_hi:[1,0]
    s_add_u32 s40, s40, 0x50000
    s_waitcnt vmcnt(6)
    v_and_b32 v46, 0x80000000, v39
    v_lshrrev_b32 v47, 14, v37
    v_bitop3_b32 v47, v47, v5, v46 bitop3:0xea
    ds_read_b64 v[106:107], v47
    v_and_b32 v99, 0x40000000, v39
    v_lshrrev_b32 v47, 14, v36
    v_bitop3_b32 v47, v47, v5, v99 bitop3:0xea
    ds_read_b64 v[104:105], v47
    v_and_b32 v46, 0x20000000, v39
    v_lshrrev_b32 v47, 14, v35
    v_bitop3_b32 v47, v47, v5, v46 bitop3:0xea
    ds_read_b64 v[102:103], v47
    v_and_b32 v99, 0x10000000, v39
    v_lshrrev_b32 v47, 14, v34
    v_bitop3_b32 v47, v47, v5, v99 bitop3:0xea
    ds_read_b64 v[100:101], v47
    s_waitcnt lgkmcnt(4)
    v_cmp_ne_u64 s[50:51], v[72:73], v[68:69]
    v_cmpx_ne_u64 s[54:55], v[74:75], v[70:71]
    s_and_b64 s[82:83], s[54:55], s[80:81]
    s_cbranch_scc1 L2_c41
L2_d41:
    v_mov_b64 v[84:85], v[70:71]
    v_mov_b32 v7, v93
    v_mov_b64 v[86:87], v[74:75]
    s_or_b64 s[80:81], s[80:81], s[54:55]
    s_mov_b64 exec, s[50:51]
    s_and_b64 s[82:83], s[50:51], s[80:81]
    s_cbranch_scc1 L2_c42
L2_d42:
    v_mov_b64 v[84:85], v[68:69]
    v_mov_b32 v7, v92
    v_mov_b64 v[86:87], v[72:73]
    s_mov_b64 exec, -1
    s_or_b64 s[80:81], s[80:81], s[50:51]
    s_and_b64 exec, s[48:49], s[80:81]
    v_mfma_f32_4x4x4_16b_bf16 v[80:83], v[12:13], v[84:85], 0
    v_mov_b32 v95, v7
    s_andn2_b64 s[80:81], s[80:81], s[48:49]
    v_mfma_f32_4x4x4_16b_bf16 v[80:83], v[10:11], v[86:87], v[80:83]
    s_mov_b64 exec, -1
    ds_read_b64 v[70:71], v95 offset:65408
    ds_read_b64 v[68:69], v94 offset:65408
    v_bitop3_b32 v92, v34, v5, v99 bitop3:0xea
    v_bitop3_b32 v93, v35, v5, v46 bitop3:0xea
    v_perm_b32 v15, v35, v38, s45
    v_bitop3_b32 v46, v35, 0.5, -0.5 bitop3:0xa8
    v_perm_b32 v14, v34, v38, s44
    v_bitop3_b32 v47, v34, 0.5, -0.5 bitop3:0xa8
    v_bitop3_b32 v15, v6, v15, v46 bitop3:0xca
    v_bitop3_b32 v14, v6, v14, v47 bitop3:0xca
    s_waitcnt lgkmcnt(1)
    v_mfma_f32_4x4x4_16b_bf16 v[80:83], v[10:11], v[70:71], v[80:83]
    s_waitcnt lgkmcnt(0)
    v_mfma_f32_4x4x4_16b_bf16 v[76:79], v[10:11], v[68:69], v[76:79]
    s_nop 2
    v_cvt_pk_bf16_f32 v80, v80, v81
    v_cvt_pk_bf16_f32 v81, v82, v83
    ds_wrxchg_rtn_b64 v[74:75], v95, v[80:81] offset:65408
    v_cvt_pk_bf16_f32 v76, v76, v77
    v_cvt_pk_bf16_f32 v77, v78, v79
    ds_wrxchg_rtn_b64 v[72:73], v94, v[76:77] offset:65408
    s_barrier
    s_setprio 3
    s_mov_b32 m0, s100
    s_nop 0
    ds_write_addtid_b32 v124 offset:34816
    ds_write_addtid_b32 v125 offset:35072
    ds_write_addtid_b32 v126 offset:35328
    ds_write_addtid_b32 v127 offset:35584
    s_add_u32 s3, s40, 4096
    buffer_load_dwordx4 v[124:127], v3, s[16:19], s3 offen
    ds_write_addtid_b32 v116 offset:32768
    ds_write_addtid_b32 v117 offset:33024
    ds_write_addtid_b32 v118 offset:33280
    ds_write_addtid_b32 v119 offset:33536
    buffer_load_dwordx4 v[116:119], v3, s[16:19], s40 offen offset:2048
    ds_write_addtid_b32 v120 offset:33792
    ds_write_addtid_b32 v121 offset:34048
    ds_write_addtid_b32 v122 offset:34304
    ds_write_addtid_b32 v123 offset:34560
    buffer_load_dwordx4 v[120:123], v3, s[16:19], s40 offen offset:3072
    v_mfma_f32_4x4x4_16b_bf16 v[80:83], v[8:9], v[102:103], 0
    v_mfma_f32_4x4x4_16b_bf16 v[76:79], v[8:9], v[100:101], 0
    s_nop 3
    v_pk_mul_f32 v[80:81], v[80:81], v[14:15] op_sel:[0,1] op_sel_hi:[1,1]
    v_pk_mul_f32 v[82:83], v[82:83], v[14:15] op_sel:[0,1] op_sel_hi:[1,1]
    v_pk_mul_f32 v[76:77], v[76:77], v[14:15] op_sel:[0,0] op_sel_hi:[1,0]
    v_pk_mul_f32 v[78:79], v[78:79], v[14:15] op_sel:[0,0] op_sel_hi:[1,0]
    v_and_b32 v47, 0x0fffffff, v42
    v_mov_b32 v31, v42
    buffer_load_dword v30, v47, s[8:11], 0 offen offset:16
    s_mov_b64 exec, s[6:7]
    v_add_u32 v47, 8, v47
    v_lshrrev_b32 v31, 2, v31
    s_mov_b64 exec, -1
    buffer_load_dwordx2 v[28:29], v47, s[8:11], 0 offen
    v_mov_b32 v44, v43
    s_cmp_gt_u32 s37, 1024
    s_cbranch_scc1 L2_xs43
    s_cmp_lg_u32 s101, 0
    s_cbranch_scc1 L2_xa43
L2_xb43:
    v_lshlrev_b32 v89, 16, v96
    v_add_u32 v90, 60, v97
    v_bitop3_b32 v90, v89, v45, v90 bitop3:0x6a
    ds_write_b32 v98, v90 offset:12
    v_lshlrev_b32 v89, 20, v96
    v_add_u32 v90, 40, v97
    v_bitop3_b32 v90, v89, v45, v90 bitop3:0x6a
    ds_write_b32 v98, v90 offset:8
    v_lshlrev_b32 v89, 24, v96
    v_add_u32 v90, 20, v97
    v_bitop3_b32 v90, v89, v45, v90 bitop3:0x6a
    ds_write_b32 v98, v90 offset:4
    v_lshlrev_b32 v89, 28, v96
    v_bitop3_b32 v90, v89, v45, v97 bitop3:0x6a
    ds_write_b32 v98, v90 offset:0
    v_mov_b32_dpp v91, v66 quad_perm:[1,1,1,1] row_mask:0xf bank_mask:0xf
    v_and_b32 v89, 3, v91
    v_and_b32 v97, 0xfffc, v91
    v_sub_u16_dpp v88, v66, v91 quad_perm:[3,3,3,3] row_mask:0xf bank_mask:0xf
    v_mad_u32_u24 v97, v97, 5, v4
    v_add_u32 v99, v88, v89
    v_bfm_b32 v96, v88, v89
    v_cmp_lt_u32 s[58:59], 16, v99
    v_lshlrev_b32 v89, v1, v96
    v_and_b32 v89, v45, v89
    v_cmp_ne_u32 vcc, 0, v89
    v_xor_b32 v90, v97, v89
    s_add_u32 s3, s37, s38
    v_mbcnt_lo_u32_b32 v98, vcc_lo, 0
    v_mbcnt_hi_u32_b32 v98, vcc_hi, v98
    s_bcnt1_i32_b64 s41, vcc
    v_lshl_add_u32 v98, v98, 2, s3
    s_lshl2_add_u32 s37, s41, s37
    s_mov_b64 exec, vcc
    ds_write_b32 v98, v90
    s_mov_b64 exec, -1
    s_cmp_lg_u64 s[58:59], 0
    s_cbranch_scc1 L2_xe43
L2_xr43:
    v_add_u32 v98, s37, v0
    v_mov_b32 v90, -1
    ds_write_b32 v98, v90
    v_add_u32 v98, s38, v0
    ds_read2st64_b32 v[40:41], v0 offset0:0 offset1:1
    ds_read_b32 v43, v0 offset:512
    v_lshrrev_b32 v98, 1, v98
    v_and_b32 v98, -4, v98
    ds_read_b32 v42, v98 offset:768
    s_sub_u32 s3, s37, 768
    s_cmp_gt_u32 s3, 128
    s_cbranch_scc1 L2_xf43
L2_xg43:
    v_lshrrev_b64 v[64:65], 16, v[64:65]
    v_lshrrev_b64 v[66:67], 16, v[66:67]
    s_setprio 2
    s_waitcnt lgkmcnt(14)
    v_cmp_ne_u64 s[50:51], v[72:73], v[68:69]
    v_cmpx_ne_u64 s[54:55], v[74:75], v[70:71]
    s_and_b64 s[82:83], s[54:55], s[80:81]
    s_cbranch_scc1 L2_c44
L2_d44:
    v_mov_b64 v[84:85], v[70:71]
    v_mov_b32 v7, v95
    v_mov_b64 v[86:87], v[74:75]
    s_or_b64 s[80:81], s[80:81], s[54:55]
    s_mov_b64 exec, s[50:51]
    s_and_b64 s[82:83], s[50:51], s[80:81]
    s_cbranch_scc1 L2_c45
L2_d45:
    v_mov_b64 v[84:85], v[68:69]
    v_mov_b32 v7, v94
    v_mov_b64 v[86:87], v[72:73]
    s_mov_b64 exec, -1
    s_or_b64 s[80:81], s[80:81], s[50:51]
    ds_read_b64 v[70:71], v93 offset:65408
    ds_read_b64 v[68:69], v92 offset:65408
    v_and_b32 v46, 0x40000000, v39
    v_bitop3_b32 v94, v36, v5, v46 bitop3:0xea
    v_and_b32 v46, 0x80000000, v39
    v_bitop3_b32 v95, v37, v5, v46 bitop3:0xea
    v_perm_b32 v15, v37, v38, s47
    v_bitop3_b32 v46, v37, 0.5, -0.5 bitop3:0xa8
    v_perm_b32 v14, v36, v38, s46
    v_bitop3_b32 v47, v36, 0.5, -0.5 bitop3:0xa8
    v_bitop3_b32 v15, v6, v15, v46 bitop3:0xca
    v_bitop3_b32 v14, v6, v14, v47 bitop3:0xca
    s_setprio 1
    s_waitcnt lgkmcnt(1)
    v_mfma_f32_4x4x4_16b_bf16 v[80:83], v[10:11], v[70:71], v[80:83]
    s_waitcnt lgkmcnt(0)
    v_mfma_f32_4x4x4_16b_bf16 v[76:79], v[10:11], v[68:69], v[76:79]
    s_nop 2
    v_cvt_pk_bf16_f32 v80, v80, v81
    v_cvt_pk_bf16_f32 v81, v82, v83
    ds_wrxchg_rtn_b64 v[74:75], v93, v[80:81] offset:65408
    v_cvt_pk_bf16_f32 v76, v76, v77
    v_cvt_pk_bf16_f32 v77, v78, v79
    ds_wrxchg_rtn_b64 v[72:73], v92, v[76:77] offset:65408
    v_and_b32 v88, 0x0fffffff, v44
    v_mov_b32 v39, v44
    buffer_load_dwordx2 v[34:35], v88, s[8:11], 0 offen
    buffer_load_dwordx3 v[36:38], v88, s[8:11], 0 offen offset:8
    s_setprio 0
    s_waitcnt vmcnt(12)
    s_mov_b32 m0, s38
    s_nop 0
    ds_write_addtid_b32 v108 offset:0
    ds_write_addtid_b32 v109 offset:256
    ds_write_addtid_b32 v110 offset:512
    ds_write_addtid_b32 v111 offset:768
    s_waitcnt vmcnt(9)
    ds_write_addtid_b32 v112 offset:1024
    ds_write_addtid_b32 v113 offset:1280
    ds_write_addtid_b32 v114 offset:1536
    ds_write_addtid_b32 v115 offset:1792
    v_mfma_f32_4x4x4_16b_bf16 v[80:83], v[8:9], v[106:107], 0
    v_mfma_f32_4x4x4_16b_bf16 v[76:79], v[8:9], v[104:105], 0
    v_cmp_lt_u32 s[84:85], v5, v94
    s_nop 2
    v_pk_mul_f32 v[80:81], v[80:81], v[14:15] op_sel:[0,1] op_sel_hi:[1,1]
    v_pk_mul_f32 v[82:83], v[82:83], v[14:15] op_sel:[0,1] op_sel_hi:[1,1]
    v_pk_mul_f32 v[76:77], v[76:77], v[14:15] op_sel:[0,0] op_sel_hi:[1,0]
    v_pk_mul_f32 v[78:79], v[78:79], v[14:15] op_sel:[0,0] op_sel_hi:[1,0]
    s_add_u32 s42, s42, 1
    s_waitcnt lgkmcnt(0)
L2_loop:
    s_barrier
    s_bitcmp1_b32 s36, s42
    s_cbranch_scc1 L2_slow
L2_ret2:
    s_setprio 3
    s_bitcmp1_b32 s43, s42
    s_cbranch_scc1 L2_oa46
L2_ob46:
    v_and_b32 v46, 0x20000000, v21
    v_lshrrev_b32 v47, 14, v17
    v_bitop3_b32 v47, v47, v5, v46 bitop3:0xea
    ds_read_b64 v[102:103], v47
    v_and_b32 v99, 0x10000000, v21
    v_lshrrev_b32 v47, 14, v16
    v_bitop3_b32 v47, v47, v5, v99 bitop3:0xea
    ds_read_b64 v[100:101], v47
    v_cmp_ne_u64 s[50:51], v[72:73], v[68:69]
    v_cmpx_ne_u64 s[54:55], v[74:75], v[70:71]
    s_and_b64 s[82:83], s[54:55], s[80:81]
    s_cbranch_scc1 L2_c47
L2_d47:
    v_mov_b64 v[84:85], v[70:71]
    v_mov_b32 v7, v93
    v_mov_b64 v[86:87], v[74:75]
    s_or_b64 s[80:81], s[80:81], s[54:55]
    s_mov_b64 exec, s[50:51]
    s_and_b64 s[82:83], s[50:51], s[80:81]
    s_cbranch_scc1 L2_c48
L2_d48:
    v_mov_b64 v[84:85], v[68:69]
    v_mov_b32 v7, v92
    v_mov_b64 v[86:87], v[72:73]
    s_mov_b64 exec, -1
    s_or_b64 s[80:81], s[80:81], s[50:51]
    s_and_b64 exec, s[84:85], s[80:81]
    v_mfma_f32_4x4x4_16b_bf16 v[76:79], v[12:13], v[84:85], 0
    v_mov_b32 v94, v7
    s_andn2_b64 s[80:81], s[80:81], s[84:85]
    v_mfma_f32_4x4x4_16b_bf16 v[76:79], v[10:11], v[86:87], v[76:79]
    s_mov_b64 exec, -1
    ds_read_b64 v[70:71], v95 offset:65408
    ds_read_b64 v[68:69], v94 offset:65408
    v_bitop3_b32 v92, v16, v5, v99 bitop3:0xea
    v_bitop3_b32 v93, v17, v5, v46 bitop3:0xea
    v_perm_b32 v15, v17, v20, s45
    v_bitop3_b32 v46, v17, 0.5, -0.5 bitop3:0xa8
    v_perm_b32 v14, v16, v20, s44
    v_bitop3_b32 v47, v16, 0.5, -0.5 bitop3:0xa8
    v_bitop3_b32 v15, v6, v15, v46 bitop3:0xca
    v_bitop3_b32 v14, v6, v14, v47 bitop3:0xca
    s_waitcnt lgkmcnt(1)
    v_mfma_f32_4x4x4_16b_bf16 v[80:83], v[10:11], v[70:71], v[80:83]
    s_waitcnt lgkmcnt(0)
    v_mfma_f32_4x4x4_16b_bf16 v[76:79], v[10:11], v[68:69], v[76:79]
    s_nop 2
    v_cvt_pk_bf16_f32 v80, v80, v81
    v_cvt_pk_bf16_f32 v81, v82, v83
    ds_wrxchg_rtn_b64 v[74:75], v95, v[80:81] offset:65408
    v_cvt_pk_bf16_f32 v76, v76, v77
    v_cvt_pk_bf16_f32 v77, v78, v79
    ds_wrxchg_rtn_b64 v[72:73], v94, v[76:77] offset:65408
    v_mfma_f32_4x4x4_16b_bf16 v[80:83], v[8:9], v[102:103], 0
    v_mfma_f32_4x4x4_16b_bf16 v[76:79], v[8:9], v[100:101], 0
    v_cmp_lt_u32 s[84:85], v5, v92
    s_nop 2
    v_pk_mul_f32 v[80:81], v[80:81], v[14:15] op_sel:[0,1] op_sel_hi:[1,1]
    v_pk_mul_f32 v[82:83], v[82:83], v[14:15] op_sel:[0,1] op_sel_hi:[1,1]
    v_pk_mul_f32 v[76:77], v[76:77], v[14:15] op_sel:[0,0] op_sel_hi:[1,0]
    v_pk_mul_f32 v[78:79], v[78:79], v[14:15] op_sel:[0,0] op_sel_hi:[1,0]
    buffer_load_dwordx4 v[108:111], v3, s[16:19], s40 offen offset:0
    v_and_b32 v46, 0x80000000, v21
    v_lshrrev_b32 v47, 14, v19
    v_bitop3_b32 v47, v47, v5, v46 bitop3:0xea
    ds_read_b64 v[106:107], v47
    v_and_b32 v99, 0x40000000, v21
    v_lshrrev_b32 v47, 14, v18
    v_bitop3_b32 v47, v47, v5, v99 bitop3:0xea
    ds_read_b64 v[104:105], v47
    s_waitcnt lgkmcnt(2)
    v_cmp_ne_u64 s[50:51], v[72:73], v[68:69]
    v_cmpx_ne_u64 s[54:55], v[74:75], v[70:71]
    s_and_b64 s[82:83], s[54:55], s[80:81]
    s_cbranch_scc1 L2_c49
L2_d49:
    v_mov_b64 v[84:85], v[70:71]
    v_mov_b32 v7, v95
    v_mov_b64 v[86:87], v[74:75]
    s_or_b64 s[80:81], s[80:81], s[54:55]
    s_mov_b64 exec, s[50:51]
    s_and_b64 s[82:83], s[50:51], s[80:81]
    s_cbranch_scc1 L2_c50
L2_d50:
    v_mov_b64 v[84:85], v[68:69]
    v_mov_b32 v7, v94
    v_mov_b64 v[86:87], v[72:73]
    s_mov_b64 exec, -1
    s_or_b64 s[80:81], s[80:81], s[50:51]
    s_and_b64 exec, s[84:85], s[80:81]
    v_mfma_f32_4x4x4_16b_bf16 v[76:79], v[12:13], v[84:85], 0
    v_mov_b32 v92, v7
    s_andn2_b64 s[80:81], s[80:81], s[84:85]
    v_mfma_f32_4x4x4_16b_bf16 v[76:79], v[10:11], v[86:87], v[76:79]
    s_mov_b64 exec, -1
    ds_read_b64 v[70:71], v93 offset:65408
    ds_read_b64 v[68:69], v92 offset:65408
    v_bitop3_b32 v94, v18, v5, v99 bitop3:0xea
    v_bitop3_b32 v95, v19, v5, v46 bitop3:0xea
    v_perm_b32 v15, v19, v20, s47
    v_bitop3_b32 v46, v19, 0.5, -0.5 bitop3:0xa8
    v_perm_b32 v14, v18, v20, s46
    v_bitop3_b32 v47, v18, 0.5, -0.5 bitop3:0xa8
    v_bitop3_b32 v15, v6, v15, v46 bitop3:0xca
    v_bitop3_b32 v14, v6, v14, v47 bitop3:0xca
    s_waitcnt lgkmcnt(1)
    v_mfma_f32_4x4x4_16b_bf16 v[80:83], v[10:11], v[70:71], v[80:83]
    s_waitcnt lgkmcnt(0)
    v_mfma_f32_4x4x4_16b_bf16 v[76:79], v[10:11], v[68:69], v[76:79]
    s_nop 2
    v_cvt_pk_bf16_f32 v80, v80, v81
    v_cvt_pk_bf16_f32 v81, v82, v83
    ds_wrxchg_rtn_b64 v[74:75], v93, v[80:81] offset:65408
    v_cvt_pk_bf16_f32 v76, v76, v77
    v_cvt_pk_bf16_f32 v77, v78, v79
    ds_wrxchg_rtn_b64 v[72:73], v92, v[76:77] offset:65408
    v_and_b32 v88, 0x0fffffff, v40
    v_mov_b32 v21, v40
    buffer_load_dwordx2 v[16:17], v88, s[8:11], 0 offen
    buffer_load_dwordx3 v[18:20], v88, s[8:11], 0 offen offset:8
    s_setprio 2
    v_mfma_f32_4x4x4_16b_bf16 v[80:83], v[8:9], v[106:107], 0
    v_mfma_f32_4x4x4_16b_bf16 v[76:79], v[8:9], v[104:105], 0
    v_cmp_lt_u32 s[48:49], v5, v95
    s_nop 2
    v_pk_mul_f32 v[80:81], v[80:81], v[14:15] op_sel:[0,1] op_sel_hi:[1,1]
    v_pk_mul_f32 v[82:83], v[82:83], v[14:15] op_sel:[0,1] op_sel_hi:[1,1]
    v_pk_mul_f32 v[76:77], v[76:77], v[14:15] op_sel:[0,0] op_sel_hi:[1,0]
    v_pk_mul_f32 v[78:79], v[78:79], v[14:15] op_sel:[0,0] op_sel_hi:[1,0]
    s_waitcnt vmcnt(10)
    v_and_b32 v46, 0x20000000, v27
    v_lshrrev_b32 v47, 14, v23
    v_bitop3_b32 v47, v47, v5, v46 bitop3:0xea
    ds_read_b64 v[102:103], v47
    v_and_b32 v99, 0x10000000, v27
    v_lshrrev_b32 v47, 14, v22
    v_bitop3_b32 v47, v47, v5, v99 bitop3:0xea
    ds_read_b64 v[100:101], v47
    s_waitcnt lgkmcnt(2)
    v_cmp_ne_u64 s[50:51], v[72:73], v[68:69]
    v_cmpx_ne_u64 s[54:55], v[74:75], v[70:71]
    s_and_b64 s[82:83], s[54:55], s[80:81]
    s_cbranch_scc1 L2_c51
L2_d51:
    v_mov_b64 v[84:85], v[70:71]
    v_mov_b32 v7, v93
    v_mov_b64 v[86:87], v[74:75]
    s_or_b64 s[80:81], s[80:81], s[54:55]
    s_mov_b64 exec, s[50:51]
    s_and_b64 s[82:83], s[50:51], s[80:81]
    s_cbranch_scc1 L2_c52
L2_d52:
    v_mov_b64 v[84:85], v[68:69]
    v_mov_b32 v7, v92
    v_mov_b64 v[86:87], v[72:73]
    s_mov_b64 exec, -1
    s_or_b64 s[80:81], s[80:81], s[50:51]
    s_and_b64 exec, s[48:49], s[80:81]
    v_mfma_f32_4x4x4_16b_bf16 v[80:83], v[12:13], v[84:85], 0
    v_mov_b32 v95, v7
    s_andn2_b64 s[80:81], s[80:81], s[48:49]
    v_mfma_f32_4x4x4_16b_bf16 v[80:83], v[10:11], v[86:87], v[80:83]
    s_mov_b64 exec, -1
    ds_read_b64 v[70:71], v95 offset:65408
    ds_read_b64 v[68:69], v94 offset:65408
    v_bitop3_b32 v92, v22, v5, v99 bitop3:0xea
    v_bitop3_b32 v93, v23, v5, v46 bitop3:0xea
    v_perm_b32 v15, v23, v26, s45
    v_bitop3_b32 v46, v23, 0.5, -0.5 bitop3:0xa8
    v_perm_b32 v14, v22, v26, s44
    v_bitop3_b32 v47, v22, 0.5, -0.5 bitop3:0xa8
    v_bitop3_b32 v15, v6, v15, v46 bitop3:0xca
    v_bitop3_b32 v14, v6, v14, v47 bitop3:0xca
    s_waitcnt lgkmcnt(1)
    v_mfma_f32_4x4x4_16b_bf16 v[80:83], v[10:11], v[70:71], v[80:83]
    s_waitcnt lgkmcnt(0)
    v_mfma_f32_4x4x4_16b_bf16 v[76:79], v[10:11], v[68:69], v[76:79]
    s_nop 2
    v_cvt_pk_bf16_f32 v80, v80, v81
    v_cvt_pk_bf16_f32 v81, v82, v83
    ds_wrxchg_rtn_b64 v[74:75], v95, v[80:81] offset:65408
    v_cvt_pk_bf16_f32 v76, v76, v77
    v_cvt_pk_bf16_f32 v77, v78, v79
    ds_wrxchg_rtn_b64 v[72:73], v94, v[76:77] offset:65408
    s_setprio 1
    v_mfma_f32_4x4x4_16b_bf16 v[80:83], v[8:9], v[102:103], 0
    v_mfma_f32_4x4x4_16b_bf16 v[76:79], v[8:9], v[100:101], 0
    s_nop 3
    v_pk_mul_f32 v[80:81], v[80:81], v[14:15] op_sel:[0,1] op_sel_hi:[1,1]
    v_pk_mul_f32 v[82:83], v[82:83], v[14:15] op_sel:[0,1] op_sel_hi:[1,1]
    v_pk_mul_f32 v[76:77], v[76:77], v[14:15] op_sel:[0,0] op_sel_hi:[1,0]
    v_pk_mul_f32 v[78:79], v[78:79], v[14:15] op_sel:[0,0] op_sel_hi:[1,0]
    s_bitcmp1_b32 s43, s42
    s_cbranch_scc1 L2_oa53
L2_ob53:
    buffer_load_dwordx4 v[112:115], v3, s[16:19], s40 offen offset:1024
    v_sub_u16 v88, v56, v48
    v_and_b32 v89, 3, v48
    v_add3_u32 v99, v88, v89, 3
    v_and_b32 v99, -4, v99
    v_max_u32 v99, 4, v99
    v_and_b32 v97, 0xfffc, v48
    v_bfm_b32 v96, v88, v89
    v_add_u32_dpp v91, v99, v99 row_shr:1 row_mask:0xf bank_mask:0xf bound_ctrl:1
    v_mad_u32_u24 v97, v97, 5, v2
    v_cmp_lt_u32 vcc, 16, v99
    v_add_u32_dpp v91, v91, v91 row_shr:2 row_mask:0xf bank_mask:0xf bound_ctrl:1
    v_sub_u32 v98, s38, v99
    v_lshrrev_b64 v[48:49], 16, v[48:49]
    v_add_u32_dpp v91, v91, v91 row_shr:4 row_mask:0xf bank_mask:0xf bound_ctrl:1
    v_lshrrev_b64 v[56:57], 16, v[56:57]
    s_mov_b32 s101, 0
    v_add_u32_dpp v91, v91, v91 row_shr:8 row_mask:0xf bank_mask:0xf bound_ctrl:1
    s_nop 1
    v_add_u32_dpp v91, v91, v91 row_bcast:15 row_mask:0xa bank_mask:0xf
    s_nop 1
    v_add_u32_dpp v91, v91, v91 row_bcast:31 row_mask:0xc bank_mask:0xf
    v_add_u32 v98, v98, v91
    v_readlane_b32 s37, v91, 63
    s_cbranch_vccnz L2_xo54
L2_xp54:
    v_and_b32 v46, 0x80000000, v27
    v_lshrrev_b32 v47, 14, v25
    v_bitop3_b32 v47, v47, v5, v46 bitop3:0xea
    ds_read_b64 v[106:107], v47
    v_and_b32 v99, 0x40000000, v27
    v_lshrrev_b32 v47, 14, v24
    v_bitop3_b32 v47, v47, v5, v99 bitop3:0xea
    ds_read_b64 v[104:105], v47
    s_waitcnt lgkmcnt(2)
    v_cmp_ne_u64 s[50:51], v[72:73], v[68:69]
    v_cmpx_ne_u64 s[54:55], v[74:75], v[70:71]
    s_and_b64 s[82:83], s[54:55], s[80:81]
    s_cbranch_scc1 L2_c55
L2_d55:
    v_mov_b64 v[84:85], v[70:71]
    v_mov_b32 v7, v95
    v_mov_b64 v[86:87], v[74:75]
    s_or_b64 s[80:81], s[80:81], s[54:55]
    s_mov_b64 exec, s[50:51]
    s_and_b64 s[82:83], s[50:51], s[80:81]
    s_cbranch_scc1 L2_c56
L2_d56:
    v_mov_b64 v[84:85], v[68:69]
    v_mov_b32 v7, v94
    v_mov_b64 v[86:87], v[72:73]
    s_mov_b64 exec, -1
    s_or_b64 s[80:81], s[80:81], s[50:51]
    ds_read_b64 v[70:71], v93 offset:65408
    ds_read_b64 v[68:69], v92 offset:65408
    v_bitop3_b32 v94, v24, v5, v99 bitop3:0xea
    v_bitop3_b32 v95, v25, v5, v46 bitop3:0xea
    v_perm_b32 v15, v25, v26, s47
    v_bitop3_b32 v46, v25, 0.5, -0.5 bitop3:0xa8
    v_perm_b32 v14, v24, v26, s46
    v_bitop3_b32 v47, v24, 0.5, -0.5 bitop3:0xa8
    v_bitop3_b32 v15, v6, v15, v46 bitop3:0xca
    v_bitop3_b32 v14, v6, v14, v47 bitop3:0xca
    s_waitcnt lgkmcnt(1)
    v_mfma_f32_4x4x4_16b_bf16 v[80:83], v[10:11], v[70:71], v[80:83]
    s_waitcnt lgkmcnt(0)
    v_mfma_f32_4x4x4_16b_bf16 v[76:79], v[10:11], v[68:69], v[76:79]
    s_nop 2
    v_cvt_pk_bf16_f32 v80, v80, v81
    v_cvt_pk_bf16_f32 v81, v82, v83
    ds_wrxchg_rtn_b64 v[74:75], v93, v[80:81] offset:65408
    v_cvt_pk_bf16_f32 v76, v76, v77
    v_cvt_pk_bf16_f32 v77, v78, v79
    ds_wrxchg_rtn_b64 v[72:73], v92, v[76:77] offset:65408
    v_and_b32 v88, 0x0fffffff, v41
    v_mov_b32 v27, v41
    buffer_load_dwordx2 v[22:23], v88, s[8:11], 0 offen
    buffer_load_dwordx3 v[24:26], v88, s[8:11], 0 offen offset:8
    v_mfma_f32_4x4x4_16b_bf16 v[80:83], v[8:9], v[106:107], 0
    v_mfma_f32_4x4x4_16b_bf16 v[76:79], v[8:9], v[104:105], 0
    v_cmp_lt_u32 s[84:85], v5, v94
    s_nop 2
    v_pk_mul_f32 v[80:81], v[80:81], v[14:15] op_sel:[0,1] op_sel_hi:[1,1]
    v_pk_mul_f32 v[82:83], v[82:83], v[14:15] op_sel:[0,1] op_sel_hi:[1,1]
    v_pk_mul_f32 v[76:77], v[76:77], v[14:15] op_sel:[0,0] op_sel_hi:[1,0]
    v_pk_mul_f32 v[78:79], v[78:79], v[14:15] op_sel:[0,0] op_sel_hi:[1,0]
    s_waitcnt vmcnt(8)
    s_mov_b64 exec, s[6:7]
    v_lshrrev_b32 v30, 16, v30
    s_mov_b64 exec, -1
    v_and_b32 v46, 0x20000000, v31
    v_lshrrev_b32 v47, 14, v29
    v_bitop3_b32 v47, v47, v5, v46 bitop3:0xea
    ds_read_b64 v[102:103], v47
    v_and_b32 v99, 0x10000000, v31
    v_lshrrev_b32 v47, 14, v28
    v_bitop3_b32 v47, v47, v5, v99 bitop3:0xea
    ds_read_b64 v[100:101], v47
    s_waitcnt lgkmcnt(2)
    v_cmp_ne_u64 s[50:51], v[72:73], v[68:69]
    v_cmpx_ne_u64 s[54:55], v[74:75], v[70:71]
    s_and_b64 s[82:83], s[54:55], s[80:81]
    s_cbranch_scc1 L2_c57
L2_d57:
    v_mov_b64 v[84:85], v[70:71]
    v_mov_b32 v7, v93
    v_mov_b64 v[86:87], v[74:75]
    s_or_b64 s[80:81], s[80:81], s[54:55]
    s_mov_b64 exec, s[50:51]
    s_and_b64 s[82:83], s[50:51], s[80:81]
    s_cbranch_scc1 L2_c58
L2_d58:
    v_mov_b64 v[84:85], v[68:69]
    v_mov_b32 v7, v92
    v_mov_b64 v[86:87], v[72:73]
    s_mov_b64 exec, -1
    s_or_b64 s[80:81], s[80:81], s[50:51]
    s_and_b64 exec, s[84:85], s[80:81]
    v_mfma_f32_4x4x4_16b_bf16 v[76:79], v[12:13], v[84:85], 0
    v_mov_b32 v94, v7
    s_andn2_b64 s[80:81], s[80:81], s[84:85]
    v_mfma_f32_4x4x4_16b_bf16 v[76:79], v[10:11], v[86:87], v[76:79]
    s_mov_b64 exec, -1
    ds_read_b64 v[70:71], v95 offset:65408
    ds_read_b64 v[68:69], v94 offset:65408
    v_bitop3_b32 v92, v28, v5, v99 bitop3:0xea
    v_bitop3_b32 v93, v29, v5, v46 bitop3:0xea
    v_perm_b32 v15, v29, v30, s45
    v_bitop3_b32 v46, v29, 0.5, -0.5 bitop3:0xa8
    v_perm_b32 v14, v28, v30, s44
    v_bitop3_b32 v47, v28, 0.5, -0.5 bitop3:0xa8
    v_bitop3_b32 v15, v6, v15, v46 bitop3:0xca
    v_bitop3_b32 v14, v6, v14, v47 bitop3:0xca
    s_waitcnt lgkmcnt(1)
    v_mfma_f32_4x4x4_16b_bf16 v[80:83], v[10:11], v[70:71], v[80:83]
    s_waitcnt lgkmcnt(0)
    v_mfma_f32_4x4x4_16b_bf16 v[76:79], v[10:11], v[68:69], v[76:79]
    s_nop 2
    v_cvt_pk_bf16_f32 v80, v80, v81
    v_cvt_pk_bf16_f32 v81, v82, v83
    ds_wrxchg_rtn_b64 v[74:75], v95, v[80:81] offset:65408
    v_cvt_pk_bf16_f32 v76, v76, v77
    v_cvt_pk_bf16_f32 v77, v78, v79
    ds_wrxchg_rtn_b64 v[72:73], v94, v[76:77] offset:65408
    s_setprio 0
    v_mfma_f32_4x4x4_16b_bf16 v[80:83], v[8:9], v[102:103], 0
    v_mfma_f32_4x4x4_16b_bf16 v[76:79], v[8:9], v[100:101], 0
    v_cmp_lt_u32 s[48:49], v5, v93
    s_nop 2
    v_pk_mul_f32 v[80:81], v[80:81], v[14:15] op_sel:[0,1] op_sel_hi:[1,1]
    v_pk_mul_f32 v[82:83], v[82:83], v[14:15] op_sel:[0,1] op_sel_hi:[1,1]
    v_pk_mul_f32 v[76:77], v[76:77], v[14:15] op_sel:[0,0] op_sel_hi:[1,0]
    v_pk_mul_f32 v[78:79], v[78:79], v[14:15] op_sel:[0,0] op_sel_hi:[1,0]
    s_add_u32 s40, s40, 0xfff24000
    v_and_b32 v47, 0x0fffffff, v42
    v_mov_b32 v31, v42
    buffer_load_dword v30, v47, s[8:11], 0 offen offset:16
    s_mov_b64 exec, s[6:7]
    v_add_u32 v47, 8, v47
    v_lshrrev_b32 v31, 2, v31
    s_mov_b64 exec, -1
    buffer_load_dwordx2 v[28:29], v47, s[8:11], 0 offen
    s_waitcnt vmcnt(8)
    v_and_b32 v46, 0x80000000, v39
    v_lshrrev_b32 v47, 14, v37
    v_bitop3_b32 v47, v47, v5, v46 bitop3:0xea
    ds_read_b64 v[102:103], v47
    v_and_b32 v99, 0x40000000, v39
    v_lshrrev_b32 v47, 14, v36
    v_bitop3_b32 v47, v47, v5, v99 bitop3:0xea
    ds_read_b64 v[100:101], v47
    v_and_b32 v46, 0x20000000, v39
    v_lshrrev_b32 v47, 14, v35
    v_bitop3_b32 v47, v47, v5, v46 bitop3:0xea
    ds_read_b64 v[106:107], v47
    v_and_b32 v99, 0x10000000, v39
    v_lshrrev_b32 v47, 14, v34
    v_bitop3_b32 v47, v47, v5, v99 bitop3:0xea
    ds_read_b64 v[104:105], v47
    s_waitcnt lgkmcnt(4)
    v_cmp_ne_u64 s[50:51], v[72:73], v[68:69]
    v_cmpx_ne_u64 s[54:55], v[74:75], v[70:71]
    s_and_b64 s[82:83], s[54:55], s[80:81]
    s_cbranch_scc1 L2_c59
L2_d59:
    v_mov_b64 v[84:85], v[70:71]
    v_mov_b32 v7, v95
    v_mov_b64 v[86:87], v[74:75]
    s_or_b64 s[80:81], s[80:81], s[54:55]
    s_mov_b64 exec, s[50:51]
    s_and_b64 s[82:83], s[50:51], s[80:81]
    s_cbranch_scc1 L2_c60
L2_d60:
    v_mov_b64 v[84:85], v[68:69]
    v_mov_b32 v7, v94
    v_mov_b64 v[86:87], v[72:73]
    s_mov_b64 exec, -1
    s_or_b64 s[80:81], s[80:81], s[50:51]
    s_and_b64 exec, s[48:49], s[80:81]
    v_mfma_f32_4x4x4_16b_bf16 v[80:83], v[12:13], v[84:85], 0
    v_mov_b32 v93, v7
    s_andn2_b64 s[80:81], s[80:81], s[48:49]
    v_mfma_f32_4x4x4_16b_bf16 v[80:83], v[10:11], v[86:87], v[80:83]
    s_mov_b64 exec, -1
    ds_read_b64 v[70:71], v93 offset:65408
    ds_read_b64 v[68:69], v92 offset:65408
    v_bitop3_b32 v94, v34, v5, v99 bitop3:0xea
    v_bitop3_b32 v95, v35, v5, v46 bitop3:0xea
    v_perm_b32 v15, v35, v38, s45
    v_bitop3_b32 v46, v35, 0.5, -0.5 bitop3:0xa8
    v_perm_b32 v14, v34, v38, s44
    v_bitop3_b32 v47, v34, 0.5, -0.5 bitop3:0xa8
    v_bitop3_b32 v15, v6, v15, v46 bitop3:0xca
    v_bitop3_b32 v14, v6, v14, v47 bitop3:0xca
    s_waitcnt lgkmcnt(1)
    v_mfma_f32_4x4x4_16b_bf16 v[80:83], v[10:11], v[70:71], v[80:83]
    s_waitcnt lgkmcnt(0)
    v_mfma_f32_4x4x4_16b_bf16 v[76:79], v[10:11], v[68:69], v[76:79]
    s_nop 2
    v_cvt_pk_bf16_f32 v80, v80, v81
    v_cvt_pk_bf16_f32 v81, v82, v83
    ds_wrxchg_rtn_b64 v[74:75], v93, v[80:81] offset:65408
    v_cvt_pk_bf16_f32 v76, v76, v77
    v_cvt_pk_bf16_f32 v77, v78, v79
    ds_wrxchg_rtn_b64 v[72:73], v92, v[76:77] offset:65408
    s_barrier
    s_setprio 3
    s_mov_b32 m0, s100
    s_nop 0
    ds_write_addtid_b32 v124 offset:34816
    ds_write_addtid_b32 v125 offset:35072
    ds_write_addtid_b32 v126 offset:35328
    ds_write_addtid_b32 v127 offset:35584
    s_add_u32 s3, s40, 4096
    buffer_load_dwordx4 v[124:127], v3, s[16:19], s3 offen
    ds_write_addtid_b32 v116 offset:32768
    ds_write_addtid_b32 v117 offset:33024
    ds_write_addtid_b32 v118 offset:33280
    ds_write_addtid_b32 v119 offset:33536
    buffer_load_dwordx4 v[116:119], v3, s[16:19], s40 offen offset:2048
    ds_write_addtid_b32 v120 offset:33792
    ds_write_addtid_b32 v121 offset:34048
    ds_write_addtid_b32 v122 offset:34304
    ds_write_addtid_b32 v123 offset:34560
    buffer_load_dwordx4 v[120:123], v3, s[16:19], s40 offen offset:3072
    v_mfma_f32_4x4x4_16b_bf16 v[80:83], v[8:9], v[106:107], 0
    v_mfma_f32_4x4x4_16b_bf16 v[76:79], v[8:9], v[104:105], 0
    s_nop 3
    v_pk_mul_f32 v[80:81], v[80:81], v[14:15] op_sel:[0,1] op_sel_hi:[1,1]
    v_pk_mul_f32 v[82:83], v[82:83], v[14:15] op_sel:[0,1] op_sel_hi:[1,1]
    v_pk_mul_f32 v[76:77], v[76:77], v[14:15] op_sel:[0,0] op_sel_hi:[1,0]
    v_pk_mul_f32 v[78:79], v[78:79], v[14:15] op_sel:[0,0] op_sel_hi:[1,0]
    v_mov_b32 v44, v43
    s_cmp_gt_u32 s37, 1024
    s_cbranch_scc1 L2_xs61
    s_cmp_lg_u32 s101, 0
    s_cbranch_scc1 L2_xa61
L2_xb61:
    v_lshlrev_b32 v89, 16, v96
    v_add_u32 v90, 60, v97
    v_bitop3_b32 v90, v89, v45, v90 bitop3:0x6a
    ds_write_b32 v98, v90 offset:12
    v_lshlrev_b32 v89, 20, v96
    v_add_u32 v90, 40, v97
    v_bitop3_b32 v90, v89, v45, v90 bitop3:0x6a
    ds_write_b32 v98, v90 offset:8
    v_lshlrev_b32 v89, 24, v96
    v_add_u32 v90, 20, v97
    v_bitop3_b32 v90, v89, v45, v90 bitop3:0x6a
    ds_write_b32 v98, v90 offset:4
    v_lshlrev_b32 v89, 28, v96
    v_bitop3_b32 v90, v89, v45, v97 bitop3:0x6a
    ds_write_b32 v98, v90 offset:0
    v_mov_b32_dpp v91, v64 quad_perm:[0,0,0,0] row_mask:0xf bank_mask:0xf
    v_and_b32 v89, 3, v91
    v_and_b32 v97, 0xfffc, v91
    v_sub_u16_dpp v88, v64, v91 quad_perm:[2,2,2,2] row_mask:0xf bank_mask:0xf
    v_mad_u32_u24 v97, v97, 5, v4
    v_add_u32 v99, v88, v89
    v_bfm_b32 v96, v88, v89
    v_cmp_lt_u32 s[58:59], 16, v99
    v_lshlrev_b32 v89, v1, v96
    v_and_b32 v89, v45, v89
    v_cmp_ne_u32 vcc, 0, v89
    v_xor_b32 v90, v97, v89
    s_add_u32 s3, s37, s38
    v_mbcnt_lo_u32_b32 v98, vcc_lo, 0
    v_mbcnt_hi_u32_b32 v98, vcc_hi, v98
    s_bcnt1_i32_b64 s41, vcc
    v_lshl_add_u32 v98, v98, 2, s3
    s_lshl2_add_u32 s37, s41, s37
    s_mov_b64 exec, vcc
    ds_write_b32 v98, v90
    s_mov_b64 exec, -1
    s_cmp_lg_u64 s[58:59], 0
    s_cbranch_scc1 L2_xe61
L2_xr61:
    v_add_u32 v98, s37, v0
    v_mov_b32 v90, -1
    ds_write_b32 v98, v90
    v_add_u32 v98, s38, v0
    ds_read2st64_b32 v[40:41], v0 offset0:0 offset1:1
    ds_read_b32 v43, v0 offset:512
    v_lshrrev_b32 v98, 1, v98
    v_and_b32 v98, -4, v98
    ds_read_b32 v42, v98 offset:768
    s_sub_u32 s3, s37, 768
    s_cmp_gt_u32 s3, 128
    s_cbranch_scc1 L2_xf61
L2_xg61:
    s_setprio 2
    s_waitcnt lgkmcnt(14)
    v_cmp_ne_u64 s[50:51], v[72:73], v[68:69]
    v_cmpx_ne_u64 s[54:55], v[74:75], v[70:71]
    s_and_b64 s[82:83], s[54:55], s[80:81]
    s_cbranch_scc1 L2_c62
L2_d62:
    v_mov_b64 v[84:85], v[70:71]
    v_mov_b32 v7, v93
    v_mov_b64 v[86:87], v[74:75]
    s_or_b64 s[80:81], s[80:81], s[54:55]
    s_mov_b64 exec, s[50:51]
    s_and_b64 s[82:83], s[50:51], s[80:81]
    s_cbranch_scc1 L2_c63
L2_d63:
    v_mov_b64 v[84:85], v[68:69]
    v_mov_b32 v7, v92
    v_mov_b64 v[86:87], v[72:73]
    s_mov_b64 exec, -1
    s_or_b64 s[80:81], s[80:81], s[50:51]
    ds_read_b64 v[70:71], v95 offset:65408
    ds_read_b64 v[68:69], v94 offset:65408
    v_and_b32 v46, 0x40000000, v39
    v_bitop3_b32 v92, v36, v5, v46 bitop3:0xea
    v_and_b32 v46, 0x80000000, v39
    v_bitop3_b32 v93, v37, v5, v46 bitop3:0xea
    v_perm_b32 v15, v37, v38, s47
    v_bitop3_b32 v46, v37, 0.5, -0.5 bitop3:0xa8
    v_perm_b32 v14, v36, v38, s46
    v_bitop3_b32 v47, v36, 0.5, -0.5 bitop3:0xa8
    v_bitop3_b32 v15, v6, v15, v46 bitop3:0xca
    v_bitop3_b32 v14, v6, v14, v47 bitop3:0xca
    s_setprio 1
    s_waitcnt lgkmcnt(1)
    v_mfma_f32_4x4x4_16b_bf16 v[80:83], v[10:11], v[70:71], v[80:83]
    s_waitcnt lgkmcnt(0)
    v_mfma_f32_4x4x4_16b_bf16 v[76:79], v[10:11], v[68:69], v[76:79]
    s_nop 2
    v_cvt_pk_bf16_f32 v80, v80, v81
    v_cvt_pk_bf16_f32 v81, v82, v83
    ds_wrxchg_rtn_b64 v[74:75], v95, v[80:81] offset:65408
    v_cvt_pk_bf16_f32 v76, v76, v77
    v_cvt_pk_bf16_f32 v77, v78, v79
    ds_wrxchg_rtn_b64 v[72:73], v94, v[76:77] offset:65408
    v_and_b32 v88, 0x0fffffff, v44
    v_mov_b32 v39, v44
    buffer_load_dwordx2 v[34:35], v88, s[8:11], 0 offen
    buffer_load_dwordx3 v[36:38], v88, s[8:11], 0 offen offset:8
    s_setprio 0
    s_waitcnt vmcnt(12)
    s_mov_b32 m0, s38
    s_nop 0
    ds_write_addtid_b32 v108 offset:0
    ds_write_addtid_b32 v109 offset:256
    ds_write_addtid_b32 v110 offset:512
    ds_write_addtid_b32 v111 offset:768
    s_waitcnt vmcnt(9)
    ds_write_addtid_b32 v112 offset:1024
    ds_write_addtid_b32 v113 offset:1280
    ds_write_addtid_b32 v114 offset:1536
    ds_write_addtid_b32 v115 offset:1792
    v_mfma_f32_4x4x4_16b_bf16 v[80:83], v[8:9], v[102:103], 0
    v_mfma_f32_4x4x4_16b_bf16 v[76:79], v[8:9], v[100:101], 0
    v_cmp_lt_u32 s[84:85], v5, v92
    s_nop 2
    v_pk_mul_f32 v[80:81], v[80:81], v[14:15] op_sel:[0,1] op_sel_hi:[1,1]
    v_pk_mul_f32 v[82:83], v[82:83], v[14:15] op_sel:[0,1] op_sel_hi:[1,1]
    v_pk_mul_f32 v[76:77], v[76:77], v[14:15] op_sel:[0,0] op_sel_hi:[1,0]
    v_pk_mul_f32 v[78:79], v[78:79], v[14:15] op_sel:[0,0] op_sel_hi:[1,0]
    s_add_u32 s42, s42, 1
    s_waitcnt lgkmcnt(0)
    s_barrier
    s_bitcmp1_b32 s36, s42
    s_cbranch_scc1 L2_slow
L2_ret3:
    s_setprio 3
    s_bitcmp1_b32 s43, s42
    s_cbranch_scc1 L2_oa64
L2_ob64:
    v_and_b32 v46, 0x20000000, v21
    v_lshrrev_b32 v47, 14, v17
    v_bitop3_b32 v47, v47, v5, v46 bitop3:0xea
    ds_read_b64 v[106:107], v47
    v_and_b32 v99, 0x10000000, v21
    v_lshrrev_b32 v47, 14, v16
    v_bitop3_b32 v47, v47, v5, v99 bitop3:0xea
    ds_read_b64 v[104:105], v47
    v_cmp_ne_u64 s[50:51], v[72:73], v[68:69]
    v_cmpx_ne_u64 s[54:55], v[74:75], v[70:71]
    s_and_b64 s[82:83], s[54:55], s[80:81]
    s_cbranch_scc1 L2_c65
L2_d65:
    v_mov_b64 v[84:85], v[70:71]
    v_mov_b32 v7, v95
    v_mov_b64 v[86:87], v[74:75]
    s_or_b64 s[80:81], s[80:81], s[54:55]
    s_mov_b64 exec, s[50:51]
    s_and_b64 s[82:83], s[50:51], s[80:81]
    s_cbranch_scc1 L2_c66
L2_d66:
    v_mov_b64 v[84:85], v[68:69]
    v_mov_b32 v7, v94
    v_mov_b64 v[86:87], v[72:73]
    s_mov_b64 exec, -1
    s_or_b64 s[80:81], s[80:81], s[50:51]
    s_and_b64 exec, s[84:85], s[80:81]
    v_mfma_f32_4x4x4_16b_bf16 v[76:79], v[12:13], v[84:85], 0
    v_mov_b32 v92, v7
    s_andn2_b64 s[80:81], s[80:81], s[84:85]
    v_mfma_f32_4x4x4_16b_bf16 v[76:79], v[10:11], v[86:87], v[76:79]
    s_mov_b64 exec, -1
    ds_read_b64 v[70:71], v93 offset:65408
    ds_read_b64 v[68:69], v92 offset:65408
    v_bitop3_b32 v94, v16, v5, v99 bitop3:0xea
    v_bitop3_b32 v95, v17, v5, v46 bitop3:0xea
    v_perm_b32 v15, v17, v20, s45
    v_bitop3_b32 v46, v17, 0.5, -0.5 bitop3:0xa8
    v_perm_b32 v14, v16, v20, s44
    v_bitop3_b32 v47, v16, 0.5, -0.5 bitop3:0xa8
    v_bitop3_b32 v15, v6, v15, v46 bitop3:0xca
    v_bitop3_b32 v14, v6, v14, v47 bitop3:0xca
    s_waitcnt lgkmcnt(1)
    v_mfma_f32_4x4x4_16b_bf16 v[80:83], v[10:11], v[70:71], v[80:83]
    s_waitcnt lgkmcnt(0)
    v_mfma_f32_4x4x4_16b_bf16 v[76:79], v[10:11], v[68:69], v[76:79]
    s_nop 2
    v_cvt_pk_bf16_f32 v80, v80, v81
    v_cvt_pk_bf16_f32 v81, v82, v83
    ds_wrxchg_rtn_b64 v[74:75], v93, v[80:81] offset:65408
    v_cvt_pk_bf16_f32 v76, v76, v77
    v_cvt_pk_bf16_f32 v77, v78, v79
    ds_wrxchg_rtn_b64 v[72:73], v92, v[76:77] offset:65408
    v_mfma_f32_4x4x4_16b_bf16 v[80:83], v[8:9], v[106:107], 0
    v_mfma_f32_4x4x4_16b_bf16 v[76:79], v[8:9], v[104:105], 0
    v_cmp_lt_u32 s[84:85], v5, v94
    s_nop 2
    v_pk_mul_f32 v[80:81], v[80:81], v[14:15] op_sel:[0,1] op_sel_hi:[1,1]
    v_pk_mul_f32 v[82:83], v[82:83], v[14:15] op_sel:[0,1] op_sel_hi:[1,1]
    v_pk_mul_f32 v[76:77], v[76:77], v[14:15] op_sel:[0,0] op_sel_hi:[1,0]
    v_pk_mul_f32 v[78:79], v[78:79], v[14:15] op_sel:[0,0] op_sel_hi:[1,0]
    buffer_load_dwordx4 v[108:111], v3, s[16:19], s40 offen offset:0
    v_and_b32 v46, 0x80000000, v21
    v_lshrrev_b32 v47, 14, v19
    v_bitop3_b32 v47, v47, v5, v46 bitop3:0xea
    ds_read_b64 v[102:103], v47
    v_and_b32 v99, 0x40000000, v21
    v_lshrrev_b32 v47, 14, v18
    v_bitop3_b32 v47, v47, v5, v99 bitop3:0xea
    ds_read_b64 v[100:101], v47
    s_waitcnt lgkmcnt(2)
    v_cmp_ne_u64 s[50:51], v[72:73], v[68:69]
    v_cmpx_ne_u64 s[54:55], v[74:75], v[70:71]
    s_and_b64 s[82:83], s[54:55], s[80:81]
    s_cbranch_scc1 L2_c67
L2_d67:
    v_mov_b64 v[84:85], v[70:71]
    v_mov_b32 v7, v93
    v_mov_b64 v[86:87], v[74:75]
    s_or_b64 s[80:81], s[80:81], s[54:55]
    s_mov_b64 exec, s[50:51]
    s_and_b64 s[82:83], s[50:51], s[80:81]
    s_cbranch_scc1 L2_c68
L2_d68:
    v_mov_b64 v[84:85], v[68:69]
    v_mov_b32 v7, v92
    v_mov_b64 v[86:87], v[72:73]
    s_mov_b64 exec, -1
    s_or_b64 s[80:81], s[80:81], s[50:51]
    s_and_b64 exec, s[84:85], s[80:81]
    v_mfma_f32_4x4x4_16b_bf16 v[76:79], v[12:13], v[84:85], 0
    v_mov_b32 v94, v7
    s_andn2_b64 s[80:81], s[80:81], s[84:85]
    v_mfma_f32_4x4x4_16b_bf16 v[76:79], v[10:11], v[86:87], v[76:79]
    s_mov_b64 exec, -1
    ds_read_b64 v[70:71], v95 offset:65408
    ds_read_b64 v[68:69], v94 offset:65408
    v_bitop3_b32 v92, v18, v5, v99 bitop3:0xea
    v_bitop3_b32 v93, v19, v5, v46 bitop3:0xea
    v_perm_b32 v15, v19, v20, s47
    v_bitop3_b32 v46, v19, 0.5, -0.5 bitop3:0xa8
    v_perm_b32 v14, v18, v20, s46
    v_bitop3_b32 v47, v18, 0.5, -0.5 bitop3:0xa8
    v_bitop3_b32 v15, v6, v15, v46 bitop3:0xca
    v_bitop3_b32 v14, v6, v14, v47 bitop3:0xca
    s_waitcnt lgkmcnt(1)
    v_mfma_f32_4x4x4_16b_bf16 v[80:83], v[10:11], v[70:71], v[80:83]
    s_waitcnt lgkmcnt(0)
    v_mfma_f32_4x4x4_16b_bf16 v[76:79], v[10:11], v[68:69], v[76:79]
    s_nop 2
    v_cvt_pk_bf16_f32 v80, v80, v81
    v_cvt_pk_bf16_f32 v81, v82, v83
    ds_wrxchg_rtn_b64 v[74:75], v95, v[80:81] offset:65408
    v_cvt_pk_bf16_f32 v76, v76, v77
    v_cvt_pk_bf16_f32 v77, v78, v79
    ds_wrxchg_rtn_b64 v[72:73], v94, v[76:77] offset:65408
    v_and_b32 v88, 0x0fffffff, v40
    v_mov_b32 v21, v40
    buffer_load_dwordx2 v[16:17], v88, s[8:11], 0 offen
    buffer_load_dwordx3 v[18:20], v88, s[8:11], 0 offen offset:8
    s_setprio 2
    v_mfma_f32_4x4x4_16b_bf16 v[80:83], v[8:9], v[102:103], 0
    v_mfma_f32_4x4x4_16b_bf16 v[76:79], v[8:9], v[100:101], 0
    v_cmp_lt_u32 s[48:49], v5, v93
    s_nop 2
    v_pk_mul_f32 v[80:81], v[80:81], v[14:15] op_sel:[0,1] op_sel_hi:[1,1]
    v_pk_mul_f32 v[82:83], v[82:83], v[14:15] op_sel:[0,1] op_sel_hi:[1,1]
    v_pk_mul_f32 v[76:77], v[76:77], v[14:15] op_sel:[0,0] op_sel_hi:[1,0]
    v_pk_mul_f32 v[78:79], v[78:79], v[14:15] op_sel:[0,0] op_sel_hi:[1,0]
    s_waitcnt vmcnt(10)
    v_and_b32 v46, 0x20000000, v27
    v_lshrrev_b32 v47, 14, v23
    v_bitop3_b32 v47, v47, v5, v46 bitop3:0xea
    ds_read_b64 v[106:107], v47
    v_and_b32 v99, 0x10000000, v27
    v_lshrrev_b32 v47, 14, v22
    v_bitop3_b32 v47, v47, v5, v99 bitop3:0xea
    ds_read_b64 v[104:105], v47
    s_waitcnt lgkmcnt(2)
    v_cmp_ne_u64 s[50:51], v[72:73], v[68:69]
    v_cmpx_ne_u64 s[54:55], v[74:75], v[70:71]
    s_and_b64 s[82:83], s[54:55], s[80:81]
    s_cbranch_scc1 L2_c69
L2_d69:
    v_mov_b64 v[84:85], v[70:71]
    v_mov_b32 v7, v95
    v_mov_b64 v[86:87], v[74:75]
    s_or_b64 s[80:81], s[80:81], s[54:55]
    s_mov_b64 exec, s[50:51]
    s_and_b64 s[82:83], s[50:51], s[80:81]
    s_cbranch_scc1 L2_c70
L2_d70:
    v_mov_b64 v[84:85], v[68:69]
    v_mov_b32 v7, v94
    v_mov_b64 v[86:87], v[72:73]
    s_mov_b64 exec, -1
    s_or_b64 s[80:81], s[80:81], s[50:51]
    s_and_b64 exec, s[48:49], s[80:81]
    v_mfma_f32_4x4x4_16b_bf16 v[80:83], v[12:13], v[84:85], 0
    v_mov_b32 v93, v7
    s_andn2_b64 s[80:81], s[80:81], s[48:49]
    v_mfma_f32_4x4x4_16b_bf16 v[80:83], v[10:11], v[86:87], v[80:83]
    s_mov_b64 exec, -1
    ds_read_b64 v[70:71], v93 offset:65408
    ds_read_b64 v[68:69], v92 offset:65408
    v_bitop3_b32 v94, v22, v5, v99 bitop3:0xea
    v_bitop3_b32 v95, v23, v5, v46 bitop3:0xea
    v_perm_b32 v15, v23, v26, s45
    v_bitop3_b32 v46, v23, 0.5, -0.5 bitop3:0xa8
    v_perm_b32 v14, v22, v26, s44
    v_bitop3_b32 v47, v22, 0.5, -0.5 bitop3:0xa8
    v_bitop3_b32 v15, v6, v15, v46 bitop3:0xca
    v_bitop3_b32 v14, v6, v14, v47 bitop3:0xca
    s_waitcnt lgkmcnt(1)
    v_mfma_f32_4x4x4_16b_bf16 v[80:83], v[10:11], v[70:71], v[80:83]
    s_waitcnt lgkmcnt(0)
    v_mfma_f32_4x4x4_16b_bf16 v[76:79], v[10:11], v[68:69], v[76:79]
    s_nop 2
    v_cvt_pk_bf16_f32 v80, v80, v81
    v_cvt_pk_bf16_f32 v81, v82, v83
    ds_wrxchg_rtn_b64 v[74:75], v93, v[80:81] offset:65408
    v_cvt_pk_bf16_f32 v76, v76, v77
    v_cvt_pk_bf16_f32 v77, v78, v79
    ds_wrxchg_rtn_b64 v[72:73], v92, v[76:77] offset:65408
    s_setprio 1
    v_mfma_f32_4x4x4_16b_bf16 v[80:83], v[8:9], v[106:107], 0
    v_mfma_f32_4x4x4_16b_bf16 v[76:79], v[8:9], v[104:105], 0
    s_nop 3
    v_pk_mul_f32 v[80:81], v[80:81], v[14:15] op_sel:[0,1] op_sel_hi:[1,1]
    v_pk_mul_f32 v[82:83], v[82:83], v[14:15] op_sel:[0,1] op_sel_hi:[1,1]
    v_pk_mul_f32 v[76:77], v[76:77], v[14:15] op_sel:[0,0] op_sel_hi:[1,0]
    v_pk_mul_f32 v[78:79], v[78:79], v[14:15] op_sel:[0,0] op_sel_hi:[1,0]
    s_bitcmp1_b32 s43, s42
    s_cbranch_scc1 L2_oa71
L2_ob71:
    buffer_load_dwordx4 v[112:115], v3, s[16:19], s40 offen offset:1024
    v_sub_u16 v88, v58, v50
    v_and_b32 v89, 3, v50
    v_add3_u32 v99, v88, v89, 3
    v_and_b32 v99, -4, v99
    v_max_u32 v99, 4, v99
    v_and_b32 v97, 0xfffc, v50
    v_bfm_b32 v96, v88, v89
    v_add_u32_dpp v91, v99, v99 row_shr:1 row_mask:0xf bank_mask:0xf bound_ctrl:1
    v_mad_u32_u24 v97, v97, 5, v2
    v_cmp_lt_u32 vcc, 16, v99
    v_add_u32_dpp v91, v91, v91 row_shr:2 row_mask:0xf bank_mask:0xf bound_ctrl:1
    v_sub_u32 v98, s38, v99
    v_lshrrev_b64 v[50:51], 16, v[50:51]
    v_add_u32_dpp v91, v91, v91 row_shr:4 row_mask:0xf bank_mask:0xf bound_ctrl:1
    v_lshrrev_b64 v[58:59], 16, v[58:59]
    s_mov_b32 s101, 0
    v_add_u32_dpp v91, v91, v91 row_shr:8 row_mask:0xf bank_mask:0xf bound_ctrl:1
    s_nop 1
    v_add_u32_dpp v91, v91, v91 row_bcast:15 row_mask:0xa bank_mask:0xf
    s_nop 1
    v_add_u32_dpp v91, v91, v91 row_bcast:31 row_mask:0xc bank_mask:0xf
    v_add_u32 v98, v98, v91
    v_readlane_b32 s37, v91, 63
    s_cbranch_vccnz L2_xo72
L2_xp72:
    v_and_b32 v46, 0x80000000, v27
    v_lshrrev_b32 v47, 14, v25
    v_bitop3_b32 v47, v47, v5, v46 bitop3:0xea
    ds_read_b64 v[102:103], v47
    v_and_b32 v99, 0x40000000, v27
    v_lshrrev_b32 v47, 14, v24
    v_bitop3_b32 v47, v47, v5, v99 bitop3:0xea
    ds_read_b64 v[100:101], v47
    s_waitcnt lgkmcnt(2)
    v_cmp_ne_u64 s[50:51], v[72:73], v[68:69]
    v_cmpx_ne_u64 s[54:55], v[74:75], v[70:71]
    s_and_b64 s[82:83], s[54:55], s[80:81]
    s_cbranch_scc1 L2_c73
L2_d73:
    v_mov_b64 v[84:85], v[70:71]
    v_mov_b32 v7, v93
    v_mov_b64 v[86:87], v[74:75]
    s_or_b64 s[80:81], s[80:81], s[54:55]
    s_mov_b64 exec, s[50:51]
    s_and_b64 s[82:83], s[50:51], s[80:81]
    s_cbranch_scc1 L2_c74
L2_d74:
    v_mov_b64 v[84:85], v[68:69]
    v_mov_b32 v7, v92
    v_mov_b64 v[86:87], v[72:73]
    s_mov_b64 exec, -1
    s_or_b64 s[80:81], s[80:81], s[50:51]
    ds_read_b64 v[70:71], v95 offset:65408
    ds_read_b64 v[68:69], v94 offset:65408
    v_bitop3_b32 v92, v24, v5, v99 bitop3:0xea
    v_bitop3_b32 v93, v25, v5, v46 bitop3:0xea
    v_perm_b32 v15, v25, v26, s47
    v_bitop3_b32 v46, v25, 0.5, -0.5 bitop3:0xa8
    v_perm_b32 v14, v24, v26, s46
    v_bitop3_b32 v47, v24, 0.5, -0.5 bitop3:0xa8
    v_bitop3_b32 v15, v6, v15, v46 bitop3:0xca
    v_bitop3_b32 v14, v6, v14, v47 bitop3:0xca
    s_waitcnt lgkmcnt(1)
    v_mfma_f32_4x4x4_16b_bf16 v[80:83], v[10:11], v[70:71], v[80:83]
    s_waitcnt lgkmcnt(0)
    v_mfma_f32_4x4x4_16b_bf16 v[76:79], v[10:11], v[68:69], v[76:79]
    s_nop 2
    v_cvt_pk_bf16_f32 v80, v80, v81
    v_cvt_pk_bf16_f32 v81, v82, v83
    ds_wrxchg_rtn_b64 v[74:75], v95, v[80:81] offset:65408
    v_cvt_pk_bf16_f32 v76, v76, v77
    v_cvt_pk_bf16_f32 v77, v78, v79
    ds_wrxchg_rtn_b64 v[72:73], v94, v[76:77] offset:65408
    v_and_b32 v88, 0x0fffffff, v41
    v_mov_b32 v27, v41
    buffer_load_dwordx2 v[22:23], v88, s[8:11], 0 offen
    buffer_load_dwordx3 v[24:26], v88, s[8:11], 0 offen offset:8
    v_mfma_f32_4x4x4_16b_bf16 v[80:83], v[8:9], v[102:103], 0
    v_mfma_f32_4x4x4_16b_bf16 v[76:79], v[8:9], v[100:101], 0
    v_cmp_lt_u32 s[84:85], v5, v92
    s_nop 2
    v_pk_mul_f32 v[80:81], v[80:81], v[14:15] op_sel:[0,1] op_sel_hi:[1,1]
    v_pk_mul_f32 v[82:83], v[82:83], v[14:15] op_sel:[0,1] op_sel_hi:[1,1]
    v_pk_mul_f32 v[76:77], v[76:77], v[14:15] op_sel:[0,0] op_sel_hi:[1,0]
    v_pk_mul_f32 v[78:79], v[78:79], v[14:15] op_sel:[0,0] op_sel_hi:[1,0]
    s_waitcnt vmcnt(11)
    s_mov_b64 exec, s[6:7]
    v_lshrrev_b32 v30, 16, v30
    s_mov_b64 exec, -1
    v_and_b32 v46, 0x20000000, v31
    v_lshrrev_b32 v47, 14, v29
    v_bitop3_b32 v47, v47, v5, v46 bitop3:0xea
    ds_read_b64 v[106:107], v47
    v_and_b32 v99, 0x10000000, v31
    v_lshrrev_b32 v47, 14, v28
    v_bitop3_b32 v47, v47, v5, v99 bitop3:0xea
    ds_read_b64 v[104:105], v47
    s_waitcnt lgkmcnt(2)
    v_cmp_ne_u64 s[50:51], v[72:73], v[68:69]
    v_cmpx_ne_u64 s[54:55], v[74:75], v[70:71]
    s_and_b64 s[82:83], s[54:55], s[80:81]
    s_cbranch_scc1 L2_c75
L2_d75:
    v_mov_b64 v[84:85], v[70:71]
    v_mov_b32 v7, v95
    v_mov_b64 v[86:87], v[74:75]
    s_or_b64 s[80:81], s[80:81], s[54:55]
    s_mov_b64 exec, s[50:51]
    s_and_b64 s[82:83], s[50:51], s[80:81]
    s_cbranch_scc1 L2_c76
L2_d76:
    v_mov_b64 v[84:85], v[68:69]
    v_mov_b32 v7, v94
    v_mov_b64 v[86:87], v[72:73]
    s_mov_b64 exec, -1
    s_or_b64 s[80:81], s[80:81], s[50:51]
    s_and_b64 exec, s[84:85], s[80:81]
    v_mfma_f32_4x4x4_16b_bf16 v[76:79], v[12:13], v[84:85], 0
    v_mov_b32 v92, v7
    s_andn2_b64 s[80:81], s[80:81], s[84:85]
    v_mfma_f32_4x4x4_16b_bf16 v[76:79], v[10:11], v[86:87], v[76:79]
    s_mov_b64 exec, -1
    ds_read_b64 v[70:71], v93 offset:65408
    ds_read_b64 v[68:69], v92 offset:65408
    v_bitop3_b32 v94, v28, v5, v99 bitop3:0xea
    v_bitop3_b32 v95, v29, v5, v46 bitop3:0xea
    v_perm_b32 v15, v29, v30, s45
    v_bitop3_b32 v46, v29, 0.5, -0.5 bitop3:0xa8
    v_perm_b32 v14, v28, v30, s44
    v_bitop3_b32 v47, v28, 0.5, -0.5 bitop3:0xa8
    v_bitop3_b32 v15, v6, v15, v46 bitop3:0xca
    v_bitop3_b32 v14, v6, v14, v47 bitop3:0xca
    s_waitcnt lgkmcnt(1)
    v_mfma_f32_4x4x4_16b_bf16 v[80:83], v[10:11], v[70:71], v[80:83]
    s_waitcnt lgkmcnt(0)
    v_mfma_f32_4x4x4_16b_bf16 v[76:79], v[10:11], v[68:69], v[76:79]
    s_nop 2
    v_cvt_pk_bf16_f32 v80, v80, v81
    v_cvt_pk_bf16_f32 v81, v82, v83
    ds_wrxchg_rtn_b64 v[74:75], v93, v[80:81] offset:65408
    v_cvt_pk_bf16_f32 v76, v76, v77
    v_cvt_pk_bf16_f32 v77, v78, v79
    ds_wrxchg_rtn_b64 v[72:73], v92, v[76:77] offset:65408
    s_setprio 0
    v_mfma_f32_4x4x4_16b_bf16 v[80:83], v[8:9], v[106:107], 0
    v_mfma_f32_4x4x4_16b_bf16 v[76:79], v[8:9], v[104:105], 0
    v_cmp_lt_u32 s[48:49], v5, v95
    s_nop 2
    v_pk_mul_f32 v[80:81], v[80:81], v[14:15] op_sel:[0,1] op_sel_hi:[1,1]
    v_pk_mul_f32 v[82:83], v[82:83], v[14:15] op_sel:[0,1] op_sel_hi:[1,1]
    v_pk_mul_f32 v[76:77], v[76:77], v[14:15] op_sel:[0,0] op_sel_hi:[1,0]
    v_pk_mul_f32 v[78:79], v[78:79], v[14:15] op_sel:[0,0] op_sel_hi:[1,0]
    s_add_u32 s40, s40, 0x50000
    v_and_b32 v47, 0x0fffffff, v42
    v_mov_b32 v31, v42
    buffer_load_dword v30, v47, s[8:11], 0 offen offset:16
    s_mov_b64 exec, s[6:7]
    v_add_u32 v47, 8, v47
    v_lshrrev_b32 v31, 2, v31
    s_mov_b64 exec, -1
    buffer_load_dwordx2 v[28:29], v47, s[8:11], 0 offen
    s_waitcnt vmcnt(8)
    v_and_b32 v46, 0x80000000, v39
    v_lshrrev_b32 v47, 14, v37
    v_bitop3_b32 v47, v47, v5, v46 bitop3:0xea
    ds_read_b64 v[106:107], v47
    v_and_b32 v99, 0x40000000, v39
    v_lshrrev_b32 v47, 14, v36
    v_bitop3_b32 v47, v47, v5, v99 bitop3:0xea
    ds_read_b64 v[104:105], v47
    v_and_b32 v46, 0x20000000, v39
    v_lshrrev_b32 v47, 14, v35
    v_bitop3_b32 v47, v47, v5, v46 bitop3:0xea
    ds_read_b64 v[102:103], v47
    v_and_b32 v99, 0x10000000, v39
    v_lshrrev_b32 v47, 14, v34
    v_bitop3_b32 v47, v47, v5, v99 bitop3:0xea
    ds_read_b64 v[100:101], v47
    s_waitcnt lgkmcnt(4)
    v_cmp_ne_u64 s[50:51], v[72:73], v[68:69]
    v_cmpx_ne_u64 s[54:55], v[74:75], v[70:71]
    s_and_b64 s[82:83], s[54:55], s[80:81]
    s_cbranch_scc1 L2_c77
L2_d77:
    v_mov_b64 v[84:85], v[70:71]
    v_mov_b32 v7, v93
    v_mov_b64 v[86:87], v[74:75]
    s_or_b64 s[80:81], s[80:81], s[54:55]
    s_mov_b64 exec, s[50:51]
    s_and_b64 s[82:83], s[50:51], s[80:81]
    s_cbranch_scc1 L2_c78
L2_d78:
    v_mov_b64 v[84:85], v[68:69]
    v_mov_b32 v7, v92
    v_mov_b64 v[86:87], v[72:73]
    s_mov_b64 exec, -1
    s_or_b64 s[80:81], s[80:81], s[50:51]
    s_and_b64 exec, s[48:49], s[80:81]
    v_mfma_f32_4x4x4_16b_bf16 v[80:83], v[12:13], v[84:85], 0
    v_mov_b32 v95, v7
    s_andn2_b64 s[80:81], s[80:81], s[48:49]
    v_mfma_f32_4x4x4_16b_bf16 v[80:83], v[10:11], v[86:87], v[80:83]
    s_mov_b64 exec, -1
    ds_read_b64 v[70:71], v95 offset:65408
    ds_read_b64 v[68:69], v94 offset:65408
    v_bitop3_b32 v92, v34, v5, v99 bitop3:0xea
    v_bitop3_b32 v93, v35, v5, v46 bitop3:0xea
    v_perm_b32 v15, v35, v38, s45
    v_bitop3_b32 v46, v35, 0.5, -0.5 bitop3:0xa8
    v_perm_b32 v14, v34, v38, s44
    v_bitop3_b32 v47, v34, 0.5, -0.5 bitop3:0xa8
    v_bitop3_b32 v15, v6, v15, v46 bitop3:0xca
    v_bitop3_b32 v14, v6, v14, v47 bitop3:0xca
    s_waitcnt lgkmcnt(1)
    v_mfma_f32_4x4x4_16b_bf16 v[80:83], v[10:11], v[70:71], v[80:83]
    s_waitcnt lgkmcnt(0)
    v_mfma_f32_4x4x4_16b_bf16 v[76:79], v[10:11], v[68:69], v[76:79]
    s_nop 2
    v_cvt_pk_bf16_f32 v80, v80, v81
    v_cvt_pk_bf16_f32 v81, v82, v83
    ds_wrxchg_rtn_b64 v[74:75], v95, v[80:81] offset:65408
    v_cvt_pk_bf16_f32 v76, v76, v77
    v_cvt_pk_bf16_f32 v77, v78, v79
    ds_wrxchg_rtn_b64 v[72:73], v94, v[76:77] offset:65408
    s_barrier
    s_setprio 3
    s_mov_b32 m0, s100
    s_nop 0
    ds_write_addtid_b32 v124 offset:34816
    ds_write_addtid_b32 v125 offset:35072
    ds_write_addtid_b32 v126 offset:35328
    ds_write_addtid_b32 v127 offset:35584
    s_add_u32 s3, s40, 4096
    buffer_load_dwordx4 v[124:127], v3, s[16:19], s3 offen
    ds_write_addtid_b32 v116 offset:32768
    ds_write_addtid_b32 v117 offset:33024
    ds_write_addtid_b32 v118 offset:33280
    ds_write_addtid_b32 v119 offset:33536
    buffer_load_dwordx4 v[116:119], v3, s[16:19], s40 offen offset:2048
    ds_write_addtid_b32 v120 offset:33792
    ds_write_addtid_b32 v121 offset:34048
    ds_write_addtid_b32 v122 offset:34304
    ds_write_addtid_b32 v123 offset:34560
    buffer_load_dwordx4 v[120:123], v3, s[16:19], s40 offen offset:3072
    v_mfma_f32_4x4x4_16b_bf16 v[80:83], v[8:9], v[102:103], 0
    v_mfma_f32_4x4x4_16b_bf16 v[76:79], v[8:9], v[100:101], 0
    s_nop 3
    v_pk_mul_f32 v[80:81], v[80:81], v[14:15] op_sel:[0,1] op_sel_hi:[1,1]
    v_pk_mul_f32 v[82:83], v[82:83], v[14:15] op_sel:[0,1] op_sel_hi:[1,1]
    v_pk_mul_f32 v[76:77], v[76:77], v[14:15] op_sel:[0,0] op_sel_hi:[1,0]
    v_pk_mul_f32 v[78:79], v[78:79], v[14:15] op_sel:[0,0] op_sel_hi:[1,0]
    v_mov_b32 v44, v43
    s_cmp_gt_u32 s37, 1024
    s_cbranch_scc1 L2_xs79
    s_cmp_lg_u32 s101, 0
    s_cbranch_scc1 L2_xa79
L2_xb79:
    v_lshlrev_b32 v89, 16, v96
    v_add_u32 v90, 60, v97
    v_bitop3_b32 v90, v89, v45, v90 bitop3:0x6a
    ds_write_b32 v98, v90 offset:12
    v_lshlrev_b32 v89, 20, v96
    v_add_u32 v90, 40, v97
    v_bitop3_b32 v90, v89, v45, v90 bitop3:0x6a
    ds_write_b32 v98, v90 offset:8
    v_lshlrev_b32 v89, 24, v96
    v_add_u32 v90, 20, v97
    v_bitop3_b32 v90, v89, v45, v90 bitop3:0x6a
    ds_write_b32 v98, v90 offset:4
    v_lshlrev_b32 v89, 28, v96
    v_bitop3_b32 v90, v89, v45, v97 bitop3:0x6a
    ds_write_b32 v98, v90 offset:0
    v_mov_b32_dpp v91, v66 quad_perm:[0,0,0,0] row_mask:0xf bank_mask:0xf
    v_and_b32 v89, 3, v91
    v_and_b32 v97, 0xfffc, v91
    v_sub_u16_dpp v88, v66, v91 quad_perm:[2,2,2,2] row_mask:0xf bank_mask:0xf
    v_mad_u32_u24 v97, v97, 5, v4
    v_add_u32 v99, v88, v89
    v_bfm_b32 v96, v88, v89
    v_cmp_lt_u32 s[58:59], 16, v99
    v_lshlrev_b32 v89, v1, v96
    v_and_b32 v89, v45, v89
    v_cmp_ne_u32 vcc, 0, v89
    v_xor_b32 v90, v97, v89
    s_add_u32 s3, s37, s38
    v_mbcnt_lo_u32_b32 v98, vcc_lo, 0
    v_mbcnt_hi_u32_b32 v98, vcc_hi, v98
    s_bcnt1_i32_b64 s41, vcc
    v_lshl_add_u32 v98, v98, 2, s3
    s_lshl2_add_u32 s37, s41, s37
    s_mov_b64 exec, vcc
    ds_write_b32 v98, v90
    s_mov_b64 exec, -1
    s_cmp_lg_u64 s[58:59], 0
    s_cbranch_scc1 L2_xe79
L2_xr79:
    v_add_u32 v98, s37, v0
    v_mov_b32 v90, -1
    ds_write_b32 v98, v90
    v_add_u32 v98, s38, v0
    ds_read2st64_b32 v[40:41], v0 offset0:0 offset1:1
    ds_read_b32 v43, v0 offset:512
    v_lshrrev_b32 v98, 1, v98
    v_and_b32 v98, -4, v98
    ds_read_b32 v42, v98 offset:768
    s_sub_u32 s3, s37, 768
    s_cmp_gt_u32 s3, 128
    s_cbranch_scc1 L2_xf79
L2_xg79:
    s_setprio 2
    s_waitcnt lgkmcnt(14)
    v_cmp_ne_u64 s[50:51], v[72:73], v[68:69]
    v_cmpx_ne_u64 s[54:55], v[74:75], v[70:71]
    s_and_b64 s[82:83], s[54:55], s[80:81]
    s_cbranch_scc1 L2_c80
L2_d80:
    v_mov_b64 v[84:85], v[70:71]
    v_mov_b32 v7, v95
    v_mov_b64 v[86:87], v[74:75]
    s_or_b64 s[80:81], s[80:81], s[54:55]
    s_mov_b64 exec, s[50:51]
    s_and_b64 s[82:83], s[50:51], s[80:81]
    s_cbranch_scc1 L2_c81
L2_d81:
    v_mov_b64 v[84:85], v[68:69]
    v_mov_b32 v7, v94
    v_mov_b64 v[86:87], v[72:73]
    s_mov_b64 exec, -1
    s_or_b64 s[80:81], s[80:81], s[50:51]
    ds_read_b64 v[70:71], v93 offset:65408
    ds_read_b64 v[68:69], v92 offset:65408
    v_and_b32 v46, 0x40000000, v39
    v_bitop3_b32 v94, v36, v5, v46 bitop3:0xea
    v_and_b32 v46, 0x80000000, v39
    v_bitop3_b32 v95, v37, v5, v46 bitop3:0xea
    v_perm_b32 v15, v37, v38, s47
    v_bitop3_b32 v46, v37, 0.5, -0.5 bitop3:0xa8
    v_perm_b32 v14, v36, v38, s46
    v_bitop3_b32 v47, v36, 0.5, -0.5 bitop3:0xa8
    v_bitop3_b32 v15, v6, v15, v46 bitop3:0xca
    v_bitop3_b32 v14, v6, v14, v47 bitop3:0xca
    s_setprio 1
    s_waitcnt lgkmcnt(1)
    v_mfma_f32_4x4x4_16b_bf16 v[80:83], v[10:11], v[70:71], v[80:83]
    s_waitcnt lgkmcnt(0)
    v_mfma_f32_4x4x4_16b_bf16 v[76:79], v[10:11], v[68:69], v[76:79]
    s_nop 2
    v_cvt_pk_bf16_f32 v80, v80, v81
    v_cvt_pk_bf16_f32 v81, v82, v83
    ds_wrxchg_rtn_b64 v[74:75], v93, v[80:81] offset:65408
    v_cvt_pk_bf16_f32 v76, v76, v77
    v_cvt_pk_bf16_f32 v77, v78, v79
    ds_wrxchg_rtn_b64 v[72:73], v92, v[76:77] offset:65408
    v_and_b32 v88, 0x0fffffff, v44
    v_mov_b32 v39, v44
    buffer_load_dwordx2 v[34:35], v88, s[8:11], 0 offen
    buffer_load_dwordx3 v[36:38], v88, s[8:11], 0 offen offset:8
    s_setprio 0
    s_waitcnt vmcnt(12)
    s_mov_b32 m0, s38
    s_nop 0
    ds_write_addtid_b32 v108 offset:0
    ds_write_addtid_b32 v109 offset:256
    ds_write_addtid_b32 v110 offset:512
    ds_write_addtid_b32 v111 offset:768
    s_waitcnt vmcnt(9)
    ds_write_addtid_b32 v112 offset:1024
    ds_write_addtid_b32 v113 offset:1280
    ds_write_addtid_b32 v114 offset:1536
    ds_write_addtid_b32 v115 offset:1792
    v_mfma_f32_4x4x4_16b_bf16 v[80:83], v[8:9], v[106:107], 0
    v_mfma_f32_4x4x4_16b_bf16 v[76:79], v[8:9], v[104:105], 0
    v_cmp_lt_u32 s[84:85], v5, v94
    s_nop 2
    v_pk_mul_f32 v[80:81], v[80:81], v[14:15] op_sel:[0,1] op_sel_hi:[1,1]
    v_pk_mul_f32 v[82:83], v[82:83], v[14:15] op_sel:[0,1] op_sel_hi:[1,1]
    v_pk_mul_f32 v[76:77], v[76:77], v[14:15] op_sel:[0,0] op_sel_hi:[1,0]
    v_pk_mul_f32 v[78:79], v[78:79], v[14:15] op_sel:[0,0] op_sel_hi:[1,0]
    s_add_u32 s42, s42, 1
    s_waitcnt lgkmcnt(0)
    s_barrier
    s_bitcmp1_b32 s36, s42
    s_cbranch_scc1 L2_slow
L2_ret4:
    s_setprio 3
    s_bitcmp1_b32 s43, s42
    s_cbranch_scc1 L2_oa82
L2_ob82:
    v_and_b32 v46, 0x20000000, v21
    v_lshrrev_b32 v47, 14, v17
    v_bitop3_b32 v47, v47, v5, v46 bitop3:0xea
    ds_read_b64 v[102:103], v47
    v_and_b32 v99, 0x10000000, v21
    v_lshrrev_b32 v47, 14, v16
    v_bitop3_b32 v47, v47, v5, v99 bitop3:0xea
    ds_read_b64 v[100:101], v47
    v_cmp_ne_u64 s[50:51], v[72:73], v[68:69]
    v_cmpx_ne_u64 s[54:55], v[74:75], v[70:71]
    s_and_b64 s[82:83], s[54:55], s[80:81]
    s_cbranch_scc1 L2_c83
L2_d83:
    v_mov_b64 v[84:85], v[70:71]
    v_mov_b32 v7, v93
    v_mov_b64 v[86:87], v[74:75]
    s_or_b64 s[80:81], s[80:81], s[54:55]
    s_mov_b64 exec, s[50:51]
    s_and_b64 s[82:83], s[50:51], s[80:81]
    s_cbranch_scc1 L2_c84
L2_d84:
    v_mov_b64 v[84:85], v[68:69]
    v_mov_b32 v7, v92
    v_mov_b64 v[86:87], v[72:73]
    s_mov_b64 exec, -1
    s_or_b64 s[80:81], s[80:81], s[50:51]
    s_and_b64 exec, s[84:85], s[80:81]
    v_mfma_f32_4x4x4_16b_bf16 v[76:79], v[12:13], v[84:85], 0
    v_mov_b32 v94, v7
    s_andn2_b64 s[80:81], s[80:81], s[84:85]
    v_mfma_f32_4x4x4_16b_bf16 v[76:79], v[10:11], v[86:87], v[76:79]
    s_mov_b64 exec, -1
    ds_read_b64 v[70:71], v95 offset:65408
    ds_read_b64 v[68:69], v94 offset:65408
    v_bitop3_b32 v92, v16, v5, v99 bitop3:0xea
    v_bitop3_b32 v93, v17, v5, v46 bitop3:0xea
    v_perm_b32 v15, v17, v20, s45
    v_bitop3_b32 v46, v17, 0.5, -0.5 bitop3:0xa8
    v_perm_b32 v14, v16, v20, s44
    v_bitop3_b32 v47, v16, 0.5, -0.5 bitop3:0xa8
    v_bitop3_b32 v15, v6, v15, v46 bitop3:0xca
    v_bitop3_b32 v14, v6, v14, v47 bitop3:0xca
    s_waitcnt lgkmcnt(1)
    v_mfma_f32_4x4x4_16b_bf16 v[80:83], v[10:11], v[70:71], v[80:83]
    s_waitcnt lgkmcnt(0)
    v_mfma_f32_4x4x4_16b_bf16 v[76:79], v[10:11], v[68:69], v[76:79]
    s_nop 2
    v_cvt_pk_bf16_f32 v80, v80, v81
    v_cvt_pk_bf16_f32 v81, v82, v83
    ds_wrxchg_rtn_b64 v[74:75], v95, v[80:81] offset:65408
    v_cvt_pk_bf16_f32 v76, v76, v77
    v_cvt_pk_bf16_f32 v77, v78, v79
    ds_wrxchg_rtn_b64 v[72:73], v94, v[76:77] offset:65408
    v_mfma_f32_4x4x4_16b_bf16 v[80:83], v[8:9], v[102:103], 0
    v_mfma_f32_4x4x4_16b_bf16 v[76:79], v[8:9], v[100:101], 0
    v_cmp_lt_u32 s[84:85], v5, v92
    s_nop 2
    v_pk_mul_f32 v[80:81], v[80:81], v[14:15] op_sel:[0,1] op_sel_hi:[1,1]
    v_pk_mul_f32 v[82:83], v[82:83], v[14:15] op_sel:[0,1] op_sel_hi:[1,1]
    v_pk_mul_f32 v[76:77], v[76:77], v[14:15] op_sel:[0,0] op_sel_hi:[1,0]
    v_pk_mul_f32 v[78:79], v[78:79], v[14:15] op_sel:[0,0] op_sel_hi:[1,0]
    buffer_load_dwordx4 v[108:111], v3, s[16:19], s40 offen offset:0
    v_and_b32 v46, 0x80000000, v21
    v_lshrrev_b32 v47, 14, v19
    v_bitop3_b32 v47, v47, v5, v46 bitop3:0xea
    ds_read_b64 v[106:107], v47
    v_and_b32 v99, 0x40000000, v21
    v_lshrrev_b32 v47, 14, v18
    v_bitop3_b32 v47, v47, v5, v99 bitop3:0xea
    ds_read_b64 v[104:105], v47
    s_waitcnt lgkmcnt(2)
    v_cmp_ne_u64 s[50:51], v[72:73], v[68:69]
    v_cmpx_ne_u64 s[54:55], v[74:75], v[70:71]
    s_and_b64 s[82:83], s[54:55], s[80:81]
    s_cbranch_scc1 L2_c85
L2_d85:
    v_mov_b64 v[84:85], v[70:71]
    v_mov_b32 v7, v95
    v_mov_b64 v[86:87], v[74:75]
    s_or_b64 s[80:81], s[80:81], s[54:55]
    s_mov_b64 exec, s[50:51]
    s_and_b64 s[82:83], s[50:51], s[80:81]
    s_cbranch_scc1 L2_c86
L2_d86:
    v_mov_b64 v[84:85], v[68:69]
    v_mov_b32 v7, v94
    v_mov_b64 v[86:87], v[72:73]
    s_mov_b64 exec, -1
    s_or_b64 s[80:81], s[80:81], s[50:51]
    s_and_b64 exec, s[84:85], s[80:81]
    v_mfma_f32_4x4x4_16b_bf16 v[76:79], v[12:13], v[84:85], 0
    v_mov_b32 v92, v7
    s_andn2_b64 s[80:81], s[80:81], s[84:85]
    v_mfma_f32_4x4x4_16b_bf16 v[76:79], v[10:11], v[86:87], v[76:79]
    s_mov_b64 exec, -1
    ds_read_b64 v[70:71], v93 offset:65408
    ds_read_b64 v[68:69], v92 offset:65408
    v_bitop3_b32 v94, v18, v5, v99 bitop3:0xea
    v_bitop3_b32 v95, v19, v5, v46 bitop3:0xea
    v_perm_b32 v15, v19, v20, s47
    v_bitop3_b32 v46, v19, 0.5, -0.5 bitop3:0xa8
    v_perm_b32 v14, v18, v20, s46
    v_bitop3_b32 v47, v18, 0.5, -0.5 bitop3:0xa8
    v_bitop3_b32 v15, v6, v15, v46 bitop3:0xca
    v_bitop3_b32 v14, v6, v14, v47 bitop3:0xca
    s_waitcnt lgkmcnt(1)
    v_mfma_f32_4x4x4_16b_bf16 v[80:83], v[10:11], v[70:71], v[80:83]
    s_waitcnt lgkmcnt(0)
    v_mfma_f32_4x4x4_16b_bf16 v[76:79], v[10:11], v[68:69], v[76:79]
    s_nop 2
    v_cvt_pk_bf16_f32 v80, v80, v81
    v_cvt_pk_bf16_f32 v81, v82, v83
    ds_wrxchg_rtn_b64 v[74:75], v93, v[80:81] offset:65408
    v_cvt_pk_bf16_f32 v76, v76, v77
    v_cvt_pk_bf16_f32 v77, v78, v79
    ds_wrxchg_rtn_b64 v[72:73], v92, v[76:77] offset:65408
    v_and_b32 v88, 0x0fffffff, v40
    v_mov_b32 v21, v40
    buffer_load_dwordx2 v[16:17], v88, s[8:11], 0 offen
    buffer_load_dwordx3 v[18:20], v88, s[8:11], 0 offen offset:8
    s_setprio 2
    v_mfma_f32_4x4x4_16b_bf16 v[80:83], v[8:9], v[106:107], 0
    v_mfma_f32_4x4x4_16b_bf16 v[76:79], v[8:9], v[104:105], 0
    v_cmp_lt_u32 s[48:49], v5, v95
    s_nop 2
    v_pk_mul_f32 v[80:81], v[80:81], v[14:15] op_sel:[0,1] op_sel_hi:[1,1]
    v_pk_mul_f32 v[82:83], v[82:83], v[14:15] op_sel:[0,1] op_sel_hi:[1,1]
    v_pk_mul_f32 v[76:77], v[76:77], v[14:15] op_sel:[0,0] op_sel_hi:[1,0]
    v_pk_mul_f32 v[78:79], v[78:79], v[14:15] op_sel:[0,0] op_sel_hi:[1,0]
    s_waitcnt vmcnt(10)
    v_and_b32 v46, 0x20000000, v27
    v_lshrrev_b32 v47, 14, v23
    v_bitop3_b32 v47, v47, v5, v46 bitop3:0xea
    ds_read_b64 v[102:103], v47
    v_and_b32 v99, 0x10000000, v27
    v_lshrrev_b32 v47, 14, v22
    v_bitop3_b32 v47, v47, v5, v99 bitop3:0xea
    ds_read_b64 v[100:101], v47
    s_waitcnt lgkmcnt(2)
    v_cmp_ne_u64 s[50:51], v[72:73], v[68:69]
    v_cmpx_ne_u64 s[54:55], v[74:75], v[70:71]
    s_and_b64 s[82:83], s[54:55], s[80:81]
    s_cbranch_scc1 L2_c87
L2_d87:
    v_mov_b64 v[84:85], v[70:71]
    v_mov_b32 v7, v93
    v_mov_b64 v[86:87], v[74:75]
    s_or_b64 s[80:81], s[80:81], s[54:55]
    s_mov_b64 exec, s[50:51]
    s_and_b64 s[82:83], s[50:51], s[80:81]
    s_cbranch_scc1 L2_c88
L2_d88:
    v_mov_b64 v[84:85], v[68:69]
    v_mov_b32 v7, v92
    v_mov_b64 v[86:87], v[72:73]
    s_mov_b64 exec, -1
    s_or_b64 s[80:81], s[80:81], s[50:51]
    s_and_b64 exec, s[48:49], s[80:81]
    v_mfma_f32_4x4x4_16b_bf16 v[80:83], v[12:13], v[84:85], 0
    v_mov_b32 v95, v7
    s_andn2_b64 s[80:81], s[80:81], s[48:49]
    v_mfma_f32_4x4x4_16b_bf16 v[80:83], v[10:11], v[86:87], v[80:83]
    s_mov_b64 exec, -1
    ds_read_b64 v[70:71], v95 offset:65408
    ds_read_b64 v[68:69], v94 offset:65408
    v_bitop3_b32 v92, v22, v5, v99 bitop3:0xea
    v_bitop3_b32 v93, v23, v5, v46 bitop3:0xea
    v_perm_b32 v15, v23, v26, s45
    v_bitop3_b32 v46, v23, 0.5, -0.5 bitop3:0xa8
    v_perm_b32 v14, v22, v26, s44
    v_bitop3_b32 v47, v22, 0.5, -0.5 bitop3:0xa8
    v_bitop3_b32 v15, v6, v15, v46 bitop3:0xca
    v_bitop3_b32 v14, v6, v14, v47 bitop3:0xca
    s_waitcnt lgkmcnt(1)
    v_mfma_f32_4x4x4_16b_bf16 v[80:83], v[10:11], v[70:71], v[80:83]
    s_waitcnt lgkmcnt(0)
    v_mfma_f32_4x4x4_16b_bf16 v[76:79], v[10:11], v[68:69], v[76:79]
    s_nop 2
    v_cvt_pk_bf16_f32 v80, v80, v81
    v_cvt_pk_bf16_f32 v81, v82, v83
    ds_wrxchg_rtn_b64 v[74:75], v95, v[80:81] offset:65408
    v_cvt_pk_bf16_f32 v76, v76, v77
    v_cvt_pk_bf16_f32 v77, v78, v79
    ds_wrxchg_rtn_b64 v[72:73], v94, v[76:77] offset:65408
    s_setprio 1
    v_mfma_f32_4x4x4_16b_bf16 v[80:83], v[8:9], v[102:103], 0
    v_mfma_f32_4x4x4_16b_bf16 v[76:79], v[8:9], v[100:101], 0
    s_nop 3
    v_pk_mul_f32 v[80:81], v[80:81], v[14:15] op_sel:[0,1] op_sel_hi:[1,1]
    v_pk_mul_f32 v[82:83], v[82:83], v[14:15] op_sel:[0,1] op_sel_hi:[1,1]
    v_pk_mul_f32 v[76:77], v[76:77], v[14:15] op_sel:[0,0] op_sel_hi:[1,0]
    v_pk_mul_f32 v[78:79], v[78:79], v[14:15] op_sel:[0,0] op_sel_hi:[1,0]
    s_bitcmp1_b32 s43, s42
    s_cbranch_scc1 L2_oa89
L2_ob89:
    buffer_load_dwordx4 v[112:115], v3, s[16:19], s40 offen offset:1024
    v_sub_u16 v88, v60, v52
    v_and_b32 v89, 3, v52
    v_add3_u32 v99, v88, v89, 3
    v_and_b32 v99, -4, v99
    v_max_u32 v99, 4, v99
    v_and_b32 v97, 0xfffc, v52
    v_bfm_b32 v96, v88, v89
    v_add_u32_dpp v91, v99, v99 row_shr:1 row_mask:0xf bank_mask:0xf bound_ctrl:1
    v_mad_u32_u24 v97, v97, 5, v2
    v_cmp_lt_u32 vcc, 16, v99
    v_add_u32_dpp v91, v91, v91 row_shr:2 row_mask:0xf bank_mask:0xf bound_ctrl:1
    v_sub_u32 v98, s38, v99
    v_lshrrev_b64 v[52:53], 16, v[52:53]
    v_add_u32_dpp v91, v91, v91 row_shr:4 row_mask:0xf bank_mask:0xf bound_ctrl:1
    v_lshrrev_b64 v[60:61], 16, v[60:61]
    s_mov_b32 s101, 0
    v_add_u32_dpp v91, v91, v91 row_shr:8 row_mask:0xf bank_mask:0xf bound_ctrl:1
    s_nop 1
    v_add_u32_dpp v91, v91, v91 row_bcast:15 row_mask:0xa bank_mask:0xf
    s_nop 1
    v_add_u32_dpp v91, v91, v91 row_bcast:31 row_mask:0xc bank_mask:0xf
    v_add_u32 v98, v98, v91
    v_readlane_b32 s37, v91, 63
    s_cbranch_vccnz L2_xo90
L2_xp90:
    v_and_b32 v46, 0x80000000, v27
    v_lshrrev_b32 v47, 14, v25
    v_bitop3_b32 v47, v47, v5, v46 bitop3:0xea
    ds_read_b64 v[106:107], v47
    v_and_b32 v99, 0x40000000, v27
    v_lshrrev_b32 v47, 14, v24
    v_bitop3_b32 v47, v47, v5, v99 bitop3:0xea
    ds_read_b64 v[104:105], v47
    s_waitcnt lgkmcnt(2)
    v_cmp_ne_u64 s[50:51], v[72:73], v[68:69]
    v_cmpx_ne_u64 s[54:55], v[74:75], v[70:71]
    s_and_b64 s[82:83], s[54:55], s[80:81]
    s_cbranch_scc1 L2_c91
L2_d91:
    v_mov_b64 v[84:85], v[70:71]
    v_mov_b32 v7, v95
    v_mov_b64 v[86:87], v[74:75]
    s_or_b64 s[80:81], s[80:81], s[54:55]
    s_mov_b64 exec, s[50:51]
    s_and_b64 s[82:83], s[50:51], s[80:81]
    s_cbranch_scc1 L2_c92
L2_d92:
    v_mov_b64 v[84:85], v[68:69]
    v_mov_b32 v7, v94
    v_mov_b64 v[86:87], v[72:73]
    s_mov_b64 exec, -1
    s_or_b64 s[80:81], s[80:81], s[50:51]
    ds_read_b64 v[70:71], v93 offset:65408
    ds_read_b64 v[68:69], v92 offset:65408
    v_bitop3_b32 v94, v24, v5, v99 bitop3:0xea
    v_bitop3_b32 v95, v25, v5, v46 bitop3:0xea
    v_perm_b32 v15, v25, v26, s47
    v_bitop3_b32 v46, v25, 0.5, -0.5 bitop3:0xa8
    v_perm_b32 v14, v24, v26, s46
    v_bitop3_b32 v47, v24, 0.5, -0.5 bitop3:0xa8
    v_bitop3_b32 v15, v6, v15, v46 bitop3:0xca
    v_bitop3_b32 v14, v6, v14, v47 bitop3:0xca
    s_waitcnt lgkmcnt(1)
    v_mfma_f32_4x4x4_16b_bf16 v[80:83], v[10:11], v[70:71], v[80:83]
    s_waitcnt lgkmcnt(0)
    v_mfma_f32_4x4x4_16b_bf16 v[76:79], v[10:11], v[68:69], v[76:79]
    s_nop 2
    v_cvt_pk_bf16_f32 v80, v80, v81
    v_cvt_pk_bf16_f32 v81, v82, v83
    ds_wrxchg_rtn_b64 v[74:75], v93, v[80:81] offset:65408
    v_cvt_pk_bf16_f32 v76, v76, v77
    v_cvt_pk_bf16_f32 v77, v78, v79
    ds_wrxchg_rtn_b64 v[72:73], v92, v[76:77] offset:65408
    v_and_b32 v88, 0x0fffffff, v41
    v_mov_b32 v27, v41
    buffer_load_dwordx2 v[22:23], v88, s[8:11], 0 offen
    buffer_load_dwordx3 v[24:26], v88, s[8:11], 0 offen offset:8
    v_mfma_f32_4x4x4_16b_bf16 v[80:83], v[8:9], v[106:107], 0
    v_mfma_f32_4x4x4_16b_bf16 v[76:79], v[8:9], v[104:105], 0
    v_cmp_lt_u32 s[84:85], v5, v94
    s_nop 2
    v_pk_mul_f32 v[80:81], v[80:81], v[14:15] op_sel:[0,1] op_sel_hi:[1,1]
    v_pk_mul_f32 v[82:83], v[82:83], v[14:15] op_sel:[0,1] op_sel_hi:[1,1]
    v_pk_mul_f32 v[76:77], v[76:77], v[14:15] op_sel:[0,0] op_sel_hi:[1,0]
    v_pk_mul_f32 v[78:79], v[78:79], v[14:15] op_sel:[0,0] op_sel_hi:[1,0]
    s_waitcnt vmcnt(11)
    s_mov_b64 exec, s[6:7]
    v_lshrrev_b32 v30, 16, v30
    s_mov_b64 exec, -1
    v_and_b32 v46, 0x20000000, v31
    v_lshrrev_b32 v47, 14, v29
    v_bitop3_b32 v47, v47, v5, v46 bitop3:0xea
    ds_read_b64 v[102:103], v47
    v_and_b32 v99, 0x10000000, v31
    v_lshrrev_b32 v47, 14, v28
    v_bitop3_b32 v47, v47, v5, v99 bitop3:0xea
    ds_read_b64 v[100:101], v47
    s_waitcnt lgkmcnt(2)
    v_cmp_ne_u64 s[50:51], v[72:73], v[68:69]
    v_cmpx_ne_u64 s[54:55], v[74:75], v[70:71]
    s_and_b64 s[82:83], s[54:55], s[80:81]
    s_cbranch_scc1 L2_c93
L2_d93:
    v_mov_b64 v[84:85], v[70:71]
    v_mov_b32 v7, v93
    v_mov_b64 v[86:87], v[74:75]
    s_or_b64 s[80:81], s[80:81], s[54:55]
    s_mov_b64 exec, s[50:51]
    s_and_b64 s[82:83], s[50:51], s[80:81]
    s_cbranch_scc1 L2_c94
L2_d94:
    v_mov_b64 v[84:85], v[68:69]
    v_mov_b32 v7, v92
    v_mov_b64 v[86:87], v[72:73]
    s_mov_b64 exec, -1
    s_or_b64 s[80:81], s[80:81], s[50:51]
    s_and_b64 exec, s[84:85], s[80:81]
    v_mfma_f32_4x4x4_16b_bf16 v[76:79], v[12:13], v[84:85], 0
    v_mov_b32 v94, v7
    s_andn2_b64 s[80:81], s[80:81], s[84:85]
    v_mfma_f32_4x4x4_16b_bf16 v[76:79], v[10:11], v[86:87], v[76:79]
    s_mov_b64 exec, -1
    ds_read_b64 v[70:71], v95 offset:65408
    ds_read_b64 v[68:69], v94 offset:65408
    v_bitop3_b32 v92, v28, v5, v99 bitop3:0xea
    v_bitop3_b32 v93, v29, v5, v46 bitop3:0xea
    v_perm_b32 v15, v29, v30, s45
    v_bitop3_b32 v46, v29, 0.5, -0.5 bitop3:0xa8
    v_perm_b32 v14, v28, v30, s44
    v_bitop3_b32 v47, v28, 0.5, -0.5 bitop3:0xa8
    v_bitop3_b32 v15, v6, v15, v46 bitop3:0xca
    v_bitop3_b32 v14, v6, v14, v47 bitop3:0xca
    s_waitcnt lgkmcnt(1)
    v_mfma_f32_4x4x4_16b_bf16 v[80:83], v[10:11], v[70:71], v[80:83]
    s_waitcnt lgkmcnt(0)
    v_mfma_f32_4x4x4_16b_bf16 v[76:79], v[10:11], v[68:69], v[76:79]
    s_nop 2
    v_cvt_pk_bf16_f32 v80, v80, v81
    v_cvt_pk_bf16_f32 v81, v82, v83
    ds_wrxchg_rtn_b64 v[74:75], v95, v[80:81] offset:65408
    v_cvt_pk_bf16_f32 v76, v76, v77
    v_cvt_pk_bf16_f32 v77, v78, v79
    ds_wrxchg_rtn_b64 v[72:73], v94, v[76:77] offset:65408
    s_setprio 0
    v_mfma_f32_4x4x4_16b_bf16 v[80:83], v[8:9], v[102:103], 0
    v_mfma_f32_4x4x4_16b_bf16 v[76:79], v[8:9], v[100:101], 0
    v_cmp_lt_u32 s[48:49], v5, v93
    s_nop 2
    v_pk_mul_f32 v[80:81], v[80:81], v[14:15] op_sel:[0,1] op_sel_hi:[1,1]
    v_pk_mul_f32 v[82:83], v[82:83], v[14:15] op_sel:[0,1] op_sel_hi:[1,1]
    v_pk_mul_f32 v[76:77], v[76:77], v[14:15] op_sel:[0,0] op_sel_hi:[1,0]
    v_pk_mul_f32 v[78:79], v[78:79], v[14:15] op_sel:[0,0] op_sel_hi:[1,0]
    s_add_u32 s40, s40, 0x50000
    v_and_b32 v47, 0x0fffffff, v42
    v_mov_b32 v31, v42
    buffer_load_dword v30, v47, s[8:11], 0 offen offset:16
    s_mov_b64 exec, s[6:7]
    v_add_u32 v47, 8, v47
    v_lshrrev_b32 v31, 2, v31
    s_mov_b64 exec, -1
    buffer_load_dwordx2 v[28:29], v47, s[8:11], 0 offen
    s_waitcnt vmcnt(8)
    v_and_b32 v46, 0x80000000, v39
    v_lshrrev_b32 v47, 14, v37
    v_bitop3_b32 v47, v47, v5, v46 bitop3:0xea
    ds_read_b64 v[102:103], v47
    v_and_b32 v99, 0x40000000, v39
    v_lshrrev_b32 v47, 14, v36
    v_bitop3_b32 v47, v47, v5, v99 bitop3:0xea
    ds_read_b64 v[100:101], v47
    v_and_b32 v46, 0x20000000, v39
    v_lshrrev_b32 v47, 14, v35
    v_bitop3_b32 v47, v47, v5, v46 bitop3:0xea
    ds_read_b64 v[106:107], v47
    v_and_b32 v99, 0x10000000, v39
    v_lshrrev_b32 v47, 14, v34
    v_bitop3_b32 v47, v47, v5, v99 bitop3:0xea
    ds_read_b64 v[104:105], v47
    s_waitcnt lgkmcnt(4)
    v_cmp_ne_u64 s[50:51], v[72:73], v[68:69]
    v_cmpx_ne_u64 s[54:55], v[74:75], v[70:71]
    s_and_b64 s[82:83], s[54:55], s[80:81]
    s_cbranch_scc1 L2_c95
L2_d95:
    v_mov_b64 v[84:85], v[70:71]
    v_mov_b32 v7, v95
    v_mov_b64 v[86:87], v[74:75]
    s_or_b64 s[80:81], s[80:81], s[54:55]
    s_mov_b64 exec, s[50:51]
    s_and_b64 s[82:83], s[50:51], s[80:81]
    s_cbranch_scc1 L2_c96
L2_d96:
    v_mov_b64 v[84:85], v[68:69]
    v_mov_b32 v7, v94
    v_mov_b64 v[86:87], v[72:73]
    s_mov_b64 exec, -1
    s_or_b64 s[80:81], s[80:81], s[50:51]
    s_and_b64 exec, s[48:49], s[80:81]
    v_mfma_f32_4x4x4_16b_bf16 v[80:83], v[12:13], v[84:85], 0
    v_mov_b32 v93, v7
    s_andn2_b64 s[80:81], s[80:81], s[48:49]
    v_mfma_f32_4x4x4_16b_bf16 v[80:83], v[10:11], v[86:87], v[80:83]
    s_mov_b64 exec, -1
    ds_read_b64 v[70:71], v93 offset:65408
    ds_read_b64 v[68:69], v92 offset:65408
    v_bitop3_b32 v94, v34, v5, v99 bitop3:0xea
    v_bitop3_b32 v95, v35, v5, v46 bitop3:0xea
    v_perm_b32 v15, v35, v38, s45
    v_bitop3_b32 v46, v35, 0.5, -0.5 bitop3:0xa8
    v_perm_b32 v14, v34, v38, s44
    v_bitop3_b32 v47, v34, 0.5, -0.5 bitop3:0xa8
    v_bitop3_b32 v15, v6, v15, v46 bitop3:0xca
    v_bitop3_b32 v14, v6, v14, v47 bitop3:0xca
    s_waitcnt lgkmcnt(1)
    v_mfma_f32_4x4x4_16b_bf16 v[80:83], v[10:11], v[70:71], v[80:83]
    s_waitcnt lgkmcnt(0)
    v_mfma_f32_4x4x4_16b_bf16 v[76:79], v[10:11], v[68:69], v[76:79]
    s_nop 2
    v_cvt_pk_bf16_f32 v80, v80, v81
    v_cvt_pk_bf16_f32 v81, v82, v83
    ds_wrxchg_rtn_b64 v[74:75], v93, v[80:81] offset:65408
    v_cvt_pk_bf16_f32 v76, v76, v77
    v_cvt_pk_bf16_f32 v77, v78, v79
    ds_wrxchg_rtn_b64 v[72:73], v92, v[76:77] offset:65408
    s_barrier
    s_setprio 3
    s_mov_b32 m0, s100
    s_nop 0
    ds_write_addtid_b32 v124 offset:34816
    ds_write_addtid_b32 v125 offset:35072
    ds_write_addtid_b32 v126 offset:35328
    ds_write_addtid_b32 v127 offset:35584
    s_add_u32 s3, s40, 4096
    buffer_load_dwordx4 v[124:127], v3, s[16:19], s3 offen
    ds_write_addtid_b32 v116 offset:32768
    ds_write_addtid_b32 v117 offset:33024
    ds_write_addtid_b32 v118 offset:33280
    ds_write_addtid_b32 v119 offset:33536
    buffer_load_dwordx4 v[116:119], v3, s[16:19], s40 offen offset:2048
    ds_write_addtid_b32 v120 offset:33792
    ds_write_addtid_b32 v121 offset:34048
    ds_write_addtid_b32 v122 offset:34304
    ds_write_addtid_b32 v123 offset:34560
    buffer_load_dwordx4 v[120:123], v3, s[16:19], s40 offen offset:3072
    v_mfma_f32_4x4x4_16b_bf16 v[80:83], v[8:9], v[106:107], 0
    v_mfma_f32_4x4x4_16b_bf16 v[76:79], v[8:9], v[104:105], 0
    s_nop 3
    v_pk_mul_f32 v[80:81], v[80:81], v[14:15] op_sel:[0,1] op_sel_hi:[1,1]
    v_pk_mul_f32 v[82:83], v[82:83], v[14:15] op_sel:[0,1] op_sel_hi:[1,1]
    v_pk_mul_f32 v[76:77], v[76:77], v[14:15] op_sel:[0,0] op_sel_hi:[1,0]
    v_pk_mul_f32 v[78:79], v[78:79], v[14:15] op_sel:[0,0] op_sel_hi:[1,0]
    v_mov_b32 v44, v43
    s_cmp_gt_u32 s37, 1024
    s_cbranch_scc1 L2_xs97
    s_cmp_lg_u32 s101, 0
    s_cbranch_scc1 L2_xa97
L2_xb97:
    v_lshlrev_b32 v89, 16, v96
    v_add_u32 v90, 60, v97
    v_bitop3_b32 v90, v89, v45, v90 bitop3:0x6a
    ds_write_b32 v98, v90 offset:12
    v_lshlrev_b32 v89, 20, v96
    v_add_u32 v90, 40, v97
    v_bitop3_b32 v90, v89, v45, v90 bitop3:0x6a
    ds_write_b32 v98, v90 offset:8
    v_lshlrev_b32 v89, 24, v96
    v_add_u32 v90, 20, v97
    v_bitop3_b32 v90, v89, v45, v90 bitop3:0x6a
    ds_write_b32 v98, v90 offset:4
    v_lshlrev_b32 v89, 28, v96
    v_bitop3_b32 v90, v89, v45, v97 bitop3:0x6a
    ds_write_b32 v98, v90 offset:0
    v_mov_b32_dpp v91, v64 quad_perm:[1,1,1,1] row_mask:0xf bank_mask:0xf
    v_and_b32 v89, 3, v91
    v_and_b32 v97, 0xfffc, v91
    v_sub_u16_dpp v88, v64, v91 quad_perm:[3,3,3,3] row_mask:0xf bank_mask:0xf
    v_mad_u32_u24 v97, v97, 5, v4
    v_add_u32 v99, v88, v89
    v_bfm_b32 v96, v88, v89
    v_cmp_lt_u32 s[58:59], 16, v99
    v_lshlrev_b32 v89, v1, v96
    v_and_b32 v89, v45, v89
    v_cmp_ne_u32 vcc, 0, v89
    v_xor_b32 v90, v97, v89
    s_add_u32 s3, s37, s38
    v_mbcnt_lo_u32_b32 v98, vcc_lo, 0
    v_mbcnt_hi_u32_b32 v98, vcc_hi, v98
    s_bcnt1_i32_b64 s41, vcc
    v_lshl_add_u32 v98, v98, 2, s3
    s_lshl2_add_u32 s37, s41, s37
    s_mov_b64 exec, vcc
    ds_write_b32 v98, v90
    s_mov_b64 exec, -1
    s_cmp_lg_u64 s[58:59], 0
    s_cbranch_scc1 L2_xe97
L2_xr97:
    v_add_u32 v98, s37, v0
    v_mov_b32 v90, -1
    ds_write_b32 v98, v90
    v_add_u32 v98, s38, v0
    ds_read2st64_b32 v[40:41], v0 offset0:0 offset1:1
    ds_read_b32 v43, v0 offset:512
    v_lshrrev_b32 v98, 1, v98
    v_and_b32 v98, -4, v98
    ds_read_b32 v42, v98 offset:768
    s_sub_u32 s3, s37, 768
    s_cmp_gt_u32 s3, 128
    s_cbranch_scc1 L2_xf97
L2_xg97:
    s_setprio 2
    s_waitcnt lgkmcnt(14)
    v_cmp_ne_u64 s[50:51], v[72:73], v[68:69]
    v_cmpx_ne_u64 s[54:55], v[74:75], v[70:71]
    s_and_b64 s[82:83], s[54:55], s[80:81]
    s_cbranch_scc1 L2_c98
L2_d98:
    v_mov_b64 v[84:85], v[70:71]
    v_mov_b32 v7, v93
    v_mov_b64 v[86:87], v[74:75]
    s_or_b64 s[80:81], s[80:81], s[54:55]
    s_mov_b64 exec, s[50:51]
    s_and_b64 s[82:83], s[50:51], s[80:81]
    s_cbranch_scc1 L2_c99
L2_d99:
    v_mov_b64 v[84:85], v[68:69]
    v_mov_b32 v7, v92
    v_mov_b64 v[86:87], v[72:73]
    s_mov_b64 exec, -1
    s_or_b64 s[80:81], s[80:81], s[50:51]
    ds_read_b64 v[70:71], v95 offset:65408
    ds_read_b64 v[68:69], v94 offset:65408
    v_and_b32 v46, 0x40000000, v39
    v_bitop3_b32 v92, v36, v5, v46 bitop3:0xea
    v_and_b32 v46, 0x80000000, v39
    v_bitop3_b32 v93, v37, v5, v46 bitop3:0xea
    v_perm_b32 v15, v37, v38, s47
    v_bitop3_b32 v46, v37, 0.5, -0.5 bitop3:0xa8
    v_perm_b32 v14, v36, v38, s46
    v_bitop3_b32 v47, v36, 0.5, -0.5 bitop3:0xa8
    v_bitop3_b32 v15, v6, v15, v46 bitop3:0xca
    v_bitop3_b32 v14, v6, v14, v47 bitop3:0xca
    s_setprio 1
    s_waitcnt lgkmcnt(1)
    v_mfma_f32_4x4x4_16b_bf16 v[80:83], v[10:11], v[70:71], v[80:83]
    s_waitcnt lgkmcnt(0)
    v_mfma_f32_4x4x4_16b_bf16 v[76:79], v[10:11], v[68:69], v[76:79]
    s_nop 2
    v_cvt_pk_bf16_f32 v80, v80, v81
    v_cvt_pk_bf16_f32 v81, v82, v83
    ds_wrxchg_rtn_b64 v[74:75], v95, v[80:81] offset:65408
    v_cvt_pk_bf16_f32 v76, v76, v77
    v_cvt_pk_bf16_f32 v77, v78, v79
    ds_wrxchg_rtn_b64 v[72:73], v94, v[76:77] offset:65408
    v_and_b32 v88, 0x0fffffff, v44
    v_mov_b32 v39, v44
    buffer_load_dwordx2 v[34:35], v88, s[8:11], 0 offen
    buffer_load_dwordx3 v[36:38], v88, s[8:11], 0 offen offset:8
    s_setprio 0
    s_waitcnt vmcnt(12)
    s_mov_b32 m0, s38
    s_nop 0
    ds_write_addtid_b32 v108 offset:0
    ds_write_addtid_b32 v109 offset:256
    ds_write_addtid_b32 v110 offset:512
    ds_write_addtid_b32 v111 offset:768
    s_waitcnt vmcnt(9)
    ds_write_addtid_b32 v112 offset:1024
    ds_write_addtid_b32 v113 offset:1280
    ds_write_addtid_b32 v114 offset:1536
    ds_write_addtid_b32 v115 offset:1792
    v_mfma_f32_4x4x4_16b_bf16 v[80:83], v[8:9], v[102:103], 0
    v_mfma_f32_4x4x4_16b_bf16 v[76:79], v[8:9], v[100:101], 0
    v_cmp_lt_u32 s[84:85], v5, v92
    s_nop 2
    v_pk_mul_f32 v[80:81], v[80:81], v[14:15] op_sel:[0,1] op_sel_hi:[1,1]
    v_pk_mul_f32 v[82:83], v[82:83], v[14:15] op_sel:[0,1] op_sel_hi:[1,1]
    v_pk_mul_f32 v[76:77], v[76:77], v[14:15] op_sel:[0,0] op_sel_hi:[1,0]
    v_pk_mul_f32 v[78:79], v[78:79], v[14:15] op_sel:[0,0] op_sel_hi:[1,0]
    s_add_u32 s42, s42, 1
    s_waitcnt lgkmcnt(0)
    s_barrier
    s_bitcmp1_b32 s36, s42
    s_cbranch_scc1 L2_slow
L2_ret5:
    s_setprio 3
    s_bitcmp1_b32 s43, s42
    s_cbranch_scc1 L2_oa100
L2_ob100:
    v_and_b32 v46, 0x20000000, v21
    v_lshrrev_b32 v47, 14, v17
    v_bitop3_b32 v47, v47, v5, v46 bitop3:0xea
    ds_read_b64 v[106:107], v47
    v_and_b32 v99, 0x10000000, v21
    v_lshrrev_b32 v47, 14, v16
    v_bitop3_b32 v47, v47, v5, v99 bitop3:0xea
    ds_read_b64 v[104:105], v47
    v_cmp_ne_u64 s[50:51], v[72:73], v[68:69]
    v_cmpx_ne_u64 s[54:55], v[74:75], v[70:71]
    s_and_b64 s[82:83], s[54:55], s[80:81]
    s_cbranch_scc1 L2_c101
L2_d101:
    v_mov_b64 v[84:85], v[70:71]
    v_mov_b32 v7, v95
    v_mov_b64 v[86:87], v[74:75]
    s_or_b64 s[80:81], s[80:81], s[54:55]
    s_mov_b64 exec, s[50:51]
    s_and_b64 s[82:83], s[50:51], s[80:81]
    s_cbranch_scc1 L2_c102
L2_d102:
    v_mov_b64 v[84:85], v[68:69]
    v_mov_b32 v7, v94
    v_mov_b64 v[86:87], v[72:73]
    s_mov_b64 exec, -1
    s_or_b64 s[80:81], s[80:81], s[50:51]
    s_and_b64 exec, s[84:85], s[80:81]
    v_mfma_f32_4x4x4_16b_bf16 v[76:79], v[12:13], v[84:85], 0
    v_mov_b32 v92, v7
    s_andn2_b64 s[80:81], s[80:81], s[84:85]
    v_mfma_f32_4x4x4_16b_bf16 v[76:79], v[10:11], v[86:87], v[76:79]
    s_mov_b64 exec, -1
    ds_read_b64 v[70:71], v93 offset:65408
    ds_read_b64 v[68:69], v92 offset:65408
    v_bitop3_b32 v94, v16, v5, v99 bitop3:0xea
    v_bitop3_b32 v95, v17, v5, v46 bitop3:0xea
    v_perm_b32 v15, v17, v20, s45
    v_bitop3_b32 v46, v17, 0.5, -0.5 bitop3:0xa8
    v_perm_b32 v14, v16, v20, s44
    v_bitop3_b32 v47, v16, 0.5, -0.5 bitop3:0xa8
    v_bitop3_b32 v15, v6, v15, v46 bitop3:0xca
    v_bitop3_b32 v14, v6, v14, v47 bitop3:0xca
    s_waitcnt lgkmcnt(1)
    v_mfma_f32_4x4x4_16b_bf16 v[80:83], v[10:11], v[70:71], v[80:83]
    s_waitcnt lgkmcnt(0)
    v_mfma_f32_4x4x4_16b_bf16 v[76:79], v[10:11], v[68:69], v[76:79]
    s_nop 2
    v_cvt_pk_bf16_f32 v80, v80, v81
    v_cvt_pk_bf16_f32 v81, v82, v83
    ds_wrxchg_rtn_b64 v[74:75], v93, v[80:81] offset:65408
    v_cvt_pk_bf16_f32 v76, v76, v77
    v_cvt_pk_bf16_f32 v77, v78, v79
    ds_wrxchg_rtn_b64 v[72:73], v92, v[76:77] offset:65408
    v_mfma_f32_4x4x4_16b_bf16 v[80:83], v[8:9], v[106:107], 0
    v_mfma_f32_4x4x4_16b_bf16 v[76:79], v[8:9], v[104:105], 0
    v_cmp_lt_u32 s[84:85], v5, v94
    s_nop 2
    v_pk_mul_f32 v[80:81], v[80:81], v[14:15] op_sel:[0,1] op_sel_hi:[1,1]
    v_pk_mul_f32 v[82:83], v[82:83], v[14:15] op_sel:[0,1] op_sel_hi:[1,1]
    v_pk_mul_f32 v[76:77], v[76:77], v[14:15] op_sel:[0,0] op_sel_hi:[1,0]
    v_pk_mul_f32 v[78:79], v[78:79], v[14:15] op_sel:[0,0] op_sel_hi:[1,0]
    buffer_load_dwordx4 v[108:111], v3, s[16:19], s40 offen offset:0
    v_and_b32 v46, 0x80000000, v21
    v_lshrrev_b32 v47, 14, v19
    v_bitop3_b32 v47, v47, v5, v46 bitop3:0xea
    ds_read_b64 v[102:103], v47
    v_and_b32 v99, 0x40000000, v21
    v_lshrrev_b32 v47, 14, v18
    v_bitop3_b32 v47, v47, v5, v99 bitop3:0xea
    ds_read_b64 v[100:101], v47
    s_waitcnt lgkmcnt(2)
    v_cmp_ne_u64 s[50:51], v[72:73], v[68:69]
    v_cmpx_ne_u64 s[54:55], v[74:75], v[70:71]
    s_and_b64 s[82:83], s[54:55], s[80:81]
    s_cbranch_scc1 L2_c103
L2_d103:
    v_mov_b64 v[84:85], v[70:71]
    v_mov_b32 v7, v93
    v_mov_b64 v[86:87], v[74:75]
    s_or_b64 s[80:81], s[80:81], s[54:55]
    s_mov_b64 exec, s[50:51]
    s_and_b64 s[82:83], s[50:51], s[80:81]
    s_cbranch_scc1 L2_c104
L2_d104:
    v_mov_b64 v[84:85], v[68:69]
    v_mov_b32 v7, v92
    v_mov_b64 v[86:87], v[72:73]
    s_mov_b64 exec, -1
    s_or_b64 s[80:81], s[80:81], s[50:51]
    s_and_b64 exec, s[84:85], s[80:81]
    v_mfma_f32_4x4x4_16b_bf16 v[76:79], v[12:13], v[84:85], 0
    v_mov_b32 v94, v7
    s_andn2_b64 s[80:81], s[80:81], s[84:85]
    v_mfma_f32_4x4x4_16b_bf16 v[76:79], v[10:11], v[86:87], v[76:79]
    s_mov_b64 exec, -1
    ds_read_b64 v[70:71], v95 offset:65408
    ds_read_b64 v[68:69], v94 offset:65408
    v_bitop3_b32 v92, v18, v5, v99 bitop3:0xea
    v_bitop3_b32 v93, v19, v5, v46 bitop3:0xea
    v_perm_b32 v15, v19, v20, s47
    v_bitop3_b32 v46, v19, 0.5, -0.5 bitop3:0xa8
    v_perm_b32 v14, v18, v20, s46
    v_bitop3_b32 v47, v18, 0.5, -0.5 bitop3:0xa8
    v_bitop3_b32 v15, v6, v15, v46 bitop3:0xca
    v_bitop3_b32 v14, v6, v14, v47 bitop3:0xca
    s_waitcnt lgkmcnt(1)
    v_mfma_f32_4x4x4_16b_bf16 v[80:83], v[10:11], v[70:71], v[80:83]
    s_waitcnt lgkmcnt(0)
    v_mfma_f32_4x4x4_16b_bf16 v[76:79], v[10:11], v[68:69], v[76:79]
    s_nop 2
    v_cvt_pk_bf16_f32 v80, v80, v81
    v_cvt_pk_bf16_f32 v81, v82, v83
    ds_wrxchg_rtn_b64 v[74:75], v95, v[80:81] offset:65408
    v_cvt_pk_bf16_f32 v76, v76, v77
    v_cvt_pk_bf16_f32 v77, v78, v79
    ds_wrxchg_rtn_b64 v[72:73], v94, v[76:77] offset:65408
    v_and_b32 v88, 0x0fffffff, v40
    v_mov_b32 v21, v40
    buffer_load_dwordx2 v[16:17], v88, s[8:11], 0 offen
    buffer_load_dwordx3 v[18:20], v88, s[8:11], 0 offen offset:8
    s_setprio 2
    v_mfma_f32_4x4x4_16b_bf16 v[80:83], v[8:9], v[102:103], 0
    v_mfma_f32_4x4x4_16b_bf16 v[76:79], v[8:9], v[100:101], 0
    v_cmp_lt_u32 s[48:49], v5, v93
    s_nop 2
    v_pk_mul_f32 v[80:81], v[80:81], v[14:15] op_sel:[0,1] op_sel_hi:[1,1]
    v_pk_mul_f32 v[82:83], v[82:83], v[14:15] op_sel:[0,1] op_sel_hi:[1,1]
    v_pk_mul_f32 v[76:77], v[76:77], v[14:15] op_sel:[0,0] op_sel_hi:[1,0]
    v_pk_mul_f32 v[78:79], v[78:79], v[14:15] op_sel:[0,0] op_sel_hi:[1,0]
    s_waitcnt vmcnt(10)
    v_and_b32 v46, 0x20000000, v27
    v_lshrrev_b32 v47, 14, v23
    v_bitop3_b32 v47, v47, v5, v46 bitop3:0xea
    ds_read_b64 v[106:107], v47
    v_and_b32 v99, 0x10000000, v27
    v_lshrrev_b32 v47, 14, v22
    v_bitop3_b32 v47, v47, v5, v99 bitop3:0xea
    ds_read_b64 v[104:105], v47
    s_waitcnt lgkmcnt(2)
    v_cmp_ne_u64 s[50:51], v[72:73], v[68:69]
    v_cmpx_ne_u64 s[54:55], v[74:75], v[70:71]
    s_and_b64 s[82:83], s[54:55], s[80:81]
    s_cbranch_scc1 L2_c105
L2_d105:
    v_mov_b64 v[84:85], v[70:71]
    v_mov_b32 v7, v95
    v_mov_b64 v[86:87], v[74:75]
    s_or_b64 s[80:81], s[80:81], s[54:55]
    s_mov_b64 exec, s[50:51]
    s_and_b64 s[82:83], s[50:51], s[80:81]
    s_cbranch_scc1 L2_c106
L2_d106:
    v_mov_b64 v[84:85], v[68:69]
    v_mov_b32 v7, v94
    v_mov_b64 v[86:87], v[72:73]
    s_mov_b64 exec, -1
    s_or_b64 s[80:81], s[80:81], s[50:51]
    s_and_b64 exec, s[48:49], s[80:81]
    v_mfma_f32_4x4x4_16b_bf16 v[80:83], v[12:13], v[84:85], 0
    v_mov_b32 v93, v7
    s_andn2_b64 s[80:81], s[80:81], s[48:49]
    v_mfma_f32_4x4x4_16b_bf16 v[80:83], v[10:11], v[86:87], v[80:83]
    s_mov_b64 exec, -1
    ds_read_b64 v[70:71], v93 offset:65408
    ds_read_b64 v[68:69], v92 offset:65408
    v_bitop3_b32 v94, v22, v5, v99 bitop3:0xea
    v_bitop3_b32 v95, v23, v5, v46 bitop3:0xea
    v_perm_b32 v15, v23, v26, s45
    v_bitop3_b32 v46, v23, 0.5, -0.5 bitop3:0xa8
    v_perm_b32 v14, v22, v26, s44
    v_bitop3_b32 v47, v22, 0.5, -0.5 bitop3:0xa8
    v_bitop3_b32 v15, v6, v15, v46 bitop3:0xca
    v_bitop3_b32 v14, v6, v14, v47 bitop3:0xca
    s_waitcnt lgkmcnt(1)
    v_mfma_f32_4x4x4_16b_bf16 v[80:83], v[10:11], v[70:71], v[80:83]
    s_waitcnt lgkmcnt(0)
    v_mfma_f32_4x4x4_16b_bf16 v[76:79], v[10:11], v[68:69], v[76:79]
    s_nop 2
    v_cvt_pk_bf16_f32 v80, v80, v81
    v_cvt_pk_bf16_f32 v81, v82, v83
    ds_wrxchg_rtn_b64 v[74:75], v93, v[80:81] offset:65408
    v_cvt_pk_bf16_f32 v76, v76, v77
    v_cvt_pk_bf16_f32 v77, v78, v79
    ds_wrxchg_rtn_b64 v[72:73], v92, v[76:77] offset:65408
    s_setprio 1
    v_mfma_f32_4x4x4_16b_bf16 v[80:83], v[8:9], v[106:107], 0
    v_mfma_f32_4x4x4_16b_bf16 v[76:79], v[8:9], v[104:105], 0
    s_nop 3
    v_pk_mul_f32 v[80:81], v[80:81], v[14:15] op_sel:[0,1] op_sel_hi:[1,1]
    v_pk_mul_f32 v[82:83], v[82:83], v[14:15] op_sel:[0,1] op_sel_hi:[1,1]
    v_pk_mul_f32 v[76:77], v[76:77], v[14:15] op_sel:[0,0] op_sel_hi:[1,0]
    v_pk_mul_f32 v[78:79], v[78:79], v[14:15] op_sel:[0,0] op_sel_hi:[1,0]
    s_bitcmp1_b32 s43, s42
    s_cbranch_scc1 L2_oa107
L2_ob107:
    buffer_load_dwordx4 v[112:115], v3, s[16:19], s40 offen offset:1024
    v_sub_u16 v88, v62, v54
    v_and_b32 v89, 3, v54
    v_add3_u32 v99, v88, v89, 3
    v_and_b32 v99, -4, v99
    v_max_u32 v99, 4, v99
    v_and_b32 v97, 0xfffc, v54
    v_bfm_b32 v96, v88, v89
    v_add_u32_dpp v91, v99, v99 row_shr:1 row_mask:0xf bank_mask:0xf bound_ctrl:1
    v_mad_u32_u24 v97, v97, 5, v2
    v_cmp_lt_u32 vcc, 16, v99
    v_add_u32_dpp v91, v91, v91 row_shr:2 row_mask:0xf bank_mask:0xf bound_ctrl:1
    v_sub_u32 v98, s38, v99
    v_lshrrev_b64 v[54:55], 16, v[54:55]
    v_add_u32_dpp v91, v91, v91 row_shr:4 row_mask:0xf bank_mask:0xf bound_ctrl:1
    v_lshrrev_b64 v[62:63], 16, v[62:63]
    s_mov_b32 s101, 0
    v_add_u32_dpp v91, v91, v91 row_shr:8 row_mask:0xf bank_mask:0xf bound_ctrl:1
    s_nop 1
    v_add_u32_dpp v91, v91, v91 row_bcast:15 row_mask:0xa bank_mask:0xf
    s_nop 1
    v_add_u32_dpp v91, v91, v91 row_bcast:31 row_mask:0xc bank_mask:0xf
    v_add_u32 v98, v98, v91
    v_readlane_b32 s37, v91, 63
    s_cbranch_vccnz L2_xo108
L2_xp108:
    v_and_b32 v46, 0x80000000, v27
    v_lshrrev_b32 v47, 14, v25
    v_bitop3_b32 v47, v47, v5, v46 bitop3:0xea
    ds_read_b64 v[102:103], v47
    v_and_b32 v99, 0x40000000, v27
    v_lshrrev_b32 v47, 14, v24
    v_bitop3_b32 v47, v47, v5, v99 bitop3:0xea
    ds_read_b64 v[100:101], v47
    s_waitcnt lgkmcnt(2)
    v_cmp_ne_u64 s[50:51], v[72:73], v[68:69]
    v_cmpx_ne_u64 s[54:55], v[74:75], v[70:71]
    s_and_b64 s[82:83], s[54:55], s[80:81]
    s_cbranch_scc1 L2_c109
L2_d109:
    v_mov_b64 v[84:85], v[70:71]
    v_mov_b32 v7, v93
    v_mov_b64 v[86:87], v[74:75]
    s_or_b64 s[80:81], s[80:81], s[54:55]
    s_mov_b64 exec, s[50:51]
    s_and_b64 s[82:83], s[50:51], s[80:81]
    s_cbranch_scc1 L2_c110
L2_d110:
    v_mov_b64 v[84:85], v[68:69]
    v_mov_b32 v7, v92
    v_mov_b64 v[86:87], v[72:73]
    s_mov_b64 exec, -1
    s_or_b64 s[80:81], s[80:81], s[50:51]
    ds_read_b64 v[70:71], v95 offset:65408
    ds_read_b64 v[68:69], v94 offset:65408
    v_bitop3_b32 v92, v24, v5, v99 bitop3:0xea
    v_bitop3_b32 v93, v25, v5, v46 bitop3:0xea
    v_perm_b32 v15, v25, v26, s47
    v_bitop3_b32 v46, v25, 0.5, -0.5 bitop3:0xa8
    v_perm_b32 v14, v24, v26, s46
    v_bitop3_b32 v47, v24, 0.5, -0.5 bitop3:0xa8
    v_bitop3_b32 v15, v6, v15, v46 bitop3:0xca
    v_bitop3_b32 v14, v6, v14, v47 bitop3:0xca
    s_waitcnt lgkmcnt(1)
    v_mfma_f32_4x4x4_16b_bf16 v[80:83], v[10:11], v[70:71], v[80:83]
    s_waitcnt lgkmcnt(0)
    v_mfma_f32_4x4x4_16b_bf16 v[76:79], v[10:11], v[68:69], v[76:79]
    s_nop 2
    v_cvt_pk_bf16_f32 v80, v80, v81
    v_cvt_pk_bf16_f32 v81, v82, v83
    ds_wrxchg_rtn_b64 v[74:75], v95, v[80:81] offset:65408
    v_cvt_pk_bf16_f32 v76, v76, v77
    v_cvt_pk_bf16_f32 v77, v78, v79
    ds_wrxchg_rtn_b64 v[72:73], v94, v[76:77] offset:65408
    v_and_b32 v88, 0x0fffffff, v41
    v_mov_b32 v27, v41
    buffer_load_dwordx2 v[22:23], v88, s[8:11], 0 offen
    buffer_load_dwordx3 v[24:26], v88, s[8:11], 0 offen offset:8
    v_mfma_f32_4x4x4_16b_bf16 v[80:83], v[8:9], v[102:103], 0
    v_mfma_f32_4x4x4_16b_bf16 v[76:79], v[8:9], v[100:101], 0
    v_cmp_lt_u32 s[84:85], v5, v92
    s_nop 2
    v_pk_mul_f32 v[80:81], v[80:81], v[14:15] op_sel:[0,1] op_sel_hi:[1,1]
    v_pk_mul_f32 v[82:83], v[82:83], v[14:15] op_sel:[0,1] op_sel_hi:[1,1]
    v_pk_mul_f32 v[76:77], v[76:77], v[14:15] op_sel:[0,0] op_sel_hi:[1,0]
    v_pk_mul_f32 v[78:79], v[78:79], v[14:15] op_sel:[0,0] op_sel_hi:[1,0]
    s_waitcnt vmcnt(11)
    s_mov_b64 exec, s[6:7]
    v_lshrrev_b32 v30, 16, v30
    s_mov_b64 exec, -1
    v_and_b32 v46, 0x20000000, v31
    v_lshrrev_b32 v47, 14, v29
    v_bitop3_b32 v47, v47, v5, v46 bitop3:0xea
    ds_read_b64 v[106:107], v47
    v_and_b32 v99, 0x10000000, v31
    v_lshrrev_b32 v47, 14, v28
    v_bitop3_b32 v47, v47, v5, v99 bitop3:0xea
    ds_read_b64 v[104:105], v47
    s_waitcnt lgkmcnt(2)
    v_cmp_ne_u64 s[50:51], v[72:73], v[68:69]
    v_cmpx_ne_u64 s[54:55], v[74:75], v[70:71]
    s_and_b64 s[82:83], s[54:55], s[80:81]
    s_cbranch_scc1 L2_c111
L2_d111:
    v_mov_b64 v[84:85], v[70:71]
    v_mov_b32 v7, v95
    v_mov_b64 v[86:87], v[74:75]
    s_or_b64 s[80:81], s[80:81], s[54:55]
    s_mov_b64 exec, s[50:51]
    s_and_b64 s[82:83], s[50:51], s[80:81]
    s_cbranch_scc1 L2_c112
L2_d112:
    v_mov_b64 v[84:85], v[68:69]
    v_mov_b32 v7, v94
    v_mov_b64 v[86:87], v[72:73]
    s_mov_b64 exec, -1
    s_or_b64 s[80:81], s[80:81], s[50:51]
    s_and_b64 exec, s[84:85], s[80:81]
    v_mfma_f32_4x4x4_16b_bf16 v[76:79], v[12:13], v[84:85], 0
    v_mov_b32 v92, v7
    s_andn2_b64 s[80:81], s[80:81], s[84:85]
    v_mfma_f32_4x4x4_16b_bf16 v[76:79], v[10:11], v[86:87], v[76:79]
    s_mov_b64 exec, -1
    ds_read_b64 v[70:71], v93 offset:65408
    ds_read_b64 v[68:69], v92 offset:65408
    v_bitop3_b32 v94, v28, v5, v99 bitop3:0xea
    v_bitop3_b32 v95, v29, v5, v46 bitop3:0xea
    v_perm_b32 v15, v29, v30, s45
    v_bitop3_b32 v46, v29, 0.5, -0.5 bitop3:0xa8
    v_perm_b32 v14, v28, v30, s44
    v_bitop3_b32 v47, v28, 0.5, -0.5 bitop3:0xa8
    v_bitop3_b32 v15, v6, v15, v46 bitop3:0xca
    v_bitop3_b32 v14, v6, v14, v47 bitop3:0xca
    s_waitcnt lgkmcnt(1)
    v_mfma_f32_4x4x4_16b_bf16 v[80:83], v[10:11], v[70:71], v[80:83]
    s_waitcnt lgkmcnt(0)
    v_mfma_f32_4x4x4_16b_bf16 v[76:79], v[10:11], v[68:69], v[76:79]
    s_nop 2
    v_cvt_pk_bf16_f32 v80, v80, v81
    v_cvt_pk_bf16_f32 v81, v82, v83
    ds_wrxchg_rtn_b64 v[74:75], v93, v[80:81] offset:65408
    v_cvt_pk_bf16_f32 v76, v76, v77
    v_cvt_pk_bf16_f32 v77, v78, v79
    ds_wrxchg_rtn_b64 v[72:73], v92, v[76:77] offset:65408
    s_setprio 0
    v_mfma_f32_4x4x4_16b_bf16 v[80:83], v[8:9], v[106:107], 0
    v_mfma_f32_4x4x4_16b_bf16 v[76:79], v[8:9], v[104:105], 0
    v_cmp_lt_u32 s[48:49], v5, v95
    s_nop 2
    v_pk_mul_f32 v[80:81], v[80:81], v[14:15] op_sel:[0,1] op_sel_hi:[1,1]
    v_pk_mul_f32 v[82:83], v[82:83], v[14:15] op_sel:[0,1] op_sel_hi:[1,1]
    v_pk_mul_f32 v[76:77], v[76:77], v[14:15] op_sel:[0,0] op_sel_hi:[1,0]
    v_pk_mul_f32 v[78:79], v[78:79], v[14:15] op_sel:[0,0] op_sel_hi:[1,0]
    s_add_u32 s40, s40, 0x50000
    v_and_b32 v47, 0x0fffffff, v42
    v_mov_b32 v31, v42
    buffer_load_dword v30, v47, s[8:11], 0 offen offset:16
    s_mov_b64 exec, s[6:7]
    v_add_u32 v47, 8, v47
    v_lshrrev_b32 v31, 2, v31
    s_mov_b64 exec, -1
    buffer_load_dwordx2 v[28:29], v47, s[8:11], 0 offen
    s_waitcnt vmcnt(8)
    v_and_b32 v46, 0x80000000, v39
    v_lshrrev_b32 v47, 14, v37
    v_bitop3_b32 v47, v47, v5, v46 bitop3:0xea
    ds_read_b64 v[106:107], v47
    v_and_b32 v99, 0x40000000, v39
    v_lshrrev_b32 v47, 14, v36
    v_bitop3_b32 v47, v47, v5, v99 bitop3:0xea
    ds_read_b64 v[104:105], v47
    v_and_b32 v46, 0x20000000, v39
    v_lshrrev_b32 v47, 14, v35
    v_bitop3_b32 v47, v47, v5, v46 bitop3:0xea
    ds_read_b64 v[102:103], v47
    v_and_b32 v99, 0x10000000, v39
    v_lshrrev_b32 v47, 14, v34
    v_bitop3_b32 v47, v47, v5, v99 bitop3:0xea
    ds_read_b64 v[100:101], v47
    s_waitcnt lgkmcnt(4)
    v_cmp_ne_u64 s[50:51], v[72:73], v[68:69]
    v_cmpx_ne_u64 s[54:55], v[74:75], v[70:71]
    s_and_b64 s[82:83], s[54:55], s[80:81]
    s_cbranch_scc1 L2_c113
L2_d113:
    v_mov_b64 v[84:85], v[70:71]
    v_mov_b32 v7, v93
    v_mov_b64 v[86:87], v[74:75]
    s_or_b64 s[80:81], s[80:81], s[54:55]
    s_mov_b64 exec, s[50:51]
    s_and_b64 s[82:83], s[50:51], s[80:81]
    s_cbranch_scc1 L2_c114
L2_d114:
    v_mov_b64 v[84:85], v[68:69]
    v_mov_b32 v7, v92
    v_mov_b64 v[86:87], v[72:73]
    s_mov_b64 exec, -1
    s_or_b64 s[80:81], s[80:81], s[50:51]
    s_and_b64 exec, s[48:49], s[80:81]
    v_mfma_f32_4x4x4_16b_bf16 v[80:83], v[12:13], v[84:85], 0
    v_mov_b32 v95, v7
    s_andn2_b64 s[80:81], s[80:81], s[48:49]
    v_mfma_f32_4x4x4_16b_bf16 v[80:83], v[10:11], v[86:87], v[80:83]
    s_mov_b64 exec, -1
    ds_read_b64 v[70:71], v95 offset:65408
    ds_read_b64 v[68:69], v94 offset:65408
    v_bitop3_b32 v92, v34, v5, v99 bitop3:0xea
    v_bitop3_b32 v93, v35, v5, v46 bitop3:0xea
    v_perm_b32 v15, v35, v38, s45
    v_bitop3_b32 v46, v35, 0.5, -0.5 bitop3:0xa8
    v_perm_b32 v14, v34, v38, s44
    v_bitop3_b32 v47, v34, 0.5, -0.5 bitop3:0xa8
    v_bitop3_b32 v15, v6, v15, v46 bitop3:0xca
    v_bitop3_b32 v14, v6, v14, v47 bitop3:0xca
    s_waitcnt lgkmcnt(1)
    v_mfma_f32_4x4x4_16b_bf16 v[80:83], v[10:11], v[70:71], v[80:83]
    s_waitcnt lgkmcnt(0)
    v_mfma_f32_4x4x4_16b_bf16 v[76:79], v[10:11], v[68:69], v[76:79]
    s_nop 2
    v_cvt_pk_bf16_f32 v80, v80, v81
    v_cvt_pk_bf16_f32 v81, v82, v83
    ds_wrxchg_rtn_b64 v[74:75], v95, v[80:81] offset:65408
    v_cvt_pk_bf16_f32 v76, v76, v77
    v_cvt_pk_bf16_f32 v77, v78, v79
    ds_wrxchg_rtn_b64 v[72:73], v94, v[76:77] offset:65408
    s_barrier
    s_setprio 3
    s_mov_b32 m0, s100
    s_nop 0
    ds_write_addtid_b32 v124 offset:34816
    ds_write_addtid_b32 v125 offset:35072
    ds_write_addtid_b32 v126 offset:35328
    ds_write_addtid_b32 v127 offset:35584
    s_add_u32 s3, s40, 4096
    buffer_load_dwordx4 v[124:127], v3, s[16:19], s3 offen
    ds_write_addtid_b32 v116 offset:32768
    ds_write_addtid_b32 v117 offset:33024
    ds_write_addtid_b32 v118 offset:33280
    ds_write_addtid_b32 v119 offset:33536
    buffer_load_dwordx4 v[116:119], v3, s[16:19], s40 offen offset:2048
    ds_write_addtid_b32 v120 offset:33792
    ds_write_addtid_b32 v121 offset:34048
    ds_write_addtid_b32 v122 offset:34304
    ds_write_addtid_b32 v123 offset:34560
    buffer_load_dwordx4 v[120:123], v3, s[16:19], s40 offen offset:3072
    v_mfma_f32_4x4x4_16b_bf16 v[80:83], v[8:9], v[102:103], 0
    v_mfma_f32_4x4x4_16b_bf16 v[76:79], v[8:9], v[100:101], 0
    s_nop 3
    v_pk_mul_f32 v[80:81], v[80:81], v[14:15] op_sel:[0,1] op_sel_hi:[1,1]
    v_pk_mul_f32 v[82:83], v[82:83], v[14:15] op_sel:[0,1] op_sel_hi:[1,1]
    v_pk_mul_f32 v[76:77], v[76:77], v[14:15] op_sel:[0,0] op_sel_hi:[1,0]
    v_pk_mul_f32 v[78:79], v[78:79], v[14:15] op_sel:[0,0] op_sel_hi:[1,0]
    v_mov_b32 v44, v43
    s_cmp_gt_u32 s37, 1024
    s_cbranch_scc1 L2_xs115
    s_cmp_lg_u32 s101, 0
    s_cbranch_scc1 L2_xa115
L2_xb115:
    v_lshlrev_b32 v89, 16, v96
    v_add_u32 v90, 60, v97
    v_bitop3_b32 v90, v89, v45, v90 bitop3:0x6a
    ds_write_b32 v98, v90 offset:12
    v_lshlrev_b32 v89, 20, v96
    v_add_u32 v90, 40, v97
    v_bitop3_b32 v90, v89, v45, v90 bitop3:0x6a
    ds_write_b32 v98, v90 offset:8
    v_lshlrev_b32 v89, 24, v96
    v_add_u32 v90, 20, v97
    v_bitop3_b32 v90, v89, v45, v90 bitop3:0x6a
    ds_write_b32 v98, v90 offset:4
    v_lshlrev_b32 v89, 28, v96
    v_bitop3_b32 v90, v89, v45, v97 bitop3:0x6a
    ds_write_b32 v98, v90 offset:0
    v_mov_b32_dpp v91, v66 quad_perm:[1,1,1,1] row_mask:0xf bank_mask:0xf
    v_and_b32 v89, 3, v91
    v_and_b32 v97, 0xfffc, v91
    v_sub_u16_dpp v88, v66, v91 quad_perm:[3,3,3,3] row_mask:0xf bank_mask:0xf
    v_mad_u32_u24 v97, v97, 5, v4
    v_add_u32 v99, v88, v89
    v_bfm_b32 v96, v88, v89
    v_cmp_lt_u32 s[58:59], 16, v99
    v_lshlrev_b32 v89, v1, v96
    v_and_b32 v89, v45, v89
    v_cmp_ne_u32 vcc, 0, v89
    v_xor_b32 v90, v97, v89
    s_add_u32 s3, s37, s38
    v_mbcnt_lo_u32_b32 v98, vcc_lo, 0
    v_mbcnt_hi_u32_b32 v98, vcc_hi, v98
    s_bcnt1_i32_b64 s41, vcc
    v_lshl_add_u32 v98, v98, 2, s3
    s_lshl2_add_u32 s37, s41, s37
    s_mov_b64 exec, vcc
    ds_write_b32 v98, v90
    s_mov_b64 exec, -1
    s_cmp_lg_u64 s[58:59], 0
    s_cbranch_scc1 L2_xe115
L2_xr115:
    v_add_u32 v98, s37, v0
    v_mov_b32 v90, -1
    ds_write_b32 v98, v90
    v_add_u32 v98, s38, v0
    ds_read2st64_b32 v[40:41], v0 offset0:0 offset1:1
    ds_read_b32 v43, v0 offset:512
    v_lshrrev_b32 v98, 1, v98
    v_and_b32 v98, -4, v98
    ds_read_b32 v42, v98 offset:768
    s_sub_u32 s3, s37, 768
    s_cmp_gt_u32 s3, 128
    s_cbranch_scc1 L2_xf115
L2_xg115:
    v_lshrrev_b64 v[64:65], 16, v[64:65]
    v_lshrrev_b64 v[66:67], 16, v[66:67]
    s_setprio 2
    s_waitcnt lgkmcnt(14)
    v_cmp_ne_u64 s[50:51], v[72:73], v[68:69]
    v_cmpx_ne_u64 s[54:55], v[74:75], v[70:71]
    s_and_b64 s[82:83], s[54:55], s[80:81]
    s_cbranch_scc1 L2_c116
L2_d116:
    v_mov_b64 v[84:85], v[70:71]
    v_mov_b32 v7, v95
    v_mov_b64 v[86:87], v[74:75]
    s_or_b64 s[80:81], s[80:81], s[54:55]
    s_mov_b64 exec, s[50:51]
    s_and_b64 s[82:83], s[50:51], s[80:81]
    s_cbranch_scc1 L2_c117
L2_d117:
    v_mov_b64 v[84:85], v[68:69]
    v_mov_b32 v7, v94
    v_mov_b64 v[86:87], v[72:73]
    s_mov_b64 exec, -1
    s_or_b64 s[80:81], s[80:81], s[50:51]
    ds_read_b64 v[70:71], v93 offset:65408
    ds_read_b64 v[68:69], v92 offset:65408
    v_and_b32 v46, 0x40000000, v39
    v_bitop3_b32 v94, v36, v5, v46 bitop3:0xea
    v_and_b32 v46, 0x80000000, v39
    v_bitop3_b32 v95, v37, v5, v46 bitop3:0xea
    v_perm_b32 v15, v37, v38, s47
    v_bitop3_b32 v46, v37, 0.5, -0.5 bitop3:0xa8
    v_perm_b32 v14, v36, v38, s46
    v_bitop3_b32 v47, v36, 0.5, -0.5 bitop3:0xa8
    v_bitop3_b32 v15, v6, v15, v46 bitop3:0xca
    v_bitop3_b32 v14, v6, v14, v47 bitop3:0xca
    s_setprio 1
    s_waitcnt lgkmcnt(1)
    v_mfma_f32_4x4x4_16b_bf16 v[80:83], v[10:11], v[70:71], v[80:83]
    s_waitcnt lgkmcnt(0)
    v_mfma_f32_4x4x4_16b_bf16 v[76:79], v[10:11], v[68:69], v[76:79]
    s_nop 2
    v_cvt_pk_bf16_f32 v80, v80, v81
    v_cvt_pk_bf16_f32 v81, v82, v83
    ds_wrxchg_rtn_b64 v[74:75], v93, v[80:81] offset:65408
    v_cvt_pk_bf16_f32 v76, v76, v77
    v_cvt_pk_bf16_f32 v77, v78, v79
    ds_wrxchg_rtn_b64 v[72:73], v92, v[76:77] offset:65408
    v_and_b32 v88, 0x0fffffff, v44
    v_mov_b32 v39, v44
    buffer_load_dwordx2 v[34:35], v88, s[8:11], 0 offen
    buffer_load_dwordx3 v[36:38], v88, s[8:11], 0 offen offset:8
    s_setprio 0
    s_waitcnt vmcnt(12)
    s_mov_b32 m0, s38
    s_nop 0
    ds_write_addtid_b32 v108 offset:0
    ds_write_addtid_b32 v109 offset:256
    ds_write_addtid_b32 v110 offset:512
    ds_write_addtid_b32 v111 offset:768
    s_waitcnt vmcnt(9)
    ds_write_addtid_b32 v112 offset:1024
    ds_write_addtid_b32 v113 offset:1280
    ds_write_addtid_b32 v114 offset:1536
    ds_write_addtid_b32 v115 offset:1792
    v_mfma_f32_4x4x4_16b_bf16 v[80:83], v[8:9], v[106:107], 0
    v_mfma_f32_4x4x4_16b_bf16 v[76:79], v[8:9], v[104:105], 0
    v_cmp_lt_u32 s[84:85], v5, v94
    s_nop 2
    v_pk_mul_f32 v[80:81], v[80:81], v[14:15] op_sel:[0,1] op_sel_hi:[1,1]
    v_pk_mul_f32 v[82:83], v[82:83], v[14:15] op_sel:[0,1] op_sel_hi:[1,1]
    v_pk_mul_f32 v[76:77], v[76:77], v[14:15] op_sel:[0,0] op_sel_hi:[1,0]
    v_pk_mul_f32 v[78:79], v[78:79], v[14:15] op_sel:[0,0] op_sel_hi:[1,0]
    s_add_u32 s42, s42, 1
    s_waitcnt lgkmcnt(0)
    s_cmp_lg_u32 s42, 14
    s_cbranch_scc1 L2_loop
    s_barrier
    s_bitcmp1_b32 s36, s42
    s_cbranch_scc1 L2_slow
L2_ret6:
    s_setprio 3
    s_bitcmp1_b32 s43, s42
    s_cbranch_scc1 L2_oa118
L2_ob118:
    v_and_b32 v46, 0x20000000, v21
    v_lshrrev_b32 v47, 14, v17
    v_bitop3_b32 v47, v47, v5, v46 bitop3:0xea
    ds_read_b64 v[102:103], v47
    v_and_b32 v99, 0x10000000, v21
    v_lshrrev_b32 v47, 14, v16
    v_bitop3_b32 v47, v47, v5, v99 bitop3:0xea
    ds_read_b64 v[100:101], v47
    v_cmp_ne_u64 s[50:51], v[72:73], v[68:69]
    v_cmpx_ne_u64 s[54:55], v[74:75], v[70:71]
    s_and_b64 s[82:83], s[54:55], s[80:81]
    s_cbranch_scc1 L2_c119
L2_d119:
    v_mov_b64 v[84:85], v[70:71]
    v_mov_b32 v7, v93
    v_mov_b64 v[86:87], v[74:75]
    s_or_b64 s[80:81], s[80:81], s[54:55]
    s_mov_b64 exec, s[50:51]
    s_and_b64 s[82:83], s[50:51], s[80:81]
    s_cbranch_scc1 L2_c120
L2_d120:
    v_mov_b64 v[84:85], v[68:69]
    v_mov_b32 v7, v92
    v_mov_b64 v[86:87], v[72:73]
    s_mov_b64 exec, -1
    s_or_b64 s[80:81], s[80:81], s[50:51]
    s_and_b64 exec, s[84:85], s[80:81]
    v_mfma_f32_4x4x4_16b_bf16 v[76:79], v[12:13], v[84:85], 0
    v_mov_b32 v94, v7
    s_andn2_b64 s[80:81], s[80:81], s[84:85]
    v_mfma_f32_4x4x4_16b_bf16 v[76:79], v[10:11], v[86:87], v[76:79]
    s_mov_b64 exec, -1
    ds_read_b64 v[70:71], v95 offset:65408
    ds_read_b64 v[68:69], v94 offset:65408
    v_bitop3_b32 v92, v16, v5, v99 bitop3:0xea
    v_bitop3_b32 v93, v17, v5, v46 bitop3:0xea
    v_perm_b32 v15, v17, v20, s45
    v_bitop3_b32 v46, v17, 0.5, -0.5 bitop3:0xa8
    v_perm_b32 v14, v16, v20, s44
    v_bitop3_b32 v47, v16, 0.5, -0.5 bitop3:0xa8
    v_bitop3_b32 v15, v6, v15, v46 bitop3:0xca
    v_bitop3_b32 v14, v6, v14, v47 bitop3:0xca
    s_waitcnt lgkmcnt(1)
    v_mfma_f32_4x4x4_16b_bf16 v[80:83], v[10:11], v[70:71], v[80:83]
    s_waitcnt lgkmcnt(0)
    v_mfma_f32_4x4x4_16b_bf16 v[76:79], v[10:11], v[68:69], v[76:79]
    s_nop 2
    v_cvt_pk_bf16_f32 v80, v80, v81
    v_cvt_pk_bf16_f32 v81, v82, v83
    ds_wrxchg_rtn_b64 v[74:75], v95, v[80:81] offset:65408
    v_cvt_pk_bf16_f32 v76, v76, v77
    v_cvt_pk_bf16_f32 v77, v78, v79
    ds_wrxchg_rtn_b64 v[72:73], v94, v[76:77] offset:65408
    v_mfma_f32_4x4x4_16b_bf16 v[80:83], v[8:9], v[102:103], 0
    v_mfma_f32_4x4x4_16b_bf16 v[76:79], v[8:9], v[100:101], 0
    v_cmp_lt_u32 s[84:85], v5, v92
    s_nop 2
    v_pk_mul_f32 v[80:81], v[80:81], v[14:15] op_sel:[0,1] op_sel_hi:[1,1]
    v_pk_mul_f32 v[82:83], v[82:83], v[14:15] op_sel:[0,1] op_sel_hi:[1,1]
    v_pk_mul_f32 v[76:77], v[76:77], v[14:15] op_sel:[0,0] op_sel_hi:[1,0]
    v_pk_mul_f32 v[78:79], v[78:79], v[14:15] op_sel:[0,0] op_sel_hi:[1,0]
    buffer_load_dwordx4 v[108:111], v3, s[16:19], s40 offen offset:0
    v_and_b32 v46, 0x80000000, v21
    v_lshrrev_b32 v47, 14, v19
    v_bitop3_b32 v47, v47, v5, v46 bitop3:0xea
    ds_read_b64 v[106:107], v47
    v_and_b32 v99, 0x40000000, v21
    v_lshrrev_b32 v47, 14, v18
    v_bitop3_b32 v47, v47, v5, v99 bitop3:0xea
    ds_read_b64 v[104:105], v47
    s_waitcnt lgkmcnt(2)
    v_cmp_ne_u64 s[50:51], v[72:73], v[68:69]
    v_cmpx_ne_u64 s[54:55], v[74:75], v[70:71]
    s_and_b64 s[82:83], s[54:55], s[80:81]
    s_cbranch_scc1 L2_c121
L2_d121:
    v_mov_b64 v[84:85], v[70:71]
    v_mov_b32 v7, v95
    v_mov_b64 v[86:87], v[74:75]
    s_or_b64 s[80:81], s[80:81], s[54:55]
    s_mov_b64 exec, s[50:51]
    s_and_b64 s[82:83], s[50:51], s[80:81]
    s_cbranch_scc1 L2_c122
L2_d122:
    v_mov_b64 v[84:85], v[68:69]
    v_mov_b32 v7, v94
    v_mov_b64 v[86:87], v[72:73]
    s_mov_b64 exec, -1
    s_or_b64 s[80:81], s[80:81], s[50:51]
    s_and_b64 exec, s[84:85], s[80:81]
    v_mfma_f32_4x4x4_16b_bf16 v[76:79], v[12:13], v[84:85], 0
    v_mov_b32 v92, v7
    s_andn2_b64 s[80:81], s[80:81], s[84:85]
    v_mfma_f32_4x4x4_16b_bf16 v[76:79], v[10:11], v[86:87], v[76:79]
    s_mov_b64 exec, -1
    ds_read_b64 v[70:71], v93 offset:65408
    ds_read_b64 v[68:69], v92 offset:65408
    v_bitop3_b32 v94, v18, v5, v99 bitop3:0xea
    v_bitop3_b32 v95, v19, v5, v46 bitop3:0xea
    v_perm_b32 v15, v19, v20, s47
    v_bitop3_b32 v46, v19, 0.5, -0.5 bitop3:0xa8
    v_perm_b32 v14, v18, v20, s46
    v_bitop3_b32 v47, v18, 0.5, -0.5 bitop3:0xa8
    v_bitop3_b32 v15, v6, v15, v46 bitop3:0xca
    v_bitop3_b32 v14, v6, v14, v47 bitop3:0xca
    s_waitcnt lgkmcnt(1)
    v_mfma_f32_4x4x4_16b_bf16 v[80:83], v[10:11], v[70:71], v[80:83]
    s_waitcnt lgkmcnt(0)
    v_mfma_f32_4x4x4_16b_bf16 v[76:79], v[10:11], v[68:69], v[76:79]
    s_nop 2
    v_cvt_pk_bf16_f32 v80, v80, v81
    v_cvt_pk_bf16_f32 v81, v82, v83
    ds_wrxchg_rtn_b64 v[74:75], v93, v[80:81] offset:65408
    v_cvt_pk_bf16_f32 v76, v76, v77
    v_cvt_pk_bf16_f32 v77, v78, v79
    ds_wrxchg_rtn_b64 v[72:73], v92, v[76:77] offset:65408
    v_and_b32 v88, 0x0fffffff, v40
    v_mov_b32 v21, v40
    buffer_load_dwordx2 v[16:17], v88, s[8:11], 0 offen
    buffer_load_dwordx3 v[18:20], v88, s[8:11], 0 offen offset:8
    s_setprio 2
    v_mfma_f32_4x4x4_16b_bf16 v[80:83], v[8:9], v[106:107], 0
    v_mfma_f32_4x4x4_16b_bf16 v[76:79], v[8:9], v[104:105], 0
    v_cmp_lt_u32 s[48:49], v5, v95
    s_nop 2
    v_pk_mul_f32 v[80:81], v[80:81], v[14:15] op_sel:[0,1] op_sel_hi:[1,1]
    v_pk_mul_f32 v[82:83], v[82:83], v[14:15] op_sel:[0,1] op_sel_hi:[1,1]
    v_pk_mul_f32 v[76:77], v[76:77], v[14:15] op_sel:[0,0] op_sel_hi:[1,0]
    v_pk_mul_f32 v[78:79], v[78:79], v[14:15] op_sel:[0,0] op_sel_hi:[1,0]
    s_waitcnt vmcnt(10)
    v_and_b32 v46, 0x20000000, v27
    v_lshrrev_b32 v47, 14, v23
    v_bitop3_b32 v47, v47, v5, v46 bitop3:0xea
    ds_read_b64 v[102:103], v47
    v_and_b32 v99, 0x10000000, v27
    v_lshrrev_b32 v47, 14, v22
    v_bitop3_b32 v47, v47, v5, v99 bitop3:0xea
    ds_read_b64 v[100:101], v47
    s_waitcnt lgkmcnt(2)
    v_cmp_ne_u64 s[50:51], v[72:73], v[68:69]
    v_cmpx_ne_u64 s[54:55], v[74:75], v[70:71]
    s_and_b64 s[82:83], s[54:55], s[80:81]
    s_cbranch_scc1 L2_c123
L2_d123:
    v_mov_b64 v[84:85], v[70:71]
    v_mov_b32 v7, v93
    v_mov_b64 v[86:87], v[74:75]
    s_or_b64 s[80:81], s[80:81], s[54:55]
    s_mov_b64 exec, s[50:51]
    s_and_b64 s[82:83], s[50:51], s[80:81]
    s_cbranch_scc1 L2_c124
L2_d124:
    v_mov_b64 v[84:85], v[68:69]
    v_mov_b32 v7, v92
    v_mov_b64 v[86:87], v[72:73]
    s_mov_b64 exec, -1
    s_or_b64 s[80:81], s[80:81], s[50:51]
    s_and_b64 exec, s[48:49], s[80:81]
    v_mfma_f32_4x4x4_16b_bf16 v[80:83], v[12:13], v[84:85], 0
    v_mov_b32 v95, v7
    s_andn2_b64 s[80:81], s[80:81], s[48:49]
    v_mfma_f32_4x4x4_16b_bf16 v[80:83], v[10:11], v[86:87], v[80:83]
    s_mov_b64 exec, -1
    ds_read_b64 v[70:71], v95 offset:65408
    ds_read_b64 v[68:69], v94 offset:65408
    v_bitop3_b32 v92, v22, v5, v99 bitop3:0xea
    v_bitop3_b32 v93, v23, v5, v46 bitop3:0xea
    v_perm_b32 v15, v23, v26, s45
    v_bitop3_b32 v46, v23, 0.5, -0.5 bitop3:0xa8
    v_perm_b32 v14, v22, v26, s44
    v_bitop3_b32 v47, v22, 0.5, -0.5 bitop3:0xa8
    v_bitop3_b32 v15, v6, v15, v46 bitop3:0xca
    v_bitop3_b32 v14, v6, v14, v47 bitop3:0xca
    s_waitcnt lgkmcnt(1)
    v_mfma_f32_4x4x4_16b_bf16 v[80:83], v[10:11], v[70:71], v[80:83]
    s_waitcnt lgkmcnt(0)
    v_mfma_f32_4x4x4_16b_bf16 v[76:79], v[10:11], v[68:69], v[76:79]
    s_nop 2
    v_cvt_pk_bf16_f32 v80, v80, v81
    v_cvt_pk_bf16_f32 v81, v82, v83
    ds_wrxchg_rtn_b64 v[74:75], v95, v[80:81] offset:65408
    v_cvt_pk_bf16_f32 v76, v76, v77
    v_cvt_pk_bf16_f32 v77, v78, v79
    ds_wrxchg_rtn_b64 v[72:73], v94, v[76:77] offset:65408
    s_setprio 1
    v_mfma_f32_4x4x4_16b_bf16 v[80:83], v[8:9], v[102:103], 0
    v_mfma_f32_4x4x4_16b_bf16 v[76:79], v[8:9], v[100:101], 0
    s_nop 3
    v_pk_mul_f32 v[80:81], v[80:81], v[14:15] op_sel:[0,1] op_sel_hi:[1,1]
    v_pk_mul_f32 v[82:83], v[82:83], v[14:15] op_sel:[0,1] op_sel_hi:[1,1]
    v_pk_mul_f32 v[76:77], v[76:77], v[14:15] op_sel:[0,0] op_sel_hi:[1,0]
    v_pk_mul_f32 v[78:79], v[78:79], v[14:15] op_sel:[0,0] op_sel_hi:[1,0]
    s_bitcmp1_b32 s43, s42
    s_cbranch_scc1 L2_oa125
L2_ob125:
    buffer_load_dwordx4 v[112:115], v3, s[16:19], s40 offen offset:1024
    v_and_b32 v46, 0x80000000, v27
    v_lshrrev_b32 v47, 14, v25
    v_bitop3_b32 v47, v47, v5, v46 bitop3:0xea
    ds_read_b64 v[106:107], v47
    v_and_b32 v99, 0x40000000, v27
    v_lshrrev_b32 v47, 14, v24
    v_bitop3_b32 v47, v47, v5, v99 bitop3:0xea
    ds_read_b64 v[104:105], v47
    s_waitcnt lgkmcnt(2)
    v_cmp_ne_u64 s[50:51], v[72:73], v[68:69]
    v_cmpx_ne_u64 s[54:55], v[74:75], v[70:71]
    s_and_b64 s[82:83], s[54:55], s[80:81]
    s_cbranch_scc1 L2_c126
L2_d126:
    v_mov_b64 v[84:85], v[70:71]
    v_mov_b32 v7, v95
    v_mov_b64 v[86:87], v[74:75]
    s_or_b64 s[80:81], s[80:81], s[54:55]
    s_mov_b64 exec, s[50:51]
    s_and_b64 s[82:83], s[50:51], s[80:81]
    s_cbranch_scc1 L2_c127
L2_d127:
    v_mov_b64 v[84:85], v[68:69]
    v_mov_b32 v7, v94
    v_mov_b64 v[86:87], v[72:73]
    s_mov_b64 exec, -1
    s_or_b64 s[80:81], s[80:81], s[50:51]
    ds_read_b64 v[70:71], v93 offset:65408
    ds_read_b64 v[68:69], v92 offset:65408
    v_bitop3_b32 v94, v24, v5, v99 bitop3:0xea
    v_bitop3_b32 v95, v25, v5, v46 bitop3:0xea
    v_perm_b32 v15, v25, v26, s47
    v_bitop3_b32 v46, v25, 0.5, -0.5 bitop3:0xa8
    v_perm_b32 v14, v24, v26, s46
    v_bitop3_b32 v47, v24, 0.5, -0.5 bitop3:0xa8
    v_bitop3_b32 v15, v6, v15, v46 bitop3:0xca
    v_bitop3_b32 v14, v6, v14, v47 bitop3:0xca
    s_waitcnt lgkmcnt(1)
    v_mfma_f32_4x4x4_16b_bf16 v[80:83], v[10:11], v[70:71], v[80:83]
    s_waitcnt lgkmcnt(0)
    v_mfma_f32_4x4x4_16b_bf16 v[76:79], v[10:11], v[68:69], v[76:79]
    s_nop 2
    v_cvt_pk_bf16_f32 v80, v80, v81
    v_cvt_pk_bf16_f32 v81, v82, v83
    ds_wrxchg_rtn_b64 v[74:75], v93, v[80:81] offset:65408
    v_cvt_pk_bf16_f32 v76, v76, v77
    v_cvt_pk_bf16_f32 v77, v78, v79
    ds_wrxchg_rtn_b64 v[72:73], v92, v[76:77] offset:65408
    v_and_b32 v88, 0x0fffffff, v41
    v_mov_b32 v27, v41
    buffer_load_dwordx2 v[22:23], v88, s[8:11], 0 offen
    buffer_load_dwordx3 v[24:26], v88, s[8:11], 0 offen offset:8
    v_mfma_f32_4x4x4_16b_bf16 v[80:83], v[8:9], v[106:107], 0
    v_mfma_f32_4x4x4_16b_bf16 v[76:79], v[8:9], v[104:105], 0
    v_cmp_lt_u32 s[84:85], v5, v94
    s_nop 2
    v_pk_mul_f32 v[80:81], v[80:81], v[14:15] op_sel:[0,1] op_sel_hi:[1,1]
    v_pk_mul_f32 v[82:83], v[82:83], v[14:15] op_sel:[0,1] op_sel_hi:[1,1]
    v_pk_mul_f32 v[76:77], v[76:77], v[14:15] op_sel:[0,0] op_sel_hi:[1,0]
    v_pk_mul_f32 v[78:79], v[78:79], v[14:15] op_sel:[0,0] op_sel_hi:[1,0]
    s_waitcnt vmcnt(11)
    s_mov_b64 exec, s[6:7]
    v_lshrrev_b32 v30, 16, v30
    s_mov_b64 exec, -1
    v_and_b32 v46, 0x20000000, v31
    v_lshrrev_b32 v47, 14, v29
    v_bitop3_b32 v47, v47, v5, v46 bitop3:0xea
    ds_read_b64 v[102:103], v47
    v_and_b32 v99, 0x10000000, v31
    v_lshrrev_b32 v47, 14, v28
    v_bitop3_b32 v47, v47, v5, v99 bitop3:0xea
    ds_read_b64 v[100:101], v47
    s_waitcnt lgkmcnt(2)
    v_cmp_ne_u64 s[50:51], v[72:73], v[68:69]
    v_cmpx_ne_u64 s[54:55], v[74:75], v[70:71]
    s_and_b64 s[82:83], s[54:55], s[80:81]
    s_cbranch_scc1 L2_c128
L2_d128:
    v_mov_b64 v[84:85], v[70:71]
    v_mov_b32 v7, v93
    v_mov_b64 v[86:87], v[74:75]
    s_or_b64 s[80:81], s[80:81], s[54:55]
    s_mov_b64 exec, s[50:51]
    s_and_b64 s[82:83], s[50:51], s[80:81]
    s_cbranch_scc1 L2_c129
L2_d129:
    v_mov_b64 v[84:85], v[68:69]
    v_mov_b32 v7, v92
    v_mov_b64 v[86:87], v[72:73]
    s_mov_b64 exec, -1
    s_or_b64 s[80:81], s[80:81], s[50:51]
    s_and_b64 exec, s[84:85], s[80:81]
    v_mfma_f32_4x4x4_16b_bf16 v[76:79], v[12:13], v[84:85], 0
    v_mov_b32 v94, v7
    s_andn2_b64 s[80:81], s[80:81], s[84:85]
    v_mfma_f32_4x4x4_16b_bf16 v[76:79], v[10:11], v[86:87], v[76:79]
    s_mov_b64 exec, -1
    ds_read_b64 v[70:71], v95 offset:65408
    ds_read_b64 v[68:69], v94 offset:65408
    v_bitop3_b32 v92, v28, v5, v99 bitop3:0xea
    v_bitop3_b32 v93, v29, v5, v46 bitop3:0xea
    v_perm_b32 v15, v29, v30, s45
    v_bitop3_b32 v46, v29, 0.5, -0.5 bitop3:0xa8
    v_perm_b32 v14, v28, v30, s44
    v_bitop3_b32 v47, v28, 0.5, -0.5 bitop3:0xa8
    v_bitop3_b32 v15, v6, v15, v46 bitop3:0xca
    v_bitop3_b32 v14, v6, v14, v47 bitop3:0xca
    s_waitcnt lgkmcnt(1)
    v_mfma_f32_4x4x4_16b_bf16 v[80:83], v[10:11], v[70:71], v[80:83]
    s_waitcnt lgkmcnt(0)
    v_mfma_f32_4x4x4_16b_bf16 v[76:79], v[10:11], v[68:69], v[76:79]
    s_nop 2
    v_cvt_pk_bf16_f32 v80, v80, v81
    v_cvt_pk_bf16_f32 v81, v82, v83
    ds_wrxchg_rtn_b64 v[74:75], v95, v[80:81] offset:65408
    v_cvt_pk_bf16_f32 v76, v76, v77
    v_cvt_pk_bf16_f32 v77, v78, v79
    ds_wrxchg_rtn_b64 v[72:73], v94, v[76:77] offset:65408
    s_setprio 0
    v_mfma_f32_4x4x4_16b_bf16 v[80:83], v[8:9], v[102:103], 0
    v_mfma_f32_4x4x4_16b_bf16 v[76:79], v[8:9], v[100:101], 0
    v_cmp_lt_u32 s[48:49], v5, v93
    s_nop 2
    v_pk_mul_f32 v[80:81], v[80:81], v[14:15] op_sel:[0,1] op_sel_hi:[1,1]
    v_pk_mul_f32 v[82:83], v[82:83], v[14:15] op_sel:[0,1] op_sel_hi:[1,1]
    v_pk_mul_f32 v[76:77], v[76:77], v[14:15] op_sel:[0,0] op_sel_hi:[1,0]
    v_pk_mul_f32 v[78:79], v[78:79], v[14:15] op_sel:[0,0] op_sel_hi:[1,0]
    s_add_u32 s40, s40, 0xfff24000
    v_and_b32 v47, 0x0fffffff, v42
    v_mov_b32 v31, v42
    buffer_load_dword v30, v47, s[8:11], 0 offen offset:16
    s_mov_b64 exec, s[6:7]
    v_add_u32 v47, 8, v47
    v_lshrrev_b32 v31, 2, v31
    s_mov_b64 exec, -1
    buffer_load_dwordx2 v[28:29], v47, s[8:11], 0 offen
    s_waitcnt vmcnt(8)
    v_and_b32 v46, 0x80000000, v39
    v_lshrrev_b32 v47, 14, v37
    v_bitop3_b32 v47, v47, v5, v46 bitop3:0xea
    ds_read_b64 v[102:103], v47
    v_and_b32 v99, 0x40000000, v39
    v_lshrrev_b32 v47, 14, v36
    v_bitop3_b32 v47, v47, v5, v99 bitop3:0xea
    ds_read_b64 v[100:101], v47
    v_and_b32 v46, 0x20000000, v39
    v_lshrrev_b32 v47, 14, v35
    v_bitop3_b32 v47, v47, v5, v46 bitop3:0xea
    ds_read_b64 v[106:107], v47
    v_and_b32 v99, 0x10000000, v39
    v_lshrrev_b32 v47, 14, v34
    v_bitop3_b32 v47, v47, v5, v99 bitop3:0xea
    ds_read_b64 v[104:105], v47
    s_waitcnt lgkmcnt(4)
    v_cmp_ne_u64 s[50:51], v[72:73], v[68:69]
    v_cmpx_ne_u64 s[54:55], v[74:75], v[70:71]
    s_and_b64 s[82:83], s[54:55], s[80:81]
    s_cbranch_scc1 L2_c130
L2_d130:
    v_mov_b64 v[84:85], v[70:71]
    v_mov_b32 v7, v95
    v_mov_b64 v[86:87], v[74:75]
    s_or_b64 s[80:81], s[80:81], s[54:55]
    s_mov_b64 exec, s[50:51]
    s_and_b64 s[82:83], s[50:51], s[80:81]
    s_cbranch_scc1 L2_c131
L2_d131:
    v_mov_b64 v[84:85], v[68:69]
    v_mov_b32 v7, v94
    v_mov_b64 v[86:87], v[72:73]
    s_mov_b64 exec, -1
    s_or_b64 s[80:81], s[80:81], s[50:51]
    s_and_b64 exec, s[48:49], s[80:81]
    v_mfma_f32_4x4x4_16b_bf16 v[80:83], v[12:13], v[84:85], 0
    v_mov_b32 v93, v7
    s_andn2_b64 s[80:81], s[80:81], s[48:49]
    v_mfma_f32_4x4x4_16b_bf16 v[80:83], v[10:11], v[86:87], v[80:83]
    s_mov_b64 exec, -1
    ds_read_b64 v[70:71], v93 offset:65408
    ds_read_b64 v[68:69], v92 offset:65408
    v_bitop3_b32 v94, v34, v5, v99 bitop3:0xea
    v_bitop3_b32 v95, v35, v5, v46 bitop3:0xea
    v_perm_b32 v15, v35, v38, s45
    v_bitop3_b32 v46, v35, 0.5, -0.5 bitop3:0xa8
    v_perm_b32 v14, v34, v38, s44
    v_bitop3_b32 v47, v34, 0.5, -0.5 bitop3:0xa8
    v_bitop3_b32 v15, v6, v15, v46 bitop3:0xca
    v_bitop3_b32 v14, v6, v14, v47 bitop3:0xca
    s_waitcnt lgkmcnt(1)
    v_mfma_f32_4x4x4_16b_bf16 v[80:83], v[10:11], v[70:71], v[80:83]
    s_waitcnt lgkmcnt(0)
    v_mfma_f32_4x4x4_16b_bf16 v[76:79], v[10:11], v[68:69], v[76:79]
    s_nop 2
    v_cvt_pk_bf16_f32 v80, v80, v81
    v_cvt_pk_bf16_f32 v81, v82, v83
    ds_wrxchg_rtn_b64 v[74:75], v93, v[80:81] offset:65408
    v_cvt_pk_bf16_f32 v76, v76, v77
    v_cvt_pk_bf16_f32 v77, v78, v79
    ds_wrxchg_rtn_b64 v[72:73], v92, v[76:77] offset:65408
    s_barrier
    s_setprio 3
    s_mov_b32 m0, s100
    s_nop 0
    ds_write_addtid_b32 v124 offset:34816
    ds_write_addtid_b32 v125 offset:35072
    ds_write_addtid_b32 v126 offset:35328
    ds_write_addtid_b32 v127 offset:35584
    ds_write_addtid_b32 v116 offset:32768
    ds_write_addtid_b32 v117 offset:33024
    ds_write_addtid_b32 v118 offset:33280
    ds_write_addtid_b32 v119 offset:33536
    ds_write_addtid_b32 v120 offset:33792
    ds_write_addtid_b32 v121 offset:34048
    ds_write_addtid_b32 v122 offset:34304
    ds_write_addtid_b32 v123 offset:34560
    v_mfma_f32_4x4x4_16b_bf16 v[80:83], v[8:9], v[106:107], 0
    v_mfma_f32_4x4x4_16b_bf16 v[76:79], v[8:9], v[104:105], 0
    s_nop 3
    v_pk_mul_f32 v[80:81], v[80:81], v[14:15] op_sel:[0,1] op_sel_hi:[1,1]
    v_pk_mul_f32 v[82:83], v[82:83], v[14:15] op_sel:[0,1] op_sel_hi:[1,1]
    v_pk_mul_f32 v[76:77], v[76:77], v[14:15] op_sel:[0,0] op_sel_hi:[1,0]
    v_pk_mul_f32 v[78:79], v[78:79], v[14:15] op_sel:[0,0] op_sel_hi:[1,0]
    v_mov_b32 v44, v43
    s_setprio 2
    s_waitcnt lgkmcnt(12)
    v_cmp_ne_u64 s[50:51], v[72:73], v[68:69]
    v_cmpx_ne_u64 s[54:55], v[74:75], v[70:71]
    s_and_b64 s[82:83], s[54:55], s[80:81]
    s_cbranch_scc1 L2_c132
L2_d132:
    v_mov_b64 v[84:85], v[70:71]
    v_mov_b32 v7, v93
    v_mov_b64 v[86:87], v[74:75]
    s_or_b64 s[80:81], s[80:81], s[54:55]
    s_mov_b64 exec, s[50:51]
    s_and_b64 s[82:83], s[50:51], s[80:81]
    s_cbranch_scc1 L2_c133
L2_d133:
    v_mov_b64 v[84:85], v[68:69]
    v_mov_b32 v7, v92
    v_mov_b64 v[86:87], v[72:73]
    s_mov_b64 exec, -1
    s_or_b64 s[80:81], s[80:81], s[50:51]
    ds_read_b64 v[70:71], v95 offset:65408
    ds_read_b64 v[68:69], v94 offset:65408
    v_and_b32 v46, 0x40000000, v39
    v_bitop3_b32 v92, v36, v5, v46 bitop3:0xea
    v_and_b32 v46, 0x80000000, v39
    v_bitop3_b32 v93, v37, v5, v46 bitop3:0xea
    v_perm_b32 v15, v37, v38, s47
    v_bitop3_b32 v46, v37, 0.5, -0.5 bitop3:0xa8
    v_perm_b32 v14, v36, v38, s46
    v_bitop3_b32 v47, v36, 0.5, -0.5 bitop3:0xa8
    v_bitop3_b32 v15, v6, v15, v46 bitop3:0xca
    v_bitop3_b32 v14, v6, v14, v47 bitop3:0xca
    s_setprio 1
    s_waitcnt lgkmcnt(1)
    v_mfma_f32_4x4x4_16b_bf16 v[80:83], v[10:11], v[70:71], v[80:83]
    s_waitcnt lgkmcnt(0)
    v_mfma_f32_4x4x4_16b_bf16 v[76:79], v[10:11], v[68:69], v[76:79]
    s_nop 2
    v_cvt_pk_bf16_f32 v80, v80, v81
    v_cvt_pk_bf16_f32 v81, v82, v83
    ds_wrxchg_rtn_b64 v[74:75], v95, v[80:81] offset:65408
    v_cvt_pk_bf16_f32 v76, v76, v77
    v_cvt_pk_bf16_f32 v77, v78, v79
    ds_wrxchg_rtn_b64 v[72:73], v94, v[76:77] offset:65408
    v_and_b32 v88, 0x0fffffff, v44
    v_mov_b32 v39, v44
    buffer_load_dwordx2 v[34:35], v88, s[8:11], 0 offen
    buffer_load_dwordx3 v[36:38], v88, s[8:11], 0 offen offset:8
    s_setprio 0
    s_waitcnt vmcnt(9)
    s_mov_b32 m0, s38
    s_nop 0
    ds_write_addtid_b32 v108 offset:0
    ds_write_addtid_b32 v109 offset:256
    ds_write_addtid_b32 v110 offset:512
    ds_write_addtid_b32 v111 offset:768
    s_waitcnt vmcnt(6)
    ds_write_addtid_b32 v112 offset:1024
    ds_write_addtid_b32 v113 offset:1280
    ds_write_addtid_b32 v114 offset:1536
    ds_write_addtid_b32 v115 offset:1792
    v_mfma_f32_4x4x4_16b_bf16 v[80:83], v[8:9], v[102:103], 0
    v_mfma_f32_4x4x4_16b_bf16 v[76:79], v[8:9], v[100:101], 0
    v_cmp_lt_u32 s[84:85], v5, v92
    s_nop 2
    v_pk_mul_f32 v[80:81], v[80:81], v[14:15] op_sel:[0,1] op_sel_hi:[1,1]
    v_pk_mul_f32 v[82:83], v[82:83], v[14:15] op_sel:[0,1] op_sel_hi:[1,1]
    v_pk_mul_f32 v[76:77], v[76:77], v[14:15] op_sel:[0,0] op_sel_hi:[1,0]
    v_pk_mul_f32 v[78:79], v[78:79], v[14:15] op_sel:[0,0] op_sel_hi:[1,0]
    s_add_u32 s42, s42, 1
    s_waitcnt lgkmcnt(0)
    s_barrier
    s_bitcmp1_b32 s36, s42
    s_cbranch_scc1 L2_slow
L2_ret7:
    s_setprio 3
    s_bitcmp1_b32 s43, s42
    s_cbranch_scc1 L2_oa134
L2_ob134:
    v_and_b32 v46, 0x20000000, v21
    v_lshrrev_b32 v47, 14, v17
    v_bitop3_b32 v47, v47, v5, v46 bitop3:0xea
    ds_read_b64 v[106:107], v47
    v_and_b32 v99, 0x10000000, v21
    v_lshrrev_b32 v47, 14, v16
    v_bitop3_b32 v47, v47, v5, v99 bitop3:0xea
    ds_read_b64 v[104:105], v47
    v_cmp_ne_u64 s[50:51], v[72:73], v[68:69]
    v_cmpx_ne_u64 s[54:55], v[74:75], v[70:71]
    s_and_b64 s[82:83], s[54:55], s[80:81]
    s_cbranch_scc1 L2_c135
L2_d135:
    v_mov_b64 v[84:85], v[70:71]
    v_mov_b32 v7, v95
    v_mov_b64 v[86:87], v[74:75]
    s_or_b64 s[80:81], s[80:81], s[54:55]
    s_mov_b64 exec, s[50:51]
    s_and_b64 s[82:83], s[50:51], s[80:81]
    s_cbranch_scc1 L2_c136
L2_d136:
    v_mov_b64 v[84:85], v[68:69]
    v_mov_b32 v7, v94
    v_mov_b64 v[86:87], v[72:73]
    s_mov_b64 exec, -1
    s_or_b64 s[80:81], s[80:81], s[50:51]
    s_and_b64 exec, s[84:85], s[80:81]
    v_mfma_f32_4x4x4_16b_bf16 v[76:79], v[12:13], v[84:85], 0
    v_mov_b32 v92, v7
    s_andn2_b64 s[80:81], s[80:81], s[84:85]
    v_mfma_f32_4x4x4_16b_bf16 v[76:79], v[10:11], v[86:87], v[76:79]
    s_mov_b64 exec, -1
    ds_read_b64 v[70:71], v93 offset:65408
    ds_read_b64 v[68:69], v92 offset:65408
    v_bitop3_b32 v94, v16, v5, v99 bitop3:0xea
    v_bitop3_b32 v95, v17, v5, v46 bitop3:0xea
    v_perm_b32 v15, v17, v20, s45
    v_bitop3_b32 v46, v17, 0.5, -0.5 bitop3:0xa8
    v_perm_b32 v14, v16, v20, s44
    v_bitop3_b32 v47, v16, 0.5, -0.5 bitop3:0xa8
    v_bitop3_b32 v15, v6, v15, v46 bitop3:0xca
    v_bitop3_b32 v14, v6, v14, v47 bitop3:0xca
    s_waitcnt lgkmcnt(1)
    v_mfma_f32_4x4x4_16b_bf16 v[80:83], v[10:11], v[70:71], v[80:83]
    s_waitcnt lgkmcnt(0)
    v_mfma_f32_4x4x4_16b_bf16 v[76:79], v[10:11], v[68:69], v[76:79]
    s_nop 2
    v_cvt_pk_bf16_f32 v80, v80, v81
    v_cvt_pk_bf16_f32 v81, v82, v83
    ds_wrxchg_rtn_b64 v[74:75], v93, v[80:81] offset:65408
    v_cvt_pk_bf16_f32 v76, v76, v77
    v_cvt_pk_bf16_f32 v77, v78, v79
    ds_wrxchg_rtn_b64 v[72:73], v92, v[76:77] offset:65408
    v_mfma_f32_4x4x4_16b_bf16 v[80:83], v[8:9], v[106:107], 0
    v_mfma_f32_4x4x4_16b_bf16 v[76:79], v[8:9], v[104:105], 0
    v_cmp_lt_u32 s[84:85], v5, v94
    s_nop 2
    v_pk_mul_f32 v[80:81], v[80:81], v[14:15] op_sel:[0,1] op_sel_hi:[1,1]
    v_pk_mul_f32 v[82:83], v[82:83], v[14:15] op_sel:[0,1] op_sel_hi:[1,1]
    v_pk_mul_f32 v[76:77], v[76:77], v[14:15] op_sel:[0,0] op_sel_hi:[1,0]
    v_pk_mul_f32 v[78:79], v[78:79], v[14:15] op_sel:[0,0] op_sel_hi:[1,0]
    v_and_b32 v46, 0x80000000, v21
    v_lshrrev_b32 v47, 14, v19
    v_bitop3_b32 v47, v47, v5, v46 bitop3:0xea
    ds_read_b64 v[102:103], v47
    v_and_b32 v99, 0x40000000, v21
    v_lshrrev_b32 v47, 14, v18
    v_bitop3_b32 v47, v47, v5, v99 bitop3:0xea
    ds_read_b64 v[100:101], v47
    s_waitcnt lgkmcnt(2)
    v_cmp_ne_u64 s[50:51], v[72:73], v[68:69]
    v_cmpx_ne_u64 s[54:55], v[74:75], v[70:71]
    s_and_b64 s[82:83], s[54:55], s[80:81]
    s_cbranch_scc1 L2_c137
L2_d137:
    v_mov_b64 v[84:85], v[70:71]
    v_mov_b32 v7, v93
    v_mov_b64 v[86:87], v[74:75]
    s_or_b64 s[80:81], s[80:81], s[54:55]
    s_mov_b64 exec, s[50:51]
    s_and_b64 s[82:83], s[50:51], s[80:81]
    s_cbranch_scc1 L2_c138
L2_d138:
    v_mov_b64 v[84:85], v[68:69]
    v_mov_b32 v7, v92
    v_mov_b64 v[86:87], v[72:73]
    s_mov_b64 exec, -1
    s_or_b64 s[80:81], s[80:81], s[50:51]
    s_and_b64 exec, s[84:85], s[80:81]
    v_mfma_f32_4x4x4_16b_bf16 v[76:79], v[12:13], v[84:85], 0
    v_mov_b32 v94, v7
    s_andn2_b64 s[80:81], s[80:81], s[84:85]
    v_mfma_f32_4x4x4_16b_bf16 v[76:79], v[10:11], v[86:87], v[76:79]
    s_mov_b64 exec, -1
    ds_read_b64 v[70:71], v95 offset:65408
    ds_read_b64 v[68:69], v94 offset:65408
    v_bitop3_b32 v92, v18, v5, v99 bitop3:0xea
    v_bitop3_b32 v93, v19, v5, v46 bitop3:0xea
    v_perm_b32 v15, v19, v20, s47
    v_bitop3_b32 v46, v19, 0.5, -0.5 bitop3:0xa8
    v_perm_b32 v14, v18, v20, s46
    v_bitop3_b32 v47, v18, 0.5, -0.5 bitop3:0xa8
    v_bitop3_b32 v15, v6, v15, v46 bitop3:0xca
    v_bitop3_b32 v14, v6, v14, v47 bitop3:0xca
    s_waitcnt lgkmcnt(1)
    v_mfma_f32_4x4x4_16b_bf16 v[80:83], v[10:11], v[70:71], v[80:83]
    s_waitcnt lgkmcnt(0)
    v_mfma_f32_4x4x4_16b_bf16 v[76:79], v[10:11], v[68:69], v[76:79]
    s_nop 2
    v_cvt_pk_bf16_f32 v80, v80, v81
    v_cvt_pk_bf16_f32 v81, v82, v83
    ds_wrxchg_rtn_b64 v[74:75], v95, v[80:81] offset:65408
    v_cvt_pk_bf16_f32 v76, v76, v77
    v_cvt_pk_bf16_f32 v77, v78, v79
    ds_wrxchg_rtn_b64 v[72:73], v94, v[76:77] offset:65408
    s_setprio 2
    v_mfma_f32_4x4x4_16b_bf16 v[80:83], v[8:9], v[102:103], 0
    v_mfma_f32_4x4x4_16b_bf16 v[76:79], v[8:9], v[100:101], 0
    v_cmp_lt_u32 s[48:49], v5, v93
    s_nop 2
    v_pk_mul_f32 v[80:81], v[80:81], v[14:15] op_sel:[0,1] op_sel_hi:[1,1]
    v_pk_mul_f32 v[82:83], v[82:83], v[14:15] op_sel:[0,1] op_sel_hi:[1,1]
    v_pk_mul_f32 v[76:77], v[76:77], v[14:15] op_sel:[0,0] op_sel_hi:[1,0]
    v_pk_mul_f32 v[78:79], v[78:79], v[14:15] op_sel:[0,0] op_sel_hi:[1,0]
    s_waitcnt vmcnt(4)
    v_and_b32 v46, 0x20000000, v27
    v_lshrrev_b32 v47, 14, v23
    v_bitop3_b32 v47, v47, v5, v46 bitop3:0xea
    ds_read_b64 v[106:107], v47
    v_and_b32 v99, 0x10000000, v27
    v_lshrrev_b32 v47, 14, v22
    v_bitop3_b32 v47, v47, v5, v99 bitop3:0xea
    ds_read_b64 v[104:105], v47
    s_waitcnt lgkmcnt(2)
    v_cmp_ne_u64 s[50:51], v[72:73], v[68:69]
    v_cmpx_ne_u64 s[54:55], v[74:75], v[70:71]
    s_and_b64 s[82:83], s[54:55], s[80:81]
    s_cbranch_scc1 L2_c139
L2_d139:
    v_mov_b64 v[84:85], v[70:71]
    v_mov_b32 v7, v95
    v_mov_b64 v[86:87], v[74:75]
    s_or_b64 s[80:81], s[80:81], s[54:55]
    s_mov_b64 exec, s[50:51]
    s_and_b64 s[82:83], s[50:51], s[80:81]
    s_cbranch_scc1 L2_c140
L2_d140:
    v_mov_b64 v[84:85], v[68:69]
    v_mov_b32 v7, v94
    v_mov_b64 v[86:87], v[72:73]
    s_mov_b64 exec, -1
    s_or_b64 s[80:81], s[80:81], s[50:51]
    s_and_b64 exec, s[48:49], s[80:81]
    v_mfma_f32_4x4x4_16b_bf16 v[80:83], v[12:13], v[84:85], 0
    v_mov_b32 v93, v7
    s_andn2_b64 s[80:81], s[80:81], s[48:49]
    v_mfma_f32_4x4x4_16b_bf16 v[80:83], v[10:11], v[86:87], v[80:83]
    s_mov_b64 exec, -1
    ds_read_b64 v[70:71], v93 offset:65408
    ds_read_b64 v[68:69], v92 offset:65408
    v_bitop3_b32 v94, v22, v5, v99 bitop3:0xea
    v_bitop3_b32 v95, v23, v5, v46 bitop3:0xea
    v_perm_b32 v15, v23, v26, s45
    v_bitop3_b32 v46, v23, 0.5, -0.5 bitop3:0xa8
    v_perm_b32 v14, v22, v26, s44
    v_bitop3_b32 v47, v22, 0.5, -0.5 bitop3:0xa8
    v_bitop3_b32 v15, v6, v15, v46 bitop3:0xca
    v_bitop3_b32 v14, v6, v14, v47 bitop3:0xca
    s_waitcnt lgkmcnt(1)
    v_mfma_f32_4x4x4_16b_bf16 v[80:83], v[10:11], v[70:71], v[80:83]
    s_waitcnt lgkmcnt(0)
    v_mfma_f32_4x4x4_16b_bf16 v[76:79], v[10:11], v[68:69], v[76:79]
    s_nop 2
    v_cvt_pk_bf16_f32 v80, v80, v81
    v_cvt_pk_bf16_f32 v81, v82, v83
    ds_wrxchg_rtn_b64 v[74:75], v93, v[80:81] offset:65408
    v_cvt_pk_bf16_f32 v76, v76, v77
    v_cvt_pk_bf16_f32 v77, v78, v79
    ds_wrxchg_rtn_b64 v[72:73], v92, v[76:77] offset:65408
    s_setprio 1
    v_mfma_f32_4x4x4_16b_bf16 v[80:83], v[8:9], v[106:107], 0
    v_mfma_f32_4x4x4_16b_bf16 v[76:79], v[8:9], v[104:105], 0
    s_nop 3
    v_pk_mul_f32 v[80:81], v[80:81], v[14:15] op_sel:[0,1] op_sel_hi:[1,1]
    v_pk_mul_f32 v[82:83], v[82:83], v[14:15] op_sel:[0,1] op_sel_hi:[1,1]
    v_pk_mul_f32 v[76:77], v[76:77], v[14:15] op_sel:[0,0] op_sel_hi:[1,0]
    v_pk_mul_f32 v[78:79], v[78:79], v[14:15] op_sel:[0,0] op_sel_hi:[1,0]
    s_bitcmp1_b32 s43, s42
    s_cbranch_scc1 L2_oa141
L2_ob141:
    v_and_b32 v46, 0x80000000, v27
    v_lshrrev_b32 v47, 14, v25
    v_bitop3_b32 v47, v47, v5, v46 bitop3:0xea
    ds_read_b64 v[102:103], v47
    v_and_b32 v99, 0x40000000, v27
    v_lshrrev_b32 v47, 14, v24
    v_bitop3_b32 v47, v47, v5, v99 bitop3:0xea
    ds_read_b64 v[100:101], v47
    s_waitcnt lgkmcnt(2)
    v_cmp_ne_u64 s[50:51], v[72:73], v[68:69]
    v_cmpx_ne_u64 s[54:55], v[74:75], v[70:71]
    s_and_b64 s[82:83], s[54:55], s[80:81]
    s_cbranch_scc1 L2_c142
L2_d142:
    v_mov_b64 v[84:85], v[70:71]
    v_mov_b32 v7, v93
    v_mov_b64 v[86:87], v[74:75]
    s_or_b64 s[80:81], s[80:81], s[54:55]
    s_mov_b64 exec, s[50:51]
    s_and_b64 s[82:83], s[50:51], s[80:81]
    s_cbranch_scc1 L2_c143
L2_d143:
    v_mov_b64 v[84:85], v[68:69]
    v_mov_b32 v7, v92
    v_mov_b64 v[86:87], v[72:73]
    s_mov_b64 exec, -1
    s_or_b64 s[80:81], s[80:81], s[50:51]
    ds_read_b64 v[70:71], v95 offset:65408
    ds_read_b64 v[68:69], v94 offset:65408
    v_bitop3_b32 v92, v24, v5, v99 bitop3:0xea
    v_bitop3_b32 v93, v25, v5, v46 bitop3:0xea
    v_perm_b32 v15, v25, v26, s47
    v_bitop3_b32 v46, v25, 0.5, -0.5 bitop3:0xa8
    v_perm_b32 v14, v24, v26, s46
    v_bitop3_b32 v47, v24, 0.5, -0.5 bitop3:0xa8
    v_bitop3_b32 v15, v6, v15, v46 bitop3:0xca
    v_bitop3_b32 v14, v6, v14, v47 bitop3:0xca
    s_waitcnt lgkmcnt(1)
    v_mfma_f32_4x4x4_16b_bf16 v[80:83], v[10:11], v[70:71], v[80:83]
    s_waitcnt lgkmcnt(0)
    v_mfma_f32_4x4x4_16b_bf16 v[76:79], v[10:11], v[68:69], v[76:79]
    s_nop 2
    v_cvt_pk_bf16_f32 v80, v80, v81
    v_cvt_pk_bf16_f32 v81, v82, v83
    ds_wrxchg_rtn_b64 v[74:75], v95, v[80:81] offset:65408
    v_cvt_pk_bf16_f32 v76, v76, v77
    v_cvt_pk_bf16_f32 v77, v78, v79
    ds_wrxchg_rtn_b64 v[72:73], v94, v[76:77] offset:65408
    v_mfma_f32_4x4x4_16b_bf16 v[80:83], v[8:9], v[102:103], 0
    v_mfma_f32_4x4x4_16b_bf16 v[76:79], v[8:9], v[100:101], 0
    v_cmp_lt_u32 s[84:85], v5, v92
    s_nop 2
    v_pk_mul_f32 v[80:81], v[80:81], v[14:15] op_sel:[0,1] op_sel_hi:[1,1]
    v_pk_mul_f32 v[82:83], v[82:83], v[14:15] op_sel:[0,1] op_sel_hi:[1,1]
    v_pk_mul_f32 v[76:77], v[76:77], v[14:15] op_sel:[0,0] op_sel_hi:[1,0]
    v_pk_mul_f32 v[78:79], v[78:79], v[14:15] op_sel:[0,0] op_sel_hi:[1,0]
    s_lshl_b32 s3, s32, 12
    v_subrev_u32 v122, s3, v3
    s_mul_i32 s3, s33, 20000
    v_add_u32 v118, s3, v122
    v_add_u32 v119, 0x4000, v118
    s_lshl_b32 s3, s34, 7
    v_lshrrev_b32 v123, 7, v118
    v_and_b32 v120, 0x70, v118
    v_lshl_add_u32 v120, v123, 13, v120
    v_add_u32 v120, s3, v120
    v_lshrrev_b32 v123, 7, v119
    v_and_b32 v121, 0x70, v119
    v_lshl_add_u32 v121, v123, 13, v121
    v_add_u32 v121, s3, v121
    v_cmp_le_u32 vcc, 3616, v122
    s_mov_b64 exec, vcc
    v_mov_b32 v119, 2.0
    v_mov_b32 v121, 2.0
    s_mov_b64 exec, -1
    v_and_b32 v123, 0x30, v122
    v_lshlrev_b32 v123, 2, v123
    buffer_load_dwordx4 v[48:51], v123, s[24:27], 0 offen
    buffer_load_dwordx4 v[52:55], v123, s[24:27], 0 offen offset:16
    buffer_load_dwordx2 v[56:57], v123, s[24:27], 0 offen offset:32
    s_mov_b32 s12, s4
    s_mov_b32 s13, s5
    s_mov_b32 s14, 0x138800
    s_mov_b32 s15, 0x20000
    s_mov_b32 s16, s28
    s_mov_b32 s17, s29
    s_mov_b32 s18, 0x4e2000
    s_mov_b32 s19, 0x20000
    v_lshrrev_b32 v123, 2, v120
    buffer_load_dword v116, v123, s[12:15], 0 offen
    buffer_load_dwordx4 v[108:111], v120, s[16:19], 0 offen
    v_lshrrev_b32 v123, 2, v121
    buffer_load_dword v117, v123, s[12:15], 0 offen
    buffer_load_dwordx4 v[112:115], v121, s[16:19], 0 offen
    s_waitcnt vmcnt(9)
    s_mov_b64 exec, s[6:7]
    v_lshrrev_b32 v30, 16, v30
    s_mov_b64 exec, -1
    v_and_b32 v46, 0x20000000, v31
    v_lshrrev_b32 v47, 14, v29
    v_bitop3_b32 v47, v47, v5, v46 bitop3:0xea
    ds_read_b64 v[106:107], v47
    v_and_b32 v99, 0x10000000, v31
    v_lshrrev_b32 v47, 14, v28
    v_bitop3_b32 v47, v47, v5, v99 bitop3:0xea
    ds_read_b64 v[104:105], v47
    s_waitcnt lgkmcnt(2)
    v_cmp_ne_u64 s[50:51], v[72:73], v[68:69]
    v_cmpx_ne_u64 s[54:55], v[74:75], v[70:71]
    s_and_b64 s[82:83], s[54:55], s[80:81]
    s_cbranch_scc1 L2_c144
L2_d144:
    v_mov_b64 v[84:85], v[70:71]
    v_mov_b32 v7, v95
    v_mov_b64 v[86:87], v[74:75]
    s_or_b64 s[80:81], s[80:81], s[54:55]
    s_mov_b64 exec, s[50:51]
    s_and_b64 s[82:83], s[50:51], s[80:81]
    s_cbranch_scc1 L2_c145
L2_d145:
    v_mov_b64 v[84:85], v[68:69]
    v_mov_b32 v7, v94
    v_mov_b64 v[86:87], v[72:73]
    s_mov_b64 exec, -1
    s_or_b64 s[80:81], s[80:81], s[50:51]
    s_and_b64 exec, s[84:85], s[80:81]
    v_mfma_f32_4x4x4_16b_bf16 v[76:79], v[12:13], v[84:85], 0
    v_mov_b32 v92, v7
    s_andn2_b64 s[80:81], s[80:81], s[84:85]
    v_mfma_f32_4x4x4_16b_bf16 v[76:79], v[10:11], v[86:87], v[76:79]
    s_mov_b64 exec, -1
    ds_read_b64 v[70:71], v93 offset:65408
    ds_read_b64 v[68:69], v92 offset:65408
    v_bitop3_b32 v94, v28, v5, v99 bitop3:0xea
    v_bitop3_b32 v95, v29, v5, v46 bitop3:0xea
    v_perm_b32 v15, v29, v30, s45
    v_bitop3_b32 v46, v29, 0.5, -0.5 bitop3:0xa8
    v_perm_b32 v14, v28, v30, s44
    v_bitop3_b32 v47, v28, 0.5, -0.5 bitop3:0xa8
    v_bitop3_b32 v15, v6, v15, v46 bitop3:0xca
    v_bitop3_b32 v14, v6, v14, v47 bitop3:0xca
    s_waitcnt lgkmcnt(1)
    v_mfma_f32_4x4x4_16b_bf16 v[80:83], v[10:11], v[70:71], v[80:83]
    s_waitcnt lgkmcnt(0)
    v_mfma_f32_4x4x4_16b_bf16 v[76:79], v[10:11], v[68:69], v[76:79]
    s_nop 2
    v_cvt_pk_bf16_f32 v80, v80, v81
    v_cvt_pk_bf16_f32 v81, v82, v83
    ds_wrxchg_rtn_b64 v[74:75], v93, v[80:81] offset:65408
    v_cvt_pk_bf16_f32 v76, v76, v77
    v_cvt_pk_bf16_f32 v77, v78, v79
    ds_wrxchg_rtn_b64 v[72:73], v92, v[76:77] offset:65408
    s_setprio 0
    v_mfma_f32_4x4x4_16b_bf16 v[80:83], v[8:9], v[106:107], 0
    v_mfma_f32_4x4x4_16b_bf16 v[76:79], v[8:9], v[104:105], 0
    v_cmp_lt_u32 s[48:49], v5, v95
    s_nop 2
    v_pk_mul_f32 v[80:81], v[80:81], v[14:15] op_sel:[0,1] op_sel_hi:[1,1]
    v_pk_mul_f32 v[82:83], v[82:83], v[14:15] op_sel:[0,1] op_sel_hi:[1,1]
    v_pk_mul_f32 v[76:77], v[76:77], v[14:15] op_sel:[0,0] op_sel_hi:[1,0]
    v_pk_mul_f32 v[78:79], v[78:79], v[14:15] op_sel:[0,0] op_sel_hi:[1,0]
    s_waitcnt vmcnt(7)
    v_and_b32 v46, 0x80000000, v39
    v_lshrrev_b32 v47, 14, v37
    v_bitop3_b32 v47, v47, v5, v46 bitop3:0xea
    ds_read_b64 v[106:107], v47
    v_and_b32 v99, 0x40000000, v39
    v_lshrrev_b32 v47, 14, v36
    v_bitop3_b32 v47, v47, v5, v99 bitop3:0xea
    ds_read_b64 v[104:105], v47
    v_and_b32 v46, 0x20000000, v39
    v_lshrrev_b32 v47, 14, v35
    v_bitop3_b32 v47, v47, v5, v46 bitop3:0xea
    ds_read_b64 v[102:103], v47
    v_and_b32 v99, 0x10000000, v39
    v_lshrrev_b32 v47, 14, v34
    v_bitop3_b32 v47, v47, v5, v99 bitop3:0xea
    ds_read_b64 v[100:101], v47
    s_waitcnt lgkmcnt(4)
    v_cmp_ne_u64 s[50:51], v[72:73], v[68:69]
    v_cmpx_ne_u64 s[54:55], v[74:75], v[70:71]
    s_and_b64 s[82:83], s[54:55], s[80:81]
    s_cbranch_scc1 L2_c146
L2_d146:
    v_mov_b64 v[84:85], v[70:71]
    v_mov_b32 v7, v93
    v_mov_b64 v[86:87], v[74:75]
    s_or_b64 s[80:81], s[80:81], s[54:55]
    s_mov_b64 exec, s[50:51]
    s_and_b64 s[82:83], s[50:51], s[80:81]
    s_cbranch_scc1 L2_c147
L2_d147:
    v_mov_b64 v[84:85], v[68:69]
    v_mov_b32 v7, v92
    v_mov_b64 v[86:87], v[72:73]
    s_mov_b64 exec, -1
    s_or_b64 s[80:81], s[80:81], s[50:51]
    s_and_b64 exec, s[48:49], s[80:81]
    v_mfma_f32_4x4x4_16b_bf16 v[80:83], v[12:13], v[84:85], 0
    v_mov_b32 v95, v7
    s_andn2_b64 s[80:81], s[80:81], s[48:49]
    v_mfma_f32_4x4x4_16b_bf16 v[80:83], v[10:11], v[86:87], v[80:83]
    s_mov_b64 exec, -1
    ds_read_b64 v[70:71], v95 offset:65408
    ds_read_b64 v[68:69], v94 offset:65408
    v_bitop3_b32 v92, v34, v5, v99 bitop3:0xea
    v_bitop3_b32 v93, v35, v5, v46 bitop3:0xea
    v_perm_b32 v15, v35, v38, s45
    v_bitop3_b32 v46, v35, 0.5, -0.5 bitop3:0xa8
    v_perm_b32 v14, v34, v38, s44
    v_bitop3_b32 v47, v34, 0.5, -0.5 bitop3:0xa8
    v_bitop3_b32 v15, v6, v15, v46 bitop3:0xca
    v_bitop3_b32 v14, v6, v14, v47 bitop3:0xca
    s_waitcnt lgkmcnt(1)
    v_mfma_f32_4x4x4_16b_bf16 v[80:83], v[10:11], v[70:71], v[80:83]
    s_waitcnt lgkmcnt(0)
    v_mfma_f32_4x4x4_16b_bf16 v[76:79], v[10:11], v[68:69], v[76:79]
    s_nop 2
    v_cvt_pk_bf16_f32 v80, v80, v81
    v_cvt_pk_bf16_f32 v81, v82, v83
    ds_wrxchg_rtn_b64 v[74:75], v95, v[80:81] offset:65408
    v_cvt_pk_bf16_f32 v76, v76, v77
    v_cvt_pk_bf16_f32 v77, v78, v79
    ds_wrxchg_rtn_b64 v[72:73], v94, v[76:77] offset:65408
    v_mfma_f32_4x4x4_16b_bf16 v[80:83], v[8:9], v[102:103], 0
    v_mfma_f32_4x4x4_16b_bf16 v[76:79], v[8:9], v[100:101], 0
    s_nop 3
    v_pk_mul_f32 v[80:81], v[80:81], v[14:15] op_sel:[0,1] op_sel_hi:[1,1]
    v_pk_mul_f32 v[82:83], v[82:83], v[14:15] op_sel:[0,1] op_sel_hi:[1,1]
    v_pk_mul_f32 v[76:77], v[76:77], v[14:15] op_sel:[0,0] op_sel_hi:[1,0]
    v_pk_mul_f32 v[78:79], v[78:79], v[14:15] op_sel:[0,0] op_sel_hi:[1,0]
    s_waitcnt lgkmcnt(0)
    v_cmp_ne_u64 s[50:51], v[72:73], v[68:69]
    v_cmpx_ne_u64 s[54:55], v[74:75], v[70:71]
    s_and_b64 s[82:83], s[54:55], s[80:81]
    s_cbranch_scc1 L2_c148
L2_d148:
    v_mov_b64 v[84:85], v[70:71]
    v_mov_b32 v7, v95
    v_mov_b64 v[86:87], v[74:75]
    s_or_b64 s[80:81], s[80:81], s[54:55]
    s_mov_b64 exec, s[50:51]
    s_and_b64 s[82:83], s[50:51], s[80:81]
    s_cbranch_scc1 L2_c149
L2_d149:
    v_mov_b64 v[84:85], v[68:69]
    v_mov_b32 v7, v94
    v_mov_b64 v[86:87], v[72:73]
    s_mov_b64 exec, -1
    s_or_b64 s[80:81], s[80:81], s[50:51]
    ds_read_b64 v[70:71], v93 offset:65408
    ds_read_b64 v[68:69], v92 offset:65408
    v_and_b32 v46, 0x40000000, v39
    v_bitop3_b32 v94, v36, v5, v46 bitop3:0xea
    v_and_b32 v46, 0x80000000, v39
    v_bitop3_b32 v95, v37, v5, v46 bitop3:0xea
    v_perm_b32 v15, v37, v38, s47
    v_bitop3_b32 v46, v37, 0.5, -0.5 bitop3:0xa8
    v_perm_b32 v14, v36, v38, s46
    v_bitop3_b32 v47, v36, 0.5, -0.5 bitop3:0xa8
    v_bitop3_b32 v15, v6, v15, v46 bitop3:0xca
    v_bitop3_b32 v14, v6, v14, v47 bitop3:0xca
    s_waitcnt lgkmcnt(1)
    v_mfma_f32_4x4x4_16b_bf16 v[80:83], v[10:11], v[70:71], v[80:83]
    s_waitcnt lgkmcnt(0)
    v_mfma_f32_4x4x4_16b_bf16 v[76:79], v[10:11], v[68:69], v[76:79]
    s_nop 2
    v_cvt_pk_bf16_f32 v80, v80, v81
    v_cvt_pk_bf16_f32 v81, v82, v83
    ds_wrxchg_rtn_b64 v[74:75], v93, v[80:81] offset:65408
    v_cvt_pk_bf16_f32 v76, v76, v77
    v_cvt_pk_bf16_f32 v77, v78, v79
    ds_wrxchg_rtn_b64 v[72:73], v92, v[76:77] offset:65408
    v_mfma_f32_4x4x4_16b_bf16 v[80:83], v[8:9], v[106:107], 0
    v_mfma_f32_4x4x4_16b_bf16 v[76:79], v[8:9], v[104:105], 0
    v_cmp_lt_u32 s[84:85], v5, v94
    s_nop 2
    v_pk_mul_f32 v[80:81], v[80:81], v[14:15] op_sel:[0,1] op_sel_hi:[1,1]
    v_pk_mul_f32 v[82:83], v[82:83], v[14:15] op_sel:[0,1] op_sel_hi:[1,1]
    v_pk_mul_f32 v[76:77], v[76:77], v[14:15] op_sel:[0,0] op_sel_hi:[1,0]
    v_pk_mul_f32 v[78:79], v[78:79], v[14:15] op_sel:[0,0] op_sel_hi:[1,0]
    s_waitcnt lgkmcnt(0)
    v_cmp_ne_u64 s[50:51], v[72:73], v[68:69]
    v_cmpx_ne_u64 s[54:55], v[74:75], v[70:71]
    s_and_b64 s[82:83], s[54:55], s[80:81]
    s_cbranch_scc1 L2_c150
L2_d150:
    v_mov_b64 v[84:85], v[70:71]
    v_mov_b32 v7, v93
    v_mov_b64 v[86:87], v[74:75]
    s_or_b64 s[80:81], s[80:81], s[54:55]
    s_mov_b64 exec, s[50:51]
    s_and_b64 s[82:83], s[50:51], s[80:81]
    s_cbranch_scc1 L2_c151
L2_d151:
    v_mov_b64 v[84:85], v[68:69]
    v_mov_b32 v7, v92
    v_mov_b64 v[86:87], v[72:73]
    s_mov_b64 exec, -1
    s_or_b64 s[80:81], s[80:81], s[50:51]
    s_and_b64 exec, s[84:85], s[80:81]
    v_mfma_f32_4x4x4_16b_bf16 v[76:79], v[12:13], v[84:85], 0
    v_mov_b32 v94, v7
    s_andn2_b64 s[80:81], s[80:81], s[84:85]
    v_mfma_f32_4x4x4_16b_bf16 v[76:79], v[10:11], v[86:87], v[76:79]
    s_mov_b64 exec, -1
    ds_read_b64 v[70:71], v95 offset:65408
    ds_read_b64 v[68:69], v94 offset:65408
    s_waitcnt lgkmcnt(1)
    v_mfma_f32_4x4x4_16b_bf16 v[80:83], v[10:11], v[70:71], v[80:83]
    s_waitcnt lgkmcnt(0)
    v_mfma_f32_4x4x4_16b_bf16 v[76:79], v[10:11], v[68:69], v[76:79]
    s_nop 2
    v_cvt_pk_bf16_f32 v80, v80, v81
    v_cvt_pk_bf16_f32 v81, v82, v83
    ds_wrxchg_rtn_b64 v[74:75], v95, v[80:81] offset:65408
    v_cvt_pk_bf16_f32 v76, v76, v77
    v_cvt_pk_bf16_f32 v77, v78, v79
    ds_wrxchg_rtn_b64 v[72:73], v94, v[76:77] offset:65408
    s_waitcnt lgkmcnt(0)
    v_cmpx_ne_u64 vcc, v[74:75], v[70:71]
    s_and_b64 s[82:83], vcc, s[80:81]
    s_cbranch_scc1 L2_c152
L2_d152:
    v_mov_b64 v[84:85], v[70:71]
    v_mov_b32 v7, v95
    v_mov_b64 v[86:87], v[74:75]
    s_mov_b64 exec, -1
    s_or_b64 s[80:81], s[80:81], vcc
    v_cmpx_ne_u64 vcc, v[72:73], v[68:69]
    s_and_b64 s[82:83], vcc, s[80:81]
    s_cbranch_scc1 L2_c153
L2_d153:
    v_mov_b64 v[84:85], v[68:69]
    v_mov_b32 v7, v94
    v_mov_b64 v[86:87], v[72:73]
    s_mov_b64 exec, -1
    s_or_b64 s[80:81], s[80:81], vcc
    s_mov_b64 exec, s[80:81]
    ds_read_b64 v[68:69], v7 offset:65408
    v_mfma_f32_4x4x4_16b_bf16 v[76:79], v[12:13], v[84:85], 0
    s_nop 1
    v_mfma_f32_4x4x4_16b_bf16 v[76:79], v[10:11], v[86:87], v[76:79]
    s_waitcnt lgkmcnt(0)
    s_nop 0
    v_mfma_f32_4x4x4_16b_bf16 v[76:79], v[10:11], v[68:69], v[76:79]
    v_mov_b64 v[84:85], v[68:69]
    s_nop 3
    v_cvt_pk_bf16_f32 v76, v76, v77
    v_cvt_pk_bf16_f32 v77, v78, v79
    ds_wrxchg_rtn_b64 v[86:87], v7, v[76:77] offset:65408
    s_waitcnt lgkmcnt(0)
    v_cmp_ne_u64 s[80:81], v[86:87], v[84:85]
    s_mov_b64 exec, s[80:81]
    s_nop 1
    v_mfma_f32_4x4x4_16b_bf16 v[88:91], v[12:13], v[84:85], 0
    s_nop 1
    v_mfma_f32_4x4x4_16b_bf16 v[88:91], v[10:11], v[86:87], v[88:91]
    s_nop 4
    v_cvt_pk_bf16_f32 v88, v88, v89
    v_cvt_pk_bf16_f32 v89, v90, v91
    ds_pk_add_bf16 v7, v88 offset:65408
    ds_pk_add_bf16 v7, v89 offset:65412
    s_mov_b64 exec, -1
    s_load_dwordx2 s[4:5], s[0:1], 88
    v_add_u32 v123, 0x4000, v122
    s_lshl_b32 s50, s96, 16
    s_and_b32 s51, s96, 0xffff0000
    s_lshl_b32 s52, s97, 16
    s_and_b32 s53, s97, 0xffff0000
    s_lshl_b32 s54, s98, 16
    s_and_b32 s55, s98, 0xffff0000
    s_lshl_b32 s56, s99, 16
    s_and_b32 s57, s99, 0xffff0000
    s_waitcnt vmcnt(0) lgkmcnt(0)
    s_barrier
    s_add_u32 s8, s30, 0xec46000
    s_addc_u32 s9, s31, 0
    s_mov_b32 s10, 0x8000
    s_mov_b32 s11, 0x20000
    s_mov_b32 s12, s4
    s_mov_b32 s13, s5
    s_mov_b32 s14, 0x4e2000
    s_mov_b32 s15, 0x20000
    s_add_u32 s20, s30, 0xd845000
    s_addc_u32 s21, s31, 0
    s_mov_b32 s22, 0x1400000
    s_mov_b32 s23, 0x20000
    s_lshl2_add_u32 s4, s34, s33
    s_mul_i32 s4, s4, 81920
    s_add_u32 s3, s33, 1
    s_and_b32 s3, s3, 3
    s_mul_i32 s36, s3, 20000
    s_add_u32 s36, s36, 81920
    s_mul_i32 s40, s3, 20480
    s_add_u32 s40, s40, s4
    s_lshl2_add_u32 s3, s34, s3
    s_mul_i32 s3, s3, 81920
    s_mul_i32 s44, s33, 20480
    s_add_u32 s44, s44, s3
    s_add_u32 s3, s33, 2
    s_and_b32 s3, s3, 3
    s_mul_i32 s37, s3, 20000
    s_add_u32 s37, s37, 81920
    s_mul_i32 s41, s3, 20480
    s_add_u32 s41, s41, s4
    s_lshl2_add_u32 s3, s34, s3
    s_mul_i32 s3, s3, 81920
    s_mul_i32 s45, s33, 20480
    s_add_u32 s45, s45, s3
    s_add_u32 s3, s33, 3
    s_and_b32 s3, s3, 3
    s_mul_i32 s38, s3, 20000
    s_add_u32 s38, s38, 81920
    s_mul_i32 s42, s3, 20480
    s_add_u32 s42, s42, s4
    s_lshl2_add_u32 s3, s34, s3
    s_mul_i32 s3, s3, 81920
    s_mul_i32 s46, s33, 20480
    s_add_u32 s46, s46, s3
    v_add_u32 v104, s36, v122
    ds_read_b128 v[16:19], v104
    v_add_u32 v104, s37, v122
    ds_read_b128 v[20:23], v104
    v_add_u32 v104, s38, v122
    ds_read_b128 v[24:27], v104
    s_waitcnt lgkmcnt(2)
    buffer_store_dwordx4 v[16:19], v122, s[20:23], s40 offen sc1
    s_waitcnt lgkmcnt(1)
    buffer_store_dwordx4 v[20:23], v122, s[20:23], s41 offen sc1
    s_waitcnt lgkmcnt(0)
    buffer_store_dwordx4 v[24:27], v122, s[20:23], s42 offen sc1
    s_cmp_ge_u32 s32, 4
    s_cbranch_scc1 L2_g0
    v_add_u32 v104, s36, v123
    ds_read_b128 v[36:39], v104
    v_add_u32 v104, s37, v123
    ds_read_b128 v[40:43], v104
    v_add_u32 v104, s38, v123
    ds_read_b128 v[44:47], v104
    s_waitcnt lgkmcnt(2)
    buffer_store_dwordx4 v[36:39], v123, s[20:23], s40 offen sc1
    s_waitcnt lgkmcnt(1)
    buffer_store_dwordx4 v[40:43], v123, s[20:23], s41 offen sc1
    s_waitcnt lgkmcnt(0)
    buffer_store_dwordx4 v[44:47], v123, s[20:23], s42 offen sc1
L2_g0:
    v_lshlrev_b32 v80, 16, v116
    v_subrev_f32 v60, s50, v80
    v_subrev_f32 v61, s51, v80
    v_subrev_f32 v62, s52, v80
    v_subrev_f32 v63, s53, v80
    v_subrev_f32 v64, s54, v80
    v_subrev_f32 v65, s55, v80
    v_subrev_f32 v66, s56, v80
    v_subrev_f32 v67, s57, v80
    v_cvt_pk_bf16_f32 v68, v60, v61
    v_cvt_pk_bf16_f32 v69, v62, v63
    v_cvt_pk_bf16_f32 v70, v64, v65
    v_cvt_pk_bf16_f32 v71, v66, v67
    v_lshlrev_b32 v60, 16, v68
    v_and_b32 v61, 0xffff0000, v68
    v_lshlrev_b32 v62, 16, v69
    v_and_b32 v63, 0xffff0000, v69
    v_lshlrev_b32 v64, 16, v70
    v_and_b32 v65, 0xffff0000, v70
    v_lshlrev_b32 v66, 16, v71
    v_and_b32 v67, 0xffff0000, v71
    v_mul_f32 v60, v60, v60
    v_mul_f32 v61, v61, v61
    v_mul_f32 v62, v62, v62
    v_mul_f32 v63, v63, v63
    v_mul_f32 v64, v64, v64
    v_mul_f32 v65, v65, v65
    v_mul_f32 v66, v66, v66
    v_mul_f32 v67, v67, v67
    v_cvt_pk_bf16_f32 v68, v60, v61
    v_cvt_pk_bf16_f32 v69, v62, v63
    v_cvt_pk_bf16_f32 v70, v64, v65
    v_cvt_pk_bf16_f32 v71, v66, v67
    v_lshlrev_b32 v60, 16, v68
    v_and_b32 v61, 0xffff0000, v68
    v_lshlrev_b32 v62, 16, v69
    v_and_b32 v63, 0xffff0000, v69
    v_lshlrev_b32 v64, 16, v70
    v_and_b32 v65, 0xffff0000, v70
    v_lshlrev_b32 v66, 16, v71
    v_and_b32 v67, 0xffff0000, v71
    v_mul_f32 v60, 0xc1200000, v60
    v_mul_f32 v61, 0xc1200000, v61
    v_mul_f32 v62, 0xc1200000, v62
    v_mul_f32 v63, 0xc1200000, v63
    v_mul_f32 v64, 0xc1200000, v64
    v_mul_f32 v65, 0xc1200000, v65
    v_mul_f32 v66, 0xc1200000, v66
    v_mul_f32 v67, 0xc1200000, v67
    v_cvt_pk_bf16_f32 v68, v60, v61
    v_cvt_pk_bf16_f32 v69, v62, v63
    v_cvt_pk_bf16_f32 v70, v64, v65
    v_cvt_pk_bf16_f32 v71, v66, v67
    v_lshlrev_b32 v60, 16, v68
    v_and_b32 v61, 0xffff0000, v68
    v_lshlrev_b32 v62, 16, v69
    v_and_b32 v63, 0xffff0000, v69
    v_lshlrev_b32 v64, 16, v70
    v_and_b32 v65, 0xffff0000, v70
    v_lshlrev_b32 v66, 16, v71
    v_and_b32 v67, 0xffff0000, v71
    v_mul_f32 v60, 0x3fb8aa3b, v60
    v_mul_f32 v61, 0x3fb8aa3b, v61
    v_mul_f32 v62, 0x3fb8aa3b, v62
    v_mul_f32 v63, 0x3fb8aa3b, v63
    v_mul_f32 v64, 0x3fb8aa3b, v64
    v_mul_f32 v65, 0x3fb8aa3b, v65
    v_mul_f32 v66, 0x3fb8aa3b, v66
    v_mul_f32 v67, 0x3fb8aa3b, v67
    v_exp_f32 v60, v60
    v_exp_f32 v61, v61
    v_exp_f32 v62, v62
    v_exp_f32 v63, v63
    v_exp_f32 v64, v64
    v_exp_f32 v65, v65
    v_exp_f32 v66, v66
    v_exp_f32 v67, v67
    v_cvt_pk_bf16_f32 v72, v60, v61
    v_cvt_pk_bf16_f32 v73, v62, v63
    v_cvt_pk_bf16_f32 v74, v64, v65
    v_cvt_pk_bf16_f32 v75, v66, v67
    v_and_b32 v80, 0xffff0000, v116
    v_subrev_f32 v60, s50, v80
    v_subrev_f32 v61, s51, v80
    v_subrev_f32 v62, s52, v80
    v_subrev_f32 v63, s53, v80
    v_subrev_f32 v64, s54, v80
    v_subrev_f32 v65, s55, v80
    v_subrev_f32 v66, s56, v80
    v_subrev_f32 v67, s57, v80
    v_cvt_pk_bf16_f32 v68, v60, v61
    v_cvt_pk_bf16_f32 v69, v62, v63
    v_cvt_pk_bf16_f32 v70, v64, v65
    v_cvt_pk_bf16_f32 v71, v66, v67
    v_lshlrev_b32 v60, 16, v68
    v_and_b32 v61, 0xffff0000, v68
    v_lshlrev_b32 v62, 16, v69
    v_and_b32 v63, 0xffff0000, v69
    v_lshlrev_b32 v64, 16, v70
    v_and_b32 v65, 0xffff0000, v70
    v_lshlrev_b32 v66, 16, v71
    v_and_b32 v67, 0xffff0000, v71
    v_mul_f32 v60, v60, v60
    v_mul_f32 v61, v61, v61
    v_mul_f32 v62, v62, v62
    v_mul_f32 v63, v63, v63
    v_mul_f32 v64, v64, v64
    v_mul_f32 v65, v65, v65
    v_mul_f32 v66, v66, v66
    v_mul_f32 v67, v67, v67
    v_cvt_pk_bf16_f32 v68, v60, v61
    v_cvt_pk_bf16_f32 v69, v62, v63
    v_cvt_pk_bf16_f32 v70, v64, v65
    v_cvt_pk_bf16_f32 v71, v66, v67
    v_lshlrev_b32 v60, 16, v68
    v_and_b32 v61, 0xffff0000, v68
    v_lshlrev_b32 v62, 16, v69
    v_and_b32 v63, 0xffff0000, v69
    v_lshlrev_b32 v64, 16, v70
    v_and_b32 v65, 0xffff0000, v70
    v_lshlrev_b32 v66, 16, v71
    v_and_b32 v67, 0xffff0000, v71
    v_mul_f32 v60, 0xc1200000, v60
    v_mul_f32 v61, 0xc1200000, v61
    v_mul_f32 v62, 0xc1200000, v62
    v_mul_f32 v63, 0xc1200000, v63
    v_mul_f32 v64, 0xc1200000, v64
    v_mul_f32 v65, 0xc1200000, v65
    v_mul_f32 v66, 0xc1200000, v66
    v_mul_f32 v67, 0xc1200000, v67
    v_cvt_pk_bf16_f32 v68, v60, v61
    v_cvt_pk_bf16_f32 v69, v62, v63
    v_cvt_pk_bf16_f32 v70, v64, v65
    v_cvt_pk_bf16_f32 v71, v66, v67
    v_lshlrev_b32 v60, 16, v68
    v_and_b32 v61, 0xffff0000, v68
    v_lshlrev_b32 v62, 16, v69
    v_and_b32 v63, 0xffff0000, v69
    v_lshlrev_b32 v64, 16, v70
    v_and_b32 v65, 0xffff0000, v70
    v_lshlrev_b32 v66, 16, v71
    v_and_b32 v67, 0xffff0000, v71
    v_mul_f32 v60, 0x3fb8aa3b, v60
    v_mul_f32 v61, 0x3fb8aa3b, v61
    v_mul_f32 v62, 0x3fb8aa3b, v62
    v_mul_f32 v63, 0x3fb8aa3b, v63
    v_mul_f32 v64, 0x3fb8aa3b, v64
    v_mul_f32 v65, 0x3fb8aa3b, v65
    v_mul_f32 v66, 0x3fb8aa3b, v66
    v_mul_f32 v67, 0x3fb8aa3b, v67
    v_exp_f32 v60, v60
    v_exp_f32 v61, v61
    v_exp_f32 v62, v62
    v_exp_f32 v63, v63
    v_exp_f32 v64, v64
    v_exp_f32 v65, v65
    v_exp_f32 v66, v66
    v_exp_f32 v67, v67
    v_cvt_pk_bf16_f32 v76, v60, v61
    v_cvt_pk_bf16_f32 v77, v62, v63
    v_cvt_pk_bf16_f32 v78, v64, v65
    v_cvt_pk_bf16_f32 v79, v66, v67
    v_mfma_f32_4x4x4_16b_bf16 v[80:83], v[48:49], v[72:73], 0
    v_mfma_f32_4x4x4_16b_bf16 v[88:91], v[52:53], v[72:73], 0
    v_mfma_f32_4x4x4_16b_bf16 v[84:87], v[48:49], v[76:77], 0
    v_mfma_f32_4x4x4_16b_bf16 v[92:95], v[52:53], v[76:77], 0
    v_mfma_f32_4x4x4_16b_bf16 v[80:83], v[50:51], v[74:75], v[80:83]
    v_mfma_f32_4x4x4_16b_bf16 v[88:91], v[54:55], v[74:75], v[88:91]
    v_mfma_f32_4x4x4_16b_bf16 v[84:87], v[50:51], v[78:79], v[84:87]
    v_mfma_f32_4x4x4_16b_bf16 v[92:95], v[54:55], v[78:79], v[92:95]
    s_lshl_b32 s3, s34, 9
    s_lshl_b32 s4, s33, 7
    s_add_u32 s4, s4, s3
    v_mov_b32 v104, 1
    v_and_b32 v105, 0x3f0, v122
    v_lshlrev_b32 v105, 3, v105
    v_add_u32 v106, 81920, v118
    ds_read_b128 v[32:35], v106
    v_add_u32 v106, 81920, v119
    ds_read_b128 v[60:63], v106
    s_waitcnt vmcnt(0)
    s_barrier
    s_cmp_lg_u32 s32, 0
    s_cbranch_scc1 L2_f2
    s_mov_b64 exec, 1
    buffer_store_dword v104, off, s[8:11], s4 sc1
    s_mov_b64 exec, 15
    s_bitset0_b64 exec, s33
L2_f3:
    buffer_load_dword v104, v105, s[8:11], s3 offen sc1
    s_waitcnt vmcnt(0)
    v_cmp_ne_u32 vcc, 1, v104
    s_cbranch_vccnz L2_f3s
    s_mov_b64 exec, -1
L2_f2:
    s_barrier
    buffer_load_dwordx4 v[36:39], v122, s[20:23], s44 offen sc1
    buffer_load_dwordx4 v[40:43], v122, s[20:23], s45 offen sc1
    buffer_load_dwordx4 v[44:47], v122, s[20:23], s46 offen sc1
    s_cmp_ge_u32 s32, 4
    s_cbranch_scc1 L2_f5
    buffer_load_dwordx4 v[64:67], v123, s[20:23], s44 offen sc1
    buffer_load_dwordx4 v[68:71], v123, s[20:23], s45 offen sc1
    buffer_load_dwordx4 v[72:75], v123, s[20:23], s46 offen sc1
    v_lshlrev_b32 v16, 16, v117
    v_subrev_f32 v96, s50, v16
    v_subrev_f32 v97, s51, v16
    v_subrev_f32 v98, s52, v16
    v_subrev_f32 v99, s53, v16
    v_subrev_f32 v100, s54, v16
    v_subrev_f32 v101, s55, v16
    v_subrev_f32 v102, s56, v16
    v_subrev_f32 v103, s57, v16
    v_cvt_pk_bf16_f32 v0, v96, v97
    v_cvt_pk_bf16_f32 v1, v98, v99
    v_cvt_pk_bf16_f32 v2, v100, v101
    v_cvt_pk_bf16_f32 v3, v102, v103
    v_lshlrev_b32 v96, 16, v0
    v_and_b32 v97, 0xffff0000, v0
    v_lshlrev_b32 v98, 16, v1
    v_and_b32 v99, 0xffff0000, v1
    v_lshlrev_b32 v100, 16, v2
    v_and_b32 v101, 0xffff0000, v2
    v_lshlrev_b32 v102, 16, v3
    v_and_b32 v103, 0xffff0000, v3
    v_mul_f32 v96, v96, v96
    v_mul_f32 v97, v97, v97
    v_mul_f32 v98, v98, v98
    v_mul_f32 v99, v99, v99
    v_mul_f32 v100, v100, v100
    v_mul_f32 v101, v101, v101
    v_mul_f32 v102, v102, v102
    v_mul_f32 v103, v103, v103
    v_cvt_pk_bf16_f32 v0, v96, v97
    v_cvt_pk_bf16_f32 v1, v98, v99
    v_cvt_pk_bf16_f32 v2, v100, v101
    v_cvt_pk_bf16_f32 v3, v102, v103
    v_lshlrev_b32 v96, 16, v0
    v_and_b32 v97, 0xffff0000, v0
    v_lshlrev_b32 v98, 16, v1
    v_and_b32 v99, 0xffff0000, v1
    v_lshlrev_b32 v100, 16, v2
    v_and_b32 v101, 0xffff0000, v2
    v_lshlrev_b32 v102, 16, v3
    v_and_b32 v103, 0xffff0000, v3
    v_mul_f32 v96, 0xc1200000, v96
    v_mul_f32 v97, 0xc1200000, v97
    v_mul_f32 v98, 0xc1200000, v98
    v_mul_f32 v99, 0xc1200000, v99
    v_mul_f32 v100, 0xc1200000, v100
    v_mul_f32 v101, 0xc1200000, v101
    v_mul_f32 v102, 0xc1200000, v102
    v_mul_f32 v103, 0xc1200000, v103
    v_cvt_pk_bf16_f32 v0, v96, v97
    v_cvt_pk_bf16_f32 v1, v98, v99
    v_cvt_pk_bf16_f32 v2, v100, v101
    v_cvt_pk_bf16_f32 v3, v102, v103
    v_lshlrev_b32 v96, 16, v0
    v_and_b32 v97, 0xffff0000, v0
    v_lshlrev_b32 v98, 16, v1
    v_and_b32 v99, 0xffff0000, v1
    v_lshlrev_b32 v100, 16, v2
    v_and_b32 v101, 0xffff0000, v2
    v_lshlrev_b32 v102, 16, v3
    v_and_b32 v103, 0xffff0000, v3
    v_mul_f32 v96, 0x3fb8aa3b, v96
    v_mul_f32 v97, 0x3fb8aa3b, v97
    v_mul_f32 v98, 0x3fb8aa3b, v98
    v_mul_f32 v99, 0x3fb8aa3b, v99
    v_mul_f32 v100, 0x3fb8aa3b, v100
    v_mul_f32 v101, 0x3fb8aa3b, v101
    v_mul_f32 v102, 0x3fb8aa3b, v102
    v_mul_f32 v103, 0x3fb8aa3b, v103
    v_exp_f32 v96, v96
    v_exp_f32 v97, v97
    v_exp_f32 v98, v98
    v_exp_f32 v99, v99
    v_exp_f32 v100, v100
    v_exp_f32 v101, v101
    v_exp_f32 v102, v102
    v_exp_f32 v103, v103
    v_cvt_pk_bf16_f32 v104, v96, v97
    v_cvt_pk_bf16_f32 v105, v98, v99
    v_cvt_pk_bf16_f32 v106, v100, v101
    v_cvt_pk_bf16_f32 v107, v102, v103
    v_and_b32 v16, 0xffff0000, v117
    v_subrev_f32 v96, s50, v16
    v_subrev_f32 v97, s51, v16
    v_subrev_f32 v98, s52, v16
    v_subrev_f32 v99, s53, v16
    v_subrev_f32 v100, s54, v16
    v_subrev_f32 v101, s55, v16
    v_subrev_f32 v102, s56, v16
    v_subrev_f32 v103, s57, v16
    v_cvt_pk_bf16_f32 v0, v96, v97
    v_cvt_pk_bf16_f32 v1, v98, v99
    v_cvt_pk_bf16_f32 v2, v100, v101
    v_cvt_pk_bf16_f32 v3, v102, v103
    v_lshlrev_b32 v96, 16, v0
    v_and_b32 v97, 0xffff0000, v0
    v_lshlrev_b32 v98, 16, v1
    v_and_b32 v99, 0xffff0000, v1
    v_lshlrev_b32 v100, 16, v2
    v_and_b32 v101, 0xffff0000, v2
    v_lshlrev_b32 v102, 16, v3
    v_and_b32 v103, 0xffff0000, v3
    v_mul_f32 v96, v96, v96
    v_mul_f32 v97, v97, v97
    v_mul_f32 v98, v98, v98
    v_mul_f32 v99, v99, v99
    v_mul_f32 v100, v100, v100
    v_mul_f32 v101, v101, v101
    v_mul_f32 v102, v102, v102
    v_mul_f32 v103, v103, v103
    v_cvt_pk_bf16_f32 v0, v96, v97
    v_cvt_pk_bf16_f32 v1, v98, v99
    v_cvt_pk_bf16_f32 v2, v100, v101
    v_cvt_pk_bf16_f32 v3, v102, v103
    v_lshlrev_b32 v96, 16, v0
    v_and_b32 v97, 0xffff0000, v0
    v_lshlrev_b32 v98, 16, v1
    v_and_b32 v99, 0xffff0000, v1
    v_lshlrev_b32 v100, 16, v2
    v_and_b32 v101, 0xffff0000, v2
    v_lshlrev_b32 v102, 16, v3
    v_and_b32 v103, 0xffff0000, v3
    v_mul_f32 v96, 0xc1200000, v96
    v_mul_f32 v97, 0xc1200000, v97
    v_mul_f32 v98, 0xc1200000, v98
    v_mul_f32 v99, 0xc1200000, v99
    v_mul_f32 v100, 0xc1200000, v100
    v_mul_f32 v101, 0xc1200000, v101
    v_mul_f32 v102, 0xc1200000, v102
    v_mul_f32 v103, 0xc1200000, v103
    v_cvt_pk_bf16_f32 v0, v96, v97
    v_cvt_pk_bf16_f32 v1, v98, v99
    v_cvt_pk_bf16_f32 v2, v100, v101
    v_cvt_pk_bf16_f32 v3, v102, v103
    v_lshlrev_b32 v96, 16, v0
    v_and_b32 v97, 0xffff0000, v0
    v_lshlrev_b32 v98, 16, v1
    v_and_b32 v99, 0xffff0000, v1
    v_lshlrev_b32 v100, 16, v2
    v_and_b32 v101, 0xffff0000, v2
    v_lshlrev_b32 v102, 16, v3
    v_and_b32 v103, 0xffff0000, v3
    v_mul_f32 v96, 0x3fb8aa3b, v96
    v_mul_f32 v97, 0x3fb8aa3b, v97
    v_mul_f32 v98, 0x3fb8aa3b, v98
    v_mul_f32 v99, 0x3fb8aa3b, v99
    v_mul_f32 v100, 0x3fb8aa3b, v100
    v_mul_f32 v101, 0x3fb8aa3b, v101
    v_mul_f32 v102, 0x3fb8aa3b, v102
    v_mul_f32 v103, 0x3fb8aa3b, v103
    v_exp_f32 v96, v96
    v_exp_f32 v97, v97
    v_exp_f32 v98, v98
    v_exp_f32 v99, v99
    v_exp_f32 v100, v100
    v_exp_f32 v101, v101
    v_exp_f32 v102, v102
    v_exp_f32 v103, v103
    v_cvt_pk_bf16_f32 v76, v96, v97
    v_cvt_pk_bf16_f32 v77, v98, v99
    v_cvt_pk_bf16_f32 v78, v100, v101
    v_cvt_pk_bf16_f32 v79, v102, v103
    v_mfma_f32_4x4x4_16b_bf16 v[16:19], v[48:49], v[104:105], 0
    v_mfma_f32_4x4x4_16b_bf16 v[24:27], v[52:53], v[104:105], 0
    v_mfma_f32_4x4x4_16b_bf16 v[20:23], v[48:49], v[76:77], 0
    v_mfma_f32_4x4x4_16b_bf16 v[28:31], v[52:53], v[76:77], 0
    v_mfma_f32_4x4x4_16b_bf16 v[16:19], v[50:51], v[106:107], v[16:19]
    v_mfma_f32_4x4x4_16b_bf16 v[24:27], v[54:55], v[106:107], v[24:27]
    v_mfma_f32_4x4x4_16b_bf16 v[20:23], v[50:51], v[78:79], v[20:23]
    v_mfma_f32_4x4x4_16b_bf16 v[28:31], v[54:55], v[78:79], v[28:31]
L2_f5:
    s_waitcnt vmcnt(0) lgkmcnt(0)
    v_mfma_f32_4x4x4_16b_bf16 v[96:99], v[10:11], v[32:33], 0
    v_mfma_f32_4x4x4_16b_bf16 v[100:103], v[10:11], v[34:35], 0
    s_nop 0
    v_mfma_f32_4x4x4_16b_bf16 v[96:99], v[10:11], v[36:37], v[96:99]
    v_mfma_f32_4x4x4_16b_bf16 v[100:103], v[10:11], v[38:39], v[100:103]
    s_nop 0
    v_mfma_f32_4x4x4_16b_bf16 v[96:99], v[10:11], v[40:41], v[96:99]
    v_mfma_f32_4x4x4_16b_bf16 v[100:103], v[10:11], v[42:43], v[100:103]
    s_nop 0
    v_mfma_f32_4x4x4_16b_bf16 v[96:99], v[10:11], v[44:45], v[96:99]
    v_mfma_f32_4x4x4_16b_bf16 v[100:103], v[10:11], v[46:47], v[100:103]
    s_nop 3
    v_mul_f32 v96, v96, v80
    v_mul_f32 v97, v97, v81
    v_mul_f32 v98, v98, v82
    v_mul_f32 v99, v99, v83
    v_cvt_pk_bf16_f32 v32, v96, v97
    v_cvt_pk_bf16_f32 v33, v98, v99
    v_mul_f32 v100, v100, v84
    v_mul_f32 v101, v101, v85
    v_mul_f32 v102, v102, v86
    v_mul_f32 v103, v103, v87
    v_cvt_pk_bf16_f32 v34, v100, v101
    v_cvt_pk_bf16_f32 v35, v102, v103
    v_mfma_f32_4x4x4_16b_bf16 v[80:83], v[56:57], v[32:33], 0
    s_nop 0
    v_mfma_f32_4x4x4_16b_bf16 v[84:87], v[56:57], v[34:35], 0
    s_nop 2
    v_mul_f32 v80, v80, v88
    v_mul_f32 v81, v81, v89
    v_mul_f32 v82, v82, v90
    v_mul_f32 v83, v83, v91
    v_mul_f32 v84, v84, v92
    v_mul_f32 v85, v85, v93
    v_mul_f32 v86, v86, v94
    v_mul_f32 v87, v87, v95
    v_mfma_f32_4x4x4_16b_bf16 v[96:99], v[10:11], v[108:109], v[80:83]
    s_nop 0
    v_mfma_f32_4x4x4_16b_bf16 v[100:103], v[10:11], v[110:111], v[84:87]
    s_nop 2
    v_cvt_pk_bf16_f32 v36, v96, v97
    v_cvt_pk_bf16_f32 v37, v98, v99
    v_cvt_pk_bf16_f32 v38, v100, v101
    v_cvt_pk_bf16_f32 v39, v102, v103
    buffer_store_dwordx4 v[36:39], v120, s[12:15], 0 offen nt
    s_cmp_ge_u32 s32, 4
    s_cbranch_scc1 L2_f6
    v_mfma_f32_4x4x4_16b_bf16 v[96:99], v[10:11], v[60:61], 0
    v_mfma_f32_4x4x4_16b_bf16 v[100:103], v[10:11], v[62:63], 0
    s_nop 0
    v_mfma_f32_4x4x4_16b_bf16 v[96:99], v[10:11], v[64:65], v[96:99]
    v_mfma_f32_4x4x4_16b_bf16 v[100:103], v[10:11], v[66:67], v[100:103]
    s_nop 0
    v_mfma_f32_4x4x4_16b_bf16 v[96:99], v[10:11], v[68:69], v[96:99]
    v_mfma_f32_4x4x4_16b_bf16 v[100:103], v[10:11], v[70:71], v[100:103]
    s_nop 0
    v_mfma_f32_4x4x4_16b_bf16 v[96:99], v[10:11], v[72:73], v[96:99]
    v_mfma_f32_4x4x4_16b_bf16 v[100:103], v[10:11], v[74:75], v[100:103]
    s_nop 3
    v_mul_f32 v96, v96, v16
    v_mul_f32 v97, v97, v17
    v_mul_f32 v98, v98, v18
    v_mul_f32 v99, v99, v19
    v_cvt_pk_bf16_f32 v60, v96, v97
    v_cvt_pk_bf16_f32 v61, v98, v99
    v_mul_f32 v100, v100, v20
    v_mul_f32 v101, v101, v21
    v_mul_f32 v102, v102, v22
    v_mul_f32 v103, v103, v23
    v_cvt_pk_bf16_f32 v62, v100, v101
    v_cvt_pk_bf16_f32 v63, v102, v103
    v_mfma_f32_4x4x4_16b_bf16 v[16:19], v[56:57], v[60:61], 0
    s_nop 0
    v_mfma_f32_4x4x4_16b_bf16 v[20:23], v[56:57], v[62:63], 0
    s_nop 2
    v_mul_f32 v16, v16, v24
    v_mul_f32 v17, v17, v25
    v_mul_f32 v18, v18, v26
    v_mul_f32 v19, v19, v27
    v_mul_f32 v20, v20, v28
    v_mul_f32 v21, v21, v29
    v_mul_f32 v22, v22, v30
    v_mul_f32 v23, v23, v31
    v_mfma_f32_4x4x4_16b_bf16 v[96:99], v[10:11], v[112:113], v[16:19]
    s_nop 0
    v_mfma_f32_4x4x4_16b_bf16 v[100:103], v[10:11], v[114:115], v[20:23]
    s_nop 2
    v_cvt_pk_bf16_f32 v64, v96, v97
    v_cvt_pk_bf16_f32 v65, v98, v99
    v_cvt_pk_bf16_f32 v66, v100, v101
    v_cvt_pk_bf16_f32 v67, v102, v103
    buffer_store_dwordx4 v[64:67], v121, s[12:15], 0 offen nt
L2_f6:
L2_end:
    s_endpgm
L2_slow:
    s_lshr_b32 s35, s42, 2
    s_lshl_b32 s50, s32, 4
    s_and_b32 s3, s42, 3
    s_lshl_b32 s53, s3, 3
    s_add_u32 s53, s53, s39
    s_and_b32 s3, s35, 2
    s_lshl_b32 s3, s3, 1
    s_add_u32 s53, s53, s3
    s_and_b32 s54, s35, 1
    s_lshl_b32 s54, s54, 4
L2_sl_seg:
    s_mul_i32 s55, s50, 173056
    s_and_b32 s3, s50, 3
    s_lshl_b32 s3, s3, 5
    s_add_u32 s3, s3, s55
    s_add_u32 s3, s3, s53
    buffer_load_dword v104, off, s[12:15], s3 sc1
    buffer_load_dword v105, off, s[12:15], s3 offset:32 sc1
    s_waitcnt vmcnt(0)
    v_readfirstlane_b32 s51, v104
    v_readfirstlane_b32 s52, v105
    s_lshr_b32 s51, s51, s54
    s_and_b32 s51, s51, 0xffff
    s_lshr_b32 s52, s52, s54
    s_and_b32 s52, s52, 0xffff
L2_sl_rec:
    s_cmp_ge_u32 s51, s52
    s_cbranch_scc1 L2_sl_next
    v_mbcnt_lo_u32_b32 v102, -1, 0
    v_mbcnt_hi_u32_b32 v102, -1, v102
    v_add_u32 v102, s51, v102
    v_and_b32 v103, -4, v102
    v_lshl_add_u32 v104, v102, 2, v103
    v_lshl_add_u32 v105, v103, 2, v102
    v_cmp_gt_u32 vcc, s52, v102
    s_mov_b64 exec, vcc
    buffer_load_dword v106, v104, s[8:11], s55 offen
    buffer_load_ubyte v107, v105, s[8:11], s55 offen offset:16
    s_waitcnt vmcnt(0)
    v_lshrrev_b32 v98, 14, v106
    v_and_b32 v98, v5, v98
    ds_read_b64 v[100:101], v98
    v_perm_b32 v97, v106, v107, s44
    v_and_b32 v96, v5, v106
    v_bitop3_b32 v103, v106, 0.5, -0.5 bitop3:0xa8
    v_bitop3_b32 v97, v6, v97, v103 bitop3:0xca
    s_waitcnt lgkmcnt(0)
    v_mfma_f32_4x4x4_16b_bf16 v[88:91], v[8:9], v[100:101], 0
    s_nop 4
    v_mul_f32 v88, v97, v88
    v_mul_f32 v89, v97, v89
    v_mul_f32 v90, v97, v90
    v_mul_f32 v91, v97, v91
    v_cvt_pk_bf16_f32 v88, v88, v89
    v_cvt_pk_bf16_f32 v89, v90, v91
    ds_pk_add_bf16 v96, v88 offset:65408
    ds_pk_add_bf16 v96, v89 offset:65412
    s_mov_b64 exec, -1
    s_add_u32 s51, s51, 64
    s_branch L2_sl_rec
L2_sl_next:
    s_add_u32 s50, s50, 1
    s_and_b32 s3, s50, 15
    s_cbranch_scc1 L2_sl_seg
    s_add_u32 s50, s50, 240
    s_cmp_lt_u32 s50, 1280
    s_cbranch_scc1 L2_sl_seg
    s_waitcnt lgkmcnt(0)
    s_cmp_eq_u32 s42, 0
    s_cbranch_scc1 L2_ret0
    s_cmp_eq_u32 s42, 1
    s_cbranch_scc1 L2_ret1
    s_cmp_eq_u32 s42, 14
    s_cbranch_scc1 L2_ret6
    s_cmp_eq_u32 s42, 15
    s_cbranch_scc1 L2_ret7
    s_and_b32 s3, s42, 3
    s_cmp_eq_u32 s3, 2
    s_cbranch_scc1 L2_ret2
    s_cmp_eq_u32 s3, 3
    s_cbranch_scc1 L2_ret3
    s_cmp_eq_u32 s3, 0
    s_cbranch_scc1 L2_ret4
    s_branch L2_ret5
L2_p1s:
    s_sleep 32
    s_branch L2_p1
L2_xo3:
    v_cmp_lt_u32 vcc, 20, v99
    s_mov_b32 s101, 1
    s_cbranch_vccz L2_xp3
    v_cmp_lt_u32 vcc, 32, v99
    v_cmp_lt_u32 s[58:59], 31, v88
    s_mov_b32 s101, 2
    s_or_b64 vcc, vcc, s[58:59]
    s_cbranch_scc0 L2_xp3
    s_mov_b32 s37, 0x10000
    s_branch L2_xp3
L2_xa4:
    s_cmp_eq_u32 s101, 1
    s_cbranch_scc1 L2_xc4
    v_lshlrev_b32 v89, 0, v96
    v_add_u32 v90, 140, v97
    v_bitop3_b32 v90, v89, v45, v90 bitop3:0x6a
    ds_write_b32 v98, v90 offset:28
    v_lshlrev_b32 v89, 4, v96
    v_add_u32 v90, 120, v97
    v_bitop3_b32 v90, v89, v45, v90 bitop3:0x6a
    ds_write_b32 v98, v90 offset:24
    v_lshlrev_b32 v89, 8, v96
    v_add_u32 v90, 100, v97
    v_bitop3_b32 v90, v89, v45, v90 bitop3:0x6a
    ds_write_b32 v98, v90 offset:20
L2_xc4:
    v_lshlrev_b32 v89, 12, v96
    v_add_u32 v90, 80, v97
    v_bitop3_b32 v90, v89, v45, v90 bitop3:0x6a
    ds_write_b32 v98, v90 offset:16
    s_branch L2_xb4
L2_xe4:
    v_cmp_lt_u32 vcc, 32, v99
    v_cmp_lt_u32 s[58:59], 31, v88
    v_lshrrev_b32 v89, 16, v96
    v_add_u32 v97, 80, v97
    s_or_b64 vcc, vcc, s[58:59]
    s_cbranch_scc1 L2_xs4
    v_lshlrev_b32 v89, v1, v89
    v_and_b32 v89, v45, v89
    v_cmp_ne_u32 vcc, 0, v89
    v_xor_b32 v90, v97, v89
    s_add_u32 s3, s37, s38
    v_mbcnt_lo_u32_b32 v98, vcc_lo, 0
    v_mbcnt_hi_u32_b32 v98, vcc_hi, v98
    s_bcnt1_i32_b64 s41, vcc
    v_lshl_add_u32 v98, v98, 2, s3
    s_lshl2_add_u32 s37, s41, s37
    s_mov_b64 exec, vcc
    ds_write_b32 v98, v90
    s_mov_b64 exec, -1
    s_branch L2_xr4
L2_xf4:
    s_waitcnt lgkmcnt(0)
    s_cmp_gt_u32 s37, 1024
    s_cbranch_scc1 L2_xs4
    s_cmp_lt_u32 s37, 768
    s_cbranch_scc1 L2_xl4
    ds_read_b32 v32, v98 offset:896
    s_add_u32 s3, s42, 0
    s_bitset1_b32 s43, s3
    s_branch L2_xg4
L2_xl4:
    v_mov_b32 v42, -1
    s_cmp_ge_u32 s37, 512
    s_cbranch_scc1 L2_xg4
    v_mov_b32 v43, -1
    s_cmp_ge_u32 s37, 256
    s_cbranch_scc1 L2_xg4
    v_mov_b32 v41, -1
    s_branch L2_xg4
L2_xs4:
    s_waitcnt lgkmcnt(0)
    v_mov_b32 v40, -1
    v_mov_b32 v41, -1
    v_mov_b32 v43, -1
    v_mov_b32 v42, -1
    s_add_u32 s3, s42, 0
    s_bitset1_b32 s36, s3
    s_branch L2_xg4
L2_xo5:
    v_cmp_lt_u32 vcc, 20, v99
    s_mov_b32 s101, 1
    s_cbranch_vccz L2_xp5
    v_cmp_lt_u32 vcc, 32, v99
    v_cmp_lt_u32 s[58:59], 31, v88
    s_mov_b32 s101, 2
    s_or_b64 vcc, vcc, s[58:59]
    s_cbranch_scc0 L2_xp5
    s_mov_b32 s37, 0x10000
    s_branch L2_xp5
L2_xa6:
    s_cmp_eq_u32 s101, 1
    s_cbranch_scc1 L2_xc6
    v_lshlrev_b32 v89, 0, v96
    v_add_u32 v90, 140, v97
    v_bitop3_b32 v90, v89, v45, v90 bitop3:0x6a
    ds_write_b32 v98, v90 offset:28
    v_lshlrev_b32 v89, 4, v96
    v_add_u32 v90, 120, v97
    v_bitop3_b32 v90, v89, v45, v90 bitop3:0x6a
    ds_write_b32 v98, v90 offset:24
    v_lshlrev_b32 v89, 8, v96
    v_add_u32 v90, 100, v97
    v_bitop3_b32 v90, v89, v45, v90 bitop3:0x6a
    ds_write_b32 v98, v90 offset:20
L2_xc6:
    v_lshlrev_b32 v89, 12, v96
    v_add_u32 v90, 80, v97
    v_bitop3_b32 v90, v89, v45, v90 bitop3:0x6a
    ds_write_b32 v98, v90 offset:16
    s_branch L2_xb6
L2_xe6:
    v_cmp_lt_u32 vcc, 32, v99
    v_cmp_lt_u32 s[58:59], 31, v88
    v_lshrrev_b32 v89, 16, v96
    v_add_u32 v97, 80, v97
    s_or_b64 vcc, vcc, s[58:59]
    s_cbranch_scc1 L2_xs6
    v_lshlrev_b32 v89, v1, v89
    v_and_b32 v89, v45, v89
    v_cmp_ne_u32 vcc, 0, v89
    v_xor_b32 v90, v97, v89
    s_add_u32 s3, s37, s38
    v_mbcnt_lo_u32_b32 v98, vcc_lo, 0
    v_mbcnt_hi_u32_b32 v98, vcc_hi, v98
    s_bcnt1_i32_b64 s41, vcc
    v_lshl_add_u32 v98, v98, 2, s3
    s_lshl2_add_u32 s37, s41, s37
    s_mov_b64 exec, vcc
    ds_write_b32 v98, v90
    s_mov_b64 exec, -1
    s_branch L2_xr6
L2_xf6:
    s_waitcnt lgkmcnt(0)
    s_cmp_gt_u32 s37, 1024
    s_cbranch_scc1 L2_xs6
    s_cmp_lt_u32 s37, 768
    s_cbranch_scc1 L2_xl6
    ds_read_b32 v33, v98 offset:896
    s_add_u32 s3, s42, 1
    s_bitset1_b32 s43, s3
    s_branch L2_xg6
L2_xl6:
    v_mov_b32 v42, -1
    s_cmp_ge_u32 s37, 512
    s_cbranch_scc1 L2_xg6
    v_mov_b32 v43, -1
    s_cmp_ge_u32 s37, 256
    s_cbranch_scc1 L2_xg6
    v_mov_b32 v41, -1
    s_branch L2_xg6
L2_xs6:
    s_waitcnt lgkmcnt(0)
    v_mov_b32 v40, -1
    v_mov_b32 v41, -1
    v_mov_b32 v43, -1
    v_mov_b32 v42, -1
    s_add_u32 s3, s42, 1
    s_bitset1_b32 s36, s3
    s_branch L2_xg6
L2_p2s:
    s_sleep 8
    s_branch L2_p2
L2_oa7:
    v_and_b32 v47, 0x0fffffff, v32
    buffer_load_dword v78, v47, s[8:11], 0 offen offset:16
    s_mov_b64 exec, s[6:7]
    v_add_u32 v47, 8, v47
    v_lshrrev_b32 v32, 2, v32
    s_mov_b64 exec, -1
    buffer_load_dwordx2 v[76:77], v47, s[8:11], 0 offen
    s_branch L2_ob7
L2_oa8:
    s_waitcnt vmcnt(0)
    s_mov_b64 exec, s[6:7]
    v_lshrrev_b32 v78, 16, v78
    s_mov_b64 exec, -1
    v_and_b32 v46, 0x10000000, v32
    v_cmpx_eq_u32 vcc, 0, v46
    v_lshrrev_b32 v47, 14, v76
    v_and_b32 v47, v5, v47
    ds_read_b64 v[96:97], v47
    v_perm_b32 v98, v76, v78, s44
    v_bitop3_b32 v99, v76, 0.5, -0.5 bitop3:0xa8
    v_bitop3_b32 v98, v6, v98, v99 bitop3:0xca
    v_and_b32 v47, v5, v76
    s_waitcnt lgkmcnt(0)
    v_mfma_f32_4x4x4_16b_bf16 v[88:91], v[8:9], v[96:97], 0
    s_nop 4
    v_mul_f32 v88, v98, v88
    v_mul_f32 v89, v98, v89
    v_mul_f32 v90, v98, v90
    v_mul_f32 v91, v98, v91
    v_cvt_pk_bf16_f32 v88, v88, v89
    v_cvt_pk_bf16_f32 v89, v90, v91
    ds_pk_add_bf16 v47, v88 offset:65408
    ds_pk_add_bf16 v47, v89 offset:65412
    s_mov_b64 exec, -1
    v_and_b32 v46, 0x20000000, v32
    v_cmpx_eq_u32 vcc, 0, v46
    v_lshrrev_b32 v47, 14, v77
    v_and_b32 v47, v5, v47
    ds_read_b64 v[96:97], v47
    v_perm_b32 v98, v77, v78, s45
    v_bitop3_b32 v99, v77, 0.5, -0.5 bitop3:0xa8
    v_bitop3_b32 v98, v6, v98, v99 bitop3:0xca
    v_and_b32 v47, v5, v77
    s_waitcnt lgkmcnt(0)
    v_mfma_f32_4x4x4_16b_bf16 v[88:91], v[8:9], v[96:97], 0
    s_nop 4
    v_mul_f32 v88, v98, v88
    v_mul_f32 v89, v98, v89
    v_mul_f32 v90, v98, v90
    v_mul_f32 v91, v98, v91
    v_cvt_pk_bf16_f32 v88, v88, v89
    v_cvt_pk_bf16_f32 v89, v90, v91
    ds_pk_add_bf16 v47, v88 offset:65408
    ds_pk_add_bf16 v47, v89 offset:65412
    s_mov_b64 exec, -1
    s_branch L2_ob8
L2_c9:
    s_lshl_b64 s[52:53], s[82:83], 1
    s_andn2_b64 s[52:53], s[52:53], s[80:81]
    s_andn2_b64 s[52:53], s[52:53], s[54:55]
    s_or_b64 s[80:81], s[80:81], s[52:53]
    s_not_b64 vcc, s[52:53]
    s_mov_b64 exec, -1
    v_cndmask_b32_dpp v84, v84, v84, vcc wave_shr:1 row_mask:0xf bank_mask:0xf
    v_cndmask_b32_dpp v85, v85, v85, vcc wave_shr:1 row_mask:0xf bank_mask:0xf
    s_lshr_b64 s[52:53], s[52:53], 1
    v_cndmask_b32_dpp v86, v86, v86, vcc wave_shr:1 row_mask:0xf bank_mask:0xf
    v_cndmask_b32_dpp v87, v87, v87, vcc wave_shr:1 row_mask:0xf bank_mask:0xf
    s_andn2_b64 s[82:83], s[82:83], s[52:53]
    v_cndmask_b32_dpp v7, v7, v7, vcc wave_shr:1 row_mask:0xf bank_mask:0xf
    s_mov_b64 exec, s[54:55]
    s_cbranch_scc0 L2_d9
    s_mov_b64 exec, s[82:83]
    s_nop 1
    v_mfma_f32_4x4x4_16b_bf16 v[88:91], v[12:13], v[84:85], 0
    s_nop 1
    v_mfma_f32_4x4x4_16b_bf16 v[88:91], v[10:11], v[86:87], v[88:91]
    s_nop 4
    v_cvt_pk_bf16_f32 v88, v88, v89
    v_cvt_pk_bf16_f32 v89, v90, v91
    ds_pk_add_bf16 v7, v88 offset:65408
    ds_pk_add_bf16 v7, v89 offset:65412
    s_mov_b64 exec, s[54:55]
    s_branch L2_d9
L2_c10:
    s_lshl_b64 s[52:53], s[82:83], 1
    s_andn2_b64 s[52:53], s[52:53], s[80:81]
    s_andn2_b64 s[52:53], s[52:53], s[50:51]
    s_or_b64 s[80:81], s[80:81], s[52:53]
    s_not_b64 vcc, s[52:53]
    s_mov_b64 exec, -1
    v_cndmask_b32_dpp v84, v84, v84, vcc wave_shr:1 row_mask:0xf bank_mask:0xf
    v_cndmask_b32_dpp v85, v85, v85, vcc wave_shr:1 row_mask:0xf bank_mask:0xf
    s_lshr_b64 s[52:53], s[52:53], 1
    v_cndmask_b32_dpp v86, v86, v86, vcc wave_shr:1 row_mask:0xf bank_mask:0xf
    v_cndmask_b32_dpp v87, v87, v87, vcc wave_shr:1 row_mask:0xf bank_mask:0xf
    s_andn2_b64 s[82:83], s[82:83], s[52:53]
    v_cndmask_b32_dpp v7, v7, v7, vcc wave_shr:1 row_mask:0xf bank_mask:0xf
    s_mov_b64 exec, s[50:51]
    s_cbranch_scc0 L2_d10
    s_mov_b64 exec, s[82:83]
    s_nop 1
    v_mfma_f32_4x4x4_16b_bf16 v[88:91], v[12:13], v[84:85], 0
    s_nop 1
    v_mfma_f32_4x4x4_16b_bf16 v[88:91], v[10:11], v[86:87], v[88:91]
    s_nop 4
    v_cvt_pk_bf16_f32 v88, v88, v89
    v_cvt_pk_bf16_f32 v89, v90, v91
    ds_pk_add_bf16 v7, v88 offset:65408
    ds_pk_add_bf16 v7, v89 offset:65412
    s_mov_b64 exec, s[50:51]
    s_branch L2_d10
L2_c13:
    s_lshl_b64 s[52:53], s[82:83], 1
    s_andn2_b64 s[52:53], s[52:53], s[80:81]
    s_andn2_b64 s[52:53], s[52:53], s[54:55]
    s_or_b64 s[80:81], s[80:81], s[52:53]
    s_not_b64 vcc, s[52:53]
    s_mov_b64 exec, -1
    v_cndmask_b32_dpp v84, v84, v84, vcc wave_shr:1 row_mask:0xf bank_mask:0xf
    v_cndmask_b32_dpp v85, v85, v85, vcc wave_shr:1 row_mask:0xf bank_mask:0xf
    s_lshr_b64 s[52:53], s[52:53], 1
    v_cndmask_b32_dpp v86, v86, v86, vcc wave_shr:1 row_mask:0xf bank_mask:0xf
    v_cndmask_b32_dpp v87, v87, v87, vcc wave_shr:1 row_mask:0xf bank_mask:0xf
    s_andn2_b64 s[82:83], s[82:83], s[52:53]
    v_cndmask_b32_dpp v7, v7, v7, vcc wave_shr:1 row_mask:0xf bank_mask:0xf
    s_mov_b64 exec, s[54:55]
    s_cbranch_scc0 L2_d13
    s_mov_b64 exec, s[82:83]
    s_nop 1
    v_mfma_f32_4x4x4_16b_bf16 v[88:91], v[12:13], v[84:85], 0
    s_nop 1
    v_mfma_f32_4x4x4_16b_bf16 v[88:91], v[10:11], v[86:87], v[88:91]
    s_nop 4
    v_cvt_pk_bf16_f32 v88, v88, v89
    v_cvt_pk_bf16_f32 v89, v90, v91
    ds_pk_add_bf16 v7, v88 offset:65408
    ds_pk_add_bf16 v7, v89 offset:65412
    s_mov_b64 exec, s[54:55]
    s_branch L2_d13
L2_c14:
    s_lshl_b64 s[52:53], s[82:83], 1
    s_andn2_b64 s[52:53], s[52:53], s[80:81]
    s_andn2_b64 s[52:53], s[52:53], s[50:51]
    s_or_b64 s[80:81], s[80:81], s[52:53]
    s_not_b64 vcc, s[52:53]
    s_mov_b64 exec, -1
    v_cndmask_b32_dpp v84, v84, v84, vcc wave_shr:1 row_mask:0xf bank_mask:0xf
    v_cndmask_b32_dpp v85, v85, v85, vcc wave_shr:1 row_mask:0xf bank_mask:0xf
    s_lshr_b64 s[52:53], s[52:53], 1
    v_cndmask_b32_dpp v86, v86, v86, vcc wave_shr:1 row_mask:0xf bank_mask:0xf
    v_cndmask_b32_dpp v87, v87, v87, vcc wave_shr:1 row_mask:0xf bank_mask:0xf
    s_andn2_b64 s[82:83], s[82:83], s[52:53]
    v_cndmask_b32_dpp v7, v7, v7, vcc wave_shr:1 row_mask:0xf bank_mask:0xf
    s_mov_b64 exec, s[50:51]
    s_cbranch_scc0 L2_d14
    s_mov_b64 exec, s[82:83]
    s_nop 1
    v_mfma_f32_4x4x4_16b_bf16 v[88:91], v[12:13], v[84:85], 0
    s_nop 1
    v_mfma_f32_4x4x4_16b_bf16 v[88:91], v[10:11], v[86:87], v[88:91]
    s_nop 4
    v_cvt_pk_bf16_f32 v88, v88, v89
    v_cvt_pk_bf16_f32 v89, v90, v91
    ds_pk_add_bf16 v7, v88 offset:65408
    ds_pk_add_bf16 v7, v89 offset:65412
    s_mov_b64 exec, s[50:51]
    s_branch L2_d14
L2_xo16:
    v_cmp_lt_u32 vcc, 20, v99
    s_mov_b32 s101, 1
    s_cbranch_vccz L2_xp16
    v_cmp_lt_u32 vcc, 32, v99
    v_cmp_lt_u32 s[58:59], 31, v88
    s_mov_b32 s101, 2
    s_or_b64 vcc, vcc, s[58:59]
    s_cbranch_scc0 L2_xp16
    s_mov_b32 s37, 0x10000
    s_branch L2_xp16
L2_c17:
    s_lshl_b64 s[52:53], s[82:83], 1
    s_andn2_b64 s[52:53], s[52:53], s[80:81]
    s_andn2_b64 s[52:53], s[52:53], s[54:55]
    s_or_b64 s[80:81], s[80:81], s[52:53]
    s_not_b64 vcc, s[52:53]
    s_mov_b64 exec, -1
    v_cndmask_b32_dpp v84, v84, v84, vcc wave_shr:1 row_mask:0xf bank_mask:0xf
    v_cndmask_b32_dpp v85, v85, v85, vcc wave_shr:1 row_mask:0xf bank_mask:0xf
    s_lshr_b64 s[52:53], s[52:53], 1
    v_cndmask_b32_dpp v86, v86, v86, vcc wave_shr:1 row_mask:0xf bank_mask:0xf
    v_cndmask_b32_dpp v87, v87, v87, vcc wave_shr:1 row_mask:0xf bank_mask:0xf
    s_andn2_b64 s[82:83], s[82:83], s[52:53]
    v_cndmask_b32_dpp v7, v7, v7, vcc wave_shr:1 row_mask:0xf bank_mask:0xf
    s_mov_b64 exec, s[54:55]
    s_cbranch_scc0 L2_d17
    s_mov_b64 exec, s[82:83]
    s_nop 1
    v_mfma_f32_4x4x4_16b_bf16 v[88:91], v[12:13], v[84:85], 0
    s_nop 1
    v_mfma_f32_4x4x4_16b_bf16 v[88:91], v[10:11], v[86:87], v[88:91]
    s_nop 4
    v_cvt_pk_bf16_f32 v88, v88, v89
    v_cvt_pk_bf16_f32 v89, v90, v91
    ds_pk_add_bf16 v7, v88 offset:65408
    ds_pk_add_bf16 v7, v89 offset:65412
    s_mov_b64 exec, s[54:55]
    s_branch L2_d17
L2_c18:
    s_lshl_b64 s[52:53], s[82:83], 1
    s_andn2_b64 s[52:53], s[52:53], s[80:81]
    s_andn2_b64 s[52:53], s[52:53], s[50:51]
    s_or_b64 s[80:81], s[80:81], s[52:53]
    s_not_b64 vcc, s[52:53]
    s_mov_b64 exec, -1
    v_cndmask_b32_dpp v84, v84, v84, vcc wave_shr:1 row_mask:0xf bank_mask:0xf
    v_cndmask_b32_dpp v85, v85, v85, vcc wave_shr:1 row_mask:0xf bank_mask:0xf
    s_lshr_b64 s[52:53], s[52:53], 1
    v_cndmask_b32_dpp v86, v86, v86, vcc wave_shr:1 row_mask:0xf bank_mask:0xf
    v_cndmask_b32_dpp v87, v87, v87, vcc wave_shr:1 row_mask:0xf bank_mask:0xf
    s_andn2_b64 s[82:83], s[82:83], s[52:53]
    v_cndmask_b32_dpp v7, v7, v7, vcc wave_shr:1 row_mask:0xf bank_mask:0xf
    s_mov_b64 exec, s[50:51]
    s_cbranch_scc0 L2_d18
    s_mov_b64 exec, s[82:83]
    s_nop 1
    v_mfma_f32_4x4x4_16b_bf16 v[88:91], v[12:13], v[84:85], 0
    s_nop 1
    v_mfma_f32_4x4x4_16b_bf16 v[88:91], v[10:11], v[86:87], v[88:91]
    s_nop 4
    v_cvt_pk_bf16_f32 v88, v88, v89
    v_cvt_pk_bf16_f32 v89, v90, v91
    ds_pk_add_bf16 v7, v88 offset:65408
    ds_pk_add_bf16 v7, v89 offset:65412
    s_mov_b64 exec, s[50:51]
    s_branch L2_d18
L2_c21:
    s_lshl_b64 s[52:53], s[82:83], 1
    s_andn2_b64 s[52:53], s[52:53], s[80:81]
    s_andn2_b64 s[52:53], s[52:53], s[54:55]
    s_or_b64 s[80:81], s[80:81], s[52:53]
    s_not_b64 vcc, s[52:53]
    s_mov_b64 exec, -1
    v_cndmask_b32_dpp v84, v84, v84, vcc wave_shr:1 row_mask:0xf bank_mask:0xf
    v_cndmask_b32_dpp v85, v85, v85, vcc wave_shr:1 row_mask:0xf bank_mask:0xf
    s_lshr_b64 s[52:53], s[52:53], 1
    v_cndmask_b32_dpp v86, v86, v86, vcc wave_shr:1 row_mask:0xf bank_mask:0xf
    v_cndmask_b32_dpp v87, v87, v87, vcc wave_shr:1 row_mask:0xf bank_mask:0xf
    s_andn2_b64 s[82:83], s[82:83], s[52:53]
    v_cndmask_b32_dpp v7, v7, v7, vcc wave_shr:1 row_mask:0xf bank_mask:0xf
    s_mov_b64 exec, s[54:55]
    s_cbranch_scc0 L2_d21
    s_mov_b64 exec, s[82:83]
    s_nop 1
    v_mfma_f32_4x4x4_16b_bf16 v[88:91], v[12:13], v[84:85], 0
    s_nop 1
    v_mfma_f32_4x4x4_16b_bf16 v[88:91], v[10:11], v[86:87], v[88:91]
    s_nop 4
    v_cvt_pk_bf16_f32 v88, v88, v89
    v_cvt_pk_bf16_f32 v89, v90, v91
    ds_pk_add_bf16 v7, v88 offset:65408
    ds_pk_add_bf16 v7, v89 offset:65412
    s_mov_b64 exec, s[54:55]
    s_branch L2_d21
L2_c22:
    s_lshl_b64 s[52:53], s[82:83], 1
    s_andn2_b64 s[52:53], s[52:53], s[80:81]
    s_andn2_b64 s[52:53], s[52:53], s[50:51]
    s_or_b64 s[80:81], s[80:81], s[52:53]
    s_not_b64 vcc, s[52:53]
    s_mov_b64 exec, -1
    v_cndmask_b32_dpp v84, v84, v84, vcc wave_shr:1 row_mask:0xf bank_mask:0xf
    v_cndmask_b32_dpp v85, v85, v85, vcc wave_shr:1 row_mask:0xf bank_mask:0xf
    s_lshr_b64 s[52:53], s[52:53], 1
    v_cndmask_b32_dpp v86, v86, v86, vcc wave_shr:1 row_mask:0xf bank_mask:0xf
    v_cndmask_b32_dpp v87, v87, v87, vcc wave_shr:1 row_mask:0xf bank_mask:0xf
    s_andn2_b64 s[82:83], s[82:83], s[52:53]
    v_cndmask_b32_dpp v7, v7, v7, vcc wave_shr:1 row_mask:0xf bank_mask:0xf
    s_mov_b64 exec, s[50:51]
    s_cbranch_scc0 L2_d22
    s_mov_b64 exec, s[82:83]
    s_nop 1
    v_mfma_f32_4x4x4_16b_bf16 v[88:91], v[12:13], v[84:85], 0
    s_nop 1
    v_mfma_f32_4x4x4_16b_bf16 v[88:91], v[10:11], v[86:87], v[88:91]
    s_nop 4
    v_cvt_pk_bf16_f32 v88, v88, v89
    v_cvt_pk_bf16_f32 v89, v90, v91
    ds_pk_add_bf16 v7, v88 offset:65408
    ds_pk_add_bf16 v7, v89 offset:65412
    s_mov_b64 exec, s[50:51]
    s_branch L2_d22
L2_c23:
    s_lshl_b64 s[52:53], s[82:83], 1
    s_andn2_b64 s[52:53], s[52:53], s[80:81]
    s_andn2_b64 s[52:53], s[52:53], s[54:55]
    s_or_b64 s[80:81], s[80:81], s[52:53]
    s_not_b64 vcc, s[52:53]
    s_mov_b64 exec, -1
    v_cndmask_b32_dpp v84, v84, v84, vcc wave_shr:1 row_mask:0xf bank_mask:0xf
    v_cndmask_b32_dpp v85, v85, v85, vcc wave_shr:1 row_mask:0xf bank_mask:0xf
    s_lshr_b64 s[52:53], s[52:53], 1
    v_cndmask_b32_dpp v86, v86, v86, vcc wave_shr:1 row_mask:0xf bank_mask:0xf
    v_cndmask_b32_dpp v87, v87, v87, vcc wave_shr:1 row_mask:0xf bank_mask:0xf
    s_andn2_b64 s[82:83], s[82:83], s[52:53]
    v_cndmask_b32_dpp v7, v7, v7, vcc wave_shr:1 row_mask:0xf bank_mask:0xf
    s_mov_b64 exec, s[54:55]
    s_cbranch_scc0 L2_d23
    s_mov_b64 exec, s[82:83]
    s_nop 1
    v_mfma_f32_4x4x4_16b_bf16 v[88:91], v[12:13], v[84:85], 0
    s_nop 1
    v_mfma_f32_4x4x4_16b_bf16 v[88:91], v[10:11], v[86:87], v[88:91]
    s_nop 4
    v_cvt_pk_bf16_f32 v88, v88, v89
    v_cvt_pk_bf16_f32 v89, v90, v91
    ds_pk_add_bf16 v7, v88 offset:65408
    ds_pk_add_bf16 v7, v89 offset:65412
    s_mov_b64 exec, s[54:55]
    s_branch L2_d23
L2_c24:
    s_lshl_b64 s[52:53], s[82:83], 1
    s_andn2_b64 s[52:53], s[52:53], s[80:81]
    s_andn2_b64 s[52:53], s[52:53], s[50:51]
    s_or_b64 s[80:81], s[80:81], s[52:53]
    s_not_b64 vcc, s[52:53]
    s_mov_b64 exec, -1
    v_cndmask_b32_dpp v84, v84, v84, vcc wave_shr:1 row_mask:0xf bank_mask:0xf
    v_cndmask_b32_dpp v85, v85, v85, vcc wave_shr:1 row_mask:0xf bank_mask:0xf
    s_lshr_b64 s[52:53], s[52:53], 1
    v_cndmask_b32_dpp v86, v86, v86, vcc wave_shr:1 row_mask:0xf bank_mask:0xf
    v_cndmask_b32_dpp v87, v87, v87, vcc wave_shr:1 row_mask:0xf bank_mask:0xf
    s_andn2_b64 s[82:83], s[82:83], s[52:53]
    v_cndmask_b32_dpp v7, v7, v7, vcc wave_shr:1 row_mask:0xf bank_mask:0xf
    s_mov_b64 exec, s[50:51]
    s_cbranch_scc0 L2_d24
    s_mov_b64 exec, s[82:83]
    s_nop 1
    v_mfma_f32_4x4x4_16b_bf16 v[88:91], v[12:13], v[84:85], 0
    s_nop 1
    v_mfma_f32_4x4x4_16b_bf16 v[88:91], v[10:11], v[86:87], v[88:91]
    s_nop 4
    v_cvt_pk_bf16_f32 v88, v88, v89
    v_cvt_pk_bf16_f32 v89, v90, v91
    ds_pk_add_bf16 v7, v88 offset:65408
    ds_pk_add_bf16 v7, v89 offset:65412
    s_mov_b64 exec, s[50:51]
    s_branch L2_d24
L2_xa25:
    s_cmp_eq_u32 s101, 1
    s_cbranch_scc1 L2_xc25
    v_lshlrev_b32 v89, 0, v96
    v_add_u32 v90, 140, v97
    v_bitop3_b32 v90, v89, v45, v90 bitop3:0x6a
    ds_write_b32 v98, v90 offset:28
    v_lshlrev_b32 v89, 4, v96
    v_add_u32 v90, 120, v97
    v_bitop3_b32 v90, v89, v45, v90 bitop3:0x6a
    ds_write_b32 v98, v90 offset:24
    v_lshlrev_b32 v89, 8, v96
    v_add_u32 v90, 100, v97
    v_bitop3_b32 v90, v89, v45, v90 bitop3:0x6a
    ds_write_b32 v98, v90 offset:20
L2_xc25:
    v_lshlrev_b32 v89, 12, v96
    v_add_u32 v90, 80, v97
    v_bitop3_b32 v90, v89, v45, v90 bitop3:0x6a
    ds_write_b32 v98, v90 offset:16
    s_branch L2_xb25
L2_xe25:
    v_cmp_lt_u32 vcc, 32, v99
    v_cmp_lt_u32 s[58:59], 31, v88
    v_lshrrev_b32 v89, 16, v96
    v_add_u32 v97, 80, v97
    s_or_b64 vcc, vcc, s[58:59]
    s_cbranch_scc1 L2_xs25
    v_lshlrev_b32 v89, v1, v89
    v_and_b32 v89, v45, v89
    v_cmp_ne_u32 vcc, 0, v89
    v_xor_b32 v90, v97, v89
    s_add_u32 s3, s37, s38
    v_mbcnt_lo_u32_b32 v98, vcc_lo, 0
    v_mbcnt_hi_u32_b32 v98, vcc_hi, v98
    s_bcnt1_i32_b64 s41, vcc
    v_lshl_add_u32 v98, v98, 2, s3
    s_lshl2_add_u32 s37, s41, s37
    s_mov_b64 exec, vcc
    ds_write_b32 v98, v90
    s_mov_b64 exec, -1
    s_branch L2_xr25
L2_xf25:
    s_waitcnt lgkmcnt(0)
    s_cmp_gt_u32 s37, 1024
    s_cbranch_scc1 L2_xs25
    s_cmp_lt_u32 s37, 768
    s_cbranch_scc1 L2_xl25
    ds_read_b32 v32, v98 offset:896
    s_add_u32 s3, s42, 2
    s_bitset1_b32 s43, s3
    s_branch L2_xg25
L2_xl25:
    v_mov_b32 v42, -1
    s_cmp_ge_u32 s37, 512
    s_cbranch_scc1 L2_xg25
    v_mov_b32 v43, -1
    s_cmp_ge_u32 s37, 256
    s_cbranch_scc1 L2_xg25
    v_mov_b32 v41, -1
    s_branch L2_xg25
L2_xs25:
    s_waitcnt lgkmcnt(0)
    v_mov_b32 v40, -1
    v_mov_b32 v41, -1
    v_mov_b32 v43, -1
    v_mov_b32 v42, -1
    s_add_u32 s3, s42, 2
    s_bitset1_b32 s36, s3
    s_branch L2_xg25
L2_c26:
    s_lshl_b64 s[52:53], s[82:83], 1
    s_andn2_b64 s[52:53], s[52:53], s[80:81]
    s_andn2_b64 s[52:53], s[52:53], s[54:55]
    s_or_b64 s[80:81], s[80:81], s[52:53]
    s_not_b64 vcc, s[52:53]
    s_mov_b64 exec, -1
    v_cndmask_b32_dpp v84, v84, v84, vcc wave_shr:1 row_mask:0xf bank_mask:0xf
    v_cndmask_b32_dpp v85, v85, v85, vcc wave_shr:1 row_mask:0xf bank_mask:0xf
    s_lshr_b64 s[52:53], s[52:53], 1
    v_cndmask_b32_dpp v86, v86, v86, vcc wave_shr:1 row_mask:0xf bank_mask:0xf
    v_cndmask_b32_dpp v87, v87, v87, vcc wave_shr:1 row_mask:0xf bank_mask:0xf
    s_andn2_b64 s[82:83], s[82:83], s[52:53]
    v_cndmask_b32_dpp v7, v7, v7, vcc wave_shr:1 row_mask:0xf bank_mask:0xf
    s_mov_b64 exec, s[54:55]
    s_cbranch_scc0 L2_d26
    s_mov_b64 exec, s[82:83]
    s_nop 1
    v_mfma_f32_4x4x4_16b_bf16 v[88:91], v[12:13], v[84:85], 0
    s_nop 1
    v_mfma_f32_4x4x4_16b_bf16 v[88:91], v[10:11], v[86:87], v[88:91]
    s_nop 4
    v_cvt_pk_bf16_f32 v88, v88, v89
    v_cvt_pk_bf16_f32 v89, v90, v91
    ds_pk_add_bf16 v7, v88 offset:65408
    ds_pk_add_bf16 v7, v89 offset:65412
    s_mov_b64 exec, s[54:55]
    s_branch L2_d26
L2_c27:
    s_lshl_b64 s[52:53], s[82:83], 1
    s_andn2_b64 s[52:53], s[52:53], s[80:81]
    s_andn2_b64 s[52:53], s[52:53], s[50:51]
    s_or_b64 s[80:81], s[80:81], s[52:53]
    s_not_b64 vcc, s[52:53]
    s_mov_b64 exec, -1
    v_cndmask_b32_dpp v84, v84, v84, vcc wave_shr:1 row_mask:0xf bank_mask:0xf
    v_cndmask_b32_dpp v85, v85, v85, vcc wave_shr:1 row_mask:0xf bank_mask:0xf
    s_lshr_b64 s[52:53], s[52:53], 1
    v_cndmask_b32_dpp v86, v86, v86, vcc wave_shr:1 row_mask:0xf bank_mask:0xf
    v_cndmask_b32_dpp v87, v87, v87, vcc wave_shr:1 row_mask:0xf bank_mask:0xf
    s_andn2_b64 s[82:83], s[82:83], s[52:53]
    v_cndmask_b32_dpp v7, v7, v7, vcc wave_shr:1 row_mask:0xf bank_mask:0xf
    s_mov_b64 exec, s[50:51]
    s_cbranch_scc0 L2_d27
    s_mov_b64 exec, s[82:83]
    s_nop 1
    v_mfma_f32_4x4x4_16b_bf16 v[88:91], v[12:13], v[84:85], 0
    s_nop 1
    v_mfma_f32_4x4x4_16b_bf16 v[88:91], v[10:11], v[86:87], v[88:91]
    s_nop 4
    v_cvt_pk_bf16_f32 v88, v88, v89
    v_cvt_pk_bf16_f32 v89, v90, v91
    ds_pk_add_bf16 v7, v88 offset:65408
    ds_pk_add_bf16 v7, v89 offset:65412
    s_mov_b64 exec, s[50:51]
    s_branch L2_d27
L2_oa28:
    v_and_b32 v47, 0x0fffffff, v33
    buffer_load_dword v114, v47, s[8:11], 0 offen offset:16
    s_mov_b64 exec, s[6:7]
    v_add_u32 v47, 8, v47
    v_lshrrev_b32 v33, 2, v33
    s_mov_b64 exec, -1
    buffer_load_dwordx2 v[112:113], v47, s[8:11], 0 offen
    s_branch L2_ob28
L2_c29:
    s_lshl_b64 s[52:53], s[82:83], 1
    s_andn2_b64 s[52:53], s[52:53], s[80:81]
    s_andn2_b64 s[52:53], s[52:53], s[54:55]
    s_or_b64 s[80:81], s[80:81], s[52:53]
    s_not_b64 vcc, s[52:53]
    s_mov_b64 exec, -1
    v_cndmask_b32_dpp v84, v84, v84, vcc wave_shr:1 row_mask:0xf bank_mask:0xf
    v_cndmask_b32_dpp v85, v85, v85, vcc wave_shr:1 row_mask:0xf bank_mask:0xf
    s_lshr_b64 s[52:53], s[52:53], 1
    v_cndmask_b32_dpp v86, v86, v86, vcc wave_shr:1 row_mask:0xf bank_mask:0xf
    v_cndmask_b32_dpp v87, v87, v87, vcc wave_shr:1 row_mask:0xf bank_mask:0xf
    s_andn2_b64 s[82:83], s[82:83], s[52:53]
    v_cndmask_b32_dpp v7, v7, v7, vcc wave_shr:1 row_mask:0xf bank_mask:0xf
    s_mov_b64 exec, s[54:55]
    s_cbranch_scc0 L2_d29
    s_mov_b64 exec, s[82:83]
    s_nop 1
    v_mfma_f32_4x4x4_16b_bf16 v[88:91], v[12:13], v[84:85], 0
    s_nop 1
    v_mfma_f32_4x4x4_16b_bf16 v[88:91], v[10:11], v[86:87], v[88:91]
    s_nop 4
    v_cvt_pk_bf16_f32 v88, v88, v89
    v_cvt_pk_bf16_f32 v89, v90, v91
    ds_pk_add_bf16 v7, v88 offset:65408
    ds_pk_add_bf16 v7, v89 offset:65412
    s_mov_b64 exec, s[54:55]
    s_branch L2_d29
L2_c30:
    s_lshl_b64 s[52:53], s[82:83], 1
    s_andn2_b64 s[52:53], s[52:53], s[80:81]
    s_andn2_b64 s[52:53], s[52:53], s[50:51]
    s_or_b64 s[80:81], s[80:81], s[52:53]
    s_not_b64 vcc, s[52:53]
    s_mov_b64 exec, -1
    v_cndmask_b32_dpp v84, v84, v84, vcc wave_shr:1 row_mask:0xf bank_mask:0xf
    v_cndmask_b32_dpp v85, v85, v85, vcc wave_shr:1 row_mask:0xf bank_mask:0xf
    s_lshr_b64 s[52:53], s[52:53], 1
    v_cndmask_b32_dpp v86, v86, v86, vcc wave_shr:1 row_mask:0xf bank_mask:0xf
    v_cndmask_b32_dpp v87, v87, v87, vcc wave_shr:1 row_mask:0xf bank_mask:0xf
    s_andn2_b64 s[82:83], s[82:83], s[52:53]
    v_cndmask_b32_dpp v7, v7, v7, vcc wave_shr:1 row_mask:0xf bank_mask:0xf
    s_mov_b64 exec, s[50:51]
    s_cbranch_scc0 L2_d30
    s_mov_b64 exec, s[82:83]
    s_nop 1
    v_mfma_f32_4x4x4_16b_bf16 v[88:91], v[12:13], v[84:85], 0
    s_nop 1
    v_mfma_f32_4x4x4_16b_bf16 v[88:91], v[10:11], v[86:87], v[88:91]
    s_nop 4
    v_cvt_pk_bf16_f32 v88, v88, v89
    v_cvt_pk_bf16_f32 v89, v90, v91
    ds_pk_add_bf16 v7, v88 offset:65408
    ds_pk_add_bf16 v7, v89 offset:65412
    s_mov_b64 exec, s[50:51]
    s_branch L2_d30
L2_c31:
    s_lshl_b64 s[52:53], s[82:83], 1
    s_andn2_b64 s[52:53], s[52:53], s[80:81]
    s_andn2_b64 s[52:53], s[52:53], s[54:55]
    s_or_b64 s[80:81], s[80:81], s[52:53]
    s_not_b64 vcc, s[52:53]
    s_mov_b64 exec, -1
    v_cndmask_b32_dpp v84, v84, v84, vcc wave_shr:1 row_mask:0xf bank_mask:0xf
    v_cndmask_b32_dpp v85, v85, v85, vcc wave_shr:1 row_mask:0xf bank_mask:0xf
    s_lshr_b64 s[52:53], s[52:53], 1
    v_cndmask_b32_dpp v86, v86, v86, vcc wave_shr:1 row_mask:0xf bank_mask:0xf
    v_cndmask_b32_dpp v87, v87, v87, vcc wave_shr:1 row_mask:0xf bank_mask:0xf
    s_andn2_b64 s[82:83], s[82:83], s[52:53]
    v_cndmask_b32_dpp v7, v7, v7, vcc wave_shr:1 row_mask:0xf bank_mask:0xf
    s_mov_b64 exec, s[54:55]
    s_cbranch_scc0 L2_d31
    s_mov_b64 exec, s[82:83]
    s_nop 1
    v_mfma_f32_4x4x4_16b_bf16 v[88:91], v[12:13], v[84:85], 0
    s_nop 1
    v_mfma_f32_4x4x4_16b_bf16 v[88:91], v[10:11], v[86:87], v[88:91]
    s_nop 4
    v_cvt_pk_bf16_f32 v88, v88, v89
    v_cvt_pk_bf16_f32 v89, v90, v91
    ds_pk_add_bf16 v7, v88 offset:65408
    ds_pk_add_bf16 v7, v89 offset:65412
    s_mov_b64 exec, s[54:55]
    s_branch L2_d31
L2_c32:
    s_lshl_b64 s[52:53], s[82:83], 1
    s_andn2_b64 s[52:53], s[52:53], s[80:81]
    s_andn2_b64 s[52:53], s[52:53], s[50:51]
    s_or_b64 s[80:81], s[80:81], s[52:53]
    s_not_b64 vcc, s[52:53]
    s_mov_b64 exec, -1
    v_cndmask_b32_dpp v84, v84, v84, vcc wave_shr:1 row_mask:0xf bank_mask:0xf
    v_cndmask_b32_dpp v85, v85, v85, vcc wave_shr:1 row_mask:0xf bank_mask:0xf
    s_lshr_b64 s[52:53], s[52:53], 1
    v_cndmask_b32_dpp v86, v86, v86, vcc wave_shr:1 row_mask:0xf bank_mask:0xf
    v_cndmask_b32_dpp v87, v87, v87, vcc wave_shr:1 row_mask:0xf bank_mask:0xf
    s_andn2_b64 s[82:83], s[82:83], s[52:53]
    v_cndmask_b32_dpp v7, v7, v7, vcc wave_shr:1 row_mask:0xf bank_mask:0xf
    s_mov_b64 exec, s[50:51]
    s_cbranch_scc0 L2_d32
    s_mov_b64 exec, s[82:83]
    s_nop 1
    v_mfma_f32_4x4x4_16b_bf16 v[88:91], v[12:13], v[84:85], 0
    s_nop 1
    v_mfma_f32_4x4x4_16b_bf16 v[88:91], v[10:11], v[86:87], v[88:91]
    s_nop 4
    v_cvt_pk_bf16_f32 v88, v88, v89
    v_cvt_pk_bf16_f32 v89, v90, v91
    ds_pk_add_bf16 v7, v88 offset:65408
    ds_pk_add_bf16 v7, v89 offset:65412
    s_mov_b64 exec, s[50:51]
    s_branch L2_d32
L2_c33:
    s_lshl_b64 s[52:53], s[82:83], 1
    s_andn2_b64 s[52:53], s[52:53], s[80:81]
    s_andn2_b64 s[52:53], s[52:53], s[54:55]
    s_or_b64 s[80:81], s[80:81], s[52:53]
    s_not_b64 vcc, s[52:53]
    s_mov_b64 exec, -1
    v_cndmask_b32_dpp v84, v84, v84, vcc wave_shr:1 row_mask:0xf bank_mask:0xf
    v_cndmask_b32_dpp v85, v85, v85, vcc wave_shr:1 row_mask:0xf bank_mask:0xf
    s_lshr_b64 s[52:53], s[52:53], 1
    v_cndmask_b32_dpp v86, v86, v86, vcc wave_shr:1 row_mask:0xf bank_mask:0xf
    v_cndmask_b32_dpp v87, v87, v87, vcc wave_shr:1 row_mask:0xf bank_mask:0xf
    s_andn2_b64 s[82:83], s[82:83], s[52:53]
    v_cndmask_b32_dpp v7, v7, v7, vcc wave_shr:1 row_mask:0xf bank_mask:0xf
    s_mov_b64 exec, s[54:55]
    s_cbranch_scc0 L2_d33
    s_mov_b64 exec, s[82:83]
    s_nop 1
    v_mfma_f32_4x4x4_16b_bf16 v[88:91], v[12:13], v[84:85], 0
    s_nop 1
    v_mfma_f32_4x4x4_16b_bf16 v[88:91], v[10:11], v[86:87], v[88:91]
    s_nop 4
    v_cvt_pk_bf16_f32 v88, v88, v89
    v_cvt_pk_bf16_f32 v89, v90, v91
    ds_pk_add_bf16 v7, v88 offset:65408
    ds_pk_add_bf16 v7, v89 offset:65412
    s_mov_b64 exec, s[54:55]
    s_branch L2_d33
L2_c34:
    s_lshl_b64 s[52:53], s[82:83], 1
    s_andn2_b64 s[52:53], s[52:53], s[80:81]
    s_andn2_b64 s[52:53], s[52:53], s[50:51]
    s_or_b64 s[80:81], s[80:81], s[52:53]
    s_not_b64 vcc, s[52:53]
    s_mov_b64 exec, -1
    v_cndmask_b32_dpp v84, v84, v84, vcc wave_shr:1 row_mask:0xf bank_mask:0xf
    v_cndmask_b32_dpp v85, v85, v85, vcc wave_shr:1 row_mask:0xf bank_mask:0xf
    s_lshr_b64 s[52:53], s[52:53], 1
    v_cndmask_b32_dpp v86, v86, v86, vcc wave_shr:1 row_mask:0xf bank_mask:0xf
    v_cndmask_b32_dpp v87, v87, v87, vcc wave_shr:1 row_mask:0xf bank_mask:0xf
    s_andn2_b64 s[82:83], s[82:83], s[52:53]
    v_cndmask_b32_dpp v7, v7, v7, vcc wave_shr:1 row_mask:0xf bank_mask:0xf
    s_mov_b64 exec, s[50:51]
    s_cbranch_scc0 L2_d34
    s_mov_b64 exec, s[82:83]
    s_nop 1
    v_mfma_f32_4x4x4_16b_bf16 v[88:91], v[12:13], v[84:85], 0
    s_nop 1
    v_mfma_f32_4x4x4_16b_bf16 v[88:91], v[10:11], v[86:87], v[88:91]
    s_nop 4
    v_cvt_pk_bf16_f32 v88, v88, v89
    v_cvt_pk_bf16_f32 v89, v90, v91
    ds_pk_add_bf16 v7, v88 offset:65408
    ds_pk_add_bf16 v7, v89 offset:65412
    s_mov_b64 exec, s[50:51]
    s_branch L2_d34
L2_oa35:
    s_waitcnt vmcnt(5)
    s_mov_b64 exec, s[6:7]
    v_lshrrev_b32 v114, 16, v114
    s_mov_b64 exec, -1
    v_and_b32 v46, 0x10000000, v33
    v_cmpx_eq_u32 vcc, 0, v46
    v_lshrrev_b32 v47, 14, v112
    v_and_b32 v47, v5, v47
    ds_read_b64 v[96:97], v47
    v_perm_b32 v98, v112, v114, s44
    v_bitop3_b32 v99, v112, 0.5, -0.5 bitop3:0xa8
    v_bitop3_b32 v98, v6, v98, v99 bitop3:0xca
    v_and_b32 v47, v5, v112
    s_waitcnt lgkmcnt(0)
    v_mfma_f32_4x4x4_16b_bf16 v[88:91], v[8:9], v[96:97], 0
    s_nop 4
    v_mul_f32 v88, v98, v88
    v_mul_f32 v89, v98, v89
    v_mul_f32 v90, v98, v90
    v_mul_f32 v91, v98, v91
    v_cvt_pk_bf16_f32 v88, v88, v89
    v_cvt_pk_bf16_f32 v89, v90, v91
    ds_pk_add_bf16 v47, v88 offset:65408
    ds_pk_add_bf16 v47, v89 offset:65412
    s_mov_b64 exec, -1
    v_and_b32 v46, 0x20000000, v33
    v_cmpx_eq_u32 vcc, 0, v46
    v_lshrrev_b32 v47, 14, v113
    v_and_b32 v47, v5, v47
    ds_read_b64 v[96:97], v47
    v_perm_b32 v98, v113, v114, s45
    v_bitop3_b32 v99, v113, 0.5, -0.5 bitop3:0xa8
    v_bitop3_b32 v98, v6, v98, v99 bitop3:0xca
    v_and_b32 v47, v5, v113
    s_waitcnt lgkmcnt(0)
    v_mfma_f32_4x4x4_16b_bf16 v[88:91], v[8:9], v[96:97], 0
    s_nop 4
    v_mul_f32 v88, v98, v88
    v_mul_f32 v89, v98, v89
    v_mul_f32 v90, v98, v90
    v_mul_f32 v91, v98, v91
    v_cvt_pk_bf16_f32 v88, v88, v89
    v_cvt_pk_bf16_f32 v89, v90, v91
    ds_pk_add_bf16 v47, v88 offset:65408
    ds_pk_add_bf16 v47, v89 offset:65412
    s_mov_b64 exec, -1
    s_branch L2_ob35
L2_xo36:
    v_cmp_lt_u32 vcc, 20, v99
    s_mov_b32 s101, 1
    s_cbranch_vccz L2_xp36
    v_cmp_lt_u32 vcc, 32, v99
    v_cmp_lt_u32 s[58:59], 31, v88
    s_mov_b32 s101, 2
    s_or_b64 vcc, vcc, s[58:59]
    s_cbranch_scc0 L2_xp36
    s_mov_b32 s37, 0x10000
    s_branch L2_xp36
L2_c37:
    s_lshl_b64 s[52:53], s[82:83], 1
    s_andn2_b64 s[52:53], s[52:53], s[80:81]
    s_andn2_b64 s[52:53], s[52:53], s[54:55]
    s_or_b64 s[80:81], s[80:81], s[52:53]
    s_not_b64 vcc, s[52:53]
    s_mov_b64 exec, -1
    v_cndmask_b32_dpp v84, v84, v84, vcc wave_shr:1 row_mask:0xf bank_mask:0xf
    v_cndmask_b32_dpp v85, v85, v85, vcc wave_shr:1 row_mask:0xf bank_mask:0xf
    s_lshr_b64 s[52:53], s[52:53], 1
    v_cndmask_b32_dpp v86, v86, v86, vcc wave_shr:1 row_mask:0xf bank_mask:0xf
    v_cndmask_b32_dpp v87, v87, v87, vcc wave_shr:1 row_mask:0xf bank_mask:0xf
    s_andn2_b64 s[82:83], s[82:83], s[52:53]
    v_cndmask_b32_dpp v7, v7, v7, vcc wave_shr:1 row_mask:0xf bank_mask:0xf
    s_mov_b64 exec, s[54:55]
    s_cbranch_scc0 L2_d37
    s_mov_b64 exec, s[82:83]
    s_nop 1
    v_mfma_f32_4x4x4_16b_bf16 v[88:91], v[12:13], v[84:85], 0
    s_nop 1
    v_mfma_f32_4x4x4_16b_bf16 v[88:91], v[10:11], v[86:87], v[88:91]
    s_nop 4
    v_cvt_pk_bf16_f32 v88, v88, v89
    v_cvt_pk_bf16_f32 v89, v90, v91
    ds_pk_add_bf16 v7, v88 offset:65408
    ds_pk_add_bf16 v7, v89 offset:65412
    s_mov_b64 exec, s[54:55]
    s_branch L2_d37
L2_c38:
    s_lshl_b64 s[52:53], s[82:83], 1
    s_andn2_b64 s[52:53], s[52:53], s[80:81]
    s_andn2_b64 s[52:53], s[52:53], s[50:51]
    s_or_b64 s[80:81], s[80:81], s[52:53]
    s_not_b64 vcc, s[52:53]
    s_mov_b64 exec, -1
    v_cndmask_b32_dpp v84, v84, v84, vcc wave_shr:1 row_mask:0xf bank_mask:0xf
    v_cndmask_b32_dpp v85, v85, v85, vcc wave_shr:1 row_mask:0xf bank_mask:0xf
    s_lshr_b64 s[52:53], s[52:53], 1
    v_cndmask_b32_dpp v86, v86, v86, vcc wave_shr:1 row_mask:0xf bank_mask:0xf
    v_cndmask_b32_dpp v87, v87, v87, vcc wave_shr:1 row_mask:0xf bank_mask:0xf
    s_andn2_b64 s[82:83], s[82:83], s[52:53]
    v_cndmask_b32_dpp v7, v7, v7, vcc wave_shr:1 row_mask:0xf bank_mask:0xf
    s_mov_b64 exec, s[50:51]
    s_cbranch_scc0 L2_d38
    s_mov_b64 exec, s[82:83]
    s_nop 1
    v_mfma_f32_4x4x4_16b_bf16 v[88:91], v[12:13], v[84:85], 0
    s_nop 1
    v_mfma_f32_4x4x4_16b_bf16 v[88:91], v[10:11], v[86:87], v[88:91]
    s_nop 4
    v_cvt_pk_bf16_f32 v88, v88, v89
    v_cvt_pk_bf16_f32 v89, v90, v91
    ds_pk_add_bf16 v7, v88 offset:65408
    ds_pk_add_bf16 v7, v89 offset:65412
    s_mov_b64 exec, s[50:51]
    s_branch L2_d38
L2_c39:
    s_lshl_b64 s[52:53], s[82:83], 1
    s_andn2_b64 s[52:53], s[52:53], s[80:81]
    s_andn2_b64 s[52:53], s[52:53], s[54:55]
    s_or_b64 s[80:81], s[80:81], s[52:53]
    s_not_b64 vcc, s[52:53]
    s_mov_b64 exec, -1
    v_cndmask_b32_dpp v84, v84, v84, vcc wave_shr:1 row_mask:0xf bank_mask:0xf
    v_cndmask_b32_dpp v85, v85, v85, vcc wave_shr:1 row_mask:0xf bank_mask:0xf
    s_lshr_b64 s[52:53], s[52:53], 1
    v_cndmask_b32_dpp v86, v86, v86, vcc wave_shr:1 row_mask:0xf bank_mask:0xf
    v_cndmask_b32_dpp v87, v87, v87, vcc wave_shr:1 row_mask:0xf bank_mask:0xf
    s_andn2_b64 s[82:83], s[82:83], s[52:53]
    v_cndmask_b32_dpp v7, v7, v7, vcc wave_shr:1 row_mask:0xf bank_mask:0xf
    s_mov_b64 exec, s[54:55]
    s_cbranch_scc0 L2_d39
    s_mov_b64 exec, s[82:83]
    s_nop 1
    v_mfma_f32_4x4x4_16b_bf16 v[88:91], v[12:13], v[84:85], 0
    s_nop 1
    v_mfma_f32_4x4x4_16b_bf16 v[88:91], v[10:11], v[86:87], v[88:91]
    s_nop 4
    v_cvt_pk_bf16_f32 v88, v88, v89
    v_cvt_pk_bf16_f32 v89, v90, v91
    ds_pk_add_bf16 v7, v88 offset:65408
    ds_pk_add_bf16 v7, v89 offset:65412
    s_mov_b64 exec, s[54:55]
    s_branch L2_d39
L2_c40:
    s_lshl_b64 s[52:53], s[82:83], 1
    s_andn2_b64 s[52:53], s[52:53], s[80:81]
    s_andn2_b64 s[52:53], s[52:53], s[50:51]
    s_or_b64 s[80:81], s[80:81], s[52:53]
    s_not_b64 vcc, s[52:53]
    s_mov_b64 exec, -1
    v_cndmask_b32_dpp v84, v84, v84, vcc wave_shr:1 row_mask:0xf bank_mask:0xf
    v_cndmask_b32_dpp v85, v85, v85, vcc wave_shr:1 row_mask:0xf bank_mask:0xf
    s_lshr_b64 s[52:53], s[52:53], 1
    v_cndmask_b32_dpp v86, v86, v86, vcc wave_shr:1 row_mask:0xf bank_mask:0xf
    v_cndmask_b32_dpp v87, v87, v87, vcc wave_shr:1 row_mask:0xf bank_mask:0xf
    s_andn2_b64 s[82:83], s[82:83], s[52:53]
    v_cndmask_b32_dpp v7, v7, v7, vcc wave_shr:1 row_mask:0xf bank_mask:0xf
    s_mov_b64 exec, s[50:51]
    s_cbranch_scc0 L2_d40
    s_mov_b64 exec, s[82:83]
    s_nop 1
    v_mfma_f32_4x4x4_16b_bf16 v[88:91], v[12:13], v[84:85], 0
    s_nop 1
    v_mfma_f32_4x4x4_16b_bf16 v[88:91], v[10:11], v[86:87], v[88:91]
    s_nop 4
    v_cvt_pk_bf16_f32 v88, v88, v89
    v_cvt_pk_bf16_f32 v89, v90, v91
    ds_pk_add_bf16 v7, v88 offset:65408
    ds_pk_add_bf16 v7, v89 offset:65412
    s_mov_b64 exec, s[50:51]
    s_branch L2_d40
L2_c41:
    s_lshl_b64 s[52:53], s[82:83], 1
    s_andn2_b64 s[52:53], s[52:53], s[80:81]
    s_andn2_b64 s[52:53], s[52:53], s[54:55]
    s_or_b64 s[80:81], s[80:81], s[52:53]
    s_not_b64 vcc, s[52:53]
    s_mov_b64 exec, -1
    v_cndmask_b32_dpp v84, v84, v84, vcc wave_shr:1 row_mask:0xf bank_mask:0xf
    v_cndmask_b32_dpp v85, v85, v85, vcc wave_shr:1 row_mask:0xf bank_mask:0xf
    s_lshr_b64 s[52:53], s[52:53], 1
    v_cndmask_b32_dpp v86, v86, v86, vcc wave_shr:1 row_mask:0xf bank_mask:0xf
    v_cndmask_b32_dpp v87, v87, v87, vcc wave_shr:1 row_mask:0xf bank_mask:0xf
    s_andn2_b64 s[82:83], s[82:83], s[52:53]
    v_cndmask_b32_dpp v7, v7, v7, vcc wave_shr:1 row_mask:0xf bank_mask:0xf
    s_mov_b64 exec, s[54:55]
    s_cbranch_scc0 L2_d41
    s_mov_b64 exec, s[82:83]
    s_nop 1
    v_mfma_f32_4x4x4_16b_bf16 v[88:91], v[12:13], v[84:85], 0
    s_nop 1
    v_mfma_f32_4x4x4_16b_bf16 v[88:91], v[10:11], v[86:87], v[88:91]
    s_nop 4
    v_cvt_pk_bf16_f32 v88, v88, v89
    v_cvt_pk_bf16_f32 v89, v90, v91
    ds_pk_add_bf16 v7, v88 offset:65408
    ds_pk_add_bf16 v7, v89 offset:65412
    s_mov_b64 exec, s[54:55]
    s_branch L2_d41
L2_c42:
    s_lshl_b64 s[52:53], s[82:83], 1
    s_andn2_b64 s[52:53], s[52:53], s[80:81]
    s_andn2_b64 s[52:53], s[52:53], s[50:51]
    s_or_b64 s[80:81], s[80:81], s[52:53]
    s_not_b64 vcc, s[52:53]
    s_mov_b64 exec, -1
    v_cndmask_b32_dpp v84, v84, v84, vcc wave_shr:1 row_mask:0xf bank_mask:0xf
    v_cndmask_b32_dpp v85, v85, v85, vcc wave_shr:1 row_mask:0xf bank_mask:0xf
    s_lshr_b64 s[52:53], s[52:53], 1
    v_cndmask_b32_dpp v86, v86, v86, vcc wave_shr:1 row_mask:0xf bank_mask:0xf
    v_cndmask_b32_dpp v87, v87, v87, vcc wave_shr:1 row_mask:0xf bank_mask:0xf
    s_andn2_b64 s[82:83], s[82:83], s[52:53]
    v_cndmask_b32_dpp v7, v7, v7, vcc wave_shr:1 row_mask:0xf bank_mask:0xf
    s_mov_b64 exec, s[50:51]
    s_cbranch_scc0 L2_d42
    s_mov_b64 exec, s[82:83]
    s_nop 1
    v_mfma_f32_4x4x4_16b_bf16 v[88:91], v[12:13], v[84:85], 0
    s_nop 1
    v_mfma_f32_4x4x4_16b_bf16 v[88:91], v[10:11], v[86:87], v[88:91]
    s_nop 4
    v_cvt_pk_bf16_f32 v88, v88, v89
    v_cvt_pk_bf16_f32 v89, v90, v91
    ds_pk_add_bf16 v7, v88 offset:65408
    ds_pk_add_bf16 v7, v89 offset:65412
    s_mov_b64 exec, s[50:51]
    s_branch L2_d42
L2_xa43:
    s_cmp_eq_u32 s101, 1
    s_cbranch_scc1 L2_xc43
    v_lshlrev_b32 v89, 0, v96
    v_add_u32 v90, 140, v97
    v_bitop3_b32 v90, v89, v45, v90 bitop3:0x6a
    ds_write_b32 v98, v90 offset:28
    v_lshlrev_b32 v89, 4, v96
    v_add_u32 v90, 120, v97
    v_bitop3_b32 v90, v89, v45, v90 bitop3:0x6a
    ds_write_b32 v98, v90 offset:24
    v_lshlrev_b32 v89, 8, v96
    v_add_u32 v90, 100, v97
    v_bitop3_b32 v90, v89, v45, v90 bitop3:0x6a
    ds_write_b32 v98, v90 offset:20
L2_xc43:
    v_lshlrev_b32 v89, 12, v96
    v_add_u32 v90, 80, v97
    v_bitop3_b32 v90, v89, v45, v90 bitop3:0x6a
    ds_write_b32 v98, v90 offset:16
    s_branch L2_xb43
L2_xe43:
    v_cmp_lt_u32 vcc, 32, v99
    v_cmp_lt_u32 s[58:59], 31, v88
    v_lshrrev_b32 v89, 16, v96
    v_add_u32 v97, 80, v97
    s_or_b64 vcc, vcc, s[58:59]
    s_cbranch_scc1 L2_xs43
    v_lshlrev_b32 v89, v1, v89
    v_and_b32 v89, v45, v89
    v_cmp_ne_u32 vcc, 0, v89
    v_xor_b32 v90, v97, v89
    s_add_u32 s3, s37, s38
    v_mbcnt_lo_u32_b32 v98, vcc_lo, 0
    v_mbcnt_hi_u32_b32 v98, vcc_hi, v98
    s_bcnt1_i32_b64 s41, vcc
    v_lshl_add_u32 v98, v98, 2, s3
    s_lshl2_add_u32 s37, s41, s37
    s_mov_b64 exec, vcc
    ds_write_b32 v98, v90
    s_mov_b64 exec, -1
    s_branch L2_xr43
L2_xf43:
    s_waitcnt lgkmcnt(0)
    s_cmp_gt_u32 s37, 1024
    s_cbranch_scc1 L2_xs43
    s_cmp_lt_u32 s37, 768
    s_cbranch_scc1 L2_xl43
    ds_read_b32 v33, v98 offset:896
    s_add_u32 s3, s42, 2
    s_bitset1_b32 s43, s3
    s_branch L2_xg43
L2_xl43:
    v_mov_b32 v42, -1
    s_cmp_ge_u32 s37, 512
    s_cbranch_scc1 L2_xg43
    v_mov_b32 v43, -1
    s_cmp_ge_u32 s37, 256
    s_cbranch_scc1 L2_xg43
    v_mov_b32 v41, -1
    s_branch L2_xg43
L2_xs43:
    s_waitcnt lgkmcnt(0)
    v_mov_b32 v40, -1
    v_mov_b32 v41, -1
    v_mov_b32 v43, -1
    v_mov_b32 v42, -1
    s_add_u32 s3, s42, 2
    s_bitset1_b32 s36, s3
    s_branch L2_xg43
L2_c44:
    s_lshl_b64 s[52:53], s[82:83], 1
    s_andn2_b64 s[52:53], s[52:53], s[80:81]
    s_andn2_b64 s[52:53], s[52:53], s[54:55]
    s_or_b64 s[80:81], s[80:81], s[52:53]
    s_not_b64 vcc, s[52:53]
    s_mov_b64 exec, -1
    v_cndmask_b32_dpp v84, v84, v84, vcc wave_shr:1 row_mask:0xf bank_mask:0xf
    v_cndmask_b32_dpp v85, v85, v85, vcc wave_shr:1 row_mask:0xf bank_mask:0xf
    s_lshr_b64 s[52:53], s[52:53], 1
    v_cndmask_b32_dpp v86, v86, v86, vcc wave_shr:1 row_mask:0xf bank_mask:0xf
    v_cndmask_b32_dpp v87, v87, v87, vcc wave_shr:1 row_mask:0xf bank_mask:0xf
    s_andn2_b64 s[82:83], s[82:83], s[52:53]
    v_cndmask_b32_dpp v7, v7, v7, vcc wave_shr:1 row_mask:0xf bank_mask:0xf
    s_mov_b64 exec, s[54:55]
    s_cbranch_scc0 L2_d44
    s_mov_b64 exec, s[82:83]
    s_nop 1
    v_mfma_f32_4x4x4_16b_bf16 v[88:91], v[12:13], v[84:85], 0
    s_nop 1
    v_mfma_f32_4x4x4_16b_bf16 v[88:91], v[10:11], v[86:87], v[88:91]
    s_nop 4
    v_cvt_pk_bf16_f32 v88, v88, v89
    v_cvt_pk_bf16_f32 v89, v90, v91
    ds_pk_add_bf16 v7, v88 offset:65408
    ds_pk_add_bf16 v7, v89 offset:65412
    s_mov_b64 exec, s[54:55]
    s_branch L2_d44
L2_c45:
    s_lshl_b64 s[52:53], s[82:83], 1
    s_andn2_b64 s[52:53], s[52:53], s[80:81]
    s_andn2_b64 s[52:53], s[52:53], s[50:51]
    s_or_b64 s[80:81], s[80:81], s[52:53]
    s_not_b64 vcc, s[52:53]
    s_mov_b64 exec, -1
    v_cndmask_b32_dpp v84, v84, v84, vcc wave_shr:1 row_mask:0xf bank_mask:0xf
    v_cndmask_b32_dpp v85, v85, v85, vcc wave_shr:1 row_mask:0xf bank_mask:0xf
    s_lshr_b64 s[52:53], s[52:53], 1
    v_cndmask_b32_dpp v86, v86, v86, vcc wave_shr:1 row_mask:0xf bank_mask:0xf
    v_cndmask_b32_dpp v87, v87, v87, vcc wave_shr:1 row_mask:0xf bank_mask:0xf
    s_andn2_b64 s[82:83], s[82:83], s[52:53]
    v_cndmask_b32_dpp v7, v7, v7, vcc wave_shr:1 row_mask:0xf bank_mask:0xf
    s_mov_b64 exec, s[50:51]
    s_cbranch_scc0 L2_d45
    s_mov_b64 exec, s[82:83]
    s_nop 1
    v_mfma_f32_4x4x4_16b_bf16 v[88:91], v[12:13], v[84:85], 0
    s_nop 1
    v_mfma_f32_4x4x4_16b_bf16 v[88:91], v[10:11], v[86:87], v[88:91]
    s_nop 4
    v_cvt_pk_bf16_f32 v88, v88, v89
    v_cvt_pk_bf16_f32 v89, v90, v91
    ds_pk_add_bf16 v7, v88 offset:65408
    ds_pk_add_bf16 v7, v89 offset:65412
    s_mov_b64 exec, s[50:51]
    s_branch L2_d45
L2_oa46:
    v_and_b32 v47, 0x0fffffff, v32
    buffer_load_dword v114, v47, s[8:11], 0 offen offset:16
    s_mov_b64 exec, s[6:7]
    v_add_u32 v47, 8, v47
    v_lshrrev_b32 v32, 2, v32
    s_mov_b64 exec, -1
    buffer_load_dwordx2 v[112:113], v47, s[8:11], 0 offen
    s_branch L2_ob46
L2_c47:
    s_lshl_b64 s[52:53], s[82:83], 1
    s_andn2_b64 s[52:53], s[52:53], s[80:81]
    s_andn2_b64 s[52:53], s[52:53], s[54:55]
    s_or_b64 s[80:81], s[80:81], s[52:53]
    s_not_b64 vcc, s[52:53]
    s_mov_b64 exec, -1
    v_cndmask_b32_dpp v84, v84, v84, vcc wave_shr:1 row_mask:0xf bank_mask:0xf
    v_cndmask_b32_dpp v85, v85, v85, vcc wave_shr:1 row_mask:0xf bank_mask:0xf
    s_lshr_b64 s[52:53], s[52:53], 1
    v_cndmask_b32_dpp v86, v86, v86, vcc wave_shr:1 row_mask:0xf bank_mask:0xf
    v_cndmask_b32_dpp v87, v87, v87, vcc wave_shr:1 row_mask:0xf bank_mask:0xf
    s_andn2_b64 s[82:83], s[82:83], s[52:53]
    v_cndmask_b32_dpp v7, v7, v7, vcc wave_shr:1 row_mask:0xf bank_mask:0xf
    s_mov_b64 exec, s[54:55]
    s_cbranch_scc0 L2_d47
    s_mov_b64 exec, s[82:83]
    s_nop 1
    v_mfma_f32_4x4x4_16b_bf16 v[88:91], v[12:13], v[84:85], 0
    s_nop 1
    v_mfma_f32_4x4x4_16b_bf16 v[88:91], v[10:11], v[86:87], v[88:91]
    s_nop 4
    v_cvt_pk_bf16_f32 v88, v88, v89
    v_cvt_pk_bf16_f32 v89, v90, v91
    ds_pk_add_bf16 v7, v88 offset:65408
    ds_pk_add_bf16 v7, v89 offset:65412
    s_mov_b64 exec, s[54:55]
    s_branch L2_d47
L2_c48:
    s_lshl_b64 s[52:53], s[82:83], 1
    s_andn2_b64 s[52:53], s[52:53], s[80:81]
    s_andn2_b64 s[52:53], s[52:53], s[50:51]
    s_or_b64 s[80:81], s[80:81], s[52:53]
    s_not_b64 vcc, s[52:53]
    s_mov_b64 exec, -1
    v_cndmask_b32_dpp v84, v84, v84, vcc wave_shr:1 row_mask:0xf bank_mask:0xf
    v_cndmask_b32_dpp v85, v85, v85, vcc wave_shr:1 row_mask:0xf bank_mask:0xf
    s_lshr_b64 s[52:53], s[52:53], 1
    v_cndmask_b32_dpp v86, v86, v86, vcc wave_shr:1 row_mask:0xf bank_mask:0xf
    v_cndmask_b32_dpp v87, v87, v87, vcc wave_shr:1 row_mask:0xf bank_mask:0xf
    s_andn2_b64 s[82:83], s[82:83], s[52:53]
    v_cndmask_b32_dpp v7, v7, v7, vcc wave_shr:1 row_mask:0xf bank_mask:0xf
    s_mov_b64 exec, s[50:51]
    s_cbranch_scc0 L2_d48
    s_mov_b64 exec, s[82:83]
    s_nop 1
    v_mfma_f32_4x4x4_16b_bf16 v[88:91], v[12:13], v[84:85], 0
    s_nop 1
    v_mfma_f32_4x4x4_16b_bf16 v[88:91], v[10:11], v[86:87], v[88:91]
    s_nop 4
    v_cvt_pk_bf16_f32 v88, v88, v89
    v_cvt_pk_bf16_f32 v89, v90, v91
    ds_pk_add_bf16 v7, v88 offset:65408
    ds_pk_add_bf16 v7, v89 offset:65412
    s_mov_b64 exec, s[50:51]
    s_branch L2_d48
L2_c49:
    s_lshl_b64 s[52:53], s[82:83], 1
    s_andn2_b64 s[52:53], s[52:53], s[80:81]
    s_andn2_b64 s[52:53], s[52:53], s[54:55]
    s_or_b64 s[80:81], s[80:81], s[52:53]
    s_not_b64 vcc, s[52:53]
    s_mov_b64 exec, -1
    v_cndmask_b32_dpp v84, v84, v84, vcc wave_shr:1 row_mask:0xf bank_mask:0xf
    v_cndmask_b32_dpp v85, v85, v85, vcc wave_shr:1 row_mask:0xf bank_mask:0xf
    s_lshr_b64 s[52:53], s[52:53], 1
    v_cndmask_b32_dpp v86, v86, v86, vcc wave_shr:1 row_mask:0xf bank_mask:0xf
    v_cndmask_b32_dpp v87, v87, v87, vcc wave_shr:1 row_mask:0xf bank_mask:0xf
    s_andn2_b64 s[82:83], s[82:83], s[52:53]
    v_cndmask_b32_dpp v7, v7, v7, vcc wave_shr:1 row_mask:0xf bank_mask:0xf
    s_mov_b64 exec, s[54:55]
    s_cbranch_scc0 L2_d49
    s_mov_b64 exec, s[82:83]
    s_nop 1
    v_mfma_f32_4x4x4_16b_bf16 v[88:91], v[12:13], v[84:85], 0
    s_nop 1
    v_mfma_f32_4x4x4_16b_bf16 v[88:91], v[10:11], v[86:87], v[88:91]
    s_nop 4
    v_cvt_pk_bf16_f32 v88, v88, v89
    v_cvt_pk_bf16_f32 v89, v90, v91
    ds_pk_add_bf16 v7, v88 offset:65408
    ds_pk_add_bf16 v7, v89 offset:65412
    s_mov_b64 exec, s[54:55]
    s_branch L2_d49
L2_c50:
    s_lshl_b64 s[52:53], s[82:83], 1
    s_andn2_b64 s[52:53], s[52:53], s[80:81]
    s_andn2_b64 s[52:53], s[52:53], s[50:51]
    s_or_b64 s[80:81], s[80:81], s[52:53]
    s_not_b64 vcc, s[52:53]
    s_mov_b64 exec, -1
    v_cndmask_b32_dpp v84, v84, v84, vcc wave_shr:1 row_mask:0xf bank_mask:0xf
    v_cndmask_b32_dpp v85, v85, v85, vcc wave_shr:1 row_mask:0xf bank_mask:0xf
    s_lshr_b64 s[52:53], s[52:53], 1
    v_cndmask_b32_dpp v86, v86, v86, vcc wave_shr:1 row_mask:0xf bank_mask:0xf
    v_cndmask_b32_dpp v87, v87, v87, vcc wave_shr:1 row_mask:0xf bank_mask:0xf
    s_andn2_b64 s[82:83], s[82:83], s[52:53]
    v_cndmask_b32_dpp v7, v7, v7, vcc wave_shr:1 row_mask:0xf bank_mask:0xf
    s_mov_b64 exec, s[50:51]
    s_cbranch_scc0 L2_d50
    s_mov_b64 exec, s[82:83]
    s_nop 1
    v_mfma_f32_4x4x4_16b_bf16 v[88:91], v[12:13], v[84:85], 0
    s_nop 1
    v_mfma_f32_4x4x4_16b_bf16 v[88:91], v[10:11], v[86:87], v[88:91]
    s_nop 4
    v_cvt_pk_bf16_f32 v88, v88, v89
    v_cvt_pk_bf16_f32 v89, v90, v91
    ds_pk_add_bf16 v7, v88 offset:65408
    ds_pk_add_bf16 v7, v89 offset:65412
    s_mov_b64 exec, s[50:51]
    s_branch L2_d50
L2_c51:
    s_lshl_b64 s[52:53], s[82:83], 1
    s_andn2_b64 s[52:53], s[52:53], s[80:81]
    s_andn2_b64 s[52:53], s[52:53], s[54:55]
    s_or_b64 s[80:81], s[80:81], s[52:53]
    s_not_b64 vcc, s[52:53]
    s_mov_b64 exec, -1
    v_cndmask_b32_dpp v84, v84, v84, vcc wave_shr:1 row_mask:0xf bank_mask:0xf
    v_cndmask_b32_dpp v85, v85, v85, vcc wave_shr:1 row_mask:0xf bank_mask:0xf
    s_lshr_b64 s[52:53], s[52:53], 1
    v_cndmask_b32_dpp v86, v86, v86, vcc wave_shr:1 row_mask:0xf bank_mask:0xf
    v_cndmask_b32_dpp v87, v87, v87, vcc wave_shr:1 row_mask:0xf bank_mask:0xf
    s_andn2_b64 s[82:83], s[82:83], s[52:53]
    v_cndmask_b32_dpp v7, v7, v7, vcc wave_shr:1 row_mask:0xf bank_mask:0xf
    s_mov_b64 exec, s[54:55]
    s_cbranch_scc0 L2_d51
    s_mov_b64 exec, s[82:83]
    s_nop 1
    v_mfma_f32_4x4x4_16b_bf16 v[88:91], v[12:13], v[84:85], 0
    s_nop 1
    v_mfma_f32_4x4x4_16b_bf16 v[88:91], v[10:11], v[86:87], v[88:91]
    s_nop 4
    v_cvt_pk_bf16_f32 v88, v88, v89
    v_cvt_pk_bf16_f32 v89, v90, v91
    ds_pk_add_bf16 v7, v88 offset:65408
    ds_pk_add_bf16 v7, v89 offset:65412
    s_mov_b64 exec, s[54:55]
    s_branch L2_d51
L2_c52:
    s_lshl_b64 s[52:53], s[82:83], 1
    s_andn2_b64 s[52:53], s[52:53], s[80:81]
    s_andn2_b64 s[52:53], s[52:53], s[50:51]
    s_or_b64 s[80:81], s[80:81], s[52:53]
    s_not_b64 vcc, s[52:53]
    s_mov_b64 exec, -1
    v_cndmask_b32_dpp v84, v84, v84, vcc wave_shr:1 row_mask:0xf bank_mask:0xf
    v_cndmask_b32_dpp v85, v85, v85, vcc wave_shr:1 row_mask:0xf bank_mask:0xf
    s_lshr_b64 s[52:53], s[52:53], 1
    v_cndmask_b32_dpp v86, v86, v86, vcc wave_shr:1 row_mask:0xf bank_mask:0xf
    v_cndmask_b32_dpp v87, v87, v87, vcc wave_shr:1 row_mask:0xf bank_mask:0xf
    s_andn2_b64 s[82:83], s[82:83], s[52:53]
    v_cndmask_b32_dpp v7, v7, v7, vcc wave_shr:1 row_mask:0xf bank_mask:0xf
    s_mov_b64 exec, s[50:51]
    s_cbranch_scc0 L2_d52
    s_mov_b64 exec, s[82:83]
    s_nop 1
    v_mfma_f32_4x4x4_16b_bf16 v[88:91], v[12:13], v[84:85], 0
    s_nop 1
    v_mfma_f32_4x4x4_16b_bf16 v[88:91], v[10:11], v[86:87], v[88:91]
    s_nop 4
    v_cvt_pk_bf16_f32 v88, v88, v89
    v_cvt_pk_bf16_f32 v89, v90, v91
    ds_pk_add_bf16 v7, v88 offset:65408
    ds_pk_add_bf16 v7, v89 offset:65412
    s_mov_b64 exec, s[50:51]
    s_branch L2_d52
L2_oa53:
    s_waitcnt vmcnt(3)
    s_mov_b64 exec, s[6:7]
    v_lshrrev_b32 v114, 16, v114
    s_mov_b64 exec, -1
    v_and_b32 v46, 0x10000000, v32
    v_cmpx_eq_u32 vcc, 0, v46
    v_lshrrev_b32 v47, 14, v112
    v_and_b32 v47, v5, v47
    ds_read_b64 v[96:97], v47
    v_perm_b32 v98, v112, v114, s44
    v_bitop3_b32 v99, v112, 0.5, -0.5 bitop3:0xa8
    v_bitop3_b32 v98, v6, v98, v99 bitop3:0xca
    v_and_b32 v47, v5, v112
    s_waitcnt lgkmcnt(0)
    v_mfma_f32_4x4x4_16b_bf16 v[88:91], v[8:9], v[96:97], 0
    s_nop 4
    v_mul_f32 v88, v98, v88
    v_mul_f32 v89, v98, v89
    v_mul_f32 v90, v98, v90
    v_mul_f32 v91, v98, v91
    v_cvt_pk_bf16_f32 v88, v88, v89
    v_cvt_pk_bf16_f32 v89, v90, v91
    ds_pk_add_bf16 v47, v88 offset:65408
    ds_pk_add_bf16 v47, v89 offset:65412
    s_mov_b64 exec, -1
    v_and_b32 v46, 0x20000000, v32
    v_cmpx_eq_u32 vcc, 0, v46
    v_lshrrev_b32 v47, 14, v113
    v_and_b32 v47, v5, v47
    ds_read_b64 v[96:97], v47
    v_perm_b32 v98, v113, v114, s45
    v_bitop3_b32 v99, v113, 0.5, -0.5 bitop3:0xa8
    v_bitop3_b32 v98, v6, v98, v99 bitop3:0xca
    v_and_b32 v47, v5, v113
    s_waitcnt lgkmcnt(0)
    v_mfma_f32_4x4x4_16b_bf16 v[88:91], v[8:9], v[96:97], 0
    s_nop 4
    v_mul_f32 v88, v98, v88
    v_mul_f32 v89, v98, v89
    v_mul_f32 v90, v98, v90
    v_mul_f32 v91, v98, v91
    v_cvt_pk_bf16_f32 v88, v88, v89
    v_cvt_pk_bf16_f32 v89, v90, v91
    ds_pk_add_bf16 v47, v88 offset:65408
    ds_pk_add_bf16 v47, v89 offset:65412
    s_mov_b64 exec, -1
    s_branch L2_ob53
L2_xo54:
    v_cmp_lt_u32 vcc, 20, v99
    s_mov_b32 s101, 1
    s_cbranch_vccz L2_xp54
    v_cmp_lt_u32 vcc, 32, v99
    v_cmp_lt_u32 s[58:59], 31, v88
    s_mov_b32 s101, 2
    s_or_b64 vcc, vcc, s[58:59]
    s_cbranch_scc0 L2_xp54
    s_mov_b32 s37, 0x10000
    s_branch L2_xp54
L2_c55:
    s_lshl_b64 s[52:53], s[82:83], 1
    s_andn2_b64 s[52:53], s[52:53], s[80:81]
    s_andn2_b64 s[52:53], s[52:53], s[54:55]
    s_or_b64 s[80:81], s[80:81], s[52:53]
    s_not_b64 vcc, s[52:53]
    s_mov_b64 exec, -1
    v_cndmask_b32_dpp v84, v84, v84, vcc wave_shr:1 row_mask:0xf bank_mask:0xf
    v_cndmask_b32_dpp v85, v85, v85, vcc wave_shr:1 row_mask:0xf bank_mask:0xf
    s_lshr_b64 s[52:53], s[52:53], 1
    v_cndmask_b32_dpp v86, v86, v86, vcc wave_shr:1 row_mask:0xf bank_mask:0xf
    v_cndmask_b32_dpp v87, v87, v87, vcc wave_shr:1 row_mask:0xf bank_mask:0xf
    s_andn2_b64 s[82:83], s[82:83], s[52:53]
    v_cndmask_b32_dpp v7, v7, v7, vcc wave_shr:1 row_mask:0xf bank_mask:0xf
    s_mov_b64 exec, s[54:55]
    s_cbranch_scc0 L2_d55
    s_mov_b64 exec, s[82:83]
    s_nop 1
    v_mfma_f32_4x4x4_16b_bf16 v[88:91], v[12:13], v[84:85], 0
    s_nop 1
    v_mfma_f32_4x4x4_16b_bf16 v[88:91], v[10:11], v[86:87], v[88:91]
    s_nop 4
    v_cvt_pk_bf16_f32 v88, v88, v89
    v_cvt_pk_bf16_f32 v89, v90, v91
    ds_pk_add_bf16 v7, v88 offset:65408
    ds_pk_add_bf16 v7, v89 offset:65412
    s_mov_b64 exec, s[54:55]
    s_branch L2_d55
L2_c56:
    s_lshl_b64 s[52:53], s[82:83], 1
    s_andn2_b64 s[52:53], s[52:53], s[80:81]
    s_andn2_b64 s[52:53], s[52:53], s[50:51]
    s_or_b64 s[80:81], s[80:81], s[52:53]
    s_not_b64 vcc, s[52:53]
    s_mov_b64 exec, -1
    v_cndmask_b32_dpp v84, v84, v84, vcc wave_shr:1 row_mask:0xf bank_mask:0xf
    v_cndmask_b32_dpp v85, v85, v85, vcc wave_shr:1 row_mask:0xf bank_mask:0xf
    s_lshr_b64 s[52:53], s[52:53], 1
    v_cndmask_b32_dpp v86, v86, v86, vcc wave_shr:1 row_mask:0xf bank_mask:0xf
    v_cndmask_b32_dpp v87, v87, v87, vcc wave_shr:1 row_mask:0xf bank_mask:0xf
    s_andn2_b64 s[82:83], s[82:83], s[52:53]
    v_cndmask_b32_dpp v7, v7, v7, vcc wave_shr:1 row_mask:0xf bank_mask:0xf
    s_mov_b64 exec, s[50:51]
    s_cbranch_scc0 L2_d56
    s_mov_b64 exec, s[82:83]
    s_nop 1
    v_mfma_f32_4x4x4_16b_bf16 v[88:91], v[12:13], v[84:85], 0
    s_nop 1
    v_mfma_f32_4x4x4_16b_bf16 v[88:91], v[10:11], v[86:87], v[88:91]
    s_nop 4
    v_cvt_pk_bf16_f32 v88, v88, v89
    v_cvt_pk_bf16_f32 v89, v90, v91
    ds_pk_add_bf16 v7, v88 offset:65408
    ds_pk_add_bf16 v7, v89 offset:65412
    s_mov_b64 exec, s[50:51]
    s_branch L2_d56
L2_c57:
    s_lshl_b64 s[52:53], s[82:83], 1
    s_andn2_b64 s[52:53], s[52:53], s[80:81]
    s_andn2_b64 s[52:53], s[52:53], s[54:55]
    s_or_b64 s[80:81], s[80:81], s[52:53]
    s_not_b64 vcc, s[52:53]
    s_mov_b64 exec, -1
    v_cndmask_b32_dpp v84, v84, v84, vcc wave_shr:1 row_mask:0xf bank_mask:0xf
    v_cndmask_b32_dpp v85, v85, v85, vcc wave_shr:1 row_mask:0xf bank_mask:0xf
    s_lshr_b64 s[52:53], s[52:53], 1
    v_cndmask_b32_dpp v86, v86, v86, vcc wave_shr:1 row_mask:0xf bank_mask:0xf
    v_cndmask_b32_dpp v87, v87, v87, vcc wave_shr:1 row_mask:0xf bank_mask:0xf
    s_andn2_b64 s[82:83], s[82:83], s[52:53]
    v_cndmask_b32_dpp v7, v7, v7, vcc wave_shr:1 row_mask:0xf bank_mask:0xf
    s_mov_b64 exec, s[54:55]
    s_cbranch_scc0 L2_d57
    s_mov_b64 exec, s[82:83]
    s_nop 1
    v_mfma_f32_4x4x4_16b_bf16 v[88:91], v[12:13], v[84:85], 0
    s_nop 1
    v_mfma_f32_4x4x4_16b_bf16 v[88:91], v[10:11], v[86:87], v[88:91]
    s_nop 4
    v_cvt_pk_bf16_f32 v88, v88, v89
    v_cvt_pk_bf16_f32 v89, v90, v91
    ds_pk_add_bf16 v7, v88 offset:65408
    ds_pk_add_bf16 v7, v89 offset:65412
    s_mov_b64 exec, s[54:55]
    s_branch L2_d57
L2_c58:
    s_lshl_b64 s[52:53], s[82:83], 1
    s_andn2_b64 s[52:53], s[52:53], s[80:81]
    s_andn2_b64 s[52:53], s[52:53], s[50:51]
    s_or_b64 s[80:81], s[80:81], s[52:53]
    s_not_b64 vcc, s[52:53]
    s_mov_b64 exec, -1
    v_cndmask_b32_dpp v84, v84, v84, vcc wave_shr:1 row_mask:0xf bank_mask:0xf
    v_cndmask_b32_dpp v85, v85, v85, vcc wave_shr:1 row_mask:0xf bank_mask:0xf
    s_lshr_b64 s[52:53], s[52:53], 1
    v_cndmask_b32_dpp v86, v86, v86, vcc wave_shr:1 row_mask:0xf bank_mask:0xf
    v_cndmask_b32_dpp v87, v87, v87, vcc wave_shr:1 row_mask:0xf bank_mask:0xf
    s_andn2_b64 s[82:83], s[82:83], s[52:53]
    v_cndmask_b32_dpp v7, v7, v7, vcc wave_shr:1 row_mask:0xf bank_mask:0xf
    s_mov_b64 exec, s[50:51]
    s_cbranch_scc0 L2_d58
    s_mov_b64 exec, s[82:83]
    s_nop 1
    v_mfma_f32_4x4x4_16b_bf16 v[88:91], v[12:13], v[84:85], 0
    s_nop 1
    v_mfma_f32_4x4x4_16b_bf16 v[88:91], v[10:11], v[86:87], v[88:91]
    s_nop 4
    v_cvt_pk_bf16_f32 v88, v88, v89
    v_cvt_pk_bf16_f32 v89, v90, v91
    ds_pk_add_bf16 v7, v88 offset:65408
    ds_pk_add_bf16 v7, v89 offset:65412
    s_mov_b64 exec, s[50:51]
    s_branch L2_d58
L2_c59:
    s_lshl_b64 s[52:53], s[82:83], 1
    s_andn2_b64 s[52:53], s[52:53], s[80:81]
    s_andn2_b64 s[52:53], s[52:53], s[54:55]
    s_or_b64 s[80:81], s[80:81], s[52:53]
    s_not_b64 vcc, s[52:53]
    s_mov_b64 exec, -1
    v_cndmask_b32_dpp v84, v84, v84, vcc wave_shr:1 row_mask:0xf bank_mask:0xf
    v_cndmask_b32_dpp v85, v85, v85, vcc wave_shr:1 row_mask:0xf bank_mask:0xf
    s_lshr_b64 s[52:53], s[52:53], 1
    v_cndmask_b32_dpp v86, v86, v86, vcc wave_shr:1 row_mask:0xf bank_mask:0xf
    v_cndmask_b32_dpp v87, v87, v87, vcc wave_shr:1 row_mask:0xf bank_mask:0xf
    s_andn2_b64 s[82:83], s[82:83], s[52:53]
    v_cndmask_b32_dpp v7, v7, v7, vcc wave_shr:1 row_mask:0xf bank_mask:0xf
    s_mov_b64 exec, s[54:55]
    s_cbranch_scc0 L2_d59
    s_mov_b64 exec, s[82:83]
    s_nop 1
    v_mfma_f32_4x4x4_16b_bf16 v[88:91], v[12:13], v[84:85], 0
    s_nop 1
    v_mfma_f32_4x4x4_16b_bf16 v[88:91], v[10:11], v[86:87], v[88:91]
    s_nop 4
    v_cvt_pk_bf16_f32 v88, v88, v89
    v_cvt_pk_bf16_f32 v89, v90, v91
    ds_pk_add_bf16 v7, v88 offset:65408
    ds_pk_add_bf16 v7, v89 offset:65412
    s_mov_b64 exec, s[54:55]
    s_branch L2_d59
L2_c60:
    s_lshl_b64 s[52:53], s[82:83], 1
    s_andn2_b64 s[52:53], s[52:53], s[80:81]
    s_andn2_b64 s[52:53], s[52:53], s[50:51]
    s_or_b64 s[80:81], s[80:81], s[52:53]
    s_not_b64 vcc, s[52:53]
    s_mov_b64 exec, -1
    v_cndmask_b32_dpp v84, v84, v84, vcc wave_shr:1 row_mask:0xf bank_mask:0xf
    v_cndmask_b32_dpp v85, v85, v85, vcc wave_shr:1 row_mask:0xf bank_mask:0xf
    s_lshr_b64 s[52:53], s[52:53], 1
    v_cndmask_b32_dpp v86, v86, v86, vcc wave_shr:1 row_mask:0xf bank_mask:0xf
    v_cndmask_b32_dpp v87, v87, v87, vcc wave_shr:1 row_mask:0xf bank_mask:0xf
    s_andn2_b64 s[82:83], s[82:83], s[52:53]
    v_cndmask_b32_dpp v7, v7, v7, vcc wave_shr:1 row_mask:0xf bank_mask:0xf
    s_mov_b64 exec, s[50:51]
    s_cbranch_scc0 L2_d60
    s_mov_b64 exec, s[82:83]
    s_nop 1
    v_mfma_f32_4x4x4_16b_bf16 v[88:91], v[12:13], v[84:85], 0
    s_nop 1
    v_mfma_f32_4x4x4_16b_bf16 v[88:91], v[10:11], v[86:87], v[88:91]
    s_nop 4
    v_cvt_pk_bf16_f32 v88, v88, v89
    v_cvt_pk_bf16_f32 v89, v90, v91
    ds_pk_add_bf16 v7, v88 offset:65408
    ds_pk_add_bf16 v7, v89 offset:65412
    s_mov_b64 exec, s[50:51]
    s_branch L2_d60
L2_xa61:
    s_cmp_eq_u32 s101, 1
    s_cbranch_scc1 L2_xc61
    v_lshlrev_b32 v89, 0, v96
    v_add_u32 v90, 140, v97
    v_bitop3_b32 v90, v89, v45, v90 bitop3:0x6a
    ds_write_b32 v98, v90 offset:28
    v_lshlrev_b32 v89, 4, v96
    v_add_u32 v90, 120, v97
    v_bitop3_b32 v90, v89, v45, v90 bitop3:0x6a
    ds_write_b32 v98, v90 offset:24
    v_lshlrev_b32 v89, 8, v96
    v_add_u32 v90, 100, v97
    v_bitop3_b32 v90, v89, v45, v90 bitop3:0x6a
    ds_write_b32 v98, v90 offset:20
L2_xc61:
    v_lshlrev_b32 v89, 12, v96
    v_add_u32 v90, 80, v97
    v_bitop3_b32 v90, v89, v45, v90 bitop3:0x6a
    ds_write_b32 v98, v90 offset:16
    s_branch L2_xb61
L2_xe61:
    v_cmp_lt_u32 vcc, 32, v99
    v_cmp_lt_u32 s[58:59], 31, v88
    v_lshrrev_b32 v89, 16, v96
    v_add_u32 v97, 80, v97
    s_or_b64 vcc, vcc, s[58:59]
    s_cbranch_scc1 L2_xs61
    v_lshlrev_b32 v89, v1, v89
    v_and_b32 v89, v45, v89
    v_cmp_ne_u32 vcc, 0, v89
    v_xor_b32 v90, v97, v89
    s_add_u32 s3, s37, s38
    v_mbcnt_lo_u32_b32 v98, vcc_lo, 0
    v_mbcnt_hi_u32_b32 v98, vcc_hi, v98
    s_bcnt1_i32_b64 s41, vcc
    v_lshl_add_u32 v98, v98, 2, s3
    s_lshl2_add_u32 s37, s41, s37
    s_mov_b64 exec, vcc
    ds_write_b32 v98, v90
    s_mov_b64 exec, -1
    s_branch L2_xr61
L2_xf61:
    s_waitcnt lgkmcnt(0)
    s_cmp_gt_u32 s37, 1024
    s_cbranch_scc1 L2_xs61
    s_cmp_lt_u32 s37, 768
    s_cbranch_scc1 L2_xl61
    ds_read_b32 v32, v98 offset:896
    s_add_u32 s3, s42, 2
    s_bitset1_b32 s43, s3
    s_branch L2_xg61
L2_xl61:
    v_mov_b32 v42, -1
    s_cmp_ge_u32 s37, 512
    s_cbranch_scc1 L2_xg61
    v_mov_b32 v43, -1
    s_cmp_ge_u32 s37, 256
    s_cbranch_scc1 L2_xg61
    v_mov_b32 v41, -1
    s_branch L2_xg61
L2_xs61:
    s_waitcnt lgkmcnt(0)
    v_mov_b32 v40, -1
    v_mov_b32 v41, -1
    v_mov_b32 v43, -1
    v_mov_b32 v42, -1
    s_add_u32 s3, s42, 2
    s_bitset1_b32 s36, s3
    s_branch L2_xg61
L2_c62:
    s_lshl_b64 s[52:53], s[82:83], 1
    s_andn2_b64 s[52:53], s[52:53], s[80:81]
    s_andn2_b64 s[52:53], s[52:53], s[54:55]
    s_or_b64 s[80:81], s[80:81], s[52:53]
    s_not_b64 vcc, s[52:53]
    s_mov_b64 exec, -1
    v_cndmask_b32_dpp v84, v84, v84, vcc wave_shr:1 row_mask:0xf bank_mask:0xf
    v_cndmask_b32_dpp v85, v85, v85, vcc wave_shr:1 row_mask:0xf bank_mask:0xf
    s_lshr_b64 s[52:53], s[52:53], 1
    v_cndmask_b32_dpp v86, v86, v86, vcc wave_shr:1 row_mask:0xf bank_mask:0xf
    v_cndmask_b32_dpp v87, v87, v87, vcc wave_shr:1 row_mask:0xf bank_mask:0xf
    s_andn2_b64 s[82:83], s[82:83], s[52:53]
    v_cndmask_b32_dpp v7, v7, v7, vcc wave_shr:1 row_mask:0xf bank_mask:0xf
    s_mov_b64 exec, s[54:55]
    s_cbranch_scc0 L2_d62
    s_mov_b64 exec, s[82:83]
    s_nop 1
    v_mfma_f32_4x4x4_16b_bf16 v[88:91], v[12:13], v[84:85], 0
    s_nop 1
    v_mfma_f32_4x4x4_16b_bf16 v[88:91], v[10:11], v[86:87], v[88:91]
    s_nop 4
    v_cvt_pk_bf16_f32 v88, v88, v89
    v_cvt_pk_bf16_f32 v89, v90, v91
    ds_pk_add_bf16 v7, v88 offset:65408
    ds_pk_add_bf16 v7, v89 offset:65412
    s_mov_b64 exec, s[54:55]
    s_branch L2_d62
L2_c63:
    s_lshl_b64 s[52:53], s[82:83], 1
    s_andn2_b64 s[52:53], s[52:53], s[80:81]
    s_andn2_b64 s[52:53], s[52:53], s[50:51]
    s_or_b64 s[80:81], s[80:81], s[52:53]
    s_not_b64 vcc, s[52:53]
    s_mov_b64 exec, -1
    v_cndmask_b32_dpp v84, v84, v84, vcc wave_shr:1 row_mask:0xf bank_mask:0xf
    v_cndmask_b32_dpp v85, v85, v85, vcc wave_shr:1 row_mask:0xf bank_mask:0xf
    s_lshr_b64 s[52:53], s[52:53], 1
    v_cndmask_b32_dpp v86, v86, v86, vcc wave_shr:1 row_mask:0xf bank_mask:0xf
    v_cndmask_b32_dpp v87, v87, v87, vcc wave_shr:1 row_mask:0xf bank_mask:0xf
    s_andn2_b64 s[82:83], s[82:83], s[52:53]
    v_cndmask_b32_dpp v7, v7, v7, vcc wave_shr:1 row_mask:0xf bank_mask:0xf
    s_mov_b64 exec, s[50:51]
    s_cbranch_scc0 L2_d63
    s_mov_b64 exec, s[82:83]
    s_nop 1
    v_mfma_f32_4x4x4_16b_bf16 v[88:91], v[12:13], v[84:85], 0
    s_nop 1
    v_mfma_f32_4x4x4_16b_bf16 v[88:91], v[10:11], v[86:87], v[88:91]
    s_nop 4
    v_cvt_pk_bf16_f32 v88, v88, v89
    v_cvt_pk_bf16_f32 v89, v90, v91
    ds_pk_add_bf16 v7, v88 offset:65408
    ds_pk_add_bf16 v7, v89 offset:65412
    s_mov_b64 exec, s[50:51]
    s_branch L2_d63
L2_oa64:
    v_and_b32 v47, 0x0fffffff, v33
    buffer_load_dword v114, v47, s[8:11], 0 offen offset:16
    s_mov_b64 exec, s[6:7]
    v_add_u32 v47, 8, v47
    v_lshrrev_b32 v33, 2, v33
    s_mov_b64 exec, -1
    buffer_load_dwordx2 v[112:113], v47, s[8:11], 0 offen
    s_branch L2_ob64
L2_c65:
    s_lshl_b64 s[52:53], s[82:83], 1
    s_andn2_b64 s[52:53], s[52:53], s[80:81]
    s_andn2_b64 s[52:53], s[52:53], s[54:55]
    s_or_b64 s[80:81], s[80:81], s[52:53]
    s_not_b64 vcc, s[52:53]
    s_mov_b64 exec, -1
    v_cndmask_b32_dpp v84, v84, v84, vcc wave_shr:1 row_mask:0xf bank_mask:0xf
    v_cndmask_b32_dpp v85, v85, v85, vcc wave_shr:1 row_mask:0xf bank_mask:0xf
    s_lshr_b64 s[52:53], s[52:53], 1
    v_cndmask_b32_dpp v86, v86, v86, vcc wave_shr:1 row_mask:0xf bank_mask:0xf
    v_cndmask_b32_dpp v87, v87, v87, vcc wave_shr:1 row_mask:0xf bank_mask:0xf
    s_andn2_b64 s[82:83], s[82:83], s[52:53]
    v_cndmask_b32_dpp v7, v7, v7, vcc wave_shr:1 row_mask:0xf bank_mask:0xf
    s_mov_b64 exec, s[54:55]
    s_cbranch_scc0 L2_d65
    s_mov_b64 exec, s[82:83]
    s_nop 1
    v_mfma_f32_4x4x4_16b_bf16 v[88:91], v[12:13], v[84:85], 0
    s_nop 1
    v_mfma_f32_4x4x4_16b_bf16 v[88:91], v[10:11], v[86:87], v[88:91]
    s_nop 4
    v_cvt_pk_bf16_f32 v88, v88, v89
    v_cvt_pk_bf16_f32 v89, v90, v91
    ds_pk_add_bf16 v7, v88 offset:65408
    ds_pk_add_bf16 v7, v89 offset:65412
    s_mov_b64 exec, s[54:55]
    s_branch L2_d65
L2_c66:
    s_lshl_b64 s[52:53], s[82:83], 1
    s_andn2_b64 s[52:53], s[52:53], s[80:81]
    s_andn2_b64 s[52:53], s[52:53], s[50:51]
    s_or_b64 s[80:81], s[80:81], s[52:53]
    s_not_b64 vcc, s[52:53]
    s_mov_b64 exec, -1
    v_cndmask_b32_dpp v84, v84, v84, vcc wave_shr:1 row_mask:0xf bank_mask:0xf
    v_cndmask_b32_dpp v85, v85, v85, vcc wave_shr:1 row_mask:0xf bank_mask:0xf
    s_lshr_b64 s[52:53], s[52:53], 1
    v_cndmask_b32_dpp v86, v86, v86, vcc wave_shr:1 row_mask:0xf bank_mask:0xf
    v_cndmask_b32_dpp v87, v87, v87, vcc wave_shr:1 row_mask:0xf bank_mask:0xf
    s_andn2_b64 s[82:83], s[82:83], s[52:53]
    v_cndmask_b32_dpp v7, v7, v7, vcc wave_shr:1 row_mask:0xf bank_mask:0xf
    s_mov_b64 exec, s[50:51]
    s_cbranch_scc0 L2_d66
    s_mov_b64 exec, s[82:83]
    s_nop 1
    v_mfma_f32_4x4x4_16b_bf16 v[88:91], v[12:13], v[84:85], 0
    s_nop 1
    v_mfma_f32_4x4x4_16b_bf16 v[88:91], v[10:11], v[86:87], v[88:91]
    s_nop 4
    v_cvt_pk_bf16_f32 v88, v88, v89
    v_cvt_pk_bf16_f32 v89, v90, v91
    ds_pk_add_bf16 v7, v88 offset:65408
    ds_pk_add_bf16 v7, v89 offset:65412
    s_mov_b64 exec, s[50:51]
    s_branch L2_d66
L2_c67:
    s_lshl_b64 s[52:53], s[82:83], 1
    s_andn2_b64 s[52:53], s[52:53], s[80:81]
    s_andn2_b64 s[52:53], s[52:53], s[54:55]
    s_or_b64 s[80:81], s[80:81], s[52:53]
    s_not_b64 vcc, s[52:53]
    s_mov_b64 exec, -1
    v_cndmask_b32_dpp v84, v84, v84, vcc wave_shr:1 row_mask:0xf bank_mask:0xf
    v_cndmask_b32_dpp v85, v85, v85, vcc wave_shr:1 row_mask:0xf bank_mask:0xf
    s_lshr_b64 s[52:53], s[52:53], 1
    v_cndmask_b32_dpp v86, v86, v86, vcc wave_shr:1 row_mask:0xf bank_mask:0xf
    v_cndmask_b32_dpp v87, v87, v87, vcc wave_shr:1 row_mask:0xf bank_mask:0xf
    s_andn2_b64 s[82:83], s[82:83], s[52:53]
    v_cndmask_b32_dpp v7, v7, v7, vcc wave_shr:1 row_mask:0xf bank_mask:0xf
    s_mov_b64 exec, s[54:55]
    s_cbranch_scc0 L2_d67
    s_mov_b64 exec, s[82:83]
    s_nop 1
    v_mfma_f32_4x4x4_16b_bf16 v[88:91], v[12:13], v[84:85], 0
    s_nop 1
    v_mfma_f32_4x4x4_16b_bf16 v[88:91], v[10:11], v[86:87], v[88:91]
    s_nop 4
    v_cvt_pk_bf16_f32 v88, v88, v89
    v_cvt_pk_bf16_f32 v89, v90, v91
    ds_pk_add_bf16 v7, v88 offset:65408
    ds_pk_add_bf16 v7, v89 offset:65412
    s_mov_b64 exec, s[54:55]
    s_branch L2_d67
L2_c68:
    s_lshl_b64 s[52:53], s[82:83], 1
    s_andn2_b64 s[52:53], s[52:53], s[80:81]
    s_andn2_b64 s[52:53], s[52:53], s[50:51]
    s_or_b64 s[80:81], s[80:81], s[52:53]
    s_not_b64 vcc, s[52:53]
    s_mov_b64 exec, -1
    v_cndmask_b32_dpp v84, v84, v84, vcc wave_shr:1 row_mask:0xf bank_mask:0xf
    v_cndmask_b32_dpp v85, v85, v85, vcc wave_shr:1 row_mask:0xf bank_mask:0xf
    s_lshr_b64 s[52:53], s[52:53], 1
    v_cndmask_b32_dpp v86, v86, v86, vcc wave_shr:1 row_mask:0xf bank_mask:0xf
    v_cndmask_b32_dpp v87, v87, v87, vcc wave_shr:1 row_mask:0xf bank_mask:0xf
    s_andn2_b64 s[82:83], s[82:83], s[52:53]
    v_cndmask_b32_dpp v7, v7, v7, vcc wave_shr:1 row_mask:0xf bank_mask:0xf
    s_mov_b64 exec, s[50:51]
    s_cbranch_scc0 L2_d68
    s_mov_b64 exec, s[82:83]
    s_nop 1
    v_mfma_f32_4x4x4_16b_bf16 v[88:91], v[12:13], v[84:85], 0
    s_nop 1
    v_mfma_f32_4x4x4_16b_bf16 v[88:91], v[10:11], v[86:87], v[88:91]
    s_nop 4
    v_cvt_pk_bf16_f32 v88, v88, v89
    v_cvt_pk_bf16_f32 v89, v90, v91
    ds_pk_add_bf16 v7, v88 offset:65408
    ds_pk_add_bf16 v7, v89 offset:65412
    s_mov_b64 exec, s[50:51]
    s_branch L2_d68
L2_c69:
    s_lshl_b64 s[52:53], s[82:83], 1
    s_andn2_b64 s[52:53], s[52:53], s[80:81]
    s_andn2_b64 s[52:53], s[52:53], s[54:55]
    s_or_b64 s[80:81], s[80:81], s[52:53]
    s_not_b64 vcc, s[52:53]
    s_mov_b64 exec, -1
    v_cndmask_b32_dpp v84, v84, v84, vcc wave_shr:1 row_mask:0xf bank_mask:0xf
    v_cndmask_b32_dpp v85, v85, v85, vcc wave_shr:1 row_mask:0xf bank_mask:0xf
    s_lshr_b64 s[52:53], s[52:53], 1
    v_cndmask_b32_dpp v86, v86, v86, vcc wave_shr:1 row_mask:0xf bank_mask:0xf
    v_cndmask_b32_dpp v87, v87, v87, vcc wave_shr:1 row_mask:0xf bank_mask:0xf
    s_andn2_b64 s[82:83], s[82:83], s[52:53]
    v_cndmask_b32_dpp v7, v7, v7, vcc wave_shr:1 row_mask:0xf bank_mask:0xf
    s_mov_b64 exec, s[54:55]
    s_cbranch_scc0 L2_d69
    s_mov_b64 exec, s[82:83]
    s_nop 1
    v_mfma_f32_4x4x4_16b_bf16 v[88:91], v[12:13], v[84:85], 0
    s_nop 1
    v_mfma_f32_4x4x4_16b_bf16 v[88:91], v[10:11], v[86:87], v[88:91]
    s_nop 4
    v_cvt_pk_bf16_f32 v88, v88, v89
    v_cvt_pk_bf16_f32 v89, v90, v91
    ds_pk_add_bf16 v7, v88 offset:65408
    ds_pk_add_bf16 v7, v89 offset:65412
    s_mov_b64 exec, s[54:55]
    s_branch L2_d69
L2_c70:
    s_lshl_b64 s[52:53], s[82:83], 1
    s_andn2_b64 s[52:53], s[52:53], s[80:81]
    s_andn2_b64 s[52:53], s[52:53], s[50:51]
    s_or_b64 s[80:81], s[80:81], s[52:53]
    s_not_b64 vcc, s[52:53]
    s_mov_b64 exec, -1
    v_cndmask_b32_dpp v84, v84, v84, vcc wave_shr:1 row_mask:0xf bank_mask:0xf
    v_cndmask_b32_dpp v85, v85, v85, vcc wave_shr:1 row_mask:0xf bank_mask:0xf
    s_lshr_b64 s[52:53], s[52:53], 1
    v_cndmask_b32_dpp v86, v86, v86, vcc wave_shr:1 row_mask:0xf bank_mask:0xf
    v_cndmask_b32_dpp v87, v87, v87, vcc wave_shr:1 row_mask:0xf bank_mask:0xf
    s_andn2_b64 s[82:83], s[82:83], s[52:53]
    v_cndmask_b32_dpp v7, v7, v7, vcc wave_shr:1 row_mask:0xf bank_mask:0xf
    s_mov_b64 exec, s[50:51]
    s_cbranch_scc0 L2_d70
    s_mov_b64 exec, s[82:83]
    s_nop 1
    v_mfma_f32_4x4x4_16b_bf16 v[88:91], v[12:13], v[84:85], 0
    s_nop 1
    v_mfma_f32_4x4x4_16b_bf16 v[88:91], v[10:11], v[86:87], v[88:91]
    s_nop 4
    v_cvt_pk_bf16_f32 v88, v88, v89
    v_cvt_pk_bf16_f32 v89, v90, v91
    ds_pk_add_bf16 v7, v88 offset:65408
    ds_pk_add_bf16 v7, v89 offset:65412
    s_mov_b64 exec, s[50:51]
    s_branch L2_d70
L2_oa71:
    s_waitcnt vmcnt(3)
    s_mov_b64 exec, s[6:7]
    v_lshrrev_b32 v114, 16, v114
    s_mov_b64 exec, -1
    v_and_b32 v46, 0x10000000, v33
    v_cmpx_eq_u32 vcc, 0, v46
    v_lshrrev_b32 v47, 14, v112
    v_and_b32 v47, v5, v47
    ds_read_b64 v[96:97], v47
    v_perm_b32 v98, v112, v114, s44
    v_bitop3_b32 v99, v112, 0.5, -0.5 bitop3:0xa8
    v_bitop3_b32 v98, v6, v98, v99 bitop3:0xca
    v_and_b32 v47, v5, v112
    s_waitcnt lgkmcnt(0)
    v_mfma_f32_4x4x4_16b_bf16 v[88:91], v[8:9], v[96:97], 0
    s_nop 4
    v_mul_f32 v88, v98, v88
    v_mul_f32 v89, v98, v89
    v_mul_f32 v90, v98, v90
    v_mul_f32 v91, v98, v91
    v_cvt_pk_bf16_f32 v88, v88, v89
    v_cvt_pk_bf16_f32 v89, v90, v91
    ds_pk_add_bf16 v47, v88 offset:65408
    ds_pk_add_bf16 v47, v89 offset:65412
    s_mov_b64 exec, -1
    v_and_b32 v46, 0x20000000, v33
    v_cmpx_eq_u32 vcc, 0, v46
    v_lshrrev_b32 v47, 14, v113
    v_and_b32 v47, v5, v47
    ds_read_b64 v[96:97], v47
    v_perm_b32 v98, v113, v114, s45
    v_bitop3_b32 v99, v113, 0.5, -0.5 bitop3:0xa8
    v_bitop3_b32 v98, v6, v98, v99 bitop3:0xca
    v_and_b32 v47, v5, v113
    s_waitcnt lgkmcnt(0)
    v_mfma_f32_4x4x4_16b_bf16 v[88:91], v[8:9], v[96:97], 0
    s_nop 4
    v_mul_f32 v88, v98, v88
    v_mul_f32 v89, v98, v89
    v_mul_f32 v90, v98, v90
    v_mul_f32 v91, v98, v91
    v_cvt_pk_bf16_f32 v88, v88, v89
    v_cvt_pk_bf16_f32 v89, v90, v91
    ds_pk_add_bf16 v47, v88 offset:65408
    ds_pk_add_bf16 v47, v89 offset:65412
    s_mov_b64 exec, -1
    s_branch L2_ob71
L2_xo72:
    v_cmp_lt_u32 vcc, 20, v99
    s_mov_b32 s101, 1
    s_cbranch_vccz L2_xp72
    v_cmp_lt_u32 vcc, 32, v99
    v_cmp_lt_u32 s[58:59], 31, v88
    s_mov_b32 s101, 2
    s_or_b64 vcc, vcc, s[58:59]
    s_cbranch_scc0 L2_xp72
    s_mov_b32 s37, 0x10000
    s_branch L2_xp72
L2_c73:
    s_lshl_b64 s[52:53], s[82:83], 1
    s_andn2_b64 s[52:53], s[52:53], s[80:81]
    s_andn2_b64 s[52:53], s[52:53], s[54:55]
    s_or_b64 s[80:81], s[80:81], s[52:53]
    s_not_b64 vcc, s[52:53]
    s_mov_b64 exec, -1
    v_cndmask_b32_dpp v84, v84, v84, vcc wave_shr:1 row_mask:0xf bank_mask:0xf
    v_cndmask_b32_dpp v85, v85, v85, vcc wave_shr:1 row_mask:0xf bank_mask:0xf
    s_lshr_b64 s[52:53], s[52:53], 1
    v_cndmask_b32_dpp v86, v86, v86, vcc wave_shr:1 row_mask:0xf bank_mask:0xf
    v_cndmask_b32_dpp v87, v87, v87, vcc wave_shr:1 row_mask:0xf bank_mask:0xf
    s_andn2_b64 s[82:83], s[82:83], s[52:53]
    v_cndmask_b32_dpp v7, v7, v7, vcc wave_shr:1 row_mask:0xf bank_mask:0xf
    s_mov_b64 exec, s[54:55]
    s_cbranch_scc0 L2_d73
    s_mov_b64 exec, s[82:83]
    s_nop 1
    v_mfma_f32_4x4x4_16b_bf16 v[88:91], v[12:13], v[84:85], 0
    s_nop 1
    v_mfma_f32_4x4x4_16b_bf16 v[88:91], v[10:11], v[86:87], v[88:91]
    s_nop 4
    v_cvt_pk_bf16_f32 v88, v88, v89
    v_cvt_pk_bf16_f32 v89, v90, v91
    ds_pk_add_bf16 v7, v88 offset:65408
    ds_pk_add_bf16 v7, v89 offset:65412
    s_mov_b64 exec, s[54:55]
    s_branch L2_d73
L2_c74:
    s_lshl_b64 s[52:53], s[82:83], 1
    s_andn2_b64 s[52:53], s[52:53], s[80:81]
    s_andn2_b64 s[52:53], s[52:53], s[50:51]
    s_or_b64 s[80:81], s[80:81], s[52:53]
    s_not_b64 vcc, s[52:53]
    s_mov_b64 exec, -1
    v_cndmask_b32_dpp v84, v84, v84, vcc wave_shr:1 row_mask:0xf bank_mask:0xf
    v_cndmask_b32_dpp v85, v85, v85, vcc wave_shr:1 row_mask:0xf bank_mask:0xf
    s_lshr_b64 s[52:53], s[52:53], 1
    v_cndmask_b32_dpp v86, v86, v86, vcc wave_shr:1 row_mask:0xf bank_mask:0xf
    v_cndmask_b32_dpp v87, v87, v87, vcc wave_shr:1 row_mask:0xf bank_mask:0xf
    s_andn2_b64 s[82:83], s[82:83], s[52:53]
    v_cndmask_b32_dpp v7, v7, v7, vcc wave_shr:1 row_mask:0xf bank_mask:0xf
    s_mov_b64 exec, s[50:51]
    s_cbranch_scc0 L2_d74
    s_mov_b64 exec, s[82:83]
    s_nop 1
    v_mfma_f32_4x4x4_16b_bf16 v[88:91], v[12:13], v[84:85], 0
    s_nop 1
    v_mfma_f32_4x4x4_16b_bf16 v[88:91], v[10:11], v[86:87], v[88:91]
    s_nop 4
    v_cvt_pk_bf16_f32 v88, v88, v89
    v_cvt_pk_bf16_f32 v89, v90, v91
    ds_pk_add_bf16 v7, v88 offset:65408
    ds_pk_add_bf16 v7, v89 offset:65412
    s_mov_b64 exec, s[50:51]
    s_branch L2_d74
L2_c75:
    s_lshl_b64 s[52:53], s[82:83], 1
    s_andn2_b64 s[52:53], s[52:53], s[80:81]
    s_andn2_b64 s[52:53], s[52:53], s[54:55]
    s_or_b64 s[80:81], s[80:81], s[52:53]
    s_not_b64 vcc, s[52:53]
    s_mov_b64 exec, -1
    v_cndmask_b32_dpp v84, v84, v84, vcc wave_shr:1 row_mask:0xf bank_mask:0xf
    v_cndmask_b32_dpp v85, v85, v85, vcc wave_shr:1 row_mask:0xf bank_mask:0xf
    s_lshr_b64 s[52:53], s[52:53], 1
    v_cndmask_b32_dpp v86, v86, v86, vcc wave_shr:1 row_mask:0xf bank_mask:0xf
    v_cndmask_b32_dpp v87, v87, v87, vcc wave_shr:1 row_mask:0xf bank_mask:0xf
    s_andn2_b64 s[82:83], s[82:83], s[52:53]
    v_cndmask_b32_dpp v7, v7, v7, vcc wave_shr:1 row_mask:0xf bank_mask:0xf
    s_mov_b64 exec, s[54:55]
    s_cbranch_scc0 L2_d75
    s_mov_b64 exec, s[82:83]
    s_nop 1
    v_mfma_f32_4x4x4_16b_bf16 v[88:91], v[12:13], v[84:85], 0
    s_nop 1
    v_mfma_f32_4x4x4_16b_bf16 v[88:91], v[10:11], v[86:87], v[88:91]
    s_nop 4
    v_cvt_pk_bf16_f32 v88, v88, v89
    v_cvt_pk_bf16_f32 v89, v90, v91
    ds_pk_add_bf16 v7, v88 offset:65408
    ds_pk_add_bf16 v7, v89 offset:65412
    s_mov_b64 exec, s[54:55]
    s_branch L2_d75
L2_c76:
    s_lshl_b64 s[52:53], s[82:83], 1
    s_andn2_b64 s[52:53], s[52:53], s[80:81]
    s_andn2_b64 s[52:53], s[52:53], s[50:51]
    s_or_b64 s[80:81], s[80:81], s[52:53]
    s_not_b64 vcc, s[52:53]
    s_mov_b64 exec, -1
    v_cndmask_b32_dpp v84, v84, v84, vcc wave_shr:1 row_mask:0xf bank_mask:0xf
    v_cndmask_b32_dpp v85, v85, v85, vcc wave_shr:1 row_mask:0xf bank_mask:0xf
    s_lshr_b64 s[52:53], s[52:53], 1
    v_cndmask_b32_dpp v86, v86, v86, vcc wave_shr:1 row_mask:0xf bank_mask:0xf
    v_cndmask_b32_dpp v87, v87, v87, vcc wave_shr:1 row_mask:0xf bank_mask:0xf
    s_andn2_b64 s[82:83], s[82:83], s[52:53]
    v_cndmask_b32_dpp v7, v7, v7, vcc wave_shr:1 row_mask:0xf bank_mask:0xf
    s_mov_b64 exec, s[50:51]
    s_cbranch_scc0 L2_d76
    s_mov_b64 exec, s[82:83]
    s_nop 1
    v_mfma_f32_4x4x4_16b_bf16 v[88:91], v[12:13], v[84:85], 0
    s_nop 1
    v_mfma_f32_4x4x4_16b_bf16 v[88:91], v[10:11], v[86:87], v[88:91]
    s_nop 4
    v_cvt_pk_bf16_f32 v88, v88, v89
    v_cvt_pk_bf16_f32 v89, v90, v91
    ds_pk_add_bf16 v7, v88 offset:65408
    ds_pk_add_bf16 v7, v89 offset:65412
    s_mov_b64 exec, s[50:51]
    s_branch L2_d76
L2_c77:
    s_lshl_b64 s[52:53], s[82:83], 1
    s_andn2_b64 s[52:53], s[52:53], s[80:81]
    s_andn2_b64 s[52:53], s[52:53], s[54:55]
    s_or_b64 s[80:81], s[80:81], s[52:53]
    s_not_b64 vcc, s[52:53]
    s_mov_b64 exec, -1
    v_cndmask_b32_dpp v84, v84, v84, vcc wave_shr:1 row_mask:0xf bank_mask:0xf
    v_cndmask_b32_dpp v85, v85, v85, vcc wave_shr:1 row_mask:0xf bank_mask:0xf
    s_lshr_b64 s[52:53], s[52:53], 1
    v_cndmask_b32_dpp v86, v86, v86, vcc wave_shr:1 row_mask:0xf bank_mask:0xf
    v_cndmask_b32_dpp v87, v87, v87, vcc wave_shr:1 row_mask:0xf bank_mask:0xf
    s_andn2_b64 s[82:83], s[82:83], s[52:53]
    v_cndmask_b32_dpp v7, v7, v7, vcc wave_shr:1 row_mask:0xf bank_mask:0xf
    s_mov_b64 exec, s[54:55]
    s_cbranch_scc0 L2_d77
    s_mov_b64 exec, s[82:83]
    s_nop 1
    v_mfma_f32_4x4x4_16b_bf16 v[88:91], v[12:13], v[84:85], 0
    s_nop 1
    v_mfma_f32_4x4x4_16b_bf16 v[88:91], v[10:11], v[86:87], v[88:91]
    s_nop 4
    v_cvt_pk_bf16_f32 v88, v88, v89
    v_cvt_pk_bf16_f32 v89, v90, v91
    ds_pk_add_bf16 v7, v88 offset:65408
    ds_pk_add_bf16 v7, v89 offset:65412
    s_mov_b64 exec, s[54:55]
    s_branch L2_d77
L2_c78:
    s_lshl_b64 s[52:53], s[82:83], 1
    s_andn2_b64 s[52:53], s[52:53], s[80:81]
    s_andn2_b64 s[52:53], s[52:53], s[50:51]
    s_or_b64 s[80:81], s[80:81], s[52:53]
    s_not_b64 vcc, s[52:53]
    s_mov_b64 exec, -1
    v_cndmask_b32_dpp v84, v84, v84, vcc wave_shr:1 row_mask:0xf bank_mask:0xf
    v_cndmask_b32_dpp v85, v85, v85, vcc wave_shr:1 row_mask:0xf bank_mask:0xf
    s_lshr_b64 s[52:53], s[52:53], 1
    v_cndmask_b32_dpp v86, v86, v86, vcc wave_shr:1 row_mask:0xf bank_mask:0xf
    v_cndmask_b32_dpp v87, v87, v87, vcc wave_shr:1 row_mask:0xf bank_mask:0xf
    s_andn2_b64 s[82:83], s[82:83], s[52:53]
    v_cndmask_b32_dpp v7, v7, v7, vcc wave_shr:1 row_mask:0xf bank_mask:0xf
    s_mov_b64 exec, s[50:51]
    s_cbranch_scc0 L2_d78
    s_mov_b64 exec, s[82:83]
    s_nop 1
    v_mfma_f32_4x4x4_16b_bf16 v[88:91], v[12:13], v[84:85], 0
    s_nop 1
    v_mfma_f32_4x4x4_16b_bf16 v[88:91], v[10:11], v[86:87], v[88:91]
    s_nop 4
    v_cvt_pk_bf16_f32 v88, v88, v89
    v_cvt_pk_bf16_f32 v89, v90, v91
    ds_pk_add_bf16 v7, v88 offset:65408
    ds_pk_add_bf16 v7, v89 offset:65412
    s_mov_b64 exec, s[50:51]
    s_branch L2_d78
L2_xa79:
    s_cmp_eq_u32 s101, 1
    s_cbranch_scc1 L2_xc79
    v_lshlrev_b32 v89, 0, v96
    v_add_u32 v90, 140, v97
    v_bitop3_b32 v90, v89, v45, v90 bitop3:0x6a
    ds_write_b32 v98, v90 offset:28
    v_lshlrev_b32 v89, 4, v96
    v_add_u32 v90, 120, v97
    v_bitop3_b32 v90, v89, v45, v90 bitop3:0x6a
    ds_write_b32 v98, v90 offset:24
    v_lshlrev_b32 v89, 8, v96
    v_add_u32 v90, 100, v97
    v_bitop3_b32 v90, v89, v45, v90 bitop3:0x6a
    ds_write_b32 v98, v90 offset:20
L2_xc79:
    v_lshlrev_b32 v89, 12, v96
    v_add_u32 v90, 80, v97
    v_bitop3_b32 v90, v89, v45, v90 bitop3:0x6a
    ds_write_b32 v98, v90 offset:16
    s_branch L2_xb79
L2_xe79:
    v_cmp_lt_u32 vcc, 32, v99
    v_cmp_lt_u32 s[58:59], 31, v88
    v_lshrrev_b32 v89, 16, v96
    v_add_u32 v97, 80, v97
    s_or_b64 vcc, vcc, s[58:59]
    s_cbranch_scc1 L2_xs79
    v_lshlrev_b32 v89, v1, v89
    v_and_b32 v89, v45, v89
    v_cmp_ne_u32 vcc, 0, v89
    v_xor_b32 v90, v97, v89
    s_add_u32 s3, s37, s38
    v_mbcnt_lo_u32_b32 v98, vcc_lo, 0
    v_mbcnt_hi_u32_b32 v98, vcc_hi, v98
    s_bcnt1_i32_b64 s41, vcc
    v_lshl_add_u32 v98, v98, 2, s3
    s_lshl2_add_u32 s37, s41, s37
    s_mov_b64 exec, vcc
    ds_write_b32 v98, v90
    s_mov_b64 exec, -1
    s_branch L2_xr79
L2_xf79:
    s_waitcnt lgkmcnt(0)
    s_cmp_gt_u32 s37, 1024
    s_cbranch_scc1 L2_xs79
    s_cmp_lt_u32 s37, 768
    s_cbranch_scc1 L2_xl79
    ds_read_b32 v33, v98 offset:896
    s_add_u32 s3, s42, 2
    s_bitset1_b32 s43, s3
    s_branch L2_xg79
L2_xl79:
    v_mov_b32 v42, -1
    s_cmp_ge_u32 s37, 512
    s_cbranch_scc1 L2_xg79
    v_mov_b32 v43, -1
    s_cmp_ge_u32 s37, 256
    s_cbranch_scc1 L2_xg79
    v_mov_b32 v41, -1
    s_branch L2_xg79
L2_xs79:
    s_waitcnt lgkmcnt(0)
    v_mov_b32 v40, -1
    v_mov_b32 v41, -1
    v_mov_b32 v43, -1
    v_mov_b32 v42, -1
    s_add_u32 s3, s42, 2
    s_bitset1_b32 s36, s3
    s_branch L2_xg79
L2_c80:
    s_lshl_b64 s[52:53], s[82:83], 1
    s_andn2_b64 s[52:53], s[52:53], s[80:81]
    s_andn2_b64 s[52:53], s[52:53], s[54:55]
    s_or_b64 s[80:81], s[80:81], s[52:53]
    s_not_b64 vcc, s[52:53]
    s_mov_b64 exec, -1
    v_cndmask_b32_dpp v84, v84, v84, vcc wave_shr:1 row_mask:0xf bank_mask:0xf
    v_cndmask_b32_dpp v85, v85, v85, vcc wave_shr:1 row_mask:0xf bank_mask:0xf
    s_lshr_b64 s[52:53], s[52:53], 1
    v_cndmask_b32_dpp v86, v86, v86, vcc wave_shr:1 row_mask:0xf bank_mask:0xf
    v_cndmask_b32_dpp v87, v87, v87, vcc wave_shr:1 row_mask:0xf bank_mask:0xf
    s_andn2_b64 s[82:83], s[82:83], s[52:53]
    v_cndmask_b32_dpp v7, v7, v7, vcc wave_shr:1 row_mask:0xf bank_mask:0xf
    s_mov_b64 exec, s[54:55]
    s_cbranch_scc0 L2_d80
    s_mov_b64 exec, s[82:83]
    s_nop 1
    v_mfma_f32_4x4x4_16b_bf16 v[88:91], v[12:13], v[84:85], 0
    s_nop 1
    v_mfma_f32_4x4x4_16b_bf16 v[88:91], v[10:11], v[86:87], v[88:91]
    s_nop 4
    v_cvt_pk_bf16_f32 v88, v88, v89
    v_cvt_pk_bf16_f32 v89, v90, v91
    ds_pk_add_bf16 v7, v88 offset:65408
    ds_pk_add_bf16 v7, v89 offset:65412
    s_mov_b64 exec, s[54:55]
    s_branch L2_d80
L2_c81:
    s_lshl_b64 s[52:53], s[82:83], 1
    s_andn2_b64 s[52:53], s[52:53], s[80:81]
    s_andn2_b64 s[52:53], s[52:53], s[50:51]
    s_or_b64 s[80:81], s[80:81], s[52:53]
    s_not_b64 vcc, s[52:53]
    s_mov_b64 exec, -1
    v_cndmask_b32_dpp v84, v84, v84, vcc wave_shr:1 row_mask:0xf bank_mask:0xf
    v_cndmask_b32_dpp v85, v85, v85, vcc wave_shr:1 row_mask:0xf bank_mask:0xf
    s_lshr_b64 s[52:53], s[52:53], 1
    v_cndmask_b32_dpp v86, v86, v86, vcc wave_shr:1 row_mask:0xf bank_mask:0xf
    v_cndmask_b32_dpp v87, v87, v87, vcc wave_shr:1 row_mask:0xf bank_mask:0xf
    s_andn2_b64 s[82:83], s[82:83], s[52:53]
    v_cndmask_b32_dpp v7, v7, v7, vcc wave_shr:1 row_mask:0xf bank_mask:0xf
    s_mov_b64 exec, s[50:51]
    s_cbranch_scc0 L2_d81
    s_mov_b64 exec, s[82:83]
    s_nop 1
    v_mfma_f32_4x4x4_16b_bf16 v[88:91], v[12:13], v[84:85], 0
    s_nop 1
    v_mfma_f32_4x4x4_16b_bf16 v[88:91], v[10:11], v[86:87], v[88:91]
    s_nop 4
    v_cvt_pk_bf16_f32 v88, v88, v89
    v_cvt_pk_bf16_f32 v89, v90, v91
    ds_pk_add_bf16 v7, v88 offset:65408
    ds_pk_add_bf16 v7, v89 offset:65412
    s_mov_b64 exec, s[50:51]
    s_branch L2_d81
L2_oa82:
    v_and_b32 v47, 0x0fffffff, v32
    buffer_load_dword v114, v47, s[8:11], 0 offen offset:16
    s_mov_b64 exec, s[6:7]
    v_add_u32 v47, 8, v47
    v_lshrrev_b32 v32, 2, v32
    s_mov_b64 exec, -1
    buffer_load_dwordx2 v[112:113], v47, s[8:11], 0 offen
    s_branch L2_ob82
L2_c83:
    s_lshl_b64 s[52:53], s[82:83], 1
    s_andn2_b64 s[52:53], s[52:53], s[80:81]
    s_andn2_b64 s[52:53], s[52:53], s[54:55]
    s_or_b64 s[80:81], s[80:81], s[52:53]
    s_not_b64 vcc, s[52:53]
    s_mov_b64 exec, -1
    v_cndmask_b32_dpp v84, v84, v84, vcc wave_shr:1 row_mask:0xf bank_mask:0xf
    v_cndmask_b32_dpp v85, v85, v85, vcc wave_shr:1 row_mask:0xf bank_mask:0xf
    s_lshr_b64 s[52:53], s[52:53], 1
    v_cndmask_b32_dpp v86, v86, v86, vcc wave_shr:1 row_mask:0xf bank_mask:0xf
    v_cndmask_b32_dpp v87, v87, v87, vcc wave_shr:1 row_mask:0xf bank_mask:0xf
    s_andn2_b64 s[82:83], s[82:83], s[52:53]
    v_cndmask_b32_dpp v7, v7, v7, vcc wave_shr:1 row_mask:0xf bank_mask:0xf
    s_mov_b64 exec, s[54:55]
    s_cbranch_scc0 L2_d83
    s_mov_b64 exec, s[82:83]
    s_nop 1
    v_mfma_f32_4x4x4_16b_bf16 v[88:91], v[12:13], v[84:85], 0
    s_nop 1
    v_mfma_f32_4x4x4_16b_bf16 v[88:91], v[10:11], v[86:87], v[88:91]
    s_nop 4
    v_cvt_pk_bf16_f32 v88, v88, v89
    v_cvt_pk_bf16_f32 v89, v90, v91
    ds_pk_add_bf16 v7, v88 offset:65408
    ds_pk_add_bf16 v7, v89 offset:65412
    s_mov_b64 exec, s[54:55]
    s_branch L2_d83
L2_c84:
    s_lshl_b64 s[52:53], s[82:83], 1
    s_andn2_b64 s[52:53], s[52:53], s[80:81]
    s_andn2_b64 s[52:53], s[52:53], s[50:51]
    s_or_b64 s[80:81], s[80:81], s[52:53]
    s_not_b64 vcc, s[52:53]
    s_mov_b64 exec, -1
    v_cndmask_b32_dpp v84, v84, v84, vcc wave_shr:1 row_mask:0xf bank_mask:0xf
    v_cndmask_b32_dpp v85, v85, v85, vcc wave_shr:1 row_mask:0xf bank_mask:0xf
    s_lshr_b64 s[52:53], s[52:53], 1
    v_cndmask_b32_dpp v86, v86, v86, vcc wave_shr:1 row_mask:0xf bank_mask:0xf
    v_cndmask_b32_dpp v87, v87, v87, vcc wave_shr:1 row_mask:0xf bank_mask:0xf
    s_andn2_b64 s[82:83], s[82:83], s[52:53]
    v_cndmask_b32_dpp v7, v7, v7, vcc wave_shr:1 row_mask:0xf bank_mask:0xf
    s_mov_b64 exec, s[50:51]
    s_cbranch_scc0 L2_d84
    s_mov_b64 exec, s[82:83]
    s_nop 1
    v_mfma_f32_4x4x4_16b_bf16 v[88:91], v[12:13], v[84:85], 0
    s_nop 1
    v_mfma_f32_4x4x4_16b_bf16 v[88:91], v[10:11], v[86:87], v[88:91]
    s_nop 4
    v_cvt_pk_bf16_f32 v88, v88, v89
    v_cvt_pk_bf16_f32 v89, v90, v91
    ds_pk_add_bf16 v7, v88 offset:65408
    ds_pk_add_bf16 v7, v89 offset:65412
    s_mov_b64 exec, s[50:51]
    s_branch L2_d84
L2_c85:
    s_lshl_b64 s[52:53], s[82:83], 1
    s_andn2_b64 s[52:53], s[52:53], s[80:81]
    s_andn2_b64 s[52:53], s[52:53], s[54:55]
    s_or_b64 s[80:81], s[80:81], s[52:53]
    s_not_b64 vcc, s[52:53]
    s_mov_b64 exec, -1
    v_cndmask_b32_dpp v84, v84, v84, vcc wave_shr:1 row_mask:0xf bank_mask:0xf
    v_cndmask_b32_dpp v85, v85, v85, vcc wave_shr:1 row_mask:0xf bank_mask:0xf
    s_lshr_b64 s[52:53], s[52:53], 1
    v_cndmask_b32_dpp v86, v86, v86, vcc wave_shr:1 row_mask:0xf bank_mask:0xf
    v_cndmask_b32_dpp v87, v87, v87, vcc wave_shr:1 row_mask:0xf bank_mask:0xf
    s_andn2_b64 s[82:83], s[82:83], s[52:53]
    v_cndmask_b32_dpp v7, v7, v7, vcc wave_shr:1 row_mask:0xf bank_mask:0xf
    s_mov_b64 exec, s[54:55]
    s_cbranch_scc0 L2_d85
    s_mov_b64 exec, s[82:83]
    s_nop 1
    v_mfma_f32_4x4x4_16b_bf16 v[88:91], v[12:13], v[84:85], 0
    s_nop 1
    v_mfma_f32_4x4x4_16b_bf16 v[88:91], v[10:11], v[86:87], v[88:91]
    s_nop 4
    v_cvt_pk_bf16_f32 v88, v88, v89
    v_cvt_pk_bf16_f32 v89, v90, v91
    ds_pk_add_bf16 v7, v88 offset:65408
    ds_pk_add_bf16 v7, v89 offset:65412
    s_mov_b64 exec, s[54:55]
    s_branch L2_d85
L2_c86:
    s_lshl_b64 s[52:53], s[82:83], 1
    s_andn2_b64 s[52:53], s[52:53], s[80:81]
    s_andn2_b64 s[52:53], s[52:53], s[50:51]
    s_or_b64 s[80:81], s[80:81], s[52:53]
    s_not_b64 vcc, s[52:53]
    s_mov_b64 exec, -1
    v_cndmask_b32_dpp v84, v84, v84, vcc wave_shr:1 row_mask:0xf bank_mask:0xf
    v_cndmask_b32_dpp v85, v85, v85, vcc wave_shr:1 row_mask:0xf bank_mask:0xf
    s_lshr_b64 s[52:53], s[52:53], 1
    v_cndmask_b32_dpp v86, v86, v86, vcc wave_shr:1 row_mask:0xf bank_mask:0xf
    v_cndmask_b32_dpp v87, v87, v87, vcc wave_shr:1 row_mask:0xf bank_mask:0xf
    s_andn2_b64 s[82:83], s[82:83], s[52:53]
    v_cndmask_b32_dpp v7, v7, v7, vcc wave_shr:1 row_mask:0xf bank_mask:0xf
    s_mov_b64 exec, s[50:51]
    s_cbranch_scc0 L2_d86
    s_mov_b64 exec, s[82:83]
    s_nop 1
    v_mfma_f32_4x4x4_16b_bf16 v[88:91], v[12:13], v[84:85], 0
    s_nop 1
    v_mfma_f32_4x4x4_16b_bf16 v[88:91], v[10:11], v[86:87], v[88:91]
    s_nop 4
    v_cvt_pk_bf16_f32 v88, v88, v89
    v_cvt_pk_bf16_f32 v89, v90, v91
    ds_pk_add_bf16 v7, v88 offset:65408
    ds_pk_add_bf16 v7, v89 offset:65412
    s_mov_b64 exec, s[50:51]
    s_branch L2_d86
L2_c87:
    s_lshl_b64 s[52:53], s[82:83], 1
    s_andn2_b64 s[52:53], s[52:53], s[80:81]
    s_andn2_b64 s[52:53], s[52:53], s[54:55]
    s_or_b64 s[80:81], s[80:81], s[52:53]
    s_not_b64 vcc, s[52:53]
    s_mov_b64 exec, -1
    v_cndmask_b32_dpp v84, v84, v84, vcc wave_shr:1 row_mask:0xf bank_mask:0xf
    v_cndmask_b32_dpp v85, v85, v85, vcc wave_shr:1 row_mask:0xf bank_mask:0xf
    s_lshr_b64 s[52:53], s[52:53], 1
    v_cndmask_b32_dpp v86, v86, v86, vcc wave_shr:1 row_mask:0xf bank_mask:0xf
    v_cndmask_b32_dpp v87, v87, v87, vcc wave_shr:1 row_mask:0xf bank_mask:0xf
    s_andn2_b64 s[82:83], s[82:83], s[52:53]
    v_cndmask_b32_dpp v7, v7, v7, vcc wave_shr:1 row_mask:0xf bank_mask:0xf
    s_mov_b64 exec, s[54:55]
    s_cbranch_scc0 L2_d87
    s_mov_b64 exec, s[82:83]
    s_nop 1
    v_mfma_f32_4x4x4_16b_bf16 v[88:91], v[12:13], v[84:85], 0
    s_nop 1
    v_mfma_f32_4x4x4_16b_bf16 v[88:91], v[10:11], v[86:87], v[88:91]
    s_nop 4
    v_cvt_pk_bf16_f32 v88, v88, v89
    v_cvt_pk_bf16_f32 v89, v90, v91
    ds_pk_add_bf16 v7, v88 offset:65408
    ds_pk_add_bf16 v7, v89 offset:65412
    s_mov_b64 exec, s[54:55]
    s_branch L2_d87
L2_c88:
    s_lshl_b64 s[52:53], s[82:83], 1
    s_andn2_b64 s[52:53], s[52:53], s[80:81]
    s_andn2_b64 s[52:53], s[52:53], s[50:51]
    s_or_b64 s[80:81], s[80:81], s[52:53]
    s_not_b64 vcc, s[52:53]
    s_mov_b64 exec, -1
    v_cndmask_b32_dpp v84, v84, v84, vcc wave_shr:1 row_mask:0xf bank_mask:0xf
    v_cndmask_b32_dpp v85, v85, v85, vcc wave_shr:1 row_mask:0xf bank_mask:0xf
    s_lshr_b64 s[52:53], s[52:53], 1
    v_cndmask_b32_dpp v86, v86, v86, vcc wave_shr:1 row_mask:0xf bank_mask:0xf
    v_cndmask_b32_dpp v87, v87, v87, vcc wave_shr:1 row_mask:0xf bank_mask:0xf
    s_andn2_b64 s[82:83], s[82:83], s[52:53]
    v_cndmask_b32_dpp v7, v7, v7, vcc wave_shr:1 row_mask:0xf bank_mask:0xf
    s_mov_b64 exec, s[50:51]
    s_cbranch_scc0 L2_d88
    s_mov_b64 exec, s[82:83]
    s_nop 1
    v_mfma_f32_4x4x4_16b_bf16 v[88:91], v[12:13], v[84:85], 0
    s_nop 1
    v_mfma_f32_4x4x4_16b_bf16 v[88:91], v[10:11], v[86:87], v[88:91]
    s_nop 4
    v_cvt_pk_bf16_f32 v88, v88, v89
    v_cvt_pk_bf16_f32 v89, v90, v91
    ds_pk_add_bf16 v7, v88 offset:65408
    ds_pk_add_bf16 v7, v89 offset:65412
    s_mov_b64 exec, s[50:51]
    s_branch L2_d88
L2_oa89:
    s_waitcnt vmcnt(3)
    s_mov_b64 exec, s[6:7]
    v_lshrrev_b32 v114, 16, v114
    s_mov_b64 exec, -1
    v_and_b32 v46, 0x10000000, v32
    v_cmpx_eq_u32 vcc, 0, v46
    v_lshrrev_b32 v47, 14, v112
    v_and_b32 v47, v5, v47
    ds_read_b64 v[96:97], v47
    v_perm_b32 v98, v112, v114, s44
    v_bitop3_b32 v99, v112, 0.5, -0.5 bitop3:0xa8
    v_bitop3_b32 v98, v6, v98, v99 bitop3:0xca
    v_and_b32 v47, v5, v112
    s_waitcnt lgkmcnt(0)
    v_mfma_f32_4x4x4_16b_bf16 v[88:91], v[8:9], v[96:97], 0
    s_nop 4
    v_mul_f32 v88, v98, v88
    v_mul_f32 v89, v98, v89
    v_mul_f32 v90, v98, v90
    v_mul_f32 v91, v98, v91
    v_cvt_pk_bf16_f32 v88, v88, v89
    v_cvt_pk_bf16_f32 v89, v90, v91
    ds_pk_add_bf16 v47, v88 offset:65408
    ds_pk_add_bf16 v47, v89 offset:65412
    s_mov_b64 exec, -1
    v_and_b32 v46, 0x20000000, v32
    v_cmpx_eq_u32 vcc, 0, v46
    v_lshrrev_b32 v47, 14, v113
    v_and_b32 v47, v5, v47
    ds_read_b64 v[96:97], v47
    v_perm_b32 v98, v113, v114, s45
    v_bitop3_b32 v99, v113, 0.5, -0.5 bitop3:0xa8
    v_bitop3_b32 v98, v6, v98, v99 bitop3:0xca
    v_and_b32 v47, v5, v113
    s_waitcnt lgkmcnt(0)
    v_mfma_f32_4x4x4_16b_bf16 v[88:91], v[8:9], v[96:97], 0
    s_nop 4
    v_mul_f32 v88, v98, v88
    v_mul_f32 v89, v98, v89
    v_mul_f32 v90, v98, v90
    v_mul_f32 v91, v98, v91
    v_cvt_pk_bf16_f32 v88, v88, v89
    v_cvt_pk_bf16_f32 v89, v90, v91
    ds_pk_add_bf16 v47, v88 offset:65408
    ds_pk_add_bf16 v47, v89 offset:65412
    s_mov_b64 exec, -1
    s_branch L2_ob89
L2_xo90:
    v_cmp_lt_u32 vcc, 20, v99
    s_mov_b32 s101, 1
    s_cbranch_vccz L2_xp90
    v_cmp_lt_u32 vcc, 32, v99
    v_cmp_lt_u32 s[58:59], 31, v88
    s_mov_b32 s101, 2
    s_or_b64 vcc, vcc, s[58:59]
    s_cbranch_scc0 L2_xp90
    s_mov_b32 s37, 0x10000
    s_branch L2_xp90
L2_c91:
    s_lshl_b64 s[52:53], s[82:83], 1
    s_andn2_b64 s[52:53], s[52:53], s[80:81]
    s_andn2_b64 s[52:53], s[52:53], s[54:55]
    s_or_b64 s[80:81], s[80:81], s[52:53]
    s_not_b64 vcc, s[52:53]
    s_mov_b64 exec, -1
    v_cndmask_b32_dpp v84, v84, v84, vcc wave_shr:1 row_mask:0xf bank_mask:0xf
    v_cndmask_b32_dpp v85, v85, v85, vcc wave_shr:1 row_mask:0xf bank_mask:0xf
    s_lshr_b64 s[52:53], s[52:53], 1
    v_cndmask_b32_dpp v86, v86, v86, vcc wave_shr:1 row_mask:0xf bank_mask:0xf
    v_cndmask_b32_dpp v87, v87, v87, vcc wave_shr:1 row_mask:0xf bank_mask:0xf
    s_andn2_b64 s[82:83], s[82:83], s[52:53]
    v_cndmask_b32_dpp v7, v7, v7, vcc wave_shr:1 row_mask:0xf bank_mask:0xf
    s_mov_b64 exec, s[54:55]
    s_cbranch_scc0 L2_d91
    s_mov_b64 exec, s[82:83]
    s_nop 1
    v_mfma_f32_4x4x4_16b_bf16 v[88:91], v[12:13], v[84:85], 0
    s_nop 1
    v_mfma_f32_4x4x4_16b_bf16 v[88:91], v[10:11], v[86:87], v[88:91]
    s_nop 4
    v_cvt_pk_bf16_f32 v88, v88, v89
    v_cvt_pk_bf16_f32 v89, v90, v91
    ds_pk_add_bf16 v7, v88 offset:65408
    ds_pk_add_bf16 v7, v89 offset:65412
    s_mov_b64 exec, s[54:55]
    s_branch L2_d91
L2_c92:
    s_lshl_b64 s[52:53], s[82:83], 1
    s_andn2_b64 s[52:53], s[52:53], s[80:81]
    s_andn2_b64 s[52:53], s[52:53], s[50:51]
    s_or_b64 s[80:81], s[80:81], s[52:53]
    s_not_b64 vcc, s[52:53]
    s_mov_b64 exec, -1
    v_cndmask_b32_dpp v84, v84, v84, vcc wave_shr:1 row_mask:0xf bank_mask:0xf
    v_cndmask_b32_dpp v85, v85, v85, vcc wave_shr:1 row_mask:0xf bank_mask:0xf
    s_lshr_b64 s[52:53], s[52:53], 1
    v_cndmask_b32_dpp v86, v86, v86, vcc wave_shr:1 row_mask:0xf bank_mask:0xf
    v_cndmask_b32_dpp v87, v87, v87, vcc wave_shr:1 row_mask:0xf bank_mask:0xf
    s_andn2_b64 s[82:83], s[82:83], s[52:53]
    v_cndmask_b32_dpp v7, v7, v7, vcc wave_shr:1 row_mask:0xf bank_mask:0xf
    s_mov_b64 exec, s[50:51]
    s_cbranch_scc0 L2_d92
    s_mov_b64 exec, s[82:83]
    s_nop 1
    v_mfma_f32_4x4x4_16b_bf16 v[88:91], v[12:13], v[84:85], 0
    s_nop 1
    v_mfma_f32_4x4x4_16b_bf16 v[88:91], v[10:11], v[86:87], v[88:91]
    s_nop 4
    v_cvt_pk_bf16_f32 v88, v88, v89
    v_cvt_pk_bf16_f32 v89, v90, v91
    ds_pk_add_bf16 v7, v88 offset:65408
    ds_pk_add_bf16 v7, v89 offset:65412
    s_mov_b64 exec, s[50:51]
    s_branch L2_d92
L2_c93:
    s_lshl_b64 s[52:53], s[82:83], 1
    s_andn2_b64 s[52:53], s[52:53], s[80:81]
    s_andn2_b64 s[52:53], s[52:53], s[54:55]
    s_or_b64 s[80:81], s[80:81], s[52:53]
    s_not_b64 vcc, s[52:53]
    s_mov_b64 exec, -1
    v_cndmask_b32_dpp v84, v84, v84, vcc wave_shr:1 row_mask:0xf bank_mask:0xf
    v_cndmask_b32_dpp v85, v85, v85, vcc wave_shr:1 row_mask:0xf bank_mask:0xf
    s_lshr_b64 s[52:53], s[52:53], 1
    v_cndmask_b32_dpp v86, v86, v86, vcc wave_shr:1 row_mask:0xf bank_mask:0xf
    v_cndmask_b32_dpp v87, v87, v87, vcc wave_shr:1 row_mask:0xf bank_mask:0xf
    s_andn2_b64 s[82:83], s[82:83], s[52:53]
    v_cndmask_b32_dpp v7, v7, v7, vcc wave_shr:1 row_mask:0xf bank_mask:0xf
    s_mov_b64 exec, s[54:55]
    s_cbranch_scc0 L2_d93
    s_mov_b64 exec, s[82:83]
    s_nop 1
    v_mfma_f32_4x4x4_16b_bf16 v[88:91], v[12:13], v[84:85], 0
    s_nop 1
    v_mfma_f32_4x4x4_16b_bf16 v[88:91], v[10:11], v[86:87], v[88:91]
    s_nop 4
    v_cvt_pk_bf16_f32 v88, v88, v89
    v_cvt_pk_bf16_f32 v89, v90, v91
    ds_pk_add_bf16 v7, v88 offset:65408
    ds_pk_add_bf16 v7, v89 offset:65412
    s_mov_b64 exec, s[54:55]
    s_branch L2_d93
L2_c94:
    s_lshl_b64 s[52:53], s[82:83], 1
    s_andn2_b64 s[52:53], s[52:53], s[80:81]
    s_andn2_b64 s[52:53], s[52:53], s[50:51]
    s_or_b64 s[80:81], s[80:81], s[52:53]
    s_not_b64 vcc, s[52:53]
    s_mov_b64 exec, -1
    v_cndmask_b32_dpp v84, v84, v84, vcc wave_shr:1 row_mask:0xf bank_mask:0xf
    v_cndmask_b32_dpp v85, v85, v85, vcc wave_shr:1 row_mask:0xf bank_mask:0xf
    s_lshr_b64 s[52:53], s[52:53], 1
    v_cndmask_b32_dpp v86, v86, v86, vcc wave_shr:1 row_mask:0xf bank_mask:0xf
    v_cndmask_b32_dpp v87, v87, v87, vcc wave_shr:1 row_mask:0xf bank_mask:0xf
    s_andn2_b64 s[82:83], s[82:83], s[52:53]
    v_cndmask_b32_dpp v7, v7, v7, vcc wave_shr:1 row_mask:0xf bank_mask:0xf
    s_mov_b64 exec, s[50:51]
    s_cbranch_scc0 L2_d94
    s_mov_b64 exec, s[82:83]
    s_nop 1
    v_mfma_f32_4x4x4_16b_bf16 v[88:91], v[12:13], v[84:85], 0
    s_nop 1
    v_mfma_f32_4x4x4_16b_bf16 v[88:91], v[10:11], v[86:87], v[88:91]
    s_nop 4
    v_cvt_pk_bf16_f32 v88, v88, v89
    v_cvt_pk_bf16_f32 v89, v90, v91
    ds_pk_add_bf16 v7, v88 offset:65408
    ds_pk_add_bf16 v7, v89 offset:65412
    s_mov_b64 exec, s[50:51]
    s_branch L2_d94
L2_c95:
    s_lshl_b64 s[52:53], s[82:83], 1
    s_andn2_b64 s[52:53], s[52:53], s[80:81]
    s_andn2_b64 s[52:53], s[52:53], s[54:55]
    s_or_b64 s[80:81], s[80:81], s[52:53]
    s_not_b64 vcc, s[52:53]
    s_mov_b64 exec, -1
    v_cndmask_b32_dpp v84, v84, v84, vcc wave_shr:1 row_mask:0xf bank_mask:0xf
    v_cndmask_b32_dpp v85, v85, v85, vcc wave_shr:1 row_mask:0xf bank_mask:0xf
    s_lshr_b64 s[52:53], s[52:53], 1
    v_cndmask_b32_dpp v86, v86, v86, vcc wave_shr:1 row_mask:0xf bank_mask:0xf
    v_cndmask_b32_dpp v87, v87, v87, vcc wave_shr:1 row_mask:0xf bank_mask:0xf
    s_andn2_b64 s[82:83], s[82:83], s[52:53]
    v_cndmask_b32_dpp v7, v7, v7, vcc wave_shr:1 row_mask:0xf bank_mask:0xf
    s_mov_b64 exec, s[54:55]
    s_cbranch_scc0 L2_d95
    s_mov_b64 exec, s[82:83]
    s_nop 1
    v_mfma_f32_4x4x4_16b_bf16 v[88:91], v[12:13], v[84:85], 0
    s_nop 1
    v_mfma_f32_4x4x4_16b_bf16 v[88:91], v[10:11], v[86:87], v[88:91]
    s_nop 4
    v_cvt_pk_bf16_f32 v88, v88, v89
    v_cvt_pk_bf16_f32 v89, v90, v91
    ds_pk_add_bf16 v7, v88 offset:65408
    ds_pk_add_bf16 v7, v89 offset:65412
    s_mov_b64 exec, s[54:55]
    s_branch L2_d95
L2_c96:
    s_lshl_b64 s[52:53], s[82:83], 1
    s_andn2_b64 s[52:53], s[52:53], s[80:81]
    s_andn2_b64 s[52:53], s[52:53], s[50:51]
    s_or_b64 s[80:81], s[80:81], s[52:53]
    s_not_b64 vcc, s[52:53]
    s_mov_b64 exec, -1
    v_cndmask_b32_dpp v84, v84, v84, vcc wave_shr:1 row_mask:0xf bank_mask:0xf
    v_cndmask_b32_dpp v85, v85, v85, vcc wave_shr:1 row_mask:0xf bank_mask:0xf
    s_lshr_b64 s[52:53], s[52:53], 1
    v_cndmask_b32_dpp v86, v86, v86, vcc wave_shr:1 row_mask:0xf bank_mask:0xf
    v_cndmask_b32_dpp v87, v87, v87, vcc wave_shr:1 row_mask:0xf bank_mask:0xf
    s_andn2_b64 s[82:83], s[82:83], s[52:53]
    v_cndmask_b32_dpp v7, v7, v7, vcc wave_shr:1 row_mask:0xf bank_mask:0xf
    s_mov_b64 exec, s[50:51]
    s_cbranch_scc0 L2_d96
    s_mov_b64 exec, s[82:83]
    s_nop 1
    v_mfma_f32_4x4x4_16b_bf16 v[88:91], v[12:13], v[84:85], 0
    s_nop 1
    v_mfma_f32_4x4x4_16b_bf16 v[88:91], v[10:11], v[86:87], v[88:91]
    s_nop 4
    v_cvt_pk_bf16_f32 v88, v88, v89
    v_cvt_pk_bf16_f32 v89, v90, v91
    ds_pk_add_bf16 v7, v88 offset:65408
    ds_pk_add_bf16 v7, v89 offset:65412
    s_mov_b64 exec, s[50:51]
    s_branch L2_d96
L2_xa97:
    s_cmp_eq_u32 s101, 1
    s_cbranch_scc1 L2_xc97
    v_lshlrev_b32 v89, 0, v96
    v_add_u32 v90, 140, v97
    v_bitop3_b32 v90, v89, v45, v90 bitop3:0x6a
    ds_write_b32 v98, v90 offset:28
    v_lshlrev_b32 v89, 4, v96
    v_add_u32 v90, 120, v97
    v_bitop3_b32 v90, v89, v45, v90 bitop3:0x6a
    ds_write_b32 v98, v90 offset:24
    v_lshlrev_b32 v89, 8, v96
    v_add_u32 v90, 100, v97
    v_bitop3_b32 v90, v89, v45, v90 bitop3:0x6a
    ds_write_b32 v98, v90 offset:20
L2_xc97:
    v_lshlrev_b32 v89, 12, v96
    v_add_u32 v90, 80, v97
    v_bitop3_b32 v90, v89, v45, v90 bitop3:0x6a
    ds_write_b32 v98, v90 offset:16
    s_branch L2_xb97
L2_xe97:
    v_cmp_lt_u32 vcc, 32, v99
    v_cmp_lt_u32 s[58:59], 31, v88
    v_lshrrev_b32 v89, 16, v96
    v_add_u32 v97, 80, v97
    s_or_b64 vcc, vcc, s[58:59]
    s_cbranch_scc1 L2_xs97
    v_lshlrev_b32 v89, v1, v89
    v_and_b32 v89, v45, v89
    v_cmp_ne_u32 vcc, 0, v89
    v_xor_b32 v90, v97, v89
    s_add_u32 s3, s37, s38
    v_mbcnt_lo_u32_b32 v98, vcc_lo, 0
    v_mbcnt_hi_u32_b32 v98, vcc_hi, v98
    s_bcnt1_i32_b64 s41, vcc
    v_lshl_add_u32 v98, v98, 2, s3
    s_lshl2_add_u32 s37, s41, s37
    s_mov_b64 exec, vcc
    ds_write_b32 v98, v90
    s_mov_b64 exec, -1
    s_branch L2_xr97
L2_xf97:
    s_waitcnt lgkmcnt(0)
    s_cmp_gt_u32 s37, 1024
    s_cbranch_scc1 L2_xs97
    s_cmp_lt_u32 s37, 768
    s_cbranch_scc1 L2_xl97
    ds_read_b32 v32, v98 offset:896
    s_add_u32 s3, s42, 2
    s_bitset1_b32 s43, s3
    s_branch L2_xg97
L2_xl97:
    v_mov_b32 v42, -1
    s_cmp_ge_u32 s37, 512
    s_cbranch_scc1 L2_xg97
    v_mov_b32 v43, -1
    s_cmp_ge_u32 s37, 256
    s_cbranch_scc1 L2_xg97
    v_mov_b32 v41, -1
    s_branch L2_xg97
L2_xs97:
    s_waitcnt lgkmcnt(0)
    v_mov_b32 v40, -1
    v_mov_b32 v41, -1
    v_mov_b32 v43, -1
    v_mov_b32 v42, -1
    s_add_u32 s3, s42, 2
    s_bitset1_b32 s36, s3
    s_branch L2_xg97
L2_c98:
    s_lshl_b64 s[52:53], s[82:83], 1
    s_andn2_b64 s[52:53], s[52:53], s[80:81]
    s_andn2_b64 s[52:53], s[52:53], s[54:55]
    s_or_b64 s[80:81], s[80:81], s[52:53]
    s_not_b64 vcc, s[52:53]
    s_mov_b64 exec, -1
    v_cndmask_b32_dpp v84, v84, v84, vcc wave_shr:1 row_mask:0xf bank_mask:0xf
    v_cndmask_b32_dpp v85, v85, v85, vcc wave_shr:1 row_mask:0xf bank_mask:0xf
    s_lshr_b64 s[52:53], s[52:53], 1
    v_cndmask_b32_dpp v86, v86, v86, vcc wave_shr:1 row_mask:0xf bank_mask:0xf
    v_cndmask_b32_dpp v87, v87, v87, vcc wave_shr:1 row_mask:0xf bank_mask:0xf
    s_andn2_b64 s[82:83], s[82:83], s[52:53]
    v_cndmask_b32_dpp v7, v7, v7, vcc wave_shr:1 row_mask:0xf bank_mask:0xf
    s_mov_b64 exec, s[54:55]
    s_cbranch_scc0 L2_d98
    s_mov_b64 exec, s[82:83]
    s_nop 1
    v_mfma_f32_4x4x4_16b_bf16 v[88:91], v[12:13], v[84:85], 0
    s_nop 1
    v_mfma_f32_4x4x4_16b_bf16 v[88:91], v[10:11], v[86:87], v[88:91]
    s_nop 4
    v_cvt_pk_bf16_f32 v88, v88, v89
    v_cvt_pk_bf16_f32 v89, v90, v91
    ds_pk_add_bf16 v7, v88 offset:65408
    ds_pk_add_bf16 v7, v89 offset:65412
    s_mov_b64 exec, s[54:55]
    s_branch L2_d98
L2_c99:
    s_lshl_b64 s[52:53], s[82:83], 1
    s_andn2_b64 s[52:53], s[52:53], s[80:81]
    s_andn2_b64 s[52:53], s[52:53], s[50:51]
    s_or_b64 s[80:81], s[80:81], s[52:53]
    s_not_b64 vcc, s[52:53]
    s_mov_b64 exec, -1
    v_cndmask_b32_dpp v84, v84, v84, vcc wave_shr:1 row_mask:0xf bank_mask:0xf
    v_cndmask_b32_dpp v85, v85, v85, vcc wave_shr:1 row_mask:0xf bank_mask:0xf
    s_lshr_b64 s[52:53], s[52:53], 1
    v_cndmask_b32_dpp v86, v86, v86, vcc wave_shr:1 row_mask:0xf bank_mask:0xf
    v_cndmask_b32_dpp v87, v87, v87, vcc wave_shr:1 row_mask:0xf bank_mask:0xf
    s_andn2_b64 s[82:83], s[82:83], s[52:53]
    v_cndmask_b32_dpp v7, v7, v7, vcc wave_shr:1 row_mask:0xf bank_mask:0xf
    s_mov_b64 exec, s[50:51]
    s_cbranch_scc0 L2_d99
    s_mov_b64 exec, s[82:83]
    s_nop 1
    v_mfma_f32_4x4x4_16b_bf16 v[88:91], v[12:13], v[84:85], 0
    s_nop 1
    v_mfma_f32_4x4x4_16b_bf16 v[88:91], v[10:11], v[86:87], v[88:91]
    s_nop 4
    v_cvt_pk_bf16_f32 v88, v88, v89
    v_cvt_pk_bf16_f32 v89, v90, v91
    ds_pk_add_bf16 v7, v88 offset:65408
    ds_pk_add_bf16 v7, v89 offset:65412
    s_mov_b64 exec, s[50:51]
    s_branch L2_d99
L2_oa100:
    v_and_b32 v47, 0x0fffffff, v33
    buffer_load_dword v114, v47, s[8:11], 0 offen offset:16
    s_mov_b64 exec, s[6:7]
    v_add_u32 v47, 8, v47
    v_lshrrev_b32 v33, 2, v33
    s_mov_b64 exec, -1
    buffer_load_dwordx2 v[112:113], v47, s[8:11], 0 offen
    s_branch L2_ob100
L2_c101:
    s_lshl_b64 s[52:53], s[82:83], 1
    s_andn2_b64 s[52:53], s[52:53], s[80:81]
    s_andn2_b64 s[52:53], s[52:53], s[54:55]
    s_or_b64 s[80:81], s[80:81], s[52:53]
    s_not_b64 vcc, s[52:53]
    s_mov_b64 exec, -1
    v_cndmask_b32_dpp v84, v84, v84, vcc wave_shr:1 row_mask:0xf bank_mask:0xf
    v_cndmask_b32_dpp v85, v85, v85, vcc wave_shr:1 row_mask:0xf bank_mask:0xf
    s_lshr_b64 s[52:53], s[52:53], 1
    v_cndmask_b32_dpp v86, v86, v86, vcc wave_shr:1 row_mask:0xf bank_mask:0xf
    v_cndmask_b32_dpp v87, v87, v87, vcc wave_shr:1 row_mask:0xf bank_mask:0xf
    s_andn2_b64 s[82:83], s[82:83], s[52:53]
    v_cndmask_b32_dpp v7, v7, v7, vcc wave_shr:1 row_mask:0xf bank_mask:0xf
    s_mov_b64 exec, s[54:55]
    s_cbranch_scc0 L2_d101
    s_mov_b64 exec, s[82:83]
    s_nop 1
    v_mfma_f32_4x4x4_16b_bf16 v[88:91], v[12:13], v[84:85], 0
    s_nop 1
    v_mfma_f32_4x4x4_16b_bf16 v[88:91], v[10:11], v[86:87], v[88:91]
    s_nop 4
    v_cvt_pk_bf16_f32 v88, v88, v89
    v_cvt_pk_bf16_f32 v89, v90, v91
    ds_pk_add_bf16 v7, v88 offset:65408
    ds_pk_add_bf16 v7, v89 offset:65412
    s_mov_b64 exec, s[54:55]
    s_branch L2_d101
L2_c102:
    s_lshl_b64 s[52:53], s[82:83], 1
    s_andn2_b64 s[52:53], s[52:53], s[80:81]
    s_andn2_b64 s[52:53], s[52:53], s[50:51]
    s_or_b64 s[80:81], s[80:81], s[52:53]
    s_not_b64 vcc, s[52:53]
    s_mov_b64 exec, -1
    v_cndmask_b32_dpp v84, v84, v84, vcc wave_shr:1 row_mask:0xf bank_mask:0xf
    v_cndmask_b32_dpp v85, v85, v85, vcc wave_shr:1 row_mask:0xf bank_mask:0xf
    s_lshr_b64 s[52:53], s[52:53], 1
    v_cndmask_b32_dpp v86, v86, v86, vcc wave_shr:1 row_mask:0xf bank_mask:0xf
    v_cndmask_b32_dpp v87, v87, v87, vcc wave_shr:1 row_mask:0xf bank_mask:0xf
    s_andn2_b64 s[82:83], s[82:83], s[52:53]
    v_cndmask_b32_dpp v7, v7, v7, vcc wave_shr:1 row_mask:0xf bank_mask:0xf
    s_mov_b64 exec, s[50:51]
    s_cbranch_scc0 L2_d102
    s_mov_b64 exec, s[82:83]
    s_nop 1
    v_mfma_f32_4x4x4_16b_bf16 v[88:91], v[12:13], v[84:85], 0
    s_nop 1
    v_mfma_f32_4x4x4_16b_bf16 v[88:91], v[10:11], v[86:87], v[88:91]
    s_nop 4
    v_cvt_pk_bf16_f32 v88, v88, v89
    v_cvt_pk_bf16_f32 v89, v90, v91
    ds_pk_add_bf16 v7, v88 offset:65408
    ds_pk_add_bf16 v7, v89 offset:65412
    s_mov_b64 exec, s[50:51]
    s_branch L2_d102
L2_c103:
    s_lshl_b64 s[52:53], s[82:83], 1
    s_andn2_b64 s[52:53], s[52:53], s[80:81]
    s_andn2_b64 s[52:53], s[52:53], s[54:55]
    s_or_b64 s[80:81], s[80:81], s[52:53]
    s_not_b64 vcc, s[52:53]
    s_mov_b64 exec, -1
    v_cndmask_b32_dpp v84, v84, v84, vcc wave_shr:1 row_mask:0xf bank_mask:0xf
    v_cndmask_b32_dpp v85, v85, v85, vcc wave_shr:1 row_mask:0xf bank_mask:0xf
    s_lshr_b64 s[52:53], s[52:53], 1
    v_cndmask_b32_dpp v86, v86, v86, vcc wave_shr:1 row_mask:0xf bank_mask:0xf
    v_cndmask_b32_dpp v87, v87, v87, vcc wave_shr:1 row_mask:0xf bank_mask:0xf
    s_andn2_b64 s[82:83], s[82:83], s[52:53]
    v_cndmask_b32_dpp v7, v7, v7, vcc wave_shr:1 row_mask:0xf bank_mask:0xf
    s_mov_b64 exec, s[54:55]
    s_cbranch_scc0 L2_d103
    s_mov_b64 exec, s[82:83]
    s_nop 1
    v_mfma_f32_4x4x4_16b_bf16 v[88:91], v[12:13], v[84:85], 0
    s_nop 1
    v_mfma_f32_4x4x4_16b_bf16 v[88:91], v[10:11], v[86:87], v[88:91]
    s_nop 4
    v_cvt_pk_bf16_f32 v88, v88, v89
    v_cvt_pk_bf16_f32 v89, v90, v91
    ds_pk_add_bf16 v7, v88 offset:65408
    ds_pk_add_bf16 v7, v89 offset:65412
    s_mov_b64 exec, s[54:55]
    s_branch L2_d103
L2_c104:
    s_lshl_b64 s[52:53], s[82:83], 1
    s_andn2_b64 s[52:53], s[52:53], s[80:81]
    s_andn2_b64 s[52:53], s[52:53], s[50:51]
    s_or_b64 s[80:81], s[80:81], s[52:53]
    s_not_b64 vcc, s[52:53]
    s_mov_b64 exec, -1
    v_cndmask_b32_dpp v84, v84, v84, vcc wave_shr:1 row_mask:0xf bank_mask:0xf
    v_cndmask_b32_dpp v85, v85, v85, vcc wave_shr:1 row_mask:0xf bank_mask:0xf
    s_lshr_b64 s[52:53], s[52:53], 1
    v_cndmask_b32_dpp v86, v86, v86, vcc wave_shr:1 row_mask:0xf bank_mask:0xf
    v_cndmask_b32_dpp v87, v87, v87, vcc wave_shr:1 row_mask:0xf bank_mask:0xf
    s_andn2_b64 s[82:83], s[82:83], s[52:53]
    v_cndmask_b32_dpp v7, v7, v7, vcc wave_shr:1 row_mask:0xf bank_mask:0xf
    s_mov_b64 exec, s[50:51]
    s_cbranch_scc0 L2_d104
    s_mov_b64 exec, s[82:83]
    s_nop 1
    v_mfma_f32_4x4x4_16b_bf16 v[88:91], v[12:13], v[84:85], 0
    s_nop 1
    v_mfma_f32_4x4x4_16b_bf16 v[88:91], v[10:11], v[86:87], v[88:91]
    s_nop 4
    v_cvt_pk_bf16_f32 v88, v88, v89
    v_cvt_pk_bf16_f32 v89, v90, v91
    ds_pk_add_bf16 v7, v88 offset:65408
    ds_pk_add_bf16 v7, v89 offset:65412
    s_mov_b64 exec, s[50:51]
    s_branch L2_d104
L2_c105:
    s_lshl_b64 s[52:53], s[82:83], 1
    s_andn2_b64 s[52:53], s[52:53], s[80:81]
    s_andn2_b64 s[52:53], s[52:53], s[54:55]
    s_or_b64 s[80:81], s[80:81], s[52:53]
    s_not_b64 vcc, s[52:53]
    s_mov_b64 exec, -1
    v_cndmask_b32_dpp v84, v84, v84, vcc wave_shr:1 row_mask:0xf bank_mask:0xf
    v_cndmask_b32_dpp v85, v85, v85, vcc wave_shr:1 row_mask:0xf bank_mask:0xf
    s_lshr_b64 s[52:53], s[52:53], 1
    v_cndmask_b32_dpp v86, v86, v86, vcc wave_shr:1 row_mask:0xf bank_mask:0xf
    v_cndmask_b32_dpp v87, v87, v87, vcc wave_shr:1 row_mask:0xf bank_mask:0xf
    s_andn2_b64 s[82:83], s[82:83], s[52:53]
    v_cndmask_b32_dpp v7, v7, v7, vcc wave_shr:1 row_mask:0xf bank_mask:0xf
    s_mov_b64 exec, s[54:55]
    s_cbranch_scc0 L2_d105
    s_mov_b64 exec, s[82:83]
    s_nop 1
    v_mfma_f32_4x4x4_16b_bf16 v[88:91], v[12:13], v[84:85], 0
    s_nop 1
    v_mfma_f32_4x4x4_16b_bf16 v[88:91], v[10:11], v[86:87], v[88:91]
    s_nop 4
    v_cvt_pk_bf16_f32 v88, v88, v89
    v_cvt_pk_bf16_f32 v89, v90, v91
    ds_pk_add_bf16 v7, v88 offset:65408
    ds_pk_add_bf16 v7, v89 offset:65412
    s_mov_b64 exec, s[54:55]
    s_branch L2_d105
L2_c106:
    s_lshl_b64 s[52:53], s[82:83], 1
    s_andn2_b64 s[52:53], s[52:53], s[80:81]
    s_andn2_b64 s[52:53], s[52:53], s[50:51]
    s_or_b64 s[80:81], s[80:81], s[52:53]
    s_not_b64 vcc, s[52:53]
    s_mov_b64 exec, -1
    v_cndmask_b32_dpp v84, v84, v84, vcc wave_shr:1 row_mask:0xf bank_mask:0xf
    v_cndmask_b32_dpp v85, v85, v85, vcc wave_shr:1 row_mask:0xf bank_mask:0xf
    s_lshr_b64 s[52:53], s[52:53], 1
    v_cndmask_b32_dpp v86, v86, v86, vcc wave_shr:1 row_mask:0xf bank_mask:0xf
    v_cndmask_b32_dpp v87, v87, v87, vcc wave_shr:1 row_mask:0xf bank_mask:0xf
    s_andn2_b64 s[82:83], s[82:83], s[52:53]
    v_cndmask_b32_dpp v7, v7, v7, vcc wave_shr:1 row_mask:0xf bank_mask:0xf
    s_mov_b64 exec, s[50:51]
    s_cbranch_scc0 L2_d106
    s_mov_b64 exec, s[82:83]
    s_nop 1
    v_mfma_f32_4x4x4_16b_bf16 v[88:91], v[12:13], v[84:85], 0
    s_nop 1
    v_mfma_f32_4x4x4_16b_bf16 v[88:91], v[10:11], v[86:87], v[88:91]
    s_nop 4
    v_cvt_pk_bf16_f32 v88, v88, v89
    v_cvt_pk_bf16_f32 v89, v90, v91
    ds_pk_add_bf16 v7, v88 offset:65408
    ds_pk_add_bf16 v7, v89 offset:65412
    s_mov_b64 exec, s[50:51]
    s_branch L2_d106
L2_oa107:
    s_waitcnt vmcnt(3)
    s_mov_b64 exec, s[6:7]
    v_lshrrev_b32 v114, 16, v114
    s_mov_b64 exec, -1
    v_and_b32 v46, 0x10000000, v33
    v_cmpx_eq_u32 vcc, 0, v46
    v_lshrrev_b32 v47, 14, v112
    v_and_b32 v47, v5, v47
    ds_read_b64 v[96:97], v47
    v_perm_b32 v98, v112, v114, s44
    v_bitop3_b32 v99, v112, 0.5, -0.5 bitop3:0xa8
    v_bitop3_b32 v98, v6, v98, v99 bitop3:0xca
    v_and_b32 v47, v5, v112
    s_waitcnt lgkmcnt(0)
    v_mfma_f32_4x4x4_16b_bf16 v[88:91], v[8:9], v[96:97], 0
    s_nop 4
    v_mul_f32 v88, v98, v88
    v_mul_f32 v89, v98, v89
    v_mul_f32 v90, v98, v90
    v_mul_f32 v91, v98, v91
    v_cvt_pk_bf16_f32 v88, v88, v89
    v_cvt_pk_bf16_f32 v89, v90, v91
    ds_pk_add_bf16 v47, v88 offset:65408
    ds_pk_add_bf16 v47, v89 offset:65412
    s_mov_b64 exec, -1
    v_and_b32 v46, 0x20000000, v33
    v_cmpx_eq_u32 vcc, 0, v46
    v_lshrrev_b32 v47, 14, v113
    v_and_b32 v47, v5, v47
    ds_read_b64 v[96:97], v47
    v_perm_b32 v98, v113, v114, s45
    v_bitop3_b32 v99, v113, 0.5, -0.5 bitop3:0xa8
    v_bitop3_b32 v98, v6, v98, v99 bitop3:0xca
    v_and_b32 v47, v5, v113
    s_waitcnt lgkmcnt(0)
    v_mfma_f32_4x4x4_16b_bf16 v[88:91], v[8:9], v[96:97], 0
    s_nop 4
    v_mul_f32 v88, v98, v88
    v_mul_f32 v89, v98, v89
    v_mul_f32 v90, v98, v90
    v_mul_f32 v91, v98, v91
    v_cvt_pk_bf16_f32 v88, v88, v89
    v_cvt_pk_bf16_f32 v89, v90, v91
    ds_pk_add_bf16 v47, v88 offset:65408
    ds_pk_add_bf16 v47, v89 offset:65412
    s_mov_b64 exec, -1
    s_branch L2_ob107
L2_xo108:
    v_cmp_lt_u32 vcc, 20, v99
    s_mov_b32 s101, 1
    s_cbranch_vccz L2_xp108
    v_cmp_lt_u32 vcc, 32, v99
    v_cmp_lt_u32 s[58:59], 31, v88
    s_mov_b32 s101, 2
    s_or_b64 vcc, vcc, s[58:59]
    s_cbranch_scc0 L2_xp108
    s_mov_b32 s37, 0x10000
    s_branch L2_xp108
L2_c109:
    s_lshl_b64 s[52:53], s[82:83], 1
    s_andn2_b64 s[52:53], s[52:53], s[80:81]
    s_andn2_b64 s[52:53], s[52:53], s[54:55]
    s_or_b64 s[80:81], s[80:81], s[52:53]
    s_not_b64 vcc, s[52:53]
    s_mov_b64 exec, -1
    v_cndmask_b32_dpp v84, v84, v84, vcc wave_shr:1 row_mask:0xf bank_mask:0xf
    v_cndmask_b32_dpp v85, v85, v85, vcc wave_shr:1 row_mask:0xf bank_mask:0xf
    s_lshr_b64 s[52:53], s[52:53], 1
    v_cndmask_b32_dpp v86, v86, v86, vcc wave_shr:1 row_mask:0xf bank_mask:0xf
    v_cndmask_b32_dpp v87, v87, v87, vcc wave_shr:1 row_mask:0xf bank_mask:0xf
    s_andn2_b64 s[82:83], s[82:83], s[52:53]
    v_cndmask_b32_dpp v7, v7, v7, vcc wave_shr:1 row_mask:0xf bank_mask:0xf
    s_mov_b64 exec, s[54:55]
    s_cbranch_scc0 L2_d109
    s_mov_b64 exec, s[82:83]
    s_nop 1
    v_mfma_f32_4x4x4_16b_bf16 v[88:91], v[12:13], v[84:85], 0
    s_nop 1
    v_mfma_f32_4x4x4_16b_bf16 v[88:91], v[10:11], v[86:87], v[88:91]
    s_nop 4
    v_cvt_pk_bf16_f32 v88, v88, v89
    v_cvt_pk_bf16_f32 v89, v90, v91
    ds_pk_add_bf16 v7, v88 offset:65408
    ds_pk_add_bf16 v7, v89 offset:65412
    s_mov_b64 exec, s[54:55]
    s_branch L2_d109
L2_c110:
    s_lshl_b64 s[52:53], s[82:83], 1
    s_andn2_b64 s[52:53], s[52:53], s[80:81]
    s_andn2_b64 s[52:53], s[52:53], s[50:51]
    s_or_b64 s[80:81], s[80:81], s[52:53]
    s_not_b64 vcc, s[52:53]
    s_mov_b64 exec, -1
    v_cndmask_b32_dpp v84, v84, v84, vcc wave_shr:1 row_mask:0xf bank_mask:0xf
    v_cndmask_b32_dpp v85, v85, v85, vcc wave_shr:1 row_mask:0xf bank_mask:0xf
    s_lshr_b64 s[52:53], s[52:53], 1
    v_cndmask_b32_dpp v86, v86, v86, vcc wave_shr:1 row_mask:0xf bank_mask:0xf
    v_cndmask_b32_dpp v87, v87, v87, vcc wave_shr:1 row_mask:0xf bank_mask:0xf
    s_andn2_b64 s[82:83], s[82:83], s[52:53]
    v_cndmask_b32_dpp v7, v7, v7, vcc wave_shr:1 row_mask:0xf bank_mask:0xf
    s_mov_b64 exec, s[50:51]
    s_cbranch_scc0 L2_d110
    s_mov_b64 exec, s[82:83]
    s_nop 1
    v_mfma_f32_4x4x4_16b_bf16 v[88:91], v[12:13], v[84:85], 0
    s_nop 1
    v_mfma_f32_4x4x4_16b_bf16 v[88:91], v[10:11], v[86:87], v[88:91]
    s_nop 4
    v_cvt_pk_bf16_f32 v88, v88, v89
    v_cvt_pk_bf16_f32 v89, v90, v91
    ds_pk_add_bf16 v7, v88 offset:65408
    ds_pk_add_bf16 v7, v89 offset:65412
    s_mov_b64 exec, s[50:51]
    s_branch L2_d110
L2_c111:
    s_lshl_b64 s[52:53], s[82:83], 1
    s_andn2_b64 s[52:53], s[52:53], s[80:81]
    s_andn2_b64 s[52:53], s[52:53], s[54:55]
    s_or_b64 s[80:81], s[80:81], s[52:53]
    s_not_b64 vcc, s[52:53]
    s_mov_b64 exec, -1
    v_cndmask_b32_dpp v84, v84, v84, vcc wave_shr:1 row_mask:0xf bank_mask:0xf
    v_cndmask_b32_dpp v85, v85, v85, vcc wave_shr:1 row_mask:0xf bank_mask:0xf
    s_lshr_b64 s[52:53], s[52:53], 1
    v_cndmask_b32_dpp v86, v86, v86, vcc wave_shr:1 row_mask:0xf bank_mask:0xf
    v_cndmask_b32_dpp v87, v87, v87, vcc wave_shr:1 row_mask:0xf bank_mask:0xf
    s_andn2_b64 s[82:83], s[82:83], s[52:53]
    v_cndmask_b32_dpp v7, v7, v7, vcc wave_shr:1 row_mask:0xf bank_mask:0xf
    s_mov_b64 exec, s[54:55]
    s_cbranch_scc0 L2_d111
    s_mov_b64 exec, s[82:83]
    s_nop 1
    v_mfma_f32_4x4x4_16b_bf16 v[88:91], v[12:13], v[84:85], 0
    s_nop 1
    v_mfma_f32_4x4x4_16b_bf16 v[88:91], v[10:11], v[86:87], v[88:91]
    s_nop 4
    v_cvt_pk_bf16_f32 v88, v88, v89
    v_cvt_pk_bf16_f32 v89, v90, v91
    ds_pk_add_bf16 v7, v88 offset:65408
    ds_pk_add_bf16 v7, v89 offset:65412
    s_mov_b64 exec, s[54:55]
    s_branch L2_d111
L2_c112:
    s_lshl_b64 s[52:53], s[82:83], 1
    s_andn2_b64 s[52:53], s[52:53], s[80:81]
    s_andn2_b64 s[52:53], s[52:53], s[50:51]
    s_or_b64 s[80:81], s[80:81], s[52:53]
    s_not_b64 vcc, s[52:53]
    s_mov_b64 exec, -1
    v_cndmask_b32_dpp v84, v84, v84, vcc wave_shr:1 row_mask:0xf bank_mask:0xf
    v_cndmask_b32_dpp v85, v85, v85, vcc wave_shr:1 row_mask:0xf bank_mask:0xf
    s_lshr_b64 s[52:53], s[52:53], 1
    v_cndmask_b32_dpp v86, v86, v86, vcc wave_shr:1 row_mask:0xf bank_mask:0xf
    v_cndmask_b32_dpp v87, v87, v87, vcc wave_shr:1 row_mask:0xf bank_mask:0xf
    s_andn2_b64 s[82:83], s[82:83], s[52:53]
    v_cndmask_b32_dpp v7, v7, v7, vcc wave_shr:1 row_mask:0xf bank_mask:0xf
    s_mov_b64 exec, s[50:51]
    s_cbranch_scc0 L2_d112
    s_mov_b64 exec, s[82:83]
    s_nop 1
    v_mfma_f32_4x4x4_16b_bf16 v[88:91], v[12:13], v[84:85], 0
    s_nop 1
    v_mfma_f32_4x4x4_16b_bf16 v[88:91], v[10:11], v[86:87], v[88:91]
    s_nop 4
    v_cvt_pk_bf16_f32 v88, v88, v89
    v_cvt_pk_bf16_f32 v89, v90, v91
    ds_pk_add_bf16 v7, v88 offset:65408
    ds_pk_add_bf16 v7, v89 offset:65412
    s_mov_b64 exec, s[50:51]
    s_branch L2_d112
L2_c113:
    s_lshl_b64 s[52:53], s[82:83], 1
    s_andn2_b64 s[52:53], s[52:53], s[80:81]
    s_andn2_b64 s[52:53], s[52:53], s[54:55]
    s_or_b64 s[80:81], s[80:81], s[52:53]
    s_not_b64 vcc, s[52:53]
    s_mov_b64 exec, -1
    v_cndmask_b32_dpp v84, v84, v84, vcc wave_shr:1 row_mask:0xf bank_mask:0xf
    v_cndmask_b32_dpp v85, v85, v85, vcc wave_shr:1 row_mask:0xf bank_mask:0xf
    s_lshr_b64 s[52:53], s[52:53], 1
    v_cndmask_b32_dpp v86, v86, v86, vcc wave_shr:1 row_mask:0xf bank_mask:0xf
    v_cndmask_b32_dpp v87, v87, v87, vcc wave_shr:1 row_mask:0xf bank_mask:0xf
    s_andn2_b64 s[82:83], s[82:83], s[52:53]
    v_cndmask_b32_dpp v7, v7, v7, vcc wave_shr:1 row_mask:0xf bank_mask:0xf
    s_mov_b64 exec, s[54:55]
    s_cbranch_scc0 L2_d113
    s_mov_b64 exec, s[82:83]
    s_nop 1
    v_mfma_f32_4x4x4_16b_bf16 v[88:91], v[12:13], v[84:85], 0
    s_nop 1
    v_mfma_f32_4x4x4_16b_bf16 v[88:91], v[10:11], v[86:87], v[88:91]
    s_nop 4
    v_cvt_pk_bf16_f32 v88, v88, v89
    v_cvt_pk_bf16_f32 v89, v90, v91
    ds_pk_add_bf16 v7, v88 offset:65408
    ds_pk_add_bf16 v7, v89 offset:65412
    s_mov_b64 exec, s[54:55]
    s_branch L2_d113
L2_c114:
    s_lshl_b64 s[52:53], s[82:83], 1
    s_andn2_b64 s[52:53], s[52:53], s[80:81]
    s_andn2_b64 s[52:53], s[52:53], s[50:51]
    s_or_b64 s[80:81], s[80:81], s[52:53]
    s_not_b64 vcc, s[52:53]
    s_mov_b64 exec, -1
    v_cndmask_b32_dpp v84, v84, v84, vcc wave_shr:1 row_mask:0xf bank_mask:0xf
    v_cndmask_b32_dpp v85, v85, v85, vcc wave_shr:1 row_mask:0xf bank_mask:0xf
    s_lshr_b64 s[52:53], s[52:53], 1
    v_cndmask_b32_dpp v86, v86, v86, vcc wave_shr:1 row_mask:0xf bank_mask:0xf
    v_cndmask_b32_dpp v87, v87, v87, vcc wave_shr:1 row_mask:0xf bank_mask:0xf
    s_andn2_b64 s[82:83], s[82:83], s[52:53]
    v_cndmask_b32_dpp v7, v7, v7, vcc wave_shr:1 row_mask:0xf bank_mask:0xf
    s_mov_b64 exec, s[50:51]
    s_cbranch_scc0 L2_d114
    s_mov_b64 exec, s[82:83]
    s_nop 1
    v_mfma_f32_4x4x4_16b_bf16 v[88:91], v[12:13], v[84:85], 0
    s_nop 1
    v_mfma_f32_4x4x4_16b_bf16 v[88:91], v[10:11], v[86:87], v[88:91]
    s_nop 4
    v_cvt_pk_bf16_f32 v88, v88, v89
    v_cvt_pk_bf16_f32 v89, v90, v91
    ds_pk_add_bf16 v7, v88 offset:65408
    ds_pk_add_bf16 v7, v89 offset:65412
    s_mov_b64 exec, s[50:51]
    s_branch L2_d114
L2_xa115:
    s_cmp_eq_u32 s101, 1
    s_cbranch_scc1 L2_xc115
    v_lshlrev_b32 v89, 0, v96
    v_add_u32 v90, 140, v97
    v_bitop3_b32 v90, v89, v45, v90 bitop3:0x6a
    ds_write_b32 v98, v90 offset:28
    v_lshlrev_b32 v89, 4, v96
    v_add_u32 v90, 120, v97
    v_bitop3_b32 v90, v89, v45, v90 bitop3:0x6a
    ds_write_b32 v98, v90 offset:24
    v_lshlrev_b32 v89, 8, v96
    v_add_u32 v90, 100, v97
    v_bitop3_b32 v90, v89, v45, v90 bitop3:0x6a
    ds_write_b32 v98, v90 offset:20
L2_xc115:
    v_lshlrev_b32 v89, 12, v96
    v_add_u32 v90, 80, v97
    v_bitop3_b32 v90, v89, v45, v90 bitop3:0x6a
    ds_write_b32 v98, v90 offset:16
    s_branch L2_xb115
L2_xe115:
    v_cmp_lt_u32 vcc, 32, v99
    v_cmp_lt_u32 s[58:59], 31, v88
    v_lshrrev_b32 v89, 16, v96
    v_add_u32 v97, 80, v97
    s_or_b64 vcc, vcc, s[58:59]
    s_cbranch_scc1 L2_xs115
    v_lshlrev_b32 v89, v1, v89
    v_and_b32 v89, v45, v89
    v_cmp_ne_u32 vcc, 0, v89
    v_xor_b32 v90, v97, v89
    s_add_u32 s3, s37, s38
    v_mbcnt_lo_u32_b32 v98, vcc_lo, 0
    v_mbcnt_hi_u32_b32 v98, vcc_hi, v98
    s_bcnt1_i32_b64 s41, vcc
    v_lshl_add_u32 v98, v98, 2, s3
    s_lshl2_add_u32 s37, s41, s37
    s_mov_b64 exec, vcc
    ds_write_b32 v98, v90
    s_mov_b64 exec, -1
    s_branch L2_xr115
L2_xf115:
    s_waitcnt lgkmcnt(0)
    s_cmp_gt_u32 s37, 1024
    s_cbranch_scc1 L2_xs115
    s_cmp_lt_u32 s37, 768
    s_cbranch_scc1 L2_xl115
    ds_read_b32 v33, v98 offset:896
    s_add_u32 s3, s42, 2
    s_bitset1_b32 s43, s3
    s_branch L2_xg115
L2_xl115:
    v_mov_b32 v42, -1
    s_cmp_ge_u32 s37, 512
    s_cbranch_scc1 L2_xg115
    v_mov_b32 v43, -1
    s_cmp_ge_u32 s37, 256
    s_cbranch_scc1 L2_xg115
    v_mov_b32 v41, -1
    s_branch L2_xg115
L2_xs115:
    s_waitcnt lgkmcnt(0)
    v_mov_b32 v40, -1
    v_mov_b32 v41, -1
    v_mov_b32 v43, -1
    v_mov_b32 v42, -1
    s_add_u32 s3, s42, 2
    s_bitset1_b32 s36, s3
    s_branch L2_xg115
L2_c116:
    s_lshl_b64 s[52:53], s[82:83], 1
    s_andn2_b64 s[52:53], s[52:53], s[80:81]
    s_andn2_b64 s[52:53], s[52:53], s[54:55]
    s_or_b64 s[80:81], s[80:81], s[52:53]
    s_not_b64 vcc, s[52:53]
    s_mov_b64 exec, -1
    v_cndmask_b32_dpp v84, v84, v84, vcc wave_shr:1 row_mask:0xf bank_mask:0xf
    v_cndmask_b32_dpp v85, v85, v85, vcc wave_shr:1 row_mask:0xf bank_mask:0xf
    s_lshr_b64 s[52:53], s[52:53], 1
    v_cndmask_b32_dpp v86, v86, v86, vcc wave_shr:1 row_mask:0xf bank_mask:0xf
    v_cndmask_b32_dpp v87, v87, v87, vcc wave_shr:1 row_mask:0xf bank_mask:0xf
    s_andn2_b64 s[82:83], s[82:83], s[52:53]
    v_cndmask_b32_dpp v7, v7, v7, vcc wave_shr:1 row_mask:0xf bank_mask:0xf
    s_mov_b64 exec, s[54:55]
    s_cbranch_scc0 L2_d116
    s_mov_b64 exec, s[82:83]
    s_nop 1
    v_mfma_f32_4x4x4_16b_bf16 v[88:91], v[12:13], v[84:85], 0
    s_nop 1
    v_mfma_f32_4x4x4_16b_bf16 v[88:91], v[10:11], v[86:87], v[88:91]
    s_nop 4
    v_cvt_pk_bf16_f32 v88, v88, v89
    v_cvt_pk_bf16_f32 v89, v90, v91
    ds_pk_add_bf16 v7, v88 offset:65408
    ds_pk_add_bf16 v7, v89 offset:65412
    s_mov_b64 exec, s[54:55]
    s_branch L2_d116
L2_c117:
    s_lshl_b64 s[52:53], s[82:83], 1
    s_andn2_b64 s[52:53], s[52:53], s[80:81]
    s_andn2_b64 s[52:53], s[52:53], s[50:51]
    s_or_b64 s[80:81], s[80:81], s[52:53]
    s_not_b64 vcc, s[52:53]
    s_mov_b64 exec, -1
    v_cndmask_b32_dpp v84, v84, v84, vcc wave_shr:1 row_mask:0xf bank_mask:0xf
    v_cndmask_b32_dpp v85, v85, v85, vcc wave_shr:1 row_mask:0xf bank_mask:0xf
    s_lshr_b64 s[52:53], s[52:53], 1
    v_cndmask_b32_dpp v86, v86, v86, vcc wave_shr:1 row_mask:0xf bank_mask:0xf
    v_cndmask_b32_dpp v87, v87, v87, vcc wave_shr:1 row_mask:0xf bank_mask:0xf
    s_andn2_b64 s[82:83], s[82:83], s[52:53]
    v_cndmask_b32_dpp v7, v7, v7, vcc wave_shr:1 row_mask:0xf bank_mask:0xf
    s_mov_b64 exec, s[50:51]
    s_cbranch_scc0 L2_d117
    s_mov_b64 exec, s[82:83]
    s_nop 1
    v_mfma_f32_4x4x4_16b_bf16 v[88:91], v[12:13], v[84:85], 0
    s_nop 1
    v_mfma_f32_4x4x4_16b_bf16 v[88:91], v[10:11], v[86:87], v[88:91]
    s_nop 4
    v_cvt_pk_bf16_f32 v88, v88, v89
    v_cvt_pk_bf16_f32 v89, v90, v91
    ds_pk_add_bf16 v7, v88 offset:65408
    ds_pk_add_bf16 v7, v89 offset:65412
    s_mov_b64 exec, s[50:51]
    s_branch L2_d117
L2_oa118:
    v_and_b32 v47, 0x0fffffff, v32
    buffer_load_dword v114, v47, s[8:11], 0 offen offset:16
    s_mov_b64 exec, s[6:7]
    v_add_u32 v47, 8, v47
    v_lshrrev_b32 v32, 2, v32
    s_mov_b64 exec, -1
    buffer_load_dwordx2 v[112:113], v47, s[8:11], 0 offen
    s_branch L2_ob118
L2_c119:
    s_lshl_b64 s[52:53], s[82:83], 1
    s_andn2_b64 s[52:53], s[52:53], s[80:81]
    s_andn2_b64 s[52:53], s[52:53], s[54:55]
    s_or_b64 s[80:81], s[80:81], s[52:53]
    s_not_b64 vcc, s[52:53]
    s_mov_b64 exec, -1
    v_cndmask_b32_dpp v84, v84, v84, vcc wave_shr:1 row_mask:0xf bank_mask:0xf
    v_cndmask_b32_dpp v85, v85, v85, vcc wave_shr:1 row_mask:0xf bank_mask:0xf
    s_lshr_b64 s[52:53], s[52:53], 1
    v_cndmask_b32_dpp v86, v86, v86, vcc wave_shr:1 row_mask:0xf bank_mask:0xf
    v_cndmask_b32_dpp v87, v87, v87, vcc wave_shr:1 row_mask:0xf bank_mask:0xf
    s_andn2_b64 s[82:83], s[82:83], s[52:53]
    v_cndmask_b32_dpp v7, v7, v7, vcc wave_shr:1 row_mask:0xf bank_mask:0xf
    s_mov_b64 exec, s[54:55]
    s_cbranch_scc0 L2_d119
    s_mov_b64 exec, s[82:83]
    s_nop 1
    v_mfma_f32_4x4x4_16b_bf16 v[88:91], v[12:13], v[84:85], 0
    s_nop 1
    v_mfma_f32_4x4x4_16b_bf16 v[88:91], v[10:11], v[86:87], v[88:91]
    s_nop 4
    v_cvt_pk_bf16_f32 v88, v88, v89
    v_cvt_pk_bf16_f32 v89, v90, v91
    ds_pk_add_bf16 v7, v88 offset:65408
    ds_pk_add_bf16 v7, v89 offset:65412
    s_mov_b64 exec, s[54:55]
    s_branch L2_d119
L2_c120:
    s_lshl_b64 s[52:53], s[82:83], 1
    s_andn2_b64 s[52:53], s[52:53], s[80:81]
    s_andn2_b64 s[52:53], s[52:53], s[50:51]
    s_or_b64 s[80:81], s[80:81], s[52:53]
    s_not_b64 vcc, s[52:53]
    s_mov_b64 exec, -1
    v_cndmask_b32_dpp v84, v84, v84, vcc wave_shr:1 row_mask:0xf bank_mask:0xf
    v_cndmask_b32_dpp v85, v85, v85, vcc wave_shr:1 row_mask:0xf bank_mask:0xf
    s_lshr_b64 s[52:53], s[52:53], 1
    v_cndmask_b32_dpp v86, v86, v86, vcc wave_shr:1 row_mask:0xf bank_mask:0xf
    v_cndmask_b32_dpp v87, v87, v87, vcc wave_shr:1 row_mask:0xf bank_mask:0xf
    s_andn2_b64 s[82:83], s[82:83], s[52:53]
    v_cndmask_b32_dpp v7, v7, v7, vcc wave_shr:1 row_mask:0xf bank_mask:0xf
    s_mov_b64 exec, s[50:51]
    s_cbranch_scc0 L2_d120
    s_mov_b64 exec, s[82:83]
    s_nop 1
    v_mfma_f32_4x4x4_16b_bf16 v[88:91], v[12:13], v[84:85], 0
    s_nop 1
    v_mfma_f32_4x4x4_16b_bf16 v[88:91], v[10:11], v[86:87], v[88:91]
    s_nop 4
    v_cvt_pk_bf16_f32 v88, v88, v89
    v_cvt_pk_bf16_f32 v89, v90, v91
    ds_pk_add_bf16 v7, v88 offset:65408
    ds_pk_add_bf16 v7, v89 offset:65412
    s_mov_b64 exec, s[50:51]
    s_branch L2_d120
L2_c121:
    s_lshl_b64 s[52:53], s[82:83], 1
    s_andn2_b64 s[52:53], s[52:53], s[80:81]
    s_andn2_b64 s[52:53], s[52:53], s[54:55]
    s_or_b64 s[80:81], s[80:81], s[52:53]
    s_not_b64 vcc, s[52:53]
    s_mov_b64 exec, -1
    v_cndmask_b32_dpp v84, v84, v84, vcc wave_shr:1 row_mask:0xf bank_mask:0xf
    v_cndmask_b32_dpp v85, v85, v85, vcc wave_shr:1 row_mask:0xf bank_mask:0xf
    s_lshr_b64 s[52:53], s[52:53], 1
    v_cndmask_b32_dpp v86, v86, v86, vcc wave_shr:1 row_mask:0xf bank_mask:0xf
    v_cndmask_b32_dpp v87, v87, v87, vcc wave_shr:1 row_mask:0xf bank_mask:0xf
    s_andn2_b64 s[82:83], s[82:83], s[52:53]
    v_cndmask_b32_dpp v7, v7, v7, vcc wave_shr:1 row_mask:0xf bank_mask:0xf
    s_mov_b64 exec, s[54:55]
    s_cbranch_scc0 L2_d121
    s_mov_b64 exec, s[82:83]
    s_nop 1
    v_mfma_f32_4x4x4_16b_bf16 v[88:91], v[12:13], v[84:85], 0
    s_nop 1
    v_mfma_f32_4x4x4_16b_bf16 v[88:91], v[10:11], v[86:87], v[88:91]
    s_nop 4
    v_cvt_pk_bf16_f32 v88, v88, v89
    v_cvt_pk_bf16_f32 v89, v90, v91
    ds_pk_add_bf16 v7, v88 offset:65408
    ds_pk_add_bf16 v7, v89 offset:65412
    s_mov_b64 exec, s[54:55]
    s_branch L2_d121
L2_c122:
    s_lshl_b64 s[52:53], s[82:83], 1
    s_andn2_b64 s[52:53], s[52:53], s[80:81]
    s_andn2_b64 s[52:53], s[52:53], s[50:51]
    s_or_b64 s[80:81], s[80:81], s[52:53]
    s_not_b64 vcc, s[52:53]
    s_mov_b64 exec, -1
    v_cndmask_b32_dpp v84, v84, v84, vcc wave_shr:1 row_mask:0xf bank_mask:0xf
    v_cndmask_b32_dpp v85, v85, v85, vcc wave_shr:1 row_mask:0xf bank_mask:0xf
    s_lshr_b64 s[52:53], s[52:53], 1
    v_cndmask_b32_dpp v86, v86, v86, vcc wave_shr:1 row_mask:0xf bank_mask:0xf
    v_cndmask_b32_dpp v87, v87, v87, vcc wave_shr:1 row_mask:0xf bank_mask:0xf
    s_andn2_b64 s[82:83], s[82:83], s[52:53]
    v_cndmask_b32_dpp v7, v7, v7, vcc wave_shr:1 row_mask:0xf bank_mask:0xf
    s_mov_b64 exec, s[50:51]
    s_cbranch_scc0 L2_d122
    s_mov_b64 exec, s[82:83]
    s_nop 1
    v_mfma_f32_4x4x4_16b_bf16 v[88:91], v[12:13], v[84:85], 0
    s_nop 1
    v_mfma_f32_4x4x4_16b_bf16 v[88:91], v[10:11], v[86:87], v[88:91]
    s_nop 4
    v_cvt_pk_bf16_f32 v88, v88, v89
    v_cvt_pk_bf16_f32 v89, v90, v91
    ds_pk_add_bf16 v7, v88 offset:65408
    ds_pk_add_bf16 v7, v89 offset:65412
    s_mov_b64 exec, s[50:51]
    s_branch L2_d122
L2_c123:
    s_lshl_b64 s[52:53], s[82:83], 1
    s_andn2_b64 s[52:53], s[52:53], s[80:81]
    s_andn2_b64 s[52:53], s[52:53], s[54:55]
    s_or_b64 s[80:81], s[80:81], s[52:53]
    s_not_b64 vcc, s[52:53]
    s_mov_b64 exec, -1
    v_cndmask_b32_dpp v84, v84, v84, vcc wave_shr:1 row_mask:0xf bank_mask:0xf
    v_cndmask_b32_dpp v85, v85, v85, vcc wave_shr:1 row_mask:0xf bank_mask:0xf
    s_lshr_b64 s[52:53], s[52:53], 1
    v_cndmask_b32_dpp v86, v86, v86, vcc wave_shr:1 row_mask:0xf bank_mask:0xf
    v_cndmask_b32_dpp v87, v87, v87, vcc wave_shr:1 row_mask:0xf bank_mask:0xf
    s_andn2_b64 s[82:83], s[82:83], s[52:53]
    v_cndmask_b32_dpp v7, v7, v7, vcc wave_shr:1 row_mask:0xf bank_mask:0xf
    s_mov_b64 exec, s[54:55]
    s_cbranch_scc0 L2_d123
    s_mov_b64 exec, s[82:83]
    s_nop 1
    v_mfma_f32_4x4x4_16b_bf16 v[88:91], v[12:13], v[84:85], 0
    s_nop 1
    v_mfma_f32_4x4x4_16b_bf16 v[88:91], v[10:11], v[86:87], v[88:91]
    s_nop 4
    v_cvt_pk_bf16_f32 v88, v88, v89
    v_cvt_pk_bf16_f32 v89, v90, v91
    ds_pk_add_bf16 v7, v88 offset:65408
    ds_pk_add_bf16 v7, v89 offset:65412
    s_mov_b64 exec, s[54:55]
    s_branch L2_d123
L2_c124:
    s_lshl_b64 s[52:53], s[82:83], 1
    s_andn2_b64 s[52:53], s[52:53], s[80:81]
    s_andn2_b64 s[52:53], s[52:53], s[50:51]
    s_or_b64 s[80:81], s[80:81], s[52:53]
    s_not_b64 vcc, s[52:53]
    s_mov_b64 exec, -1
    v_cndmask_b32_dpp v84, v84, v84, vcc wave_shr:1 row_mask:0xf bank_mask:0xf
    v_cndmask_b32_dpp v85, v85, v85, vcc wave_shr:1 row_mask:0xf bank_mask:0xf
    s_lshr_b64 s[52:53], s[52:53], 1
    v_cndmask_b32_dpp v86, v86, v86, vcc wave_shr:1 row_mask:0xf bank_mask:0xf
    v_cndmask_b32_dpp v87, v87, v87, vcc wave_shr:1 row_mask:0xf bank_mask:0xf
    s_andn2_b64 s[82:83], s[82:83], s[52:53]
    v_cndmask_b32_dpp v7, v7, v7, vcc wave_shr:1 row_mask:0xf bank_mask:0xf
    s_mov_b64 exec, s[50:51]
    s_cbranch_scc0 L2_d124
    s_mov_b64 exec, s[82:83]
    s_nop 1
    v_mfma_f32_4x4x4_16b_bf16 v[88:91], v[12:13], v[84:85], 0
    s_nop 1
    v_mfma_f32_4x4x4_16b_bf16 v[88:91], v[10:11], v[86:87], v[88:91]
    s_nop 4
    v_cvt_pk_bf16_f32 v88, v88, v89
    v_cvt_pk_bf16_f32 v89, v90, v91
    ds_pk_add_bf16 v7, v88 offset:65408
    ds_pk_add_bf16 v7, v89 offset:65412
    s_mov_b64 exec, s[50:51]
    s_branch L2_d124
L2_oa125:
    s_waitcnt vmcnt(3)
    s_mov_b64 exec, s[6:7]
    v_lshrrev_b32 v114, 16, v114
    s_mov_b64 exec, -1
    v_and_b32 v46, 0x10000000, v32
    v_cmpx_eq_u32 vcc, 0, v46
    v_lshrrev_b32 v47, 14, v112
    v_and_b32 v47, v5, v47
    ds_read_b64 v[96:97], v47
    v_perm_b32 v98, v112, v114, s44
    v_bitop3_b32 v99, v112, 0.5, -0.5 bitop3:0xa8
    v_bitop3_b32 v98, v6, v98, v99 bitop3:0xca
    v_and_b32 v47, v5, v112
    s_waitcnt lgkmcnt(0)
    v_mfma_f32_4x4x4_16b_bf16 v[88:91], v[8:9], v[96:97], 0
    s_nop 4
    v_mul_f32 v88, v98, v88
    v_mul_f32 v89, v98, v89
    v_mul_f32 v90, v98, v90
    v_mul_f32 v91, v98, v91
    v_cvt_pk_bf16_f32 v88, v88, v89
    v_cvt_pk_bf16_f32 v89, v90, v91
    ds_pk_add_bf16 v47, v88 offset:65408
    ds_pk_add_bf16 v47, v89 offset:65412
    s_mov_b64 exec, -1
    v_and_b32 v46, 0x20000000, v32
    v_cmpx_eq_u32 vcc, 0, v46
    v_lshrrev_b32 v47, 14, v113
    v_and_b32 v47, v5, v47
    ds_read_b64 v[96:97], v47
    v_perm_b32 v98, v113, v114, s45
    v_bitop3_b32 v99, v113, 0.5, -0.5 bitop3:0xa8
    v_bitop3_b32 v98, v6, v98, v99 bitop3:0xca
    v_and_b32 v47, v5, v113
    s_waitcnt lgkmcnt(0)
    v_mfma_f32_4x4x4_16b_bf16 v[88:91], v[8:9], v[96:97], 0
    s_nop 4
    v_mul_f32 v88, v98, v88
    v_mul_f32 v89, v98, v89
    v_mul_f32 v90, v98, v90
    v_mul_f32 v91, v98, v91
    v_cvt_pk_bf16_f32 v88, v88, v89
    v_cvt_pk_bf16_f32 v89, v90, v91
    ds_pk_add_bf16 v47, v88 offset:65408
    ds_pk_add_bf16 v47, v89 offset:65412
    s_mov_b64 exec, -1
    s_branch L2_ob125
L2_c126:
    s_lshl_b64 s[52:53], s[82:83], 1
    s_andn2_b64 s[52:53], s[52:53], s[80:81]
    s_andn2_b64 s[52:53], s[52:53], s[54:55]
    s_or_b64 s[80:81], s[80:81], s[52:53]
    s_not_b64 vcc, s[52:53]
    s_mov_b64 exec, -1
    v_cndmask_b32_dpp v84, v84, v84, vcc wave_shr:1 row_mask:0xf bank_mask:0xf
    v_cndmask_b32_dpp v85, v85, v85, vcc wave_shr:1 row_mask:0xf bank_mask:0xf
    s_lshr_b64 s[52:53], s[52:53], 1
    v_cndmask_b32_dpp v86, v86, v86, vcc wave_shr:1 row_mask:0xf bank_mask:0xf
    v_cndmask_b32_dpp v87, v87, v87, vcc wave_shr:1 row_mask:0xf bank_mask:0xf
    s_andn2_b64 s[82:83], s[82:83], s[52:53]
    v_cndmask_b32_dpp v7, v7, v7, vcc wave_shr:1 row_mask:0xf bank_mask:0xf
    s_mov_b64 exec, s[54:55]
    s_cbranch_scc0 L2_d126
    s_mov_b64 exec, s[82:83]
    s_nop 1
    v_mfma_f32_4x4x4_16b_bf16 v[88:91], v[12:13], v[84:85], 0
    s_nop 1
    v_mfma_f32_4x4x4_16b_bf16 v[88:91], v[10:11], v[86:87], v[88:91]
    s_nop 4
    v_cvt_pk_bf16_f32 v88, v88, v89
    v_cvt_pk_bf16_f32 v89, v90, v91
    ds_pk_add_bf16 v7, v88 offset:65408
    ds_pk_add_bf16 v7, v89 offset:65412
    s_mov_b64 exec, s[54:55]
    s_branch L2_d126
L2_c127:
    s_lshl_b64 s[52:53], s[82:83], 1
    s_andn2_b64 s[52:53], s[52:53], s[80:81]
    s_andn2_b64 s[52:53], s[52:53], s[50:51]
    s_or_b64 s[80:81], s[80:81], s[52:53]
    s_not_b64 vcc, s[52:53]
    s_mov_b64 exec, -1
    v_cndmask_b32_dpp v84, v84, v84, vcc wave_shr:1 row_mask:0xf bank_mask:0xf
    v_cndmask_b32_dpp v85, v85, v85, vcc wave_shr:1 row_mask:0xf bank_mask:0xf
    s_lshr_b64 s[52:53], s[52:53], 1
    v_cndmask_b32_dpp v86, v86, v86, vcc wave_shr:1 row_mask:0xf bank_mask:0xf
    v_cndmask_b32_dpp v87, v87, v87, vcc wave_shr:1 row_mask:0xf bank_mask:0xf
    s_andn2_b64 s[82:83], s[82:83], s[52:53]
    v_cndmask_b32_dpp v7, v7, v7, vcc wave_shr:1 row_mask:0xf bank_mask:0xf
    s_mov_b64 exec, s[50:51]
    s_cbranch_scc0 L2_d127
    s_mov_b64 exec, s[82:83]
    s_nop 1
    v_mfma_f32_4x4x4_16b_bf16 v[88:91], v[12:13], v[84:85], 0
    s_nop 1
    v_mfma_f32_4x4x4_16b_bf16 v[88:91], v[10:11], v[86:87], v[88:91]
    s_nop 4
    v_cvt_pk_bf16_f32 v88, v88, v89
    v_cvt_pk_bf16_f32 v89, v90, v91
    ds_pk_add_bf16 v7, v88 offset:65408
    ds_pk_add_bf16 v7, v89 offset:65412
    s_mov_b64 exec, s[50:51]
    s_branch L2_d127
L2_c128:
    s_lshl_b64 s[52:53], s[82:83], 1
    s_andn2_b64 s[52:53], s[52:53], s[80:81]
    s_andn2_b64 s[52:53], s[52:53], s[54:55]
    s_or_b64 s[80:81], s[80:81], s[52:53]
    s_not_b64 vcc, s[52:53]
    s_mov_b64 exec, -1
    v_cndmask_b32_dpp v84, v84, v84, vcc wave_shr:1 row_mask:0xf bank_mask:0xf
    v_cndmask_b32_dpp v85, v85, v85, vcc wave_shr:1 row_mask:0xf bank_mask:0xf
    s_lshr_b64 s[52:53], s[52:53], 1
    v_cndmask_b32_dpp v86, v86, v86, vcc wave_shr:1 row_mask:0xf bank_mask:0xf
    v_cndmask_b32_dpp v87, v87, v87, vcc wave_shr:1 row_mask:0xf bank_mask:0xf
    s_andn2_b64 s[82:83], s[82:83], s[52:53]
    v_cndmask_b32_dpp v7, v7, v7, vcc wave_shr:1 row_mask:0xf bank_mask:0xf
    s_mov_b64 exec, s[54:55]
    s_cbranch_scc0 L2_d128
    s_mov_b64 exec, s[82:83]
    s_nop 1
    v_mfma_f32_4x4x4_16b_bf16 v[88:91], v[12:13], v[84:85], 0
    s_nop 1
    v_mfma_f32_4x4x4_16b_bf16 v[88:91], v[10:11], v[86:87], v[88:91]
    s_nop 4
    v_cvt_pk_bf16_f32 v88, v88, v89
    v_cvt_pk_bf16_f32 v89, v90, v91
    ds_pk_add_bf16 v7, v88 offset:65408
    ds_pk_add_bf16 v7, v89 offset:65412
    s_mov_b64 exec, s[54:55]
    s_branch L2_d128
L2_c129:
    s_lshl_b64 s[52:53], s[82:83], 1
    s_andn2_b64 s[52:53], s[52:53], s[80:81]
    s_andn2_b64 s[52:53], s[52:53], s[50:51]
    s_or_b64 s[80:81], s[80:81], s[52:53]
    s_not_b64 vcc, s[52:53]
    s_mov_b64 exec, -1
    v_cndmask_b32_dpp v84, v84, v84, vcc wave_shr:1 row_mask:0xf bank_mask:0xf
    v_cndmask_b32_dpp v85, v85, v85, vcc wave_shr:1 row_mask:0xf bank_mask:0xf
    s_lshr_b64 s[52:53], s[52:53], 1
    v_cndmask_b32_dpp v86, v86, v86, vcc wave_shr:1 row_mask:0xf bank_mask:0xf
    v_cndmask_b32_dpp v87, v87, v87, vcc wave_shr:1 row_mask:0xf bank_mask:0xf
    s_andn2_b64 s[82:83], s[82:83], s[52:53]
    v_cndmask_b32_dpp v7, v7, v7, vcc wave_shr:1 row_mask:0xf bank_mask:0xf
    s_mov_b64 exec, s[50:51]
    s_cbranch_scc0 L2_d129
    s_mov_b64 exec, s[82:83]
    s_nop 1
    v_mfma_f32_4x4x4_16b_bf16 v[88:91], v[12:13], v[84:85], 0
    s_nop 1
    v_mfma_f32_4x4x4_16b_bf16 v[88:91], v[10:11], v[86:87], v[88:91]
    s_nop 4
    v_cvt_pk_bf16_f32 v88, v88, v89
    v_cvt_pk_bf16_f32 v89, v90, v91
    ds_pk_add_bf16 v7, v88 offset:65408
    ds_pk_add_bf16 v7, v89 offset:65412
    s_mov_b64 exec, s[50:51]
    s_branch L2_d129
L2_c130:
    s_lshl_b64 s[52:53], s[82:83], 1
    s_andn2_b64 s[52:53], s[52:53], s[80:81]
    s_andn2_b64 s[52:53], s[52:53], s[54:55]
    s_or_b64 s[80:81], s[80:81], s[52:53]
    s_not_b64 vcc, s[52:53]
    s_mov_b64 exec, -1
    v_cndmask_b32_dpp v84, v84, v84, vcc wave_shr:1 row_mask:0xf bank_mask:0xf
    v_cndmask_b32_dpp v85, v85, v85, vcc wave_shr:1 row_mask:0xf bank_mask:0xf
    s_lshr_b64 s[52:53], s[52:53], 1
    v_cndmask_b32_dpp v86, v86, v86, vcc wave_shr:1 row_mask:0xf bank_mask:0xf
    v_cndmask_b32_dpp v87, v87, v87, vcc wave_shr:1 row_mask:0xf bank_mask:0xf
    s_andn2_b64 s[82:83], s[82:83], s[52:53]
    v_cndmask_b32_dpp v7, v7, v7, vcc wave_shr:1 row_mask:0xf bank_mask:0xf
    s_mov_b64 exec, s[54:55]
    s_cbranch_scc0 L2_d130
    s_mov_b64 exec, s[82:83]
    s_nop 1
    v_mfma_f32_4x4x4_16b_bf16 v[88:91], v[12:13], v[84:85], 0
    s_nop 1
    v_mfma_f32_4x4x4_16b_bf16 v[88:91], v[10:11], v[86:87], v[88:91]
    s_nop 4
    v_cvt_pk_bf16_f32 v88, v88, v89
    v_cvt_pk_bf16_f32 v89, v90, v91
    ds_pk_add_bf16 v7, v88 offset:65408
    ds_pk_add_bf16 v7, v89 offset:65412
    s_mov_b64 exec, s[54:55]
    s_branch L2_d130
L2_c131:
    s_lshl_b64 s[52:53], s[82:83], 1
    s_andn2_b64 s[52:53], s[52:53], s[80:81]
    s_andn2_b64 s[52:53], s[52:53], s[50:51]
    s_or_b64 s[80:81], s[80:81], s[52:53]
    s_not_b64 vcc, s[52:53]
    s_mov_b64 exec, -1
    v_cndmask_b32_dpp v84, v84, v84, vcc wave_shr:1 row_mask:0xf bank_mask:0xf
    v_cndmask_b32_dpp v85, v85, v85, vcc wave_shr:1 row_mask:0xf bank_mask:0xf
    s_lshr_b64 s[52:53], s[52:53], 1
    v_cndmask_b32_dpp v86, v86, v86, vcc wave_shr:1 row_mask:0xf bank_mask:0xf
    v_cndmask_b32_dpp v87, v87, v87, vcc wave_shr:1 row_mask:0xf bank_mask:0xf
    s_andn2_b64 s[82:83], s[82:83], s[52:53]
    v_cndmask_b32_dpp v7, v7, v7, vcc wave_shr:1 row_mask:0xf bank_mask:0xf
    s_mov_b64 exec, s[50:51]
    s_cbranch_scc0 L2_d131
    s_mov_b64 exec, s[82:83]
    s_nop 1
    v_mfma_f32_4x4x4_16b_bf16 v[88:91], v[12:13], v[84:85], 0
    s_nop 1
    v_mfma_f32_4x4x4_16b_bf16 v[88:91], v[10:11], v[86:87], v[88:91]
    s_nop 4
    v_cvt_pk_bf16_f32 v88, v88, v89
    v_cvt_pk_bf16_f32 v89, v90, v91
    ds_pk_add_bf16 v7, v88 offset:65408
    ds_pk_add_bf16 v7, v89 offset:65412
    s_mov_b64 exec, s[50:51]
    s_branch L2_d131
L2_c132:
    s_lshl_b64 s[52:53], s[82:83], 1
    s_andn2_b64 s[52:53], s[52:53], s[80:81]
    s_andn2_b64 s[52:53], s[52:53], s[54:55]
    s_or_b64 s[80:81], s[80:81], s[52:53]
    s_not_b64 vcc, s[52:53]
    s_mov_b64 exec, -1
    v_cndmask_b32_dpp v84, v84, v84, vcc wave_shr:1 row_mask:0xf bank_mask:0xf
    v_cndmask_b32_dpp v85, v85, v85, vcc wave_shr:1 row_mask:0xf bank_mask:0xf
    s_lshr_b64 s[52:53], s[52:53], 1
    v_cndmask_b32_dpp v86, v86, v86, vcc wave_shr:1 row_mask:0xf bank_mask:0xf
    v_cndmask_b32_dpp v87, v87, v87, vcc wave_shr:1 row_mask:0xf bank_mask:0xf
    s_andn2_b64 s[82:83], s[82:83], s[52:53]
    v_cndmask_b32_dpp v7, v7, v7, vcc wave_shr:1 row_mask:0xf bank_mask:0xf
    s_mov_b64 exec, s[54:55]
    s_cbranch_scc0 L2_d132
    s_mov_b64 exec, s[82:83]
    s_nop 1
    v_mfma_f32_4x4x4_16b_bf16 v[88:91], v[12:13], v[84:85], 0
    s_nop 1
    v_mfma_f32_4x4x4_16b_bf16 v[88:91], v[10:11], v[86:87], v[88:91]
    s_nop 4
    v_cvt_pk_bf16_f32 v88, v88, v89
    v_cvt_pk_bf16_f32 v89, v90, v91
    ds_pk_add_bf16 v7, v88 offset:65408
    ds_pk_add_bf16 v7, v89 offset:65412
    s_mov_b64 exec, s[54:55]
    s_branch L2_d132
L2_c133:
    s_lshl_b64 s[52:53], s[82:83], 1
    s_andn2_b64 s[52:53], s[52:53], s[80:81]
    s_andn2_b64 s[52:53], s[52:53], s[50:51]
    s_or_b64 s[80:81], s[80:81], s[52:53]
    s_not_b64 vcc, s[52:53]
    s_mov_b64 exec, -1
    v_cndmask_b32_dpp v84, v84, v84, vcc wave_shr:1 row_mask:0xf bank_mask:0xf
    v_cndmask_b32_dpp v85, v85, v85, vcc wave_shr:1 row_mask:0xf bank_mask:0xf
    s_lshr_b64 s[52:53], s[52:53], 1
    v_cndmask_b32_dpp v86, v86, v86, vcc wave_shr:1 row_mask:0xf bank_mask:0xf
    v_cndmask_b32_dpp v87, v87, v87, vcc wave_shr:1 row_mask:0xf bank_mask:0xf
    s_andn2_b64 s[82:83], s[82:83], s[52:53]
    v_cndmask_b32_dpp v7, v7, v7, vcc wave_shr:1 row_mask:0xf bank_mask:0xf
    s_mov_b64 exec, s[50:51]
    s_cbranch_scc0 L2_d133
    s_mov_b64 exec, s[82:83]
    s_nop 1
    v_mfma_f32_4x4x4_16b_bf16 v[88:91], v[12:13], v[84:85], 0
    s_nop 1
    v_mfma_f32_4x4x4_16b_bf16 v[88:91], v[10:11], v[86:87], v[88:91]
    s_nop 4
    v_cvt_pk_bf16_f32 v88, v88, v89
    v_cvt_pk_bf16_f32 v89, v90, v91
    ds_pk_add_bf16 v7, v88 offset:65408
    ds_pk_add_bf16 v7, v89 offset:65412
    s_mov_b64 exec, s[50:51]
    s_branch L2_d133
L2_oa134:
    v_and_b32 v47, 0x0fffffff, v33
    buffer_load_dword v114, v47, s[8:11], 0 offen offset:16
    s_mov_b64 exec, s[6:7]
    v_add_u32 v47, 8, v47
    v_lshrrev_b32 v33, 2, v33
    s_mov_b64 exec, -1
    buffer_load_dwordx2 v[112:113], v47, s[8:11], 0 offen
    s_branch L2_ob134
L2_c135:
    s_lshl_b64 s[52:53], s[82:83], 1
    s_andn2_b64 s[52:53], s[52:53], s[80:81]
    s_andn2_b64 s[52:53], s[52:53], s[54:55]
    s_or_b64 s[80:81], s[80:81], s[52:53]
    s_not_b64 vcc, s[52:53]
    s_mov_b64 exec, -1
    v_cndmask_b32_dpp v84, v84, v84, vcc wave_shr:1 row_mask:0xf bank_mask:0xf
    v_cndmask_b32_dpp v85, v85, v85, vcc wave_shr:1 row_mask:0xf bank_mask:0xf
    s_lshr_b64 s[52:53], s[52:53], 1
    v_cndmask_b32_dpp v86, v86, v86, vcc wave_shr:1 row_mask:0xf bank_mask:0xf
    v_cndmask_b32_dpp v87, v87, v87, vcc wave_shr:1 row_mask:0xf bank_mask:0xf
    s_andn2_b64 s[82:83], s[82:83], s[52:53]
    v_cndmask_b32_dpp v7, v7, v7, vcc wave_shr:1 row_mask:0xf bank_mask:0xf
    s_mov_b64 exec, s[54:55]
    s_cbranch_scc0 L2_d135
    s_mov_b64 exec, s[82:83]
    s_nop 1
    v_mfma_f32_4x4x4_16b_bf16 v[88:91], v[12:13], v[84:85], 0
    s_nop 1
    v_mfma_f32_4x4x4_16b_bf16 v[88:91], v[10:11], v[86:87], v[88:91]
    s_nop 4
    v_cvt_pk_bf16_f32 v88, v88, v89
    v_cvt_pk_bf16_f32 v89, v90, v91
    ds_pk_add_bf16 v7, v88 offset:65408
    ds_pk_add_bf16 v7, v89 offset:65412
    s_mov_b64 exec, s[54:55]
    s_branch L2_d135
L2_c136:
    s_lshl_b64 s[52:53], s[82:83], 1
    s_andn2_b64 s[52:53], s[52:53], s[80:81]
    s_andn2_b64 s[52:53], s[52:53], s[50:51]
    s_or_b64 s[80:81], s[80:81], s[52:53]
    s_not_b64 vcc, s[52:53]
    s_mov_b64 exec, -1
    v_cndmask_b32_dpp v84, v84, v84, vcc wave_shr:1 row_mask:0xf bank_mask:0xf
    v_cndmask_b32_dpp v85, v85, v85, vcc wave_shr:1 row_mask:0xf bank_mask:0xf
    s_lshr_b64 s[52:53], s[52:53], 1
    v_cndmask_b32_dpp v86, v86, v86, vcc wave_shr:1 row_mask:0xf bank_mask:0xf
    v_cndmask_b32_dpp v87, v87, v87, vcc wave_shr:1 row_mask:0xf bank_mask:0xf
    s_andn2_b64 s[82:83], s[82:83], s[52:53]
    v_cndmask_b32_dpp v7, v7, v7, vcc wave_shr:1 row_mask:0xf bank_mask:0xf
    s_mov_b64 exec, s[50:51]
    s_cbranch_scc0 L2_d136
    s_mov_b64 exec, s[82:83]
    s_nop 1
    v_mfma_f32_4x4x4_16b_bf16 v[88:91], v[12:13], v[84:85], 0
    s_nop 1
    v_mfma_f32_4x4x4_16b_bf16 v[88:91], v[10:11], v[86:87], v[88:91]
    s_nop 4
    v_cvt_pk_bf16_f32 v88, v88, v89
    v_cvt_pk_bf16_f32 v89, v90, v91
    ds_pk_add_bf16 v7, v88 offset:65408
    ds_pk_add_bf16 v7, v89 offset:65412
    s_mov_b64 exec, s[50:51]
    s_branch L2_d136
L2_c137:
    s_lshl_b64 s[52:53], s[82:83], 1
    s_andn2_b64 s[52:53], s[52:53], s[80:81]
    s_andn2_b64 s[52:53], s[52:53], s[54:55]
    s_or_b64 s[80:81], s[80:81], s[52:53]
    s_not_b64 vcc, s[52:53]
    s_mov_b64 exec, -1
    v_cndmask_b32_dpp v84, v84, v84, vcc wave_shr:1 row_mask:0xf bank_mask:0xf
    v_cndmask_b32_dpp v85, v85, v85, vcc wave_shr:1 row_mask:0xf bank_mask:0xf
    s_lshr_b64 s[52:53], s[52:53], 1
    v_cndmask_b32_dpp v86, v86, v86, vcc wave_shr:1 row_mask:0xf bank_mask:0xf
    v_cndmask_b32_dpp v87, v87, v87, vcc wave_shr:1 row_mask:0xf bank_mask:0xf
    s_andn2_b64 s[82:83], s[82:83], s[52:53]
    v_cndmask_b32_dpp v7, v7, v7, vcc wave_shr:1 row_mask:0xf bank_mask:0xf
    s_mov_b64 exec, s[54:55]
    s_cbranch_scc0 L2_d137
    s_mov_b64 exec, s[82:83]
    s_nop 1
    v_mfma_f32_4x4x4_16b_bf16 v[88:91], v[12:13], v[84:85], 0
    s_nop 1
    v_mfma_f32_4x4x4_16b_bf16 v[88:91], v[10:11], v[86:87], v[88:91]
    s_nop 4
    v_cvt_pk_bf16_f32 v88, v88, v89
    v_cvt_pk_bf16_f32 v89, v90, v91
    ds_pk_add_bf16 v7, v88 offset:65408
    ds_pk_add_bf16 v7, v89 offset:65412
    s_mov_b64 exec, s[54:55]
    s_branch L2_d137
L2_c138:
    s_lshl_b64 s[52:53], s[82:83], 1
    s_andn2_b64 s[52:53], s[52:53], s[80:81]
    s_andn2_b64 s[52:53], s[52:53], s[50:51]
    s_or_b64 s[80:81], s[80:81], s[52:53]
    s_not_b64 vcc, s[52:53]
    s_mov_b64 exec, -1
    v_cndmask_b32_dpp v84, v84, v84, vcc wave_shr:1 row_mask:0xf bank_mask:0xf
    v_cndmask_b32_dpp v85, v85, v85, vcc wave_shr:1 row_mask:0xf bank_mask:0xf
    s_lshr_b64 s[52:53], s[52:53], 1
    v_cndmask_b32_dpp v86, v86, v86, vcc wave_shr:1 row_mask:0xf bank_mask:0xf
    v_cndmask_b32_dpp v87, v87, v87, vcc wave_shr:1 row_mask:0xf bank_mask:0xf
    s_andn2_b64 s[82:83], s[82:83], s[52:53]
    v_cndmask_b32_dpp v7, v7, v7, vcc wave_shr:1 row_mask:0xf bank_mask:0xf
    s_mov_b64 exec, s[50:51]
    s_cbranch_scc0 L2_d138
    s_mov_b64 exec, s[82:83]
    s_nop 1
    v_mfma_f32_4x4x4_16b_bf16 v[88:91], v[12:13], v[84:85], 0
    s_nop 1
    v_mfma_f32_4x4x4_16b_bf16 v[88:91], v[10:11], v[86:87], v[88:91]
    s_nop 4
    v_cvt_pk_bf16_f32 v88, v88, v89
    v_cvt_pk_bf16_f32 v89, v90, v91
    ds_pk_add_bf16 v7, v88 offset:65408
    ds_pk_add_bf16 v7, v89 offset:65412
    s_mov_b64 exec, s[50:51]
    s_branch L2_d138
L2_c139:
    s_lshl_b64 s[52:53], s[82:83], 1
    s_andn2_b64 s[52:53], s[52:53], s[80:81]
    s_andn2_b64 s[52:53], s[52:53], s[54:55]
    s_or_b64 s[80:81], s[80:81], s[52:53]
    s_not_b64 vcc, s[52:53]
    s_mov_b64 exec, -1
    v_cndmask_b32_dpp v84, v84, v84, vcc wave_shr:1 row_mask:0xf bank_mask:0xf
    v_cndmask_b32_dpp v85, v85, v85, vcc wave_shr:1 row_mask:0xf bank_mask:0xf
    s_lshr_b64 s[52:53], s[52:53], 1
    v_cndmask_b32_dpp v86, v86, v86, vcc wave_shr:1 row_mask:0xf bank_mask:0xf
    v_cndmask_b32_dpp v87, v87, v87, vcc wave_shr:1 row_mask:0xf bank_mask:0xf
    s_andn2_b64 s[82:83], s[82:83], s[52:53]
    v_cndmask_b32_dpp v7, v7, v7, vcc wave_shr:1 row_mask:0xf bank_mask:0xf
    s_mov_b64 exec, s[54:55]
    s_cbranch_scc0 L2_d139
    s_mov_b64 exec, s[82:83]
    s_nop 1
    v_mfma_f32_4x4x4_16b_bf16 v[88:91], v[12:13], v[84:85], 0
    s_nop 1
    v_mfma_f32_4x4x4_16b_bf16 v[88:91], v[10:11], v[86:87], v[88:91]
    s_nop 4
    v_cvt_pk_bf16_f32 v88, v88, v89
    v_cvt_pk_bf16_f32 v89, v90, v91
    ds_pk_add_bf16 v7, v88 offset:65408
    ds_pk_add_bf16 v7, v89 offset:65412
    s_mov_b64 exec, s[54:55]
    s_branch L2_d139
L2_c140:
    s_lshl_b64 s[52:53], s[82:83], 1
    s_andn2_b64 s[52:53], s[52:53], s[80:81]
    s_andn2_b64 s[52:53], s[52:53], s[50:51]
    s_or_b64 s[80:81], s[80:81], s[52:53]
    s_not_b64 vcc, s[52:53]
    s_mov_b64 exec, -1
    v_cndmask_b32_dpp v84, v84, v84, vcc wave_shr:1 row_mask:0xf bank_mask:0xf
    v_cndmask_b32_dpp v85, v85, v85, vcc wave_shr:1 row_mask:0xf bank_mask:0xf
    s_lshr_b64 s[52:53], s[52:53], 1
    v_cndmask_b32_dpp v86, v86, v86, vcc wave_shr:1 row_mask:0xf bank_mask:0xf
    v_cndmask_b32_dpp v87, v87, v87, vcc wave_shr:1 row_mask:0xf bank_mask:0xf
    s_andn2_b64 s[82:83], s[82:83], s[52:53]
    v_cndmask_b32_dpp v7, v7, v7, vcc wave_shr:1 row_mask:0xf bank_mask:0xf
    s_mov_b64 exec, s[50:51]
    s_cbranch_scc0 L2_d140
    s_mov_b64 exec, s[82:83]
    s_nop 1
    v_mfma_f32_4x4x4_16b_bf16 v[88:91], v[12:13], v[84:85], 0
    s_nop 1
    v_mfma_f32_4x4x4_16b_bf16 v[88:91], v[10:11], v[86:87], v[88:91]
    s_nop 4
    v_cvt_pk_bf16_f32 v88, v88, v89
    v_cvt_pk_bf16_f32 v89, v90, v91
    ds_pk_add_bf16 v7, v88 offset:65408
    ds_pk_add_bf16 v7, v89 offset:65412
    s_mov_b64 exec, s[50:51]
    s_branch L2_d140
L2_oa141:
    s_waitcnt vmcnt(0)
    s_mov_b64 exec, s[6:7]
    v_lshrrev_b32 v114, 16, v114
    s_mov_b64 exec, -1
    v_and_b32 v46, 0x10000000, v33
    v_cmpx_eq_u32 vcc, 0, v46
    v_lshrrev_b32 v47, 14, v112
    v_and_b32 v47, v5, v47
    ds_read_b64 v[96:97], v47
    v_perm_b32 v98, v112, v114, s44
    v_bitop3_b32 v99, v112, 0.5, -0.5 bitop3:0xa8
    v_bitop3_b32 v98, v6, v98, v99 bitop3:0xca
    v_and_b32 v47, v5, v112
    s_waitcnt lgkmcnt(0)
    v_mfma_f32_4x4x4_16b_bf16 v[88:91], v[8:9], v[96:97], 0
    s_nop 4
    v_mul_f32 v88, v98, v88
    v_mul_f32 v89, v98, v89
    v_mul_f32 v90, v98, v90
    v_mul_f32 v91, v98, v91
    v_cvt_pk_bf16_f32 v88, v88, v89
    v_cvt_pk_bf16_f32 v89, v90, v91
    ds_pk_add_bf16 v47, v88 offset:65408
    ds_pk_add_bf16 v47, v89 offset:65412
    s_mov_b64 exec, -1
    v_and_b32 v46, 0x20000000, v33
    v_cmpx_eq_u32 vcc, 0, v46
    v_lshrrev_b32 v47, 14, v113
    v_and_b32 v47, v5, v47
    ds_read_b64 v[96:97], v47
    v_perm_b32 v98, v113, v114, s45
    v_bitop3_b32 v99, v113, 0.5, -0.5 bitop3:0xa8
    v_bitop3_b32 v98, v6, v98, v99 bitop3:0xca
    v_and_b32 v47, v5, v113
    s_waitcnt lgkmcnt(0)
    v_mfma_f32_4x4x4_16b_bf16 v[88:91], v[8:9], v[96:97], 0
    s_nop 4
    v_mul_f32 v88, v98, v88
    v_mul_f32 v89, v98, v89
    v_mul_f32 v90, v98, v90
    v_mul_f32 v91, v98, v91
    v_cvt_pk_bf16_f32 v88, v88, v89
    v_cvt_pk_bf16_f32 v89, v90, v91
    ds_pk_add_bf16 v47, v88 offset:65408
    ds_pk_add_bf16 v47, v89 offset:65412
    s_mov_b64 exec, -1
    s_branch L2_ob141
L2_c142:
    s_lshl_b64 s[52:53], s[82:83], 1
    s_andn2_b64 s[52:53], s[52:53], s[80:81]
    s_andn2_b64 s[52:53], s[52:53], s[54:55]
    s_or_b64 s[80:81], s[80:81], s[52:53]
    s_not_b64 vcc, s[52:53]
    s_mov_b64 exec, -1
    v_cndmask_b32_dpp v84, v84, v84, vcc wave_shr:1 row_mask:0xf bank_mask:0xf
    v_cndmask_b32_dpp v85, v85, v85, vcc wave_shr:1 row_mask:0xf bank_mask:0xf
    s_lshr_b64 s[52:53], s[52:53], 1
    v_cndmask_b32_dpp v86, v86, v86, vcc wave_shr:1 row_mask:0xf bank_mask:0xf
    v_cndmask_b32_dpp v87, v87, v87, vcc wave_shr:1 row_mask:0xf bank_mask:0xf
    s_andn2_b64 s[82:83], s[82:83], s[52:53]
    v_cndmask_b32_dpp v7, v7, v7, vcc wave_shr:1 row_mask:0xf bank_mask:0xf
    s_mov_b64 exec, s[54:55]
    s_cbranch_scc0 L2_d142
    s_mov_b64 exec, s[82:83]
    s_nop 1
    v_mfma_f32_4x4x4_16b_bf16 v[88:91], v[12:13], v[84:85], 0
    s_nop 1
    v_mfma_f32_4x4x4_16b_bf16 v[88:91], v[10:11], v[86:87], v[88:91]
    s_nop 4
    v_cvt_pk_bf16_f32 v88, v88, v89
    v_cvt_pk_bf16_f32 v89, v90, v91
    ds_pk_add_bf16 v7, v88 offset:65408
    ds_pk_add_bf16 v7, v89 offset:65412
    s_mov_b64 exec, s[54:55]
    s_branch L2_d142
L2_c143:
    s_lshl_b64 s[52:53], s[82:83], 1
    s_andn2_b64 s[52:53], s[52:53], s[80:81]
    s_andn2_b64 s[52:53], s[52:53], s[50:51]
    s_or_b64 s[80:81], s[80:81], s[52:53]
    s_not_b64 vcc, s[52:53]
    s_mov_b64 exec, -1
    v_cndmask_b32_dpp v84, v84, v84, vcc wave_shr:1 row_mask:0xf bank_mask:0xf
    v_cndmask_b32_dpp v85, v85, v85, vcc wave_shr:1 row_mask:0xf bank_mask:0xf
    s_lshr_b64 s[52:53], s[52:53], 1
    v_cndmask_b32_dpp v86, v86, v86, vcc wave_shr:1 row_mask:0xf bank_mask:0xf
    v_cndmask_b32_dpp v87, v87, v87, vcc wave_shr:1 row_mask:0xf bank_mask:0xf
    s_andn2_b64 s[82:83], s[82:83], s[52:53]
    v_cndmask_b32_dpp v7, v7, v7, vcc wave_shr:1 row_mask:0xf bank_mask:0xf
    s_mov_b64 exec, s[50:51]
    s_cbranch_scc0 L2_d143
    s_mov_b64 exec, s[82:83]
    s_nop 1
    v_mfma_f32_4x4x4_16b_bf16 v[88:91], v[12:13], v[84:85], 0
    s_nop 1
    v_mfma_f32_4x4x4_16b_bf16 v[88:91], v[10:11], v[86:87], v[88:91]
    s_nop 4
    v_cvt_pk_bf16_f32 v88, v88, v89
    v_cvt_pk_bf16_f32 v89, v90, v91
    ds_pk_add_bf16 v7, v88 offset:65408
    ds_pk_add_bf16 v7, v89 offset:65412
    s_mov_b64 exec, s[50:51]
    s_branch L2_d143
L2_c144:
    s_lshl_b64 s[52:53], s[82:83], 1
    s_andn2_b64 s[52:53], s[52:53], s[80:81]
    s_andn2_b64 s[52:53], s[52:53], s[54:55]
    s_or_b64 s[80:81], s[80:81], s[52:53]
    s_not_b64 vcc, s[52:53]
    s_mov_b64 exec, -1
    v_cndmask_b32_dpp v84, v84, v84, vcc wave_shr:1 row_mask:0xf bank_mask:0xf
    v_cndmask_b32_dpp v85, v85, v85, vcc wave_shr:1 row_mask:0xf bank_mask:0xf
    s_lshr_b64 s[52:53], s[52:53], 1
    v_cndmask_b32_dpp v86, v86, v86, vcc wave_shr:1 row_mask:0xf bank_mask:0xf
    v_cndmask_b32_dpp v87, v87, v87, vcc wave_shr:1 row_mask:0xf bank_mask:0xf
    s_andn2_b64 s[82:83], s[82:83], s[52:53]
    v_cndmask_b32_dpp v7, v7, v7, vcc wave_shr:1 row_mask:0xf bank_mask:0xf
    s_mov_b64 exec, s[54:55]
    s_cbranch_scc0 L2_d144
    s_mov_b64 exec, s[82:83]
    s_nop 1
    v_mfma_f32_4x4x4_16b_bf16 v[88:91], v[12:13], v[84:85], 0
    s_nop 1
    v_mfma_f32_4x4x4_16b_bf16 v[88:91], v[10:11], v[86:87], v[88:91]
    s_nop 4
    v_cvt_pk_bf16_f32 v88, v88, v89
    v_cvt_pk_bf16_f32 v89, v90, v91
    ds_pk_add_bf16 v7, v88 offset:65408
    ds_pk_add_bf16 v7, v89 offset:65412
    s_mov_b64 exec, s[54:55]
    s_branch L2_d144
L2_c145:
    s_lshl_b64 s[52:53], s[82:83], 1
    s_andn2_b64 s[52:53], s[52:53], s[80:81]
    s_andn2_b64 s[52:53], s[52:53], s[50:51]
    s_or_b64 s[80:81], s[80:81], s[52:53]
    s_not_b64 vcc, s[52:53]
    s_mov_b64 exec, -1
    v_cndmask_b32_dpp v84, v84, v84, vcc wave_shr:1 row_mask:0xf bank_mask:0xf
    v_cndmask_b32_dpp v85, v85, v85, vcc wave_shr:1 row_mask:0xf bank_mask:0xf
    s_lshr_b64 s[52:53], s[52:53], 1
    v_cndmask_b32_dpp v86, v86, v86, vcc wave_shr:1 row_mask:0xf bank_mask:0xf
    v_cndmask_b32_dpp v87, v87, v87, vcc wave_shr:1 row_mask:0xf bank_mask:0xf
    s_andn2_b64 s[82:83], s[82:83], s[52:53]
    v_cndmask_b32_dpp v7, v7, v7, vcc wave_shr:1 row_mask:0xf bank_mask:0xf
    s_mov_b64 exec, s[50:51]
    s_cbranch_scc0 L2_d145
    s_mov_b64 exec, s[82:83]
    s_nop 1
    v_mfma_f32_4x4x4_16b_bf16 v[88:91], v[12:13], v[84:85], 0
    s_nop 1
    v_mfma_f32_4x4x4_16b_bf16 v[88:91], v[10:11], v[86:87], v[88:91]
    s_nop 4
    v_cvt_pk_bf16_f32 v88, v88, v89
    v_cvt_pk_bf16_f32 v89, v90, v91
    ds_pk_add_bf16 v7, v88 offset:65408
    ds_pk_add_bf16 v7, v89 offset:65412
    s_mov_b64 exec, s[50:51]
    s_branch L2_d145
L2_c146:
    s_lshl_b64 s[52:53], s[82:83], 1
    s_andn2_b64 s[52:53], s[52:53], s[80:81]
    s_andn2_b64 s[52:53], s[52:53], s[54:55]
    s_or_b64 s[80:81], s[80:81], s[52:53]
    s_not_b64 vcc, s[52:53]
    s_mov_b64 exec, -1
    v_cndmask_b32_dpp v84, v84, v84, vcc wave_shr:1 row_mask:0xf bank_mask:0xf
    v_cndmask_b32_dpp v85, v85, v85, vcc wave_shr:1 row_mask:0xf bank_mask:0xf
    s_lshr_b64 s[52:53], s[52:53], 1
    v_cndmask_b32_dpp v86, v86, v86, vcc wave_shr:1 row_mask:0xf bank_mask:0xf
    v_cndmask_b32_dpp v87, v87, v87, vcc wave_shr:1 row_mask:0xf bank_mask:0xf
    s_andn2_b64 s[82:83], s[82:83], s[52:53]
    v_cndmask_b32_dpp v7, v7, v7, vcc wave_shr:1 row_mask:0xf bank_mask:0xf
    s_mov_b64 exec, s[54:55]
    s_cbranch_scc0 L2_d146
    s_mov_b64 exec, s[82:83]
    s_nop 1
    v_mfma_f32_4x4x4_16b_bf16 v[88:91], v[12:13], v[84:85], 0
    s_nop 1
    v_mfma_f32_4x4x4_16b_bf16 v[88:91], v[10:11], v[86:87], v[88:91]
    s_nop 4
    v_cvt_pk_bf16_f32 v88, v88, v89
    v_cvt_pk_bf16_f32 v89, v90, v91
    ds_pk_add_bf16 v7, v88 offset:65408
    ds_pk_add_bf16 v7, v89 offset:65412
    s_mov_b64 exec, s[54:55]
    s_branch L2_d146
L2_c147:
    s_lshl_b64 s[52:53], s[82:83], 1
    s_andn2_b64 s[52:53], s[52:53], s[80:81]
    s_andn2_b64 s[52:53], s[52:53], s[50:51]
    s_or_b64 s[80:81], s[80:81], s[52:53]
    s_not_b64 vcc, s[52:53]
    s_mov_b64 exec, -1
    v_cndmask_b32_dpp v84, v84, v84, vcc wave_shr:1 row_mask:0xf bank_mask:0xf
    v_cndmask_b32_dpp v85, v85, v85, vcc wave_shr:1 row_mask:0xf bank_mask:0xf
    s_lshr_b64 s[52:53], s[52:53], 1
    v_cndmask_b32_dpp v86, v86, v86, vcc wave_shr:1 row_mask:0xf bank_mask:0xf
    v_cndmask_b32_dpp v87, v87, v87, vcc wave_shr:1 row_mask:0xf bank_mask:0xf
    s_andn2_b64 s[82:83], s[82:83], s[52:53]
    v_cndmask_b32_dpp v7, v7, v7, vcc wave_shr:1 row_mask:0xf bank_mask:0xf
    s_mov_b64 exec, s[50:51]
    s_cbranch_scc0 L2_d147
    s_mov_b64 exec, s[82:83]
    s_nop 1
    v_mfma_f32_4x4x4_16b_bf16 v[88:91], v[12:13], v[84:85], 0
    s_nop 1
    v_mfma_f32_4x4x4_16b_bf16 v[88:91], v[10:11], v[86:87], v[88:91]
    s_nop 4
    v_cvt_pk_bf16_f32 v88, v88, v89
    v_cvt_pk_bf16_f32 v89, v90, v91
    ds_pk_add_bf16 v7, v88 offset:65408
    ds_pk_add_bf16 v7, v89 offset:65412
    s_mov_b64 exec, s[50:51]
    s_branch L2_d147
L2_c148:
    s_lshl_b64 s[52:53], s[82:83], 1
    s_andn2_b64 s[52:53], s[52:53], s[80:81]
    s_andn2_b64 s[52:53], s[52:53], s[54:55]
    s_or_b64 s[80:81], s[80:81], s[52:53]
    s_not_b64 vcc, s[52:53]
    s_mov_b64 exec, -1
    v_cndmask_b32_dpp v84, v84, v84, vcc wave_shr:1 row_mask:0xf bank_mask:0xf
    v_cndmask_b32_dpp v85, v85, v85, vcc wave_shr:1 row_mask:0xf bank_mask:0xf
    s_lshr_b64 s[52:53], s[52:53], 1
    v_cndmask_b32_dpp v86, v86, v86, vcc wave_shr:1 row_mask:0xf bank_mask:0xf
    v_cndmask_b32_dpp v87, v87, v87, vcc wave_shr:1 row_mask:0xf bank_mask:0xf
    s_andn2_b64 s[82:83], s[82:83], s[52:53]
    v_cndmask_b32_dpp v7, v7, v7, vcc wave_shr:1 row_mask:0xf bank_mask:0xf
    s_mov_b64 exec, s[54:55]
    s_cbranch_scc0 L2_d148
    s_mov_b64 exec, s[82:83]
    s_nop 1
    v_mfma_f32_4x4x4_16b_bf16 v[88:91], v[12:13], v[84:85], 0
    s_nop 1
    v_mfma_f32_4x4x4_16b_bf16 v[88:91], v[10:11], v[86:87], v[88:91]
    s_nop 4
    v_cvt_pk_bf16_f32 v88, v88, v89
    v_cvt_pk_bf16_f32 v89, v90, v91
    ds_pk_add_bf16 v7, v88 offset:65408
    ds_pk_add_bf16 v7, v89 offset:65412
    s_mov_b64 exec, s[54:55]
    s_branch L2_d148
L2_c149:
    s_lshl_b64 s[52:53], s[82:83], 1
    s_andn2_b64 s[52:53], s[52:53], s[80:81]
    s_andn2_b64 s[52:53], s[52:53], s[50:51]
    s_or_b64 s[80:81], s[80:81], s[52:53]
    s_not_b64 vcc, s[52:53]
    s_mov_b64 exec, -1
    v_cndmask_b32_dpp v84, v84, v84, vcc wave_shr:1 row_mask:0xf bank_mask:0xf
    v_cndmask_b32_dpp v85, v85, v85, vcc wave_shr:1 row_mask:0xf bank_mask:0xf
    s_lshr_b64 s[52:53], s[52:53], 1
    v_cndmask_b32_dpp v86, v86, v86, vcc wave_shr:1 row_mask:0xf bank_mask:0xf
    v_cndmask_b32_dpp v87, v87, v87, vcc wave_shr:1 row_mask:0xf bank_mask:0xf
    s_andn2_b64 s[82:83], s[82:83], s[52:53]
    v_cndmask_b32_dpp v7, v7, v7, vcc wave_shr:1 row_mask:0xf bank_mask:0xf
    s_mov_b64 exec, s[50:51]
    s_cbranch_scc0 L2_d149
    s_mov_b64 exec, s[82:83]
    s_nop 1
    v_mfma_f32_4x4x4_16b_bf16 v[88:91], v[12:13], v[84:85], 0
    s_nop 1
    v_mfma_f32_4x4x4_16b_bf16 v[88:91], v[10:11], v[86:87], v[88:91]
    s_nop 4
    v_cvt_pk_bf16_f32 v88, v88, v89
    v_cvt_pk_bf16_f32 v89, v90, v91
    ds_pk_add_bf16 v7, v88 offset:65408
    ds_pk_add_bf16 v7, v89 offset:65412
    s_mov_b64 exec, s[50:51]
    s_branch L2_d149
L2_c150:
    s_lshl_b64 s[52:53], s[82:83], 1
    s_andn2_b64 s[52:53], s[52:53], s[80:81]
    s_andn2_b64 s[52:53], s[52:53], s[54:55]
    s_or_b64 s[80:81], s[80:81], s[52:53]
    s_not_b64 vcc, s[52:53]
    s_mov_b64 exec, -1
    v_cndmask_b32_dpp v84, v84, v84, vcc wave_shr:1 row_mask:0xf bank_mask:0xf
    v_cndmask_b32_dpp v85, v85, v85, vcc wave_shr:1 row_mask:0xf bank_mask:0xf
    s_lshr_b64 s[52:53], s[52:53], 1
    v_cndmask_b32_dpp v86, v86, v86, vcc wave_shr:1 row_mask:0xf bank_mask:0xf
    v_cndmask_b32_dpp v87, v87, v87, vcc wave_shr:1 row_mask:0xf bank_mask:0xf
    s_andn2_b64 s[82:83], s[82:83], s[52:53]
    v_cndmask_b32_dpp v7, v7, v7, vcc wave_shr:1 row_mask:0xf bank_mask:0xf
    s_mov_b64 exec, s[54:55]
    s_cbranch_scc0 L2_d150
    s_mov_b64 exec, s[82:83]
    s_nop 1
    v_mfma_f32_4x4x4_16b_bf16 v[88:91], v[12:13], v[84:85], 0
    s_nop 1
    v_mfma_f32_4x4x4_16b_bf16 v[88:91], v[10:11], v[86:87], v[88:91]
    s_nop 4
    v_cvt_pk_bf16_f32 v88, v88, v89
    v_cvt_pk_bf16_f32 v89, v90, v91
    ds_pk_add_bf16 v7, v88 offset:65408
    ds_pk_add_bf16 v7, v89 offset:65412
    s_mov_b64 exec, s[54:55]
    s_branch L2_d150
L2_c151:
    s_lshl_b64 s[52:53], s[82:83], 1
    s_andn2_b64 s[52:53], s[52:53], s[80:81]
    s_andn2_b64 s[52:53], s[52:53], s[50:51]
    s_or_b64 s[80:81], s[80:81], s[52:53]
    s_not_b64 vcc, s[52:53]
    s_mov_b64 exec, -1
    v_cndmask_b32_dpp v84, v84, v84, vcc wave_shr:1 row_mask:0xf bank_mask:0xf
    v_cndmask_b32_dpp v85, v85, v85, vcc wave_shr:1 row_mask:0xf bank_mask:0xf
    s_lshr_b64 s[52:53], s[52:53], 1
    v_cndmask_b32_dpp v86, v86, v86, vcc wave_shr:1 row_mask:0xf bank_mask:0xf
    v_cndmask_b32_dpp v87, v87, v87, vcc wave_shr:1 row_mask:0xf bank_mask:0xf
    s_andn2_b64 s[82:83], s[82:83], s[52:53]
    v_cndmask_b32_dpp v7, v7, v7, vcc wave_shr:1 row_mask:0xf bank_mask:0xf
    s_mov_b64 exec, s[50:51]
    s_cbranch_scc0 L2_d151
    s_mov_b64 exec, s[82:83]
    s_nop 1
    v_mfma_f32_4x4x4_16b_bf16 v[88:91], v[12:13], v[84:85], 0
    s_nop 1
    v_mfma_f32_4x4x4_16b_bf16 v[88:91], v[10:11], v[86:87], v[88:91]
    s_nop 4
    v_cvt_pk_bf16_f32 v88, v88, v89
    v_cvt_pk_bf16_f32 v89, v90, v91
    ds_pk_add_bf16 v7, v88 offset:65408
    ds_pk_add_bf16 v7, v89 offset:65412
    s_mov_b64 exec, s[50:51]
    s_branch L2_d151
L2_c152:
    s_mov_b64 s[50:51], vcc
    s_lshl_b64 s[52:53], s[82:83], 1
    s_andn2_b64 s[52:53], s[52:53], s[80:81]
    s_andn2_b64 s[52:53], s[52:53], s[50:51]
    s_or_b64 s[80:81], s[80:81], s[52:53]
    s_not_b64 vcc, s[52:53]
    s_mov_b64 exec, -1
    v_cndmask_b32_dpp v84, v84, v84, vcc wave_shr:1 row_mask:0xf bank_mask:0xf
    v_cndmask_b32_dpp v85, v85, v85, vcc wave_shr:1 row_mask:0xf bank_mask:0xf
    s_lshr_b64 s[52:53], s[52:53], 1
    v_cndmask_b32_dpp v86, v86, v86, vcc wave_shr:1 row_mask:0xf bank_mask:0xf
    v_cndmask_b32_dpp v87, v87, v87, vcc wave_shr:1 row_mask:0xf bank_mask:0xf
    s_andn2_b64 s[82:83], s[82:83], s[52:53]
    v_cndmask_b32_dpp v7, v7, v7, vcc wave_shr:1 row_mask:0xf bank_mask:0xf
    s_mov_b64 vcc, s[50:51]
    s_mov_b64 exec, s[50:51]
    s_cbranch_scc0 L2_d152
    s_mov_b64 exec, s[82:83]
    s_nop 1
    v_mfma_f32_4x4x4_16b_bf16 v[88:91], v[12:13], v[84:85], 0
    s_nop 1
    v_mfma_f32_4x4x4_16b_bf16 v[88:91], v[10:11], v[86:87], v[88:91]
    s_nop 4
    v_cvt_pk_bf16_f32 v88, v88, v89
    v_cvt_pk_bf16_f32 v89, v90, v91
    ds_pk_add_bf16 v7, v88 offset:65408
    ds_pk_add_bf16 v7, v89 offset:65412
    s_mov_b64 exec, vcc
    s_branch L2_d152
L2_c153:
    s_mov_b64 s[50:51], vcc
    s_lshl_b64 s[52:53], s[82:83], 1
    s_andn2_b64 s[52:53], s[52:53], s[80:81]
    s_andn2_b64 s[52:53], s[52:53], s[50:51]
    s_or_b64 s[80:81], s[80:81], s[52:53]
    s_not_b64 vcc, s[52:53]
    s_mov_b64 exec, -1
    v_cndmask_b32_dpp v84, v84, v84, vcc wave_shr:1 row_mask:0xf bank_mask:0xf
    v_cndmask_b32_dpp v85, v85, v85, vcc wave_shr:1 row_mask:0xf bank_mask:0xf
    s_lshr_b64 s[52:53], s[52:53], 1
    v_cndmask_b32_dpp v86, v86, v86, vcc wave_shr:1 row_mask:0xf bank_mask:0xf
    v_cndmask_b32_dpp v87, v87, v87, vcc wave_shr:1 row_mask:0xf bank_mask:0xf
    s_andn2_b64 s[82:83], s[82:83], s[52:53]
    v_cndmask_b32_dpp v7, v7, v7, vcc wave_shr:1 row_mask:0xf bank_mask:0xf
    s_mov_b64 vcc, s[50:51]
    s_mov_b64 exec, s[50:51]
    s_cbranch_scc0 L2_d153
    s_mov_b64 exec, s[82:83]
    s_nop 1
    v_mfma_f32_4x4x4_16b_bf16 v[88:91], v[12:13], v[84:85], 0
    s_nop 1
    v_mfma_f32_4x4x4_16b_bf16 v[88:91], v[10:11], v[86:87], v[88:91]
    s_nop 4
    v_cvt_pk_bf16_f32 v88, v88, v89
    v_cvt_pk_bf16_f32 v89, v90, v91
    ds_pk_add_bf16 v7, v88 offset:65408
    ds_pk_add_bf16 v7, v89 offset:65412
    s_mov_b64 exec, vcc
    s_branch L2_d153
L2_f3s:
    s_branch L2_f3
.section .rodata,"a"
.p2align 6
.amdhsa_kernel gather_scatter__molecular_angular_gemnet__graph_kernel
  .amdhsa_next_free_vgpr 128
  .amdhsa_next_free_sgpr 102
  .amdhsa_accum_offset 128
  .amdhsa_group_segment_fixed_size 0
  .amdhsa_kernarg_size 112
  .amdhsa_user_sgpr_count 2
  .amdhsa_user_sgpr_kernarg_segment_ptr 1
  .amdhsa_system_sgpr_workgroup_id_x 1
  .amdhsa_float_denorm_mode_32 3
.end_amdhsa_kernel
```

```asm
; @launch grid=(256,1,1) block=(1024,1,1) lds=163840
.amdgcn_target "amdgcn-amd-amdhsa--gfx950"
.text
.globl gather_scatter__molecular_angular_gemnet__graph_kernel
.p2align 8
.type gather_scatter__molecular_angular_gemnet__graph_kernel,@function
gather_scatter__molecular_angular_gemnet__graph_kernel:
    s_cmp_ge_u32 s2, 256
    s_cbranch_scc0 L1_go
    s_endpgm
L1_go:
    s_load_dwordx4 s[4:7], s[0:1], 8
    s_load_dwordx2 s[28:29], s[0:1], 32
    s_load_dwordx2 s[30:31], s[0:1], 104
    s_load_dwordx2 s[56:57], s[0:1], 96
    s_load_dwordx2 s[86:87], s[0:1], 0
    s_load_dwordx4 s[60:63], s[0:1], 56
    s_load_dwordx4 s[64:67], s[0:1], 72
    v_lshrrev_b32 v7, 6, v0
    v_lshlrev_b32 v1, 3, v0
    v_readfirstlane_b32 s32, v7
    v_lshlrev_b32 v0, 4, v0
    v_and_b32 v1, 0x1f8, v1
    v_lshlrev_b32 v15, 1, v1
    s_lshr_b32 s3, s32, 1
    s_and_b32 s44, s32, 1
    s_lshl_b32 s44, s44, 3
    s_or_b32 s3, s3, s44
    s_lshl_b32 s3, s3, 10
    s_lshl_b32 s96, s2, 14
    s_add_u32 s96, s96, s3
    s_lshr_b32 s3, s32, 1
    s_and_b32 s44, s32, 1
    s_lshl_b32 s44, s44, 3
    s_or_b32 s3, s3, s44
    s_lshl_b32 s3, s3, 10
    s_lshl_b32 s97, s2, 14
    s_add_u32 s97, s97, s3
    s_lshr_b32 s3, s32, 1
    s_and_b32 s44, s32, 1
    s_lshl_b32 s44, s44, 3
    s_or_b32 s3, s3, s44
    s_lshl_b32 s3, s3, 10
    s_lshl_b32 s98, s2, 14
    s_add_u32 s98, s98, s3
    s_lshr_b32 s3, s32, 1
    s_and_b32 s44, s32, 1
    s_lshl_b32 s44, s44, 3
    s_or_b32 s3, s3, s44
    s_lshl_b32 s3, s3, 10
    s_lshl_b32 s99, s2, 14
    s_add_u32 s99, s99, s3
    s_waitcnt lgkmcnt(0)
    s_mov_b32 s8, s4
    s_mov_b32 s9, s5
    s_mov_b32 s10, 0x9c40000
    s_mov_b32 s11, 0x20000
    s_mov_b32 s12, s6
    s_mov_b32 s13, s7
    s_mov_b32 s14, 0x9c40000
    s_mov_b32 s15, 0x20000
    s_mov_b32 s16, s28
    s_mov_b32 s17, s29
    s_mov_b32 s18, 0x4e20000
    s_mov_b32 s19, 0x20000
    s_mov_b32 s68, s62
    s_mov_b32 s69, s63
    s_mov_b32 s70, 0x40
    s_mov_b32 s71, 0x20000
    s_mov_b32 s72, s60
    s_mov_b32 s73, s61
    s_mov_b32 s74, 0x40
    s_mov_b32 s75, 0x20000
    s_mov_b32 s20, s66
    s_mov_b32 s21, s67
    s_mov_b32 s22, 0x20
    s_mov_b32 s23, 0x20000
    s_mov_b32 s80, s64
    s_mov_b32 s81, s65
    s_mov_b32 s82, 0x20
    s_mov_b32 s83, 0x20000
    s_add_u32 s24, s30, 0xec45000
    s_addc_u32 s25, s31, 0
    s_mov_b32 s26, 0x100
    s_mov_b32 s27, 0x20000
    v_lshrrev_b32 v2, 3, v0
    v_and_b32 v2, 6, v2
    v_lshlrev_b32 v3, 2, v0
    s_lshl_b32 s3, s32, 8
    s_add_u32 s3, s3, s2
    s_cmp_lg_u32 s3, 254
    s_cbranch_scc1 L1_wt
    buffer_load_ushort v96, v2, s[68:71], 0 offen offset:0
    buffer_load_ushort v108, v2, s[68:71], 0 offen offset:8
    buffer_load_ushort v97, v2, s[68:71], 0 offen offset:16
    buffer_load_ushort v109, v2, s[68:71], 0 offen offset:24
    buffer_load_ushort v98, v2, s[68:71], 0 offen offset:32
    buffer_load_ushort v110, v2, s[68:71], 0 offen offset:40
    buffer_load_ushort v99, v2, s[68:71], 0 offen offset:48
    buffer_load_ushort v111, v2, s[68:71], 0 offen offset:56
    buffer_load_ushort v100, v2, s[72:75], 0 offen offset:0
    buffer_load_ushort v112, v2, s[72:75], 0 offen offset:8
    buffer_load_ushort v101, v2, s[72:75], 0 offen offset:16
    buffer_load_ushort v113, v2, s[72:75], 0 offen offset:24
    buffer_load_ushort v102, v2, s[72:75], 0 offen offset:32
    buffer_load_ushort v114, v2, s[72:75], 0 offen offset:40
    buffer_load_ushort v103, v2, s[72:75], 0 offen offset:48
    buffer_load_ushort v115, v2, s[72:75], 0 offen offset:56
    buffer_load_ushort v104, v2, s[20:23], 0 offen offset:0
    buffer_load_ushort v116, v2, s[20:23], 0 offen offset:8
    buffer_load_ushort v105, v2, s[20:23], 0 offen offset:16
    buffer_load_ushort v117, v2, s[20:23], 0 offen offset:24
    buffer_load_ushort v106, v2, s[80:83], 0 offen offset:0
    buffer_load_ushort v118, v2, s[80:83], 0 offen offset:8
    buffer_load_ushort v107, v2, s[80:83], 0 offen offset:16
    buffer_load_ushort v119, v2, s[80:83], 0 offen offset:24
    s_waitcnt vmcnt(0)
    v_lshl_or_b32 v96, v108, 16, v96
    v_lshl_or_b32 v97, v109, 16, v97
    v_lshl_or_b32 v98, v110, 16, v98
    v_lshl_or_b32 v99, v111, 16, v99
    v_lshl_or_b32 v100, v112, 16, v100
    v_lshl_or_b32 v101, v113, 16, v101
    v_lshl_or_b32 v102, v114, 16, v102
    v_lshl_or_b32 v103, v115, 16, v103
    v_lshl_or_b32 v104, v116, 16, v104
    v_lshl_or_b32 v105, v117, 16, v105
    v_lshl_or_b32 v106, v118, 16, v106
    v_lshl_or_b32 v107, v119, 16, v107
    buffer_store_dwordx4 v[96:99], v3, s[24:27], 0 offen offset:0 sc1
    buffer_store_dwordx4 v[100:103], v3, s[24:27], 0 offen offset:16 sc1
    buffer_store_dwordx4 v[104:107], v3, s[24:27], 0 offen offset:32 sc1
L1_wt:
    s_nop 1
    s_add_u32 s44, s96, 0x0
    v_lshlrev_b32 v16, 1, v1
    buffer_load_dwordx4 v[16:19], v16, s[8:11], s44 offen nt
    s_add_u32 s45, s96, 0x0
    v_lshlrev_b32 v20, 1, v1
    buffer_load_dwordx4 v[20:23], v20, s[12:15], s45 offen nt
    s_add_u32 s46, s96, 0x0
    s_lshr_b32 s46, s46, 1
    buffer_load_dwordx2 v[24:25], v1, s[16:19], s46 offen nt
    s_add_u32 s47, s97, 0x400000
    s_lshr_b32 s47, s47, 1
    buffer_load_dwordx2 v[26:27], v1, s[16:19], s47 offen nt
    s_add_u32 s44, s97, 0x400000
    v_lshlrev_b32 v28, 1, v1
    buffer_load_dwordx4 v[28:31], v28, s[8:11], s44 offen nt
    s_add_u32 s45, s97, 0x400000
    v_lshlrev_b32 v32, 1, v1
    buffer_load_dwordx4 v[32:35], v32, s[12:15], s45 offen nt
    s_add_u32 s46, s98, 0x800000
    v_lshlrev_b32 v36, 1, v1
    buffer_load_dwordx4 v[36:39], v36, s[8:11], s46 offen nt
    s_add_u32 s47, s98, 0x800000
    v_lshlrev_b32 v40, 1, v1
    buffer_load_dwordx4 v[40:43], v40, s[12:15], s47 offen nt
    s_add_u32 s44, s98, 0x800000
    s_lshr_b32 s44, s44, 1
    buffer_load_dwordx2 v[44:45], v1, s[16:19], s44 offen nt
    s_add_u32 s45, s99, 0xc00000
    s_lshr_b32 s45, s45, 1
    buffer_load_dwordx2 v[46:47], v1, s[16:19], s45 offen nt
    s_mov_b32 s20, s30
    s_mov_b32 s21, s31
    s_mov_b32 s22, 0xd344000
    s_mov_b32 s23, 0x20000
    s_add_u32 s24, s30, 0x2c000
    s_addc_u32 s25, s31, 0
    s_mov_b32 s26, 0xd318000
    s_mov_b32 s27, 0x20000
    s_add_u32 s3, s32, 0
    s_mul_i32 s4, s3, 205
    s_lshr_b32 s4, s4, 10
    s_mul_i32 s5, s4, 5
    s_sub_u32 s5, s3, s5
    s_lshl_b32 s5, s5, 5
    s_add_u32 s4, s4, s5
    s_sub_u32 s4, s4, s32
    s_lshl_b32 s72, s4, 10
    s_add_u32 s3, s32, 16
    s_mul_i32 s4, s3, 205
    s_lshr_b32 s4, s4, 10
    s_mul_i32 s5, s4, 5
    s_sub_u32 s5, s3, s5
    s_lshl_b32 s5, s5, 5
    s_add_u32 s4, s4, s5
    s_sub_u32 s4, s4, s32
    s_lshl_b32 s73, s4, 10
    s_add_u32 s3, s32, 32
    s_mul_i32 s4, s3, 205
    s_lshr_b32 s4, s4, 10
    s_mul_i32 s5, s4, 5
    s_sub_u32 s5, s3, s5
    s_lshl_b32 s5, s5, 5
    s_add_u32 s4, s4, s5
    s_sub_u32 s4, s4, s32
    s_lshl_b32 s85, s4, 10
    s_add_u32 s3, s32, 48
    s_mul_i32 s4, s3, 205
    s_lshr_b32 s4, s4, 10
    s_mul_i32 s5, s4, 5
    s_sub_u32 s5, s3, s5
    s_lshl_b32 s5, s5, 5
    s_add_u32 s4, s4, s5
    s_sub_u32 s4, s4, s32
    s_lshl_b32 s91, s4, 10
    s_add_u32 s3, s32, 64
    s_mul_i32 s4, s3, 205
    s_lshr_b32 s4, s4, 10
    s_mul_i32 s5, s4, 5
    s_sub_u32 s5, s3, s5
    s_lshl_b32 s5, s5, 5
    s_add_u32 s4, s4, s5
    s_sub_u32 s4, s4, s32
    s_lshl_b32 s93, s4, 10
    s_mov_b32 s80, s86
    s_mov_b32 s81, s87
    s_mov_b32 s82, 0x4e2000
    s_mov_b32 s83, 0x20000
    s_mul_i32 s35, s2, 173056
    s_and_b32 s37, s32, 3
    s_lshl_b32 s37, s37, 3
    s_mov_b32 s36, s37
    s_lshr_b32 s37, s32, 2
    s_mul_i32 s37, s37, 2080
    s_add_u32 s36, s36, s37
    s_and_b32 s37, s2, 3
    s_lshl_b32 s37, s37, 5
    s_add_u32 s36, s36, s37
    s_mul_i32 s4, s2, 5
    s_add_u32 s4, s4, 8192
    s_lshl_b32 s38, s4, 14
    s_lshl_b32 s39, s4, 13
    v_mov_b32 v2, 1
    v_mov_b32 v4, 0x80000007
    v_mov_b32 v5, 0xfc
    v_mov_b32 v6, 0x78
    s_mov_b32 s40, 16512
    s_mov_b32 s55, -10000
    s_mov_b32 s41, 0x010c0c01
    s_mov_b32 s42, 0x030c0c03
    v_mov_b32 v8, 0
    v_mov_b32 v9, 0
    v_mov_b32 v10, 0
    v_mov_b32 v11, 0
    ds_write_b128 v0, v[8:11]
    s_add_u32 s60, s30, 0xec4e000
    s_addc_u32 s61, s31, 0
    s_mov_b32 s62, 0x8000
    s_mov_b32 s63, 0x20000
    s_mov_b64 s[66:67], s[56:57]
    s_lshl_b32 s57, s2, 7
    s_add_u32 s68, s30, 0xec46000
    s_addc_u32 s69, s31, 0
    s_mov_b32 s70, 0x80
    s_mov_b32 s71, 0x20000
    s_lshl_b32 s3, s2, 7
    s_add_u32 s68, s68, s3
    s_addc_u32 s69, s69, 0
    s_cmp_lg_u32 s32, 0
    s_cbranch_scc1 L1_fl
    buffer_store_dwordx4 v[8:11], v0, s[68:71], 0 offen sc1
    s_mov_b64 exec, 0xff
    buffer_store_dwordx4 v[8:11], v0, s[60:63], s57 offen sc1
    s_mov_b64 exec, -1
L1_fl:
    s_waitcnt lgkmcnt(0)
    s_barrier
    s_setprio 3
    s_add_u32 s46, s99, 0xc00000
    v_lshlrev_b32 v48, 1, v1
    buffer_load_dwordx4 v[48:51], v48, s[8:11], s46 offen nt
    s_add_u32 s47, s99, 0xc00000
    v_lshlrev_b32 v52, 1, v1
    buffer_load_dwordx4 v[52:55], v52, s[12:15], s47 offen nt
    s_waitcnt vmcnt(8)
    v_lshlrev_b32 v7, 16, v24
    v_and_b32 v8, 0xffff0000, v24
    v_lshlrev_b32 v9, 16, v25
    v_and_b32 v10, 0xffff0000, v25
    v_mul_f32 v7, 0.15915494, v7
    v_mul_f32 v8, 0.15915494, v8
    v_mul_f32 v9, 0.15915494, v9
    v_mul_f32 v10, 0.15915494, v10
    v_mul_hi_u32_u24 v14, 429497, v16
    v_lshrrev_b32 v12, 3, v20
    v_cos_f32 v7, v7
    v_lshlrev_b16 v13, 3, v20
    v_mad_i32_i24 v11, v14, s55, v16
    v_bitop3_b32 v12, v6, v13, v12 bitop3:0xca
    v_lshl_add_u32 v11, v11, 17, s40
    v_lshlrev_b16 v14, 8, v14
    v_lshrrev_b32 v13, 2, v20
    v_add_u32 v16, v12, v11
    v_bitop3_b32 v20, v5, v13, v14 bitop3:0xea
    ds_add_u32 v20, v2
    v_mul_hi_u32_u24 v14, 429497, v17
    v_lshrrev_b32 v12, 3, v21
    v_cos_f32 v8, v8
    v_lshlrev_b16 v13, 3, v21
    v_mad_i32_i24 v11, v14, s55, v17
    v_bitop3_b32 v12, v6, v13, v12 bitop3:0xca
    v_lshl_add_u32 v11, v11, 17, s40
    v_lshlrev_b16 v14, 8, v14
    v_lshrrev_b32 v13, 2, v21
    v_add_u32 v17, v12, v11
    v_bitop3_b32 v21, v5, v13, v14 bitop3:0xea
    ds_add_u32 v21, v2
    v_cvt_pk_bf16_f32 v24, v7, v8
    v_perm_b32 v12, v24, v24, s41
    v_bitop3_b32 v16, v4, v12, v16 bitop3:0xca
    v_perm_b32 v13, v24, v24, s42
    v_bitop3_b32 v17, v4, v13, v17 bitop3:0xca
    v_mul_hi_u32_u24 v14, 429497, v18
    v_lshrrev_b32 v12, 3, v22
    v_cos_f32 v9, v9
    v_lshlrev_b16 v13, 3, v22
    v_mad_i32_i24 v11, v14, s55, v18
    v_bitop3_b32 v12, v6, v13, v12 bitop3:0xca
    v_lshl_add_u32 v11, v11, 17, s40
    v_lshlrev_b16 v14, 8, v14
    v_lshrrev_b32 v13, 2, v22
    v_add_u32 v18, v12, v11
    v_bitop3_b32 v22, v5, v13, v14 bitop3:0xea
    ds_add_u32 v22, v2
    v_mul_hi_u32_u24 v14, 429497, v19
    v_lshrrev_b32 v12, 3, v23
    v_cos_f32 v10, v10
    v_lshlrev_b16 v13, 3, v23
    v_mad_i32_i24 v11, v14, s55, v19
    v_bitop3_b32 v12, v6, v13, v12 bitop3:0xca
    v_lshl_add_u32 v11, v11, 17, s40
    v_lshlrev_b16 v14, 8, v14
    v_lshrrev_b32 v13, 2, v23
    v_add_u32 v19, v12, v11
    v_bitop3_b32 v23, v5, v13, v14 bitop3:0xea
    ds_add_u32 v23, v2
    v_cvt_pk_bf16_f32 v25, v9, v10
    v_perm_b32 v12, v25, v25, s41
    v_bitop3_b32 v18, v4, v12, v18 bitop3:0xca
    v_perm_b32 v13, v25, v25, s42
    v_bitop3_b32 v19, v4, v13, v19 bitop3:0xca
    s_add_u32 s44, s96, 0x1000000
    v_lshlrev_b32 v56, 1, v1
    buffer_load_dwordx4 v[56:59], v56, s[8:11], s44 offen nt
    s_add_u32 s45, s96, 0x1000000
    v_lshlrev_b32 v60, 1, v1
    buffer_load_dwordx4 v[60:63], v60, s[12:15], s45 offen nt
    s_add_u32 s46, s96, 0x1000000
    s_lshr_b32 s46, s46, 1
    buffer_load_dwordx2 v[64:65], v1, s[16:19], s46 offen nt
    s_add_u32 s47, s97, 0x1400000
    s_lshr_b32 s47, s47, 1
    buffer_load_dwordx2 v[66:67], v1, s[16:19], s47 offen nt
    s_waitcnt vmcnt(10)
    v_lshlrev_b32 v7, 16, v26
    v_and_b32 v8, 0xffff0000, v26
    v_lshlrev_b32 v9, 16, v27
    v_and_b32 v10, 0xffff0000, v27
    v_mul_f32 v7, 0.15915494, v7
    v_mul_f32 v8, 0.15915494, v8
    v_mul_f32 v9, 0.15915494, v9
    v_mul_f32 v10, 0.15915494, v10
    v_mul_hi_u32_u24 v14, 429497, v28
    v_lshrrev_b32 v12, 3, v32
    v_cos_f32 v7, v7
    v_lshlrev_b16 v13, 3, v32
    v_mad_i32_i24 v11, v14, s55, v28
    v_bitop3_b32 v12, v6, v13, v12 bitop3:0xca
    v_lshl_add_u32 v11, v11, 17, s40
    v_lshlrev_b16 v14, 8, v14
    v_lshrrev_b32 v13, 2, v32
    v_add_u32 v28, v12, v11
    v_bitop3_b32 v32, v5, v13, v14 bitop3:0xea
    ds_add_u32 v32, v2
    v_mul_hi_u32_u24 v14, 429497, v29
    v_lshrrev_b32 v12, 3, v33
    v_cos_f32 v8, v8
    v_lshlrev_b16 v13, 3, v33
    v_mad_i32_i24 v11, v14, s55, v29
    v_bitop3_b32 v12, v6, v13, v12 bitop3:0xca
    v_lshl_add_u32 v11, v11, 17, s40
    v_lshlrev_b16 v14, 8, v14
    v_lshrrev_b32 v13, 2, v33
    v_add_u32 v29, v12, v11
    v_bitop3_b32 v33, v5, v13, v14 bitop3:0xea
    ds_add_u32 v33, v2
    v_cvt_pk_bf16_f32 v26, v7, v8
    v_perm_b32 v12, v26, v26, s41
    v_bitop3_b32 v28, v4, v12, v28 bitop3:0xca
    v_perm_b32 v13, v26, v26, s42
    v_bitop3_b32 v29, v4, v13, v29 bitop3:0xca
    v_mul_hi_u32_u24 v14, 429497, v30
    v_lshrrev_b32 v12, 3, v34
    v_cos_f32 v9, v9
    v_lshlrev_b16 v13, 3, v34
    v_mad_i32_i24 v11, v14, s55, v30
    v_bitop3_b32 v12, v6, v13, v12 bitop3:0xca
    v_lshl_add_u32 v11, v11, 17, s40
    v_lshlrev_b16 v14, 8, v14
    v_lshrrev_b32 v13, 2, v34
    v_add_u32 v30, v12, v11
    v_bitop3_b32 v34, v5, v13, v14 bitop3:0xea
    ds_add_u32 v34, v2
    v_mul_hi_u32_u24 v14, 429497, v31
    v_lshrrev_b32 v12, 3, v35
    v_cos_f32 v10, v10
    v_lshlrev_b16 v13, 3, v35
    v_mad_i32_i24 v11, v14, s55, v31
    v_bitop3_b32 v12, v6, v13, v12 bitop3:0xca
    v_lshl_add_u32 v11, v11, 17, s40
    v_lshlrev_b16 v14, 8, v14
    v_lshrrev_b32 v13, 2, v35
    v_add_u32 v31, v12, v11
    v_bitop3_b32 v35, v5, v13, v14 bitop3:0xea
    ds_add_u32 v35, v2
    v_cvt_pk_bf16_f32 v27, v9, v10
    v_perm_b32 v12, v27, v27, s41
    v_bitop3_b32 v30, v4, v12, v30 bitop3:0xca
    v_perm_b32 v13, v27, v27, s42
    v_bitop3_b32 v31, v4, v13, v31 bitop3:0xca
    s_setprio 2
    s_add_u32 s44, s97, 0x1400000
    v_lshlrev_b32 v68, 1, v1
    buffer_load_dwordx4 v[68:71], v68, s[8:11], s44 offen nt
    s_add_u32 s45, s97, 0x1400000
    v_lshlrev_b32 v72, 1, v1
    buffer_load_dwordx4 v[72:75], v72, s[12:15], s45 offen nt
    s_waitcnt vmcnt(8)
    v_lshlrev_b32 v7, 16, v44
    v_and_b32 v8, 0xffff0000, v44
    v_lshlrev_b32 v9, 16, v45
    v_and_b32 v10, 0xffff0000, v45
    v_mul_f32 v7, 0.15915494, v7
    v_mul_f32 v8, 0.15915494, v8
    v_mul_f32 v9, 0.15915494, v9
    v_mul_f32 v10, 0.15915494, v10
    v_mul_hi_u32_u24 v14, 429497, v36
    v_lshrrev_b32 v12, 3, v40
    v_cos_f32 v7, v7
    v_lshlrev_b16 v13, 3, v40
    v_mad_i32_i24 v11, v14, s55, v36
    v_bitop3_b32 v12, v6, v13, v12 bitop3:0xca
    v_lshl_add_u32 v11, v11, 17, s40
    v_lshlrev_b16 v14, 8, v14
    v_lshrrev_b32 v13, 2, v40
    v_add_u32 v36, v12, v11
    v_bitop3_b32 v40, v5, v13, v14 bitop3:0xea
    ds_add_u32 v40, v2
    v_mul_hi_u32_u24 v14, 429497, v37
    v_lshrrev_b32 v12, 3, v41
    v_cos_f32 v8, v8
    v_lshlrev_b16 v13, 3, v41
    v_mad_i32_i24 v11, v14, s55, v37
    v_bitop3_b32 v12, v6, v13, v12 bitop3:0xca
    v_lshl_add_u32 v11, v11, 17, s40
    v_lshlrev_b16 v14, 8, v14
    v_lshrrev_b32 v13, 2, v41
    v_add_u32 v37, v12, v11
    v_bitop3_b32 v41, v5, v13, v14 bitop3:0xea
    ds_add_u32 v41, v2
    v_cvt_pk_bf16_f32 v44, v7, v8
    v_perm_b32 v12, v44, v44, s41
    v_bitop3_b32 v36, v4, v12, v36 bitop3:0xca
    v_perm_b32 v13, v44, v44, s42
    v_bitop3_b32 v37, v4, v13, v37 bitop3:0xca
    v_mul_hi_u32_u24 v14, 429497, v38
    v_lshrrev_b32 v12, 3, v42
    v_cos_f32 v9, v9
    v_lshlrev_b16 v13, 3, v42
    v_mad_i32_i24 v11, v14, s55, v38
    v_bitop3_b32 v12, v6, v13, v12 bitop3:0xca
    v_lshl_add_u32 v11, v11, 17, s40
    v_lshlrev_b16 v14, 8, v14
    v_lshrrev_b32 v13, 2, v42
    v_add_u32 v38, v12, v11
    v_bitop3_b32 v42, v5, v13, v14 bitop3:0xea
    ds_add_u32 v42, v2
    v_mul_hi_u32_u24 v14, 429497, v39
    v_lshrrev_b32 v12, 3, v43
    v_cos_f32 v10, v10
    v_lshlrev_b16 v13, 3, v43
    v_mad_i32_i24 v11, v14, s55, v39
    v_bitop3_b32 v12, v6, v13, v12 bitop3:0xca
    v_lshl_add_u32 v11, v11, 17, s40
    v_lshlrev_b16 v14, 8, v14
    v_lshrrev_b32 v13, 2, v43
    v_add_u32 v39, v12, v11
    v_bitop3_b32 v43, v5, v13, v14 bitop3:0xea
    ds_add_u32 v43, v2
    v_cvt_pk_bf16_f32 v45, v9, v10
    v_perm_b32 v12, v45, v45, s41
    v_bitop3_b32 v38, v4, v12, v38 bitop3:0xca
    v_perm_b32 v13, v45, v45, s42
    v_bitop3_b32 v39, v4, v13, v39 bitop3:0xca
    s_add_u32 s46, s98, 0x1800000
    v_lshlrev_b32 v76, 1, v1
    buffer_load_dwordx4 v[76:79], v76, s[8:11], s46 offen nt
    s_add_u32 s47, s98, 0x1800000
    v_lshlrev_b32 v80, 1, v1
    buffer_load_dwordx4 v[80:83], v80, s[12:15], s47 offen nt
    s_add_u32 s44, s98, 0x1800000
    s_lshr_b32 s44, s44, 1
    buffer_load_dwordx2 v[84:85], v1, s[16:19], s44 offen nt
    s_add_u32 s45, s99, 0x1c00000
    s_lshr_b32 s45, s45, 1
    buffer_load_dwordx2 v[86:87], v1, s[16:19], s45 offen nt
    s_waitcnt vmcnt(10)
    v_lshlrev_b32 v7, 16, v46
    v_and_b32 v8, 0xffff0000, v46
    v_lshlrev_b32 v9, 16, v47
    v_and_b32 v10, 0xffff0000, v47
    v_mul_f32 v7, 0.15915494, v7
    v_mul_f32 v8, 0.15915494, v8
    v_mul_f32 v9, 0.15915494, v9
    v_mul_f32 v10, 0.15915494, v10
    v_mul_hi_u32_u24 v14, 429497, v48
    v_lshrrev_b32 v12, 3, v52
    v_cos_f32 v7, v7
    v_lshlrev_b16 v13, 3, v52
    v_mad_i32_i24 v11, v14, s55, v48
    v_bitop3_b32 v12, v6, v13, v12 bitop3:0xca
    v_lshl_add_u32 v11, v11, 17, s40
    v_lshlrev_b16 v14, 8, v14
    v_lshrrev_b32 v13, 2, v52
    v_add_u32 v48, v12, v11
    v_bitop3_b32 v52, v5, v13, v14 bitop3:0xea
    ds_add_u32 v52, v2
    v_mul_hi_u32_u24 v14, 429497, v49
    v_lshrrev_b32 v12, 3, v53
    v_cos_f32 v8, v8
    v_lshlrev_b16 v13, 3, v53
    v_mad_i32_i24 v11, v14, s55, v49
    v_bitop3_b32 v12, v6, v13, v12 bitop3:0xca
    v_lshl_add_u32 v11, v11, 17, s40
    v_lshlrev_b16 v14, 8, v14
    v_lshrrev_b32 v13, 2, v53
    v_add_u32 v49, v12, v11
    v_bitop3_b32 v53, v5, v13, v14 bitop3:0xea
    ds_add_u32 v53, v2
    v_cvt_pk_bf16_f32 v46, v7, v8
    v_perm_b32 v12, v46, v46, s41
    v_bitop3_b32 v48, v4, v12, v48 bitop3:0xca
    v_perm_b32 v13, v46, v46, s42
    v_bitop3_b32 v49, v4, v13, v49 bitop3:0xca
    v_mul_hi_u32_u24 v14, 429497, v50
    v_lshrrev_b32 v12, 3, v54
    v_cos_f32 v9, v9
    v_lshlrev_b16 v13, 3, v54
    v_mad_i32_i24 v11, v14, s55, v50
    v_bitop3_b32 v12, v6, v13, v12 bitop3:0xca
    v_lshl_add_u32 v11, v11, 17, s40
    v_lshlrev_b16 v14, 8, v14
    v_lshrrev_b32 v13, 2, v54
    v_add_u32 v50, v12, v11
    v_bitop3_b32 v54, v5, v13, v14 bitop3:0xea
    ds_add_u32 v54, v2
    v_mul_hi_u32_u24 v14, 429497, v51
    v_lshrrev_b32 v12, 3, v55
    v_cos_f32 v10, v10
    v_lshlrev_b16 v13, 3, v55
    v_mad_i32_i24 v11, v14, s55, v51
    v_bitop3_b32 v12, v6, v13, v12 bitop3:0xca
    v_lshl_add_u32 v11, v11, 17, s40
    v_lshlrev_b16 v14, 8, v14
    v_lshrrev_b32 v13, 2, v55
    v_add_u32 v51, v12, v11
    v_bitop3_b32 v55, v5, v13, v14 bitop3:0xea
    ds_add_u32 v55, v2
    v_cvt_pk_bf16_f32 v47, v9, v10
    v_perm_b32 v12, v47, v47, s41
    v_bitop3_b32 v50, v4, v12, v50 bitop3:0xca
    v_perm_b32 v13, v47, v47, s42
    v_bitop3_b32 v51, v4, v13, v51 bitop3:0xca
    s_setprio 1
    s_add_u32 s46, s99, 0x1c00000
    v_lshlrev_b32 v88, 1, v1
    buffer_load_dwordx4 v[88:91], v88, s[8:11], s46 offen nt
    s_add_u32 s47, s99, 0x1c00000
    v_lshlrev_b32 v92, 1, v1
    buffer_load_dwordx4 v[92:95], v92, s[12:15], s47 offen nt
    s_waitcnt vmcnt(8)
    v_lshlrev_b32 v7, 16, v64
    v_and_b32 v8, 0xffff0000, v64
    v_lshlrev_b32 v9, 16, v65
    v_and_b32 v10, 0xffff0000, v65
    v_mul_f32 v7, 0.15915494, v7
    v_mul_f32 v8, 0.15915494, v8
    v_mul_f32 v9, 0.15915494, v9
    v_mul_f32 v10, 0.15915494, v10
    v_mul_hi_u32_u24 v14, 429497, v56
    v_lshrrev_b32 v12, 3, v60
    v_cos_f32 v7, v7
    v_lshlrev_b16 v13, 3, v60
    v_mad_i32_i24 v11, v14, s55, v56
    v_bitop3_b32 v12, v6, v13, v12 bitop3:0xca
    v_lshl_add_u32 v11, v11, 17, s40
    v_lshlrev_b16 v14, 8, v14
    v_lshrrev_b32 v13, 2, v60
    v_add_u32 v56, v12, v11
    v_bitop3_b32 v60, v5, v13, v14 bitop3:0xea
    ds_add_u32 v60, v2
    v_mul_hi_u32_u24 v14, 429497, v57
    v_lshrrev_b32 v12, 3, v61
    v_cos_f32 v8, v8
    v_lshlrev_b16 v13, 3, v61
    v_mad_i32_i24 v11, v14, s55, v57
    v_bitop3_b32 v12, v6, v13, v12 bitop3:0xca
    v_lshl_add_u32 v11, v11, 17, s40
    v_lshlrev_b16 v14, 8, v14
    v_lshrrev_b32 v13, 2, v61
    v_add_u32 v57, v12, v11
    v_bitop3_b32 v61, v5, v13, v14 bitop3:0xea
    ds_add_u32 v61, v2
    v_cvt_pk_bf16_f32 v64, v7, v8
    v_perm_b32 v12, v64, v64, s41
    v_bitop3_b32 v56, v4, v12, v56 bitop3:0xca
    v_perm_b32 v13, v64, v64, s42
    v_bitop3_b32 v57, v4, v13, v57 bitop3:0xca
    v_mul_hi_u32_u24 v14, 429497, v58
    v_lshrrev_b32 v12, 3, v62
    v_cos_f32 v9, v9
    v_lshlrev_b16 v13, 3, v62
    v_mad_i32_i24 v11, v14, s55, v58
    v_bitop3_b32 v12, v6, v13, v12 bitop3:0xca
    v_lshl_add_u32 v11, v11, 17, s40
    v_lshlrev_b16 v14, 8, v14
    v_lshrrev_b32 v13, 2, v62
    v_add_u32 v58, v12, v11
    v_bitop3_b32 v62, v5, v13, v14 bitop3:0xea
    ds_add_u32 v62, v2
    v_mul_hi_u32_u24 v14, 429497, v59
    v_lshrrev_b32 v12, 3, v63
    v_cos_f32 v10, v10
    v_lshlrev_b16 v13, 3, v63
    v_mad_i32_i24 v11, v14, s55, v59
    v_bitop3_b32 v12, v6, v13, v12 bitop3:0xca
    v_lshl_add_u32 v11, v11, 17, s40
    v_lshlrev_b16 v14, 8, v14
    v_lshrrev_b32 v13, 2, v63
    v_add_u32 v59, v12, v11
    v_bitop3_b32 v63, v5, v13, v14 bitop3:0xea
    ds_add_u32 v63, v2
    v_cvt_pk_bf16_f32 v65, v9, v10
    v_perm_b32 v12, v65, v65, s41
    v_bitop3_b32 v58, v4, v12, v58 bitop3:0xca
    v_perm_b32 v13, v65, v65, s42
    v_bitop3_b32 v59, v4, v13, v59 bitop3:0xca
    s_add_u32 s44, s96, 0x2000000
    v_lshlrev_b32 v96, 1, v1
    buffer_load_dwordx4 v[96:99], v96, s[8:11], s44 offen nt
    s_add_u32 s45, s96, 0x2000000
    v_lshlrev_b32 v104, 1, v1
    buffer_load_dwordx4 v[104:107], v104, s[12:15], s45 offen nt
    s_add_u32 s46, s96, 0x2000000
    s_lshr_b32 s46, s46, 1
    buffer_load_dwordx2 v[108:109], v1, s[16:19], s46 offen nt
    s_add_u32 s47, s97, 0x2400000
    s_lshr_b32 s47, s47, 1
    buffer_load_dwordx2 v[110:111], v1, s[16:19], s47 offen nt
    s_waitcnt vmcnt(10)
    v_lshlrev_b32 v7, 16, v66
    v_and_b32 v8, 0xffff0000, v66
    v_lshlrev_b32 v9, 16, v67
    v_and_b32 v10, 0xffff0000, v67
    v_mul_f32 v7, 0.15915494, v7
    v_mul_f32 v8, 0.15915494, v8
    v_mul_f32 v9, 0.15915494, v9
    v_mul_f32 v10, 0.15915494, v10
    v_mul_hi_u32_u24 v14, 429497, v68
    v_lshrrev_b32 v12, 3, v72
    v_cos_f32 v7, v7
    v_lshlrev_b16 v13, 3, v72
    v_mad_i32_i24 v11, v14, s55, v68
    v_bitop3_b32 v12, v6, v13, v12 bitop3:0xca
    v_lshl_add_u32 v11, v11, 17, s40
    v_lshlrev_b16 v14, 8, v14
    v_lshrrev_b32 v13, 2, v72
    v_add_u32 v68, v12, v11
    v_bitop3_b32 v72, v5, v13, v14 bitop3:0xea
    ds_add_u32 v72, v2
    v_mul_hi_u32_u24 v14, 429497, v69
    v_lshrrev_b32 v12, 3, v73
    v_cos_f32 v8, v8
    v_lshlrev_b16 v13, 3, v73
    v_mad_i32_i24 v11, v14, s55, v69
    v_bitop3_b32 v12, v6, v13, v12 bitop3:0xca
    v_lshl_add_u32 v11, v11, 17, s40
    v_lshlrev_b16 v14, 8, v14
    v_lshrrev_b32 v13, 2, v73
    v_add_u32 v69, v12, v11
    v_bitop3_b32 v73, v5, v13, v14 bitop3:0xea
    ds_add_u32 v73, v2
    v_cvt_pk_bf16_f32 v66, v7, v8
    v_perm_b32 v12, v66, v66, s41
    v_bitop3_b32 v68, v4, v12, v68 bitop3:0xca
    v_perm_b32 v13, v66, v66, s42
    v_bitop3_b32 v69, v4, v13, v69 bitop3:0xca
    v_mul_hi_u32_u24 v14, 429497, v70
    v_lshrrev_b32 v12, 3, v74
    v_cos_f32 v9, v9
    v_lshlrev_b16 v13, 3, v74
    v_mad_i32_i24 v11, v14, s55, v70
    v_bitop3_b32 v12, v6, v13, v12 bitop3:0xca
    v_lshl_add_u32 v11, v11, 17, s40
    v_lshlrev_b16 v14, 8, v14
    v_lshrrev_b32 v13, 2, v74
    v_add_u32 v70, v12, v11
    v_bitop3_b32 v74, v5, v13, v14 bitop3:0xea
    ds_add_u32 v74, v2
    v_mul_hi_u32_u24 v14, 429497, v71
    v_lshrrev_b32 v12, 3, v75
    v_cos_f32 v10, v10
    v_lshlrev_b16 v13, 3, v75
    v_mad_i32_i24 v11, v14, s55, v71
    v_bitop3_b32 v12, v6, v13, v12 bitop3:0xca
    v_lshl_add_u32 v11, v11, 17, s40
    v_lshlrev_b16 v14, 8, v14
    v_lshrrev_b32 v13, 2, v75
    v_add_u32 v71, v12, v11
    v_bitop3_b32 v75, v5, v13, v14 bitop3:0xea
    ds_add_u32 v75, v2
    v_cvt_pk_bf16_f32 v67, v9, v10
    v_perm_b32 v12, v67, v67, s41
    v_bitop3_b32 v70, v4, v12, v70 bitop3:0xca
    v_perm_b32 v13, v67, v67, s42
    v_bitop3_b32 v71, v4, v13, v71 bitop3:0xca
    s_setprio 0
    s_add_u32 s44, s97, 0x2400000
    v_lshlrev_b32 v100, 1, v1
    buffer_load_dwordx4 v[100:103], v100, s[8:11], s44 offen nt
    s_waitcnt vmcnt(7)
    v_lshlrev_b32 v7, 16, v84
    v_and_b32 v8, 0xffff0000, v84
    v_lshlrev_b32 v9, 16, v85
    v_and_b32 v10, 0xffff0000, v85
    v_mul_f32 v7, 0.15915494, v7
    v_mul_f32 v8, 0.15915494, v8
    v_mul_f32 v9, 0.15915494, v9
    v_mul_f32 v10, 0.15915494, v10
    v_mul_hi_u32_u24 v14, 429497, v76
    v_lshrrev_b32 v12, 3, v80
    v_cos_f32 v7, v7
    v_lshlrev_b16 v13, 3, v80
    v_mad_i32_i24 v11, v14, s55, v76
    v_bitop3_b32 v12, v6, v13, v12 bitop3:0xca
    v_lshl_add_u32 v11, v11, 17, s40
    v_lshlrev_b16 v14, 8, v14
    v_lshrrev_b32 v13, 2, v80
    v_add_u32 v76, v12, v11
    v_bitop3_b32 v80, v5, v13, v14 bitop3:0xea
    ds_add_u32 v80, v2
    v_mul_hi_u32_u24 v14, 429497, v77
    v_lshrrev_b32 v12, 3, v81
    v_cos_f32 v8, v8
    v_lshlrev_b16 v13, 3, v81
    v_mad_i32_i24 v11, v14, s55, v77
    v_bitop3_b32 v12, v6, v13, v12 bitop3:0xca
    v_lshl_add_u32 v11, v11, 17, s40
    v_lshlrev_b16 v14, 8, v14
    v_lshrrev_b32 v13, 2, v81
    v_add_u32 v77, v12, v11
    v_bitop3_b32 v81, v5, v13, v14 bitop3:0xea
    ds_add_u32 v81, v2
    v_cvt_pk_bf16_f32 v84, v7, v8
    v_perm_b32 v12, v84, v84, s41
    v_bitop3_b32 v76, v4, v12, v76 bitop3:0xca
    v_perm_b32 v13, v84, v84, s42
    v_bitop3_b32 v77, v4, v13, v77 bitop3:0xca
    v_mul_hi_u32_u24 v14, 429497, v78
    v_lshrrev_b32 v12, 3, v82
    v_cos_f32 v9, v9
    v_lshlrev_b16 v13, 3, v82
    v_mad_i32_i24 v11, v14, s55, v78
    v_bitop3_b32 v12, v6, v13, v12 bitop3:0xca
    v_lshl_add_u32 v11, v11, 17, s40
    v_lshlrev_b16 v14, 8, v14
    v_lshrrev_b32 v13, 2, v82
    v_add_u32 v78, v12, v11
    v_bitop3_b32 v82, v5, v13, v14 bitop3:0xea
    ds_add_u32 v82, v2
    v_mul_hi_u32_u24 v14, 429497, v79
    v_lshrrev_b32 v12, 3, v83
    v_cos_f32 v10, v10
    v_lshlrev_b16 v13, 3, v83
    v_mad_i32_i24 v11, v14, s55, v79
    v_bitop3_b32 v12, v6, v13, v12 bitop3:0xca
    v_lshl_add_u32 v11, v11, 17, s40
    v_lshlrev_b16 v14, 8, v14
    v_lshrrev_b32 v13, 2, v83
    v_add_u32 v79, v12, v11
    v_bitop3_b32 v83, v5, v13, v14 bitop3:0xea
    ds_add_u32 v83, v2
    v_cvt_pk_bf16_f32 v85, v9, v10
    v_perm_b32 v12, v85, v85, s41
    v_bitop3_b32 v78, v4, v12, v78 bitop3:0xca
    v_perm_b32 v13, v85, v85, s42
    v_bitop3_b32 v79, v4, v13, v79 bitop3:0xca
    s_waitcnt vmcnt(5)
    v_lshlrev_b32 v7, 16, v86
    v_and_b32 v8, 0xffff0000, v86
    v_lshlrev_b32 v9, 16, v87
    v_and_b32 v10, 0xffff0000, v87
    v_mul_f32 v7, 0.15915494, v7
    v_mul_f32 v8, 0.15915494, v8
    v_mul_f32 v9, 0.15915494, v9
    v_mul_f32 v10, 0.15915494, v10
    v_mul_hi_u32_u24 v14, 429497, v88
    v_lshrrev_b32 v12, 3, v92
    v_cos_f32 v7, v7
    v_lshlrev_b16 v13, 3, v92
    v_mad_i32_i24 v11, v14, s55, v88
    v_bitop3_b32 v12, v6, v13, v12 bitop3:0xca
    v_lshl_add_u32 v11, v11, 17, s40
    v_lshlrev_b16 v14, 8, v14
    v_lshrrev_b32 v13, 2, v92
    v_add_u32 v88, v12, v11
    v_bitop3_b32 v92, v5, v13, v14 bitop3:0xea
    ds_add_u32 v92, v2
    v_mul_hi_u32_u24 v14, 429497, v89
    v_lshrrev_b32 v12, 3, v93
    v_cos_f32 v8, v8
    v_lshlrev_b16 v13, 3, v93
    v_mad_i32_i24 v11, v14, s55, v89
    v_bitop3_b32 v12, v6, v13, v12 bitop3:0xca
    v_lshl_add_u32 v11, v11, 17, s40
    v_lshlrev_b16 v14, 8, v14
    v_lshrrev_b32 v13, 2, v93
    v_add_u32 v89, v12, v11
    v_bitop3_b32 v93, v5, v13, v14 bitop3:0xea
    ds_add_u32 v93, v2
    v_cvt_pk_bf16_f32 v86, v7, v8
    v_perm_b32 v12, v86, v86, s41
    v_bitop3_b32 v88, v4, v12, v88 bitop3:0xca
    v_perm_b32 v13, v86, v86, s42
    v_bitop3_b32 v89, v4, v13, v89 bitop3:0xca
    v_mul_hi_u32_u24 v14, 429497, v90
    v_lshrrev_b32 v12, 3, v94
    v_cos_f32 v9, v9
    v_lshlrev_b16 v13, 3, v94
    v_mad_i32_i24 v11, v14, s55, v90
    v_bitop3_b32 v12, v6, v13, v12 bitop3:0xca
    v_lshl_add_u32 v11, v11, 17, s40
    v_lshlrev_b16 v14, 8, v14
    v_lshrrev_b32 v13, 2, v94
    v_add_u32 v90, v12, v11
    v_bitop3_b32 v94, v5, v13, v14 bitop3:0xea
    ds_add_u32 v94, v2
    v_mul_hi_u32_u24 v14, 429497, v91
    v_lshrrev_b32 v12, 3, v95
    v_cos_f32 v10, v10
    v_lshlrev_b16 v13, 3, v95
    v_mad_i32_i24 v11, v14, s55, v91
    v_bitop3_b32 v12, v6, v13, v12 bitop3:0xca
    v_lshl_add_u32 v11, v11, 17, s40
    v_lshlrev_b16 v14, 8, v14
    v_lshrrev_b32 v13, 2, v95
    v_add_u32 v91, v12, v11
    v_bitop3_b32 v95, v5, v13, v14 bitop3:0xea
    ds_add_u32 v95, v2
    v_cvt_pk_bf16_f32 v87, v9, v10
    v_perm_b32 v12, v87, v87, s41
    v_bitop3_b32 v90, v4, v12, v90 bitop3:0xca
    v_perm_b32 v13, v87, v87, s42
    v_bitop3_b32 v91, v4, v13, v91 bitop3:0xca
    v_lshrrev_b32 v8, 2, v0
    v_and_b32 v7, 0x3c00, v0
    v_bitop3_b32 v7, v5, v8, v7 bitop3:0xea
    s_waitcnt lgkmcnt(0)
    s_barrier
    ds_read2st64_b32 v[8:9], v7 offset0:0 offset1:1
    ds_read2st64_b32 v[10:11], v7 offset0:2 offset1:3
    s_add_u32 s45, s97, 0x2400000
    v_lshlrev_b32 v112, 1, v1
    buffer_load_dwordx4 v[112:115], v112, s[12:15], s45 offen nt
    s_waitcnt lgkmcnt(0)
    v_lshl_or_b32 v12, v9, 16, v8
    v_lshl_or_b32 v13, v11, 16, v10
    v_mov_b32 v14, v12
    v_mov_b32 v15, v13
    s_nop 0
    v_add_u32_dpp v14, v14, v14 row_shr:1 row_mask:0xf bank_mask:0xf bound_ctrl:1
    v_add_u32_dpp v15, v15, v15 row_shr:1 row_mask:0xf bank_mask:0xf bound_ctrl:1
    s_nop 0
    v_add_u32_dpp v14, v14, v14 row_shr:2 row_mask:0xf bank_mask:0xf bound_ctrl:1
    v_add_u32_dpp v15, v15, v15 row_shr:2 row_mask:0xf bank_mask:0xf bound_ctrl:1
    s_nop 0
    v_add_u32_dpp v14, v14, v14 row_shr:4 row_mask:0xf bank_mask:0xf bound_ctrl:1
    v_add_u32_dpp v15, v15, v15 row_shr:4 row_mask:0xf bank_mask:0xf bound_ctrl:1
    s_nop 0
    v_add_u32_dpp v14, v14, v14 row_shr:8 row_mask:0xf bank_mask:0xf bound_ctrl:1
    v_add_u32_dpp v15, v15, v15 row_shr:8 row_mask:0xf bank_mask:0xf bound_ctrl:1
    s_nop 0
    v_add_u32_dpp v14, v14, v14 row_bcast:15 row_mask:0xa bank_mask:0xf
    v_add_u32_dpp v15, v15, v15 row_bcast:15 row_mask:0xa bank_mask:0xf
    s_nop 0
    v_add_u32_dpp v14, v14, v14 row_bcast:31 row_mask:0xc bank_mask:0xf
    v_add_u32_dpp v15, v15, v15 row_bcast:31 row_mask:0xc bank_mask:0xf
    v_readlane_b32 s48, v14, 63
    v_readlane_b32 s49, v15, 63
    s_lshl_b32 s54, s32, 2
    v_mov_b32 v8, s54
    s_and_b32 s50, s48, 0xffff
    s_lshr_b32 s51, s48, 16
    s_and_b32 s52, s49, 0xffff
    s_lshr_b32 s53, s49, 16
    s_add_u32 s51, s51, s50
    s_add_u32 s52, s52, s51
    s_add_u32 s53, s53, s52
    v_mov_b32 v9, s53
    s_mov_b64 exec, 1
    ds_write_b32 v8, v9 offset:16384
    s_mov_b64 exec, -1
    v_and_b32 v8, 60, v7
    s_waitcnt lgkmcnt(0)
    s_barrier
    ds_read_b32 v9, v8 offset:16384
    s_waitcnt lgkmcnt(0)
    v_add_u32_dpp v9, v9, v9 row_shr:1 row_mask:0xf bank_mask:0xf bound_ctrl:1
    s_nop 1
    v_add_u32_dpp v9, v9, v9 row_shr:2 row_mask:0xf bank_mask:0xf bound_ctrl:1
    s_nop 1
    v_add_u32_dpp v9, v9, v9 row_shr:4 row_mask:0xf bank_mask:0xf bound_ctrl:1
    s_nop 1
    v_add_u32_dpp v9, v9, v9 row_shr:8 row_mask:0xf bank_mask:0xf bound_ctrl:1
    s_nop 0
    v_readlane_b32 s54, v9, s32
    s_sub_u32 s54, s54, s53
    s_add_u32 s50, s50, s54
    s_add_u32 s51, s51, s54
    s_add_u32 s52, s52, s54
    s_pack_ll_b32_b16 s48, s54, s50
    s_pack_ll_b32_b16 s49, s51, s52
    v_add_u32 v14, s48, v14
    v_add_u32 v15, s49, v15
    v_sub_u32 v12, v14, v12
    v_sub_u32 v13, v15, v13
    v_and_b32 v8, 0xffff, v12
    v_lshrrev_b32 v9, 16, v12
    v_and_b32 v10, 0xffff, v13
    v_lshrrev_b32 v11, 16, v13
    ds_write2st64_b32 v7, v8, v9 offset0:0 offset1:1
    ds_write2st64_b32 v7, v10, v11 offset0:2 offset1:3
    v_and_b32 v8, 0x3f0, v0
    v_lshl_add_u32 v8, v8, 1, s36
    ds_write_b64 v8, v[12:13] offset:20480
    s_bitset0_b64 exec, 63
    s_not_b64 exec, exec
    ds_write_b64 v8, v[14:15] offset:20512
    s_mov_b64 exec, -1
    s_waitcnt lgkmcnt(0)
    s_barrier
    s_setprio 3
    ds_add_rtn_u32 v20, v20, v2
    ds_add_rtn_u32 v21, v21, v2
    ds_add_rtn_u32 v22, v22, v2
    ds_add_rtn_u32 v23, v23, v2
    ds_read_b128 v[12:15], v0 offset:20480
    v_cmp_gt_u32 vcc, 8448, v0
    ds_add_rtn_u32 v32, v32, v2
    ds_add_rtn_u32 v33, v33, v2
    ds_add_rtn_u32 v34, v34, v2
    ds_add_rtn_u32 v35, v35, v2
    s_setprio 2
    ds_add_rtn_u32 v40, v40, v2
    ds_add_rtn_u32 v41, v41, v2
    ds_add_rtn_u32 v42, v42, v2
    ds_add_rtn_u32 v43, v43, v2
    s_waitcnt lgkmcnt(8)
    s_cbranch_vccz L1_p1
    s_add_u32 s46, s35, 0x0
    s_mov_b64 exec, vcc
    buffer_store_dwordx4 v[12:15], v0, s[24:27], s46 offen sc1
    s_mov_b64 exec, -1
L1_p1:
    s_add_u32 s47, s98, 0x2800000
    v_lshlrev_b32 v116, 1, v1
    buffer_load_dwordx4 v[116:119], v116, s[8:11], s47 offen nt
    ds_add_rtn_u32 v52, v52, v2
    ds_add_rtn_u32 v53, v53, v2
    ds_add_rtn_u32 v54, v54, v2
    ds_add_rtn_u32 v55, v55, v2
    s_setprio 1
    ds_add_rtn_u32 v60, v60, v2
    ds_add_rtn_u32 v61, v61, v2
    ds_add_rtn_u32 v62, v62, v2
    ds_add_rtn_u32 v63, v63, v2
    ds_add_rtn_u32 v72, v72, v2
    ds_add_rtn_u32 v73, v73, v2
    ds_add_rtn_u32 v74, v74, v2
    ds_add_rtn_u32 v75, v75, v2
    s_add_u32 s44, s98, 0x2800000
    v_lshlrev_b32 v120, 1, v1
    buffer_load_dwordx4 v[120:123], v120, s[12:15], s44 offen nt
    s_setprio 0
    ds_add_rtn_u32 v80, v80, v2
    ds_add_rtn_u32 v81, v81, v2
    ds_add_rtn_u32 v82, v82, v2
    ds_add_rtn_u32 v83, v83, v2
    ds_add_rtn_u32 v92, v92, v2
    ds_add_rtn_u32 v93, v93, v2
    ds_add_rtn_u32 v94, v94, v2
    ds_add_rtn_u32 v95, v95, v2
    s_waitcnt lgkmcnt(0)
    s_barrier
    s_setprio 3
    v_and_b32 v7, -4, v20
    v_lshl_add_u32 v8, v20, 2, v7
    ds_write_b32 v8, v16
    v_lshl_add_u32 v7, v7, 2, v20
    ds_write_b8 v7, v24 offset:16
    v_and_b32 v9, -4, v21
    v_lshl_add_u32 v10, v21, 2, v9
    ds_write_b32 v10, v17
    v_lshl_add_u32 v9, v9, 2, v21
    ds_write_b8_d16_hi v9, v24 offset:16
    v_and_b32 v7, -4, v22
    v_lshl_add_u32 v8, v22, 2, v7
    ds_write_b32 v8, v18
    v_lshl_add_u32 v7, v7, 2, v22
    ds_write_b8 v7, v25 offset:16
    v_and_b32 v9, -4, v23
    v_lshl_add_u32 v10, v23, 2, v9
    ds_write_b32 v10, v19
    v_lshl_add_u32 v9, v9, 2, v23
    ds_write_b8_d16_hi v9, v25 offset:16
    s_add_u32 s45, s98, 0x2800000
    s_lshr_b32 s45, s45, 1
    buffer_load_dwordx2 v[124:125], v1, s[16:19], s45 offen nt
    s_add_u32 s46, s99, 0x2c00000
    s_lshr_b32 s46, s46, 1
    buffer_load_dwordx2 v[126:127], v1, s[16:19], s46 offen nt
    s_add_u32 s47, s99, 0x2c00000
    v_lshlrev_b32 v16, 1, v1
    buffer_load_dwordx4 v[16:19], v16, s[8:11], s47 offen nt
    v_and_b32 v7, -4, v32
    v_lshl_add_u32 v8, v32, 2, v7
    ds_write_b32 v8, v28
    v_lshl_add_u32 v7, v7, 2, v32
    ds_write_b8 v7, v26 offset:16
    v_and_b32 v9, -4, v33
    v_lshl_add_u32 v10, v33, 2, v9
    ds_write_b32 v10, v29
    v_lshl_add_u32 v9, v9, 2, v33
    ds_write_b8_d16_hi v9, v26 offset:16
    v_and_b32 v7, -4, v34
    v_lshl_add_u32 v8, v34, 2, v7
    ds_write_b32 v8, v30
    v_lshl_add_u32 v7, v7, 2, v34
    ds_write_b8 v7, v27 offset:16
    v_and_b32 v9, -4, v35
    v_lshl_add_u32 v10, v35, 2, v9
    ds_write_b32 v10, v31
    v_lshl_add_u32 v9, v9, 2, v35
    ds_write_b8_d16_hi v9, v27 offset:16
    s_add_u32 s44, s99, 0x2c00000
    v_lshlrev_b32 v20, 1, v1
    buffer_load_dwordx4 v[20:23], v20, s[12:15], s44 offen nt
    s_setprio 2
    v_and_b32 v7, -4, v40
    v_lshl_add_u32 v8, v40, 2, v7
    ds_write_b32 v8, v36
    v_lshl_add_u32 v7, v7, 2, v40
    ds_write_b8 v7, v44 offset:16
    v_and_b32 v9, -4, v41
    v_lshl_add_u32 v10, v41, 2, v9
    ds_write_b32 v10, v37
    v_lshl_add_u32 v9, v9, 2, v41
    ds_write_b8_d16_hi v9, v44 offset:16
    v_and_b32 v7, -4, v42
    v_lshl_add_u32 v8, v42, 2, v7
    ds_write_b32 v8, v38
    v_lshl_add_u32 v7, v7, 2, v42
    ds_write_b8 v7, v45 offset:16
    v_and_b32 v9, -4, v43
    v_lshl_add_u32 v10, v43, 2, v9
    ds_write_b32 v10, v39
    v_lshl_add_u32 v9, v9, 2, v43
    ds_write_b8_d16_hi v9, v45 offset:16
    s_add_u32 s45, s96, 0x3000000
    v_lshlrev_b32 v28, 1, v1
    buffer_load_dwordx4 v[28:31], v28, s[8:11], s45 offen nt
    s_add_u32 s46, s96, 0x3000000
    v_lshlrev_b32 v32, 1, v1
    buffer_load_dwordx4 v[32:35], v32, s[12:15], s46 offen nt
    v_and_b32 v7, -4, v52
    v_lshl_add_u32 v8, v52, 2, v7
    ds_write_b32 v8, v48
    v_lshl_add_u32 v7, v7, 2, v52
    ds_write_b8 v7, v46 offset:16
    v_and_b32 v9, -4, v53
    v_lshl_add_u32 v10, v53, 2, v9
    ds_write_b32 v10, v49
    v_lshl_add_u32 v9, v9, 2, v53
    ds_write_b8_d16_hi v9, v46 offset:16
    v_and_b32 v7, -4, v54
    v_lshl_add_u32 v8, v54, 2, v7
    ds_write_b32 v8, v50
    v_lshl_add_u32 v7, v7, 2, v54
    ds_write_b8 v7, v47 offset:16
    v_and_b32 v9, -4, v55
    v_lshl_add_u32 v10, v55, 2, v9
    ds_write_b32 v10, v51
    v_lshl_add_u32 v9, v9, 2, v55
    ds_write_b8_d16_hi v9, v47 offset:16
    s_add_u32 s47, s96, 0x3000000
    s_lshr_b32 s47, s47, 1
    buffer_load_dwordx2 v[24:25], v1, s[16:19], s47 offen nt
    s_add_u32 s44, s97, 0x3400000
    s_lshr_b32 s44, s44, 1
    buffer_load_dwordx2 v[26:27], v1, s[16:19], s44 offen nt
    s_setprio 1
    v_and_b32 v7, -4, v60
    v_lshl_add_u32 v8, v60, 2, v7
    ds_write_b32 v8, v56
    v_lshl_add_u32 v7, v7, 2, v60
    ds_write_b8 v7, v64 offset:16
    v_and_b32 v9, -4, v61
    v_lshl_add_u32 v10, v61, 2, v9
    ds_write_b32 v10, v57
    v_lshl_add_u32 v9, v9, 2, v61
    ds_write_b8_d16_hi v9, v64 offset:16
    v_and_b32 v7, -4, v62
    v_lshl_add_u32 v8, v62, 2, v7
    ds_write_b32 v8, v58
    v_lshl_add_u32 v7, v7, 2, v62
    ds_write_b8 v7, v65 offset:16
    v_and_b32 v9, -4, v63
    v_lshl_add_u32 v10, v63, 2, v9
    ds_write_b32 v10, v59
    v_lshl_add_u32 v9, v9, 2, v63
    ds_write_b8_d16_hi v9, v65 offset:16
    s_add_u32 s45, s97, 0x3400000
    v_lshlrev_b32 v36, 1, v1
    buffer_load_dwordx4 v[36:39], v36, s[8:11], s45 offen nt
    v_and_b32 v7, -4, v72
    v_lshl_add_u32 v8, v72, 2, v7
    ds_write_b32 v8, v68
    v_lshl_add_u32 v7, v7, 2, v72
    ds_write_b8 v7, v66 offset:16
    v_and_b32 v9, -4, v73
    v_lshl_add_u32 v10, v73, 2, v9
    ds_write_b32 v10, v69
    v_lshl_add_u32 v9, v9, 2, v73
    ds_write_b8_d16_hi v9, v66 offset:16
    v_and_b32 v7, -4, v74
    v_lshl_add_u32 v8, v74, 2, v7
    ds_write_b32 v8, v70
    v_lshl_add_u32 v7, v7, 2, v74
    ds_write_b8 v7, v67 offset:16
    v_and_b32 v9, -4, v75
    v_lshl_add_u32 v10, v75, 2, v9
    ds_write_b32 v10, v71
    v_lshl_add_u32 v9, v9, 2, v75
    ds_write_b8_d16_hi v9, v67 offset:16
    s_add_u32 s46, s97, 0x3400000
    v_lshlrev_b32 v40, 1, v1
    buffer_load_dwordx4 v[40:43], v40, s[12:15], s46 offen nt
    s_add_u32 s47, s98, 0x3800000
    v_lshlrev_b32 v48, 1, v1
    buffer_load_dwordx4 v[48:51], v48, s[8:11], s47 offen nt
    s_setprio 0
    v_and_b32 v7, -4, v80
    v_lshl_add_u32 v8, v80, 2, v7
    ds_write_b32 v8, v76
    v_lshl_add_u32 v7, v7, 2, v80
    ds_write_b8 v7, v84 offset:16
    v_and_b32 v9, -4, v81
    v_lshl_add_u32 v10, v81, 2, v9
    ds_write_b32 v10, v77
    v_lshl_add_u32 v9, v9, 2, v81
    ds_write_b8_d16_hi v9, v84 offset:16
    v_and_b32 v7, -4, v82
    v_lshl_add_u32 v8, v82, 2, v7
    ds_write_b32 v8, v78
    v_lshl_add_u32 v7, v7, 2, v82
    ds_write_b8 v7, v85 offset:16
    v_and_b32 v9, -4, v83
    v_lshl_add_u32 v10, v83, 2, v9
    ds_write_b32 v10, v79
    v_lshl_add_u32 v9, v9, 2, v83
    ds_write_b8_d16_hi v9, v85 offset:16
    s_add_u32 s44, s98, 0x3800000
    v_lshlrev_b32 v52, 1, v1
    buffer_load_dwordx4 v[52:55], v52, s[12:15], s44 offen nt
    v_and_b32 v7, -4, v92
    v_lshl_add_u32 v8, v92, 2, v7
    ds_write_b32 v8, v88
    v_lshl_add_u32 v7, v7, 2, v92
    ds_write_b8 v7, v86 offset:16
    v_and_b32 v9, -4, v93
    v_lshl_add_u32 v10, v93, 2, v9
    ds_write_b32 v10, v89
    v_lshl_add_u32 v9, v9, 2, v93
    ds_write_b8_d16_hi v9, v86 offset:16
    v_and_b32 v7, -4, v94
    v_lshl_add_u32 v8, v94, 2, v7
    ds_write_b32 v8, v90
    v_lshl_add_u32 v7, v7, 2, v94
    ds_write_b8 v7, v87 offset:16
    v_and_b32 v9, -4, v95
    v_lshl_add_u32 v10, v95, 2, v9
    ds_write_b32 v10, v91
    v_lshl_add_u32 v9, v9, 2, v95
    ds_write_b8_d16_hi v9, v87 offset:16
    s_add_u32 s45, s98, 0x3800000
    s_lshr_b32 s45, s45, 1
    buffer_load_dwordx2 v[44:45], v1, s[16:19], s45 offen nt
    s_add_u32 s46, s99, 0x3c00000
    s_lshr_b32 s46, s46, 1
    buffer_load_dwordx2 v[46:47], v1, s[16:19], s46 offen nt
    v_add_u32 v7, s72, v0
    v_add_u32 v12, s73, v0
    v_add_u32 v13, s85, v0
    v_add_u32 v14, s91, v0
    v_add_u32 v15, s93, v0
    s_min_i32 s3, s72, s73
    s_min_i32 s3, s3, s85
    s_min_i32 s3, s3, s91
    s_min_i32 s3, s3, s93
    v_add_u32 v3, s3, v0
    v_mov_b32 v8, 0
    v_mov_b32 v9, 0
    v_mov_b32 v10, 0
    v_mov_b32 v11, 0
    s_waitcnt lgkmcnt(0)
    s_barrier
    ds_read_b128 v[56:59], v7 offset:0
    ds_read_b128 v[60:63], v12 offset:0
    ds_read_b128 v[68:71], v13 offset:0
    ds_read_b128 v[72:75], v14 offset:0
    ds_read_b128 v[64:67], v15 offset:0
    ds_write_b128 v3, v[8:11]
    ds_read_b128 v[76:79], v7 offset:16384
    ds_read_b128 v[80:83], v12 offset:16384
    ds_read_b128 v[88:91], v13 offset:16384
    ds_read_b128 v[92:95], v14 offset:16384
    ds_read_b128 v[84:87], v15 offset:16384
    s_waitcnt lgkmcnt(0)
    s_barrier
    s_setprio 3
    s_add_u32 s47, s35, 0x4000
    s_add_u32 s47, s47, s72
    buffer_store_dwordx4 v[56:59], v0, s[20:23], s47 offen sc1
    s_add_u32 s44, s99, 0x3c00000
    s_nop 0
    v_lshlrev_b32 v56, 1, v1
    buffer_load_dwordx4 v[56:59], v56, s[8:11], s44 offen nt
    s_add_u32 s45, s35, 0x4000
    s_add_u32 s45, s45, s73
    buffer_store_dwordx4 v[60:63], v0, s[20:23], s45 offen sc1
    s_add_u32 s46, s99, 0x3c00000
    s_nop 0
    v_lshlrev_b32 v60, 1, v1
    buffer_load_dwordx4 v[60:63], v60, s[12:15], s46 offen nt
    s_waitcnt vmcnt(22)
    v_lshlrev_b32 v7, 16, v108
    v_and_b32 v8, 0xffff0000, v108
    v_lshlrev_b32 v9, 16, v109
    v_and_b32 v10, 0xffff0000, v109
    v_mul_f32 v7, 0.15915494, v7
    v_mul_f32 v8, 0.15915494, v8
    v_mul_f32 v9, 0.15915494, v9
    v_mul_f32 v10, 0.15915494, v10
    v_mul_hi_u32_u24 v14, 429497, v96
    v_lshrrev_b32 v12, 3, v104
    v_cos_f32 v7, v7
    v_lshlrev_b16 v13, 3, v104
    v_mad_i32_i24 v11, v14, s55, v96
    v_bitop3_b32 v12, v6, v13, v12 bitop3:0xca
    v_lshl_add_u32 v11, v11, 17, s40
    v_lshlrev_b16 v14, 8, v14
    v_lshrrev_b32 v13, 2, v104
    v_add_u32 v96, v12, v11
    v_bitop3_b32 v104, v5, v13, v14 bitop3:0xea
    ds_add_u32 v104, v2
    v_mul_hi_u32_u24 v14, 429497, v97
    v_lshrrev_b32 v12, 3, v105
    v_cos_f32 v8, v8
    v_lshlrev_b16 v13, 3, v105
    v_mad_i32_i24 v11, v14, s55, v97
    v_bitop3_b32 v12, v6, v13, v12 bitop3:0xca
    v_lshl_add_u32 v11, v11, 17, s40
    v_lshlrev_b16 v14, 8, v14
    v_lshrrev_b32 v13, 2, v105
    v_add_u32 v97, v12, v11
    v_bitop3_b32 v105, v5, v13, v14 bitop3:0xea
    ds_add_u32 v105, v2
    v_cvt_pk_bf16_f32 v108, v7, v8
    v_perm_b32 v12, v108, v108, s41
    v_bitop3_b32 v96, v4, v12, v96 bitop3:0xca
    v_perm_b32 v13, v108, v108, s42
    v_bitop3_b32 v97, v4, v13, v97 bitop3:0xca
    v_mul_hi_u32_u24 v14, 429497, v98
    v_lshrrev_b32 v12, 3, v106
    v_cos_f32 v9, v9
    v_lshlrev_b16 v13, 3, v106
    v_mad_i32_i24 v11, v14, s55, v98
    v_bitop3_b32 v12, v6, v13, v12 bitop3:0xca
    v_lshl_add_u32 v11, v11, 17, s40
    v_lshlrev_b16 v14, 8, v14
    v_lshrrev_b32 v13, 2, v106
    v_add_u32 v98, v12, v11
    v_bitop3_b32 v106, v5, v13, v14 bitop3:0xea
    ds_add_u32 v106, v2
    v_mul_hi_u32_u24 v14, 429497, v99
    v_lshrrev_b32 v12, 3, v107
    v_cos_f32 v10, v10
    v_lshlrev_b16 v13, 3, v107
    v_mad_i32_i24 v11, v14, s55, v99
    v_bitop3_b32 v12, v6, v13, v12 bitop3:0xca
    v_lshl_add_u32 v11, v11, 17, s40
    v_lshlrev_b16 v14, 8, v14
    v_lshrrev_b32 v13, 2, v107
    v_add_u32 v99, v12, v11
    v_bitop3_b32 v107, v5, v13, v14 bitop3:0xea
    ds_add_u32 v107, v2
    v_cvt_pk_bf16_f32 v109, v9, v10
    v_perm_b32 v12, v109, v109, s41
    v_bitop3_b32 v98, v4, v12, v98 bitop3:0xca
    v_perm_b32 v13, v109, v109, s42
    v_bitop3_b32 v99, v4, v13, v99 bitop3:0xca
    s_waitcnt vmcnt(20)
    v_lshlrev_b32 v7, 16, v110
    v_and_b32 v8, 0xffff0000, v110
    v_lshlrev_b32 v9, 16, v111
    v_and_b32 v10, 0xffff0000, v111
    v_mul_f32 v7, 0.15915494, v7
    v_mul_f32 v8, 0.15915494, v8
    v_mul_f32 v9, 0.15915494, v9
    v_mul_f32 v10, 0.15915494, v10
    v_mul_hi_u32_u24 v14, 429497, v100
    v_lshrrev_b32 v12, 3, v112
    v_cos_f32 v7, v7
    v_lshlrev_b16 v13, 3, v112
    v_mad_i32_i24 v11, v14, s55, v100
    v_bitop3_b32 v12, v6, v13, v12 bitop3:0xca
    v_lshl_add_u32 v11, v11, 17, s40
    v_lshlrev_b16 v14, 8, v14
    v_lshrrev_b32 v13, 2, v112
    v_add_u32 v100, v12, v11
    v_bitop3_b32 v112, v5, v13, v14 bitop3:0xea
    ds_add_u32 v112, v2
    v_mul_hi_u32_u24 v14, 429497, v101
    v_lshrrev_b32 v12, 3, v113
    v_cos_f32 v8, v8
    v_lshlrev_b16 v13, 3, v113
    v_mad_i32_i24 v11, v14, s55, v101
    v_bitop3_b32 v12, v6, v13, v12 bitop3:0xca
    v_lshl_add_u32 v11, v11, 17, s40
    v_lshlrev_b16 v14, 8, v14
    v_lshrrev_b32 v13, 2, v113
    v_add_u32 v101, v12, v11
    v_bitop3_b32 v113, v5, v13, v14 bitop3:0xea
    ds_add_u32 v113, v2
    v_cvt_pk_bf16_f32 v110, v7, v8
    v_perm_b32 v12, v110, v110, s41
    v_bitop3_b32 v100, v4, v12, v100 bitop3:0xca
    v_perm_b32 v13, v110, v110, s42
    v_bitop3_b32 v101, v4, v13, v101 bitop3:0xca
    v_mul_hi_u32_u24 v14, 429497, v102
    v_lshrrev_b32 v12, 3, v114
    v_cos_f32 v9, v9
    v_lshlrev_b16 v13, 3, v114
    v_mad_i32_i24 v11, v14, s55, v102
    v_bitop3_b32 v12, v6, v13, v12 bitop3:0xca
    v_lshl_add_u32 v11, v11, 17, s40
    v_lshlrev_b16 v14, 8, v14
    v_lshrrev_b32 v13, 2, v114
    v_add_u32 v102, v12, v11
    v_bitop3_b32 v114, v5, v13, v14 bitop3:0xea
    ds_add_u32 v114, v2
    v_mul_hi_u32_u24 v14, 429497, v103
    v_lshrrev_b32 v12, 3, v115
    v_cos_f32 v10, v10
    v_lshlrev_b16 v13, 3, v115
    v_mad_i32_i24 v11, v14, s55, v103
    v_bitop3_b32 v12, v6, v13, v12 bitop3:0xca
    v_lshl_add_u32 v11, v11, 17, s40
    v_lshlrev_b16 v14, 8, v14
    v_lshrrev_b32 v13, 2, v115
    v_add_u32 v103, v12, v11
    v_bitop3_b32 v115, v5, v13, v14 bitop3:0xea
    ds_add_u32 v115, v2
    v_cvt_pk_bf16_f32 v111, v9, v10
    v_perm_b32 v12, v111, v111, s41
    v_bitop3_b32 v102, v4, v12, v102 bitop3:0xca
    v_perm_b32 v13, v111, v111, s42
    v_bitop3_b32 v103, v4, v13, v103 bitop3:0xca
    s_setprio 2
    s_waitcnt vmcnt(16)
    v_lshlrev_b32 v7, 16, v124
    v_and_b32 v8, 0xffff0000, v124
    v_lshlrev_b32 v9, 16, v125
    v_and_b32 v10, 0xffff0000, v125
    v_mul_f32 v7, 0.15915494, v7
    v_mul_f32 v8, 0.15915494, v8
    v_mul_f32 v9, 0.15915494, v9
    v_mul_f32 v10, 0.15915494, v10
    v_mul_hi_u32_u24 v14, 429497, v116
    v_lshrrev_b32 v12, 3, v120
    v_cos_f32 v7, v7
    v_lshlrev_b16 v13, 3, v120
    v_mad_i32_i24 v11, v14, s55, v116
    v_bitop3_b32 v12, v6, v13, v12 bitop3:0xca
    v_lshl_add_u32 v11, v11, 17, s40
    v_lshlrev_b16 v14, 8, v14
    v_lshrrev_b32 v13, 2, v120
    v_add_u32 v116, v12, v11
    v_bitop3_b32 v120, v5, v13, v14 bitop3:0xea
    ds_add_u32 v120, v2
    v_mul_hi_u32_u24 v14, 429497, v117
    v_lshrrev_b32 v12, 3, v121
    v_cos_f32 v8, v8
    v_lshlrev_b16 v13, 3, v121
    v_mad_i32_i24 v11, v14, s55, v117
    v_bitop3_b32 v12, v6, v13, v12 bitop3:0xca
    v_lshl_add_u32 v11, v11, 17, s40
    v_lshlrev_b16 v14, 8, v14
    v_lshrrev_b32 v13, 2, v121
    v_add_u32 v117, v12, v11
    v_bitop3_b32 v121, v5, v13, v14 bitop3:0xea
    ds_add_u32 v121, v2
    v_cvt_pk_bf16_f32 v124, v7, v8
    v_perm_b32 v12, v124, v124, s41
    v_bitop3_b32 v116, v4, v12, v116 bitop3:0xca
    v_perm_b32 v13, v124, v124, s42
    v_bitop3_b32 v117, v4, v13, v117 bitop3:0xca
    v_mul_hi_u32_u24 v14, 429497, v118
    v_lshrrev_b32 v12, 3, v122
    v_cos_f32 v9, v9
    v_lshlrev_b16 v13, 3, v122
    v_mad_i32_i24 v11, v14, s55, v118
    v_bitop3_b32 v12, v6, v13, v12 bitop3:0xca
    v_lshl_add_u32 v11, v11, 17, s40
    v_lshlrev_b16 v14, 8, v14
    v_lshrrev_b32 v13, 2, v122
    v_add_u32 v118, v12, v11
    v_bitop3_b32 v122, v5, v13, v14 bitop3:0xea
    ds_add_u32 v122, v2
    v_mul_hi_u32_u24 v14, 429497, v119
    v_lshrrev_b32 v12, 3, v123
    v_cos_f32 v10, v10
    v_lshlrev_b16 v13, 3, v123
    v_mad_i32_i24 v11, v14, s55, v119
    v_bitop3_b32 v12, v6, v13, v12 bitop3:0xca
    v_lshl_add_u32 v11, v11, 17, s40
    v_lshlrev_b16 v14, 8, v14
    v_lshrrev_b32 v13, 2, v123
    v_add_u32 v119, v12, v11
    v_bitop3_b32 v123, v5, v13, v14 bitop3:0xea
    ds_add_u32 v123, v2
    v_cvt_pk_bf16_f32 v125, v9, v10
    v_perm_b32 v12, v125, v125, s41
    v_bitop3_b32 v118, v4, v12, v118 bitop3:0xca
    v_perm_b32 v13, v125, v125, s42
    v_bitop3_b32 v119, v4, v13, v119 bitop3:0xca
    s_add_u32 s47, s35, 0x4000
    s_add_u32 s47, s47, s85
    buffer_store_dwordx4 v[68:71], v0, s[20:23], s47 offen sc1
    s_add_u32 s44, s96, 0x4000000
    s_nop 0
    v_lshlrev_b32 v68, 1, v1
    buffer_load_dwordx4 v[68:71], v68, s[8:11], s44 offen nt
    s_waitcnt vmcnt(16)
    v_lshlrev_b32 v7, 16, v126
    v_and_b32 v8, 0xffff0000, v126
    v_lshlrev_b32 v9, 16, v127
    v_and_b32 v10, 0xffff0000, v127
    v_mul_f32 v7, 0.15915494, v7
    v_mul_f32 v8, 0.15915494, v8
    v_mul_f32 v9, 0.15915494, v9
    v_mul_f32 v10, 0.15915494, v10
    v_mul_hi_u32_u24 v14, 429497, v16
    v_lshrrev_b32 v12, 3, v20
    v_cos_f32 v7, v7
    v_lshlrev_b16 v13, 3, v20
    v_mad_i32_i24 v11, v14, s55, v16
    v_bitop3_b32 v12, v6, v13, v12 bitop3:0xca
    v_lshl_add_u32 v11, v11, 17, s40
    v_lshlrev_b16 v14, 8, v14
    v_lshrrev_b32 v13, 2, v20
    v_add_u32 v16, v12, v11
    v_bitop3_b32 v20, v5, v13, v14 bitop3:0xea
    ds_add_u32 v20, v2
    v_mul_hi_u32_u24 v14, 429497, v17
    v_lshrrev_b32 v12, 3, v21
    v_cos_f32 v8, v8
    v_lshlrev_b16 v13, 3, v21
    v_mad_i32_i24 v11, v14, s55, v17
    v_bitop3_b32 v12, v6, v13, v12 bitop3:0xca
    v_lshl_add_u32 v11, v11, 17, s40
    v_lshlrev_b16 v14, 8, v14
    v_lshrrev_b32 v13, 2, v21
    v_add_u32 v17, v12, v11
    v_bitop3_b32 v21, v5, v13, v14 bitop3:0xea
    ds_add_u32 v21, v2
    v_cvt_pk_bf16_f32 v126, v7, v8
    v_perm_b32 v12, v126, v126, s41
    v_bitop3_b32 v16, v4, v12, v16 bitop3:0xca
    v_perm_b32 v13, v126, v126, s42
    v_bitop3_b32 v17, v4, v13, v17 bitop3:0xca
    v_mul_hi_u32_u24 v14, 429497, v18
    v_lshrrev_b32 v12, 3, v22
    v_cos_f32 v9, v9
    v_lshlrev_b16 v13, 3, v22
    v_mad_i32_i24 v11, v14, s55, v18
    v_bitop3_b32 v12, v6, v13, v12 bitop3:0xca
    v_lshl_add_u32 v11, v11, 17, s40
    v_lshlrev_b16 v14, 8, v14
    v_lshrrev_b32 v13, 2, v22
    v_add_u32 v18, v12, v11
    v_bitop3_b32 v22, v5, v13, v14 bitop3:0xea
    ds_add_u32 v22, v2
    v_mul_hi_u32_u24 v14, 429497, v19
    v_lshrrev_b32 v12, 3, v23
    v_cos_f32 v10, v10
    v_lshlrev_b16 v13, 3, v23
    v_mad_i32_i24 v11, v14, s55, v19
    v_bitop3_b32 v12, v6, v13, v12 bitop3:0xca
    v_lshl_add_u32 v11, v11, 17, s40
    v_lshlrev_b16 v14, 8, v14
    v_lshrrev_b32 v13, 2, v23
    v_add_u32 v19, v12, v11
    v_bitop3_b32 v23, v5, v13, v14 bitop3:0xea
    ds_add_u32 v23, v2
    v_cvt_pk_bf16_f32 v127, v9, v10
    v_perm_b32 v12, v127, v127, s41
    v_bitop3_b32 v18, v4, v12, v18 bitop3:0xca
    v_perm_b32 v13, v127, v127, s42
    v_bitop3_b32 v19, v4, v13, v19 bitop3:0xca
    s_setprio 1
    s_waitcnt vmcnt(12)
    v_lshlrev_b32 v7, 16, v24
    v_and_b32 v8, 0xffff0000, v24
    v_lshlrev_b32 v9, 16, v25
    v_and_b32 v10, 0xffff0000, v25
    v_mul_f32 v7, 0.15915494, v7
    v_mul_f32 v8, 0.15915494, v8
    v_mul_f32 v9, 0.15915494, v9
    v_mul_f32 v10, 0.15915494, v10
    v_mul_hi_u32_u24 v14, 429497, v28
    v_lshrrev_b32 v12, 3, v32
    v_cos_f32 v7, v7
    v_lshlrev_b16 v13, 3, v32
    v_mad_i32_i24 v11, v14, s55, v28
    v_bitop3_b32 v12, v6, v13, v12 bitop3:0xca
    v_lshl_add_u32 v11, v11, 17, s40
    v_lshlrev_b16 v14, 8, v14
    v_lshrrev_b32 v13, 2, v32
    v_add_u32 v28, v12, v11
    v_bitop3_b32 v32, v5, v13, v14 bitop3:0xea
    ds_add_u32 v32, v2
    v_mul_hi_u32_u24 v14, 429497, v29
    v_lshrrev_b32 v12, 3, v33
    v_cos_f32 v8, v8
    v_lshlrev_b16 v13, 3, v33
    v_mad_i32_i24 v11, v14, s55, v29
    v_bitop3_b32 v12, v6, v13, v12 bitop3:0xca
    v_lshl_add_u32 v11, v11, 17, s40
    v_lshlrev_b16 v14, 8, v14
    v_lshrrev_b32 v13, 2, v33
    v_add_u32 v29, v12, v11
    v_bitop3_b32 v33, v5, v13, v14 bitop3:0xea
    ds_add_u32 v33, v2
    v_cvt_pk_bf16_f32 v24, v7, v8
    v_perm_b32 v12, v24, v24, s41
    v_bitop3_b32 v28, v4, v12, v28 bitop3:0xca
    v_perm_b32 v13, v24, v24, s42
    v_bitop3_b32 v29, v4, v13, v29 bitop3:0xca
    v_mul_hi_u32_u24 v14, 429497, v30
    v_lshrrev_b32 v12, 3, v34
    v_cos_f32 v9, v9
    v_lshlrev_b16 v13, 3, v34
    v_mad_i32_i24 v11, v14, s55, v30
    v_bitop3_b32 v12, v6, v13, v12 bitop3:0xca
    v_lshl_add_u32 v11, v11, 17, s40
    v_lshlrev_b16 v14, 8, v14
    v_lshrrev_b32 v13, 2, v34
    v_add_u32 v30, v12, v11
    v_bitop3_b32 v34, v5, v13, v14 bitop3:0xea
    ds_add_u32 v34, v2
    v_mul_hi_u32_u24 v14, 429497, v31
    v_lshrrev_b32 v12, 3, v35
    v_cos_f32 v10, v10
    v_lshlrev_b16 v13, 3, v35
    v_mad_i32_i24 v11, v14, s55, v31
    v_bitop3_b32 v12, v6, v13, v12 bitop3:0xca
    v_lshl_add_u32 v11, v11, 17, s40
    v_lshlrev_b16 v14, 8, v14
    v_lshrrev_b32 v13, 2, v35
    v_add_u32 v31, v12, v11
    v_bitop3_b32 v35, v5, v13, v14 bitop3:0xea
    ds_add_u32 v35, v2
    v_cvt_pk_bf16_f32 v25, v9, v10
    v_perm_b32 v12, v25, v25, s41
    v_bitop3_b32 v30, v4, v12, v30 bitop3:0xca
    v_perm_b32 v13, v25, v25, s42
    v_bitop3_b32 v31, v4, v13, v31 bitop3:0xca
    s_waitcnt vmcnt(10)
    v_lshlrev_b32 v7, 16, v26
    v_and_b32 v8, 0xffff0000, v26
    v_lshlrev_b32 v9, 16, v27
    v_and_b32 v10, 0xffff0000, v27
    v_mul_f32 v7, 0.15915494, v7
    v_mul_f32 v8, 0.15915494, v8
    v_mul_f32 v9, 0.15915494, v9
    v_mul_f32 v10, 0.15915494, v10
    v_mul_hi_u32_u24 v14, 429497, v36
    v_lshrrev_b32 v12, 3, v40
    v_cos_f32 v7, v7
    v_lshlrev_b16 v13, 3, v40
    v_mad_i32_i24 v11, v14, s55, v36
    v_bitop3_b32 v12, v6, v13, v12 bitop3:0xca
    v_lshl_add_u32 v11, v11, 17, s40
    v_lshlrev_b16 v14, 8, v14
    v_lshrrev_b32 v13, 2, v40
    v_add_u32 v36, v12, v11
    v_bitop3_b32 v40, v5, v13, v14 bitop3:0xea
    ds_add_u32 v40, v2
    v_mul_hi_u32_u24 v14, 429497, v37
    v_lshrrev_b32 v12, 3, v41
    v_cos_f32 v8, v8
    v_lshlrev_b16 v13, 3, v41
    v_mad_i32_i24 v11, v14, s55, v37
    v_bitop3_b32 v12, v6, v13, v12 bitop3:0xca
    v_lshl_add_u32 v11, v11, 17, s40
    v_lshlrev_b16 v14, 8, v14
    v_lshrrev_b32 v13, 2, v41
    v_add_u32 v37, v12, v11
    v_bitop3_b32 v41, v5, v13, v14 bitop3:0xea
    ds_add_u32 v41, v2
    v_cvt_pk_bf16_f32 v26, v7, v8
    v_perm_b32 v12, v26, v26, s41
    v_bitop3_b32 v36, v4, v12, v36 bitop3:0xca
    v_perm_b32 v13, v26, v26, s42
    v_bitop3_b32 v37, v4, v13, v37 bitop3:0xca
    v_mul_hi_u32_u24 v14, 429497, v38
    v_lshrrev_b32 v12, 3, v42
    v_cos_f32 v9, v9
    v_lshlrev_b16 v13, 3, v42
    v_mad_i32_i24 v11, v14, s55, v38
    v_bitop3_b32 v12, v6, v13, v12 bitop3:0xca
    v_lshl_add_u32 v11, v11, 17, s40
    v_lshlrev_b16 v14, 8, v14
    v_lshrrev_b32 v13, 2, v42
    v_add_u32 v38, v12, v11
    v_bitop3_b32 v42, v5, v13, v14 bitop3:0xea
    ds_add_u32 v42, v2
    v_mul_hi_u32_u24 v14, 429497, v39
    v_lshrrev_b32 v12, 3, v43
    v_cos_f32 v10, v10
    v_lshlrev_b16 v13, 3, v43
    v_mad_i32_i24 v11, v14, s55, v39
    v_bitop3_b32 v12, v6, v13, v12 bitop3:0xca
    v_lshl_add_u32 v11, v11, 17, s40
    v_lshlrev_b16 v14, 8, v14
    v_lshrrev_b32 v13, 2, v43
    v_add_u32 v39, v12, v11
    v_bitop3_b32 v43, v5, v13, v14 bitop3:0xea
    ds_add_u32 v43, v2
    v_cvt_pk_bf16_f32 v27, v9, v10
    v_perm_b32 v12, v27, v27, s41
    v_bitop3_b32 v38, v4, v12, v38 bitop3:0xca
    v_perm_b32 v13, v27, v27, s42
    v_bitop3_b32 v39, v4, v13, v39 bitop3:0xca
    s_setprio 0
    s_add_u32 s45, s35, 0x4000
    s_add_u32 s45, s45, s91
    buffer_store_dwordx4 v[72:75], v0, s[20:23], s45 offen sc1
    s_add_u32 s46, s96, 0x4000000
    s_nop 0
    v_lshlrev_b32 v72, 1, v1
    buffer_load_dwordx4 v[72:75], v72, s[12:15], s46 offen nt
    s_waitcnt vmcnt(8)
    v_lshlrev_b32 v7, 16, v44
    v_and_b32 v8, 0xffff0000, v44
    v_lshlrev_b32 v9, 16, v45
    v_and_b32 v10, 0xffff0000, v45
    v_mul_f32 v7, 0.15915494, v7
    v_mul_f32 v8, 0.15915494, v8
    v_mul_f32 v9, 0.15915494, v9
    v_mul_f32 v10, 0.15915494, v10
    v_mul_hi_u32_u24 v14, 429497, v48
    v_lshrrev_b32 v12, 3, v52
    v_cos_f32 v7, v7
    v_lshlrev_b16 v13, 3, v52
    v_mad_i32_i24 v11, v14, s55, v48
    v_bitop3_b32 v12, v6, v13, v12 bitop3:0xca
    v_lshl_add_u32 v11, v11, 17, s40
    v_lshlrev_b16 v14, 8, v14
    v_lshrrev_b32 v13, 2, v52
    v_add_u32 v48, v12, v11
    v_bitop3_b32 v52, v5, v13, v14 bitop3:0xea
    ds_add_u32 v52, v2
    v_mul_hi_u32_u24 v14, 429497, v49
    v_lshrrev_b32 v12, 3, v53
    v_cos_f32 v8, v8
    v_lshlrev_b16 v13, 3, v53
    v_mad_i32_i24 v11, v14, s55, v49
    v_bitop3_b32 v12, v6, v13, v12 bitop3:0xca
    v_lshl_add_u32 v11, v11, 17, s40
    v_lshlrev_b16 v14, 8, v14
    v_lshrrev_b32 v13, 2, v53
    v_add_u32 v49, v12, v11
    v_bitop3_b32 v53, v5, v13, v14 bitop3:0xea
    ds_add_u32 v53, v2
    v_cvt_pk_bf16_f32 v44, v7, v8
    v_perm_b32 v12, v44, v44, s41
    v_bitop3_b32 v48, v4, v12, v48 bitop3:0xca
    v_perm_b32 v13, v44, v44, s42
    v_bitop3_b32 v49, v4, v13, v49 bitop3:0xca
    v_mul_hi_u32_u24 v14, 429497, v50
    v_lshrrev_b32 v12, 3, v54
    v_cos_f32 v9, v9
    v_lshlrev_b16 v13, 3, v54
    v_mad_i32_i24 v11, v14, s55, v50
    v_bitop3_b32 v12, v6, v13, v12 bitop3:0xca
    v_lshl_add_u32 v11, v11, 17, s40
    v_lshlrev_b16 v14, 8, v14
    v_lshrrev_b32 v13, 2, v54
    v_add_u32 v50, v12, v11
    v_bitop3_b32 v54, v5, v13, v14 bitop3:0xea
    ds_add_u32 v54, v2
    v_mul_hi_u32_u24 v14, 429497, v51
    v_lshrrev_b32 v12, 3, v55
    v_cos_f32 v10, v10
    v_lshlrev_b16 v13, 3, v55
    v_mad_i32_i24 v11, v14, s55, v51
    v_bitop3_b32 v12, v6, v13, v12 bitop3:0xca
    v_lshl_add_u32 v11, v11, 17, s40
    v_lshlrev_b16 v14, 8, v14
    v_lshrrev_b32 v13, 2, v55
    v_add_u32 v51, v12, v11
    v_bitop3_b32 v55, v5, v13, v14 bitop3:0xea
    ds_add_u32 v55, v2
    v_cvt_pk_bf16_f32 v45, v9, v10
    v_perm_b32 v12, v45, v45, s41
    v_bitop3_b32 v50, v4, v12, v50 bitop3:0xca
    v_perm_b32 v13, v45, v45, s42
    v_bitop3_b32 v51, v4, v13, v51 bitop3:0xca
    s_waitcnt vmcnt(4)
    v_lshlrev_b32 v7, 16, v46
    v_and_b32 v8, 0xffff0000, v46
    v_lshlrev_b32 v9, 16, v47
    v_and_b32 v10, 0xffff0000, v47
    v_mul_f32 v7, 0.15915494, v7
    v_mul_f32 v8, 0.15915494, v8
    v_mul_f32 v9, 0.15915494, v9
    v_mul_f32 v10, 0.15915494, v10
    v_mul_hi_u32_u24 v14, 429497, v56
    v_lshrrev_b32 v12, 3, v60
    v_cos_f32 v7, v7
    v_lshlrev_b16 v13, 3, v60
    v_mad_i32_i24 v11, v14, s55, v56
    v_bitop3_b32 v12, v6, v13, v12 bitop3:0xca
    v_lshl_add_u32 v11, v11, 17, s40
    v_lshlrev_b16 v14, 8, v14
    v_lshrrev_b32 v13, 2, v60
    v_add_u32 v56, v12, v11
    v_bitop3_b32 v60, v5, v13, v14 bitop3:0xea
    ds_add_u32 v60, v2
    v_mul_hi_u32_u24 v14, 429497, v57
    v_lshrrev_b32 v12, 3, v61
    v_cos_f32 v8, v8
    v_lshlrev_b16 v13, 3, v61
    v_mad_i32_i24 v11, v14, s55, v57
    v_bitop3_b32 v12, v6, v13, v12 bitop3:0xca
    v_lshl_add_u32 v11, v11, 17, s40
    v_lshlrev_b16 v14, 8, v14
    v_lshrrev_b32 v13, 2, v61
    v_add_u32 v57, v12, v11
    v_bitop3_b32 v61, v5, v13, v14 bitop3:0xea
    ds_add_u32 v61, v2
    v_cvt_pk_bf16_f32 v46, v7, v8
    v_perm_b32 v12, v46, v46, s41
    v_bitop3_b32 v56, v4, v12, v56 bitop3:0xca
    v_perm_b32 v13, v46, v46, s42
    v_bitop3_b32 v57, v4, v13, v57 bitop3:0xca
    v_mul_hi_u32_u24 v14, 429497, v58
    v_lshrrev_b32 v12, 3, v62
    v_cos_f32 v9, v9
    v_lshlrev_b16 v13, 3, v62
    v_mad_i32_i24 v11, v14, s55, v58
    v_bitop3_b32 v12, v6, v13, v12 bitop3:0xca
    v_lshl_add_u32 v11, v11, 17, s40
    v_lshlrev_b16 v14, 8, v14
    v_lshrrev_b32 v13, 2, v62
    v_add_u32 v58, v12, v11
    v_bitop3_b32 v62, v5, v13, v14 bitop3:0xea
    ds_add_u32 v62, v2
    v_mul_hi_u32_u24 v14, 429497, v59
    v_lshrrev_b32 v12, 3, v63
    v_cos_f32 v10, v10
    v_lshlrev_b16 v13, 3, v63
    v_mad_i32_i24 v11, v14, s55, v59
    v_bitop3_b32 v12, v6, v13, v12 bitop3:0xca
    v_lshl_add_u32 v11, v11, 17, s40
    v_lshlrev_b16 v14, 8, v14
    v_lshrrev_b32 v13, 2, v63
    v_add_u32 v59, v12, v11
    v_bitop3_b32 v63, v5, v13, v14 bitop3:0xea
    ds_add_u32 v63, v2
    v_cvt_pk_bf16_f32 v47, v9, v10
    v_perm_b32 v12, v47, v47, s41
    v_bitop3_b32 v58, v4, v12, v58 bitop3:0xca
    v_perm_b32 v13, v47, v47, s42
    v_bitop3_b32 v59, v4, v13, v59 bitop3:0xca
    v_lshrrev_b32 v8, 2, v0
    v_and_b32 v7, 0x3c00, v0
    v_bitop3_b32 v7, v5, v8, v7 bitop3:0xea
    s_waitcnt lgkmcnt(0)
    s_barrier
    ds_read2st64_b32 v[8:9], v7 offset0:0 offset1:1
    ds_read2st64_b32 v[10:11], v7 offset0:2 offset1:3
    s_add_u32 s47, s35, 0x4000
    s_add_u32 s47, s47, s93
    buffer_store_dwordx4 v[64:67], v0, s[20:23], s47 offen sc1
    s_add_u32 s44, s96, 0x4000000
    s_lshr_b32 s44, s44, 1
    buffer_load_dwordx2 v[64:65], v1, s[16:19], s44 offen nt
    s_add_u32 s45, s97, 0x4400000
    s_lshr_b32 s45, s45, 1
    buffer_load_dwordx2 v[66:67], v1, s[16:19], s45 offen nt
    s_waitcnt lgkmcnt(0)
    v_lshl_or_b32 v12, v9, 16, v8
    v_lshl_or_b32 v13, v11, 16, v10
    v_mov_b32 v14, v12
    v_mov_b32 v15, v13
    s_nop 0
    v_add_u32_dpp v14, v14, v14 row_shr:1 row_mask:0xf bank_mask:0xf bound_ctrl:1
    v_add_u32_dpp v15, v15, v15 row_shr:1 row_mask:0xf bank_mask:0xf bound_ctrl:1
    s_nop 0
    v_add_u32_dpp v14, v14, v14 row_shr:2 row_mask:0xf bank_mask:0xf bound_ctrl:1
    v_add_u32_dpp v15, v15, v15 row_shr:2 row_mask:0xf bank_mask:0xf bound_ctrl:1
    s_nop 0
    v_add_u32_dpp v14, v14, v14 row_shr:4 row_mask:0xf bank_mask:0xf bound_ctrl:1
    v_add_u32_dpp v15, v15, v15 row_shr:4 row_mask:0xf bank_mask:0xf bound_ctrl:1
    s_nop 0
    v_add_u32_dpp v14, v14, v14 row_shr:8 row_mask:0xf bank_mask:0xf bound_ctrl:1
    v_add_u32_dpp v15, v15, v15 row_shr:8 row_mask:0xf bank_mask:0xf bound_ctrl:1
    s_nop 0
    v_add_u32_dpp v14, v14, v14 row_bcast:15 row_mask:0xa bank_mask:0xf
    v_add_u32_dpp v15, v15, v15 row_bcast:15 row_mask:0xa bank_mask:0xf
    s_nop 0
    v_add_u32_dpp v14, v14, v14 row_bcast:31 row_mask:0xc bank_mask:0xf
    v_add_u32_dpp v15, v15, v15 row_bcast:31 row_mask:0xc bank_mask:0xf
    v_readlane_b32 s48, v14, 63
    v_readlane_b32 s49, v15, 63
    s_lshl_b32 s54, s32, 2
    v_mov_b32 v8, s54
    s_and_b32 s50, s48, 0xffff
    s_lshr_b32 s51, s48, 16
    s_and_b32 s52, s49, 0xffff
    s_lshr_b32 s53, s49, 16
    s_add_u32 s51, s51, s50
    s_add_u32 s52, s52, s51
    s_add_u32 s53, s53, s52
    v_mov_b32 v9, s53
    s_mov_b64 exec, 1
    ds_write_b32 v8, v9 offset:16384
    s_mov_b64 exec, -1
    v_and_b32 v8, 60, v7
    s_waitcnt lgkmcnt(0)
    s_barrier
    ds_read_b32 v9, v8 offset:16384
    s_waitcnt lgkmcnt(0)
    v_add_u32_dpp v9, v9, v9 row_shr:1 row_mask:0xf bank_mask:0xf bound_ctrl:1
    s_nop 1
    v_add_u32_dpp v9, v9, v9 row_shr:2 row_mask:0xf bank_mask:0xf bound_ctrl:1
    s_nop 1
    v_add_u32_dpp v9, v9, v9 row_shr:4 row_mask:0xf bank_mask:0xf bound_ctrl:1
    s_nop 1
    v_add_u32_dpp v9, v9, v9 row_shr:8 row_mask:0xf bank_mask:0xf bound_ctrl:1
    s_nop 0
    v_readlane_b32 s54, v9, s32
    s_sub_u32 s54, s54, s53
    s_add_u32 s50, s50, s54
    s_add_u32 s51, s51, s54
    s_add_u32 s52, s52, s54
    s_pack_ll_b32_b16 s48, s54, s50
    s_pack_ll_b32_b16 s49, s51, s52
    v_add_u32 v14, s48, v14
    v_add_u32 v15, s49, v15
    v_sub_u32 v12, v14, v12
    v_sub_u32 v13, v15, v13
    v_and_b32 v8, 0xffff, v12
    v_lshrrev_b32 v9, 16, v12
    v_and_b32 v10, 0xffff, v13
    v_lshrrev_b32 v11, 16, v13
    ds_write2st64_b32 v7, v8, v9 offset0:0 offset1:1
    ds_write2st64_b32 v7, v10, v11 offset0:2 offset1:3
    v_and_b32 v8, 0x3f0, v0
    v_lshl_add_u32 v8, v8, 1, s36
    ds_write_b64 v8, v[12:13] offset:20480
    s_bitset0_b64 exec, 63
    s_not_b64 exec, exec
    ds_write_b64 v8, v[14:15] offset:20512
    s_mov_b64 exec, -1
    s_waitcnt lgkmcnt(0)
    s_barrier
    s_setprio 3
    ds_add_rtn_u32 v104, v104, v2
    ds_add_rtn_u32 v105, v105, v2
    ds_add_rtn_u32 v106, v106, v2
    ds_add_rtn_u32 v107, v107, v2
    ds_read_b128 v[12:15], v0 offset:20480
    v_cmp_gt_u32 vcc, 8448, v0
    ds_add_rtn_u32 v112, v112, v2
    ds_add_rtn_u32 v113, v113, v2
    ds_add_rtn_u32 v114, v114, v2
    ds_add_rtn_u32 v115, v115, v2
    s_setprio 2
    ds_add_rtn_u32 v120, v120, v2
    ds_add_rtn_u32 v121, v121, v2
    ds_add_rtn_u32 v122, v122, v2
    ds_add_rtn_u32 v123, v123, v2
    s_waitcnt lgkmcnt(8)
    s_cbranch_vccz L1_p2
    s_add_u32 s46, s35, 0x2a40000
    s_mov_b64 exec, vcc
    buffer_store_dwordx4 v[12:15], v0, s[24:27], s46 offen sc1
    s_mov_b64 exec, -1
L1_p2:
    s_add_u32 s47, s35, 0x8000
    s_add_u32 s47, s47, s72
    buffer_store_dwordx4 v[76:79], v0, s[20:23], s47 offen sc1
    s_add_u32 s44, s97, 0x4400000
    s_nop 0
    v_lshlrev_b32 v76, 1, v1
    buffer_load_dwordx4 v[76:79], v76, s[8:11], s44 offen nt
    ds_add_rtn_u32 v20, v20, v2
    ds_add_rtn_u32 v21, v21, v2
    ds_add_rtn_u32 v22, v22, v2
    ds_add_rtn_u32 v23, v23, v2
    s_setprio 1
    ds_add_rtn_u32 v32, v32, v2
    ds_add_rtn_u32 v33, v33, v2
    ds_add_rtn_u32 v34, v34, v2
    ds_add_rtn_u32 v35, v35, v2
    ds_add_rtn_u32 v40, v40, v2
    ds_add_rtn_u32 v41, v41, v2
    ds_add_rtn_u32 v42, v42, v2
    ds_add_rtn_u32 v43, v43, v2
    s_add_u32 s45, s35, 0x8000
    s_add_u32 s45, s45, s73
    buffer_store_dwordx4 v[80:83], v0, s[20:23], s45 offen sc1
    s_add_u32 s46, s97, 0x4400000
    s_nop 0
    v_lshlrev_b32 v80, 1, v1
    buffer_load_dwordx4 v[80:83], v80, s[12:15], s46 offen nt
    s_setprio 0
    ds_add_rtn_u32 v52, v52, v2
    ds_add_rtn_u32 v53, v53, v2
    ds_add_rtn_u32 v54, v54, v2
    ds_add_rtn_u32 v55, v55, v2
    ds_add_rtn_u32 v60, v60, v2
    ds_add_rtn_u32 v61, v61, v2
    ds_add_rtn_u32 v62, v62, v2
    ds_add_rtn_u32 v63, v63, v2
    s_waitcnt lgkmcnt(0)
    s_barrier
    s_setprio 3
    v_and_b32 v7, -4, v104
    v_lshl_add_u32 v8, v104, 2, v7
    ds_write_b32 v8, v96
    v_lshl_add_u32 v7, v7, 2, v104
    ds_write_b8 v7, v108 offset:16
    v_and_b32 v9, -4, v105
    v_lshl_add_u32 v10, v105, 2, v9
    ds_write_b32 v10, v97
    v_lshl_add_u32 v9, v9, 2, v105
    ds_write_b8_d16_hi v9, v108 offset:16
    v_and_b32 v7, -4, v106
    v_lshl_add_u32 v8, v106, 2, v7
    ds_write_b32 v8, v98
    v_lshl_add_u32 v7, v7, 2, v106
    ds_write_b8 v7, v109 offset:16
    v_and_b32 v9, -4, v107
    v_lshl_add_u32 v10, v107, 2, v9
    ds_write_b32 v10, v99
    v_lshl_add_u32 v9, v9, 2, v107
    ds_write_b8_d16_hi v9, v109 offset:16
    s_add_u32 s47, s35, 0x8000
    s_add_u32 s47, s47, s85
    buffer_store_dwordx4 v[88:91], v0, s[20:23], s47 offen sc1
    s_add_u32 s44, s98, 0x4800000
    v_lshlrev_b32 v96, 1, v1
    buffer_load_dwordx4 v[96:99], v96, s[8:11], s44 offen nt
    s_add_u32 s45, s98, 0x4800000
    v_lshlrev_b32 v104, 1, v1
    buffer_load_dwordx4 v[104:107], v104, s[12:15], s45 offen nt
    v_and_b32 v7, -4, v112
    v_lshl_add_u32 v8, v112, 2, v7
    ds_write_b32 v8, v100
    v_lshl_add_u32 v7, v7, 2, v112
    ds_write_b8 v7, v110 offset:16
    v_and_b32 v9, -4, v113
    v_lshl_add_u32 v10, v113, 2, v9
    ds_write_b32 v10, v101
    v_lshl_add_u32 v9, v9, 2, v113
    ds_write_b8_d16_hi v9, v110 offset:16
    v_and_b32 v7, -4, v114
    v_lshl_add_u32 v8, v114, 2, v7
    ds_write_b32 v8, v102
    v_lshl_add_u32 v7, v7, 2, v114
    ds_write_b8 v7, v111 offset:16
    v_and_b32 v9, -4, v115
    v_lshl_add_u32 v10, v115, 2, v9
    ds_write_b32 v10, v103
    v_lshl_add_u32 v9, v9, 2, v115
    ds_write_b8_d16_hi v9, v111 offset:16
    s_add_u32 s46, s98, 0x4800000
    s_lshr_b32 s46, s46, 1
    buffer_load_dwordx2 v[88:89], v1, s[16:19], s46 offen nt
    s_add_u32 s47, s99, 0x4c00000
    s_lshr_b32 s47, s47, 1
    buffer_load_dwordx2 v[90:91], v1, s[16:19], s47 offen nt
    s_add_u32 s44, s99, 0x4c00000
    v_lshlrev_b32 v100, 1, v1
    buffer_load_dwordx4 v[100:103], v100, s[8:11], s44 offen nt
    s_setprio 2
    v_and_b32 v7, -4, v120
    v_lshl_add_u32 v8, v120, 2, v7
    ds_write_b32 v8, v116
    v_lshl_add_u32 v7, v7, 2, v120
    ds_write_b8 v7, v124 offset:16
    v_and_b32 v9, -4, v121
    v_lshl_add_u32 v10, v121, 2, v9
    ds_write_b32 v10, v117
    v_lshl_add_u32 v9, v9, 2, v121
    ds_write_b8_d16_hi v9, v124 offset:16
    v_and_b32 v7, -4, v122
    v_lshl_add_u32 v8, v122, 2, v7
    ds_write_b32 v8, v118
    v_lshl_add_u32 v7, v7, 2, v122
    ds_write_b8 v7, v125 offset:16
    v_and_b32 v9, -4, v123
    v_lshl_add_u32 v10, v123, 2, v9
    ds_write_b32 v10, v119
    v_lshl_add_u32 v9, v9, 2, v123
    ds_write_b8_d16_hi v9, v125 offset:16
    s_add_u32 s45, s35, 0x8000
    s_add_u32 s45, s45, s91
    buffer_store_dwordx4 v[92:95], v0, s[20:23], s45 offen sc1
    s_add_u32 s46, s99, 0x4c00000
    v_lshlrev_b32 v112, 1, v1
    buffer_load_dwordx4 v[112:115], v112, s[12:15], s46 offen nt
    v_and_b32 v7, -4, v20
    v_lshl_add_u32 v8, v20, 2, v7
    ds_write_b32 v8, v16
    v_lshl_add_u32 v7, v7, 2, v20
    ds_write_b8 v7, v126 offset:16
    v_and_b32 v9, -4, v21
    v_lshl_add_u32 v10, v21, 2, v9
    ds_write_b32 v10, v17
    v_lshl_add_u32 v9, v9, 2, v21
    ds_write_b8_d16_hi v9, v126 offset:16
    v_and_b32 v7, -4, v22
    v_lshl_add_u32 v8, v22, 2, v7
    ds_write_b32 v8, v18
    v_lshl_add_u32 v7, v7, 2, v22
    ds_write_b8 v7, v127 offset:16
    v_and_b32 v9, -4, v23
    v_lshl_add_u32 v10, v23, 2, v9
    ds_write_b32 v10, v19
    v_lshl_add_u32 v9, v9, 2, v23
    ds_write_b8_d16_hi v9, v127 offset:16
    s_add_u32 s47, s96, 0x5000000
    v_lshlrev_b32 v108, 1, v1
    buffer_load_dwordx4 v[108:111], v108, s[8:11], s47 offen nt
    s_add_u32 s44, s96, 0x5000000
    v_lshlrev_b32 v116, 1, v1
    buffer_load_dwordx4 v[116:119], v116, s[12:15], s44 offen nt
    s_setprio 1
    v_and_b32 v7, -4, v32
    v_lshl_add_u32 v8, v32, 2, v7
    ds_write_b32 v8, v28
    v_lshl_add_u32 v7, v7, 2, v32
    ds_write_b8 v7, v24 offset:16
    v_and_b32 v9, -4, v33
    v_lshl_add_u32 v10, v33, 2, v9
    ds_write_b32 v10, v29
    v_lshl_add_u32 v9, v9, 2, v33
    ds_write_b8_d16_hi v9, v24 offset:16
    v_and_b32 v7, -4, v34
    v_lshl_add_u32 v8, v34, 2, v7
    ds_write_b32 v8, v30
    v_lshl_add_u32 v7, v7, 2, v34
    ds_write_b8 v7, v25 offset:16
    v_and_b32 v9, -4, v35
    v_lshl_add_u32 v10, v35, 2, v9
    ds_write_b32 v10, v31
    v_lshl_add_u32 v9, v9, 2, v35
    ds_write_b8_d16_hi v9, v25 offset:16
    s_add_u32 s45, s96, 0x5000000
    s_lshr_b32 s45, s45, 1
    buffer_load_dwordx2 v[120:121], v1, s[16:19], s45 offen nt
    s_add_u32 s46, s97, 0x5400000
    s_lshr_b32 s46, s46, 1
    buffer_load_dwordx2 v[122:123], v1, s[16:19], s46 offen nt
    s_add_u32 s47, s97, 0x5400000
    v_lshlrev_b32 v92, 1, v1
    buffer_load_dwordx4 v[92:95], v92, s[8:11], s47 offen nt
    v_and_b32 v7, -4, v40
    v_lshl_add_u32 v8, v40, 2, v7
    ds_write_b32 v8, v36
    v_lshl_add_u32 v7, v7, 2, v40
    ds_write_b8 v7, v26 offset:16
    v_and_b32 v9, -4, v41
    v_lshl_add_u32 v10, v41, 2, v9
    ds_write_b32 v10, v37
    v_lshl_add_u32 v9, v9, 2, v41
    ds_write_b8_d16_hi v9, v26 offset:16
    v_and_b32 v7, -4, v42
    v_lshl_add_u32 v8, v42, 2, v7
    ds_write_b32 v8, v38
    v_lshl_add_u32 v7, v7, 2, v42
    ds_write_b8 v7, v27 offset:16
    v_and_b32 v9, -4, v43
    v_lshl_add_u32 v10, v43, 2, v9
    ds_write_b32 v10, v39
    v_lshl_add_u32 v9, v9, 2, v43
    ds_write_b8_d16_hi v9, v27 offset:16
    s_add_u32 s44, s35, 0x8000
    s_add_u32 s44, s44, s93
    buffer_store_dwordx4 v[84:87], v0, s[20:23], s44 offen sc1
    s_add_u32 s45, s97, 0x5400000
    v_lshlrev_b32 v16, 1, v1
    buffer_load_dwordx4 v[16:19], v16, s[12:15], s45 offen nt
    s_setprio 0
    v_and_b32 v7, -4, v52
    v_lshl_add_u32 v8, v52, 2, v7
    ds_write_b32 v8, v48
    v_lshl_add_u32 v7, v7, 2, v52
    ds_write_b8 v7, v44 offset:16
    v_and_b32 v9, -4, v53
    v_lshl_add_u32 v10, v53, 2, v9
    ds_write_b32 v10, v49
    v_lshl_add_u32 v9, v9, 2, v53
    ds_write_b8_d16_hi v9, v44 offset:16
    v_and_b32 v7, -4, v54
    v_lshl_add_u32 v8, v54, 2, v7
    ds_write_b32 v8, v50
    v_lshl_add_u32 v7, v7, 2, v54
    ds_write_b8 v7, v45 offset:16
    v_and_b32 v9, -4, v55
    v_lshl_add_u32 v10, v55, 2, v9
    ds_write_b32 v10, v51
    v_lshl_add_u32 v9, v9, 2, v55
    ds_write_b8_d16_hi v9, v45 offset:16
    s_add_u32 s46, s98, 0x5800000
    v_lshlrev_b32 v20, 1, v1
    buffer_load_dwordx4 v[20:23], v20, s[8:11], s46 offen nt
    s_add_u32 s47, s98, 0x5800000
    v_lshlrev_b32 v124, 1, v1
    buffer_load_dwordx4 v[124:127], v124, s[12:15], s47 offen nt
    v_and_b32 v7, -4, v60
    v_lshl_add_u32 v8, v60, 2, v7
    ds_write_b32 v8, v56
    v_lshl_add_u32 v7, v7, 2, v60
    ds_write_b8 v7, v46 offset:16
    v_and_b32 v9, -4, v61
    v_lshl_add_u32 v10, v61, 2, v9
    ds_write_b32 v10, v57
    v_lshl_add_u32 v9, v9, 2, v61
    ds_write_b8_d16_hi v9, v46 offset:16
    v_and_b32 v7, -4, v62
    v_lshl_add_u32 v8, v62, 2, v7
    ds_write_b32 v8, v58
    v_lshl_add_u32 v7, v7, 2, v62
    ds_write_b8 v7, v47 offset:16
    v_and_b32 v9, -4, v63
    v_lshl_add_u32 v10, v63, 2, v9
    ds_write_b32 v10, v59
    v_lshl_add_u32 v9, v9, 2, v63
    ds_write_b8_d16_hi v9, v47 offset:16
    s_add_u32 s44, s98, 0x5800000
    s_lshr_b32 s44, s44, 1
    buffer_load_dwordx2 v[28:29], v1, s[16:19], s44 offen nt
    s_add_u32 s45, s99, 0x5c00000
    s_lshr_b32 s45, s45, 1
    buffer_load_dwordx2 v[30:31], v1, s[16:19], s45 offen nt
    v_add_u32 v7, s72, v0
    v_add_u32 v12, s73, v0
    v_add_u32 v13, s85, v0
    v_add_u32 v14, s91, v0
    v_add_u32 v15, s93, v0
    s_min_i32 s3, s72, s73
    s_min_i32 s3, s3, s85
    s_min_i32 s3, s3, s91
    s_min_i32 s3, s3, s93
    v_add_u32 v3, s3, v0
    v_mov_b32 v8, 0
    v_mov_b32 v9, 0
    v_mov_b32 v10, 0
    v_mov_b32 v11, 0
    s_waitcnt lgkmcnt(0)
    s_barrier
    ds_read_b128 v[32:35], v7 offset:0
    ds_read_b128 v[36:39], v12 offset:0
    ds_read_b128 v[40:43], v13 offset:0
    ds_read_b128 v[24:27], v14 offset:0
    ds_read_b128 v[84:87], v15 offset:0
    ds_write_b128 v3, v[8:11]
    ds_read_b128 v[48:51], v7 offset:16384
    ds_read_b128 v[52:55], v12 offset:16384
    ds_read_b128 v[56:59], v13 offset:16384
    ds_read_b128 v[60:63], v14 offset:16384
    ds_read_b128 v[44:47], v15 offset:16384
    s_waitcnt lgkmcnt(0)
    s_barrier
    s_setprio 3
    s_add_u32 s46, s35, 0x2a44000
    s_add_u32 s46, s46, s72
    buffer_store_dwordx4 v[32:35], v0, s[20:23], s46 offen sc1
    s_add_u32 s47, s99, 0x5c00000
    s_nop 0
    v_lshlrev_b32 v32, 1, v1
    buffer_load_dwordx4 v[32:35], v32, s[8:11], s47 offen nt
    s_add_u32 s44, s35, 0x2a44000
    s_add_u32 s44, s44, s73
    buffer_store_dwordx4 v[36:39], v0, s[20:23], s44 offen sc1
    s_add_u32 s45, s99, 0x5c00000
    s_nop 0
    v_lshlrev_b32 v36, 1, v1
    buffer_load_dwordx4 v[36:39], v36, s[12:15], s45 offen nt
    s_waitcnt vmcnt(27)
    v_lshlrev_b32 v7, 16, v64
    v_and_b32 v8, 0xffff0000, v64
    v_lshlrev_b32 v9, 16, v65
    v_and_b32 v10, 0xffff0000, v65
    v_mul_f32 v7, 0.15915494, v7
    v_mul_f32 v8, 0.15915494, v8
    v_mul_f32 v9, 0.15915494, v9
    v_mul_f32 v10, 0.15915494, v10
    v_mul_hi_u32_u24 v14, 429497, v68
    v_lshrrev_b32 v12, 3, v72
    v_cos_f32 v7, v7
    v_lshlrev_b16 v13, 3, v72
    v_mad_i32_i24 v11, v14, s55, v68
    v_bitop3_b32 v12, v6, v13, v12 bitop3:0xca
    v_lshl_add_u32 v11, v11, 17, s40
    v_lshlrev_b16 v14, 8, v14
    v_lshrrev_b32 v13, 2, v72
    v_add_u32 v68, v12, v11
    v_bitop3_b32 v72, v5, v13, v14 bitop3:0xea
    ds_add_u32 v72, v2
    v_mul_hi_u32_u24 v14, 429497, v69
    v_lshrrev_b32 v12, 3, v73
    v_cos_f32 v8, v8
    v_lshlrev_b16 v13, 3, v73
    v_mad_i32_i24 v11, v14, s55, v69
    v_bitop3_b32 v12, v6, v13, v12 bitop3:0xca
    v_lshl_add_u32 v11, v11, 17, s40
    v_lshlrev_b16 v14, 8, v14
    v_lshrrev_b32 v13, 2, v73
    v_add_u32 v69, v12, v11
    v_bitop3_b32 v73, v5, v13, v14 bitop3:0xea
    ds_add_u32 v73, v2
    v_cvt_pk_bf16_f32 v64, v7, v8
    v_perm_b32 v12, v64, v64, s41
    v_bitop3_b32 v68, v4, v12, v68 bitop3:0xca
    v_perm_b32 v13, v64, v64, s42
    v_bitop3_b32 v69, v4, v13, v69 bitop3:0xca
    v_mul_hi_u32_u24 v14, 429497, v70
    v_lshrrev_b32 v12, 3, v74
    v_cos_f32 v9, v9
    v_lshlrev_b16 v13, 3, v74
    v_mad_i32_i24 v11, v14, s55, v70
    v_bitop3_b32 v12, v6, v13, v12 bitop3:0xca
    v_lshl_add_u32 v11, v11, 17, s40
    v_lshlrev_b16 v14, 8, v14
    v_lshrrev_b32 v13, 2, v74
    v_add_u32 v70, v12, v11
    v_bitop3_b32 v74, v5, v13, v14 bitop3:0xea
    ds_add_u32 v74, v2
    v_mul_hi_u32_u24 v14, 429497, v71
    v_lshrrev_b32 v12, 3, v75
    v_cos_f32 v10, v10
    v_lshlrev_b16 v13, 3, v75
    v_mad_i32_i24 v11, v14, s55, v71
    v_bitop3_b32 v12, v6, v13, v12 bitop3:0xca
    v_lshl_add_u32 v11, v11, 17, s40
    v_lshlrev_b16 v14, 8, v14
    v_lshrrev_b32 v13, 2, v75
    v_add_u32 v71, v12, v11
    v_bitop3_b32 v75, v5, v13, v14 bitop3:0xea
    ds_add_u32 v75, v2
    v_cvt_pk_bf16_f32 v65, v9, v10
    v_perm_b32 v12, v65, v65, s41
    v_bitop3_b32 v70, v4, v12, v70 bitop3:0xca
    v_perm_b32 v13, v65, v65, s42
    v_bitop3_b32 v71, v4, v13, v71 bitop3:0xca
    s_waitcnt vmcnt(23)
    v_lshlrev_b32 v7, 16, v66
    v_and_b32 v8, 0xffff0000, v66
    v_lshlrev_b32 v9, 16, v67
    v_and_b32 v10, 0xffff0000, v67
    v_mul_f32 v7, 0.15915494, v7
    v_mul_f32 v8, 0.15915494, v8
    v_mul_f32 v9, 0.15915494, v9
    v_mul_f32 v10, 0.15915494, v10
    v_mul_hi_u32_u24 v14, 429497, v76
    v_lshrrev_b32 v12, 3, v80
    v_cos_f32 v7, v7
    v_lshlrev_b16 v13, 3, v80
    v_mad_i32_i24 v11, v14, s55, v76
    v_bitop3_b32 v12, v6, v13, v12 bitop3:0xca
    v_lshl_add_u32 v11, v11, 17, s40
    v_lshlrev_b16 v14, 8, v14
    v_lshrrev_b32 v13, 2, v80
    v_add_u32 v76, v12, v11
    v_bitop3_b32 v80, v5, v13, v14 bitop3:0xea
    ds_add_u32 v80, v2
    v_mul_hi_u32_u24 v14, 429497, v77
    v_lshrrev_b32 v12, 3, v81
    v_cos_f32 v8, v8
    v_lshlrev_b16 v13, 3, v81
    v_mad_i32_i24 v11, v14, s55, v77
    v_bitop3_b32 v12, v6, v13, v12 bitop3:0xca
    v_lshl_add_u32 v11, v11, 17, s40
    v_lshlrev_b16 v14, 8, v14
    v_lshrrev_b32 v13, 2, v81
    v_add_u32 v77, v12, v11
    v_bitop3_b32 v81, v5, v13, v14 bitop3:0xea
    ds_add_u32 v81, v2
    v_cvt_pk_bf16_f32 v66, v7, v8
    v_perm_b32 v12, v66, v66, s41
    v_bitop3_b32 v76, v4, v12, v76 bitop3:0xca
    v_perm_b32 v13, v66, v66, s42
    v_bitop3_b32 v77, v4, v13, v77 bitop3:0xca
    v_mul_hi_u32_u24 v14, 429497, v78
    v_lshrrev_b32 v12, 3, v82
    v_cos_f32 v9, v9
    v_lshlrev_b16 v13, 3, v82
    v_mad_i32_i24 v11, v14, s55, v78
    v_bitop3_b32 v12, v6, v13, v12 bitop3:0xca
    v_lshl_add_u32 v11, v11, 17, s40
    v_lshlrev_b16 v14, 8, v14
    v_lshrrev_b32 v13, 2, v82
    v_add_u32 v78, v12, v11
    v_bitop3_b32 v82, v5, v13, v14 bitop3:0xea
    ds_add_u32 v82, v2
    v_mul_hi_u32_u24 v14, 429497, v79
    v_lshrrev_b32 v12, 3, v83
    v_cos_f32 v10, v10
    v_lshlrev_b16 v13, 3, v83
    v_mad_i32_i24 v11, v14, s55, v79
    v_bitop3_b32 v12, v6, v13, v12 bitop3:0xca
    v_lshl_add_u32 v11, v11, 17, s40
    v_lshlrev_b16 v14, 8, v14
    v_lshrrev_b32 v13, 2, v83
    v_add_u32 v79, v12, v11
    v_bitop3_b32 v83, v5, v13, v14 bitop3:0xea
    ds_add_u32 v83, v2
    v_cvt_pk_bf16_f32 v67, v9, v10
    v_perm_b32 v12, v67, v67, s41
    v_bitop3_b32 v78, v4, v12, v78 bitop3:0xca
    v_perm_b32 v13, v67, v67, s42
    v_bitop3_b32 v79, v4, v13, v79 bitop3:0xca
    s_setprio 2
    s_waitcnt vmcnt(18)
    v_lshlrev_b32 v7, 16, v88
    v_and_b32 v8, 0xffff0000, v88
    v_lshlrev_b32 v9, 16, v89
    v_and_b32 v10, 0xffff0000, v89
    v_mul_f32 v7, 0.15915494, v7
    v_mul_f32 v8, 0.15915494, v8
    v_mul_f32 v9, 0.15915494, v9
    v_mul_f32 v10, 0.15915494, v10
    v_mul_hi_u32_u24 v14, 429497, v96
    v_lshrrev_b32 v12, 3, v104
    v_cos_f32 v7, v7
    v_lshlrev_b16 v13, 3, v104
    v_mad_i32_i24 v11, v14, s55, v96
    v_bitop3_b32 v12, v6, v13, v12 bitop3:0xca
    v_lshl_add_u32 v11, v11, 17, s40
    v_lshlrev_b16 v14, 8, v14
    v_lshrrev_b32 v13, 2, v104
    v_add_u32 v96, v12, v11
    v_bitop3_b32 v104, v5, v13, v14 bitop3:0xea
    ds_add_u32 v104, v2
    v_mul_hi_u32_u24 v14, 429497, v97
    v_lshrrev_b32 v12, 3, v105
    v_cos_f32 v8, v8
    v_lshlrev_b16 v13, 3, v105
    v_mad_i32_i24 v11, v14, s55, v97
    v_bitop3_b32 v12, v6, v13, v12 bitop3:0xca
    v_lshl_add_u32 v11, v11, 17, s40
    v_lshlrev_b16 v14, 8, v14
    v_lshrrev_b32 v13, 2, v105
    v_add_u32 v97, v12, v11
    v_bitop3_b32 v105, v5, v13, v14 bitop3:0xea
    ds_add_u32 v105, v2
    v_cvt_pk_bf16_f32 v88, v7, v8
    v_perm_b32 v12, v88, v88, s41
    v_bitop3_b32 v96, v4, v12, v96 bitop3:0xca
    v_perm_b32 v13, v88, v88, s42
    v_bitop3_b32 v97, v4, v13, v97 bitop3:0xca
    v_mul_hi_u32_u24 v14, 429497, v98
    v_lshrrev_b32 v12, 3, v106
    v_cos_f32 v9, v9
    v_lshlrev_b16 v13, 3, v106
    v_mad_i32_i24 v11, v14, s55, v98
    v_bitop3_b32 v12, v6, v13, v12 bitop3:0xca
    v_lshl_add_u32 v11, v11, 17, s40
    v_lshlrev_b16 v14, 8, v14
    v_lshrrev_b32 v13, 2, v106
    v_add_u32 v98, v12, v11
    v_bitop3_b32 v106, v5, v13, v14 bitop3:0xea
    ds_add_u32 v106, v2
    v_mul_hi_u32_u24 v14, 429497, v99
    v_lshrrev_b32 v12, 3, v107
    v_cos_f32 v10, v10
    v_lshlrev_b16 v13, 3, v107
    v_mad_i32_i24 v11, v14, s55, v99
    v_bitop3_b32 v12, v6, v13, v12 bitop3:0xca
    v_lshl_add_u32 v11, v11, 17, s40
    v_lshlrev_b16 v14, 8, v14
    v_lshrrev_b32 v13, 2, v107
    v_add_u32 v99, v12, v11
    v_bitop3_b32 v107, v5, v13, v14 bitop3:0xea
    ds_add_u32 v107, v2
    v_cvt_pk_bf16_f32 v89, v9, v10
    v_perm_b32 v12, v89, v89, s41
    v_bitop3_b32 v98, v4, v12, v98 bitop3:0xca
    v_perm_b32 v13, v89, v89, s42
    v_bitop3_b32 v99, v4, v13, v99 bitop3:0xca
    s_add_u32 s46, s35, 0x2a44000
    s_add_u32 s46, s46, s85
    buffer_store_dwordx4 v[40:43], v0, s[20:23], s46 offen sc1
    s_add_u32 s47, s96, 0x6000000
    s_nop 0
    v_lshlrev_b32 v40, 1, v1
    buffer_load_dwordx4 v[40:43], v40, s[8:11], s47 offen nt
    s_waitcnt vmcnt(17)
    v_lshlrev_b32 v7, 16, v90
    v_and_b32 v8, 0xffff0000, v90
    v_lshlrev_b32 v9, 16, v91
    v_and_b32 v10, 0xffff0000, v91
    v_mul_f32 v7, 0.15915494, v7
    v_mul_f32 v8, 0.15915494, v8
    v_mul_f32 v9, 0.15915494, v9
    v_mul_f32 v10, 0.15915494, v10
    v_mul_hi_u32_u24 v14, 429497, v100
    v_lshrrev_b32 v12, 3, v112
    v_cos_f32 v7, v7
    v_lshlrev_b16 v13, 3, v112
    v_mad_i32_i24 v11, v14, s55, v100
    v_bitop3_b32 v12, v6, v13, v12 bitop3:0xca
    v_lshl_add_u32 v11, v11, 17, s40
    v_lshlrev_b16 v14, 8, v14
    v_lshrrev_b32 v13, 2, v112
    v_add_u32 v100, v12, v11
    v_bitop3_b32 v112, v5, v13, v14 bitop3:0xea
    ds_add_u32 v112, v2
    v_mul_hi_u32_u24 v14, 429497, v101
    v_lshrrev_b32 v12, 3, v113
    v_cos_f32 v8, v8
    v_lshlrev_b16 v13, 3, v113
    v_mad_i32_i24 v11, v14, s55, v101
    v_bitop3_b32 v12, v6, v13, v12 bitop3:0xca
    v_lshl_add_u32 v11, v11, 17, s40
    v_lshlrev_b16 v14, 8, v14
    v_lshrrev_b32 v13, 2, v113
    v_add_u32 v101, v12, v11
    v_bitop3_b32 v113, v5, v13, v14 bitop3:0xea
    ds_add_u32 v113, v2
    v_cvt_pk_bf16_f32 v90, v7, v8
    v_perm_b32 v12, v90, v90, s41
    v_bitop3_b32 v100, v4, v12, v100 bitop3:0xca
    v_perm_b32 v13, v90, v90, s42
    v_bitop3_b32 v101, v4, v13, v101 bitop3:0xca
    v_mul_hi_u32_u24 v14, 429497, v102
    v_lshrrev_b32 v12, 3, v114
    v_cos_f32 v9, v9
    v_lshlrev_b16 v13, 3, v114
    v_mad_i32_i24 v11, v14, s55, v102
    v_bitop3_b32 v12, v6, v13, v12 bitop3:0xca
    v_lshl_add_u32 v11, v11, 17, s40
    v_lshlrev_b16 v14, 8, v14
    v_lshrrev_b32 v13, 2, v114
    v_add_u32 v102, v12, v11
    v_bitop3_b32 v114, v5, v13, v14 bitop3:0xea
    ds_add_u32 v114, v2
    v_mul_hi_u32_u24 v14, 429497, v103
    v_lshrrev_b32 v12, 3, v115
    v_cos_f32 v10, v10
    v_lshlrev_b16 v13, 3, v115
    v_mad_i32_i24 v11, v14, s55, v103
    v_bitop3_b32 v12, v6, v13, v12 bitop3:0xca
    v_lshl_add_u32 v11, v11, 17, s40
    v_lshlrev_b16 v14, 8, v14
    v_lshrrev_b32 v13, 2, v115
    v_add_u32 v103, v12, v11
    v_bitop3_b32 v115, v5, v13, v14 bitop3:0xea
    ds_add_u32 v115, v2
    v_cvt_pk_bf16_f32 v91, v9, v10
    v_perm_b32 v12, v91, v91, s41
    v_bitop3_b32 v102, v4, v12, v102 bitop3:0xca
    v_perm_b32 v13, v91, v91, s42
    v_bitop3_b32 v103, v4, v13, v103 bitop3:0xca
    s_setprio 1
    s_waitcnt vmcnt(13)
    v_lshlrev_b32 v7, 16, v120
    v_and_b32 v8, 0xffff0000, v120
    v_lshlrev_b32 v9, 16, v121
    v_and_b32 v10, 0xffff0000, v121
    v_mul_f32 v7, 0.15915494, v7
    v_mul_f32 v8, 0.15915494, v8
    v_mul_f32 v9, 0.15915494, v9
    v_mul_f32 v10, 0.15915494, v10
    v_mul_hi_u32_u24 v14, 429497, v108
    v_lshrrev_b32 v12, 3, v116
    v_cos_f32 v7, v7
    v_lshlrev_b16 v13, 3, v116
    v_mad_i32_i24 v11, v14, s55, v108
    v_bitop3_b32 v12, v6, v13, v12 bitop3:0xca
    v_lshl_add_u32 v11, v11, 17, s40
    v_lshlrev_b16 v14, 8, v14
    v_lshrrev_b32 v13, 2, v116
    v_add_u32 v108, v12, v11
    v_bitop3_b32 v116, v5, v13, v14 bitop3:0xea
    ds_add_u32 v116, v2
    v_mul_hi_u32_u24 v14, 429497, v109
    v_lshrrev_b32 v12, 3, v117
    v_cos_f32 v8, v8
    v_lshlrev_b16 v13, 3, v117
    v_mad_i32_i24 v11, v14, s55, v109
    v_bitop3_b32 v12, v6, v13, v12 bitop3:0xca
    v_lshl_add_u32 v11, v11, 17, s40
    v_lshlrev_b16 v14, 8, v14
    v_lshrrev_b32 v13, 2, v117
    v_add_u32 v109, v12, v11
    v_bitop3_b32 v117, v5, v13, v14 bitop3:0xea
    ds_add_u32 v117, v2
    v_cvt_pk_bf16_f32 v120, v7, v8
    v_perm_b32 v12, v120, v120, s41
    v_bitop3_b32 v108, v4, v12, v108 bitop3:0xca
    v_perm_b32 v13, v120, v120, s42
    v_bitop3_b32 v109, v4, v13, v109 bitop3:0xca
    v_mul_hi_u32_u24 v14, 429497, v110
    v_lshrrev_b32 v12, 3, v118
    v_cos_f32 v9, v9
    v_lshlrev_b16 v13, 3, v118
    v_mad_i32_i24 v11, v14, s55, v110
    v_bitop3_b32 v12, v6, v13, v12 bitop3:0xca
    v_lshl_add_u32 v11, v11, 17, s40
    v_lshlrev_b16 v14, 8, v14
    v_lshrrev_b32 v13, 2, v118
    v_add_u32 v110, v12, v11
    v_bitop3_b32 v118, v5, v13, v14 bitop3:0xea
    ds_add_u32 v118, v2
    v_mul_hi_u32_u24 v14, 429497, v111
    v_lshrrev_b32 v12, 3, v119
    v_cos_f32 v10, v10
    v_lshlrev_b16 v13, 3, v119
    v_mad_i32_i24 v11, v14, s55, v111
    v_bitop3_b32 v12, v6, v13, v12 bitop3:0xca
    v_lshl_add_u32 v11, v11, 17, s40
    v_lshlrev_b16 v14, 8, v14
    v_lshrrev_b32 v13, 2, v119
    v_add_u32 v111, v12, v11
    v_bitop3_b32 v119, v5, v13, v14 bitop3:0xea
    ds_add_u32 v119, v2
    v_cvt_pk_bf16_f32 v121, v9, v10
    v_perm_b32 v12, v121, v121, s41
    v_bitop3_b32 v110, v4, v12, v110 bitop3:0xca
    v_perm_b32 v13, v121, v121, s42
    v_bitop3_b32 v111, v4, v13, v111 bitop3:0xca
    s_waitcnt vmcnt(10)
    v_lshlrev_b32 v7, 16, v122
    v_and_b32 v8, 0xffff0000, v122
    v_lshlrev_b32 v9, 16, v123
    v_and_b32 v10, 0xffff0000, v123
    v_mul_f32 v7, 0.15915494, v7
    v_mul_f32 v8, 0.15915494, v8
    v_mul_f32 v9, 0.15915494, v9
    v_mul_f32 v10, 0.15915494, v10
    v_mul_hi_u32_u24 v14, 429497, v92
    v_lshrrev_b32 v12, 3, v16
    v_cos_f32 v7, v7
    v_lshlrev_b16 v13, 3, v16
    v_mad_i32_i24 v11, v14, s55, v92
    v_bitop3_b32 v12, v6, v13, v12 bitop3:0xca
    v_lshl_add_u32 v11, v11, 17, s40
    v_lshlrev_b16 v14, 8, v14
    v_lshrrev_b32 v13, 2, v16
    v_add_u32 v92, v12, v11
    v_bitop3_b32 v16, v5, v13, v14 bitop3:0xea
    ds_add_u32 v16, v2
    v_mul_hi_u32_u24 v14, 429497, v93
    v_lshrrev_b32 v12, 3, v17
    v_cos_f32 v8, v8
    v_lshlrev_b16 v13, 3, v17
    v_mad_i32_i24 v11, v14, s55, v93
    v_bitop3_b32 v12, v6, v13, v12 bitop3:0xca
    v_lshl_add_u32 v11, v11, 17, s40
    v_lshlrev_b16 v14, 8, v14
    v_lshrrev_b32 v13, 2, v17
    v_add_u32 v93, v12, v11
    v_bitop3_b32 v17, v5, v13, v14 bitop3:0xea
    ds_add_u32 v17, v2
    v_cvt_pk_bf16_f32 v122, v7, v8
    v_perm_b32 v12, v122, v122, s41
    v_bitop3_b32 v92, v4, v12, v92 bitop3:0xca
    v_perm_b32 v13, v122, v122, s42
    v_bitop3_b32 v93, v4, v13, v93 bitop3:0xca
    v_mul_hi_u32_u24 v14, 429497, v94
    v_lshrrev_b32 v12, 3, v18
    v_cos_f32 v9, v9
    v_lshlrev_b16 v13, 3, v18
    v_mad_i32_i24 v11, v14, s55, v94
    v_bitop3_b32 v12, v6, v13, v12 bitop3:0xca
    v_lshl_add_u32 v11, v11, 17, s40
    v_lshlrev_b16 v14, 8, v14
    v_lshrrev_b32 v13, 2, v18
    v_add_u32 v94, v12, v11
    v_bitop3_b32 v18, v5, v13, v14 bitop3:0xea
    ds_add_u32 v18, v2
    v_mul_hi_u32_u24 v14, 429497, v95
    v_lshrrev_b32 v12, 3, v19
    v_cos_f32 v10, v10
    v_lshlrev_b16 v13, 3, v19
    v_mad_i32_i24 v11, v14, s55, v95
    v_bitop3_b32 v12, v6, v13, v12 bitop3:0xca
    v_lshl_add_u32 v11, v11, 17, s40
    v_lshlrev_b16 v14, 8, v14
    v_lshrrev_b32 v13, 2, v19
    v_add_u32 v95, v12, v11
    v_bitop3_b32 v19, v5, v13, v14 bitop3:0xea
    ds_add_u32 v19, v2
    v_cvt_pk_bf16_f32 v123, v9, v10
    v_perm_b32 v12, v123, v123, s41
    v_bitop3_b32 v94, v4, v12, v94 bitop3:0xca
    v_perm_b32 v13, v123, v123, s42
    v_bitop3_b32 v95, v4, v13, v95 bitop3:0xca
    s_setprio 0
    s_add_u32 s44, s35, 0x2a44000
    s_add_u32 s44, s44, s91
    buffer_store_dwordx4 v[24:27], v0, s[20:23], s44 offen sc1
    s_add_u32 s45, s96, 0x6000000
    s_nop 0
    v_lshlrev_b32 v24, 1, v1
    buffer_load_dwordx4 v[24:27], v24, s[12:15], s45 offen nt
    s_waitcnt vmcnt(8)
    v_lshlrev_b32 v7, 16, v28
    v_and_b32 v8, 0xffff0000, v28
    v_lshlrev_b32 v9, 16, v29
    v_and_b32 v10, 0xffff0000, v29
    v_mul_f32 v7, 0.15915494, v7
    v_mul_f32 v8, 0.15915494, v8
    v_mul_f32 v9, 0.15915494, v9
    v_mul_f32 v10, 0.15915494, v10
    v_mul_hi_u32_u24 v14, 429497, v20
    v_lshrrev_b32 v12, 3, v124
    v_cos_f32 v7, v7
    v_lshlrev_b16 v13, 3, v124
    v_mad_i32_i24 v11, v14, s55, v20
    v_bitop3_b32 v12, v6, v13, v12 bitop3:0xca
    v_lshl_add_u32 v11, v11, 17, s40
    v_lshlrev_b16 v14, 8, v14
    v_lshrrev_b32 v13, 2, v124
    v_add_u32 v20, v12, v11
    v_bitop3_b32 v124, v5, v13, v14 bitop3:0xea
    ds_add_u32 v124, v2
    v_mul_hi_u32_u24 v14, 429497, v21
    v_lshrrev_b32 v12, 3, v125
    v_cos_f32 v8, v8
    v_lshlrev_b16 v13, 3, v125
    v_mad_i32_i24 v11, v14, s55, v21
    v_bitop3_b32 v12, v6, v13, v12 bitop3:0xca
    v_lshl_add_u32 v11, v11, 17, s40
    v_lshlrev_b16 v14, 8, v14
    v_lshrrev_b32 v13, 2, v125
    v_add_u32 v21, v12, v11
    v_bitop3_b32 v125, v5, v13, v14 bitop3:0xea
    ds_add_u32 v125, v2
    v_cvt_pk_bf16_f32 v28, v7, v8
    v_perm_b32 v12, v28, v28, s41
    v_bitop3_b32 v20, v4, v12, v20 bitop3:0xca
    v_perm_b32 v13, v28, v28, s42
    v_bitop3_b32 v21, v4, v13, v21 bitop3:0xca
    v_mul_hi_u32_u24 v14, 429497, v22
    v_lshrrev_b32 v12, 3, v126
    v_cos_f32 v9, v9
    v_lshlrev_b16 v13, 3, v126
    v_mad_i32_i24 v11, v14, s55, v22
    v_bitop3_b32 v12, v6, v13, v12 bitop3:0xca
    v_lshl_add_u32 v11, v11, 17, s40
    v_lshlrev_b16 v14, 8, v14
    v_lshrrev_b32 v13, 2, v126
    v_add_u32 v22, v12, v11
    v_bitop3_b32 v126, v5, v13, v14 bitop3:0xea
    ds_add_u32 v126, v2
    v_mul_hi_u32_u24 v14, 429497, v23
    v_lshrrev_b32 v12, 3, v127
    v_cos_f32 v10, v10
    v_lshlrev_b16 v13, 3, v127
    v_mad_i32_i24 v11, v14, s55, v23
    v_bitop3_b32 v12, v6, v13, v12 bitop3:0xca
    v_lshl_add_u32 v11, v11, 17, s40
    v_lshlrev_b16 v14, 8, v14
    v_lshrrev_b32 v13, 2, v127
    v_add_u32 v23, v12, v11
    v_bitop3_b32 v127, v5, v13, v14 bitop3:0xea
    ds_add_u32 v127, v2
    v_cvt_pk_bf16_f32 v29, v9, v10
    v_perm_b32 v12, v29, v29, s41
    v_bitop3_b32 v22, v4, v12, v22 bitop3:0xca
    v_perm_b32 v13, v29, v29, s42
    v_bitop3_b32 v23, v4, v13, v23 bitop3:0xca
    s_waitcnt vmcnt(4)
    v_lshlrev_b32 v7, 16, v30
    v_and_b32 v8, 0xffff0000, v30
    v_lshlrev_b32 v9, 16, v31
    v_and_b32 v10, 0xffff0000, v31
    v_mul_f32 v7, 0.15915494, v7
    v_mul_f32 v8, 0.15915494, v8
    v_mul_f32 v9, 0.15915494, v9
    v_mul_f32 v10, 0.15915494, v10
    v_mul_hi_u32_u24 v14, 429497, v32
    v_lshrrev_b32 v12, 3, v36
    v_cos_f32 v7, v7
    v_lshlrev_b16 v13, 3, v36
    v_mad_i32_i24 v11, v14, s55, v32
    v_bitop3_b32 v12, v6, v13, v12 bitop3:0xca
    v_lshl_add_u32 v11, v11, 17, s40
    v_lshlrev_b16 v14, 8, v14
    v_lshrrev_b32 v13, 2, v36
    v_add_u32 v32, v12, v11
    v_bitop3_b32 v36, v5, v13, v14 bitop3:0xea
    ds_add_u32 v36, v2
    v_mul_hi_u32_u24 v14, 429497, v33
    v_lshrrev_b32 v12, 3, v37
    v_cos_f32 v8, v8
    v_lshlrev_b16 v13, 3, v37
    v_mad_i32_i24 v11, v14, s55, v33
    v_bitop3_b32 v12, v6, v13, v12 bitop3:0xca
    v_lshl_add_u32 v11, v11, 17, s40
    v_lshlrev_b16 v14, 8, v14
    v_lshrrev_b32 v13, 2, v37
    v_add_u32 v33, v12, v11
    v_bitop3_b32 v37, v5, v13, v14 bitop3:0xea
    ds_add_u32 v37, v2
    v_cvt_pk_bf16_f32 v30, v7, v8
    v_perm_b32 v12, v30, v30, s41
    v_bitop3_b32 v32, v4, v12, v32 bitop3:0xca
    v_perm_b32 v13, v30, v30, s42
    v_bitop3_b32 v33, v4, v13, v33 bitop3:0xca
    v_mul_hi_u32_u24 v14, 429497, v34
    v_lshrrev_b32 v12, 3, v38
    v_cos_f32 v9, v9
    v_lshlrev_b16 v13, 3, v38
    v_mad_i32_i24 v11, v14, s55, v34
    v_bitop3_b32 v12, v6, v13, v12 bitop3:0xca
    v_lshl_add_u32 v11, v11, 17, s40
    v_lshlrev_b16 v14, 8, v14
    v_lshrrev_b32 v13, 2, v38
    v_add_u32 v34, v12, v11
    v_bitop3_b32 v38, v5, v13, v14 bitop3:0xea
    ds_add_u32 v38, v2
    v_mul_hi_u32_u24 v14, 429497, v35
    v_lshrrev_b32 v12, 3, v39
    v_cos_f32 v10, v10
    v_lshlrev_b16 v13, 3, v39
    v_mad_i32_i24 v11, v14, s55, v35
    v_bitop3_b32 v12, v6, v13, v12 bitop3:0xca
    v_lshl_add_u32 v11, v11, 17, s40
    v_lshlrev_b16 v14, 8, v14
    v_lshrrev_b32 v13, 2, v39
    v_add_u32 v35, v12, v11
    v_bitop3_b32 v39, v5, v13, v14 bitop3:0xea
    ds_add_u32 v39, v2
    v_cvt_pk_bf16_f32 v31, v9, v10
    v_perm_b32 v12, v31, v31, s41
    v_bitop3_b32 v34, v4, v12, v34 bitop3:0xca
    v_perm_b32 v13, v31, v31, s42
    v_bitop3_b32 v35, v4, v13, v35 bitop3:0xca
    v_lshrrev_b32 v8, 2, v0
    v_and_b32 v7, 0x3c00, v0
    v_bitop3_b32 v7, v5, v8, v7 bitop3:0xea
    s_waitcnt lgkmcnt(0)
    s_barrier
    ds_read2st64_b32 v[8:9], v7 offset0:0 offset1:1
    ds_read2st64_b32 v[10:11], v7 offset0:2 offset1:3
    s_add_u32 s46, s35, 0x2a44000
    s_add_u32 s46, s46, s93
    buffer_store_dwordx4 v[84:87], v0, s[20:23], s46 offen sc1
    s_add_u32 s47, s96, 0x6000000
    s_lshr_b32 s47, s47, 1
    buffer_load_dwordx2 v[84:85], v1, s[16:19], s47 offen nt
    s_add_u32 s44, s97, 0x6400000
    s_lshr_b32 s44, s44, 1
    buffer_load_dwordx2 v[86:87], v1, s[16:19], s44 offen nt
    s_waitcnt lgkmcnt(0)
    v_lshl_or_b32 v12, v9, 16, v8
    v_lshl_or_b32 v13, v11, 16, v10
    v_mov_b32 v14, v12
    v_mov_b32 v15, v13
    s_nop 0
    v_add_u32_dpp v14, v14, v14 row_shr:1 row_mask:0xf bank_mask:0xf bound_ctrl:1
    v_add_u32_dpp v15, v15, v15 row_shr:1 row_mask:0xf bank_mask:0xf bound_ctrl:1
    s_nop 0
    v_add_u32_dpp v14, v14, v14 row_shr:2 row_mask:0xf bank_mask:0xf bound_ctrl:1
    v_add_u32_dpp v15, v15, v15 row_shr:2 row_mask:0xf bank_mask:0xf bound_ctrl:1
    s_nop 0
    v_add_u32_dpp v14, v14, v14 row_shr:4 row_mask:0xf bank_mask:0xf bound_ctrl:1
    v_add_u32_dpp v15, v15, v15 row_shr:4 row_mask:0xf bank_mask:0xf bound_ctrl:1
    s_nop 0
    v_add_u32_dpp v14, v14, v14 row_shr:8 row_mask:0xf bank_mask:0xf bound_ctrl:1
    v_add_u32_dpp v15, v15, v15 row_shr:8 row_mask:0xf bank_mask:0xf bound_ctrl:1
    s_nop 0
    v_add_u32_dpp v14, v14, v14 row_bcast:15 row_mask:0xa bank_mask:0xf
    v_add_u32_dpp v15, v15, v15 row_bcast:15 row_mask:0xa bank_mask:0xf
    s_nop 0
    v_add_u32_dpp v14, v14, v14 row_bcast:31 row_mask:0xc bank_mask:0xf
    v_add_u32_dpp v15, v15, v15 row_bcast:31 row_mask:0xc bank_mask:0xf
    v_readlane_b32 s48, v14, 63
    v_readlane_b32 s49, v15, 63
    s_lshl_b32 s54, s32, 2
    v_mov_b32 v8, s54
    s_and_b32 s50, s48, 0xffff
    s_lshr_b32 s51, s48, 16
    s_and_b32 s52, s49, 0xffff
    s_lshr_b32 s53, s49, 16
    s_add_u32 s51, s51, s50
    s_add_u32 s52, s52, s51
    s_add_u32 s53, s53, s52
    v_mov_b32 v9, s53
    s_mov_b64 exec, 1
    ds_write_b32 v8, v9 offset:16384
    s_mov_b64 exec, -1
    v_and_b32 v8, 60, v7
    s_waitcnt lgkmcnt(0)
    s_barrier
    ds_read_b32 v9, v8 offset:16384
    s_waitcnt lgkmcnt(0)
    v_add_u32_dpp v9, v9, v9 row_shr:1 row_mask:0xf bank_mask:0xf bound_ctrl:1
    s_nop 1
    v_add_u32_dpp v9, v9, v9 row_shr:2 row_mask:0xf bank_mask:0xf bound_ctrl:1
    s_nop 1
    v_add_u32_dpp v9, v9, v9 row_shr:4 row_mask:0xf bank_mask:0xf bound_ctrl:1
    s_nop 1
    v_add_u32_dpp v9, v9, v9 row_shr:8 row_mask:0xf bank_mask:0xf bound_ctrl:1
    s_nop 0
    v_readlane_b32 s54, v9, s32
    s_sub_u32 s54, s54, s53
    s_add_u32 s50, s50, s54
    s_add_u32 s51, s51, s54
    s_add_u32 s52, s52, s54
    s_pack_ll_b32_b16 s48, s54, s50
    s_pack_ll_b32_b16 s49, s51, s52
    v_add_u32 v14, s48, v14
    v_add_u32 v15, s49, v15
    v_sub_u32 v12, v14, v12
    v_sub_u32 v13, v15, v13
    v_and_b32 v8, 0xffff, v12
    v_lshrrev_b32 v9, 16, v12
    v_and_b32 v10, 0xffff, v13
    v_lshrrev_b32 v11, 16, v13
    ds_write2st64_b32 v7, v8, v9 offset0:0 offset1:1
    ds_write2st64_b32 v7, v10, v11 offset0:2 offset1:3
    v_and_b32 v8, 0x3f0, v0
    v_lshl_add_u32 v8, v8, 1, s36
    ds_write_b64 v8, v[12:13] offset:20480
    s_bitset0_b64 exec, 63
    s_not_b64 exec, exec
    ds_write_b64 v8, v[14:15] offset:20512
    s_mov_b64 exec, -1
    s_waitcnt lgkmcnt(0)
    s_barrier
    s_setprio 3
    ds_add_rtn_u32 v72, v72, v2
    ds_add_rtn_u32 v73, v73, v2
    ds_add_rtn_u32 v74, v74, v2
    ds_add_rtn_u32 v75, v75, v2
    ds_read_b128 v[12:15], v0 offset:20480
    v_cmp_gt_u32 vcc, 8448, v0
    ds_add_rtn_u32 v80, v80, v2
    ds_add_rtn_u32 v81, v81, v2
    ds_add_rtn_u32 v82, v82, v2
    ds_add_rtn_u32 v83, v83, v2
    s_setprio 2
    ds_add_rtn_u32 v104, v104, v2
    ds_add_rtn_u32 v105, v105, v2
    ds_add_rtn_u32 v106, v106, v2
    ds_add_rtn_u32 v107, v107, v2
    s_waitcnt lgkmcnt(8)
    s_cbranch_vccz L1_p3
    s_add_u32 s45, s35, 0x5480000
    s_mov_b64 exec, vcc
    buffer_store_dwordx4 v[12:15], v0, s[24:27], s45 offen sc1
    s_mov_b64 exec, -1
L1_p3:
    s_add_u32 s46, s35, 0x2a48000
    s_add_u32 s46, s46, s72
    buffer_store_dwordx4 v[48:51], v0, s[20:23], s46 offen sc1
    s_add_u32 s47, s97, 0x6400000
    s_nop 0
    v_lshlrev_b32 v48, 1, v1
    buffer_load_dwordx4 v[48:51], v48, s[8:11], s47 offen nt
    ds_add_rtn_u32 v112, v112, v2
    ds_add_rtn_u32 v113, v113, v2
    ds_add_rtn_u32 v114, v114, v2
    ds_add_rtn_u32 v115, v115, v2
    s_setprio 1
    ds_add_rtn_u32 v116, v116, v2
    ds_add_rtn_u32 v117, v117, v2
    ds_add_rtn_u32 v118, v118, v2
    ds_add_rtn_u32 v119, v119, v2
    ds_add_rtn_u32 v16, v16, v2
    ds_add_rtn_u32 v17, v17, v2
    ds_add_rtn_u32 v18, v18, v2
    ds_add_rtn_u32 v19, v19, v2
    s_add_u32 s44, s35, 0x2a48000
    s_add_u32 s44, s44, s73
    buffer_store_dwordx4 v[52:55], v0, s[20:23], s44 offen sc1
    s_add_u32 s45, s97, 0x6400000
    s_nop 0
    v_lshlrev_b32 v52, 1, v1
    buffer_load_dwordx4 v[52:55], v52, s[12:15], s45 offen nt
    s_setprio 0
    ds_add_rtn_u32 v124, v124, v2
    ds_add_rtn_u32 v125, v125, v2
    ds_add_rtn_u32 v126, v126, v2
    ds_add_rtn_u32 v127, v127, v2
    ds_add_rtn_u32 v36, v36, v2
    ds_add_rtn_u32 v37, v37, v2
    ds_add_rtn_u32 v38, v38, v2
    ds_add_rtn_u32 v39, v39, v2
    s_waitcnt lgkmcnt(0)
    s_barrier
    s_setprio 3
    v_and_b32 v7, -4, v72
    v_lshl_add_u32 v8, v72, 2, v7
    ds_write_b32 v8, v68
    v_lshl_add_u32 v7, v7, 2, v72
    ds_write_b8 v7, v64 offset:16
    v_and_b32 v9, -4, v73
    v_lshl_add_u32 v10, v73, 2, v9
    ds_write_b32 v10, v69
    v_lshl_add_u32 v9, v9, 2, v73
    ds_write_b8_d16_hi v9, v64 offset:16
    v_and_b32 v7, -4, v74
    v_lshl_add_u32 v8, v74, 2, v7
    ds_write_b32 v8, v70
    v_lshl_add_u32 v7, v7, 2, v74
    ds_write_b8 v7, v65 offset:16
    v_and_b32 v9, -4, v75
    v_lshl_add_u32 v10, v75, 2, v9
    ds_write_b32 v10, v71
    v_lshl_add_u32 v9, v9, 2, v75
    ds_write_b8_d16_hi v9, v65 offset:16
    s_add_u32 s46, s35, 0x2a48000
    s_add_u32 s46, s46, s85
    buffer_store_dwordx4 v[56:59], v0, s[20:23], s46 offen sc1
    s_add_u32 s47, s98, 0x6800000
    v_lshlrev_b32 v68, 1, v1
    buffer_load_dwordx4 v[68:71], v68, s[8:11], s47 offen nt
    s_add_u32 s44, s98, 0x6800000
    v_lshlrev_b32 v72, 1, v1
    buffer_load_dwordx4 v[72:75], v72, s[12:15], s44 offen nt
    v_and_b32 v7, -4, v80
    v_lshl_add_u32 v8, v80, 2, v7
    ds_write_b32 v8, v76
    v_lshl_add_u32 v7, v7, 2, v80
    ds_write_b8 v7, v66 offset:16
    v_and_b32 v9, -4, v81
    v_lshl_add_u32 v10, v81, 2, v9
    ds_write_b32 v10, v77
    v_lshl_add_u32 v9, v9, 2, v81
    ds_write_b8_d16_hi v9, v66 offset:16
    v_and_b32 v7, -4, v82
    v_lshl_add_u32 v8, v82, 2, v7
    ds_write_b32 v8, v78
    v_lshl_add_u32 v7, v7, 2, v82
    ds_write_b8 v7, v67 offset:16
    v_and_b32 v9, -4, v83
    v_lshl_add_u32 v10, v83, 2, v9
    ds_write_b32 v10, v79
    v_lshl_add_u32 v9, v9, 2, v83
    ds_write_b8_d16_hi v9, v67 offset:16
    s_add_u32 s45, s98, 0x6800000
    s_lshr_b32 s45, s45, 1
    buffer_load_dwordx2 v[56:57], v1, s[16:19], s45 offen nt
    s_add_u32 s46, s99, 0x6c00000
    s_lshr_b32 s46, s46, 1
    buffer_load_dwordx2 v[58:59], v1, s[16:19], s46 offen nt
    s_add_u32 s47, s99, 0x6c00000
    v_lshlrev_b32 v76, 1, v1
    buffer_load_dwordx4 v[76:79], v76, s[8:11], s47 offen nt
    s_setprio 2
    v_and_b32 v7, -4, v104
    v_lshl_add_u32 v8, v104, 2, v7
    ds_write_b32 v8, v96
    v_lshl_add_u32 v7, v7, 2, v104
    ds_write_b8 v7, v88 offset:16
    v_and_b32 v9, -4, v105
    v_lshl_add_u32 v10, v105, 2, v9
    ds_write_b32 v10, v97
    v_lshl_add_u32 v9, v9, 2, v105
    ds_write_b8_d16_hi v9, v88 offset:16
    v_and_b32 v7, -4, v106
    v_lshl_add_u32 v8, v106, 2, v7
    ds_write_b32 v8, v98
    v_lshl_add_u32 v7, v7, 2, v106
    ds_write_b8 v7, v89 offset:16
    v_and_b32 v9, -4, v107
    v_lshl_add_u32 v10, v107, 2, v9
    ds_write_b32 v10, v99
    v_lshl_add_u32 v9, v9, 2, v107
    ds_write_b8_d16_hi v9, v89 offset:16
    s_add_u32 s44, s35, 0x2a48000
    s_add_u32 s44, s44, s91
    buffer_store_dwordx4 v[60:63], v0, s[20:23], s44 offen sc1
    s_add_u32 s45, s99, 0x6c00000
    v_lshlrev_b32 v80, 1, v1
    buffer_load_dwordx4 v[80:83], v80, s[12:15], s45 offen nt
    v_and_b32 v7, -4, v112
    v_lshl_add_u32 v8, v112, 2, v7
    ds_write_b32 v8, v100
    v_lshl_add_u32 v7, v7, 2, v112
    ds_write_b8 v7, v90 offset:16
    v_and_b32 v9, -4, v113
    v_lshl_add_u32 v10, v113, 2, v9
    ds_write_b32 v10, v101
    v_lshl_add_u32 v9, v9, 2, v113
    ds_write_b8_d16_hi v9, v90 offset:16
    v_and_b32 v7, -4, v114
    v_lshl_add_u32 v8, v114, 2, v7
    ds_write_b32 v8, v102
    v_lshl_add_u32 v7, v7, 2, v114
    ds_write_b8 v7, v91 offset:16
    v_and_b32 v9, -4, v115
    v_lshl_add_u32 v10, v115, 2, v9
    ds_write_b32 v10, v103
    v_lshl_add_u32 v9, v9, 2, v115
    ds_write_b8_d16_hi v9, v91 offset:16
    s_add_u32 s46, s96, 0x7000000
    v_lshlrev_b32 v64, 1, v1
    buffer_load_dwordx4 v[64:67], v64, s[8:11], s46 offen nt
    s_add_u32 s47, s96, 0x7000000
    v_lshlrev_b32 v96, 1, v1
    buffer_load_dwordx4 v[96:99], v96, s[12:15], s47 offen nt
    s_setprio 1
    v_and_b32 v7, -4, v116
    v_lshl_add_u32 v8, v116, 2, v7
    ds_write_b32 v8, v108
    v_lshl_add_u32 v7, v7, 2, v116
    ds_write_b8 v7, v120 offset:16
    v_and_b32 v9, -4, v117
    v_lshl_add_u32 v10, v117, 2, v9
    ds_write_b32 v10, v109
    v_lshl_add_u32 v9, v9, 2, v117
    ds_write_b8_d16_hi v9, v120 offset:16
    v_and_b32 v7, -4, v118
    v_lshl_add_u32 v8, v118, 2, v7
    ds_write_b32 v8, v110
    v_lshl_add_u32 v7, v7, 2, v118
    ds_write_b8 v7, v121 offset:16
    v_and_b32 v9, -4, v119
    v_lshl_add_u32 v10, v119, 2, v9
    ds_write_b32 v10, v111
    v_lshl_add_u32 v9, v9, 2, v119
    ds_write_b8_d16_hi v9, v121 offset:16
    s_add_u32 s44, s96, 0x7000000
    s_lshr_b32 s44, s44, 1
    buffer_load_dwordx2 v[104:105], v1, s[16:19], s44 offen nt
    s_add_u32 s45, s97, 0x7400000
    s_lshr_b32 s45, s45, 1
    buffer_load_dwordx2 v[106:107], v1, s[16:19], s45 offen nt
    s_add_u32 s46, s97, 0x7400000
    v_lshlrev_b32 v60, 1, v1
    buffer_load_dwordx4 v[60:63], v60, s[8:11], s46 offen nt
    v_and_b32 v7, -4, v16
    v_lshl_add_u32 v8, v16, 2, v7
    ds_write_b32 v8, v92
    v_lshl_add_u32 v7, v7, 2, v16
    ds_write_b8 v7, v122 offset:16
    v_and_b32 v9, -4, v17
    v_lshl_add_u32 v10, v17, 2, v9
    ds_write_b32 v10, v93
    v_lshl_add_u32 v9, v9, 2, v17
    ds_write_b8_d16_hi v9, v122 offset:16
    v_and_b32 v7, -4, v18
    v_lshl_add_u32 v8, v18, 2, v7
    ds_write_b32 v8, v94
    v_lshl_add_u32 v7, v7, 2, v18
    ds_write_b8 v7, v123 offset:16
    v_and_b32 v9, -4, v19
    v_lshl_add_u32 v10, v19, 2, v9
    ds_write_b32 v10, v95
    v_lshl_add_u32 v9, v9, 2, v19
    ds_write_b8_d16_hi v9, v123 offset:16
    s_add_u32 s47, s35, 0x2a48000
    s_add_u32 s47, s47, s93
    buffer_store_dwordx4 v[44:47], v0, s[20:23], s47 offen sc1
    s_add_u32 s44, s97, 0x7400000
    v_lshlrev_b32 v100, 1, v1
    buffer_load_dwordx4 v[100:103], v100, s[12:15], s44 offen nt
    s_setprio 0
    v_and_b32 v7, -4, v124
    v_lshl_add_u32 v8, v124, 2, v7
    ds_write_b32 v8, v20
    v_lshl_add_u32 v7, v7, 2, v124
    ds_write_b8 v7, v28 offset:16
    v_and_b32 v9, -4, v125
    v_lshl_add_u32 v10, v125, 2, v9
    ds_write_b32 v10, v21
    v_lshl_add_u32 v9, v9, 2, v125
    ds_write_b8_d16_hi v9, v28 offset:16
    v_and_b32 v7, -4, v126
    v_lshl_add_u32 v8, v126, 2, v7
    ds_write_b32 v8, v22
    v_lshl_add_u32 v7, v7, 2, v126
    ds_write_b8 v7, v29 offset:16
    v_and_b32 v9, -4, v127
    v_lshl_add_u32 v10, v127, 2, v9
    ds_write_b32 v10, v23
    v_lshl_add_u32 v9, v9, 2, v127
    ds_write_b8_d16_hi v9, v29 offset:16
    s_add_u32 s45, s98, 0x7800000
    v_lshlrev_b32 v112, 1, v1
    buffer_load_dwordx4 v[112:115], v112, s[8:11], s45 offen nt
    s_add_u32 s46, s98, 0x7800000
    v_lshlrev_b32 v88, 1, v1
    buffer_load_dwordx4 v[88:91], v88, s[12:15], s46 offen nt
    v_and_b32 v7, -4, v36
    v_lshl_add_u32 v8, v36, 2, v7
    ds_write_b32 v8, v32
    v_lshl_add_u32 v7, v7, 2, v36
    ds_write_b8 v7, v30 offset:16
    v_and_b32 v9, -4, v37
    v_lshl_add_u32 v10, v37, 2, v9
    ds_write_b32 v10, v33
    v_lshl_add_u32 v9, v9, 2, v37
    ds_write_b8_d16_hi v9, v30 offset:16
    v_and_b32 v7, -4, v38
    v_lshl_add_u32 v8, v38, 2, v7
    ds_write_b32 v8, v34
    v_lshl_add_u32 v7, v7, 2, v38
    ds_write_b8 v7, v31 offset:16
    v_and_b32 v9, -4, v39
    v_lshl_add_u32 v10, v39, 2, v9
    ds_write_b32 v10, v35
    v_lshl_add_u32 v9, v9, 2, v39
    ds_write_b8_d16_hi v9, v31 offset:16
    s_add_u32 s47, s98, 0x7800000
    s_lshr_b32 s47, s47, 1
    buffer_load_dwordx2 v[108:109], v1, s[16:19], s47 offen nt
    s_add_u32 s44, s99, 0x7c00000
    s_lshr_b32 s44, s44, 1
    buffer_load_dwordx2 v[110:111], v1, s[16:19], s44 offen nt
    v_add_u32 v7, s72, v0
    v_add_u32 v12, s73, v0
    v_add_u32 v13, s85, v0
    v_add_u32 v14, s91, v0
    v_add_u32 v15, s93, v0
    s_min_i32 s3, s72, s73
    s_min_i32 s3, s3, s85
    s_min_i32 s3, s3, s91
    s_min_i32 s3, s3, s93
    v_add_u32 v3, s3, v0
    v_mov_b32 v8, 0
    v_mov_b32 v9, 0
    v_mov_b32 v10, 0
    v_mov_b32 v11, 0
    s_waitcnt lgkmcnt(0)
    s_barrier
    ds_read_b128 v[116:119], v7 offset:0
    ds_read_b128 v[92:95], v12 offset:0
    ds_read_b128 v[16:19], v13 offset:0
    ds_read_b128 v[120:123], v14 offset:0
    ds_read_b128 v[44:47], v15 offset:0
    ds_write_b128 v3, v[8:11]
    ds_read_b128 v[20:23], v7 offset:16384
    ds_read_b128 v[124:127], v12 offset:16384
    ds_read_b128 v[32:35], v13 offset:16384
    ds_read_b128 v[36:39], v14 offset:16384
    ds_read_b128 v[28:31], v15 offset:16384
    s_waitcnt lgkmcnt(0)
    s_barrier
    s_setprio 3
    s_add_u32 s45, s35, 0x5484000
    s_add_u32 s45, s45, s72
    buffer_store_dwordx4 v[116:119], v0, s[20:23], s45 offen sc1
    s_add_u32 s46, s99, 0x7c00000
    s_nop 0
    v_lshlrev_b32 v116, 1, v1
    buffer_load_dwordx4 v[116:119], v116, s[8:11], s46 offen nt
    s_add_u32 s47, s35, 0x5484000
    s_add_u32 s47, s47, s73
    buffer_store_dwordx4 v[92:95], v0, s[20:23], s47 offen sc1
    s_add_u32 s44, s99, 0x7c00000
    s_nop 0
    v_lshlrev_b32 v92, 1, v1
    buffer_load_dwordx4 v[92:95], v92, s[12:15], s44 offen nt
    s_waitcnt vmcnt(27)
    v_lshlrev_b32 v7, 16, v84
    v_and_b32 v8, 0xffff0000, v84
    v_lshlrev_b32 v9, 16, v85
    v_and_b32 v10, 0xffff0000, v85
    v_mul_f32 v7, 0.15915494, v7
    v_mul_f32 v8, 0.15915494, v8
    v_mul_f32 v9, 0.15915494, v9
    v_mul_f32 v10, 0.15915494, v10
    v_mul_hi_u32_u24 v14, 429497, v40
    v_lshrrev_b32 v12, 3, v24
    v_cos_f32 v7, v7
    v_lshlrev_b16 v13, 3, v24
    v_mad_i32_i24 v11, v14, s55, v40
    v_bitop3_b32 v12, v6, v13, v12 bitop3:0xca
    v_lshl_add_u32 v11, v11, 17, s40
    v_lshlrev_b16 v14, 8, v14
    v_lshrrev_b32 v13, 2, v24
    v_add_u32 v40, v12, v11
    v_bitop3_b32 v24, v5, v13, v14 bitop3:0xea
    ds_add_u32 v24, v2
    v_mul_hi_u32_u24 v14, 429497, v41
    v_lshrrev_b32 v12, 3, v25
    v_cos_f32 v8, v8
    v_lshlrev_b16 v13, 3, v25
    v_mad_i32_i24 v11, v14, s55, v41
    v_bitop3_b32 v12, v6, v13, v12 bitop3:0xca
    v_lshl_add_u32 v11, v11, 17, s40
    v_lshlrev_b16 v14, 8, v14
    v_lshrrev_b32 v13, 2, v25
    v_add_u32 v41, v12, v11
    v_bitop3_b32 v25, v5, v13, v14 bitop3:0xea
    ds_add_u32 v25, v2
    v_cvt_pk_bf16_f32 v84, v7, v8
    v_perm_b32 v12, v84, v84, s41
    v_bitop3_b32 v40, v4, v12, v40 bitop3:0xca
    v_perm_b32 v13, v84, v84, s42
    v_bitop3_b32 v41, v4, v13, v41 bitop3:0xca
    v_mul_hi_u32_u24 v14, 429497, v42
    v_lshrrev_b32 v12, 3, v26
    v_cos_f32 v9, v9
    v_lshlrev_b16 v13, 3, v26
    v_mad_i32_i24 v11, v14, s55, v42
    v_bitop3_b32 v12, v6, v13, v12 bitop3:0xca
    v_lshl_add_u32 v11, v11, 17, s40
    v_lshlrev_b16 v14, 8, v14
    v_lshrrev_b32 v13, 2, v26
    v_add_u32 v42, v12, v11
    v_bitop3_b32 v26, v5, v13, v14 bitop3:0xea
    ds_add_u32 v26, v2
    v_mul_hi_u32_u24 v14, 429497, v43
    v_lshrrev_b32 v12, 3, v27
    v_cos_f32 v10, v10
    v_lshlrev_b16 v13, 3, v27
    v_mad_i32_i24 v11, v14, s55, v43
    v_bitop3_b32 v12, v6, v13, v12 bitop3:0xca
    v_lshl_add_u32 v11, v11, 17, s40
    v_lshlrev_b16 v14, 8, v14
    v_lshrrev_b32 v13, 2, v27
    v_add_u32 v43, v12, v11
    v_bitop3_b32 v27, v5, v13, v14 bitop3:0xea
    ds_add_u32 v27, v2
    v_cvt_pk_bf16_f32 v85, v9, v10
    v_perm_b32 v12, v85, v85, s41
    v_bitop3_b32 v42, v4, v12, v42 bitop3:0xca
    v_perm_b32 v13, v85, v85, s42
    v_bitop3_b32 v43, v4, v13, v43 bitop3:0xca
    s_waitcnt vmcnt(23)
    v_lshlrev_b32 v7, 16, v86
    v_and_b32 v8, 0xffff0000, v86
    v_lshlrev_b32 v9, 16, v87
    v_and_b32 v10, 0xffff0000, v87
    v_mul_f32 v7, 0.15915494, v7
    v_mul_f32 v8, 0.15915494, v8
    v_mul_f32 v9, 0.15915494, v9
    v_mul_f32 v10, 0.15915494, v10
    v_mul_hi_u32_u24 v14, 429497, v48
    v_lshrrev_b32 v12, 3, v52
    v_cos_f32 v7, v7
    v_lshlrev_b16 v13, 3, v52
    v_mad_i32_i24 v11, v14, s55, v48
    v_bitop3_b32 v12, v6, v13, v12 bitop3:0xca
    v_lshl_add_u32 v11, v11, 17, s40
    v_lshlrev_b16 v14, 8, v14
    v_lshrrev_b32 v13, 2, v52
    v_add_u32 v48, v12, v11
    v_bitop3_b32 v52, v5, v13, v14 bitop3:0xea
    ds_add_u32 v52, v2
    v_mul_hi_u32_u24 v14, 429497, v49
    v_lshrrev_b32 v12, 3, v53
    v_cos_f32 v8, v8
    v_lshlrev_b16 v13, 3, v53
    v_mad_i32_i24 v11, v14, s55, v49
    v_bitop3_b32 v12, v6, v13, v12 bitop3:0xca
    v_lshl_add_u32 v11, v11, 17, s40
    v_lshlrev_b16 v14, 8, v14
    v_lshrrev_b32 v13, 2, v53
    v_add_u32 v49, v12, v11
    v_bitop3_b32 v53, v5, v13, v14 bitop3:0xea
    ds_add_u32 v53, v2
    v_cvt_pk_bf16_f32 v86, v7, v8
    v_perm_b32 v12, v86, v86, s41
    v_bitop3_b32 v48, v4, v12, v48 bitop3:0xca
    v_perm_b32 v13, v86, v86, s42
    v_bitop3_b32 v49, v4, v13, v49 bitop3:0xca
    v_mul_hi_u32_u24 v14, 429497, v50
    v_lshrrev_b32 v12, 3, v54
    v_cos_f32 v9, v9
    v_lshlrev_b16 v13, 3, v54
    v_mad_i32_i24 v11, v14, s55, v50
    v_bitop3_b32 v12, v6, v13, v12 bitop3:0xca
    v_lshl_add_u32 v11, v11, 17, s40
    v_lshlrev_b16 v14, 8, v14
    v_lshrrev_b32 v13, 2, v54
    v_add_u32 v50, v12, v11
    v_bitop3_b32 v54, v5, v13, v14 bitop3:0xea
    ds_add_u32 v54, v2
    v_mul_hi_u32_u24 v14, 429497, v51
    v_lshrrev_b32 v12, 3, v55
    v_cos_f32 v10, v10
    v_lshlrev_b16 v13, 3, v55
    v_mad_i32_i24 v11, v14, s55, v51
    v_bitop3_b32 v12, v6, v13, v12 bitop3:0xca
    v_lshl_add_u32 v11, v11, 17, s40
    v_lshlrev_b16 v14, 8, v14
    v_lshrrev_b32 v13, 2, v55
    v_add_u32 v51, v12, v11
    v_bitop3_b32 v55, v5, v13, v14 bitop3:0xea
    ds_add_u32 v55, v2
    v_cvt_pk_bf16_f32 v87, v9, v10
    v_perm_b32 v12, v87, v87, s41
    v_bitop3_b32 v50, v4, v12, v50 bitop3:0xca
    v_perm_b32 v13, v87, v87, s42
    v_bitop3_b32 v51, v4, v13, v51 bitop3:0xca
    s_setprio 2
    s_waitcnt vmcnt(18)
    v_lshlrev_b32 v7, 16, v56
    v_and_b32 v8, 0xffff0000, v56
    v_lshlrev_b32 v9, 16, v57
    v_and_b32 v10, 0xffff0000, v57
    v_mul_f32 v7, 0.15915494, v7
    v_mul_f32 v8, 0.15915494, v8
    v_mul_f32 v9, 0.15915494, v9
    v_mul_f32 v10, 0.15915494, v10
    v_mul_hi_u32_u24 v14, 429497, v68
    v_lshrrev_b32 v12, 3, v72
    v_cos_f32 v7, v7
    v_lshlrev_b16 v13, 3, v72
    v_mad_i32_i24 v11, v14, s55, v68
    v_bitop3_b32 v12, v6, v13, v12 bitop3:0xca
    v_lshl_add_u32 v11, v11, 17, s40
    v_lshlrev_b16 v14, 8, v14
    v_lshrrev_b32 v13, 2, v72
    v_add_u32 v68, v12, v11
    v_bitop3_b32 v72, v5, v13, v14 bitop3:0xea
    ds_add_u32 v72, v2
    v_mul_hi_u32_u24 v14, 429497, v69
    v_lshrrev_b32 v12, 3, v73
    v_cos_f32 v8, v8
    v_lshlrev_b16 v13, 3, v73
    v_mad_i32_i24 v11, v14, s55, v69
    v_bitop3_b32 v12, v6, v13, v12 bitop3:0xca
    v_lshl_add_u32 v11, v11, 17, s40
    v_lshlrev_b16 v14, 8, v14
    v_lshrrev_b32 v13, 2, v73
    v_add_u32 v69, v12, v11
    v_bitop3_b32 v73, v5, v13, v14 bitop3:0xea
    ds_add_u32 v73, v2
    v_cvt_pk_bf16_f32 v56, v7, v8
    v_perm_b32 v12, v56, v56, s41
    v_bitop3_b32 v68, v4, v12, v68 bitop3:0xca
    v_perm_b32 v13, v56, v56, s42
    v_bitop3_b32 v69, v4, v13, v69 bitop3:0xca
    v_mul_hi_u32_u24 v14, 429497, v70
    v_lshrrev_b32 v12, 3, v74
    v_cos_f32 v9, v9
    v_lshlrev_b16 v13, 3, v74
    v_mad_i32_i24 v11, v14, s55, v70
    v_bitop3_b32 v12, v6, v13, v12 bitop3:0xca
    v_lshl_add_u32 v11, v11, 17, s40
    v_lshlrev_b16 v14, 8, v14
    v_lshrrev_b32 v13, 2, v74
    v_add_u32 v70, v12, v11
    v_bitop3_b32 v74, v5, v13, v14 bitop3:0xea
    ds_add_u32 v74, v2
    v_mul_hi_u32_u24 v14, 429497, v71
    v_lshrrev_b32 v12, 3, v75
    v_cos_f32 v10, v10
    v_lshlrev_b16 v13, 3, v75
    v_mad_i32_i24 v11, v14, s55, v71
    v_bitop3_b32 v12, v6, v13, v12 bitop3:0xca
    v_lshl_add_u32 v11, v11, 17, s40
    v_lshlrev_b16 v14, 8, v14
    v_lshrrev_b32 v13, 2, v75
    v_add_u32 v71, v12, v11
    v_bitop3_b32 v75, v5, v13, v14 bitop3:0xea
    ds_add_u32 v75, v2
    v_cvt_pk_bf16_f32 v57, v9, v10
    v_perm_b32 v12, v57, v57, s41
    v_bitop3_b32 v70, v4, v12, v70 bitop3:0xca
    v_perm_b32 v13, v57, v57, s42
    v_bitop3_b32 v71, v4, v13, v71 bitop3:0xca
    s_add_u32 s45, s35, 0x5484000
    s_add_u32 s45, s45, s85
    buffer_store_dwordx4 v[16:19], v0, s[20:23], s45 offen sc1
    s_add_u32 s46, s96, 0x8000000
    s_nop 0
    v_lshlrev_b32 v16, 1, v1
    buffer_load_dwordx4 v[16:19], v16, s[8:11], s46 offen nt
    s_waitcnt vmcnt(17)
    v_lshlrev_b32 v7, 16, v58
    v_and_b32 v8, 0xffff0000, v58
    v_lshlrev_b32 v9, 16, v59
    v_and_b32 v10, 0xffff0000, v59
    v_mul_f32 v7, 0.15915494, v7
    v_mul_f32 v8, 0.15915494, v8
    v_mul_f32 v9, 0.15915494, v9
    v_mul_f32 v10, 0.15915494, v10
    v_mul_hi_u32_u24 v14, 429497, v76
    v_lshrrev_b32 v12, 3, v80
    v_cos_f32 v7, v7
    v_lshlrev_b16 v13, 3, v80
    v_mad_i32_i24 v11, v14, s55, v76
    v_bitop3_b32 v12, v6, v13, v12 bitop3:0xca
    v_lshl_add_u32 v11, v11, 17, s40
    v_lshlrev_b16 v14, 8, v14
    v_lshrrev_b32 v13, 2, v80
    v_add_u32 v76, v12, v11
    v_bitop3_b32 v80, v5, v13, v14 bitop3:0xea
    ds_add_u32 v80, v2
    v_mul_hi_u32_u24 v14, 429497, v77
    v_lshrrev_b32 v12, 3, v81
    v_cos_f32 v8, v8
    v_lshlrev_b16 v13, 3, v81
    v_mad_i32_i24 v11, v14, s55, v77
    v_bitop3_b32 v12, v6, v13, v12 bitop3:0xca
    v_lshl_add_u32 v11, v11, 17, s40
    v_lshlrev_b16 v14, 8, v14
    v_lshrrev_b32 v13, 2, v81
    v_add_u32 v77, v12, v11
    v_bitop3_b32 v81, v5, v13, v14 bitop3:0xea
    ds_add_u32 v81, v2
    v_cvt_pk_bf16_f32 v58, v7, v8
    v_perm_b32 v12, v58, v58, s41
    v_bitop3_b32 v76, v4, v12, v76 bitop3:0xca
    v_perm_b32 v13, v58, v58, s42
    v_bitop3_b32 v77, v4, v13, v77 bitop3:0xca
    v_mul_hi_u32_u24 v14, 429497, v78
    v_lshrrev_b32 v12, 3, v82
    v_cos_f32 v9, v9
    v_lshlrev_b16 v13, 3, v82
    v_mad_i32_i24 v11, v14, s55, v78
    v_bitop3_b32 v12, v6, v13, v12 bitop3:0xca
    v_lshl_add_u32 v11, v11, 17, s40
    v_lshlrev_b16 v14, 8, v14
    v_lshrrev_b32 v13, 2, v82
    v_add_u32 v78, v12, v11
    v_bitop3_b32 v82, v5, v13, v14 bitop3:0xea
    ds_add_u32 v82, v2
    v_mul_hi_u32_u24 v14, 429497, v79
    v_lshrrev_b32 v12, 3, v83
    v_cos_f32 v10, v10
    v_lshlrev_b16 v13, 3, v83
    v_mad_i32_i24 v11, v14, s55, v79
    v_bitop3_b32 v12, v6, v13, v12 bitop3:0xca
    v_lshl_add_u32 v11, v11, 17, s40
    v_lshlrev_b16 v14, 8, v14
    v_lshrrev_b32 v13, 2, v83
    v_add_u32 v79, v12, v11
    v_bitop3_b32 v83, v5, v13, v14 bitop3:0xea
    ds_add_u32 v83, v2
    v_cvt_pk_bf16_f32 v59, v9, v10
    v_perm_b32 v12, v59, v59, s41
    v_bitop3_b32 v78, v4, v12, v78 bitop3:0xca
    v_perm_b32 v13, v59, v59, s42
    v_bitop3_b32 v79, v4, v13, v79 bitop3:0xca
    s_setprio 1
    s_waitcnt vmcnt(13)
    v_lshlrev_b32 v7, 16, v104
    v_and_b32 v8, 0xffff0000, v104
    v_lshlrev_b32 v9, 16, v105
    v_and_b32 v10, 0xffff0000, v105
    v_mul_f32 v7, 0.15915494, v7
    v_mul_f32 v8, 0.15915494, v8
    v_mul_f32 v9, 0.15915494, v9
    v_mul_f32 v10, 0.15915494, v10
    v_mul_hi_u32_u24 v14, 429497, v64
    v_lshrrev_b32 v12, 3, v96
    v_cos_f32 v7, v7
    v_lshlrev_b16 v13, 3, v96
    v_mad_i32_i24 v11, v14, s55, v64
    v_bitop3_b32 v12, v6, v13, v12 bitop3:0xca
    v_lshl_add_u32 v11, v11, 17, s40
    v_lshlrev_b16 v14, 8, v14
    v_lshrrev_b32 v13, 2, v96
    v_add_u32 v64, v12, v11
    v_bitop3_b32 v96, v5, v13, v14 bitop3:0xea
    ds_add_u32 v96, v2
    v_mul_hi_u32_u24 v14, 429497, v65
    v_lshrrev_b32 v12, 3, v97
    v_cos_f32 v8, v8
    v_lshlrev_b16 v13, 3, v97
    v_mad_i32_i24 v11, v14, s55, v65
    v_bitop3_b32 v12, v6, v13, v12 bitop3:0xca
    v_lshl_add_u32 v11, v11, 17, s40
    v_lshlrev_b16 v14, 8, v14
    v_lshrrev_b32 v13, 2, v97
    v_add_u32 v65, v12, v11
    v_bitop3_b32 v97, v5, v13, v14 bitop3:0xea
    ds_add_u32 v97, v2
    v_cvt_pk_bf16_f32 v104, v7, v8
    v_perm_b32 v12, v104, v104, s41
    v_bitop3_b32 v64, v4, v12, v64 bitop3:0xca
    v_perm_b32 v13, v104, v104, s42
    v_bitop3_b32 v65, v4, v13, v65 bitop3:0xca
    v_mul_hi_u32_u24 v14, 429497, v66
    v_lshrrev_b32 v12, 3, v98
    v_cos_f32 v9, v9
    v_lshlrev_b16 v13, 3, v98
    v_mad_i32_i24 v11, v14, s55, v66
    v_bitop3_b32 v12, v6, v13, v12 bitop3:0xca
    v_lshl_add_u32 v11, v11, 17, s40
    v_lshlrev_b16 v14, 8, v14
    v_lshrrev_b32 v13, 2, v98
    v_add_u32 v66, v12, v11
    v_bitop3_b32 v98, v5, v13, v14 bitop3:0xea
    ds_add_u32 v98, v2
    v_mul_hi_u32_u24 v14, 429497, v67
    v_lshrrev_b32 v12, 3, v99
    v_cos_f32 v10, v10
    v_lshlrev_b16 v13, 3, v99
    v_mad_i32_i24 v11, v14, s55, v67
    v_bitop3_b32 v12, v6, v13, v12 bitop3:0xca
    v_lshl_add_u32 v11, v11, 17, s40
    v_lshlrev_b16 v14, 8, v14
    v_lshrrev_b32 v13, 2, v99
    v_add_u32 v67, v12, v11
    v_bitop3_b32 v99, v5, v13, v14 bitop3:0xea
    ds_add_u32 v99, v2
    v_cvt_pk_bf16_f32 v105, v9, v10
    v_perm_b32 v12, v105, v105, s41
    v_bitop3_b32 v66, v4, v12, v66 bitop3:0xca
    v_perm_b32 v13, v105, v105, s42
    v_bitop3_b32 v67, v4, v13, v67 bitop3:0xca
    s_mov_b32 s68, s66
    s_mov_b32 s69, s67
    s_mov_b32 s70, 0x100
    s_mov_b32 s71, 0x20000
    v_mov_b32 v3, 1
    s_cmp_lg_u32 s32, 15
    s_cbranch_scc1 L1_tk
    s_mov_b64 exec, 1
    s_and_b32 s3, s2, 1
    s_lshl_b32 s3, s3, 7
    buffer_atomic_add v3, off, s[68:71], s3 sc0
    s_mov_b64 exec, -1
L1_tk:
    s_waitcnt vmcnt(10)
    v_lshlrev_b32 v7, 16, v106
    v_and_b32 v8, 0xffff0000, v106
    v_lshlrev_b32 v9, 16, v107
    v_and_b32 v10, 0xffff0000, v107
    v_mul_f32 v7, 0.15915494, v7
    v_mul_f32 v8, 0.15915494, v8
    v_mul_f32 v9, 0.15915494, v9
    v_mul_f32 v10, 0.15915494, v10
    v_mul_hi_u32_u24 v14, 429497, v60
    v_lshrrev_b32 v12, 3, v100
    v_cos_f32 v7, v7
    v_lshlrev_b16 v13, 3, v100
    v_mad_i32_i24 v11, v14, s55, v60
    v_bitop3_b32 v12, v6, v13, v12 bitop3:0xca
    v_lshl_add_u32 v11, v11, 17, s40
    v_lshlrev_b16 v14, 8, v14
    v_lshrrev_b32 v13, 2, v100
    v_add_u32 v60, v12, v11
    v_bitop3_b32 v100, v5, v13, v14 bitop3:0xea
    ds_add_u32 v100, v2
    v_mul_hi_u32_u24 v14, 429497, v61
    v_lshrrev_b32 v12, 3, v101
    v_cos_f32 v8, v8
    v_lshlrev_b16 v13, 3, v101
    v_mad_i32_i24 v11, v14, s55, v61
    v_bitop3_b32 v12, v6, v13, v12 bitop3:0xca
    v_lshl_add_u32 v11, v11, 17, s40
    v_lshlrev_b16 v14, 8, v14
    v_lshrrev_b32 v13, 2, v101
    v_add_u32 v61, v12, v11
    v_bitop3_b32 v101, v5, v13, v14 bitop3:0xea
    ds_add_u32 v101, v2
    v_cvt_pk_bf16_f32 v106, v7, v8
    v_perm_b32 v12, v106, v106, s41
    v_bitop3_b32 v60, v4, v12, v60 bitop3:0xca
    v_perm_b32 v13, v106, v106, s42
    v_bitop3_b32 v61, v4, v13, v61 bitop3:0xca
    v_mul_hi_u32_u24 v14, 429497, v62
    v_lshrrev_b32 v12, 3, v102
    v_cos_f32 v9, v9
    v_lshlrev_b16 v13, 3, v102
    v_mad_i32_i24 v11, v14, s55, v62
    v_bitop3_b32 v12, v6, v13, v12 bitop3:0xca
    v_lshl_add_u32 v11, v11, 17, s40
    v_lshlrev_b16 v14, 8, v14
    v_lshrrev_b32 v13, 2, v102
    v_add_u32 v62, v12, v11
    v_bitop3_b32 v102, v5, v13, v14 bitop3:0xea
    ds_add_u32 v102, v2
    v_mul_hi_u32_u24 v14, 429497, v63
    v_lshrrev_b32 v12, 3, v103
    v_cos_f32 v10, v10
    v_lshlrev_b16 v13, 3, v103
    v_mad_i32_i24 v11, v14, s55, v63
    v_bitop3_b32 v12, v6, v13, v12 bitop3:0xca
    v_lshl_add_u32 v11, v11, 17, s40
    v_lshlrev_b16 v14, 8, v14
    v_lshrrev_b32 v13, 2, v103
    v_add_u32 v63, v12, v11
    v_bitop3_b32 v103, v5, v13, v14 bitop3:0xea
    ds_add_u32 v103, v2
    v_cvt_pk_bf16_f32 v107, v9, v10
    v_perm_b32 v12, v107, v107, s41
    v_bitop3_b32 v62, v4, v12, v62 bitop3:0xca
    v_perm_b32 v13, v107, v107, s42
    v_bitop3_b32 v63, v4, v13, v63 bitop3:0xca
    s_setprio 0
    s_add_u32 s47, s35, 0x5484000
    s_add_u32 s47, s47, s91
    buffer_store_dwordx4 v[120:123], v0, s[20:23], s47 offen sc1
    s_add_u32 s44, s96, 0x8000000
    s_nop 0
    v_lshlrev_b32 v120, 1, v1
    buffer_load_dwordx4 v[120:123], v120, s[12:15], s44 offen nt
    s_waitcnt vmcnt(8)
    v_lshlrev_b32 v7, 16, v108
    v_and_b32 v8, 0xffff0000, v108
    v_lshlrev_b32 v9, 16, v109
    v_and_b32 v10, 0xffff0000, v109
    v_mul_f32 v7, 0.15915494, v7
    v_mul_f32 v8, 0.15915494, v8
    v_mul_f32 v9, 0.15915494, v9
    v_mul_f32 v10, 0.15915494, v10
    v_mul_hi_u32_u24 v14, 429497, v112
    v_lshrrev_b32 v12, 3, v88
    v_cos_f32 v7, v7
    v_lshlrev_b16 v13, 3, v88
    v_mad_i32_i24 v11, v14, s55, v112
    v_bitop3_b32 v12, v6, v13, v12 bitop3:0xca
    v_lshl_add_u32 v11, v11, 17, s40
    v_lshlrev_b16 v14, 8, v14
    v_lshrrev_b32 v13, 2, v88
    v_add_u32 v112, v12, v11
    v_bitop3_b32 v88, v5, v13, v14 bitop3:0xea
    ds_add_u32 v88, v2
    v_mul_hi_u32_u24 v14, 429497, v113
    v_lshrrev_b32 v12, 3, v89
    v_cos_f32 v8, v8
    v_lshlrev_b16 v13, 3, v89
    v_mad_i32_i24 v11, v14, s55, v113
    v_bitop3_b32 v12, v6, v13, v12 bitop3:0xca
    v_lshl_add_u32 v11, v11, 17, s40
    v_lshlrev_b16 v14, 8, v14
    v_lshrrev_b32 v13, 2, v89
    v_add_u32 v113, v12, v11
    v_bitop3_b32 v89, v5, v13, v14 bitop3:0xea
    ds_add_u32 v89, v2
    v_cvt_pk_bf16_f32 v108, v7, v8
    v_perm_b32 v12, v108, v108, s41
    v_bitop3_b32 v112, v4, v12, v112 bitop3:0xca
    v_perm_b32 v13, v108, v108, s42
    v_bitop3_b32 v113, v4, v13, v113 bitop3:0xca
    v_mul_hi_u32_u24 v14, 429497, v114
    v_lshrrev_b32 v12, 3, v90
    v_cos_f32 v9, v9
    v_lshlrev_b16 v13, 3, v90
    v_mad_i32_i24 v11, v14, s55, v114
    v_bitop3_b32 v12, v6, v13, v12 bitop3:0xca
    v_lshl_add_u32 v11, v11, 17, s40
    v_lshlrev_b16 v14, 8, v14
    v_lshrrev_b32 v13, 2, v90
    v_add_u32 v114, v12, v11
    v_bitop3_b32 v90, v5, v13, v14 bitop3:0xea
    ds_add_u32 v90, v2
    v_mul_hi_u32_u24 v14, 429497, v115
    v_lshrrev_b32 v12, 3, v91
    v_cos_f32 v10, v10
    v_lshlrev_b16 v13, 3, v91
    v_mad_i32_i24 v11, v14, s55, v115
    v_bitop3_b32 v12, v6, v13, v12 bitop3:0xca
    v_lshl_add_u32 v11, v11, 17, s40
    v_lshlrev_b16 v14, 8, v14
    v_lshrrev_b32 v13, 2, v91
    v_add_u32 v115, v12, v11
    v_bitop3_b32 v91, v5, v13, v14 bitop3:0xea
    ds_add_u32 v91, v2
    v_cvt_pk_bf16_f32 v109, v9, v10
    v_perm_b32 v12, v109, v109, s41
    v_bitop3_b32 v114, v4, v12, v114 bitop3:0xca
    v_perm_b32 v13, v109, v109, s42
    v_bitop3_b32 v115, v4, v13, v115 bitop3:0xca
    s_waitcnt vmcnt(4)
    v_lshlrev_b32 v7, 16, v110
    v_and_b32 v8, 0xffff0000, v110
    v_lshlrev_b32 v9, 16, v111
    v_and_b32 v10, 0xffff0000, v111
    v_mul_f32 v7, 0.15915494, v7
    v_mul_f32 v8, 0.15915494, v8
    v_mul_f32 v9, 0.15915494, v9
    v_mul_f32 v10, 0.15915494, v10
    v_mul_hi_u32_u24 v14, 429497, v116
    v_lshrrev_b32 v12, 3, v92
    v_cos_f32 v7, v7
    v_lshlrev_b16 v13, 3, v92
    v_mad_i32_i24 v11, v14, s55, v116
    v_bitop3_b32 v12, v6, v13, v12 bitop3:0xca
    v_lshl_add_u32 v11, v11, 17, s40
    v_lshlrev_b16 v14, 8, v14
    v_lshrrev_b32 v13, 2, v92
    v_add_u32 v116, v12, v11
    v_bitop3_b32 v92, v5, v13, v14 bitop3:0xea
    ds_add_u32 v92, v2
    v_mul_hi_u32_u24 v14, 429497, v117
    v_lshrrev_b32 v12, 3, v93
    v_cos_f32 v8, v8
    v_lshlrev_b16 v13, 3, v93
    v_mad_i32_i24 v11, v14, s55, v117
    v_bitop3_b32 v12, v6, v13, v12 bitop3:0xca
    v_lshl_add_u32 v11, v11, 17, s40
    v_lshlrev_b16 v14, 8, v14
    v_lshrrev_b32 v13, 2, v93
    v_add_u32 v117, v12, v11
    v_bitop3_b32 v93, v5, v13, v14 bitop3:0xea
    ds_add_u32 v93, v2
    v_cvt_pk_bf16_f32 v110, v7, v8
    v_perm_b32 v12, v110, v110, s41
    v_bitop3_b32 v116, v4, v12, v116 bitop3:0xca
    v_perm_b32 v13, v110, v110, s42
    v_bitop3_b32 v117, v4, v13, v117 bitop3:0xca
    v_mul_hi_u32_u24 v14, 429497, v118
    v_lshrrev_b32 v12, 3, v94
    v_cos_f32 v9, v9
    v_lshlrev_b16 v13, 3, v94
    v_mad_i32_i24 v11, v14, s55, v118
    v_bitop3_b32 v12, v6, v13, v12 bitop3:0xca
    v_lshl_add_u32 v11, v11, 17, s40
    v_lshlrev_b16 v14, 8, v14
    v_lshrrev_b32 v13, 2, v94
    v_add_u32 v118, v12, v11
    v_bitop3_b32 v94, v5, v13, v14 bitop3:0xea
    ds_add_u32 v94, v2
    v_mul_hi_u32_u24 v14, 429497, v119
    v_lshrrev_b32 v12, 3, v95
    v_cos_f32 v10, v10
    v_lshlrev_b16 v13, 3, v95
    v_mad_i32_i24 v11, v14, s55, v119
    v_bitop3_b32 v12, v6, v13, v12 bitop3:0xca
    v_lshl_add_u32 v11, v11, 17, s40
    v_lshlrev_b16 v14, 8, v14
    v_lshrrev_b32 v13, 2, v95
    v_add_u32 v119, v12, v11
    v_bitop3_b32 v95, v5, v13, v14 bitop3:0xea
    ds_add_u32 v95, v2
    v_cvt_pk_bf16_f32 v111, v9, v10
    v_perm_b32 v12, v111, v111, s41
    v_bitop3_b32 v118, v4, v12, v118 bitop3:0xca
    v_perm_b32 v13, v111, v111, s42
    v_bitop3_b32 v119, v4, v13, v119 bitop3:0xca
    v_lshrrev_b32 v8, 2, v0
    v_and_b32 v7, 0x3c00, v0
    v_bitop3_b32 v7, v5, v8, v7 bitop3:0xea
    s_waitcnt lgkmcnt(0)
    s_barrier
    ds_read2st64_b32 v[8:9], v7 offset0:0 offset1:1
    ds_read2st64_b32 v[10:11], v7 offset0:2 offset1:3
    s_add_u32 s45, s35, 0x5484000
    s_add_u32 s45, s45, s93
    buffer_store_dwordx4 v[44:47], v0, s[20:23], s45 offen sc1
    s_add_u32 s46, s96, 0x8000000
    s_lshr_b32 s46, s46, 1
    buffer_load_dwordx2 v[44:45], v1, s[16:19], s46 offen nt
    s_add_u32 s47, s97, 0x8400000
    s_lshr_b32 s47, s47, 1
    buffer_load_dwordx2 v[46:47], v1, s[16:19], s47 offen nt
    s_waitcnt lgkmcnt(0)
    v_lshl_or_b32 v12, v9, 16, v8
    v_lshl_or_b32 v13, v11, 16, v10
    v_mov_b32 v14, v12
    v_mov_b32 v15, v13
    s_nop 0
    v_add_u32_dpp v14, v14, v14 row_shr:1 row_mask:0xf bank_mask:0xf bound_ctrl:1
    v_add_u32_dpp v15, v15, v15 row_shr:1 row_mask:0xf bank_mask:0xf bound_ctrl:1
    s_nop 0
    v_add_u32_dpp v14, v14, v14 row_shr:2 row_mask:0xf bank_mask:0xf bound_ctrl:1
    v_add_u32_dpp v15, v15, v15 row_shr:2 row_mask:0xf bank_mask:0xf bound_ctrl:1
    s_nop 0
    v_add_u32_dpp v14, v14, v14 row_shr:4 row_mask:0xf bank_mask:0xf bound_ctrl:1
    v_add_u32_dpp v15, v15, v15 row_shr:4 row_mask:0xf bank_mask:0xf bound_ctrl:1
    s_nop 0
    v_add_u32_dpp v14, v14, v14 row_shr:8 row_mask:0xf bank_mask:0xf bound_ctrl:1
    v_add_u32_dpp v15, v15, v15 row_shr:8 row_mask:0xf bank_mask:0xf bound_ctrl:1
    s_nop 0
    v_add_u32_dpp v14, v14, v14 row_bcast:15 row_mask:0xa bank_mask:0xf
    v_add_u32_dpp v15, v15, v15 row_bcast:15 row_mask:0xa bank_mask:0xf
    s_nop 0
    v_add_u32_dpp v14, v14, v14 row_bcast:31 row_mask:0xc bank_mask:0xf
    v_add_u32_dpp v15, v15, v15 row_bcast:31 row_mask:0xc bank_mask:0xf
    v_readlane_b32 s48, v14, 63
    v_readlane_b32 s49, v15, 63
    s_lshl_b32 s54, s32, 2
    v_mov_b32 v8, s54
    s_and_b32 s50, s48, 0xffff
    s_lshr_b32 s51, s48, 16
    s_and_b32 s52, s49, 0xffff
    s_lshr_b32 s53, s49, 16
    s_add_u32 s51, s51, s50
    s_add_u32 s52, s52, s51
    s_add_u32 s53, s53, s52
    v_mov_b32 v9, s53
    s_mov_b64 exec, 1
    ds_write_b32 v8, v9 offset:16384
    s_cmp_lg_u32 s32, 15
    s_cbranch_scc1 L1_tk2
    s_waitcnt vmcnt(3)
L1_tk2:
    ds_write_b32 v8, v3 offset:16448
    s_mov_b64 exec, -1
    v_and_b32 v8, 60, v7
    s_waitcnt lgkmcnt(0)
    s_barrier
    ds_read_b32 v9, v8 offset:16384
    ds_read_b32 v10, v8 offset:16448
    s_waitcnt lgkmcnt(0)
    v_readlane_b32 s84, v10, 15
    s_and_b32 s3, s2, 1
    s_lshl_b32 s3, s3, 7
    s_add_u32 s84, s84, s3
    s_min_u32 s4, s84, 72
    s_min_u32 s5, s84, 216
    s_min_u32 s6, s84, 240
    s_add_u32 s4, s4, s5
    s_add_u32 s4, s4, s6
    s_add_u32 s4, s4, 9467
    s_mov_b32 s4, s84
    s_lshl_b32 s58, s4, 14
    s_lshl_b32 s5, s32, 10
    s_add_u32 s58, s58, s5
    s_lshr_b32 s59, s58, 1
    s_mov_b32 s43, 5
    s_cmp_lt_u32 s84, 72
    s_addc_u32 s43, s43, 0
    s_cmp_lt_u32 s84, 216
    s_addc_u32 s43, s43, 0
    s_cmp_lt_u32 s84, 240
    s_addc_u32 s43, s43, 0
    v_add_u32_dpp v9, v9, v9 row_shr:1 row_mask:0xf bank_mask:0xf bound_ctrl:1
    s_nop 1
    v_add_u32_dpp v9, v9, v9 row_shr:2 row_mask:0xf bank_mask:0xf bound_ctrl:1
    s_nop 1
    v_add_u32_dpp v9, v9, v9 row_shr:4 row_mask:0xf bank_mask:0xf bound_ctrl:1
    s_nop 1
    v_add_u32_dpp v9, v9, v9 row_shr:8 row_mask:0xf bank_mask:0xf bound_ctrl:1
    s_nop 0
    v_readlane_b32 s54, v9, s32
    s_sub_u32 s54, s54, s53
    s_add_u32 s50, s50, s54
    s_add_u32 s51, s51, s54
    s_add_u32 s52, s52, s54
    s_pack_ll_b32_b16 s48, s54, s50
    s_pack_ll_b32_b16 s49, s51, s52
    v_add_u32 v14, s48, v14
    v_add_u32 v15, s49, v15
    v_sub_u32 v12, v14, v12
    v_sub_u32 v13, v15, v13
    v_and_b32 v8, 0xffff, v12
    v_lshrrev_b32 v9, 16, v12
    v_and_b32 v10, 0xffff, v13
    v_lshrrev_b32 v11, 16, v13
    ds_write2st64_b32 v7, v8, v9 offset0:0 offset1:1
    ds_write2st64_b32 v7, v10, v11 offset0:2 offset1:3
    v_and_b32 v8, 0x3f0, v0
    v_lshl_add_u32 v8, v8, 1, s36
    ds_write_b64 v8, v[12:13] offset:20480
    s_bitset0_b64 exec, 63
    s_not_b64 exec, exec
    ds_write_b64 v8, v[14:15] offset:20512
    s_mov_b64 exec, -1
    s_waitcnt lgkmcnt(0)
    s_barrier
    s_setprio 3
    ds_add_rtn_u32 v24, v24, v2
    ds_add_rtn_u32 v25, v25, v2
    ds_add_rtn_u32 v26, v26, v2
    ds_add_rtn_u32 v27, v27, v2
    ds_read_b128 v[12:15], v0 offset:20480
    v_cmp_gt_u32 vcc, 8448, v0
    ds_add_rtn_u32 v52, v52, v2
    ds_add_rtn_u32 v53, v53, v2
    ds_add_rtn_u32 v54, v54, v2
    ds_add_rtn_u32 v55, v55, v2
    s_setprio 2
    ds_add_rtn_u32 v72, v72, v2
    ds_add_rtn_u32 v73, v73, v2
    ds_add_rtn_u32 v74, v74, v2
    ds_add_rtn_u32 v75, v75, v2
    s_waitcnt lgkmcnt(8)
    s_cbranch_vccz L1_p4
    s_add_u32 s44, s35, 0x7ec0000
    s_mov_b64 exec, vcc
    buffer_store_dwordx4 v[12:15], v0, s[24:27], s44 offen sc1
    s_mov_b64 exec, -1
L1_p4:
    s_add_u32 s45, s35, 0x5488000
    s_add_u32 s45, s45, s72
    buffer_store_dwordx4 v[20:23], v0, s[20:23], s45 offen sc1
    s_add_u32 s46, s97, 0x8400000
    s_nop 0
    v_lshlrev_b32 v20, 1, v1
    buffer_load_dwordx4 v[20:23], v20, s[8:11], s46 offen nt
    ds_add_rtn_u32 v80, v80, v2
    ds_add_rtn_u32 v81, v81, v2
    ds_add_rtn_u32 v82, v82, v2
    ds_add_rtn_u32 v83, v83, v2
    s_setprio 1
    ds_add_rtn_u32 v96, v96, v2
    ds_add_rtn_u32 v97, v97, v2
    ds_add_rtn_u32 v98, v98, v2
    ds_add_rtn_u32 v99, v99, v2
    ds_add_rtn_u32 v100, v100, v2
    ds_add_rtn_u32 v101, v101, v2
    ds_add_rtn_u32 v102, v102, v2
    ds_add_rtn_u32 v103, v103, v2
    s_add_u32 s47, s35, 0x5488000
    s_add_u32 s47, s47, s73
    buffer_store_dwordx4 v[124:127], v0, s[20:23], s47 offen sc1
    s_add_u32 s44, s97, 0x8400000
    s_nop 0
    v_lshlrev_b32 v124, 1, v1
    buffer_load_dwordx4 v[124:127], v124, s[12:15], s44 offen nt
    s_setprio 0
    ds_add_rtn_u32 v88, v88, v2
    ds_add_rtn_u32 v89, v89, v2
    ds_add_rtn_u32 v90, v90, v2
    ds_add_rtn_u32 v91, v91, v2
    ds_add_rtn_u32 v92, v92, v2
    ds_add_rtn_u32 v93, v93, v2
    ds_add_rtn_u32 v94, v94, v2
    ds_add_rtn_u32 v95, v95, v2
    s_waitcnt lgkmcnt(0)
    s_barrier
    s_setprio 3
    v_and_b32 v7, -4, v24
    v_lshl_add_u32 v8, v24, 2, v7
    ds_write_b32 v8, v40
    v_lshl_add_u32 v7, v7, 2, v24
    ds_write_b8 v7, v84 offset:16
    v_and_b32 v9, -4, v25
    v_lshl_add_u32 v10, v25, 2, v9
    ds_write_b32 v10, v41
    v_lshl_add_u32 v9, v9, 2, v25
    ds_write_b8_d16_hi v9, v84 offset:16
    v_and_b32 v7, -4, v26
    v_lshl_add_u32 v8, v26, 2, v7
    ds_write_b32 v8, v42
    v_lshl_add_u32 v7, v7, 2, v26
    ds_write_b8 v7, v85 offset:16
    v_and_b32 v9, -4, v27
    v_lshl_add_u32 v10, v27, 2, v9
    ds_write_b32 v10, v43
    v_lshl_add_u32 v9, v9, 2, v27
    ds_write_b8_d16_hi v9, v85 offset:16
    s_add_u32 s45, s35, 0x5488000
    s_add_u32 s45, s45, s85
    buffer_store_dwordx4 v[32:35], v0, s[20:23], s45 offen sc1
    s_add_u32 s46, s98, 0x8800000
    v_lshlrev_b32 v40, 1, v1
    buffer_load_dwordx4 v[40:43], v40, s[8:11], s46 offen nt
    s_add_u32 s47, s98, 0x8800000
    v_lshlrev_b32 v24, 1, v1
    buffer_load_dwordx4 v[24:27], v24, s[12:15], s47 offen nt
    v_and_b32 v7, -4, v52
    v_lshl_add_u32 v8, v52, 2, v7
    ds_write_b32 v8, v48
    v_lshl_add_u32 v7, v7, 2, v52
    ds_write_b8 v7, v86 offset:16
    v_and_b32 v9, -4, v53
    v_lshl_add_u32 v10, v53, 2, v9
    ds_write_b32 v10, v49
    v_lshl_add_u32 v9, v9, 2, v53
    ds_write_b8_d16_hi v9, v86 offset:16
    v_and_b32 v7, -4, v54
    v_lshl_add_u32 v8, v54, 2, v7
    ds_write_b32 v8, v50
    v_lshl_add_u32 v7, v7, 2, v54
    ds_write_b8 v7, v87 offset:16
    v_and_b32 v9, -4, v55
    v_lshl_add_u32 v10, v55, 2, v9
    ds_write_b32 v10, v51
    v_lshl_add_u32 v9, v9, 2, v55
    ds_write_b8_d16_hi v9, v87 offset:16
    s_add_u32 s44, s98, 0x8800000
    s_lshr_b32 s44, s44, 1
    buffer_load_dwordx2 v[32:33], v1, s[16:19], s44 offen nt
    s_add_u32 s45, s99, 0x8c00000
    s_lshr_b32 s45, s45, 1
    buffer_load_dwordx2 v[34:35], v1, s[16:19], s45 offen nt
    s_add_u32 s46, s99, 0x8c00000
    v_lshlrev_b32 v48, 1, v1
    buffer_load_dwordx4 v[48:51], v48, s[8:11], s46 offen nt
    s_setprio 2
    v_and_b32 v7, -4, v72
    v_lshl_add_u32 v8, v72, 2, v7
    ds_write_b32 v8, v68
    v_lshl_add_u32 v7, v7, 2, v72
    ds_write_b8 v7, v56 offset:16
    v_and_b32 v9, -4, v73
    v_lshl_add_u32 v10, v73, 2, v9
    ds_write_b32 v10, v69
    v_lshl_add_u32 v9, v9, 2, v73
    ds_write_b8_d16_hi v9, v56 offset:16
    v_and_b32 v7, -4, v74
    v_lshl_add_u32 v8, v74, 2, v7
    ds_write_b32 v8, v70
    v_lshl_add_u32 v7, v7, 2, v74
    ds_write_b8 v7, v57 offset:16
    v_and_b32 v9, -4, v75
    v_lshl_add_u32 v10, v75, 2, v9
    ds_write_b32 v10, v71
    v_lshl_add_u32 v9, v9, 2, v75
    ds_write_b8_d16_hi v9, v57 offset:16
    s_add_u32 s47, s35, 0x5488000
    s_add_u32 s47, s47, s91
    buffer_store_dwordx4 v[36:39], v0, s[20:23], s47 offen sc1
    s_add_u32 s44, s99, 0x8c00000
    v_lshlrev_b32 v52, 1, v1
    buffer_load_dwordx4 v[52:55], v52, s[12:15], s44 offen nt
    v_and_b32 v7, -4, v80
    v_lshl_add_u32 v8, v80, 2, v7
    ds_write_b32 v8, v76
    v_lshl_add_u32 v7, v7, 2, v80
    ds_write_b8 v7, v58 offset:16
    v_and_b32 v9, -4, v81
    v_lshl_add_u32 v10, v81, 2, v9
    ds_write_b32 v10, v77
    v_lshl_add_u32 v9, v9, 2, v81
    ds_write_b8_d16_hi v9, v58 offset:16
    v_and_b32 v7, -4, v82
    v_lshl_add_u32 v8, v82, 2, v7
    ds_write_b32 v8, v78
    v_lshl_add_u32 v7, v7, 2, v82
    ds_write_b8 v7, v59 offset:16
    v_and_b32 v9, -4, v83
    v_lshl_add_u32 v10, v83, 2, v9
    ds_write_b32 v10, v79
    v_lshl_add_u32 v9, v9, 2, v83
    ds_write_b8_d16_hi v9, v59 offset:16
    s_add_u32 s45, s96, 0x9000000
    v_lshlrev_b32 v84, 1, v1
    buffer_load_dwordx4 v[84:87], v84, s[8:11], s45 offen nt
    s_add_u32 s46, s96, 0x9000000
    v_lshlrev_b32 v68, 1, v1
    buffer_load_dwordx4 v[68:71], v68, s[12:15], s46 offen nt
    s_setprio 1
    v_and_b32 v7, -4, v96
    v_lshl_add_u32 v8, v96, 2, v7
    ds_write_b32 v8, v64
    v_lshl_add_u32 v7, v7, 2, v96
    ds_write_b8 v7, v104 offset:16
    v_and_b32 v9, -4, v97
    v_lshl_add_u32 v10, v97, 2, v9
    ds_write_b32 v10, v65
    v_lshl_add_u32 v9, v9, 2, v97
    ds_write_b8_d16_hi v9, v104 offset:16
    v_and_b32 v7, -4, v98
    v_lshl_add_u32 v8, v98, 2, v7
    ds_write_b32 v8, v66
    v_lshl_add_u32 v7, v7, 2, v98
    ds_write_b8 v7, v105 offset:16
    v_and_b32 v9, -4, v99
    v_lshl_add_u32 v10, v99, 2, v9
    ds_write_b32 v10, v67
    v_lshl_add_u32 v9, v9, 2, v99
    ds_write_b8_d16_hi v9, v105 offset:16
    s_add_u32 s47, s96, 0x9000000
    s_lshr_b32 s47, s47, 1
    buffer_load_dwordx2 v[72:73], v1, s[16:19], s47 offen nt
    s_cmp_le_u32 s43, 5
    s_cselect_b32 s18, 0, s18
    s_add_u32 s44, s59, 0x4a00000
    buffer_load_dwordx2 v[74:75], v1, s[16:19], s44 offen nt
    s_cmp_le_u32 s43, 5
    s_cselect_b32 s10, 0, s10
    s_add_u32 s45, s58, 0x9400000
    v_lshlrev_b32 v36, 1, v1
    buffer_load_dwordx4 v[36:39], v36, s[8:11], s45 offen nt
    v_and_b32 v7, -4, v100
    v_lshl_add_u32 v8, v100, 2, v7
    ds_write_b32 v8, v60
    v_lshl_add_u32 v7, v7, 2, v100
    ds_write_b8 v7, v106 offset:16
    v_and_b32 v9, -4, v101
    v_lshl_add_u32 v10, v101, 2, v9
    ds_write_b32 v10, v61
    v_lshl_add_u32 v9, v9, 2, v101
    ds_write_b8_d16_hi v9, v106 offset:16
    v_and_b32 v7, -4, v102
    v_lshl_add_u32 v8, v102, 2, v7
    ds_write_b32 v8, v62
    v_lshl_add_u32 v7, v7, 2, v102
    ds_write_b8 v7, v107 offset:16
    v_and_b32 v9, -4, v103
    v_lshl_add_u32 v10, v103, 2, v9
    ds_write_b32 v10, v63
    v_lshl_add_u32 v9, v9, 2, v103
    ds_write_b8_d16_hi v9, v107 offset:16
    s_add_u32 s46, s35, 0x5488000
    s_add_u32 s46, s46, s93
    buffer_store_dwordx4 v[28:31], v0, s[20:23], s46 offen sc1
    s_cmp_le_u32 s43, 5
    s_cselect_b32 s14, 0, s14
    s_add_u32 s47, s58, 0x9400000
    v_lshlrev_b32 v76, 1, v1
    buffer_load_dwordx4 v[76:79], v76, s[12:15], s47 offen nt
    s_setprio 0
    v_and_b32 v7, -4, v88
    v_lshl_add_u32 v8, v88, 2, v7
    ds_write_b32 v8, v112
    v_lshl_add_u32 v7, v7, 2, v88
    ds_write_b8 v7, v108 offset:16
    v_and_b32 v9, -4, v89
    v_lshl_add_u32 v10, v89, 2, v9
    ds_write_b32 v10, v113
    v_lshl_add_u32 v9, v9, 2, v89
    ds_write_b8_d16_hi v9, v108 offset:16
    v_and_b32 v7, -4, v90
    v_lshl_add_u32 v8, v90, 2, v7
    ds_write_b32 v8, v114
    v_lshl_add_u32 v7, v7, 2, v90
    ds_write_b8 v7, v109 offset:16
    v_and_b32 v9, -4, v91
    v_lshl_add_u32 v10, v91, 2, v9
    ds_write_b32 v10, v115
    v_lshl_add_u32 v9, v9, 2, v91
    ds_write_b8_d16_hi v9, v109 offset:16
    s_cmp_le_u32 s43, 6
    s_cselect_b32 s10, 0, s10
    s_add_u32 s44, s58, 0x97c0000
    v_lshlrev_b32 v80, 1, v1
    buffer_load_dwordx4 v[80:83], v80, s[8:11], s44 offen nt
    s_cmp_le_u32 s43, 6
    s_cselect_b32 s14, 0, s14
    s_add_u32 s45, s58, 0x97c0000
    v_lshlrev_b32 v56, 1, v1
    buffer_load_dwordx4 v[56:59], v56, s[12:15], s45 offen nt
    v_and_b32 v7, -4, v92
    v_lshl_add_u32 v8, v92, 2, v7
    ds_write_b32 v8, v116
    v_lshl_add_u32 v7, v7, 2, v92
    ds_write_b8 v7, v110 offset:16
    v_and_b32 v9, -4, v93
    v_lshl_add_u32 v10, v93, 2, v9
    ds_write_b32 v10, v117
    v_lshl_add_u32 v9, v9, 2, v93
    ds_write_b8_d16_hi v9, v110 offset:16
    v_and_b32 v7, -4, v94
    v_lshl_add_u32 v8, v94, 2, v7
    ds_write_b32 v8, v118
    v_lshl_add_u32 v7, v7, 2, v94
    ds_write_b8 v7, v111 offset:16
    v_and_b32 v9, -4, v95
    v_lshl_add_u32 v10, v95, 2, v9
    ds_write_b32 v10, v119
    v_lshl_add_u32 v9, v9, 2, v95
    ds_write_b8_d16_hi v9, v111 offset:16
    s_cmp_le_u32 s43, 6
    s_cselect_b32 s18, 0, s18
    s_add_u32 s46, s59, 0x4be0000
    buffer_load_dwordx2 v[64:65], v1, s[16:19], s46 offen nt
    s_cmp_le_u32 s43, 7
    s_cselect_b32 s18, 0, s18
    s_add_u32 s47, s59, 0x4d90000
    buffer_load_dwordx2 v[66:67], v1, s[16:19], s47 offen nt
    v_add_u32 v7, s72, v0
    v_add_u32 v12, s73, v0
    v_add_u32 v13, s85, v0
    v_add_u32 v14, s91, v0
    v_add_u32 v15, s93, v0
    s_min_i32 s3, s72, s73
    s_min_i32 s3, s3, s85
    s_min_i32 s3, s3, s91
    s_min_i32 s3, s3, s93
    v_add_u32 v3, s3, v0
    v_mov_b32 v8, 0
    v_mov_b32 v9, 0
    v_mov_b32 v10, 0
    v_mov_b32 v11, 0
    s_waitcnt lgkmcnt(0)
    s_barrier
    ds_read_b128 v[96:99], v7 offset:0
    ds_read_b128 v[60:63], v12 offset:0
    ds_read_b128 v[100:103], v13 offset:0
    ds_read_b128 v[104:107], v14 offset:0
    ds_read_b128 v[28:31], v15 offset:0
    ds_write_b128 v3, v[8:11]
    ds_read_b128 v[112:115], v7 offset:16384
    ds_read_b128 v[88:91], v12 offset:16384
    ds_read_b128 v[116:119], v13 offset:16384
    ds_read_b128 v[92:95], v14 offset:16384
    ds_read_b128 v[108:111], v15 offset:16384
    s_waitcnt lgkmcnt(0)
    s_barrier
    v_lshlrev_b32 v3, 3, v0
    v_and_b32 v3, 0x80, v3
    s_cmp_lg_u32 s32, 15
    s_cbranch_scc1 L2_k0
    s_mov_b64 exec, 3
    buffer_load_dword v3, v3, s[68:71], 0 offen sc1
    s_mov_b64 exec, -1
L2_k0:
    s_add_u32 s44, s35, 0x7ec4000
    s_add_u32 s44, s44, s72
    buffer_store_dwordx4 v[96:99], v0, s[20:23], s44 offen sc1
    s_cmp_le_u32 s43, 7
    s_cselect_b32 s10, 0, s10
    s_add_u32 s45, s58, 0x9b20000
    v_lshlrev_b32 v96, 1, v1
    buffer_load_dwordx4 v[96:99], v96, s[8:11], s45 offen nt
    s_add_u32 s46, s35, 0x7ec4000
    s_add_u32 s46, s46, s73
    buffer_store_dwordx4 v[60:63], v0, s[20:23], s46 offen sc1
    s_cmp_le_u32 s43, 7
    s_cselect_b32 s14, 0, s14
    s_add_u32 s47, s58, 0x9b20000
    v_lshlrev_b32 v60, 1, v1
    buffer_load_dwordx4 v[60:63], v60, s[12:15], s47 offen nt
    s_setprio 3
    s_waitcnt vmcnt(27)
    v_lshlrev_b32 v7, 16, v44
    v_and_b32 v8, 0xffff0000, v44
    v_lshlrev_b32 v9, 16, v45
    v_and_b32 v10, 0xffff0000, v45
    v_mul_f32 v7, 0.15915494, v7
    v_mul_f32 v8, 0.15915494, v8
    v_mul_f32 v9, 0.15915494, v9
    v_mul_f32 v10, 0.15915494, v10
    v_mul_hi_u32_u24 v14, 429497, v16
    v_lshrrev_b32 v12, 3, v120
    v_cos_f32 v7, v7
    v_lshlrev_b16 v13, 3, v120
    v_mad_i32_i24 v11, v14, s55, v16
    v_bitop3_b32 v12, v6, v13, v12 bitop3:0xca
    v_lshl_add_u32 v11, v11, 17, s40
    v_lshlrev_b16 v14, 8, v14
    v_lshrrev_b32 v13, 2, v120
    v_add_u32 v16, v12, v11
    v_bitop3_b32 v120, v5, v13, v14 bitop3:0xea
    ds_add_u32 v120, v2
    v_mul_hi_u32_u24 v14, 429497, v17
    v_lshrrev_b32 v12, 3, v121
    v_cos_f32 v8, v8
    v_lshlrev_b16 v13, 3, v121
    v_mad_i32_i24 v11, v14, s55, v17
    v_bitop3_b32 v12, v6, v13, v12 bitop3:0xca
    v_lshl_add_u32 v11, v11, 17, s40
    v_lshlrev_b16 v14, 8, v14
    v_lshrrev_b32 v13, 2, v121
    v_add_u32 v17, v12, v11
    v_bitop3_b32 v121, v5, v13, v14 bitop3:0xea
    ds_add_u32 v121, v2
    v_cvt_pk_bf16_f32 v44, v7, v8
    v_perm_b32 v12, v44, v44, s41
    v_bitop3_b32 v16, v4, v12, v16 bitop3:0xca
    v_perm_b32 v13, v44, v44, s42
    v_bitop3_b32 v17, v4, v13, v17 bitop3:0xca
    v_mul_hi_u32_u24 v14, 429497, v18
    v_lshrrev_b32 v12, 3, v122
    v_cos_f32 v9, v9
    v_lshlrev_b16 v13, 3, v122
    v_mad_i32_i24 v11, v14, s55, v18
    v_bitop3_b32 v12, v6, v13, v12 bitop3:0xca
    v_lshl_add_u32 v11, v11, 17, s40
    v_lshlrev_b16 v14, 8, v14
    v_lshrrev_b32 v13, 2, v122
    v_add_u32 v18, v12, v11
    v_bitop3_b32 v122, v5, v13, v14 bitop3:0xea
    ds_add_u32 v122, v2
    v_mul_hi_u32_u24 v14, 429497, v19
    v_lshrrev_b32 v12, 3, v123
    v_cos_f32 v10, v10
    v_lshlrev_b16 v13, 3, v123
    v_mad_i32_i24 v11, v14, s55, v19
    v_bitop3_b32 v12, v6, v13, v12 bitop3:0xca
    v_lshl_add_u32 v11, v11, 17, s40
    v_lshlrev_b16 v14, 8, v14
    v_lshrrev_b32 v13, 2, v123
    v_add_u32 v19, v12, v11
    v_bitop3_b32 v123, v5, v13, v14 bitop3:0xea
    ds_add_u32 v123, v2
    v_cvt_pk_bf16_f32 v45, v9, v10
    v_perm_b32 v12, v45, v45, s41
    v_bitop3_b32 v18, v4, v12, v18 bitop3:0xca
    v_perm_b32 v13, v45, v45, s42
    v_bitop3_b32 v19, v4, v13, v19 bitop3:0xca
    s_waitcnt vmcnt(23)
    v_lshlrev_b32 v7, 16, v46
    v_and_b32 v8, 0xffff0000, v46
    v_lshlrev_b32 v9, 16, v47
    v_and_b32 v10, 0xffff0000, v47
    v_mul_f32 v7, 0.15915494, v7
    v_mul_f32 v8, 0.15915494, v8
    v_mul_f32 v9, 0.15915494, v9
    v_mul_f32 v10, 0.15915494, v10
    v_mul_hi_u32_u24 v14, 429497, v20
    v_lshrrev_b32 v12, 3, v124
    v_cos_f32 v7, v7
    v_lshlrev_b16 v13, 3, v124
    v_mad_i32_i24 v11, v14, s55, v20
    v_bitop3_b32 v12, v6, v13, v12 bitop3:0xca
    v_lshl_add_u32 v11, v11, 17, s40
    v_lshlrev_b16 v14, 8, v14
    v_lshrrev_b32 v13, 2, v124
    v_add_u32 v20, v12, v11
    v_bitop3_b32 v124, v5, v13, v14 bitop3:0xea
    ds_add_u32 v124, v2
    v_mul_hi_u32_u24 v14, 429497, v21
    v_lshrrev_b32 v12, 3, v125
    v_cos_f32 v8, v8
    v_lshlrev_b16 v13, 3, v125
    v_mad_i32_i24 v11, v14, s55, v21
    v_bitop3_b32 v12, v6, v13, v12 bitop3:0xca
    v_lshl_add_u32 v11, v11, 17, s40
    v_lshlrev_b16 v14, 8, v14
    v_lshrrev_b32 v13, 2, v125
    v_add_u32 v21, v12, v11
    v_bitop3_b32 v125, v5, v13, v14 bitop3:0xea
    ds_add_u32 v125, v2
    v_cvt_pk_bf16_f32 v46, v7, v8
    v_perm_b32 v12, v46, v46, s41
    v_bitop3_b32 v20, v4, v12, v20 bitop3:0xca
    v_perm_b32 v13, v46, v46, s42
    v_bitop3_b32 v21, v4, v13, v21 bitop3:0xca
    v_mul_hi_u32_u24 v14, 429497, v22
    v_lshrrev_b32 v12, 3, v126
    v_cos_f32 v9, v9
    v_lshlrev_b16 v13, 3, v126
    v_mad_i32_i24 v11, v14, s55, v22
    v_bitop3_b32 v12, v6, v13, v12 bitop3:0xca
    v_lshl_add_u32 v11, v11, 17, s40
    v_lshlrev_b16 v14, 8, v14
    v_lshrrev_b32 v13, 2, v126
    v_add_u32 v22, v12, v11
    v_bitop3_b32 v126, v5, v13, v14 bitop3:0xea
    ds_add_u32 v126, v2
    v_mul_hi_u32_u24 v14, 429497, v23
    v_lshrrev_b32 v12, 3, v127
    v_cos_f32 v10, v10
    v_lshlrev_b16 v13, 3, v127
    v_mad_i32_i24 v11, v14, s55, v23
    v_bitop3_b32 v12, v6, v13, v12 bitop3:0xca
    v_lshl_add_u32 v11, v11, 17, s40
    v_lshlrev_b16 v14, 8, v14
    v_lshrrev_b32 v13, 2, v127
    v_add_u32 v23, v12, v11
    v_bitop3_b32 v127, v5, v13, v14 bitop3:0xea
    ds_add_u32 v127, v2
    v_cvt_pk_bf16_f32 v47, v9, v10
    v_perm_b32 v12, v47, v47, s41
    v_bitop3_b32 v22, v4, v12, v22 bitop3:0xca
    v_perm_b32 v13, v47, v47, s42
    v_bitop3_b32 v23, v4, v13, v23 bitop3:0xca
    s_setprio 2
    s_add_u32 s44, s35, 0x7ec4000
    s_add_u32 s44, s44, s85
    buffer_store_dwordx4 v[100:103], v0, s[20:23], s44 offen sc1
    s_waitcnt vmcnt(19)
    v_lshlrev_b32 v7, 16, v32
    v_and_b32 v8, 0xffff0000, v32
    v_lshlrev_b32 v9, 16, v33
    v_and_b32 v10, 0xffff0000, v33
    v_mul_f32 v7, 0.15915494, v7
    v_mul_f32 v8, 0.15915494, v8
    v_mul_f32 v9, 0.15915494, v9
    v_mul_f32 v10, 0.15915494, v10
    v_mul_hi_u32_u24 v14, 429497, v40
    v_lshrrev_b32 v12, 3, v24
    v_cos_f32 v7, v7
    v_lshlrev_b16 v13, 3, v24
    v_mad_i32_i24 v11, v14, s55, v40
    v_bitop3_b32 v12, v6, v13, v12 bitop3:0xca
    v_lshl_add_u32 v11, v11, 17, s40
    v_lshlrev_b16 v14, 8, v14
    v_lshrrev_b32 v13, 2, v24
    v_add_u32 v40, v12, v11
    v_bitop3_b32 v24, v5, v13, v14 bitop3:0xea
    ds_add_u32 v24, v2
    v_mul_hi_u32_u24 v14, 429497, v41
    v_lshrrev_b32 v12, 3, v25
    v_cos_f32 v8, v8
    v_lshlrev_b16 v13, 3, v25
    v_mad_i32_i24 v11, v14, s55, v41
    v_bitop3_b32 v12, v6, v13, v12 bitop3:0xca
    v_lshl_add_u32 v11, v11, 17, s40
    v_lshlrev_b16 v14, 8, v14
    v_lshrrev_b32 v13, 2, v25
    v_add_u32 v41, v12, v11
    v_bitop3_b32 v25, v5, v13, v14 bitop3:0xea
    ds_add_u32 v25, v2
    v_cvt_pk_bf16_f32 v32, v7, v8
    v_perm_b32 v12, v32, v32, s41
    v_bitop3_b32 v40, v4, v12, v40 bitop3:0xca
    v_perm_b32 v13, v32, v32, s42
    v_bitop3_b32 v41, v4, v13, v41 bitop3:0xca
    v_mul_hi_u32_u24 v14, 429497, v42
    v_lshrrev_b32 v12, 3, v26
    v_cos_f32 v9, v9
    v_lshlrev_b16 v13, 3, v26
    v_mad_i32_i24 v11, v14, s55, v42
    v_bitop3_b32 v12, v6, v13, v12 bitop3:0xca
    v_lshl_add_u32 v11, v11, 17, s40
    v_lshlrev_b16 v14, 8, v14
    v_lshrrev_b32 v13, 2, v26
    v_add_u32 v42, v12, v11
    v_bitop3_b32 v26, v5, v13, v14 bitop3:0xea
    ds_add_u32 v26, v2
    v_mul_hi_u32_u24 v14, 429497, v43
    v_lshrrev_b32 v12, 3, v27
    v_cos_f32 v10, v10
    v_lshlrev_b16 v13, 3, v27
    v_mad_i32_i24 v11, v14, s55, v43
    v_bitop3_b32 v12, v6, v13, v12 bitop3:0xca
    v_lshl_add_u32 v11, v11, 17, s40
    v_lshlrev_b16 v14, 8, v14
    v_lshrrev_b32 v13, 2, v27
    v_add_u32 v43, v12, v11
    v_bitop3_b32 v27, v5, v13, v14 bitop3:0xea
    ds_add_u32 v27, v2
    v_cvt_pk_bf16_f32 v33, v9, v10
    v_perm_b32 v12, v33, v33, s41
    v_bitop3_b32 v42, v4, v12, v42 bitop3:0xca
    v_perm_b32 v13, v33, v33, s42
    v_bitop3_b32 v43, v4, v13, v43 bitop3:0xca
    s_waitcnt vmcnt(16)
    v_lshlrev_b32 v7, 16, v34
    v_and_b32 v8, 0xffff0000, v34
    v_lshlrev_b32 v9, 16, v35
    v_and_b32 v10, 0xffff0000, v35
    v_mul_f32 v7, 0.15915494, v7
    v_mul_f32 v8, 0.15915494, v8
    v_mul_f32 v9, 0.15915494, v9
    v_mul_f32 v10, 0.15915494, v10
    v_mul_hi_u32_u24 v14, 429497, v48
    v_lshrrev_b32 v12, 3, v52
    v_cos_f32 v7, v7
    v_lshlrev_b16 v13, 3, v52
    v_mad_i32_i24 v11, v14, s55, v48
    v_bitop3_b32 v12, v6, v13, v12 bitop3:0xca
    v_lshl_add_u32 v11, v11, 17, s40
    v_lshlrev_b16 v14, 8, v14
    v_lshrrev_b32 v13, 2, v52
    v_add_u32 v48, v12, v11
    v_bitop3_b32 v52, v5, v13, v14 bitop3:0xea
    ds_add_u32 v52, v2
    v_mul_hi_u32_u24 v14, 429497, v49
    v_lshrrev_b32 v12, 3, v53
    v_cos_f32 v8, v8
    v_lshlrev_b16 v13, 3, v53
    v_mad_i32_i24 v11, v14, s55, v49
    v_bitop3_b32 v12, v6, v13, v12 bitop3:0xca
    v_lshl_add_u32 v11, v11, 17, s40
    v_lshlrev_b16 v14, 8, v14
    v_lshrrev_b32 v13, 2, v53
    v_add_u32 v49, v12, v11
    v_bitop3_b32 v53, v5, v13, v14 bitop3:0xea
    ds_add_u32 v53, v2
    v_cvt_pk_bf16_f32 v34, v7, v8
    v_perm_b32 v12, v34, v34, s41
    v_bitop3_b32 v48, v4, v12, v48 bitop3:0xca
    v_perm_b32 v13, v34, v34, s42
    v_bitop3_b32 v49, v4, v13, v49 bitop3:0xca
    v_mul_hi_u32_u24 v14, 429497, v50
    v_lshrrev_b32 v12, 3, v54
    v_cos_f32 v9, v9
    v_lshlrev_b16 v13, 3, v54
    v_mad_i32_i24 v11, v14, s55, v50
    v_bitop3_b32 v12, v6, v13, v12 bitop3:0xca
    v_lshl_add_u32 v11, v11, 17, s40
    v_lshlrev_b16 v14, 8, v14
    v_lshrrev_b32 v13, 2, v54
    v_add_u32 v50, v12, v11
    v_bitop3_b32 v54, v5, v13, v14 bitop3:0xea
    ds_add_u32 v54, v2
    v_mul_hi_u32_u24 v14, 429497, v51
    v_lshrrev_b32 v12, 3, v55
    v_cos_f32 v10, v10
    v_lshlrev_b16 v13, 3, v55
    v_mad_i32_i24 v11, v14, s55, v51
    v_bitop3_b32 v12, v6, v13, v12 bitop3:0xca
    v_lshl_add_u32 v11, v11, 17, s40
    v_lshlrev_b16 v14, 8, v14
    v_lshrrev_b32 v13, 2, v55
    v_add_u32 v51, v12, v11
    v_bitop3_b32 v55, v5, v13, v14 bitop3:0xea
    ds_add_u32 v55, v2
    v_cvt_pk_bf16_f32 v35, v9, v10
    v_perm_b32 v12, v35, v35, s41
    v_bitop3_b32 v50, v4, v12, v50 bitop3:0xca
    v_perm_b32 v13, v35, v35, s42
    v_bitop3_b32 v51, v4, v13, v51 bitop3:0xca
    s_setprio 1
    s_waitcnt vmcnt(12)
    v_lshlrev_b32 v7, 16, v72
    v_and_b32 v8, 0xffff0000, v72
    v_lshlrev_b32 v9, 16, v73
    v_and_b32 v10, 0xffff0000, v73
    v_mul_f32 v7, 0.15915494, v7
    v_mul_f32 v8, 0.15915494, v8
    v_mul_f32 v9, 0.15915494, v9
    v_mul_f32 v10, 0.15915494, v10
    v_mul_hi_u32_u24 v14, 429497, v84
    v_lshrrev_b32 v12, 3, v68
    v_cos_f32 v7, v7
    v_lshlrev_b16 v13, 3, v68
    v_mad_i32_i24 v11, v14, s55, v84
    v_bitop3_b32 v12, v6, v13, v12 bitop3:0xca
    v_lshl_add_u32 v11, v11, 17, s40
    v_lshlrev_b16 v14, 8, v14
    v_lshrrev_b32 v13, 2, v68
    v_add_u32 v84, v12, v11
    v_bitop3_b32 v68, v5, v13, v14 bitop3:0xea
    ds_add_u32 v68, v2
    v_mul_hi_u32_u24 v14, 429497, v85
    v_lshrrev_b32 v12, 3, v69
    v_cos_f32 v8, v8
    v_lshlrev_b16 v13, 3, v69
    v_mad_i32_i24 v11, v14, s55, v85
    v_bitop3_b32 v12, v6, v13, v12 bitop3:0xca
    v_lshl_add_u32 v11, v11, 17, s40
    v_lshlrev_b16 v14, 8, v14
    v_lshrrev_b32 v13, 2, v69
    v_add_u32 v85, v12, v11
    v_bitop3_b32 v69, v5, v13, v14 bitop3:0xea
    ds_add_u32 v69, v2
    v_cvt_pk_bf16_f32 v72, v7, v8
    v_perm_b32 v12, v72, v72, s41
    v_bitop3_b32 v84, v4, v12, v84 bitop3:0xca
    v_perm_b32 v13, v72, v72, s42
    v_bitop3_b32 v85, v4, v13, v85 bitop3:0xca
    v_mul_hi_u32_u24 v14, 429497, v86
    v_lshrrev_b32 v12, 3, v70
    v_cos_f32 v9, v9
    v_lshlrev_b16 v13, 3, v70
    v_mad_i32_i24 v11, v14, s55, v86
    v_bitop3_b32 v12, v6, v13, v12 bitop3:0xca
    v_lshl_add_u32 v11, v11, 17, s40
    v_lshlrev_b16 v14, 8, v14
    v_lshrrev_b32 v13, 2, v70
    v_add_u32 v86, v12, v11
    v_bitop3_b32 v70, v5, v13, v14 bitop3:0xea
    ds_add_u32 v70, v2
    v_mul_hi_u32_u24 v14, 429497, v87
    v_lshrrev_b32 v12, 3, v71
    v_cos_f32 v10, v10
    v_lshlrev_b16 v13, 3, v71
    v_mad_i32_i24 v11, v14, s55, v87
    v_bitop3_b32 v12, v6, v13, v12 bitop3:0xca
    v_lshl_add_u32 v11, v11, 17, s40
    v_lshlrev_b16 v14, 8, v14
    v_lshrrev_b32 v13, 2, v71
    v_add_u32 v87, v12, v11
    v_bitop3_b32 v71, v5, v13, v14 bitop3:0xea
    ds_add_u32 v71, v2
    v_cvt_pk_bf16_f32 v73, v9, v10
    v_perm_b32 v12, v73, v73, s41
    v_bitop3_b32 v86, v4, v12, v86 bitop3:0xca
    v_perm_b32 v13, v73, v73, s42
    v_bitop3_b32 v87, v4, v13, v87 bitop3:0xca
    s_add_u32 s45, s35, 0x7ec4000
    s_add_u32 s45, s45, s91
    buffer_store_dwordx4 v[104:107], v0, s[20:23], s45 offen sc1
    s_waitcnt vmcnt(10)
    s_cmp_le_u32 s43, 5
    s_cbranch_scc1 L1_s5
    v_lshlrev_b32 v7, 16, v74
    v_and_b32 v8, 0xffff0000, v74
    v_lshlrev_b32 v9, 16, v75
    v_and_b32 v10, 0xffff0000, v75
    v_mul_f32 v7, 0.15915494, v7
    v_mul_f32 v8, 0.15915494, v8
    v_mul_f32 v9, 0.15915494, v9
    v_mul_f32 v10, 0.15915494, v10
    v_mul_hi_u32_u24 v14, 429497, v36
    v_lshrrev_b32 v12, 3, v76
    v_cos_f32 v7, v7
    v_lshlrev_b16 v13, 3, v76
    v_mad_i32_i24 v11, v14, s55, v36
    v_bitop3_b32 v12, v6, v13, v12 bitop3:0xca
    v_lshl_add_u32 v11, v11, 17, s40
    v_lshlrev_b16 v14, 8, v14
    v_lshrrev_b32 v13, 2, v76
    v_add_u32 v36, v12, v11
    v_bitop3_b32 v76, v5, v13, v14 bitop3:0xea
    ds_add_u32 v76, v2
    v_mul_hi_u32_u24 v14, 429497, v37
    v_lshrrev_b32 v12, 3, v77
    v_cos_f32 v8, v8
    v_lshlrev_b16 v13, 3, v77
    v_mad_i32_i24 v11, v14, s55, v37
    v_bitop3_b32 v12, v6, v13, v12 bitop3:0xca
    v_lshl_add_u32 v11, v11, 17, s40
    v_lshlrev_b16 v14, 8, v14
    v_lshrrev_b32 v13, 2, v77
    v_add_u32 v37, v12, v11
    v_bitop3_b32 v77, v5, v13, v14 bitop3:0xea
    ds_add_u32 v77, v2
    v_cvt_pk_bf16_f32 v74, v7, v8
    v_perm_b32 v12, v74, v74, s41
    v_bitop3_b32 v36, v4, v12, v36 bitop3:0xca
    v_perm_b32 v13, v74, v74, s42
    v_bitop3_b32 v37, v4, v13, v37 bitop3:0xca
    v_mul_hi_u32_u24 v14, 429497, v38
    v_lshrrev_b32 v12, 3, v78
    v_cos_f32 v9, v9
    v_lshlrev_b16 v13, 3, v78
    v_mad_i32_i24 v11, v14, s55, v38
    v_bitop3_b32 v12, v6, v13, v12 bitop3:0xca
    v_lshl_add_u32 v11, v11, 17, s40
    v_lshlrev_b16 v14, 8, v14
    v_lshrrev_b32 v13, 2, v78
    v_add_u32 v38, v12, v11
    v_bitop3_b32 v78, v5, v13, v14 bitop3:0xea
    ds_add_u32 v78, v2
    v_mul_hi_u32_u24 v14, 429497, v39
    v_lshrrev_b32 v12, 3, v79
    v_cos_f32 v10, v10
    v_lshlrev_b16 v13, 3, v79
    v_mad_i32_i24 v11, v14, s55, v39
    v_bitop3_b32 v12, v6, v13, v12 bitop3:0xca
    v_lshl_add_u32 v11, v11, 17, s40
    v_lshlrev_b16 v14, 8, v14
    v_lshrrev_b32 v13, 2, v79
    v_add_u32 v39, v12, v11
    v_bitop3_b32 v79, v5, v13, v14 bitop3:0xea
    ds_add_u32 v79, v2
    v_cvt_pk_bf16_f32 v75, v9, v10
    v_perm_b32 v12, v75, v75, s41
    v_bitop3_b32 v38, v4, v12, v38 bitop3:0xca
    v_perm_b32 v13, v75, v75, s42
    v_bitop3_b32 v39, v4, v13, v39 bitop3:0xca
L1_s5:
    s_setprio 0
    s_waitcnt vmcnt(6)
    s_cmp_le_u32 s43, 6
    s_cbranch_scc1 L1_s6
    v_lshlrev_b32 v7, 16, v64
    v_and_b32 v8, 0xffff0000, v64
    v_lshlrev_b32 v9, 16, v65
    v_and_b32 v10, 0xffff0000, v65
    v_mul_f32 v7, 0.15915494, v7
    v_mul_f32 v8, 0.15915494, v8
    v_mul_f32 v9, 0.15915494, v9
    v_mul_f32 v10, 0.15915494, v10
    v_mul_hi_u32_u24 v14, 429497, v80
    v_lshrrev_b32 v12, 3, v56
    v_cos_f32 v7, v7
    v_lshlrev_b16 v13, 3, v56
    v_mad_i32_i24 v11, v14, s55, v80
    v_bitop3_b32 v12, v6, v13, v12 bitop3:0xca
    v_lshl_add_u32 v11, v11, 17, s40
    v_lshlrev_b16 v14, 8, v14
    v_lshrrev_b32 v13, 2, v56
    v_add_u32 v80, v12, v11
    v_bitop3_b32 v56, v5, v13, v14 bitop3:0xea
    ds_add_u32 v56, v2
    v_mul_hi_u32_u24 v14, 429497, v81
    v_lshrrev_b32 v12, 3, v57
    v_cos_f32 v8, v8
    v_lshlrev_b16 v13, 3, v57
    v_mad_i32_i24 v11, v14, s55, v81
    v_bitop3_b32 v12, v6, v13, v12 bitop3:0xca
    v_lshl_add_u32 v11, v11, 17, s40
    v_lshlrev_b16 v14, 8, v14
    v_lshrrev_b32 v13, 2, v57
    v_add_u32 v81, v12, v11
    v_bitop3_b32 v57, v5, v13, v14 bitop3:0xea
    ds_add_u32 v57, v2
    v_cvt_pk_bf16_f32 v64, v7, v8
    v_perm_b32 v12, v64, v64, s41
    v_bitop3_b32 v80, v4, v12, v80 bitop3:0xca
    v_perm_b32 v13, v64, v64, s42
    v_bitop3_b32 v81, v4, v13, v81 bitop3:0xca
    v_mul_hi_u32_u24 v14, 429497, v82
    v_lshrrev_b32 v12, 3, v58
    v_cos_f32 v9, v9
    v_lshlrev_b16 v13, 3, v58
    v_mad_i32_i24 v11, v14, s55, v82
    v_bitop3_b32 v12, v6, v13, v12 bitop3:0xca
    v_lshl_add_u32 v11, v11, 17, s40
    v_lshlrev_b16 v14, 8, v14
    v_lshrrev_b32 v13, 2, v58
    v_add_u32 v82, v12, v11
    v_bitop3_b32 v58, v5, v13, v14 bitop3:0xea
    ds_add_u32 v58, v2
    v_mul_hi_u32_u24 v14, 429497, v83
    v_lshrrev_b32 v12, 3, v59
    v_cos_f32 v10, v10
    v_lshlrev_b16 v13, 3, v59
    v_mad_i32_i24 v11, v14, s55, v83
    v_bitop3_b32 v12, v6, v13, v12 bitop3:0xca
    v_lshl_add_u32 v11, v11, 17, s40
    v_lshlrev_b16 v14, 8, v14
    v_lshrrev_b32 v13, 2, v59
    v_add_u32 v83, v12, v11
    v_bitop3_b32 v59, v5, v13, v14 bitop3:0xea
    ds_add_u32 v59, v2
    v_cvt_pk_bf16_f32 v65, v9, v10
    v_perm_b32 v12, v65, v65, s41
    v_bitop3_b32 v82, v4, v12, v82 bitop3:0xca
    v_perm_b32 v13, v65, v65, s42
    v_bitop3_b32 v83, v4, v13, v83 bitop3:0xca
L1_s6:
    s_waitcnt vmcnt(2)
    s_cmp_le_u32 s43, 7
    s_cbranch_scc1 L1_s7
    v_lshlrev_b32 v7, 16, v66
    v_and_b32 v8, 0xffff0000, v66
    v_lshlrev_b32 v9, 16, v67
    v_and_b32 v10, 0xffff0000, v67
    v_mul_f32 v7, 0.15915494, v7
    v_mul_f32 v8, 0.15915494, v8
    v_mul_f32 v9, 0.15915494, v9
    v_mul_f32 v10, 0.15915494, v10
    v_mul_hi_u32_u24 v14, 429497, v96
    v_lshrrev_b32 v12, 3, v60
    v_cos_f32 v7, v7
    v_lshlrev_b16 v13, 3, v60
    v_mad_i32_i24 v11, v14, s55, v96
    v_bitop3_b32 v12, v6, v13, v12 bitop3:0xca
    v_lshl_add_u32 v11, v11, 17, s40
    v_lshlrev_b16 v14, 8, v14
    v_lshrrev_b32 v13, 2, v60
    v_add_u32 v96, v12, v11
    v_bitop3_b32 v60, v5, v13, v14 bitop3:0xea
    ds_add_u32 v60, v2
    v_mul_hi_u32_u24 v14, 429497, v97
    v_lshrrev_b32 v12, 3, v61
    v_cos_f32 v8, v8
    v_lshlrev_b16 v13, 3, v61
    v_mad_i32_i24 v11, v14, s55, v97
    v_bitop3_b32 v12, v6, v13, v12 bitop3:0xca
    v_lshl_add_u32 v11, v11, 17, s40
    v_lshlrev_b16 v14, 8, v14
    v_lshrrev_b32 v13, 2, v61
    v_add_u32 v97, v12, v11
    v_bitop3_b32 v61, v5, v13, v14 bitop3:0xea
    ds_add_u32 v61, v2
    v_cvt_pk_bf16_f32 v66, v7, v8
    v_perm_b32 v12, v66, v66, s41
    v_bitop3_b32 v96, v4, v12, v96 bitop3:0xca
    v_perm_b32 v13, v66, v66, s42
    v_bitop3_b32 v97, v4, v13, v97 bitop3:0xca
    v_mul_hi_u32_u24 v14, 429497, v98
    v_lshrrev_b32 v12, 3, v62
    v_cos_f32 v9, v9
    v_lshlrev_b16 v13, 3, v62
    v_mad_i32_i24 v11, v14, s55, v98
    v_bitop3_b32 v12, v6, v13, v12 bitop3:0xca
    v_lshl_add_u32 v11, v11, 17, s40
    v_lshlrev_b16 v14, 8, v14
    v_lshrrev_b32 v13, 2, v62
    v_add_u32 v98, v12, v11
    v_bitop3_b32 v62, v5, v13, v14 bitop3:0xea
    ds_add_u32 v62, v2
    v_mul_hi_u32_u24 v14, 429497, v99
    v_lshrrev_b32 v12, 3, v63
    v_cos_f32 v10, v10
    v_lshlrev_b16 v13, 3, v63
    v_mad_i32_i24 v11, v14, s55, v99
    v_bitop3_b32 v12, v6, v13, v12 bitop3:0xca
    v_lshl_add_u32 v11, v11, 17, s40
    v_lshlrev_b16 v14, 8, v14
    v_lshrrev_b32 v13, 2, v63
    v_add_u32 v99, v12, v11
    v_bitop3_b32 v63, v5, v13, v14 bitop3:0xea
    ds_add_u32 v63, v2
    v_cvt_pk_bf16_f32 v67, v9, v10
    v_perm_b32 v12, v67, v67, s41
    v_bitop3_b32 v98, v4, v12, v98 bitop3:0xca
    v_perm_b32 v13, v67, v67, s42
    v_bitop3_b32 v99, v4, v13, v99 bitop3:0xca
L1_s7:
    v_lshrrev_b32 v8, 2, v0
    v_and_b32 v7, 0x3c00, v0
    v_bitop3_b32 v7, v5, v8, v7 bitop3:0xea
    s_waitcnt lgkmcnt(0)
    s_barrier
    ds_read2st64_b32 v[8:9], v7 offset0:0 offset1:1
    ds_read2st64_b32 v[10:11], v7 offset0:2 offset1:3
    s_add_u32 s46, s35, 0x7ec4000
    s_add_u32 s46, s46, s93
    buffer_store_dwordx4 v[28:31], v0, s[20:23], s46 offen sc1
    s_waitcnt lgkmcnt(0)
    v_lshl_or_b32 v12, v9, 16, v8
    v_lshl_or_b32 v13, v11, 16, v10
    v_mov_b32 v14, v12
    v_mov_b32 v15, v13
    s_nop 0
    v_add_u32_dpp v14, v14, v14 row_shr:1 row_mask:0xf bank_mask:0xf bound_ctrl:1
    v_add_u32_dpp v15, v15, v15 row_shr:1 row_mask:0xf bank_mask:0xf bound_ctrl:1
    s_nop 0
    v_add_u32_dpp v14, v14, v14 row_shr:2 row_mask:0xf bank_mask:0xf bound_ctrl:1
    v_add_u32_dpp v15, v15, v15 row_shr:2 row_mask:0xf bank_mask:0xf bound_ctrl:1
    s_nop 0
    v_add_u32_dpp v14, v14, v14 row_shr:4 row_mask:0xf bank_mask:0xf bound_ctrl:1
    v_add_u32_dpp v15, v15, v15 row_shr:4 row_mask:0xf bank_mask:0xf bound_ctrl:1
    s_nop 0
    v_add_u32_dpp v14, v14, v14 row_shr:8 row_mask:0xf bank_mask:0xf bound_ctrl:1
    v_add_u32_dpp v15, v15, v15 row_shr:8 row_mask:0xf bank_mask:0xf bound_ctrl:1
    s_nop 0
    v_add_u32_dpp v14, v14, v14 row_bcast:15 row_mask:0xa bank_mask:0xf
    v_add_u32_dpp v15, v15, v15 row_bcast:15 row_mask:0xa bank_mask:0xf
    s_nop 0
    v_add_u32_dpp v14, v14, v14 row_bcast:31 row_mask:0xc bank_mask:0xf
    v_add_u32_dpp v15, v15, v15 row_bcast:31 row_mask:0xc bank_mask:0xf
    v_readlane_b32 s48, v14, 63
    v_readlane_b32 s49, v15, 63
    s_lshl_b32 s54, s32, 2
    v_mov_b32 v8, s54
    s_and_b32 s50, s48, 0xffff
    s_lshr_b32 s51, s48, 16
    s_and_b32 s52, s49, 0xffff
    s_lshr_b32 s53, s49, 16
    s_add_u32 s51, s51, s50
    s_add_u32 s52, s52, s51
    s_add_u32 s53, s53, s52
    v_mov_b32 v9, s53
    v_and_b32_dpp v3, v3, v3 quad_perm:[1,0,3,2] row_mask:0xf bank_mask:0xf
    s_mov_b64 exec, 1
    ds_write_b32 v8, v9 offset:16384
    ds_write_b32 v8, v3 offset:16448
    s_mov_b64 exec, -1
    v_and_b32 v8, 60, v7
    s_waitcnt lgkmcnt(0)
    s_barrier
    ds_read_b32 v9, v8 offset:16384
    ds_read_b32 v10, v8 offset:16448
    s_waitcnt lgkmcnt(0)
    v_readlane_b32 s56, v10, 15
    s_xor_b32 s56, s56, 0x80
    v_add_u32_dpp v9, v9, v9 row_shr:1 row_mask:0xf bank_mask:0xf bound_ctrl:1
    s_nop 1
    v_add_u32_dpp v9, v9, v9 row_shr:2 row_mask:0xf bank_mask:0xf bound_ctrl:1
    s_nop 1
    v_add_u32_dpp v9, v9, v9 row_shr:4 row_mask:0xf bank_mask:0xf bound_ctrl:1
    s_nop 1
    v_add_u32_dpp v9, v9, v9 row_shr:8 row_mask:0xf bank_mask:0xf bound_ctrl:1
    s_nop 0
    v_readlane_b32 s54, v9, s32
    s_sub_u32 s54, s54, s53
    s_add_u32 s50, s50, s54
    s_add_u32 s51, s51, s54
    s_add_u32 s52, s52, s54
    s_pack_ll_b32_b16 s48, s54, s50
    s_pack_ll_b32_b16 s49, s51, s52
    v_add_u32 v14, s48, v14
    v_add_u32 v15, s49, v15
    v_sub_u32 v12, v14, v12
    v_sub_u32 v13, v15, v13
    v_and_b32 v8, 0xffff, v12
    v_lshrrev_b32 v9, 16, v12
    v_and_b32 v10, 0xffff, v13
    v_lshrrev_b32 v11, 16, v13
    ds_write2st64_b32 v7, v8, v9 offset0:0 offset1:1
    ds_write2st64_b32 v7, v10, v11 offset0:2 offset1:3
    v_and_b32 v8, 0x3f0, v0
    v_lshl_add_u32 v8, v8, 1, s36
    ds_write_b64 v8, v[12:13] offset:20480
    s_bitset0_b64 exec, 63
    s_not_b64 exec, exec
    ds_write_b64 v8, v[14:15] offset:20512
    s_mov_b64 exec, -1
    s_waitcnt lgkmcnt(0)
    s_barrier
    s_setprio 3
    ds_add_rtn_u32 v120, v120, v2
    ds_add_rtn_u32 v121, v121, v2
    ds_add_rtn_u32 v122, v122, v2
    ds_add_rtn_u32 v123, v123, v2
    ds_read_b128 v[12:15], v0 offset:20480
    v_cmp_gt_u32 vcc, 8448, v0
    ds_add_rtn_u32 v124, v124, v2
    ds_add_rtn_u32 v125, v125, v2
    ds_add_rtn_u32 v126, v126, v2
    ds_add_rtn_u32 v127, v127, v2
    s_setprio 2
    ds_add_rtn_u32 v24, v24, v2
    ds_add_rtn_u32 v25, v25, v2
    ds_add_rtn_u32 v26, v26, v2
    ds_add_rtn_u32 v27, v27, v2
    s_waitcnt lgkmcnt(8)
    s_cbranch_vccz L1_p8
    s_add_u32 s47, s35, 0xa900000
    s_mov_b64 exec, vcc
    buffer_store_dwordx4 v[12:15], v0, s[24:27], s47 offen sc1
    s_mov_b64 exec, -1
L1_p8:
    s_add_u32 s44, s35, 0x7ec8000
    s_add_u32 s44, s44, s72
    buffer_store_dwordx4 v[112:115], v0, s[20:23], s44 offen sc1
    ds_add_rtn_u32 v52, v52, v2
    ds_add_rtn_u32 v53, v53, v2
    ds_add_rtn_u32 v54, v54, v2
    ds_add_rtn_u32 v55, v55, v2
    s_load_dwordx2 s[28:29], s[0:1], 0
    s_load_dwordx2 s[50:51], s[0:1], 40
    s_load_dwordx2 s[52:53], s[0:1], 24
    s_setprio 1
    ds_add_rtn_u32 v68, v68, v2
    ds_add_rtn_u32 v69, v69, v2
    ds_add_rtn_u32 v70, v70, v2
    ds_add_rtn_u32 v71, v71, v2
    s_cmp_le_u32 s43, 5
    s_cbranch_scc1 L1_s9
    ds_add_rtn_u32 v76, v76, v2
    ds_add_rtn_u32 v77, v77, v2
    ds_add_rtn_u32 v78, v78, v2
    ds_add_rtn_u32 v79, v79, v2
L1_s9:
    s_add_u32 s45, s35, 0x7ec8000
    s_add_u32 s45, s45, s73
    buffer_store_dwordx4 v[88:91], v0, s[20:23], s45 offen sc1
    s_setprio 0
    s_cmp_le_u32 s43, 6
    s_cbranch_scc1 L1_s10
    ds_add_rtn_u32 v56, v56, v2
    ds_add_rtn_u32 v57, v57, v2
    ds_add_rtn_u32 v58, v58, v2
    ds_add_rtn_u32 v59, v59, v2
L1_s10:
    s_cmp_le_u32 s43, 7
    s_cbranch_scc1 L1_s11
    ds_add_rtn_u32 v60, v60, v2
    ds_add_rtn_u32 v61, v61, v2
    ds_add_rtn_u32 v62, v62, v2
    ds_add_rtn_u32 v63, v63, v2
L1_s11:
    s_waitcnt lgkmcnt(0)
    s_barrier
    s_load_dwordx4 s[96:99], s[50:51], 0
    s_mov_b64 s[4:5], s[52:53]
    s_bfe_u32 s33, s2, 0x20001
    s_and_b32 s34, s2, 1
    s_lshl_b32 s34, s34, 5
    s_lshr_b32 s3, s2, 3
    s_add_u32 s34, s34, s3
    s_mul_i32 s39, s33, 2080
    s_lshl_b32 s3, s34, 5
    s_add_u32 s39, s39, s3
    s_mul_i32 s40, s33, 1310720
    s_add_u32 s40, s40, 0x50000
    s_lshl_b32 s38, s32, 11
    s_mul_i32 s100, s32, 3072
    s_add_u32 s8, s30, 0x4000
    s_addc_u32 s9, s31, 0
    s_mov_b32 s10, 0xd340000
    s_mov_b32 s11, 0x20000
    s_add_u32 s12, s30, 0x2c000
    s_addc_u32 s13, s31, 0
    s_mov_b32 s14, 0xd318000
    s_mov_b32 s15, 0x20000
    s_mov_b32 s16, s64
    s_mov_b32 s17, s65
    s_mov_b32 s18, 0x20
    s_mov_b32 s19, 0x20000
    s_mov_b32 s24, s28
    s_mov_b32 s25, s29
    s_mov_b32 s26, 0x4e2000
    s_mov_b32 s27, 0x20000
    s_setprio 3
    v_and_b32 v7, -4, v120
    v_lshl_add_u32 v8, v120, 2, v7
    ds_write_b32 v8, v16
    v_lshl_add_u32 v7, v7, 2, v120
    ds_write_b8 v7, v44 offset:16
    v_and_b32 v9, -4, v121
    v_lshl_add_u32 v10, v121, 2, v9
    ds_write_b32 v10, v17
    v_lshl_add_u32 v9, v9, 2, v121
    ds_write_b8_d16_hi v9, v44 offset:16
    v_and_b32 v7, -4, v122
    v_lshl_add_u32 v8, v122, 2, v7
    ds_write_b32 v8, v18
    v_lshl_add_u32 v7, v7, 2, v122
    ds_write_b8 v7, v45 offset:16
    v_and_b32 v9, -4, v123
    v_lshl_add_u32 v10, v123, 2, v9
    ds_write_b32 v10, v19
    v_lshl_add_u32 v9, v9, 2, v123
    ds_write_b8_d16_hi v9, v45 offset:16
    s_add_u32 s46, s35, 0x7ec8000
    s_add_u32 s46, s46, s85
    buffer_store_dwordx4 v[116:119], v0, s[20:23], s46 offen sc1
    v_and_b32 v13, 0x3f0, v0
    v_and_b32 v14, 0x300, v13
    v_bfe_u32 v15, v13, 4, 4
    s_lshl_b32 s3, s32, 4
    v_add3_u32 v14, v14, v15, s3
    v_mul_u32_u24 v2, 173056, v14
    v_lshrrev_b32 v14, 6, v13
    s_add_u32 s3, s3, 0x400
    v_add_u32 v14, s3, v14
    v_mul_u32_u24 v4, 173056, v14
    v_and_b32 v14, 3, v14
    v_and_b32 v15, 0x30, v13
    v_lshl_add_u32 v14, v14, 5, v15
    v_add_u32 v6, v14, v4
    v_lshl_add_u32 v5, v15, 1, v2
    v_lshrrev_b32 v14, 3, v15
    buffer_load_ushort v100, v14, s[16:19], 0 offen offset:0
    buffer_load_ushort v101, v14, s[16:19], 0 offen offset:8
    buffer_load_ushort v102, v14, s[16:19], 0 offen offset:16
    buffer_load_ushort v103, v14, s[16:19], 0 offen offset:24
    s_mul_i32 s3, s32, 5120
    v_add_u32 v3, s3, v13
    v_lshrrev_b32 v14, 2, v13
    v_add_u32 v14, s38, v14
    v_and_b32 v7, -4, v124
    v_lshl_add_u32 v8, v124, 2, v7
    ds_write_b32 v8, v20
    v_lshl_add_u32 v7, v7, 2, v124
    ds_write_b8 v7, v46 offset:16
    v_and_b32 v9, -4, v125
    v_lshl_add_u32 v10, v125, 2, v9
    ds_write_b32 v10, v21
    v_lshl_add_u32 v9, v9, 2, v125
    ds_write_b8_d16_hi v9, v46 offset:16
    v_and_b32 v7, -4, v126
    v_lshl_add_u32 v8, v126, 2, v7
    ds_write_b32 v8, v22
    v_lshl_add_u32 v7, v7, 2, v126
    ds_write_b8 v7, v47 offset:16
    v_and_b32 v9, -4, v127
    v_lshl_add_u32 v10, v127, 2, v9
    ds_write_b32 v10, v23
    v_lshl_add_u32 v9, v9, 2, v127
    ds_write_b8_d16_hi v9, v47 offset:16
    v_lshrrev_b32 v11, 2, v0
    v_and_b32 v11, 0xfc, v11
    s_cmp_ge_u32 s84, 128
    s_cselect_b32 s82, 0, s82
    s_and_b32 s3, s84, 1
    s_mul_i32 s3, s3, 40
    s_add_u32 s3, s3, s32
    s_mul_i32 s74, s3, 205
    s_lshr_b32 s74, s74, 10
    s_mul_i32 s75, s74, 5
    s_sub_u32 s75, s3, s75
    s_lshl_b32 s48, s74, 1
    s_add_u32 s48, s48, s75
    s_add_u32 s49, s48, s74
    s_add_u32 s49, s49, 30
    s_cmp_lt_u32 s75, 2
    s_cselect_b32 s48, s48, s49
    s_lshl_b32 s48, s48, 10
    s_lshr_b32 s49, s84, 1
    s_mul_i32 s49, s49, 80000
    s_add_u32 s48, s48, s49
    buffer_load_dword v104, v11, s[80:83], s48 offen offset:0
    buffer_load_dword v105, v11, s[80:83], s48 offen offset:256
    buffer_load_dword v106, v11, s[80:83], s48 offen offset:512
    buffer_load_dword v107, v11, s[80:83], s48 offen offset:768
    s_and_b32 s3, s84, 1
    s_mul_i32 s3, s3, 40
    s_add_u32 s3, s3, s32
    s_add_u32 s3, s3, 16
    s_mul_i32 s74, s3, 205
    s_lshr_b32 s74, s74, 10
    s_mul_i32 s75, s74, 5
    s_sub_u32 s75, s3, s75
    s_lshl_b32 s48, s74, 1
    s_add_u32 s48, s48, s75
    s_add_u32 s49, s48, s74
    s_add_u32 s49, s49, 30
    s_cmp_lt_u32 s75, 2
    s_cselect_b32 s48, s48, s49
    s_lshl_b32 s48, s48, 10
    s_lshr_b32 s49, s84, 1
    s_mul_i32 s49, s49, 80000
    s_add_u32 s48, s48, s49
    buffer_load_dword v28, v11, s[80:83], s48 offen offset:0
    buffer_load_dword v29, v11, s[80:83], s48 offen offset:256
    buffer_load_dword v30, v11, s[80:83], s48 offen offset:512
    buffer_load_dword v31, v11, s[80:83], s48 offen offset:768
    s_and_b32 s3, s84, 1
    s_mul_i32 s3, s3, 40
    s_add_u32 s3, s3, s32
    s_add_u32 s3, s3, 32
    s_cmp_ge_u32 s32, 8
    s_cselect_b32 s82, 0, s82
    s_mul_i32 s74, s3, 205
    s_lshr_b32 s74, s74, 10
    s_mul_i32 s75, s74, 5
    s_sub_u32 s75, s3, s75
    s_lshl_b32 s48, s74, 1
    s_add_u32 s48, s48, s75
    s_add_u32 s49, s48, s74
    s_add_u32 s49, s49, 30
    s_cmp_lt_u32 s75, 2
    s_cselect_b32 s48, s48, s49
    s_lshl_b32 s48, s48, 10
    s_lshr_b32 s49, s84, 1
    s_mul_i32 s49, s49, 80000
    s_add_u32 s48, s48, s49
    buffer_load_dword v112, v11, s[80:83], s48 offen offset:0
    buffer_load_dword v113, v11, s[80:83], s48 offen offset:256
    buffer_load_dword v114, v11, s[80:83], s48 offen offset:512
    buffer_load_dword v115, v11, s[80:83], s48 offen offset:768
    s_setprio 2
    v_and_b32 v7, -4, v24
    v_lshl_add_u32 v8, v24, 2, v7
    ds_write_b32 v8, v40
    v_lshl_add_u32 v7, v7, 2, v24
    ds_write_b8 v7, v32 offset:16
    v_and_b32 v9, -4, v25
    v_lshl_add_u32 v10, v25, 2, v9
    ds_write_b32 v10, v41
    v_lshl_add_u32 v9, v9, 2, v25
    ds_write_b8_d16_hi v9, v32 offset:16
    v_and_b32 v7, -4, v26
    v_lshl_add_u32 v8, v26, 2, v7
    ds_write_b32 v8, v42
    v_lshl_add_u32 v7, v7, 2, v26
    ds_write_b8 v7, v33 offset:16
    v_and_b32 v9, -4, v27
    v_lshl_add_u32 v10, v27, 2, v9
    ds_write_b32 v10, v43
    v_lshl_add_u32 v9, v9, 2, v27
    ds_write_b8_d16_hi v9, v33 offset:16
    s_add_u32 s47, s35, 0x7ec8000
    s_add_u32 s47, s47, s91
    buffer_store_dwordx4 v[92:95], v0, s[20:23], s47 offen sc1
    v_and_b32 v7, -4, v52
    v_lshl_add_u32 v8, v52, 2, v7
    ds_write_b32 v8, v48
    v_lshl_add_u32 v7, v7, 2, v52
    ds_write_b8 v7, v34 offset:16
    v_and_b32 v9, -4, v53
    v_lshl_add_u32 v10, v53, 2, v9
    ds_write_b32 v10, v49
    v_lshl_add_u32 v9, v9, 2, v53
    ds_write_b8_d16_hi v9, v34 offset:16
    v_and_b32 v7, -4, v54
    v_lshl_add_u32 v8, v54, 2, v7
    ds_write_b32 v8, v50
    v_lshl_add_u32 v7, v7, 2, v54
    ds_write_b8 v7, v35 offset:16
    v_and_b32 v9, -4, v55
    v_lshl_add_u32 v10, v55, 2, v9
    ds_write_b32 v10, v51
    v_lshl_add_u32 v9, v9, 2, v55
    ds_write_b8_d16_hi v9, v35 offset:16
    s_setprio 1
    v_and_b32 v7, -4, v68
    v_lshl_add_u32 v8, v68, 2, v7
    ds_write_b32 v8, v84
    v_lshl_add_u32 v7, v7, 2, v68
    ds_write_b8 v7, v72 offset:16
    v_and_b32 v9, -4, v69
    v_lshl_add_u32 v10, v69, 2, v9
    ds_write_b32 v10, v85
    v_lshl_add_u32 v9, v9, 2, v69
    ds_write_b8_d16_hi v9, v72 offset:16
    v_and_b32 v7, -4, v70
    v_lshl_add_u32 v8, v70, 2, v7
    ds_write_b32 v8, v86
    v_lshl_add_u32 v7, v7, 2, v70
    ds_write_b8 v7, v73 offset:16
    v_and_b32 v9, -4, v71
    v_lshl_add_u32 v10, v71, 2, v9
    ds_write_b32 v10, v87
    v_lshl_add_u32 v9, v9, 2, v71
    ds_write_b8_d16_hi v9, v73 offset:16
    s_cmp_le_u32 s43, 5
    s_cbranch_scc1 L1_s12
    v_and_b32 v7, -4, v76
    v_lshl_add_u32 v8, v76, 2, v7
    ds_write_b32 v8, v36
    v_lshl_add_u32 v7, v7, 2, v76
    ds_write_b8 v7, v74 offset:16
    v_and_b32 v9, -4, v77
    v_lshl_add_u32 v10, v77, 2, v9
    ds_write_b32 v10, v37
    v_lshl_add_u32 v9, v9, 2, v77
    ds_write_b8_d16_hi v9, v74 offset:16
    v_and_b32 v7, -4, v78
    v_lshl_add_u32 v8, v78, 2, v7
    ds_write_b32 v8, v38
    v_lshl_add_u32 v7, v7, 2, v78
    ds_write_b8 v7, v75 offset:16
    v_and_b32 v9, -4, v79
    v_lshl_add_u32 v10, v79, 2, v9
    ds_write_b32 v10, v39
    v_lshl_add_u32 v9, v9, 2, v79
    ds_write_b8_d16_hi v9, v75 offset:16
L1_s12:
    s_add_u32 s44, s35, 0x7ec8000
    s_add_u32 s44, s44, s93
    buffer_store_dwordx4 v[108:111], v0, s[20:23], s44 offen sc1
    s_setprio 0
    s_cmp_le_u32 s43, 6
    s_cbranch_scc1 L1_s13
    v_and_b32 v7, -4, v56
    v_lshl_add_u32 v8, v56, 2, v7
    ds_write_b32 v8, v80
    v_lshl_add_u32 v7, v7, 2, v56
    ds_write_b8 v7, v64 offset:16
    v_and_b32 v9, -4, v57
    v_lshl_add_u32 v10, v57, 2, v9
    ds_write_b32 v10, v81
    v_lshl_add_u32 v9, v9, 2, v57
    ds_write_b8_d16_hi v9, v64 offset:16
    v_and_b32 v7, -4, v58
    v_lshl_add_u32 v8, v58, 2, v7
    ds_write_b32 v8, v82
    v_lshl_add_u32 v7, v7, 2, v58
    ds_write_b8 v7, v65 offset:16
    v_and_b32 v9, -4, v59
    v_lshl_add_u32 v10, v59, 2, v9
    ds_write_b32 v10, v83
    v_lshl_add_u32 v9, v9, 2, v59
    ds_write_b8_d16_hi v9, v65 offset:16
L1_s13:
    s_add_u32 s80, s30, 0xd344000
    s_addc_u32 s81, s31, 0
    s_mov_b32 s82, 0xa000
    s_mov_b32 s83, 0x20000
    s_min_u32 s3, s84, 127
    s_mul_i32 s3, s3, 40960
    s_add_u32 s80, s80, s3
    s_addc_u32 s81, s81, 0
    s_cmp_ge_u32 s84, 128
    s_cselect_b32 s82, 0, s82
    s_waitcnt vmcnt(2)
    v_add_u32 v11, 0, v0
    buffer_store_dwordx4 v[104:107], v11, s[80:83], 0 offen sc1
    v_add_u32 v11, 16384, v0
    buffer_store_dwordx4 v[28:31], v11, s[80:83], 0 offen sc1
    v_add_u32 v11, 32768, v0
    buffer_store_dwordx4 v[112:115], v11, s[80:83], 0 offen sc1
    s_cmp_le_u32 s43, 7
    s_cbranch_scc1 L1_s14
    v_and_b32 v7, -4, v60
    v_lshl_add_u32 v8, v60, 2, v7
    ds_write_b32 v8, v96
    v_lshl_add_u32 v7, v7, 2, v60
    ds_write_b8 v7, v66 offset:16
    v_and_b32 v9, -4, v61
    v_lshl_add_u32 v10, v61, 2, v9
    ds_write_b32 v10, v97
    v_lshl_add_u32 v9, v9, 2, v61
    ds_write_b8_d16_hi v9, v66 offset:16
    v_and_b32 v7, -4, v62
    v_lshl_add_u32 v8, v62, 2, v7
    ds_write_b32 v8, v98
    v_lshl_add_u32 v7, v7, 2, v62
    ds_write_b8 v7, v67 offset:16
    v_and_b32 v9, -4, v63
    v_lshl_add_u32 v10, v63, 2, v9
    ds_write_b32 v10, v99
    v_lshl_add_u32 v9, v9, 2, v63
    ds_write_b8_d16_hi v9, v67 offset:16
L1_s14:
    v_add_u32 v7, 0x10000, v0
    v_add_u32 v12, 0x20000, v0
    s_waitcnt lgkmcnt(0)
    s_barrier
    ds_read_b128 v[24:27], v0 offset:0
    ds_read_b128 v[28:31], v0 offset:16384
    ds_read_b128 v[32:35], v0 offset:32768
    ds_read_b128 v[36:39], v0 offset:49152
    ds_read_b128 v[76:79], v7 offset:0
    ds_read_b128 v[80:83], v7 offset:16384
    ds_read_b128 v[84:87], v7 offset:32768
    ds_read_b128 v[104:107], v7 offset:49152
    ds_read_b128 v[68:71], v12 offset:0
    ds_read_b128 v[72:75], v12 offset:16384
    s_cmp_lg_u32 s32, 0
    s_cbranch_scc1 L2_sg1
    s_mov_b32 exec_hi, 0
    v_mov_b32 v11, 1
    buffer_store_dword v11, v14, s[60:63], s57 offen sc1
    s_mov_b64 exec, -1
L2_sg1:
    s_waitcnt lgkmcnt(9)
    s_add_u32 s45, s35, 0xa904000
    buffer_store_dwordx4 v[24:27], v0, s[20:23], s45 offen sc1
    s_waitcnt lgkmcnt(8)
    s_add_u32 s46, s35, 0xa908000
    buffer_store_dwordx4 v[28:31], v0, s[20:23], s46 offen sc1
    s_waitcnt lgkmcnt(7)
    s_add_u32 s47, s35, 0xa90c000
    buffer_store_dwordx4 v[32:35], v0, s[20:23], s47 offen sc1
    s_waitcnt lgkmcnt(6)
    s_add_u32 s44, s35, 0xa910000
    buffer_store_dwordx4 v[36:39], v0, s[20:23], s44 offen sc1
    s_waitcnt lgkmcnt(5)
    s_add_u32 s45, s35, 0xa914000
    buffer_store_dwordx4 v[76:79], v0, s[20:23], s45 offen sc1
    s_waitcnt lgkmcnt(4)
    s_add_u32 s46, s35, 0xa918000
    buffer_store_dwordx4 v[80:83], v0, s[20:23], s46 offen sc1
    s_waitcnt lgkmcnt(3)
    s_add_u32 s47, s35, 0xa91c000
    buffer_store_dwordx4 v[84:87], v0, s[20:23], s47 offen sc1
    s_waitcnt lgkmcnt(2)
    s_cmp_le_u32 s43, 5
    s_cbranch_scc1 L1_q15
    s_add_u32 s44, s35, 0xa920000
    buffer_store_dwordx4 v[104:107], v0, s[20:23], s44 offen sc1
L1_q15:
    s_waitcnt lgkmcnt(1)
    s_cmp_le_u32 s43, 6
    s_cbranch_scc1 L1_q16
    s_add_u32 s45, s35, 0xa924000
    buffer_store_dwordx4 v[68:71], v0, s[20:23], s45 offen sc1
L1_q16:
    s_waitcnt lgkmcnt(0)
    s_cmp_le_u32 s43, 7
    s_cbranch_scc1 L1_q17
    s_add_u32 s46, s35, 0xa928000
    buffer_store_dwordx4 v[72:75], v0, s[20:23], s46 offen sc1
L1_q17:
    s_waitcnt lgkmcnt(0)
    s_setprio 3
    v_mov_b32 v92, v0
    v_mov_b32 v93, v6
    v_mov_b32 v94, v13
    v_mov_b32 v95, v5
    v_mov_b32 v0, v14
    v_lshl_add_u32 v7, v13, 3, s38
    v_lshrrev_b32 v16, 2, v15
    v_mad_u32_u24 v4, v16, 5, v4
    v_or_b32 v4, 0xf0000000, v4
    v_or_b32 v2, 0xf0000000, v2
    v_sub_u32 v1, 28, v16
    v_lshrrev_b32 v17, 2, v16
    v_and_b32 v18, 3, v17
    v_lshlrev_b32 v18, 4, v18
    v_mov_b32 v10, 0x3f80
    v_mov_b32 v11, 0
    v_lshlrev_b64 v[10:11], v18, v[10:11]
    v_and_b32 v18, 3, v17
    v_lshlrev_b32 v18, 4, v18
    v_mov_b32 v12, 0xbf80
    v_mov_b32 v13, 0
    v_lshlrev_b64 v[12:13], v18, v[12:13]
    v_mov_b32 v45, 0xf0000000
    v_mov_b32 v5, 0x1fff8
    v_mov_b32 v6, 0x07ff0000
    v_mov_b32 v16, 0
    v_mov_b32 v17, 0
    v_mov_b32 v18, 0
    v_mov_b32 v19, 0
    v_add_u32 v20, 81920, v92
    v_add_u32 v21, 0x10000, v20
    s_setprio 1
    s_setprio 2
    s_mov_b32 s44, 0x4000c0c
    s_mov_b32 s45, 0x4010c0c
    s_mov_b32 s46, 0x4020c0c
    s_mov_b32 s47, 0x4030c0c
    s_mov_b32 s36, 0
    s_mov_b32 s43, 0
    s_mov_b32 s42, 0
    s_mov_b64 s[80:81], 0
    s_mov_b64 s[48:49], 0
    s_add_u32 s16, s30, 0xd344000
    s_addc_u32 s17, s31, 0
    s_mov_b32 s18, 0x500000
    s_mov_b32 s19, 0x20000
    v_mov_b32 v68, 0
    v_mov_b32 v69, 0
    v_mov_b32 v70, 0
    v_mov_b32 v71, 0
    v_mov_b32 v72, 0
    v_mov_b32 v73, 0
    v_mov_b32 v74, 0
    v_mov_b32 v75, 0
    s_waitcnt vmcnt(0)
    v_lshl_or_b32 v8, v101, 16, v100
    v_lshl_or_b32 v9, v103, 16, v102
    s_barrier
    s_cmp_lg_u32 s32, 0
    s_cbranch_scc1 L2_sg2
    s_mov_b32 exec_hi, 0
    v_mov_b32 v88, 2
    buffer_store_dword v88, v0, s[60:63], s57 offen sc1
    s_mov_b64 exec, -1
L2_sg2:
    s_mov_b64 s[84:85], 0
    s_mul_i32 s3, s33, 1280000
    s_add_u32 s3, s3, s100
    s_add_u32 s3, s3, 32768
    buffer_load_dwordx4 v[124:127], v94, s[24:27], s3 offen offset:2048
    s_mul_i32 s3, s33, 1280000
    s_add_u32 s3, s3, s100
    s_add_u32 s3, s3, 32768
    buffer_load_dwordx4 v[116:119], v94, s[24:27], s3 offen offset:0
    s_mul_i32 s3, s33, 1280000
    s_add_u32 s3, s3, s100
    s_add_u32 s3, s3, 32768
    buffer_load_dwordx4 v[120:123], v94, s[24:27], s3 offen offset:1024
    s_mul_i32 s3, s33, 1280000
    s_add_u32 s3, s3, s38
    s_add_u32 s3, s3, 0
    buffer_load_dwordx4 v[108:111], v94, s[24:27], s3 offen offset:0
    s_mul_i32 s3, s33, 1280000
    s_add_u32 s3, s3, s38
    s_add_u32 s3, s3, 0
    buffer_load_dwordx4 v[112:115], v94, s[24:27], s3 offen offset:1024
    ds_write_b128 v20, v[16:19] offset:0
    ds_write_b128 v20, v[16:19] offset:16384
    ds_write_b128 v20, v[16:19] offset:32768
    ds_write_b128 v20, v[16:19] offset:49152
    ds_write_b128 v21, v[16:19]
    s_cmp_eq_u32 s56, 0
    s_cbranch_scc1 L2_e3
    v_lshlrev_b32 v16, 3, v94
    v_and_b32 v16, 0x80, v16
L2_e4:
    buffer_load_dword v88, v16, s[68:71], 0 offen sc1
    s_waitcnt vmcnt(0)
    v_cmp_gt_u32 vcc, 0x80, v88
    s_cbranch_vccnz L2_e4
L2_e3:
    s_mov_b64 exec, 0xffff
L2_p1:
    buffer_load_dword v88, v7, s[60:63], 0 offen sc1
    s_waitcnt vmcnt(0)
    v_cmpx_gt_u32 vcc, 1, v88
    s_cbranch_vccnz L2_p1s
    s_mov_b64 exec, -1
    v_cmp_gt_u32 vcc, 2, v88
    s_and_b32 s56, vcc_lo, 0xffff
    buffer_load_dwordx4 v[48:51], v95, s[12:15], s39 offen offset:0
    buffer_load_dwordx4 v[56:59], v95, s[12:15], s39 offen offset:32
    buffer_load_dwordx4 v[52:55], v95, s[12:15], s39 offen offset:16
    buffer_load_dwordx4 v[60:63], v95, s[12:15], s39 offen offset:48
    buffer_load_dwordx4 v[64:67], v93, s[12:15], s39 offen
    s_waitcnt vmcnt(0)
    v_sub_u16 v88, v56, v48
    v_and_b32 v89, 3, v48
    v_add3_u32 v99, v88, v89, 3
    v_and_b32 v99, -4, v99
    v_max_u32 v99, 4, v99
    v_and_b32 v97, 0xfffc, v48
    v_bfm_b32 v96, v88, v89
    v_add_u32_dpp v91, v99, v99 row_shr:1 row_mask:0xf bank_mask:0xf bound_ctrl:1
    v_mad_u32_u24 v97, v97, 5, v2
    v_cmp_lt_u32 vcc, 16, v99
    v_add_u32_dpp v91, v91, v91 row_shr:2 row_mask:0xf bank_mask:0xf bound_ctrl:1
    v_sub_u32 v98, s38, v99
    v_lshrrev_b64 v[48:49], 16, v[48:49]
    v_add_u32_dpp v91, v91, v91 row_shr:4 row_mask:0xf bank_mask:0xf bound_ctrl:1
    v_lshrrev_b64 v[56:57], 16, v[56:57]
    s_mov_b32 s101, 0
    v_add_u32_dpp v91, v91, v91 row_shr:8 row_mask:0xf bank_mask:0xf bound_ctrl:1
    s_nop 1
    v_add_u32_dpp v91, v91, v91 row_bcast:15 row_mask:0xa bank_mask:0xf
    s_nop 1
    v_add_u32_dpp v91, v91, v91 row_bcast:31 row_mask:0xc bank_mask:0xf
    v_add_u32 v98, v98, v91
    v_readlane_b32 s37, v91, 63
    s_cbranch_vccnz L2_xo3
L2_xp3:
    v_mov_b32 v44, v43
    s_cmp_gt_u32 s37, 1024
    s_cbranch_scc1 L2_xs4
    s_cmp_lg_u32 s101, 0
    s_cbranch_scc1 L2_xa4
L2_xb4:
    v_lshlrev_b32 v89, 16, v96
    v_add_u32 v90, 60, v97
    v_bitop3_b32 v90, v89, v45, v90 bitop3:0x6a
    ds_write_b32 v98, v90 offset:12
    v_lshlrev_b32 v89, 20, v96
    v_add_u32 v90, 40, v97
    v_bitop3_b32 v90, v89, v45, v90 bitop3:0x6a
    ds_write_b32 v98, v90 offset:8
    v_lshlrev_b32 v89, 24, v96
    v_add_u32 v90, 20, v97
    v_bitop3_b32 v90, v89, v45, v90 bitop3:0x6a
    ds_write_b32 v98, v90 offset:4
    v_lshlrev_b32 v89, 28, v96
    v_bitop3_b32 v90, v89, v45, v97 bitop3:0x6a
    ds_write_b32 v98, v90 offset:0
    v_mov_b32_dpp v91, v64 quad_perm:[0,0,0,0] row_mask:0xf bank_mask:0xf
    v_and_b32 v89, 3, v91
    v_and_b32 v97, 0xfffc, v91
    v_sub_u16_dpp v88, v64, v91 quad_perm:[2,2,2,2] row_mask:0xf bank_mask:0xf
    v_mad_u32_u24 v97, v97, 5, v4
    v_add_u32 v99, v88, v89
    v_bfm_b32 v96, v88, v89
    v_cmp_lt_u32 s[58:59], 16, v99
    v_lshlrev_b32 v89, v1, v96
    v_and_b32 v89, v45, v89
    v_cmp_ne_u32 vcc, 0, v89
    v_xor_b32 v90, v97, v89
    s_add_u32 s3, s37, s38
    v_mbcnt_lo_u32_b32 v98, vcc_lo, 0
    v_mbcnt_hi_u32_b32 v98, vcc_hi, v98
    s_bcnt1_i32_b64 s41, vcc
    v_lshl_add_u32 v98, v98, 2, s3
    s_lshl2_add_u32 s37, s41, s37
    s_mov_b64 exec, vcc
    ds_write_b32 v98, v90
    s_mov_b64 exec, -1
    s_cmp_lg_u64 s[58:59], 0
    s_cbranch_scc1 L2_xe4
L2_xr4:
    v_add_u32 v98, s37, v0
    v_mov_b32 v90, -1
    ds_write_b32 v98, v90
    v_add_u32 v98, s38, v0
    ds_read2st64_b32 v[40:41], v0 offset0:0 offset1:1
    ds_read_b32 v43, v0 offset:512
    v_lshrrev_b32 v98, 1, v98
    v_and_b32 v98, -4, v98
    ds_read_b32 v42, v98 offset:768
    s_sub_u32 s3, s37, 768
    s_cmp_gt_u32 s3, 128
    s_cbranch_scc1 L2_xf4
L2_xg4:
    v_sub_u16 v88, v58, v50
    v_and_b32 v89, 3, v50
    v_add3_u32 v99, v88, v89, 3
    v_and_b32 v99, -4, v99
    v_max_u32 v99, 4, v99
    v_and_b32 v97, 0xfffc, v50
    v_bfm_b32 v96, v88, v89
    v_add_u32_dpp v91, v99, v99 row_shr:1 row_mask:0xf bank_mask:0xf bound_ctrl:1
    v_mad_u32_u24 v97, v97, 5, v2
    v_cmp_lt_u32 vcc, 16, v99
    v_add_u32_dpp v91, v91, v91 row_shr:2 row_mask:0xf bank_mask:0xf bound_ctrl:1
    v_sub_u32 v98, s38, v99
    v_lshrrev_b64 v[50:51], 16, v[50:51]
    v_add_u32_dpp v91, v91, v91 row_shr:4 row_mask:0xf bank_mask:0xf bound_ctrl:1
    v_lshrrev_b64 v[58:59], 16, v[58:59]
    s_mov_b32 s101, 0
    v_add_u32_dpp v91, v91, v91 row_shr:8 row_mask:0xf bank_mask:0xf bound_ctrl:1
    s_nop 1
    v_add_u32_dpp v91, v91, v91 row_bcast:15 row_mask:0xa bank_mask:0xf
    s_nop 1
    v_add_u32_dpp v91, v91, v91 row_bcast:31 row_mask:0xc bank_mask:0xf
    v_add_u32 v98, v98, v91
    v_readlane_b32 s37, v91, 63
    s_cbranch_vccnz L2_xo5
L2_xp5:
    s_waitcnt lgkmcnt(0)
    v_mov_b32 v21, v40
    v_mov_b32 v27, v41
    v_mov_b32 v31, v42
    v_mov_b32 v39, v43
    v_mov_b32 v44, v43
    s_cmp_gt_u32 s37, 1024
    s_cbranch_scc1 L2_xs6
    s_cmp_lg_u32 s101, 0
    s_cbranch_scc1 L2_xa6
L2_xb6:
    v_lshlrev_b32 v89, 16, v96
    v_add_u32 v90, 60, v97
    v_bitop3_b32 v90, v89, v45, v90 bitop3:0x6a
    ds_write_b32 v98, v90 offset:12
    v_lshlrev_b32 v89, 20, v96
    v_add_u32 v90, 40, v97
    v_bitop3_b32 v90, v89, v45, v90 bitop3:0x6a
    ds_write_b32 v98, v90 offset:8
    v_lshlrev_b32 v89, 24, v96
    v_add_u32 v90, 20, v97
    v_bitop3_b32 v90, v89, v45, v90 bitop3:0x6a
    ds_write_b32 v98, v90 offset:4
    v_lshlrev_b32 v89, 28, v96
    v_bitop3_b32 v90, v89, v45, v97 bitop3:0x6a
    ds_write_b32 v98, v90 offset:0
    v_mov_b32_dpp v91, v66 quad_perm:[0,0,0,0] row_mask:0xf bank_mask:0xf
    v_and_b32 v89, 3, v91
    v_and_b32 v97, 0xfffc, v91
    v_sub_u16_dpp v88, v66, v91 quad_perm:[2,2,2,2] row_mask:0xf bank_mask:0xf
    v_mad_u32_u24 v97, v97, 5, v4
    v_add_u32 v99, v88, v89
    v_bfm_b32 v96, v88, v89
    v_cmp_lt_u32 s[58:59], 16, v99
    v_lshlrev_b32 v89, v1, v96
    v_and_b32 v89, v45, v89
    v_cmp_ne_u32 vcc, 0, v89
    v_xor_b32 v90, v97, v89
    s_add_u32 s3, s37, s38
    v_mbcnt_lo_u32_b32 v98, vcc_lo, 0
    v_mbcnt_hi_u32_b32 v98, vcc_hi, v98
    s_bcnt1_i32_b64 s41, vcc
    v_lshl_add_u32 v98, v98, 2, s3
    s_lshl2_add_u32 s37, s41, s37
    s_mov_b64 exec, vcc
    ds_write_b32 v98, v90
    s_mov_b64 exec, -1
    s_cmp_lg_u64 s[58:59], 0
    s_cbranch_scc1 L2_xe6
L2_xr6:
    v_add_u32 v98, s37, v0
    v_mov_b32 v90, -1
    ds_write_b32 v98, v90
    v_add_u32 v98, s38, v0
    ds_read2st64_b32 v[40:41], v0 offset0:0 offset1:1
    ds_read_b32 v43, v0 offset:512
    v_lshrrev_b32 v98, 1, v98
    v_and_b32 v98, -4, v98
    ds_read_b32 v42, v98 offset:768
    s_sub_u32 s3, s37, 768
    s_cmp_gt_u32 s3, 128
    s_cbranch_scc1 L2_xf6
L2_xg6:
    v_subrev_u32 v88, s38, v3
    ds_write_b128 v88, v[124:127] offset:34816
    v_subrev_u32 v88, s38, v3
    ds_write_b128 v88, v[116:119] offset:32768
    v_subrev_u32 v88, s38, v3
    ds_write_b128 v88, v[120:123] offset:33792
    v_subrev_u32 v88, s100, v3
    ds_write_b128 v88, v[108:111] offset:0
    v_subrev_u32 v88, s100, v3
    ds_write_b128 v88, v[112:115] offset:1024
    s_cmp_eq_u32 s56, 0
    s_cbranch_scc1 L2_e2
    s_mov_b32 exec_lo, s56
    s_mov_b32 exec_hi, 0
    buffer_load_dword v88, v7, s[60:63], 0 offen sc1
    s_mov_b64 exec, -1
    s_waitcnt vmcnt(0)
    v_cmp_gt_u32 vcc, 2, v88
    s_and_b32 s56, vcc_lo, s56
    s_cbranch_scc0 L2_e2
    s_mul_i32 s3, s33, 1280000
    s_add_u32 s3, s3, s100
    s_add_u32 s3, s3, 352768
    buffer_load_dwordx4 v[124:127], v94, s[24:27], s3 offen offset:2048
    s_mul_i32 s3, s33, 1280000
    s_add_u32 s3, s3, s100
    s_add_u32 s3, s3, 352768
    buffer_load_dwordx4 v[116:119], v94, s[24:27], s3 offen offset:0
    s_mul_i32 s3, s33, 1280000
    s_add_u32 s3, s3, s100
    s_add_u32 s3, s3, 352768
    buffer_load_dwordx4 v[120:123], v94, s[24:27], s3 offen offset:1024
    s_mul_i32 s3, s33, 1280000
    s_add_u32 s3, s3, s38
    s_add_u32 s3, s3, 320000
    buffer_load_dwordx4 v[108:111], v94, s[24:27], s3 offen offset:0
    s_mul_i32 s3, s33, 1280000
    s_add_u32 s3, s3, s38
    s_add_u32 s3, s3, 320000
    buffer_load_dwordx4 v[112:115], v94, s[24:27], s3 offen offset:1024
    s_mov_b32 exec_lo, s56
    s_mov_b32 exec_hi, 0
L2_p2:
    buffer_load_dword v88, v7, s[60:63], 0 offen sc1
    s_waitcnt vmcnt(0)
    v_cmpx_gt_u32 vcc, 2, v88
    s_cbranch_vccnz L2_p2s
    s_mov_b64 exec, -1
L2_e2:
    s_mov_b32 s6, 0xaaaaaaaa
    s_mov_b32 s7, 0xaaaaaaaa
    v_and_b32 v47, 0x0fffffff, v21
    buffer_load_dwordx2 v[16:17], v47, s[8:11], 0 offen
    buffer_load_dwordx3 v[18:20], v47, s[8:11], 0 offen offset:8
    s_setprio 1
    v_and_b32 v47, 0x0fffffff, v27
    buffer_load_dwordx2 v[22:23], v47, s[8:11], 0 offen
    buffer_load_dwordx3 v[24:26], v47, s[8:11], 0 offen offset:8
    s_waitcnt lgkmcnt(0)
    s_barrier
    s_bitcmp1_b32 s36, s42
    s_cbranch_scc1 L2_slow
L2_ret0:
    s_setprio 3
    s_bitcmp1_b32 s43, s42
    s_cbranch_scc1 L2_oa7
L2_ob7:
    s_bitcmp1_b32 s43, s42
    s_cbranch_scc1 L2_oa8
L2_ob8:
    s_waitcnt vmcnt(2)
    v_and_b32 v46, 0x20000000, v21
    v_lshrrev_b32 v47, 14, v17
    v_bitop3_b32 v47, v47, v5, v46 bitop3:0xea
    ds_read_b64 v[102:103], v47
    v_bitop3_b32 v93, v17, v5, v46 bitop3:0xea
    v_and_b32 v46, 0x10000000, v21
    v_lshrrev_b32 v47, 14, v16
    v_bitop3_b32 v47, v47, v5, v46 bitop3:0xea
    ds_read_b64 v[100:101], v47
    v_bitop3_b32 v92, v16, v5, v46 bitop3:0xea
    v_perm_b32 v15, v17, v20, s45
    v_bitop3_b32 v46, v17, 0.5, -0.5 bitop3:0xa8
    v_perm_b32 v14, v16, v20, s44
    v_bitop3_b32 v47, v16, 0.5, -0.5 bitop3:0xa8
    v_bitop3_b32 v15, v6, v15, v46 bitop3:0xca
    v_bitop3_b32 v14, v6, v14, v47 bitop3:0xca
    s_waitcnt lgkmcnt(0)
    v_mfma_f32_4x4x4_16b_bf16 v[80:83], v[8:9], v[102:103], 0
    v_mfma_f32_4x4x4_16b_bf16 v[76:79], v[8:9], v[100:101], 0
    v_cmp_lt_u32 s[84:85], v5, v92
    s_nop 2
    v_pk_mul_f32 v[80:81], v[80:81], v[14:15] op_sel:[0,1] op_sel_hi:[1,1]
    v_pk_mul_f32 v[82:83], v[82:83], v[14:15] op_sel:[0,1] op_sel_hi:[1,1]
    v_pk_mul_f32 v[76:77], v[76:77], v[14:15] op_sel:[0,0] op_sel_hi:[1,0]
    v_pk_mul_f32 v[78:79], v[78:79], v[14:15] op_sel:[0,0] op_sel_hi:[1,0]
    v_and_b32 v47, 0x0fffffff, v39
    buffer_load_dwordx2 v[34:35], v47, s[8:11], 0 offen
    buffer_load_dwordx3 v[36:38], v47, s[8:11], 0 offen offset:8
    v_and_b32 v46, 0x80000000, v21
    v_lshrrev_b32 v47, 14, v19
    v_bitop3_b32 v47, v47, v5, v46 bitop3:0xea
    ds_read_b64 v[106:107], v47
    v_and_b32 v99, 0x40000000, v21
    v_lshrrev_b32 v47, 14, v18
    v_bitop3_b32 v47, v47, v5, v99 bitop3:0xea
    ds_read_b64 v[104:105], v47
    v_cmp_ne_u64 s[50:51], v[72:73], v[68:69]
    v_cmpx_ne_u64 s[54:55], v[74:75], v[70:71]
    s_and_b64 s[82:83], s[54:55], s[80:81]
    s_cbranch_scc1 L2_c9
L2_d9:
    v_mov_b64 v[84:85], v[70:71]
    v_mov_b32 v7, v95
    v_mov_b64 v[86:87], v[74:75]
    s_or_b64 s[80:81], s[80:81], s[54:55]
    s_mov_b64 exec, s[50:51]
    s_and_b64 s[82:83], s[50:51], s[80:81]
    s_cbranch_scc1 L2_c10
L2_d10:
    v_mov_b64 v[84:85], v[68:69]
    v_mov_b32 v7, v94
    v_mov_b64 v[86:87], v[72:73]
    s_mov_b64 exec, -1
    s_or_b64 s[80:81], s[80:81], s[50:51]
    s_and_b64 exec, s[84:85], s[80:81]
    v_mfma_f32_4x4x4_16b_bf16 v[76:79], v[12:13], v[84:85], 0
    v_mov_b32 v92, v7
    s_andn2_b64 s[80:81], s[80:81], s[84:85]
    v_mfma_f32_4x4x4_16b_bf16 v[76:79], v[10:11], v[86:87], v[76:79]
    s_mov_b64 exec, -1
    ds_read_b64 v[70:71], v93 offset:65408
    ds_read_b64 v[68:69], v92 offset:65408
    v_bitop3_b32 v94, v18, v5, v99 bitop3:0xea
    v_bitop3_b32 v95, v19, v5, v46 bitop3:0xea
    v_perm_b32 v15, v19, v20, s47
    v_bitop3_b32 v46, v19, 0.5, -0.5 bitop3:0xa8
    v_perm_b32 v14, v18, v20, s46
    v_bitop3_b32 v47, v18, 0.5, -0.5 bitop3:0xa8
    v_bitop3_b32 v15, v6, v15, v46 bitop3:0xca
    v_bitop3_b32 v14, v6, v14, v47 bitop3:0xca
    s_waitcnt lgkmcnt(1)
    v_mfma_f32_4x4x4_16b_bf16 v[80:83], v[10:11], v[70:71], v[80:83]
    s_waitcnt lgkmcnt(0)
    v_mfma_f32_4x4x4_16b_bf16 v[76:79], v[10:11], v[68:69], v[76:79]
    s_nop 2
    v_cvt_pk_bf16_f32 v80, v80, v81
    v_cvt_pk_bf16_f32 v81, v82, v83
    ds_wrxchg_rtn_b64 v[74:75], v93, v[80:81] offset:65408
    v_cvt_pk_bf16_f32 v76, v76, v77
    v_cvt_pk_bf16_f32 v77, v78, v79
    ds_wrxchg_rtn_b64 v[72:73], v92, v[76:77] offset:65408
    s_setprio 2
    v_mfma_f32_4x4x4_16b_bf16 v[80:83], v[8:9], v[106:107], 0
    v_mfma_f32_4x4x4_16b_bf16 v[76:79], v[8:9], v[104:105], 0
    v_cmp_lt_u32 s[48:49], v5, v95
    s_nop 2
    v_pk_mul_f32 v[80:81], v[80:81], v[14:15] op_sel:[0,1] op_sel_hi:[1,1]
    v_pk_mul_f32 v[82:83], v[82:83], v[14:15] op_sel:[0,1] op_sel_hi:[1,1]
    v_pk_mul_f32 v[76:77], v[76:77], v[14:15] op_sel:[0,0] op_sel_hi:[1,0]
    v_pk_mul_f32 v[78:79], v[78:79], v[14:15] op_sel:[0,0] op_sel_hi:[1,0]
    v_and_b32 v47, 0x0fffffff, v31
    buffer_load_dword v30, v47, s[8:11], 0 offen offset:16
    s_mov_b64 exec, s[6:7]
    v_add_u32 v47, 8, v47
    v_lshrrev_b32 v31, 2, v31
    s_mov_b64 exec, -1
    buffer_load_dwordx2 v[28:29], v47, s[8:11], 0 offen
    v_and_b32 v47, 0x3f0, v3
    s_cmp_lg_u32 s56, 0
    s_cbranch_scc1 L2_m11
    s_mul_i32 s3, s33, 1280000
    s_add_u32 s3, s3, s100
    s_add_u32 s3, s3, 352768
    buffer_load_dwordx4 v[124:127], v47, s[24:27], s3 offen offset:2048
L2_m11:
    v_and_b32 v47, 0x3f0, v3
    s_cmp_lg_u32 s56, 0
    s_cbranch_scc1 L2_m12
    s_mul_i32 s3, s33, 1280000
    s_add_u32 s3, s3, s100
    s_add_u32 s3, s3, 352768
    buffer_load_dwordx4 v[116:119], v47, s[24:27], s3 offen offset:0
L2_m12:
    s_waitcnt vmcnt(4)
    v_and_b32 v46, 0x20000000, v27
    v_lshrrev_b32 v47, 14, v23
    v_bitop3_b32 v47, v47, v5, v46 bitop3:0xea
    ds_read_b64 v[102:103], v47
    v_and_b32 v99, 0x10000000, v27
    v_lshrrev_b32 v47, 14, v22
    v_bitop3_b32 v47, v47, v5, v99 bitop3:0xea
    ds_read_b64 v[100:101], v47
    s_waitcnt lgkmcnt(2)
    v_cmp_ne_u64 s[50:51], v[72:73], v[68:69]
    v_cmpx_ne_u64 s[54:55], v[74:75], v[70:71]
    s_and_b64 s[82:83], s[54:55], s[80:81]
    s_cbranch_scc1 L2_c13
L2_d13:
    v_mov_b64 v[84:85], v[70:71]
    v_mov_b32 v7, v93
    v_mov_b64 v[86:87], v[74:75]
    s_or_b64 s[80:81], s[80:81], s[54:55]
    s_mov_b64 exec, s[50:51]
    s_and_b64 s[82:83], s[50:51], s[80:81]
    s_cbranch_scc1 L2_c14
L2_d14:
    v_mov_b64 v[84:85], v[68:69]
    v_mov_b32 v7, v92
    v_mov_b64 v[86:87], v[72:73]
    s_mov_b64 exec, -1
    s_or_b64 s[80:81], s[80:81], s[50:51]
    s_and_b64 exec, s[48:49], s[80:81]
    v_mfma_f32_4x4x4_16b_bf16 v[80:83], v[12:13], v[84:85], 0
    v_mov_b32 v95, v7
    s_andn2_b64 s[80:81], s[80:81], s[48:49]
    v_mfma_f32_4x4x4_16b_bf16 v[80:83], v[10:11], v[86:87], v[80:83]
    s_mov_b64 exec, -1
    ds_read_b64 v[70:71], v95 offset:65408
    ds_read_b64 v[68:69], v94 offset:65408
    v_bitop3_b32 v92, v22, v5, v99 bitop3:0xea
    v_bitop3_b32 v93, v23, v5, v46 bitop3:0xea
    v_perm_b32 v15, v23, v26, s45
    v_bitop3_b32 v46, v23, 0.5, -0.5 bitop3:0xa8
    v_perm_b32 v14, v22, v26, s44
    v_bitop3_b32 v47, v22, 0.5, -0.5 bitop3:0xa8
    v_bitop3_b32 v15, v6, v15, v46 bitop3:0xca
    v_bitop3_b32 v14, v6, v14, v47 bitop3:0xca
    s_waitcnt lgkmcnt(1)
    v_mfma_f32_4x4x4_16b_bf16 v[80:83], v[10:11], v[70:71], v[80:83]
    s_waitcnt lgkmcnt(0)
    v_mfma_f32_4x4x4_16b_bf16 v[76:79], v[10:11], v[68:69], v[76:79]
    s_nop 2
    v_cvt_pk_bf16_f32 v80, v80, v81
    v_cvt_pk_bf16_f32 v81, v82, v83
    ds_wrxchg_rtn_b64 v[74:75], v95, v[80:81] offset:65408
    v_cvt_pk_bf16_f32 v76, v76, v77
    v_cvt_pk_bf16_f32 v77, v78, v79
    ds_wrxchg_rtn_b64 v[72:73], v94, v[76:77] offset:65408
    s_setprio 1
    v_mfma_f32_4x4x4_16b_bf16 v[80:83], v[8:9], v[102:103], 0
    v_mfma_f32_4x4x4_16b_bf16 v[76:79], v[8:9], v[100:101], 0
    s_nop 3
    v_pk_mul_f32 v[80:81], v[80:81], v[14:15] op_sel:[0,1] op_sel_hi:[1,1]
    v_pk_mul_f32 v[82:83], v[82:83], v[14:15] op_sel:[0,1] op_sel_hi:[1,1]
    v_pk_mul_f32 v[76:77], v[76:77], v[14:15] op_sel:[0,0] op_sel_hi:[1,0]
    v_pk_mul_f32 v[78:79], v[78:79], v[14:15] op_sel:[0,0] op_sel_hi:[1,0]
    v_and_b32 v47, 0x3f0, v3
    s_cmp_lg_u32 s56, 0
    s_cbranch_scc1 L2_m15
    s_mul_i32 s3, s33, 1280000
    s_add_u32 s3, s3, s100
    s_add_u32 s3, s3, 352768
    buffer_load_dwordx4 v[120:123], v47, s[24:27], s3 offen offset:1024
L2_m15:
    v_sub_u16 v88, v60, v52
    v_and_b32 v89, 3, v52
    v_add3_u32 v99, v88, v89, 3
    v_and_b32 v99, -4, v99
    v_max_u32 v99, 4, v99
    v_and_b32 v97, 0xfffc, v52
    v_bfm_b32 v96, v88, v89
    v_add_u32_dpp v91, v99, v99 row_shr:1 row_mask:0xf bank_mask:0xf bound_ctrl:1
    v_mad_u32_u24 v97, v97, 5, v2
    v_cmp_lt_u32 vcc, 16, v99
    v_add_u32_dpp v91, v91, v91 row_shr:2 row_mask:0xf bank_mask:0xf bound_ctrl:1
    v_sub_u32 v98, s38, v99
    v_lshrrev_b64 v[52:53], 16, v[52:53]
    v_add_u32_dpp v91, v91, v91 row_shr:4 row_mask:0xf bank_mask:0xf bound_ctrl:1
    v_lshrrev_b64 v[60:61], 16, v[60:61]
    s_mov_b32 s101, 0
    v_add_u32_dpp v91, v91, v91 row_shr:8 row_mask:0xf bank_mask:0xf bound_ctrl:1
    s_nop 1
    v_add_u32_dpp v91, v91, v91 row_bcast:15 row_mask:0xa bank_mask:0xf
    s_nop 1
    v_add_u32_dpp v91, v91, v91 row_bcast:31 row_mask:0xc bank_mask:0xf
    v_add_u32 v98, v98, v91
    v_readlane_b32 s37, v91, 63
    s_cbranch_vccnz L2_xo16
L2_xp16:
    v_and_b32 v46, 0x80000000, v27
    v_lshrrev_b32 v47, 14, v25
    v_bitop3_b32 v47, v47, v5, v46 bitop3:0xea
    ds_read_b64 v[106:107], v47
    v_and_b32 v99, 0x40000000, v27
    v_lshrrev_b32 v47, 14, v24
    v_bitop3_b32 v47, v47, v5, v99 bitop3:0xea
    ds_read_b64 v[104:105], v47
    s_waitcnt lgkmcnt(2)
    v_cmp_ne_u64 s[50:51], v[72:73], v[68:69]
    v_cmpx_ne_u64 s[54:55], v[74:75], v[70:71]
    s_and_b64 s[82:83], s[54:55], s[80:81]
    s_cbranch_scc1 L2_c17
L2_d17:
    v_mov_b64 v[84:85], v[70:71]
    v_mov_b32 v7, v95
    v_mov_b64 v[86:87], v[74:75]
    s_or_b64 s[80:81], s[80:81], s[54:55]
    s_mov_b64 exec, s[50:51]
    s_and_b64 s[82:83], s[50:51], s[80:81]
    s_cbranch_scc1 L2_c18
L2_d18:
    v_mov_b64 v[84:85], v[68:69]
    v_mov_b32 v7, v94
    v_mov_b64 v[86:87], v[72:73]
    s_mov_b64 exec, -1
    s_or_b64 s[80:81], s[80:81], s[50:51]
    ds_read_b64 v[70:71], v93 offset:65408
    ds_read_b64 v[68:69], v92 offset:65408
    v_bitop3_b32 v94, v24, v5, v99 bitop3:0xea
    v_bitop3_b32 v95, v25, v5, v46 bitop3:0xea
    v_perm_b32 v15, v25, v26, s47
    v_bitop3_b32 v46, v25, 0.5, -0.5 bitop3:0xa8
    v_perm_b32 v14, v24, v26, s46
    v_bitop3_b32 v47, v24, 0.5, -0.5 bitop3:0xa8
    v_bitop3_b32 v15, v6, v15, v46 bitop3:0xca
    v_bitop3_b32 v14, v6, v14, v47 bitop3:0xca
    s_waitcnt lgkmcnt(1)
    v_mfma_f32_4x4x4_16b_bf16 v[80:83], v[10:11], v[70:71], v[80:83]
    s_waitcnt lgkmcnt(0)
    v_mfma_f32_4x4x4_16b_bf16 v[76:79], v[10:11], v[68:69], v[76:79]
    s_nop 2
    v_cvt_pk_bf16_f32 v80, v80, v81
    v_cvt_pk_bf16_f32 v81, v82, v83
    ds_wrxchg_rtn_b64 v[74:75], v93, v[80:81] offset:65408
    v_cvt_pk_bf16_f32 v76, v76, v77
    v_cvt_pk_bf16_f32 v77, v78, v79
    ds_wrxchg_rtn_b64 v[72:73], v92, v[76:77] offset:65408
    v_mfma_f32_4x4x4_16b_bf16 v[80:83], v[8:9], v[106:107], 0
    v_mfma_f32_4x4x4_16b_bf16 v[76:79], v[8:9], v[104:105], 0
    v_cmp_lt_u32 s[84:85], v5, v94
    s_nop 2
    v_pk_mul_f32 v[80:81], v[80:81], v[14:15] op_sel:[0,1] op_sel_hi:[1,1]
    v_pk_mul_f32 v[82:83], v[82:83], v[14:15] op_sel:[0,1] op_sel_hi:[1,1]
    v_pk_mul_f32 v[76:77], v[76:77], v[14:15] op_sel:[0,0] op_sel_hi:[1,0]
    v_pk_mul_f32 v[78:79], v[78:79], v[14:15] op_sel:[0,0] op_sel_hi:[1,0]
    v_and_b32 v47, 0x3f0, v3
    s_cmp_lg_u32 s56, 0
    s_cbranch_scc1 L2_m19
    s_mul_i32 s3, s33, 1280000
    s_add_u32 s3, s3, s38
    s_add_u32 s3, s3, 320000
    buffer_load_dwordx4 v[108:111], v47, s[24:27], s3 offen offset:0
L2_m19:
    v_and_b32 v47, 0x3f0, v3
    s_cmp_lg_u32 s56, 0
    s_cbranch_scc1 L2_m20
    s_mul_i32 s3, s33, 1280000
    s_add_u32 s3, s3, s38
    s_add_u32 s3, s3, 320000
    buffer_load_dwordx4 v[112:115], v47, s[24:27], s3 offen offset:1024
L2_m20:
    v_and_b32 v47, 0x0fffffff, v40
    v_mov_b32 v21, v40
    buffer_load_dwordx2 v[16:17], v47, s[8:11], 0 offen
    buffer_load_dwordx3 v[18:20], v47, s[8:11], 0 offen offset:8
    s_waitcnt vmcnt(2)
    s_mov_b64 exec, s[6:7]
    v_lshrrev_b32 v30, 16, v30
    s_mov_b64 exec, -1
    v_and_b32 v46, 0x20000000, v31
    v_lshrrev_b32 v47, 14, v29
    v_bitop3_b32 v47, v47, v5, v46 bitop3:0xea
    ds_read_b64 v[102:103], v47
    v_and_b32 v99, 0x10000000, v31
    v_lshrrev_b32 v47, 14, v28
    v_bitop3_b32 v47, v47, v5, v99 bitop3:0xea
    ds_read_b64 v[100:101], v47
    s_waitcnt lgkmcnt(2)
    v_cmp_ne_u64 s[50:51], v[72:73], v[68:69]
    v_cmpx_ne_u64 s[54:55], v[74:75], v[70:71]
    s_and_b64 s[82:83], s[54:55], s[80:81]
    s_cbranch_scc1 L2_c21
L2_d21:
    v_mov_b64 v[84:85], v[70:71]
    v_mov_b32 v7, v93
    v_mov_b64 v[86:87], v[74:75]
    s_or_b64 s[80:81], s[80:81], s[54:55]
    s_mov_b64 exec, s[50:51]
    s_and_b64 s[82:83], s[50:51], s[80:81]
    s_cbranch_scc1 L2_c22
L2_d22:
    v_mov_b64 v[84:85], v[68:69]
    v_mov_b32 v7, v92
    v_mov_b64 v[86:87], v[72:73]
    s_mov_b64 exec, -1
    s_or_b64 s[80:81], s[80:81], s[50:51]
    s_and_b64 exec, s[84:85], s[80:81]
    v_mfma_f32_4x4x4_16b_bf16 v[76:79], v[12:13], v[84:85], 0
    v_mov_b32 v94, v7
    s_andn2_b64 s[80:81], s[80:81], s[84:85]
    v_mfma_f32_4x4x4_16b_bf16 v[76:79], v[10:11], v[86:87], v[76:79]
    s_mov_b64 exec, -1
    ds_read_b64 v[70:71], v95 offset:65408
    ds_read_b64 v[68:69], v94 offset:65408
    v_bitop3_b32 v92, v28, v5, v99 bitop3:0xea
    v_bitop3_b32 v93, v29, v5, v46 bitop3:0xea
    v_perm_b32 v15, v29, v30, s45
    v_bitop3_b32 v46, v29, 0.5, -0.5 bitop3:0xa8
    v_perm_b32 v14, v28, v30, s44
    v_bitop3_b32 v47, v28, 0.5, -0.5 bitop3:0xa8
    v_bitop3_b32 v15, v6, v15, v46 bitop3:0xca
    v_bitop3_b32 v14, v6, v14, v47 bitop3:0xca
    s_waitcnt lgkmcnt(1)
    v_mfma_f32_4x4x4_16b_bf16 v[80:83], v[10:11], v[70:71], v[80:83]
    s_waitcnt lgkmcnt(0)
    v_mfma_f32_4x4x4_16b_bf16 v[76:79], v[10:11], v[68:69], v[76:79]
    s_nop 2
    v_cvt_pk_bf16_f32 v80, v80, v81
    v_cvt_pk_bf16_f32 v81, v82, v83
    ds_wrxchg_rtn_b64 v[74:75], v95, v[80:81] offset:65408
    v_cvt_pk_bf16_f32 v76, v76, v77
    v_cvt_pk_bf16_f32 v77, v78, v79
    ds_wrxchg_rtn_b64 v[72:73], v94, v[76:77] offset:65408
    s_setprio 0
    v_mfma_f32_4x4x4_16b_bf16 v[80:83], v[8:9], v[102:103], 0
    v_mfma_f32_4x4x4_16b_bf16 v[76:79], v[8:9], v[100:101], 0
    v_cmp_lt_u32 s[48:49], v5, v93
    s_nop 2
    v_pk_mul_f32 v[80:81], v[80:81], v[14:15] op_sel:[0,1] op_sel_hi:[1,1]
    v_pk_mul_f32 v[82:83], v[82:83], v[14:15] op_sel:[0,1] op_sel_hi:[1,1]
    v_pk_mul_f32 v[76:77], v[76:77], v[14:15] op_sel:[0,0] op_sel_hi:[1,0]
    v_pk_mul_f32 v[78:79], v[78:79], v[14:15] op_sel:[0,0] op_sel_hi:[1,0]
    s_add_u32 s40, s40, 0x50000
    v_and_b32 v47, 0x0fffffff, v41
    v_mov_b32 v27, v41
    buffer_load_dwordx2 v[22:23], v47, s[8:11], 0 offen
    buffer_load_dwordx3 v[24:26], v47, s[8:11], 0 offen offset:8
    v_and_b32 v46, 0x80000000, v39
    v_lshrrev_b32 v47, 14, v37
    v_bitop3_b32 v47, v47, v5, v46 bitop3:0xea
    ds_read_b64 v[102:103], v47
    v_and_b32 v99, 0x40000000, v39
    v_lshrrev_b32 v47, 14, v36
    v_bitop3_b32 v47, v47, v5, v99 bitop3:0xea
    ds_read_b64 v[100:101], v47
    v_and_b32 v46, 0x20000000, v39
    v_lshrrev_b32 v47, 14, v35
    v_bitop3_b32 v47, v47, v5, v46 bitop3:0xea
    ds_read_b64 v[106:107], v47
    v_and_b32 v99, 0x10000000, v39
    v_lshrrev_b32 v47, 14, v34
    v_bitop3_b32 v47, v47, v5, v99 bitop3:0xea
    ds_read_b64 v[104:105], v47
    s_waitcnt lgkmcnt(4)
    v_cmp_ne_u64 s[50:51], v[72:73], v[68:69]
    v_cmpx_ne_u64 s[54:55], v[74:75], v[70:71]
    s_and_b64 s[82:83], s[54:55], s[80:81]
    s_cbranch_scc1 L2_c23
L2_d23:
    v_mov_b64 v[84:85], v[70:71]
    v_mov_b32 v7, v95
    v_mov_b64 v[86:87], v[74:75]
    s_or_b64 s[80:81], s[80:81], s[54:55]
    s_mov_b64 exec, s[50:51]
    s_and_b64 s[82:83], s[50:51], s[80:81]
    s_cbranch_scc1 L2_c24
L2_d24:
    v_mov_b64 v[84:85], v[68:69]
    v_mov_b32 v7, v94
    v_mov_b64 v[86:87], v[72:73]
    s_mov_b64 exec, -1
    s_or_b64 s[80:81], s[80:81], s[50:51]
    s_and_b64 exec, s[48:49], s[80:81]
    v_mfma_f32_4x4x4_16b_bf16 v[80:83], v[12:13], v[84:85], 0
    v_mov_b32 v93, v7
    s_andn2_b64 s[80:81], s[80:81], s[48:49]
    v_mfma_f32_4x4x4_16b_bf16 v[80:83], v[10:11], v[86:87], v[80:83]
    s_mov_b64 exec, -1
    ds_read_b64 v[70:71], v93 offset:65408
    ds_read_b64 v[68:69], v92 offset:65408
    v_bitop3_b32 v94, v34, v5, v99 bitop3:0xea
    v_bitop3_b32 v95, v35, v5, v46 bitop3:0xea
    v_perm_b32 v15, v35, v38, s45
    v_bitop3_b32 v46, v35, 0.5, -0.5 bitop3:0xa8
    v_perm_b32 v14, v34, v38, s44
    v_bitop3_b32 v47, v34, 0.5, -0.5 bitop3:0xa8
    v_bitop3_b32 v15, v6, v15, v46 bitop3:0xca
    v_bitop3_b32 v14, v6, v14, v47 bitop3:0xca
    s_waitcnt lgkmcnt(1)
    v_mfma_f32_4x4x4_16b_bf16 v[80:83], v[10:11], v[70:71], v[80:83]
    s_waitcnt lgkmcnt(0)
    v_mfma_f32_4x4x4_16b_bf16 v[76:79], v[10:11], v[68:69], v[76:79]
    s_nop 2
    v_cvt_pk_bf16_f32 v80, v80, v81
    v_cvt_pk_bf16_f32 v81, v82, v83
    ds_wrxchg_rtn_b64 v[74:75], v93, v[80:81] offset:65408
    v_cvt_pk_bf16_f32 v76, v76, v77
    v_cvt_pk_bf16_f32 v77, v78, v79
    ds_wrxchg_rtn_b64 v[72:73], v92, v[76:77] offset:65408
    s_barrier
    s_setprio 3
    s_waitcnt vmcnt(4)
    v_subrev_u32 v88, s38, v3
    ds_write_b128 v88, v[124:127] offset:34816
    s_add_u32 s3, s40, 4096
    buffer_load_dwordx4 v[124:127], v3, s[16:19], s3 offen sc1
    s_waitcnt vmcnt(5)
    v_subrev_u32 v88, s38, v3
    ds_write_b128 v88, v[116:119] offset:32768
    buffer_load_dwordx4 v[116:119], v3, s[16:19], s40 offen offset:2048 sc1
    s_waitcnt vmcnt(6)
    v_subrev_u32 v88, s38, v3
    ds_write_b128 v88, v[120:123] offset:33792
    buffer_load_dwordx4 v[120:123], v3, s[16:19], s40 offen offset:3072 sc1
    v_mfma_f32_4x4x4_16b_bf16 v[80:83], v[8:9], v[106:107], 0
    v_mfma_f32_4x4x4_16b_bf16 v[76:79], v[8:9], v[104:105], 0
    s_nop 3
    v_pk_mul_f32 v[80:81], v[80:81], v[14:15] op_sel:[0,1] op_sel_hi:[1,1]
    v_pk_mul_f32 v[82:83], v[82:83], v[14:15] op_sel:[0,1] op_sel_hi:[1,1]
    v_pk_mul_f32 v[76:77], v[76:77], v[14:15] op_sel:[0,0] op_sel_hi:[1,0]
    v_pk_mul_f32 v[78:79], v[78:79], v[14:15] op_sel:[0,0] op_sel_hi:[1,0]
    v_and_b32 v47, 0x0fffffff, v42
    v_mov_b32 v31, v42
    buffer_load_dword v30, v47, s[8:11], 0 offen offset:16
    s_mov_b64 exec, s[6:7]
    v_add_u32 v47, 8, v47
    v_lshrrev_b32 v31, 2, v31
    s_mov_b64 exec, -1
    buffer_load_dwordx2 v[28:29], v47, s[8:11], 0 offen
    v_mov_b32 v44, v43
    s_cmp_gt_u32 s37, 1024
    s_cbranch_scc1 L2_xs25
    s_cmp_lg_u32 s101, 0
    s_cbranch_scc1 L2_xa25
L2_xb25:
    v_lshlrev_b32 v89, 16, v96
    v_add_u32 v90, 60, v97
    v_bitop3_b32 v90, v89, v45, v90 bitop3:0x6a
    ds_write_b32 v98, v90 offset:12
    v_lshlrev_b32 v89, 20, v96
    v_add_u32 v90, 40, v97
    v_bitop3_b32 v90, v89, v45, v90 bitop3:0x6a
    ds_write_b32 v98, v90 offset:8
    v_lshlrev_b32 v89, 24, v96
    v_add_u32 v90, 20, v97
    v_bitop3_b32 v90, v89, v45, v90 bitop3:0x6a
    ds_write_b32 v98, v90 offset:4
    v_lshlrev_b32 v89, 28, v96
    v_bitop3_b32 v90, v89, v45, v97 bitop3:0x6a
    ds_write_b32 v98, v90 offset:0
    v_mov_b32_dpp v91, v64 quad_perm:[1,1,1,1] row_mask:0xf bank_mask:0xf
    v_and_b32 v89, 3, v91
    v_and_b32 v97, 0xfffc, v91
    v_sub_u16_dpp v88, v64, v91 quad_perm:[3,3,3,3] row_mask:0xf bank_mask:0xf
    v_mad_u32_u24 v97, v97, 5, v4
    v_add_u32 v99, v88, v89
    v_bfm_b32 v96, v88, v89
    v_cmp_lt_u32 s[58:59], 16, v99
    v_lshlrev_b32 v89, v1, v96
    v_and_b32 v89, v45, v89
    v_cmp_ne_u32 vcc, 0, v89
    v_xor_b32 v90, v97, v89
    s_add_u32 s3, s37, s38
    v_mbcnt_lo_u32_b32 v98, vcc_lo, 0
    v_mbcnt_hi_u32_b32 v98, vcc_hi, v98
    s_bcnt1_i32_b64 s41, vcc
    v_lshl_add_u32 v98, v98, 2, s3
    s_lshl2_add_u32 s37, s41, s37
    s_mov_b64 exec, vcc
    ds_write_b32 v98, v90
    s_mov_b64 exec, -1
    s_cmp_lg_u64 s[58:59], 0
    s_cbranch_scc1 L2_xe25
L2_xr25:
    v_add_u32 v98, s37, v0
    v_mov_b32 v90, -1
    ds_write_b32 v98, v90
    v_add_u32 v98, s38, v0
    ds_read2st64_b32 v[40:41], v0 offset0:0 offset1:1
    ds_read_b32 v43, v0 offset:512
    v_lshrrev_b32 v98, 1, v98
    v_and_b32 v98, -4, v98
    ds_read_b32 v42, v98 offset:768
    s_sub_u32 s3, s37, 768
    s_cmp_gt_u32 s3, 128
    s_cbranch_scc1 L2_xf25
L2_xg25:
    s_setprio 2
    s_waitcnt lgkmcnt(12)
    v_cmp_ne_u64 s[50:51], v[72:73], v[68:69]
    v_cmpx_ne_u64 s[54:55], v[74:75], v[70:71]
    s_and_b64 s[82:83], s[54:55], s[80:81]
    s_cbranch_scc1 L2_c26
L2_d26:
    v_mov_b64 v[84:85], v[70:71]
    v_mov_b32 v7, v93
    v_mov_b64 v[86:87], v[74:75]
    s_or_b64 s[80:81], s[80:81], s[54:55]
    s_mov_b64 exec, s[50:51]
    s_and_b64 s[82:83], s[50:51], s[80:81]
    s_cbranch_scc1 L2_c27
L2_d27:
    v_mov_b64 v[84:85], v[68:69]
    v_mov_b32 v7, v92
    v_mov_b64 v[86:87], v[72:73]
    s_mov_b64 exec, -1
    s_or_b64 s[80:81], s[80:81], s[50:51]
    ds_read_b64 v[70:71], v95 offset:65408
    ds_read_b64 v[68:69], v94 offset:65408
    v_and_b32 v46, 0x40000000, v39
    v_bitop3_b32 v92, v36, v5, v46 bitop3:0xea
    v_and_b32 v46, 0x80000000, v39
    v_bitop3_b32 v93, v37, v5, v46 bitop3:0xea
    v_perm_b32 v15, v37, v38, s47
    v_bitop3_b32 v46, v37, 0.5, -0.5 bitop3:0xa8
    v_perm_b32 v14, v36, v38, s46
    v_bitop3_b32 v47, v36, 0.5, -0.5 bitop3:0xa8
    v_bitop3_b32 v15, v6, v15, v46 bitop3:0xca
    v_bitop3_b32 v14, v6, v14, v47 bitop3:0xca
    s_setprio 1
    s_waitcnt lgkmcnt(1)
    v_mfma_f32_4x4x4_16b_bf16 v[80:83], v[10:11], v[70:71], v[80:83]
    s_waitcnt lgkmcnt(0)
    v_mfma_f32_4x4x4_16b_bf16 v[76:79], v[10:11], v[68:69], v[76:79]
    s_nop 2
    v_cvt_pk_bf16_f32 v80, v80, v81
    v_cvt_pk_bf16_f32 v81, v82, v83
    ds_wrxchg_rtn_b64 v[74:75], v95, v[80:81] offset:65408
    v_cvt_pk_bf16_f32 v76, v76, v77
    v_cvt_pk_bf16_f32 v77, v78, v79
    ds_wrxchg_rtn_b64 v[72:73], v94, v[76:77] offset:65408
    s_setprio 0
    s_waitcnt vmcnt(9)
    v_subrev_u32 v88, s100, v3
    ds_write_b128 v88, v[108:111] offset:0
    s_waitcnt vmcnt(9)
    v_subrev_u32 v88, s100, v3
    ds_write_b128 v88, v[112:115] offset:1024
    v_mfma_f32_4x4x4_16b_bf16 v[80:83], v[8:9], v[102:103], 0
    v_mfma_f32_4x4x4_16b_bf16 v[76:79], v[8:9], v[100:101], 0
    v_cmp_lt_u32 s[84:85], v5, v92
    s_nop 2
    v_pk_mul_f32 v[80:81], v[80:81], v[14:15] op_sel:[0,1] op_sel_hi:[1,1]
    v_pk_mul_f32 v[82:83], v[82:83], v[14:15] op_sel:[0,1] op_sel_hi:[1,1]
    v_pk_mul_f32 v[76:77], v[76:77], v[14:15] op_sel:[0,0] op_sel_hi:[1,0]
    v_pk_mul_f32 v[78:79], v[78:79], v[14:15] op_sel:[0,0] op_sel_hi:[1,0]
    s_add_u32 s42, s42, 1
    s_waitcnt lgkmcnt(0)
    s_add_u32 s24, s30, 0xec45000
    s_addc_u32 s25, s31, 0
    s_mov_b32 s26, 0x100
    s_mov_b32 s27, 0x20000
    s_barrier
    s_bitcmp1_b32 s36, s42
    s_cbranch_scc1 L2_slow
L2_ret1:
    s_setprio 3
    s_bitcmp1_b32 s43, s42
    s_cbranch_scc1 L2_oa28
L2_ob28:
    v_and_b32 v47, 0x0fffffff, v44
    v_mov_b32 v39, v44
    buffer_load_dwordx2 v[34:35], v47, s[8:11], 0 offen
    buffer_load_dwordx3 v[36:38], v47, s[8:11], 0 offen offset:8
    s_waitcnt vmcnt(9)
    v_and_b32 v46, 0x20000000, v21
    v_lshrrev_b32 v47, 14, v17
    v_bitop3_b32 v47, v47, v5, v46 bitop3:0xea
    ds_read_b64 v[106:107], v47
    v_and_b32 v99, 0x10000000, v21
    v_lshrrev_b32 v47, 14, v16
    v_bitop3_b32 v47, v47, v5, v99 bitop3:0xea
    ds_read_b64 v[104:105], v47
    v_cmp_ne_u64 s[50:51], v[72:73], v[68:69]
    v_cmpx_ne_u64 s[54:55], v[74:75], v[70:71]
    s_and_b64 s[82:83], s[54:55], s[80:81]
    s_cbranch_scc1 L2_c29
L2_d29:
    v_mov_b64 v[84:85], v[70:71]
    v_mov_b32 v7, v95
    v_mov_b64 v[86:87], v[74:75]
    s_or_b64 s[80:81], s[80:81], s[54:55]
    s_mov_b64 exec, s[50:51]
    s_and_b64 s[82:83], s[50:51], s[80:81]
    s_cbranch_scc1 L2_c30
L2_d30:
    v_mov_b64 v[84:85], v[68:69]
    v_mov_b32 v7, v94
    v_mov_b64 v[86:87], v[72:73]
    s_mov_b64 exec, -1
    s_or_b64 s[80:81], s[80:81], s[50:51]
    s_and_b64 exec, s[84:85], s[80:81]
    v_mfma_f32_4x4x4_16b_bf16 v[76:79], v[12:13], v[84:85], 0
    v_mov_b32 v92, v7
    s_andn2_b64 s[80:81], s[80:81], s[84:85]
    v_mfma_f32_4x4x4_16b_bf16 v[76:79], v[10:11], v[86:87], v[76:79]
    s_mov_b64 exec, -1
    ds_read_b64 v[70:71], v93 offset:65408
    ds_read_b64 v[68:69], v92 offset:65408
    v_bitop3_b32 v94, v16, v5, v99 bitop3:0xea
    v_bitop3_b32 v95, v17, v5, v46 bitop3:0xea
    v_perm_b32 v15, v17, v20, s45
    v_bitop3_b32 v46, v17, 0.5, -0.5 bitop3:0xa8
    v_perm_b32 v14, v16, v20, s44
    v_bitop3_b32 v47, v16, 0.5, -0.5 bitop3:0xa8
    v_bitop3_b32 v15, v6, v15, v46 bitop3:0xca
    v_bitop3_b32 v14, v6, v14, v47 bitop3:0xca
    s_waitcnt lgkmcnt(1)
    v_mfma_f32_4x4x4_16b_bf16 v[80:83], v[10:11], v[70:71], v[80:83]
    s_waitcnt lgkmcnt(0)
    v_mfma_f32_4x4x4_16b_bf16 v[76:79], v[10:11], v[68:69], v[76:79]
    s_nop 2
    v_cvt_pk_bf16_f32 v80, v80, v81
    v_cvt_pk_bf16_f32 v81, v82, v83
    ds_wrxchg_rtn_b64 v[74:75], v93, v[80:81] offset:65408
    v_cvt_pk_bf16_f32 v76, v76, v77
    v_cvt_pk_bf16_f32 v77, v78, v79
    ds_wrxchg_rtn_b64 v[72:73], v92, v[76:77] offset:65408
    v_mfma_f32_4x4x4_16b_bf16 v[80:83], v[8:9], v[106:107], 0
    v_mfma_f32_4x4x4_16b_bf16 v[76:79], v[8:9], v[104:105], 0
    v_cmp_lt_u32 s[84:85], v5, v94
    s_nop 2
    v_pk_mul_f32 v[80:81], v[80:81], v[14:15] op_sel:[0,1] op_sel_hi:[1,1]
    v_pk_mul_f32 v[82:83], v[82:83], v[14:15] op_sel:[0,1] op_sel_hi:[1,1]
    v_pk_mul_f32 v[76:77], v[76:77], v[14:15] op_sel:[0,0] op_sel_hi:[1,0]
    v_pk_mul_f32 v[78:79], v[78:79], v[14:15] op_sel:[0,0] op_sel_hi:[1,0]
    buffer_load_dwordx4 v[108:111], v3, s[16:19], s40 offen offset:0 sc1
    v_and_b32 v46, 0x80000000, v21
    v_lshrrev_b32 v47, 14, v19
    v_bitop3_b32 v47, v47, v5, v46 bitop3:0xea
    ds_read_b64 v[102:103], v47
    v_and_b32 v99, 0x40000000, v21
    v_lshrrev_b32 v47, 14, v18
    v_bitop3_b32 v47, v47, v5, v99 bitop3:0xea
    ds_read_b64 v[100:101], v47
    s_waitcnt lgkmcnt(2)
    v_cmp_ne_u64 s[50:51], v[72:73], v[68:69]
    v_cmpx_ne_u64 s[54:55], v[74:75], v[70:71]
    s_and_b64 s[82:83], s[54:55], s[80:81]
    s_cbranch_scc1 L2_c31
L2_d31:
    v_mov_b64 v[84:85], v[70:71]
    v_mov_b32 v7, v93
    v_mov_b64 v[86:87], v[74:75]
    s_or_b64 s[80:81], s[80:81], s[54:55]
    s_mov_b64 exec, s[50:51]
    s_and_b64 s[82:83], s[50:51], s[80:81]
    s_cbranch_scc1 L2_c32
L2_d32:
    v_mov_b64 v[84:85], v[68:69]
    v_mov_b32 v7, v92
    v_mov_b64 v[86:87], v[72:73]
    s_mov_b64 exec, -1
    s_or_b64 s[80:81], s[80:81], s[50:51]
    s_and_b64 exec, s[84:85], s[80:81]
    v_mfma_f32_4x4x4_16b_bf16 v[76:79], v[12:13], v[84:85], 0
    v_mov_b32 v94, v7
    s_andn2_b64 s[80:81], s[80:81], s[84:85]
    v_mfma_f32_4x4x4_16b_bf16 v[76:79], v[10:11], v[86:87], v[76:79]
    s_mov_b64 exec, -1
    ds_read_b64 v[70:71], v95 offset:65408
    ds_read_b64 v[68:69], v94 offset:65408
    v_bitop3_b32 v92, v18, v5, v99 bitop3:0xea
    v_bitop3_b32 v93, v19, v5, v46 bitop3:0xea
    v_perm_b32 v15, v19, v20, s47
    v_bitop3_b32 v46, v19, 0.5, -0.5 bitop3:0xa8
    v_perm_b32 v14, v18, v20, s46
    v_bitop3_b32 v47, v18, 0.5, -0.5 bitop3:0xa8
    v_bitop3_b32 v15, v6, v15, v46 bitop3:0xca
    v_bitop3_b32 v14, v6, v14, v47 bitop3:0xca
    s_waitcnt lgkmcnt(1)
    v_mfma_f32_4x4x4_16b_bf16 v[80:83], v[10:11], v[70:71], v[80:83]
    s_waitcnt lgkmcnt(0)
    v_mfma_f32_4x4x4_16b_bf16 v[76:79], v[10:11], v[68:69], v[76:79]
    s_nop 2
    v_cvt_pk_bf16_f32 v80, v80, v81
    v_cvt_pk_bf16_f32 v81, v82, v83
    ds_wrxchg_rtn_b64 v[74:75], v95, v[80:81] offset:65408
    v_cvt_pk_bf16_f32 v76, v76, v77
    v_cvt_pk_bf16_f32 v77, v78, v79
    ds_wrxchg_rtn_b64 v[72:73], v94, v[76:77] offset:65408
    s_setprio 2
    v_mfma_f32_4x4x4_16b_bf16 v[80:83], v[8:9], v[102:103], 0
    v_mfma_f32_4x4x4_16b_bf16 v[76:79], v[8:9], v[100:101], 0
    v_cmp_lt_u32 s[48:49], v5, v93
    s_nop 2
    v_pk_mul_f32 v[80:81], v[80:81], v[14:15] op_sel:[0,1] op_sel_hi:[1,1]
    v_pk_mul_f32 v[82:83], v[82:83], v[14:15] op_sel:[0,1] op_sel_hi:[1,1]
    v_pk_mul_f32 v[76:77], v[76:77], v[14:15] op_sel:[0,0] op_sel_hi:[1,0]
    v_pk_mul_f32 v[78:79], v[78:79], v[14:15] op_sel:[0,0] op_sel_hi:[1,0]
    v_and_b32 v47, 0x0fffffff, v40
    v_mov_b32 v21, v40
    buffer_load_dwordx2 v[16:17], v47, s[8:11], 0 offen
    buffer_load_dwordx3 v[18:20], v47, s[8:11], 0 offen offset:8
    s_waitcnt vmcnt(10)
    v_and_b32 v46, 0x20000000, v27
    v_lshrrev_b32 v47, 14, v23
    v_bitop3_b32 v47, v47, v5, v46 bitop3:0xea
    ds_read_b64 v[106:107], v47
    v_and_b32 v99, 0x10000000, v27
    v_lshrrev_b32 v47, 14, v22
    v_bitop3_b32 v47, v47, v5, v99 bitop3:0xea
    ds_read_b64 v[104:105], v47
    s_waitcnt lgkmcnt(2)
    v_cmp_ne_u64 s[50:51], v[72:73], v[68:69]
    v_cmpx_ne_u64 s[54:55], v[74:75], v[70:71]
    s_and_b64 s[82:83], s[54:55], s[80:81]
    s_cbranch_scc1 L2_c33
L2_d33:
    v_mov_b64 v[84:85], v[70:71]
    v_mov_b32 v7, v95
    v_mov_b64 v[86:87], v[74:75]
    s_or_b64 s[80:81], s[80:81], s[54:55]
    s_mov_b64 exec, s[50:51]
    s_and_b64 s[82:83], s[50:51], s[80:81]
    s_cbranch_scc1 L2_c34
L2_d34:
    v_mov_b64 v[84:85], v[68:69]
    v_mov_b32 v7, v94
    v_mov_b64 v[86:87], v[72:73]
    s_mov_b64 exec, -1
    s_or_b64 s[80:81], s[80:81], s[50:51]
    s_and_b64 exec, s[48:49], s[80:81]
    v_mfma_f32_4x4x4_16b_bf16 v[80:83], v[12:13], v[84:85], 0
    v_mov_b32 v93, v7
    s_andn2_b64 s[80:81], s[80:81], s[48:49]
    v_mfma_f32_4x4x4_16b_bf16 v[80:83], v[10:11], v[86:87], v[80:83]
    s_mov_b64 exec, -1
    ds_read_b64 v[70:71], v93 offset:65408
    ds_read_b64 v[68:69], v92 offset:65408
    v_bitop3_b32 v94, v22, v5, v99 bitop3:0xea
    v_bitop3_b32 v95, v23, v5, v46 bitop3:0xea
    v_perm_b32 v15, v23, v26, s45
    v_bitop3_b32 v46, v23, 0.5, -0.5 bitop3:0xa8
    v_perm_b32 v14, v22, v26, s44
    v_bitop3_b32 v47, v22, 0.5, -0.5 bitop3:0xa8
    v_bitop3_b32 v15, v6, v15, v46 bitop3:0xca
    v_bitop3_b32 v14, v6, v14, v47 bitop3:0xca
    s_waitcnt lgkmcnt(1)
    v_mfma_f32_4x4x4_16b_bf16 v[80:83], v[10:11], v[70:71], v[80:83]
    s_waitcnt lgkmcnt(0)
    v_mfma_f32_4x4x4_16b_bf16 v[76:79], v[10:11], v[68:69], v[76:79]
    s_nop 2
    v_cvt_pk_bf16_f32 v80, v80, v81
    v_cvt_pk_bf16_f32 v81, v82, v83
    ds_wrxchg_rtn_b64 v[74:75], v93, v[80:81] offset:65408
    v_cvt_pk_bf16_f32 v76, v76, v77
    v_cvt_pk_bf16_f32 v77, v78, v79
    ds_wrxchg_rtn_b64 v[72:73], v92, v[76:77] offset:65408
    s_setprio 1
    v_mfma_f32_4x4x4_16b_bf16 v[80:83], v[8:9], v[106:107], 0
    v_mfma_f32_4x4x4_16b_bf16 v[76:79], v[8:9], v[104:105], 0
    s_nop 3
    v_pk_mul_f32 v[80:81], v[80:81], v[14:15] op_sel:[0,1] op_sel_hi:[1,1]
    v_pk_mul_f32 v[82:83], v[82:83], v[14:15] op_sel:[0,1] op_sel_hi:[1,1]
    v_pk_mul_f32 v[76:77], v[76:77], v[14:15] op_sel:[0,0] op_sel_hi:[1,0]
    v_pk_mul_f32 v[78:79], v[78:79], v[14:15] op_sel:[0,0] op_sel_hi:[1,0]
    s_bitcmp1_b32 s43, s42
    s_cbranch_scc1 L2_oa35
L2_ob35:
    buffer_load_dwordx4 v[112:115], v3, s[16:19], s40 offen offset:1024 sc1
    v_sub_u16 v88, v62, v54
    v_and_b32 v89, 3, v54
    v_add3_u32 v99, v88, v89, 3
    v_and_b32 v99, -4, v99
    v_max_u32 v99, 4, v99
    v_and_b32 v97, 0xfffc, v54
    v_bfm_b32 v96, v88, v89
    v_add_u32_dpp v91, v99, v99 row_shr:1 row_mask:0xf bank_mask:0xf bound_ctrl:1
    v_mad_u32_u24 v97, v97, 5, v2
    v_cmp_lt_u32 vcc, 16, v99
    v_add_u32_dpp v91, v91, v91 row_shr:2 row_mask:0xf bank_mask:0xf bound_ctrl:1
    v_sub_u32 v98, s38, v99
    v_lshrrev_b64 v[54:55], 16, v[54:55]
    v_add_u32_dpp v91, v91, v91 row_shr:4 row_mask:0xf bank_mask:0xf bound_ctrl:1
    v_lshrrev_b64 v[62:63], 16, v[62:63]
    s_mov_b32 s101, 0
    v_add_u32_dpp v91, v91, v91 row_shr:8 row_mask:0xf bank_mask:0xf bound_ctrl:1
    s_nop 1
    v_add_u32_dpp v91, v91, v91 row_bcast:15 row_mask:0xa bank_mask:0xf
    s_nop 1
    v_add_u32_dpp v91, v91, v91 row_bcast:31 row_mask:0xc bank_mask:0xf
    v_add_u32 v98, v98, v91
    v_readlane_b32 s37, v91, 63
    s_cbranch_vccnz L2_xo36
L2_xp36:
    v_and_b32 v46, 0x80000000, v27
    v_lshrrev_b32 v47, 14, v25
    v_bitop3_b32 v47, v47, v5, v46 bitop3:0xea
    ds_read_b64 v[102:103], v47
    v_and_b32 v99, 0x40000000, v27
    v_lshrrev_b32 v47, 14, v24
    v_bitop3_b32 v47, v47, v5, v99 bitop3:0xea
    ds_read_b64 v[100:101], v47
    s_waitcnt lgkmcnt(2)
    v_cmp_ne_u64 s[50:51], v[72:73], v[68:69]
    v_cmpx_ne_u64 s[54:55], v[74:75], v[70:71]
    s_and_b64 s[82:83], s[54:55], s[80:81]
    s_cbranch_scc1 L2_c37
L2_d37:
    v_mov_b64 v[84:85], v[70:71]
    v_mov_b32 v7, v93
    v_mov_b64 v[86:87], v[74:75]
    s_or_b64 s[80:81], s[80:81], s[54:55]
    s_mov_b64 exec, s[50:51]
    s_and_b64 s[82:83], s[50:51], s[80:81]
    s_cbranch_scc1 L2_c38
L2_d38:
    v_mov_b64 v[84:85], v[68:69]
    v_mov_b32 v7, v92
    v_mov_b64 v[86:87], v[72:73]
    s_mov_b64 exec, -1
    s_or_b64 s[80:81], s[80:81], s[50:51]
    ds_read_b64 v[70:71], v95 offset:65408
    ds_read_b64 v[68:69], v94 offset:65408
    v_bitop3_b32 v92, v24, v5, v99 bitop3:0xea
    v_bitop3_b32 v93, v25, v5, v46 bitop3:0xea
    v_perm_b32 v15, v25, v26, s47
    v_bitop3_b32 v46, v25, 0.5, -0.5 bitop3:0xa8
    v_perm_b32 v14, v24, v26, s46
    v_bitop3_b32 v47, v24, 0.5, -0.5 bitop3:0xa8
    v_bitop3_b32 v15, v6, v15, v46 bitop3:0xca
    v_bitop3_b32 v14, v6, v14, v47 bitop3:0xca
    s_waitcnt lgkmcnt(1)
    v_mfma_f32_4x4x4_16b_bf16 v[80:83], v[10:11], v[70:71], v[80:83]
    s_waitcnt lgkmcnt(0)
    v_mfma_f32_4x4x4_16b_bf16 v[76:79], v[10:11], v[68:69], v[76:79]
    s_nop 2
    v_cvt_pk_bf16_f32 v80, v80, v81
    v_cvt_pk_bf16_f32 v81, v82, v83
    ds_wrxchg_rtn_b64 v[74:75], v95, v[80:81] offset:65408
    v_cvt_pk_bf16_f32 v76, v76, v77
    v_cvt_pk_bf16_f32 v77, v78, v79
    ds_wrxchg_rtn_b64 v[72:73], v94, v[76:77] offset:65408
    v_mfma_f32_4x4x4_16b_bf16 v[80:83], v[8:9], v[102:103], 0
    v_mfma_f32_4x4x4_16b_bf16 v[76:79], v[8:9], v[100:101], 0
    v_cmp_lt_u32 s[84:85], v5, v92
    s_nop 2
    v_pk_mul_f32 v[80:81], v[80:81], v[14:15] op_sel:[0,1] op_sel_hi:[1,1]
    v_pk_mul_f32 v[82:83], v[82:83], v[14:15] op_sel:[0,1] op_sel_hi:[1,1]
    v_pk_mul_f32 v[76:77], v[76:77], v[14:15] op_sel:[0,0] op_sel_hi:[1,0]
    v_pk_mul_f32 v[78:79], v[78:79], v[14:15] op_sel:[0,0] op_sel_hi:[1,0]
    v_and_b32 v47, 0x0fffffff, v41
    v_mov_b32 v27, v41
    buffer_load_dwordx2 v[22:23], v47, s[8:11], 0 offen
    buffer_load_dwordx3 v[24:26], v47, s[8:11], 0 offen offset:8
    s_waitcnt vmcnt(8)
    s_mov_b64 exec, s[6:7]
    v_lshrrev_b32 v30, 16, v30
    s_mov_b64 exec, -1
    v_and_b32 v46, 0x20000000, v31
    v_lshrrev_b32 v47, 14, v29
    v_bitop3_b32 v47, v47, v5, v46 bitop3:0xea
    ds_read_b64 v[106:107], v47
    v_and_b32 v99, 0x10000000, v31
    v_lshrrev_b32 v47, 14, v28
    v_bitop3_b32 v47, v47, v5, v99 bitop3:0xea
    ds_read_b64 v[104:105], v47
    s_waitcnt lgkmcnt(2)
    v_cmp_ne_u64 s[50:51], v[72:73], v[68:69]
    v_cmpx_ne_u64 s[54:55], v[74:75], v[70:71]
    s_and_b64 s[82:83], s[54:55], s[80:81]
    s_cbranch_scc1 L2_c39
L2_d39:
    v_mov_b64 v[84:85], v[70:71]
    v_mov_b32 v7, v95
    v_mov_b64 v[86:87], v[74:75]
    s_or_b64 s[80:81], s[80:81], s[54:55]
    s_mov_b64 exec, s[50:51]
    s_and_b64 s[82:83], s[50:51], s[80:81]
    s_cbranch_scc1 L2_c40
L2_d40:
    v_mov_b64 v[84:85], v[68:69]
    v_mov_b32 v7, v94
    v_mov_b64 v[86:87], v[72:73]
    s_mov_b64 exec, -1
    s_or_b64 s[80:81], s[80:81], s[50:51]
    s_and_b64 exec, s[84:85], s[80:81]
    v_mfma_f32_4x4x4_16b_bf16 v[76:79], v[12:13], v[84:85], 0
    v_mov_b32 v92, v7
    s_andn2_b64 s[80:81], s[80:81], s[84:85]
    v_mfma_f32_4x4x4_16b_bf16 v[76:79], v[10:11], v[86:87], v[76:79]
    s_mov_b64 exec, -1
    ds_read_b64 v[70:71], v93 offset:65408
    ds_read_b64 v[68:69], v92 offset:65408
    v_bitop3_b32 v94, v28, v5, v99 bitop3:0xea
    v_bitop3_b32 v95, v29, v5, v46 bitop3:0xea
    v_perm_b32 v15, v29, v30, s45
    v_bitop3_b32 v46, v29, 0.5, -0.5 bitop3:0xa8
    v_perm_b32 v14, v28, v30, s44
    v_bitop3_b32 v47, v28, 0.5, -0.5 bitop3:0xa8
    v_bitop3_b32 v15, v6, v15, v46 bitop3:0xca
    v_bitop3_b32 v14, v6, v14, v47 bitop3:0xca
    s_waitcnt lgkmcnt(1)
    v_mfma_f32_4x4x4_16b_bf16 v[80:83], v[10:11], v[70:71], v[80:83]
    s_waitcnt lgkmcnt(0)
    v_mfma_f32_4x4x4_16b_bf16 v[76:79], v[10:11], v[68:69], v[76:79]
    s_nop 2
    v_cvt_pk_bf16_f32 v80, v80, v81
    v_cvt_pk_bf16_f32 v81, v82, v83
    ds_wrxchg_rtn_b64 v[74:75], v93, v[80:81] offset:65408
    v_cvt_pk_bf16_f32 v76, v76, v77
    v_cvt_pk_bf16_f32 v77, v78, v79
    ds_wrxchg_rtn_b64 v[72:73], v92, v[76:77] offset:65408
    s_setprio 0
    v_mfma_f32_4x4x4_16b_bf16 v[80:83], v[8:9], v[106:107], 0
    v_mfma_f32_4x4x4_16b_bf16 v[76:79], v[8:9], v[104:105], 0
    v_cmp_lt_u32 s[48:49], v5, v95
    s_nop 2
    v_pk_mul_f32 v[80:81], v[80:81], v[14:15] op_sel:[0,1] op_sel_hi:[1,1]
    v_pk_mul_f32 v[82:83], v[82:83], v[14:15] op_sel:[0,1] op_sel_hi:[1,1]
    v_pk_mul_f32 v[76:77], v[76:77], v[14:15] op_sel:[0,0] op_sel_hi:[1,0]
    v_pk_mul_f32 v[78:79], v[78:79], v[14:15] op_sel:[0,0] op_sel_hi:[1,0]
    s_add_u32 s40, s40, 0x50000
    s_waitcnt vmcnt(6)
    v_and_b32 v46, 0x80000000, v39
    v_lshrrev_b32 v47, 14, v37
    v_bitop3_b32 v47, v47, v5, v46 bitop3:0xea
    ds_read_b64 v[106:107], v47
    v_and_b32 v99, 0x40000000, v39
    v_lshrrev_b32 v47, 14, v36
    v_bitop3_b32 v47, v47, v5, v99 bitop3:0xea
    ds_read_b64 v[104:105], v47
    v_and_b32 v46, 0x20000000, v39
    v_lshrrev_b32 v47, 14, v35
    v_bitop3_b32 v47, v47, v5, v46 bitop3:0xea
    ds_read_b64 v[102:103], v47
    v_and_b32 v99, 0x10000000, v39
    v_lshrrev_b32 v47, 14, v34
    v_bitop3_b32 v47, v47, v5, v99 bitop3:0xea
    ds_read_b64 v[100:101], v47
    s_waitcnt lgkmcnt(4)
    v_cmp_ne_u64 s[50:51], v[72:73], v[68:69]
    v_cmpx_ne_u64 s[54:55], v[74:75], v[70:71]
    s_and_b64 s[82:83], s[54:55], s[80:81]
    s_cbranch_scc1 L2_c41
L2_d41:
    v_mov_b64 v[84:85], v[70:71]
    v_mov_b32 v7, v93
    v_mov_b64 v[86:87], v[74:75]
    s_or_b64 s[80:81], s[80:81], s[54:55]
    s_mov_b64 exec, s[50:51]
    s_and_b64 s[82:83], s[50:51], s[80:81]
    s_cbranch_scc1 L2_c42
L2_d42:
    v_mov_b64 v[84:85], v[68:69]
    v_mov_b32 v7, v92
    v_mov_b64 v[86:87], v[72:73]
    s_mov_b64 exec, -1
    s_or_b64 s[80:81], s[80:81], s[50:51]
    s_and_b64 exec, s[48:49], s[80:81]
    v_mfma_f32_4x4x4_16b_bf16 v[80:83], v[12:13], v[84:85], 0
    v_mov_b32 v95, v7
    s_andn2_b64 s[80:81], s[80:81], s[48:49]
    v_mfma_f32_4x4x4_16b_bf16 v[80:83], v[10:11], v[86:87], v[80:83]
    s_mov_b64 exec, -1
    ds_read_b64 v[70:71], v95 offset:65408
    ds_read_b64 v[68:69], v94 offset:65408
    v_bitop3_b32 v92, v34, v5, v99 bitop3:0xea
    v_bitop3_b32 v93, v35, v5, v46 bitop3:0xea
    v_perm_b32 v15, v35, v38, s45
    v_bitop3_b32 v46, v35, 0.5, -0.5 bitop3:0xa8
    v_perm_b32 v14, v34, v38, s44
    v_bitop3_b32 v47, v34, 0.5, -0.5 bitop3:0xa8
    v_bitop3_b32 v15, v6, v15, v46 bitop3:0xca
    v_bitop3_b32 v14, v6, v14, v47 bitop3:0xca
    s_waitcnt lgkmcnt(1)
    v_mfma_f32_4x4x4_16b_bf16 v[80:83], v[10:11], v[70:71], v[80:83]
    s_waitcnt lgkmcnt(0)
    v_mfma_f32_4x4x4_16b_bf16 v[76:79], v[10:11], v[68:69], v[76:79]
    s_nop 2
    v_cvt_pk_bf16_f32 v80, v80, v81
    v_cvt_pk_bf16_f32 v81, v82, v83
    ds_wrxchg_rtn_b64 v[74:75], v95, v[80:81] offset:65408
    v_cvt_pk_bf16_f32 v76, v76, v77
    v_cvt_pk_bf16_f32 v77, v78, v79
    ds_wrxchg_rtn_b64 v[72:73], v94, v[76:77] offset:65408
    s_barrier
    s_setprio 3
    s_mov_b32 m0, s100
    s_nop 0
    ds_write_addtid_b32 v124 offset:34816
    ds_write_addtid_b32 v125 offset:35072
    ds_write_addtid_b32 v126 offset:35328
    ds_write_addtid_b32 v127 offset:35584
    s_add_u32 s3, s40, 4096
    buffer_load_dwordx4 v[124:127], v3, s[16:19], s3 offen sc1
    ds_write_addtid_b32 v116 offset:32768
    ds_write_addtid_b32 v117 offset:33024
    ds_write_addtid_b32 v118 offset:33280
    ds_write_addtid_b32 v119 offset:33536
    buffer_load_dwordx4 v[116:119], v3, s[16:19], s40 offen offset:2048 sc1
    ds_write_addtid_b32 v120 offset:33792
    ds_write_addtid_b32 v121 offset:34048
    ds_write_addtid_b32 v122 offset:34304
    ds_write_addtid_b32 v123 offset:34560
    buffer_load_dwordx4 v[120:123], v3, s[16:19], s40 offen offset:3072 sc1
    v_mfma_f32_4x4x4_16b_bf16 v[80:83], v[8:9], v[102:103], 0
    v_mfma_f32_4x4x4_16b_bf16 v[76:79], v[8:9], v[100:101], 0
    s_nop 3
    v_pk_mul_f32 v[80:81], v[80:81], v[14:15] op_sel:[0,1] op_sel_hi:[1,1]
    v_pk_mul_f32 v[82:83], v[82:83], v[14:15] op_sel:[0,1] op_sel_hi:[1,1]
    v_pk_mul_f32 v[76:77], v[76:77], v[14:15] op_sel:[0,0] op_sel_hi:[1,0]
    v_pk_mul_f32 v[78:79], v[78:79], v[14:15] op_sel:[0,0] op_sel_hi:[1,0]
    v_and_b32 v47, 0x0fffffff, v42
    v_mov_b32 v31, v42
    buffer_load_dword v30, v47, s[8:11], 0 offen offset:16
    s_mov_b64 exec, s[6:7]
    v_add_u32 v47, 8, v47
    v_lshrrev_b32 v31, 2, v31
    s_mov_b64 exec, -1
    buffer_load_dwordx2 v[28:29], v47, s[8:11], 0 offen
    v_mov_b32 v44, v43
    s_cmp_gt_u32 s37, 1024
    s_cbranch_scc1 L2_xs43
    s_cmp_lg_u32 s101, 0
    s_cbranch_scc1 L2_xa43
L2_xb43:
    v_lshlrev_b32 v89, 16, v96
    v_add_u32 v90, 60, v97
    v_bitop3_b32 v90, v89, v45, v90 bitop3:0x6a
    ds_write_b32 v98, v90 offset:12
    v_lshlrev_b32 v89, 20, v96
    v_add_u32 v90, 40, v97
    v_bitop3_b32 v90, v89, v45, v90 bitop3:0x6a
    ds_write_b32 v98, v90 offset:8
    v_lshlrev_b32 v89, 24, v96
    v_add_u32 v90, 20, v97
    v_bitop3_b32 v90, v89, v45, v90 bitop3:0x6a
    ds_write_b32 v98, v90 offset:4
    v_lshlrev_b32 v89, 28, v96
    v_bitop3_b32 v90, v89, v45, v97 bitop3:0x6a
    ds_write_b32 v98, v90 offset:0
    v_mov_b32_dpp v91, v66 quad_perm:[1,1,1,1] row_mask:0xf bank_mask:0xf
    v_and_b32 v89, 3, v91
    v_and_b32 v97, 0xfffc, v91
    v_sub_u16_dpp v88, v66, v91 quad_perm:[3,3,3,3] row_mask:0xf bank_mask:0xf
    v_mad_u32_u24 v97, v97, 5, v4
    v_add_u32 v99, v88, v89
    v_bfm_b32 v96, v88, v89
    v_cmp_lt_u32 s[58:59], 16, v99
    v_lshlrev_b32 v89, v1, v96
    v_and_b32 v89, v45, v89
    v_cmp_ne_u32 vcc, 0, v89
    v_xor_b32 v90, v97, v89
    s_add_u32 s3, s37, s38
    v_mbcnt_lo_u32_b32 v98, vcc_lo, 0
    v_mbcnt_hi_u32_b32 v98, vcc_hi, v98
    s_bcnt1_i32_b64 s41, vcc
    v_lshl_add_u32 v98, v98, 2, s3
    s_lshl2_add_u32 s37, s41, s37
    s_mov_b64 exec, vcc
    ds_write_b32 v98, v90
    s_mov_b64 exec, -1
    s_cmp_lg_u64 s[58:59], 0
    s_cbranch_scc1 L2_xe43
L2_xr43:
    v_add_u32 v98, s37, v0
    v_mov_b32 v90, -1
    ds_write_b32 v98, v90
    v_add_u32 v98, s38, v0
    ds_read2st64_b32 v[40:41], v0 offset0:0 offset1:1
    ds_read_b32 v43, v0 offset:512
    v_lshrrev_b32 v98, 1, v98
    v_and_b32 v98, -4, v98
    ds_read_b32 v42, v98 offset:768
    s_sub_u32 s3, s37, 768
    s_cmp_gt_u32 s3, 128
    s_cbranch_scc1 L2_xf43
L2_xg43:
    v_lshrrev_b64 v[64:65], 16, v[64:65]
    v_lshrrev_b64 v[66:67], 16, v[66:67]
    s_setprio 2
    s_waitcnt lgkmcnt(14)
    v_cmp_ne_u64 s[50:51], v[72:73], v[68:69]
    v_cmpx_ne_u64 s[54:55], v[74:75], v[70:71]
    s_and_b64 s[82:83], s[54:55], s[80:81]
    s_cbranch_scc1 L2_c44
L2_d44:
    v_mov_b64 v[84:85], v[70:71]
    v_mov_b32 v7, v95
    v_mov_b64 v[86:87], v[74:75]
    s_or_b64 s[80:81], s[80:81], s[54:55]
    s_mov_b64 exec, s[50:51]
    s_and_b64 s[82:83], s[50:51], s[80:81]
    s_cbranch_scc1 L2_c45
L2_d45:
    v_mov_b64 v[84:85], v[68:69]
    v_mov_b32 v7, v94
    v_mov_b64 v[86:87], v[72:73]
    s_mov_b64 exec, -1
    s_or_b64 s[80:81], s[80:81], s[50:51]
    ds_read_b64 v[70:71], v93 offset:65408
    ds_read_b64 v[68:69], v92 offset:65408
    v_and_b32 v46, 0x40000000, v39
    v_bitop3_b32 v94, v36, v5, v46 bitop3:0xea
    v_and_b32 v46, 0x80000000, v39
    v_bitop3_b32 v95, v37, v5, v46 bitop3:0xea
    v_perm_b32 v15, v37, v38, s47
    v_bitop3_b32 v46, v37, 0.5, -0.5 bitop3:0xa8
    v_perm_b32 v14, v36, v38, s46
    v_bitop3_b32 v47, v36, 0.5, -0.5 bitop3:0xa8
    v_bitop3_b32 v15, v6, v15, v46 bitop3:0xca
    v_bitop3_b32 v14, v6, v14, v47 bitop3:0xca
    s_setprio 1
    s_waitcnt lgkmcnt(1)
    v_mfma_f32_4x4x4_16b_bf16 v[80:83], v[10:11], v[70:71], v[80:83]
    s_waitcnt lgkmcnt(0)
    v_mfma_f32_4x4x4_16b_bf16 v[76:79], v[10:11], v[68:69], v[76:79]
    s_nop 2
    v_cvt_pk_bf16_f32 v80, v80, v81
    v_cvt_pk_bf16_f32 v81, v82, v83
    ds_wrxchg_rtn_b64 v[74:75], v93, v[80:81] offset:65408
    v_cvt_pk_bf16_f32 v76, v76, v77
    v_cvt_pk_bf16_f32 v77, v78, v79
    ds_wrxchg_rtn_b64 v[72:73], v92, v[76:77] offset:65408
    v_and_b32 v88, 0x0fffffff, v44
    v_mov_b32 v39, v44
    buffer_load_dwordx2 v[34:35], v88, s[8:11], 0 offen
    buffer_load_dwordx3 v[36:38], v88, s[8:11], 0 offen offset:8
    s_setprio 0
    s_waitcnt vmcnt(12)
    s_mov_b32 m0, s38
    s_nop 0
    ds_write_addtid_b32 v108 offset:0
    ds_write_addtid_b32 v109 offset:256
    ds_write_addtid_b32 v110 offset:512
    ds_write_addtid_b32 v111 offset:768
    s_waitcnt vmcnt(9)
    ds_write_addtid_b32 v112 offset:1024
    ds_write_addtid_b32 v113 offset:1280
    ds_write_addtid_b32 v114 offset:1536
    ds_write_addtid_b32 v115 offset:1792
    v_mfma_f32_4x4x4_16b_bf16 v[80:83], v[8:9], v[106:107], 0
    v_mfma_f32_4x4x4_16b_bf16 v[76:79], v[8:9], v[104:105], 0
    v_cmp_lt_u32 s[84:85], v5, v94
    s_nop 2
    v_pk_mul_f32 v[80:81], v[80:81], v[14:15] op_sel:[0,1] op_sel_hi:[1,1]
    v_pk_mul_f32 v[82:83], v[82:83], v[14:15] op_sel:[0,1] op_sel_hi:[1,1]
    v_pk_mul_f32 v[76:77], v[76:77], v[14:15] op_sel:[0,0] op_sel_hi:[1,0]
    v_pk_mul_f32 v[78:79], v[78:79], v[14:15] op_sel:[0,0] op_sel_hi:[1,0]
    s_add_u32 s42, s42, 1
    s_waitcnt lgkmcnt(0)
L2_loop:
    s_barrier
    s_bitcmp1_b32 s36, s42
    s_cbranch_scc1 L2_slow
L2_ret2:
    s_setprio 3
    s_bitcmp1_b32 s43, s42
    s_cbranch_scc1 L2_oa46
L2_ob46:
    v_and_b32 v46, 0x20000000, v21
    v_lshrrev_b32 v47, 14, v17
    v_bitop3_b32 v47, v47, v5, v46 bitop3:0xea
    ds_read_b64 v[102:103], v47
    v_and_b32 v99, 0x10000000, v21
    v_lshrrev_b32 v47, 14, v16
    v_bitop3_b32 v47, v47, v5, v99 bitop3:0xea
    ds_read_b64 v[100:101], v47
    v_cmp_ne_u64 s[50:51], v[72:73], v[68:69]
    v_cmpx_ne_u64 s[54:55], v[74:75], v[70:71]
    s_and_b64 s[82:83], s[54:55], s[80:81]
    s_cbranch_scc1 L2_c47
L2_d47:
    v_mov_b64 v[84:85], v[70:71]
    v_mov_b32 v7, v93
    v_mov_b64 v[86:87], v[74:75]
    s_or_b64 s[80:81], s[80:81], s[54:55]
    s_mov_b64 exec, s[50:51]
    s_and_b64 s[82:83], s[50:51], s[80:81]
    s_cbranch_scc1 L2_c48
L2_d48:
    v_mov_b64 v[84:85], v[68:69]
    v_mov_b32 v7, v92
    v_mov_b64 v[86:87], v[72:73]
    s_mov_b64 exec, -1
    s_or_b64 s[80:81], s[80:81], s[50:51]
    s_and_b64 exec, s[84:85], s[80:81]
    v_mfma_f32_4x4x4_16b_bf16 v[76:79], v[12:13], v[84:85], 0
    v_mov_b32 v94, v7
    s_andn2_b64 s[80:81], s[80:81], s[84:85]
    v_mfma_f32_4x4x4_16b_bf16 v[76:79], v[10:11], v[86:87], v[76:79]
    s_mov_b64 exec, -1
    ds_read_b64 v[70:71], v95 offset:65408
    ds_read_b64 v[68:69], v94 offset:65408
    v_bitop3_b32 v92, v16, v5, v99 bitop3:0xea
    v_bitop3_b32 v93, v17, v5, v46 bitop3:0xea
    v_perm_b32 v15, v17, v20, s45
    v_bitop3_b32 v46, v17, 0.5, -0.5 bitop3:0xa8
    v_perm_b32 v14, v16, v20, s44
    v_bitop3_b32 v47, v16, 0.5, -0.5 bitop3:0xa8
    v_bitop3_b32 v15, v6, v15, v46 bitop3:0xca
    v_bitop3_b32 v14, v6, v14, v47 bitop3:0xca
    s_waitcnt lgkmcnt(1)
    v_mfma_f32_4x4x4_16b_bf16 v[80:83], v[10:11], v[70:71], v[80:83]
    s_waitcnt lgkmcnt(0)
    v_mfma_f32_4x4x4_16b_bf16 v[76:79], v[10:11], v[68:69], v[76:79]
    s_nop 2
    v_cvt_pk_bf16_f32 v80, v80, v81
    v_cvt_pk_bf16_f32 v81, v82, v83
    ds_wrxchg_rtn_b64 v[74:75], v95, v[80:81] offset:65408
    v_cvt_pk_bf16_f32 v76, v76, v77
    v_cvt_pk_bf16_f32 v77, v78, v79
    ds_wrxchg_rtn_b64 v[72:73], v94, v[76:77] offset:65408
    v_mfma_f32_4x4x4_16b_bf16 v[80:83], v[8:9], v[102:103], 0
    v_mfma_f32_4x4x4_16b_bf16 v[76:79], v[8:9], v[100:101], 0
    v_cmp_lt_u32 s[84:85], v5, v92
    s_nop 2
    v_pk_mul_f32 v[80:81], v[80:81], v[14:15] op_sel:[0,1] op_sel_hi:[1,1]
    v_pk_mul_f32 v[82:83], v[82:83], v[14:15] op_sel:[0,1] op_sel_hi:[1,1]
    v_pk_mul_f32 v[76:77], v[76:77], v[14:15] op_sel:[0,0] op_sel_hi:[1,0]
    v_pk_mul_f32 v[78:79], v[78:79], v[14:15] op_sel:[0,0] op_sel_hi:[1,0]
    buffer_load_dwordx4 v[108:111], v3, s[16:19], s40 offen offset:0 sc1
    v_and_b32 v46, 0x80000000, v21
    v_lshrrev_b32 v47, 14, v19
    v_bitop3_b32 v47, v47, v5, v46 bitop3:0xea
    ds_read_b64 v[106:107], v47
    v_and_b32 v99, 0x40000000, v21
    v_lshrrev_b32 v47, 14, v18
    v_bitop3_b32 v47, v47, v5, v99 bitop3:0xea
    ds_read_b64 v[104:105], v47
    s_waitcnt lgkmcnt(2)
    v_cmp_ne_u64 s[50:51], v[72:73], v[68:69]
    v_cmpx_ne_u64 s[54:55], v[74:75], v[70:71]
    s_and_b64 s[82:83], s[54:55], s[80:81]
    s_cbranch_scc1 L2_c49
L2_d49:
    v_mov_b64 v[84:85], v[70:71]
    v_mov_b32 v7, v95
    v_mov_b64 v[86:87], v[74:75]
    s_or_b64 s[80:81], s[80:81], s[54:55]
    s_mov_b64 exec, s[50:51]
    s_and_b64 s[82:83], s[50:51], s[80:81]
    s_cbranch_scc1 L2_c50
L2_d50:
    v_mov_b64 v[84:85], v[68:69]
    v_mov_b32 v7, v94
    v_mov_b64 v[86:87], v[72:73]
    s_mov_b64 exec, -1
    s_or_b64 s[80:81], s[80:81], s[50:51]
    s_and_b64 exec, s[84:85], s[80:81]
    v_mfma_f32_4x4x4_16b_bf16 v[76:79], v[12:13], v[84:85], 0
    v_mov_b32 v92, v7
    s_andn2_b64 s[80:81], s[80:81], s[84:85]
    v_mfma_f32_4x4x4_16b_bf16 v[76:79], v[10:11], v[86:87], v[76:79]
    s_mov_b64 exec, -1
    ds_read_b64 v[70:71], v93 offset:65408
    ds_read_b64 v[68:69], v92 offset:65408
    v_bitop3_b32 v94, v18, v5, v99 bitop3:0xea
    v_bitop3_b32 v95, v19, v5, v46 bitop3:0xea
    v_perm_b32 v15, v19, v20, s47
    v_bitop3_b32 v46, v19, 0.5, -0.5 bitop3:0xa8
    v_perm_b32 v14, v18, v20, s46
    v_bitop3_b32 v47, v18, 0.5, -0.5 bitop3:0xa8
    v_bitop3_b32 v15, v6, v15, v46 bitop3:0xca
    v_bitop3_b32 v14, v6, v14, v47 bitop3:0xca
    s_waitcnt lgkmcnt(1)
    v_mfma_f32_4x4x4_16b_bf16 v[80:83], v[10:11], v[70:71], v[80:83]
    s_waitcnt lgkmcnt(0)
    v_mfma_f32_4x4x4_16b_bf16 v[76:79], v[10:11], v[68:69], v[76:79]
    s_nop 2
    v_cvt_pk_bf16_f32 v80, v80, v81
    v_cvt_pk_bf16_f32 v81, v82, v83
    ds_wrxchg_rtn_b64 v[74:75], v93, v[80:81] offset:65408
    v_cvt_pk_bf16_f32 v76, v76, v77
    v_cvt_pk_bf16_f32 v77, v78, v79
    ds_wrxchg_rtn_b64 v[72:73], v92, v[76:77] offset:65408
    v_and_b32 v88, 0x0fffffff, v40
    v_mov_b32 v21, v40
    buffer_load_dwordx2 v[16:17], v88, s[8:11], 0 offen
    buffer_load_dwordx3 v[18:20], v88, s[8:11], 0 offen offset:8
    s_setprio 2
    v_mfma_f32_4x4x4_16b_bf16 v[80:83], v[8:9], v[106:107], 0
    v_mfma_f32_4x4x4_16b_bf16 v[76:79], v[8:9], v[104:105], 0
    v_cmp_lt_u32 s[48:49], v5, v95
    s_nop 2
    v_pk_mul_f32 v[80:81], v[80:81], v[14:15] op_sel:[0,1] op_sel_hi:[1,1]
    v_pk_mul_f32 v[82:83], v[82:83], v[14:15] op_sel:[0,1] op_sel_hi:[1,1]
    v_pk_mul_f32 v[76:77], v[76:77], v[14:15] op_sel:[0,0] op_sel_hi:[1,0]
    v_pk_mul_f32 v[78:79], v[78:79], v[14:15] op_sel:[0,0] op_sel_hi:[1,0]
    s_waitcnt vmcnt(10)
    v_and_b32 v46, 0x20000000, v27
    v_lshrrev_b32 v47, 14, v23
    v_bitop3_b32 v47, v47, v5, v46 bitop3:0xea
    ds_read_b64 v[102:103], v47
    v_and_b32 v99, 0x10000000, v27
    v_lshrrev_b32 v47, 14, v22
    v_bitop3_b32 v47, v47, v5, v99 bitop3:0xea
    ds_read_b64 v[100:101], v47
    s_waitcnt lgkmcnt(2)
    v_cmp_ne_u64 s[50:51], v[72:73], v[68:69]
    v_cmpx_ne_u64 s[54:55], v[74:75], v[70:71]
    s_and_b64 s[82:83], s[54:55], s[80:81]
    s_cbranch_scc1 L2_c51
L2_d51:
    v_mov_b64 v[84:85], v[70:71]
    v_mov_b32 v7, v93
    v_mov_b64 v[86:87], v[74:75]
    s_or_b64 s[80:81], s[80:81], s[54:55]
    s_mov_b64 exec, s[50:51]
    s_and_b64 s[82:83], s[50:51], s[80:81]
    s_cbranch_scc1 L2_c52
L2_d52:
    v_mov_b64 v[84:85], v[68:69]
    v_mov_b32 v7, v92
    v_mov_b64 v[86:87], v[72:73]
    s_mov_b64 exec, -1
    s_or_b64 s[80:81], s[80:81], s[50:51]
    s_and_b64 exec, s[48:49], s[80:81]
    v_mfma_f32_4x4x4_16b_bf16 v[80:83], v[12:13], v[84:85], 0
    v_mov_b32 v95, v7
    s_andn2_b64 s[80:81], s[80:81], s[48:49]
    v_mfma_f32_4x4x4_16b_bf16 v[80:83], v[10:11], v[86:87], v[80:83]
    s_mov_b64 exec, -1
    ds_read_b64 v[70:71], v95 offset:65408
    ds_read_b64 v[68:69], v94 offset:65408
    v_bitop3_b32 v92, v22, v5, v99 bitop3:0xea
    v_bitop3_b32 v93, v23, v5, v46 bitop3:0xea
    v_perm_b32 v15, v23, v26, s45
    v_bitop3_b32 v46, v23, 0.5, -0.5 bitop3:0xa8
    v_perm_b32 v14, v22, v26, s44
    v_bitop3_b32 v47, v22, 0.5, -0.5 bitop3:0xa8
    v_bitop3_b32 v15, v6, v15, v46 bitop3:0xca
    v_bitop3_b32 v14, v6, v14, v47 bitop3:0xca
    s_waitcnt lgkmcnt(1)
    v_mfma_f32_4x4x4_16b_bf16 v[80:83], v[10:11], v[70:71], v[80:83]
    s_waitcnt lgkmcnt(0)
    v_mfma_f32_4x4x4_16b_bf16 v[76:79], v[10:11], v[68:69], v[76:79]
    s_nop 2
    v_cvt_pk_bf16_f32 v80, v80, v81
    v_cvt_pk_bf16_f32 v81, v82, v83
    ds_wrxchg_rtn_b64 v[74:75], v95, v[80:81] offset:65408
    v_cvt_pk_bf16_f32 v76, v76, v77
    v_cvt_pk_bf16_f32 v77, v78, v79
    ds_wrxchg_rtn_b64 v[72:73], v94, v[76:77] offset:65408
    s_setprio 1
    v_mfma_f32_4x4x4_16b_bf16 v[80:83], v[8:9], v[102:103], 0
    v_mfma_f32_4x4x4_16b_bf16 v[76:79], v[8:9], v[100:101], 0
    s_nop 3
    v_pk_mul_f32 v[80:81], v[80:81], v[14:15] op_sel:[0,1] op_sel_hi:[1,1]
    v_pk_mul_f32 v[82:83], v[82:83], v[14:15] op_sel:[0,1] op_sel_hi:[1,1]
    v_pk_mul_f32 v[76:77], v[76:77], v[14:15] op_sel:[0,0] op_sel_hi:[1,0]
    v_pk_mul_f32 v[78:79], v[78:79], v[14:15] op_sel:[0,0] op_sel_hi:[1,0]
    s_bitcmp1_b32 s43, s42
    s_cbranch_scc1 L2_oa53
L2_ob53:
    buffer_load_dwordx4 v[112:115], v3, s[16:19], s40 offen offset:1024 sc1
    v_sub_u16 v88, v56, v48
    v_and_b32 v89, 3, v48
    v_add3_u32 v99, v88, v89, 3
    v_and_b32 v99, -4, v99
    v_max_u32 v99, 4, v99
    v_and_b32 v97, 0xfffc, v48
    v_bfm_b32 v96, v88, v89
    v_add_u32_dpp v91, v99, v99 row_shr:1 row_mask:0xf bank_mask:0xf bound_ctrl:1
    v_mad_u32_u24 v97, v97, 5, v2
    v_cmp_lt_u32 vcc, 16, v99
    v_add_u32_dpp v91, v91, v91 row_shr:2 row_mask:0xf bank_mask:0xf bound_ctrl:1
    v_sub_u32 v98, s38, v99
    v_lshrrev_b64 v[48:49], 16, v[48:49]
    v_add_u32_dpp v91, v91, v91 row_shr:4 row_mask:0xf bank_mask:0xf bound_ctrl:1
    v_lshrrev_b64 v[56:57], 16, v[56:57]
    s_mov_b32 s101, 0
    v_add_u32_dpp v91, v91, v91 row_shr:8 row_mask:0xf bank_mask:0xf bound_ctrl:1
    s_nop 1
    v_add_u32_dpp v91, v91, v91 row_bcast:15 row_mask:0xa bank_mask:0xf
    s_nop 1
    v_add_u32_dpp v91, v91, v91 row_bcast:31 row_mask:0xc bank_mask:0xf
    v_add_u32 v98, v98, v91
    v_readlane_b32 s37, v91, 63
    s_cbranch_vccnz L2_xo54
L2_xp54:
    v_and_b32 v46, 0x80000000, v27
    v_lshrrev_b32 v47, 14, v25
    v_bitop3_b32 v47, v47, v5, v46 bitop3:0xea
    ds_read_b64 v[106:107], v47
    v_and_b32 v99, 0x40000000, v27
    v_lshrrev_b32 v47, 14, v24
    v_bitop3_b32 v47, v47, v5, v99 bitop3:0xea
    ds_read_b64 v[104:105], v47
    s_waitcnt lgkmcnt(2)
    v_cmp_ne_u64 s[50:51], v[72:73], v[68:69]
    v_cmpx_ne_u64 s[54:55], v[74:75], v[70:71]
    s_and_b64 s[82:83], s[54:55], s[80:81]
    s_cbranch_scc1 L2_c55
L2_d55:
    v_mov_b64 v[84:85], v[70:71]
    v_mov_b32 v7, v95
    v_mov_b64 v[86:87], v[74:75]
    s_or_b64 s[80:81], s[80:81], s[54:55]
    s_mov_b64 exec, s[50:51]
    s_and_b64 s[82:83], s[50:51], s[80:81]
    s_cbranch_scc1 L2_c56
L2_d56:
    v_mov_b64 v[84:85], v[68:69]
    v_mov_b32 v7, v94
    v_mov_b64 v[86:87], v[72:73]
    s_mov_b64 exec, -1
    s_or_b64 s[80:81], s[80:81], s[50:51]
    ds_read_b64 v[70:71], v93 offset:65408
    ds_read_b64 v[68:69], v92 offset:65408
    v_bitop3_b32 v94, v24, v5, v99 bitop3:0xea
    v_bitop3_b32 v95, v25, v5, v46 bitop3:0xea
    v_perm_b32 v15, v25, v26, s47
    v_bitop3_b32 v46, v25, 0.5, -0.5 bitop3:0xa8
    v_perm_b32 v14, v24, v26, s46
    v_bitop3_b32 v47, v24, 0.5, -0.5 bitop3:0xa8
    v_bitop3_b32 v15, v6, v15, v46 bitop3:0xca
    v_bitop3_b32 v14, v6, v14, v47 bitop3:0xca
    s_waitcnt lgkmcnt(1)
    v_mfma_f32_4x4x4_16b_bf16 v[80:83], v[10:11], v[70:71], v[80:83]
    s_waitcnt lgkmcnt(0)
    v_mfma_f32_4x4x4_16b_bf16 v[76:79], v[10:11], v[68:69], v[76:79]
    s_nop 2
    v_cvt_pk_bf16_f32 v80, v80, v81
    v_cvt_pk_bf16_f32 v81, v82, v83
    ds_wrxchg_rtn_b64 v[74:75], v93, v[80:81] offset:65408
    v_cvt_pk_bf16_f32 v76, v76, v77
    v_cvt_pk_bf16_f32 v77, v78, v79
    ds_wrxchg_rtn_b64 v[72:73], v92, v[76:77] offset:65408
    v_and_b32 v88, 0x0fffffff, v41
    v_mov_b32 v27, v41
    buffer_load_dwordx2 v[22:23], v88, s[8:11], 0 offen
    buffer_load_dwordx3 v[24:26], v88, s[8:11], 0 offen offset:8
    v_mfma_f32_4x4x4_16b_bf16 v[80:83], v[8:9], v[106:107], 0
    v_mfma_f32_4x4x4_16b_bf16 v[76:79], v[8:9], v[104:105], 0
    v_cmp_lt_u32 s[84:85], v5, v94
    s_nop 2
    v_pk_mul_f32 v[80:81], v[80:81], v[14:15] op_sel:[0,1] op_sel_hi:[1,1]
    v_pk_mul_f32 v[82:83], v[82:83], v[14:15] op_sel:[0,1] op_sel_hi:[1,1]
    v_pk_mul_f32 v[76:77], v[76:77], v[14:15] op_sel:[0,0] op_sel_hi:[1,0]
    v_pk_mul_f32 v[78:79], v[78:79], v[14:15] op_sel:[0,0] op_sel_hi:[1,0]
    s_waitcnt vmcnt(8)
    s_mov_b64 exec, s[6:7]
    v_lshrrev_b32 v30, 16, v30
    s_mov_b64 exec, -1
    v_and_b32 v46, 0x20000000, v31
    v_lshrrev_b32 v47, 14, v29
    v_bitop3_b32 v47, v47, v5, v46 bitop3:0xea
    ds_read_b64 v[102:103], v47
    v_and_b32 v99, 0x10000000, v31
    v_lshrrev_b32 v47, 14, v28
    v_bitop3_b32 v47, v47, v5, v99 bitop3:0xea
    ds_read_b64 v[100:101], v47
    s_waitcnt lgkmcnt(2)
    v_cmp_ne_u64 s[50:51], v[72:73], v[68:69]
    v_cmpx_ne_u64 s[54:55], v[74:75], v[70:71]
    s_and_b64 s[82:83], s[54:55], s[80:81]
    s_cbranch_scc1 L2_c57
L2_d57:
    v_mov_b64 v[84:85], v[70:71]
    v_mov_b32 v7, v93
    v_mov_b64 v[86:87], v[74:75]
    s_or_b64 s[80:81], s[80:81], s[54:55]
    s_mov_b64 exec, s[50:51]
    s_and_b64 s[82:83], s[50:51], s[80:81]
    s_cbranch_scc1 L2_c58
L2_d58:
    v_mov_b64 v[84:85], v[68:69]
    v_mov_b32 v7, v92
    v_mov_b64 v[86:87], v[72:73]
    s_mov_b64 exec, -1
    s_or_b64 s[80:81], s[80:81], s[50:51]
    s_and_b64 exec, s[84:85], s[80:81]
    v_mfma_f32_4x4x4_16b_bf16 v[76:79], v[12:13], v[84:85], 0
    v_mov_b32 v94, v7
    s_andn2_b64 s[80:81], s[80:81], s[84:85]
    v_mfma_f32_4x4x4_16b_bf16 v[76:79], v[10:11], v[86:87], v[76:79]
    s_mov_b64 exec, -1
    ds_read_b64 v[70:71], v95 offset:65408
    ds_read_b64 v[68:69], v94 offset:65408
    v_bitop3_b32 v92, v28, v5, v99 bitop3:0xea
    v_bitop3_b32 v93, v29, v5, v46 bitop3:0xea
    v_perm_b32 v15, v29, v30, s45
    v_bitop3_b32 v46, v29, 0.5, -0.5 bitop3:0xa8
    v_perm_b32 v14, v28, v30, s44
    v_bitop3_b32 v47, v28, 0.5, -0.5 bitop3:0xa8
    v_bitop3_b32 v15, v6, v15, v46 bitop3:0xca
    v_bitop3_b32 v14, v6, v14, v47 bitop3:0xca
    s_waitcnt lgkmcnt(1)
    v_mfma_f32_4x4x4_16b_bf16 v[80:83], v[10:11], v[70:71], v[80:83]
    s_waitcnt lgkmcnt(0)
    v_mfma_f32_4x4x4_16b_bf16 v[76:79], v[10:11], v[68:69], v[76:79]
    s_nop 2
    v_cvt_pk_bf16_f32 v80, v80, v81
    v_cvt_pk_bf16_f32 v81, v82, v83
    ds_wrxchg_rtn_b64 v[74:75], v95, v[80:81] offset:65408
    v_cvt_pk_bf16_f32 v76, v76, v77
    v_cvt_pk_bf16_f32 v77, v78, v79
    ds_wrxchg_rtn_b64 v[72:73], v94, v[76:77] offset:65408
    s_setprio 0
    v_mfma_f32_4x4x4_16b_bf16 v[80:83], v[8:9], v[102:103], 0
    v_mfma_f32_4x4x4_16b_bf16 v[76:79], v[8:9], v[100:101], 0
    v_cmp_lt_u32 s[48:49], v5, v93
    s_nop 2
    v_pk_mul_f32 v[80:81], v[80:81], v[14:15] op_sel:[0,1] op_sel_hi:[1,1]
    v_pk_mul_f32 v[82:83], v[82:83], v[14:15] op_sel:[0,1] op_sel_hi:[1,1]
    v_pk_mul_f32 v[76:77], v[76:77], v[14:15] op_sel:[0,0] op_sel_hi:[1,0]
    v_pk_mul_f32 v[78:79], v[78:79], v[14:15] op_sel:[0,0] op_sel_hi:[1,0]
    s_add_u32 s40, s40, 0xfff24000
    v_and_b32 v47, 0x0fffffff, v42
    v_mov_b32 v31, v42
    buffer_load_dword v30, v47, s[8:11], 0 offen offset:16
    s_mov_b64 exec, s[6:7]
    v_add_u32 v47, 8, v47
    v_lshrrev_b32 v31, 2, v31
    s_mov_b64 exec, -1
    buffer_load_dwordx2 v[28:29], v47, s[8:11], 0 offen
    s_waitcnt vmcnt(8)
    v_and_b32 v46, 0x80000000, v39
    v_lshrrev_b32 v47, 14, v37
    v_bitop3_b32 v47, v47, v5, v46 bitop3:0xea
    ds_read_b64 v[102:103], v47
    v_and_b32 v99, 0x40000000, v39
    v_lshrrev_b32 v47, 14, v36
    v_bitop3_b32 v47, v47, v5, v99 bitop3:0xea
    ds_read_b64 v[100:101], v47
    v_and_b32 v46, 0x20000000, v39
    v_lshrrev_b32 v47, 14, v35
    v_bitop3_b32 v47, v47, v5, v46 bitop3:0xea
    ds_read_b64 v[106:107], v47
    v_and_b32 v99, 0x10000000, v39
    v_lshrrev_b32 v47, 14, v34
    v_bitop3_b32 v47, v47, v5, v99 bitop3:0xea
    ds_read_b64 v[104:105], v47
    s_waitcnt lgkmcnt(4)
    v_cmp_ne_u64 s[50:51], v[72:73], v[68:69]
    v_cmpx_ne_u64 s[54:55], v[74:75], v[70:71]
    s_and_b64 s[82:83], s[54:55], s[80:81]
    s_cbranch_scc1 L2_c59
L2_d59:
    v_mov_b64 v[84:85], v[70:71]
    v_mov_b32 v7, v95
    v_mov_b64 v[86:87], v[74:75]
    s_or_b64 s[80:81], s[80:81], s[54:55]
    s_mov_b64 exec, s[50:51]
    s_and_b64 s[82:83], s[50:51], s[80:81]
    s_cbranch_scc1 L2_c60
L2_d60:
    v_mov_b64 v[84:85], v[68:69]
    v_mov_b32 v7, v94
    v_mov_b64 v[86:87], v[72:73]
    s_mov_b64 exec, -1
    s_or_b64 s[80:81], s[80:81], s[50:51]
    s_and_b64 exec, s[48:49], s[80:81]
    v_mfma_f32_4x4x4_16b_bf16 v[80:83], v[12:13], v[84:85], 0
    v_mov_b32 v93, v7
    s_andn2_b64 s[80:81], s[80:81], s[48:49]
    v_mfma_f32_4x4x4_16b_bf16 v[80:83], v[10:11], v[86:87], v[80:83]
    s_mov_b64 exec, -1
    ds_read_b64 v[70:71], v93 offset:65408
    ds_read_b64 v[68:69], v92 offset:65408
    v_bitop3_b32 v94, v34, v5, v99 bitop3:0xea
    v_bitop3_b32 v95, v35, v5, v46 bitop3:0xea
    v_perm_b32 v15, v35, v38, s45
    v_bitop3_b32 v46, v35, 0.5, -0.5 bitop3:0xa8
    v_perm_b32 v14, v34, v38, s44
    v_bitop3_b32 v47, v34, 0.5, -0.5 bitop3:0xa8
    v_bitop3_b32 v15, v6, v15, v46 bitop3:0xca
    v_bitop3_b32 v14, v6, v14, v47 bitop3:0xca
    s_waitcnt lgkmcnt(1)
    v_mfma_f32_4x4x4_16b_bf16 v[80:83], v[10:11], v[70:71], v[80:83]
    s_waitcnt lgkmcnt(0)
    v_mfma_f32_4x4x4_16b_bf16 v[76:79], v[10:11], v[68:69], v[76:79]
    s_nop 2
    v_cvt_pk_bf16_f32 v80, v80, v81
    v_cvt_pk_bf16_f32 v81, v82, v83
    ds_wrxchg_rtn_b64 v[74:75], v93, v[80:81] offset:65408
    v_cvt_pk_bf16_f32 v76, v76, v77
    v_cvt_pk_bf16_f32 v77, v78, v79
    ds_wrxchg_rtn_b64 v[72:73], v92, v[76:77] offset:65408
    s_barrier
    s_setprio 3
    s_mov_b32 m0, s100
    s_nop 0
    ds_write_addtid_b32 v124 offset:34816
    ds_write_addtid_b32 v125 offset:35072
    ds_write_addtid_b32 v126 offset:35328
    ds_write_addtid_b32 v127 offset:35584
    s_add_u32 s3, s40, 4096
    buffer_load_dwordx4 v[124:127], v3, s[16:19], s3 offen sc1
    ds_write_addtid_b32 v116 offset:32768
    ds_write_addtid_b32 v117 offset:33024
    ds_write_addtid_b32 v118 offset:33280
    ds_write_addtid_b32 v119 offset:33536
    buffer_load_dwordx4 v[116:119], v3, s[16:19], s40 offen offset:2048 sc1
    ds_write_addtid_b32 v120 offset:33792
    ds_write_addtid_b32 v121 offset:34048
    ds_write_addtid_b32 v122 offset:34304
    ds_write_addtid_b32 v123 offset:34560
    buffer_load_dwordx4 v[120:123], v3, s[16:19], s40 offen offset:3072 sc1
    v_mfma_f32_4x4x4_16b_bf16 v[80:83], v[8:9], v[106:107], 0
    v_mfma_f32_4x4x4_16b_bf16 v[76:79], v[8:9], v[104:105], 0
    s_nop 3
    v_pk_mul_f32 v[80:81], v[80:81], v[14:15] op_sel:[0,1] op_sel_hi:[1,1]
    v_pk_mul_f32 v[82:83], v[82:83], v[14:15] op_sel:[0,1] op_sel_hi:[1,1]
    v_pk_mul_f32 v[76:77], v[76:77], v[14:15] op_sel:[0,0] op_sel_hi:[1,0]
    v_pk_mul_f32 v[78:79], v[78:79], v[14:15] op_sel:[0,0] op_sel_hi:[1,0]
    v_mov_b32 v44, v43
    s_cmp_gt_u32 s37, 1024
    s_cbranch_scc1 L2_xs61
    s_cmp_lg_u32 s101, 0
    s_cbranch_scc1 L2_xa61
L2_xb61:
    v_lshlrev_b32 v89, 16, v96
    v_add_u32 v90, 60, v97
    v_bitop3_b32 v90, v89, v45, v90 bitop3:0x6a
    ds_write_b32 v98, v90 offset:12
    v_lshlrev_b32 v89, 20, v96
    v_add_u32 v90, 40, v97
    v_bitop3_b32 v90, v89, v45, v90 bitop3:0x6a
    ds_write_b32 v98, v90 offset:8
    v_lshlrev_b32 v89, 24, v96
    v_add_u32 v90, 20, v97
    v_bitop3_b32 v90, v89, v45, v90 bitop3:0x6a
    ds_write_b32 v98, v90 offset:4
    v_lshlrev_b32 v89, 28, v96
    v_bitop3_b32 v90, v89, v45, v97 bitop3:0x6a
    ds_write_b32 v98, v90 offset:0
    v_mov_b32_dpp v91, v64 quad_perm:[0,0,0,0] row_mask:0xf bank_mask:0xf
    v_and_b32 v89, 3, v91
    v_and_b32 v97, 0xfffc, v91
    v_sub_u16_dpp v88, v64, v91 quad_perm:[2,2,2,2] row_mask:0xf bank_mask:0xf
    v_mad_u32_u24 v97, v97, 5, v4
    v_add_u32 v99, v88, v89
    v_bfm_b32 v96, v88, v89
    v_cmp_lt_u32 s[58:59], 16, v99
    v_lshlrev_b32 v89, v1, v96
    v_and_b32 v89, v45, v89
    v_cmp_ne_u32 vcc, 0, v89
    v_xor_b32 v90, v97, v89
    s_add_u32 s3, s37, s38
    v_mbcnt_lo_u32_b32 v98, vcc_lo, 0
    v_mbcnt_hi_u32_b32 v98, vcc_hi, v98
    s_bcnt1_i32_b64 s41, vcc
    v_lshl_add_u32 v98, v98, 2, s3
    s_lshl2_add_u32 s37, s41, s37
    s_mov_b64 exec, vcc
    ds_write_b32 v98, v90
    s_mov_b64 exec, -1
    s_cmp_lg_u64 s[58:59], 0
    s_cbranch_scc1 L2_xe61
L2_xr61:
    v_add_u32 v98, s37, v0
    v_mov_b32 v90, -1
    ds_write_b32 v98, v90
    v_add_u32 v98, s38, v0
    ds_read2st64_b32 v[40:41], v0 offset0:0 offset1:1
    ds_read_b32 v43, v0 offset:512
    v_lshrrev_b32 v98, 1, v98
    v_and_b32 v98, -4, v98
    ds_read_b32 v42, v98 offset:768
    s_sub_u32 s3, s37, 768
    s_cmp_gt_u32 s3, 128
    s_cbranch_scc1 L2_xf61
L2_xg61:
    s_setprio 2
    s_waitcnt lgkmcnt(14)
    v_cmp_ne_u64 s[50:51], v[72:73], v[68:69]
    v_cmpx_ne_u64 s[54:55], v[74:75], v[70:71]
    s_and_b64 s[82:83], s[54:55], s[80:81]
    s_cbranch_scc1 L2_c62
L2_d62:
    v_mov_b64 v[84:85], v[70:71]
    v_mov_b32 v7, v93
    v_mov_b64 v[86:87], v[74:75]
    s_or_b64 s[80:81], s[80:81], s[54:55]
    s_mov_b64 exec, s[50:51]
    s_and_b64 s[82:83], s[50:51], s[80:81]
    s_cbranch_scc1 L2_c63
L2_d63:
    v_mov_b64 v[84:85], v[68:69]
    v_mov_b32 v7, v92
    v_mov_b64 v[86:87], v[72:73]
    s_mov_b64 exec, -1
    s_or_b64 s[80:81], s[80:81], s[50:51]
    ds_read_b64 v[70:71], v95 offset:65408
    ds_read_b64 v[68:69], v94 offset:65408
    v_and_b32 v46, 0x40000000, v39
    v_bitop3_b32 v92, v36, v5, v46 bitop3:0xea
    v_and_b32 v46, 0x80000000, v39
    v_bitop3_b32 v93, v37, v5, v46 bitop3:0xea
    v_perm_b32 v15, v37, v38, s47
    v_bitop3_b32 v46, v37, 0.5, -0.5 bitop3:0xa8
    v_perm_b32 v14, v36, v38, s46
    v_bitop3_b32 v47, v36, 0.5, -0.5 bitop3:0xa8
    v_bitop3_b32 v15, v6, v15, v46 bitop3:0xca
    v_bitop3_b32 v14, v6, v14, v47 bitop3:0xca
    s_setprio 1
    s_waitcnt lgkmcnt(1)
    v_mfma_f32_4x4x4_16b_bf16 v[80:83], v[10:11], v[70:71], v[80:83]
    s_waitcnt lgkmcnt(0)
    v_mfma_f32_4x4x4_16b_bf16 v[76:79], v[10:11], v[68:69], v[76:79]
    s_nop 2
    v_cvt_pk_bf16_f32 v80, v80, v81
    v_cvt_pk_bf16_f32 v81, v82, v83
    ds_wrxchg_rtn_b64 v[74:75], v95, v[80:81] offset:65408
    v_cvt_pk_bf16_f32 v76, v76, v77
    v_cvt_pk_bf16_f32 v77, v78, v79
    ds_wrxchg_rtn_b64 v[72:73], v94, v[76:77] offset:65408
    v_and_b32 v88, 0x0fffffff, v44
    v_mov_b32 v39, v44
    buffer_load_dwordx2 v[34:35], v88, s[8:11], 0 offen
    buffer_load_dwordx3 v[36:38], v88, s[8:11], 0 offen offset:8
    s_setprio 0
    s_waitcnt vmcnt(12)
    s_mov_b32 m0, s38
    s_nop 0
    ds_write_addtid_b32 v108 offset:0
    ds_write_addtid_b32 v109 offset:256
    ds_write_addtid_b32 v110 offset:512
    ds_write_addtid_b32 v111 offset:768
    s_waitcnt vmcnt(9)
    ds_write_addtid_b32 v112 offset:1024
    ds_write_addtid_b32 v113 offset:1280
    ds_write_addtid_b32 v114 offset:1536
    ds_write_addtid_b32 v115 offset:1792
    v_mfma_f32_4x4x4_16b_bf16 v[80:83], v[8:9], v[102:103], 0
    v_mfma_f32_4x4x4_16b_bf16 v[76:79], v[8:9], v[100:101], 0
    v_cmp_lt_u32 s[84:85], v5, v92
    s_nop 2
    v_pk_mul_f32 v[80:81], v[80:81], v[14:15] op_sel:[0,1] op_sel_hi:[1,1]
    v_pk_mul_f32 v[82:83], v[82:83], v[14:15] op_sel:[0,1] op_sel_hi:[1,1]
    v_pk_mul_f32 v[76:77], v[76:77], v[14:15] op_sel:[0,0] op_sel_hi:[1,0]
    v_pk_mul_f32 v[78:79], v[78:79], v[14:15] op_sel:[0,0] op_sel_hi:[1,0]
    s_add_u32 s42, s42, 1
    s_waitcnt lgkmcnt(0)
    s_barrier
    s_bitcmp1_b32 s36, s42
    s_cbranch_scc1 L2_slow
L2_ret3:
    s_setprio 3
    s_bitcmp1_b32 s43, s42
    s_cbranch_scc1 L2_oa64
L2_ob64:
    v_and_b32 v46, 0x20000000, v21
    v_lshrrev_b32 v47, 14, v17
    v_bitop3_b32 v47, v47, v5, v46 bitop3:0xea
    ds_read_b64 v[106:107], v47
    v_and_b32 v99, 0x10000000, v21
    v_lshrrev_b32 v47, 14, v16
    v_bitop3_b32 v47, v47, v5, v99 bitop3:0xea
    ds_read_b64 v[104:105], v47
    v_cmp_ne_u64 s[50:51], v[72:73], v[68:69]
    v_cmpx_ne_u64 s[54:55], v[74:75], v[70:71]
    s_and_b64 s[82:83], s[54:55], s[80:81]
    s_cbranch_scc1 L2_c65
L2_d65:
    v_mov_b64 v[84:85], v[70:71]
    v_mov_b32 v7, v95
    v_mov_b64 v[86:87], v[74:75]
    s_or_b64 s[80:81], s[80:81], s[54:55]
    s_mov_b64 exec, s[50:51]
    s_and_b64 s[82:83], s[50:51], s[80:81]
    s_cbranch_scc1 L2_c66
L2_d66:
    v_mov_b64 v[84:85], v[68:69]
    v_mov_b32 v7, v94
    v_mov_b64 v[86:87], v[72:73]
    s_mov_b64 exec, -1
    s_or_b64 s[80:81], s[80:81], s[50:51]
    s_and_b64 exec, s[84:85], s[80:81]
    v_mfma_f32_4x4x4_16b_bf16 v[76:79], v[12:13], v[84:85], 0
    v_mov_b32 v92, v7
    s_andn2_b64 s[80:81], s[80:81], s[84:85]
    v_mfma_f32_4x4x4_16b_bf16 v[76:79], v[10:11], v[86:87], v[76:79]
    s_mov_b64 exec, -1
    ds_read_b64 v[70:71], v93 offset:65408
    ds_read_b64 v[68:69], v92 offset:65408
    v_bitop3_b32 v94, v16, v5, v99 bitop3:0xea
    v_bitop3_b32 v95, v17, v5, v46 bitop3:0xea
    v_perm_b32 v15, v17, v20, s45
    v_bitop3_b32 v46, v17, 0.5, -0.5 bitop3:0xa8
    v_perm_b32 v14, v16, v20, s44
    v_bitop3_b32 v47, v16, 0.5, -0.5 bitop3:0xa8
    v_bitop3_b32 v15, v6, v15, v46 bitop3:0xca
    v_bitop3_b32 v14, v6, v14, v47 bitop3:0xca
    s_waitcnt lgkmcnt(1)
    v_mfma_f32_4x4x4_16b_bf16 v[80:83], v[10:11], v[70:71], v[80:83]
    s_waitcnt lgkmcnt(0)
    v_mfma_f32_4x4x4_16b_bf16 v[76:79], v[10:11], v[68:69], v[76:79]
    s_nop 2
    v_cvt_pk_bf16_f32 v80, v80, v81
    v_cvt_pk_bf16_f32 v81, v82, v83
    ds_wrxchg_rtn_b64 v[74:75], v93, v[80:81] offset:65408
    v_cvt_pk_bf16_f32 v76, v76, v77
    v_cvt_pk_bf16_f32 v77, v78, v79
    ds_wrxchg_rtn_b64 v[72:73], v92, v[76:77] offset:65408
    v_mfma_f32_4x4x4_16b_bf16 v[80:83], v[8:9], v[106:107], 0
    v_mfma_f32_4x4x4_16b_bf16 v[76:79], v[8:9], v[104:105], 0
    v_cmp_lt_u32 s[84:85], v5, v94
    s_nop 2
    v_pk_mul_f32 v[80:81], v[80:81], v[14:15] op_sel:[0,1] op_sel_hi:[1,1]
    v_pk_mul_f32 v[82:83], v[82:83], v[14:15] op_sel:[0,1] op_sel_hi:[1,1]
    v_pk_mul_f32 v[76:77], v[76:77], v[14:15] op_sel:[0,0] op_sel_hi:[1,0]
    v_pk_mul_f32 v[78:79], v[78:79], v[14:15] op_sel:[0,0] op_sel_hi:[1,0]
    buffer_load_dwordx4 v[108:111], v3, s[16:19], s40 offen offset:0 sc1
    v_and_b32 v46, 0x80000000, v21
    v_lshrrev_b32 v47, 14, v19
    v_bitop3_b32 v47, v47, v5, v46 bitop3:0xea
    ds_read_b64 v[102:103], v47
    v_and_b32 v99, 0x40000000, v21
    v_lshrrev_b32 v47, 14, v18
    v_bitop3_b32 v47, v47, v5, v99 bitop3:0xea
    ds_read_b64 v[100:101], v47
    s_waitcnt lgkmcnt(2)
    v_cmp_ne_u64 s[50:51], v[72:73], v[68:69]
    v_cmpx_ne_u64 s[54:55], v[74:75], v[70:71]
    s_and_b64 s[82:83], s[54:55], s[80:81]
    s_cbranch_scc1 L2_c67
L2_d67:
    v_mov_b64 v[84:85], v[70:71]
    v_mov_b32 v7, v93
    v_mov_b64 v[86:87], v[74:75]
    s_or_b64 s[80:81], s[80:81], s[54:55]
    s_mov_b64 exec, s[50:51]
    s_and_b64 s[82:83], s[50:51], s[80:81]
    s_cbranch_scc1 L2_c68
L2_d68:
    v_mov_b64 v[84:85], v[68:69]
    v_mov_b32 v7, v92
    v_mov_b64 v[86:87], v[72:73]
    s_mov_b64 exec, -1
    s_or_b64 s[80:81], s[80:81], s[50:51]
    s_and_b64 exec, s[84:85], s[80:81]
    v_mfma_f32_4x4x4_16b_bf16 v[76:79], v[12:13], v[84:85], 0
    v_mov_b32 v94, v7
    s_andn2_b64 s[80:81], s[80:81], s[84:85]
    v_mfma_f32_4x4x4_16b_bf16 v[76:79], v[10:11], v[86:87], v[76:79]
    s_mov_b64 exec, -1
    ds_read_b64 v[70:71], v95 offset:65408
    ds_read_b64 v[68:69], v94 offset:65408
    v_bitop3_b32 v92, v18, v5, v99 bitop3:0xea
    v_bitop3_b32 v93, v19, v5, v46 bitop3:0xea
    v_perm_b32 v15, v19, v20, s47
    v_bitop3_b32 v46, v19, 0.5, -0.5 bitop3:0xa8
    v_perm_b32 v14, v18, v20, s46
    v_bitop3_b32 v47, v18, 0.5, -0.5 bitop3:0xa8
    v_bitop3_b32 v15, v6, v15, v46 bitop3:0xca
    v_bitop3_b32 v14, v6, v14, v47 bitop3:0xca
    s_waitcnt lgkmcnt(1)
    v_mfma_f32_4x4x4_16b_bf16 v[80:83], v[10:11], v[70:71], v[80:83]
    s_waitcnt lgkmcnt(0)
    v_mfma_f32_4x4x4_16b_bf16 v[76:79], v[10:11], v[68:69], v[76:79]
    s_nop 2
    v_cvt_pk_bf16_f32 v80, v80, v81
    v_cvt_pk_bf16_f32 v81, v82, v83
    ds_wrxchg_rtn_b64 v[74:75], v95, v[80:81] offset:65408
    v_cvt_pk_bf16_f32 v76, v76, v77
    v_cvt_pk_bf16_f32 v77, v78, v79
    ds_wrxchg_rtn_b64 v[72:73], v94, v[76:77] offset:65408
    v_and_b32 v88, 0x0fffffff, v40
    v_mov_b32 v21, v40
    buffer_load_dwordx2 v[16:17], v88, s[8:11], 0 offen
    buffer_load_dwordx3 v[18:20], v88, s[8:11], 0 offen offset:8
    s_setprio 2
    v_mfma_f32_4x4x4_16b_bf16 v[80:83], v[8:9], v[102:103], 0
    v_mfma_f32_4x4x4_16b_bf16 v[76:79], v[8:9], v[100:101], 0
    v_cmp_lt_u32 s[48:49], v5, v93
    s_nop 2
    v_pk_mul_f32 v[80:81], v[80:81], v[14:15] op_sel:[0,1] op_sel_hi:[1,1]
    v_pk_mul_f32 v[82:83], v[82:83], v[14:15] op_sel:[0,1] op_sel_hi:[1,1]
    v_pk_mul_f32 v[76:77], v[76:77], v[14:15] op_sel:[0,0] op_sel_hi:[1,0]
    v_pk_mul_f32 v[78:79], v[78:79], v[14:15] op_sel:[0,0] op_sel_hi:[1,0]
    s_waitcnt vmcnt(10)
    v_and_b32 v46, 0x20000000, v27
    v_lshrrev_b32 v47, 14, v23
    v_bitop3_b32 v47, v47, v5, v46 bitop3:0xea
    ds_read_b64 v[106:107], v47
    v_and_b32 v99, 0x10000000, v27
    v_lshrrev_b32 v47, 14, v22
    v_bitop3_b32 v47, v47, v5, v99 bitop3:0xea
    ds_read_b64 v[104:105], v47
    s_waitcnt lgkmcnt(2)
    v_cmp_ne_u64 s[50:51], v[72:73], v[68:69]
    v_cmpx_ne_u64 s[54:55], v[74:75], v[70:71]
    s_and_b64 s[82:83], s[54:55], s[80:81]
    s_cbranch_scc1 L2_c69
L2_d69:
    v_mov_b64 v[84:85], v[70:71]
    v_mov_b32 v7, v95
    v_mov_b64 v[86:87], v[74:75]
    s_or_b64 s[80:81], s[80:81], s[54:55]
    s_mov_b64 exec, s[50:51]
    s_and_b64 s[82:83], s[50:51], s[80:81]
    s_cbranch_scc1 L2_c70
L2_d70:
    v_mov_b64 v[84:85], v[68:69]
    v_mov_b32 v7, v94
    v_mov_b64 v[86:87], v[72:73]
    s_mov_b64 exec, -1
    s_or_b64 s[80:81], s[80:81], s[50:51]
    s_and_b64 exec, s[48:49], s[80:81]
    v_mfma_f32_4x4x4_16b_bf16 v[80:83], v[12:13], v[84:85], 0
    v_mov_b32 v93, v7
    s_andn2_b64 s[80:81], s[80:81], s[48:49]
    v_mfma_f32_4x4x4_16b_bf16 v[80:83], v[10:11], v[86:87], v[80:83]
    s_mov_b64 exec, -1
    ds_read_b64 v[70:71], v93 offset:65408
    ds_read_b64 v[68:69], v92 offset:65408
    v_bitop3_b32 v94, v22, v5, v99 bitop3:0xea
    v_bitop3_b32 v95, v23, v5, v46 bitop3:0xea
    v_perm_b32 v15, v23, v26, s45
    v_bitop3_b32 v46, v23, 0.5, -0.5 bitop3:0xa8
    v_perm_b32 v14, v22, v26, s44
    v_bitop3_b32 v47, v22, 0.5, -0.5 bitop3:0xa8
    v_bitop3_b32 v15, v6, v15, v46 bitop3:0xca
    v_bitop3_b32 v14, v6, v14, v47 bitop3:0xca
    s_waitcnt lgkmcnt(1)
    v_mfma_f32_4x4x4_16b_bf16 v[80:83], v[10:11], v[70:71], v[80:83]
    s_waitcnt lgkmcnt(0)
    v_mfma_f32_4x4x4_16b_bf16 v[76:79], v[10:11], v[68:69], v[76:79]
    s_nop 2
    v_cvt_pk_bf16_f32 v80, v80, v81
    v_cvt_pk_bf16_f32 v81, v82, v83
    ds_wrxchg_rtn_b64 v[74:75], v93, v[80:81] offset:65408
    v_cvt_pk_bf16_f32 v76, v76, v77
    v_cvt_pk_bf16_f32 v77, v78, v79
    ds_wrxchg_rtn_b64 v[72:73], v92, v[76:77] offset:65408
    s_setprio 1
    v_mfma_f32_4x4x4_16b_bf16 v[80:83], v[8:9], v[106:107], 0
    v_mfma_f32_4x4x4_16b_bf16 v[76:79], v[8:9], v[104:105], 0
    s_nop 3
    v_pk_mul_f32 v[80:81], v[80:81], v[14:15] op_sel:[0,1] op_sel_hi:[1,1]
    v_pk_mul_f32 v[82:83], v[82:83], v[14:15] op_sel:[0,1] op_sel_hi:[1,1]
    v_pk_mul_f32 v[76:77], v[76:77], v[14:15] op_sel:[0,0] op_sel_hi:[1,0]
    v_pk_mul_f32 v[78:79], v[78:79], v[14:15] op_sel:[0,0] op_sel_hi:[1,0]
    s_bitcmp1_b32 s43, s42
    s_cbranch_scc1 L2_oa71
L2_ob71:
    buffer_load_dwordx4 v[112:115], v3, s[16:19], s40 offen offset:1024 sc1
    v_sub_u16 v88, v58, v50
    v_and_b32 v89, 3, v50
    v_add3_u32 v99, v88, v89, 3
    v_and_b32 v99, -4, v99
    v_max_u32 v99, 4, v99
    v_and_b32 v97, 0xfffc, v50
    v_bfm_b32 v96, v88, v89
    v_add_u32_dpp v91, v99, v99 row_shr:1 row_mask:0xf bank_mask:0xf bound_ctrl:1
    v_mad_u32_u24 v97, v97, 5, v2
    v_cmp_lt_u32 vcc, 16, v99
    v_add_u32_dpp v91, v91, v91 row_shr:2 row_mask:0xf bank_mask:0xf bound_ctrl:1
    v_sub_u32 v98, s38, v99
    v_lshrrev_b64 v[50:51], 16, v[50:51]
    v_add_u32_dpp v91, v91, v91 row_shr:4 row_mask:0xf bank_mask:0xf bound_ctrl:1
    v_lshrrev_b64 v[58:59], 16, v[58:59]
    s_mov_b32 s101, 0
    v_add_u32_dpp v91, v91, v91 row_shr:8 row_mask:0xf bank_mask:0xf bound_ctrl:1
    s_nop 1
    v_add_u32_dpp v91, v91, v91 row_bcast:15 row_mask:0xa bank_mask:0xf
    s_nop 1
    v_add_u32_dpp v91, v91, v91 row_bcast:31 row_mask:0xc bank_mask:0xf
    v_add_u32 v98, v98, v91
    v_readlane_b32 s37, v91, 63
    s_cbranch_vccnz L2_xo72
L2_xp72:
    v_and_b32 v46, 0x80000000, v27
    v_lshrrev_b32 v47, 14, v25
    v_bitop3_b32 v47, v47, v5, v46 bitop3:0xea
    ds_read_b64 v[102:103], v47
    v_and_b32 v99, 0x40000000, v27
    v_lshrrev_b32 v47, 14, v24
    v_bitop3_b32 v47, v47, v5, v99 bitop3:0xea
    ds_read_b64 v[100:101], v47
    s_waitcnt lgkmcnt(2)
    v_cmp_ne_u64 s[50:51], v[72:73], v[68:69]
    v_cmpx_ne_u64 s[54:55], v[74:75], v[70:71]
    s_and_b64 s[82:83], s[54:55], s[80:81]
    s_cbranch_scc1 L2_c73
L2_d73:
    v_mov_b64 v[84:85], v[70:71]
    v_mov_b32 v7, v93
    v_mov_b64 v[86:87], v[74:75]
    s_or_b64 s[80:81], s[80:81], s[54:55]
    s_mov_b64 exec, s[50:51]
    s_and_b64 s[82:83], s[50:51], s[80:81]
    s_cbranch_scc1 L2_c74
L2_d74:
    v_mov_b64 v[84:85], v[68:69]
    v_mov_b32 v7, v92
    v_mov_b64 v[86:87], v[72:73]
    s_mov_b64 exec, -1
    s_or_b64 s[80:81], s[80:81], s[50:51]
    ds_read_b64 v[70:71], v95 offset:65408
    ds_read_b64 v[68:69], v94 offset:65408
    v_bitop3_b32 v92, v24, v5, v99 bitop3:0xea
    v_bitop3_b32 v93, v25, v5, v46 bitop3:0xea
    v_perm_b32 v15, v25, v26, s47
    v_bitop3_b32 v46, v25, 0.5, -0.5 bitop3:0xa8
    v_perm_b32 v14, v24, v26, s46
    v_bitop3_b32 v47, v24, 0.5, -0.5 bitop3:0xa8
    v_bitop3_b32 v15, v6, v15, v46 bitop3:0xca
    v_bitop3_b32 v14, v6, v14, v47 bitop3:0xca
    s_waitcnt lgkmcnt(1)
    v_mfma_f32_4x4x4_16b_bf16 v[80:83], v[10:11], v[70:71], v[80:83]
    s_waitcnt lgkmcnt(0)
    v_mfma_f32_4x4x4_16b_bf16 v[76:79], v[10:11], v[68:69], v[76:79]
    s_nop 2
    v_cvt_pk_bf16_f32 v80, v80, v81
    v_cvt_pk_bf16_f32 v81, v82, v83
    ds_wrxchg_rtn_b64 v[74:75], v95, v[80:81] offset:65408
    v_cvt_pk_bf16_f32 v76, v76, v77
    v_cvt_pk_bf16_f32 v77, v78, v79
    ds_wrxchg_rtn_b64 v[72:73], v94, v[76:77] offset:65408
    v_and_b32 v88, 0x0fffffff, v41
    v_mov_b32 v27, v41
    buffer_load_dwordx2 v[22:23], v88, s[8:11], 0 offen
    buffer_load_dwordx3 v[24:26], v88, s[8:11], 0 offen offset:8
    v_mfma_f32_4x4x4_16b_bf16 v[80:83], v[8:9], v[102:103], 0
    v_mfma_f32_4x4x4_16b_bf16 v[76:79], v[8:9], v[100:101], 0
    v_cmp_lt_u32 s[84:85], v5, v92
    s_nop 2
    v_pk_mul_f32 v[80:81], v[80:81], v[14:15] op_sel:[0,1] op_sel_hi:[1,1]
    v_pk_mul_f32 v[82:83], v[82:83], v[14:15] op_sel:[0,1] op_sel_hi:[1,1]
    v_pk_mul_f32 v[76:77], v[76:77], v[14:15] op_sel:[0,0] op_sel_hi:[1,0]
    v_pk_mul_f32 v[78:79], v[78:79], v[14:15] op_sel:[0,0] op_sel_hi:[1,0]
    s_waitcnt vmcnt(11)
    s_mov_b64 exec, s[6:7]
    v_lshrrev_b32 v30, 16, v30
    s_mov_b64 exec, -1
    v_and_b32 v46, 0x20000000, v31
    v_lshrrev_b32 v47, 14, v29
    v_bitop3_b32 v47, v47, v5, v46 bitop3:0xea
    ds_read_b64 v[106:107], v47
    v_and_b32 v99, 0x10000000, v31
    v_lshrrev_b32 v47, 14, v28
    v_bitop3_b32 v47, v47, v5, v99 bitop3:0xea
    ds_read_b64 v[104:105], v47
    s_waitcnt lgkmcnt(2)
    v_cmp_ne_u64 s[50:51], v[72:73], v[68:69]
    v_cmpx_ne_u64 s[54:55], v[74:75], v[70:71]
    s_and_b64 s[82:83], s[54:55], s[80:81]
    s_cbranch_scc1 L2_c75
L2_d75:
    v_mov_b64 v[84:85], v[70:71]
    v_mov_b32 v7, v95
    v_mov_b64 v[86:87], v[74:75]
    s_or_b64 s[80:81], s[80:81], s[54:55]
    s_mov_b64 exec, s[50:51]
    s_and_b64 s[82:83], s[50:51], s[80:81]
    s_cbranch_scc1 L2_c76
L2_d76:
    v_mov_b64 v[84:85], v[68:69]
    v_mov_b32 v7, v94
    v_mov_b64 v[86:87], v[72:73]
    s_mov_b64 exec, -1
    s_or_b64 s[80:81], s[80:81], s[50:51]
    s_and_b64 exec, s[84:85], s[80:81]
    v_mfma_f32_4x4x4_16b_bf16 v[76:79], v[12:13], v[84:85], 0
    v_mov_b32 v92, v7
    s_andn2_b64 s[80:81], s[80:81], s[84:85]
    v_mfma_f32_4x4x4_16b_bf16 v[76:79], v[10:11], v[86:87], v[76:79]
    s_mov_b64 exec, -1
    ds_read_b64 v[70:71], v93 offset:65408
    ds_read_b64 v[68:69], v92 offset:65408
    v_bitop3_b32 v94, v28, v5, v99 bitop3:0xea
    v_bitop3_b32 v95, v29, v5, v46 bitop3:0xea
    v_perm_b32 v15, v29, v30, s45
    v_bitop3_b32 v46, v29, 0.5, -0.5 bitop3:0xa8
    v_perm_b32 v14, v28, v30, s44
    v_bitop3_b32 v47, v28, 0.5, -0.5 bitop3:0xa8
    v_bitop3_b32 v15, v6, v15, v46 bitop3:0xca
    v_bitop3_b32 v14, v6, v14, v47 bitop3:0xca
    s_waitcnt lgkmcnt(1)
    v_mfma_f32_4x4x4_16b_bf16 v[80:83], v[10:11], v[70:71], v[80:83]
    s_waitcnt lgkmcnt(0)
    v_mfma_f32_4x4x4_16b_bf16 v[76:79], v[10:11], v[68:69], v[76:79]
    s_nop 2
    v_cvt_pk_bf16_f32 v80, v80, v81
    v_cvt_pk_bf16_f32 v81, v82, v83
    ds_wrxchg_rtn_b64 v[74:75], v93, v[80:81] offset:65408
    v_cvt_pk_bf16_f32 v76, v76, v77
    v_cvt_pk_bf16_f32 v77, v78, v79
    ds_wrxchg_rtn_b64 v[72:73], v92, v[76:77] offset:65408
    s_setprio 0
    v_mfma_f32_4x4x4_16b_bf16 v[80:83], v[8:9], v[106:107], 0
    v_mfma_f32_4x4x4_16b_bf16 v[76:79], v[8:9], v[104:105], 0
    v_cmp_lt_u32 s[48:49], v5, v95
    s_nop 2
    v_pk_mul_f32 v[80:81], v[80:81], v[14:15] op_sel:[0,1] op_sel_hi:[1,1]
    v_pk_mul_f32 v[82:83], v[82:83], v[14:15] op_sel:[0,1] op_sel_hi:[1,1]
    v_pk_mul_f32 v[76:77], v[76:77], v[14:15] op_sel:[0,0] op_sel_hi:[1,0]
    v_pk_mul_f32 v[78:79], v[78:79], v[14:15] op_sel:[0,0] op_sel_hi:[1,0]
    s_add_u32 s40, s40, 0x50000
    v_and_b32 v47, 0x0fffffff, v42
    v_mov_b32 v31, v42
    buffer_load_dword v30, v47, s[8:11], 0 offen offset:16
    s_mov_b64 exec, s[6:7]
    v_add_u32 v47, 8, v47
    v_lshrrev_b32 v31, 2, v31
    s_mov_b64 exec, -1
    buffer_load_dwordx2 v[28:29], v47, s[8:11], 0 offen
    s_waitcnt vmcnt(8)
    v_and_b32 v46, 0x80000000, v39
    v_lshrrev_b32 v47, 14, v37
    v_bitop3_b32 v47, v47, v5, v46 bitop3:0xea
    ds_read_b64 v[106:107], v47
    v_and_b32 v99, 0x40000000, v39
    v_lshrrev_b32 v47, 14, v36
    v_bitop3_b32 v47, v47, v5, v99 bitop3:0xea
    ds_read_b64 v[104:105], v47
    v_and_b32 v46, 0x20000000, v39
    v_lshrrev_b32 v47, 14, v35
    v_bitop3_b32 v47, v47, v5, v46 bitop3:0xea
    ds_read_b64 v[102:103], v47
    v_and_b32 v99, 0x10000000, v39
    v_lshrrev_b32 v47, 14, v34
    v_bitop3_b32 v47, v47, v5, v99 bitop3:0xea
    ds_read_b64 v[100:101], v47
    s_waitcnt lgkmcnt(4)
    v_cmp_ne_u64 s[50:51], v[72:73], v[68:69]
    v_cmpx_ne_u64 s[54:55], v[74:75], v[70:71]
    s_and_b64 s[82:83], s[54:55], s[80:81]
    s_cbranch_scc1 L2_c77
L2_d77:
    v_mov_b64 v[84:85], v[70:71]
    v_mov_b32 v7, v93
    v_mov_b64 v[86:87], v[74:75]
    s_or_b64 s[80:81], s[80:81], s[54:55]
    s_mov_b64 exec, s[50:51]
    s_and_b64 s[82:83], s[50:51], s[80:81]
    s_cbranch_scc1 L2_c78
L2_d78:
    v_mov_b64 v[84:85], v[68:69]
    v_mov_b32 v7, v92
    v_mov_b64 v[86:87], v[72:73]
    s_mov_b64 exec, -1
    s_or_b64 s[80:81], s[80:81], s[50:51]
    s_and_b64 exec, s[48:49], s[80:81]
    v_mfma_f32_4x4x4_16b_bf16 v[80:83], v[12:13], v[84:85], 0
    v_mov_b32 v95, v7
    s_andn2_b64 s[80:81], s[80:81], s[48:49]
    v_mfma_f32_4x4x4_16b_bf16 v[80:83], v[10:11], v[86:87], v[80:83]
    s_mov_b64 exec, -1
    ds_read_b64 v[70:71], v95 offset:65408
    ds_read_b64 v[68:69], v94 offset:65408
    v_bitop3_b32 v92, v34, v5, v99 bitop3:0xea
    v_bitop3_b32 v93, v35, v5, v46 bitop3:0xea
    v_perm_b32 v15, v35, v38, s45
    v_bitop3_b32 v46, v35, 0.5, -0.5 bitop3:0xa8
    v_perm_b32 v14, v34, v38, s44
    v_bitop3_b32 v47, v34, 0.5, -0.5 bitop3:0xa8
    v_bitop3_b32 v15, v6, v15, v46 bitop3:0xca
    v_bitop3_b32 v14, v6, v14, v47 bitop3:0xca
    s_waitcnt lgkmcnt(1)
    v_mfma_f32_4x4x4_16b_bf16 v[80:83], v[10:11], v[70:71], v[80:83]
    s_waitcnt lgkmcnt(0)
    v_mfma_f32_4x4x4_16b_bf16 v[76:79], v[10:11], v[68:69], v[76:79]
    s_nop 2
    v_cvt_pk_bf16_f32 v80, v80, v81
    v_cvt_pk_bf16_f32 v81, v82, v83
    ds_wrxchg_rtn_b64 v[74:75], v95, v[80:81] offset:65408
    v_cvt_pk_bf16_f32 v76, v76, v77
    v_cvt_pk_bf16_f32 v77, v78, v79
    ds_wrxchg_rtn_b64 v[72:73], v94, v[76:77] offset:65408
    s_barrier
    s_setprio 3
    s_mov_b32 m0, s100
    s_nop 0
    ds_write_addtid_b32 v124 offset:34816
    ds_write_addtid_b32 v125 offset:35072
    ds_write_addtid_b32 v126 offset:35328
    ds_write_addtid_b32 v127 offset:35584
    s_add_u32 s3, s40, 4096
    buffer_load_dwordx4 v[124:127], v3, s[16:19], s3 offen sc1
    ds_write_addtid_b32 v116 offset:32768
    ds_write_addtid_b32 v117 offset:33024
    ds_write_addtid_b32 v118 offset:33280
    ds_write_addtid_b32 v119 offset:33536
    buffer_load_dwordx4 v[116:119], v3, s[16:19], s40 offen offset:2048 sc1
    ds_write_addtid_b32 v120 offset:33792
    ds_write_addtid_b32 v121 offset:34048
    ds_write_addtid_b32 v122 offset:34304
    ds_write_addtid_b32 v123 offset:34560
    buffer_load_dwordx4 v[120:123], v3, s[16:19], s40 offen offset:3072 sc1
    v_mfma_f32_4x4x4_16b_bf16 v[80:83], v[8:9], v[102:103], 0
    v_mfma_f32_4x4x4_16b_bf16 v[76:79], v[8:9], v[100:101], 0
    s_nop 3
    v_pk_mul_f32 v[80:81], v[80:81], v[14:15] op_sel:[0,1] op_sel_hi:[1,1]
    v_pk_mul_f32 v[82:83], v[82:83], v[14:15] op_sel:[0,1] op_sel_hi:[1,1]
    v_pk_mul_f32 v[76:77], v[76:77], v[14:15] op_sel:[0,0] op_sel_hi:[1,0]
    v_pk_mul_f32 v[78:79], v[78:79], v[14:15] op_sel:[0,0] op_sel_hi:[1,0]
    v_mov_b32 v44, v43
    s_cmp_gt_u32 s37, 1024
    s_cbranch_scc1 L2_xs79
    s_cmp_lg_u32 s101, 0
    s_cbranch_scc1 L2_xa79
L2_xb79:
    v_lshlrev_b32 v89, 16, v96
    v_add_u32 v90, 60, v97
    v_bitop3_b32 v90, v89, v45, v90 bitop3:0x6a
    ds_write_b32 v98, v90 offset:12
    v_lshlrev_b32 v89, 20, v96
    v_add_u32 v90, 40, v97
    v_bitop3_b32 v90, v89, v45, v90 bitop3:0x6a
    ds_write_b32 v98, v90 offset:8
    v_lshlrev_b32 v89, 24, v96
    v_add_u32 v90, 20, v97
    v_bitop3_b32 v90, v89, v45, v90 bitop3:0x6a
    ds_write_b32 v98, v90 offset:4
    v_lshlrev_b32 v89, 28, v96
    v_bitop3_b32 v90, v89, v45, v97 bitop3:0x6a
    ds_write_b32 v98, v90 offset:0
    v_mov_b32_dpp v91, v66 quad_perm:[0,0,0,0] row_mask:0xf bank_mask:0xf
    v_and_b32 v89, 3, v91
    v_and_b32 v97, 0xfffc, v91
    v_sub_u16_dpp v88, v66, v91 quad_perm:[2,2,2,2] row_mask:0xf bank_mask:0xf
    v_mad_u32_u24 v97, v97, 5, v4
    v_add_u32 v99, v88, v89
    v_bfm_b32 v96, v88, v89
    v_cmp_lt_u32 s[58:59], 16, v99
    v_lshlrev_b32 v89, v1, v96
    v_and_b32 v89, v45, v89
    v_cmp_ne_u32 vcc, 0, v89
    v_xor_b32 v90, v97, v89
    s_add_u32 s3, s37, s38
    v_mbcnt_lo_u32_b32 v98, vcc_lo, 0
    v_mbcnt_hi_u32_b32 v98, vcc_hi, v98
    s_bcnt1_i32_b64 s41, vcc
    v_lshl_add_u32 v98, v98, 2, s3
    s_lshl2_add_u32 s37, s41, s37
    s_mov_b64 exec, vcc
    ds_write_b32 v98, v90
    s_mov_b64 exec, -1
    s_cmp_lg_u64 s[58:59], 0
    s_cbranch_scc1 L2_xe79
L2_xr79:
    v_add_u32 v98, s37, v0
    v_mov_b32 v90, -1
    ds_write_b32 v98, v90
    v_add_u32 v98, s38, v0
    ds_read2st64_b32 v[40:41], v0 offset0:0 offset1:1
    ds_read_b32 v43, v0 offset:512
    v_lshrrev_b32 v98, 1, v98
    v_and_b32 v98, -4, v98
    ds_read_b32 v42, v98 offset:768
    s_sub_u32 s3, s37, 768
    s_cmp_gt_u32 s3, 128
    s_cbranch_scc1 L2_xf79
L2_xg79:
    s_setprio 2
    s_waitcnt lgkmcnt(14)
    v_cmp_ne_u64 s[50:51], v[72:73], v[68:69]
    v_cmpx_ne_u64 s[54:55], v[74:75], v[70:71]
    s_and_b64 s[82:83], s[54:55], s[80:81]
    s_cbranch_scc1 L2_c80
L2_d80:
    v_mov_b64 v[84:85], v[70:71]
    v_mov_b32 v7, v95
    v_mov_b64 v[86:87], v[74:75]
    s_or_b64 s[80:81], s[80:81], s[54:55]
    s_mov_b64 exec, s[50:51]
    s_and_b64 s[82:83], s[50:51], s[80:81]
    s_cbranch_scc1 L2_c81
L2_d81:
    v_mov_b64 v[84:85], v[68:69]
    v_mov_b32 v7, v94
    v_mov_b64 v[86:87], v[72:73]
    s_mov_b64 exec, -1
    s_or_b64 s[80:81], s[80:81], s[50:51]
    ds_read_b64 v[70:71], v93 offset:65408
    ds_read_b64 v[68:69], v92 offset:65408
    v_and_b32 v46, 0x40000000, v39
    v_bitop3_b32 v94, v36, v5, v46 bitop3:0xea
    v_and_b32 v46, 0x80000000, v39
    v_bitop3_b32 v95, v37, v5, v46 bitop3:0xea
    v_perm_b32 v15, v37, v38, s47
    v_bitop3_b32 v46, v37, 0.5, -0.5 bitop3:0xa8
    v_perm_b32 v14, v36, v38, s46
    v_bitop3_b32 v47, v36, 0.5, -0.5 bitop3:0xa8
    v_bitop3_b32 v15, v6, v15, v46 bitop3:0xca
    v_bitop3_b32 v14, v6, v14, v47 bitop3:0xca
    s_setprio 1
    s_waitcnt lgkmcnt(1)
    v_mfma_f32_4x4x4_16b_bf16 v[80:83], v[10:11], v[70:71], v[80:83]
    s_waitcnt lgkmcnt(0)
    v_mfma_f32_4x4x4_16b_bf16 v[76:79], v[10:11], v[68:69], v[76:79]
    s_nop 2
    v_cvt_pk_bf16_f32 v80, v80, v81
    v_cvt_pk_bf16_f32 v81, v82, v83
    ds_wrxchg_rtn_b64 v[74:75], v93, v[80:81] offset:65408
    v_cvt_pk_bf16_f32 v76, v76, v77
    v_cvt_pk_bf16_f32 v77, v78, v79
    ds_wrxchg_rtn_b64 v[72:73], v92, v[76:77] offset:65408
    v_and_b32 v88, 0x0fffffff, v44
    v_mov_b32 v39, v44
    buffer_load_dwordx2 v[34:35], v88, s[8:11], 0 offen
    buffer_load_dwordx3 v[36:38], v88, s[8:11], 0 offen offset:8
    s_setprio 0
    s_waitcnt vmcnt(12)
    s_mov_b32 m0, s38
    s_nop 0
    ds_write_addtid_b32 v108 offset:0
    ds_write_addtid_b32 v109 offset:256
    ds_write_addtid_b32 v110 offset:512
    ds_write_addtid_b32 v111 offset:768
    s_waitcnt vmcnt(9)
    ds_write_addtid_b32 v112 offset:1024
    ds_write_addtid_b32 v113 offset:1280
    ds_write_addtid_b32 v114 offset:1536
    ds_write_addtid_b32 v115 offset:1792
    v_mfma_f32_4x4x4_16b_bf16 v[80:83], v[8:9], v[106:107], 0
    v_mfma_f32_4x4x4_16b_bf16 v[76:79], v[8:9], v[104:105], 0
    v_cmp_lt_u32 s[84:85], v5, v94
    s_nop 2
    v_pk_mul_f32 v[80:81], v[80:81], v[14:15] op_sel:[0,1] op_sel_hi:[1,1]
    v_pk_mul_f32 v[82:83], v[82:83], v[14:15] op_sel:[0,1] op_sel_hi:[1,1]
    v_pk_mul_f32 v[76:77], v[76:77], v[14:15] op_sel:[0,0] op_sel_hi:[1,0]
    v_pk_mul_f32 v[78:79], v[78:79], v[14:15] op_sel:[0,0] op_sel_hi:[1,0]
    s_add_u32 s42, s42, 1
    s_waitcnt lgkmcnt(0)
    s_barrier
    s_bitcmp1_b32 s36, s42
    s_cbranch_scc1 L2_slow
L2_ret4:
    s_setprio 3
    s_bitcmp1_b32 s43, s42
    s_cbranch_scc1 L2_oa82
L2_ob82:
    v_and_b32 v46, 0x20000000, v21
    v_lshrrev_b32 v47, 14, v17
    v_bitop3_b32 v47, v47, v5, v46 bitop3:0xea
    ds_read_b64 v[102:103], v47
    v_and_b32 v99, 0x10000000, v21
    v_lshrrev_b32 v47, 14, v16
    v_bitop3_b32 v47, v47, v5, v99 bitop3:0xea
    ds_read_b64 v[100:101], v47
    v_cmp_ne_u64 s[50:51], v[72:73], v[68:69]
    v_cmpx_ne_u64 s[54:55], v[74:75], v[70:71]
    s_and_b64 s[82:83], s[54:55], s[80:81]
    s_cbranch_scc1 L2_c83
L2_d83:
    v_mov_b64 v[84:85], v[70:71]
    v_mov_b32 v7, v93
    v_mov_b64 v[86:87], v[74:75]
    s_or_b64 s[80:81], s[80:81], s[54:55]
    s_mov_b64 exec, s[50:51]
    s_and_b64 s[82:83], s[50:51], s[80:81]
    s_cbranch_scc1 L2_c84
L2_d84:
    v_mov_b64 v[84:85], v[68:69]
    v_mov_b32 v7, v92
    v_mov_b64 v[86:87], v[72:73]
    s_mov_b64 exec, -1
    s_or_b64 s[80:81], s[80:81], s[50:51]
    s_and_b64 exec, s[84:85], s[80:81]
    v_mfma_f32_4x4x4_16b_bf16 v[76:79], v[12:13], v[84:85], 0
    v_mov_b32 v94, v7
    s_andn2_b64 s[80:81], s[80:81], s[84:85]
    v_mfma_f32_4x4x4_16b_bf16 v[76:79], v[10:11], v[86:87], v[76:79]
    s_mov_b64 exec, -1
    ds_read_b64 v[70:71], v95 offset:65408
    ds_read_b64 v[68:69], v94 offset:65408
    v_bitop3_b32 v92, v16, v5, v99 bitop3:0xea
    v_bitop3_b32 v93, v17, v5, v46 bitop3:0xea
    v_perm_b32 v15, v17, v20, s45
    v_bitop3_b32 v46, v17, 0.5, -0.5 bitop3:0xa8
    v_perm_b32 v14, v16, v20, s44
    v_bitop3_b32 v47, v16, 0.5, -0.5 bitop3:0xa8
    v_bitop3_b32 v15, v6, v15, v46 bitop3:0xca
    v_bitop3_b32 v14, v6, v14, v47 bitop3:0xca
    s_waitcnt lgkmcnt(1)
    v_mfma_f32_4x4x4_16b_bf16 v[80:83], v[10:11], v[70:71], v[80:83]
    s_waitcnt lgkmcnt(0)
    v_mfma_f32_4x4x4_16b_bf16 v[76:79], v[10:11], v[68:69], v[76:79]
    s_nop 2
    v_cvt_pk_bf16_f32 v80, v80, v81
    v_cvt_pk_bf16_f32 v81, v82, v83
    ds_wrxchg_rtn_b64 v[74:75], v95, v[80:81] offset:65408
    v_cvt_pk_bf16_f32 v76, v76, v77
    v_cvt_pk_bf16_f32 v77, v78, v79
    ds_wrxchg_rtn_b64 v[72:73], v94, v[76:77] offset:65408
    v_mfma_f32_4x4x4_16b_bf16 v[80:83], v[8:9], v[102:103], 0
    v_mfma_f32_4x4x4_16b_bf16 v[76:79], v[8:9], v[100:101], 0
    v_cmp_lt_u32 s[84:85], v5, v92
    s_nop 2
    v_pk_mul_f32 v[80:81], v[80:81], v[14:15] op_sel:[0,1] op_sel_hi:[1,1]
    v_pk_mul_f32 v[82:83], v[82:83], v[14:15] op_sel:[0,1] op_sel_hi:[1,1]
    v_pk_mul_f32 v[76:77], v[76:77], v[14:15] op_sel:[0,0] op_sel_hi:[1,0]
    v_pk_mul_f32 v[78:79], v[78:79], v[14:15] op_sel:[0,0] op_sel_hi:[1,0]
    buffer_load_dwordx4 v[108:111], v3, s[16:19], s40 offen offset:0 sc1
    v_and_b32 v46, 0x80000000, v21
    v_lshrrev_b32 v47, 14, v19
    v_bitop3_b32 v47, v47, v5, v46 bitop3:0xea
    ds_read_b64 v[106:107], v47
    v_and_b32 v99, 0x40000000, v21
    v_lshrrev_b32 v47, 14, v18
    v_bitop3_b32 v47, v47, v5, v99 bitop3:0xea
    ds_read_b64 v[104:105], v47
    s_waitcnt lgkmcnt(2)
    v_cmp_ne_u64 s[50:51], v[72:73], v[68:69]
    v_cmpx_ne_u64 s[54:55], v[74:75], v[70:71]
    s_and_b64 s[82:83], s[54:55], s[80:81]
    s_cbranch_scc1 L2_c85
L2_d85:
    v_mov_b64 v[84:85], v[70:71]
    v_mov_b32 v7, v95
    v_mov_b64 v[86:87], v[74:75]
    s_or_b64 s[80:81], s[80:81], s[54:55]
    s_mov_b64 exec, s[50:51]
    s_and_b64 s[82:83], s[50:51], s[80:81]
    s_cbranch_scc1 L2_c86
L2_d86:
    v_mov_b64 v[84:85], v[68:69]
    v_mov_b32 v7, v94
    v_mov_b64 v[86:87], v[72:73]
    s_mov_b64 exec, -1
    s_or_b64 s[80:81], s[80:81], s[50:51]
    s_and_b64 exec, s[84:85], s[80:81]
    v_mfma_f32_4x4x4_16b_bf16 v[76:79], v[12:13], v[84:85], 0
    v_mov_b32 v92, v7
    s_andn2_b64 s[80:81], s[80:81], s[84:85]
    v_mfma_f32_4x4x4_16b_bf16 v[76:79], v[10:11], v[86:87], v[76:79]
    s_mov_b64 exec, -1
    ds_read_b64 v[70:71], v93 offset:65408
    ds_read_b64 v[68:69], v92 offset:65408
    v_bitop3_b32 v94, v18, v5, v99 bitop3:0xea
    v_bitop3_b32 v95, v19, v5, v46 bitop3:0xea
    v_perm_b32 v15, v19, v20, s47
    v_bitop3_b32 v46, v19, 0.5, -0.5 bitop3:0xa8
    v_perm_b32 v14, v18, v20, s46
    v_bitop3_b32 v47, v18, 0.5, -0.5 bitop3:0xa8
    v_bitop3_b32 v15, v6, v15, v46 bitop3:0xca
    v_bitop3_b32 v14, v6, v14, v47 bitop3:0xca
    s_waitcnt lgkmcnt(1)
    v_mfma_f32_4x4x4_16b_bf16 v[80:83], v[10:11], v[70:71], v[80:83]
    s_waitcnt lgkmcnt(0)
    v_mfma_f32_4x4x4_16b_bf16 v[76:79], v[10:11], v[68:69], v[76:79]
    s_nop 2
    v_cvt_pk_bf16_f32 v80, v80, v81
    v_cvt_pk_bf16_f32 v81, v82, v83
    ds_wrxchg_rtn_b64 v[74:75], v93, v[80:81] offset:65408
    v_cvt_pk_bf16_f32 v76, v76, v77
    v_cvt_pk_bf16_f32 v77, v78, v79
    ds_wrxchg_rtn_b64 v[72:73], v92, v[76:77] offset:65408
    v_and_b32 v88, 0x0fffffff, v40
    v_mov_b32 v21, v40
    buffer_load_dwordx2 v[16:17], v88, s[8:11], 0 offen
    buffer_load_dwordx3 v[18:20], v88, s[8:11], 0 offen offset:8
    s_setprio 2
    v_mfma_f32_4x4x4_16b_bf16 v[80:83], v[8:9], v[106:107], 0
    v_mfma_f32_4x4x4_16b_bf16 v[76:79], v[8:9], v[104:105], 0
    v_cmp_lt_u32 s[48:49], v5, v95
    s_nop 2
    v_pk_mul_f32 v[80:81], v[80:81], v[14:15] op_sel:[0,1] op_sel_hi:[1,1]
    v_pk_mul_f32 v[82:83], v[82:83], v[14:15] op_sel:[0,1] op_sel_hi:[1,1]
    v_pk_mul_f32 v[76:77], v[76:77], v[14:15] op_sel:[0,0] op_sel_hi:[1,0]
    v_pk_mul_f32 v[78:79], v[78:79], v[14:15] op_sel:[0,0] op_sel_hi:[1,0]
    s_waitcnt vmcnt(10)
    v_and_b32 v46, 0x20000000, v27
    v_lshrrev_b32 v47, 14, v23
    v_bitop3_b32 v47, v47, v5, v46 bitop3:0xea
    ds_read_b64 v[102:103], v47
    v_and_b32 v99, 0x10000000, v27
    v_lshrrev_b32 v47, 14, v22
    v_bitop3_b32 v47, v47, v5, v99 bitop3:0xea
    ds_read_b64 v[100:101], v47
    s_waitcnt lgkmcnt(2)
    v_cmp_ne_u64 s[50:51], v[72:73], v[68:69]
    v_cmpx_ne_u64 s[54:55], v[74:75], v[70:71]
    s_and_b64 s[82:83], s[54:55], s[80:81]
    s_cbranch_scc1 L2_c87
L2_d87:
    v_mov_b64 v[84:85], v[70:71]
    v_mov_b32 v7, v93
    v_mov_b64 v[86:87], v[74:75]
    s_or_b64 s[80:81], s[80:81], s[54:55]
    s_mov_b64 exec, s[50:51]
    s_and_b64 s[82:83], s[50:51], s[80:81]
    s_cbranch_scc1 L2_c88
L2_d88:
    v_mov_b64 v[84:85], v[68:69]
    v_mov_b32 v7, v92
    v_mov_b64 v[86:87], v[72:73]
    s_mov_b64 exec, -1
    s_or_b64 s[80:81], s[80:81], s[50:51]
    s_and_b64 exec, s[48:49], s[80:81]
    v_mfma_f32_4x4x4_16b_bf16 v[80:83], v[12:13], v[84:85], 0
    v_mov_b32 v95, v7
    s_andn2_b64 s[80:81], s[80:81], s[48:49]
    v_mfma_f32_4x4x4_16b_bf16 v[80:83], v[10:11], v[86:87], v[80:83]
    s_mov_b64 exec, -1
    ds_read_b64 v[70:71], v95 offset:65408
    ds_read_b64 v[68:69], v94 offset:65408
    v_bitop3_b32 v92, v22, v5, v99 bitop3:0xea
    v_bitop3_b32 v93, v23, v5, v46 bitop3:0xea
    v_perm_b32 v15, v23, v26, s45
    v_bitop3_b32 v46, v23, 0.5, -0.5 bitop3:0xa8
    v_perm_b32 v14, v22, v26, s44
    v_bitop3_b32 v47, v22, 0.5, -0.5 bitop3:0xa8
    v_bitop3_b32 v15, v6, v15, v46 bitop3:0xca
    v_bitop3_b32 v14, v6, v14, v47 bitop3:0xca
    s_waitcnt lgkmcnt(1)
    v_mfma_f32_4x4x4_16b_bf16 v[80:83], v[10:11], v[70:71], v[80:83]
    s_waitcnt lgkmcnt(0)
    v_mfma_f32_4x4x4_16b_bf16 v[76:79], v[10:11], v[68:69], v[76:79]
    s_nop 2
    v_cvt_pk_bf16_f32 v80, v80, v81
    v_cvt_pk_bf16_f32 v81, v82, v83
    ds_wrxchg_rtn_b64 v[74:75], v95, v[80:81] offset:65408
    v_cvt_pk_bf16_f32 v76, v76, v77
    v_cvt_pk_bf16_f32 v77, v78, v79
    ds_wrxchg_rtn_b64 v[72:73], v94, v[76:77] offset:65408
    s_setprio 1
    v_mfma_f32_4x4x4_16b_bf16 v[80:83], v[8:9], v[102:103], 0
    v_mfma_f32_4x4x4_16b_bf16 v[76:79], v[8:9], v[100:101], 0
    s_nop 3
    v_pk_mul_f32 v[80:81], v[80:81], v[14:15] op_sel:[0,1] op_sel_hi:[1,1]
    v_pk_mul_f32 v[82:83], v[82:83], v[14:15] op_sel:[0,1] op_sel_hi:[1,1]
    v_pk_mul_f32 v[76:77], v[76:77], v[14:15] op_sel:[0,0] op_sel_hi:[1,0]
    v_pk_mul_f32 v[78:79], v[78:79], v[14:15] op_sel:[0,0] op_sel_hi:[1,0]
    s_bitcmp1_b32 s43, s42
    s_cbranch_scc1 L2_oa89
L2_ob89:
    buffer_load_dwordx4 v[112:115], v3, s[16:19], s40 offen offset:1024 sc1
    v_sub_u16 v88, v60, v52
    v_and_b32 v89, 3, v52
    v_add3_u32 v99, v88, v89, 3
    v_and_b32 v99, -4, v99
    v_max_u32 v99, 4, v99
    v_and_b32 v97, 0xfffc, v52
    v_bfm_b32 v96, v88, v89
    v_add_u32_dpp v91, v99, v99 row_shr:1 row_mask:0xf bank_mask:0xf bound_ctrl:1
    v_mad_u32_u24 v97, v97, 5, v2
    v_cmp_lt_u32 vcc, 16, v99
    v_add_u32_dpp v91, v91, v91 row_shr:2 row_mask:0xf bank_mask:0xf bound_ctrl:1
    v_sub_u32 v98, s38, v99
    v_lshrrev_b64 v[52:53], 16, v[52:53]
    v_add_u32_dpp v91, v91, v91 row_shr:4 row_mask:0xf bank_mask:0xf bound_ctrl:1
    v_lshrrev_b64 v[60:61], 16, v[60:61]
    s_mov_b32 s101, 0
    v_add_u32_dpp v91, v91, v91 row_shr:8 row_mask:0xf bank_mask:0xf bound_ctrl:1
    s_nop 1
    v_add_u32_dpp v91, v91, v91 row_bcast:15 row_mask:0xa bank_mask:0xf
    s_nop 1
    v_add_u32_dpp v91, v91, v91 row_bcast:31 row_mask:0xc bank_mask:0xf
    v_add_u32 v98, v98, v91
    v_readlane_b32 s37, v91, 63
    s_cbranch_vccnz L2_xo90
L2_xp90:
    v_and_b32 v46, 0x80000000, v27
    v_lshrrev_b32 v47, 14, v25
    v_bitop3_b32 v47, v47, v5, v46 bitop3:0xea
    ds_read_b64 v[106:107], v47
    v_and_b32 v99, 0x40000000, v27
    v_lshrrev_b32 v47, 14, v24
    v_bitop3_b32 v47, v47, v5, v99 bitop3:0xea
    ds_read_b64 v[104:105], v47
    s_waitcnt lgkmcnt(2)
    v_cmp_ne_u64 s[50:51], v[72:73], v[68:69]
    v_cmpx_ne_u64 s[54:55], v[74:75], v[70:71]
    s_and_b64 s[82:83], s[54:55], s[80:81]
    s_cbranch_scc1 L2_c91
L2_d91:
    v_mov_b64 v[84:85], v[70:71]
    v_mov_b32 v7, v95
    v_mov_b64 v[86:87], v[74:75]
    s_or_b64 s[80:81], s[80:81], s[54:55]
    s_mov_b64 exec, s[50:51]
    s_and_b64 s[82:83], s[50:51], s[80:81]
    s_cbranch_scc1 L2_c92
L2_d92:
    v_mov_b64 v[84:85], v[68:69]
    v_mov_b32 v7, v94
    v_mov_b64 v[86:87], v[72:73]
    s_mov_b64 exec, -1
    s_or_b64 s[80:81], s[80:81], s[50:51]
    ds_read_b64 v[70:71], v93 offset:65408
    ds_read_b64 v[68:69], v92 offset:65408
    v_bitop3_b32 v94, v24, v5, v99 bitop3:0xea
    v_bitop3_b32 v95, v25, v5, v46 bitop3:0xea
    v_perm_b32 v15, v25, v26, s47
    v_bitop3_b32 v46, v25, 0.5, -0.5 bitop3:0xa8
    v_perm_b32 v14, v24, v26, s46
    v_bitop3_b32 v47, v24, 0.5, -0.5 bitop3:0xa8
    v_bitop3_b32 v15, v6, v15, v46 bitop3:0xca
    v_bitop3_b32 v14, v6, v14, v47 bitop3:0xca
    s_waitcnt lgkmcnt(1)
    v_mfma_f32_4x4x4_16b_bf16 v[80:83], v[10:11], v[70:71], v[80:83]
    s_waitcnt lgkmcnt(0)
    v_mfma_f32_4x4x4_16b_bf16 v[76:79], v[10:11], v[68:69], v[76:79]
    s_nop 2
    v_cvt_pk_bf16_f32 v80, v80, v81
    v_cvt_pk_bf16_f32 v81, v82, v83
    ds_wrxchg_rtn_b64 v[74:75], v93, v[80:81] offset:65408
    v_cvt_pk_bf16_f32 v76, v76, v77
    v_cvt_pk_bf16_f32 v77, v78, v79
    ds_wrxchg_rtn_b64 v[72:73], v92, v[76:77] offset:65408
    v_and_b32 v88, 0x0fffffff, v41
    v_mov_b32 v27, v41
    buffer_load_dwordx2 v[22:23], v88, s[8:11], 0 offen
    buffer_load_dwordx3 v[24:26], v88, s[8:11], 0 offen offset:8
    v_mfma_f32_4x4x4_16b_bf16 v[80:83], v[8:9], v[106:107], 0
    v_mfma_f32_4x4x4_16b_bf16 v[76:79], v[8:9], v[104:105], 0
    v_cmp_lt_u32 s[84:85], v5, v94
    s_nop 2
    v_pk_mul_f32 v[80:81], v[80:81], v[14:15] op_sel:[0,1] op_sel_hi:[1,1]
    v_pk_mul_f32 v[82:83], v[82:83], v[14:15] op_sel:[0,1] op_sel_hi:[1,1]
    v_pk_mul_f32 v[76:77], v[76:77], v[14:15] op_sel:[0,0] op_sel_hi:[1,0]
    v_pk_mul_f32 v[78:79], v[78:79], v[14:15] op_sel:[0,0] op_sel_hi:[1,0]
    s_waitcnt vmcnt(11)
    s_mov_b64 exec, s[6:7]
    v_lshrrev_b32 v30, 16, v30
    s_mov_b64 exec, -1
    v_and_b32 v46, 0x20000000, v31
    v_lshrrev_b32 v47, 14, v29
    v_bitop3_b32 v47, v47, v5, v46 bitop3:0xea
    ds_read_b64 v[102:103], v47
    v_and_b32 v99, 0x10000000, v31
    v_lshrrev_b32 v47, 14, v28
    v_bitop3_b32 v47, v47, v5, v99 bitop3:0xea
    ds_read_b64 v[100:101], v47
    s_waitcnt lgkmcnt(2)
    v_cmp_ne_u64 s[50:51], v[72:73], v[68:69]
    v_cmpx_ne_u64 s[54:55], v[74:75], v[70:71]
    s_and_b64 s[82:83], s[54:55], s[80:81]
    s_cbranch_scc1 L2_c93
L2_d93:
    v_mov_b64 v[84:85], v[70:71]
    v_mov_b32 v7, v93
    v_mov_b64 v[86:87], v[74:75]
    s_or_b64 s[80:81], s[80:81], s[54:55]
    s_mov_b64 exec, s[50:51]
    s_and_b64 s[82:83], s[50:51], s[80:81]
    s_cbranch_scc1 L2_c94
L2_d94:
    v_mov_b64 v[84:85], v[68:69]
    v_mov_b32 v7, v92
    v_mov_b64 v[86:87], v[72:73]
    s_mov_b64 exec, -1
    s_or_b64 s[80:81], s[80:81], s[50:51]
    s_and_b64 exec, s[84:85], s[80:81]
    v_mfma_f32_4x4x4_16b_bf16 v[76:79], v[12:13], v[84:85], 0
    v_mov_b32 v94, v7
    s_andn2_b64 s[80:81], s[80:81], s[84:85]
    v_mfma_f32_4x4x4_16b_bf16 v[76:79], v[10:11], v[86:87], v[76:79]
    s_mov_b64 exec, -1
    ds_read_b64 v[70:71], v95 offset:65408
    ds_read_b64 v[68:69], v94 offset:65408
    v_bitop3_b32 v92, v28, v5, v99 bitop3:0xea
    v_bitop3_b32 v93, v29, v5, v46 bitop3:0xea
    v_perm_b32 v15, v29, v30, s45
    v_bitop3_b32 v46, v29, 0.5, -0.5 bitop3:0xa8
    v_perm_b32 v14, v28, v30, s44
    v_bitop3_b32 v47, v28, 0.5, -0.5 bitop3:0xa8
    v_bitop3_b32 v15, v6, v15, v46 bitop3:0xca
    v_bitop3_b32 v14, v6, v14, v47 bitop3:0xca
    s_waitcnt lgkmcnt(1)
    v_mfma_f32_4x4x4_16b_bf16 v[80:83], v[10:11], v[70:71], v[80:83]
    s_waitcnt lgkmcnt(0)
    v_mfma_f32_4x4x4_16b_bf16 v[76:79], v[10:11], v[68:69], v[76:79]
    s_nop 2
    v_cvt_pk_bf16_f32 v80, v80, v81
    v_cvt_pk_bf16_f32 v81, v82, v83
    ds_wrxchg_rtn_b64 v[74:75], v95, v[80:81] offset:65408
    v_cvt_pk_bf16_f32 v76, v76, v77
    v_cvt_pk_bf16_f32 v77, v78, v79
    ds_wrxchg_rtn_b64 v[72:73], v94, v[76:77] offset:65408
    s_setprio 0
    v_mfma_f32_4x4x4_16b_bf16 v[80:83], v[8:9], v[102:103], 0
    v_mfma_f32_4x4x4_16b_bf16 v[76:79], v[8:9], v[100:101], 0
    v_cmp_lt_u32 s[48:49], v5, v93
    s_nop 2
    v_pk_mul_f32 v[80:81], v[80:81], v[14:15] op_sel:[0,1] op_sel_hi:[1,1]
    v_pk_mul_f32 v[82:83], v[82:83], v[14:15] op_sel:[0,1] op_sel_hi:[1,1]
    v_pk_mul_f32 v[76:77], v[76:77], v[14:15] op_sel:[0,0] op_sel_hi:[1,0]
    v_pk_mul_f32 v[78:79], v[78:79], v[14:15] op_sel:[0,0] op_sel_hi:[1,0]
    s_add_u32 s40, s40, 0x50000
    v_and_b32 v47, 0x0fffffff, v42
    v_mov_b32 v31, v42
    buffer_load_dword v30, v47, s[8:11], 0 offen offset:16
    s_mov_b64 exec, s[6:7]
    v_add_u32 v47, 8, v47
    v_lshrrev_b32 v31, 2, v31
    s_mov_b64 exec, -1
    buffer_load_dwordx2 v[28:29], v47, s[8:11], 0 offen
    s_waitcnt vmcnt(8)
    v_and_b32 v46, 0x80000000, v39
    v_lshrrev_b32 v47, 14, v37
    v_bitop3_b32 v47, v47, v5, v46 bitop3:0xea
    ds_read_b64 v[102:103], v47
    v_and_b32 v99, 0x40000000, v39
    v_lshrrev_b32 v47, 14, v36
    v_bitop3_b32 v47, v47, v5, v99 bitop3:0xea
    ds_read_b64 v[100:101], v47
    v_and_b32 v46, 0x20000000, v39
    v_lshrrev_b32 v47, 14, v35
    v_bitop3_b32 v47, v47, v5, v46 bitop3:0xea
    ds_read_b64 v[106:107], v47
    v_and_b32 v99, 0x10000000, v39
    v_lshrrev_b32 v47, 14, v34
    v_bitop3_b32 v47, v47, v5, v99 bitop3:0xea
    ds_read_b64 v[104:105], v47
    s_waitcnt lgkmcnt(4)
    v_cmp_ne_u64 s[50:51], v[72:73], v[68:69]
    v_cmpx_ne_u64 s[54:55], v[74:75], v[70:71]
    s_and_b64 s[82:83], s[54:55], s[80:81]
    s_cbranch_scc1 L2_c95
L2_d95:
    v_mov_b64 v[84:85], v[70:71]
    v_mov_b32 v7, v95
    v_mov_b64 v[86:87], v[74:75]
    s_or_b64 s[80:81], s[80:81], s[54:55]
    s_mov_b64 exec, s[50:51]
    s_and_b64 s[82:83], s[50:51], s[80:81]
    s_cbranch_scc1 L2_c96
L2_d96:
    v_mov_b64 v[84:85], v[68:69]
    v_mov_b32 v7, v94
    v_mov_b64 v[86:87], v[72:73]
    s_mov_b64 exec, -1
    s_or_b64 s[80:81], s[80:81], s[50:51]
    s_and_b64 exec, s[48:49], s[80:81]
    v_mfma_f32_4x4x4_16b_bf16 v[80:83], v[12:13], v[84:85], 0
    v_mov_b32 v93, v7
    s_andn2_b64 s[80:81], s[80:81], s[48:49]
    v_mfma_f32_4x4x4_16b_bf16 v[80:83], v[10:11], v[86:87], v[80:83]
    s_mov_b64 exec, -1
    ds_read_b64 v[70:71], v93 offset:65408
    ds_read_b64 v[68:69], v92 offset:65408
    v_bitop3_b32 v94, v34, v5, v99 bitop3:0xea
    v_bitop3_b32 v95, v35, v5, v46 bitop3:0xea
    v_perm_b32 v15, v35, v38, s45
    v_bitop3_b32 v46, v35, 0.5, -0.5 bitop3:0xa8
    v_perm_b32 v14, v34, v38, s44
    v_bitop3_b32 v47, v34, 0.5, -0.5 bitop3:0xa8
    v_bitop3_b32 v15, v6, v15, v46 bitop3:0xca
    v_bitop3_b32 v14, v6, v14, v47 bitop3:0xca
    s_waitcnt lgkmcnt(1)
    v_mfma_f32_4x4x4_16b_bf16 v[80:83], v[10:11], v[70:71], v[80:83]
    s_waitcnt lgkmcnt(0)
    v_mfma_f32_4x4x4_16b_bf16 v[76:79], v[10:11], v[68:69], v[76:79]
    s_nop 2
    v_cvt_pk_bf16_f32 v80, v80, v81
    v_cvt_pk_bf16_f32 v81, v82, v83
    ds_wrxchg_rtn_b64 v[74:75], v93, v[80:81] offset:65408
    v_cvt_pk_bf16_f32 v76, v76, v77
    v_cvt_pk_bf16_f32 v77, v78, v79
    ds_wrxchg_rtn_b64 v[72:73], v92, v[76:77] offset:65408
    s_barrier
    s_setprio 3
    s_mov_b32 m0, s100
    s_nop 0
    ds_write_addtid_b32 v124 offset:34816
    ds_write_addtid_b32 v125 offset:35072
    ds_write_addtid_b32 v126 offset:35328
    ds_write_addtid_b32 v127 offset:35584
    s_add_u32 s3, s40, 4096
    buffer_load_dwordx4 v[124:127], v3, s[16:19], s3 offen sc1
    ds_write_addtid_b32 v116 offset:32768
    ds_write_addtid_b32 v117 offset:33024
    ds_write_addtid_b32 v118 offset:33280
    ds_write_addtid_b32 v119 offset:33536
    buffer_load_dwordx4 v[116:119], v3, s[16:19], s40 offen offset:2048 sc1
    ds_write_addtid_b32 v120 offset:33792
    ds_write_addtid_b32 v121 offset:34048
    ds_write_addtid_b32 v122 offset:34304
    ds_write_addtid_b32 v123 offset:34560
    buffer_load_dwordx4 v[120:123], v3, s[16:19], s40 offen offset:3072 sc1
    v_mfma_f32_4x4x4_16b_bf16 v[80:83], v[8:9], v[106:107], 0
    v_mfma_f32_4x4x4_16b_bf16 v[76:79], v[8:9], v[104:105], 0
    s_nop 3
    v_pk_mul_f32 v[80:81], v[80:81], v[14:15] op_sel:[0,1] op_sel_hi:[1,1]
    v_pk_mul_f32 v[82:83], v[82:83], v[14:15] op_sel:[0,1] op_sel_hi:[1,1]
    v_pk_mul_f32 v[76:77], v[76:77], v[14:15] op_sel:[0,0] op_sel_hi:[1,0]
    v_pk_mul_f32 v[78:79], v[78:79], v[14:15] op_sel:[0,0] op_sel_hi:[1,0]
    v_mov_b32 v44, v43
    s_cmp_gt_u32 s37, 1024
    s_cbranch_scc1 L2_xs97
    s_cmp_lg_u32 s101, 0
    s_cbranch_scc1 L2_xa97
L2_xb97:
    v_lshlrev_b32 v89, 16, v96
    v_add_u32 v90, 60, v97
    v_bitop3_b32 v90, v89, v45, v90 bitop3:0x6a
    ds_write_b32 v98, v90 offset:12
    v_lshlrev_b32 v89, 20, v96
    v_add_u32 v90, 40, v97
    v_bitop3_b32 v90, v89, v45, v90 bitop3:0x6a
    ds_write_b32 v98, v90 offset:8
    v_lshlrev_b32 v89, 24, v96
    v_add_u32 v90, 20, v97
    v_bitop3_b32 v90, v89, v45, v90 bitop3:0x6a
    ds_write_b32 v98, v90 offset:4
    v_lshlrev_b32 v89, 28, v96
    v_bitop3_b32 v90, v89, v45, v97 bitop3:0x6a
    ds_write_b32 v98, v90 offset:0
    v_mov_b32_dpp v91, v64 quad_perm:[1,1,1,1] row_mask:0xf bank_mask:0xf
    v_and_b32 v89, 3, v91
    v_and_b32 v97, 0xfffc, v91
    v_sub_u16_dpp v88, v64, v91 quad_perm:[3,3,3,3] row_mask:0xf bank_mask:0xf
    v_mad_u32_u24 v97, v97, 5, v4
    v_add_u32 v99, v88, v89
    v_bfm_b32 v96, v88, v89
    v_cmp_lt_u32 s[58:59], 16, v99
    v_lshlrev_b32 v89, v1, v96
    v_and_b32 v89, v45, v89
    v_cmp_ne_u32 vcc, 0, v89
    v_xor_b32 v90, v97, v89
    s_add_u32 s3, s37, s38
    v_mbcnt_lo_u32_b32 v98, vcc_lo, 0
    v_mbcnt_hi_u32_b32 v98, vcc_hi, v98
    s_bcnt1_i32_b64 s41, vcc
    v_lshl_add_u32 v98, v98, 2, s3
    s_lshl2_add_u32 s37, s41, s37
    s_mov_b64 exec, vcc
    ds_write_b32 v98, v90
    s_mov_b64 exec, -1
    s_cmp_lg_u64 s[58:59], 0
    s_cbranch_scc1 L2_xe97
L2_xr97:
    v_add_u32 v98, s37, v0
    v_mov_b32 v90, -1
    ds_write_b32 v98, v90
    v_add_u32 v98, s38, v0
    ds_read2st64_b32 v[40:41], v0 offset0:0 offset1:1
    ds_read_b32 v43, v0 offset:512
    v_lshrrev_b32 v98, 1, v98
    v_and_b32 v98, -4, v98
    ds_read_b32 v42, v98 offset:768
    s_sub_u32 s3, s37, 768
    s_cmp_gt_u32 s3, 128
    s_cbranch_scc1 L2_xf97
L2_xg97:
    s_setprio 2
    s_waitcnt lgkmcnt(14)
    v_cmp_ne_u64 s[50:51], v[72:73], v[68:69]
    v_cmpx_ne_u64 s[54:55], v[74:75], v[70:71]
    s_and_b64 s[82:83], s[54:55], s[80:81]
    s_cbranch_scc1 L2_c98
L2_d98:
    v_mov_b64 v[84:85], v[70:71]
    v_mov_b32 v7, v93
    v_mov_b64 v[86:87], v[74:75]
    s_or_b64 s[80:81], s[80:81], s[54:55]
    s_mov_b64 exec, s[50:51]
    s_and_b64 s[82:83], s[50:51], s[80:81]
    s_cbranch_scc1 L2_c99
L2_d99:
    v_mov_b64 v[84:85], v[68:69]
    v_mov_b32 v7, v92
    v_mov_b64 v[86:87], v[72:73]
    s_mov_b64 exec, -1
    s_or_b64 s[80:81], s[80:81], s[50:51]
    ds_read_b64 v[70:71], v95 offset:65408
    ds_read_b64 v[68:69], v94 offset:65408
    v_and_b32 v46, 0x40000000, v39
    v_bitop3_b32 v92, v36, v5, v46 bitop3:0xea
    v_and_b32 v46, 0x80000000, v39
    v_bitop3_b32 v93, v37, v5, v46 bitop3:0xea
    v_perm_b32 v15, v37, v38, s47
    v_bitop3_b32 v46, v37, 0.5, -0.5 bitop3:0xa8
    v_perm_b32 v14, v36, v38, s46
    v_bitop3_b32 v47, v36, 0.5, -0.5 bitop3:0xa8
    v_bitop3_b32 v15, v6, v15, v46 bitop3:0xca
    v_bitop3_b32 v14, v6, v14, v47 bitop3:0xca
    s_setprio 1
    s_waitcnt lgkmcnt(1)
    v_mfma_f32_4x4x4_16b_bf16 v[80:83], v[10:11], v[70:71], v[80:83]
    s_waitcnt lgkmcnt(0)
    v_mfma_f32_4x4x4_16b_bf16 v[76:79], v[10:11], v[68:69], v[76:79]
    s_nop 2
    v_cvt_pk_bf16_f32 v80, v80, v81
    v_cvt_pk_bf16_f32 v81, v82, v83
    ds_wrxchg_rtn_b64 v[74:75], v95, v[80:81] offset:65408
    v_cvt_pk_bf16_f32 v76, v76, v77
    v_cvt_pk_bf16_f32 v77, v78, v79
    ds_wrxchg_rtn_b64 v[72:73], v94, v[76:77] offset:65408
    v_and_b32 v88, 0x0fffffff, v44
    v_mov_b32 v39, v44
    buffer_load_dwordx2 v[34:35], v88, s[8:11], 0 offen
    buffer_load_dwordx3 v[36:38], v88, s[8:11], 0 offen offset:8
    s_setprio 0
    s_waitcnt vmcnt(12)
    s_mov_b32 m0, s38
    s_nop 0
    ds_write_addtid_b32 v108 offset:0
    ds_write_addtid_b32 v109 offset:256
    ds_write_addtid_b32 v110 offset:512
    ds_write_addtid_b32 v111 offset:768
    s_waitcnt vmcnt(9)
    ds_write_addtid_b32 v112 offset:1024
    ds_write_addtid_b32 v113 offset:1280
    ds_write_addtid_b32 v114 offset:1536
    ds_write_addtid_b32 v115 offset:1792
    v_mfma_f32_4x4x4_16b_bf16 v[80:83], v[8:9], v[102:103], 0
    v_mfma_f32_4x4x4_16b_bf16 v[76:79], v[8:9], v[100:101], 0
    v_cmp_lt_u32 s[84:85], v5, v92
    s_nop 2
    v_pk_mul_f32 v[80:81], v[80:81], v[14:15] op_sel:[0,1] op_sel_hi:[1,1]
    v_pk_mul_f32 v[82:83], v[82:83], v[14:15] op_sel:[0,1] op_sel_hi:[1,1]
    v_pk_mul_f32 v[76:77], v[76:77], v[14:15] op_sel:[0,0] op_sel_hi:[1,0]
    v_pk_mul_f32 v[78:79], v[78:79], v[14:15] op_sel:[0,0] op_sel_hi:[1,0]
    s_add_u32 s42, s42, 1
    s_waitcnt lgkmcnt(0)
    s_barrier
    s_bitcmp1_b32 s36, s42
    s_cbranch_scc1 L2_slow
L2_ret5:
    s_setprio 3
    s_bitcmp1_b32 s43, s42
    s_cbranch_scc1 L2_oa100
L2_ob100:
    v_and_b32 v46, 0x20000000, v21
    v_lshrrev_b32 v47, 14, v17
    v_bitop3_b32 v47, v47, v5, v46 bitop3:0xea
    ds_read_b64 v[106:107], v47
    v_and_b32 v99, 0x10000000, v21
    v_lshrrev_b32 v47, 14, v16
    v_bitop3_b32 v47, v47, v5, v99 bitop3:0xea
    ds_read_b64 v[104:105], v47
    v_cmp_ne_u64 s[50:51], v[72:73], v[68:69]
    v_cmpx_ne_u64 s[54:55], v[74:75], v[70:71]
    s_and_b64 s[82:83], s[54:55], s[80:81]
    s_cbranch_scc1 L2_c101
L2_d101:
    v_mov_b64 v[84:85], v[70:71]
    v_mov_b32 v7, v95
    v_mov_b64 v[86:87], v[74:75]
    s_or_b64 s[80:81], s[80:81], s[54:55]
    s_mov_b64 exec, s[50:51]
    s_and_b64 s[82:83], s[50:51], s[80:81]
    s_cbranch_scc1 L2_c102
L2_d102:
    v_mov_b64 v[84:85], v[68:69]
    v_mov_b32 v7, v94
    v_mov_b64 v[86:87], v[72:73]
    s_mov_b64 exec, -1
    s_or_b64 s[80:81], s[80:81], s[50:51]
    s_and_b64 exec, s[84:85], s[80:81]
    v_mfma_f32_4x4x4_16b_bf16 v[76:79], v[12:13], v[84:85], 0
    v_mov_b32 v92, v7
    s_andn2_b64 s[80:81], s[80:81], s[84:85]
    v_mfma_f32_4x4x4_16b_bf16 v[76:79], v[10:11], v[86:87], v[76:79]
    s_mov_b64 exec, -1
    ds_read_b64 v[70:71], v93 offset:65408
    ds_read_b64 v[68:69], v92 offset:65408
    v_bitop3_b32 v94, v16, v5, v99 bitop3:0xea
    v_bitop3_b32 v95, v17, v5, v46 bitop3:0xea
    v_perm_b32 v15, v17, v20, s45
    v_bitop3_b32 v46, v17, 0.5, -0.5 bitop3:0xa8
    v_perm_b32 v14, v16, v20, s44
    v_bitop3_b32 v47, v16, 0.5, -0.5 bitop3:0xa8
    v_bitop3_b32 v15, v6, v15, v46 bitop3:0xca
    v_bitop3_b32 v14, v6, v14, v47 bitop3:0xca
    s_waitcnt lgkmcnt(1)
    v_mfma_f32_4x4x4_16b_bf16 v[80:83], v[10:11], v[70:71], v[80:83]
    s_waitcnt lgkmcnt(0)
    v_mfma_f32_4x4x4_16b_bf16 v[76:79], v[10:11], v[68:69], v[76:79]
    s_nop 2
    v_cvt_pk_bf16_f32 v80, v80, v81
    v_cvt_pk_bf16_f32 v81, v82, v83
    ds_wrxchg_rtn_b64 v[74:75], v93, v[80:81] offset:65408
    v_cvt_pk_bf16_f32 v76, v76, v77
    v_cvt_pk_bf16_f32 v77, v78, v79
    ds_wrxchg_rtn_b64 v[72:73], v92, v[76:77] offset:65408
    v_mfma_f32_4x4x4_16b_bf16 v[80:83], v[8:9], v[106:107], 0
    v_mfma_f32_4x4x4_16b_bf16 v[76:79], v[8:9], v[104:105], 0
    v_cmp_lt_u32 s[84:85], v5, v94
    s_nop 2
    v_pk_mul_f32 v[80:81], v[80:81], v[14:15] op_sel:[0,1] op_sel_hi:[1,1]
    v_pk_mul_f32 v[82:83], v[82:83], v[14:15] op_sel:[0,1] op_sel_hi:[1,1]
    v_pk_mul_f32 v[76:77], v[76:77], v[14:15] op_sel:[0,0] op_sel_hi:[1,0]
    v_pk_mul_f32 v[78:79], v[78:79], v[14:15] op_sel:[0,0] op_sel_hi:[1,0]
    buffer_load_dwordx4 v[108:111], v3, s[16:19], s40 offen offset:0 sc1
    v_and_b32 v46, 0x80000000, v21
    v_lshrrev_b32 v47, 14, v19
    v_bitop3_b32 v47, v47, v5, v46 bitop3:0xea
    ds_read_b64 v[102:103], v47
    v_and_b32 v99, 0x40000000, v21
    v_lshrrev_b32 v47, 14, v18
    v_bitop3_b32 v47, v47, v5, v99 bitop3:0xea
    ds_read_b64 v[100:101], v47
    s_waitcnt lgkmcnt(2)
    v_cmp_ne_u64 s[50:51], v[72:73], v[68:69]
    v_cmpx_ne_u64 s[54:55], v[74:75], v[70:71]
    s_and_b64 s[82:83], s[54:55], s[80:81]
    s_cbranch_scc1 L2_c103
L2_d103:
    v_mov_b64 v[84:85], v[70:71]
    v_mov_b32 v7, v93
    v_mov_b64 v[86:87], v[74:75]
    s_or_b64 s[80:81], s[80:81], s[54:55]
    s_mov_b64 exec, s[50:51]
    s_and_b64 s[82:83], s[50:51], s[80:81]
    s_cbranch_scc1 L2_c104
L2_d104:
    v_mov_b64 v[84:85], v[68:69]
    v_mov_b32 v7, v92
    v_mov_b64 v[86:87], v[72:73]
    s_mov_b64 exec, -1
    s_or_b64 s[80:81], s[80:81], s[50:51]
    s_and_b64 exec, s[84:85], s[80:81]
    v_mfma_f32_4x4x4_16b_bf16 v[76:79], v[12:13], v[84:85], 0
    v_mov_b32 v94, v7
    s_andn2_b64 s[80:81], s[80:81], s[84:85]
    v_mfma_f32_4x4x4_16b_bf16 v[76:79], v[10:11], v[86:87], v[76:79]
    s_mov_b64 exec, -1
    ds_read_b64 v[70:71], v95 offset:65408
    ds_read_b64 v[68:69], v94 offset:65408
    v_bitop3_b32 v92, v18, v5, v99 bitop3:0xea
    v_bitop3_b32 v93, v19, v5, v46 bitop3:0xea
    v_perm_b32 v15, v19, v20, s47
    v_bitop3_b32 v46, v19, 0.5, -0.5 bitop3:0xa8
    v_perm_b32 v14, v18, v20, s46
    v_bitop3_b32 v47, v18, 0.5, -0.5 bitop3:0xa8
    v_bitop3_b32 v15, v6, v15, v46 bitop3:0xca
    v_bitop3_b32 v14, v6, v14, v47 bitop3:0xca
    s_waitcnt lgkmcnt(1)
    v_mfma_f32_4x4x4_16b_bf16 v[80:83], v[10:11], v[70:71], v[80:83]
    s_waitcnt lgkmcnt(0)
    v_mfma_f32_4x4x4_16b_bf16 v[76:79], v[10:11], v[68:69], v[76:79]
    s_nop 2
    v_cvt_pk_bf16_f32 v80, v80, v81
    v_cvt_pk_bf16_f32 v81, v82, v83
    ds_wrxchg_rtn_b64 v[74:75], v95, v[80:81] offset:65408
    v_cvt_pk_bf16_f32 v76, v76, v77
    v_cvt_pk_bf16_f32 v77, v78, v79
    ds_wrxchg_rtn_b64 v[72:73], v94, v[76:77] offset:65408
    v_and_b32 v88, 0x0fffffff, v40
    v_mov_b32 v21, v40
    buffer_load_dwordx2 v[16:17], v88, s[8:11], 0 offen
    buffer_load_dwordx3 v[18:20], v88, s[8:11], 0 offen offset:8
    s_setprio 2
    v_mfma_f32_4x4x4_16b_bf16 v[80:83], v[8:9], v[102:103], 0
    v_mfma_f32_4x4x4_16b_bf16 v[76:79], v[8:9], v[100:101], 0
    v_cmp_lt_u32 s[48:49], v5, v93
    s_nop 2
    v_pk_mul_f32 v[80:81], v[80:81], v[14:15] op_sel:[0,1] op_sel_hi:[1,1]
    v_pk_mul_f32 v[82:83], v[82:83], v[14:15] op_sel:[0,1] op_sel_hi:[1,1]
    v_pk_mul_f32 v[76:77], v[76:77], v[14:15] op_sel:[0,0] op_sel_hi:[1,0]
    v_pk_mul_f32 v[78:79], v[78:79], v[14:15] op_sel:[0,0] op_sel_hi:[1,0]
    s_waitcnt vmcnt(10)
    v_and_b32 v46, 0x20000000, v27
    v_lshrrev_b32 v47, 14, v23
    v_bitop3_b32 v47, v47, v5, v46 bitop3:0xea
    ds_read_b64 v[106:107], v47
    v_and_b32 v99, 0x10000000, v27
    v_lshrrev_b32 v47, 14, v22
    v_bitop3_b32 v47, v47, v5, v99 bitop3:0xea
    ds_read_b64 v[104:105], v47
    s_waitcnt lgkmcnt(2)
    v_cmp_ne_u64 s[50:51], v[72:73], v[68:69]
    v_cmpx_ne_u64 s[54:55], v[74:75], v[70:71]
    s_and_b64 s[82:83], s[54:55], s[80:81]
    s_cbranch_scc1 L2_c105
L2_d105:
    v_mov_b64 v[84:85], v[70:71]
    v_mov_b32 v7, v95
    v_mov_b64 v[86:87], v[74:75]
    s_or_b64 s[80:81], s[80:81], s[54:55]
    s_mov_b64 exec, s[50:51]
    s_and_b64 s[82:83], s[50:51], s[80:81]
    s_cbranch_scc1 L2_c106
L2_d106:
    v_mov_b64 v[84:85], v[68:69]
    v_mov_b32 v7, v94
    v_mov_b64 v[86:87], v[72:73]
    s_mov_b64 exec, -1
    s_or_b64 s[80:81], s[80:81], s[50:51]
    s_and_b64 exec, s[48:49], s[80:81]
    v_mfma_f32_4x4x4_16b_bf16 v[80:83], v[12:13], v[84:85], 0
    v_mov_b32 v93, v7
    s_andn2_b64 s[80:81], s[80:81], s[48:49]
    v_mfma_f32_4x4x4_16b_bf16 v[80:83], v[10:11], v[86:87], v[80:83]
    s_mov_b64 exec, -1
    ds_read_b64 v[70:71], v93 offset:65408
    ds_read_b64 v[68:69], v92 offset:65408
    v_bitop3_b32 v94, v22, v5, v99 bitop3:0xea
    v_bitop3_b32 v95, v23, v5, v46 bitop3:0xea
    v_perm_b32 v15, v23, v26, s45
    v_bitop3_b32 v46, v23, 0.5, -0.5 bitop3:0xa8
    v_perm_b32 v14, v22, v26, s44
    v_bitop3_b32 v47, v22, 0.5, -0.5 bitop3:0xa8
    v_bitop3_b32 v15, v6, v15, v46 bitop3:0xca
    v_bitop3_b32 v14, v6, v14, v47 bitop3:0xca
    s_waitcnt lgkmcnt(1)
    v_mfma_f32_4x4x4_16b_bf16 v[80:83], v[10:11], v[70:71], v[80:83]
    s_waitcnt lgkmcnt(0)
    v_mfma_f32_4x4x4_16b_bf16 v[76:79], v[10:11], v[68:69], v[76:79]
    s_nop 2
    v_cvt_pk_bf16_f32 v80, v80, v81
    v_cvt_pk_bf16_f32 v81, v82, v83
    ds_wrxchg_rtn_b64 v[74:75], v93, v[80:81] offset:65408
    v_cvt_pk_bf16_f32 v76, v76, v77
    v_cvt_pk_bf16_f32 v77, v78, v79
    ds_wrxchg_rtn_b64 v[72:73], v92, v[76:77] offset:65408
    s_setprio 1
    v_mfma_f32_4x4x4_16b_bf16 v[80:83], v[8:9], v[106:107], 0
    v_mfma_f32_4x4x4_16b_bf16 v[76:79], v[8:9], v[104:105], 0
    s_nop 3
    v_pk_mul_f32 v[80:81], v[80:81], v[14:15] op_sel:[0,1] op_sel_hi:[1,1]
    v_pk_mul_f32 v[82:83], v[82:83], v[14:15] op_sel:[0,1] op_sel_hi:[1,1]
    v_pk_mul_f32 v[76:77], v[76:77], v[14:15] op_sel:[0,0] op_sel_hi:[1,0]
    v_pk_mul_f32 v[78:79], v[78:79], v[14:15] op_sel:[0,0] op_sel_hi:[1,0]
    s_bitcmp1_b32 s43, s42
    s_cbranch_scc1 L2_oa107
L2_ob107:
    buffer_load_dwordx4 v[112:115], v3, s[16:19], s40 offen offset:1024 sc1
    v_sub_u16 v88, v62, v54
    v_and_b32 v89, 3, v54
    v_add3_u32 v99, v88, v89, 3
    v_and_b32 v99, -4, v99
    v_max_u32 v99, 4, v99
    v_and_b32 v97, 0xfffc, v54
    v_bfm_b32 v96, v88, v89
    v_add_u32_dpp v91, v99, v99 row_shr:1 row_mask:0xf bank_mask:0xf bound_ctrl:1
    v_mad_u32_u24 v97, v97, 5, v2
    v_cmp_lt_u32 vcc, 16, v99
    v_add_u32_dpp v91, v91, v91 row_shr:2 row_mask:0xf bank_mask:0xf bound_ctrl:1
    v_sub_u32 v98, s38, v99
    v_lshrrev_b64 v[54:55], 16, v[54:55]
    v_add_u32_dpp v91, v91, v91 row_shr:4 row_mask:0xf bank_mask:0xf bound_ctrl:1
    v_lshrrev_b64 v[62:63], 16, v[62:63]
    s_mov_b32 s101, 0
    v_add_u32_dpp v91, v91, v91 row_shr:8 row_mask:0xf bank_mask:0xf bound_ctrl:1
    s_nop 1
    v_add_u32_dpp v91, v91, v91 row_bcast:15 row_mask:0xa bank_mask:0xf
    s_nop 1
    v_add_u32_dpp v91, v91, v91 row_bcast:31 row_mask:0xc bank_mask:0xf
    v_add_u32 v98, v98, v91
    v_readlane_b32 s37, v91, 63
    s_cbranch_vccnz L2_xo108
L2_xp108:
    v_and_b32 v46, 0x80000000, v27
    v_lshrrev_b32 v47, 14, v25
    v_bitop3_b32 v47, v47, v5, v46 bitop3:0xea
    ds_read_b64 v[102:103], v47
    v_and_b32 v99, 0x40000000, v27
    v_lshrrev_b32 v47, 14, v24
    v_bitop3_b32 v47, v47, v5, v99 bitop3:0xea
    ds_read_b64 v[100:101], v47
    s_waitcnt lgkmcnt(2)
    v_cmp_ne_u64 s[50:51], v[72:73], v[68:69]
    v_cmpx_ne_u64 s[54:55], v[74:75], v[70:71]
    s_and_b64 s[82:83], s[54:55], s[80:81]
    s_cbranch_scc1 L2_c109
L2_d109:
    v_mov_b64 v[84:85], v[70:71]
    v_mov_b32 v7, v93
    v_mov_b64 v[86:87], v[74:75]
    s_or_b64 s[80:81], s[80:81], s[54:55]
    s_mov_b64 exec, s[50:51]
    s_and_b64 s[82:83], s[50:51], s[80:81]
    s_cbranch_scc1 L2_c110
L2_d110:
    v_mov_b64 v[84:85], v[68:69]
    v_mov_b32 v7, v92
    v_mov_b64 v[86:87], v[72:73]
    s_mov_b64 exec, -1
    s_or_b64 s[80:81], s[80:81], s[50:51]
    ds_read_b64 v[70:71], v95 offset:65408
    ds_read_b64 v[68:69], v94 offset:65408
    v_bitop3_b32 v92, v24, v5, v99 bitop3:0xea
    v_bitop3_b32 v93, v25, v5, v46 bitop3:0xea
    v_perm_b32 v15, v25, v26, s47
    v_bitop3_b32 v46, v25, 0.5, -0.5 bitop3:0xa8
    v_perm_b32 v14, v24, v26, s46
    v_bitop3_b32 v47, v24, 0.5, -0.5 bitop3:0xa8
    v_bitop3_b32 v15, v6, v15, v46 bitop3:0xca
    v_bitop3_b32 v14, v6, v14, v47 bitop3:0xca
    s_waitcnt lgkmcnt(1)
    v_mfma_f32_4x4x4_16b_bf16 v[80:83], v[10:11], v[70:71], v[80:83]
    s_waitcnt lgkmcnt(0)
    v_mfma_f32_4x4x4_16b_bf16 v[76:79], v[10:11], v[68:69], v[76:79]
    s_nop 2
    v_cvt_pk_bf16_f32 v80, v80, v81
    v_cvt_pk_bf16_f32 v81, v82, v83
    ds_wrxchg_rtn_b64 v[74:75], v95, v[80:81] offset:65408
    v_cvt_pk_bf16_f32 v76, v76, v77
    v_cvt_pk_bf16_f32 v77, v78, v79
    ds_wrxchg_rtn_b64 v[72:73], v94, v[76:77] offset:65408
    v_and_b32 v88, 0x0fffffff, v41
    v_mov_b32 v27, v41
    buffer_load_dwordx2 v[22:23], v88, s[8:11], 0 offen
    buffer_load_dwordx3 v[24:26], v88, s[8:11], 0 offen offset:8
    v_mfma_f32_4x4x4_16b_bf16 v[80:83], v[8:9], v[102:103], 0
    v_mfma_f32_4x4x4_16b_bf16 v[76:79], v[8:9], v[100:101], 0
    v_cmp_lt_u32 s[84:85], v5, v92
    s_nop 2
    v_pk_mul_f32 v[80:81], v[80:81], v[14:15] op_sel:[0,1] op_sel_hi:[1,1]
    v_pk_mul_f32 v[82:83], v[82:83], v[14:15] op_sel:[0,1] op_sel_hi:[1,1]
    v_pk_mul_f32 v[76:77], v[76:77], v[14:15] op_sel:[0,0] op_sel_hi:[1,0]
    v_pk_mul_f32 v[78:79], v[78:79], v[14:15] op_sel:[0,0] op_sel_hi:[1,0]
    s_waitcnt vmcnt(11)
    s_mov_b64 exec, s[6:7]
    v_lshrrev_b32 v30, 16, v30
    s_mov_b64 exec, -1
    v_and_b32 v46, 0x20000000, v31
    v_lshrrev_b32 v47, 14, v29
    v_bitop3_b32 v47, v47, v5, v46 bitop3:0xea
    ds_read_b64 v[106:107], v47
    v_and_b32 v99, 0x10000000, v31
    v_lshrrev_b32 v47, 14, v28
    v_bitop3_b32 v47, v47, v5, v99 bitop3:0xea
    ds_read_b64 v[104:105], v47
    s_waitcnt lgkmcnt(2)
    v_cmp_ne_u64 s[50:51], v[72:73], v[68:69]
    v_cmpx_ne_u64 s[54:55], v[74:75], v[70:71]
    s_and_b64 s[82:83], s[54:55], s[80:81]
    s_cbranch_scc1 L2_c111
L2_d111:
    v_mov_b64 v[84:85], v[70:71]
    v_mov_b32 v7, v95
    v_mov_b64 v[86:87], v[74:75]
    s_or_b64 s[80:81], s[80:81], s[54:55]
    s_mov_b64 exec, s[50:51]
    s_and_b64 s[82:83], s[50:51], s[80:81]
    s_cbranch_scc1 L2_c112
L2_d112:
    v_mov_b64 v[84:85], v[68:69]
    v_mov_b32 v7, v94
    v_mov_b64 v[86:87], v[72:73]
    s_mov_b64 exec, -1
    s_or_b64 s[80:81], s[80:81], s[50:51]
    s_and_b64 exec, s[84:85], s[80:81]
    v_mfma_f32_4x4x4_16b_bf16 v[76:79], v[12:13], v[84:85], 0
    v_mov_b32 v92, v7
    s_andn2_b64 s[80:81], s[80:81], s[84:85]
    v_mfma_f32_4x4x4_16b_bf16 v[76:79], v[10:11], v[86:87], v[76:79]
    s_mov_b64 exec, -1
    ds_read_b64 v[70:71], v93 offset:65408
    ds_read_b64 v[68:69], v92 offset:65408
    v_bitop3_b32 v94, v28, v5, v99 bitop3:0xea
    v_bitop3_b32 v95, v29, v5, v46 bitop3:0xea
    v_perm_b32 v15, v29, v30, s45
    v_bitop3_b32 v46, v29, 0.5, -0.5 bitop3:0xa8
    v_perm_b32 v14, v28, v30, s44
    v_bitop3_b32 v47, v28, 0.5, -0.5 bitop3:0xa8
    v_bitop3_b32 v15, v6, v15, v46 bitop3:0xca
    v_bitop3_b32 v14, v6, v14, v47 bitop3:0xca
    s_waitcnt lgkmcnt(1)
    v_mfma_f32_4x4x4_16b_bf16 v[80:83], v[10:11], v[70:71], v[80:83]
    s_waitcnt lgkmcnt(0)
    v_mfma_f32_4x4x4_16b_bf16 v[76:79], v[10:11], v[68:69], v[76:79]
    s_nop 2
    v_cvt_pk_bf16_f32 v80, v80, v81
    v_cvt_pk_bf16_f32 v81, v82, v83
    ds_wrxchg_rtn_b64 v[74:75], v93, v[80:81] offset:65408
    v_cvt_pk_bf16_f32 v76, v76, v77
    v_cvt_pk_bf16_f32 v77, v78, v79
    ds_wrxchg_rtn_b64 v[72:73], v92, v[76:77] offset:65408
    s_setprio 0
    v_mfma_f32_4x4x4_16b_bf16 v[80:83], v[8:9], v[106:107], 0
    v_mfma_f32_4x4x4_16b_bf16 v[76:79], v[8:9], v[104:105], 0
    v_cmp_lt_u32 s[48:49], v5, v95
    s_nop 2
    v_pk_mul_f32 v[80:81], v[80:81], v[14:15] op_sel:[0,1] op_sel_hi:[1,1]
    v_pk_mul_f32 v[82:83], v[82:83], v[14:15] op_sel:[0,1] op_sel_hi:[1,1]
    v_pk_mul_f32 v[76:77], v[76:77], v[14:15] op_sel:[0,0] op_sel_hi:[1,0]
    v_pk_mul_f32 v[78:79], v[78:79], v[14:15] op_sel:[0,0] op_sel_hi:[1,0]
    s_add_u32 s40, s40, 0x50000
    v_and_b32 v47, 0x0fffffff, v42
    v_mov_b32 v31, v42
    buffer_load_dword v30, v47, s[8:11], 0 offen offset:16
    s_mov_b64 exec, s[6:7]
    v_add_u32 v47, 8, v47
    v_lshrrev_b32 v31, 2, v31
    s_mov_b64 exec, -1
    buffer_load_dwordx2 v[28:29], v47, s[8:11], 0 offen
    s_waitcnt vmcnt(8)
    v_and_b32 v46, 0x80000000, v39
    v_lshrrev_b32 v47, 14, v37
    v_bitop3_b32 v47, v47, v5, v46 bitop3:0xea
    ds_read_b64 v[106:107], v47
    v_and_b32 v99, 0x40000000, v39
    v_lshrrev_b32 v47, 14, v36
    v_bitop3_b32 v47, v47, v5, v99 bitop3:0xea
    ds_read_b64 v[104:105], v47
    v_and_b32 v46, 0x20000000, v39
    v_lshrrev_b32 v47, 14, v35
    v_bitop3_b32 v47, v47, v5, v46 bitop3:0xea
    ds_read_b64 v[102:103], v47
    v_and_b32 v99, 0x10000000, v39
    v_lshrrev_b32 v47, 14, v34
    v_bitop3_b32 v47, v47, v5, v99 bitop3:0xea
    ds_read_b64 v[100:101], v47
    s_waitcnt lgkmcnt(4)
    v_cmp_ne_u64 s[50:51], v[72:73], v[68:69]
    v_cmpx_ne_u64 s[54:55], v[74:75], v[70:71]
    s_and_b64 s[82:83], s[54:55], s[80:81]
    s_cbranch_scc1 L2_c113
L2_d113:
    v_mov_b64 v[84:85], v[70:71]
    v_mov_b32 v7, v93
    v_mov_b64 v[86:87], v[74:75]
    s_or_b64 s[80:81], s[80:81], s[54:55]
    s_mov_b64 exec, s[50:51]
    s_and_b64 s[82:83], s[50:51], s[80:81]
    s_cbranch_scc1 L2_c114
L2_d114:
    v_mov_b64 v[84:85], v[68:69]
    v_mov_b32 v7, v92
    v_mov_b64 v[86:87], v[72:73]
    s_mov_b64 exec, -1
    s_or_b64 s[80:81], s[80:81], s[50:51]
    s_and_b64 exec, s[48:49], s[80:81]
    v_mfma_f32_4x4x4_16b_bf16 v[80:83], v[12:13], v[84:85], 0
    v_mov_b32 v95, v7
    s_andn2_b64 s[80:81], s[80:81], s[48:49]
    v_mfma_f32_4x4x4_16b_bf16 v[80:83], v[10:11], v[86:87], v[80:83]
    s_mov_b64 exec, -1
    ds_read_b64 v[70:71], v95 offset:65408
    ds_read_b64 v[68:69], v94 offset:65408
    v_bitop3_b32 v92, v34, v5, v99 bitop3:0xea
    v_bitop3_b32 v93, v35, v5, v46 bitop3:0xea
    v_perm_b32 v15, v35, v38, s45
    v_bitop3_b32 v46, v35, 0.5, -0.5 bitop3:0xa8
    v_perm_b32 v14, v34, v38, s44
    v_bitop3_b32 v47, v34, 0.5, -0.5 bitop3:0xa8
    v_bitop3_b32 v15, v6, v15, v46 bitop3:0xca
    v_bitop3_b32 v14, v6, v14, v47 bitop3:0xca
    s_waitcnt lgkmcnt(1)
    v_mfma_f32_4x4x4_16b_bf16 v[80:83], v[10:11], v[70:71], v[80:83]
    s_waitcnt lgkmcnt(0)
    v_mfma_f32_4x4x4_16b_bf16 v[76:79], v[10:11], v[68:69], v[76:79]
    s_nop 2
    v_cvt_pk_bf16_f32 v80, v80, v81
    v_cvt_pk_bf16_f32 v81, v82, v83
    ds_wrxchg_rtn_b64 v[74:75], v95, v[80:81] offset:65408
    v_cvt_pk_bf16_f32 v76, v76, v77
    v_cvt_pk_bf16_f32 v77, v78, v79
    ds_wrxchg_rtn_b64 v[72:73], v94, v[76:77] offset:65408
    s_barrier
    s_setprio 3
    s_mov_b32 m0, s100
    s_nop 0
    ds_write_addtid_b32 v124 offset:34816
    ds_write_addtid_b32 v125 offset:35072
    ds_write_addtid_b32 v126 offset:35328
    ds_write_addtid_b32 v127 offset:35584
    s_add_u32 s3, s40, 4096
    buffer_load_dwordx4 v[124:127], v3, s[16:19], s3 offen sc1
    ds_write_addtid_b32 v116 offset:32768
    ds_write_addtid_b32 v117 offset:33024
    ds_write_addtid_b32 v118 offset:33280
    ds_write_addtid_b32 v119 offset:33536
    buffer_load_dwordx4 v[116:119], v3, s[16:19], s40 offen offset:2048 sc1
    ds_write_addtid_b32 v120 offset:33792
    ds_write_addtid_b32 v121 offset:34048
    ds_write_addtid_b32 v122 offset:34304
    ds_write_addtid_b32 v123 offset:34560
    buffer_load_dwordx4 v[120:123], v3, s[16:19], s40 offen offset:3072 sc1
    v_mfma_f32_4x4x4_16b_bf16 v[80:83], v[8:9], v[102:103], 0
    v_mfma_f32_4x4x4_16b_bf16 v[76:79], v[8:9], v[100:101], 0
    s_nop 3
    v_pk_mul_f32 v[80:81], v[80:81], v[14:15] op_sel:[0,1] op_sel_hi:[1,1]
    v_pk_mul_f32 v[82:83], v[82:83], v[14:15] op_sel:[0,1] op_sel_hi:[1,1]
    v_pk_mul_f32 v[76:77], v[76:77], v[14:15] op_sel:[0,0] op_sel_hi:[1,0]
    v_pk_mul_f32 v[78:79], v[78:79], v[14:15] op_sel:[0,0] op_sel_hi:[1,0]
    v_mov_b32 v44, v43
    s_cmp_gt_u32 s37, 1024
    s_cbranch_scc1 L2_xs115
    s_cmp_lg_u32 s101, 0
    s_cbranch_scc1 L2_xa115
L2_xb115:
    v_lshlrev_b32 v89, 16, v96
    v_add_u32 v90, 60, v97
    v_bitop3_b32 v90, v89, v45, v90 bitop3:0x6a
    ds_write_b32 v98, v90 offset:12
    v_lshlrev_b32 v89, 20, v96
    v_add_u32 v90, 40, v97
    v_bitop3_b32 v90, v89, v45, v90 bitop3:0x6a
    ds_write_b32 v98, v90 offset:8
    v_lshlrev_b32 v89, 24, v96
    v_add_u32 v90, 20, v97
    v_bitop3_b32 v90, v89, v45, v90 bitop3:0x6a
    ds_write_b32 v98, v90 offset:4
    v_lshlrev_b32 v89, 28, v96
    v_bitop3_b32 v90, v89, v45, v97 bitop3:0x6a
    ds_write_b32 v98, v90 offset:0
    v_mov_b32_dpp v91, v66 quad_perm:[1,1,1,1] row_mask:0xf bank_mask:0xf
    v_and_b32 v89, 3, v91
    v_and_b32 v97, 0xfffc, v91
    v_sub_u16_dpp v88, v66, v91 quad_perm:[3,3,3,3] row_mask:0xf bank_mask:0xf
    v_mad_u32_u24 v97, v97, 5, v4
    v_add_u32 v99, v88, v89
    v_bfm_b32 v96, v88, v89
    v_cmp_lt_u32 s[58:59], 16, v99
    v_lshlrev_b32 v89, v1, v96
    v_and_b32 v89, v45, v89
    v_cmp_ne_u32 vcc, 0, v89
    v_xor_b32 v90, v97, v89
    s_add_u32 s3, s37, s38
    v_mbcnt_lo_u32_b32 v98, vcc_lo, 0
    v_mbcnt_hi_u32_b32 v98, vcc_hi, v98
    s_bcnt1_i32_b64 s41, vcc
    v_lshl_add_u32 v98, v98, 2, s3
    s_lshl2_add_u32 s37, s41, s37
    s_mov_b64 exec, vcc
    ds_write_b32 v98, v90
    s_mov_b64 exec, -1
    s_cmp_lg_u64 s[58:59], 0
    s_cbranch_scc1 L2_xe115
L2_xr115:
    v_add_u32 v98, s37, v0
    v_mov_b32 v90, -1
    ds_write_b32 v98, v90
    v_add_u32 v98, s38, v0
    ds_read2st64_b32 v[40:41], v0 offset0:0 offset1:1
    ds_read_b32 v43, v0 offset:512
    v_lshrrev_b32 v98, 1, v98
    v_and_b32 v98, -4, v98
    ds_read_b32 v42, v98 offset:768
    s_sub_u32 s3, s37, 768
    s_cmp_gt_u32 s3, 128
    s_cbranch_scc1 L2_xf115
L2_xg115:
    v_lshrrev_b64 v[64:65], 16, v[64:65]
    v_lshrrev_b64 v[66:67], 16, v[66:67]
    s_setprio 2
    s_waitcnt lgkmcnt(14)
    v_cmp_ne_u64 s[50:51], v[72:73], v[68:69]
    v_cmpx_ne_u64 s[54:55], v[74:75], v[70:71]
    s_and_b64 s[82:83], s[54:55], s[80:81]
    s_cbranch_scc1 L2_c116
L2_d116:
    v_mov_b64 v[84:85], v[70:71]
    v_mov_b32 v7, v95
    v_mov_b64 v[86:87], v[74:75]
    s_or_b64 s[80:81], s[80:81], s[54:55]
    s_mov_b64 exec, s[50:51]
    s_and_b64 s[82:83], s[50:51], s[80:81]
    s_cbranch_scc1 L2_c117
L2_d117:
    v_mov_b64 v[84:85], v[68:69]
    v_mov_b32 v7, v94
    v_mov_b64 v[86:87], v[72:73]
    s_mov_b64 exec, -1
    s_or_b64 s[80:81], s[80:81], s[50:51]
    ds_read_b64 v[70:71], v93 offset:65408
    ds_read_b64 v[68:69], v92 offset:65408
    v_and_b32 v46, 0x40000000, v39
    v_bitop3_b32 v94, v36, v5, v46 bitop3:0xea
    v_and_b32 v46, 0x80000000, v39
    v_bitop3_b32 v95, v37, v5, v46 bitop3:0xea
    v_perm_b32 v15, v37, v38, s47
    v_bitop3_b32 v46, v37, 0.5, -0.5 bitop3:0xa8
    v_perm_b32 v14, v36, v38, s46
    v_bitop3_b32 v47, v36, 0.5, -0.5 bitop3:0xa8
    v_bitop3_b32 v15, v6, v15, v46 bitop3:0xca
    v_bitop3_b32 v14, v6, v14, v47 bitop3:0xca
    s_setprio 1
    s_waitcnt lgkmcnt(1)
    v_mfma_f32_4x4x4_16b_bf16 v[80:83], v[10:11], v[70:71], v[80:83]
    s_waitcnt lgkmcnt(0)
    v_mfma_f32_4x4x4_16b_bf16 v[76:79], v[10:11], v[68:69], v[76:79]
    s_nop 2
    v_cvt_pk_bf16_f32 v80, v80, v81
    v_cvt_pk_bf16_f32 v81, v82, v83
    ds_wrxchg_rtn_b64 v[74:75], v93, v[80:81] offset:65408
    v_cvt_pk_bf16_f32 v76, v76, v77
    v_cvt_pk_bf16_f32 v77, v78, v79
    ds_wrxchg_rtn_b64 v[72:73], v92, v[76:77] offset:65408
    v_and_b32 v88, 0x0fffffff, v44
    v_mov_b32 v39, v44
    buffer_load_dwordx2 v[34:35], v88, s[8:11], 0 offen
    buffer_load_dwordx3 v[36:38], v88, s[8:11], 0 offen offset:8
    s_setprio 0
    s_waitcnt vmcnt(12)
    s_mov_b32 m0, s38
    s_nop 0
    ds_write_addtid_b32 v108 offset:0
    ds_write_addtid_b32 v109 offset:256
    ds_write_addtid_b32 v110 offset:512
    ds_write_addtid_b32 v111 offset:768
    s_waitcnt vmcnt(9)
    ds_write_addtid_b32 v112 offset:1024
    ds_write_addtid_b32 v113 offset:1280
    ds_write_addtid_b32 v114 offset:1536
    ds_write_addtid_b32 v115 offset:1792
    v_mfma_f32_4x4x4_16b_bf16 v[80:83], v[8:9], v[106:107], 0
    v_mfma_f32_4x4x4_16b_bf16 v[76:79], v[8:9], v[104:105], 0
    v_cmp_lt_u32 s[84:85], v5, v94
    s_nop 2
    v_pk_mul_f32 v[80:81], v[80:81], v[14:15] op_sel:[0,1] op_sel_hi:[1,1]
    v_pk_mul_f32 v[82:83], v[82:83], v[14:15] op_sel:[0,1] op_sel_hi:[1,1]
    v_pk_mul_f32 v[76:77], v[76:77], v[14:15] op_sel:[0,0] op_sel_hi:[1,0]
    v_pk_mul_f32 v[78:79], v[78:79], v[14:15] op_sel:[0,0] op_sel_hi:[1,0]
    s_add_u32 s42, s42, 1
    s_waitcnt lgkmcnt(0)
    s_cmp_lg_u32 s42, 14
    s_cbranch_scc1 L2_loop
    s_barrier
    s_bitcmp1_b32 s36, s42
    s_cbranch_scc1 L2_slow
L2_ret6:
    s_setprio 3
    s_bitcmp1_b32 s43, s42
    s_cbranch_scc1 L2_oa118
L2_ob118:
    v_and_b32 v46, 0x20000000, v21
    v_lshrrev_b32 v47, 14, v17
    v_bitop3_b32 v47, v47, v5, v46 bitop3:0xea
    ds_read_b64 v[102:103], v47
    v_and_b32 v99, 0x10000000, v21
    v_lshrrev_b32 v47, 14, v16
    v_bitop3_b32 v47, v47, v5, v99 bitop3:0xea
    ds_read_b64 v[100:101], v47
    v_cmp_ne_u64 s[50:51], v[72:73], v[68:69]
    v_cmpx_ne_u64 s[54:55], v[74:75], v[70:71]
    s_and_b64 s[82:83], s[54:55], s[80:81]
    s_cbranch_scc1 L2_c119
L2_d119:
    v_mov_b64 v[84:85], v[70:71]
    v_mov_b32 v7, v93
    v_mov_b64 v[86:87], v[74:75]
    s_or_b64 s[80:81], s[80:81], s[54:55]
    s_mov_b64 exec, s[50:51]
    s_and_b64 s[82:83], s[50:51], s[80:81]
    s_cbranch_scc1 L2_c120
L2_d120:
    v_mov_b64 v[84:85], v[68:69]
    v_mov_b32 v7, v92
    v_mov_b64 v[86:87], v[72:73]
    s_mov_b64 exec, -1
    s_or_b64 s[80:81], s[80:81], s[50:51]
    s_and_b64 exec, s[84:85], s[80:81]
    v_mfma_f32_4x4x4_16b_bf16 v[76:79], v[12:13], v[84:85], 0
    v_mov_b32 v94, v7
    s_andn2_b64 s[80:81], s[80:81], s[84:85]
    v_mfma_f32_4x4x4_16b_bf16 v[76:79], v[10:11], v[86:87], v[76:79]
    s_mov_b64 exec, -1
    ds_read_b64 v[70:71], v95 offset:65408
    ds_read_b64 v[68:69], v94 offset:65408
    v_bitop3_b32 v92, v16, v5, v99 bitop3:0xea
    v_bitop3_b32 v93, v17, v5, v46 bitop3:0xea
    v_perm_b32 v15, v17, v20, s45
    v_bitop3_b32 v46, v17, 0.5, -0.5 bitop3:0xa8
    v_perm_b32 v14, v16, v20, s44
    v_bitop3_b32 v47, v16, 0.5, -0.5 bitop3:0xa8
    v_bitop3_b32 v15, v6, v15, v46 bitop3:0xca
    v_bitop3_b32 v14, v6, v14, v47 bitop3:0xca
    s_waitcnt lgkmcnt(1)
    v_mfma_f32_4x4x4_16b_bf16 v[80:83], v[10:11], v[70:71], v[80:83]
    s_waitcnt lgkmcnt(0)
    v_mfma_f32_4x4x4_16b_bf16 v[76:79], v[10:11], v[68:69], v[76:79]
    s_nop 2
    v_cvt_pk_bf16_f32 v80, v80, v81
    v_cvt_pk_bf16_f32 v81, v82, v83
    ds_wrxchg_rtn_b64 v[74:75], v95, v[80:81] offset:65408
    v_cvt_pk_bf16_f32 v76, v76, v77
    v_cvt_pk_bf16_f32 v77, v78, v79
    ds_wrxchg_rtn_b64 v[72:73], v94, v[76:77] offset:65408
    v_mfma_f32_4x4x4_16b_bf16 v[80:83], v[8:9], v[102:103], 0
    v_mfma_f32_4x4x4_16b_bf16 v[76:79], v[8:9], v[100:101], 0
    v_cmp_lt_u32 s[84:85], v5, v92
    s_nop 2
    v_pk_mul_f32 v[80:81], v[80:81], v[14:15] op_sel:[0,1] op_sel_hi:[1,1]
    v_pk_mul_f32 v[82:83], v[82:83], v[14:15] op_sel:[0,1] op_sel_hi:[1,1]
    v_pk_mul_f32 v[76:77], v[76:77], v[14:15] op_sel:[0,0] op_sel_hi:[1,0]
    v_pk_mul_f32 v[78:79], v[78:79], v[14:15] op_sel:[0,0] op_sel_hi:[1,0]
    buffer_load_dwordx4 v[108:111], v3, s[16:19], s40 offen offset:0 sc1
    v_and_b32 v46, 0x80000000, v21
    v_lshrrev_b32 v47, 14, v19
    v_bitop3_b32 v47, v47, v5, v46 bitop3:0xea
    ds_read_b64 v[106:107], v47
    v_and_b32 v99, 0x40000000, v21
    v_lshrrev_b32 v47, 14, v18
    v_bitop3_b32 v47, v47, v5, v99 bitop3:0xea
    ds_read_b64 v[104:105], v47
    s_waitcnt lgkmcnt(2)
    v_cmp_ne_u64 s[50:51], v[72:73], v[68:69]
    v_cmpx_ne_u64 s[54:55], v[74:75], v[70:71]
    s_and_b64 s[82:83], s[54:55], s[80:81]
    s_cbranch_scc1 L2_c121
L2_d121:
    v_mov_b64 v[84:85], v[70:71]
    v_mov_b32 v7, v95
    v_mov_b64 v[86:87], v[74:75]
    s_or_b64 s[80:81], s[80:81], s[54:55]
    s_mov_b64 exec, s[50:51]
    s_and_b64 s[82:83], s[50:51], s[80:81]
    s_cbranch_scc1 L2_c122
L2_d122:
    v_mov_b64 v[84:85], v[68:69]
    v_mov_b32 v7, v94
    v_mov_b64 v[86:87], v[72:73]
    s_mov_b64 exec, -1
    s_or_b64 s[80:81], s[80:81], s[50:51]
    s_and_b64 exec, s[84:85], s[80:81]
    v_mfma_f32_4x4x4_16b_bf16 v[76:79], v[12:13], v[84:85], 0
    v_mov_b32 v92, v7
    s_andn2_b64 s[80:81], s[80:81], s[84:85]
    v_mfma_f32_4x4x4_16b_bf16 v[76:79], v[10:11], v[86:87], v[76:79]
    s_mov_b64 exec, -1
    ds_read_b64 v[70:71], v93 offset:65408
    ds_read_b64 v[68:69], v92 offset:65408
    v_bitop3_b32 v94, v18, v5, v99 bitop3:0xea
    v_bitop3_b32 v95, v19, v5, v46 bitop3:0xea
    v_perm_b32 v15, v19, v20, s47
    v_bitop3_b32 v46, v19, 0.5, -0.5 bitop3:0xa8
    v_perm_b32 v14, v18, v20, s46
    v_bitop3_b32 v47, v18, 0.5, -0.5 bitop3:0xa8
    v_bitop3_b32 v15, v6, v15, v46 bitop3:0xca
    v_bitop3_b32 v14, v6, v14, v47 bitop3:0xca
    s_waitcnt lgkmcnt(1)
    v_mfma_f32_4x4x4_16b_bf16 v[80:83], v[10:11], v[70:71], v[80:83]
    s_waitcnt lgkmcnt(0)
    v_mfma_f32_4x4x4_16b_bf16 v[76:79], v[10:11], v[68:69], v[76:79]
    s_nop 2
    v_cvt_pk_bf16_f32 v80, v80, v81
    v_cvt_pk_bf16_f32 v81, v82, v83
    ds_wrxchg_rtn_b64 v[74:75], v93, v[80:81] offset:65408
    v_cvt_pk_bf16_f32 v76, v76, v77
    v_cvt_pk_bf16_f32 v77, v78, v79
    ds_wrxchg_rtn_b64 v[72:73], v92, v[76:77] offset:65408
    v_and_b32 v88, 0x0fffffff, v40
    v_mov_b32 v21, v40
    buffer_load_dwordx2 v[16:17], v88, s[8:11], 0 offen
    buffer_load_dwordx3 v[18:20], v88, s[8:11], 0 offen offset:8
    s_setprio 2
    v_mfma_f32_4x4x4_16b_bf16 v[80:83], v[8:9], v[106:107], 0
    v_mfma_f32_4x4x4_16b_bf16 v[76:79], v[8:9], v[104:105], 0
    v_cmp_lt_u32 s[48:49], v5, v95
    s_nop 2
    v_pk_mul_f32 v[80:81], v[80:81], v[14:15] op_sel:[0,1] op_sel_hi:[1,1]
    v_pk_mul_f32 v[82:83], v[82:83], v[14:15] op_sel:[0,1] op_sel_hi:[1,1]
    v_pk_mul_f32 v[76:77], v[76:77], v[14:15] op_sel:[0,0] op_sel_hi:[1,0]
    v_pk_mul_f32 v[78:79], v[78:79], v[14:15] op_sel:[0,0] op_sel_hi:[1,0]
    s_waitcnt vmcnt(10)
    v_and_b32 v46, 0x20000000, v27
    v_lshrrev_b32 v47, 14, v23
    v_bitop3_b32 v47, v47, v5, v46 bitop3:0xea
    ds_read_b64 v[102:103], v47
    v_and_b32 v99, 0x10000000, v27
    v_lshrrev_b32 v47, 14, v22
    v_bitop3_b32 v47, v47, v5, v99 bitop3:0xea
    ds_read_b64 v[100:101], v47
    s_waitcnt lgkmcnt(2)
    v_cmp_ne_u64 s[50:51], v[72:73], v[68:69]
    v_cmpx_ne_u64 s[54:55], v[74:75], v[70:71]
    s_and_b64 s[82:83], s[54:55], s[80:81]
    s_cbranch_scc1 L2_c123
L2_d123:
    v_mov_b64 v[84:85], v[70:71]
    v_mov_b32 v7, v93
    v_mov_b64 v[86:87], v[74:75]
    s_or_b64 s[80:81], s[80:81], s[54:55]
    s_mov_b64 exec, s[50:51]
    s_and_b64 s[82:83], s[50:51], s[80:81]
    s_cbranch_scc1 L2_c124
L2_d124:
    v_mov_b64 v[84:85], v[68:69]
    v_mov_b32 v7, v92
    v_mov_b64 v[86:87], v[72:73]
    s_mov_b64 exec, -1
    s_or_b64 s[80:81], s[80:81], s[50:51]
    s_and_b64 exec, s[48:49], s[80:81]
    v_mfma_f32_4x4x4_16b_bf16 v[80:83], v[12:13], v[84:85], 0
    v_mov_b32 v95, v7
    s_andn2_b64 s[80:81], s[80:81], s[48:49]
    v_mfma_f32_4x4x4_16b_bf16 v[80:83], v[10:11], v[86:87], v[80:83]
    s_mov_b64 exec, -1
    ds_read_b64 v[70:71], v95 offset:65408
    ds_read_b64 v[68:69], v94 offset:65408
    v_bitop3_b32 v92, v22, v5, v99 bitop3:0xea
    v_bitop3_b32 v93, v23, v5, v46 bitop3:0xea
    v_perm_b32 v15, v23, v26, s45
    v_bitop3_b32 v46, v23, 0.5, -0.5 bitop3:0xa8
    v_perm_b32 v14, v22, v26, s44
    v_bitop3_b32 v47, v22, 0.5, -0.5 bitop3:0xa8
    v_bitop3_b32 v15, v6, v15, v46 bitop3:0xca
    v_bitop3_b32 v14, v6, v14, v47 bitop3:0xca
    s_waitcnt lgkmcnt(1)
    v_mfma_f32_4x4x4_16b_bf16 v[80:83], v[10:11], v[70:71], v[80:83]
    s_waitcnt lgkmcnt(0)
    v_mfma_f32_4x4x4_16b_bf16 v[76:79], v[10:11], v[68:69], v[76:79]
    s_nop 2
    v_cvt_pk_bf16_f32 v80, v80, v81
    v_cvt_pk_bf16_f32 v81, v82, v83
    ds_wrxchg_rtn_b64 v[74:75], v95, v[80:81] offset:65408
    v_cvt_pk_bf16_f32 v76, v76, v77
    v_cvt_pk_bf16_f32 v77, v78, v79
    ds_wrxchg_rtn_b64 v[72:73], v94, v[76:77] offset:65408
    s_setprio 1
    v_mfma_f32_4x4x4_16b_bf16 v[80:83], v[8:9], v[102:103], 0
    v_mfma_f32_4x4x4_16b_bf16 v[76:79], v[8:9], v[100:101], 0
    s_nop 3
    v_pk_mul_f32 v[80:81], v[80:81], v[14:15] op_sel:[0,1] op_sel_hi:[1,1]
    v_pk_mul_f32 v[82:83], v[82:83], v[14:15] op_sel:[0,1] op_sel_hi:[1,1]
    v_pk_mul_f32 v[76:77], v[76:77], v[14:15] op_sel:[0,0] op_sel_hi:[1,0]
    v_pk_mul_f32 v[78:79], v[78:79], v[14:15] op_sel:[0,0] op_sel_hi:[1,0]
    s_bitcmp1_b32 s43, s42
    s_cbranch_scc1 L2_oa125
L2_ob125:
    buffer_load_dwordx4 v[112:115], v3, s[16:19], s40 offen offset:1024 sc1
    v_and_b32 v46, 0x80000000, v27
    v_lshrrev_b32 v47, 14, v25
    v_bitop3_b32 v47, v47, v5, v46 bitop3:0xea
    ds_read_b64 v[106:107], v47
    v_and_b32 v99, 0x40000000, v27
    v_lshrrev_b32 v47, 14, v24
    v_bitop3_b32 v47, v47, v5, v99 bitop3:0xea
    ds_read_b64 v[104:105], v47
    s_waitcnt lgkmcnt(2)
    v_cmp_ne_u64 s[50:51], v[72:73], v[68:69]
    v_cmpx_ne_u64 s[54:55], v[74:75], v[70:71]
    s_and_b64 s[82:83], s[54:55], s[80:81]
    s_cbranch_scc1 L2_c126
L2_d126:
    v_mov_b64 v[84:85], v[70:71]
    v_mov_b32 v7, v95
    v_mov_b64 v[86:87], v[74:75]
    s_or_b64 s[80:81], s[80:81], s[54:55]
    s_mov_b64 exec, s[50:51]
    s_and_b64 s[82:83], s[50:51], s[80:81]
    s_cbranch_scc1 L2_c127
L2_d127:
    v_mov_b64 v[84:85], v[68:69]
    v_mov_b32 v7, v94
    v_mov_b64 v[86:87], v[72:73]
    s_mov_b64 exec, -1
    s_or_b64 s[80:81], s[80:81], s[50:51]
    ds_read_b64 v[70:71], v93 offset:65408
    ds_read_b64 v[68:69], v92 offset:65408
    v_bitop3_b32 v94, v24, v5, v99 bitop3:0xea
    v_bitop3_b32 v95, v25, v5, v46 bitop3:0xea
    v_perm_b32 v15, v25, v26, s47
    v_bitop3_b32 v46, v25, 0.5, -0.5 bitop3:0xa8
    v_perm_b32 v14, v24, v26, s46
    v_bitop3_b32 v47, v24, 0.5, -0.5 bitop3:0xa8
    v_bitop3_b32 v15, v6, v15, v46 bitop3:0xca
    v_bitop3_b32 v14, v6, v14, v47 bitop3:0xca
    s_waitcnt lgkmcnt(1)
    v_mfma_f32_4x4x4_16b_bf16 v[80:83], v[10:11], v[70:71], v[80:83]
    s_waitcnt lgkmcnt(0)
    v_mfma_f32_4x4x4_16b_bf16 v[76:79], v[10:11], v[68:69], v[76:79]
    s_nop 2
    v_cvt_pk_bf16_f32 v80, v80, v81
    v_cvt_pk_bf16_f32 v81, v82, v83
    ds_wrxchg_rtn_b64 v[74:75], v93, v[80:81] offset:65408
    v_cvt_pk_bf16_f32 v76, v76, v77
    v_cvt_pk_bf16_f32 v77, v78, v79
    ds_wrxchg_rtn_b64 v[72:73], v92, v[76:77] offset:65408
    v_and_b32 v88, 0x0fffffff, v41
    v_mov_b32 v27, v41
    buffer_load_dwordx2 v[22:23], v88, s[8:11], 0 offen
    buffer_load_dwordx3 v[24:26], v88, s[8:11], 0 offen offset:8
    v_mfma_f32_4x4x4_16b_bf16 v[80:83], v[8:9], v[106:107], 0
    v_mfma_f32_4x4x4_16b_bf16 v[76:79], v[8:9], v[104:105], 0
    v_cmp_lt_u32 s[84:85], v5, v94
    s_nop 2
    v_pk_mul_f32 v[80:81], v[80:81], v[14:15] op_sel:[0,1] op_sel_hi:[1,1]
    v_pk_mul_f32 v[82:83], v[82:83], v[14:15] op_sel:[0,1] op_sel_hi:[1,1]
    v_pk_mul_f32 v[76:77], v[76:77], v[14:15] op_sel:[0,0] op_sel_hi:[1,0]
    v_pk_mul_f32 v[78:79], v[78:79], v[14:15] op_sel:[0,0] op_sel_hi:[1,0]
    s_waitcnt vmcnt(11)
    s_mov_b64 exec, s[6:7]
    v_lshrrev_b32 v30, 16, v30
    s_mov_b64 exec, -1
    v_and_b32 v46, 0x20000000, v31
    v_lshrrev_b32 v47, 14, v29
    v_bitop3_b32 v47, v47, v5, v46 bitop3:0xea
    ds_read_b64 v[102:103], v47
    v_and_b32 v99, 0x10000000, v31
    v_lshrrev_b32 v47, 14, v28
    v_bitop3_b32 v47, v47, v5, v99 bitop3:0xea
    ds_read_b64 v[100:101], v47
    s_waitcnt lgkmcnt(2)
    v_cmp_ne_u64 s[50:51], v[72:73], v[68:69]
    v_cmpx_ne_u64 s[54:55], v[74:75], v[70:71]
    s_and_b64 s[82:83], s[54:55], s[80:81]
    s_cbranch_scc1 L2_c128
L2_d128:
    v_mov_b64 v[84:85], v[70:71]
    v_mov_b32 v7, v93
    v_mov_b64 v[86:87], v[74:75]
    s_or_b64 s[80:81], s[80:81], s[54:55]
    s_mov_b64 exec, s[50:51]
    s_and_b64 s[82:83], s[50:51], s[80:81]
    s_cbranch_scc1 L2_c129
L2_d129:
    v_mov_b64 v[84:85], v[68:69]
    v_mov_b32 v7, v92
    v_mov_b64 v[86:87], v[72:73]
    s_mov_b64 exec, -1
    s_or_b64 s[80:81], s[80:81], s[50:51]
    s_and_b64 exec, s[84:85], s[80:81]
    v_mfma_f32_4x4x4_16b_bf16 v[76:79], v[12:13], v[84:85], 0
    v_mov_b32 v94, v7
    s_andn2_b64 s[80:81], s[80:81], s[84:85]
    v_mfma_f32_4x4x4_16b_bf16 v[76:79], v[10:11], v[86:87], v[76:79]
    s_mov_b64 exec, -1
    ds_read_b64 v[70:71], v95 offset:65408
    ds_read_b64 v[68:69], v94 offset:65408
    v_bitop3_b32 v92, v28, v5, v99 bitop3:0xea
    v_bitop3_b32 v93, v29, v5, v46 bitop3:0xea
    v_perm_b32 v15, v29, v30, s45
    v_bitop3_b32 v46, v29, 0.5, -0.5 bitop3:0xa8
    v_perm_b32 v14, v28, v30, s44
    v_bitop3_b32 v47, v28, 0.5, -0.5 bitop3:0xa8
    v_bitop3_b32 v15, v6, v15, v46 bitop3:0xca
    v_bitop3_b32 v14, v6, v14, v47 bitop3:0xca
    s_waitcnt lgkmcnt(1)
    v_mfma_f32_4x4x4_16b_bf16 v[80:83], v[10:11], v[70:71], v[80:83]
    s_waitcnt lgkmcnt(0)
    v_mfma_f32_4x4x4_16b_bf16 v[76:79], v[10:11], v[68:69], v[76:79]
    s_nop 2
    v_cvt_pk_bf16_f32 v80, v80, v81
    v_cvt_pk_bf16_f32 v81, v82, v83
    ds_wrxchg_rtn_b64 v[74:75], v95, v[80:81] offset:65408
    v_cvt_pk_bf16_f32 v76, v76, v77
    v_cvt_pk_bf16_f32 v77, v78, v79
    ds_wrxchg_rtn_b64 v[72:73], v94, v[76:77] offset:65408
    s_setprio 0
    v_mfma_f32_4x4x4_16b_bf16 v[80:83], v[8:9], v[102:103], 0
    v_mfma_f32_4x4x4_16b_bf16 v[76:79], v[8:9], v[100:101], 0
    v_cmp_lt_u32 s[48:49], v5, v93
    s_nop 2
    v_pk_mul_f32 v[80:81], v[80:81], v[14:15] op_sel:[0,1] op_sel_hi:[1,1]
    v_pk_mul_f32 v[82:83], v[82:83], v[14:15] op_sel:[0,1] op_sel_hi:[1,1]
    v_pk_mul_f32 v[76:77], v[76:77], v[14:15] op_sel:[0,0] op_sel_hi:[1,0]
    v_pk_mul_f32 v[78:79], v[78:79], v[14:15] op_sel:[0,0] op_sel_hi:[1,0]
    s_add_u32 s40, s40, 0xfff24000
    v_and_b32 v47, 0x0fffffff, v42
    v_mov_b32 v31, v42
    buffer_load_dword v30, v47, s[8:11], 0 offen offset:16
    s_mov_b64 exec, s[6:7]
    v_add_u32 v47, 8, v47
    v_lshrrev_b32 v31, 2, v31
    s_mov_b64 exec, -1
    buffer_load_dwordx2 v[28:29], v47, s[8:11], 0 offen
    s_waitcnt vmcnt(8)
    v_and_b32 v46, 0x80000000, v39
    v_lshrrev_b32 v47, 14, v37
    v_bitop3_b32 v47, v47, v5, v46 bitop3:0xea
    ds_read_b64 v[102:103], v47
    v_and_b32 v99, 0x40000000, v39
    v_lshrrev_b32 v47, 14, v36
    v_bitop3_b32 v47, v47, v5, v99 bitop3:0xea
    ds_read_b64 v[100:101], v47
    v_and_b32 v46, 0x20000000, v39
    v_lshrrev_b32 v47, 14, v35
    v_bitop3_b32 v47, v47, v5, v46 bitop3:0xea
    ds_read_b64 v[106:107], v47
    v_and_b32 v99, 0x10000000, v39
    v_lshrrev_b32 v47, 14, v34
    v_bitop3_b32 v47, v47, v5, v99 bitop3:0xea
    ds_read_b64 v[104:105], v47
    s_waitcnt lgkmcnt(4)
    v_cmp_ne_u64 s[50:51], v[72:73], v[68:69]
    v_cmpx_ne_u64 s[54:55], v[74:75], v[70:71]
    s_and_b64 s[82:83], s[54:55], s[80:81]
    s_cbranch_scc1 L2_c130
L2_d130:
    v_mov_b64 v[84:85], v[70:71]
    v_mov_b32 v7, v95
    v_mov_b64 v[86:87], v[74:75]
    s_or_b64 s[80:81], s[80:81], s[54:55]
    s_mov_b64 exec, s[50:51]
    s_and_b64 s[82:83], s[50:51], s[80:81]
    s_cbranch_scc1 L2_c131
L2_d131:
    v_mov_b64 v[84:85], v[68:69]
    v_mov_b32 v7, v94
    v_mov_b64 v[86:87], v[72:73]
    s_mov_b64 exec, -1
    s_or_b64 s[80:81], s[80:81], s[50:51]
    s_and_b64 exec, s[48:49], s[80:81]
    v_mfma_f32_4x4x4_16b_bf16 v[80:83], v[12:13], v[84:85], 0
    v_mov_b32 v93, v7
    s_andn2_b64 s[80:81], s[80:81], s[48:49]
    v_mfma_f32_4x4x4_16b_bf16 v[80:83], v[10:11], v[86:87], v[80:83]
    s_mov_b64 exec, -1
    ds_read_b64 v[70:71], v93 offset:65408
    ds_read_b64 v[68:69], v92 offset:65408
    v_bitop3_b32 v94, v34, v5, v99 bitop3:0xea
    v_bitop3_b32 v95, v35, v5, v46 bitop3:0xea
    v_perm_b32 v15, v35, v38, s45
    v_bitop3_b32 v46, v35, 0.5, -0.5 bitop3:0xa8
    v_perm_b32 v14, v34, v38, s44
    v_bitop3_b32 v47, v34, 0.5, -0.5 bitop3:0xa8
    v_bitop3_b32 v15, v6, v15, v46 bitop3:0xca
    v_bitop3_b32 v14, v6, v14, v47 bitop3:0xca
    s_waitcnt lgkmcnt(1)
    v_mfma_f32_4x4x4_16b_bf16 v[80:83], v[10:11], v[70:71], v[80:83]
    s_waitcnt lgkmcnt(0)
    v_mfma_f32_4x4x4_16b_bf16 v[76:79], v[10:11], v[68:69], v[76:79]
    s_nop 2
    v_cvt_pk_bf16_f32 v80, v80, v81
    v_cvt_pk_bf16_f32 v81, v82, v83
    ds_wrxchg_rtn_b64 v[74:75], v93, v[80:81] offset:65408
    v_cvt_pk_bf16_f32 v76, v76, v77
    v_cvt_pk_bf16_f32 v77, v78, v79
    ds_wrxchg_rtn_b64 v[72:73], v92, v[76:77] offset:65408
    s_barrier
    s_setprio 3
    s_mov_b32 m0, s100
    s_nop 0
    ds_write_addtid_b32 v124 offset:34816
    ds_write_addtid_b32 v125 offset:35072
    ds_write_addtid_b32 v126 offset:35328
    ds_write_addtid_b32 v127 offset:35584
    ds_write_addtid_b32 v116 offset:32768
    ds_write_addtid_b32 v117 offset:33024
    ds_write_addtid_b32 v118 offset:33280
    ds_write_addtid_b32 v119 offset:33536
    ds_write_addtid_b32 v120 offset:33792
    ds_write_addtid_b32 v121 offset:34048
    ds_write_addtid_b32 v122 offset:34304
    ds_write_addtid_b32 v123 offset:34560
    v_mfma_f32_4x4x4_16b_bf16 v[80:83], v[8:9], v[106:107], 0
    v_mfma_f32_4x4x4_16b_bf16 v[76:79], v[8:9], v[104:105], 0
    s_nop 3
    v_pk_mul_f32 v[80:81], v[80:81], v[14:15] op_sel:[0,1] op_sel_hi:[1,1]
    v_pk_mul_f32 v[82:83], v[82:83], v[14:15] op_sel:[0,1] op_sel_hi:[1,1]
    v_pk_mul_f32 v[76:77], v[76:77], v[14:15] op_sel:[0,0] op_sel_hi:[1,0]
    v_pk_mul_f32 v[78:79], v[78:79], v[14:15] op_sel:[0,0] op_sel_hi:[1,0]
    v_mov_b32 v44, v43
    s_setprio 2
    s_waitcnt lgkmcnt(12)
    v_cmp_ne_u64 s[50:51], v[72:73], v[68:69]
    v_cmpx_ne_u64 s[54:55], v[74:75], v[70:71]
    s_and_b64 s[82:83], s[54:55], s[80:81]
    s_cbranch_scc1 L2_c132
L2_d132:
    v_mov_b64 v[84:85], v[70:71]
    v_mov_b32 v7, v93
    v_mov_b64 v[86:87], v[74:75]
    s_or_b64 s[80:81], s[80:81], s[54:55]
    s_mov_b64 exec, s[50:51]
    s_and_b64 s[82:83], s[50:51], s[80:81]
    s_cbranch_scc1 L2_c133
L2_d133:
    v_mov_b64 v[84:85], v[68:69]
    v_mov_b32 v7, v92
    v_mov_b64 v[86:87], v[72:73]
    s_mov_b64 exec, -1
    s_or_b64 s[80:81], s[80:81], s[50:51]
    ds_read_b64 v[70:71], v95 offset:65408
    ds_read_b64 v[68:69], v94 offset:65408
    v_and_b32 v46, 0x40000000, v39
    v_bitop3_b32 v92, v36, v5, v46 bitop3:0xea
    v_and_b32 v46, 0x80000000, v39
    v_bitop3_b32 v93, v37, v5, v46 bitop3:0xea
    v_perm_b32 v15, v37, v38, s47
    v_bitop3_b32 v46, v37, 0.5, -0.5 bitop3:0xa8
    v_perm_b32 v14, v36, v38, s46
    v_bitop3_b32 v47, v36, 0.5, -0.5 bitop3:0xa8
    v_bitop3_b32 v15, v6, v15, v46 bitop3:0xca
    v_bitop3_b32 v14, v6, v14, v47 bitop3:0xca
    s_setprio 1
    s_waitcnt lgkmcnt(1)
    v_mfma_f32_4x4x4_16b_bf16 v[80:83], v[10:11], v[70:71], v[80:83]
    s_waitcnt lgkmcnt(0)
    v_mfma_f32_4x4x4_16b_bf16 v[76:79], v[10:11], v[68:69], v[76:79]
    s_nop 2
    v_cvt_pk_bf16_f32 v80, v80, v81
    v_cvt_pk_bf16_f32 v81, v82, v83
    ds_wrxchg_rtn_b64 v[74:75], v95, v[80:81] offset:65408
    v_cvt_pk_bf16_f32 v76, v76, v77
    v_cvt_pk_bf16_f32 v77, v78, v79
    ds_wrxchg_rtn_b64 v[72:73], v94, v[76:77] offset:65408
    v_and_b32 v88, 0x0fffffff, v44
    v_mov_b32 v39, v44
    buffer_load_dwordx2 v[34:35], v88, s[8:11], 0 offen
    buffer_load_dwordx3 v[36:38], v88, s[8:11], 0 offen offset:8
    s_setprio 0
    s_waitcnt vmcnt(9)
    s_mov_b32 m0, s38
    s_nop 0
    ds_write_addtid_b32 v108 offset:0
    ds_write_addtid_b32 v109 offset:256
    ds_write_addtid_b32 v110 offset:512
    ds_write_addtid_b32 v111 offset:768
    s_waitcnt vmcnt(6)
    ds_write_addtid_b32 v112 offset:1024
    ds_write_addtid_b32 v113 offset:1280
    ds_write_addtid_b32 v114 offset:1536
    ds_write_addtid_b32 v115 offset:1792
    v_mfma_f32_4x4x4_16b_bf16 v[80:83], v[8:9], v[102:103], 0
    v_mfma_f32_4x4x4_16b_bf16 v[76:79], v[8:9], v[100:101], 0
    v_cmp_lt_u32 s[84:85], v5, v92
    s_nop 2
    v_pk_mul_f32 v[80:81], v[80:81], v[14:15] op_sel:[0,1] op_sel_hi:[1,1]
    v_pk_mul_f32 v[82:83], v[82:83], v[14:15] op_sel:[0,1] op_sel_hi:[1,1]
    v_pk_mul_f32 v[76:77], v[76:77], v[14:15] op_sel:[0,0] op_sel_hi:[1,0]
    v_pk_mul_f32 v[78:79], v[78:79], v[14:15] op_sel:[0,0] op_sel_hi:[1,0]
    s_add_u32 s42, s42, 1
    s_waitcnt lgkmcnt(0)
    s_barrier
    s_bitcmp1_b32 s36, s42
    s_cbranch_scc1 L2_slow
L2_ret7:
    s_setprio 3
    s_bitcmp1_b32 s43, s42
    s_cbranch_scc1 L2_oa134
L2_ob134:
    v_and_b32 v46, 0x20000000, v21
    v_lshrrev_b32 v47, 14, v17
    v_bitop3_b32 v47, v47, v5, v46 bitop3:0xea
    ds_read_b64 v[106:107], v47
    v_and_b32 v99, 0x10000000, v21
    v_lshrrev_b32 v47, 14, v16
    v_bitop3_b32 v47, v47, v5, v99 bitop3:0xea
    ds_read_b64 v[104:105], v47
    v_cmp_ne_u64 s[50:51], v[72:73], v[68:69]
    v_cmpx_ne_u64 s[54:55], v[74:75], v[70:71]
    s_and_b64 s[82:83], s[54:55], s[80:81]
    s_cbranch_scc1 L2_c135
L2_d135:
    v_mov_b64 v[84:85], v[70:71]
    v_mov_b32 v7, v95
    v_mov_b64 v[86:87], v[74:75]
    s_or_b64 s[80:81], s[80:81], s[54:55]
    s_mov_b64 exec, s[50:51]
    s_and_b64 s[82:83], s[50:51], s[80:81]
    s_cbranch_scc1 L2_c136
L2_d136:
    v_mov_b64 v[84:85], v[68:69]
    v_mov_b32 v7, v94
    v_mov_b64 v[86:87], v[72:73]
    s_mov_b64 exec, -1
    s_or_b64 s[80:81], s[80:81], s[50:51]
    s_and_b64 exec, s[84:85], s[80:81]
    v_mfma_f32_4x4x4_16b_bf16 v[76:79], v[12:13], v[84:85], 0
    v_mov_b32 v92, v7
    s_andn2_b64 s[80:81], s[80:81], s[84:85]
    v_mfma_f32_4x4x4_16b_bf16 v[76:79], v[10:11], v[86:87], v[76:79]
    s_mov_b64 exec, -1
    ds_read_b64 v[70:71], v93 offset:65408
    ds_read_b64 v[68:69], v92 offset:65408
    v_bitop3_b32 v94, v16, v5, v99 bitop3:0xea
    v_bitop3_b32 v95, v17, v5, v46 bitop3:0xea
    v_perm_b32 v15, v17, v20, s45
    v_bitop3_b32 v46, v17, 0.5, -0.5 bitop3:0xa8
    v_perm_b32 v14, v16, v20, s44
    v_bitop3_b32 v47, v16, 0.5, -0.5 bitop3:0xa8
    v_bitop3_b32 v15, v6, v15, v46 bitop3:0xca
    v_bitop3_b32 v14, v6, v14, v47 bitop3:0xca
    s_waitcnt lgkmcnt(1)
    v_mfma_f32_4x4x4_16b_bf16 v[80:83], v[10:11], v[70:71], v[80:83]
    s_waitcnt lgkmcnt(0)
    v_mfma_f32_4x4x4_16b_bf16 v[76:79], v[10:11], v[68:69], v[76:79]
    s_nop 2
    v_cvt_pk_bf16_f32 v80, v80, v81
    v_cvt_pk_bf16_f32 v81, v82, v83
    ds_wrxchg_rtn_b64 v[74:75], v93, v[80:81] offset:65408
    v_cvt_pk_bf16_f32 v76, v76, v77
    v_cvt_pk_bf16_f32 v77, v78, v79
    ds_wrxchg_rtn_b64 v[72:73], v92, v[76:77] offset:65408
    v_mfma_f32_4x4x4_16b_bf16 v[80:83], v[8:9], v[106:107], 0
    v_mfma_f32_4x4x4_16b_bf16 v[76:79], v[8:9], v[104:105], 0
    v_cmp_lt_u32 s[84:85], v5, v94
    s_nop 2
    v_pk_mul_f32 v[80:81], v[80:81], v[14:15] op_sel:[0,1] op_sel_hi:[1,1]
    v_pk_mul_f32 v[82:83], v[82:83], v[14:15] op_sel:[0,1] op_sel_hi:[1,1]
    v_pk_mul_f32 v[76:77], v[76:77], v[14:15] op_sel:[0,0] op_sel_hi:[1,0]
    v_pk_mul_f32 v[78:79], v[78:79], v[14:15] op_sel:[0,0] op_sel_hi:[1,0]
    v_and_b32 v46, 0x80000000, v21
    v_lshrrev_b32 v47, 14, v19
    v_bitop3_b32 v47, v47, v5, v46 bitop3:0xea
    ds_read_b64 v[102:103], v47
    v_and_b32 v99, 0x40000000, v21
    v_lshrrev_b32 v47, 14, v18
    v_bitop3_b32 v47, v47, v5, v99 bitop3:0xea
    ds_read_b64 v[100:101], v47
    s_waitcnt lgkmcnt(2)
    v_cmp_ne_u64 s[50:51], v[72:73], v[68:69]
    v_cmpx_ne_u64 s[54:55], v[74:75], v[70:71]
    s_and_b64 s[82:83], s[54:55], s[80:81]
    s_cbranch_scc1 L2_c137
L2_d137:
    v_mov_b64 v[84:85], v[70:71]
    v_mov_b32 v7, v93
    v_mov_b64 v[86:87], v[74:75]
    s_or_b64 s[80:81], s[80:81], s[54:55]
    s_mov_b64 exec, s[50:51]
    s_and_b64 s[82:83], s[50:51], s[80:81]
    s_cbranch_scc1 L2_c138
L2_d138:
    v_mov_b64 v[84:85], v[68:69]
    v_mov_b32 v7, v92
    v_mov_b64 v[86:87], v[72:73]
    s_mov_b64 exec, -1
    s_or_b64 s[80:81], s[80:81], s[50:51]
    s_and_b64 exec, s[84:85], s[80:81]
    v_mfma_f32_4x4x4_16b_bf16 v[76:79], v[12:13], v[84:85], 0
    v_mov_b32 v94, v7
    s_andn2_b64 s[80:81], s[80:81], s[84:85]
    v_mfma_f32_4x4x4_16b_bf16 v[76:79], v[10:11], v[86:87], v[76:79]
    s_mov_b64 exec, -1
    ds_read_b64 v[70:71], v95 offset:65408
    ds_read_b64 v[68:69], v94 offset:65408
    v_bitop3_b32 v92, v18, v5, v99 bitop3:0xea
    v_bitop3_b32 v93, v19, v5, v46 bitop3:0xea
    v_perm_b32 v15, v19, v20, s47
    v_bitop3_b32 v46, v19, 0.5, -0.5 bitop3:0xa8
    v_perm_b32 v14, v18, v20, s46
    v_bitop3_b32 v47, v18, 0.5, -0.5 bitop3:0xa8
    v_bitop3_b32 v15, v6, v15, v46 bitop3:0xca
    v_bitop3_b32 v14, v6, v14, v47 bitop3:0xca
    s_waitcnt lgkmcnt(1)
    v_mfma_f32_4x4x4_16b_bf16 v[80:83], v[10:11], v[70:71], v[80:83]
    s_waitcnt lgkmcnt(0)
    v_mfma_f32_4x4x4_16b_bf16 v[76:79], v[10:11], v[68:69], v[76:79]
    s_nop 2
    v_cvt_pk_bf16_f32 v80, v80, v81
    v_cvt_pk_bf16_f32 v81, v82, v83
    ds_wrxchg_rtn_b64 v[74:75], v95, v[80:81] offset:65408
    v_cvt_pk_bf16_f32 v76, v76, v77
    v_cvt_pk_bf16_f32 v77, v78, v79
    ds_wrxchg_rtn_b64 v[72:73], v94, v[76:77] offset:65408
    s_setprio 2
    v_mfma_f32_4x4x4_16b_bf16 v[80:83], v[8:9], v[102:103], 0
    v_mfma_f32_4x4x4_16b_bf16 v[76:79], v[8:9], v[100:101], 0
    v_cmp_lt_u32 s[48:49], v5, v93
    s_nop 2
    v_pk_mul_f32 v[80:81], v[80:81], v[14:15] op_sel:[0,1] op_sel_hi:[1,1]
    v_pk_mul_f32 v[82:83], v[82:83], v[14:15] op_sel:[0,1] op_sel_hi:[1,1]
    v_pk_mul_f32 v[76:77], v[76:77], v[14:15] op_sel:[0,0] op_sel_hi:[1,0]
    v_pk_mul_f32 v[78:79], v[78:79], v[14:15] op_sel:[0,0] op_sel_hi:[1,0]
    s_waitcnt vmcnt(4)
    v_and_b32 v46, 0x20000000, v27
    v_lshrrev_b32 v47, 14, v23
    v_bitop3_b32 v47, v47, v5, v46 bitop3:0xea
    ds_read_b64 v[106:107], v47
    v_and_b32 v99, 0x10000000, v27
    v_lshrrev_b32 v47, 14, v22
    v_bitop3_b32 v47, v47, v5, v99 bitop3:0xea
    ds_read_b64 v[104:105], v47
    s_waitcnt lgkmcnt(2)
    v_cmp_ne_u64 s[50:51], v[72:73], v[68:69]
    v_cmpx_ne_u64 s[54:55], v[74:75], v[70:71]
    s_and_b64 s[82:83], s[54:55], s[80:81]
    s_cbranch_scc1 L2_c139
L2_d139:
    v_mov_b64 v[84:85], v[70:71]
    v_mov_b32 v7, v95
    v_mov_b64 v[86:87], v[74:75]
    s_or_b64 s[80:81], s[80:81], s[54:55]
    s_mov_b64 exec, s[50:51]
    s_and_b64 s[82:83], s[50:51], s[80:81]
    s_cbranch_scc1 L2_c140
L2_d140:
    v_mov_b64 v[84:85], v[68:69]
    v_mov_b32 v7, v94
    v_mov_b64 v[86:87], v[72:73]
    s_mov_b64 exec, -1
    s_or_b64 s[80:81], s[80:81], s[50:51]
    s_and_b64 exec, s[48:49], s[80:81]
    v_mfma_f32_4x4x4_16b_bf16 v[80:83], v[12:13], v[84:85], 0
    v_mov_b32 v93, v7
    s_andn2_b64 s[80:81], s[80:81], s[48:49]
    v_mfma_f32_4x4x4_16b_bf16 v[80:83], v[10:11], v[86:87], v[80:83]
    s_mov_b64 exec, -1
    ds_read_b64 v[70:71], v93 offset:65408
    ds_read_b64 v[68:69], v92 offset:65408
    v_bitop3_b32 v94, v22, v5, v99 bitop3:0xea
    v_bitop3_b32 v95, v23, v5, v46 bitop3:0xea
    v_perm_b32 v15, v23, v26, s45
    v_bitop3_b32 v46, v23, 0.5, -0.5 bitop3:0xa8
    v_perm_b32 v14, v22, v26, s44
    v_bitop3_b32 v47, v22, 0.5, -0.5 bitop3:0xa8
    v_bitop3_b32 v15, v6, v15, v46 bitop3:0xca
    v_bitop3_b32 v14, v6, v14, v47 bitop3:0xca
    s_waitcnt lgkmcnt(1)
    v_mfma_f32_4x4x4_16b_bf16 v[80:83], v[10:11], v[70:71], v[80:83]
    s_waitcnt lgkmcnt(0)
    v_mfma_f32_4x4x4_16b_bf16 v[76:79], v[10:11], v[68:69], v[76:79]
    s_nop 2
    v_cvt_pk_bf16_f32 v80, v80, v81
    v_cvt_pk_bf16_f32 v81, v82, v83
    ds_wrxchg_rtn_b64 v[74:75], v93, v[80:81] offset:65408
    v_cvt_pk_bf16_f32 v76, v76, v77
    v_cvt_pk_bf16_f32 v77, v78, v79
    ds_wrxchg_rtn_b64 v[72:73], v92, v[76:77] offset:65408
    s_setprio 1
    v_mfma_f32_4x4x4_16b_bf16 v[80:83], v[8:9], v[106:107], 0
    v_mfma_f32_4x4x4_16b_bf16 v[76:79], v[8:9], v[104:105], 0
    s_nop 3
    v_pk_mul_f32 v[80:81], v[80:81], v[14:15] op_sel:[0,1] op_sel_hi:[1,1]
    v_pk_mul_f32 v[82:83], v[82:83], v[14:15] op_sel:[0,1] op_sel_hi:[1,1]
    v_pk_mul_f32 v[76:77], v[76:77], v[14:15] op_sel:[0,0] op_sel_hi:[1,0]
    v_pk_mul_f32 v[78:79], v[78:79], v[14:15] op_sel:[0,0] op_sel_hi:[1,0]
    s_bitcmp1_b32 s43, s42
    s_cbranch_scc1 L2_oa141
L2_ob141:
    v_and_b32 v46, 0x80000000, v27
    v_lshrrev_b32 v47, 14, v25
    v_bitop3_b32 v47, v47, v5, v46 bitop3:0xea
    ds_read_b64 v[102:103], v47
    v_and_b32 v99, 0x40000000, v27
    v_lshrrev_b32 v47, 14, v24
    v_bitop3_b32 v47, v47, v5, v99 bitop3:0xea
    ds_read_b64 v[100:101], v47
    s_waitcnt lgkmcnt(2)
    v_cmp_ne_u64 s[50:51], v[72:73], v[68:69]
    v_cmpx_ne_u64 s[54:55], v[74:75], v[70:71]
    s_and_b64 s[82:83], s[54:55], s[80:81]
    s_cbranch_scc1 L2_c142
L2_d142:
    v_mov_b64 v[84:85], v[70:71]
    v_mov_b32 v7, v93
    v_mov_b64 v[86:87], v[74:75]
    s_or_b64 s[80:81], s[80:81], s[54:55]
    s_mov_b64 exec, s[50:51]
    s_and_b64 s[82:83], s[50:51], s[80:81]
    s_cbranch_scc1 L2_c143
L2_d143:
    v_mov_b64 v[84:85], v[68:69]
    v_mov_b32 v7, v92
    v_mov_b64 v[86:87], v[72:73]
    s_mov_b64 exec, -1
    s_or_b64 s[80:81], s[80:81], s[50:51]
    ds_read_b64 v[70:71], v95 offset:65408
    ds_read_b64 v[68:69], v94 offset:65408
    v_bitop3_b32 v92, v24, v5, v99 bitop3:0xea
    v_bitop3_b32 v93, v25, v5, v46 bitop3:0xea
    v_perm_b32 v15, v25, v26, s47
    v_bitop3_b32 v46, v25, 0.5, -0.5 bitop3:0xa8
    v_perm_b32 v14, v24, v26, s46
    v_bitop3_b32 v47, v24, 0.5, -0.5 bitop3:0xa8
    v_bitop3_b32 v15, v6, v15, v46 bitop3:0xca
    v_bitop3_b32 v14, v6, v14, v47 bitop3:0xca
    s_waitcnt lgkmcnt(1)
    v_mfma_f32_4x4x4_16b_bf16 v[80:83], v[10:11], v[70:71], v[80:83]
    s_waitcnt lgkmcnt(0)
    v_mfma_f32_4x4x4_16b_bf16 v[76:79], v[10:11], v[68:69], v[76:79]
    s_nop 2
    v_cvt_pk_bf16_f32 v80, v80, v81
    v_cvt_pk_bf16_f32 v81, v82, v83
    ds_wrxchg_rtn_b64 v[74:75], v95, v[80:81] offset:65408
    v_cvt_pk_bf16_f32 v76, v76, v77
    v_cvt_pk_bf16_f32 v77, v78, v79
    ds_wrxchg_rtn_b64 v[72:73], v94, v[76:77] offset:65408
    v_mfma_f32_4x4x4_16b_bf16 v[80:83], v[8:9], v[102:103], 0
    v_mfma_f32_4x4x4_16b_bf16 v[76:79], v[8:9], v[100:101], 0
    v_cmp_lt_u32 s[84:85], v5, v92
    s_nop 2
    v_pk_mul_f32 v[80:81], v[80:81], v[14:15] op_sel:[0,1] op_sel_hi:[1,1]
    v_pk_mul_f32 v[82:83], v[82:83], v[14:15] op_sel:[0,1] op_sel_hi:[1,1]
    v_pk_mul_f32 v[76:77], v[76:77], v[14:15] op_sel:[0,0] op_sel_hi:[1,0]
    v_pk_mul_f32 v[78:79], v[78:79], v[14:15] op_sel:[0,0] op_sel_hi:[1,0]
    s_lshl_b32 s3, s32, 12
    v_subrev_u32 v122, s3, v3
    s_mul_i32 s3, s33, 20000
    v_add_u32 v118, s3, v122
    v_add_u32 v119, 0x4000, v118
    s_lshl_b32 s3, s34, 7
    v_lshrrev_b32 v123, 7, v118
    v_and_b32 v120, 0x70, v118
    v_lshl_add_u32 v120, v123, 13, v120
    v_add_u32 v120, s3, v120
    v_lshrrev_b32 v123, 7, v119
    v_and_b32 v121, 0x70, v119
    v_lshl_add_u32 v121, v123, 13, v121
    v_add_u32 v121, s3, v121
    v_cmp_le_u32 vcc, 3616, v122
    s_mov_b64 exec, vcc
    v_mov_b32 v119, 2.0
    v_mov_b32 v121, 2.0
    s_mov_b64 exec, -1
    v_and_b32 v123, 0x30, v122
    v_lshlrev_b32 v123, 2, v123
    buffer_load_dwordx4 v[48:51], v123, s[24:27], 0 offen
    buffer_load_dwordx4 v[52:55], v123, s[24:27], 0 offen offset:16
    buffer_load_dwordx2 v[56:57], v123, s[24:27], 0 offen offset:32
    s_mov_b32 s12, s4
    s_mov_b32 s13, s5
    s_mov_b32 s14, 0x138800
    s_mov_b32 s15, 0x20000
    s_mov_b32 s16, s28
    s_mov_b32 s17, s29
    s_mov_b32 s18, 0x4e2000
    s_mov_b32 s19, 0x20000
    v_lshrrev_b32 v123, 2, v120
    buffer_load_dword v116, v123, s[12:15], 0 offen
    buffer_load_dwordx4 v[108:111], v120, s[16:19], 0 offen
    v_lshrrev_b32 v123, 2, v121
    buffer_load_dword v117, v123, s[12:15], 0 offen
    buffer_load_dwordx4 v[112:115], v121, s[16:19], 0 offen
    s_waitcnt vmcnt(9)
    s_mov_b64 exec, s[6:7]
    v_lshrrev_b32 v30, 16, v30
    s_mov_b64 exec, -1
    v_and_b32 v46, 0x20000000, v31
    v_lshrrev_b32 v47, 14, v29
    v_bitop3_b32 v47, v47, v5, v46 bitop3:0xea
    ds_read_b64 v[106:107], v47
    v_and_b32 v99, 0x10000000, v31
    v_lshrrev_b32 v47, 14, v28
    v_bitop3_b32 v47, v47, v5, v99 bitop3:0xea
    ds_read_b64 v[104:105], v47
    s_waitcnt lgkmcnt(2)
    v_cmp_ne_u64 s[50:51], v[72:73], v[68:69]
    v_cmpx_ne_u64 s[54:55], v[74:75], v[70:71]
    s_and_b64 s[82:83], s[54:55], s[80:81]
    s_cbranch_scc1 L2_c144
L2_d144:
    v_mov_b64 v[84:85], v[70:71]
    v_mov_b32 v7, v95
    v_mov_b64 v[86:87], v[74:75]
    s_or_b64 s[80:81], s[80:81], s[54:55]
    s_mov_b64 exec, s[50:51]
    s_and_b64 s[82:83], s[50:51], s[80:81]
    s_cbranch_scc1 L2_c145
L2_d145:
    v_mov_b64 v[84:85], v[68:69]
    v_mov_b32 v7, v94
    v_mov_b64 v[86:87], v[72:73]
    s_mov_b64 exec, -1
    s_or_b64 s[80:81], s[80:81], s[50:51]
    s_and_b64 exec, s[84:85], s[80:81]
    v_mfma_f32_4x4x4_16b_bf16 v[76:79], v[12:13], v[84:85], 0
    v_mov_b32 v92, v7
    s_andn2_b64 s[80:81], s[80:81], s[84:85]
    v_mfma_f32_4x4x4_16b_bf16 v[76:79], v[10:11], v[86:87], v[76:79]
    s_mov_b64 exec, -1
    ds_read_b64 v[70:71], v93 offset:65408
    ds_read_b64 v[68:69], v92 offset:65408
    v_bitop3_b32 v94, v28, v5, v99 bitop3:0xea
    v_bitop3_b32 v95, v29, v5, v46 bitop3:0xea
    v_perm_b32 v15, v29, v30, s45
    v_bitop3_b32 v46, v29, 0.5, -0.5 bitop3:0xa8
    v_perm_b32 v14, v28, v30, s44
    v_bitop3_b32 v47, v28, 0.5, -0.5 bitop3:0xa8
    v_bitop3_b32 v15, v6, v15, v46 bitop3:0xca
    v_bitop3_b32 v14, v6, v14, v47 bitop3:0xca
    s_waitcnt lgkmcnt(1)
    v_mfma_f32_4x4x4_16b_bf16 v[80:83], v[10:11], v[70:71], v[80:83]
    s_waitcnt lgkmcnt(0)
    v_mfma_f32_4x4x4_16b_bf16 v[76:79], v[10:11], v[68:69], v[76:79]
    s_nop 2
    v_cvt_pk_bf16_f32 v80, v80, v81
    v_cvt_pk_bf16_f32 v81, v82, v83
    ds_wrxchg_rtn_b64 v[74:75], v93, v[80:81] offset:65408
    v_cvt_pk_bf16_f32 v76, v76, v77
    v_cvt_pk_bf16_f32 v77, v78, v79
    ds_wrxchg_rtn_b64 v[72:73], v92, v[76:77] offset:65408
    s_setprio 0
    v_mfma_f32_4x4x4_16b_bf16 v[80:83], v[8:9], v[106:107], 0
    v_mfma_f32_4x4x4_16b_bf16 v[76:79], v[8:9], v[104:105], 0
    v_cmp_lt_u32 s[48:49], v5, v95
    s_nop 2
    v_pk_mul_f32 v[80:81], v[80:81], v[14:15] op_sel:[0,1] op_sel_hi:[1,1]
    v_pk_mul_f32 v[82:83], v[82:83], v[14:15] op_sel:[0,1] op_sel_hi:[1,1]
    v_pk_mul_f32 v[76:77], v[76:77], v[14:15] op_sel:[0,0] op_sel_hi:[1,0]
    v_pk_mul_f32 v[78:79], v[78:79], v[14:15] op_sel:[0,0] op_sel_hi:[1,0]
    s_waitcnt vmcnt(7)
    v_and_b32 v46, 0x80000000, v39
    v_lshrrev_b32 v47, 14, v37
    v_bitop3_b32 v47, v47, v5, v46 bitop3:0xea
    ds_read_b64 v[106:107], v47
    v_and_b32 v99, 0x40000000, v39
    v_lshrrev_b32 v47, 14, v36
    v_bitop3_b32 v47, v47, v5, v99 bitop3:0xea
    ds_read_b64 v[104:105], v47
    v_and_b32 v46, 0x20000000, v39
    v_lshrrev_b32 v47, 14, v35
    v_bitop3_b32 v47, v47, v5, v46 bitop3:0xea
    ds_read_b64 v[102:103], v47
    v_and_b32 v99, 0x10000000, v39
    v_lshrrev_b32 v47, 14, v34
    v_bitop3_b32 v47, v47, v5, v99 bitop3:0xea
    ds_read_b64 v[100:101], v47
    s_waitcnt lgkmcnt(4)
    v_cmp_ne_u64 s[50:51], v[72:73], v[68:69]
    v_cmpx_ne_u64 s[54:55], v[74:75], v[70:71]
    s_and_b64 s[82:83], s[54:55], s[80:81]
    s_cbranch_scc1 L2_c146
L2_d146:
    v_mov_b64 v[84:85], v[70:71]
    v_mov_b32 v7, v93
    v_mov_b64 v[86:87], v[74:75]
    s_or_b64 s[80:81], s[80:81], s[54:55]
    s_mov_b64 exec, s[50:51]
    s_and_b64 s[82:83], s[50:51], s[80:81]
    s_cbranch_scc1 L2_c147
L2_d147:
    v_mov_b64 v[84:85], v[68:69]
    v_mov_b32 v7, v92
    v_mov_b64 v[86:87], v[72:73]
    s_mov_b64 exec, -1
    s_or_b64 s[80:81], s[80:81], s[50:51]
    s_and_b64 exec, s[48:49], s[80:81]
    v_mfma_f32_4x4x4_16b_bf16 v[80:83], v[12:13], v[84:85], 0
    v_mov_b32 v95, v7
    s_andn2_b64 s[80:81], s[80:81], s[48:49]
    v_mfma_f32_4x4x4_16b_bf16 v[80:83], v[10:11], v[86:87], v[80:83]
    s_mov_b64 exec, -1
    ds_read_b64 v[70:71], v95 offset:65408
    ds_read_b64 v[68:69], v94 offset:65408
    v_bitop3_b32 v92, v34, v5, v99 bitop3:0xea
    v_bitop3_b32 v93, v35, v5, v46 bitop3:0xea
    v_perm_b32 v15, v35, v38, s45
    v_bitop3_b32 v46, v35, 0.5, -0.5 bitop3:0xa8
    v_perm_b32 v14, v34, v38, s44
    v_bitop3_b32 v47, v34, 0.5, -0.5 bitop3:0xa8
    v_bitop3_b32 v15, v6, v15, v46 bitop3:0xca
    v_bitop3_b32 v14, v6, v14, v47 bitop3:0xca
    s_waitcnt lgkmcnt(1)
    v_mfma_f32_4x4x4_16b_bf16 v[80:83], v[10:11], v[70:71], v[80:83]
    s_waitcnt lgkmcnt(0)
    v_mfma_f32_4x4x4_16b_bf16 v[76:79], v[10:11], v[68:69], v[76:79]
    s_nop 2
    v_cvt_pk_bf16_f32 v80, v80, v81
    v_cvt_pk_bf16_f32 v81, v82, v83
    ds_wrxchg_rtn_b64 v[74:75], v95, v[80:81] offset:65408
    v_cvt_pk_bf16_f32 v76, v76, v77
    v_cvt_pk_bf16_f32 v77, v78, v79
    ds_wrxchg_rtn_b64 v[72:73], v94, v[76:77] offset:65408
    v_mfma_f32_4x4x4_16b_bf16 v[80:83], v[8:9], v[102:103], 0
    v_mfma_f32_4x4x4_16b_bf16 v[76:79], v[8:9], v[100:101], 0
    s_nop 3
    v_pk_mul_f32 v[80:81], v[80:81], v[14:15] op_sel:[0,1] op_sel_hi:[1,1]
    v_pk_mul_f32 v[82:83], v[82:83], v[14:15] op_sel:[0,1] op_sel_hi:[1,1]
    v_pk_mul_f32 v[76:77], v[76:77], v[14:15] op_sel:[0,0] op_sel_hi:[1,0]
    v_pk_mul_f32 v[78:79], v[78:79], v[14:15] op_sel:[0,0] op_sel_hi:[1,0]
    s_waitcnt lgkmcnt(0)
    v_cmp_ne_u64 s[50:51], v[72:73], v[68:69]
    v_cmpx_ne_u64 s[54:55], v[74:75], v[70:71]
    s_and_b64 s[82:83], s[54:55], s[80:81]
    s_cbranch_scc1 L2_c148
L2_d148:
    v_mov_b64 v[84:85], v[70:71]
    v_mov_b32 v7, v95
    v_mov_b64 v[86:87], v[74:75]
    s_or_b64 s[80:81], s[80:81], s[54:55]
    s_mov_b64 exec, s[50:51]
    s_and_b64 s[82:83], s[50:51], s[80:81]
    s_cbranch_scc1 L2_c149
L2_d149:
    v_mov_b64 v[84:85], v[68:69]
    v_mov_b32 v7, v94
    v_mov_b64 v[86:87], v[72:73]
    s_mov_b64 exec, -1
    s_or_b64 s[80:81], s[80:81], s[50:51]
    ds_read_b64 v[70:71], v93 offset:65408
    ds_read_b64 v[68:69], v92 offset:65408
    v_and_b32 v46, 0x40000000, v39
    v_bitop3_b32 v94, v36, v5, v46 bitop3:0xea
    v_and_b32 v46, 0x80000000, v39
    v_bitop3_b32 v95, v37, v5, v46 bitop3:0xea
    v_perm_b32 v15, v37, v38, s47
    v_bitop3_b32 v46, v37, 0.5, -0.5 bitop3:0xa8
    v_perm_b32 v14, v36, v38, s46
    v_bitop3_b32 v47, v36, 0.5, -0.5 bitop3:0xa8
    v_bitop3_b32 v15, v6, v15, v46 bitop3:0xca
    v_bitop3_b32 v14, v6, v14, v47 bitop3:0xca
    s_waitcnt lgkmcnt(1)
    v_mfma_f32_4x4x4_16b_bf16 v[80:83], v[10:11], v[70:71], v[80:83]
    s_waitcnt lgkmcnt(0)
    v_mfma_f32_4x4x4_16b_bf16 v[76:79], v[10:11], v[68:69], v[76:79]
    s_nop 2
    v_cvt_pk_bf16_f32 v80, v80, v81
    v_cvt_pk_bf16_f32 v81, v82, v83
    ds_wrxchg_rtn_b64 v[74:75], v93, v[80:81] offset:65408
    v_cvt_pk_bf16_f32 v76, v76, v77
    v_cvt_pk_bf16_f32 v77, v78, v79
    ds_wrxchg_rtn_b64 v[72:73], v92, v[76:77] offset:65408
    v_mfma_f32_4x4x4_16b_bf16 v[80:83], v[8:9], v[106:107], 0
    v_mfma_f32_4x4x4_16b_bf16 v[76:79], v[8:9], v[104:105], 0
    v_cmp_lt_u32 s[84:85], v5, v94
    s_nop 2
    v_pk_mul_f32 v[80:81], v[80:81], v[14:15] op_sel:[0,1] op_sel_hi:[1,1]
    v_pk_mul_f32 v[82:83], v[82:83], v[14:15] op_sel:[0,1] op_sel_hi:[1,1]
    v_pk_mul_f32 v[76:77], v[76:77], v[14:15] op_sel:[0,0] op_sel_hi:[1,0]
    v_pk_mul_f32 v[78:79], v[78:79], v[14:15] op_sel:[0,0] op_sel_hi:[1,0]
    s_waitcnt lgkmcnt(0)
    v_cmp_ne_u64 s[50:51], v[72:73], v[68:69]
    v_cmpx_ne_u64 s[54:55], v[74:75], v[70:71]
    s_and_b64 s[82:83], s[54:55], s[80:81]
    s_cbranch_scc1 L2_c150
L2_d150:
    v_mov_b64 v[84:85], v[70:71]
    v_mov_b32 v7, v93
    v_mov_b64 v[86:87], v[74:75]
    s_or_b64 s[80:81], s[80:81], s[54:55]
    s_mov_b64 exec, s[50:51]
    s_and_b64 s[82:83], s[50:51], s[80:81]
    s_cbranch_scc1 L2_c151
L2_d151:
    v_mov_b64 v[84:85], v[68:69]
    v_mov_b32 v7, v92
    v_mov_b64 v[86:87], v[72:73]
    s_mov_b64 exec, -1
    s_or_b64 s[80:81], s[80:81], s[50:51]
    s_and_b64 exec, s[84:85], s[80:81]
    v_mfma_f32_4x4x4_16b_bf16 v[76:79], v[12:13], v[84:85], 0
    v_mov_b32 v94, v7
    s_andn2_b64 s[80:81], s[80:81], s[84:85]
    v_mfma_f32_4x4x4_16b_bf16 v[76:79], v[10:11], v[86:87], v[76:79]
    s_mov_b64 exec, -1
    ds_read_b64 v[70:71], v95 offset:65408
    ds_read_b64 v[68:69], v94 offset:65408
    s_waitcnt lgkmcnt(1)
    v_mfma_f32_4x4x4_16b_bf16 v[80:83], v[10:11], v[70:71], v[80:83]
    s_waitcnt lgkmcnt(0)
    v_mfma_f32_4x4x4_16b_bf16 v[76:79], v[10:11], v[68:69], v[76:79]
    s_nop 2
    v_cvt_pk_bf16_f32 v80, v80, v81
    v_cvt_pk_bf16_f32 v81, v82, v83
    ds_wrxchg_rtn_b64 v[74:75], v95, v[80:81] offset:65408
    v_cvt_pk_bf16_f32 v76, v76, v77
    v_cvt_pk_bf16_f32 v77, v78, v79
    ds_wrxchg_rtn_b64 v[72:73], v94, v[76:77] offset:65408
    s_waitcnt lgkmcnt(0)
    v_cmpx_ne_u64 vcc, v[74:75], v[70:71]
    s_and_b64 s[82:83], vcc, s[80:81]
    s_cbranch_scc1 L2_c152
L2_d152:
    v_mov_b64 v[84:85], v[70:71]
    v_mov_b32 v7, v95
    v_mov_b64 v[86:87], v[74:75]
    s_mov_b64 exec, -1
    s_or_b64 s[80:81], s[80:81], vcc
    v_cmpx_ne_u64 vcc, v[72:73], v[68:69]
    s_and_b64 s[82:83], vcc, s[80:81]
    s_cbranch_scc1 L2_c153
L2_d153:
    v_mov_b64 v[84:85], v[68:69]
    v_mov_b32 v7, v94
    v_mov_b64 v[86:87], v[72:73]
    s_mov_b64 exec, -1
    s_or_b64 s[80:81], s[80:81], vcc
    s_mov_b64 exec, s[80:81]
    ds_read_b64 v[68:69], v7 offset:65408
    v_mfma_f32_4x4x4_16b_bf16 v[76:79], v[12:13], v[84:85], 0
    s_nop 1
    v_mfma_f32_4x4x4_16b_bf16 v[76:79], v[10:11], v[86:87], v[76:79]
    s_waitcnt lgkmcnt(0)
    s_nop 0
    v_mfma_f32_4x4x4_16b_bf16 v[76:79], v[10:11], v[68:69], v[76:79]
    v_mov_b64 v[84:85], v[68:69]
    s_nop 3
    v_cvt_pk_bf16_f32 v76, v76, v77
    v_cvt_pk_bf16_f32 v77, v78, v79
    ds_wrxchg_rtn_b64 v[86:87], v7, v[76:77] offset:65408
    s_waitcnt lgkmcnt(0)
    v_cmp_ne_u64 s[80:81], v[86:87], v[84:85]
    s_mov_b64 exec, s[80:81]
    s_nop 1
    v_mfma_f32_4x4x4_16b_bf16 v[88:91], v[12:13], v[84:85], 0
    s_nop 1
    v_mfma_f32_4x4x4_16b_bf16 v[88:91], v[10:11], v[86:87], v[88:91]
    s_nop 4
    v_cvt_pk_bf16_f32 v88, v88, v89
    v_cvt_pk_bf16_f32 v89, v90, v91
    ds_pk_add_bf16 v7, v88 offset:65408
    ds_pk_add_bf16 v7, v89 offset:65412
    s_mov_b64 exec, -1
    s_load_dwordx2 s[4:5], s[0:1], 88
    v_add_u32 v123, 0x4000, v122
    s_lshl_b32 s50, s96, 16
    s_and_b32 s51, s96, 0xffff0000
    s_lshl_b32 s52, s97, 16
    s_and_b32 s53, s97, 0xffff0000
    s_lshl_b32 s54, s98, 16
    s_and_b32 s55, s98, 0xffff0000
    s_lshl_b32 s56, s99, 16
    s_and_b32 s57, s99, 0xffff0000
    s_waitcnt vmcnt(0) lgkmcnt(0)
    s_barrier
    s_add_u32 s8, s30, 0xec46000
    s_addc_u32 s9, s31, 0
    s_mov_b32 s10, 0x8000
    s_mov_b32 s11, 0x20000
    s_mov_b32 s12, s4
    s_mov_b32 s13, s5
    s_mov_b32 s14, 0x4e2000
    s_mov_b32 s15, 0x20000
    s_add_u32 s20, s30, 0xd845000
    s_addc_u32 s21, s31, 0
    s_mov_b32 s22, 0x1400000
    s_mov_b32 s23, 0x20000
    s_lshl2_add_u32 s4, s34, s33
    s_mul_i32 s4, s4, 81920
    s_add_u32 s3, s33, 1
    s_and_b32 s3, s3, 3
    s_mul_i32 s36, s3, 20000
    s_add_u32 s36, s36, 81920
    s_mul_i32 s40, s3, 20480
    s_add_u32 s40, s40, s4
    s_lshl2_add_u32 s3, s34, s3
    s_mul_i32 s3, s3, 81920
    s_mul_i32 s44, s33, 20480
    s_add_u32 s44, s44, s3
    s_add_u32 s3, s33, 2
    s_and_b32 s3, s3, 3
    s_mul_i32 s37, s3, 20000
    s_add_u32 s37, s37, 81920
    s_mul_i32 s41, s3, 20480
    s_add_u32 s41, s41, s4
    s_lshl2_add_u32 s3, s34, s3
    s_mul_i32 s3, s3, 81920
    s_mul_i32 s45, s33, 20480
    s_add_u32 s45, s45, s3
    s_add_u32 s3, s33, 3
    s_and_b32 s3, s3, 3
    s_mul_i32 s38, s3, 20000
    s_add_u32 s38, s38, 81920
    s_mul_i32 s42, s3, 20480
    s_add_u32 s42, s42, s4
    s_lshl2_add_u32 s3, s34, s3
    s_mul_i32 s3, s3, 81920
    s_mul_i32 s46, s33, 20480
    s_add_u32 s46, s46, s3
    v_add_u32 v104, s36, v122
    ds_read_b128 v[16:19], v104
    v_add_u32 v104, s37, v122
    ds_read_b128 v[20:23], v104
    v_add_u32 v104, s38, v122
    ds_read_b128 v[24:27], v104
    s_waitcnt lgkmcnt(2)
    buffer_store_dwordx4 v[16:19], v122, s[20:23], s40 offen sc1
    s_waitcnt lgkmcnt(1)
    buffer_store_dwordx4 v[20:23], v122, s[20:23], s41 offen sc1
    s_waitcnt lgkmcnt(0)
    buffer_store_dwordx4 v[24:27], v122, s[20:23], s42 offen sc1
    s_cmp_ge_u32 s32, 4
    s_cbranch_scc1 L2_g0
    v_add_u32 v104, s36, v123
    ds_read_b128 v[36:39], v104
    v_add_u32 v104, s37, v123
    ds_read_b128 v[40:43], v104
    v_add_u32 v104, s38, v123
    ds_read_b128 v[44:47], v104
    s_waitcnt lgkmcnt(2)
    buffer_store_dwordx4 v[36:39], v123, s[20:23], s40 offen sc1
    s_waitcnt lgkmcnt(1)
    buffer_store_dwordx4 v[40:43], v123, s[20:23], s41 offen sc1
    s_waitcnt lgkmcnt(0)
    buffer_store_dwordx4 v[44:47], v123, s[20:23], s42 offen sc1
L2_g0:
    v_lshlrev_b32 v80, 16, v116
    v_subrev_f32 v60, s50, v80
    v_subrev_f32 v61, s51, v80
    v_subrev_f32 v62, s52, v80
    v_subrev_f32 v63, s53, v80
    v_subrev_f32 v64, s54, v80
    v_subrev_f32 v65, s55, v80
    v_subrev_f32 v66, s56, v80
    v_subrev_f32 v67, s57, v80
    v_cvt_pk_bf16_f32 v68, v60, v61
    v_cvt_pk_bf16_f32 v69, v62, v63
    v_cvt_pk_bf16_f32 v70, v64, v65
    v_cvt_pk_bf16_f32 v71, v66, v67
    v_lshlrev_b32 v60, 16, v68
    v_and_b32 v61, 0xffff0000, v68
    v_lshlrev_b32 v62, 16, v69
    v_and_b32 v63, 0xffff0000, v69
    v_lshlrev_b32 v64, 16, v70
    v_and_b32 v65, 0xffff0000, v70
    v_lshlrev_b32 v66, 16, v71
    v_and_b32 v67, 0xffff0000, v71
    v_mul_f32 v60, v60, v60
    v_mul_f32 v61, v61, v61
    v_mul_f32 v62, v62, v62
    v_mul_f32 v63, v63, v63
    v_mul_f32 v64, v64, v64
    v_mul_f32 v65, v65, v65
    v_mul_f32 v66, v66, v66
    v_mul_f32 v67, v67, v67
    v_cvt_pk_bf16_f32 v68, v60, v61
    v_cvt_pk_bf16_f32 v69, v62, v63
    v_cvt_pk_bf16_f32 v70, v64, v65
    v_cvt_pk_bf16_f32 v71, v66, v67
    v_lshlrev_b32 v60, 16, v68
    v_and_b32 v61, 0xffff0000, v68
    v_lshlrev_b32 v62, 16, v69
    v_and_b32 v63, 0xffff0000, v69
    v_lshlrev_b32 v64, 16, v70
    v_and_b32 v65, 0xffff0000, v70
    v_lshlrev_b32 v66, 16, v71
    v_and_b32 v67, 0xffff0000, v71
    v_mul_f32 v60, 0xc1200000, v60
    v_mul_f32 v61, 0xc1200000, v61
    v_mul_f32 v62, 0xc1200000, v62
    v_mul_f32 v63, 0xc1200000, v63
    v_mul_f32 v64, 0xc1200000, v64
    v_mul_f32 v65, 0xc1200000, v65
    v_mul_f32 v66, 0xc1200000, v66
    v_mul_f32 v67, 0xc1200000, v67
    v_cvt_pk_bf16_f32 v68, v60, v61
    v_cvt_pk_bf16_f32 v69, v62, v63
    v_cvt_pk_bf16_f32 v70, v64, v65
    v_cvt_pk_bf16_f32 v71, v66, v67
    v_lshlrev_b32 v60, 16, v68
    v_and_b32 v61, 0xffff0000, v68
    v_lshlrev_b32 v62, 16, v69
    v_and_b32 v63, 0xffff0000, v69
    v_lshlrev_b32 v64, 16, v70
    v_and_b32 v65, 0xffff0000, v70
    v_lshlrev_b32 v66, 16, v71
    v_and_b32 v67, 0xffff0000, v71
    v_mul_f32 v60, 0x3fb8aa3b, v60
    v_mul_f32 v61, 0x3fb8aa3b, v61
    v_mul_f32 v62, 0x3fb8aa3b, v62
    v_mul_f32 v63, 0x3fb8aa3b, v63
    v_mul_f32 v64, 0x3fb8aa3b, v64
    v_mul_f32 v65, 0x3fb8aa3b, v65
    v_mul_f32 v66, 0x3fb8aa3b, v66
    v_mul_f32 v67, 0x3fb8aa3b, v67
    v_exp_f32 v60, v60
    v_exp_f32 v61, v61
    v_exp_f32 v62, v62
    v_exp_f32 v63, v63
    v_exp_f32 v64, v64
    v_exp_f32 v65, v65
    v_exp_f32 v66, v66
    v_exp_f32 v67, v67
    v_cvt_pk_bf16_f32 v72, v60, v61
    v_cvt_pk_bf16_f32 v73, v62, v63
    v_cvt_pk_bf16_f32 v74, v64, v65
    v_cvt_pk_bf16_f32 v75, v66, v67
    v_and_b32 v80, 0xffff0000, v116
    v_subrev_f32 v60, s50, v80
    v_subrev_f32 v61, s51, v80
    v_subrev_f32 v62, s52, v80
    v_subrev_f32 v63, s53, v80
    v_subrev_f32 v64, s54, v80
    v_subrev_f32 v65, s55, v80
    v_subrev_f32 v66, s56, v80
    v_subrev_f32 v67, s57, v80
    v_cvt_pk_bf16_f32 v68, v60, v61
    v_cvt_pk_bf16_f32 v69, v62, v63
    v_cvt_pk_bf16_f32 v70, v64, v65
    v_cvt_pk_bf16_f32 v71, v66, v67
    v_lshlrev_b32 v60, 16, v68
    v_and_b32 v61, 0xffff0000, v68
    v_lshlrev_b32 v62, 16, v69
    v_and_b32 v63, 0xffff0000, v69
    v_lshlrev_b32 v64, 16, v70
    v_and_b32 v65, 0xffff0000, v70
    v_lshlrev_b32 v66, 16, v71
    v_and_b32 v67, 0xffff0000, v71
    v_mul_f32 v60, v60, v60
    v_mul_f32 v61, v61, v61
    v_mul_f32 v62, v62, v62
    v_mul_f32 v63, v63, v63
    v_mul_f32 v64, v64, v64
    v_mul_f32 v65, v65, v65
    v_mul_f32 v66, v66, v66
    v_mul_f32 v67, v67, v67
    v_cvt_pk_bf16_f32 v68, v60, v61
    v_cvt_pk_bf16_f32 v69, v62, v63
    v_cvt_pk_bf16_f32 v70, v64, v65
    v_cvt_pk_bf16_f32 v71, v66, v67
    v_lshlrev_b32 v60, 16, v68
    v_and_b32 v61, 0xffff0000, v68
    v_lshlrev_b32 v62, 16, v69
    v_and_b32 v63, 0xffff0000, v69
    v_lshlrev_b32 v64, 16, v70
    v_and_b32 v65, 0xffff0000, v70
    v_lshlrev_b32 v66, 16, v71
    v_and_b32 v67, 0xffff0000, v71
    v_mul_f32 v60, 0xc1200000, v60
    v_mul_f32 v61, 0xc1200000, v61
    v_mul_f32 v62, 0xc1200000, v62
    v_mul_f32 v63, 0xc1200000, v63
    v_mul_f32 v64, 0xc1200000, v64
    v_mul_f32 v65, 0xc1200000, v65
    v_mul_f32 v66, 0xc1200000, v66
    v_mul_f32 v67, 0xc1200000, v67
    v_cvt_pk_bf16_f32 v68, v60, v61
    v_cvt_pk_bf16_f32 v69, v62, v63
    v_cvt_pk_bf16_f32 v70, v64, v65
    v_cvt_pk_bf16_f32 v71, v66, v67
    v_lshlrev_b32 v60, 16, v68
    v_and_b32 v61, 0xffff0000, v68
    v_lshlrev_b32 v62, 16, v69
    v_and_b32 v63, 0xffff0000, v69
    v_lshlrev_b32 v64, 16, v70
    v_and_b32 v65, 0xffff0000, v70
    v_lshlrev_b32 v66, 16, v71
    v_and_b32 v67, 0xffff0000, v71
    v_mul_f32 v60, 0x3fb8aa3b, v60
    v_mul_f32 v61, 0x3fb8aa3b, v61
    v_mul_f32 v62, 0x3fb8aa3b, v62
    v_mul_f32 v63, 0x3fb8aa3b, v63
    v_mul_f32 v64, 0x3fb8aa3b, v64
    v_mul_f32 v65, 0x3fb8aa3b, v65
    v_mul_f32 v66, 0x3fb8aa3b, v66
    v_mul_f32 v67, 0x3fb8aa3b, v67
    v_exp_f32 v60, v60
    v_exp_f32 v61, v61
    v_exp_f32 v62, v62
    v_exp_f32 v63, v63
    v_exp_f32 v64, v64
    v_exp_f32 v65, v65
    v_exp_f32 v66, v66
    v_exp_f32 v67, v67
    v_cvt_pk_bf16_f32 v76, v60, v61
    v_cvt_pk_bf16_f32 v77, v62, v63
    v_cvt_pk_bf16_f32 v78, v64, v65
    v_cvt_pk_bf16_f32 v79, v66, v67
    v_mfma_f32_4x4x4_16b_bf16 v[80:83], v[48:49], v[72:73], 0
    v_mfma_f32_4x4x4_16b_bf16 v[88:91], v[52:53], v[72:73], 0
    v_mfma_f32_4x4x4_16b_bf16 v[84:87], v[48:49], v[76:77], 0
    v_mfma_f32_4x4x4_16b_bf16 v[92:95], v[52:53], v[76:77], 0
    v_mfma_f32_4x4x4_16b_bf16 v[80:83], v[50:51], v[74:75], v[80:83]
    v_mfma_f32_4x4x4_16b_bf16 v[88:91], v[54:55], v[74:75], v[88:91]
    v_mfma_f32_4x4x4_16b_bf16 v[84:87], v[50:51], v[78:79], v[84:87]
    v_mfma_f32_4x4x4_16b_bf16 v[92:95], v[54:55], v[78:79], v[92:95]
    s_lshl_b32 s3, s34, 9
    s_lshl_b32 s4, s33, 7
    s_add_u32 s4, s4, s3
    v_mov_b32 v104, 1
    v_and_b32 v105, 0x3f0, v122
    v_lshlrev_b32 v105, 3, v105
    v_add_u32 v106, 81920, v118
    ds_read_b128 v[32:35], v106
    v_add_u32 v106, 81920, v119
    ds_read_b128 v[60:63], v106
    s_waitcnt vmcnt(0)
    s_barrier
    s_cmp_lg_u32 s32, 0
    s_cbranch_scc1 L2_f2
    s_mov_b64 exec, 1
    buffer_store_dword v104, off, s[8:11], s4 sc1
    s_mov_b64 exec, 15
    s_bitset0_b64 exec, s33
L2_f3:
    buffer_load_dword v104, v105, s[8:11], s3 offen sc1
    s_waitcnt vmcnt(0)
    v_cmp_ne_u32 vcc, 1, v104
    s_cbranch_vccnz L2_f3s
    s_mov_b64 exec, -1
L2_f2:
    s_barrier
    buffer_load_dwordx4 v[36:39], v122, s[20:23], s44 offen sc1
    buffer_load_dwordx4 v[40:43], v122, s[20:23], s45 offen sc1
    buffer_load_dwordx4 v[44:47], v122, s[20:23], s46 offen sc1
    s_cmp_ge_u32 s32, 4
    s_cbranch_scc1 L2_f5
    buffer_load_dwordx4 v[64:67], v123, s[20:23], s44 offen sc1
    buffer_load_dwordx4 v[68:71], v123, s[20:23], s45 offen sc1
    buffer_load_dwordx4 v[72:75], v123, s[20:23], s46 offen sc1
    v_lshlrev_b32 v16, 16, v117
    v_subrev_f32 v96, s50, v16
    v_subrev_f32 v97, s51, v16
    v_subrev_f32 v98, s52, v16
    v_subrev_f32 v99, s53, v16
    v_subrev_f32 v100, s54, v16
    v_subrev_f32 v101, s55, v16
    v_subrev_f32 v102, s56, v16
    v_subrev_f32 v103, s57, v16
    v_cvt_pk_bf16_f32 v0, v96, v97
    v_cvt_pk_bf16_f32 v1, v98, v99
    v_cvt_pk_bf16_f32 v2, v100, v101
    v_cvt_pk_bf16_f32 v3, v102, v103
    v_lshlrev_b32 v96, 16, v0
    v_and_b32 v97, 0xffff0000, v0
    v_lshlrev_b32 v98, 16, v1
    v_and_b32 v99, 0xffff0000, v1
    v_lshlrev_b32 v100, 16, v2
    v_and_b32 v101, 0xffff0000, v2
    v_lshlrev_b32 v102, 16, v3
    v_and_b32 v103, 0xffff0000, v3
    v_mul_f32 v96, v96, v96
    v_mul_f32 v97, v97, v97
    v_mul_f32 v98, v98, v98
    v_mul_f32 v99, v99, v99
    v_mul_f32 v100, v100, v100
    v_mul_f32 v101, v101, v101
    v_mul_f32 v102, v102, v102
    v_mul_f32 v103, v103, v103
    v_cvt_pk_bf16_f32 v0, v96, v97
    v_cvt_pk_bf16_f32 v1, v98, v99
    v_cvt_pk_bf16_f32 v2, v100, v101
    v_cvt_pk_bf16_f32 v3, v102, v103
    v_lshlrev_b32 v96, 16, v0
    v_and_b32 v97, 0xffff0000, v0
    v_lshlrev_b32 v98, 16, v1
    v_and_b32 v99, 0xffff0000, v1
    v_lshlrev_b32 v100, 16, v2
    v_and_b32 v101, 0xffff0000, v2
    v_lshlrev_b32 v102, 16, v3
    v_and_b32 v103, 0xffff0000, v3
    v_mul_f32 v96, 0xc1200000, v96
    v_mul_f32 v97, 0xc1200000, v97
    v_mul_f32 v98, 0xc1200000, v98
    v_mul_f32 v99, 0xc1200000, v99
    v_mul_f32 v100, 0xc1200000, v100
    v_mul_f32 v101, 0xc1200000, v101
    v_mul_f32 v102, 0xc1200000, v102
    v_mul_f32 v103, 0xc1200000, v103
    v_cvt_pk_bf16_f32 v0, v96, v97
    v_cvt_pk_bf16_f32 v1, v98, v99
    v_cvt_pk_bf16_f32 v2, v100, v101
    v_cvt_pk_bf16_f32 v3, v102, v103
    v_lshlrev_b32 v96, 16, v0
    v_and_b32 v97, 0xffff0000, v0
    v_lshlrev_b32 v98, 16, v1
    v_and_b32 v99, 0xffff0000, v1
    v_lshlrev_b32 v100, 16, v2
    v_and_b32 v101, 0xffff0000, v2
    v_lshlrev_b32 v102, 16, v3
    v_and_b32 v103, 0xffff0000, v3
    v_mul_f32 v96, 0x3fb8aa3b, v96
    v_mul_f32 v97, 0x3fb8aa3b, v97
    v_mul_f32 v98, 0x3fb8aa3b, v98
    v_mul_f32 v99, 0x3fb8aa3b, v99
    v_mul_f32 v100, 0x3fb8aa3b, v100
    v_mul_f32 v101, 0x3fb8aa3b, v101
    v_mul_f32 v102, 0x3fb8aa3b, v102
    v_mul_f32 v103, 0x3fb8aa3b, v103
    v_exp_f32 v96, v96
    v_exp_f32 v97, v97
    v_exp_f32 v98, v98
    v_exp_f32 v99, v99
    v_exp_f32 v100, v100
    v_exp_f32 v101, v101
    v_exp_f32 v102, v102
    v_exp_f32 v103, v103
    v_cvt_pk_bf16_f32 v104, v96, v97
    v_cvt_pk_bf16_f32 v105, v98, v99
    v_cvt_pk_bf16_f32 v106, v100, v101
    v_cvt_pk_bf16_f32 v107, v102, v103
    v_and_b32 v16, 0xffff0000, v117
    v_subrev_f32 v96, s50, v16
    v_subrev_f32 v97, s51, v16
    v_subrev_f32 v98, s52, v16
    v_subrev_f32 v99, s53, v16
    v_subrev_f32 v100, s54, v16
    v_subrev_f32 v101, s55, v16
    v_subrev_f32 v102, s56, v16
    v_subrev_f32 v103, s57, v16
    v_cvt_pk_bf16_f32 v0, v96, v97
    v_cvt_pk_bf16_f32 v1, v98, v99
    v_cvt_pk_bf16_f32 v2, v100, v101
    v_cvt_pk_bf16_f32 v3, v102, v103
    v_lshlrev_b32 v96, 16, v0
    v_and_b32 v97, 0xffff0000, v0
    v_lshlrev_b32 v98, 16, v1
    v_and_b32 v99, 0xffff0000, v1
    v_lshlrev_b32 v100, 16, v2
    v_and_b32 v101, 0xffff0000, v2
    v_lshlrev_b32 v102, 16, v3
    v_and_b32 v103, 0xffff0000, v3
    v_mul_f32 v96, v96, v96
    v_mul_f32 v97, v97, v97
    v_mul_f32 v98, v98, v98
    v_mul_f32 v99, v99, v99
    v_mul_f32 v100, v100, v100
    v_mul_f32 v101, v101, v101
    v_mul_f32 v102, v102, v102
    v_mul_f32 v103, v103, v103
    v_cvt_pk_bf16_f32 v0, v96, v97
    v_cvt_pk_bf16_f32 v1, v98, v99
    v_cvt_pk_bf16_f32 v2, v100, v101
    v_cvt_pk_bf16_f32 v3, v102, v103
    v_lshlrev_b32 v96, 16, v0
    v_and_b32 v97, 0xffff0000, v0
    v_lshlrev_b32 v98, 16, v1
    v_and_b32 v99, 0xffff0000, v1
    v_lshlrev_b32 v100, 16, v2
    v_and_b32 v101, 0xffff0000, v2
    v_lshlrev_b32 v102, 16, v3
    v_and_b32 v103, 0xffff0000, v3
    v_mul_f32 v96, 0xc1200000, v96
    v_mul_f32 v97, 0xc1200000, v97
    v_mul_f32 v98, 0xc1200000, v98
    v_mul_f32 v99, 0xc1200000, v99
    v_mul_f32 v100, 0xc1200000, v100
    v_mul_f32 v101, 0xc1200000, v101
    v_mul_f32 v102, 0xc1200000, v102
    v_mul_f32 v103, 0xc1200000, v103
    v_cvt_pk_bf16_f32 v0, v96, v97
    v_cvt_pk_bf16_f32 v1, v98, v99
    v_cvt_pk_bf16_f32 v2, v100, v101
    v_cvt_pk_bf16_f32 v3, v102, v103
    v_lshlrev_b32 v96, 16, v0
    v_and_b32 v97, 0xffff0000, v0
    v_lshlrev_b32 v98, 16, v1
    v_and_b32 v99, 0xffff0000, v1
    v_lshlrev_b32 v100, 16, v2
    v_and_b32 v101, 0xffff0000, v2
    v_lshlrev_b32 v102, 16, v3
    v_and_b32 v103, 0xffff0000, v3
    v_mul_f32 v96, 0x3fb8aa3b, v96
    v_mul_f32 v97, 0x3fb8aa3b, v97
    v_mul_f32 v98, 0x3fb8aa3b, v98
    v_mul_f32 v99, 0x3fb8aa3b, v99
    v_mul_f32 v100, 0x3fb8aa3b, v100
    v_mul_f32 v101, 0x3fb8aa3b, v101
    v_mul_f32 v102, 0x3fb8aa3b, v102
    v_mul_f32 v103, 0x3fb8aa3b, v103
    v_exp_f32 v96, v96
    v_exp_f32 v97, v97
    v_exp_f32 v98, v98
    v_exp_f32 v99, v99
    v_exp_f32 v100, v100
    v_exp_f32 v101, v101
    v_exp_f32 v102, v102
    v_exp_f32 v103, v103
    v_cvt_pk_bf16_f32 v76, v96, v97
    v_cvt_pk_bf16_f32 v77, v98, v99
    v_cvt_pk_bf16_f32 v78, v100, v101
    v_cvt_pk_bf16_f32 v79, v102, v103
    v_mfma_f32_4x4x4_16b_bf16 v[16:19], v[48:49], v[104:105], 0
    v_mfma_f32_4x4x4_16b_bf16 v[24:27], v[52:53], v[104:105], 0
    v_mfma_f32_4x4x4_16b_bf16 v[20:23], v[48:49], v[76:77], 0
    v_mfma_f32_4x4x4_16b_bf16 v[28:31], v[52:53], v[76:77], 0
    v_mfma_f32_4x4x4_16b_bf16 v[16:19], v[50:51], v[106:107], v[16:19]
    v_mfma_f32_4x4x4_16b_bf16 v[24:27], v[54:55], v[106:107], v[24:27]
    v_mfma_f32_4x4x4_16b_bf16 v[20:23], v[50:51], v[78:79], v[20:23]
    v_mfma_f32_4x4x4_16b_bf16 v[28:31], v[54:55], v[78:79], v[28:31]
L2_f5:
    s_waitcnt vmcnt(0) lgkmcnt(0)
    v_mfma_f32_4x4x4_16b_bf16 v[96:99], v[10:11], v[32:33], 0
    v_mfma_f32_4x4x4_16b_bf16 v[100:103], v[10:11], v[34:35], 0
    s_nop 0
    v_mfma_f32_4x4x4_16b_bf16 v[96:99], v[10:11], v[36:37], v[96:99]
    v_mfma_f32_4x4x4_16b_bf16 v[100:103], v[10:11], v[38:39], v[100:103]
    s_nop 0
    v_mfma_f32_4x4x4_16b_bf16 v[96:99], v[10:11], v[40:41], v[96:99]
    v_mfma_f32_4x4x4_16b_bf16 v[100:103], v[10:11], v[42:43], v[100:103]
    s_nop 0
    v_mfma_f32_4x4x4_16b_bf16 v[96:99], v[10:11], v[44:45], v[96:99]
    v_mfma_f32_4x4x4_16b_bf16 v[100:103], v[10:11], v[46:47], v[100:103]
    s_nop 3
    v_mul_f32 v96, v96, v80
    v_mul_f32 v97, v97, v81
    v_mul_f32 v98, v98, v82
    v_mul_f32 v99, v99, v83
    v_cvt_pk_bf16_f32 v32, v96, v97
    v_cvt_pk_bf16_f32 v33, v98, v99
    v_mul_f32 v100, v100, v84
    v_mul_f32 v101, v101, v85
    v_mul_f32 v102, v102, v86
    v_mul_f32 v103, v103, v87
    v_cvt_pk_bf16_f32 v34, v100, v101
    v_cvt_pk_bf16_f32 v35, v102, v103
    v_mfma_f32_4x4x4_16b_bf16 v[80:83], v[56:57], v[32:33], 0
    s_nop 0
    v_mfma_f32_4x4x4_16b_bf16 v[84:87], v[56:57], v[34:35], 0
    s_nop 2
    v_mul_f32 v80, v80, v88
    v_mul_f32 v81, v81, v89
    v_mul_f32 v82, v82, v90
    v_mul_f32 v83, v83, v91
    v_mul_f32 v84, v84, v92
    v_mul_f32 v85, v85, v93
    v_mul_f32 v86, v86, v94
    v_mul_f32 v87, v87, v95
    v_mfma_f32_4x4x4_16b_bf16 v[96:99], v[10:11], v[108:109], v[80:83]
    s_nop 0
    v_mfma_f32_4x4x4_16b_bf16 v[100:103], v[10:11], v[110:111], v[84:87]
    s_nop 2
    v_cvt_pk_bf16_f32 v36, v96, v97
    v_cvt_pk_bf16_f32 v37, v98, v99
    v_cvt_pk_bf16_f32 v38, v100, v101
    v_cvt_pk_bf16_f32 v39, v102, v103
    buffer_store_dwordx4 v[36:39], v120, s[12:15], 0 offen nt
    s_cmp_ge_u32 s32, 4
    s_cbranch_scc1 L2_f6
    v_mfma_f32_4x4x4_16b_bf16 v[96:99], v[10:11], v[60:61], 0
    v_mfma_f32_4x4x4_16b_bf16 v[100:103], v[10:11], v[62:63], 0
    s_nop 0
    v_mfma_f32_4x4x4_16b_bf16 v[96:99], v[10:11], v[64:65], v[96:99]
    v_mfma_f32_4x4x4_16b_bf16 v[100:103], v[10:11], v[66:67], v[100:103]
    s_nop 0
    v_mfma_f32_4x4x4_16b_bf16 v[96:99], v[10:11], v[68:69], v[96:99]
    v_mfma_f32_4x4x4_16b_bf16 v[100:103], v[10:11], v[70:71], v[100:103]
    s_nop 0
    v_mfma_f32_4x4x4_16b_bf16 v[96:99], v[10:11], v[72:73], v[96:99]
    v_mfma_f32_4x4x4_16b_bf16 v[100:103], v[10:11], v[74:75], v[100:103]
    s_nop 3
    v_mul_f32 v96, v96, v16
    v_mul_f32 v97, v97, v17
    v_mul_f32 v98, v98, v18
    v_mul_f32 v99, v99, v19
    v_cvt_pk_bf16_f32 v60, v96, v97
    v_cvt_pk_bf16_f32 v61, v98, v99
    v_mul_f32 v100, v100, v20
    v_mul_f32 v101, v101, v21
    v_mul_f32 v102, v102, v22
    v_mul_f32 v103, v103, v23
    v_cvt_pk_bf16_f32 v62, v100, v101
    v_cvt_pk_bf16_f32 v63, v102, v103
    v_mfma_f32_4x4x4_16b_bf16 v[16:19], v[56:57], v[60:61], 0
    s_nop 0
    v_mfma_f32_4x4x4_16b_bf16 v[20:23], v[56:57], v[62:63], 0
    s_nop 2
    v_mul_f32 v16, v16, v24
    v_mul_f32 v17, v17, v25
    v_mul_f32 v18, v18, v26
    v_mul_f32 v19, v19, v27
    v_mul_f32 v20, v20, v28
    v_mul_f32 v21, v21, v29
    v_mul_f32 v22, v22, v30
    v_mul_f32 v23, v23, v31
    v_mfma_f32_4x4x4_16b_bf16 v[96:99], v[10:11], v[112:113], v[16:19]
    s_nop 0
    v_mfma_f32_4x4x4_16b_bf16 v[100:103], v[10:11], v[114:115], v[20:23]
    s_nop 2
    v_cvt_pk_bf16_f32 v64, v96, v97
    v_cvt_pk_bf16_f32 v65, v98, v99
    v_cvt_pk_bf16_f32 v66, v100, v101
    v_cvt_pk_bf16_f32 v67, v102, v103
    buffer_store_dwordx4 v[64:67], v121, s[12:15], 0 offen nt
L2_f6:
L2_end:
    s_endpgm
L2_slow:
    s_lshr_b32 s35, s42, 2
    s_lshl_b32 s50, s32, 4
    s_and_b32 s3, s42, 3
    s_lshl_b32 s53, s3, 3
    s_add_u32 s53, s53, s39
    s_and_b32 s3, s35, 2
    s_lshl_b32 s3, s3, 1
    s_add_u32 s53, s53, s3
    s_and_b32 s54, s35, 1
    s_lshl_b32 s54, s54, 4
L2_sl_seg:
    s_mul_i32 s55, s50, 173056
    s_and_b32 s3, s50, 3
    s_lshl_b32 s3, s3, 5
    s_add_u32 s3, s3, s55
    s_add_u32 s3, s3, s53
    buffer_load_dword v104, off, s[12:15], s3 sc1
    buffer_load_dword v105, off, s[12:15], s3 offset:32 sc1
    s_waitcnt vmcnt(0)
    v_readfirstlane_b32 s51, v104
    v_readfirstlane_b32 s52, v105
    s_lshr_b32 s51, s51, s54
    s_and_b32 s51, s51, 0xffff
    s_lshr_b32 s52, s52, s54
    s_and_b32 s52, s52, 0xffff
L2_sl_rec:
    s_cmp_ge_u32 s51, s52
    s_cbranch_scc1 L2_sl_next
    v_mbcnt_lo_u32_b32 v102, -1, 0
    v_mbcnt_hi_u32_b32 v102, -1, v102
    v_add_u32 v102, s51, v102
    v_and_b32 v103, -4, v102
    v_lshl_add_u32 v104, v102, 2, v103
    v_lshl_add_u32 v105, v103, 2, v102
    v_cmp_gt_u32 vcc, s52, v102
    s_mov_b64 exec, vcc
    buffer_load_dword v106, v104, s[8:11], s55 offen
    buffer_load_ubyte v107, v105, s[8:11], s55 offen offset:16
    s_waitcnt vmcnt(0)
    v_lshrrev_b32 v98, 14, v106
    v_and_b32 v98, v5, v98
    ds_read_b64 v[100:101], v98
    v_perm_b32 v97, v106, v107, s44
    v_and_b32 v96, v5, v106
    v_bitop3_b32 v103, v106, 0.5, -0.5 bitop3:0xa8
    v_bitop3_b32 v97, v6, v97, v103 bitop3:0xca
    s_waitcnt lgkmcnt(0)
    v_mfma_f32_4x4x4_16b_bf16 v[88:91], v[8:9], v[100:101], 0
    s_nop 4
    v_mul_f32 v88, v97, v88
    v_mul_f32 v89, v97, v89
    v_mul_f32 v90, v97, v90
    v_mul_f32 v91, v97, v91
    v_cvt_pk_bf16_f32 v88, v88, v89
    v_cvt_pk_bf16_f32 v89, v90, v91
    ds_pk_add_bf16 v96, v88 offset:65408
    ds_pk_add_bf16 v96, v89 offset:65412
    s_mov_b64 exec, -1
    s_add_u32 s51, s51, 64
    s_branch L2_sl_rec
L2_sl_next:
    s_add_u32 s50, s50, 1
    s_and_b32 s3, s50, 15
    s_cbranch_scc1 L2_sl_seg
    s_add_u32 s50, s50, 240
    s_cmp_lt_u32 s50, 1280
    s_cbranch_scc1 L2_sl_seg
    s_waitcnt lgkmcnt(0)
    s_cmp_eq_u32 s42, 0
    s_cbranch_scc1 L2_ret0
    s_cmp_eq_u32 s42, 1
    s_cbranch_scc1 L2_ret1
    s_cmp_eq_u32 s42, 14
    s_cbranch_scc1 L2_ret6
    s_cmp_eq_u32 s42, 15
    s_cbranch_scc1 L2_ret7
    s_and_b32 s3, s42, 3
    s_cmp_eq_u32 s3, 2
    s_cbranch_scc1 L2_ret2
    s_cmp_eq_u32 s3, 3
    s_cbranch_scc1 L2_ret3
    s_cmp_eq_u32 s3, 0
    s_cbranch_scc1 L2_ret4
    s_branch L2_ret5
L2_p1s:
    s_sleep 32
    s_branch L2_p1
L2_xo3:
    v_cmp_lt_u32 vcc, 20, v99
    s_mov_b32 s101, 1
    s_cbranch_vccz L2_xp3
    v_cmp_lt_u32 vcc, 32, v99
    v_cmp_lt_u32 s[58:59], 31, v88
    s_mov_b32 s101, 2
    s_or_b64 vcc, vcc, s[58:59]
    s_cbranch_scc0 L2_xp3
    s_mov_b32 s37, 0x10000
    s_branch L2_xp3
L2_xa4:
    s_cmp_eq_u32 s101, 1
    s_cbranch_scc1 L2_xc4
    v_lshlrev_b32 v89, 0, v96
    v_add_u32 v90, 140, v97
    v_bitop3_b32 v90, v89, v45, v90 bitop3:0x6a
    ds_write_b32 v98, v90 offset:28
    v_lshlrev_b32 v89, 4, v96
    v_add_u32 v90, 120, v97
    v_bitop3_b32 v90, v89, v45, v90 bitop3:0x6a
    ds_write_b32 v98, v90 offset:24
    v_lshlrev_b32 v89, 8, v96
    v_add_u32 v90, 100, v97
    v_bitop3_b32 v90, v89, v45, v90 bitop3:0x6a
    ds_write_b32 v98, v90 offset:20
L2_xc4:
    v_lshlrev_b32 v89, 12, v96
    v_add_u32 v90, 80, v97
    v_bitop3_b32 v90, v89, v45, v90 bitop3:0x6a
    ds_write_b32 v98, v90 offset:16
    s_branch L2_xb4
L2_xe4:
    v_cmp_lt_u32 vcc, 32, v99
    v_cmp_lt_u32 s[58:59], 31, v88
    v_lshrrev_b32 v89, 16, v96
    v_add_u32 v97, 80, v97
    s_or_b64 vcc, vcc, s[58:59]
    s_cbranch_scc1 L2_xs4
    v_lshlrev_b32 v89, v1, v89
    v_and_b32 v89, v45, v89
    v_cmp_ne_u32 vcc, 0, v89
    v_xor_b32 v90, v97, v89
    s_add_u32 s3, s37, s38
    v_mbcnt_lo_u32_b32 v98, vcc_lo, 0
    v_mbcnt_hi_u32_b32 v98, vcc_hi, v98
    s_bcnt1_i32_b64 s41, vcc
    v_lshl_add_u32 v98, v98, 2, s3
    s_lshl2_add_u32 s37, s41, s37
    s_mov_b64 exec, vcc
    ds_write_b32 v98, v90
    s_mov_b64 exec, -1
    s_branch L2_xr4
L2_xf4:
    s_waitcnt lgkmcnt(0)
    s_cmp_gt_u32 s37, 1024
    s_cbranch_scc1 L2_xs4
    s_cmp_lt_u32 s37, 768
    s_cbranch_scc1 L2_xl4
    ds_read_b32 v32, v98 offset:896
    s_add_u32 s3, s42, 0
    s_bitset1_b32 s43, s3
    s_branch L2_xg4
L2_xl4:
    v_mov_b32 v42, -1
    s_cmp_ge_u32 s37, 512
    s_cbranch_scc1 L2_xg4
    v_mov_b32 v43, -1
    s_cmp_ge_u32 s37, 256
    s_cbranch_scc1 L2_xg4
    v_mov_b32 v41, -1
    s_branch L2_xg4
L2_xs4:
    s_waitcnt lgkmcnt(0)
    v_mov_b32 v40, -1
    v_mov_b32 v41, -1
    v_mov_b32 v43, -1
    v_mov_b32 v42, -1
    s_add_u32 s3, s42, 0
    s_bitset1_b32 s36, s3
    s_branch L2_xg4
L2_xo5:
    v_cmp_lt_u32 vcc, 20, v99
    s_mov_b32 s101, 1
    s_cbranch_vccz L2_xp5
    v_cmp_lt_u32 vcc, 32, v99
    v_cmp_lt_u32 s[58:59], 31, v88
    s_mov_b32 s101, 2
    s_or_b64 vcc, vcc, s[58:59]
    s_cbranch_scc0 L2_xp5
    s_mov_b32 s37, 0x10000
    s_branch L2_xp5
L2_xa6:
    s_cmp_eq_u32 s101, 1
    s_cbranch_scc1 L2_xc6
    v_lshlrev_b32 v89, 0, v96
    v_add_u32 v90, 140, v97
    v_bitop3_b32 v90, v89, v45, v90 bitop3:0x6a
    ds_write_b32 v98, v90 offset:28
    v_lshlrev_b32 v89, 4, v96
    v_add_u32 v90, 120, v97
    v_bitop3_b32 v90, v89, v45, v90 bitop3:0x6a
    ds_write_b32 v98, v90 offset:24
    v_lshlrev_b32 v89, 8, v96
    v_add_u32 v90, 100, v97
    v_bitop3_b32 v90, v89, v45, v90 bitop3:0x6a
    ds_write_b32 v98, v90 offset:20
L2_xc6:
    v_lshlrev_b32 v89, 12, v96
    v_add_u32 v90, 80, v97
    v_bitop3_b32 v90, v89, v45, v90 bitop3:0x6a
    ds_write_b32 v98, v90 offset:16
    s_branch L2_xb6
L2_xe6:
    v_cmp_lt_u32 vcc, 32, v99
    v_cmp_lt_u32 s[58:59], 31, v88
    v_lshrrev_b32 v89, 16, v96
    v_add_u32 v97, 80, v97
    s_or_b64 vcc, vcc, s[58:59]
    s_cbranch_scc1 L2_xs6
    v_lshlrev_b32 v89, v1, v89
    v_and_b32 v89, v45, v89
    v_cmp_ne_u32 vcc, 0, v89
    v_xor_b32 v90, v97, v89
    s_add_u32 s3, s37, s38
    v_mbcnt_lo_u32_b32 v98, vcc_lo, 0
    v_mbcnt_hi_u32_b32 v98, vcc_hi, v98
    s_bcnt1_i32_b64 s41, vcc
    v_lshl_add_u32 v98, v98, 2, s3
    s_lshl2_add_u32 s37, s41, s37
    s_mov_b64 exec, vcc
    ds_write_b32 v98, v90
    s_mov_b64 exec, -1
    s_branch L2_xr6
L2_xf6:
    s_waitcnt lgkmcnt(0)
    s_cmp_gt_u32 s37, 1024
    s_cbranch_scc1 L2_xs6
    s_cmp_lt_u32 s37, 768
    s_cbranch_scc1 L2_xl6
    ds_read_b32 v33, v98 offset:896
    s_add_u32 s3, s42, 1
    s_bitset1_b32 s43, s3
    s_branch L2_xg6
L2_xl6:
    v_mov_b32 v42, -1
    s_cmp_ge_u32 s37, 512
    s_cbranch_scc1 L2_xg6
    v_mov_b32 v43, -1
    s_cmp_ge_u32 s37, 256
    s_cbranch_scc1 L2_xg6
    v_mov_b32 v41, -1
    s_branch L2_xg6
L2_xs6:
    s_waitcnt lgkmcnt(0)
    v_mov_b32 v40, -1
    v_mov_b32 v41, -1
    v_mov_b32 v43, -1
    v_mov_b32 v42, -1
    s_add_u32 s3, s42, 1
    s_bitset1_b32 s36, s3
    s_branch L2_xg6
L2_p2s:
    s_sleep 8
    s_branch L2_p2
L2_oa7:
    v_and_b32 v47, 0x0fffffff, v32
    buffer_load_dword v78, v47, s[8:11], 0 offen offset:16
    s_mov_b64 exec, s[6:7]
    v_add_u32 v47, 8, v47
    v_lshrrev_b32 v32, 2, v32
    s_mov_b64 exec, -1
    buffer_load_dwordx2 v[76:77], v47, s[8:11], 0 offen
    s_branch L2_ob7
L2_oa8:
    s_waitcnt vmcnt(0)
    s_mov_b64 exec, s[6:7]
    v_lshrrev_b32 v78, 16, v78
    s_mov_b64 exec, -1
    v_and_b32 v46, 0x10000000, v32
    v_cmpx_eq_u32 vcc, 0, v46
    v_lshrrev_b32 v47, 14, v76
    v_and_b32 v47, v5, v47
    ds_read_b64 v[96:97], v47
    v_perm_b32 v98, v76, v78, s44
    v_bitop3_b32 v99, v76, 0.5, -0.5 bitop3:0xa8
    v_bitop3_b32 v98, v6, v98, v99 bitop3:0xca
    v_and_b32 v47, v5, v76
    s_waitcnt lgkmcnt(0)
    v_mfma_f32_4x4x4_16b_bf16 v[88:91], v[8:9], v[96:97], 0
    s_nop 4
    v_mul_f32 v88, v98, v88
    v_mul_f32 v89, v98, v89
    v_mul_f32 v90, v98, v90
    v_mul_f32 v91, v98, v91
    v_cvt_pk_bf16_f32 v88, v88, v89
    v_cvt_pk_bf16_f32 v89, v90, v91
    ds_pk_add_bf16 v47, v88 offset:65408
    ds_pk_add_bf16 v47, v89 offset:65412
    s_mov_b64 exec, -1
    v_and_b32 v46, 0x20000000, v32
    v_cmpx_eq_u32 vcc, 0, v46
    v_lshrrev_b32 v47, 14, v77
    v_and_b32 v47, v5, v47
    ds_read_b64 v[96:97], v47
    v_perm_b32 v98, v77, v78, s45
    v_bitop3_b32 v99, v77, 0.5, -0.5 bitop3:0xa8
    v_bitop3_b32 v98, v6, v98, v99 bitop3:0xca
    v_and_b32 v47, v5, v77
    s_waitcnt lgkmcnt(0)
    v_mfma_f32_4x4x4_16b_bf16 v[88:91], v[8:9], v[96:97], 0
    s_nop 4
    v_mul_f32 v88, v98, v88
    v_mul_f32 v89, v98, v89
    v_mul_f32 v90, v98, v90
    v_mul_f32 v91, v98, v91
    v_cvt_pk_bf16_f32 v88, v88, v89
    v_cvt_pk_bf16_f32 v89, v90, v91
    ds_pk_add_bf16 v47, v88 offset:65408
    ds_pk_add_bf16 v47, v89 offset:65412
    s_mov_b64 exec, -1
    s_branch L2_ob8
L2_c9:
    s_lshl_b64 s[52:53], s[82:83], 1
    s_andn2_b64 s[52:53], s[52:53], s[80:81]
    s_andn2_b64 s[52:53], s[52:53], s[54:55]
    s_or_b64 s[80:81], s[80:81], s[52:53]
    s_not_b64 vcc, s[52:53]
    s_mov_b64 exec, -1
    v_cndmask_b32_dpp v84, v84, v84, vcc wave_shr:1 row_mask:0xf bank_mask:0xf
    v_cndmask_b32_dpp v85, v85, v85, vcc wave_shr:1 row_mask:0xf bank_mask:0xf
    s_lshr_b64 s[52:53], s[52:53], 1
    v_cndmask_b32_dpp v86, v86, v86, vcc wave_shr:1 row_mask:0xf bank_mask:0xf
    v_cndmask_b32_dpp v87, v87, v87, vcc wave_shr:1 row_mask:0xf bank_mask:0xf
    s_andn2_b64 s[82:83], s[82:83], s[52:53]
    v_cndmask_b32_dpp v7, v7, v7, vcc wave_shr:1 row_mask:0xf bank_mask:0xf
    s_mov_b64 exec, s[54:55]
    s_cbranch_scc0 L2_d9
    s_mov_b64 exec, s[82:83]
    s_nop 1
    v_mfma_f32_4x4x4_16b_bf16 v[88:91], v[12:13], v[84:85], 0
    s_nop 1
    v_mfma_f32_4x4x4_16b_bf16 v[88:91], v[10:11], v[86:87], v[88:91]
    s_nop 4
    v_cvt_pk_bf16_f32 v88, v88, v89
    v_cvt_pk_bf16_f32 v89, v90, v91
    ds_pk_add_bf16 v7, v88 offset:65408
    ds_pk_add_bf16 v7, v89 offset:65412
    s_mov_b64 exec, s[54:55]
    s_branch L2_d9
L2_c10:
    s_lshl_b64 s[52:53], s[82:83], 1
    s_andn2_b64 s[52:53], s[52:53], s[80:81]
    s_andn2_b64 s[52:53], s[52:53], s[50:51]
    s_or_b64 s[80:81], s[80:81], s[52:53]
    s_not_b64 vcc, s[52:53]
    s_mov_b64 exec, -1
    v_cndmask_b32_dpp v84, v84, v84, vcc wave_shr:1 row_mask:0xf bank_mask:0xf
    v_cndmask_b32_dpp v85, v85, v85, vcc wave_shr:1 row_mask:0xf bank_mask:0xf
    s_lshr_b64 s[52:53], s[52:53], 1
    v_cndmask_b32_dpp v86, v86, v86, vcc wave_shr:1 row_mask:0xf bank_mask:0xf
    v_cndmask_b32_dpp v87, v87, v87, vcc wave_shr:1 row_mask:0xf bank_mask:0xf
    s_andn2_b64 s[82:83], s[82:83], s[52:53]
    v_cndmask_b32_dpp v7, v7, v7, vcc wave_shr:1 row_mask:0xf bank_mask:0xf
    s_mov_b64 exec, s[50:51]
    s_cbranch_scc0 L2_d10
    s_mov_b64 exec, s[82:83]
    s_nop 1
    v_mfma_f32_4x4x4_16b_bf16 v[88:91], v[12:13], v[84:85], 0
    s_nop 1
    v_mfma_f32_4x4x4_16b_bf16 v[88:91], v[10:11], v[86:87], v[88:91]
    s_nop 4
    v_cvt_pk_bf16_f32 v88, v88, v89
    v_cvt_pk_bf16_f32 v89, v90, v91
    ds_pk_add_bf16 v7, v88 offset:65408
    ds_pk_add_bf16 v7, v89 offset:65412
    s_mov_b64 exec, s[50:51]
    s_branch L2_d10
L2_c13:
    s_lshl_b64 s[52:53], s[82:83], 1
    s_andn2_b64 s[52:53], s[52:53], s[80:81]
    s_andn2_b64 s[52:53], s[52:53], s[54:55]
    s_or_b64 s[80:81], s[80:81], s[52:53]
    s_not_b64 vcc, s[52:53]
    s_mov_b64 exec, -1
    v_cndmask_b32_dpp v84, v84, v84, vcc wave_shr:1 row_mask:0xf bank_mask:0xf
    v_cndmask_b32_dpp v85, v85, v85, vcc wave_shr:1 row_mask:0xf bank_mask:0xf
    s_lshr_b64 s[52:53], s[52:53], 1
    v_cndmask_b32_dpp v86, v86, v86, vcc wave_shr:1 row_mask:0xf bank_mask:0xf
    v_cndmask_b32_dpp v87, v87, v87, vcc wave_shr:1 row_mask:0xf bank_mask:0xf
    s_andn2_b64 s[82:83], s[82:83], s[52:53]
    v_cndmask_b32_dpp v7, v7, v7, vcc wave_shr:1 row_mask:0xf bank_mask:0xf
    s_mov_b64 exec, s[54:55]
    s_cbranch_scc0 L2_d13
    s_mov_b64 exec, s[82:83]
    s_nop 1
    v_mfma_f32_4x4x4_16b_bf16 v[88:91], v[12:13], v[84:85], 0
    s_nop 1
    v_mfma_f32_4x4x4_16b_bf16 v[88:91], v[10:11], v[86:87], v[88:91]
    s_nop 4
    v_cvt_pk_bf16_f32 v88, v88, v89
    v_cvt_pk_bf16_f32 v89, v90, v91
    ds_pk_add_bf16 v7, v88 offset:65408
    ds_pk_add_bf16 v7, v89 offset:65412
    s_mov_b64 exec, s[54:55]
    s_branch L2_d13
L2_c14:
    s_lshl_b64 s[52:53], s[82:83], 1
    s_andn2_b64 s[52:53], s[52:53], s[80:81]
    s_andn2_b64 s[52:53], s[52:53], s[50:51]
    s_or_b64 s[80:81], s[80:81], s[52:53]
    s_not_b64 vcc, s[52:53]
    s_mov_b64 exec, -1
    v_cndmask_b32_dpp v84, v84, v84, vcc wave_shr:1 row_mask:0xf bank_mask:0xf
    v_cndmask_b32_dpp v85, v85, v85, vcc wave_shr:1 row_mask:0xf bank_mask:0xf
    s_lshr_b64 s[52:53], s[52:53], 1
    v_cndmask_b32_dpp v86, v86, v86, vcc wave_shr:1 row_mask:0xf bank_mask:0xf
    v_cndmask_b32_dpp v87, v87, v87, vcc wave_shr:1 row_mask:0xf bank_mask:0xf
    s_andn2_b64 s[82:83], s[82:83], s[52:53]
    v_cndmask_b32_dpp v7, v7, v7, vcc wave_shr:1 row_mask:0xf bank_mask:0xf
    s_mov_b64 exec, s[50:51]
    s_cbranch_scc0 L2_d14
    s_mov_b64 exec, s[82:83]
    s_nop 1
    v_mfma_f32_4x4x4_16b_bf16 v[88:91], v[12:13], v[84:85], 0
    s_nop 1
    v_mfma_f32_4x4x4_16b_bf16 v[88:91], v[10:11], v[86:87], v[88:91]
    s_nop 4
    v_cvt_pk_bf16_f32 v88, v88, v89
    v_cvt_pk_bf16_f32 v89, v90, v91
    ds_pk_add_bf16 v7, v88 offset:65408
    ds_pk_add_bf16 v7, v89 offset:65412
    s_mov_b64 exec, s[50:51]
    s_branch L2_d14
L2_xo16:
    v_cmp_lt_u32 vcc, 20, v99
    s_mov_b32 s101, 1
    s_cbranch_vccz L2_xp16
    v_cmp_lt_u32 vcc, 32, v99
    v_cmp_lt_u32 s[58:59], 31, v88
    s_mov_b32 s101, 2
    s_or_b64 vcc, vcc, s[58:59]
    s_cbranch_scc0 L2_xp16
    s_mov_b32 s37, 0x10000
    s_branch L2_xp16
L2_c17:
    s_lshl_b64 s[52:53], s[82:83], 1
    s_andn2_b64 s[52:53], s[52:53], s[80:81]
    s_andn2_b64 s[52:53], s[52:53], s[54:55]
    s_or_b64 s[80:81], s[80:81], s[52:53]
    s_not_b64 vcc, s[52:53]
    s_mov_b64 exec, -1
    v_cndmask_b32_dpp v84, v84, v84, vcc wave_shr:1 row_mask:0xf bank_mask:0xf
    v_cndmask_b32_dpp v85, v85, v85, vcc wave_shr:1 row_mask:0xf bank_mask:0xf
    s_lshr_b64 s[52:53], s[52:53], 1
    v_cndmask_b32_dpp v86, v86, v86, vcc wave_shr:1 row_mask:0xf bank_mask:0xf
    v_cndmask_b32_dpp v87, v87, v87, vcc wave_shr:1 row_mask:0xf bank_mask:0xf
    s_andn2_b64 s[82:83], s[82:83], s[52:53]
    v_cndmask_b32_dpp v7, v7, v7, vcc wave_shr:1 row_mask:0xf bank_mask:0xf
    s_mov_b64 exec, s[54:55]
    s_cbranch_scc0 L2_d17
    s_mov_b64 exec, s[82:83]
    s_nop 1
    v_mfma_f32_4x4x4_16b_bf16 v[88:91], v[12:13], v[84:85], 0
    s_nop 1
    v_mfma_f32_4x4x4_16b_bf16 v[88:91], v[10:11], v[86:87], v[88:91]
    s_nop 4
    v_cvt_pk_bf16_f32 v88, v88, v89
    v_cvt_pk_bf16_f32 v89, v90, v91
    ds_pk_add_bf16 v7, v88 offset:65408
    ds_pk_add_bf16 v7, v89 offset:65412
    s_mov_b64 exec, s[54:55]
    s_branch L2_d17
L2_c18:
    s_lshl_b64 s[52:53], s[82:83], 1
    s_andn2_b64 s[52:53], s[52:53], s[80:81]
    s_andn2_b64 s[52:53], s[52:53], s[50:51]
    s_or_b64 s[80:81], s[80:81], s[52:53]
    s_not_b64 vcc, s[52:53]
    s_mov_b64 exec, -1
    v_cndmask_b32_dpp v84, v84, v84, vcc wave_shr:1 row_mask:0xf bank_mask:0xf
    v_cndmask_b32_dpp v85, v85, v85, vcc wave_shr:1 row_mask:0xf bank_mask:0xf
    s_lshr_b64 s[52:53], s[52:53], 1
    v_cndmask_b32_dpp v86, v86, v86, vcc wave_shr:1 row_mask:0xf bank_mask:0xf
    v_cndmask_b32_dpp v87, v87, v87, vcc wave_shr:1 row_mask:0xf bank_mask:0xf
    s_andn2_b64 s[82:83], s[82:83], s[52:53]
    v_cndmask_b32_dpp v7, v7, v7, vcc wave_shr:1 row_mask:0xf bank_mask:0xf
    s_mov_b64 exec, s[50:51]
    s_cbranch_scc0 L2_d18
    s_mov_b64 exec, s[82:83]
    s_nop 1
    v_mfma_f32_4x4x4_16b_bf16 v[88:91], v[12:13], v[84:85], 0
    s_nop 1
    v_mfma_f32_4x4x4_16b_bf16 v[88:91], v[10:11], v[86:87], v[88:91]
    s_nop 4
    v_cvt_pk_bf16_f32 v88, v88, v89
    v_cvt_pk_bf16_f32 v89, v90, v91
    ds_pk_add_bf16 v7, v88 offset:65408
    ds_pk_add_bf16 v7, v89 offset:65412
    s_mov_b64 exec, s[50:51]
    s_branch L2_d18
L2_c21:
    s_lshl_b64 s[52:53], s[82:83], 1
    s_andn2_b64 s[52:53], s[52:53], s[80:81]
    s_andn2_b64 s[52:53], s[52:53], s[54:55]
    s_or_b64 s[80:81], s[80:81], s[52:53]
    s_not_b64 vcc, s[52:53]
    s_mov_b64 exec, -1
    v_cndmask_b32_dpp v84, v84, v84, vcc wave_shr:1 row_mask:0xf bank_mask:0xf
    v_cndmask_b32_dpp v85, v85, v85, vcc wave_shr:1 row_mask:0xf bank_mask:0xf
    s_lshr_b64 s[52:53], s[52:53], 1
    v_cndmask_b32_dpp v86, v86, v86, vcc wave_shr:1 row_mask:0xf bank_mask:0xf
    v_cndmask_b32_dpp v87, v87, v87, vcc wave_shr:1 row_mask:0xf bank_mask:0xf
    s_andn2_b64 s[82:83], s[82:83], s[52:53]
    v_cndmask_b32_dpp v7, v7, v7, vcc wave_shr:1 row_mask:0xf bank_mask:0xf
    s_mov_b64 exec, s[54:55]
    s_cbranch_scc0 L2_d21
    s_mov_b64 exec, s[82:83]
    s_nop 1
    v_mfma_f32_4x4x4_16b_bf16 v[88:91], v[12:13], v[84:85], 0
    s_nop 1
    v_mfma_f32_4x4x4_16b_bf16 v[88:91], v[10:11], v[86:87], v[88:91]
    s_nop 4
    v_cvt_pk_bf16_f32 v88, v88, v89
    v_cvt_pk_bf16_f32 v89, v90, v91
    ds_pk_add_bf16 v7, v88 offset:65408
    ds_pk_add_bf16 v7, v89 offset:65412
    s_mov_b64 exec, s[54:55]
    s_branch L2_d21
L2_c22:
    s_lshl_b64 s[52:53], s[82:83], 1
    s_andn2_b64 s[52:53], s[52:53], s[80:81]
    s_andn2_b64 s[52:53], s[52:53], s[50:51]
    s_or_b64 s[80:81], s[80:81], s[52:53]
    s_not_b64 vcc, s[52:53]
    s_mov_b64 exec, -1
    v_cndmask_b32_dpp v84, v84, v84, vcc wave_shr:1 row_mask:0xf bank_mask:0xf
    v_cndmask_b32_dpp v85, v85, v85, vcc wave_shr:1 row_mask:0xf bank_mask:0xf
    s_lshr_b64 s[52:53], s[52:53], 1
    v_cndmask_b32_dpp v86, v86, v86, vcc wave_shr:1 row_mask:0xf bank_mask:0xf
    v_cndmask_b32_dpp v87, v87, v87, vcc wave_shr:1 row_mask:0xf bank_mask:0xf
    s_andn2_b64 s[82:83], s[82:83], s[52:53]
    v_cndmask_b32_dpp v7, v7, v7, vcc wave_shr:1 row_mask:0xf bank_mask:0xf
    s_mov_b64 exec, s[50:51]
    s_cbranch_scc0 L2_d22
    s_mov_b64 exec, s[82:83]
    s_nop 1
    v_mfma_f32_4x4x4_16b_bf16 v[88:91], v[12:13], v[84:85], 0
    s_nop 1
    v_mfma_f32_4x4x4_16b_bf16 v[88:91], v[10:11], v[86:87], v[88:91]
    s_nop 4
    v_cvt_pk_bf16_f32 v88, v88, v89
    v_cvt_pk_bf16_f32 v89, v90, v91
    ds_pk_add_bf16 v7, v88 offset:65408
    ds_pk_add_bf16 v7, v89 offset:65412
    s_mov_b64 exec, s[50:51]
    s_branch L2_d22
L2_c23:
    s_lshl_b64 s[52:53], s[82:83], 1
    s_andn2_b64 s[52:53], s[52:53], s[80:81]
    s_andn2_b64 s[52:53], s[52:53], s[54:55]
    s_or_b64 s[80:81], s[80:81], s[52:53]
    s_not_b64 vcc, s[52:53]
    s_mov_b64 exec, -1
    v_cndmask_b32_dpp v84, v84, v84, vcc wave_shr:1 row_mask:0xf bank_mask:0xf
    v_cndmask_b32_dpp v85, v85, v85, vcc wave_shr:1 row_mask:0xf bank_mask:0xf
    s_lshr_b64 s[52:53], s[52:53], 1
    v_cndmask_b32_dpp v86, v86, v86, vcc wave_shr:1 row_mask:0xf bank_mask:0xf
    v_cndmask_b32_dpp v87, v87, v87, vcc wave_shr:1 row_mask:0xf bank_mask:0xf
    s_andn2_b64 s[82:83], s[82:83], s[52:53]
    v_cndmask_b32_dpp v7, v7, v7, vcc wave_shr:1 row_mask:0xf bank_mask:0xf
    s_mov_b64 exec, s[54:55]
    s_cbranch_scc0 L2_d23
    s_mov_b64 exec, s[82:83]
    s_nop 1
    v_mfma_f32_4x4x4_16b_bf16 v[88:91], v[12:13], v[84:85], 0
    s_nop 1
    v_mfma_f32_4x4x4_16b_bf16 v[88:91], v[10:11], v[86:87], v[88:91]
    s_nop 4
    v_cvt_pk_bf16_f32 v88, v88, v89
    v_cvt_pk_bf16_f32 v89, v90, v91
    ds_pk_add_bf16 v7, v88 offset:65408
    ds_pk_add_bf16 v7, v89 offset:65412
    s_mov_b64 exec, s[54:55]
    s_branch L2_d23
L2_c24:
    s_lshl_b64 s[52:53], s[82:83], 1
    s_andn2_b64 s[52:53], s[52:53], s[80:81]
    s_andn2_b64 s[52:53], s[52:53], s[50:51]
    s_or_b64 s[80:81], s[80:81], s[52:53]
    s_not_b64 vcc, s[52:53]
    s_mov_b64 exec, -1
    v_cndmask_b32_dpp v84, v84, v84, vcc wave_shr:1 row_mask:0xf bank_mask:0xf
    v_cndmask_b32_dpp v85, v85, v85, vcc wave_shr:1 row_mask:0xf bank_mask:0xf
    s_lshr_b64 s[52:53], s[52:53], 1
    v_cndmask_b32_dpp v86, v86, v86, vcc wave_shr:1 row_mask:0xf bank_mask:0xf
    v_cndmask_b32_dpp v87, v87, v87, vcc wave_shr:1 row_mask:0xf bank_mask:0xf
    s_andn2_b64 s[82:83], s[82:83], s[52:53]
    v_cndmask_b32_dpp v7, v7, v7, vcc wave_shr:1 row_mask:0xf bank_mask:0xf
    s_mov_b64 exec, s[50:51]
    s_cbranch_scc0 L2_d24
    s_mov_b64 exec, s[82:83]
    s_nop 1
    v_mfma_f32_4x4x4_16b_bf16 v[88:91], v[12:13], v[84:85], 0
    s_nop 1
    v_mfma_f32_4x4x4_16b_bf16 v[88:91], v[10:11], v[86:87], v[88:91]
    s_nop 4
    v_cvt_pk_bf16_f32 v88, v88, v89
    v_cvt_pk_bf16_f32 v89, v90, v91
    ds_pk_add_bf16 v7, v88 offset:65408
    ds_pk_add_bf16 v7, v89 offset:65412
    s_mov_b64 exec, s[50:51]
    s_branch L2_d24
L2_xa25:
    s_cmp_eq_u32 s101, 1
    s_cbranch_scc1 L2_xc25
    v_lshlrev_b32 v89, 0, v96
    v_add_u32 v90, 140, v97
    v_bitop3_b32 v90, v89, v45, v90 bitop3:0x6a
    ds_write_b32 v98, v90 offset:28
    v_lshlrev_b32 v89, 4, v96
    v_add_u32 v90, 120, v97
    v_bitop3_b32 v90, v89, v45, v90 bitop3:0x6a
    ds_write_b32 v98, v90 offset:24
    v_lshlrev_b32 v89, 8, v96
    v_add_u32 v90, 100, v97
    v_bitop3_b32 v90, v89, v45, v90 bitop3:0x6a
    ds_write_b32 v98, v90 offset:20
L2_xc25:
    v_lshlrev_b32 v89, 12, v96
    v_add_u32 v90, 80, v97
    v_bitop3_b32 v90, v89, v45, v90 bitop3:0x6a
    ds_write_b32 v98, v90 offset:16
    s_branch L2_xb25
L2_xe25:
    v_cmp_lt_u32 vcc, 32, v99
    v_cmp_lt_u32 s[58:59], 31, v88
    v_lshrrev_b32 v89, 16, v96
    v_add_u32 v97, 80, v97
    s_or_b64 vcc, vcc, s[58:59]
    s_cbranch_scc1 L2_xs25
    v_lshlrev_b32 v89, v1, v89
    v_and_b32 v89, v45, v89
    v_cmp_ne_u32 vcc, 0, v89
    v_xor_b32 v90, v97, v89
    s_add_u32 s3, s37, s38
    v_mbcnt_lo_u32_b32 v98, vcc_lo, 0
    v_mbcnt_hi_u32_b32 v98, vcc_hi, v98
    s_bcnt1_i32_b64 s41, vcc
    v_lshl_add_u32 v98, v98, 2, s3
    s_lshl2_add_u32 s37, s41, s37
    s_mov_b64 exec, vcc
    ds_write_b32 v98, v90
    s_mov_b64 exec, -1
    s_branch L2_xr25
L2_xf25:
    s_waitcnt lgkmcnt(0)
    s_cmp_gt_u32 s37, 1024
    s_cbranch_scc1 L2_xs25
    s_cmp_lt_u32 s37, 768
    s_cbranch_scc1 L2_xl25
    ds_read_b32 v32, v98 offset:896
    s_add_u32 s3, s42, 2
    s_bitset1_b32 s43, s3
    s_branch L2_xg25
L2_xl25:
    v_mov_b32 v42, -1
    s_cmp_ge_u32 s37, 512
    s_cbranch_scc1 L2_xg25
    v_mov_b32 v43, -1
    s_cmp_ge_u32 s37, 256
    s_cbranch_scc1 L2_xg25
    v_mov_b32 v41, -1
    s_branch L2_xg25
L2_xs25:
    s_waitcnt lgkmcnt(0)
    v_mov_b32 v40, -1
    v_mov_b32 v41, -1
    v_mov_b32 v43, -1
    v_mov_b32 v42, -1
    s_add_u32 s3, s42, 2
    s_bitset1_b32 s36, s3
    s_branch L2_xg25
L2_c26:
    s_lshl_b64 s[52:53], s[82:83], 1
    s_andn2_b64 s[52:53], s[52:53], s[80:81]
    s_andn2_b64 s[52:53], s[52:53], s[54:55]
    s_or_b64 s[80:81], s[80:81], s[52:53]
    s_not_b64 vcc, s[52:53]
    s_mov_b64 exec, -1
    v_cndmask_b32_dpp v84, v84, v84, vcc wave_shr:1 row_mask:0xf bank_mask:0xf
    v_cndmask_b32_dpp v85, v85, v85, vcc wave_shr:1 row_mask:0xf bank_mask:0xf
    s_lshr_b64 s[52:53], s[52:53], 1
    v_cndmask_b32_dpp v86, v86, v86, vcc wave_shr:1 row_mask:0xf bank_mask:0xf
    v_cndmask_b32_dpp v87, v87, v87, vcc wave_shr:1 row_mask:0xf bank_mask:0xf
    s_andn2_b64 s[82:83], s[82:83], s[52:53]
    v_cndmask_b32_dpp v7, v7, v7, vcc wave_shr:1 row_mask:0xf bank_mask:0xf
    s_mov_b64 exec, s[54:55]
    s_cbranch_scc0 L2_d26
    s_mov_b64 exec, s[82:83]
    s_nop 1
    v_mfma_f32_4x4x4_16b_bf16 v[88:91], v[12:13], v[84:85], 0
    s_nop 1
    v_mfma_f32_4x4x4_16b_bf16 v[88:91], v[10:11], v[86:87], v[88:91]
    s_nop 4
    v_cvt_pk_bf16_f32 v88, v88, v89
    v_cvt_pk_bf16_f32 v89, v90, v91
    ds_pk_add_bf16 v7, v88 offset:65408
    ds_pk_add_bf16 v7, v89 offset:65412
    s_mov_b64 exec, s[54:55]
    s_branch L2_d26
L2_c27:
    s_lshl_b64 s[52:53], s[82:83], 1
    s_andn2_b64 s[52:53], s[52:53], s[80:81]
    s_andn2_b64 s[52:53], s[52:53], s[50:51]
    s_or_b64 s[80:81], s[80:81], s[52:53]
    s_not_b64 vcc, s[52:53]
    s_mov_b64 exec, -1
    v_cndmask_b32_dpp v84, v84, v84, vcc wave_shr:1 row_mask:0xf bank_mask:0xf
    v_cndmask_b32_dpp v85, v85, v85, vcc wave_shr:1 row_mask:0xf bank_mask:0xf
    s_lshr_b64 s[52:53], s[52:53], 1
    v_cndmask_b32_dpp v86, v86, v86, vcc wave_shr:1 row_mask:0xf bank_mask:0xf
    v_cndmask_b32_dpp v87, v87, v87, vcc wave_shr:1 row_mask:0xf bank_mask:0xf
    s_andn2_b64 s[82:83], s[82:83], s[52:53]
    v_cndmask_b32_dpp v7, v7, v7, vcc wave_shr:1 row_mask:0xf bank_mask:0xf
    s_mov_b64 exec, s[50:51]
    s_cbranch_scc0 L2_d27
    s_mov_b64 exec, s[82:83]
    s_nop 1
    v_mfma_f32_4x4x4_16b_bf16 v[88:91], v[12:13], v[84:85], 0
    s_nop 1
    v_mfma_f32_4x4x4_16b_bf16 v[88:91], v[10:11], v[86:87], v[88:91]
    s_nop 4
    v_cvt_pk_bf16_f32 v88, v88, v89
    v_cvt_pk_bf16_f32 v89, v90, v91
    ds_pk_add_bf16 v7, v88 offset:65408
    ds_pk_add_bf16 v7, v89 offset:65412
    s_mov_b64 exec, s[50:51]
    s_branch L2_d27
L2_oa28:
    v_and_b32 v47, 0x0fffffff, v33
    buffer_load_dword v114, v47, s[8:11], 0 offen offset:16
    s_mov_b64 exec, s[6:7]
    v_add_u32 v47, 8, v47
    v_lshrrev_b32 v33, 2, v33
    s_mov_b64 exec, -1
    buffer_load_dwordx2 v[112:113], v47, s[8:11], 0 offen
    s_branch L2_ob28
L2_c29:
    s_lshl_b64 s[52:53], s[82:83], 1
    s_andn2_b64 s[52:53], s[52:53], s[80:81]
    s_andn2_b64 s[52:53], s[52:53], s[54:55]
    s_or_b64 s[80:81], s[80:81], s[52:53]
    s_not_b64 vcc, s[52:53]
    s_mov_b64 exec, -1
    v_cndmask_b32_dpp v84, v84, v84, vcc wave_shr:1 row_mask:0xf bank_mask:0xf
    v_cndmask_b32_dpp v85, v85, v85, vcc wave_shr:1 row_mask:0xf bank_mask:0xf
    s_lshr_b64 s[52:53], s[52:53], 1
    v_cndmask_b32_dpp v86, v86, v86, vcc wave_shr:1 row_mask:0xf bank_mask:0xf
    v_cndmask_b32_dpp v87, v87, v87, vcc wave_shr:1 row_mask:0xf bank_mask:0xf
    s_andn2_b64 s[82:83], s[82:83], s[52:53]
    v_cndmask_b32_dpp v7, v7, v7, vcc wave_shr:1 row_mask:0xf bank_mask:0xf
    s_mov_b64 exec, s[54:55]
    s_cbranch_scc0 L2_d29
    s_mov_b64 exec, s[82:83]
    s_nop 1
    v_mfma_f32_4x4x4_16b_bf16 v[88:91], v[12:13], v[84:85], 0
    s_nop 1
    v_mfma_f32_4x4x4_16b_bf16 v[88:91], v[10:11], v[86:87], v[88:91]
    s_nop 4
    v_cvt_pk_bf16_f32 v88, v88, v89
    v_cvt_pk_bf16_f32 v89, v90, v91
    ds_pk_add_bf16 v7, v88 offset:65408
    ds_pk_add_bf16 v7, v89 offset:65412
    s_mov_b64 exec, s[54:55]
    s_branch L2_d29
L2_c30:
    s_lshl_b64 s[52:53], s[82:83], 1
    s_andn2_b64 s[52:53], s[52:53], s[80:81]
    s_andn2_b64 s[52:53], s[52:53], s[50:51]
    s_or_b64 s[80:81], s[80:81], s[52:53]
    s_not_b64 vcc, s[52:53]
    s_mov_b64 exec, -1
    v_cndmask_b32_dpp v84, v84, v84, vcc wave_shr:1 row_mask:0xf bank_mask:0xf
    v_cndmask_b32_dpp v85, v85, v85, vcc wave_shr:1 row_mask:0xf bank_mask:0xf
    s_lshr_b64 s[52:53], s[52:53], 1
    v_cndmask_b32_dpp v86, v86, v86, vcc wave_shr:1 row_mask:0xf bank_mask:0xf
    v_cndmask_b32_dpp v87, v87, v87, vcc wave_shr:1 row_mask:0xf bank_mask:0xf
    s_andn2_b64 s[82:83], s[82:83], s[52:53]
    v_cndmask_b32_dpp v7, v7, v7, vcc wave_shr:1 row_mask:0xf bank_mask:0xf
    s_mov_b64 exec, s[50:51]
    s_cbranch_scc0 L2_d30
    s_mov_b64 exec, s[82:83]
    s_nop 1
    v_mfma_f32_4x4x4_16b_bf16 v[88:91], v[12:13], v[84:85], 0
    s_nop 1
    v_mfma_f32_4x4x4_16b_bf16 v[88:91], v[10:11], v[86:87], v[88:91]
    s_nop 4
    v_cvt_pk_bf16_f32 v88, v88, v89
    v_cvt_pk_bf16_f32 v89, v90, v91
    ds_pk_add_bf16 v7, v88 offset:65408
    ds_pk_add_bf16 v7, v89 offset:65412
    s_mov_b64 exec, s[50:51]
    s_branch L2_d30
L2_c31:
    s_lshl_b64 s[52:53], s[82:83], 1
    s_andn2_b64 s[52:53], s[52:53], s[80:81]
    s_andn2_b64 s[52:53], s[52:53], s[54:55]
    s_or_b64 s[80:81], s[80:81], s[52:53]
    s_not_b64 vcc, s[52:53]
    s_mov_b64 exec, -1
    v_cndmask_b32_dpp v84, v84, v84, vcc wave_shr:1 row_mask:0xf bank_mask:0xf
    v_cndmask_b32_dpp v85, v85, v85, vcc wave_shr:1 row_mask:0xf bank_mask:0xf
    s_lshr_b64 s[52:53], s[52:53], 1
    v_cndmask_b32_dpp v86, v86, v86, vcc wave_shr:1 row_mask:0xf bank_mask:0xf
    v_cndmask_b32_dpp v87, v87, v87, vcc wave_shr:1 row_mask:0xf bank_mask:0xf
    s_andn2_b64 s[82:83], s[82:83], s[52:53]
    v_cndmask_b32_dpp v7, v7, v7, vcc wave_shr:1 row_mask:0xf bank_mask:0xf
    s_mov_b64 exec, s[54:55]
    s_cbranch_scc0 L2_d31
    s_mov_b64 exec, s[82:83]
    s_nop 1
    v_mfma_f32_4x4x4_16b_bf16 v[88:91], v[12:13], v[84:85], 0
    s_nop 1
    v_mfma_f32_4x4x4_16b_bf16 v[88:91], v[10:11], v[86:87], v[88:91]
    s_nop 4
    v_cvt_pk_bf16_f32 v88, v88, v89
    v_cvt_pk_bf16_f32 v89, v90, v91
    ds_pk_add_bf16 v7, v88 offset:65408
    ds_pk_add_bf16 v7, v89 offset:65412
    s_mov_b64 exec, s[54:55]
    s_branch L2_d31
L2_c32:
    s_lshl_b64 s[52:53], s[82:83], 1
    s_andn2_b64 s[52:53], s[52:53], s[80:81]
    s_andn2_b64 s[52:53], s[52:53], s[50:51]
    s_or_b64 s[80:81], s[80:81], s[52:53]
    s_not_b64 vcc, s[52:53]
    s_mov_b64 exec, -1
    v_cndmask_b32_dpp v84, v84, v84, vcc wave_shr:1 row_mask:0xf bank_mask:0xf
    v_cndmask_b32_dpp v85, v85, v85, vcc wave_shr:1 row_mask:0xf bank_mask:0xf
    s_lshr_b64 s[52:53], s[52:53], 1
    v_cndmask_b32_dpp v86, v86, v86, vcc wave_shr:1 row_mask:0xf bank_mask:0xf
    v_cndmask_b32_dpp v87, v87, v87, vcc wave_shr:1 row_mask:0xf bank_mask:0xf
    s_andn2_b64 s[82:83], s[82:83], s[52:53]
    v_cndmask_b32_dpp v7, v7, v7, vcc wave_shr:1 row_mask:0xf bank_mask:0xf
    s_mov_b64 exec, s[50:51]
    s_cbranch_scc0 L2_d32
    s_mov_b64 exec, s[82:83]
    s_nop 1
    v_mfma_f32_4x4x4_16b_bf16 v[88:91], v[12:13], v[84:85], 0
    s_nop 1
    v_mfma_f32_4x4x4_16b_bf16 v[88:91], v[10:11], v[86:87], v[88:91]
    s_nop 4
    v_cvt_pk_bf16_f32 v88, v88, v89
    v_cvt_pk_bf16_f32 v89, v90, v91
    ds_pk_add_bf16 v7, v88 offset:65408
    ds_pk_add_bf16 v7, v89 offset:65412
    s_mov_b64 exec, s[50:51]
    s_branch L2_d32
L2_c33:
    s_lshl_b64 s[52:53], s[82:83], 1
    s_andn2_b64 s[52:53], s[52:53], s[80:81]
    s_andn2_b64 s[52:53], s[52:53], s[54:55]
    s_or_b64 s[80:81], s[80:81], s[52:53]
    s_not_b64 vcc, s[52:53]
    s_mov_b64 exec, -1
    v_cndmask_b32_dpp v84, v84, v84, vcc wave_shr:1 row_mask:0xf bank_mask:0xf
    v_cndmask_b32_dpp v85, v85, v85, vcc wave_shr:1 row_mask:0xf bank_mask:0xf
    s_lshr_b64 s[52:53], s[52:53], 1
    v_cndmask_b32_dpp v86, v86, v86, vcc wave_shr:1 row_mask:0xf bank_mask:0xf
    v_cndmask_b32_dpp v87, v87, v87, vcc wave_shr:1 row_mask:0xf bank_mask:0xf
    s_andn2_b64 s[82:83], s[82:83], s[52:53]
    v_cndmask_b32_dpp v7, v7, v7, vcc wave_shr:1 row_mask:0xf bank_mask:0xf
    s_mov_b64 exec, s[54:55]
    s_cbranch_scc0 L2_d33
    s_mov_b64 exec, s[82:83]
    s_nop 1
    v_mfma_f32_4x4x4_16b_bf16 v[88:91], v[12:13], v[84:85], 0
    s_nop 1
    v_mfma_f32_4x4x4_16b_bf16 v[88:91], v[10:11], v[86:87], v[88:91]
    s_nop 4
    v_cvt_pk_bf16_f32 v88, v88, v89
    v_cvt_pk_bf16_f32 v89, v90, v91
    ds_pk_add_bf16 v7, v88 offset:65408
    ds_pk_add_bf16 v7, v89 offset:65412
    s_mov_b64 exec, s[54:55]
    s_branch L2_d33
L2_c34:
    s_lshl_b64 s[52:53], s[82:83], 1
    s_andn2_b64 s[52:53], s[52:53], s[80:81]
    s_andn2_b64 s[52:53], s[52:53], s[50:51]
    s_or_b64 s[80:81], s[80:81], s[52:53]
    s_not_b64 vcc, s[52:53]
    s_mov_b64 exec, -1
    v_cndmask_b32_dpp v84, v84, v84, vcc wave_shr:1 row_mask:0xf bank_mask:0xf
    v_cndmask_b32_dpp v85, v85, v85, vcc wave_shr:1 row_mask:0xf bank_mask:0xf
    s_lshr_b64 s[52:53], s[52:53], 1
    v_cndmask_b32_dpp v86, v86, v86, vcc wave_shr:1 row_mask:0xf bank_mask:0xf
    v_cndmask_b32_dpp v87, v87, v87, vcc wave_shr:1 row_mask:0xf bank_mask:0xf
    s_andn2_b64 s[82:83], s[82:83], s[52:53]
    v_cndmask_b32_dpp v7, v7, v7, vcc wave_shr:1 row_mask:0xf bank_mask:0xf
    s_mov_b64 exec, s[50:51]
    s_cbranch_scc0 L2_d34
    s_mov_b64 exec, s[82:83]
    s_nop 1
    v_mfma_f32_4x4x4_16b_bf16 v[88:91], v[12:13], v[84:85], 0
    s_nop 1
    v_mfma_f32_4x4x4_16b_bf16 v[88:91], v[10:11], v[86:87], v[88:91]
    s_nop 4
    v_cvt_pk_bf16_f32 v88, v88, v89
    v_cvt_pk_bf16_f32 v89, v90, v91
    ds_pk_add_bf16 v7, v88 offset:65408
    ds_pk_add_bf16 v7, v89 offset:65412
    s_mov_b64 exec, s[50:51]
    s_branch L2_d34
L2_oa35:
    s_waitcnt vmcnt(5)
    s_mov_b64 exec, s[6:7]
    v_lshrrev_b32 v114, 16, v114
    s_mov_b64 exec, -1
    v_and_b32 v46, 0x10000000, v33
    v_cmpx_eq_u32 vcc, 0, v46
    v_lshrrev_b32 v47, 14, v112
    v_and_b32 v47, v5, v47
    ds_read_b64 v[96:97], v47
    v_perm_b32 v98, v112, v114, s44
    v_bitop3_b32 v99, v112, 0.5, -0.5 bitop3:0xa8
    v_bitop3_b32 v98, v6, v98, v99 bitop3:0xca
    v_and_b32 v47, v5, v112
    s_waitcnt lgkmcnt(0)
    v_mfma_f32_4x4x4_16b_bf16 v[88:91], v[8:9], v[96:97], 0
    s_nop 4
    v_mul_f32 v88, v98, v88
    v_mul_f32 v89, v98, v89
    v_mul_f32 v90, v98, v90
    v_mul_f32 v91, v98, v91
    v_cvt_pk_bf16_f32 v88, v88, v89
    v_cvt_pk_bf16_f32 v89, v90, v91
    ds_pk_add_bf16 v47, v88 offset:65408
    ds_pk_add_bf16 v47, v89 offset:65412
    s_mov_b64 exec, -1
    v_and_b32 v46, 0x20000000, v33
    v_cmpx_eq_u32 vcc, 0, v46
    v_lshrrev_b32 v47, 14, v113
    v_and_b32 v47, v5, v47
    ds_read_b64 v[96:97], v47
    v_perm_b32 v98, v113, v114, s45
    v_bitop3_b32 v99, v113, 0.5, -0.5 bitop3:0xa8
    v_bitop3_b32 v98, v6, v98, v99 bitop3:0xca
    v_and_b32 v47, v5, v113
    s_waitcnt lgkmcnt(0)
    v_mfma_f32_4x4x4_16b_bf16 v[88:91], v[8:9], v[96:97], 0
    s_nop 4
    v_mul_f32 v88, v98, v88
    v_mul_f32 v89, v98, v89
    v_mul_f32 v90, v98, v90
    v_mul_f32 v91, v98, v91
    v_cvt_pk_bf16_f32 v88, v88, v89
    v_cvt_pk_bf16_f32 v89, v90, v91
    ds_pk_add_bf16 v47, v88 offset:65408
    ds_pk_add_bf16 v47, v89 offset:65412
    s_mov_b64 exec, -1
    s_branch L2_ob35
L2_xo36:
    v_cmp_lt_u32 vcc, 20, v99
    s_mov_b32 s101, 1
    s_cbranch_vccz L2_xp36
    v_cmp_lt_u32 vcc, 32, v99
    v_cmp_lt_u32 s[58:59], 31, v88
    s_mov_b32 s101, 2
    s_or_b64 vcc, vcc, s[58:59]
    s_cbranch_scc0 L2_xp36
    s_mov_b32 s37, 0x10000
    s_branch L2_xp36
L2_c37:
    s_lshl_b64 s[52:53], s[82:83], 1
    s_andn2_b64 s[52:53], s[52:53], s[80:81]
    s_andn2_b64 s[52:53], s[52:53], s[54:55]
    s_or_b64 s[80:81], s[80:81], s[52:53]
    s_not_b64 vcc, s[52:53]
    s_mov_b64 exec, -1
    v_cndmask_b32_dpp v84, v84, v84, vcc wave_shr:1 row_mask:0xf bank_mask:0xf
    v_cndmask_b32_dpp v85, v85, v85, vcc wave_shr:1 row_mask:0xf bank_mask:0xf
    s_lshr_b64 s[52:53], s[52:53], 1
    v_cndmask_b32_dpp v86, v86, v86, vcc wave_shr:1 row_mask:0xf bank_mask:0xf
    v_cndmask_b32_dpp v87, v87, v87, vcc wave_shr:1 row_mask:0xf bank_mask:0xf
    s_andn2_b64 s[82:83], s[82:83], s[52:53]
    v_cndmask_b32_dpp v7, v7, v7, vcc wave_shr:1 row_mask:0xf bank_mask:0xf
    s_mov_b64 exec, s[54:55]
    s_cbranch_scc0 L2_d37
    s_mov_b64 exec, s[82:83]
    s_nop 1
    v_mfma_f32_4x4x4_16b_bf16 v[88:91], v[12:13], v[84:85], 0
    s_nop 1
    v_mfma_f32_4x4x4_16b_bf16 v[88:91], v[10:11], v[86:87], v[88:91]
    s_nop 4
    v_cvt_pk_bf16_f32 v88, v88, v89
    v_cvt_pk_bf16_f32 v89, v90, v91
    ds_pk_add_bf16 v7, v88 offset:65408
    ds_pk_add_bf16 v7, v89 offset:65412
    s_mov_b64 exec, s[54:55]
    s_branch L2_d37
L2_c38:
    s_lshl_b64 s[52:53], s[82:83], 1
    s_andn2_b64 s[52:53], s[52:53], s[80:81]
    s_andn2_b64 s[52:53], s[52:53], s[50:51]
    s_or_b64 s[80:81], s[80:81], s[52:53]
    s_not_b64 vcc, s[52:53]
    s_mov_b64 exec, -1
    v_cndmask_b32_dpp v84, v84, v84, vcc wave_shr:1 row_mask:0xf bank_mask:0xf
    v_cndmask_b32_dpp v85, v85, v85, vcc wave_shr:1 row_mask:0xf bank_mask:0xf
    s_lshr_b64 s[52:53], s[52:53], 1
    v_cndmask_b32_dpp v86, v86, v86, vcc wave_shr:1 row_mask:0xf bank_mask:0xf
    v_cndmask_b32_dpp v87, v87, v87, vcc wave_shr:1 row_mask:0xf bank_mask:0xf
    s_andn2_b64 s[82:83], s[82:83], s[52:53]
    v_cndmask_b32_dpp v7, v7, v7, vcc wave_shr:1 row_mask:0xf bank_mask:0xf
    s_mov_b64 exec, s[50:51]
    s_cbranch_scc0 L2_d38
    s_mov_b64 exec, s[82:83]
    s_nop 1
    v_mfma_f32_4x4x4_16b_bf16 v[88:91], v[12:13], v[84:85], 0
    s_nop 1
    v_mfma_f32_4x4x4_16b_bf16 v[88:91], v[10:11], v[86:87], v[88:91]
    s_nop 4
    v_cvt_pk_bf16_f32 v88, v88, v89
    v_cvt_pk_bf16_f32 v89, v90, v91
    ds_pk_add_bf16 v7, v88 offset:65408
    ds_pk_add_bf16 v7, v89 offset:65412
    s_mov_b64 exec, s[50:51]
    s_branch L2_d38
L2_c39:
    s_lshl_b64 s[52:53], s[82:83], 1
    s_andn2_b64 s[52:53], s[52:53], s[80:81]
    s_andn2_b64 s[52:53], s[52:53], s[54:55]
    s_or_b64 s[80:81], s[80:81], s[52:53]
    s_not_b64 vcc, s[52:53]
    s_mov_b64 exec, -1
    v_cndmask_b32_dpp v84, v84, v84, vcc wave_shr:1 row_mask:0xf bank_mask:0xf
    v_cndmask_b32_dpp v85, v85, v85, vcc wave_shr:1 row_mask:0xf bank_mask:0xf
    s_lshr_b64 s[52:53], s[52:53], 1
    v_cndmask_b32_dpp v86, v86, v86, vcc wave_shr:1 row_mask:0xf bank_mask:0xf
    v_cndmask_b32_dpp v87, v87, v87, vcc wave_shr:1 row_mask:0xf bank_mask:0xf
    s_andn2_b64 s[82:83], s[82:83], s[52:53]
    v_cndmask_b32_dpp v7, v7, v7, vcc wave_shr:1 row_mask:0xf bank_mask:0xf
    s_mov_b64 exec, s[54:55]
    s_cbranch_scc0 L2_d39
    s_mov_b64 exec, s[82:83]
    s_nop 1
    v_mfma_f32_4x4x4_16b_bf16 v[88:91], v[12:13], v[84:85], 0
    s_nop 1
    v_mfma_f32_4x4x4_16b_bf16 v[88:91], v[10:11], v[86:87], v[88:91]
    s_nop 4
    v_cvt_pk_bf16_f32 v88, v88, v89
    v_cvt_pk_bf16_f32 v89, v90, v91
    ds_pk_add_bf16 v7, v88 offset:65408
    ds_pk_add_bf16 v7, v89 offset:65412
    s_mov_b64 exec, s[54:55]
    s_branch L2_d39
L2_c40:
    s_lshl_b64 s[52:53], s[82:83], 1
    s_andn2_b64 s[52:53], s[52:53], s[80:81]
    s_andn2_b64 s[52:53], s[52:53], s[50:51]
    s_or_b64 s[80:81], s[80:81], s[52:53]
    s_not_b64 vcc, s[52:53]
    s_mov_b64 exec, -1
    v_cndmask_b32_dpp v84, v84, v84, vcc wave_shr:1 row_mask:0xf bank_mask:0xf
    v_cndmask_b32_dpp v85, v85, v85, vcc wave_shr:1 row_mask:0xf bank_mask:0xf
    s_lshr_b64 s[52:53], s[52:53], 1
    v_cndmask_b32_dpp v86, v86, v86, vcc wave_shr:1 row_mask:0xf bank_mask:0xf
    v_cndmask_b32_dpp v87, v87, v87, vcc wave_shr:1 row_mask:0xf bank_mask:0xf
    s_andn2_b64 s[82:83], s[82:83], s[52:53]
    v_cndmask_b32_dpp v7, v7, v7, vcc wave_shr:1 row_mask:0xf bank_mask:0xf
    s_mov_b64 exec, s[50:51]
    s_cbranch_scc0 L2_d40
    s_mov_b64 exec, s[82:83]
    s_nop 1
    v_mfma_f32_4x4x4_16b_bf16 v[88:91], v[12:13], v[84:85], 0
    s_nop 1
    v_mfma_f32_4x4x4_16b_bf16 v[88:91], v[10:11], v[86:87], v[88:91]
    s_nop 4
    v_cvt_pk_bf16_f32 v88, v88, v89
    v_cvt_pk_bf16_f32 v89, v90, v91
    ds_pk_add_bf16 v7, v88 offset:65408
    ds_pk_add_bf16 v7, v89 offset:65412
    s_mov_b64 exec, s[50:51]
    s_branch L2_d40
L2_c41:
    s_lshl_b64 s[52:53], s[82:83], 1
    s_andn2_b64 s[52:53], s[52:53], s[80:81]
    s_andn2_b64 s[52:53], s[52:53], s[54:55]
    s_or_b64 s[80:81], s[80:81], s[52:53]
    s_not_b64 vcc, s[52:53]
    s_mov_b64 exec, -1
    v_cndmask_b32_dpp v84, v84, v84, vcc wave_shr:1 row_mask:0xf bank_mask:0xf
    v_cndmask_b32_dpp v85, v85, v85, vcc wave_shr:1 row_mask:0xf bank_mask:0xf
    s_lshr_b64 s[52:53], s[52:53], 1
    v_cndmask_b32_dpp v86, v86, v86, vcc wave_shr:1 row_mask:0xf bank_mask:0xf
    v_cndmask_b32_dpp v87, v87, v87, vcc wave_shr:1 row_mask:0xf bank_mask:0xf
    s_andn2_b64 s[82:83], s[82:83], s[52:53]
    v_cndmask_b32_dpp v7, v7, v7, vcc wave_shr:1 row_mask:0xf bank_mask:0xf
    s_mov_b64 exec, s[54:55]
    s_cbranch_scc0 L2_d41
    s_mov_b64 exec, s[82:83]
    s_nop 1
    v_mfma_f32_4x4x4_16b_bf16 v[88:91], v[12:13], v[84:85], 0
    s_nop 1
    v_mfma_f32_4x4x4_16b_bf16 v[88:91], v[10:11], v[86:87], v[88:91]
    s_nop 4
    v_cvt_pk_bf16_f32 v88, v88, v89
    v_cvt_pk_bf16_f32 v89, v90, v91
    ds_pk_add_bf16 v7, v88 offset:65408
    ds_pk_add_bf16 v7, v89 offset:65412
    s_mov_b64 exec, s[54:55]
    s_branch L2_d41
L2_c42:
    s_lshl_b64 s[52:53], s[82:83], 1
    s_andn2_b64 s[52:53], s[52:53], s[80:81]
    s_andn2_b64 s[52:53], s[52:53], s[50:51]
    s_or_b64 s[80:81], s[80:81], s[52:53]
    s_not_b64 vcc, s[52:53]
    s_mov_b64 exec, -1
    v_cndmask_b32_dpp v84, v84, v84, vcc wave_shr:1 row_mask:0xf bank_mask:0xf
    v_cndmask_b32_dpp v85, v85, v85, vcc wave_shr:1 row_mask:0xf bank_mask:0xf
    s_lshr_b64 s[52:53], s[52:53], 1
    v_cndmask_b32_dpp v86, v86, v86, vcc wave_shr:1 row_mask:0xf bank_mask:0xf
    v_cndmask_b32_dpp v87, v87, v87, vcc wave_shr:1 row_mask:0xf bank_mask:0xf
    s_andn2_b64 s[82:83], s[82:83], s[52:53]
    v_cndmask_b32_dpp v7, v7, v7, vcc wave_shr:1 row_mask:0xf bank_mask:0xf
    s_mov_b64 exec, s[50:51]
    s_cbranch_scc0 L2_d42
    s_mov_b64 exec, s[82:83]
    s_nop 1
    v_mfma_f32_4x4x4_16b_bf16 v[88:91], v[12:13], v[84:85], 0
    s_nop 1
    v_mfma_f32_4x4x4_16b_bf16 v[88:91], v[10:11], v[86:87], v[88:91]
    s_nop 4
    v_cvt_pk_bf16_f32 v88, v88, v89
    v_cvt_pk_bf16_f32 v89, v90, v91
    ds_pk_add_bf16 v7, v88 offset:65408
    ds_pk_add_bf16 v7, v89 offset:65412
    s_mov_b64 exec, s[50:51]
    s_branch L2_d42
L2_xa43:
    s_cmp_eq_u32 s101, 1
    s_cbranch_scc1 L2_xc43
    v_lshlrev_b32 v89, 0, v96
    v_add_u32 v90, 140, v97
    v_bitop3_b32 v90, v89, v45, v90 bitop3:0x6a
    ds_write_b32 v98, v90 offset:28
    v_lshlrev_b32 v89, 4, v96
    v_add_u32 v90, 120, v97
    v_bitop3_b32 v90, v89, v45, v90 bitop3:0x6a
    ds_write_b32 v98, v90 offset:24
    v_lshlrev_b32 v89, 8, v96
    v_add_u32 v90, 100, v97
    v_bitop3_b32 v90, v89, v45, v90 bitop3:0x6a
    ds_write_b32 v98, v90 offset:20
L2_xc43:
    v_lshlrev_b32 v89, 12, v96
    v_add_u32 v90, 80, v97
    v_bitop3_b32 v90, v89, v45, v90 bitop3:0x6a
    ds_write_b32 v98, v90 offset:16
    s_branch L2_xb43
L2_xe43:
    v_cmp_lt_u32 vcc, 32, v99
    v_cmp_lt_u32 s[58:59], 31, v88
    v_lshrrev_b32 v89, 16, v96
    v_add_u32 v97, 80, v97
    s_or_b64 vcc, vcc, s[58:59]
    s_cbranch_scc1 L2_xs43
    v_lshlrev_b32 v89, v1, v89
    v_and_b32 v89, v45, v89
    v_cmp_ne_u32 vcc, 0, v89
    v_xor_b32 v90, v97, v89
    s_add_u32 s3, s37, s38
    v_mbcnt_lo_u32_b32 v98, vcc_lo, 0
    v_mbcnt_hi_u32_b32 v98, vcc_hi, v98
    s_bcnt1_i32_b64 s41, vcc
    v_lshl_add_u32 v98, v98, 2, s3
    s_lshl2_add_u32 s37, s41, s37
    s_mov_b64 exec, vcc
    ds_write_b32 v98, v90
    s_mov_b64 exec, -1
    s_branch L2_xr43
L2_xf43:
    s_waitcnt lgkmcnt(0)
    s_cmp_gt_u32 s37, 1024
    s_cbranch_scc1 L2_xs43
    s_cmp_lt_u32 s37, 768
    s_cbranch_scc1 L2_xl43
    ds_read_b32 v33, v98 offset:896
    s_add_u32 s3, s42, 2
    s_bitset1_b32 s43, s3
    s_branch L2_xg43
L2_xl43:
    v_mov_b32 v42, -1
    s_cmp_ge_u32 s37, 512
    s_cbranch_scc1 L2_xg43
    v_mov_b32 v43, -1
    s_cmp_ge_u32 s37, 256
    s_cbranch_scc1 L2_xg43
    v_mov_b32 v41, -1
    s_branch L2_xg43
L2_xs43:
    s_waitcnt lgkmcnt(0)
    v_mov_b32 v40, -1
    v_mov_b32 v41, -1
    v_mov_b32 v43, -1
    v_mov_b32 v42, -1
    s_add_u32 s3, s42, 2
    s_bitset1_b32 s36, s3
    s_branch L2_xg43
L2_c44:
    s_lshl_b64 s[52:53], s[82:83], 1
    s_andn2_b64 s[52:53], s[52:53], s[80:81]
    s_andn2_b64 s[52:53], s[52:53], s[54:55]
    s_or_b64 s[80:81], s[80:81], s[52:53]
    s_not_b64 vcc, s[52:53]
    s_mov_b64 exec, -1
    v_cndmask_b32_dpp v84, v84, v84, vcc wave_shr:1 row_mask:0xf bank_mask:0xf
    v_cndmask_b32_dpp v85, v85, v85, vcc wave_shr:1 row_mask:0xf bank_mask:0xf
    s_lshr_b64 s[52:53], s[52:53], 1
    v_cndmask_b32_dpp v86, v86, v86, vcc wave_shr:1 row_mask:0xf bank_mask:0xf
    v_cndmask_b32_dpp v87, v87, v87, vcc wave_shr:1 row_mask:0xf bank_mask:0xf
    s_andn2_b64 s[82:83], s[82:83], s[52:53]
    v_cndmask_b32_dpp v7, v7, v7, vcc wave_shr:1 row_mask:0xf bank_mask:0xf
    s_mov_b64 exec, s[54:55]
    s_cbranch_scc0 L2_d44
    s_mov_b64 exec, s[82:83]
    s_nop 1
    v_mfma_f32_4x4x4_16b_bf16 v[88:91], v[12:13], v[84:85], 0
    s_nop 1
    v_mfma_f32_4x4x4_16b_bf16 v[88:91], v[10:11], v[86:87], v[88:91]
    s_nop 4
    v_cvt_pk_bf16_f32 v88, v88, v89
    v_cvt_pk_bf16_f32 v89, v90, v91
    ds_pk_add_bf16 v7, v88 offset:65408
    ds_pk_add_bf16 v7, v89 offset:65412
    s_mov_b64 exec, s[54:55]
    s_branch L2_d44
L2_c45:
    s_lshl_b64 s[52:53], s[82:83], 1
    s_andn2_b64 s[52:53], s[52:53], s[80:81]
    s_andn2_b64 s[52:53], s[52:53], s[50:51]
    s_or_b64 s[80:81], s[80:81], s[52:53]
    s_not_b64 vcc, s[52:53]
    s_mov_b64 exec, -1
    v_cndmask_b32_dpp v84, v84, v84, vcc wave_shr:1 row_mask:0xf bank_mask:0xf
    v_cndmask_b32_dpp v85, v85, v85, vcc wave_shr:1 row_mask:0xf bank_mask:0xf
    s_lshr_b64 s[52:53], s[52:53], 1
    v_cndmask_b32_dpp v86, v86, v86, vcc wave_shr:1 row_mask:0xf bank_mask:0xf
    v_cndmask_b32_dpp v87, v87, v87, vcc wave_shr:1 row_mask:0xf bank_mask:0xf
    s_andn2_b64 s[82:83], s[82:83], s[52:53]
    v_cndmask_b32_dpp v7, v7, v7, vcc wave_shr:1 row_mask:0xf bank_mask:0xf
    s_mov_b64 exec, s[50:51]
    s_cbranch_scc0 L2_d45
    s_mov_b64 exec, s[82:83]
    s_nop 1
    v_mfma_f32_4x4x4_16b_bf16 v[88:91], v[12:13], v[84:85], 0
    s_nop 1
    v_mfma_f32_4x4x4_16b_bf16 v[88:91], v[10:11], v[86:87], v[88:91]
    s_nop 4
    v_cvt_pk_bf16_f32 v88, v88, v89
    v_cvt_pk_bf16_f32 v89, v90, v91
    ds_pk_add_bf16 v7, v88 offset:65408
    ds_pk_add_bf16 v7, v89 offset:65412
    s_mov_b64 exec, s[50:51]
    s_branch L2_d45
L2_oa46:
    v_and_b32 v47, 0x0fffffff, v32
    buffer_load_dword v114, v47, s[8:11], 0 offen offset:16
    s_mov_b64 exec, s[6:7]
    v_add_u32 v47, 8, v47
    v_lshrrev_b32 v32, 2, v32
    s_mov_b64 exec, -1
    buffer_load_dwordx2 v[112:113], v47, s[8:11], 0 offen
    s_branch L2_ob46
L2_c47:
    s_lshl_b64 s[52:53], s[82:83], 1
    s_andn2_b64 s[52:53], s[52:53], s[80:81]
    s_andn2_b64 s[52:53], s[52:53], s[54:55]
    s_or_b64 s[80:81], s[80:81], s[52:53]
    s_not_b64 vcc, s[52:53]
    s_mov_b64 exec, -1
    v_cndmask_b32_dpp v84, v84, v84, vcc wave_shr:1 row_mask:0xf bank_mask:0xf
    v_cndmask_b32_dpp v85, v85, v85, vcc wave_shr:1 row_mask:0xf bank_mask:0xf
    s_lshr_b64 s[52:53], s[52:53], 1
    v_cndmask_b32_dpp v86, v86, v86, vcc wave_shr:1 row_mask:0xf bank_mask:0xf
    v_cndmask_b32_dpp v87, v87, v87, vcc wave_shr:1 row_mask:0xf bank_mask:0xf
    s_andn2_b64 s[82:83], s[82:83], s[52:53]
    v_cndmask_b32_dpp v7, v7, v7, vcc wave_shr:1 row_mask:0xf bank_mask:0xf
    s_mov_b64 exec, s[54:55]
    s_cbranch_scc0 L2_d47
    s_mov_b64 exec, s[82:83]
    s_nop 1
    v_mfma_f32_4x4x4_16b_bf16 v[88:91], v[12:13], v[84:85], 0
    s_nop 1
    v_mfma_f32_4x4x4_16b_bf16 v[88:91], v[10:11], v[86:87], v[88:91]
    s_nop 4
    v_cvt_pk_bf16_f32 v88, v88, v89
    v_cvt_pk_bf16_f32 v89, v90, v91
    ds_pk_add_bf16 v7, v88 offset:65408
    ds_pk_add_bf16 v7, v89 offset:65412
    s_mov_b64 exec, s[54:55]
    s_branch L2_d47
L2_c48:
    s_lshl_b64 s[52:53], s[82:83], 1
    s_andn2_b64 s[52:53], s[52:53], s[80:81]
    s_andn2_b64 s[52:53], s[52:53], s[50:51]
    s_or_b64 s[80:81], s[80:81], s[52:53]
    s_not_b64 vcc, s[52:53]
    s_mov_b64 exec, -1
    v_cndmask_b32_dpp v84, v84, v84, vcc wave_shr:1 row_mask:0xf bank_mask:0xf
    v_cndmask_b32_dpp v85, v85, v85, vcc wave_shr:1 row_mask:0xf bank_mask:0xf
    s_lshr_b64 s[52:53], s[52:53], 1
    v_cndmask_b32_dpp v86, v86, v86, vcc wave_shr:1 row_mask:0xf bank_mask:0xf
    v_cndmask_b32_dpp v87, v87, v87, vcc wave_shr:1 row_mask:0xf bank_mask:0xf
    s_andn2_b64 s[82:83], s[82:83], s[52:53]
    v_cndmask_b32_dpp v7, v7, v7, vcc wave_shr:1 row_mask:0xf bank_mask:0xf
    s_mov_b64 exec, s[50:51]
    s_cbranch_scc0 L2_d48
    s_mov_b64 exec, s[82:83]
    s_nop 1
    v_mfma_f32_4x4x4_16b_bf16 v[88:91], v[12:13], v[84:85], 0
    s_nop 1
    v_mfma_f32_4x4x4_16b_bf16 v[88:91], v[10:11], v[86:87], v[88:91]
    s_nop 4
    v_cvt_pk_bf16_f32 v88, v88, v89
    v_cvt_pk_bf16_f32 v89, v90, v91
    ds_pk_add_bf16 v7, v88 offset:65408
    ds_pk_add_bf16 v7, v89 offset:65412
    s_mov_b64 exec, s[50:51]
    s_branch L2_d48
L2_c49:
    s_lshl_b64 s[52:53], s[82:83], 1
    s_andn2_b64 s[52:53], s[52:53], s[80:81]
    s_andn2_b64 s[52:53], s[52:53], s[54:55]
    s_or_b64 s[80:81], s[80:81], s[52:53]
    s_not_b64 vcc, s[52:53]
    s_mov_b64 exec, -1
    v_cndmask_b32_dpp v84, v84, v84, vcc wave_shr:1 row_mask:0xf bank_mask:0xf
    v_cndmask_b32_dpp v85, v85, v85, vcc wave_shr:1 row_mask:0xf bank_mask:0xf
    s_lshr_b64 s[52:53], s[52:53], 1
    v_cndmask_b32_dpp v86, v86, v86, vcc wave_shr:1 row_mask:0xf bank_mask:0xf
    v_cndmask_b32_dpp v87, v87, v87, vcc wave_shr:1 row_mask:0xf bank_mask:0xf
    s_andn2_b64 s[82:83], s[82:83], s[52:53]
    v_cndmask_b32_dpp v7, v7, v7, vcc wave_shr:1 row_mask:0xf bank_mask:0xf
    s_mov_b64 exec, s[54:55]
    s_cbranch_scc0 L2_d49
    s_mov_b64 exec, s[82:83]
    s_nop 1
    v_mfma_f32_4x4x4_16b_bf16 v[88:91], v[12:13], v[84:85], 0
    s_nop 1
    v_mfma_f32_4x4x4_16b_bf16 v[88:91], v[10:11], v[86:87], v[88:91]
    s_nop 4
    v_cvt_pk_bf16_f32 v88, v88, v89
    v_cvt_pk_bf16_f32 v89, v90, v91
    ds_pk_add_bf16 v7, v88 offset:65408
    ds_pk_add_bf16 v7, v89 offset:65412
    s_mov_b64 exec, s[54:55]
    s_branch L2_d49
L2_c50:
    s_lshl_b64 s[52:53], s[82:83], 1
    s_andn2_b64 s[52:53], s[52:53], s[80:81]
    s_andn2_b64 s[52:53], s[52:53], s[50:51]
    s_or_b64 s[80:81], s[80:81], s[52:53]
    s_not_b64 vcc, s[52:53]
    s_mov_b64 exec, -1
    v_cndmask_b32_dpp v84, v84, v84, vcc wave_shr:1 row_mask:0xf bank_mask:0xf
    v_cndmask_b32_dpp v85, v85, v85, vcc wave_shr:1 row_mask:0xf bank_mask:0xf
    s_lshr_b64 s[52:53], s[52:53], 1
    v_cndmask_b32_dpp v86, v86, v86, vcc wave_shr:1 row_mask:0xf bank_mask:0xf
    v_cndmask_b32_dpp v87, v87, v87, vcc wave_shr:1 row_mask:0xf bank_mask:0xf
    s_andn2_b64 s[82:83], s[82:83], s[52:53]
    v_cndmask_b32_dpp v7, v7, v7, vcc wave_shr:1 row_mask:0xf bank_mask:0xf
    s_mov_b64 exec, s[50:51]
    s_cbranch_scc0 L2_d50
    s_mov_b64 exec, s[82:83]
    s_nop 1
    v_mfma_f32_4x4x4_16b_bf16 v[88:91], v[12:13], v[84:85], 0
    s_nop 1
    v_mfma_f32_4x4x4_16b_bf16 v[88:91], v[10:11], v[86:87], v[88:91]
    s_nop 4
    v_cvt_pk_bf16_f32 v88, v88, v89
    v_cvt_pk_bf16_f32 v89, v90, v91
    ds_pk_add_bf16 v7, v88 offset:65408
    ds_pk_add_bf16 v7, v89 offset:65412
    s_mov_b64 exec, s[50:51]
    s_branch L2_d50
L2_c51:
    s_lshl_b64 s[52:53], s[82:83], 1
    s_andn2_b64 s[52:53], s[52:53], s[80:81]
    s_andn2_b64 s[52:53], s[52:53], s[54:55]
    s_or_b64 s[80:81], s[80:81], s[52:53]
    s_not_b64 vcc, s[52:53]
    s_mov_b64 exec, -1
    v_cndmask_b32_dpp v84, v84, v84, vcc wave_shr:1 row_mask:0xf bank_mask:0xf
    v_cndmask_b32_dpp v85, v85, v85, vcc wave_shr:1 row_mask:0xf bank_mask:0xf
    s_lshr_b64 s[52:53], s[52:53], 1
    v_cndmask_b32_dpp v86, v86, v86, vcc wave_shr:1 row_mask:0xf bank_mask:0xf
    v_cndmask_b32_dpp v87, v87, v87, vcc wave_shr:1 row_mask:0xf bank_mask:0xf
    s_andn2_b64 s[82:83], s[82:83], s[52:53]
    v_cndmask_b32_dpp v7, v7, v7, vcc wave_shr:1 row_mask:0xf bank_mask:0xf
    s_mov_b64 exec, s[54:55]
    s_cbranch_scc0 L2_d51
    s_mov_b64 exec, s[82:83]
    s_nop 1
    v_mfma_f32_4x4x4_16b_bf16 v[88:91], v[12:13], v[84:85], 0
    s_nop 1
    v_mfma_f32_4x4x4_16b_bf16 v[88:91], v[10:11], v[86:87], v[88:91]
    s_nop 4
    v_cvt_pk_bf16_f32 v88, v88, v89
    v_cvt_pk_bf16_f32 v89, v90, v91
    ds_pk_add_bf16 v7, v88 offset:65408
    ds_pk_add_bf16 v7, v89 offset:65412
    s_mov_b64 exec, s[54:55]
    s_branch L2_d51
L2_c52:
    s_lshl_b64 s[52:53], s[82:83], 1
    s_andn2_b64 s[52:53], s[52:53], s[80:81]
    s_andn2_b64 s[52:53], s[52:53], s[50:51]
    s_or_b64 s[80:81], s[80:81], s[52:53]
    s_not_b64 vcc, s[52:53]
    s_mov_b64 exec, -1
    v_cndmask_b32_dpp v84, v84, v84, vcc wave_shr:1 row_mask:0xf bank_mask:0xf
    v_cndmask_b32_dpp v85, v85, v85, vcc wave_shr:1 row_mask:0xf bank_mask:0xf
    s_lshr_b64 s[52:53], s[52:53], 1
    v_cndmask_b32_dpp v86, v86, v86, vcc wave_shr:1 row_mask:0xf bank_mask:0xf
    v_cndmask_b32_dpp v87, v87, v87, vcc wave_shr:1 row_mask:0xf bank_mask:0xf
    s_andn2_b64 s[82:83], s[82:83], s[52:53]
    v_cndmask_b32_dpp v7, v7, v7, vcc wave_shr:1 row_mask:0xf bank_mask:0xf
    s_mov_b64 exec, s[50:51]
    s_cbranch_scc0 L2_d52
    s_mov_b64 exec, s[82:83]
    s_nop 1
    v_mfma_f32_4x4x4_16b_bf16 v[88:91], v[12:13], v[84:85], 0
    s_nop 1
    v_mfma_f32_4x4x4_16b_bf16 v[88:91], v[10:11], v[86:87], v[88:91]
    s_nop 4
    v_cvt_pk_bf16_f32 v88, v88, v89
    v_cvt_pk_bf16_f32 v89, v90, v91
    ds_pk_add_bf16 v7, v88 offset:65408
    ds_pk_add_bf16 v7, v89 offset:65412
    s_mov_b64 exec, s[50:51]
    s_branch L2_d52
L2_oa53:
    s_waitcnt vmcnt(3)
    s_mov_b64 exec, s[6:7]
    v_lshrrev_b32 v114, 16, v114
    s_mov_b64 exec, -1
    v_and_b32 v46, 0x10000000, v32
    v_cmpx_eq_u32 vcc, 0, v46
    v_lshrrev_b32 v47, 14, v112
    v_and_b32 v47, v5, v47
    ds_read_b64 v[96:97], v47
    v_perm_b32 v98, v112, v114, s44
    v_bitop3_b32 v99, v112, 0.5, -0.5 bitop3:0xa8
    v_bitop3_b32 v98, v6, v98, v99 bitop3:0xca
    v_and_b32 v47, v5, v112
    s_waitcnt lgkmcnt(0)
    v_mfma_f32_4x4x4_16b_bf16 v[88:91], v[8:9], v[96:97], 0
    s_nop 4
    v_mul_f32 v88, v98, v88
    v_mul_f32 v89, v98, v89
    v_mul_f32 v90, v98, v90
    v_mul_f32 v91, v98, v91
    v_cvt_pk_bf16_f32 v88, v88, v89
    v_cvt_pk_bf16_f32 v89, v90, v91
    ds_pk_add_bf16 v47, v88 offset:65408
    ds_pk_add_bf16 v47, v89 offset:65412
    s_mov_b64 exec, -1
    v_and_b32 v46, 0x20000000, v32
    v_cmpx_eq_u32 vcc, 0, v46
    v_lshrrev_b32 v47, 14, v113
    v_and_b32 v47, v5, v47
    ds_read_b64 v[96:97], v47
    v_perm_b32 v98, v113, v114, s45
    v_bitop3_b32 v99, v113, 0.5, -0.5 bitop3:0xa8
    v_bitop3_b32 v98, v6, v98, v99 bitop3:0xca
    v_and_b32 v47, v5, v113
    s_waitcnt lgkmcnt(0)
    v_mfma_f32_4x4x4_16b_bf16 v[88:91], v[8:9], v[96:97], 0
    s_nop 4
    v_mul_f32 v88, v98, v88
    v_mul_f32 v89, v98, v89
    v_mul_f32 v90, v98, v90
    v_mul_f32 v91, v98, v91
    v_cvt_pk_bf16_f32 v88, v88, v89
    v_cvt_pk_bf16_f32 v89, v90, v91
    ds_pk_add_bf16 v47, v88 offset:65408
    ds_pk_add_bf16 v47, v89 offset:65412
    s_mov_b64 exec, -1
    s_branch L2_ob53
L2_xo54:
    v_cmp_lt_u32 vcc, 20, v99
    s_mov_b32 s101, 1
    s_cbranch_vccz L2_xp54
    v_cmp_lt_u32 vcc, 32, v99
    v_cmp_lt_u32 s[58:59], 31, v88
    s_mov_b32 s101, 2
    s_or_b64 vcc, vcc, s[58:59]
    s_cbranch_scc0 L2_xp54
    s_mov_b32 s37, 0x10000
    s_branch L2_xp54
L2_c55:
    s_lshl_b64 s[52:53], s[82:83], 1
    s_andn2_b64 s[52:53], s[52:53], s[80:81]
    s_andn2_b64 s[52:53], s[52:53], s[54:55]
    s_or_b64 s[80:81], s[80:81], s[52:53]
    s_not_b64 vcc, s[52:53]
    s_mov_b64 exec, -1
    v_cndmask_b32_dpp v84, v84, v84, vcc wave_shr:1 row_mask:0xf bank_mask:0xf
    v_cndmask_b32_dpp v85, v85, v85, vcc wave_shr:1 row_mask:0xf bank_mask:0xf
    s_lshr_b64 s[52:53], s[52:53], 1
    v_cndmask_b32_dpp v86, v86, v86, vcc wave_shr:1 row_mask:0xf bank_mask:0xf
    v_cndmask_b32_dpp v87, v87, v87, vcc wave_shr:1 row_mask:0xf bank_mask:0xf
    s_andn2_b64 s[82:83], s[82:83], s[52:53]
    v_cndmask_b32_dpp v7, v7, v7, vcc wave_shr:1 row_mask:0xf bank_mask:0xf
    s_mov_b64 exec, s[54:55]
    s_cbranch_scc0 L2_d55
    s_mov_b64 exec, s[82:83]
    s_nop 1
    v_mfma_f32_4x4x4_16b_bf16 v[88:91], v[12:13], v[84:85], 0
    s_nop 1
    v_mfma_f32_4x4x4_16b_bf16 v[88:91], v[10:11], v[86:87], v[88:91]
    s_nop 4
    v_cvt_pk_bf16_f32 v88, v88, v89
    v_cvt_pk_bf16_f32 v89, v90, v91
    ds_pk_add_bf16 v7, v88 offset:65408
    ds_pk_add_bf16 v7, v89 offset:65412
    s_mov_b64 exec, s[54:55]
    s_branch L2_d55
L2_c56:
    s_lshl_b64 s[52:53], s[82:83], 1
    s_andn2_b64 s[52:53], s[52:53], s[80:81]
    s_andn2_b64 s[52:53], s[52:53], s[50:51]
    s_or_b64 s[80:81], s[80:81], s[52:53]
    s_not_b64 vcc, s[52:53]
    s_mov_b64 exec, -1
    v_cndmask_b32_dpp v84, v84, v84, vcc wave_shr:1 row_mask:0xf bank_mask:0xf
    v_cndmask_b32_dpp v85, v85, v85, vcc wave_shr:1 row_mask:0xf bank_mask:0xf
    s_lshr_b64 s[52:53], s[52:53], 1
    v_cndmask_b32_dpp v86, v86, v86, vcc wave_shr:1 row_mask:0xf bank_mask:0xf
    v_cndmask_b32_dpp v87, v87, v87, vcc wave_shr:1 row_mask:0xf bank_mask:0xf
    s_andn2_b64 s[82:83], s[82:83], s[52:53]
    v_cndmask_b32_dpp v7, v7, v7, vcc wave_shr:1 row_mask:0xf bank_mask:0xf
    s_mov_b64 exec, s[50:51]
    s_cbranch_scc0 L2_d56
    s_mov_b64 exec, s[82:83]
    s_nop 1
    v_mfma_f32_4x4x4_16b_bf16 v[88:91], v[12:13], v[84:85], 0
    s_nop 1
    v_mfma_f32_4x4x4_16b_bf16 v[88:91], v[10:11], v[86:87], v[88:91]
    s_nop 4
    v_cvt_pk_bf16_f32 v88, v88, v89
    v_cvt_pk_bf16_f32 v89, v90, v91
    ds_pk_add_bf16 v7, v88 offset:65408
    ds_pk_add_bf16 v7, v89 offset:65412
    s_mov_b64 exec, s[50:51]
    s_branch L2_d56
L2_c57:
    s_lshl_b64 s[52:53], s[82:83], 1
    s_andn2_b64 s[52:53], s[52:53], s[80:81]
    s_andn2_b64 s[52:53], s[52:53], s[54:55]
    s_or_b64 s[80:81], s[80:81], s[52:53]
    s_not_b64 vcc, s[52:53]
    s_mov_b64 exec, -1
    v_cndmask_b32_dpp v84, v84, v84, vcc wave_shr:1 row_mask:0xf bank_mask:0xf
    v_cndmask_b32_dpp v85, v85, v85, vcc wave_shr:1 row_mask:0xf bank_mask:0xf
    s_lshr_b64 s[52:53], s[52:53], 1
    v_cndmask_b32_dpp v86, v86, v86, vcc wave_shr:1 row_mask:0xf bank_mask:0xf
    v_cndmask_b32_dpp v87, v87, v87, vcc wave_shr:1 row_mask:0xf bank_mask:0xf
    s_andn2_b64 s[82:83], s[82:83], s[52:53]
    v_cndmask_b32_dpp v7, v7, v7, vcc wave_shr:1 row_mask:0xf bank_mask:0xf
    s_mov_b64 exec, s[54:55]
    s_cbranch_scc0 L2_d57
    s_mov_b64 exec, s[82:83]
    s_nop 1
    v_mfma_f32_4x4x4_16b_bf16 v[88:91], v[12:13], v[84:85], 0
    s_nop 1
    v_mfma_f32_4x4x4_16b_bf16 v[88:91], v[10:11], v[86:87], v[88:91]
    s_nop 4
    v_cvt_pk_bf16_f32 v88, v88, v89
    v_cvt_pk_bf16_f32 v89, v90, v91
    ds_pk_add_bf16 v7, v88 offset:65408
    ds_pk_add_bf16 v7, v89 offset:65412
    s_mov_b64 exec, s[54:55]
    s_branch L2_d57
L2_c58:
    s_lshl_b64 s[52:53], s[82:83], 1
    s_andn2_b64 s[52:53], s[52:53], s[80:81]
    s_andn2_b64 s[52:53], s[52:53], s[50:51]
    s_or_b64 s[80:81], s[80:81], s[52:53]
    s_not_b64 vcc, s[52:53]
    s_mov_b64 exec, -1
    v_cndmask_b32_dpp v84, v84, v84, vcc wave_shr:1 row_mask:0xf bank_mask:0xf
    v_cndmask_b32_dpp v85, v85, v85, vcc wave_shr:1 row_mask:0xf bank_mask:0xf
    s_lshr_b64 s[52:53], s[52:53], 1
    v_cndmask_b32_dpp v86, v86, v86, vcc wave_shr:1 row_mask:0xf bank_mask:0xf
    v_cndmask_b32_dpp v87, v87, v87, vcc wave_shr:1 row_mask:0xf bank_mask:0xf
    s_andn2_b64 s[82:83], s[82:83], s[52:53]
    v_cndmask_b32_dpp v7, v7, v7, vcc wave_shr:1 row_mask:0xf bank_mask:0xf
    s_mov_b64 exec, s[50:51]
    s_cbranch_scc0 L2_d58
    s_mov_b64 exec, s[82:83]
    s_nop 1
    v_mfma_f32_4x4x4_16b_bf16 v[88:91], v[12:13], v[84:85], 0
    s_nop 1
    v_mfma_f32_4x4x4_16b_bf16 v[88:91], v[10:11], v[86:87], v[88:91]
    s_nop 4
    v_cvt_pk_bf16_f32 v88, v88, v89
    v_cvt_pk_bf16_f32 v89, v90, v91
    ds_pk_add_bf16 v7, v88 offset:65408
    ds_pk_add_bf16 v7, v89 offset:65412
    s_mov_b64 exec, s[50:51]
    s_branch L2_d58
L2_c59:
    s_lshl_b64 s[52:53], s[82:83], 1
    s_andn2_b64 s[52:53], s[52:53], s[80:81]
    s_andn2_b64 s[52:53], s[52:53], s[54:55]
    s_or_b64 s[80:81], s[80:81], s[52:53]
    s_not_b64 vcc, s[52:53]
    s_mov_b64 exec, -1
    v_cndmask_b32_dpp v84, v84, v84, vcc wave_shr:1 row_mask:0xf bank_mask:0xf
    v_cndmask_b32_dpp v85, v85, v85, vcc wave_shr:1 row_mask:0xf bank_mask:0xf
    s_lshr_b64 s[52:53], s[52:53], 1
    v_cndmask_b32_dpp v86, v86, v86, vcc wave_shr:1 row_mask:0xf bank_mask:0xf
    v_cndmask_b32_dpp v87, v87, v87, vcc wave_shr:1 row_mask:0xf bank_mask:0xf
    s_andn2_b64 s[82:83], s[82:83], s[52:53]
    v_cndmask_b32_dpp v7, v7, v7, vcc wave_shr:1 row_mask:0xf bank_mask:0xf
    s_mov_b64 exec, s[54:55]
    s_cbranch_scc0 L2_d59
    s_mov_b64 exec, s[82:83]
    s_nop 1
    v_mfma_f32_4x4x4_16b_bf16 v[88:91], v[12:13], v[84:85], 0
    s_nop 1
    v_mfma_f32_4x4x4_16b_bf16 v[88:91], v[10:11], v[86:87], v[88:91]
    s_nop 4
    v_cvt_pk_bf16_f32 v88, v88, v89
    v_cvt_pk_bf16_f32 v89, v90, v91
    ds_pk_add_bf16 v7, v88 offset:65408
    ds_pk_add_bf16 v7, v89 offset:65412
    s_mov_b64 exec, s[54:55]
    s_branch L2_d59
L2_c60:
    s_lshl_b64 s[52:53], s[82:83], 1
    s_andn2_b64 s[52:53], s[52:53], s[80:81]
    s_andn2_b64 s[52:53], s[52:53], s[50:51]
    s_or_b64 s[80:81], s[80:81], s[52:53]
    s_not_b64 vcc, s[52:53]
    s_mov_b64 exec, -1
    v_cndmask_b32_dpp v84, v84, v84, vcc wave_shr:1 row_mask:0xf bank_mask:0xf
    v_cndmask_b32_dpp v85, v85, v85, vcc wave_shr:1 row_mask:0xf bank_mask:0xf
    s_lshr_b64 s[52:53], s[52:53], 1
    v_cndmask_b32_dpp v86, v86, v86, vcc wave_shr:1 row_mask:0xf bank_mask:0xf
    v_cndmask_b32_dpp v87, v87, v87, vcc wave_shr:1 row_mask:0xf bank_mask:0xf
    s_andn2_b64 s[82:83], s[82:83], s[52:53]
    v_cndmask_b32_dpp v7, v7, v7, vcc wave_shr:1 row_mask:0xf bank_mask:0xf
    s_mov_b64 exec, s[50:51]
    s_cbranch_scc0 L2_d60
    s_mov_b64 exec, s[82:83]
    s_nop 1
    v_mfma_f32_4x4x4_16b_bf16 v[88:91], v[12:13], v[84:85], 0
    s_nop 1
    v_mfma_f32_4x4x4_16b_bf16 v[88:91], v[10:11], v[86:87], v[88:91]
    s_nop 4
    v_cvt_pk_bf16_f32 v88, v88, v89
    v_cvt_pk_bf16_f32 v89, v90, v91
    ds_pk_add_bf16 v7, v88 offset:65408
    ds_pk_add_bf16 v7, v89 offset:65412
    s_mov_b64 exec, s[50:51]
    s_branch L2_d60
L2_xa61:
    s_cmp_eq_u32 s101, 1
    s_cbranch_scc1 L2_xc61
    v_lshlrev_b32 v89, 0, v96
    v_add_u32 v90, 140, v97
    v_bitop3_b32 v90, v89, v45, v90 bitop3:0x6a
    ds_write_b32 v98, v90 offset:28
    v_lshlrev_b32 v89, 4, v96
    v_add_u32 v90, 120, v97
    v_bitop3_b32 v90, v89, v45, v90 bitop3:0x6a
    ds_write_b32 v98, v90 offset:24
    v_lshlrev_b32 v89, 8, v96
    v_add_u32 v90, 100, v97
    v_bitop3_b32 v90, v89, v45, v90 bitop3:0x6a
    ds_write_b32 v98, v90 offset:20
L2_xc61:
    v_lshlrev_b32 v89, 12, v96
    v_add_u32 v90, 80, v97
    v_bitop3_b32 v90, v89, v45, v90 bitop3:0x6a
    ds_write_b32 v98, v90 offset:16
    s_branch L2_xb61
L2_xe61:
    v_cmp_lt_u32 vcc, 32, v99
    v_cmp_lt_u32 s[58:59], 31, v88
    v_lshrrev_b32 v89, 16, v96
    v_add_u32 v97, 80, v97
    s_or_b64 vcc, vcc, s[58:59]
    s_cbranch_scc1 L2_xs61
    v_lshlrev_b32 v89, v1, v89
    v_and_b32 v89, v45, v89
    v_cmp_ne_u32 vcc, 0, v89
    v_xor_b32 v90, v97, v89
    s_add_u32 s3, s37, s38
    v_mbcnt_lo_u32_b32 v98, vcc_lo, 0
    v_mbcnt_hi_u32_b32 v98, vcc_hi, v98
    s_bcnt1_i32_b64 s41, vcc
    v_lshl_add_u32 v98, v98, 2, s3
    s_lshl2_add_u32 s37, s41, s37
    s_mov_b64 exec, vcc
    ds_write_b32 v98, v90
    s_mov_b64 exec, -1
    s_branch L2_xr61
L2_xf61:
    s_waitcnt lgkmcnt(0)
    s_cmp_gt_u32 s37, 1024
    s_cbranch_scc1 L2_xs61
    s_cmp_lt_u32 s37, 768
    s_cbranch_scc1 L2_xl61
    ds_read_b32 v32, v98 offset:896
    s_add_u32 s3, s42, 2
    s_bitset1_b32 s43, s3
    s_branch L2_xg61
L2_xl61:
    v_mov_b32 v42, -1
    s_cmp_ge_u32 s37, 512
    s_cbranch_scc1 L2_xg61
    v_mov_b32 v43, -1
    s_cmp_ge_u32 s37, 256
    s_cbranch_scc1 L2_xg61
    v_mov_b32 v41, -1
    s_branch L2_xg61
L2_xs61:
    s_waitcnt lgkmcnt(0)
    v_mov_b32 v40, -1
    v_mov_b32 v41, -1
    v_mov_b32 v43, -1
    v_mov_b32 v42, -1
    s_add_u32 s3, s42, 2
    s_bitset1_b32 s36, s3
    s_branch L2_xg61
L2_c62:
    s_lshl_b64 s[52:53], s[82:83], 1
    s_andn2_b64 s[52:53], s[52:53], s[80:81]
    s_andn2_b64 s[52:53], s[52:53], s[54:55]
    s_or_b64 s[80:81], s[80:81], s[52:53]
    s_not_b64 vcc, s[52:53]
    s_mov_b64 exec, -1
    v_cndmask_b32_dpp v84, v84, v84, vcc wave_shr:1 row_mask:0xf bank_mask:0xf
    v_cndmask_b32_dpp v85, v85, v85, vcc wave_shr:1 row_mask:0xf bank_mask:0xf
    s_lshr_b64 s[52:53], s[52:53], 1
    v_cndmask_b32_dpp v86, v86, v86, vcc wave_shr:1 row_mask:0xf bank_mask:0xf
    v_cndmask_b32_dpp v87, v87, v87, vcc wave_shr:1 row_mask:0xf bank_mask:0xf
    s_andn2_b64 s[82:83], s[82:83], s[52:53]
    v_cndmask_b32_dpp v7, v7, v7, vcc wave_shr:1 row_mask:0xf bank_mask:0xf
    s_mov_b64 exec, s[54:55]
    s_cbranch_scc0 L2_d62
    s_mov_b64 exec, s[82:83]
    s_nop 1
    v_mfma_f32_4x4x4_16b_bf16 v[88:91], v[12:13], v[84:85], 0
    s_nop 1
    v_mfma_f32_4x4x4_16b_bf16 v[88:91], v[10:11], v[86:87], v[88:91]
    s_nop 4
    v_cvt_pk_bf16_f32 v88, v88, v89
    v_cvt_pk_bf16_f32 v89, v90, v91
    ds_pk_add_bf16 v7, v88 offset:65408
    ds_pk_add_bf16 v7, v89 offset:65412
    s_mov_b64 exec, s[54:55]
    s_branch L2_d62
L2_c63:
    s_lshl_b64 s[52:53], s[82:83], 1
    s_andn2_b64 s[52:53], s[52:53], s[80:81]
    s_andn2_b64 s[52:53], s[52:53], s[50:51]
    s_or_b64 s[80:81], s[80:81], s[52:53]
    s_not_b64 vcc, s[52:53]
    s_mov_b64 exec, -1
    v_cndmask_b32_dpp v84, v84, v84, vcc wave_shr:1 row_mask:0xf bank_mask:0xf
    v_cndmask_b32_dpp v85, v85, v85, vcc wave_shr:1 row_mask:0xf bank_mask:0xf
    s_lshr_b64 s[52:53], s[52:53], 1
    v_cndmask_b32_dpp v86, v86, v86, vcc wave_shr:1 row_mask:0xf bank_mask:0xf
    v_cndmask_b32_dpp v87, v87, v87, vcc wave_shr:1 row_mask:0xf bank_mask:0xf
    s_andn2_b64 s[82:83], s[82:83], s[52:53]
    v_cndmask_b32_dpp v7, v7, v7, vcc wave_shr:1 row_mask:0xf bank_mask:0xf
    s_mov_b64 exec, s[50:51]
    s_cbranch_scc0 L2_d63
    s_mov_b64 exec, s[82:83]
    s_nop 1
    v_mfma_f32_4x4x4_16b_bf16 v[88:91], v[12:13], v[84:85], 0
    s_nop 1
    v_mfma_f32_4x4x4_16b_bf16 v[88:91], v[10:11], v[86:87], v[88:91]
    s_nop 4
    v_cvt_pk_bf16_f32 v88, v88, v89
    v_cvt_pk_bf16_f32 v89, v90, v91
    ds_pk_add_bf16 v7, v88 offset:65408
    ds_pk_add_bf16 v7, v89 offset:65412
    s_mov_b64 exec, s[50:51]
    s_branch L2_d63
L2_oa64:
    v_and_b32 v47, 0x0fffffff, v33
    buffer_load_dword v114, v47, s[8:11], 0 offen offset:16
    s_mov_b64 exec, s[6:7]
    v_add_u32 v47, 8, v47
    v_lshrrev_b32 v33, 2, v33
    s_mov_b64 exec, -1
    buffer_load_dwordx2 v[112:113], v47, s[8:11], 0 offen
    s_branch L2_ob64
L2_c65:
    s_lshl_b64 s[52:53], s[82:83], 1
    s_andn2_b64 s[52:53], s[52:53], s[80:81]
    s_andn2_b64 s[52:53], s[52:53], s[54:55]
    s_or_b64 s[80:81], s[80:81], s[52:53]
    s_not_b64 vcc, s[52:53]
    s_mov_b64 exec, -1
    v_cndmask_b32_dpp v84, v84, v84, vcc wave_shr:1 row_mask:0xf bank_mask:0xf
    v_cndmask_b32_dpp v85, v85, v85, vcc wave_shr:1 row_mask:0xf bank_mask:0xf
    s_lshr_b64 s[52:53], s[52:53], 1
    v_cndmask_b32_dpp v86, v86, v86, vcc wave_shr:1 row_mask:0xf bank_mask:0xf
    v_cndmask_b32_dpp v87, v87, v87, vcc wave_shr:1 row_mask:0xf bank_mask:0xf
    s_andn2_b64 s[82:83], s[82:83], s[52:53]
    v_cndmask_b32_dpp v7, v7, v7, vcc wave_shr:1 row_mask:0xf bank_mask:0xf
    s_mov_b64 exec, s[54:55]
    s_cbranch_scc0 L2_d65
    s_mov_b64 exec, s[82:83]
    s_nop 1
    v_mfma_f32_4x4x4_16b_bf16 v[88:91], v[12:13], v[84:85], 0
    s_nop 1
    v_mfma_f32_4x4x4_16b_bf16 v[88:91], v[10:11], v[86:87], v[88:91]
    s_nop 4
    v_cvt_pk_bf16_f32 v88, v88, v89
    v_cvt_pk_bf16_f32 v89, v90, v91
    ds_pk_add_bf16 v7, v88 offset:65408
    ds_pk_add_bf16 v7, v89 offset:65412
    s_mov_b64 exec, s[54:55]
    s_branch L2_d65
L2_c66:
    s_lshl_b64 s[52:53], s[82:83], 1
    s_andn2_b64 s[52:53], s[52:53], s[80:81]
    s_andn2_b64 s[52:53], s[52:53], s[50:51]
    s_or_b64 s[80:81], s[80:81], s[52:53]
    s_not_b64 vcc, s[52:53]
    s_mov_b64 exec, -1
    v_cndmask_b32_dpp v84, v84, v84, vcc wave_shr:1 row_mask:0xf bank_mask:0xf
    v_cndmask_b32_dpp v85, v85, v85, vcc wave_shr:1 row_mask:0xf bank_mask:0xf
    s_lshr_b64 s[52:53], s[52:53], 1
    v_cndmask_b32_dpp v86, v86, v86, vcc wave_shr:1 row_mask:0xf bank_mask:0xf
    v_cndmask_b32_dpp v87, v87, v87, vcc wave_shr:1 row_mask:0xf bank_mask:0xf
    s_andn2_b64 s[82:83], s[82:83], s[52:53]
    v_cndmask_b32_dpp v7, v7, v7, vcc wave_shr:1 row_mask:0xf bank_mask:0xf
    s_mov_b64 exec, s[50:51]
    s_cbranch_scc0 L2_d66
    s_mov_b64 exec, s[82:83]
    s_nop 1
    v_mfma_f32_4x4x4_16b_bf16 v[88:91], v[12:13], v[84:85], 0
    s_nop 1
    v_mfma_f32_4x4x4_16b_bf16 v[88:91], v[10:11], v[86:87], v[88:91]
    s_nop 4
    v_cvt_pk_bf16_f32 v88, v88, v89
    v_cvt_pk_bf16_f32 v89, v90, v91
    ds_pk_add_bf16 v7, v88 offset:65408
    ds_pk_add_bf16 v7, v89 offset:65412
    s_mov_b64 exec, s[50:51]
    s_branch L2_d66
L2_c67:
    s_lshl_b64 s[52:53], s[82:83], 1
    s_andn2_b64 s[52:53], s[52:53], s[80:81]
    s_andn2_b64 s[52:53], s[52:53], s[54:55]
    s_or_b64 s[80:81], s[80:81], s[52:53]
    s_not_b64 vcc, s[52:53]
    s_mov_b64 exec, -1
    v_cndmask_b32_dpp v84, v84, v84, vcc wave_shr:1 row_mask:0xf bank_mask:0xf
    v_cndmask_b32_dpp v85, v85, v85, vcc wave_shr:1 row_mask:0xf bank_mask:0xf
    s_lshr_b64 s[52:53], s[52:53], 1
    v_cndmask_b32_dpp v86, v86, v86, vcc wave_shr:1 row_mask:0xf bank_mask:0xf
    v_cndmask_b32_dpp v87, v87, v87, vcc wave_shr:1 row_mask:0xf bank_mask:0xf
    s_andn2_b64 s[82:83], s[82:83], s[52:53]
    v_cndmask_b32_dpp v7, v7, v7, vcc wave_shr:1 row_mask:0xf bank_mask:0xf
    s_mov_b64 exec, s[54:55]
    s_cbranch_scc0 L2_d67
    s_mov_b64 exec, s[82:83]
    s_nop 1
    v_mfma_f32_4x4x4_16b_bf16 v[88:91], v[12:13], v[84:85], 0
    s_nop 1
    v_mfma_f32_4x4x4_16b_bf16 v[88:91], v[10:11], v[86:87], v[88:91]
    s_nop 4
    v_cvt_pk_bf16_f32 v88, v88, v89
    v_cvt_pk_bf16_f32 v89, v90, v91
    ds_pk_add_bf16 v7, v88 offset:65408
    ds_pk_add_bf16 v7, v89 offset:65412
    s_mov_b64 exec, s[54:55]
    s_branch L2_d67
L2_c68:
    s_lshl_b64 s[52:53], s[82:83], 1
    s_andn2_b64 s[52:53], s[52:53], s[80:81]
    s_andn2_b64 s[52:53], s[52:53], s[50:51]
    s_or_b64 s[80:81], s[80:81], s[52:53]
    s_not_b64 vcc, s[52:53]
    s_mov_b64 exec, -1
    v_cndmask_b32_dpp v84, v84, v84, vcc wave_shr:1 row_mask:0xf bank_mask:0xf
    v_cndmask_b32_dpp v85, v85, v85, vcc wave_shr:1 row_mask:0xf bank_mask:0xf
    s_lshr_b64 s[52:53], s[52:53], 1
    v_cndmask_b32_dpp v86, v86, v86, vcc wave_shr:1 row_mask:0xf bank_mask:0xf
    v_cndmask_b32_dpp v87, v87, v87, vcc wave_shr:1 row_mask:0xf bank_mask:0xf
    s_andn2_b64 s[82:83], s[82:83], s[52:53]
    v_cndmask_b32_dpp v7, v7, v7, vcc wave_shr:1 row_mask:0xf bank_mask:0xf
    s_mov_b64 exec, s[50:51]
    s_cbranch_scc0 L2_d68
    s_mov_b64 exec, s[82:83]
    s_nop 1
    v_mfma_f32_4x4x4_16b_bf16 v[88:91], v[12:13], v[84:85], 0
    s_nop 1
    v_mfma_f32_4x4x4_16b_bf16 v[88:91], v[10:11], v[86:87], v[88:91]
    s_nop 4
    v_cvt_pk_bf16_f32 v88, v88, v89
    v_cvt_pk_bf16_f32 v89, v90, v91
    ds_pk_add_bf16 v7, v88 offset:65408
    ds_pk_add_bf16 v7, v89 offset:65412
    s_mov_b64 exec, s[50:51]
    s_branch L2_d68
L2_c69:
    s_lshl_b64 s[52:53], s[82:83], 1
    s_andn2_b64 s[52:53], s[52:53], s[80:81]
    s_andn2_b64 s[52:53], s[52:53], s[54:55]
    s_or_b64 s[80:81], s[80:81], s[52:53]
    s_not_b64 vcc, s[52:53]
    s_mov_b64 exec, -1
    v_cndmask_b32_dpp v84, v84, v84, vcc wave_shr:1 row_mask:0xf bank_mask:0xf
    v_cndmask_b32_dpp v85, v85, v85, vcc wave_shr:1 row_mask:0xf bank_mask:0xf
    s_lshr_b64 s[52:53], s[52:53], 1
    v_cndmask_b32_dpp v86, v86, v86, vcc wave_shr:1 row_mask:0xf bank_mask:0xf
    v_cndmask_b32_dpp v87, v87, v87, vcc wave_shr:1 row_mask:0xf bank_mask:0xf
    s_andn2_b64 s[82:83], s[82:83], s[52:53]
    v_cndmask_b32_dpp v7, v7, v7, vcc wave_shr:1 row_mask:0xf bank_mask:0xf
    s_mov_b64 exec, s[54:55]
    s_cbranch_scc0 L2_d69
    s_mov_b64 exec, s[82:83]
    s_nop 1
    v_mfma_f32_4x4x4_16b_bf16 v[88:91], v[12:13], v[84:85], 0
    s_nop 1
    v_mfma_f32_4x4x4_16b_bf16 v[88:91], v[10:11], v[86:87], v[88:91]
    s_nop 4
    v_cvt_pk_bf16_f32 v88, v88, v89
    v_cvt_pk_bf16_f32 v89, v90, v91
    ds_pk_add_bf16 v7, v88 offset:65408
    ds_pk_add_bf16 v7, v89 offset:65412
    s_mov_b64 exec, s[54:55]
    s_branch L2_d69
L2_c70:
    s_lshl_b64 s[52:53], s[82:83], 1
    s_andn2_b64 s[52:53], s[52:53], s[80:81]
    s_andn2_b64 s[52:53], s[52:53], s[50:51]
    s_or_b64 s[80:81], s[80:81], s[52:53]
    s_not_b64 vcc, s[52:53]
    s_mov_b64 exec, -1
    v_cndmask_b32_dpp v84, v84, v84, vcc wave_shr:1 row_mask:0xf bank_mask:0xf
    v_cndmask_b32_dpp v85, v85, v85, vcc wave_shr:1 row_mask:0xf bank_mask:0xf
    s_lshr_b64 s[52:53], s[52:53], 1
    v_cndmask_b32_dpp v86, v86, v86, vcc wave_shr:1 row_mask:0xf bank_mask:0xf
    v_cndmask_b32_dpp v87, v87, v87, vcc wave_shr:1 row_mask:0xf bank_mask:0xf
    s_andn2_b64 s[82:83], s[82:83], s[52:53]
    v_cndmask_b32_dpp v7, v7, v7, vcc wave_shr:1 row_mask:0xf bank_mask:0xf
    s_mov_b64 exec, s[50:51]
    s_cbranch_scc0 L2_d70
    s_mov_b64 exec, s[82:83]
    s_nop 1
    v_mfma_f32_4x4x4_16b_bf16 v[88:91], v[12:13], v[84:85], 0
    s_nop 1
    v_mfma_f32_4x4x4_16b_bf16 v[88:91], v[10:11], v[86:87], v[88:91]
    s_nop 4
    v_cvt_pk_bf16_f32 v88, v88, v89
    v_cvt_pk_bf16_f32 v89, v90, v91
    ds_pk_add_bf16 v7, v88 offset:65408
    ds_pk_add_bf16 v7, v89 offset:65412
    s_mov_b64 exec, s[50:51]
    s_branch L2_d70
L2_oa71:
    s_waitcnt vmcnt(3)
    s_mov_b64 exec, s[6:7]
    v_lshrrev_b32 v114, 16, v114
    s_mov_b64 exec, -1
    v_and_b32 v46, 0x10000000, v33
    v_cmpx_eq_u32 vcc, 0, v46
    v_lshrrev_b32 v47, 14, v112
    v_and_b32 v47, v5, v47
    ds_read_b64 v[96:97], v47
    v_perm_b32 v98, v112, v114, s44
    v_bitop3_b32 v99, v112, 0.5, -0.5 bitop3:0xa8
    v_bitop3_b32 v98, v6, v98, v99 bitop3:0xca
    v_and_b32 v47, v5, v112
    s_waitcnt lgkmcnt(0)
    v_mfma_f32_4x4x4_16b_bf16 v[88:91], v[8:9], v[96:97], 0
    s_nop 4
    v_mul_f32 v88, v98, v88
    v_mul_f32 v89, v98, v89
    v_mul_f32 v90, v98, v90
    v_mul_f32 v91, v98, v91
    v_cvt_pk_bf16_f32 v88, v88, v89
    v_cvt_pk_bf16_f32 v89, v90, v91
    ds_pk_add_bf16 v47, v88 offset:65408
    ds_pk_add_bf16 v47, v89 offset:65412
    s_mov_b64 exec, -1
    v_and_b32 v46, 0x20000000, v33
    v_cmpx_eq_u32 vcc, 0, v46
    v_lshrrev_b32 v47, 14, v113
    v_and_b32 v47, v5, v47
    ds_read_b64 v[96:97], v47
    v_perm_b32 v98, v113, v114, s45
    v_bitop3_b32 v99, v113, 0.5, -0.5 bitop3:0xa8
    v_bitop3_b32 v98, v6, v98, v99 bitop3:0xca
    v_and_b32 v47, v5, v113
    s_waitcnt lgkmcnt(0)
    v_mfma_f32_4x4x4_16b_bf16 v[88:91], v[8:9], v[96:97], 0
    s_nop 4
    v_mul_f32 v88, v98, v88
    v_mul_f32 v89, v98, v89
    v_mul_f32 v90, v98, v90
    v_mul_f32 v91, v98, v91
    v_cvt_pk_bf16_f32 v88, v88, v89
    v_cvt_pk_bf16_f32 v89, v90, v91
    ds_pk_add_bf16 v47, v88 offset:65408
    ds_pk_add_bf16 v47, v89 offset:65412
    s_mov_b64 exec, -1
    s_branch L2_ob71
L2_xo72:
    v_cmp_lt_u32 vcc, 20, v99
    s_mov_b32 s101, 1
    s_cbranch_vccz L2_xp72
    v_cmp_lt_u32 vcc, 32, v99
    v_cmp_lt_u32 s[58:59], 31, v88
    s_mov_b32 s101, 2
    s_or_b64 vcc, vcc, s[58:59]
    s_cbranch_scc0 L2_xp72
    s_mov_b32 s37, 0x10000
    s_branch L2_xp72
L2_c73:
    s_lshl_b64 s[52:53], s[82:83], 1
    s_andn2_b64 s[52:53], s[52:53], s[80:81]
    s_andn2_b64 s[52:53], s[52:53], s[54:55]
    s_or_b64 s[80:81], s[80:81], s[52:53]
    s_not_b64 vcc, s[52:53]
    s_mov_b64 exec, -1
    v_cndmask_b32_dpp v84, v84, v84, vcc wave_shr:1 row_mask:0xf bank_mask:0xf
    v_cndmask_b32_dpp v85, v85, v85, vcc wave_shr:1 row_mask:0xf bank_mask:0xf
    s_lshr_b64 s[52:53], s[52:53], 1
    v_cndmask_b32_dpp v86, v86, v86, vcc wave_shr:1 row_mask:0xf bank_mask:0xf
    v_cndmask_b32_dpp v87, v87, v87, vcc wave_shr:1 row_mask:0xf bank_mask:0xf
    s_andn2_b64 s[82:83], s[82:83], s[52:53]
    v_cndmask_b32_dpp v7, v7, v7, vcc wave_shr:1 row_mask:0xf bank_mask:0xf
    s_mov_b64 exec, s[54:55]
    s_cbranch_scc0 L2_d73
    s_mov_b64 exec, s[82:83]
    s_nop 1
    v_mfma_f32_4x4x4_16b_bf16 v[88:91], v[12:13], v[84:85], 0
    s_nop 1
    v_mfma_f32_4x4x4_16b_bf16 v[88:91], v[10:11], v[86:87], v[88:91]
    s_nop 4
    v_cvt_pk_bf16_f32 v88, v88, v89
    v_cvt_pk_bf16_f32 v89, v90, v91
    ds_pk_add_bf16 v7, v88 offset:65408
    ds_pk_add_bf16 v7, v89 offset:65412
    s_mov_b64 exec, s[54:55]
    s_branch L2_d73
L2_c74:
    s_lshl_b64 s[52:53], s[82:83], 1
    s_andn2_b64 s[52:53], s[52:53], s[80:81]
    s_andn2_b64 s[52:53], s[52:53], s[50:51]
    s_or_b64 s[80:81], s[80:81], s[52:53]
    s_not_b64 vcc, s[52:53]
    s_mov_b64 exec, -1
    v_cndmask_b32_dpp v84, v84, v84, vcc wave_shr:1 row_mask:0xf bank_mask:0xf
    v_cndmask_b32_dpp v85, v85, v85, vcc wave_shr:1 row_mask:0xf bank_mask:0xf
    s_lshr_b64 s[52:53], s[52:53], 1
    v_cndmask_b32_dpp v86, v86, v86, vcc wave_shr:1 row_mask:0xf bank_mask:0xf
    v_cndmask_b32_dpp v87, v87, v87, vcc wave_shr:1 row_mask:0xf bank_mask:0xf
    s_andn2_b64 s[82:83], s[82:83], s[52:53]
    v_cndmask_b32_dpp v7, v7, v7, vcc wave_shr:1 row_mask:0xf bank_mask:0xf
    s_mov_b64 exec, s[50:51]
    s_cbranch_scc0 L2_d74
    s_mov_b64 exec, s[82:83]
    s_nop 1
    v_mfma_f32_4x4x4_16b_bf16 v[88:91], v[12:13], v[84:85], 0
    s_nop 1
    v_mfma_f32_4x4x4_16b_bf16 v[88:91], v[10:11], v[86:87], v[88:91]
    s_nop 4
    v_cvt_pk_bf16_f32 v88, v88, v89
    v_cvt_pk_bf16_f32 v89, v90, v91
    ds_pk_add_bf16 v7, v88 offset:65408
    ds_pk_add_bf16 v7, v89 offset:65412
    s_mov_b64 exec, s[50:51]
    s_branch L2_d74
L2_c75:
    s_lshl_b64 s[52:53], s[82:83], 1
    s_andn2_b64 s[52:53], s[52:53], s[80:81]
    s_andn2_b64 s[52:53], s[52:53], s[54:55]
    s_or_b64 s[80:81], s[80:81], s[52:53]
    s_not_b64 vcc, s[52:53]
    s_mov_b64 exec, -1
    v_cndmask_b32_dpp v84, v84, v84, vcc wave_shr:1 row_mask:0xf bank_mask:0xf
    v_cndmask_b32_dpp v85, v85, v85, vcc wave_shr:1 row_mask:0xf bank_mask:0xf
    s_lshr_b64 s[52:53], s[52:53], 1
    v_cndmask_b32_dpp v86, v86, v86, vcc wave_shr:1 row_mask:0xf bank_mask:0xf
    v_cndmask_b32_dpp v87, v87, v87, vcc wave_shr:1 row_mask:0xf bank_mask:0xf
    s_andn2_b64 s[82:83], s[82:83], s[52:53]
    v_cndmask_b32_dpp v7, v7, v7, vcc wave_shr:1 row_mask:0xf bank_mask:0xf
    s_mov_b64 exec, s[54:55]
    s_cbranch_scc0 L2_d75
    s_mov_b64 exec, s[82:83]
    s_nop 1
    v_mfma_f32_4x4x4_16b_bf16 v[88:91], v[12:13], v[84:85], 0
    s_nop 1
    v_mfma_f32_4x4x4_16b_bf16 v[88:91], v[10:11], v[86:87], v[88:91]
    s_nop 4
    v_cvt_pk_bf16_f32 v88, v88, v89
    v_cvt_pk_bf16_f32 v89, v90, v91
    ds_pk_add_bf16 v7, v88 offset:65408
    ds_pk_add_bf16 v7, v89 offset:65412
    s_mov_b64 exec, s[54:55]
    s_branch L2_d75
L2_c76:
    s_lshl_b64 s[52:53], s[82:83], 1
    s_andn2_b64 s[52:53], s[52:53], s[80:81]
    s_andn2_b64 s[52:53], s[52:53], s[50:51]
    s_or_b64 s[80:81], s[80:81], s[52:53]
    s_not_b64 vcc, s[52:53]
    s_mov_b64 exec, -1
    v_cndmask_b32_dpp v84, v84, v84, vcc wave_shr:1 row_mask:0xf bank_mask:0xf
    v_cndmask_b32_dpp v85, v85, v85, vcc wave_shr:1 row_mask:0xf bank_mask:0xf
    s_lshr_b64 s[52:53], s[52:53], 1
    v_cndmask_b32_dpp v86, v86, v86, vcc wave_shr:1 row_mask:0xf bank_mask:0xf
    v_cndmask_b32_dpp v87, v87, v87, vcc wave_shr:1 row_mask:0xf bank_mask:0xf
    s_andn2_b64 s[82:83], s[82:83], s[52:53]
    v_cndmask_b32_dpp v7, v7, v7, vcc wave_shr:1 row_mask:0xf bank_mask:0xf
    s_mov_b64 exec, s[50:51]
    s_cbranch_scc0 L2_d76
    s_mov_b64 exec, s[82:83]
    s_nop 1
    v_mfma_f32_4x4x4_16b_bf16 v[88:91], v[12:13], v[84:85], 0
    s_nop 1
    v_mfma_f32_4x4x4_16b_bf16 v[88:91], v[10:11], v[86:87], v[88:91]
    s_nop 4
    v_cvt_pk_bf16_f32 v88, v88, v89
    v_cvt_pk_bf16_f32 v89, v90, v91
    ds_pk_add_bf16 v7, v88 offset:65408
    ds_pk_add_bf16 v7, v89 offset:65412
    s_mov_b64 exec, s[50:51]
    s_branch L2_d76
L2_c77:
    s_lshl_b64 s[52:53], s[82:83], 1
    s_andn2_b64 s[52:53], s[52:53], s[80:81]
    s_andn2_b64 s[52:53], s[52:53], s[54:55]
    s_or_b64 s[80:81], s[80:81], s[52:53]
    s_not_b64 vcc, s[52:53]
    s_mov_b64 exec, -1
    v_cndmask_b32_dpp v84, v84, v84, vcc wave_shr:1 row_mask:0xf bank_mask:0xf
    v_cndmask_b32_dpp v85, v85, v85, vcc wave_shr:1 row_mask:0xf bank_mask:0xf
    s_lshr_b64 s[52:53], s[52:53], 1
    v_cndmask_b32_dpp v86, v86, v86, vcc wave_shr:1 row_mask:0xf bank_mask:0xf
    v_cndmask_b32_dpp v87, v87, v87, vcc wave_shr:1 row_mask:0xf bank_mask:0xf
    s_andn2_b64 s[82:83], s[82:83], s[52:53]
    v_cndmask_b32_dpp v7, v7, v7, vcc wave_shr:1 row_mask:0xf bank_mask:0xf
    s_mov_b64 exec, s[54:55]
    s_cbranch_scc0 L2_d77
    s_mov_b64 exec, s[82:83]
    s_nop 1
    v_mfma_f32_4x4x4_16b_bf16 v[88:91], v[12:13], v[84:85], 0
    s_nop 1
    v_mfma_f32_4x4x4_16b_bf16 v[88:91], v[10:11], v[86:87], v[88:91]
    s_nop 4
    v_cvt_pk_bf16_f32 v88, v88, v89
    v_cvt_pk_bf16_f32 v89, v90, v91
    ds_pk_add_bf16 v7, v88 offset:65408
    ds_pk_add_bf16 v7, v89 offset:65412
    s_mov_b64 exec, s[54:55]
    s_branch L2_d77
L2_c78:
    s_lshl_b64 s[52:53], s[82:83], 1
    s_andn2_b64 s[52:53], s[52:53], s[80:81]
    s_andn2_b64 s[52:53], s[52:53], s[50:51]
    s_or_b64 s[80:81], s[80:81], s[52:53]
    s_not_b64 vcc, s[52:53]
    s_mov_b64 exec, -1
    v_cndmask_b32_dpp v84, v84, v84, vcc wave_shr:1 row_mask:0xf bank_mask:0xf
    v_cndmask_b32_dpp v85, v85, v85, vcc wave_shr:1 row_mask:0xf bank_mask:0xf
    s_lshr_b64 s[52:53], s[52:53], 1
    v_cndmask_b32_dpp v86, v86, v86, vcc wave_shr:1 row_mask:0xf bank_mask:0xf
    v_cndmask_b32_dpp v87, v87, v87, vcc wave_shr:1 row_mask:0xf bank_mask:0xf
    s_andn2_b64 s[82:83], s[82:83], s[52:53]
    v_cndmask_b32_dpp v7, v7, v7, vcc wave_shr:1 row_mask:0xf bank_mask:0xf
    s_mov_b64 exec, s[50:51]
    s_cbranch_scc0 L2_d78
    s_mov_b64 exec, s[82:83]
    s_nop 1
    v_mfma_f32_4x4x4_16b_bf16 v[88:91], v[12:13], v[84:85], 0
    s_nop 1
    v_mfma_f32_4x4x4_16b_bf16 v[88:91], v[10:11], v[86:87], v[88:91]
    s_nop 4
    v_cvt_pk_bf16_f32 v88, v88, v89
    v_cvt_pk_bf16_f32 v89, v90, v91
    ds_pk_add_bf16 v7, v88 offset:65408
    ds_pk_add_bf16 v7, v89 offset:65412
    s_mov_b64 exec, s[50:51]
    s_branch L2_d78
L2_xa79:
    s_cmp_eq_u32 s101, 1
    s_cbranch_scc1 L2_xc79
    v_lshlrev_b32 v89, 0, v96
    v_add_u32 v90, 140, v97
    v_bitop3_b32 v90, v89, v45, v90 bitop3:0x6a
    ds_write_b32 v98, v90 offset:28
    v_lshlrev_b32 v89, 4, v96
    v_add_u32 v90, 120, v97
    v_bitop3_b32 v90, v89, v45, v90 bitop3:0x6a
    ds_write_b32 v98, v90 offset:24
    v_lshlrev_b32 v89, 8, v96
    v_add_u32 v90, 100, v97
    v_bitop3_b32 v90, v89, v45, v90 bitop3:0x6a
    ds_write_b32 v98, v90 offset:20
L2_xc79:
    v_lshlrev_b32 v89, 12, v96
    v_add_u32 v90, 80, v97
    v_bitop3_b32 v90, v89, v45, v90 bitop3:0x6a
    ds_write_b32 v98, v90 offset:16
    s_branch L2_xb79
L2_xe79:
    v_cmp_lt_u32 vcc, 32, v99
    v_cmp_lt_u32 s[58:59], 31, v88
    v_lshrrev_b32 v89, 16, v96
    v_add_u32 v97, 80, v97
    s_or_b64 vcc, vcc, s[58:59]
    s_cbranch_scc1 L2_xs79
    v_lshlrev_b32 v89, v1, v89
    v_and_b32 v89, v45, v89
    v_cmp_ne_u32 vcc, 0, v89
    v_xor_b32 v90, v97, v89
    s_add_u32 s3, s37, s38
    v_mbcnt_lo_u32_b32 v98, vcc_lo, 0
    v_mbcnt_hi_u32_b32 v98, vcc_hi, v98
    s_bcnt1_i32_b64 s41, vcc
    v_lshl_add_u32 v98, v98, 2, s3
    s_lshl2_add_u32 s37, s41, s37
    s_mov_b64 exec, vcc
    ds_write_b32 v98, v90
    s_mov_b64 exec, -1
    s_branch L2_xr79
L2_xf79:
    s_waitcnt lgkmcnt(0)
    s_cmp_gt_u32 s37, 1024
    s_cbranch_scc1 L2_xs79
    s_cmp_lt_u32 s37, 768
    s_cbranch_scc1 L2_xl79
    ds_read_b32 v33, v98 offset:896
    s_add_u32 s3, s42, 2
    s_bitset1_b32 s43, s3
    s_branch L2_xg79
L2_xl79:
    v_mov_b32 v42, -1
    s_cmp_ge_u32 s37, 512
    s_cbranch_scc1 L2_xg79
    v_mov_b32 v43, -1
    s_cmp_ge_u32 s37, 256
    s_cbranch_scc1 L2_xg79
    v_mov_b32 v41, -1
    s_branch L2_xg79
L2_xs79:
    s_waitcnt lgkmcnt(0)
    v_mov_b32 v40, -1
    v_mov_b32 v41, -1
    v_mov_b32 v43, -1
    v_mov_b32 v42, -1
    s_add_u32 s3, s42, 2
    s_bitset1_b32 s36, s3
    s_branch L2_xg79
L2_c80:
    s_lshl_b64 s[52:53], s[82:83], 1
    s_andn2_b64 s[52:53], s[52:53], s[80:81]
    s_andn2_b64 s[52:53], s[52:53], s[54:55]
    s_or_b64 s[80:81], s[80:81], s[52:53]
    s_not_b64 vcc, s[52:53]
    s_mov_b64 exec, -1
    v_cndmask_b32_dpp v84, v84, v84, vcc wave_shr:1 row_mask:0xf bank_mask:0xf
    v_cndmask_b32_dpp v85, v85, v85, vcc wave_shr:1 row_mask:0xf bank_mask:0xf
    s_lshr_b64 s[52:53], s[52:53], 1
    v_cndmask_b32_dpp v86, v86, v86, vcc wave_shr:1 row_mask:0xf bank_mask:0xf
    v_cndmask_b32_dpp v87, v87, v87, vcc wave_shr:1 row_mask:0xf bank_mask:0xf
    s_andn2_b64 s[82:83], s[82:83], s[52:53]
    v_cndmask_b32_dpp v7, v7, v7, vcc wave_shr:1 row_mask:0xf bank_mask:0xf
    s_mov_b64 exec, s[54:55]
    s_cbranch_scc0 L2_d80
    s_mov_b64 exec, s[82:83]
    s_nop 1
    v_mfma_f32_4x4x4_16b_bf16 v[88:91], v[12:13], v[84:85], 0
    s_nop 1
    v_mfma_f32_4x4x4_16b_bf16 v[88:91], v[10:11], v[86:87], v[88:91]
    s_nop 4
    v_cvt_pk_bf16_f32 v88, v88, v89
    v_cvt_pk_bf16_f32 v89, v90, v91
    ds_pk_add_bf16 v7, v88 offset:65408
    ds_pk_add_bf16 v7, v89 offset:65412
    s_mov_b64 exec, s[54:55]
    s_branch L2_d80
L2_c81:
    s_lshl_b64 s[52:53], s[82:83], 1
    s_andn2_b64 s[52:53], s[52:53], s[80:81]
    s_andn2_b64 s[52:53], s[52:53], s[50:51]
    s_or_b64 s[80:81], s[80:81], s[52:53]
    s_not_b64 vcc, s[52:53]
    s_mov_b64 exec, -1
    v_cndmask_b32_dpp v84, v84, v84, vcc wave_shr:1 row_mask:0xf bank_mask:0xf
    v_cndmask_b32_dpp v85, v85, v85, vcc wave_shr:1 row_mask:0xf bank_mask:0xf
    s_lshr_b64 s[52:53], s[52:53], 1
    v_cndmask_b32_dpp v86, v86, v86, vcc wave_shr:1 row_mask:0xf bank_mask:0xf
    v_cndmask_b32_dpp v87, v87, v87, vcc wave_shr:1 row_mask:0xf bank_mask:0xf
    s_andn2_b64 s[82:83], s[82:83], s[52:53]
    v_cndmask_b32_dpp v7, v7, v7, vcc wave_shr:1 row_mask:0xf bank_mask:0xf
    s_mov_b64 exec, s[50:51]
    s_cbranch_scc0 L2_d81
    s_mov_b64 exec, s[82:83]
    s_nop 1
    v_mfma_f32_4x4x4_16b_bf16 v[88:91], v[12:13], v[84:85], 0
    s_nop 1
    v_mfma_f32_4x4x4_16b_bf16 v[88:91], v[10:11], v[86:87], v[88:91]
    s_nop 4
    v_cvt_pk_bf16_f32 v88, v88, v89
    v_cvt_pk_bf16_f32 v89, v90, v91
    ds_pk_add_bf16 v7, v88 offset:65408
    ds_pk_add_bf16 v7, v89 offset:65412
    s_mov_b64 exec, s[50:51]
    s_branch L2_d81
L2_oa82:
    v_and_b32 v47, 0x0fffffff, v32
    buffer_load_dword v114, v47, s[8:11], 0 offen offset:16
    s_mov_b64 exec, s[6:7]
    v_add_u32 v47, 8, v47
    v_lshrrev_b32 v32, 2, v32
    s_mov_b64 exec, -1
    buffer_load_dwordx2 v[112:113], v47, s[8:11], 0 offen
    s_branch L2_ob82
L2_c83:
    s_lshl_b64 s[52:53], s[82:83], 1
    s_andn2_b64 s[52:53], s[52:53], s[80:81]
    s_andn2_b64 s[52:53], s[52:53], s[54:55]
    s_or_b64 s[80:81], s[80:81], s[52:53]
    s_not_b64 vcc, s[52:53]
    s_mov_b64 exec, -1
    v_cndmask_b32_dpp v84, v84, v84, vcc wave_shr:1 row_mask:0xf bank_mask:0xf
    v_cndmask_b32_dpp v85, v85, v85, vcc wave_shr:1 row_mask:0xf bank_mask:0xf
    s_lshr_b64 s[52:53], s[52:53], 1
    v_cndmask_b32_dpp v86, v86, v86, vcc wave_shr:1 row_mask:0xf bank_mask:0xf
    v_cndmask_b32_dpp v87, v87, v87, vcc wave_shr:1 row_mask:0xf bank_mask:0xf
    s_andn2_b64 s[82:83], s[82:83], s[52:53]
    v_cndmask_b32_dpp v7, v7, v7, vcc wave_shr:1 row_mask:0xf bank_mask:0xf
    s_mov_b64 exec, s[54:55]
    s_cbranch_scc0 L2_d83
    s_mov_b64 exec, s[82:83]
    s_nop 1
    v_mfma_f32_4x4x4_16b_bf16 v[88:91], v[12:13], v[84:85], 0
    s_nop 1
    v_mfma_f32_4x4x4_16b_bf16 v[88:91], v[10:11], v[86:87], v[88:91]
    s_nop 4
    v_cvt_pk_bf16_f32 v88, v88, v89
    v_cvt_pk_bf16_f32 v89, v90, v91
    ds_pk_add_bf16 v7, v88 offset:65408
    ds_pk_add_bf16 v7, v89 offset:65412
    s_mov_b64 exec, s[54:55]
    s_branch L2_d83
L2_c84:
    s_lshl_b64 s[52:53], s[82:83], 1
    s_andn2_b64 s[52:53], s[52:53], s[80:81]
    s_andn2_b64 s[52:53], s[52:53], s[50:51]
    s_or_b64 s[80:81], s[80:81], s[52:53]
    s_not_b64 vcc, s[52:53]
    s_mov_b64 exec, -1
    v_cndmask_b32_dpp v84, v84, v84, vcc wave_shr:1 row_mask:0xf bank_mask:0xf
    v_cndmask_b32_dpp v85, v85, v85, vcc wave_shr:1 row_mask:0xf bank_mask:0xf
    s_lshr_b64 s[52:53], s[52:53], 1
    v_cndmask_b32_dpp v86, v86, v86, vcc wave_shr:1 row_mask:0xf bank_mask:0xf
    v_cndmask_b32_dpp v87, v87, v87, vcc wave_shr:1 row_mask:0xf bank_mask:0xf
    s_andn2_b64 s[82:83], s[82:83], s[52:53]
    v_cndmask_b32_dpp v7, v7, v7, vcc wave_shr:1 row_mask:0xf bank_mask:0xf
    s_mov_b64 exec, s[50:51]
    s_cbranch_scc0 L2_d84
    s_mov_b64 exec, s[82:83]
    s_nop 1
    v_mfma_f32_4x4x4_16b_bf16 v[88:91], v[12:13], v[84:85], 0
    s_nop 1
    v_mfma_f32_4x4x4_16b_bf16 v[88:91], v[10:11], v[86:87], v[88:91]
    s_nop 4
    v_cvt_pk_bf16_f32 v88, v88, v89
    v_cvt_pk_bf16_f32 v89, v90, v91
    ds_pk_add_bf16 v7, v88 offset:65408
    ds_pk_add_bf16 v7, v89 offset:65412
    s_mov_b64 exec, s[50:51]
    s_branch L2_d84
L2_c85:
    s_lshl_b64 s[52:53], s[82:83], 1
    s_andn2_b64 s[52:53], s[52:53], s[80:81]
    s_andn2_b64 s[52:53], s[52:53], s[54:55]
    s_or_b64 s[80:81], s[80:81], s[52:53]
    s_not_b64 vcc, s[52:53]
    s_mov_b64 exec, -1
    v_cndmask_b32_dpp v84, v84, v84, vcc wave_shr:1 row_mask:0xf bank_mask:0xf
    v_cndmask_b32_dpp v85, v85, v85, vcc wave_shr:1 row_mask:0xf bank_mask:0xf
    s_lshr_b64 s[52:53], s[52:53], 1
    v_cndmask_b32_dpp v86, v86, v86, vcc wave_shr:1 row_mask:0xf bank_mask:0xf
    v_cndmask_b32_dpp v87, v87, v87, vcc wave_shr:1 row_mask:0xf bank_mask:0xf
    s_andn2_b64 s[82:83], s[82:83], s[52:53]
    v_cndmask_b32_dpp v7, v7, v7, vcc wave_shr:1 row_mask:0xf bank_mask:0xf
    s_mov_b64 exec, s[54:55]
    s_cbranch_scc0 L2_d85
    s_mov_b64 exec, s[82:83]
    s_nop 1
    v_mfma_f32_4x4x4_16b_bf16 v[88:91], v[12:13], v[84:85], 0
    s_nop 1
    v_mfma_f32_4x4x4_16b_bf16 v[88:91], v[10:11], v[86:87], v[88:91]
    s_nop 4
    v_cvt_pk_bf16_f32 v88, v88, v89
    v_cvt_pk_bf16_f32 v89, v90, v91
    ds_pk_add_bf16 v7, v88 offset:65408
    ds_pk_add_bf16 v7, v89 offset:65412
    s_mov_b64 exec, s[54:55]
    s_branch L2_d85
L2_c86:
    s_lshl_b64 s[52:53], s[82:83], 1
    s_andn2_b64 s[52:53], s[52:53], s[80:81]
    s_andn2_b64 s[52:53], s[52:53], s[50:51]
    s_or_b64 s[80:81], s[80:81], s[52:53]
    s_not_b64 vcc, s[52:53]
    s_mov_b64 exec, -1
    v_cndmask_b32_dpp v84, v84, v84, vcc wave_shr:1 row_mask:0xf bank_mask:0xf
    v_cndmask_b32_dpp v85, v85, v85, vcc wave_shr:1 row_mask:0xf bank_mask:0xf
    s_lshr_b64 s[52:53], s[52:53], 1
    v_cndmask_b32_dpp v86, v86, v86, vcc wave_shr:1 row_mask:0xf bank_mask:0xf
    v_cndmask_b32_dpp v87, v87, v87, vcc wave_shr:1 row_mask:0xf bank_mask:0xf
    s_andn2_b64 s[82:83], s[82:83], s[52:53]
    v_cndmask_b32_dpp v7, v7, v7, vcc wave_shr:1 row_mask:0xf bank_mask:0xf
    s_mov_b64 exec, s[50:51]
    s_cbranch_scc0 L2_d86
    s_mov_b64 exec, s[82:83]
    s_nop 1
    v_mfma_f32_4x4x4_16b_bf16 v[88:91], v[12:13], v[84:85], 0
    s_nop 1
    v_mfma_f32_4x4x4_16b_bf16 v[88:91], v[10:11], v[86:87], v[88:91]
    s_nop 4
    v_cvt_pk_bf16_f32 v88, v88, v89
    v_cvt_pk_bf16_f32 v89, v90, v91
    ds_pk_add_bf16 v7, v88 offset:65408
    ds_pk_add_bf16 v7, v89 offset:65412
    s_mov_b64 exec, s[50:51]
    s_branch L2_d86
L2_c87:
    s_lshl_b64 s[52:53], s[82:83], 1
    s_andn2_b64 s[52:53], s[52:53], s[80:81]
    s_andn2_b64 s[52:53], s[52:53], s[54:55]
    s_or_b64 s[80:81], s[80:81], s[52:53]
    s_not_b64 vcc, s[52:53]
    s_mov_b64 exec, -1
    v_cndmask_b32_dpp v84, v84, v84, vcc wave_shr:1 row_mask:0xf bank_mask:0xf
    v_cndmask_b32_dpp v85, v85, v85, vcc wave_shr:1 row_mask:0xf bank_mask:0xf
    s_lshr_b64 s[52:53], s[52:53], 1
    v_cndmask_b32_dpp v86, v86, v86, vcc wave_shr:1 row_mask:0xf bank_mask:0xf
    v_cndmask_b32_dpp v87, v87, v87, vcc wave_shr:1 row_mask:0xf bank_mask:0xf
    s_andn2_b64 s[82:83], s[82:83], s[52:53]
    v_cndmask_b32_dpp v7, v7, v7, vcc wave_shr:1 row_mask:0xf bank_mask:0xf
    s_mov_b64 exec, s[54:55]
    s_cbranch_scc0 L2_d87
    s_mov_b64 exec, s[82:83]
    s_nop 1
    v_mfma_f32_4x4x4_16b_bf16 v[88:91], v[12:13], v[84:85], 0
    s_nop 1
    v_mfma_f32_4x4x4_16b_bf16 v[88:91], v[10:11], v[86:87], v[88:91]
    s_nop 4
    v_cvt_pk_bf16_f32 v88, v88, v89
    v_cvt_pk_bf16_f32 v89, v90, v91
    ds_pk_add_bf16 v7, v88 offset:65408
    ds_pk_add_bf16 v7, v89 offset:65412
    s_mov_b64 exec, s[54:55]
    s_branch L2_d87
L2_c88:
    s_lshl_b64 s[52:53], s[82:83], 1
    s_andn2_b64 s[52:53], s[52:53], s[80:81]
    s_andn2_b64 s[52:53], s[52:53], s[50:51]
    s_or_b64 s[80:81], s[80:81], s[52:53]
    s_not_b64 vcc, s[52:53]
    s_mov_b64 exec, -1
    v_cndmask_b32_dpp v84, v84, v84, vcc wave_shr:1 row_mask:0xf bank_mask:0xf
    v_cndmask_b32_dpp v85, v85, v85, vcc wave_shr:1 row_mask:0xf bank_mask:0xf
    s_lshr_b64 s[52:53], s[52:53], 1
    v_cndmask_b32_dpp v86, v86, v86, vcc wave_shr:1 row_mask:0xf bank_mask:0xf
    v_cndmask_b32_dpp v87, v87, v87, vcc wave_shr:1 row_mask:0xf bank_mask:0xf
    s_andn2_b64 s[82:83], s[82:83], s[52:53]
    v_cndmask_b32_dpp v7, v7, v7, vcc wave_shr:1 row_mask:0xf bank_mask:0xf
    s_mov_b64 exec, s[50:51]
    s_cbranch_scc0 L2_d88
    s_mov_b64 exec, s[82:83]
    s_nop 1
    v_mfma_f32_4x4x4_16b_bf16 v[88:91], v[12:13], v[84:85], 0
    s_nop 1
    v_mfma_f32_4x4x4_16b_bf16 v[88:91], v[10:11], v[86:87], v[88:91]
    s_nop 4
    v_cvt_pk_bf16_f32 v88, v88, v89
    v_cvt_pk_bf16_f32 v89, v90, v91
    ds_pk_add_bf16 v7, v88 offset:65408
    ds_pk_add_bf16 v7, v89 offset:65412
    s_mov_b64 exec, s[50:51]
    s_branch L2_d88
L2_oa89:
    s_waitcnt vmcnt(3)
    s_mov_b64 exec, s[6:7]
    v_lshrrev_b32 v114, 16, v114
    s_mov_b64 exec, -1
    v_and_b32 v46, 0x10000000, v32
    v_cmpx_eq_u32 vcc, 0, v46
    v_lshrrev_b32 v47, 14, v112
    v_and_b32 v47, v5, v47
    ds_read_b64 v[96:97], v47
    v_perm_b32 v98, v112, v114, s44
    v_bitop3_b32 v99, v112, 0.5, -0.5 bitop3:0xa8
    v_bitop3_b32 v98, v6, v98, v99 bitop3:0xca
    v_and_b32 v47, v5, v112
    s_waitcnt lgkmcnt(0)
    v_mfma_f32_4x4x4_16b_bf16 v[88:91], v[8:9], v[96:97], 0
    s_nop 4
    v_mul_f32 v88, v98, v88
    v_mul_f32 v89, v98, v89
    v_mul_f32 v90, v98, v90
    v_mul_f32 v91, v98, v91
    v_cvt_pk_bf16_f32 v88, v88, v89
    v_cvt_pk_bf16_f32 v89, v90, v91
    ds_pk_add_bf16 v47, v88 offset:65408
    ds_pk_add_bf16 v47, v89 offset:65412
    s_mov_b64 exec, -1
    v_and_b32 v46, 0x20000000, v32
    v_cmpx_eq_u32 vcc, 0, v46
    v_lshrrev_b32 v47, 14, v113
    v_and_b32 v47, v5, v47
    ds_read_b64 v[96:97], v47
    v_perm_b32 v98, v113, v114, s45
    v_bitop3_b32 v99, v113, 0.5, -0.5 bitop3:0xa8
    v_bitop3_b32 v98, v6, v98, v99 bitop3:0xca
    v_and_b32 v47, v5, v113
    s_waitcnt lgkmcnt(0)
    v_mfma_f32_4x4x4_16b_bf16 v[88:91], v[8:9], v[96:97], 0
    s_nop 4
    v_mul_f32 v88, v98, v88
    v_mul_f32 v89, v98, v89
    v_mul_f32 v90, v98, v90
    v_mul_f32 v91, v98, v91
    v_cvt_pk_bf16_f32 v88, v88, v89
    v_cvt_pk_bf16_f32 v89, v90, v91
    ds_pk_add_bf16 v47, v88 offset:65408
    ds_pk_add_bf16 v47, v89 offset:65412
    s_mov_b64 exec, -1
    s_branch L2_ob89
L2_xo90:
    v_cmp_lt_u32 vcc, 20, v99
    s_mov_b32 s101, 1
    s_cbranch_vccz L2_xp90
    v_cmp_lt_u32 vcc, 32, v99
    v_cmp_lt_u32 s[58:59], 31, v88
    s_mov_b32 s101, 2
    s_or_b64 vcc, vcc, s[58:59]
    s_cbranch_scc0 L2_xp90
    s_mov_b32 s37, 0x10000
    s_branch L2_xp90
L2_c91:
    s_lshl_b64 s[52:53], s[82:83], 1
    s_andn2_b64 s[52:53], s[52:53], s[80:81]
    s_andn2_b64 s[52:53], s[52:53], s[54:55]
    s_or_b64 s[80:81], s[80:81], s[52:53]
    s_not_b64 vcc, s[52:53]
    s_mov_b64 exec, -1
    v_cndmask_b32_dpp v84, v84, v84, vcc wave_shr:1 row_mask:0xf bank_mask:0xf
    v_cndmask_b32_dpp v85, v85, v85, vcc wave_shr:1 row_mask:0xf bank_mask:0xf
    s_lshr_b64 s[52:53], s[52:53], 1
    v_cndmask_b32_dpp v86, v86, v86, vcc wave_shr:1 row_mask:0xf bank_mask:0xf
    v_cndmask_b32_dpp v87, v87, v87, vcc wave_shr:1 row_mask:0xf bank_mask:0xf
    s_andn2_b64 s[82:83], s[82:83], s[52:53]
    v_cndmask_b32_dpp v7, v7, v7, vcc wave_shr:1 row_mask:0xf bank_mask:0xf
    s_mov_b64 exec, s[54:55]
    s_cbranch_scc0 L2_d91
    s_mov_b64 exec, s[82:83]
    s_nop 1
    v_mfma_f32_4x4x4_16b_bf16 v[88:91], v[12:13], v[84:85], 0
    s_nop 1
    v_mfma_f32_4x4x4_16b_bf16 v[88:91], v[10:11], v[86:87], v[88:91]
    s_nop 4
    v_cvt_pk_bf16_f32 v88, v88, v89
    v_cvt_pk_bf16_f32 v89, v90, v91
    ds_pk_add_bf16 v7, v88 offset:65408
    ds_pk_add_bf16 v7, v89 offset:65412
    s_mov_b64 exec, s[54:55]
    s_branch L2_d91
L2_c92:
    s_lshl_b64 s[52:53], s[82:83], 1
    s_andn2_b64 s[52:53], s[52:53], s[80:81]
    s_andn2_b64 s[52:53], s[52:53], s[50:51]
    s_or_b64 s[80:81], s[80:81], s[52:53]
    s_not_b64 vcc, s[52:53]
    s_mov_b64 exec, -1
    v_cndmask_b32_dpp v84, v84, v84, vcc wave_shr:1 row_mask:0xf bank_mask:0xf
    v_cndmask_b32_dpp v85, v85, v85, vcc wave_shr:1 row_mask:0xf bank_mask:0xf
    s_lshr_b64 s[52:53], s[52:53], 1
    v_cndmask_b32_dpp v86, v86, v86, vcc wave_shr:1 row_mask:0xf bank_mask:0xf
    v_cndmask_b32_dpp v87, v87, v87, vcc wave_shr:1 row_mask:0xf bank_mask:0xf
    s_andn2_b64 s[82:83], s[82:83], s[52:53]
    v_cndmask_b32_dpp v7, v7, v7, vcc wave_shr:1 row_mask:0xf bank_mask:0xf
    s_mov_b64 exec, s[50:51]
    s_cbranch_scc0 L2_d92
    s_mov_b64 exec, s[82:83]
    s_nop 1
    v_mfma_f32_4x4x4_16b_bf16 v[88:91], v[12:13], v[84:85], 0
    s_nop 1
    v_mfma_f32_4x4x4_16b_bf16 v[88:91], v[10:11], v[86:87], v[88:91]
    s_nop 4
    v_cvt_pk_bf16_f32 v88, v88, v89
    v_cvt_pk_bf16_f32 v89, v90, v91
    ds_pk_add_bf16 v7, v88 offset:65408
    ds_pk_add_bf16 v7, v89 offset:65412
    s_mov_b64 exec, s[50:51]
    s_branch L2_d92
L2_c93:
    s_lshl_b64 s[52:53], s[82:83], 1
    s_andn2_b64 s[52:53], s[52:53], s[80:81]
    s_andn2_b64 s[52:53], s[52:53], s[54:55]
    s_or_b64 s[80:81], s[80:81], s[52:53]
    s_not_b64 vcc, s[52:53]
    s_mov_b64 exec, -1
    v_cndmask_b32_dpp v84, v84, v84, vcc wave_shr:1 row_mask:0xf bank_mask:0xf
    v_cndmask_b32_dpp v85, v85, v85, vcc wave_shr:1 row_mask:0xf bank_mask:0xf
    s_lshr_b64 s[52:53], s[52:53], 1
    v_cndmask_b32_dpp v86, v86, v86, vcc wave_shr:1 row_mask:0xf bank_mask:0xf
    v_cndmask_b32_dpp v87, v87, v87, vcc wave_shr:1 row_mask:0xf bank_mask:0xf
    s_andn2_b64 s[82:83], s[82:83], s[52:53]
    v_cndmask_b32_dpp v7, v7, v7, vcc wave_shr:1 row_mask:0xf bank_mask:0xf
    s_mov_b64 exec, s[54:55]
    s_cbranch_scc0 L2_d93
    s_mov_b64 exec, s[82:83]
    s_nop 1
    v_mfma_f32_4x4x4_16b_bf16 v[88:91], v[12:13], v[84:85], 0
    s_nop 1
    v_mfma_f32_4x4x4_16b_bf16 v[88:91], v[10:11], v[86:87], v[88:91]
    s_nop 4
    v_cvt_pk_bf16_f32 v88, v88, v89
    v_cvt_pk_bf16_f32 v89, v90, v91
    ds_pk_add_bf16 v7, v88 offset:65408
    ds_pk_add_bf16 v7, v89 offset:65412
    s_mov_b64 exec, s[54:55]
    s_branch L2_d93
L2_c94:
    s_lshl_b64 s[52:53], s[82:83], 1
    s_andn2_b64 s[52:53], s[52:53], s[80:81]
    s_andn2_b64 s[52:53], s[52:53], s[50:51]
    s_or_b64 s[80:81], s[80:81], s[52:53]
    s_not_b64 vcc, s[52:53]
    s_mov_b64 exec, -1
    v_cndmask_b32_dpp v84, v84, v84, vcc wave_shr:1 row_mask:0xf bank_mask:0xf
    v_cndmask_b32_dpp v85, v85, v85, vcc wave_shr:1 row_mask:0xf bank_mask:0xf
    s_lshr_b64 s[52:53], s[52:53], 1
    v_cndmask_b32_dpp v86, v86, v86, vcc wave_shr:1 row_mask:0xf bank_mask:0xf
    v_cndmask_b32_dpp v87, v87, v87, vcc wave_shr:1 row_mask:0xf bank_mask:0xf
    s_andn2_b64 s[82:83], s[82:83], s[52:53]
    v_cndmask_b32_dpp v7, v7, v7, vcc wave_shr:1 row_mask:0xf bank_mask:0xf
    s_mov_b64 exec, s[50:51]
    s_cbranch_scc0 L2_d94
    s_mov_b64 exec, s[82:83]
    s_nop 1
    v_mfma_f32_4x4x4_16b_bf16 v[88:91], v[12:13], v[84:85], 0
    s_nop 1
    v_mfma_f32_4x4x4_16b_bf16 v[88:91], v[10:11], v[86:87], v[88:91]
    s_nop 4
    v_cvt_pk_bf16_f32 v88, v88, v89
    v_cvt_pk_bf16_f32 v89, v90, v91
    ds_pk_add_bf16 v7, v88 offset:65408
    ds_pk_add_bf16 v7, v89 offset:65412
    s_mov_b64 exec, s[50:51]
    s_branch L2_d94
L2_c95:
    s_lshl_b64 s[52:53], s[82:83], 1
    s_andn2_b64 s[52:53], s[52:53], s[80:81]
    s_andn2_b64 s[52:53], s[52:53], s[54:55]
    s_or_b64 s[80:81], s[80:81], s[52:53]
    s_not_b64 vcc, s[52:53]
    s_mov_b64 exec, -1
    v_cndmask_b32_dpp v84, v84, v84, vcc wave_shr:1 row_mask:0xf bank_mask:0xf
    v_cndmask_b32_dpp v85, v85, v85, vcc wave_shr:1 row_mask:0xf bank_mask:0xf
    s_lshr_b64 s[52:53], s[52:53], 1
    v_cndmask_b32_dpp v86, v86, v86, vcc wave_shr:1 row_mask:0xf bank_mask:0xf
    v_cndmask_b32_dpp v87, v87, v87, vcc wave_shr:1 row_mask:0xf bank_mask:0xf
    s_andn2_b64 s[82:83], s[82:83], s[52:53]
    v_cndmask_b32_dpp v7, v7, v7, vcc wave_shr:1 row_mask:0xf bank_mask:0xf
    s_mov_b64 exec, s[54:55]
    s_cbranch_scc0 L2_d95
    s_mov_b64 exec, s[82:83]
    s_nop 1
    v_mfma_f32_4x4x4_16b_bf16 v[88:91], v[12:13], v[84:85], 0
    s_nop 1
    v_mfma_f32_4x4x4_16b_bf16 v[88:91], v[10:11], v[86:87], v[88:91]
    s_nop 4
    v_cvt_pk_bf16_f32 v88, v88, v89
    v_cvt_pk_bf16_f32 v89, v90, v91
    ds_pk_add_bf16 v7, v88 offset:65408
    ds_pk_add_bf16 v7, v89 offset:65412
    s_mov_b64 exec, s[54:55]
    s_branch L2_d95
L2_c96:
    s_lshl_b64 s[52:53], s[82:83], 1
    s_andn2_b64 s[52:53], s[52:53], s[80:81]
    s_andn2_b64 s[52:53], s[52:53], s[50:51]
    s_or_b64 s[80:81], s[80:81], s[52:53]
    s_not_b64 vcc, s[52:53]
    s_mov_b64 exec, -1
    v_cndmask_b32_dpp v84, v84, v84, vcc wave_shr:1 row_mask:0xf bank_mask:0xf
    v_cndmask_b32_dpp v85, v85, v85, vcc wave_shr:1 row_mask:0xf bank_mask:0xf
    s_lshr_b64 s[52:53], s[52:53], 1
    v_cndmask_b32_dpp v86, v86, v86, vcc wave_shr:1 row_mask:0xf bank_mask:0xf
    v_cndmask_b32_dpp v87, v87, v87, vcc wave_shr:1 row_mask:0xf bank_mask:0xf
    s_andn2_b64 s[82:83], s[82:83], s[52:53]
    v_cndmask_b32_dpp v7, v7, v7, vcc wave_shr:1 row_mask:0xf bank_mask:0xf
    s_mov_b64 exec, s[50:51]
    s_cbranch_scc0 L2_d96
    s_mov_b64 exec, s[82:83]
    s_nop 1
    v_mfma_f32_4x4x4_16b_bf16 v[88:91], v[12:13], v[84:85], 0
    s_nop 1
    v_mfma_f32_4x4x4_16b_bf16 v[88:91], v[10:11], v[86:87], v[88:91]
    s_nop 4
    v_cvt_pk_bf16_f32 v88, v88, v89
    v_cvt_pk_bf16_f32 v89, v90, v91
    ds_pk_add_bf16 v7, v88 offset:65408
    ds_pk_add_bf16 v7, v89 offset:65412
    s_mov_b64 exec, s[50:51]
    s_branch L2_d96
L2_xa97:
    s_cmp_eq_u32 s101, 1
    s_cbranch_scc1 L2_xc97
    v_lshlrev_b32 v89, 0, v96
    v_add_u32 v90, 140, v97
    v_bitop3_b32 v90, v89, v45, v90 bitop3:0x6a
    ds_write_b32 v98, v90 offset:28
    v_lshlrev_b32 v89, 4, v96
    v_add_u32 v90, 120, v97
    v_bitop3_b32 v90, v89, v45, v90 bitop3:0x6a
    ds_write_b32 v98, v90 offset:24
    v_lshlrev_b32 v89, 8, v96
    v_add_u32 v90, 100, v97
    v_bitop3_b32 v90, v89, v45, v90 bitop3:0x6a
    ds_write_b32 v98, v90 offset:20
L2_xc97:
    v_lshlrev_b32 v89, 12, v96
    v_add_u32 v90, 80, v97
    v_bitop3_b32 v90, v89, v45, v90 bitop3:0x6a
    ds_write_b32 v98, v90 offset:16
    s_branch L2_xb97
L2_xe97:
    v_cmp_lt_u32 vcc, 32, v99
    v_cmp_lt_u32 s[58:59], 31, v88
    v_lshrrev_b32 v89, 16, v96
    v_add_u32 v97, 80, v97
    s_or_b64 vcc, vcc, s[58:59]
    s_cbranch_scc1 L2_xs97
    v_lshlrev_b32 v89, v1, v89
    v_and_b32 v89, v45, v89
    v_cmp_ne_u32 vcc, 0, v89
    v_xor_b32 v90, v97, v89
    s_add_u32 s3, s37, s38
    v_mbcnt_lo_u32_b32 v98, vcc_lo, 0
    v_mbcnt_hi_u32_b32 v98, vcc_hi, v98
    s_bcnt1_i32_b64 s41, vcc
    v_lshl_add_u32 v98, v98, 2, s3
    s_lshl2_add_u32 s37, s41, s37
    s_mov_b64 exec, vcc
    ds_write_b32 v98, v90
    s_mov_b64 exec, -1
    s_branch L2_xr97
L2_xf97:
    s_waitcnt lgkmcnt(0)
    s_cmp_gt_u32 s37, 1024
    s_cbranch_scc1 L2_xs97
    s_cmp_lt_u32 s37, 768
    s_cbranch_scc1 L2_xl97
    ds_read_b32 v32, v98 offset:896
    s_add_u32 s3, s42, 2
    s_bitset1_b32 s43, s3
    s_branch L2_xg97
L2_xl97:
    v_mov_b32 v42, -1
    s_cmp_ge_u32 s37, 512
    s_cbranch_scc1 L2_xg97
    v_mov_b32 v43, -1
    s_cmp_ge_u32 s37, 256
    s_cbranch_scc1 L2_xg97
    v_mov_b32 v41, -1
    s_branch L2_xg97
L2_xs97:
    s_waitcnt lgkmcnt(0)
    v_mov_b32 v40, -1
    v_mov_b32 v41, -1
    v_mov_b32 v43, -1
    v_mov_b32 v42, -1
    s_add_u32 s3, s42, 2
    s_bitset1_b32 s36, s3
    s_branch L2_xg97
L2_c98:
    s_lshl_b64 s[52:53], s[82:83], 1
    s_andn2_b64 s[52:53], s[52:53], s[80:81]
    s_andn2_b64 s[52:53], s[52:53], s[54:55]
    s_or_b64 s[80:81], s[80:81], s[52:53]
    s_not_b64 vcc, s[52:53]
    s_mov_b64 exec, -1
    v_cndmask_b32_dpp v84, v84, v84, vcc wave_shr:1 row_mask:0xf bank_mask:0xf
    v_cndmask_b32_dpp v85, v85, v85, vcc wave_shr:1 row_mask:0xf bank_mask:0xf
    s_lshr_b64 s[52:53], s[52:53], 1
    v_cndmask_b32_dpp v86, v86, v86, vcc wave_shr:1 row_mask:0xf bank_mask:0xf
    v_cndmask_b32_dpp v87, v87, v87, vcc wave_shr:1 row_mask:0xf bank_mask:0xf
    s_andn2_b64 s[82:83], s[82:83], s[52:53]
    v_cndmask_b32_dpp v7, v7, v7, vcc wave_shr:1 row_mask:0xf bank_mask:0xf
    s_mov_b64 exec, s[54:55]
    s_cbranch_scc0 L2_d98
    s_mov_b64 exec, s[82:83]
    s_nop 1
    v_mfma_f32_4x4x4_16b_bf16 v[88:91], v[12:13], v[84:85], 0
    s_nop 1
    v_mfma_f32_4x4x4_16b_bf16 v[88:91], v[10:11], v[86:87], v[88:91]
    s_nop 4
    v_cvt_pk_bf16_f32 v88, v88, v89
    v_cvt_pk_bf16_f32 v89, v90, v91
    ds_pk_add_bf16 v7, v88 offset:65408
    ds_pk_add_bf16 v7, v89 offset:65412
    s_mov_b64 exec, s[54:55]
    s_branch L2_d98
L2_c99:
    s_lshl_b64 s[52:53], s[82:83], 1
    s_andn2_b64 s[52:53], s[52:53], s[80:81]
    s_andn2_b64 s[52:53], s[52:53], s[50:51]
    s_or_b64 s[80:81], s[80:81], s[52:53]
    s_not_b64 vcc, s[52:53]
    s_mov_b64 exec, -1
    v_cndmask_b32_dpp v84, v84, v84, vcc wave_shr:1 row_mask:0xf bank_mask:0xf
    v_cndmask_b32_dpp v85, v85, v85, vcc wave_shr:1 row_mask:0xf bank_mask:0xf
    s_lshr_b64 s[52:53], s[52:53], 1
    v_cndmask_b32_dpp v86, v86, v86, vcc wave_shr:1 row_mask:0xf bank_mask:0xf
    v_cndmask_b32_dpp v87, v87, v87, vcc wave_shr:1 row_mask:0xf bank_mask:0xf
    s_andn2_b64 s[82:83], s[82:83], s[52:53]
    v_cndmask_b32_dpp v7, v7, v7, vcc wave_shr:1 row_mask:0xf bank_mask:0xf
    s_mov_b64 exec, s[50:51]
    s_cbranch_scc0 L2_d99
    s_mov_b64 exec, s[82:83]
    s_nop 1
    v_mfma_f32_4x4x4_16b_bf16 v[88:91], v[12:13], v[84:85], 0
    s_nop 1
    v_mfma_f32_4x4x4_16b_bf16 v[88:91], v[10:11], v[86:87], v[88:91]
    s_nop 4
    v_cvt_pk_bf16_f32 v88, v88, v89
    v_cvt_pk_bf16_f32 v89, v90, v91
    ds_pk_add_bf16 v7, v88 offset:65408
    ds_pk_add_bf16 v7, v89 offset:65412
    s_mov_b64 exec, s[50:51]
    s_branch L2_d99
L2_oa100:
    v_and_b32 v47, 0x0fffffff, v33
    buffer_load_dword v114, v47, s[8:11], 0 offen offset:16
    s_mov_b64 exec, s[6:7]
    v_add_u32 v47, 8, v47
    v_lshrrev_b32 v33, 2, v33
    s_mov_b64 exec, -1
    buffer_load_dwordx2 v[112:113], v47, s[8:11], 0 offen
    s_branch L2_ob100
L2_c101:
    s_lshl_b64 s[52:53], s[82:83], 1
    s_andn2_b64 s[52:53], s[52:53], s[80:81]
    s_andn2_b64 s[52:53], s[52:53], s[54:55]
    s_or_b64 s[80:81], s[80:81], s[52:53]
    s_not_b64 vcc, s[52:53]
    s_mov_b64 exec, -1
    v_cndmask_b32_dpp v84, v84, v84, vcc wave_shr:1 row_mask:0xf bank_mask:0xf
    v_cndmask_b32_dpp v85, v85, v85, vcc wave_shr:1 row_mask:0xf bank_mask:0xf
    s_lshr_b64 s[52:53], s[52:53], 1
    v_cndmask_b32_dpp v86, v86, v86, vcc wave_shr:1 row_mask:0xf bank_mask:0xf
    v_cndmask_b32_dpp v87, v87, v87, vcc wave_shr:1 row_mask:0xf bank_mask:0xf
    s_andn2_b64 s[82:83], s[82:83], s[52:53]
    v_cndmask_b32_dpp v7, v7, v7, vcc wave_shr:1 row_mask:0xf bank_mask:0xf
    s_mov_b64 exec, s[54:55]
    s_cbranch_scc0 L2_d101
    s_mov_b64 exec, s[82:83]
    s_nop 1
    v_mfma_f32_4x4x4_16b_bf16 v[88:91], v[12:13], v[84:85], 0
    s_nop 1
    v_mfma_f32_4x4x4_16b_bf16 v[88:91], v[10:11], v[86:87], v[88:91]
    s_nop 4
    v_cvt_pk_bf16_f32 v88, v88, v89
    v_cvt_pk_bf16_f32 v89, v90, v91
    ds_pk_add_bf16 v7, v88 offset:65408
    ds_pk_add_bf16 v7, v89 offset:65412
    s_mov_b64 exec, s[54:55]
    s_branch L2_d101
L2_c102:
    s_lshl_b64 s[52:53], s[82:83], 1
    s_andn2_b64 s[52:53], s[52:53], s[80:81]
    s_andn2_b64 s[52:53], s[52:53], s[50:51]
    s_or_b64 s[80:81], s[80:81], s[52:53]
    s_not_b64 vcc, s[52:53]
    s_mov_b64 exec, -1
    v_cndmask_b32_dpp v84, v84, v84, vcc wave_shr:1 row_mask:0xf bank_mask:0xf
    v_cndmask_b32_dpp v85, v85, v85, vcc wave_shr:1 row_mask:0xf bank_mask:0xf
    s_lshr_b64 s[52:53], s[52:53], 1
    v_cndmask_b32_dpp v86, v86, v86, vcc wave_shr:1 row_mask:0xf bank_mask:0xf
    v_cndmask_b32_dpp v87, v87, v87, vcc wave_shr:1 row_mask:0xf bank_mask:0xf
    s_andn2_b64 s[82:83], s[82:83], s[52:53]
    v_cndmask_b32_dpp v7, v7, v7, vcc wave_shr:1 row_mask:0xf bank_mask:0xf
    s_mov_b64 exec, s[50:51]
    s_cbranch_scc0 L2_d102
    s_mov_b64 exec, s[82:83]
    s_nop 1
    v_mfma_f32_4x4x4_16b_bf16 v[88:91], v[12:13], v[84:85], 0
    s_nop 1
    v_mfma_f32_4x4x4_16b_bf16 v[88:91], v[10:11], v[86:87], v[88:91]
    s_nop 4
    v_cvt_pk_bf16_f32 v88, v88, v89
    v_cvt_pk_bf16_f32 v89, v90, v91
    ds_pk_add_bf16 v7, v88 offset:65408
    ds_pk_add_bf16 v7, v89 offset:65412
    s_mov_b64 exec, s[50:51]
    s_branch L2_d102
L2_c103:
    s_lshl_b64 s[52:53], s[82:83], 1
    s_andn2_b64 s[52:53], s[52:53], s[80:81]
    s_andn2_b64 s[52:53], s[52:53], s[54:55]
    s_or_b64 s[80:81], s[80:81], s[52:53]
    s_not_b64 vcc, s[52:53]
    s_mov_b64 exec, -1
    v_cndmask_b32_dpp v84, v84, v84, vcc wave_shr:1 row_mask:0xf bank_mask:0xf
    v_cndmask_b32_dpp v85, v85, v85, vcc wave_shr:1 row_mask:0xf bank_mask:0xf
    s_lshr_b64 s[52:53], s[52:53], 1
    v_cndmask_b32_dpp v86, v86, v86, vcc wave_shr:1 row_mask:0xf bank_mask:0xf
    v_cndmask_b32_dpp v87, v87, v87, vcc wave_shr:1 row_mask:0xf bank_mask:0xf
    s_andn2_b64 s[82:83], s[82:83], s[52:53]
    v_cndmask_b32_dpp v7, v7, v7, vcc wave_shr:1 row_mask:0xf bank_mask:0xf
    s_mov_b64 exec, s[54:55]
    s_cbranch_scc0 L2_d103
    s_mov_b64 exec, s[82:83]
    s_nop 1
    v_mfma_f32_4x4x4_16b_bf16 v[88:91], v[12:13], v[84:85], 0
    s_nop 1
    v_mfma_f32_4x4x4_16b_bf16 v[88:91], v[10:11], v[86:87], v[88:91]
    s_nop 4
    v_cvt_pk_bf16_f32 v88, v88, v89
    v_cvt_pk_bf16_f32 v89, v90, v91
    ds_pk_add_bf16 v7, v88 offset:65408
    ds_pk_add_bf16 v7, v89 offset:65412
    s_mov_b64 exec, s[54:55]
    s_branch L2_d103
L2_c104:
    s_lshl_b64 s[52:53], s[82:83], 1
    s_andn2_b64 s[52:53], s[52:53], s[80:81]
    s_andn2_b64 s[52:53], s[52:53], s[50:51]
    s_or_b64 s[80:81], s[80:81], s[52:53]
    s_not_b64 vcc, s[52:53]
    s_mov_b64 exec, -1
    v_cndmask_b32_dpp v84, v84, v84, vcc wave_shr:1 row_mask:0xf bank_mask:0xf
    v_cndmask_b32_dpp v85, v85, v85, vcc wave_shr:1 row_mask:0xf bank_mask:0xf
    s_lshr_b64 s[52:53], s[52:53], 1
    v_cndmask_b32_dpp v86, v86, v86, vcc wave_shr:1 row_mask:0xf bank_mask:0xf
    v_cndmask_b32_dpp v87, v87, v87, vcc wave_shr:1 row_mask:0xf bank_mask:0xf
    s_andn2_b64 s[82:83], s[82:83], s[52:53]
    v_cndmask_b32_dpp v7, v7, v7, vcc wave_shr:1 row_mask:0xf bank_mask:0xf
    s_mov_b64 exec, s[50:51]
    s_cbranch_scc0 L2_d104
    s_mov_b64 exec, s[82:83]
    s_nop 1
    v_mfma_f32_4x4x4_16b_bf16 v[88:91], v[12:13], v[84:85], 0
    s_nop 1
    v_mfma_f32_4x4x4_16b_bf16 v[88:91], v[10:11], v[86:87], v[88:91]
    s_nop 4
    v_cvt_pk_bf16_f32 v88, v88, v89
    v_cvt_pk_bf16_f32 v89, v90, v91
    ds_pk_add_bf16 v7, v88 offset:65408
    ds_pk_add_bf16 v7, v89 offset:65412
    s_mov_b64 exec, s[50:51]
    s_branch L2_d104
L2_c105:
    s_lshl_b64 s[52:53], s[82:83], 1
    s_andn2_b64 s[52:53], s[52:53], s[80:81]
    s_andn2_b64 s[52:53], s[52:53], s[54:55]
    s_or_b64 s[80:81], s[80:81], s[52:53]
    s_not_b64 vcc, s[52:53]
    s_mov_b64 exec, -1
    v_cndmask_b32_dpp v84, v84, v84, vcc wave_shr:1 row_mask:0xf bank_mask:0xf
    v_cndmask_b32_dpp v85, v85, v85, vcc wave_shr:1 row_mask:0xf bank_mask:0xf
    s_lshr_b64 s[52:53], s[52:53], 1
    v_cndmask_b32_dpp v86, v86, v86, vcc wave_shr:1 row_mask:0xf bank_mask:0xf
    v_cndmask_b32_dpp v87, v87, v87, vcc wave_shr:1 row_mask:0xf bank_mask:0xf
    s_andn2_b64 s[82:83], s[82:83], s[52:53]
    v_cndmask_b32_dpp v7, v7, v7, vcc wave_shr:1 row_mask:0xf bank_mask:0xf
    s_mov_b64 exec, s[54:55]
    s_cbranch_scc0 L2_d105
    s_mov_b64 exec, s[82:83]
    s_nop 1
    v_mfma_f32_4x4x4_16b_bf16 v[88:91], v[12:13], v[84:85], 0
    s_nop 1
    v_mfma_f32_4x4x4_16b_bf16 v[88:91], v[10:11], v[86:87], v[88:91]
    s_nop 4
    v_cvt_pk_bf16_f32 v88, v88, v89
    v_cvt_pk_bf16_f32 v89, v90, v91
    ds_pk_add_bf16 v7, v88 offset:65408
    ds_pk_add_bf16 v7, v89 offset:65412
    s_mov_b64 exec, s[54:55]
    s_branch L2_d105
L2_c106:
    s_lshl_b64 s[52:53], s[82:83], 1
    s_andn2_b64 s[52:53], s[52:53], s[80:81]
    s_andn2_b64 s[52:53], s[52:53], s[50:51]
    s_or_b64 s[80:81], s[80:81], s[52:53]
    s_not_b64 vcc, s[52:53]
    s_mov_b64 exec, -1
    v_cndmask_b32_dpp v84, v84, v84, vcc wave_shr:1 row_mask:0xf bank_mask:0xf
    v_cndmask_b32_dpp v85, v85, v85, vcc wave_shr:1 row_mask:0xf bank_mask:0xf
    s_lshr_b64 s[52:53], s[52:53], 1
    v_cndmask_b32_dpp v86, v86, v86, vcc wave_shr:1 row_mask:0xf bank_mask:0xf
    v_cndmask_b32_dpp v87, v87, v87, vcc wave_shr:1 row_mask:0xf bank_mask:0xf
    s_andn2_b64 s[82:83], s[82:83], s[52:53]
    v_cndmask_b32_dpp v7, v7, v7, vcc wave_shr:1 row_mask:0xf bank_mask:0xf
    s_mov_b64 exec, s[50:51]
    s_cbranch_scc0 L2_d106
    s_mov_b64 exec, s[82:83]
    s_nop 1
    v_mfma_f32_4x4x4_16b_bf16 v[88:91], v[12:13], v[84:85], 0
    s_nop 1
    v_mfma_f32_4x4x4_16b_bf16 v[88:91], v[10:11], v[86:87], v[88:91]
    s_nop 4
    v_cvt_pk_bf16_f32 v88, v88, v89
    v_cvt_pk_bf16_f32 v89, v90, v91
    ds_pk_add_bf16 v7, v88 offset:65408
    ds_pk_add_bf16 v7, v89 offset:65412
    s_mov_b64 exec, s[50:51]
    s_branch L2_d106
L2_oa107:
    s_waitcnt vmcnt(3)
    s_mov_b64 exec, s[6:7]
    v_lshrrev_b32 v114, 16, v114
    s_mov_b64 exec, -1
    v_and_b32 v46, 0x10000000, v33
    v_cmpx_eq_u32 vcc, 0, v46
    v_lshrrev_b32 v47, 14, v112
    v_and_b32 v47, v5, v47
    ds_read_b64 v[96:97], v47
    v_perm_b32 v98, v112, v114, s44
    v_bitop3_b32 v99, v112, 0.5, -0.5 bitop3:0xa8
    v_bitop3_b32 v98, v6, v98, v99 bitop3:0xca
    v_and_b32 v47, v5, v112
    s_waitcnt lgkmcnt(0)
    v_mfma_f32_4x4x4_16b_bf16 v[88:91], v[8:9], v[96:97], 0
    s_nop 4
    v_mul_f32 v88, v98, v88
    v_mul_f32 v89, v98, v89
    v_mul_f32 v90, v98, v90
    v_mul_f32 v91, v98, v91
    v_cvt_pk_bf16_f32 v88, v88, v89
    v_cvt_pk_bf16_f32 v89, v90, v91
    ds_pk_add_bf16 v47, v88 offset:65408
    ds_pk_add_bf16 v47, v89 offset:65412
    s_mov_b64 exec, -1
    v_and_b32 v46, 0x20000000, v33
    v_cmpx_eq_u32 vcc, 0, v46
    v_lshrrev_b32 v47, 14, v113
    v_and_b32 v47, v5, v47
    ds_read_b64 v[96:97], v47
    v_perm_b32 v98, v113, v114, s45
    v_bitop3_b32 v99, v113, 0.5, -0.5 bitop3:0xa8
    v_bitop3_b32 v98, v6, v98, v99 bitop3:0xca
    v_and_b32 v47, v5, v113
    s_waitcnt lgkmcnt(0)
    v_mfma_f32_4x4x4_16b_bf16 v[88:91], v[8:9], v[96:97], 0
    s_nop 4
    v_mul_f32 v88, v98, v88
    v_mul_f32 v89, v98, v89
    v_mul_f32 v90, v98, v90
    v_mul_f32 v91, v98, v91
    v_cvt_pk_bf16_f32 v88, v88, v89
    v_cvt_pk_bf16_f32 v89, v90, v91
    ds_pk_add_bf16 v47, v88 offset:65408
    ds_pk_add_bf16 v47, v89 offset:65412
    s_mov_b64 exec, -1
    s_branch L2_ob107
L2_xo108:
    v_cmp_lt_u32 vcc, 20, v99
    s_mov_b32 s101, 1
    s_cbranch_vccz L2_xp108
    v_cmp_lt_u32 vcc, 32, v99
    v_cmp_lt_u32 s[58:59], 31, v88
    s_mov_b32 s101, 2
    s_or_b64 vcc, vcc, s[58:59]
    s_cbranch_scc0 L2_xp108
    s_mov_b32 s37, 0x10000
    s_branch L2_xp108
L2_c109:
    s_lshl_b64 s[52:53], s[82:83], 1
    s_andn2_b64 s[52:53], s[52:53], s[80:81]
    s_andn2_b64 s[52:53], s[52:53], s[54:55]
    s_or_b64 s[80:81], s[80:81], s[52:53]
    s_not_b64 vcc, s[52:53]
    s_mov_b64 exec, -1
    v_cndmask_b32_dpp v84, v84, v84, vcc wave_shr:1 row_mask:0xf bank_mask:0xf
    v_cndmask_b32_dpp v85, v85, v85, vcc wave_shr:1 row_mask:0xf bank_mask:0xf
    s_lshr_b64 s[52:53], s[52:53], 1
    v_cndmask_b32_dpp v86, v86, v86, vcc wave_shr:1 row_mask:0xf bank_mask:0xf
    v_cndmask_b32_dpp v87, v87, v87, vcc wave_shr:1 row_mask:0xf bank_mask:0xf
    s_andn2_b64 s[82:83], s[82:83], s[52:53]
    v_cndmask_b32_dpp v7, v7, v7, vcc wave_shr:1 row_mask:0xf bank_mask:0xf
    s_mov_b64 exec, s[54:55]
    s_cbranch_scc0 L2_d109
    s_mov_b64 exec, s[82:83]
    s_nop 1
    v_mfma_f32_4x4x4_16b_bf16 v[88:91], v[12:13], v[84:85], 0
    s_nop 1
    v_mfma_f32_4x4x4_16b_bf16 v[88:91], v[10:11], v[86:87], v[88:91]
    s_nop 4
    v_cvt_pk_bf16_f32 v88, v88, v89
    v_cvt_pk_bf16_f32 v89, v90, v91
    ds_pk_add_bf16 v7, v88 offset:65408
    ds_pk_add_bf16 v7, v89 offset:65412
    s_mov_b64 exec, s[54:55]
    s_branch L2_d109
L2_c110:
    s_lshl_b64 s[52:53], s[82:83], 1
    s_andn2_b64 s[52:53], s[52:53], s[80:81]
    s_andn2_b64 s[52:53], s[52:53], s[50:51]
    s_or_b64 s[80:81], s[80:81], s[52:53]
    s_not_b64 vcc, s[52:53]
    s_mov_b64 exec, -1
    v_cndmask_b32_dpp v84, v84, v84, vcc wave_shr:1 row_mask:0xf bank_mask:0xf
    v_cndmask_b32_dpp v85, v85, v85, vcc wave_shr:1 row_mask:0xf bank_mask:0xf
    s_lshr_b64 s[52:53], s[52:53], 1
    v_cndmask_b32_dpp v86, v86, v86, vcc wave_shr:1 row_mask:0xf bank_mask:0xf
    v_cndmask_b32_dpp v87, v87, v87, vcc wave_shr:1 row_mask:0xf bank_mask:0xf
    s_andn2_b64 s[82:83], s[82:83], s[52:53]
    v_cndmask_b32_dpp v7, v7, v7, vcc wave_shr:1 row_mask:0xf bank_mask:0xf
    s_mov_b64 exec, s[50:51]
    s_cbranch_scc0 L2_d110
    s_mov_b64 exec, s[82:83]
    s_nop 1
    v_mfma_f32_4x4x4_16b_bf16 v[88:91], v[12:13], v[84:85], 0
    s_nop 1
    v_mfma_f32_4x4x4_16b_bf16 v[88:91], v[10:11], v[86:87], v[88:91]
    s_nop 4
    v_cvt_pk_bf16_f32 v88, v88, v89
    v_cvt_pk_bf16_f32 v89, v90, v91
    ds_pk_add_bf16 v7, v88 offset:65408
    ds_pk_add_bf16 v7, v89 offset:65412
    s_mov_b64 exec, s[50:51]
    s_branch L2_d110
L2_c111:
    s_lshl_b64 s[52:53], s[82:83], 1
    s_andn2_b64 s[52:53], s[52:53], s[80:81]
    s_andn2_b64 s[52:53], s[52:53], s[54:55]
    s_or_b64 s[80:81], s[80:81], s[52:53]
    s_not_b64 vcc, s[52:53]
    s_mov_b64 exec, -1
    v_cndmask_b32_dpp v84, v84, v84, vcc wave_shr:1 row_mask:0xf bank_mask:0xf
    v_cndmask_b32_dpp v85, v85, v85, vcc wave_shr:1 row_mask:0xf bank_mask:0xf
    s_lshr_b64 s[52:53], s[52:53], 1
    v_cndmask_b32_dpp v86, v86, v86, vcc wave_shr:1 row_mask:0xf bank_mask:0xf
    v_cndmask_b32_dpp v87, v87, v87, vcc wave_shr:1 row_mask:0xf bank_mask:0xf
    s_andn2_b64 s[82:83], s[82:83], s[52:53]
    v_cndmask_b32_dpp v7, v7, v7, vcc wave_shr:1 row_mask:0xf bank_mask:0xf
    s_mov_b64 exec, s[54:55]
    s_cbranch_scc0 L2_d111
    s_mov_b64 exec, s[82:83]
    s_nop 1
    v_mfma_f32_4x4x4_16b_bf16 v[88:91], v[12:13], v[84:85], 0
    s_nop 1
    v_mfma_f32_4x4x4_16b_bf16 v[88:91], v[10:11], v[86:87], v[88:91]
    s_nop 4
    v_cvt_pk_bf16_f32 v88, v88, v89
    v_cvt_pk_bf16_f32 v89, v90, v91
    ds_pk_add_bf16 v7, v88 offset:65408
    ds_pk_add_bf16 v7, v89 offset:65412
    s_mov_b64 exec, s[54:55]
    s_branch L2_d111
L2_c112:
    s_lshl_b64 s[52:53], s[82:83], 1
    s_andn2_b64 s[52:53], s[52:53], s[80:81]
    s_andn2_b64 s[52:53], s[52:53], s[50:51]
    s_or_b64 s[80:81], s[80:81], s[52:53]
    s_not_b64 vcc, s[52:53]
    s_mov_b64 exec, -1
    v_cndmask_b32_dpp v84, v84, v84, vcc wave_shr:1 row_mask:0xf bank_mask:0xf
    v_cndmask_b32_dpp v85, v85, v85, vcc wave_shr:1 row_mask:0xf bank_mask:0xf
    s_lshr_b64 s[52:53], s[52:53], 1
    v_cndmask_b32_dpp v86, v86, v86, vcc wave_shr:1 row_mask:0xf bank_mask:0xf
    v_cndmask_b32_dpp v87, v87, v87, vcc wave_shr:1 row_mask:0xf bank_mask:0xf
    s_andn2_b64 s[82:83], s[82:83], s[52:53]
    v_cndmask_b32_dpp v7, v7, v7, vcc wave_shr:1 row_mask:0xf bank_mask:0xf
    s_mov_b64 exec, s[50:51]
    s_cbranch_scc0 L2_d112
    s_mov_b64 exec, s[82:83]
    s_nop 1
    v_mfma_f32_4x4x4_16b_bf16 v[88:91], v[12:13], v[84:85], 0
    s_nop 1
    v_mfma_f32_4x4x4_16b_bf16 v[88:91], v[10:11], v[86:87], v[88:91]
    s_nop 4
    v_cvt_pk_bf16_f32 v88, v88, v89
    v_cvt_pk_bf16_f32 v89, v90, v91
    ds_pk_add_bf16 v7, v88 offset:65408
    ds_pk_add_bf16 v7, v89 offset:65412
    s_mov_b64 exec, s[50:51]
    s_branch L2_d112
L2_c113:
    s_lshl_b64 s[52:53], s[82:83], 1
    s_andn2_b64 s[52:53], s[52:53], s[80:81]
    s_andn2_b64 s[52:53], s[52:53], s[54:55]
    s_or_b64 s[80:81], s[80:81], s[52:53]
    s_not_b64 vcc, s[52:53]
    s_mov_b64 exec, -1
    v_cndmask_b32_dpp v84, v84, v84, vcc wave_shr:1 row_mask:0xf bank_mask:0xf
    v_cndmask_b32_dpp v85, v85, v85, vcc wave_shr:1 row_mask:0xf bank_mask:0xf
    s_lshr_b64 s[52:53], s[52:53], 1
    v_cndmask_b32_dpp v86, v86, v86, vcc wave_shr:1 row_mask:0xf bank_mask:0xf
    v_cndmask_b32_dpp v87, v87, v87, vcc wave_shr:1 row_mask:0xf bank_mask:0xf
    s_andn2_b64 s[82:83], s[82:83], s[52:53]
    v_cndmask_b32_dpp v7, v7, v7, vcc wave_shr:1 row_mask:0xf bank_mask:0xf
    s_mov_b64 exec, s[54:55]
    s_cbranch_scc0 L2_d113
    s_mov_b64 exec, s[82:83]
    s_nop 1
    v_mfma_f32_4x4x4_16b_bf16 v[88:91], v[12:13], v[84:85], 0
    s_nop 1
    v_mfma_f32_4x4x4_16b_bf16 v[88:91], v[10:11], v[86:87], v[88:91]
    s_nop 4
    v_cvt_pk_bf16_f32 v88, v88, v89
    v_cvt_pk_bf16_f32 v89, v90, v91
    ds_pk_add_bf16 v7, v88 offset:65408
    ds_pk_add_bf16 v7, v89 offset:65412
    s_mov_b64 exec, s[54:55]
    s_branch L2_d113
L2_c114:
    s_lshl_b64 s[52:53], s[82:83], 1
    s_andn2_b64 s[52:53], s[52:53], s[80:81]
    s_andn2_b64 s[52:53], s[52:53], s[50:51]
    s_or_b64 s[80:81], s[80:81], s[52:53]
    s_not_b64 vcc, s[52:53]
    s_mov_b64 exec, -1
    v_cndmask_b32_dpp v84, v84, v84, vcc wave_shr:1 row_mask:0xf bank_mask:0xf
    v_cndmask_b32_dpp v85, v85, v85, vcc wave_shr:1 row_mask:0xf bank_mask:0xf
    s_lshr_b64 s[52:53], s[52:53], 1
    v_cndmask_b32_dpp v86, v86, v86, vcc wave_shr:1 row_mask:0xf bank_mask:0xf
    v_cndmask_b32_dpp v87, v87, v87, vcc wave_shr:1 row_mask:0xf bank_mask:0xf
    s_andn2_b64 s[82:83], s[82:83], s[52:53]
    v_cndmask_b32_dpp v7, v7, v7, vcc wave_shr:1 row_mask:0xf bank_mask:0xf
    s_mov_b64 exec, s[50:51]
    s_cbranch_scc0 L2_d114
    s_mov_b64 exec, s[82:83]
    s_nop 1
    v_mfma_f32_4x4x4_16b_bf16 v[88:91], v[12:13], v[84:85], 0
    s_nop 1
    v_mfma_f32_4x4x4_16b_bf16 v[88:91], v[10:11], v[86:87], v[88:91]
    s_nop 4
    v_cvt_pk_bf16_f32 v88, v88, v89
    v_cvt_pk_bf16_f32 v89, v90, v91
    ds_pk_add_bf16 v7, v88 offset:65408
    ds_pk_add_bf16 v7, v89 offset:65412
    s_mov_b64 exec, s[50:51]
    s_branch L2_d114
L2_xa115:
    s_cmp_eq_u32 s101, 1
    s_cbranch_scc1 L2_xc115
    v_lshlrev_b32 v89, 0, v96
    v_add_u32 v90, 140, v97
    v_bitop3_b32 v90, v89, v45, v90 bitop3:0x6a
    ds_write_b32 v98, v90 offset:28
    v_lshlrev_b32 v89, 4, v96
    v_add_u32 v90, 120, v97
    v_bitop3_b32 v90, v89, v45, v90 bitop3:0x6a
    ds_write_b32 v98, v90 offset:24
    v_lshlrev_b32 v89, 8, v96
    v_add_u32 v90, 100, v97
    v_bitop3_b32 v90, v89, v45, v90 bitop3:0x6a
    ds_write_b32 v98, v90 offset:20
L2_xc115:
    v_lshlrev_b32 v89, 12, v96
    v_add_u32 v90, 80, v97
    v_bitop3_b32 v90, v89, v45, v90 bitop3:0x6a
    ds_write_b32 v98, v90 offset:16
    s_branch L2_xb115
L2_xe115:
    v_cmp_lt_u32 vcc, 32, v99
    v_cmp_lt_u32 s[58:59], 31, v88
    v_lshrrev_b32 v89, 16, v96
    v_add_u32 v97, 80, v97
    s_or_b64 vcc, vcc, s[58:59]
    s_cbranch_scc1 L2_xs115
    v_lshlrev_b32 v89, v1, v89
    v_and_b32 v89, v45, v89
    v_cmp_ne_u32 vcc, 0, v89
    v_xor_b32 v90, v97, v89
    s_add_u32 s3, s37, s38
    v_mbcnt_lo_u32_b32 v98, vcc_lo, 0
    v_mbcnt_hi_u32_b32 v98, vcc_hi, v98
    s_bcnt1_i32_b64 s41, vcc
    v_lshl_add_u32 v98, v98, 2, s3
    s_lshl2_add_u32 s37, s41, s37
    s_mov_b64 exec, vcc
    ds_write_b32 v98, v90
    s_mov_b64 exec, -1
    s_branch L2_xr115
L2_xf115:
    s_waitcnt lgkmcnt(0)
    s_cmp_gt_u32 s37, 1024
    s_cbranch_scc1 L2_xs115
    s_cmp_lt_u32 s37, 768
    s_cbranch_scc1 L2_xl115
    ds_read_b32 v33, v98 offset:896
    s_add_u32 s3, s42, 2
    s_bitset1_b32 s43, s3
    s_branch L2_xg115
L2_xl115:
    v_mov_b32 v42, -1
    s_cmp_ge_u32 s37, 512
    s_cbranch_scc1 L2_xg115
    v_mov_b32 v43, -1
    s_cmp_ge_u32 s37, 256
    s_cbranch_scc1 L2_xg115
    v_mov_b32 v41, -1
    s_branch L2_xg115
L2_xs115:
    s_waitcnt lgkmcnt(0)
    v_mov_b32 v40, -1
    v_mov_b32 v41, -1
    v_mov_b32 v43, -1
    v_mov_b32 v42, -1
    s_add_u32 s3, s42, 2
    s_bitset1_b32 s36, s3
    s_branch L2_xg115
L2_c116:
    s_lshl_b64 s[52:53], s[82:83], 1
    s_andn2_b64 s[52:53], s[52:53], s[80:81]
    s_andn2_b64 s[52:53], s[52:53], s[54:55]
    s_or_b64 s[80:81], s[80:81], s[52:53]
    s_not_b64 vcc, s[52:53]
    s_mov_b64 exec, -1
    v_cndmask_b32_dpp v84, v84, v84, vcc wave_shr:1 row_mask:0xf bank_mask:0xf
    v_cndmask_b32_dpp v85, v85, v85, vcc wave_shr:1 row_mask:0xf bank_mask:0xf
    s_lshr_b64 s[52:53], s[52:53], 1
    v_cndmask_b32_dpp v86, v86, v86, vcc wave_shr:1 row_mask:0xf bank_mask:0xf
    v_cndmask_b32_dpp v87, v87, v87, vcc wave_shr:1 row_mask:0xf bank_mask:0xf
    s_andn2_b64 s[82:83], s[82:83], s[52:53]
    v_cndmask_b32_dpp v7, v7, v7, vcc wave_shr:1 row_mask:0xf bank_mask:0xf
    s_mov_b64 exec, s[54:55]
    s_cbranch_scc0 L2_d116
    s_mov_b64 exec, s[82:83]
    s_nop 1
    v_mfma_f32_4x4x4_16b_bf16 v[88:91], v[12:13], v[84:85], 0
    s_nop 1
    v_mfma_f32_4x4x4_16b_bf16 v[88:91], v[10:11], v[86:87], v[88:91]
    s_nop 4
    v_cvt_pk_bf16_f32 v88, v88, v89
    v_cvt_pk_bf16_f32 v89, v90, v91
    ds_pk_add_bf16 v7, v88 offset:65408
    ds_pk_add_bf16 v7, v89 offset:65412
    s_mov_b64 exec, s[54:55]
    s_branch L2_d116
L2_c117:
    s_lshl_b64 s[52:53], s[82:83], 1
    s_andn2_b64 s[52:53], s[52:53], s[80:81]
    s_andn2_b64 s[52:53], s[52:53], s[50:51]
    s_or_b64 s[80:81], s[80:81], s[52:53]
    s_not_b64 vcc, s[52:53]
    s_mov_b64 exec, -1
    v_cndmask_b32_dpp v84, v84, v84, vcc wave_shr:1 row_mask:0xf bank_mask:0xf
    v_cndmask_b32_dpp v85, v85, v85, vcc wave_shr:1 row_mask:0xf bank_mask:0xf
    s_lshr_b64 s[52:53], s[52:53], 1
    v_cndmask_b32_dpp v86, v86, v86, vcc wave_shr:1 row_mask:0xf bank_mask:0xf
    v_cndmask_b32_dpp v87, v87, v87, vcc wave_shr:1 row_mask:0xf bank_mask:0xf
    s_andn2_b64 s[82:83], s[82:83], s[52:53]
    v_cndmask_b32_dpp v7, v7, v7, vcc wave_shr:1 row_mask:0xf bank_mask:0xf
    s_mov_b64 exec, s[50:51]
    s_cbranch_scc0 L2_d117
    s_mov_b64 exec, s[82:83]
    s_nop 1
    v_mfma_f32_4x4x4_16b_bf16 v[88:91], v[12:13], v[84:85], 0
    s_nop 1
    v_mfma_f32_4x4x4_16b_bf16 v[88:91], v[10:11], v[86:87], v[88:91]
    s_nop 4
    v_cvt_pk_bf16_f32 v88, v88, v89
    v_cvt_pk_bf16_f32 v89, v90, v91
    ds_pk_add_bf16 v7, v88 offset:65408
    ds_pk_add_bf16 v7, v89 offset:65412
    s_mov_b64 exec, s[50:51]
    s_branch L2_d117
L2_oa118:
    v_and_b32 v47, 0x0fffffff, v32
    buffer_load_dword v114, v47, s[8:11], 0 offen offset:16
    s_mov_b64 exec, s[6:7]
    v_add_u32 v47, 8, v47
    v_lshrrev_b32 v32, 2, v32
    s_mov_b64 exec, -1
    buffer_load_dwordx2 v[112:113], v47, s[8:11], 0 offen
    s_branch L2_ob118
L2_c119:
    s_lshl_b64 s[52:53], s[82:83], 1
    s_andn2_b64 s[52:53], s[52:53], s[80:81]
    s_andn2_b64 s[52:53], s[52:53], s[54:55]
    s_or_b64 s[80:81], s[80:81], s[52:53]
    s_not_b64 vcc, s[52:53]
    s_mov_b64 exec, -1
    v_cndmask_b32_dpp v84, v84, v84, vcc wave_shr:1 row_mask:0xf bank_mask:0xf
    v_cndmask_b32_dpp v85, v85, v85, vcc wave_shr:1 row_mask:0xf bank_mask:0xf
    s_lshr_b64 s[52:53], s[52:53], 1
    v_cndmask_b32_dpp v86, v86, v86, vcc wave_shr:1 row_mask:0xf bank_mask:0xf
    v_cndmask_b32_dpp v87, v87, v87, vcc wave_shr:1 row_mask:0xf bank_mask:0xf
    s_andn2_b64 s[82:83], s[82:83], s[52:53]
    v_cndmask_b32_dpp v7, v7, v7, vcc wave_shr:1 row_mask:0xf bank_mask:0xf
    s_mov_b64 exec, s[54:55]
    s_cbranch_scc0 L2_d119
    s_mov_b64 exec, s[82:83]
    s_nop 1
    v_mfma_f32_4x4x4_16b_bf16 v[88:91], v[12:13], v[84:85], 0
    s_nop 1
    v_mfma_f32_4x4x4_16b_bf16 v[88:91], v[10:11], v[86:87], v[88:91]
    s_nop 4
    v_cvt_pk_bf16_f32 v88, v88, v89
    v_cvt_pk_bf16_f32 v89, v90, v91
    ds_pk_add_bf16 v7, v88 offset:65408
    ds_pk_add_bf16 v7, v89 offset:65412
    s_mov_b64 exec, s[54:55]
    s_branch L2_d119
L2_c120:
    s_lshl_b64 s[52:53], s[82:83], 1
    s_andn2_b64 s[52:53], s[52:53], s[80:81]
    s_andn2_b64 s[52:53], s[52:53], s[50:51]
    s_or_b64 s[80:81], s[80:81], s[52:53]
    s_not_b64 vcc, s[52:53]
    s_mov_b64 exec, -1
    v_cndmask_b32_dpp v84, v84, v84, vcc wave_shr:1 row_mask:0xf bank_mask:0xf
    v_cndmask_b32_dpp v85, v85, v85, vcc wave_shr:1 row_mask:0xf bank_mask:0xf
    s_lshr_b64 s[52:53], s[52:53], 1
    v_cndmask_b32_dpp v86, v86, v86, vcc wave_shr:1 row_mask:0xf bank_mask:0xf
    v_cndmask_b32_dpp v87, v87, v87, vcc wave_shr:1 row_mask:0xf bank_mask:0xf
    s_andn2_b64 s[82:83], s[82:83], s[52:53]
    v_cndmask_b32_dpp v7, v7, v7, vcc wave_shr:1 row_mask:0xf bank_mask:0xf
    s_mov_b64 exec, s[50:51]
    s_cbranch_scc0 L2_d120
    s_mov_b64 exec, s[82:83]
    s_nop 1
    v_mfma_f32_4x4x4_16b_bf16 v[88:91], v[12:13], v[84:85], 0
    s_nop 1
    v_mfma_f32_4x4x4_16b_bf16 v[88:91], v[10:11], v[86:87], v[88:91]
    s_nop 4
    v_cvt_pk_bf16_f32 v88, v88, v89
    v_cvt_pk_bf16_f32 v89, v90, v91
    ds_pk_add_bf16 v7, v88 offset:65408
    ds_pk_add_bf16 v7, v89 offset:65412
    s_mov_b64 exec, s[50:51]
    s_branch L2_d120
L2_c121:
    s_lshl_b64 s[52:53], s[82:83], 1
    s_andn2_b64 s[52:53], s[52:53], s[80:81]
    s_andn2_b64 s[52:53], s[52:53], s[54:55]
    s_or_b64 s[80:81], s[80:81], s[52:53]
    s_not_b64 vcc, s[52:53]
    s_mov_b64 exec, -1
    v_cndmask_b32_dpp v84, v84, v84, vcc wave_shr:1 row_mask:0xf bank_mask:0xf
    v_cndmask_b32_dpp v85, v85, v85, vcc wave_shr:1 row_mask:0xf bank_mask:0xf
    s_lshr_b64 s[52:53], s[52:53], 1
    v_cndmask_b32_dpp v86, v86, v86, vcc wave_shr:1 row_mask:0xf bank_mask:0xf
    v_cndmask_b32_dpp v87, v87, v87, vcc wave_shr:1 row_mask:0xf bank_mask:0xf
    s_andn2_b64 s[82:83], s[82:83], s[52:53]
    v_cndmask_b32_dpp v7, v7, v7, vcc wave_shr:1 row_mask:0xf bank_mask:0xf
    s_mov_b64 exec, s[54:55]
    s_cbranch_scc0 L2_d121
    s_mov_b64 exec, s[82:83]
    s_nop 1
    v_mfma_f32_4x4x4_16b_bf16 v[88:91], v[12:13], v[84:85], 0
    s_nop 1
    v_mfma_f32_4x4x4_16b_bf16 v[88:91], v[10:11], v[86:87], v[88:91]
    s_nop 4
    v_cvt_pk_bf16_f32 v88, v88, v89
    v_cvt_pk_bf16_f32 v89, v90, v91
    ds_pk_add_bf16 v7, v88 offset:65408
    ds_pk_add_bf16 v7, v89 offset:65412
    s_mov_b64 exec, s[54:55]
    s_branch L2_d121
L2_c122:
    s_lshl_b64 s[52:53], s[82:83], 1
    s_andn2_b64 s[52:53], s[52:53], s[80:81]
    s_andn2_b64 s[52:53], s[52:53], s[50:51]
    s_or_b64 s[80:81], s[80:81], s[52:53]
    s_not_b64 vcc, s[52:53]
    s_mov_b64 exec, -1
    v_cndmask_b32_dpp v84, v84, v84, vcc wave_shr:1 row_mask:0xf bank_mask:0xf
    v_cndmask_b32_dpp v85, v85, v85, vcc wave_shr:1 row_mask:0xf bank_mask:0xf
    s_lshr_b64 s[52:53], s[52:53], 1
    v_cndmask_b32_dpp v86, v86, v86, vcc wave_shr:1 row_mask:0xf bank_mask:0xf
    v_cndmask_b32_dpp v87, v87, v87, vcc wave_shr:1 row_mask:0xf bank_mask:0xf
    s_andn2_b64 s[82:83], s[82:83], s[52:53]
    v_cndmask_b32_dpp v7, v7, v7, vcc wave_shr:1 row_mask:0xf bank_mask:0xf
    s_mov_b64 exec, s[50:51]
    s_cbranch_scc0 L2_d122
    s_mov_b64 exec, s[82:83]
    s_nop 1
    v_mfma_f32_4x4x4_16b_bf16 v[88:91], v[12:13], v[84:85], 0
    s_nop 1
    v_mfma_f32_4x4x4_16b_bf16 v[88:91], v[10:11], v[86:87], v[88:91]
    s_nop 4
    v_cvt_pk_bf16_f32 v88, v88, v89
    v_cvt_pk_bf16_f32 v89, v90, v91
    ds_pk_add_bf16 v7, v88 offset:65408
    ds_pk_add_bf16 v7, v89 offset:65412
    s_mov_b64 exec, s[50:51]
    s_branch L2_d122
L2_c123:
    s_lshl_b64 s[52:53], s[82:83], 1
    s_andn2_b64 s[52:53], s[52:53], s[80:81]
    s_andn2_b64 s[52:53], s[52:53], s[54:55]
    s_or_b64 s[80:81], s[80:81], s[52:53]
    s_not_b64 vcc, s[52:53]
    s_mov_b64 exec, -1
    v_cndmask_b32_dpp v84, v84, v84, vcc wave_shr:1 row_mask:0xf bank_mask:0xf
    v_cndmask_b32_dpp v85, v85, v85, vcc wave_shr:1 row_mask:0xf bank_mask:0xf
    s_lshr_b64 s[52:53], s[52:53], 1
    v_cndmask_b32_dpp v86, v86, v86, vcc wave_shr:1 row_mask:0xf bank_mask:0xf
    v_cndmask_b32_dpp v87, v87, v87, vcc wave_shr:1 row_mask:0xf bank_mask:0xf
    s_andn2_b64 s[82:83], s[82:83], s[52:53]
    v_cndmask_b32_dpp v7, v7, v7, vcc wave_shr:1 row_mask:0xf bank_mask:0xf
    s_mov_b64 exec, s[54:55]
    s_cbranch_scc0 L2_d123
    s_mov_b64 exec, s[82:83]
    s_nop 1
    v_mfma_f32_4x4x4_16b_bf16 v[88:91], v[12:13], v[84:85], 0
    s_nop 1
    v_mfma_f32_4x4x4_16b_bf16 v[88:91], v[10:11], v[86:87], v[88:91]
    s_nop 4
    v_cvt_pk_bf16_f32 v88, v88, v89
    v_cvt_pk_bf16_f32 v89, v90, v91
    ds_pk_add_bf16 v7, v88 offset:65408
    ds_pk_add_bf16 v7, v89 offset:65412
    s_mov_b64 exec, s[54:55]
    s_branch L2_d123
L2_c124:
    s_lshl_b64 s[52:53], s[82:83], 1
    s_andn2_b64 s[52:53], s[52:53], s[80:81]
    s_andn2_b64 s[52:53], s[52:53], s[50:51]
    s_or_b64 s[80:81], s[80:81], s[52:53]
    s_not_b64 vcc, s[52:53]
    s_mov_b64 exec, -1
    v_cndmask_b32_dpp v84, v84, v84, vcc wave_shr:1 row_mask:0xf bank_mask:0xf
    v_cndmask_b32_dpp v85, v85, v85, vcc wave_shr:1 row_mask:0xf bank_mask:0xf
    s_lshr_b64 s[52:53], s[52:53], 1
    v_cndmask_b32_dpp v86, v86, v86, vcc wave_shr:1 row_mask:0xf bank_mask:0xf
    v_cndmask_b32_dpp v87, v87, v87, vcc wave_shr:1 row_mask:0xf bank_mask:0xf
    s_andn2_b64 s[82:83], s[82:83], s[52:53]
    v_cndmask_b32_dpp v7, v7, v7, vcc wave_shr:1 row_mask:0xf bank_mask:0xf
    s_mov_b64 exec, s[50:51]
    s_cbranch_scc0 L2_d124
    s_mov_b64 exec, s[82:83]
    s_nop 1
    v_mfma_f32_4x4x4_16b_bf16 v[88:91], v[12:13], v[84:85], 0
    s_nop 1
    v_mfma_f32_4x4x4_16b_bf16 v[88:91], v[10:11], v[86:87], v[88:91]
    s_nop 4
    v_cvt_pk_bf16_f32 v88, v88, v89
    v_cvt_pk_bf16_f32 v89, v90, v91
    ds_pk_add_bf16 v7, v88 offset:65408
    ds_pk_add_bf16 v7, v89 offset:65412
    s_mov_b64 exec, s[50:51]
    s_branch L2_d124
L2_oa125:
    s_waitcnt vmcnt(3)
    s_mov_b64 exec, s[6:7]
    v_lshrrev_b32 v114, 16, v114
    s_mov_b64 exec, -1
    v_and_b32 v46, 0x10000000, v32
    v_cmpx_eq_u32 vcc, 0, v46
    v_lshrrev_b32 v47, 14, v112
    v_and_b32 v47, v5, v47
    ds_read_b64 v[96:97], v47
    v_perm_b32 v98, v112, v114, s44
    v_bitop3_b32 v99, v112, 0.5, -0.5 bitop3:0xa8
    v_bitop3_b32 v98, v6, v98, v99 bitop3:0xca
    v_and_b32 v47, v5, v112
    s_waitcnt lgkmcnt(0)
    v_mfma_f32_4x4x4_16b_bf16 v[88:91], v[8:9], v[96:97], 0
    s_nop 4
    v_mul_f32 v88, v98, v88
    v_mul_f32 v89, v98, v89
    v_mul_f32 v90, v98, v90
    v_mul_f32 v91, v98, v91
    v_cvt_pk_bf16_f32 v88, v88, v89
    v_cvt_pk_bf16_f32 v89, v90, v91
    ds_pk_add_bf16 v47, v88 offset:65408
    ds_pk_add_bf16 v47, v89 offset:65412
    s_mov_b64 exec, -1
    v_and_b32 v46, 0x20000000, v32
    v_cmpx_eq_u32 vcc, 0, v46
    v_lshrrev_b32 v47, 14, v113
    v_and_b32 v47, v5, v47
    ds_read_b64 v[96:97], v47
    v_perm_b32 v98, v113, v114, s45
    v_bitop3_b32 v99, v113, 0.5, -0.5 bitop3:0xa8
    v_bitop3_b32 v98, v6, v98, v99 bitop3:0xca
    v_and_b32 v47, v5, v113
    s_waitcnt lgkmcnt(0)
    v_mfma_f32_4x4x4_16b_bf16 v[88:91], v[8:9], v[96:97], 0
    s_nop 4
    v_mul_f32 v88, v98, v88
    v_mul_f32 v89, v98, v89
    v_mul_f32 v90, v98, v90
    v_mul_f32 v91, v98, v91
    v_cvt_pk_bf16_f32 v88, v88, v89
    v_cvt_pk_bf16_f32 v89, v90, v91
    ds_pk_add_bf16 v47, v88 offset:65408
    ds_pk_add_bf16 v47, v89 offset:65412
    s_mov_b64 exec, -1
    s_branch L2_ob125
L2_c126:
    s_lshl_b64 s[52:53], s[82:83], 1
    s_andn2_b64 s[52:53], s[52:53], s[80:81]
    s_andn2_b64 s[52:53], s[52:53], s[54:55]
    s_or_b64 s[80:81], s[80:81], s[52:53]
    s_not_b64 vcc, s[52:53]
    s_mov_b64 exec, -1
    v_cndmask_b32_dpp v84, v84, v84, vcc wave_shr:1 row_mask:0xf bank_mask:0xf
    v_cndmask_b32_dpp v85, v85, v85, vcc wave_shr:1 row_mask:0xf bank_mask:0xf
    s_lshr_b64 s[52:53], s[52:53], 1
    v_cndmask_b32_dpp v86, v86, v86, vcc wave_shr:1 row_mask:0xf bank_mask:0xf
    v_cndmask_b32_dpp v87, v87, v87, vcc wave_shr:1 row_mask:0xf bank_mask:0xf
    s_andn2_b64 s[82:83], s[82:83], s[52:53]
    v_cndmask_b32_dpp v7, v7, v7, vcc wave_shr:1 row_mask:0xf bank_mask:0xf
    s_mov_b64 exec, s[54:55]
    s_cbranch_scc0 L2_d126
    s_mov_b64 exec, s[82:83]
    s_nop 1
    v_mfma_f32_4x4x4_16b_bf16 v[88:91], v[12:13], v[84:85], 0
    s_nop 1
    v_mfma_f32_4x4x4_16b_bf16 v[88:91], v[10:11], v[86:87], v[88:91]
    s_nop 4
    v_cvt_pk_bf16_f32 v88, v88, v89
    v_cvt_pk_bf16_f32 v89, v90, v91
    ds_pk_add_bf16 v7, v88 offset:65408
    ds_pk_add_bf16 v7, v89 offset:65412
    s_mov_b64 exec, s[54:55]
    s_branch L2_d126
L2_c127:
    s_lshl_b64 s[52:53], s[82:83], 1
    s_andn2_b64 s[52:53], s[52:53], s[80:81]
    s_andn2_b64 s[52:53], s[52:53], s[50:51]
    s_or_b64 s[80:81], s[80:81], s[52:53]
    s_not_b64 vcc, s[52:53]
    s_mov_b64 exec, -1
    v_cndmask_b32_dpp v84, v84, v84, vcc wave_shr:1 row_mask:0xf bank_mask:0xf
    v_cndmask_b32_dpp v85, v85, v85, vcc wave_shr:1 row_mask:0xf bank_mask:0xf
    s_lshr_b64 s[52:53], s[52:53], 1
    v_cndmask_b32_dpp v86, v86, v86, vcc wave_shr:1 row_mask:0xf bank_mask:0xf
    v_cndmask_b32_dpp v87, v87, v87, vcc wave_shr:1 row_mask:0xf bank_mask:0xf
    s_andn2_b64 s[82:83], s[82:83], s[52:53]
    v_cndmask_b32_dpp v7, v7, v7, vcc wave_shr:1 row_mask:0xf bank_mask:0xf
    s_mov_b64 exec, s[50:51]
    s_cbranch_scc0 L2_d127
    s_mov_b64 exec, s[82:83]
    s_nop 1
    v_mfma_f32_4x4x4_16b_bf16 v[88:91], v[12:13], v[84:85], 0
    s_nop 1
    v_mfma_f32_4x4x4_16b_bf16 v[88:91], v[10:11], v[86:87], v[88:91]
    s_nop 4
    v_cvt_pk_bf16_f32 v88, v88, v89
    v_cvt_pk_bf16_f32 v89, v90, v91
    ds_pk_add_bf16 v7, v88 offset:65408
    ds_pk_add_bf16 v7, v89 offset:65412
    s_mov_b64 exec, s[50:51]
    s_branch L2_d127
L2_c128:
    s_lshl_b64 s[52:53], s[82:83], 1
    s_andn2_b64 s[52:53], s[52:53], s[80:81]
    s_andn2_b64 s[52:53], s[52:53], s[54:55]
    s_or_b64 s[80:81], s[80:81], s[52:53]
    s_not_b64 vcc, s[52:53]
    s_mov_b64 exec, -1
    v_cndmask_b32_dpp v84, v84, v84, vcc wave_shr:1 row_mask:0xf bank_mask:0xf
    v_cndmask_b32_dpp v85, v85, v85, vcc wave_shr:1 row_mask:0xf bank_mask:0xf
    s_lshr_b64 s[52:53], s[52:53], 1
    v_cndmask_b32_dpp v86, v86, v86, vcc wave_shr:1 row_mask:0xf bank_mask:0xf
    v_cndmask_b32_dpp v87, v87, v87, vcc wave_shr:1 row_mask:0xf bank_mask:0xf
    s_andn2_b64 s[82:83], s[82:83], s[52:53]
    v_cndmask_b32_dpp v7, v7, v7, vcc wave_shr:1 row_mask:0xf bank_mask:0xf
    s_mov_b64 exec, s[54:55]
    s_cbranch_scc0 L2_d128
    s_mov_b64 exec, s[82:83]
    s_nop 1
    v_mfma_f32_4x4x4_16b_bf16 v[88:91], v[12:13], v[84:85], 0
    s_nop 1
    v_mfma_f32_4x4x4_16b_bf16 v[88:91], v[10:11], v[86:87], v[88:91]
    s_nop 4
    v_cvt_pk_bf16_f32 v88, v88, v89
    v_cvt_pk_bf16_f32 v89, v90, v91
    ds_pk_add_bf16 v7, v88 offset:65408
    ds_pk_add_bf16 v7, v89 offset:65412
    s_mov_b64 exec, s[54:55]
    s_branch L2_d128
L2_c129:
    s_lshl_b64 s[52:53], s[82:83], 1
    s_andn2_b64 s[52:53], s[52:53], s[80:81]
    s_andn2_b64 s[52:53], s[52:53], s[50:51]
    s_or_b64 s[80:81], s[80:81], s[52:53]
    s_not_b64 vcc, s[52:53]
    s_mov_b64 exec, -1
    v_cndmask_b32_dpp v84, v84, v84, vcc wave_shr:1 row_mask:0xf bank_mask:0xf
    v_cndmask_b32_dpp v85, v85, v85, vcc wave_shr:1 row_mask:0xf bank_mask:0xf
    s_lshr_b64 s[52:53], s[52:53], 1
    v_cndmask_b32_dpp v86, v86, v86, vcc wave_shr:1 row_mask:0xf bank_mask:0xf
    v_cndmask_b32_dpp v87, v87, v87, vcc wave_shr:1 row_mask:0xf bank_mask:0xf
    s_andn2_b64 s[82:83], s[82:83], s[52:53]
    v_cndmask_b32_dpp v7, v7, v7, vcc wave_shr:1 row_mask:0xf bank_mask:0xf
    s_mov_b64 exec, s[50:51]
    s_cbranch_scc0 L2_d129
    s_mov_b64 exec, s[82:83]
    s_nop 1
    v_mfma_f32_4x4x4_16b_bf16 v[88:91], v[12:13], v[84:85], 0
    s_nop 1
    v_mfma_f32_4x4x4_16b_bf16 v[88:91], v[10:11], v[86:87], v[88:91]
    s_nop 4
    v_cvt_pk_bf16_f32 v88, v88, v89
    v_cvt_pk_bf16_f32 v89, v90, v91
    ds_pk_add_bf16 v7, v88 offset:65408
    ds_pk_add_bf16 v7, v89 offset:65412
    s_mov_b64 exec, s[50:51]
    s_branch L2_d129
L2_c130:
    s_lshl_b64 s[52:53], s[82:83], 1
    s_andn2_b64 s[52:53], s[52:53], s[80:81]
    s_andn2_b64 s[52:53], s[52:53], s[54:55]
    s_or_b64 s[80:81], s[80:81], s[52:53]
    s_not_b64 vcc, s[52:53]
    s_mov_b64 exec, -1
    v_cndmask_b32_dpp v84, v84, v84, vcc wave_shr:1 row_mask:0xf bank_mask:0xf
    v_cndmask_b32_dpp v85, v85, v85, vcc wave_shr:1 row_mask:0xf bank_mask:0xf
    s_lshr_b64 s[52:53], s[52:53], 1
    v_cndmask_b32_dpp v86, v86, v86, vcc wave_shr:1 row_mask:0xf bank_mask:0xf
    v_cndmask_b32_dpp v87, v87, v87, vcc wave_shr:1 row_mask:0xf bank_mask:0xf
    s_andn2_b64 s[82:83], s[82:83], s[52:53]
    v_cndmask_b32_dpp v7, v7, v7, vcc wave_shr:1 row_mask:0xf bank_mask:0xf
    s_mov_b64 exec, s[54:55]
    s_cbranch_scc0 L2_d130
    s_mov_b64 exec, s[82:83]
    s_nop 1
    v_mfma_f32_4x4x4_16b_bf16 v[88:91], v[12:13], v[84:85], 0
    s_nop 1
    v_mfma_f32_4x4x4_16b_bf16 v[88:91], v[10:11], v[86:87], v[88:91]
    s_nop 4
    v_cvt_pk_bf16_f32 v88, v88, v89
    v_cvt_pk_bf16_f32 v89, v90, v91
    ds_pk_add_bf16 v7, v88 offset:65408
    ds_pk_add_bf16 v7, v89 offset:65412
    s_mov_b64 exec, s[54:55]
    s_branch L2_d130
L2_c131:
    s_lshl_b64 s[52:53], s[82:83], 1
    s_andn2_b64 s[52:53], s[52:53], s[80:81]
    s_andn2_b64 s[52:53], s[52:53], s[50:51]
    s_or_b64 s[80:81], s[80:81], s[52:53]
    s_not_b64 vcc, s[52:53]
    s_mov_b64 exec, -1
    v_cndmask_b32_dpp v84, v84, v84, vcc wave_shr:1 row_mask:0xf bank_mask:0xf
    v_cndmask_b32_dpp v85, v85, v85, vcc wave_shr:1 row_mask:0xf bank_mask:0xf
    s_lshr_b64 s[52:53], s[52:53], 1
    v_cndmask_b32_dpp v86, v86, v86, vcc wave_shr:1 row_mask:0xf bank_mask:0xf
    v_cndmask_b32_dpp v87, v87, v87, vcc wave_shr:1 row_mask:0xf bank_mask:0xf
    s_andn2_b64 s[82:83], s[82:83], s[52:53]
    v_cndmask_b32_dpp v7, v7, v7, vcc wave_shr:1 row_mask:0xf bank_mask:0xf
    s_mov_b64 exec, s[50:51]
    s_cbranch_scc0 L2_d131
    s_mov_b64 exec, s[82:83]
    s_nop 1
    v_mfma_f32_4x4x4_16b_bf16 v[88:91], v[12:13], v[84:85], 0
    s_nop 1
    v_mfma_f32_4x4x4_16b_bf16 v[88:91], v[10:11], v[86:87], v[88:91]
    s_nop 4
    v_cvt_pk_bf16_f32 v88, v88, v89
    v_cvt_pk_bf16_f32 v89, v90, v91
    ds_pk_add_bf16 v7, v88 offset:65408
    ds_pk_add_bf16 v7, v89 offset:65412
    s_mov_b64 exec, s[50:51]
    s_branch L2_d131
L2_c132:
    s_lshl_b64 s[52:53], s[82:83], 1
    s_andn2_b64 s[52:53], s[52:53], s[80:81]
    s_andn2_b64 s[52:53], s[52:53], s[54:55]
    s_or_b64 s[80:81], s[80:81], s[52:53]
    s_not_b64 vcc, s[52:53]
    s_mov_b64 exec, -1
    v_cndmask_b32_dpp v84, v84, v84, vcc wave_shr:1 row_mask:0xf bank_mask:0xf
    v_cndmask_b32_dpp v85, v85, v85, vcc wave_shr:1 row_mask:0xf bank_mask:0xf
    s_lshr_b64 s[52:53], s[52:53], 1
    v_cndmask_b32_dpp v86, v86, v86, vcc wave_shr:1 row_mask:0xf bank_mask:0xf
    v_cndmask_b32_dpp v87, v87, v87, vcc wave_shr:1 row_mask:0xf bank_mask:0xf
    s_andn2_b64 s[82:83], s[82:83], s[52:53]
    v_cndmask_b32_dpp v7, v7, v7, vcc wave_shr:1 row_mask:0xf bank_mask:0xf
    s_mov_b64 exec, s[54:55]
    s_cbranch_scc0 L2_d132
    s_mov_b64 exec, s[82:83]
    s_nop 1
    v_mfma_f32_4x4x4_16b_bf16 v[88:91], v[12:13], v[84:85], 0
    s_nop 1
    v_mfma_f32_4x4x4_16b_bf16 v[88:91], v[10:11], v[86:87], v[88:91]
    s_nop 4
    v_cvt_pk_bf16_f32 v88, v88, v89
    v_cvt_pk_bf16_f32 v89, v90, v91
    ds_pk_add_bf16 v7, v88 offset:65408
    ds_pk_add_bf16 v7, v89 offset:65412
    s_mov_b64 exec, s[54:55]
    s_branch L2_d132
L2_c133:
    s_lshl_b64 s[52:53], s[82:83], 1
    s_andn2_b64 s[52:53], s[52:53], s[80:81]
    s_andn2_b64 s[52:53], s[52:53], s[50:51]
    s_or_b64 s[80:81], s[80:81], s[52:53]
    s_not_b64 vcc, s[52:53]
    s_mov_b64 exec, -1
    v_cndmask_b32_dpp v84, v84, v84, vcc wave_shr:1 row_mask:0xf bank_mask:0xf
    v_cndmask_b32_dpp v85, v85, v85, vcc wave_shr:1 row_mask:0xf bank_mask:0xf
    s_lshr_b64 s[52:53], s[52:53], 1
    v_cndmask_b32_dpp v86, v86, v86, vcc wave_shr:1 row_mask:0xf bank_mask:0xf
    v_cndmask_b32_dpp v87, v87, v87, vcc wave_shr:1 row_mask:0xf bank_mask:0xf
    s_andn2_b64 s[82:83], s[82:83], s[52:53]
    v_cndmask_b32_dpp v7, v7, v7, vcc wave_shr:1 row_mask:0xf bank_mask:0xf
    s_mov_b64 exec, s[50:51]
    s_cbranch_scc0 L2_d133
    s_mov_b64 exec, s[82:83]
    s_nop 1
    v_mfma_f32_4x4x4_16b_bf16 v[88:91], v[12:13], v[84:85], 0
    s_nop 1
    v_mfma_f32_4x4x4_16b_bf16 v[88:91], v[10:11], v[86:87], v[88:91]
    s_nop 4
    v_cvt_pk_bf16_f32 v88, v88, v89
    v_cvt_pk_bf16_f32 v89, v90, v91
    ds_pk_add_bf16 v7, v88 offset:65408
    ds_pk_add_bf16 v7, v89 offset:65412
    s_mov_b64 exec, s[50:51]
    s_branch L2_d133
L2_oa134:
    v_and_b32 v47, 0x0fffffff, v33
    buffer_load_dword v114, v47, s[8:11], 0 offen offset:16
    s_mov_b64 exec, s[6:7]
    v_add_u32 v47, 8, v47
    v_lshrrev_b32 v33, 2, v33
    s_mov_b64 exec, -1
    buffer_load_dwordx2 v[112:113], v47, s[8:11], 0 offen
    s_branch L2_ob134
L2_c135:
    s_lshl_b64 s[52:53], s[82:83], 1
    s_andn2_b64 s[52:53], s[52:53], s[80:81]
    s_andn2_b64 s[52:53], s[52:53], s[54:55]
    s_or_b64 s[80:81], s[80:81], s[52:53]
    s_not_b64 vcc, s[52:53]
    s_mov_b64 exec, -1
    v_cndmask_b32_dpp v84, v84, v84, vcc wave_shr:1 row_mask:0xf bank_mask:0xf
    v_cndmask_b32_dpp v85, v85, v85, vcc wave_shr:1 row_mask:0xf bank_mask:0xf
    s_lshr_b64 s[52:53], s[52:53], 1
    v_cndmask_b32_dpp v86, v86, v86, vcc wave_shr:1 row_mask:0xf bank_mask:0xf
    v_cndmask_b32_dpp v87, v87, v87, vcc wave_shr:1 row_mask:0xf bank_mask:0xf
    s_andn2_b64 s[82:83], s[82:83], s[52:53]
    v_cndmask_b32_dpp v7, v7, v7, vcc wave_shr:1 row_mask:0xf bank_mask:0xf
    s_mov_b64 exec, s[54:55]
    s_cbranch_scc0 L2_d135
    s_mov_b64 exec, s[82:83]
    s_nop 1
    v_mfma_f32_4x4x4_16b_bf16 v[88:91], v[12:13], v[84:85], 0
    s_nop 1
    v_mfma_f32_4x4x4_16b_bf16 v[88:91], v[10:11], v[86:87], v[88:91]
    s_nop 4
    v_cvt_pk_bf16_f32 v88, v88, v89
    v_cvt_pk_bf16_f32 v89, v90, v91
    ds_pk_add_bf16 v7, v88 offset:65408
    ds_pk_add_bf16 v7, v89 offset:65412
    s_mov_b64 exec, s[54:55]
    s_branch L2_d135
L2_c136:
    s_lshl_b64 s[52:53], s[82:83], 1
    s_andn2_b64 s[52:53], s[52:53], s[80:81]
    s_andn2_b64 s[52:53], s[52:53], s[50:51]
    s_or_b64 s[80:81], s[80:81], s[52:53]
    s_not_b64 vcc, s[52:53]
    s_mov_b64 exec, -1
    v_cndmask_b32_dpp v84, v84, v84, vcc wave_shr:1 row_mask:0xf bank_mask:0xf
    v_cndmask_b32_dpp v85, v85, v85, vcc wave_shr:1 row_mask:0xf bank_mask:0xf
    s_lshr_b64 s[52:53], s[52:53], 1
    v_cndmask_b32_dpp v86, v86, v86, vcc wave_shr:1 row_mask:0xf bank_mask:0xf
    v_cndmask_b32_dpp v87, v87, v87, vcc wave_shr:1 row_mask:0xf bank_mask:0xf
    s_andn2_b64 s[82:83], s[82:83], s[52:53]
    v_cndmask_b32_dpp v7, v7, v7, vcc wave_shr:1 row_mask:0xf bank_mask:0xf
    s_mov_b64 exec, s[50:51]
    s_cbranch_scc0 L2_d136
    s_mov_b64 exec, s[82:83]
    s_nop 1
    v_mfma_f32_4x4x4_16b_bf16 v[88:91], v[12:13], v[84:85], 0
    s_nop 1
    v_mfma_f32_4x4x4_16b_bf16 v[88:91], v[10:11], v[86:87], v[88:91]
    s_nop 4
    v_cvt_pk_bf16_f32 v88, v88, v89
    v_cvt_pk_bf16_f32 v89, v90, v91
    ds_pk_add_bf16 v7, v88 offset:65408
    ds_pk_add_bf16 v7, v89 offset:65412
    s_mov_b64 exec, s[50:51]
    s_branch L2_d136
L2_c137:
    s_lshl_b64 s[52:53], s[82:83], 1
    s_andn2_b64 s[52:53], s[52:53], s[80:81]
    s_andn2_b64 s[52:53], s[52:53], s[54:55]
    s_or_b64 s[80:81], s[80:81], s[52:53]
    s_not_b64 vcc, s[52:53]
    s_mov_b64 exec, -1
    v_cndmask_b32_dpp v84, v84, v84, vcc wave_shr:1 row_mask:0xf bank_mask:0xf
    v_cndmask_b32_dpp v85, v85, v85, vcc wave_shr:1 row_mask:0xf bank_mask:0xf
    s_lshr_b64 s[52:53], s[52:53], 1
    v_cndmask_b32_dpp v86, v86, v86, vcc wave_shr:1 row_mask:0xf bank_mask:0xf
    v_cndmask_b32_dpp v87, v87, v87, vcc wave_shr:1 row_mask:0xf bank_mask:0xf
    s_andn2_b64 s[82:83], s[82:83], s[52:53]
    v_cndmask_b32_dpp v7, v7, v7, vcc wave_shr:1 row_mask:0xf bank_mask:0xf
    s_mov_b64 exec, s[54:55]
    s_cbranch_scc0 L2_d137
    s_mov_b64 exec, s[82:83]
    s_nop 1
    v_mfma_f32_4x4x4_16b_bf16 v[88:91], v[12:13], v[84:85], 0
    s_nop 1
    v_mfma_f32_4x4x4_16b_bf16 v[88:91], v[10:11], v[86:87], v[88:91]
    s_nop 4
    v_cvt_pk_bf16_f32 v88, v88, v89
    v_cvt_pk_bf16_f32 v89, v90, v91
    ds_pk_add_bf16 v7, v88 offset:65408
    ds_pk_add_bf16 v7, v89 offset:65412
    s_mov_b64 exec, s[54:55]
    s_branch L2_d137
L2_c138:
    s_lshl_b64 s[52:53], s[82:83], 1
    s_andn2_b64 s[52:53], s[52:53], s[80:81]
    s_andn2_b64 s[52:53], s[52:53], s[50:51]
    s_or_b64 s[80:81], s[80:81], s[52:53]
    s_not_b64 vcc, s[52:53]
    s_mov_b64 exec, -1
    v_cndmask_b32_dpp v84, v84, v84, vcc wave_shr:1 row_mask:0xf bank_mask:0xf
    v_cndmask_b32_dpp v85, v85, v85, vcc wave_shr:1 row_mask:0xf bank_mask:0xf
    s_lshr_b64 s[52:53], s[52:53], 1
    v_cndmask_b32_dpp v86, v86, v86, vcc wave_shr:1 row_mask:0xf bank_mask:0xf
    v_cndmask_b32_dpp v87, v87, v87, vcc wave_shr:1 row_mask:0xf bank_mask:0xf
    s_andn2_b64 s[82:83], s[82:83], s[52:53]
    v_cndmask_b32_dpp v7, v7, v7, vcc wave_shr:1 row_mask:0xf bank_mask:0xf
    s_mov_b64 exec, s[50:51]
    s_cbranch_scc0 L2_d138
    s_mov_b64 exec, s[82:83]
    s_nop 1
    v_mfma_f32_4x4x4_16b_bf16 v[88:91], v[12:13], v[84:85], 0
    s_nop 1
    v_mfma_f32_4x4x4_16b_bf16 v[88:91], v[10:11], v[86:87], v[88:91]
    s_nop 4
    v_cvt_pk_bf16_f32 v88, v88, v89
    v_cvt_pk_bf16_f32 v89, v90, v91
    ds_pk_add_bf16 v7, v88 offset:65408
    ds_pk_add_bf16 v7, v89 offset:65412
    s_mov_b64 exec, s[50:51]
    s_branch L2_d138
L2_c139:
    s_lshl_b64 s[52:53], s[82:83], 1
    s_andn2_b64 s[52:53], s[52:53], s[80:81]
    s_andn2_b64 s[52:53], s[52:53], s[54:55]
    s_or_b64 s[80:81], s[80:81], s[52:53]
    s_not_b64 vcc, s[52:53]
    s_mov_b64 exec, -1
    v_cndmask_b32_dpp v84, v84, v84, vcc wave_shr:1 row_mask:0xf bank_mask:0xf
    v_cndmask_b32_dpp v85, v85, v85, vcc wave_shr:1 row_mask:0xf bank_mask:0xf
    s_lshr_b64 s[52:53], s[52:53], 1
    v_cndmask_b32_dpp v86, v86, v86, vcc wave_shr:1 row_mask:0xf bank_mask:0xf
    v_cndmask_b32_dpp v87, v87, v87, vcc wave_shr:1 row_mask:0xf bank_mask:0xf
    s_andn2_b64 s[82:83], s[82:83], s[52:53]
    v_cndmask_b32_dpp v7, v7, v7, vcc wave_shr:1 row_mask:0xf bank_mask:0xf
    s_mov_b64 exec, s[54:55]
    s_cbranch_scc0 L2_d139
    s_mov_b64 exec, s[82:83]
    s_nop 1
    v_mfma_f32_4x4x4_16b_bf16 v[88:91], v[12:13], v[84:85], 0
    s_nop 1
    v_mfma_f32_4x4x4_16b_bf16 v[88:91], v[10:11], v[86:87], v[88:91]
    s_nop 4
    v_cvt_pk_bf16_f32 v88, v88, v89
    v_cvt_pk_bf16_f32 v89, v90, v91
    ds_pk_add_bf16 v7, v88 offset:65408
    ds_pk_add_bf16 v7, v89 offset:65412
    s_mov_b64 exec, s[54:55]
    s_branch L2_d139
L2_c140:
    s_lshl_b64 s[52:53], s[82:83], 1
    s_andn2_b64 s[52:53], s[52:53], s[80:81]
    s_andn2_b64 s[52:53], s[52:53], s[50:51]
    s_or_b64 s[80:81], s[80:81], s[52:53]
    s_not_b64 vcc, s[52:53]
    s_mov_b64 exec, -1
    v_cndmask_b32_dpp v84, v84, v84, vcc wave_shr:1 row_mask:0xf bank_mask:0xf
    v_cndmask_b32_dpp v85, v85, v85, vcc wave_shr:1 row_mask:0xf bank_mask:0xf
    s_lshr_b64 s[52:53], s[52:53], 1
    v_cndmask_b32_dpp v86, v86, v86, vcc wave_shr:1 row_mask:0xf bank_mask:0xf
    v_cndmask_b32_dpp v87, v87, v87, vcc wave_shr:1 row_mask:0xf bank_mask:0xf
    s_andn2_b64 s[82:83], s[82:83], s[52:53]
    v_cndmask_b32_dpp v7, v7, v7, vcc wave_shr:1 row_mask:0xf bank_mask:0xf
    s_mov_b64 exec, s[50:51]
    s_cbranch_scc0 L2_d140
    s_mov_b64 exec, s[82:83]
    s_nop 1
    v_mfma_f32_4x4x4_16b_bf16 v[88:91], v[12:13], v[84:85], 0
    s_nop 1
    v_mfma_f32_4x4x4_16b_bf16 v[88:91], v[10:11], v[86:87], v[88:91]
    s_nop 4
    v_cvt_pk_bf16_f32 v88, v88, v89
    v_cvt_pk_bf16_f32 v89, v90, v91
    ds_pk_add_bf16 v7, v88 offset:65408
    ds_pk_add_bf16 v7, v89 offset:65412
    s_mov_b64 exec, s[50:51]
    s_branch L2_d140
L2_oa141:
    s_waitcnt vmcnt(0)
    s_mov_b64 exec, s[6:7]
    v_lshrrev_b32 v114, 16, v114
    s_mov_b64 exec, -1
    v_and_b32 v46, 0x10000000, v33
    v_cmpx_eq_u32 vcc, 0, v46
    v_lshrrev_b32 v47, 14, v112
    v_and_b32 v47, v5, v47
    ds_read_b64 v[96:97], v47
    v_perm_b32 v98, v112, v114, s44
    v_bitop3_b32 v99, v112, 0.5, -0.5 bitop3:0xa8
    v_bitop3_b32 v98, v6, v98, v99 bitop3:0xca
    v_and_b32 v47, v5, v112
    s_waitcnt lgkmcnt(0)
    v_mfma_f32_4x4x4_16b_bf16 v[88:91], v[8:9], v[96:97], 0
    s_nop 4
    v_mul_f32 v88, v98, v88
    v_mul_f32 v89, v98, v89
    v_mul_f32 v90, v98, v90
    v_mul_f32 v91, v98, v91
    v_cvt_pk_bf16_f32 v88, v88, v89
    v_cvt_pk_bf16_f32 v89, v90, v91
    ds_pk_add_bf16 v47, v88 offset:65408
    ds_pk_add_bf16 v47, v89 offset:65412
    s_mov_b64 exec, -1
    v_and_b32 v46, 0x20000000, v33
    v_cmpx_eq_u32 vcc, 0, v46
    v_lshrrev_b32 v47, 14, v113
    v_and_b32 v47, v5, v47
    ds_read_b64 v[96:97], v47
    v_perm_b32 v98, v113, v114, s45
    v_bitop3_b32 v99, v113, 0.5, -0.5 bitop3:0xa8
    v_bitop3_b32 v98, v6, v98, v99 bitop3:0xca
    v_and_b32 v47, v5, v113
    s_waitcnt lgkmcnt(0)
    v_mfma_f32_4x4x4_16b_bf16 v[88:91], v[8:9], v[96:97], 0
    s_nop 4
    v_mul_f32 v88, v98, v88
    v_mul_f32 v89, v98, v89
    v_mul_f32 v90, v98, v90
    v_mul_f32 v91, v98, v91
    v_cvt_pk_bf16_f32 v88, v88, v89
    v_cvt_pk_bf16_f32 v89, v90, v91
    ds_pk_add_bf16 v47, v88 offset:65408
    ds_pk_add_bf16 v47, v89 offset:65412
    s_mov_b64 exec, -1
    s_branch L2_ob141
L2_c142:
    s_lshl_b64 s[52:53], s[82:83], 1
    s_andn2_b64 s[52:53], s[52:53], s[80:81]
    s_andn2_b64 s[52:53], s[52:53], s[54:55]
    s_or_b64 s[80:81], s[80:81], s[52:53]
    s_not_b64 vcc, s[52:53]
    s_mov_b64 exec, -1
    v_cndmask_b32_dpp v84, v84, v84, vcc wave_shr:1 row_mask:0xf bank_mask:0xf
    v_cndmask_b32_dpp v85, v85, v85, vcc wave_shr:1 row_mask:0xf bank_mask:0xf
    s_lshr_b64 s[52:53], s[52:53], 1
    v_cndmask_b32_dpp v86, v86, v86, vcc wave_shr:1 row_mask:0xf bank_mask:0xf
    v_cndmask_b32_dpp v87, v87, v87, vcc wave_shr:1 row_mask:0xf bank_mask:0xf
    s_andn2_b64 s[82:83], s[82:83], s[52:53]
    v_cndmask_b32_dpp v7, v7, v7, vcc wave_shr:1 row_mask:0xf bank_mask:0xf
    s_mov_b64 exec, s[54:55]
    s_cbranch_scc0 L2_d142
    s_mov_b64 exec, s[82:83]
    s_nop 1
    v_mfma_f32_4x4x4_16b_bf16 v[88:91], v[12:13], v[84:85], 0
    s_nop 1
    v_mfma_f32_4x4x4_16b_bf16 v[88:91], v[10:11], v[86:87], v[88:91]
    s_nop 4
    v_cvt_pk_bf16_f32 v88, v88, v89
    v_cvt_pk_bf16_f32 v89, v90, v91
    ds_pk_add_bf16 v7, v88 offset:65408
    ds_pk_add_bf16 v7, v89 offset:65412
    s_mov_b64 exec, s[54:55]
    s_branch L2_d142
L2_c143:
    s_lshl_b64 s[52:53], s[82:83], 1
    s_andn2_b64 s[52:53], s[52:53], s[80:81]
    s_andn2_b64 s[52:53], s[52:53], s[50:51]
    s_or_b64 s[80:81], s[80:81], s[52:53]
    s_not_b64 vcc, s[52:53]
    s_mov_b64 exec, -1
    v_cndmask_b32_dpp v84, v84, v84, vcc wave_shr:1 row_mask:0xf bank_mask:0xf
    v_cndmask_b32_dpp v85, v85, v85, vcc wave_shr:1 row_mask:0xf bank_mask:0xf
    s_lshr_b64 s[52:53], s[52:53], 1
    v_cndmask_b32_dpp v86, v86, v86, vcc wave_shr:1 row_mask:0xf bank_mask:0xf
    v_cndmask_b32_dpp v87, v87, v87, vcc wave_shr:1 row_mask:0xf bank_mask:0xf
    s_andn2_b64 s[82:83], s[82:83], s[52:53]
    v_cndmask_b32_dpp v7, v7, v7, vcc wave_shr:1 row_mask:0xf bank_mask:0xf
    s_mov_b64 exec, s[50:51]
    s_cbranch_scc0 L2_d143
    s_mov_b64 exec, s[82:83]
    s_nop 1
    v_mfma_f32_4x4x4_16b_bf16 v[88:91], v[12:13], v[84:85], 0
    s_nop 1
    v_mfma_f32_4x4x4_16b_bf16 v[88:91], v[10:11], v[86:87], v[88:91]
    s_nop 4
    v_cvt_pk_bf16_f32 v88, v88, v89
    v_cvt_pk_bf16_f32 v89, v90, v91
    ds_pk_add_bf16 v7, v88 offset:65408
    ds_pk_add_bf16 v7, v89 offset:65412
    s_mov_b64 exec, s[50:51]
    s_branch L2_d143
L2_c144:
    s_lshl_b64 s[52:53], s[82:83], 1
    s_andn2_b64 s[52:53], s[52:53], s[80:81]
    s_andn2_b64 s[52:53], s[52:53], s[54:55]
    s_or_b64 s[80:81], s[80:81], s[52:53]
    s_not_b64 vcc, s[52:53]
    s_mov_b64 exec, -1
    v_cndmask_b32_dpp v84, v84, v84, vcc wave_shr:1 row_mask:0xf bank_mask:0xf
    v_cndmask_b32_dpp v85, v85, v85, vcc wave_shr:1 row_mask:0xf bank_mask:0xf
    s_lshr_b64 s[52:53], s[52:53], 1
    v_cndmask_b32_dpp v86, v86, v86, vcc wave_shr:1 row_mask:0xf bank_mask:0xf
    v_cndmask_b32_dpp v87, v87, v87, vcc wave_shr:1 row_mask:0xf bank_mask:0xf
    s_andn2_b64 s[82:83], s[82:83], s[52:53]
    v_cndmask_b32_dpp v7, v7, v7, vcc wave_shr:1 row_mask:0xf bank_mask:0xf
    s_mov_b64 exec, s[54:55]
    s_cbranch_scc0 L2_d144
    s_mov_b64 exec, s[82:83]
    s_nop 1
    v_mfma_f32_4x4x4_16b_bf16 v[88:91], v[12:13], v[84:85], 0
    s_nop 1
    v_mfma_f32_4x4x4_16b_bf16 v[88:91], v[10:11], v[86:87], v[88:91]
    s_nop 4
    v_cvt_pk_bf16_f32 v88, v88, v89
    v_cvt_pk_bf16_f32 v89, v90, v91
    ds_pk_add_bf16 v7, v88 offset:65408
    ds_pk_add_bf16 v7, v89 offset:65412
    s_mov_b64 exec, s[54:55]
    s_branch L2_d144
L2_c145:
    s_lshl_b64 s[52:53], s[82:83], 1
    s_andn2_b64 s[52:53], s[52:53], s[80:81]
    s_andn2_b64 s[52:53], s[52:53], s[50:51]
    s_or_b64 s[80:81], s[80:81], s[52:53]
    s_not_b64 vcc, s[52:53]
    s_mov_b64 exec, -1
    v_cndmask_b32_dpp v84, v84, v84, vcc wave_shr:1 row_mask:0xf bank_mask:0xf
    v_cndmask_b32_dpp v85, v85, v85, vcc wave_shr:1 row_mask:0xf bank_mask:0xf
    s_lshr_b64 s[52:53], s[52:53], 1
    v_cndmask_b32_dpp v86, v86, v86, vcc wave_shr:1 row_mask:0xf bank_mask:0xf
    v_cndmask_b32_dpp v87, v87, v87, vcc wave_shr:1 row_mask:0xf bank_mask:0xf
    s_andn2_b64 s[82:83], s[82:83], s[52:53]
    v_cndmask_b32_dpp v7, v7, v7, vcc wave_shr:1 row_mask:0xf bank_mask:0xf
    s_mov_b64 exec, s[50:51]
    s_cbranch_scc0 L2_d145
    s_mov_b64 exec, s[82:83]
    s_nop 1
    v_mfma_f32_4x4x4_16b_bf16 v[88:91], v[12:13], v[84:85], 0
    s_nop 1
    v_mfma_f32_4x4x4_16b_bf16 v[88:91], v[10:11], v[86:87], v[88:91]
    s_nop 4
    v_cvt_pk_bf16_f32 v88, v88, v89
    v_cvt_pk_bf16_f32 v89, v90, v91
    ds_pk_add_bf16 v7, v88 offset:65408
    ds_pk_add_bf16 v7, v89 offset:65412
    s_mov_b64 exec, s[50:51]
    s_branch L2_d145
L2_c146:
    s_lshl_b64 s[52:53], s[82:83], 1
    s_andn2_b64 s[52:53], s[52:53], s[80:81]
    s_andn2_b64 s[52:53], s[52:53], s[54:55]
    s_or_b64 s[80:81], s[80:81], s[52:53]
    s_not_b64 vcc, s[52:53]
    s_mov_b64 exec, -1
    v_cndmask_b32_dpp v84, v84, v84, vcc wave_shr:1 row_mask:0xf bank_mask:0xf
    v_cndmask_b32_dpp v85, v85, v85, vcc wave_shr:1 row_mask:0xf bank_mask:0xf
    s_lshr_b64 s[52:53], s[52:53], 1
    v_cndmask_b32_dpp v86, v86, v86, vcc wave_shr:1 row_mask:0xf bank_mask:0xf
    v_cndmask_b32_dpp v87, v87, v87, vcc wave_shr:1 row_mask:0xf bank_mask:0xf
    s_andn2_b64 s[82:83], s[82:83], s[52:53]
    v_cndmask_b32_dpp v7, v7, v7, vcc wave_shr:1 row_mask:0xf bank_mask:0xf
    s_mov_b64 exec, s[54:55]
    s_cbranch_scc0 L2_d146
    s_mov_b64 exec, s[82:83]
    s_nop 1
    v_mfma_f32_4x4x4_16b_bf16 v[88:91], v[12:13], v[84:85], 0
    s_nop 1
    v_mfma_f32_4x4x4_16b_bf16 v[88:91], v[10:11], v[86:87], v[88:91]
    s_nop 4
    v_cvt_pk_bf16_f32 v88, v88, v89
    v_cvt_pk_bf16_f32 v89, v90, v91
    ds_pk_add_bf16 v7, v88 offset:65408
    ds_pk_add_bf16 v7, v89 offset:65412
    s_mov_b64 exec, s[54:55]
    s_branch L2_d146
L2_c147:
    s_lshl_b64 s[52:53], s[82:83], 1
    s_andn2_b64 s[52:53], s[52:53], s[80:81]
    s_andn2_b64 s[52:53], s[52:53], s[50:51]
    s_or_b64 s[80:81], s[80:81], s[52:53]
    s_not_b64 vcc, s[52:53]
    s_mov_b64 exec, -1
    v_cndmask_b32_dpp v84, v84, v84, vcc wave_shr:1 row_mask:0xf bank_mask:0xf
    v_cndmask_b32_dpp v85, v85, v85, vcc wave_shr:1 row_mask:0xf bank_mask:0xf
    s_lshr_b64 s[52:53], s[52:53], 1
    v_cndmask_b32_dpp v86, v86, v86, vcc wave_shr:1 row_mask:0xf bank_mask:0xf
    v_cndmask_b32_dpp v87, v87, v87, vcc wave_shr:1 row_mask:0xf bank_mask:0xf
    s_andn2_b64 s[82:83], s[82:83], s[52:53]
    v_cndmask_b32_dpp v7, v7, v7, vcc wave_shr:1 row_mask:0xf bank_mask:0xf
    s_mov_b64 exec, s[50:51]
    s_cbranch_scc0 L2_d147
    s_mov_b64 exec, s[82:83]
    s_nop 1
    v_mfma_f32_4x4x4_16b_bf16 v[88:91], v[12:13], v[84:85], 0
    s_nop 1
    v_mfma_f32_4x4x4_16b_bf16 v[88:91], v[10:11], v[86:87], v[88:91]
    s_nop 4
    v_cvt_pk_bf16_f32 v88, v88, v89
    v_cvt_pk_bf16_f32 v89, v90, v91
    ds_pk_add_bf16 v7, v88 offset:65408
    ds_pk_add_bf16 v7, v89 offset:65412
    s_mov_b64 exec, s[50:51]
    s_branch L2_d147
L2_c148:
    s_lshl_b64 s[52:53], s[82:83], 1
    s_andn2_b64 s[52:53], s[52:53], s[80:81]
    s_andn2_b64 s[52:53], s[52:53], s[54:55]
    s_or_b64 s[80:81], s[80:81], s[52:53]
    s_not_b64 vcc, s[52:53]
    s_mov_b64 exec, -1
    v_cndmask_b32_dpp v84, v84, v84, vcc wave_shr:1 row_mask:0xf bank_mask:0xf
    v_cndmask_b32_dpp v85, v85, v85, vcc wave_shr:1 row_mask:0xf bank_mask:0xf
    s_lshr_b64 s[52:53], s[52:53], 1
    v_cndmask_b32_dpp v86, v86, v86, vcc wave_shr:1 row_mask:0xf bank_mask:0xf
    v_cndmask_b32_dpp v87, v87, v87, vcc wave_shr:1 row_mask:0xf bank_mask:0xf
    s_andn2_b64 s[82:83], s[82:83], s[52:53]
    v_cndmask_b32_dpp v7, v7, v7, vcc wave_shr:1 row_mask:0xf bank_mask:0xf
    s_mov_b64 exec, s[54:55]
    s_cbranch_scc0 L2_d148
    s_mov_b64 exec, s[82:83]
    s_nop 1
    v_mfma_f32_4x4x4_16b_bf16 v[88:91], v[12:13], v[84:85], 0
    s_nop 1
    v_mfma_f32_4x4x4_16b_bf16 v[88:91], v[10:11], v[86:87], v[88:91]
    s_nop 4
    v_cvt_pk_bf16_f32 v88, v88, v89
    v_cvt_pk_bf16_f32 v89, v90, v91
    ds_pk_add_bf16 v7, v88 offset:65408
    ds_pk_add_bf16 v7, v89 offset:65412
    s_mov_b64 exec, s[54:55]
    s_branch L2_d148
L2_c149:
    s_lshl_b64 s[52:53], s[82:83], 1
    s_andn2_b64 s[52:53], s[52:53], s[80:81]
    s_andn2_b64 s[52:53], s[52:53], s[50:51]
    s_or_b64 s[80:81], s[80:81], s[52:53]
    s_not_b64 vcc, s[52:53]
    s_mov_b64 exec, -1
    v_cndmask_b32_dpp v84, v84, v84, vcc wave_shr:1 row_mask:0xf bank_mask:0xf
    v_cndmask_b32_dpp v85, v85, v85, vcc wave_shr:1 row_mask:0xf bank_mask:0xf
    s_lshr_b64 s[52:53], s[52:53], 1
    v_cndmask_b32_dpp v86, v86, v86, vcc wave_shr:1 row_mask:0xf bank_mask:0xf
    v_cndmask_b32_dpp v87, v87, v87, vcc wave_shr:1 row_mask:0xf bank_mask:0xf
    s_andn2_b64 s[82:83], s[82:83], s[52:53]
    v_cndmask_b32_dpp v7, v7, v7, vcc wave_shr:1 row_mask:0xf bank_mask:0xf
    s_mov_b64 exec, s[50:51]
    s_cbranch_scc0 L2_d149
    s_mov_b64 exec, s[82:83]
    s_nop 1
    v_mfma_f32_4x4x4_16b_bf16 v[88:91], v[12:13], v[84:85], 0
    s_nop 1
    v_mfma_f32_4x4x4_16b_bf16 v[88:91], v[10:11], v[86:87], v[88:91]
    s_nop 4
    v_cvt_pk_bf16_f32 v88, v88, v89
    v_cvt_pk_bf16_f32 v89, v90, v91
    ds_pk_add_bf16 v7, v88 offset:65408
    ds_pk_add_bf16 v7, v89 offset:65412
    s_mov_b64 exec, s[50:51]
    s_branch L2_d149
L2_c150:
    s_lshl_b64 s[52:53], s[82:83], 1
    s_andn2_b64 s[52:53], s[52:53], s[80:81]
    s_andn2_b64 s[52:53], s[52:53], s[54:55]
    s_or_b64 s[80:81], s[80:81], s[52:53]
    s_not_b64 vcc, s[52:53]
    s_mov_b64 exec, -1
    v_cndmask_b32_dpp v84, v84, v84, vcc wave_shr:1 row_mask:0xf bank_mask:0xf
    v_cndmask_b32_dpp v85, v85, v85, vcc wave_shr:1 row_mask:0xf bank_mask:0xf
    s_lshr_b64 s[52:53], s[52:53], 1
    v_cndmask_b32_dpp v86, v86, v86, vcc wave_shr:1 row_mask:0xf bank_mask:0xf
    v_cndmask_b32_dpp v87, v87, v87, vcc wave_shr:1 row_mask:0xf bank_mask:0xf
    s_andn2_b64 s[82:83], s[82:83], s[52:53]
    v_cndmask_b32_dpp v7, v7, v7, vcc wave_shr:1 row_mask:0xf bank_mask:0xf
    s_mov_b64 exec, s[54:55]
    s_cbranch_scc0 L2_d150
    s_mov_b64 exec, s[82:83]
    s_nop 1
    v_mfma_f32_4x4x4_16b_bf16 v[88:91], v[12:13], v[84:85], 0
    s_nop 1
    v_mfma_f32_4x4x4_16b_bf16 v[88:91], v[10:11], v[86:87], v[88:91]
    s_nop 4
    v_cvt_pk_bf16_f32 v88, v88, v89
    v_cvt_pk_bf16_f32 v89, v90, v91
    ds_pk_add_bf16 v7, v88 offset:65408
    ds_pk_add_bf16 v7, v89 offset:65412
    s_mov_b64 exec, s[54:55]
    s_branch L2_d150
L2_c151:
    s_lshl_b64 s[52:53], s[82:83], 1
    s_andn2_b64 s[52:53], s[52:53], s[80:81]
    s_andn2_b64 s[52:53], s[52:53], s[50:51]
    s_or_b64 s[80:81], s[80:81], s[52:53]
    s_not_b64 vcc, s[52:53]
    s_mov_b64 exec, -1
    v_cndmask_b32_dpp v84, v84, v84, vcc wave_shr:1 row_mask:0xf bank_mask:0xf
    v_cndmask_b32_dpp v85, v85, v85, vcc wave_shr:1 row_mask:0xf bank_mask:0xf
    s_lshr_b64 s[52:53], s[52:53], 1
    v_cndmask_b32_dpp v86, v86, v86, vcc wave_shr:1 row_mask:0xf bank_mask:0xf
    v_cndmask_b32_dpp v87, v87, v87, vcc wave_shr:1 row_mask:0xf bank_mask:0xf
    s_andn2_b64 s[82:83], s[82:83], s[52:53]
    v_cndmask_b32_dpp v7, v7, v7, vcc wave_shr:1 row_mask:0xf bank_mask:0xf
    s_mov_b64 exec, s[50:51]
    s_cbranch_scc0 L2_d151
    s_mov_b64 exec, s[82:83]
    s_nop 1
    v_mfma_f32_4x4x4_16b_bf16 v[88:91], v[12:13], v[84:85], 0
    s_nop 1
    v_mfma_f32_4x4x4_16b_bf16 v[88:91], v[10:11], v[86:87], v[88:91]
    s_nop 4
    v_cvt_pk_bf16_f32 v88, v88, v89
    v_cvt_pk_bf16_f32 v89, v90, v91
    ds_pk_add_bf16 v7, v88 offset:65408
    ds_pk_add_bf16 v7, v89 offset:65412
    s_mov_b64 exec, s[50:51]
    s_branch L2_d151
L2_c152:
    s_mov_b64 s[50:51], vcc
    s_lshl_b64 s[52:53], s[82:83], 1
    s_andn2_b64 s[52:53], s[52:53], s[80:81]
    s_andn2_b64 s[52:53], s[52:53], s[50:51]
    s_or_b64 s[80:81], s[80:81], s[52:53]
    s_not_b64 vcc, s[52:53]
    s_mov_b64 exec, -1
    v_cndmask_b32_dpp v84, v84, v84, vcc wave_shr:1 row_mask:0xf bank_mask:0xf
    v_cndmask_b32_dpp v85, v85, v85, vcc wave_shr:1 row_mask:0xf bank_mask:0xf
    s_lshr_b64 s[52:53], s[52:53], 1
    v_cndmask_b32_dpp v86, v86, v86, vcc wave_shr:1 row_mask:0xf bank_mask:0xf
    v_cndmask_b32_dpp v87, v87, v87, vcc wave_shr:1 row_mask:0xf bank_mask:0xf
    s_andn2_b64 s[82:83], s[82:83], s[52:53]
    v_cndmask_b32_dpp v7, v7, v7, vcc wave_shr:1 row_mask:0xf bank_mask:0xf
    s_mov_b64 vcc, s[50:51]
    s_mov_b64 exec, s[50:51]
    s_cbranch_scc0 L2_d152
    s_mov_b64 exec, s[82:83]
    s_nop 1
    v_mfma_f32_4x4x4_16b_bf16 v[88:91], v[12:13], v[84:85], 0
    s_nop 1
    v_mfma_f32_4x4x4_16b_bf16 v[88:91], v[10:11], v[86:87], v[88:91]
    s_nop 4
    v_cvt_pk_bf16_f32 v88, v88, v89
    v_cvt_pk_bf16_f32 v89, v90, v91
    ds_pk_add_bf16 v7, v88 offset:65408
    ds_pk_add_bf16 v7, v89 offset:65412
    s_mov_b64 exec, vcc
    s_branch L2_d152
L2_c153:
    s_mov_b64 s[50:51], vcc
    s_lshl_b64 s[52:53], s[82:83], 1
    s_andn2_b64 s[52:53], s[52:53], s[80:81]
    s_andn2_b64 s[52:53], s[52:53], s[50:51]
    s_or_b64 s[80:81], s[80:81], s[52:53]
    s_not_b64 vcc, s[52:53]
    s_mov_b64 exec, -1
    v_cndmask_b32_dpp v84, v84, v84, vcc wave_shr:1 row_mask:0xf bank_mask:0xf
    v_cndmask_b32_dpp v85, v85, v85, vcc wave_shr:1 row_mask:0xf bank_mask:0xf
    s_lshr_b64 s[52:53], s[52:53], 1
    v_cndmask_b32_dpp v86, v86, v86, vcc wave_shr:1 row_mask:0xf bank_mask:0xf
    v_cndmask_b32_dpp v87, v87, v87, vcc wave_shr:1 row_mask:0xf bank_mask:0xf
    s_andn2_b64 s[82:83], s[82:83], s[52:53]
    v_cndmask_b32_dpp v7, v7, v7, vcc wave_shr:1 row_mask:0xf bank_mask:0xf
    s_mov_b64 vcc, s[50:51]
    s_mov_b64 exec, s[50:51]
    s_cbranch_scc0 L2_d153
    s_mov_b64 exec, s[82:83]
    s_nop 1
    v_mfma_f32_4x4x4_16b_bf16 v[88:91], v[12:13], v[84:85], 0
    s_nop 1
    v_mfma_f32_4x4x4_16b_bf16 v[88:91], v[10:11], v[86:87], v[88:91]
    s_nop 4
    v_cvt_pk_bf16_f32 v88, v88, v89
    v_cvt_pk_bf16_f32 v89, v90, v91
    ds_pk_add_bf16 v7, v88 offset:65408
    ds_pk_add_bf16 v7, v89 offset:65412
    s_mov_b64 exec, vcc
    s_branch L2_d153
L2_f3s:
    s_branch L2_f3
.section .rodata,"a"
.p2align 6
.amdhsa_kernel gather_scatter__molecular_angular_gemnet__graph_kernel
  .amdhsa_next_free_vgpr 128
  .amdhsa_next_free_sgpr 102
  .amdhsa_accum_offset 128
  .amdhsa_group_segment_fixed_size 0
  .amdhsa_kernarg_size 112
  .amdhsa_user_sgpr_count 2
  .amdhsa_user_sgpr_kernarg_segment_ptr 1
  .amdhsa_system_sgpr_workgroup_id_x 1
  .amdhsa_float_denorm_mode_32 3
.end_amdhsa_kernel
```

```asm
; @launch grid=(256,1,1) block=(1024,1,1) lds=163840
.amdgcn_target "amdgcn-amd-amdhsa--gfx950"
.text
.globl gather_scatter__molecular_angular_gemnet__graph_kernel
.p2align 8
.type gather_scatter__molecular_angular_gemnet__graph_kernel,@function
gather_scatter__molecular_angular_gemnet__graph_kernel:
    s_cmp_ge_u32 s2, 256
    s_cbranch_scc0 L1_go
    s_endpgm
L1_go:
    s_load_dwordx4 s[4:7], s[0:1], 8
    s_load_dwordx2 s[28:29], s[0:1], 32
    s_load_dwordx2 s[30:31], s[0:1], 104
    s_load_dwordx2 s[56:57], s[0:1], 96
    s_load_dwordx2 s[86:87], s[0:1], 0
    s_load_dwordx4 s[60:63], s[0:1], 56
    s_load_dwordx4 s[64:67], s[0:1], 72
    v_lshrrev_b32 v7, 6, v0
    v_lshlrev_b32 v1, 3, v0
    v_readfirstlane_b32 s32, v7
    v_lshlrev_b32 v0, 4, v0
    v_and_b32 v1, 0x1f8, v1
    v_lshlrev_b32 v15, 1, v1
    s_lshr_b32 s3, s32, 1
    s_and_b32 s44, s32, 1
    s_lshl_b32 s44, s44, 3
    s_or_b32 s3, s3, s44
    s_lshl_b32 s3, s3, 10
    s_lshl_b32 s96, s2, 14
    s_add_u32 s96, s96, s3
    s_lshr_b32 s3, s32, 1
    s_and_b32 s44, s32, 1
    s_lshl_b32 s44, s44, 3
    s_or_b32 s3, s3, s44
    s_lshl_b32 s3, s3, 10
    s_lshl_b32 s97, s2, 14
    s_add_u32 s97, s97, s3
    s_lshr_b32 s3, s32, 1
    s_and_b32 s44, s32, 1
    s_lshl_b32 s44, s44, 3
    s_or_b32 s3, s3, s44
    s_lshl_b32 s3, s3, 10
    s_lshl_b32 s98, s2, 14
    s_add_u32 s98, s98, s3
    s_lshr_b32 s3, s32, 1
    s_and_b32 s44, s32, 1
    s_lshl_b32 s44, s44, 3
    s_or_b32 s3, s3, s44
    s_lshl_b32 s3, s3, 10
    s_lshl_b32 s99, s2, 14
    s_add_u32 s99, s99, s3
    s_waitcnt lgkmcnt(0)
    s_mov_b32 s8, s4
    s_mov_b32 s9, s5
    s_mov_b32 s10, 0x9c40000
    s_mov_b32 s11, 0x20000
    s_mov_b32 s12, s6
    s_mov_b32 s13, s7
    s_mov_b32 s14, 0x9c40000
    s_mov_b32 s15, 0x20000
    s_mov_b32 s16, s28
    s_mov_b32 s17, s29
    s_mov_b32 s18, 0x4e20000
    s_mov_b32 s19, 0x20000
    s_mov_b32 s68, s62
    s_mov_b32 s69, s63
    s_mov_b32 s70, 0x40
    s_mov_b32 s71, 0x20000
    s_mov_b32 s72, s60
    s_mov_b32 s73, s61
    s_mov_b32 s74, 0x40
    s_mov_b32 s75, 0x20000
    s_mov_b32 s20, s66
    s_mov_b32 s21, s67
    s_mov_b32 s22, 0x20
    s_mov_b32 s23, 0x20000
    s_mov_b32 s80, s64
    s_mov_b32 s81, s65
    s_mov_b32 s82, 0x20
    s_mov_b32 s83, 0x20000
    s_add_u32 s24, s30, 0xec45000
    s_addc_u32 s25, s31, 0
    s_mov_b32 s26, 0x100
    s_mov_b32 s27, 0x20000
    v_lshrrev_b32 v2, 3, v0
    v_and_b32 v2, 6, v2
    v_lshlrev_b32 v3, 2, v0
    s_lshl_b32 s3, s32, 8
    s_add_u32 s3, s3, s2
    s_cmp_lg_u32 s3, 254
    s_cbranch_scc1 L1_wt
    buffer_load_ushort v96, v2, s[68:71], 0 offen offset:0
    buffer_load_ushort v108, v2, s[68:71], 0 offen offset:8
    buffer_load_ushort v97, v2, s[68:71], 0 offen offset:16
    buffer_load_ushort v109, v2, s[68:71], 0 offen offset:24
    buffer_load_ushort v98, v2, s[68:71], 0 offen offset:32
    buffer_load_ushort v110, v2, s[68:71], 0 offen offset:40
    buffer_load_ushort v99, v2, s[68:71], 0 offen offset:48
    buffer_load_ushort v111, v2, s[68:71], 0 offen offset:56
    buffer_load_ushort v100, v2, s[72:75], 0 offen offset:0
    buffer_load_ushort v112, v2, s[72:75], 0 offen offset:8
    buffer_load_ushort v101, v2, s[72:75], 0 offen offset:16
    buffer_load_ushort v113, v2, s[72:75], 0 offen offset:24
    buffer_load_ushort v102, v2, s[72:75], 0 offen offset:32
    buffer_load_ushort v114, v2, s[72:75], 0 offen offset:40
    buffer_load_ushort v103, v2, s[72:75], 0 offen offset:48
    buffer_load_ushort v115, v2, s[72:75], 0 offen offset:56
    buffer_load_ushort v104, v2, s[20:23], 0 offen offset:0
    buffer_load_ushort v116, v2, s[20:23], 0 offen offset:8
    buffer_load_ushort v105, v2, s[20:23], 0 offen offset:16
    buffer_load_ushort v117, v2, s[20:23], 0 offen offset:24
    buffer_load_ushort v106, v2, s[80:83], 0 offen offset:0
    buffer_load_ushort v118, v2, s[80:83], 0 offen offset:8
    buffer_load_ushort v107, v2, s[80:83], 0 offen offset:16
    buffer_load_ushort v119, v2, s[80:83], 0 offen offset:24
    s_waitcnt vmcnt(0)
    v_lshl_or_b32 v96, v108, 16, v96
    v_lshl_or_b32 v97, v109, 16, v97
    v_lshl_or_b32 v98, v110, 16, v98
    v_lshl_or_b32 v99, v111, 16, v99
    v_lshl_or_b32 v100, v112, 16, v100
    v_lshl_or_b32 v101, v113, 16, v101
    v_lshl_or_b32 v102, v114, 16, v102
    v_lshl_or_b32 v103, v115, 16, v103
    v_lshl_or_b32 v104, v116, 16, v104
    v_lshl_or_b32 v105, v117, 16, v105
    v_lshl_or_b32 v106, v118, 16, v106
    v_lshl_or_b32 v107, v119, 16, v107
    buffer_store_dwordx4 v[96:99], v3, s[24:27], 0 offen offset:0 sc1
    buffer_store_dwordx4 v[100:103], v3, s[24:27], 0 offen offset:16 sc1
    buffer_store_dwordx4 v[104:107], v3, s[24:27], 0 offen offset:32 sc1
L1_wt:
    s_nop 1
    s_add_u32 s44, s96, 0x0
    v_lshlrev_b32 v16, 1, v1
    buffer_load_dwordx4 v[16:19], v16, s[8:11], s44 offen nt
    s_add_u32 s45, s96, 0x0
    v_lshlrev_b32 v20, 1, v1
    buffer_load_dwordx4 v[20:23], v20, s[12:15], s45 offen nt
    s_add_u32 s46, s96, 0x0
    s_lshr_b32 s46, s46, 1
    buffer_load_dwordx2 v[24:25], v1, s[16:19], s46 offen nt
    s_add_u32 s47, s97, 0x400000
    s_lshr_b32 s47, s47, 1
    buffer_load_dwordx2 v[26:27], v1, s[16:19], s47 offen nt
    s_add_u32 s44, s97, 0x400000
    v_lshlrev_b32 v28, 1, v1
    buffer_load_dwordx4 v[28:31], v28, s[8:11], s44 offen nt
    s_add_u32 s45, s97, 0x400000
    v_lshlrev_b32 v32, 1, v1
    buffer_load_dwordx4 v[32:35], v32, s[12:15], s45 offen nt
    s_add_u32 s46, s98, 0x800000
    v_lshlrev_b32 v36, 1, v1
    buffer_load_dwordx4 v[36:39], v36, s[8:11], s46 offen nt
    s_add_u32 s47, s98, 0x800000
    v_lshlrev_b32 v40, 1, v1
    buffer_load_dwordx4 v[40:43], v40, s[12:15], s47 offen nt
    s_add_u32 s44, s98, 0x800000
    s_lshr_b32 s44, s44, 1
    buffer_load_dwordx2 v[44:45], v1, s[16:19], s44 offen nt
    s_add_u32 s45, s99, 0xc00000
    s_lshr_b32 s45, s45, 1
    buffer_load_dwordx2 v[46:47], v1, s[16:19], s45 offen nt
    s_mov_b32 s20, s30
    s_mov_b32 s21, s31
    s_mov_b32 s22, 0xd344000
    s_mov_b32 s23, 0x20000
    s_add_u32 s24, s30, 0x2c000
    s_addc_u32 s25, s31, 0
    s_mov_b32 s26, 0xd318000
    s_mov_b32 s27, 0x20000
    s_add_u32 s3, s32, 0
    s_mul_i32 s4, s3, 205
    s_lshr_b32 s4, s4, 10
    s_mul_i32 s5, s4, 5
    s_sub_u32 s5, s3, s5
    s_lshl_b32 s5, s5, 5
    s_add_u32 s4, s4, s5
    s_sub_u32 s4, s4, s32
    s_lshl_b32 s72, s4, 10
    s_add_u32 s3, s32, 16
    s_mul_i32 s4, s3, 205
    s_lshr_b32 s4, s4, 10
    s_mul_i32 s5, s4, 5
    s_sub_u32 s5, s3, s5
    s_lshl_b32 s5, s5, 5
    s_add_u32 s4, s4, s5
    s_sub_u32 s4, s4, s32
    s_lshl_b32 s73, s4, 10
    s_add_u32 s3, s32, 32
    s_mul_i32 s4, s3, 205
    s_lshr_b32 s4, s4, 10
    s_mul_i32 s5, s4, 5
    s_sub_u32 s5, s3, s5
    s_lshl_b32 s5, s5, 5
    s_add_u32 s4, s4, s5
    s_sub_u32 s4, s4, s32
    s_lshl_b32 s85, s4, 10
    s_add_u32 s3, s32, 48
    s_mul_i32 s4, s3, 205
    s_lshr_b32 s4, s4, 10
    s_mul_i32 s5, s4, 5
    s_sub_u32 s5, s3, s5
    s_lshl_b32 s5, s5, 5
    s_add_u32 s4, s4, s5
    s_sub_u32 s4, s4, s32
    s_lshl_b32 s91, s4, 10
    s_add_u32 s3, s32, 64
    s_mul_i32 s4, s3, 205
    s_lshr_b32 s4, s4, 10
    s_mul_i32 s5, s4, 5
    s_sub_u32 s5, s3, s5
    s_lshl_b32 s5, s5, 5
    s_add_u32 s4, s4, s5
    s_sub_u32 s4, s4, s32
    s_lshl_b32 s93, s4, 10
    s_mov_b32 s80, s86
    s_mov_b32 s81, s87
    s_mov_b32 s82, 0x4e2000
    s_mov_b32 s83, 0x20000
    s_mul_i32 s35, s2, 173056
    s_and_b32 s37, s32, 3
    s_lshl_b32 s37, s37, 3
    s_mov_b32 s36, s37
    s_lshr_b32 s37, s32, 2
    s_mul_i32 s37, s37, 2080
    s_add_u32 s36, s36, s37
    s_and_b32 s37, s2, 3
    s_lshl_b32 s37, s37, 5
    s_add_u32 s36, s36, s37
    s_mul_i32 s4, s2, 5
    s_add_u32 s4, s4, 8192
    s_lshl_b32 s38, s4, 14
    s_lshl_b32 s39, s4, 13
    v_mov_b32 v2, 1
    v_mov_b32 v4, 0x80000007
    v_mov_b32 v5, 0xfc
    v_mov_b32 v6, 0x78
    s_mov_b32 s40, 16512
    s_mov_b32 s55, -10000
    s_mov_b32 s41, 0x010c0c01
    s_mov_b32 s42, 0x030c0c03
    v_mov_b32 v8, 0
    v_mov_b32 v9, 0
    v_mov_b32 v10, 0
    v_mov_b32 v11, 0
    ds_write_b128 v0, v[8:11]
    s_add_u32 s60, s30, 0xec4e000
    s_addc_u32 s61, s31, 0
    s_mov_b32 s62, 0x8000
    s_mov_b32 s63, 0x20000
    s_mov_b64 s[66:67], s[56:57]
    s_lshl_b32 s57, s2, 7
    s_add_u32 s68, s30, 0xec46000
    s_addc_u32 s69, s31, 0
    s_mov_b32 s70, 0x80
    s_mov_b32 s71, 0x20000
    s_lshl_b32 s3, s2, 7
    s_add_u32 s68, s68, s3
    s_addc_u32 s69, s69, 0
    s_cmp_lg_u32 s32, 0
    s_cbranch_scc1 L1_fl
    buffer_store_dwordx4 v[8:11], v0, s[68:71], 0 offen sc1
    s_mov_b64 exec, 0xff
    buffer_store_dwordx4 v[8:11], v0, s[60:63], s57 offen sc1
    s_mov_b64 exec, -1
L1_fl:
    s_waitcnt lgkmcnt(0)
    s_barrier
    s_setprio 3
    s_add_u32 s46, s99, 0xc00000
    v_lshlrev_b32 v48, 1, v1
    buffer_load_dwordx4 v[48:51], v48, s[8:11], s46 offen nt
    s_add_u32 s47, s99, 0xc00000
    v_lshlrev_b32 v52, 1, v1
    buffer_load_dwordx4 v[52:55], v52, s[12:15], s47 offen nt
    s_waitcnt vmcnt(8)
    v_lshlrev_b32 v7, 16, v24
    v_and_b32 v8, 0xffff0000, v24
    v_lshlrev_b32 v9, 16, v25
    v_and_b32 v10, 0xffff0000, v25
    v_mul_f32 v7, 0.15915494, v7
    v_mul_f32 v8, 0.15915494, v8
    v_mul_f32 v9, 0.15915494, v9
    v_mul_f32 v10, 0.15915494, v10
    v_mul_hi_u32_u24 v14, 429497, v16
    v_lshrrev_b32 v12, 3, v20
    v_cos_f32 v7, v7
    v_lshlrev_b16 v13, 3, v20
    v_mad_i32_i24 v11, v14, s55, v16
    v_bitop3_b32 v12, v6, v13, v12 bitop3:0xca
    v_lshl_add_u32 v11, v11, 17, s40
    v_lshlrev_b16 v14, 8, v14
    v_lshrrev_b32 v13, 2, v20
    v_add_u32 v16, v12, v11
    v_bitop3_b32 v20, v5, v13, v14 bitop3:0xea
    ds_add_u32 v20, v2
    v_mul_hi_u32_u24 v14, 429497, v17
    v_lshrrev_b32 v12, 3, v21
    v_cos_f32 v8, v8
    v_lshlrev_b16 v13, 3, v21
    v_mad_i32_i24 v11, v14, s55, v17
    v_bitop3_b32 v12, v6, v13, v12 bitop3:0xca
    v_lshl_add_u32 v11, v11, 17, s40
    v_lshlrev_b16 v14, 8, v14
    v_lshrrev_b32 v13, 2, v21
    v_add_u32 v17, v12, v11
    v_bitop3_b32 v21, v5, v13, v14 bitop3:0xea
    ds_add_u32 v21, v2
    v_cvt_pk_bf16_f32 v24, v7, v8
    v_perm_b32 v12, v24, v24, s41
    v_bitop3_b32 v16, v4, v12, v16 bitop3:0xca
    v_perm_b32 v13, v24, v24, s42
    v_bitop3_b32 v17, v4, v13, v17 bitop3:0xca
    v_mul_hi_u32_u24 v14, 429497, v18
    v_lshrrev_b32 v12, 3, v22
    v_cos_f32 v9, v9
    v_lshlrev_b16 v13, 3, v22
    v_mad_i32_i24 v11, v14, s55, v18
    v_bitop3_b32 v12, v6, v13, v12 bitop3:0xca
    v_lshl_add_u32 v11, v11, 17, s40
    v_lshlrev_b16 v14, 8, v14
    v_lshrrev_b32 v13, 2, v22
    v_add_u32 v18, v12, v11
    v_bitop3_b32 v22, v5, v13, v14 bitop3:0xea
    ds_add_u32 v22, v2
    v_mul_hi_u32_u24 v14, 429497, v19
    v_lshrrev_b32 v12, 3, v23
    v_cos_f32 v10, v10
    v_lshlrev_b16 v13, 3, v23
    v_mad_i32_i24 v11, v14, s55, v19
    v_bitop3_b32 v12, v6, v13, v12 bitop3:0xca
    v_lshl_add_u32 v11, v11, 17, s40
    v_lshlrev_b16 v14, 8, v14
    v_lshrrev_b32 v13, 2, v23
    v_add_u32 v19, v12, v11
    v_bitop3_b32 v23, v5, v13, v14 bitop3:0xea
    ds_add_u32 v23, v2
    v_cvt_pk_bf16_f32 v25, v9, v10
    v_perm_b32 v12, v25, v25, s41
    v_bitop3_b32 v18, v4, v12, v18 bitop3:0xca
    v_perm_b32 v13, v25, v25, s42
    v_bitop3_b32 v19, v4, v13, v19 bitop3:0xca
    s_add_u32 s44, s96, 0x1000000
    v_lshlrev_b32 v56, 1, v1
    buffer_load_dwordx4 v[56:59], v56, s[8:11], s44 offen nt
    s_add_u32 s45, s96, 0x1000000
    v_lshlrev_b32 v60, 1, v1
    buffer_load_dwordx4 v[60:63], v60, s[12:15], s45 offen nt
    s_add_u32 s46, s96, 0x1000000
    s_lshr_b32 s46, s46, 1
    buffer_load_dwordx2 v[64:65], v1, s[16:19], s46 offen nt
    s_add_u32 s47, s97, 0x1400000
    s_lshr_b32 s47, s47, 1
    buffer_load_dwordx2 v[66:67], v1, s[16:19], s47 offen nt
    s_waitcnt vmcnt(10)
    v_lshlrev_b32 v7, 16, v26
    v_and_b32 v8, 0xffff0000, v26
    v_lshlrev_b32 v9, 16, v27
    v_and_b32 v10, 0xffff0000, v27
    v_mul_f32 v7, 0.15915494, v7
    v_mul_f32 v8, 0.15915494, v8
    v_mul_f32 v9, 0.15915494, v9
    v_mul_f32 v10, 0.15915494, v10
    v_mul_hi_u32_u24 v14, 429497, v28
    v_lshrrev_b32 v12, 3, v32
    v_cos_f32 v7, v7
    v_lshlrev_b16 v13, 3, v32
    v_mad_i32_i24 v11, v14, s55, v28
    v_bitop3_b32 v12, v6, v13, v12 bitop3:0xca
    v_lshl_add_u32 v11, v11, 17, s40
    v_lshlrev_b16 v14, 8, v14
    v_lshrrev_b32 v13, 2, v32
    v_add_u32 v28, v12, v11
    v_bitop3_b32 v32, v5, v13, v14 bitop3:0xea
    ds_add_u32 v32, v2
    v_mul_hi_u32_u24 v14, 429497, v29
    v_lshrrev_b32 v12, 3, v33
    v_cos_f32 v8, v8
    v_lshlrev_b16 v13, 3, v33
    v_mad_i32_i24 v11, v14, s55, v29
    v_bitop3_b32 v12, v6, v13, v12 bitop3:0xca
    v_lshl_add_u32 v11, v11, 17, s40
    v_lshlrev_b16 v14, 8, v14
    v_lshrrev_b32 v13, 2, v33
    v_add_u32 v29, v12, v11
    v_bitop3_b32 v33, v5, v13, v14 bitop3:0xea
    ds_add_u32 v33, v2
    v_cvt_pk_bf16_f32 v26, v7, v8
    v_perm_b32 v12, v26, v26, s41
    v_bitop3_b32 v28, v4, v12, v28 bitop3:0xca
    v_perm_b32 v13, v26, v26, s42
    v_bitop3_b32 v29, v4, v13, v29 bitop3:0xca
    v_mul_hi_u32_u24 v14, 429497, v30
    v_lshrrev_b32 v12, 3, v34
    v_cos_f32 v9, v9
    v_lshlrev_b16 v13, 3, v34
    v_mad_i32_i24 v11, v14, s55, v30
    v_bitop3_b32 v12, v6, v13, v12 bitop3:0xca
    v_lshl_add_u32 v11, v11, 17, s40
    v_lshlrev_b16 v14, 8, v14
    v_lshrrev_b32 v13, 2, v34
    v_add_u32 v30, v12, v11
    v_bitop3_b32 v34, v5, v13, v14 bitop3:0xea
    ds_add_u32 v34, v2
    v_mul_hi_u32_u24 v14, 429497, v31
    v_lshrrev_b32 v12, 3, v35
    v_cos_f32 v10, v10
    v_lshlrev_b16 v13, 3, v35
    v_mad_i32_i24 v11, v14, s55, v31
    v_bitop3_b32 v12, v6, v13, v12 bitop3:0xca
    v_lshl_add_u32 v11, v11, 17, s40
    v_lshlrev_b16 v14, 8, v14
    v_lshrrev_b32 v13, 2, v35
    v_add_u32 v31, v12, v11
    v_bitop3_b32 v35, v5, v13, v14 bitop3:0xea
    ds_add_u32 v35, v2
    v_cvt_pk_bf16_f32 v27, v9, v10
    v_perm_b32 v12, v27, v27, s41
    v_bitop3_b32 v30, v4, v12, v30 bitop3:0xca
    v_perm_b32 v13, v27, v27, s42
    v_bitop3_b32 v31, v4, v13, v31 bitop3:0xca
    s_setprio 2
    s_add_u32 s44, s97, 0x1400000
    v_lshlrev_b32 v68, 1, v1
    buffer_load_dwordx4 v[68:71], v68, s[8:11], s44 offen nt
    s_add_u32 s45, s97, 0x1400000
    v_lshlrev_b32 v72, 1, v1
    buffer_load_dwordx4 v[72:75], v72, s[12:15], s45 offen nt
    s_waitcnt vmcnt(8)
    v_lshlrev_b32 v7, 16, v44
    v_and_b32 v8, 0xffff0000, v44
    v_lshlrev_b32 v9, 16, v45
    v_and_b32 v10, 0xffff0000, v45
    v_mul_f32 v7, 0.15915494, v7
    v_mul_f32 v8, 0.15915494, v8
    v_mul_f32 v9, 0.15915494, v9
    v_mul_f32 v10, 0.15915494, v10
    v_mul_hi_u32_u24 v14, 429497, v36
    v_lshrrev_b32 v12, 3, v40
    v_cos_f32 v7, v7
    v_lshlrev_b16 v13, 3, v40
    v_mad_i32_i24 v11, v14, s55, v36
    v_bitop3_b32 v12, v6, v13, v12 bitop3:0xca
    v_lshl_add_u32 v11, v11, 17, s40
    v_lshlrev_b16 v14, 8, v14
    v_lshrrev_b32 v13, 2, v40
    v_add_u32 v36, v12, v11
    v_bitop3_b32 v40, v5, v13, v14 bitop3:0xea
    ds_add_u32 v40, v2
    v_mul_hi_u32_u24 v14, 429497, v37
    v_lshrrev_b32 v12, 3, v41
    v_cos_f32 v8, v8
    v_lshlrev_b16 v13, 3, v41
    v_mad_i32_i24 v11, v14, s55, v37
    v_bitop3_b32 v12, v6, v13, v12 bitop3:0xca
    v_lshl_add_u32 v11, v11, 17, s40
    v_lshlrev_b16 v14, 8, v14
    v_lshrrev_b32 v13, 2, v41
    v_add_u32 v37, v12, v11
    v_bitop3_b32 v41, v5, v13, v14 bitop3:0xea
    ds_add_u32 v41, v2
    v_cvt_pk_bf16_f32 v44, v7, v8
    v_perm_b32 v12, v44, v44, s41
    v_bitop3_b32 v36, v4, v12, v36 bitop3:0xca
    v_perm_b32 v13, v44, v44, s42
    v_bitop3_b32 v37, v4, v13, v37 bitop3:0xca
    v_mul_hi_u32_u24 v14, 429497, v38
    v_lshrrev_b32 v12, 3, v42
    v_cos_f32 v9, v9
    v_lshlrev_b16 v13, 3, v42
    v_mad_i32_i24 v11, v14, s55, v38
    v_bitop3_b32 v12, v6, v13, v12 bitop3:0xca
    v_lshl_add_u32 v11, v11, 17, s40
    v_lshlrev_b16 v14, 8, v14
    v_lshrrev_b32 v13, 2, v42
    v_add_u32 v38, v12, v11
    v_bitop3_b32 v42, v5, v13, v14 bitop3:0xea
    ds_add_u32 v42, v2
    v_mul_hi_u32_u24 v14, 429497, v39
    v_lshrrev_b32 v12, 3, v43
    v_cos_f32 v10, v10
    v_lshlrev_b16 v13, 3, v43
    v_mad_i32_i24 v11, v14, s55, v39
    v_bitop3_b32 v12, v6, v13, v12 bitop3:0xca
    v_lshl_add_u32 v11, v11, 17, s40
    v_lshlrev_b16 v14, 8, v14
    v_lshrrev_b32 v13, 2, v43
    v_add_u32 v39, v12, v11
    v_bitop3_b32 v43, v5, v13, v14 bitop3:0xea
    ds_add_u32 v43, v2
    v_cvt_pk_bf16_f32 v45, v9, v10
    v_perm_b32 v12, v45, v45, s41
    v_bitop3_b32 v38, v4, v12, v38 bitop3:0xca
    v_perm_b32 v13, v45, v45, s42
    v_bitop3_b32 v39, v4, v13, v39 bitop3:0xca
    s_add_u32 s46, s98, 0x1800000
    v_lshlrev_b32 v76, 1, v1
    buffer_load_dwordx4 v[76:79], v76, s[8:11], s46 offen nt
    s_add_u32 s47, s98, 0x1800000
    v_lshlrev_b32 v80, 1, v1
    buffer_load_dwordx4 v[80:83], v80, s[12:15], s47 offen nt
    s_add_u32 s44, s98, 0x1800000
    s_lshr_b32 s44, s44, 1
    buffer_load_dwordx2 v[84:85], v1, s[16:19], s44 offen nt
    s_add_u32 s45, s99, 0x1c00000
    s_lshr_b32 s45, s45, 1
    buffer_load_dwordx2 v[86:87], v1, s[16:19], s45 offen nt
    s_waitcnt vmcnt(10)
    v_lshlrev_b32 v7, 16, v46
    v_and_b32 v8, 0xffff0000, v46
    v_lshlrev_b32 v9, 16, v47
    v_and_b32 v10, 0xffff0000, v47
    v_mul_f32 v7, 0.15915494, v7
    v_mul_f32 v8, 0.15915494, v8
    v_mul_f32 v9, 0.15915494, v9
    v_mul_f32 v10, 0.15915494, v10
    v_mul_hi_u32_u24 v14, 429497, v48
    v_lshrrev_b32 v12, 3, v52
    v_cos_f32 v7, v7
    v_lshlrev_b16 v13, 3, v52
    v_mad_i32_i24 v11, v14, s55, v48
    v_bitop3_b32 v12, v6, v13, v12 bitop3:0xca
    v_lshl_add_u32 v11, v11, 17, s40
    v_lshlrev_b16 v14, 8, v14
    v_lshrrev_b32 v13, 2, v52
    v_add_u32 v48, v12, v11
    v_bitop3_b32 v52, v5, v13, v14 bitop3:0xea
    ds_add_u32 v52, v2
    v_mul_hi_u32_u24 v14, 429497, v49
    v_lshrrev_b32 v12, 3, v53
    v_cos_f32 v8, v8
    v_lshlrev_b16 v13, 3, v53
    v_mad_i32_i24 v11, v14, s55, v49
    v_bitop3_b32 v12, v6, v13, v12 bitop3:0xca
    v_lshl_add_u32 v11, v11, 17, s40
    v_lshlrev_b16 v14, 8, v14
    v_lshrrev_b32 v13, 2, v53
    v_add_u32 v49, v12, v11
    v_bitop3_b32 v53, v5, v13, v14 bitop3:0xea
    ds_add_u32 v53, v2
    v_cvt_pk_bf16_f32 v46, v7, v8
    v_perm_b32 v12, v46, v46, s41
    v_bitop3_b32 v48, v4, v12, v48 bitop3:0xca
    v_perm_b32 v13, v46, v46, s42
    v_bitop3_b32 v49, v4, v13, v49 bitop3:0xca
    v_mul_hi_u32_u24 v14, 429497, v50
    v_lshrrev_b32 v12, 3, v54
    v_cos_f32 v9, v9
    v_lshlrev_b16 v13, 3, v54
    v_mad_i32_i24 v11, v14, s55, v50
    v_bitop3_b32 v12, v6, v13, v12 bitop3:0xca
    v_lshl_add_u32 v11, v11, 17, s40
    v_lshlrev_b16 v14, 8, v14
    v_lshrrev_b32 v13, 2, v54
    v_add_u32 v50, v12, v11
    v_bitop3_b32 v54, v5, v13, v14 bitop3:0xea
    ds_add_u32 v54, v2
    v_mul_hi_u32_u24 v14, 429497, v51
    v_lshrrev_b32 v12, 3, v55
    v_cos_f32 v10, v10
    v_lshlrev_b16 v13, 3, v55
    v_mad_i32_i24 v11, v14, s55, v51
    v_bitop3_b32 v12, v6, v13, v12 bitop3:0xca
    v_lshl_add_u32 v11, v11, 17, s40
    v_lshlrev_b16 v14, 8, v14
    v_lshrrev_b32 v13, 2, v55
    v_add_u32 v51, v12, v11
    v_bitop3_b32 v55, v5, v13, v14 bitop3:0xea
    ds_add_u32 v55, v2
    v_cvt_pk_bf16_f32 v47, v9, v10
    v_perm_b32 v12, v47, v47, s41
    v_bitop3_b32 v50, v4, v12, v50 bitop3:0xca
    v_perm_b32 v13, v47, v47, s42
    v_bitop3_b32 v51, v4, v13, v51 bitop3:0xca
    s_setprio 1
    s_add_u32 s46, s99, 0x1c00000
    v_lshlrev_b32 v88, 1, v1
    buffer_load_dwordx4 v[88:91], v88, s[8:11], s46 offen nt
    s_add_u32 s47, s99, 0x1c00000
    v_lshlrev_b32 v92, 1, v1
    buffer_load_dwordx4 v[92:95], v92, s[12:15], s47 offen nt
    s_waitcnt vmcnt(8)
    v_lshlrev_b32 v7, 16, v64
    v_and_b32 v8, 0xffff0000, v64
    v_lshlrev_b32 v9, 16, v65
    v_and_b32 v10, 0xffff0000, v65
    v_mul_f32 v7, 0.15915494, v7
    v_mul_f32 v8, 0.15915494, v8
    v_mul_f32 v9, 0.15915494, v9
    v_mul_f32 v10, 0.15915494, v10
    v_mul_hi_u32_u24 v14, 429497, v56
    v_lshrrev_b32 v12, 3, v60
    v_cos_f32 v7, v7
    v_lshlrev_b16 v13, 3, v60
    v_mad_i32_i24 v11, v14, s55, v56
    v_bitop3_b32 v12, v6, v13, v12 bitop3:0xca
    v_lshl_add_u32 v11, v11, 17, s40
    v_lshlrev_b16 v14, 8, v14
    v_lshrrev_b32 v13, 2, v60
    v_add_u32 v56, v12, v11
    v_bitop3_b32 v60, v5, v13, v14 bitop3:0xea
    ds_add_u32 v60, v2
    v_mul_hi_u32_u24 v14, 429497, v57
    v_lshrrev_b32 v12, 3, v61
    v_cos_f32 v8, v8
    v_lshlrev_b16 v13, 3, v61
    v_mad_i32_i24 v11, v14, s55, v57
    v_bitop3_b32 v12, v6, v13, v12 bitop3:0xca
    v_lshl_add_u32 v11, v11, 17, s40
    v_lshlrev_b16 v14, 8, v14
    v_lshrrev_b32 v13, 2, v61
    v_add_u32 v57, v12, v11
    v_bitop3_b32 v61, v5, v13, v14 bitop3:0xea
    ds_add_u32 v61, v2
    v_cvt_pk_bf16_f32 v64, v7, v8
    v_perm_b32 v12, v64, v64, s41
    v_bitop3_b32 v56, v4, v12, v56 bitop3:0xca
    v_perm_b32 v13, v64, v64, s42
    v_bitop3_b32 v57, v4, v13, v57 bitop3:0xca
    v_mul_hi_u32_u24 v14, 429497, v58
    v_lshrrev_b32 v12, 3, v62
    v_cos_f32 v9, v9
    v_lshlrev_b16 v13, 3, v62
    v_mad_i32_i24 v11, v14, s55, v58
    v_bitop3_b32 v12, v6, v13, v12 bitop3:0xca
    v_lshl_add_u32 v11, v11, 17, s40
    v_lshlrev_b16 v14, 8, v14
    v_lshrrev_b32 v13, 2, v62
    v_add_u32 v58, v12, v11
    v_bitop3_b32 v62, v5, v13, v14 bitop3:0xea
    ds_add_u32 v62, v2
    v_mul_hi_u32_u24 v14, 429497, v59
    v_lshrrev_b32 v12, 3, v63
    v_cos_f32 v10, v10
    v_lshlrev_b16 v13, 3, v63
    v_mad_i32_i24 v11, v14, s55, v59
    v_bitop3_b32 v12, v6, v13, v12 bitop3:0xca
    v_lshl_add_u32 v11, v11, 17, s40
    v_lshlrev_b16 v14, 8, v14
    v_lshrrev_b32 v13, 2, v63
    v_add_u32 v59, v12, v11
    v_bitop3_b32 v63, v5, v13, v14 bitop3:0xea
    ds_add_u32 v63, v2
    v_cvt_pk_bf16_f32 v65, v9, v10
    v_perm_b32 v12, v65, v65, s41
    v_bitop3_b32 v58, v4, v12, v58 bitop3:0xca
    v_perm_b32 v13, v65, v65, s42
    v_bitop3_b32 v59, v4, v13, v59 bitop3:0xca
    s_add_u32 s44, s96, 0x2000000
    v_lshlrev_b32 v96, 1, v1
    buffer_load_dwordx4 v[96:99], v96, s[8:11], s44 offen nt
    s_add_u32 s45, s96, 0x2000000
    v_lshlrev_b32 v104, 1, v1
    buffer_load_dwordx4 v[104:107], v104, s[12:15], s45 offen nt
    s_add_u32 s46, s96, 0x2000000
    s_lshr_b32 s46, s46, 1
    buffer_load_dwordx2 v[108:109], v1, s[16:19], s46 offen nt
    s_add_u32 s47, s97, 0x2400000
    s_lshr_b32 s47, s47, 1
    buffer_load_dwordx2 v[110:111], v1, s[16:19], s47 offen nt
    s_waitcnt vmcnt(10)
    v_lshlrev_b32 v7, 16, v66
    v_and_b32 v8, 0xffff0000, v66
    v_lshlrev_b32 v9, 16, v67
    v_and_b32 v10, 0xffff0000, v67
    v_mul_f32 v7, 0.15915494, v7
    v_mul_f32 v8, 0.15915494, v8
    v_mul_f32 v9, 0.15915494, v9
    v_mul_f32 v10, 0.15915494, v10
    v_mul_hi_u32_u24 v14, 429497, v68
    v_lshrrev_b32 v12, 3, v72
    v_cos_f32 v7, v7
    v_lshlrev_b16 v13, 3, v72
    v_mad_i32_i24 v11, v14, s55, v68
    v_bitop3_b32 v12, v6, v13, v12 bitop3:0xca
    v_lshl_add_u32 v11, v11, 17, s40
    v_lshlrev_b16 v14, 8, v14
    v_lshrrev_b32 v13, 2, v72
    v_add_u32 v68, v12, v11
    v_bitop3_b32 v72, v5, v13, v14 bitop3:0xea
    ds_add_u32 v72, v2
    v_mul_hi_u32_u24 v14, 429497, v69
    v_lshrrev_b32 v12, 3, v73
    v_cos_f32 v8, v8
    v_lshlrev_b16 v13, 3, v73
    v_mad_i32_i24 v11, v14, s55, v69
    v_bitop3_b32 v12, v6, v13, v12 bitop3:0xca
    v_lshl_add_u32 v11, v11, 17, s40
    v_lshlrev_b16 v14, 8, v14
    v_lshrrev_b32 v13, 2, v73
    v_add_u32 v69, v12, v11
    v_bitop3_b32 v73, v5, v13, v14 bitop3:0xea
    ds_add_u32 v73, v2
    v_cvt_pk_bf16_f32 v66, v7, v8
    v_perm_b32 v12, v66, v66, s41
    v_bitop3_b32 v68, v4, v12, v68 bitop3:0xca
    v_perm_b32 v13, v66, v66, s42
    v_bitop3_b32 v69, v4, v13, v69 bitop3:0xca
    v_mul_hi_u32_u24 v14, 429497, v70
    v_lshrrev_b32 v12, 3, v74
    v_cos_f32 v9, v9
    v_lshlrev_b16 v13, 3, v74
    v_mad_i32_i24 v11, v14, s55, v70
    v_bitop3_b32 v12, v6, v13, v12 bitop3:0xca
    v_lshl_add_u32 v11, v11, 17, s40
    v_lshlrev_b16 v14, 8, v14
    v_lshrrev_b32 v13, 2, v74
    v_add_u32 v70, v12, v11
    v_bitop3_b32 v74, v5, v13, v14 bitop3:0xea
    ds_add_u32 v74, v2
    v_mul_hi_u32_u24 v14, 429497, v71
    v_lshrrev_b32 v12, 3, v75
    v_cos_f32 v10, v10
    v_lshlrev_b16 v13, 3, v75
    v_mad_i32_i24 v11, v14, s55, v71
    v_bitop3_b32 v12, v6, v13, v12 bitop3:0xca
    v_lshl_add_u32 v11, v11, 17, s40
    v_lshlrev_b16 v14, 8, v14
    v_lshrrev_b32 v13, 2, v75
    v_add_u32 v71, v12, v11
    v_bitop3_b32 v75, v5, v13, v14 bitop3:0xea
    ds_add_u32 v75, v2
    v_cvt_pk_bf16_f32 v67, v9, v10
    v_perm_b32 v12, v67, v67, s41
    v_bitop3_b32 v70, v4, v12, v70 bitop3:0xca
    v_perm_b32 v13, v67, v67, s42
    v_bitop3_b32 v71, v4, v13, v71 bitop3:0xca
    s_setprio 0
    s_add_u32 s44, s97, 0x2400000
    v_lshlrev_b32 v100, 1, v1
    buffer_load_dwordx4 v[100:103], v100, s[8:11], s44 offen nt
    s_waitcnt vmcnt(7)
    v_lshlrev_b32 v7, 16, v84
    v_and_b32 v8, 0xffff0000, v84
    v_lshlrev_b32 v9, 16, v85
    v_and_b32 v10, 0xffff0000, v85
    v_mul_f32 v7, 0.15915494, v7
    v_mul_f32 v8, 0.15915494, v8
    v_mul_f32 v9, 0.15915494, v9
    v_mul_f32 v10, 0.15915494, v10
    v_mul_hi_u32_u24 v14, 429497, v76
    v_lshrrev_b32 v12, 3, v80
    v_cos_f32 v7, v7
    v_lshlrev_b16 v13, 3, v80
    v_mad_i32_i24 v11, v14, s55, v76
    v_bitop3_b32 v12, v6, v13, v12 bitop3:0xca
    v_lshl_add_u32 v11, v11, 17, s40
    v_lshlrev_b16 v14, 8, v14
    v_lshrrev_b32 v13, 2, v80
    v_add_u32 v76, v12, v11
    v_bitop3_b32 v80, v5, v13, v14 bitop3:0xea
    ds_add_u32 v80, v2
    v_mul_hi_u32_u24 v14, 429497, v77
    v_lshrrev_b32 v12, 3, v81
    v_cos_f32 v8, v8
    v_lshlrev_b16 v13, 3, v81
    v_mad_i32_i24 v11, v14, s55, v77
    v_bitop3_b32 v12, v6, v13, v12 bitop3:0xca
    v_lshl_add_u32 v11, v11, 17, s40
    v_lshlrev_b16 v14, 8, v14
    v_lshrrev_b32 v13, 2, v81
    v_add_u32 v77, v12, v11
    v_bitop3_b32 v81, v5, v13, v14 bitop3:0xea
    ds_add_u32 v81, v2
    v_cvt_pk_bf16_f32 v84, v7, v8
    v_perm_b32 v12, v84, v84, s41
    v_bitop3_b32 v76, v4, v12, v76 bitop3:0xca
    v_perm_b32 v13, v84, v84, s42
    v_bitop3_b32 v77, v4, v13, v77 bitop3:0xca
    v_mul_hi_u32_u24 v14, 429497, v78
    v_lshrrev_b32 v12, 3, v82
    v_cos_f32 v9, v9
    v_lshlrev_b16 v13, 3, v82
    v_mad_i32_i24 v11, v14, s55, v78
    v_bitop3_b32 v12, v6, v13, v12 bitop3:0xca
    v_lshl_add_u32 v11, v11, 17, s40
    v_lshlrev_b16 v14, 8, v14
    v_lshrrev_b32 v13, 2, v82
    v_add_u32 v78, v12, v11
    v_bitop3_b32 v82, v5, v13, v14 bitop3:0xea
    ds_add_u32 v82, v2
    v_mul_hi_u32_u24 v14, 429497, v79
    v_lshrrev_b32 v12, 3, v83
    v_cos_f32 v10, v10
    v_lshlrev_b16 v13, 3, v83
    v_mad_i32_i24 v11, v14, s55, v79
    v_bitop3_b32 v12, v6, v13, v12 bitop3:0xca
    v_lshl_add_u32 v11, v11, 17, s40
    v_lshlrev_b16 v14, 8, v14
    v_lshrrev_b32 v13, 2, v83
    v_add_u32 v79, v12, v11
    v_bitop3_b32 v83, v5, v13, v14 bitop3:0xea
    ds_add_u32 v83, v2
    v_cvt_pk_bf16_f32 v85, v9, v10
    v_perm_b32 v12, v85, v85, s41
    v_bitop3_b32 v78, v4, v12, v78 bitop3:0xca
    v_perm_b32 v13, v85, v85, s42
    v_bitop3_b32 v79, v4, v13, v79 bitop3:0xca
    s_waitcnt vmcnt(5)
    v_lshlrev_b32 v7, 16, v86
    v_and_b32 v8, 0xffff0000, v86
    v_lshlrev_b32 v9, 16, v87
    v_and_b32 v10, 0xffff0000, v87
    v_mul_f32 v7, 0.15915494, v7
    v_mul_f32 v8, 0.15915494, v8
    v_mul_f32 v9, 0.15915494, v9
    v_mul_f32 v10, 0.15915494, v10
    v_mul_hi_u32_u24 v14, 429497, v88
    v_lshrrev_b32 v12, 3, v92
    v_cos_f32 v7, v7
    v_lshlrev_b16 v13, 3, v92
    v_mad_i32_i24 v11, v14, s55, v88
    v_bitop3_b32 v12, v6, v13, v12 bitop3:0xca
    v_lshl_add_u32 v11, v11, 17, s40
    v_lshlrev_b16 v14, 8, v14
    v_lshrrev_b32 v13, 2, v92
    v_add_u32 v88, v12, v11
    v_bitop3_b32 v92, v5, v13, v14 bitop3:0xea
    ds_add_u32 v92, v2
    v_mul_hi_u32_u24 v14, 429497, v89
    v_lshrrev_b32 v12, 3, v93
    v_cos_f32 v8, v8
    v_lshlrev_b16 v13, 3, v93
    v_mad_i32_i24 v11, v14, s55, v89
    v_bitop3_b32 v12, v6, v13, v12 bitop3:0xca
    v_lshl_add_u32 v11, v11, 17, s40
    v_lshlrev_b16 v14, 8, v14
    v_lshrrev_b32 v13, 2, v93
    v_add_u32 v89, v12, v11
    v_bitop3_b32 v93, v5, v13, v14 bitop3:0xea
    ds_add_u32 v93, v2
    v_cvt_pk_bf16_f32 v86, v7, v8
    v_perm_b32 v12, v86, v86, s41
    v_bitop3_b32 v88, v4, v12, v88 bitop3:0xca
    v_perm_b32 v13, v86, v86, s42
    v_bitop3_b32 v89, v4, v13, v89 bitop3:0xca
    v_mul_hi_u32_u24 v14, 429497, v90
    v_lshrrev_b32 v12, 3, v94
    v_cos_f32 v9, v9
    v_lshlrev_b16 v13, 3, v94
    v_mad_i32_i24 v11, v14, s55, v90
    v_bitop3_b32 v12, v6, v13, v12 bitop3:0xca
    v_lshl_add_u32 v11, v11, 17, s40
    v_lshlrev_b16 v14, 8, v14
    v_lshrrev_b32 v13, 2, v94
    v_add_u32 v90, v12, v11
    v_bitop3_b32 v94, v5, v13, v14 bitop3:0xea
    ds_add_u32 v94, v2
    v_mul_hi_u32_u24 v14, 429497, v91
    v_lshrrev_b32 v12, 3, v95
    v_cos_f32 v10, v10
    v_lshlrev_b16 v13, 3, v95
    v_mad_i32_i24 v11, v14, s55, v91
    v_bitop3_b32 v12, v6, v13, v12 bitop3:0xca
    v_lshl_add_u32 v11, v11, 17, s40
    v_lshlrev_b16 v14, 8, v14
    v_lshrrev_b32 v13, 2, v95
    v_add_u32 v91, v12, v11
    v_bitop3_b32 v95, v5, v13, v14 bitop3:0xea
    ds_add_u32 v95, v2
    v_cvt_pk_bf16_f32 v87, v9, v10
    v_perm_b32 v12, v87, v87, s41
    v_bitop3_b32 v90, v4, v12, v90 bitop3:0xca
    v_perm_b32 v13, v87, v87, s42
    v_bitop3_b32 v91, v4, v13, v91 bitop3:0xca
    v_lshrrev_b32 v8, 2, v0
    v_and_b32 v7, 0x3c00, v0
    v_bitop3_b32 v7, v5, v8, v7 bitop3:0xea
    s_waitcnt lgkmcnt(0)
    s_barrier
    ds_read2st64_b32 v[8:9], v7 offset0:0 offset1:1
    ds_read2st64_b32 v[10:11], v7 offset0:2 offset1:3
    s_add_u32 s45, s97, 0x2400000
    v_lshlrev_b32 v112, 1, v1
    buffer_load_dwordx4 v[112:115], v112, s[12:15], s45 offen nt
    s_waitcnt lgkmcnt(0)
    v_lshl_or_b32 v12, v9, 16, v8
    v_lshl_or_b32 v13, v11, 16, v10
    v_mov_b32 v14, v12
    v_mov_b32 v15, v13
    s_nop 0
    v_add_u32_dpp v14, v14, v14 row_shr:1 row_mask:0xf bank_mask:0xf bound_ctrl:1
    v_add_u32_dpp v15, v15, v15 row_shr:1 row_mask:0xf bank_mask:0xf bound_ctrl:1
    s_nop 0
    v_add_u32_dpp v14, v14, v14 row_shr:2 row_mask:0xf bank_mask:0xf bound_ctrl:1
    v_add_u32_dpp v15, v15, v15 row_shr:2 row_mask:0xf bank_mask:0xf bound_ctrl:1
    s_nop 0
    v_add_u32_dpp v14, v14, v14 row_shr:4 row_mask:0xf bank_mask:0xf bound_ctrl:1
    v_add_u32_dpp v15, v15, v15 row_shr:4 row_mask:0xf bank_mask:0xf bound_ctrl:1
    s_nop 0
    v_add_u32_dpp v14, v14, v14 row_shr:8 row_mask:0xf bank_mask:0xf bound_ctrl:1
    v_add_u32_dpp v15, v15, v15 row_shr:8 row_mask:0xf bank_mask:0xf bound_ctrl:1
    s_nop 0
    v_add_u32_dpp v14, v14, v14 row_bcast:15 row_mask:0xa bank_mask:0xf
    v_add_u32_dpp v15, v15, v15 row_bcast:15 row_mask:0xa bank_mask:0xf
    s_nop 0
    v_add_u32_dpp v14, v14, v14 row_bcast:31 row_mask:0xc bank_mask:0xf
    v_add_u32_dpp v15, v15, v15 row_bcast:31 row_mask:0xc bank_mask:0xf
    v_readlane_b32 s48, v14, 63
    v_readlane_b32 s49, v15, 63
    s_lshl_b32 s54, s32, 2
    v_mov_b32 v8, s54
    s_and_b32 s50, s48, 0xffff
    s_lshr_b32 s51, s48, 16
    s_and_b32 s52, s49, 0xffff
    s_lshr_b32 s53, s49, 16
    s_add_u32 s51, s51, s50
    s_add_u32 s52, s52, s51
    s_add_u32 s53, s53, s52
    v_mov_b32 v9, s53
    s_mov_b64 exec, 1
    ds_write_b32 v8, v9 offset:16384
    s_mov_b64 exec, -1
    v_and_b32 v8, 60, v7
    s_waitcnt lgkmcnt(0)
    s_barrier
    ds_read_b32 v9, v8 offset:16384
    s_waitcnt lgkmcnt(0)
    v_add_u32_dpp v9, v9, v9 row_shr:1 row_mask:0xf bank_mask:0xf bound_ctrl:1
    s_nop 1
    v_add_u32_dpp v9, v9, v9 row_shr:2 row_mask:0xf bank_mask:0xf bound_ctrl:1
    s_nop 1
    v_add_u32_dpp v9, v9, v9 row_shr:4 row_mask:0xf bank_mask:0xf bound_ctrl:1
    s_nop 1
    v_add_u32_dpp v9, v9, v9 row_shr:8 row_mask:0xf bank_mask:0xf bound_ctrl:1
    s_nop 0
    v_readlane_b32 s54, v9, s32
    s_sub_u32 s54, s54, s53
    s_add_u32 s50, s50, s54
    s_add_u32 s51, s51, s54
    s_add_u32 s52, s52, s54
    s_pack_ll_b32_b16 s48, s54, s50
    s_pack_ll_b32_b16 s49, s51, s52
    v_add_u32 v14, s48, v14
    v_add_u32 v15, s49, v15
    v_sub_u32 v12, v14, v12
    v_sub_u32 v13, v15, v13
    v_and_b32 v8, 0xffff, v12
    v_lshrrev_b32 v9, 16, v12
    v_and_b32 v10, 0xffff, v13
    v_lshrrev_b32 v11, 16, v13
    ds_write2st64_b32 v7, v8, v9 offset0:0 offset1:1
    ds_write2st64_b32 v7, v10, v11 offset0:2 offset1:3
    v_and_b32 v8, 0x3f0, v0
    v_lshl_add_u32 v8, v8, 1, s36
    ds_write_b64 v8, v[12:13] offset:20480
    s_bitset0_b64 exec, 63
    s_not_b64 exec, exec
    ds_write_b64 v8, v[14:15] offset:20512
    s_mov_b64 exec, -1
    s_waitcnt lgkmcnt(0)
    s_barrier
    s_setprio 3
    ds_add_rtn_u32 v20, v20, v2
    ds_add_rtn_u32 v21, v21, v2
    ds_add_rtn_u32 v22, v22, v2
    ds_add_rtn_u32 v23, v23, v2
    ds_read_b128 v[12:15], v0 offset:20480
    v_cmp_gt_u32 vcc, 8448, v0
    ds_add_rtn_u32 v32, v32, v2
    ds_add_rtn_u32 v33, v33, v2
    ds_add_rtn_u32 v34, v34, v2
    ds_add_rtn_u32 v35, v35, v2
    s_setprio 2
    ds_add_rtn_u32 v40, v40, v2
    ds_add_rtn_u32 v41, v41, v2
    ds_add_rtn_u32 v42, v42, v2
    ds_add_rtn_u32 v43, v43, v2
    s_waitcnt lgkmcnt(8)
    s_cbranch_vccz L1_p1
    s_add_u32 s46, s35, 0x0
    s_mov_b64 exec, vcc
    buffer_store_dwordx4 v[12:15], v0, s[24:27], s46 offen sc1
    s_mov_b64 exec, -1
L1_p1:
    s_add_u32 s47, s98, 0x2800000
    v_lshlrev_b32 v116, 1, v1
    buffer_load_dwordx4 v[116:119], v116, s[8:11], s47 offen nt
    ds_add_rtn_u32 v52, v52, v2
    ds_add_rtn_u32 v53, v53, v2
    ds_add_rtn_u32 v54, v54, v2
    ds_add_rtn_u32 v55, v55, v2
    s_setprio 1
    ds_add_rtn_u32 v60, v60, v2
    ds_add_rtn_u32 v61, v61, v2
    ds_add_rtn_u32 v62, v62, v2
    ds_add_rtn_u32 v63, v63, v2
    ds_add_rtn_u32 v72, v72, v2
    ds_add_rtn_u32 v73, v73, v2
    ds_add_rtn_u32 v74, v74, v2
    ds_add_rtn_u32 v75, v75, v2
    s_add_u32 s44, s98, 0x2800000
    v_lshlrev_b32 v120, 1, v1
    buffer_load_dwordx4 v[120:123], v120, s[12:15], s44 offen nt
    s_setprio 0
    ds_add_rtn_u32 v80, v80, v2
    ds_add_rtn_u32 v81, v81, v2
    ds_add_rtn_u32 v82, v82, v2
    ds_add_rtn_u32 v83, v83, v2
    ds_add_rtn_u32 v92, v92, v2
    ds_add_rtn_u32 v93, v93, v2
    ds_add_rtn_u32 v94, v94, v2
    ds_add_rtn_u32 v95, v95, v2
    s_waitcnt lgkmcnt(0)
    s_barrier
    s_setprio 3
    v_and_b32 v7, -4, v20
    v_lshl_add_u32 v8, v20, 2, v7
    ds_write_b32 v8, v16
    v_lshl_add_u32 v7, v7, 2, v20
    ds_write_b8 v7, v24 offset:16
    v_and_b32 v9, -4, v21
    v_lshl_add_u32 v10, v21, 2, v9
    ds_write_b32 v10, v17
    v_lshl_add_u32 v9, v9, 2, v21
    ds_write_b8_d16_hi v9, v24 offset:16
    v_and_b32 v7, -4, v22
    v_lshl_add_u32 v8, v22, 2, v7
    ds_write_b32 v8, v18
    v_lshl_add_u32 v7, v7, 2, v22
    ds_write_b8 v7, v25 offset:16
    v_and_b32 v9, -4, v23
    v_lshl_add_u32 v10, v23, 2, v9
    ds_write_b32 v10, v19
    v_lshl_add_u32 v9, v9, 2, v23
    ds_write_b8_d16_hi v9, v25 offset:16
    s_add_u32 s45, s98, 0x2800000
    s_lshr_b32 s45, s45, 1
    buffer_load_dwordx2 v[124:125], v1, s[16:19], s45 offen nt
    s_add_u32 s46, s99, 0x2c00000
    s_lshr_b32 s46, s46, 1
    buffer_load_dwordx2 v[126:127], v1, s[16:19], s46 offen nt
    s_add_u32 s47, s99, 0x2c00000
    v_lshlrev_b32 v16, 1, v1
    buffer_load_dwordx4 v[16:19], v16, s[8:11], s47 offen nt
    v_and_b32 v7, -4, v32
    v_lshl_add_u32 v8, v32, 2, v7
    ds_write_b32 v8, v28
    v_lshl_add_u32 v7, v7, 2, v32
    ds_write_b8 v7, v26 offset:16
    v_and_b32 v9, -4, v33
    v_lshl_add_u32 v10, v33, 2, v9
    ds_write_b32 v10, v29
    v_lshl_add_u32 v9, v9, 2, v33
    ds_write_b8_d16_hi v9, v26 offset:16
    v_and_b32 v7, -4, v34
    v_lshl_add_u32 v8, v34, 2, v7
    ds_write_b32 v8, v30
    v_lshl_add_u32 v7, v7, 2, v34
    ds_write_b8 v7, v27 offset:16
    v_and_b32 v9, -4, v35
    v_lshl_add_u32 v10, v35, 2, v9
    ds_write_b32 v10, v31
    v_lshl_add_u32 v9, v9, 2, v35
    ds_write_b8_d16_hi v9, v27 offset:16
    s_add_u32 s44, s99, 0x2c00000
    v_lshlrev_b32 v20, 1, v1
    buffer_load_dwordx4 v[20:23], v20, s[12:15], s44 offen nt
    s_setprio 2
    v_and_b32 v7, -4, v40
    v_lshl_add_u32 v8, v40, 2, v7
    ds_write_b32 v8, v36
    v_lshl_add_u32 v7, v7, 2, v40
    ds_write_b8 v7, v44 offset:16
    v_and_b32 v9, -4, v41
    v_lshl_add_u32 v10, v41, 2, v9
    ds_write_b32 v10, v37
    v_lshl_add_u32 v9, v9, 2, v41
    ds_write_b8_d16_hi v9, v44 offset:16
    v_and_b32 v7, -4, v42
    v_lshl_add_u32 v8, v42, 2, v7
    ds_write_b32 v8, v38
    v_lshl_add_u32 v7, v7, 2, v42
    ds_write_b8 v7, v45 offset:16
    v_and_b32 v9, -4, v43
    v_lshl_add_u32 v10, v43, 2, v9
    ds_write_b32 v10, v39
    v_lshl_add_u32 v9, v9, 2, v43
    ds_write_b8_d16_hi v9, v45 offset:16
    s_add_u32 s45, s96, 0x3000000
    v_lshlrev_b32 v28, 1, v1
    buffer_load_dwordx4 v[28:31], v28, s[8:11], s45 offen nt
    s_add_u32 s46, s96, 0x3000000
    v_lshlrev_b32 v32, 1, v1
    buffer_load_dwordx4 v[32:35], v32, s[12:15], s46 offen nt
    v_and_b32 v7, -4, v52
    v_lshl_add_u32 v8, v52, 2, v7
    ds_write_b32 v8, v48
    v_lshl_add_u32 v7, v7, 2, v52
    ds_write_b8 v7, v46 offset:16
    v_and_b32 v9, -4, v53
    v_lshl_add_u32 v10, v53, 2, v9
    ds_write_b32 v10, v49
    v_lshl_add_u32 v9, v9, 2, v53
    ds_write_b8_d16_hi v9, v46 offset:16
    v_and_b32 v7, -4, v54
    v_lshl_add_u32 v8, v54, 2, v7
    ds_write_b32 v8, v50
    v_lshl_add_u32 v7, v7, 2, v54
    ds_write_b8 v7, v47 offset:16
    v_and_b32 v9, -4, v55
    v_lshl_add_u32 v10, v55, 2, v9
    ds_write_b32 v10, v51
    v_lshl_add_u32 v9, v9, 2, v55
    ds_write_b8_d16_hi v9, v47 offset:16
    s_add_u32 s47, s96, 0x3000000
    s_lshr_b32 s47, s47, 1
    buffer_load_dwordx2 v[24:25], v1, s[16:19], s47 offen nt
    s_add_u32 s44, s97, 0x3400000
    s_lshr_b32 s44, s44, 1
    buffer_load_dwordx2 v[26:27], v1, s[16:19], s44 offen nt
    s_setprio 1
    v_and_b32 v7, -4, v60
    v_lshl_add_u32 v8, v60, 2, v7
    ds_write_b32 v8, v56
    v_lshl_add_u32 v7, v7, 2, v60
    ds_write_b8 v7, v64 offset:16
    v_and_b32 v9, -4, v61
    v_lshl_add_u32 v10, v61, 2, v9
    ds_write_b32 v10, v57
    v_lshl_add_u32 v9, v9, 2, v61
    ds_write_b8_d16_hi v9, v64 offset:16
    v_and_b32 v7, -4, v62
    v_lshl_add_u32 v8, v62, 2, v7
    ds_write_b32 v8, v58
    v_lshl_add_u32 v7, v7, 2, v62
    ds_write_b8 v7, v65 offset:16
    v_and_b32 v9, -4, v63
    v_lshl_add_u32 v10, v63, 2, v9
    ds_write_b32 v10, v59
    v_lshl_add_u32 v9, v9, 2, v63
    ds_write_b8_d16_hi v9, v65 offset:16
    s_add_u32 s45, s97, 0x3400000
    v_lshlrev_b32 v36, 1, v1
    buffer_load_dwordx4 v[36:39], v36, s[8:11], s45 offen nt
    v_and_b32 v7, -4, v72
    v_lshl_add_u32 v8, v72, 2, v7
    ds_write_b32 v8, v68
    v_lshl_add_u32 v7, v7, 2, v72
    ds_write_b8 v7, v66 offset:16
    v_and_b32 v9, -4, v73
    v_lshl_add_u32 v10, v73, 2, v9
    ds_write_b32 v10, v69
    v_lshl_add_u32 v9, v9, 2, v73
    ds_write_b8_d16_hi v9, v66 offset:16
    v_and_b32 v7, -4, v74
    v_lshl_add_u32 v8, v74, 2, v7
    ds_write_b32 v8, v70
    v_lshl_add_u32 v7, v7, 2, v74
    ds_write_b8 v7, v67 offset:16
    v_and_b32 v9, -4, v75
    v_lshl_add_u32 v10, v75, 2, v9
    ds_write_b32 v10, v71
    v_lshl_add_u32 v9, v9, 2, v75
    ds_write_b8_d16_hi v9, v67 offset:16
    s_add_u32 s46, s97, 0x3400000
    v_lshlrev_b32 v40, 1, v1
    buffer_load_dwordx4 v[40:43], v40, s[12:15], s46 offen nt
    s_add_u32 s47, s98, 0x3800000
    v_lshlrev_b32 v48, 1, v1
    buffer_load_dwordx4 v[48:51], v48, s[8:11], s47 offen nt
    s_setprio 0
    v_and_b32 v7, -4, v80
    v_lshl_add_u32 v8, v80, 2, v7
    ds_write_b32 v8, v76
    v_lshl_add_u32 v7, v7, 2, v80
    ds_write_b8 v7, v84 offset:16
    v_and_b32 v9, -4, v81
    v_lshl_add_u32 v10, v81, 2, v9
    ds_write_b32 v10, v77
    v_lshl_add_u32 v9, v9, 2, v81
    ds_write_b8_d16_hi v9, v84 offset:16
    v_and_b32 v7, -4, v82
    v_lshl_add_u32 v8, v82, 2, v7
    ds_write_b32 v8, v78
    v_lshl_add_u32 v7, v7, 2, v82
    ds_write_b8 v7, v85 offset:16
    v_and_b32 v9, -4, v83
    v_lshl_add_u32 v10, v83, 2, v9
    ds_write_b32 v10, v79
    v_lshl_add_u32 v9, v9, 2, v83
    ds_write_b8_d16_hi v9, v85 offset:16
    s_add_u32 s44, s98, 0x3800000
    v_lshlrev_b32 v52, 1, v1
    buffer_load_dwordx4 v[52:55], v52, s[12:15], s44 offen nt
    v_and_b32 v7, -4, v92
    v_lshl_add_u32 v8, v92, 2, v7
    ds_write_b32 v8, v88
    v_lshl_add_u32 v7, v7, 2, v92
    ds_write_b8 v7, v86 offset:16
    v_and_b32 v9, -4, v93
    v_lshl_add_u32 v10, v93, 2, v9
    ds_write_b32 v10, v89
    v_lshl_add_u32 v9, v9, 2, v93
    ds_write_b8_d16_hi v9, v86 offset:16
    v_and_b32 v7, -4, v94
    v_lshl_add_u32 v8, v94, 2, v7
    ds_write_b32 v8, v90
    v_lshl_add_u32 v7, v7, 2, v94
    ds_write_b8 v7, v87 offset:16
    v_and_b32 v9, -4, v95
    v_lshl_add_u32 v10, v95, 2, v9
    ds_write_b32 v10, v91
    v_lshl_add_u32 v9, v9, 2, v95
    ds_write_b8_d16_hi v9, v87 offset:16
    s_add_u32 s45, s98, 0x3800000
    s_lshr_b32 s45, s45, 1
    buffer_load_dwordx2 v[44:45], v1, s[16:19], s45 offen nt
    s_add_u32 s46, s99, 0x3c00000
    s_lshr_b32 s46, s46, 1
    buffer_load_dwordx2 v[46:47], v1, s[16:19], s46 offen nt
    v_add_u32 v7, s72, v0
    v_add_u32 v12, s73, v0
    v_add_u32 v13, s85, v0
    v_add_u32 v14, s91, v0
    v_add_u32 v15, s93, v0
    s_min_i32 s3, s72, s73
    s_min_i32 s3, s3, s85
    s_min_i32 s3, s3, s91
    s_min_i32 s3, s3, s93
    v_add_u32 v3, s3, v0
    v_mov_b32 v8, 0
    v_mov_b32 v9, 0
    v_mov_b32 v10, 0
    v_mov_b32 v11, 0
    s_waitcnt lgkmcnt(0)
    s_barrier
    ds_read_b128 v[56:59], v7 offset:0
    ds_read_b128 v[60:63], v12 offset:0
    ds_read_b128 v[68:71], v13 offset:0
    ds_read_b128 v[72:75], v14 offset:0
    ds_read_b128 v[64:67], v15 offset:0
    ds_write_b128 v3, v[8:11]
    ds_read_b128 v[76:79], v7 offset:16384
    ds_read_b128 v[80:83], v12 offset:16384
    ds_read_b128 v[88:91], v13 offset:16384
    ds_read_b128 v[92:95], v14 offset:16384
    ds_read_b128 v[84:87], v15 offset:16384
    s_waitcnt lgkmcnt(0)
    s_barrier
    s_setprio 3
    s_add_u32 s47, s35, 0x4000
    s_add_u32 s47, s47, s72
    buffer_store_dwordx4 v[56:59], v0, s[20:23], s47 offen sc1
    s_add_u32 s44, s99, 0x3c00000
    s_nop 0
    v_lshlrev_b32 v56, 1, v1
    buffer_load_dwordx4 v[56:59], v56, s[8:11], s44 offen nt
    s_add_u32 s45, s35, 0x4000
    s_add_u32 s45, s45, s73
    buffer_store_dwordx4 v[60:63], v0, s[20:23], s45 offen sc1
    s_add_u32 s46, s99, 0x3c00000
    s_nop 0
    v_lshlrev_b32 v60, 1, v1
    buffer_load_dwordx4 v[60:63], v60, s[12:15], s46 offen nt
    s_waitcnt vmcnt(22)
    v_lshlrev_b32 v7, 16, v108
    v_and_b32 v8, 0xffff0000, v108
    v_lshlrev_b32 v9, 16, v109
    v_and_b32 v10, 0xffff0000, v109
    v_mul_f32 v7, 0.15915494, v7
    v_mul_f32 v8, 0.15915494, v8
    v_mul_f32 v9, 0.15915494, v9
    v_mul_f32 v10, 0.15915494, v10
    v_mul_hi_u32_u24 v14, 429497, v96
    v_lshrrev_b32 v12, 3, v104
    v_cos_f32 v7, v7
    v_lshlrev_b16 v13, 3, v104
    v_mad_i32_i24 v11, v14, s55, v96
    v_bitop3_b32 v12, v6, v13, v12 bitop3:0xca
    v_lshl_add_u32 v11, v11, 17, s40
    v_lshlrev_b16 v14, 8, v14
    v_lshrrev_b32 v13, 2, v104
    v_add_u32 v96, v12, v11
    v_bitop3_b32 v104, v5, v13, v14 bitop3:0xea
    ds_add_u32 v104, v2
    v_mul_hi_u32_u24 v14, 429497, v97
    v_lshrrev_b32 v12, 3, v105
    v_cos_f32 v8, v8
    v_lshlrev_b16 v13, 3, v105
    v_mad_i32_i24 v11, v14, s55, v97
    v_bitop3_b32 v12, v6, v13, v12 bitop3:0xca
    v_lshl_add_u32 v11, v11, 17, s40
    v_lshlrev_b16 v14, 8, v14
    v_lshrrev_b32 v13, 2, v105
    v_add_u32 v97, v12, v11
    v_bitop3_b32 v105, v5, v13, v14 bitop3:0xea
    ds_add_u32 v105, v2
    v_cvt_pk_bf16_f32 v108, v7, v8
    v_perm_b32 v12, v108, v108, s41
    v_bitop3_b32 v96, v4, v12, v96 bitop3:0xca
    v_perm_b32 v13, v108, v108, s42
    v_bitop3_b32 v97, v4, v13, v97 bitop3:0xca
    v_mul_hi_u32_u24 v14, 429497, v98
    v_lshrrev_b32 v12, 3, v106
    v_cos_f32 v9, v9
    v_lshlrev_b16 v13, 3, v106
    v_mad_i32_i24 v11, v14, s55, v98
    v_bitop3_b32 v12, v6, v13, v12 bitop3:0xca
    v_lshl_add_u32 v11, v11, 17, s40
    v_lshlrev_b16 v14, 8, v14
    v_lshrrev_b32 v13, 2, v106
    v_add_u32 v98, v12, v11
    v_bitop3_b32 v106, v5, v13, v14 bitop3:0xea
    ds_add_u32 v106, v2
    v_mul_hi_u32_u24 v14, 429497, v99
    v_lshrrev_b32 v12, 3, v107
    v_cos_f32 v10, v10
    v_lshlrev_b16 v13, 3, v107
    v_mad_i32_i24 v11, v14, s55, v99
    v_bitop3_b32 v12, v6, v13, v12 bitop3:0xca
    v_lshl_add_u32 v11, v11, 17, s40
    v_lshlrev_b16 v14, 8, v14
    v_lshrrev_b32 v13, 2, v107
    v_add_u32 v99, v12, v11
    v_bitop3_b32 v107, v5, v13, v14 bitop3:0xea
    ds_add_u32 v107, v2
    v_cvt_pk_bf16_f32 v109, v9, v10
    v_perm_b32 v12, v109, v109, s41
    v_bitop3_b32 v98, v4, v12, v98 bitop3:0xca
    v_perm_b32 v13, v109, v109, s42
    v_bitop3_b32 v99, v4, v13, v99 bitop3:0xca
    s_waitcnt vmcnt(20)
    v_lshlrev_b32 v7, 16, v110
    v_and_b32 v8, 0xffff0000, v110
    v_lshlrev_b32 v9, 16, v111
    v_and_b32 v10, 0xffff0000, v111
    v_mul_f32 v7, 0.15915494, v7
    v_mul_f32 v8, 0.15915494, v8
    v_mul_f32 v9, 0.15915494, v9
    v_mul_f32 v10, 0.15915494, v10
    v_mul_hi_u32_u24 v14, 429497, v100
    v_lshrrev_b32 v12, 3, v112
    v_cos_f32 v7, v7
    v_lshlrev_b16 v13, 3, v112
    v_mad_i32_i24 v11, v14, s55, v100
    v_bitop3_b32 v12, v6, v13, v12 bitop3:0xca
    v_lshl_add_u32 v11, v11, 17, s40
    v_lshlrev_b16 v14, 8, v14
    v_lshrrev_b32 v13, 2, v112
    v_add_u32 v100, v12, v11
    v_bitop3_b32 v112, v5, v13, v14 bitop3:0xea
    ds_add_u32 v112, v2
    v_mul_hi_u32_u24 v14, 429497, v101
    v_lshrrev_b32 v12, 3, v113
    v_cos_f32 v8, v8
    v_lshlrev_b16 v13, 3, v113
    v_mad_i32_i24 v11, v14, s55, v101
    v_bitop3_b32 v12, v6, v13, v12 bitop3:0xca
    v_lshl_add_u32 v11, v11, 17, s40
    v_lshlrev_b16 v14, 8, v14
    v_lshrrev_b32 v13, 2, v113
    v_add_u32 v101, v12, v11
    v_bitop3_b32 v113, v5, v13, v14 bitop3:0xea
    ds_add_u32 v113, v2
    v_cvt_pk_bf16_f32 v110, v7, v8
    v_perm_b32 v12, v110, v110, s41
    v_bitop3_b32 v100, v4, v12, v100 bitop3:0xca
    v_perm_b32 v13, v110, v110, s42
    v_bitop3_b32 v101, v4, v13, v101 bitop3:0xca
    v_mul_hi_u32_u24 v14, 429497, v102
    v_lshrrev_b32 v12, 3, v114
    v_cos_f32 v9, v9
    v_lshlrev_b16 v13, 3, v114
    v_mad_i32_i24 v11, v14, s55, v102
    v_bitop3_b32 v12, v6, v13, v12 bitop3:0xca
    v_lshl_add_u32 v11, v11, 17, s40
    v_lshlrev_b16 v14, 8, v14
    v_lshrrev_b32 v13, 2, v114
    v_add_u32 v102, v12, v11
    v_bitop3_b32 v114, v5, v13, v14 bitop3:0xea
    ds_add_u32 v114, v2
    v_mul_hi_u32_u24 v14, 429497, v103
    v_lshrrev_b32 v12, 3, v115
    v_cos_f32 v10, v10
    v_lshlrev_b16 v13, 3, v115
    v_mad_i32_i24 v11, v14, s55, v103
    v_bitop3_b32 v12, v6, v13, v12 bitop3:0xca
    v_lshl_add_u32 v11, v11, 17, s40
    v_lshlrev_b16 v14, 8, v14
    v_lshrrev_b32 v13, 2, v115
    v_add_u32 v103, v12, v11
    v_bitop3_b32 v115, v5, v13, v14 bitop3:0xea
    ds_add_u32 v115, v2
    v_cvt_pk_bf16_f32 v111, v9, v10
    v_perm_b32 v12, v111, v111, s41
    v_bitop3_b32 v102, v4, v12, v102 bitop3:0xca
    v_perm_b32 v13, v111, v111, s42
    v_bitop3_b32 v103, v4, v13, v103 bitop3:0xca
    s_setprio 2
    s_waitcnt vmcnt(16)
    v_lshlrev_b32 v7, 16, v124
    v_and_b32 v8, 0xffff0000, v124
    v_lshlrev_b32 v9, 16, v125
    v_and_b32 v10, 0xffff0000, v125
    v_mul_f32 v7, 0.15915494, v7
    v_mul_f32 v8, 0.15915494, v8
    v_mul_f32 v9, 0.15915494, v9
    v_mul_f32 v10, 0.15915494, v10
    v_mul_hi_u32_u24 v14, 429497, v116
    v_lshrrev_b32 v12, 3, v120
    v_cos_f32 v7, v7
    v_lshlrev_b16 v13, 3, v120
    v_mad_i32_i24 v11, v14, s55, v116
    v_bitop3_b32 v12, v6, v13, v12 bitop3:0xca
    v_lshl_add_u32 v11, v11, 17, s40
    v_lshlrev_b16 v14, 8, v14
    v_lshrrev_b32 v13, 2, v120
    v_add_u32 v116, v12, v11
    v_bitop3_b32 v120, v5, v13, v14 bitop3:0xea
    ds_add_u32 v120, v2
    v_mul_hi_u32_u24 v14, 429497, v117
    v_lshrrev_b32 v12, 3, v121
    v_cos_f32 v8, v8
    v_lshlrev_b16 v13, 3, v121
    v_mad_i32_i24 v11, v14, s55, v117
    v_bitop3_b32 v12, v6, v13, v12 bitop3:0xca
    v_lshl_add_u32 v11, v11, 17, s40
    v_lshlrev_b16 v14, 8, v14
    v_lshrrev_b32 v13, 2, v121
    v_add_u32 v117, v12, v11
    v_bitop3_b32 v121, v5, v13, v14 bitop3:0xea
    ds_add_u32 v121, v2
    v_cvt_pk_bf16_f32 v124, v7, v8
    v_perm_b32 v12, v124, v124, s41
    v_bitop3_b32 v116, v4, v12, v116 bitop3:0xca
    v_perm_b32 v13, v124, v124, s42
    v_bitop3_b32 v117, v4, v13, v117 bitop3:0xca
    v_mul_hi_u32_u24 v14, 429497, v118
    v_lshrrev_b32 v12, 3, v122
    v_cos_f32 v9, v9
    v_lshlrev_b16 v13, 3, v122
    v_mad_i32_i24 v11, v14, s55, v118
    v_bitop3_b32 v12, v6, v13, v12 bitop3:0xca
    v_lshl_add_u32 v11, v11, 17, s40
    v_lshlrev_b16 v14, 8, v14
    v_lshrrev_b32 v13, 2, v122
    v_add_u32 v118, v12, v11
    v_bitop3_b32 v122, v5, v13, v14 bitop3:0xea
    ds_add_u32 v122, v2
    v_mul_hi_u32_u24 v14, 429497, v119
    v_lshrrev_b32 v12, 3, v123
    v_cos_f32 v10, v10
    v_lshlrev_b16 v13, 3, v123
    v_mad_i32_i24 v11, v14, s55, v119
    v_bitop3_b32 v12, v6, v13, v12 bitop3:0xca
    v_lshl_add_u32 v11, v11, 17, s40
    v_lshlrev_b16 v14, 8, v14
    v_lshrrev_b32 v13, 2, v123
    v_add_u32 v119, v12, v11
    v_bitop3_b32 v123, v5, v13, v14 bitop3:0xea
    ds_add_u32 v123, v2
    v_cvt_pk_bf16_f32 v125, v9, v10
    v_perm_b32 v12, v125, v125, s41
    v_bitop3_b32 v118, v4, v12, v118 bitop3:0xca
    v_perm_b32 v13, v125, v125, s42
    v_bitop3_b32 v119, v4, v13, v119 bitop3:0xca
    s_add_u32 s47, s35, 0x4000
    s_add_u32 s47, s47, s85
    buffer_store_dwordx4 v[68:71], v0, s[20:23], s47 offen sc1
    s_add_u32 s44, s96, 0x4000000
    s_nop 0
    v_lshlrev_b32 v68, 1, v1
    buffer_load_dwordx4 v[68:71], v68, s[8:11], s44 offen nt
    s_waitcnt vmcnt(16)
    v_lshlrev_b32 v7, 16, v126
    v_and_b32 v8, 0xffff0000, v126
    v_lshlrev_b32 v9, 16, v127
    v_and_b32 v10, 0xffff0000, v127
    v_mul_f32 v7, 0.15915494, v7
    v_mul_f32 v8, 0.15915494, v8
    v_mul_f32 v9, 0.15915494, v9
    v_mul_f32 v10, 0.15915494, v10
    v_mul_hi_u32_u24 v14, 429497, v16
    v_lshrrev_b32 v12, 3, v20
    v_cos_f32 v7, v7
    v_lshlrev_b16 v13, 3, v20
    v_mad_i32_i24 v11, v14, s55, v16
    v_bitop3_b32 v12, v6, v13, v12 bitop3:0xca
    v_lshl_add_u32 v11, v11, 17, s40
    v_lshlrev_b16 v14, 8, v14
    v_lshrrev_b32 v13, 2, v20
    v_add_u32 v16, v12, v11
    v_bitop3_b32 v20, v5, v13, v14 bitop3:0xea
    ds_add_u32 v20, v2
    v_mul_hi_u32_u24 v14, 429497, v17
    v_lshrrev_b32 v12, 3, v21
    v_cos_f32 v8, v8
    v_lshlrev_b16 v13, 3, v21
    v_mad_i32_i24 v11, v14, s55, v17
    v_bitop3_b32 v12, v6, v13, v12 bitop3:0xca
    v_lshl_add_u32 v11, v11, 17, s40
    v_lshlrev_b16 v14, 8, v14
    v_lshrrev_b32 v13, 2, v21
    v_add_u32 v17, v12, v11
    v_bitop3_b32 v21, v5, v13, v14 bitop3:0xea
    ds_add_u32 v21, v2
    v_cvt_pk_bf16_f32 v126, v7, v8
    v_perm_b32 v12, v126, v126, s41
    v_bitop3_b32 v16, v4, v12, v16 bitop3:0xca
    v_perm_b32 v13, v126, v126, s42
    v_bitop3_b32 v17, v4, v13, v17 bitop3:0xca
    v_mul_hi_u32_u24 v14, 429497, v18
    v_lshrrev_b32 v12, 3, v22
    v_cos_f32 v9, v9
    v_lshlrev_b16 v13, 3, v22
    v_mad_i32_i24 v11, v14, s55, v18
    v_bitop3_b32 v12, v6, v13, v12 bitop3:0xca
    v_lshl_add_u32 v11, v11, 17, s40
    v_lshlrev_b16 v14, 8, v14
    v_lshrrev_b32 v13, 2, v22
    v_add_u32 v18, v12, v11
    v_bitop3_b32 v22, v5, v13, v14 bitop3:0xea
    ds_add_u32 v22, v2
    v_mul_hi_u32_u24 v14, 429497, v19
    v_lshrrev_b32 v12, 3, v23
    v_cos_f32 v10, v10
    v_lshlrev_b16 v13, 3, v23
    v_mad_i32_i24 v11, v14, s55, v19
    v_bitop3_b32 v12, v6, v13, v12 bitop3:0xca
    v_lshl_add_u32 v11, v11, 17, s40
    v_lshlrev_b16 v14, 8, v14
    v_lshrrev_b32 v13, 2, v23
    v_add_u32 v19, v12, v11
    v_bitop3_b32 v23, v5, v13, v14 bitop3:0xea
    ds_add_u32 v23, v2
    v_cvt_pk_bf16_f32 v127, v9, v10
    v_perm_b32 v12, v127, v127, s41
    v_bitop3_b32 v18, v4, v12, v18 bitop3:0xca
    v_perm_b32 v13, v127, v127, s42
    v_bitop3_b32 v19, v4, v13, v19 bitop3:0xca
    s_setprio 1
    s_waitcnt vmcnt(12)
    v_lshlrev_b32 v7, 16, v24
    v_and_b32 v8, 0xffff0000, v24
    v_lshlrev_b32 v9, 16, v25
    v_and_b32 v10, 0xffff0000, v25
    v_mul_f32 v7, 0.15915494, v7
    v_mul_f32 v8, 0.15915494, v8
    v_mul_f32 v9, 0.15915494, v9
    v_mul_f32 v10, 0.15915494, v10
    v_mul_hi_u32_u24 v14, 429497, v28
    v_lshrrev_b32 v12, 3, v32
    v_cos_f32 v7, v7
    v_lshlrev_b16 v13, 3, v32
    v_mad_i32_i24 v11, v14, s55, v28
    v_bitop3_b32 v12, v6, v13, v12 bitop3:0xca
    v_lshl_add_u32 v11, v11, 17, s40
    v_lshlrev_b16 v14, 8, v14
    v_lshrrev_b32 v13, 2, v32
    v_add_u32 v28, v12, v11
    v_bitop3_b32 v32, v5, v13, v14 bitop3:0xea
    ds_add_u32 v32, v2
    v_mul_hi_u32_u24 v14, 429497, v29
    v_lshrrev_b32 v12, 3, v33
    v_cos_f32 v8, v8
    v_lshlrev_b16 v13, 3, v33
    v_mad_i32_i24 v11, v14, s55, v29
    v_bitop3_b32 v12, v6, v13, v12 bitop3:0xca
    v_lshl_add_u32 v11, v11, 17, s40
    v_lshlrev_b16 v14, 8, v14
    v_lshrrev_b32 v13, 2, v33
    v_add_u32 v29, v12, v11
    v_bitop3_b32 v33, v5, v13, v14 bitop3:0xea
    ds_add_u32 v33, v2
    v_cvt_pk_bf16_f32 v24, v7, v8
    v_perm_b32 v12, v24, v24, s41
    v_bitop3_b32 v28, v4, v12, v28 bitop3:0xca
    v_perm_b32 v13, v24, v24, s42
    v_bitop3_b32 v29, v4, v13, v29 bitop3:0xca
    v_mul_hi_u32_u24 v14, 429497, v30
    v_lshrrev_b32 v12, 3, v34
    v_cos_f32 v9, v9
    v_lshlrev_b16 v13, 3, v34
    v_mad_i32_i24 v11, v14, s55, v30
    v_bitop3_b32 v12, v6, v13, v12 bitop3:0xca
    v_lshl_add_u32 v11, v11, 17, s40
    v_lshlrev_b16 v14, 8, v14
    v_lshrrev_b32 v13, 2, v34
    v_add_u32 v30, v12, v11
    v_bitop3_b32 v34, v5, v13, v14 bitop3:0xea
    ds_add_u32 v34, v2
    v_mul_hi_u32_u24 v14, 429497, v31
    v_lshrrev_b32 v12, 3, v35
    v_cos_f32 v10, v10
    v_lshlrev_b16 v13, 3, v35
    v_mad_i32_i24 v11, v14, s55, v31
    v_bitop3_b32 v12, v6, v13, v12 bitop3:0xca
    v_lshl_add_u32 v11, v11, 17, s40
    v_lshlrev_b16 v14, 8, v14
    v_lshrrev_b32 v13, 2, v35
    v_add_u32 v31, v12, v11
    v_bitop3_b32 v35, v5, v13, v14 bitop3:0xea
    ds_add_u32 v35, v2
    v_cvt_pk_bf16_f32 v25, v9, v10
    v_perm_b32 v12, v25, v25, s41
    v_bitop3_b32 v30, v4, v12, v30 bitop3:0xca
    v_perm_b32 v13, v25, v25, s42
    v_bitop3_b32 v31, v4, v13, v31 bitop3:0xca
    s_waitcnt vmcnt(10)
    v_lshlrev_b32 v7, 16, v26
    v_and_b32 v8, 0xffff0000, v26
    v_lshlrev_b32 v9, 16, v27
    v_and_b32 v10, 0xffff0000, v27
    v_mul_f32 v7, 0.15915494, v7
    v_mul_f32 v8, 0.15915494, v8
    v_mul_f32 v9, 0.15915494, v9
    v_mul_f32 v10, 0.15915494, v10
    v_mul_hi_u32_u24 v14, 429497, v36
    v_lshrrev_b32 v12, 3, v40
    v_cos_f32 v7, v7
    v_lshlrev_b16 v13, 3, v40
    v_mad_i32_i24 v11, v14, s55, v36
    v_bitop3_b32 v12, v6, v13, v12 bitop3:0xca
    v_lshl_add_u32 v11, v11, 17, s40
    v_lshlrev_b16 v14, 8, v14
    v_lshrrev_b32 v13, 2, v40
    v_add_u32 v36, v12, v11
    v_bitop3_b32 v40, v5, v13, v14 bitop3:0xea
    ds_add_u32 v40, v2
    v_mul_hi_u32_u24 v14, 429497, v37
    v_lshrrev_b32 v12, 3, v41
    v_cos_f32 v8, v8
    v_lshlrev_b16 v13, 3, v41
    v_mad_i32_i24 v11, v14, s55, v37
    v_bitop3_b32 v12, v6, v13, v12 bitop3:0xca
    v_lshl_add_u32 v11, v11, 17, s40
    v_lshlrev_b16 v14, 8, v14
    v_lshrrev_b32 v13, 2, v41
    v_add_u32 v37, v12, v11
    v_bitop3_b32 v41, v5, v13, v14 bitop3:0xea
    ds_add_u32 v41, v2
    v_cvt_pk_bf16_f32 v26, v7, v8
    v_perm_b32 v12, v26, v26, s41
    v_bitop3_b32 v36, v4, v12, v36 bitop3:0xca
    v_perm_b32 v13, v26, v26, s42
    v_bitop3_b32 v37, v4, v13, v37 bitop3:0xca
    v_mul_hi_u32_u24 v14, 429497, v38
    v_lshrrev_b32 v12, 3, v42
    v_cos_f32 v9, v9
    v_lshlrev_b16 v13, 3, v42
    v_mad_i32_i24 v11, v14, s55, v38
    v_bitop3_b32 v12, v6, v13, v12 bitop3:0xca
    v_lshl_add_u32 v11, v11, 17, s40
    v_lshlrev_b16 v14, 8, v14
    v_lshrrev_b32 v13, 2, v42
    v_add_u32 v38, v12, v11
    v_bitop3_b32 v42, v5, v13, v14 bitop3:0xea
    ds_add_u32 v42, v2
    v_mul_hi_u32_u24 v14, 429497, v39
    v_lshrrev_b32 v12, 3, v43
    v_cos_f32 v10, v10
    v_lshlrev_b16 v13, 3, v43
    v_mad_i32_i24 v11, v14, s55, v39
    v_bitop3_b32 v12, v6, v13, v12 bitop3:0xca
    v_lshl_add_u32 v11, v11, 17, s40
    v_lshlrev_b16 v14, 8, v14
    v_lshrrev_b32 v13, 2, v43
    v_add_u32 v39, v12, v11
    v_bitop3_b32 v43, v5, v13, v14 bitop3:0xea
    ds_add_u32 v43, v2
    v_cvt_pk_bf16_f32 v27, v9, v10
    v_perm_b32 v12, v27, v27, s41
    v_bitop3_b32 v38, v4, v12, v38 bitop3:0xca
    v_perm_b32 v13, v27, v27, s42
    v_bitop3_b32 v39, v4, v13, v39 bitop3:0xca
    s_setprio 0
    s_add_u32 s45, s35, 0x4000
    s_add_u32 s45, s45, s91
    buffer_store_dwordx4 v[72:75], v0, s[20:23], s45 offen sc1
    s_add_u32 s46, s96, 0x4000000
    s_nop 0
    v_lshlrev_b32 v72, 1, v1
    buffer_load_dwordx4 v[72:75], v72, s[12:15], s46 offen nt
    s_waitcnt vmcnt(8)
    v_lshlrev_b32 v7, 16, v44
    v_and_b32 v8, 0xffff0000, v44
    v_lshlrev_b32 v9, 16, v45
    v_and_b32 v10, 0xffff0000, v45
    v_mul_f32 v7, 0.15915494, v7
    v_mul_f32 v8, 0.15915494, v8
    v_mul_f32 v9, 0.15915494, v9
    v_mul_f32 v10, 0.15915494, v10
    v_mul_hi_u32_u24 v14, 429497, v48
    v_lshrrev_b32 v12, 3, v52
    v_cos_f32 v7, v7
    v_lshlrev_b16 v13, 3, v52
    v_mad_i32_i24 v11, v14, s55, v48
    v_bitop3_b32 v12, v6, v13, v12 bitop3:0xca
    v_lshl_add_u32 v11, v11, 17, s40
    v_lshlrev_b16 v14, 8, v14
    v_lshrrev_b32 v13, 2, v52
    v_add_u32 v48, v12, v11
    v_bitop3_b32 v52, v5, v13, v14 bitop3:0xea
    ds_add_u32 v52, v2
    v_mul_hi_u32_u24 v14, 429497, v49
    v_lshrrev_b32 v12, 3, v53
    v_cos_f32 v8, v8
    v_lshlrev_b16 v13, 3, v53
    v_mad_i32_i24 v11, v14, s55, v49
    v_bitop3_b32 v12, v6, v13, v12 bitop3:0xca
    v_lshl_add_u32 v11, v11, 17, s40
    v_lshlrev_b16 v14, 8, v14
    v_lshrrev_b32 v13, 2, v53
    v_add_u32 v49, v12, v11
    v_bitop3_b32 v53, v5, v13, v14 bitop3:0xea
    ds_add_u32 v53, v2
    v_cvt_pk_bf16_f32 v44, v7, v8
    v_perm_b32 v12, v44, v44, s41
    v_bitop3_b32 v48, v4, v12, v48 bitop3:0xca
    v_perm_b32 v13, v44, v44, s42
    v_bitop3_b32 v49, v4, v13, v49 bitop3:0xca
    v_mul_hi_u32_u24 v14, 429497, v50
    v_lshrrev_b32 v12, 3, v54
    v_cos_f32 v9, v9
    v_lshlrev_b16 v13, 3, v54
    v_mad_i32_i24 v11, v14, s55, v50
    v_bitop3_b32 v12, v6, v13, v12 bitop3:0xca
    v_lshl_add_u32 v11, v11, 17, s40
    v_lshlrev_b16 v14, 8, v14
    v_lshrrev_b32 v13, 2, v54
    v_add_u32 v50, v12, v11
    v_bitop3_b32 v54, v5, v13, v14 bitop3:0xea
    ds_add_u32 v54, v2
    v_mul_hi_u32_u24 v14, 429497, v51
    v_lshrrev_b32 v12, 3, v55
    v_cos_f32 v10, v10
    v_lshlrev_b16 v13, 3, v55
    v_mad_i32_i24 v11, v14, s55, v51
    v_bitop3_b32 v12, v6, v13, v12 bitop3:0xca
    v_lshl_add_u32 v11, v11, 17, s40
    v_lshlrev_b16 v14, 8, v14
    v_lshrrev_b32 v13, 2, v55
    v_add_u32 v51, v12, v11
    v_bitop3_b32 v55, v5, v13, v14 bitop3:0xea
    ds_add_u32 v55, v2
    v_cvt_pk_bf16_f32 v45, v9, v10
    v_perm_b32 v12, v45, v45, s41
    v_bitop3_b32 v50, v4, v12, v50 bitop3:0xca
    v_perm_b32 v13, v45, v45, s42
    v_bitop3_b32 v51, v4, v13, v51 bitop3:0xca
    s_waitcnt vmcnt(4)
    v_lshlrev_b32 v7, 16, v46
    v_and_b32 v8, 0xffff0000, v46
    v_lshlrev_b32 v9, 16, v47
    v_and_b32 v10, 0xffff0000, v47
    v_mul_f32 v7, 0.15915494, v7
    v_mul_f32 v8, 0.15915494, v8
    v_mul_f32 v9, 0.15915494, v9
    v_mul_f32 v10, 0.15915494, v10
    v_mul_hi_u32_u24 v14, 429497, v56
    v_lshrrev_b32 v12, 3, v60
    v_cos_f32 v7, v7
    v_lshlrev_b16 v13, 3, v60
    v_mad_i32_i24 v11, v14, s55, v56
    v_bitop3_b32 v12, v6, v13, v12 bitop3:0xca
    v_lshl_add_u32 v11, v11, 17, s40
    v_lshlrev_b16 v14, 8, v14
    v_lshrrev_b32 v13, 2, v60
    v_add_u32 v56, v12, v11
    v_bitop3_b32 v60, v5, v13, v14 bitop3:0xea
    ds_add_u32 v60, v2
    v_mul_hi_u32_u24 v14, 429497, v57
    v_lshrrev_b32 v12, 3, v61
    v_cos_f32 v8, v8
    v_lshlrev_b16 v13, 3, v61
    v_mad_i32_i24 v11, v14, s55, v57
    v_bitop3_b32 v12, v6, v13, v12 bitop3:0xca
    v_lshl_add_u32 v11, v11, 17, s40
    v_lshlrev_b16 v14, 8, v14
    v_lshrrev_b32 v13, 2, v61
    v_add_u32 v57, v12, v11
    v_bitop3_b32 v61, v5, v13, v14 bitop3:0xea
    ds_add_u32 v61, v2
    v_cvt_pk_bf16_f32 v46, v7, v8
    v_perm_b32 v12, v46, v46, s41
    v_bitop3_b32 v56, v4, v12, v56 bitop3:0xca
    v_perm_b32 v13, v46, v46, s42
    v_bitop3_b32 v57, v4, v13, v57 bitop3:0xca
    v_mul_hi_u32_u24 v14, 429497, v58
    v_lshrrev_b32 v12, 3, v62
    v_cos_f32 v9, v9
    v_lshlrev_b16 v13, 3, v62
    v_mad_i32_i24 v11, v14, s55, v58
    v_bitop3_b32 v12, v6, v13, v12 bitop3:0xca
    v_lshl_add_u32 v11, v11, 17, s40
    v_lshlrev_b16 v14, 8, v14
    v_lshrrev_b32 v13, 2, v62
    v_add_u32 v58, v12, v11
    v_bitop3_b32 v62, v5, v13, v14 bitop3:0xea
    ds_add_u32 v62, v2
    v_mul_hi_u32_u24 v14, 429497, v59
    v_lshrrev_b32 v12, 3, v63
    v_cos_f32 v10, v10
    v_lshlrev_b16 v13, 3, v63
    v_mad_i32_i24 v11, v14, s55, v59
    v_bitop3_b32 v12, v6, v13, v12 bitop3:0xca
    v_lshl_add_u32 v11, v11, 17, s40
    v_lshlrev_b16 v14, 8, v14
    v_lshrrev_b32 v13, 2, v63
    v_add_u32 v59, v12, v11
    v_bitop3_b32 v63, v5, v13, v14 bitop3:0xea
    ds_add_u32 v63, v2
    v_cvt_pk_bf16_f32 v47, v9, v10
    v_perm_b32 v12, v47, v47, s41
    v_bitop3_b32 v58, v4, v12, v58 bitop3:0xca
    v_perm_b32 v13, v47, v47, s42
    v_bitop3_b32 v59, v4, v13, v59 bitop3:0xca
    v_lshrrev_b32 v8, 2, v0
    v_and_b32 v7, 0x3c00, v0
    v_bitop3_b32 v7, v5, v8, v7 bitop3:0xea
    s_waitcnt lgkmcnt(0)
    s_barrier
    ds_read2st64_b32 v[8:9], v7 offset0:0 offset1:1
    ds_read2st64_b32 v[10:11], v7 offset0:2 offset1:3
    s_add_u32 s47, s35, 0x4000
    s_add_u32 s47, s47, s93
    buffer_store_dwordx4 v[64:67], v0, s[20:23], s47 offen sc1
    s_add_u32 s44, s96, 0x4000000
    s_lshr_b32 s44, s44, 1
    buffer_load_dwordx2 v[64:65], v1, s[16:19], s44 offen nt
    s_add_u32 s45, s97, 0x4400000
    s_lshr_b32 s45, s45, 1
    buffer_load_dwordx2 v[66:67], v1, s[16:19], s45 offen nt
    s_waitcnt lgkmcnt(0)
    v_lshl_or_b32 v12, v9, 16, v8
    v_lshl_or_b32 v13, v11, 16, v10
    v_mov_b32 v14, v12
    v_mov_b32 v15, v13
    s_nop 0
    v_add_u32_dpp v14, v14, v14 row_shr:1 row_mask:0xf bank_mask:0xf bound_ctrl:1
    v_add_u32_dpp v15, v15, v15 row_shr:1 row_mask:0xf bank_mask:0xf bound_ctrl:1
    s_nop 0
    v_add_u32_dpp v14, v14, v14 row_shr:2 row_mask:0xf bank_mask:0xf bound_ctrl:1
    v_add_u32_dpp v15, v15, v15 row_shr:2 row_mask:0xf bank_mask:0xf bound_ctrl:1
    s_nop 0
    v_add_u32_dpp v14, v14, v14 row_shr:4 row_mask:0xf bank_mask:0xf bound_ctrl:1
    v_add_u32_dpp v15, v15, v15 row_shr:4 row_mask:0xf bank_mask:0xf bound_ctrl:1
    s_nop 0
    v_add_u32_dpp v14, v14, v14 row_shr:8 row_mask:0xf bank_mask:0xf bound_ctrl:1
    v_add_u32_dpp v15, v15, v15 row_shr:8 row_mask:0xf bank_mask:0xf bound_ctrl:1
    s_nop 0
    v_add_u32_dpp v14, v14, v14 row_bcast:15 row_mask:0xa bank_mask:0xf
    v_add_u32_dpp v15, v15, v15 row_bcast:15 row_mask:0xa bank_mask:0xf
    s_nop 0
    v_add_u32_dpp v14, v14, v14 row_bcast:31 row_mask:0xc bank_mask:0xf
    v_add_u32_dpp v15, v15, v15 row_bcast:31 row_mask:0xc bank_mask:0xf
    v_readlane_b32 s48, v14, 63
    v_readlane_b32 s49, v15, 63
    s_lshl_b32 s54, s32, 2
    v_mov_b32 v8, s54
    s_and_b32 s50, s48, 0xffff
    s_lshr_b32 s51, s48, 16
    s_and_b32 s52, s49, 0xffff
    s_lshr_b32 s53, s49, 16
    s_add_u32 s51, s51, s50
    s_add_u32 s52, s52, s51
    s_add_u32 s53, s53, s52
    v_mov_b32 v9, s53
    s_mov_b64 exec, 1
    ds_write_b32 v8, v9 offset:16384
    s_mov_b64 exec, -1
    v_and_b32 v8, 60, v7
    s_waitcnt lgkmcnt(0)
    s_barrier
    ds_read_b32 v9, v8 offset:16384
    s_waitcnt lgkmcnt(0)
    v_add_u32_dpp v9, v9, v9 row_shr:1 row_mask:0xf bank_mask:0xf bound_ctrl:1
    s_nop 1
    v_add_u32_dpp v9, v9, v9 row_shr:2 row_mask:0xf bank_mask:0xf bound_ctrl:1
    s_nop 1
    v_add_u32_dpp v9, v9, v9 row_shr:4 row_mask:0xf bank_mask:0xf bound_ctrl:1
    s_nop 1
    v_add_u32_dpp v9, v9, v9 row_shr:8 row_mask:0xf bank_mask:0xf bound_ctrl:1
    s_nop 0
    v_readlane_b32 s54, v9, s32
    s_sub_u32 s54, s54, s53
    s_add_u32 s50, s50, s54
    s_add_u32 s51, s51, s54
    s_add_u32 s52, s52, s54
    s_pack_ll_b32_b16 s48, s54, s50
    s_pack_ll_b32_b16 s49, s51, s52
    v_add_u32 v14, s48, v14
    v_add_u32 v15, s49, v15
    v_sub_u32 v12, v14, v12
    v_sub_u32 v13, v15, v13
    v_and_b32 v8, 0xffff, v12
    v_lshrrev_b32 v9, 16, v12
    v_and_b32 v10, 0xffff, v13
    v_lshrrev_b32 v11, 16, v13
    ds_write2st64_b32 v7, v8, v9 offset0:0 offset1:1
    ds_write2st64_b32 v7, v10, v11 offset0:2 offset1:3
    v_and_b32 v8, 0x3f0, v0
    v_lshl_add_u32 v8, v8, 1, s36
    ds_write_b64 v8, v[12:13] offset:20480
    s_bitset0_b64 exec, 63
    s_not_b64 exec, exec
    ds_write_b64 v8, v[14:15] offset:20512
    s_mov_b64 exec, -1
    s_waitcnt lgkmcnt(0)
    s_barrier
    s_setprio 3
    ds_add_rtn_u32 v104, v104, v2
    ds_add_rtn_u32 v105, v105, v2
    ds_add_rtn_u32 v106, v106, v2
    ds_add_rtn_u32 v107, v107, v2
    ds_read_b128 v[12:15], v0 offset:20480
    v_cmp_gt_u32 vcc, 8448, v0
    ds_add_rtn_u32 v112, v112, v2
    ds_add_rtn_u32 v113, v113, v2
    ds_add_rtn_u32 v114, v114, v2
    ds_add_rtn_u32 v115, v115, v2
    s_setprio 2
    ds_add_rtn_u32 v120, v120, v2
    ds_add_rtn_u32 v121, v121, v2
    ds_add_rtn_u32 v122, v122, v2
    ds_add_rtn_u32 v123, v123, v2
    s_waitcnt lgkmcnt(8)
    s_cbranch_vccz L1_p2
    s_add_u32 s46, s35, 0x2a40000
    s_mov_b64 exec, vcc
    buffer_store_dwordx4 v[12:15], v0, s[24:27], s46 offen sc1
    s_mov_b64 exec, -1
L1_p2:
    s_add_u32 s47, s35, 0x8000
    s_add_u32 s47, s47, s72
    buffer_store_dwordx4 v[76:79], v0, s[20:23], s47 offen sc1
    s_add_u32 s44, s97, 0x4400000
    s_nop 0
    v_lshlrev_b32 v76, 1, v1
    buffer_load_dwordx4 v[76:79], v76, s[8:11], s44 offen nt
    ds_add_rtn_u32 v20, v20, v2
    ds_add_rtn_u32 v21, v21, v2
    ds_add_rtn_u32 v22, v22, v2
    ds_add_rtn_u32 v23, v23, v2
    s_setprio 1
    ds_add_rtn_u32 v32, v32, v2
    ds_add_rtn_u32 v33, v33, v2
    ds_add_rtn_u32 v34, v34, v2
    ds_add_rtn_u32 v35, v35, v2
    ds_add_rtn_u32 v40, v40, v2
    ds_add_rtn_u32 v41, v41, v2
    ds_add_rtn_u32 v42, v42, v2
    ds_add_rtn_u32 v43, v43, v2
    s_add_u32 s45, s35, 0x8000
    s_add_u32 s45, s45, s73
    buffer_store_dwordx4 v[80:83], v0, s[20:23], s45 offen sc1
    s_add_u32 s46, s97, 0x4400000
    s_nop 0
    v_lshlrev_b32 v80, 1, v1
    buffer_load_dwordx4 v[80:83], v80, s[12:15], s46 offen nt
    s_setprio 0
    ds_add_rtn_u32 v52, v52, v2
    ds_add_rtn_u32 v53, v53, v2
    ds_add_rtn_u32 v54, v54, v2
    ds_add_rtn_u32 v55, v55, v2
    ds_add_rtn_u32 v60, v60, v2
    ds_add_rtn_u32 v61, v61, v2
    ds_add_rtn_u32 v62, v62, v2
    ds_add_rtn_u32 v63, v63, v2
    s_waitcnt lgkmcnt(0)
    s_barrier
    s_setprio 3
    v_and_b32 v7, -4, v104
    v_lshl_add_u32 v8, v104, 2, v7
    ds_write_b32 v8, v96
    v_lshl_add_u32 v7, v7, 2, v104
    ds_write_b8 v7, v108 offset:16
    v_and_b32 v9, -4, v105
    v_lshl_add_u32 v10, v105, 2, v9
    ds_write_b32 v10, v97
    v_lshl_add_u32 v9, v9, 2, v105
    ds_write_b8_d16_hi v9, v108 offset:16
    v_and_b32 v7, -4, v106
    v_lshl_add_u32 v8, v106, 2, v7
    ds_write_b32 v8, v98
    v_lshl_add_u32 v7, v7, 2, v106
    ds_write_b8 v7, v109 offset:16
    v_and_b32 v9, -4, v107
    v_lshl_add_u32 v10, v107, 2, v9
    ds_write_b32 v10, v99
    v_lshl_add_u32 v9, v9, 2, v107
    ds_write_b8_d16_hi v9, v109 offset:16
    s_add_u32 s47, s35, 0x8000
    s_add_u32 s47, s47, s85
    buffer_store_dwordx4 v[88:91], v0, s[20:23], s47 offen sc1
    s_add_u32 s44, s98, 0x4800000
    v_lshlrev_b32 v96, 1, v1
    buffer_load_dwordx4 v[96:99], v96, s[8:11], s44 offen nt
    s_add_u32 s45, s98, 0x4800000
    v_lshlrev_b32 v104, 1, v1
    buffer_load_dwordx4 v[104:107], v104, s[12:15], s45 offen nt
    v_and_b32 v7, -4, v112
    v_lshl_add_u32 v8, v112, 2, v7
    ds_write_b32 v8, v100
    v_lshl_add_u32 v7, v7, 2, v112
    ds_write_b8 v7, v110 offset:16
    v_and_b32 v9, -4, v113
    v_lshl_add_u32 v10, v113, 2, v9
    ds_write_b32 v10, v101
    v_lshl_add_u32 v9, v9, 2, v113
    ds_write_b8_d16_hi v9, v110 offset:16
    v_and_b32 v7, -4, v114
    v_lshl_add_u32 v8, v114, 2, v7
    ds_write_b32 v8, v102
    v_lshl_add_u32 v7, v7, 2, v114
    ds_write_b8 v7, v111 offset:16
    v_and_b32 v9, -4, v115
    v_lshl_add_u32 v10, v115, 2, v9
    ds_write_b32 v10, v103
    v_lshl_add_u32 v9, v9, 2, v115
    ds_write_b8_d16_hi v9, v111 offset:16
    s_add_u32 s46, s98, 0x4800000
    s_lshr_b32 s46, s46, 1
    buffer_load_dwordx2 v[88:89], v1, s[16:19], s46 offen nt
    s_add_u32 s47, s99, 0x4c00000
    s_lshr_b32 s47, s47, 1
    buffer_load_dwordx2 v[90:91], v1, s[16:19], s47 offen nt
    s_add_u32 s44, s99, 0x4c00000
    v_lshlrev_b32 v100, 1, v1
    buffer_load_dwordx4 v[100:103], v100, s[8:11], s44 offen nt
    s_setprio 2
    v_and_b32 v7, -4, v120
    v_lshl_add_u32 v8, v120, 2, v7
    ds_write_b32 v8, v116
    v_lshl_add_u32 v7, v7, 2, v120
    ds_write_b8 v7, v124 offset:16
    v_and_b32 v9, -4, v121
    v_lshl_add_u32 v10, v121, 2, v9
    ds_write_b32 v10, v117
    v_lshl_add_u32 v9, v9, 2, v121
    ds_write_b8_d16_hi v9, v124 offset:16
    v_and_b32 v7, -4, v122
    v_lshl_add_u32 v8, v122, 2, v7
    ds_write_b32 v8, v118
    v_lshl_add_u32 v7, v7, 2, v122
    ds_write_b8 v7, v125 offset:16
    v_and_b32 v9, -4, v123
    v_lshl_add_u32 v10, v123, 2, v9
    ds_write_b32 v10, v119
    v_lshl_add_u32 v9, v9, 2, v123
    ds_write_b8_d16_hi v9, v125 offset:16
    s_add_u32 s45, s35, 0x8000
    s_add_u32 s45, s45, s91
    buffer_store_dwordx4 v[92:95], v0, s[20:23], s45 offen sc1
    s_add_u32 s46, s99, 0x4c00000
    v_lshlrev_b32 v112, 1, v1
    buffer_load_dwordx4 v[112:115], v112, s[12:15], s46 offen nt
    v_and_b32 v7, -4, v20
    v_lshl_add_u32 v8, v20, 2, v7
    ds_write_b32 v8, v16
    v_lshl_add_u32 v7, v7, 2, v20
    ds_write_b8 v7, v126 offset:16
    v_and_b32 v9, -4, v21
    v_lshl_add_u32 v10, v21, 2, v9
    ds_write_b32 v10, v17
    v_lshl_add_u32 v9, v9, 2, v21
    ds_write_b8_d16_hi v9, v126 offset:16
    v_and_b32 v7, -4, v22
    v_lshl_add_u32 v8, v22, 2, v7
    ds_write_b32 v8, v18
    v_lshl_add_u32 v7, v7, 2, v22
    ds_write_b8 v7, v127 offset:16
    v_and_b32 v9, -4, v23
    v_lshl_add_u32 v10, v23, 2, v9
    ds_write_b32 v10, v19
    v_lshl_add_u32 v9, v9, 2, v23
    ds_write_b8_d16_hi v9, v127 offset:16
    s_add_u32 s47, s96, 0x5000000
    v_lshlrev_b32 v108, 1, v1
    buffer_load_dwordx4 v[108:111], v108, s[8:11], s47 offen nt
    s_add_u32 s44, s96, 0x5000000
    v_lshlrev_b32 v116, 1, v1
    buffer_load_dwordx4 v[116:119], v116, s[12:15], s44 offen nt
    s_setprio 1
    v_and_b32 v7, -4, v32
    v_lshl_add_u32 v8, v32, 2, v7
    ds_write_b32 v8, v28
    v_lshl_add_u32 v7, v7, 2, v32
    ds_write_b8 v7, v24 offset:16
    v_and_b32 v9, -4, v33
    v_lshl_add_u32 v10, v33, 2, v9
    ds_write_b32 v10, v29
    v_lshl_add_u32 v9, v9, 2, v33
    ds_write_b8_d16_hi v9, v24 offset:16
    v_and_b32 v7, -4, v34
    v_lshl_add_u32 v8, v34, 2, v7
    ds_write_b32 v8, v30
    v_lshl_add_u32 v7, v7, 2, v34
    ds_write_b8 v7, v25 offset:16
    v_and_b32 v9, -4, v35
    v_lshl_add_u32 v10, v35, 2, v9
    ds_write_b32 v10, v31
    v_lshl_add_u32 v9, v9, 2, v35
    ds_write_b8_d16_hi v9, v25 offset:16
    s_add_u32 s45, s96, 0x5000000
    s_lshr_b32 s45, s45, 1
    buffer_load_dwordx2 v[120:121], v1, s[16:19], s45 offen nt
    s_add_u32 s46, s97, 0x5400000
    s_lshr_b32 s46, s46, 1
    buffer_load_dwordx2 v[122:123], v1, s[16:19], s46 offen nt
    s_add_u32 s47, s97, 0x5400000
    v_lshlrev_b32 v92, 1, v1
    buffer_load_dwordx4 v[92:95], v92, s[8:11], s47 offen nt
    v_and_b32 v7, -4, v40
    v_lshl_add_u32 v8, v40, 2, v7
    ds_write_b32 v8, v36
    v_lshl_add_u32 v7, v7, 2, v40
    ds_write_b8 v7, v26 offset:16
    v_and_b32 v9, -4, v41
    v_lshl_add_u32 v10, v41, 2, v9
    ds_write_b32 v10, v37
    v_lshl_add_u32 v9, v9, 2, v41
    ds_write_b8_d16_hi v9, v26 offset:16
    v_and_b32 v7, -4, v42
    v_lshl_add_u32 v8, v42, 2, v7
    ds_write_b32 v8, v38
    v_lshl_add_u32 v7, v7, 2, v42
    ds_write_b8 v7, v27 offset:16
    v_and_b32 v9, -4, v43
    v_lshl_add_u32 v10, v43, 2, v9
    ds_write_b32 v10, v39
    v_lshl_add_u32 v9, v9, 2, v43
    ds_write_b8_d16_hi v9, v27 offset:16
    s_add_u32 s44, s35, 0x8000
    s_add_u32 s44, s44, s93
    buffer_store_dwordx4 v[84:87], v0, s[20:23], s44 offen sc1
    s_add_u32 s45, s97, 0x5400000
    v_lshlrev_b32 v16, 1, v1
    buffer_load_dwordx4 v[16:19], v16, s[12:15], s45 offen nt
    s_setprio 0
    v_and_b32 v7, -4, v52
    v_lshl_add_u32 v8, v52, 2, v7
    ds_write_b32 v8, v48
    v_lshl_add_u32 v7, v7, 2, v52
    ds_write_b8 v7, v44 offset:16
    v_and_b32 v9, -4, v53
    v_lshl_add_u32 v10, v53, 2, v9
    ds_write_b32 v10, v49
    v_lshl_add_u32 v9, v9, 2, v53
    ds_write_b8_d16_hi v9, v44 offset:16
    v_and_b32 v7, -4, v54
    v_lshl_add_u32 v8, v54, 2, v7
    ds_write_b32 v8, v50
    v_lshl_add_u32 v7, v7, 2, v54
    ds_write_b8 v7, v45 offset:16
    v_and_b32 v9, -4, v55
    v_lshl_add_u32 v10, v55, 2, v9
    ds_write_b32 v10, v51
    v_lshl_add_u32 v9, v9, 2, v55
    ds_write_b8_d16_hi v9, v45 offset:16
    s_add_u32 s46, s98, 0x5800000
    v_lshlrev_b32 v20, 1, v1
    buffer_load_dwordx4 v[20:23], v20, s[8:11], s46 offen nt
    s_add_u32 s47, s98, 0x5800000
    v_lshlrev_b32 v124, 1, v1
    buffer_load_dwordx4 v[124:127], v124, s[12:15], s47 offen nt
    v_and_b32 v7, -4, v60
    v_lshl_add_u32 v8, v60, 2, v7
    ds_write_b32 v8, v56
    v_lshl_add_u32 v7, v7, 2, v60
    ds_write_b8 v7, v46 offset:16
    v_and_b32 v9, -4, v61
    v_lshl_add_u32 v10, v61, 2, v9
    ds_write_b32 v10, v57
    v_lshl_add_u32 v9, v9, 2, v61
    ds_write_b8_d16_hi v9, v46 offset:16
    v_and_b32 v7, -4, v62
    v_lshl_add_u32 v8, v62, 2, v7
    ds_write_b32 v8, v58
    v_lshl_add_u32 v7, v7, 2, v62
    ds_write_b8 v7, v47 offset:16
    v_and_b32 v9, -4, v63
    v_lshl_add_u32 v10, v63, 2, v9
    ds_write_b32 v10, v59
    v_lshl_add_u32 v9, v9, 2, v63
    ds_write_b8_d16_hi v9, v47 offset:16
    s_add_u32 s44, s98, 0x5800000
    s_lshr_b32 s44, s44, 1
    buffer_load_dwordx2 v[28:29], v1, s[16:19], s44 offen nt
    s_add_u32 s45, s99, 0x5c00000
    s_lshr_b32 s45, s45, 1
    buffer_load_dwordx2 v[30:31], v1, s[16:19], s45 offen nt
    v_add_u32 v7, s72, v0
    v_add_u32 v12, s73, v0
    v_add_u32 v13, s85, v0
    v_add_u32 v14, s91, v0
    v_add_u32 v15, s93, v0
    s_min_i32 s3, s72, s73
    s_min_i32 s3, s3, s85
    s_min_i32 s3, s3, s91
    s_min_i32 s3, s3, s93
    v_add_u32 v3, s3, v0
    v_mov_b32 v8, 0
    v_mov_b32 v9, 0
    v_mov_b32 v10, 0
    v_mov_b32 v11, 0
    s_waitcnt lgkmcnt(0)
    s_barrier
    ds_read_b128 v[32:35], v7 offset:0
    ds_read_b128 v[36:39], v12 offset:0
    ds_read_b128 v[40:43], v13 offset:0
    ds_read_b128 v[24:27], v14 offset:0
    ds_read_b128 v[84:87], v15 offset:0
    ds_write_b128 v3, v[8:11]
    ds_read_b128 v[48:51], v7 offset:16384
    ds_read_b128 v[52:55], v12 offset:16384
    ds_read_b128 v[56:59], v13 offset:16384
    ds_read_b128 v[60:63], v14 offset:16384
    ds_read_b128 v[44:47], v15 offset:16384
    s_waitcnt lgkmcnt(0)
    s_barrier
    s_setprio 3
    s_add_u32 s46, s35, 0x2a44000
    s_add_u32 s46, s46, s72
    buffer_store_dwordx4 v[32:35], v0, s[20:23], s46 offen sc1
    s_add_u32 s47, s99, 0x5c00000
    s_nop 0
    v_lshlrev_b32 v32, 1, v1
    buffer_load_dwordx4 v[32:35], v32, s[8:11], s47 offen nt
    s_add_u32 s44, s35, 0x2a44000
    s_add_u32 s44, s44, s73
    buffer_store_dwordx4 v[36:39], v0, s[20:23], s44 offen sc1
    s_add_u32 s45, s99, 0x5c00000
    s_nop 0
    v_lshlrev_b32 v36, 1, v1
    buffer_load_dwordx4 v[36:39], v36, s[12:15], s45 offen nt
    s_waitcnt vmcnt(27)
    v_lshlrev_b32 v7, 16, v64
    v_and_b32 v8, 0xffff0000, v64
    v_lshlrev_b32 v9, 16, v65
    v_and_b32 v10, 0xffff0000, v65
    v_mul_f32 v7, 0.15915494, v7
    v_mul_f32 v8, 0.15915494, v8
    v_mul_f32 v9, 0.15915494, v9
    v_mul_f32 v10, 0.15915494, v10
    v_mul_hi_u32_u24 v14, 429497, v68
    v_lshrrev_b32 v12, 3, v72
    v_cos_f32 v7, v7
    v_lshlrev_b16 v13, 3, v72
    v_mad_i32_i24 v11, v14, s55, v68
    v_bitop3_b32 v12, v6, v13, v12 bitop3:0xca
    v_lshl_add_u32 v11, v11, 17, s40
    v_lshlrev_b16 v14, 8, v14
    v_lshrrev_b32 v13, 2, v72
    v_add_u32 v68, v12, v11
    v_bitop3_b32 v72, v5, v13, v14 bitop3:0xea
    ds_add_u32 v72, v2
    v_mul_hi_u32_u24 v14, 429497, v69
    v_lshrrev_b32 v12, 3, v73
    v_cos_f32 v8, v8
    v_lshlrev_b16 v13, 3, v73
    v_mad_i32_i24 v11, v14, s55, v69
    v_bitop3_b32 v12, v6, v13, v12 bitop3:0xca
    v_lshl_add_u32 v11, v11, 17, s40
    v_lshlrev_b16 v14, 8, v14
    v_lshrrev_b32 v13, 2, v73
    v_add_u32 v69, v12, v11
    v_bitop3_b32 v73, v5, v13, v14 bitop3:0xea
    ds_add_u32 v73, v2
    v_cvt_pk_bf16_f32 v64, v7, v8
    v_perm_b32 v12, v64, v64, s41
    v_bitop3_b32 v68, v4, v12, v68 bitop3:0xca
    v_perm_b32 v13, v64, v64, s42
    v_bitop3_b32 v69, v4, v13, v69 bitop3:0xca
    v_mul_hi_u32_u24 v14, 429497, v70
    v_lshrrev_b32 v12, 3, v74
    v_cos_f32 v9, v9
    v_lshlrev_b16 v13, 3, v74
    v_mad_i32_i24 v11, v14, s55, v70
    v_bitop3_b32 v12, v6, v13, v12 bitop3:0xca
    v_lshl_add_u32 v11, v11, 17, s40
    v_lshlrev_b16 v14, 8, v14
    v_lshrrev_b32 v13, 2, v74
    v_add_u32 v70, v12, v11
    v_bitop3_b32 v74, v5, v13, v14 bitop3:0xea
    ds_add_u32 v74, v2
    v_mul_hi_u32_u24 v14, 429497, v71
    v_lshrrev_b32 v12, 3, v75
    v_cos_f32 v10, v10
    v_lshlrev_b16 v13, 3, v75
    v_mad_i32_i24 v11, v14, s55, v71
    v_bitop3_b32 v12, v6, v13, v12 bitop3:0xca
    v_lshl_add_u32 v11, v11, 17, s40
    v_lshlrev_b16 v14, 8, v14
    v_lshrrev_b32 v13, 2, v75
    v_add_u32 v71, v12, v11
    v_bitop3_b32 v75, v5, v13, v14 bitop3:0xea
    ds_add_u32 v75, v2
    v_cvt_pk_bf16_f32 v65, v9, v10
    v_perm_b32 v12, v65, v65, s41
    v_bitop3_b32 v70, v4, v12, v70 bitop3:0xca
    v_perm_b32 v13, v65, v65, s42
    v_bitop3_b32 v71, v4, v13, v71 bitop3:0xca
    s_waitcnt vmcnt(23)
    v_lshlrev_b32 v7, 16, v66
    v_and_b32 v8, 0xffff0000, v66
    v_lshlrev_b32 v9, 16, v67
    v_and_b32 v10, 0xffff0000, v67
    v_mul_f32 v7, 0.15915494, v7
    v_mul_f32 v8, 0.15915494, v8
    v_mul_f32 v9, 0.15915494, v9
    v_mul_f32 v10, 0.15915494, v10
    v_mul_hi_u32_u24 v14, 429497, v76
    v_lshrrev_b32 v12, 3, v80
    v_cos_f32 v7, v7
    v_lshlrev_b16 v13, 3, v80
    v_mad_i32_i24 v11, v14, s55, v76
    v_bitop3_b32 v12, v6, v13, v12 bitop3:0xca
    v_lshl_add_u32 v11, v11, 17, s40
    v_lshlrev_b16 v14, 8, v14
    v_lshrrev_b32 v13, 2, v80
    v_add_u32 v76, v12, v11
    v_bitop3_b32 v80, v5, v13, v14 bitop3:0xea
    ds_add_u32 v80, v2
    v_mul_hi_u32_u24 v14, 429497, v77
    v_lshrrev_b32 v12, 3, v81
    v_cos_f32 v8, v8
    v_lshlrev_b16 v13, 3, v81
    v_mad_i32_i24 v11, v14, s55, v77
    v_bitop3_b32 v12, v6, v13, v12 bitop3:0xca
    v_lshl_add_u32 v11, v11, 17, s40
    v_lshlrev_b16 v14, 8, v14
    v_lshrrev_b32 v13, 2, v81
    v_add_u32 v77, v12, v11
    v_bitop3_b32 v81, v5, v13, v14 bitop3:0xea
    ds_add_u32 v81, v2
    v_cvt_pk_bf16_f32 v66, v7, v8
    v_perm_b32 v12, v66, v66, s41
    v_bitop3_b32 v76, v4, v12, v76 bitop3:0xca
    v_perm_b32 v13, v66, v66, s42
    v_bitop3_b32 v77, v4, v13, v77 bitop3:0xca
    v_mul_hi_u32_u24 v14, 429497, v78
    v_lshrrev_b32 v12, 3, v82
    v_cos_f32 v9, v9
    v_lshlrev_b16 v13, 3, v82
    v_mad_i32_i24 v11, v14, s55, v78
    v_bitop3_b32 v12, v6, v13, v12 bitop3:0xca
    v_lshl_add_u32 v11, v11, 17, s40
    v_lshlrev_b16 v14, 8, v14
    v_lshrrev_b32 v13, 2, v82
    v_add_u32 v78, v12, v11
    v_bitop3_b32 v82, v5, v13, v14 bitop3:0xea
    ds_add_u32 v82, v2
    v_mul_hi_u32_u24 v14, 429497, v79
    v_lshrrev_b32 v12, 3, v83
    v_cos_f32 v10, v10
    v_lshlrev_b16 v13, 3, v83
    v_mad_i32_i24 v11, v14, s55, v79
    v_bitop3_b32 v12, v6, v13, v12 bitop3:0xca
    v_lshl_add_u32 v11, v11, 17, s40
    v_lshlrev_b16 v14, 8, v14
    v_lshrrev_b32 v13, 2, v83
    v_add_u32 v79, v12, v11
    v_bitop3_b32 v83, v5, v13, v14 bitop3:0xea
    ds_add_u32 v83, v2
    v_cvt_pk_bf16_f32 v67, v9, v10
    v_perm_b32 v12, v67, v67, s41
    v_bitop3_b32 v78, v4, v12, v78 bitop3:0xca
    v_perm_b32 v13, v67, v67, s42
    v_bitop3_b32 v79, v4, v13, v79 bitop3:0xca
    s_setprio 2
    s_waitcnt vmcnt(18)
    v_lshlrev_b32 v7, 16, v88
    v_and_b32 v8, 0xffff0000, v88
    v_lshlrev_b32 v9, 16, v89
    v_and_b32 v10, 0xffff0000, v89
    v_mul_f32 v7, 0.15915494, v7
    v_mul_f32 v8, 0.15915494, v8
    v_mul_f32 v9, 0.15915494, v9
    v_mul_f32 v10, 0.15915494, v10
    v_mul_hi_u32_u24 v14, 429497, v96
    v_lshrrev_b32 v12, 3, v104
    v_cos_f32 v7, v7
    v_lshlrev_b16 v13, 3, v104
    v_mad_i32_i24 v11, v14, s55, v96
    v_bitop3_b32 v12, v6, v13, v12 bitop3:0xca
    v_lshl_add_u32 v11, v11, 17, s40
    v_lshlrev_b16 v14, 8, v14
    v_lshrrev_b32 v13, 2, v104
    v_add_u32 v96, v12, v11
    v_bitop3_b32 v104, v5, v13, v14 bitop3:0xea
    ds_add_u32 v104, v2
    v_mul_hi_u32_u24 v14, 429497, v97
    v_lshrrev_b32 v12, 3, v105
    v_cos_f32 v8, v8
    v_lshlrev_b16 v13, 3, v105
    v_mad_i32_i24 v11, v14, s55, v97
    v_bitop3_b32 v12, v6, v13, v12 bitop3:0xca
    v_lshl_add_u32 v11, v11, 17, s40
    v_lshlrev_b16 v14, 8, v14
    v_lshrrev_b32 v13, 2, v105
    v_add_u32 v97, v12, v11
    v_bitop3_b32 v105, v5, v13, v14 bitop3:0xea
    ds_add_u32 v105, v2
    v_cvt_pk_bf16_f32 v88, v7, v8
    v_perm_b32 v12, v88, v88, s41
    v_bitop3_b32 v96, v4, v12, v96 bitop3:0xca
    v_perm_b32 v13, v88, v88, s42
    v_bitop3_b32 v97, v4, v13, v97 bitop3:0xca
    v_mul_hi_u32_u24 v14, 429497, v98
    v_lshrrev_b32 v12, 3, v106
    v_cos_f32 v9, v9
    v_lshlrev_b16 v13, 3, v106
    v_mad_i32_i24 v11, v14, s55, v98
    v_bitop3_b32 v12, v6, v13, v12 bitop3:0xca
    v_lshl_add_u32 v11, v11, 17, s40
    v_lshlrev_b16 v14, 8, v14
    v_lshrrev_b32 v13, 2, v106
    v_add_u32 v98, v12, v11
    v_bitop3_b32 v106, v5, v13, v14 bitop3:0xea
    ds_add_u32 v106, v2
    v_mul_hi_u32_u24 v14, 429497, v99
    v_lshrrev_b32 v12, 3, v107
    v_cos_f32 v10, v10
    v_lshlrev_b16 v13, 3, v107
    v_mad_i32_i24 v11, v14, s55, v99
    v_bitop3_b32 v12, v6, v13, v12 bitop3:0xca
    v_lshl_add_u32 v11, v11, 17, s40
    v_lshlrev_b16 v14, 8, v14
    v_lshrrev_b32 v13, 2, v107
    v_add_u32 v99, v12, v11
    v_bitop3_b32 v107, v5, v13, v14 bitop3:0xea
    ds_add_u32 v107, v2
    v_cvt_pk_bf16_f32 v89, v9, v10
    v_perm_b32 v12, v89, v89, s41
    v_bitop3_b32 v98, v4, v12, v98 bitop3:0xca
    v_perm_b32 v13, v89, v89, s42
    v_bitop3_b32 v99, v4, v13, v99 bitop3:0xca
    s_add_u32 s46, s35, 0x2a44000
    s_add_u32 s46, s46, s85
    buffer_store_dwordx4 v[40:43], v0, s[20:23], s46 offen sc1
    s_add_u32 s47, s96, 0x6000000
    s_nop 0
    v_lshlrev_b32 v40, 1, v1
    buffer_load_dwordx4 v[40:43], v40, s[8:11], s47 offen nt
    s_waitcnt vmcnt(17)
    v_lshlrev_b32 v7, 16, v90
    v_and_b32 v8, 0xffff0000, v90
    v_lshlrev_b32 v9, 16, v91
    v_and_b32 v10, 0xffff0000, v91
    v_mul_f32 v7, 0.15915494, v7
    v_mul_f32 v8, 0.15915494, v8
    v_mul_f32 v9, 0.15915494, v9
    v_mul_f32 v10, 0.15915494, v10
    v_mul_hi_u32_u24 v14, 429497, v100
    v_lshrrev_b32 v12, 3, v112
    v_cos_f32 v7, v7
    v_lshlrev_b16 v13, 3, v112
    v_mad_i32_i24 v11, v14, s55, v100
    v_bitop3_b32 v12, v6, v13, v12 bitop3:0xca
    v_lshl_add_u32 v11, v11, 17, s40
    v_lshlrev_b16 v14, 8, v14
    v_lshrrev_b32 v13, 2, v112
    v_add_u32 v100, v12, v11
    v_bitop3_b32 v112, v5, v13, v14 bitop3:0xea
    ds_add_u32 v112, v2
    v_mul_hi_u32_u24 v14, 429497, v101
    v_lshrrev_b32 v12, 3, v113
    v_cos_f32 v8, v8
    v_lshlrev_b16 v13, 3, v113
    v_mad_i32_i24 v11, v14, s55, v101
    v_bitop3_b32 v12, v6, v13, v12 bitop3:0xca
    v_lshl_add_u32 v11, v11, 17, s40
    v_lshlrev_b16 v14, 8, v14
    v_lshrrev_b32 v13, 2, v113
    v_add_u32 v101, v12, v11
    v_bitop3_b32 v113, v5, v13, v14 bitop3:0xea
    ds_add_u32 v113, v2
    v_cvt_pk_bf16_f32 v90, v7, v8
    v_perm_b32 v12, v90, v90, s41
    v_bitop3_b32 v100, v4, v12, v100 bitop3:0xca
    v_perm_b32 v13, v90, v90, s42
    v_bitop3_b32 v101, v4, v13, v101 bitop3:0xca
    v_mul_hi_u32_u24 v14, 429497, v102
    v_lshrrev_b32 v12, 3, v114
    v_cos_f32 v9, v9
    v_lshlrev_b16 v13, 3, v114
    v_mad_i32_i24 v11, v14, s55, v102
    v_bitop3_b32 v12, v6, v13, v12 bitop3:0xca
    v_lshl_add_u32 v11, v11, 17, s40
    v_lshlrev_b16 v14, 8, v14
    v_lshrrev_b32 v13, 2, v114
    v_add_u32 v102, v12, v11
    v_bitop3_b32 v114, v5, v13, v14 bitop3:0xea
    ds_add_u32 v114, v2
    v_mul_hi_u32_u24 v14, 429497, v103
    v_lshrrev_b32 v12, 3, v115
    v_cos_f32 v10, v10
    v_lshlrev_b16 v13, 3, v115
    v_mad_i32_i24 v11, v14, s55, v103
    v_bitop3_b32 v12, v6, v13, v12 bitop3:0xca
    v_lshl_add_u32 v11, v11, 17, s40
    v_lshlrev_b16 v14, 8, v14
    v_lshrrev_b32 v13, 2, v115
    v_add_u32 v103, v12, v11
    v_bitop3_b32 v115, v5, v13, v14 bitop3:0xea
    ds_add_u32 v115, v2
    v_cvt_pk_bf16_f32 v91, v9, v10
    v_perm_b32 v12, v91, v91, s41
    v_bitop3_b32 v102, v4, v12, v102 bitop3:0xca
    v_perm_b32 v13, v91, v91, s42
    v_bitop3_b32 v103, v4, v13, v103 bitop3:0xca
    s_setprio 1
    s_waitcnt vmcnt(13)
    v_lshlrev_b32 v7, 16, v120
    v_and_b32 v8, 0xffff0000, v120
    v_lshlrev_b32 v9, 16, v121
    v_and_b32 v10, 0xffff0000, v121
    v_mul_f32 v7, 0.15915494, v7
    v_mul_f32 v8, 0.15915494, v8
    v_mul_f32 v9, 0.15915494, v9
    v_mul_f32 v10, 0.15915494, v10
    v_mul_hi_u32_u24 v14, 429497, v108
    v_lshrrev_b32 v12, 3, v116
    v_cos_f32 v7, v7
    v_lshlrev_b16 v13, 3, v116
    v_mad_i32_i24 v11, v14, s55, v108
    v_bitop3_b32 v12, v6, v13, v12 bitop3:0xca
    v_lshl_add_u32 v11, v11, 17, s40
    v_lshlrev_b16 v14, 8, v14
    v_lshrrev_b32 v13, 2, v116
    v_add_u32 v108, v12, v11
    v_bitop3_b32 v116, v5, v13, v14 bitop3:0xea
    ds_add_u32 v116, v2
    v_mul_hi_u32_u24 v14, 429497, v109
    v_lshrrev_b32 v12, 3, v117
    v_cos_f32 v8, v8
    v_lshlrev_b16 v13, 3, v117
    v_mad_i32_i24 v11, v14, s55, v109
    v_bitop3_b32 v12, v6, v13, v12 bitop3:0xca
    v_lshl_add_u32 v11, v11, 17, s40
    v_lshlrev_b16 v14, 8, v14
    v_lshrrev_b32 v13, 2, v117
    v_add_u32 v109, v12, v11
    v_bitop3_b32 v117, v5, v13, v14 bitop3:0xea
    ds_add_u32 v117, v2
    v_cvt_pk_bf16_f32 v120, v7, v8
    v_perm_b32 v12, v120, v120, s41
    v_bitop3_b32 v108, v4, v12, v108 bitop3:0xca
    v_perm_b32 v13, v120, v120, s42
    v_bitop3_b32 v109, v4, v13, v109 bitop3:0xca
    v_mul_hi_u32_u24 v14, 429497, v110
    v_lshrrev_b32 v12, 3, v118
    v_cos_f32 v9, v9
    v_lshlrev_b16 v13, 3, v118
    v_mad_i32_i24 v11, v14, s55, v110
    v_bitop3_b32 v12, v6, v13, v12 bitop3:0xca
    v_lshl_add_u32 v11, v11, 17, s40
    v_lshlrev_b16 v14, 8, v14
    v_lshrrev_b32 v13, 2, v118
    v_add_u32 v110, v12, v11
    v_bitop3_b32 v118, v5, v13, v14 bitop3:0xea
    ds_add_u32 v118, v2
    v_mul_hi_u32_u24 v14, 429497, v111
    v_lshrrev_b32 v12, 3, v119
    v_cos_f32 v10, v10
    v_lshlrev_b16 v13, 3, v119
    v_mad_i32_i24 v11, v14, s55, v111
    v_bitop3_b32 v12, v6, v13, v12 bitop3:0xca
    v_lshl_add_u32 v11, v11, 17, s40
    v_lshlrev_b16 v14, 8, v14
    v_lshrrev_b32 v13, 2, v119
    v_add_u32 v111, v12, v11
    v_bitop3_b32 v119, v5, v13, v14 bitop3:0xea
    ds_add_u32 v119, v2
    v_cvt_pk_bf16_f32 v121, v9, v10
    v_perm_b32 v12, v121, v121, s41
    v_bitop3_b32 v110, v4, v12, v110 bitop3:0xca
    v_perm_b32 v13, v121, v121, s42
    v_bitop3_b32 v111, v4, v13, v111 bitop3:0xca
    s_waitcnt vmcnt(10)
    v_lshlrev_b32 v7, 16, v122
    v_and_b32 v8, 0xffff0000, v122
    v_lshlrev_b32 v9, 16, v123
    v_and_b32 v10, 0xffff0000, v123
    v_mul_f32 v7, 0.15915494, v7
    v_mul_f32 v8, 0.15915494, v8
    v_mul_f32 v9, 0.15915494, v9
    v_mul_f32 v10, 0.15915494, v10
    v_mul_hi_u32_u24 v14, 429497, v92
    v_lshrrev_b32 v12, 3, v16
    v_cos_f32 v7, v7
    v_lshlrev_b16 v13, 3, v16
    v_mad_i32_i24 v11, v14, s55, v92
    v_bitop3_b32 v12, v6, v13, v12 bitop3:0xca
    v_lshl_add_u32 v11, v11, 17, s40
    v_lshlrev_b16 v14, 8, v14
    v_lshrrev_b32 v13, 2, v16
    v_add_u32 v92, v12, v11
    v_bitop3_b32 v16, v5, v13, v14 bitop3:0xea
    ds_add_u32 v16, v2
    v_mul_hi_u32_u24 v14, 429497, v93
    v_lshrrev_b32 v12, 3, v17
    v_cos_f32 v8, v8
    v_lshlrev_b16 v13, 3, v17
    v_mad_i32_i24 v11, v14, s55, v93
    v_bitop3_b32 v12, v6, v13, v12 bitop3:0xca
    v_lshl_add_u32 v11, v11, 17, s40
    v_lshlrev_b16 v14, 8, v14
    v_lshrrev_b32 v13, 2, v17
    v_add_u32 v93, v12, v11
    v_bitop3_b32 v17, v5, v13, v14 bitop3:0xea
    ds_add_u32 v17, v2
    v_cvt_pk_bf16_f32 v122, v7, v8
    v_perm_b32 v12, v122, v122, s41
    v_bitop3_b32 v92, v4, v12, v92 bitop3:0xca
    v_perm_b32 v13, v122, v122, s42
    v_bitop3_b32 v93, v4, v13, v93 bitop3:0xca
    v_mul_hi_u32_u24 v14, 429497, v94
    v_lshrrev_b32 v12, 3, v18
    v_cos_f32 v9, v9
    v_lshlrev_b16 v13, 3, v18
    v_mad_i32_i24 v11, v14, s55, v94
    v_bitop3_b32 v12, v6, v13, v12 bitop3:0xca
    v_lshl_add_u32 v11, v11, 17, s40
    v_lshlrev_b16 v14, 8, v14
    v_lshrrev_b32 v13, 2, v18
    v_add_u32 v94, v12, v11
    v_bitop3_b32 v18, v5, v13, v14 bitop3:0xea
    ds_add_u32 v18, v2
    v_mul_hi_u32_u24 v14, 429497, v95
    v_lshrrev_b32 v12, 3, v19
    v_cos_f32 v10, v10
    v_lshlrev_b16 v13, 3, v19
    v_mad_i32_i24 v11, v14, s55, v95
    v_bitop3_b32 v12, v6, v13, v12 bitop3:0xca
    v_lshl_add_u32 v11, v11, 17, s40
    v_lshlrev_b16 v14, 8, v14
    v_lshrrev_b32 v13, 2, v19
    v_add_u32 v95, v12, v11
    v_bitop3_b32 v19, v5, v13, v14 bitop3:0xea
    ds_add_u32 v19, v2
    v_cvt_pk_bf16_f32 v123, v9, v10
    v_perm_b32 v12, v123, v123, s41
    v_bitop3_b32 v94, v4, v12, v94 bitop3:0xca
    v_perm_b32 v13, v123, v123, s42
    v_bitop3_b32 v95, v4, v13, v95 bitop3:0xca
    s_setprio 0
    s_add_u32 s44, s35, 0x2a44000
    s_add_u32 s44, s44, s91
    buffer_store_dwordx4 v[24:27], v0, s[20:23], s44 offen sc1
    s_add_u32 s45, s96, 0x6000000
    s_nop 0
    v_lshlrev_b32 v24, 1, v1
    buffer_load_dwordx4 v[24:27], v24, s[12:15], s45 offen nt
    s_waitcnt vmcnt(8)
    v_lshlrev_b32 v7, 16, v28
    v_and_b32 v8, 0xffff0000, v28
    v_lshlrev_b32 v9, 16, v29
    v_and_b32 v10, 0xffff0000, v29
    v_mul_f32 v7, 0.15915494, v7
    v_mul_f32 v8, 0.15915494, v8
    v_mul_f32 v9, 0.15915494, v9
    v_mul_f32 v10, 0.15915494, v10
    v_mul_hi_u32_u24 v14, 429497, v20
    v_lshrrev_b32 v12, 3, v124
    v_cos_f32 v7, v7
    v_lshlrev_b16 v13, 3, v124
    v_mad_i32_i24 v11, v14, s55, v20
    v_bitop3_b32 v12, v6, v13, v12 bitop3:0xca
    v_lshl_add_u32 v11, v11, 17, s40
    v_lshlrev_b16 v14, 8, v14
    v_lshrrev_b32 v13, 2, v124
    v_add_u32 v20, v12, v11
    v_bitop3_b32 v124, v5, v13, v14 bitop3:0xea
    ds_add_u32 v124, v2
    v_mul_hi_u32_u24 v14, 429497, v21
    v_lshrrev_b32 v12, 3, v125
    v_cos_f32 v8, v8
    v_lshlrev_b16 v13, 3, v125
    v_mad_i32_i24 v11, v14, s55, v21
    v_bitop3_b32 v12, v6, v13, v12 bitop3:0xca
    v_lshl_add_u32 v11, v11, 17, s40
    v_lshlrev_b16 v14, 8, v14
    v_lshrrev_b32 v13, 2, v125
    v_add_u32 v21, v12, v11
    v_bitop3_b32 v125, v5, v13, v14 bitop3:0xea
    ds_add_u32 v125, v2
    v_cvt_pk_bf16_f32 v28, v7, v8
    v_perm_b32 v12, v28, v28, s41
    v_bitop3_b32 v20, v4, v12, v20 bitop3:0xca
    v_perm_b32 v13, v28, v28, s42
    v_bitop3_b32 v21, v4, v13, v21 bitop3:0xca
    v_mul_hi_u32_u24 v14, 429497, v22
    v_lshrrev_b32 v12, 3, v126
    v_cos_f32 v9, v9
    v_lshlrev_b16 v13, 3, v126
    v_mad_i32_i24 v11, v14, s55, v22
    v_bitop3_b32 v12, v6, v13, v12 bitop3:0xca
    v_lshl_add_u32 v11, v11, 17, s40
    v_lshlrev_b16 v14, 8, v14
    v_lshrrev_b32 v13, 2, v126
    v_add_u32 v22, v12, v11
    v_bitop3_b32 v126, v5, v13, v14 bitop3:0xea
    ds_add_u32 v126, v2
    v_mul_hi_u32_u24 v14, 429497, v23
    v_lshrrev_b32 v12, 3, v127
    v_cos_f32 v10, v10
    v_lshlrev_b16 v13, 3, v127
    v_mad_i32_i24 v11, v14, s55, v23
    v_bitop3_b32 v12, v6, v13, v12 bitop3:0xca
    v_lshl_add_u32 v11, v11, 17, s40
    v_lshlrev_b16 v14, 8, v14
    v_lshrrev_b32 v13, 2, v127
    v_add_u32 v23, v12, v11
    v_bitop3_b32 v127, v5, v13, v14 bitop3:0xea
    ds_add_u32 v127, v2
    v_cvt_pk_bf16_f32 v29, v9, v10
    v_perm_b32 v12, v29, v29, s41
    v_bitop3_b32 v22, v4, v12, v22 bitop3:0xca
    v_perm_b32 v13, v29, v29, s42
    v_bitop3_b32 v23, v4, v13, v23 bitop3:0xca
    s_waitcnt vmcnt(4)
    v_lshlrev_b32 v7, 16, v30
    v_and_b32 v8, 0xffff0000, v30
    v_lshlrev_b32 v9, 16, v31
    v_and_b32 v10, 0xffff0000, v31
    v_mul_f32 v7, 0.15915494, v7
    v_mul_f32 v8, 0.15915494, v8
    v_mul_f32 v9, 0.15915494, v9
    v_mul_f32 v10, 0.15915494, v10
    v_mul_hi_u32_u24 v14, 429497, v32
    v_lshrrev_b32 v12, 3, v36
    v_cos_f32 v7, v7
    v_lshlrev_b16 v13, 3, v36
    v_mad_i32_i24 v11, v14, s55, v32
    v_bitop3_b32 v12, v6, v13, v12 bitop3:0xca
    v_lshl_add_u32 v11, v11, 17, s40
    v_lshlrev_b16 v14, 8, v14
    v_lshrrev_b32 v13, 2, v36
    v_add_u32 v32, v12, v11
    v_bitop3_b32 v36, v5, v13, v14 bitop3:0xea
    ds_add_u32 v36, v2
    v_mul_hi_u32_u24 v14, 429497, v33
    v_lshrrev_b32 v12, 3, v37
    v_cos_f32 v8, v8
    v_lshlrev_b16 v13, 3, v37
    v_mad_i32_i24 v11, v14, s55, v33
    v_bitop3_b32 v12, v6, v13, v12 bitop3:0xca
    v_lshl_add_u32 v11, v11, 17, s40
    v_lshlrev_b16 v14, 8, v14
    v_lshrrev_b32 v13, 2, v37
    v_add_u32 v33, v12, v11
    v_bitop3_b32 v37, v5, v13, v14 bitop3:0xea
    ds_add_u32 v37, v2
    v_cvt_pk_bf16_f32 v30, v7, v8
    v_perm_b32 v12, v30, v30, s41
    v_bitop3_b32 v32, v4, v12, v32 bitop3:0xca
    v_perm_b32 v13, v30, v30, s42
    v_bitop3_b32 v33, v4, v13, v33 bitop3:0xca
    v_mul_hi_u32_u24 v14, 429497, v34
    v_lshrrev_b32 v12, 3, v38
    v_cos_f32 v9, v9
    v_lshlrev_b16 v13, 3, v38
    v_mad_i32_i24 v11, v14, s55, v34
    v_bitop3_b32 v12, v6, v13, v12 bitop3:0xca
    v_lshl_add_u32 v11, v11, 17, s40
    v_lshlrev_b16 v14, 8, v14
    v_lshrrev_b32 v13, 2, v38
    v_add_u32 v34, v12, v11
    v_bitop3_b32 v38, v5, v13, v14 bitop3:0xea
    ds_add_u32 v38, v2
    v_mul_hi_u32_u24 v14, 429497, v35
    v_lshrrev_b32 v12, 3, v39
    v_cos_f32 v10, v10
    v_lshlrev_b16 v13, 3, v39
    v_mad_i32_i24 v11, v14, s55, v35
    v_bitop3_b32 v12, v6, v13, v12 bitop3:0xca
    v_lshl_add_u32 v11, v11, 17, s40
    v_lshlrev_b16 v14, 8, v14
    v_lshrrev_b32 v13, 2, v39
    v_add_u32 v35, v12, v11
    v_bitop3_b32 v39, v5, v13, v14 bitop3:0xea
    ds_add_u32 v39, v2
    v_cvt_pk_bf16_f32 v31, v9, v10
    v_perm_b32 v12, v31, v31, s41
    v_bitop3_b32 v34, v4, v12, v34 bitop3:0xca
    v_perm_b32 v13, v31, v31, s42
    v_bitop3_b32 v35, v4, v13, v35 bitop3:0xca
    v_lshrrev_b32 v8, 2, v0
    v_and_b32 v7, 0x3c00, v0
    v_bitop3_b32 v7, v5, v8, v7 bitop3:0xea
    s_waitcnt lgkmcnt(0)
    s_barrier
    ds_read2st64_b32 v[8:9], v7 offset0:0 offset1:1
    ds_read2st64_b32 v[10:11], v7 offset0:2 offset1:3
    s_add_u32 s46, s35, 0x2a44000
    s_add_u32 s46, s46, s93
    buffer_store_dwordx4 v[84:87], v0, s[20:23], s46 offen sc1
    s_add_u32 s47, s96, 0x6000000
    s_lshr_b32 s47, s47, 1
    buffer_load_dwordx2 v[84:85], v1, s[16:19], s47 offen nt
    s_add_u32 s44, s97, 0x6400000
    s_lshr_b32 s44, s44, 1
    buffer_load_dwordx2 v[86:87], v1, s[16:19], s44 offen nt
    s_waitcnt lgkmcnt(0)
    v_lshl_or_b32 v12, v9, 16, v8
    v_lshl_or_b32 v13, v11, 16, v10
    v_mov_b32 v14, v12
    v_mov_b32 v15, v13
    s_nop 0
    v_add_u32_dpp v14, v14, v14 row_shr:1 row_mask:0xf bank_mask:0xf bound_ctrl:1
    v_add_u32_dpp v15, v15, v15 row_shr:1 row_mask:0xf bank_mask:0xf bound_ctrl:1
    s_nop 0
    v_add_u32_dpp v14, v14, v14 row_shr:2 row_mask:0xf bank_mask:0xf bound_ctrl:1
    v_add_u32_dpp v15, v15, v15 row_shr:2 row_mask:0xf bank_mask:0xf bound_ctrl:1
    s_nop 0
    v_add_u32_dpp v14, v14, v14 row_shr:4 row_mask:0xf bank_mask:0xf bound_ctrl:1
    v_add_u32_dpp v15, v15, v15 row_shr:4 row_mask:0xf bank_mask:0xf bound_ctrl:1
    s_nop 0
    v_add_u32_dpp v14, v14, v14 row_shr:8 row_mask:0xf bank_mask:0xf bound_ctrl:1
    v_add_u32_dpp v15, v15, v15 row_shr:8 row_mask:0xf bank_mask:0xf bound_ctrl:1
    s_nop 0
    v_add_u32_dpp v14, v14, v14 row_bcast:15 row_mask:0xa bank_mask:0xf
    v_add_u32_dpp v15, v15, v15 row_bcast:15 row_mask:0xa bank_mask:0xf
    s_nop 0
    v_add_u32_dpp v14, v14, v14 row_bcast:31 row_mask:0xc bank_mask:0xf
    v_add_u32_dpp v15, v15, v15 row_bcast:31 row_mask:0xc bank_mask:0xf
    v_readlane_b32 s48, v14, 63
    v_readlane_b32 s49, v15, 63
    s_lshl_b32 s54, s32, 2
    v_mov_b32 v8, s54
    s_and_b32 s50, s48, 0xffff
    s_lshr_b32 s51, s48, 16
    s_and_b32 s52, s49, 0xffff
    s_lshr_b32 s53, s49, 16
    s_add_u32 s51, s51, s50
    s_add_u32 s52, s52, s51
    s_add_u32 s53, s53, s52
    v_mov_b32 v9, s53
    s_mov_b64 exec, 1
    ds_write_b32 v8, v9 offset:16384
    s_mov_b64 exec, -1
    v_and_b32 v8, 60, v7
    s_waitcnt lgkmcnt(0)
    s_barrier
    ds_read_b32 v9, v8 offset:16384
    s_waitcnt lgkmcnt(0)
    v_add_u32_dpp v9, v9, v9 row_shr:1 row_mask:0xf bank_mask:0xf bound_ctrl:1
    s_nop 1
    v_add_u32_dpp v9, v9, v9 row_shr:2 row_mask:0xf bank_mask:0xf bound_ctrl:1
    s_nop 1
    v_add_u32_dpp v9, v9, v9 row_shr:4 row_mask:0xf bank_mask:0xf bound_ctrl:1
    s_nop 1
    v_add_u32_dpp v9, v9, v9 row_shr:8 row_mask:0xf bank_mask:0xf bound_ctrl:1
    s_nop 0
    v_readlane_b32 s54, v9, s32
    s_sub_u32 s54, s54, s53
    s_add_u32 s50, s50, s54
    s_add_u32 s51, s51, s54
    s_add_u32 s52, s52, s54
    s_pack_ll_b32_b16 s48, s54, s50
    s_pack_ll_b32_b16 s49, s51, s52
    v_add_u32 v14, s48, v14
    v_add_u32 v15, s49, v15
    v_sub_u32 v12, v14, v12
    v_sub_u32 v13, v15, v13
    v_and_b32 v8, 0xffff, v12
    v_lshrrev_b32 v9, 16, v12
    v_and_b32 v10, 0xffff, v13
    v_lshrrev_b32 v11, 16, v13
    ds_write2st64_b32 v7, v8, v9 offset0:0 offset1:1
    ds_write2st64_b32 v7, v10, v11 offset0:2 offset1:3
    v_and_b32 v8, 0x3f0, v0
    v_lshl_add_u32 v8, v8, 1, s36
    ds_write_b64 v8, v[12:13] offset:20480
    s_bitset0_b64 exec, 63
    s_not_b64 exec, exec
    ds_write_b64 v8, v[14:15] offset:20512
    s_mov_b64 exec, -1
    s_waitcnt lgkmcnt(0)
    s_barrier
    s_setprio 3
    ds_add_rtn_u32 v72, v72, v2
    ds_add_rtn_u32 v73, v73, v2
    ds_add_rtn_u32 v74, v74, v2
    ds_add_rtn_u32 v75, v75, v2
    ds_read_b128 v[12:15], v0 offset:20480
    v_cmp_gt_u32 vcc, 8448, v0
    ds_add_rtn_u32 v80, v80, v2
    ds_add_rtn_u32 v81, v81, v2
    ds_add_rtn_u32 v82, v82, v2
    ds_add_rtn_u32 v83, v83, v2
    s_setprio 2
    ds_add_rtn_u32 v104, v104, v2
    ds_add_rtn_u32 v105, v105, v2
    ds_add_rtn_u32 v106, v106, v2
    ds_add_rtn_u32 v107, v107, v2
    s_waitcnt lgkmcnt(8)
    s_cbranch_vccz L1_p3
    s_add_u32 s45, s35, 0x5480000
    s_mov_b64 exec, vcc
    buffer_store_dwordx4 v[12:15], v0, s[24:27], s45 offen sc1
    s_mov_b64 exec, -1
L1_p3:
    s_add_u32 s46, s35, 0x2a48000
    s_add_u32 s46, s46, s72
    buffer_store_dwordx4 v[48:51], v0, s[20:23], s46 offen sc1
    s_add_u32 s47, s97, 0x6400000
    s_nop 0
    v_lshlrev_b32 v48, 1, v1
    buffer_load_dwordx4 v[48:51], v48, s[8:11], s47 offen nt
    ds_add_rtn_u32 v112, v112, v2
    ds_add_rtn_u32 v113, v113, v2
    ds_add_rtn_u32 v114, v114, v2
    ds_add_rtn_u32 v115, v115, v2
    s_setprio 1
    ds_add_rtn_u32 v116, v116, v2
    ds_add_rtn_u32 v117, v117, v2
    ds_add_rtn_u32 v118, v118, v2
    ds_add_rtn_u32 v119, v119, v2
    ds_add_rtn_u32 v16, v16, v2
    ds_add_rtn_u32 v17, v17, v2
    ds_add_rtn_u32 v18, v18, v2
    ds_add_rtn_u32 v19, v19, v2
    s_add_u32 s44, s35, 0x2a48000
    s_add_u32 s44, s44, s73
    buffer_store_dwordx4 v[52:55], v0, s[20:23], s44 offen sc1
    s_add_u32 s45, s97, 0x6400000
    s_nop 0
    v_lshlrev_b32 v52, 1, v1
    buffer_load_dwordx4 v[52:55], v52, s[12:15], s45 offen nt
    s_setprio 0
    ds_add_rtn_u32 v124, v124, v2
    ds_add_rtn_u32 v125, v125, v2
    ds_add_rtn_u32 v126, v126, v2
    ds_add_rtn_u32 v127, v127, v2
    ds_add_rtn_u32 v36, v36, v2
    ds_add_rtn_u32 v37, v37, v2
    ds_add_rtn_u32 v38, v38, v2
    ds_add_rtn_u32 v39, v39, v2
    s_waitcnt lgkmcnt(0)
    s_barrier
    s_setprio 3
    v_and_b32 v7, -4, v72
    v_lshl_add_u32 v8, v72, 2, v7
    ds_write_b32 v8, v68
    v_lshl_add_u32 v7, v7, 2, v72
    ds_write_b8 v7, v64 offset:16
    v_and_b32 v9, -4, v73
    v_lshl_add_u32 v10, v73, 2, v9
    ds_write_b32 v10, v69
    v_lshl_add_u32 v9, v9, 2, v73
    ds_write_b8_d16_hi v9, v64 offset:16
    v_and_b32 v7, -4, v74
    v_lshl_add_u32 v8, v74, 2, v7
    ds_write_b32 v8, v70
    v_lshl_add_u32 v7, v7, 2, v74
    ds_write_b8 v7, v65 offset:16
    v_and_b32 v9, -4, v75
    v_lshl_add_u32 v10, v75, 2, v9
    ds_write_b32 v10, v71
    v_lshl_add_u32 v9, v9, 2, v75
    ds_write_b8_d16_hi v9, v65 offset:16
    s_add_u32 s46, s35, 0x2a48000
    s_add_u32 s46, s46, s85
    buffer_store_dwordx4 v[56:59], v0, s[20:23], s46 offen sc1
    s_add_u32 s47, s98, 0x6800000
    v_lshlrev_b32 v68, 1, v1
    buffer_load_dwordx4 v[68:71], v68, s[8:11], s47 offen nt
    s_add_u32 s44, s98, 0x6800000
    v_lshlrev_b32 v72, 1, v1
    buffer_load_dwordx4 v[72:75], v72, s[12:15], s44 offen nt
    v_and_b32 v7, -4, v80
    v_lshl_add_u32 v8, v80, 2, v7
    ds_write_b32 v8, v76
    v_lshl_add_u32 v7, v7, 2, v80
    ds_write_b8 v7, v66 offset:16
    v_and_b32 v9, -4, v81
    v_lshl_add_u32 v10, v81, 2, v9
    ds_write_b32 v10, v77
    v_lshl_add_u32 v9, v9, 2, v81
    ds_write_b8_d16_hi v9, v66 offset:16
    v_and_b32 v7, -4, v82
    v_lshl_add_u32 v8, v82, 2, v7
    ds_write_b32 v8, v78
    v_lshl_add_u32 v7, v7, 2, v82
    ds_write_b8 v7, v67 offset:16
    v_and_b32 v9, -4, v83
    v_lshl_add_u32 v10, v83, 2, v9
    ds_write_b32 v10, v79
    v_lshl_add_u32 v9, v9, 2, v83
    ds_write_b8_d16_hi v9, v67 offset:16
    s_add_u32 s45, s98, 0x6800000
    s_lshr_b32 s45, s45, 1
    buffer_load_dwordx2 v[56:57], v1, s[16:19], s45 offen nt
    s_add_u32 s46, s99, 0x6c00000
    s_lshr_b32 s46, s46, 1
    buffer_load_dwordx2 v[58:59], v1, s[16:19], s46 offen nt
    s_add_u32 s47, s99, 0x6c00000
    v_lshlrev_b32 v76, 1, v1
    buffer_load_dwordx4 v[76:79], v76, s[8:11], s47 offen nt
    s_setprio 2
    v_and_b32 v7, -4, v104
    v_lshl_add_u32 v8, v104, 2, v7
    ds_write_b32 v8, v96
    v_lshl_add_u32 v7, v7, 2, v104
    ds_write_b8 v7, v88 offset:16
    v_and_b32 v9, -4, v105
    v_lshl_add_u32 v10, v105, 2, v9
    ds_write_b32 v10, v97
    v_lshl_add_u32 v9, v9, 2, v105
    ds_write_b8_d16_hi v9, v88 offset:16
    v_and_b32 v7, -4, v106
    v_lshl_add_u32 v8, v106, 2, v7
    ds_write_b32 v8, v98
    v_lshl_add_u32 v7, v7, 2, v106
    ds_write_b8 v7, v89 offset:16
    v_and_b32 v9, -4, v107
    v_lshl_add_u32 v10, v107, 2, v9
    ds_write_b32 v10, v99
    v_lshl_add_u32 v9, v9, 2, v107
    ds_write_b8_d16_hi v9, v89 offset:16
    s_add_u32 s44, s35, 0x2a48000
    s_add_u32 s44, s44, s91
    buffer_store_dwordx4 v[60:63], v0, s[20:23], s44 offen sc1
    s_add_u32 s45, s99, 0x6c00000
    v_lshlrev_b32 v80, 1, v1
    buffer_load_dwordx4 v[80:83], v80, s[12:15], s45 offen nt
    v_and_b32 v7, -4, v112
    v_lshl_add_u32 v8, v112, 2, v7
    ds_write_b32 v8, v100
    v_lshl_add_u32 v7, v7, 2, v112
    ds_write_b8 v7, v90 offset:16
    v_and_b32 v9, -4, v113
    v_lshl_add_u32 v10, v113, 2, v9
    ds_write_b32 v10, v101
    v_lshl_add_u32 v9, v9, 2, v113
    ds_write_b8_d16_hi v9, v90 offset:16
    v_and_b32 v7, -4, v114
    v_lshl_add_u32 v8, v114, 2, v7
    ds_write_b32 v8, v102
    v_lshl_add_u32 v7, v7, 2, v114
    ds_write_b8 v7, v91 offset:16
    v_and_b32 v9, -4, v115
    v_lshl_add_u32 v10, v115, 2, v9
    ds_write_b32 v10, v103
    v_lshl_add_u32 v9, v9, 2, v115
    ds_write_b8_d16_hi v9, v91 offset:16
    s_add_u32 s46, s96, 0x7000000
    v_lshlrev_b32 v64, 1, v1
    buffer_load_dwordx4 v[64:67], v64, s[8:11], s46 offen nt
    s_add_u32 s47, s96, 0x7000000
    v_lshlrev_b32 v96, 1, v1
    buffer_load_dwordx4 v[96:99], v96, s[12:15], s47 offen nt
    s_setprio 1
    v_and_b32 v7, -4, v116
    v_lshl_add_u32 v8, v116, 2, v7
    ds_write_b32 v8, v108
    v_lshl_add_u32 v7, v7, 2, v116
    ds_write_b8 v7, v120 offset:16
    v_and_b32 v9, -4, v117
    v_lshl_add_u32 v10, v117, 2, v9
    ds_write_b32 v10, v109
    v_lshl_add_u32 v9, v9, 2, v117
    ds_write_b8_d16_hi v9, v120 offset:16
    v_and_b32 v7, -4, v118
    v_lshl_add_u32 v8, v118, 2, v7
    ds_write_b32 v8, v110
    v_lshl_add_u32 v7, v7, 2, v118
    ds_write_b8 v7, v121 offset:16
    v_and_b32 v9, -4, v119
    v_lshl_add_u32 v10, v119, 2, v9
    ds_write_b32 v10, v111
    v_lshl_add_u32 v9, v9, 2, v119
    ds_write_b8_d16_hi v9, v121 offset:16
    s_add_u32 s44, s96, 0x7000000
    s_lshr_b32 s44, s44, 1
    buffer_load_dwordx2 v[104:105], v1, s[16:19], s44 offen nt
    s_add_u32 s45, s97, 0x7400000
    s_lshr_b32 s45, s45, 1
    buffer_load_dwordx2 v[106:107], v1, s[16:19], s45 offen nt
    s_add_u32 s46, s97, 0x7400000
    v_lshlrev_b32 v60, 1, v1
    buffer_load_dwordx4 v[60:63], v60, s[8:11], s46 offen nt
    v_and_b32 v7, -4, v16
    v_lshl_add_u32 v8, v16, 2, v7
    ds_write_b32 v8, v92
    v_lshl_add_u32 v7, v7, 2, v16
    ds_write_b8 v7, v122 offset:16
    v_and_b32 v9, -4, v17
    v_lshl_add_u32 v10, v17, 2, v9
    ds_write_b32 v10, v93
    v_lshl_add_u32 v9, v9, 2, v17
    ds_write_b8_d16_hi v9, v122 offset:16
    v_and_b32 v7, -4, v18
    v_lshl_add_u32 v8, v18, 2, v7
    ds_write_b32 v8, v94
    v_lshl_add_u32 v7, v7, 2, v18
    ds_write_b8 v7, v123 offset:16
    v_and_b32 v9, -4, v19
    v_lshl_add_u32 v10, v19, 2, v9
    ds_write_b32 v10, v95
    v_lshl_add_u32 v9, v9, 2, v19
    ds_write_b8_d16_hi v9, v123 offset:16
    s_add_u32 s47, s35, 0x2a48000
    s_add_u32 s47, s47, s93
    buffer_store_dwordx4 v[44:47], v0, s[20:23], s47 offen sc1
    s_add_u32 s44, s97, 0x7400000
    v_lshlrev_b32 v100, 1, v1
    buffer_load_dwordx4 v[100:103], v100, s[12:15], s44 offen nt
    s_setprio 0
    v_and_b32 v7, -4, v124
    v_lshl_add_u32 v8, v124, 2, v7
    ds_write_b32 v8, v20
    v_lshl_add_u32 v7, v7, 2, v124
    ds_write_b8 v7, v28 offset:16
    v_and_b32 v9, -4, v125
    v_lshl_add_u32 v10, v125, 2, v9
    ds_write_b32 v10, v21
    v_lshl_add_u32 v9, v9, 2, v125
    ds_write_b8_d16_hi v9, v28 offset:16
    v_and_b32 v7, -4, v126
    v_lshl_add_u32 v8, v126, 2, v7
    ds_write_b32 v8, v22
    v_lshl_add_u32 v7, v7, 2, v126
    ds_write_b8 v7, v29 offset:16
    v_and_b32 v9, -4, v127
    v_lshl_add_u32 v10, v127, 2, v9
    ds_write_b32 v10, v23
    v_lshl_add_u32 v9, v9, 2, v127
    ds_write_b8_d16_hi v9, v29 offset:16
    s_add_u32 s45, s98, 0x7800000
    v_lshlrev_b32 v112, 1, v1
    buffer_load_dwordx4 v[112:115], v112, s[8:11], s45 offen nt
    s_add_u32 s46, s98, 0x7800000
    v_lshlrev_b32 v88, 1, v1
    buffer_load_dwordx4 v[88:91], v88, s[12:15], s46 offen nt
    v_and_b32 v7, -4, v36
    v_lshl_add_u32 v8, v36, 2, v7
    ds_write_b32 v8, v32
    v_lshl_add_u32 v7, v7, 2, v36
    ds_write_b8 v7, v30 offset:16
    v_and_b32 v9, -4, v37
    v_lshl_add_u32 v10, v37, 2, v9
    ds_write_b32 v10, v33
    v_lshl_add_u32 v9, v9, 2, v37
    ds_write_b8_d16_hi v9, v30 offset:16
    v_and_b32 v7, -4, v38
    v_lshl_add_u32 v8, v38, 2, v7
    ds_write_b32 v8, v34
    v_lshl_add_u32 v7, v7, 2, v38
    ds_write_b8 v7, v31 offset:16
    v_and_b32 v9, -4, v39
    v_lshl_add_u32 v10, v39, 2, v9
    ds_write_b32 v10, v35
    v_lshl_add_u32 v9, v9, 2, v39
    ds_write_b8_d16_hi v9, v31 offset:16
    s_add_u32 s47, s98, 0x7800000
    s_lshr_b32 s47, s47, 1
    buffer_load_dwordx2 v[108:109], v1, s[16:19], s47 offen nt
    s_add_u32 s44, s99, 0x7c00000
    s_lshr_b32 s44, s44, 1
    buffer_load_dwordx2 v[110:111], v1, s[16:19], s44 offen nt
    v_add_u32 v7, s72, v0
    v_add_u32 v12, s73, v0
    v_add_u32 v13, s85, v0
    v_add_u32 v14, s91, v0
    v_add_u32 v15, s93, v0
    s_min_i32 s3, s72, s73
    s_min_i32 s3, s3, s85
    s_min_i32 s3, s3, s91
    s_min_i32 s3, s3, s93
    v_add_u32 v3, s3, v0
    v_mov_b32 v8, 0
    v_mov_b32 v9, 0
    v_mov_b32 v10, 0
    v_mov_b32 v11, 0
    s_waitcnt lgkmcnt(0)
    s_barrier
    ds_read_b128 v[116:119], v7 offset:0
    ds_read_b128 v[92:95], v12 offset:0
    ds_read_b128 v[16:19], v13 offset:0
    ds_read_b128 v[120:123], v14 offset:0
    ds_read_b128 v[44:47], v15 offset:0
    ds_write_b128 v3, v[8:11]
    ds_read_b128 v[20:23], v7 offset:16384
    ds_read_b128 v[124:127], v12 offset:16384
    ds_read_b128 v[32:35], v13 offset:16384
    ds_read_b128 v[36:39], v14 offset:16384
    ds_read_b128 v[28:31], v15 offset:16384
    s_waitcnt lgkmcnt(0)
    s_barrier
    s_setprio 3
    s_add_u32 s45, s35, 0x5484000
    s_add_u32 s45, s45, s72
    buffer_store_dwordx4 v[116:119], v0, s[20:23], s45 offen sc1
    s_add_u32 s46, s99, 0x7c00000
    s_nop 0
    v_lshlrev_b32 v116, 1, v1
    buffer_load_dwordx4 v[116:119], v116, s[8:11], s46 offen nt
    s_add_u32 s47, s35, 0x5484000
    s_add_u32 s47, s47, s73
    buffer_store_dwordx4 v[92:95], v0, s[20:23], s47 offen sc1
    s_add_u32 s44, s99, 0x7c00000
    s_nop 0
    v_lshlrev_b32 v92, 1, v1
    buffer_load_dwordx4 v[92:95], v92, s[12:15], s44 offen nt
    s_waitcnt vmcnt(27)
    v_lshlrev_b32 v7, 16, v84
    v_and_b32 v8, 0xffff0000, v84
    v_lshlrev_b32 v9, 16, v85
    v_and_b32 v10, 0xffff0000, v85
    v_mul_f32 v7, 0.15915494, v7
    v_mul_f32 v8, 0.15915494, v8
    v_mul_f32 v9, 0.15915494, v9
    v_mul_f32 v10, 0.15915494, v10
    v_mul_hi_u32_u24 v14, 429497, v40
    v_lshrrev_b32 v12, 3, v24
    v_cos_f32 v7, v7
    v_lshlrev_b16 v13, 3, v24
    v_mad_i32_i24 v11, v14, s55, v40
    v_bitop3_b32 v12, v6, v13, v12 bitop3:0xca
    v_lshl_add_u32 v11, v11, 17, s40
    v_lshlrev_b16 v14, 8, v14
    v_lshrrev_b32 v13, 2, v24
    v_add_u32 v40, v12, v11
    v_bitop3_b32 v24, v5, v13, v14 bitop3:0xea
    ds_add_u32 v24, v2
    v_mul_hi_u32_u24 v14, 429497, v41
    v_lshrrev_b32 v12, 3, v25
    v_cos_f32 v8, v8
    v_lshlrev_b16 v13, 3, v25
    v_mad_i32_i24 v11, v14, s55, v41
    v_bitop3_b32 v12, v6, v13, v12 bitop3:0xca
    v_lshl_add_u32 v11, v11, 17, s40
    v_lshlrev_b16 v14, 8, v14
    v_lshrrev_b32 v13, 2, v25
    v_add_u32 v41, v12, v11
    v_bitop3_b32 v25, v5, v13, v14 bitop3:0xea
    ds_add_u32 v25, v2
    v_cvt_pk_bf16_f32 v84, v7, v8
    v_perm_b32 v12, v84, v84, s41
    v_bitop3_b32 v40, v4, v12, v40 bitop3:0xca
    v_perm_b32 v13, v84, v84, s42
    v_bitop3_b32 v41, v4, v13, v41 bitop3:0xca
    v_mul_hi_u32_u24 v14, 429497, v42
    v_lshrrev_b32 v12, 3, v26
    v_cos_f32 v9, v9
    v_lshlrev_b16 v13, 3, v26
    v_mad_i32_i24 v11, v14, s55, v42
    v_bitop3_b32 v12, v6, v13, v12 bitop3:0xca
    v_lshl_add_u32 v11, v11, 17, s40
    v_lshlrev_b16 v14, 8, v14
    v_lshrrev_b32 v13, 2, v26
    v_add_u32 v42, v12, v11
    v_bitop3_b32 v26, v5, v13, v14 bitop3:0xea
    ds_add_u32 v26, v2
    v_mul_hi_u32_u24 v14, 429497, v43
    v_lshrrev_b32 v12, 3, v27
    v_cos_f32 v10, v10
    v_lshlrev_b16 v13, 3, v27
    v_mad_i32_i24 v11, v14, s55, v43
    v_bitop3_b32 v12, v6, v13, v12 bitop3:0xca
    v_lshl_add_u32 v11, v11, 17, s40
    v_lshlrev_b16 v14, 8, v14
    v_lshrrev_b32 v13, 2, v27
    v_add_u32 v43, v12, v11
    v_bitop3_b32 v27, v5, v13, v14 bitop3:0xea
    ds_add_u32 v27, v2
    v_cvt_pk_bf16_f32 v85, v9, v10
    v_perm_b32 v12, v85, v85, s41
    v_bitop3_b32 v42, v4, v12, v42 bitop3:0xca
    v_perm_b32 v13, v85, v85, s42
    v_bitop3_b32 v43, v4, v13, v43 bitop3:0xca
    s_waitcnt vmcnt(23)
    v_lshlrev_b32 v7, 16, v86
    v_and_b32 v8, 0xffff0000, v86
    v_lshlrev_b32 v9, 16, v87
    v_and_b32 v10, 0xffff0000, v87
    v_mul_f32 v7, 0.15915494, v7
    v_mul_f32 v8, 0.15915494, v8
    v_mul_f32 v9, 0.15915494, v9
    v_mul_f32 v10, 0.15915494, v10
    v_mul_hi_u32_u24 v14, 429497, v48
    v_lshrrev_b32 v12, 3, v52
    v_cos_f32 v7, v7
    v_lshlrev_b16 v13, 3, v52
    v_mad_i32_i24 v11, v14, s55, v48
    v_bitop3_b32 v12, v6, v13, v12 bitop3:0xca
    v_lshl_add_u32 v11, v11, 17, s40
    v_lshlrev_b16 v14, 8, v14
    v_lshrrev_b32 v13, 2, v52
    v_add_u32 v48, v12, v11
    v_bitop3_b32 v52, v5, v13, v14 bitop3:0xea
    ds_add_u32 v52, v2
    v_mul_hi_u32_u24 v14, 429497, v49
    v_lshrrev_b32 v12, 3, v53
    v_cos_f32 v8, v8
    v_lshlrev_b16 v13, 3, v53
    v_mad_i32_i24 v11, v14, s55, v49
    v_bitop3_b32 v12, v6, v13, v12 bitop3:0xca
    v_lshl_add_u32 v11, v11, 17, s40
    v_lshlrev_b16 v14, 8, v14
    v_lshrrev_b32 v13, 2, v53
    v_add_u32 v49, v12, v11
    v_bitop3_b32 v53, v5, v13, v14 bitop3:0xea
    ds_add_u32 v53, v2
    v_cvt_pk_bf16_f32 v86, v7, v8
    v_perm_b32 v12, v86, v86, s41
    v_bitop3_b32 v48, v4, v12, v48 bitop3:0xca
    v_perm_b32 v13, v86, v86, s42
    v_bitop3_b32 v49, v4, v13, v49 bitop3:0xca
    v_mul_hi_u32_u24 v14, 429497, v50
    v_lshrrev_b32 v12, 3, v54
    v_cos_f32 v9, v9
    v_lshlrev_b16 v13, 3, v54
    v_mad_i32_i24 v11, v14, s55, v50
    v_bitop3_b32 v12, v6, v13, v12 bitop3:0xca
    v_lshl_add_u32 v11, v11, 17, s40
    v_lshlrev_b16 v14, 8, v14
    v_lshrrev_b32 v13, 2, v54
    v_add_u32 v50, v12, v11
    v_bitop3_b32 v54, v5, v13, v14 bitop3:0xea
    ds_add_u32 v54, v2
    v_mul_hi_u32_u24 v14, 429497, v51
    v_lshrrev_b32 v12, 3, v55
    v_cos_f32 v10, v10
    v_lshlrev_b16 v13, 3, v55
    v_mad_i32_i24 v11, v14, s55, v51
    v_bitop3_b32 v12, v6, v13, v12 bitop3:0xca
    v_lshl_add_u32 v11, v11, 17, s40
    v_lshlrev_b16 v14, 8, v14
    v_lshrrev_b32 v13, 2, v55
    v_add_u32 v51, v12, v11
    v_bitop3_b32 v55, v5, v13, v14 bitop3:0xea
    ds_add_u32 v55, v2
    v_cvt_pk_bf16_f32 v87, v9, v10
    v_perm_b32 v12, v87, v87, s41
    v_bitop3_b32 v50, v4, v12, v50 bitop3:0xca
    v_perm_b32 v13, v87, v87, s42
    v_bitop3_b32 v51, v4, v13, v51 bitop3:0xca
    s_setprio 2
    s_waitcnt vmcnt(18)
    v_lshlrev_b32 v7, 16, v56
    v_and_b32 v8, 0xffff0000, v56
    v_lshlrev_b32 v9, 16, v57
    v_and_b32 v10, 0xffff0000, v57
    v_mul_f32 v7, 0.15915494, v7
    v_mul_f32 v8, 0.15915494, v8
    v_mul_f32 v9, 0.15915494, v9
    v_mul_f32 v10, 0.15915494, v10
    v_mul_hi_u32_u24 v14, 429497, v68
    v_lshrrev_b32 v12, 3, v72
    v_cos_f32 v7, v7
    v_lshlrev_b16 v13, 3, v72
    v_mad_i32_i24 v11, v14, s55, v68
    v_bitop3_b32 v12, v6, v13, v12 bitop3:0xca
    v_lshl_add_u32 v11, v11, 17, s40
    v_lshlrev_b16 v14, 8, v14
    v_lshrrev_b32 v13, 2, v72
    v_add_u32 v68, v12, v11
    v_bitop3_b32 v72, v5, v13, v14 bitop3:0xea
    ds_add_u32 v72, v2
    v_mul_hi_u32_u24 v14, 429497, v69
    v_lshrrev_b32 v12, 3, v73
    v_cos_f32 v8, v8
    v_lshlrev_b16 v13, 3, v73
    v_mad_i32_i24 v11, v14, s55, v69
    v_bitop3_b32 v12, v6, v13, v12 bitop3:0xca
    v_lshl_add_u32 v11, v11, 17, s40
    v_lshlrev_b16 v14, 8, v14
    v_lshrrev_b32 v13, 2, v73
    v_add_u32 v69, v12, v11
    v_bitop3_b32 v73, v5, v13, v14 bitop3:0xea
    ds_add_u32 v73, v2
    v_cvt_pk_bf16_f32 v56, v7, v8
    v_perm_b32 v12, v56, v56, s41
    v_bitop3_b32 v68, v4, v12, v68 bitop3:0xca
    v_perm_b32 v13, v56, v56, s42
    v_bitop3_b32 v69, v4, v13, v69 bitop3:0xca
    v_mul_hi_u32_u24 v14, 429497, v70
    v_lshrrev_b32 v12, 3, v74
    v_cos_f32 v9, v9
    v_lshlrev_b16 v13, 3, v74
    v_mad_i32_i24 v11, v14, s55, v70
    v_bitop3_b32 v12, v6, v13, v12 bitop3:0xca
    v_lshl_add_u32 v11, v11, 17, s40
    v_lshlrev_b16 v14, 8, v14
    v_lshrrev_b32 v13, 2, v74
    v_add_u32 v70, v12, v11
    v_bitop3_b32 v74, v5, v13, v14 bitop3:0xea
    ds_add_u32 v74, v2
    v_mul_hi_u32_u24 v14, 429497, v71
    v_lshrrev_b32 v12, 3, v75
    v_cos_f32 v10, v10
    v_lshlrev_b16 v13, 3, v75
    v_mad_i32_i24 v11, v14, s55, v71
    v_bitop3_b32 v12, v6, v13, v12 bitop3:0xca
    v_lshl_add_u32 v11, v11, 17, s40
    v_lshlrev_b16 v14, 8, v14
    v_lshrrev_b32 v13, 2, v75
    v_add_u32 v71, v12, v11
    v_bitop3_b32 v75, v5, v13, v14 bitop3:0xea
    ds_add_u32 v75, v2
    v_cvt_pk_bf16_f32 v57, v9, v10
    v_perm_b32 v12, v57, v57, s41
    v_bitop3_b32 v70, v4, v12, v70 bitop3:0xca
    v_perm_b32 v13, v57, v57, s42
    v_bitop3_b32 v71, v4, v13, v71 bitop3:0xca
    s_add_u32 s45, s35, 0x5484000
    s_add_u32 s45, s45, s85
    buffer_store_dwordx4 v[16:19], v0, s[20:23], s45 offen sc1
    s_add_u32 s46, s96, 0x8000000
    s_nop 0
    v_lshlrev_b32 v16, 1, v1
    buffer_load_dwordx4 v[16:19], v16, s[8:11], s46 offen nt
    s_waitcnt vmcnt(17)
    v_lshlrev_b32 v7, 16, v58
    v_and_b32 v8, 0xffff0000, v58
    v_lshlrev_b32 v9, 16, v59
    v_and_b32 v10, 0xffff0000, v59
    v_mul_f32 v7, 0.15915494, v7
    v_mul_f32 v8, 0.15915494, v8
    v_mul_f32 v9, 0.15915494, v9
    v_mul_f32 v10, 0.15915494, v10
    v_mul_hi_u32_u24 v14, 429497, v76
    v_lshrrev_b32 v12, 3, v80
    v_cos_f32 v7, v7
    v_lshlrev_b16 v13, 3, v80
    v_mad_i32_i24 v11, v14, s55, v76
    v_bitop3_b32 v12, v6, v13, v12 bitop3:0xca
    v_lshl_add_u32 v11, v11, 17, s40
    v_lshlrev_b16 v14, 8, v14
    v_lshrrev_b32 v13, 2, v80
    v_add_u32 v76, v12, v11
    v_bitop3_b32 v80, v5, v13, v14 bitop3:0xea
    ds_add_u32 v80, v2
    v_mul_hi_u32_u24 v14, 429497, v77
    v_lshrrev_b32 v12, 3, v81
    v_cos_f32 v8, v8
    v_lshlrev_b16 v13, 3, v81
    v_mad_i32_i24 v11, v14, s55, v77
    v_bitop3_b32 v12, v6, v13, v12 bitop3:0xca
    v_lshl_add_u32 v11, v11, 17, s40
    v_lshlrev_b16 v14, 8, v14
    v_lshrrev_b32 v13, 2, v81
    v_add_u32 v77, v12, v11
    v_bitop3_b32 v81, v5, v13, v14 bitop3:0xea
    ds_add_u32 v81, v2
    v_cvt_pk_bf16_f32 v58, v7, v8
    v_perm_b32 v12, v58, v58, s41
    v_bitop3_b32 v76, v4, v12, v76 bitop3:0xca
    v_perm_b32 v13, v58, v58, s42
    v_bitop3_b32 v77, v4, v13, v77 bitop3:0xca
    v_mul_hi_u32_u24 v14, 429497, v78
    v_lshrrev_b32 v12, 3, v82
    v_cos_f32 v9, v9
    v_lshlrev_b16 v13, 3, v82
    v_mad_i32_i24 v11, v14, s55, v78
    v_bitop3_b32 v12, v6, v13, v12 bitop3:0xca
    v_lshl_add_u32 v11, v11, 17, s40
    v_lshlrev_b16 v14, 8, v14
    v_lshrrev_b32 v13, 2, v82
    v_add_u32 v78, v12, v11
    v_bitop3_b32 v82, v5, v13, v14 bitop3:0xea
    ds_add_u32 v82, v2
    v_mul_hi_u32_u24 v14, 429497, v79
    v_lshrrev_b32 v12, 3, v83
    v_cos_f32 v10, v10
    v_lshlrev_b16 v13, 3, v83
    v_mad_i32_i24 v11, v14, s55, v79
    v_bitop3_b32 v12, v6, v13, v12 bitop3:0xca
    v_lshl_add_u32 v11, v11, 17, s40
    v_lshlrev_b16 v14, 8, v14
    v_lshrrev_b32 v13, 2, v83
    v_add_u32 v79, v12, v11
    v_bitop3_b32 v83, v5, v13, v14 bitop3:0xea
    ds_add_u32 v83, v2
    v_cvt_pk_bf16_f32 v59, v9, v10
    v_perm_b32 v12, v59, v59, s41
    v_bitop3_b32 v78, v4, v12, v78 bitop3:0xca
    v_perm_b32 v13, v59, v59, s42
    v_bitop3_b32 v79, v4, v13, v79 bitop3:0xca
    s_setprio 1
    s_waitcnt vmcnt(13)
    v_lshlrev_b32 v7, 16, v104
    v_and_b32 v8, 0xffff0000, v104
    v_lshlrev_b32 v9, 16, v105
    v_and_b32 v10, 0xffff0000, v105
    v_mul_f32 v7, 0.15915494, v7
    v_mul_f32 v8, 0.15915494, v8
    v_mul_f32 v9, 0.15915494, v9
    v_mul_f32 v10, 0.15915494, v10
    v_mul_hi_u32_u24 v14, 429497, v64
    v_lshrrev_b32 v12, 3, v96
    v_cos_f32 v7, v7
    v_lshlrev_b16 v13, 3, v96
    v_mad_i32_i24 v11, v14, s55, v64
    v_bitop3_b32 v12, v6, v13, v12 bitop3:0xca
    v_lshl_add_u32 v11, v11, 17, s40
    v_lshlrev_b16 v14, 8, v14
    v_lshrrev_b32 v13, 2, v96
    v_add_u32 v64, v12, v11
    v_bitop3_b32 v96, v5, v13, v14 bitop3:0xea
    ds_add_u32 v96, v2
    v_mul_hi_u32_u24 v14, 429497, v65
    v_lshrrev_b32 v12, 3, v97
    v_cos_f32 v8, v8
    v_lshlrev_b16 v13, 3, v97
    v_mad_i32_i24 v11, v14, s55, v65
    v_bitop3_b32 v12, v6, v13, v12 bitop3:0xca
    v_lshl_add_u32 v11, v11, 17, s40
    v_lshlrev_b16 v14, 8, v14
    v_lshrrev_b32 v13, 2, v97
    v_add_u32 v65, v12, v11
    v_bitop3_b32 v97, v5, v13, v14 bitop3:0xea
    ds_add_u32 v97, v2
    v_cvt_pk_bf16_f32 v104, v7, v8
    v_perm_b32 v12, v104, v104, s41
    v_bitop3_b32 v64, v4, v12, v64 bitop3:0xca
    v_perm_b32 v13, v104, v104, s42
    v_bitop3_b32 v65, v4, v13, v65 bitop3:0xca
    v_mul_hi_u32_u24 v14, 429497, v66
    v_lshrrev_b32 v12, 3, v98
    v_cos_f32 v9, v9
    v_lshlrev_b16 v13, 3, v98
    v_mad_i32_i24 v11, v14, s55, v66
    v_bitop3_b32 v12, v6, v13, v12 bitop3:0xca
    v_lshl_add_u32 v11, v11, 17, s40
    v_lshlrev_b16 v14, 8, v14
    v_lshrrev_b32 v13, 2, v98
    v_add_u32 v66, v12, v11
    v_bitop3_b32 v98, v5, v13, v14 bitop3:0xea
    ds_add_u32 v98, v2
    v_mul_hi_u32_u24 v14, 429497, v67
    v_lshrrev_b32 v12, 3, v99
    v_cos_f32 v10, v10
    v_lshlrev_b16 v13, 3, v99
    v_mad_i32_i24 v11, v14, s55, v67
    v_bitop3_b32 v12, v6, v13, v12 bitop3:0xca
    v_lshl_add_u32 v11, v11, 17, s40
    v_lshlrev_b16 v14, 8, v14
    v_lshrrev_b32 v13, 2, v99
    v_add_u32 v67, v12, v11
    v_bitop3_b32 v99, v5, v13, v14 bitop3:0xea
    ds_add_u32 v99, v2
    v_cvt_pk_bf16_f32 v105, v9, v10
    v_perm_b32 v12, v105, v105, s41
    v_bitop3_b32 v66, v4, v12, v66 bitop3:0xca
    v_perm_b32 v13, v105, v105, s42
    v_bitop3_b32 v67, v4, v13, v67 bitop3:0xca
    s_mov_b32 s68, s66
    s_mov_b32 s69, s67
    s_mov_b32 s70, 0x100
    s_mov_b32 s71, 0x20000
    v_mov_b32 v3, 1
    s_cmp_lg_u32 s32, 15
    s_cbranch_scc1 L1_tk
    s_mov_b64 exec, 1
    s_and_b32 s3, s2, 1
    s_lshl_b32 s3, s3, 7
    buffer_atomic_add v3, off, s[68:71], s3 sc0
    s_mov_b64 exec, -1
L1_tk:
    s_waitcnt vmcnt(10)
    v_lshlrev_b32 v7, 16, v106
    v_and_b32 v8, 0xffff0000, v106
    v_lshlrev_b32 v9, 16, v107
    v_and_b32 v10, 0xffff0000, v107
    v_mul_f32 v7, 0.15915494, v7
    v_mul_f32 v8, 0.15915494, v8
    v_mul_f32 v9, 0.15915494, v9
    v_mul_f32 v10, 0.15915494, v10
    v_mul_hi_u32_u24 v14, 429497, v60
    v_lshrrev_b32 v12, 3, v100
    v_cos_f32 v7, v7
    v_lshlrev_b16 v13, 3, v100
    v_mad_i32_i24 v11, v14, s55, v60
    v_bitop3_b32 v12, v6, v13, v12 bitop3:0xca
    v_lshl_add_u32 v11, v11, 17, s40
    v_lshlrev_b16 v14, 8, v14
    v_lshrrev_b32 v13, 2, v100
    v_add_u32 v60, v12, v11
    v_bitop3_b32 v100, v5, v13, v14 bitop3:0xea
    ds_add_u32 v100, v2
    v_mul_hi_u32_u24 v14, 429497, v61
    v_lshrrev_b32 v12, 3, v101
    v_cos_f32 v8, v8
    v_lshlrev_b16 v13, 3, v101
    v_mad_i32_i24 v11, v14, s55, v61
    v_bitop3_b32 v12, v6, v13, v12 bitop3:0xca
    v_lshl_add_u32 v11, v11, 17, s40
    v_lshlrev_b16 v14, 8, v14
    v_lshrrev_b32 v13, 2, v101
    v_add_u32 v61, v12, v11
    v_bitop3_b32 v101, v5, v13, v14 bitop3:0xea
    ds_add_u32 v101, v2
    v_cvt_pk_bf16_f32 v106, v7, v8
    v_perm_b32 v12, v106, v106, s41
    v_bitop3_b32 v60, v4, v12, v60 bitop3:0xca
    v_perm_b32 v13, v106, v106, s42
    v_bitop3_b32 v61, v4, v13, v61 bitop3:0xca
    v_mul_hi_u32_u24 v14, 429497, v62
    v_lshrrev_b32 v12, 3, v102
    v_cos_f32 v9, v9
    v_lshlrev_b16 v13, 3, v102
    v_mad_i32_i24 v11, v14, s55, v62
    v_bitop3_b32 v12, v6, v13, v12 bitop3:0xca
    v_lshl_add_u32 v11, v11, 17, s40
    v_lshlrev_b16 v14, 8, v14
    v_lshrrev_b32 v13, 2, v102
    v_add_u32 v62, v12, v11
    v_bitop3_b32 v102, v5, v13, v14 bitop3:0xea
    ds_add_u32 v102, v2
    v_mul_hi_u32_u24 v14, 429497, v63
    v_lshrrev_b32 v12, 3, v103
    v_cos_f32 v10, v10
    v_lshlrev_b16 v13, 3, v103
    v_mad_i32_i24 v11, v14, s55, v63
    v_bitop3_b32 v12, v6, v13, v12 bitop3:0xca
    v_lshl_add_u32 v11, v11, 17, s40
    v_lshlrev_b16 v14, 8, v14
    v_lshrrev_b32 v13, 2, v103
    v_add_u32 v63, v12, v11
    v_bitop3_b32 v103, v5, v13, v14 bitop3:0xea
    ds_add_u32 v103, v2
    v_cvt_pk_bf16_f32 v107, v9, v10
    v_perm_b32 v12, v107, v107, s41
    v_bitop3_b32 v62, v4, v12, v62 bitop3:0xca
    v_perm_b32 v13, v107, v107, s42
    v_bitop3_b32 v63, v4, v13, v63 bitop3:0xca
    s_setprio 0
    s_add_u32 s47, s35, 0x5484000
    s_add_u32 s47, s47, s91
    buffer_store_dwordx4 v[120:123], v0, s[20:23], s47 offen sc1
    s_add_u32 s44, s96, 0x8000000
    s_nop 0
    v_lshlrev_b32 v120, 1, v1
    buffer_load_dwordx4 v[120:123], v120, s[12:15], s44 offen nt
    s_waitcnt vmcnt(8)
    v_lshlrev_b32 v7, 16, v108
    v_and_b32 v8, 0xffff0000, v108
    v_lshlrev_b32 v9, 16, v109
    v_and_b32 v10, 0xffff0000, v109
    v_mul_f32 v7, 0.15915494, v7
    v_mul_f32 v8, 0.15915494, v8
    v_mul_f32 v9, 0.15915494, v9
    v_mul_f32 v10, 0.15915494, v10
    v_mul_hi_u32_u24 v14, 429497, v112
    v_lshrrev_b32 v12, 3, v88
    v_cos_f32 v7, v7
    v_lshlrev_b16 v13, 3, v88
    v_mad_i32_i24 v11, v14, s55, v112
    v_bitop3_b32 v12, v6, v13, v12 bitop3:0xca
    v_lshl_add_u32 v11, v11, 17, s40
    v_lshlrev_b16 v14, 8, v14
    v_lshrrev_b32 v13, 2, v88
    v_add_u32 v112, v12, v11
    v_bitop3_b32 v88, v5, v13, v14 bitop3:0xea
    ds_add_u32 v88, v2
    v_mul_hi_u32_u24 v14, 429497, v113
    v_lshrrev_b32 v12, 3, v89
    v_cos_f32 v8, v8
    v_lshlrev_b16 v13, 3, v89
    v_mad_i32_i24 v11, v14, s55, v113
    v_bitop3_b32 v12, v6, v13, v12 bitop3:0xca
    v_lshl_add_u32 v11, v11, 17, s40
    v_lshlrev_b16 v14, 8, v14
    v_lshrrev_b32 v13, 2, v89
    v_add_u32 v113, v12, v11
    v_bitop3_b32 v89, v5, v13, v14 bitop3:0xea
    ds_add_u32 v89, v2
    v_cvt_pk_bf16_f32 v108, v7, v8
    v_perm_b32 v12, v108, v108, s41
    v_bitop3_b32 v112, v4, v12, v112 bitop3:0xca
    v_perm_b32 v13, v108, v108, s42
    v_bitop3_b32 v113, v4, v13, v113 bitop3:0xca
    v_mul_hi_u32_u24 v14, 429497, v114
    v_lshrrev_b32 v12, 3, v90
    v_cos_f32 v9, v9
    v_lshlrev_b16 v13, 3, v90
    v_mad_i32_i24 v11, v14, s55, v114
    v_bitop3_b32 v12, v6, v13, v12 bitop3:0xca
    v_lshl_add_u32 v11, v11, 17, s40
    v_lshlrev_b16 v14, 8, v14
    v_lshrrev_b32 v13, 2, v90
    v_add_u32 v114, v12, v11
    v_bitop3_b32 v90, v5, v13, v14 bitop3:0xea
    ds_add_u32 v90, v2
    v_mul_hi_u32_u24 v14, 429497, v115
    v_lshrrev_b32 v12, 3, v91
    v_cos_f32 v10, v10
    v_lshlrev_b16 v13, 3, v91
    v_mad_i32_i24 v11, v14, s55, v115
    v_bitop3_b32 v12, v6, v13, v12 bitop3:0xca
    v_lshl_add_u32 v11, v11, 17, s40
    v_lshlrev_b16 v14, 8, v14
    v_lshrrev_b32 v13, 2, v91
    v_add_u32 v115, v12, v11
    v_bitop3_b32 v91, v5, v13, v14 bitop3:0xea
    ds_add_u32 v91, v2
    v_cvt_pk_bf16_f32 v109, v9, v10
    v_perm_b32 v12, v109, v109, s41
    v_bitop3_b32 v114, v4, v12, v114 bitop3:0xca
    v_perm_b32 v13, v109, v109, s42
    v_bitop3_b32 v115, v4, v13, v115 bitop3:0xca
    s_waitcnt vmcnt(4)
    v_lshlrev_b32 v7, 16, v110
    v_and_b32 v8, 0xffff0000, v110
    v_lshlrev_b32 v9, 16, v111
    v_and_b32 v10, 0xffff0000, v111
    v_mul_f32 v7, 0.15915494, v7
    v_mul_f32 v8, 0.15915494, v8
    v_mul_f32 v9, 0.15915494, v9
    v_mul_f32 v10, 0.15915494, v10
    v_mul_hi_u32_u24 v14, 429497, v116
    v_lshrrev_b32 v12, 3, v92
    v_cos_f32 v7, v7
    v_lshlrev_b16 v13, 3, v92
    v_mad_i32_i24 v11, v14, s55, v116
    v_bitop3_b32 v12, v6, v13, v12 bitop3:0xca
    v_lshl_add_u32 v11, v11, 17, s40
    v_lshlrev_b16 v14, 8, v14
    v_lshrrev_b32 v13, 2, v92
    v_add_u32 v116, v12, v11
    v_bitop3_b32 v92, v5, v13, v14 bitop3:0xea
    ds_add_u32 v92, v2
    v_mul_hi_u32_u24 v14, 429497, v117
    v_lshrrev_b32 v12, 3, v93
    v_cos_f32 v8, v8
    v_lshlrev_b16 v13, 3, v93
    v_mad_i32_i24 v11, v14, s55, v117
    v_bitop3_b32 v12, v6, v13, v12 bitop3:0xca
    v_lshl_add_u32 v11, v11, 17, s40
    v_lshlrev_b16 v14, 8, v14
    v_lshrrev_b32 v13, 2, v93
    v_add_u32 v117, v12, v11
    v_bitop3_b32 v93, v5, v13, v14 bitop3:0xea
    ds_add_u32 v93, v2
    v_cvt_pk_bf16_f32 v110, v7, v8
    v_perm_b32 v12, v110, v110, s41
    v_bitop3_b32 v116, v4, v12, v116 bitop3:0xca
    v_perm_b32 v13, v110, v110, s42
    v_bitop3_b32 v117, v4, v13, v117 bitop3:0xca
    v_mul_hi_u32_u24 v14, 429497, v118
    v_lshrrev_b32 v12, 3, v94
    v_cos_f32 v9, v9
    v_lshlrev_b16 v13, 3, v94
    v_mad_i32_i24 v11, v14, s55, v118
    v_bitop3_b32 v12, v6, v13, v12 bitop3:0xca
    v_lshl_add_u32 v11, v11, 17, s40
    v_lshlrev_b16 v14, 8, v14
    v_lshrrev_b32 v13, 2, v94
    v_add_u32 v118, v12, v11
    v_bitop3_b32 v94, v5, v13, v14 bitop3:0xea
    ds_add_u32 v94, v2
    v_mul_hi_u32_u24 v14, 429497, v119
    v_lshrrev_b32 v12, 3, v95
    v_cos_f32 v10, v10
    v_lshlrev_b16 v13, 3, v95
    v_mad_i32_i24 v11, v14, s55, v119
    v_bitop3_b32 v12, v6, v13, v12 bitop3:0xca
    v_lshl_add_u32 v11, v11, 17, s40
    v_lshlrev_b16 v14, 8, v14
    v_lshrrev_b32 v13, 2, v95
    v_add_u32 v119, v12, v11
    v_bitop3_b32 v95, v5, v13, v14 bitop3:0xea
    ds_add_u32 v95, v2
    v_cvt_pk_bf16_f32 v111, v9, v10
    v_perm_b32 v12, v111, v111, s41
    v_bitop3_b32 v118, v4, v12, v118 bitop3:0xca
    v_perm_b32 v13, v111, v111, s42
    v_bitop3_b32 v119, v4, v13, v119 bitop3:0xca
    v_lshrrev_b32 v8, 2, v0
    v_and_b32 v7, 0x3c00, v0
    v_bitop3_b32 v7, v5, v8, v7 bitop3:0xea
    s_waitcnt lgkmcnt(0)
    s_barrier
    ds_read2st64_b32 v[8:9], v7 offset0:0 offset1:1
    ds_read2st64_b32 v[10:11], v7 offset0:2 offset1:3
    s_add_u32 s45, s35, 0x5484000
    s_add_u32 s45, s45, s93
    buffer_store_dwordx4 v[44:47], v0, s[20:23], s45 offen sc1
    s_add_u32 s46, s96, 0x8000000
    s_lshr_b32 s46, s46, 1
    buffer_load_dwordx2 v[44:45], v1, s[16:19], s46 offen nt
    s_add_u32 s47, s97, 0x8400000
    s_lshr_b32 s47, s47, 1
    buffer_load_dwordx2 v[46:47], v1, s[16:19], s47 offen nt
    s_waitcnt lgkmcnt(0)
    v_lshl_or_b32 v12, v9, 16, v8
    v_lshl_or_b32 v13, v11, 16, v10
    v_mov_b32 v14, v12
    v_mov_b32 v15, v13
    s_nop 0
    v_add_u32_dpp v14, v14, v14 row_shr:1 row_mask:0xf bank_mask:0xf bound_ctrl:1
    v_add_u32_dpp v15, v15, v15 row_shr:1 row_mask:0xf bank_mask:0xf bound_ctrl:1
    s_nop 0
    v_add_u32_dpp v14, v14, v14 row_shr:2 row_mask:0xf bank_mask:0xf bound_ctrl:1
    v_add_u32_dpp v15, v15, v15 row_shr:2 row_mask:0xf bank_mask:0xf bound_ctrl:1
    s_nop 0
    v_add_u32_dpp v14, v14, v14 row_shr:4 row_mask:0xf bank_mask:0xf bound_ctrl:1
    v_add_u32_dpp v15, v15, v15 row_shr:4 row_mask:0xf bank_mask:0xf bound_ctrl:1
    s_nop 0
    v_add_u32_dpp v14, v14, v14 row_shr:8 row_mask:0xf bank_mask:0xf bound_ctrl:1
    v_add_u32_dpp v15, v15, v15 row_shr:8 row_mask:0xf bank_mask:0xf bound_ctrl:1
    s_nop 0
    v_add_u32_dpp v14, v14, v14 row_bcast:15 row_mask:0xa bank_mask:0xf
    v_add_u32_dpp v15, v15, v15 row_bcast:15 row_mask:0xa bank_mask:0xf
    s_nop 0
    v_add_u32_dpp v14, v14, v14 row_bcast:31 row_mask:0xc bank_mask:0xf
    v_add_u32_dpp v15, v15, v15 row_bcast:31 row_mask:0xc bank_mask:0xf
    v_readlane_b32 s48, v14, 63
    v_readlane_b32 s49, v15, 63
    s_lshl_b32 s54, s32, 2
    v_mov_b32 v8, s54
    s_and_b32 s50, s48, 0xffff
    s_lshr_b32 s51, s48, 16
    s_and_b32 s52, s49, 0xffff
    s_lshr_b32 s53, s49, 16
    s_add_u32 s51, s51, s50
    s_add_u32 s52, s52, s51
    s_add_u32 s53, s53, s52
    v_mov_b32 v9, s53
    s_mov_b64 exec, 1
    ds_write_b32 v8, v9 offset:16384
    s_cmp_lg_u32 s32, 15
    s_cbranch_scc1 L1_tk2
    s_waitcnt vmcnt(3)
L1_tk2:
    ds_write_b32 v8, v3 offset:16448
    s_mov_b64 exec, -1
    v_and_b32 v8, 60, v7
    s_waitcnt lgkmcnt(0)
    s_barrier
    ds_read_b32 v9, v8 offset:16384
    ds_read_b32 v10, v8 offset:16448
    s_waitcnt lgkmcnt(0)
    v_readlane_b32 s84, v10, 15
    s_and_b32 s3, s2, 1
    s_lshl_b32 s3, s3, 7
    s_add_u32 s84, s84, s3
    s_min_u32 s4, s84, 72
    s_min_u32 s5, s84, 216
    s_min_u32 s6, s84, 240
    s_add_u32 s4, s4, s5
    s_add_u32 s4, s4, s6
    s_add_u32 s4, s4, 9467
    s_mov_b32 s4, s84
    s_lshl_b32 s58, s4, 14
    s_lshl_b32 s5, s32, 10
    s_add_u32 s58, s58, s5
    s_lshr_b32 s59, s58, 1
    s_mov_b32 s43, 5
    s_cmp_lt_u32 s84, 72
    s_addc_u32 s43, s43, 0
    s_cmp_lt_u32 s84, 216
    s_addc_u32 s43, s43, 0
    s_cmp_lt_u32 s84, 240
    s_addc_u32 s43, s43, 0
    v_add_u32_dpp v9, v9, v9 row_shr:1 row_mask:0xf bank_mask:0xf bound_ctrl:1
    s_nop 1
    v_add_u32_dpp v9, v9, v9 row_shr:2 row_mask:0xf bank_mask:0xf bound_ctrl:1
    s_nop 1
    v_add_u32_dpp v9, v9, v9 row_shr:4 row_mask:0xf bank_mask:0xf bound_ctrl:1
    s_nop 1
    v_add_u32_dpp v9, v9, v9 row_shr:8 row_mask:0xf bank_mask:0xf bound_ctrl:1
    s_nop 0
    v_readlane_b32 s54, v9, s32
    s_sub_u32 s54, s54, s53
    s_add_u32 s50, s50, s54
    s_add_u32 s51, s51, s54
    s_add_u32 s52, s52, s54
    s_pack_ll_b32_b16 s48, s54, s50
    s_pack_ll_b32_b16 s49, s51, s52
    v_add_u32 v14, s48, v14
    v_add_u32 v15, s49, v15
    v_sub_u32 v12, v14, v12
    v_sub_u32 v13, v15, v13
    v_and_b32 v8, 0xffff, v12
    v_lshrrev_b32 v9, 16, v12
    v_and_b32 v10, 0xffff, v13
    v_lshrrev_b32 v11, 16, v13
    ds_write2st64_b32 v7, v8, v9 offset0:0 offset1:1
    ds_write2st64_b32 v7, v10, v11 offset0:2 offset1:3
    v_and_b32 v8, 0x3f0, v0
    v_lshl_add_u32 v8, v8, 1, s36
    ds_write_b64 v8, v[12:13] offset:20480
    s_bitset0_b64 exec, 63
    s_not_b64 exec, exec
    ds_write_b64 v8, v[14:15] offset:20512
    s_mov_b64 exec, -1
    s_waitcnt lgkmcnt(0)
    s_barrier
    s_setprio 3
    ds_add_rtn_u32 v24, v24, v2
    ds_add_rtn_u32 v25, v25, v2
    ds_add_rtn_u32 v26, v26, v2
    ds_add_rtn_u32 v27, v27, v2
    ds_read_b128 v[12:15], v0 offset:20480
    v_cmp_gt_u32 vcc, 8448, v0
    ds_add_rtn_u32 v52, v52, v2
    ds_add_rtn_u32 v53, v53, v2
    ds_add_rtn_u32 v54, v54, v2
    ds_add_rtn_u32 v55, v55, v2
    s_setprio 2
    ds_add_rtn_u32 v72, v72, v2
    ds_add_rtn_u32 v73, v73, v2
    ds_add_rtn_u32 v74, v74, v2
    ds_add_rtn_u32 v75, v75, v2
    s_waitcnt lgkmcnt(8)
    s_cbranch_vccz L1_p4
    s_add_u32 s44, s35, 0x7ec0000
    s_mov_b64 exec, vcc
    buffer_store_dwordx4 v[12:15], v0, s[24:27], s44 offen sc1
    s_mov_b64 exec, -1
L1_p4:
    s_add_u32 s45, s35, 0x5488000
    s_add_u32 s45, s45, s72
    buffer_store_dwordx4 v[20:23], v0, s[20:23], s45 offen sc1
    s_add_u32 s46, s97, 0x8400000
    s_nop 0
    v_lshlrev_b32 v20, 1, v1
    buffer_load_dwordx4 v[20:23], v20, s[8:11], s46 offen nt
    ds_add_rtn_u32 v80, v80, v2
    ds_add_rtn_u32 v81, v81, v2
    ds_add_rtn_u32 v82, v82, v2
    ds_add_rtn_u32 v83, v83, v2
    s_setprio 1
    ds_add_rtn_u32 v96, v96, v2
    ds_add_rtn_u32 v97, v97, v2
    ds_add_rtn_u32 v98, v98, v2
    ds_add_rtn_u32 v99, v99, v2
    ds_add_rtn_u32 v100, v100, v2
    ds_add_rtn_u32 v101, v101, v2
    ds_add_rtn_u32 v102, v102, v2
    ds_add_rtn_u32 v103, v103, v2
    s_add_u32 s47, s35, 0x5488000
    s_add_u32 s47, s47, s73
    buffer_store_dwordx4 v[124:127], v0, s[20:23], s47 offen sc1
    s_add_u32 s44, s97, 0x8400000
    s_nop 0
    v_lshlrev_b32 v124, 1, v1
    buffer_load_dwordx4 v[124:127], v124, s[12:15], s44 offen nt
    s_setprio 0
    ds_add_rtn_u32 v88, v88, v2
    ds_add_rtn_u32 v89, v89, v2
    ds_add_rtn_u32 v90, v90, v2
    ds_add_rtn_u32 v91, v91, v2
    ds_add_rtn_u32 v92, v92, v2
    ds_add_rtn_u32 v93, v93, v2
    ds_add_rtn_u32 v94, v94, v2
    ds_add_rtn_u32 v95, v95, v2
    s_waitcnt lgkmcnt(0)
    s_barrier
    s_setprio 3
    v_and_b32 v7, -4, v24
    v_lshl_add_u32 v8, v24, 2, v7
    ds_write_b32 v8, v40
    v_lshl_add_u32 v7, v7, 2, v24
    ds_write_b8 v7, v84 offset:16
    v_and_b32 v9, -4, v25
    v_lshl_add_u32 v10, v25, 2, v9
    ds_write_b32 v10, v41
    v_lshl_add_u32 v9, v9, 2, v25
    ds_write_b8_d16_hi v9, v84 offset:16
    v_and_b32 v7, -4, v26
    v_lshl_add_u32 v8, v26, 2, v7
    ds_write_b32 v8, v42
    v_lshl_add_u32 v7, v7, 2, v26
    ds_write_b8 v7, v85 offset:16
    v_and_b32 v9, -4, v27
    v_lshl_add_u32 v10, v27, 2, v9
    ds_write_b32 v10, v43
    v_lshl_add_u32 v9, v9, 2, v27
    ds_write_b8_d16_hi v9, v85 offset:16
    s_add_u32 s45, s35, 0x5488000
    s_add_u32 s45, s45, s85
    buffer_store_dwordx4 v[32:35], v0, s[20:23], s45 offen sc1
    s_add_u32 s46, s98, 0x8800000
    v_lshlrev_b32 v40, 1, v1
    buffer_load_dwordx4 v[40:43], v40, s[8:11], s46 offen nt
    s_add_u32 s47, s98, 0x8800000
    v_lshlrev_b32 v24, 1, v1
    buffer_load_dwordx4 v[24:27], v24, s[12:15], s47 offen nt
    v_and_b32 v7, -4, v52
    v_lshl_add_u32 v8, v52, 2, v7
    ds_write_b32 v8, v48
    v_lshl_add_u32 v7, v7, 2, v52
    ds_write_b8 v7, v86 offset:16
    v_and_b32 v9, -4, v53
    v_lshl_add_u32 v10, v53, 2, v9
    ds_write_b32 v10, v49
    v_lshl_add_u32 v9, v9, 2, v53
    ds_write_b8_d16_hi v9, v86 offset:16
    v_and_b32 v7, -4, v54
    v_lshl_add_u32 v8, v54, 2, v7
    ds_write_b32 v8, v50
    v_lshl_add_u32 v7, v7, 2, v54
    ds_write_b8 v7, v87 offset:16
    v_and_b32 v9, -4, v55
    v_lshl_add_u32 v10, v55, 2, v9
    ds_write_b32 v10, v51
    v_lshl_add_u32 v9, v9, 2, v55
    ds_write_b8_d16_hi v9, v87 offset:16
    s_add_u32 s44, s98, 0x8800000
    s_lshr_b32 s44, s44, 1
    buffer_load_dwordx2 v[32:33], v1, s[16:19], s44 offen nt
    s_add_u32 s45, s99, 0x8c00000
    s_lshr_b32 s45, s45, 1
    buffer_load_dwordx2 v[34:35], v1, s[16:19], s45 offen nt
    s_add_u32 s46, s99, 0x8c00000
    v_lshlrev_b32 v48, 1, v1
    buffer_load_dwordx4 v[48:51], v48, s[8:11], s46 offen nt
    s_setprio 2
    v_and_b32 v7, -4, v72
    v_lshl_add_u32 v8, v72, 2, v7
    ds_write_b32 v8, v68
    v_lshl_add_u32 v7, v7, 2, v72
    ds_write_b8 v7, v56 offset:16
    v_and_b32 v9, -4, v73
    v_lshl_add_u32 v10, v73, 2, v9
    ds_write_b32 v10, v69
    v_lshl_add_u32 v9, v9, 2, v73
    ds_write_b8_d16_hi v9, v56 offset:16
    v_and_b32 v7, -4, v74
    v_lshl_add_u32 v8, v74, 2, v7
    ds_write_b32 v8, v70
    v_lshl_add_u32 v7, v7, 2, v74
    ds_write_b8 v7, v57 offset:16
    v_and_b32 v9, -4, v75
    v_lshl_add_u32 v10, v75, 2, v9
    ds_write_b32 v10, v71
    v_lshl_add_u32 v9, v9, 2, v75
    ds_write_b8_d16_hi v9, v57 offset:16
    s_add_u32 s47, s35, 0x5488000
    s_add_u32 s47, s47, s91
    buffer_store_dwordx4 v[36:39], v0, s[20:23], s47 offen sc1
    s_add_u32 s44, s99, 0x8c00000
    v_lshlrev_b32 v52, 1, v1
    buffer_load_dwordx4 v[52:55], v52, s[12:15], s44 offen nt
    v_and_b32 v7, -4, v80
    v_lshl_add_u32 v8, v80, 2, v7
    ds_write_b32 v8, v76
    v_lshl_add_u32 v7, v7, 2, v80
    ds_write_b8 v7, v58 offset:16
    v_and_b32 v9, -4, v81
    v_lshl_add_u32 v10, v81, 2, v9
    ds_write_b32 v10, v77
    v_lshl_add_u32 v9, v9, 2, v81
    ds_write_b8_d16_hi v9, v58 offset:16
    v_and_b32 v7, -4, v82
    v_lshl_add_u32 v8, v82, 2, v7
    ds_write_b32 v8, v78
    v_lshl_add_u32 v7, v7, 2, v82
    ds_write_b8 v7, v59 offset:16
    v_and_b32 v9, -4, v83
    v_lshl_add_u32 v10, v83, 2, v9
    ds_write_b32 v10, v79
    v_lshl_add_u32 v9, v9, 2, v83
    ds_write_b8_d16_hi v9, v59 offset:16
    s_add_u32 s45, s96, 0x9000000
    v_lshlrev_b32 v84, 1, v1
    buffer_load_dwordx4 v[84:87], v84, s[8:11], s45 offen nt
    s_add_u32 s46, s96, 0x9000000
    v_lshlrev_b32 v68, 1, v1
    buffer_load_dwordx4 v[68:71], v68, s[12:15], s46 offen nt
    s_setprio 1
    v_and_b32 v7, -4, v96
    v_lshl_add_u32 v8, v96, 2, v7
    ds_write_b32 v8, v64
    v_lshl_add_u32 v7, v7, 2, v96
    ds_write_b8 v7, v104 offset:16
    v_and_b32 v9, -4, v97
    v_lshl_add_u32 v10, v97, 2, v9
    ds_write_b32 v10, v65
    v_lshl_add_u32 v9, v9, 2, v97
    ds_write_b8_d16_hi v9, v104 offset:16
    v_and_b32 v7, -4, v98
    v_lshl_add_u32 v8, v98, 2, v7
    ds_write_b32 v8, v66
    v_lshl_add_u32 v7, v7, 2, v98
    ds_write_b8 v7, v105 offset:16
    v_and_b32 v9, -4, v99
    v_lshl_add_u32 v10, v99, 2, v9
    ds_write_b32 v10, v67
    v_lshl_add_u32 v9, v9, 2, v99
    ds_write_b8_d16_hi v9, v105 offset:16
    s_add_u32 s47, s96, 0x9000000
    s_lshr_b32 s47, s47, 1
    buffer_load_dwordx2 v[72:73], v1, s[16:19], s47 offen nt
    s_cmp_le_u32 s43, 5
    s_cselect_b32 s18, 0, s18
    s_add_u32 s44, s59, 0x4a00000
    buffer_load_dwordx2 v[74:75], v1, s[16:19], s44 offen nt
    s_cmp_le_u32 s43, 5
    s_cselect_b32 s10, 0, s10
    s_add_u32 s45, s58, 0x9400000
    v_lshlrev_b32 v36, 1, v1
    buffer_load_dwordx4 v[36:39], v36, s[8:11], s45 offen nt
    v_and_b32 v7, -4, v100
    v_lshl_add_u32 v8, v100, 2, v7
    ds_write_b32 v8, v60
    v_lshl_add_u32 v7, v7, 2, v100
    ds_write_b8 v7, v106 offset:16
    v_and_b32 v9, -4, v101
    v_lshl_add_u32 v10, v101, 2, v9
    ds_write_b32 v10, v61
    v_lshl_add_u32 v9, v9, 2, v101
    ds_write_b8_d16_hi v9, v106 offset:16
    v_and_b32 v7, -4, v102
    v_lshl_add_u32 v8, v102, 2, v7
    ds_write_b32 v8, v62
    v_lshl_add_u32 v7, v7, 2, v102
    ds_write_b8 v7, v107 offset:16
    v_and_b32 v9, -4, v103
    v_lshl_add_u32 v10, v103, 2, v9
    ds_write_b32 v10, v63
    v_lshl_add_u32 v9, v9, 2, v103
    ds_write_b8_d16_hi v9, v107 offset:16
    s_add_u32 s46, s35, 0x5488000
    s_add_u32 s46, s46, s93
    buffer_store_dwordx4 v[28:31], v0, s[20:23], s46 offen sc1
    s_cmp_le_u32 s43, 5
    s_cselect_b32 s14, 0, s14
    s_add_u32 s47, s58, 0x9400000
    v_lshlrev_b32 v76, 1, v1
    buffer_load_dwordx4 v[76:79], v76, s[12:15], s47 offen nt
    s_setprio 0
    v_and_b32 v7, -4, v88
    v_lshl_add_u32 v8, v88, 2, v7
    ds_write_b32 v8, v112
    v_lshl_add_u32 v7, v7, 2, v88
    ds_write_b8 v7, v108 offset:16
    v_and_b32 v9, -4, v89
    v_lshl_add_u32 v10, v89, 2, v9
    ds_write_b32 v10, v113
    v_lshl_add_u32 v9, v9, 2, v89
    ds_write_b8_d16_hi v9, v108 offset:16
    v_and_b32 v7, -4, v90
    v_lshl_add_u32 v8, v90, 2, v7
    ds_write_b32 v8, v114
    v_lshl_add_u32 v7, v7, 2, v90
    ds_write_b8 v7, v109 offset:16
    v_and_b32 v9, -4, v91
    v_lshl_add_u32 v10, v91, 2, v9
    ds_write_b32 v10, v115
    v_lshl_add_u32 v9, v9, 2, v91
    ds_write_b8_d16_hi v9, v109 offset:16
    s_cmp_le_u32 s43, 6
    s_cselect_b32 s10, 0, s10
    s_add_u32 s44, s58, 0x97c0000
    v_lshlrev_b32 v80, 1, v1
    buffer_load_dwordx4 v[80:83], v80, s[8:11], s44 offen nt
    s_cmp_le_u32 s43, 6
    s_cselect_b32 s14, 0, s14
    s_add_u32 s45, s58, 0x97c0000
    v_lshlrev_b32 v56, 1, v1
    buffer_load_dwordx4 v[56:59], v56, s[12:15], s45 offen nt
    v_and_b32 v7, -4, v92
    v_lshl_add_u32 v8, v92, 2, v7
    ds_write_b32 v8, v116
    v_lshl_add_u32 v7, v7, 2, v92
    ds_write_b8 v7, v110 offset:16
    v_and_b32 v9, -4, v93
    v_lshl_add_u32 v10, v93, 2, v9
    ds_write_b32 v10, v117
    v_lshl_add_u32 v9, v9, 2, v93
    ds_write_b8_d16_hi v9, v110 offset:16
    v_and_b32 v7, -4, v94
    v_lshl_add_u32 v8, v94, 2, v7
    ds_write_b32 v8, v118
    v_lshl_add_u32 v7, v7, 2, v94
    ds_write_b8 v7, v111 offset:16
    v_and_b32 v9, -4, v95
    v_lshl_add_u32 v10, v95, 2, v9
    ds_write_b32 v10, v119
    v_lshl_add_u32 v9, v9, 2, v95
    ds_write_b8_d16_hi v9, v111 offset:16
    s_cmp_le_u32 s43, 6
    s_cselect_b32 s18, 0, s18
    s_add_u32 s46, s59, 0x4be0000
    buffer_load_dwordx2 v[64:65], v1, s[16:19], s46 offen nt
    s_cmp_le_u32 s43, 7
    s_cselect_b32 s18, 0, s18
    s_add_u32 s47, s59, 0x4d90000
    buffer_load_dwordx2 v[66:67], v1, s[16:19], s47 offen nt
    v_add_u32 v7, s72, v0
    v_add_u32 v12, s73, v0
    v_add_u32 v13, s85, v0
    v_add_u32 v14, s91, v0
    v_add_u32 v15, s93, v0
    s_min_i32 s3, s72, s73
    s_min_i32 s3, s3, s85
    s_min_i32 s3, s3, s91
    s_min_i32 s3, s3, s93
    v_add_u32 v3, s3, v0
    v_mov_b32 v8, 0
    v_mov_b32 v9, 0
    v_mov_b32 v10, 0
    v_mov_b32 v11, 0
    s_waitcnt lgkmcnt(0)
    s_barrier
    ds_read_b128 v[96:99], v7 offset:0
    ds_read_b128 v[60:63], v12 offset:0
    ds_read_b128 v[100:103], v13 offset:0
    ds_read_b128 v[104:107], v14 offset:0
    ds_read_b128 v[28:31], v15 offset:0
    ds_write_b128 v3, v[8:11]
    ds_read_b128 v[112:115], v7 offset:16384
    ds_read_b128 v[88:91], v12 offset:16384
    ds_read_b128 v[116:119], v13 offset:16384
    ds_read_b128 v[92:95], v14 offset:16384
    ds_read_b128 v[108:111], v15 offset:16384
    s_waitcnt lgkmcnt(0)
    s_barrier
    v_lshlrev_b32 v3, 3, v0
    v_and_b32 v3, 0x80, v3
    s_cmp_lg_u32 s32, 15
    s_cbranch_scc1 L2_k0
    s_mov_b64 exec, 3
    buffer_load_dword v3, v3, s[68:71], 0 offen sc1
    s_mov_b64 exec, -1
L2_k0:
    s_add_u32 s44, s35, 0x7ec4000
    s_add_u32 s44, s44, s72
    buffer_store_dwordx4 v[96:99], v0, s[20:23], s44 offen sc1
    s_cmp_le_u32 s43, 7
    s_cselect_b32 s10, 0, s10
    s_add_u32 s45, s58, 0x9b20000
    v_lshlrev_b32 v96, 1, v1
    buffer_load_dwordx4 v[96:99], v96, s[8:11], s45 offen nt
    s_add_u32 s46, s35, 0x7ec4000
    s_add_u32 s46, s46, s73
    buffer_store_dwordx4 v[60:63], v0, s[20:23], s46 offen sc1
    s_cmp_le_u32 s43, 7
    s_cselect_b32 s14, 0, s14
    s_add_u32 s47, s58, 0x9b20000
    v_lshlrev_b32 v60, 1, v1
    buffer_load_dwordx4 v[60:63], v60, s[12:15], s47 offen nt
    s_setprio 3
    s_waitcnt vmcnt(27)
    v_lshlrev_b32 v7, 16, v44
    v_and_b32 v8, 0xffff0000, v44
    v_lshlrev_b32 v9, 16, v45
    v_and_b32 v10, 0xffff0000, v45
    v_mul_f32 v7, 0.15915494, v7
    v_mul_f32 v8, 0.15915494, v8
    v_mul_f32 v9, 0.15915494, v9
    v_mul_f32 v10, 0.15915494, v10
    v_mul_hi_u32_u24 v14, 429497, v16
    v_lshrrev_b32 v12, 3, v120
    v_cos_f32 v7, v7
    v_lshlrev_b16 v13, 3, v120
    v_mad_i32_i24 v11, v14, s55, v16
    v_bitop3_b32 v12, v6, v13, v12 bitop3:0xca
    v_lshl_add_u32 v11, v11, 17, s40
    v_lshlrev_b16 v14, 8, v14
    v_lshrrev_b32 v13, 2, v120
    v_add_u32 v16, v12, v11
    v_bitop3_b32 v120, v5, v13, v14 bitop3:0xea
    ds_add_u32 v120, v2
    v_mul_hi_u32_u24 v14, 429497, v17
    v_lshrrev_b32 v12, 3, v121
    v_cos_f32 v8, v8
    v_lshlrev_b16 v13, 3, v121
    v_mad_i32_i24 v11, v14, s55, v17
    v_bitop3_b32 v12, v6, v13, v12 bitop3:0xca
    v_lshl_add_u32 v11, v11, 17, s40
    v_lshlrev_b16 v14, 8, v14
    v_lshrrev_b32 v13, 2, v121
    v_add_u32 v17, v12, v11
    v_bitop3_b32 v121, v5, v13, v14 bitop3:0xea
    ds_add_u32 v121, v2
    v_cvt_pk_bf16_f32 v44, v7, v8
    v_perm_b32 v12, v44, v44, s41
    v_bitop3_b32 v16, v4, v12, v16 bitop3:0xca
    v_perm_b32 v13, v44, v44, s42
    v_bitop3_b32 v17, v4, v13, v17 bitop3:0xca
    v_mul_hi_u32_u24 v14, 429497, v18
    v_lshrrev_b32 v12, 3, v122
    v_cos_f32 v9, v9
    v_lshlrev_b16 v13, 3, v122
    v_mad_i32_i24 v11, v14, s55, v18
    v_bitop3_b32 v12, v6, v13, v12 bitop3:0xca
    v_lshl_add_u32 v11, v11, 17, s40
    v_lshlrev_b16 v14, 8, v14
    v_lshrrev_b32 v13, 2, v122
    v_add_u32 v18, v12, v11
    v_bitop3_b32 v122, v5, v13, v14 bitop3:0xea
    ds_add_u32 v122, v2
    v_mul_hi_u32_u24 v14, 429497, v19
    v_lshrrev_b32 v12, 3, v123
    v_cos_f32 v10, v10
    v_lshlrev_b16 v13, 3, v123
    v_mad_i32_i24 v11, v14, s55, v19
    v_bitop3_b32 v12, v6, v13, v12 bitop3:0xca
    v_lshl_add_u32 v11, v11, 17, s40
    v_lshlrev_b16 v14, 8, v14
    v_lshrrev_b32 v13, 2, v123
    v_add_u32 v19, v12, v11
    v_bitop3_b32 v123, v5, v13, v14 bitop3:0xea
    ds_add_u32 v123, v2
    v_cvt_pk_bf16_f32 v45, v9, v10
    v_perm_b32 v12, v45, v45, s41
    v_bitop3_b32 v18, v4, v12, v18 bitop3:0xca
    v_perm_b32 v13, v45, v45, s42
    v_bitop3_b32 v19, v4, v13, v19 bitop3:0xca
    s_waitcnt vmcnt(23)
    v_lshlrev_b32 v7, 16, v46
    v_and_b32 v8, 0xffff0000, v46
    v_lshlrev_b32 v9, 16, v47
    v_and_b32 v10, 0xffff0000, v47
    v_mul_f32 v7, 0.15915494, v7
    v_mul_f32 v8, 0.15915494, v8
    v_mul_f32 v9, 0.15915494, v9
    v_mul_f32 v10, 0.15915494, v10
    v_mul_hi_u32_u24 v14, 429497, v20
    v_lshrrev_b32 v12, 3, v124
    v_cos_f32 v7, v7
    v_lshlrev_b16 v13, 3, v124
    v_mad_i32_i24 v11, v14, s55, v20
    v_bitop3_b32 v12, v6, v13, v12 bitop3:0xca
    v_lshl_add_u32 v11, v11, 17, s40
    v_lshlrev_b16 v14, 8, v14
    v_lshrrev_b32 v13, 2, v124
    v_add_u32 v20, v12, v11
    v_bitop3_b32 v124, v5, v13, v14 bitop3:0xea
    ds_add_u32 v124, v2
    v_mul_hi_u32_u24 v14, 429497, v21
    v_lshrrev_b32 v12, 3, v125
    v_cos_f32 v8, v8
    v_lshlrev_b16 v13, 3, v125
    v_mad_i32_i24 v11, v14, s55, v21
    v_bitop3_b32 v12, v6, v13, v12 bitop3:0xca
    v_lshl_add_u32 v11, v11, 17, s40
    v_lshlrev_b16 v14, 8, v14
    v_lshrrev_b32 v13, 2, v125
    v_add_u32 v21, v12, v11
    v_bitop3_b32 v125, v5, v13, v14 bitop3:0xea
    ds_add_u32 v125, v2
    v_cvt_pk_bf16_f32 v46, v7, v8
    v_perm_b32 v12, v46, v46, s41
    v_bitop3_b32 v20, v4, v12, v20 bitop3:0xca
    v_perm_b32 v13, v46, v46, s42
    v_bitop3_b32 v21, v4, v13, v21 bitop3:0xca
    v_mul_hi_u32_u24 v14, 429497, v22
    v_lshrrev_b32 v12, 3, v126
    v_cos_f32 v9, v9
    v_lshlrev_b16 v13, 3, v126
    v_mad_i32_i24 v11, v14, s55, v22
    v_bitop3_b32 v12, v6, v13, v12 bitop3:0xca
    v_lshl_add_u32 v11, v11, 17, s40
    v_lshlrev_b16 v14, 8, v14
    v_lshrrev_b32 v13, 2, v126
    v_add_u32 v22, v12, v11
    v_bitop3_b32 v126, v5, v13, v14 bitop3:0xea
    ds_add_u32 v126, v2
    v_mul_hi_u32_u24 v14, 429497, v23
    v_lshrrev_b32 v12, 3, v127
    v_cos_f32 v10, v10
    v_lshlrev_b16 v13, 3, v127
    v_mad_i32_i24 v11, v14, s55, v23
    v_bitop3_b32 v12, v6, v13, v12 bitop3:0xca
    v_lshl_add_u32 v11, v11, 17, s40
    v_lshlrev_b16 v14, 8, v14
    v_lshrrev_b32 v13, 2, v127
    v_add_u32 v23, v12, v11
    v_bitop3_b32 v127, v5, v13, v14 bitop3:0xea
    ds_add_u32 v127, v2
    v_cvt_pk_bf16_f32 v47, v9, v10
    v_perm_b32 v12, v47, v47, s41
    v_bitop3_b32 v22, v4, v12, v22 bitop3:0xca
    v_perm_b32 v13, v47, v47, s42
    v_bitop3_b32 v23, v4, v13, v23 bitop3:0xca
    s_setprio 2
    s_add_u32 s44, s35, 0x7ec4000
    s_add_u32 s44, s44, s85
    buffer_store_dwordx4 v[100:103], v0, s[20:23], s44 offen sc1
    s_waitcnt vmcnt(19)
    v_lshlrev_b32 v7, 16, v32
    v_and_b32 v8, 0xffff0000, v32
    v_lshlrev_b32 v9, 16, v33
    v_and_b32 v10, 0xffff0000, v33
    v_mul_f32 v7, 0.15915494, v7
    v_mul_f32 v8, 0.15915494, v8
    v_mul_f32 v9, 0.15915494, v9
    v_mul_f32 v10, 0.15915494, v10
    v_mul_hi_u32_u24 v14, 429497, v40
    v_lshrrev_b32 v12, 3, v24
    v_cos_f32 v7, v7
    v_lshlrev_b16 v13, 3, v24
    v_mad_i32_i24 v11, v14, s55, v40
    v_bitop3_b32 v12, v6, v13, v12 bitop3:0xca
    v_lshl_add_u32 v11, v11, 17, s40
    v_lshlrev_b16 v14, 8, v14
    v_lshrrev_b32 v13, 2, v24
    v_add_u32 v40, v12, v11
    v_bitop3_b32 v24, v5, v13, v14 bitop3:0xea
    ds_add_u32 v24, v2
    v_mul_hi_u32_u24 v14, 429497, v41
    v_lshrrev_b32 v12, 3, v25
    v_cos_f32 v8, v8
    v_lshlrev_b16 v13, 3, v25
    v_mad_i32_i24 v11, v14, s55, v41
    v_bitop3_b32 v12, v6, v13, v12 bitop3:0xca
    v_lshl_add_u32 v11, v11, 17, s40
    v_lshlrev_b16 v14, 8, v14
    v_lshrrev_b32 v13, 2, v25
    v_add_u32 v41, v12, v11
    v_bitop3_b32 v25, v5, v13, v14 bitop3:0xea
    ds_add_u32 v25, v2
    v_cvt_pk_bf16_f32 v32, v7, v8
    v_perm_b32 v12, v32, v32, s41
    v_bitop3_b32 v40, v4, v12, v40 bitop3:0xca
    v_perm_b32 v13, v32, v32, s42
    v_bitop3_b32 v41, v4, v13, v41 bitop3:0xca
    v_mul_hi_u32_u24 v14, 429497, v42
    v_lshrrev_b32 v12, 3, v26
    v_cos_f32 v9, v9
    v_lshlrev_b16 v13, 3, v26
    v_mad_i32_i24 v11, v14, s55, v42
    v_bitop3_b32 v12, v6, v13, v12 bitop3:0xca
    v_lshl_add_u32 v11, v11, 17, s40
    v_lshlrev_b16 v14, 8, v14
    v_lshrrev_b32 v13, 2, v26
    v_add_u32 v42, v12, v11
    v_bitop3_b32 v26, v5, v13, v14 bitop3:0xea
    ds_add_u32 v26, v2
    v_mul_hi_u32_u24 v14, 429497, v43
    v_lshrrev_b32 v12, 3, v27
    v_cos_f32 v10, v10
    v_lshlrev_b16 v13, 3, v27
    v_mad_i32_i24 v11, v14, s55, v43
    v_bitop3_b32 v12, v6, v13, v12 bitop3:0xca
    v_lshl_add_u32 v11, v11, 17, s40
    v_lshlrev_b16 v14, 8, v14
    v_lshrrev_b32 v13, 2, v27
    v_add_u32 v43, v12, v11
    v_bitop3_b32 v27, v5, v13, v14 bitop3:0xea
    ds_add_u32 v27, v2
    v_cvt_pk_bf16_f32 v33, v9, v10
    v_perm_b32 v12, v33, v33, s41
    v_bitop3_b32 v42, v4, v12, v42 bitop3:0xca
    v_perm_b32 v13, v33, v33, s42
    v_bitop3_b32 v43, v4, v13, v43 bitop3:0xca
    s_waitcnt vmcnt(16)
    v_lshlrev_b32 v7, 16, v34
    v_and_b32 v8, 0xffff0000, v34
    v_lshlrev_b32 v9, 16, v35
    v_and_b32 v10, 0xffff0000, v35
    v_mul_f32 v7, 0.15915494, v7
    v_mul_f32 v8, 0.15915494, v8
    v_mul_f32 v9, 0.15915494, v9
    v_mul_f32 v10, 0.15915494, v10
    v_mul_hi_u32_u24 v14, 429497, v48
    v_lshrrev_b32 v12, 3, v52
    v_cos_f32 v7, v7
    v_lshlrev_b16 v13, 3, v52
    v_mad_i32_i24 v11, v14, s55, v48
    v_bitop3_b32 v12, v6, v13, v12 bitop3:0xca
    v_lshl_add_u32 v11, v11, 17, s40
    v_lshlrev_b16 v14, 8, v14
    v_lshrrev_b32 v13, 2, v52
    v_add_u32 v48, v12, v11
    v_bitop3_b32 v52, v5, v13, v14 bitop3:0xea
    ds_add_u32 v52, v2
    v_mul_hi_u32_u24 v14, 429497, v49
    v_lshrrev_b32 v12, 3, v53
    v_cos_f32 v8, v8
    v_lshlrev_b16 v13, 3, v53
    v_mad_i32_i24 v11, v14, s55, v49
    v_bitop3_b32 v12, v6, v13, v12 bitop3:0xca
    v_lshl_add_u32 v11, v11, 17, s40
    v_lshlrev_b16 v14, 8, v14
    v_lshrrev_b32 v13, 2, v53
    v_add_u32 v49, v12, v11
    v_bitop3_b32 v53, v5, v13, v14 bitop3:0xea
    ds_add_u32 v53, v2
    v_cvt_pk_bf16_f32 v34, v7, v8
    v_perm_b32 v12, v34, v34, s41
    v_bitop3_b32 v48, v4, v12, v48 bitop3:0xca
    v_perm_b32 v13, v34, v34, s42
    v_bitop3_b32 v49, v4, v13, v49 bitop3:0xca
    v_mul_hi_u32_u24 v14, 429497, v50
    v_lshrrev_b32 v12, 3, v54
    v_cos_f32 v9, v9
    v_lshlrev_b16 v13, 3, v54
    v_mad_i32_i24 v11, v14, s55, v50
    v_bitop3_b32 v12, v6, v13, v12 bitop3:0xca
    v_lshl_add_u32 v11, v11, 17, s40
    v_lshlrev_b16 v14, 8, v14
    v_lshrrev_b32 v13, 2, v54
    v_add_u32 v50, v12, v11
    v_bitop3_b32 v54, v5, v13, v14 bitop3:0xea
    ds_add_u32 v54, v2
    v_mul_hi_u32_u24 v14, 429497, v51
    v_lshrrev_b32 v12, 3, v55
    v_cos_f32 v10, v10
    v_lshlrev_b16 v13, 3, v55
    v_mad_i32_i24 v11, v14, s55, v51
    v_bitop3_b32 v12, v6, v13, v12 bitop3:0xca
    v_lshl_add_u32 v11, v11, 17, s40
    v_lshlrev_b16 v14, 8, v14
    v_lshrrev_b32 v13, 2, v55
    v_add_u32 v51, v12, v11
    v_bitop3_b32 v55, v5, v13, v14 bitop3:0xea
    ds_add_u32 v55, v2
    v_cvt_pk_bf16_f32 v35, v9, v10
    v_perm_b32 v12, v35, v35, s41
    v_bitop3_b32 v50, v4, v12, v50 bitop3:0xca
    v_perm_b32 v13, v35, v35, s42
    v_bitop3_b32 v51, v4, v13, v51 bitop3:0xca
    s_setprio 1
    s_waitcnt vmcnt(12)
    v_lshlrev_b32 v7, 16, v72
    v_and_b32 v8, 0xffff0000, v72
    v_lshlrev_b32 v9, 16, v73
    v_and_b32 v10, 0xffff0000, v73
    v_mul_f32 v7, 0.15915494, v7
    v_mul_f32 v8, 0.15915494, v8
    v_mul_f32 v9, 0.15915494, v9
    v_mul_f32 v10, 0.15915494, v10
    v_mul_hi_u32_u24 v14, 429497, v84
    v_lshrrev_b32 v12, 3, v68
    v_cos_f32 v7, v7
    v_lshlrev_b16 v13, 3, v68
    v_mad_i32_i24 v11, v14, s55, v84
    v_bitop3_b32 v12, v6, v13, v12 bitop3:0xca
    v_lshl_add_u32 v11, v11, 17, s40
    v_lshlrev_b16 v14, 8, v14
    v_lshrrev_b32 v13, 2, v68
    v_add_u32 v84, v12, v11
    v_bitop3_b32 v68, v5, v13, v14 bitop3:0xea
    ds_add_u32 v68, v2
    v_mul_hi_u32_u24 v14, 429497, v85
    v_lshrrev_b32 v12, 3, v69
    v_cos_f32 v8, v8
    v_lshlrev_b16 v13, 3, v69
    v_mad_i32_i24 v11, v14, s55, v85
    v_bitop3_b32 v12, v6, v13, v12 bitop3:0xca
    v_lshl_add_u32 v11, v11, 17, s40
    v_lshlrev_b16 v14, 8, v14
    v_lshrrev_b32 v13, 2, v69
    v_add_u32 v85, v12, v11
    v_bitop3_b32 v69, v5, v13, v14 bitop3:0xea
    ds_add_u32 v69, v2
    v_cvt_pk_bf16_f32 v72, v7, v8
    v_perm_b32 v12, v72, v72, s41
    v_bitop3_b32 v84, v4, v12, v84 bitop3:0xca
    v_perm_b32 v13, v72, v72, s42
    v_bitop3_b32 v85, v4, v13, v85 bitop3:0xca
    v_mul_hi_u32_u24 v14, 429497, v86
    v_lshrrev_b32 v12, 3, v70
    v_cos_f32 v9, v9
    v_lshlrev_b16 v13, 3, v70
    v_mad_i32_i24 v11, v14, s55, v86
    v_bitop3_b32 v12, v6, v13, v12 bitop3:0xca
    v_lshl_add_u32 v11, v11, 17, s40
    v_lshlrev_b16 v14, 8, v14
    v_lshrrev_b32 v13, 2, v70
    v_add_u32 v86, v12, v11
    v_bitop3_b32 v70, v5, v13, v14 bitop3:0xea
    ds_add_u32 v70, v2
    v_mul_hi_u32_u24 v14, 429497, v87
    v_lshrrev_b32 v12, 3, v71
    v_cos_f32 v10, v10
    v_lshlrev_b16 v13, 3, v71
    v_mad_i32_i24 v11, v14, s55, v87
    v_bitop3_b32 v12, v6, v13, v12 bitop3:0xca
    v_lshl_add_u32 v11, v11, 17, s40
    v_lshlrev_b16 v14, 8, v14
    v_lshrrev_b32 v13, 2, v71
    v_add_u32 v87, v12, v11
    v_bitop3_b32 v71, v5, v13, v14 bitop3:0xea
    ds_add_u32 v71, v2
    v_cvt_pk_bf16_f32 v73, v9, v10
    v_perm_b32 v12, v73, v73, s41
    v_bitop3_b32 v86, v4, v12, v86 bitop3:0xca
    v_perm_b32 v13, v73, v73, s42
    v_bitop3_b32 v87, v4, v13, v87 bitop3:0xca
    s_add_u32 s45, s35, 0x7ec4000
    s_add_u32 s45, s45, s91
    buffer_store_dwordx4 v[104:107], v0, s[20:23], s45 offen sc1
    s_waitcnt vmcnt(10)
    s_cmp_le_u32 s43, 5
    s_cbranch_scc1 L1_s5
    v_lshlrev_b32 v7, 16, v74
    v_and_b32 v8, 0xffff0000, v74
    v_lshlrev_b32 v9, 16, v75
    v_and_b32 v10, 0xffff0000, v75
    v_mul_f32 v7, 0.15915494, v7
    v_mul_f32 v8, 0.15915494, v8
    v_mul_f32 v9, 0.15915494, v9
    v_mul_f32 v10, 0.15915494, v10
    v_mul_hi_u32_u24 v14, 429497, v36
    v_lshrrev_b32 v12, 3, v76
    v_cos_f32 v7, v7
    v_lshlrev_b16 v13, 3, v76
    v_mad_i32_i24 v11, v14, s55, v36
    v_bitop3_b32 v12, v6, v13, v12 bitop3:0xca
    v_lshl_add_u32 v11, v11, 17, s40
    v_lshlrev_b16 v14, 8, v14
    v_lshrrev_b32 v13, 2, v76
    v_add_u32 v36, v12, v11
    v_bitop3_b32 v76, v5, v13, v14 bitop3:0xea
    ds_add_u32 v76, v2
    v_mul_hi_u32_u24 v14, 429497, v37
    v_lshrrev_b32 v12, 3, v77
    v_cos_f32 v8, v8
    v_lshlrev_b16 v13, 3, v77
    v_mad_i32_i24 v11, v14, s55, v37
    v_bitop3_b32 v12, v6, v13, v12 bitop3:0xca
    v_lshl_add_u32 v11, v11, 17, s40
    v_lshlrev_b16 v14, 8, v14
    v_lshrrev_b32 v13, 2, v77
    v_add_u32 v37, v12, v11
    v_bitop3_b32 v77, v5, v13, v14 bitop3:0xea
    ds_add_u32 v77, v2
    v_cvt_pk_bf16_f32 v74, v7, v8
    v_perm_b32 v12, v74, v74, s41
    v_bitop3_b32 v36, v4, v12, v36 bitop3:0xca
    v_perm_b32 v13, v74, v74, s42
    v_bitop3_b32 v37, v4, v13, v37 bitop3:0xca
    v_mul_hi_u32_u24 v14, 429497, v38
    v_lshrrev_b32 v12, 3, v78
    v_cos_f32 v9, v9
    v_lshlrev_b16 v13, 3, v78
    v_mad_i32_i24 v11, v14, s55, v38
    v_bitop3_b32 v12, v6, v13, v12 bitop3:0xca
    v_lshl_add_u32 v11, v11, 17, s40
    v_lshlrev_b16 v14, 8, v14
    v_lshrrev_b32 v13, 2, v78
    v_add_u32 v38, v12, v11
    v_bitop3_b32 v78, v5, v13, v14 bitop3:0xea
    ds_add_u32 v78, v2
    v_mul_hi_u32_u24 v14, 429497, v39
    v_lshrrev_b32 v12, 3, v79
    v_cos_f32 v10, v10
    v_lshlrev_b16 v13, 3, v79
    v_mad_i32_i24 v11, v14, s55, v39
    v_bitop3_b32 v12, v6, v13, v12 bitop3:0xca
    v_lshl_add_u32 v11, v11, 17, s40
    v_lshlrev_b16 v14, 8, v14
    v_lshrrev_b32 v13, 2, v79
    v_add_u32 v39, v12, v11
    v_bitop3_b32 v79, v5, v13, v14 bitop3:0xea
    ds_add_u32 v79, v2
    v_cvt_pk_bf16_f32 v75, v9, v10
    v_perm_b32 v12, v75, v75, s41
    v_bitop3_b32 v38, v4, v12, v38 bitop3:0xca
    v_perm_b32 v13, v75, v75, s42
    v_bitop3_b32 v39, v4, v13, v39 bitop3:0xca
L1_s5:
    s_setprio 0
    s_waitcnt vmcnt(6)
    s_cmp_le_u32 s43, 6
    s_cbranch_scc1 L1_s6
    v_lshlrev_b32 v7, 16, v64
    v_and_b32 v8, 0xffff0000, v64
    v_lshlrev_b32 v9, 16, v65
    v_and_b32 v10, 0xffff0000, v65
    v_mul_f32 v7, 0.15915494, v7
    v_mul_f32 v8, 0.15915494, v8
    v_mul_f32 v9, 0.15915494, v9
    v_mul_f32 v10, 0.15915494, v10
    v_mul_hi_u32_u24 v14, 429497, v80
    v_lshrrev_b32 v12, 3, v56
    v_cos_f32 v7, v7
    v_lshlrev_b16 v13, 3, v56
    v_mad_i32_i24 v11, v14, s55, v80
    v_bitop3_b32 v12, v6, v13, v12 bitop3:0xca
    v_lshl_add_u32 v11, v11, 17, s40
    v_lshlrev_b16 v14, 8, v14
    v_lshrrev_b32 v13, 2, v56
    v_add_u32 v80, v12, v11
    v_bitop3_b32 v56, v5, v13, v14 bitop3:0xea
    ds_add_u32 v56, v2
    v_mul_hi_u32_u24 v14, 429497, v81
    v_lshrrev_b32 v12, 3, v57
    v_cos_f32 v8, v8
    v_lshlrev_b16 v13, 3, v57
    v_mad_i32_i24 v11, v14, s55, v81
    v_bitop3_b32 v12, v6, v13, v12 bitop3:0xca
    v_lshl_add_u32 v11, v11, 17, s40
    v_lshlrev_b16 v14, 8, v14
    v_lshrrev_b32 v13, 2, v57
    v_add_u32 v81, v12, v11
    v_bitop3_b32 v57, v5, v13, v14 bitop3:0xea
    ds_add_u32 v57, v2
    v_cvt_pk_bf16_f32 v64, v7, v8
    v_perm_b32 v12, v64, v64, s41
    v_bitop3_b32 v80, v4, v12, v80 bitop3:0xca
    v_perm_b32 v13, v64, v64, s42
    v_bitop3_b32 v81, v4, v13, v81 bitop3:0xca
    v_mul_hi_u32_u24 v14, 429497, v82
    v_lshrrev_b32 v12, 3, v58
    v_cos_f32 v9, v9
    v_lshlrev_b16 v13, 3, v58
    v_mad_i32_i24 v11, v14, s55, v82
    v_bitop3_b32 v12, v6, v13, v12 bitop3:0xca
    v_lshl_add_u32 v11, v11, 17, s40
    v_lshlrev_b16 v14, 8, v14
    v_lshrrev_b32 v13, 2, v58
    v_add_u32 v82, v12, v11
    v_bitop3_b32 v58, v5, v13, v14 bitop3:0xea
    ds_add_u32 v58, v2
    v_mul_hi_u32_u24 v14, 429497, v83
    v_lshrrev_b32 v12, 3, v59
    v_cos_f32 v10, v10
    v_lshlrev_b16 v13, 3, v59
    v_mad_i32_i24 v11, v14, s55, v83
    v_bitop3_b32 v12, v6, v13, v12 bitop3:0xca
    v_lshl_add_u32 v11, v11, 17, s40
    v_lshlrev_b16 v14, 8, v14
    v_lshrrev_b32 v13, 2, v59
    v_add_u32 v83, v12, v11
    v_bitop3_b32 v59, v5, v13, v14 bitop3:0xea
    ds_add_u32 v59, v2
    v_cvt_pk_bf16_f32 v65, v9, v10
    v_perm_b32 v12, v65, v65, s41
    v_bitop3_b32 v82, v4, v12, v82 bitop3:0xca
    v_perm_b32 v13, v65, v65, s42
    v_bitop3_b32 v83, v4, v13, v83 bitop3:0xca
L1_s6:
    s_waitcnt vmcnt(2)
    s_cmp_le_u32 s43, 7
    s_cbranch_scc1 L1_s7
    v_lshlrev_b32 v7, 16, v66
    v_and_b32 v8, 0xffff0000, v66
    v_lshlrev_b32 v9, 16, v67
    v_and_b32 v10, 0xffff0000, v67
    v_mul_f32 v7, 0.15915494, v7
    v_mul_f32 v8, 0.15915494, v8
    v_mul_f32 v9, 0.15915494, v9
    v_mul_f32 v10, 0.15915494, v10
    v_mul_hi_u32_u24 v14, 429497, v96
    v_lshrrev_b32 v12, 3, v60
    v_cos_f32 v7, v7
    v_lshlrev_b16 v13, 3, v60
    v_mad_i32_i24 v11, v14, s55, v96
    v_bitop3_b32 v12, v6, v13, v12 bitop3:0xca
    v_lshl_add_u32 v11, v11, 17, s40
    v_lshlrev_b16 v14, 8, v14
    v_lshrrev_b32 v13, 2, v60
    v_add_u32 v96, v12, v11
    v_bitop3_b32 v60, v5, v13, v14 bitop3:0xea
    ds_add_u32 v60, v2
    v_mul_hi_u32_u24 v14, 429497, v97
    v_lshrrev_b32 v12, 3, v61
    v_cos_f32 v8, v8
    v_lshlrev_b16 v13, 3, v61
    v_mad_i32_i24 v11, v14, s55, v97
    v_bitop3_b32 v12, v6, v13, v12 bitop3:0xca
    v_lshl_add_u32 v11, v11, 17, s40
    v_lshlrev_b16 v14, 8, v14
    v_lshrrev_b32 v13, 2, v61
    v_add_u32 v97, v12, v11
    v_bitop3_b32 v61, v5, v13, v14 bitop3:0xea
    ds_add_u32 v61, v2
    v_cvt_pk_bf16_f32 v66, v7, v8
    v_perm_b32 v12, v66, v66, s41
    v_bitop3_b32 v96, v4, v12, v96 bitop3:0xca
    v_perm_b32 v13, v66, v66, s42
    v_bitop3_b32 v97, v4, v13, v97 bitop3:0xca
    v_mul_hi_u32_u24 v14, 429497, v98
    v_lshrrev_b32 v12, 3, v62
    v_cos_f32 v9, v9
    v_lshlrev_b16 v13, 3, v62
    v_mad_i32_i24 v11, v14, s55, v98
    v_bitop3_b32 v12, v6, v13, v12 bitop3:0xca
    v_lshl_add_u32 v11, v11, 17, s40
    v_lshlrev_b16 v14, 8, v14
    v_lshrrev_b32 v13, 2, v62
    v_add_u32 v98, v12, v11
    v_bitop3_b32 v62, v5, v13, v14 bitop3:0xea
    ds_add_u32 v62, v2
    v_mul_hi_u32_u24 v14, 429497, v99
    v_lshrrev_b32 v12, 3, v63
    v_cos_f32 v10, v10
    v_lshlrev_b16 v13, 3, v63
    v_mad_i32_i24 v11, v14, s55, v99
    v_bitop3_b32 v12, v6, v13, v12 bitop3:0xca
    v_lshl_add_u32 v11, v11, 17, s40
    v_lshlrev_b16 v14, 8, v14
    v_lshrrev_b32 v13, 2, v63
    v_add_u32 v99, v12, v11
    v_bitop3_b32 v63, v5, v13, v14 bitop3:0xea
    ds_add_u32 v63, v2
    v_cvt_pk_bf16_f32 v67, v9, v10
    v_perm_b32 v12, v67, v67, s41
    v_bitop3_b32 v98, v4, v12, v98 bitop3:0xca
    v_perm_b32 v13, v67, v67, s42
    v_bitop3_b32 v99, v4, v13, v99 bitop3:0xca
L1_s7:
    v_lshrrev_b32 v8, 2, v0
    v_and_b32 v7, 0x3c00, v0
    v_bitop3_b32 v7, v5, v8, v7 bitop3:0xea
    s_waitcnt lgkmcnt(0)
    s_barrier
    ds_read2st64_b32 v[8:9], v7 offset0:0 offset1:1
    ds_read2st64_b32 v[10:11], v7 offset0:2 offset1:3
    s_add_u32 s46, s35, 0x7ec4000
    s_add_u32 s46, s46, s93
    buffer_store_dwordx4 v[28:31], v0, s[20:23], s46 offen sc1
    s_waitcnt lgkmcnt(0)
    v_lshl_or_b32 v12, v9, 16, v8
    v_lshl_or_b32 v13, v11, 16, v10
    v_mov_b32 v14, v12
    v_mov_b32 v15, v13
    s_nop 0
    v_add_u32_dpp v14, v14, v14 row_shr:1 row_mask:0xf bank_mask:0xf bound_ctrl:1
    v_add_u32_dpp v15, v15, v15 row_shr:1 row_mask:0xf bank_mask:0xf bound_ctrl:1
    s_nop 0
    v_add_u32_dpp v14, v14, v14 row_shr:2 row_mask:0xf bank_mask:0xf bound_ctrl:1
    v_add_u32_dpp v15, v15, v15 row_shr:2 row_mask:0xf bank_mask:0xf bound_ctrl:1
    s_nop 0
    v_add_u32_dpp v14, v14, v14 row_shr:4 row_mask:0xf bank_mask:0xf bound_ctrl:1
    v_add_u32_dpp v15, v15, v15 row_shr:4 row_mask:0xf bank_mask:0xf bound_ctrl:1
    s_nop 0
    v_add_u32_dpp v14, v14, v14 row_shr:8 row_mask:0xf bank_mask:0xf bound_ctrl:1
    v_add_u32_dpp v15, v15, v15 row_shr:8 row_mask:0xf bank_mask:0xf bound_ctrl:1
    s_nop 0
    v_add_u32_dpp v14, v14, v14 row_bcast:15 row_mask:0xa bank_mask:0xf
    v_add_u32_dpp v15, v15, v15 row_bcast:15 row_mask:0xa bank_mask:0xf
    s_nop 0
    v_add_u32_dpp v14, v14, v14 row_bcast:31 row_mask:0xc bank_mask:0xf
    v_add_u32_dpp v15, v15, v15 row_bcast:31 row_mask:0xc bank_mask:0xf
    v_readlane_b32 s48, v14, 63
    v_readlane_b32 s49, v15, 63
    s_lshl_b32 s54, s32, 2
    v_mov_b32 v8, s54
    s_and_b32 s50, s48, 0xffff
    s_lshr_b32 s51, s48, 16
    s_and_b32 s52, s49, 0xffff
    s_lshr_b32 s53, s49, 16
    s_add_u32 s51, s51, s50
    s_add_u32 s52, s52, s51
    s_add_u32 s53, s53, s52
    v_mov_b32 v9, s53
    v_and_b32_dpp v3, v3, v3 quad_perm:[1,0,3,2] row_mask:0xf bank_mask:0xf
    s_mov_b64 exec, 1
    ds_write_b32 v8, v9 offset:16384
    ds_write_b32 v8, v3 offset:16448
    s_mov_b64 exec, -1
    v_and_b32 v8, 60, v7
    s_waitcnt lgkmcnt(0)
    s_barrier
    ds_read_b32 v9, v8 offset:16384
    ds_read_b32 v10, v8 offset:16448
    s_waitcnt lgkmcnt(0)
    v_readlane_b32 s56, v10, 15
    s_xor_b32 s56, s56, 0x80
    v_add_u32_dpp v9, v9, v9 row_shr:1 row_mask:0xf bank_mask:0xf bound_ctrl:1
    s_nop 1
    v_add_u32_dpp v9, v9, v9 row_shr:2 row_mask:0xf bank_mask:0xf bound_ctrl:1
    s_nop 1
    v_add_u32_dpp v9, v9, v9 row_shr:4 row_mask:0xf bank_mask:0xf bound_ctrl:1
    s_nop 1
    v_add_u32_dpp v9, v9, v9 row_shr:8 row_mask:0xf bank_mask:0xf bound_ctrl:1
    s_nop 0
    v_readlane_b32 s54, v9, s32
    s_sub_u32 s54, s54, s53
    s_add_u32 s50, s50, s54
    s_add_u32 s51, s51, s54
    s_add_u32 s52, s52, s54
    s_pack_ll_b32_b16 s48, s54, s50
    s_pack_ll_b32_b16 s49, s51, s52
    v_add_u32 v14, s48, v14
    v_add_u32 v15, s49, v15
    v_sub_u32 v12, v14, v12
    v_sub_u32 v13, v15, v13
    v_and_b32 v8, 0xffff, v12
    v_lshrrev_b32 v9, 16, v12
    v_and_b32 v10, 0xffff, v13
    v_lshrrev_b32 v11, 16, v13
    ds_write2st64_b32 v7, v8, v9 offset0:0 offset1:1
    ds_write2st64_b32 v7, v10, v11 offset0:2 offset1:3
    v_and_b32 v8, 0x3f0, v0
    v_lshl_add_u32 v8, v8, 1, s36
    ds_write_b64 v8, v[12:13] offset:20480
    s_bitset0_b64 exec, 63
    s_not_b64 exec, exec
    ds_write_b64 v8, v[14:15] offset:20512
    s_mov_b64 exec, -1
    s_waitcnt lgkmcnt(0)
    s_barrier
    s_setprio 3
    ds_add_rtn_u32 v120, v120, v2
    ds_add_rtn_u32 v121, v121, v2
    ds_add_rtn_u32 v122, v122, v2
    ds_add_rtn_u32 v123, v123, v2
    ds_read_b128 v[12:15], v0 offset:20480
    v_cmp_gt_u32 vcc, 8448, v0
    ds_add_rtn_u32 v124, v124, v2
    ds_add_rtn_u32 v125, v125, v2
    ds_add_rtn_u32 v126, v126, v2
    ds_add_rtn_u32 v127, v127, v2
    s_setprio 2
    ds_add_rtn_u32 v24, v24, v2
    ds_add_rtn_u32 v25, v25, v2
    ds_add_rtn_u32 v26, v26, v2
    ds_add_rtn_u32 v27, v27, v2
    s_waitcnt lgkmcnt(8)
    s_cbranch_vccz L1_p8
    s_add_u32 s47, s35, 0xa900000
    s_mov_b64 exec, vcc
    buffer_store_dwordx4 v[12:15], v0, s[24:27], s47 offen sc1
    s_mov_b64 exec, -1
L1_p8:
    s_add_u32 s44, s35, 0x7ec8000
    s_add_u32 s44, s44, s72
    buffer_store_dwordx4 v[112:115], v0, s[20:23], s44 offen sc1
    ds_add_rtn_u32 v52, v52, v2
    ds_add_rtn_u32 v53, v53, v2
    ds_add_rtn_u32 v54, v54, v2
    ds_add_rtn_u32 v55, v55, v2
    s_load_dwordx2 s[28:29], s[0:1], 0
    s_load_dwordx2 s[50:51], s[0:1], 40
    s_load_dwordx2 s[52:53], s[0:1], 24
    s_setprio 1
    ds_add_rtn_u32 v68, v68, v2
    ds_add_rtn_u32 v69, v69, v2
    ds_add_rtn_u32 v70, v70, v2
    ds_add_rtn_u32 v71, v71, v2
    s_cmp_le_u32 s43, 5
    s_cbranch_scc1 L1_s9
    ds_add_rtn_u32 v76, v76, v2
    ds_add_rtn_u32 v77, v77, v2
    ds_add_rtn_u32 v78, v78, v2
    ds_add_rtn_u32 v79, v79, v2
L1_s9:
    s_add_u32 s45, s35, 0x7ec8000
    s_add_u32 s45, s45, s73
    buffer_store_dwordx4 v[88:91], v0, s[20:23], s45 offen sc1
    s_setprio 0
    s_cmp_le_u32 s43, 6
    s_cbranch_scc1 L1_s10
    ds_add_rtn_u32 v56, v56, v2
    ds_add_rtn_u32 v57, v57, v2
    ds_add_rtn_u32 v58, v58, v2
    ds_add_rtn_u32 v59, v59, v2
L1_s10:
    s_cmp_le_u32 s43, 7
    s_cbranch_scc1 L1_s11
    ds_add_rtn_u32 v60, v60, v2
    ds_add_rtn_u32 v61, v61, v2
    ds_add_rtn_u32 v62, v62, v2
    ds_add_rtn_u32 v63, v63, v2
L1_s11:
    s_waitcnt lgkmcnt(0)
    s_barrier
    s_load_dwordx4 s[96:99], s[50:51], 0
    s_mov_b64 s[4:5], s[52:53]
    s_bfe_u32 s33, s2, 0x20001
    s_and_b32 s34, s2, 1
    s_lshl_b32 s34, s34, 5
    s_lshr_b32 s3, s2, 3
    s_add_u32 s34, s34, s3
    s_mul_i32 s39, s33, 2080
    s_lshl_b32 s3, s34, 5
    s_add_u32 s39, s39, s3
    s_mul_i32 s40, s33, 1310720
    s_add_u32 s40, s40, 0x50000
    s_lshl_b32 s38, s32, 11
    s_mul_i32 s100, s32, 3072
    s_add_u32 s8, s30, 0x4000
    s_addc_u32 s9, s31, 0
    s_mov_b32 s10, 0xd340000
    s_mov_b32 s11, 0x20000
    s_add_u32 s12, s30, 0x2c000
    s_addc_u32 s13, s31, 0
    s_mov_b32 s14, 0xd318000
    s_mov_b32 s15, 0x20000
    s_mov_b32 s16, s64
    s_mov_b32 s17, s65
    s_mov_b32 s18, 0x20
    s_mov_b32 s19, 0x20000
    s_mov_b32 s24, s28
    s_mov_b32 s25, s29
    s_mov_b32 s26, 0x4e2000
    s_mov_b32 s27, 0x20000
    s_setprio 3
    v_and_b32 v7, -4, v120
    v_lshl_add_u32 v8, v120, 2, v7
    ds_write_b32 v8, v16
    v_lshl_add_u32 v7, v7, 2, v120
    ds_write_b8 v7, v44 offset:16
    v_and_b32 v9, -4, v121
    v_lshl_add_u32 v10, v121, 2, v9
    ds_write_b32 v10, v17
    v_lshl_add_u32 v9, v9, 2, v121
    ds_write_b8_d16_hi v9, v44 offset:16
    v_and_b32 v7, -4, v122
    v_lshl_add_u32 v8, v122, 2, v7
    ds_write_b32 v8, v18
    v_lshl_add_u32 v7, v7, 2, v122
    ds_write_b8 v7, v45 offset:16
    v_and_b32 v9, -4, v123
    v_lshl_add_u32 v10, v123, 2, v9
    ds_write_b32 v10, v19
    v_lshl_add_u32 v9, v9, 2, v123
    ds_write_b8_d16_hi v9, v45 offset:16
    s_add_u32 s46, s35, 0x7ec8000
    s_add_u32 s46, s46, s85
    buffer_store_dwordx4 v[116:119], v0, s[20:23], s46 offen sc1
    v_and_b32 v13, 0x3f0, v0
    v_and_b32 v14, 0x300, v13
    v_bfe_u32 v15, v13, 4, 4
    s_lshl_b32 s3, s32, 4
    v_add3_u32 v14, v14, v15, s3
    v_mul_u32_u24 v2, 173056, v14
    v_lshrrev_b32 v14, 6, v13
    s_add_u32 s3, s3, 0x400
    v_add_u32 v14, s3, v14
    v_mul_u32_u24 v4, 173056, v14
    v_and_b32 v14, 3, v14
    v_and_b32 v15, 0x30, v13
    v_lshl_add_u32 v14, v14, 5, v15
    v_add_u32 v6, v14, v4
    v_lshl_add_u32 v5, v15, 1, v2
    v_lshrrev_b32 v14, 3, v15
    buffer_load_ushort v100, v14, s[16:19], 0 offen offset:0
    buffer_load_ushort v101, v14, s[16:19], 0 offen offset:8
    buffer_load_ushort v102, v14, s[16:19], 0 offen offset:16
    buffer_load_ushort v103, v14, s[16:19], 0 offen offset:24
    s_mul_i32 s3, s32, 5120
    v_add_u32 v3, s3, v13
    v_lshrrev_b32 v14, 2, v13
    v_add_u32 v14, s38, v14
    v_and_b32 v7, -4, v124
    v_lshl_add_u32 v8, v124, 2, v7
    ds_write_b32 v8, v20
    v_lshl_add_u32 v7, v7, 2, v124
    ds_write_b8 v7, v46 offset:16
    v_and_b32 v9, -4, v125
    v_lshl_add_u32 v10, v125, 2, v9
    ds_write_b32 v10, v21
    v_lshl_add_u32 v9, v9, 2, v125
    ds_write_b8_d16_hi v9, v46 offset:16
    v_and_b32 v7, -4, v126
    v_lshl_add_u32 v8, v126, 2, v7
    ds_write_b32 v8, v22
    v_lshl_add_u32 v7, v7, 2, v126
    ds_write_b8 v7, v47 offset:16
    v_and_b32 v9, -4, v127
    v_lshl_add_u32 v10, v127, 2, v9
    ds_write_b32 v10, v23
    v_lshl_add_u32 v9, v9, 2, v127
    ds_write_b8_d16_hi v9, v47 offset:16
    v_lshrrev_b32 v11, 2, v0
    v_and_b32 v11, 0xfc, v11
    s_cmp_ge_u32 s84, 128
    s_cselect_b32 s82, 0, s82
    s_and_b32 s3, s84, 1
    s_mul_i32 s3, s3, 40
    s_add_u32 s3, s3, s32
    s_mul_i32 s74, s3, 205
    s_lshr_b32 s74, s74, 10
    s_mul_i32 s75, s74, 5
    s_sub_u32 s75, s3, s75
    s_lshl_b32 s48, s74, 1
    s_add_u32 s48, s48, s75
    s_add_u32 s49, s48, s74
    s_add_u32 s49, s49, 30
    s_cmp_lt_u32 s75, 2
    s_cselect_b32 s48, s48, s49
    s_lshl_b32 s48, s48, 10
    s_lshr_b32 s49, s84, 1
    s_mul_i32 s49, s49, 80000
    s_add_u32 s48, s48, s49
    buffer_load_dword v104, v11, s[80:83], s48 offen offset:0
    buffer_load_dword v105, v11, s[80:83], s48 offen offset:256
    buffer_load_dword v106, v11, s[80:83], s48 offen offset:512
    buffer_load_dword v107, v11, s[80:83], s48 offen offset:768
    s_and_b32 s3, s84, 1
    s_mul_i32 s3, s3, 40
    s_add_u32 s3, s3, s32
    s_add_u32 s3, s3, 16
    s_mul_i32 s74, s3, 205
    s_lshr_b32 s74, s74, 10
    s_mul_i32 s75, s74, 5
    s_sub_u32 s75, s3, s75
    s_lshl_b32 s48, s74, 1
    s_add_u32 s48, s48, s75
    s_add_u32 s49, s48, s74
    s_add_u32 s49, s49, 30
    s_cmp_lt_u32 s75, 2
    s_cselect_b32 s48, s48, s49
    s_lshl_b32 s48, s48, 10
    s_lshr_b32 s49, s84, 1
    s_mul_i32 s49, s49, 80000
    s_add_u32 s48, s48, s49
    buffer_load_dword v28, v11, s[80:83], s48 offen offset:0
    buffer_load_dword v29, v11, s[80:83], s48 offen offset:256
    buffer_load_dword v30, v11, s[80:83], s48 offen offset:512
    buffer_load_dword v31, v11, s[80:83], s48 offen offset:768
    s_and_b32 s3, s84, 1
    s_mul_i32 s3, s3, 40
    s_add_u32 s3, s3, s32
    s_add_u32 s3, s3, 32
    s_cmp_ge_u32 s32, 8
    s_cselect_b32 s82, 0, s82
    s_mul_i32 s74, s3, 205
    s_lshr_b32 s74, s74, 10
    s_mul_i32 s75, s74, 5
    s_sub_u32 s75, s3, s75
    s_lshl_b32 s48, s74, 1
    s_add_u32 s48, s48, s75
    s_add_u32 s49, s48, s74
    s_add_u32 s49, s49, 30
    s_cmp_lt_u32 s75, 2
    s_cselect_b32 s48, s48, s49
    s_lshl_b32 s48, s48, 10
    s_lshr_b32 s49, s84, 1
    s_mul_i32 s49, s49, 80000
    s_add_u32 s48, s48, s49
    buffer_load_dword v112, v11, s[80:83], s48 offen offset:0
    buffer_load_dword v113, v11, s[80:83], s48 offen offset:256
    buffer_load_dword v114, v11, s[80:83], s48 offen offset:512
    buffer_load_dword v115, v11, s[80:83], s48 offen offset:768
    s_setprio 2
    v_and_b32 v7, -4, v24
    v_lshl_add_u32 v8, v24, 2, v7
    ds_write_b32 v8, v40
    v_lshl_add_u32 v7, v7, 2, v24
    ds_write_b8 v7, v32 offset:16
    v_and_b32 v9, -4, v25
    v_lshl_add_u32 v10, v25, 2, v9
    ds_write_b32 v10, v41
    v_lshl_add_u32 v9, v9, 2, v25
    ds_write_b8_d16_hi v9, v32 offset:16
    v_and_b32 v7, -4, v26
    v_lshl_add_u32 v8, v26, 2, v7
    ds_write_b32 v8, v42
    v_lshl_add_u32 v7, v7, 2, v26
    ds_write_b8 v7, v33 offset:16
    v_and_b32 v9, -4, v27
    v_lshl_add_u32 v10, v27, 2, v9
    ds_write_b32 v10, v43
    v_lshl_add_u32 v9, v9, 2, v27
    ds_write_b8_d16_hi v9, v33 offset:16
    s_add_u32 s47, s35, 0x7ec8000
    s_add_u32 s47, s47, s91
    buffer_store_dwordx4 v[92:95], v0, s[20:23], s47 offen sc1
    v_and_b32 v7, -4, v52
    v_lshl_add_u32 v8, v52, 2, v7
    ds_write_b32 v8, v48
    v_lshl_add_u32 v7, v7, 2, v52
    ds_write_b8 v7, v34 offset:16
    v_and_b32 v9, -4, v53
    v_lshl_add_u32 v10, v53, 2, v9
    ds_write_b32 v10, v49
    v_lshl_add_u32 v9, v9, 2, v53
    ds_write_b8_d16_hi v9, v34 offset:16
    v_and_b32 v7, -4, v54
    v_lshl_add_u32 v8, v54, 2, v7
    ds_write_b32 v8, v50
    v_lshl_add_u32 v7, v7, 2, v54
    ds_write_b8 v7, v35 offset:16
    v_and_b32 v9, -4, v55
    v_lshl_add_u32 v10, v55, 2, v9
    ds_write_b32 v10, v51
    v_lshl_add_u32 v9, v9, 2, v55
    ds_write_b8_d16_hi v9, v35 offset:16
    s_setprio 1
    v_and_b32 v7, -4, v68
    v_lshl_add_u32 v8, v68, 2, v7
    ds_write_b32 v8, v84
    v_lshl_add_u32 v7, v7, 2, v68
    ds_write_b8 v7, v72 offset:16
    v_and_b32 v9, -4, v69
    v_lshl_add_u32 v10, v69, 2, v9
    ds_write_b32 v10, v85
    v_lshl_add_u32 v9, v9, 2, v69
    ds_write_b8_d16_hi v9, v72 offset:16
    v_and_b32 v7, -4, v70
    v_lshl_add_u32 v8, v70, 2, v7
    ds_write_b32 v8, v86
    v_lshl_add_u32 v7, v7, 2, v70
    ds_write_b8 v7, v73 offset:16
    v_and_b32 v9, -4, v71
    v_lshl_add_u32 v10, v71, 2, v9
    ds_write_b32 v10, v87
    v_lshl_add_u32 v9, v9, 2, v71
    ds_write_b8_d16_hi v9, v73 offset:16
    s_cmp_le_u32 s43, 5
    s_cbranch_scc1 L1_s12
    v_and_b32 v7, -4, v76
    v_lshl_add_u32 v8, v76, 2, v7
    ds_write_b32 v8, v36
    v_lshl_add_u32 v7, v7, 2, v76
    ds_write_b8 v7, v74 offset:16
    v_and_b32 v9, -4, v77
    v_lshl_add_u32 v10, v77, 2, v9
    ds_write_b32 v10, v37
    v_lshl_add_u32 v9, v9, 2, v77
    ds_write_b8_d16_hi v9, v74 offset:16
    v_and_b32 v7, -4, v78
    v_lshl_add_u32 v8, v78, 2, v7
    ds_write_b32 v8, v38
    v_lshl_add_u32 v7, v7, 2, v78
    ds_write_b8 v7, v75 offset:16
    v_and_b32 v9, -4, v79
    v_lshl_add_u32 v10, v79, 2, v9
    ds_write_b32 v10, v39
    v_lshl_add_u32 v9, v9, 2, v79
    ds_write_b8_d16_hi v9, v75 offset:16
L1_s12:
    s_add_u32 s44, s35, 0x7ec8000
    s_add_u32 s44, s44, s93
    buffer_store_dwordx4 v[108:111], v0, s[20:23], s44 offen sc1
    s_setprio 0
    s_cmp_le_u32 s43, 6
    s_cbranch_scc1 L1_s13
    v_and_b32 v7, -4, v56
    v_lshl_add_u32 v8, v56, 2, v7
    ds_write_b32 v8, v80
    v_lshl_add_u32 v7, v7, 2, v56
    ds_write_b8 v7, v64 offset:16
    v_and_b32 v9, -4, v57
    v_lshl_add_u32 v10, v57, 2, v9
    ds_write_b32 v10, v81
    v_lshl_add_u32 v9, v9, 2, v57
    ds_write_b8_d16_hi v9, v64 offset:16
    v_and_b32 v7, -4, v58
    v_lshl_add_u32 v8, v58, 2, v7
    ds_write_b32 v8, v82
    v_lshl_add_u32 v7, v7, 2, v58
    ds_write_b8 v7, v65 offset:16
    v_and_b32 v9, -4, v59
    v_lshl_add_u32 v10, v59, 2, v9
    ds_write_b32 v10, v83
    v_lshl_add_u32 v9, v9, 2, v59
    ds_write_b8_d16_hi v9, v65 offset:16
L1_s13:
    s_add_u32 s80, s30, 0xd344000
    s_addc_u32 s81, s31, 0
    s_mov_b32 s82, 0xa000
    s_mov_b32 s83, 0x20000
    s_min_u32 s3, s84, 127
    s_mul_i32 s3, s3, 40960
    s_add_u32 s80, s80, s3
    s_addc_u32 s81, s81, 0
    s_cmp_ge_u32 s84, 128
    s_cselect_b32 s82, 0, s82
    s_waitcnt vmcnt(2)
    v_add_u32 v11, 0, v0
    buffer_store_dwordx4 v[104:107], v11, s[80:83], 0 offen sc1
    v_add_u32 v11, 16384, v0
    buffer_store_dwordx4 v[28:31], v11, s[80:83], 0 offen sc1
    v_add_u32 v11, 32768, v0
    buffer_store_dwordx4 v[112:115], v11, s[80:83], 0 offen sc1
    s_cmp_le_u32 s43, 7
    s_cbranch_scc1 L1_s14
    v_and_b32 v7, -4, v60
    v_lshl_add_u32 v8, v60, 2, v7
    ds_write_b32 v8, v96
    v_lshl_add_u32 v7, v7, 2, v60
    ds_write_b8 v7, v66 offset:16
    v_and_b32 v9, -4, v61
    v_lshl_add_u32 v10, v61, 2, v9
    ds_write_b32 v10, v97
    v_lshl_add_u32 v9, v9, 2, v61
    ds_write_b8_d16_hi v9, v66 offset:16
    v_and_b32 v7, -4, v62
    v_lshl_add_u32 v8, v62, 2, v7
    ds_write_b32 v8, v98
    v_lshl_add_u32 v7, v7, 2, v62
    ds_write_b8 v7, v67 offset:16
    v_and_b32 v9, -4, v63
    v_lshl_add_u32 v10, v63, 2, v9
    ds_write_b32 v10, v99
    v_lshl_add_u32 v9, v9, 2, v63
    ds_write_b8_d16_hi v9, v67 offset:16
L1_s14:
    v_add_u32 v7, 0x10000, v0
    v_add_u32 v12, 0x20000, v0
    s_waitcnt lgkmcnt(0)
    s_barrier
    ds_read_b128 v[24:27], v0 offset:0
    ds_read_b128 v[28:31], v0 offset:16384
    ds_read_b128 v[32:35], v0 offset:32768
    ds_read_b128 v[36:39], v0 offset:49152
    ds_read_b128 v[76:79], v7 offset:0
    ds_read_b128 v[80:83], v7 offset:16384
    ds_read_b128 v[84:87], v7 offset:32768
    ds_read_b128 v[104:107], v7 offset:49152
    ds_read_b128 v[68:71], v12 offset:0
    ds_read_b128 v[72:75], v12 offset:16384
    s_cmp_lg_u32 s32, 0
    s_cbranch_scc1 L2_sg1
    s_mov_b32 exec_hi, 0
    v_mov_b32 v11, 1
    buffer_store_dword v11, v14, s[60:63], s57 offen sc1
    s_mov_b64 exec, -1
L2_sg1:
    s_waitcnt lgkmcnt(9)
    s_add_u32 s45, s35, 0xa904000
    buffer_store_dwordx4 v[24:27], v0, s[20:23], s45 offen sc1
    s_waitcnt lgkmcnt(8)
    s_add_u32 s46, s35, 0xa908000
    buffer_store_dwordx4 v[28:31], v0, s[20:23], s46 offen sc1
    s_waitcnt lgkmcnt(7)
    s_add_u32 s47, s35, 0xa90c000
    buffer_store_dwordx4 v[32:35], v0, s[20:23], s47 offen sc1
    s_waitcnt lgkmcnt(6)
    s_add_u32 s44, s35, 0xa910000
    buffer_store_dwordx4 v[36:39], v0, s[20:23], s44 offen sc1
    s_waitcnt lgkmcnt(5)
    s_add_u32 s45, s35, 0xa914000
    buffer_store_dwordx4 v[76:79], v0, s[20:23], s45 offen sc1
    s_waitcnt lgkmcnt(4)
    s_add_u32 s46, s35, 0xa918000
    buffer_store_dwordx4 v[80:83], v0, s[20:23], s46 offen sc1
    s_waitcnt lgkmcnt(3)
    s_add_u32 s47, s35, 0xa91c000
    buffer_store_dwordx4 v[84:87], v0, s[20:23], s47 offen sc1
    s_waitcnt lgkmcnt(2)
    s_cmp_le_u32 s43, 5
    s_cbranch_scc1 L1_q15
    s_add_u32 s44, s35, 0xa920000
    buffer_store_dwordx4 v[104:107], v0, s[20:23], s44 offen sc1
L1_q15:
    s_waitcnt lgkmcnt(1)
    s_cmp_le_u32 s43, 6
    s_cbranch_scc1 L1_q16
    s_add_u32 s45, s35, 0xa924000
    buffer_store_dwordx4 v[68:71], v0, s[20:23], s45 offen sc1
L1_q16:
    s_waitcnt lgkmcnt(0)
    s_cmp_le_u32 s43, 7
    s_cbranch_scc1 L1_q17
    s_add_u32 s46, s35, 0xa928000
    buffer_store_dwordx4 v[72:75], v0, s[20:23], s46 offen sc1
L1_q17:
    s_waitcnt lgkmcnt(0)
    s_setprio 3
    v_mov_b32 v92, v0
    v_mov_b32 v93, v6
    v_mov_b32 v94, v13
    v_mov_b32 v95, v5
    v_mov_b32 v0, v14
    v_lshl_add_u32 v7, v13, 3, s38
    v_lshrrev_b32 v16, 2, v15
    v_mad_u32_u24 v4, v16, 5, v4
    v_or_b32 v4, 0xf0000000, v4
    v_or_b32 v2, 0xf0000000, v2
    v_sub_u32 v1, 28, v16
    v_lshrrev_b32 v17, 2, v16
    v_and_b32 v18, 3, v17
    v_lshlrev_b32 v18, 4, v18
    v_mov_b32 v10, 0x3f80
    v_mov_b32 v11, 0
    v_lshlrev_b64 v[10:11], v18, v[10:11]
    v_and_b32 v18, 3, v17
    v_lshlrev_b32 v18, 4, v18
    v_mov_b32 v12, 0xbf80
    v_mov_b32 v13, 0
    v_lshlrev_b64 v[12:13], v18, v[12:13]
    v_mov_b32 v45, 0xf0000000
    v_mov_b32 v5, 0x1fff8
    v_mov_b32 v6, 0x07ff0000
    v_mov_b32 v16, 0
    v_mov_b32 v17, 0
    v_mov_b32 v18, 0
    v_mov_b32 v19, 0
    v_add_u32 v20, 81920, v92
    v_add_u32 v21, 0x10000, v20
    s_setprio 1
    s_setprio 2
    s_mov_b32 s44, 0x4000c0c
    s_mov_b32 s45, 0x4010c0c
    s_mov_b32 s46, 0x4020c0c
    s_mov_b32 s47, 0x4030c0c
    s_mov_b32 s36, 0
    s_mov_b32 s43, 0
    s_mov_b32 s42, 0
    s_mov_b64 s[80:81], 0
    s_mov_b64 s[48:49], 0
    s_add_u32 s16, s30, 0xd344000
    s_addc_u32 s17, s31, 0
    s_mov_b32 s18, 0x500000
    s_mov_b32 s19, 0x20000
    v_mov_b32 v68, 0
    v_mov_b32 v69, 0
    v_mov_b32 v70, 0
    v_mov_b32 v71, 0
    v_mov_b32 v72, 0
    v_mov_b32 v73, 0
    v_mov_b32 v74, 0
    v_mov_b32 v75, 0
    s_waitcnt vmcnt(0)
    v_lshl_or_b32 v8, v101, 16, v100
    v_lshl_or_b32 v9, v103, 16, v102
    s_barrier
    s_cmp_lg_u32 s32, 0
    s_cbranch_scc1 L2_sg2
    s_mov_b32 exec_hi, 0
    v_mov_b32 v88, 2
    buffer_store_dword v88, v0, s[60:63], s57 offen sc1
    s_mov_b64 exec, -1
L2_sg2:
    s_mov_b64 s[84:85], 0
    s_mul_i32 s3, s33, 1280000
    s_add_u32 s3, s3, s100
    s_add_u32 s3, s3, 32768
    buffer_load_dwordx4 v[124:127], v94, s[24:27], s3 offen offset:2048
    s_mul_i32 s3, s33, 1280000
    s_add_u32 s3, s3, s100
    s_add_u32 s3, s3, 32768
    buffer_load_dwordx4 v[116:119], v94, s[24:27], s3 offen offset:0
    s_mul_i32 s3, s33, 1280000
    s_add_u32 s3, s3, s100
    s_add_u32 s3, s3, 32768
    buffer_load_dwordx4 v[120:123], v94, s[24:27], s3 offen offset:1024
    s_mul_i32 s3, s33, 1280000
    s_add_u32 s3, s3, s38
    s_add_u32 s3, s3, 0
    buffer_load_dwordx4 v[108:111], v94, s[24:27], s3 offen offset:0
    s_mul_i32 s3, s33, 1280000
    s_add_u32 s3, s3, s38
    s_add_u32 s3, s3, 0
    buffer_load_dwordx4 v[112:115], v94, s[24:27], s3 offen offset:1024
    ds_write_b128 v20, v[16:19] offset:0
    ds_write_b128 v20, v[16:19] offset:16384
    ds_write_b128 v20, v[16:19] offset:32768
    ds_write_b128 v20, v[16:19] offset:49152
    ds_write_b128 v21, v[16:19]
    s_cmp_eq_u32 s56, 0
    s_cbranch_scc1 L2_e3
    v_lshlrev_b32 v16, 3, v94
    v_and_b32 v16, 0x80, v16
L2_e4:
    buffer_load_dword v88, v16, s[68:71], 0 offen sc1
    s_waitcnt vmcnt(0)
    v_cmp_gt_u32 vcc, 0x80, v88
    s_cbranch_vccnz L2_e4
L2_e3:
    s_mov_b64 exec, 0xffff
L2_p1:
    buffer_load_dword v88, v7, s[60:63], 0 offen sc1
    s_waitcnt vmcnt(0)
    v_cmpx_gt_u32 vcc, 1, v88
    s_cbranch_vccnz L2_p1s
    s_mov_b64 exec, -1
    v_cmp_gt_u32 vcc, 2, v88
    s_and_b32 s56, vcc_lo, 0xffff
    buffer_load_dwordx4 v[48:51], v95, s[12:15], s39 offen offset:0
    buffer_load_dwordx4 v[56:59], v95, s[12:15], s39 offen offset:32
    buffer_load_dwordx4 v[52:55], v95, s[12:15], s39 offen offset:16
    buffer_load_dwordx4 v[60:63], v95, s[12:15], s39 offen offset:48
    buffer_load_dwordx4 v[64:67], v93, s[12:15], s39 offen
    s_waitcnt vmcnt(0)
    v_sub_u16 v88, v56, v48
    v_and_b32 v89, 3, v48
    v_add3_u32 v99, v88, v89, 3
    v_and_b32 v99, -4, v99
    v_max_u32 v99, 4, v99
    v_and_b32 v97, 0xfffc, v48
    v_bfm_b32 v96, v88, v89
    v_add_u32_dpp v91, v99, v99 row_shr:1 row_mask:0xf bank_mask:0xf bound_ctrl:1
    v_mad_u32_u24 v97, v97, 5, v2
    v_cmp_lt_u32 vcc, 16, v99
    v_add_u32_dpp v91, v91, v91 row_shr:2 row_mask:0xf bank_mask:0xf bound_ctrl:1
    v_sub_u32 v98, s38, v99
    v_lshrrev_b64 v[48:49], 16, v[48:49]
    v_add_u32_dpp v91, v91, v91 row_shr:4 row_mask:0xf bank_mask:0xf bound_ctrl:1
    v_lshrrev_b64 v[56:57], 16, v[56:57]
    s_mov_b32 s101, 0
    v_add_u32_dpp v91, v91, v91 row_shr:8 row_mask:0xf bank_mask:0xf bound_ctrl:1
    s_nop 1
    v_add_u32_dpp v91, v91, v91 row_bcast:15 row_mask:0xa bank_mask:0xf
    s_nop 1
    v_add_u32_dpp v91, v91, v91 row_bcast:31 row_mask:0xc bank_mask:0xf
    v_add_u32 v98, v98, v91
    v_readlane_b32 s37, v91, 63
    s_cbranch_vccnz L2_xo3
L2_xp3:
    v_mov_b32 v44, v43
    s_cmp_gt_u32 s37, 1024
    s_cbranch_scc1 L2_xs4
    s_cmp_lg_u32 s101, 0
    s_cbranch_scc1 L2_xa4
L2_xb4:
    v_lshlrev_b32 v89, 16, v96
    v_add_u32 v90, 60, v97
    v_bitop3_b32 v90, v89, v45, v90 bitop3:0x6a
    ds_write_b32 v98, v90 offset:12
    v_lshlrev_b32 v89, 20, v96
    v_add_u32 v90, 40, v97
    v_bitop3_b32 v90, v89, v45, v90 bitop3:0x6a
    ds_write_b32 v98, v90 offset:8
    v_lshlrev_b32 v89, 24, v96
    v_add_u32 v90, 20, v97
    v_bitop3_b32 v90, v89, v45, v90 bitop3:0x6a
    ds_write_b32 v98, v90 offset:4
    v_lshlrev_b32 v89, 28, v96
    v_bitop3_b32 v90, v89, v45, v97 bitop3:0x6a
    ds_write_b32 v98, v90 offset:0
    v_mov_b32_dpp v91, v64 quad_perm:[0,0,0,0] row_mask:0xf bank_mask:0xf
    v_and_b32 v89, 3, v91
    v_and_b32 v97, 0xfffc, v91
    v_sub_u16_dpp v88, v64, v91 quad_perm:[2,2,2,2] row_mask:0xf bank_mask:0xf
    v_mad_u32_u24 v97, v97, 5, v4
    v_add_u32 v99, v88, v89
    v_bfm_b32 v96, v88, v89
    v_cmp_lt_u32 s[58:59], 16, v99
    v_lshlrev_b32 v89, v1, v96
    v_and_b32 v89, v45, v89
    v_cmp_ne_u32 vcc, 0, v89
    v_xor_b32 v90, v97, v89
    s_add_u32 s3, s37, s38
    v_mbcnt_lo_u32_b32 v98, vcc_lo, 0
    v_mbcnt_hi_u32_b32 v98, vcc_hi, v98
    s_bcnt1_i32_b64 s41, vcc
    v_lshl_add_u32 v98, v98, 2, s3
    s_lshl2_add_u32 s37, s41, s37
    s_mov_b64 exec, vcc
    ds_write_b32 v98, v90
    s_mov_b64 exec, -1
    s_cmp_lg_u64 s[58:59], 0
    s_cbranch_scc1 L2_xe4
L2_xr4:
    v_add_u32 v98, s37, v0
    v_mov_b32 v90, -1
    ds_write_b32 v98, v90
    v_add_u32 v98, s38, v0
    ds_read2st64_b32 v[40:41], v0 offset0:0 offset1:1
    ds_read_b32 v43, v0 offset:512
    v_lshrrev_b32 v98, 1, v98
    v_and_b32 v98, -4, v98
    ds_read_b32 v42, v98 offset:768
    s_sub_u32 s3, s37, 768
    s_cmp_gt_u32 s3, 128
    s_cbranch_scc1 L2_xf4
L2_xg4:
    v_sub_u16 v88, v58, v50
    v_and_b32 v89, 3, v50
    v_add3_u32 v99, v88, v89, 3
    v_and_b32 v99, -4, v99
    v_max_u32 v99, 4, v99
    v_and_b32 v97, 0xfffc, v50
    v_bfm_b32 v96, v88, v89
    v_add_u32_dpp v91, v99, v99 row_shr:1 row_mask:0xf bank_mask:0xf bound_ctrl:1
    v_mad_u32_u24 v97, v97, 5, v2
    v_cmp_lt_u32 vcc, 16, v99
    v_add_u32_dpp v91, v91, v91 row_shr:2 row_mask:0xf bank_mask:0xf bound_ctrl:1
    v_sub_u32 v98, s38, v99
    v_lshrrev_b64 v[50:51], 16, v[50:51]
    v_add_u32_dpp v91, v91, v91 row_shr:4 row_mask:0xf bank_mask:0xf bound_ctrl:1
    v_lshrrev_b64 v[58:59], 16, v[58:59]
    s_mov_b32 s101, 0
    v_add_u32_dpp v91, v91, v91 row_shr:8 row_mask:0xf bank_mask:0xf bound_ctrl:1
    s_nop 1
    v_add_u32_dpp v91, v91, v91 row_bcast:15 row_mask:0xa bank_mask:0xf
    s_nop 1
    v_add_u32_dpp v91, v91, v91 row_bcast:31 row_mask:0xc bank_mask:0xf
    v_add_u32 v98, v98, v91
    v_readlane_b32 s37, v91, 63
    s_cbranch_vccnz L2_xo5
L2_xp5:
    s_waitcnt lgkmcnt(0)
    v_mov_b32 v21, v40
    v_mov_b32 v27, v41
    v_mov_b32 v31, v42
    v_mov_b32 v39, v43
    v_mov_b32 v44, v43
    s_cmp_gt_u32 s37, 1024
    s_cbranch_scc1 L2_xs6
    s_cmp_lg_u32 s101, 0
    s_cbranch_scc1 L2_xa6
L2_xb6:
    v_lshlrev_b32 v89, 16, v96
    v_add_u32 v90, 60, v97
    v_bitop3_b32 v90, v89, v45, v90 bitop3:0x6a
    ds_write_b32 v98, v90 offset:12
    v_lshlrev_b32 v89, 20, v96
    v_add_u32 v90, 40, v97
    v_bitop3_b32 v90, v89, v45, v90 bitop3:0x6a
    ds_write_b32 v98, v90 offset:8
    v_lshlrev_b32 v89, 24, v96
    v_add_u32 v90, 20, v97
    v_bitop3_b32 v90, v89, v45, v90 bitop3:0x6a
    ds_write_b32 v98, v90 offset:4
    v_lshlrev_b32 v89, 28, v96
    v_bitop3_b32 v90, v89, v45, v97 bitop3:0x6a
    ds_write_b32 v98, v90 offset:0
    v_mov_b32_dpp v91, v66 quad_perm:[0,0,0,0] row_mask:0xf bank_mask:0xf
    v_and_b32 v89, 3, v91
    v_and_b32 v97, 0xfffc, v91
    v_sub_u16_dpp v88, v66, v91 quad_perm:[2,2,2,2] row_mask:0xf bank_mask:0xf
    v_mad_u32_u24 v97, v97, 5, v4
    v_add_u32 v99, v88, v89
    v_bfm_b32 v96, v88, v89
    v_cmp_lt_u32 s[58:59], 16, v99
    v_lshlrev_b32 v89, v1, v96
    v_and_b32 v89, v45, v89
    v_cmp_ne_u32 vcc, 0, v89
    v_xor_b32 v90, v97, v89
    s_add_u32 s3, s37, s38
    v_mbcnt_lo_u32_b32 v98, vcc_lo, 0
    v_mbcnt_hi_u32_b32 v98, vcc_hi, v98
    s_bcnt1_i32_b64 s41, vcc
    v_lshl_add_u32 v98, v98, 2, s3
    s_lshl2_add_u32 s37, s41, s37
    s_mov_b64 exec, vcc
    ds_write_b32 v98, v90
    s_mov_b64 exec, -1
    s_cmp_lg_u64 s[58:59], 0
    s_cbranch_scc1 L2_xe6
L2_xr6:
    v_add_u32 v98, s37, v0
    v_mov_b32 v90, -1
    ds_write_b32 v98, v90
    v_add_u32 v98, s38, v0
    ds_read2st64_b32 v[40:41], v0 offset0:0 offset1:1
    ds_read_b32 v43, v0 offset:512
    v_lshrrev_b32 v98, 1, v98
    v_and_b32 v98, -4, v98
    ds_read_b32 v42, v98 offset:768
    s_sub_u32 s3, s37, 768
    s_cmp_gt_u32 s3, 128
    s_cbranch_scc1 L2_xf6
L2_xg6:
    v_subrev_u32 v88, s38, v3
    ds_write_b128 v88, v[124:127] offset:34816
    v_subrev_u32 v88, s38, v3
    ds_write_b128 v88, v[116:119] offset:32768
    v_subrev_u32 v88, s38, v3
    ds_write_b128 v88, v[120:123] offset:33792
    v_subrev_u32 v88, s100, v3
    ds_write_b128 v88, v[108:111] offset:0
    v_subrev_u32 v88, s100, v3
    ds_write_b128 v88, v[112:115] offset:1024
    s_cmp_eq_u32 s56, 0
    s_cbranch_scc1 L2_e2
    s_mov_b32 exec_lo, s56
    s_mov_b32 exec_hi, 0
    buffer_load_dword v88, v7, s[60:63], 0 offen sc1
    s_mov_b64 exec, -1
    s_waitcnt vmcnt(0)
    v_cmp_gt_u32 vcc, 2, v88
    s_and_b32 s56, vcc_lo, s56
    s_cbranch_scc0 L2_e2
    s_mul_i32 s3, s33, 1280000
    s_add_u32 s3, s3, s100
    s_add_u32 s3, s3, 352768
    buffer_load_dwordx4 v[124:127], v94, s[24:27], s3 offen offset:2048
    s_mul_i32 s3, s33, 1280000
    s_add_u32 s3, s3, s100
    s_add_u32 s3, s3, 352768
    buffer_load_dwordx4 v[116:119], v94, s[24:27], s3 offen offset:0
    s_mul_i32 s3, s33, 1280000
    s_add_u32 s3, s3, s100
    s_add_u32 s3, s3, 352768
    buffer_load_dwordx4 v[120:123], v94, s[24:27], s3 offen offset:1024
    s_mul_i32 s3, s33, 1280000
    s_add_u32 s3, s3, s38
    s_add_u32 s3, s3, 320000
    buffer_load_dwordx4 v[108:111], v94, s[24:27], s3 offen offset:0
    s_mul_i32 s3, s33, 1280000
    s_add_u32 s3, s3, s38
    s_add_u32 s3, s3, 320000
    buffer_load_dwordx4 v[112:115], v94, s[24:27], s3 offen offset:1024
    s_mov_b32 exec_lo, s56
    s_mov_b32 exec_hi, 0
L2_p2:
    buffer_load_dword v88, v7, s[60:63], 0 offen sc1
    s_waitcnt vmcnt(0)
    v_cmpx_gt_u32 vcc, 2, v88
    s_cbranch_vccnz L2_p2s
    s_mov_b64 exec, -1
L2_e2:
    s_mov_b32 s6, 0xaaaaaaaa
    s_mov_b32 s7, 0xaaaaaaaa
    v_and_b32 v47, 0x0fffffff, v21
    buffer_load_dwordx2 v[16:17], v47, s[8:11], 0 offen
    buffer_load_dwordx3 v[18:20], v47, s[8:11], 0 offen offset:8
    s_setprio 1
    v_and_b32 v47, 0x0fffffff, v27
    buffer_load_dwordx2 v[22:23], v47, s[8:11], 0 offen
    buffer_load_dwordx3 v[24:26], v47, s[8:11], 0 offen offset:8
    s_waitcnt lgkmcnt(0)
    s_barrier
    s_bitcmp1_b32 s36, s42
    s_cbranch_scc1 L2_slow
L2_ret0:
    s_setprio 3
    s_bitcmp1_b32 s43, s42
    s_cbranch_scc1 L2_oa7
L2_ob7:
    s_bitcmp1_b32 s43, s42
    s_cbranch_scc1 L2_oa8
L2_ob8:
    s_waitcnt vmcnt(2)
    v_and_b32 v46, 0x20000000, v21
    v_lshrrev_b32 v47, 14, v17
    v_bitop3_b32 v47, v47, v5, v46 bitop3:0xea
    ds_read_b64 v[102:103], v47
    v_bitop3_b32 v93, v17, v5, v46 bitop3:0xea
    v_and_b32 v46, 0x10000000, v21
    v_lshrrev_b32 v47, 14, v16
    v_bitop3_b32 v47, v47, v5, v46 bitop3:0xea
    ds_read_b64 v[100:101], v47
    v_bitop3_b32 v92, v16, v5, v46 bitop3:0xea
    v_perm_b32 v15, v17, v20, s45
    v_bitop3_b32 v46, v17, 0.5, -0.5 bitop3:0xa8
    v_perm_b32 v14, v16, v20, s44
    v_bitop3_b32 v47, v16, 0.5, -0.5 bitop3:0xa8
    v_bitop3_b32 v15, v6, v15, v46 bitop3:0xca
    v_bitop3_b32 v14, v6, v14, v47 bitop3:0xca
    s_waitcnt lgkmcnt(0)
    v_mfma_f32_4x4x4_16b_bf16 v[80:83], v[8:9], v[102:103], 0
    v_mfma_f32_4x4x4_16b_bf16 v[76:79], v[8:9], v[100:101], 0
    v_cmp_lt_u32 s[84:85], v5, v92
    s_nop 2
    v_pk_mul_f32 v[80:81], v[80:81], v[14:15] op_sel:[0,1] op_sel_hi:[1,1]
    v_pk_mul_f32 v[82:83], v[82:83], v[14:15] op_sel:[0,1] op_sel_hi:[1,1]
    v_pk_mul_f32 v[76:77], v[76:77], v[14:15] op_sel:[0,0] op_sel_hi:[1,0]
    v_pk_mul_f32 v[78:79], v[78:79], v[14:15] op_sel:[0,0] op_sel_hi:[1,0]
    v_and_b32 v47, 0x0fffffff, v39
    buffer_load_dwordx2 v[34:35], v47, s[8:11], 0 offen
    buffer_load_dwordx3 v[36:38], v47, s[8:11], 0 offen offset:8
    v_and_b32 v46, 0x80000000, v21
    v_lshrrev_b32 v47, 14, v19
    v_bitop3_b32 v47, v47, v5, v46 bitop3:0xea
    ds_read_b64 v[106:107], v47
    v_and_b32 v99, 0x40000000, v21
    v_lshrrev_b32 v47, 14, v18
    v_bitop3_b32 v47, v47, v5, v99 bitop3:0xea
    ds_read_b64 v[104:105], v47
    v_cmp_ne_u64 s[50:51], v[72:73], v[68:69]
    v_cmpx_ne_u64 s[54:55], v[74:75], v[70:71]
    s_and_b64 s[82:83], s[54:55], s[80:81]
    s_cbranch_scc1 L2_c9
L2_d9:
    v_mov_b64 v[84:85], v[70:71]
    v_mov_b32 v7, v95
    v_mov_b64 v[86:87], v[74:75]
    s_or_b64 s[80:81], s[80:81], s[54:55]
    s_mov_b64 exec, s[50:51]
    s_and_b64 s[82:83], s[50:51], s[80:81]
    s_cbranch_scc1 L2_c10
L2_d10:
    v_mov_b64 v[84:85], v[68:69]
    v_mov_b32 v7, v94
    v_mov_b64 v[86:87], v[72:73]
    s_mov_b64 exec, -1
    s_or_b64 s[80:81], s[80:81], s[50:51]
    s_and_b64 exec, s[84:85], s[80:81]
    v_mfma_f32_4x4x4_16b_bf16 v[76:79], v[12:13], v[84:85], 0
    v_mov_b32 v92, v7
    s_andn2_b64 s[80:81], s[80:81], s[84:85]
    v_mfma_f32_4x4x4_16b_bf16 v[76:79], v[10:11], v[86:87], v[76:79]
    s_mov_b64 exec, -1
    ds_read_b64 v[70:71], v93 offset:65408
    ds_read_b64 v[68:69], v92 offset:65408
    v_bitop3_b32 v94, v18, v5, v99 bitop3:0xea
    v_bitop3_b32 v95, v19, v5, v46 bitop3:0xea
    v_perm_b32 v15, v19, v20, s47
    v_bitop3_b32 v46, v19, 0.5, -0.5 bitop3:0xa8
    v_perm_b32 v14, v18, v20, s46
    v_bitop3_b32 v47, v18, 0.5, -0.5 bitop3:0xa8
    v_bitop3_b32 v15, v6, v15, v46 bitop3:0xca
    v_bitop3_b32 v14, v6, v14, v47 bitop3:0xca
    s_waitcnt lgkmcnt(1)
    v_mfma_f32_4x4x4_16b_bf16 v[80:83], v[10:11], v[70:71], v[80:83]
    s_waitcnt lgkmcnt(0)
    v_mfma_f32_4x4x4_16b_bf16 v[76:79], v[10:11], v[68:69], v[76:79]
    s_nop 2
    v_cvt_pk_bf16_f32 v80, v80, v81
    v_cvt_pk_bf16_f32 v81, v82, v83
    ds_wrxchg_rtn_b64 v[74:75], v93, v[80:81] offset:65408
    v_cvt_pk_bf16_f32 v76, v76, v77
    v_cvt_pk_bf16_f32 v77, v78, v79
    ds_wrxchg_rtn_b64 v[72:73], v92, v[76:77] offset:65408
    s_setprio 2
    v_mfma_f32_4x4x4_16b_bf16 v[80:83], v[8:9], v[106:107], 0
    v_mfma_f32_4x4x4_16b_bf16 v[76:79], v[8:9], v[104:105], 0
    v_cmp_lt_u32 s[48:49], v5, v95
    s_nop 2
    v_pk_mul_f32 v[80:81], v[80:81], v[14:15] op_sel:[0,1] op_sel_hi:[1,1]
    v_pk_mul_f32 v[82:83], v[82:83], v[14:15] op_sel:[0,1] op_sel_hi:[1,1]
    v_pk_mul_f32 v[76:77], v[76:77], v[14:15] op_sel:[0,0] op_sel_hi:[1,0]
    v_pk_mul_f32 v[78:79], v[78:79], v[14:15] op_sel:[0,0] op_sel_hi:[1,0]
    v_and_b32 v47, 0x0fffffff, v31
    buffer_load_dword v30, v47, s[8:11], 0 offen offset:16
    s_mov_b64 exec, s[6:7]
    v_add_u32 v47, 8, v47
    v_lshrrev_b32 v31, 2, v31
    s_mov_b64 exec, -1
    buffer_load_dwordx2 v[28:29], v47, s[8:11], 0 offen
    v_and_b32 v47, 0x3f0, v3
    s_cmp_lg_u32 s56, 0
    s_cbranch_scc1 L2_m11
    s_mul_i32 s3, s33, 1280000
    s_add_u32 s3, s3, s100
    s_add_u32 s3, s3, 352768
    buffer_load_dwordx4 v[124:127], v47, s[24:27], s3 offen offset:2048
L2_m11:
    v_and_b32 v47, 0x3f0, v3
    s_cmp_lg_u32 s56, 0
    s_cbranch_scc1 L2_m12
    s_mul_i32 s3, s33, 1280000
    s_add_u32 s3, s3, s100
    s_add_u32 s3, s3, 352768
    buffer_load_dwordx4 v[116:119], v47, s[24:27], s3 offen offset:0
L2_m12:
    s_waitcnt vmcnt(4)
    v_and_b32 v46, 0x20000000, v27
    v_lshrrev_b32 v47, 14, v23
    v_bitop3_b32 v47, v47, v5, v46 bitop3:0xea
    ds_read_b64 v[102:103], v47
    v_and_b32 v99, 0x10000000, v27
    v_lshrrev_b32 v47, 14, v22
    v_bitop3_b32 v47, v47, v5, v99 bitop3:0xea
    ds_read_b64 v[100:101], v47
    s_waitcnt lgkmcnt(2)
    v_cmp_ne_u64 s[50:51], v[72:73], v[68:69]
    v_cmpx_ne_u64 s[54:55], v[74:75], v[70:71]
    s_and_b64 s[82:83], s[54:55], s[80:81]
    s_cbranch_scc1 L2_c13
L2_d13:
    v_mov_b64 v[84:85], v[70:71]
    v_mov_b32 v7, v93
    v_mov_b64 v[86:87], v[74:75]
    s_or_b64 s[80:81], s[80:81], s[54:55]
    s_mov_b64 exec, s[50:51]
    s_and_b64 s[82:83], s[50:51], s[80:81]
    s_cbranch_scc1 L2_c14
L2_d14:
    v_mov_b64 v[84:85], v[68:69]
    v_mov_b32 v7, v92
    v_mov_b64 v[86:87], v[72:73]
    s_mov_b64 exec, -1
    s_or_b64 s[80:81], s[80:81], s[50:51]
    s_and_b64 exec, s[48:49], s[80:81]
    v_mfma_f32_4x4x4_16b_bf16 v[80:83], v[12:13], v[84:85], 0
    v_mov_b32 v95, v7
    s_andn2_b64 s[80:81], s[80:81], s[48:49]
    v_mfma_f32_4x4x4_16b_bf16 v[80:83], v[10:11], v[86:87], v[80:83]
    s_mov_b64 exec, -1
    ds_read_b64 v[70:71], v95 offset:65408
    ds_read_b64 v[68:69], v94 offset:65408
    v_bitop3_b32 v92, v22, v5, v99 bitop3:0xea
    v_bitop3_b32 v93, v23, v5, v46 bitop3:0xea
    v_perm_b32 v15, v23, v26, s45
    v_bitop3_b32 v46, v23, 0.5, -0.5 bitop3:0xa8
    v_perm_b32 v14, v22, v26, s44
    v_bitop3_b32 v47, v22, 0.5, -0.5 bitop3:0xa8
    v_bitop3_b32 v15, v6, v15, v46 bitop3:0xca
    v_bitop3_b32 v14, v6, v14, v47 bitop3:0xca
    s_waitcnt lgkmcnt(1)
    v_mfma_f32_4x4x4_16b_bf16 v[80:83], v[10:11], v[70:71], v[80:83]
    s_waitcnt lgkmcnt(0)
    v_mfma_f32_4x4x4_16b_bf16 v[76:79], v[10:11], v[68:69], v[76:79]
    s_nop 2
    v_cvt_pk_bf16_f32 v80, v80, v81
    v_cvt_pk_bf16_f32 v81, v82, v83
    ds_wrxchg_rtn_b64 v[74:75], v95, v[80:81] offset:65408
    v_cvt_pk_bf16_f32 v76, v76, v77
    v_cvt_pk_bf16_f32 v77, v78, v79
    ds_wrxchg_rtn_b64 v[72:73], v94, v[76:77] offset:65408
    s_setprio 1
    v_mfma_f32_4x4x4_16b_bf16 v[80:83], v[8:9], v[102:103], 0
    v_mfma_f32_4x4x4_16b_bf16 v[76:79], v[8:9], v[100:101], 0
    s_nop 3
    v_pk_mul_f32 v[80:81], v[80:81], v[14:15] op_sel:[0,1] op_sel_hi:[1,1]
    v_pk_mul_f32 v[82:83], v[82:83], v[14:15] op_sel:[0,1] op_sel_hi:[1,1]
    v_pk_mul_f32 v[76:77], v[76:77], v[14:15] op_sel:[0,0] op_sel_hi:[1,0]
    v_pk_mul_f32 v[78:79], v[78:79], v[14:15] op_sel:[0,0] op_sel_hi:[1,0]
    v_and_b32 v47, 0x3f0, v3
    s_cmp_lg_u32 s56, 0
    s_cbranch_scc1 L2_m15
    s_mul_i32 s3, s33, 1280000
    s_add_u32 s3, s3, s100
    s_add_u32 s3, s3, 352768
    buffer_load_dwordx4 v[120:123], v47, s[24:27], s3 offen offset:1024
L2_m15:
    v_sub_u16 v88, v60, v52
    v_and_b32 v89, 3, v52
    v_add3_u32 v99, v88, v89, 3
    v_and_b32 v99, -4, v99
    v_max_u32 v99, 4, v99
    v_and_b32 v97, 0xfffc, v52
    v_bfm_b32 v96, v88, v89
    v_add_u32_dpp v91, v99, v99 row_shr:1 row_mask:0xf bank_mask:0xf bound_ctrl:1
    v_mad_u32_u24 v97, v97, 5, v2
    v_cmp_lt_u32 vcc, 16, v99
    v_add_u32_dpp v91, v91, v91 row_shr:2 row_mask:0xf bank_mask:0xf bound_ctrl:1
    v_sub_u32 v98, s38, v99
    v_lshrrev_b64 v[52:53], 16, v[52:53]
    v_add_u32_dpp v91, v91, v91 row_shr:4 row_mask:0xf bank_mask:0xf bound_ctrl:1
    v_lshrrev_b64 v[60:61], 16, v[60:61]
    s_mov_b32 s101, 0
    v_add_u32_dpp v91, v91, v91 row_shr:8 row_mask:0xf bank_mask:0xf bound_ctrl:1
    s_nop 1
    v_add_u32_dpp v91, v91, v91 row_bcast:15 row_mask:0xa bank_mask:0xf
    s_nop 1
    v_add_u32_dpp v91, v91, v91 row_bcast:31 row_mask:0xc bank_mask:0xf
    v_add_u32 v98, v98, v91
    v_readlane_b32 s37, v91, 63
    s_cbranch_vccnz L2_xo16
L2_xp16:
    v_and_b32 v46, 0x80000000, v27
    v_lshrrev_b32 v47, 14, v25
    v_bitop3_b32 v47, v47, v5, v46 bitop3:0xea
    ds_read_b64 v[106:107], v47
    v_and_b32 v99, 0x40000000, v27
    v_lshrrev_b32 v47, 14, v24
    v_bitop3_b32 v47, v47, v5, v99 bitop3:0xea
    ds_read_b64 v[104:105], v47
    s_waitcnt lgkmcnt(2)
    v_cmp_ne_u64 s[50:51], v[72:73], v[68:69]
    v_cmpx_ne_u64 s[54:55], v[74:75], v[70:71]
    s_and_b64 s[82:83], s[54:55], s[80:81]
    s_cbranch_scc1 L2_c17
L2_d17:
    v_mov_b64 v[84:85], v[70:71]
    v_mov_b32 v7, v95
    v_mov_b64 v[86:87], v[74:75]
    s_or_b64 s[80:81], s[80:81], s[54:55]
    s_mov_b64 exec, s[50:51]
    s_and_b64 s[82:83], s[50:51], s[80:81]
    s_cbranch_scc1 L2_c18
L2_d18:
    v_mov_b64 v[84:85], v[68:69]
    v_mov_b32 v7, v94
    v_mov_b64 v[86:87], v[72:73]
    s_mov_b64 exec, -1
    s_or_b64 s[80:81], s[80:81], s[50:51]
    ds_read_b64 v[70:71], v93 offset:65408
    ds_read_b64 v[68:69], v92 offset:65408
    v_bitop3_b32 v94, v24, v5, v99 bitop3:0xea
    v_bitop3_b32 v95, v25, v5, v46 bitop3:0xea
    v_perm_b32 v15, v25, v26, s47
    v_bitop3_b32 v46, v25, 0.5, -0.5 bitop3:0xa8
    v_perm_b32 v14, v24, v26, s46
    v_bitop3_b32 v47, v24, 0.5, -0.5 bitop3:0xa8
    v_bitop3_b32 v15, v6, v15, v46 bitop3:0xca
    v_bitop3_b32 v14, v6, v14, v47 bitop3:0xca
    s_waitcnt lgkmcnt(1)
    v_mfma_f32_4x4x4_16b_bf16 v[80:83], v[10:11], v[70:71], v[80:83]
    s_waitcnt lgkmcnt(0)
    v_mfma_f32_4x4x4_16b_bf16 v[76:79], v[10:11], v[68:69], v[76:79]
    s_nop 2
    v_cvt_pk_bf16_f32 v80, v80, v81
    v_cvt_pk_bf16_f32 v81, v82, v83
    ds_wrxchg_rtn_b64 v[74:75], v93, v[80:81] offset:65408
    v_cvt_pk_bf16_f32 v76, v76, v77
    v_cvt_pk_bf16_f32 v77, v78, v79
    ds_wrxchg_rtn_b64 v[72:73], v92, v[76:77] offset:65408
    v_mfma_f32_4x4x4_16b_bf16 v[80:83], v[8:9], v[106:107], 0
    v_mfma_f32_4x4x4_16b_bf16 v[76:79], v[8:9], v[104:105], 0
    v_cmp_lt_u32 s[84:85], v5, v94
    s_nop 2
    v_pk_mul_f32 v[80:81], v[80:81], v[14:15] op_sel:[0,1] op_sel_hi:[1,1]
    v_pk_mul_f32 v[82:83], v[82:83], v[14:15] op_sel:[0,1] op_sel_hi:[1,1]
    v_pk_mul_f32 v[76:77], v[76:77], v[14:15] op_sel:[0,0] op_sel_hi:[1,0]
    v_pk_mul_f32 v[78:79], v[78:79], v[14:15] op_sel:[0,0] op_sel_hi:[1,0]
    v_and_b32 v47, 0x3f0, v3
    s_cmp_lg_u32 s56, 0
    s_cbranch_scc1 L2_m19
    s_mul_i32 s3, s33, 1280000
    s_add_u32 s3, s3, s38
    s_add_u32 s3, s3, 320000
    buffer_load_dwordx4 v[108:111], v47, s[24:27], s3 offen offset:0
L2_m19:
    v_and_b32 v47, 0x3f0, v3
    s_cmp_lg_u32 s56, 0
    s_cbranch_scc1 L2_m20
    s_mul_i32 s3, s33, 1280000
    s_add_u32 s3, s3, s38
    s_add_u32 s3, s3, 320000
    buffer_load_dwordx4 v[112:115], v47, s[24:27], s3 offen offset:1024
L2_m20:
    v_and_b32 v47, 0x0fffffff, v40
    v_mov_b32 v21, v40
    buffer_load_dwordx2 v[16:17], v47, s[8:11], 0 offen
    buffer_load_dwordx3 v[18:20], v47, s[8:11], 0 offen offset:8
    s_waitcnt vmcnt(2)
    s_mov_b64 exec, s[6:7]
    v_lshrrev_b32 v30, 16, v30
    s_mov_b64 exec, -1
    v_and_b32 v46, 0x20000000, v31
    v_lshrrev_b32 v47, 14, v29
    v_bitop3_b32 v47, v47, v5, v46 bitop3:0xea
    ds_read_b64 v[102:103], v47
    v_and_b32 v99, 0x10000000, v31
    v_lshrrev_b32 v47, 14, v28
    v_bitop3_b32 v47, v47, v5, v99 bitop3:0xea
    ds_read_b64 v[100:101], v47
    s_waitcnt lgkmcnt(2)
    v_cmp_ne_u64 s[50:51], v[72:73], v[68:69]
    v_cmpx_ne_u64 s[54:55], v[74:75], v[70:71]
    s_and_b64 s[82:83], s[54:55], s[80:81]
    s_cbranch_scc1 L2_c21
L2_d21:
    v_mov_b64 v[84:85], v[70:71]
    v_mov_b32 v7, v93
    v_mov_b64 v[86:87], v[74:75]
    s_or_b64 s[80:81], s[80:81], s[54:55]
    s_mov_b64 exec, s[50:51]
    s_and_b64 s[82:83], s[50:51], s[80:81]
    s_cbranch_scc1 L2_c22
L2_d22:
    v_mov_b64 v[84:85], v[68:69]
    v_mov_b32 v7, v92
    v_mov_b64 v[86:87], v[72:73]
    s_mov_b64 exec, -1
    s_or_b64 s[80:81], s[80:81], s[50:51]
    s_and_b64 exec, s[84:85], s[80:81]
    v_mfma_f32_4x4x4_16b_bf16 v[76:79], v[12:13], v[84:85], 0
    v_mov_b32 v94, v7
    s_andn2_b64 s[80:81], s[80:81], s[84:85]
    v_mfma_f32_4x4x4_16b_bf16 v[76:79], v[10:11], v[86:87], v[76:79]
    s_mov_b64 exec, -1
    ds_read_b64 v[70:71], v95 offset:65408
    ds_read_b64 v[68:69], v94 offset:65408
    v_bitop3_b32 v92, v28, v5, v99 bitop3:0xea
    v_bitop3_b32 v93, v29, v5, v46 bitop3:0xea
    v_perm_b32 v15, v29, v30, s45
    v_bitop3_b32 v46, v29, 0.5, -0.5 bitop3:0xa8
    v_perm_b32 v14, v28, v30, s44
    v_bitop3_b32 v47, v28, 0.5, -0.5 bitop3:0xa8
    v_bitop3_b32 v15, v6, v15, v46 bitop3:0xca
    v_bitop3_b32 v14, v6, v14, v47 bitop3:0xca
    s_waitcnt lgkmcnt(1)
    v_mfma_f32_4x4x4_16b_bf16 v[80:83], v[10:11], v[70:71], v[80:83]
    s_waitcnt lgkmcnt(0)
    v_mfma_f32_4x4x4_16b_bf16 v[76:79], v[10:11], v[68:69], v[76:79]
    s_nop 2
    v_cvt_pk_bf16_f32 v80, v80, v81
    v_cvt_pk_bf16_f32 v81, v82, v83
    ds_wrxchg_rtn_b64 v[74:75], v95, v[80:81] offset:65408
    v_cvt_pk_bf16_f32 v76, v76, v77
    v_cvt_pk_bf16_f32 v77, v78, v79
    ds_wrxchg_rtn_b64 v[72:73], v94, v[76:77] offset:65408
    s_setprio 0
    v_mfma_f32_4x4x4_16b_bf16 v[80:83], v[8:9], v[102:103], 0
    v_mfma_f32_4x4x4_16b_bf16 v[76:79], v[8:9], v[100:101], 0
    v_cmp_lt_u32 s[48:49], v5, v93
    s_nop 2
    v_pk_mul_f32 v[80:81], v[80:81], v[14:15] op_sel:[0,1] op_sel_hi:[1,1]
    v_pk_mul_f32 v[82:83], v[82:83], v[14:15] op_sel:[0,1] op_sel_hi:[1,1]
    v_pk_mul_f32 v[76:77], v[76:77], v[14:15] op_sel:[0,0] op_sel_hi:[1,0]
    v_pk_mul_f32 v[78:79], v[78:79], v[14:15] op_sel:[0,0] op_sel_hi:[1,0]
    s_add_u32 s40, s40, 0x50000
    v_and_b32 v47, 0x0fffffff, v41
    v_mov_b32 v27, v41
    buffer_load_dwordx2 v[22:23], v47, s[8:11], 0 offen
    buffer_load_dwordx3 v[24:26], v47, s[8:11], 0 offen offset:8
    v_and_b32 v46, 0x80000000, v39
    v_lshrrev_b32 v47, 14, v37
    v_bitop3_b32 v47, v47, v5, v46 bitop3:0xea
    ds_read_b64 v[102:103], v47
    v_and_b32 v99, 0x40000000, v39
    v_lshrrev_b32 v47, 14, v36
    v_bitop3_b32 v47, v47, v5, v99 bitop3:0xea
    ds_read_b64 v[100:101], v47
    v_and_b32 v46, 0x20000000, v39
    v_lshrrev_b32 v47, 14, v35
    v_bitop3_b32 v47, v47, v5, v46 bitop3:0xea
    ds_read_b64 v[106:107], v47
    v_and_b32 v99, 0x10000000, v39
    v_lshrrev_b32 v47, 14, v34
    v_bitop3_b32 v47, v47, v5, v99 bitop3:0xea
    ds_read_b64 v[104:105], v47
    s_waitcnt lgkmcnt(4)
    v_cmp_ne_u64 s[50:51], v[72:73], v[68:69]
    v_cmpx_ne_u64 s[54:55], v[74:75], v[70:71]
    s_and_b64 s[82:83], s[54:55], s[80:81]
    s_cbranch_scc1 L2_c23
L2_d23:
    v_mov_b64 v[84:85], v[70:71]
    v_mov_b32 v7, v95
    v_mov_b64 v[86:87], v[74:75]
    s_or_b64 s[80:81], s[80:81], s[54:55]
    s_mov_b64 exec, s[50:51]
    s_and_b64 s[82:83], s[50:51], s[80:81]
    s_cbranch_scc1 L2_c24
L2_d24:
    v_mov_b64 v[84:85], v[68:69]
    v_mov_b32 v7, v94
    v_mov_b64 v[86:87], v[72:73]
    s_mov_b64 exec, -1
    s_or_b64 s[80:81], s[80:81], s[50:51]
    s_and_b64 exec, s[48:49], s[80:81]
    v_mfma_f32_4x4x4_16b_bf16 v[80:83], v[12:13], v[84:85], 0
    v_mov_b32 v93, v7
    s_andn2_b64 s[80:81], s[80:81], s[48:49]
    v_mfma_f32_4x4x4_16b_bf16 v[80:83], v[10:11], v[86:87], v[80:83]
    s_mov_b64 exec, -1
    ds_read_b64 v[70:71], v93 offset:65408
    ds_read_b64 v[68:69], v92 offset:65408
    v_bitop3_b32 v94, v34, v5, v99 bitop3:0xea
    v_bitop3_b32 v95, v35, v5, v46 bitop3:0xea
    v_perm_b32 v15, v35, v38, s45
    v_bitop3_b32 v46, v35, 0.5, -0.5 bitop3:0xa8
    v_perm_b32 v14, v34, v38, s44
    v_bitop3_b32 v47, v34, 0.5, -0.5 bitop3:0xa8
    v_bitop3_b32 v15, v6, v15, v46 bitop3:0xca
    v_bitop3_b32 v14, v6, v14, v47 bitop3:0xca
    s_waitcnt lgkmcnt(1)
    v_mfma_f32_4x4x4_16b_bf16 v[80:83], v[10:11], v[70:71], v[80:83]
    s_waitcnt lgkmcnt(0)
    v_mfma_f32_4x4x4_16b_bf16 v[76:79], v[10:11], v[68:69], v[76:79]
    s_nop 2
    v_cvt_pk_bf16_f32 v80, v80, v81
    v_cvt_pk_bf16_f32 v81, v82, v83
    ds_wrxchg_rtn_b64 v[74:75], v93, v[80:81] offset:65408
    v_cvt_pk_bf16_f32 v76, v76, v77
    v_cvt_pk_bf16_f32 v77, v78, v79
    ds_wrxchg_rtn_b64 v[72:73], v92, v[76:77] offset:65408
    s_barrier
    s_setprio 3
    s_waitcnt vmcnt(4)
    v_subrev_u32 v88, s38, v3
    ds_write_b128 v88, v[124:127] offset:34816
    s_add_u32 s3, s40, 4096
    buffer_load_dwordx4 v[124:127], v3, s[16:19], s3 offen sc1
    s_waitcnt vmcnt(5)
    v_subrev_u32 v88, s38, v3
    ds_write_b128 v88, v[116:119] offset:32768
    buffer_load_dwordx4 v[116:119], v3, s[16:19], s40 offen offset:2048 sc1
    s_waitcnt vmcnt(6)
    v_subrev_u32 v88, s38, v3
    ds_write_b128 v88, v[120:123] offset:33792
    buffer_load_dwordx4 v[120:123], v3, s[16:19], s40 offen offset:3072 sc1
    v_mfma_f32_4x4x4_16b_bf16 v[80:83], v[8:9], v[106:107], 0
    v_mfma_f32_4x4x4_16b_bf16 v[76:79], v[8:9], v[104:105], 0
    s_nop 3
    v_pk_mul_f32 v[80:81], v[80:81], v[14:15] op_sel:[0,1] op_sel_hi:[1,1]
    v_pk_mul_f32 v[82:83], v[82:83], v[14:15] op_sel:[0,1] op_sel_hi:[1,1]
    v_pk_mul_f32 v[76:77], v[76:77], v[14:15] op_sel:[0,0] op_sel_hi:[1,0]
    v_pk_mul_f32 v[78:79], v[78:79], v[14:15] op_sel:[0,0] op_sel_hi:[1,0]
    v_and_b32 v47, 0x0fffffff, v42
    v_mov_b32 v31, v42
    buffer_load_dword v30, v47, s[8:11], 0 offen offset:16
    s_mov_b64 exec, s[6:7]
    v_add_u32 v47, 8, v47
    v_lshrrev_b32 v31, 2, v31
    s_mov_b64 exec, -1
    buffer_load_dwordx2 v[28:29], v47, s[8:11], 0 offen
    v_mov_b32 v44, v43
    s_cmp_gt_u32 s37, 1024
    s_cbranch_scc1 L2_xs25
    s_cmp_lg_u32 s101, 0
    s_cbranch_scc1 L2_xa25
L2_xb25:
    v_lshlrev_b32 v89, 16, v96
    v_add_u32 v90, 60, v97
    v_bitop3_b32 v90, v89, v45, v90 bitop3:0x6a
    ds_write_b32 v98, v90 offset:12
    v_lshlrev_b32 v89, 20, v96
    v_add_u32 v90, 40, v97
    v_bitop3_b32 v90, v89, v45, v90 bitop3:0x6a
    ds_write_b32 v98, v90 offset:8
    v_lshlrev_b32 v89, 24, v96
    v_add_u32 v90, 20, v97
    v_bitop3_b32 v90, v89, v45, v90 bitop3:0x6a
    ds_write_b32 v98, v90 offset:4
    v_lshlrev_b32 v89, 28, v96
    v_bitop3_b32 v90, v89, v45, v97 bitop3:0x6a
    ds_write_b32 v98, v90 offset:0
    v_mov_b32_dpp v91, v64 quad_perm:[1,1,1,1] row_mask:0xf bank_mask:0xf
    v_and_b32 v89, 3, v91
    v_and_b32 v97, 0xfffc, v91
    v_sub_u16_dpp v88, v64, v91 quad_perm:[3,3,3,3] row_mask:0xf bank_mask:0xf
    v_mad_u32_u24 v97, v97, 5, v4
    v_add_u32 v99, v88, v89
    v_bfm_b32 v96, v88, v89
    v_cmp_lt_u32 s[58:59], 16, v99
    v_lshlrev_b32 v89, v1, v96
    v_and_b32 v89, v45, v89
    v_cmp_ne_u32 vcc, 0, v89
    v_xor_b32 v90, v97, v89
    s_add_u32 s3, s37, s38
    v_mbcnt_lo_u32_b32 v98, vcc_lo, 0
    v_mbcnt_hi_u32_b32 v98, vcc_hi, v98
    s_bcnt1_i32_b64 s41, vcc
    v_lshl_add_u32 v98, v98, 2, s3
    s_lshl2_add_u32 s37, s41, s37
    s_mov_b64 exec, vcc
    ds_write_b32 v98, v90
    s_mov_b64 exec, -1
    s_cmp_lg_u64 s[58:59], 0
    s_cbranch_scc1 L2_xe25
L2_xr25:
    v_add_u32 v98, s37, v0
    v_mov_b32 v90, -1
    ds_write_b32 v98, v90
    v_add_u32 v98, s38, v0
    ds_read2st64_b32 v[40:41], v0 offset0:0 offset1:1
    ds_read_b32 v43, v0 offset:512
    v_lshrrev_b32 v98, 1, v98
    v_and_b32 v98, -4, v98
    ds_read_b32 v42, v98 offset:768
    s_sub_u32 s3, s37, 768
    s_cmp_gt_u32 s3, 128
    s_cbranch_scc1 L2_xf25
L2_xg25:
    s_setprio 2
    s_waitcnt lgkmcnt(12)
    v_cmp_ne_u64 s[50:51], v[72:73], v[68:69]
    v_cmpx_ne_u64 s[54:55], v[74:75], v[70:71]
    s_and_b64 s[82:83], s[54:55], s[80:81]
    s_cbranch_scc1 L2_c26
L2_d26:
    v_mov_b64 v[84:85], v[70:71]
    v_mov_b32 v7, v93
    v_mov_b64 v[86:87], v[74:75]
    s_or_b64 s[80:81], s[80:81], s[54:55]
    s_mov_b64 exec, s[50:51]
    s_and_b64 s[82:83], s[50:51], s[80:81]
    s_cbranch_scc1 L2_c27
L2_d27:
    v_mov_b64 v[84:85], v[68:69]
    v_mov_b32 v7, v92
    v_mov_b64 v[86:87], v[72:73]
    s_mov_b64 exec, -1
    s_or_b64 s[80:81], s[80:81], s[50:51]
    ds_read_b64 v[70:71], v95 offset:65408
    ds_read_b64 v[68:69], v94 offset:65408
    v_and_b32 v46, 0x40000000, v39
    v_bitop3_b32 v92, v36, v5, v46 bitop3:0xea
    v_and_b32 v46, 0x80000000, v39
    v_bitop3_b32 v93, v37, v5, v46 bitop3:0xea
    v_perm_b32 v15, v37, v38, s47
    v_bitop3_b32 v46, v37, 0.5, -0.5 bitop3:0xa8
    v_perm_b32 v14, v36, v38, s46
    v_bitop3_b32 v47, v36, 0.5, -0.5 bitop3:0xa8
    v_bitop3_b32 v15, v6, v15, v46 bitop3:0xca
    v_bitop3_b32 v14, v6, v14, v47 bitop3:0xca
    s_setprio 1
    s_waitcnt lgkmcnt(1)
    v_mfma_f32_4x4x4_16b_bf16 v[80:83], v[10:11], v[70:71], v[80:83]
    s_waitcnt lgkmcnt(0)
    v_mfma_f32_4x4x4_16b_bf16 v[76:79], v[10:11], v[68:69], v[76:79]
    s_nop 2
    v_cvt_pk_bf16_f32 v80, v80, v81
    v_cvt_pk_bf16_f32 v81, v82, v83
    ds_wrxchg_rtn_b64 v[74:75], v95, v[80:81] offset:65408
    v_cvt_pk_bf16_f32 v76, v76, v77
    v_cvt_pk_bf16_f32 v77, v78, v79
    ds_wrxchg_rtn_b64 v[72:73], v94, v[76:77] offset:65408
    v_and_b32 v88, 0x0fffffff, v44
    v_mov_b32 v39, v44
    buffer_load_dwordx2 v[34:35], v88, s[8:11], 0 offen
    buffer_load_dwordx3 v[36:38], v88, s[8:11], 0 offen offset:8
    s_setprio 0
    s_waitcnt vmcnt(11)
    v_subrev_u32 v88, s100, v3
    ds_write_b128 v88, v[108:111] offset:0
    s_waitcnt vmcnt(11)
    v_subrev_u32 v88, s100, v3
    ds_write_b128 v88, v[112:115] offset:1024
    v_mfma_f32_4x4x4_16b_bf16 v[80:83], v[8:9], v[102:103], 0
    v_mfma_f32_4x4x4_16b_bf16 v[76:79], v[8:9], v[100:101], 0
    v_cmp_lt_u32 s[84:85], v5, v92
    s_nop 2
    v_pk_mul_f32 v[80:81], v[80:81], v[14:15] op_sel:[0,1] op_sel_hi:[1,1]
    v_pk_mul_f32 v[82:83], v[82:83], v[14:15] op_sel:[0,1] op_sel_hi:[1,1]
    v_pk_mul_f32 v[76:77], v[76:77], v[14:15] op_sel:[0,0] op_sel_hi:[1,0]
    v_pk_mul_f32 v[78:79], v[78:79], v[14:15] op_sel:[0,0] op_sel_hi:[1,0]
    s_add_u32 s42, s42, 1
    s_waitcnt lgkmcnt(0)
    s_add_u32 s24, s30, 0xec45000
    s_addc_u32 s25, s31, 0
    s_mov_b32 s26, 0x100
    s_mov_b32 s27, 0x20000
    s_barrier
    s_bitcmp1_b32 s36, s42
    s_cbranch_scc1 L2_slow
L2_ret1:
    s_setprio 3
    s_bitcmp1_b32 s43, s42
    s_cbranch_scc1 L2_oa28
L2_ob28:
    s_waitcnt vmcnt(9)
    v_and_b32 v46, 0x20000000, v21
    v_lshrrev_b32 v47, 14, v17
    v_bitop3_b32 v47, v47, v5, v46 bitop3:0xea
    ds_read_b64 v[106:107], v47
    v_and_b32 v99, 0x10000000, v21
    v_lshrrev_b32 v47, 14, v16
    v_bitop3_b32 v47, v47, v5, v99 bitop3:0xea
    ds_read_b64 v[104:105], v47
    v_cmp_ne_u64 s[50:51], v[72:73], v[68:69]
    v_cmpx_ne_u64 s[54:55], v[74:75], v[70:71]
    s_and_b64 s[82:83], s[54:55], s[80:81]
    s_cbranch_scc1 L2_c29
L2_d29:
    v_mov_b64 v[84:85], v[70:71]
    v_mov_b32 v7, v95
    v_mov_b64 v[86:87], v[74:75]
    s_or_b64 s[80:81], s[80:81], s[54:55]
    s_mov_b64 exec, s[50:51]
    s_and_b64 s[82:83], s[50:51], s[80:81]
    s_cbranch_scc1 L2_c30
L2_d30:
    v_mov_b64 v[84:85], v[68:69]
    v_mov_b32 v7, v94
    v_mov_b64 v[86:87], v[72:73]
    s_mov_b64 exec, -1
    s_or_b64 s[80:81], s[80:81], s[50:51]
    s_and_b64 exec, s[84:85], s[80:81]
    v_mfma_f32_4x4x4_16b_bf16 v[76:79], v[12:13], v[84:85], 0
    v_mov_b32 v92, v7
    s_andn2_b64 s[80:81], s[80:81], s[84:85]
    v_mfma_f32_4x4x4_16b_bf16 v[76:79], v[10:11], v[86:87], v[76:79]
    s_mov_b64 exec, -1
    ds_read_b64 v[70:71], v93 offset:65408
    ds_read_b64 v[68:69], v92 offset:65408
    v_bitop3_b32 v94, v16, v5, v99 bitop3:0xea
    v_bitop3_b32 v95, v17, v5, v46 bitop3:0xea
    v_perm_b32 v15, v17, v20, s45
    v_bitop3_b32 v46, v17, 0.5, -0.5 bitop3:0xa8
    v_perm_b32 v14, v16, v20, s44
    v_bitop3_b32 v47, v16, 0.5, -0.5 bitop3:0xa8
    v_bitop3_b32 v15, v6, v15, v46 bitop3:0xca
    v_bitop3_b32 v14, v6, v14, v47 bitop3:0xca
    s_waitcnt lgkmcnt(1)
    v_mfma_f32_4x4x4_16b_bf16 v[80:83], v[10:11], v[70:71], v[80:83]
    s_waitcnt lgkmcnt(0)
    v_mfma_f32_4x4x4_16b_bf16 v[76:79], v[10:11], v[68:69], v[76:79]
    s_nop 2
    v_cvt_pk_bf16_f32 v80, v80, v81
    v_cvt_pk_bf16_f32 v81, v82, v83
    ds_wrxchg_rtn_b64 v[74:75], v93, v[80:81] offset:65408
    v_cvt_pk_bf16_f32 v76, v76, v77
    v_cvt_pk_bf16_f32 v77, v78, v79
    ds_wrxchg_rtn_b64 v[72:73], v92, v[76:77] offset:65408
    v_mfma_f32_4x4x4_16b_bf16 v[80:83], v[8:9], v[106:107], 0
    v_mfma_f32_4x4x4_16b_bf16 v[76:79], v[8:9], v[104:105], 0
    v_cmp_lt_u32 s[84:85], v5, v94
    s_nop 2
    v_pk_mul_f32 v[80:81], v[80:81], v[14:15] op_sel:[0,1] op_sel_hi:[1,1]
    v_pk_mul_f32 v[82:83], v[82:83], v[14:15] op_sel:[0,1] op_sel_hi:[1,1]
    v_pk_mul_f32 v[76:77], v[76:77], v[14:15] op_sel:[0,0] op_sel_hi:[1,0]
    v_pk_mul_f32 v[78:79], v[78:79], v[14:15] op_sel:[0,0] op_sel_hi:[1,0]
    buffer_load_dwordx4 v[108:111], v3, s[16:19], s40 offen offset:0 sc1
    v_and_b32 v46, 0x80000000, v21
    v_lshrrev_b32 v47, 14, v19
    v_bitop3_b32 v47, v47, v5, v46 bitop3:0xea
    ds_read_b64 v[102:103], v47
    v_and_b32 v99, 0x40000000, v21
    v_lshrrev_b32 v47, 14, v18
    v_bitop3_b32 v47, v47, v5, v99 bitop3:0xea
    ds_read_b64 v[100:101], v47
    s_waitcnt lgkmcnt(2)
    v_cmp_ne_u64 s[50:51], v[72:73], v[68:69]
    v_cmpx_ne_u64 s[54:55], v[74:75], v[70:71]
    s_and_b64 s[82:83], s[54:55], s[80:81]
    s_cbranch_scc1 L2_c31
L2_d31:
    v_mov_b64 v[84:85], v[70:71]
    v_mov_b32 v7, v93
    v_mov_b64 v[86:87], v[74:75]
    s_or_b64 s[80:81], s[80:81], s[54:55]
    s_mov_b64 exec, s[50:51]
    s_and_b64 s[82:83], s[50:51], s[80:81]
    s_cbranch_scc1 L2_c32
L2_d32:
    v_mov_b64 v[84:85], v[68:69]
    v_mov_b32 v7, v92
    v_mov_b64 v[86:87], v[72:73]
    s_mov_b64 exec, -1
    s_or_b64 s[80:81], s[80:81], s[50:51]
    s_and_b64 exec, s[84:85], s[80:81]
    v_mfma_f32_4x4x4_16b_bf16 v[76:79], v[12:13], v[84:85], 0
    v_mov_b32 v94, v7
    s_andn2_b64 s[80:81], s[80:81], s[84:85]
    v_mfma_f32_4x4x4_16b_bf16 v[76:79], v[10:11], v[86:87], v[76:79]
    s_mov_b64 exec, -1
    ds_read_b64 v[70:71], v95 offset:65408
    ds_read_b64 v[68:69], v94 offset:65408
    v_bitop3_b32 v92, v18, v5, v99 bitop3:0xea
    v_bitop3_b32 v93, v19, v5, v46 bitop3:0xea
    v_perm_b32 v15, v19, v20, s47
    v_bitop3_b32 v46, v19, 0.5, -0.5 bitop3:0xa8
    v_perm_b32 v14, v18, v20, s46
    v_bitop3_b32 v47, v18, 0.5, -0.5 bitop3:0xa8
    v_bitop3_b32 v15, v6, v15, v46 bitop3:0xca
    v_bitop3_b32 v14, v6, v14, v47 bitop3:0xca
    s_waitcnt lgkmcnt(1)
    v_mfma_f32_4x4x4_16b_bf16 v[80:83], v[10:11], v[70:71], v[80:83]
    s_waitcnt lgkmcnt(0)
    v_mfma_f32_4x4x4_16b_bf16 v[76:79], v[10:11], v[68:69], v[76:79]
    s_nop 2
    v_cvt_pk_bf16_f32 v80, v80, v81
    v_cvt_pk_bf16_f32 v81, v82, v83
    ds_wrxchg_rtn_b64 v[74:75], v95, v[80:81] offset:65408
    v_cvt_pk_bf16_f32 v76, v76, v77
    v_cvt_pk_bf16_f32 v77, v78, v79
    ds_wrxchg_rtn_b64 v[72:73], v94, v[76:77] offset:65408
    v_and_b32 v88, 0x0fffffff, v40
    v_mov_b32 v21, v40
    buffer_load_dwordx2 v[16:17], v88, s[8:11], 0 offen
    buffer_load_dwordx3 v[18:20], v88, s[8:11], 0 offen offset:8
    s_setprio 2
    v_mfma_f32_4x4x4_16b_bf16 v[80:83], v[8:9], v[102:103], 0
    v_mfma_f32_4x4x4_16b_bf16 v[76:79], v[8:9], v[100:101], 0
    v_cmp_lt_u32 s[48:49], v5, v93
    s_nop 2
    v_pk_mul_f32 v[80:81], v[80:81], v[14:15] op_sel:[0,1] op_sel_hi:[1,1]
    v_pk_mul_f32 v[82:83], v[82:83], v[14:15] op_sel:[0,1] op_sel_hi:[1,1]
    v_pk_mul_f32 v[76:77], v[76:77], v[14:15] op_sel:[0,0] op_sel_hi:[1,0]
    v_pk_mul_f32 v[78:79], v[78:79], v[14:15] op_sel:[0,0] op_sel_hi:[1,0]
    s_waitcnt vmcnt(10)
    v_and_b32 v46, 0x20000000, v27
    v_lshrrev_b32 v47, 14, v23
    v_bitop3_b32 v47, v47, v5, v46 bitop3:0xea
    ds_read_b64 v[106:107], v47
    v_and_b32 v99, 0x10000000, v27
    v_lshrrev_b32 v47, 14, v22
    v_bitop3_b32 v47, v47, v5, v99 bitop3:0xea
    ds_read_b64 v[104:105], v47
    s_waitcnt lgkmcnt(2)
    v_cmp_ne_u64 s[50:51], v[72:73], v[68:69]
    v_cmpx_ne_u64 s[54:55], v[74:75], v[70:71]
    s_and_b64 s[82:83], s[54:55], s[80:81]
    s_cbranch_scc1 L2_c33
L2_d33:
    v_mov_b64 v[84:85], v[70:71]
    v_mov_b32 v7, v95
    v_mov_b64 v[86:87], v[74:75]
    s_or_b64 s[80:81], s[80:81], s[54:55]
    s_mov_b64 exec, s[50:51]
    s_and_b64 s[82:83], s[50:51], s[80:81]
    s_cbranch_scc1 L2_c34
L2_d34:
    v_mov_b64 v[84:85], v[68:69]
    v_mov_b32 v7, v94
    v_mov_b64 v[86:87], v[72:73]
    s_mov_b64 exec, -1
    s_or_b64 s[80:81], s[80:81], s[50:51]
    s_and_b64 exec, s[48:49], s[80:81]
    v_mfma_f32_4x4x4_16b_bf16 v[80:83], v[12:13], v[84:85], 0
    v_mov_b32 v93, v7
    s_andn2_b64 s[80:81], s[80:81], s[48:49]
    v_mfma_f32_4x4x4_16b_bf16 v[80:83], v[10:11], v[86:87], v[80:83]
    s_mov_b64 exec, -1
    ds_read_b64 v[70:71], v93 offset:65408
    ds_read_b64 v[68:69], v92 offset:65408
    v_bitop3_b32 v94, v22, v5, v99 bitop3:0xea
    v_bitop3_b32 v95, v23, v5, v46 bitop3:0xea
    v_perm_b32 v15, v23, v26, s45
    v_bitop3_b32 v46, v23, 0.5, -0.5 bitop3:0xa8
    v_perm_b32 v14, v22, v26, s44
    v_bitop3_b32 v47, v22, 0.5, -0.5 bitop3:0xa8
    v_bitop3_b32 v15, v6, v15, v46 bitop3:0xca
    v_bitop3_b32 v14, v6, v14, v47 bitop3:0xca
    s_waitcnt lgkmcnt(1)
    v_mfma_f32_4x4x4_16b_bf16 v[80:83], v[10:11], v[70:71], v[80:83]
    s_waitcnt lgkmcnt(0)
    v_mfma_f32_4x4x4_16b_bf16 v[76:79], v[10:11], v[68:69], v[76:79]
    s_nop 2
    v_cvt_pk_bf16_f32 v80, v80, v81
    v_cvt_pk_bf16_f32 v81, v82, v83
    ds_wrxchg_rtn_b64 v[74:75], v93, v[80:81] offset:65408
    v_cvt_pk_bf16_f32 v76, v76, v77
    v_cvt_pk_bf16_f32 v77, v78, v79
    ds_wrxchg_rtn_b64 v[72:73], v92, v[76:77] offset:65408
    s_setprio 1
    v_mfma_f32_4x4x4_16b_bf16 v[80:83], v[8:9], v[106:107], 0
    v_mfma_f32_4x4x4_16b_bf16 v[76:79], v[8:9], v[104:105], 0
    s_nop 3
    v_pk_mul_f32 v[80:81], v[80:81], v[14:15] op_sel:[0,1] op_sel_hi:[1,1]
    v_pk_mul_f32 v[82:83], v[82:83], v[14:15] op_sel:[0,1] op_sel_hi:[1,1]
    v_pk_mul_f32 v[76:77], v[76:77], v[14:15] op_sel:[0,0] op_sel_hi:[1,0]
    v_pk_mul_f32 v[78:79], v[78:79], v[14:15] op_sel:[0,0] op_sel_hi:[1,0]
    s_bitcmp1_b32 s43, s42
    s_cbranch_scc1 L2_oa35
L2_ob35:
    buffer_load_dwordx4 v[112:115], v3, s[16:19], s40 offen offset:1024 sc1
    v_sub_u16 v88, v62, v54
    v_and_b32 v89, 3, v54
    v_add3_u32 v99, v88, v89, 3
    v_and_b32 v99, -4, v99
    v_max_u32 v99, 4, v99
    v_and_b32 v97, 0xfffc, v54
    v_bfm_b32 v96, v88, v89
    v_add_u32_dpp v91, v99, v99 row_shr:1 row_mask:0xf bank_mask:0xf bound_ctrl:1
    v_mad_u32_u24 v97, v97, 5, v2
    v_cmp_lt_u32 vcc, 16, v99
    v_add_u32_dpp v91, v91, v91 row_shr:2 row_mask:0xf bank_mask:0xf bound_ctrl:1
    v_sub_u32 v98, s38, v99
    v_lshrrev_b64 v[54:55], 16, v[54:55]
    v_add_u32_dpp v91, v91, v91 row_shr:4 row_mask:0xf bank_mask:0xf bound_ctrl:1
    v_lshrrev_b64 v[62:63], 16, v[62:63]
    s_mov_b32 s101, 0
    v_add_u32_dpp v91, v91, v91 row_shr:8 row_mask:0xf bank_mask:0xf bound_ctrl:1
    s_nop 1
    v_add_u32_dpp v91, v91, v91 row_bcast:15 row_mask:0xa bank_mask:0xf
    s_nop 1
    v_add_u32_dpp v91, v91, v91 row_bcast:31 row_mask:0xc bank_mask:0xf
    v_add_u32 v98, v98, v91
    v_readlane_b32 s37, v91, 63
    s_cbranch_vccnz L2_xo36
L2_xp36:
    v_and_b32 v46, 0x80000000, v27
    v_lshrrev_b32 v47, 14, v25
    v_bitop3_b32 v47, v47, v5, v46 bitop3:0xea
    ds_read_b64 v[102:103], v47
    v_and_b32 v99, 0x40000000, v27
    v_lshrrev_b32 v47, 14, v24
    v_bitop3_b32 v47, v47, v5, v99 bitop3:0xea
    ds_read_b64 v[100:101], v47
    s_waitcnt lgkmcnt(2)
    v_cmp_ne_u64 s[50:51], v[72:73], v[68:69]
    v_cmpx_ne_u64 s[54:55], v[74:75], v[70:71]
    s_and_b64 s[82:83], s[54:55], s[80:81]
    s_cbranch_scc1 L2_c37
L2_d37:
    v_mov_b64 v[84:85], v[70:71]
    v_mov_b32 v7, v93
    v_mov_b64 v[86:87], v[74:75]
    s_or_b64 s[80:81], s[80:81], s[54:55]
    s_mov_b64 exec, s[50:51]
    s_and_b64 s[82:83], s[50:51], s[80:81]
    s_cbranch_scc1 L2_c38
L2_d38:
    v_mov_b64 v[84:85], v[68:69]
    v_mov_b32 v7, v92
    v_mov_b64 v[86:87], v[72:73]
    s_mov_b64 exec, -1
    s_or_b64 s[80:81], s[80:81], s[50:51]
    ds_read_b64 v[70:71], v95 offset:65408
    ds_read_b64 v[68:69], v94 offset:65408
    v_bitop3_b32 v92, v24, v5, v99 bitop3:0xea
    v_bitop3_b32 v93, v25, v5, v46 bitop3:0xea
    v_perm_b32 v15, v25, v26, s47
    v_bitop3_b32 v46, v25, 0.5, -0.5 bitop3:0xa8
    v_perm_b32 v14, v24, v26, s46
    v_bitop3_b32 v47, v24, 0.5, -0.5 bitop3:0xa8
    v_bitop3_b32 v15, v6, v15, v46 bitop3:0xca
    v_bitop3_b32 v14, v6, v14, v47 bitop3:0xca
    s_waitcnt lgkmcnt(1)
    v_mfma_f32_4x4x4_16b_bf16 v[80:83], v[10:11], v[70:71], v[80:83]
    s_waitcnt lgkmcnt(0)
    v_mfma_f32_4x4x4_16b_bf16 v[76:79], v[10:11], v[68:69], v[76:79]
    s_nop 2
    v_cvt_pk_bf16_f32 v80, v80, v81
    v_cvt_pk_bf16_f32 v81, v82, v83
    ds_wrxchg_rtn_b64 v[74:75], v95, v[80:81] offset:65408
    v_cvt_pk_bf16_f32 v76, v76, v77
    v_cvt_pk_bf16_f32 v77, v78, v79
    ds_wrxchg_rtn_b64 v[72:73], v94, v[76:77] offset:65408
    v_and_b32 v88, 0x0fffffff, v41
    v_mov_b32 v27, v41
    buffer_load_dwordx2 v[22:23], v88, s[8:11], 0 offen
    buffer_load_dwordx3 v[24:26], v88, s[8:11], 0 offen offset:8
    v_mfma_f32_4x4x4_16b_bf16 v[80:83], v[8:9], v[102:103], 0
    v_mfma_f32_4x4x4_16b_bf16 v[76:79], v[8:9], v[100:101], 0
    v_cmp_lt_u32 s[84:85], v5, v92
    s_nop 2
    v_pk_mul_f32 v[80:81], v[80:81], v[14:15] op_sel:[0,1] op_sel_hi:[1,1]
    v_pk_mul_f32 v[82:83], v[82:83], v[14:15] op_sel:[0,1] op_sel_hi:[1,1]
    v_pk_mul_f32 v[76:77], v[76:77], v[14:15] op_sel:[0,0] op_sel_hi:[1,0]
    v_pk_mul_f32 v[78:79], v[78:79], v[14:15] op_sel:[0,0] op_sel_hi:[1,0]
    s_waitcnt vmcnt(8)
    s_mov_b64 exec, s[6:7]
    v_lshrrev_b32 v30, 16, v30
    s_mov_b64 exec, -1
    v_and_b32 v46, 0x20000000, v31
    v_lshrrev_b32 v47, 14, v29
    v_bitop3_b32 v47, v47, v5, v46 bitop3:0xea
    ds_read_b64 v[106:107], v47
    v_and_b32 v99, 0x10000000, v31
    v_lshrrev_b32 v47, 14, v28
    v_bitop3_b32 v47, v47, v5, v99 bitop3:0xea
    ds_read_b64 v[104:105], v47
    s_waitcnt lgkmcnt(2)
    v_cmp_ne_u64 s[50:51], v[72:73], v[68:69]
    v_cmpx_ne_u64 s[54:55], v[74:75], v[70:71]
    s_and_b64 s[82:83], s[54:55], s[80:81]
    s_cbranch_scc1 L2_c39
L2_d39:
    v_mov_b64 v[84:85], v[70:71]
    v_mov_b32 v7, v95
    v_mov_b64 v[86:87], v[74:75]
    s_or_b64 s[80:81], s[80:81], s[54:55]
    s_mov_b64 exec, s[50:51]
    s_and_b64 s[82:83], s[50:51], s[80:81]
    s_cbranch_scc1 L2_c40
L2_d40:
    v_mov_b64 v[84:85], v[68:69]
    v_mov_b32 v7, v94
    v_mov_b64 v[86:87], v[72:73]
    s_mov_b64 exec, -1
    s_or_b64 s[80:81], s[80:81], s[50:51]
    s_and_b64 exec, s[84:85], s[80:81]
    v_mfma_f32_4x4x4_16b_bf16 v[76:79], v[12:13], v[84:85], 0
    v_mov_b32 v92, v7
    s_andn2_b64 s[80:81], s[80:81], s[84:85]
    v_mfma_f32_4x4x4_16b_bf16 v[76:79], v[10:11], v[86:87], v[76:79]
    s_mov_b64 exec, -1
    ds_read_b64 v[70:71], v93 offset:65408
    ds_read_b64 v[68:69], v92 offset:65408
    v_bitop3_b32 v94, v28, v5, v99 bitop3:0xea
    v_bitop3_b32 v95, v29, v5, v46 bitop3:0xea
    v_perm_b32 v15, v29, v30, s45
    v_bitop3_b32 v46, v29, 0.5, -0.5 bitop3:0xa8
    v_perm_b32 v14, v28, v30, s44
    v_bitop3_b32 v47, v28, 0.5, -0.5 bitop3:0xa8
    v_bitop3_b32 v15, v6, v15, v46 bitop3:0xca
    v_bitop3_b32 v14, v6, v14, v47 bitop3:0xca
    s_waitcnt lgkmcnt(1)
    v_mfma_f32_4x4x4_16b_bf16 v[80:83], v[10:11], v[70:71], v[80:83]
    s_waitcnt lgkmcnt(0)
    v_mfma_f32_4x4x4_16b_bf16 v[76:79], v[10:11], v[68:69], v[76:79]
    s_nop 2
    v_cvt_pk_bf16_f32 v80, v80, v81
    v_cvt_pk_bf16_f32 v81, v82, v83
    ds_wrxchg_rtn_b64 v[74:75], v93, v[80:81] offset:65408
    v_cvt_pk_bf16_f32 v76, v76, v77
    v_cvt_pk_bf16_f32 v77, v78, v79
    ds_wrxchg_rtn_b64 v[72:73], v92, v[76:77] offset:65408
    s_setprio 0
    v_mfma_f32_4x4x4_16b_bf16 v[80:83], v[8:9], v[106:107], 0
    v_mfma_f32_4x4x4_16b_bf16 v[76:79], v[8:9], v[104:105], 0
    v_cmp_lt_u32 s[48:49], v5, v95
    s_nop 2
    v_pk_mul_f32 v[80:81], v[80:81], v[14:15] op_sel:[0,1] op_sel_hi:[1,1]
    v_pk_mul_f32 v[82:83], v[82:83], v[14:15] op_sel:[0,1] op_sel_hi:[1,1]
    v_pk_mul_f32 v[76:77], v[76:77], v[14:15] op_sel:[0,0] op_sel_hi:[1,0]
    v_pk_mul_f32 v[78:79], v[78:79], v[14:15] op_sel:[0,0] op_sel_hi:[1,0]
    s_add_u32 s40, s40, 0x50000
    v_and_b32 v47, 0x0fffffff, v42
    v_mov_b32 v31, v42
    buffer_load_dword v30, v47, s[8:11], 0 offen offset:16
    s_mov_b64 exec, s[6:7]
    v_add_u32 v47, 8, v47
    v_lshrrev_b32 v31, 2, v31
    s_mov_b64 exec, -1
    buffer_load_dwordx2 v[28:29], v47, s[8:11], 0 offen
    s_waitcnt vmcnt(8)
    v_and_b32 v46, 0x80000000, v39
    v_lshrrev_b32 v47, 14, v37
    v_bitop3_b32 v47, v47, v5, v46 bitop3:0xea
    ds_read_b64 v[106:107], v47
    v_and_b32 v99, 0x40000000, v39
    v_lshrrev_b32 v47, 14, v36
    v_bitop3_b32 v47, v47, v5, v99 bitop3:0xea
    ds_read_b64 v[104:105], v47
    v_and_b32 v46, 0x20000000, v39
    v_lshrrev_b32 v47, 14, v35
    v_bitop3_b32 v47, v47, v5, v46 bitop3:0xea
    ds_read_b64 v[102:103], v47
    v_and_b32 v99, 0x10000000, v39
    v_lshrrev_b32 v47, 14, v34
    v_bitop3_b32 v47, v47, v5, v99 bitop3:0xea
    ds_read_b64 v[100:101], v47
    s_waitcnt lgkmcnt(4)
    v_cmp_ne_u64 s[50:51], v[72:73], v[68:69]
    v_cmpx_ne_u64 s[54:55], v[74:75], v[70:71]
    s_and_b64 s[82:83], s[54:55], s[80:81]
    s_cbranch_scc1 L2_c41
L2_d41:
    v_mov_b64 v[84:85], v[70:71]
    v_mov_b32 v7, v93
    v_mov_b64 v[86:87], v[74:75]
    s_or_b64 s[80:81], s[80:81], s[54:55]
    s_mov_b64 exec, s[50:51]
    s_and_b64 s[82:83], s[50:51], s[80:81]
    s_cbranch_scc1 L2_c42
L2_d42:
    v_mov_b64 v[84:85], v[68:69]
    v_mov_b32 v7, v92
    v_mov_b64 v[86:87], v[72:73]
    s_mov_b64 exec, -1
    s_or_b64 s[80:81], s[80:81], s[50:51]
    s_and_b64 exec, s[48:49], s[80:81]
    v_mfma_f32_4x4x4_16b_bf16 v[80:83], v[12:13], v[84:85], 0
    v_mov_b32 v95, v7
    s_andn2_b64 s[80:81], s[80:81], s[48:49]
    v_mfma_f32_4x4x4_16b_bf16 v[80:83], v[10:11], v[86:87], v[80:83]
    s_mov_b64 exec, -1
    ds_read_b64 v[70:71], v95 offset:65408
    ds_read_b64 v[68:69], v94 offset:65408
    v_bitop3_b32 v92, v34, v5, v99 bitop3:0xea
    v_bitop3_b32 v93, v35, v5, v46 bitop3:0xea
    v_perm_b32 v15, v35, v38, s45
    v_bitop3_b32 v46, v35, 0.5, -0.5 bitop3:0xa8
    v_perm_b32 v14, v34, v38, s44
    v_bitop3_b32 v47, v34, 0.5, -0.5 bitop3:0xa8
    v_bitop3_b32 v15, v6, v15, v46 bitop3:0xca
    v_bitop3_b32 v14, v6, v14, v47 bitop3:0xca
    s_waitcnt lgkmcnt(1)
    v_mfma_f32_4x4x4_16b_bf16 v[80:83], v[10:11], v[70:71], v[80:83]
    s_waitcnt lgkmcnt(0)
    v_mfma_f32_4x4x4_16b_bf16 v[76:79], v[10:11], v[68:69], v[76:79]
    s_nop 2
    v_cvt_pk_bf16_f32 v80, v80, v81
    v_cvt_pk_bf16_f32 v81, v82, v83
    ds_wrxchg_rtn_b64 v[74:75], v95, v[80:81] offset:65408
    v_cvt_pk_bf16_f32 v76, v76, v77
    v_cvt_pk_bf16_f32 v77, v78, v79
    ds_wrxchg_rtn_b64 v[72:73], v94, v[76:77] offset:65408
    s_barrier
    s_setprio 3
    s_mov_b32 m0, s100
    s_nop 0
    ds_write_addtid_b32 v124 offset:34816
    ds_write_addtid_b32 v125 offset:35072
    ds_write_addtid_b32 v126 offset:35328
    ds_write_addtid_b32 v127 offset:35584
    s_add_u32 s3, s40, 4096
    buffer_load_dwordx4 v[124:127], v3, s[16:19], s3 offen sc1
    ds_write_addtid_b32 v116 offset:32768
    ds_write_addtid_b32 v117 offset:33024
    ds_write_addtid_b32 v118 offset:33280
    ds_write_addtid_b32 v119 offset:33536
    buffer_load_dwordx4 v[116:119], v3, s[16:19], s40 offen offset:2048 sc1
    ds_write_addtid_b32 v120 offset:33792
    ds_write_addtid_b32 v121 offset:34048
    ds_write_addtid_b32 v122 offset:34304
    ds_write_addtid_b32 v123 offset:34560
    buffer_load_dwordx4 v[120:123], v3, s[16:19], s40 offen offset:3072 sc1
    v_mfma_f32_4x4x4_16b_bf16 v[80:83], v[8:9], v[102:103], 0
    v_mfma_f32_4x4x4_16b_bf16 v[76:79], v[8:9], v[100:101], 0
    s_nop 3
    v_pk_mul_f32 v[80:81], v[80:81], v[14:15] op_sel:[0,1] op_sel_hi:[1,1]
    v_pk_mul_f32 v[82:83], v[82:83], v[14:15] op_sel:[0,1] op_sel_hi:[1,1]
    v_pk_mul_f32 v[76:77], v[76:77], v[14:15] op_sel:[0,0] op_sel_hi:[1,0]
    v_pk_mul_f32 v[78:79], v[78:79], v[14:15] op_sel:[0,0] op_sel_hi:[1,0]
    v_mov_b32 v44, v43
    s_cmp_gt_u32 s37, 1024
    s_cbranch_scc1 L2_xs43
    s_cmp_lg_u32 s101, 0
    s_cbranch_scc1 L2_xa43
L2_xb43:
    v_lshlrev_b32 v89, 16, v96
    v_add_u32 v90, 60, v97
    v_bitop3_b32 v90, v89, v45, v90 bitop3:0x6a
    ds_write_b32 v98, v90 offset:12
    v_lshlrev_b32 v89, 20, v96
    v_add_u32 v90, 40, v97
    v_bitop3_b32 v90, v89, v45, v90 bitop3:0x6a
    ds_write_b32 v98, v90 offset:8
    v_lshlrev_b32 v89, 24, v96
    v_add_u32 v90, 20, v97
    v_bitop3_b32 v90, v89, v45, v90 bitop3:0x6a
    ds_write_b32 v98, v90 offset:4
    v_lshlrev_b32 v89, 28, v96
    v_bitop3_b32 v90, v89, v45, v97 bitop3:0x6a
    ds_write_b32 v98, v90 offset:0
    v_mov_b32_dpp v91, v66 quad_perm:[1,1,1,1] row_mask:0xf bank_mask:0xf
    v_and_b32 v89, 3, v91
    v_and_b32 v97, 0xfffc, v91
    v_sub_u16_dpp v88, v66, v91 quad_perm:[3,3,3,3] row_mask:0xf bank_mask:0xf
    v_mad_u32_u24 v97, v97, 5, v4
    v_add_u32 v99, v88, v89
    v_bfm_b32 v96, v88, v89
    v_cmp_lt_u32 s[58:59], 16, v99
    v_lshlrev_b32 v89, v1, v96
    v_and_b32 v89, v45, v89
    v_cmp_ne_u32 vcc, 0, v89
    v_xor_b32 v90, v97, v89
    s_add_u32 s3, s37, s38
    v_mbcnt_lo_u32_b32 v98, vcc_lo, 0
    v_mbcnt_hi_u32_b32 v98, vcc_hi, v98
    s_bcnt1_i32_b64 s41, vcc
    v_lshl_add_u32 v98, v98, 2, s3
    s_lshl2_add_u32 s37, s41, s37
    s_mov_b64 exec, vcc
    ds_write_b32 v98, v90
    s_mov_b64 exec, -1
    s_cmp_lg_u64 s[58:59], 0
    s_cbranch_scc1 L2_xe43
L2_xr43:
    v_add_u32 v98, s37, v0
    v_mov_b32 v90, -1
    ds_write_b32 v98, v90
    v_add_u32 v98, s38, v0
    ds_read2st64_b32 v[40:41], v0 offset0:0 offset1:1
    ds_read_b32 v43, v0 offset:512
    v_lshrrev_b32 v98, 1, v98
    v_and_b32 v98, -4, v98
    ds_read_b32 v42, v98 offset:768
    s_sub_u32 s3, s37, 768
    s_cmp_gt_u32 s3, 128
    s_cbranch_scc1 L2_xf43
L2_xg43:
    v_lshrrev_b64 v[64:65], 16, v[64:65]
    v_lshrrev_b64 v[66:67], 16, v[66:67]
    s_setprio 2
    s_waitcnt lgkmcnt(14)
    v_cmp_ne_u64 s[50:51], v[72:73], v[68:69]
    v_cmpx_ne_u64 s[54:55], v[74:75], v[70:71]
    s_and_b64 s[82:83], s[54:55], s[80:81]
    s_cbranch_scc1 L2_c44
L2_d44:
    v_mov_b64 v[84:85], v[70:71]
    v_mov_b32 v7, v95
    v_mov_b64 v[86:87], v[74:75]
    s_or_b64 s[80:81], s[80:81], s[54:55]
    s_mov_b64 exec, s[50:51]
    s_and_b64 s[82:83], s[50:51], s[80:81]
    s_cbranch_scc1 L2_c45
L2_d45:
    v_mov_b64 v[84:85], v[68:69]
    v_mov_b32 v7, v94
    v_mov_b64 v[86:87], v[72:73]
    s_mov_b64 exec, -1
    s_or_b64 s[80:81], s[80:81], s[50:51]
    ds_read_b64 v[70:71], v93 offset:65408
    ds_read_b64 v[68:69], v92 offset:65408
    v_and_b32 v46, 0x40000000, v39
    v_bitop3_b32 v94, v36, v5, v46 bitop3:0xea
    v_and_b32 v46, 0x80000000, v39
    v_bitop3_b32 v95, v37, v5, v46 bitop3:0xea
    v_perm_b32 v15, v37, v38, s47
    v_bitop3_b32 v46, v37, 0.5, -0.5 bitop3:0xa8
    v_perm_b32 v14, v36, v38, s46
    v_bitop3_b32 v47, v36, 0.5, -0.5 bitop3:0xa8
    v_bitop3_b32 v15, v6, v15, v46 bitop3:0xca
    v_bitop3_b32 v14, v6, v14, v47 bitop3:0xca
    s_setprio 1
    s_waitcnt lgkmcnt(1)
    v_mfma_f32_4x4x4_16b_bf16 v[80:83], v[10:11], v[70:71], v[80:83]
    s_waitcnt lgkmcnt(0)
    v_mfma_f32_4x4x4_16b_bf16 v[76:79], v[10:11], v[68:69], v[76:79]
    s_nop 2
    v_cvt_pk_bf16_f32 v80, v80, v81
    v_cvt_pk_bf16_f32 v81, v82, v83
    ds_wrxchg_rtn_b64 v[74:75], v93, v[80:81] offset:65408
    v_cvt_pk_bf16_f32 v76, v76, v77
    v_cvt_pk_bf16_f32 v77, v78, v79
    ds_wrxchg_rtn_b64 v[72:73], v92, v[76:77] offset:65408
    v_and_b32 v88, 0x0fffffff, v44
    v_mov_b32 v39, v44
    buffer_load_dwordx2 v[34:35], v88, s[8:11], 0 offen
    buffer_load_dwordx3 v[36:38], v88, s[8:11], 0 offen offset:8
    s_setprio 0
    s_waitcnt vmcnt(12)
    s_mov_b32 m0, s38
    s_nop 0
    ds_write_addtid_b32 v108 offset:0
    ds_write_addtid_b32 v109 offset:256
    ds_write_addtid_b32 v110 offset:512
    ds_write_addtid_b32 v111 offset:768
    s_waitcnt vmcnt(9)
    ds_write_addtid_b32 v112 offset:1024
    ds_write_addtid_b32 v113 offset:1280
    ds_write_addtid_b32 v114 offset:1536
    ds_write_addtid_b32 v115 offset:1792
    v_mfma_f32_4x4x4_16b_bf16 v[80:83], v[8:9], v[106:107], 0
    v_mfma_f32_4x4x4_16b_bf16 v[76:79], v[8:9], v[104:105], 0
    v_cmp_lt_u32 s[84:85], v5, v94
    s_nop 2
    v_pk_mul_f32 v[80:81], v[80:81], v[14:15] op_sel:[0,1] op_sel_hi:[1,1]
    v_pk_mul_f32 v[82:83], v[82:83], v[14:15] op_sel:[0,1] op_sel_hi:[1,1]
    v_pk_mul_f32 v[76:77], v[76:77], v[14:15] op_sel:[0,0] op_sel_hi:[1,0]
    v_pk_mul_f32 v[78:79], v[78:79], v[14:15] op_sel:[0,0] op_sel_hi:[1,0]
    s_add_u32 s42, s42, 1
    s_waitcnt lgkmcnt(0)
L2_loop:
    s_barrier
    s_bitcmp1_b32 s36, s42
    s_cbranch_scc1 L2_slow
L2_ret2:
    s_setprio 3
    s_bitcmp1_b32 s43, s42
    s_cbranch_scc1 L2_oa46
L2_ob46:
    v_and_b32 v46, 0x20000000, v21
    v_lshrrev_b32 v47, 14, v17
    v_bitop3_b32 v47, v47, v5, v46 bitop3:0xea
    ds_read_b64 v[102:103], v47
    v_and_b32 v99, 0x10000000, v21
    v_lshrrev_b32 v47, 14, v16
    v_bitop3_b32 v47, v47, v5, v99 bitop3:0xea
    ds_read_b64 v[100:101], v47
    v_cmp_ne_u64 s[50:51], v[72:73], v[68:69]
    v_cmpx_ne_u64 s[54:55], v[74:75], v[70:71]
    s_and_b64 s[82:83], s[54:55], s[80:81]
    s_cbranch_scc1 L2_c47
L2_d47:
    v_mov_b64 v[84:85], v[70:71]
    v_mov_b32 v7, v93
    v_mov_b64 v[86:87], v[74:75]
    s_or_b64 s[80:81], s[80:81], s[54:55]
    s_mov_b64 exec, s[50:51]
    s_and_b64 s[82:83], s[50:51], s[80:81]
    s_cbranch_scc1 L2_c48
L2_d48:
    v_mov_b64 v[84:85], v[68:69]
    v_mov_b32 v7, v92
    v_mov_b64 v[86:87], v[72:73]
    s_mov_b64 exec, -1
    s_or_b64 s[80:81], s[80:81], s[50:51]
    s_and_b64 exec, s[84:85], s[80:81]
    v_mfma_f32_4x4x4_16b_bf16 v[76:79], v[12:13], v[84:85], 0
    v_mov_b32 v94, v7
    s_andn2_b64 s[80:81], s[80:81], s[84:85]
    v_mfma_f32_4x4x4_16b_bf16 v[76:79], v[10:11], v[86:87], v[76:79]
    s_mov_b64 exec, -1
    ds_read_b64 v[70:71], v95 offset:65408
    ds_read_b64 v[68:69], v94 offset:65408
    v_bitop3_b32 v92, v16, v5, v99 bitop3:0xea
    v_bitop3_b32 v93, v17, v5, v46 bitop3:0xea
    v_perm_b32 v15, v17, v20, s45
    v_bitop3_b32 v46, v17, 0.5, -0.5 bitop3:0xa8
    v_perm_b32 v14, v16, v20, s44
    v_bitop3_b32 v47, v16, 0.5, -0.5 bitop3:0xa8
    v_bitop3_b32 v15, v6, v15, v46 bitop3:0xca
    v_bitop3_b32 v14, v6, v14, v47 bitop3:0xca
    s_waitcnt lgkmcnt(1)
    v_mfma_f32_4x4x4_16b_bf16 v[80:83], v[10:11], v[70:71], v[80:83]
    s_waitcnt lgkmcnt(0)
    v_mfma_f32_4x4x4_16b_bf16 v[76:79], v[10:11], v[68:69], v[76:79]
    s_nop 2
    v_cvt_pk_bf16_f32 v80, v80, v81
    v_cvt_pk_bf16_f32 v81, v82, v83
    ds_wrxchg_rtn_b64 v[74:75], v95, v[80:81] offset:65408
    v_cvt_pk_bf16_f32 v76, v76, v77
    v_cvt_pk_bf16_f32 v77, v78, v79
    ds_wrxchg_rtn_b64 v[72:73], v94, v[76:77] offset:65408
    v_mfma_f32_4x4x4_16b_bf16 v[80:83], v[8:9], v[102:103], 0
    v_mfma_f32_4x4x4_16b_bf16 v[76:79], v[8:9], v[100:101], 0
    v_cmp_lt_u32 s[84:85], v5, v92
    s_nop 2
    v_pk_mul_f32 v[80:81], v[80:81], v[14:15] op_sel:[0,1] op_sel_hi:[1,1]
    v_pk_mul_f32 v[82:83], v[82:83], v[14:15] op_sel:[0,1] op_sel_hi:[1,1]
    v_pk_mul_f32 v[76:77], v[76:77], v[14:15] op_sel:[0,0] op_sel_hi:[1,0]
    v_pk_mul_f32 v[78:79], v[78:79], v[14:15] op_sel:[0,0] op_sel_hi:[1,0]
    buffer_load_dwordx4 v[108:111], v3, s[16:19], s40 offen offset:0 sc1
    v_and_b32 v46, 0x80000000, v21
    v_lshrrev_b32 v47, 14, v19
    v_bitop3_b32 v47, v47, v5, v46 bitop3:0xea
    ds_read_b64 v[106:107], v47
    v_and_b32 v99, 0x40000000, v21
    v_lshrrev_b32 v47, 14, v18
    v_bitop3_b32 v47, v47, v5, v99 bitop3:0xea
    ds_read_b64 v[104:105], v47
    s_waitcnt lgkmcnt(2)
    v_cmp_ne_u64 s[50:51], v[72:73], v[68:69]
    v_cmpx_ne_u64 s[54:55], v[74:75], v[70:71]
    s_and_b64 s[82:83], s[54:55], s[80:81]
    s_cbranch_scc1 L2_c49
L2_d49:
    v_mov_b64 v[84:85], v[70:71]
    v_mov_b32 v7, v95
    v_mov_b64 v[86:87], v[74:75]
    s_or_b64 s[80:81], s[80:81], s[54:55]
    s_mov_b64 exec, s[50:51]
    s_and_b64 s[82:83], s[50:51], s[80:81]
    s_cbranch_scc1 L2_c50
L2_d50:
    v_mov_b64 v[84:85], v[68:69]
    v_mov_b32 v7, v94
    v_mov_b64 v[86:87], v[72:73]
    s_mov_b64 exec, -1
    s_or_b64 s[80:81], s[80:81], s[50:51]
    s_and_b64 exec, s[84:85], s[80:81]
    v_mfma_f32_4x4x4_16b_bf16 v[76:79], v[12:13], v[84:85], 0
    v_mov_b32 v92, v7
    s_andn2_b64 s[80:81], s[80:81], s[84:85]
    v_mfma_f32_4x4x4_16b_bf16 v[76:79], v[10:11], v[86:87], v[76:79]
    s_mov_b64 exec, -1
    ds_read_b64 v[70:71], v93 offset:65408
    ds_read_b64 v[68:69], v92 offset:65408
    v_bitop3_b32 v94, v18, v5, v99 bitop3:0xea
    v_bitop3_b32 v95, v19, v5, v46 bitop3:0xea
    v_perm_b32 v15, v19, v20, s47
    v_bitop3_b32 v46, v19, 0.5, -0.5 bitop3:0xa8
    v_perm_b32 v14, v18, v20, s46
    v_bitop3_b32 v47, v18, 0.5, -0.5 bitop3:0xa8
    v_bitop3_b32 v15, v6, v15, v46 bitop3:0xca
    v_bitop3_b32 v14, v6, v14, v47 bitop3:0xca
    s_waitcnt lgkmcnt(1)
    v_mfma_f32_4x4x4_16b_bf16 v[80:83], v[10:11], v[70:71], v[80:83]
    s_waitcnt lgkmcnt(0)
    v_mfma_f32_4x4x4_16b_bf16 v[76:79], v[10:11], v[68:69], v[76:79]
    s_nop 2
    v_cvt_pk_bf16_f32 v80, v80, v81
    v_cvt_pk_bf16_f32 v81, v82, v83
    ds_wrxchg_rtn_b64 v[74:75], v93, v[80:81] offset:65408
    v_cvt_pk_bf16_f32 v76, v76, v77
    v_cvt_pk_bf16_f32 v77, v78, v79
    ds_wrxchg_rtn_b64 v[72:73], v92, v[76:77] offset:65408
    v_and_b32 v88, 0x0fffffff, v40
    v_mov_b32 v21, v40
    buffer_load_dwordx2 v[16:17], v88, s[8:11], 0 offen
    buffer_load_dwordx3 v[18:20], v88, s[8:11], 0 offen offset:8
    s_setprio 2
    v_mfma_f32_4x4x4_16b_bf16 v[80:83], v[8:9], v[106:107], 0
    v_mfma_f32_4x4x4_16b_bf16 v[76:79], v[8:9], v[104:105], 0
    v_cmp_lt_u32 s[48:49], v5, v95
    s_nop 2
    v_pk_mul_f32 v[80:81], v[80:81], v[14:15] op_sel:[0,1] op_sel_hi:[1,1]
    v_pk_mul_f32 v[82:83], v[82:83], v[14:15] op_sel:[0,1] op_sel_hi:[1,1]
    v_pk_mul_f32 v[76:77], v[76:77], v[14:15] op_sel:[0,0] op_sel_hi:[1,0]
    v_pk_mul_f32 v[78:79], v[78:79], v[14:15] op_sel:[0,0] op_sel_hi:[1,0]
    s_waitcnt vmcnt(10)
    v_and_b32 v46, 0x20000000, v27
    v_lshrrev_b32 v47, 14, v23
    v_bitop3_b32 v47, v47, v5, v46 bitop3:0xea
    ds_read_b64 v[102:103], v47
    v_and_b32 v99, 0x10000000, v27
    v_lshrrev_b32 v47, 14, v22
    v_bitop3_b32 v47, v47, v5, v99 bitop3:0xea
    ds_read_b64 v[100:101], v47
    s_waitcnt lgkmcnt(2)
    v_cmp_ne_u64 s[50:51], v[72:73], v[68:69]
    v_cmpx_ne_u64 s[54:55], v[74:75], v[70:71]
    s_and_b64 s[82:83], s[54:55], s[80:81]
    s_cbranch_scc1 L2_c51
L2_d51:
    v_mov_b64 v[84:85], v[70:71]
    v_mov_b32 v7, v93
    v_mov_b64 v[86:87], v[74:75]
    s_or_b64 s[80:81], s[80:81], s[54:55]
    s_mov_b64 exec, s[50:51]
    s_and_b64 s[82:83], s[50:51], s[80:81]
    s_cbranch_scc1 L2_c52
L2_d52:
    v_mov_b64 v[84:85], v[68:69]
    v_mov_b32 v7, v92
    v_mov_b64 v[86:87], v[72:73]
    s_mov_b64 exec, -1
    s_or_b64 s[80:81], s[80:81], s[50:51]
    s_and_b64 exec, s[48:49], s[80:81]
    v_mfma_f32_4x4x4_16b_bf16 v[80:83], v[12:13], v[84:85], 0
    v_mov_b32 v95, v7
    s_andn2_b64 s[80:81], s[80:81], s[48:49]
    v_mfma_f32_4x4x4_16b_bf16 v[80:83], v[10:11], v[86:87], v[80:83]
    s_mov_b64 exec, -1
    ds_read_b64 v[70:71], v95 offset:65408
    ds_read_b64 v[68:69], v94 offset:65408
    v_bitop3_b32 v92, v22, v5, v99 bitop3:0xea
    v_bitop3_b32 v93, v23, v5, v46 bitop3:0xea
    v_perm_b32 v15, v23, v26, s45
    v_bitop3_b32 v46, v23, 0.5, -0.5 bitop3:0xa8
    v_perm_b32 v14, v22, v26, s44
    v_bitop3_b32 v47, v22, 0.5, -0.5 bitop3:0xa8
    v_bitop3_b32 v15, v6, v15, v46 bitop3:0xca
    v_bitop3_b32 v14, v6, v14, v47 bitop3:0xca
    s_waitcnt lgkmcnt(1)
    v_mfma_f32_4x4x4_16b_bf16 v[80:83], v[10:11], v[70:71], v[80:83]
    s_waitcnt lgkmcnt(0)
    v_mfma_f32_4x4x4_16b_bf16 v[76:79], v[10:11], v[68:69], v[76:79]
    s_nop 2
    v_cvt_pk_bf16_f32 v80, v80, v81
    v_cvt_pk_bf16_f32 v81, v82, v83
    ds_wrxchg_rtn_b64 v[74:75], v95, v[80:81] offset:65408
    v_cvt_pk_bf16_f32 v76, v76, v77
    v_cvt_pk_bf16_f32 v77, v78, v79
    ds_wrxchg_rtn_b64 v[72:73], v94, v[76:77] offset:65408
    s_setprio 1
    v_mfma_f32_4x4x4_16b_bf16 v[80:83], v[8:9], v[102:103], 0
    v_mfma_f32_4x4x4_16b_bf16 v[76:79], v[8:9], v[100:101], 0
    s_nop 3
    v_pk_mul_f32 v[80:81], v[80:81], v[14:15] op_sel:[0,1] op_sel_hi:[1,1]
    v_pk_mul_f32 v[82:83], v[82:83], v[14:15] op_sel:[0,1] op_sel_hi:[1,1]
    v_pk_mul_f32 v[76:77], v[76:77], v[14:15] op_sel:[0,0] op_sel_hi:[1,0]
    v_pk_mul_f32 v[78:79], v[78:79], v[14:15] op_sel:[0,0] op_sel_hi:[1,0]
    s_bitcmp1_b32 s43, s42
    s_cbranch_scc1 L2_oa53
L2_ob53:
    buffer_load_dwordx4 v[112:115], v3, s[16:19], s40 offen offset:1024 sc1
    v_sub_u16 v88, v56, v48
    v_and_b32 v89, 3, v48
    v_add3_u32 v99, v88, v89, 3
    v_and_b32 v99, -4, v99
    v_max_u32 v99, 4, v99
    v_and_b32 v97, 0xfffc, v48
    v_bfm_b32 v96, v88, v89
    v_add_u32_dpp v91, v99, v99 row_shr:1 row_mask:0xf bank_mask:0xf bound_ctrl:1
    v_mad_u32_u24 v97, v97, 5, v2
    v_cmp_lt_u32 vcc, 16, v99
    v_add_u32_dpp v91, v91, v91 row_shr:2 row_mask:0xf bank_mask:0xf bound_ctrl:1
    v_sub_u32 v98, s38, v99
    v_lshrrev_b64 v[48:49], 16, v[48:49]
    v_add_u32_dpp v91, v91, v91 row_shr:4 row_mask:0xf bank_mask:0xf bound_ctrl:1
    v_lshrrev_b64 v[56:57], 16, v[56:57]
    s_mov_b32 s101, 0
    v_add_u32_dpp v91, v91, v91 row_shr:8 row_mask:0xf bank_mask:0xf bound_ctrl:1
    s_nop 1
    v_add_u32_dpp v91, v91, v91 row_bcast:15 row_mask:0xa bank_mask:0xf
    s_nop 1
    v_add_u32_dpp v91, v91, v91 row_bcast:31 row_mask:0xc bank_mask:0xf
    v_add_u32 v98, v98, v91
    v_readlane_b32 s37, v91, 63
    s_cbranch_vccnz L2_xo54
L2_xp54:
    v_and_b32 v46, 0x80000000, v27
    v_lshrrev_b32 v47, 14, v25
    v_bitop3_b32 v47, v47, v5, v46 bitop3:0xea
    ds_read_b64 v[106:107], v47
    v_and_b32 v99, 0x40000000, v27
    v_lshrrev_b32 v47, 14, v24
    v_bitop3_b32 v47, v47, v5, v99 bitop3:0xea
    ds_read_b64 v[104:105], v47
    s_waitcnt lgkmcnt(2)
    v_cmp_ne_u64 s[50:51], v[72:73], v[68:69]
    v_cmpx_ne_u64 s[54:55], v[74:75], v[70:71]
    s_and_b64 s[82:83], s[54:55], s[80:81]
    s_cbranch_scc1 L2_c55
L2_d55:
    v_mov_b64 v[84:85], v[70:71]
    v_mov_b32 v7, v95
    v_mov_b64 v[86:87], v[74:75]
    s_or_b64 s[80:81], s[80:81], s[54:55]
    s_mov_b64 exec, s[50:51]
    s_and_b64 s[82:83], s[50:51], s[80:81]
    s_cbranch_scc1 L2_c56
L2_d56:
    v_mov_b64 v[84:85], v[68:69]
    v_mov_b32 v7, v94
    v_mov_b64 v[86:87], v[72:73]
    s_mov_b64 exec, -1
    s_or_b64 s[80:81], s[80:81], s[50:51]
    ds_read_b64 v[70:71], v93 offset:65408
    ds_read_b64 v[68:69], v92 offset:65408
    v_bitop3_b32 v94, v24, v5, v99 bitop3:0xea
    v_bitop3_b32 v95, v25, v5, v46 bitop3:0xea
    v_perm_b32 v15, v25, v26, s47
    v_bitop3_b32 v46, v25, 0.5, -0.5 bitop3:0xa8
    v_perm_b32 v14, v24, v26, s46
    v_bitop3_b32 v47, v24, 0.5, -0.5 bitop3:0xa8
    v_bitop3_b32 v15, v6, v15, v46 bitop3:0xca
    v_bitop3_b32 v14, v6, v14, v47 bitop3:0xca
    s_waitcnt lgkmcnt(1)
    v_mfma_f32_4x4x4_16b_bf16 v[80:83], v[10:11], v[70:71], v[80:83]
    s_waitcnt lgkmcnt(0)
    v_mfma_f32_4x4x4_16b_bf16 v[76:79], v[10:11], v[68:69], v[76:79]
    s_nop 2
    v_cvt_pk_bf16_f32 v80, v80, v81
    v_cvt_pk_bf16_f32 v81, v82, v83
    ds_wrxchg_rtn_b64 v[74:75], v93, v[80:81] offset:65408
    v_cvt_pk_bf16_f32 v76, v76, v77
    v_cvt_pk_bf16_f32 v77, v78, v79
    ds_wrxchg_rtn_b64 v[72:73], v92, v[76:77] offset:65408
    v_and_b32 v88, 0x0fffffff, v41
    v_mov_b32 v27, v41
    buffer_load_dwordx2 v[22:23], v88, s[8:11], 0 offen
    buffer_load_dwordx3 v[24:26], v88, s[8:11], 0 offen offset:8
    v_mfma_f32_4x4x4_16b_bf16 v[80:83], v[8:9], v[106:107], 0
    v_mfma_f32_4x4x4_16b_bf16 v[76:79], v[8:9], v[104:105], 0
    v_cmp_lt_u32 s[84:85], v5, v94
    s_nop 2
    v_pk_mul_f32 v[80:81], v[80:81], v[14:15] op_sel:[0,1] op_sel_hi:[1,1]
    v_pk_mul_f32 v[82:83], v[82:83], v[14:15] op_sel:[0,1] op_sel_hi:[1,1]
    v_pk_mul_f32 v[76:77], v[76:77], v[14:15] op_sel:[0,0] op_sel_hi:[1,0]
    v_pk_mul_f32 v[78:79], v[78:79], v[14:15] op_sel:[0,0] op_sel_hi:[1,0]
    s_waitcnt vmcnt(11)
    s_mov_b64 exec, s[6:7]
    v_lshrrev_b32 v30, 16, v30
    s_mov_b64 exec, -1
    v_and_b32 v46, 0x20000000, v31
    v_lshrrev_b32 v47, 14, v29
    v_bitop3_b32 v47, v47, v5, v46 bitop3:0xea
    ds_read_b64 v[102:103], v47
    v_and_b32 v99, 0x10000000, v31
    v_lshrrev_b32 v47, 14, v28
    v_bitop3_b32 v47, v47, v5, v99 bitop3:0xea
    ds_read_b64 v[100:101], v47
    s_waitcnt lgkmcnt(2)
    v_cmp_ne_u64 s[50:51], v[72:73], v[68:69]
    v_cmpx_ne_u64 s[54:55], v[74:75], v[70:71]
    s_and_b64 s[82:83], s[54:55], s[80:81]
    s_cbranch_scc1 L2_c57
L2_d57:
    v_mov_b64 v[84:85], v[70:71]
    v_mov_b32 v7, v93
    v_mov_b64 v[86:87], v[74:75]
    s_or_b64 s[80:81], s[80:81], s[54:55]
    s_mov_b64 exec, s[50:51]
    s_and_b64 s[82:83], s[50:51], s[80:81]
    s_cbranch_scc1 L2_c58
L2_d58:
    v_mov_b64 v[84:85], v[68:69]
    v_mov_b32 v7, v92
    v_mov_b64 v[86:87], v[72:73]
    s_mov_b64 exec, -1
    s_or_b64 s[80:81], s[80:81], s[50:51]
    s_and_b64 exec, s[84:85], s[80:81]
    v_mfma_f32_4x4x4_16b_bf16 v[76:79], v[12:13], v[84:85], 0
    v_mov_b32 v94, v7
    s_andn2_b64 s[80:81], s[80:81], s[84:85]
    v_mfma_f32_4x4x4_16b_bf16 v[76:79], v[10:11], v[86:87], v[76:79]
    s_mov_b64 exec, -1
    ds_read_b64 v[70:71], v95 offset:65408
    ds_read_b64 v[68:69], v94 offset:65408
    v_bitop3_b32 v92, v28, v5, v99 bitop3:0xea
    v_bitop3_b32 v93, v29, v5, v46 bitop3:0xea
    v_perm_b32 v15, v29, v30, s45
    v_bitop3_b32 v46, v29, 0.5, -0.5 bitop3:0xa8
    v_perm_b32 v14, v28, v30, s44
    v_bitop3_b32 v47, v28, 0.5, -0.5 bitop3:0xa8
    v_bitop3_b32 v15, v6, v15, v46 bitop3:0xca
    v_bitop3_b32 v14, v6, v14, v47 bitop3:0xca
    s_waitcnt lgkmcnt(1)
    v_mfma_f32_4x4x4_16b_bf16 v[80:83], v[10:11], v[70:71], v[80:83]
    s_waitcnt lgkmcnt(0)
    v_mfma_f32_4x4x4_16b_bf16 v[76:79], v[10:11], v[68:69], v[76:79]
    s_nop 2
    v_cvt_pk_bf16_f32 v80, v80, v81
    v_cvt_pk_bf16_f32 v81, v82, v83
    ds_wrxchg_rtn_b64 v[74:75], v95, v[80:81] offset:65408
    v_cvt_pk_bf16_f32 v76, v76, v77
    v_cvt_pk_bf16_f32 v77, v78, v79
    ds_wrxchg_rtn_b64 v[72:73], v94, v[76:77] offset:65408
    s_setprio 0
    v_mfma_f32_4x4x4_16b_bf16 v[80:83], v[8:9], v[102:103], 0
    v_mfma_f32_4x4x4_16b_bf16 v[76:79], v[8:9], v[100:101], 0
    v_cmp_lt_u32 s[48:49], v5, v93
    s_nop 2
    v_pk_mul_f32 v[80:81], v[80:81], v[14:15] op_sel:[0,1] op_sel_hi:[1,1]
    v_pk_mul_f32 v[82:83], v[82:83], v[14:15] op_sel:[0,1] op_sel_hi:[1,1]
    v_pk_mul_f32 v[76:77], v[76:77], v[14:15] op_sel:[0,0] op_sel_hi:[1,0]
    v_pk_mul_f32 v[78:79], v[78:79], v[14:15] op_sel:[0,0] op_sel_hi:[1,0]
    s_add_u32 s40, s40, 0xfff24000
    v_and_b32 v47, 0x0fffffff, v42
    v_mov_b32 v31, v42
    buffer_load_dword v30, v47, s[8:11], 0 offen offset:16
    s_mov_b64 exec, s[6:7]
    v_add_u32 v47, 8, v47
    v_lshrrev_b32 v31, 2, v31
    s_mov_b64 exec, -1
    buffer_load_dwordx2 v[28:29], v47, s[8:11], 0 offen
    s_waitcnt vmcnt(8)
    v_and_b32 v46, 0x80000000, v39
    v_lshrrev_b32 v47, 14, v37
    v_bitop3_b32 v47, v47, v5, v46 bitop3:0xea
    ds_read_b64 v[102:103], v47
    v_and_b32 v99, 0x40000000, v39
    v_lshrrev_b32 v47, 14, v36
    v_bitop3_b32 v47, v47, v5, v99 bitop3:0xea
    ds_read_b64 v[100:101], v47
    v_and_b32 v46, 0x20000000, v39
    v_lshrrev_b32 v47, 14, v35
    v_bitop3_b32 v47, v47, v5, v46 bitop3:0xea
    ds_read_b64 v[106:107], v47
    v_and_b32 v99, 0x10000000, v39
    v_lshrrev_b32 v47, 14, v34
    v_bitop3_b32 v47, v47, v5, v99 bitop3:0xea
    ds_read_b64 v[104:105], v47
    s_waitcnt lgkmcnt(4)
    v_cmp_ne_u64 s[50:51], v[72:73], v[68:69]
    v_cmpx_ne_u64 s[54:55], v[74:75], v[70:71]
    s_and_b64 s[82:83], s[54:55], s[80:81]
    s_cbranch_scc1 L2_c59
L2_d59:
    v_mov_b64 v[84:85], v[70:71]
    v_mov_b32 v7, v95
    v_mov_b64 v[86:87], v[74:75]
    s_or_b64 s[80:81], s[80:81], s[54:55]
    s_mov_b64 exec, s[50:51]
    s_and_b64 s[82:83], s[50:51], s[80:81]
    s_cbranch_scc1 L2_c60
L2_d60:
    v_mov_b64 v[84:85], v[68:69]
    v_mov_b32 v7, v94
    v_mov_b64 v[86:87], v[72:73]
    s_mov_b64 exec, -1
    s_or_b64 s[80:81], s[80:81], s[50:51]
    s_and_b64 exec, s[48:49], s[80:81]
    v_mfma_f32_4x4x4_16b_bf16 v[80:83], v[12:13], v[84:85], 0
    v_mov_b32 v93, v7
    s_andn2_b64 s[80:81], s[80:81], s[48:49]
    v_mfma_f32_4x4x4_16b_bf16 v[80:83], v[10:11], v[86:87], v[80:83]
    s_mov_b64 exec, -1
    ds_read_b64 v[70:71], v93 offset:65408
    ds_read_b64 v[68:69], v92 offset:65408
    v_bitop3_b32 v94, v34, v5, v99 bitop3:0xea
    v_bitop3_b32 v95, v35, v5, v46 bitop3:0xea
    v_perm_b32 v15, v35, v38, s45
    v_bitop3_b32 v46, v35, 0.5, -0.5 bitop3:0xa8
    v_perm_b32 v14, v34, v38, s44
    v_bitop3_b32 v47, v34, 0.5, -0.5 bitop3:0xa8
    v_bitop3_b32 v15, v6, v15, v46 bitop3:0xca
    v_bitop3_b32 v14, v6, v14, v47 bitop3:0xca
    s_waitcnt lgkmcnt(1)
    v_mfma_f32_4x4x4_16b_bf16 v[80:83], v[10:11], v[70:71], v[80:83]
    s_waitcnt lgkmcnt(0)
    v_mfma_f32_4x4x4_16b_bf16 v[76:79], v[10:11], v[68:69], v[76:79]
    s_nop 2
    v_cvt_pk_bf16_f32 v80, v80, v81
    v_cvt_pk_bf16_f32 v81, v82, v83
    ds_wrxchg_rtn_b64 v[74:75], v93, v[80:81] offset:65408
    v_cvt_pk_bf16_f32 v76, v76, v77
    v_cvt_pk_bf16_f32 v77, v78, v79
    ds_wrxchg_rtn_b64 v[72:73], v92, v[76:77] offset:65408
    s_barrier
    s_setprio 3
    s_mov_b32 m0, s100
    s_nop 0
    ds_write_addtid_b32 v124 offset:34816
    ds_write_addtid_b32 v125 offset:35072
    ds_write_addtid_b32 v126 offset:35328
    ds_write_addtid_b32 v127 offset:35584
    s_add_u32 s3, s40, 4096
    buffer_load_dwordx4 v[124:127], v3, s[16:19], s3 offen sc1
    ds_write_addtid_b32 v116 offset:32768
    ds_write_addtid_b32 v117 offset:33024
    ds_write_addtid_b32 v118 offset:33280
    ds_write_addtid_b32 v119 offset:33536
    buffer_load_dwordx4 v[116:119], v3, s[16:19], s40 offen offset:2048 sc1
    ds_write_addtid_b32 v120 offset:33792
    ds_write_addtid_b32 v121 offset:34048
    ds_write_addtid_b32 v122 offset:34304
    ds_write_addtid_b32 v123 offset:34560
    buffer_load_dwordx4 v[120:123], v3, s[16:19], s40 offen offset:3072 sc1
    v_mfma_f32_4x4x4_16b_bf16 v[80:83], v[8:9], v[106:107], 0
    v_mfma_f32_4x4x4_16b_bf16 v[76:79], v[8:9], v[104:105], 0
    s_nop 3
    v_pk_mul_f32 v[80:81], v[80:81], v[14:15] op_sel:[0,1] op_sel_hi:[1,1]
    v_pk_mul_f32 v[82:83], v[82:83], v[14:15] op_sel:[0,1] op_sel_hi:[1,1]
    v_pk_mul_f32 v[76:77], v[76:77], v[14:15] op_sel:[0,0] op_sel_hi:[1,0]
    v_pk_mul_f32 v[78:79], v[78:79], v[14:15] op_sel:[0,0] op_sel_hi:[1,0]
    v_mov_b32 v44, v43
    s_cmp_gt_u32 s37, 1024
    s_cbranch_scc1 L2_xs61
    s_cmp_lg_u32 s101, 0
    s_cbranch_scc1 L2_xa61
L2_xb61:
    v_lshlrev_b32 v89, 16, v96
    v_add_u32 v90, 60, v97
    v_bitop3_b32 v90, v89, v45, v90 bitop3:0x6a
    ds_write_b32 v98, v90 offset:12
    v_lshlrev_b32 v89, 20, v96
    v_add_u32 v90, 40, v97
    v_bitop3_b32 v90, v89, v45, v90 bitop3:0x6a
    ds_write_b32 v98, v90 offset:8
    v_lshlrev_b32 v89, 24, v96
    v_add_u32 v90, 20, v97
    v_bitop3_b32 v90, v89, v45, v90 bitop3:0x6a
    ds_write_b32 v98, v90 offset:4
    v_lshlrev_b32 v89, 28, v96
    v_bitop3_b32 v90, v89, v45, v97 bitop3:0x6a
    ds_write_b32 v98, v90 offset:0
    v_mov_b32_dpp v91, v64 quad_perm:[0,0,0,0] row_mask:0xf bank_mask:0xf
    v_and_b32 v89, 3, v91
    v_and_b32 v97, 0xfffc, v91
    v_sub_u16_dpp v88, v64, v91 quad_perm:[2,2,2,2] row_mask:0xf bank_mask:0xf
    v_mad_u32_u24 v97, v97, 5, v4
    v_add_u32 v99, v88, v89
    v_bfm_b32 v96, v88, v89
    v_cmp_lt_u32 s[58:59], 16, v99
    v_lshlrev_b32 v89, v1, v96
    v_and_b32 v89, v45, v89
    v_cmp_ne_u32 vcc, 0, v89
    v_xor_b32 v90, v97, v89
    s_add_u32 s3, s37, s38
    v_mbcnt_lo_u32_b32 v98, vcc_lo, 0
    v_mbcnt_hi_u32_b32 v98, vcc_hi, v98
    s_bcnt1_i32_b64 s41, vcc
    v_lshl_add_u32 v98, v98, 2, s3
    s_lshl2_add_u32 s37, s41, s37
    s_mov_b64 exec, vcc
    ds_write_b32 v98, v90
    s_mov_b64 exec, -1
    s_cmp_lg_u64 s[58:59], 0
    s_cbranch_scc1 L2_xe61
L2_xr61:
    v_add_u32 v98, s37, v0
    v_mov_b32 v90, -1
    ds_write_b32 v98, v90
    v_add_u32 v98, s38, v0
    ds_read2st64_b32 v[40:41], v0 offset0:0 offset1:1
    ds_read_b32 v43, v0 offset:512
    v_lshrrev_b32 v98, 1, v98
    v_and_b32 v98, -4, v98
    ds_read_b32 v42, v98 offset:768
    s_sub_u32 s3, s37, 768
    s_cmp_gt_u32 s3, 128
    s_cbranch_scc1 L2_xf61
L2_xg61:
    s_setprio 2
    s_waitcnt lgkmcnt(14)
    v_cmp_ne_u64 s[50:51], v[72:73], v[68:69]
    v_cmpx_ne_u64 s[54:55], v[74:75], v[70:71]
    s_and_b64 s[82:83], s[54:55], s[80:81]
    s_cbranch_scc1 L2_c62
L2_d62:
    v_mov_b64 v[84:85], v[70:71]
    v_mov_b32 v7, v93
    v_mov_b64 v[86:87], v[74:75]
    s_or_b64 s[80:81], s[80:81], s[54:55]
    s_mov_b64 exec, s[50:51]
    s_and_b64 s[82:83], s[50:51], s[80:81]
    s_cbranch_scc1 L2_c63
L2_d63:
    v_mov_b64 v[84:85], v[68:69]
    v_mov_b32 v7, v92
    v_mov_b64 v[86:87], v[72:73]
    s_mov_b64 exec, -1
    s_or_b64 s[80:81], s[80:81], s[50:51]
    ds_read_b64 v[70:71], v95 offset:65408
    ds_read_b64 v[68:69], v94 offset:65408
    v_and_b32 v46, 0x40000000, v39
    v_bitop3_b32 v92, v36, v5, v46 bitop3:0xea
    v_and_b32 v46, 0x80000000, v39
    v_bitop3_b32 v93, v37, v5, v46 bitop3:0xea
    v_perm_b32 v15, v37, v38, s47
    v_bitop3_b32 v46, v37, 0.5, -0.5 bitop3:0xa8
    v_perm_b32 v14, v36, v38, s46
    v_bitop3_b32 v47, v36, 0.5, -0.5 bitop3:0xa8
    v_bitop3_b32 v15, v6, v15, v46 bitop3:0xca
    v_bitop3_b32 v14, v6, v14, v47 bitop3:0xca
    s_setprio 1
    s_waitcnt lgkmcnt(1)
    v_mfma_f32_4x4x4_16b_bf16 v[80:83], v[10:11], v[70:71], v[80:83]
    s_waitcnt lgkmcnt(0)
    v_mfma_f32_4x4x4_16b_bf16 v[76:79], v[10:11], v[68:69], v[76:79]
    s_nop 2
    v_cvt_pk_bf16_f32 v80, v80, v81
    v_cvt_pk_bf16_f32 v81, v82, v83
    ds_wrxchg_rtn_b64 v[74:75], v95, v[80:81] offset:65408
    v_cvt_pk_bf16_f32 v76, v76, v77
    v_cvt_pk_bf16_f32 v77, v78, v79
    ds_wrxchg_rtn_b64 v[72:73], v94, v[76:77] offset:65408
    v_and_b32 v88, 0x0fffffff, v44
    v_mov_b32 v39, v44
    buffer_load_dwordx2 v[34:35], v88, s[8:11], 0 offen
    buffer_load_dwordx3 v[36:38], v88, s[8:11], 0 offen offset:8
    s_setprio 0
    s_waitcnt vmcnt(12)
    s_mov_b32 m0, s38
    s_nop 0
    ds_write_addtid_b32 v108 offset:0
    ds_write_addtid_b32 v109 offset:256
    ds_write_addtid_b32 v110 offset:512
    ds_write_addtid_b32 v111 offset:768
    s_waitcnt vmcnt(9)
    ds_write_addtid_b32 v112 offset:1024
    ds_write_addtid_b32 v113 offset:1280
    ds_write_addtid_b32 v114 offset:1536
    ds_write_addtid_b32 v115 offset:1792
    v_mfma_f32_4x4x4_16b_bf16 v[80:83], v[8:9], v[102:103], 0
    v_mfma_f32_4x4x4_16b_bf16 v[76:79], v[8:9], v[100:101], 0
    v_cmp_lt_u32 s[84:85], v5, v92
    s_nop 2
    v_pk_mul_f32 v[80:81], v[80:81], v[14:15] op_sel:[0,1] op_sel_hi:[1,1]
    v_pk_mul_f32 v[82:83], v[82:83], v[14:15] op_sel:[0,1] op_sel_hi:[1,1]
    v_pk_mul_f32 v[76:77], v[76:77], v[14:15] op_sel:[0,0] op_sel_hi:[1,0]
    v_pk_mul_f32 v[78:79], v[78:79], v[14:15] op_sel:[0,0] op_sel_hi:[1,0]
    s_add_u32 s42, s42, 1
    s_waitcnt lgkmcnt(0)
    s_barrier
    s_bitcmp1_b32 s36, s42
    s_cbranch_scc1 L2_slow
L2_ret3:
    s_setprio 3
    s_bitcmp1_b32 s43, s42
    s_cbranch_scc1 L2_oa64
L2_ob64:
    v_and_b32 v46, 0x20000000, v21
    v_lshrrev_b32 v47, 14, v17
    v_bitop3_b32 v47, v47, v5, v46 bitop3:0xea
    ds_read_b64 v[106:107], v47
    v_and_b32 v99, 0x10000000, v21
    v_lshrrev_b32 v47, 14, v16
    v_bitop3_b32 v47, v47, v5, v99 bitop3:0xea
    ds_read_b64 v[104:105], v47
    v_cmp_ne_u64 s[50:51], v[72:73], v[68:69]
    v_cmpx_ne_u64 s[54:55], v[74:75], v[70:71]
    s_and_b64 s[82:83], s[54:55], s[80:81]
    s_cbranch_scc1 L2_c65
L2_d65:
    v_mov_b64 v[84:85], v[70:71]
    v_mov_b32 v7, v95
    v_mov_b64 v[86:87], v[74:75]
    s_or_b64 s[80:81], s[80:81], s[54:55]
    s_mov_b64 exec, s[50:51]
    s_and_b64 s[82:83], s[50:51], s[80:81]
    s_cbranch_scc1 L2_c66
L2_d66:
    v_mov_b64 v[84:85], v[68:69]
    v_mov_b32 v7, v94
    v_mov_b64 v[86:87], v[72:73]
    s_mov_b64 exec, -1
    s_or_b64 s[80:81], s[80:81], s[50:51]
    s_and_b64 exec, s[84:85], s[80:81]
    v_mfma_f32_4x4x4_16b_bf16 v[76:79], v[12:13], v[84:85], 0
    v_mov_b32 v92, v7
    s_andn2_b64 s[80:81], s[80:81], s[84:85]
    v_mfma_f32_4x4x4_16b_bf16 v[76:79], v[10:11], v[86:87], v[76:79]
    s_mov_b64 exec, -1
    ds_read_b64 v[70:71], v93 offset:65408
    ds_read_b64 v[68:69], v92 offset:65408
    v_bitop3_b32 v94, v16, v5, v99 bitop3:0xea
    v_bitop3_b32 v95, v17, v5, v46 bitop3:0xea
    v_perm_b32 v15, v17, v20, s45
    v_bitop3_b32 v46, v17, 0.5, -0.5 bitop3:0xa8
    v_perm_b32 v14, v16, v20, s44
    v_bitop3_b32 v47, v16, 0.5, -0.5 bitop3:0xa8
    v_bitop3_b32 v15, v6, v15, v46 bitop3:0xca
    v_bitop3_b32 v14, v6, v14, v47 bitop3:0xca
    s_waitcnt lgkmcnt(1)
    v_mfma_f32_4x4x4_16b_bf16 v[80:83], v[10:11], v[70:71], v[80:83]
    s_waitcnt lgkmcnt(0)
    v_mfma_f32_4x4x4_16b_bf16 v[76:79], v[10:11], v[68:69], v[76:79]
    s_nop 2
    v_cvt_pk_bf16_f32 v80, v80, v81
    v_cvt_pk_bf16_f32 v81, v82, v83
    ds_wrxchg_rtn_b64 v[74:75], v93, v[80:81] offset:65408
    v_cvt_pk_bf16_f32 v76, v76, v77
    v_cvt_pk_bf16_f32 v77, v78, v79
    ds_wrxchg_rtn_b64 v[72:73], v92, v[76:77] offset:65408
    v_mfma_f32_4x4x4_16b_bf16 v[80:83], v[8:9], v[106:107], 0
    v_mfma_f32_4x4x4_16b_bf16 v[76:79], v[8:9], v[104:105], 0
    v_cmp_lt_u32 s[84:85], v5, v94
    s_nop 2
    v_pk_mul_f32 v[80:81], v[80:81], v[14:15] op_sel:[0,1] op_sel_hi:[1,1]
    v_pk_mul_f32 v[82:83], v[82:83], v[14:15] op_sel:[0,1] op_sel_hi:[1,1]
    v_pk_mul_f32 v[76:77], v[76:77], v[14:15] op_sel:[0,0] op_sel_hi:[1,0]
    v_pk_mul_f32 v[78:79], v[78:79], v[14:15] op_sel:[0,0] op_sel_hi:[1,0]
    buffer_load_dwordx4 v[108:111], v3, s[16:19], s40 offen offset:0 sc1
    v_and_b32 v46, 0x80000000, v21
    v_lshrrev_b32 v47, 14, v19
    v_bitop3_b32 v47, v47, v5, v46 bitop3:0xea
    ds_read_b64 v[102:103], v47
    v_and_b32 v99, 0x40000000, v21
    v_lshrrev_b32 v47, 14, v18
    v_bitop3_b32 v47, v47, v5, v99 bitop3:0xea
    ds_read_b64 v[100:101], v47
    s_waitcnt lgkmcnt(2)
    v_cmp_ne_u64 s[50:51], v[72:73], v[68:69]
    v_cmpx_ne_u64 s[54:55], v[74:75], v[70:71]
    s_and_b64 s[82:83], s[54:55], s[80:81]
    s_cbranch_scc1 L2_c67
L2_d67:
    v_mov_b64 v[84:85], v[70:71]
    v_mov_b32 v7, v93
    v_mov_b64 v[86:87], v[74:75]
    s_or_b64 s[80:81], s[80:81], s[54:55]
    s_mov_b64 exec, s[50:51]
    s_and_b64 s[82:83], s[50:51], s[80:81]
    s_cbranch_scc1 L2_c68
L2_d68:
    v_mov_b64 v[84:85], v[68:69]
    v_mov_b32 v7, v92
    v_mov_b64 v[86:87], v[72:73]
    s_mov_b64 exec, -1
    s_or_b64 s[80:81], s[80:81], s[50:51]
    s_and_b64 exec, s[84:85], s[80:81]
    v_mfma_f32_4x4x4_16b_bf16 v[76:79], v[12:13], v[84:85], 0
    v_mov_b32 v94, v7
    s_andn2_b64 s[80:81], s[80:81], s[84:85]
    v_mfma_f32_4x4x4_16b_bf16 v[76:79], v[10:11], v[86:87], v[76:79]
    s_mov_b64 exec, -1
    ds_read_b64 v[70:71], v95 offset:65408
    ds_read_b64 v[68:69], v94 offset:65408
    v_bitop3_b32 v92, v18, v5, v99 bitop3:0xea
    v_bitop3_b32 v93, v19, v5, v46 bitop3:0xea
    v_perm_b32 v15, v19, v20, s47
    v_bitop3_b32 v46, v19, 0.5, -0.5 bitop3:0xa8
    v_perm_b32 v14, v18, v20, s46
    v_bitop3_b32 v47, v18, 0.5, -0.5 bitop3:0xa8
    v_bitop3_b32 v15, v6, v15, v46 bitop3:0xca
    v_bitop3_b32 v14, v6, v14, v47 bitop3:0xca
    s_waitcnt lgkmcnt(1)
    v_mfma_f32_4x4x4_16b_bf16 v[80:83], v[10:11], v[70:71], v[80:83]
    s_waitcnt lgkmcnt(0)
    v_mfma_f32_4x4x4_16b_bf16 v[76:79], v[10:11], v[68:69], v[76:79]
    s_nop 2
    v_cvt_pk_bf16_f32 v80, v80, v81
    v_cvt_pk_bf16_f32 v81, v82, v83
    ds_wrxchg_rtn_b64 v[74:75], v95, v[80:81] offset:65408
    v_cvt_pk_bf16_f32 v76, v76, v77
    v_cvt_pk_bf16_f32 v77, v78, v79
    ds_wrxchg_rtn_b64 v[72:73], v94, v[76:77] offset:65408
    v_and_b32 v88, 0x0fffffff, v40
    v_mov_b32 v21, v40
    buffer_load_dwordx2 v[16:17], v88, s[8:11], 0 offen
    buffer_load_dwordx3 v[18:20], v88, s[8:11], 0 offen offset:8
    s_setprio 2
    v_mfma_f32_4x4x4_16b_bf16 v[80:83], v[8:9], v[102:103], 0
    v_mfma_f32_4x4x4_16b_bf16 v[76:79], v[8:9], v[100:101], 0
    v_cmp_lt_u32 s[48:49], v5, v93
    s_nop 2
    v_pk_mul_f32 v[80:81], v[80:81], v[14:15] op_sel:[0,1] op_sel_hi:[1,1]
    v_pk_mul_f32 v[82:83], v[82:83], v[14:15] op_sel:[0,1] op_sel_hi:[1,1]
    v_pk_mul_f32 v[76:77], v[76:77], v[14:15] op_sel:[0,0] op_sel_hi:[1,0]
    v_pk_mul_f32 v[78:79], v[78:79], v[14:15] op_sel:[0,0] op_sel_hi:[1,0]
    s_waitcnt vmcnt(10)
    v_and_b32 v46, 0x20000000, v27
    v_lshrrev_b32 v47, 14, v23
    v_bitop3_b32 v47, v47, v5, v46 bitop3:0xea
    ds_read_b64 v[106:107], v47
    v_and_b32 v99, 0x10000000, v27
    v_lshrrev_b32 v47, 14, v22
    v_bitop3_b32 v47, v47, v5, v99 bitop3:0xea
    ds_read_b64 v[104:105], v47
    s_waitcnt lgkmcnt(2)
    v_cmp_ne_u64 s[50:51], v[72:73], v[68:69]
    v_cmpx_ne_u64 s[54:55], v[74:75], v[70:71]
    s_and_b64 s[82:83], s[54:55], s[80:81]
    s_cbranch_scc1 L2_c69
L2_d69:
    v_mov_b64 v[84:85], v[70:71]
    v_mov_b32 v7, v95
    v_mov_b64 v[86:87], v[74:75]
    s_or_b64 s[80:81], s[80:81], s[54:55]
    s_mov_b64 exec, s[50:51]
    s_and_b64 s[82:83], s[50:51], s[80:81]
    s_cbranch_scc1 L2_c70
L2_d70:
    v_mov_b64 v[84:85], v[68:69]
    v_mov_b32 v7, v94
    v_mov_b64 v[86:87], v[72:73]
    s_mov_b64 exec, -1
    s_or_b64 s[80:81], s[80:81], s[50:51]
    s_and_b64 exec, s[48:49], s[80:81]
    v_mfma_f32_4x4x4_16b_bf16 v[80:83], v[12:13], v[84:85], 0
    v_mov_b32 v93, v7
    s_andn2_b64 s[80:81], s[80:81], s[48:49]
    v_mfma_f32_4x4x4_16b_bf16 v[80:83], v[10:11], v[86:87], v[80:83]
    s_mov_b64 exec, -1
    ds_read_b64 v[70:71], v93 offset:65408
    ds_read_b64 v[68:69], v92 offset:65408
    v_bitop3_b32 v94, v22, v5, v99 bitop3:0xea
    v_bitop3_b32 v95, v23, v5, v46 bitop3:0xea
    v_perm_b32 v15, v23, v26, s45
    v_bitop3_b32 v46, v23, 0.5, -0.5 bitop3:0xa8
    v_perm_b32 v14, v22, v26, s44
    v_bitop3_b32 v47, v22, 0.5, -0.5 bitop3:0xa8
    v_bitop3_b32 v15, v6, v15, v46 bitop3:0xca
    v_bitop3_b32 v14, v6, v14, v47 bitop3:0xca
    s_waitcnt lgkmcnt(1)
    v_mfma_f32_4x4x4_16b_bf16 v[80:83], v[10:11], v[70:71], v[80:83]
    s_waitcnt lgkmcnt(0)
    v_mfma_f32_4x4x4_16b_bf16 v[76:79], v[10:11], v[68:69], v[76:79]
    s_nop 2
    v_cvt_pk_bf16_f32 v80, v80, v81
    v_cvt_pk_bf16_f32 v81, v82, v83
    ds_wrxchg_rtn_b64 v[74:75], v93, v[80:81] offset:65408
    v_cvt_pk_bf16_f32 v76, v76, v77
    v_cvt_pk_bf16_f32 v77, v78, v79
    ds_wrxchg_rtn_b64 v[72:73], v92, v[76:77] offset:65408
    s_setprio 1
    v_mfma_f32_4x4x4_16b_bf16 v[80:83], v[8:9], v[106:107], 0
    v_mfma_f32_4x4x4_16b_bf16 v[76:79], v[8:9], v[104:105], 0
    s_nop 3
    v_pk_mul_f32 v[80:81], v[80:81], v[14:15] op_sel:[0,1] op_sel_hi:[1,1]
    v_pk_mul_f32 v[82:83], v[82:83], v[14:15] op_sel:[0,1] op_sel_hi:[1,1]
    v_pk_mul_f32 v[76:77], v[76:77], v[14:15] op_sel:[0,0] op_sel_hi:[1,0]
    v_pk_mul_f32 v[78:79], v[78:79], v[14:15] op_sel:[0,0] op_sel_hi:[1,0]
    s_bitcmp1_b32 s43, s42
    s_cbranch_scc1 L2_oa71
L2_ob71:
    buffer_load_dwordx4 v[112:115], v3, s[16:19], s40 offen offset:1024 sc1
    v_sub_u16 v88, v58, v50
    v_and_b32 v89, 3, v50
    v_add3_u32 v99, v88, v89, 3
    v_and_b32 v99, -4, v99
    v_max_u32 v99, 4, v99
    v_and_b32 v97, 0xfffc, v50
    v_bfm_b32 v96, v88, v89
    v_add_u32_dpp v91, v99, v99 row_shr:1 row_mask:0xf bank_mask:0xf bound_ctrl:1
    v_mad_u32_u24 v97, v97, 5, v2
    v_cmp_lt_u32 vcc, 16, v99
    v_add_u32_dpp v91, v91, v91 row_shr:2 row_mask:0xf bank_mask:0xf bound_ctrl:1
    v_sub_u32 v98, s38, v99
    v_lshrrev_b64 v[50:51], 16, v[50:51]
    v_add_u32_dpp v91, v91, v91 row_shr:4 row_mask:0xf bank_mask:0xf bound_ctrl:1
    v_lshrrev_b64 v[58:59], 16, v[58:59]
    s_mov_b32 s101, 0
    v_add_u32_dpp v91, v91, v91 row_shr:8 row_mask:0xf bank_mask:0xf bound_ctrl:1
    s_nop 1
    v_add_u32_dpp v91, v91, v91 row_bcast:15 row_mask:0xa bank_mask:0xf
    s_nop 1
    v_add_u32_dpp v91, v91, v91 row_bcast:31 row_mask:0xc bank_mask:0xf
    v_add_u32 v98, v98, v91
    v_readlane_b32 s37, v91, 63
    s_cbranch_vccnz L2_xo72
L2_xp72:
    v_and_b32 v46, 0x80000000, v27
    v_lshrrev_b32 v47, 14, v25
    v_bitop3_b32 v47, v47, v5, v46 bitop3:0xea
    ds_read_b64 v[102:103], v47
    v_and_b32 v99, 0x40000000, v27
    v_lshrrev_b32 v47, 14, v24
    v_bitop3_b32 v47, v47, v5, v99 bitop3:0xea
    ds_read_b64 v[100:101], v47
    s_waitcnt lgkmcnt(2)
    v_cmp_ne_u64 s[50:51], v[72:73], v[68:69]
    v_cmpx_ne_u64 s[54:55], v[74:75], v[70:71]
    s_and_b64 s[82:83], s[54:55], s[80:81]
    s_cbranch_scc1 L2_c73
L2_d73:
    v_mov_b64 v[84:85], v[70:71]
    v_mov_b32 v7, v93
    v_mov_b64 v[86:87], v[74:75]
    s_or_b64 s[80:81], s[80:81], s[54:55]
    s_mov_b64 exec, s[50:51]
    s_and_b64 s[82:83], s[50:51], s[80:81]
    s_cbranch_scc1 L2_c74
L2_d74:
    v_mov_b64 v[84:85], v[68:69]
    v_mov_b32 v7, v92
    v_mov_b64 v[86:87], v[72:73]
    s_mov_b64 exec, -1
    s_or_b64 s[80:81], s[80:81], s[50:51]
    ds_read_b64 v[70:71], v95 offset:65408
    ds_read_b64 v[68:69], v94 offset:65408
    v_bitop3_b32 v92, v24, v5, v99 bitop3:0xea
    v_bitop3_b32 v93, v25, v5, v46 bitop3:0xea
    v_perm_b32 v15, v25, v26, s47
    v_bitop3_b32 v46, v25, 0.5, -0.5 bitop3:0xa8
    v_perm_b32 v14, v24, v26, s46
    v_bitop3_b32 v47, v24, 0.5, -0.5 bitop3:0xa8
    v_bitop3_b32 v15, v6, v15, v46 bitop3:0xca
    v_bitop3_b32 v14, v6, v14, v47 bitop3:0xca
    s_waitcnt lgkmcnt(1)
    v_mfma_f32_4x4x4_16b_bf16 v[80:83], v[10:11], v[70:71], v[80:83]
    s_waitcnt lgkmcnt(0)
    v_mfma_f32_4x4x4_16b_bf16 v[76:79], v[10:11], v[68:69], v[76:79]
    s_nop 2
    v_cvt_pk_bf16_f32 v80, v80, v81
    v_cvt_pk_bf16_f32 v81, v82, v83
    ds_wrxchg_rtn_b64 v[74:75], v95, v[80:81] offset:65408
    v_cvt_pk_bf16_f32 v76, v76, v77
    v_cvt_pk_bf16_f32 v77, v78, v79
    ds_wrxchg_rtn_b64 v[72:73], v94, v[76:77] offset:65408
    v_and_b32 v88, 0x0fffffff, v41
    v_mov_b32 v27, v41
    buffer_load_dwordx2 v[22:23], v88, s[8:11], 0 offen
    buffer_load_dwordx3 v[24:26], v88, s[8:11], 0 offen offset:8
    v_mfma_f32_4x4x4_16b_bf16 v[80:83], v[8:9], v[102:103], 0
    v_mfma_f32_4x4x4_16b_bf16 v[76:79], v[8:9], v[100:101], 0
    v_cmp_lt_u32 s[84:85], v5, v92
    s_nop 2
    v_pk_mul_f32 v[80:81], v[80:81], v[14:15] op_sel:[0,1] op_sel_hi:[1,1]
    v_pk_mul_f32 v[82:83], v[82:83], v[14:15] op_sel:[0,1] op_sel_hi:[1,1]
    v_pk_mul_f32 v[76:77], v[76:77], v[14:15] op_sel:[0,0] op_sel_hi:[1,0]
    v_pk_mul_f32 v[78:79], v[78:79], v[14:15] op_sel:[0,0] op_sel_hi:[1,0]
    s_waitcnt vmcnt(11)
    s_mov_b64 exec, s[6:7]
    v_lshrrev_b32 v30, 16, v30
    s_mov_b64 exec, -1
    v_and_b32 v46, 0x20000000, v31
    v_lshrrev_b32 v47, 14, v29
    v_bitop3_b32 v47, v47, v5, v46 bitop3:0xea
    ds_read_b64 v[106:107], v47
    v_and_b32 v99, 0x10000000, v31
    v_lshrrev_b32 v47, 14, v28
    v_bitop3_b32 v47, v47, v5, v99 bitop3:0xea
    ds_read_b64 v[104:105], v47
    s_waitcnt lgkmcnt(2)
    v_cmp_ne_u64 s[50:51], v[72:73], v[68:69]
    v_cmpx_ne_u64 s[54:55], v[74:75], v[70:71]
    s_and_b64 s[82:83], s[54:55], s[80:81]
    s_cbranch_scc1 L2_c75
L2_d75:
    v_mov_b64 v[84:85], v[70:71]
    v_mov_b32 v7, v95
    v_mov_b64 v[86:87], v[74:75]
    s_or_b64 s[80:81], s[80:81], s[54:55]
    s_mov_b64 exec, s[50:51]
    s_and_b64 s[82:83], s[50:51], s[80:81]
    s_cbranch_scc1 L2_c76
L2_d76:
    v_mov_b64 v[84:85], v[68:69]
    v_mov_b32 v7, v94
    v_mov_b64 v[86:87], v[72:73]
    s_mov_b64 exec, -1
    s_or_b64 s[80:81], s[80:81], s[50:51]
    s_and_b64 exec, s[84:85], s[80:81]
    v_mfma_f32_4x4x4_16b_bf16 v[76:79], v[12:13], v[84:85], 0
    v_mov_b32 v92, v7
    s_andn2_b64 s[80:81], s[80:81], s[84:85]
    v_mfma_f32_4x4x4_16b_bf16 v[76:79], v[10:11], v[86:87], v[76:79]
    s_mov_b64 exec, -1
    ds_read_b64 v[70:71], v93 offset:65408
    ds_read_b64 v[68:69], v92 offset:65408
    v_bitop3_b32 v94, v28, v5, v99 bitop3:0xea
    v_bitop3_b32 v95, v29, v5, v46 bitop3:0xea
    v_perm_b32 v15, v29, v30, s45
    v_bitop3_b32 v46, v29, 0.5, -0.5 bitop3:0xa8
    v_perm_b32 v14, v28, v30, s44
    v_bitop3_b32 v47, v28, 0.5, -0.5 bitop3:0xa8
    v_bitop3_b32 v15, v6, v15, v46 bitop3:0xca
    v_bitop3_b32 v14, v6, v14, v47 bitop3:0xca
    s_waitcnt lgkmcnt(1)
    v_mfma_f32_4x4x4_16b_bf16 v[80:83], v[10:11], v[70:71], v[80:83]
    s_waitcnt lgkmcnt(0)
    v_mfma_f32_4x4x4_16b_bf16 v[76:79], v[10:11], v[68:69], v[76:79]
    s_nop 2
    v_cvt_pk_bf16_f32 v80, v80, v81
    v_cvt_pk_bf16_f32 v81, v82, v83
    ds_wrxchg_rtn_b64 v[74:75], v93, v[80:81] offset:65408
    v_cvt_pk_bf16_f32 v76, v76, v77
    v_cvt_pk_bf16_f32 v77, v78, v79
    ds_wrxchg_rtn_b64 v[72:73], v92, v[76:77] offset:65408
    s_setprio 0
    v_mfma_f32_4x4x4_16b_bf16 v[80:83], v[8:9], v[106:107], 0
    v_mfma_f32_4x4x4_16b_bf16 v[76:79], v[8:9], v[104:105], 0
    v_cmp_lt_u32 s[48:49], v5, v95
    s_nop 2
    v_pk_mul_f32 v[80:81], v[80:81], v[14:15] op_sel:[0,1] op_sel_hi:[1,1]
    v_pk_mul_f32 v[82:83], v[82:83], v[14:15] op_sel:[0,1] op_sel_hi:[1,1]
    v_pk_mul_f32 v[76:77], v[76:77], v[14:15] op_sel:[0,0] op_sel_hi:[1,0]
    v_pk_mul_f32 v[78:79], v[78:79], v[14:15] op_sel:[0,0] op_sel_hi:[1,0]
    s_add_u32 s40, s40, 0x50000
    v_and_b32 v47, 0x0fffffff, v42
    v_mov_b32 v31, v42
    buffer_load_dword v30, v47, s[8:11], 0 offen offset:16
    s_mov_b64 exec, s[6:7]
    v_add_u32 v47, 8, v47
    v_lshrrev_b32 v31, 2, v31
    s_mov_b64 exec, -1
    buffer_load_dwordx2 v[28:29], v47, s[8:11], 0 offen
    s_waitcnt vmcnt(8)
    v_and_b32 v46, 0x80000000, v39
    v_lshrrev_b32 v47, 14, v37
    v_bitop3_b32 v47, v47, v5, v46 bitop3:0xea
    ds_read_b64 v[106:107], v47
    v_and_b32 v99, 0x40000000, v39
    v_lshrrev_b32 v47, 14, v36
    v_bitop3_b32 v47, v47, v5, v99 bitop3:0xea
    ds_read_b64 v[104:105], v47
    v_and_b32 v46, 0x20000000, v39
    v_lshrrev_b32 v47, 14, v35
    v_bitop3_b32 v47, v47, v5, v46 bitop3:0xea
    ds_read_b64 v[102:103], v47
    v_and_b32 v99, 0x10000000, v39
    v_lshrrev_b32 v47, 14, v34
    v_bitop3_b32 v47, v47, v5, v99 bitop3:0xea
    ds_read_b64 v[100:101], v47
    s_waitcnt lgkmcnt(4)
    v_cmp_ne_u64 s[50:51], v[72:73], v[68:69]
    v_cmpx_ne_u64 s[54:55], v[74:75], v[70:71]
    s_and_b64 s[82:83], s[54:55], s[80:81]
    s_cbranch_scc1 L2_c77
L2_d77:
    v_mov_b64 v[84:85], v[70:71]
    v_mov_b32 v7, v93
    v_mov_b64 v[86:87], v[74:75]
    s_or_b64 s[80:81], s[80:81], s[54:55]
    s_mov_b64 exec, s[50:51]
    s_and_b64 s[82:83], s[50:51], s[80:81]
    s_cbranch_scc1 L2_c78
L2_d78:
    v_mov_b64 v[84:85], v[68:69]
    v_mov_b32 v7, v92
    v_mov_b64 v[86:87], v[72:73]
    s_mov_b64 exec, -1
    s_or_b64 s[80:81], s[80:81], s[50:51]
    s_and_b64 exec, s[48:49], s[80:81]
    v_mfma_f32_4x4x4_16b_bf16 v[80:83], v[12:13], v[84:85], 0
    v_mov_b32 v95, v7
    s_andn2_b64 s[80:81], s[80:81], s[48:49]
    v_mfma_f32_4x4x4_16b_bf16 v[80:83], v[10:11], v[86:87], v[80:83]
    s_mov_b64 exec, -1
    ds_read_b64 v[70:71], v95 offset:65408
    ds_read_b64 v[68:69], v94 offset:65408
    v_bitop3_b32 v92, v34, v5, v99 bitop3:0xea
    v_bitop3_b32 v93, v35, v5, v46 bitop3:0xea
    v_perm_b32 v15, v35, v38, s45
    v_bitop3_b32 v46, v35, 0.5, -0.5 bitop3:0xa8
    v_perm_b32 v14, v34, v38, s44
    v_bitop3_b32 v47, v34, 0.5, -0.5 bitop3:0xa8
    v_bitop3_b32 v15, v6, v15, v46 bitop3:0xca
    v_bitop3_b32 v14, v6, v14, v47 bitop3:0xca
    s_waitcnt lgkmcnt(1)
    v_mfma_f32_4x4x4_16b_bf16 v[80:83], v[10:11], v[70:71], v[80:83]
    s_waitcnt lgkmcnt(0)
    v_mfma_f32_4x4x4_16b_bf16 v[76:79], v[10:11], v[68:69], v[76:79]
    s_nop 2
    v_cvt_pk_bf16_f32 v80, v80, v81
    v_cvt_pk_bf16_f32 v81, v82, v83
    ds_wrxchg_rtn_b64 v[74:75], v95, v[80:81] offset:65408
    v_cvt_pk_bf16_f32 v76, v76, v77
    v_cvt_pk_bf16_f32 v77, v78, v79
    ds_wrxchg_rtn_b64 v[72:73], v94, v[76:77] offset:65408
    s_barrier
    s_setprio 3
    s_mov_b32 m0, s100
    s_nop 0
    ds_write_addtid_b32 v124 offset:34816
    ds_write_addtid_b32 v125 offset:35072
    ds_write_addtid_b32 v126 offset:35328
    ds_write_addtid_b32 v127 offset:35584
    s_add_u32 s3, s40, 4096
    buffer_load_dwordx4 v[124:127], v3, s[16:19], s3 offen sc1
    ds_write_addtid_b32 v116 offset:32768
    ds_write_addtid_b32 v117 offset:33024
    ds_write_addtid_b32 v118 offset:33280
    ds_write_addtid_b32 v119 offset:33536
    buffer_load_dwordx4 v[116:119], v3, s[16:19], s40 offen offset:2048 sc1
    ds_write_addtid_b32 v120 offset:33792
    ds_write_addtid_b32 v121 offset:34048
    ds_write_addtid_b32 v122 offset:34304
    ds_write_addtid_b32 v123 offset:34560
    buffer_load_dwordx4 v[120:123], v3, s[16:19], s40 offen offset:3072 sc1
    v_mfma_f32_4x4x4_16b_bf16 v[80:83], v[8:9], v[102:103], 0
    v_mfma_f32_4x4x4_16b_bf16 v[76:79], v[8:9], v[100:101], 0
    s_nop 3
    v_pk_mul_f32 v[80:81], v[80:81], v[14:15] op_sel:[0,1] op_sel_hi:[1,1]
    v_pk_mul_f32 v[82:83], v[82:83], v[14:15] op_sel:[0,1] op_sel_hi:[1,1]
    v_pk_mul_f32 v[76:77], v[76:77], v[14:15] op_sel:[0,0] op_sel_hi:[1,0]
    v_pk_mul_f32 v[78:79], v[78:79], v[14:15] op_sel:[0,0] op_sel_hi:[1,0]
    v_mov_b32 v44, v43
    s_cmp_gt_u32 s37, 1024
    s_cbranch_scc1 L2_xs79
    s_cmp_lg_u32 s101, 0
    s_cbranch_scc1 L2_xa79
L2_xb79:
    v_lshlrev_b32 v89, 16, v96
    v_add_u32 v90, 60, v97
    v_bitop3_b32 v90, v89, v45, v90 bitop3:0x6a
    ds_write_b32 v98, v90 offset:12
    v_lshlrev_b32 v89, 20, v96
    v_add_u32 v90, 40, v97
    v_bitop3_b32 v90, v89, v45, v90 bitop3:0x6a
    ds_write_b32 v98, v90 offset:8
    v_lshlrev_b32 v89, 24, v96
    v_add_u32 v90, 20, v97
    v_bitop3_b32 v90, v89, v45, v90 bitop3:0x6a
    ds_write_b32 v98, v90 offset:4
    v_lshlrev_b32 v89, 28, v96
    v_bitop3_b32 v90, v89, v45, v97 bitop3:0x6a
    ds_write_b32 v98, v90 offset:0
    v_mov_b32_dpp v91, v66 quad_perm:[0,0,0,0] row_mask:0xf bank_mask:0xf
    v_and_b32 v89, 3, v91
    v_and_b32 v97, 0xfffc, v91
    v_sub_u16_dpp v88, v66, v91 quad_perm:[2,2,2,2] row_mask:0xf bank_mask:0xf
    v_mad_u32_u24 v97, v97, 5, v4
    v_add_u32 v99, v88, v89
    v_bfm_b32 v96, v88, v89
    v_cmp_lt_u32 s[58:59], 16, v99
    v_lshlrev_b32 v89, v1, v96
    v_and_b32 v89, v45, v89
    v_cmp_ne_u32 vcc, 0, v89
    v_xor_b32 v90, v97, v89
    s_add_u32 s3, s37, s38
    v_mbcnt_lo_u32_b32 v98, vcc_lo, 0
    v_mbcnt_hi_u32_b32 v98, vcc_hi, v98
    s_bcnt1_i32_b64 s41, vcc
    v_lshl_add_u32 v98, v98, 2, s3
    s_lshl2_add_u32 s37, s41, s37
    s_mov_b64 exec, vcc
    ds_write_b32 v98, v90
    s_mov_b64 exec, -1
    s_cmp_lg_u64 s[58:59], 0
    s_cbranch_scc1 L2_xe79
L2_xr79:
    v_add_u32 v98, s37, v0
    v_mov_b32 v90, -1
    ds_write_b32 v98, v90
    v_add_u32 v98, s38, v0
    ds_read2st64_b32 v[40:41], v0 offset0:0 offset1:1
    ds_read_b32 v43, v0 offset:512
    v_lshrrev_b32 v98, 1, v98
    v_and_b32 v98, -4, v98
    ds_read_b32 v42, v98 offset:768
    s_sub_u32 s3, s37, 768
    s_cmp_gt_u32 s3, 128
    s_cbranch_scc1 L2_xf79
L2_xg79:
    s_setprio 2
    s_waitcnt lgkmcnt(14)
    v_cmp_ne_u64 s[50:51], v[72:73], v[68:69]
    v_cmpx_ne_u64 s[54:55], v[74:75], v[70:71]
    s_and_b64 s[82:83], s[54:55], s[80:81]
    s_cbranch_scc1 L2_c80
L2_d80:
    v_mov_b64 v[84:85], v[70:71]
    v_mov_b32 v7, v95
    v_mov_b64 v[86:87], v[74:75]
    s_or_b64 s[80:81], s[80:81], s[54:55]
    s_mov_b64 exec, s[50:51]
    s_and_b64 s[82:83], s[50:51], s[80:81]
    s_cbranch_scc1 L2_c81
L2_d81:
    v_mov_b64 v[84:85], v[68:69]
    v_mov_b32 v7, v94
    v_mov_b64 v[86:87], v[72:73]
    s_mov_b64 exec, -1
    s_or_b64 s[80:81], s[80:81], s[50:51]
    ds_read_b64 v[70:71], v93 offset:65408
    ds_read_b64 v[68:69], v92 offset:65408
    v_and_b32 v46, 0x40000000, v39
    v_bitop3_b32 v94, v36, v5, v46 bitop3:0xea
    v_and_b32 v46, 0x80000000, v39
    v_bitop3_b32 v95, v37, v5, v46 bitop3:0xea
    v_perm_b32 v15, v37, v38, s47
    v_bitop3_b32 v46, v37, 0.5, -0.5 bitop3:0xa8
    v_perm_b32 v14, v36, v38, s46
    v_bitop3_b32 v47, v36, 0.5, -0.5 bitop3:0xa8
    v_bitop3_b32 v15, v6, v15, v46 bitop3:0xca
    v_bitop3_b32 v14, v6, v14, v47 bitop3:0xca
    s_setprio 1
    s_waitcnt lgkmcnt(1)
    v_mfma_f32_4x4x4_16b_bf16 v[80:83], v[10:11], v[70:71], v[80:83]
    s_waitcnt lgkmcnt(0)
    v_mfma_f32_4x4x4_16b_bf16 v[76:79], v[10:11], v[68:69], v[76:79]
    s_nop 2
    v_cvt_pk_bf16_f32 v80, v80, v81
    v_cvt_pk_bf16_f32 v81, v82, v83
    ds_wrxchg_rtn_b64 v[74:75], v93, v[80:81] offset:65408
    v_cvt_pk_bf16_f32 v76, v76, v77
    v_cvt_pk_bf16_f32 v77, v78, v79
    ds_wrxchg_rtn_b64 v[72:73], v92, v[76:77] offset:65408
    v_and_b32 v88, 0x0fffffff, v44
    v_mov_b32 v39, v44
    buffer_load_dwordx2 v[34:35], v88, s[8:11], 0 offen
    buffer_load_dwordx3 v[36:38], v88, s[8:11], 0 offen offset:8
    s_setprio 0
    s_waitcnt vmcnt(12)
    s_mov_b32 m0, s38
    s_nop 0
    ds_write_addtid_b32 v108 offset:0
    ds_write_addtid_b32 v109 offset:256
    ds_write_addtid_b32 v110 offset:512
    ds_write_addtid_b32 v111 offset:768
    s_waitcnt vmcnt(9)
    ds_write_addtid_b32 v112 offset:1024
    ds_write_addtid_b32 v113 offset:1280
    ds_write_addtid_b32 v114 offset:1536
    ds_write_addtid_b32 v115 offset:1792
    v_mfma_f32_4x4x4_16b_bf16 v[80:83], v[8:9], v[106:107], 0
    v_mfma_f32_4x4x4_16b_bf16 v[76:79], v[8:9], v[104:105], 0
    v_cmp_lt_u32 s[84:85], v5, v94
    s_nop 2
    v_pk_mul_f32 v[80:81], v[80:81], v[14:15] op_sel:[0,1] op_sel_hi:[1,1]
    v_pk_mul_f32 v[82:83], v[82:83], v[14:15] op_sel:[0,1] op_sel_hi:[1,1]
    v_pk_mul_f32 v[76:77], v[76:77], v[14:15] op_sel:[0,0] op_sel_hi:[1,0]
    v_pk_mul_f32 v[78:79], v[78:79], v[14:15] op_sel:[0,0] op_sel_hi:[1,0]
    s_add_u32 s42, s42, 1
    s_waitcnt lgkmcnt(0)
    s_barrier
    s_bitcmp1_b32 s36, s42
    s_cbranch_scc1 L2_slow
L2_ret4:
    s_setprio 3
    s_bitcmp1_b32 s43, s42
    s_cbranch_scc1 L2_oa82
L2_ob82:
    v_and_b32 v46, 0x20000000, v21
    v_lshrrev_b32 v47, 14, v17
    v_bitop3_b32 v47, v47, v5, v46 bitop3:0xea
    ds_read_b64 v[102:103], v47
    v_and_b32 v99, 0x10000000, v21
    v_lshrrev_b32 v47, 14, v16
    v_bitop3_b32 v47, v47, v5, v99 bitop3:0xea
    ds_read_b64 v[100:101], v47
    v_cmp_ne_u64 s[50:51], v[72:73], v[68:69]
    v_cmpx_ne_u64 s[54:55], v[74:75], v[70:71]
    s_and_b64 s[82:83], s[54:55], s[80:81]
    s_cbranch_scc1 L2_c83
L2_d83:
    v_mov_b64 v[84:85], v[70:71]
    v_mov_b32 v7, v93
    v_mov_b64 v[86:87], v[74:75]
    s_or_b64 s[80:81], s[80:81], s[54:55]
    s_mov_b64 exec, s[50:51]
    s_and_b64 s[82:83], s[50:51], s[80:81]
    s_cbranch_scc1 L2_c84
L2_d84:
    v_mov_b64 v[84:85], v[68:69]
    v_mov_b32 v7, v92
    v_mov_b64 v[86:87], v[72:73]
    s_mov_b64 exec, -1
    s_or_b64 s[80:81], s[80:81], s[50:51]
    s_and_b64 exec, s[84:85], s[80:81]
    v_mfma_f32_4x4x4_16b_bf16 v[76:79], v[12:13], v[84:85], 0
    v_mov_b32 v94, v7
    s_andn2_b64 s[80:81], s[80:81], s[84:85]
    v_mfma_f32_4x4x4_16b_bf16 v[76:79], v[10:11], v[86:87], v[76:79]
    s_mov_b64 exec, -1
    ds_read_b64 v[70:71], v95 offset:65408
    ds_read_b64 v[68:69], v94 offset:65408
    v_bitop3_b32 v92, v16, v5, v99 bitop3:0xea
    v_bitop3_b32 v93, v17, v5, v46 bitop3:0xea
    v_perm_b32 v15, v17, v20, s45
    v_bitop3_b32 v46, v17, 0.5, -0.5 bitop3:0xa8
    v_perm_b32 v14, v16, v20, s44
    v_bitop3_b32 v47, v16, 0.5, -0.5 bitop3:0xa8
    v_bitop3_b32 v15, v6, v15, v46 bitop3:0xca
    v_bitop3_b32 v14, v6, v14, v47 bitop3:0xca
    s_waitcnt lgkmcnt(1)
    v_mfma_f32_4x4x4_16b_bf16 v[80:83], v[10:11], v[70:71], v[80:83]
    s_waitcnt lgkmcnt(0)
    v_mfma_f32_4x4x4_16b_bf16 v[76:79], v[10:11], v[68:69], v[76:79]
    s_nop 2
    v_cvt_pk_bf16_f32 v80, v80, v81
    v_cvt_pk_bf16_f32 v81, v82, v83
    ds_wrxchg_rtn_b64 v[74:75], v95, v[80:81] offset:65408
    v_cvt_pk_bf16_f32 v76, v76, v77
    v_cvt_pk_bf16_f32 v77, v78, v79
    ds_wrxchg_rtn_b64 v[72:73], v94, v[76:77] offset:65408
    v_mfma_f32_4x4x4_16b_bf16 v[80:83], v[8:9], v[102:103], 0
    v_mfma_f32_4x4x4_16b_bf16 v[76:79], v[8:9], v[100:101], 0
    v_cmp_lt_u32 s[84:85], v5, v92
    s_nop 2
    v_pk_mul_f32 v[80:81], v[80:81], v[14:15] op_sel:[0,1] op_sel_hi:[1,1]
    v_pk_mul_f32 v[82:83], v[82:83], v[14:15] op_sel:[0,1] op_sel_hi:[1,1]
    v_pk_mul_f32 v[76:77], v[76:77], v[14:15] op_sel:[0,0] op_sel_hi:[1,0]
    v_pk_mul_f32 v[78:79], v[78:79], v[14:15] op_sel:[0,0] op_sel_hi:[1,0]
    buffer_load_dwordx4 v[108:111], v3, s[16:19], s40 offen offset:0 sc1
    v_and_b32 v46, 0x80000000, v21
    v_lshrrev_b32 v47, 14, v19
    v_bitop3_b32 v47, v47, v5, v46 bitop3:0xea
    ds_read_b64 v[106:107], v47
    v_and_b32 v99, 0x40000000, v21
    v_lshrrev_b32 v47, 14, v18
    v_bitop3_b32 v47, v47, v5, v99 bitop3:0xea
    ds_read_b64 v[104:105], v47
    s_waitcnt lgkmcnt(2)
    v_cmp_ne_u64 s[50:51], v[72:73], v[68:69]
    v_cmpx_ne_u64 s[54:55], v[74:75], v[70:71]
    s_and_b64 s[82:83], s[54:55], s[80:81]
    s_cbranch_scc1 L2_c85
L2_d85:
    v_mov_b64 v[84:85], v[70:71]
    v_mov_b32 v7, v95
    v_mov_b64 v[86:87], v[74:75]
    s_or_b64 s[80:81], s[80:81], s[54:55]
    s_mov_b64 exec, s[50:51]
    s_and_b64 s[82:83], s[50:51], s[80:81]
    s_cbranch_scc1 L2_c86
L2_d86:
    v_mov_b64 v[84:85], v[68:69]
    v_mov_b32 v7, v94
    v_mov_b64 v[86:87], v[72:73]
    s_mov_b64 exec, -1
    s_or_b64 s[80:81], s[80:81], s[50:51]
    s_and_b64 exec, s[84:85], s[80:81]
    v_mfma_f32_4x4x4_16b_bf16 v[76:79], v[12:13], v[84:85], 0
    v_mov_b32 v92, v7
    s_andn2_b64 s[80:81], s[80:81], s[84:85]
    v_mfma_f32_4x4x4_16b_bf16 v[76:79], v[10:11], v[86:87], v[76:79]
    s_mov_b64 exec, -1
    ds_read_b64 v[70:71], v93 offset:65408
    ds_read_b64 v[68:69], v92 offset:65408
    v_bitop3_b32 v94, v18, v5, v99 bitop3:0xea
    v_bitop3_b32 v95, v19, v5, v46 bitop3:0xea
    v_perm_b32 v15, v19, v20, s47
    v_bitop3_b32 v46, v19, 0.5, -0.5 bitop3:0xa8
    v_perm_b32 v14, v18, v20, s46
    v_bitop3_b32 v47, v18, 0.5, -0.5 bitop3:0xa8
    v_bitop3_b32 v15, v6, v15, v46 bitop3:0xca
    v_bitop3_b32 v14, v6, v14, v47 bitop3:0xca
    s_waitcnt lgkmcnt(1)
    v_mfma_f32_4x4x4_16b_bf16 v[80:83], v[10:11], v[70:71], v[80:83]
    s_waitcnt lgkmcnt(0)
    v_mfma_f32_4x4x4_16b_bf16 v[76:79], v[10:11], v[68:69], v[76:79]
    s_nop 2
    v_cvt_pk_bf16_f32 v80, v80, v81
    v_cvt_pk_bf16_f32 v81, v82, v83
    ds_wrxchg_rtn_b64 v[74:75], v93, v[80:81] offset:65408
    v_cvt_pk_bf16_f32 v76, v76, v77
    v_cvt_pk_bf16_f32 v77, v78, v79
    ds_wrxchg_rtn_b64 v[72:73], v92, v[76:77] offset:65408
    v_and_b32 v88, 0x0fffffff, v40
    v_mov_b32 v21, v40
    buffer_load_dwordx2 v[16:17], v88, s[8:11], 0 offen
    buffer_load_dwordx3 v[18:20], v88, s[8:11], 0 offen offset:8
    s_setprio 2
    v_mfma_f32_4x4x4_16b_bf16 v[80:83], v[8:9], v[106:107], 0
    v_mfma_f32_4x4x4_16b_bf16 v[76:79], v[8:9], v[104:105], 0
    v_cmp_lt_u32 s[48:49], v5, v95
    s_nop 2
    v_pk_mul_f32 v[80:81], v[80:81], v[14:15] op_sel:[0,1] op_sel_hi:[1,1]
    v_pk_mul_f32 v[82:83], v[82:83], v[14:15] op_sel:[0,1] op_sel_hi:[1,1]
    v_pk_mul_f32 v[76:77], v[76:77], v[14:15] op_sel:[0,0] op_sel_hi:[1,0]
    v_pk_mul_f32 v[78:79], v[78:79], v[14:15] op_sel:[0,0] op_sel_hi:[1,0]
    s_waitcnt vmcnt(10)
    v_and_b32 v46, 0x20000000, v27
    v_lshrrev_b32 v47, 14, v23
    v_bitop3_b32 v47, v47, v5, v46 bitop3:0xea
    ds_read_b64 v[102:103], v47
    v_and_b32 v99, 0x10000000, v27
    v_lshrrev_b32 v47, 14, v22
    v_bitop3_b32 v47, v47, v5, v99 bitop3:0xea
    ds_read_b64 v[100:101], v47
    s_waitcnt lgkmcnt(2)
    v_cmp_ne_u64 s[50:51], v[72:73], v[68:69]
    v_cmpx_ne_u64 s[54:55], v[74:75], v[70:71]
    s_and_b64 s[82:83], s[54:55], s[80:81]
    s_cbranch_scc1 L2_c87
L2_d87:
    v_mov_b64 v[84:85], v[70:71]
    v_mov_b32 v7, v93
    v_mov_b64 v[86:87], v[74:75]
    s_or_b64 s[80:81], s[80:81], s[54:55]
    s_mov_b64 exec, s[50:51]
    s_and_b64 s[82:83], s[50:51], s[80:81]
    s_cbranch_scc1 L2_c88
L2_d88:
    v_mov_b64 v[84:85], v[68:69]
    v_mov_b32 v7, v92
    v_mov_b64 v[86:87], v[72:73]
    s_mov_b64 exec, -1
    s_or_b64 s[80:81], s[80:81], s[50:51]
    s_and_b64 exec, s[48:49], s[80:81]
    v_mfma_f32_4x4x4_16b_bf16 v[80:83], v[12:13], v[84:85], 0
    v_mov_b32 v95, v7
    s_andn2_b64 s[80:81], s[80:81], s[48:49]
    v_mfma_f32_4x4x4_16b_bf16 v[80:83], v[10:11], v[86:87], v[80:83]
    s_mov_b64 exec, -1
    ds_read_b64 v[70:71], v95 offset:65408
    ds_read_b64 v[68:69], v94 offset:65408
    v_bitop3_b32 v92, v22, v5, v99 bitop3:0xea
    v_bitop3_b32 v93, v23, v5, v46 bitop3:0xea
    v_perm_b32 v15, v23, v26, s45
    v_bitop3_b32 v46, v23, 0.5, -0.5 bitop3:0xa8
    v_perm_b32 v14, v22, v26, s44
    v_bitop3_b32 v47, v22, 0.5, -0.5 bitop3:0xa8
    v_bitop3_b32 v15, v6, v15, v46 bitop3:0xca
    v_bitop3_b32 v14, v6, v14, v47 bitop3:0xca
    s_waitcnt lgkmcnt(1)
    v_mfma_f32_4x4x4_16b_bf16 v[80:83], v[10:11], v[70:71], v[80:83]
    s_waitcnt lgkmcnt(0)
    v_mfma_f32_4x4x4_16b_bf16 v[76:79], v[10:11], v[68:69], v[76:79]
    s_nop 2
    v_cvt_pk_bf16_f32 v80, v80, v81
    v_cvt_pk_bf16_f32 v81, v82, v83
    ds_wrxchg_rtn_b64 v[74:75], v95, v[80:81] offset:65408
    v_cvt_pk_bf16_f32 v76, v76, v77
    v_cvt_pk_bf16_f32 v77, v78, v79
    ds_wrxchg_rtn_b64 v[72:73], v94, v[76:77] offset:65408
    s_setprio 1
    v_mfma_f32_4x4x4_16b_bf16 v[80:83], v[8:9], v[102:103], 0
    v_mfma_f32_4x4x4_16b_bf16 v[76:79], v[8:9], v[100:101], 0
    s_nop 3
    v_pk_mul_f32 v[80:81], v[80:81], v[14:15] op_sel:[0,1] op_sel_hi:[1,1]
    v_pk_mul_f32 v[82:83], v[82:83], v[14:15] op_sel:[0,1] op_sel_hi:[1,1]
    v_pk_mul_f32 v[76:77], v[76:77], v[14:15] op_sel:[0,0] op_sel_hi:[1,0]
    v_pk_mul_f32 v[78:79], v[78:79], v[14:15] op_sel:[0,0] op_sel_hi:[1,0]
    s_bitcmp1_b32 s43, s42
    s_cbranch_scc1 L2_oa89
L2_ob89:
    buffer_load_dwordx4 v[112:115], v3, s[16:19], s40 offen offset:1024 sc1
    v_sub_u16 v88, v60, v52
    v_and_b32 v89, 3, v52
    v_add3_u32 v99, v88, v89, 3
    v_and_b32 v99, -4, v99
    v_max_u32 v99, 4, v99
    v_and_b32 v97, 0xfffc, v52
    v_bfm_b32 v96, v88, v89
    v_add_u32_dpp v91, v99, v99 row_shr:1 row_mask:0xf bank_mask:0xf bound_ctrl:1
    v_mad_u32_u24 v97, v97, 5, v2
    v_cmp_lt_u32 vcc, 16, v99
    v_add_u32_dpp v91, v91, v91 row_shr:2 row_mask:0xf bank_mask:0xf bound_ctrl:1
    v_sub_u32 v98, s38, v99
    v_lshrrev_b64 v[52:53], 16, v[52:53]
    v_add_u32_dpp v91, v91, v91 row_shr:4 row_mask:0xf bank_mask:0xf bound_ctrl:1
    v_lshrrev_b64 v[60:61], 16, v[60:61]
    s_mov_b32 s101, 0
    v_add_u32_dpp v91, v91, v91 row_shr:8 row_mask:0xf bank_mask:0xf bound_ctrl:1
    s_nop 1
    v_add_u32_dpp v91, v91, v91 row_bcast:15 row_mask:0xa bank_mask:0xf
    s_nop 1
    v_add_u32_dpp v91, v91, v91 row_bcast:31 row_mask:0xc bank_mask:0xf
    v_add_u32 v98, v98, v91
    v_readlane_b32 s37, v91, 63
    s_cbranch_vccnz L2_xo90
L2_xp90:
    v_and_b32 v46, 0x80000000, v27
    v_lshrrev_b32 v47, 14, v25
    v_bitop3_b32 v47, v47, v5, v46 bitop3:0xea
    ds_read_b64 v[106:107], v47
    v_and_b32 v99, 0x40000000, v27
    v_lshrrev_b32 v47, 14, v24
    v_bitop3_b32 v47, v47, v5, v99 bitop3:0xea
    ds_read_b64 v[104:105], v47
    s_waitcnt lgkmcnt(2)
    v_cmp_ne_u64 s[50:51], v[72:73], v[68:69]
    v_cmpx_ne_u64 s[54:55], v[74:75], v[70:71]
    s_and_b64 s[82:83], s[54:55], s[80:81]
    s_cbranch_scc1 L2_c91
L2_d91:
    v_mov_b64 v[84:85], v[70:71]
    v_mov_b32 v7, v95
    v_mov_b64 v[86:87], v[74:75]
    s_or_b64 s[80:81], s[80:81], s[54:55]
    s_mov_b64 exec, s[50:51]
    s_and_b64 s[82:83], s[50:51], s[80:81]
    s_cbranch_scc1 L2_c92
L2_d92:
    v_mov_b64 v[84:85], v[68:69]
    v_mov_b32 v7, v94
    v_mov_b64 v[86:87], v[72:73]
    s_mov_b64 exec, -1
    s_or_b64 s[80:81], s[80:81], s[50:51]
    ds_read_b64 v[70:71], v93 offset:65408
    ds_read_b64 v[68:69], v92 offset:65408
    v_bitop3_b32 v94, v24, v5, v99 bitop3:0xea
    v_bitop3_b32 v95, v25, v5, v46 bitop3:0xea
    v_perm_b32 v15, v25, v26, s47
    v_bitop3_b32 v46, v25, 0.5, -0.5 bitop3:0xa8
    v_perm_b32 v14, v24, v26, s46
    v_bitop3_b32 v47, v24, 0.5, -0.5 bitop3:0xa8
    v_bitop3_b32 v15, v6, v15, v46 bitop3:0xca
    v_bitop3_b32 v14, v6, v14, v47 bitop3:0xca
    s_waitcnt lgkmcnt(1)
    v_mfma_f32_4x4x4_16b_bf16 v[80:83], v[10:11], v[70:71], v[80:83]
    s_waitcnt lgkmcnt(0)
    v_mfma_f32_4x4x4_16b_bf16 v[76:79], v[10:11], v[68:69], v[76:79]
    s_nop 2
    v_cvt_pk_bf16_f32 v80, v80, v81
    v_cvt_pk_bf16_f32 v81, v82, v83
    ds_wrxchg_rtn_b64 v[74:75], v93, v[80:81] offset:65408
    v_cvt_pk_bf16_f32 v76, v76, v77
    v_cvt_pk_bf16_f32 v77, v78, v79
    ds_wrxchg_rtn_b64 v[72:73], v92, v[76:77] offset:65408
    v_and_b32 v88, 0x0fffffff, v41
    v_mov_b32 v27, v41
    buffer_load_dwordx2 v[22:23], v88, s[8:11], 0 offen
    buffer_load_dwordx3 v[24:26], v88, s[8:11], 0 offen offset:8
    v_mfma_f32_4x4x4_16b_bf16 v[80:83], v[8:9], v[106:107], 0
    v_mfma_f32_4x4x4_16b_bf16 v[76:79], v[8:9], v[104:105], 0
    v_cmp_lt_u32 s[84:85], v5, v94
    s_nop 2
    v_pk_mul_f32 v[80:81], v[80:81], v[14:15] op_sel:[0,1] op_sel_hi:[1,1]
    v_pk_mul_f32 v[82:83], v[82:83], v[14:15] op_sel:[0,1] op_sel_hi:[1,1]
    v_pk_mul_f32 v[76:77], v[76:77], v[14:15] op_sel:[0,0] op_sel_hi:[1,0]
    v_pk_mul_f32 v[78:79], v[78:79], v[14:15] op_sel:[0,0] op_sel_hi:[1,0]
    s_waitcnt vmcnt(11)
    s_mov_b64 exec, s[6:7]
    v_lshrrev_b32 v30, 16, v30
    s_mov_b64 exec, -1
    v_and_b32 v46, 0x20000000, v31
    v_lshrrev_b32 v47, 14, v29
    v_bitop3_b32 v47, v47, v5, v46 bitop3:0xea
    ds_read_b64 v[102:103], v47
    v_and_b32 v99, 0x10000000, v31
    v_lshrrev_b32 v47, 14, v28
    v_bitop3_b32 v47, v47, v5, v99 bitop3:0xea
    ds_read_b64 v[100:101], v47
    s_waitcnt lgkmcnt(2)
    v_cmp_ne_u64 s[50:51], v[72:73], v[68:69]
    v_cmpx_ne_u64 s[54:55], v[74:75], v[70:71]
    s_and_b64 s[82:83], s[54:55], s[80:81]
    s_cbranch_scc1 L2_c93
L2_d93:
    v_mov_b64 v[84:85], v[70:71]
    v_mov_b32 v7, v93
    v_mov_b64 v[86:87], v[74:75]
    s_or_b64 s[80:81], s[80:81], s[54:55]
    s_mov_b64 exec, s[50:51]
    s_and_b64 s[82:83], s[50:51], s[80:81]
    s_cbranch_scc1 L2_c94
L2_d94:
    v_mov_b64 v[84:85], v[68:69]
    v_mov_b32 v7, v92
    v_mov_b64 v[86:87], v[72:73]
    s_mov_b64 exec, -1
    s_or_b64 s[80:81], s[80:81], s[50:51]
    s_and_b64 exec, s[84:85], s[80:81]
    v_mfma_f32_4x4x4_16b_bf16 v[76:79], v[12:13], v[84:85], 0
    v_mov_b32 v94, v7
    s_andn2_b64 s[80:81], s[80:81], s[84:85]
    v_mfma_f32_4x4x4_16b_bf16 v[76:79], v[10:11], v[86:87], v[76:79]
    s_mov_b64 exec, -1
    ds_read_b64 v[70:71], v95 offset:65408
    ds_read_b64 v[68:69], v94 offset:65408
    v_bitop3_b32 v92, v28, v5, v99 bitop3:0xea
    v_bitop3_b32 v93, v29, v5, v46 bitop3:0xea
    v_perm_b32 v15, v29, v30, s45
    v_bitop3_b32 v46, v29, 0.5, -0.5 bitop3:0xa8
    v_perm_b32 v14, v28, v30, s44
    v_bitop3_b32 v47, v28, 0.5, -0.5 bitop3:0xa8
    v_bitop3_b32 v15, v6, v15, v46 bitop3:0xca
    v_bitop3_b32 v14, v6, v14, v47 bitop3:0xca
    s_waitcnt lgkmcnt(1)
    v_mfma_f32_4x4x4_16b_bf16 v[80:83], v[10:11], v[70:71], v[80:83]
    s_waitcnt lgkmcnt(0)
    v_mfma_f32_4x4x4_16b_bf16 v[76:79], v[10:11], v[68:69], v[76:79]
    s_nop 2
    v_cvt_pk_bf16_f32 v80, v80, v81
    v_cvt_pk_bf16_f32 v81, v82, v83
    ds_wrxchg_rtn_b64 v[74:75], v95, v[80:81] offset:65408
    v_cvt_pk_bf16_f32 v76, v76, v77
    v_cvt_pk_bf16_f32 v77, v78, v79
    ds_wrxchg_rtn_b64 v[72:73], v94, v[76:77] offset:65408
    s_setprio 0
    v_mfma_f32_4x4x4_16b_bf16 v[80:83], v[8:9], v[102:103], 0
    v_mfma_f32_4x4x4_16b_bf16 v[76:79], v[8:9], v[100:101], 0
    v_cmp_lt_u32 s[48:49], v5, v93
    s_nop 2
    v_pk_mul_f32 v[80:81], v[80:81], v[14:15] op_sel:[0,1] op_sel_hi:[1,1]
    v_pk_mul_f32 v[82:83], v[82:83], v[14:15] op_sel:[0,1] op_sel_hi:[1,1]
    v_pk_mul_f32 v[76:77], v[76:77], v[14:15] op_sel:[0,0] op_sel_hi:[1,0]
    v_pk_mul_f32 v[78:79], v[78:79], v[14:15] op_sel:[0,0] op_sel_hi:[1,0]
    s_add_u32 s40, s40, 0x50000
    v_and_b32 v47, 0x0fffffff, v42
    v_mov_b32 v31, v42
    buffer_load_dword v30, v47, s[8:11], 0 offen offset:16
    s_mov_b64 exec, s[6:7]
    v_add_u32 v47, 8, v47
    v_lshrrev_b32 v31, 2, v31
    s_mov_b64 exec, -1
    buffer_load_dwordx2 v[28:29], v47, s[8:11], 0 offen
    s_waitcnt vmcnt(8)
    v_and_b32 v46, 0x80000000, v39
    v_lshrrev_b32 v47, 14, v37
    v_bitop3_b32 v47, v47, v5, v46 bitop3:0xea
    ds_read_b64 v[102:103], v47
    v_and_b32 v99, 0x40000000, v39
    v_lshrrev_b32 v47, 14, v36
    v_bitop3_b32 v47, v47, v5, v99 bitop3:0xea
    ds_read_b64 v[100:101], v47
    v_and_b32 v46, 0x20000000, v39
    v_lshrrev_b32 v47, 14, v35
    v_bitop3_b32 v47, v47, v5, v46 bitop3:0xea
    ds_read_b64 v[106:107], v47
    v_and_b32 v99, 0x10000000, v39
    v_lshrrev_b32 v47, 14, v34
    v_bitop3_b32 v47, v47, v5, v99 bitop3:0xea
    ds_read_b64 v[104:105], v47
    s_waitcnt lgkmcnt(4)
    v_cmp_ne_u64 s[50:51], v[72:73], v[68:69]
    v_cmpx_ne_u64 s[54:55], v[74:75], v[70:71]
    s_and_b64 s[82:83], s[54:55], s[80:81]
    s_cbranch_scc1 L2_c95
L2_d95:
    v_mov_b64 v[84:85], v[70:71]
    v_mov_b32 v7, v95
    v_mov_b64 v[86:87], v[74:75]
    s_or_b64 s[80:81], s[80:81], s[54:55]
    s_mov_b64 exec, s[50:51]
    s_and_b64 s[82:83], s[50:51], s[80:81]
    s_cbranch_scc1 L2_c96
L2_d96:
    v_mov_b64 v[84:85], v[68:69]
    v_mov_b32 v7, v94
    v_mov_b64 v[86:87], v[72:73]
    s_mov_b64 exec, -1
    s_or_b64 s[80:81], s[80:81], s[50:51]
    s_and_b64 exec, s[48:49], s[80:81]
    v_mfma_f32_4x4x4_16b_bf16 v[80:83], v[12:13], v[84:85], 0
    v_mov_b32 v93, v7
    s_andn2_b64 s[80:81], s[80:81], s[48:49]
    v_mfma_f32_4x4x4_16b_bf16 v[80:83], v[10:11], v[86:87], v[80:83]
    s_mov_b64 exec, -1
    ds_read_b64 v[70:71], v93 offset:65408
    ds_read_b64 v[68:69], v92 offset:65408
    v_bitop3_b32 v94, v34, v5, v99 bitop3:0xea
    v_bitop3_b32 v95, v35, v5, v46 bitop3:0xea
    v_perm_b32 v15, v35, v38, s45
    v_bitop3_b32 v46, v35, 0.5, -0.5 bitop3:0xa8
    v_perm_b32 v14, v34, v38, s44
    v_bitop3_b32 v47, v34, 0.5, -0.5 bitop3:0xa8
    v_bitop3_b32 v15, v6, v15, v46 bitop3:0xca
    v_bitop3_b32 v14, v6, v14, v47 bitop3:0xca
    s_waitcnt lgkmcnt(1)
    v_mfma_f32_4x4x4_16b_bf16 v[80:83], v[10:11], v[70:71], v[80:83]
    s_waitcnt lgkmcnt(0)
    v_mfma_f32_4x4x4_16b_bf16 v[76:79], v[10:11], v[68:69], v[76:79]
    s_nop 2
    v_cvt_pk_bf16_f32 v80, v80, v81
    v_cvt_pk_bf16_f32 v81, v82, v83
    ds_wrxchg_rtn_b64 v[74:75], v93, v[80:81] offset:65408
    v_cvt_pk_bf16_f32 v76, v76, v77
    v_cvt_pk_bf16_f32 v77, v78, v79
    ds_wrxchg_rtn_b64 v[72:73], v92, v[76:77] offset:65408
    s_barrier
    s_setprio 3
    s_mov_b32 m0, s100
    s_nop 0
    ds_write_addtid_b32 v124 offset:34816
    ds_write_addtid_b32 v125 offset:35072
    ds_write_addtid_b32 v126 offset:35328
    ds_write_addtid_b32 v127 offset:35584
    s_add_u32 s3, s40, 4096
    buffer_load_dwordx4 v[124:127], v3, s[16:19], s3 offen sc1
    ds_write_addtid_b32 v116 offset:32768
    ds_write_addtid_b32 v117 offset:33024
    ds_write_addtid_b32 v118 offset:33280
    ds_write_addtid_b32 v119 offset:33536
    buffer_load_dwordx4 v[116:119], v3, s[16:19], s40 offen offset:2048 sc1
    ds_write_addtid_b32 v120 offset:33792
    ds_write_addtid_b32 v121 offset:34048
    ds_write_addtid_b32 v122 offset:34304
    ds_write_addtid_b32 v123 offset:34560
    buffer_load_dwordx4 v[120:123], v3, s[16:19], s40 offen offset:3072 sc1
    v_mfma_f32_4x4x4_16b_bf16 v[80:83], v[8:9], v[106:107], 0
    v_mfma_f32_4x4x4_16b_bf16 v[76:79], v[8:9], v[104:105], 0
    s_nop 3
    v_pk_mul_f32 v[80:81], v[80:81], v[14:15] op_sel:[0,1] op_sel_hi:[1,1]
    v_pk_mul_f32 v[82:83], v[82:83], v[14:15] op_sel:[0,1] op_sel_hi:[1,1]
    v_pk_mul_f32 v[76:77], v[76:77], v[14:15] op_sel:[0,0] op_sel_hi:[1,0]
    v_pk_mul_f32 v[78:79], v[78:79], v[14:15] op_sel:[0,0] op_sel_hi:[1,0]
    v_mov_b32 v44, v43
    s_cmp_gt_u32 s37, 1024
    s_cbranch_scc1 L2_xs97
    s_cmp_lg_u32 s101, 0
    s_cbranch_scc1 L2_xa97
L2_xb97:
    v_lshlrev_b32 v89, 16, v96
    v_add_u32 v90, 60, v97
    v_bitop3_b32 v90, v89, v45, v90 bitop3:0x6a
    ds_write_b32 v98, v90 offset:12
    v_lshlrev_b32 v89, 20, v96
    v_add_u32 v90, 40, v97
    v_bitop3_b32 v90, v89, v45, v90 bitop3:0x6a
    ds_write_b32 v98, v90 offset:8
    v_lshlrev_b32 v89, 24, v96
    v_add_u32 v90, 20, v97
    v_bitop3_b32 v90, v89, v45, v90 bitop3:0x6a
    ds_write_b32 v98, v90 offset:4
    v_lshlrev_b32 v89, 28, v96
    v_bitop3_b32 v90, v89, v45, v97 bitop3:0x6a
    ds_write_b32 v98, v90 offset:0
    v_mov_b32_dpp v91, v64 quad_perm:[1,1,1,1] row_mask:0xf bank_mask:0xf
    v_and_b32 v89, 3, v91
    v_and_b32 v97, 0xfffc, v91
    v_sub_u16_dpp v88, v64, v91 quad_perm:[3,3,3,3] row_mask:0xf bank_mask:0xf
    v_mad_u32_u24 v97, v97, 5, v4
    v_add_u32 v99, v88, v89
    v_bfm_b32 v96, v88, v89
    v_cmp_lt_u32 s[58:59], 16, v99
    v_lshlrev_b32 v89, v1, v96
    v_and_b32 v89, v45, v89
    v_cmp_ne_u32 vcc, 0, v89
    v_xor_b32 v90, v97, v89
    s_add_u32 s3, s37, s38
    v_mbcnt_lo_u32_b32 v98, vcc_lo, 0
    v_mbcnt_hi_u32_b32 v98, vcc_hi, v98
    s_bcnt1_i32_b64 s41, vcc
    v_lshl_add_u32 v98, v98, 2, s3
    s_lshl2_add_u32 s37, s41, s37
    s_mov_b64 exec, vcc
    ds_write_b32 v98, v90
    s_mov_b64 exec, -1
    s_cmp_lg_u64 s[58:59], 0
    s_cbranch_scc1 L2_xe97
L2_xr97:
    v_add_u32 v98, s37, v0
    v_mov_b32 v90, -1
    ds_write_b32 v98, v90
    v_add_u32 v98, s38, v0
    ds_read2st64_b32 v[40:41], v0 offset0:0 offset1:1
    ds_read_b32 v43, v0 offset:512
    v_lshrrev_b32 v98, 1, v98
    v_and_b32 v98, -4, v98
    ds_read_b32 v42, v98 offset:768
    s_sub_u32 s3, s37, 768
    s_cmp_gt_u32 s3, 128
    s_cbranch_scc1 L2_xf97
L2_xg97:
    s_setprio 2
    s_waitcnt lgkmcnt(14)
    v_cmp_ne_u64 s[50:51], v[72:73], v[68:69]
    v_cmpx_ne_u64 s[54:55], v[74:75], v[70:71]
    s_and_b64 s[82:83], s[54:55], s[80:81]
    s_cbranch_scc1 L2_c98
L2_d98:
    v_mov_b64 v[84:85], v[70:71]
    v_mov_b32 v7, v93
    v_mov_b64 v[86:87], v[74:75]
    s_or_b64 s[80:81], s[80:81], s[54:55]
    s_mov_b64 exec, s[50:51]
    s_and_b64 s[82:83], s[50:51], s[80:81]
    s_cbranch_scc1 L2_c99
L2_d99:
    v_mov_b64 v[84:85], v[68:69]
    v_mov_b32 v7, v92
    v_mov_b64 v[86:87], v[72:73]
    s_mov_b64 exec, -1
    s_or_b64 s[80:81], s[80:81], s[50:51]
    ds_read_b64 v[70:71], v95 offset:65408
    ds_read_b64 v[68:69], v94 offset:65408
    v_and_b32 v46, 0x40000000, v39
    v_bitop3_b32 v92, v36, v5, v46 bitop3:0xea
    v_and_b32 v46, 0x80000000, v39
    v_bitop3_b32 v93, v37, v5, v46 bitop3:0xea
    v_perm_b32 v15, v37, v38, s47
    v_bitop3_b32 v46, v37, 0.5, -0.5 bitop3:0xa8
    v_perm_b32 v14, v36, v38, s46
    v_bitop3_b32 v47, v36, 0.5, -0.5 bitop3:0xa8
    v_bitop3_b32 v15, v6, v15, v46 bitop3:0xca
    v_bitop3_b32 v14, v6, v14, v47 bitop3:0xca
    s_setprio 1
    s_waitcnt lgkmcnt(1)
    v_mfma_f32_4x4x4_16b_bf16 v[80:83], v[10:11], v[70:71], v[80:83]
    s_waitcnt lgkmcnt(0)
    v_mfma_f32_4x4x4_16b_bf16 v[76:79], v[10:11], v[68:69], v[76:79]
    s_nop 2
    v_cvt_pk_bf16_f32 v80, v80, v81
    v_cvt_pk_bf16_f32 v81, v82, v83
    ds_wrxchg_rtn_b64 v[74:75], v95, v[80:81] offset:65408
    v_cvt_pk_bf16_f32 v76, v76, v77
    v_cvt_pk_bf16_f32 v77, v78, v79
    ds_wrxchg_rtn_b64 v[72:73], v94, v[76:77] offset:65408
    v_and_b32 v88, 0x0fffffff, v44
    v_mov_b32 v39, v44
    buffer_load_dwordx2 v[34:35], v88, s[8:11], 0 offen
    buffer_load_dwordx3 v[36:38], v88, s[8:11], 0 offen offset:8
    s_setprio 0
    s_waitcnt vmcnt(12)
    s_mov_b32 m0, s38
    s_nop 0
    ds_write_addtid_b32 v108 offset:0
    ds_write_addtid_b32 v109 offset:256
    ds_write_addtid_b32 v110 offset:512
    ds_write_addtid_b32 v111 offset:768
    s_waitcnt vmcnt(9)
    ds_write_addtid_b32 v112 offset:1024
    ds_write_addtid_b32 v113 offset:1280
    ds_write_addtid_b32 v114 offset:1536
    ds_write_addtid_b32 v115 offset:1792
    v_mfma_f32_4x4x4_16b_bf16 v[80:83], v[8:9], v[102:103], 0
    v_mfma_f32_4x4x4_16b_bf16 v[76:79], v[8:9], v[100:101], 0
    v_cmp_lt_u32 s[84:85], v5, v92
    s_nop 2
    v_pk_mul_f32 v[80:81], v[80:81], v[14:15] op_sel:[0,1] op_sel_hi:[1,1]
    v_pk_mul_f32 v[82:83], v[82:83], v[14:15] op_sel:[0,1] op_sel_hi:[1,1]
    v_pk_mul_f32 v[76:77], v[76:77], v[14:15] op_sel:[0,0] op_sel_hi:[1,0]
    v_pk_mul_f32 v[78:79], v[78:79], v[14:15] op_sel:[0,0] op_sel_hi:[1,0]
    s_add_u32 s42, s42, 1
    s_waitcnt lgkmcnt(0)
    s_barrier
    s_bitcmp1_b32 s36, s42
    s_cbranch_scc1 L2_slow
L2_ret5:
    s_setprio 3
    s_bitcmp1_b32 s43, s42
    s_cbranch_scc1 L2_oa100
L2_ob100:
    v_and_b32 v46, 0x20000000, v21
    v_lshrrev_b32 v47, 14, v17
    v_bitop3_b32 v47, v47, v5, v46 bitop3:0xea
    ds_read_b64 v[106:107], v47
    v_and_b32 v99, 0x10000000, v21
    v_lshrrev_b32 v47, 14, v16
    v_bitop3_b32 v47, v47, v5, v99 bitop3:0xea
    ds_read_b64 v[104:105], v47
    v_cmp_ne_u64 s[50:51], v[72:73], v[68:69]
    v_cmpx_ne_u64 s[54:55], v[74:75], v[70:71]
    s_and_b64 s[82:83], s[54:55], s[80:81]
    s_cbranch_scc1 L2_c101
L2_d101:
    v_mov_b64 v[84:85], v[70:71]
    v_mov_b32 v7, v95
    v_mov_b64 v[86:87], v[74:75]
    s_or_b64 s[80:81], s[80:81], s[54:55]
    s_mov_b64 exec, s[50:51]
    s_and_b64 s[82:83], s[50:51], s[80:81]
    s_cbranch_scc1 L2_c102
L2_d102:
    v_mov_b64 v[84:85], v[68:69]
    v_mov_b32 v7, v94
    v_mov_b64 v[86:87], v[72:73]
    s_mov_b64 exec, -1
    s_or_b64 s[80:81], s[80:81], s[50:51]
    s_and_b64 exec, s[84:85], s[80:81]
    v_mfma_f32_4x4x4_16b_bf16 v[76:79], v[12:13], v[84:85], 0
    v_mov_b32 v92, v7
    s_andn2_b64 s[80:81], s[80:81], s[84:85]
    v_mfma_f32_4x4x4_16b_bf16 v[76:79], v[10:11], v[86:87], v[76:79]
    s_mov_b64 exec, -1
    ds_read_b64 v[70:71], v93 offset:65408
    ds_read_b64 v[68:69], v92 offset:65408
    v_bitop3_b32 v94, v16, v5, v99 bitop3:0xea
    v_bitop3_b32 v95, v17, v5, v46 bitop3:0xea
    v_perm_b32 v15, v17, v20, s45
    v_bitop3_b32 v46, v17, 0.5, -0.5 bitop3:0xa8
    v_perm_b32 v14, v16, v20, s44
    v_bitop3_b32 v47, v16, 0.5, -0.5 bitop3:0xa8
    v_bitop3_b32 v15, v6, v15, v46 bitop3:0xca
    v_bitop3_b32 v14, v6, v14, v47 bitop3:0xca
    s_waitcnt lgkmcnt(1)
    v_mfma_f32_4x4x4_16b_bf16 v[80:83], v[10:11], v[70:71], v[80:83]
    s_waitcnt lgkmcnt(0)
    v_mfma_f32_4x4x4_16b_bf16 v[76:79], v[10:11], v[68:69], v[76:79]
    s_nop 2
    v_cvt_pk_bf16_f32 v80, v80, v81
    v_cvt_pk_bf16_f32 v81, v82, v83
    ds_wrxchg_rtn_b64 v[74:75], v93, v[80:81] offset:65408
    v_cvt_pk_bf16_f32 v76, v76, v77
    v_cvt_pk_bf16_f32 v77, v78, v79
    ds_wrxchg_rtn_b64 v[72:73], v92, v[76:77] offset:65408
    v_mfma_f32_4x4x4_16b_bf16 v[80:83], v[8:9], v[106:107], 0
    v_mfma_f32_4x4x4_16b_bf16 v[76:79], v[8:9], v[104:105], 0
    v_cmp_lt_u32 s[84:85], v5, v94
    s_nop 2
    v_pk_mul_f32 v[80:81], v[80:81], v[14:15] op_sel:[0,1] op_sel_hi:[1,1]
    v_pk_mul_f32 v[82:83], v[82:83], v[14:15] op_sel:[0,1] op_sel_hi:[1,1]
    v_pk_mul_f32 v[76:77], v[76:77], v[14:15] op_sel:[0,0] op_sel_hi:[1,0]
    v_pk_mul_f32 v[78:79], v[78:79], v[14:15] op_sel:[0,0] op_sel_hi:[1,0]
    buffer_load_dwordx4 v[108:111], v3, s[16:19], s40 offen offset:0 sc1
    v_and_b32 v46, 0x80000000, v21
    v_lshrrev_b32 v47, 14, v19
    v_bitop3_b32 v47, v47, v5, v46 bitop3:0xea
    ds_read_b64 v[102:103], v47
    v_and_b32 v99, 0x40000000, v21
    v_lshrrev_b32 v47, 14, v18
    v_bitop3_b32 v47, v47, v5, v99 bitop3:0xea
    ds_read_b64 v[100:101], v47
    s_waitcnt lgkmcnt(2)
    v_cmp_ne_u64 s[50:51], v[72:73], v[68:69]
    v_cmpx_ne_u64 s[54:55], v[74:75], v[70:71]
    s_and_b64 s[82:83], s[54:55], s[80:81]
    s_cbranch_scc1 L2_c103
L2_d103:
    v_mov_b64 v[84:85], v[70:71]
    v_mov_b32 v7, v93
    v_mov_b64 v[86:87], v[74:75]
    s_or_b64 s[80:81], s[80:81], s[54:55]
    s_mov_b64 exec, s[50:51]
    s_and_b64 s[82:83], s[50:51], s[80:81]
    s_cbranch_scc1 L2_c104
L2_d104:
    v_mov_b64 v[84:85], v[68:69]
    v_mov_b32 v7, v92
    v_mov_b64 v[86:87], v[72:73]
    s_mov_b64 exec, -1
    s_or_b64 s[80:81], s[80:81], s[50:51]
    s_and_b64 exec, s[84:85], s[80:81]
    v_mfma_f32_4x4x4_16b_bf16 v[76:79], v[12:13], v[84:85], 0
    v_mov_b32 v94, v7
    s_andn2_b64 s[80:81], s[80:81], s[84:85]
    v_mfma_f32_4x4x4_16b_bf16 v[76:79], v[10:11], v[86:87], v[76:79]
    s_mov_b64 exec, -1
    ds_read_b64 v[70:71], v95 offset:65408
    ds_read_b64 v[68:69], v94 offset:65408
    v_bitop3_b32 v92, v18, v5, v99 bitop3:0xea
    v_bitop3_b32 v93, v19, v5, v46 bitop3:0xea
    v_perm_b32 v15, v19, v20, s47
    v_bitop3_b32 v46, v19, 0.5, -0.5 bitop3:0xa8
    v_perm_b32 v14, v18, v20, s46
    v_bitop3_b32 v47, v18, 0.5, -0.5 bitop3:0xa8
    v_bitop3_b32 v15, v6, v15, v46 bitop3:0xca
    v_bitop3_b32 v14, v6, v14, v47 bitop3:0xca
    s_waitcnt lgkmcnt(1)
    v_mfma_f32_4x4x4_16b_bf16 v[80:83], v[10:11], v[70:71], v[80:83]
    s_waitcnt lgkmcnt(0)
    v_mfma_f32_4x4x4_16b_bf16 v[76:79], v[10:11], v[68:69], v[76:79]
    s_nop 2
    v_cvt_pk_bf16_f32 v80, v80, v81
    v_cvt_pk_bf16_f32 v81, v82, v83
    ds_wrxchg_rtn_b64 v[74:75], v95, v[80:81] offset:65408
    v_cvt_pk_bf16_f32 v76, v76, v77
    v_cvt_pk_bf16_f32 v77, v78, v79
    ds_wrxchg_rtn_b64 v[72:73], v94, v[76:77] offset:65408
    v_and_b32 v88, 0x0fffffff, v40
    v_mov_b32 v21, v40
    buffer_load_dwordx2 v[16:17], v88, s[8:11], 0 offen
    buffer_load_dwordx3 v[18:20], v88, s[8:11], 0 offen offset:8
    s_setprio 2
    v_mfma_f32_4x4x4_16b_bf16 v[80:83], v[8:9], v[102:103], 0
    v_mfma_f32_4x4x4_16b_bf16 v[76:79], v[8:9], v[100:101], 0
    v_cmp_lt_u32 s[48:49], v5, v93
    s_nop 2
    v_pk_mul_f32 v[80:81], v[80:81], v[14:15] op_sel:[0,1] op_sel_hi:[1,1]
    v_pk_mul_f32 v[82:83], v[82:83], v[14:15] op_sel:[0,1] op_sel_hi:[1,1]
    v_pk_mul_f32 v[76:77], v[76:77], v[14:15] op_sel:[0,0] op_sel_hi:[1,0]
    v_pk_mul_f32 v[78:79], v[78:79], v[14:15] op_sel:[0,0] op_sel_hi:[1,0]
    s_waitcnt vmcnt(10)
    v_and_b32 v46, 0x20000000, v27
    v_lshrrev_b32 v47, 14, v23
    v_bitop3_b32 v47, v47, v5, v46 bitop3:0xea
    ds_read_b64 v[106:107], v47
    v_and_b32 v99, 0x10000000, v27
    v_lshrrev_b32 v47, 14, v22
    v_bitop3_b32 v47, v47, v5, v99 bitop3:0xea
    ds_read_b64 v[104:105], v47
    s_waitcnt lgkmcnt(2)
    v_cmp_ne_u64 s[50:51], v[72:73], v[68:69]
    v_cmpx_ne_u64 s[54:55], v[74:75], v[70:71]
    s_and_b64 s[82:83], s[54:55], s[80:81]
    s_cbranch_scc1 L2_c105
L2_d105:
    v_mov_b64 v[84:85], v[70:71]
    v_mov_b32 v7, v95
    v_mov_b64 v[86:87], v[74:75]
    s_or_b64 s[80:81], s[80:81], s[54:55]
    s_mov_b64 exec, s[50:51]
    s_and_b64 s[82:83], s[50:51], s[80:81]
    s_cbranch_scc1 L2_c106
L2_d106:
    v_mov_b64 v[84:85], v[68:69]
    v_mov_b32 v7, v94
    v_mov_b64 v[86:87], v[72:73]
    s_mov_b64 exec, -1
    s_or_b64 s[80:81], s[80:81], s[50:51]
    s_and_b64 exec, s[48:49], s[80:81]
    v_mfma_f32_4x4x4_16b_bf16 v[80:83], v[12:13], v[84:85], 0
    v_mov_b32 v93, v7
    s_andn2_b64 s[80:81], s[80:81], s[48:49]
    v_mfma_f32_4x4x4_16b_bf16 v[80:83], v[10:11], v[86:87], v[80:83]
    s_mov_b64 exec, -1
    ds_read_b64 v[70:71], v93 offset:65408
    ds_read_b64 v[68:69], v92 offset:65408
    v_bitop3_b32 v94, v22, v5, v99 bitop3:0xea
    v_bitop3_b32 v95, v23, v5, v46 bitop3:0xea
    v_perm_b32 v15, v23, v26, s45
    v_bitop3_b32 v46, v23, 0.5, -0.5 bitop3:0xa8
    v_perm_b32 v14, v22, v26, s44
    v_bitop3_b32 v47, v22, 0.5, -0.5 bitop3:0xa8
    v_bitop3_b32 v15, v6, v15, v46 bitop3:0xca
    v_bitop3_b32 v14, v6, v14, v47 bitop3:0xca
    s_waitcnt lgkmcnt(1)
    v_mfma_f32_4x4x4_16b_bf16 v[80:83], v[10:11], v[70:71], v[80:83]
    s_waitcnt lgkmcnt(0)
    v_mfma_f32_4x4x4_16b_bf16 v[76:79], v[10:11], v[68:69], v[76:79]
    s_nop 2
    v_cvt_pk_bf16_f32 v80, v80, v81
    v_cvt_pk_bf16_f32 v81, v82, v83
    ds_wrxchg_rtn_b64 v[74:75], v93, v[80:81] offset:65408
    v_cvt_pk_bf16_f32 v76, v76, v77
    v_cvt_pk_bf16_f32 v77, v78, v79
    ds_wrxchg_rtn_b64 v[72:73], v92, v[76:77] offset:65408
    s_setprio 1
    v_mfma_f32_4x4x4_16b_bf16 v[80:83], v[8:9], v[106:107], 0
    v_mfma_f32_4x4x4_16b_bf16 v[76:79], v[8:9], v[104:105], 0
    s_nop 3
    v_pk_mul_f32 v[80:81], v[80:81], v[14:15] op_sel:[0,1] op_sel_hi:[1,1]
    v_pk_mul_f32 v[82:83], v[82:83], v[14:15] op_sel:[0,1] op_sel_hi:[1,1]
    v_pk_mul_f32 v[76:77], v[76:77], v[14:15] op_sel:[0,0] op_sel_hi:[1,0]
    v_pk_mul_f32 v[78:79], v[78:79], v[14:15] op_sel:[0,0] op_sel_hi:[1,0]
    s_bitcmp1_b32 s43, s42
    s_cbranch_scc1 L2_oa107
L2_ob107:
    buffer_load_dwordx4 v[112:115], v3, s[16:19], s40 offen offset:1024 sc1
    v_sub_u16 v88, v62, v54
    v_and_b32 v89, 3, v54
    v_add3_u32 v99, v88, v89, 3
    v_and_b32 v99, -4, v99
    v_max_u32 v99, 4, v99
    v_and_b32 v97, 0xfffc, v54
    v_bfm_b32 v96, v88, v89
    v_add_u32_dpp v91, v99, v99 row_shr:1 row_mask:0xf bank_mask:0xf bound_ctrl:1
    v_mad_u32_u24 v97, v97, 5, v2
    v_cmp_lt_u32 vcc, 16, v99
    v_add_u32_dpp v91, v91, v91 row_shr:2 row_mask:0xf bank_mask:0xf bound_ctrl:1
    v_sub_u32 v98, s38, v99
    v_lshrrev_b64 v[54:55], 16, v[54:55]
    v_add_u32_dpp v91, v91, v91 row_shr:4 row_mask:0xf bank_mask:0xf bound_ctrl:1
    v_lshrrev_b64 v[62:63], 16, v[62:63]
    s_mov_b32 s101, 0
    v_add_u32_dpp v91, v91, v91 row_shr:8 row_mask:0xf bank_mask:0xf bound_ctrl:1
    s_nop 1
    v_add_u32_dpp v91, v91, v91 row_bcast:15 row_mask:0xa bank_mask:0xf
    s_nop 1
    v_add_u32_dpp v91, v91, v91 row_bcast:31 row_mask:0xc bank_mask:0xf
    v_add_u32 v98, v98, v91
    v_readlane_b32 s37, v91, 63
    s_cbranch_vccnz L2_xo108
L2_xp108:
    v_and_b32 v46, 0x80000000, v27
    v_lshrrev_b32 v47, 14, v25
    v_bitop3_b32 v47, v47, v5, v46 bitop3:0xea
    ds_read_b64 v[102:103], v47
    v_and_b32 v99, 0x40000000, v27
    v_lshrrev_b32 v47, 14, v24
    v_bitop3_b32 v47, v47, v5, v99 bitop3:0xea
    ds_read_b64 v[100:101], v47
    s_waitcnt lgkmcnt(2)
    v_cmp_ne_u64 s[50:51], v[72:73], v[68:69]
    v_cmpx_ne_u64 s[54:55], v[74:75], v[70:71]
    s_and_b64 s[82:83], s[54:55], s[80:81]
    s_cbranch_scc1 L2_c109
L2_d109:
    v_mov_b64 v[84:85], v[70:71]
    v_mov_b32 v7, v93
    v_mov_b64 v[86:87], v[74:75]
    s_or_b64 s[80:81], s[80:81], s[54:55]
    s_mov_b64 exec, s[50:51]
    s_and_b64 s[82:83], s[50:51], s[80:81]
    s_cbranch_scc1 L2_c110
L2_d110:
    v_mov_b64 v[84:85], v[68:69]
    v_mov_b32 v7, v92
    v_mov_b64 v[86:87], v[72:73]
    s_mov_b64 exec, -1
    s_or_b64 s[80:81], s[80:81], s[50:51]
    ds_read_b64 v[70:71], v95 offset:65408
    ds_read_b64 v[68:69], v94 offset:65408
    v_bitop3_b32 v92, v24, v5, v99 bitop3:0xea
    v_bitop3_b32 v93, v25, v5, v46 bitop3:0xea
    v_perm_b32 v15, v25, v26, s47
    v_bitop3_b32 v46, v25, 0.5, -0.5 bitop3:0xa8
    v_perm_b32 v14, v24, v26, s46
    v_bitop3_b32 v47, v24, 0.5, -0.5 bitop3:0xa8
    v_bitop3_b32 v15, v6, v15, v46 bitop3:0xca
    v_bitop3_b32 v14, v6, v14, v47 bitop3:0xca
    s_waitcnt lgkmcnt(1)
    v_mfma_f32_4x4x4_16b_bf16 v[80:83], v[10:11], v[70:71], v[80:83]
    s_waitcnt lgkmcnt(0)
    v_mfma_f32_4x4x4_16b_bf16 v[76:79], v[10:11], v[68:69], v[76:79]
    s_nop 2
    v_cvt_pk_bf16_f32 v80, v80, v81
    v_cvt_pk_bf16_f32 v81, v82, v83
    ds_wrxchg_rtn_b64 v[74:75], v95, v[80:81] offset:65408
    v_cvt_pk_bf16_f32 v76, v76, v77
    v_cvt_pk_bf16_f32 v77, v78, v79
    ds_wrxchg_rtn_b64 v[72:73], v94, v[76:77] offset:65408
    v_and_b32 v88, 0x0fffffff, v41
    v_mov_b32 v27, v41
    buffer_load_dwordx2 v[22:23], v88, s[8:11], 0 offen
    buffer_load_dwordx3 v[24:26], v88, s[8:11], 0 offen offset:8
    v_mfma_f32_4x4x4_16b_bf16 v[80:83], v[8:9], v[102:103], 0
    v_mfma_f32_4x4x4_16b_bf16 v[76:79], v[8:9], v[100:101], 0
    v_cmp_lt_u32 s[84:85], v5, v92
    s_nop 2
    v_pk_mul_f32 v[80:81], v[80:81], v[14:15] op_sel:[0,1] op_sel_hi:[1,1]
    v_pk_mul_f32 v[82:83], v[82:83], v[14:15] op_sel:[0,1] op_sel_hi:[1,1]
    v_pk_mul_f32 v[76:77], v[76:77], v[14:15] op_sel:[0,0] op_sel_hi:[1,0]
    v_pk_mul_f32 v[78:79], v[78:79], v[14:15] op_sel:[0,0] op_sel_hi:[1,0]
    s_waitcnt vmcnt(11)
    s_mov_b64 exec, s[6:7]
    v_lshrrev_b32 v30, 16, v30
    s_mov_b64 exec, -1
    v_and_b32 v46, 0x20000000, v31
    v_lshrrev_b32 v47, 14, v29
    v_bitop3_b32 v47, v47, v5, v46 bitop3:0xea
    ds_read_b64 v[106:107], v47
    v_and_b32 v99, 0x10000000, v31
    v_lshrrev_b32 v47, 14, v28
    v_bitop3_b32 v47, v47, v5, v99 bitop3:0xea
    ds_read_b64 v[104:105], v47
    s_waitcnt lgkmcnt(2)
    v_cmp_ne_u64 s[50:51], v[72:73], v[68:69]
    v_cmpx_ne_u64 s[54:55], v[74:75], v[70:71]
    s_and_b64 s[82:83], s[54:55], s[80:81]
    s_cbranch_scc1 L2_c111
L2_d111:
    v_mov_b64 v[84:85], v[70:71]
    v_mov_b32 v7, v95
    v_mov_b64 v[86:87], v[74:75]
    s_or_b64 s[80:81], s[80:81], s[54:55]
    s_mov_b64 exec, s[50:51]
    s_and_b64 s[82:83], s[50:51], s[80:81]
    s_cbranch_scc1 L2_c112
L2_d112:
    v_mov_b64 v[84:85], v[68:69]
    v_mov_b32 v7, v94
    v_mov_b64 v[86:87], v[72:73]
    s_mov_b64 exec, -1
    s_or_b64 s[80:81], s[80:81], s[50:51]
    s_and_b64 exec, s[84:85], s[80:81]
    v_mfma_f32_4x4x4_16b_bf16 v[76:79], v[12:13], v[84:85], 0
    v_mov_b32 v92, v7
    s_andn2_b64 s[80:81], s[80:81], s[84:85]
    v_mfma_f32_4x4x4_16b_bf16 v[76:79], v[10:11], v[86:87], v[76:79]
    s_mov_b64 exec, -1
    ds_read_b64 v[70:71], v93 offset:65408
    ds_read_b64 v[68:69], v92 offset:65408
    v_bitop3_b32 v94, v28, v5, v99 bitop3:0xea
    v_bitop3_b32 v95, v29, v5, v46 bitop3:0xea
    v_perm_b32 v15, v29, v30, s45
    v_bitop3_b32 v46, v29, 0.5, -0.5 bitop3:0xa8
    v_perm_b32 v14, v28, v30, s44
    v_bitop3_b32 v47, v28, 0.5, -0.5 bitop3:0xa8
    v_bitop3_b32 v15, v6, v15, v46 bitop3:0xca
    v_bitop3_b32 v14, v6, v14, v47 bitop3:0xca
    s_waitcnt lgkmcnt(1)
    v_mfma_f32_4x4x4_16b_bf16 v[80:83], v[10:11], v[70:71], v[80:83]
    s_waitcnt lgkmcnt(0)
    v_mfma_f32_4x4x4_16b_bf16 v[76:79], v[10:11], v[68:69], v[76:79]
    s_nop 2
    v_cvt_pk_bf16_f32 v80, v80, v81
    v_cvt_pk_bf16_f32 v81, v82, v83
    ds_wrxchg_rtn_b64 v[74:75], v93, v[80:81] offset:65408
    v_cvt_pk_bf16_f32 v76, v76, v77
    v_cvt_pk_bf16_f32 v77, v78, v79
    ds_wrxchg_rtn_b64 v[72:73], v92, v[76:77] offset:65408
    s_setprio 0
    v_mfma_f32_4x4x4_16b_bf16 v[80:83], v[8:9], v[106:107], 0
    v_mfma_f32_4x4x4_16b_bf16 v[76:79], v[8:9], v[104:105], 0
    v_cmp_lt_u32 s[48:49], v5, v95
    s_nop 2
    v_pk_mul_f32 v[80:81], v[80:81], v[14:15] op_sel:[0,1] op_sel_hi:[1,1]
    v_pk_mul_f32 v[82:83], v[82:83], v[14:15] op_sel:[0,1] op_sel_hi:[1,1]
    v_pk_mul_f32 v[76:77], v[76:77], v[14:15] op_sel:[0,0] op_sel_hi:[1,0]
    v_pk_mul_f32 v[78:79], v[78:79], v[14:15] op_sel:[0,0] op_sel_hi:[1,0]
    s_add_u32 s40, s40, 0x50000
    v_and_b32 v47, 0x0fffffff, v42
    v_mov_b32 v31, v42
    buffer_load_dword v30, v47, s[8:11], 0 offen offset:16
    s_mov_b64 exec, s[6:7]
    v_add_u32 v47, 8, v47
    v_lshrrev_b32 v31, 2, v31
    s_mov_b64 exec, -1
    buffer_load_dwordx2 v[28:29], v47, s[8:11], 0 offen
    s_waitcnt vmcnt(8)
    v_and_b32 v46, 0x80000000, v39
    v_lshrrev_b32 v47, 14, v37
    v_bitop3_b32 v47, v47, v5, v46 bitop3:0xea
    ds_read_b64 v[106:107], v47
    v_and_b32 v99, 0x40000000, v39
    v_lshrrev_b32 v47, 14, v36
    v_bitop3_b32 v47, v47, v5, v99 bitop3:0xea
    ds_read_b64 v[104:105], v47
    v_and_b32 v46, 0x20000000, v39
    v_lshrrev_b32 v47, 14, v35
    v_bitop3_b32 v47, v47, v5, v46 bitop3:0xea
    ds_read_b64 v[102:103], v47
    v_and_b32 v99, 0x10000000, v39
    v_lshrrev_b32 v47, 14, v34
    v_bitop3_b32 v47, v47, v5, v99 bitop3:0xea
    ds_read_b64 v[100:101], v47
    s_waitcnt lgkmcnt(4)
    v_cmp_ne_u64 s[50:51], v[72:73], v[68:69]
    v_cmpx_ne_u64 s[54:55], v[74:75], v[70:71]
    s_and_b64 s[82:83], s[54:55], s[80:81]
    s_cbranch_scc1 L2_c113
L2_d113:
    v_mov_b64 v[84:85], v[70:71]
    v_mov_b32 v7, v93
    v_mov_b64 v[86:87], v[74:75]
    s_or_b64 s[80:81], s[80:81], s[54:55]
    s_mov_b64 exec, s[50:51]
    s_and_b64 s[82:83], s[50:51], s[80:81]
    s_cbranch_scc1 L2_c114
L2_d114:
    v_mov_b64 v[84:85], v[68:69]
    v_mov_b32 v7, v92
    v_mov_b64 v[86:87], v[72:73]
    s_mov_b64 exec, -1
    s_or_b64 s[80:81], s[80:81], s[50:51]
    s_and_b64 exec, s[48:49], s[80:81]
    v_mfma_f32_4x4x4_16b_bf16 v[80:83], v[12:13], v[84:85], 0
    v_mov_b32 v95, v7
    s_andn2_b64 s[80:81], s[80:81], s[48:49]
    v_mfma_f32_4x4x4_16b_bf16 v[80:83], v[10:11], v[86:87], v[80:83]
    s_mov_b64 exec, -1
    ds_read_b64 v[70:71], v95 offset:65408
    ds_read_b64 v[68:69], v94 offset:65408
    v_bitop3_b32 v92, v34, v5, v99 bitop3:0xea
    v_bitop3_b32 v93, v35, v5, v46 bitop3:0xea
    v_perm_b32 v15, v35, v38, s45
    v_bitop3_b32 v46, v35, 0.5, -0.5 bitop3:0xa8
    v_perm_b32 v14, v34, v38, s44
    v_bitop3_b32 v47, v34, 0.5, -0.5 bitop3:0xa8
    v_bitop3_b32 v15, v6, v15, v46 bitop3:0xca
    v_bitop3_b32 v14, v6, v14, v47 bitop3:0xca
    s_waitcnt lgkmcnt(1)
    v_mfma_f32_4x4x4_16b_bf16 v[80:83], v[10:11], v[70:71], v[80:83]
    s_waitcnt lgkmcnt(0)
    v_mfma_f32_4x4x4_16b_bf16 v[76:79], v[10:11], v[68:69], v[76:79]
    s_nop 2
    v_cvt_pk_bf16_f32 v80, v80, v81
    v_cvt_pk_bf16_f32 v81, v82, v83
    ds_wrxchg_rtn_b64 v[74:75], v95, v[80:81] offset:65408
    v_cvt_pk_bf16_f32 v76, v76, v77
    v_cvt_pk_bf16_f32 v77, v78, v79
    ds_wrxchg_rtn_b64 v[72:73], v94, v[76:77] offset:65408
    s_barrier
    s_setprio 3
    s_mov_b32 m0, s100
    s_nop 0
    ds_write_addtid_b32 v124 offset:34816
    ds_write_addtid_b32 v125 offset:35072
    ds_write_addtid_b32 v126 offset:35328
    ds_write_addtid_b32 v127 offset:35584
    s_add_u32 s3, s40, 4096
    buffer_load_dwordx4 v[124:127], v3, s[16:19], s3 offen sc1
    ds_write_addtid_b32 v116 offset:32768
    ds_write_addtid_b32 v117 offset:33024
    ds_write_addtid_b32 v118 offset:33280
    ds_write_addtid_b32 v119 offset:33536
    buffer_load_dwordx4 v[116:119], v3, s[16:19], s40 offen offset:2048 sc1
    ds_write_addtid_b32 v120 offset:33792
    ds_write_addtid_b32 v121 offset:34048
    ds_write_addtid_b32 v122 offset:34304
    ds_write_addtid_b32 v123 offset:34560
    buffer_load_dwordx4 v[120:123], v3, s[16:19], s40 offen offset:3072 sc1
    v_mfma_f32_4x4x4_16b_bf16 v[80:83], v[8:9], v[102:103], 0
    v_mfma_f32_4x4x4_16b_bf16 v[76:79], v[8:9], v[100:101], 0
    s_nop 3
    v_pk_mul_f32 v[80:81], v[80:81], v[14:15] op_sel:[0,1] op_sel_hi:[1,1]
    v_pk_mul_f32 v[82:83], v[82:83], v[14:15] op_sel:[0,1] op_sel_hi:[1,1]
    v_pk_mul_f32 v[76:77], v[76:77], v[14:15] op_sel:[0,0] op_sel_hi:[1,0]
    v_pk_mul_f32 v[78:79], v[78:79], v[14:15] op_sel:[0,0] op_sel_hi:[1,0]
    v_mov_b32 v44, v43
    s_cmp_gt_u32 s37, 1024
    s_cbranch_scc1 L2_xs115
    s_cmp_lg_u32 s101, 0
    s_cbranch_scc1 L2_xa115
L2_xb115:
    v_lshlrev_b32 v89, 16, v96
    v_add_u32 v90, 60, v97
    v_bitop3_b32 v90, v89, v45, v90 bitop3:0x6a
    ds_write_b32 v98, v90 offset:12
    v_lshlrev_b32 v89, 20, v96
    v_add_u32 v90, 40, v97
    v_bitop3_b32 v90, v89, v45, v90 bitop3:0x6a
    ds_write_b32 v98, v90 offset:8
    v_lshlrev_b32 v89, 24, v96
    v_add_u32 v90, 20, v97
    v_bitop3_b32 v90, v89, v45, v90 bitop3:0x6a
    ds_write_b32 v98, v90 offset:4
    v_lshlrev_b32 v89, 28, v96
    v_bitop3_b32 v90, v89, v45, v97 bitop3:0x6a
    ds_write_b32 v98, v90 offset:0
    v_mov_b32_dpp v91, v66 quad_perm:[1,1,1,1] row_mask:0xf bank_mask:0xf
    v_and_b32 v89, 3, v91
    v_and_b32 v97, 0xfffc, v91
    v_sub_u16_dpp v88, v66, v91 quad_perm:[3,3,3,3] row_mask:0xf bank_mask:0xf
    v_mad_u32_u24 v97, v97, 5, v4
    v_add_u32 v99, v88, v89
    v_bfm_b32 v96, v88, v89
    v_cmp_lt_u32 s[58:59], 16, v99
    v_lshlrev_b32 v89, v1, v96
    v_and_b32 v89, v45, v89
    v_cmp_ne_u32 vcc, 0, v89
    v_xor_b32 v90, v97, v89
    s_add_u32 s3, s37, s38
    v_mbcnt_lo_u32_b32 v98, vcc_lo, 0
    v_mbcnt_hi_u32_b32 v98, vcc_hi, v98
    s_bcnt1_i32_b64 s41, vcc
    v_lshl_add_u32 v98, v98, 2, s3
    s_lshl2_add_u32 s37, s41, s37
    s_mov_b64 exec, vcc
    ds_write_b32 v98, v90
    s_mov_b64 exec, -1
    s_cmp_lg_u64 s[58:59], 0
    s_cbranch_scc1 L2_xe115
L2_xr115:
    v_add_u32 v98, s37, v0
    v_mov_b32 v90, -1
    ds_write_b32 v98, v90
    v_add_u32 v98, s38, v0
    ds_read2st64_b32 v[40:41], v0 offset0:0 offset1:1
    ds_read_b32 v43, v0 offset:512
    v_lshrrev_b32 v98, 1, v98
    v_and_b32 v98, -4, v98
    ds_read_b32 v42, v98 offset:768
    s_sub_u32 s3, s37, 768
    s_cmp_gt_u32 s3, 128
    s_cbranch_scc1 L2_xf115
L2_xg115:
    v_lshrrev_b64 v[64:65], 16, v[64:65]
    v_lshrrev_b64 v[66:67], 16, v[66:67]
    s_setprio 2
    s_waitcnt lgkmcnt(14)
    v_cmp_ne_u64 s[50:51], v[72:73], v[68:69]
    v_cmpx_ne_u64 s[54:55], v[74:75], v[70:71]
    s_and_b64 s[82:83], s[54:55], s[80:81]
    s_cbranch_scc1 L2_c116
L2_d116:
    v_mov_b64 v[84:85], v[70:71]
    v_mov_b32 v7, v95
    v_mov_b64 v[86:87], v[74:75]
    s_or_b64 s[80:81], s[80:81], s[54:55]
    s_mov_b64 exec, s[50:51]
    s_and_b64 s[82:83], s[50:51], s[80:81]
    s_cbranch_scc1 L2_c117
L2_d117:
    v_mov_b64 v[84:85], v[68:69]
    v_mov_b32 v7, v94
    v_mov_b64 v[86:87], v[72:73]
    s_mov_b64 exec, -1
    s_or_b64 s[80:81], s[80:81], s[50:51]
    ds_read_b64 v[70:71], v93 offset:65408
    ds_read_b64 v[68:69], v92 offset:65408
    v_and_b32 v46, 0x40000000, v39
    v_bitop3_b32 v94, v36, v5, v46 bitop3:0xea
    v_and_b32 v46, 0x80000000, v39
    v_bitop3_b32 v95, v37, v5, v46 bitop3:0xea
    v_perm_b32 v15, v37, v38, s47
    v_bitop3_b32 v46, v37, 0.5, -0.5 bitop3:0xa8
    v_perm_b32 v14, v36, v38, s46
    v_bitop3_b32 v47, v36, 0.5, -0.5 bitop3:0xa8
    v_bitop3_b32 v15, v6, v15, v46 bitop3:0xca
    v_bitop3_b32 v14, v6, v14, v47 bitop3:0xca
    s_setprio 1
    s_waitcnt lgkmcnt(1)
    v_mfma_f32_4x4x4_16b_bf16 v[80:83], v[10:11], v[70:71], v[80:83]
    s_waitcnt lgkmcnt(0)
    v_mfma_f32_4x4x4_16b_bf16 v[76:79], v[10:11], v[68:69], v[76:79]
    s_nop 2
    v_cvt_pk_bf16_f32 v80, v80, v81
    v_cvt_pk_bf16_f32 v81, v82, v83
    ds_wrxchg_rtn_b64 v[74:75], v93, v[80:81] offset:65408
    v_cvt_pk_bf16_f32 v76, v76, v77
    v_cvt_pk_bf16_f32 v77, v78, v79
    ds_wrxchg_rtn_b64 v[72:73], v92, v[76:77] offset:65408
    v_and_b32 v88, 0x0fffffff, v44
    v_mov_b32 v39, v44
    buffer_load_dwordx2 v[34:35], v88, s[8:11], 0 offen
    buffer_load_dwordx3 v[36:38], v88, s[8:11], 0 offen offset:8
    s_setprio 0
    s_waitcnt vmcnt(12)
    s_mov_b32 m0, s38
    s_nop 0
    ds_write_addtid_b32 v108 offset:0
    ds_write_addtid_b32 v109 offset:256
    ds_write_addtid_b32 v110 offset:512
    ds_write_addtid_b32 v111 offset:768
    s_waitcnt vmcnt(9)
    ds_write_addtid_b32 v112 offset:1024
    ds_write_addtid_b32 v113 offset:1280
    ds_write_addtid_b32 v114 offset:1536
    ds_write_addtid_b32 v115 offset:1792
    v_mfma_f32_4x4x4_16b_bf16 v[80:83], v[8:9], v[106:107], 0
    v_mfma_f32_4x4x4_16b_bf16 v[76:79], v[8:9], v[104:105], 0
    v_cmp_lt_u32 s[84:85], v5, v94
    s_nop 2
    v_pk_mul_f32 v[80:81], v[80:81], v[14:15] op_sel:[0,1] op_sel_hi:[1,1]
    v_pk_mul_f32 v[82:83], v[82:83], v[14:15] op_sel:[0,1] op_sel_hi:[1,1]
    v_pk_mul_f32 v[76:77], v[76:77], v[14:15] op_sel:[0,0] op_sel_hi:[1,0]
    v_pk_mul_f32 v[78:79], v[78:79], v[14:15] op_sel:[0,0] op_sel_hi:[1,0]
    s_add_u32 s42, s42, 1
    s_waitcnt lgkmcnt(0)
    s_cmp_lg_u32 s42, 14
    s_cbranch_scc1 L2_loop
    s_barrier
    s_bitcmp1_b32 s36, s42
    s_cbranch_scc1 L2_slow
L2_ret6:
    s_setprio 3
    s_bitcmp1_b32 s43, s42
    s_cbranch_scc1 L2_oa118
L2_ob118:
    v_and_b32 v46, 0x20000000, v21
    v_lshrrev_b32 v47, 14, v17
    v_bitop3_b32 v47, v47, v5, v46 bitop3:0xea
    ds_read_b64 v[102:103], v47
    v_and_b32 v99, 0x10000000, v21
    v_lshrrev_b32 v47, 14, v16
    v_bitop3_b32 v47, v47, v5, v99 bitop3:0xea
    ds_read_b64 v[100:101], v47
    v_cmp_ne_u64 s[50:51], v[72:73], v[68:69]
    v_cmpx_ne_u64 s[54:55], v[74:75], v[70:71]
    s_and_b64 s[82:83], s[54:55], s[80:81]
    s_cbranch_scc1 L2_c119
L2_d119:
    v_mov_b64 v[84:85], v[70:71]
    v_mov_b32 v7, v93
    v_mov_b64 v[86:87], v[74:75]
    s_or_b64 s[80:81], s[80:81], s[54:55]
    s_mov_b64 exec, s[50:51]
    s_and_b64 s[82:83], s[50:51], s[80:81]
    s_cbranch_scc1 L2_c120
L2_d120:
    v_mov_b64 v[84:85], v[68:69]
    v_mov_b32 v7, v92
    v_mov_b64 v[86:87], v[72:73]
    s_mov_b64 exec, -1
    s_or_b64 s[80:81], s[80:81], s[50:51]
    s_and_b64 exec, s[84:85], s[80:81]
    v_mfma_f32_4x4x4_16b_bf16 v[76:79], v[12:13], v[84:85], 0
    v_mov_b32 v94, v7
    s_andn2_b64 s[80:81], s[80:81], s[84:85]
    v_mfma_f32_4x4x4_16b_bf16 v[76:79], v[10:11], v[86:87], v[76:79]
    s_mov_b64 exec, -1
    ds_read_b64 v[70:71], v95 offset:65408
    ds_read_b64 v[68:69], v94 offset:65408
    v_bitop3_b32 v92, v16, v5, v99 bitop3:0xea
    v_bitop3_b32 v93, v17, v5, v46 bitop3:0xea
    v_perm_b32 v15, v17, v20, s45
    v_bitop3_b32 v46, v17, 0.5, -0.5 bitop3:0xa8
    v_perm_b32 v14, v16, v20, s44
    v_bitop3_b32 v47, v16, 0.5, -0.5 bitop3:0xa8
    v_bitop3_b32 v15, v6, v15, v46 bitop3:0xca
    v_bitop3_b32 v14, v6, v14, v47 bitop3:0xca
    s_waitcnt lgkmcnt(1)
    v_mfma_f32_4x4x4_16b_bf16 v[80:83], v[10:11], v[70:71], v[80:83]
    s_waitcnt lgkmcnt(0)
    v_mfma_f32_4x4x4_16b_bf16 v[76:79], v[10:11], v[68:69], v[76:79]
    s_nop 2
    v_cvt_pk_bf16_f32 v80, v80, v81
    v_cvt_pk_bf16_f32 v81, v82, v83
    ds_wrxchg_rtn_b64 v[74:75], v95, v[80:81] offset:65408
    v_cvt_pk_bf16_f32 v76, v76, v77
    v_cvt_pk_bf16_f32 v77, v78, v79
    ds_wrxchg_rtn_b64 v[72:73], v94, v[76:77] offset:65408
    v_mfma_f32_4x4x4_16b_bf16 v[80:83], v[8:9], v[102:103], 0
    v_mfma_f32_4x4x4_16b_bf16 v[76:79], v[8:9], v[100:101], 0
    v_cmp_lt_u32 s[84:85], v5, v92
    s_nop 2
    v_pk_mul_f32 v[80:81], v[80:81], v[14:15] op_sel:[0,1] op_sel_hi:[1,1]
    v_pk_mul_f32 v[82:83], v[82:83], v[14:15] op_sel:[0,1] op_sel_hi:[1,1]
    v_pk_mul_f32 v[76:77], v[76:77], v[14:15] op_sel:[0,0] op_sel_hi:[1,0]
    v_pk_mul_f32 v[78:79], v[78:79], v[14:15] op_sel:[0,0] op_sel_hi:[1,0]
    buffer_load_dwordx4 v[108:111], v3, s[16:19], s40 offen offset:0 sc1
    v_and_b32 v46, 0x80000000, v21
    v_lshrrev_b32 v47, 14, v19
    v_bitop3_b32 v47, v47, v5, v46 bitop3:0xea
    ds_read_b64 v[106:107], v47
    v_and_b32 v99, 0x40000000, v21
    v_lshrrev_b32 v47, 14, v18
    v_bitop3_b32 v47, v47, v5, v99 bitop3:0xea
    ds_read_b64 v[104:105], v47
    s_waitcnt lgkmcnt(2)
    v_cmp_ne_u64 s[50:51], v[72:73], v[68:69]
    v_cmpx_ne_u64 s[54:55], v[74:75], v[70:71]
    s_and_b64 s[82:83], s[54:55], s[80:81]
    s_cbranch_scc1 L2_c121
L2_d121:
    v_mov_b64 v[84:85], v[70:71]
    v_mov_b32 v7, v95
    v_mov_b64 v[86:87], v[74:75]
    s_or_b64 s[80:81], s[80:81], s[54:55]
    s_mov_b64 exec, s[50:51]
    s_and_b64 s[82:83], s[50:51], s[80:81]
    s_cbranch_scc1 L2_c122
L2_d122:
    v_mov_b64 v[84:85], v[68:69]
    v_mov_b32 v7, v94
    v_mov_b64 v[86:87], v[72:73]
    s_mov_b64 exec, -1
    s_or_b64 s[80:81], s[80:81], s[50:51]
    s_and_b64 exec, s[84:85], s[80:81]
    v_mfma_f32_4x4x4_16b_bf16 v[76:79], v[12:13], v[84:85], 0
    v_mov_b32 v92, v7
    s_andn2_b64 s[80:81], s[80:81], s[84:85]
    v_mfma_f32_4x4x4_16b_bf16 v[76:79], v[10:11], v[86:87], v[76:79]
    s_mov_b64 exec, -1
    ds_read_b64 v[70:71], v93 offset:65408
    ds_read_b64 v[68:69], v92 offset:65408
    v_bitop3_b32 v94, v18, v5, v99 bitop3:0xea
    v_bitop3_b32 v95, v19, v5, v46 bitop3:0xea
    v_perm_b32 v15, v19, v20, s47
    v_bitop3_b32 v46, v19, 0.5, -0.5 bitop3:0xa8
    v_perm_b32 v14, v18, v20, s46
    v_bitop3_b32 v47, v18, 0.5, -0.5 bitop3:0xa8
    v_bitop3_b32 v15, v6, v15, v46 bitop3:0xca
    v_bitop3_b32 v14, v6, v14, v47 bitop3:0xca
    s_waitcnt lgkmcnt(1)
    v_mfma_f32_4x4x4_16b_bf16 v[80:83], v[10:11], v[70:71], v[80:83]
    s_waitcnt lgkmcnt(0)
    v_mfma_f32_4x4x4_16b_bf16 v[76:79], v[10:11], v[68:69], v[76:79]
    s_nop 2
    v_cvt_pk_bf16_f32 v80, v80, v81
    v_cvt_pk_bf16_f32 v81, v82, v83
    ds_wrxchg_rtn_b64 v[74:75], v93, v[80:81] offset:65408
    v_cvt_pk_bf16_f32 v76, v76, v77
    v_cvt_pk_bf16_f32 v77, v78, v79
    ds_wrxchg_rtn_b64 v[72:73], v92, v[76:77] offset:65408
    v_and_b32 v88, 0x0fffffff, v40
    v_mov_b32 v21, v40
    buffer_load_dwordx2 v[16:17], v88, s[8:11], 0 offen
    buffer_load_dwordx3 v[18:20], v88, s[8:11], 0 offen offset:8
    s_setprio 2
    v_mfma_f32_4x4x4_16b_bf16 v[80:83], v[8:9], v[106:107], 0
    v_mfma_f32_4x4x4_16b_bf16 v[76:79], v[8:9], v[104:105], 0
    v_cmp_lt_u32 s[48:49], v5, v95
    s_nop 2
    v_pk_mul_f32 v[80:81], v[80:81], v[14:15] op_sel:[0,1] op_sel_hi:[1,1]
    v_pk_mul_f32 v[82:83], v[82:83], v[14:15] op_sel:[0,1] op_sel_hi:[1,1]
    v_pk_mul_f32 v[76:77], v[76:77], v[14:15] op_sel:[0,0] op_sel_hi:[1,0]
    v_pk_mul_f32 v[78:79], v[78:79], v[14:15] op_sel:[0,0] op_sel_hi:[1,0]
    s_waitcnt vmcnt(10)
    v_and_b32 v46, 0x20000000, v27
    v_lshrrev_b32 v47, 14, v23
    v_bitop3_b32 v47, v47, v5, v46 bitop3:0xea
    ds_read_b64 v[102:103], v47
    v_and_b32 v99, 0x10000000, v27
    v_lshrrev_b32 v47, 14, v22
    v_bitop3_b32 v47, v47, v5, v99 bitop3:0xea
    ds_read_b64 v[100:101], v47
    s_waitcnt lgkmcnt(2)
    v_cmp_ne_u64 s[50:51], v[72:73], v[68:69]
    v_cmpx_ne_u64 s[54:55], v[74:75], v[70:71]
    s_and_b64 s[82:83], s[54:55], s[80:81]
    s_cbranch_scc1 L2_c123
L2_d123:
    v_mov_b64 v[84:85], v[70:71]
    v_mov_b32 v7, v93
    v_mov_b64 v[86:87], v[74:75]
    s_or_b64 s[80:81], s[80:81], s[54:55]
    s_mov_b64 exec, s[50:51]
    s_and_b64 s[82:83], s[50:51], s[80:81]
    s_cbranch_scc1 L2_c124
L2_d124:
    v_mov_b64 v[84:85], v[68:69]
    v_mov_b32 v7, v92
    v_mov_b64 v[86:87], v[72:73]
    s_mov_b64 exec, -1
    s_or_b64 s[80:81], s[80:81], s[50:51]
    s_and_b64 exec, s[48:49], s[80:81]
    v_mfma_f32_4x4x4_16b_bf16 v[80:83], v[12:13], v[84:85], 0
    v_mov_b32 v95, v7
    s_andn2_b64 s[80:81], s[80:81], s[48:49]
    v_mfma_f32_4x4x4_16b_bf16 v[80:83], v[10:11], v[86:87], v[80:83]
    s_mov_b64 exec, -1
    ds_read_b64 v[70:71], v95 offset:65408
    ds_read_b64 v[68:69], v94 offset:65408
    v_bitop3_b32 v92, v22, v5, v99 bitop3:0xea
    v_bitop3_b32 v93, v23, v5, v46 bitop3:0xea
    v_perm_b32 v15, v23, v26, s45
    v_bitop3_b32 v46, v23, 0.5, -0.5 bitop3:0xa8
    v_perm_b32 v14, v22, v26, s44
    v_bitop3_b32 v47, v22, 0.5, -0.5 bitop3:0xa8
    v_bitop3_b32 v15, v6, v15, v46 bitop3:0xca
    v_bitop3_b32 v14, v6, v14, v47 bitop3:0xca
    s_waitcnt lgkmcnt(1)
    v_mfma_f32_4x4x4_16b_bf16 v[80:83], v[10:11], v[70:71], v[80:83]
    s_waitcnt lgkmcnt(0)
    v_mfma_f32_4x4x4_16b_bf16 v[76:79], v[10:11], v[68:69], v[76:79]
    s_nop 2
    v_cvt_pk_bf16_f32 v80, v80, v81
    v_cvt_pk_bf16_f32 v81, v82, v83
    ds_wrxchg_rtn_b64 v[74:75], v95, v[80:81] offset:65408
    v_cvt_pk_bf16_f32 v76, v76, v77
    v_cvt_pk_bf16_f32 v77, v78, v79
    ds_wrxchg_rtn_b64 v[72:73], v94, v[76:77] offset:65408
    s_setprio 1
    v_mfma_f32_4x4x4_16b_bf16 v[80:83], v[8:9], v[102:103], 0
    v_mfma_f32_4x4x4_16b_bf16 v[76:79], v[8:9], v[100:101], 0
    s_nop 3
    v_pk_mul_f32 v[80:81], v[80:81], v[14:15] op_sel:[0,1] op_sel_hi:[1,1]
    v_pk_mul_f32 v[82:83], v[82:83], v[14:15] op_sel:[0,1] op_sel_hi:[1,1]
    v_pk_mul_f32 v[76:77], v[76:77], v[14:15] op_sel:[0,0] op_sel_hi:[1,0]
    v_pk_mul_f32 v[78:79], v[78:79], v[14:15] op_sel:[0,0] op_sel_hi:[1,0]
    s_bitcmp1_b32 s43, s42
    s_cbranch_scc1 L2_oa125
L2_ob125:
    buffer_load_dwordx4 v[112:115], v3, s[16:19], s40 offen offset:1024 sc1
    v_and_b32 v46, 0x80000000, v27
    v_lshrrev_b32 v47, 14, v25
    v_bitop3_b32 v47, v47, v5, v46 bitop3:0xea
    ds_read_b64 v[106:107], v47
    v_and_b32 v99, 0x40000000, v27
    v_lshrrev_b32 v47, 14, v24
    v_bitop3_b32 v47, v47, v5, v99 bitop3:0xea
    ds_read_b64 v[104:105], v47
    s_waitcnt lgkmcnt(2)
    v_cmp_ne_u64 s[50:51], v[72:73], v[68:69]
    v_cmpx_ne_u64 s[54:55], v[74:75], v[70:71]
    s_and_b64 s[82:83], s[54:55], s[80:81]
    s_cbranch_scc1 L2_c126
L2_d126:
    v_mov_b64 v[84:85], v[70:71]
    v_mov_b32 v7, v95
    v_mov_b64 v[86:87], v[74:75]
    s_or_b64 s[80:81], s[80:81], s[54:55]
    s_mov_b64 exec, s[50:51]
    s_and_b64 s[82:83], s[50:51], s[80:81]
    s_cbranch_scc1 L2_c127
L2_d127:
    v_mov_b64 v[84:85], v[68:69]
    v_mov_b32 v7, v94
    v_mov_b64 v[86:87], v[72:73]
    s_mov_b64 exec, -1
    s_or_b64 s[80:81], s[80:81], s[50:51]
    ds_read_b64 v[70:71], v93 offset:65408
    ds_read_b64 v[68:69], v92 offset:65408
    v_bitop3_b32 v94, v24, v5, v99 bitop3:0xea
    v_bitop3_b32 v95, v25, v5, v46 bitop3:0xea
    v_perm_b32 v15, v25, v26, s47
    v_bitop3_b32 v46, v25, 0.5, -0.5 bitop3:0xa8
    v_perm_b32 v14, v24, v26, s46
    v_bitop3_b32 v47, v24, 0.5, -0.5 bitop3:0xa8
    v_bitop3_b32 v15, v6, v15, v46 bitop3:0xca
    v_bitop3_b32 v14, v6, v14, v47 bitop3:0xca
    s_waitcnt lgkmcnt(1)
    v_mfma_f32_4x4x4_16b_bf16 v[80:83], v[10:11], v[70:71], v[80:83]
    s_waitcnt lgkmcnt(0)
    v_mfma_f32_4x4x4_16b_bf16 v[76:79], v[10:11], v[68:69], v[76:79]
    s_nop 2
    v_cvt_pk_bf16_f32 v80, v80, v81
    v_cvt_pk_bf16_f32 v81, v82, v83
    ds_wrxchg_rtn_b64 v[74:75], v93, v[80:81] offset:65408
    v_cvt_pk_bf16_f32 v76, v76, v77
    v_cvt_pk_bf16_f32 v77, v78, v79
    ds_wrxchg_rtn_b64 v[72:73], v92, v[76:77] offset:65408
    v_and_b32 v88, 0x0fffffff, v41
    v_mov_b32 v27, v41
    buffer_load_dwordx2 v[22:23], v88, s[8:11], 0 offen
    buffer_load_dwordx3 v[24:26], v88, s[8:11], 0 offen offset:8
    v_mfma_f32_4x4x4_16b_bf16 v[80:83], v[8:9], v[106:107], 0
    v_mfma_f32_4x4x4_16b_bf16 v[76:79], v[8:9], v[104:105], 0
    v_cmp_lt_u32 s[84:85], v5, v94
    s_nop 2
    v_pk_mul_f32 v[80:81], v[80:81], v[14:15] op_sel:[0,1] op_sel_hi:[1,1]
    v_pk_mul_f32 v[82:83], v[82:83], v[14:15] op_sel:[0,1] op_sel_hi:[1,1]
    v_pk_mul_f32 v[76:77], v[76:77], v[14:15] op_sel:[0,0] op_sel_hi:[1,0]
    v_pk_mul_f32 v[78:79], v[78:79], v[14:15] op_sel:[0,0] op_sel_hi:[1,0]
    s_waitcnt vmcnt(11)
    s_mov_b64 exec, s[6:7]
    v_lshrrev_b32 v30, 16, v30
    s_mov_b64 exec, -1
    v_and_b32 v46, 0x20000000, v31
    v_lshrrev_b32 v47, 14, v29
    v_bitop3_b32 v47, v47, v5, v46 bitop3:0xea
    ds_read_b64 v[102:103], v47
    v_and_b32 v99, 0x10000000, v31
    v_lshrrev_b32 v47, 14, v28
    v_bitop3_b32 v47, v47, v5, v99 bitop3:0xea
    ds_read_b64 v[100:101], v47
    s_waitcnt lgkmcnt(2)
    v_cmp_ne_u64 s[50:51], v[72:73], v[68:69]
    v_cmpx_ne_u64 s[54:55], v[74:75], v[70:71]
    s_and_b64 s[82:83], s[54:55], s[80:81]
    s_cbranch_scc1 L2_c128
L2_d128:
    v_mov_b64 v[84:85], v[70:71]
    v_mov_b32 v7, v93
    v_mov_b64 v[86:87], v[74:75]
    s_or_b64 s[80:81], s[80:81], s[54:55]
    s_mov_b64 exec, s[50:51]
    s_and_b64 s[82:83], s[50:51], s[80:81]
    s_cbranch_scc1 L2_c129
L2_d129:
    v_mov_b64 v[84:85], v[68:69]
    v_mov_b32 v7, v92
    v_mov_b64 v[86:87], v[72:73]
    s_mov_b64 exec, -1
    s_or_b64 s[80:81], s[80:81], s[50:51]
    s_and_b64 exec, s[84:85], s[80:81]
    v_mfma_f32_4x4x4_16b_bf16 v[76:79], v[12:13], v[84:85], 0
    v_mov_b32 v94, v7
    s_andn2_b64 s[80:81], s[80:81], s[84:85]
    v_mfma_f32_4x4x4_16b_bf16 v[76:79], v[10:11], v[86:87], v[76:79]
    s_mov_b64 exec, -1
    ds_read_b64 v[70:71], v95 offset:65408
    ds_read_b64 v[68:69], v94 offset:65408
    v_bitop3_b32 v92, v28, v5, v99 bitop3:0xea
    v_bitop3_b32 v93, v29, v5, v46 bitop3:0xea
    v_perm_b32 v15, v29, v30, s45
    v_bitop3_b32 v46, v29, 0.5, -0.5 bitop3:0xa8
    v_perm_b32 v14, v28, v30, s44
    v_bitop3_b32 v47, v28, 0.5, -0.5 bitop3:0xa8
    v_bitop3_b32 v15, v6, v15, v46 bitop3:0xca
    v_bitop3_b32 v14, v6, v14, v47 bitop3:0xca
    s_waitcnt lgkmcnt(1)
    v_mfma_f32_4x4x4_16b_bf16 v[80:83], v[10:11], v[70:71], v[80:83]
    s_waitcnt lgkmcnt(0)
    v_mfma_f32_4x4x4_16b_bf16 v[76:79], v[10:11], v[68:69], v[76:79]
    s_nop 2
    v_cvt_pk_bf16_f32 v80, v80, v81
    v_cvt_pk_bf16_f32 v81, v82, v83
    ds_wrxchg_rtn_b64 v[74:75], v95, v[80:81] offset:65408
    v_cvt_pk_bf16_f32 v76, v76, v77
    v_cvt_pk_bf16_f32 v77, v78, v79
    ds_wrxchg_rtn_b64 v[72:73], v94, v[76:77] offset:65408
    s_setprio 0
    v_mfma_f32_4x4x4_16b_bf16 v[80:83], v[8:9], v[102:103], 0
    v_mfma_f32_4x4x4_16b_bf16 v[76:79], v[8:9], v[100:101], 0
    v_cmp_lt_u32 s[48:49], v5, v93
    s_nop 2
    v_pk_mul_f32 v[80:81], v[80:81], v[14:15] op_sel:[0,1] op_sel_hi:[1,1]
    v_pk_mul_f32 v[82:83], v[82:83], v[14:15] op_sel:[0,1] op_sel_hi:[1,1]
    v_pk_mul_f32 v[76:77], v[76:77], v[14:15] op_sel:[0,0] op_sel_hi:[1,0]
    v_pk_mul_f32 v[78:79], v[78:79], v[14:15] op_sel:[0,0] op_sel_hi:[1,0]
    s_add_u32 s40, s40, 0xfff24000
    v_and_b32 v47, 0x0fffffff, v42
    v_mov_b32 v31, v42
    buffer_load_dword v30, v47, s[8:11], 0 offen offset:16
    s_mov_b64 exec, s[6:7]
    v_add_u32 v47, 8, v47
    v_lshrrev_b32 v31, 2, v31
    s_mov_b64 exec, -1
    buffer_load_dwordx2 v[28:29], v47, s[8:11], 0 offen
    s_waitcnt vmcnt(8)
    v_and_b32 v46, 0x80000000, v39
    v_lshrrev_b32 v47, 14, v37
    v_bitop3_b32 v47, v47, v5, v46 bitop3:0xea
    ds_read_b64 v[102:103], v47
    v_and_b32 v99, 0x40000000, v39
    v_lshrrev_b32 v47, 14, v36
    v_bitop3_b32 v47, v47, v5, v99 bitop3:0xea
    ds_read_b64 v[100:101], v47
    v_and_b32 v46, 0x20000000, v39
    v_lshrrev_b32 v47, 14, v35
    v_bitop3_b32 v47, v47, v5, v46 bitop3:0xea
    ds_read_b64 v[106:107], v47
    v_and_b32 v99, 0x10000000, v39
    v_lshrrev_b32 v47, 14, v34
    v_bitop3_b32 v47, v47, v5, v99 bitop3:0xea
    ds_read_b64 v[104:105], v47
    s_waitcnt lgkmcnt(4)
    v_cmp_ne_u64 s[50:51], v[72:73], v[68:69]
    v_cmpx_ne_u64 s[54:55], v[74:75], v[70:71]
    s_and_b64 s[82:83], s[54:55], s[80:81]
    s_cbranch_scc1 L2_c130
L2_d130:
    v_mov_b64 v[84:85], v[70:71]
    v_mov_b32 v7, v95
    v_mov_b64 v[86:87], v[74:75]
    s_or_b64 s[80:81], s[80:81], s[54:55]
    s_mov_b64 exec, s[50:51]
    s_and_b64 s[82:83], s[50:51], s[80:81]
    s_cbranch_scc1 L2_c131
L2_d131:
    v_mov_b64 v[84:85], v[68:69]
    v_mov_b32 v7, v94
    v_mov_b64 v[86:87], v[72:73]
    s_mov_b64 exec, -1
    s_or_b64 s[80:81], s[80:81], s[50:51]
    s_and_b64 exec, s[48:49], s[80:81]
    v_mfma_f32_4x4x4_16b_bf16 v[80:83], v[12:13], v[84:85], 0
    v_mov_b32 v93, v7
    s_andn2_b64 s[80:81], s[80:81], s[48:49]
    v_mfma_f32_4x4x4_16b_bf16 v[80:83], v[10:11], v[86:87], v[80:83]
    s_mov_b64 exec, -1
    ds_read_b64 v[70:71], v93 offset:65408
    ds_read_b64 v[68:69], v92 offset:65408
    v_bitop3_b32 v94, v34, v5, v99 bitop3:0xea
    v_bitop3_b32 v95, v35, v5, v46 bitop3:0xea
    v_perm_b32 v15, v35, v38, s45
    v_bitop3_b32 v46, v35, 0.5, -0.5 bitop3:0xa8
    v_perm_b32 v14, v34, v38, s44
    v_bitop3_b32 v47, v34, 0.5, -0.5 bitop3:0xa8
    v_bitop3_b32 v15, v6, v15, v46 bitop3:0xca
    v_bitop3_b32 v14, v6, v14, v47 bitop3:0xca
    s_waitcnt lgkmcnt(1)
    v_mfma_f32_4x4x4_16b_bf16 v[80:83], v[10:11], v[70:71], v[80:83]
    s_waitcnt lgkmcnt(0)
    v_mfma_f32_4x4x4_16b_bf16 v[76:79], v[10:11], v[68:69], v[76:79]
    s_nop 2
    v_cvt_pk_bf16_f32 v80, v80, v81
    v_cvt_pk_bf16_f32 v81, v82, v83
    ds_wrxchg_rtn_b64 v[74:75], v93, v[80:81] offset:65408
    v_cvt_pk_bf16_f32 v76, v76, v77
    v_cvt_pk_bf16_f32 v77, v78, v79
    ds_wrxchg_rtn_b64 v[72:73], v92, v[76:77] offset:65408
    s_barrier
    s_setprio 3
    s_mov_b32 m0, s100
    s_nop 0
    ds_write_addtid_b32 v124 offset:34816
    ds_write_addtid_b32 v125 offset:35072
    ds_write_addtid_b32 v126 offset:35328
    ds_write_addtid_b32 v127 offset:35584
    ds_write_addtid_b32 v116 offset:32768
    ds_write_addtid_b32 v117 offset:33024
    ds_write_addtid_b32 v118 offset:33280
    ds_write_addtid_b32 v119 offset:33536
    ds_write_addtid_b32 v120 offset:33792
    ds_write_addtid_b32 v121 offset:34048
    ds_write_addtid_b32 v122 offset:34304
    ds_write_addtid_b32 v123 offset:34560
    v_mfma_f32_4x4x4_16b_bf16 v[80:83], v[8:9], v[106:107], 0
    v_mfma_f32_4x4x4_16b_bf16 v[76:79], v[8:9], v[104:105], 0
    s_nop 3
    v_pk_mul_f32 v[80:81], v[80:81], v[14:15] op_sel:[0,1] op_sel_hi:[1,1]
    v_pk_mul_f32 v[82:83], v[82:83], v[14:15] op_sel:[0,1] op_sel_hi:[1,1]
    v_pk_mul_f32 v[76:77], v[76:77], v[14:15] op_sel:[0,0] op_sel_hi:[1,0]
    v_pk_mul_f32 v[78:79], v[78:79], v[14:15] op_sel:[0,0] op_sel_hi:[1,0]
    v_mov_b32 v44, v43
    s_setprio 2
    s_waitcnt lgkmcnt(12)
    v_cmp_ne_u64 s[50:51], v[72:73], v[68:69]
    v_cmpx_ne_u64 s[54:55], v[74:75], v[70:71]
    s_and_b64 s[82:83], s[54:55], s[80:81]
    s_cbranch_scc1 L2_c132
L2_d132:
    v_mov_b64 v[84:85], v[70:71]
    v_mov_b32 v7, v93
    v_mov_b64 v[86:87], v[74:75]
    s_or_b64 s[80:81], s[80:81], s[54:55]
    s_mov_b64 exec, s[50:51]
    s_and_b64 s[82:83], s[50:51], s[80:81]
    s_cbranch_scc1 L2_c133
L2_d133:
    v_mov_b64 v[84:85], v[68:69]
    v_mov_b32 v7, v92
    v_mov_b64 v[86:87], v[72:73]
    s_mov_b64 exec, -1
    s_or_b64 s[80:81], s[80:81], s[50:51]
    ds_read_b64 v[70:71], v95 offset:65408
    ds_read_b64 v[68:69], v94 offset:65408
    v_and_b32 v46, 0x40000000, v39
    v_bitop3_b32 v92, v36, v5, v46 bitop3:0xea
    v_and_b32 v46, 0x80000000, v39
    v_bitop3_b32 v93, v37, v5, v46 bitop3:0xea
    v_perm_b32 v15, v37, v38, s47
    v_bitop3_b32 v46, v37, 0.5, -0.5 bitop3:0xa8
    v_perm_b32 v14, v36, v38, s46
    v_bitop3_b32 v47, v36, 0.5, -0.5 bitop3:0xa8
    v_bitop3_b32 v15, v6, v15, v46 bitop3:0xca
    v_bitop3_b32 v14, v6, v14, v47 bitop3:0xca
    s_setprio 1
    s_waitcnt lgkmcnt(1)
    v_mfma_f32_4x4x4_16b_bf16 v[80:83], v[10:11], v[70:71], v[80:83]
    s_waitcnt lgkmcnt(0)
    v_mfma_f32_4x4x4_16b_bf16 v[76:79], v[10:11], v[68:69], v[76:79]
    s_nop 2
    v_cvt_pk_bf16_f32 v80, v80, v81
    v_cvt_pk_bf16_f32 v81, v82, v83
    ds_wrxchg_rtn_b64 v[74:75], v95, v[80:81] offset:65408
    v_cvt_pk_bf16_f32 v76, v76, v77
    v_cvt_pk_bf16_f32 v77, v78, v79
    ds_wrxchg_rtn_b64 v[72:73], v94, v[76:77] offset:65408
    v_and_b32 v88, 0x0fffffff, v44
    v_mov_b32 v39, v44
    buffer_load_dwordx2 v[34:35], v88, s[8:11], 0 offen
    buffer_load_dwordx3 v[36:38], v88, s[8:11], 0 offen offset:8
    s_setprio 0
    s_waitcnt vmcnt(9)
    s_mov_b32 m0, s38
    s_nop 0
    ds_write_addtid_b32 v108 offset:0
    ds_write_addtid_b32 v109 offset:256
    ds_write_addtid_b32 v110 offset:512
    ds_write_addtid_b32 v111 offset:768
    s_waitcnt vmcnt(6)
    ds_write_addtid_b32 v112 offset:1024
    ds_write_addtid_b32 v113 offset:1280
    ds_write_addtid_b32 v114 offset:1536
    ds_write_addtid_b32 v115 offset:1792
    v_mfma_f32_4x4x4_16b_bf16 v[80:83], v[8:9], v[102:103], 0
    v_mfma_f32_4x4x4_16b_bf16 v[76:79], v[8:9], v[100:101], 0
    v_cmp_lt_u32 s[84:85], v5, v92
    s_nop 2
    v_pk_mul_f32 v[80:81], v[80:81], v[14:15] op_sel:[0,1] op_sel_hi:[1,1]
    v_pk_mul_f32 v[82:83], v[82:83], v[14:15] op_sel:[0,1] op_sel_hi:[1,1]
    v_pk_mul_f32 v[76:77], v[76:77], v[14:15] op_sel:[0,0] op_sel_hi:[1,0]
    v_pk_mul_f32 v[78:79], v[78:79], v[14:15] op_sel:[0,0] op_sel_hi:[1,0]
    s_add_u32 s42, s42, 1
    s_waitcnt lgkmcnt(0)
    s_barrier
    s_bitcmp1_b32 s36, s42
    s_cbranch_scc1 L2_slow
L2_ret7:
    s_setprio 3
    s_bitcmp1_b32 s43, s42
    s_cbranch_scc1 L2_oa134
L2_ob134:
    v_and_b32 v46, 0x20000000, v21
    v_lshrrev_b32 v47, 14, v17
    v_bitop3_b32 v47, v47, v5, v46 bitop3:0xea
    ds_read_b64 v[106:107], v47
    v_and_b32 v99, 0x10000000, v21
    v_lshrrev_b32 v47, 14, v16
    v_bitop3_b32 v47, v47, v5, v99 bitop3:0xea
    ds_read_b64 v[104:105], v47
    v_cmp_ne_u64 s[50:51], v[72:73], v[68:69]
    v_cmpx_ne_u64 s[54:55], v[74:75], v[70:71]
    s_and_b64 s[82:83], s[54:55], s[80:81]
    s_cbranch_scc1 L2_c135
L2_d135:
    v_mov_b64 v[84:85], v[70:71]
    v_mov_b32 v7, v95
    v_mov_b64 v[86:87], v[74:75]
    s_or_b64 s[80:81], s[80:81], s[54:55]
    s_mov_b64 exec, s[50:51]
    s_and_b64 s[82:83], s[50:51], s[80:81]
    s_cbranch_scc1 L2_c136
L2_d136:
    v_mov_b64 v[84:85], v[68:69]
    v_mov_b32 v7, v94
    v_mov_b64 v[86:87], v[72:73]
    s_mov_b64 exec, -1
    s_or_b64 s[80:81], s[80:81], s[50:51]
    s_and_b64 exec, s[84:85], s[80:81]
    v_mfma_f32_4x4x4_16b_bf16 v[76:79], v[12:13], v[84:85], 0
    v_mov_b32 v92, v7
    s_andn2_b64 s[80:81], s[80:81], s[84:85]
    v_mfma_f32_4x4x4_16b_bf16 v[76:79], v[10:11], v[86:87], v[76:79]
    s_mov_b64 exec, -1
    ds_read_b64 v[70:71], v93 offset:65408
    ds_read_b64 v[68:69], v92 offset:65408
    v_bitop3_b32 v94, v16, v5, v99 bitop3:0xea
    v_bitop3_b32 v95, v17, v5, v46 bitop3:0xea
    v_perm_b32 v15, v17, v20, s45
    v_bitop3_b32 v46, v17, 0.5, -0.5 bitop3:0xa8
    v_perm_b32 v14, v16, v20, s44
    v_bitop3_b32 v47, v16, 0.5, -0.5 bitop3:0xa8
    v_bitop3_b32 v15, v6, v15, v46 bitop3:0xca
    v_bitop3_b32 v14, v6, v14, v47 bitop3:0xca
    s_waitcnt lgkmcnt(1)
    v_mfma_f32_4x4x4_16b_bf16 v[80:83], v[10:11], v[70:71], v[80:83]
    s_waitcnt lgkmcnt(0)
    v_mfma_f32_4x4x4_16b_bf16 v[76:79], v[10:11], v[68:69], v[76:79]
    s_nop 2
    v_cvt_pk_bf16_f32 v80, v80, v81
    v_cvt_pk_bf16_f32 v81, v82, v83
    ds_wrxchg_rtn_b64 v[74:75], v93, v[80:81] offset:65408
    v_cvt_pk_bf16_f32 v76, v76, v77
    v_cvt_pk_bf16_f32 v77, v78, v79
    ds_wrxchg_rtn_b64 v[72:73], v92, v[76:77] offset:65408
    v_mfma_f32_4x4x4_16b_bf16 v[80:83], v[8:9], v[106:107], 0
    v_mfma_f32_4x4x4_16b_bf16 v[76:79], v[8:9], v[104:105], 0
    v_cmp_lt_u32 s[84:85], v5, v94
    s_nop 2
    v_pk_mul_f32 v[80:81], v[80:81], v[14:15] op_sel:[0,1] op_sel_hi:[1,1]
    v_pk_mul_f32 v[82:83], v[82:83], v[14:15] op_sel:[0,1] op_sel_hi:[1,1]
    v_pk_mul_f32 v[76:77], v[76:77], v[14:15] op_sel:[0,0] op_sel_hi:[1,0]
    v_pk_mul_f32 v[78:79], v[78:79], v[14:15] op_sel:[0,0] op_sel_hi:[1,0]
    v_and_b32 v46, 0x80000000, v21
    v_lshrrev_b32 v47, 14, v19
    v_bitop3_b32 v47, v47, v5, v46 bitop3:0xea
    ds_read_b64 v[102:103], v47
    v_and_b32 v99, 0x40000000, v21
    v_lshrrev_b32 v47, 14, v18
    v_bitop3_b32 v47, v47, v5, v99 bitop3:0xea
    ds_read_b64 v[100:101], v47
    s_waitcnt lgkmcnt(2)
    v_cmp_ne_u64 s[50:51], v[72:73], v[68:69]
    v_cmpx_ne_u64 s[54:55], v[74:75], v[70:71]
    s_and_b64 s[82:83], s[54:55], s[80:81]
    s_cbranch_scc1 L2_c137
L2_d137:
    v_mov_b64 v[84:85], v[70:71]
    v_mov_b32 v7, v93
    v_mov_b64 v[86:87], v[74:75]
    s_or_b64 s[80:81], s[80:81], s[54:55]
    s_mov_b64 exec, s[50:51]
    s_and_b64 s[82:83], s[50:51], s[80:81]
    s_cbranch_scc1 L2_c138
L2_d138:
    v_mov_b64 v[84:85], v[68:69]
    v_mov_b32 v7, v92
    v_mov_b64 v[86:87], v[72:73]
    s_mov_b64 exec, -1
    s_or_b64 s[80:81], s[80:81], s[50:51]
    s_and_b64 exec, s[84:85], s[80:81]
    v_mfma_f32_4x4x4_16b_bf16 v[76:79], v[12:13], v[84:85], 0
    v_mov_b32 v94, v7
    s_andn2_b64 s[80:81], s[80:81], s[84:85]
    v_mfma_f32_4x4x4_16b_bf16 v[76:79], v[10:11], v[86:87], v[76:79]
    s_mov_b64 exec, -1
    ds_read_b64 v[70:71], v95 offset:65408
    ds_read_b64 v[68:69], v94 offset:65408
    v_bitop3_b32 v92, v18, v5, v99 bitop3:0xea
    v_bitop3_b32 v93, v19, v5, v46 bitop3:0xea
    v_perm_b32 v15, v19, v20, s47
    v_bitop3_b32 v46, v19, 0.5, -0.5 bitop3:0xa8
    v_perm_b32 v14, v18, v20, s46
    v_bitop3_b32 v47, v18, 0.5, -0.5 bitop3:0xa8
    v_bitop3_b32 v15, v6, v15, v46 bitop3:0xca
    v_bitop3_b32 v14, v6, v14, v47 bitop3:0xca
    s_waitcnt lgkmcnt(1)
    v_mfma_f32_4x4x4_16b_bf16 v[80:83], v[10:11], v[70:71], v[80:83]
    s_waitcnt lgkmcnt(0)
    v_mfma_f32_4x4x4_16b_bf16 v[76:79], v[10:11], v[68:69], v[76:79]
    s_nop 2
    v_cvt_pk_bf16_f32 v80, v80, v81
    v_cvt_pk_bf16_f32 v81, v82, v83
    ds_wrxchg_rtn_b64 v[74:75], v95, v[80:81] offset:65408
    v_cvt_pk_bf16_f32 v76, v76, v77
    v_cvt_pk_bf16_f32 v77, v78, v79
    ds_wrxchg_rtn_b64 v[72:73], v94, v[76:77] offset:65408
    s_setprio 2
    v_mfma_f32_4x4x4_16b_bf16 v[80:83], v[8:9], v[102:103], 0
    v_mfma_f32_4x4x4_16b_bf16 v[76:79], v[8:9], v[100:101], 0
    v_cmp_lt_u32 s[48:49], v5, v93
    s_nop 2
    v_pk_mul_f32 v[80:81], v[80:81], v[14:15] op_sel:[0,1] op_sel_hi:[1,1]
    v_pk_mul_f32 v[82:83], v[82:83], v[14:15] op_sel:[0,1] op_sel_hi:[1,1]
    v_pk_mul_f32 v[76:77], v[76:77], v[14:15] op_sel:[0,0] op_sel_hi:[1,0]
    v_pk_mul_f32 v[78:79], v[78:79], v[14:15] op_sel:[0,0] op_sel_hi:[1,0]
    s_waitcnt vmcnt(4)
    v_and_b32 v46, 0x20000000, v27
    v_lshrrev_b32 v47, 14, v23
    v_bitop3_b32 v47, v47, v5, v46 bitop3:0xea
    ds_read_b64 v[106:107], v47
    v_and_b32 v99, 0x10000000, v27
    v_lshrrev_b32 v47, 14, v22
    v_bitop3_b32 v47, v47, v5, v99 bitop3:0xea
    ds_read_b64 v[104:105], v47
    s_waitcnt lgkmcnt(2)
    v_cmp_ne_u64 s[50:51], v[72:73], v[68:69]
    v_cmpx_ne_u64 s[54:55], v[74:75], v[70:71]
    s_and_b64 s[82:83], s[54:55], s[80:81]
    s_cbranch_scc1 L2_c139
L2_d139:
    v_mov_b64 v[84:85], v[70:71]
    v_mov_b32 v7, v95
    v_mov_b64 v[86:87], v[74:75]
    s_or_b64 s[80:81], s[80:81], s[54:55]
    s_mov_b64 exec, s[50:51]
    s_and_b64 s[82:83], s[50:51], s[80:81]
    s_cbranch_scc1 L2_c140
L2_d140:
    v_mov_b64 v[84:85], v[68:69]
    v_mov_b32 v7, v94
    v_mov_b64 v[86:87], v[72:73]
    s_mov_b64 exec, -1
    s_or_b64 s[80:81], s[80:81], s[50:51]
    s_and_b64 exec, s[48:49], s[80:81]
    v_mfma_f32_4x4x4_16b_bf16 v[80:83], v[12:13], v[84:85], 0
    v_mov_b32 v93, v7
    s_andn2_b64 s[80:81], s[80:81], s[48:49]
    v_mfma_f32_4x4x4_16b_bf16 v[80:83], v[10:11], v[86:87], v[80:83]
    s_mov_b64 exec, -1
    ds_read_b64 v[70:71], v93 offset:65408
    ds_read_b64 v[68:69], v92 offset:65408
    v_bitop3_b32 v94, v22, v5, v99 bitop3:0xea
    v_bitop3_b32 v95, v23, v5, v46 bitop3:0xea
    v_perm_b32 v15, v23, v26, s45
    v_bitop3_b32 v46, v23, 0.5, -0.5 bitop3:0xa8
    v_perm_b32 v14, v22, v26, s44
    v_bitop3_b32 v47, v22, 0.5, -0.5 bitop3:0xa8
    v_bitop3_b32 v15, v6, v15, v46 bitop3:0xca
    v_bitop3_b32 v14, v6, v14, v47 bitop3:0xca
    s_waitcnt lgkmcnt(1)
    v_mfma_f32_4x4x4_16b_bf16 v[80:83], v[10:11], v[70:71], v[80:83]
    s_waitcnt lgkmcnt(0)
    v_mfma_f32_4x4x4_16b_bf16 v[76:79], v[10:11], v[68:69], v[76:79]
    s_nop 2
    v_cvt_pk_bf16_f32 v80, v80, v81
    v_cvt_pk_bf16_f32 v81, v82, v83
    ds_wrxchg_rtn_b64 v[74:75], v93, v[80:81] offset:65408
    v_cvt_pk_bf16_f32 v76, v76, v77
    v_cvt_pk_bf16_f32 v77, v78, v79
    ds_wrxchg_rtn_b64 v[72:73], v92, v[76:77] offset:65408
    s_setprio 1
    v_mfma_f32_4x4x4_16b_bf16 v[80:83], v[8:9], v[106:107], 0
    v_mfma_f32_4x4x4_16b_bf16 v[76:79], v[8:9], v[104:105], 0
    s_nop 3
    v_pk_mul_f32 v[80:81], v[80:81], v[14:15] op_sel:[0,1] op_sel_hi:[1,1]
    v_pk_mul_f32 v[82:83], v[82:83], v[14:15] op_sel:[0,1] op_sel_hi:[1,1]
    v_pk_mul_f32 v[76:77], v[76:77], v[14:15] op_sel:[0,0] op_sel_hi:[1,0]
    v_pk_mul_f32 v[78:79], v[78:79], v[14:15] op_sel:[0,0] op_sel_hi:[1,0]
    s_bitcmp1_b32 s43, s42
    s_cbranch_scc1 L2_oa141
L2_ob141:
    v_and_b32 v46, 0x80000000, v27
    v_lshrrev_b32 v47, 14, v25
    v_bitop3_b32 v47, v47, v5, v46 bitop3:0xea
    ds_read_b64 v[102:103], v47
    v_and_b32 v99, 0x40000000, v27
    v_lshrrev_b32 v47, 14, v24
    v_bitop3_b32 v47, v47, v5, v99 bitop3:0xea
    ds_read_b64 v[100:101], v47
    s_waitcnt lgkmcnt(2)
    v_cmp_ne_u64 s[50:51], v[72:73], v[68:69]
    v_cmpx_ne_u64 s[54:55], v[74:75], v[70:71]
    s_and_b64 s[82:83], s[54:55], s[80:81]
    s_cbranch_scc1 L2_c142
L2_d142:
    v_mov_b64 v[84:85], v[70:71]
    v_mov_b32 v7, v93
    v_mov_b64 v[86:87], v[74:75]
    s_or_b64 s[80:81], s[80:81], s[54:55]
    s_mov_b64 exec, s[50:51]
    s_and_b64 s[82:83], s[50:51], s[80:81]
    s_cbranch_scc1 L2_c143
L2_d143:
    v_mov_b64 v[84:85], v[68:69]
    v_mov_b32 v7, v92
    v_mov_b64 v[86:87], v[72:73]
    s_mov_b64 exec, -1
    s_or_b64 s[80:81], s[80:81], s[50:51]
    ds_read_b64 v[70:71], v95 offset:65408
    ds_read_b64 v[68:69], v94 offset:65408
    v_bitop3_b32 v92, v24, v5, v99 bitop3:0xea
    v_bitop3_b32 v93, v25, v5, v46 bitop3:0xea
    v_perm_b32 v15, v25, v26, s47
    v_bitop3_b32 v46, v25, 0.5, -0.5 bitop3:0xa8
    v_perm_b32 v14, v24, v26, s46
    v_bitop3_b32 v47, v24, 0.5, -0.5 bitop3:0xa8
    v_bitop3_b32 v15, v6, v15, v46 bitop3:0xca
    v_bitop3_b32 v14, v6, v14, v47 bitop3:0xca
    s_waitcnt lgkmcnt(1)
    v_mfma_f32_4x4x4_16b_bf16 v[80:83], v[10:11], v[70:71], v[80:83]
    s_waitcnt lgkmcnt(0)
    v_mfma_f32_4x4x4_16b_bf16 v[76:79], v[10:11], v[68:69], v[76:79]
    s_nop 2
    v_cvt_pk_bf16_f32 v80, v80, v81
    v_cvt_pk_bf16_f32 v81, v82, v83
    ds_wrxchg_rtn_b64 v[74:75], v95, v[80:81] offset:65408
    v_cvt_pk_bf16_f32 v76, v76, v77
    v_cvt_pk_bf16_f32 v77, v78, v79
    ds_wrxchg_rtn_b64 v[72:73], v94, v[76:77] offset:65408
    v_mfma_f32_4x4x4_16b_bf16 v[80:83], v[8:9], v[102:103], 0
    v_mfma_f32_4x4x4_16b_bf16 v[76:79], v[8:9], v[100:101], 0
    v_cmp_lt_u32 s[84:85], v5, v92
    s_nop 2
    v_pk_mul_f32 v[80:81], v[80:81], v[14:15] op_sel:[0,1] op_sel_hi:[1,1]
    v_pk_mul_f32 v[82:83], v[82:83], v[14:15] op_sel:[0,1] op_sel_hi:[1,1]
    v_pk_mul_f32 v[76:77], v[76:77], v[14:15] op_sel:[0,0] op_sel_hi:[1,0]
    v_pk_mul_f32 v[78:79], v[78:79], v[14:15] op_sel:[0,0] op_sel_hi:[1,0]
    s_lshl_b32 s3, s32, 12
    v_subrev_u32 v122, s3, v3
    s_mul_i32 s3, s33, 20000
    v_add_u32 v118, s3, v122
    v_add_u32 v119, 0x4000, v118
    s_lshl_b32 s3, s34, 7
    v_lshrrev_b32 v123, 7, v118
    v_and_b32 v120, 0x70, v118
    v_lshl_add_u32 v120, v123, 13, v120
    v_add_u32 v120, s3, v120
    v_lshrrev_b32 v123, 7, v119
    v_and_b32 v121, 0x70, v119
    v_lshl_add_u32 v121, v123, 13, v121
    v_add_u32 v121, s3, v121
    v_cmp_le_u32 vcc, 3616, v122
    s_mov_b64 exec, vcc
    v_mov_b32 v119, 2.0
    v_mov_b32 v121, 2.0
    s_mov_b64 exec, -1
    v_and_b32 v123, 0x30, v122
    v_lshlrev_b32 v123, 2, v123
    buffer_load_dwordx4 v[48:51], v123, s[24:27], 0 offen
    buffer_load_dwordx4 v[52:55], v123, s[24:27], 0 offen offset:16
    buffer_load_dwordx2 v[56:57], v123, s[24:27], 0 offen offset:32
    s_mov_b32 s12, s4
    s_mov_b32 s13, s5
    s_mov_b32 s14, 0x138800
    s_mov_b32 s15, 0x20000
    s_mov_b32 s16, s28
    s_mov_b32 s17, s29
    s_mov_b32 s18, 0x4e2000
    s_mov_b32 s19, 0x20000
    v_lshrrev_b32 v123, 2, v120
    buffer_load_dword v116, v123, s[12:15], 0 offen
    buffer_load_dwordx4 v[108:111], v120, s[16:19], 0 offen
    v_lshrrev_b32 v123, 2, v121
    buffer_load_dword v117, v123, s[12:15], 0 offen
    buffer_load_dwordx4 v[112:115], v121, s[16:19], 0 offen
    s_waitcnt vmcnt(9)
    s_mov_b64 exec, s[6:7]
    v_lshrrev_b32 v30, 16, v30
    s_mov_b64 exec, -1
    v_and_b32 v46, 0x20000000, v31
    v_lshrrev_b32 v47, 14, v29
    v_bitop3_b32 v47, v47, v5, v46 bitop3:0xea
    ds_read_b64 v[106:107], v47
    v_and_b32 v99, 0x10000000, v31
    v_lshrrev_b32 v47, 14, v28
    v_bitop3_b32 v47, v47, v5, v99 bitop3:0xea
    ds_read_b64 v[104:105], v47
    s_waitcnt lgkmcnt(2)
    v_cmp_ne_u64 s[50:51], v[72:73], v[68:69]
    v_cmpx_ne_u64 s[54:55], v[74:75], v[70:71]
    s_and_b64 s[82:83], s[54:55], s[80:81]
    s_cbranch_scc1 L2_c144
L2_d144:
    v_mov_b64 v[84:85], v[70:71]
    v_mov_b32 v7, v95
    v_mov_b64 v[86:87], v[74:75]
    s_or_b64 s[80:81], s[80:81], s[54:55]
    s_mov_b64 exec, s[50:51]
    s_and_b64 s[82:83], s[50:51], s[80:81]
    s_cbranch_scc1 L2_c145
L2_d145:
    v_mov_b64 v[84:85], v[68:69]
    v_mov_b32 v7, v94
    v_mov_b64 v[86:87], v[72:73]
    s_mov_b64 exec, -1
    s_or_b64 s[80:81], s[80:81], s[50:51]
    s_and_b64 exec, s[84:85], s[80:81]
    v_mfma_f32_4x4x4_16b_bf16 v[76:79], v[12:13], v[84:85], 0
    v_mov_b32 v92, v7
    s_andn2_b64 s[80:81], s[80:81], s[84:85]
    v_mfma_f32_4x4x4_16b_bf16 v[76:79], v[10:11], v[86:87], v[76:79]
    s_mov_b64 exec, -1
    ds_read_b64 v[70:71], v93 offset:65408
    ds_read_b64 v[68:69], v92 offset:65408
    v_bitop3_b32 v94, v28, v5, v99 bitop3:0xea
    v_bitop3_b32 v95, v29, v5, v46 bitop3:0xea
    v_perm_b32 v15, v29, v30, s45
    v_bitop3_b32 v46, v29, 0.5, -0.5 bitop3:0xa8
    v_perm_b32 v14, v28, v30, s44
    v_bitop3_b32 v47, v28, 0.5, -0.5 bitop3:0xa8
    v_bitop3_b32 v15, v6, v15, v46 bitop3:0xca
    v_bitop3_b32 v14, v6, v14, v47 bitop3:0xca
    s_waitcnt lgkmcnt(1)
    v_mfma_f32_4x4x4_16b_bf16 v[80:83], v[10:11], v[70:71], v[80:83]
    s_waitcnt lgkmcnt(0)
    v_mfma_f32_4x4x4_16b_bf16 v[76:79], v[10:11], v[68:69], v[76:79]
    s_nop 2
    v_cvt_pk_bf16_f32 v80, v80, v81
    v_cvt_pk_bf16_f32 v81, v82, v83
    ds_wrxchg_rtn_b64 v[74:75], v93, v[80:81] offset:65408
    v_cvt_pk_bf16_f32 v76, v76, v77
    v_cvt_pk_bf16_f32 v77, v78, v79
    ds_wrxchg_rtn_b64 v[72:73], v92, v[76:77] offset:65408
    s_setprio 0
    v_mfma_f32_4x4x4_16b_bf16 v[80:83], v[8:9], v[106:107], 0
    v_mfma_f32_4x4x4_16b_bf16 v[76:79], v[8:9], v[104:105], 0
    v_cmp_lt_u32 s[48:49], v5, v95
    s_nop 2
    v_pk_mul_f32 v[80:81], v[80:81], v[14:15] op_sel:[0,1] op_sel_hi:[1,1]
    v_pk_mul_f32 v[82:83], v[82:83], v[14:15] op_sel:[0,1] op_sel_hi:[1,1]
    v_pk_mul_f32 v[76:77], v[76:77], v[14:15] op_sel:[0,0] op_sel_hi:[1,0]
    v_pk_mul_f32 v[78:79], v[78:79], v[14:15] op_sel:[0,0] op_sel_hi:[1,0]
    s_waitcnt vmcnt(7)
    v_and_b32 v46, 0x80000000, v39
    v_lshrrev_b32 v47, 14, v37
    v_bitop3_b32 v47, v47, v5, v46 bitop3:0xea
    ds_read_b64 v[106:107], v47
    v_and_b32 v99, 0x40000000, v39
    v_lshrrev_b32 v47, 14, v36
    v_bitop3_b32 v47, v47, v5, v99 bitop3:0xea
    ds_read_b64 v[104:105], v47
    v_and_b32 v46, 0x20000000, v39
    v_lshrrev_b32 v47, 14, v35
    v_bitop3_b32 v47, v47, v5, v46 bitop3:0xea
    ds_read_b64 v[102:103], v47
    v_and_b32 v99, 0x10000000, v39
    v_lshrrev_b32 v47, 14, v34
    v_bitop3_b32 v47, v47, v5, v99 bitop3:0xea
    ds_read_b64 v[100:101], v47
    s_waitcnt lgkmcnt(4)
    v_cmp_ne_u64 s[50:51], v[72:73], v[68:69]
    v_cmpx_ne_u64 s[54:55], v[74:75], v[70:71]
    s_and_b64 s[82:83], s[54:55], s[80:81]
    s_cbranch_scc1 L2_c146
L2_d146:
    v_mov_b64 v[84:85], v[70:71]
    v_mov_b32 v7, v93
    v_mov_b64 v[86:87], v[74:75]
    s_or_b64 s[80:81], s[80:81], s[54:55]
    s_mov_b64 exec, s[50:51]
    s_and_b64 s[82:83], s[50:51], s[80:81]
    s_cbranch_scc1 L2_c147
L2_d147:
    v_mov_b64 v[84:85], v[68:69]
    v_mov_b32 v7, v92
    v_mov_b64 v[86:87], v[72:73]
    s_mov_b64 exec, -1
    s_or_b64 s[80:81], s[80:81], s[50:51]
    s_and_b64 exec, s[48:49], s[80:81]
    v_mfma_f32_4x4x4_16b_bf16 v[80:83], v[12:13], v[84:85], 0
    v_mov_b32 v95, v7
    s_andn2_b64 s[80:81], s[80:81], s[48:49]
    v_mfma_f32_4x4x4_16b_bf16 v[80:83], v[10:11], v[86:87], v[80:83]
    s_mov_b64 exec, -1
    ds_read_b64 v[70:71], v95 offset:65408
    ds_read_b64 v[68:69], v94 offset:65408
    v_bitop3_b32 v92, v34, v5, v99 bitop3:0xea
    v_bitop3_b32 v93, v35, v5, v46 bitop3:0xea
    v_perm_b32 v15, v35, v38, s45
    v_bitop3_b32 v46, v35, 0.5, -0.5 bitop3:0xa8
    v_perm_b32 v14, v34, v38, s44
    v_bitop3_b32 v47, v34, 0.5, -0.5 bitop3:0xa8
    v_bitop3_b32 v15, v6, v15, v46 bitop3:0xca
    v_bitop3_b32 v14, v6, v14, v47 bitop3:0xca
    s_waitcnt lgkmcnt(1)
    v_mfma_f32_4x4x4_16b_bf16 v[80:83], v[10:11], v[70:71], v[80:83]
    s_waitcnt lgkmcnt(0)
    v_mfma_f32_4x4x4_16b_bf16 v[76:79], v[10:11], v[68:69], v[76:79]
    s_nop 2
    v_cvt_pk_bf16_f32 v80, v80, v81
    v_cvt_pk_bf16_f32 v81, v82, v83
    ds_wrxchg_rtn_b64 v[74:75], v95, v[80:81] offset:65408
    v_cvt_pk_bf16_f32 v76, v76, v77
    v_cvt_pk_bf16_f32 v77, v78, v79
    ds_wrxchg_rtn_b64 v[72:73], v94, v[76:77] offset:65408
    v_mfma_f32_4x4x4_16b_bf16 v[80:83], v[8:9], v[102:103], 0
    v_mfma_f32_4x4x4_16b_bf16 v[76:79], v[8:9], v[100:101], 0
    s_nop 3
    v_pk_mul_f32 v[80:81], v[80:81], v[14:15] op_sel:[0,1] op_sel_hi:[1,1]
    v_pk_mul_f32 v[82:83], v[82:83], v[14:15] op_sel:[0,1] op_sel_hi:[1,1]
    v_pk_mul_f32 v[76:77], v[76:77], v[14:15] op_sel:[0,0] op_sel_hi:[1,0]
    v_pk_mul_f32 v[78:79], v[78:79], v[14:15] op_sel:[0,0] op_sel_hi:[1,0]
    s_waitcnt lgkmcnt(0)
    v_cmp_ne_u64 s[50:51], v[72:73], v[68:69]
    v_cmpx_ne_u64 s[54:55], v[74:75], v[70:71]
    s_and_b64 s[82:83], s[54:55], s[80:81]
    s_cbranch_scc1 L2_c148
L2_d148:
    v_mov_b64 v[84:85], v[70:71]
    v_mov_b32 v7, v95
    v_mov_b64 v[86:87], v[74:75]
    s_or_b64 s[80:81], s[80:81], s[54:55]
    s_mov_b64 exec, s[50:51]
    s_and_b64 s[82:83], s[50:51], s[80:81]
    s_cbranch_scc1 L2_c149
L2_d149:
    v_mov_b64 v[84:85], v[68:69]
    v_mov_b32 v7, v94
    v_mov_b64 v[86:87], v[72:73]
    s_mov_b64 exec, -1
    s_or_b64 s[80:81], s[80:81], s[50:51]
    ds_read_b64 v[70:71], v93 offset:65408
    ds_read_b64 v[68:69], v92 offset:65408
    v_and_b32 v46, 0x40000000, v39
    v_bitop3_b32 v94, v36, v5, v46 bitop3:0xea
    v_and_b32 v46, 0x80000000, v39
    v_bitop3_b32 v95, v37, v5, v46 bitop3:0xea
    v_perm_b32 v15, v37, v38, s47
    v_bitop3_b32 v46, v37, 0.5, -0.5 bitop3:0xa8
    v_perm_b32 v14, v36, v38, s46
    v_bitop3_b32 v47, v36, 0.5, -0.5 bitop3:0xa8
    v_bitop3_b32 v15, v6, v15, v46 bitop3:0xca
    v_bitop3_b32 v14, v6, v14, v47 bitop3:0xca
    s_waitcnt lgkmcnt(1)
    v_mfma_f32_4x4x4_16b_bf16 v[80:83], v[10:11], v[70:71], v[80:83]
    s_waitcnt lgkmcnt(0)
    v_mfma_f32_4x4x4_16b_bf16 v[76:79], v[10:11], v[68:69], v[76:79]
    s_nop 2
    v_cvt_pk_bf16_f32 v80, v80, v81
    v_cvt_pk_bf16_f32 v81, v82, v83
    ds_wrxchg_rtn_b64 v[74:75], v93, v[80:81] offset:65408
    v_cvt_pk_bf16_f32 v76, v76, v77
    v_cvt_pk_bf16_f32 v77, v78, v79
    ds_wrxchg_rtn_b64 v[72:73], v92, v[76:77] offset:65408
    v_mfma_f32_4x4x4_16b_bf16 v[80:83], v[8:9], v[106:107], 0
    v_mfma_f32_4x4x4_16b_bf16 v[76:79], v[8:9], v[104:105], 0
    v_cmp_lt_u32 s[84:85], v5, v94
    s_nop 2
    v_pk_mul_f32 v[80:81], v[80:81], v[14:15] op_sel:[0,1] op_sel_hi:[1,1]
    v_pk_mul_f32 v[82:83], v[82:83], v[14:15] op_sel:[0,1] op_sel_hi:[1,1]
    v_pk_mul_f32 v[76:77], v[76:77], v[14:15] op_sel:[0,0] op_sel_hi:[1,0]
    v_pk_mul_f32 v[78:79], v[78:79], v[14:15] op_sel:[0,0] op_sel_hi:[1,0]
    s_waitcnt lgkmcnt(0)
    v_cmp_ne_u64 s[50:51], v[72:73], v[68:69]
    v_cmpx_ne_u64 s[54:55], v[74:75], v[70:71]
    s_and_b64 s[82:83], s[54:55], s[80:81]
    s_cbranch_scc1 L2_c150
L2_d150:
    v_mov_b64 v[84:85], v[70:71]
    v_mov_b32 v7, v93
    v_mov_b64 v[86:87], v[74:75]
    s_or_b64 s[80:81], s[80:81], s[54:55]
    s_mov_b64 exec, s[50:51]
    s_and_b64 s[82:83], s[50:51], s[80:81]
    s_cbranch_scc1 L2_c151
L2_d151:
    v_mov_b64 v[84:85], v[68:69]
    v_mov_b32 v7, v92
    v_mov_b64 v[86:87], v[72:73]
    s_mov_b64 exec, -1
    s_or_b64 s[80:81], s[80:81], s[50:51]
    s_and_b64 exec, s[84:85], s[80:81]
    v_mfma_f32_4x4x4_16b_bf16 v[76:79], v[12:13], v[84:85], 0
    v_mov_b32 v94, v7
    s_andn2_b64 s[80:81], s[80:81], s[84:85]
    v_mfma_f32_4x4x4_16b_bf16 v[76:79], v[10:11], v[86:87], v[76:79]
    s_mov_b64 exec, -1
    ds_read_b64 v[70:71], v95 offset:65408
    ds_read_b64 v[68:69], v94 offset:65408
    s_waitcnt lgkmcnt(1)
    v_mfma_f32_4x4x4_16b_bf16 v[80:83], v[10:11], v[70:71], v[80:83]
    s_waitcnt lgkmcnt(0)
    v_mfma_f32_4x4x4_16b_bf16 v[76:79], v[10:11], v[68:69], v[76:79]
    s_nop 2
    v_cvt_pk_bf16_f32 v80, v80, v81
    v_cvt_pk_bf16_f32 v81, v82, v83
    ds_wrxchg_rtn_b64 v[74:75], v95, v[80:81] offset:65408
    v_cvt_pk_bf16_f32 v76, v76, v77
    v_cvt_pk_bf16_f32 v77, v78, v79
    ds_wrxchg_rtn_b64 v[72:73], v94, v[76:77] offset:65408
    s_waitcnt lgkmcnt(0)
    v_cmpx_ne_u64 vcc, v[74:75], v[70:71]
    s_and_b64 s[82:83], vcc, s[80:81]
    s_cbranch_scc1 L2_c152
L2_d152:
    v_mov_b64 v[84:85], v[70:71]
    v_mov_b32 v7, v95
    v_mov_b64 v[86:87], v[74:75]
    s_mov_b64 exec, -1
    s_or_b64 s[80:81], s[80:81], vcc
    v_cmpx_ne_u64 vcc, v[72:73], v[68:69]
    s_and_b64 s[82:83], vcc, s[80:81]
    s_cbranch_scc1 L2_c153
L2_d153:
    v_mov_b64 v[84:85], v[68:69]
    v_mov_b32 v7, v94
    v_mov_b64 v[86:87], v[72:73]
    s_mov_b64 exec, -1
    s_or_b64 s[80:81], s[80:81], vcc
    s_mov_b64 exec, s[80:81]
    ds_read_b64 v[68:69], v7 offset:65408
    v_mfma_f32_4x4x4_16b_bf16 v[76:79], v[12:13], v[84:85], 0
    s_nop 1
    v_mfma_f32_4x4x4_16b_bf16 v[76:79], v[10:11], v[86:87], v[76:79]
    s_waitcnt lgkmcnt(0)
    s_nop 0
    v_mfma_f32_4x4x4_16b_bf16 v[76:79], v[10:11], v[68:69], v[76:79]
    v_mov_b64 v[84:85], v[68:69]
    s_nop 3
    v_cvt_pk_bf16_f32 v76, v76, v77
    v_cvt_pk_bf16_f32 v77, v78, v79
    ds_wrxchg_rtn_b64 v[86:87], v7, v[76:77] offset:65408
    s_waitcnt lgkmcnt(0)
    v_cmp_ne_u64 s[80:81], v[86:87], v[84:85]
    s_mov_b64 exec, s[80:81]
    s_nop 1
    v_mfma_f32_4x4x4_16b_bf16 v[88:91], v[12:13], v[84:85], 0
    s_nop 1
    v_mfma_f32_4x4x4_16b_bf16 v[88:91], v[10:11], v[86:87], v[88:91]
    s_nop 4
    v_cvt_pk_bf16_f32 v88, v88, v89
    v_cvt_pk_bf16_f32 v89, v90, v91
    ds_pk_add_bf16 v7, v88 offset:65408
    ds_pk_add_bf16 v7, v89 offset:65412
    s_mov_b64 exec, -1
    s_load_dwordx2 s[4:5], s[0:1], 88
    v_add_u32 v123, 0x4000, v122
    s_lshl_b32 s50, s96, 16
    s_and_b32 s51, s96, 0xffff0000
    s_lshl_b32 s52, s97, 16
    s_and_b32 s53, s97, 0xffff0000
    s_lshl_b32 s54, s98, 16
    s_and_b32 s55, s98, 0xffff0000
    s_lshl_b32 s56, s99, 16
    s_and_b32 s57, s99, 0xffff0000
    s_waitcnt vmcnt(0) lgkmcnt(0)
    s_barrier
    s_add_u32 s8, s30, 0xec46000
    s_addc_u32 s9, s31, 0
    s_mov_b32 s10, 0x8000
    s_mov_b32 s11, 0x20000
    s_mov_b32 s12, s4
    s_mov_b32 s13, s5
    s_mov_b32 s14, 0x4e2000
    s_mov_b32 s15, 0x20000
    s_add_u32 s20, s30, 0xd845000
    s_addc_u32 s21, s31, 0
    s_mov_b32 s22, 0x1400000
    s_mov_b32 s23, 0x20000
    s_lshl2_add_u32 s4, s34, s33
    s_mul_i32 s4, s4, 81920
    s_add_u32 s3, s33, 1
    s_and_b32 s3, s3, 3
    s_mul_i32 s36, s3, 20000
    s_add_u32 s36, s36, 81920
    s_mul_i32 s40, s3, 20480
    s_add_u32 s40, s40, s4
    s_lshl2_add_u32 s3, s34, s3
    s_mul_i32 s3, s3, 81920
    s_mul_i32 s44, s33, 20480
    s_add_u32 s44, s44, s3
    s_add_u32 s3, s33, 2
    s_and_b32 s3, s3, 3
    s_mul_i32 s37, s3, 20000
    s_add_u32 s37, s37, 81920
    s_mul_i32 s41, s3, 20480
    s_add_u32 s41, s41, s4
    s_lshl2_add_u32 s3, s34, s3
    s_mul_i32 s3, s3, 81920
    s_mul_i32 s45, s33, 20480
    s_add_u32 s45, s45, s3
    s_add_u32 s3, s33, 3
    s_and_b32 s3, s3, 3
    s_mul_i32 s38, s3, 20000
    s_add_u32 s38, s38, 81920
    s_mul_i32 s42, s3, 20480
    s_add_u32 s42, s42, s4
    s_lshl2_add_u32 s3, s34, s3
    s_mul_i32 s3, s3, 81920
    s_mul_i32 s46, s33, 20480
    s_add_u32 s46, s46, s3
    v_add_u32 v104, s36, v122
    ds_read_b128 v[16:19], v104
    v_add_u32 v104, s37, v122
    ds_read_b128 v[20:23], v104
    v_add_u32 v104, s38, v122
    ds_read_b128 v[24:27], v104
    s_waitcnt lgkmcnt(2)
    buffer_store_dwordx4 v[16:19], v122, s[20:23], s40 offen sc1
    s_waitcnt lgkmcnt(1)
    buffer_store_dwordx4 v[20:23], v122, s[20:23], s41 offen sc1
    s_waitcnt lgkmcnt(0)
    buffer_store_dwordx4 v[24:27], v122, s[20:23], s42 offen sc1
    s_cmp_ge_u32 s32, 4
    s_cbranch_scc1 L2_g0
    v_add_u32 v104, s36, v123
    ds_read_b128 v[36:39], v104
    v_add_u32 v104, s37, v123
    ds_read_b128 v[40:43], v104
    v_add_u32 v104, s38, v123
    ds_read_b128 v[44:47], v104
    s_waitcnt lgkmcnt(2)
    buffer_store_dwordx4 v[36:39], v123, s[20:23], s40 offen sc1
    s_waitcnt lgkmcnt(1)
    buffer_store_dwordx4 v[40:43], v123, s[20:23], s41 offen sc1
    s_waitcnt lgkmcnt(0)
    buffer_store_dwordx4 v[44:47], v123, s[20:23], s42 offen sc1
L2_g0:
    v_lshlrev_b32 v80, 16, v116
    v_subrev_f32 v60, s50, v80
    v_subrev_f32 v61, s51, v80
    v_subrev_f32 v62, s52, v80
    v_subrev_f32 v63, s53, v80
    v_subrev_f32 v64, s54, v80
    v_subrev_f32 v65, s55, v80
    v_subrev_f32 v66, s56, v80
    v_subrev_f32 v67, s57, v80
    v_cvt_pk_bf16_f32 v68, v60, v61
    v_cvt_pk_bf16_f32 v69, v62, v63
    v_cvt_pk_bf16_f32 v70, v64, v65
    v_cvt_pk_bf16_f32 v71, v66, v67
    v_lshlrev_b32 v60, 16, v68
    v_and_b32 v61, 0xffff0000, v68
    v_lshlrev_b32 v62, 16, v69
    v_and_b32 v63, 0xffff0000, v69
    v_lshlrev_b32 v64, 16, v70
    v_and_b32 v65, 0xffff0000, v70
    v_lshlrev_b32 v66, 16, v71
    v_and_b32 v67, 0xffff0000, v71
    v_mul_f32 v60, v60, v60
    v_mul_f32 v61, v61, v61
    v_mul_f32 v62, v62, v62
    v_mul_f32 v63, v63, v63
    v_mul_f32 v64, v64, v64
    v_mul_f32 v65, v65, v65
    v_mul_f32 v66, v66, v66
    v_mul_f32 v67, v67, v67
    v_cvt_pk_bf16_f32 v68, v60, v61
    v_cvt_pk_bf16_f32 v69, v62, v63
    v_cvt_pk_bf16_f32 v70, v64, v65
    v_cvt_pk_bf16_f32 v71, v66, v67
    v_lshlrev_b32 v60, 16, v68
    v_and_b32 v61, 0xffff0000, v68
    v_lshlrev_b32 v62, 16, v69
    v_and_b32 v63, 0xffff0000, v69
    v_lshlrev_b32 v64, 16, v70
    v_and_b32 v65, 0xffff0000, v70
    v_lshlrev_b32 v66, 16, v71
    v_and_b32 v67, 0xffff0000, v71
    v_mul_f32 v60, 0xc1200000, v60
    v_mul_f32 v61, 0xc1200000, v61
    v_mul_f32 v62, 0xc1200000, v62
    v_mul_f32 v63, 0xc1200000, v63
    v_mul_f32 v64, 0xc1200000, v64
    v_mul_f32 v65, 0xc1200000, v65
    v_mul_f32 v66, 0xc1200000, v66
    v_mul_f32 v67, 0xc1200000, v67
    v_cvt_pk_bf16_f32 v68, v60, v61
    v_cvt_pk_bf16_f32 v69, v62, v63
    v_cvt_pk_bf16_f32 v70, v64, v65
    v_cvt_pk_bf16_f32 v71, v66, v67
    v_lshlrev_b32 v60, 16, v68
    v_and_b32 v61, 0xffff0000, v68
    v_lshlrev_b32 v62, 16, v69
    v_and_b32 v63, 0xffff0000, v69
    v_lshlrev_b32 v64, 16, v70
    v_and_b32 v65, 0xffff0000, v70
    v_lshlrev_b32 v66, 16, v71
    v_and_b32 v67, 0xffff0000, v71
    v_mul_f32 v60, 0x3fb8aa3b, v60
    v_mul_f32 v61, 0x3fb8aa3b, v61
    v_mul_f32 v62, 0x3fb8aa3b, v62
    v_mul_f32 v63, 0x3fb8aa3b, v63
    v_mul_f32 v64, 0x3fb8aa3b, v64
    v_mul_f32 v65, 0x3fb8aa3b, v65
    v_mul_f32 v66, 0x3fb8aa3b, v66
    v_mul_f32 v67, 0x3fb8aa3b, v67
    v_exp_f32 v60, v60
    v_exp_f32 v61, v61
    v_exp_f32 v62, v62
    v_exp_f32 v63, v63
    v_exp_f32 v64, v64
    v_exp_f32 v65, v65
    v_exp_f32 v66, v66
    v_exp_f32 v67, v67
    v_cvt_pk_bf16_f32 v72, v60, v61
    v_cvt_pk_bf16_f32 v73, v62, v63
    v_cvt_pk_bf16_f32 v74, v64, v65
    v_cvt_pk_bf16_f32 v75, v66, v67
    v_and_b32 v84, 0xffff0000, v116
    v_subrev_f32 v60, s50, v84
    v_subrev_f32 v61, s51, v84
    v_subrev_f32 v62, s52, v84
    v_subrev_f32 v63, s53, v84
    v_subrev_f32 v64, s54, v84
    v_subrev_f32 v65, s55, v84
    v_subrev_f32 v66, s56, v84
    v_subrev_f32 v67, s57, v84
    v_cvt_pk_bf16_f32 v68, v60, v61
    v_cvt_pk_bf16_f32 v69, v62, v63
    v_cvt_pk_bf16_f32 v70, v64, v65
    v_cvt_pk_bf16_f32 v71, v66, v67
    v_lshlrev_b32 v60, 16, v68
    v_and_b32 v61, 0xffff0000, v68
    v_lshlrev_b32 v62, 16, v69
    v_and_b32 v63, 0xffff0000, v69
    v_lshlrev_b32 v64, 16, v70
    v_and_b32 v65, 0xffff0000, v70
    v_lshlrev_b32 v66, 16, v71
    v_and_b32 v67, 0xffff0000, v71
    v_mul_f32 v60, v60, v60
    v_mul_f32 v61, v61, v61
    v_mul_f32 v62, v62, v62
    v_mul_f32 v63, v63, v63
    v_mul_f32 v64, v64, v64
    v_mul_f32 v65, v65, v65
    v_mul_f32 v66, v66, v66
    v_mul_f32 v67, v67, v67
    v_cvt_pk_bf16_f32 v68, v60, v61
    v_cvt_pk_bf16_f32 v69, v62, v63
    v_cvt_pk_bf16_f32 v70, v64, v65
    v_cvt_pk_bf16_f32 v71, v66, v67
    v_lshlrev_b32 v60, 16, v68
    v_and_b32 v61, 0xffff0000, v68
    v_lshlrev_b32 v62, 16, v69
    v_and_b32 v63, 0xffff0000, v69
    v_lshlrev_b32 v64, 16, v70
    v_and_b32 v65, 0xffff0000, v70
    v_lshlrev_b32 v66, 16, v71
    v_and_b32 v67, 0xffff0000, v71
    v_mul_f32 v60, 0xc1200000, v60
    v_mul_f32 v61, 0xc1200000, v61
    v_mul_f32 v62, 0xc1200000, v62
    v_mul_f32 v63, 0xc1200000, v63
    v_mul_f32 v64, 0xc1200000, v64
    v_mul_f32 v65, 0xc1200000, v65
    v_mul_f32 v66, 0xc1200000, v66
    v_mul_f32 v67, 0xc1200000, v67
    v_cvt_pk_bf16_f32 v68, v60, v61
    v_cvt_pk_bf16_f32 v69, v62, v63
    v_cvt_pk_bf16_f32 v70, v64, v65
    v_cvt_pk_bf16_f32 v71, v66, v67
    v_lshlrev_b32 v60, 16, v68
    v_and_b32 v61, 0xffff0000, v68
    v_lshlrev_b32 v62, 16, v69
    v_and_b32 v63, 0xffff0000, v69
    v_lshlrev_b32 v64, 16, v70
    v_and_b32 v65, 0xffff0000, v70
    v_lshlrev_b32 v66, 16, v71
    v_and_b32 v67, 0xffff0000, v71
    v_mul_f32 v60, 0x3fb8aa3b, v60
    v_mul_f32 v61, 0x3fb8aa3b, v61
    v_mul_f32 v62, 0x3fb8aa3b, v62
    v_mul_f32 v63, 0x3fb8aa3b, v63
    v_mul_f32 v64, 0x3fb8aa3b, v64
    v_mul_f32 v65, 0x3fb8aa3b, v65
    v_mul_f32 v66, 0x3fb8aa3b, v66
    v_mul_f32 v67, 0x3fb8aa3b, v67
    v_exp_f32 v60, v60
    v_exp_f32 v61, v61
    v_exp_f32 v62, v62
    v_exp_f32 v63, v63
    v_exp_f32 v64, v64
    v_exp_f32 v65, v65
    v_exp_f32 v66, v66
    v_exp_f32 v67, v67
    v_cvt_pk_bf16_f32 v76, v60, v61
    v_cvt_pk_bf16_f32 v77, v62, v63
    v_cvt_pk_bf16_f32 v78, v64, v65
    v_cvt_pk_bf16_f32 v79, v66, v67
    v_mfma_f32_4x4x4_16b_bf16 v[80:83], v[48:49], v[72:73], 0
    v_mfma_f32_4x4x4_16b_bf16 v[88:91], v[52:53], v[72:73], 0
    v_mfma_f32_4x4x4_16b_bf16 v[84:87], v[48:49], v[76:77], 0
    v_mfma_f32_4x4x4_16b_bf16 v[92:95], v[52:53], v[76:77], 0
    v_mfma_f32_4x4x4_16b_bf16 v[80:83], v[50:51], v[74:75], v[80:83]
    v_mfma_f32_4x4x4_16b_bf16 v[88:91], v[54:55], v[74:75], v[88:91]
    v_mfma_f32_4x4x4_16b_bf16 v[84:87], v[50:51], v[78:79], v[84:87]
    v_mfma_f32_4x4x4_16b_bf16 v[92:95], v[54:55], v[78:79], v[92:95]
    s_lshl_b32 s3, s34, 9
    s_lshl_b32 s4, s33, 7
    s_add_u32 s4, s4, s3
    v_mov_b32 v104, 1
    v_and_b32 v105, 0x3f0, v122
    v_lshlrev_b32 v105, 3, v105
    v_add_u32 v106, 81920, v118
    ds_read_b128 v[32:35], v106
    v_add_u32 v106, 81920, v119
    ds_read_b128 v[60:63], v106
    s_waitcnt vmcnt(0)
    s_barrier
    s_cmp_lg_u32 s32, 0
    s_cbranch_scc1 L2_f2
    s_mov_b64 exec, 1
    buffer_store_dword v104, off, s[8:11], s4 sc1
    s_mov_b64 exec, 15
    s_bitset0_b64 exec, s33
L2_f3:
    buffer_load_dword v104, v105, s[8:11], s3 offen sc1
    s_waitcnt vmcnt(0)
    v_cmp_ne_u32 vcc, 1, v104
    s_cbranch_vccnz L2_f3s
    s_mov_b64 exec, -1
L2_f2:
    s_barrier
    buffer_load_dwordx4 v[36:39], v122, s[20:23], s44 offen sc1
    buffer_load_dwordx4 v[40:43], v122, s[20:23], s45 offen sc1
    buffer_load_dwordx4 v[44:47], v122, s[20:23], s46 offen sc1
    s_cmp_ge_u32 s32, 4
    s_cbranch_scc1 L2_f5
    buffer_load_dwordx4 v[64:67], v123, s[20:23], s44 offen sc1
    buffer_load_dwordx4 v[68:71], v123, s[20:23], s45 offen sc1
    buffer_load_dwordx4 v[72:75], v123, s[20:23], s46 offen sc1
    v_lshlrev_b32 v16, 16, v117
    v_subrev_f32 v96, s50, v16
    v_subrev_f32 v97, s51, v16
    v_subrev_f32 v98, s52, v16
    v_subrev_f32 v99, s53, v16
    v_subrev_f32 v100, s54, v16
    v_subrev_f32 v101, s55, v16
    v_subrev_f32 v102, s56, v16
    v_subrev_f32 v103, s57, v16
    v_cvt_pk_bf16_f32 v0, v96, v97
    v_cvt_pk_bf16_f32 v1, v98, v99
    v_cvt_pk_bf16_f32 v2, v100, v101
    v_cvt_pk_bf16_f32 v3, v102, v103
    v_lshlrev_b32 v96, 16, v0
    v_and_b32 v97, 0xffff0000, v0
    v_lshlrev_b32 v98, 16, v1
    v_and_b32 v99, 0xffff0000, v1
    v_lshlrev_b32 v100, 16, v2
    v_and_b32 v101, 0xffff0000, v2
    v_lshlrev_b32 v102, 16, v3
    v_and_b32 v103, 0xffff0000, v3
    v_mul_f32 v96, v96, v96
    v_mul_f32 v97, v97, v97
    v_mul_f32 v98, v98, v98
    v_mul_f32 v99, v99, v99
    v_mul_f32 v100, v100, v100
    v_mul_f32 v101, v101, v101
    v_mul_f32 v102, v102, v102
    v_mul_f32 v103, v103, v103
    v_cvt_pk_bf16_f32 v0, v96, v97
    v_cvt_pk_bf16_f32 v1, v98, v99
    v_cvt_pk_bf16_f32 v2, v100, v101
    v_cvt_pk_bf16_f32 v3, v102, v103
    v_lshlrev_b32 v96, 16, v0
    v_and_b32 v97, 0xffff0000, v0
    v_lshlrev_b32 v98, 16, v1
    v_and_b32 v99, 0xffff0000, v1
    v_lshlrev_b32 v100, 16, v2
    v_and_b32 v101, 0xffff0000, v2
    v_lshlrev_b32 v102, 16, v3
    v_and_b32 v103, 0xffff0000, v3
    v_mul_f32 v96, 0xc1200000, v96
    v_mul_f32 v97, 0xc1200000, v97
    v_mul_f32 v98, 0xc1200000, v98
    v_mul_f32 v99, 0xc1200000, v99
    v_mul_f32 v100, 0xc1200000, v100
    v_mul_f32 v101, 0xc1200000, v101
    v_mul_f32 v102, 0xc1200000, v102
    v_mul_f32 v103, 0xc1200000, v103
    v_cvt_pk_bf16_f32 v0, v96, v97
    v_cvt_pk_bf16_f32 v1, v98, v99
    v_cvt_pk_bf16_f32 v2, v100, v101
    v_cvt_pk_bf16_f32 v3, v102, v103
    v_lshlrev_b32 v96, 16, v0
    v_and_b32 v97, 0xffff0000, v0
    v_lshlrev_b32 v98, 16, v1
    v_and_b32 v99, 0xffff0000, v1
    v_lshlrev_b32 v100, 16, v2
    v_and_b32 v101, 0xffff0000, v2
    v_lshlrev_b32 v102, 16, v3
    v_and_b32 v103, 0xffff0000, v3
    v_mul_f32 v96, 0x3fb8aa3b, v96
    v_mul_f32 v97, 0x3fb8aa3b, v97
    v_mul_f32 v98, 0x3fb8aa3b, v98
    v_mul_f32 v99, 0x3fb8aa3b, v99
    v_mul_f32 v100, 0x3fb8aa3b, v100
    v_mul_f32 v101, 0x3fb8aa3b, v101
    v_mul_f32 v102, 0x3fb8aa3b, v102
    v_mul_f32 v103, 0x3fb8aa3b, v103
    v_exp_f32 v96, v96
    v_exp_f32 v97, v97
    v_exp_f32 v98, v98
    v_exp_f32 v99, v99
    v_exp_f32 v100, v100
    v_exp_f32 v101, v101
    v_exp_f32 v102, v102
    v_exp_f32 v103, v103
    v_cvt_pk_bf16_f32 v104, v96, v97
    v_cvt_pk_bf16_f32 v105, v98, v99
    v_cvt_pk_bf16_f32 v106, v100, v101
    v_cvt_pk_bf16_f32 v107, v102, v103
    v_and_b32 v20, 0xffff0000, v117
    v_subrev_f32 v96, s50, v20
    v_subrev_f32 v97, s51, v20
    v_subrev_f32 v98, s52, v20
    v_subrev_f32 v99, s53, v20
    v_subrev_f32 v100, s54, v20
    v_subrev_f32 v101, s55, v20
    v_subrev_f32 v102, s56, v20
    v_subrev_f32 v103, s57, v20
    v_cvt_pk_bf16_f32 v0, v96, v97
    v_cvt_pk_bf16_f32 v1, v98, v99
    v_cvt_pk_bf16_f32 v2, v100, v101
    v_cvt_pk_bf16_f32 v3, v102, v103
    v_lshlrev_b32 v96, 16, v0
    v_and_b32 v97, 0xffff0000, v0
    v_lshlrev_b32 v98, 16, v1
    v_and_b32 v99, 0xffff0000, v1
    v_lshlrev_b32 v100, 16, v2
    v_and_b32 v101, 0xffff0000, v2
    v_lshlrev_b32 v102, 16, v3
    v_and_b32 v103, 0xffff0000, v3
    v_mul_f32 v96, v96, v96
    v_mul_f32 v97, v97, v97
    v_mul_f32 v98, v98, v98
    v_mul_f32 v99, v99, v99
    v_mul_f32 v100, v100, v100
    v_mul_f32 v101, v101, v101
    v_mul_f32 v102, v102, v102
    v_mul_f32 v103, v103, v103
    v_cvt_pk_bf16_f32 v0, v96, v97
    v_cvt_pk_bf16_f32 v1, v98, v99
    v_cvt_pk_bf16_f32 v2, v100, v101
    v_cvt_pk_bf16_f32 v3, v102, v103
    v_lshlrev_b32 v96, 16, v0
    v_and_b32 v97, 0xffff0000, v0
    v_lshlrev_b32 v98, 16, v1
    v_and_b32 v99, 0xffff0000, v1
    v_lshlrev_b32 v100, 16, v2
    v_and_b32 v101, 0xffff0000, v2
    v_lshlrev_b32 v102, 16, v3
    v_and_b32 v103, 0xffff0000, v3
    v_mul_f32 v96, 0xc1200000, v96
    v_mul_f32 v97, 0xc1200000, v97
    v_mul_f32 v98, 0xc1200000, v98
    v_mul_f32 v99, 0xc1200000, v99
    v_mul_f32 v100, 0xc1200000, v100
    v_mul_f32 v101, 0xc1200000, v101
    v_mul_f32 v102, 0xc1200000, v102
    v_mul_f32 v103, 0xc1200000, v103
    v_cvt_pk_bf16_f32 v0, v96, v97
    v_cvt_pk_bf16_f32 v1, v98, v99
    v_cvt_pk_bf16_f32 v2, v100, v101
    v_cvt_pk_bf16_f32 v3, v102, v103
    v_lshlrev_b32 v96, 16, v0
    v_and_b32 v97, 0xffff0000, v0
    v_lshlrev_b32 v98, 16, v1
    v_and_b32 v99, 0xffff0000, v1
    v_lshlrev_b32 v100, 16, v2
    v_and_b32 v101, 0xffff0000, v2
    v_lshlrev_b32 v102, 16, v3
    v_and_b32 v103, 0xffff0000, v3
    v_mul_f32 v96, 0x3fb8aa3b, v96
    v_mul_f32 v97, 0x3fb8aa3b, v97
    v_mul_f32 v98, 0x3fb8aa3b, v98
    v_mul_f32 v99, 0x3fb8aa3b, v99
    v_mul_f32 v100, 0x3fb8aa3b, v100
    v_mul_f32 v101, 0x3fb8aa3b, v101
    v_mul_f32 v102, 0x3fb8aa3b, v102
    v_mul_f32 v103, 0x3fb8aa3b, v103
    v_exp_f32 v96, v96
    v_exp_f32 v97, v97
    v_exp_f32 v98, v98
    v_exp_f32 v99, v99
    v_exp_f32 v100, v100
    v_exp_f32 v101, v101
    v_exp_f32 v102, v102
    v_exp_f32 v103, v103
    v_cvt_pk_bf16_f32 v76, v96, v97
    v_cvt_pk_bf16_f32 v77, v98, v99
    v_cvt_pk_bf16_f32 v78, v100, v101
    v_cvt_pk_bf16_f32 v79, v102, v103
    v_mfma_f32_4x4x4_16b_bf16 v[16:19], v[48:49], v[104:105], 0
    v_mfma_f32_4x4x4_16b_bf16 v[24:27], v[52:53], v[104:105], 0
    v_mfma_f32_4x4x4_16b_bf16 v[20:23], v[48:49], v[76:77], 0
    v_mfma_f32_4x4x4_16b_bf16 v[28:31], v[52:53], v[76:77], 0
    v_mfma_f32_4x4x4_16b_bf16 v[16:19], v[50:51], v[106:107], v[16:19]
    v_mfma_f32_4x4x4_16b_bf16 v[24:27], v[54:55], v[106:107], v[24:27]
    v_mfma_f32_4x4x4_16b_bf16 v[20:23], v[50:51], v[78:79], v[20:23]
    v_mfma_f32_4x4x4_16b_bf16 v[28:31], v[54:55], v[78:79], v[28:31]
L2_f5:
    s_waitcnt vmcnt(0) lgkmcnt(0)
    v_mfma_f32_4x4x4_16b_bf16 v[96:99], v[10:11], v[32:33], 0
    v_mfma_f32_4x4x4_16b_bf16 v[100:103], v[10:11], v[34:35], 0
    s_nop 0
    v_mfma_f32_4x4x4_16b_bf16 v[96:99], v[10:11], v[36:37], v[96:99]
    v_mfma_f32_4x4x4_16b_bf16 v[100:103], v[10:11], v[38:39], v[100:103]
    s_nop 0
    v_mfma_f32_4x4x4_16b_bf16 v[96:99], v[10:11], v[40:41], v[96:99]
    v_mfma_f32_4x4x4_16b_bf16 v[100:103], v[10:11], v[42:43], v[100:103]
    s_nop 0
    v_mfma_f32_4x4x4_16b_bf16 v[96:99], v[10:11], v[44:45], v[96:99]
    v_mfma_f32_4x4x4_16b_bf16 v[100:103], v[10:11], v[46:47], v[100:103]
    s_nop 3
    v_mul_f32 v96, v96, v80
    v_mul_f32 v97, v97, v81
    v_mul_f32 v98, v98, v82
    v_mul_f32 v99, v99, v83
    v_cvt_pk_bf16_f32 v32, v96, v97
    v_cvt_pk_bf16_f32 v33, v98, v99
    v_mul_f32 v100, v100, v84
    v_mul_f32 v101, v101, v85
    v_mul_f32 v102, v102, v86
    v_mul_f32 v103, v103, v87
    v_cvt_pk_bf16_f32 v34, v100, v101
    v_cvt_pk_bf16_f32 v35, v102, v103
    v_mfma_f32_4x4x4_16b_bf16 v[80:83], v[56:57], v[32:33], 0
    s_nop 0
    v_mfma_f32_4x4x4_16b_bf16 v[84:87], v[56:57], v[34:35], 0
    s_nop 2
    v_mul_f32 v80, v80, v88
    v_mul_f32 v81, v81, v89
    v_mul_f32 v82, v82, v90
    v_mul_f32 v83, v83, v91
    v_mul_f32 v84, v84, v92
    v_mul_f32 v85, v85, v93
    v_mul_f32 v86, v86, v94
    v_mul_f32 v87, v87, v95
    v_mfma_f32_4x4x4_16b_bf16 v[96:99], v[10:11], v[108:109], v[80:83]
    s_nop 0
    v_mfma_f32_4x4x4_16b_bf16 v[100:103], v[10:11], v[110:111], v[84:87]
    s_nop 2
    v_cvt_pk_bf16_f32 v36, v96, v97
    v_cvt_pk_bf16_f32 v37, v98, v99
    v_cvt_pk_bf16_f32 v38, v100, v101
    v_cvt_pk_bf16_f32 v39, v102, v103
    buffer_store_dwordx4 v[36:39], v120, s[12:15], 0 offen nt
    s_cmp_ge_u32 s32, 4
    s_cbranch_scc1 L2_f6
    v_mfma_f32_4x4x4_16b_bf16 v[96:99], v[10:11], v[60:61], 0
    v_mfma_f32_4x4x4_16b_bf16 v[100:103], v[10:11], v[62:63], 0
    s_nop 0
    v_mfma_f32_4x4x4_16b_bf16 v[96:99], v[10:11], v[64:65], v[96:99]
    v_mfma_f32_4x4x4_16b_bf16 v[100:103], v[10:11], v[66:67], v[100:103]
    s_nop 0
    v_mfma_f32_4x4x4_16b_bf16 v[96:99], v[10:11], v[68:69], v[96:99]
    v_mfma_f32_4x4x4_16b_bf16 v[100:103], v[10:11], v[70:71], v[100:103]
    s_nop 0
    v_mfma_f32_4x4x4_16b_bf16 v[96:99], v[10:11], v[72:73], v[96:99]
    v_mfma_f32_4x4x4_16b_bf16 v[100:103], v[10:11], v[74:75], v[100:103]
    s_nop 3
    v_mul_f32 v96, v96, v16
    v_mul_f32 v97, v97, v17
    v_mul_f32 v98, v98, v18
    v_mul_f32 v99, v99, v19
    v_cvt_pk_bf16_f32 v60, v96, v97
    v_cvt_pk_bf16_f32 v61, v98, v99
    v_mul_f32 v100, v100, v20
    v_mul_f32 v101, v101, v21
    v_mul_f32 v102, v102, v22
    v_mul_f32 v103, v103, v23
    v_cvt_pk_bf16_f32 v62, v100, v101
    v_cvt_pk_bf16_f32 v63, v102, v103
    v_mfma_f32_4x4x4_16b_bf16 v[16:19], v[56:57], v[60:61], 0
    s_nop 0
    v_mfma_f32_4x4x4_16b_bf16 v[20:23], v[56:57], v[62:63], 0
    s_nop 2
    v_mul_f32 v16, v16, v24
    v_mul_f32 v17, v17, v25
    v_mul_f32 v18, v18, v26
    v_mul_f32 v19, v19, v27
    v_mul_f32 v20, v20, v28
    v_mul_f32 v21, v21, v29
    v_mul_f32 v22, v22, v30
    v_mul_f32 v23, v23, v31
    v_mfma_f32_4x4x4_16b_bf16 v[96:99], v[10:11], v[112:113], v[16:19]
    s_nop 0
    v_mfma_f32_4x4x4_16b_bf16 v[100:103], v[10:11], v[114:115], v[20:23]
    s_nop 2
    v_cvt_pk_bf16_f32 v64, v96, v97
    v_cvt_pk_bf16_f32 v65, v98, v99
    v_cvt_pk_bf16_f32 v66, v100, v101
    v_cvt_pk_bf16_f32 v67, v102, v103
    buffer_store_dwordx4 v[64:67], v121, s[12:15], 0 offen nt
L2_f6:
L2_end:
    s_endpgm
L2_slow:
    s_lshr_b32 s35, s42, 2
    s_lshl_b32 s50, s32, 4
    s_and_b32 s3, s42, 3
    s_lshl_b32 s53, s3, 3
    s_add_u32 s53, s53, s39
    s_and_b32 s3, s35, 2
    s_lshl_b32 s3, s3, 1
    s_add_u32 s53, s53, s3
    s_and_b32 s54, s35, 1
    s_lshl_b32 s54, s54, 4
L2_sl_seg:
    s_mul_i32 s55, s50, 173056
    s_and_b32 s3, s50, 3
    s_lshl_b32 s3, s3, 5
    s_add_u32 s3, s3, s55
    s_add_u32 s3, s3, s53
    buffer_load_dword v104, off, s[12:15], s3 sc1
    buffer_load_dword v105, off, s[12:15], s3 offset:32 sc1
    s_waitcnt vmcnt(0)
    v_readfirstlane_b32 s51, v104
    v_readfirstlane_b32 s52, v105
    s_lshr_b32 s51, s51, s54
    s_and_b32 s51, s51, 0xffff
    s_lshr_b32 s52, s52, s54
    s_and_b32 s52, s52, 0xffff
L2_sl_rec:
    s_cmp_ge_u32 s51, s52
    s_cbranch_scc1 L2_sl_next
    v_mbcnt_lo_u32_b32 v102, -1, 0
    v_mbcnt_hi_u32_b32 v102, -1, v102
    v_add_u32 v102, s51, v102
    v_and_b32 v103, -4, v102
    v_lshl_add_u32 v104, v102, 2, v103
    v_lshl_add_u32 v105, v103, 2, v102
    v_cmp_gt_u32 vcc, s52, v102
    s_mov_b64 exec, vcc
    buffer_load_dword v106, v104, s[8:11], s55 offen
    buffer_load_ubyte v107, v105, s[8:11], s55 offen offset:16
    s_waitcnt vmcnt(0)
    v_lshrrev_b32 v98, 14, v106
    v_and_b32 v98, v5, v98
    ds_read_b64 v[100:101], v98
    v_perm_b32 v97, v106, v107, s44
    v_and_b32 v96, v5, v106
    v_bitop3_b32 v103, v106, 0.5, -0.5 bitop3:0xa8
    v_bitop3_b32 v97, v6, v97, v103 bitop3:0xca
    s_waitcnt lgkmcnt(0)
    v_mfma_f32_4x4x4_16b_bf16 v[88:91], v[8:9], v[100:101], 0
    s_nop 4
    v_mul_f32 v88, v97, v88
    v_mul_f32 v89, v97, v89
    v_mul_f32 v90, v97, v90
    v_mul_f32 v91, v97, v91
    v_cvt_pk_bf16_f32 v88, v88, v89
    v_cvt_pk_bf16_f32 v89, v90, v91
    ds_pk_add_bf16 v96, v88 offset:65408
    ds_pk_add_bf16 v96, v89 offset:65412
    s_mov_b64 exec, -1
    s_add_u32 s51, s51, 64
    s_branch L2_sl_rec
L2_sl_next:
    s_add_u32 s50, s50, 1
    s_and_b32 s3, s50, 15
    s_cbranch_scc1 L2_sl_seg
    s_add_u32 s50, s50, 240
    s_cmp_lt_u32 s50, 1280
    s_cbranch_scc1 L2_sl_seg
    s_waitcnt lgkmcnt(0)
    s_cmp_eq_u32 s42, 0
    s_cbranch_scc1 L2_ret0
    s_cmp_eq_u32 s42, 1
    s_cbranch_scc1 L2_ret1
    s_cmp_eq_u32 s42, 14
    s_cbranch_scc1 L2_ret6
    s_cmp_eq_u32 s42, 15
    s_cbranch_scc1 L2_ret7
    s_and_b32 s3, s42, 3
    s_cmp_eq_u32 s3, 2
    s_cbranch_scc1 L2_ret2
    s_cmp_eq_u32 s3, 3
    s_cbranch_scc1 L2_ret3
    s_cmp_eq_u32 s3, 0
    s_cbranch_scc1 L2_ret4
    s_branch L2_ret5
L2_p1s:
    s_sleep 32
    s_branch L2_p1
L2_xo3:
    v_cmp_lt_u32 vcc, 20, v99
    s_mov_b32 s101, 1
    s_cbranch_vccz L2_xp3
    v_cmp_lt_u32 vcc, 32, v99
    v_cmp_lt_u32 s[58:59], 31, v88
    s_mov_b32 s101, 2
    s_or_b64 vcc, vcc, s[58:59]
    s_cbranch_scc0 L2_xp3
    s_mov_b32 s37, 0x10000
    s_branch L2_xp3
L2_xa4:
    s_cmp_eq_u32 s101, 1
    s_cbranch_scc1 L2_xc4
    v_lshlrev_b32 v89, 0, v96
    v_add_u32 v90, 140, v97
    v_bitop3_b32 v90, v89, v45, v90 bitop3:0x6a
    ds_write_b32 v98, v90 offset:28
    v_lshlrev_b32 v89, 4, v96
    v_add_u32 v90, 120, v97
    v_bitop3_b32 v90, v89, v45, v90 bitop3:0x6a
    ds_write_b32 v98, v90 offset:24
    v_lshlrev_b32 v89, 8, v96
    v_add_u32 v90, 100, v97
    v_bitop3_b32 v90, v89, v45, v90 bitop3:0x6a
    ds_write_b32 v98, v90 offset:20
L2_xc4:
    v_lshlrev_b32 v89, 12, v96
    v_add_u32 v90, 80, v97
    v_bitop3_b32 v90, v89, v45, v90 bitop3:0x6a
    ds_write_b32 v98, v90 offset:16
    s_branch L2_xb4
L2_xe4:
    v_cmp_lt_u32 vcc, 32, v99
    v_cmp_lt_u32 s[58:59], 31, v88
    v_lshrrev_b32 v89, 16, v96
    v_add_u32 v97, 80, v97
    s_or_b64 vcc, vcc, s[58:59]
    s_cbranch_scc1 L2_xs4
    v_lshlrev_b32 v89, v1, v89
    v_and_b32 v89, v45, v89
    v_cmp_ne_u32 vcc, 0, v89
    v_xor_b32 v90, v97, v89
    s_add_u32 s3, s37, s38
    v_mbcnt_lo_u32_b32 v98, vcc_lo, 0
    v_mbcnt_hi_u32_b32 v98, vcc_hi, v98
    s_bcnt1_i32_b64 s41, vcc
    v_lshl_add_u32 v98, v98, 2, s3
    s_lshl2_add_u32 s37, s41, s37
    s_mov_b64 exec, vcc
    ds_write_b32 v98, v90
    s_mov_b64 exec, -1
    s_branch L2_xr4
L2_xf4:
    s_waitcnt lgkmcnt(0)
    s_cmp_gt_u32 s37, 1024
    s_cbranch_scc1 L2_xs4
    s_cmp_lt_u32 s37, 768
    s_cbranch_scc1 L2_xl4
    ds_read_b32 v32, v98 offset:896
    s_add_u32 s3, s42, 0
    s_bitset1_b32 s43, s3
    s_branch L2_xg4
L2_xl4:
    v_mov_b32 v42, -1
    s_cmp_ge_u32 s37, 512
    s_cbranch_scc1 L2_xg4
    v_mov_b32 v43, -1
    s_cmp_ge_u32 s37, 256
    s_cbranch_scc1 L2_xg4
    v_mov_b32 v41, -1
    s_branch L2_xg4
L2_xs4:
    s_waitcnt lgkmcnt(0)
    v_mov_b32 v40, -1
    v_mov_b32 v41, -1
    v_mov_b32 v43, -1
    v_mov_b32 v42, -1
    s_add_u32 s3, s42, 0
    s_bitset1_b32 s36, s3
    s_branch L2_xg4
L2_xo5:
    v_cmp_lt_u32 vcc, 20, v99
    s_mov_b32 s101, 1
    s_cbranch_vccz L2_xp5
    v_cmp_lt_u32 vcc, 32, v99
    v_cmp_lt_u32 s[58:59], 31, v88
    s_mov_b32 s101, 2
    s_or_b64 vcc, vcc, s[58:59]
    s_cbranch_scc0 L2_xp5
    s_mov_b32 s37, 0x10000
    s_branch L2_xp5
L2_xa6:
    s_cmp_eq_u32 s101, 1
    s_cbranch_scc1 L2_xc6
    v_lshlrev_b32 v89, 0, v96
    v_add_u32 v90, 140, v97
    v_bitop3_b32 v90, v89, v45, v90 bitop3:0x6a
    ds_write_b32 v98, v90 offset:28
    v_lshlrev_b32 v89, 4, v96
    v_add_u32 v90, 120, v97
    v_bitop3_b32 v90, v89, v45, v90 bitop3:0x6a
    ds_write_b32 v98, v90 offset:24
    v_lshlrev_b32 v89, 8, v96
    v_add_u32 v90, 100, v97
    v_bitop3_b32 v90, v89, v45, v90 bitop3:0x6a
    ds_write_b32 v98, v90 offset:20
L2_xc6:
    v_lshlrev_b32 v89, 12, v96
    v_add_u32 v90, 80, v97
    v_bitop3_b32 v90, v89, v45, v90 bitop3:0x6a
    ds_write_b32 v98, v90 offset:16
    s_branch L2_xb6
L2_xe6:
    v_cmp_lt_u32 vcc, 32, v99
    v_cmp_lt_u32 s[58:59], 31, v88
    v_lshrrev_b32 v89, 16, v96
    v_add_u32 v97, 80, v97
    s_or_b64 vcc, vcc, s[58:59]
    s_cbranch_scc1 L2_xs6
    v_lshlrev_b32 v89, v1, v89
    v_and_b32 v89, v45, v89
    v_cmp_ne_u32 vcc, 0, v89
    v_xor_b32 v90, v97, v89
    s_add_u32 s3, s37, s38
    v_mbcnt_lo_u32_b32 v98, vcc_lo, 0
    v_mbcnt_hi_u32_b32 v98, vcc_hi, v98
    s_bcnt1_i32_b64 s41, vcc
    v_lshl_add_u32 v98, v98, 2, s3
    s_lshl2_add_u32 s37, s41, s37
    s_mov_b64 exec, vcc
    ds_write_b32 v98, v90
    s_mov_b64 exec, -1
    s_branch L2_xr6
L2_xf6:
    s_waitcnt lgkmcnt(0)
    s_cmp_gt_u32 s37, 1024
    s_cbranch_scc1 L2_xs6
    s_cmp_lt_u32 s37, 768
    s_cbranch_scc1 L2_xl6
    ds_read_b32 v33, v98 offset:896
    s_add_u32 s3, s42, 1
    s_bitset1_b32 s43, s3
    s_branch L2_xg6
L2_xl6:
    v_mov_b32 v42, -1
    s_cmp_ge_u32 s37, 512
    s_cbranch_scc1 L2_xg6
    v_mov_b32 v43, -1
    s_cmp_ge_u32 s37, 256
    s_cbranch_scc1 L2_xg6
    v_mov_b32 v41, -1
    s_branch L2_xg6
L2_xs6:
    s_waitcnt lgkmcnt(0)
    v_mov_b32 v40, -1
    v_mov_b32 v41, -1
    v_mov_b32 v43, -1
    v_mov_b32 v42, -1
    s_add_u32 s3, s42, 1
    s_bitset1_b32 s36, s3
    s_branch L2_xg6
L2_p2s:
    s_sleep 8
    s_branch L2_p2
L2_oa7:
    v_and_b32 v47, 0x0fffffff, v32
    buffer_load_dword v78, v47, s[8:11], 0 offen offset:16
    s_mov_b64 exec, s[6:7]
    v_add_u32 v47, 8, v47
    v_lshrrev_b32 v32, 2, v32
    s_mov_b64 exec, -1
    buffer_load_dwordx2 v[76:77], v47, s[8:11], 0 offen
    s_branch L2_ob7
L2_oa8:
    s_waitcnt vmcnt(0)
    s_mov_b64 exec, s[6:7]
    v_lshrrev_b32 v78, 16, v78
    s_mov_b64 exec, -1
    v_and_b32 v46, 0x10000000, v32
    v_cmpx_eq_u32 vcc, 0, v46
    v_lshrrev_b32 v47, 14, v76
    v_and_b32 v47, v5, v47
    ds_read_b64 v[96:97], v47
    v_perm_b32 v98, v76, v78, s44
    v_bitop3_b32 v99, v76, 0.5, -0.5 bitop3:0xa8
    v_bitop3_b32 v98, v6, v98, v99 bitop3:0xca
    v_and_b32 v47, v5, v76
    s_waitcnt lgkmcnt(0)
    v_mfma_f32_4x4x4_16b_bf16 v[88:91], v[8:9], v[96:97], 0
    s_nop 4
    v_mul_f32 v88, v98, v88
    v_mul_f32 v89, v98, v89
    v_mul_f32 v90, v98, v90
    v_mul_f32 v91, v98, v91
    v_cvt_pk_bf16_f32 v88, v88, v89
    v_cvt_pk_bf16_f32 v89, v90, v91
    ds_pk_add_bf16 v47, v88 offset:65408
    ds_pk_add_bf16 v47, v89 offset:65412
    s_mov_b64 exec, -1
    v_and_b32 v46, 0x20000000, v32
    v_cmpx_eq_u32 vcc, 0, v46
    v_lshrrev_b32 v47, 14, v77
    v_and_b32 v47, v5, v47
    ds_read_b64 v[96:97], v47
    v_perm_b32 v98, v77, v78, s45
    v_bitop3_b32 v99, v77, 0.5, -0.5 bitop3:0xa8
    v_bitop3_b32 v98, v6, v98, v99 bitop3:0xca
    v_and_b32 v47, v5, v77
    s_waitcnt lgkmcnt(0)
    v_mfma_f32_4x4x4_16b_bf16 v[88:91], v[8:9], v[96:97], 0
    s_nop 4
    v_mul_f32 v88, v98, v88
    v_mul_f32 v89, v98, v89
    v_mul_f32 v90, v98, v90
    v_mul_f32 v91, v98, v91
    v_cvt_pk_bf16_f32 v88, v88, v89
    v_cvt_pk_bf16_f32 v89, v90, v91
    ds_pk_add_bf16 v47, v88 offset:65408
    ds_pk_add_bf16 v47, v89 offset:65412
    s_mov_b64 exec, -1
    s_branch L2_ob8
L2_c9:
    s_lshl_b64 s[52:53], s[82:83], 1
    s_andn2_b64 s[52:53], s[52:53], s[80:81]
    s_andn2_b64 s[52:53], s[52:53], s[54:55]
    s_or_b64 s[80:81], s[80:81], s[52:53]
    s_not_b64 vcc, s[52:53]
    s_mov_b64 exec, -1
    v_cndmask_b32_dpp v84, v84, v84, vcc wave_shr:1 row_mask:0xf bank_mask:0xf
    v_cndmask_b32_dpp v85, v85, v85, vcc wave_shr:1 row_mask:0xf bank_mask:0xf
    s_lshr_b64 s[52:53], s[52:53], 1
    v_cndmask_b32_dpp v86, v86, v86, vcc wave_shr:1 row_mask:0xf bank_mask:0xf
    v_cndmask_b32_dpp v87, v87, v87, vcc wave_shr:1 row_mask:0xf bank_mask:0xf
    s_andn2_b64 s[82:83], s[82:83], s[52:53]
    v_cndmask_b32_dpp v7, v7, v7, vcc wave_shr:1 row_mask:0xf bank_mask:0xf
    s_mov_b64 exec, s[54:55]
    s_cbranch_scc0 L2_d9
    s_mov_b64 exec, s[82:83]
    s_nop 1
    v_mfma_f32_4x4x4_16b_bf16 v[88:91], v[12:13], v[84:85], 0
    s_nop 1
    v_mfma_f32_4x4x4_16b_bf16 v[88:91], v[10:11], v[86:87], v[88:91]
    s_nop 4
    v_cvt_pk_bf16_f32 v88, v88, v89
    v_cvt_pk_bf16_f32 v89, v90, v91
    ds_pk_add_bf16 v7, v88 offset:65408
    ds_pk_add_bf16 v7, v89 offset:65412
    s_mov_b64 exec, s[54:55]
    s_branch L2_d9
L2_c10:
    s_lshl_b64 s[52:53], s[82:83], 1
    s_andn2_b64 s[52:53], s[52:53], s[80:81]
    s_andn2_b64 s[52:53], s[52:53], s[50:51]
    s_or_b64 s[80:81], s[80:81], s[52:53]
    s_not_b64 vcc, s[52:53]
    s_mov_b64 exec, -1
    v_cndmask_b32_dpp v84, v84, v84, vcc wave_shr:1 row_mask:0xf bank_mask:0xf
    v_cndmask_b32_dpp v85, v85, v85, vcc wave_shr:1 row_mask:0xf bank_mask:0xf
    s_lshr_b64 s[52:53], s[52:53], 1
    v_cndmask_b32_dpp v86, v86, v86, vcc wave_shr:1 row_mask:0xf bank_mask:0xf
    v_cndmask_b32_dpp v87, v87, v87, vcc wave_shr:1 row_mask:0xf bank_mask:0xf
    s_andn2_b64 s[82:83], s[82:83], s[52:53]
    v_cndmask_b32_dpp v7, v7, v7, vcc wave_shr:1 row_mask:0xf bank_mask:0xf
    s_mov_b64 exec, s[50:51]
    s_cbranch_scc0 L2_d10
    s_mov_b64 exec, s[82:83]
    s_nop 1
    v_mfma_f32_4x4x4_16b_bf16 v[88:91], v[12:13], v[84:85], 0
    s_nop 1
    v_mfma_f32_4x4x4_16b_bf16 v[88:91], v[10:11], v[86:87], v[88:91]
    s_nop 4
    v_cvt_pk_bf16_f32 v88, v88, v89
    v_cvt_pk_bf16_f32 v89, v90, v91
    ds_pk_add_bf16 v7, v88 offset:65408
    ds_pk_add_bf16 v7, v89 offset:65412
    s_mov_b64 exec, s[50:51]
    s_branch L2_d10
L2_c13:
    s_lshl_b64 s[52:53], s[82:83], 1
    s_andn2_b64 s[52:53], s[52:53], s[80:81]
    s_andn2_b64 s[52:53], s[52:53], s[54:55]
    s_or_b64 s[80:81], s[80:81], s[52:53]
    s_not_b64 vcc, s[52:53]
    s_mov_b64 exec, -1
    v_cndmask_b32_dpp v84, v84, v84, vcc wave_shr:1 row_mask:0xf bank_mask:0xf
    v_cndmask_b32_dpp v85, v85, v85, vcc wave_shr:1 row_mask:0xf bank_mask:0xf
    s_lshr_b64 s[52:53], s[52:53], 1
    v_cndmask_b32_dpp v86, v86, v86, vcc wave_shr:1 row_mask:0xf bank_mask:0xf
    v_cndmask_b32_dpp v87, v87, v87, vcc wave_shr:1 row_mask:0xf bank_mask:0xf
    s_andn2_b64 s[82:83], s[82:83], s[52:53]
    v_cndmask_b32_dpp v7, v7, v7, vcc wave_shr:1 row_mask:0xf bank_mask:0xf
    s_mov_b64 exec, s[54:55]
    s_cbranch_scc0 L2_d13
    s_mov_b64 exec, s[82:83]
    s_nop 1
    v_mfma_f32_4x4x4_16b_bf16 v[88:91], v[12:13], v[84:85], 0
    s_nop 1
    v_mfma_f32_4x4x4_16b_bf16 v[88:91], v[10:11], v[86:87], v[88:91]
    s_nop 4
    v_cvt_pk_bf16_f32 v88, v88, v89
    v_cvt_pk_bf16_f32 v89, v90, v91
    ds_pk_add_bf16 v7, v88 offset:65408
    ds_pk_add_bf16 v7, v89 offset:65412
    s_mov_b64 exec, s[54:55]
    s_branch L2_d13
L2_c14:
    s_lshl_b64 s[52:53], s[82:83], 1
    s_andn2_b64 s[52:53], s[52:53], s[80:81]
    s_andn2_b64 s[52:53], s[52:53], s[50:51]
    s_or_b64 s[80:81], s[80:81], s[52:53]
    s_not_b64 vcc, s[52:53]
    s_mov_b64 exec, -1
    v_cndmask_b32_dpp v84, v84, v84, vcc wave_shr:1 row_mask:0xf bank_mask:0xf
    v_cndmask_b32_dpp v85, v85, v85, vcc wave_shr:1 row_mask:0xf bank_mask:0xf
    s_lshr_b64 s[52:53], s[52:53], 1
    v_cndmask_b32_dpp v86, v86, v86, vcc wave_shr:1 row_mask:0xf bank_mask:0xf
    v_cndmask_b32_dpp v87, v87, v87, vcc wave_shr:1 row_mask:0xf bank_mask:0xf
    s_andn2_b64 s[82:83], s[82:83], s[52:53]
    v_cndmask_b32_dpp v7, v7, v7, vcc wave_shr:1 row_mask:0xf bank_mask:0xf
    s_mov_b64 exec, s[50:51]
    s_cbranch_scc0 L2_d14
    s_mov_b64 exec, s[82:83]
    s_nop 1
    v_mfma_f32_4x4x4_16b_bf16 v[88:91], v[12:13], v[84:85], 0
    s_nop 1
    v_mfma_f32_4x4x4_16b_bf16 v[88:91], v[10:11], v[86:87], v[88:91]
    s_nop 4
    v_cvt_pk_bf16_f32 v88, v88, v89
    v_cvt_pk_bf16_f32 v89, v90, v91
    ds_pk_add_bf16 v7, v88 offset:65408
    ds_pk_add_bf16 v7, v89 offset:65412
    s_mov_b64 exec, s[50:51]
    s_branch L2_d14
L2_xo16:
    v_cmp_lt_u32 vcc, 20, v99
    s_mov_b32 s101, 1
    s_cbranch_vccz L2_xp16
    v_cmp_lt_u32 vcc, 32, v99
    v_cmp_lt_u32 s[58:59], 31, v88
    s_mov_b32 s101, 2
    s_or_b64 vcc, vcc, s[58:59]
    s_cbranch_scc0 L2_xp16
    s_mov_b32 s37, 0x10000
    s_branch L2_xp16
L2_c17:
    s_lshl_b64 s[52:53], s[82:83], 1
    s_andn2_b64 s[52:53], s[52:53], s[80:81]
    s_andn2_b64 s[52:53], s[52:53], s[54:55]
    s_or_b64 s[80:81], s[80:81], s[52:53]
    s_not_b64 vcc, s[52:53]
    s_mov_b64 exec, -1
    v_cndmask_b32_dpp v84, v84, v84, vcc wave_shr:1 row_mask:0xf bank_mask:0xf
    v_cndmask_b32_dpp v85, v85, v85, vcc wave_shr:1 row_mask:0xf bank_mask:0xf
    s_lshr_b64 s[52:53], s[52:53], 1
    v_cndmask_b32_dpp v86, v86, v86, vcc wave_shr:1 row_mask:0xf bank_mask:0xf
    v_cndmask_b32_dpp v87, v87, v87, vcc wave_shr:1 row_mask:0xf bank_mask:0xf
    s_andn2_b64 s[82:83], s[82:83], s[52:53]
    v_cndmask_b32_dpp v7, v7, v7, vcc wave_shr:1 row_mask:0xf bank_mask:0xf
    s_mov_b64 exec, s[54:55]
    s_cbranch_scc0 L2_d17
    s_mov_b64 exec, s[82:83]
    s_nop 1
    v_mfma_f32_4x4x4_16b_bf16 v[88:91], v[12:13], v[84:85], 0
    s_nop 1
    v_mfma_f32_4x4x4_16b_bf16 v[88:91], v[10:11], v[86:87], v[88:91]
    s_nop 4
    v_cvt_pk_bf16_f32 v88, v88, v89
    v_cvt_pk_bf16_f32 v89, v90, v91
    ds_pk_add_bf16 v7, v88 offset:65408
    ds_pk_add_bf16 v7, v89 offset:65412
    s_mov_b64 exec, s[54:55]
    s_branch L2_d17
L2_c18:
    s_lshl_b64 s[52:53], s[82:83], 1
    s_andn2_b64 s[52:53], s[52:53], s[80:81]
    s_andn2_b64 s[52:53], s[52:53], s[50:51]
    s_or_b64 s[80:81], s[80:81], s[52:53]
    s_not_b64 vcc, s[52:53]
    s_mov_b64 exec, -1
    v_cndmask_b32_dpp v84, v84, v84, vcc wave_shr:1 row_mask:0xf bank_mask:0xf
    v_cndmask_b32_dpp v85, v85, v85, vcc wave_shr:1 row_mask:0xf bank_mask:0xf
    s_lshr_b64 s[52:53], s[52:53], 1
    v_cndmask_b32_dpp v86, v86, v86, vcc wave_shr:1 row_mask:0xf bank_mask:0xf
    v_cndmask_b32_dpp v87, v87, v87, vcc wave_shr:1 row_mask:0xf bank_mask:0xf
    s_andn2_b64 s[82:83], s[82:83], s[52:53]
    v_cndmask_b32_dpp v7, v7, v7, vcc wave_shr:1 row_mask:0xf bank_mask:0xf
    s_mov_b64 exec, s[50:51]
    s_cbranch_scc0 L2_d18
    s_mov_b64 exec, s[82:83]
    s_nop 1
    v_mfma_f32_4x4x4_16b_bf16 v[88:91], v[12:13], v[84:85], 0
    s_nop 1
    v_mfma_f32_4x4x4_16b_bf16 v[88:91], v[10:11], v[86:87], v[88:91]
    s_nop 4
    v_cvt_pk_bf16_f32 v88, v88, v89
    v_cvt_pk_bf16_f32 v89, v90, v91
    ds_pk_add_bf16 v7, v88 offset:65408
    ds_pk_add_bf16 v7, v89 offset:65412
    s_mov_b64 exec, s[50:51]
    s_branch L2_d18
L2_c21:
    s_lshl_b64 s[52:53], s[82:83], 1
    s_andn2_b64 s[52:53], s[52:53], s[80:81]
    s_andn2_b64 s[52:53], s[52:53], s[54:55]
    s_or_b64 s[80:81], s[80:81], s[52:53]
    s_not_b64 vcc, s[52:53]
    s_mov_b64 exec, -1
    v_cndmask_b32_dpp v84, v84, v84, vcc wave_shr:1 row_mask:0xf bank_mask:0xf
    v_cndmask_b32_dpp v85, v85, v85, vcc wave_shr:1 row_mask:0xf bank_mask:0xf
    s_lshr_b64 s[52:53], s[52:53], 1
    v_cndmask_b32_dpp v86, v86, v86, vcc wave_shr:1 row_mask:0xf bank_mask:0xf
    v_cndmask_b32_dpp v87, v87, v87, vcc wave_shr:1 row_mask:0xf bank_mask:0xf
    s_andn2_b64 s[82:83], s[82:83], s[52:53]
    v_cndmask_b32_dpp v7, v7, v7, vcc wave_shr:1 row_mask:0xf bank_mask:0xf
    s_mov_b64 exec, s[54:55]
    s_cbranch_scc0 L2_d21
    s_mov_b64 exec, s[82:83]
    s_nop 1
    v_mfma_f32_4x4x4_16b_bf16 v[88:91], v[12:13], v[84:85], 0
    s_nop 1
    v_mfma_f32_4x4x4_16b_bf16 v[88:91], v[10:11], v[86:87], v[88:91]
    s_nop 4
    v_cvt_pk_bf16_f32 v88, v88, v89
    v_cvt_pk_bf16_f32 v89, v90, v91
    ds_pk_add_bf16 v7, v88 offset:65408
    ds_pk_add_bf16 v7, v89 offset:65412
    s_mov_b64 exec, s[54:55]
    s_branch L2_d21
L2_c22:
    s_lshl_b64 s[52:53], s[82:83], 1
    s_andn2_b64 s[52:53], s[52:53], s[80:81]
    s_andn2_b64 s[52:53], s[52:53], s[50:51]
    s_or_b64 s[80:81], s[80:81], s[52:53]
    s_not_b64 vcc, s[52:53]
    s_mov_b64 exec, -1
    v_cndmask_b32_dpp v84, v84, v84, vcc wave_shr:1 row_mask:0xf bank_mask:0xf
    v_cndmask_b32_dpp v85, v85, v85, vcc wave_shr:1 row_mask:0xf bank_mask:0xf
    s_lshr_b64 s[52:53], s[52:53], 1
    v_cndmask_b32_dpp v86, v86, v86, vcc wave_shr:1 row_mask:0xf bank_mask:0xf
    v_cndmask_b32_dpp v87, v87, v87, vcc wave_shr:1 row_mask:0xf bank_mask:0xf
    s_andn2_b64 s[82:83], s[82:83], s[52:53]
    v_cndmask_b32_dpp v7, v7, v7, vcc wave_shr:1 row_mask:0xf bank_mask:0xf
    s_mov_b64 exec, s[50:51]
    s_cbranch_scc0 L2_d22
    s_mov_b64 exec, s[82:83]
    s_nop 1
    v_mfma_f32_4x4x4_16b_bf16 v[88:91], v[12:13], v[84:85], 0
    s_nop 1
    v_mfma_f32_4x4x4_16b_bf16 v[88:91], v[10:11], v[86:87], v[88:91]
    s_nop 4
    v_cvt_pk_bf16_f32 v88, v88, v89
    v_cvt_pk_bf16_f32 v89, v90, v91
    ds_pk_add_bf16 v7, v88 offset:65408
    ds_pk_add_bf16 v7, v89 offset:65412
    s_mov_b64 exec, s[50:51]
    s_branch L2_d22
L2_c23:
    s_lshl_b64 s[52:53], s[82:83], 1
    s_andn2_b64 s[52:53], s[52:53], s[80:81]
    s_andn2_b64 s[52:53], s[52:53], s[54:55]
    s_or_b64 s[80:81], s[80:81], s[52:53]
    s_not_b64 vcc, s[52:53]
    s_mov_b64 exec, -1
    v_cndmask_b32_dpp v84, v84, v84, vcc wave_shr:1 row_mask:0xf bank_mask:0xf
    v_cndmask_b32_dpp v85, v85, v85, vcc wave_shr:1 row_mask:0xf bank_mask:0xf
    s_lshr_b64 s[52:53], s[52:53], 1
    v_cndmask_b32_dpp v86, v86, v86, vcc wave_shr:1 row_mask:0xf bank_mask:0xf
    v_cndmask_b32_dpp v87, v87, v87, vcc wave_shr:1 row_mask:0xf bank_mask:0xf
    s_andn2_b64 s[82:83], s[82:83], s[52:53]
    v_cndmask_b32_dpp v7, v7, v7, vcc wave_shr:1 row_mask:0xf bank_mask:0xf
    s_mov_b64 exec, s[54:55]
    s_cbranch_scc0 L2_d23
    s_mov_b64 exec, s[82:83]
    s_nop 1
    v_mfma_f32_4x4x4_16b_bf16 v[88:91], v[12:13], v[84:85], 0
    s_nop 1
    v_mfma_f32_4x4x4_16b_bf16 v[88:91], v[10:11], v[86:87], v[88:91]
    s_nop 4
    v_cvt_pk_bf16_f32 v88, v88, v89
    v_cvt_pk_bf16_f32 v89, v90, v91
    ds_pk_add_bf16 v7, v88 offset:65408
    ds_pk_add_bf16 v7, v89 offset:65412
    s_mov_b64 exec, s[54:55]
    s_branch L2_d23
L2_c24:
    s_lshl_b64 s[52:53], s[82:83], 1
    s_andn2_b64 s[52:53], s[52:53], s[80:81]
    s_andn2_b64 s[52:53], s[52:53], s[50:51]
    s_or_b64 s[80:81], s[80:81], s[52:53]
    s_not_b64 vcc, s[52:53]
    s_mov_b64 exec, -1
    v_cndmask_b32_dpp v84, v84, v84, vcc wave_shr:1 row_mask:0xf bank_mask:0xf
    v_cndmask_b32_dpp v85, v85, v85, vcc wave_shr:1 row_mask:0xf bank_mask:0xf
    s_lshr_b64 s[52:53], s[52:53], 1
    v_cndmask_b32_dpp v86, v86, v86, vcc wave_shr:1 row_mask:0xf bank_mask:0xf
    v_cndmask_b32_dpp v87, v87, v87, vcc wave_shr:1 row_mask:0xf bank_mask:0xf
    s_andn2_b64 s[82:83], s[82:83], s[52:53]
    v_cndmask_b32_dpp v7, v7, v7, vcc wave_shr:1 row_mask:0xf bank_mask:0xf
    s_mov_b64 exec, s[50:51]
    s_cbranch_scc0 L2_d24
    s_mov_b64 exec, s[82:83]
    s_nop 1
    v_mfma_f32_4x4x4_16b_bf16 v[88:91], v[12:13], v[84:85], 0
    s_nop 1
    v_mfma_f32_4x4x4_16b_bf16 v[88:91], v[10:11], v[86:87], v[88:91]
    s_nop 4
    v_cvt_pk_bf16_f32 v88, v88, v89
    v_cvt_pk_bf16_f32 v89, v90, v91
    ds_pk_add_bf16 v7, v88 offset:65408
    ds_pk_add_bf16 v7, v89 offset:65412
    s_mov_b64 exec, s[50:51]
    s_branch L2_d24
L2_xa25:
    s_cmp_eq_u32 s101, 1
    s_cbranch_scc1 L2_xc25
    v_lshlrev_b32 v89, 0, v96
    v_add_u32 v90, 140, v97
    v_bitop3_b32 v90, v89, v45, v90 bitop3:0x6a
    ds_write_b32 v98, v90 offset:28
    v_lshlrev_b32 v89, 4, v96
    v_add_u32 v90, 120, v97
    v_bitop3_b32 v90, v89, v45, v90 bitop3:0x6a
    ds_write_b32 v98, v90 offset:24
    v_lshlrev_b32 v89, 8, v96
    v_add_u32 v90, 100, v97
    v_bitop3_b32 v90, v89, v45, v90 bitop3:0x6a
    ds_write_b32 v98, v90 offset:20
L2_xc25:
    v_lshlrev_b32 v89, 12, v96
    v_add_u32 v90, 80, v97
    v_bitop3_b32 v90, v89, v45, v90 bitop3:0x6a
    ds_write_b32 v98, v90 offset:16
    s_branch L2_xb25
L2_xe25:
    v_cmp_lt_u32 vcc, 32, v99
    v_cmp_lt_u32 s[58:59], 31, v88
    v_lshrrev_b32 v89, 16, v96
    v_add_u32 v97, 80, v97
    s_or_b64 vcc, vcc, s[58:59]
    s_cbranch_scc1 L2_xs25
    v_lshlrev_b32 v89, v1, v89
    v_and_b32 v89, v45, v89
    v_cmp_ne_u32 vcc, 0, v89
    v_xor_b32 v90, v97, v89
    s_add_u32 s3, s37, s38
    v_mbcnt_lo_u32_b32 v98, vcc_lo, 0
    v_mbcnt_hi_u32_b32 v98, vcc_hi, v98
    s_bcnt1_i32_b64 s41, vcc
    v_lshl_add_u32 v98, v98, 2, s3
    s_lshl2_add_u32 s37, s41, s37
    s_mov_b64 exec, vcc
    ds_write_b32 v98, v90
    s_mov_b64 exec, -1
    s_branch L2_xr25
L2_xf25:
    s_waitcnt lgkmcnt(0)
    s_cmp_gt_u32 s37, 1024
    s_cbranch_scc1 L2_xs25
    s_cmp_lt_u32 s37, 768
    s_cbranch_scc1 L2_xl25
    ds_read_b32 v32, v98 offset:896
    s_add_u32 s3, s42, 2
    s_bitset1_b32 s43, s3
    s_branch L2_xg25
L2_xl25:
    v_mov_b32 v42, -1
    s_cmp_ge_u32 s37, 512
    s_cbranch_scc1 L2_xg25
    v_mov_b32 v43, -1
    s_cmp_ge_u32 s37, 256
    s_cbranch_scc1 L2_xg25
    v_mov_b32 v41, -1
    s_branch L2_xg25
L2_xs25:
    s_waitcnt lgkmcnt(0)
    v_mov_b32 v40, -1
    v_mov_b32 v41, -1
    v_mov_b32 v43, -1
    v_mov_b32 v42, -1
    s_add_u32 s3, s42, 2
    s_bitset1_b32 s36, s3
    s_branch L2_xg25
L2_c26:
    s_lshl_b64 s[52:53], s[82:83], 1
    s_andn2_b64 s[52:53], s[52:53], s[80:81]
    s_andn2_b64 s[52:53], s[52:53], s[54:55]
    s_or_b64 s[80:81], s[80:81], s[52:53]
    s_not_b64 vcc, s[52:53]
    s_mov_b64 exec, -1
    v_cndmask_b32_dpp v84, v84, v84, vcc wave_shr:1 row_mask:0xf bank_mask:0xf
    v_cndmask_b32_dpp v85, v85, v85, vcc wave_shr:1 row_mask:0xf bank_mask:0xf
    s_lshr_b64 s[52:53], s[52:53], 1
    v_cndmask_b32_dpp v86, v86, v86, vcc wave_shr:1 row_mask:0xf bank_mask:0xf
    v_cndmask_b32_dpp v87, v87, v87, vcc wave_shr:1 row_mask:0xf bank_mask:0xf
    s_andn2_b64 s[82:83], s[82:83], s[52:53]
    v_cndmask_b32_dpp v7, v7, v7, vcc wave_shr:1 row_mask:0xf bank_mask:0xf
    s_mov_b64 exec, s[54:55]
    s_cbranch_scc0 L2_d26
    s_mov_b64 exec, s[82:83]
    s_nop 1
    v_mfma_f32_4x4x4_16b_bf16 v[88:91], v[12:13], v[84:85], 0
    s_nop 1
    v_mfma_f32_4x4x4_16b_bf16 v[88:91], v[10:11], v[86:87], v[88:91]
    s_nop 4
    v_cvt_pk_bf16_f32 v88, v88, v89
    v_cvt_pk_bf16_f32 v89, v90, v91
    ds_pk_add_bf16 v7, v88 offset:65408
    ds_pk_add_bf16 v7, v89 offset:65412
    s_mov_b64 exec, s[54:55]
    s_branch L2_d26
L2_c27:
    s_lshl_b64 s[52:53], s[82:83], 1
    s_andn2_b64 s[52:53], s[52:53], s[80:81]
    s_andn2_b64 s[52:53], s[52:53], s[50:51]
    s_or_b64 s[80:81], s[80:81], s[52:53]
    s_not_b64 vcc, s[52:53]
    s_mov_b64 exec, -1
    v_cndmask_b32_dpp v84, v84, v84, vcc wave_shr:1 row_mask:0xf bank_mask:0xf
    v_cndmask_b32_dpp v85, v85, v85, vcc wave_shr:1 row_mask:0xf bank_mask:0xf
    s_lshr_b64 s[52:53], s[52:53], 1
    v_cndmask_b32_dpp v86, v86, v86, vcc wave_shr:1 row_mask:0xf bank_mask:0xf
    v_cndmask_b32_dpp v87, v87, v87, vcc wave_shr:1 row_mask:0xf bank_mask:0xf
    s_andn2_b64 s[82:83], s[82:83], s[52:53]
    v_cndmask_b32_dpp v7, v7, v7, vcc wave_shr:1 row_mask:0xf bank_mask:0xf
    s_mov_b64 exec, s[50:51]
    s_cbranch_scc0 L2_d27
    s_mov_b64 exec, s[82:83]
    s_nop 1
    v_mfma_f32_4x4x4_16b_bf16 v[88:91], v[12:13], v[84:85], 0
    s_nop 1
    v_mfma_f32_4x4x4_16b_bf16 v[88:91], v[10:11], v[86:87], v[88:91]
    s_nop 4
    v_cvt_pk_bf16_f32 v88, v88, v89
    v_cvt_pk_bf16_f32 v89, v90, v91
    ds_pk_add_bf16 v7, v88 offset:65408
    ds_pk_add_bf16 v7, v89 offset:65412
    s_mov_b64 exec, s[50:51]
    s_branch L2_d27
L2_oa28:
    v_and_b32 v47, 0x0fffffff, v33
    buffer_load_dword v114, v47, s[8:11], 0 offen offset:16
    s_mov_b64 exec, s[6:7]
    v_add_u32 v47, 8, v47
    v_lshrrev_b32 v33, 2, v33
    s_mov_b64 exec, -1
    buffer_load_dwordx2 v[112:113], v47, s[8:11], 0 offen
    s_branch L2_ob28
L2_c29:
    s_lshl_b64 s[52:53], s[82:83], 1
    s_andn2_b64 s[52:53], s[52:53], s[80:81]
    s_andn2_b64 s[52:53], s[52:53], s[54:55]
    s_or_b64 s[80:81], s[80:81], s[52:53]
    s_not_b64 vcc, s[52:53]
    s_mov_b64 exec, -1
    v_cndmask_b32_dpp v84, v84, v84, vcc wave_shr:1 row_mask:0xf bank_mask:0xf
    v_cndmask_b32_dpp v85, v85, v85, vcc wave_shr:1 row_mask:0xf bank_mask:0xf
    s_lshr_b64 s[52:53], s[52:53], 1
    v_cndmask_b32_dpp v86, v86, v86, vcc wave_shr:1 row_mask:0xf bank_mask:0xf
    v_cndmask_b32_dpp v87, v87, v87, vcc wave_shr:1 row_mask:0xf bank_mask:0xf
    s_andn2_b64 s[82:83], s[82:83], s[52:53]
    v_cndmask_b32_dpp v7, v7, v7, vcc wave_shr:1 row_mask:0xf bank_mask:0xf
    s_mov_b64 exec, s[54:55]
    s_cbranch_scc0 L2_d29
    s_mov_b64 exec, s[82:83]
    s_nop 1
    v_mfma_f32_4x4x4_16b_bf16 v[88:91], v[12:13], v[84:85], 0
    s_nop 1
    v_mfma_f32_4x4x4_16b_bf16 v[88:91], v[10:11], v[86:87], v[88:91]
    s_nop 4
    v_cvt_pk_bf16_f32 v88, v88, v89
    v_cvt_pk_bf16_f32 v89, v90, v91
    ds_pk_add_bf16 v7, v88 offset:65408
    ds_pk_add_bf16 v7, v89 offset:65412
    s_mov_b64 exec, s[54:55]
    s_branch L2_d29
L2_c30:
    s_lshl_b64 s[52:53], s[82:83], 1
    s_andn2_b64 s[52:53], s[52:53], s[80:81]
    s_andn2_b64 s[52:53], s[52:53], s[50:51]
    s_or_b64 s[80:81], s[80:81], s[52:53]
    s_not_b64 vcc, s[52:53]
    s_mov_b64 exec, -1
    v_cndmask_b32_dpp v84, v84, v84, vcc wave_shr:1 row_mask:0xf bank_mask:0xf
    v_cndmask_b32_dpp v85, v85, v85, vcc wave_shr:1 row_mask:0xf bank_mask:0xf
    s_lshr_b64 s[52:53], s[52:53], 1
    v_cndmask_b32_dpp v86, v86, v86, vcc wave_shr:1 row_mask:0xf bank_mask:0xf
    v_cndmask_b32_dpp v87, v87, v87, vcc wave_shr:1 row_mask:0xf bank_mask:0xf
    s_andn2_b64 s[82:83], s[82:83], s[52:53]
    v_cndmask_b32_dpp v7, v7, v7, vcc wave_shr:1 row_mask:0xf bank_mask:0xf
    s_mov_b64 exec, s[50:51]
    s_cbranch_scc0 L2_d30
    s_mov_b64 exec, s[82:83]
    s_nop 1
    v_mfma_f32_4x4x4_16b_bf16 v[88:91], v[12:13], v[84:85], 0
    s_nop 1
    v_mfma_f32_4x4x4_16b_bf16 v[88:91], v[10:11], v[86:87], v[88:91]
    s_nop 4
    v_cvt_pk_bf16_f32 v88, v88, v89
    v_cvt_pk_bf16_f32 v89, v90, v91
    ds_pk_add_bf16 v7, v88 offset:65408
    ds_pk_add_bf16 v7, v89 offset:65412
    s_mov_b64 exec, s[50:51]
    s_branch L2_d30
L2_c31:
    s_lshl_b64 s[52:53], s[82:83], 1
    s_andn2_b64 s[52:53], s[52:53], s[80:81]
    s_andn2_b64 s[52:53], s[52:53], s[54:55]
    s_or_b64 s[80:81], s[80:81], s[52:53]
    s_not_b64 vcc, s[52:53]
    s_mov_b64 exec, -1
    v_cndmask_b32_dpp v84, v84, v84, vcc wave_shr:1 row_mask:0xf bank_mask:0xf
    v_cndmask_b32_dpp v85, v85, v85, vcc wave_shr:1 row_mask:0xf bank_mask:0xf
    s_lshr_b64 s[52:53], s[52:53], 1
    v_cndmask_b32_dpp v86, v86, v86, vcc wave_shr:1 row_mask:0xf bank_mask:0xf
    v_cndmask_b32_dpp v87, v87, v87, vcc wave_shr:1 row_mask:0xf bank_mask:0xf
    s_andn2_b64 s[82:83], s[82:83], s[52:53]
    v_cndmask_b32_dpp v7, v7, v7, vcc wave_shr:1 row_mask:0xf bank_mask:0xf
    s_mov_b64 exec, s[54:55]
    s_cbranch_scc0 L2_d31
    s_mov_b64 exec, s[82:83]
    s_nop 1
    v_mfma_f32_4x4x4_16b_bf16 v[88:91], v[12:13], v[84:85], 0
    s_nop 1
    v_mfma_f32_4x4x4_16b_bf16 v[88:91], v[10:11], v[86:87], v[88:91]
    s_nop 4
    v_cvt_pk_bf16_f32 v88, v88, v89
    v_cvt_pk_bf16_f32 v89, v90, v91
    ds_pk_add_bf16 v7, v88 offset:65408
    ds_pk_add_bf16 v7, v89 offset:65412
    s_mov_b64 exec, s[54:55]
    s_branch L2_d31
L2_c32:
    s_lshl_b64 s[52:53], s[82:83], 1
    s_andn2_b64 s[52:53], s[52:53], s[80:81]
    s_andn2_b64 s[52:53], s[52:53], s[50:51]
    s_or_b64 s[80:81], s[80:81], s[52:53]
    s_not_b64 vcc, s[52:53]
    s_mov_b64 exec, -1
    v_cndmask_b32_dpp v84, v84, v84, vcc wave_shr:1 row_mask:0xf bank_mask:0xf
    v_cndmask_b32_dpp v85, v85, v85, vcc wave_shr:1 row_mask:0xf bank_mask:0xf
    s_lshr_b64 s[52:53], s[52:53], 1
    v_cndmask_b32_dpp v86, v86, v86, vcc wave_shr:1 row_mask:0xf bank_mask:0xf
    v_cndmask_b32_dpp v87, v87, v87, vcc wave_shr:1 row_mask:0xf bank_mask:0xf
    s_andn2_b64 s[82:83], s[82:83], s[52:53]
    v_cndmask_b32_dpp v7, v7, v7, vcc wave_shr:1 row_mask:0xf bank_mask:0xf
    s_mov_b64 exec, s[50:51]
    s_cbranch_scc0 L2_d32
    s_mov_b64 exec, s[82:83]
    s_nop 1
    v_mfma_f32_4x4x4_16b_bf16 v[88:91], v[12:13], v[84:85], 0
    s_nop 1
    v_mfma_f32_4x4x4_16b_bf16 v[88:91], v[10:11], v[86:87], v[88:91]
    s_nop 4
    v_cvt_pk_bf16_f32 v88, v88, v89
    v_cvt_pk_bf16_f32 v89, v90, v91
    ds_pk_add_bf16 v7, v88 offset:65408
    ds_pk_add_bf16 v7, v89 offset:65412
    s_mov_b64 exec, s[50:51]
    s_branch L2_d32
L2_c33:
    s_lshl_b64 s[52:53], s[82:83], 1
    s_andn2_b64 s[52:53], s[52:53], s[80:81]
    s_andn2_b64 s[52:53], s[52:53], s[54:55]
    s_or_b64 s[80:81], s[80:81], s[52:53]
    s_not_b64 vcc, s[52:53]
    s_mov_b64 exec, -1
    v_cndmask_b32_dpp v84, v84, v84, vcc wave_shr:1 row_mask:0xf bank_mask:0xf
    v_cndmask_b32_dpp v85, v85, v85, vcc wave_shr:1 row_mask:0xf bank_mask:0xf
    s_lshr_b64 s[52:53], s[52:53], 1
    v_cndmask_b32_dpp v86, v86, v86, vcc wave_shr:1 row_mask:0xf bank_mask:0xf
    v_cndmask_b32_dpp v87, v87, v87, vcc wave_shr:1 row_mask:0xf bank_mask:0xf
    s_andn2_b64 s[82:83], s[82:83], s[52:53]
    v_cndmask_b32_dpp v7, v7, v7, vcc wave_shr:1 row_mask:0xf bank_mask:0xf
    s_mov_b64 exec, s[54:55]
    s_cbranch_scc0 L2_d33
    s_mov_b64 exec, s[82:83]
    s_nop 1
    v_mfma_f32_4x4x4_16b_bf16 v[88:91], v[12:13], v[84:85], 0
    s_nop 1
    v_mfma_f32_4x4x4_16b_bf16 v[88:91], v[10:11], v[86:87], v[88:91]
    s_nop 4
    v_cvt_pk_bf16_f32 v88, v88, v89
    v_cvt_pk_bf16_f32 v89, v90, v91
    ds_pk_add_bf16 v7, v88 offset:65408
    ds_pk_add_bf16 v7, v89 offset:65412
    s_mov_b64 exec, s[54:55]
    s_branch L2_d33
L2_c34:
    s_lshl_b64 s[52:53], s[82:83], 1
    s_andn2_b64 s[52:53], s[52:53], s[80:81]
    s_andn2_b64 s[52:53], s[52:53], s[50:51]
    s_or_b64 s[80:81], s[80:81], s[52:53]
    s_not_b64 vcc, s[52:53]
    s_mov_b64 exec, -1
    v_cndmask_b32_dpp v84, v84, v84, vcc wave_shr:1 row_mask:0xf bank_mask:0xf
    v_cndmask_b32_dpp v85, v85, v85, vcc wave_shr:1 row_mask:0xf bank_mask:0xf
    s_lshr_b64 s[52:53], s[52:53], 1
    v_cndmask_b32_dpp v86, v86, v86, vcc wave_shr:1 row_mask:0xf bank_mask:0xf
    v_cndmask_b32_dpp v87, v87, v87, vcc wave_shr:1 row_mask:0xf bank_mask:0xf
    s_andn2_b64 s[82:83], s[82:83], s[52:53]
    v_cndmask_b32_dpp v7, v7, v7, vcc wave_shr:1 row_mask:0xf bank_mask:0xf
    s_mov_b64 exec, s[50:51]
    s_cbranch_scc0 L2_d34
    s_mov_b64 exec, s[82:83]
    s_nop 1
    v_mfma_f32_4x4x4_16b_bf16 v[88:91], v[12:13], v[84:85], 0
    s_nop 1
    v_mfma_f32_4x4x4_16b_bf16 v[88:91], v[10:11], v[86:87], v[88:91]
    s_nop 4
    v_cvt_pk_bf16_f32 v88, v88, v89
    v_cvt_pk_bf16_f32 v89, v90, v91
    ds_pk_add_bf16 v7, v88 offset:65408
    ds_pk_add_bf16 v7, v89 offset:65412
    s_mov_b64 exec, s[50:51]
    s_branch L2_d34
L2_oa35:
    s_waitcnt vmcnt(3)
    s_mov_b64 exec, s[6:7]
    v_lshrrev_b32 v114, 16, v114
    s_mov_b64 exec, -1
    v_and_b32 v46, 0x10000000, v33
    v_cmpx_eq_u32 vcc, 0, v46
    v_lshrrev_b32 v47, 14, v112
    v_and_b32 v47, v5, v47
    ds_read_b64 v[96:97], v47
    v_perm_b32 v98, v112, v114, s44
    v_bitop3_b32 v99, v112, 0.5, -0.5 bitop3:0xa8
    v_bitop3_b32 v98, v6, v98, v99 bitop3:0xca
    v_and_b32 v47, v5, v112
    s_waitcnt lgkmcnt(0)
    v_mfma_f32_4x4x4_16b_bf16 v[88:91], v[8:9], v[96:97], 0
    s_nop 4
    v_mul_f32 v88, v98, v88
    v_mul_f32 v89, v98, v89
    v_mul_f32 v90, v98, v90
    v_mul_f32 v91, v98, v91
    v_cvt_pk_bf16_f32 v88, v88, v89
    v_cvt_pk_bf16_f32 v89, v90, v91
    ds_pk_add_bf16 v47, v88 offset:65408
    ds_pk_add_bf16 v47, v89 offset:65412
    s_mov_b64 exec, -1
    v_and_b32 v46, 0x20000000, v33
    v_cmpx_eq_u32 vcc, 0, v46
    v_lshrrev_b32 v47, 14, v113
    v_and_b32 v47, v5, v47
    ds_read_b64 v[96:97], v47
    v_perm_b32 v98, v113, v114, s45
    v_bitop3_b32 v99, v113, 0.5, -0.5 bitop3:0xa8
    v_bitop3_b32 v98, v6, v98, v99 bitop3:0xca
    v_and_b32 v47, v5, v113
    s_waitcnt lgkmcnt(0)
    v_mfma_f32_4x4x4_16b_bf16 v[88:91], v[8:9], v[96:97], 0
    s_nop 4
    v_mul_f32 v88, v98, v88
    v_mul_f32 v89, v98, v89
    v_mul_f32 v90, v98, v90
    v_mul_f32 v91, v98, v91
    v_cvt_pk_bf16_f32 v88, v88, v89
    v_cvt_pk_bf16_f32 v89, v90, v91
    ds_pk_add_bf16 v47, v88 offset:65408
    ds_pk_add_bf16 v47, v89 offset:65412
    s_mov_b64 exec, -1
    s_branch L2_ob35
L2_xo36:
    v_cmp_lt_u32 vcc, 20, v99
    s_mov_b32 s101, 1
    s_cbranch_vccz L2_xp36
    v_cmp_lt_u32 vcc, 32, v99
    v_cmp_lt_u32 s[58:59], 31, v88
    s_mov_b32 s101, 2
    s_or_b64 vcc, vcc, s[58:59]
    s_cbranch_scc0 L2_xp36
    s_mov_b32 s37, 0x10000
    s_branch L2_xp36
L2_c37:
    s_lshl_b64 s[52:53], s[82:83], 1
    s_andn2_b64 s[52:53], s[52:53], s[80:81]
    s_andn2_b64 s[52:53], s[52:53], s[54:55]
    s_or_b64 s[80:81], s[80:81], s[52:53]
    s_not_b64 vcc, s[52:53]
    s_mov_b64 exec, -1
    v_cndmask_b32_dpp v84, v84, v84, vcc wave_shr:1 row_mask:0xf bank_mask:0xf
    v_cndmask_b32_dpp v85, v85, v85, vcc wave_shr:1 row_mask:0xf bank_mask:0xf
    s_lshr_b64 s[52:53], s[52:53], 1
    v_cndmask_b32_dpp v86, v86, v86, vcc wave_shr:1 row_mask:0xf bank_mask:0xf
    v_cndmask_b32_dpp v87, v87, v87, vcc wave_shr:1 row_mask:0xf bank_mask:0xf
    s_andn2_b64 s[82:83], s[82:83], s[52:53]
    v_cndmask_b32_dpp v7, v7, v7, vcc wave_shr:1 row_mask:0xf bank_mask:0xf
    s_mov_b64 exec, s[54:55]
    s_cbranch_scc0 L2_d37
    s_mov_b64 exec, s[82:83]
    s_nop 1
    v_mfma_f32_4x4x4_16b_bf16 v[88:91], v[12:13], v[84:85], 0
    s_nop 1
    v_mfma_f32_4x4x4_16b_bf16 v[88:91], v[10:11], v[86:87], v[88:91]
    s_nop 4
    v_cvt_pk_bf16_f32 v88, v88, v89
    v_cvt_pk_bf16_f32 v89, v90, v91
    ds_pk_add_bf16 v7, v88 offset:65408
    ds_pk_add_bf16 v7, v89 offset:65412
    s_mov_b64 exec, s[54:55]
    s_branch L2_d37
L2_c38:
    s_lshl_b64 s[52:53], s[82:83], 1
    s_andn2_b64 s[52:53], s[52:53], s[80:81]
    s_andn2_b64 s[52:53], s[52:53], s[50:51]
    s_or_b64 s[80:81], s[80:81], s[52:53]
    s_not_b64 vcc, s[52:53]
    s_mov_b64 exec, -1
    v_cndmask_b32_dpp v84, v84, v84, vcc wave_shr:1 row_mask:0xf bank_mask:0xf
    v_cndmask_b32_dpp v85, v85, v85, vcc wave_shr:1 row_mask:0xf bank_mask:0xf
    s_lshr_b64 s[52:53], s[52:53], 1
    v_cndmask_b32_dpp v86, v86, v86, vcc wave_shr:1 row_mask:0xf bank_mask:0xf
    v_cndmask_b32_dpp v87, v87, v87, vcc wave_shr:1 row_mask:0xf bank_mask:0xf
    s_andn2_b64 s[82:83], s[82:83], s[52:53]
    v_cndmask_b32_dpp v7, v7, v7, vcc wave_shr:1 row_mask:0xf bank_mask:0xf
    s_mov_b64 exec, s[50:51]
    s_cbranch_scc0 L2_d38
    s_mov_b64 exec, s[82:83]
    s_nop 1
    v_mfma_f32_4x4x4_16b_bf16 v[88:91], v[12:13], v[84:85], 0
    s_nop 1
    v_mfma_f32_4x4x4_16b_bf16 v[88:91], v[10:11], v[86:87], v[88:91]
    s_nop 4
    v_cvt_pk_bf16_f32 v88, v88, v89
    v_cvt_pk_bf16_f32 v89, v90, v91
    ds_pk_add_bf16 v7, v88 offset:65408
    ds_pk_add_bf16 v7, v89 offset:65412
    s_mov_b64 exec, s[50:51]
    s_branch L2_d38
L2_c39:
    s_lshl_b64 s[52:53], s[82:83], 1
    s_andn2_b64 s[52:53], s[52:53], s[80:81]
    s_andn2_b64 s[52:53], s[52:53], s[54:55]
    s_or_b64 s[80:81], s[80:81], s[52:53]
    s_not_b64 vcc, s[52:53]
    s_mov_b64 exec, -1
    v_cndmask_b32_dpp v84, v84, v84, vcc wave_shr:1 row_mask:0xf bank_mask:0xf
    v_cndmask_b32_dpp v85, v85, v85, vcc wave_shr:1 row_mask:0xf bank_mask:0xf
    s_lshr_b64 s[52:53], s[52:53], 1
    v_cndmask_b32_dpp v86, v86, v86, vcc wave_shr:1 row_mask:0xf bank_mask:0xf
    v_cndmask_b32_dpp v87, v87, v87, vcc wave_shr:1 row_mask:0xf bank_mask:0xf
    s_andn2_b64 s[82:83], s[82:83], s[52:53]
    v_cndmask_b32_dpp v7, v7, v7, vcc wave_shr:1 row_mask:0xf bank_mask:0xf
    s_mov_b64 exec, s[54:55]
    s_cbranch_scc0 L2_d39
    s_mov_b64 exec, s[82:83]
    s_nop 1
    v_mfma_f32_4x4x4_16b_bf16 v[88:91], v[12:13], v[84:85], 0
    s_nop 1
    v_mfma_f32_4x4x4_16b_bf16 v[88:91], v[10:11], v[86:87], v[88:91]
    s_nop 4
    v_cvt_pk_bf16_f32 v88, v88, v89
    v_cvt_pk_bf16_f32 v89, v90, v91
    ds_pk_add_bf16 v7, v88 offset:65408
    ds_pk_add_bf16 v7, v89 offset:65412
    s_mov_b64 exec, s[54:55]
    s_branch L2_d39
L2_c40:
    s_lshl_b64 s[52:53], s[82:83], 1
    s_andn2_b64 s[52:53], s[52:53], s[80:81]
    s_andn2_b64 s[52:53], s[52:53], s[50:51]
    s_or_b64 s[80:81], s[80:81], s[52:53]
    s_not_b64 vcc, s[52:53]
    s_mov_b64 exec, -1
    v_cndmask_b32_dpp v84, v84, v84, vcc wave_shr:1 row_mask:0xf bank_mask:0xf
    v_cndmask_b32_dpp v85, v85, v85, vcc wave_shr:1 row_mask:0xf bank_mask:0xf
    s_lshr_b64 s[52:53], s[52:53], 1
    v_cndmask_b32_dpp v86, v86, v86, vcc wave_shr:1 row_mask:0xf bank_mask:0xf
    v_cndmask_b32_dpp v87, v87, v87, vcc wave_shr:1 row_mask:0xf bank_mask:0xf
    s_andn2_b64 s[82:83], s[82:83], s[52:53]
    v_cndmask_b32_dpp v7, v7, v7, vcc wave_shr:1 row_mask:0xf bank_mask:0xf
    s_mov_b64 exec, s[50:51]
    s_cbranch_scc0 L2_d40
    s_mov_b64 exec, s[82:83]
    s_nop 1
    v_mfma_f32_4x4x4_16b_bf16 v[88:91], v[12:13], v[84:85], 0
    s_nop 1
    v_mfma_f32_4x4x4_16b_bf16 v[88:91], v[10:11], v[86:87], v[88:91]
    s_nop 4
    v_cvt_pk_bf16_f32 v88, v88, v89
    v_cvt_pk_bf16_f32 v89, v90, v91
    ds_pk_add_bf16 v7, v88 offset:65408
    ds_pk_add_bf16 v7, v89 offset:65412
    s_mov_b64 exec, s[50:51]
    s_branch L2_d40
L2_c41:
    s_lshl_b64 s[52:53], s[82:83], 1
    s_andn2_b64 s[52:53], s[52:53], s[80:81]
    s_andn2_b64 s[52:53], s[52:53], s[54:55]
    s_or_b64 s[80:81], s[80:81], s[52:53]
    s_not_b64 vcc, s[52:53]
    s_mov_b64 exec, -1
    v_cndmask_b32_dpp v84, v84, v84, vcc wave_shr:1 row_mask:0xf bank_mask:0xf
    v_cndmask_b32_dpp v85, v85, v85, vcc wave_shr:1 row_mask:0xf bank_mask:0xf
    s_lshr_b64 s[52:53], s[52:53], 1
    v_cndmask_b32_dpp v86, v86, v86, vcc wave_shr:1 row_mask:0xf bank_mask:0xf
    v_cndmask_b32_dpp v87, v87, v87, vcc wave_shr:1 row_mask:0xf bank_mask:0xf
    s_andn2_b64 s[82:83], s[82:83], s[52:53]
    v_cndmask_b32_dpp v7, v7, v7, vcc wave_shr:1 row_mask:0xf bank_mask:0xf
    s_mov_b64 exec, s[54:55]
    s_cbranch_scc0 L2_d41
    s_mov_b64 exec, s[82:83]
    s_nop 1
    v_mfma_f32_4x4x4_16b_bf16 v[88:91], v[12:13], v[84:85], 0
    s_nop 1
    v_mfma_f32_4x4x4_16b_bf16 v[88:91], v[10:11], v[86:87], v[88:91]
    s_nop 4
    v_cvt_pk_bf16_f32 v88, v88, v89
    v_cvt_pk_bf16_f32 v89, v90, v91
    ds_pk_add_bf16 v7, v88 offset:65408
    ds_pk_add_bf16 v7, v89 offset:65412
    s_mov_b64 exec, s[54:55]
    s_branch L2_d41
L2_c42:
    s_lshl_b64 s[52:53], s[82:83], 1
    s_andn2_b64 s[52:53], s[52:53], s[80:81]
    s_andn2_b64 s[52:53], s[52:53], s[50:51]
    s_or_b64 s[80:81], s[80:81], s[52:53]
    s_not_b64 vcc, s[52:53]
    s_mov_b64 exec, -1
    v_cndmask_b32_dpp v84, v84, v84, vcc wave_shr:1 row_mask:0xf bank_mask:0xf
    v_cndmask_b32_dpp v85, v85, v85, vcc wave_shr:1 row_mask:0xf bank_mask:0xf
    s_lshr_b64 s[52:53], s[52:53], 1
    v_cndmask_b32_dpp v86, v86, v86, vcc wave_shr:1 row_mask:0xf bank_mask:0xf
    v_cndmask_b32_dpp v87, v87, v87, vcc wave_shr:1 row_mask:0xf bank_mask:0xf
    s_andn2_b64 s[82:83], s[82:83], s[52:53]
    v_cndmask_b32_dpp v7, v7, v7, vcc wave_shr:1 row_mask:0xf bank_mask:0xf
    s_mov_b64 exec, s[50:51]
    s_cbranch_scc0 L2_d42
    s_mov_b64 exec, s[82:83]
    s_nop 1
    v_mfma_f32_4x4x4_16b_bf16 v[88:91], v[12:13], v[84:85], 0
    s_nop 1
    v_mfma_f32_4x4x4_16b_bf16 v[88:91], v[10:11], v[86:87], v[88:91]
    s_nop 4
    v_cvt_pk_bf16_f32 v88, v88, v89
    v_cvt_pk_bf16_f32 v89, v90, v91
    ds_pk_add_bf16 v7, v88 offset:65408
    ds_pk_add_bf16 v7, v89 offset:65412
    s_mov_b64 exec, s[50:51]
    s_branch L2_d42
L2_xa43:
    s_cmp_eq_u32 s101, 1
    s_cbranch_scc1 L2_xc43
    v_lshlrev_b32 v89, 0, v96
    v_add_u32 v90, 140, v97
    v_bitop3_b32 v90, v89, v45, v90 bitop3:0x6a
    ds_write_b32 v98, v90 offset:28
    v_lshlrev_b32 v89, 4, v96
    v_add_u32 v90, 120, v97
    v_bitop3_b32 v90, v89, v45, v90 bitop3:0x6a
    ds_write_b32 v98, v90 offset:24
    v_lshlrev_b32 v89, 8, v96
    v_add_u32 v90, 100, v97
    v_bitop3_b32 v90, v89, v45, v90 bitop3:0x6a
    ds_write_b32 v98, v90 offset:20
L2_xc43:
    v_lshlrev_b32 v89, 12, v96
    v_add_u32 v90, 80, v97
    v_bitop3_b32 v90, v89, v45, v90 bitop3:0x6a
    ds_write_b32 v98, v90 offset:16
    s_branch L2_xb43
L2_xe43:
    v_cmp_lt_u32 vcc, 32, v99
    v_cmp_lt_u32 s[58:59], 31, v88
    v_lshrrev_b32 v89, 16, v96
    v_add_u32 v97, 80, v97
    s_or_b64 vcc, vcc, s[58:59]
    s_cbranch_scc1 L2_xs43
    v_lshlrev_b32 v89, v1, v89
    v_and_b32 v89, v45, v89
    v_cmp_ne_u32 vcc, 0, v89
    v_xor_b32 v90, v97, v89
    s_add_u32 s3, s37, s38
    v_mbcnt_lo_u32_b32 v98, vcc_lo, 0
    v_mbcnt_hi_u32_b32 v98, vcc_hi, v98
    s_bcnt1_i32_b64 s41, vcc
    v_lshl_add_u32 v98, v98, 2, s3
    s_lshl2_add_u32 s37, s41, s37
    s_mov_b64 exec, vcc
    ds_write_b32 v98, v90
    s_mov_b64 exec, -1
    s_branch L2_xr43
L2_xf43:
    s_waitcnt lgkmcnt(0)
    s_cmp_gt_u32 s37, 1024
    s_cbranch_scc1 L2_xs43
    s_cmp_lt_u32 s37, 768
    s_cbranch_scc1 L2_xl43
    ds_read_b32 v33, v98 offset:896
    s_add_u32 s3, s42, 2
    s_bitset1_b32 s43, s3
    s_branch L2_xg43
L2_xl43:
    v_mov_b32 v42, -1
    s_cmp_ge_u32 s37, 512
    s_cbranch_scc1 L2_xg43
    v_mov_b32 v43, -1
    s_cmp_ge_u32 s37, 256
    s_cbranch_scc1 L2_xg43
    v_mov_b32 v41, -1
    s_branch L2_xg43
L2_xs43:
    s_waitcnt lgkmcnt(0)
    v_mov_b32 v40, -1
    v_mov_b32 v41, -1
    v_mov_b32 v43, -1
    v_mov_b32 v42, -1
    s_add_u32 s3, s42, 2
    s_bitset1_b32 s36, s3
    s_branch L2_xg43
L2_c44:
    s_lshl_b64 s[52:53], s[82:83], 1
    s_andn2_b64 s[52:53], s[52:53], s[80:81]
    s_andn2_b64 s[52:53], s[52:53], s[54:55]
    s_or_b64 s[80:81], s[80:81], s[52:53]
    s_not_b64 vcc, s[52:53]
    s_mov_b64 exec, -1
    v_cndmask_b32_dpp v84, v84, v84, vcc wave_shr:1 row_mask:0xf bank_mask:0xf
    v_cndmask_b32_dpp v85, v85, v85, vcc wave_shr:1 row_mask:0xf bank_mask:0xf
    s_lshr_b64 s[52:53], s[52:53], 1
    v_cndmask_b32_dpp v86, v86, v86, vcc wave_shr:1 row_mask:0xf bank_mask:0xf
    v_cndmask_b32_dpp v87, v87, v87, vcc wave_shr:1 row_mask:0xf bank_mask:0xf
    s_andn2_b64 s[82:83], s[82:83], s[52:53]
    v_cndmask_b32_dpp v7, v7, v7, vcc wave_shr:1 row_mask:0xf bank_mask:0xf
    s_mov_b64 exec, s[54:55]
    s_cbranch_scc0 L2_d44
    s_mov_b64 exec, s[82:83]
    s_nop 1
    v_mfma_f32_4x4x4_16b_bf16 v[88:91], v[12:13], v[84:85], 0
    s_nop 1
    v_mfma_f32_4x4x4_16b_bf16 v[88:91], v[10:11], v[86:87], v[88:91]
    s_nop 4
    v_cvt_pk_bf16_f32 v88, v88, v89
    v_cvt_pk_bf16_f32 v89, v90, v91
    ds_pk_add_bf16 v7, v88 offset:65408
    ds_pk_add_bf16 v7, v89 offset:65412
    s_mov_b64 exec, s[54:55]
    s_branch L2_d44
L2_c45:
    s_lshl_b64 s[52:53], s[82:83], 1
    s_andn2_b64 s[52:53], s[52:53], s[80:81]
    s_andn2_b64 s[52:53], s[52:53], s[50:51]
    s_or_b64 s[80:81], s[80:81], s[52:53]
    s_not_b64 vcc, s[52:53]
    s_mov_b64 exec, -1
    v_cndmask_b32_dpp v84, v84, v84, vcc wave_shr:1 row_mask:0xf bank_mask:0xf
    v_cndmask_b32_dpp v85, v85, v85, vcc wave_shr:1 row_mask:0xf bank_mask:0xf
    s_lshr_b64 s[52:53], s[52:53], 1
    v_cndmask_b32_dpp v86, v86, v86, vcc wave_shr:1 row_mask:0xf bank_mask:0xf
    v_cndmask_b32_dpp v87, v87, v87, vcc wave_shr:1 row_mask:0xf bank_mask:0xf
    s_andn2_b64 s[82:83], s[82:83], s[52:53]
    v_cndmask_b32_dpp v7, v7, v7, vcc wave_shr:1 row_mask:0xf bank_mask:0xf
    s_mov_b64 exec, s[50:51]
    s_cbranch_scc0 L2_d45
    s_mov_b64 exec, s[82:83]
    s_nop 1
    v_mfma_f32_4x4x4_16b_bf16 v[88:91], v[12:13], v[84:85], 0
    s_nop 1
    v_mfma_f32_4x4x4_16b_bf16 v[88:91], v[10:11], v[86:87], v[88:91]
    s_nop 4
    v_cvt_pk_bf16_f32 v88, v88, v89
    v_cvt_pk_bf16_f32 v89, v90, v91
    ds_pk_add_bf16 v7, v88 offset:65408
    ds_pk_add_bf16 v7, v89 offset:65412
    s_mov_b64 exec, s[50:51]
    s_branch L2_d45
L2_oa46:
    v_and_b32 v47, 0x0fffffff, v32
    buffer_load_dword v114, v47, s[8:11], 0 offen offset:16
    s_mov_b64 exec, s[6:7]
    v_add_u32 v47, 8, v47
    v_lshrrev_b32 v32, 2, v32
    s_mov_b64 exec, -1
    buffer_load_dwordx2 v[112:113], v47, s[8:11], 0 offen
    s_branch L2_ob46
L2_c47:
    s_lshl_b64 s[52:53], s[82:83], 1
    s_andn2_b64 s[52:53], s[52:53], s[80:81]
    s_andn2_b64 s[52:53], s[52:53], s[54:55]
    s_or_b64 s[80:81], s[80:81], s[52:53]
    s_not_b64 vcc, s[52:53]
    s_mov_b64 exec, -1
    v_cndmask_b32_dpp v84, v84, v84, vcc wave_shr:1 row_mask:0xf bank_mask:0xf
    v_cndmask_b32_dpp v85, v85, v85, vcc wave_shr:1 row_mask:0xf bank_mask:0xf
    s_lshr_b64 s[52:53], s[52:53], 1
    v_cndmask_b32_dpp v86, v86, v86, vcc wave_shr:1 row_mask:0xf bank_mask:0xf
    v_cndmask_b32_dpp v87, v87, v87, vcc wave_shr:1 row_mask:0xf bank_mask:0xf
    s_andn2_b64 s[82:83], s[82:83], s[52:53]
    v_cndmask_b32_dpp v7, v7, v7, vcc wave_shr:1 row_mask:0xf bank_mask:0xf
    s_mov_b64 exec, s[54:55]
    s_cbranch_scc0 L2_d47
    s_mov_b64 exec, s[82:83]
    s_nop 1
    v_mfma_f32_4x4x4_16b_bf16 v[88:91], v[12:13], v[84:85], 0
    s_nop 1
    v_mfma_f32_4x4x4_16b_bf16 v[88:91], v[10:11], v[86:87], v[88:91]
    s_nop 4
    v_cvt_pk_bf16_f32 v88, v88, v89
    v_cvt_pk_bf16_f32 v89, v90, v91
    ds_pk_add_bf16 v7, v88 offset:65408
    ds_pk_add_bf16 v7, v89 offset:65412
    s_mov_b64 exec, s[54:55]
    s_branch L2_d47
L2_c48:
    s_lshl_b64 s[52:53], s[82:83], 1
    s_andn2_b64 s[52:53], s[52:53], s[80:81]
    s_andn2_b64 s[52:53], s[52:53], s[50:51]
    s_or_b64 s[80:81], s[80:81], s[52:53]
    s_not_b64 vcc, s[52:53]
    s_mov_b64 exec, -1
    v_cndmask_b32_dpp v84, v84, v84, vcc wave_shr:1 row_mask:0xf bank_mask:0xf
    v_cndmask_b32_dpp v85, v85, v85, vcc wave_shr:1 row_mask:0xf bank_mask:0xf
    s_lshr_b64 s[52:53], s[52:53], 1
    v_cndmask_b32_dpp v86, v86, v86, vcc wave_shr:1 row_mask:0xf bank_mask:0xf
    v_cndmask_b32_dpp v87, v87, v87, vcc wave_shr:1 row_mask:0xf bank_mask:0xf
    s_andn2_b64 s[82:83], s[82:83], s[52:53]
    v_cndmask_b32_dpp v7, v7, v7, vcc wave_shr:1 row_mask:0xf bank_mask:0xf
    s_mov_b64 exec, s[50:51]
    s_cbranch_scc0 L2_d48
    s_mov_b64 exec, s[82:83]
    s_nop 1
    v_mfma_f32_4x4x4_16b_bf16 v[88:91], v[12:13], v[84:85], 0
    s_nop 1
    v_mfma_f32_4x4x4_16b_bf16 v[88:91], v[10:11], v[86:87], v[88:91]
    s_nop 4
    v_cvt_pk_bf16_f32 v88, v88, v89
    v_cvt_pk_bf16_f32 v89, v90, v91
    ds_pk_add_bf16 v7, v88 offset:65408
    ds_pk_add_bf16 v7, v89 offset:65412
    s_mov_b64 exec, s[50:51]
    s_branch L2_d48
L2_c49:
    s_lshl_b64 s[52:53], s[82:83], 1
    s_andn2_b64 s[52:53], s[52:53], s[80:81]
    s_andn2_b64 s[52:53], s[52:53], s[54:55]
    s_or_b64 s[80:81], s[80:81], s[52:53]
    s_not_b64 vcc, s[52:53]
    s_mov_b64 exec, -1
    v_cndmask_b32_dpp v84, v84, v84, vcc wave_shr:1 row_mask:0xf bank_mask:0xf
    v_cndmask_b32_dpp v85, v85, v85, vcc wave_shr:1 row_mask:0xf bank_mask:0xf
    s_lshr_b64 s[52:53], s[52:53], 1
    v_cndmask_b32_dpp v86, v86, v86, vcc wave_shr:1 row_mask:0xf bank_mask:0xf
    v_cndmask_b32_dpp v87, v87, v87, vcc wave_shr:1 row_mask:0xf bank_mask:0xf
    s_andn2_b64 s[82:83], s[82:83], s[52:53]
    v_cndmask_b32_dpp v7, v7, v7, vcc wave_shr:1 row_mask:0xf bank_mask:0xf
    s_mov_b64 exec, s[54:55]
    s_cbranch_scc0 L2_d49
    s_mov_b64 exec, s[82:83]
    s_nop 1
    v_mfma_f32_4x4x4_16b_bf16 v[88:91], v[12:13], v[84:85], 0
    s_nop 1
    v_mfma_f32_4x4x4_16b_bf16 v[88:91], v[10:11], v[86:87], v[88:91]
    s_nop 4
    v_cvt_pk_bf16_f32 v88, v88, v89
    v_cvt_pk_bf16_f32 v89, v90, v91
    ds_pk_add_bf16 v7, v88 offset:65408
    ds_pk_add_bf16 v7, v89 offset:65412
    s_mov_b64 exec, s[54:55]
    s_branch L2_d49
L2_c50:
    s_lshl_b64 s[52:53], s[82:83], 1
    s_andn2_b64 s[52:53], s[52:53], s[80:81]
    s_andn2_b64 s[52:53], s[52:53], s[50:51]
    s_or_b64 s[80:81], s[80:81], s[52:53]
    s_not_b64 vcc, s[52:53]
    s_mov_b64 exec, -1
    v_cndmask_b32_dpp v84, v84, v84, vcc wave_shr:1 row_mask:0xf bank_mask:0xf
    v_cndmask_b32_dpp v85, v85, v85, vcc wave_shr:1 row_mask:0xf bank_mask:0xf
    s_lshr_b64 s[52:53], s[52:53], 1
    v_cndmask_b32_dpp v86, v86, v86, vcc wave_shr:1 row_mask:0xf bank_mask:0xf
    v_cndmask_b32_dpp v87, v87, v87, vcc wave_shr:1 row_mask:0xf bank_mask:0xf
    s_andn2_b64 s[82:83], s[82:83], s[52:53]
    v_cndmask_b32_dpp v7, v7, v7, vcc wave_shr:1 row_mask:0xf bank_mask:0xf
    s_mov_b64 exec, s[50:51]
    s_cbranch_scc0 L2_d50
    s_mov_b64 exec, s[82:83]
    s_nop 1
    v_mfma_f32_4x4x4_16b_bf16 v[88:91], v[12:13], v[84:85], 0
    s_nop 1
    v_mfma_f32_4x4x4_16b_bf16 v[88:91], v[10:11], v[86:87], v[88:91]
    s_nop 4
    v_cvt_pk_bf16_f32 v88, v88, v89
    v_cvt_pk_bf16_f32 v89, v90, v91
    ds_pk_add_bf16 v7, v88 offset:65408
    ds_pk_add_bf16 v7, v89 offset:65412
    s_mov_b64 exec, s[50:51]
    s_branch L2_d50
L2_c51:
    s_lshl_b64 s[52:53], s[82:83], 1
    s_andn2_b64 s[52:53], s[52:53], s[80:81]
    s_andn2_b64 s[52:53], s[52:53], s[54:55]
    s_or_b64 s[80:81], s[80:81], s[52:53]
    s_not_b64 vcc, s[52:53]
    s_mov_b64 exec, -1
    v_cndmask_b32_dpp v84, v84, v84, vcc wave_shr:1 row_mask:0xf bank_mask:0xf
    v_cndmask_b32_dpp v85, v85, v85, vcc wave_shr:1 row_mask:0xf bank_mask:0xf
    s_lshr_b64 s[52:53], s[52:53], 1
    v_cndmask_b32_dpp v86, v86, v86, vcc wave_shr:1 row_mask:0xf bank_mask:0xf
    v_cndmask_b32_dpp v87, v87, v87, vcc wave_shr:1 row_mask:0xf bank_mask:0xf
    s_andn2_b64 s[82:83], s[82:83], s[52:53]
    v_cndmask_b32_dpp v7, v7, v7, vcc wave_shr:1 row_mask:0xf bank_mask:0xf
    s_mov_b64 exec, s[54:55]
    s_cbranch_scc0 L2_d51
    s_mov_b64 exec, s[82:83]
    s_nop 1
    v_mfma_f32_4x4x4_16b_bf16 v[88:91], v[12:13], v[84:85], 0
    s_nop 1
    v_mfma_f32_4x4x4_16b_bf16 v[88:91], v[10:11], v[86:87], v[88:91]
    s_nop 4
    v_cvt_pk_bf16_f32 v88, v88, v89
    v_cvt_pk_bf16_f32 v89, v90, v91
    ds_pk_add_bf16 v7, v88 offset:65408
    ds_pk_add_bf16 v7, v89 offset:65412
    s_mov_b64 exec, s[54:55]
    s_branch L2_d51
L2_c52:
    s_lshl_b64 s[52:53], s[82:83], 1
    s_andn2_b64 s[52:53], s[52:53], s[80:81]
    s_andn2_b64 s[52:53], s[52:53], s[50:51]
    s_or_b64 s[80:81], s[80:81], s[52:53]
    s_not_b64 vcc, s[52:53]
    s_mov_b64 exec, -1
    v_cndmask_b32_dpp v84, v84, v84, vcc wave_shr:1 row_mask:0xf bank_mask:0xf
    v_cndmask_b32_dpp v85, v85, v85, vcc wave_shr:1 row_mask:0xf bank_mask:0xf
    s_lshr_b64 s[52:53], s[52:53], 1
    v_cndmask_b32_dpp v86, v86, v86, vcc wave_shr:1 row_mask:0xf bank_mask:0xf
    v_cndmask_b32_dpp v87, v87, v87, vcc wave_shr:1 row_mask:0xf bank_mask:0xf
    s_andn2_b64 s[82:83], s[82:83], s[52:53]
    v_cndmask_b32_dpp v7, v7, v7, vcc wave_shr:1 row_mask:0xf bank_mask:0xf
    s_mov_b64 exec, s[50:51]
    s_cbranch_scc0 L2_d52
    s_mov_b64 exec, s[82:83]
    s_nop 1
    v_mfma_f32_4x4x4_16b_bf16 v[88:91], v[12:13], v[84:85], 0
    s_nop 1
    v_mfma_f32_4x4x4_16b_bf16 v[88:91], v[10:11], v[86:87], v[88:91]
    s_nop 4
    v_cvt_pk_bf16_f32 v88, v88, v89
    v_cvt_pk_bf16_f32 v89, v90, v91
    ds_pk_add_bf16 v7, v88 offset:65408
    ds_pk_add_bf16 v7, v89 offset:65412
    s_mov_b64 exec, s[50:51]
    s_branch L2_d52
L2_oa53:
    s_waitcnt vmcnt(3)
    s_mov_b64 exec, s[6:7]
    v_lshrrev_b32 v114, 16, v114
    s_mov_b64 exec, -1
    v_and_b32 v46, 0x10000000, v32
    v_cmpx_eq_u32 vcc, 0, v46
    v_lshrrev_b32 v47, 14, v112
    v_and_b32 v47, v5, v47
    ds_read_b64 v[96:97], v47
    v_perm_b32 v98, v112, v114, s44
    v_bitop3_b32 v99, v112, 0.5, -0.5 bitop3:0xa8
    v_bitop3_b32 v98, v6, v98, v99 bitop3:0xca
    v_and_b32 v47, v5, v112
    s_waitcnt lgkmcnt(0)
    v_mfma_f32_4x4x4_16b_bf16 v[88:91], v[8:9], v[96:97], 0
    s_nop 4
    v_mul_f32 v88, v98, v88
    v_mul_f32 v89, v98, v89
    v_mul_f32 v90, v98, v90
    v_mul_f32 v91, v98, v91
    v_cvt_pk_bf16_f32 v88, v88, v89
    v_cvt_pk_bf16_f32 v89, v90, v91
    ds_pk_add_bf16 v47, v88 offset:65408
    ds_pk_add_bf16 v47, v89 offset:65412
    s_mov_b64 exec, -1
    v_and_b32 v46, 0x20000000, v32
    v_cmpx_eq_u32 vcc, 0, v46
    v_lshrrev_b32 v47, 14, v113
    v_and_b32 v47, v5, v47
    ds_read_b64 v[96:97], v47
    v_perm_b32 v98, v113, v114, s45
    v_bitop3_b32 v99, v113, 0.5, -0.5 bitop3:0xa8
    v_bitop3_b32 v98, v6, v98, v99 bitop3:0xca
    v_and_b32 v47, v5, v113
    s_waitcnt lgkmcnt(0)
    v_mfma_f32_4x4x4_16b_bf16 v[88:91], v[8:9], v[96:97], 0
    s_nop 4
    v_mul_f32 v88, v98, v88
    v_mul_f32 v89, v98, v89
    v_mul_f32 v90, v98, v90
    v_mul_f32 v91, v98, v91
    v_cvt_pk_bf16_f32 v88, v88, v89
    v_cvt_pk_bf16_f32 v89, v90, v91
    ds_pk_add_bf16 v47, v88 offset:65408
    ds_pk_add_bf16 v47, v89 offset:65412
    s_mov_b64 exec, -1
    s_branch L2_ob53
L2_xo54:
    v_cmp_lt_u32 vcc, 20, v99
    s_mov_b32 s101, 1
    s_cbranch_vccz L2_xp54
    v_cmp_lt_u32 vcc, 32, v99
    v_cmp_lt_u32 s[58:59], 31, v88
    s_mov_b32 s101, 2
    s_or_b64 vcc, vcc, s[58:59]
    s_cbranch_scc0 L2_xp54
    s_mov_b32 s37, 0x10000
    s_branch L2_xp54
L2_c55:
    s_lshl_b64 s[52:53], s[82:83], 1
    s_andn2_b64 s[52:53], s[52:53], s[80:81]
    s_andn2_b64 s[52:53], s[52:53], s[54:55]
    s_or_b64 s[80:81], s[80:81], s[52:53]
    s_not_b64 vcc, s[52:53]
    s_mov_b64 exec, -1
    v_cndmask_b32_dpp v84, v84, v84, vcc wave_shr:1 row_mask:0xf bank_mask:0xf
    v_cndmask_b32_dpp v85, v85, v85, vcc wave_shr:1 row_mask:0xf bank_mask:0xf
    s_lshr_b64 s[52:53], s[52:53], 1
    v_cndmask_b32_dpp v86, v86, v86, vcc wave_shr:1 row_mask:0xf bank_mask:0xf
    v_cndmask_b32_dpp v87, v87, v87, vcc wave_shr:1 row_mask:0xf bank_mask:0xf
    s_andn2_b64 s[82:83], s[82:83], s[52:53]
    v_cndmask_b32_dpp v7, v7, v7, vcc wave_shr:1 row_mask:0xf bank_mask:0xf
    s_mov_b64 exec, s[54:55]
    s_cbranch_scc0 L2_d55
    s_mov_b64 exec, s[82:83]
    s_nop 1
    v_mfma_f32_4x4x4_16b_bf16 v[88:91], v[12:13], v[84:85], 0
    s_nop 1
    v_mfma_f32_4x4x4_16b_bf16 v[88:91], v[10:11], v[86:87], v[88:91]
    s_nop 4
    v_cvt_pk_bf16_f32 v88, v88, v89
    v_cvt_pk_bf16_f32 v89, v90, v91
    ds_pk_add_bf16 v7, v88 offset:65408
    ds_pk_add_bf16 v7, v89 offset:65412
    s_mov_b64 exec, s[54:55]
    s_branch L2_d55
L2_c56:
    s_lshl_b64 s[52:53], s[82:83], 1
    s_andn2_b64 s[52:53], s[52:53], s[80:81]
    s_andn2_b64 s[52:53], s[52:53], s[50:51]
    s_or_b64 s[80:81], s[80:81], s[52:53]
    s_not_b64 vcc, s[52:53]
    s_mov_b64 exec, -1
    v_cndmask_b32_dpp v84, v84, v84, vcc wave_shr:1 row_mask:0xf bank_mask:0xf
    v_cndmask_b32_dpp v85, v85, v85, vcc wave_shr:1 row_mask:0xf bank_mask:0xf
    s_lshr_b64 s[52:53], s[52:53], 1
    v_cndmask_b32_dpp v86, v86, v86, vcc wave_shr:1 row_mask:0xf bank_mask:0xf
    v_cndmask_b32_dpp v87, v87, v87, vcc wave_shr:1 row_mask:0xf bank_mask:0xf
    s_andn2_b64 s[82:83], s[82:83], s[52:53]
    v_cndmask_b32_dpp v7, v7, v7, vcc wave_shr:1 row_mask:0xf bank_mask:0xf
    s_mov_b64 exec, s[50:51]
    s_cbranch_scc0 L2_d56
    s_mov_b64 exec, s[82:83]
    s_nop 1
    v_mfma_f32_4x4x4_16b_bf16 v[88:91], v[12:13], v[84:85], 0
    s_nop 1
    v_mfma_f32_4x4x4_16b_bf16 v[88:91], v[10:11], v[86:87], v[88:91]
    s_nop 4
    v_cvt_pk_bf16_f32 v88, v88, v89
    v_cvt_pk_bf16_f32 v89, v90, v91
    ds_pk_add_bf16 v7, v88 offset:65408
    ds_pk_add_bf16 v7, v89 offset:65412
    s_mov_b64 exec, s[50:51]
    s_branch L2_d56
L2_c57:
    s_lshl_b64 s[52:53], s[82:83], 1
    s_andn2_b64 s[52:53], s[52:53], s[80:81]
    s_andn2_b64 s[52:53], s[52:53], s[54:55]
    s_or_b64 s[80:81], s[80:81], s[52:53]
    s_not_b64 vcc, s[52:53]
    s_mov_b64 exec, -1
    v_cndmask_b32_dpp v84, v84, v84, vcc wave_shr:1 row_mask:0xf bank_mask:0xf
    v_cndmask_b32_dpp v85, v85, v85, vcc wave_shr:1 row_mask:0xf bank_mask:0xf
    s_lshr_b64 s[52:53], s[52:53], 1
    v_cndmask_b32_dpp v86, v86, v86, vcc wave_shr:1 row_mask:0xf bank_mask:0xf
    v_cndmask_b32_dpp v87, v87, v87, vcc wave_shr:1 row_mask:0xf bank_mask:0xf
    s_andn2_b64 s[82:83], s[82:83], s[52:53]
    v_cndmask_b32_dpp v7, v7, v7, vcc wave_shr:1 row_mask:0xf bank_mask:0xf
    s_mov_b64 exec, s[54:55]
    s_cbranch_scc0 L2_d57
    s_mov_b64 exec, s[82:83]
    s_nop 1
    v_mfma_f32_4x4x4_16b_bf16 v[88:91], v[12:13], v[84:85], 0
    s_nop 1
    v_mfma_f32_4x4x4_16b_bf16 v[88:91], v[10:11], v[86:87], v[88:91]
    s_nop 4
    v_cvt_pk_bf16_f32 v88, v88, v89
    v_cvt_pk_bf16_f32 v89, v90, v91
    ds_pk_add_bf16 v7, v88 offset:65408
    ds_pk_add_bf16 v7, v89 offset:65412
    s_mov_b64 exec, s[54:55]
    s_branch L2_d57
L2_c58:
    s_lshl_b64 s[52:53], s[82:83], 1
    s_andn2_b64 s[52:53], s[52:53], s[80:81]
    s_andn2_b64 s[52:53], s[52:53], s[50:51]
    s_or_b64 s[80:81], s[80:81], s[52:53]
    s_not_b64 vcc, s[52:53]
    s_mov_b64 exec, -1
    v_cndmask_b32_dpp v84, v84, v84, vcc wave_shr:1 row_mask:0xf bank_mask:0xf
    v_cndmask_b32_dpp v85, v85, v85, vcc wave_shr:1 row_mask:0xf bank_mask:0xf
    s_lshr_b64 s[52:53], s[52:53], 1
    v_cndmask_b32_dpp v86, v86, v86, vcc wave_shr:1 row_mask:0xf bank_mask:0xf
    v_cndmask_b32_dpp v87, v87, v87, vcc wave_shr:1 row_mask:0xf bank_mask:0xf
    s_andn2_b64 s[82:83], s[82:83], s[52:53]
    v_cndmask_b32_dpp v7, v7, v7, vcc wave_shr:1 row_mask:0xf bank_mask:0xf
    s_mov_b64 exec, s[50:51]
    s_cbranch_scc0 L2_d58
    s_mov_b64 exec, s[82:83]
    s_nop 1
    v_mfma_f32_4x4x4_16b_bf16 v[88:91], v[12:13], v[84:85], 0
    s_nop 1
    v_mfma_f32_4x4x4_16b_bf16 v[88:91], v[10:11], v[86:87], v[88:91]
    s_nop 4
    v_cvt_pk_bf16_f32 v88, v88, v89
    v_cvt_pk_bf16_f32 v89, v90, v91
    ds_pk_add_bf16 v7, v88 offset:65408
    ds_pk_add_bf16 v7, v89 offset:65412
    s_mov_b64 exec, s[50:51]
    s_branch L2_d58
L2_c59:
    s_lshl_b64 s[52:53], s[82:83], 1
    s_andn2_b64 s[52:53], s[52:53], s[80:81]
    s_andn2_b64 s[52:53], s[52:53], s[54:55]
    s_or_b64 s[80:81], s[80:81], s[52:53]
    s_not_b64 vcc, s[52:53]
    s_mov_b64 exec, -1
    v_cndmask_b32_dpp v84, v84, v84, vcc wave_shr:1 row_mask:0xf bank_mask:0xf
    v_cndmask_b32_dpp v85, v85, v85, vcc wave_shr:1 row_mask:0xf bank_mask:0xf
    s_lshr_b64 s[52:53], s[52:53], 1
    v_cndmask_b32_dpp v86, v86, v86, vcc wave_shr:1 row_mask:0xf bank_mask:0xf
    v_cndmask_b32_dpp v87, v87, v87, vcc wave_shr:1 row_mask:0xf bank_mask:0xf
    s_andn2_b64 s[82:83], s[82:83], s[52:53]
    v_cndmask_b32_dpp v7, v7, v7, vcc wave_shr:1 row_mask:0xf bank_mask:0xf
    s_mov_b64 exec, s[54:55]
    s_cbranch_scc0 L2_d59
    s_mov_b64 exec, s[82:83]
    s_nop 1
    v_mfma_f32_4x4x4_16b_bf16 v[88:91], v[12:13], v[84:85], 0
    s_nop 1
    v_mfma_f32_4x4x4_16b_bf16 v[88:91], v[10:11], v[86:87], v[88:91]
    s_nop 4
    v_cvt_pk_bf16_f32 v88, v88, v89
    v_cvt_pk_bf16_f32 v89, v90, v91
    ds_pk_add_bf16 v7, v88 offset:65408
    ds_pk_add_bf16 v7, v89 offset:65412
    s_mov_b64 exec, s[54:55]
    s_branch L2_d59
L2_c60:
    s_lshl_b64 s[52:53], s[82:83], 1
    s_andn2_b64 s[52:53], s[52:53], s[80:81]
    s_andn2_b64 s[52:53], s[52:53], s[50:51]
    s_or_b64 s[80:81], s[80:81], s[52:53]
    s_not_b64 vcc, s[52:53]
    s_mov_b64 exec, -1
    v_cndmask_b32_dpp v84, v84, v84, vcc wave_shr:1 row_mask:0xf bank_mask:0xf
    v_cndmask_b32_dpp v85, v85, v85, vcc wave_shr:1 row_mask:0xf bank_mask:0xf
    s_lshr_b64 s[52:53], s[52:53], 1
    v_cndmask_b32_dpp v86, v86, v86, vcc wave_shr:1 row_mask:0xf bank_mask:0xf
    v_cndmask_b32_dpp v87, v87, v87, vcc wave_shr:1 row_mask:0xf bank_mask:0xf
    s_andn2_b64 s[82:83], s[82:83], s[52:53]
    v_cndmask_b32_dpp v7, v7, v7, vcc wave_shr:1 row_mask:0xf bank_mask:0xf
    s_mov_b64 exec, s[50:51]
    s_cbranch_scc0 L2_d60
    s_mov_b64 exec, s[82:83]
    s_nop 1
    v_mfma_f32_4x4x4_16b_bf16 v[88:91], v[12:13], v[84:85], 0
    s_nop 1
    v_mfma_f32_4x4x4_16b_bf16 v[88:91], v[10:11], v[86:87], v[88:91]
    s_nop 4
    v_cvt_pk_bf16_f32 v88, v88, v89
    v_cvt_pk_bf16_f32 v89, v90, v91
    ds_pk_add_bf16 v7, v88 offset:65408
    ds_pk_add_bf16 v7, v89 offset:65412
    s_mov_b64 exec, s[50:51]
    s_branch L2_d60
L2_xa61:
    s_cmp_eq_u32 s101, 1
    s_cbranch_scc1 L2_xc61
    v_lshlrev_b32 v89, 0, v96
    v_add_u32 v90, 140, v97
    v_bitop3_b32 v90, v89, v45, v90 bitop3:0x6a
    ds_write_b32 v98, v90 offset:28
    v_lshlrev_b32 v89, 4, v96
    v_add_u32 v90, 120, v97
    v_bitop3_b32 v90, v89, v45, v90 bitop3:0x6a
    ds_write_b32 v98, v90 offset:24
    v_lshlrev_b32 v89, 8, v96
    v_add_u32 v90, 100, v97
    v_bitop3_b32 v90, v89, v45, v90 bitop3:0x6a
    ds_write_b32 v98, v90 offset:20
L2_xc61:
    v_lshlrev_b32 v89, 12, v96
    v_add_u32 v90, 80, v97
    v_bitop3_b32 v90, v89, v45, v90 bitop3:0x6a
    ds_write_b32 v98, v90 offset:16
    s_branch L2_xb61
L2_xe61:
    v_cmp_lt_u32 vcc, 32, v99
    v_cmp_lt_u32 s[58:59], 31, v88
    v_lshrrev_b32 v89, 16, v96
    v_add_u32 v97, 80, v97
    s_or_b64 vcc, vcc, s[58:59]
    s_cbranch_scc1 L2_xs61
    v_lshlrev_b32 v89, v1, v89
    v_and_b32 v89, v45, v89
    v_cmp_ne_u32 vcc, 0, v89
    v_xor_b32 v90, v97, v89
    s_add_u32 s3, s37, s38
    v_mbcnt_lo_u32_b32 v98, vcc_lo, 0
    v_mbcnt_hi_u32_b32 v98, vcc_hi, v98
    s_bcnt1_i32_b64 s41, vcc
    v_lshl_add_u32 v98, v98, 2, s3
    s_lshl2_add_u32 s37, s41, s37
    s_mov_b64 exec, vcc
    ds_write_b32 v98, v90
    s_mov_b64 exec, -1
    s_branch L2_xr61
L2_xf61:
    s_waitcnt lgkmcnt(0)
    s_cmp_gt_u32 s37, 1024
    s_cbranch_scc1 L2_xs61
    s_cmp_lt_u32 s37, 768
    s_cbranch_scc1 L2_xl61
    ds_read_b32 v32, v98 offset:896
    s_add_u32 s3, s42, 2
    s_bitset1_b32 s43, s3
    s_branch L2_xg61
L2_xl61:
    v_mov_b32 v42, -1
    s_cmp_ge_u32 s37, 512
    s_cbranch_scc1 L2_xg61
    v_mov_b32 v43, -1
    s_cmp_ge_u32 s37, 256
    s_cbranch_scc1 L2_xg61
    v_mov_b32 v41, -1
    s_branch L2_xg61
L2_xs61:
    s_waitcnt lgkmcnt(0)
    v_mov_b32 v40, -1
    v_mov_b32 v41, -1
    v_mov_b32 v43, -1
    v_mov_b32 v42, -1
    s_add_u32 s3, s42, 2
    s_bitset1_b32 s36, s3
    s_branch L2_xg61
L2_c62:
    s_lshl_b64 s[52:53], s[82:83], 1
    s_andn2_b64 s[52:53], s[52:53], s[80:81]
    s_andn2_b64 s[52:53], s[52:53], s[54:55]
    s_or_b64 s[80:81], s[80:81], s[52:53]
    s_not_b64 vcc, s[52:53]
    s_mov_b64 exec, -1
    v_cndmask_b32_dpp v84, v84, v84, vcc wave_shr:1 row_mask:0xf bank_mask:0xf
    v_cndmask_b32_dpp v85, v85, v85, vcc wave_shr:1 row_mask:0xf bank_mask:0xf
    s_lshr_b64 s[52:53], s[52:53], 1
    v_cndmask_b32_dpp v86, v86, v86, vcc wave_shr:1 row_mask:0xf bank_mask:0xf
    v_cndmask_b32_dpp v87, v87, v87, vcc wave_shr:1 row_mask:0xf bank_mask:0xf
    s_andn2_b64 s[82:83], s[82:83], s[52:53]
    v_cndmask_b32_dpp v7, v7, v7, vcc wave_shr:1 row_mask:0xf bank_mask:0xf
    s_mov_b64 exec, s[54:55]
    s_cbranch_scc0 L2_d62
    s_mov_b64 exec, s[82:83]
    s_nop 1
    v_mfma_f32_4x4x4_16b_bf16 v[88:91], v[12:13], v[84:85], 0
    s_nop 1
    v_mfma_f32_4x4x4_16b_bf16 v[88:91], v[10:11], v[86:87], v[88:91]
    s_nop 4
    v_cvt_pk_bf16_f32 v88, v88, v89
    v_cvt_pk_bf16_f32 v89, v90, v91
    ds_pk_add_bf16 v7, v88 offset:65408
    ds_pk_add_bf16 v7, v89 offset:65412
    s_mov_b64 exec, s[54:55]
    s_branch L2_d62
L2_c63:
    s_lshl_b64 s[52:53], s[82:83], 1
    s_andn2_b64 s[52:53], s[52:53], s[80:81]
    s_andn2_b64 s[52:53], s[52:53], s[50:51]
    s_or_b64 s[80:81], s[80:81], s[52:53]
    s_not_b64 vcc, s[52:53]
    s_mov_b64 exec, -1
    v_cndmask_b32_dpp v84, v84, v84, vcc wave_shr:1 row_mask:0xf bank_mask:0xf
    v_cndmask_b32_dpp v85, v85, v85, vcc wave_shr:1 row_mask:0xf bank_mask:0xf
    s_lshr_b64 s[52:53], s[52:53], 1
    v_cndmask_b32_dpp v86, v86, v86, vcc wave_shr:1 row_mask:0xf bank_mask:0xf
    v_cndmask_b32_dpp v87, v87, v87, vcc wave_shr:1 row_mask:0xf bank_mask:0xf
    s_andn2_b64 s[82:83], s[82:83], s[52:53]
    v_cndmask_b32_dpp v7, v7, v7, vcc wave_shr:1 row_mask:0xf bank_mask:0xf
    s_mov_b64 exec, s[50:51]
    s_cbranch_scc0 L2_d63
    s_mov_b64 exec, s[82:83]
    s_nop 1
    v_mfma_f32_4x4x4_16b_bf16 v[88:91], v[12:13], v[84:85], 0
    s_nop 1
    v_mfma_f32_4x4x4_16b_bf16 v[88:91], v[10:11], v[86:87], v[88:91]
    s_nop 4
    v_cvt_pk_bf16_f32 v88, v88, v89
    v_cvt_pk_bf16_f32 v89, v90, v91
    ds_pk_add_bf16 v7, v88 offset:65408
    ds_pk_add_bf16 v7, v89 offset:65412
    s_mov_b64 exec, s[50:51]
    s_branch L2_d63
L2_oa64:
    v_and_b32 v47, 0x0fffffff, v33
    buffer_load_dword v114, v47, s[8:11], 0 offen offset:16
    s_mov_b64 exec, s[6:7]
    v_add_u32 v47, 8, v47
    v_lshrrev_b32 v33, 2, v33
    s_mov_b64 exec, -1
    buffer_load_dwordx2 v[112:113], v47, s[8:11], 0 offen
    s_branch L2_ob64
L2_c65:
    s_lshl_b64 s[52:53], s[82:83], 1
    s_andn2_b64 s[52:53], s[52:53], s[80:81]
    s_andn2_b64 s[52:53], s[52:53], s[54:55]
    s_or_b64 s[80:81], s[80:81], s[52:53]
    s_not_b64 vcc, s[52:53]
    s_mov_b64 exec, -1
    v_cndmask_b32_dpp v84, v84, v84, vcc wave_shr:1 row_mask:0xf bank_mask:0xf
    v_cndmask_b32_dpp v85, v85, v85, vcc wave_shr:1 row_mask:0xf bank_mask:0xf
    s_lshr_b64 s[52:53], s[52:53], 1
    v_cndmask_b32_dpp v86, v86, v86, vcc wave_shr:1 row_mask:0xf bank_mask:0xf
    v_cndmask_b32_dpp v87, v87, v87, vcc wave_shr:1 row_mask:0xf bank_mask:0xf
    s_andn2_b64 s[82:83], s[82:83], s[52:53]
    v_cndmask_b32_dpp v7, v7, v7, vcc wave_shr:1 row_mask:0xf bank_mask:0xf
    s_mov_b64 exec, s[54:55]
    s_cbranch_scc0 L2_d65
    s_mov_b64 exec, s[82:83]
    s_nop 1
    v_mfma_f32_4x4x4_16b_bf16 v[88:91], v[12:13], v[84:85], 0
    s_nop 1
    v_mfma_f32_4x4x4_16b_bf16 v[88:91], v[10:11], v[86:87], v[88:91]
    s_nop 4
    v_cvt_pk_bf16_f32 v88, v88, v89
    v_cvt_pk_bf16_f32 v89, v90, v91
    ds_pk_add_bf16 v7, v88 offset:65408
    ds_pk_add_bf16 v7, v89 offset:65412
    s_mov_b64 exec, s[54:55]
    s_branch L2_d65
L2_c66:
    s_lshl_b64 s[52:53], s[82:83], 1
    s_andn2_b64 s[52:53], s[52:53], s[80:81]
    s_andn2_b64 s[52:53], s[52:53], s[50:51]
    s_or_b64 s[80:81], s[80:81], s[52:53]
    s_not_b64 vcc, s[52:53]
    s_mov_b64 exec, -1
    v_cndmask_b32_dpp v84, v84, v84, vcc wave_shr:1 row_mask:0xf bank_mask:0xf
    v_cndmask_b32_dpp v85, v85, v85, vcc wave_shr:1 row_mask:0xf bank_mask:0xf
    s_lshr_b64 s[52:53], s[52:53], 1
    v_cndmask_b32_dpp v86, v86, v86, vcc wave_shr:1 row_mask:0xf bank_mask:0xf
    v_cndmask_b32_dpp v87, v87, v87, vcc wave_shr:1 row_mask:0xf bank_mask:0xf
    s_andn2_b64 s[82:83], s[82:83], s[52:53]
    v_cndmask_b32_dpp v7, v7, v7, vcc wave_shr:1 row_mask:0xf bank_mask:0xf
    s_mov_b64 exec, s[50:51]
    s_cbranch_scc0 L2_d66
    s_mov_b64 exec, s[82:83]
    s_nop 1
    v_mfma_f32_4x4x4_16b_bf16 v[88:91], v[12:13], v[84:85], 0
    s_nop 1
    v_mfma_f32_4x4x4_16b_bf16 v[88:91], v[10:11], v[86:87], v[88:91]
    s_nop 4
    v_cvt_pk_bf16_f32 v88, v88, v89
    v_cvt_pk_bf16_f32 v89, v90, v91
    ds_pk_add_bf16 v7, v88 offset:65408
    ds_pk_add_bf16 v7, v89 offset:65412
    s_mov_b64 exec, s[50:51]
    s_branch L2_d66
L2_c67:
    s_lshl_b64 s[52:53], s[82:83], 1
    s_andn2_b64 s[52:53], s[52:53], s[80:81]
    s_andn2_b64 s[52:53], s[52:53], s[54:55]
    s_or_b64 s[80:81], s[80:81], s[52:53]
    s_not_b64 vcc, s[52:53]
    s_mov_b64 exec, -1
    v_cndmask_b32_dpp v84, v84, v84, vcc wave_shr:1 row_mask:0xf bank_mask:0xf
    v_cndmask_b32_dpp v85, v85, v85, vcc wave_shr:1 row_mask:0xf bank_mask:0xf
    s_lshr_b64 s[52:53], s[52:53], 1
    v_cndmask_b32_dpp v86, v86, v86, vcc wave_shr:1 row_mask:0xf bank_mask:0xf
    v_cndmask_b32_dpp v87, v87, v87, vcc wave_shr:1 row_mask:0xf bank_mask:0xf
    s_andn2_b64 s[82:83], s[82:83], s[52:53]
    v_cndmask_b32_dpp v7, v7, v7, vcc wave_shr:1 row_mask:0xf bank_mask:0xf
    s_mov_b64 exec, s[54:55]
    s_cbranch_scc0 L2_d67
    s_mov_b64 exec, s[82:83]
    s_nop 1
    v_mfma_f32_4x4x4_16b_bf16 v[88:91], v[12:13], v[84:85], 0
    s_nop 1
    v_mfma_f32_4x4x4_16b_bf16 v[88:91], v[10:11], v[86:87], v[88:91]
    s_nop 4
    v_cvt_pk_bf16_f32 v88, v88, v89
    v_cvt_pk_bf16_f32 v89, v90, v91
    ds_pk_add_bf16 v7, v88 offset:65408
    ds_pk_add_bf16 v7, v89 offset:65412
    s_mov_b64 exec, s[54:55]
    s_branch L2_d67
L2_c68:
    s_lshl_b64 s[52:53], s[82:83], 1
    s_andn2_b64 s[52:53], s[52:53], s[80:81]
    s_andn2_b64 s[52:53], s[52:53], s[50:51]
    s_or_b64 s[80:81], s[80:81], s[52:53]
    s_not_b64 vcc, s[52:53]
    s_mov_b64 exec, -1
    v_cndmask_b32_dpp v84, v84, v84, vcc wave_shr:1 row_mask:0xf bank_mask:0xf
    v_cndmask_b32_dpp v85, v85, v85, vcc wave_shr:1 row_mask:0xf bank_mask:0xf
    s_lshr_b64 s[52:53], s[52:53], 1
    v_cndmask_b32_dpp v86, v86, v86, vcc wave_shr:1 row_mask:0xf bank_mask:0xf
    v_cndmask_b32_dpp v87, v87, v87, vcc wave_shr:1 row_mask:0xf bank_mask:0xf
    s_andn2_b64 s[82:83], s[82:83], s[52:53]
    v_cndmask_b32_dpp v7, v7, v7, vcc wave_shr:1 row_mask:0xf bank_mask:0xf
    s_mov_b64 exec, s[50:51]
    s_cbranch_scc0 L2_d68
    s_mov_b64 exec, s[82:83]
    s_nop 1
    v_mfma_f32_4x4x4_16b_bf16 v[88:91], v[12:13], v[84:85], 0
    s_nop 1
    v_mfma_f32_4x4x4_16b_bf16 v[88:91], v[10:11], v[86:87], v[88:91]
    s_nop 4
    v_cvt_pk_bf16_f32 v88, v88, v89
    v_cvt_pk_bf16_f32 v89, v90, v91
    ds_pk_add_bf16 v7, v88 offset:65408
    ds_pk_add_bf16 v7, v89 offset:65412
    s_mov_b64 exec, s[50:51]
    s_branch L2_d68
L2_c69:
    s_lshl_b64 s[52:53], s[82:83], 1
    s_andn2_b64 s[52:53], s[52:53], s[80:81]
    s_andn2_b64 s[52:53], s[52:53], s[54:55]
    s_or_b64 s[80:81], s[80:81], s[52:53]
    s_not_b64 vcc, s[52:53]
    s_mov_b64 exec, -1
    v_cndmask_b32_dpp v84, v84, v84, vcc wave_shr:1 row_mask:0xf bank_mask:0xf
    v_cndmask_b32_dpp v85, v85, v85, vcc wave_shr:1 row_mask:0xf bank_mask:0xf
    s_lshr_b64 s[52:53], s[52:53], 1
    v_cndmask_b32_dpp v86, v86, v86, vcc wave_shr:1 row_mask:0xf bank_mask:0xf
    v_cndmask_b32_dpp v87, v87, v87, vcc wave_shr:1 row_mask:0xf bank_mask:0xf
    s_andn2_b64 s[82:83], s[82:83], s[52:53]
    v_cndmask_b32_dpp v7, v7, v7, vcc wave_shr:1 row_mask:0xf bank_mask:0xf
    s_mov_b64 exec, s[54:55]
    s_cbranch_scc0 L2_d69
    s_mov_b64 exec, s[82:83]
    s_nop 1
    v_mfma_f32_4x4x4_16b_bf16 v[88:91], v[12:13], v[84:85], 0
    s_nop 1
    v_mfma_f32_4x4x4_16b_bf16 v[88:91], v[10:11], v[86:87], v[88:91]
    s_nop 4
    v_cvt_pk_bf16_f32 v88, v88, v89
    v_cvt_pk_bf16_f32 v89, v90, v91
    ds_pk_add_bf16 v7, v88 offset:65408
    ds_pk_add_bf16 v7, v89 offset:65412
    s_mov_b64 exec, s[54:55]
    s_branch L2_d69
L2_c70:
    s_lshl_b64 s[52:53], s[82:83], 1
    s_andn2_b64 s[52:53], s[52:53], s[80:81]
    s_andn2_b64 s[52:53], s[52:53], s[50:51]
    s_or_b64 s[80:81], s[80:81], s[52:53]
    s_not_b64 vcc, s[52:53]
    s_mov_b64 exec, -1
    v_cndmask_b32_dpp v84, v84, v84, vcc wave_shr:1 row_mask:0xf bank_mask:0xf
    v_cndmask_b32_dpp v85, v85, v85, vcc wave_shr:1 row_mask:0xf bank_mask:0xf
    s_lshr_b64 s[52:53], s[52:53], 1
    v_cndmask_b32_dpp v86, v86, v86, vcc wave_shr:1 row_mask:0xf bank_mask:0xf
    v_cndmask_b32_dpp v87, v87, v87, vcc wave_shr:1 row_mask:0xf bank_mask:0xf
    s_andn2_b64 s[82:83], s[82:83], s[52:53]
    v_cndmask_b32_dpp v7, v7, v7, vcc wave_shr:1 row_mask:0xf bank_mask:0xf
    s_mov_b64 exec, s[50:51]
    s_cbranch_scc0 L2_d70
    s_mov_b64 exec, s[82:83]
    s_nop 1
    v_mfma_f32_4x4x4_16b_bf16 v[88:91], v[12:13], v[84:85], 0
    s_nop 1
    v_mfma_f32_4x4x4_16b_bf16 v[88:91], v[10:11], v[86:87], v[88:91]
    s_nop 4
    v_cvt_pk_bf16_f32 v88, v88, v89
    v_cvt_pk_bf16_f32 v89, v90, v91
    ds_pk_add_bf16 v7, v88 offset:65408
    ds_pk_add_bf16 v7, v89 offset:65412
    s_mov_b64 exec, s[50:51]
    s_branch L2_d70
L2_oa71:
    s_waitcnt vmcnt(3)
    s_mov_b64 exec, s[6:7]
    v_lshrrev_b32 v114, 16, v114
    s_mov_b64 exec, -1
    v_and_b32 v46, 0x10000000, v33
    v_cmpx_eq_u32 vcc, 0, v46
    v_lshrrev_b32 v47, 14, v112
    v_and_b32 v47, v5, v47
    ds_read_b64 v[96:97], v47
    v_perm_b32 v98, v112, v114, s44
    v_bitop3_b32 v99, v112, 0.5, -0.5 bitop3:0xa8
    v_bitop3_b32 v98, v6, v98, v99 bitop3:0xca
    v_and_b32 v47, v5, v112
    s_waitcnt lgkmcnt(0)
    v_mfma_f32_4x4x4_16b_bf16 v[88:91], v[8:9], v[96:97], 0
    s_nop 4
    v_mul_f32 v88, v98, v88
    v_mul_f32 v89, v98, v89
    v_mul_f32 v90, v98, v90
    v_mul_f32 v91, v98, v91
    v_cvt_pk_bf16_f32 v88, v88, v89
    v_cvt_pk_bf16_f32 v89, v90, v91
    ds_pk_add_bf16 v47, v88 offset:65408
    ds_pk_add_bf16 v47, v89 offset:65412
    s_mov_b64 exec, -1
    v_and_b32 v46, 0x20000000, v33
    v_cmpx_eq_u32 vcc, 0, v46
    v_lshrrev_b32 v47, 14, v113
    v_and_b32 v47, v5, v47
    ds_read_b64 v[96:97], v47
    v_perm_b32 v98, v113, v114, s45
    v_bitop3_b32 v99, v113, 0.5, -0.5 bitop3:0xa8
    v_bitop3_b32 v98, v6, v98, v99 bitop3:0xca
    v_and_b32 v47, v5, v113
    s_waitcnt lgkmcnt(0)
    v_mfma_f32_4x4x4_16b_bf16 v[88:91], v[8:9], v[96:97], 0
    s_nop 4
    v_mul_f32 v88, v98, v88
    v_mul_f32 v89, v98, v89
    v_mul_f32 v90, v98, v90
    v_mul_f32 v91, v98, v91
    v_cvt_pk_bf16_f32 v88, v88, v89
    v_cvt_pk_bf16_f32 v89, v90, v91
    ds_pk_add_bf16 v47, v88 offset:65408
    ds_pk_add_bf16 v47, v89 offset:65412
    s_mov_b64 exec, -1
    s_branch L2_ob71
L2_xo72:
    v_cmp_lt_u32 vcc, 20, v99
    s_mov_b32 s101, 1
    s_cbranch_vccz L2_xp72
    v_cmp_lt_u32 vcc, 32, v99
    v_cmp_lt_u32 s[58:59], 31, v88
    s_mov_b32 s101, 2
    s_or_b64 vcc, vcc, s[58:59]
    s_cbranch_scc0 L2_xp72
    s_mov_b32 s37, 0x10000
    s_branch L2_xp72
L2_c73:
    s_lshl_b64 s[52:53], s[82:83], 1
    s_andn2_b64 s[52:53], s[52:53], s[80:81]
    s_andn2_b64 s[52:53], s[52:53], s[54:55]
    s_or_b64 s[80:81], s[80:81], s[52:53]
    s_not_b64 vcc, s[52:53]
    s_mov_b64 exec, -1
    v_cndmask_b32_dpp v84, v84, v84, vcc wave_shr:1 row_mask:0xf bank_mask:0xf
    v_cndmask_b32_dpp v85, v85, v85, vcc wave_shr:1 row_mask:0xf bank_mask:0xf
    s_lshr_b64 s[52:53], s[52:53], 1
    v_cndmask_b32_dpp v86, v86, v86, vcc wave_shr:1 row_mask:0xf bank_mask:0xf
    v_cndmask_b32_dpp v87, v87, v87, vcc wave_shr:1 row_mask:0xf bank_mask:0xf
    s_andn2_b64 s[82:83], s[82:83], s[52:53]
    v_cndmask_b32_dpp v7, v7, v7, vcc wave_shr:1 row_mask:0xf bank_mask:0xf
    s_mov_b64 exec, s[54:55]
    s_cbranch_scc0 L2_d73
    s_mov_b64 exec, s[82:83]
    s_nop 1
    v_mfma_f32_4x4x4_16b_bf16 v[88:91], v[12:13], v[84:85], 0
    s_nop 1
    v_mfma_f32_4x4x4_16b_bf16 v[88:91], v[10:11], v[86:87], v[88:91]
    s_nop 4
    v_cvt_pk_bf16_f32 v88, v88, v89
    v_cvt_pk_bf16_f32 v89, v90, v91
    ds_pk_add_bf16 v7, v88 offset:65408
    ds_pk_add_bf16 v7, v89 offset:65412
    s_mov_b64 exec, s[54:55]
    s_branch L2_d73
L2_c74:
    s_lshl_b64 s[52:53], s[82:83], 1
    s_andn2_b64 s[52:53], s[52:53], s[80:81]
    s_andn2_b64 s[52:53], s[52:53], s[50:51]
    s_or_b64 s[80:81], s[80:81], s[52:53]
    s_not_b64 vcc, s[52:53]
    s_mov_b64 exec, -1
    v_cndmask_b32_dpp v84, v84, v84, vcc wave_shr:1 row_mask:0xf bank_mask:0xf
    v_cndmask_b32_dpp v85, v85, v85, vcc wave_shr:1 row_mask:0xf bank_mask:0xf
    s_lshr_b64 s[52:53], s[52:53], 1
    v_cndmask_b32_dpp v86, v86, v86, vcc wave_shr:1 row_mask:0xf bank_mask:0xf
    v_cndmask_b32_dpp v87, v87, v87, vcc wave_shr:1 row_mask:0xf bank_mask:0xf
    s_andn2_b64 s[82:83], s[82:83], s[52:53]
    v_cndmask_b32_dpp v7, v7, v7, vcc wave_shr:1 row_mask:0xf bank_mask:0xf
    s_mov_b64 exec, s[50:51]
    s_cbranch_scc0 L2_d74
    s_mov_b64 exec, s[82:83]
    s_nop 1
    v_mfma_f32_4x4x4_16b_bf16 v[88:91], v[12:13], v[84:85], 0
    s_nop 1
    v_mfma_f32_4x4x4_16b_bf16 v[88:91], v[10:11], v[86:87], v[88:91]
    s_nop 4
    v_cvt_pk_bf16_f32 v88, v88, v89
    v_cvt_pk_bf16_f32 v89, v90, v91
    ds_pk_add_bf16 v7, v88 offset:65408
    ds_pk_add_bf16 v7, v89 offset:65412
    s_mov_b64 exec, s[50:51]
    s_branch L2_d74
L2_c75:
    s_lshl_b64 s[52:53], s[82:83], 1
    s_andn2_b64 s[52:53], s[52:53], s[80:81]
    s_andn2_b64 s[52:53], s[52:53], s[54:55]
    s_or_b64 s[80:81], s[80:81], s[52:53]
    s_not_b64 vcc, s[52:53]
    s_mov_b64 exec, -1
    v_cndmask_b32_dpp v84, v84, v84, vcc wave_shr:1 row_mask:0xf bank_mask:0xf
    v_cndmask_b32_dpp v85, v85, v85, vcc wave_shr:1 row_mask:0xf bank_mask:0xf
    s_lshr_b64 s[52:53], s[52:53], 1
    v_cndmask_b32_dpp v86, v86, v86, vcc wave_shr:1 row_mask:0xf bank_mask:0xf
    v_cndmask_b32_dpp v87, v87, v87, vcc wave_shr:1 row_mask:0xf bank_mask:0xf
    s_andn2_b64 s[82:83], s[82:83], s[52:53]
    v_cndmask_b32_dpp v7, v7, v7, vcc wave_shr:1 row_mask:0xf bank_mask:0xf
    s_mov_b64 exec, s[54:55]
    s_cbranch_scc0 L2_d75
    s_mov_b64 exec, s[82:83]
    s_nop 1
    v_mfma_f32_4x4x4_16b_bf16 v[88:91], v[12:13], v[84:85], 0
    s_nop 1
    v_mfma_f32_4x4x4_16b_bf16 v[88:91], v[10:11], v[86:87], v[88:91]
    s_nop 4
    v_cvt_pk_bf16_f32 v88, v88, v89
    v_cvt_pk_bf16_f32 v89, v90, v91
    ds_pk_add_bf16 v7, v88 offset:65408
    ds_pk_add_bf16 v7, v89 offset:65412
    s_mov_b64 exec, s[54:55]
    s_branch L2_d75
L2_c76:
    s_lshl_b64 s[52:53], s[82:83], 1
    s_andn2_b64 s[52:53], s[52:53], s[80:81]
    s_andn2_b64 s[52:53], s[52:53], s[50:51]
    s_or_b64 s[80:81], s[80:81], s[52:53]
    s_not_b64 vcc, s[52:53]
    s_mov_b64 exec, -1
    v_cndmask_b32_dpp v84, v84, v84, vcc wave_shr:1 row_mask:0xf bank_mask:0xf
    v_cndmask_b32_dpp v85, v85, v85, vcc wave_shr:1 row_mask:0xf bank_mask:0xf
    s_lshr_b64 s[52:53], s[52:53], 1
    v_cndmask_b32_dpp v86, v86, v86, vcc wave_shr:1 row_mask:0xf bank_mask:0xf
    v_cndmask_b32_dpp v87, v87, v87, vcc wave_shr:1 row_mask:0xf bank_mask:0xf
    s_andn2_b64 s[82:83], s[82:83], s[52:53]
    v_cndmask_b32_dpp v7, v7, v7, vcc wave_shr:1 row_mask:0xf bank_mask:0xf
    s_mov_b64 exec, s[50:51]
    s_cbranch_scc0 L2_d76
    s_mov_b64 exec, s[82:83]
    s_nop 1
    v_mfma_f32_4x4x4_16b_bf16 v[88:91], v[12:13], v[84:85], 0
    s_nop 1
    v_mfma_f32_4x4x4_16b_bf16 v[88:91], v[10:11], v[86:87], v[88:91]
    s_nop 4
    v_cvt_pk_bf16_f32 v88, v88, v89
    v_cvt_pk_bf16_f32 v89, v90, v91
    ds_pk_add_bf16 v7, v88 offset:65408
    ds_pk_add_bf16 v7, v89 offset:65412
    s_mov_b64 exec, s[50:51]
    s_branch L2_d76
L2_c77:
    s_lshl_b64 s[52:53], s[82:83], 1
    s_andn2_b64 s[52:53], s[52:53], s[80:81]
    s_andn2_b64 s[52:53], s[52:53], s[54:55]
    s_or_b64 s[80:81], s[80:81], s[52:53]
    s_not_b64 vcc, s[52:53]
    s_mov_b64 exec, -1
    v_cndmask_b32_dpp v84, v84, v84, vcc wave_shr:1 row_mask:0xf bank_mask:0xf
    v_cndmask_b32_dpp v85, v85, v85, vcc wave_shr:1 row_mask:0xf bank_mask:0xf
    s_lshr_b64 s[52:53], s[52:53], 1
    v_cndmask_b32_dpp v86, v86, v86, vcc wave_shr:1 row_mask:0xf bank_mask:0xf
    v_cndmask_b32_dpp v87, v87, v87, vcc wave_shr:1 row_mask:0xf bank_mask:0xf
    s_andn2_b64 s[82:83], s[82:83], s[52:53]
    v_cndmask_b32_dpp v7, v7, v7, vcc wave_shr:1 row_mask:0xf bank_mask:0xf
    s_mov_b64 exec, s[54:55]
    s_cbranch_scc0 L2_d77
    s_mov_b64 exec, s[82:83]
    s_nop 1
    v_mfma_f32_4x4x4_16b_bf16 v[88:91], v[12:13], v[84:85], 0
    s_nop 1
    v_mfma_f32_4x4x4_16b_bf16 v[88:91], v[10:11], v[86:87], v[88:91]
    s_nop 4
    v_cvt_pk_bf16_f32 v88, v88, v89
    v_cvt_pk_bf16_f32 v89, v90, v91
    ds_pk_add_bf16 v7, v88 offset:65408
    ds_pk_add_bf16 v7, v89 offset:65412
    s_mov_b64 exec, s[54:55]
    s_branch L2_d77
L2_c78:
    s_lshl_b64 s[52:53], s[82:83], 1
    s_andn2_b64 s[52:53], s[52:53], s[80:81]
    s_andn2_b64 s[52:53], s[52:53], s[50:51]
    s_or_b64 s[80:81], s[80:81], s[52:53]
    s_not_b64 vcc, s[52:53]
    s_mov_b64 exec, -1
    v_cndmask_b32_dpp v84, v84, v84, vcc wave_shr:1 row_mask:0xf bank_mask:0xf
    v_cndmask_b32_dpp v85, v85, v85, vcc wave_shr:1 row_mask:0xf bank_mask:0xf
    s_lshr_b64 s[52:53], s[52:53], 1
    v_cndmask_b32_dpp v86, v86, v86, vcc wave_shr:1 row_mask:0xf bank_mask:0xf
    v_cndmask_b32_dpp v87, v87, v87, vcc wave_shr:1 row_mask:0xf bank_mask:0xf
    s_andn2_b64 s[82:83], s[82:83], s[52:53]
    v_cndmask_b32_dpp v7, v7, v7, vcc wave_shr:1 row_mask:0xf bank_mask:0xf
    s_mov_b64 exec, s[50:51]
    s_cbranch_scc0 L2_d78
    s_mov_b64 exec, s[82:83]
    s_nop 1
    v_mfma_f32_4x4x4_16b_bf16 v[88:91], v[12:13], v[84:85], 0
    s_nop 1
    v_mfma_f32_4x4x4_16b_bf16 v[88:91], v[10:11], v[86:87], v[88:91]
    s_nop 4
    v_cvt_pk_bf16_f32 v88, v88, v89
    v_cvt_pk_bf16_f32 v89, v90, v91
    ds_pk_add_bf16 v7, v88 offset:65408
    ds_pk_add_bf16 v7, v89 offset:65412
    s_mov_b64 exec, s[50:51]
    s_branch L2_d78
L2_xa79:
    s_cmp_eq_u32 s101, 1
    s_cbranch_scc1 L2_xc79
    v_lshlrev_b32 v89, 0, v96
    v_add_u32 v90, 140, v97
    v_bitop3_b32 v90, v89, v45, v90 bitop3:0x6a
    ds_write_b32 v98, v90 offset:28
    v_lshlrev_b32 v89, 4, v96
    v_add_u32 v90, 120, v97
    v_bitop3_b32 v90, v89, v45, v90 bitop3:0x6a
    ds_write_b32 v98, v90 offset:24
    v_lshlrev_b32 v89, 8, v96
    v_add_u32 v90, 100, v97
    v_bitop3_b32 v90, v89, v45, v90 bitop3:0x6a
    ds_write_b32 v98, v90 offset:20
L2_xc79:
    v_lshlrev_b32 v89, 12, v96
    v_add_u32 v90, 80, v97
    v_bitop3_b32 v90, v89, v45, v90 bitop3:0x6a
    ds_write_b32 v98, v90 offset:16
    s_branch L2_xb79
L2_xe79:
    v_cmp_lt_u32 vcc, 32, v99
    v_cmp_lt_u32 s[58:59], 31, v88
    v_lshrrev_b32 v89, 16, v96
    v_add_u32 v97, 80, v97
    s_or_b64 vcc, vcc, s[58:59]
    s_cbranch_scc1 L2_xs79
    v_lshlrev_b32 v89, v1, v89
    v_and_b32 v89, v45, v89
    v_cmp_ne_u32 vcc, 0, v89
    v_xor_b32 v90, v97, v89
    s_add_u32 s3, s37, s38
    v_mbcnt_lo_u32_b32 v98, vcc_lo, 0
    v_mbcnt_hi_u32_b32 v98, vcc_hi, v98
    s_bcnt1_i32_b64 s41, vcc
    v_lshl_add_u32 v98, v98, 2, s3
    s_lshl2_add_u32 s37, s41, s37
    s_mov_b64 exec, vcc
    ds_write_b32 v98, v90
    s_mov_b64 exec, -1
    s_branch L2_xr79
L2_xf79:
    s_waitcnt lgkmcnt(0)
    s_cmp_gt_u32 s37, 1024
    s_cbranch_scc1 L2_xs79
    s_cmp_lt_u32 s37, 768
    s_cbranch_scc1 L2_xl79
    ds_read_b32 v33, v98 offset:896
    s_add_u32 s3, s42, 2
    s_bitset1_b32 s43, s3
    s_branch L2_xg79
L2_xl79:
    v_mov_b32 v42, -1
    s_cmp_ge_u32 s37, 512
    s_cbranch_scc1 L2_xg79
    v_mov_b32 v43, -1
    s_cmp_ge_u32 s37, 256
    s_cbranch_scc1 L2_xg79
    v_mov_b32 v41, -1
    s_branch L2_xg79
L2_xs79:
    s_waitcnt lgkmcnt(0)
    v_mov_b32 v40, -1
    v_mov_b32 v41, -1
    v_mov_b32 v43, -1
    v_mov_b32 v42, -1
    s_add_u32 s3, s42, 2
    s_bitset1_b32 s36, s3
    s_branch L2_xg79
L2_c80:
    s_lshl_b64 s[52:53], s[82:83], 1
    s_andn2_b64 s[52:53], s[52:53], s[80:81]
    s_andn2_b64 s[52:53], s[52:53], s[54:55]
    s_or_b64 s[80:81], s[80:81], s[52:53]
    s_not_b64 vcc, s[52:53]
    s_mov_b64 exec, -1
    v_cndmask_b32_dpp v84, v84, v84, vcc wave_shr:1 row_mask:0xf bank_mask:0xf
    v_cndmask_b32_dpp v85, v85, v85, vcc wave_shr:1 row_mask:0xf bank_mask:0xf
    s_lshr_b64 s[52:53], s[52:53], 1
    v_cndmask_b32_dpp v86, v86, v86, vcc wave_shr:1 row_mask:0xf bank_mask:0xf
    v_cndmask_b32_dpp v87, v87, v87, vcc wave_shr:1 row_mask:0xf bank_mask:0xf
    s_andn2_b64 s[82:83], s[82:83], s[52:53]
    v_cndmask_b32_dpp v7, v7, v7, vcc wave_shr:1 row_mask:0xf bank_mask:0xf
    s_mov_b64 exec, s[54:55]
    s_cbranch_scc0 L2_d80
    s_mov_b64 exec, s[82:83]
    s_nop 1
    v_mfma_f32_4x4x4_16b_bf16 v[88:91], v[12:13], v[84:85], 0
    s_nop 1
    v_mfma_f32_4x4x4_16b_bf16 v[88:91], v[10:11], v[86:87], v[88:91]
    s_nop 4
    v_cvt_pk_bf16_f32 v88, v88, v89
    v_cvt_pk_bf16_f32 v89, v90, v91
    ds_pk_add_bf16 v7, v88 offset:65408
    ds_pk_add_bf16 v7, v89 offset:65412
    s_mov_b64 exec, s[54:55]
    s_branch L2_d80
L2_c81:
    s_lshl_b64 s[52:53], s[82:83], 1
    s_andn2_b64 s[52:53], s[52:53], s[80:81]
    s_andn2_b64 s[52:53], s[52:53], s[50:51]
    s_or_b64 s[80:81], s[80:81], s[52:53]
    s_not_b64 vcc, s[52:53]
    s_mov_b64 exec, -1
    v_cndmask_b32_dpp v84, v84, v84, vcc wave_shr:1 row_mask:0xf bank_mask:0xf
    v_cndmask_b32_dpp v85, v85, v85, vcc wave_shr:1 row_mask:0xf bank_mask:0xf
    s_lshr_b64 s[52:53], s[52:53], 1
    v_cndmask_b32_dpp v86, v86, v86, vcc wave_shr:1 row_mask:0xf bank_mask:0xf
    v_cndmask_b32_dpp v87, v87, v87, vcc wave_shr:1 row_mask:0xf bank_mask:0xf
    s_andn2_b64 s[82:83], s[82:83], s[52:53]
    v_cndmask_b32_dpp v7, v7, v7, vcc wave_shr:1 row_mask:0xf bank_mask:0xf
    s_mov_b64 exec, s[50:51]
    s_cbranch_scc0 L2_d81
    s_mov_b64 exec, s[82:83]
    s_nop 1
    v_mfma_f32_4x4x4_16b_bf16 v[88:91], v[12:13], v[84:85], 0
    s_nop 1
    v_mfma_f32_4x4x4_16b_bf16 v[88:91], v[10:11], v[86:87], v[88:91]
    s_nop 4
    v_cvt_pk_bf16_f32 v88, v88, v89
    v_cvt_pk_bf16_f32 v89, v90, v91
    ds_pk_add_bf16 v7, v88 offset:65408
    ds_pk_add_bf16 v7, v89 offset:65412
    s_mov_b64 exec, s[50:51]
    s_branch L2_d81
L2_oa82:
    v_and_b32 v47, 0x0fffffff, v32
    buffer_load_dword v114, v47, s[8:11], 0 offen offset:16
    s_mov_b64 exec, s[6:7]
    v_add_u32 v47, 8, v47
    v_lshrrev_b32 v32, 2, v32
    s_mov_b64 exec, -1
    buffer_load_dwordx2 v[112:113], v47, s[8:11], 0 offen
    s_branch L2_ob82
L2_c83:
    s_lshl_b64 s[52:53], s[82:83], 1
    s_andn2_b64 s[52:53], s[52:53], s[80:81]
    s_andn2_b64 s[52:53], s[52:53], s[54:55]
    s_or_b64 s[80:81], s[80:81], s[52:53]
    s_not_b64 vcc, s[52:53]
    s_mov_b64 exec, -1
    v_cndmask_b32_dpp v84, v84, v84, vcc wave_shr:1 row_mask:0xf bank_mask:0xf
    v_cndmask_b32_dpp v85, v85, v85, vcc wave_shr:1 row_mask:0xf bank_mask:0xf
    s_lshr_b64 s[52:53], s[52:53], 1
    v_cndmask_b32_dpp v86, v86, v86, vcc wave_shr:1 row_mask:0xf bank_mask:0xf
    v_cndmask_b32_dpp v87, v87, v87, vcc wave_shr:1 row_mask:0xf bank_mask:0xf
    s_andn2_b64 s[82:83], s[82:83], s[52:53]
    v_cndmask_b32_dpp v7, v7, v7, vcc wave_shr:1 row_mask:0xf bank_mask:0xf
    s_mov_b64 exec, s[54:55]
    s_cbranch_scc0 L2_d83
    s_mov_b64 exec, s[82:83]
    s_nop 1
    v_mfma_f32_4x4x4_16b_bf16 v[88:91], v[12:13], v[84:85], 0
    s_nop 1
    v_mfma_f32_4x4x4_16b_bf16 v[88:91], v[10:11], v[86:87], v[88:91]
    s_nop 4
    v_cvt_pk_bf16_f32 v88, v88, v89
    v_cvt_pk_bf16_f32 v89, v90, v91
    ds_pk_add_bf16 v7, v88 offset:65408
    ds_pk_add_bf16 v7, v89 offset:65412
    s_mov_b64 exec, s[54:55]
    s_branch L2_d83
L2_c84:
    s_lshl_b64 s[52:53], s[82:83], 1
    s_andn2_b64 s[52:53], s[52:53], s[80:81]
    s_andn2_b64 s[52:53], s[52:53], s[50:51]
    s_or_b64 s[80:81], s[80:81], s[52:53]
    s_not_b64 vcc, s[52:53]
    s_mov_b64 exec, -1
    v_cndmask_b32_dpp v84, v84, v84, vcc wave_shr:1 row_mask:0xf bank_mask:0xf
    v_cndmask_b32_dpp v85, v85, v85, vcc wave_shr:1 row_mask:0xf bank_mask:0xf
    s_lshr_b64 s[52:53], s[52:53], 1
    v_cndmask_b32_dpp v86, v86, v86, vcc wave_shr:1 row_mask:0xf bank_mask:0xf
    v_cndmask_b32_dpp v87, v87, v87, vcc wave_shr:1 row_mask:0xf bank_mask:0xf
    s_andn2_b64 s[82:83], s[82:83], s[52:53]
    v_cndmask_b32_dpp v7, v7, v7, vcc wave_shr:1 row_mask:0xf bank_mask:0xf
    s_mov_b64 exec, s[50:51]
    s_cbranch_scc0 L2_d84
    s_mov_b64 exec, s[82:83]
    s_nop 1
    v_mfma_f32_4x4x4_16b_bf16 v[88:91], v[12:13], v[84:85], 0
    s_nop 1
    v_mfma_f32_4x4x4_16b_bf16 v[88:91], v[10:11], v[86:87], v[88:91]
    s_nop 4
    v_cvt_pk_bf16_f32 v88, v88, v89
    v_cvt_pk_bf16_f32 v89, v90, v91
    ds_pk_add_bf16 v7, v88 offset:65408
    ds_pk_add_bf16 v7, v89 offset:65412
    s_mov_b64 exec, s[50:51]
    s_branch L2_d84
L2_c85:
    s_lshl_b64 s[52:53], s[82:83], 1
    s_andn2_b64 s[52:53], s[52:53], s[80:81]
    s_andn2_b64 s[52:53], s[52:53], s[54:55]
    s_or_b64 s[80:81], s[80:81], s[52:53]
    s_not_b64 vcc, s[52:53]
    s_mov_b64 exec, -1
    v_cndmask_b32_dpp v84, v84, v84, vcc wave_shr:1 row_mask:0xf bank_mask:0xf
    v_cndmask_b32_dpp v85, v85, v85, vcc wave_shr:1 row_mask:0xf bank_mask:0xf
    s_lshr_b64 s[52:53], s[52:53], 1
    v_cndmask_b32_dpp v86, v86, v86, vcc wave_shr:1 row_mask:0xf bank_mask:0xf
    v_cndmask_b32_dpp v87, v87, v87, vcc wave_shr:1 row_mask:0xf bank_mask:0xf
    s_andn2_b64 s[82:83], s[82:83], s[52:53]
    v_cndmask_b32_dpp v7, v7, v7, vcc wave_shr:1 row_mask:0xf bank_mask:0xf
    s_mov_b64 exec, s[54:55]
    s_cbranch_scc0 L2_d85
    s_mov_b64 exec, s[82:83]
    s_nop 1
    v_mfma_f32_4x4x4_16b_bf16 v[88:91], v[12:13], v[84:85], 0
    s_nop 1
    v_mfma_f32_4x4x4_16b_bf16 v[88:91], v[10:11], v[86:87], v[88:91]
    s_nop 4
    v_cvt_pk_bf16_f32 v88, v88, v89
    v_cvt_pk_bf16_f32 v89, v90, v91
    ds_pk_add_bf16 v7, v88 offset:65408
    ds_pk_add_bf16 v7, v89 offset:65412
    s_mov_b64 exec, s[54:55]
    s_branch L2_d85
L2_c86:
    s_lshl_b64 s[52:53], s[82:83], 1
    s_andn2_b64 s[52:53], s[52:53], s[80:81]
    s_andn2_b64 s[52:53], s[52:53], s[50:51]
    s_or_b64 s[80:81], s[80:81], s[52:53]
    s_not_b64 vcc, s[52:53]
    s_mov_b64 exec, -1
    v_cndmask_b32_dpp v84, v84, v84, vcc wave_shr:1 row_mask:0xf bank_mask:0xf
    v_cndmask_b32_dpp v85, v85, v85, vcc wave_shr:1 row_mask:0xf bank_mask:0xf
    s_lshr_b64 s[52:53], s[52:53], 1
    v_cndmask_b32_dpp v86, v86, v86, vcc wave_shr:1 row_mask:0xf bank_mask:0xf
    v_cndmask_b32_dpp v87, v87, v87, vcc wave_shr:1 row_mask:0xf bank_mask:0xf
    s_andn2_b64 s[82:83], s[82:83], s[52:53]
    v_cndmask_b32_dpp v7, v7, v7, vcc wave_shr:1 row_mask:0xf bank_mask:0xf
    s_mov_b64 exec, s[50:51]
    s_cbranch_scc0 L2_d86
    s_mov_b64 exec, s[82:83]
    s_nop 1
    v_mfma_f32_4x4x4_16b_bf16 v[88:91], v[12:13], v[84:85], 0
    s_nop 1
    v_mfma_f32_4x4x4_16b_bf16 v[88:91], v[10:11], v[86:87], v[88:91]
    s_nop 4
    v_cvt_pk_bf16_f32 v88, v88, v89
    v_cvt_pk_bf16_f32 v89, v90, v91
    ds_pk_add_bf16 v7, v88 offset:65408
    ds_pk_add_bf16 v7, v89 offset:65412
    s_mov_b64 exec, s[50:51]
    s_branch L2_d86
L2_c87:
    s_lshl_b64 s[52:53], s[82:83], 1
    s_andn2_b64 s[52:53], s[52:53], s[80:81]
    s_andn2_b64 s[52:53], s[52:53], s[54:55]
    s_or_b64 s[80:81], s[80:81], s[52:53]
    s_not_b64 vcc, s[52:53]
    s_mov_b64 exec, -1
    v_cndmask_b32_dpp v84, v84, v84, vcc wave_shr:1 row_mask:0xf bank_mask:0xf
    v_cndmask_b32_dpp v85, v85, v85, vcc wave_shr:1 row_mask:0xf bank_mask:0xf
    s_lshr_b64 s[52:53], s[52:53], 1
    v_cndmask_b32_dpp v86, v86, v86, vcc wave_shr:1 row_mask:0xf bank_mask:0xf
    v_cndmask_b32_dpp v87, v87, v87, vcc wave_shr:1 row_mask:0xf bank_mask:0xf
    s_andn2_b64 s[82:83], s[82:83], s[52:53]
    v_cndmask_b32_dpp v7, v7, v7, vcc wave_shr:1 row_mask:0xf bank_mask:0xf
    s_mov_b64 exec, s[54:55]
    s_cbranch_scc0 L2_d87
    s_mov_b64 exec, s[82:83]
    s_nop 1
    v_mfma_f32_4x4x4_16b_bf16 v[88:91], v[12:13], v[84:85], 0
    s_nop 1
    v_mfma_f32_4x4x4_16b_bf16 v[88:91], v[10:11], v[86:87], v[88:91]
    s_nop 4
    v_cvt_pk_bf16_f32 v88, v88, v89
    v_cvt_pk_bf16_f32 v89, v90, v91
    ds_pk_add_bf16 v7, v88 offset:65408
    ds_pk_add_bf16 v7, v89 offset:65412
    s_mov_b64 exec, s[54:55]
    s_branch L2_d87
L2_c88:
    s_lshl_b64 s[52:53], s[82:83], 1
    s_andn2_b64 s[52:53], s[52:53], s[80:81]
    s_andn2_b64 s[52:53], s[52:53], s[50:51]
    s_or_b64 s[80:81], s[80:81], s[52:53]
    s_not_b64 vcc, s[52:53]
    s_mov_b64 exec, -1
    v_cndmask_b32_dpp v84, v84, v84, vcc wave_shr:1 row_mask:0xf bank_mask:0xf
    v_cndmask_b32_dpp v85, v85, v85, vcc wave_shr:1 row_mask:0xf bank_mask:0xf
    s_lshr_b64 s[52:53], s[52:53], 1
    v_cndmask_b32_dpp v86, v86, v86, vcc wave_shr:1 row_mask:0xf bank_mask:0xf
    v_cndmask_b32_dpp v87, v87, v87, vcc wave_shr:1 row_mask:0xf bank_mask:0xf
    s_andn2_b64 s[82:83], s[82:83], s[52:53]
    v_cndmask_b32_dpp v7, v7, v7, vcc wave_shr:1 row_mask:0xf bank_mask:0xf
    s_mov_b64 exec, s[50:51]
    s_cbranch_scc0 L2_d88
    s_mov_b64 exec, s[82:83]
    s_nop 1
    v_mfma_f32_4x4x4_16b_bf16 v[88:91], v[12:13], v[84:85], 0
    s_nop 1
    v_mfma_f32_4x4x4_16b_bf16 v[88:91], v[10:11], v[86:87], v[88:91]
    s_nop 4
    v_cvt_pk_bf16_f32 v88, v88, v89
    v_cvt_pk_bf16_f32 v89, v90, v91
    ds_pk_add_bf16 v7, v88 offset:65408
    ds_pk_add_bf16 v7, v89 offset:65412
    s_mov_b64 exec, s[50:51]
    s_branch L2_d88
L2_oa89:
    s_waitcnt vmcnt(3)
    s_mov_b64 exec, s[6:7]
    v_lshrrev_b32 v114, 16, v114
    s_mov_b64 exec, -1
    v_and_b32 v46, 0x10000000, v32
    v_cmpx_eq_u32 vcc, 0, v46
    v_lshrrev_b32 v47, 14, v112
    v_and_b32 v47, v5, v47
    ds_read_b64 v[96:97], v47
    v_perm_b32 v98, v112, v114, s44
    v_bitop3_b32 v99, v112, 0.5, -0.5 bitop3:0xa8
    v_bitop3_b32 v98, v6, v98, v99 bitop3:0xca
    v_and_b32 v47, v5, v112
    s_waitcnt lgkmcnt(0)
    v_mfma_f32_4x4x4_16b_bf16 v[88:91], v[8:9], v[96:97], 0
    s_nop 4
    v_mul_f32 v88, v98, v88
    v_mul_f32 v89, v98, v89
    v_mul_f32 v90, v98, v90
    v_mul_f32 v91, v98, v91
    v_cvt_pk_bf16_f32 v88, v88, v89
    v_cvt_pk_bf16_f32 v89, v90, v91
    ds_pk_add_bf16 v47, v88 offset:65408
    ds_pk_add_bf16 v47, v89 offset:65412
    s_mov_b64 exec, -1
    v_and_b32 v46, 0x20000000, v32
    v_cmpx_eq_u32 vcc, 0, v46
    v_lshrrev_b32 v47, 14, v113
    v_and_b32 v47, v5, v47
    ds_read_b64 v[96:97], v47
    v_perm_b32 v98, v113, v114, s45
    v_bitop3_b32 v99, v113, 0.5, -0.5 bitop3:0xa8
    v_bitop3_b32 v98, v6, v98, v99 bitop3:0xca
    v_and_b32 v47, v5, v113
    s_waitcnt lgkmcnt(0)
    v_mfma_f32_4x4x4_16b_bf16 v[88:91], v[8:9], v[96:97], 0
    s_nop 4
    v_mul_f32 v88, v98, v88
    v_mul_f32 v89, v98, v89
    v_mul_f32 v90, v98, v90
    v_mul_f32 v91, v98, v91
    v_cvt_pk_bf16_f32 v88, v88, v89
    v_cvt_pk_bf16_f32 v89, v90, v91
    ds_pk_add_bf16 v47, v88 offset:65408
    ds_pk_add_bf16 v47, v89 offset:65412
    s_mov_b64 exec, -1
    s_branch L2_ob89
L2_xo90:
    v_cmp_lt_u32 vcc, 20, v99
    s_mov_b32 s101, 1
    s_cbranch_vccz L2_xp90
    v_cmp_lt_u32 vcc, 32, v99
    v_cmp_lt_u32 s[58:59], 31, v88
    s_mov_b32 s101, 2
    s_or_b64 vcc, vcc, s[58:59]
    s_cbranch_scc0 L2_xp90
    s_mov_b32 s37, 0x10000
    s_branch L2_xp90
L2_c91:
    s_lshl_b64 s[52:53], s[82:83], 1
    s_andn2_b64 s[52:53], s[52:53], s[80:81]
    s_andn2_b64 s[52:53], s[52:53], s[54:55]
    s_or_b64 s[80:81], s[80:81], s[52:53]
    s_not_b64 vcc, s[52:53]
    s_mov_b64 exec, -1
    v_cndmask_b32_dpp v84, v84, v84, vcc wave_shr:1 row_mask:0xf bank_mask:0xf
    v_cndmask_b32_dpp v85, v85, v85, vcc wave_shr:1 row_mask:0xf bank_mask:0xf
    s_lshr_b64 s[52:53], s[52:53], 1
    v_cndmask_b32_dpp v86, v86, v86, vcc wave_shr:1 row_mask:0xf bank_mask:0xf
    v_cndmask_b32_dpp v87, v87, v87, vcc wave_shr:1 row_mask:0xf bank_mask:0xf
    s_andn2_b64 s[82:83], s[82:83], s[52:53]
    v_cndmask_b32_dpp v7, v7, v7, vcc wave_shr:1 row_mask:0xf bank_mask:0xf
    s_mov_b64 exec, s[54:55]
    s_cbranch_scc0 L2_d91
    s_mov_b64 exec, s[82:83]
    s_nop 1
    v_mfma_f32_4x4x4_16b_bf16 v[88:91], v[12:13], v[84:85], 0
    s_nop 1
    v_mfma_f32_4x4x4_16b_bf16 v[88:91], v[10:11], v[86:87], v[88:91]
    s_nop 4
    v_cvt_pk_bf16_f32 v88, v88, v89
    v_cvt_pk_bf16_f32 v89, v90, v91
    ds_pk_add_bf16 v7, v88 offset:65408
    ds_pk_add_bf16 v7, v89 offset:65412
    s_mov_b64 exec, s[54:55]
    s_branch L2_d91
L2_c92:
    s_lshl_b64 s[52:53], s[82:83], 1
    s_andn2_b64 s[52:53], s[52:53], s[80:81]
    s_andn2_b64 s[52:53], s[52:53], s[50:51]
    s_or_b64 s[80:81], s[80:81], s[52:53]
    s_not_b64 vcc, s[52:53]
    s_mov_b64 exec, -1
    v_cndmask_b32_dpp v84, v84, v84, vcc wave_shr:1 row_mask:0xf bank_mask:0xf
    v_cndmask_b32_dpp v85, v85, v85, vcc wave_shr:1 row_mask:0xf bank_mask:0xf
    s_lshr_b64 s[52:53], s[52:53], 1
    v_cndmask_b32_dpp v86, v86, v86, vcc wave_shr:1 row_mask:0xf bank_mask:0xf
    v_cndmask_b32_dpp v87, v87, v87, vcc wave_shr:1 row_mask:0xf bank_mask:0xf
    s_andn2_b64 s[82:83], s[82:83], s[52:53]
    v_cndmask_b32_dpp v7, v7, v7, vcc wave_shr:1 row_mask:0xf bank_mask:0xf
    s_mov_b64 exec, s[50:51]
    s_cbranch_scc0 L2_d92
    s_mov_b64 exec, s[82:83]
    s_nop 1
    v_mfma_f32_4x4x4_16b_bf16 v[88:91], v[12:13], v[84:85], 0
    s_nop 1
    v_mfma_f32_4x4x4_16b_bf16 v[88:91], v[10:11], v[86:87], v[88:91]
    s_nop 4
    v_cvt_pk_bf16_f32 v88, v88, v89
    v_cvt_pk_bf16_f32 v89, v90, v91
    ds_pk_add_bf16 v7, v88 offset:65408
    ds_pk_add_bf16 v7, v89 offset:65412
    s_mov_b64 exec, s[50:51]
    s_branch L2_d92
L2_c93:
    s_lshl_b64 s[52:53], s[82:83], 1
    s_andn2_b64 s[52:53], s[52:53], s[80:81]
    s_andn2_b64 s[52:53], s[52:53], s[54:55]
    s_or_b64 s[80:81], s[80:81], s[52:53]
    s_not_b64 vcc, s[52:53]
    s_mov_b64 exec, -1
    v_cndmask_b32_dpp v84, v84, v84, vcc wave_shr:1 row_mask:0xf bank_mask:0xf
    v_cndmask_b32_dpp v85, v85, v85, vcc wave_shr:1 row_mask:0xf bank_mask:0xf
    s_lshr_b64 s[52:53], s[52:53], 1
    v_cndmask_b32_dpp v86, v86, v86, vcc wave_shr:1 row_mask:0xf bank_mask:0xf
    v_cndmask_b32_dpp v87, v87, v87, vcc wave_shr:1 row_mask:0xf bank_mask:0xf
    s_andn2_b64 s[82:83], s[82:83], s[52:53]
    v_cndmask_b32_dpp v7, v7, v7, vcc wave_shr:1 row_mask:0xf bank_mask:0xf
    s_mov_b64 exec, s[54:55]
    s_cbranch_scc0 L2_d93
    s_mov_b64 exec, s[82:83]
    s_nop 1
    v_mfma_f32_4x4x4_16b_bf16 v[88:91], v[12:13], v[84:85], 0
    s_nop 1
    v_mfma_f32_4x4x4_16b_bf16 v[88:91], v[10:11], v[86:87], v[88:91]
    s_nop 4
    v_cvt_pk_bf16_f32 v88, v88, v89
    v_cvt_pk_bf16_f32 v89, v90, v91
    ds_pk_add_bf16 v7, v88 offset:65408
    ds_pk_add_bf16 v7, v89 offset:65412
    s_mov_b64 exec, s[54:55]
    s_branch L2_d93
L2_c94:
    s_lshl_b64 s[52:53], s[82:83], 1
    s_andn2_b64 s[52:53], s[52:53], s[80:81]
    s_andn2_b64 s[52:53], s[52:53], s[50:51]
    s_or_b64 s[80:81], s[80:81], s[52:53]
    s_not_b64 vcc, s[52:53]
    s_mov_b64 exec, -1
    v_cndmask_b32_dpp v84, v84, v84, vcc wave_shr:1 row_mask:0xf bank_mask:0xf
    v_cndmask_b32_dpp v85, v85, v85, vcc wave_shr:1 row_mask:0xf bank_mask:0xf
    s_lshr_b64 s[52:53], s[52:53], 1
    v_cndmask_b32_dpp v86, v86, v86, vcc wave_shr:1 row_mask:0xf bank_mask:0xf
    v_cndmask_b32_dpp v87, v87, v87, vcc wave_shr:1 row_mask:0xf bank_mask:0xf
    s_andn2_b64 s[82:83], s[82:83], s[52:53]
    v_cndmask_b32_dpp v7, v7, v7, vcc wave_shr:1 row_mask:0xf bank_mask:0xf
    s_mov_b64 exec, s[50:51]
    s_cbranch_scc0 L2_d94
    s_mov_b64 exec, s[82:83]
    s_nop 1
    v_mfma_f32_4x4x4_16b_bf16 v[88:91], v[12:13], v[84:85], 0
    s_nop 1
    v_mfma_f32_4x4x4_16b_bf16 v[88:91], v[10:11], v[86:87], v[88:91]
    s_nop 4
    v_cvt_pk_bf16_f32 v88, v88, v89
    v_cvt_pk_bf16_f32 v89, v90, v91
    ds_pk_add_bf16 v7, v88 offset:65408
    ds_pk_add_bf16 v7, v89 offset:65412
    s_mov_b64 exec, s[50:51]
    s_branch L2_d94
L2_c95:
    s_lshl_b64 s[52:53], s[82:83], 1
    s_andn2_b64 s[52:53], s[52:53], s[80:81]
    s_andn2_b64 s[52:53], s[52:53], s[54:55]
    s_or_b64 s[80:81], s[80:81], s[52:53]
    s_not_b64 vcc, s[52:53]
    s_mov_b64 exec, -1
    v_cndmask_b32_dpp v84, v84, v84, vcc wave_shr:1 row_mask:0xf bank_mask:0xf
    v_cndmask_b32_dpp v85, v85, v85, vcc wave_shr:1 row_mask:0xf bank_mask:0xf
    s_lshr_b64 s[52:53], s[52:53], 1
    v_cndmask_b32_dpp v86, v86, v86, vcc wave_shr:1 row_mask:0xf bank_mask:0xf
    v_cndmask_b32_dpp v87, v87, v87, vcc wave_shr:1 row_mask:0xf bank_mask:0xf
    s_andn2_b64 s[82:83], s[82:83], s[52:53]
    v_cndmask_b32_dpp v7, v7, v7, vcc wave_shr:1 row_mask:0xf bank_mask:0xf
    s_mov_b64 exec, s[54:55]
    s_cbranch_scc0 L2_d95
    s_mov_b64 exec, s[82:83]
    s_nop 1
    v_mfma_f32_4x4x4_16b_bf16 v[88:91], v[12:13], v[84:85], 0
    s_nop 1
    v_mfma_f32_4x4x4_16b_bf16 v[88:91], v[10:11], v[86:87], v[88:91]
    s_nop 4
    v_cvt_pk_bf16_f32 v88, v88, v89
    v_cvt_pk_bf16_f32 v89, v90, v91
    ds_pk_add_bf16 v7, v88 offset:65408
    ds_pk_add_bf16 v7, v89 offset:65412
    s_mov_b64 exec, s[54:55]
    s_branch L2_d95
L2_c96:
    s_lshl_b64 s[52:53], s[82:83], 1
    s_andn2_b64 s[52:53], s[52:53], s[80:81]
    s_andn2_b64 s[52:53], s[52:53], s[50:51]
    s_or_b64 s[80:81], s[80:81], s[52:53]
    s_not_b64 vcc, s[52:53]
    s_mov_b64 exec, -1
    v_cndmask_b32_dpp v84, v84, v84, vcc wave_shr:1 row_mask:0xf bank_mask:0xf
    v_cndmask_b32_dpp v85, v85, v85, vcc wave_shr:1 row_mask:0xf bank_mask:0xf
    s_lshr_b64 s[52:53], s[52:53], 1
    v_cndmask_b32_dpp v86, v86, v86, vcc wave_shr:1 row_mask:0xf bank_mask:0xf
    v_cndmask_b32_dpp v87, v87, v87, vcc wave_shr:1 row_mask:0xf bank_mask:0xf
    s_andn2_b64 s[82:83], s[82:83], s[52:53]
    v_cndmask_b32_dpp v7, v7, v7, vcc wave_shr:1 row_mask:0xf bank_mask:0xf
    s_mov_b64 exec, s[50:51]
    s_cbranch_scc0 L2_d96
    s_mov_b64 exec, s[82:83]
    s_nop 1
    v_mfma_f32_4x4x4_16b_bf16 v[88:91], v[12:13], v[84:85], 0
    s_nop 1
    v_mfma_f32_4x4x4_16b_bf16 v[88:91], v[10:11], v[86:87], v[88:91]
    s_nop 4
    v_cvt_pk_bf16_f32 v88, v88, v89
    v_cvt_pk_bf16_f32 v89, v90, v91
    ds_pk_add_bf16 v7, v88 offset:65408
    ds_pk_add_bf16 v7, v89 offset:65412
    s_mov_b64 exec, s[50:51]
    s_branch L2_d96
L2_xa97:
    s_cmp_eq_u32 s101, 1
    s_cbranch_scc1 L2_xc97
    v_lshlrev_b32 v89, 0, v96
    v_add_u32 v90, 140, v97
    v_bitop3_b32 v90, v89, v45, v90 bitop3:0x6a
    ds_write_b32 v98, v90 offset:28
    v_lshlrev_b32 v89, 4, v96
    v_add_u32 v90, 120, v97
    v_bitop3_b32 v90, v89, v45, v90 bitop3:0x6a
    ds_write_b32 v98, v90 offset:24
    v_lshlrev_b32 v89, 8, v96
    v_add_u32 v90, 100, v97
    v_bitop3_b32 v90, v89, v45, v90 bitop3:0x6a
    ds_write_b32 v98, v90 offset:20
L2_xc97:
    v_lshlrev_b32 v89, 12, v96
    v_add_u32 v90, 80, v97
    v_bitop3_b32 v90, v89, v45, v90 bitop3:0x6a
    ds_write_b32 v98, v90 offset:16
    s_branch L2_xb97
L2_xe97:
    v_cmp_lt_u32 vcc, 32, v99
    v_cmp_lt_u32 s[58:59], 31, v88
    v_lshrrev_b32 v89, 16, v96
    v_add_u32 v97, 80, v97
    s_or_b64 vcc, vcc, s[58:59]
    s_cbranch_scc1 L2_xs97
    v_lshlrev_b32 v89, v1, v89
    v_and_b32 v89, v45, v89
    v_cmp_ne_u32 vcc, 0, v89
    v_xor_b32 v90, v97, v89
    s_add_u32 s3, s37, s38
    v_mbcnt_lo_u32_b32 v98, vcc_lo, 0
    v_mbcnt_hi_u32_b32 v98, vcc_hi, v98
    s_bcnt1_i32_b64 s41, vcc
    v_lshl_add_u32 v98, v98, 2, s3
    s_lshl2_add_u32 s37, s41, s37
    s_mov_b64 exec, vcc
    ds_write_b32 v98, v90
    s_mov_b64 exec, -1
    s_branch L2_xr97
L2_xf97:
    s_waitcnt lgkmcnt(0)
    s_cmp_gt_u32 s37, 1024
    s_cbranch_scc1 L2_xs97
    s_cmp_lt_u32 s37, 768
    s_cbranch_scc1 L2_xl97
    ds_read_b32 v32, v98 offset:896
    s_add_u32 s3, s42, 2
    s_bitset1_b32 s43, s3
    s_branch L2_xg97
L2_xl97:
    v_mov_b32 v42, -1
    s_cmp_ge_u32 s37, 512
    s_cbranch_scc1 L2_xg97
    v_mov_b32 v43, -1
    s_cmp_ge_u32 s37, 256
    s_cbranch_scc1 L2_xg97
    v_mov_b32 v41, -1
    s_branch L2_xg97
L2_xs97:
    s_waitcnt lgkmcnt(0)
    v_mov_b32 v40, -1
    v_mov_b32 v41, -1
    v_mov_b32 v43, -1
    v_mov_b32 v42, -1
    s_add_u32 s3, s42, 2
    s_bitset1_b32 s36, s3
    s_branch L2_xg97
L2_c98:
    s_lshl_b64 s[52:53], s[82:83], 1
    s_andn2_b64 s[52:53], s[52:53], s[80:81]
    s_andn2_b64 s[52:53], s[52:53], s[54:55]
    s_or_b64 s[80:81], s[80:81], s[52:53]
    s_not_b64 vcc, s[52:53]
    s_mov_b64 exec, -1
    v_cndmask_b32_dpp v84, v84, v84, vcc wave_shr:1 row_mask:0xf bank_mask:0xf
    v_cndmask_b32_dpp v85, v85, v85, vcc wave_shr:1 row_mask:0xf bank_mask:0xf
    s_lshr_b64 s[52:53], s[52:53], 1
    v_cndmask_b32_dpp v86, v86, v86, vcc wave_shr:1 row_mask:0xf bank_mask:0xf
    v_cndmask_b32_dpp v87, v87, v87, vcc wave_shr:1 row_mask:0xf bank_mask:0xf
    s_andn2_b64 s[82:83], s[82:83], s[52:53]
    v_cndmask_b32_dpp v7, v7, v7, vcc wave_shr:1 row_mask:0xf bank_mask:0xf
    s_mov_b64 exec, s[54:55]
    s_cbranch_scc0 L2_d98
    s_mov_b64 exec, s[82:83]
    s_nop 1
    v_mfma_f32_4x4x4_16b_bf16 v[88:91], v[12:13], v[84:85], 0
    s_nop 1
    v_mfma_f32_4x4x4_16b_bf16 v[88:91], v[10:11], v[86:87], v[88:91]
    s_nop 4
    v_cvt_pk_bf16_f32 v88, v88, v89
    v_cvt_pk_bf16_f32 v89, v90, v91
    ds_pk_add_bf16 v7, v88 offset:65408
    ds_pk_add_bf16 v7, v89 offset:65412
    s_mov_b64 exec, s[54:55]
    s_branch L2_d98
L2_c99:
    s_lshl_b64 s[52:53], s[82:83], 1
    s_andn2_b64 s[52:53], s[52:53], s[80:81]
    s_andn2_b64 s[52:53], s[52:53], s[50:51]
    s_or_b64 s[80:81], s[80:81], s[52:53]
    s_not_b64 vcc, s[52:53]
    s_mov_b64 exec, -1
    v_cndmask_b32_dpp v84, v84, v84, vcc wave_shr:1 row_mask:0xf bank_mask:0xf
    v_cndmask_b32_dpp v85, v85, v85, vcc wave_shr:1 row_mask:0xf bank_mask:0xf
    s_lshr_b64 s[52:53], s[52:53], 1
    v_cndmask_b32_dpp v86, v86, v86, vcc wave_shr:1 row_mask:0xf bank_mask:0xf
    v_cndmask_b32_dpp v87, v87, v87, vcc wave_shr:1 row_mask:0xf bank_mask:0xf
    s_andn2_b64 s[82:83], s[82:83], s[52:53]
    v_cndmask_b32_dpp v7, v7, v7, vcc wave_shr:1 row_mask:0xf bank_mask:0xf
    s_mov_b64 exec, s[50:51]
    s_cbranch_scc0 L2_d99
    s_mov_b64 exec, s[82:83]
    s_nop 1
    v_mfma_f32_4x4x4_16b_bf16 v[88:91], v[12:13], v[84:85], 0
    s_nop 1
    v_mfma_f32_4x4x4_16b_bf16 v[88:91], v[10:11], v[86:87], v[88:91]
    s_nop 4
    v_cvt_pk_bf16_f32 v88, v88, v89
    v_cvt_pk_bf16_f32 v89, v90, v91
    ds_pk_add_bf16 v7, v88 offset:65408
    ds_pk_add_bf16 v7, v89 offset:65412
    s_mov_b64 exec, s[50:51]
    s_branch L2_d99
L2_oa100:
    v_and_b32 v47, 0x0fffffff, v33
    buffer_load_dword v114, v47, s[8:11], 0 offen offset:16
    s_mov_b64 exec, s[6:7]
    v_add_u32 v47, 8, v47
    v_lshrrev_b32 v33, 2, v33
    s_mov_b64 exec, -1
    buffer_load_dwordx2 v[112:113], v47, s[8:11], 0 offen
    s_branch L2_ob100
L2_c101:
    s_lshl_b64 s[52:53], s[82:83], 1
    s_andn2_b64 s[52:53], s[52:53], s[80:81]
    s_andn2_b64 s[52:53], s[52:53], s[54:55]
    s_or_b64 s[80:81], s[80:81], s[52:53]
    s_not_b64 vcc, s[52:53]
    s_mov_b64 exec, -1
    v_cndmask_b32_dpp v84, v84, v84, vcc wave_shr:1 row_mask:0xf bank_mask:0xf
    v_cndmask_b32_dpp v85, v85, v85, vcc wave_shr:1 row_mask:0xf bank_mask:0xf
    s_lshr_b64 s[52:53], s[52:53], 1
    v_cndmask_b32_dpp v86, v86, v86, vcc wave_shr:1 row_mask:0xf bank_mask:0xf
    v_cndmask_b32_dpp v87, v87, v87, vcc wave_shr:1 row_mask:0xf bank_mask:0xf
    s_andn2_b64 s[82:83], s[82:83], s[52:53]
    v_cndmask_b32_dpp v7, v7, v7, vcc wave_shr:1 row_mask:0xf bank_mask:0xf
    s_mov_b64 exec, s[54:55]
    s_cbranch_scc0 L2_d101
    s_mov_b64 exec, s[82:83]
    s_nop 1
    v_mfma_f32_4x4x4_16b_bf16 v[88:91], v[12:13], v[84:85], 0
    s_nop 1
    v_mfma_f32_4x4x4_16b_bf16 v[88:91], v[10:11], v[86:87], v[88:91]
    s_nop 4
    v_cvt_pk_bf16_f32 v88, v88, v89
    v_cvt_pk_bf16_f32 v89, v90, v91
    ds_pk_add_bf16 v7, v88 offset:65408
    ds_pk_add_bf16 v7, v89 offset:65412
    s_mov_b64 exec, s[54:55]
    s_branch L2_d101
L2_c102:
    s_lshl_b64 s[52:53], s[82:83], 1
    s_andn2_b64 s[52:53], s[52:53], s[80:81]
    s_andn2_b64 s[52:53], s[52:53], s[50:51]
    s_or_b64 s[80:81], s[80:81], s[52:53]
    s_not_b64 vcc, s[52:53]
    s_mov_b64 exec, -1
    v_cndmask_b32_dpp v84, v84, v84, vcc wave_shr:1 row_mask:0xf bank_mask:0xf
    v_cndmask_b32_dpp v85, v85, v85, vcc wave_shr:1 row_mask:0xf bank_mask:0xf
    s_lshr_b64 s[52:53], s[52:53], 1
    v_cndmask_b32_dpp v86, v86, v86, vcc wave_shr:1 row_mask:0xf bank_mask:0xf
    v_cndmask_b32_dpp v87, v87, v87, vcc wave_shr:1 row_mask:0xf bank_mask:0xf
    s_andn2_b64 s[82:83], s[82:83], s[52:53]
    v_cndmask_b32_dpp v7, v7, v7, vcc wave_shr:1 row_mask:0xf bank_mask:0xf
    s_mov_b64 exec, s[50:51]
    s_cbranch_scc0 L2_d102
    s_mov_b64 exec, s[82:83]
    s_nop 1
    v_mfma_f32_4x4x4_16b_bf16 v[88:91], v[12:13], v[84:85], 0
    s_nop 1
    v_mfma_f32_4x4x4_16b_bf16 v[88:91], v[10:11], v[86:87], v[88:91]
    s_nop 4
    v_cvt_pk_bf16_f32 v88, v88, v89
    v_cvt_pk_bf16_f32 v89, v90, v91
    ds_pk_add_bf16 v7, v88 offset:65408
    ds_pk_add_bf16 v7, v89 offset:65412
    s_mov_b64 exec, s[50:51]
    s_branch L2_d102
L2_c103:
    s_lshl_b64 s[52:53], s[82:83], 1
    s_andn2_b64 s[52:53], s[52:53], s[80:81]
    s_andn2_b64 s[52:53], s[52:53], s[54:55]
    s_or_b64 s[80:81], s[80:81], s[52:53]
    s_not_b64 vcc, s[52:53]
    s_mov_b64 exec, -1
    v_cndmask_b32_dpp v84, v84, v84, vcc wave_shr:1 row_mask:0xf bank_mask:0xf
    v_cndmask_b32_dpp v85, v85, v85, vcc wave_shr:1 row_mask:0xf bank_mask:0xf
    s_lshr_b64 s[52:53], s[52:53], 1
    v_cndmask_b32_dpp v86, v86, v86, vcc wave_shr:1 row_mask:0xf bank_mask:0xf
    v_cndmask_b32_dpp v87, v87, v87, vcc wave_shr:1 row_mask:0xf bank_mask:0xf
    s_andn2_b64 s[82:83], s[82:83], s[52:53]
    v_cndmask_b32_dpp v7, v7, v7, vcc wave_shr:1 row_mask:0xf bank_mask:0xf
    s_mov_b64 exec, s[54:55]
    s_cbranch_scc0 L2_d103
    s_mov_b64 exec, s[82:83]
    s_nop 1
    v_mfma_f32_4x4x4_16b_bf16 v[88:91], v[12:13], v[84:85], 0
    s_nop 1
    v_mfma_f32_4x4x4_16b_bf16 v[88:91], v[10:11], v[86:87], v[88:91]
    s_nop 4
    v_cvt_pk_bf16_f32 v88, v88, v89
    v_cvt_pk_bf16_f32 v89, v90, v91
    ds_pk_add_bf16 v7, v88 offset:65408
    ds_pk_add_bf16 v7, v89 offset:65412
    s_mov_b64 exec, s[54:55]
    s_branch L2_d103
L2_c104:
    s_lshl_b64 s[52:53], s[82:83], 1
    s_andn2_b64 s[52:53], s[52:53], s[80:81]
    s_andn2_b64 s[52:53], s[52:53], s[50:51]
    s_or_b64 s[80:81], s[80:81], s[52:53]
    s_not_b64 vcc, s[52:53]
    s_mov_b64 exec, -1
    v_cndmask_b32_dpp v84, v84, v84, vcc wave_shr:1 row_mask:0xf bank_mask:0xf
    v_cndmask_b32_dpp v85, v85, v85, vcc wave_shr:1 row_mask:0xf bank_mask:0xf
    s_lshr_b64 s[52:53], s[52:53], 1
    v_cndmask_b32_dpp v86, v86, v86, vcc wave_shr:1 row_mask:0xf bank_mask:0xf
    v_cndmask_b32_dpp v87, v87, v87, vcc wave_shr:1 row_mask:0xf bank_mask:0xf
    s_andn2_b64 s[82:83], s[82:83], s[52:53]
    v_cndmask_b32_dpp v7, v7, v7, vcc wave_shr:1 row_mask:0xf bank_mask:0xf
    s_mov_b64 exec, s[50:51]
    s_cbranch_scc0 L2_d104
    s_mov_b64 exec, s[82:83]
    s_nop 1
    v_mfma_f32_4x4x4_16b_bf16 v[88:91], v[12:13], v[84:85], 0
    s_nop 1
    v_mfma_f32_4x4x4_16b_bf16 v[88:91], v[10:11], v[86:87], v[88:91]
    s_nop 4
    v_cvt_pk_bf16_f32 v88, v88, v89
    v_cvt_pk_bf16_f32 v89, v90, v91
    ds_pk_add_bf16 v7, v88 offset:65408
    ds_pk_add_bf16 v7, v89 offset:65412
    s_mov_b64 exec, s[50:51]
    s_branch L2_d104
L2_c105:
    s_lshl_b64 s[52:53], s[82:83], 1
    s_andn2_b64 s[52:53], s[52:53], s[80:81]
    s_andn2_b64 s[52:53], s[52:53], s[54:55]
    s_or_b64 s[80:81], s[80:81], s[52:53]
    s_not_b64 vcc, s[52:53]
    s_mov_b64 exec, -1
    v_cndmask_b32_dpp v84, v84, v84, vcc wave_shr:1 row_mask:0xf bank_mask:0xf
    v_cndmask_b32_dpp v85, v85, v85, vcc wave_shr:1 row_mask:0xf bank_mask:0xf
    s_lshr_b64 s[52:53], s[52:53], 1
    v_cndmask_b32_dpp v86, v86, v86, vcc wave_shr:1 row_mask:0xf bank_mask:0xf
    v_cndmask_b32_dpp v87, v87, v87, vcc wave_shr:1 row_mask:0xf bank_mask:0xf
    s_andn2_b64 s[82:83], s[82:83], s[52:53]
    v_cndmask_b32_dpp v7, v7, v7, vcc wave_shr:1 row_mask:0xf bank_mask:0xf
    s_mov_b64 exec, s[54:55]
    s_cbranch_scc0 L2_d105
    s_mov_b64 exec, s[82:83]
    s_nop 1
    v_mfma_f32_4x4x4_16b_bf16 v[88:91], v[12:13], v[84:85], 0
    s_nop 1
    v_mfma_f32_4x4x4_16b_bf16 v[88:91], v[10:11], v[86:87], v[88:91]
    s_nop 4
    v_cvt_pk_bf16_f32 v88, v88, v89
    v_cvt_pk_bf16_f32 v89, v90, v91
    ds_pk_add_bf16 v7, v88 offset:65408
    ds_pk_add_bf16 v7, v89 offset:65412
    s_mov_b64 exec, s[54:55]
    s_branch L2_d105
L2_c106:
    s_lshl_b64 s[52:53], s[82:83], 1
    s_andn2_b64 s[52:53], s[52:53], s[80:81]
    s_andn2_b64 s[52:53], s[52:53], s[50:51]
    s_or_b64 s[80:81], s[80:81], s[52:53]
    s_not_b64 vcc, s[52:53]
    s_mov_b64 exec, -1
    v_cndmask_b32_dpp v84, v84, v84, vcc wave_shr:1 row_mask:0xf bank_mask:0xf
    v_cndmask_b32_dpp v85, v85, v85, vcc wave_shr:1 row_mask:0xf bank_mask:0xf
    s_lshr_b64 s[52:53], s[52:53], 1
    v_cndmask_b32_dpp v86, v86, v86, vcc wave_shr:1 row_mask:0xf bank_mask:0xf
    v_cndmask_b32_dpp v87, v87, v87, vcc wave_shr:1 row_mask:0xf bank_mask:0xf
    s_andn2_b64 s[82:83], s[82:83], s[52:53]
    v_cndmask_b32_dpp v7, v7, v7, vcc wave_shr:1 row_mask:0xf bank_mask:0xf
    s_mov_b64 exec, s[50:51]
    s_cbranch_scc0 L2_d106
    s_mov_b64 exec, s[82:83]
    s_nop 1
    v_mfma_f32_4x4x4_16b_bf16 v[88:91], v[12:13], v[84:85], 0
    s_nop 1
    v_mfma_f32_4x4x4_16b_bf16 v[88:91], v[10:11], v[86:87], v[88:91]
    s_nop 4
    v_cvt_pk_bf16_f32 v88, v88, v89
    v_cvt_pk_bf16_f32 v89, v90, v91
    ds_pk_add_bf16 v7, v88 offset:65408
    ds_pk_add_bf16 v7, v89 offset:65412
    s_mov_b64 exec, s[50:51]
    s_branch L2_d106
L2_oa107:
    s_waitcnt vmcnt(3)
    s_mov_b64 exec, s[6:7]
    v_lshrrev_b32 v114, 16, v114
    s_mov_b64 exec, -1
    v_and_b32 v46, 0x10000000, v33
    v_cmpx_eq_u32 vcc, 0, v46
    v_lshrrev_b32 v47, 14, v112
    v_and_b32 v47, v5, v47
    ds_read_b64 v[96:97], v47
    v_perm_b32 v98, v112, v114, s44
    v_bitop3_b32 v99, v112, 0.5, -0.5 bitop3:0xa8
    v_bitop3_b32 v98, v6, v98, v99 bitop3:0xca
    v_and_b32 v47, v5, v112
    s_waitcnt lgkmcnt(0)
    v_mfma_f32_4x4x4_16b_bf16 v[88:91], v[8:9], v[96:97], 0
    s_nop 4
    v_mul_f32 v88, v98, v88
    v_mul_f32 v89, v98, v89
    v_mul_f32 v90, v98, v90
    v_mul_f32 v91, v98, v91
    v_cvt_pk_bf16_f32 v88, v88, v89
    v_cvt_pk_bf16_f32 v89, v90, v91
    ds_pk_add_bf16 v47, v88 offset:65408
    ds_pk_add_bf16 v47, v89 offset:65412
    s_mov_b64 exec, -1
    v_and_b32 v46, 0x20000000, v33
    v_cmpx_eq_u32 vcc, 0, v46
    v_lshrrev_b32 v47, 14, v113
    v_and_b32 v47, v5, v47
    ds_read_b64 v[96:97], v47
    v_perm_b32 v98, v113, v114, s45
    v_bitop3_b32 v99, v113, 0.5, -0.5 bitop3:0xa8
    v_bitop3_b32 v98, v6, v98, v99 bitop3:0xca
    v_and_b32 v47, v5, v113
    s_waitcnt lgkmcnt(0)
    v_mfma_f32_4x4x4_16b_bf16 v[88:91], v[8:9], v[96:97], 0
    s_nop 4
    v_mul_f32 v88, v98, v88
    v_mul_f32 v89, v98, v89
    v_mul_f32 v90, v98, v90
    v_mul_f32 v91, v98, v91
    v_cvt_pk_bf16_f32 v88, v88, v89
    v_cvt_pk_bf16_f32 v89, v90, v91
    ds_pk_add_bf16 v47, v88 offset:65408
    ds_pk_add_bf16 v47, v89 offset:65412
    s_mov_b64 exec, -1
    s_branch L2_ob107
L2_xo108:
    v_cmp_lt_u32 vcc, 20, v99
    s_mov_b32 s101, 1
    s_cbranch_vccz L2_xp108
    v_cmp_lt_u32 vcc, 32, v99
    v_cmp_lt_u32 s[58:59], 31, v88
    s_mov_b32 s101, 2
    s_or_b64 vcc, vcc, s[58:59]
    s_cbranch_scc0 L2_xp108
    s_mov_b32 s37, 0x10000
    s_branch L2_xp108
L2_c109:
    s_lshl_b64 s[52:53], s[82:83], 1
    s_andn2_b64 s[52:53], s[52:53], s[80:81]
    s_andn2_b64 s[52:53], s[52:53], s[54:55]
    s_or_b64 s[80:81], s[80:81], s[52:53]
    s_not_b64 vcc, s[52:53]
    s_mov_b64 exec, -1
    v_cndmask_b32_dpp v84, v84, v84, vcc wave_shr:1 row_mask:0xf bank_mask:0xf
    v_cndmask_b32_dpp v85, v85, v85, vcc wave_shr:1 row_mask:0xf bank_mask:0xf
    s_lshr_b64 s[52:53], s[52:53], 1
    v_cndmask_b32_dpp v86, v86, v86, vcc wave_shr:1 row_mask:0xf bank_mask:0xf
    v_cndmask_b32_dpp v87, v87, v87, vcc wave_shr:1 row_mask:0xf bank_mask:0xf
    s_andn2_b64 s[82:83], s[82:83], s[52:53]
    v_cndmask_b32_dpp v7, v7, v7, vcc wave_shr:1 row_mask:0xf bank_mask:0xf
    s_mov_b64 exec, s[54:55]
    s_cbranch_scc0 L2_d109
    s_mov_b64 exec, s[82:83]
    s_nop 1
    v_mfma_f32_4x4x4_16b_bf16 v[88:91], v[12:13], v[84:85], 0
    s_nop 1
    v_mfma_f32_4x4x4_16b_bf16 v[88:91], v[10:11], v[86:87], v[88:91]
    s_nop 4
    v_cvt_pk_bf16_f32 v88, v88, v89
    v_cvt_pk_bf16_f32 v89, v90, v91
    ds_pk_add_bf16 v7, v88 offset:65408
    ds_pk_add_bf16 v7, v89 offset:65412
    s_mov_b64 exec, s[54:55]
    s_branch L2_d109
L2_c110:
    s_lshl_b64 s[52:53], s[82:83], 1
    s_andn2_b64 s[52:53], s[52:53], s[80:81]
    s_andn2_b64 s[52:53], s[52:53], s[50:51]
    s_or_b64 s[80:81], s[80:81], s[52:53]
    s_not_b64 vcc, s[52:53]
    s_mov_b64 exec, -1
    v_cndmask_b32_dpp v84, v84, v84, vcc wave_shr:1 row_mask:0xf bank_mask:0xf
    v_cndmask_b32_dpp v85, v85, v85, vcc wave_shr:1 row_mask:0xf bank_mask:0xf
    s_lshr_b64 s[52:53], s[52:53], 1
    v_cndmask_b32_dpp v86, v86, v86, vcc wave_shr:1 row_mask:0xf bank_mask:0xf
    v_cndmask_b32_dpp v87, v87, v87, vcc wave_shr:1 row_mask:0xf bank_mask:0xf
    s_andn2_b64 s[82:83], s[82:83], s[52:53]
    v_cndmask_b32_dpp v7, v7, v7, vcc wave_shr:1 row_mask:0xf bank_mask:0xf
    s_mov_b64 exec, s[50:51]
    s_cbranch_scc0 L2_d110
    s_mov_b64 exec, s[82:83]
    s_nop 1
    v_mfma_f32_4x4x4_16b_bf16 v[88:91], v[12:13], v[84:85], 0
    s_nop 1
    v_mfma_f32_4x4x4_16b_bf16 v[88:91], v[10:11], v[86:87], v[88:91]
    s_nop 4
    v_cvt_pk_bf16_f32 v88, v88, v89
    v_cvt_pk_bf16_f32 v89, v90, v91
    ds_pk_add_bf16 v7, v88 offset:65408
    ds_pk_add_bf16 v7, v89 offset:65412
    s_mov_b64 exec, s[50:51]
    s_branch L2_d110
L2_c111:
    s_lshl_b64 s[52:53], s[82:83], 1
    s_andn2_b64 s[52:53], s[52:53], s[80:81]
    s_andn2_b64 s[52:53], s[52:53], s[54:55]
    s_or_b64 s[80:81], s[80:81], s[52:53]
    s_not_b64 vcc, s[52:53]
    s_mov_b64 exec, -1
    v_cndmask_b32_dpp v84, v84, v84, vcc wave_shr:1 row_mask:0xf bank_mask:0xf
    v_cndmask_b32_dpp v85, v85, v85, vcc wave_shr:1 row_mask:0xf bank_mask:0xf
    s_lshr_b64 s[52:53], s[52:53], 1
    v_cndmask_b32_dpp v86, v86, v86, vcc wave_shr:1 row_mask:0xf bank_mask:0xf
    v_cndmask_b32_dpp v87, v87, v87, vcc wave_shr:1 row_mask:0xf bank_mask:0xf
    s_andn2_b64 s[82:83], s[82:83], s[52:53]
    v_cndmask_b32_dpp v7, v7, v7, vcc wave_shr:1 row_mask:0xf bank_mask:0xf
    s_mov_b64 exec, s[54:55]
    s_cbranch_scc0 L2_d111
    s_mov_b64 exec, s[82:83]
    s_nop 1
    v_mfma_f32_4x4x4_16b_bf16 v[88:91], v[12:13], v[84:85], 0
    s_nop 1
    v_mfma_f32_4x4x4_16b_bf16 v[88:91], v[10:11], v[86:87], v[88:91]
    s_nop 4
    v_cvt_pk_bf16_f32 v88, v88, v89
    v_cvt_pk_bf16_f32 v89, v90, v91
    ds_pk_add_bf16 v7, v88 offset:65408
    ds_pk_add_bf16 v7, v89 offset:65412
    s_mov_b64 exec, s[54:55]
    s_branch L2_d111
L2_c112:
    s_lshl_b64 s[52:53], s[82:83], 1
    s_andn2_b64 s[52:53], s[52:53], s[80:81]
    s_andn2_b64 s[52:53], s[52:53], s[50:51]
    s_or_b64 s[80:81], s[80:81], s[52:53]
    s_not_b64 vcc, s[52:53]
    s_mov_b64 exec, -1
    v_cndmask_b32_dpp v84, v84, v84, vcc wave_shr:1 row_mask:0xf bank_mask:0xf
    v_cndmask_b32_dpp v85, v85, v85, vcc wave_shr:1 row_mask:0xf bank_mask:0xf
    s_lshr_b64 s[52:53], s[52:53], 1
    v_cndmask_b32_dpp v86, v86, v86, vcc wave_shr:1 row_mask:0xf bank_mask:0xf
    v_cndmask_b32_dpp v87, v87, v87, vcc wave_shr:1 row_mask:0xf bank_mask:0xf
    s_andn2_b64 s[82:83], s[82:83], s[52:53]
    v_cndmask_b32_dpp v7, v7, v7, vcc wave_shr:1 row_mask:0xf bank_mask:0xf
    s_mov_b64 exec, s[50:51]
    s_cbranch_scc0 L2_d112
    s_mov_b64 exec, s[82:83]
    s_nop 1
    v_mfma_f32_4x4x4_16b_bf16 v[88:91], v[12:13], v[84:85], 0
    s_nop 1
    v_mfma_f32_4x4x4_16b_bf16 v[88:91], v[10:11], v[86:87], v[88:91]
    s_nop 4
    v_cvt_pk_bf16_f32 v88, v88, v89
    v_cvt_pk_bf16_f32 v89, v90, v91
    ds_pk_add_bf16 v7, v88 offset:65408
    ds_pk_add_bf16 v7, v89 offset:65412
    s_mov_b64 exec, s[50:51]
    s_branch L2_d112
L2_c113:
    s_lshl_b64 s[52:53], s[82:83], 1
    s_andn2_b64 s[52:53], s[52:53], s[80:81]
    s_andn2_b64 s[52:53], s[52:53], s[54:55]
    s_or_b64 s[80:81], s[80:81], s[52:53]
    s_not_b64 vcc, s[52:53]
    s_mov_b64 exec, -1
    v_cndmask_b32_dpp v84, v84, v84, vcc wave_shr:1 row_mask:0xf bank_mask:0xf
    v_cndmask_b32_dpp v85, v85, v85, vcc wave_shr:1 row_mask:0xf bank_mask:0xf
    s_lshr_b64 s[52:53], s[52:53], 1
    v_cndmask_b32_dpp v86, v86, v86, vcc wave_shr:1 row_mask:0xf bank_mask:0xf
    v_cndmask_b32_dpp v87, v87, v87, vcc wave_shr:1 row_mask:0xf bank_mask:0xf
    s_andn2_b64 s[82:83], s[82:83], s[52:53]
    v_cndmask_b32_dpp v7, v7, v7, vcc wave_shr:1 row_mask:0xf bank_mask:0xf
    s_mov_b64 exec, s[54:55]
    s_cbranch_scc0 L2_d113
    s_mov_b64 exec, s[82:83]
    s_nop 1
    v_mfma_f32_4x4x4_16b_bf16 v[88:91], v[12:13], v[84:85], 0
    s_nop 1
    v_mfma_f32_4x4x4_16b_bf16 v[88:91], v[10:11], v[86:87], v[88:91]
    s_nop 4
    v_cvt_pk_bf16_f32 v88, v88, v89
    v_cvt_pk_bf16_f32 v89, v90, v91
    ds_pk_add_bf16 v7, v88 offset:65408
    ds_pk_add_bf16 v7, v89 offset:65412
    s_mov_b64 exec, s[54:55]
    s_branch L2_d113
L2_c114:
    s_lshl_b64 s[52:53], s[82:83], 1
    s_andn2_b64 s[52:53], s[52:53], s[80:81]
    s_andn2_b64 s[52:53], s[52:53], s[50:51]
    s_or_b64 s[80:81], s[80:81], s[52:53]
    s_not_b64 vcc, s[52:53]
    s_mov_b64 exec, -1
    v_cndmask_b32_dpp v84, v84, v84, vcc wave_shr:1 row_mask:0xf bank_mask:0xf
    v_cndmask_b32_dpp v85, v85, v85, vcc wave_shr:1 row_mask:0xf bank_mask:0xf
    s_lshr_b64 s[52:53], s[52:53], 1
    v_cndmask_b32_dpp v86, v86, v86, vcc wave_shr:1 row_mask:0xf bank_mask:0xf
    v_cndmask_b32_dpp v87, v87, v87, vcc wave_shr:1 row_mask:0xf bank_mask:0xf
    s_andn2_b64 s[82:83], s[82:83], s[52:53]
    v_cndmask_b32_dpp v7, v7, v7, vcc wave_shr:1 row_mask:0xf bank_mask:0xf
    s_mov_b64 exec, s[50:51]
    s_cbranch_scc0 L2_d114
    s_mov_b64 exec, s[82:83]
    s_nop 1
    v_mfma_f32_4x4x4_16b_bf16 v[88:91], v[12:13], v[84:85], 0
    s_nop 1
    v_mfma_f32_4x4x4_16b_bf16 v[88:91], v[10:11], v[86:87], v[88:91]
    s_nop 4
    v_cvt_pk_bf16_f32 v88, v88, v89
    v_cvt_pk_bf16_f32 v89, v90, v91
    ds_pk_add_bf16 v7, v88 offset:65408
    ds_pk_add_bf16 v7, v89 offset:65412
    s_mov_b64 exec, s[50:51]
    s_branch L2_d114
L2_xa115:
    s_cmp_eq_u32 s101, 1
    s_cbranch_scc1 L2_xc115
    v_lshlrev_b32 v89, 0, v96
    v_add_u32 v90, 140, v97
    v_bitop3_b32 v90, v89, v45, v90 bitop3:0x6a
    ds_write_b32 v98, v90 offset:28
    v_lshlrev_b32 v89, 4, v96
    v_add_u32 v90, 120, v97
    v_bitop3_b32 v90, v89, v45, v90 bitop3:0x6a
    ds_write_b32 v98, v90 offset:24
    v_lshlrev_b32 v89, 8, v96
    v_add_u32 v90, 100, v97
    v_bitop3_b32 v90, v89, v45, v90 bitop3:0x6a
    ds_write_b32 v98, v90 offset:20
L2_xc115:
    v_lshlrev_b32 v89, 12, v96
    v_add_u32 v90, 80, v97
    v_bitop3_b32 v90, v89, v45, v90 bitop3:0x6a
    ds_write_b32 v98, v90 offset:16
    s_branch L2_xb115
L2_xe115:
    v_cmp_lt_u32 vcc, 32, v99
    v_cmp_lt_u32 s[58:59], 31, v88
    v_lshrrev_b32 v89, 16, v96
    v_add_u32 v97, 80, v97
    s_or_b64 vcc, vcc, s[58:59]
    s_cbranch_scc1 L2_xs115
    v_lshlrev_b32 v89, v1, v89
    v_and_b32 v89, v45, v89
    v_cmp_ne_u32 vcc, 0, v89
    v_xor_b32 v90, v97, v89
    s_add_u32 s3, s37, s38
    v_mbcnt_lo_u32_b32 v98, vcc_lo, 0
    v_mbcnt_hi_u32_b32 v98, vcc_hi, v98
    s_bcnt1_i32_b64 s41, vcc
    v_lshl_add_u32 v98, v98, 2, s3
    s_lshl2_add_u32 s37, s41, s37
    s_mov_b64 exec, vcc
    ds_write_b32 v98, v90
    s_mov_b64 exec, -1
    s_branch L2_xr115
L2_xf115:
    s_waitcnt lgkmcnt(0)
    s_cmp_gt_u32 s37, 1024
    s_cbranch_scc1 L2_xs115
    s_cmp_lt_u32 s37, 768
    s_cbranch_scc1 L2_xl115
    ds_read_b32 v33, v98 offset:896
    s_add_u32 s3, s42, 2
    s_bitset1_b32 s43, s3
    s_branch L2_xg115
L2_xl115:
    v_mov_b32 v42, -1
    s_cmp_ge_u32 s37, 512
    s_cbranch_scc1 L2_xg115
    v_mov_b32 v43, -1
    s_cmp_ge_u32 s37, 256
    s_cbranch_scc1 L2_xg115
    v_mov_b32 v41, -1
    s_branch L2_xg115
L2_xs115:
    s_waitcnt lgkmcnt(0)
    v_mov_b32 v40, -1
    v_mov_b32 v41, -1
    v_mov_b32 v43, -1
    v_mov_b32 v42, -1
    s_add_u32 s3, s42, 2
    s_bitset1_b32 s36, s3
    s_branch L2_xg115
L2_c116:
    s_lshl_b64 s[52:53], s[82:83], 1
    s_andn2_b64 s[52:53], s[52:53], s[80:81]
    s_andn2_b64 s[52:53], s[52:53], s[54:55]
    s_or_b64 s[80:81], s[80:81], s[52:53]
    s_not_b64 vcc, s[52:53]
    s_mov_b64 exec, -1
    v_cndmask_b32_dpp v84, v84, v84, vcc wave_shr:1 row_mask:0xf bank_mask:0xf
    v_cndmask_b32_dpp v85, v85, v85, vcc wave_shr:1 row_mask:0xf bank_mask:0xf
    s_lshr_b64 s[52:53], s[52:53], 1
    v_cndmask_b32_dpp v86, v86, v86, vcc wave_shr:1 row_mask:0xf bank_mask:0xf
    v_cndmask_b32_dpp v87, v87, v87, vcc wave_shr:1 row_mask:0xf bank_mask:0xf
    s_andn2_b64 s[82:83], s[82:83], s[52:53]
    v_cndmask_b32_dpp v7, v7, v7, vcc wave_shr:1 row_mask:0xf bank_mask:0xf
    s_mov_b64 exec, s[54:55]
    s_cbranch_scc0 L2_d116
    s_mov_b64 exec, s[82:83]
    s_nop 1
    v_mfma_f32_4x4x4_16b_bf16 v[88:91], v[12:13], v[84:85], 0
    s_nop 1
    v_mfma_f32_4x4x4_16b_bf16 v[88:91], v[10:11], v[86:87], v[88:91]
    s_nop 4
    v_cvt_pk_bf16_f32 v88, v88, v89
    v_cvt_pk_bf16_f32 v89, v90, v91
    ds_pk_add_bf16 v7, v88 offset:65408
    ds_pk_add_bf16 v7, v89 offset:65412
    s_mov_b64 exec, s[54:55]
    s_branch L2_d116
L2_c117:
    s_lshl_b64 s[52:53], s[82:83], 1
    s_andn2_b64 s[52:53], s[52:53], s[80:81]
    s_andn2_b64 s[52:53], s[52:53], s[50:51]
    s_or_b64 s[80:81], s[80:81], s[52:53]
    s_not_b64 vcc, s[52:53]
    s_mov_b64 exec, -1
    v_cndmask_b32_dpp v84, v84, v84, vcc wave_shr:1 row_mask:0xf bank_mask:0xf
    v_cndmask_b32_dpp v85, v85, v85, vcc wave_shr:1 row_mask:0xf bank_mask:0xf
    s_lshr_b64 s[52:53], s[52:53], 1
    v_cndmask_b32_dpp v86, v86, v86, vcc wave_shr:1 row_mask:0xf bank_mask:0xf
    v_cndmask_b32_dpp v87, v87, v87, vcc wave_shr:1 row_mask:0xf bank_mask:0xf
    s_andn2_b64 s[82:83], s[82:83], s[52:53]
    v_cndmask_b32_dpp v7, v7, v7, vcc wave_shr:1 row_mask:0xf bank_mask:0xf
    s_mov_b64 exec, s[50:51]
    s_cbranch_scc0 L2_d117
    s_mov_b64 exec, s[82:83]
    s_nop 1
    v_mfma_f32_4x4x4_16b_bf16 v[88:91], v[12:13], v[84:85], 0
    s_nop 1
    v_mfma_f32_4x4x4_16b_bf16 v[88:91], v[10:11], v[86:87], v[88:91]
    s_nop 4
    v_cvt_pk_bf16_f32 v88, v88, v89
    v_cvt_pk_bf16_f32 v89, v90, v91
    ds_pk_add_bf16 v7, v88 offset:65408
    ds_pk_add_bf16 v7, v89 offset:65412
    s_mov_b64 exec, s[50:51]
    s_branch L2_d117
L2_oa118:
    v_and_b32 v47, 0x0fffffff, v32
    buffer_load_dword v114, v47, s[8:11], 0 offen offset:16
    s_mov_b64 exec, s[6:7]
    v_add_u32 v47, 8, v47
    v_lshrrev_b32 v32, 2, v32
    s_mov_b64 exec, -1
    buffer_load_dwordx2 v[112:113], v47, s[8:11], 0 offen
    s_branch L2_ob118
L2_c119:
    s_lshl_b64 s[52:53], s[82:83], 1
    s_andn2_b64 s[52:53], s[52:53], s[80:81]
    s_andn2_b64 s[52:53], s[52:53], s[54:55]
    s_or_b64 s[80:81], s[80:81], s[52:53]
    s_not_b64 vcc, s[52:53]
    s_mov_b64 exec, -1
    v_cndmask_b32_dpp v84, v84, v84, vcc wave_shr:1 row_mask:0xf bank_mask:0xf
    v_cndmask_b32_dpp v85, v85, v85, vcc wave_shr:1 row_mask:0xf bank_mask:0xf
    s_lshr_b64 s[52:53], s[52:53], 1
    v_cndmask_b32_dpp v86, v86, v86, vcc wave_shr:1 row_mask:0xf bank_mask:0xf
    v_cndmask_b32_dpp v87, v87, v87, vcc wave_shr:1 row_mask:0xf bank_mask:0xf
    s_andn2_b64 s[82:83], s[82:83], s[52:53]
    v_cndmask_b32_dpp v7, v7, v7, vcc wave_shr:1 row_mask:0xf bank_mask:0xf
    s_mov_b64 exec, s[54:55]
    s_cbranch_scc0 L2_d119
    s_mov_b64 exec, s[82:83]
    s_nop 1
    v_mfma_f32_4x4x4_16b_bf16 v[88:91], v[12:13], v[84:85], 0
    s_nop 1
    v_mfma_f32_4x4x4_16b_bf16 v[88:91], v[10:11], v[86:87], v[88:91]
    s_nop 4
    v_cvt_pk_bf16_f32 v88, v88, v89
    v_cvt_pk_bf16_f32 v89, v90, v91
    ds_pk_add_bf16 v7, v88 offset:65408
    ds_pk_add_bf16 v7, v89 offset:65412
    s_mov_b64 exec, s[54:55]
    s_branch L2_d119
L2_c120:
    s_lshl_b64 s[52:53], s[82:83], 1
    s_andn2_b64 s[52:53], s[52:53], s[80:81]
    s_andn2_b64 s[52:53], s[52:53], s[50:51]
    s_or_b64 s[80:81], s[80:81], s[52:53]
    s_not_b64 vcc, s[52:53]
    s_mov_b64 exec, -1
    v_cndmask_b32_dpp v84, v84, v84, vcc wave_shr:1 row_mask:0xf bank_mask:0xf
    v_cndmask_b32_dpp v85, v85, v85, vcc wave_shr:1 row_mask:0xf bank_mask:0xf
    s_lshr_b64 s[52:53], s[52:53], 1
    v_cndmask_b32_dpp v86, v86, v86, vcc wave_shr:1 row_mask:0xf bank_mask:0xf
    v_cndmask_b32_dpp v87, v87, v87, vcc wave_shr:1 row_mask:0xf bank_mask:0xf
    s_andn2_b64 s[82:83], s[82:83], s[52:53]
    v_cndmask_b32_dpp v7, v7, v7, vcc wave_shr:1 row_mask:0xf bank_mask:0xf
    s_mov_b64 exec, s[50:51]
    s_cbranch_scc0 L2_d120
    s_mov_b64 exec, s[82:83]
    s_nop 1
    v_mfma_f32_4x4x4_16b_bf16 v[88:91], v[12:13], v[84:85], 0
    s_nop 1
    v_mfma_f32_4x4x4_16b_bf16 v[88:91], v[10:11], v[86:87], v[88:91]
    s_nop 4
    v_cvt_pk_bf16_f32 v88, v88, v89
    v_cvt_pk_bf16_f32 v89, v90, v91
    ds_pk_add_bf16 v7, v88 offset:65408
    ds_pk_add_bf16 v7, v89 offset:65412
    s_mov_b64 exec, s[50:51]
    s_branch L2_d120
L2_c121:
    s_lshl_b64 s[52:53], s[82:83], 1
    s_andn2_b64 s[52:53], s[52:53], s[80:81]
    s_andn2_b64 s[52:53], s[52:53], s[54:55]
    s_or_b64 s[80:81], s[80:81], s[52:53]
    s_not_b64 vcc, s[52:53]
    s_mov_b64 exec, -1
    v_cndmask_b32_dpp v84, v84, v84, vcc wave_shr:1 row_mask:0xf bank_mask:0xf
    v_cndmask_b32_dpp v85, v85, v85, vcc wave_shr:1 row_mask:0xf bank_mask:0xf
    s_lshr_b64 s[52:53], s[52:53], 1
    v_cndmask_b32_dpp v86, v86, v86, vcc wave_shr:1 row_mask:0xf bank_mask:0xf
    v_cndmask_b32_dpp v87, v87, v87, vcc wave_shr:1 row_mask:0xf bank_mask:0xf
    s_andn2_b64 s[82:83], s[82:83], s[52:53]
    v_cndmask_b32_dpp v7, v7, v7, vcc wave_shr:1 row_mask:0xf bank_mask:0xf
    s_mov_b64 exec, s[54:55]
    s_cbranch_scc0 L2_d121
    s_mov_b64 exec, s[82:83]
    s_nop 1
    v_mfma_f32_4x4x4_16b_bf16 v[88:91], v[12:13], v[84:85], 0
    s_nop 1
    v_mfma_f32_4x4x4_16b_bf16 v[88:91], v[10:11], v[86:87], v[88:91]
    s_nop 4
    v_cvt_pk_bf16_f32 v88, v88, v89
    v_cvt_pk_bf16_f32 v89, v90, v91
    ds_pk_add_bf16 v7, v88 offset:65408
    ds_pk_add_bf16 v7, v89 offset:65412
    s_mov_b64 exec, s[54:55]
    s_branch L2_d121
L2_c122:
    s_lshl_b64 s[52:53], s[82:83], 1
    s_andn2_b64 s[52:53], s[52:53], s[80:81]
    s_andn2_b64 s[52:53], s[52:53], s[50:51]
    s_or_b64 s[80:81], s[80:81], s[52:53]
    s_not_b64 vcc, s[52:53]
    s_mov_b64 exec, -1
    v_cndmask_b32_dpp v84, v84, v84, vcc wave_shr:1 row_mask:0xf bank_mask:0xf
    v_cndmask_b32_dpp v85, v85, v85, vcc wave_shr:1 row_mask:0xf bank_mask:0xf
    s_lshr_b64 s[52:53], s[52:53], 1
    v_cndmask_b32_dpp v86, v86, v86, vcc wave_shr:1 row_mask:0xf bank_mask:0xf
    v_cndmask_b32_dpp v87, v87, v87, vcc wave_shr:1 row_mask:0xf bank_mask:0xf
    s_andn2_b64 s[82:83], s[82:83], s[52:53]
    v_cndmask_b32_dpp v7, v7, v7, vcc wave_shr:1 row_mask:0xf bank_mask:0xf
    s_mov_b64 exec, s[50:51]
    s_cbranch_scc0 L2_d122
    s_mov_b64 exec, s[82:83]
    s_nop 1
    v_mfma_f32_4x4x4_16b_bf16 v[88:91], v[12:13], v[84:85], 0
    s_nop 1
    v_mfma_f32_4x4x4_16b_bf16 v[88:91], v[10:11], v[86:87], v[88:91]
    s_nop 4
    v_cvt_pk_bf16_f32 v88, v88, v89
    v_cvt_pk_bf16_f32 v89, v90, v91
    ds_pk_add_bf16 v7, v88 offset:65408
    ds_pk_add_bf16 v7, v89 offset:65412
    s_mov_b64 exec, s[50:51]
    s_branch L2_d122
L2_c123:
    s_lshl_b64 s[52:53], s[82:83], 1
    s_andn2_b64 s[52:53], s[52:53], s[80:81]
    s_andn2_b64 s[52:53], s[52:53], s[54:55]
    s_or_b64 s[80:81], s[80:81], s[52:53]
    s_not_b64 vcc, s[52:53]
    s_mov_b64 exec, -1
    v_cndmask_b32_dpp v84, v84, v84, vcc wave_shr:1 row_mask:0xf bank_mask:0xf
    v_cndmask_b32_dpp v85, v85, v85, vcc wave_shr:1 row_mask:0xf bank_mask:0xf
    s_lshr_b64 s[52:53], s[52:53], 1
    v_cndmask_b32_dpp v86, v86, v86, vcc wave_shr:1 row_mask:0xf bank_mask:0xf
    v_cndmask_b32_dpp v87, v87, v87, vcc wave_shr:1 row_mask:0xf bank_mask:0xf
    s_andn2_b64 s[82:83], s[82:83], s[52:53]
    v_cndmask_b32_dpp v7, v7, v7, vcc wave_shr:1 row_mask:0xf bank_mask:0xf
    s_mov_b64 exec, s[54:55]
    s_cbranch_scc0 L2_d123
    s_mov_b64 exec, s[82:83]
    s_nop 1
    v_mfma_f32_4x4x4_16b_bf16 v[88:91], v[12:13], v[84:85], 0
    s_nop 1
    v_mfma_f32_4x4x4_16b_bf16 v[88:91], v[10:11], v[86:87], v[88:91]
    s_nop 4
    v_cvt_pk_bf16_f32 v88, v88, v89
    v_cvt_pk_bf16_f32 v89, v90, v91
    ds_pk_add_bf16 v7, v88 offset:65408
    ds_pk_add_bf16 v7, v89 offset:65412
    s_mov_b64 exec, s[54:55]
    s_branch L2_d123
L2_c124:
    s_lshl_b64 s[52:53], s[82:83], 1
    s_andn2_b64 s[52:53], s[52:53], s[80:81]
    s_andn2_b64 s[52:53], s[52:53], s[50:51]
    s_or_b64 s[80:81], s[80:81], s[52:53]
    s_not_b64 vcc, s[52:53]
    s_mov_b64 exec, -1
    v_cndmask_b32_dpp v84, v84, v84, vcc wave_shr:1 row_mask:0xf bank_mask:0xf
    v_cndmask_b32_dpp v85, v85, v85, vcc wave_shr:1 row_mask:0xf bank_mask:0xf
    s_lshr_b64 s[52:53], s[52:53], 1
    v_cndmask_b32_dpp v86, v86, v86, vcc wave_shr:1 row_mask:0xf bank_mask:0xf
    v_cndmask_b32_dpp v87, v87, v87, vcc wave_shr:1 row_mask:0xf bank_mask:0xf
    s_andn2_b64 s[82:83], s[82:83], s[52:53]
    v_cndmask_b32_dpp v7, v7, v7, vcc wave_shr:1 row_mask:0xf bank_mask:0xf
    s_mov_b64 exec, s[50:51]
    s_cbranch_scc0 L2_d124
    s_mov_b64 exec, s[82:83]
    s_nop 1
    v_mfma_f32_4x4x4_16b_bf16 v[88:91], v[12:13], v[84:85], 0
    s_nop 1
    v_mfma_f32_4x4x4_16b_bf16 v[88:91], v[10:11], v[86:87], v[88:91]
    s_nop 4
    v_cvt_pk_bf16_f32 v88, v88, v89
    v_cvt_pk_bf16_f32 v89, v90, v91
    ds_pk_add_bf16 v7, v88 offset:65408
    ds_pk_add_bf16 v7, v89 offset:65412
    s_mov_b64 exec, s[50:51]
    s_branch L2_d124
L2_oa125:
    s_waitcnt vmcnt(3)
    s_mov_b64 exec, s[6:7]
    v_lshrrev_b32 v114, 16, v114
    s_mov_b64 exec, -1
    v_and_b32 v46, 0x10000000, v32
    v_cmpx_eq_u32 vcc, 0, v46
    v_lshrrev_b32 v47, 14, v112
    v_and_b32 v47, v5, v47
    ds_read_b64 v[96:97], v47
    v_perm_b32 v98, v112, v114, s44
    v_bitop3_b32 v99, v112, 0.5, -0.5 bitop3:0xa8
    v_bitop3_b32 v98, v6, v98, v99 bitop3:0xca
    v_and_b32 v47, v5, v112
    s_waitcnt lgkmcnt(0)
    v_mfma_f32_4x4x4_16b_bf16 v[88:91], v[8:9], v[96:97], 0
    s_nop 4
    v_mul_f32 v88, v98, v88
    v_mul_f32 v89, v98, v89
    v_mul_f32 v90, v98, v90
    v_mul_f32 v91, v98, v91
    v_cvt_pk_bf16_f32 v88, v88, v89
    v_cvt_pk_bf16_f32 v89, v90, v91
    ds_pk_add_bf16 v47, v88 offset:65408
    ds_pk_add_bf16 v47, v89 offset:65412
    s_mov_b64 exec, -1
    v_and_b32 v46, 0x20000000, v32
    v_cmpx_eq_u32 vcc, 0, v46
    v_lshrrev_b32 v47, 14, v113
    v_and_b32 v47, v5, v47
    ds_read_b64 v[96:97], v47
    v_perm_b32 v98, v113, v114, s45
    v_bitop3_b32 v99, v113, 0.5, -0.5 bitop3:0xa8
    v_bitop3_b32 v98, v6, v98, v99 bitop3:0xca
    v_and_b32 v47, v5, v113
    s_waitcnt lgkmcnt(0)
    v_mfma_f32_4x4x4_16b_bf16 v[88:91], v[8:9], v[96:97], 0
    s_nop 4
    v_mul_f32 v88, v98, v88
    v_mul_f32 v89, v98, v89
    v_mul_f32 v90, v98, v90
    v_mul_f32 v91, v98, v91
    v_cvt_pk_bf16_f32 v88, v88, v89
    v_cvt_pk_bf16_f32 v89, v90, v91
    ds_pk_add_bf16 v47, v88 offset:65408
    ds_pk_add_bf16 v47, v89 offset:65412
    s_mov_b64 exec, -1
    s_branch L2_ob125
L2_c126:
    s_lshl_b64 s[52:53], s[82:83], 1
    s_andn2_b64 s[52:53], s[52:53], s[80:81]
    s_andn2_b64 s[52:53], s[52:53], s[54:55]
    s_or_b64 s[80:81], s[80:81], s[52:53]
    s_not_b64 vcc, s[52:53]
    s_mov_b64 exec, -1
    v_cndmask_b32_dpp v84, v84, v84, vcc wave_shr:1 row_mask:0xf bank_mask:0xf
    v_cndmask_b32_dpp v85, v85, v85, vcc wave_shr:1 row_mask:0xf bank_mask:0xf
    s_lshr_b64 s[52:53], s[52:53], 1
    v_cndmask_b32_dpp v86, v86, v86, vcc wave_shr:1 row_mask:0xf bank_mask:0xf
    v_cndmask_b32_dpp v87, v87, v87, vcc wave_shr:1 row_mask:0xf bank_mask:0xf
    s_andn2_b64 s[82:83], s[82:83], s[52:53]
    v_cndmask_b32_dpp v7, v7, v7, vcc wave_shr:1 row_mask:0xf bank_mask:0xf
    s_mov_b64 exec, s[54:55]
    s_cbranch_scc0 L2_d126
    s_mov_b64 exec, s[82:83]
    s_nop 1
    v_mfma_f32_4x4x4_16b_bf16 v[88:91], v[12:13], v[84:85], 0
    s_nop 1
    v_mfma_f32_4x4x4_16b_bf16 v[88:91], v[10:11], v[86:87], v[88:91]
    s_nop 4
    v_cvt_pk_bf16_f32 v88, v88, v89
    v_cvt_pk_bf16_f32 v89, v90, v91
    ds_pk_add_bf16 v7, v88 offset:65408
    ds_pk_add_bf16 v7, v89 offset:65412
    s_mov_b64 exec, s[54:55]
    s_branch L2_d126
L2_c127:
    s_lshl_b64 s[52:53], s[82:83], 1
    s_andn2_b64 s[52:53], s[52:53], s[80:81]
    s_andn2_b64 s[52:53], s[52:53], s[50:51]
    s_or_b64 s[80:81], s[80:81], s[52:53]
    s_not_b64 vcc, s[52:53]
    s_mov_b64 exec, -1
    v_cndmask_b32_dpp v84, v84, v84, vcc wave_shr:1 row_mask:0xf bank_mask:0xf
    v_cndmask_b32_dpp v85, v85, v85, vcc wave_shr:1 row_mask:0xf bank_mask:0xf
    s_lshr_b64 s[52:53], s[52:53], 1
    v_cndmask_b32_dpp v86, v86, v86, vcc wave_shr:1 row_mask:0xf bank_mask:0xf
    v_cndmask_b32_dpp v87, v87, v87, vcc wave_shr:1 row_mask:0xf bank_mask:0xf
    s_andn2_b64 s[82:83], s[82:83], s[52:53]
    v_cndmask_b32_dpp v7, v7, v7, vcc wave_shr:1 row_mask:0xf bank_mask:0xf
    s_mov_b64 exec, s[50:51]
    s_cbranch_scc0 L2_d127
    s_mov_b64 exec, s[82:83]
    s_nop 1
    v_mfma_f32_4x4x4_16b_bf16 v[88:91], v[12:13], v[84:85], 0
    s_nop 1
    v_mfma_f32_4x4x4_16b_bf16 v[88:91], v[10:11], v[86:87], v[88:91]
    s_nop 4
    v_cvt_pk_bf16_f32 v88, v88, v89
    v_cvt_pk_bf16_f32 v89, v90, v91
    ds_pk_add_bf16 v7, v88 offset:65408
    ds_pk_add_bf16 v7, v89 offset:65412
    s_mov_b64 exec, s[50:51]
    s_branch L2_d127
L2_c128:
    s_lshl_b64 s[52:53], s[82:83], 1
    s_andn2_b64 s[52:53], s[52:53], s[80:81]
    s_andn2_b64 s[52:53], s[52:53], s[54:55]
    s_or_b64 s[80:81], s[80:81], s[52:53]
    s_not_b64 vcc, s[52:53]
    s_mov_b64 exec, -1
    v_cndmask_b32_dpp v84, v84, v84, vcc wave_shr:1 row_mask:0xf bank_mask:0xf
    v_cndmask_b32_dpp v85, v85, v85, vcc wave_shr:1 row_mask:0xf bank_mask:0xf
    s_lshr_b64 s[52:53], s[52:53], 1
    v_cndmask_b32_dpp v86, v86, v86, vcc wave_shr:1 row_mask:0xf bank_mask:0xf
    v_cndmask_b32_dpp v87, v87, v87, vcc wave_shr:1 row_mask:0xf bank_mask:0xf
    s_andn2_b64 s[82:83], s[82:83], s[52:53]
    v_cndmask_b32_dpp v7, v7, v7, vcc wave_shr:1 row_mask:0xf bank_mask:0xf
    s_mov_b64 exec, s[54:55]
    s_cbranch_scc0 L2_d128
    s_mov_b64 exec, s[82:83]
    s_nop 1
    v_mfma_f32_4x4x4_16b_bf16 v[88:91], v[12:13], v[84:85], 0
    s_nop 1
    v_mfma_f32_4x4x4_16b_bf16 v[88:91], v[10:11], v[86:87], v[88:91]
    s_nop 4
    v_cvt_pk_bf16_f32 v88, v88, v89
    v_cvt_pk_bf16_f32 v89, v90, v91
    ds_pk_add_bf16 v7, v88 offset:65408
    ds_pk_add_bf16 v7, v89 offset:65412
    s_mov_b64 exec, s[54:55]
    s_branch L2_d128
L2_c129:
    s_lshl_b64 s[52:53], s[82:83], 1
    s_andn2_b64 s[52:53], s[52:53], s[80:81]
    s_andn2_b64 s[52:53], s[52:53], s[50:51]
    s_or_b64 s[80:81], s[80:81], s[52:53]
    s_not_b64 vcc, s[52:53]
    s_mov_b64 exec, -1
    v_cndmask_b32_dpp v84, v84, v84, vcc wave_shr:1 row_mask:0xf bank_mask:0xf
    v_cndmask_b32_dpp v85, v85, v85, vcc wave_shr:1 row_mask:0xf bank_mask:0xf
    s_lshr_b64 s[52:53], s[52:53], 1
    v_cndmask_b32_dpp v86, v86, v86, vcc wave_shr:1 row_mask:0xf bank_mask:0xf
    v_cndmask_b32_dpp v87, v87, v87, vcc wave_shr:1 row_mask:0xf bank_mask:0xf
    s_andn2_b64 s[82:83], s[82:83], s[52:53]
    v_cndmask_b32_dpp v7, v7, v7, vcc wave_shr:1 row_mask:0xf bank_mask:0xf
    s_mov_b64 exec, s[50:51]
    s_cbranch_scc0 L2_d129
    s_mov_b64 exec, s[82:83]
    s_nop 1
    v_mfma_f32_4x4x4_16b_bf16 v[88:91], v[12:13], v[84:85], 0
    s_nop 1
    v_mfma_f32_4x4x4_16b_bf16 v[88:91], v[10:11], v[86:87], v[88:91]
    s_nop 4
    v_cvt_pk_bf16_f32 v88, v88, v89
    v_cvt_pk_bf16_f32 v89, v90, v91
    ds_pk_add_bf16 v7, v88 offset:65408
    ds_pk_add_bf16 v7, v89 offset:65412
    s_mov_b64 exec, s[50:51]
    s_branch L2_d129
L2_c130:
    s_lshl_b64 s[52:53], s[82:83], 1
    s_andn2_b64 s[52:53], s[52:53], s[80:81]
    s_andn2_b64 s[52:53], s[52:53], s[54:55]
    s_or_b64 s[80:81], s[80:81], s[52:53]
    s_not_b64 vcc, s[52:53]
    s_mov_b64 exec, -1
    v_cndmask_b32_dpp v84, v84, v84, vcc wave_shr:1 row_mask:0xf bank_mask:0xf
    v_cndmask_b32_dpp v85, v85, v85, vcc wave_shr:1 row_mask:0xf bank_mask:0xf
    s_lshr_b64 s[52:53], s[52:53], 1
    v_cndmask_b32_dpp v86, v86, v86, vcc wave_shr:1 row_mask:0xf bank_mask:0xf
    v_cndmask_b32_dpp v87, v87, v87, vcc wave_shr:1 row_mask:0xf bank_mask:0xf
    s_andn2_b64 s[82:83], s[82:83], s[52:53]
    v_cndmask_b32_dpp v7, v7, v7, vcc wave_shr:1 row_mask:0xf bank_mask:0xf
    s_mov_b64 exec, s[54:55]
    s_cbranch_scc0 L2_d130
    s_mov_b64 exec, s[82:83]
    s_nop 1
    v_mfma_f32_4x4x4_16b_bf16 v[88:91], v[12:13], v[84:85], 0
    s_nop 1
    v_mfma_f32_4x4x4_16b_bf16 v[88:91], v[10:11], v[86:87], v[88:91]
    s_nop 4
    v_cvt_pk_bf16_f32 v88, v88, v89
    v_cvt_pk_bf16_f32 v89, v90, v91
    ds_pk_add_bf16 v7, v88 offset:65408
    ds_pk_add_bf16 v7, v89 offset:65412
    s_mov_b64 exec, s[54:55]
    s_branch L2_d130
L2_c131:
    s_lshl_b64 s[52:53], s[82:83], 1
    s_andn2_b64 s[52:53], s[52:53], s[80:81]
    s_andn2_b64 s[52:53], s[52:53], s[50:51]
    s_or_b64 s[80:81], s[80:81], s[52:53]
    s_not_b64 vcc, s[52:53]
    s_mov_b64 exec, -1
    v_cndmask_b32_dpp v84, v84, v84, vcc wave_shr:1 row_mask:0xf bank_mask:0xf
    v_cndmask_b32_dpp v85, v85, v85, vcc wave_shr:1 row_mask:0xf bank_mask:0xf
    s_lshr_b64 s[52:53], s[52:53], 1
    v_cndmask_b32_dpp v86, v86, v86, vcc wave_shr:1 row_mask:0xf bank_mask:0xf
    v_cndmask_b32_dpp v87, v87, v87, vcc wave_shr:1 row_mask:0xf bank_mask:0xf
    s_andn2_b64 s[82:83], s[82:83], s[52:53]
    v_cndmask_b32_dpp v7, v7, v7, vcc wave_shr:1 row_mask:0xf bank_mask:0xf
    s_mov_b64 exec, s[50:51]
    s_cbranch_scc0 L2_d131
    s_mov_b64 exec, s[82:83]
    s_nop 1
    v_mfma_f32_4x4x4_16b_bf16 v[88:91], v[12:13], v[84:85], 0
    s_nop 1
    v_mfma_f32_4x4x4_16b_bf16 v[88:91], v[10:11], v[86:87], v[88:91]
    s_nop 4
    v_cvt_pk_bf16_f32 v88, v88, v89
    v_cvt_pk_bf16_f32 v89, v90, v91
    ds_pk_add_bf16 v7, v88 offset:65408
    ds_pk_add_bf16 v7, v89 offset:65412
    s_mov_b64 exec, s[50:51]
    s_branch L2_d131
L2_c132:
    s_lshl_b64 s[52:53], s[82:83], 1
    s_andn2_b64 s[52:53], s[52:53], s[80:81]
    s_andn2_b64 s[52:53], s[52:53], s[54:55]
    s_or_b64 s[80:81], s[80:81], s[52:53]
    s_not_b64 vcc, s[52:53]
    s_mov_b64 exec, -1
    v_cndmask_b32_dpp v84, v84, v84, vcc wave_shr:1 row_mask:0xf bank_mask:0xf
    v_cndmask_b32_dpp v85, v85, v85, vcc wave_shr:1 row_mask:0xf bank_mask:0xf
    s_lshr_b64 s[52:53], s[52:53], 1
    v_cndmask_b32_dpp v86, v86, v86, vcc wave_shr:1 row_mask:0xf bank_mask:0xf
    v_cndmask_b32_dpp v87, v87, v87, vcc wave_shr:1 row_mask:0xf bank_mask:0xf
    s_andn2_b64 s[82:83], s[82:83], s[52:53]
    v_cndmask_b32_dpp v7, v7, v7, vcc wave_shr:1 row_mask:0xf bank_mask:0xf
    s_mov_b64 exec, s[54:55]
    s_cbranch_scc0 L2_d132
    s_mov_b64 exec, s[82:83]
    s_nop 1
    v_mfma_f32_4x4x4_16b_bf16 v[88:91], v[12:13], v[84:85], 0
    s_nop 1
    v_mfma_f32_4x4x4_16b_bf16 v[88:91], v[10:11], v[86:87], v[88:91]
    s_nop 4
    v_cvt_pk_bf16_f32 v88, v88, v89
    v_cvt_pk_bf16_f32 v89, v90, v91
    ds_pk_add_bf16 v7, v88 offset:65408
    ds_pk_add_bf16 v7, v89 offset:65412
    s_mov_b64 exec, s[54:55]
    s_branch L2_d132
L2_c133:
    s_lshl_b64 s[52:53], s[82:83], 1
    s_andn2_b64 s[52:53], s[52:53], s[80:81]
    s_andn2_b64 s[52:53], s[52:53], s[50:51]
    s_or_b64 s[80:81], s[80:81], s[52:53]
    s_not_b64 vcc, s[52:53]
    s_mov_b64 exec, -1
    v_cndmask_b32_dpp v84, v84, v84, vcc wave_shr:1 row_mask:0xf bank_mask:0xf
    v_cndmask_b32_dpp v85, v85, v85, vcc wave_shr:1 row_mask:0xf bank_mask:0xf
    s_lshr_b64 s[52:53], s[52:53], 1
    v_cndmask_b32_dpp v86, v86, v86, vcc wave_shr:1 row_mask:0xf bank_mask:0xf
    v_cndmask_b32_dpp v87, v87, v87, vcc wave_shr:1 row_mask:0xf bank_mask:0xf
    s_andn2_b64 s[82:83], s[82:83], s[52:53]
    v_cndmask_b32_dpp v7, v7, v7, vcc wave_shr:1 row_mask:0xf bank_mask:0xf
    s_mov_b64 exec, s[50:51]
    s_cbranch_scc0 L2_d133
    s_mov_b64 exec, s[82:83]
    s_nop 1
    v_mfma_f32_4x4x4_16b_bf16 v[88:91], v[12:13], v[84:85], 0
    s_nop 1
    v_mfma_f32_4x4x4_16b_bf16 v[88:91], v[10:11], v[86:87], v[88:91]
    s_nop 4
    v_cvt_pk_bf16_f32 v88, v88, v89
    v_cvt_pk_bf16_f32 v89, v90, v91
    ds_pk_add_bf16 v7, v88 offset:65408
    ds_pk_add_bf16 v7, v89 offset:65412
    s_mov_b64 exec, s[50:51]
    s_branch L2_d133
L2_oa134:
    v_and_b32 v47, 0x0fffffff, v33
    buffer_load_dword v114, v47, s[8:11], 0 offen offset:16
    s_mov_b64 exec, s[6:7]
    v_add_u32 v47, 8, v47
    v_lshrrev_b32 v33, 2, v33
    s_mov_b64 exec, -1
    buffer_load_dwordx2 v[112:113], v47, s[8:11], 0 offen
    s_branch L2_ob134
L2_c135:
    s_lshl_b64 s[52:53], s[82:83], 1
    s_andn2_b64 s[52:53], s[52:53], s[80:81]
    s_andn2_b64 s[52:53], s[52:53], s[54:55]
    s_or_b64 s[80:81], s[80:81], s[52:53]
    s_not_b64 vcc, s[52:53]
    s_mov_b64 exec, -1
    v_cndmask_b32_dpp v84, v84, v84, vcc wave_shr:1 row_mask:0xf bank_mask:0xf
    v_cndmask_b32_dpp v85, v85, v85, vcc wave_shr:1 row_mask:0xf bank_mask:0xf
    s_lshr_b64 s[52:53], s[52:53], 1
    v_cndmask_b32_dpp v86, v86, v86, vcc wave_shr:1 row_mask:0xf bank_mask:0xf
    v_cndmask_b32_dpp v87, v87, v87, vcc wave_shr:1 row_mask:0xf bank_mask:0xf
    s_andn2_b64 s[82:83], s[82:83], s[52:53]
    v_cndmask_b32_dpp v7, v7, v7, vcc wave_shr:1 row_mask:0xf bank_mask:0xf
    s_mov_b64 exec, s[54:55]
    s_cbranch_scc0 L2_d135
    s_mov_b64 exec, s[82:83]
    s_nop 1
    v_mfma_f32_4x4x4_16b_bf16 v[88:91], v[12:13], v[84:85], 0
    s_nop 1
    v_mfma_f32_4x4x4_16b_bf16 v[88:91], v[10:11], v[86:87], v[88:91]
    s_nop 4
    v_cvt_pk_bf16_f32 v88, v88, v89
    v_cvt_pk_bf16_f32 v89, v90, v91
    ds_pk_add_bf16 v7, v88 offset:65408
    ds_pk_add_bf16 v7, v89 offset:65412
    s_mov_b64 exec, s[54:55]
    s_branch L2_d135
L2_c136:
    s_lshl_b64 s[52:53], s[82:83], 1
    s_andn2_b64 s[52:53], s[52:53], s[80:81]
    s_andn2_b64 s[52:53], s[52:53], s[50:51]
    s_or_b64 s[80:81], s[80:81], s[52:53]
    s_not_b64 vcc, s[52:53]
    s_mov_b64 exec, -1
    v_cndmask_b32_dpp v84, v84, v84, vcc wave_shr:1 row_mask:0xf bank_mask:0xf
    v_cndmask_b32_dpp v85, v85, v85, vcc wave_shr:1 row_mask:0xf bank_mask:0xf
    s_lshr_b64 s[52:53], s[52:53], 1
    v_cndmask_b32_dpp v86, v86, v86, vcc wave_shr:1 row_mask:0xf bank_mask:0xf
    v_cndmask_b32_dpp v87, v87, v87, vcc wave_shr:1 row_mask:0xf bank_mask:0xf
    s_andn2_b64 s[82:83], s[82:83], s[52:53]
    v_cndmask_b32_dpp v7, v7, v7, vcc wave_shr:1 row_mask:0xf bank_mask:0xf
    s_mov_b64 exec, s[50:51]
    s_cbranch_scc0 L2_d136
    s_mov_b64 exec, s[82:83]
    s_nop 1
    v_mfma_f32_4x4x4_16b_bf16 v[88:91], v[12:13], v[84:85], 0
    s_nop 1
    v_mfma_f32_4x4x4_16b_bf16 v[88:91], v[10:11], v[86:87], v[88:91]
    s_nop 4
    v_cvt_pk_bf16_f32 v88, v88, v89
    v_cvt_pk_bf16_f32 v89, v90, v91
    ds_pk_add_bf16 v7, v88 offset:65408
    ds_pk_add_bf16 v7, v89 offset:65412
    s_mov_b64 exec, s[50:51]
    s_branch L2_d136
L2_c137:
    s_lshl_b64 s[52:53], s[82:83], 1
    s_andn2_b64 s[52:53], s[52:53], s[80:81]
    s_andn2_b64 s[52:53], s[52:53], s[54:55]
    s_or_b64 s[80:81], s[80:81], s[52:53]
    s_not_b64 vcc, s[52:53]
    s_mov_b64 exec, -1
    v_cndmask_b32_dpp v84, v84, v84, vcc wave_shr:1 row_mask:0xf bank_mask:0xf
    v_cndmask_b32_dpp v85, v85, v85, vcc wave_shr:1 row_mask:0xf bank_mask:0xf
    s_lshr_b64 s[52:53], s[52:53], 1
    v_cndmask_b32_dpp v86, v86, v86, vcc wave_shr:1 row_mask:0xf bank_mask:0xf
    v_cndmask_b32_dpp v87, v87, v87, vcc wave_shr:1 row_mask:0xf bank_mask:0xf
    s_andn2_b64 s[82:83], s[82:83], s[52:53]
    v_cndmask_b32_dpp v7, v7, v7, vcc wave_shr:1 row_mask:0xf bank_mask:0xf
    s_mov_b64 exec, s[54:55]
    s_cbranch_scc0 L2_d137
    s_mov_b64 exec, s[82:83]
    s_nop 1
    v_mfma_f32_4x4x4_16b_bf16 v[88:91], v[12:13], v[84:85], 0
    s_nop 1
    v_mfma_f32_4x4x4_16b_bf16 v[88:91], v[10:11], v[86:87], v[88:91]
    s_nop 4
    v_cvt_pk_bf16_f32 v88, v88, v89
    v_cvt_pk_bf16_f32 v89, v90, v91
    ds_pk_add_bf16 v7, v88 offset:65408
    ds_pk_add_bf16 v7, v89 offset:65412
    s_mov_b64 exec, s[54:55]
    s_branch L2_d137
L2_c138:
    s_lshl_b64 s[52:53], s[82:83], 1
    s_andn2_b64 s[52:53], s[52:53], s[80:81]
    s_andn2_b64 s[52:53], s[52:53], s[50:51]
    s_or_b64 s[80:81], s[80:81], s[52:53]
    s_not_b64 vcc, s[52:53]
    s_mov_b64 exec, -1
    v_cndmask_b32_dpp v84, v84, v84, vcc wave_shr:1 row_mask:0xf bank_mask:0xf
    v_cndmask_b32_dpp v85, v85, v85, vcc wave_shr:1 row_mask:0xf bank_mask:0xf
    s_lshr_b64 s[52:53], s[52:53], 1
    v_cndmask_b32_dpp v86, v86, v86, vcc wave_shr:1 row_mask:0xf bank_mask:0xf
    v_cndmask_b32_dpp v87, v87, v87, vcc wave_shr:1 row_mask:0xf bank_mask:0xf
    s_andn2_b64 s[82:83], s[82:83], s[52:53]
    v_cndmask_b32_dpp v7, v7, v7, vcc wave_shr:1 row_mask:0xf bank_mask:0xf
    s_mov_b64 exec, s[50:51]
    s_cbranch_scc0 L2_d138
    s_mov_b64 exec, s[82:83]
    s_nop 1
    v_mfma_f32_4x4x4_16b_bf16 v[88:91], v[12:13], v[84:85], 0
    s_nop 1
    v_mfma_f32_4x4x4_16b_bf16 v[88:91], v[10:11], v[86:87], v[88:91]
    s_nop 4
    v_cvt_pk_bf16_f32 v88, v88, v89
    v_cvt_pk_bf16_f32 v89, v90, v91
    ds_pk_add_bf16 v7, v88 offset:65408
    ds_pk_add_bf16 v7, v89 offset:65412
    s_mov_b64 exec, s[50:51]
    s_branch L2_d138
L2_c139:
    s_lshl_b64 s[52:53], s[82:83], 1
    s_andn2_b64 s[52:53], s[52:53], s[80:81]
    s_andn2_b64 s[52:53], s[52:53], s[54:55]
    s_or_b64 s[80:81], s[80:81], s[52:53]
    s_not_b64 vcc, s[52:53]
    s_mov_b64 exec, -1
    v_cndmask_b32_dpp v84, v84, v84, vcc wave_shr:1 row_mask:0xf bank_mask:0xf
    v_cndmask_b32_dpp v85, v85, v85, vcc wave_shr:1 row_mask:0xf bank_mask:0xf
    s_lshr_b64 s[52:53], s[52:53], 1
    v_cndmask_b32_dpp v86, v86, v86, vcc wave_shr:1 row_mask:0xf bank_mask:0xf
    v_cndmask_b32_dpp v87, v87, v87, vcc wave_shr:1 row_mask:0xf bank_mask:0xf
    s_andn2_b64 s[82:83], s[82:83], s[52:53]
    v_cndmask_b32_dpp v7, v7, v7, vcc wave_shr:1 row_mask:0xf bank_mask:0xf
    s_mov_b64 exec, s[54:55]
    s_cbranch_scc0 L2_d139
    s_mov_b64 exec, s[82:83]
    s_nop 1
    v_mfma_f32_4x4x4_16b_bf16 v[88:91], v[12:13], v[84:85], 0
    s_nop 1
    v_mfma_f32_4x4x4_16b_bf16 v[88:91], v[10:11], v[86:87], v[88:91]
    s_nop 4
    v_cvt_pk_bf16_f32 v88, v88, v89
    v_cvt_pk_bf16_f32 v89, v90, v91
    ds_pk_add_bf16 v7, v88 offset:65408
    ds_pk_add_bf16 v7, v89 offset:65412
    s_mov_b64 exec, s[54:55]
    s_branch L2_d139
L2_c140:
    s_lshl_b64 s[52:53], s[82:83], 1
    s_andn2_b64 s[52:53], s[52:53], s[80:81]
    s_andn2_b64 s[52:53], s[52:53], s[50:51]
    s_or_b64 s[80:81], s[80:81], s[52:53]
    s_not_b64 vcc, s[52:53]
    s_mov_b64 exec, -1
    v_cndmask_b32_dpp v84, v84, v84, vcc wave_shr:1 row_mask:0xf bank_mask:0xf
    v_cndmask_b32_dpp v85, v85, v85, vcc wave_shr:1 row_mask:0xf bank_mask:0xf
    s_lshr_b64 s[52:53], s[52:53], 1
    v_cndmask_b32_dpp v86, v86, v86, vcc wave_shr:1 row_mask:0xf bank_mask:0xf
    v_cndmask_b32_dpp v87, v87, v87, vcc wave_shr:1 row_mask:0xf bank_mask:0xf
    s_andn2_b64 s[82:83], s[82:83], s[52:53]
    v_cndmask_b32_dpp v7, v7, v7, vcc wave_shr:1 row_mask:0xf bank_mask:0xf
    s_mov_b64 exec, s[50:51]
    s_cbranch_scc0 L2_d140
    s_mov_b64 exec, s[82:83]
    s_nop 1
    v_mfma_f32_4x4x4_16b_bf16 v[88:91], v[12:13], v[84:85], 0
    s_nop 1
    v_mfma_f32_4x4x4_16b_bf16 v[88:91], v[10:11], v[86:87], v[88:91]
    s_nop 4
    v_cvt_pk_bf16_f32 v88, v88, v89
    v_cvt_pk_bf16_f32 v89, v90, v91
    ds_pk_add_bf16 v7, v88 offset:65408
    ds_pk_add_bf16 v7, v89 offset:65412
    s_mov_b64 exec, s[50:51]
    s_branch L2_d140
L2_oa141:
    s_waitcnt vmcnt(0)
    s_mov_b64 exec, s[6:7]
    v_lshrrev_b32 v114, 16, v114
    s_mov_b64 exec, -1
    v_and_b32 v46, 0x10000000, v33
    v_cmpx_eq_u32 vcc, 0, v46
    v_lshrrev_b32 v47, 14, v112
    v_and_b32 v47, v5, v47
    ds_read_b64 v[96:97], v47
    v_perm_b32 v98, v112, v114, s44
    v_bitop3_b32 v99, v112, 0.5, -0.5 bitop3:0xa8
    v_bitop3_b32 v98, v6, v98, v99 bitop3:0xca
    v_and_b32 v47, v5, v112
    s_waitcnt lgkmcnt(0)
    v_mfma_f32_4x4x4_16b_bf16 v[88:91], v[8:9], v[96:97], 0
    s_nop 4
    v_mul_f32 v88, v98, v88
    v_mul_f32 v89, v98, v89
    v_mul_f32 v90, v98, v90
    v_mul_f32 v91, v98, v91
    v_cvt_pk_bf16_f32 v88, v88, v89
    v_cvt_pk_bf16_f32 v89, v90, v91
    ds_pk_add_bf16 v47, v88 offset:65408
    ds_pk_add_bf16 v47, v89 offset:65412
    s_mov_b64 exec, -1
    v_and_b32 v46, 0x20000000, v33
    v_cmpx_eq_u32 vcc, 0, v46
    v_lshrrev_b32 v47, 14, v113
    v_and_b32 v47, v5, v47
    ds_read_b64 v[96:97], v47
    v_perm_b32 v98, v113, v114, s45
    v_bitop3_b32 v99, v113, 0.5, -0.5 bitop3:0xa8
    v_bitop3_b32 v98, v6, v98, v99 bitop3:0xca
    v_and_b32 v47, v5, v113
    s_waitcnt lgkmcnt(0)
    v_mfma_f32_4x4x4_16b_bf16 v[88:91], v[8:9], v[96:97], 0
    s_nop 4
    v_mul_f32 v88, v98, v88
    v_mul_f32 v89, v98, v89
    v_mul_f32 v90, v98, v90
    v_mul_f32 v91, v98, v91
    v_cvt_pk_bf16_f32 v88, v88, v89
    v_cvt_pk_bf16_f32 v89, v90, v91
    ds_pk_add_bf16 v47, v88 offset:65408
    ds_pk_add_bf16 v47, v89 offset:65412
    s_mov_b64 exec, -1
    s_branch L2_ob141
L2_c142:
    s_lshl_b64 s[52:53], s[82:83], 1
    s_andn2_b64 s[52:53], s[52:53], s[80:81]
    s_andn2_b64 s[52:53], s[52:53], s[54:55]
    s_or_b64 s[80:81], s[80:81], s[52:53]
    s_not_b64 vcc, s[52:53]
    s_mov_b64 exec, -1
    v_cndmask_b32_dpp v84, v84, v84, vcc wave_shr:1 row_mask:0xf bank_mask:0xf
    v_cndmask_b32_dpp v85, v85, v85, vcc wave_shr:1 row_mask:0xf bank_mask:0xf
    s_lshr_b64 s[52:53], s[52:53], 1
    v_cndmask_b32_dpp v86, v86, v86, vcc wave_shr:1 row_mask:0xf bank_mask:0xf
    v_cndmask_b32_dpp v87, v87, v87, vcc wave_shr:1 row_mask:0xf bank_mask:0xf
    s_andn2_b64 s[82:83], s[82:83], s[52:53]
    v_cndmask_b32_dpp v7, v7, v7, vcc wave_shr:1 row_mask:0xf bank_mask:0xf
    s_mov_b64 exec, s[54:55]
    s_cbranch_scc0 L2_d142
    s_mov_b64 exec, s[82:83]
    s_nop 1
    v_mfma_f32_4x4x4_16b_bf16 v[88:91], v[12:13], v[84:85], 0
    s_nop 1
    v_mfma_f32_4x4x4_16b_bf16 v[88:91], v[10:11], v[86:87], v[88:91]
    s_nop 4
    v_cvt_pk_bf16_f32 v88, v88, v89
    v_cvt_pk_bf16_f32 v89, v90, v91
    ds_pk_add_bf16 v7, v88 offset:65408
    ds_pk_add_bf16 v7, v89 offset:65412
    s_mov_b64 exec, s[54:55]
    s_branch L2_d142
L2_c143:
    s_lshl_b64 s[52:53], s[82:83], 1
    s_andn2_b64 s[52:53], s[52:53], s[80:81]
    s_andn2_b64 s[52:53], s[52:53], s[50:51]
    s_or_b64 s[80:81], s[80:81], s[52:53]
    s_not_b64 vcc, s[52:53]
    s_mov_b64 exec, -1
    v_cndmask_b32_dpp v84, v84, v84, vcc wave_shr:1 row_mask:0xf bank_mask:0xf
    v_cndmask_b32_dpp v85, v85, v85, vcc wave_shr:1 row_mask:0xf bank_mask:0xf
    s_lshr_b64 s[52:53], s[52:53], 1
    v_cndmask_b32_dpp v86, v86, v86, vcc wave_shr:1 row_mask:0xf bank_mask:0xf
    v_cndmask_b32_dpp v87, v87, v87, vcc wave_shr:1 row_mask:0xf bank_mask:0xf
    s_andn2_b64 s[82:83], s[82:83], s[52:53]
    v_cndmask_b32_dpp v7, v7, v7, vcc wave_shr:1 row_mask:0xf bank_mask:0xf
    s_mov_b64 exec, s[50:51]
    s_cbranch_scc0 L2_d143
    s_mov_b64 exec, s[82:83]
    s_nop 1
    v_mfma_f32_4x4x4_16b_bf16 v[88:91], v[12:13], v[84:85], 0
    s_nop 1
    v_mfma_f32_4x4x4_16b_bf16 v[88:91], v[10:11], v[86:87], v[88:91]
    s_nop 4
    v_cvt_pk_bf16_f32 v88, v88, v89
    v_cvt_pk_bf16_f32 v89, v90, v91
    ds_pk_add_bf16 v7, v88 offset:65408
    ds_pk_add_bf16 v7, v89 offset:65412
    s_mov_b64 exec, s[50:51]
    s_branch L2_d143
L2_c144:
    s_lshl_b64 s[52:53], s[82:83], 1
    s_andn2_b64 s[52:53], s[52:53], s[80:81]
    s_andn2_b64 s[52:53], s[52:53], s[54:55]
    s_or_b64 s[80:81], s[80:81], s[52:53]
    s_not_b64 vcc, s[52:53]
    s_mov_b64 exec, -1
    v_cndmask_b32_dpp v84, v84, v84, vcc wave_shr:1 row_mask:0xf bank_mask:0xf
    v_cndmask_b32_dpp v85, v85, v85, vcc wave_shr:1 row_mask:0xf bank_mask:0xf
    s_lshr_b64 s[52:53], s[52:53], 1
    v_cndmask_b32_dpp v86, v86, v86, vcc wave_shr:1 row_mask:0xf bank_mask:0xf
    v_cndmask_b32_dpp v87, v87, v87, vcc wave_shr:1 row_mask:0xf bank_mask:0xf
    s_andn2_b64 s[82:83], s[82:83], s[52:53]
    v_cndmask_b32_dpp v7, v7, v7, vcc wave_shr:1 row_mask:0xf bank_mask:0xf
    s_mov_b64 exec, s[54:55]
    s_cbranch_scc0 L2_d144
    s_mov_b64 exec, s[82:83]
    s_nop 1
    v_mfma_f32_4x4x4_16b_bf16 v[88:91], v[12:13], v[84:85], 0
    s_nop 1
    v_mfma_f32_4x4x4_16b_bf16 v[88:91], v[10:11], v[86:87], v[88:91]
    s_nop 4
    v_cvt_pk_bf16_f32 v88, v88, v89
    v_cvt_pk_bf16_f32 v89, v90, v91
    ds_pk_add_bf16 v7, v88 offset:65408
    ds_pk_add_bf16 v7, v89 offset:65412
    s_mov_b64 exec, s[54:55]
    s_branch L2_d144
L2_c145:
    s_lshl_b64 s[52:53], s[82:83], 1
    s_andn2_b64 s[52:53], s[52:53], s[80:81]
    s_andn2_b64 s[52:53], s[52:53], s[50:51]
    s_or_b64 s[80:81], s[80:81], s[52:53]
    s_not_b64 vcc, s[52:53]
    s_mov_b64 exec, -1
    v_cndmask_b32_dpp v84, v84, v84, vcc wave_shr:1 row_mask:0xf bank_mask:0xf
    v_cndmask_b32_dpp v85, v85, v85, vcc wave_shr:1 row_mask:0xf bank_mask:0xf
    s_lshr_b64 s[52:53], s[52:53], 1
    v_cndmask_b32_dpp v86, v86, v86, vcc wave_shr:1 row_mask:0xf bank_mask:0xf
    v_cndmask_b32_dpp v87, v87, v87, vcc wave_shr:1 row_mask:0xf bank_mask:0xf
    s_andn2_b64 s[82:83], s[82:83], s[52:53]
    v_cndmask_b32_dpp v7, v7, v7, vcc wave_shr:1 row_mask:0xf bank_mask:0xf
    s_mov_b64 exec, s[50:51]
    s_cbranch_scc0 L2_d145
    s_mov_b64 exec, s[82:83]
    s_nop 1
    v_mfma_f32_4x4x4_16b_bf16 v[88:91], v[12:13], v[84:85], 0
    s_nop 1
    v_mfma_f32_4x4x4_16b_bf16 v[88:91], v[10:11], v[86:87], v[88:91]
    s_nop 4
    v_cvt_pk_bf16_f32 v88, v88, v89
    v_cvt_pk_bf16_f32 v89, v90, v91
    ds_pk_add_bf16 v7, v88 offset:65408
    ds_pk_add_bf16 v7, v89 offset:65412
    s_mov_b64 exec, s[50:51]
    s_branch L2_d145
L2_c146:
    s_lshl_b64 s[52:53], s[82:83], 1
    s_andn2_b64 s[52:53], s[52:53], s[80:81]
    s_andn2_b64 s[52:53], s[52:53], s[54:55]
    s_or_b64 s[80:81], s[80:81], s[52:53]
    s_not_b64 vcc, s[52:53]
    s_mov_b64 exec, -1
    v_cndmask_b32_dpp v84, v84, v84, vcc wave_shr:1 row_mask:0xf bank_mask:0xf
    v_cndmask_b32_dpp v85, v85, v85, vcc wave_shr:1 row_mask:0xf bank_mask:0xf
    s_lshr_b64 s[52:53], s[52:53], 1
    v_cndmask_b32_dpp v86, v86, v86, vcc wave_shr:1 row_mask:0xf bank_mask:0xf
    v_cndmask_b32_dpp v87, v87, v87, vcc wave_shr:1 row_mask:0xf bank_mask:0xf
    s_andn2_b64 s[82:83], s[82:83], s[52:53]
    v_cndmask_b32_dpp v7, v7, v7, vcc wave_shr:1 row_mask:0xf bank_mask:0xf
    s_mov_b64 exec, s[54:55]
    s_cbranch_scc0 L2_d146
    s_mov_b64 exec, s[82:83]
    s_nop 1
    v_mfma_f32_4x4x4_16b_bf16 v[88:91], v[12:13], v[84:85], 0
    s_nop 1
    v_mfma_f32_4x4x4_16b_bf16 v[88:91], v[10:11], v[86:87], v[88:91]
    s_nop 4
    v_cvt_pk_bf16_f32 v88, v88, v89
    v_cvt_pk_bf16_f32 v89, v90, v91
    ds_pk_add_bf16 v7, v88 offset:65408
    ds_pk_add_bf16 v7, v89 offset:65412
    s_mov_b64 exec, s[54:55]
    s_branch L2_d146
L2_c147:
    s_lshl_b64 s[52:53], s[82:83], 1
    s_andn2_b64 s[52:53], s[52:53], s[80:81]
    s_andn2_b64 s[52:53], s[52:53], s[50:51]
    s_or_b64 s[80:81], s[80:81], s[52:53]
    s_not_b64 vcc, s[52:53]
    s_mov_b64 exec, -1
    v_cndmask_b32_dpp v84, v84, v84, vcc wave_shr:1 row_mask:0xf bank_mask:0xf
    v_cndmask_b32_dpp v85, v85, v85, vcc wave_shr:1 row_mask:0xf bank_mask:0xf
    s_lshr_b64 s[52:53], s[52:53], 1
    v_cndmask_b32_dpp v86, v86, v86, vcc wave_shr:1 row_mask:0xf bank_mask:0xf
    v_cndmask_b32_dpp v87, v87, v87, vcc wave_shr:1 row_mask:0xf bank_mask:0xf
    s_andn2_b64 s[82:83], s[82:83], s[52:53]
    v_cndmask_b32_dpp v7, v7, v7, vcc wave_shr:1 row_mask:0xf bank_mask:0xf
    s_mov_b64 exec, s[50:51]
    s_cbranch_scc0 L2_d147
    s_mov_b64 exec, s[82:83]
    s_nop 1
    v_mfma_f32_4x4x4_16b_bf16 v[88:91], v[12:13], v[84:85], 0
    s_nop 1
    v_mfma_f32_4x4x4_16b_bf16 v[88:91], v[10:11], v[86:87], v[88:91]
    s_nop 4
    v_cvt_pk_bf16_f32 v88, v88, v89
    v_cvt_pk_bf16_f32 v89, v90, v91
    ds_pk_add_bf16 v7, v88 offset:65408
    ds_pk_add_bf16 v7, v89 offset:65412
    s_mov_b64 exec, s[50:51]
    s_branch L2_d147
L2_c148:
    s_lshl_b64 s[52:53], s[82:83], 1
    s_andn2_b64 s[52:53], s[52:53], s[80:81]
    s_andn2_b64 s[52:53], s[52:53], s[54:55]
    s_or_b64 s[80:81], s[80:81], s[52:53]
    s_not_b64 vcc, s[52:53]
    s_mov_b64 exec, -1
    v_cndmask_b32_dpp v84, v84, v84, vcc wave_shr:1 row_mask:0xf bank_mask:0xf
    v_cndmask_b32_dpp v85, v85, v85, vcc wave_shr:1 row_mask:0xf bank_mask:0xf
    s_lshr_b64 s[52:53], s[52:53], 1
    v_cndmask_b32_dpp v86, v86, v86, vcc wave_shr:1 row_mask:0xf bank_mask:0xf
    v_cndmask_b32_dpp v87, v87, v87, vcc wave_shr:1 row_mask:0xf bank_mask:0xf
    s_andn2_b64 s[82:83], s[82:83], s[52:53]
    v_cndmask_b32_dpp v7, v7, v7, vcc wave_shr:1 row_mask:0xf bank_mask:0xf
    s_mov_b64 exec, s[54:55]
    s_cbranch_scc0 L2_d148
    s_mov_b64 exec, s[82:83]
    s_nop 1
    v_mfma_f32_4x4x4_16b_bf16 v[88:91], v[12:13], v[84:85], 0
    s_nop 1
    v_mfma_f32_4x4x4_16b_bf16 v[88:91], v[10:11], v[86:87], v[88:91]
    s_nop 4
    v_cvt_pk_bf16_f32 v88, v88, v89
    v_cvt_pk_bf16_f32 v89, v90, v91
    ds_pk_add_bf16 v7, v88 offset:65408
    ds_pk_add_bf16 v7, v89 offset:65412
    s_mov_b64 exec, s[54:55]
    s_branch L2_d148
L2_c149:
    s_lshl_b64 s[52:53], s[82:83], 1
    s_andn2_b64 s[52:53], s[52:53], s[80:81]
    s_andn2_b64 s[52:53], s[52:53], s[50:51]
    s_or_b64 s[80:81], s[80:81], s[52:53]
    s_not_b64 vcc, s[52:53]
    s_mov_b64 exec, -1
    v_cndmask_b32_dpp v84, v84, v84, vcc wave_shr:1 row_mask:0xf bank_mask:0xf
    v_cndmask_b32_dpp v85, v85, v85, vcc wave_shr:1 row_mask:0xf bank_mask:0xf
    s_lshr_b64 s[52:53], s[52:53], 1
    v_cndmask_b32_dpp v86, v86, v86, vcc wave_shr:1 row_mask:0xf bank_mask:0xf
    v_cndmask_b32_dpp v87, v87, v87, vcc wave_shr:1 row_mask:0xf bank_mask:0xf
    s_andn2_b64 s[82:83], s[82:83], s[52:53]
    v_cndmask_b32_dpp v7, v7, v7, vcc wave_shr:1 row_mask:0xf bank_mask:0xf
    s_mov_b64 exec, s[50:51]
    s_cbranch_scc0 L2_d149
    s_mov_b64 exec, s[82:83]
    s_nop 1
    v_mfma_f32_4x4x4_16b_bf16 v[88:91], v[12:13], v[84:85], 0
    s_nop 1
    v_mfma_f32_4x4x4_16b_bf16 v[88:91], v[10:11], v[86:87], v[88:91]
    s_nop 4
    v_cvt_pk_bf16_f32 v88, v88, v89
    v_cvt_pk_bf16_f32 v89, v90, v91
    ds_pk_add_bf16 v7, v88 offset:65408
    ds_pk_add_bf16 v7, v89 offset:65412
    s_mov_b64 exec, s[50:51]
    s_branch L2_d149
L2_c150:
    s_lshl_b64 s[52:53], s[82:83], 1
    s_andn2_b64 s[52:53], s[52:53], s[80:81]
    s_andn2_b64 s[52:53], s[52:53], s[54:55]
    s_or_b64 s[80:81], s[80:81], s[52:53]
    s_not_b64 vcc, s[52:53]
    s_mov_b64 exec, -1
    v_cndmask_b32_dpp v84, v84, v84, vcc wave_shr:1 row_mask:0xf bank_mask:0xf
    v_cndmask_b32_dpp v85, v85, v85, vcc wave_shr:1 row_mask:0xf bank_mask:0xf
    s_lshr_b64 s[52:53], s[52:53], 1
    v_cndmask_b32_dpp v86, v86, v86, vcc wave_shr:1 row_mask:0xf bank_mask:0xf
    v_cndmask_b32_dpp v87, v87, v87, vcc wave_shr:1 row_mask:0xf bank_mask:0xf
    s_andn2_b64 s[82:83], s[82:83], s[52:53]
    v_cndmask_b32_dpp v7, v7, v7, vcc wave_shr:1 row_mask:0xf bank_mask:0xf
    s_mov_b64 exec, s[54:55]
    s_cbranch_scc0 L2_d150
    s_mov_b64 exec, s[82:83]
    s_nop 1
    v_mfma_f32_4x4x4_16b_bf16 v[88:91], v[12:13], v[84:85], 0
    s_nop 1
    v_mfma_f32_4x4x4_16b_bf16 v[88:91], v[10:11], v[86:87], v[88:91]
    s_nop 4
    v_cvt_pk_bf16_f32 v88, v88, v89
    v_cvt_pk_bf16_f32 v89, v90, v91
    ds_pk_add_bf16 v7, v88 offset:65408
    ds_pk_add_bf16 v7, v89 offset:65412
    s_mov_b64 exec, s[54:55]
    s_branch L2_d150
L2_c151:
    s_lshl_b64 s[52:53], s[82:83], 1
    s_andn2_b64 s[52:53], s[52:53], s[80:81]
    s_andn2_b64 s[52:53], s[52:53], s[50:51]
    s_or_b64 s[80:81], s[80:81], s[52:53]
    s_not_b64 vcc, s[52:53]
    s_mov_b64 exec, -1
    v_cndmask_b32_dpp v84, v84, v84, vcc wave_shr:1 row_mask:0xf bank_mask:0xf
    v_cndmask_b32_dpp v85, v85, v85, vcc wave_shr:1 row_mask:0xf bank_mask:0xf
    s_lshr_b64 s[52:53], s[52:53], 1
    v_cndmask_b32_dpp v86, v86, v86, vcc wave_shr:1 row_mask:0xf bank_mask:0xf
    v_cndmask_b32_dpp v87, v87, v87, vcc wave_shr:1 row_mask:0xf bank_mask:0xf
    s_andn2_b64 s[82:83], s[82:83], s[52:53]
    v_cndmask_b32_dpp v7, v7, v7, vcc wave_shr:1 row_mask:0xf bank_mask:0xf
    s_mov_b64 exec, s[50:51]
    s_cbranch_scc0 L2_d151
    s_mov_b64 exec, s[82:83]
    s_nop 1
    v_mfma_f32_4x4x4_16b_bf16 v[88:91], v[12:13], v[84:85], 0
    s_nop 1
    v_mfma_f32_4x4x4_16b_bf16 v[88:91], v[10:11], v[86:87], v[88:91]
    s_nop 4
    v_cvt_pk_bf16_f32 v88, v88, v89
    v_cvt_pk_bf16_f32 v89, v90, v91
    ds_pk_add_bf16 v7, v88 offset:65408
    ds_pk_add_bf16 v7, v89 offset:65412
    s_mov_b64 exec, s[50:51]
    s_branch L2_d151
L2_c152:
    s_mov_b64 s[50:51], vcc
    s_lshl_b64 s[52:53], s[82:83], 1
    s_andn2_b64 s[52:53], s[52:53], s[80:81]
    s_andn2_b64 s[52:53], s[52:53], s[50:51]
    s_or_b64 s[80:81], s[80:81], s[52:53]
    s_not_b64 vcc, s[52:53]
    s_mov_b64 exec, -1
    v_cndmask_b32_dpp v84, v84, v84, vcc wave_shr:1 row_mask:0xf bank_mask:0xf
    v_cndmask_b32_dpp v85, v85, v85, vcc wave_shr:1 row_mask:0xf bank_mask:0xf
    s_lshr_b64 s[52:53], s[52:53], 1
    v_cndmask_b32_dpp v86, v86, v86, vcc wave_shr:1 row_mask:0xf bank_mask:0xf
    v_cndmask_b32_dpp v87, v87, v87, vcc wave_shr:1 row_mask:0xf bank_mask:0xf
    s_andn2_b64 s[82:83], s[82:83], s[52:53]
    v_cndmask_b32_dpp v7, v7, v7, vcc wave_shr:1 row_mask:0xf bank_mask:0xf
    s_mov_b64 vcc, s[50:51]
    s_mov_b64 exec, s[50:51]
    s_cbranch_scc0 L2_d152
    s_mov_b64 exec, s[82:83]
    s_nop 1
    v_mfma_f32_4x4x4_16b_bf16 v[88:91], v[12:13], v[84:85], 0
    s_nop 1
    v_mfma_f32_4x4x4_16b_bf16 v[88:91], v[10:11], v[86:87], v[88:91]
    s_nop 4
    v_cvt_pk_bf16_f32 v88, v88, v89
    v_cvt_pk_bf16_f32 v89, v90, v91
    ds_pk_add_bf16 v7, v88 offset:65408
    ds_pk_add_bf16 v7, v89 offset:65412
    s_mov_b64 exec, vcc
    s_branch L2_d152
L2_c153:
    s_mov_b64 s[50:51], vcc
    s_lshl_b64 s[52:53], s[82:83], 1
    s_andn2_b64 s[52:53], s[52:53], s[80:81]
    s_andn2_b64 s[52:53], s[52:53], s[50:51]
    s_or_b64 s[80:81], s[80:81], s[52:53]
    s_not_b64 vcc, s[52:53]
    s_mov_b64 exec, -1
    v_cndmask_b32_dpp v84, v84, v84, vcc wave_shr:1 row_mask:0xf bank_mask:0xf
    v_cndmask_b32_dpp v85, v85, v85, vcc wave_shr:1 row_mask:0xf bank_mask:0xf
    s_lshr_b64 s[52:53], s[52:53], 1
    v_cndmask_b32_dpp v86, v86, v86, vcc wave_shr:1 row_mask:0xf bank_mask:0xf
    v_cndmask_b32_dpp v87, v87, v87, vcc wave_shr:1 row_mask:0xf bank_mask:0xf
    s_andn2_b64 s[82:83], s[82:83], s[52:53]
    v_cndmask_b32_dpp v7, v7, v7, vcc wave_shr:1 row_mask:0xf bank_mask:0xf
    s_mov_b64 vcc, s[50:51]
    s_mov_b64 exec, s[50:51]
    s_cbranch_scc0 L2_d153
    s_mov_b64 exec, s[82:83]
    s_nop 1
    v_mfma_f32_4x4x4_16b_bf16 v[88:91], v[12:13], v[84:85], 0
    s_nop 1
    v_mfma_f32_4x4x4_16b_bf16 v[88:91], v[10:11], v[86:87], v[88:91]
    s_nop 4
    v_cvt_pk_bf16_f32 v88, v88, v89
    v_cvt_pk_bf16_f32 v89, v90, v91
    ds_pk_add_bf16 v7, v88 offset:65408
    ds_pk_add_bf16 v7, v89 offset:65412
    s_mov_b64 exec, vcc
    s_branch L2_d153
L2_f3s:
    s_branch L2_f3
.section .rodata,"a"
.p2align 6
.amdhsa_kernel gather_scatter__molecular_angular_gemnet__graph_kernel
  .amdhsa_next_free_vgpr 128
  .amdhsa_next_free_sgpr 102
  .amdhsa_accum_offset 128
  .amdhsa_group_segment_fixed_size 0
  .amdhsa_kernarg_size 112
  .amdhsa_user_sgpr_count 2
  .amdhsa_user_sgpr_kernarg_segment_ptr 1
  .amdhsa_system_sgpr_workgroup_id_x 1
  .amdhsa_float_denorm_mode_32 3
.end_amdhsa_kernel
```

```asm
; @launch grid=(256,1,1) block=(1024,1,1) lds=163840
.amdgcn_target "amdgcn-amd-amdhsa--gfx950"
.text
.globl gather_scatter__molecular_angular_gemnet__graph_kernel
.p2align 8
.type gather_scatter__molecular_angular_gemnet__graph_kernel,@function
gather_scatter__molecular_angular_gemnet__graph_kernel:
    s_cmp_ge_u32 s2, 256
    s_cbranch_scc0 L1_go
    s_endpgm
L1_go:
    s_load_dwordx4 s[4:7], s[0:1], 8
    s_load_dwordx2 s[28:29], s[0:1], 32
    s_load_dwordx2 s[30:31], s[0:1], 104
    s_load_dwordx2 s[56:57], s[0:1], 96
    s_load_dwordx2 s[86:87], s[0:1], 0
    s_load_dwordx4 s[60:63], s[0:1], 56
    s_load_dwordx4 s[64:67], s[0:1], 72
    v_lshrrev_b32 v7, 6, v0
    v_lshlrev_b32 v1, 3, v0
    v_readfirstlane_b32 s32, v7
    v_lshlrev_b32 v0, 4, v0
    v_and_b32 v1, 0x1f8, v1
    v_lshlrev_b32 v15, 1, v1
    s_lshr_b32 s3, s32, 1
    s_and_b32 s44, s32, 1
    s_lshl_b32 s44, s44, 3
    s_or_b32 s3, s3, s44
    s_lshl_b32 s3, s3, 10
    s_lshl_b32 s96, s2, 14
    s_add_u32 s96, s96, s3
    s_lshr_b32 s3, s32, 1
    s_and_b32 s44, s32, 1
    s_lshl_b32 s44, s44, 3
    s_or_b32 s3, s3, s44
    s_lshl_b32 s3, s3, 10
    s_lshl_b32 s97, s2, 14
    s_add_u32 s97, s97, s3
    s_lshr_b32 s3, s32, 1
    s_and_b32 s44, s32, 1
    s_lshl_b32 s44, s44, 3
    s_or_b32 s3, s3, s44
    s_lshl_b32 s3, s3, 10
    s_lshl_b32 s98, s2, 14
    s_add_u32 s98, s98, s3
    s_lshr_b32 s3, s32, 1
    s_and_b32 s44, s32, 1
    s_lshl_b32 s44, s44, 3
    s_or_b32 s3, s3, s44
    s_lshl_b32 s3, s3, 10
    s_lshl_b32 s99, s2, 14
    s_add_u32 s99, s99, s3
    s_waitcnt lgkmcnt(0)
    s_mov_b32 s8, s4
    s_mov_b32 s9, s5
    s_mov_b32 s10, 0x9c40000
    s_mov_b32 s11, 0x20000
    s_mov_b32 s12, s6
    s_mov_b32 s13, s7
    s_mov_b32 s14, 0x9c40000
    s_mov_b32 s15, 0x20000
    s_mov_b32 s16, s28
    s_mov_b32 s17, s29
    s_mov_b32 s18, 0x4e20000
    s_mov_b32 s19, 0x20000
    s_mov_b32 s68, s62
    s_mov_b32 s69, s63
    s_mov_b32 s70, 0x40
    s_mov_b32 s71, 0x20000
    s_mov_b32 s72, s60
    s_mov_b32 s73, s61
    s_mov_b32 s74, 0x40
    s_mov_b32 s75, 0x20000
    s_mov_b32 s20, s66
    s_mov_b32 s21, s67
    s_mov_b32 s22, 0x20
    s_mov_b32 s23, 0x20000
    s_mov_b32 s80, s64
    s_mov_b32 s81, s65
    s_mov_b32 s82, 0x20
    s_mov_b32 s83, 0x20000
    s_add_u32 s24, s30, 0xec45000
    s_addc_u32 s25, s31, 0
    s_mov_b32 s26, 0x100
    s_mov_b32 s27, 0x20000
    v_lshrrev_b32 v2, 3, v0
    v_and_b32 v2, 6, v2
    v_lshlrev_b32 v3, 2, v0
    s_lshl_b32 s3, s32, 8
    s_add_u32 s3, s3, s2
    s_cmp_lg_u32 s3, 254
    s_cbranch_scc1 L1_wt
    buffer_load_ushort v96, v2, s[68:71], 0 offen offset:0
    buffer_load_ushort v108, v2, s[68:71], 0 offen offset:8
    buffer_load_ushort v97, v2, s[68:71], 0 offen offset:16
    buffer_load_ushort v109, v2, s[68:71], 0 offen offset:24
    buffer_load_ushort v98, v2, s[68:71], 0 offen offset:32
    buffer_load_ushort v110, v2, s[68:71], 0 offen offset:40
    buffer_load_ushort v99, v2, s[68:71], 0 offen offset:48
    buffer_load_ushort v111, v2, s[68:71], 0 offen offset:56
    buffer_load_ushort v100, v2, s[72:75], 0 offen offset:0
    buffer_load_ushort v112, v2, s[72:75], 0 offen offset:8
    buffer_load_ushort v101, v2, s[72:75], 0 offen offset:16
    buffer_load_ushort v113, v2, s[72:75], 0 offen offset:24
    buffer_load_ushort v102, v2, s[72:75], 0 offen offset:32
    buffer_load_ushort v114, v2, s[72:75], 0 offen offset:40
    buffer_load_ushort v103, v2, s[72:75], 0 offen offset:48
    buffer_load_ushort v115, v2, s[72:75], 0 offen offset:56
    buffer_load_ushort v104, v2, s[20:23], 0 offen offset:0
    buffer_load_ushort v116, v2, s[20:23], 0 offen offset:8
    buffer_load_ushort v105, v2, s[20:23], 0 offen offset:16
    buffer_load_ushort v117, v2, s[20:23], 0 offen offset:24
    buffer_load_ushort v106, v2, s[80:83], 0 offen offset:0
    buffer_load_ushort v118, v2, s[80:83], 0 offen offset:8
    buffer_load_ushort v107, v2, s[80:83], 0 offen offset:16
    buffer_load_ushort v119, v2, s[80:83], 0 offen offset:24
    s_waitcnt vmcnt(0)
    v_lshl_or_b32 v96, v108, 16, v96
    v_lshl_or_b32 v97, v109, 16, v97
    v_lshl_or_b32 v98, v110, 16, v98
    v_lshl_or_b32 v99, v111, 16, v99
    v_lshl_or_b32 v100, v112, 16, v100
    v_lshl_or_b32 v101, v113, 16, v101
    v_lshl_or_b32 v102, v114, 16, v102
    v_lshl_or_b32 v103, v115, 16, v103
    v_lshl_or_b32 v104, v116, 16, v104
    v_lshl_or_b32 v105, v117, 16, v105
    v_lshl_or_b32 v106, v118, 16, v106
    v_lshl_or_b32 v107, v119, 16, v107
    buffer_store_dwordx4 v[96:99], v3, s[24:27], 0 offen offset:0 sc1
    buffer_store_dwordx4 v[100:103], v3, s[24:27], 0 offen offset:16 sc1
    buffer_store_dwordx4 v[104:107], v3, s[24:27], 0 offen offset:32 sc1
L1_wt:
    s_nop 1
    s_add_u32 s44, s96, 0x0
    v_lshlrev_b32 v16, 1, v1
    buffer_load_dwordx4 v[16:19], v16, s[8:11], s44 offen nt
    s_add_u32 s45, s96, 0x0
    v_lshlrev_b32 v20, 1, v1
    buffer_load_dwordx4 v[20:23], v20, s[12:15], s45 offen nt
    s_add_u32 s46, s96, 0x0
    s_lshr_b32 s46, s46, 1
    buffer_load_dwordx2 v[24:25], v1, s[16:19], s46 offen nt
    s_add_u32 s47, s97, 0x400000
    s_lshr_b32 s47, s47, 1
    buffer_load_dwordx2 v[26:27], v1, s[16:19], s47 offen nt
    s_add_u32 s44, s97, 0x400000
    v_lshlrev_b32 v28, 1, v1
    buffer_load_dwordx4 v[28:31], v28, s[8:11], s44 offen nt
    s_add_u32 s45, s97, 0x400000
    v_lshlrev_b32 v32, 1, v1
    buffer_load_dwordx4 v[32:35], v32, s[12:15], s45 offen nt
    s_add_u32 s46, s98, 0x800000
    v_lshlrev_b32 v36, 1, v1
    buffer_load_dwordx4 v[36:39], v36, s[8:11], s46 offen nt
    s_add_u32 s47, s98, 0x800000
    v_lshlrev_b32 v40, 1, v1
    buffer_load_dwordx4 v[40:43], v40, s[12:15], s47 offen nt
    s_add_u32 s44, s98, 0x800000
    s_lshr_b32 s44, s44, 1
    buffer_load_dwordx2 v[44:45], v1, s[16:19], s44 offen nt
    s_add_u32 s45, s99, 0xc00000
    s_lshr_b32 s45, s45, 1
    buffer_load_dwordx2 v[46:47], v1, s[16:19], s45 offen nt
    s_mov_b32 s20, s30
    s_mov_b32 s21, s31
    s_mov_b32 s22, 0xd344000
    s_mov_b32 s23, 0x20000
    s_add_u32 s24, s30, 0x2c000
    s_addc_u32 s25, s31, 0
    s_mov_b32 s26, 0xd318000
    s_mov_b32 s27, 0x20000
    s_add_u32 s3, s32, 0
    s_mul_i32 s4, s3, 205
    s_lshr_b32 s4, s4, 10
    s_mul_i32 s5, s4, 5
    s_sub_u32 s5, s3, s5
    s_lshl_b32 s5, s5, 5
    s_add_u32 s4, s4, s5
    s_sub_u32 s4, s4, s32
    s_lshl_b32 s72, s4, 10
    s_add_u32 s3, s32, 16
    s_mul_i32 s4, s3, 205
    s_lshr_b32 s4, s4, 10
    s_mul_i32 s5, s4, 5
    s_sub_u32 s5, s3, s5
    s_lshl_b32 s5, s5, 5
    s_add_u32 s4, s4, s5
    s_sub_u32 s4, s4, s32
    s_lshl_b32 s73, s4, 10
    s_add_u32 s3, s32, 32
    s_mul_i32 s4, s3, 205
    s_lshr_b32 s4, s4, 10
    s_mul_i32 s5, s4, 5
    s_sub_u32 s5, s3, s5
    s_lshl_b32 s5, s5, 5
    s_add_u32 s4, s4, s5
    s_sub_u32 s4, s4, s32
    s_lshl_b32 s85, s4, 10
    s_add_u32 s3, s32, 48
    s_mul_i32 s4, s3, 205
    s_lshr_b32 s4, s4, 10
    s_mul_i32 s5, s4, 5
    s_sub_u32 s5, s3, s5
    s_lshl_b32 s5, s5, 5
    s_add_u32 s4, s4, s5
    s_sub_u32 s4, s4, s32
    s_lshl_b32 s91, s4, 10
    s_add_u32 s3, s32, 64
    s_mul_i32 s4, s3, 205
    s_lshr_b32 s4, s4, 10
    s_mul_i32 s5, s4, 5
    s_sub_u32 s5, s3, s5
    s_lshl_b32 s5, s5, 5
    s_add_u32 s4, s4, s5
    s_sub_u32 s4, s4, s32
    s_lshl_b32 s93, s4, 10
    s_mov_b32 s80, s86
    s_mov_b32 s81, s87
    s_mov_b32 s82, 0x4e2000
    s_mov_b32 s83, 0x20000
    s_mul_i32 s35, s2, 173056
    s_and_b32 s37, s32, 3
    s_lshl_b32 s37, s37, 3
    s_mov_b32 s36, s37
    s_lshr_b32 s37, s32, 2
    s_mul_i32 s37, s37, 2080
    s_add_u32 s36, s36, s37
    s_and_b32 s37, s2, 3
    s_lshl_b32 s37, s37, 5
    s_add_u32 s36, s36, s37
    s_mul_i32 s4, s2, 5
    s_add_u32 s4, s4, 8192
    s_lshl_b32 s38, s4, 14
    s_lshl_b32 s39, s4, 13
    v_mov_b32 v2, 1
    v_mov_b32 v4, 0x80000007
    v_mov_b32 v5, 0xfc
    v_mov_b32 v6, 0x78
    s_mov_b32 s40, 16512
    s_mov_b32 s55, -10000
    s_mov_b32 s41, 0x010c0c01
    s_mov_b32 s42, 0x030c0c03
    v_mov_b32 v8, 0
    v_mov_b32 v9, 0
    v_mov_b32 v10, 0
    v_mov_b32 v11, 0
    ds_write_b128 v0, v[8:11]
    s_add_u32 s60, s30, 0xec4e000
    s_addc_u32 s61, s31, 0
    s_mov_b32 s62, 0x8000
    s_mov_b32 s63, 0x20000
    s_mov_b64 s[66:67], s[56:57]
    s_lshl_b32 s57, s2, 7
    s_add_u32 s68, s30, 0xec46000
    s_addc_u32 s69, s31, 0
    s_mov_b32 s70, 0x80
    s_mov_b32 s71, 0x20000
    s_lshl_b32 s3, s2, 7
    s_add_u32 s68, s68, s3
    s_addc_u32 s69, s69, 0
    s_cmp_lg_u32 s32, 0
    s_cbranch_scc1 L1_fl
    buffer_store_dwordx4 v[8:11], v0, s[68:71], 0 offen sc1
    s_mov_b64 exec, 0xff
    buffer_store_dwordx4 v[8:11], v0, s[60:63], s57 offen sc1
    s_mov_b64 exec, -1
L1_fl:
    s_waitcnt lgkmcnt(0)
    s_barrier
    s_setprio 3
    s_add_u32 s46, s99, 0xc00000
    v_lshlrev_b32 v48, 1, v1
    buffer_load_dwordx4 v[48:51], v48, s[8:11], s46 offen nt
    s_add_u32 s47, s99, 0xc00000
    v_lshlrev_b32 v52, 1, v1
    buffer_load_dwordx4 v[52:55], v52, s[12:15], s47 offen nt
    s_waitcnt vmcnt(8)
    v_lshlrev_b32 v7, 16, v24
    v_and_b32 v8, 0xffff0000, v24
    v_lshlrev_b32 v9, 16, v25
    v_and_b32 v10, 0xffff0000, v25
    v_mul_f32 v7, 0.15915494, v7
    v_mul_f32 v8, 0.15915494, v8
    v_mul_f32 v9, 0.15915494, v9
    v_mul_f32 v10, 0.15915494, v10
    v_mul_hi_u32_u24 v14, 429497, v16
    v_lshrrev_b32 v12, 3, v20
    v_cos_f32 v7, v7
    v_lshlrev_b16 v13, 3, v20
    v_mad_i32_i24 v11, v14, s55, v16
    v_bitop3_b32 v12, v6, v13, v12 bitop3:0xca
    v_lshl_add_u32 v11, v11, 17, s40
    v_lshlrev_b16 v14, 8, v14
    v_lshrrev_b32 v13, 2, v20
    v_add_u32 v16, v12, v11
    v_bitop3_b32 v20, v5, v13, v14 bitop3:0xea
    ds_add_u32 v20, v2
    v_mul_hi_u32_u24 v14, 429497, v17
    v_lshrrev_b32 v12, 3, v21
    v_cos_f32 v8, v8
    v_lshlrev_b16 v13, 3, v21
    v_mad_i32_i24 v11, v14, s55, v17
    v_bitop3_b32 v12, v6, v13, v12 bitop3:0xca
    v_lshl_add_u32 v11, v11, 17, s40
    v_lshlrev_b16 v14, 8, v14
    v_lshrrev_b32 v13, 2, v21
    v_add_u32 v17, v12, v11
    v_bitop3_b32 v21, v5, v13, v14 bitop3:0xea
    ds_add_u32 v21, v2
    v_cvt_pk_bf16_f32 v24, v7, v8
    v_perm_b32 v12, v24, v24, s41
    v_bitop3_b32 v16, v4, v12, v16 bitop3:0xca
    v_perm_b32 v13, v24, v24, s42
    v_bitop3_b32 v17, v4, v13, v17 bitop3:0xca
    v_mul_hi_u32_u24 v14, 429497, v18
    v_lshrrev_b32 v12, 3, v22
    v_cos_f32 v9, v9
    v_lshlrev_b16 v13, 3, v22
    v_mad_i32_i24 v11, v14, s55, v18
    v_bitop3_b32 v12, v6, v13, v12 bitop3:0xca
    v_lshl_add_u32 v11, v11, 17, s40
    v_lshlrev_b16 v14, 8, v14
    v_lshrrev_b32 v13, 2, v22
    v_add_u32 v18, v12, v11
    v_bitop3_b32 v22, v5, v13, v14 bitop3:0xea
    ds_add_u32 v22, v2
    v_mul_hi_u32_u24 v14, 429497, v19
    v_lshrrev_b32 v12, 3, v23
    v_cos_f32 v10, v10
    v_lshlrev_b16 v13, 3, v23
    v_mad_i32_i24 v11, v14, s55, v19
    v_bitop3_b32 v12, v6, v13, v12 bitop3:0xca
    v_lshl_add_u32 v11, v11, 17, s40
    v_lshlrev_b16 v14, 8, v14
    v_lshrrev_b32 v13, 2, v23
    v_add_u32 v19, v12, v11
    v_bitop3_b32 v23, v5, v13, v14 bitop3:0xea
    ds_add_u32 v23, v2
    v_cvt_pk_bf16_f32 v25, v9, v10
    v_perm_b32 v12, v25, v25, s41
    v_bitop3_b32 v18, v4, v12, v18 bitop3:0xca
    v_perm_b32 v13, v25, v25, s42
    v_bitop3_b32 v19, v4, v13, v19 bitop3:0xca
    s_add_u32 s44, s96, 0x1000000
    v_lshlrev_b32 v56, 1, v1
    buffer_load_dwordx4 v[56:59], v56, s[8:11], s44 offen nt
    s_add_u32 s45, s96, 0x1000000
    v_lshlrev_b32 v60, 1, v1
    buffer_load_dwordx4 v[60:63], v60, s[12:15], s45 offen nt
    s_add_u32 s46, s96, 0x1000000
    s_lshr_b32 s46, s46, 1
    buffer_load_dwordx2 v[64:65], v1, s[16:19], s46 offen nt
    s_add_u32 s47, s97, 0x1400000
    s_lshr_b32 s47, s47, 1
    buffer_load_dwordx2 v[66:67], v1, s[16:19], s47 offen nt
    s_waitcnt vmcnt(10)
    v_lshlrev_b32 v7, 16, v26
    v_and_b32 v8, 0xffff0000, v26
    v_lshlrev_b32 v9, 16, v27
    v_and_b32 v10, 0xffff0000, v27
    v_mul_f32 v7, 0.15915494, v7
    v_mul_f32 v8, 0.15915494, v8
    v_mul_f32 v9, 0.15915494, v9
    v_mul_f32 v10, 0.15915494, v10
    v_mul_hi_u32_u24 v14, 429497, v28
    v_lshrrev_b32 v12, 3, v32
    v_cos_f32 v7, v7
    v_lshlrev_b16 v13, 3, v32
    v_mad_i32_i24 v11, v14, s55, v28
    v_bitop3_b32 v12, v6, v13, v12 bitop3:0xca
    v_lshl_add_u32 v11, v11, 17, s40
    v_lshlrev_b16 v14, 8, v14
    v_lshrrev_b32 v13, 2, v32
    v_add_u32 v28, v12, v11
    v_bitop3_b32 v32, v5, v13, v14 bitop3:0xea
    ds_add_u32 v32, v2
    v_mul_hi_u32_u24 v14, 429497, v29
    v_lshrrev_b32 v12, 3, v33
    v_cos_f32 v8, v8
    v_lshlrev_b16 v13, 3, v33
    v_mad_i32_i24 v11, v14, s55, v29
    v_bitop3_b32 v12, v6, v13, v12 bitop3:0xca
    v_lshl_add_u32 v11, v11, 17, s40
    v_lshlrev_b16 v14, 8, v14
    v_lshrrev_b32 v13, 2, v33
    v_add_u32 v29, v12, v11
    v_bitop3_b32 v33, v5, v13, v14 bitop3:0xea
    ds_add_u32 v33, v2
    v_cvt_pk_bf16_f32 v26, v7, v8
    v_perm_b32 v12, v26, v26, s41
    v_bitop3_b32 v28, v4, v12, v28 bitop3:0xca
    v_perm_b32 v13, v26, v26, s42
    v_bitop3_b32 v29, v4, v13, v29 bitop3:0xca
    v_mul_hi_u32_u24 v14, 429497, v30
    v_lshrrev_b32 v12, 3, v34
    v_cos_f32 v9, v9
    v_lshlrev_b16 v13, 3, v34
    v_mad_i32_i24 v11, v14, s55, v30
    v_bitop3_b32 v12, v6, v13, v12 bitop3:0xca
    v_lshl_add_u32 v11, v11, 17, s40
    v_lshlrev_b16 v14, 8, v14
    v_lshrrev_b32 v13, 2, v34
    v_add_u32 v30, v12, v11
    v_bitop3_b32 v34, v5, v13, v14 bitop3:0xea
    ds_add_u32 v34, v2
    v_mul_hi_u32_u24 v14, 429497, v31
    v_lshrrev_b32 v12, 3, v35
    v_cos_f32 v10, v10
    v_lshlrev_b16 v13, 3, v35
    v_mad_i32_i24 v11, v14, s55, v31
    v_bitop3_b32 v12, v6, v13, v12 bitop3:0xca
    v_lshl_add_u32 v11, v11, 17, s40
    v_lshlrev_b16 v14, 8, v14
    v_lshrrev_b32 v13, 2, v35
    v_add_u32 v31, v12, v11
    v_bitop3_b32 v35, v5, v13, v14 bitop3:0xea
    ds_add_u32 v35, v2
    v_cvt_pk_bf16_f32 v27, v9, v10
    v_perm_b32 v12, v27, v27, s41
    v_bitop3_b32 v30, v4, v12, v30 bitop3:0xca
    v_perm_b32 v13, v27, v27, s42
    v_bitop3_b32 v31, v4, v13, v31 bitop3:0xca
    s_setprio 2
    s_add_u32 s44, s97, 0x1400000
    v_lshlrev_b32 v68, 1, v1
    buffer_load_dwordx4 v[68:71], v68, s[8:11], s44 offen nt
    s_add_u32 s45, s97, 0x1400000
    v_lshlrev_b32 v72, 1, v1
    buffer_load_dwordx4 v[72:75], v72, s[12:15], s45 offen nt
    s_waitcnt vmcnt(8)
    v_lshlrev_b32 v7, 16, v44
    v_and_b32 v8, 0xffff0000, v44
    v_lshlrev_b32 v9, 16, v45
    v_and_b32 v10, 0xffff0000, v45
    v_mul_f32 v7, 0.15915494, v7
    v_mul_f32 v8, 0.15915494, v8
    v_mul_f32 v9, 0.15915494, v9
    v_mul_f32 v10, 0.15915494, v10
    v_mul_hi_u32_u24 v14, 429497, v36
    v_lshrrev_b32 v12, 3, v40
    v_cos_f32 v7, v7
    v_lshlrev_b16 v13, 3, v40
    v_mad_i32_i24 v11, v14, s55, v36
    v_bitop3_b32 v12, v6, v13, v12 bitop3:0xca
    v_lshl_add_u32 v11, v11, 17, s40
    v_lshlrev_b16 v14, 8, v14
    v_lshrrev_b32 v13, 2, v40
    v_add_u32 v36, v12, v11
    v_bitop3_b32 v40, v5, v13, v14 bitop3:0xea
    ds_add_u32 v40, v2
    v_mul_hi_u32_u24 v14, 429497, v37
    v_lshrrev_b32 v12, 3, v41
    v_cos_f32 v8, v8
    v_lshlrev_b16 v13, 3, v41
    v_mad_i32_i24 v11, v14, s55, v37
    v_bitop3_b32 v12, v6, v13, v12 bitop3:0xca
    v_lshl_add_u32 v11, v11, 17, s40
    v_lshlrev_b16 v14, 8, v14
    v_lshrrev_b32 v13, 2, v41
    v_add_u32 v37, v12, v11
    v_bitop3_b32 v41, v5, v13, v14 bitop3:0xea
    ds_add_u32 v41, v2
    v_cvt_pk_bf16_f32 v44, v7, v8
    v_perm_b32 v12, v44, v44, s41
    v_bitop3_b32 v36, v4, v12, v36 bitop3:0xca
    v_perm_b32 v13, v44, v44, s42
    v_bitop3_b32 v37, v4, v13, v37 bitop3:0xca
    v_mul_hi_u32_u24 v14, 429497, v38
    v_lshrrev_b32 v12, 3, v42
    v_cos_f32 v9, v9
    v_lshlrev_b16 v13, 3, v42
    v_mad_i32_i24 v11, v14, s55, v38
    v_bitop3_b32 v12, v6, v13, v12 bitop3:0xca
    v_lshl_add_u32 v11, v11, 17, s40
    v_lshlrev_b16 v14, 8, v14
    v_lshrrev_b32 v13, 2, v42
    v_add_u32 v38, v12, v11
    v_bitop3_b32 v42, v5, v13, v14 bitop3:0xea
    ds_add_u32 v42, v2
    v_mul_hi_u32_u24 v14, 429497, v39
    v_lshrrev_b32 v12, 3, v43
    v_cos_f32 v10, v10
    v_lshlrev_b16 v13, 3, v43
    v_mad_i32_i24 v11, v14, s55, v39
    v_bitop3_b32 v12, v6, v13, v12 bitop3:0xca
    v_lshl_add_u32 v11, v11, 17, s40
    v_lshlrev_b16 v14, 8, v14
    v_lshrrev_b32 v13, 2, v43
    v_add_u32 v39, v12, v11
    v_bitop3_b32 v43, v5, v13, v14 bitop3:0xea
    ds_add_u32 v43, v2
    v_cvt_pk_bf16_f32 v45, v9, v10
    v_perm_b32 v12, v45, v45, s41
    v_bitop3_b32 v38, v4, v12, v38 bitop3:0xca
    v_perm_b32 v13, v45, v45, s42
    v_bitop3_b32 v39, v4, v13, v39 bitop3:0xca
    s_add_u32 s46, s98, 0x1800000
    v_lshlrev_b32 v76, 1, v1
    buffer_load_dwordx4 v[76:79], v76, s[8:11], s46 offen nt
    s_add_u32 s47, s98, 0x1800000
    v_lshlrev_b32 v80, 1, v1
    buffer_load_dwordx4 v[80:83], v80, s[12:15], s47 offen nt
    s_add_u32 s44, s98, 0x1800000
    s_lshr_b32 s44, s44, 1
    buffer_load_dwordx2 v[84:85], v1, s[16:19], s44 offen nt
    s_add_u32 s45, s99, 0x1c00000
    s_lshr_b32 s45, s45, 1
    buffer_load_dwordx2 v[86:87], v1, s[16:19], s45 offen nt
    s_waitcnt vmcnt(10)
    v_lshlrev_b32 v7, 16, v46
    v_and_b32 v8, 0xffff0000, v46
    v_lshlrev_b32 v9, 16, v47
    v_and_b32 v10, 0xffff0000, v47
    v_mul_f32 v7, 0.15915494, v7
    v_mul_f32 v8, 0.15915494, v8
    v_mul_f32 v9, 0.15915494, v9
    v_mul_f32 v10, 0.15915494, v10
    v_mul_hi_u32_u24 v14, 429497, v48
    v_lshrrev_b32 v12, 3, v52
    v_cos_f32 v7, v7
    v_lshlrev_b16 v13, 3, v52
    v_mad_i32_i24 v11, v14, s55, v48
    v_bitop3_b32 v12, v6, v13, v12 bitop3:0xca
    v_lshl_add_u32 v11, v11, 17, s40
    v_lshlrev_b16 v14, 8, v14
    v_lshrrev_b32 v13, 2, v52
    v_add_u32 v48, v12, v11
    v_bitop3_b32 v52, v5, v13, v14 bitop3:0xea
    ds_add_u32 v52, v2
    v_mul_hi_u32_u24 v14, 429497, v49
    v_lshrrev_b32 v12, 3, v53
    v_cos_f32 v8, v8
    v_lshlrev_b16 v13, 3, v53
    v_mad_i32_i24 v11, v14, s55, v49
    v_bitop3_b32 v12, v6, v13, v12 bitop3:0xca
    v_lshl_add_u32 v11, v11, 17, s40
    v_lshlrev_b16 v14, 8, v14
    v_lshrrev_b32 v13, 2, v53
    v_add_u32 v49, v12, v11
    v_bitop3_b32 v53, v5, v13, v14 bitop3:0xea
    ds_add_u32 v53, v2
    v_cvt_pk_bf16_f32 v46, v7, v8
    v_perm_b32 v12, v46, v46, s41
    v_bitop3_b32 v48, v4, v12, v48 bitop3:0xca
    v_perm_b32 v13, v46, v46, s42
    v_bitop3_b32 v49, v4, v13, v49 bitop3:0xca
    v_mul_hi_u32_u24 v14, 429497, v50
    v_lshrrev_b32 v12, 3, v54
    v_cos_f32 v9, v9
    v_lshlrev_b16 v13, 3, v54
    v_mad_i32_i24 v11, v14, s55, v50
    v_bitop3_b32 v12, v6, v13, v12 bitop3:0xca
    v_lshl_add_u32 v11, v11, 17, s40
    v_lshlrev_b16 v14, 8, v14
    v_lshrrev_b32 v13, 2, v54
    v_add_u32 v50, v12, v11
    v_bitop3_b32 v54, v5, v13, v14 bitop3:0xea
    ds_add_u32 v54, v2
    v_mul_hi_u32_u24 v14, 429497, v51
    v_lshrrev_b32 v12, 3, v55
    v_cos_f32 v10, v10
    v_lshlrev_b16 v13, 3, v55
    v_mad_i32_i24 v11, v14, s55, v51
    v_bitop3_b32 v12, v6, v13, v12 bitop3:0xca
    v_lshl_add_u32 v11, v11, 17, s40
    v_lshlrev_b16 v14, 8, v14
    v_lshrrev_b32 v13, 2, v55
    v_add_u32 v51, v12, v11
    v_bitop3_b32 v55, v5, v13, v14 bitop3:0xea
    ds_add_u32 v55, v2
    v_cvt_pk_bf16_f32 v47, v9, v10
    v_perm_b32 v12, v47, v47, s41
    v_bitop3_b32 v50, v4, v12, v50 bitop3:0xca
    v_perm_b32 v13, v47, v47, s42
    v_bitop3_b32 v51, v4, v13, v51 bitop3:0xca
    s_setprio 1
    s_add_u32 s46, s99, 0x1c00000
    v_lshlrev_b32 v88, 1, v1
    buffer_load_dwordx4 v[88:91], v88, s[8:11], s46 offen nt
    s_add_u32 s47, s99, 0x1c00000
    v_lshlrev_b32 v92, 1, v1
    buffer_load_dwordx4 v[92:95], v92, s[12:15], s47 offen nt
    s_waitcnt vmcnt(8)
    v_lshlrev_b32 v7, 16, v64
    v_and_b32 v8, 0xffff0000, v64
    v_lshlrev_b32 v9, 16, v65
    v_and_b32 v10, 0xffff0000, v65
    v_mul_f32 v7, 0.15915494, v7
    v_mul_f32 v8, 0.15915494, v8
    v_mul_f32 v9, 0.15915494, v9
    v_mul_f32 v10, 0.15915494, v10
    v_mul_hi_u32_u24 v14, 429497, v56
    v_lshrrev_b32 v12, 3, v60
    v_cos_f32 v7, v7
    v_lshlrev_b16 v13, 3, v60
    v_mad_i32_i24 v11, v14, s55, v56
    v_bitop3_b32 v12, v6, v13, v12 bitop3:0xca
    v_lshl_add_u32 v11, v11, 17, s40
    v_lshlrev_b16 v14, 8, v14
    v_lshrrev_b32 v13, 2, v60
    v_add_u32 v56, v12, v11
    v_bitop3_b32 v60, v5, v13, v14 bitop3:0xea
    ds_add_u32 v60, v2
    v_mul_hi_u32_u24 v14, 429497, v57
    v_lshrrev_b32 v12, 3, v61
    v_cos_f32 v8, v8
    v_lshlrev_b16 v13, 3, v61
    v_mad_i32_i24 v11, v14, s55, v57
    v_bitop3_b32 v12, v6, v13, v12 bitop3:0xca
    v_lshl_add_u32 v11, v11, 17, s40
    v_lshlrev_b16 v14, 8, v14
    v_lshrrev_b32 v13, 2, v61
    v_add_u32 v57, v12, v11
    v_bitop3_b32 v61, v5, v13, v14 bitop3:0xea
    ds_add_u32 v61, v2
    v_cvt_pk_bf16_f32 v64, v7, v8
    v_perm_b32 v12, v64, v64, s41
    v_bitop3_b32 v56, v4, v12, v56 bitop3:0xca
    v_perm_b32 v13, v64, v64, s42
    v_bitop3_b32 v57, v4, v13, v57 bitop3:0xca
    v_mul_hi_u32_u24 v14, 429497, v58
    v_lshrrev_b32 v12, 3, v62
    v_cos_f32 v9, v9
    v_lshlrev_b16 v13, 3, v62
    v_mad_i32_i24 v11, v14, s55, v58
    v_bitop3_b32 v12, v6, v13, v12 bitop3:0xca
    v_lshl_add_u32 v11, v11, 17, s40
    v_lshlrev_b16 v14, 8, v14
    v_lshrrev_b32 v13, 2, v62
    v_add_u32 v58, v12, v11
    v_bitop3_b32 v62, v5, v13, v14 bitop3:0xea
    ds_add_u32 v62, v2
    v_mul_hi_u32_u24 v14, 429497, v59
    v_lshrrev_b32 v12, 3, v63
    v_cos_f32 v10, v10
    v_lshlrev_b16 v13, 3, v63
    v_mad_i32_i24 v11, v14, s55, v59
    v_bitop3_b32 v12, v6, v13, v12 bitop3:0xca
    v_lshl_add_u32 v11, v11, 17, s40
    v_lshlrev_b16 v14, 8, v14
    v_lshrrev_b32 v13, 2, v63
    v_add_u32 v59, v12, v11
    v_bitop3_b32 v63, v5, v13, v14 bitop3:0xea
    ds_add_u32 v63, v2
    v_cvt_pk_bf16_f32 v65, v9, v10
    v_perm_b32 v12, v65, v65, s41
    v_bitop3_b32 v58, v4, v12, v58 bitop3:0xca
    v_perm_b32 v13, v65, v65, s42
    v_bitop3_b32 v59, v4, v13, v59 bitop3:0xca
    s_add_u32 s44, s96, 0x2000000
    v_lshlrev_b32 v96, 1, v1
    buffer_load_dwordx4 v[96:99], v96, s[8:11], s44 offen nt
    s_add_u32 s45, s96, 0x2000000
    v_lshlrev_b32 v104, 1, v1
    buffer_load_dwordx4 v[104:107], v104, s[12:15], s45 offen nt
    s_add_u32 s46, s96, 0x2000000
    s_lshr_b32 s46, s46, 1
    buffer_load_dwordx2 v[108:109], v1, s[16:19], s46 offen nt
    s_add_u32 s47, s97, 0x2400000
    s_lshr_b32 s47, s47, 1
    buffer_load_dwordx2 v[110:111], v1, s[16:19], s47 offen nt
    s_waitcnt vmcnt(10)
    v_lshlrev_b32 v7, 16, v66
    v_and_b32 v8, 0xffff0000, v66
    v_lshlrev_b32 v9, 16, v67
    v_and_b32 v10, 0xffff0000, v67
    v_mul_f32 v7, 0.15915494, v7
    v_mul_f32 v8, 0.15915494, v8
    v_mul_f32 v9, 0.15915494, v9
    v_mul_f32 v10, 0.15915494, v10
    v_mul_hi_u32_u24 v14, 429497, v68
    v_lshrrev_b32 v12, 3, v72
    v_cos_f32 v7, v7
    v_lshlrev_b16 v13, 3, v72
    v_mad_i32_i24 v11, v14, s55, v68
    v_bitop3_b32 v12, v6, v13, v12 bitop3:0xca
    v_lshl_add_u32 v11, v11, 17, s40
    v_lshlrev_b16 v14, 8, v14
    v_lshrrev_b32 v13, 2, v72
    v_add_u32 v68, v12, v11
    v_bitop3_b32 v72, v5, v13, v14 bitop3:0xea
    ds_add_u32 v72, v2
    v_mul_hi_u32_u24 v14, 429497, v69
    v_lshrrev_b32 v12, 3, v73
    v_cos_f32 v8, v8
    v_lshlrev_b16 v13, 3, v73
    v_mad_i32_i24 v11, v14, s55, v69
    v_bitop3_b32 v12, v6, v13, v12 bitop3:0xca
    v_lshl_add_u32 v11, v11, 17, s40
    v_lshlrev_b16 v14, 8, v14
    v_lshrrev_b32 v13, 2, v73
    v_add_u32 v69, v12, v11
    v_bitop3_b32 v73, v5, v13, v14 bitop3:0xea
    ds_add_u32 v73, v2
    v_cvt_pk_bf16_f32 v66, v7, v8
    v_perm_b32 v12, v66, v66, s41
    v_bitop3_b32 v68, v4, v12, v68 bitop3:0xca
    v_perm_b32 v13, v66, v66, s42
    v_bitop3_b32 v69, v4, v13, v69 bitop3:0xca
    v_mul_hi_u32_u24 v14, 429497, v70
    v_lshrrev_b32 v12, 3, v74
    v_cos_f32 v9, v9
    v_lshlrev_b16 v13, 3, v74
    v_mad_i32_i24 v11, v14, s55, v70
    v_bitop3_b32 v12, v6, v13, v12 bitop3:0xca
    v_lshl_add_u32 v11, v11, 17, s40
    v_lshlrev_b16 v14, 8, v14
    v_lshrrev_b32 v13, 2, v74
    v_add_u32 v70, v12, v11
    v_bitop3_b32 v74, v5, v13, v14 bitop3:0xea
    ds_add_u32 v74, v2
    v_mul_hi_u32_u24 v14, 429497, v71
    v_lshrrev_b32 v12, 3, v75
    v_cos_f32 v10, v10
    v_lshlrev_b16 v13, 3, v75
    v_mad_i32_i24 v11, v14, s55, v71
    v_bitop3_b32 v12, v6, v13, v12 bitop3:0xca
    v_lshl_add_u32 v11, v11, 17, s40
    v_lshlrev_b16 v14, 8, v14
    v_lshrrev_b32 v13, 2, v75
    v_add_u32 v71, v12, v11
    v_bitop3_b32 v75, v5, v13, v14 bitop3:0xea
    ds_add_u32 v75, v2
    v_cvt_pk_bf16_f32 v67, v9, v10
    v_perm_b32 v12, v67, v67, s41
    v_bitop3_b32 v70, v4, v12, v70 bitop3:0xca
    v_perm_b32 v13, v67, v67, s42
    v_bitop3_b32 v71, v4, v13, v71 bitop3:0xca
    s_setprio 0
    s_add_u32 s44, s97, 0x2400000
    v_lshlrev_b32 v100, 1, v1
    buffer_load_dwordx4 v[100:103], v100, s[8:11], s44 offen nt
    s_waitcnt vmcnt(7)
    v_lshlrev_b32 v7, 16, v84
    v_and_b32 v8, 0xffff0000, v84
    v_lshlrev_b32 v9, 16, v85
    v_and_b32 v10, 0xffff0000, v85
    v_mul_f32 v7, 0.15915494, v7
    v_mul_f32 v8, 0.15915494, v8
    v_mul_f32 v9, 0.15915494, v9
    v_mul_f32 v10, 0.15915494, v10
    v_mul_hi_u32_u24 v14, 429497, v76
    v_lshrrev_b32 v12, 3, v80
    v_cos_f32 v7, v7
    v_lshlrev_b16 v13, 3, v80
    v_mad_i32_i24 v11, v14, s55, v76
    v_bitop3_b32 v12, v6, v13, v12 bitop3:0xca
    v_lshl_add_u32 v11, v11, 17, s40
    v_lshlrev_b16 v14, 8, v14
    v_lshrrev_b32 v13, 2, v80
    v_add_u32 v76, v12, v11
    v_bitop3_b32 v80, v5, v13, v14 bitop3:0xea
    ds_add_u32 v80, v2
    v_mul_hi_u32_u24 v14, 429497, v77
    v_lshrrev_b32 v12, 3, v81
    v_cos_f32 v8, v8
    v_lshlrev_b16 v13, 3, v81
    v_mad_i32_i24 v11, v14, s55, v77
    v_bitop3_b32 v12, v6, v13, v12 bitop3:0xca
    v_lshl_add_u32 v11, v11, 17, s40
    v_lshlrev_b16 v14, 8, v14
    v_lshrrev_b32 v13, 2, v81
    v_add_u32 v77, v12, v11
    v_bitop3_b32 v81, v5, v13, v14 bitop3:0xea
    ds_add_u32 v81, v2
    v_cvt_pk_bf16_f32 v84, v7, v8
    v_perm_b32 v12, v84, v84, s41
    v_bitop3_b32 v76, v4, v12, v76 bitop3:0xca
    v_perm_b32 v13, v84, v84, s42
    v_bitop3_b32 v77, v4, v13, v77 bitop3:0xca
    v_mul_hi_u32_u24 v14, 429497, v78
    v_lshrrev_b32 v12, 3, v82
    v_cos_f32 v9, v9
    v_lshlrev_b16 v13, 3, v82
    v_mad_i32_i24 v11, v14, s55, v78
    v_bitop3_b32 v12, v6, v13, v12 bitop3:0xca
    v_lshl_add_u32 v11, v11, 17, s40
    v_lshlrev_b16 v14, 8, v14
    v_lshrrev_b32 v13, 2, v82
    v_add_u32 v78, v12, v11
    v_bitop3_b32 v82, v5, v13, v14 bitop3:0xea
    ds_add_u32 v82, v2
    v_mul_hi_u32_u24 v14, 429497, v79
    v_lshrrev_b32 v12, 3, v83
    v_cos_f32 v10, v10
    v_lshlrev_b16 v13, 3, v83
    v_mad_i32_i24 v11, v14, s55, v79
    v_bitop3_b32 v12, v6, v13, v12 bitop3:0xca
    v_lshl_add_u32 v11, v11, 17, s40
    v_lshlrev_b16 v14, 8, v14
    v_lshrrev_b32 v13, 2, v83
    v_add_u32 v79, v12, v11
    v_bitop3_b32 v83, v5, v13, v14 bitop3:0xea
    ds_add_u32 v83, v2
    v_cvt_pk_bf16_f32 v85, v9, v10
    v_perm_b32 v12, v85, v85, s41
    v_bitop3_b32 v78, v4, v12, v78 bitop3:0xca
    v_perm_b32 v13, v85, v85, s42
    v_bitop3_b32 v79, v4, v13, v79 bitop3:0xca
    s_waitcnt vmcnt(5)
    v_lshlrev_b32 v7, 16, v86
    v_and_b32 v8, 0xffff0000, v86
    v_lshlrev_b32 v9, 16, v87
    v_and_b32 v10, 0xffff0000, v87
    v_mul_f32 v7, 0.15915494, v7
    v_mul_f32 v8, 0.15915494, v8
    v_mul_f32 v9, 0.15915494, v9
    v_mul_f32 v10, 0.15915494, v10
    v_mul_hi_u32_u24 v14, 429497, v88
    v_lshrrev_b32 v12, 3, v92
    v_cos_f32 v7, v7
    v_lshlrev_b16 v13, 3, v92
    v_mad_i32_i24 v11, v14, s55, v88
    v_bitop3_b32 v12, v6, v13, v12 bitop3:0xca
    v_lshl_add_u32 v11, v11, 17, s40
    v_lshlrev_b16 v14, 8, v14
    v_lshrrev_b32 v13, 2, v92
    v_add_u32 v88, v12, v11
    v_bitop3_b32 v92, v5, v13, v14 bitop3:0xea
    ds_add_u32 v92, v2
    v_mul_hi_u32_u24 v14, 429497, v89
    v_lshrrev_b32 v12, 3, v93
    v_cos_f32 v8, v8
    v_lshlrev_b16 v13, 3, v93
    v_mad_i32_i24 v11, v14, s55, v89
    v_bitop3_b32 v12, v6, v13, v12 bitop3:0xca
    v_lshl_add_u32 v11, v11, 17, s40
    v_lshlrev_b16 v14, 8, v14
    v_lshrrev_b32 v13, 2, v93
    v_add_u32 v89, v12, v11
    v_bitop3_b32 v93, v5, v13, v14 bitop3:0xea
    ds_add_u32 v93, v2
    v_cvt_pk_bf16_f32 v86, v7, v8
    v_perm_b32 v12, v86, v86, s41
    v_bitop3_b32 v88, v4, v12, v88 bitop3:0xca
    v_perm_b32 v13, v86, v86, s42
    v_bitop3_b32 v89, v4, v13, v89 bitop3:0xca
    v_mul_hi_u32_u24 v14, 429497, v90
    v_lshrrev_b32 v12, 3, v94
    v_cos_f32 v9, v9
    v_lshlrev_b16 v13, 3, v94
    v_mad_i32_i24 v11, v14, s55, v90
    v_bitop3_b32 v12, v6, v13, v12 bitop3:0xca
    v_lshl_add_u32 v11, v11, 17, s40
    v_lshlrev_b16 v14, 8, v14
    v_lshrrev_b32 v13, 2, v94
    v_add_u32 v90, v12, v11
    v_bitop3_b32 v94, v5, v13, v14 bitop3:0xea
    ds_add_u32 v94, v2
    v_mul_hi_u32_u24 v14, 429497, v91
    v_lshrrev_b32 v12, 3, v95
    v_cos_f32 v10, v10
    v_lshlrev_b16 v13, 3, v95
    v_mad_i32_i24 v11, v14, s55, v91
    v_bitop3_b32 v12, v6, v13, v12 bitop3:0xca
    v_lshl_add_u32 v11, v11, 17, s40
    v_lshlrev_b16 v14, 8, v14
    v_lshrrev_b32 v13, 2, v95
    v_add_u32 v91, v12, v11
    v_bitop3_b32 v95, v5, v13, v14 bitop3:0xea
    ds_add_u32 v95, v2
    v_cvt_pk_bf16_f32 v87, v9, v10
    v_perm_b32 v12, v87, v87, s41
    v_bitop3_b32 v90, v4, v12, v90 bitop3:0xca
    v_perm_b32 v13, v87, v87, s42
    v_bitop3_b32 v91, v4, v13, v91 bitop3:0xca
    v_lshrrev_b32 v8, 2, v0
    v_and_b32 v7, 0x3c00, v0
    v_bitop3_b32 v7, v5, v8, v7 bitop3:0xea
    s_waitcnt lgkmcnt(0)
    s_barrier
    ds_read2st64_b32 v[8:9], v7 offset0:0 offset1:1
    ds_read2st64_b32 v[10:11], v7 offset0:2 offset1:3
    s_add_u32 s45, s97, 0x2400000
    v_lshlrev_b32 v112, 1, v1
    buffer_load_dwordx4 v[112:115], v112, s[12:15], s45 offen nt
    s_waitcnt lgkmcnt(0)
    v_lshl_or_b32 v12, v9, 16, v8
    v_lshl_or_b32 v13, v11, 16, v10
    v_mov_b32 v14, v12
    v_mov_b32 v15, v13
    s_nop 0
    v_add_u32_dpp v14, v14, v14 row_shr:1 row_mask:0xf bank_mask:0xf bound_ctrl:1
    v_add_u32_dpp v15, v15, v15 row_shr:1 row_mask:0xf bank_mask:0xf bound_ctrl:1
    s_nop 0
    v_add_u32_dpp v14, v14, v14 row_shr:2 row_mask:0xf bank_mask:0xf bound_ctrl:1
    v_add_u32_dpp v15, v15, v15 row_shr:2 row_mask:0xf bank_mask:0xf bound_ctrl:1
    s_nop 0
    v_add_u32_dpp v14, v14, v14 row_shr:4 row_mask:0xf bank_mask:0xf bound_ctrl:1
    v_add_u32_dpp v15, v15, v15 row_shr:4 row_mask:0xf bank_mask:0xf bound_ctrl:1
    s_nop 0
    v_add_u32_dpp v14, v14, v14 row_shr:8 row_mask:0xf bank_mask:0xf bound_ctrl:1
    v_add_u32_dpp v15, v15, v15 row_shr:8 row_mask:0xf bank_mask:0xf bound_ctrl:1
    s_nop 0
    v_add_u32_dpp v14, v14, v14 row_bcast:15 row_mask:0xa bank_mask:0xf
    v_add_u32_dpp v15, v15, v15 row_bcast:15 row_mask:0xa bank_mask:0xf
    s_nop 0
    v_add_u32_dpp v14, v14, v14 row_bcast:31 row_mask:0xc bank_mask:0xf
    v_add_u32_dpp v15, v15, v15 row_bcast:31 row_mask:0xc bank_mask:0xf
    v_readlane_b32 s48, v14, 63
    v_readlane_b32 s49, v15, 63
    s_lshl_b32 s54, s32, 2
    v_mov_b32 v8, s54
    s_and_b32 s50, s48, 0xffff
    s_lshr_b32 s51, s48, 16
    s_and_b32 s52, s49, 0xffff
    s_lshr_b32 s53, s49, 16
    s_add_u32 s51, s51, s50
    s_add_u32 s52, s52, s51
    s_add_u32 s53, s53, s52
    v_mov_b32 v9, s53
    s_mov_b64 exec, 1
    ds_write_b32 v8, v9 offset:16384
    s_mov_b64 exec, -1
    v_and_b32 v8, 60, v7
    s_waitcnt lgkmcnt(0)
    s_barrier
    ds_read_b32 v9, v8 offset:16384
    s_waitcnt lgkmcnt(0)
    v_add_u32_dpp v9, v9, v9 row_shr:1 row_mask:0xf bank_mask:0xf bound_ctrl:1
    s_nop 1
    v_add_u32_dpp v9, v9, v9 row_shr:2 row_mask:0xf bank_mask:0xf bound_ctrl:1
    s_nop 1
    v_add_u32_dpp v9, v9, v9 row_shr:4 row_mask:0xf bank_mask:0xf bound_ctrl:1
    s_nop 1
    v_add_u32_dpp v9, v9, v9 row_shr:8 row_mask:0xf bank_mask:0xf bound_ctrl:1
    s_nop 0
    v_readlane_b32 s54, v9, s32
    s_sub_u32 s54, s54, s53
    s_add_u32 s50, s50, s54
    s_add_u32 s51, s51, s54
    s_add_u32 s52, s52, s54
    s_pack_ll_b32_b16 s48, s54, s50
    s_pack_ll_b32_b16 s49, s51, s52
    v_add_u32 v14, s48, v14
    v_add_u32 v15, s49, v15
    v_sub_u32 v12, v14, v12
    v_sub_u32 v13, v15, v13
    v_and_b32 v8, 0xffff, v12
    v_lshrrev_b32 v9, 16, v12
    v_and_b32 v10, 0xffff, v13
    v_lshrrev_b32 v11, 16, v13
    ds_write2st64_b32 v7, v8, v9 offset0:0 offset1:1
    ds_write2st64_b32 v7, v10, v11 offset0:2 offset1:3
    v_and_b32 v8, 0x3f0, v0
    v_lshl_add_u32 v8, v8, 1, s36
    ds_write_b64 v8, v[12:13] offset:20480
    s_bitset0_b64 exec, 63
    s_not_b64 exec, exec
    ds_write_b64 v8, v[14:15] offset:20512
    s_mov_b64 exec, -1
    s_waitcnt lgkmcnt(0)
    s_barrier
    s_setprio 3
    ds_add_rtn_u32 v20, v20, v2
    ds_add_rtn_u32 v21, v21, v2
    ds_add_rtn_u32 v22, v22, v2
    ds_add_rtn_u32 v23, v23, v2
    ds_read_b128 v[12:15], v0 offset:20480
    v_cmp_gt_u32 vcc, 8448, v0
    ds_add_rtn_u32 v32, v32, v2
    ds_add_rtn_u32 v33, v33, v2
    ds_add_rtn_u32 v34, v34, v2
    ds_add_rtn_u32 v35, v35, v2
    s_setprio 2
    ds_add_rtn_u32 v40, v40, v2
    ds_add_rtn_u32 v41, v41, v2
    ds_add_rtn_u32 v42, v42, v2
    ds_add_rtn_u32 v43, v43, v2
    s_waitcnt lgkmcnt(8)
    s_cbranch_vccz L1_p1
    s_add_u32 s46, s35, 0x0
    s_mov_b64 exec, vcc
    buffer_store_dwordx4 v[12:15], v0, s[24:27], s46 offen sc1
    s_mov_b64 exec, -1
L1_p1:
    s_add_u32 s47, s98, 0x2800000
    v_lshlrev_b32 v116, 1, v1
    buffer_load_dwordx4 v[116:119], v116, s[8:11], s47 offen nt
    ds_add_rtn_u32 v52, v52, v2
    ds_add_rtn_u32 v53, v53, v2
    ds_add_rtn_u32 v54, v54, v2
    ds_add_rtn_u32 v55, v55, v2
    s_setprio 1
    ds_add_rtn_u32 v60, v60, v2
    ds_add_rtn_u32 v61, v61, v2
    ds_add_rtn_u32 v62, v62, v2
    ds_add_rtn_u32 v63, v63, v2
    ds_add_rtn_u32 v72, v72, v2
    ds_add_rtn_u32 v73, v73, v2
    ds_add_rtn_u32 v74, v74, v2
    ds_add_rtn_u32 v75, v75, v2
    s_add_u32 s44, s98, 0x2800000
    v_lshlrev_b32 v120, 1, v1
    buffer_load_dwordx4 v[120:123], v120, s[12:15], s44 offen nt
    s_setprio 0
    ds_add_rtn_u32 v80, v80, v2
    ds_add_rtn_u32 v81, v81, v2
    ds_add_rtn_u32 v82, v82, v2
    ds_add_rtn_u32 v83, v83, v2
    ds_add_rtn_u32 v92, v92, v2
    ds_add_rtn_u32 v93, v93, v2
    ds_add_rtn_u32 v94, v94, v2
    ds_add_rtn_u32 v95, v95, v2
    s_waitcnt lgkmcnt(0)
    s_barrier
    s_setprio 3
    v_and_b32 v7, -4, v20
    v_lshl_add_u32 v8, v20, 2, v7
    ds_write_b32 v8, v16
    v_lshl_add_u32 v7, v7, 2, v20
    ds_write_b8 v7, v24 offset:16
    v_and_b32 v9, -4, v21
    v_lshl_add_u32 v10, v21, 2, v9
    ds_write_b32 v10, v17
    v_lshl_add_u32 v9, v9, 2, v21
    ds_write_b8_d16_hi v9, v24 offset:16
    v_and_b32 v7, -4, v22
    v_lshl_add_u32 v8, v22, 2, v7
    ds_write_b32 v8, v18
    v_lshl_add_u32 v7, v7, 2, v22
    ds_write_b8 v7, v25 offset:16
    v_and_b32 v9, -4, v23
    v_lshl_add_u32 v10, v23, 2, v9
    ds_write_b32 v10, v19
    v_lshl_add_u32 v9, v9, 2, v23
    ds_write_b8_d16_hi v9, v25 offset:16
    s_add_u32 s45, s98, 0x2800000
    s_lshr_b32 s45, s45, 1
    buffer_load_dwordx2 v[124:125], v1, s[16:19], s45 offen nt
    s_add_u32 s46, s99, 0x2c00000
    s_lshr_b32 s46, s46, 1
    buffer_load_dwordx2 v[126:127], v1, s[16:19], s46 offen nt
    s_add_u32 s47, s99, 0x2c00000
    v_lshlrev_b32 v16, 1, v1
    buffer_load_dwordx4 v[16:19], v16, s[8:11], s47 offen nt
    v_and_b32 v7, -4, v32
    v_lshl_add_u32 v8, v32, 2, v7
    ds_write_b32 v8, v28
    v_lshl_add_u32 v7, v7, 2, v32
    ds_write_b8 v7, v26 offset:16
    v_and_b32 v9, -4, v33
    v_lshl_add_u32 v10, v33, 2, v9
    ds_write_b32 v10, v29
    v_lshl_add_u32 v9, v9, 2, v33
    ds_write_b8_d16_hi v9, v26 offset:16
    v_and_b32 v7, -4, v34
    v_lshl_add_u32 v8, v34, 2, v7
    ds_write_b32 v8, v30
    v_lshl_add_u32 v7, v7, 2, v34
    ds_write_b8 v7, v27 offset:16
    v_and_b32 v9, -4, v35
    v_lshl_add_u32 v10, v35, 2, v9
    ds_write_b32 v10, v31
    v_lshl_add_u32 v9, v9, 2, v35
    ds_write_b8_d16_hi v9, v27 offset:16
    s_add_u32 s44, s99, 0x2c00000
    v_lshlrev_b32 v20, 1, v1
    buffer_load_dwordx4 v[20:23], v20, s[12:15], s44 offen nt
    s_setprio 2
    v_and_b32 v7, -4, v40
    v_lshl_add_u32 v8, v40, 2, v7
    ds_write_b32 v8, v36
    v_lshl_add_u32 v7, v7, 2, v40
    ds_write_b8 v7, v44 offset:16
    v_and_b32 v9, -4, v41
    v_lshl_add_u32 v10, v41, 2, v9
    ds_write_b32 v10, v37
    v_lshl_add_u32 v9, v9, 2, v41
    ds_write_b8_d16_hi v9, v44 offset:16
    v_and_b32 v7, -4, v42
    v_lshl_add_u32 v8, v42, 2, v7
    ds_write_b32 v8, v38
    v_lshl_add_u32 v7, v7, 2, v42
    ds_write_b8 v7, v45 offset:16
    v_and_b32 v9, -4, v43
    v_lshl_add_u32 v10, v43, 2, v9
    ds_write_b32 v10, v39
    v_lshl_add_u32 v9, v9, 2, v43
    ds_write_b8_d16_hi v9, v45 offset:16
    s_add_u32 s45, s96, 0x3000000
    v_lshlrev_b32 v28, 1, v1
    buffer_load_dwordx4 v[28:31], v28, s[8:11], s45 offen nt
    s_add_u32 s46, s96, 0x3000000
    v_lshlrev_b32 v32, 1, v1
    buffer_load_dwordx4 v[32:35], v32, s[12:15], s46 offen nt
    v_and_b32 v7, -4, v52
    v_lshl_add_u32 v8, v52, 2, v7
    ds_write_b32 v8, v48
    v_lshl_add_u32 v7, v7, 2, v52
    ds_write_b8 v7, v46 offset:16
    v_and_b32 v9, -4, v53
    v_lshl_add_u32 v10, v53, 2, v9
    ds_write_b32 v10, v49
    v_lshl_add_u32 v9, v9, 2, v53
    ds_write_b8_d16_hi v9, v46 offset:16
    v_and_b32 v7, -4, v54
    v_lshl_add_u32 v8, v54, 2, v7
    ds_write_b32 v8, v50
    v_lshl_add_u32 v7, v7, 2, v54
    ds_write_b8 v7, v47 offset:16
    v_and_b32 v9, -4, v55
    v_lshl_add_u32 v10, v55, 2, v9
    ds_write_b32 v10, v51
    v_lshl_add_u32 v9, v9, 2, v55
    ds_write_b8_d16_hi v9, v47 offset:16
    s_add_u32 s47, s96, 0x3000000
    s_lshr_b32 s47, s47, 1
    buffer_load_dwordx2 v[24:25], v1, s[16:19], s47 offen nt
    s_add_u32 s44, s97, 0x3400000
    s_lshr_b32 s44, s44, 1
    buffer_load_dwordx2 v[26:27], v1, s[16:19], s44 offen nt
    s_setprio 1
    v_and_b32 v7, -4, v60
    v_lshl_add_u32 v8, v60, 2, v7
    ds_write_b32 v8, v56
    v_lshl_add_u32 v7, v7, 2, v60
    ds_write_b8 v7, v64 offset:16
    v_and_b32 v9, -4, v61
    v_lshl_add_u32 v10, v61, 2, v9
    ds_write_b32 v10, v57
    v_lshl_add_u32 v9, v9, 2, v61
    ds_write_b8_d16_hi v9, v64 offset:16
    v_and_b32 v7, -4, v62
    v_lshl_add_u32 v8, v62, 2, v7
    ds_write_b32 v8, v58
    v_lshl_add_u32 v7, v7, 2, v62
    ds_write_b8 v7, v65 offset:16
    v_and_b32 v9, -4, v63
    v_lshl_add_u32 v10, v63, 2, v9
    ds_write_b32 v10, v59
    v_lshl_add_u32 v9, v9, 2, v63
    ds_write_b8_d16_hi v9, v65 offset:16
    s_add_u32 s45, s97, 0x3400000
    v_lshlrev_b32 v36, 1, v1
    buffer_load_dwordx4 v[36:39], v36, s[8:11], s45 offen nt
    v_and_b32 v7, -4, v72
    v_lshl_add_u32 v8, v72, 2, v7
    ds_write_b32 v8, v68
    v_lshl_add_u32 v7, v7, 2, v72
    ds_write_b8 v7, v66 offset:16
    v_and_b32 v9, -4, v73
    v_lshl_add_u32 v10, v73, 2, v9
    ds_write_b32 v10, v69
    v_lshl_add_u32 v9, v9, 2, v73
    ds_write_b8_d16_hi v9, v66 offset:16
    v_and_b32 v7, -4, v74
    v_lshl_add_u32 v8, v74, 2, v7
    ds_write_b32 v8, v70
    v_lshl_add_u32 v7, v7, 2, v74
    ds_write_b8 v7, v67 offset:16
    v_and_b32 v9, -4, v75
    v_lshl_add_u32 v10, v75, 2, v9
    ds_write_b32 v10, v71
    v_lshl_add_u32 v9, v9, 2, v75
    ds_write_b8_d16_hi v9, v67 offset:16
    s_add_u32 s46, s97, 0x3400000
    v_lshlrev_b32 v40, 1, v1
    buffer_load_dwordx4 v[40:43], v40, s[12:15], s46 offen nt
    s_add_u32 s47, s98, 0x3800000
    v_lshlrev_b32 v48, 1, v1
    buffer_load_dwordx4 v[48:51], v48, s[8:11], s47 offen nt
    s_setprio 0
    v_and_b32 v7, -4, v80
    v_lshl_add_u32 v8, v80, 2, v7
    ds_write_b32 v8, v76
    v_lshl_add_u32 v7, v7, 2, v80
    ds_write_b8 v7, v84 offset:16
    v_and_b32 v9, -4, v81
    v_lshl_add_u32 v10, v81, 2, v9
    ds_write_b32 v10, v77
    v_lshl_add_u32 v9, v9, 2, v81
    ds_write_b8_d16_hi v9, v84 offset:16
    v_and_b32 v7, -4, v82
    v_lshl_add_u32 v8, v82, 2, v7
    ds_write_b32 v8, v78
    v_lshl_add_u32 v7, v7, 2, v82
    ds_write_b8 v7, v85 offset:16
    v_and_b32 v9, -4, v83
    v_lshl_add_u32 v10, v83, 2, v9
    ds_write_b32 v10, v79
    v_lshl_add_u32 v9, v9, 2, v83
    ds_write_b8_d16_hi v9, v85 offset:16
    s_add_u32 s44, s98, 0x3800000
    v_lshlrev_b32 v52, 1, v1
    buffer_load_dwordx4 v[52:55], v52, s[12:15], s44 offen nt
    v_and_b32 v7, -4, v92
    v_lshl_add_u32 v8, v92, 2, v7
    ds_write_b32 v8, v88
    v_lshl_add_u32 v7, v7, 2, v92
    ds_write_b8 v7, v86 offset:16
    v_and_b32 v9, -4, v93
    v_lshl_add_u32 v10, v93, 2, v9
    ds_write_b32 v10, v89
    v_lshl_add_u32 v9, v9, 2, v93
    ds_write_b8_d16_hi v9, v86 offset:16
    v_and_b32 v7, -4, v94
    v_lshl_add_u32 v8, v94, 2, v7
    ds_write_b32 v8, v90
    v_lshl_add_u32 v7, v7, 2, v94
    ds_write_b8 v7, v87 offset:16
    v_and_b32 v9, -4, v95
    v_lshl_add_u32 v10, v95, 2, v9
    ds_write_b32 v10, v91
    v_lshl_add_u32 v9, v9, 2, v95
    ds_write_b8_d16_hi v9, v87 offset:16
    s_add_u32 s45, s98, 0x3800000
    s_lshr_b32 s45, s45, 1
    buffer_load_dwordx2 v[44:45], v1, s[16:19], s45 offen nt
    s_add_u32 s46, s99, 0x3c00000
    s_lshr_b32 s46, s46, 1
    buffer_load_dwordx2 v[46:47], v1, s[16:19], s46 offen nt
    v_add_u32 v7, s72, v0
    v_add_u32 v12, s73, v0
    v_add_u32 v13, s85, v0
    v_add_u32 v14, s91, v0
    v_add_u32 v15, s93, v0
    s_min_i32 s3, s72, s73
    s_min_i32 s3, s3, s85
    s_min_i32 s3, s3, s91
    s_min_i32 s3, s3, s93
    v_add_u32 v3, s3, v0
    v_mov_b32 v8, 0
    v_mov_b32 v9, 0
    v_mov_b32 v10, 0
    v_mov_b32 v11, 0
    s_waitcnt lgkmcnt(0)
    s_barrier
    ds_read_b128 v[56:59], v7 offset:0
    ds_read_b128 v[60:63], v12 offset:0
    ds_read_b128 v[68:71], v13 offset:0
    ds_read_b128 v[72:75], v14 offset:0
    ds_read_b128 v[64:67], v15 offset:0
    ds_write_b128 v3, v[8:11]
    ds_read_b128 v[76:79], v7 offset:16384
    ds_read_b128 v[80:83], v12 offset:16384
    ds_read_b128 v[88:91], v13 offset:16384
    ds_read_b128 v[92:95], v14 offset:16384
    ds_read_b128 v[84:87], v15 offset:16384
    s_waitcnt lgkmcnt(0)
    s_barrier
    s_setprio 3
    s_add_u32 s47, s35, 0x4000
    s_add_u32 s47, s47, s72
    buffer_store_dwordx4 v[56:59], v0, s[20:23], s47 offen sc1
    s_add_u32 s44, s99, 0x3c00000
    s_nop 0
    v_lshlrev_b32 v56, 1, v1
    buffer_load_dwordx4 v[56:59], v56, s[8:11], s44 offen nt
    s_add_u32 s45, s35, 0x4000
    s_add_u32 s45, s45, s73
    buffer_store_dwordx4 v[60:63], v0, s[20:23], s45 offen sc1
    s_add_u32 s46, s99, 0x3c00000
    s_nop 0
    v_lshlrev_b32 v60, 1, v1
    buffer_load_dwordx4 v[60:63], v60, s[12:15], s46 offen nt
    s_waitcnt vmcnt(22)
    v_lshlrev_b32 v7, 16, v108
    v_and_b32 v8, 0xffff0000, v108
    v_lshlrev_b32 v9, 16, v109
    v_and_b32 v10, 0xffff0000, v109
    v_mul_f32 v7, 0.15915494, v7
    v_mul_f32 v8, 0.15915494, v8
    v_mul_f32 v9, 0.15915494, v9
    v_mul_f32 v10, 0.15915494, v10
    v_mul_hi_u32_u24 v14, 429497, v96
    v_lshrrev_b32 v12, 3, v104
    v_cos_f32 v7, v7
    v_lshlrev_b16 v13, 3, v104
    v_mad_i32_i24 v11, v14, s55, v96
    v_bitop3_b32 v12, v6, v13, v12 bitop3:0xca
    v_lshl_add_u32 v11, v11, 17, s40
    v_lshlrev_b16 v14, 8, v14
    v_lshrrev_b32 v13, 2, v104
    v_add_u32 v96, v12, v11
    v_bitop3_b32 v104, v5, v13, v14 bitop3:0xea
    ds_add_u32 v104, v2
    v_mul_hi_u32_u24 v14, 429497, v97
    v_lshrrev_b32 v12, 3, v105
    v_cos_f32 v8, v8
    v_lshlrev_b16 v13, 3, v105
    v_mad_i32_i24 v11, v14, s55, v97
    v_bitop3_b32 v12, v6, v13, v12 bitop3:0xca
    v_lshl_add_u32 v11, v11, 17, s40
    v_lshlrev_b16 v14, 8, v14
    v_lshrrev_b32 v13, 2, v105
    v_add_u32 v97, v12, v11
    v_bitop3_b32 v105, v5, v13, v14 bitop3:0xea
    ds_add_u32 v105, v2
    v_cvt_pk_bf16_f32 v108, v7, v8
    v_perm_b32 v12, v108, v108, s41
    v_bitop3_b32 v96, v4, v12, v96 bitop3:0xca
    v_perm_b32 v13, v108, v108, s42
    v_bitop3_b32 v97, v4, v13, v97 bitop3:0xca
    v_mul_hi_u32_u24 v14, 429497, v98
    v_lshrrev_b32 v12, 3, v106
    v_cos_f32 v9, v9
    v_lshlrev_b16 v13, 3, v106
    v_mad_i32_i24 v11, v14, s55, v98
    v_bitop3_b32 v12, v6, v13, v12 bitop3:0xca
    v_lshl_add_u32 v11, v11, 17, s40
    v_lshlrev_b16 v14, 8, v14
    v_lshrrev_b32 v13, 2, v106
    v_add_u32 v98, v12, v11
    v_bitop3_b32 v106, v5, v13, v14 bitop3:0xea
    ds_add_u32 v106, v2
    v_mul_hi_u32_u24 v14, 429497, v99
    v_lshrrev_b32 v12, 3, v107
    v_cos_f32 v10, v10
    v_lshlrev_b16 v13, 3, v107
    v_mad_i32_i24 v11, v14, s55, v99
    v_bitop3_b32 v12, v6, v13, v12 bitop3:0xca
    v_lshl_add_u32 v11, v11, 17, s40
    v_lshlrev_b16 v14, 8, v14
    v_lshrrev_b32 v13, 2, v107
    v_add_u32 v99, v12, v11
    v_bitop3_b32 v107, v5, v13, v14 bitop3:0xea
    ds_add_u32 v107, v2
    v_cvt_pk_bf16_f32 v109, v9, v10
    v_perm_b32 v12, v109, v109, s41
    v_bitop3_b32 v98, v4, v12, v98 bitop3:0xca
    v_perm_b32 v13, v109, v109, s42
    v_bitop3_b32 v99, v4, v13, v99 bitop3:0xca
    s_waitcnt vmcnt(20)
    v_lshlrev_b32 v7, 16, v110
    v_and_b32 v8, 0xffff0000, v110
    v_lshlrev_b32 v9, 16, v111
    v_and_b32 v10, 0xffff0000, v111
    v_mul_f32 v7, 0.15915494, v7
    v_mul_f32 v8, 0.15915494, v8
    v_mul_f32 v9, 0.15915494, v9
    v_mul_f32 v10, 0.15915494, v10
    v_mul_hi_u32_u24 v14, 429497, v100
    v_lshrrev_b32 v12, 3, v112
    v_cos_f32 v7, v7
    v_lshlrev_b16 v13, 3, v112
    v_mad_i32_i24 v11, v14, s55, v100
    v_bitop3_b32 v12, v6, v13, v12 bitop3:0xca
    v_lshl_add_u32 v11, v11, 17, s40
    v_lshlrev_b16 v14, 8, v14
    v_lshrrev_b32 v13, 2, v112
    v_add_u32 v100, v12, v11
    v_bitop3_b32 v112, v5, v13, v14 bitop3:0xea
    ds_add_u32 v112, v2
    v_mul_hi_u32_u24 v14, 429497, v101
    v_lshrrev_b32 v12, 3, v113
    v_cos_f32 v8, v8
    v_lshlrev_b16 v13, 3, v113
    v_mad_i32_i24 v11, v14, s55, v101
    v_bitop3_b32 v12, v6, v13, v12 bitop3:0xca
    v_lshl_add_u32 v11, v11, 17, s40
    v_lshlrev_b16 v14, 8, v14
    v_lshrrev_b32 v13, 2, v113
    v_add_u32 v101, v12, v11
    v_bitop3_b32 v113, v5, v13, v14 bitop3:0xea
    ds_add_u32 v113, v2
    v_cvt_pk_bf16_f32 v110, v7, v8
    v_perm_b32 v12, v110, v110, s41
    v_bitop3_b32 v100, v4, v12, v100 bitop3:0xca
    v_perm_b32 v13, v110, v110, s42
    v_bitop3_b32 v101, v4, v13, v101 bitop3:0xca
    v_mul_hi_u32_u24 v14, 429497, v102
    v_lshrrev_b32 v12, 3, v114
    v_cos_f32 v9, v9
    v_lshlrev_b16 v13, 3, v114
    v_mad_i32_i24 v11, v14, s55, v102
    v_bitop3_b32 v12, v6, v13, v12 bitop3:0xca
    v_lshl_add_u32 v11, v11, 17, s40
    v_lshlrev_b16 v14, 8, v14
    v_lshrrev_b32 v13, 2, v114
    v_add_u32 v102, v12, v11
    v_bitop3_b32 v114, v5, v13, v14 bitop3:0xea
    ds_add_u32 v114, v2
    v_mul_hi_u32_u24 v14, 429497, v103
    v_lshrrev_b32 v12, 3, v115
    v_cos_f32 v10, v10
    v_lshlrev_b16 v13, 3, v115
    v_mad_i32_i24 v11, v14, s55, v103
    v_bitop3_b32 v12, v6, v13, v12 bitop3:0xca
    v_lshl_add_u32 v11, v11, 17, s40
    v_lshlrev_b16 v14, 8, v14
    v_lshrrev_b32 v13, 2, v115
    v_add_u32 v103, v12, v11
    v_bitop3_b32 v115, v5, v13, v14 bitop3:0xea
    ds_add_u32 v115, v2
    v_cvt_pk_bf16_f32 v111, v9, v10
    v_perm_b32 v12, v111, v111, s41
    v_bitop3_b32 v102, v4, v12, v102 bitop3:0xca
    v_perm_b32 v13, v111, v111, s42
    v_bitop3_b32 v103, v4, v13, v103 bitop3:0xca
    s_setprio 2
    s_waitcnt vmcnt(16)
    v_lshlrev_b32 v7, 16, v124
    v_and_b32 v8, 0xffff0000, v124
    v_lshlrev_b32 v9, 16, v125
    v_and_b32 v10, 0xffff0000, v125
    v_mul_f32 v7, 0.15915494, v7
    v_mul_f32 v8, 0.15915494, v8
    v_mul_f32 v9, 0.15915494, v9
    v_mul_f32 v10, 0.15915494, v10
    v_mul_hi_u32_u24 v14, 429497, v116
    v_lshrrev_b32 v12, 3, v120
    v_cos_f32 v7, v7
    v_lshlrev_b16 v13, 3, v120
    v_mad_i32_i24 v11, v14, s55, v116
    v_bitop3_b32 v12, v6, v13, v12 bitop3:0xca
    v_lshl_add_u32 v11, v11, 17, s40
    v_lshlrev_b16 v14, 8, v14
    v_lshrrev_b32 v13, 2, v120
    v_add_u32 v116, v12, v11
    v_bitop3_b32 v120, v5, v13, v14 bitop3:0xea
    ds_add_u32 v120, v2
    v_mul_hi_u32_u24 v14, 429497, v117
    v_lshrrev_b32 v12, 3, v121
    v_cos_f32 v8, v8
    v_lshlrev_b16 v13, 3, v121
    v_mad_i32_i24 v11, v14, s55, v117
    v_bitop3_b32 v12, v6, v13, v12 bitop3:0xca
    v_lshl_add_u32 v11, v11, 17, s40
    v_lshlrev_b16 v14, 8, v14
    v_lshrrev_b32 v13, 2, v121
    v_add_u32 v117, v12, v11
    v_bitop3_b32 v121, v5, v13, v14 bitop3:0xea
    ds_add_u32 v121, v2
    v_cvt_pk_bf16_f32 v124, v7, v8
    v_perm_b32 v12, v124, v124, s41
    v_bitop3_b32 v116, v4, v12, v116 bitop3:0xca
    v_perm_b32 v13, v124, v124, s42
    v_bitop3_b32 v117, v4, v13, v117 bitop3:0xca
    v_mul_hi_u32_u24 v14, 429497, v118
    v_lshrrev_b32 v12, 3, v122
    v_cos_f32 v9, v9
    v_lshlrev_b16 v13, 3, v122
    v_mad_i32_i24 v11, v14, s55, v118
    v_bitop3_b32 v12, v6, v13, v12 bitop3:0xca
    v_lshl_add_u32 v11, v11, 17, s40
    v_lshlrev_b16 v14, 8, v14
    v_lshrrev_b32 v13, 2, v122
    v_add_u32 v118, v12, v11
    v_bitop3_b32 v122, v5, v13, v14 bitop3:0xea
    ds_add_u32 v122, v2
    v_mul_hi_u32_u24 v14, 429497, v119
    v_lshrrev_b32 v12, 3, v123
    v_cos_f32 v10, v10
    v_lshlrev_b16 v13, 3, v123
    v_mad_i32_i24 v11, v14, s55, v119
    v_bitop3_b32 v12, v6, v13, v12 bitop3:0xca
    v_lshl_add_u32 v11, v11, 17, s40
    v_lshlrev_b16 v14, 8, v14
    v_lshrrev_b32 v13, 2, v123
    v_add_u32 v119, v12, v11
    v_bitop3_b32 v123, v5, v13, v14 bitop3:0xea
    ds_add_u32 v123, v2
    v_cvt_pk_bf16_f32 v125, v9, v10
    v_perm_b32 v12, v125, v125, s41
    v_bitop3_b32 v118, v4, v12, v118 bitop3:0xca
    v_perm_b32 v13, v125, v125, s42
    v_bitop3_b32 v119, v4, v13, v119 bitop3:0xca
    s_add_u32 s47, s35, 0x4000
    s_add_u32 s47, s47, s85
    buffer_store_dwordx4 v[68:71], v0, s[20:23], s47 offen sc1
    s_add_u32 s44, s96, 0x4000000
    s_nop 0
    v_lshlrev_b32 v68, 1, v1
    buffer_load_dwordx4 v[68:71], v68, s[8:11], s44 offen nt
    s_waitcnt vmcnt(16)
    v_lshlrev_b32 v7, 16, v126
    v_and_b32 v8, 0xffff0000, v126
    v_lshlrev_b32 v9, 16, v127
    v_and_b32 v10, 0xffff0000, v127
    v_mul_f32 v7, 0.15915494, v7
    v_mul_f32 v8, 0.15915494, v8
    v_mul_f32 v9, 0.15915494, v9
    v_mul_f32 v10, 0.15915494, v10
    v_mul_hi_u32_u24 v14, 429497, v16
    v_lshrrev_b32 v12, 3, v20
    v_cos_f32 v7, v7
    v_lshlrev_b16 v13, 3, v20
    v_mad_i32_i24 v11, v14, s55, v16
    v_bitop3_b32 v12, v6, v13, v12 bitop3:0xca
    v_lshl_add_u32 v11, v11, 17, s40
    v_lshlrev_b16 v14, 8, v14
    v_lshrrev_b32 v13, 2, v20
    v_add_u32 v16, v12, v11
    v_bitop3_b32 v20, v5, v13, v14 bitop3:0xea
    ds_add_u32 v20, v2
    v_mul_hi_u32_u24 v14, 429497, v17
    v_lshrrev_b32 v12, 3, v21
    v_cos_f32 v8, v8
    v_lshlrev_b16 v13, 3, v21
    v_mad_i32_i24 v11, v14, s55, v17
    v_bitop3_b32 v12, v6, v13, v12 bitop3:0xca
    v_lshl_add_u32 v11, v11, 17, s40
    v_lshlrev_b16 v14, 8, v14
    v_lshrrev_b32 v13, 2, v21
    v_add_u32 v17, v12, v11
    v_bitop3_b32 v21, v5, v13, v14 bitop3:0xea
    ds_add_u32 v21, v2
    v_cvt_pk_bf16_f32 v126, v7, v8
    v_perm_b32 v12, v126, v126, s41
    v_bitop3_b32 v16, v4, v12, v16 bitop3:0xca
    v_perm_b32 v13, v126, v126, s42
    v_bitop3_b32 v17, v4, v13, v17 bitop3:0xca
    v_mul_hi_u32_u24 v14, 429497, v18
    v_lshrrev_b32 v12, 3, v22
    v_cos_f32 v9, v9
    v_lshlrev_b16 v13, 3, v22
    v_mad_i32_i24 v11, v14, s55, v18
    v_bitop3_b32 v12, v6, v13, v12 bitop3:0xca
    v_lshl_add_u32 v11, v11, 17, s40
    v_lshlrev_b16 v14, 8, v14
    v_lshrrev_b32 v13, 2, v22
    v_add_u32 v18, v12, v11
    v_bitop3_b32 v22, v5, v13, v14 bitop3:0xea
    ds_add_u32 v22, v2
    v_mul_hi_u32_u24 v14, 429497, v19
    v_lshrrev_b32 v12, 3, v23
    v_cos_f32 v10, v10
    v_lshlrev_b16 v13, 3, v23
    v_mad_i32_i24 v11, v14, s55, v19
    v_bitop3_b32 v12, v6, v13, v12 bitop3:0xca
    v_lshl_add_u32 v11, v11, 17, s40
    v_lshlrev_b16 v14, 8, v14
    v_lshrrev_b32 v13, 2, v23
    v_add_u32 v19, v12, v11
    v_bitop3_b32 v23, v5, v13, v14 bitop3:0xea
    ds_add_u32 v23, v2
    v_cvt_pk_bf16_f32 v127, v9, v10
    v_perm_b32 v12, v127, v127, s41
    v_bitop3_b32 v18, v4, v12, v18 bitop3:0xca
    v_perm_b32 v13, v127, v127, s42
    v_bitop3_b32 v19, v4, v13, v19 bitop3:0xca
    s_setprio 1
    s_waitcnt vmcnt(12)
    v_lshlrev_b32 v7, 16, v24
    v_and_b32 v8, 0xffff0000, v24
    v_lshlrev_b32 v9, 16, v25
    v_and_b32 v10, 0xffff0000, v25
    v_mul_f32 v7, 0.15915494, v7
    v_mul_f32 v8, 0.15915494, v8
    v_mul_f32 v9, 0.15915494, v9
    v_mul_f32 v10, 0.15915494, v10
    v_mul_hi_u32_u24 v14, 429497, v28
    v_lshrrev_b32 v12, 3, v32
    v_cos_f32 v7, v7
    v_lshlrev_b16 v13, 3, v32
    v_mad_i32_i24 v11, v14, s55, v28
    v_bitop3_b32 v12, v6, v13, v12 bitop3:0xca
    v_lshl_add_u32 v11, v11, 17, s40
    v_lshlrev_b16 v14, 8, v14
    v_lshrrev_b32 v13, 2, v32
    v_add_u32 v28, v12, v11
    v_bitop3_b32 v32, v5, v13, v14 bitop3:0xea
    ds_add_u32 v32, v2
    v_mul_hi_u32_u24 v14, 429497, v29
    v_lshrrev_b32 v12, 3, v33
    v_cos_f32 v8, v8
    v_lshlrev_b16 v13, 3, v33
    v_mad_i32_i24 v11, v14, s55, v29
    v_bitop3_b32 v12, v6, v13, v12 bitop3:0xca
    v_lshl_add_u32 v11, v11, 17, s40
    v_lshlrev_b16 v14, 8, v14
    v_lshrrev_b32 v13, 2, v33
    v_add_u32 v29, v12, v11
    v_bitop3_b32 v33, v5, v13, v14 bitop3:0xea
    ds_add_u32 v33, v2
    v_cvt_pk_bf16_f32 v24, v7, v8
    v_perm_b32 v12, v24, v24, s41
    v_bitop3_b32 v28, v4, v12, v28 bitop3:0xca
    v_perm_b32 v13, v24, v24, s42
    v_bitop3_b32 v29, v4, v13, v29 bitop3:0xca
    v_mul_hi_u32_u24 v14, 429497, v30
    v_lshrrev_b32 v12, 3, v34
    v_cos_f32 v9, v9
    v_lshlrev_b16 v13, 3, v34
    v_mad_i32_i24 v11, v14, s55, v30
    v_bitop3_b32 v12, v6, v13, v12 bitop3:0xca
    v_lshl_add_u32 v11, v11, 17, s40
    v_lshlrev_b16 v14, 8, v14
    v_lshrrev_b32 v13, 2, v34
    v_add_u32 v30, v12, v11
    v_bitop3_b32 v34, v5, v13, v14 bitop3:0xea
    ds_add_u32 v34, v2
    v_mul_hi_u32_u24 v14, 429497, v31
    v_lshrrev_b32 v12, 3, v35
    v_cos_f32 v10, v10
    v_lshlrev_b16 v13, 3, v35
    v_mad_i32_i24 v11, v14, s55, v31
    v_bitop3_b32 v12, v6, v13, v12 bitop3:0xca
    v_lshl_add_u32 v11, v11, 17, s40
    v_lshlrev_b16 v14, 8, v14
    v_lshrrev_b32 v13, 2, v35
    v_add_u32 v31, v12, v11
    v_bitop3_b32 v35, v5, v13, v14 bitop3:0xea
    ds_add_u32 v35, v2
    v_cvt_pk_bf16_f32 v25, v9, v10
    v_perm_b32 v12, v25, v25, s41
    v_bitop3_b32 v30, v4, v12, v30 bitop3:0xca
    v_perm_b32 v13, v25, v25, s42
    v_bitop3_b32 v31, v4, v13, v31 bitop3:0xca
    s_waitcnt vmcnt(10)
    v_lshlrev_b32 v7, 16, v26
    v_and_b32 v8, 0xffff0000, v26
    v_lshlrev_b32 v9, 16, v27
    v_and_b32 v10, 0xffff0000, v27
    v_mul_f32 v7, 0.15915494, v7
    v_mul_f32 v8, 0.15915494, v8
    v_mul_f32 v9, 0.15915494, v9
    v_mul_f32 v10, 0.15915494, v10
    v_mul_hi_u32_u24 v14, 429497, v36
    v_lshrrev_b32 v12, 3, v40
    v_cos_f32 v7, v7
    v_lshlrev_b16 v13, 3, v40
    v_mad_i32_i24 v11, v14, s55, v36
    v_bitop3_b32 v12, v6, v13, v12 bitop3:0xca
    v_lshl_add_u32 v11, v11, 17, s40
    v_lshlrev_b16 v14, 8, v14
    v_lshrrev_b32 v13, 2, v40
    v_add_u32 v36, v12, v11
    v_bitop3_b32 v40, v5, v13, v14 bitop3:0xea
    ds_add_u32 v40, v2
    v_mul_hi_u32_u24 v14, 429497, v37
    v_lshrrev_b32 v12, 3, v41
    v_cos_f32 v8, v8
    v_lshlrev_b16 v13, 3, v41
    v_mad_i32_i24 v11, v14, s55, v37
    v_bitop3_b32 v12, v6, v13, v12 bitop3:0xca
    v_lshl_add_u32 v11, v11, 17, s40
    v_lshlrev_b16 v14, 8, v14
    v_lshrrev_b32 v13, 2, v41
    v_add_u32 v37, v12, v11
    v_bitop3_b32 v41, v5, v13, v14 bitop3:0xea
    ds_add_u32 v41, v2
    v_cvt_pk_bf16_f32 v26, v7, v8
    v_perm_b32 v12, v26, v26, s41
    v_bitop3_b32 v36, v4, v12, v36 bitop3:0xca
    v_perm_b32 v13, v26, v26, s42
    v_bitop3_b32 v37, v4, v13, v37 bitop3:0xca
    v_mul_hi_u32_u24 v14, 429497, v38
    v_lshrrev_b32 v12, 3, v42
    v_cos_f32 v9, v9
    v_lshlrev_b16 v13, 3, v42
    v_mad_i32_i24 v11, v14, s55, v38
    v_bitop3_b32 v12, v6, v13, v12 bitop3:0xca
    v_lshl_add_u32 v11, v11, 17, s40
    v_lshlrev_b16 v14, 8, v14
    v_lshrrev_b32 v13, 2, v42
    v_add_u32 v38, v12, v11
    v_bitop3_b32 v42, v5, v13, v14 bitop3:0xea
    ds_add_u32 v42, v2
    v_mul_hi_u32_u24 v14, 429497, v39
    v_lshrrev_b32 v12, 3, v43
    v_cos_f32 v10, v10
    v_lshlrev_b16 v13, 3, v43
    v_mad_i32_i24 v11, v14, s55, v39
    v_bitop3_b32 v12, v6, v13, v12 bitop3:0xca
    v_lshl_add_u32 v11, v11, 17, s40
    v_lshlrev_b16 v14, 8, v14
    v_lshrrev_b32 v13, 2, v43
    v_add_u32 v39, v12, v11
    v_bitop3_b32 v43, v5, v13, v14 bitop3:0xea
    ds_add_u32 v43, v2
    v_cvt_pk_bf16_f32 v27, v9, v10
    v_perm_b32 v12, v27, v27, s41
    v_bitop3_b32 v38, v4, v12, v38 bitop3:0xca
    v_perm_b32 v13, v27, v27, s42
    v_bitop3_b32 v39, v4, v13, v39 bitop3:0xca
    s_setprio 0
    s_add_u32 s45, s35, 0x4000
    s_add_u32 s45, s45, s91
    buffer_store_dwordx4 v[72:75], v0, s[20:23], s45 offen sc1
    s_add_u32 s46, s96, 0x4000000
    s_nop 0
    v_lshlrev_b32 v72, 1, v1
    buffer_load_dwordx4 v[72:75], v72, s[12:15], s46 offen nt
    s_waitcnt vmcnt(8)
    v_lshlrev_b32 v7, 16, v44
    v_and_b32 v8, 0xffff0000, v44
    v_lshlrev_b32 v9, 16, v45
    v_and_b32 v10, 0xffff0000, v45
    v_mul_f32 v7, 0.15915494, v7
    v_mul_f32 v8, 0.15915494, v8
    v_mul_f32 v9, 0.15915494, v9
    v_mul_f32 v10, 0.15915494, v10
    v_mul_hi_u32_u24 v14, 429497, v48
    v_lshrrev_b32 v12, 3, v52
    v_cos_f32 v7, v7
    v_lshlrev_b16 v13, 3, v52
    v_mad_i32_i24 v11, v14, s55, v48
    v_bitop3_b32 v12, v6, v13, v12 bitop3:0xca
    v_lshl_add_u32 v11, v11, 17, s40
    v_lshlrev_b16 v14, 8, v14
    v_lshrrev_b32 v13, 2, v52
    v_add_u32 v48, v12, v11
    v_bitop3_b32 v52, v5, v13, v14 bitop3:0xea
    ds_add_u32 v52, v2
    v_mul_hi_u32_u24 v14, 429497, v49
    v_lshrrev_b32 v12, 3, v53
    v_cos_f32 v8, v8
    v_lshlrev_b16 v13, 3, v53
    v_mad_i32_i24 v11, v14, s55, v49
    v_bitop3_b32 v12, v6, v13, v12 bitop3:0xca
    v_lshl_add_u32 v11, v11, 17, s40
    v_lshlrev_b16 v14, 8, v14
    v_lshrrev_b32 v13, 2, v53
    v_add_u32 v49, v12, v11
    v_bitop3_b32 v53, v5, v13, v14 bitop3:0xea
    ds_add_u32 v53, v2
    v_cvt_pk_bf16_f32 v44, v7, v8
    v_perm_b32 v12, v44, v44, s41
    v_bitop3_b32 v48, v4, v12, v48 bitop3:0xca
    v_perm_b32 v13, v44, v44, s42
    v_bitop3_b32 v49, v4, v13, v49 bitop3:0xca
    v_mul_hi_u32_u24 v14, 429497, v50
    v_lshrrev_b32 v12, 3, v54
    v_cos_f32 v9, v9
    v_lshlrev_b16 v13, 3, v54
    v_mad_i32_i24 v11, v14, s55, v50
    v_bitop3_b32 v12, v6, v13, v12 bitop3:0xca
    v_lshl_add_u32 v11, v11, 17, s40
    v_lshlrev_b16 v14, 8, v14
    v_lshrrev_b32 v13, 2, v54
    v_add_u32 v50, v12, v11
    v_bitop3_b32 v54, v5, v13, v14 bitop3:0xea
    ds_add_u32 v54, v2
    v_mul_hi_u32_u24 v14, 429497, v51
    v_lshrrev_b32 v12, 3, v55
    v_cos_f32 v10, v10
    v_lshlrev_b16 v13, 3, v55
    v_mad_i32_i24 v11, v14, s55, v51
    v_bitop3_b32 v12, v6, v13, v12 bitop3:0xca
    v_lshl_add_u32 v11, v11, 17, s40
    v_lshlrev_b16 v14, 8, v14
    v_lshrrev_b32 v13, 2, v55
    v_add_u32 v51, v12, v11
    v_bitop3_b32 v55, v5, v13, v14 bitop3:0xea
    ds_add_u32 v55, v2
    v_cvt_pk_bf16_f32 v45, v9, v10
    v_perm_b32 v12, v45, v45, s41
    v_bitop3_b32 v50, v4, v12, v50 bitop3:0xca
    v_perm_b32 v13, v45, v45, s42
    v_bitop3_b32 v51, v4, v13, v51 bitop3:0xca
    s_waitcnt vmcnt(4)
    v_lshlrev_b32 v7, 16, v46
    v_and_b32 v8, 0xffff0000, v46
    v_lshlrev_b32 v9, 16, v47
    v_and_b32 v10, 0xffff0000, v47
    v_mul_f32 v7, 0.15915494, v7
    v_mul_f32 v8, 0.15915494, v8
    v_mul_f32 v9, 0.15915494, v9
    v_mul_f32 v10, 0.15915494, v10
    v_mul_hi_u32_u24 v14, 429497, v56
    v_lshrrev_b32 v12, 3, v60
    v_cos_f32 v7, v7
    v_lshlrev_b16 v13, 3, v60
    v_mad_i32_i24 v11, v14, s55, v56
    v_bitop3_b32 v12, v6, v13, v12 bitop3:0xca
    v_lshl_add_u32 v11, v11, 17, s40
    v_lshlrev_b16 v14, 8, v14
    v_lshrrev_b32 v13, 2, v60
    v_add_u32 v56, v12, v11
    v_bitop3_b32 v60, v5, v13, v14 bitop3:0xea
    ds_add_u32 v60, v2
    v_mul_hi_u32_u24 v14, 429497, v57
    v_lshrrev_b32 v12, 3, v61
    v_cos_f32 v8, v8
    v_lshlrev_b16 v13, 3, v61
    v_mad_i32_i24 v11, v14, s55, v57
    v_bitop3_b32 v12, v6, v13, v12 bitop3:0xca
    v_lshl_add_u32 v11, v11, 17, s40
    v_lshlrev_b16 v14, 8, v14
    v_lshrrev_b32 v13, 2, v61
    v_add_u32 v57, v12, v11
    v_bitop3_b32 v61, v5, v13, v14 bitop3:0xea
    ds_add_u32 v61, v2
    v_cvt_pk_bf16_f32 v46, v7, v8
    v_perm_b32 v12, v46, v46, s41
    v_bitop3_b32 v56, v4, v12, v56 bitop3:0xca
    v_perm_b32 v13, v46, v46, s42
    v_bitop3_b32 v57, v4, v13, v57 bitop3:0xca
    v_mul_hi_u32_u24 v14, 429497, v58
    v_lshrrev_b32 v12, 3, v62
    v_cos_f32 v9, v9
    v_lshlrev_b16 v13, 3, v62
    v_mad_i32_i24 v11, v14, s55, v58
    v_bitop3_b32 v12, v6, v13, v12 bitop3:0xca
    v_lshl_add_u32 v11, v11, 17, s40
    v_lshlrev_b16 v14, 8, v14
    v_lshrrev_b32 v13, 2, v62
    v_add_u32 v58, v12, v11
    v_bitop3_b32 v62, v5, v13, v14 bitop3:0xea
    ds_add_u32 v62, v2
    v_mul_hi_u32_u24 v14, 429497, v59
    v_lshrrev_b32 v12, 3, v63
    v_cos_f32 v10, v10
    v_lshlrev_b16 v13, 3, v63
    v_mad_i32_i24 v11, v14, s55, v59
    v_bitop3_b32 v12, v6, v13, v12 bitop3:0xca
    v_lshl_add_u32 v11, v11, 17, s40
    v_lshlrev_b16 v14, 8, v14
    v_lshrrev_b32 v13, 2, v63
    v_add_u32 v59, v12, v11
    v_bitop3_b32 v63, v5, v13, v14 bitop3:0xea
    ds_add_u32 v63, v2
    v_cvt_pk_bf16_f32 v47, v9, v10
    v_perm_b32 v12, v47, v47, s41
    v_bitop3_b32 v58, v4, v12, v58 bitop3:0xca
    v_perm_b32 v13, v47, v47, s42
    v_bitop3_b32 v59, v4, v13, v59 bitop3:0xca
    v_lshrrev_b32 v8, 2, v0
    v_and_b32 v7, 0x3c00, v0
    v_bitop3_b32 v7, v5, v8, v7 bitop3:0xea
    s_waitcnt lgkmcnt(0)
    s_barrier
    ds_read2st64_b32 v[8:9], v7 offset0:0 offset1:1
    ds_read2st64_b32 v[10:11], v7 offset0:2 offset1:3
    s_add_u32 s47, s35, 0x4000
    s_add_u32 s47, s47, s93
    buffer_store_dwordx4 v[64:67], v0, s[20:23], s47 offen sc1
    s_add_u32 s44, s96, 0x4000000
    s_lshr_b32 s44, s44, 1
    buffer_load_dwordx2 v[64:65], v1, s[16:19], s44 offen nt
    s_add_u32 s45, s97, 0x4400000
    s_lshr_b32 s45, s45, 1
    buffer_load_dwordx2 v[66:67], v1, s[16:19], s45 offen nt
    s_waitcnt lgkmcnt(0)
    v_lshl_or_b32 v12, v9, 16, v8
    v_lshl_or_b32 v13, v11, 16, v10
    v_mov_b32 v14, v12
    v_mov_b32 v15, v13
    s_nop 0
    v_add_u32_dpp v14, v14, v14 row_shr:1 row_mask:0xf bank_mask:0xf bound_ctrl:1
    v_add_u32_dpp v15, v15, v15 row_shr:1 row_mask:0xf bank_mask:0xf bound_ctrl:1
    s_nop 0
    v_add_u32_dpp v14, v14, v14 row_shr:2 row_mask:0xf bank_mask:0xf bound_ctrl:1
    v_add_u32_dpp v15, v15, v15 row_shr:2 row_mask:0xf bank_mask:0xf bound_ctrl:1
    s_nop 0
    v_add_u32_dpp v14, v14, v14 row_shr:4 row_mask:0xf bank_mask:0xf bound_ctrl:1
    v_add_u32_dpp v15, v15, v15 row_shr:4 row_mask:0xf bank_mask:0xf bound_ctrl:1
    s_nop 0
    v_add_u32_dpp v14, v14, v14 row_shr:8 row_mask:0xf bank_mask:0xf bound_ctrl:1
    v_add_u32_dpp v15, v15, v15 row_shr:8 row_mask:0xf bank_mask:0xf bound_ctrl:1
    s_nop 0
    v_add_u32_dpp v14, v14, v14 row_bcast:15 row_mask:0xa bank_mask:0xf
    v_add_u32_dpp v15, v15, v15 row_bcast:15 row_mask:0xa bank_mask:0xf
    s_nop 0
    v_add_u32_dpp v14, v14, v14 row_bcast:31 row_mask:0xc bank_mask:0xf
    v_add_u32_dpp v15, v15, v15 row_bcast:31 row_mask:0xc bank_mask:0xf
    v_readlane_b32 s48, v14, 63
    v_readlane_b32 s49, v15, 63
    s_lshl_b32 s54, s32, 2
    v_mov_b32 v8, s54
    s_and_b32 s50, s48, 0xffff
    s_lshr_b32 s51, s48, 16
    s_and_b32 s52, s49, 0xffff
    s_lshr_b32 s53, s49, 16
    s_add_u32 s51, s51, s50
    s_add_u32 s52, s52, s51
    s_add_u32 s53, s53, s52
    v_mov_b32 v9, s53
    s_mov_b64 exec, 1
    ds_write_b32 v8, v9 offset:16384
    s_mov_b64 exec, -1
    v_and_b32 v8, 60, v7
    s_waitcnt lgkmcnt(0)
    s_barrier
    ds_read_b32 v9, v8 offset:16384
    s_waitcnt lgkmcnt(0)
    v_add_u32_dpp v9, v9, v9 row_shr:1 row_mask:0xf bank_mask:0xf bound_ctrl:1
    s_nop 1
    v_add_u32_dpp v9, v9, v9 row_shr:2 row_mask:0xf bank_mask:0xf bound_ctrl:1
    s_nop 1
    v_add_u32_dpp v9, v9, v9 row_shr:4 row_mask:0xf bank_mask:0xf bound_ctrl:1
    s_nop 1
    v_add_u32_dpp v9, v9, v9 row_shr:8 row_mask:0xf bank_mask:0xf bound_ctrl:1
    s_nop 0
    v_readlane_b32 s54, v9, s32
    s_sub_u32 s54, s54, s53
    s_add_u32 s50, s50, s54
    s_add_u32 s51, s51, s54
    s_add_u32 s52, s52, s54
    s_pack_ll_b32_b16 s48, s54, s50
    s_pack_ll_b32_b16 s49, s51, s52
    v_add_u32 v14, s48, v14
    v_add_u32 v15, s49, v15
    v_sub_u32 v12, v14, v12
    v_sub_u32 v13, v15, v13
    v_and_b32 v8, 0xffff, v12
    v_lshrrev_b32 v9, 16, v12
    v_and_b32 v10, 0xffff, v13
    v_lshrrev_b32 v11, 16, v13
    ds_write2st64_b32 v7, v8, v9 offset0:0 offset1:1
    ds_write2st64_b32 v7, v10, v11 offset0:2 offset1:3
    v_and_b32 v8, 0x3f0, v0
    v_lshl_add_u32 v8, v8, 1, s36
    ds_write_b64 v8, v[12:13] offset:20480
    s_bitset0_b64 exec, 63
    s_not_b64 exec, exec
    ds_write_b64 v8, v[14:15] offset:20512
    s_mov_b64 exec, -1
    s_waitcnt lgkmcnt(0)
    s_barrier
    s_setprio 3
    ds_add_rtn_u32 v104, v104, v2
    ds_add_rtn_u32 v105, v105, v2
    ds_add_rtn_u32 v106, v106, v2
    ds_add_rtn_u32 v107, v107, v2
    ds_read_b128 v[12:15], v0 offset:20480
    v_cmp_gt_u32 vcc, 8448, v0
    ds_add_rtn_u32 v112, v112, v2
    ds_add_rtn_u32 v113, v113, v2
    ds_add_rtn_u32 v114, v114, v2
    ds_add_rtn_u32 v115, v115, v2
    s_setprio 2
    ds_add_rtn_u32 v120, v120, v2
    ds_add_rtn_u32 v121, v121, v2
    ds_add_rtn_u32 v122, v122, v2
    ds_add_rtn_u32 v123, v123, v2
    s_waitcnt lgkmcnt(8)
    s_cbranch_vccz L1_p2
    s_add_u32 s46, s35, 0x2a40000
    s_mov_b64 exec, vcc
    buffer_store_dwordx4 v[12:15], v0, s[24:27], s46 offen sc1
    s_mov_b64 exec, -1
L1_p2:
    s_add_u32 s47, s35, 0x8000
    s_add_u32 s47, s47, s72
    buffer_store_dwordx4 v[76:79], v0, s[20:23], s47 offen sc1
    s_add_u32 s44, s97, 0x4400000
    s_nop 0
    v_lshlrev_b32 v76, 1, v1
    buffer_load_dwordx4 v[76:79], v76, s[8:11], s44 offen nt
    ds_add_rtn_u32 v20, v20, v2
    ds_add_rtn_u32 v21, v21, v2
    ds_add_rtn_u32 v22, v22, v2
    ds_add_rtn_u32 v23, v23, v2
    s_setprio 1
    ds_add_rtn_u32 v32, v32, v2
    ds_add_rtn_u32 v33, v33, v2
    ds_add_rtn_u32 v34, v34, v2
    ds_add_rtn_u32 v35, v35, v2
    ds_add_rtn_u32 v40, v40, v2
    ds_add_rtn_u32 v41, v41, v2
    ds_add_rtn_u32 v42, v42, v2
    ds_add_rtn_u32 v43, v43, v2
    s_add_u32 s45, s35, 0x8000
    s_add_u32 s45, s45, s73
    buffer_store_dwordx4 v[80:83], v0, s[20:23], s45 offen sc1
    s_add_u32 s46, s97, 0x4400000
    s_nop 0
    v_lshlrev_b32 v80, 1, v1
    buffer_load_dwordx4 v[80:83], v80, s[12:15], s46 offen nt
    s_setprio 0
    ds_add_rtn_u32 v52, v52, v2
    ds_add_rtn_u32 v53, v53, v2
    ds_add_rtn_u32 v54, v54, v2
    ds_add_rtn_u32 v55, v55, v2
    ds_add_rtn_u32 v60, v60, v2
    ds_add_rtn_u32 v61, v61, v2
    ds_add_rtn_u32 v62, v62, v2
    ds_add_rtn_u32 v63, v63, v2
    s_waitcnt lgkmcnt(0)
    s_barrier
    s_setprio 3
    v_and_b32 v7, -4, v104
    v_lshl_add_u32 v8, v104, 2, v7
    ds_write_b32 v8, v96
    v_lshl_add_u32 v7, v7, 2, v104
    ds_write_b8 v7, v108 offset:16
    v_and_b32 v9, -4, v105
    v_lshl_add_u32 v10, v105, 2, v9
    ds_write_b32 v10, v97
    v_lshl_add_u32 v9, v9, 2, v105
    ds_write_b8_d16_hi v9, v108 offset:16
    v_and_b32 v7, -4, v106
    v_lshl_add_u32 v8, v106, 2, v7
    ds_write_b32 v8, v98
    v_lshl_add_u32 v7, v7, 2, v106
    ds_write_b8 v7, v109 offset:16
    v_and_b32 v9, -4, v107
    v_lshl_add_u32 v10, v107, 2, v9
    ds_write_b32 v10, v99
    v_lshl_add_u32 v9, v9, 2, v107
    ds_write_b8_d16_hi v9, v109 offset:16
    s_add_u32 s47, s35, 0x8000
    s_add_u32 s47, s47, s85
    buffer_store_dwordx4 v[88:91], v0, s[20:23], s47 offen sc1
    s_add_u32 s44, s98, 0x4800000
    v_lshlrev_b32 v96, 1, v1
    buffer_load_dwordx4 v[96:99], v96, s[8:11], s44 offen nt
    s_add_u32 s45, s98, 0x4800000
    v_lshlrev_b32 v104, 1, v1
    buffer_load_dwordx4 v[104:107], v104, s[12:15], s45 offen nt
    v_and_b32 v7, -4, v112
    v_lshl_add_u32 v8, v112, 2, v7
    ds_write_b32 v8, v100
    v_lshl_add_u32 v7, v7, 2, v112
    ds_write_b8 v7, v110 offset:16
    v_and_b32 v9, -4, v113
    v_lshl_add_u32 v10, v113, 2, v9
    ds_write_b32 v10, v101
    v_lshl_add_u32 v9, v9, 2, v113
    ds_write_b8_d16_hi v9, v110 offset:16
    v_and_b32 v7, -4, v114
    v_lshl_add_u32 v8, v114, 2, v7
    ds_write_b32 v8, v102
    v_lshl_add_u32 v7, v7, 2, v114
    ds_write_b8 v7, v111 offset:16
    v_and_b32 v9, -4, v115
    v_lshl_add_u32 v10, v115, 2, v9
    ds_write_b32 v10, v103
    v_lshl_add_u32 v9, v9, 2, v115
    ds_write_b8_d16_hi v9, v111 offset:16
    s_add_u32 s46, s98, 0x4800000
    s_lshr_b32 s46, s46, 1
    buffer_load_dwordx2 v[88:89], v1, s[16:19], s46 offen nt
    s_add_u32 s47, s99, 0x4c00000
    s_lshr_b32 s47, s47, 1
    buffer_load_dwordx2 v[90:91], v1, s[16:19], s47 offen nt
    s_add_u32 s44, s99, 0x4c00000
    v_lshlrev_b32 v100, 1, v1
    buffer_load_dwordx4 v[100:103], v100, s[8:11], s44 offen nt
    s_setprio 2
    v_and_b32 v7, -4, v120
    v_lshl_add_u32 v8, v120, 2, v7
    ds_write_b32 v8, v116
    v_lshl_add_u32 v7, v7, 2, v120
    ds_write_b8 v7, v124 offset:16
    v_and_b32 v9, -4, v121
    v_lshl_add_u32 v10, v121, 2, v9
    ds_write_b32 v10, v117
    v_lshl_add_u32 v9, v9, 2, v121
    ds_write_b8_d16_hi v9, v124 offset:16
    v_and_b32 v7, -4, v122
    v_lshl_add_u32 v8, v122, 2, v7
    ds_write_b32 v8, v118
    v_lshl_add_u32 v7, v7, 2, v122
    ds_write_b8 v7, v125 offset:16
    v_and_b32 v9, -4, v123
    v_lshl_add_u32 v10, v123, 2, v9
    ds_write_b32 v10, v119
    v_lshl_add_u32 v9, v9, 2, v123
    ds_write_b8_d16_hi v9, v125 offset:16
    s_add_u32 s45, s35, 0x8000
    s_add_u32 s45, s45, s91
    buffer_store_dwordx4 v[92:95], v0, s[20:23], s45 offen sc1
    s_add_u32 s46, s99, 0x4c00000
    v_lshlrev_b32 v112, 1, v1
    buffer_load_dwordx4 v[112:115], v112, s[12:15], s46 offen nt
    v_and_b32 v7, -4, v20
    v_lshl_add_u32 v8, v20, 2, v7
    ds_write_b32 v8, v16
    v_lshl_add_u32 v7, v7, 2, v20
    ds_write_b8 v7, v126 offset:16
    v_and_b32 v9, -4, v21
    v_lshl_add_u32 v10, v21, 2, v9
    ds_write_b32 v10, v17
    v_lshl_add_u32 v9, v9, 2, v21
    ds_write_b8_d16_hi v9, v126 offset:16
    v_and_b32 v7, -4, v22
    v_lshl_add_u32 v8, v22, 2, v7
    ds_write_b32 v8, v18
    v_lshl_add_u32 v7, v7, 2, v22
    ds_write_b8 v7, v127 offset:16
    v_and_b32 v9, -4, v23
    v_lshl_add_u32 v10, v23, 2, v9
    ds_write_b32 v10, v19
    v_lshl_add_u32 v9, v9, 2, v23
    ds_write_b8_d16_hi v9, v127 offset:16
    s_add_u32 s47, s96, 0x5000000
    v_lshlrev_b32 v108, 1, v1
    buffer_load_dwordx4 v[108:111], v108, s[8:11], s47 offen nt
    s_add_u32 s44, s96, 0x5000000
    v_lshlrev_b32 v116, 1, v1
    buffer_load_dwordx4 v[116:119], v116, s[12:15], s44 offen nt
    s_setprio 1
    v_and_b32 v7, -4, v32
    v_lshl_add_u32 v8, v32, 2, v7
    ds_write_b32 v8, v28
    v_lshl_add_u32 v7, v7, 2, v32
    ds_write_b8 v7, v24 offset:16
    v_and_b32 v9, -4, v33
    v_lshl_add_u32 v10, v33, 2, v9
    ds_write_b32 v10, v29
    v_lshl_add_u32 v9, v9, 2, v33
    ds_write_b8_d16_hi v9, v24 offset:16
    v_and_b32 v7, -4, v34
    v_lshl_add_u32 v8, v34, 2, v7
    ds_write_b32 v8, v30
    v_lshl_add_u32 v7, v7, 2, v34
    ds_write_b8 v7, v25 offset:16
    v_and_b32 v9, -4, v35
    v_lshl_add_u32 v10, v35, 2, v9
    ds_write_b32 v10, v31
    v_lshl_add_u32 v9, v9, 2, v35
    ds_write_b8_d16_hi v9, v25 offset:16
    s_add_u32 s45, s96, 0x5000000
    s_lshr_b32 s45, s45, 1
    buffer_load_dwordx2 v[120:121], v1, s[16:19], s45 offen nt
    s_add_u32 s46, s97, 0x5400000
    s_lshr_b32 s46, s46, 1
    buffer_load_dwordx2 v[122:123], v1, s[16:19], s46 offen nt
    s_add_u32 s47, s97, 0x5400000
    v_lshlrev_b32 v92, 1, v1
    buffer_load_dwordx4 v[92:95], v92, s[8:11], s47 offen nt
    v_and_b32 v7, -4, v40
    v_lshl_add_u32 v8, v40, 2, v7
    ds_write_b32 v8, v36
    v_lshl_add_u32 v7, v7, 2, v40
    ds_write_b8 v7, v26 offset:16
    v_and_b32 v9, -4, v41
    v_lshl_add_u32 v10, v41, 2, v9
    ds_write_b32 v10, v37
    v_lshl_add_u32 v9, v9, 2, v41
    ds_write_b8_d16_hi v9, v26 offset:16
    v_and_b32 v7, -4, v42
    v_lshl_add_u32 v8, v42, 2, v7
    ds_write_b32 v8, v38
    v_lshl_add_u32 v7, v7, 2, v42
    ds_write_b8 v7, v27 offset:16
    v_and_b32 v9, -4, v43
    v_lshl_add_u32 v10, v43, 2, v9
    ds_write_b32 v10, v39
    v_lshl_add_u32 v9, v9, 2, v43
    ds_write_b8_d16_hi v9, v27 offset:16
    s_add_u32 s44, s35, 0x8000
    s_add_u32 s44, s44, s93
    buffer_store_dwordx4 v[84:87], v0, s[20:23], s44 offen sc1
    s_add_u32 s45, s97, 0x5400000
    v_lshlrev_b32 v16, 1, v1
    buffer_load_dwordx4 v[16:19], v16, s[12:15], s45 offen nt
    s_setprio 0
    v_and_b32 v7, -4, v52
    v_lshl_add_u32 v8, v52, 2, v7
    ds_write_b32 v8, v48
    v_lshl_add_u32 v7, v7, 2, v52
    ds_write_b8 v7, v44 offset:16
    v_and_b32 v9, -4, v53
    v_lshl_add_u32 v10, v53, 2, v9
    ds_write_b32 v10, v49
    v_lshl_add_u32 v9, v9, 2, v53
    ds_write_b8_d16_hi v9, v44 offset:16
    v_and_b32 v7, -4, v54
    v_lshl_add_u32 v8, v54, 2, v7
    ds_write_b32 v8, v50
    v_lshl_add_u32 v7, v7, 2, v54
    ds_write_b8 v7, v45 offset:16
    v_and_b32 v9, -4, v55
    v_lshl_add_u32 v10, v55, 2, v9
    ds_write_b32 v10, v51
    v_lshl_add_u32 v9, v9, 2, v55
    ds_write_b8_d16_hi v9, v45 offset:16
    s_add_u32 s46, s98, 0x5800000
    v_lshlrev_b32 v20, 1, v1
    buffer_load_dwordx4 v[20:23], v20, s[8:11], s46 offen nt
    s_add_u32 s47, s98, 0x5800000
    v_lshlrev_b32 v124, 1, v1
    buffer_load_dwordx4 v[124:127], v124, s[12:15], s47 offen nt
    v_and_b32 v7, -4, v60
    v_lshl_add_u32 v8, v60, 2, v7
    ds_write_b32 v8, v56
    v_lshl_add_u32 v7, v7, 2, v60
    ds_write_b8 v7, v46 offset:16
    v_and_b32 v9, -4, v61
    v_lshl_add_u32 v10, v61, 2, v9
    ds_write_b32 v10, v57
    v_lshl_add_u32 v9, v9, 2, v61
    ds_write_b8_d16_hi v9, v46 offset:16
    v_and_b32 v7, -4, v62
    v_lshl_add_u32 v8, v62, 2, v7
    ds_write_b32 v8, v58
    v_lshl_add_u32 v7, v7, 2, v62
    ds_write_b8 v7, v47 offset:16
    v_and_b32 v9, -4, v63
    v_lshl_add_u32 v10, v63, 2, v9
    ds_write_b32 v10, v59
    v_lshl_add_u32 v9, v9, 2, v63
    ds_write_b8_d16_hi v9, v47 offset:16
    s_add_u32 s44, s98, 0x5800000
    s_lshr_b32 s44, s44, 1
    buffer_load_dwordx2 v[28:29], v1, s[16:19], s44 offen nt
    s_add_u32 s45, s99, 0x5c00000
    s_lshr_b32 s45, s45, 1
    buffer_load_dwordx2 v[30:31], v1, s[16:19], s45 offen nt
    v_add_u32 v7, s72, v0
    v_add_u32 v12, s73, v0
    v_add_u32 v13, s85, v0
    v_add_u32 v14, s91, v0
    v_add_u32 v15, s93, v0
    s_min_i32 s3, s72, s73
    s_min_i32 s3, s3, s85
    s_min_i32 s3, s3, s91
    s_min_i32 s3, s3, s93
    v_add_u32 v3, s3, v0
    v_mov_b32 v8, 0
    v_mov_b32 v9, 0
    v_mov_b32 v10, 0
    v_mov_b32 v11, 0
    s_waitcnt lgkmcnt(0)
    s_barrier
    ds_read_b128 v[32:35], v7 offset:0
    ds_read_b128 v[36:39], v12 offset:0
    ds_read_b128 v[40:43], v13 offset:0
    ds_read_b128 v[24:27], v14 offset:0
    ds_read_b128 v[84:87], v15 offset:0
    ds_write_b128 v3, v[8:11]
    ds_read_b128 v[48:51], v7 offset:16384
    ds_read_b128 v[52:55], v12 offset:16384
    ds_read_b128 v[56:59], v13 offset:16384
    ds_read_b128 v[60:63], v14 offset:16384
    ds_read_b128 v[44:47], v15 offset:16384
    s_waitcnt lgkmcnt(0)
    s_barrier
    s_setprio 3
    s_add_u32 s46, s35, 0x2a44000
    s_add_u32 s46, s46, s72
    buffer_store_dwordx4 v[32:35], v0, s[20:23], s46 offen sc1
    s_add_u32 s47, s99, 0x5c00000
    s_nop 0
    v_lshlrev_b32 v32, 1, v1
    buffer_load_dwordx4 v[32:35], v32, s[8:11], s47 offen nt
    s_add_u32 s44, s35, 0x2a44000
    s_add_u32 s44, s44, s73
    buffer_store_dwordx4 v[36:39], v0, s[20:23], s44 offen sc1
    s_add_u32 s45, s99, 0x5c00000
    s_nop 0
    v_lshlrev_b32 v36, 1, v1
    buffer_load_dwordx4 v[36:39], v36, s[12:15], s45 offen nt
    s_waitcnt vmcnt(27)
    v_lshlrev_b32 v7, 16, v64
    v_and_b32 v8, 0xffff0000, v64
    v_lshlrev_b32 v9, 16, v65
    v_and_b32 v10, 0xffff0000, v65
    v_mul_f32 v7, 0.15915494, v7
    v_mul_f32 v8, 0.15915494, v8
    v_mul_f32 v9, 0.15915494, v9
    v_mul_f32 v10, 0.15915494, v10
    v_mul_hi_u32_u24 v14, 429497, v68
    v_lshrrev_b32 v12, 3, v72
    v_cos_f32 v7, v7
    v_lshlrev_b16 v13, 3, v72
    v_mad_i32_i24 v11, v14, s55, v68
    v_bitop3_b32 v12, v6, v13, v12 bitop3:0xca
    v_lshl_add_u32 v11, v11, 17, s40
    v_lshlrev_b16 v14, 8, v14
    v_lshrrev_b32 v13, 2, v72
    v_add_u32 v68, v12, v11
    v_bitop3_b32 v72, v5, v13, v14 bitop3:0xea
    ds_add_u32 v72, v2
    v_mul_hi_u32_u24 v14, 429497, v69
    v_lshrrev_b32 v12, 3, v73
    v_cos_f32 v8, v8
    v_lshlrev_b16 v13, 3, v73
    v_mad_i32_i24 v11, v14, s55, v69
    v_bitop3_b32 v12, v6, v13, v12 bitop3:0xca
    v_lshl_add_u32 v11, v11, 17, s40
    v_lshlrev_b16 v14, 8, v14
    v_lshrrev_b32 v13, 2, v73
    v_add_u32 v69, v12, v11
    v_bitop3_b32 v73, v5, v13, v14 bitop3:0xea
    ds_add_u32 v73, v2
    v_cvt_pk_bf16_f32 v64, v7, v8
    v_perm_b32 v12, v64, v64, s41
    v_bitop3_b32 v68, v4, v12, v68 bitop3:0xca
    v_perm_b32 v13, v64, v64, s42
    v_bitop3_b32 v69, v4, v13, v69 bitop3:0xca
    v_mul_hi_u32_u24 v14, 429497, v70
    v_lshrrev_b32 v12, 3, v74
    v_cos_f32 v9, v9
    v_lshlrev_b16 v13, 3, v74
    v_mad_i32_i24 v11, v14, s55, v70
    v_bitop3_b32 v12, v6, v13, v12 bitop3:0xca
    v_lshl_add_u32 v11, v11, 17, s40
    v_lshlrev_b16 v14, 8, v14
    v_lshrrev_b32 v13, 2, v74
    v_add_u32 v70, v12, v11
    v_bitop3_b32 v74, v5, v13, v14 bitop3:0xea
    ds_add_u32 v74, v2
    v_mul_hi_u32_u24 v14, 429497, v71
    v_lshrrev_b32 v12, 3, v75
    v_cos_f32 v10, v10
    v_lshlrev_b16 v13, 3, v75
    v_mad_i32_i24 v11, v14, s55, v71
    v_bitop3_b32 v12, v6, v13, v12 bitop3:0xca
    v_lshl_add_u32 v11, v11, 17, s40
    v_lshlrev_b16 v14, 8, v14
    v_lshrrev_b32 v13, 2, v75
    v_add_u32 v71, v12, v11
    v_bitop3_b32 v75, v5, v13, v14 bitop3:0xea
    ds_add_u32 v75, v2
    v_cvt_pk_bf16_f32 v65, v9, v10
    v_perm_b32 v12, v65, v65, s41
    v_bitop3_b32 v70, v4, v12, v70 bitop3:0xca
    v_perm_b32 v13, v65, v65, s42
    v_bitop3_b32 v71, v4, v13, v71 bitop3:0xca
    s_waitcnt vmcnt(23)
    v_lshlrev_b32 v7, 16, v66
    v_and_b32 v8, 0xffff0000, v66
    v_lshlrev_b32 v9, 16, v67
    v_and_b32 v10, 0xffff0000, v67
    v_mul_f32 v7, 0.15915494, v7
    v_mul_f32 v8, 0.15915494, v8
    v_mul_f32 v9, 0.15915494, v9
    v_mul_f32 v10, 0.15915494, v10
    v_mul_hi_u32_u24 v14, 429497, v76
    v_lshrrev_b32 v12, 3, v80
    v_cos_f32 v7, v7
    v_lshlrev_b16 v13, 3, v80
    v_mad_i32_i24 v11, v14, s55, v76
    v_bitop3_b32 v12, v6, v13, v12 bitop3:0xca
    v_lshl_add_u32 v11, v11, 17, s40
    v_lshlrev_b16 v14, 8, v14
    v_lshrrev_b32 v13, 2, v80
    v_add_u32 v76, v12, v11
    v_bitop3_b32 v80, v5, v13, v14 bitop3:0xea
    ds_add_u32 v80, v2
    v_mul_hi_u32_u24 v14, 429497, v77
    v_lshrrev_b32 v12, 3, v81
    v_cos_f32 v8, v8
    v_lshlrev_b16 v13, 3, v81
    v_mad_i32_i24 v11, v14, s55, v77
    v_bitop3_b32 v12, v6, v13, v12 bitop3:0xca
    v_lshl_add_u32 v11, v11, 17, s40
    v_lshlrev_b16 v14, 8, v14
    v_lshrrev_b32 v13, 2, v81
    v_add_u32 v77, v12, v11
    v_bitop3_b32 v81, v5, v13, v14 bitop3:0xea
    ds_add_u32 v81, v2
    v_cvt_pk_bf16_f32 v66, v7, v8
    v_perm_b32 v12, v66, v66, s41
    v_bitop3_b32 v76, v4, v12, v76 bitop3:0xca
    v_perm_b32 v13, v66, v66, s42
    v_bitop3_b32 v77, v4, v13, v77 bitop3:0xca
    v_mul_hi_u32_u24 v14, 429497, v78
    v_lshrrev_b32 v12, 3, v82
    v_cos_f32 v9, v9
    v_lshlrev_b16 v13, 3, v82
    v_mad_i32_i24 v11, v14, s55, v78
    v_bitop3_b32 v12, v6, v13, v12 bitop3:0xca
    v_lshl_add_u32 v11, v11, 17, s40
    v_lshlrev_b16 v14, 8, v14
    v_lshrrev_b32 v13, 2, v82
    v_add_u32 v78, v12, v11
    v_bitop3_b32 v82, v5, v13, v14 bitop3:0xea
    ds_add_u32 v82, v2
    v_mul_hi_u32_u24 v14, 429497, v79
    v_lshrrev_b32 v12, 3, v83
    v_cos_f32 v10, v10
    v_lshlrev_b16 v13, 3, v83
    v_mad_i32_i24 v11, v14, s55, v79
    v_bitop3_b32 v12, v6, v13, v12 bitop3:0xca
    v_lshl_add_u32 v11, v11, 17, s40
    v_lshlrev_b16 v14, 8, v14
    v_lshrrev_b32 v13, 2, v83
    v_add_u32 v79, v12, v11
    v_bitop3_b32 v83, v5, v13, v14 bitop3:0xea
    ds_add_u32 v83, v2
    v_cvt_pk_bf16_f32 v67, v9, v10
    v_perm_b32 v12, v67, v67, s41
    v_bitop3_b32 v78, v4, v12, v78 bitop3:0xca
    v_perm_b32 v13, v67, v67, s42
    v_bitop3_b32 v79, v4, v13, v79 bitop3:0xca
    s_setprio 2
    s_waitcnt vmcnt(18)
    v_lshlrev_b32 v7, 16, v88
    v_and_b32 v8, 0xffff0000, v88
    v_lshlrev_b32 v9, 16, v89
    v_and_b32 v10, 0xffff0000, v89
    v_mul_f32 v7, 0.15915494, v7
    v_mul_f32 v8, 0.15915494, v8
    v_mul_f32 v9, 0.15915494, v9
    v_mul_f32 v10, 0.15915494, v10
    v_mul_hi_u32_u24 v14, 429497, v96
    v_lshrrev_b32 v12, 3, v104
    v_cos_f32 v7, v7
    v_lshlrev_b16 v13, 3, v104
    v_mad_i32_i24 v11, v14, s55, v96
    v_bitop3_b32 v12, v6, v13, v12 bitop3:0xca
    v_lshl_add_u32 v11, v11, 17, s40
    v_lshlrev_b16 v14, 8, v14
    v_lshrrev_b32 v13, 2, v104
    v_add_u32 v96, v12, v11
    v_bitop3_b32 v104, v5, v13, v14 bitop3:0xea
    ds_add_u32 v104, v2
    v_mul_hi_u32_u24 v14, 429497, v97
    v_lshrrev_b32 v12, 3, v105
    v_cos_f32 v8, v8
    v_lshlrev_b16 v13, 3, v105
    v_mad_i32_i24 v11, v14, s55, v97
    v_bitop3_b32 v12, v6, v13, v12 bitop3:0xca
    v_lshl_add_u32 v11, v11, 17, s40
    v_lshlrev_b16 v14, 8, v14
    v_lshrrev_b32 v13, 2, v105
    v_add_u32 v97, v12, v11
    v_bitop3_b32 v105, v5, v13, v14 bitop3:0xea
    ds_add_u32 v105, v2
    v_cvt_pk_bf16_f32 v88, v7, v8
    v_perm_b32 v12, v88, v88, s41
    v_bitop3_b32 v96, v4, v12, v96 bitop3:0xca
    v_perm_b32 v13, v88, v88, s42
    v_bitop3_b32 v97, v4, v13, v97 bitop3:0xca
    v_mul_hi_u32_u24 v14, 429497, v98
    v_lshrrev_b32 v12, 3, v106
    v_cos_f32 v9, v9
    v_lshlrev_b16 v13, 3, v106
    v_mad_i32_i24 v11, v14, s55, v98
    v_bitop3_b32 v12, v6, v13, v12 bitop3:0xca
    v_lshl_add_u32 v11, v11, 17, s40
    v_lshlrev_b16 v14, 8, v14
    v_lshrrev_b32 v13, 2, v106
    v_add_u32 v98, v12, v11
    v_bitop3_b32 v106, v5, v13, v14 bitop3:0xea
    ds_add_u32 v106, v2
    v_mul_hi_u32_u24 v14, 429497, v99
    v_lshrrev_b32 v12, 3, v107
    v_cos_f32 v10, v10
    v_lshlrev_b16 v13, 3, v107
    v_mad_i32_i24 v11, v14, s55, v99
    v_bitop3_b32 v12, v6, v13, v12 bitop3:0xca
    v_lshl_add_u32 v11, v11, 17, s40
    v_lshlrev_b16 v14, 8, v14
    v_lshrrev_b32 v13, 2, v107
    v_add_u32 v99, v12, v11
    v_bitop3_b32 v107, v5, v13, v14 bitop3:0xea
    ds_add_u32 v107, v2
    v_cvt_pk_bf16_f32 v89, v9, v10
    v_perm_b32 v12, v89, v89, s41
    v_bitop3_b32 v98, v4, v12, v98 bitop3:0xca
    v_perm_b32 v13, v89, v89, s42
    v_bitop3_b32 v99, v4, v13, v99 bitop3:0xca
    s_add_u32 s46, s35, 0x2a44000
    s_add_u32 s46, s46, s85
    buffer_store_dwordx4 v[40:43], v0, s[20:23], s46 offen sc1
    s_add_u32 s47, s96, 0x6000000
    s_nop 0
    v_lshlrev_b32 v40, 1, v1
    buffer_load_dwordx4 v[40:43], v40, s[8:11], s47 offen nt
    s_waitcnt vmcnt(17)
    v_lshlrev_b32 v7, 16, v90
    v_and_b32 v8, 0xffff0000, v90
    v_lshlrev_b32 v9, 16, v91
    v_and_b32 v10, 0xffff0000, v91
    v_mul_f32 v7, 0.15915494, v7
    v_mul_f32 v8, 0.15915494, v8
    v_mul_f32 v9, 0.15915494, v9
    v_mul_f32 v10, 0.15915494, v10
    v_mul_hi_u32_u24 v14, 429497, v100
    v_lshrrev_b32 v12, 3, v112
    v_cos_f32 v7, v7
    v_lshlrev_b16 v13, 3, v112
    v_mad_i32_i24 v11, v14, s55, v100
    v_bitop3_b32 v12, v6, v13, v12 bitop3:0xca
    v_lshl_add_u32 v11, v11, 17, s40
    v_lshlrev_b16 v14, 8, v14
    v_lshrrev_b32 v13, 2, v112
    v_add_u32 v100, v12, v11
    v_bitop3_b32 v112, v5, v13, v14 bitop3:0xea
    ds_add_u32 v112, v2
    v_mul_hi_u32_u24 v14, 429497, v101
    v_lshrrev_b32 v12, 3, v113
    v_cos_f32 v8, v8
    v_lshlrev_b16 v13, 3, v113
    v_mad_i32_i24 v11, v14, s55, v101
    v_bitop3_b32 v12, v6, v13, v12 bitop3:0xca
    v_lshl_add_u32 v11, v11, 17, s40
    v_lshlrev_b16 v14, 8, v14
    v_lshrrev_b32 v13, 2, v113
    v_add_u32 v101, v12, v11
    v_bitop3_b32 v113, v5, v13, v14 bitop3:0xea
    ds_add_u32 v113, v2
    v_cvt_pk_bf16_f32 v90, v7, v8
    v_perm_b32 v12, v90, v90, s41
    v_bitop3_b32 v100, v4, v12, v100 bitop3:0xca
    v_perm_b32 v13, v90, v90, s42
    v_bitop3_b32 v101, v4, v13, v101 bitop3:0xca
    v_mul_hi_u32_u24 v14, 429497, v102
    v_lshrrev_b32 v12, 3, v114
    v_cos_f32 v9, v9
    v_lshlrev_b16 v13, 3, v114
    v_mad_i32_i24 v11, v14, s55, v102
    v_bitop3_b32 v12, v6, v13, v12 bitop3:0xca
    v_lshl_add_u32 v11, v11, 17, s40
    v_lshlrev_b16 v14, 8, v14
    v_lshrrev_b32 v13, 2, v114
    v_add_u32 v102, v12, v11
    v_bitop3_b32 v114, v5, v13, v14 bitop3:0xea
    ds_add_u32 v114, v2
    v_mul_hi_u32_u24 v14, 429497, v103
    v_lshrrev_b32 v12, 3, v115
    v_cos_f32 v10, v10
    v_lshlrev_b16 v13, 3, v115
    v_mad_i32_i24 v11, v14, s55, v103
    v_bitop3_b32 v12, v6, v13, v12 bitop3:0xca
    v_lshl_add_u32 v11, v11, 17, s40
    v_lshlrev_b16 v14, 8, v14
    v_lshrrev_b32 v13, 2, v115
    v_add_u32 v103, v12, v11
    v_bitop3_b32 v115, v5, v13, v14 bitop3:0xea
    ds_add_u32 v115, v2
    v_cvt_pk_bf16_f32 v91, v9, v10
    v_perm_b32 v12, v91, v91, s41
    v_bitop3_b32 v102, v4, v12, v102 bitop3:0xca
    v_perm_b32 v13, v91, v91, s42
    v_bitop3_b32 v103, v4, v13, v103 bitop3:0xca
    s_setprio 1
    s_waitcnt vmcnt(13)
    v_lshlrev_b32 v7, 16, v120
    v_and_b32 v8, 0xffff0000, v120
    v_lshlrev_b32 v9, 16, v121
    v_and_b32 v10, 0xffff0000, v121
    v_mul_f32 v7, 0.15915494, v7
    v_mul_f32 v8, 0.15915494, v8
    v_mul_f32 v9, 0.15915494, v9
    v_mul_f32 v10, 0.15915494, v10
    v_mul_hi_u32_u24 v14, 429497, v108
    v_lshrrev_b32 v12, 3, v116
    v_cos_f32 v7, v7
    v_lshlrev_b16 v13, 3, v116
    v_mad_i32_i24 v11, v14, s55, v108
    v_bitop3_b32 v12, v6, v13, v12 bitop3:0xca
    v_lshl_add_u32 v11, v11, 17, s40
    v_lshlrev_b16 v14, 8, v14
    v_lshrrev_b32 v13, 2, v116
    v_add_u32 v108, v12, v11
    v_bitop3_b32 v116, v5, v13, v14 bitop3:0xea
    ds_add_u32 v116, v2
    v_mul_hi_u32_u24 v14, 429497, v109
    v_lshrrev_b32 v12, 3, v117
    v_cos_f32 v8, v8
    v_lshlrev_b16 v13, 3, v117
    v_mad_i32_i24 v11, v14, s55, v109
    v_bitop3_b32 v12, v6, v13, v12 bitop3:0xca
    v_lshl_add_u32 v11, v11, 17, s40
    v_lshlrev_b16 v14, 8, v14
    v_lshrrev_b32 v13, 2, v117
    v_add_u32 v109, v12, v11
    v_bitop3_b32 v117, v5, v13, v14 bitop3:0xea
    ds_add_u32 v117, v2
    v_cvt_pk_bf16_f32 v120, v7, v8
    v_perm_b32 v12, v120, v120, s41
    v_bitop3_b32 v108, v4, v12, v108 bitop3:0xca
    v_perm_b32 v13, v120, v120, s42
    v_bitop3_b32 v109, v4, v13, v109 bitop3:0xca
    v_mul_hi_u32_u24 v14, 429497, v110
    v_lshrrev_b32 v12, 3, v118
    v_cos_f32 v9, v9
    v_lshlrev_b16 v13, 3, v118
    v_mad_i32_i24 v11, v14, s55, v110
    v_bitop3_b32 v12, v6, v13, v12 bitop3:0xca
    v_lshl_add_u32 v11, v11, 17, s40
    v_lshlrev_b16 v14, 8, v14
    v_lshrrev_b32 v13, 2, v118
    v_add_u32 v110, v12, v11
    v_bitop3_b32 v118, v5, v13, v14 bitop3:0xea
    ds_add_u32 v118, v2
    v_mul_hi_u32_u24 v14, 429497, v111
    v_lshrrev_b32 v12, 3, v119
    v_cos_f32 v10, v10
    v_lshlrev_b16 v13, 3, v119
    v_mad_i32_i24 v11, v14, s55, v111
    v_bitop3_b32 v12, v6, v13, v12 bitop3:0xca
    v_lshl_add_u32 v11, v11, 17, s40
    v_lshlrev_b16 v14, 8, v14
    v_lshrrev_b32 v13, 2, v119
    v_add_u32 v111, v12, v11
    v_bitop3_b32 v119, v5, v13, v14 bitop3:0xea
    ds_add_u32 v119, v2
    v_cvt_pk_bf16_f32 v121, v9, v10
    v_perm_b32 v12, v121, v121, s41
    v_bitop3_b32 v110, v4, v12, v110 bitop3:0xca
    v_perm_b32 v13, v121, v121, s42
    v_bitop3_b32 v111, v4, v13, v111 bitop3:0xca
    s_waitcnt vmcnt(10)
    v_lshlrev_b32 v7, 16, v122
    v_and_b32 v8, 0xffff0000, v122
    v_lshlrev_b32 v9, 16, v123
    v_and_b32 v10, 0xffff0000, v123
    v_mul_f32 v7, 0.15915494, v7
    v_mul_f32 v8, 0.15915494, v8
    v_mul_f32 v9, 0.15915494, v9
    v_mul_f32 v10, 0.15915494, v10
    v_mul_hi_u32_u24 v14, 429497, v92
    v_lshrrev_b32 v12, 3, v16
    v_cos_f32 v7, v7
    v_lshlrev_b16 v13, 3, v16
    v_mad_i32_i24 v11, v14, s55, v92
    v_bitop3_b32 v12, v6, v13, v12 bitop3:0xca
    v_lshl_add_u32 v11, v11, 17, s40
    v_lshlrev_b16 v14, 8, v14
    v_lshrrev_b32 v13, 2, v16
    v_add_u32 v92, v12, v11
    v_bitop3_b32 v16, v5, v13, v14 bitop3:0xea
    ds_add_u32 v16, v2
    v_mul_hi_u32_u24 v14, 429497, v93
    v_lshrrev_b32 v12, 3, v17
    v_cos_f32 v8, v8
    v_lshlrev_b16 v13, 3, v17
    v_mad_i32_i24 v11, v14, s55, v93
    v_bitop3_b32 v12, v6, v13, v12 bitop3:0xca
    v_lshl_add_u32 v11, v11, 17, s40
    v_lshlrev_b16 v14, 8, v14
    v_lshrrev_b32 v13, 2, v17
    v_add_u32 v93, v12, v11
    v_bitop3_b32 v17, v5, v13, v14 bitop3:0xea
    ds_add_u32 v17, v2
    v_cvt_pk_bf16_f32 v122, v7, v8
    v_perm_b32 v12, v122, v122, s41
    v_bitop3_b32 v92, v4, v12, v92 bitop3:0xca
    v_perm_b32 v13, v122, v122, s42
    v_bitop3_b32 v93, v4, v13, v93 bitop3:0xca
    v_mul_hi_u32_u24 v14, 429497, v94
    v_lshrrev_b32 v12, 3, v18
    v_cos_f32 v9, v9
    v_lshlrev_b16 v13, 3, v18
    v_mad_i32_i24 v11, v14, s55, v94
    v_bitop3_b32 v12, v6, v13, v12 bitop3:0xca
    v_lshl_add_u32 v11, v11, 17, s40
    v_lshlrev_b16 v14, 8, v14
    v_lshrrev_b32 v13, 2, v18
    v_add_u32 v94, v12, v11
    v_bitop3_b32 v18, v5, v13, v14 bitop3:0xea
    ds_add_u32 v18, v2
    v_mul_hi_u32_u24 v14, 429497, v95
    v_lshrrev_b32 v12, 3, v19
    v_cos_f32 v10, v10
    v_lshlrev_b16 v13, 3, v19
    v_mad_i32_i24 v11, v14, s55, v95
    v_bitop3_b32 v12, v6, v13, v12 bitop3:0xca
    v_lshl_add_u32 v11, v11, 17, s40
    v_lshlrev_b16 v14, 8, v14
    v_lshrrev_b32 v13, 2, v19
    v_add_u32 v95, v12, v11
    v_bitop3_b32 v19, v5, v13, v14 bitop3:0xea
    ds_add_u32 v19, v2
    v_cvt_pk_bf16_f32 v123, v9, v10
    v_perm_b32 v12, v123, v123, s41
    v_bitop3_b32 v94, v4, v12, v94 bitop3:0xca
    v_perm_b32 v13, v123, v123, s42
    v_bitop3_b32 v95, v4, v13, v95 bitop3:0xca
    s_setprio 0
    s_add_u32 s44, s35, 0x2a44000
    s_add_u32 s44, s44, s91
    buffer_store_dwordx4 v[24:27], v0, s[20:23], s44 offen sc1
    s_add_u32 s45, s96, 0x6000000
    s_nop 0
    v_lshlrev_b32 v24, 1, v1
    buffer_load_dwordx4 v[24:27], v24, s[12:15], s45 offen nt
    s_waitcnt vmcnt(8)
    v_lshlrev_b32 v7, 16, v28
    v_and_b32 v8, 0xffff0000, v28
    v_lshlrev_b32 v9, 16, v29
    v_and_b32 v10, 0xffff0000, v29
    v_mul_f32 v7, 0.15915494, v7
    v_mul_f32 v8, 0.15915494, v8
    v_mul_f32 v9, 0.15915494, v9
    v_mul_f32 v10, 0.15915494, v10
    v_mul_hi_u32_u24 v14, 429497, v20
    v_lshrrev_b32 v12, 3, v124
    v_cos_f32 v7, v7
    v_lshlrev_b16 v13, 3, v124
    v_mad_i32_i24 v11, v14, s55, v20
    v_bitop3_b32 v12, v6, v13, v12 bitop3:0xca
    v_lshl_add_u32 v11, v11, 17, s40
    v_lshlrev_b16 v14, 8, v14
    v_lshrrev_b32 v13, 2, v124
    v_add_u32 v20, v12, v11
    v_bitop3_b32 v124, v5, v13, v14 bitop3:0xea
    ds_add_u32 v124, v2
    v_mul_hi_u32_u24 v14, 429497, v21
    v_lshrrev_b32 v12, 3, v125
    v_cos_f32 v8, v8
    v_lshlrev_b16 v13, 3, v125
    v_mad_i32_i24 v11, v14, s55, v21
    v_bitop3_b32 v12, v6, v13, v12 bitop3:0xca
    v_lshl_add_u32 v11, v11, 17, s40
    v_lshlrev_b16 v14, 8, v14
    v_lshrrev_b32 v13, 2, v125
    v_add_u32 v21, v12, v11
    v_bitop3_b32 v125, v5, v13, v14 bitop3:0xea
    ds_add_u32 v125, v2
    v_cvt_pk_bf16_f32 v28, v7, v8
    v_perm_b32 v12, v28, v28, s41
    v_bitop3_b32 v20, v4, v12, v20 bitop3:0xca
    v_perm_b32 v13, v28, v28, s42
    v_bitop3_b32 v21, v4, v13, v21 bitop3:0xca
    v_mul_hi_u32_u24 v14, 429497, v22
    v_lshrrev_b32 v12, 3, v126
    v_cos_f32 v9, v9
    v_lshlrev_b16 v13, 3, v126
    v_mad_i32_i24 v11, v14, s55, v22
    v_bitop3_b32 v12, v6, v13, v12 bitop3:0xca
    v_lshl_add_u32 v11, v11, 17, s40
    v_lshlrev_b16 v14, 8, v14
    v_lshrrev_b32 v13, 2, v126
    v_add_u32 v22, v12, v11
    v_bitop3_b32 v126, v5, v13, v14 bitop3:0xea
    ds_add_u32 v126, v2
    v_mul_hi_u32_u24 v14, 429497, v23
    v_lshrrev_b32 v12, 3, v127
    v_cos_f32 v10, v10
    v_lshlrev_b16 v13, 3, v127
    v_mad_i32_i24 v11, v14, s55, v23
    v_bitop3_b32 v12, v6, v13, v12 bitop3:0xca
    v_lshl_add_u32 v11, v11, 17, s40
    v_lshlrev_b16 v14, 8, v14
    v_lshrrev_b32 v13, 2, v127
    v_add_u32 v23, v12, v11
    v_bitop3_b32 v127, v5, v13, v14 bitop3:0xea
    ds_add_u32 v127, v2
    v_cvt_pk_bf16_f32 v29, v9, v10
    v_perm_b32 v12, v29, v29, s41
    v_bitop3_b32 v22, v4, v12, v22 bitop3:0xca
    v_perm_b32 v13, v29, v29, s42
    v_bitop3_b32 v23, v4, v13, v23 bitop3:0xca
    s_waitcnt vmcnt(4)
    v_lshlrev_b32 v7, 16, v30
    v_and_b32 v8, 0xffff0000, v30
    v_lshlrev_b32 v9, 16, v31
    v_and_b32 v10, 0xffff0000, v31
    v_mul_f32 v7, 0.15915494, v7
    v_mul_f32 v8, 0.15915494, v8
    v_mul_f32 v9, 0.15915494, v9
    v_mul_f32 v10, 0.15915494, v10
    v_mul_hi_u32_u24 v14, 429497, v32
    v_lshrrev_b32 v12, 3, v36
    v_cos_f32 v7, v7
    v_lshlrev_b16 v13, 3, v36
    v_mad_i32_i24 v11, v14, s55, v32
    v_bitop3_b32 v12, v6, v13, v12 bitop3:0xca
    v_lshl_add_u32 v11, v11, 17, s40
    v_lshlrev_b16 v14, 8, v14
    v_lshrrev_b32 v13, 2, v36
    v_add_u32 v32, v12, v11
    v_bitop3_b32 v36, v5, v13, v14 bitop3:0xea
    ds_add_u32 v36, v2
    v_mul_hi_u32_u24 v14, 429497, v33
    v_lshrrev_b32 v12, 3, v37
    v_cos_f32 v8, v8
    v_lshlrev_b16 v13, 3, v37
    v_mad_i32_i24 v11, v14, s55, v33
    v_bitop3_b32 v12, v6, v13, v12 bitop3:0xca
    v_lshl_add_u32 v11, v11, 17, s40
    v_lshlrev_b16 v14, 8, v14
    v_lshrrev_b32 v13, 2, v37
    v_add_u32 v33, v12, v11
    v_bitop3_b32 v37, v5, v13, v14 bitop3:0xea
    ds_add_u32 v37, v2
    v_cvt_pk_bf16_f32 v30, v7, v8
    v_perm_b32 v12, v30, v30, s41
    v_bitop3_b32 v32, v4, v12, v32 bitop3:0xca
    v_perm_b32 v13, v30, v30, s42
    v_bitop3_b32 v33, v4, v13, v33 bitop3:0xca
    v_mul_hi_u32_u24 v14, 429497, v34
    v_lshrrev_b32 v12, 3, v38
    v_cos_f32 v9, v9
    v_lshlrev_b16 v13, 3, v38
    v_mad_i32_i24 v11, v14, s55, v34
    v_bitop3_b32 v12, v6, v13, v12 bitop3:0xca
    v_lshl_add_u32 v11, v11, 17, s40
    v_lshlrev_b16 v14, 8, v14
    v_lshrrev_b32 v13, 2, v38
    v_add_u32 v34, v12, v11
    v_bitop3_b32 v38, v5, v13, v14 bitop3:0xea
    ds_add_u32 v38, v2
    v_mul_hi_u32_u24 v14, 429497, v35
    v_lshrrev_b32 v12, 3, v39
    v_cos_f32 v10, v10
    v_lshlrev_b16 v13, 3, v39
    v_mad_i32_i24 v11, v14, s55, v35
    v_bitop3_b32 v12, v6, v13, v12 bitop3:0xca
    v_lshl_add_u32 v11, v11, 17, s40
    v_lshlrev_b16 v14, 8, v14
    v_lshrrev_b32 v13, 2, v39
    v_add_u32 v35, v12, v11
    v_bitop3_b32 v39, v5, v13, v14 bitop3:0xea
    ds_add_u32 v39, v2
    v_cvt_pk_bf16_f32 v31, v9, v10
    v_perm_b32 v12, v31, v31, s41
    v_bitop3_b32 v34, v4, v12, v34 bitop3:0xca
    v_perm_b32 v13, v31, v31, s42
    v_bitop3_b32 v35, v4, v13, v35 bitop3:0xca
    v_lshrrev_b32 v8, 2, v0
    v_and_b32 v7, 0x3c00, v0
    v_bitop3_b32 v7, v5, v8, v7 bitop3:0xea
    s_waitcnt lgkmcnt(0)
    s_barrier
    ds_read2st64_b32 v[8:9], v7 offset0:0 offset1:1
    ds_read2st64_b32 v[10:11], v7 offset0:2 offset1:3
    s_add_u32 s46, s35, 0x2a44000
    s_add_u32 s46, s46, s93
    buffer_store_dwordx4 v[84:87], v0, s[20:23], s46 offen sc1
    s_add_u32 s47, s96, 0x6000000
    s_lshr_b32 s47, s47, 1
    buffer_load_dwordx2 v[84:85], v1, s[16:19], s47 offen nt
    s_add_u32 s44, s97, 0x6400000
    s_lshr_b32 s44, s44, 1
    buffer_load_dwordx2 v[86:87], v1, s[16:19], s44 offen nt
    s_waitcnt lgkmcnt(0)
    v_lshl_or_b32 v12, v9, 16, v8
    v_lshl_or_b32 v13, v11, 16, v10
    v_mov_b32 v14, v12
    v_mov_b32 v15, v13
    s_nop 0
    v_add_u32_dpp v14, v14, v14 row_shr:1 row_mask:0xf bank_mask:0xf bound_ctrl:1
    v_add_u32_dpp v15, v15, v15 row_shr:1 row_mask:0xf bank_mask:0xf bound_ctrl:1
    s_nop 0
    v_add_u32_dpp v14, v14, v14 row_shr:2 row_mask:0xf bank_mask:0xf bound_ctrl:1
    v_add_u32_dpp v15, v15, v15 row_shr:2 row_mask:0xf bank_mask:0xf bound_ctrl:1
    s_nop 0
    v_add_u32_dpp v14, v14, v14 row_shr:4 row_mask:0xf bank_mask:0xf bound_ctrl:1
    v_add_u32_dpp v15, v15, v15 row_shr:4 row_mask:0xf bank_mask:0xf bound_ctrl:1
    s_nop 0
    v_add_u32_dpp v14, v14, v14 row_shr:8 row_mask:0xf bank_mask:0xf bound_ctrl:1
    v_add_u32_dpp v15, v15, v15 row_shr:8 row_mask:0xf bank_mask:0xf bound_ctrl:1
    s_nop 0
    v_add_u32_dpp v14, v14, v14 row_bcast:15 row_mask:0xa bank_mask:0xf
    v_add_u32_dpp v15, v15, v15 row_bcast:15 row_mask:0xa bank_mask:0xf
    s_nop 0
    v_add_u32_dpp v14, v14, v14 row_bcast:31 row_mask:0xc bank_mask:0xf
    v_add_u32_dpp v15, v15, v15 row_bcast:31 row_mask:0xc bank_mask:0xf
    v_readlane_b32 s48, v14, 63
    v_readlane_b32 s49, v15, 63
    s_lshl_b32 s54, s32, 2
    v_mov_b32 v8, s54
    s_and_b32 s50, s48, 0xffff
    s_lshr_b32 s51, s48, 16
    s_and_b32 s52, s49, 0xffff
    s_lshr_b32 s53, s49, 16
    s_add_u32 s51, s51, s50
    s_add_u32 s52, s52, s51
    s_add_u32 s53, s53, s52
    v_mov_b32 v9, s53
    s_mov_b64 exec, 1
    ds_write_b32 v8, v9 offset:16384
    s_mov_b64 exec, -1
    v_and_b32 v8, 60, v7
    s_waitcnt lgkmcnt(0)
    s_barrier
    ds_read_b32 v9, v8 offset:16384
    s_waitcnt lgkmcnt(0)
    v_add_u32_dpp v9, v9, v9 row_shr:1 row_mask:0xf bank_mask:0xf bound_ctrl:1
    s_nop 1
    v_add_u32_dpp v9, v9, v9 row_shr:2 row_mask:0xf bank_mask:0xf bound_ctrl:1
    s_nop 1
    v_add_u32_dpp v9, v9, v9 row_shr:4 row_mask:0xf bank_mask:0xf bound_ctrl:1
    s_nop 1
    v_add_u32_dpp v9, v9, v9 row_shr:8 row_mask:0xf bank_mask:0xf bound_ctrl:1
    s_nop 0
    v_readlane_b32 s54, v9, s32
    s_sub_u32 s54, s54, s53
    s_add_u32 s50, s50, s54
    s_add_u32 s51, s51, s54
    s_add_u32 s52, s52, s54
    s_pack_ll_b32_b16 s48, s54, s50
    s_pack_ll_b32_b16 s49, s51, s52
    v_add_u32 v14, s48, v14
    v_add_u32 v15, s49, v15
    v_sub_u32 v12, v14, v12
    v_sub_u32 v13, v15, v13
    v_and_b32 v8, 0xffff, v12
    v_lshrrev_b32 v9, 16, v12
    v_and_b32 v10, 0xffff, v13
    v_lshrrev_b32 v11, 16, v13
    ds_write2st64_b32 v7, v8, v9 offset0:0 offset1:1
    ds_write2st64_b32 v7, v10, v11 offset0:2 offset1:3
    v_and_b32 v8, 0x3f0, v0
    v_lshl_add_u32 v8, v8, 1, s36
    ds_write_b64 v8, v[12:13] offset:20480
    s_bitset0_b64 exec, 63
    s_not_b64 exec, exec
    ds_write_b64 v8, v[14:15] offset:20512
    s_mov_b64 exec, -1
    s_waitcnt lgkmcnt(0)
    s_barrier
    s_setprio 3
    ds_add_rtn_u32 v72, v72, v2
    ds_add_rtn_u32 v73, v73, v2
    ds_add_rtn_u32 v74, v74, v2
    ds_add_rtn_u32 v75, v75, v2
    ds_read_b128 v[12:15], v0 offset:20480
    v_cmp_gt_u32 vcc, 8448, v0
    ds_add_rtn_u32 v80, v80, v2
    ds_add_rtn_u32 v81, v81, v2
    ds_add_rtn_u32 v82, v82, v2
    ds_add_rtn_u32 v83, v83, v2
    s_setprio 2
    ds_add_rtn_u32 v104, v104, v2
    ds_add_rtn_u32 v105, v105, v2
    ds_add_rtn_u32 v106, v106, v2
    ds_add_rtn_u32 v107, v107, v2
    s_waitcnt lgkmcnt(8)
    s_cbranch_vccz L1_p3
    s_add_u32 s45, s35, 0x5480000
    s_mov_b64 exec, vcc
    buffer_store_dwordx4 v[12:15], v0, s[24:27], s45 offen sc1
    s_mov_b64 exec, -1
L1_p3:
    s_add_u32 s46, s35, 0x2a48000
    s_add_u32 s46, s46, s72
    buffer_store_dwordx4 v[48:51], v0, s[20:23], s46 offen sc1
    s_add_u32 s47, s97, 0x6400000
    s_nop 0
    v_lshlrev_b32 v48, 1, v1
    buffer_load_dwordx4 v[48:51], v48, s[8:11], s47 offen nt
    ds_add_rtn_u32 v112, v112, v2
    ds_add_rtn_u32 v113, v113, v2
    ds_add_rtn_u32 v114, v114, v2
    ds_add_rtn_u32 v115, v115, v2
    s_setprio 1
    ds_add_rtn_u32 v116, v116, v2
    ds_add_rtn_u32 v117, v117, v2
    ds_add_rtn_u32 v118, v118, v2
    ds_add_rtn_u32 v119, v119, v2
    ds_add_rtn_u32 v16, v16, v2
    ds_add_rtn_u32 v17, v17, v2
    ds_add_rtn_u32 v18, v18, v2
    ds_add_rtn_u32 v19, v19, v2
    s_add_u32 s44, s35, 0x2a48000
    s_add_u32 s44, s44, s73
    buffer_store_dwordx4 v[52:55], v0, s[20:23], s44 offen sc1
    s_add_u32 s45, s97, 0x6400000
    s_nop 0
    v_lshlrev_b32 v52, 1, v1
    buffer_load_dwordx4 v[52:55], v52, s[12:15], s45 offen nt
    s_setprio 0
    ds_add_rtn_u32 v124, v124, v2
    ds_add_rtn_u32 v125, v125, v2
    ds_add_rtn_u32 v126, v126, v2
    ds_add_rtn_u32 v127, v127, v2
    ds_add_rtn_u32 v36, v36, v2
    ds_add_rtn_u32 v37, v37, v2
    ds_add_rtn_u32 v38, v38, v2
    ds_add_rtn_u32 v39, v39, v2
    s_waitcnt lgkmcnt(0)
    s_barrier
    s_setprio 3
    v_and_b32 v7, -4, v72
    v_lshl_add_u32 v8, v72, 2, v7
    ds_write_b32 v8, v68
    v_lshl_add_u32 v7, v7, 2, v72
    ds_write_b8 v7, v64 offset:16
    v_and_b32 v9, -4, v73
    v_lshl_add_u32 v10, v73, 2, v9
    ds_write_b32 v10, v69
    v_lshl_add_u32 v9, v9, 2, v73
    ds_write_b8_d16_hi v9, v64 offset:16
    v_and_b32 v7, -4, v74
    v_lshl_add_u32 v8, v74, 2, v7
    ds_write_b32 v8, v70
    v_lshl_add_u32 v7, v7, 2, v74
    ds_write_b8 v7, v65 offset:16
    v_and_b32 v9, -4, v75
    v_lshl_add_u32 v10, v75, 2, v9
    ds_write_b32 v10, v71
    v_lshl_add_u32 v9, v9, 2, v75
    ds_write_b8_d16_hi v9, v65 offset:16
    s_add_u32 s46, s35, 0x2a48000
    s_add_u32 s46, s46, s85
    buffer_store_dwordx4 v[56:59], v0, s[20:23], s46 offen sc1
    s_add_u32 s47, s98, 0x6800000
    v_lshlrev_b32 v68, 1, v1
    buffer_load_dwordx4 v[68:71], v68, s[8:11], s47 offen nt
    s_add_u32 s44, s98, 0x6800000
    v_lshlrev_b32 v72, 1, v1
    buffer_load_dwordx4 v[72:75], v72, s[12:15], s44 offen nt
    v_and_b32 v7, -4, v80
    v_lshl_add_u32 v8, v80, 2, v7
    ds_write_b32 v8, v76
    v_lshl_add_u32 v7, v7, 2, v80
    ds_write_b8 v7, v66 offset:16
    v_and_b32 v9, -4, v81
    v_lshl_add_u32 v10, v81, 2, v9
    ds_write_b32 v10, v77
    v_lshl_add_u32 v9, v9, 2, v81
    ds_write_b8_d16_hi v9, v66 offset:16
    v_and_b32 v7, -4, v82
    v_lshl_add_u32 v8, v82, 2, v7
    ds_write_b32 v8, v78
    v_lshl_add_u32 v7, v7, 2, v82
    ds_write_b8 v7, v67 offset:16
    v_and_b32 v9, -4, v83
    v_lshl_add_u32 v10, v83, 2, v9
    ds_write_b32 v10, v79
    v_lshl_add_u32 v9, v9, 2, v83
    ds_write_b8_d16_hi v9, v67 offset:16
    s_add_u32 s45, s98, 0x6800000
    s_lshr_b32 s45, s45, 1
    buffer_load_dwordx2 v[56:57], v1, s[16:19], s45 offen nt
    s_add_u32 s46, s99, 0x6c00000
    s_lshr_b32 s46, s46, 1
    buffer_load_dwordx2 v[58:59], v1, s[16:19], s46 offen nt
    s_add_u32 s47, s99, 0x6c00000
    v_lshlrev_b32 v76, 1, v1
    buffer_load_dwordx4 v[76:79], v76, s[8:11], s47 offen nt
    s_setprio 2
    v_and_b32 v7, -4, v104
    v_lshl_add_u32 v8, v104, 2, v7
    ds_write_b32 v8, v96
    v_lshl_add_u32 v7, v7, 2, v104
    ds_write_b8 v7, v88 offset:16
    v_and_b32 v9, -4, v105
    v_lshl_add_u32 v10, v105, 2, v9
    ds_write_b32 v10, v97
    v_lshl_add_u32 v9, v9, 2, v105
    ds_write_b8_d16_hi v9, v88 offset:16
    v_and_b32 v7, -4, v106
    v_lshl_add_u32 v8, v106, 2, v7
    ds_write_b32 v8, v98
    v_lshl_add_u32 v7, v7, 2, v106
    ds_write_b8 v7, v89 offset:16
    v_and_b32 v9, -4, v107
    v_lshl_add_u32 v10, v107, 2, v9
    ds_write_b32 v10, v99
    v_lshl_add_u32 v9, v9, 2, v107
    ds_write_b8_d16_hi v9, v89 offset:16
    s_add_u32 s44, s35, 0x2a48000
    s_add_u32 s44, s44, s91
    buffer_store_dwordx4 v[60:63], v0, s[20:23], s44 offen sc1
    s_add_u32 s45, s99, 0x6c00000
    v_lshlrev_b32 v80, 1, v1
    buffer_load_dwordx4 v[80:83], v80, s[12:15], s45 offen nt
    v_and_b32 v7, -4, v112
    v_lshl_add_u32 v8, v112, 2, v7
    ds_write_b32 v8, v100
    v_lshl_add_u32 v7, v7, 2, v112
    ds_write_b8 v7, v90 offset:16
    v_and_b32 v9, -4, v113
    v_lshl_add_u32 v10, v113, 2, v9
    ds_write_b32 v10, v101
    v_lshl_add_u32 v9, v9, 2, v113
    ds_write_b8_d16_hi v9, v90 offset:16
    v_and_b32 v7, -4, v114
    v_lshl_add_u32 v8, v114, 2, v7
    ds_write_b32 v8, v102
    v_lshl_add_u32 v7, v7, 2, v114
    ds_write_b8 v7, v91 offset:16
    v_and_b32 v9, -4, v115
    v_lshl_add_u32 v10, v115, 2, v9
    ds_write_b32 v10, v103
    v_lshl_add_u32 v9, v9, 2, v115
    ds_write_b8_d16_hi v9, v91 offset:16
    s_add_u32 s46, s96, 0x7000000
    v_lshlrev_b32 v64, 1, v1
    buffer_load_dwordx4 v[64:67], v64, s[8:11], s46 offen nt
    s_add_u32 s47, s96, 0x7000000
    v_lshlrev_b32 v96, 1, v1
    buffer_load_dwordx4 v[96:99], v96, s[12:15], s47 offen nt
    s_setprio 1
    v_and_b32 v7, -4, v116
    v_lshl_add_u32 v8, v116, 2, v7
    ds_write_b32 v8, v108
    v_lshl_add_u32 v7, v7, 2, v116
    ds_write_b8 v7, v120 offset:16
    v_and_b32 v9, -4, v117
    v_lshl_add_u32 v10, v117, 2, v9
    ds_write_b32 v10, v109
    v_lshl_add_u32 v9, v9, 2, v117
    ds_write_b8_d16_hi v9, v120 offset:16
    v_and_b32 v7, -4, v118
    v_lshl_add_u32 v8, v118, 2, v7
    ds_write_b32 v8, v110
    v_lshl_add_u32 v7, v7, 2, v118
    ds_write_b8 v7, v121 offset:16
    v_and_b32 v9, -4, v119
    v_lshl_add_u32 v10, v119, 2, v9
    ds_write_b32 v10, v111
    v_lshl_add_u32 v9, v9, 2, v119
    ds_write_b8_d16_hi v9, v121 offset:16
    s_add_u32 s44, s96, 0x7000000
    s_lshr_b32 s44, s44, 1
    buffer_load_dwordx2 v[104:105], v1, s[16:19], s44 offen nt
    s_add_u32 s45, s97, 0x7400000
    s_lshr_b32 s45, s45, 1
    buffer_load_dwordx2 v[106:107], v1, s[16:19], s45 offen nt
    s_add_u32 s46, s97, 0x7400000
    v_lshlrev_b32 v60, 1, v1
    buffer_load_dwordx4 v[60:63], v60, s[8:11], s46 offen nt
    v_and_b32 v7, -4, v16
    v_lshl_add_u32 v8, v16, 2, v7
    ds_write_b32 v8, v92
    v_lshl_add_u32 v7, v7, 2, v16
    ds_write_b8 v7, v122 offset:16
    v_and_b32 v9, -4, v17
    v_lshl_add_u32 v10, v17, 2, v9
    ds_write_b32 v10, v93
    v_lshl_add_u32 v9, v9, 2, v17
    ds_write_b8_d16_hi v9, v122 offset:16
    v_and_b32 v7, -4, v18
    v_lshl_add_u32 v8, v18, 2, v7
    ds_write_b32 v8, v94
    v_lshl_add_u32 v7, v7, 2, v18
    ds_write_b8 v7, v123 offset:16
    v_and_b32 v9, -4, v19
    v_lshl_add_u32 v10, v19, 2, v9
    ds_write_b32 v10, v95
    v_lshl_add_u32 v9, v9, 2, v19
    ds_write_b8_d16_hi v9, v123 offset:16
    s_add_u32 s47, s35, 0x2a48000
    s_add_u32 s47, s47, s93
    buffer_store_dwordx4 v[44:47], v0, s[20:23], s47 offen sc1
    s_add_u32 s44, s97, 0x7400000
    v_lshlrev_b32 v100, 1, v1
    buffer_load_dwordx4 v[100:103], v100, s[12:15], s44 offen nt
    s_setprio 0
    v_and_b32 v7, -4, v124
    v_lshl_add_u32 v8, v124, 2, v7
    ds_write_b32 v8, v20
    v_lshl_add_u32 v7, v7, 2, v124
    ds_write_b8 v7, v28 offset:16
    v_and_b32 v9, -4, v125
    v_lshl_add_u32 v10, v125, 2, v9
    ds_write_b32 v10, v21
    v_lshl_add_u32 v9, v9, 2, v125
    ds_write_b8_d16_hi v9, v28 offset:16
    v_and_b32 v7, -4, v126
    v_lshl_add_u32 v8, v126, 2, v7
    ds_write_b32 v8, v22
    v_lshl_add_u32 v7, v7, 2, v126
    ds_write_b8 v7, v29 offset:16
    v_and_b32 v9, -4, v127
    v_lshl_add_u32 v10, v127, 2, v9
    ds_write_b32 v10, v23
    v_lshl_add_u32 v9, v9, 2, v127
    ds_write_b8_d16_hi v9, v29 offset:16
    s_add_u32 s45, s98, 0x7800000
    v_lshlrev_b32 v112, 1, v1
    buffer_load_dwordx4 v[112:115], v112, s[8:11], s45 offen nt
    s_add_u32 s46, s98, 0x7800000
    v_lshlrev_b32 v88, 1, v1
    buffer_load_dwordx4 v[88:91], v88, s[12:15], s46 offen nt
    v_and_b32 v7, -4, v36
    v_lshl_add_u32 v8, v36, 2, v7
    ds_write_b32 v8, v32
    v_lshl_add_u32 v7, v7, 2, v36
    ds_write_b8 v7, v30 offset:16
    v_and_b32 v9, -4, v37
    v_lshl_add_u32 v10, v37, 2, v9
    ds_write_b32 v10, v33
    v_lshl_add_u32 v9, v9, 2, v37
    ds_write_b8_d16_hi v9, v30 offset:16
    v_and_b32 v7, -4, v38
    v_lshl_add_u32 v8, v38, 2, v7
    ds_write_b32 v8, v34
    v_lshl_add_u32 v7, v7, 2, v38
    ds_write_b8 v7, v31 offset:16
    v_and_b32 v9, -4, v39
    v_lshl_add_u32 v10, v39, 2, v9
    ds_write_b32 v10, v35
    v_lshl_add_u32 v9, v9, 2, v39
    ds_write_b8_d16_hi v9, v31 offset:16
    s_add_u32 s47, s98, 0x7800000
    s_lshr_b32 s47, s47, 1
    buffer_load_dwordx2 v[108:109], v1, s[16:19], s47 offen nt
    s_add_u32 s44, s99, 0x7c00000
    s_lshr_b32 s44, s44, 1
    buffer_load_dwordx2 v[110:111], v1, s[16:19], s44 offen nt
    v_add_u32 v7, s72, v0
    v_add_u32 v12, s73, v0
    v_add_u32 v13, s85, v0
    v_add_u32 v14, s91, v0
    v_add_u32 v15, s93, v0
    s_min_i32 s3, s72, s73
    s_min_i32 s3, s3, s85
    s_min_i32 s3, s3, s91
    s_min_i32 s3, s3, s93
    v_add_u32 v3, s3, v0
    v_mov_b32 v8, 0
    v_mov_b32 v9, 0
    v_mov_b32 v10, 0
    v_mov_b32 v11, 0
    s_waitcnt lgkmcnt(0)
    s_barrier
    ds_read_b128 v[116:119], v7 offset:0
    ds_read_b128 v[92:95], v12 offset:0
    ds_read_b128 v[16:19], v13 offset:0
    ds_read_b128 v[120:123], v14 offset:0
    ds_read_b128 v[44:47], v15 offset:0
    ds_write_b128 v3, v[8:11]
    ds_read_b128 v[20:23], v7 offset:16384
    ds_read_b128 v[124:127], v12 offset:16384
    ds_read_b128 v[32:35], v13 offset:16384
    ds_read_b128 v[36:39], v14 offset:16384
    ds_read_b128 v[28:31], v15 offset:16384
    s_waitcnt lgkmcnt(0)
    s_barrier
    s_setprio 3
    s_add_u32 s45, s35, 0x5484000
    s_add_u32 s45, s45, s72
    buffer_store_dwordx4 v[116:119], v0, s[20:23], s45 offen sc1
    s_add_u32 s46, s99, 0x7c00000
    s_nop 0
    v_lshlrev_b32 v116, 1, v1
    buffer_load_dwordx4 v[116:119], v116, s[8:11], s46 offen nt
    s_add_u32 s47, s35, 0x5484000
    s_add_u32 s47, s47, s73
    buffer_store_dwordx4 v[92:95], v0, s[20:23], s47 offen sc1
    s_add_u32 s44, s99, 0x7c00000
    s_nop 0
    v_lshlrev_b32 v92, 1, v1
    buffer_load_dwordx4 v[92:95], v92, s[12:15], s44 offen nt
    s_waitcnt vmcnt(27)
    v_lshlrev_b32 v7, 16, v84
    v_and_b32 v8, 0xffff0000, v84
    v_lshlrev_b32 v9, 16, v85
    v_and_b32 v10, 0xffff0000, v85
    v_mul_f32 v7, 0.15915494, v7
    v_mul_f32 v8, 0.15915494, v8
    v_mul_f32 v9, 0.15915494, v9
    v_mul_f32 v10, 0.15915494, v10
    v_mul_hi_u32_u24 v14, 429497, v40
    v_lshrrev_b32 v12, 3, v24
    v_cos_f32 v7, v7
    v_lshlrev_b16 v13, 3, v24
    v_mad_i32_i24 v11, v14, s55, v40
    v_bitop3_b32 v12, v6, v13, v12 bitop3:0xca
    v_lshl_add_u32 v11, v11, 17, s40
    v_lshlrev_b16 v14, 8, v14
    v_lshrrev_b32 v13, 2, v24
    v_add_u32 v40, v12, v11
    v_bitop3_b32 v24, v5, v13, v14 bitop3:0xea
    ds_add_u32 v24, v2
    v_mul_hi_u32_u24 v14, 429497, v41
    v_lshrrev_b32 v12, 3, v25
    v_cos_f32 v8, v8
    v_lshlrev_b16 v13, 3, v25
    v_mad_i32_i24 v11, v14, s55, v41
    v_bitop3_b32 v12, v6, v13, v12 bitop3:0xca
    v_lshl_add_u32 v11, v11, 17, s40
    v_lshlrev_b16 v14, 8, v14
    v_lshrrev_b32 v13, 2, v25
    v_add_u32 v41, v12, v11
    v_bitop3_b32 v25, v5, v13, v14 bitop3:0xea
    ds_add_u32 v25, v2
    v_cvt_pk_bf16_f32 v84, v7, v8
    v_perm_b32 v12, v84, v84, s41
    v_bitop3_b32 v40, v4, v12, v40 bitop3:0xca
    v_perm_b32 v13, v84, v84, s42
    v_bitop3_b32 v41, v4, v13, v41 bitop3:0xca
    v_mul_hi_u32_u24 v14, 429497, v42
    v_lshrrev_b32 v12, 3, v26
    v_cos_f32 v9, v9
    v_lshlrev_b16 v13, 3, v26
    v_mad_i32_i24 v11, v14, s55, v42
    v_bitop3_b32 v12, v6, v13, v12 bitop3:0xca
    v_lshl_add_u32 v11, v11, 17, s40
    v_lshlrev_b16 v14, 8, v14
    v_lshrrev_b32 v13, 2, v26
    v_add_u32 v42, v12, v11
    v_bitop3_b32 v26, v5, v13, v14 bitop3:0xea
    ds_add_u32 v26, v2
    v_mul_hi_u32_u24 v14, 429497, v43
    v_lshrrev_b32 v12, 3, v27
    v_cos_f32 v10, v10
    v_lshlrev_b16 v13, 3, v27
    v_mad_i32_i24 v11, v14, s55, v43
    v_bitop3_b32 v12, v6, v13, v12 bitop3:0xca
    v_lshl_add_u32 v11, v11, 17, s40
    v_lshlrev_b16 v14, 8, v14
    v_lshrrev_b32 v13, 2, v27
    v_add_u32 v43, v12, v11
    v_bitop3_b32 v27, v5, v13, v14 bitop3:0xea
    ds_add_u32 v27, v2
    v_cvt_pk_bf16_f32 v85, v9, v10
    v_perm_b32 v12, v85, v85, s41
    v_bitop3_b32 v42, v4, v12, v42 bitop3:0xca
    v_perm_b32 v13, v85, v85, s42
    v_bitop3_b32 v43, v4, v13, v43 bitop3:0xca
    s_waitcnt vmcnt(23)
    v_lshlrev_b32 v7, 16, v86
    v_and_b32 v8, 0xffff0000, v86
    v_lshlrev_b32 v9, 16, v87
    v_and_b32 v10, 0xffff0000, v87
    v_mul_f32 v7, 0.15915494, v7
    v_mul_f32 v8, 0.15915494, v8
    v_mul_f32 v9, 0.15915494, v9
    v_mul_f32 v10, 0.15915494, v10
    v_mul_hi_u32_u24 v14, 429497, v48
    v_lshrrev_b32 v12, 3, v52
    v_cos_f32 v7, v7
    v_lshlrev_b16 v13, 3, v52
    v_mad_i32_i24 v11, v14, s55, v48
    v_bitop3_b32 v12, v6, v13, v12 bitop3:0xca
    v_lshl_add_u32 v11, v11, 17, s40
    v_lshlrev_b16 v14, 8, v14
    v_lshrrev_b32 v13, 2, v52
    v_add_u32 v48, v12, v11
    v_bitop3_b32 v52, v5, v13, v14 bitop3:0xea
    ds_add_u32 v52, v2
    v_mul_hi_u32_u24 v14, 429497, v49
    v_lshrrev_b32 v12, 3, v53
    v_cos_f32 v8, v8
    v_lshlrev_b16 v13, 3, v53
    v_mad_i32_i24 v11, v14, s55, v49
    v_bitop3_b32 v12, v6, v13, v12 bitop3:0xca
    v_lshl_add_u32 v11, v11, 17, s40
    v_lshlrev_b16 v14, 8, v14
    v_lshrrev_b32 v13, 2, v53
    v_add_u32 v49, v12, v11
    v_bitop3_b32 v53, v5, v13, v14 bitop3:0xea
    ds_add_u32 v53, v2
    v_cvt_pk_bf16_f32 v86, v7, v8
    v_perm_b32 v12, v86, v86, s41
    v_bitop3_b32 v48, v4, v12, v48 bitop3:0xca
    v_perm_b32 v13, v86, v86, s42
    v_bitop3_b32 v49, v4, v13, v49 bitop3:0xca
    v_mul_hi_u32_u24 v14, 429497, v50
    v_lshrrev_b32 v12, 3, v54
    v_cos_f32 v9, v9
    v_lshlrev_b16 v13, 3, v54
    v_mad_i32_i24 v11, v14, s55, v50
    v_bitop3_b32 v12, v6, v13, v12 bitop3:0xca
    v_lshl_add_u32 v11, v11, 17, s40
    v_lshlrev_b16 v14, 8, v14
    v_lshrrev_b32 v13, 2, v54
    v_add_u32 v50, v12, v11
    v_bitop3_b32 v54, v5, v13, v14 bitop3:0xea
    ds_add_u32 v54, v2
    v_mul_hi_u32_u24 v14, 429497, v51
    v_lshrrev_b32 v12, 3, v55
    v_cos_f32 v10, v10
    v_lshlrev_b16 v13, 3, v55
    v_mad_i32_i24 v11, v14, s55, v51
    v_bitop3_b32 v12, v6, v13, v12 bitop3:0xca
    v_lshl_add_u32 v11, v11, 17, s40
    v_lshlrev_b16 v14, 8, v14
    v_lshrrev_b32 v13, 2, v55
    v_add_u32 v51, v12, v11
    v_bitop3_b32 v55, v5, v13, v14 bitop3:0xea
    ds_add_u32 v55, v2
    v_cvt_pk_bf16_f32 v87, v9, v10
    v_perm_b32 v12, v87, v87, s41
    v_bitop3_b32 v50, v4, v12, v50 bitop3:0xca
    v_perm_b32 v13, v87, v87, s42
    v_bitop3_b32 v51, v4, v13, v51 bitop3:0xca
    s_setprio 2
    s_waitcnt vmcnt(18)
    v_lshlrev_b32 v7, 16, v56
    v_and_b32 v8, 0xffff0000, v56
    v_lshlrev_b32 v9, 16, v57
    v_and_b32 v10, 0xffff0000, v57
    v_mul_f32 v7, 0.15915494, v7
    v_mul_f32 v8, 0.15915494, v8
    v_mul_f32 v9, 0.15915494, v9
    v_mul_f32 v10, 0.15915494, v10
    v_mul_hi_u32_u24 v14, 429497, v68
    v_lshrrev_b32 v12, 3, v72
    v_cos_f32 v7, v7
    v_lshlrev_b16 v13, 3, v72
    v_mad_i32_i24 v11, v14, s55, v68
    v_bitop3_b32 v12, v6, v13, v12 bitop3:0xca
    v_lshl_add_u32 v11, v11, 17, s40
    v_lshlrev_b16 v14, 8, v14
    v_lshrrev_b32 v13, 2, v72
    v_add_u32 v68, v12, v11
    v_bitop3_b32 v72, v5, v13, v14 bitop3:0xea
    ds_add_u32 v72, v2
    v_mul_hi_u32_u24 v14, 429497, v69
    v_lshrrev_b32 v12, 3, v73
    v_cos_f32 v8, v8
    v_lshlrev_b16 v13, 3, v73
    v_mad_i32_i24 v11, v14, s55, v69
    v_bitop3_b32 v12, v6, v13, v12 bitop3:0xca
    v_lshl_add_u32 v11, v11, 17, s40
    v_lshlrev_b16 v14, 8, v14
    v_lshrrev_b32 v13, 2, v73
    v_add_u32 v69, v12, v11
    v_bitop3_b32 v73, v5, v13, v14 bitop3:0xea
    ds_add_u32 v73, v2
    v_cvt_pk_bf16_f32 v56, v7, v8
    v_perm_b32 v12, v56, v56, s41
    v_bitop3_b32 v68, v4, v12, v68 bitop3:0xca
    v_perm_b32 v13, v56, v56, s42
    v_bitop3_b32 v69, v4, v13, v69 bitop3:0xca
    v_mul_hi_u32_u24 v14, 429497, v70
    v_lshrrev_b32 v12, 3, v74
    v_cos_f32 v9, v9
    v_lshlrev_b16 v13, 3, v74
    v_mad_i32_i24 v11, v14, s55, v70
    v_bitop3_b32 v12, v6, v13, v12 bitop3:0xca
    v_lshl_add_u32 v11, v11, 17, s40
    v_lshlrev_b16 v14, 8, v14
    v_lshrrev_b32 v13, 2, v74
    v_add_u32 v70, v12, v11
    v_bitop3_b32 v74, v5, v13, v14 bitop3:0xea
    ds_add_u32 v74, v2
    v_mul_hi_u32_u24 v14, 429497, v71
    v_lshrrev_b32 v12, 3, v75
    v_cos_f32 v10, v10
    v_lshlrev_b16 v13, 3, v75
    v_mad_i32_i24 v11, v14, s55, v71
    v_bitop3_b32 v12, v6, v13, v12 bitop3:0xca
    v_lshl_add_u32 v11, v11, 17, s40
    v_lshlrev_b16 v14, 8, v14
    v_lshrrev_b32 v13, 2, v75
    v_add_u32 v71, v12, v11
    v_bitop3_b32 v75, v5, v13, v14 bitop3:0xea
    ds_add_u32 v75, v2
    v_cvt_pk_bf16_f32 v57, v9, v10
    v_perm_b32 v12, v57, v57, s41
    v_bitop3_b32 v70, v4, v12, v70 bitop3:0xca
    v_perm_b32 v13, v57, v57, s42
    v_bitop3_b32 v71, v4, v13, v71 bitop3:0xca
    s_add_u32 s45, s35, 0x5484000
    s_add_u32 s45, s45, s85
    buffer_store_dwordx4 v[16:19], v0, s[20:23], s45 offen sc1
    s_add_u32 s46, s96, 0x8000000
    s_nop 0
    v_lshlrev_b32 v16, 1, v1
    buffer_load_dwordx4 v[16:19], v16, s[8:11], s46 offen nt
    s_waitcnt vmcnt(17)
    v_lshlrev_b32 v7, 16, v58
    v_and_b32 v8, 0xffff0000, v58
    v_lshlrev_b32 v9, 16, v59
    v_and_b32 v10, 0xffff0000, v59
    v_mul_f32 v7, 0.15915494, v7
    v_mul_f32 v8, 0.15915494, v8
    v_mul_f32 v9, 0.15915494, v9
    v_mul_f32 v10, 0.15915494, v10
    v_mul_hi_u32_u24 v14, 429497, v76
    v_lshrrev_b32 v12, 3, v80
    v_cos_f32 v7, v7
    v_lshlrev_b16 v13, 3, v80
    v_mad_i32_i24 v11, v14, s55, v76
    v_bitop3_b32 v12, v6, v13, v12 bitop3:0xca
    v_lshl_add_u32 v11, v11, 17, s40
    v_lshlrev_b16 v14, 8, v14
    v_lshrrev_b32 v13, 2, v80
    v_add_u32 v76, v12, v11
    v_bitop3_b32 v80, v5, v13, v14 bitop3:0xea
    ds_add_u32 v80, v2
    v_mul_hi_u32_u24 v14, 429497, v77
    v_lshrrev_b32 v12, 3, v81
    v_cos_f32 v8, v8
    v_lshlrev_b16 v13, 3, v81
    v_mad_i32_i24 v11, v14, s55, v77
    v_bitop3_b32 v12, v6, v13, v12 bitop3:0xca
    v_lshl_add_u32 v11, v11, 17, s40
    v_lshlrev_b16 v14, 8, v14
    v_lshrrev_b32 v13, 2, v81
    v_add_u32 v77, v12, v11
    v_bitop3_b32 v81, v5, v13, v14 bitop3:0xea
    ds_add_u32 v81, v2
    v_cvt_pk_bf16_f32 v58, v7, v8
    v_perm_b32 v12, v58, v58, s41
    v_bitop3_b32 v76, v4, v12, v76 bitop3:0xca
    v_perm_b32 v13, v58, v58, s42
    v_bitop3_b32 v77, v4, v13, v77 bitop3:0xca
    v_mul_hi_u32_u24 v14, 429497, v78
    v_lshrrev_b32 v12, 3, v82
    v_cos_f32 v9, v9
    v_lshlrev_b16 v13, 3, v82
    v_mad_i32_i24 v11, v14, s55, v78
    v_bitop3_b32 v12, v6, v13, v12 bitop3:0xca
    v_lshl_add_u32 v11, v11, 17, s40
    v_lshlrev_b16 v14, 8, v14
    v_lshrrev_b32 v13, 2, v82
    v_add_u32 v78, v12, v11
    v_bitop3_b32 v82, v5, v13, v14 bitop3:0xea
    ds_add_u32 v82, v2
    v_mul_hi_u32_u24 v14, 429497, v79
    v_lshrrev_b32 v12, 3, v83
    v_cos_f32 v10, v10
    v_lshlrev_b16 v13, 3, v83
    v_mad_i32_i24 v11, v14, s55, v79
    v_bitop3_b32 v12, v6, v13, v12 bitop3:0xca
    v_lshl_add_u32 v11, v11, 17, s40
    v_lshlrev_b16 v14, 8, v14
    v_lshrrev_b32 v13, 2, v83
    v_add_u32 v79, v12, v11
    v_bitop3_b32 v83, v5, v13, v14 bitop3:0xea
    ds_add_u32 v83, v2
    v_cvt_pk_bf16_f32 v59, v9, v10
    v_perm_b32 v12, v59, v59, s41
    v_bitop3_b32 v78, v4, v12, v78 bitop3:0xca
    v_perm_b32 v13, v59, v59, s42
    v_bitop3_b32 v79, v4, v13, v79 bitop3:0xca
    s_setprio 1
    s_waitcnt vmcnt(13)
    v_lshlrev_b32 v7, 16, v104
    v_and_b32 v8, 0xffff0000, v104
    v_lshlrev_b32 v9, 16, v105
    v_and_b32 v10, 0xffff0000, v105
    v_mul_f32 v7, 0.15915494, v7
    v_mul_f32 v8, 0.15915494, v8
    v_mul_f32 v9, 0.15915494, v9
    v_mul_f32 v10, 0.15915494, v10
    v_mul_hi_u32_u24 v14, 429497, v64
    v_lshrrev_b32 v12, 3, v96
    v_cos_f32 v7, v7
    v_lshlrev_b16 v13, 3, v96
    v_mad_i32_i24 v11, v14, s55, v64
    v_bitop3_b32 v12, v6, v13, v12 bitop3:0xca
    v_lshl_add_u32 v11, v11, 17, s40
    v_lshlrev_b16 v14, 8, v14
    v_lshrrev_b32 v13, 2, v96
    v_add_u32 v64, v12, v11
    v_bitop3_b32 v96, v5, v13, v14 bitop3:0xea
    ds_add_u32 v96, v2
    v_mul_hi_u32_u24 v14, 429497, v65
    v_lshrrev_b32 v12, 3, v97
    v_cos_f32 v8, v8
    v_lshlrev_b16 v13, 3, v97
    v_mad_i32_i24 v11, v14, s55, v65
    v_bitop3_b32 v12, v6, v13, v12 bitop3:0xca
    v_lshl_add_u32 v11, v11, 17, s40
    v_lshlrev_b16 v14, 8, v14
    v_lshrrev_b32 v13, 2, v97
    v_add_u32 v65, v12, v11
    v_bitop3_b32 v97, v5, v13, v14 bitop3:0xea
    ds_add_u32 v97, v2
    v_cvt_pk_bf16_f32 v104, v7, v8
    v_perm_b32 v12, v104, v104, s41
    v_bitop3_b32 v64, v4, v12, v64 bitop3:0xca
    v_perm_b32 v13, v104, v104, s42
    v_bitop3_b32 v65, v4, v13, v65 bitop3:0xca
    v_mul_hi_u32_u24 v14, 429497, v66
    v_lshrrev_b32 v12, 3, v98
    v_cos_f32 v9, v9
    v_lshlrev_b16 v13, 3, v98
    v_mad_i32_i24 v11, v14, s55, v66
    v_bitop3_b32 v12, v6, v13, v12 bitop3:0xca
    v_lshl_add_u32 v11, v11, 17, s40
    v_lshlrev_b16 v14, 8, v14
    v_lshrrev_b32 v13, 2, v98
    v_add_u32 v66, v12, v11
    v_bitop3_b32 v98, v5, v13, v14 bitop3:0xea
    ds_add_u32 v98, v2
    v_mul_hi_u32_u24 v14, 429497, v67
    v_lshrrev_b32 v12, 3, v99
    v_cos_f32 v10, v10
    v_lshlrev_b16 v13, 3, v99
    v_mad_i32_i24 v11, v14, s55, v67
    v_bitop3_b32 v12, v6, v13, v12 bitop3:0xca
    v_lshl_add_u32 v11, v11, 17, s40
    v_lshlrev_b16 v14, 8, v14
    v_lshrrev_b32 v13, 2, v99
    v_add_u32 v67, v12, v11
    v_bitop3_b32 v99, v5, v13, v14 bitop3:0xea
    ds_add_u32 v99, v2
    v_cvt_pk_bf16_f32 v105, v9, v10
    v_perm_b32 v12, v105, v105, s41
    v_bitop3_b32 v66, v4, v12, v66 bitop3:0xca
    v_perm_b32 v13, v105, v105, s42
    v_bitop3_b32 v67, v4, v13, v67 bitop3:0xca
    s_mov_b32 s68, s66
    s_mov_b32 s69, s67
    s_mov_b32 s70, 0x100
    s_mov_b32 s71, 0x20000
    v_mov_b32 v3, 1
    s_cmp_lg_u32 s32, 15
    s_cbranch_scc1 L1_tk
    s_mov_b64 exec, 1
    s_and_b32 s3, s2, 1
    s_lshl_b32 s3, s3, 7
    buffer_atomic_add v3, off, s[68:71], s3 sc0
    s_mov_b64 exec, -1
L1_tk:
    s_waitcnt vmcnt(10)
    v_lshlrev_b32 v7, 16, v106
    v_and_b32 v8, 0xffff0000, v106
    v_lshlrev_b32 v9, 16, v107
    v_and_b32 v10, 0xffff0000, v107
    v_mul_f32 v7, 0.15915494, v7
    v_mul_f32 v8, 0.15915494, v8
    v_mul_f32 v9, 0.15915494, v9
    v_mul_f32 v10, 0.15915494, v10
    v_mul_hi_u32_u24 v14, 429497, v60
    v_lshrrev_b32 v12, 3, v100
    v_cos_f32 v7, v7
    v_lshlrev_b16 v13, 3, v100
    v_mad_i32_i24 v11, v14, s55, v60
    v_bitop3_b32 v12, v6, v13, v12 bitop3:0xca
    v_lshl_add_u32 v11, v11, 17, s40
    v_lshlrev_b16 v14, 8, v14
    v_lshrrev_b32 v13, 2, v100
    v_add_u32 v60, v12, v11
    v_bitop3_b32 v100, v5, v13, v14 bitop3:0xea
    ds_add_u32 v100, v2
    v_mul_hi_u32_u24 v14, 429497, v61
    v_lshrrev_b32 v12, 3, v101
    v_cos_f32 v8, v8
    v_lshlrev_b16 v13, 3, v101
    v_mad_i32_i24 v11, v14, s55, v61
    v_bitop3_b32 v12, v6, v13, v12 bitop3:0xca
    v_lshl_add_u32 v11, v11, 17, s40
    v_lshlrev_b16 v14, 8, v14
    v_lshrrev_b32 v13, 2, v101
    v_add_u32 v61, v12, v11
    v_bitop3_b32 v101, v5, v13, v14 bitop3:0xea
    ds_add_u32 v101, v2
    v_cvt_pk_bf16_f32 v106, v7, v8
    v_perm_b32 v12, v106, v106, s41
    v_bitop3_b32 v60, v4, v12, v60 bitop3:0xca
    v_perm_b32 v13, v106, v106, s42
    v_bitop3_b32 v61, v4, v13, v61 bitop3:0xca
    v_mul_hi_u32_u24 v14, 429497, v62
    v_lshrrev_b32 v12, 3, v102
    v_cos_f32 v9, v9
    v_lshlrev_b16 v13, 3, v102
    v_mad_i32_i24 v11, v14, s55, v62
    v_bitop3_b32 v12, v6, v13, v12 bitop3:0xca
    v_lshl_add_u32 v11, v11, 17, s40
    v_lshlrev_b16 v14, 8, v14
    v_lshrrev_b32 v13, 2, v102
    v_add_u32 v62, v12, v11
    v_bitop3_b32 v102, v5, v13, v14 bitop3:0xea
    ds_add_u32 v102, v2
    v_mul_hi_u32_u24 v14, 429497, v63
    v_lshrrev_b32 v12, 3, v103
    v_cos_f32 v10, v10
    v_lshlrev_b16 v13, 3, v103
    v_mad_i32_i24 v11, v14, s55, v63
    v_bitop3_b32 v12, v6, v13, v12 bitop3:0xca
    v_lshl_add_u32 v11, v11, 17, s40
    v_lshlrev_b16 v14, 8, v14
    v_lshrrev_b32 v13, 2, v103
    v_add_u32 v63, v12, v11
    v_bitop3_b32 v103, v5, v13, v14 bitop3:0xea
    ds_add_u32 v103, v2
    v_cvt_pk_bf16_f32 v107, v9, v10
    v_perm_b32 v12, v107, v107, s41
    v_bitop3_b32 v62, v4, v12, v62 bitop3:0xca
    v_perm_b32 v13, v107, v107, s42
    v_bitop3_b32 v63, v4, v13, v63 bitop3:0xca
    s_setprio 0
    s_add_u32 s47, s35, 0x5484000
    s_add_u32 s47, s47, s91
    buffer_store_dwordx4 v[120:123], v0, s[20:23], s47 offen sc1
    s_add_u32 s44, s96, 0x8000000
    s_nop 0
    v_lshlrev_b32 v120, 1, v1
    buffer_load_dwordx4 v[120:123], v120, s[12:15], s44 offen nt
    s_waitcnt vmcnt(8)
    v_lshlrev_b32 v7, 16, v108
    v_and_b32 v8, 0xffff0000, v108
    v_lshlrev_b32 v9, 16, v109
    v_and_b32 v10, 0xffff0000, v109
    v_mul_f32 v7, 0.15915494, v7
    v_mul_f32 v8, 0.15915494, v8
    v_mul_f32 v9, 0.15915494, v9
    v_mul_f32 v10, 0.15915494, v10
    v_mul_hi_u32_u24 v14, 429497, v112
    v_lshrrev_b32 v12, 3, v88
    v_cos_f32 v7, v7
    v_lshlrev_b16 v13, 3, v88
    v_mad_i32_i24 v11, v14, s55, v112
    v_bitop3_b32 v12, v6, v13, v12 bitop3:0xca
    v_lshl_add_u32 v11, v11, 17, s40
    v_lshlrev_b16 v14, 8, v14
    v_lshrrev_b32 v13, 2, v88
    v_add_u32 v112, v12, v11
    v_bitop3_b32 v88, v5, v13, v14 bitop3:0xea
    ds_add_u32 v88, v2
    v_mul_hi_u32_u24 v14, 429497, v113
    v_lshrrev_b32 v12, 3, v89
    v_cos_f32 v8, v8
    v_lshlrev_b16 v13, 3, v89
    v_mad_i32_i24 v11, v14, s55, v113
    v_bitop3_b32 v12, v6, v13, v12 bitop3:0xca
    v_lshl_add_u32 v11, v11, 17, s40
    v_lshlrev_b16 v14, 8, v14
    v_lshrrev_b32 v13, 2, v89
    v_add_u32 v113, v12, v11
    v_bitop3_b32 v89, v5, v13, v14 bitop3:0xea
    ds_add_u32 v89, v2
    v_cvt_pk_bf16_f32 v108, v7, v8
    v_perm_b32 v12, v108, v108, s41
    v_bitop3_b32 v112, v4, v12, v112 bitop3:0xca
    v_perm_b32 v13, v108, v108, s42
    v_bitop3_b32 v113, v4, v13, v113 bitop3:0xca
    v_mul_hi_u32_u24 v14, 429497, v114
    v_lshrrev_b32 v12, 3, v90
    v_cos_f32 v9, v9
    v_lshlrev_b16 v13, 3, v90
    v_mad_i32_i24 v11, v14, s55, v114
    v_bitop3_b32 v12, v6, v13, v12 bitop3:0xca
    v_lshl_add_u32 v11, v11, 17, s40
    v_lshlrev_b16 v14, 8, v14
    v_lshrrev_b32 v13, 2, v90
    v_add_u32 v114, v12, v11
    v_bitop3_b32 v90, v5, v13, v14 bitop3:0xea
    ds_add_u32 v90, v2
    v_mul_hi_u32_u24 v14, 429497, v115
    v_lshrrev_b32 v12, 3, v91
    v_cos_f32 v10, v10
    v_lshlrev_b16 v13, 3, v91
    v_mad_i32_i24 v11, v14, s55, v115
    v_bitop3_b32 v12, v6, v13, v12 bitop3:0xca
    v_lshl_add_u32 v11, v11, 17, s40
    v_lshlrev_b16 v14, 8, v14
    v_lshrrev_b32 v13, 2, v91
    v_add_u32 v115, v12, v11
    v_bitop3_b32 v91, v5, v13, v14 bitop3:0xea
    ds_add_u32 v91, v2
    v_cvt_pk_bf16_f32 v109, v9, v10
    v_perm_b32 v12, v109, v109, s41
    v_bitop3_b32 v114, v4, v12, v114 bitop3:0xca
    v_perm_b32 v13, v109, v109, s42
    v_bitop3_b32 v115, v4, v13, v115 bitop3:0xca
    s_waitcnt vmcnt(4)
    v_lshlrev_b32 v7, 16, v110
    v_and_b32 v8, 0xffff0000, v110
    v_lshlrev_b32 v9, 16, v111
    v_and_b32 v10, 0xffff0000, v111
    v_mul_f32 v7, 0.15915494, v7
    v_mul_f32 v8, 0.15915494, v8
    v_mul_f32 v9, 0.15915494, v9
    v_mul_f32 v10, 0.15915494, v10
    v_mul_hi_u32_u24 v14, 429497, v116
    v_lshrrev_b32 v12, 3, v92
    v_cos_f32 v7, v7
    v_lshlrev_b16 v13, 3, v92
    v_mad_i32_i24 v11, v14, s55, v116
    v_bitop3_b32 v12, v6, v13, v12 bitop3:0xca
    v_lshl_add_u32 v11, v11, 17, s40
    v_lshlrev_b16 v14, 8, v14
    v_lshrrev_b32 v13, 2, v92
    v_add_u32 v116, v12, v11
    v_bitop3_b32 v92, v5, v13, v14 bitop3:0xea
    ds_add_u32 v92, v2
    v_mul_hi_u32_u24 v14, 429497, v117
    v_lshrrev_b32 v12, 3, v93
    v_cos_f32 v8, v8
    v_lshlrev_b16 v13, 3, v93
    v_mad_i32_i24 v11, v14, s55, v117
    v_bitop3_b32 v12, v6, v13, v12 bitop3:0xca
    v_lshl_add_u32 v11, v11, 17, s40
    v_lshlrev_b16 v14, 8, v14
    v_lshrrev_b32 v13, 2, v93
    v_add_u32 v117, v12, v11
    v_bitop3_b32 v93, v5, v13, v14 bitop3:0xea
    ds_add_u32 v93, v2
    v_cvt_pk_bf16_f32 v110, v7, v8
    v_perm_b32 v12, v110, v110, s41
    v_bitop3_b32 v116, v4, v12, v116 bitop3:0xca
    v_perm_b32 v13, v110, v110, s42
    v_bitop3_b32 v117, v4, v13, v117 bitop3:0xca
    v_mul_hi_u32_u24 v14, 429497, v118
    v_lshrrev_b32 v12, 3, v94
    v_cos_f32 v9, v9
    v_lshlrev_b16 v13, 3, v94
    v_mad_i32_i24 v11, v14, s55, v118
    v_bitop3_b32 v12, v6, v13, v12 bitop3:0xca
    v_lshl_add_u32 v11, v11, 17, s40
    v_lshlrev_b16 v14, 8, v14
    v_lshrrev_b32 v13, 2, v94
    v_add_u32 v118, v12, v11
    v_bitop3_b32 v94, v5, v13, v14 bitop3:0xea
    ds_add_u32 v94, v2
    v_mul_hi_u32_u24 v14, 429497, v119
    v_lshrrev_b32 v12, 3, v95
    v_cos_f32 v10, v10
    v_lshlrev_b16 v13, 3, v95
    v_mad_i32_i24 v11, v14, s55, v119
    v_bitop3_b32 v12, v6, v13, v12 bitop3:0xca
    v_lshl_add_u32 v11, v11, 17, s40
    v_lshlrev_b16 v14, 8, v14
    v_lshrrev_b32 v13, 2, v95
    v_add_u32 v119, v12, v11
    v_bitop3_b32 v95, v5, v13, v14 bitop3:0xea
    ds_add_u32 v95, v2
    v_cvt_pk_bf16_f32 v111, v9, v10
    v_perm_b32 v12, v111, v111, s41
    v_bitop3_b32 v118, v4, v12, v118 bitop3:0xca
    v_perm_b32 v13, v111, v111, s42
    v_bitop3_b32 v119, v4, v13, v119 bitop3:0xca
    v_lshrrev_b32 v8, 2, v0
    v_and_b32 v7, 0x3c00, v0
    v_bitop3_b32 v7, v5, v8, v7 bitop3:0xea
    s_waitcnt lgkmcnt(0)
    s_barrier
    ds_read2st64_b32 v[8:9], v7 offset0:0 offset1:1
    ds_read2st64_b32 v[10:11], v7 offset0:2 offset1:3
    s_add_u32 s45, s35, 0x5484000
    s_add_u32 s45, s45, s93
    buffer_store_dwordx4 v[44:47], v0, s[20:23], s45 offen sc1
    s_add_u32 s46, s96, 0x8000000
    s_lshr_b32 s46, s46, 1
    buffer_load_dwordx2 v[44:45], v1, s[16:19], s46 offen nt
    s_add_u32 s47, s97, 0x8400000
    s_lshr_b32 s47, s47, 1
    buffer_load_dwordx2 v[46:47], v1, s[16:19], s47 offen nt
    s_waitcnt lgkmcnt(0)
    v_lshl_or_b32 v12, v9, 16, v8
    v_lshl_or_b32 v13, v11, 16, v10
    v_mov_b32 v14, v12
    v_mov_b32 v15, v13
    s_nop 0
    v_add_u32_dpp v14, v14, v14 row_shr:1 row_mask:0xf bank_mask:0xf bound_ctrl:1
    v_add_u32_dpp v15, v15, v15 row_shr:1 row_mask:0xf bank_mask:0xf bound_ctrl:1
    s_nop 0
    v_add_u32_dpp v14, v14, v14 row_shr:2 row_mask:0xf bank_mask:0xf bound_ctrl:1
    v_add_u32_dpp v15, v15, v15 row_shr:2 row_mask:0xf bank_mask:0xf bound_ctrl:1
    s_nop 0
    v_add_u32_dpp v14, v14, v14 row_shr:4 row_mask:0xf bank_mask:0xf bound_ctrl:1
    v_add_u32_dpp v15, v15, v15 row_shr:4 row_mask:0xf bank_mask:0xf bound_ctrl:1
    s_nop 0
    v_add_u32_dpp v14, v14, v14 row_shr:8 row_mask:0xf bank_mask:0xf bound_ctrl:1
    v_add_u32_dpp v15, v15, v15 row_shr:8 row_mask:0xf bank_mask:0xf bound_ctrl:1
    s_nop 0
    v_add_u32_dpp v14, v14, v14 row_bcast:15 row_mask:0xa bank_mask:0xf
    v_add_u32_dpp v15, v15, v15 row_bcast:15 row_mask:0xa bank_mask:0xf
    s_nop 0
    v_add_u32_dpp v14, v14, v14 row_bcast:31 row_mask:0xc bank_mask:0xf
    v_add_u32_dpp v15, v15, v15 row_bcast:31 row_mask:0xc bank_mask:0xf
    v_readlane_b32 s48, v14, 63
    v_readlane_b32 s49, v15, 63
    s_lshl_b32 s54, s32, 2
    v_mov_b32 v8, s54
    s_and_b32 s50, s48, 0xffff
    s_lshr_b32 s51, s48, 16
    s_and_b32 s52, s49, 0xffff
    s_lshr_b32 s53, s49, 16
    s_add_u32 s51, s51, s50
    s_add_u32 s52, s52, s51
    s_add_u32 s53, s53, s52
    v_mov_b32 v9, s53
    s_mov_b64 exec, 1
    ds_write_b32 v8, v9 offset:16384
    s_cmp_lg_u32 s32, 15
    s_cbranch_scc1 L1_tk2
    s_waitcnt vmcnt(3)
L1_tk2:
    ds_write_b32 v8, v3 offset:16448
    s_mov_b64 exec, -1
    v_and_b32 v8, 60, v7
    s_waitcnt lgkmcnt(0)
    s_barrier
    ds_read_b32 v9, v8 offset:16384
    ds_read_b32 v10, v8 offset:16448
    s_waitcnt lgkmcnt(0)
    v_readlane_b32 s84, v10, 15
    s_and_b32 s3, s2, 1
    s_lshl_b32 s3, s3, 7
    s_add_u32 s84, s84, s3
    s_min_u32 s4, s84, 72
    s_min_u32 s5, s84, 216
    s_min_u32 s6, s84, 240
    s_add_u32 s4, s4, s5
    s_add_u32 s4, s4, s6
    s_add_u32 s4, s4, 9467
    s_mov_b32 s4, s84
    s_lshl_b32 s58, s4, 14
    s_lshl_b32 s5, s32, 10
    s_add_u32 s58, s58, s5
    s_lshr_b32 s59, s58, 1
    s_mov_b32 s43, 5
    s_cmp_lt_u32 s84, 72
    s_addc_u32 s43, s43, 0
    s_cmp_lt_u32 s84, 216
    s_addc_u32 s43, s43, 0
    s_cmp_lt_u32 s84, 240
    s_addc_u32 s43, s43, 0
    v_add_u32_dpp v9, v9, v9 row_shr:1 row_mask:0xf bank_mask:0xf bound_ctrl:1
    s_nop 1
    v_add_u32_dpp v9, v9, v9 row_shr:2 row_mask:0xf bank_mask:0xf bound_ctrl:1
    s_nop 1
    v_add_u32_dpp v9, v9, v9 row_shr:4 row_mask:0xf bank_mask:0xf bound_ctrl:1
    s_nop 1
    v_add_u32_dpp v9, v9, v9 row_shr:8 row_mask:0xf bank_mask:0xf bound_ctrl:1
    s_nop 0
    v_readlane_b32 s54, v9, s32
    s_sub_u32 s54, s54, s53
    s_add_u32 s50, s50, s54
    s_add_u32 s51, s51, s54
    s_add_u32 s52, s52, s54
    s_pack_ll_b32_b16 s48, s54, s50
    s_pack_ll_b32_b16 s49, s51, s52
    v_add_u32 v14, s48, v14
    v_add_u32 v15, s49, v15
    v_sub_u32 v12, v14, v12
    v_sub_u32 v13, v15, v13
    v_and_b32 v8, 0xffff, v12
    v_lshrrev_b32 v9, 16, v12
    v_and_b32 v10, 0xffff, v13
    v_lshrrev_b32 v11, 16, v13
    ds_write2st64_b32 v7, v8, v9 offset0:0 offset1:1
    ds_write2st64_b32 v7, v10, v11 offset0:2 offset1:3
    v_and_b32 v8, 0x3f0, v0
    v_lshl_add_u32 v8, v8, 1, s36
    ds_write_b64 v8, v[12:13] offset:20480
    s_bitset0_b64 exec, 63
    s_not_b64 exec, exec
    ds_write_b64 v8, v[14:15] offset:20512
    s_mov_b64 exec, -1
    s_waitcnt lgkmcnt(0)
    s_barrier
    s_setprio 3
    ds_add_rtn_u32 v24, v24, v2
    ds_add_rtn_u32 v25, v25, v2
    ds_add_rtn_u32 v26, v26, v2
    ds_add_rtn_u32 v27, v27, v2
    ds_read_b128 v[12:15], v0 offset:20480
    v_cmp_gt_u32 vcc, 8448, v0
    ds_add_rtn_u32 v52, v52, v2
    ds_add_rtn_u32 v53, v53, v2
    ds_add_rtn_u32 v54, v54, v2
    ds_add_rtn_u32 v55, v55, v2
    s_setprio 2
    ds_add_rtn_u32 v72, v72, v2
    ds_add_rtn_u32 v73, v73, v2
    ds_add_rtn_u32 v74, v74, v2
    ds_add_rtn_u32 v75, v75, v2
    s_waitcnt lgkmcnt(8)
    s_cbranch_vccz L1_p4
    s_add_u32 s44, s35, 0x7ec0000
    s_mov_b64 exec, vcc
    buffer_store_dwordx4 v[12:15], v0, s[24:27], s44 offen sc1
    s_mov_b64 exec, -1
L1_p4:
    s_add_u32 s45, s35, 0x5488000
    s_add_u32 s45, s45, s72
    buffer_store_dwordx4 v[20:23], v0, s[20:23], s45 offen sc1
    s_add_u32 s46, s97, 0x8400000
    s_nop 0
    v_lshlrev_b32 v20, 1, v1
    buffer_load_dwordx4 v[20:23], v20, s[8:11], s46 offen nt
    ds_add_rtn_u32 v80, v80, v2
    ds_add_rtn_u32 v81, v81, v2
    ds_add_rtn_u32 v82, v82, v2
    ds_add_rtn_u32 v83, v83, v2
    s_setprio 1
    ds_add_rtn_u32 v96, v96, v2
    ds_add_rtn_u32 v97, v97, v2
    ds_add_rtn_u32 v98, v98, v2
    ds_add_rtn_u32 v99, v99, v2
    ds_add_rtn_u32 v100, v100, v2
    ds_add_rtn_u32 v101, v101, v2
    ds_add_rtn_u32 v102, v102, v2
    ds_add_rtn_u32 v103, v103, v2
    s_add_u32 s47, s35, 0x5488000
    s_add_u32 s47, s47, s73
    buffer_store_dwordx4 v[124:127], v0, s[20:23], s47 offen sc1
    s_add_u32 s44, s97, 0x8400000
    s_nop 0
    v_lshlrev_b32 v124, 1, v1
    buffer_load_dwordx4 v[124:127], v124, s[12:15], s44 offen nt
    s_setprio 0
    ds_add_rtn_u32 v88, v88, v2
    ds_add_rtn_u32 v89, v89, v2
    ds_add_rtn_u32 v90, v90, v2
    ds_add_rtn_u32 v91, v91, v2
    ds_add_rtn_u32 v92, v92, v2
    ds_add_rtn_u32 v93, v93, v2
    ds_add_rtn_u32 v94, v94, v2
    ds_add_rtn_u32 v95, v95, v2
    s_waitcnt lgkmcnt(0)
    s_barrier
    s_setprio 3
    v_and_b32 v7, -4, v24
    v_lshl_add_u32 v8, v24, 2, v7
    ds_write_b32 v8, v40
    v_lshl_add_u32 v7, v7, 2, v24
    ds_write_b8 v7, v84 offset:16
    v_and_b32 v9, -4, v25
    v_lshl_add_u32 v10, v25, 2, v9
    ds_write_b32 v10, v41
    v_lshl_add_u32 v9, v9, 2, v25
    ds_write_b8_d16_hi v9, v84 offset:16
    v_and_b32 v7, -4, v26
    v_lshl_add_u32 v8, v26, 2, v7
    ds_write_b32 v8, v42
    v_lshl_add_u32 v7, v7, 2, v26
    ds_write_b8 v7, v85 offset:16
    v_and_b32 v9, -4, v27
    v_lshl_add_u32 v10, v27, 2, v9
    ds_write_b32 v10, v43
    v_lshl_add_u32 v9, v9, 2, v27
    ds_write_b8_d16_hi v9, v85 offset:16
    s_add_u32 s45, s35, 0x5488000
    s_add_u32 s45, s45, s85
    buffer_store_dwordx4 v[32:35], v0, s[20:23], s45 offen sc1
    s_add_u32 s46, s98, 0x8800000
    v_lshlrev_b32 v40, 1, v1
    buffer_load_dwordx4 v[40:43], v40, s[8:11], s46 offen nt
    s_add_u32 s47, s98, 0x8800000
    v_lshlrev_b32 v24, 1, v1
    buffer_load_dwordx4 v[24:27], v24, s[12:15], s47 offen nt
    v_and_b32 v7, -4, v52
    v_lshl_add_u32 v8, v52, 2, v7
    ds_write_b32 v8, v48
    v_lshl_add_u32 v7, v7, 2, v52
    ds_write_b8 v7, v86 offset:16
    v_and_b32 v9, -4, v53
    v_lshl_add_u32 v10, v53, 2, v9
    ds_write_b32 v10, v49
    v_lshl_add_u32 v9, v9, 2, v53
    ds_write_b8_d16_hi v9, v86 offset:16
    v_and_b32 v7, -4, v54
    v_lshl_add_u32 v8, v54, 2, v7
    ds_write_b32 v8, v50
    v_lshl_add_u32 v7, v7, 2, v54
    ds_write_b8 v7, v87 offset:16
    v_and_b32 v9, -4, v55
    v_lshl_add_u32 v10, v55, 2, v9
    ds_write_b32 v10, v51
    v_lshl_add_u32 v9, v9, 2, v55
    ds_write_b8_d16_hi v9, v87 offset:16
    s_add_u32 s44, s98, 0x8800000
    s_lshr_b32 s44, s44, 1
    buffer_load_dwordx2 v[32:33], v1, s[16:19], s44 offen nt
    s_add_u32 s45, s99, 0x8c00000
    s_lshr_b32 s45, s45, 1
    buffer_load_dwordx2 v[34:35], v1, s[16:19], s45 offen nt
    s_add_u32 s46, s99, 0x8c00000
    v_lshlrev_b32 v48, 1, v1
    buffer_load_dwordx4 v[48:51], v48, s[8:11], s46 offen nt
    s_setprio 2
    v_and_b32 v7, -4, v72
    v_lshl_add_u32 v8, v72, 2, v7
    ds_write_b32 v8, v68
    v_lshl_add_u32 v7, v7, 2, v72
    ds_write_b8 v7, v56 offset:16
    v_and_b32 v9, -4, v73
    v_lshl_add_u32 v10, v73, 2, v9
    ds_write_b32 v10, v69
    v_lshl_add_u32 v9, v9, 2, v73
    ds_write_b8_d16_hi v9, v56 offset:16
    v_and_b32 v7, -4, v74
    v_lshl_add_u32 v8, v74, 2, v7
    ds_write_b32 v8, v70
    v_lshl_add_u32 v7, v7, 2, v74
    ds_write_b8 v7, v57 offset:16
    v_and_b32 v9, -4, v75
    v_lshl_add_u32 v10, v75, 2, v9
    ds_write_b32 v10, v71
    v_lshl_add_u32 v9, v9, 2, v75
    ds_write_b8_d16_hi v9, v57 offset:16
    s_add_u32 s47, s35, 0x5488000
    s_add_u32 s47, s47, s91
    buffer_store_dwordx4 v[36:39], v0, s[20:23], s47 offen sc1
    s_add_u32 s44, s99, 0x8c00000
    v_lshlrev_b32 v52, 1, v1
    buffer_load_dwordx4 v[52:55], v52, s[12:15], s44 offen nt
    v_and_b32 v7, -4, v80
    v_lshl_add_u32 v8, v80, 2, v7
    ds_write_b32 v8, v76
    v_lshl_add_u32 v7, v7, 2, v80
    ds_write_b8 v7, v58 offset:16
    v_and_b32 v9, -4, v81
    v_lshl_add_u32 v10, v81, 2, v9
    ds_write_b32 v10, v77
    v_lshl_add_u32 v9, v9, 2, v81
    ds_write_b8_d16_hi v9, v58 offset:16
    v_and_b32 v7, -4, v82
    v_lshl_add_u32 v8, v82, 2, v7
    ds_write_b32 v8, v78
    v_lshl_add_u32 v7, v7, 2, v82
    ds_write_b8 v7, v59 offset:16
    v_and_b32 v9, -4, v83
    v_lshl_add_u32 v10, v83, 2, v9
    ds_write_b32 v10, v79
    v_lshl_add_u32 v9, v9, 2, v83
    ds_write_b8_d16_hi v9, v59 offset:16
    s_add_u32 s45, s96, 0x9000000
    v_lshlrev_b32 v84, 1, v1
    buffer_load_dwordx4 v[84:87], v84, s[8:11], s45 offen nt
    s_add_u32 s46, s96, 0x9000000
    v_lshlrev_b32 v68, 1, v1
    buffer_load_dwordx4 v[68:71], v68, s[12:15], s46 offen nt
    s_setprio 1
    v_and_b32 v7, -4, v96
    v_lshl_add_u32 v8, v96, 2, v7
    ds_write_b32 v8, v64
    v_lshl_add_u32 v7, v7, 2, v96
    ds_write_b8 v7, v104 offset:16
    v_and_b32 v9, -4, v97
    v_lshl_add_u32 v10, v97, 2, v9
    ds_write_b32 v10, v65
    v_lshl_add_u32 v9, v9, 2, v97
    ds_write_b8_d16_hi v9, v104 offset:16
    v_and_b32 v7, -4, v98
    v_lshl_add_u32 v8, v98, 2, v7
    ds_write_b32 v8, v66
    v_lshl_add_u32 v7, v7, 2, v98
    ds_write_b8 v7, v105 offset:16
    v_and_b32 v9, -4, v99
    v_lshl_add_u32 v10, v99, 2, v9
    ds_write_b32 v10, v67
    v_lshl_add_u32 v9, v9, 2, v99
    ds_write_b8_d16_hi v9, v105 offset:16
    s_add_u32 s47, s96, 0x9000000
    s_lshr_b32 s47, s47, 1
    buffer_load_dwordx2 v[72:73], v1, s[16:19], s47 offen nt
    s_cmp_le_u32 s43, 5
    s_cselect_b32 s18, 0, s18
    s_add_u32 s44, s59, 0x4a00000
    buffer_load_dwordx2 v[74:75], v1, s[16:19], s44 offen nt
    s_cmp_le_u32 s43, 5
    s_cselect_b32 s10, 0, s10
    s_add_u32 s45, s58, 0x9400000
    v_lshlrev_b32 v36, 1, v1
    buffer_load_dwordx4 v[36:39], v36, s[8:11], s45 offen nt
    v_and_b32 v7, -4, v100
    v_lshl_add_u32 v8, v100, 2, v7
    ds_write_b32 v8, v60
    v_lshl_add_u32 v7, v7, 2, v100
    ds_write_b8 v7, v106 offset:16
    v_and_b32 v9, -4, v101
    v_lshl_add_u32 v10, v101, 2, v9
    ds_write_b32 v10, v61
    v_lshl_add_u32 v9, v9, 2, v101
    ds_write_b8_d16_hi v9, v106 offset:16
    v_and_b32 v7, -4, v102
    v_lshl_add_u32 v8, v102, 2, v7
    ds_write_b32 v8, v62
    v_lshl_add_u32 v7, v7, 2, v102
    ds_write_b8 v7, v107 offset:16
    v_and_b32 v9, -4, v103
    v_lshl_add_u32 v10, v103, 2, v9
    ds_write_b32 v10, v63
    v_lshl_add_u32 v9, v9, 2, v103
    ds_write_b8_d16_hi v9, v107 offset:16
    s_add_u32 s46, s35, 0x5488000
    s_add_u32 s46, s46, s93
    buffer_store_dwordx4 v[28:31], v0, s[20:23], s46 offen sc1
    s_cmp_le_u32 s43, 5
    s_cselect_b32 s14, 0, s14
    s_add_u32 s47, s58, 0x9400000
    v_lshlrev_b32 v76, 1, v1
    buffer_load_dwordx4 v[76:79], v76, s[12:15], s47 offen nt
    s_setprio 0
    v_and_b32 v7, -4, v88
    v_lshl_add_u32 v8, v88, 2, v7
    ds_write_b32 v8, v112
    v_lshl_add_u32 v7, v7, 2, v88
    ds_write_b8 v7, v108 offset:16
    v_and_b32 v9, -4, v89
    v_lshl_add_u32 v10, v89, 2, v9
    ds_write_b32 v10, v113
    v_lshl_add_u32 v9, v9, 2, v89
    ds_write_b8_d16_hi v9, v108 offset:16
    v_and_b32 v7, -4, v90
    v_lshl_add_u32 v8, v90, 2, v7
    ds_write_b32 v8, v114
    v_lshl_add_u32 v7, v7, 2, v90
    ds_write_b8 v7, v109 offset:16
    v_and_b32 v9, -4, v91
    v_lshl_add_u32 v10, v91, 2, v9
    ds_write_b32 v10, v115
    v_lshl_add_u32 v9, v9, 2, v91
    ds_write_b8_d16_hi v9, v109 offset:16
    s_cmp_le_u32 s43, 6
    s_cselect_b32 s10, 0, s10
    s_add_u32 s44, s58, 0x97c0000
    v_lshlrev_b32 v80, 1, v1
    buffer_load_dwordx4 v[80:83], v80, s[8:11], s44 offen nt
    s_cmp_le_u32 s43, 6
    s_cselect_b32 s14, 0, s14
    s_add_u32 s45, s58, 0x97c0000
    v_lshlrev_b32 v56, 1, v1
    buffer_load_dwordx4 v[56:59], v56, s[12:15], s45 offen nt
    v_and_b32 v7, -4, v92
    v_lshl_add_u32 v8, v92, 2, v7
    ds_write_b32 v8, v116
    v_lshl_add_u32 v7, v7, 2, v92
    ds_write_b8 v7, v110 offset:16
    v_and_b32 v9, -4, v93
    v_lshl_add_u32 v10, v93, 2, v9
    ds_write_b32 v10, v117
    v_lshl_add_u32 v9, v9, 2, v93
    ds_write_b8_d16_hi v9, v110 offset:16
    v_and_b32 v7, -4, v94
    v_lshl_add_u32 v8, v94, 2, v7
    ds_write_b32 v8, v118
    v_lshl_add_u32 v7, v7, 2, v94
    ds_write_b8 v7, v111 offset:16
    v_and_b32 v9, -4, v95
    v_lshl_add_u32 v10, v95, 2, v9
    ds_write_b32 v10, v119
    v_lshl_add_u32 v9, v9, 2, v95
    ds_write_b8_d16_hi v9, v111 offset:16
    s_cmp_le_u32 s43, 6
    s_cselect_b32 s18, 0, s18
    s_add_u32 s46, s59, 0x4be0000
    buffer_load_dwordx2 v[64:65], v1, s[16:19], s46 offen nt
    s_cmp_le_u32 s43, 7
    s_cselect_b32 s18, 0, s18
    s_add_u32 s47, s59, 0x4d90000
    buffer_load_dwordx2 v[66:67], v1, s[16:19], s47 offen nt
    v_add_u32 v7, s72, v0
    v_add_u32 v12, s73, v0
    v_add_u32 v13, s85, v0
    v_add_u32 v14, s91, v0
    v_add_u32 v15, s93, v0
    s_min_i32 s3, s72, s73
    s_min_i32 s3, s3, s85
    s_min_i32 s3, s3, s91
    s_min_i32 s3, s3, s93
    v_add_u32 v3, s3, v0
    v_mov_b32 v8, 0
    v_mov_b32 v9, 0
    v_mov_b32 v10, 0
    v_mov_b32 v11, 0
    s_waitcnt lgkmcnt(0)
    s_barrier
    ds_read_b128 v[96:99], v7 offset:0
    ds_read_b128 v[60:63], v12 offset:0
    ds_read_b128 v[100:103], v13 offset:0
    ds_read_b128 v[104:107], v14 offset:0
    ds_read_b128 v[28:31], v15 offset:0
    ds_write_b128 v3, v[8:11]
    ds_read_b128 v[112:115], v7 offset:16384
    ds_read_b128 v[88:91], v12 offset:16384
    ds_read_b128 v[116:119], v13 offset:16384
    ds_read_b128 v[92:95], v14 offset:16384
    ds_read_b128 v[108:111], v15 offset:16384
    s_waitcnt lgkmcnt(0)
    s_barrier
    v_lshlrev_b32 v3, 3, v0
    v_and_b32 v3, 0x80, v3
    s_cmp_lg_u32 s32, 15
    s_cbranch_scc1 L2_k0
    s_mov_b64 exec, 3
    buffer_load_dword v3, v3, s[68:71], 0 offen sc1
    s_mov_b64 exec, -1
L2_k0:
    s_add_u32 s44, s35, 0x7ec4000
    s_add_u32 s44, s44, s72
    buffer_store_dwordx4 v[96:99], v0, s[20:23], s44 offen sc1
    s_cmp_le_u32 s43, 7
    s_cselect_b32 s10, 0, s10
    s_add_u32 s45, s58, 0x9b20000
    v_lshlrev_b32 v96, 1, v1
    buffer_load_dwordx4 v[96:99], v96, s[8:11], s45 offen nt
    s_add_u32 s46, s35, 0x7ec4000
    s_add_u32 s46, s46, s73
    buffer_store_dwordx4 v[60:63], v0, s[20:23], s46 offen sc1
    s_cmp_le_u32 s43, 7
    s_cselect_b32 s14, 0, s14
    s_add_u32 s47, s58, 0x9b20000
    v_lshlrev_b32 v60, 1, v1
    buffer_load_dwordx4 v[60:63], v60, s[12:15], s47 offen nt
    s_setprio 3
    s_waitcnt vmcnt(27)
    v_lshlrev_b32 v7, 16, v44
    v_and_b32 v8, 0xffff0000, v44
    v_lshlrev_b32 v9, 16, v45
    v_and_b32 v10, 0xffff0000, v45
    v_mul_f32 v7, 0.15915494, v7
    v_mul_f32 v8, 0.15915494, v8
    v_mul_f32 v9, 0.15915494, v9
    v_mul_f32 v10, 0.15915494, v10
    v_mul_hi_u32_u24 v14, 429497, v16
    v_lshrrev_b32 v12, 3, v120
    v_cos_f32 v7, v7
    v_lshlrev_b16 v13, 3, v120
    v_mad_i32_i24 v11, v14, s55, v16
    v_bitop3_b32 v12, v6, v13, v12 bitop3:0xca
    v_lshl_add_u32 v11, v11, 17, s40
    v_lshlrev_b16 v14, 8, v14
    v_lshrrev_b32 v13, 2, v120
    v_add_u32 v16, v12, v11
    v_bitop3_b32 v120, v5, v13, v14 bitop3:0xea
    ds_add_u32 v120, v2
    v_mul_hi_u32_u24 v14, 429497, v17
    v_lshrrev_b32 v12, 3, v121
    v_cos_f32 v8, v8
    v_lshlrev_b16 v13, 3, v121
    v_mad_i32_i24 v11, v14, s55, v17
    v_bitop3_b32 v12, v6, v13, v12 bitop3:0xca
    v_lshl_add_u32 v11, v11, 17, s40
    v_lshlrev_b16 v14, 8, v14
    v_lshrrev_b32 v13, 2, v121
    v_add_u32 v17, v12, v11
    v_bitop3_b32 v121, v5, v13, v14 bitop3:0xea
    ds_add_u32 v121, v2
    v_cvt_pk_bf16_f32 v44, v7, v8
    v_perm_b32 v12, v44, v44, s41
    v_bitop3_b32 v16, v4, v12, v16 bitop3:0xca
    v_perm_b32 v13, v44, v44, s42
    v_bitop3_b32 v17, v4, v13, v17 bitop3:0xca
    v_mul_hi_u32_u24 v14, 429497, v18
    v_lshrrev_b32 v12, 3, v122
    v_cos_f32 v9, v9
    v_lshlrev_b16 v13, 3, v122
    v_mad_i32_i24 v11, v14, s55, v18
    v_bitop3_b32 v12, v6, v13, v12 bitop3:0xca
    v_lshl_add_u32 v11, v11, 17, s40
    v_lshlrev_b16 v14, 8, v14
    v_lshrrev_b32 v13, 2, v122
    v_add_u32 v18, v12, v11
    v_bitop3_b32 v122, v5, v13, v14 bitop3:0xea
    ds_add_u32 v122, v2
    v_mul_hi_u32_u24 v14, 429497, v19
    v_lshrrev_b32 v12, 3, v123
    v_cos_f32 v10, v10
    v_lshlrev_b16 v13, 3, v123
    v_mad_i32_i24 v11, v14, s55, v19
    v_bitop3_b32 v12, v6, v13, v12 bitop3:0xca
    v_lshl_add_u32 v11, v11, 17, s40
    v_lshlrev_b16 v14, 8, v14
    v_lshrrev_b32 v13, 2, v123
    v_add_u32 v19, v12, v11
    v_bitop3_b32 v123, v5, v13, v14 bitop3:0xea
    ds_add_u32 v123, v2
    v_cvt_pk_bf16_f32 v45, v9, v10
    v_perm_b32 v12, v45, v45, s41
    v_bitop3_b32 v18, v4, v12, v18 bitop3:0xca
    v_perm_b32 v13, v45, v45, s42
    v_bitop3_b32 v19, v4, v13, v19 bitop3:0xca
    s_waitcnt vmcnt(23)
    v_lshlrev_b32 v7, 16, v46
    v_and_b32 v8, 0xffff0000, v46
    v_lshlrev_b32 v9, 16, v47
    v_and_b32 v10, 0xffff0000, v47
    v_mul_f32 v7, 0.15915494, v7
    v_mul_f32 v8, 0.15915494, v8
    v_mul_f32 v9, 0.15915494, v9
    v_mul_f32 v10, 0.15915494, v10
    v_mul_hi_u32_u24 v14, 429497, v20
    v_lshrrev_b32 v12, 3, v124
    v_cos_f32 v7, v7
    v_lshlrev_b16 v13, 3, v124
    v_mad_i32_i24 v11, v14, s55, v20
    v_bitop3_b32 v12, v6, v13, v12 bitop3:0xca
    v_lshl_add_u32 v11, v11, 17, s40
    v_lshlrev_b16 v14, 8, v14
    v_lshrrev_b32 v13, 2, v124
    v_add_u32 v20, v12, v11
    v_bitop3_b32 v124, v5, v13, v14 bitop3:0xea
    ds_add_u32 v124, v2
    v_mul_hi_u32_u24 v14, 429497, v21
    v_lshrrev_b32 v12, 3, v125
    v_cos_f32 v8, v8
    v_lshlrev_b16 v13, 3, v125
    v_mad_i32_i24 v11, v14, s55, v21
    v_bitop3_b32 v12, v6, v13, v12 bitop3:0xca
    v_lshl_add_u32 v11, v11, 17, s40
    v_lshlrev_b16 v14, 8, v14
    v_lshrrev_b32 v13, 2, v125
    v_add_u32 v21, v12, v11
    v_bitop3_b32 v125, v5, v13, v14 bitop3:0xea
    ds_add_u32 v125, v2
    v_cvt_pk_bf16_f32 v46, v7, v8
    v_perm_b32 v12, v46, v46, s41
    v_bitop3_b32 v20, v4, v12, v20 bitop3:0xca
    v_perm_b32 v13, v46, v46, s42
    v_bitop3_b32 v21, v4, v13, v21 bitop3:0xca
    v_mul_hi_u32_u24 v14, 429497, v22
    v_lshrrev_b32 v12, 3, v126
    v_cos_f32 v9, v9
    v_lshlrev_b16 v13, 3, v126
    v_mad_i32_i24 v11, v14, s55, v22
    v_bitop3_b32 v12, v6, v13, v12 bitop3:0xca
    v_lshl_add_u32 v11, v11, 17, s40
    v_lshlrev_b16 v14, 8, v14
    v_lshrrev_b32 v13, 2, v126
    v_add_u32 v22, v12, v11
    v_bitop3_b32 v126, v5, v13, v14 bitop3:0xea
    ds_add_u32 v126, v2
    v_mul_hi_u32_u24 v14, 429497, v23
    v_lshrrev_b32 v12, 3, v127
    v_cos_f32 v10, v10
    v_lshlrev_b16 v13, 3, v127
    v_mad_i32_i24 v11, v14, s55, v23
    v_bitop3_b32 v12, v6, v13, v12 bitop3:0xca
    v_lshl_add_u32 v11, v11, 17, s40
    v_lshlrev_b16 v14, 8, v14
    v_lshrrev_b32 v13, 2, v127
    v_add_u32 v23, v12, v11
    v_bitop3_b32 v127, v5, v13, v14 bitop3:0xea
    ds_add_u32 v127, v2
    v_cvt_pk_bf16_f32 v47, v9, v10
    v_perm_b32 v12, v47, v47, s41
    v_bitop3_b32 v22, v4, v12, v22 bitop3:0xca
    v_perm_b32 v13, v47, v47, s42
    v_bitop3_b32 v23, v4, v13, v23 bitop3:0xca
    s_setprio 2
    s_add_u32 s44, s35, 0x7ec4000
    s_add_u32 s44, s44, s85
    buffer_store_dwordx4 v[100:103], v0, s[20:23], s44 offen sc1
    s_waitcnt vmcnt(19)
    v_lshlrev_b32 v7, 16, v32
    v_and_b32 v8, 0xffff0000, v32
    v_lshlrev_b32 v9, 16, v33
    v_and_b32 v10, 0xffff0000, v33
    v_mul_f32 v7, 0.15915494, v7
    v_mul_f32 v8, 0.15915494, v8
    v_mul_f32 v9, 0.15915494, v9
    v_mul_f32 v10, 0.15915494, v10
    v_mul_hi_u32_u24 v14, 429497, v40
    v_lshrrev_b32 v12, 3, v24
    v_cos_f32 v7, v7
    v_lshlrev_b16 v13, 3, v24
    v_mad_i32_i24 v11, v14, s55, v40
    v_bitop3_b32 v12, v6, v13, v12 bitop3:0xca
    v_lshl_add_u32 v11, v11, 17, s40
    v_lshlrev_b16 v14, 8, v14
    v_lshrrev_b32 v13, 2, v24
    v_add_u32 v40, v12, v11
    v_bitop3_b32 v24, v5, v13, v14 bitop3:0xea
    ds_add_u32 v24, v2
    v_mul_hi_u32_u24 v14, 429497, v41
    v_lshrrev_b32 v12, 3, v25
    v_cos_f32 v8, v8
    v_lshlrev_b16 v13, 3, v25
    v_mad_i32_i24 v11, v14, s55, v41
    v_bitop3_b32 v12, v6, v13, v12 bitop3:0xca
    v_lshl_add_u32 v11, v11, 17, s40
    v_lshlrev_b16 v14, 8, v14
    v_lshrrev_b32 v13, 2, v25
    v_add_u32 v41, v12, v11
    v_bitop3_b32 v25, v5, v13, v14 bitop3:0xea
    ds_add_u32 v25, v2
    v_cvt_pk_bf16_f32 v32, v7, v8
    v_perm_b32 v12, v32, v32, s41
    v_bitop3_b32 v40, v4, v12, v40 bitop3:0xca
    v_perm_b32 v13, v32, v32, s42
    v_bitop3_b32 v41, v4, v13, v41 bitop3:0xca
    v_mul_hi_u32_u24 v14, 429497, v42
    v_lshrrev_b32 v12, 3, v26
    v_cos_f32 v9, v9
    v_lshlrev_b16 v13, 3, v26
    v_mad_i32_i24 v11, v14, s55, v42
    v_bitop3_b32 v12, v6, v13, v12 bitop3:0xca
    v_lshl_add_u32 v11, v11, 17, s40
    v_lshlrev_b16 v14, 8, v14
    v_lshrrev_b32 v13, 2, v26
    v_add_u32 v42, v12, v11
    v_bitop3_b32 v26, v5, v13, v14 bitop3:0xea
    ds_add_u32 v26, v2
    v_mul_hi_u32_u24 v14, 429497, v43
    v_lshrrev_b32 v12, 3, v27
    v_cos_f32 v10, v10
    v_lshlrev_b16 v13, 3, v27
    v_mad_i32_i24 v11, v14, s55, v43
    v_bitop3_b32 v12, v6, v13, v12 bitop3:0xca
    v_lshl_add_u32 v11, v11, 17, s40
    v_lshlrev_b16 v14, 8, v14
    v_lshrrev_b32 v13, 2, v27
    v_add_u32 v43, v12, v11
    v_bitop3_b32 v27, v5, v13, v14 bitop3:0xea
    ds_add_u32 v27, v2
    v_cvt_pk_bf16_f32 v33, v9, v10
    v_perm_b32 v12, v33, v33, s41
    v_bitop3_b32 v42, v4, v12, v42 bitop3:0xca
    v_perm_b32 v13, v33, v33, s42
    v_bitop3_b32 v43, v4, v13, v43 bitop3:0xca
    s_waitcnt vmcnt(16)
    v_lshlrev_b32 v7, 16, v34
    v_and_b32 v8, 0xffff0000, v34
    v_lshlrev_b32 v9, 16, v35
    v_and_b32 v10, 0xffff0000, v35
    v_mul_f32 v7, 0.15915494, v7
    v_mul_f32 v8, 0.15915494, v8
    v_mul_f32 v9, 0.15915494, v9
    v_mul_f32 v10, 0.15915494, v10
    v_mul_hi_u32_u24 v14, 429497, v48
    v_lshrrev_b32 v12, 3, v52
    v_cos_f32 v7, v7
    v_lshlrev_b16 v13, 3, v52
    v_mad_i32_i24 v11, v14, s55, v48
    v_bitop3_b32 v12, v6, v13, v12 bitop3:0xca
    v_lshl_add_u32 v11, v11, 17, s40
    v_lshlrev_b16 v14, 8, v14
    v_lshrrev_b32 v13, 2, v52
    v_add_u32 v48, v12, v11
    v_bitop3_b32 v52, v5, v13, v14 bitop3:0xea
    ds_add_u32 v52, v2
    v_mul_hi_u32_u24 v14, 429497, v49
    v_lshrrev_b32 v12, 3, v53
    v_cos_f32 v8, v8
    v_lshlrev_b16 v13, 3, v53
    v_mad_i32_i24 v11, v14, s55, v49
    v_bitop3_b32 v12, v6, v13, v12 bitop3:0xca
    v_lshl_add_u32 v11, v11, 17, s40
    v_lshlrev_b16 v14, 8, v14
    v_lshrrev_b32 v13, 2, v53
    v_add_u32 v49, v12, v11
    v_bitop3_b32 v53, v5, v13, v14 bitop3:0xea
    ds_add_u32 v53, v2
    v_cvt_pk_bf16_f32 v34, v7, v8
    v_perm_b32 v12, v34, v34, s41
    v_bitop3_b32 v48, v4, v12, v48 bitop3:0xca
    v_perm_b32 v13, v34, v34, s42
    v_bitop3_b32 v49, v4, v13, v49 bitop3:0xca
    v_mul_hi_u32_u24 v14, 429497, v50
    v_lshrrev_b32 v12, 3, v54
    v_cos_f32 v9, v9
    v_lshlrev_b16 v13, 3, v54
    v_mad_i32_i24 v11, v14, s55, v50
    v_bitop3_b32 v12, v6, v13, v12 bitop3:0xca
    v_lshl_add_u32 v11, v11, 17, s40
    v_lshlrev_b16 v14, 8, v14
    v_lshrrev_b32 v13, 2, v54
    v_add_u32 v50, v12, v11
    v_bitop3_b32 v54, v5, v13, v14 bitop3:0xea
    ds_add_u32 v54, v2
    v_mul_hi_u32_u24 v14, 429497, v51
    v_lshrrev_b32 v12, 3, v55
    v_cos_f32 v10, v10
    v_lshlrev_b16 v13, 3, v55
    v_mad_i32_i24 v11, v14, s55, v51
    v_bitop3_b32 v12, v6, v13, v12 bitop3:0xca
    v_lshl_add_u32 v11, v11, 17, s40
    v_lshlrev_b16 v14, 8, v14
    v_lshrrev_b32 v13, 2, v55
    v_add_u32 v51, v12, v11
    v_bitop3_b32 v55, v5, v13, v14 bitop3:0xea
    ds_add_u32 v55, v2
    v_cvt_pk_bf16_f32 v35, v9, v10
    v_perm_b32 v12, v35, v35, s41
    v_bitop3_b32 v50, v4, v12, v50 bitop3:0xca
    v_perm_b32 v13, v35, v35, s42
    v_bitop3_b32 v51, v4, v13, v51 bitop3:0xca
    s_setprio 1
    s_waitcnt vmcnt(12)
    v_lshlrev_b32 v7, 16, v72
    v_and_b32 v8, 0xffff0000, v72
    v_lshlrev_b32 v9, 16, v73
    v_and_b32 v10, 0xffff0000, v73
    v_mul_f32 v7, 0.15915494, v7
    v_mul_f32 v8, 0.15915494, v8
    v_mul_f32 v9, 0.15915494, v9
    v_mul_f32 v10, 0.15915494, v10
    v_mul_hi_u32_u24 v14, 429497, v84
    v_lshrrev_b32 v12, 3, v68
    v_cos_f32 v7, v7
    v_lshlrev_b16 v13, 3, v68
    v_mad_i32_i24 v11, v14, s55, v84
    v_bitop3_b32 v12, v6, v13, v12 bitop3:0xca
    v_lshl_add_u32 v11, v11, 17, s40
    v_lshlrev_b16 v14, 8, v14
    v_lshrrev_b32 v13, 2, v68
    v_add_u32 v84, v12, v11
    v_bitop3_b32 v68, v5, v13, v14 bitop3:0xea
    ds_add_u32 v68, v2
    v_mul_hi_u32_u24 v14, 429497, v85
    v_lshrrev_b32 v12, 3, v69
    v_cos_f32 v8, v8
    v_lshlrev_b16 v13, 3, v69
    v_mad_i32_i24 v11, v14, s55, v85
    v_bitop3_b32 v12, v6, v13, v12 bitop3:0xca
    v_lshl_add_u32 v11, v11, 17, s40
    v_lshlrev_b16 v14, 8, v14
    v_lshrrev_b32 v13, 2, v69
    v_add_u32 v85, v12, v11
    v_bitop3_b32 v69, v5, v13, v14 bitop3:0xea
    ds_add_u32 v69, v2
    v_cvt_pk_bf16_f32 v72, v7, v8
    v_perm_b32 v12, v72, v72, s41
    v_bitop3_b32 v84, v4, v12, v84 bitop3:0xca
    v_perm_b32 v13, v72, v72, s42
    v_bitop3_b32 v85, v4, v13, v85 bitop3:0xca
    v_mul_hi_u32_u24 v14, 429497, v86
    v_lshrrev_b32 v12, 3, v70
    v_cos_f32 v9, v9
    v_lshlrev_b16 v13, 3, v70
    v_mad_i32_i24 v11, v14, s55, v86
    v_bitop3_b32 v12, v6, v13, v12 bitop3:0xca
    v_lshl_add_u32 v11, v11, 17, s40
    v_lshlrev_b16 v14, 8, v14
    v_lshrrev_b32 v13, 2, v70
    v_add_u32 v86, v12, v11
    v_bitop3_b32 v70, v5, v13, v14 bitop3:0xea
    ds_add_u32 v70, v2
    v_mul_hi_u32_u24 v14, 429497, v87
    v_lshrrev_b32 v12, 3, v71
    v_cos_f32 v10, v10
    v_lshlrev_b16 v13, 3, v71
    v_mad_i32_i24 v11, v14, s55, v87
    v_bitop3_b32 v12, v6, v13, v12 bitop3:0xca
    v_lshl_add_u32 v11, v11, 17, s40
    v_lshlrev_b16 v14, 8, v14
    v_lshrrev_b32 v13, 2, v71
    v_add_u32 v87, v12, v11
    v_bitop3_b32 v71, v5, v13, v14 bitop3:0xea
    ds_add_u32 v71, v2
    v_cvt_pk_bf16_f32 v73, v9, v10
    v_perm_b32 v12, v73, v73, s41
    v_bitop3_b32 v86, v4, v12, v86 bitop3:0xca
    v_perm_b32 v13, v73, v73, s42
    v_bitop3_b32 v87, v4, v13, v87 bitop3:0xca
    s_add_u32 s45, s35, 0x7ec4000
    s_add_u32 s45, s45, s91
    buffer_store_dwordx4 v[104:107], v0, s[20:23], s45 offen sc1
    s_waitcnt vmcnt(10)
    s_cmp_le_u32 s43, 5
    s_cbranch_scc1 L1_s5
    v_lshlrev_b32 v7, 16, v74
    v_and_b32 v8, 0xffff0000, v74
    v_lshlrev_b32 v9, 16, v75
    v_and_b32 v10, 0xffff0000, v75
    v_mul_f32 v7, 0.15915494, v7
    v_mul_f32 v8, 0.15915494, v8
    v_mul_f32 v9, 0.15915494, v9
    v_mul_f32 v10, 0.15915494, v10
    v_mul_hi_u32_u24 v14, 429497, v36
    v_lshrrev_b32 v12, 3, v76
    v_cos_f32 v7, v7
    v_lshlrev_b16 v13, 3, v76
    v_mad_i32_i24 v11, v14, s55, v36
    v_bitop3_b32 v12, v6, v13, v12 bitop3:0xca
    v_lshl_add_u32 v11, v11, 17, s40
    v_lshlrev_b16 v14, 8, v14
    v_lshrrev_b32 v13, 2, v76
    v_add_u32 v36, v12, v11
    v_bitop3_b32 v76, v5, v13, v14 bitop3:0xea
    ds_add_u32 v76, v2
    v_mul_hi_u32_u24 v14, 429497, v37
    v_lshrrev_b32 v12, 3, v77
    v_cos_f32 v8, v8
    v_lshlrev_b16 v13, 3, v77
    v_mad_i32_i24 v11, v14, s55, v37
    v_bitop3_b32 v12, v6, v13, v12 bitop3:0xca
    v_lshl_add_u32 v11, v11, 17, s40
    v_lshlrev_b16 v14, 8, v14
    v_lshrrev_b32 v13, 2, v77
    v_add_u32 v37, v12, v11
    v_bitop3_b32 v77, v5, v13, v14 bitop3:0xea
    ds_add_u32 v77, v2
    v_cvt_pk_bf16_f32 v74, v7, v8
    v_perm_b32 v12, v74, v74, s41
    v_bitop3_b32 v36, v4, v12, v36 bitop3:0xca
    v_perm_b32 v13, v74, v74, s42
    v_bitop3_b32 v37, v4, v13, v37 bitop3:0xca
    v_mul_hi_u32_u24 v14, 429497, v38
    v_lshrrev_b32 v12, 3, v78
    v_cos_f32 v9, v9
    v_lshlrev_b16 v13, 3, v78
    v_mad_i32_i24 v11, v14, s55, v38
    v_bitop3_b32 v12, v6, v13, v12 bitop3:0xca
    v_lshl_add_u32 v11, v11, 17, s40
    v_lshlrev_b16 v14, 8, v14
    v_lshrrev_b32 v13, 2, v78
    v_add_u32 v38, v12, v11
    v_bitop3_b32 v78, v5, v13, v14 bitop3:0xea
    ds_add_u32 v78, v2
    v_mul_hi_u32_u24 v14, 429497, v39
    v_lshrrev_b32 v12, 3, v79
    v_cos_f32 v10, v10
    v_lshlrev_b16 v13, 3, v79
    v_mad_i32_i24 v11, v14, s55, v39
    v_bitop3_b32 v12, v6, v13, v12 bitop3:0xca
    v_lshl_add_u32 v11, v11, 17, s40
    v_lshlrev_b16 v14, 8, v14
    v_lshrrev_b32 v13, 2, v79
    v_add_u32 v39, v12, v11
    v_bitop3_b32 v79, v5, v13, v14 bitop3:0xea
    ds_add_u32 v79, v2
    v_cvt_pk_bf16_f32 v75, v9, v10
    v_perm_b32 v12, v75, v75, s41
    v_bitop3_b32 v38, v4, v12, v38 bitop3:0xca
    v_perm_b32 v13, v75, v75, s42
    v_bitop3_b32 v39, v4, v13, v39 bitop3:0xca
L1_s5:
    s_setprio 0
    s_waitcnt vmcnt(6)
    s_cmp_le_u32 s43, 6
    s_cbranch_scc1 L1_s6
    v_lshlrev_b32 v7, 16, v64
    v_and_b32 v8, 0xffff0000, v64
    v_lshlrev_b32 v9, 16, v65
    v_and_b32 v10, 0xffff0000, v65
    v_mul_f32 v7, 0.15915494, v7
    v_mul_f32 v8, 0.15915494, v8
    v_mul_f32 v9, 0.15915494, v9
    v_mul_f32 v10, 0.15915494, v10
    v_mul_hi_u32_u24 v14, 429497, v80
    v_lshrrev_b32 v12, 3, v56
    v_cos_f32 v7, v7
    v_lshlrev_b16 v13, 3, v56
    v_mad_i32_i24 v11, v14, s55, v80
    v_bitop3_b32 v12, v6, v13, v12 bitop3:0xca
    v_lshl_add_u32 v11, v11, 17, s40
    v_lshlrev_b16 v14, 8, v14
    v_lshrrev_b32 v13, 2, v56
    v_add_u32 v80, v12, v11
    v_bitop3_b32 v56, v5, v13, v14 bitop3:0xea
    ds_add_u32 v56, v2
    v_mul_hi_u32_u24 v14, 429497, v81
    v_lshrrev_b32 v12, 3, v57
    v_cos_f32 v8, v8
    v_lshlrev_b16 v13, 3, v57
    v_mad_i32_i24 v11, v14, s55, v81
    v_bitop3_b32 v12, v6, v13, v12 bitop3:0xca
    v_lshl_add_u32 v11, v11, 17, s40
    v_lshlrev_b16 v14, 8, v14
    v_lshrrev_b32 v13, 2, v57
    v_add_u32 v81, v12, v11
    v_bitop3_b32 v57, v5, v13, v14 bitop3:0xea
    ds_add_u32 v57, v2
    v_cvt_pk_bf16_f32 v64, v7, v8
    v_perm_b32 v12, v64, v64, s41
    v_bitop3_b32 v80, v4, v12, v80 bitop3:0xca
    v_perm_b32 v13, v64, v64, s42
    v_bitop3_b32 v81, v4, v13, v81 bitop3:0xca
    v_mul_hi_u32_u24 v14, 429497, v82
    v_lshrrev_b32 v12, 3, v58
    v_cos_f32 v9, v9
    v_lshlrev_b16 v13, 3, v58
    v_mad_i32_i24 v11, v14, s55, v82
    v_bitop3_b32 v12, v6, v13, v12 bitop3:0xca
    v_lshl_add_u32 v11, v11, 17, s40
    v_lshlrev_b16 v14, 8, v14
    v_lshrrev_b32 v13, 2, v58
    v_add_u32 v82, v12, v11
    v_bitop3_b32 v58, v5, v13, v14 bitop3:0xea
    ds_add_u32 v58, v2
    v_mul_hi_u32_u24 v14, 429497, v83
    v_lshrrev_b32 v12, 3, v59
    v_cos_f32 v10, v10
    v_lshlrev_b16 v13, 3, v59
    v_mad_i32_i24 v11, v14, s55, v83
    v_bitop3_b32 v12, v6, v13, v12 bitop3:0xca
    v_lshl_add_u32 v11, v11, 17, s40
    v_lshlrev_b16 v14, 8, v14
    v_lshrrev_b32 v13, 2, v59
    v_add_u32 v83, v12, v11
    v_bitop3_b32 v59, v5, v13, v14 bitop3:0xea
    ds_add_u32 v59, v2
    v_cvt_pk_bf16_f32 v65, v9, v10
    v_perm_b32 v12, v65, v65, s41
    v_bitop3_b32 v82, v4, v12, v82 bitop3:0xca
    v_perm_b32 v13, v65, v65, s42
    v_bitop3_b32 v83, v4, v13, v83 bitop3:0xca
L1_s6:
    s_waitcnt vmcnt(2)
    s_cmp_le_u32 s43, 7
    s_cbranch_scc1 L1_s7
    v_lshlrev_b32 v7, 16, v66
    v_and_b32 v8, 0xffff0000, v66
    v_lshlrev_b32 v9, 16, v67
    v_and_b32 v10, 0xffff0000, v67
    v_mul_f32 v7, 0.15915494, v7
    v_mul_f32 v8, 0.15915494, v8
    v_mul_f32 v9, 0.15915494, v9
    v_mul_f32 v10, 0.15915494, v10
    v_mul_hi_u32_u24 v14, 429497, v96
    v_lshrrev_b32 v12, 3, v60
    v_cos_f32 v7, v7
    v_lshlrev_b16 v13, 3, v60
    v_mad_i32_i24 v11, v14, s55, v96
    v_bitop3_b32 v12, v6, v13, v12 bitop3:0xca
    v_lshl_add_u32 v11, v11, 17, s40
    v_lshlrev_b16 v14, 8, v14
    v_lshrrev_b32 v13, 2, v60
    v_add_u32 v96, v12, v11
    v_bitop3_b32 v60, v5, v13, v14 bitop3:0xea
    ds_add_u32 v60, v2
    v_mul_hi_u32_u24 v14, 429497, v97
    v_lshrrev_b32 v12, 3, v61
    v_cos_f32 v8, v8
    v_lshlrev_b16 v13, 3, v61
    v_mad_i32_i24 v11, v14, s55, v97
    v_bitop3_b32 v12, v6, v13, v12 bitop3:0xca
    v_lshl_add_u32 v11, v11, 17, s40
    v_lshlrev_b16 v14, 8, v14
    v_lshrrev_b32 v13, 2, v61
    v_add_u32 v97, v12, v11
    v_bitop3_b32 v61, v5, v13, v14 bitop3:0xea
    ds_add_u32 v61, v2
    v_cvt_pk_bf16_f32 v66, v7, v8
    v_perm_b32 v12, v66, v66, s41
    v_bitop3_b32 v96, v4, v12, v96 bitop3:0xca
    v_perm_b32 v13, v66, v66, s42
    v_bitop3_b32 v97, v4, v13, v97 bitop3:0xca
    v_mul_hi_u32_u24 v14, 429497, v98
    v_lshrrev_b32 v12, 3, v62
    v_cos_f32 v9, v9
    v_lshlrev_b16 v13, 3, v62
    v_mad_i32_i24 v11, v14, s55, v98
    v_bitop3_b32 v12, v6, v13, v12 bitop3:0xca
    v_lshl_add_u32 v11, v11, 17, s40
    v_lshlrev_b16 v14, 8, v14
    v_lshrrev_b32 v13, 2, v62
    v_add_u32 v98, v12, v11
    v_bitop3_b32 v62, v5, v13, v14 bitop3:0xea
    ds_add_u32 v62, v2
    v_mul_hi_u32_u24 v14, 429497, v99
    v_lshrrev_b32 v12, 3, v63
    v_cos_f32 v10, v10
    v_lshlrev_b16 v13, 3, v63
    v_mad_i32_i24 v11, v14, s55, v99
    v_bitop3_b32 v12, v6, v13, v12 bitop3:0xca
    v_lshl_add_u32 v11, v11, 17, s40
    v_lshlrev_b16 v14, 8, v14
    v_lshrrev_b32 v13, 2, v63
    v_add_u32 v99, v12, v11
    v_bitop3_b32 v63, v5, v13, v14 bitop3:0xea
    ds_add_u32 v63, v2
    v_cvt_pk_bf16_f32 v67, v9, v10
    v_perm_b32 v12, v67, v67, s41
    v_bitop3_b32 v98, v4, v12, v98 bitop3:0xca
    v_perm_b32 v13, v67, v67, s42
    v_bitop3_b32 v99, v4, v13, v99 bitop3:0xca
L1_s7:
    v_lshrrev_b32 v8, 2, v0
    v_and_b32 v7, 0x3c00, v0
    v_bitop3_b32 v7, v5, v8, v7 bitop3:0xea
    s_waitcnt lgkmcnt(0)
    s_barrier
    ds_read2st64_b32 v[8:9], v7 offset0:0 offset1:1
    ds_read2st64_b32 v[10:11], v7 offset0:2 offset1:3
    s_add_u32 s46, s35, 0x7ec4000
    s_add_u32 s46, s46, s93
    buffer_store_dwordx4 v[28:31], v0, s[20:23], s46 offen sc1
    s_waitcnt lgkmcnt(0)
    v_lshl_or_b32 v12, v9, 16, v8
    v_lshl_or_b32 v13, v11, 16, v10
    v_mov_b32 v14, v12
    v_mov_b32 v15, v13
    s_nop 0
    v_add_u32_dpp v14, v14, v14 row_shr:1 row_mask:0xf bank_mask:0xf bound_ctrl:1
    v_add_u32_dpp v15, v15, v15 row_shr:1 row_mask:0xf bank_mask:0xf bound_ctrl:1
    s_nop 0
    v_add_u32_dpp v14, v14, v14 row_shr:2 row_mask:0xf bank_mask:0xf bound_ctrl:1
    v_add_u32_dpp v15, v15, v15 row_shr:2 row_mask:0xf bank_mask:0xf bound_ctrl:1
    s_nop 0
    v_add_u32_dpp v14, v14, v14 row_shr:4 row_mask:0xf bank_mask:0xf bound_ctrl:1
    v_add_u32_dpp v15, v15, v15 row_shr:4 row_mask:0xf bank_mask:0xf bound_ctrl:1
    s_nop 0
    v_add_u32_dpp v14, v14, v14 row_shr:8 row_mask:0xf bank_mask:0xf bound_ctrl:1
    v_add_u32_dpp v15, v15, v15 row_shr:8 row_mask:0xf bank_mask:0xf bound_ctrl:1
    s_nop 0
    v_add_u32_dpp v14, v14, v14 row_bcast:15 row_mask:0xa bank_mask:0xf
    v_add_u32_dpp v15, v15, v15 row_bcast:15 row_mask:0xa bank_mask:0xf
    s_nop 0
    v_add_u32_dpp v14, v14, v14 row_bcast:31 row_mask:0xc bank_mask:0xf
    v_add_u32_dpp v15, v15, v15 row_bcast:31 row_mask:0xc bank_mask:0xf
    v_readlane_b32 s48, v14, 63
    v_readlane_b32 s49, v15, 63
    s_lshl_b32 s54, s32, 2
    v_mov_b32 v8, s54
    s_and_b32 s50, s48, 0xffff
    s_lshr_b32 s51, s48, 16
    s_and_b32 s52, s49, 0xffff
    s_lshr_b32 s53, s49, 16
    s_add_u32 s51, s51, s50
    s_add_u32 s52, s52, s51
    s_add_u32 s53, s53, s52
    v_mov_b32 v9, s53
    v_and_b32_dpp v3, v3, v3 quad_perm:[1,0,3,2] row_mask:0xf bank_mask:0xf
    s_mov_b64 exec, 1
    ds_write_b32 v8, v9 offset:16384
    ds_write_b32 v8, v3 offset:16448
    s_mov_b64 exec, -1
    v_and_b32 v8, 60, v7
    s_waitcnt lgkmcnt(0)
    s_barrier
    ds_read_b32 v9, v8 offset:16384
    ds_read_b32 v10, v8 offset:16448
    s_waitcnt lgkmcnt(0)
    v_readlane_b32 s56, v10, 15
    s_xor_b32 s56, s56, 0x80
    v_add_u32_dpp v9, v9, v9 row_shr:1 row_mask:0xf bank_mask:0xf bound_ctrl:1
    s_nop 1
    v_add_u32_dpp v9, v9, v9 row_shr:2 row_mask:0xf bank_mask:0xf bound_ctrl:1
    s_nop 1
    v_add_u32_dpp v9, v9, v9 row_shr:4 row_mask:0xf bank_mask:0xf bound_ctrl:1
    s_nop 1
    v_add_u32_dpp v9, v9, v9 row_shr:8 row_mask:0xf bank_mask:0xf bound_ctrl:1
    s_nop 0
    v_readlane_b32 s54, v9, s32
    s_sub_u32 s54, s54, s53
    s_add_u32 s50, s50, s54
    s_add_u32 s51, s51, s54
    s_add_u32 s52, s52, s54
    s_pack_ll_b32_b16 s48, s54, s50
    s_pack_ll_b32_b16 s49, s51, s52
    v_add_u32 v14, s48, v14
    v_add_u32 v15, s49, v15
    v_sub_u32 v12, v14, v12
    v_sub_u32 v13, v15, v13
    v_and_b32 v8, 0xffff, v12
    v_lshrrev_b32 v9, 16, v12
    v_and_b32 v10, 0xffff, v13
    v_lshrrev_b32 v11, 16, v13
    ds_write2st64_b32 v7, v8, v9 offset0:0 offset1:1
    ds_write2st64_b32 v7, v10, v11 offset0:2 offset1:3
    v_and_b32 v8, 0x3f0, v0
    v_lshl_add_u32 v8, v8, 1, s36
    ds_write_b64 v8, v[12:13] offset:20480
    s_bitset0_b64 exec, 63
    s_not_b64 exec, exec
    ds_write_b64 v8, v[14:15] offset:20512
    s_mov_b64 exec, -1
    s_waitcnt lgkmcnt(0)
    s_barrier
    s_setprio 3
    ds_add_rtn_u32 v120, v120, v2
    ds_add_rtn_u32 v121, v121, v2
    ds_add_rtn_u32 v122, v122, v2
    ds_add_rtn_u32 v123, v123, v2
    ds_read_b128 v[12:15], v0 offset:20480
    v_cmp_gt_u32 vcc, 8448, v0
    ds_add_rtn_u32 v124, v124, v2
    ds_add_rtn_u32 v125, v125, v2
    ds_add_rtn_u32 v126, v126, v2
    ds_add_rtn_u32 v127, v127, v2
    s_setprio 2
    ds_add_rtn_u32 v24, v24, v2
    ds_add_rtn_u32 v25, v25, v2
    ds_add_rtn_u32 v26, v26, v2
    ds_add_rtn_u32 v27, v27, v2
    s_waitcnt lgkmcnt(8)
    s_cbranch_vccz L1_p8
    s_add_u32 s47, s35, 0xa900000
    s_mov_b64 exec, vcc
    buffer_store_dwordx4 v[12:15], v0, s[24:27], s47 offen sc1
    s_mov_b64 exec, -1
L1_p8:
    s_add_u32 s44, s35, 0x7ec8000
    s_add_u32 s44, s44, s72
    buffer_store_dwordx4 v[112:115], v0, s[20:23], s44 offen sc1
    ds_add_rtn_u32 v52, v52, v2
    ds_add_rtn_u32 v53, v53, v2
    ds_add_rtn_u32 v54, v54, v2
    ds_add_rtn_u32 v55, v55, v2
    s_load_dwordx2 s[28:29], s[0:1], 0
    s_load_dwordx2 s[50:51], s[0:1], 40
    s_load_dwordx2 s[52:53], s[0:1], 24
    s_setprio 1
    ds_add_rtn_u32 v68, v68, v2
    ds_add_rtn_u32 v69, v69, v2
    ds_add_rtn_u32 v70, v70, v2
    ds_add_rtn_u32 v71, v71, v2
    s_cmp_le_u32 s43, 5
    s_cbranch_scc1 L1_s9
    ds_add_rtn_u32 v76, v76, v2
    ds_add_rtn_u32 v77, v77, v2
    ds_add_rtn_u32 v78, v78, v2
    ds_add_rtn_u32 v79, v79, v2
L1_s9:
    s_add_u32 s45, s35, 0x7ec8000
    s_add_u32 s45, s45, s73
    buffer_store_dwordx4 v[88:91], v0, s[20:23], s45 offen sc1
    s_setprio 0
    s_cmp_le_u32 s43, 6
    s_cbranch_scc1 L1_s10
    ds_add_rtn_u32 v56, v56, v2
    ds_add_rtn_u32 v57, v57, v2
    ds_add_rtn_u32 v58, v58, v2
    ds_add_rtn_u32 v59, v59, v2
L1_s10:
    s_cmp_le_u32 s43, 7
    s_cbranch_scc1 L1_s11
    ds_add_rtn_u32 v60, v60, v2
    ds_add_rtn_u32 v61, v61, v2
    ds_add_rtn_u32 v62, v62, v2
    ds_add_rtn_u32 v63, v63, v2
L1_s11:
    s_waitcnt lgkmcnt(0)
    s_barrier
    s_load_dwordx4 s[96:99], s[50:51], 0
    s_mov_b64 s[4:5], s[52:53]
    s_bfe_u32 s33, s2, 0x20001
    s_and_b32 s34, s2, 1
    s_lshl_b32 s34, s34, 5
    s_lshr_b32 s3, s2, 3
    s_add_u32 s34, s34, s3
    s_mul_i32 s39, s33, 2080
    s_lshl_b32 s3, s34, 5
    s_add_u32 s39, s39, s3
    s_mul_i32 s40, s33, 1310720
    s_add_u32 s40, s40, 0x50000
    s_lshl_b32 s38, s32, 11
    s_mul_i32 s100, s32, 3072
    s_add_u32 s8, s30, 0x4000
    s_addc_u32 s9, s31, 0
    s_mov_b32 s10, 0xd340000
    s_mov_b32 s11, 0x20000
    s_add_u32 s12, s30, 0x2c000
    s_addc_u32 s13, s31, 0
    s_mov_b32 s14, 0xd318000
    s_mov_b32 s15, 0x20000
    s_mov_b32 s16, s64
    s_mov_b32 s17, s65
    s_mov_b32 s18, 0x20
    s_mov_b32 s19, 0x20000
    s_mov_b32 s24, s28
    s_mov_b32 s25, s29
    s_mov_b32 s26, 0x4e2000
    s_mov_b32 s27, 0x20000
    s_setprio 3
    v_and_b32 v7, -4, v120
    v_lshl_add_u32 v8, v120, 2, v7
    ds_write_b32 v8, v16
    v_lshl_add_u32 v7, v7, 2, v120
    ds_write_b8 v7, v44 offset:16
    v_and_b32 v9, -4, v121
    v_lshl_add_u32 v10, v121, 2, v9
    ds_write_b32 v10, v17
    v_lshl_add_u32 v9, v9, 2, v121
    ds_write_b8_d16_hi v9, v44 offset:16
    v_and_b32 v7, -4, v122
    v_lshl_add_u32 v8, v122, 2, v7
    ds_write_b32 v8, v18
    v_lshl_add_u32 v7, v7, 2, v122
    ds_write_b8 v7, v45 offset:16
    v_and_b32 v9, -4, v123
    v_lshl_add_u32 v10, v123, 2, v9
    ds_write_b32 v10, v19
    v_lshl_add_u32 v9, v9, 2, v123
    ds_write_b8_d16_hi v9, v45 offset:16
    s_add_u32 s46, s35, 0x7ec8000
    s_add_u32 s46, s46, s85
    buffer_store_dwordx4 v[116:119], v0, s[20:23], s46 offen sc1
    v_and_b32 v13, 0x3f0, v0
    v_and_b32 v14, 0x300, v13
    v_bfe_u32 v15, v13, 4, 4
    s_lshl_b32 s3, s32, 4
    v_add3_u32 v14, v14, v15, s3
    v_mul_u32_u24 v2, 173056, v14
    v_lshrrev_b32 v14, 6, v13
    s_add_u32 s3, s3, 0x400
    v_add_u32 v14, s3, v14
    v_mul_u32_u24 v4, 173056, v14
    v_and_b32 v14, 3, v14
    v_and_b32 v15, 0x30, v13
    v_lshl_add_u32 v14, v14, 5, v15
    v_add_u32 v6, v14, v4
    v_lshl_add_u32 v5, v15, 1, v2
    v_lshrrev_b32 v14, 3, v15
    buffer_load_ushort v100, v14, s[16:19], 0 offen offset:0
    buffer_load_ushort v101, v14, s[16:19], 0 offen offset:8
    buffer_load_ushort v102, v14, s[16:19], 0 offen offset:16
    buffer_load_ushort v103, v14, s[16:19], 0 offen offset:24
    s_mul_i32 s3, s32, 5120
    v_add_u32 v3, s3, v13
    v_lshrrev_b32 v14, 2, v13
    v_add_u32 v14, s38, v14
    v_and_b32 v7, -4, v124
    v_lshl_add_u32 v8, v124, 2, v7
    ds_write_b32 v8, v20
    v_lshl_add_u32 v7, v7, 2, v124
    ds_write_b8 v7, v46 offset:16
    v_and_b32 v9, -4, v125
    v_lshl_add_u32 v10, v125, 2, v9
    ds_write_b32 v10, v21
    v_lshl_add_u32 v9, v9, 2, v125
    ds_write_b8_d16_hi v9, v46 offset:16
    v_and_b32 v7, -4, v126
    v_lshl_add_u32 v8, v126, 2, v7
    ds_write_b32 v8, v22
    v_lshl_add_u32 v7, v7, 2, v126
    ds_write_b8 v7, v47 offset:16
    v_and_b32 v9, -4, v127
    v_lshl_add_u32 v10, v127, 2, v9
    ds_write_b32 v10, v23
    v_lshl_add_u32 v9, v9, 2, v127
    ds_write_b8_d16_hi v9, v47 offset:16
    v_lshrrev_b32 v11, 2, v0
    v_and_b32 v11, 0xfc, v11
    s_cmp_ge_u32 s84, 128
    s_cselect_b32 s82, 0, s82
    s_and_b32 s3, s84, 1
    s_mul_i32 s3, s3, 40
    s_add_u32 s3, s3, s32
    s_mul_i32 s74, s3, 205
    s_lshr_b32 s74, s74, 10
    s_mul_i32 s75, s74, 5
    s_sub_u32 s75, s3, s75
    s_lshl_b32 s48, s74, 1
    s_add_u32 s48, s48, s75
    s_add_u32 s49, s48, s74
    s_add_u32 s49, s49, 30
    s_cmp_lt_u32 s75, 2
    s_cselect_b32 s48, s48, s49
    s_lshl_b32 s48, s48, 10
    s_lshr_b32 s49, s84, 1
    s_mul_i32 s49, s49, 80000
    s_add_u32 s48, s48, s49
    buffer_load_dword v104, v11, s[80:83], s48 offen offset:0
    buffer_load_dword v105, v11, s[80:83], s48 offen offset:256
    buffer_load_dword v106, v11, s[80:83], s48 offen offset:512
    buffer_load_dword v107, v11, s[80:83], s48 offen offset:768
    s_and_b32 s3, s84, 1
    s_mul_i32 s3, s3, 40
    s_add_u32 s3, s3, s32
    s_add_u32 s3, s3, 16
    s_mul_i32 s74, s3, 205
    s_lshr_b32 s74, s74, 10
    s_mul_i32 s75, s74, 5
    s_sub_u32 s75, s3, s75
    s_lshl_b32 s48, s74, 1
    s_add_u32 s48, s48, s75
    s_add_u32 s49, s48, s74
    s_add_u32 s49, s49, 30
    s_cmp_lt_u32 s75, 2
    s_cselect_b32 s48, s48, s49
    s_lshl_b32 s48, s48, 10
    s_lshr_b32 s49, s84, 1
    s_mul_i32 s49, s49, 80000
    s_add_u32 s48, s48, s49
    buffer_load_dword v28, v11, s[80:83], s48 offen offset:0
    buffer_load_dword v29, v11, s[80:83], s48 offen offset:256
    buffer_load_dword v30, v11, s[80:83], s48 offen offset:512
    buffer_load_dword v31, v11, s[80:83], s48 offen offset:768
    s_and_b32 s3, s84, 1
    s_mul_i32 s3, s3, 40
    s_add_u32 s3, s3, s32
    s_add_u32 s3, s3, 32
    s_cmp_ge_u32 s32, 8
    s_cselect_b32 s82, 0, s82
    s_mul_i32 s74, s3, 205
    s_lshr_b32 s74, s74, 10
    s_mul_i32 s75, s74, 5
    s_sub_u32 s75, s3, s75
    s_lshl_b32 s48, s74, 1
    s_add_u32 s48, s48, s75
    s_add_u32 s49, s48, s74
    s_add_u32 s49, s49, 30
    s_cmp_lt_u32 s75, 2
    s_cselect_b32 s48, s48, s49
    s_lshl_b32 s48, s48, 10
    s_lshr_b32 s49, s84, 1
    s_mul_i32 s49, s49, 80000
    s_add_u32 s48, s48, s49
    buffer_load_dword v112, v11, s[80:83], s48 offen offset:0
    buffer_load_dword v113, v11, s[80:83], s48 offen offset:256
    buffer_load_dword v114, v11, s[80:83], s48 offen offset:512
    buffer_load_dword v115, v11, s[80:83], s48 offen offset:768
    s_setprio 2
    v_and_b32 v7, -4, v24
    v_lshl_add_u32 v8, v24, 2, v7
    ds_write_b32 v8, v40
    v_lshl_add_u32 v7, v7, 2, v24
    ds_write_b8 v7, v32 offset:16
    v_and_b32 v9, -4, v25
    v_lshl_add_u32 v10, v25, 2, v9
    ds_write_b32 v10, v41
    v_lshl_add_u32 v9, v9, 2, v25
    ds_write_b8_d16_hi v9, v32 offset:16
    v_and_b32 v7, -4, v26
    v_lshl_add_u32 v8, v26, 2, v7
    ds_write_b32 v8, v42
    v_lshl_add_u32 v7, v7, 2, v26
    ds_write_b8 v7, v33 offset:16
    v_and_b32 v9, -4, v27
    v_lshl_add_u32 v10, v27, 2, v9
    ds_write_b32 v10, v43
    v_lshl_add_u32 v9, v9, 2, v27
    ds_write_b8_d16_hi v9, v33 offset:16
    s_add_u32 s47, s35, 0x7ec8000
    s_add_u32 s47, s47, s91
    buffer_store_dwordx4 v[92:95], v0, s[20:23], s47 offen sc1
    v_and_b32 v7, -4, v52
    v_lshl_add_u32 v8, v52, 2, v7
    ds_write_b32 v8, v48
    v_lshl_add_u32 v7, v7, 2, v52
    ds_write_b8 v7, v34 offset:16
    v_and_b32 v9, -4, v53
    v_lshl_add_u32 v10, v53, 2, v9
    ds_write_b32 v10, v49
    v_lshl_add_u32 v9, v9, 2, v53
    ds_write_b8_d16_hi v9, v34 offset:16
    v_and_b32 v7, -4, v54
    v_lshl_add_u32 v8, v54, 2, v7
    ds_write_b32 v8, v50
    v_lshl_add_u32 v7, v7, 2, v54
    ds_write_b8 v7, v35 offset:16
    v_and_b32 v9, -4, v55
    v_lshl_add_u32 v10, v55, 2, v9
    ds_write_b32 v10, v51
    v_lshl_add_u32 v9, v9, 2, v55
    ds_write_b8_d16_hi v9, v35 offset:16
    s_setprio 1
    v_and_b32 v7, -4, v68
    v_lshl_add_u32 v8, v68, 2, v7
    ds_write_b32 v8, v84
    v_lshl_add_u32 v7, v7, 2, v68
    ds_write_b8 v7, v72 offset:16
    v_and_b32 v9, -4, v69
    v_lshl_add_u32 v10, v69, 2, v9
    ds_write_b32 v10, v85
    v_lshl_add_u32 v9, v9, 2, v69
    ds_write_b8_d16_hi v9, v72 offset:16
    v_and_b32 v7, -4, v70
    v_lshl_add_u32 v8, v70, 2, v7
    ds_write_b32 v8, v86
    v_lshl_add_u32 v7, v7, 2, v70
    ds_write_b8 v7, v73 offset:16
    v_and_b32 v9, -4, v71
    v_lshl_add_u32 v10, v71, 2, v9
    ds_write_b32 v10, v87
    v_lshl_add_u32 v9, v9, 2, v71
    ds_write_b8_d16_hi v9, v73 offset:16
    s_cmp_le_u32 s43, 5
    s_cbranch_scc1 L1_s12
    v_and_b32 v7, -4, v76
    v_lshl_add_u32 v8, v76, 2, v7
    ds_write_b32 v8, v36
    v_lshl_add_u32 v7, v7, 2, v76
    ds_write_b8 v7, v74 offset:16
    v_and_b32 v9, -4, v77
    v_lshl_add_u32 v10, v77, 2, v9
    ds_write_b32 v10, v37
    v_lshl_add_u32 v9, v9, 2, v77
    ds_write_b8_d16_hi v9, v74 offset:16
    v_and_b32 v7, -4, v78
    v_lshl_add_u32 v8, v78, 2, v7
    ds_write_b32 v8, v38
    v_lshl_add_u32 v7, v7, 2, v78
    ds_write_b8 v7, v75 offset:16
    v_and_b32 v9, -4, v79
    v_lshl_add_u32 v10, v79, 2, v9
    ds_write_b32 v10, v39
    v_lshl_add_u32 v9, v9, 2, v79
    ds_write_b8_d16_hi v9, v75 offset:16
L1_s12:
    s_add_u32 s44, s35, 0x7ec8000
    s_add_u32 s44, s44, s93
    buffer_store_dwordx4 v[108:111], v0, s[20:23], s44 offen sc1
    s_setprio 0
    s_cmp_le_u32 s43, 6
    s_cbranch_scc1 L1_s13
    v_and_b32 v7, -4, v56
    v_lshl_add_u32 v8, v56, 2, v7
    ds_write_b32 v8, v80
    v_lshl_add_u32 v7, v7, 2, v56
    ds_write_b8 v7, v64 offset:16
    v_and_b32 v9, -4, v57
    v_lshl_add_u32 v10, v57, 2, v9
    ds_write_b32 v10, v81
    v_lshl_add_u32 v9, v9, 2, v57
    ds_write_b8_d16_hi v9, v64 offset:16
    v_and_b32 v7, -4, v58
    v_lshl_add_u32 v8, v58, 2, v7
    ds_write_b32 v8, v82
    v_lshl_add_u32 v7, v7, 2, v58
    ds_write_b8 v7, v65 offset:16
    v_and_b32 v9, -4, v59
    v_lshl_add_u32 v10, v59, 2, v9
    ds_write_b32 v10, v83
    v_lshl_add_u32 v9, v9, 2, v59
    ds_write_b8_d16_hi v9, v65 offset:16
L1_s13:
    s_add_u32 s80, s30, 0xd344000
    s_addc_u32 s81, s31, 0
    s_mov_b32 s82, 0xa000
    s_mov_b32 s83, 0x20000
    s_min_u32 s3, s84, 127
    s_mul_i32 s3, s3, 40960
    s_add_u32 s80, s80, s3
    s_addc_u32 s81, s81, 0
    s_cmp_ge_u32 s84, 128
    s_cselect_b32 s82, 0, s82
    s_waitcnt vmcnt(2)
    v_add_u32 v11, 0, v0
    buffer_store_dwordx4 v[104:107], v11, s[80:83], 0 offen sc1
    v_add_u32 v11, 16384, v0
    buffer_store_dwordx4 v[28:31], v11, s[80:83], 0 offen sc1
    v_add_u32 v11, 32768, v0
    buffer_store_dwordx4 v[112:115], v11, s[80:83], 0 offen sc1
    s_cmp_le_u32 s43, 7
    s_cbranch_scc1 L1_s14
    v_and_b32 v7, -4, v60
    v_lshl_add_u32 v8, v60, 2, v7
    ds_write_b32 v8, v96
    v_lshl_add_u32 v7, v7, 2, v60
    ds_write_b8 v7, v66 offset:16
    v_and_b32 v9, -4, v61
    v_lshl_add_u32 v10, v61, 2, v9
    ds_write_b32 v10, v97
    v_lshl_add_u32 v9, v9, 2, v61
    ds_write_b8_d16_hi v9, v66 offset:16
    v_and_b32 v7, -4, v62
    v_lshl_add_u32 v8, v62, 2, v7
    ds_write_b32 v8, v98
    v_lshl_add_u32 v7, v7, 2, v62
    ds_write_b8 v7, v67 offset:16
    v_and_b32 v9, -4, v63
    v_lshl_add_u32 v10, v63, 2, v9
    ds_write_b32 v10, v99
    v_lshl_add_u32 v9, v9, 2, v63
    ds_write_b8_d16_hi v9, v67 offset:16
L1_s14:
    v_add_u32 v7, 0x10000, v0
    v_add_u32 v12, 0x20000, v0
    s_waitcnt lgkmcnt(0)
    s_barrier
    ds_read_b128 v[24:27], v0 offset:0
    ds_read_b128 v[28:31], v0 offset:16384
    ds_read_b128 v[32:35], v0 offset:32768
    ds_read_b128 v[36:39], v0 offset:49152
    ds_read_b128 v[76:79], v7 offset:0
    ds_read_b128 v[80:83], v7 offset:16384
    ds_read_b128 v[84:87], v7 offset:32768
    ds_read_b128 v[104:107], v7 offset:49152
    ds_read_b128 v[68:71], v12 offset:0
    ds_read_b128 v[72:75], v12 offset:16384
    s_cmp_lg_u32 s32, 0
    s_cbranch_scc1 L2_sg1
    s_mov_b32 exec_hi, 0
    v_mov_b32 v11, 1
    buffer_store_dword v11, v14, s[60:63], s57 offen sc1
    s_mov_b64 exec, -1
L2_sg1:
    s_waitcnt lgkmcnt(9)
    s_add_u32 s45, s35, 0xa904000
    buffer_store_dwordx4 v[24:27], v0, s[20:23], s45 offen sc1
    s_waitcnt lgkmcnt(8)
    s_add_u32 s46, s35, 0xa908000
    buffer_store_dwordx4 v[28:31], v0, s[20:23], s46 offen sc1
    s_waitcnt lgkmcnt(7)
    s_add_u32 s47, s35, 0xa90c000
    buffer_store_dwordx4 v[32:35], v0, s[20:23], s47 offen sc1
    s_waitcnt lgkmcnt(6)
    s_add_u32 s44, s35, 0xa910000
    buffer_store_dwordx4 v[36:39], v0, s[20:23], s44 offen sc1
    s_waitcnt lgkmcnt(5)
    s_add_u32 s45, s35, 0xa914000
    buffer_store_dwordx4 v[76:79], v0, s[20:23], s45 offen sc1
    s_waitcnt lgkmcnt(4)
    s_add_u32 s46, s35, 0xa918000
    buffer_store_dwordx4 v[80:83], v0, s[20:23], s46 offen sc1
    s_waitcnt lgkmcnt(3)
    s_add_u32 s47, s35, 0xa91c000
    buffer_store_dwordx4 v[84:87], v0, s[20:23], s47 offen sc1
    s_waitcnt lgkmcnt(2)
    s_cmp_le_u32 s43, 5
    s_cbranch_scc1 L1_q15
    s_add_u32 s44, s35, 0xa920000
    buffer_store_dwordx4 v[104:107], v0, s[20:23], s44 offen sc1
L1_q15:
    s_waitcnt lgkmcnt(1)
    s_cmp_le_u32 s43, 6
    s_cbranch_scc1 L1_q16
    s_add_u32 s45, s35, 0xa924000
    buffer_store_dwordx4 v[68:71], v0, s[20:23], s45 offen sc1
L1_q16:
    s_waitcnt lgkmcnt(0)
    s_cmp_le_u32 s43, 7
    s_cbranch_scc1 L1_q17
    s_add_u32 s46, s35, 0xa928000
    buffer_store_dwordx4 v[72:75], v0, s[20:23], s46 offen sc1
L1_q17:
    s_waitcnt lgkmcnt(0)
    s_setprio 3
    v_mov_b32 v92, v0
    v_mov_b32 v93, v6
    v_mov_b32 v94, v13
    v_mov_b32 v95, v5
    v_mov_b32 v0, v14
    v_lshl_add_u32 v7, v13, 3, s38
    v_lshrrev_b32 v16, 2, v15
    v_mad_u32_u24 v4, v16, 5, v4
    v_or_b32 v4, 0xf0000000, v4
    v_or_b32 v2, 0xf0000000, v2
    v_sub_u32 v1, 28, v16
    v_lshrrev_b32 v17, 2, v16
    v_and_b32 v18, 3, v17
    v_lshlrev_b32 v18, 4, v18
    v_mov_b32 v10, 0x3f80
    v_mov_b32 v11, 0
    v_lshlrev_b64 v[10:11], v18, v[10:11]
    v_and_b32 v18, 3, v17
    v_lshlrev_b32 v18, 4, v18
    v_mov_b32 v12, 0xbf80
    v_mov_b32 v13, 0
    v_lshlrev_b64 v[12:13], v18, v[12:13]
    v_mov_b32 v45, 0xf0000000
    v_add_u32 v44, s38, v0
    v_lshrrev_b32 v44, 1, v44
    v_and_b32 v44, -4, v44
    v_mov_b32 v5, 0x1fff8
    v_mov_b32 v6, 0x07ff0000
    v_mov_b32 v16, 0
    v_mov_b32 v17, 0
    v_mov_b32 v18, 0
    v_mov_b32 v19, 0
    v_add_u32 v20, 81920, v92
    v_add_u32 v21, 0x10000, v20
    s_setprio 1
    s_setprio 2
    s_mov_b32 s44, 0x4000c0c
    s_mov_b32 s45, 0x4010c0c
    s_mov_b32 s46, 0x4020c0c
    s_mov_b32 s47, 0x4030c0c
    s_mov_b32 s36, 0
    s_mov_b32 s43, 0
    s_mov_b32 s42, 0
    s_mov_b64 s[80:81], 0
    s_mov_b64 s[48:49], 0
    s_add_u32 s16, s30, 0xd344000
    s_addc_u32 s17, s31, 0
    s_mov_b32 s18, 0x500000
    s_mov_b32 s19, 0x20000
    v_mov_b32 v68, 0
    v_mov_b32 v69, 0
    v_mov_b32 v70, 0
    v_mov_b32 v71, 0
    v_mov_b32 v72, 0
    v_mov_b32 v73, 0
    v_mov_b32 v74, 0
    v_mov_b32 v75, 0
    s_waitcnt vmcnt(0)
    v_lshl_or_b32 v8, v101, 16, v100
    v_lshl_or_b32 v9, v103, 16, v102
    s_barrier
    s_cmp_lg_u32 s32, 0
    s_cbranch_scc1 L2_sg2
    s_mov_b32 exec_hi, 0
    v_mov_b32 v88, 2
    buffer_store_dword v88, v0, s[60:63], s57 offen sc1
    s_mov_b64 exec, -1
L2_sg2:
    s_mov_b64 s[84:85], 0
    s_mul_i32 s3, s33, 1280000
    s_add_u32 s3, s3, s100
    s_add_u32 s3, s3, 32768
    buffer_load_dwordx4 v[124:127], v94, s[24:27], s3 offen offset:2048
    s_mul_i32 s3, s33, 1280000
    s_add_u32 s3, s3, s100
    s_add_u32 s3, s3, 32768
    buffer_load_dwordx4 v[116:119], v94, s[24:27], s3 offen offset:0
    s_mul_i32 s3, s33, 1280000
    s_add_u32 s3, s3, s100
    s_add_u32 s3, s3, 32768
    buffer_load_dwordx4 v[120:123], v94, s[24:27], s3 offen offset:1024
    s_mul_i32 s3, s33, 1280000
    s_add_u32 s3, s3, s38
    s_add_u32 s3, s3, 0
    buffer_load_dwordx4 v[108:111], v94, s[24:27], s3 offen offset:0
    s_mul_i32 s3, s33, 1280000
    s_add_u32 s3, s3, s38
    s_add_u32 s3, s3, 0
    buffer_load_dwordx4 v[112:115], v94, s[24:27], s3 offen offset:1024
    ds_write_b128 v20, v[16:19] offset:0
    ds_write_b128 v20, v[16:19] offset:16384
    ds_write_b128 v20, v[16:19] offset:32768
    ds_write_b128 v20, v[16:19] offset:49152
    ds_write_b128 v21, v[16:19]
    s_cmp_eq_u32 s56, 0
    s_cbranch_scc1 L2_e3
    v_lshlrev_b32 v16, 3, v94
    v_and_b32 v16, 0x80, v16
L2_e4:
    buffer_load_dword v88, v16, s[68:71], 0 offen sc1
    s_waitcnt vmcnt(0)
    v_cmp_gt_u32 vcc, 0x80, v88
    s_cbranch_vccnz L2_e4
L2_e3:
    s_mov_b64 exec, 0xffff
L2_p1:
    buffer_load_dword v88, v7, s[60:63], 0 offen sc1
    s_waitcnt vmcnt(0)
    v_cmpx_gt_u32 vcc, 1, v88
    s_cbranch_vccnz L2_p1s
    s_mov_b64 exec, -1
    v_cmp_gt_u32 vcc, 2, v88
    s_and_b32 s56, vcc_lo, 0xffff
    buffer_load_dwordx4 v[48:51], v95, s[12:15], s39 offen offset:0
    buffer_load_dwordx4 v[56:59], v95, s[12:15], s39 offen offset:32
    buffer_load_dwordx4 v[52:55], v95, s[12:15], s39 offen offset:16
    buffer_load_dwordx4 v[60:63], v95, s[12:15], s39 offen offset:48
    buffer_load_dwordx4 v[64:67], v93, s[12:15], s39 offen
    s_waitcnt vmcnt(0)
    v_sub_u16 v88, v56, v48
    v_and_b32 v89, 3, v48
    v_add3_u32 v99, v88, v89, 3
    v_and_b32 v99, -4, v99
    v_max_u32 v99, 4, v99
    v_and_b32 v97, 0xfffc, v48
    v_bfm_b32 v96, v88, v89
    v_add_u32_dpp v91, v99, v99 row_shr:1 row_mask:0xf bank_mask:0xf bound_ctrl:1
    v_mad_u32_u24 v97, v97, 5, v2
    v_cmp_lt_u32 vcc, 16, v99
    v_add_u32_dpp v91, v91, v91 row_shr:2 row_mask:0xf bank_mask:0xf bound_ctrl:1
    v_sub_u32 v98, s38, v99
    v_lshrrev_b64 v[48:49], 16, v[48:49]
    v_add_u32_dpp v91, v91, v91 row_shr:4 row_mask:0xf bank_mask:0xf bound_ctrl:1
    v_lshrrev_b64 v[56:57], 16, v[56:57]
    s_mov_b32 s101, 0
    v_add_u32_dpp v91, v91, v91 row_shr:8 row_mask:0xf bank_mask:0xf bound_ctrl:1
    s_nop 1
    v_add_u32_dpp v91, v91, v91 row_bcast:15 row_mask:0xa bank_mask:0xf
    s_nop 1
    v_add_u32_dpp v91, v91, v91 row_bcast:31 row_mask:0xc bank_mask:0xf
    v_add_u32 v98, v98, v91
    v_readlane_b32 s37, v91, 63
    s_cbranch_vccnz L2_xo3
L2_xp3:
    s_cmp_gt_u32 s37, 1024
    s_cbranch_scc1 L2_xs4
    s_cmp_lg_u32 s101, 0
    s_cbranch_scc1 L2_xa4
L2_xb4:
    v_lshlrev_b32 v89, 16, v96
    v_add_u32 v90, 60, v97
    v_bitop3_b32 v90, v89, v45, v90 bitop3:0x6a
    ds_write_b32 v98, v90 offset:12
    v_lshlrev_b32 v89, 20, v96
    v_add_u32 v90, 40, v97
    v_bitop3_b32 v90, v89, v45, v90 bitop3:0x6a
    ds_write_b32 v98, v90 offset:8
    v_lshlrev_b32 v89, 24, v96
    v_add_u32 v90, 20, v97
    v_bitop3_b32 v90, v89, v45, v90 bitop3:0x6a
    ds_write_b32 v98, v90 offset:4
    v_lshlrev_b32 v89, 28, v96
    v_bitop3_b32 v90, v89, v45, v97 bitop3:0x6a
    ds_write_b32 v98, v90 offset:0
    v_mov_b32_dpp v91, v64 quad_perm:[0,0,0,0] row_mask:0xf bank_mask:0xf
    v_and_b32 v89, 3, v91
    v_and_b32 v97, 0xfffc, v91
    v_sub_u16_dpp v88, v64, v91 quad_perm:[2,2,2,2] row_mask:0xf bank_mask:0xf
    v_mad_u32_u24 v97, v97, 5, v4
    v_add_u32 v99, v88, v89
    v_bfm_b32 v96, v88, v89
    v_cmp_lt_u32 s[58:59], 16, v99
    v_lshlrev_b32 v89, v1, v96
    v_and_b32 v89, v45, v89
    v_cmp_ne_u32 vcc, 0, v89
    v_xor_b32 v90, v97, v89
    s_add_u32 s3, s37, s38
    v_mbcnt_lo_u32_b32 v98, vcc_lo, 0
    v_mbcnt_hi_u32_b32 v98, vcc_hi, v98
    s_bcnt1_i32_b64 s41, vcc
    v_lshl_add_u32 v98, v98, 2, s3
    s_lshl2_add_u32 s37, s41, s37
    s_mov_b64 exec, vcc
    ds_write_b32 v98, v90
    s_mov_b64 exec, -1
    s_cmp_lg_u64 s[58:59], 0
    s_cbranch_scc1 L2_xe4
L2_xr4:
    v_add_u32 v98, s37, v0
    v_mov_b32 v90, -1
    ds_write_b32 v98, v90
L2_xw4:
    ds_read_b32 v21, v0 offset:0
    ds_read_b32 v27, v0 offset:256
    ds_read_b32 v31, v44 offset:768
    ds_read_b32 v39, v0 offset:512
    s_sub_u32 s3, s37, 768
    s_cmp_gt_u32 s3, 128
    s_cbranch_scc1 L2_xf4
L2_xg4:
    v_sub_u16 v88, v58, v50
    v_and_b32 v89, 3, v50
    v_add3_u32 v99, v88, v89, 3
    v_and_b32 v99, -4, v99
    v_max_u32 v99, 4, v99
    v_and_b32 v97, 0xfffc, v50
    v_bfm_b32 v96, v88, v89
    v_add_u32_dpp v91, v99, v99 row_shr:1 row_mask:0xf bank_mask:0xf bound_ctrl:1
    v_mad_u32_u24 v97, v97, 5, v2
    v_cmp_lt_u32 vcc, 16, v99
    v_add_u32_dpp v91, v91, v91 row_shr:2 row_mask:0xf bank_mask:0xf bound_ctrl:1
    v_sub_u32 v98, s38, v99
    v_lshrrev_b64 v[50:51], 16, v[50:51]
    v_add_u32_dpp v91, v91, v91 row_shr:4 row_mask:0xf bank_mask:0xf bound_ctrl:1
    v_lshrrev_b64 v[58:59], 16, v[58:59]
    s_mov_b32 s101, 0
    v_add_u32_dpp v91, v91, v91 row_shr:8 row_mask:0xf bank_mask:0xf bound_ctrl:1
    s_nop 1
    v_add_u32_dpp v91, v91, v91 row_bcast:15 row_mask:0xa bank_mask:0xf
    s_nop 1
    v_add_u32_dpp v91, v91, v91 row_bcast:31 row_mask:0xc bank_mask:0xf
    v_add_u32 v98, v98, v91
    v_readlane_b32 s37, v91, 63
    s_cbranch_vccnz L2_xo5
L2_xp5:
    s_waitcnt lgkmcnt(0)
    s_cmp_gt_u32 s37, 1024
    s_cbranch_scc1 L2_xs6
    s_cmp_lg_u32 s101, 0
    s_cbranch_scc1 L2_xa6
L2_xb6:
    v_lshlrev_b32 v89, 16, v96
    v_add_u32 v90, 60, v97
    v_bitop3_b32 v90, v89, v45, v90 bitop3:0x6a
    ds_write_b32 v98, v90 offset:12
    v_lshlrev_b32 v89, 20, v96
    v_add_u32 v90, 40, v97
    v_bitop3_b32 v90, v89, v45, v90 bitop3:0x6a
    ds_write_b32 v98, v90 offset:8
    v_lshlrev_b32 v89, 24, v96
    v_add_u32 v90, 20, v97
    v_bitop3_b32 v90, v89, v45, v90 bitop3:0x6a
    ds_write_b32 v98, v90 offset:4
    v_lshlrev_b32 v89, 28, v96
    v_bitop3_b32 v90, v89, v45, v97 bitop3:0x6a
    ds_write_b32 v98, v90 offset:0
    v_mov_b32_dpp v91, v66 quad_perm:[0,0,0,0] row_mask:0xf bank_mask:0xf
    v_and_b32 v89, 3, v91
    v_and_b32 v97, 0xfffc, v91
    v_sub_u16_dpp v88, v66, v91 quad_perm:[2,2,2,2] row_mask:0xf bank_mask:0xf
    v_mad_u32_u24 v97, v97, 5, v4
    v_add_u32 v99, v88, v89
    v_bfm_b32 v96, v88, v89
    v_cmp_lt_u32 s[58:59], 16, v99
    v_lshlrev_b32 v89, v1, v96
    v_and_b32 v89, v45, v89
    v_cmp_ne_u32 vcc, 0, v89
    v_xor_b32 v90, v97, v89
    s_add_u32 s3, s37, s38
    v_mbcnt_lo_u32_b32 v98, vcc_lo, 0
    v_mbcnt_hi_u32_b32 v98, vcc_hi, v98
    s_bcnt1_i32_b64 s41, vcc
    v_lshl_add_u32 v98, v98, 2, s3
    s_lshl2_add_u32 s37, s41, s37
    s_mov_b64 exec, vcc
    ds_write_b32 v98, v90
    s_mov_b64 exec, -1
    s_cmp_lg_u64 s[58:59], 0
    s_cbranch_scc1 L2_xe6
L2_xr6:
    v_add_u32 v98, s37, v0
    v_mov_b32 v90, -1
    ds_write_b32 v98, v90
L2_xw6:
    ds_read_b32 v40, v0 offset:0
    ds_read_b32 v41, v0 offset:256
    ds_read_b32 v42, v44 offset:768
    ds_read_b32 v43, v0 offset:512
    s_sub_u32 s3, s37, 768
    s_cmp_gt_u32 s3, 128
    s_cbranch_scc1 L2_xf6
L2_xg6:
    v_subrev_u32 v88, s38, v3
    ds_write_b128 v88, v[124:127] offset:34816
    v_subrev_u32 v88, s38, v3
    ds_write_b128 v88, v[116:119] offset:32768
    v_subrev_u32 v88, s38, v3
    ds_write_b128 v88, v[120:123] offset:33792
    v_subrev_u32 v88, s100, v3
    ds_write_b128 v88, v[108:111] offset:0
    v_subrev_u32 v88, s100, v3
    ds_write_b128 v88, v[112:115] offset:1024
    s_cmp_eq_u32 s56, 0
    s_cbranch_scc1 L2_e2
    s_mov_b32 exec_lo, s56
    s_mov_b32 exec_hi, 0
    buffer_load_dword v88, v7, s[60:63], 0 offen sc1
    s_mov_b64 exec, -1
    s_waitcnt vmcnt(0)
    v_cmp_gt_u32 vcc, 2, v88
    s_and_b32 s56, vcc_lo, s56
    s_cbranch_scc0 L2_e2
    s_mul_i32 s3, s33, 1280000
    s_add_u32 s3, s3, s100
    s_add_u32 s3, s3, 352768
    buffer_load_dwordx4 v[124:127], v94, s[24:27], s3 offen offset:2048
    s_mul_i32 s3, s33, 1280000
    s_add_u32 s3, s3, s100
    s_add_u32 s3, s3, 352768
    buffer_load_dwordx4 v[116:119], v94, s[24:27], s3 offen offset:0
    s_mul_i32 s3, s33, 1280000
    s_add_u32 s3, s3, s100
    s_add_u32 s3, s3, 352768
    buffer_load_dwordx4 v[120:123], v94, s[24:27], s3 offen offset:1024
    s_mul_i32 s3, s33, 1280000
    s_add_u32 s3, s3, s38
    s_add_u32 s3, s3, 320000
    buffer_load_dwordx4 v[108:111], v94, s[24:27], s3 offen offset:0
    s_mul_i32 s3, s33, 1280000
    s_add_u32 s3, s3, s38
    s_add_u32 s3, s3, 320000
    buffer_load_dwordx4 v[112:115], v94, s[24:27], s3 offen offset:1024
    s_mov_b32 exec_lo, s56
    s_mov_b32 exec_hi, 0
L2_p2:
    buffer_load_dword v88, v7, s[60:63], 0 offen sc1
    s_waitcnt vmcnt(0)
    v_cmpx_gt_u32 vcc, 2, v88
    s_cbranch_vccnz L2_p2s
    s_mov_b64 exec, -1
L2_e2:
    s_mov_b32 s6, 0xaaaaaaaa
    s_mov_b32 s7, 0xaaaaaaaa
    v_and_b32 v47, 0x0fffffff, v21
    buffer_load_dwordx2 v[16:17], v47, s[8:11], 0 offen
    buffer_load_dwordx3 v[18:20], v47, s[8:11], 0 offen offset:8
    s_setprio 1
    v_and_b32 v47, 0x0fffffff, v27
    buffer_load_dwordx2 v[22:23], v47, s[8:11], 0 offen
    buffer_load_dwordx3 v[24:26], v47, s[8:11], 0 offen offset:8
    s_waitcnt lgkmcnt(0)
    s_barrier
    s_bitcmp1_b32 s36, s42
    s_cbranch_scc1 L2_slow
L2_ret0:
    s_setprio 3
    s_bitcmp1_b32 s43, s42
    s_cbranch_scc1 L2_oa7
L2_ob7:
    s_bitcmp1_b32 s43, s42
    s_cbranch_scc1 L2_oa8
L2_ob8:
    s_waitcnt vmcnt(2)
    v_and_b32 v46, 0x20000000, v21
    v_lshrrev_b32 v47, 14, v17
    v_bitop3_b32 v47, v47, v5, v46 bitop3:0xea
    ds_read_b64 v[102:103], v47
    v_bitop3_b32 v93, v17, v5, v46 bitop3:0xea
    v_and_b32 v46, 0x10000000, v21
    v_lshrrev_b32 v47, 14, v16
    v_bitop3_b32 v47, v47, v5, v46 bitop3:0xea
    ds_read_b64 v[100:101], v47
    v_bitop3_b32 v92, v16, v5, v46 bitop3:0xea
    v_perm_b32 v15, v17, v20, s45
    v_bitop3_b32 v46, v17, 0.5, -0.5 bitop3:0xa8
    v_perm_b32 v14, v16, v20, s44
    v_bitop3_b32 v47, v16, 0.5, -0.5 bitop3:0xa8
    v_bitop3_b32 v15, v6, v15, v46 bitop3:0xca
    v_bitop3_b32 v14, v6, v14, v47 bitop3:0xca
    s_waitcnt lgkmcnt(0)
    v_mfma_f32_4x4x4_16b_bf16 v[80:83], v[8:9], v[102:103], 0
    v_mfma_f32_4x4x4_16b_bf16 v[76:79], v[8:9], v[100:101], 0
    v_cmp_lt_u32 s[84:85], v5, v92
    s_nop 2
    v_pk_mul_f32 v[80:81], v[80:81], v[14:15] op_sel:[0,1] op_sel_hi:[1,1]
    v_pk_mul_f32 v[82:83], v[82:83], v[14:15] op_sel:[0,1] op_sel_hi:[1,1]
    v_pk_mul_f32 v[76:77], v[76:77], v[14:15] op_sel:[0,0] op_sel_hi:[1,0]
    v_pk_mul_f32 v[78:79], v[78:79], v[14:15] op_sel:[0,0] op_sel_hi:[1,0]
    v_and_b32 v47, 0x0fffffff, v39
    buffer_load_dwordx2 v[34:35], v47, s[8:11], 0 offen
    buffer_load_dwordx3 v[36:38], v47, s[8:11], 0 offen offset:8
    v_and_b32 v46, 0x80000000, v21
    v_lshrrev_b32 v47, 14, v19
    v_bitop3_b32 v47, v47, v5, v46 bitop3:0xea
    ds_read_b64 v[106:107], v47
    v_and_b32 v99, 0x40000000, v21
    v_lshrrev_b32 v47, 14, v18
    v_bitop3_b32 v47, v47, v5, v99 bitop3:0xea
    ds_read_b64 v[104:105], v47
    v_cmp_ne_u64 s[50:51], v[72:73], v[68:69]
    v_cmpx_ne_u64 s[54:55], v[74:75], v[70:71]
    s_and_b64 s[82:83], s[54:55], s[80:81]
    s_cbranch_scc1 L2_c9
L2_d9:
    v_mov_b64 v[84:85], v[70:71]
    v_mov_b32 v7, v95
    v_mov_b64 v[86:87], v[74:75]
    s_or_b64 s[80:81], s[80:81], s[54:55]
    s_mov_b64 exec, s[50:51]
    s_and_b64 s[82:83], s[50:51], s[80:81]
    s_cbranch_scc1 L2_c10
L2_d10:
    v_mov_b64 v[84:85], v[68:69]
    v_mov_b32 v7, v94
    v_mov_b64 v[86:87], v[72:73]
    s_mov_b64 exec, -1
    s_or_b64 s[80:81], s[80:81], s[50:51]
    s_and_b64 exec, s[84:85], s[80:81]
    v_mfma_f32_4x4x4_16b_bf16 v[76:79], v[12:13], v[84:85], 0
    v_mov_b32 v92, v7
    s_andn2_b64 s[80:81], s[80:81], s[84:85]
    v_mfma_f32_4x4x4_16b_bf16 v[76:79], v[10:11], v[86:87], v[76:79]
    s_mov_b64 exec, -1
    ds_read_b64 v[70:71], v93 offset:65408
    ds_read_b64 v[68:69], v92 offset:65408
    v_bitop3_b32 v94, v18, v5, v99 bitop3:0xea
    v_bitop3_b32 v95, v19, v5, v46 bitop3:0xea
    v_perm_b32 v15, v19, v20, s47
    v_bitop3_b32 v46, v19, 0.5, -0.5 bitop3:0xa8
    v_perm_b32 v14, v18, v20, s46
    v_bitop3_b32 v47, v18, 0.5, -0.5 bitop3:0xa8
    v_bitop3_b32 v15, v6, v15, v46 bitop3:0xca
    v_bitop3_b32 v14, v6, v14, v47 bitop3:0xca
    s_waitcnt lgkmcnt(1)
    v_mfma_f32_4x4x4_16b_bf16 v[80:83], v[10:11], v[70:71], v[80:83]
    s_waitcnt lgkmcnt(0)
    v_mfma_f32_4x4x4_16b_bf16 v[76:79], v[10:11], v[68:69], v[76:79]
    s_nop 2
    v_cvt_pk_bf16_f32 v80, v80, v81
    v_cvt_pk_bf16_f32 v81, v82, v83
    ds_wrxchg_rtn_b64 v[74:75], v93, v[80:81] offset:65408
    v_cvt_pk_bf16_f32 v76, v76, v77
    v_cvt_pk_bf16_f32 v77, v78, v79
    ds_wrxchg_rtn_b64 v[72:73], v92, v[76:77] offset:65408
    s_setprio 2
    v_mfma_f32_4x4x4_16b_bf16 v[80:83], v[8:9], v[106:107], 0
    v_mfma_f32_4x4x4_16b_bf16 v[76:79], v[8:9], v[104:105], 0
    v_cmp_lt_u32 s[48:49], v5, v95
    s_nop 2
    v_pk_mul_f32 v[80:81], v[80:81], v[14:15] op_sel:[0,1] op_sel_hi:[1,1]
    v_pk_mul_f32 v[82:83], v[82:83], v[14:15] op_sel:[0,1] op_sel_hi:[1,1]
    v_pk_mul_f32 v[76:77], v[76:77], v[14:15] op_sel:[0,0] op_sel_hi:[1,0]
    v_pk_mul_f32 v[78:79], v[78:79], v[14:15] op_sel:[0,0] op_sel_hi:[1,0]
    v_and_b32 v47, 0x0fffffff, v31
    buffer_load_dword v30, v47, s[8:11], 0 offen offset:16
    s_mov_b64 exec, s[6:7]
    v_add_u32 v47, 8, v47
    v_lshrrev_b32 v31, 2, v31
    s_mov_b64 exec, -1
    buffer_load_dwordx2 v[28:29], v47, s[8:11], 0 offen
    v_and_b32 v47, 0x3f0, v3
    s_cmp_lg_u32 s56, 0
    s_cbranch_scc1 L2_m11
    s_mul_i32 s3, s33, 1280000
    s_add_u32 s3, s3, s100
    s_add_u32 s3, s3, 352768
    buffer_load_dwordx4 v[124:127], v47, s[24:27], s3 offen offset:2048
L2_m11:
    v_and_b32 v47, 0x3f0, v3
    s_cmp_lg_u32 s56, 0
    s_cbranch_scc1 L2_m12
    s_mul_i32 s3, s33, 1280000
    s_add_u32 s3, s3, s100
    s_add_u32 s3, s3, 352768
    buffer_load_dwordx4 v[116:119], v47, s[24:27], s3 offen offset:0
L2_m12:
    s_waitcnt vmcnt(4)
    v_and_b32 v46, 0x20000000, v27
    v_lshrrev_b32 v47, 14, v23
    v_bitop3_b32 v47, v47, v5, v46 bitop3:0xea
    ds_read_b64 v[102:103], v47
    v_and_b32 v99, 0x10000000, v27
    v_lshrrev_b32 v47, 14, v22
    v_bitop3_b32 v47, v47, v5, v99 bitop3:0xea
    ds_read_b64 v[100:101], v47
    s_waitcnt lgkmcnt(2)
    v_cmp_ne_u64 s[50:51], v[72:73], v[68:69]
    v_cmpx_ne_u64 s[54:55], v[74:75], v[70:71]
    s_and_b64 s[82:83], s[54:55], s[80:81]
    s_cbranch_scc1 L2_c13
L2_d13:
    v_mov_b64 v[84:85], v[70:71]
    v_mov_b32 v7, v93
    v_mov_b64 v[86:87], v[74:75]
    s_or_b64 s[80:81], s[80:81], s[54:55]
    s_mov_b64 exec, s[50:51]
    s_and_b64 s[82:83], s[50:51], s[80:81]
    s_cbranch_scc1 L2_c14
L2_d14:
    v_mov_b64 v[84:85], v[68:69]
    v_mov_b32 v7, v92
    v_mov_b64 v[86:87], v[72:73]
    s_mov_b64 exec, -1
    s_or_b64 s[80:81], s[80:81], s[50:51]
    s_and_b64 exec, s[48:49], s[80:81]
    v_mfma_f32_4x4x4_16b_bf16 v[80:83], v[12:13], v[84:85], 0
    v_mov_b32 v95, v7
    s_andn2_b64 s[80:81], s[80:81], s[48:49]
    v_mfma_f32_4x4x4_16b_bf16 v[80:83], v[10:11], v[86:87], v[80:83]
    s_mov_b64 exec, -1
    ds_read_b64 v[70:71], v95 offset:65408
    ds_read_b64 v[68:69], v94 offset:65408
    v_bitop3_b32 v92, v22, v5, v99 bitop3:0xea
    v_bitop3_b32 v93, v23, v5, v46 bitop3:0xea
    v_perm_b32 v15, v23, v26, s45
    v_bitop3_b32 v46, v23, 0.5, -0.5 bitop3:0xa8
    v_perm_b32 v14, v22, v26, s44
    v_bitop3_b32 v47, v22, 0.5, -0.5 bitop3:0xa8
    v_bitop3_b32 v15, v6, v15, v46 bitop3:0xca
    v_bitop3_b32 v14, v6, v14, v47 bitop3:0xca
    s_waitcnt lgkmcnt(1)
    v_mfma_f32_4x4x4_16b_bf16 v[80:83], v[10:11], v[70:71], v[80:83]
    s_waitcnt lgkmcnt(0)
    v_mfma_f32_4x4x4_16b_bf16 v[76:79], v[10:11], v[68:69], v[76:79]
    s_nop 2
    v_cvt_pk_bf16_f32 v80, v80, v81
    v_cvt_pk_bf16_f32 v81, v82, v83
    ds_wrxchg_rtn_b64 v[74:75], v95, v[80:81] offset:65408
    v_cvt_pk_bf16_f32 v76, v76, v77
    v_cvt_pk_bf16_f32 v77, v78, v79
    ds_wrxchg_rtn_b64 v[72:73], v94, v[76:77] offset:65408
    s_setprio 1
    v_mfma_f32_4x4x4_16b_bf16 v[80:83], v[8:9], v[102:103], 0
    v_mfma_f32_4x4x4_16b_bf16 v[76:79], v[8:9], v[100:101], 0
    s_nop 3
    v_pk_mul_f32 v[80:81], v[80:81], v[14:15] op_sel:[0,1] op_sel_hi:[1,1]
    v_pk_mul_f32 v[82:83], v[82:83], v[14:15] op_sel:[0,1] op_sel_hi:[1,1]
    v_pk_mul_f32 v[76:77], v[76:77], v[14:15] op_sel:[0,0] op_sel_hi:[1,0]
    v_pk_mul_f32 v[78:79], v[78:79], v[14:15] op_sel:[0,0] op_sel_hi:[1,0]
    v_and_b32 v47, 0x3f0, v3
    s_cmp_lg_u32 s56, 0
    s_cbranch_scc1 L2_m15
    s_mul_i32 s3, s33, 1280000
    s_add_u32 s3, s3, s100
    s_add_u32 s3, s3, 352768
    buffer_load_dwordx4 v[120:123], v47, s[24:27], s3 offen offset:1024
L2_m15:
    v_sub_u16 v88, v60, v52
    v_and_b32 v89, 3, v52
    v_add3_u32 v99, v88, v89, 3
    v_and_b32 v99, -4, v99
    v_max_u32 v99, 4, v99
    v_and_b32 v97, 0xfffc, v52
    v_bfm_b32 v96, v88, v89
    v_add_u32_dpp v91, v99, v99 row_shr:1 row_mask:0xf bank_mask:0xf bound_ctrl:1
    v_mad_u32_u24 v97, v97, 5, v2
    v_cmp_lt_u32 vcc, 16, v99
    v_add_u32_dpp v91, v91, v91 row_shr:2 row_mask:0xf bank_mask:0xf bound_ctrl:1
    v_sub_u32 v98, s38, v99
    v_lshrrev_b64 v[52:53], 16, v[52:53]
    v_add_u32_dpp v91, v91, v91 row_shr:4 row_mask:0xf bank_mask:0xf bound_ctrl:1
    v_lshrrev_b64 v[60:61], 16, v[60:61]
    s_mov_b32 s101, 0
    v_add_u32_dpp v91, v91, v91 row_shr:8 row_mask:0xf bank_mask:0xf bound_ctrl:1
    s_nop 1
    v_add_u32_dpp v91, v91, v91 row_bcast:15 row_mask:0xa bank_mask:0xf
    s_nop 1
    v_add_u32_dpp v91, v91, v91 row_bcast:31 row_mask:0xc bank_mask:0xf
    v_add_u32 v98, v98, v91
    v_readlane_b32 s37, v91, 63
    s_cbranch_vccnz L2_xo16
L2_xp16:
    v_and_b32 v46, 0x80000000, v27
    v_lshrrev_b32 v47, 14, v25
    v_bitop3_b32 v47, v47, v5, v46 bitop3:0xea
    ds_read_b64 v[106:107], v47
    v_and_b32 v99, 0x40000000, v27
    v_lshrrev_b32 v47, 14, v24
    v_bitop3_b32 v47, v47, v5, v99 bitop3:0xea
    ds_read_b64 v[104:105], v47
    s_waitcnt lgkmcnt(2)
    v_cmp_ne_u64 s[50:51], v[72:73], v[68:69]
    v_cmpx_ne_u64 s[54:55], v[74:75], v[70:71]
    s_and_b64 s[82:83], s[54:55], s[80:81]
    s_cbranch_scc1 L2_c17
L2_d17:
    v_mov_b64 v[84:85], v[70:71]
    v_mov_b32 v7, v95
    v_mov_b64 v[86:87], v[74:75]
    s_or_b64 s[80:81], s[80:81], s[54:55]
    s_mov_b64 exec, s[50:51]
    s_and_b64 s[82:83], s[50:51], s[80:81]
    s_cbranch_scc1 L2_c18
L2_d18:
    v_mov_b64 v[84:85], v[68:69]
    v_mov_b32 v7, v94
    v_mov_b64 v[86:87], v[72:73]
    s_mov_b64 exec, -1
    s_or_b64 s[80:81], s[80:81], s[50:51]
    ds_read_b64 v[70:71], v93 offset:65408
    ds_read_b64 v[68:69], v92 offset:65408
    v_bitop3_b32 v94, v24, v5, v99 bitop3:0xea
    v_bitop3_b32 v95, v25, v5, v46 bitop3:0xea
    v_perm_b32 v15, v25, v26, s47
    v_bitop3_b32 v46, v25, 0.5, -0.5 bitop3:0xa8
    v_perm_b32 v14, v24, v26, s46
    v_bitop3_b32 v47, v24, 0.5, -0.5 bitop3:0xa8
    v_bitop3_b32 v15, v6, v15, v46 bitop3:0xca
    v_bitop3_b32 v14, v6, v14, v47 bitop3:0xca
    s_waitcnt lgkmcnt(1)
    v_mfma_f32_4x4x4_16b_bf16 v[80:83], v[10:11], v[70:71], v[80:83]
    s_waitcnt lgkmcnt(0)
    v_mfma_f32_4x4x4_16b_bf16 v[76:79], v[10:11], v[68:69], v[76:79]
    s_nop 2
    v_cvt_pk_bf16_f32 v80, v80, v81
    v_cvt_pk_bf16_f32 v81, v82, v83
    ds_wrxchg_rtn_b64 v[74:75], v93, v[80:81] offset:65408
    v_cvt_pk_bf16_f32 v76, v76, v77
    v_cvt_pk_bf16_f32 v77, v78, v79
    ds_wrxchg_rtn_b64 v[72:73], v92, v[76:77] offset:65408
    v_mfma_f32_4x4x4_16b_bf16 v[80:83], v[8:9], v[106:107], 0
    v_mfma_f32_4x4x4_16b_bf16 v[76:79], v[8:9], v[104:105], 0
    v_cmp_lt_u32 s[84:85], v5, v94
    s_nop 2
    v_pk_mul_f32 v[80:81], v[80:81], v[14:15] op_sel:[0,1] op_sel_hi:[1,1]
    v_pk_mul_f32 v[82:83], v[82:83], v[14:15] op_sel:[0,1] op_sel_hi:[1,1]
    v_pk_mul_f32 v[76:77], v[76:77], v[14:15] op_sel:[0,0] op_sel_hi:[1,0]
    v_pk_mul_f32 v[78:79], v[78:79], v[14:15] op_sel:[0,0] op_sel_hi:[1,0]
    v_and_b32 v47, 0x3f0, v3
    s_cmp_lg_u32 s56, 0
    s_cbranch_scc1 L2_m19
    s_mul_i32 s3, s33, 1280000
    s_add_u32 s3, s3, s38
    s_add_u32 s3, s3, 320000
    buffer_load_dwordx4 v[108:111], v47, s[24:27], s3 offen offset:0
L2_m19:
    v_and_b32 v47, 0x3f0, v3
    s_cmp_lg_u32 s56, 0
    s_cbranch_scc1 L2_m20
    s_mul_i32 s3, s33, 1280000
    s_add_u32 s3, s3, s38
    s_add_u32 s3, s3, 320000
    buffer_load_dwordx4 v[112:115], v47, s[24:27], s3 offen offset:1024
L2_m20:
    v_and_b32 v47, 0x0fffffff, v40
    buffer_load_dwordx2 v[16:17], v47, s[8:11], 0 offen
    buffer_load_dwordx3 v[18:20], v47, s[8:11], 0 offen offset:8
    s_waitcnt vmcnt(2)
    s_mov_b64 exec, s[6:7]
    v_lshrrev_b32 v30, 16, v30
    s_mov_b64 exec, -1
    v_and_b32 v46, 0x20000000, v31
    v_lshrrev_b32 v47, 14, v29
    v_bitop3_b32 v47, v47, v5, v46 bitop3:0xea
    ds_read_b64 v[102:103], v47
    v_and_b32 v99, 0x10000000, v31
    v_lshrrev_b32 v47, 14, v28
    v_bitop3_b32 v47, v47, v5, v99 bitop3:0xea
    ds_read_b64 v[100:101], v47
    s_waitcnt lgkmcnt(2)
    v_cmp_ne_u64 s[50:51], v[72:73], v[68:69]
    v_cmpx_ne_u64 s[54:55], v[74:75], v[70:71]
    s_and_b64 s[82:83], s[54:55], s[80:81]
    s_cbranch_scc1 L2_c21
L2_d21:
    v_mov_b64 v[84:85], v[70:71]
    v_mov_b32 v7, v93
    v_mov_b64 v[86:87], v[74:75]
    s_or_b64 s[80:81], s[80:81], s[54:55]
    s_mov_b64 exec, s[50:51]
    s_and_b64 s[82:83], s[50:51], s[80:81]
    s_cbranch_scc1 L2_c22
L2_d22:
    v_mov_b64 v[84:85], v[68:69]
    v_mov_b32 v7, v92
    v_mov_b64 v[86:87], v[72:73]
    s_mov_b64 exec, -1
    s_or_b64 s[80:81], s[80:81], s[50:51]
    s_and_b64 exec, s[84:85], s[80:81]
    v_mfma_f32_4x4x4_16b_bf16 v[76:79], v[12:13], v[84:85], 0
    v_mov_b32 v94, v7
    s_andn2_b64 s[80:81], s[80:81], s[84:85]
    v_mfma_f32_4x4x4_16b_bf16 v[76:79], v[10:11], v[86:87], v[76:79]
    s_mov_b64 exec, -1
    ds_read_b64 v[70:71], v95 offset:65408
    ds_read_b64 v[68:69], v94 offset:65408
    v_bitop3_b32 v92, v28, v5, v99 bitop3:0xea
    v_bitop3_b32 v93, v29, v5, v46 bitop3:0xea
    v_perm_b32 v15, v29, v30, s45
    v_bitop3_b32 v46, v29, 0.5, -0.5 bitop3:0xa8
    v_perm_b32 v14, v28, v30, s44
    v_bitop3_b32 v47, v28, 0.5, -0.5 bitop3:0xa8
    v_bitop3_b32 v15, v6, v15, v46 bitop3:0xca
    v_bitop3_b32 v14, v6, v14, v47 bitop3:0xca
    s_waitcnt lgkmcnt(1)
    v_mfma_f32_4x4x4_16b_bf16 v[80:83], v[10:11], v[70:71], v[80:83]
    s_waitcnt lgkmcnt(0)
    v_mfma_f32_4x4x4_16b_bf16 v[76:79], v[10:11], v[68:69], v[76:79]
    s_nop 2
    v_cvt_pk_bf16_f32 v80, v80, v81
    v_cvt_pk_bf16_f32 v81, v82, v83
    ds_wrxchg_rtn_b64 v[74:75], v95, v[80:81] offset:65408
    v_cvt_pk_bf16_f32 v76, v76, v77
    v_cvt_pk_bf16_f32 v77, v78, v79
    ds_wrxchg_rtn_b64 v[72:73], v94, v[76:77] offset:65408
    s_setprio 0
    v_mfma_f32_4x4x4_16b_bf16 v[80:83], v[8:9], v[102:103], 0
    v_mfma_f32_4x4x4_16b_bf16 v[76:79], v[8:9], v[100:101], 0
    v_cmp_lt_u32 s[48:49], v5, v93
    s_nop 2
    v_pk_mul_f32 v[80:81], v[80:81], v[14:15] op_sel:[0,1] op_sel_hi:[1,1]
    v_pk_mul_f32 v[82:83], v[82:83], v[14:15] op_sel:[0,1] op_sel_hi:[1,1]
    v_pk_mul_f32 v[76:77], v[76:77], v[14:15] op_sel:[0,0] op_sel_hi:[1,0]
    v_pk_mul_f32 v[78:79], v[78:79], v[14:15] op_sel:[0,0] op_sel_hi:[1,0]
    s_add_u32 s40, s40, 0x50000
    v_and_b32 v47, 0x0fffffff, v41
    buffer_load_dwordx2 v[22:23], v47, s[8:11], 0 offen
    buffer_load_dwordx3 v[24:26], v47, s[8:11], 0 offen offset:8
    v_and_b32 v46, 0x80000000, v39
    v_lshrrev_b32 v47, 14, v37
    v_bitop3_b32 v47, v47, v5, v46 bitop3:0xea
    ds_read_b64 v[102:103], v47
    v_and_b32 v99, 0x40000000, v39
    v_lshrrev_b32 v47, 14, v36
    v_bitop3_b32 v47, v47, v5, v99 bitop3:0xea
    ds_read_b64 v[100:101], v47
    v_and_b32 v46, 0x20000000, v39
    v_lshrrev_b32 v47, 14, v35
    v_bitop3_b32 v47, v47, v5, v46 bitop3:0xea
    ds_read_b64 v[106:107], v47
    v_and_b32 v99, 0x10000000, v39
    v_lshrrev_b32 v47, 14, v34
    v_bitop3_b32 v47, v47, v5, v99 bitop3:0xea
    ds_read_b64 v[104:105], v47
    s_waitcnt lgkmcnt(4)
    v_cmp_ne_u64 s[50:51], v[72:73], v[68:69]
    v_cmpx_ne_u64 s[54:55], v[74:75], v[70:71]
    s_and_b64 s[82:83], s[54:55], s[80:81]
    s_cbranch_scc1 L2_c23
L2_d23:
    v_mov_b64 v[84:85], v[70:71]
    v_mov_b32 v7, v95
    v_mov_b64 v[86:87], v[74:75]
    s_or_b64 s[80:81], s[80:81], s[54:55]
    s_mov_b64 exec, s[50:51]
    s_and_b64 s[82:83], s[50:51], s[80:81]
    s_cbranch_scc1 L2_c24
L2_d24:
    v_mov_b64 v[84:85], v[68:69]
    v_mov_b32 v7, v94
    v_mov_b64 v[86:87], v[72:73]
    s_mov_b64 exec, -1
    s_or_b64 s[80:81], s[80:81], s[50:51]
    s_and_b64 exec, s[48:49], s[80:81]
    v_mfma_f32_4x4x4_16b_bf16 v[80:83], v[12:13], v[84:85], 0
    v_mov_b32 v93, v7
    s_andn2_b64 s[80:81], s[80:81], s[48:49]
    v_mfma_f32_4x4x4_16b_bf16 v[80:83], v[10:11], v[86:87], v[80:83]
    s_mov_b64 exec, -1
    ds_read_b64 v[70:71], v93 offset:65408
    ds_read_b64 v[68:69], v92 offset:65408
    v_bitop3_b32 v94, v34, v5, v99 bitop3:0xea
    v_bitop3_b32 v95, v35, v5, v46 bitop3:0xea
    v_perm_b32 v15, v35, v38, s45
    v_bitop3_b32 v46, v35, 0.5, -0.5 bitop3:0xa8
    v_perm_b32 v14, v34, v38, s44
    v_bitop3_b32 v47, v34, 0.5, -0.5 bitop3:0xa8
    v_bitop3_b32 v15, v6, v15, v46 bitop3:0xca
    v_bitop3_b32 v14, v6, v14, v47 bitop3:0xca
    s_waitcnt lgkmcnt(1)
    v_mfma_f32_4x4x4_16b_bf16 v[80:83], v[10:11], v[70:71], v[80:83]
    s_waitcnt lgkmcnt(0)
    v_mfma_f32_4x4x4_16b_bf16 v[76:79], v[10:11], v[68:69], v[76:79]
    s_nop 2
    v_cvt_pk_bf16_f32 v80, v80, v81
    v_cvt_pk_bf16_f32 v81, v82, v83
    ds_wrxchg_rtn_b64 v[74:75], v93, v[80:81] offset:65408
    v_cvt_pk_bf16_f32 v76, v76, v77
    v_cvt_pk_bf16_f32 v77, v78, v79
    ds_wrxchg_rtn_b64 v[72:73], v92, v[76:77] offset:65408
    s_barrier
    s_setprio 3
    s_waitcnt vmcnt(4)
    v_subrev_u32 v88, s38, v3
    ds_write_b128 v88, v[124:127] offset:34816
    s_add_u32 s3, s40, 4096
    buffer_load_dwordx4 v[124:127], v3, s[16:19], s3 offen sc1
    s_waitcnt vmcnt(5)
    v_subrev_u32 v88, s38, v3
    ds_write_b128 v88, v[116:119] offset:32768
    buffer_load_dwordx4 v[116:119], v3, s[16:19], s40 offen offset:2048 sc1
    s_waitcnt vmcnt(6)
    v_subrev_u32 v88, s38, v3
    ds_write_b128 v88, v[120:123] offset:33792
    buffer_load_dwordx4 v[120:123], v3, s[16:19], s40 offen offset:3072 sc1
    v_mfma_f32_4x4x4_16b_bf16 v[80:83], v[8:9], v[106:107], 0
    v_mfma_f32_4x4x4_16b_bf16 v[76:79], v[8:9], v[104:105], 0
    s_nop 3
    v_pk_mul_f32 v[80:81], v[80:81], v[14:15] op_sel:[0,1] op_sel_hi:[1,1]
    v_pk_mul_f32 v[82:83], v[82:83], v[14:15] op_sel:[0,1] op_sel_hi:[1,1]
    v_pk_mul_f32 v[76:77], v[76:77], v[14:15] op_sel:[0,0] op_sel_hi:[1,0]
    v_pk_mul_f32 v[78:79], v[78:79], v[14:15] op_sel:[0,0] op_sel_hi:[1,0]
    v_and_b32 v47, 0x0fffffff, v42
    buffer_load_dword v30, v47, s[8:11], 0 offen offset:16
    s_mov_b64 exec, s[6:7]
    v_add_u32 v47, 8, v47
    v_lshrrev_b32 v42, 2, v42
    s_mov_b64 exec, -1
    buffer_load_dwordx2 v[28:29], v47, s[8:11], 0 offen
    s_cmp_gt_u32 s37, 1024
    s_cbranch_scc1 L2_xs25
    s_cmp_lg_u32 s101, 0
    s_cbranch_scc1 L2_xa25
L2_xb25:
    v_lshlrev_b32 v89, 16, v96
    v_add_u32 v90, 60, v97
    v_bitop3_b32 v90, v89, v45, v90 bitop3:0x6a
    ds_write_b32 v98, v90 offset:12
    v_lshlrev_b32 v89, 20, v96
    v_add_u32 v90, 40, v97
    v_bitop3_b32 v90, v89, v45, v90 bitop3:0x6a
    ds_write_b32 v98, v90 offset:8
    v_lshlrev_b32 v89, 24, v96
    v_add_u32 v90, 20, v97
    v_bitop3_b32 v90, v89, v45, v90 bitop3:0x6a
    ds_write_b32 v98, v90 offset:4
    v_lshlrev_b32 v89, 28, v96
    v_bitop3_b32 v90, v89, v45, v97 bitop3:0x6a
    ds_write_b32 v98, v90 offset:0
    v_mov_b32_dpp v91, v64 quad_perm:[1,1,1,1] row_mask:0xf bank_mask:0xf
    v_and_b32 v89, 3, v91
    v_and_b32 v97, 0xfffc, v91
    v_sub_u16_dpp v88, v64, v91 quad_perm:[3,3,3,3] row_mask:0xf bank_mask:0xf
    v_mad_u32_u24 v97, v97, 5, v4
    v_add_u32 v99, v88, v89
    v_bfm_b32 v96, v88, v89
    v_cmp_lt_u32 s[58:59], 16, v99
    v_lshlrev_b32 v89, v1, v96
    v_and_b32 v89, v45, v89
    v_cmp_ne_u32 vcc, 0, v89
    v_xor_b32 v90, v97, v89
    s_add_u32 s3, s37, s38
    v_mbcnt_lo_u32_b32 v98, vcc_lo, 0
    v_mbcnt_hi_u32_b32 v98, vcc_hi, v98
    s_bcnt1_i32_b64 s41, vcc
    v_lshl_add_u32 v98, v98, 2, s3
    s_lshl2_add_u32 s37, s41, s37
    s_mov_b64 exec, vcc
    ds_write_b32 v98, v90
    s_mov_b64 exec, -1
    s_cmp_lg_u64 s[58:59], 0
    s_cbranch_scc1 L2_xe25
L2_xr25:
    v_add_u32 v98, s37, v0
    v_mov_b32 v90, -1
    ds_write_b32 v98, v90
L2_xw25:
    s_setprio 2
    s_waitcnt lgkmcnt(9)
    v_cmp_ne_u64 s[50:51], v[72:73], v[68:69]
    v_cmpx_ne_u64 s[54:55], v[74:75], v[70:71]
    s_and_b64 s[82:83], s[54:55], s[80:81]
    s_cbranch_scc1 L2_c26
L2_d26:
    v_mov_b64 v[84:85], v[70:71]
    v_mov_b32 v7, v93
    v_mov_b64 v[86:87], v[74:75]
    s_or_b64 s[80:81], s[80:81], s[54:55]
    s_mov_b64 exec, s[50:51]
    s_and_b64 s[82:83], s[50:51], s[80:81]
    s_cbranch_scc1 L2_c27
L2_d27:
    v_mov_b64 v[84:85], v[68:69]
    v_mov_b32 v7, v92
    v_mov_b64 v[86:87], v[72:73]
    s_mov_b64 exec, -1
    s_or_b64 s[80:81], s[80:81], s[50:51]
    ds_read_b64 v[70:71], v95 offset:65408
    ds_read_b64 v[68:69], v94 offset:65408
    v_and_b32 v46, 0x40000000, v39
    v_bitop3_b32 v92, v36, v5, v46 bitop3:0xea
    v_and_b32 v46, 0x80000000, v39
    v_bitop3_b32 v93, v37, v5, v46 bitop3:0xea
    v_perm_b32 v15, v37, v38, s47
    v_bitop3_b32 v46, v37, 0.5, -0.5 bitop3:0xa8
    v_perm_b32 v14, v36, v38, s46
    v_bitop3_b32 v47, v36, 0.5, -0.5 bitop3:0xa8
    v_bitop3_b32 v15, v6, v15, v46 bitop3:0xca
    v_bitop3_b32 v14, v6, v14, v47 bitop3:0xca
    s_setprio 1
    s_waitcnt lgkmcnt(1)
    v_mfma_f32_4x4x4_16b_bf16 v[80:83], v[10:11], v[70:71], v[80:83]
    s_waitcnt lgkmcnt(0)
    v_mfma_f32_4x4x4_16b_bf16 v[76:79], v[10:11], v[68:69], v[76:79]
    s_nop 2
    v_cvt_pk_bf16_f32 v80, v80, v81
    v_cvt_pk_bf16_f32 v81, v82, v83
    ds_wrxchg_rtn_b64 v[74:75], v95, v[80:81] offset:65408
    v_cvt_pk_bf16_f32 v76, v76, v77
    v_cvt_pk_bf16_f32 v77, v78, v79
    ds_wrxchg_rtn_b64 v[72:73], v94, v[76:77] offset:65408
    ds_read_b32 v21, v0 offset:0
    ds_read_b32 v27, v0 offset:256
    ds_read_b32 v31, v44 offset:768
    ds_read_b32 v39, v0 offset:512
    s_sub_u32 s3, s37, 768
    s_cmp_gt_u32 s3, 128
    s_cbranch_scc1 L2_xf25
L2_xg25:
    v_and_b32 v88, 0x0fffffff, v43
    buffer_load_dwordx2 v[34:35], v88, s[8:11], 0 offen
    buffer_load_dwordx3 v[36:38], v88, s[8:11], 0 offen offset:8
    s_setprio 0
    s_waitcnt vmcnt(11)
    v_subrev_u32 v88, s100, v3
    ds_write_b128 v88, v[108:111] offset:0
    s_waitcnt vmcnt(11)
    v_subrev_u32 v88, s100, v3
    ds_write_b128 v88, v[112:115] offset:1024
    v_mfma_f32_4x4x4_16b_bf16 v[80:83], v[8:9], v[102:103], 0
    v_mfma_f32_4x4x4_16b_bf16 v[76:79], v[8:9], v[100:101], 0
    v_cmp_lt_u32 s[84:85], v5, v92
    s_nop 2
    v_pk_mul_f32 v[80:81], v[80:81], v[14:15] op_sel:[0,1] op_sel_hi:[1,1]
    v_pk_mul_f32 v[82:83], v[82:83], v[14:15] op_sel:[0,1] op_sel_hi:[1,1]
    v_pk_mul_f32 v[76:77], v[76:77], v[14:15] op_sel:[0,0] op_sel_hi:[1,0]
    v_pk_mul_f32 v[78:79], v[78:79], v[14:15] op_sel:[0,0] op_sel_hi:[1,0]
    s_add_u32 s42, s42, 1
    s_waitcnt lgkmcnt(0)
    s_add_u32 s24, s30, 0xec45000
    s_addc_u32 s25, s31, 0
    s_mov_b32 s26, 0x100
    s_mov_b32 s27, 0x20000
    s_barrier
    s_bitcmp1_b32 s36, s42
    s_cbranch_scc1 L2_slow
L2_ret1:
    s_setprio 3
    s_bitcmp1_b32 s43, s42
    s_cbranch_scc1 L2_oa28
L2_ob28:
    s_waitcnt vmcnt(9)
    v_and_b32 v46, 0x20000000, v40
    v_lshrrev_b32 v47, 14, v17
    v_bitop3_b32 v47, v47, v5, v46 bitop3:0xea
    ds_read_b64 v[106:107], v47
    v_and_b32 v99, 0x10000000, v40
    v_lshrrev_b32 v47, 14, v16
    v_bitop3_b32 v47, v47, v5, v99 bitop3:0xea
    ds_read_b64 v[104:105], v47
    v_cmp_ne_u64 s[50:51], v[72:73], v[68:69]
    v_cmpx_ne_u64 s[54:55], v[74:75], v[70:71]
    s_and_b64 s[82:83], s[54:55], s[80:81]
    s_cbranch_scc1 L2_c29
L2_d29:
    v_mov_b64 v[84:85], v[70:71]
    v_mov_b32 v7, v95
    v_mov_b64 v[86:87], v[74:75]
    s_or_b64 s[80:81], s[80:81], s[54:55]
    s_mov_b64 exec, s[50:51]
    s_and_b64 s[82:83], s[50:51], s[80:81]
    s_cbranch_scc1 L2_c30
L2_d30:
    v_mov_b64 v[84:85], v[68:69]
    v_mov_b32 v7, v94
    v_mov_b64 v[86:87], v[72:73]
    s_mov_b64 exec, -1
    s_or_b64 s[80:81], s[80:81], s[50:51]
    s_and_b64 exec, s[84:85], s[80:81]
    v_mfma_f32_4x4x4_16b_bf16 v[76:79], v[12:13], v[84:85], 0
    v_mov_b32 v92, v7
    s_andn2_b64 s[80:81], s[80:81], s[84:85]
    v_mfma_f32_4x4x4_16b_bf16 v[76:79], v[10:11], v[86:87], v[76:79]
    s_mov_b64 exec, -1
    ds_read_b64 v[70:71], v93 offset:65408
    ds_read_b64 v[68:69], v92 offset:65408
    v_bitop3_b32 v94, v16, v5, v99 bitop3:0xea
    v_bitop3_b32 v95, v17, v5, v46 bitop3:0xea
    v_perm_b32 v15, v17, v20, s45
    v_bitop3_b32 v46, v17, 0.5, -0.5 bitop3:0xa8
    v_perm_b32 v14, v16, v20, s44
    v_bitop3_b32 v47, v16, 0.5, -0.5 bitop3:0xa8
    v_bitop3_b32 v15, v6, v15, v46 bitop3:0xca
    v_bitop3_b32 v14, v6, v14, v47 bitop3:0xca
    s_waitcnt lgkmcnt(1)
    v_mfma_f32_4x4x4_16b_bf16 v[80:83], v[10:11], v[70:71], v[80:83]
    s_waitcnt lgkmcnt(0)
    v_mfma_f32_4x4x4_16b_bf16 v[76:79], v[10:11], v[68:69], v[76:79]
    s_nop 2
    v_cvt_pk_bf16_f32 v80, v80, v81
    v_cvt_pk_bf16_f32 v81, v82, v83
    ds_wrxchg_rtn_b64 v[74:75], v93, v[80:81] offset:65408
    v_cvt_pk_bf16_f32 v76, v76, v77
    v_cvt_pk_bf16_f32 v77, v78, v79
    ds_wrxchg_rtn_b64 v[72:73], v92, v[76:77] offset:65408
    v_mfma_f32_4x4x4_16b_bf16 v[80:83], v[8:9], v[106:107], 0
    v_mfma_f32_4x4x4_16b_bf16 v[76:79], v[8:9], v[104:105], 0
    v_cmp_lt_u32 s[84:85], v5, v94
    s_nop 2
    v_pk_mul_f32 v[80:81], v[80:81], v[14:15] op_sel:[0,1] op_sel_hi:[1,1]
    v_pk_mul_f32 v[82:83], v[82:83], v[14:15] op_sel:[0,1] op_sel_hi:[1,1]
    v_pk_mul_f32 v[76:77], v[76:77], v[14:15] op_sel:[0,0] op_sel_hi:[1,0]
    v_pk_mul_f32 v[78:79], v[78:79], v[14:15] op_sel:[0,0] op_sel_hi:[1,0]
    buffer_load_dwordx4 v[108:111], v3, s[16:19], s40 offen offset:0 sc1
    v_and_b32 v46, 0x80000000, v40
    v_lshrrev_b32 v47, 14, v19
    v_bitop3_b32 v47, v47, v5, v46 bitop3:0xea
    ds_read_b64 v[102:103], v47
    v_and_b32 v99, 0x40000000, v40
    v_lshrrev_b32 v47, 14, v18
    v_bitop3_b32 v47, v47, v5, v99 bitop3:0xea
    ds_read_b64 v[100:101], v47
    s_waitcnt lgkmcnt(2)
    v_cmp_ne_u64 s[50:51], v[72:73], v[68:69]
    v_cmpx_ne_u64 s[54:55], v[74:75], v[70:71]
    s_and_b64 s[82:83], s[54:55], s[80:81]
    s_cbranch_scc1 L2_c31
L2_d31:
    v_mov_b64 v[84:85], v[70:71]
    v_mov_b32 v7, v93
    v_mov_b64 v[86:87], v[74:75]
    s_or_b64 s[80:81], s[80:81], s[54:55]
    s_mov_b64 exec, s[50:51]
    s_and_b64 s[82:83], s[50:51], s[80:81]
    s_cbranch_scc1 L2_c32
L2_d32:
    v_mov_b64 v[84:85], v[68:69]
    v_mov_b32 v7, v92
    v_mov_b64 v[86:87], v[72:73]
    s_mov_b64 exec, -1
    s_or_b64 s[80:81], s[80:81], s[50:51]
    s_and_b64 exec, s[84:85], s[80:81]
    v_mfma_f32_4x4x4_16b_bf16 v[76:79], v[12:13], v[84:85], 0
    v_mov_b32 v94, v7
    s_andn2_b64 s[80:81], s[80:81], s[84:85]
    v_mfma_f32_4x4x4_16b_bf16 v[76:79], v[10:11], v[86:87], v[76:79]
    s_mov_b64 exec, -1
    ds_read_b64 v[70:71], v95 offset:65408
    ds_read_b64 v[68:69], v94 offset:65408
    v_bitop3_b32 v92, v18, v5, v99 bitop3:0xea
    v_bitop3_b32 v93, v19, v5, v46 bitop3:0xea
    v_perm_b32 v15, v19, v20, s47
    v_bitop3_b32 v46, v19, 0.5, -0.5 bitop3:0xa8
    v_perm_b32 v14, v18, v20, s46
    v_bitop3_b32 v47, v18, 0.5, -0.5 bitop3:0xa8
    v_bitop3_b32 v15, v6, v15, v46 bitop3:0xca
    v_bitop3_b32 v14, v6, v14, v47 bitop3:0xca
    s_waitcnt lgkmcnt(1)
    v_mfma_f32_4x4x4_16b_bf16 v[80:83], v[10:11], v[70:71], v[80:83]
    s_waitcnt lgkmcnt(0)
    v_mfma_f32_4x4x4_16b_bf16 v[76:79], v[10:11], v[68:69], v[76:79]
    s_nop 2
    v_cvt_pk_bf16_f32 v80, v80, v81
    v_cvt_pk_bf16_f32 v81, v82, v83
    ds_wrxchg_rtn_b64 v[74:75], v95, v[80:81] offset:65408
    v_cvt_pk_bf16_f32 v76, v76, v77
    v_cvt_pk_bf16_f32 v77, v78, v79
    ds_wrxchg_rtn_b64 v[72:73], v94, v[76:77] offset:65408
    v_and_b32 v88, 0x0fffffff, v21
    buffer_load_dwordx2 v[16:17], v88, s[8:11], 0 offen
    buffer_load_dwordx3 v[18:20], v88, s[8:11], 0 offen offset:8
    s_setprio 2
    v_mfma_f32_4x4x4_16b_bf16 v[80:83], v[8:9], v[102:103], 0
    v_mfma_f32_4x4x4_16b_bf16 v[76:79], v[8:9], v[100:101], 0
    v_cmp_lt_u32 s[48:49], v5, v93
    s_nop 2
    v_pk_mul_f32 v[80:81], v[80:81], v[14:15] op_sel:[0,1] op_sel_hi:[1,1]
    v_pk_mul_f32 v[82:83], v[82:83], v[14:15] op_sel:[0,1] op_sel_hi:[1,1]
    v_pk_mul_f32 v[76:77], v[76:77], v[14:15] op_sel:[0,0] op_sel_hi:[1,0]
    v_pk_mul_f32 v[78:79], v[78:79], v[14:15] op_sel:[0,0] op_sel_hi:[1,0]
    s_waitcnt vmcnt(10)
    v_and_b32 v46, 0x20000000, v41
    v_lshrrev_b32 v47, 14, v23
    v_bitop3_b32 v47, v47, v5, v46 bitop3:0xea
    ds_read_b64 v[106:107], v47
    v_and_b32 v99, 0x10000000, v41
    v_lshrrev_b32 v47, 14, v22
    v_bitop3_b32 v47, v47, v5, v99 bitop3:0xea
    ds_read_b64 v[104:105], v47
    s_waitcnt lgkmcnt(2)
    v_cmp_ne_u64 s[50:51], v[72:73], v[68:69]
    v_cmpx_ne_u64 s[54:55], v[74:75], v[70:71]
    s_and_b64 s[82:83], s[54:55], s[80:81]
    s_cbranch_scc1 L2_c33
L2_d33:
    v_mov_b64 v[84:85], v[70:71]
    v_mov_b32 v7, v95
    v_mov_b64 v[86:87], v[74:75]
    s_or_b64 s[80:81], s[80:81], s[54:55]
    s_mov_b64 exec, s[50:51]
    s_and_b64 s[82:83], s[50:51], s[80:81]
    s_cbranch_scc1 L2_c34
L2_d34:
    v_mov_b64 v[84:85], v[68:69]
    v_mov_b32 v7, v94
    v_mov_b64 v[86:87], v[72:73]
    s_mov_b64 exec, -1
    s_or_b64 s[80:81], s[80:81], s[50:51]
    s_and_b64 exec, s[48:49], s[80:81]
    v_mfma_f32_4x4x4_16b_bf16 v[80:83], v[12:13], v[84:85], 0
    v_mov_b32 v93, v7
    s_andn2_b64 s[80:81], s[80:81], s[48:49]
    v_mfma_f32_4x4x4_16b_bf16 v[80:83], v[10:11], v[86:87], v[80:83]
    s_mov_b64 exec, -1
    ds_read_b64 v[70:71], v93 offset:65408
    ds_read_b64 v[68:69], v92 offset:65408
    v_bitop3_b32 v94, v22, v5, v99 bitop3:0xea
    v_bitop3_b32 v95, v23, v5, v46 bitop3:0xea
    v_perm_b32 v15, v23, v26, s45
    v_bitop3_b32 v46, v23, 0.5, -0.5 bitop3:0xa8
    v_perm_b32 v14, v22, v26, s44
    v_bitop3_b32 v47, v22, 0.5, -0.5 bitop3:0xa8
    v_bitop3_b32 v15, v6, v15, v46 bitop3:0xca
    v_bitop3_b32 v14, v6, v14, v47 bitop3:0xca
    s_waitcnt lgkmcnt(1)
    v_mfma_f32_4x4x4_16b_bf16 v[80:83], v[10:11], v[70:71], v[80:83]
    s_waitcnt lgkmcnt(0)
    v_mfma_f32_4x4x4_16b_bf16 v[76:79], v[10:11], v[68:69], v[76:79]
    s_nop 2
    v_cvt_pk_bf16_f32 v80, v80, v81
    v_cvt_pk_bf16_f32 v81, v82, v83
    ds_wrxchg_rtn_b64 v[74:75], v93, v[80:81] offset:65408
    v_cvt_pk_bf16_f32 v76, v76, v77
    v_cvt_pk_bf16_f32 v77, v78, v79
    ds_wrxchg_rtn_b64 v[72:73], v92, v[76:77] offset:65408
    s_setprio 1
    v_mfma_f32_4x4x4_16b_bf16 v[80:83], v[8:9], v[106:107], 0
    v_mfma_f32_4x4x4_16b_bf16 v[76:79], v[8:9], v[104:105], 0
    s_nop 3
    v_pk_mul_f32 v[80:81], v[80:81], v[14:15] op_sel:[0,1] op_sel_hi:[1,1]
    v_pk_mul_f32 v[82:83], v[82:83], v[14:15] op_sel:[0,1] op_sel_hi:[1,1]
    v_pk_mul_f32 v[76:77], v[76:77], v[14:15] op_sel:[0,0] op_sel_hi:[1,0]
    v_pk_mul_f32 v[78:79], v[78:79], v[14:15] op_sel:[0,0] op_sel_hi:[1,0]
    s_bitcmp1_b32 s43, s42
    s_cbranch_scc1 L2_oa35
L2_ob35:
    buffer_load_dwordx4 v[112:115], v3, s[16:19], s40 offen offset:1024 sc1
    v_sub_u16 v88, v62, v54
    v_and_b32 v89, 3, v54
    v_add3_u32 v99, v88, v89, 3
    v_and_b32 v99, -4, v99
    v_max_u32 v99, 4, v99
    v_and_b32 v97, 0xfffc, v54
    v_bfm_b32 v96, v88, v89
    v_add_u32_dpp v91, v99, v99 row_shr:1 row_mask:0xf bank_mask:0xf bound_ctrl:1
    v_mad_u32_u24 v97, v97, 5, v2
    v_cmp_lt_u32 vcc, 16, v99
    v_add_u32_dpp v91, v91, v91 row_shr:2 row_mask:0xf bank_mask:0xf bound_ctrl:1
    v_sub_u32 v98, s38, v99
    v_lshrrev_b64 v[54:55], 16, v[54:55]
    v_add_u32_dpp v91, v91, v91 row_shr:4 row_mask:0xf bank_mask:0xf bound_ctrl:1
    v_lshrrev_b64 v[62:63], 16, v[62:63]
    s_mov_b32 s101, 0
    v_add_u32_dpp v91, v91, v91 row_shr:8 row_mask:0xf bank_mask:0xf bound_ctrl:1
    s_nop 1
    v_add_u32_dpp v91, v91, v91 row_bcast:15 row_mask:0xa bank_mask:0xf
    s_nop 1
    v_add_u32_dpp v91, v91, v91 row_bcast:31 row_mask:0xc bank_mask:0xf
    v_add_u32 v98, v98, v91
    v_readlane_b32 s37, v91, 63
    s_cbranch_vccnz L2_xo36
L2_xp36:
    v_and_b32 v46, 0x80000000, v41
    v_lshrrev_b32 v47, 14, v25
    v_bitop3_b32 v47, v47, v5, v46 bitop3:0xea
    ds_read_b64 v[102:103], v47
    v_and_b32 v99, 0x40000000, v41
    v_lshrrev_b32 v47, 14, v24
    v_bitop3_b32 v47, v47, v5, v99 bitop3:0xea
    ds_read_b64 v[100:101], v47
    s_waitcnt lgkmcnt(2)
    v_cmp_ne_u64 s[50:51], v[72:73], v[68:69]
    v_cmpx_ne_u64 s[54:55], v[74:75], v[70:71]
    s_and_b64 s[82:83], s[54:55], s[80:81]
    s_cbranch_scc1 L2_c37
L2_d37:
    v_mov_b64 v[84:85], v[70:71]
    v_mov_b32 v7, v93
    v_mov_b64 v[86:87], v[74:75]
    s_or_b64 s[80:81], s[80:81], s[54:55]
    s_mov_b64 exec, s[50:51]
    s_and_b64 s[82:83], s[50:51], s[80:81]
    s_cbranch_scc1 L2_c38
L2_d38:
    v_mov_b64 v[84:85], v[68:69]
    v_mov_b32 v7, v92
    v_mov_b64 v[86:87], v[72:73]
    s_mov_b64 exec, -1
    s_or_b64 s[80:81], s[80:81], s[50:51]
    ds_read_b64 v[70:71], v95 offset:65408
    ds_read_b64 v[68:69], v94 offset:65408
    v_bitop3_b32 v92, v24, v5, v99 bitop3:0xea
    v_bitop3_b32 v93, v25, v5, v46 bitop3:0xea
    v_perm_b32 v15, v25, v26, s47
    v_bitop3_b32 v46, v25, 0.5, -0.5 bitop3:0xa8
    v_perm_b32 v14, v24, v26, s46
    v_bitop3_b32 v47, v24, 0.5, -0.5 bitop3:0xa8
    v_bitop3_b32 v15, v6, v15, v46 bitop3:0xca
    v_bitop3_b32 v14, v6, v14, v47 bitop3:0xca
    s_waitcnt lgkmcnt(1)
    v_mfma_f32_4x4x4_16b_bf16 v[80:83], v[10:11], v[70:71], v[80:83]
    s_waitcnt lgkmcnt(0)
    v_mfma_f32_4x4x4_16b_bf16 v[76:79], v[10:11], v[68:69], v[76:79]
    s_nop 2
    v_cvt_pk_bf16_f32 v80, v80, v81
    v_cvt_pk_bf16_f32 v81, v82, v83
    ds_wrxchg_rtn_b64 v[74:75], v95, v[80:81] offset:65408
    v_cvt_pk_bf16_f32 v76, v76, v77
    v_cvt_pk_bf16_f32 v77, v78, v79
    ds_wrxchg_rtn_b64 v[72:73], v94, v[76:77] offset:65408
    v_and_b32 v88, 0x0fffffff, v27
    buffer_load_dwordx2 v[22:23], v88, s[8:11], 0 offen
    buffer_load_dwordx3 v[24:26], v88, s[8:11], 0 offen offset:8
    v_mfma_f32_4x4x4_16b_bf16 v[80:83], v[8:9], v[102:103], 0
    v_mfma_f32_4x4x4_16b_bf16 v[76:79], v[8:9], v[100:101], 0
    v_cmp_lt_u32 s[84:85], v5, v92
    s_nop 2
    v_pk_mul_f32 v[80:81], v[80:81], v[14:15] op_sel:[0,1] op_sel_hi:[1,1]
    v_pk_mul_f32 v[82:83], v[82:83], v[14:15] op_sel:[0,1] op_sel_hi:[1,1]
    v_pk_mul_f32 v[76:77], v[76:77], v[14:15] op_sel:[0,0] op_sel_hi:[1,0]
    v_pk_mul_f32 v[78:79], v[78:79], v[14:15] op_sel:[0,0] op_sel_hi:[1,0]
    s_waitcnt vmcnt(8)
    s_mov_b64 exec, s[6:7]
    v_lshrrev_b32 v30, 16, v30
    s_mov_b64 exec, -1
    v_and_b32 v46, 0x20000000, v42
    v_lshrrev_b32 v47, 14, v29
    v_bitop3_b32 v47, v47, v5, v46 bitop3:0xea
    ds_read_b64 v[106:107], v47
    v_and_b32 v99, 0x10000000, v42
    v_lshrrev_b32 v47, 14, v28
    v_bitop3_b32 v47, v47, v5, v99 bitop3:0xea
    ds_read_b64 v[104:105], v47
    s_waitcnt lgkmcnt(2)
    v_cmp_ne_u64 s[50:51], v[72:73], v[68:69]
    v_cmpx_ne_u64 s[54:55], v[74:75], v[70:71]
    s_and_b64 s[82:83], s[54:55], s[80:81]
    s_cbranch_scc1 L2_c39
L2_d39:
    v_mov_b64 v[84:85], v[70:71]
    v_mov_b32 v7, v95
    v_mov_b64 v[86:87], v[74:75]
    s_or_b64 s[80:81], s[80:81], s[54:55]
    s_mov_b64 exec, s[50:51]
    s_and_b64 s[82:83], s[50:51], s[80:81]
    s_cbranch_scc1 L2_c40
L2_d40:
    v_mov_b64 v[84:85], v[68:69]
    v_mov_b32 v7, v94
    v_mov_b64 v[86:87], v[72:73]
    s_mov_b64 exec, -1
    s_or_b64 s[80:81], s[80:81], s[50:51]
    s_and_b64 exec, s[84:85], s[80:81]
    v_mfma_f32_4x4x4_16b_bf16 v[76:79], v[12:13], v[84:85], 0
    v_mov_b32 v92, v7
    s_andn2_b64 s[80:81], s[80:81], s[84:85]
    v_mfma_f32_4x4x4_16b_bf16 v[76:79], v[10:11], v[86:87], v[76:79]
    s_mov_b64 exec, -1
    ds_read_b64 v[70:71], v93 offset:65408
    ds_read_b64 v[68:69], v92 offset:65408
    v_bitop3_b32 v94, v28, v5, v99 bitop3:0xea
    v_bitop3_b32 v95, v29, v5, v46 bitop3:0xea
    v_perm_b32 v15, v29, v30, s45
    v_bitop3_b32 v46, v29, 0.5, -0.5 bitop3:0xa8
    v_perm_b32 v14, v28, v30, s44
    v_bitop3_b32 v47, v28, 0.5, -0.5 bitop3:0xa8
    v_bitop3_b32 v15, v6, v15, v46 bitop3:0xca
    v_bitop3_b32 v14, v6, v14, v47 bitop3:0xca
    s_waitcnt lgkmcnt(1)
    v_mfma_f32_4x4x4_16b_bf16 v[80:83], v[10:11], v[70:71], v[80:83]
    s_waitcnt lgkmcnt(0)
    v_mfma_f32_4x4x4_16b_bf16 v[76:79], v[10:11], v[68:69], v[76:79]
    s_nop 2
    v_cvt_pk_bf16_f32 v80, v80, v81
    v_cvt_pk_bf16_f32 v81, v82, v83
    ds_wrxchg_rtn_b64 v[74:75], v93, v[80:81] offset:65408
    v_cvt_pk_bf16_f32 v76, v76, v77
    v_cvt_pk_bf16_f32 v77, v78, v79
    ds_wrxchg_rtn_b64 v[72:73], v92, v[76:77] offset:65408
    s_setprio 0
    v_mfma_f32_4x4x4_16b_bf16 v[80:83], v[8:9], v[106:107], 0
    v_mfma_f32_4x4x4_16b_bf16 v[76:79], v[8:9], v[104:105], 0
    v_cmp_lt_u32 s[48:49], v5, v95
    s_nop 2
    v_pk_mul_f32 v[80:81], v[80:81], v[14:15] op_sel:[0,1] op_sel_hi:[1,1]
    v_pk_mul_f32 v[82:83], v[82:83], v[14:15] op_sel:[0,1] op_sel_hi:[1,1]
    v_pk_mul_f32 v[76:77], v[76:77], v[14:15] op_sel:[0,0] op_sel_hi:[1,0]
    v_pk_mul_f32 v[78:79], v[78:79], v[14:15] op_sel:[0,0] op_sel_hi:[1,0]
    s_add_u32 s40, s40, 0x50000
    v_and_b32 v47, 0x0fffffff, v31
    buffer_load_dword v30, v47, s[8:11], 0 offen offset:16
    s_mov_b64 exec, s[6:7]
    v_add_u32 v47, 8, v47
    v_lshrrev_b32 v31, 2, v31
    s_mov_b64 exec, -1
    buffer_load_dwordx2 v[28:29], v47, s[8:11], 0 offen
    s_waitcnt vmcnt(8)
    v_and_b32 v46, 0x80000000, v43
    v_lshrrev_b32 v47, 14, v37
    v_bitop3_b32 v47, v47, v5, v46 bitop3:0xea
    ds_read_b64 v[106:107], v47
    v_and_b32 v99, 0x40000000, v43
    v_lshrrev_b32 v47, 14, v36
    v_bitop3_b32 v47, v47, v5, v99 bitop3:0xea
    ds_read_b64 v[104:105], v47
    v_and_b32 v46, 0x20000000, v43
    v_lshrrev_b32 v47, 14, v35
    v_bitop3_b32 v47, v47, v5, v46 bitop3:0xea
    ds_read_b64 v[102:103], v47
    v_and_b32 v99, 0x10000000, v43
    v_lshrrev_b32 v47, 14, v34
    v_bitop3_b32 v47, v47, v5, v99 bitop3:0xea
    ds_read_b64 v[100:101], v47
    s_waitcnt lgkmcnt(4)
    v_cmp_ne_u64 s[50:51], v[72:73], v[68:69]
    v_cmpx_ne_u64 s[54:55], v[74:75], v[70:71]
    s_and_b64 s[82:83], s[54:55], s[80:81]
    s_cbranch_scc1 L2_c41
L2_d41:
    v_mov_b64 v[84:85], v[70:71]
    v_mov_b32 v7, v93
    v_mov_b64 v[86:87], v[74:75]
    s_or_b64 s[80:81], s[80:81], s[54:55]
    s_mov_b64 exec, s[50:51]
    s_and_b64 s[82:83], s[50:51], s[80:81]
    s_cbranch_scc1 L2_c42
L2_d42:
    v_mov_b64 v[84:85], v[68:69]
    v_mov_b32 v7, v92
    v_mov_b64 v[86:87], v[72:73]
    s_mov_b64 exec, -1
    s_or_b64 s[80:81], s[80:81], s[50:51]
    s_and_b64 exec, s[48:49], s[80:81]
    v_mfma_f32_4x4x4_16b_bf16 v[80:83], v[12:13], v[84:85], 0
    v_mov_b32 v95, v7
    s_andn2_b64 s[80:81], s[80:81], s[48:49]
    v_mfma_f32_4x4x4_16b_bf16 v[80:83], v[10:11], v[86:87], v[80:83]
    s_mov_b64 exec, -1
    ds_read_b64 v[70:71], v95 offset:65408
    ds_read_b64 v[68:69], v94 offset:65408
    v_bitop3_b32 v92, v34, v5, v99 bitop3:0xea
    v_bitop3_b32 v93, v35, v5, v46 bitop3:0xea
    v_perm_b32 v15, v35, v38, s45
    v_bitop3_b32 v46, v35, 0.5, -0.5 bitop3:0xa8
    v_perm_b32 v14, v34, v38, s44
    v_bitop3_b32 v47, v34, 0.5, -0.5 bitop3:0xa8
    v_bitop3_b32 v15, v6, v15, v46 bitop3:0xca
    v_bitop3_b32 v14, v6, v14, v47 bitop3:0xca
    s_waitcnt lgkmcnt(1)
    v_mfma_f32_4x4x4_16b_bf16 v[80:83], v[10:11], v[70:71], v[80:83]
    s_waitcnt lgkmcnt(0)
    v_mfma_f32_4x4x4_16b_bf16 v[76:79], v[10:11], v[68:69], v[76:79]
    s_nop 2
    v_cvt_pk_bf16_f32 v80, v80, v81
    v_cvt_pk_bf16_f32 v81, v82, v83
    ds_wrxchg_rtn_b64 v[74:75], v95, v[80:81] offset:65408
    v_cvt_pk_bf16_f32 v76, v76, v77
    v_cvt_pk_bf16_f32 v77, v78, v79
    ds_wrxchg_rtn_b64 v[72:73], v94, v[76:77] offset:65408
    s_barrier
    s_setprio 3
    s_mov_b32 m0, s100
    s_nop 0
    ds_write_addtid_b32 v124 offset:34816
    ds_write_addtid_b32 v125 offset:35072
    ds_write_addtid_b32 v126 offset:35328
    ds_write_addtid_b32 v127 offset:35584
    s_add_u32 s3, s40, 4096
    buffer_load_dwordx4 v[124:127], v3, s[16:19], s3 offen sc1
    ds_write_addtid_b32 v116 offset:32768
    ds_write_addtid_b32 v117 offset:33024
    ds_write_addtid_b32 v118 offset:33280
    ds_write_addtid_b32 v119 offset:33536
    buffer_load_dwordx4 v[116:119], v3, s[16:19], s40 offen offset:2048 sc1
    ds_write_addtid_b32 v120 offset:33792
    ds_write_addtid_b32 v121 offset:34048
    ds_write_addtid_b32 v122 offset:34304
    ds_write_addtid_b32 v123 offset:34560
    buffer_load_dwordx4 v[120:123], v3, s[16:19], s40 offen offset:3072 sc1
    v_mfma_f32_4x4x4_16b_bf16 v[80:83], v[8:9], v[102:103], 0
    v_mfma_f32_4x4x4_16b_bf16 v[76:79], v[8:9], v[100:101], 0
    s_nop 3
    v_pk_mul_f32 v[80:81], v[80:81], v[14:15] op_sel:[0,1] op_sel_hi:[1,1]
    v_pk_mul_f32 v[82:83], v[82:83], v[14:15] op_sel:[0,1] op_sel_hi:[1,1]
    v_pk_mul_f32 v[76:77], v[76:77], v[14:15] op_sel:[0,0] op_sel_hi:[1,0]
    v_pk_mul_f32 v[78:79], v[78:79], v[14:15] op_sel:[0,0] op_sel_hi:[1,0]
    s_cmp_gt_u32 s37, 1024
    s_cbranch_scc1 L2_xs43
    s_cmp_lg_u32 s101, 0
    s_cbranch_scc1 L2_xa43
L2_xb43:
    v_lshlrev_b32 v89, 16, v96
    v_add_u32 v90, 60, v97
    v_bitop3_b32 v90, v89, v45, v90 bitop3:0x6a
    ds_write_b32 v98, v90 offset:12
    v_lshlrev_b32 v89, 20, v96
    v_add_u32 v90, 40, v97
    v_bitop3_b32 v90, v89, v45, v90 bitop3:0x6a
    ds_write_b32 v98, v90 offset:8
    v_lshlrev_b32 v89, 24, v96
    v_add_u32 v90, 20, v97
    v_bitop3_b32 v90, v89, v45, v90 bitop3:0x6a
    ds_write_b32 v98, v90 offset:4
    v_lshlrev_b32 v89, 28, v96
    v_bitop3_b32 v90, v89, v45, v97 bitop3:0x6a
    ds_write_b32 v98, v90 offset:0
    v_mov_b32_dpp v91, v66 quad_perm:[1,1,1,1] row_mask:0xf bank_mask:0xf
    v_and_b32 v89, 3, v91
    v_and_b32 v97, 0xfffc, v91
    v_sub_u16_dpp v88, v66, v91 quad_perm:[3,3,3,3] row_mask:0xf bank_mask:0xf
    v_mad_u32_u24 v97, v97, 5, v4
    v_add_u32 v99, v88, v89
    v_bfm_b32 v96, v88, v89
    v_cmp_lt_u32 s[58:59], 16, v99
    v_lshlrev_b32 v89, v1, v96
    v_and_b32 v89, v45, v89
    v_cmp_ne_u32 vcc, 0, v89
    v_xor_b32 v90, v97, v89
    s_add_u32 s3, s37, s38
    v_mbcnt_lo_u32_b32 v98, vcc_lo, 0
    v_mbcnt_hi_u32_b32 v98, vcc_hi, v98
    s_bcnt1_i32_b64 s41, vcc
    v_lshl_add_u32 v98, v98, 2, s3
    s_lshl2_add_u32 s37, s41, s37
    s_mov_b64 exec, vcc
    ds_write_b32 v98, v90
    s_mov_b64 exec, -1
    s_cmp_lg_u64 s[58:59], 0
    s_cbranch_scc1 L2_xe43
L2_xr43:
    v_add_u32 v98, s37, v0
    v_mov_b32 v90, -1
    ds_write_b32 v98, v90
L2_xw43:
    s_setprio 2
    s_waitcnt lgkmcnt(14)
    v_cmp_ne_u64 s[50:51], v[72:73], v[68:69]
    v_cmpx_ne_u64 s[54:55], v[74:75], v[70:71]
    s_and_b64 s[82:83], s[54:55], s[80:81]
    s_cbranch_scc1 L2_c44
L2_d44:
    v_mov_b64 v[84:85], v[70:71]
    v_mov_b32 v7, v95
    v_mov_b64 v[86:87], v[74:75]
    s_or_b64 s[80:81], s[80:81], s[54:55]
    s_mov_b64 exec, s[50:51]
    s_and_b64 s[82:83], s[50:51], s[80:81]
    s_cbranch_scc1 L2_c45
L2_d45:
    v_mov_b64 v[84:85], v[68:69]
    v_mov_b32 v7, v94
    v_mov_b64 v[86:87], v[72:73]
    s_mov_b64 exec, -1
    s_or_b64 s[80:81], s[80:81], s[50:51]
    ds_read_b64 v[70:71], v93 offset:65408
    ds_read_b64 v[68:69], v92 offset:65408
    v_and_b32 v46, 0x40000000, v43
    v_bitop3_b32 v94, v36, v5, v46 bitop3:0xea
    v_and_b32 v46, 0x80000000, v43
    v_bitop3_b32 v95, v37, v5, v46 bitop3:0xea
    v_perm_b32 v15, v37, v38, s47
    v_bitop3_b32 v46, v37, 0.5, -0.5 bitop3:0xa8
    v_perm_b32 v14, v36, v38, s46
    v_bitop3_b32 v47, v36, 0.5, -0.5 bitop3:0xa8
    v_bitop3_b32 v15, v6, v15, v46 bitop3:0xca
    v_bitop3_b32 v14, v6, v14, v47 bitop3:0xca
    s_setprio 1
    s_waitcnt lgkmcnt(1)
    v_mfma_f32_4x4x4_16b_bf16 v[80:83], v[10:11], v[70:71], v[80:83]
    s_waitcnt lgkmcnt(0)
    v_mfma_f32_4x4x4_16b_bf16 v[76:79], v[10:11], v[68:69], v[76:79]
    s_nop 2
    v_cvt_pk_bf16_f32 v80, v80, v81
    v_cvt_pk_bf16_f32 v81, v82, v83
    ds_wrxchg_rtn_b64 v[74:75], v93, v[80:81] offset:65408
    v_cvt_pk_bf16_f32 v76, v76, v77
    v_cvt_pk_bf16_f32 v77, v78, v79
    ds_wrxchg_rtn_b64 v[72:73], v92, v[76:77] offset:65408
    ds_read_b32 v40, v0 offset:0
    ds_read_b32 v41, v0 offset:256
    ds_read_b32 v42, v44 offset:768
    ds_read_b32 v43, v0 offset:512
    s_sub_u32 s3, s37, 768
    s_cmp_gt_u32 s3, 128
    s_cbranch_scc1 L2_xf43
L2_xg43:
    v_lshrrev_b64 v[64:65], 16, v[64:65]
    v_lshrrev_b64 v[66:67], 16, v[66:67]
    v_and_b32 v88, 0x0fffffff, v39
    buffer_load_dwordx2 v[34:35], v88, s[8:11], 0 offen
    buffer_load_dwordx3 v[36:38], v88, s[8:11], 0 offen offset:8
    s_setprio 0
    s_waitcnt vmcnt(12)
    s_mov_b32 m0, s38
    s_nop 0
    ds_write_addtid_b32 v108 offset:0
    ds_write_addtid_b32 v109 offset:256
    ds_write_addtid_b32 v110 offset:512
    ds_write_addtid_b32 v111 offset:768
    s_waitcnt vmcnt(9)
    ds_write_addtid_b32 v112 offset:1024
    ds_write_addtid_b32 v113 offset:1280
    ds_write_addtid_b32 v114 offset:1536
    ds_write_addtid_b32 v115 offset:1792
    v_mfma_f32_4x4x4_16b_bf16 v[80:83], v[8:9], v[106:107], 0
    v_mfma_f32_4x4x4_16b_bf16 v[76:79], v[8:9], v[104:105], 0
    v_cmp_lt_u32 s[84:85], v5, v94
    s_nop 2
    v_pk_mul_f32 v[80:81], v[80:81], v[14:15] op_sel:[0,1] op_sel_hi:[1,1]
    v_pk_mul_f32 v[82:83], v[82:83], v[14:15] op_sel:[0,1] op_sel_hi:[1,1]
    v_pk_mul_f32 v[76:77], v[76:77], v[14:15] op_sel:[0,0] op_sel_hi:[1,0]
    v_pk_mul_f32 v[78:79], v[78:79], v[14:15] op_sel:[0,0] op_sel_hi:[1,0]
    s_add_u32 s42, s42, 1
    s_waitcnt lgkmcnt(0)
L2_loop:
    s_barrier
    s_bitcmp1_b32 s36, s42
    s_cbranch_scc1 L2_slow
L2_ret2:
    s_setprio 3
    s_bitcmp1_b32 s43, s42
    s_cbranch_scc1 L2_oa46
L2_ob46:
    v_and_b32 v46, 0x20000000, v21
    v_lshrrev_b32 v47, 14, v17
    v_bitop3_b32 v47, v47, v5, v46 bitop3:0xea
    ds_read_b64 v[102:103], v47
    v_and_b32 v99, 0x10000000, v21
    v_lshrrev_b32 v47, 14, v16
    v_bitop3_b32 v47, v47, v5, v99 bitop3:0xea
    ds_read_b64 v[100:101], v47
    v_cmp_ne_u64 s[50:51], v[72:73], v[68:69]
    v_cmpx_ne_u64 s[54:55], v[74:75], v[70:71]
    s_and_b64 s[82:83], s[54:55], s[80:81]
    s_cbranch_scc1 L2_c47
L2_d47:
    v_mov_b64 v[84:85], v[70:71]
    v_mov_b32 v7, v93
    v_mov_b64 v[86:87], v[74:75]
    s_or_b64 s[80:81], s[80:81], s[54:55]
    s_mov_b64 exec, s[50:51]
    s_and_b64 s[82:83], s[50:51], s[80:81]
    s_cbranch_scc1 L2_c48
L2_d48:
    v_mov_b64 v[84:85], v[68:69]
    v_mov_b32 v7, v92
    v_mov_b64 v[86:87], v[72:73]
    s_mov_b64 exec, -1
    s_or_b64 s[80:81], s[80:81], s[50:51]
    s_and_b64 exec, s[84:85], s[80:81]
    v_mfma_f32_4x4x4_16b_bf16 v[76:79], v[12:13], v[84:85], 0
    v_mov_b32 v94, v7
    s_andn2_b64 s[80:81], s[80:81], s[84:85]
    v_mfma_f32_4x4x4_16b_bf16 v[76:79], v[10:11], v[86:87], v[76:79]
    s_mov_b64 exec, -1
    ds_read_b64 v[70:71], v95 offset:65408
    ds_read_b64 v[68:69], v94 offset:65408
    v_bitop3_b32 v92, v16, v5, v99 bitop3:0xea
    v_bitop3_b32 v93, v17, v5, v46 bitop3:0xea
    v_perm_b32 v15, v17, v20, s45
    v_bitop3_b32 v46, v17, 0.5, -0.5 bitop3:0xa8
    v_perm_b32 v14, v16, v20, s44
    v_bitop3_b32 v47, v16, 0.5, -0.5 bitop3:0xa8
    v_bitop3_b32 v15, v6, v15, v46 bitop3:0xca
    v_bitop3_b32 v14, v6, v14, v47 bitop3:0xca
    s_waitcnt lgkmcnt(1)
    v_mfma_f32_4x4x4_16b_bf16 v[80:83], v[10:11], v[70:71], v[80:83]
    s_waitcnt lgkmcnt(0)
    v_mfma_f32_4x4x4_16b_bf16 v[76:79], v[10:11], v[68:69], v[76:79]
    s_nop 2
    v_cvt_pk_bf16_f32 v80, v80, v81
    v_cvt_pk_bf16_f32 v81, v82, v83
    ds_wrxchg_rtn_b64 v[74:75], v95, v[80:81] offset:65408
    v_cvt_pk_bf16_f32 v76, v76, v77
    v_cvt_pk_bf16_f32 v77, v78, v79
    ds_wrxchg_rtn_b64 v[72:73], v94, v[76:77] offset:65408
    v_mfma_f32_4x4x4_16b_bf16 v[80:83], v[8:9], v[102:103], 0
    v_mfma_f32_4x4x4_16b_bf16 v[76:79], v[8:9], v[100:101], 0
    v_cmp_lt_u32 s[84:85], v5, v92
    s_nop 2
    v_pk_mul_f32 v[80:81], v[80:81], v[14:15] op_sel:[0,1] op_sel_hi:[1,1]
    v_pk_mul_f32 v[82:83], v[82:83], v[14:15] op_sel:[0,1] op_sel_hi:[1,1]
    v_pk_mul_f32 v[76:77], v[76:77], v[14:15] op_sel:[0,0] op_sel_hi:[1,0]
    v_pk_mul_f32 v[78:79], v[78:79], v[14:15] op_sel:[0,0] op_sel_hi:[1,0]
    buffer_load_dwordx4 v[108:111], v3, s[16:19], s40 offen offset:0 sc1
    v_and_b32 v46, 0x80000000, v21
    v_lshrrev_b32 v47, 14, v19
    v_bitop3_b32 v47, v47, v5, v46 bitop3:0xea
    ds_read_b64 v[106:107], v47
    v_and_b32 v99, 0x40000000, v21
    v_lshrrev_b32 v47, 14, v18
    v_bitop3_b32 v47, v47, v5, v99 bitop3:0xea
    ds_read_b64 v[104:105], v47
    s_waitcnt lgkmcnt(2)
    v_cmp_ne_u64 s[50:51], v[72:73], v[68:69]
    v_cmpx_ne_u64 s[54:55], v[74:75], v[70:71]
    s_and_b64 s[82:83], s[54:55], s[80:81]
    s_cbranch_scc1 L2_c49
L2_d49:
    v_mov_b64 v[84:85], v[70:71]
    v_mov_b32 v7, v95
    v_mov_b64 v[86:87], v[74:75]
    s_or_b64 s[80:81], s[80:81], s[54:55]
    s_mov_b64 exec, s[50:51]
    s_and_b64 s[82:83], s[50:51], s[80:81]
    s_cbranch_scc1 L2_c50
L2_d50:
    v_mov_b64 v[84:85], v[68:69]
    v_mov_b32 v7, v94
    v_mov_b64 v[86:87], v[72:73]
    s_mov_b64 exec, -1
    s_or_b64 s[80:81], s[80:81], s[50:51]
    s_and_b64 exec, s[84:85], s[80:81]
    v_mfma_f32_4x4x4_16b_bf16 v[76:79], v[12:13], v[84:85], 0
    v_mov_b32 v92, v7
    s_andn2_b64 s[80:81], s[80:81], s[84:85]
    v_mfma_f32_4x4x4_16b_bf16 v[76:79], v[10:11], v[86:87], v[76:79]
    s_mov_b64 exec, -1
    ds_read_b64 v[70:71], v93 offset:65408
    ds_read_b64 v[68:69], v92 offset:65408
    v_bitop3_b32 v94, v18, v5, v99 bitop3:0xea
    v_bitop3_b32 v95, v19, v5, v46 bitop3:0xea
    v_perm_b32 v15, v19, v20, s47
    v_bitop3_b32 v46, v19, 0.5, -0.5 bitop3:0xa8
    v_perm_b32 v14, v18, v20, s46
    v_bitop3_b32 v47, v18, 0.5, -0.5 bitop3:0xa8
    v_bitop3_b32 v15, v6, v15, v46 bitop3:0xca
    v_bitop3_b32 v14, v6, v14, v47 bitop3:0xca
    s_waitcnt lgkmcnt(1)
    v_mfma_f32_4x4x4_16b_bf16 v[80:83], v[10:11], v[70:71], v[80:83]
    s_waitcnt lgkmcnt(0)
    v_mfma_f32_4x4x4_16b_bf16 v[76:79], v[10:11], v[68:69], v[76:79]
    s_nop 2
    v_cvt_pk_bf16_f32 v80, v80, v81
    v_cvt_pk_bf16_f32 v81, v82, v83
    ds_wrxchg_rtn_b64 v[74:75], v93, v[80:81] offset:65408
    v_cvt_pk_bf16_f32 v76, v76, v77
    v_cvt_pk_bf16_f32 v77, v78, v79
    ds_wrxchg_rtn_b64 v[72:73], v92, v[76:77] offset:65408
    v_and_b32 v88, 0x0fffffff, v40
    buffer_load_dwordx2 v[16:17], v88, s[8:11], 0 offen
    buffer_load_dwordx3 v[18:20], v88, s[8:11], 0 offen offset:8
    s_setprio 2
    v_mfma_f32_4x4x4_16b_bf16 v[80:83], v[8:9], v[106:107], 0
    v_mfma_f32_4x4x4_16b_bf16 v[76:79], v[8:9], v[104:105], 0
    v_cmp_lt_u32 s[48:49], v5, v95
    s_nop 2
    v_pk_mul_f32 v[80:81], v[80:81], v[14:15] op_sel:[0,1] op_sel_hi:[1,1]
    v_pk_mul_f32 v[82:83], v[82:83], v[14:15] op_sel:[0,1] op_sel_hi:[1,1]
    v_pk_mul_f32 v[76:77], v[76:77], v[14:15] op_sel:[0,0] op_sel_hi:[1,0]
    v_pk_mul_f32 v[78:79], v[78:79], v[14:15] op_sel:[0,0] op_sel_hi:[1,0]
    s_waitcnt vmcnt(10)
    v_and_b32 v46, 0x20000000, v27
    v_lshrrev_b32 v47, 14, v23
    v_bitop3_b32 v47, v47, v5, v46 bitop3:0xea
    ds_read_b64 v[102:103], v47
    v_and_b32 v99, 0x10000000, v27
    v_lshrrev_b32 v47, 14, v22
    v_bitop3_b32 v47, v47, v5, v99 bitop3:0xea
    ds_read_b64 v[100:101], v47
    s_waitcnt lgkmcnt(2)
    v_cmp_ne_u64 s[50:51], v[72:73], v[68:69]
    v_cmpx_ne_u64 s[54:55], v[74:75], v[70:71]
    s_and_b64 s[82:83], s[54:55], s[80:81]
    s_cbranch_scc1 L2_c51
L2_d51:
    v_mov_b64 v[84:85], v[70:71]
    v_mov_b32 v7, v93
    v_mov_b64 v[86:87], v[74:75]
    s_or_b64 s[80:81], s[80:81], s[54:55]
    s_mov_b64 exec, s[50:51]
    s_and_b64 s[82:83], s[50:51], s[80:81]
    s_cbranch_scc1 L2_c52
L2_d52:
    v_mov_b64 v[84:85], v[68:69]
    v_mov_b32 v7, v92
    v_mov_b64 v[86:87], v[72:73]
    s_mov_b64 exec, -1
    s_or_b64 s[80:81], s[80:81], s[50:51]
    s_and_b64 exec, s[48:49], s[80:81]
    v_mfma_f32_4x4x4_16b_bf16 v[80:83], v[12:13], v[84:85], 0
    v_mov_b32 v95, v7
    s_andn2_b64 s[80:81], s[80:81], s[48:49]
    v_mfma_f32_4x4x4_16b_bf16 v[80:83], v[10:11], v[86:87], v[80:83]
    s_mov_b64 exec, -1
    ds_read_b64 v[70:71], v95 offset:65408
    ds_read_b64 v[68:69], v94 offset:65408
    v_bitop3_b32 v92, v22, v5, v99 bitop3:0xea
    v_bitop3_b32 v93, v23, v5, v46 bitop3:0xea
    v_perm_b32 v15, v23, v26, s45
    v_bitop3_b32 v46, v23, 0.5, -0.5 bitop3:0xa8
    v_perm_b32 v14, v22, v26, s44
    v_bitop3_b32 v47, v22, 0.5, -0.5 bitop3:0xa8
    v_bitop3_b32 v15, v6, v15, v46 bitop3:0xca
    v_bitop3_b32 v14, v6, v14, v47 bitop3:0xca
    s_waitcnt lgkmcnt(1)
    v_mfma_f32_4x4x4_16b_bf16 v[80:83], v[10:11], v[70:71], v[80:83]
    s_waitcnt lgkmcnt(0)
    v_mfma_f32_4x4x4_16b_bf16 v[76:79], v[10:11], v[68:69], v[76:79]
    s_nop 2
    v_cvt_pk_bf16_f32 v80, v80, v81
    v_cvt_pk_bf16_f32 v81, v82, v83
    ds_wrxchg_rtn_b64 v[74:75], v95, v[80:81] offset:65408
    v_cvt_pk_bf16_f32 v76, v76, v77
    v_cvt_pk_bf16_f32 v77, v78, v79
    ds_wrxchg_rtn_b64 v[72:73], v94, v[76:77] offset:65408
    s_setprio 1
    v_mfma_f32_4x4x4_16b_bf16 v[80:83], v[8:9], v[102:103], 0
    v_mfma_f32_4x4x4_16b_bf16 v[76:79], v[8:9], v[100:101], 0
    s_nop 3
    v_pk_mul_f32 v[80:81], v[80:81], v[14:15] op_sel:[0,1] op_sel_hi:[1,1]
    v_pk_mul_f32 v[82:83], v[82:83], v[14:15] op_sel:[0,1] op_sel_hi:[1,1]
    v_pk_mul_f32 v[76:77], v[76:77], v[14:15] op_sel:[0,0] op_sel_hi:[1,0]
    v_pk_mul_f32 v[78:79], v[78:79], v[14:15] op_sel:[0,0] op_sel_hi:[1,0]
    s_bitcmp1_b32 s43, s42
    s_cbranch_scc1 L2_oa53
L2_ob53:
    buffer_load_dwordx4 v[112:115], v3, s[16:19], s40 offen offset:1024 sc1
    v_sub_u16 v88, v56, v48
    v_and_b32 v89, 3, v48
    v_add3_u32 v99, v88, v89, 3
    v_and_b32 v99, -4, v99
    v_max_u32 v99, 4, v99
    v_and_b32 v97, 0xfffc, v48
    v_bfm_b32 v96, v88, v89
    v_add_u32_dpp v91, v99, v99 row_shr:1 row_mask:0xf bank_mask:0xf bound_ctrl:1
    v_mad_u32_u24 v97, v97, 5, v2
    v_cmp_lt_u32 vcc, 16, v99
    v_add_u32_dpp v91, v91, v91 row_shr:2 row_mask:0xf bank_mask:0xf bound_ctrl:1
    v_sub_u32 v98, s38, v99
    v_lshrrev_b64 v[48:49], 16, v[48:49]
    v_add_u32_dpp v91, v91, v91 row_shr:4 row_mask:0xf bank_mask:0xf bound_ctrl:1
    v_lshrrev_b64 v[56:57], 16, v[56:57]
    s_mov_b32 s101, 0
    v_add_u32_dpp v91, v91, v91 row_shr:8 row_mask:0xf bank_mask:0xf bound_ctrl:1
    s_nop 1
    v_add_u32_dpp v91, v91, v91 row_bcast:15 row_mask:0xa bank_mask:0xf
    s_nop 1
    v_add_u32_dpp v91, v91, v91 row_bcast:31 row_mask:0xc bank_mask:0xf
    v_add_u32 v98, v98, v91
    v_readlane_b32 s37, v91, 63
    s_cbranch_vccnz L2_xo54
L2_xp54:
    v_and_b32 v46, 0x80000000, v27
    v_lshrrev_b32 v47, 14, v25
    v_bitop3_b32 v47, v47, v5, v46 bitop3:0xea
    ds_read_b64 v[106:107], v47
    v_and_b32 v99, 0x40000000, v27
    v_lshrrev_b32 v47, 14, v24
    v_bitop3_b32 v47, v47, v5, v99 bitop3:0xea
    ds_read_b64 v[104:105], v47
    s_waitcnt lgkmcnt(2)
    v_cmp_ne_u64 s[50:51], v[72:73], v[68:69]
    v_cmpx_ne_u64 s[54:55], v[74:75], v[70:71]
    s_and_b64 s[82:83], s[54:55], s[80:81]
    s_cbranch_scc1 L2_c55
L2_d55:
    v_mov_b64 v[84:85], v[70:71]
    v_mov_b32 v7, v95
    v_mov_b64 v[86:87], v[74:75]
    s_or_b64 s[80:81], s[80:81], s[54:55]
    s_mov_b64 exec, s[50:51]
    s_and_b64 s[82:83], s[50:51], s[80:81]
    s_cbranch_scc1 L2_c56
L2_d56:
    v_mov_b64 v[84:85], v[68:69]
    v_mov_b32 v7, v94
    v_mov_b64 v[86:87], v[72:73]
    s_mov_b64 exec, -1
    s_or_b64 s[80:81], s[80:81], s[50:51]
    ds_read_b64 v[70:71], v93 offset:65408
    ds_read_b64 v[68:69], v92 offset:65408
    v_bitop3_b32 v94, v24, v5, v99 bitop3:0xea
    v_bitop3_b32 v95, v25, v5, v46 bitop3:0xea
    v_perm_b32 v15, v25, v26, s47
    v_bitop3_b32 v46, v25, 0.5, -0.5 bitop3:0xa8
    v_perm_b32 v14, v24, v26, s46
    v_bitop3_b32 v47, v24, 0.5, -0.5 bitop3:0xa8
    v_bitop3_b32 v15, v6, v15, v46 bitop3:0xca
    v_bitop3_b32 v14, v6, v14, v47 bitop3:0xca
    s_waitcnt lgkmcnt(1)
    v_mfma_f32_4x4x4_16b_bf16 v[80:83], v[10:11], v[70:71], v[80:83]
    s_waitcnt lgkmcnt(0)
    v_mfma_f32_4x4x4_16b_bf16 v[76:79], v[10:11], v[68:69], v[76:79]
    s_nop 2
    v_cvt_pk_bf16_f32 v80, v80, v81
    v_cvt_pk_bf16_f32 v81, v82, v83
    ds_wrxchg_rtn_b64 v[74:75], v93, v[80:81] offset:65408
    v_cvt_pk_bf16_f32 v76, v76, v77
    v_cvt_pk_bf16_f32 v77, v78, v79
    ds_wrxchg_rtn_b64 v[72:73], v92, v[76:77] offset:65408
    v_and_b32 v88, 0x0fffffff, v41
    buffer_load_dwordx2 v[22:23], v88, s[8:11], 0 offen
    buffer_load_dwordx3 v[24:26], v88, s[8:11], 0 offen offset:8
    v_mfma_f32_4x4x4_16b_bf16 v[80:83], v[8:9], v[106:107], 0
    v_mfma_f32_4x4x4_16b_bf16 v[76:79], v[8:9], v[104:105], 0
    v_cmp_lt_u32 s[84:85], v5, v94
    s_nop 2
    v_pk_mul_f32 v[80:81], v[80:81], v[14:15] op_sel:[0,1] op_sel_hi:[1,1]
    v_pk_mul_f32 v[82:83], v[82:83], v[14:15] op_sel:[0,1] op_sel_hi:[1,1]
    v_pk_mul_f32 v[76:77], v[76:77], v[14:15] op_sel:[0,0] op_sel_hi:[1,0]
    v_pk_mul_f32 v[78:79], v[78:79], v[14:15] op_sel:[0,0] op_sel_hi:[1,0]
    s_waitcnt vmcnt(11)
    s_mov_b64 exec, s[6:7]
    v_lshrrev_b32 v30, 16, v30
    s_mov_b64 exec, -1
    v_and_b32 v46, 0x20000000, v31
    v_lshrrev_b32 v47, 14, v29
    v_bitop3_b32 v47, v47, v5, v46 bitop3:0xea
    ds_read_b64 v[102:103], v47
    v_and_b32 v99, 0x10000000, v31
    v_lshrrev_b32 v47, 14, v28
    v_bitop3_b32 v47, v47, v5, v99 bitop3:0xea
    ds_read_b64 v[100:101], v47
    s_waitcnt lgkmcnt(2)
    v_cmp_ne_u64 s[50:51], v[72:73], v[68:69]
    v_cmpx_ne_u64 s[54:55], v[74:75], v[70:71]
    s_and_b64 s[82:83], s[54:55], s[80:81]
    s_cbranch_scc1 L2_c57
L2_d57:
    v_mov_b64 v[84:85], v[70:71]
    v_mov_b32 v7, v93
    v_mov_b64 v[86:87], v[74:75]
    s_or_b64 s[80:81], s[80:81], s[54:55]
    s_mov_b64 exec, s[50:51]
    s_and_b64 s[82:83], s[50:51], s[80:81]
    s_cbranch_scc1 L2_c58
L2_d58:
    v_mov_b64 v[84:85], v[68:69]
    v_mov_b32 v7, v92
    v_mov_b64 v[86:87], v[72:73]
    s_mov_b64 exec, -1
    s_or_b64 s[80:81], s[80:81], s[50:51]
    s_and_b64 exec, s[84:85], s[80:81]
    v_mfma_f32_4x4x4_16b_bf16 v[76:79], v[12:13], v[84:85], 0
    v_mov_b32 v94, v7
    s_andn2_b64 s[80:81], s[80:81], s[84:85]
    v_mfma_f32_4x4x4_16b_bf16 v[76:79], v[10:11], v[86:87], v[76:79]
    s_mov_b64 exec, -1
    ds_read_b64 v[70:71], v95 offset:65408
    ds_read_b64 v[68:69], v94 offset:65408
    v_bitop3_b32 v92, v28, v5, v99 bitop3:0xea
    v_bitop3_b32 v93, v29, v5, v46 bitop3:0xea
    v_perm_b32 v15, v29, v30, s45
    v_bitop3_b32 v46, v29, 0.5, -0.5 bitop3:0xa8
    v_perm_b32 v14, v28, v30, s44
    v_bitop3_b32 v47, v28, 0.5, -0.5 bitop3:0xa8
    v_bitop3_b32 v15, v6, v15, v46 bitop3:0xca
    v_bitop3_b32 v14, v6, v14, v47 bitop3:0xca
    s_waitcnt lgkmcnt(1)
    v_mfma_f32_4x4x4_16b_bf16 v[80:83], v[10:11], v[70:71], v[80:83]
    s_waitcnt lgkmcnt(0)
    v_mfma_f32_4x4x4_16b_bf16 v[76:79], v[10:11], v[68:69], v[76:79]
    s_nop 2
    v_cvt_pk_bf16_f32 v80, v80, v81
    v_cvt_pk_bf16_f32 v81, v82, v83
    ds_wrxchg_rtn_b64 v[74:75], v95, v[80:81] offset:65408
    v_cvt_pk_bf16_f32 v76, v76, v77
    v_cvt_pk_bf16_f32 v77, v78, v79
    ds_wrxchg_rtn_b64 v[72:73], v94, v[76:77] offset:65408
    s_setprio 0
    v_mfma_f32_4x4x4_16b_bf16 v[80:83], v[8:9], v[102:103], 0
    v_mfma_f32_4x4x4_16b_bf16 v[76:79], v[8:9], v[100:101], 0
    v_cmp_lt_u32 s[48:49], v5, v93
    s_nop 2
    v_pk_mul_f32 v[80:81], v[80:81], v[14:15] op_sel:[0,1] op_sel_hi:[1,1]
    v_pk_mul_f32 v[82:83], v[82:83], v[14:15] op_sel:[0,1] op_sel_hi:[1,1]
    v_pk_mul_f32 v[76:77], v[76:77], v[14:15] op_sel:[0,0] op_sel_hi:[1,0]
    v_pk_mul_f32 v[78:79], v[78:79], v[14:15] op_sel:[0,0] op_sel_hi:[1,0]
    s_add_u32 s40, s40, 0xfff24000
    v_and_b32 v47, 0x0fffffff, v42
    buffer_load_dword v30, v47, s[8:11], 0 offen offset:16
    s_mov_b64 exec, s[6:7]
    v_add_u32 v47, 8, v47
    v_lshrrev_b32 v42, 2, v42
    s_mov_b64 exec, -1
    buffer_load_dwordx2 v[28:29], v47, s[8:11], 0 offen
    s_waitcnt vmcnt(8)
    v_and_b32 v46, 0x80000000, v39
    v_lshrrev_b32 v47, 14, v37
    v_bitop3_b32 v47, v47, v5, v46 bitop3:0xea
    ds_read_b64 v[102:103], v47
    v_and_b32 v99, 0x40000000, v39
    v_lshrrev_b32 v47, 14, v36
    v_bitop3_b32 v47, v47, v5, v99 bitop3:0xea
    ds_read_b64 v[100:101], v47
    v_and_b32 v46, 0x20000000, v39
    v_lshrrev_b32 v47, 14, v35
    v_bitop3_b32 v47, v47, v5, v46 bitop3:0xea
    ds_read_b64 v[106:107], v47
    v_and_b32 v99, 0x10000000, v39
    v_lshrrev_b32 v47, 14, v34
    v_bitop3_b32 v47, v47, v5, v99 bitop3:0xea
    ds_read_b64 v[104:105], v47
    s_waitcnt lgkmcnt(4)
    v_cmp_ne_u64 s[50:51], v[72:73], v[68:69]
    v_cmpx_ne_u64 s[54:55], v[74:75], v[70:71]
    s_and_b64 s[82:83], s[54:55], s[80:81]
    s_cbranch_scc1 L2_c59
L2_d59:
    v_mov_b64 v[84:85], v[70:71]
    v_mov_b32 v7, v95
    v_mov_b64 v[86:87], v[74:75]
    s_or_b64 s[80:81], s[80:81], s[54:55]
    s_mov_b64 exec, s[50:51]
    s_and_b64 s[82:83], s[50:51], s[80:81]
    s_cbranch_scc1 L2_c60
L2_d60:
    v_mov_b64 v[84:85], v[68:69]
    v_mov_b32 v7, v94
    v_mov_b64 v[86:87], v[72:73]
    s_mov_b64 exec, -1
    s_or_b64 s[80:81], s[80:81], s[50:51]
    s_and_b64 exec, s[48:49], s[80:81]
    v_mfma_f32_4x4x4_16b_bf16 v[80:83], v[12:13], v[84:85], 0
    v_mov_b32 v93, v7
    s_andn2_b64 s[80:81], s[80:81], s[48:49]
    v_mfma_f32_4x4x4_16b_bf16 v[80:83], v[10:11], v[86:87], v[80:83]
    s_mov_b64 exec, -1
    ds_read_b64 v[70:71], v93 offset:65408
    ds_read_b64 v[68:69], v92 offset:65408
    v_bitop3_b32 v94, v34, v5, v99 bitop3:0xea
    v_bitop3_b32 v95, v35, v5, v46 bitop3:0xea
    v_perm_b32 v15, v35, v38, s45
    v_bitop3_b32 v46, v35, 0.5, -0.5 bitop3:0xa8
    v_perm_b32 v14, v34, v38, s44
    v_bitop3_b32 v47, v34, 0.5, -0.5 bitop3:0xa8
    v_bitop3_b32 v15, v6, v15, v46 bitop3:0xca
    v_bitop3_b32 v14, v6, v14, v47 bitop3:0xca
    s_waitcnt lgkmcnt(1)
    v_mfma_f32_4x4x4_16b_bf16 v[80:83], v[10:11], v[70:71], v[80:83]
    s_waitcnt lgkmcnt(0)
    v_mfma_f32_4x4x4_16b_bf16 v[76:79], v[10:11], v[68:69], v[76:79]
    s_nop 2
    v_cvt_pk_bf16_f32 v80, v80, v81
    v_cvt_pk_bf16_f32 v81, v82, v83
    ds_wrxchg_rtn_b64 v[74:75], v93, v[80:81] offset:65408
    v_cvt_pk_bf16_f32 v76, v76, v77
    v_cvt_pk_bf16_f32 v77, v78, v79
    ds_wrxchg_rtn_b64 v[72:73], v92, v[76:77] offset:65408
    s_barrier
    s_setprio 3
    s_mov_b32 m0, s100
    s_nop 0
    ds_write_addtid_b32 v124 offset:34816
    ds_write_addtid_b32 v125 offset:35072
    ds_write_addtid_b32 v126 offset:35328
    ds_write_addtid_b32 v127 offset:35584
    s_add_u32 s3, s40, 4096
    buffer_load_dwordx4 v[124:127], v3, s[16:19], s3 offen sc1
    ds_write_addtid_b32 v116 offset:32768
    ds_write_addtid_b32 v117 offset:33024
    ds_write_addtid_b32 v118 offset:33280
    ds_write_addtid_b32 v119 offset:33536
    buffer_load_dwordx4 v[116:119], v3, s[16:19], s40 offen offset:2048 sc1
    ds_write_addtid_b32 v120 offset:33792
    ds_write_addtid_b32 v121 offset:34048
    ds_write_addtid_b32 v122 offset:34304
    ds_write_addtid_b32 v123 offset:34560
    buffer_load_dwordx4 v[120:123], v3, s[16:19], s40 offen offset:3072 sc1
    v_mfma_f32_4x4x4_16b_bf16 v[80:83], v[8:9], v[106:107], 0
    v_mfma_f32_4x4x4_16b_bf16 v[76:79], v[8:9], v[104:105], 0
    s_nop 3
    v_pk_mul_f32 v[80:81], v[80:81], v[14:15] op_sel:[0,1] op_sel_hi:[1,1]
    v_pk_mul_f32 v[82:83], v[82:83], v[14:15] op_sel:[0,1] op_sel_hi:[1,1]
    v_pk_mul_f32 v[76:77], v[76:77], v[14:15] op_sel:[0,0] op_sel_hi:[1,0]
    v_pk_mul_f32 v[78:79], v[78:79], v[14:15] op_sel:[0,0] op_sel_hi:[1,0]
    s_cmp_gt_u32 s37, 1024
    s_cbranch_scc1 L2_xs61
    s_cmp_lg_u32 s101, 0
    s_cbranch_scc1 L2_xa61
L2_xb61:
    v_lshlrev_b32 v89, 16, v96
    v_add_u32 v90, 60, v97
    v_bitop3_b32 v90, v89, v45, v90 bitop3:0x6a
    ds_write_b32 v98, v90 offset:12
    v_lshlrev_b32 v89, 20, v96
    v_add_u32 v90, 40, v97
    v_bitop3_b32 v90, v89, v45, v90 bitop3:0x6a
    ds_write_b32 v98, v90 offset:8
    v_lshlrev_b32 v89, 24, v96
    v_add_u32 v90, 20, v97
    v_bitop3_b32 v90, v89, v45, v90 bitop3:0x6a
    ds_write_b32 v98, v90 offset:4
    v_lshlrev_b32 v89, 28, v96
    v_bitop3_b32 v90, v89, v45, v97 bitop3:0x6a
    ds_write_b32 v98, v90 offset:0
    v_mov_b32_dpp v91, v64 quad_perm:[0,0,0,0] row_mask:0xf bank_mask:0xf
    v_and_b32 v89, 3, v91
    v_and_b32 v97, 0xfffc, v91
    v_sub_u16_dpp v88, v64, v91 quad_perm:[2,2,2,2] row_mask:0xf bank_mask:0xf
    v_mad_u32_u24 v97, v97, 5, v4
    v_add_u32 v99, v88, v89
    v_bfm_b32 v96, v88, v89
    v_cmp_lt_u32 s[58:59], 16, v99
    v_lshlrev_b32 v89, v1, v96
    v_and_b32 v89, v45, v89
    v_cmp_ne_u32 vcc, 0, v89
    v_xor_b32 v90, v97, v89
    s_add_u32 s3, s37, s38
    v_mbcnt_lo_u32_b32 v98, vcc_lo, 0
    v_mbcnt_hi_u32_b32 v98, vcc_hi, v98
    s_bcnt1_i32_b64 s41, vcc
    v_lshl_add_u32 v98, v98, 2, s3
    s_lshl2_add_u32 s37, s41, s37
    s_mov_b64 exec, vcc
    ds_write_b32 v98, v90
    s_mov_b64 exec, -1
    s_cmp_lg_u64 s[58:59], 0
    s_cbranch_scc1 L2_xe61
L2_xr61:
    v_add_u32 v98, s37, v0
    v_mov_b32 v90, -1
    ds_write_b32 v98, v90
L2_xw61:
    s_setprio 2
    s_waitcnt lgkmcnt(14)
    v_cmp_ne_u64 s[50:51], v[72:73], v[68:69]
    v_cmpx_ne_u64 s[54:55], v[74:75], v[70:71]
    s_and_b64 s[82:83], s[54:55], s[80:81]
    s_cbranch_scc1 L2_c62
L2_d62:
    v_mov_b64 v[84:85], v[70:71]
    v_mov_b32 v7, v93
    v_mov_b64 v[86:87], v[74:75]
    s_or_b64 s[80:81], s[80:81], s[54:55]
    s_mov_b64 exec, s[50:51]
    s_and_b64 s[82:83], s[50:51], s[80:81]
    s_cbranch_scc1 L2_c63
L2_d63:
    v_mov_b64 v[84:85], v[68:69]
    v_mov_b32 v7, v92
    v_mov_b64 v[86:87], v[72:73]
    s_mov_b64 exec, -1
    s_or_b64 s[80:81], s[80:81], s[50:51]
    ds_read_b64 v[70:71], v95 offset:65408
    ds_read_b64 v[68:69], v94 offset:65408
    v_and_b32 v46, 0x40000000, v39
    v_bitop3_b32 v92, v36, v5, v46 bitop3:0xea
    v_and_b32 v46, 0x80000000, v39
    v_bitop3_b32 v93, v37, v5, v46 bitop3:0xea
    v_perm_b32 v15, v37, v38, s47
    v_bitop3_b32 v46, v37, 0.5, -0.5 bitop3:0xa8
    v_perm_b32 v14, v36, v38, s46
    v_bitop3_b32 v47, v36, 0.5, -0.5 bitop3:0xa8
    v_bitop3_b32 v15, v6, v15, v46 bitop3:0xca
    v_bitop3_b32 v14, v6, v14, v47 bitop3:0xca
    s_setprio 1
    s_waitcnt lgkmcnt(1)
    v_mfma_f32_4x4x4_16b_bf16 v[80:83], v[10:11], v[70:71], v[80:83]
    s_waitcnt lgkmcnt(0)
    v_mfma_f32_4x4x4_16b_bf16 v[76:79], v[10:11], v[68:69], v[76:79]
    s_nop 2
    v_cvt_pk_bf16_f32 v80, v80, v81
    v_cvt_pk_bf16_f32 v81, v82, v83
    ds_wrxchg_rtn_b64 v[74:75], v95, v[80:81] offset:65408
    v_cvt_pk_bf16_f32 v76, v76, v77
    v_cvt_pk_bf16_f32 v77, v78, v79
    ds_wrxchg_rtn_b64 v[72:73], v94, v[76:77] offset:65408
    ds_read_b32 v21, v0 offset:0
    ds_read_b32 v27, v0 offset:256
    ds_read_b32 v31, v44 offset:768
    ds_read_b32 v39, v0 offset:512
    s_sub_u32 s3, s37, 768
    s_cmp_gt_u32 s3, 128
    s_cbranch_scc1 L2_xf61
L2_xg61:
    v_and_b32 v88, 0x0fffffff, v43
    buffer_load_dwordx2 v[34:35], v88, s[8:11], 0 offen
    buffer_load_dwordx3 v[36:38], v88, s[8:11], 0 offen offset:8
    s_setprio 0
    s_waitcnt vmcnt(12)
    s_mov_b32 m0, s38
    s_nop 0
    ds_write_addtid_b32 v108 offset:0
    ds_write_addtid_b32 v109 offset:256
    ds_write_addtid_b32 v110 offset:512
    ds_write_addtid_b32 v111 offset:768
    s_waitcnt vmcnt(9)
    ds_write_addtid_b32 v112 offset:1024
    ds_write_addtid_b32 v113 offset:1280
    ds_write_addtid_b32 v114 offset:1536
    ds_write_addtid_b32 v115 offset:1792
    v_mfma_f32_4x4x4_16b_bf16 v[80:83], v[8:9], v[102:103], 0
    v_mfma_f32_4x4x4_16b_bf16 v[76:79], v[8:9], v[100:101], 0
    v_cmp_lt_u32 s[84:85], v5, v92
    s_nop 2
    v_pk_mul_f32 v[80:81], v[80:81], v[14:15] op_sel:[0,1] op_sel_hi:[1,1]
    v_pk_mul_f32 v[82:83], v[82:83], v[14:15] op_sel:[0,1] op_sel_hi:[1,1]
    v_pk_mul_f32 v[76:77], v[76:77], v[14:15] op_sel:[0,0] op_sel_hi:[1,0]
    v_pk_mul_f32 v[78:79], v[78:79], v[14:15] op_sel:[0,0] op_sel_hi:[1,0]
    s_add_u32 s42, s42, 1
    s_waitcnt lgkmcnt(0)
    s_barrier
    s_bitcmp1_b32 s36, s42
    s_cbranch_scc1 L2_slow
L2_ret3:
    s_setprio 3
    s_bitcmp1_b32 s43, s42
    s_cbranch_scc1 L2_oa64
L2_ob64:
    v_and_b32 v46, 0x20000000, v40
    v_lshrrev_b32 v47, 14, v17
    v_bitop3_b32 v47, v47, v5, v46 bitop3:0xea
    ds_read_b64 v[106:107], v47
    v_and_b32 v99, 0x10000000, v40
    v_lshrrev_b32 v47, 14, v16
    v_bitop3_b32 v47, v47, v5, v99 bitop3:0xea
    ds_read_b64 v[104:105], v47
    v_cmp_ne_u64 s[50:51], v[72:73], v[68:69]
    v_cmpx_ne_u64 s[54:55], v[74:75], v[70:71]
    s_and_b64 s[82:83], s[54:55], s[80:81]
    s_cbranch_scc1 L2_c65
L2_d65:
    v_mov_b64 v[84:85], v[70:71]
    v_mov_b32 v7, v95
    v_mov_b64 v[86:87], v[74:75]
    s_or_b64 s[80:81], s[80:81], s[54:55]
    s_mov_b64 exec, s[50:51]
    s_and_b64 s[82:83], s[50:51], s[80:81]
    s_cbranch_scc1 L2_c66
L2_d66:
    v_mov_b64 v[84:85], v[68:69]
    v_mov_b32 v7, v94
    v_mov_b64 v[86:87], v[72:73]
    s_mov_b64 exec, -1
    s_or_b64 s[80:81], s[80:81], s[50:51]
    s_and_b64 exec, s[84:85], s[80:81]
    v_mfma_f32_4x4x4_16b_bf16 v[76:79], v[12:13], v[84:85], 0
    v_mov_b32 v92, v7
    s_andn2_b64 s[80:81], s[80:81], s[84:85]
    v_mfma_f32_4x4x4_16b_bf16 v[76:79], v[10:11], v[86:87], v[76:79]
    s_mov_b64 exec, -1
    ds_read_b64 v[70:71], v93 offset:65408
    ds_read_b64 v[68:69], v92 offset:65408
    v_bitop3_b32 v94, v16, v5, v99 bitop3:0xea
    v_bitop3_b32 v95, v17, v5, v46 bitop3:0xea
    v_perm_b32 v15, v17, v20, s45
    v_bitop3_b32 v46, v17, 0.5, -0.5 bitop3:0xa8
    v_perm_b32 v14, v16, v20, s44
    v_bitop3_b32 v47, v16, 0.5, -0.5 bitop3:0xa8
    v_bitop3_b32 v15, v6, v15, v46 bitop3:0xca
    v_bitop3_b32 v14, v6, v14, v47 bitop3:0xca
    s_waitcnt lgkmcnt(1)
    v_mfma_f32_4x4x4_16b_bf16 v[80:83], v[10:11], v[70:71], v[80:83]
    s_waitcnt lgkmcnt(0)
    v_mfma_f32_4x4x4_16b_bf16 v[76:79], v[10:11], v[68:69], v[76:79]
    s_nop 2
    v_cvt_pk_bf16_f32 v80, v80, v81
    v_cvt_pk_bf16_f32 v81, v82, v83
    ds_wrxchg_rtn_b64 v[74:75], v93, v[80:81] offset:65408
    v_cvt_pk_bf16_f32 v76, v76, v77
    v_cvt_pk_bf16_f32 v77, v78, v79
    ds_wrxchg_rtn_b64 v[72:73], v92, v[76:77] offset:65408
    v_mfma_f32_4x4x4_16b_bf16 v[80:83], v[8:9], v[106:107], 0
    v_mfma_f32_4x4x4_16b_bf16 v[76:79], v[8:9], v[104:105], 0
    v_cmp_lt_u32 s[84:85], v5, v94
    s_nop 2
    v_pk_mul_f32 v[80:81], v[80:81], v[14:15] op_sel:[0,1] op_sel_hi:[1,1]
    v_pk_mul_f32 v[82:83], v[82:83], v[14:15] op_sel:[0,1] op_sel_hi:[1,1]
    v_pk_mul_f32 v[76:77], v[76:77], v[14:15] op_sel:[0,0] op_sel_hi:[1,0]
    v_pk_mul_f32 v[78:79], v[78:79], v[14:15] op_sel:[0,0] op_sel_hi:[1,0]
    buffer_load_dwordx4 v[108:111], v3, s[16:19], s40 offen offset:0 sc1
    v_and_b32 v46, 0x80000000, v40
    v_lshrrev_b32 v47, 14, v19
    v_bitop3_b32 v47, v47, v5, v46 bitop3:0xea
    ds_read_b64 v[102:103], v47
    v_and_b32 v99, 0x40000000, v40
    v_lshrrev_b32 v47, 14, v18
    v_bitop3_b32 v47, v47, v5, v99 bitop3:0xea
    ds_read_b64 v[100:101], v47
    s_waitcnt lgkmcnt(2)
    v_cmp_ne_u64 s[50:51], v[72:73], v[68:69]
    v_cmpx_ne_u64 s[54:55], v[74:75], v[70:71]
    s_and_b64 s[82:83], s[54:55], s[80:81]
    s_cbranch_scc1 L2_c67
L2_d67:
    v_mov_b64 v[84:85], v[70:71]
    v_mov_b32 v7, v93
    v_mov_b64 v[86:87], v[74:75]
    s_or_b64 s[80:81], s[80:81], s[54:55]
    s_mov_b64 exec, s[50:51]
    s_and_b64 s[82:83], s[50:51], s[80:81]
    s_cbranch_scc1 L2_c68
L2_d68:
    v_mov_b64 v[84:85], v[68:69]
    v_mov_b32 v7, v92
    v_mov_b64 v[86:87], v[72:73]
    s_mov_b64 exec, -1
    s_or_b64 s[80:81], s[80:81], s[50:51]
    s_and_b64 exec, s[84:85], s[80:81]
    v_mfma_f32_4x4x4_16b_bf16 v[76:79], v[12:13], v[84:85], 0
    v_mov_b32 v94, v7
    s_andn2_b64 s[80:81], s[80:81], s[84:85]
    v_mfma_f32_4x4x4_16b_bf16 v[76:79], v[10:11], v[86:87], v[76:79]
    s_mov_b64 exec, -1
    ds_read_b64 v[70:71], v95 offset:65408
    ds_read_b64 v[68:69], v94 offset:65408
    v_bitop3_b32 v92, v18, v5, v99 bitop3:0xea
    v_bitop3_b32 v93, v19, v5, v46 bitop3:0xea
    v_perm_b32 v15, v19, v20, s47
    v_bitop3_b32 v46, v19, 0.5, -0.5 bitop3:0xa8
    v_perm_b32 v14, v18, v20, s46
    v_bitop3_b32 v47, v18, 0.5, -0.5 bitop3:0xa8
    v_bitop3_b32 v15, v6, v15, v46 bitop3:0xca
    v_bitop3_b32 v14, v6, v14, v47 bitop3:0xca
    s_waitcnt lgkmcnt(1)
    v_mfma_f32_4x4x4_16b_bf16 v[80:83], v[10:11], v[70:71], v[80:83]
    s_waitcnt lgkmcnt(0)
    v_mfma_f32_4x4x4_16b_bf16 v[76:79], v[10:11], v[68:69], v[76:79]
    s_nop 2
    v_cvt_pk_bf16_f32 v80, v80, v81
    v_cvt_pk_bf16_f32 v81, v82, v83
    ds_wrxchg_rtn_b64 v[74:75], v95, v[80:81] offset:65408
    v_cvt_pk_bf16_f32 v76, v76, v77
    v_cvt_pk_bf16_f32 v77, v78, v79
    ds_wrxchg_rtn_b64 v[72:73], v94, v[76:77] offset:65408
    v_and_b32 v88, 0x0fffffff, v21
    buffer_load_dwordx2 v[16:17], v88, s[8:11], 0 offen
    buffer_load_dwordx3 v[18:20], v88, s[8:11], 0 offen offset:8
    s_setprio 2
    v_mfma_f32_4x4x4_16b_bf16 v[80:83], v[8:9], v[102:103], 0
    v_mfma_f32_4x4x4_16b_bf16 v[76:79], v[8:9], v[100:101], 0
    v_cmp_lt_u32 s[48:49], v5, v93
    s_nop 2
    v_pk_mul_f32 v[80:81], v[80:81], v[14:15] op_sel:[0,1] op_sel_hi:[1,1]
    v_pk_mul_f32 v[82:83], v[82:83], v[14:15] op_sel:[0,1] op_sel_hi:[1,1]
    v_pk_mul_f32 v[76:77], v[76:77], v[14:15] op_sel:[0,0] op_sel_hi:[1,0]
    v_pk_mul_f32 v[78:79], v[78:79], v[14:15] op_sel:[0,0] op_sel_hi:[1,0]
    s_waitcnt vmcnt(10)
    v_and_b32 v46, 0x20000000, v41
    v_lshrrev_b32 v47, 14, v23
    v_bitop3_b32 v47, v47, v5, v46 bitop3:0xea
    ds_read_b64 v[106:107], v47
    v_and_b32 v99, 0x10000000, v41
    v_lshrrev_b32 v47, 14, v22
    v_bitop3_b32 v47, v47, v5, v99 bitop3:0xea
    ds_read_b64 v[104:105], v47
    s_waitcnt lgkmcnt(2)
    v_cmp_ne_u64 s[50:51], v[72:73], v[68:69]
    v_cmpx_ne_u64 s[54:55], v[74:75], v[70:71]
    s_and_b64 s[82:83], s[54:55], s[80:81]
    s_cbranch_scc1 L2_c69
L2_d69:
    v_mov_b64 v[84:85], v[70:71]
    v_mov_b32 v7, v95
    v_mov_b64 v[86:87], v[74:75]
    s_or_b64 s[80:81], s[80:81], s[54:55]
    s_mov_b64 exec, s[50:51]
    s_and_b64 s[82:83], s[50:51], s[80:81]
    s_cbranch_scc1 L2_c70
L2_d70:
    v_mov_b64 v[84:85], v[68:69]
    v_mov_b32 v7, v94
    v_mov_b64 v[86:87], v[72:73]
    s_mov_b64 exec, -1
    s_or_b64 s[80:81], s[80:81], s[50:51]
    s_and_b64 exec, s[48:49], s[80:81]
    v_mfma_f32_4x4x4_16b_bf16 v[80:83], v[12:13], v[84:85], 0
    v_mov_b32 v93, v7
    s_andn2_b64 s[80:81], s[80:81], s[48:49]
    v_mfma_f32_4x4x4_16b_bf16 v[80:83], v[10:11], v[86:87], v[80:83]
    s_mov_b64 exec, -1
    ds_read_b64 v[70:71], v93 offset:65408
    ds_read_b64 v[68:69], v92 offset:65408
    v_bitop3_b32 v94, v22, v5, v99 bitop3:0xea
    v_bitop3_b32 v95, v23, v5, v46 bitop3:0xea
    v_perm_b32 v15, v23, v26, s45
    v_bitop3_b32 v46, v23, 0.5, -0.5 bitop3:0xa8
    v_perm_b32 v14, v22, v26, s44
    v_bitop3_b32 v47, v22, 0.5, -0.5 bitop3:0xa8
    v_bitop3_b32 v15, v6, v15, v46 bitop3:0xca
    v_bitop3_b32 v14, v6, v14, v47 bitop3:0xca
    s_waitcnt lgkmcnt(1)
    v_mfma_f32_4x4x4_16b_bf16 v[80:83], v[10:11], v[70:71], v[80:83]
    s_waitcnt lgkmcnt(0)
    v_mfma_f32_4x4x4_16b_bf16 v[76:79], v[10:11], v[68:69], v[76:79]
    s_nop 2
    v_cvt_pk_bf16_f32 v80, v80, v81
    v_cvt_pk_bf16_f32 v81, v82, v83
    ds_wrxchg_rtn_b64 v[74:75], v93, v[80:81] offset:65408
    v_cvt_pk_bf16_f32 v76, v76, v77
    v_cvt_pk_bf16_f32 v77, v78, v79
    ds_wrxchg_rtn_b64 v[72:73], v92, v[76:77] offset:65408
    s_setprio 1
    v_mfma_f32_4x4x4_16b_bf16 v[80:83], v[8:9], v[106:107], 0
    v_mfma_f32_4x4x4_16b_bf16 v[76:79], v[8:9], v[104:105], 0
    s_nop 3
    v_pk_mul_f32 v[80:81], v[80:81], v[14:15] op_sel:[0,1] op_sel_hi:[1,1]
    v_pk_mul_f32 v[82:83], v[82:83], v[14:15] op_sel:[0,1] op_sel_hi:[1,1]
    v_pk_mul_f32 v[76:77], v[76:77], v[14:15] op_sel:[0,0] op_sel_hi:[1,0]
    v_pk_mul_f32 v[78:79], v[78:79], v[14:15] op_sel:[0,0] op_sel_hi:[1,0]
    s_bitcmp1_b32 s43, s42
    s_cbranch_scc1 L2_oa71
L2_ob71:
    buffer_load_dwordx4 v[112:115], v3, s[16:19], s40 offen offset:1024 sc1
    v_sub_u16 v88, v58, v50
    v_and_b32 v89, 3, v50
    v_add3_u32 v99, v88, v89, 3
    v_and_b32 v99, -4, v99
    v_max_u32 v99, 4, v99
    v_and_b32 v97, 0xfffc, v50
    v_bfm_b32 v96, v88, v89
    v_add_u32_dpp v91, v99, v99 row_shr:1 row_mask:0xf bank_mask:0xf bound_ctrl:1
    v_mad_u32_u24 v97, v97, 5, v2
    v_cmp_lt_u32 vcc, 16, v99
    v_add_u32_dpp v91, v91, v91 row_shr:2 row_mask:0xf bank_mask:0xf bound_ctrl:1
    v_sub_u32 v98, s38, v99
    v_lshrrev_b64 v[50:51], 16, v[50:51]
    v_add_u32_dpp v91, v91, v91 row_shr:4 row_mask:0xf bank_mask:0xf bound_ctrl:1
    v_lshrrev_b64 v[58:59], 16, v[58:59]
    s_mov_b32 s101, 0
    v_add_u32_dpp v91, v91, v91 row_shr:8 row_mask:0xf bank_mask:0xf bound_ctrl:1
    s_nop 1
    v_add_u32_dpp v91, v91, v91 row_bcast:15 row_mask:0xa bank_mask:0xf
    s_nop 1
    v_add_u32_dpp v91, v91, v91 row_bcast:31 row_mask:0xc bank_mask:0xf
    v_add_u32 v98, v98, v91
    v_readlane_b32 s37, v91, 63
    s_cbranch_vccnz L2_xo72
L2_xp72:
    v_and_b32 v46, 0x80000000, v41
    v_lshrrev_b32 v47, 14, v25
    v_bitop3_b32 v47, v47, v5, v46 bitop3:0xea
    ds_read_b64 v[102:103], v47
    v_and_b32 v99, 0x40000000, v41
    v_lshrrev_b32 v47, 14, v24
    v_bitop3_b32 v47, v47, v5, v99 bitop3:0xea
    ds_read_b64 v[100:101], v47
    s_waitcnt lgkmcnt(2)
    v_cmp_ne_u64 s[50:51], v[72:73], v[68:69]
    v_cmpx_ne_u64 s[54:55], v[74:75], v[70:71]
    s_and_b64 s[82:83], s[54:55], s[80:81]
    s_cbranch_scc1 L2_c73
L2_d73:
    v_mov_b64 v[84:85], v[70:71]
    v_mov_b32 v7, v93
    v_mov_b64 v[86:87], v[74:75]
    s_or_b64 s[80:81], s[80:81], s[54:55]
    s_mov_b64 exec, s[50:51]
    s_and_b64 s[82:83], s[50:51], s[80:81]
    s_cbranch_scc1 L2_c74
L2_d74:
    v_mov_b64 v[84:85], v[68:69]
    v_mov_b32 v7, v92
    v_mov_b64 v[86:87], v[72:73]
    s_mov_b64 exec, -1
    s_or_b64 s[80:81], s[80:81], s[50:51]
    ds_read_b64 v[70:71], v95 offset:65408
    ds_read_b64 v[68:69], v94 offset:65408
    v_bitop3_b32 v92, v24, v5, v99 bitop3:0xea
    v_bitop3_b32 v93, v25, v5, v46 bitop3:0xea
    v_perm_b32 v15, v25, v26, s47
    v_bitop3_b32 v46, v25, 0.5, -0.5 bitop3:0xa8
    v_perm_b32 v14, v24, v26, s46
    v_bitop3_b32 v47, v24, 0.5, -0.5 bitop3:0xa8
    v_bitop3_b32 v15, v6, v15, v46 bitop3:0xca
    v_bitop3_b32 v14, v6, v14, v47 bitop3:0xca
    s_waitcnt lgkmcnt(1)
    v_mfma_f32_4x4x4_16b_bf16 v[80:83], v[10:11], v[70:71], v[80:83]
    s_waitcnt lgkmcnt(0)
    v_mfma_f32_4x4x4_16b_bf16 v[76:79], v[10:11], v[68:69], v[76:79]
    s_nop 2
    v_cvt_pk_bf16_f32 v80, v80, v81
    v_cvt_pk_bf16_f32 v81, v82, v83
    ds_wrxchg_rtn_b64 v[74:75], v95, v[80:81] offset:65408
    v_cvt_pk_bf16_f32 v76, v76, v77
    v_cvt_pk_bf16_f32 v77, v78, v79
    ds_wrxchg_rtn_b64 v[72:73], v94, v[76:77] offset:65408
    v_and_b32 v88, 0x0fffffff, v27
    buffer_load_dwordx2 v[22:23], v88, s[8:11], 0 offen
    buffer_load_dwordx3 v[24:26], v88, s[8:11], 0 offen offset:8
    v_mfma_f32_4x4x4_16b_bf16 v[80:83], v[8:9], v[102:103], 0
    v_mfma_f32_4x4x4_16b_bf16 v[76:79], v[8:9], v[100:101], 0
    v_cmp_lt_u32 s[84:85], v5, v92
    s_nop 2
    v_pk_mul_f32 v[80:81], v[80:81], v[14:15] op_sel:[0,1] op_sel_hi:[1,1]
    v_pk_mul_f32 v[82:83], v[82:83], v[14:15] op_sel:[0,1] op_sel_hi:[1,1]
    v_pk_mul_f32 v[76:77], v[76:77], v[14:15] op_sel:[0,0] op_sel_hi:[1,0]
    v_pk_mul_f32 v[78:79], v[78:79], v[14:15] op_sel:[0,0] op_sel_hi:[1,0]
    s_waitcnt vmcnt(11)
    s_mov_b64 exec, s[6:7]
    v_lshrrev_b32 v30, 16, v30
    s_mov_b64 exec, -1
    v_and_b32 v46, 0x20000000, v42
    v_lshrrev_b32 v47, 14, v29
    v_bitop3_b32 v47, v47, v5, v46 bitop3:0xea
    ds_read_b64 v[106:107], v47
    v_and_b32 v99, 0x10000000, v42
    v_lshrrev_b32 v47, 14, v28
    v_bitop3_b32 v47, v47, v5, v99 bitop3:0xea
    ds_read_b64 v[104:105], v47
    s_waitcnt lgkmcnt(2)
    v_cmp_ne_u64 s[50:51], v[72:73], v[68:69]
    v_cmpx_ne_u64 s[54:55], v[74:75], v[70:71]
    s_and_b64 s[82:83], s[54:55], s[80:81]
    s_cbranch_scc1 L2_c75
L2_d75:
    v_mov_b64 v[84:85], v[70:71]
    v_mov_b32 v7, v95
    v_mov_b64 v[86:87], v[74:75]
    s_or_b64 s[80:81], s[80:81], s[54:55]
    s_mov_b64 exec, s[50:51]
    s_and_b64 s[82:83], s[50:51], s[80:81]
    s_cbranch_scc1 L2_c76
L2_d76:
    v_mov_b64 v[84:85], v[68:69]
    v_mov_b32 v7, v94
    v_mov_b64 v[86:87], v[72:73]
    s_mov_b64 exec, -1
    s_or_b64 s[80:81], s[80:81], s[50:51]
    s_and_b64 exec, s[84:85], s[80:81]
    v_mfma_f32_4x4x4_16b_bf16 v[76:79], v[12:13], v[84:85], 0
    v_mov_b32 v92, v7
    s_andn2_b64 s[80:81], s[80:81], s[84:85]
    v_mfma_f32_4x4x4_16b_bf16 v[76:79], v[10:11], v[86:87], v[76:79]
    s_mov_b64 exec, -1
    ds_read_b64 v[70:71], v93 offset:65408
    ds_read_b64 v[68:69], v92 offset:65408
    v_bitop3_b32 v94, v28, v5, v99 bitop3:0xea
    v_bitop3_b32 v95, v29, v5, v46 bitop3:0xea
    v_perm_b32 v15, v29, v30, s45
    v_bitop3_b32 v46, v29, 0.5, -0.5 bitop3:0xa8
    v_perm_b32 v14, v28, v30, s44
    v_bitop3_b32 v47, v28, 0.5, -0.5 bitop3:0xa8
    v_bitop3_b32 v15, v6, v15, v46 bitop3:0xca
    v_bitop3_b32 v14, v6, v14, v47 bitop3:0xca
    s_waitcnt lgkmcnt(1)
    v_mfma_f32_4x4x4_16b_bf16 v[80:83], v[10:11], v[70:71], v[80:83]
    s_waitcnt lgkmcnt(0)
    v_mfma_f32_4x4x4_16b_bf16 v[76:79], v[10:11], v[68:69], v[76:79]
    s_nop 2
    v_cvt_pk_bf16_f32 v80, v80, v81
    v_cvt_pk_bf16_f32 v81, v82, v83
    ds_wrxchg_rtn_b64 v[74:75], v93, v[80:81] offset:65408
    v_cvt_pk_bf16_f32 v76, v76, v77
    v_cvt_pk_bf16_f32 v77, v78, v79
    ds_wrxchg_rtn_b64 v[72:73], v92, v[76:77] offset:65408
    s_setprio 0
    v_mfma_f32_4x4x4_16b_bf16 v[80:83], v[8:9], v[106:107], 0
    v_mfma_f32_4x4x4_16b_bf16 v[76:79], v[8:9], v[104:105], 0
    v_cmp_lt_u32 s[48:49], v5, v95
    s_nop 2
    v_pk_mul_f32 v[80:81], v[80:81], v[14:15] op_sel:[0,1] op_sel_hi:[1,1]
    v_pk_mul_f32 v[82:83], v[82:83], v[14:15] op_sel:[0,1] op_sel_hi:[1,1]
    v_pk_mul_f32 v[76:77], v[76:77], v[14:15] op_sel:[0,0] op_sel_hi:[1,0]
    v_pk_mul_f32 v[78:79], v[78:79], v[14:15] op_sel:[0,0] op_sel_hi:[1,0]
    s_add_u32 s40, s40, 0x50000
    v_and_b32 v47, 0x0fffffff, v31
    buffer_load_dword v30, v47, s[8:11], 0 offen offset:16
    s_mov_b64 exec, s[6:7]
    v_add_u32 v47, 8, v47
    v_lshrrev_b32 v31, 2, v31
    s_mov_b64 exec, -1
    buffer_load_dwordx2 v[28:29], v47, s[8:11], 0 offen
    s_waitcnt vmcnt(8)
    v_and_b32 v46, 0x80000000, v43
    v_lshrrev_b32 v47, 14, v37
    v_bitop3_b32 v47, v47, v5, v46 bitop3:0xea
    ds_read_b64 v[106:107], v47
    v_and_b32 v99, 0x40000000, v43
    v_lshrrev_b32 v47, 14, v36
    v_bitop3_b32 v47, v47, v5, v99 bitop3:0xea
    ds_read_b64 v[104:105], v47
    v_and_b32 v46, 0x20000000, v43
    v_lshrrev_b32 v47, 14, v35
    v_bitop3_b32 v47, v47, v5, v46 bitop3:0xea
    ds_read_b64 v[102:103], v47
    v_and_b32 v99, 0x10000000, v43
    v_lshrrev_b32 v47, 14, v34
    v_bitop3_b32 v47, v47, v5, v99 bitop3:0xea
    ds_read_b64 v[100:101], v47
    s_waitcnt lgkmcnt(4)
    v_cmp_ne_u64 s[50:51], v[72:73], v[68:69]
    v_cmpx_ne_u64 s[54:55], v[74:75], v[70:71]
    s_and_b64 s[82:83], s[54:55], s[80:81]
    s_cbranch_scc1 L2_c77
L2_d77:
    v_mov_b64 v[84:85], v[70:71]
    v_mov_b32 v7, v93
    v_mov_b64 v[86:87], v[74:75]
    s_or_b64 s[80:81], s[80:81], s[54:55]
    s_mov_b64 exec, s[50:51]
    s_and_b64 s[82:83], s[50:51], s[80:81]
    s_cbranch_scc1 L2_c78
L2_d78:
    v_mov_b64 v[84:85], v[68:69]
    v_mov_b32 v7, v92
    v_mov_b64 v[86:87], v[72:73]
    s_mov_b64 exec, -1
    s_or_b64 s[80:81], s[80:81], s[50:51]
    s_and_b64 exec, s[48:49], s[80:81]
    v_mfma_f32_4x4x4_16b_bf16 v[80:83], v[12:13], v[84:85], 0
    v_mov_b32 v95, v7
    s_andn2_b64 s[80:81], s[80:81], s[48:49]
    v_mfma_f32_4x4x4_16b_bf16 v[80:83], v[10:11], v[86:87], v[80:83]
    s_mov_b64 exec, -1
    ds_read_b64 v[70:71], v95 offset:65408
    ds_read_b64 v[68:69], v94 offset:65408
    v_bitop3_b32 v92, v34, v5, v99 bitop3:0xea
    v_bitop3_b32 v93, v35, v5, v46 bitop3:0xea
    v_perm_b32 v15, v35, v38, s45
    v_bitop3_b32 v46, v35, 0.5, -0.5 bitop3:0xa8
    v_perm_b32 v14, v34, v38, s44
    v_bitop3_b32 v47, v34, 0.5, -0.5 bitop3:0xa8
    v_bitop3_b32 v15, v6, v15, v46 bitop3:0xca
    v_bitop3_b32 v14, v6, v14, v47 bitop3:0xca
    s_waitcnt lgkmcnt(1)
    v_mfma_f32_4x4x4_16b_bf16 v[80:83], v[10:11], v[70:71], v[80:83]
    s_waitcnt lgkmcnt(0)
    v_mfma_f32_4x4x4_16b_bf16 v[76:79], v[10:11], v[68:69], v[76:79]
    s_nop 2
    v_cvt_pk_bf16_f32 v80, v80, v81
    v_cvt_pk_bf16_f32 v81, v82, v83
    ds_wrxchg_rtn_b64 v[74:75], v95, v[80:81] offset:65408
    v_cvt_pk_bf16_f32 v76, v76, v77
    v_cvt_pk_bf16_f32 v77, v78, v79
    ds_wrxchg_rtn_b64 v[72:73], v94, v[76:77] offset:65408
    s_barrier
    s_setprio 3
    s_mov_b32 m0, s100
    s_nop 0
    ds_write_addtid_b32 v124 offset:34816
    ds_write_addtid_b32 v125 offset:35072
    ds_write_addtid_b32 v126 offset:35328
    ds_write_addtid_b32 v127 offset:35584
    s_add_u32 s3, s40, 4096
    buffer_load_dwordx4 v[124:127], v3, s[16:19], s3 offen sc1
    ds_write_addtid_b32 v116 offset:32768
    ds_write_addtid_b32 v117 offset:33024
    ds_write_addtid_b32 v118 offset:33280
    ds_write_addtid_b32 v119 offset:33536
    buffer_load_dwordx4 v[116:119], v3, s[16:19], s40 offen offset:2048 sc1
    ds_write_addtid_b32 v120 offset:33792
    ds_write_addtid_b32 v121 offset:34048
    ds_write_addtid_b32 v122 offset:34304
    ds_write_addtid_b32 v123 offset:34560
    buffer_load_dwordx4 v[120:123], v3, s[16:19], s40 offen offset:3072 sc1
    v_mfma_f32_4x4x4_16b_bf16 v[80:83], v[8:9], v[102:103], 0
    v_mfma_f32_4x4x4_16b_bf16 v[76:79], v[8:9], v[100:101], 0
    s_nop 3
    v_pk_mul_f32 v[80:81], v[80:81], v[14:15] op_sel:[0,1] op_sel_hi:[1,1]
    v_pk_mul_f32 v[82:83], v[82:83], v[14:15] op_sel:[0,1] op_sel_hi:[1,1]
    v_pk_mul_f32 v[76:77], v[76:77], v[14:15] op_sel:[0,0] op_sel_hi:[1,0]
    v_pk_mul_f32 v[78:79], v[78:79], v[14:15] op_sel:[0,0] op_sel_hi:[1,0]
    s_cmp_gt_u32 s37, 1024
    s_cbranch_scc1 L2_xs79
    s_cmp_lg_u32 s101, 0
    s_cbranch_scc1 L2_xa79
L2_xb79:
    v_lshlrev_b32 v89, 16, v96
    v_add_u32 v90, 60, v97
    v_bitop3_b32 v90, v89, v45, v90 bitop3:0x6a
    ds_write_b32 v98, v90 offset:12
    v_lshlrev_b32 v89, 20, v96
    v_add_u32 v90, 40, v97
    v_bitop3_b32 v90, v89, v45, v90 bitop3:0x6a
    ds_write_b32 v98, v90 offset:8
    v_lshlrev_b32 v89, 24, v96
    v_add_u32 v90, 20, v97
    v_bitop3_b32 v90, v89, v45, v90 bitop3:0x6a
    ds_write_b32 v98, v90 offset:4
    v_lshlrev_b32 v89, 28, v96
    v_bitop3_b32 v90, v89, v45, v97 bitop3:0x6a
    ds_write_b32 v98, v90 offset:0
    v_mov_b32_dpp v91, v66 quad_perm:[0,0,0,0] row_mask:0xf bank_mask:0xf
    v_and_b32 v89, 3, v91
    v_and_b32 v97, 0xfffc, v91
    v_sub_u16_dpp v88, v66, v91 quad_perm:[2,2,2,2] row_mask:0xf bank_mask:0xf
    v_mad_u32_u24 v97, v97, 5, v4
    v_add_u32 v99, v88, v89
    v_bfm_b32 v96, v88, v89
    v_cmp_lt_u32 s[58:59], 16, v99
    v_lshlrev_b32 v89, v1, v96
    v_and_b32 v89, v45, v89
    v_cmp_ne_u32 vcc, 0, v89
    v_xor_b32 v90, v97, v89
    s_add_u32 s3, s37, s38
    v_mbcnt_lo_u32_b32 v98, vcc_lo, 0
    v_mbcnt_hi_u32_b32 v98, vcc_hi, v98
    s_bcnt1_i32_b64 s41, vcc
    v_lshl_add_u32 v98, v98, 2, s3
    s_lshl2_add_u32 s37, s41, s37
    s_mov_b64 exec, vcc
    ds_write_b32 v98, v90
    s_mov_b64 exec, -1
    s_cmp_lg_u64 s[58:59], 0
    s_cbranch_scc1 L2_xe79
L2_xr79:
    v_add_u32 v98, s37, v0
    v_mov_b32 v90, -1
    ds_write_b32 v98, v90
L2_xw79:
    s_setprio 2
    s_waitcnt lgkmcnt(14)
    v_cmp_ne_u64 s[50:51], v[72:73], v[68:69]
    v_cmpx_ne_u64 s[54:55], v[74:75], v[70:71]
    s_and_b64 s[82:83], s[54:55], s[80:81]
    s_cbranch_scc1 L2_c80
L2_d80:
    v_mov_b64 v[84:85], v[70:71]
    v_mov_b32 v7, v95
    v_mov_b64 v[86:87], v[74:75]
    s_or_b64 s[80:81], s[80:81], s[54:55]
    s_mov_b64 exec, s[50:51]
    s_and_b64 s[82:83], s[50:51], s[80:81]
    s_cbranch_scc1 L2_c81
L2_d81:
    v_mov_b64 v[84:85], v[68:69]
    v_mov_b32 v7, v94
    v_mov_b64 v[86:87], v[72:73]
    s_mov_b64 exec, -1
    s_or_b64 s[80:81], s[80:81], s[50:51]
    ds_read_b64 v[70:71], v93 offset:65408
    ds_read_b64 v[68:69], v92 offset:65408
    v_and_b32 v46, 0x40000000, v43
    v_bitop3_b32 v94, v36, v5, v46 bitop3:0xea
    v_and_b32 v46, 0x80000000, v43
    v_bitop3_b32 v95, v37, v5, v46 bitop3:0xea
    v_perm_b32 v15, v37, v38, s47
    v_bitop3_b32 v46, v37, 0.5, -0.5 bitop3:0xa8
    v_perm_b32 v14, v36, v38, s46
    v_bitop3_b32 v47, v36, 0.5, -0.5 bitop3:0xa8
    v_bitop3_b32 v15, v6, v15, v46 bitop3:0xca
    v_bitop3_b32 v14, v6, v14, v47 bitop3:0xca
    s_setprio 1
    s_waitcnt lgkmcnt(1)
    v_mfma_f32_4x4x4_16b_bf16 v[80:83], v[10:11], v[70:71], v[80:83]
    s_waitcnt lgkmcnt(0)
    v_mfma_f32_4x4x4_16b_bf16 v[76:79], v[10:11], v[68:69], v[76:79]
    s_nop 2
    v_cvt_pk_bf16_f32 v80, v80, v81
    v_cvt_pk_bf16_f32 v81, v82, v83
    ds_wrxchg_rtn_b64 v[74:75], v93, v[80:81] offset:65408
    v_cvt_pk_bf16_f32 v76, v76, v77
    v_cvt_pk_bf16_f32 v77, v78, v79
    ds_wrxchg_rtn_b64 v[72:73], v92, v[76:77] offset:65408
    ds_read_b32 v40, v0 offset:0
    ds_read_b32 v41, v0 offset:256
    ds_read_b32 v42, v44 offset:768
    ds_read_b32 v43, v0 offset:512
    s_sub_u32 s3, s37, 768
    s_cmp_gt_u32 s3, 128
    s_cbranch_scc1 L2_xf79
L2_xg79:
    v_and_b32 v88, 0x0fffffff, v39
    buffer_load_dwordx2 v[34:35], v88, s[8:11], 0 offen
    buffer_load_dwordx3 v[36:38], v88, s[8:11], 0 offen offset:8
    s_setprio 0
    s_waitcnt vmcnt(12)
    s_mov_b32 m0, s38
    s_nop 0
    ds_write_addtid_b32 v108 offset:0
    ds_write_addtid_b32 v109 offset:256
    ds_write_addtid_b32 v110 offset:512
    ds_write_addtid_b32 v111 offset:768
    s_waitcnt vmcnt(9)
    ds_write_addtid_b32 v112 offset:1024
    ds_write_addtid_b32 v113 offset:1280
    ds_write_addtid_b32 v114 offset:1536
    ds_write_addtid_b32 v115 offset:1792
    v_mfma_f32_4x4x4_16b_bf16 v[80:83], v[8:9], v[106:107], 0
    v_mfma_f32_4x4x4_16b_bf16 v[76:79], v[8:9], v[104:105], 0
    v_cmp_lt_u32 s[84:85], v5, v94
    s_nop 2
    v_pk_mul_f32 v[80:81], v[80:81], v[14:15] op_sel:[0,1] op_sel_hi:[1,1]
    v_pk_mul_f32 v[82:83], v[82:83], v[14:15] op_sel:[0,1] op_sel_hi:[1,1]
    v_pk_mul_f32 v[76:77], v[76:77], v[14:15] op_sel:[0,0] op_sel_hi:[1,0]
    v_pk_mul_f32 v[78:79], v[78:79], v[14:15] op_sel:[0,0] op_sel_hi:[1,0]
    s_add_u32 s42, s42, 1
    s_waitcnt lgkmcnt(0)
    s_barrier
    s_bitcmp1_b32 s36, s42
    s_cbranch_scc1 L2_slow
L2_ret4:
    s_setprio 3
    s_bitcmp1_b32 s43, s42
    s_cbranch_scc1 L2_oa82
L2_ob82:
    v_and_b32 v46, 0x20000000, v21
    v_lshrrev_b32 v47, 14, v17
    v_bitop3_b32 v47, v47, v5, v46 bitop3:0xea
    ds_read_b64 v[102:103], v47
    v_and_b32 v99, 0x10000000, v21
    v_lshrrev_b32 v47, 14, v16
    v_bitop3_b32 v47, v47, v5, v99 bitop3:0xea
    ds_read_b64 v[100:101], v47
    v_cmp_ne_u64 s[50:51], v[72:73], v[68:69]
    v_cmpx_ne_u64 s[54:55], v[74:75], v[70:71]
    s_and_b64 s[82:83], s[54:55], s[80:81]
    s_cbranch_scc1 L2_c83
L2_d83:
    v_mov_b64 v[84:85], v[70:71]
    v_mov_b32 v7, v93
    v_mov_b64 v[86:87], v[74:75]
    s_or_b64 s[80:81], s[80:81], s[54:55]
    s_mov_b64 exec, s[50:51]
    s_and_b64 s[82:83], s[50:51], s[80:81]
    s_cbranch_scc1 L2_c84
L2_d84:
    v_mov_b64 v[84:85], v[68:69]
    v_mov_b32 v7, v92
    v_mov_b64 v[86:87], v[72:73]
    s_mov_b64 exec, -1
    s_or_b64 s[80:81], s[80:81], s[50:51]
    s_and_b64 exec, s[84:85], s[80:81]
    v_mfma_f32_4x4x4_16b_bf16 v[76:79], v[12:13], v[84:85], 0
    v_mov_b32 v94, v7
    s_andn2_b64 s[80:81], s[80:81], s[84:85]
    v_mfma_f32_4x4x4_16b_bf16 v[76:79], v[10:11], v[86:87], v[76:79]
    s_mov_b64 exec, -1
    ds_read_b64 v[70:71], v95 offset:65408
    ds_read_b64 v[68:69], v94 offset:65408
    v_bitop3_b32 v92, v16, v5, v99 bitop3:0xea
    v_bitop3_b32 v93, v17, v5, v46 bitop3:0xea
    v_perm_b32 v15, v17, v20, s45
    v_bitop3_b32 v46, v17, 0.5, -0.5 bitop3:0xa8
    v_perm_b32 v14, v16, v20, s44
    v_bitop3_b32 v47, v16, 0.5, -0.5 bitop3:0xa8
    v_bitop3_b32 v15, v6, v15, v46 bitop3:0xca
    v_bitop3_b32 v14, v6, v14, v47 bitop3:0xca
    s_waitcnt lgkmcnt(1)
    v_mfma_f32_4x4x4_16b_bf16 v[80:83], v[10:11], v[70:71], v[80:83]
    s_waitcnt lgkmcnt(0)
    v_mfma_f32_4x4x4_16b_bf16 v[76:79], v[10:11], v[68:69], v[76:79]
    s_nop 2
    v_cvt_pk_bf16_f32 v80, v80, v81
    v_cvt_pk_bf16_f32 v81, v82, v83
    ds_wrxchg_rtn_b64 v[74:75], v95, v[80:81] offset:65408
    v_cvt_pk_bf16_f32 v76, v76, v77
    v_cvt_pk_bf16_f32 v77, v78, v79
    ds_wrxchg_rtn_b64 v[72:73], v94, v[76:77] offset:65408
    v_mfma_f32_4x4x4_16b_bf16 v[80:83], v[8:9], v[102:103], 0
    v_mfma_f32_4x4x4_16b_bf16 v[76:79], v[8:9], v[100:101], 0
    v_cmp_lt_u32 s[84:85], v5, v92
    s_nop 2
    v_pk_mul_f32 v[80:81], v[80:81], v[14:15] op_sel:[0,1] op_sel_hi:[1,1]
    v_pk_mul_f32 v[82:83], v[82:83], v[14:15] op_sel:[0,1] op_sel_hi:[1,1]
    v_pk_mul_f32 v[76:77], v[76:77], v[14:15] op_sel:[0,0] op_sel_hi:[1,0]
    v_pk_mul_f32 v[78:79], v[78:79], v[14:15] op_sel:[0,0] op_sel_hi:[1,0]
    buffer_load_dwordx4 v[108:111], v3, s[16:19], s40 offen offset:0 sc1
    v_and_b32 v46, 0x80000000, v21
    v_lshrrev_b32 v47, 14, v19
    v_bitop3_b32 v47, v47, v5, v46 bitop3:0xea
    ds_read_b64 v[106:107], v47
    v_and_b32 v99, 0x40000000, v21
    v_lshrrev_b32 v47, 14, v18
    v_bitop3_b32 v47, v47, v5, v99 bitop3:0xea
    ds_read_b64 v[104:105], v47
    s_waitcnt lgkmcnt(2)
    v_cmp_ne_u64 s[50:51], v[72:73], v[68:69]
    v_cmpx_ne_u64 s[54:55], v[74:75], v[70:71]
    s_and_b64 s[82:83], s[54:55], s[80:81]
    s_cbranch_scc1 L2_c85
L2_d85:
    v_mov_b64 v[84:85], v[70:71]
    v_mov_b32 v7, v95
    v_mov_b64 v[86:87], v[74:75]
    s_or_b64 s[80:81], s[80:81], s[54:55]
    s_mov_b64 exec, s[50:51]
    s_and_b64 s[82:83], s[50:51], s[80:81]
    s_cbranch_scc1 L2_c86
L2_d86:
    v_mov_b64 v[84:85], v[68:69]
    v_mov_b32 v7, v94
    v_mov_b64 v[86:87], v[72:73]
    s_mov_b64 exec, -1
    s_or_b64 s[80:81], s[80:81], s[50:51]
    s_and_b64 exec, s[84:85], s[80:81]
    v_mfma_f32_4x4x4_16b_bf16 v[76:79], v[12:13], v[84:85], 0
    v_mov_b32 v92, v7
    s_andn2_b64 s[80:81], s[80:81], s[84:85]
    v_mfma_f32_4x4x4_16b_bf16 v[76:79], v[10:11], v[86:87], v[76:79]
    s_mov_b64 exec, -1
    ds_read_b64 v[70:71], v93 offset:65408
    ds_read_b64 v[68:69], v92 offset:65408
    v_bitop3_b32 v94, v18, v5, v99 bitop3:0xea
    v_bitop3_b32 v95, v19, v5, v46 bitop3:0xea
    v_perm_b32 v15, v19, v20, s47
    v_bitop3_b32 v46, v19, 0.5, -0.5 bitop3:0xa8
    v_perm_b32 v14, v18, v20, s46
    v_bitop3_b32 v47, v18, 0.5, -0.5 bitop3:0xa8
    v_bitop3_b32 v15, v6, v15, v46 bitop3:0xca
    v_bitop3_b32 v14, v6, v14, v47 bitop3:0xca
    s_waitcnt lgkmcnt(1)
    v_mfma_f32_4x4x4_16b_bf16 v[80:83], v[10:11], v[70:71], v[80:83]
    s_waitcnt lgkmcnt(0)
    v_mfma_f32_4x4x4_16b_bf16 v[76:79], v[10:11], v[68:69], v[76:79]
    s_nop 2
    v_cvt_pk_bf16_f32 v80, v80, v81
    v_cvt_pk_bf16_f32 v81, v82, v83
    ds_wrxchg_rtn_b64 v[74:75], v93, v[80:81] offset:65408
    v_cvt_pk_bf16_f32 v76, v76, v77
    v_cvt_pk_bf16_f32 v77, v78, v79
    ds_wrxchg_rtn_b64 v[72:73], v92, v[76:77] offset:65408
    v_and_b32 v88, 0x0fffffff, v40
    buffer_load_dwordx2 v[16:17], v88, s[8:11], 0 offen
    buffer_load_dwordx3 v[18:20], v88, s[8:11], 0 offen offset:8
    s_setprio 2
    v_mfma_f32_4x4x4_16b_bf16 v[80:83], v[8:9], v[106:107], 0
    v_mfma_f32_4x4x4_16b_bf16 v[76:79], v[8:9], v[104:105], 0
    v_cmp_lt_u32 s[48:49], v5, v95
    s_nop 2
    v_pk_mul_f32 v[80:81], v[80:81], v[14:15] op_sel:[0,1] op_sel_hi:[1,1]
    v_pk_mul_f32 v[82:83], v[82:83], v[14:15] op_sel:[0,1] op_sel_hi:[1,1]
    v_pk_mul_f32 v[76:77], v[76:77], v[14:15] op_sel:[0,0] op_sel_hi:[1,0]
    v_pk_mul_f32 v[78:79], v[78:79], v[14:15] op_sel:[0,0] op_sel_hi:[1,0]
    s_waitcnt vmcnt(10)
    v_and_b32 v46, 0x20000000, v27
    v_lshrrev_b32 v47, 14, v23
    v_bitop3_b32 v47, v47, v5, v46 bitop3:0xea
    ds_read_b64 v[102:103], v47
    v_and_b32 v99, 0x10000000, v27
    v_lshrrev_b32 v47, 14, v22
    v_bitop3_b32 v47, v47, v5, v99 bitop3:0xea
    ds_read_b64 v[100:101], v47
    s_waitcnt lgkmcnt(2)
    v_cmp_ne_u64 s[50:51], v[72:73], v[68:69]
    v_cmpx_ne_u64 s[54:55], v[74:75], v[70:71]
    s_and_b64 s[82:83], s[54:55], s[80:81]
    s_cbranch_scc1 L2_c87
L2_d87:
    v_mov_b64 v[84:85], v[70:71]
    v_mov_b32 v7, v93
    v_mov_b64 v[86:87], v[74:75]
    s_or_b64 s[80:81], s[80:81], s[54:55]
    s_mov_b64 exec, s[50:51]
    s_and_b64 s[82:83], s[50:51], s[80:81]
    s_cbranch_scc1 L2_c88
L2_d88:
    v_mov_b64 v[84:85], v[68:69]
    v_mov_b32 v7, v92
    v_mov_b64 v[86:87], v[72:73]
    s_mov_b64 exec, -1
    s_or_b64 s[80:81], s[80:81], s[50:51]
    s_and_b64 exec, s[48:49], s[80:81]
    v_mfma_f32_4x4x4_16b_bf16 v[80:83], v[12:13], v[84:85], 0
    v_mov_b32 v95, v7
    s_andn2_b64 s[80:81], s[80:81], s[48:49]
    v_mfma_f32_4x4x4_16b_bf16 v[80:83], v[10:11], v[86:87], v[80:83]
    s_mov_b64 exec, -1
    ds_read_b64 v[70:71], v95 offset:65408
    ds_read_b64 v[68:69], v94 offset:65408
    v_bitop3_b32 v92, v22, v5, v99 bitop3:0xea
    v_bitop3_b32 v93, v23, v5, v46 bitop3:0xea
    v_perm_b32 v15, v23, v26, s45
    v_bitop3_b32 v46, v23, 0.5, -0.5 bitop3:0xa8
    v_perm_b32 v14, v22, v26, s44
    v_bitop3_b32 v47, v22, 0.5, -0.5 bitop3:0xa8
    v_bitop3_b32 v15, v6, v15, v46 bitop3:0xca
    v_bitop3_b32 v14, v6, v14, v47 bitop3:0xca
    s_waitcnt lgkmcnt(1)
    v_mfma_f32_4x4x4_16b_bf16 v[80:83], v[10:11], v[70:71], v[80:83]
    s_waitcnt lgkmcnt(0)
    v_mfma_f32_4x4x4_16b_bf16 v[76:79], v[10:11], v[68:69], v[76:79]
    s_nop 2
    v_cvt_pk_bf16_f32 v80, v80, v81
    v_cvt_pk_bf16_f32 v81, v82, v83
    ds_wrxchg_rtn_b64 v[74:75], v95, v[80:81] offset:65408
    v_cvt_pk_bf16_f32 v76, v76, v77
    v_cvt_pk_bf16_f32 v77, v78, v79
    ds_wrxchg_rtn_b64 v[72:73], v94, v[76:77] offset:65408
    s_setprio 1
    v_mfma_f32_4x4x4_16b_bf16 v[80:83], v[8:9], v[102:103], 0
    v_mfma_f32_4x4x4_16b_bf16 v[76:79], v[8:9], v[100:101], 0
    s_nop 3
    v_pk_mul_f32 v[80:81], v[80:81], v[14:15] op_sel:[0,1] op_sel_hi:[1,1]
    v_pk_mul_f32 v[82:83], v[82:83], v[14:15] op_sel:[0,1] op_sel_hi:[1,1]
    v_pk_mul_f32 v[76:77], v[76:77], v[14:15] op_sel:[0,0] op_sel_hi:[1,0]
    v_pk_mul_f32 v[78:79], v[78:79], v[14:15] op_sel:[0,0] op_sel_hi:[1,0]
    s_bitcmp1_b32 s43, s42
    s_cbranch_scc1 L2_oa89
L2_ob89:
    buffer_load_dwordx4 v[112:115], v3, s[16:19], s40 offen offset:1024 sc1
    v_sub_u16 v88, v60, v52
    v_and_b32 v89, 3, v52
    v_add3_u32 v99, v88, v89, 3
    v_and_b32 v99, -4, v99
    v_max_u32 v99, 4, v99
    v_and_b32 v97, 0xfffc, v52
    v_bfm_b32 v96, v88, v89
    v_add_u32_dpp v91, v99, v99 row_shr:1 row_mask:0xf bank_mask:0xf bound_ctrl:1
    v_mad_u32_u24 v97, v97, 5, v2
    v_cmp_lt_u32 vcc, 16, v99
    v_add_u32_dpp v91, v91, v91 row_shr:2 row_mask:0xf bank_mask:0xf bound_ctrl:1
    v_sub_u32 v98, s38, v99
    v_lshrrev_b64 v[52:53], 16, v[52:53]
    v_add_u32_dpp v91, v91, v91 row_shr:4 row_mask:0xf bank_mask:0xf bound_ctrl:1
    v_lshrrev_b64 v[60:61], 16, v[60:61]
    s_mov_b32 s101, 0
    v_add_u32_dpp v91, v91, v91 row_shr:8 row_mask:0xf bank_mask:0xf bound_ctrl:1
    s_nop 1
    v_add_u32_dpp v91, v91, v91 row_bcast:15 row_mask:0xa bank_mask:0xf
    s_nop 1
    v_add_u32_dpp v91, v91, v91 row_bcast:31 row_mask:0xc bank_mask:0xf
    v_add_u32 v98, v98, v91
    v_readlane_b32 s37, v91, 63
    s_cbranch_vccnz L2_xo90
L2_xp90:
    v_and_b32 v46, 0x80000000, v27
    v_lshrrev_b32 v47, 14, v25
    v_bitop3_b32 v47, v47, v5, v46 bitop3:0xea
    ds_read_b64 v[106:107], v47
    v_and_b32 v99, 0x40000000, v27
    v_lshrrev_b32 v47, 14, v24
    v_bitop3_b32 v47, v47, v5, v99 bitop3:0xea
    ds_read_b64 v[104:105], v47
    s_waitcnt lgkmcnt(2)
    v_cmp_ne_u64 s[50:51], v[72:73], v[68:69]
    v_cmpx_ne_u64 s[54:55], v[74:75], v[70:71]
    s_and_b64 s[82:83], s[54:55], s[80:81]
    s_cbranch_scc1 L2_c91
L2_d91:
    v_mov_b64 v[84:85], v[70:71]
    v_mov_b32 v7, v95
    v_mov_b64 v[86:87], v[74:75]
    s_or_b64 s[80:81], s[80:81], s[54:55]
    s_mov_b64 exec, s[50:51]
    s_and_b64 s[82:83], s[50:51], s[80:81]
    s_cbranch_scc1 L2_c92
L2_d92:
    v_mov_b64 v[84:85], v[68:69]
    v_mov_b32 v7, v94
    v_mov_b64 v[86:87], v[72:73]
    s_mov_b64 exec, -1
    s_or_b64 s[80:81], s[80:81], s[50:51]
    ds_read_b64 v[70:71], v93 offset:65408
    ds_read_b64 v[68:69], v92 offset:65408
    v_bitop3_b32 v94, v24, v5, v99 bitop3:0xea
    v_bitop3_b32 v95, v25, v5, v46 bitop3:0xea
    v_perm_b32 v15, v25, v26, s47
    v_bitop3_b32 v46, v25, 0.5, -0.5 bitop3:0xa8
    v_perm_b32 v14, v24, v26, s46
    v_bitop3_b32 v47, v24, 0.5, -0.5 bitop3:0xa8
    v_bitop3_b32 v15, v6, v15, v46 bitop3:0xca
    v_bitop3_b32 v14, v6, v14, v47 bitop3:0xca
    s_waitcnt lgkmcnt(1)
    v_mfma_f32_4x4x4_16b_bf16 v[80:83], v[10:11], v[70:71], v[80:83]
    s_waitcnt lgkmcnt(0)
    v_mfma_f32_4x4x4_16b_bf16 v[76:79], v[10:11], v[68:69], v[76:79]
    s_nop 2
    v_cvt_pk_bf16_f32 v80, v80, v81
    v_cvt_pk_bf16_f32 v81, v82, v83
    ds_wrxchg_rtn_b64 v[74:75], v93, v[80:81] offset:65408
    v_cvt_pk_bf16_f32 v76, v76, v77
    v_cvt_pk_bf16_f32 v77, v78, v79
    ds_wrxchg_rtn_b64 v[72:73], v92, v[76:77] offset:65408
    v_and_b32 v88, 0x0fffffff, v41
    buffer_load_dwordx2 v[22:23], v88, s[8:11], 0 offen
    buffer_load_dwordx3 v[24:26], v88, s[8:11], 0 offen offset:8
    v_mfma_f32_4x4x4_16b_bf16 v[80:83], v[8:9], v[106:107], 0
    v_mfma_f32_4x4x4_16b_bf16 v[76:79], v[8:9], v[104:105], 0
    v_cmp_lt_u32 s[84:85], v5, v94
    s_nop 2
    v_pk_mul_f32 v[80:81], v[80:81], v[14:15] op_sel:[0,1] op_sel_hi:[1,1]
    v_pk_mul_f32 v[82:83], v[82:83], v[14:15] op_sel:[0,1] op_sel_hi:[1,1]
    v_pk_mul_f32 v[76:77], v[76:77], v[14:15] op_sel:[0,0] op_sel_hi:[1,0]
    v_pk_mul_f32 v[78:79], v[78:79], v[14:15] op_sel:[0,0] op_sel_hi:[1,0]
    s_waitcnt vmcnt(11)
    s_mov_b64 exec, s[6:7]
    v_lshrrev_b32 v30, 16, v30
    s_mov_b64 exec, -1
    v_and_b32 v46, 0x20000000, v31
    v_lshrrev_b32 v47, 14, v29
    v_bitop3_b32 v47, v47, v5, v46 bitop3:0xea
    ds_read_b64 v[102:103], v47
    v_and_b32 v99, 0x10000000, v31
    v_lshrrev_b32 v47, 14, v28
    v_bitop3_b32 v47, v47, v5, v99 bitop3:0xea
    ds_read_b64 v[100:101], v47
    s_waitcnt lgkmcnt(2)
    v_cmp_ne_u64 s[50:51], v[72:73], v[68:69]
    v_cmpx_ne_u64 s[54:55], v[74:75], v[70:71]
    s_and_b64 s[82:83], s[54:55], s[80:81]
    s_cbranch_scc1 L2_c93
L2_d93:
    v_mov_b64 v[84:85], v[70:71]
    v_mov_b32 v7, v93
    v_mov_b64 v[86:87], v[74:75]
    s_or_b64 s[80:81], s[80:81], s[54:55]
    s_mov_b64 exec, s[50:51]
    s_and_b64 s[82:83], s[50:51], s[80:81]
    s_cbranch_scc1 L2_c94
L2_d94:
    v_mov_b64 v[84:85], v[68:69]
    v_mov_b32 v7, v92
    v_mov_b64 v[86:87], v[72:73]
    s_mov_b64 exec, -1
    s_or_b64 s[80:81], s[80:81], s[50:51]
    s_and_b64 exec, s[84:85], s[80:81]
    v_mfma_f32_4x4x4_16b_bf16 v[76:79], v[12:13], v[84:85], 0
    v_mov_b32 v94, v7
    s_andn2_b64 s[80:81], s[80:81], s[84:85]
    v_mfma_f32_4x4x4_16b_bf16 v[76:79], v[10:11], v[86:87], v[76:79]
    s_mov_b64 exec, -1
    ds_read_b64 v[70:71], v95 offset:65408
    ds_read_b64 v[68:69], v94 offset:65408
    v_bitop3_b32 v92, v28, v5, v99 bitop3:0xea
    v_bitop3_b32 v93, v29, v5, v46 bitop3:0xea
    v_perm_b32 v15, v29, v30, s45
    v_bitop3_b32 v46, v29, 0.5, -0.5 bitop3:0xa8
    v_perm_b32 v14, v28, v30, s44
    v_bitop3_b32 v47, v28, 0.5, -0.5 bitop3:0xa8
    v_bitop3_b32 v15, v6, v15, v46 bitop3:0xca
    v_bitop3_b32 v14, v6, v14, v47 bitop3:0xca
    s_waitcnt lgkmcnt(1)
    v_mfma_f32_4x4x4_16b_bf16 v[80:83], v[10:11], v[70:71], v[80:83]
    s_waitcnt lgkmcnt(0)
    v_mfma_f32_4x4x4_16b_bf16 v[76:79], v[10:11], v[68:69], v[76:79]
    s_nop 2
    v_cvt_pk_bf16_f32 v80, v80, v81
    v_cvt_pk_bf16_f32 v81, v82, v83
    ds_wrxchg_rtn_b64 v[74:75], v95, v[80:81] offset:65408
    v_cvt_pk_bf16_f32 v76, v76, v77
    v_cvt_pk_bf16_f32 v77, v78, v79
    ds_wrxchg_rtn_b64 v[72:73], v94, v[76:77] offset:65408
    s_setprio 0
    v_mfma_f32_4x4x4_16b_bf16 v[80:83], v[8:9], v[102:103], 0
    v_mfma_f32_4x4x4_16b_bf16 v[76:79], v[8:9], v[100:101], 0
    v_cmp_lt_u32 s[48:49], v5, v93
    s_nop 2
    v_pk_mul_f32 v[80:81], v[80:81], v[14:15] op_sel:[0,1] op_sel_hi:[1,1]
    v_pk_mul_f32 v[82:83], v[82:83], v[14:15] op_sel:[0,1] op_sel_hi:[1,1]
    v_pk_mul_f32 v[76:77], v[76:77], v[14:15] op_sel:[0,0] op_sel_hi:[1,0]
    v_pk_mul_f32 v[78:79], v[78:79], v[14:15] op_sel:[0,0] op_sel_hi:[1,0]
    s_add_u32 s40, s40, 0x50000
    v_and_b32 v47, 0x0fffffff, v42
    buffer_load_dword v30, v47, s[8:11], 0 offen offset:16
    s_mov_b64 exec, s[6:7]
    v_add_u32 v47, 8, v47
    v_lshrrev_b32 v42, 2, v42
    s_mov_b64 exec, -1
    buffer_load_dwordx2 v[28:29], v47, s[8:11], 0 offen
    s_waitcnt vmcnt(8)
    v_and_b32 v46, 0x80000000, v39
    v_lshrrev_b32 v47, 14, v37
    v_bitop3_b32 v47, v47, v5, v46 bitop3:0xea
    ds_read_b64 v[102:103], v47
    v_and_b32 v99, 0x40000000, v39
    v_lshrrev_b32 v47, 14, v36
    v_bitop3_b32 v47, v47, v5, v99 bitop3:0xea
    ds_read_b64 v[100:101], v47
    v_and_b32 v46, 0x20000000, v39
    v_lshrrev_b32 v47, 14, v35
    v_bitop3_b32 v47, v47, v5, v46 bitop3:0xea
    ds_read_b64 v[106:107], v47
    v_and_b32 v99, 0x10000000, v39
    v_lshrrev_b32 v47, 14, v34
    v_bitop3_b32 v47, v47, v5, v99 bitop3:0xea
    ds_read_b64 v[104:105], v47
    s_waitcnt lgkmcnt(4)
    v_cmp_ne_u64 s[50:51], v[72:73], v[68:69]
    v_cmpx_ne_u64 s[54:55], v[74:75], v[70:71]
    s_and_b64 s[82:83], s[54:55], s[80:81]
    s_cbranch_scc1 L2_c95
L2_d95:
    v_mov_b64 v[84:85], v[70:71]
    v_mov_b32 v7, v95
    v_mov_b64 v[86:87], v[74:75]
    s_or_b64 s[80:81], s[80:81], s[54:55]
    s_mov_b64 exec, s[50:51]
    s_and_b64 s[82:83], s[50:51], s[80:81]
    s_cbranch_scc1 L2_c96
L2_d96:
    v_mov_b64 v[84:85], v[68:69]
    v_mov_b32 v7, v94
    v_mov_b64 v[86:87], v[72:73]
    s_mov_b64 exec, -1
    s_or_b64 s[80:81], s[80:81], s[50:51]
    s_and_b64 exec, s[48:49], s[80:81]
    v_mfma_f32_4x4x4_16b_bf16 v[80:83], v[12:13], v[84:85], 0
    v_mov_b32 v93, v7
    s_andn2_b64 s[80:81], s[80:81], s[48:49]
    v_mfma_f32_4x4x4_16b_bf16 v[80:83], v[10:11], v[86:87], v[80:83]
    s_mov_b64 exec, -1
    ds_read_b64 v[70:71], v93 offset:65408
    ds_read_b64 v[68:69], v92 offset:65408
    v_bitop3_b32 v94, v34, v5, v99 bitop3:0xea
    v_bitop3_b32 v95, v35, v5, v46 bitop3:0xea
    v_perm_b32 v15, v35, v38, s45
    v_bitop3_b32 v46, v35, 0.5, -0.5 bitop3:0xa8
    v_perm_b32 v14, v34, v38, s44
    v_bitop3_b32 v47, v34, 0.5, -0.5 bitop3:0xa8
    v_bitop3_b32 v15, v6, v15, v46 bitop3:0xca
    v_bitop3_b32 v14, v6, v14, v47 bitop3:0xca
    s_waitcnt lgkmcnt(1)
    v_mfma_f32_4x4x4_16b_bf16 v[80:83], v[10:11], v[70:71], v[80:83]
    s_waitcnt lgkmcnt(0)
    v_mfma_f32_4x4x4_16b_bf16 v[76:79], v[10:11], v[68:69], v[76:79]
    s_nop 2
    v_cvt_pk_bf16_f32 v80, v80, v81
    v_cvt_pk_bf16_f32 v81, v82, v83
    ds_wrxchg_rtn_b64 v[74:75], v93, v[80:81] offset:65408
    v_cvt_pk_bf16_f32 v76, v76, v77
    v_cvt_pk_bf16_f32 v77, v78, v79
    ds_wrxchg_rtn_b64 v[72:73], v92, v[76:77] offset:65408
    s_barrier
    s_setprio 3
    s_mov_b32 m0, s100
    s_nop 0
    ds_write_addtid_b32 v124 offset:34816
    ds_write_addtid_b32 v125 offset:35072
    ds_write_addtid_b32 v126 offset:35328
    ds_write_addtid_b32 v127 offset:35584
    s_add_u32 s3, s40, 4096
    buffer_load_dwordx4 v[124:127], v3, s[16:19], s3 offen sc1
    ds_write_addtid_b32 v116 offset:32768
    ds_write_addtid_b32 v117 offset:33024
    ds_write_addtid_b32 v118 offset:33280
    ds_write_addtid_b32 v119 offset:33536
    buffer_load_dwordx4 v[116:119], v3, s[16:19], s40 offen offset:2048 sc1
    ds_write_addtid_b32 v120 offset:33792
    ds_write_addtid_b32 v121 offset:34048
    ds_write_addtid_b32 v122 offset:34304
    ds_write_addtid_b32 v123 offset:34560
    buffer_load_dwordx4 v[120:123], v3, s[16:19], s40 offen offset:3072 sc1
    v_mfma_f32_4x4x4_16b_bf16 v[80:83], v[8:9], v[106:107], 0
    v_mfma_f32_4x4x4_16b_bf16 v[76:79], v[8:9], v[104:105], 0
    s_nop 3
    v_pk_mul_f32 v[80:81], v[80:81], v[14:15] op_sel:[0,1] op_sel_hi:[1,1]
    v_pk_mul_f32 v[82:83], v[82:83], v[14:15] op_sel:[0,1] op_sel_hi:[1,1]
    v_pk_mul_f32 v[76:77], v[76:77], v[14:15] op_sel:[0,0] op_sel_hi:[1,0]
    v_pk_mul_f32 v[78:79], v[78:79], v[14:15] op_sel:[0,0] op_sel_hi:[1,0]
    s_cmp_gt_u32 s37, 1024
    s_cbranch_scc1 L2_xs97
    s_cmp_lg_u32 s101, 0
    s_cbranch_scc1 L2_xa97
L2_xb97:
    v_lshlrev_b32 v89, 16, v96
    v_add_u32 v90, 60, v97
    v_bitop3_b32 v90, v89, v45, v90 bitop3:0x6a
    ds_write_b32 v98, v90 offset:12
    v_lshlrev_b32 v89, 20, v96
    v_add_u32 v90, 40, v97
    v_bitop3_b32 v90, v89, v45, v90 bitop3:0x6a
    ds_write_b32 v98, v90 offset:8
    v_lshlrev_b32 v89, 24, v96
    v_add_u32 v90, 20, v97
    v_bitop3_b32 v90, v89, v45, v90 bitop3:0x6a
    ds_write_b32 v98, v90 offset:4
    v_lshlrev_b32 v89, 28, v96
    v_bitop3_b32 v90, v89, v45, v97 bitop3:0x6a
    ds_write_b32 v98, v90 offset:0
    v_mov_b32_dpp v91, v64 quad_perm:[1,1,1,1] row_mask:0xf bank_mask:0xf
    v_and_b32 v89, 3, v91
    v_and_b32 v97, 0xfffc, v91
    v_sub_u16_dpp v88, v64, v91 quad_perm:[3,3,3,3] row_mask:0xf bank_mask:0xf
    v_mad_u32_u24 v97, v97, 5, v4
    v_add_u32 v99, v88, v89
    v_bfm_b32 v96, v88, v89
    v_cmp_lt_u32 s[58:59], 16, v99
    v_lshlrev_b32 v89, v1, v96
    v_and_b32 v89, v45, v89
    v_cmp_ne_u32 vcc, 0, v89
    v_xor_b32 v90, v97, v89
    s_add_u32 s3, s37, s38
    v_mbcnt_lo_u32_b32 v98, vcc_lo, 0
    v_mbcnt_hi_u32_b32 v98, vcc_hi, v98
    s_bcnt1_i32_b64 s41, vcc
    v_lshl_add_u32 v98, v98, 2, s3
    s_lshl2_add_u32 s37, s41, s37
    s_mov_b64 exec, vcc
    ds_write_b32 v98, v90
    s_mov_b64 exec, -1
    s_cmp_lg_u64 s[58:59], 0
    s_cbranch_scc1 L2_xe97
L2_xr97:
    v_add_u32 v98, s37, v0
    v_mov_b32 v90, -1
    ds_write_b32 v98, v90
L2_xw97:
    s_setprio 2
    s_waitcnt lgkmcnt(14)
    v_cmp_ne_u64 s[50:51], v[72:73], v[68:69]
    v_cmpx_ne_u64 s[54:55], v[74:75], v[70:71]
    s_and_b64 s[82:83], s[54:55], s[80:81]
    s_cbranch_scc1 L2_c98
L2_d98:
    v_mov_b64 v[84:85], v[70:71]
    v_mov_b32 v7, v93
    v_mov_b64 v[86:87], v[74:75]
    s_or_b64 s[80:81], s[80:81], s[54:55]
    s_mov_b64 exec, s[50:51]
    s_and_b64 s[82:83], s[50:51], s[80:81]
    s_cbranch_scc1 L2_c99
L2_d99:
    v_mov_b64 v[84:85], v[68:69]
    v_mov_b32 v7, v92
    v_mov_b64 v[86:87], v[72:73]
    s_mov_b64 exec, -1
    s_or_b64 s[80:81], s[80:81], s[50:51]
    ds_read_b64 v[70:71], v95 offset:65408
    ds_read_b64 v[68:69], v94 offset:65408
    v_and_b32 v46, 0x40000000, v39
    v_bitop3_b32 v92, v36, v5, v46 bitop3:0xea
    v_and_b32 v46, 0x80000000, v39
    v_bitop3_b32 v93, v37, v5, v46 bitop3:0xea
    v_perm_b32 v15, v37, v38, s47
    v_bitop3_b32 v46, v37, 0.5, -0.5 bitop3:0xa8
    v_perm_b32 v14, v36, v38, s46
    v_bitop3_b32 v47, v36, 0.5, -0.5 bitop3:0xa8
    v_bitop3_b32 v15, v6, v15, v46 bitop3:0xca
    v_bitop3_b32 v14, v6, v14, v47 bitop3:0xca
    s_setprio 1
    s_waitcnt lgkmcnt(1)
    v_mfma_f32_4x4x4_16b_bf16 v[80:83], v[10:11], v[70:71], v[80:83]
    s_waitcnt lgkmcnt(0)
    v_mfma_f32_4x4x4_16b_bf16 v[76:79], v[10:11], v[68:69], v[76:79]
    s_nop 2
    v_cvt_pk_bf16_f32 v80, v80, v81
    v_cvt_pk_bf16_f32 v81, v82, v83
    ds_wrxchg_rtn_b64 v[74:75], v95, v[80:81] offset:65408
    v_cvt_pk_bf16_f32 v76, v76, v77
    v_cvt_pk_bf16_f32 v77, v78, v79
    ds_wrxchg_rtn_b64 v[72:73], v94, v[76:77] offset:65408
    ds_read_b32 v21, v0 offset:0
    ds_read_b32 v27, v0 offset:256
    ds_read_b32 v31, v44 offset:768
    ds_read_b32 v39, v0 offset:512
    s_sub_u32 s3, s37, 768
    s_cmp_gt_u32 s3, 128
    s_cbranch_scc1 L2_xf97
L2_xg97:
    v_and_b32 v88, 0x0fffffff, v43
    buffer_load_dwordx2 v[34:35], v88, s[8:11], 0 offen
    buffer_load_dwordx3 v[36:38], v88, s[8:11], 0 offen offset:8
    s_setprio 0
    s_waitcnt vmcnt(12)
    s_mov_b32 m0, s38
    s_nop 0
    ds_write_addtid_b32 v108 offset:0
    ds_write_addtid_b32 v109 offset:256
    ds_write_addtid_b32 v110 offset:512
    ds_write_addtid_b32 v111 offset:768
    s_waitcnt vmcnt(9)
    ds_write_addtid_b32 v112 offset:1024
    ds_write_addtid_b32 v113 offset:1280
    ds_write_addtid_b32 v114 offset:1536
    ds_write_addtid_b32 v115 offset:1792
    v_mfma_f32_4x4x4_16b_bf16 v[80:83], v[8:9], v[102:103], 0
    v_mfma_f32_4x4x4_16b_bf16 v[76:79], v[8:9], v[100:101], 0
    v_cmp_lt_u32 s[84:85], v5, v92
    s_nop 2
    v_pk_mul_f32 v[80:81], v[80:81], v[14:15] op_sel:[0,1] op_sel_hi:[1,1]
    v_pk_mul_f32 v[82:83], v[82:83], v[14:15] op_sel:[0,1] op_sel_hi:[1,1]
    v_pk_mul_f32 v[76:77], v[76:77], v[14:15] op_sel:[0,0] op_sel_hi:[1,0]
    v_pk_mul_f32 v[78:79], v[78:79], v[14:15] op_sel:[0,0] op_sel_hi:[1,0]
    s_add_u32 s42, s42, 1
    s_waitcnt lgkmcnt(0)
    s_barrier
    s_bitcmp1_b32 s36, s42
    s_cbranch_scc1 L2_slow
L2_ret5:
    s_setprio 3
    s_bitcmp1_b32 s43, s42
    s_cbranch_scc1 L2_oa100
L2_ob100:
    v_and_b32 v46, 0x20000000, v40
    v_lshrrev_b32 v47, 14, v17
    v_bitop3_b32 v47, v47, v5, v46 bitop3:0xea
    ds_read_b64 v[106:107], v47
    v_and_b32 v99, 0x10000000, v40
    v_lshrrev_b32 v47, 14, v16
    v_bitop3_b32 v47, v47, v5, v99 bitop3:0xea
    ds_read_b64 v[104:105], v47
    v_cmp_ne_u64 s[50:51], v[72:73], v[68:69]
    v_cmpx_ne_u64 s[54:55], v[74:75], v[70:71]
    s_and_b64 s[82:83], s[54:55], s[80:81]
    s_cbranch_scc1 L2_c101
L2_d101:
    v_mov_b64 v[84:85], v[70:71]
    v_mov_b32 v7, v95
    v_mov_b64 v[86:87], v[74:75]
    s_or_b64 s[80:81], s[80:81], s[54:55]
    s_mov_b64 exec, s[50:51]
    s_and_b64 s[82:83], s[50:51], s[80:81]
    s_cbranch_scc1 L2_c102
L2_d102:
    v_mov_b64 v[84:85], v[68:69]
    v_mov_b32 v7, v94
    v_mov_b64 v[86:87], v[72:73]
    s_mov_b64 exec, -1
    s_or_b64 s[80:81], s[80:81], s[50:51]
    s_and_b64 exec, s[84:85], s[80:81]
    v_mfma_f32_4x4x4_16b_bf16 v[76:79], v[12:13], v[84:85], 0
    v_mov_b32 v92, v7
    s_andn2_b64 s[80:81], s[80:81], s[84:85]
    v_mfma_f32_4x4x4_16b_bf16 v[76:79], v[10:11], v[86:87], v[76:79]
    s_mov_b64 exec, -1
    ds_read_b64 v[70:71], v93 offset:65408
    ds_read_b64 v[68:69], v92 offset:65408
    v_bitop3_b32 v94, v16, v5, v99 bitop3:0xea
    v_bitop3_b32 v95, v17, v5, v46 bitop3:0xea
    v_perm_b32 v15, v17, v20, s45
    v_bitop3_b32 v46, v17, 0.5, -0.5 bitop3:0xa8
    v_perm_b32 v14, v16, v20, s44
    v_bitop3_b32 v47, v16, 0.5, -0.5 bitop3:0xa8
    v_bitop3_b32 v15, v6, v15, v46 bitop3:0xca
    v_bitop3_b32 v14, v6, v14, v47 bitop3:0xca
    s_waitcnt lgkmcnt(1)
    v_mfma_f32_4x4x4_16b_bf16 v[80:83], v[10:11], v[70:71], v[80:83]
    s_waitcnt lgkmcnt(0)
    v_mfma_f32_4x4x4_16b_bf16 v[76:79], v[10:11], v[68:69], v[76:79]
    s_nop 2
    v_cvt_pk_bf16_f32 v80, v80, v81
    v_cvt_pk_bf16_f32 v81, v82, v83
    ds_wrxchg_rtn_b64 v[74:75], v93, v[80:81] offset:65408
    v_cvt_pk_bf16_f32 v76, v76, v77
    v_cvt_pk_bf16_f32 v77, v78, v79
    ds_wrxchg_rtn_b64 v[72:73], v92, v[76:77] offset:65408
    v_mfma_f32_4x4x4_16b_bf16 v[80:83], v[8:9], v[106:107], 0
    v_mfma_f32_4x4x4_16b_bf16 v[76:79], v[8:9], v[104:105], 0
    v_cmp_lt_u32 s[84:85], v5, v94
    s_nop 2
    v_pk_mul_f32 v[80:81], v[80:81], v[14:15] op_sel:[0,1] op_sel_hi:[1,1]
    v_pk_mul_f32 v[82:83], v[82:83], v[14:15] op_sel:[0,1] op_sel_hi:[1,1]
    v_pk_mul_f32 v[76:77], v[76:77], v[14:15] op_sel:[0,0] op_sel_hi:[1,0]
    v_pk_mul_f32 v[78:79], v[78:79], v[14:15] op_sel:[0,0] op_sel_hi:[1,0]
    buffer_load_dwordx4 v[108:111], v3, s[16:19], s40 offen offset:0 sc1
    v_and_b32 v46, 0x80000000, v40
    v_lshrrev_b32 v47, 14, v19
    v_bitop3_b32 v47, v47, v5, v46 bitop3:0xea
    ds_read_b64 v[102:103], v47
    v_and_b32 v99, 0x40000000, v40
    v_lshrrev_b32 v47, 14, v18
    v_bitop3_b32 v47, v47, v5, v99 bitop3:0xea
    ds_read_b64 v[100:101], v47
    s_waitcnt lgkmcnt(2)
    v_cmp_ne_u64 s[50:51], v[72:73], v[68:69]
    v_cmpx_ne_u64 s[54:55], v[74:75], v[70:71]
    s_and_b64 s[82:83], s[54:55], s[80:81]
    s_cbranch_scc1 L2_c103
L2_d103:
    v_mov_b64 v[84:85], v[70:71]
    v_mov_b32 v7, v93
    v_mov_b64 v[86:87], v[74:75]
    s_or_b64 s[80:81], s[80:81], s[54:55]
    s_mov_b64 exec, s[50:51]
    s_and_b64 s[82:83], s[50:51], s[80:81]
    s_cbranch_scc1 L2_c104
L2_d104:
    v_mov_b64 v[84:85], v[68:69]
    v_mov_b32 v7, v92
    v_mov_b64 v[86:87], v[72:73]
    s_mov_b64 exec, -1
    s_or_b64 s[80:81], s[80:81], s[50:51]
    s_and_b64 exec, s[84:85], s[80:81]
    v_mfma_f32_4x4x4_16b_bf16 v[76:79], v[12:13], v[84:85], 0
    v_mov_b32 v94, v7
    s_andn2_b64 s[80:81], s[80:81], s[84:85]
    v_mfma_f32_4x4x4_16b_bf16 v[76:79], v[10:11], v[86:87], v[76:79]
    s_mov_b64 exec, -1
    ds_read_b64 v[70:71], v95 offset:65408
    ds_read_b64 v[68:69], v94 offset:65408
    v_bitop3_b32 v92, v18, v5, v99 bitop3:0xea
    v_bitop3_b32 v93, v19, v5, v46 bitop3:0xea
    v_perm_b32 v15, v19, v20, s47
    v_bitop3_b32 v46, v19, 0.5, -0.5 bitop3:0xa8
    v_perm_b32 v14, v18, v20, s46
    v_bitop3_b32 v47, v18, 0.5, -0.5 bitop3:0xa8
    v_bitop3_b32 v15, v6, v15, v46 bitop3:0xca
    v_bitop3_b32 v14, v6, v14, v47 bitop3:0xca
    s_waitcnt lgkmcnt(1)
    v_mfma_f32_4x4x4_16b_bf16 v[80:83], v[10:11], v[70:71], v[80:83]
    s_waitcnt lgkmcnt(0)
    v_mfma_f32_4x4x4_16b_bf16 v[76:79], v[10:11], v[68:69], v[76:79]
    s_nop 2
    v_cvt_pk_bf16_f32 v80, v80, v81
    v_cvt_pk_bf16_f32 v81, v82, v83
    ds_wrxchg_rtn_b64 v[74:75], v95, v[80:81] offset:65408
    v_cvt_pk_bf16_f32 v76, v76, v77
    v_cvt_pk_bf16_f32 v77, v78, v79
    ds_wrxchg_rtn_b64 v[72:73], v94, v[76:77] offset:65408
    v_and_b32 v88, 0x0fffffff, v21
    buffer_load_dwordx2 v[16:17], v88, s[8:11], 0 offen
    buffer_load_dwordx3 v[18:20], v88, s[8:11], 0 offen offset:8
    s_setprio 2
    v_mfma_f32_4x4x4_16b_bf16 v[80:83], v[8:9], v[102:103], 0
    v_mfma_f32_4x4x4_16b_bf16 v[76:79], v[8:9], v[100:101], 0
    v_cmp_lt_u32 s[48:49], v5, v93
    s_nop 2
    v_pk_mul_f32 v[80:81], v[80:81], v[14:15] op_sel:[0,1] op_sel_hi:[1,1]
    v_pk_mul_f32 v[82:83], v[82:83], v[14:15] op_sel:[0,1] op_sel_hi:[1,1]
    v_pk_mul_f32 v[76:77], v[76:77], v[14:15] op_sel:[0,0] op_sel_hi:[1,0]
    v_pk_mul_f32 v[78:79], v[78:79], v[14:15] op_sel:[0,0] op_sel_hi:[1,0]
    s_waitcnt vmcnt(10)
    v_and_b32 v46, 0x20000000, v41
    v_lshrrev_b32 v47, 14, v23
    v_bitop3_b32 v47, v47, v5, v46 bitop3:0xea
    ds_read_b64 v[106:107], v47
    v_and_b32 v99, 0x10000000, v41
    v_lshrrev_b32 v47, 14, v22
    v_bitop3_b32 v47, v47, v5, v99 bitop3:0xea
    ds_read_b64 v[104:105], v47
    s_waitcnt lgkmcnt(2)
    v_cmp_ne_u64 s[50:51], v[72:73], v[68:69]
    v_cmpx_ne_u64 s[54:55], v[74:75], v[70:71]
    s_and_b64 s[82:83], s[54:55], s[80:81]
    s_cbranch_scc1 L2_c105
L2_d105:
    v_mov_b64 v[84:85], v[70:71]
    v_mov_b32 v7, v95
    v_mov_b64 v[86:87], v[74:75]
    s_or_b64 s[80:81], s[80:81], s[54:55]
    s_mov_b64 exec, s[50:51]
    s_and_b64 s[82:83], s[50:51], s[80:81]
    s_cbranch_scc1 L2_c106
L2_d106:
    v_mov_b64 v[84:85], v[68:69]
    v_mov_b32 v7, v94
    v_mov_b64 v[86:87], v[72:73]
    s_mov_b64 exec, -1
    s_or_b64 s[80:81], s[80:81], s[50:51]
    s_and_b64 exec, s[48:49], s[80:81]
    v_mfma_f32_4x4x4_16b_bf16 v[80:83], v[12:13], v[84:85], 0
    v_mov_b32 v93, v7
    s_andn2_b64 s[80:81], s[80:81], s[48:49]
    v_mfma_f32_4x4x4_16b_bf16 v[80:83], v[10:11], v[86:87], v[80:83]
    s_mov_b64 exec, -1
    ds_read_b64 v[70:71], v93 offset:65408
    ds_read_b64 v[68:69], v92 offset:65408
    v_bitop3_b32 v94, v22, v5, v99 bitop3:0xea
    v_bitop3_b32 v95, v23, v5, v46 bitop3:0xea
    v_perm_b32 v15, v23, v26, s45
    v_bitop3_b32 v46, v23, 0.5, -0.5 bitop3:0xa8
    v_perm_b32 v14, v22, v26, s44
    v_bitop3_b32 v47, v22, 0.5, -0.5 bitop3:0xa8
    v_bitop3_b32 v15, v6, v15, v46 bitop3:0xca
    v_bitop3_b32 v14, v6, v14, v47 bitop3:0xca
    s_waitcnt lgkmcnt(1)
    v_mfma_f32_4x4x4_16b_bf16 v[80:83], v[10:11], v[70:71], v[80:83]
    s_waitcnt lgkmcnt(0)
    v_mfma_f32_4x4x4_16b_bf16 v[76:79], v[10:11], v[68:69], v[76:79]
    s_nop 2
    v_cvt_pk_bf16_f32 v80, v80, v81
    v_cvt_pk_bf16_f32 v81, v82, v83
    ds_wrxchg_rtn_b64 v[74:75], v93, v[80:81] offset:65408
    v_cvt_pk_bf16_f32 v76, v76, v77
    v_cvt_pk_bf16_f32 v77, v78, v79
    ds_wrxchg_rtn_b64 v[72:73], v92, v[76:77] offset:65408
    s_setprio 1
    v_mfma_f32_4x4x4_16b_bf16 v[80:83], v[8:9], v[106:107], 0
    v_mfma_f32_4x4x4_16b_bf16 v[76:79], v[8:9], v[104:105], 0
    s_nop 3
    v_pk_mul_f32 v[80:81], v[80:81], v[14:15] op_sel:[0,1] op_sel_hi:[1,1]
    v_pk_mul_f32 v[82:83], v[82:83], v[14:15] op_sel:[0,1] op_sel_hi:[1,1]
    v_pk_mul_f32 v[76:77], v[76:77], v[14:15] op_sel:[0,0] op_sel_hi:[1,0]
    v_pk_mul_f32 v[78:79], v[78:79], v[14:15] op_sel:[0,0] op_sel_hi:[1,0]
    s_bitcmp1_b32 s43, s42
    s_cbranch_scc1 L2_oa107
L2_ob107:
    buffer_load_dwordx4 v[112:115], v3, s[16:19], s40 offen offset:1024 sc1
    v_sub_u16 v88, v62, v54
    v_and_b32 v89, 3, v54
    v_add3_u32 v99, v88, v89, 3
    v_and_b32 v99, -4, v99
    v_max_u32 v99, 4, v99
    v_and_b32 v97, 0xfffc, v54
    v_bfm_b32 v96, v88, v89
    v_add_u32_dpp v91, v99, v99 row_shr:1 row_mask:0xf bank_mask:0xf bound_ctrl:1
    v_mad_u32_u24 v97, v97, 5, v2
    v_cmp_lt_u32 vcc, 16, v99
    v_add_u32_dpp v91, v91, v91 row_shr:2 row_mask:0xf bank_mask:0xf bound_ctrl:1
    v_sub_u32 v98, s38, v99
    v_lshrrev_b64 v[54:55], 16, v[54:55]
    v_add_u32_dpp v91, v91, v91 row_shr:4 row_mask:0xf bank_mask:0xf bound_ctrl:1
    v_lshrrev_b64 v[62:63], 16, v[62:63]
    s_mov_b32 s101, 0
    v_add_u32_dpp v91, v91, v91 row_shr:8 row_mask:0xf bank_mask:0xf bound_ctrl:1
    s_nop 1
    v_add_u32_dpp v91, v91, v91 row_bcast:15 row_mask:0xa bank_mask:0xf
    s_nop 1
    v_add_u32_dpp v91, v91, v91 row_bcast:31 row_mask:0xc bank_mask:0xf
    v_add_u32 v98, v98, v91
    v_readlane_b32 s37, v91, 63
    s_cbranch_vccnz L2_xo108
L2_xp108:
    v_and_b32 v46, 0x80000000, v41
    v_lshrrev_b32 v47, 14, v25
    v_bitop3_b32 v47, v47, v5, v46 bitop3:0xea
    ds_read_b64 v[102:103], v47
    v_and_b32 v99, 0x40000000, v41
    v_lshrrev_b32 v47, 14, v24
    v_bitop3_b32 v47, v47, v5, v99 bitop3:0xea
    ds_read_b64 v[100:101], v47
    s_waitcnt lgkmcnt(2)
    v_cmp_ne_u64 s[50:51], v[72:73], v[68:69]
    v_cmpx_ne_u64 s[54:55], v[74:75], v[70:71]
    s_and_b64 s[82:83], s[54:55], s[80:81]
    s_cbranch_scc1 L2_c109
L2_d109:
    v_mov_b64 v[84:85], v[70:71]
    v_mov_b32 v7, v93
    v_mov_b64 v[86:87], v[74:75]
    s_or_b64 s[80:81], s[80:81], s[54:55]
    s_mov_b64 exec, s[50:51]
    s_and_b64 s[82:83], s[50:51], s[80:81]
    s_cbranch_scc1 L2_c110
L2_d110:
    v_mov_b64 v[84:85], v[68:69]
    v_mov_b32 v7, v92
    v_mov_b64 v[86:87], v[72:73]
    s_mov_b64 exec, -1
    s_or_b64 s[80:81], s[80:81], s[50:51]
    ds_read_b64 v[70:71], v95 offset:65408
    ds_read_b64 v[68:69], v94 offset:65408
    v_bitop3_b32 v92, v24, v5, v99 bitop3:0xea
    v_bitop3_b32 v93, v25, v5, v46 bitop3:0xea
    v_perm_b32 v15, v25, v26, s47
    v_bitop3_b32 v46, v25, 0.5, -0.5 bitop3:0xa8
    v_perm_b32 v14, v24, v26, s46
    v_bitop3_b32 v47, v24, 0.5, -0.5 bitop3:0xa8
    v_bitop3_b32 v15, v6, v15, v46 bitop3:0xca
    v_bitop3_b32 v14, v6, v14, v47 bitop3:0xca
    s_waitcnt lgkmcnt(1)
    v_mfma_f32_4x4x4_16b_bf16 v[80:83], v[10:11], v[70:71], v[80:83]
    s_waitcnt lgkmcnt(0)
    v_mfma_f32_4x4x4_16b_bf16 v[76:79], v[10:11], v[68:69], v[76:79]
    s_nop 2
    v_cvt_pk_bf16_f32 v80, v80, v81
    v_cvt_pk_bf16_f32 v81, v82, v83
    ds_wrxchg_rtn_b64 v[74:75], v95, v[80:81] offset:65408
    v_cvt_pk_bf16_f32 v76, v76, v77
    v_cvt_pk_bf16_f32 v77, v78, v79
    ds_wrxchg_rtn_b64 v[72:73], v94, v[76:77] offset:65408
    v_and_b32 v88, 0x0fffffff, v27
    buffer_load_dwordx2 v[22:23], v88, s[8:11], 0 offen
    buffer_load_dwordx3 v[24:26], v88, s[8:11], 0 offen offset:8
    v_mfma_f32_4x4x4_16b_bf16 v[80:83], v[8:9], v[102:103], 0
    v_mfma_f32_4x4x4_16b_bf16 v[76:79], v[8:9], v[100:101], 0
    v_cmp_lt_u32 s[84:85], v5, v92
    s_nop 2
    v_pk_mul_f32 v[80:81], v[80:81], v[14:15] op_sel:[0,1] op_sel_hi:[1,1]
    v_pk_mul_f32 v[82:83], v[82:83], v[14:15] op_sel:[0,1] op_sel_hi:[1,1]
    v_pk_mul_f32 v[76:77], v[76:77], v[14:15] op_sel:[0,0] op_sel_hi:[1,0]
    v_pk_mul_f32 v[78:79], v[78:79], v[14:15] op_sel:[0,0] op_sel_hi:[1,0]
    s_waitcnt vmcnt(11)
    s_mov_b64 exec, s[6:7]
    v_lshrrev_b32 v30, 16, v30
    s_mov_b64 exec, -1
    v_and_b32 v46, 0x20000000, v42
    v_lshrrev_b32 v47, 14, v29
    v_bitop3_b32 v47, v47, v5, v46 bitop3:0xea
    ds_read_b64 v[106:107], v47
    v_and_b32 v99, 0x10000000, v42
    v_lshrrev_b32 v47, 14, v28
    v_bitop3_b32 v47, v47, v5, v99 bitop3:0xea
    ds_read_b64 v[104:105], v47
    s_waitcnt lgkmcnt(2)
    v_cmp_ne_u64 s[50:51], v[72:73], v[68:69]
    v_cmpx_ne_u64 s[54:55], v[74:75], v[70:71]
    s_and_b64 s[82:83], s[54:55], s[80:81]
    s_cbranch_scc1 L2_c111
L2_d111:
    v_mov_b64 v[84:85], v[70:71]
    v_mov_b32 v7, v95
    v_mov_b64 v[86:87], v[74:75]
    s_or_b64 s[80:81], s[80:81], s[54:55]
    s_mov_b64 exec, s[50:51]
    s_and_b64 s[82:83], s[50:51], s[80:81]
    s_cbranch_scc1 L2_c112
L2_d112:
    v_mov_b64 v[84:85], v[68:69]
    v_mov_b32 v7, v94
    v_mov_b64 v[86:87], v[72:73]
    s_mov_b64 exec, -1
    s_or_b64 s[80:81], s[80:81], s[50:51]
    s_and_b64 exec, s[84:85], s[80:81]
    v_mfma_f32_4x4x4_16b_bf16 v[76:79], v[12:13], v[84:85], 0
    v_mov_b32 v92, v7
    s_andn2_b64 s[80:81], s[80:81], s[84:85]
    v_mfma_f32_4x4x4_16b_bf16 v[76:79], v[10:11], v[86:87], v[76:79]
    s_mov_b64 exec, -1
    ds_read_b64 v[70:71], v93 offset:65408
    ds_read_b64 v[68:69], v92 offset:65408
    v_bitop3_b32 v94, v28, v5, v99 bitop3:0xea
    v_bitop3_b32 v95, v29, v5, v46 bitop3:0xea
    v_perm_b32 v15, v29, v30, s45
    v_bitop3_b32 v46, v29, 0.5, -0.5 bitop3:0xa8
    v_perm_b32 v14, v28, v30, s44
    v_bitop3_b32 v47, v28, 0.5, -0.5 bitop3:0xa8
    v_bitop3_b32 v15, v6, v15, v46 bitop3:0xca
    v_bitop3_b32 v14, v6, v14, v47 bitop3:0xca
    s_waitcnt lgkmcnt(1)
    v_mfma_f32_4x4x4_16b_bf16 v[80:83], v[10:11], v[70:71], v[80:83]
    s_waitcnt lgkmcnt(0)
    v_mfma_f32_4x4x4_16b_bf16 v[76:79], v[10:11], v[68:69], v[76:79]
    s_nop 2
    v_cvt_pk_bf16_f32 v80, v80, v81
    v_cvt_pk_bf16_f32 v81, v82, v83
    ds_wrxchg_rtn_b64 v[74:75], v93, v[80:81] offset:65408
    v_cvt_pk_bf16_f32 v76, v76, v77
    v_cvt_pk_bf16_f32 v77, v78, v79
    ds_wrxchg_rtn_b64 v[72:73], v92, v[76:77] offset:65408
    s_setprio 0
    v_mfma_f32_4x4x4_16b_bf16 v[80:83], v[8:9], v[106:107], 0
    v_mfma_f32_4x4x4_16b_bf16 v[76:79], v[8:9], v[104:105], 0
    v_cmp_lt_u32 s[48:49], v5, v95
    s_nop 2
    v_pk_mul_f32 v[80:81], v[80:81], v[14:15] op_sel:[0,1] op_sel_hi:[1,1]
    v_pk_mul_f32 v[82:83], v[82:83], v[14:15] op_sel:[0,1] op_sel_hi:[1,1]
    v_pk_mul_f32 v[76:77], v[76:77], v[14:15] op_sel:[0,0] op_sel_hi:[1,0]
    v_pk_mul_f32 v[78:79], v[78:79], v[14:15] op_sel:[0,0] op_sel_hi:[1,0]
    s_add_u32 s40, s40, 0x50000
    v_and_b32 v47, 0x0fffffff, v31
    buffer_load_dword v30, v47, s[8:11], 0 offen offset:16
    s_mov_b64 exec, s[6:7]
    v_add_u32 v47, 8, v47
    v_lshrrev_b32 v31, 2, v31
    s_mov_b64 exec, -1
    buffer_load_dwordx2 v[28:29], v47, s[8:11], 0 offen
    s_waitcnt vmcnt(8)
    v_and_b32 v46, 0x80000000, v43
    v_lshrrev_b32 v47, 14, v37
    v_bitop3_b32 v47, v47, v5, v46 bitop3:0xea
    ds_read_b64 v[106:107], v47
    v_and_b32 v99, 0x40000000, v43
    v_lshrrev_b32 v47, 14, v36
    v_bitop3_b32 v47, v47, v5, v99 bitop3:0xea
    ds_read_b64 v[104:105], v47
    v_and_b32 v46, 0x20000000, v43
    v_lshrrev_b32 v47, 14, v35
    v_bitop3_b32 v47, v47, v5, v46 bitop3:0xea
    ds_read_b64 v[102:103], v47
    v_and_b32 v99, 0x10000000, v43
    v_lshrrev_b32 v47, 14, v34
    v_bitop3_b32 v47, v47, v5, v99 bitop3:0xea
    ds_read_b64 v[100:101], v47
    s_waitcnt lgkmcnt(4)
    v_cmp_ne_u64 s[50:51], v[72:73], v[68:69]
    v_cmpx_ne_u64 s[54:55], v[74:75], v[70:71]
    s_and_b64 s[82:83], s[54:55], s[80:81]
    s_cbranch_scc1 L2_c113
L2_d113:
    v_mov_b64 v[84:85], v[70:71]
    v_mov_b32 v7, v93
    v_mov_b64 v[86:87], v[74:75]
    s_or_b64 s[80:81], s[80:81], s[54:55]
    s_mov_b64 exec, s[50:51]
    s_and_b64 s[82:83], s[50:51], s[80:81]
    s_cbranch_scc1 L2_c114
L2_d114:
    v_mov_b64 v[84:85], v[68:69]
    v_mov_b32 v7, v92
    v_mov_b64 v[86:87], v[72:73]
    s_mov_b64 exec, -1
    s_or_b64 s[80:81], s[80:81], s[50:51]
    s_and_b64 exec, s[48:49], s[80:81]
    v_mfma_f32_4x4x4_16b_bf16 v[80:83], v[12:13], v[84:85], 0
    v_mov_b32 v95, v7
    s_andn2_b64 s[80:81], s[80:81], s[48:49]
    v_mfma_f32_4x4x4_16b_bf16 v[80:83], v[10:11], v[86:87], v[80:83]
    s_mov_b64 exec, -1
    ds_read_b64 v[70:71], v95 offset:65408
    ds_read_b64 v[68:69], v94 offset:65408
    v_bitop3_b32 v92, v34, v5, v99 bitop3:0xea
    v_bitop3_b32 v93, v35, v5, v46 bitop3:0xea
    v_perm_b32 v15, v35, v38, s45
    v_bitop3_b32 v46, v35, 0.5, -0.5 bitop3:0xa8
    v_perm_b32 v14, v34, v38, s44
    v_bitop3_b32 v47, v34, 0.5, -0.5 bitop3:0xa8
    v_bitop3_b32 v15, v6, v15, v46 bitop3:0xca
    v_bitop3_b32 v14, v6, v14, v47 bitop3:0xca
    s_waitcnt lgkmcnt(1)
    v_mfma_f32_4x4x4_16b_bf16 v[80:83], v[10:11], v[70:71], v[80:83]
    s_waitcnt lgkmcnt(0)
    v_mfma_f32_4x4x4_16b_bf16 v[76:79], v[10:11], v[68:69], v[76:79]
    s_nop 2
    v_cvt_pk_bf16_f32 v80, v80, v81
    v_cvt_pk_bf16_f32 v81, v82, v83
    ds_wrxchg_rtn_b64 v[74:75], v95, v[80:81] offset:65408
    v_cvt_pk_bf16_f32 v76, v76, v77
    v_cvt_pk_bf16_f32 v77, v78, v79
    ds_wrxchg_rtn_b64 v[72:73], v94, v[76:77] offset:65408
    s_barrier
    s_setprio 3
    s_mov_b32 m0, s100
    s_nop 0
    ds_write_addtid_b32 v124 offset:34816
    ds_write_addtid_b32 v125 offset:35072
    ds_write_addtid_b32 v126 offset:35328
    ds_write_addtid_b32 v127 offset:35584
    s_add_u32 s3, s40, 4096
    buffer_load_dwordx4 v[124:127], v3, s[16:19], s3 offen sc1
    ds_write_addtid_b32 v116 offset:32768
    ds_write_addtid_b32 v117 offset:33024
    ds_write_addtid_b32 v118 offset:33280
    ds_write_addtid_b32 v119 offset:33536
    buffer_load_dwordx4 v[116:119], v3, s[16:19], s40 offen offset:2048 sc1
    ds_write_addtid_b32 v120 offset:33792
    ds_write_addtid_b32 v121 offset:34048
    ds_write_addtid_b32 v122 offset:34304
    ds_write_addtid_b32 v123 offset:34560
    buffer_load_dwordx4 v[120:123], v3, s[16:19], s40 offen offset:3072 sc1
    v_mfma_f32_4x4x4_16b_bf16 v[80:83], v[8:9], v[102:103], 0
    v_mfma_f32_4x4x4_16b_bf16 v[76:79], v[8:9], v[100:101], 0
    s_nop 3
    v_pk_mul_f32 v[80:81], v[80:81], v[14:15] op_sel:[0,1] op_sel_hi:[1,1]
    v_pk_mul_f32 v[82:83], v[82:83], v[14:15] op_sel:[0,1] op_sel_hi:[1,1]
    v_pk_mul_f32 v[76:77], v[76:77], v[14:15] op_sel:[0,0] op_sel_hi:[1,0]
    v_pk_mul_f32 v[78:79], v[78:79], v[14:15] op_sel:[0,0] op_sel_hi:[1,0]
    s_cmp_gt_u32 s37, 1024
    s_cbranch_scc1 L2_xs115
    s_cmp_lg_u32 s101, 0
    s_cbranch_scc1 L2_xa115
L2_xb115:
    v_lshlrev_b32 v89, 16, v96
    v_add_u32 v90, 60, v97
    v_bitop3_b32 v90, v89, v45, v90 bitop3:0x6a
    ds_write_b32 v98, v90 offset:12
    v_lshlrev_b32 v89, 20, v96
    v_add_u32 v90, 40, v97
    v_bitop3_b32 v90, v89, v45, v90 bitop3:0x6a
    ds_write_b32 v98, v90 offset:8
    v_lshlrev_b32 v89, 24, v96
    v_add_u32 v90, 20, v97
    v_bitop3_b32 v90, v89, v45, v90 bitop3:0x6a
    ds_write_b32 v98, v90 offset:4
    v_lshlrev_b32 v89, 28, v96
    v_bitop3_b32 v90, v89, v45, v97 bitop3:0x6a
    ds_write_b32 v98, v90 offset:0
    v_mov_b32_dpp v91, v66 quad_perm:[1,1,1,1] row_mask:0xf bank_mask:0xf
    v_and_b32 v89, 3, v91
    v_and_b32 v97, 0xfffc, v91
    v_sub_u16_dpp v88, v66, v91 quad_perm:[3,3,3,3] row_mask:0xf bank_mask:0xf
    v_mad_u32_u24 v97, v97, 5, v4
    v_add_u32 v99, v88, v89
    v_bfm_b32 v96, v88, v89
    v_cmp_lt_u32 s[58:59], 16, v99
    v_lshlrev_b32 v89, v1, v96
    v_and_b32 v89, v45, v89
    v_cmp_ne_u32 vcc, 0, v89
    v_xor_b32 v90, v97, v89
    s_add_u32 s3, s37, s38
    v_mbcnt_lo_u32_b32 v98, vcc_lo, 0
    v_mbcnt_hi_u32_b32 v98, vcc_hi, v98
    s_bcnt1_i32_b64 s41, vcc
    v_lshl_add_u32 v98, v98, 2, s3
    s_lshl2_add_u32 s37, s41, s37
    s_mov_b64 exec, vcc
    ds_write_b32 v98, v90
    s_mov_b64 exec, -1
    s_cmp_lg_u64 s[58:59], 0
    s_cbranch_scc1 L2_xe115
L2_xr115:
    v_add_u32 v98, s37, v0
    v_mov_b32 v90, -1
    ds_write_b32 v98, v90
L2_xw115:
    s_setprio 2
    s_waitcnt lgkmcnt(14)
    v_cmp_ne_u64 s[50:51], v[72:73], v[68:69]
    v_cmpx_ne_u64 s[54:55], v[74:75], v[70:71]
    s_and_b64 s[82:83], s[54:55], s[80:81]
    s_cbranch_scc1 L2_c116
L2_d116:
    v_mov_b64 v[84:85], v[70:71]
    v_mov_b32 v7, v95
    v_mov_b64 v[86:87], v[74:75]
    s_or_b64 s[80:81], s[80:81], s[54:55]
    s_mov_b64 exec, s[50:51]
    s_and_b64 s[82:83], s[50:51], s[80:81]
    s_cbranch_scc1 L2_c117
L2_d117:
    v_mov_b64 v[84:85], v[68:69]
    v_mov_b32 v7, v94
    v_mov_b64 v[86:87], v[72:73]
    s_mov_b64 exec, -1
    s_or_b64 s[80:81], s[80:81], s[50:51]
    ds_read_b64 v[70:71], v93 offset:65408
    ds_read_b64 v[68:69], v92 offset:65408
    v_and_b32 v46, 0x40000000, v43
    v_bitop3_b32 v94, v36, v5, v46 bitop3:0xea
    v_and_b32 v46, 0x80000000, v43
    v_bitop3_b32 v95, v37, v5, v46 bitop3:0xea
    v_perm_b32 v15, v37, v38, s47
    v_bitop3_b32 v46, v37, 0.5, -0.5 bitop3:0xa8
    v_perm_b32 v14, v36, v38, s46
    v_bitop3_b32 v47, v36, 0.5, -0.5 bitop3:0xa8
    v_bitop3_b32 v15, v6, v15, v46 bitop3:0xca
    v_bitop3_b32 v14, v6, v14, v47 bitop3:0xca
    s_setprio 1
    s_waitcnt lgkmcnt(1)
    v_mfma_f32_4x4x4_16b_bf16 v[80:83], v[10:11], v[70:71], v[80:83]
    s_waitcnt lgkmcnt(0)
    v_mfma_f32_4x4x4_16b_bf16 v[76:79], v[10:11], v[68:69], v[76:79]
    s_nop 2
    v_cvt_pk_bf16_f32 v80, v80, v81
    v_cvt_pk_bf16_f32 v81, v82, v83
    ds_wrxchg_rtn_b64 v[74:75], v93, v[80:81] offset:65408
    v_cvt_pk_bf16_f32 v76, v76, v77
    v_cvt_pk_bf16_f32 v77, v78, v79
    ds_wrxchg_rtn_b64 v[72:73], v92, v[76:77] offset:65408
    ds_read_b32 v40, v0 offset:0
    ds_read_b32 v41, v0 offset:256
    ds_read_b32 v42, v44 offset:768
    ds_read_b32 v43, v0 offset:512
    s_sub_u32 s3, s37, 768
    s_cmp_gt_u32 s3, 128
    s_cbranch_scc1 L2_xf115
L2_xg115:
    v_lshrrev_b64 v[64:65], 16, v[64:65]
    v_lshrrev_b64 v[66:67], 16, v[66:67]
    v_and_b32 v88, 0x0fffffff, v39
    buffer_load_dwordx2 v[34:35], v88, s[8:11], 0 offen
    buffer_load_dwordx3 v[36:38], v88, s[8:11], 0 offen offset:8
    s_setprio 0
    s_waitcnt vmcnt(12)
    s_mov_b32 m0, s38
    s_nop 0
    ds_write_addtid_b32 v108 offset:0
    ds_write_addtid_b32 v109 offset:256
    ds_write_addtid_b32 v110 offset:512
    ds_write_addtid_b32 v111 offset:768
    s_waitcnt vmcnt(9)
    ds_write_addtid_b32 v112 offset:1024
    ds_write_addtid_b32 v113 offset:1280
    ds_write_addtid_b32 v114 offset:1536
    ds_write_addtid_b32 v115 offset:1792
    v_mfma_f32_4x4x4_16b_bf16 v[80:83], v[8:9], v[106:107], 0
    v_mfma_f32_4x4x4_16b_bf16 v[76:79], v[8:9], v[104:105], 0
    v_cmp_lt_u32 s[84:85], v5, v94
    s_nop 2
    v_pk_mul_f32 v[80:81], v[80:81], v[14:15] op_sel:[0,1] op_sel_hi:[1,1]
    v_pk_mul_f32 v[82:83], v[82:83], v[14:15] op_sel:[0,1] op_sel_hi:[1,1]
    v_pk_mul_f32 v[76:77], v[76:77], v[14:15] op_sel:[0,0] op_sel_hi:[1,0]
    v_pk_mul_f32 v[78:79], v[78:79], v[14:15] op_sel:[0,0] op_sel_hi:[1,0]
    s_add_u32 s42, s42, 1
    s_waitcnt lgkmcnt(0)
    s_cmp_lg_u32 s42, 14
    s_cbranch_scc1 L2_loop
    s_barrier
    s_bitcmp1_b32 s36, s42
    s_cbranch_scc1 L2_slow
L2_ret6:
    s_setprio 3
    s_bitcmp1_b32 s43, s42
    s_cbranch_scc1 L2_oa118
L2_ob118:
    v_and_b32 v46, 0x20000000, v21
    v_lshrrev_b32 v47, 14, v17
    v_bitop3_b32 v47, v47, v5, v46 bitop3:0xea
    ds_read_b64 v[102:103], v47
    v_and_b32 v99, 0x10000000, v21
    v_lshrrev_b32 v47, 14, v16
    v_bitop3_b32 v47, v47, v5, v99 bitop3:0xea
    ds_read_b64 v[100:101], v47
    v_cmp_ne_u64 s[50:51], v[72:73], v[68:69]
    v_cmpx_ne_u64 s[54:55], v[74:75], v[70:71]
    s_and_b64 s[82:83], s[54:55], s[80:81]
    s_cbranch_scc1 L2_c119
L2_d119:
    v_mov_b64 v[84:85], v[70:71]
    v_mov_b32 v7, v93
    v_mov_b64 v[86:87], v[74:75]
    s_or_b64 s[80:81], s[80:81], s[54:55]
    s_mov_b64 exec, s[50:51]
    s_and_b64 s[82:83], s[50:51], s[80:81]
    s_cbranch_scc1 L2_c120
L2_d120:
    v_mov_b64 v[84:85], v[68:69]
    v_mov_b32 v7, v92
    v_mov_b64 v[86:87], v[72:73]
    s_mov_b64 exec, -1
    s_or_b64 s[80:81], s[80:81], s[50:51]
    s_and_b64 exec, s[84:85], s[80:81]
    v_mfma_f32_4x4x4_16b_bf16 v[76:79], v[12:13], v[84:85], 0
    v_mov_b32 v94, v7
    s_andn2_b64 s[80:81], s[80:81], s[84:85]
    v_mfma_f32_4x4x4_16b_bf16 v[76:79], v[10:11], v[86:87], v[76:79]
    s_mov_b64 exec, -1
    ds_read_b64 v[70:71], v95 offset:65408
    ds_read_b64 v[68:69], v94 offset:65408
    v_bitop3_b32 v92, v16, v5, v99 bitop3:0xea
    v_bitop3_b32 v93, v17, v5, v46 bitop3:0xea
    v_perm_b32 v15, v17, v20, s45
    v_bitop3_b32 v46, v17, 0.5, -0.5 bitop3:0xa8
    v_perm_b32 v14, v16, v20, s44
    v_bitop3_b32 v47, v16, 0.5, -0.5 bitop3:0xa8
    v_bitop3_b32 v15, v6, v15, v46 bitop3:0xca
    v_bitop3_b32 v14, v6, v14, v47 bitop3:0xca
    s_waitcnt lgkmcnt(1)
    v_mfma_f32_4x4x4_16b_bf16 v[80:83], v[10:11], v[70:71], v[80:83]
    s_waitcnt lgkmcnt(0)
    v_mfma_f32_4x4x4_16b_bf16 v[76:79], v[10:11], v[68:69], v[76:79]
    s_nop 2
    v_cvt_pk_bf16_f32 v80, v80, v81
    v_cvt_pk_bf16_f32 v81, v82, v83
    ds_wrxchg_rtn_b64 v[74:75], v95, v[80:81] offset:65408
    v_cvt_pk_bf16_f32 v76, v76, v77
    v_cvt_pk_bf16_f32 v77, v78, v79
    ds_wrxchg_rtn_b64 v[72:73], v94, v[76:77] offset:65408
    v_mfma_f32_4x4x4_16b_bf16 v[80:83], v[8:9], v[102:103], 0
    v_mfma_f32_4x4x4_16b_bf16 v[76:79], v[8:9], v[100:101], 0
    v_cmp_lt_u32 s[84:85], v5, v92
    s_nop 2
    v_pk_mul_f32 v[80:81], v[80:81], v[14:15] op_sel:[0,1] op_sel_hi:[1,1]
    v_pk_mul_f32 v[82:83], v[82:83], v[14:15] op_sel:[0,1] op_sel_hi:[1,1]
    v_pk_mul_f32 v[76:77], v[76:77], v[14:15] op_sel:[0,0] op_sel_hi:[1,0]
    v_pk_mul_f32 v[78:79], v[78:79], v[14:15] op_sel:[0,0] op_sel_hi:[1,0]
    buffer_load_dwordx4 v[108:111], v3, s[16:19], s40 offen offset:0 sc1
    v_and_b32 v46, 0x80000000, v21
    v_lshrrev_b32 v47, 14, v19
    v_bitop3_b32 v47, v47, v5, v46 bitop3:0xea
    ds_read_b64 v[106:107], v47
    v_and_b32 v99, 0x40000000, v21
    v_lshrrev_b32 v47, 14, v18
    v_bitop3_b32 v47, v47, v5, v99 bitop3:0xea
    ds_read_b64 v[104:105], v47
    s_waitcnt lgkmcnt(2)
    v_cmp_ne_u64 s[50:51], v[72:73], v[68:69]
    v_cmpx_ne_u64 s[54:55], v[74:75], v[70:71]
    s_and_b64 s[82:83], s[54:55], s[80:81]
    s_cbranch_scc1 L2_c121
L2_d121:
    v_mov_b64 v[84:85], v[70:71]
    v_mov_b32 v7, v95
    v_mov_b64 v[86:87], v[74:75]
    s_or_b64 s[80:81], s[80:81], s[54:55]
    s_mov_b64 exec, s[50:51]
    s_and_b64 s[82:83], s[50:51], s[80:81]
    s_cbranch_scc1 L2_c122
L2_d122:
    v_mov_b64 v[84:85], v[68:69]
    v_mov_b32 v7, v94
    v_mov_b64 v[86:87], v[72:73]
    s_mov_b64 exec, -1
    s_or_b64 s[80:81], s[80:81], s[50:51]
    s_and_b64 exec, s[84:85], s[80:81]
    v_mfma_f32_4x4x4_16b_bf16 v[76:79], v[12:13], v[84:85], 0
    v_mov_b32 v92, v7
    s_andn2_b64 s[80:81], s[80:81], s[84:85]
    v_mfma_f32_4x4x4_16b_bf16 v[76:79], v[10:11], v[86:87], v[76:79]
    s_mov_b64 exec, -1
    ds_read_b64 v[70:71], v93 offset:65408
    ds_read_b64 v[68:69], v92 offset:65408
    v_bitop3_b32 v94, v18, v5, v99 bitop3:0xea
    v_bitop3_b32 v95, v19, v5, v46 bitop3:0xea
    v_perm_b32 v15, v19, v20, s47
    v_bitop3_b32 v46, v19, 0.5, -0.5 bitop3:0xa8
    v_perm_b32 v14, v18, v20, s46
    v_bitop3_b32 v47, v18, 0.5, -0.5 bitop3:0xa8
    v_bitop3_b32 v15, v6, v15, v46 bitop3:0xca
    v_bitop3_b32 v14, v6, v14, v47 bitop3:0xca
    s_waitcnt lgkmcnt(1)
    v_mfma_f32_4x4x4_16b_bf16 v[80:83], v[10:11], v[70:71], v[80:83]
    s_waitcnt lgkmcnt(0)
    v_mfma_f32_4x4x4_16b_bf16 v[76:79], v[10:11], v[68:69], v[76:79]
    s_nop 2
    v_cvt_pk_bf16_f32 v80, v80, v81
    v_cvt_pk_bf16_f32 v81, v82, v83
    ds_wrxchg_rtn_b64 v[74:75], v93, v[80:81] offset:65408
    v_cvt_pk_bf16_f32 v76, v76, v77
    v_cvt_pk_bf16_f32 v77, v78, v79
    ds_wrxchg_rtn_b64 v[72:73], v92, v[76:77] offset:65408
    v_and_b32 v88, 0x0fffffff, v40
    buffer_load_dwordx2 v[16:17], v88, s[8:11], 0 offen
    buffer_load_dwordx3 v[18:20], v88, s[8:11], 0 offen offset:8
    s_setprio 2
    v_mfma_f32_4x4x4_16b_bf16 v[80:83], v[8:9], v[106:107], 0
    v_mfma_f32_4x4x4_16b_bf16 v[76:79], v[8:9], v[104:105], 0
    v_cmp_lt_u32 s[48:49], v5, v95
    s_nop 2
    v_pk_mul_f32 v[80:81], v[80:81], v[14:15] op_sel:[0,1] op_sel_hi:[1,1]
    v_pk_mul_f32 v[82:83], v[82:83], v[14:15] op_sel:[0,1] op_sel_hi:[1,1]
    v_pk_mul_f32 v[76:77], v[76:77], v[14:15] op_sel:[0,0] op_sel_hi:[1,0]
    v_pk_mul_f32 v[78:79], v[78:79], v[14:15] op_sel:[0,0] op_sel_hi:[1,0]
    s_waitcnt vmcnt(10)
    v_and_b32 v46, 0x20000000, v27
    v_lshrrev_b32 v47, 14, v23
    v_bitop3_b32 v47, v47, v5, v46 bitop3:0xea
    ds_read_b64 v[102:103], v47
    v_and_b32 v99, 0x10000000, v27
    v_lshrrev_b32 v47, 14, v22
    v_bitop3_b32 v47, v47, v5, v99 bitop3:0xea
    ds_read_b64 v[100:101], v47
    s_waitcnt lgkmcnt(2)
    v_cmp_ne_u64 s[50:51], v[72:73], v[68:69]
    v_cmpx_ne_u64 s[54:55], v[74:75], v[70:71]
    s_and_b64 s[82:83], s[54:55], s[80:81]
    s_cbranch_scc1 L2_c123
L2_d123:
    v_mov_b64 v[84:85], v[70:71]
    v_mov_b32 v7, v93
    v_mov_b64 v[86:87], v[74:75]
    s_or_b64 s[80:81], s[80:81], s[54:55]
    s_mov_b64 exec, s[50:51]
    s_and_b64 s[82:83], s[50:51], s[80:81]
    s_cbranch_scc1 L2_c124
L2_d124:
    v_mov_b64 v[84:85], v[68:69]
    v_mov_b32 v7, v92
    v_mov_b64 v[86:87], v[72:73]
    s_mov_b64 exec, -1
    s_or_b64 s[80:81], s[80:81], s[50:51]
    s_and_b64 exec, s[48:49], s[80:81]
    v_mfma_f32_4x4x4_16b_bf16 v[80:83], v[12:13], v[84:85], 0
    v_mov_b32 v95, v7
    s_andn2_b64 s[80:81], s[80:81], s[48:49]
    v_mfma_f32_4x4x4_16b_bf16 v[80:83], v[10:11], v[86:87], v[80:83]
    s_mov_b64 exec, -1
    ds_read_b64 v[70:71], v95 offset:65408
    ds_read_b64 v[68:69], v94 offset:65408
    v_bitop3_b32 v92, v22, v5, v99 bitop3:0xea
    v_bitop3_b32 v93, v23, v5, v46 bitop3:0xea
    v_perm_b32 v15, v23, v26, s45
    v_bitop3_b32 v46, v23, 0.5, -0.5 bitop3:0xa8
    v_perm_b32 v14, v22, v26, s44
    v_bitop3_b32 v47, v22, 0.5, -0.5 bitop3:0xa8
    v_bitop3_b32 v15, v6, v15, v46 bitop3:0xca
    v_bitop3_b32 v14, v6, v14, v47 bitop3:0xca
    s_waitcnt lgkmcnt(1)
    v_mfma_f32_4x4x4_16b_bf16 v[80:83], v[10:11], v[70:71], v[80:83]
    s_waitcnt lgkmcnt(0)
    v_mfma_f32_4x4x4_16b_bf16 v[76:79], v[10:11], v[68:69], v[76:79]
    s_nop 2
    v_cvt_pk_bf16_f32 v80, v80, v81
    v_cvt_pk_bf16_f32 v81, v82, v83
    ds_wrxchg_rtn_b64 v[74:75], v95, v[80:81] offset:65408
    v_cvt_pk_bf16_f32 v76, v76, v77
    v_cvt_pk_bf16_f32 v77, v78, v79
    ds_wrxchg_rtn_b64 v[72:73], v94, v[76:77] offset:65408
    s_setprio 1
    v_mfma_f32_4x4x4_16b_bf16 v[80:83], v[8:9], v[102:103], 0
    v_mfma_f32_4x4x4_16b_bf16 v[76:79], v[8:9], v[100:101], 0
    s_nop 3
    v_pk_mul_f32 v[80:81], v[80:81], v[14:15] op_sel:[0,1] op_sel_hi:[1,1]
    v_pk_mul_f32 v[82:83], v[82:83], v[14:15] op_sel:[0,1] op_sel_hi:[1,1]
    v_pk_mul_f32 v[76:77], v[76:77], v[14:15] op_sel:[0,0] op_sel_hi:[1,0]
    v_pk_mul_f32 v[78:79], v[78:79], v[14:15] op_sel:[0,0] op_sel_hi:[1,0]
    s_bitcmp1_b32 s43, s42
    s_cbranch_scc1 L2_oa125
L2_ob125:
    buffer_load_dwordx4 v[112:115], v3, s[16:19], s40 offen offset:1024 sc1
    v_and_b32 v46, 0x80000000, v27
    v_lshrrev_b32 v47, 14, v25
    v_bitop3_b32 v47, v47, v5, v46 bitop3:0xea
    ds_read_b64 v[106:107], v47
    v_and_b32 v99, 0x40000000, v27
    v_lshrrev_b32 v47, 14, v24
    v_bitop3_b32 v47, v47, v5, v99 bitop3:0xea
    ds_read_b64 v[104:105], v47
    s_waitcnt lgkmcnt(2)
    v_cmp_ne_u64 s[50:51], v[72:73], v[68:69]
    v_cmpx_ne_u64 s[54:55], v[74:75], v[70:71]
    s_and_b64 s[82:83], s[54:55], s[80:81]
    s_cbranch_scc1 L2_c126
L2_d126:
    v_mov_b64 v[84:85], v[70:71]
    v_mov_b32 v7, v95
    v_mov_b64 v[86:87], v[74:75]
    s_or_b64 s[80:81], s[80:81], s[54:55]
    s_mov_b64 exec, s[50:51]
    s_and_b64 s[82:83], s[50:51], s[80:81]
    s_cbranch_scc1 L2_c127
L2_d127:
    v_mov_b64 v[84:85], v[68:69]
    v_mov_b32 v7, v94
    v_mov_b64 v[86:87], v[72:73]
    s_mov_b64 exec, -1
    s_or_b64 s[80:81], s[80:81], s[50:51]
    ds_read_b64 v[70:71], v93 offset:65408
    ds_read_b64 v[68:69], v92 offset:65408
    v_bitop3_b32 v94, v24, v5, v99 bitop3:0xea
    v_bitop3_b32 v95, v25, v5, v46 bitop3:0xea
    v_perm_b32 v15, v25, v26, s47
    v_bitop3_b32 v46, v25, 0.5, -0.5 bitop3:0xa8
    v_perm_b32 v14, v24, v26, s46
    v_bitop3_b32 v47, v24, 0.5, -0.5 bitop3:0xa8
    v_bitop3_b32 v15, v6, v15, v46 bitop3:0xca
    v_bitop3_b32 v14, v6, v14, v47 bitop3:0xca
    s_waitcnt lgkmcnt(1)
    v_mfma_f32_4x4x4_16b_bf16 v[80:83], v[10:11], v[70:71], v[80:83]
    s_waitcnt lgkmcnt(0)
    v_mfma_f32_4x4x4_16b_bf16 v[76:79], v[10:11], v[68:69], v[76:79]
    s_nop 2
    v_cvt_pk_bf16_f32 v80, v80, v81
    v_cvt_pk_bf16_f32 v81, v82, v83
    ds_wrxchg_rtn_b64 v[74:75], v93, v[80:81] offset:65408
    v_cvt_pk_bf16_f32 v76, v76, v77
    v_cvt_pk_bf16_f32 v77, v78, v79
    ds_wrxchg_rtn_b64 v[72:73], v92, v[76:77] offset:65408
    v_and_b32 v88, 0x0fffffff, v41
    buffer_load_dwordx2 v[22:23], v88, s[8:11], 0 offen
    buffer_load_dwordx3 v[24:26], v88, s[8:11], 0 offen offset:8
    v_mfma_f32_4x4x4_16b_bf16 v[80:83], v[8:9], v[106:107], 0
    v_mfma_f32_4x4x4_16b_bf16 v[76:79], v[8:9], v[104:105], 0
    v_cmp_lt_u32 s[84:85], v5, v94
    s_nop 2
    v_pk_mul_f32 v[80:81], v[80:81], v[14:15] op_sel:[0,1] op_sel_hi:[1,1]
    v_pk_mul_f32 v[82:83], v[82:83], v[14:15] op_sel:[0,1] op_sel_hi:[1,1]
    v_pk_mul_f32 v[76:77], v[76:77], v[14:15] op_sel:[0,0] op_sel_hi:[1,0]
    v_pk_mul_f32 v[78:79], v[78:79], v[14:15] op_sel:[0,0] op_sel_hi:[1,0]
    s_waitcnt vmcnt(11)
    s_mov_b64 exec, s[6:7]
    v_lshrrev_b32 v30, 16, v30
    s_mov_b64 exec, -1
    v_and_b32 v46, 0x20000000, v31
    v_lshrrev_b32 v47, 14, v29
    v_bitop3_b32 v47, v47, v5, v46 bitop3:0xea
    ds_read_b64 v[102:103], v47
    v_and_b32 v99, 0x10000000, v31
    v_lshrrev_b32 v47, 14, v28
    v_bitop3_b32 v47, v47, v5, v99 bitop3:0xea
    ds_read_b64 v[100:101], v47
    s_waitcnt lgkmcnt(2)
    v_cmp_ne_u64 s[50:51], v[72:73], v[68:69]
    v_cmpx_ne_u64 s[54:55], v[74:75], v[70:71]
    s_and_b64 s[82:83], s[54:55], s[80:81]
    s_cbranch_scc1 L2_c128
L2_d128:
    v_mov_b64 v[84:85], v[70:71]
    v_mov_b32 v7, v93
    v_mov_b64 v[86:87], v[74:75]
    s_or_b64 s[80:81], s[80:81], s[54:55]
    s_mov_b64 exec, s[50:51]
    s_and_b64 s[82:83], s[50:51], s[80:81]
    s_cbranch_scc1 L2_c129
L2_d129:
    v_mov_b64 v[84:85], v[68:69]
    v_mov_b32 v7, v92
    v_mov_b64 v[86:87], v[72:73]
    s_mov_b64 exec, -1
    s_or_b64 s[80:81], s[80:81], s[50:51]
    s_and_b64 exec, s[84:85], s[80:81]
    v_mfma_f32_4x4x4_16b_bf16 v[76:79], v[12:13], v[84:85], 0
    v_mov_b32 v94, v7
    s_andn2_b64 s[80:81], s[80:81], s[84:85]
    v_mfma_f32_4x4x4_16b_bf16 v[76:79], v[10:11], v[86:87], v[76:79]
    s_mov_b64 exec, -1
    ds_read_b64 v[70:71], v95 offset:65408
    ds_read_b64 v[68:69], v94 offset:65408
    v_bitop3_b32 v92, v28, v5, v99 bitop3:0xea
    v_bitop3_b32 v93, v29, v5, v46 bitop3:0xea
    v_perm_b32 v15, v29, v30, s45
    v_bitop3_b32 v46, v29, 0.5, -0.5 bitop3:0xa8
    v_perm_b32 v14, v28, v30, s44
    v_bitop3_b32 v47, v28, 0.5, -0.5 bitop3:0xa8
    v_bitop3_b32 v15, v6, v15, v46 bitop3:0xca
    v_bitop3_b32 v14, v6, v14, v47 bitop3:0xca
    s_waitcnt lgkmcnt(1)
    v_mfma_f32_4x4x4_16b_bf16 v[80:83], v[10:11], v[70:71], v[80:83]
    s_waitcnt lgkmcnt(0)
    v_mfma_f32_4x4x4_16b_bf16 v[76:79], v[10:11], v[68:69], v[76:79]
    s_nop 2
    v_cvt_pk_bf16_f32 v80, v80, v81
    v_cvt_pk_bf16_f32 v81, v82, v83
    ds_wrxchg_rtn_b64 v[74:75], v95, v[80:81] offset:65408
    v_cvt_pk_bf16_f32 v76, v76, v77
    v_cvt_pk_bf16_f32 v77, v78, v79
    ds_wrxchg_rtn_b64 v[72:73], v94, v[76:77] offset:65408
    s_setprio 0
    v_mfma_f32_4x4x4_16b_bf16 v[80:83], v[8:9], v[102:103], 0
    v_mfma_f32_4x4x4_16b_bf16 v[76:79], v[8:9], v[100:101], 0
    v_cmp_lt_u32 s[48:49], v5, v93
    s_nop 2
    v_pk_mul_f32 v[80:81], v[80:81], v[14:15] op_sel:[0,1] op_sel_hi:[1,1]
    v_pk_mul_f32 v[82:83], v[82:83], v[14:15] op_sel:[0,1] op_sel_hi:[1,1]
    v_pk_mul_f32 v[76:77], v[76:77], v[14:15] op_sel:[0,0] op_sel_hi:[1,0]
    v_pk_mul_f32 v[78:79], v[78:79], v[14:15] op_sel:[0,0] op_sel_hi:[1,0]
    s_add_u32 s40, s40, 0xfff24000
    v_and_b32 v47, 0x0fffffff, v42
    buffer_load_dword v30, v47, s[8:11], 0 offen offset:16
    s_mov_b64 exec, s[6:7]
    v_add_u32 v47, 8, v47
    v_lshrrev_b32 v42, 2, v42
    s_mov_b64 exec, -1
    buffer_load_dwordx2 v[28:29], v47, s[8:11], 0 offen
    s_waitcnt vmcnt(8)
    v_and_b32 v46, 0x80000000, v39
    v_lshrrev_b32 v47, 14, v37
    v_bitop3_b32 v47, v47, v5, v46 bitop3:0xea
    ds_read_b64 v[102:103], v47
    v_and_b32 v99, 0x40000000, v39
    v_lshrrev_b32 v47, 14, v36
    v_bitop3_b32 v47, v47, v5, v99 bitop3:0xea
    ds_read_b64 v[100:101], v47
    v_and_b32 v46, 0x20000000, v39
    v_lshrrev_b32 v47, 14, v35
    v_bitop3_b32 v47, v47, v5, v46 bitop3:0xea
    ds_read_b64 v[106:107], v47
    v_and_b32 v99, 0x10000000, v39
    v_lshrrev_b32 v47, 14, v34
    v_bitop3_b32 v47, v47, v5, v99 bitop3:0xea
    ds_read_b64 v[104:105], v47
    s_waitcnt lgkmcnt(4)
    v_cmp_ne_u64 s[50:51], v[72:73], v[68:69]
    v_cmpx_ne_u64 s[54:55], v[74:75], v[70:71]
    s_and_b64 s[82:83], s[54:55], s[80:81]
    s_cbranch_scc1 L2_c130
L2_d130:
    v_mov_b64 v[84:85], v[70:71]
    v_mov_b32 v7, v95
    v_mov_b64 v[86:87], v[74:75]
    s_or_b64 s[80:81], s[80:81], s[54:55]
    s_mov_b64 exec, s[50:51]
    s_and_b64 s[82:83], s[50:51], s[80:81]
    s_cbranch_scc1 L2_c131
L2_d131:
    v_mov_b64 v[84:85], v[68:69]
    v_mov_b32 v7, v94
    v_mov_b64 v[86:87], v[72:73]
    s_mov_b64 exec, -1
    s_or_b64 s[80:81], s[80:81], s[50:51]
    s_and_b64 exec, s[48:49], s[80:81]
    v_mfma_f32_4x4x4_16b_bf16 v[80:83], v[12:13], v[84:85], 0
    v_mov_b32 v93, v7
    s_andn2_b64 s[80:81], s[80:81], s[48:49]
    v_mfma_f32_4x4x4_16b_bf16 v[80:83], v[10:11], v[86:87], v[80:83]
    s_mov_b64 exec, -1
    ds_read_b64 v[70:71], v93 offset:65408
    ds_read_b64 v[68:69], v92 offset:65408
    v_bitop3_b32 v94, v34, v5, v99 bitop3:0xea
    v_bitop3_b32 v95, v35, v5, v46 bitop3:0xea
    v_perm_b32 v15, v35, v38, s45
    v_bitop3_b32 v46, v35, 0.5, -0.5 bitop3:0xa8
    v_perm_b32 v14, v34, v38, s44
    v_bitop3_b32 v47, v34, 0.5, -0.5 bitop3:0xa8
    v_bitop3_b32 v15, v6, v15, v46 bitop3:0xca
    v_bitop3_b32 v14, v6, v14, v47 bitop3:0xca
    s_waitcnt lgkmcnt(1)
    v_mfma_f32_4x4x4_16b_bf16 v[80:83], v[10:11], v[70:71], v[80:83]
    s_waitcnt lgkmcnt(0)
    v_mfma_f32_4x4x4_16b_bf16 v[76:79], v[10:11], v[68:69], v[76:79]
    s_nop 2
    v_cvt_pk_bf16_f32 v80, v80, v81
    v_cvt_pk_bf16_f32 v81, v82, v83
    ds_wrxchg_rtn_b64 v[74:75], v93, v[80:81] offset:65408
    v_cvt_pk_bf16_f32 v76, v76, v77
    v_cvt_pk_bf16_f32 v77, v78, v79
    ds_wrxchg_rtn_b64 v[72:73], v92, v[76:77] offset:65408
    s_barrier
    s_setprio 3
    s_mov_b32 m0, s100
    s_nop 0
    ds_write_addtid_b32 v124 offset:34816
    ds_write_addtid_b32 v125 offset:35072
    ds_write_addtid_b32 v126 offset:35328
    ds_write_addtid_b32 v127 offset:35584
    ds_write_addtid_b32 v116 offset:32768
    ds_write_addtid_b32 v117 offset:33024
    ds_write_addtid_b32 v118 offset:33280
    ds_write_addtid_b32 v119 offset:33536
    ds_write_addtid_b32 v120 offset:33792
    ds_write_addtid_b32 v121 offset:34048
    ds_write_addtid_b32 v122 offset:34304
    ds_write_addtid_b32 v123 offset:34560
    v_mfma_f32_4x4x4_16b_bf16 v[80:83], v[8:9], v[106:107], 0
    v_mfma_f32_4x4x4_16b_bf16 v[76:79], v[8:9], v[104:105], 0
    s_nop 3
    v_pk_mul_f32 v[80:81], v[80:81], v[14:15] op_sel:[0,1] op_sel_hi:[1,1]
    v_pk_mul_f32 v[82:83], v[82:83], v[14:15] op_sel:[0,1] op_sel_hi:[1,1]
    v_pk_mul_f32 v[76:77], v[76:77], v[14:15] op_sel:[0,0] op_sel_hi:[1,0]
    v_pk_mul_f32 v[78:79], v[78:79], v[14:15] op_sel:[0,0] op_sel_hi:[1,0]
    s_setprio 2
    s_waitcnt lgkmcnt(12)
    v_cmp_ne_u64 s[50:51], v[72:73], v[68:69]
    v_cmpx_ne_u64 s[54:55], v[74:75], v[70:71]
    s_and_b64 s[82:83], s[54:55], s[80:81]
    s_cbranch_scc1 L2_c132
L2_d132:
    v_mov_b64 v[84:85], v[70:71]
    v_mov_b32 v7, v93
    v_mov_b64 v[86:87], v[74:75]
    s_or_b64 s[80:81], s[80:81], s[54:55]
    s_mov_b64 exec, s[50:51]
    s_and_b64 s[82:83], s[50:51], s[80:81]
    s_cbranch_scc1 L2_c133
L2_d133:
    v_mov_b64 v[84:85], v[68:69]
    v_mov_b32 v7, v92
    v_mov_b64 v[86:87], v[72:73]
    s_mov_b64 exec, -1
    s_or_b64 s[80:81], s[80:81], s[50:51]
    ds_read_b64 v[70:71], v95 offset:65408
    ds_read_b64 v[68:69], v94 offset:65408
    v_and_b32 v46, 0x40000000, v39
    v_bitop3_b32 v92, v36, v5, v46 bitop3:0xea
    v_and_b32 v46, 0x80000000, v39
    v_bitop3_b32 v93, v37, v5, v46 bitop3:0xea
    v_perm_b32 v15, v37, v38, s47
    v_bitop3_b32 v46, v37, 0.5, -0.5 bitop3:0xa8
    v_perm_b32 v14, v36, v38, s46
    v_bitop3_b32 v47, v36, 0.5, -0.5 bitop3:0xa8
    v_bitop3_b32 v15, v6, v15, v46 bitop3:0xca
    v_bitop3_b32 v14, v6, v14, v47 bitop3:0xca
    s_setprio 1
    s_waitcnt lgkmcnt(1)
    v_mfma_f32_4x4x4_16b_bf16 v[80:83], v[10:11], v[70:71], v[80:83]
    s_waitcnt lgkmcnt(0)
    v_mfma_f32_4x4x4_16b_bf16 v[76:79], v[10:11], v[68:69], v[76:79]
    s_nop 2
    v_cvt_pk_bf16_f32 v80, v80, v81
    v_cvt_pk_bf16_f32 v81, v82, v83
    ds_wrxchg_rtn_b64 v[74:75], v95, v[80:81] offset:65408
    v_cvt_pk_bf16_f32 v76, v76, v77
    v_cvt_pk_bf16_f32 v77, v78, v79
    ds_wrxchg_rtn_b64 v[72:73], v94, v[76:77] offset:65408
    v_and_b32 v88, 0x0fffffff, v43
    buffer_load_dwordx2 v[34:35], v88, s[8:11], 0 offen
    buffer_load_dwordx3 v[36:38], v88, s[8:11], 0 offen offset:8
    s_setprio 0
    s_waitcnt vmcnt(9)
    s_mov_b32 m0, s38
    s_nop 0
    ds_write_addtid_b32 v108 offset:0
    ds_write_addtid_b32 v109 offset:256
    ds_write_addtid_b32 v110 offset:512
    ds_write_addtid_b32 v111 offset:768
    s_waitcnt vmcnt(6)
    ds_write_addtid_b32 v112 offset:1024
    ds_write_addtid_b32 v113 offset:1280
    ds_write_addtid_b32 v114 offset:1536
    ds_write_addtid_b32 v115 offset:1792
    v_mfma_f32_4x4x4_16b_bf16 v[80:83], v[8:9], v[102:103], 0
    v_mfma_f32_4x4x4_16b_bf16 v[76:79], v[8:9], v[100:101], 0
    v_cmp_lt_u32 s[84:85], v5, v92
    s_nop 2
    v_pk_mul_f32 v[80:81], v[80:81], v[14:15] op_sel:[0,1] op_sel_hi:[1,1]
    v_pk_mul_f32 v[82:83], v[82:83], v[14:15] op_sel:[0,1] op_sel_hi:[1,1]
    v_pk_mul_f32 v[76:77], v[76:77], v[14:15] op_sel:[0,0] op_sel_hi:[1,0]
    v_pk_mul_f32 v[78:79], v[78:79], v[14:15] op_sel:[0,0] op_sel_hi:[1,0]
    s_add_u32 s42, s42, 1
    s_waitcnt lgkmcnt(0)
    s_barrier
    s_bitcmp1_b32 s36, s42
    s_cbranch_scc1 L2_slow
L2_ret7:
    s_setprio 3
    s_bitcmp1_b32 s43, s42
    s_cbranch_scc1 L2_oa134
L2_ob134:
    v_and_b32 v46, 0x20000000, v40
    v_lshrrev_b32 v47, 14, v17
    v_bitop3_b32 v47, v47, v5, v46 bitop3:0xea
    ds_read_b64 v[106:107], v47
    v_and_b32 v99, 0x10000000, v40
    v_lshrrev_b32 v47, 14, v16
    v_bitop3_b32 v47, v47, v5, v99 bitop3:0xea
    ds_read_b64 v[104:105], v47
    v_cmp_ne_u64 s[50:51], v[72:73], v[68:69]
    v_cmpx_ne_u64 s[54:55], v[74:75], v[70:71]
    s_and_b64 s[82:83], s[54:55], s[80:81]
    s_cbranch_scc1 L2_c135
L2_d135:
    v_mov_b64 v[84:85], v[70:71]
    v_mov_b32 v7, v95
    v_mov_b64 v[86:87], v[74:75]
    s_or_b64 s[80:81], s[80:81], s[54:55]
    s_mov_b64 exec, s[50:51]
    s_and_b64 s[82:83], s[50:51], s[80:81]
    s_cbranch_scc1 L2_c136
L2_d136:
    v_mov_b64 v[84:85], v[68:69]
    v_mov_b32 v7, v94
    v_mov_b64 v[86:87], v[72:73]
    s_mov_b64 exec, -1
    s_or_b64 s[80:81], s[80:81], s[50:51]
    s_and_b64 exec, s[84:85], s[80:81]
    v_mfma_f32_4x4x4_16b_bf16 v[76:79], v[12:13], v[84:85], 0
    v_mov_b32 v92, v7
    s_andn2_b64 s[80:81], s[80:81], s[84:85]
    v_mfma_f32_4x4x4_16b_bf16 v[76:79], v[10:11], v[86:87], v[76:79]
    s_mov_b64 exec, -1
    ds_read_b64 v[70:71], v93 offset:65408
    ds_read_b64 v[68:69], v92 offset:65408
    v_bitop3_b32 v94, v16, v5, v99 bitop3:0xea
    v_bitop3_b32 v95, v17, v5, v46 bitop3:0xea
    v_perm_b32 v15, v17, v20, s45
    v_bitop3_b32 v46, v17, 0.5, -0.5 bitop3:0xa8
    v_perm_b32 v14, v16, v20, s44
    v_bitop3_b32 v47, v16, 0.5, -0.5 bitop3:0xa8
    v_bitop3_b32 v15, v6, v15, v46 bitop3:0xca
    v_bitop3_b32 v14, v6, v14, v47 bitop3:0xca
    s_waitcnt lgkmcnt(1)
    v_mfma_f32_4x4x4_16b_bf16 v[80:83], v[10:11], v[70:71], v[80:83]
    s_waitcnt lgkmcnt(0)
    v_mfma_f32_4x4x4_16b_bf16 v[76:79], v[10:11], v[68:69], v[76:79]
    s_nop 2
    v_cvt_pk_bf16_f32 v80, v80, v81
    v_cvt_pk_bf16_f32 v81, v82, v83
    ds_wrxchg_rtn_b64 v[74:75], v93, v[80:81] offset:65408
    v_cvt_pk_bf16_f32 v76, v76, v77
    v_cvt_pk_bf16_f32 v77, v78, v79
    ds_wrxchg_rtn_b64 v[72:73], v92, v[76:77] offset:65408
    v_mfma_f32_4x4x4_16b_bf16 v[80:83], v[8:9], v[106:107], 0
    v_mfma_f32_4x4x4_16b_bf16 v[76:79], v[8:9], v[104:105], 0
    v_cmp_lt_u32 s[84:85], v5, v94
    s_nop 2
    v_pk_mul_f32 v[80:81], v[80:81], v[14:15] op_sel:[0,1] op_sel_hi:[1,1]
    v_pk_mul_f32 v[82:83], v[82:83], v[14:15] op_sel:[0,1] op_sel_hi:[1,1]
    v_pk_mul_f32 v[76:77], v[76:77], v[14:15] op_sel:[0,0] op_sel_hi:[1,0]
    v_pk_mul_f32 v[78:79], v[78:79], v[14:15] op_sel:[0,0] op_sel_hi:[1,0]
    v_and_b32 v46, 0x80000000, v40
    v_lshrrev_b32 v47, 14, v19
    v_bitop3_b32 v47, v47, v5, v46 bitop3:0xea
    ds_read_b64 v[102:103], v47
    v_and_b32 v99, 0x40000000, v40
    v_lshrrev_b32 v47, 14, v18
    v_bitop3_b32 v47, v47, v5, v99 bitop3:0xea
    ds_read_b64 v[100:101], v47
    s_waitcnt lgkmcnt(2)
    v_cmp_ne_u64 s[50:51], v[72:73], v[68:69]
    v_cmpx_ne_u64 s[54:55], v[74:75], v[70:71]
    s_and_b64 s[82:83], s[54:55], s[80:81]
    s_cbranch_scc1 L2_c137
L2_d137:
    v_mov_b64 v[84:85], v[70:71]
    v_mov_b32 v7, v93
    v_mov_b64 v[86:87], v[74:75]
    s_or_b64 s[80:81], s[80:81], s[54:55]
    s_mov_b64 exec, s[50:51]
    s_and_b64 s[82:83], s[50:51], s[80:81]
    s_cbranch_scc1 L2_c138
L2_d138:
    v_mov_b64 v[84:85], v[68:69]
    v_mov_b32 v7, v92
    v_mov_b64 v[86:87], v[72:73]
    s_mov_b64 exec, -1
    s_or_b64 s[80:81], s[80:81], s[50:51]
    s_and_b64 exec, s[84:85], s[80:81]
    v_mfma_f32_4x4x4_16b_bf16 v[76:79], v[12:13], v[84:85], 0
    v_mov_b32 v94, v7
    s_andn2_b64 s[80:81], s[80:81], s[84:85]
    v_mfma_f32_4x4x4_16b_bf16 v[76:79], v[10:11], v[86:87], v[76:79]
    s_mov_b64 exec, -1
    ds_read_b64 v[70:71], v95 offset:65408
    ds_read_b64 v[68:69], v94 offset:65408
    v_bitop3_b32 v92, v18, v5, v99 bitop3:0xea
    v_bitop3_b32 v93, v19, v5, v46 bitop3:0xea
    v_perm_b32 v15, v19, v20, s47
    v_bitop3_b32 v46, v19, 0.5, -0.5 bitop3:0xa8
    v_perm_b32 v14, v18, v20, s46
    v_bitop3_b32 v47, v18, 0.5, -0.5 bitop3:0xa8
    v_bitop3_b32 v15, v6, v15, v46 bitop3:0xca
    v_bitop3_b32 v14, v6, v14, v47 bitop3:0xca
    s_waitcnt lgkmcnt(1)
    v_mfma_f32_4x4x4_16b_bf16 v[80:83], v[10:11], v[70:71], v[80:83]
    s_waitcnt lgkmcnt(0)
    v_mfma_f32_4x4x4_16b_bf16 v[76:79], v[10:11], v[68:69], v[76:79]
    s_nop 2
    v_cvt_pk_bf16_f32 v80, v80, v81
    v_cvt_pk_bf16_f32 v81, v82, v83
    ds_wrxchg_rtn_b64 v[74:75], v95, v[80:81] offset:65408
    v_cvt_pk_bf16_f32 v76, v76, v77
    v_cvt_pk_bf16_f32 v77, v78, v79
    ds_wrxchg_rtn_b64 v[72:73], v94, v[76:77] offset:65408
    s_setprio 2
    v_mfma_f32_4x4x4_16b_bf16 v[80:83], v[8:9], v[102:103], 0
    v_mfma_f32_4x4x4_16b_bf16 v[76:79], v[8:9], v[100:101], 0
    v_cmp_lt_u32 s[48:49], v5, v93
    s_nop 2
    v_pk_mul_f32 v[80:81], v[80:81], v[14:15] op_sel:[0,1] op_sel_hi:[1,1]
    v_pk_mul_f32 v[82:83], v[82:83], v[14:15] op_sel:[0,1] op_sel_hi:[1,1]
    v_pk_mul_f32 v[76:77], v[76:77], v[14:15] op_sel:[0,0] op_sel_hi:[1,0]
    v_pk_mul_f32 v[78:79], v[78:79], v[14:15] op_sel:[0,0] op_sel_hi:[1,0]
    s_waitcnt vmcnt(4)
    v_and_b32 v46, 0x20000000, v41
    v_lshrrev_b32 v47, 14, v23
    v_bitop3_b32 v47, v47, v5, v46 bitop3:0xea
    ds_read_b64 v[106:107], v47
    v_and_b32 v99, 0x10000000, v41
    v_lshrrev_b32 v47, 14, v22
    v_bitop3_b32 v47, v47, v5, v99 bitop3:0xea
    ds_read_b64 v[104:105], v47
    s_waitcnt lgkmcnt(2)
    v_cmp_ne_u64 s[50:51], v[72:73], v[68:69]
    v_cmpx_ne_u64 s[54:55], v[74:75], v[70:71]
    s_and_b64 s[82:83], s[54:55], s[80:81]
    s_cbranch_scc1 L2_c139
L2_d139:
    v_mov_b64 v[84:85], v[70:71]
    v_mov_b32 v7, v95
    v_mov_b64 v[86:87], v[74:75]
    s_or_b64 s[80:81], s[80:81], s[54:55]
    s_mov_b64 exec, s[50:51]
    s_and_b64 s[82:83], s[50:51], s[80:81]
    s_cbranch_scc1 L2_c140
L2_d140:
    v_mov_b64 v[84:85], v[68:69]
    v_mov_b32 v7, v94
    v_mov_b64 v[86:87], v[72:73]
    s_mov_b64 exec, -1
    s_or_b64 s[80:81], s[80:81], s[50:51]
    s_and_b64 exec, s[48:49], s[80:81]
    v_mfma_f32_4x4x4_16b_bf16 v[80:83], v[12:13], v[84:85], 0
    v_mov_b32 v93, v7
    s_andn2_b64 s[80:81], s[80:81], s[48:49]
    v_mfma_f32_4x4x4_16b_bf16 v[80:83], v[10:11], v[86:87], v[80:83]
    s_mov_b64 exec, -1
    ds_read_b64 v[70:71], v93 offset:65408
    ds_read_b64 v[68:69], v92 offset:65408
    v_bitop3_b32 v94, v22, v5, v99 bitop3:0xea
    v_bitop3_b32 v95, v23, v5, v46 bitop3:0xea
    v_perm_b32 v15, v23, v26, s45
    v_bitop3_b32 v46, v23, 0.5, -0.5 bitop3:0xa8
    v_perm_b32 v14, v22, v26, s44
    v_bitop3_b32 v47, v22, 0.5, -0.5 bitop3:0xa8
    v_bitop3_b32 v15, v6, v15, v46 bitop3:0xca
    v_bitop3_b32 v14, v6, v14, v47 bitop3:0xca
    s_waitcnt lgkmcnt(1)
    v_mfma_f32_4x4x4_16b_bf16 v[80:83], v[10:11], v[70:71], v[80:83]
    s_waitcnt lgkmcnt(0)
    v_mfma_f32_4x4x4_16b_bf16 v[76:79], v[10:11], v[68:69], v[76:79]
    s_nop 2
    v_cvt_pk_bf16_f32 v80, v80, v81
    v_cvt_pk_bf16_f32 v81, v82, v83
    ds_wrxchg_rtn_b64 v[74:75], v93, v[80:81] offset:65408
    v_cvt_pk_bf16_f32 v76, v76, v77
    v_cvt_pk_bf16_f32 v77, v78, v79
    ds_wrxchg_rtn_b64 v[72:73], v92, v[76:77] offset:65408
    s_setprio 1
    v_mfma_f32_4x4x4_16b_bf16 v[80:83], v[8:9], v[106:107], 0
    v_mfma_f32_4x4x4_16b_bf16 v[76:79], v[8:9], v[104:105], 0
    s_nop 3
    v_pk_mul_f32 v[80:81], v[80:81], v[14:15] op_sel:[0,1] op_sel_hi:[1,1]
    v_pk_mul_f32 v[82:83], v[82:83], v[14:15] op_sel:[0,1] op_sel_hi:[1,1]
    v_pk_mul_f32 v[76:77], v[76:77], v[14:15] op_sel:[0,0] op_sel_hi:[1,0]
    v_pk_mul_f32 v[78:79], v[78:79], v[14:15] op_sel:[0,0] op_sel_hi:[1,0]
    s_bitcmp1_b32 s43, s42
    s_cbranch_scc1 L2_oa141
L2_ob141:
    v_and_b32 v46, 0x80000000, v41
    v_lshrrev_b32 v47, 14, v25
    v_bitop3_b32 v47, v47, v5, v46 bitop3:0xea
    ds_read_b64 v[102:103], v47
    v_and_b32 v99, 0x40000000, v41
    v_lshrrev_b32 v47, 14, v24
    v_bitop3_b32 v47, v47, v5, v99 bitop3:0xea
    ds_read_b64 v[100:101], v47
    s_waitcnt lgkmcnt(2)
    v_cmp_ne_u64 s[50:51], v[72:73], v[68:69]
    v_cmpx_ne_u64 s[54:55], v[74:75], v[70:71]
    s_and_b64 s[82:83], s[54:55], s[80:81]
    s_cbranch_scc1 L2_c142
L2_d142:
    v_mov_b64 v[84:85], v[70:71]
    v_mov_b32 v7, v93
    v_mov_b64 v[86:87], v[74:75]
    s_or_b64 s[80:81], s[80:81], s[54:55]
    s_mov_b64 exec, s[50:51]
    s_and_b64 s[82:83], s[50:51], s[80:81]
    s_cbranch_scc1 L2_c143
L2_d143:
    v_mov_b64 v[84:85], v[68:69]
    v_mov_b32 v7, v92
    v_mov_b64 v[86:87], v[72:73]
    s_mov_b64 exec, -1
    s_or_b64 s[80:81], s[80:81], s[50:51]
    ds_read_b64 v[70:71], v95 offset:65408
    ds_read_b64 v[68:69], v94 offset:65408
    v_bitop3_b32 v92, v24, v5, v99 bitop3:0xea
    v_bitop3_b32 v93, v25, v5, v46 bitop3:0xea
    v_perm_b32 v15, v25, v26, s47
    v_bitop3_b32 v46, v25, 0.5, -0.5 bitop3:0xa8
    v_perm_b32 v14, v24, v26, s46
    v_bitop3_b32 v47, v24, 0.5, -0.5 bitop3:0xa8
    v_bitop3_b32 v15, v6, v15, v46 bitop3:0xca
    v_bitop3_b32 v14, v6, v14, v47 bitop3:0xca
    s_waitcnt lgkmcnt(1)
    v_mfma_f32_4x4x4_16b_bf16 v[80:83], v[10:11], v[70:71], v[80:83]
    s_waitcnt lgkmcnt(0)
    v_mfma_f32_4x4x4_16b_bf16 v[76:79], v[10:11], v[68:69], v[76:79]
    s_nop 2
    v_cvt_pk_bf16_f32 v80, v80, v81
    v_cvt_pk_bf16_f32 v81, v82, v83
    ds_wrxchg_rtn_b64 v[74:75], v95, v[80:81] offset:65408
    v_cvt_pk_bf16_f32 v76, v76, v77
    v_cvt_pk_bf16_f32 v77, v78, v79
    ds_wrxchg_rtn_b64 v[72:73], v94, v[76:77] offset:65408
    v_mfma_f32_4x4x4_16b_bf16 v[80:83], v[8:9], v[102:103], 0
    v_mfma_f32_4x4x4_16b_bf16 v[76:79], v[8:9], v[100:101], 0
    v_cmp_lt_u32 s[84:85], v5, v92
    s_nop 2
    v_pk_mul_f32 v[80:81], v[80:81], v[14:15] op_sel:[0,1] op_sel_hi:[1,1]
    v_pk_mul_f32 v[82:83], v[82:83], v[14:15] op_sel:[0,1] op_sel_hi:[1,1]
    v_pk_mul_f32 v[76:77], v[76:77], v[14:15] op_sel:[0,0] op_sel_hi:[1,0]
    v_pk_mul_f32 v[78:79], v[78:79], v[14:15] op_sel:[0,0] op_sel_hi:[1,0]
    s_lshl_b32 s3, s32, 12
    v_subrev_u32 v122, s3, v3
    s_mul_i32 s3, s33, 20000
    v_add_u32 v118, s3, v122
    v_add_u32 v119, 0x4000, v118
    s_lshl_b32 s3, s34, 7
    v_lshrrev_b32 v123, 7, v118
    v_and_b32 v120, 0x70, v118
    v_lshl_add_u32 v120, v123, 13, v120
    v_add_u32 v120, s3, v120
    v_lshrrev_b32 v123, 7, v119
    v_and_b32 v121, 0x70, v119
    v_lshl_add_u32 v121, v123, 13, v121
    v_add_u32 v121, s3, v121
    v_cmp_le_u32 vcc, 3616, v122
    s_mov_b64 exec, vcc
    v_mov_b32 v119, 2.0
    v_mov_b32 v121, 2.0
    s_mov_b64 exec, -1
    v_and_b32 v123, 0x30, v122
    v_lshlrev_b32 v123, 2, v123
    buffer_load_dwordx4 v[48:51], v123, s[24:27], 0 offen
    buffer_load_dwordx4 v[52:55], v123, s[24:27], 0 offen offset:16
    buffer_load_dwordx2 v[56:57], v123, s[24:27], 0 offen offset:32
    s_mov_b32 s12, s4
    s_mov_b32 s13, s5
    s_mov_b32 s14, 0x138800
    s_mov_b32 s15, 0x20000
    s_mov_b32 s16, s28
    s_mov_b32 s17, s29
    s_mov_b32 s18, 0x4e2000
    s_mov_b32 s19, 0x20000
    v_lshrrev_b32 v123, 2, v120
    buffer_load_dword v116, v123, s[12:15], 0 offen
    buffer_load_dwordx4 v[108:111], v120, s[16:19], 0 offen
    v_lshrrev_b32 v123, 2, v121
    buffer_load_dword v117, v123, s[12:15], 0 offen
    buffer_load_dwordx4 v[112:115], v121, s[16:19], 0 offen
    s_waitcnt vmcnt(9)
    s_mov_b64 exec, s[6:7]
    v_lshrrev_b32 v30, 16, v30
    s_mov_b64 exec, -1
    v_and_b32 v46, 0x20000000, v42
    v_lshrrev_b32 v47, 14, v29
    v_bitop3_b32 v47, v47, v5, v46 bitop3:0xea
    ds_read_b64 v[106:107], v47
    v_and_b32 v99, 0x10000000, v42
    v_lshrrev_b32 v47, 14, v28
    v_bitop3_b32 v47, v47, v5, v99 bitop3:0xea
    ds_read_b64 v[104:105], v47
    s_waitcnt lgkmcnt(2)
    v_cmp_ne_u64 s[50:51], v[72:73], v[68:69]
    v_cmpx_ne_u64 s[54:55], v[74:75], v[70:71]
    s_and_b64 s[82:83], s[54:55], s[80:81]
    s_cbranch_scc1 L2_c144
L2_d144:
    v_mov_b64 v[84:85], v[70:71]
    v_mov_b32 v7, v95
    v_mov_b64 v[86:87], v[74:75]
    s_or_b64 s[80:81], s[80:81], s[54:55]
    s_mov_b64 exec, s[50:51]
    s_and_b64 s[82:83], s[50:51], s[80:81]
    s_cbranch_scc1 L2_c145
L2_d145:
    v_mov_b64 v[84:85], v[68:69]
    v_mov_b32 v7, v94
    v_mov_b64 v[86:87], v[72:73]
    s_mov_b64 exec, -1
    s_or_b64 s[80:81], s[80:81], s[50:51]
    s_and_b64 exec, s[84:85], s[80:81]
    v_mfma_f32_4x4x4_16b_bf16 v[76:79], v[12:13], v[84:85], 0
    v_mov_b32 v92, v7
    s_andn2_b64 s[80:81], s[80:81], s[84:85]
    v_mfma_f32_4x4x4_16b_bf16 v[76:79], v[10:11], v[86:87], v[76:79]
    s_mov_b64 exec, -1
    ds_read_b64 v[70:71], v93 offset:65408
    ds_read_b64 v[68:69], v92 offset:65408
    v_bitop3_b32 v94, v28, v5, v99 bitop3:0xea
    v_bitop3_b32 v95, v29, v5, v46 bitop3:0xea
    v_perm_b32 v15, v29, v30, s45
    v_bitop3_b32 v46, v29, 0.5, -0.5 bitop3:0xa8
    v_perm_b32 v14, v28, v30, s44
    v_bitop3_b32 v47, v28, 0.5, -0.5 bitop3:0xa8
    v_bitop3_b32 v15, v6, v15, v46 bitop3:0xca
    v_bitop3_b32 v14, v6, v14, v47 bitop3:0xca
    s_waitcnt lgkmcnt(1)
    v_mfma_f32_4x4x4_16b_bf16 v[80:83], v[10:11], v[70:71], v[80:83]
    s_waitcnt lgkmcnt(0)
    v_mfma_f32_4x4x4_16b_bf16 v[76:79], v[10:11], v[68:69], v[76:79]
    s_nop 2
    v_cvt_pk_bf16_f32 v80, v80, v81
    v_cvt_pk_bf16_f32 v81, v82, v83
    ds_wrxchg_rtn_b64 v[74:75], v93, v[80:81] offset:65408
    v_cvt_pk_bf16_f32 v76, v76, v77
    v_cvt_pk_bf16_f32 v77, v78, v79
    ds_wrxchg_rtn_b64 v[72:73], v92, v[76:77] offset:65408
    s_setprio 0
    v_mfma_f32_4x4x4_16b_bf16 v[80:83], v[8:9], v[106:107], 0
    v_mfma_f32_4x4x4_16b_bf16 v[76:79], v[8:9], v[104:105], 0
    v_cmp_lt_u32 s[48:49], v5, v95
    s_nop 2
    v_pk_mul_f32 v[80:81], v[80:81], v[14:15] op_sel:[0,1] op_sel_hi:[1,1]
    v_pk_mul_f32 v[82:83], v[82:83], v[14:15] op_sel:[0,1] op_sel_hi:[1,1]
    v_pk_mul_f32 v[76:77], v[76:77], v[14:15] op_sel:[0,0] op_sel_hi:[1,0]
    v_pk_mul_f32 v[78:79], v[78:79], v[14:15] op_sel:[0,0] op_sel_hi:[1,0]
    s_waitcnt vmcnt(7)
    v_and_b32 v46, 0x80000000, v43
    v_lshrrev_b32 v47, 14, v37
    v_bitop3_b32 v47, v47, v5, v46 bitop3:0xea
    ds_read_b64 v[106:107], v47
    v_and_b32 v99, 0x40000000, v43
    v_lshrrev_b32 v47, 14, v36
    v_bitop3_b32 v47, v47, v5, v99 bitop3:0xea
    ds_read_b64 v[104:105], v47
    v_and_b32 v46, 0x20000000, v43
    v_lshrrev_b32 v47, 14, v35
    v_bitop3_b32 v47, v47, v5, v46 bitop3:0xea
    ds_read_b64 v[102:103], v47
    v_and_b32 v99, 0x10000000, v43
    v_lshrrev_b32 v47, 14, v34
    v_bitop3_b32 v47, v47, v5, v99 bitop3:0xea
    ds_read_b64 v[100:101], v47
    s_waitcnt lgkmcnt(4)
    v_cmp_ne_u64 s[50:51], v[72:73], v[68:69]
    v_cmpx_ne_u64 s[54:55], v[74:75], v[70:71]
    s_and_b64 s[82:83], s[54:55], s[80:81]
    s_cbranch_scc1 L2_c146
L2_d146:
    v_mov_b64 v[84:85], v[70:71]
    v_mov_b32 v7, v93
    v_mov_b64 v[86:87], v[74:75]
    s_or_b64 s[80:81], s[80:81], s[54:55]
    s_mov_b64 exec, s[50:51]
    s_and_b64 s[82:83], s[50:51], s[80:81]
    s_cbranch_scc1 L2_c147
L2_d147:
    v_mov_b64 v[84:85], v[68:69]
    v_mov_b32 v7, v92
    v_mov_b64 v[86:87], v[72:73]
    s_mov_b64 exec, -1
    s_or_b64 s[80:81], s[80:81], s[50:51]
    s_and_b64 exec, s[48:49], s[80:81]
    v_mfma_f32_4x4x4_16b_bf16 v[80:83], v[12:13], v[84:85], 0
    v_mov_b32 v95, v7
    s_andn2_b64 s[80:81], s[80:81], s[48:49]
    v_mfma_f32_4x4x4_16b_bf16 v[80:83], v[10:11], v[86:87], v[80:83]
    s_mov_b64 exec, -1
    ds_read_b64 v[70:71], v95 offset:65408
    ds_read_b64 v[68:69], v94 offset:65408
    v_bitop3_b32 v92, v34, v5, v99 bitop3:0xea
    v_bitop3_b32 v93, v35, v5, v46 bitop3:0xea
    v_perm_b32 v15, v35, v38, s45
    v_bitop3_b32 v46, v35, 0.5, -0.5 bitop3:0xa8
    v_perm_b32 v14, v34, v38, s44
    v_bitop3_b32 v47, v34, 0.5, -0.5 bitop3:0xa8
    v_bitop3_b32 v15, v6, v15, v46 bitop3:0xca
    v_bitop3_b32 v14, v6, v14, v47 bitop3:0xca
    s_waitcnt lgkmcnt(1)
    v_mfma_f32_4x4x4_16b_bf16 v[80:83], v[10:11], v[70:71], v[80:83]
    s_waitcnt lgkmcnt(0)
    v_mfma_f32_4x4x4_16b_bf16 v[76:79], v[10:11], v[68:69], v[76:79]
    s_nop 2
    v_cvt_pk_bf16_f32 v80, v80, v81
    v_cvt_pk_bf16_f32 v81, v82, v83
    ds_wrxchg_rtn_b64 v[74:75], v95, v[80:81] offset:65408
    v_cvt_pk_bf16_f32 v76, v76, v77
    v_cvt_pk_bf16_f32 v77, v78, v79
    ds_wrxchg_rtn_b64 v[72:73], v94, v[76:77] offset:65408
    v_mfma_f32_4x4x4_16b_bf16 v[80:83], v[8:9], v[102:103], 0
    v_mfma_f32_4x4x4_16b_bf16 v[76:79], v[8:9], v[100:101], 0
    s_nop 3
    v_pk_mul_f32 v[80:81], v[80:81], v[14:15] op_sel:[0,1] op_sel_hi:[1,1]
    v_pk_mul_f32 v[82:83], v[82:83], v[14:15] op_sel:[0,1] op_sel_hi:[1,1]
    v_pk_mul_f32 v[76:77], v[76:77], v[14:15] op_sel:[0,0] op_sel_hi:[1,0]
    v_pk_mul_f32 v[78:79], v[78:79], v[14:15] op_sel:[0,0] op_sel_hi:[1,0]
    s_waitcnt lgkmcnt(0)
    v_cmp_ne_u64 s[50:51], v[72:73], v[68:69]
    v_cmpx_ne_u64 s[54:55], v[74:75], v[70:71]
    s_and_b64 s[82:83], s[54:55], s[80:81]
    s_cbranch_scc1 L2_c148
L2_d148:
    v_mov_b64 v[84:85], v[70:71]
    v_mov_b32 v7, v95
    v_mov_b64 v[86:87], v[74:75]
    s_or_b64 s[80:81], s[80:81], s[54:55]
    s_mov_b64 exec, s[50:51]
    s_and_b64 s[82:83], s[50:51], s[80:81]
    s_cbranch_scc1 L2_c149
L2_d149:
    v_mov_b64 v[84:85], v[68:69]
    v_mov_b32 v7, v94
    v_mov_b64 v[86:87], v[72:73]
    s_mov_b64 exec, -1
    s_or_b64 s[80:81], s[80:81], s[50:51]
    ds_read_b64 v[70:71], v93 offset:65408
    ds_read_b64 v[68:69], v92 offset:65408
    v_and_b32 v46, 0x40000000, v43
    v_bitop3_b32 v94, v36, v5, v46 bitop3:0xea
    v_and_b32 v46, 0x80000000, v43
    v_bitop3_b32 v95, v37, v5, v46 bitop3:0xea
    v_perm_b32 v15, v37, v38, s47
    v_bitop3_b32 v46, v37, 0.5, -0.5 bitop3:0xa8
    v_perm_b32 v14, v36, v38, s46
    v_bitop3_b32 v47, v36, 0.5, -0.5 bitop3:0xa8
    v_bitop3_b32 v15, v6, v15, v46 bitop3:0xca
    v_bitop3_b32 v14, v6, v14, v47 bitop3:0xca
    s_waitcnt lgkmcnt(1)
    v_mfma_f32_4x4x4_16b_bf16 v[80:83], v[10:11], v[70:71], v[80:83]
    s_waitcnt lgkmcnt(0)
    v_mfma_f32_4x4x4_16b_bf16 v[76:79], v[10:11], v[68:69], v[76:79]
    s_nop 2
    v_cvt_pk_bf16_f32 v80, v80, v81
    v_cvt_pk_bf16_f32 v81, v82, v83
    ds_wrxchg_rtn_b64 v[74:75], v93, v[80:81] offset:65408
    v_cvt_pk_bf16_f32 v76, v76, v77
    v_cvt_pk_bf16_f32 v77, v78, v79
    ds_wrxchg_rtn_b64 v[72:73], v92, v[76:77] offset:65408
    v_mfma_f32_4x4x4_16b_bf16 v[80:83], v[8:9], v[106:107], 0
    v_mfma_f32_4x4x4_16b_bf16 v[76:79], v[8:9], v[104:105], 0
    v_cmp_lt_u32 s[84:85], v5, v94
    s_nop 2
    v_pk_mul_f32 v[80:81], v[80:81], v[14:15] op_sel:[0,1] op_sel_hi:[1,1]
    v_pk_mul_f32 v[82:83], v[82:83], v[14:15] op_sel:[0,1] op_sel_hi:[1,1]
    v_pk_mul_f32 v[76:77], v[76:77], v[14:15] op_sel:[0,0] op_sel_hi:[1,0]
    v_pk_mul_f32 v[78:79], v[78:79], v[14:15] op_sel:[0,0] op_sel_hi:[1,0]
    s_waitcnt lgkmcnt(0)
    v_cmp_ne_u64 s[50:51], v[72:73], v[68:69]
    v_cmpx_ne_u64 s[54:55], v[74:75], v[70:71]
    s_and_b64 s[82:83], s[54:55], s[80:81]
    s_cbranch_scc1 L2_c150
L2_d150:
    v_mov_b64 v[84:85], v[70:71]
    v_mov_b32 v7, v93
    v_mov_b64 v[86:87], v[74:75]
    s_or_b64 s[80:81], s[80:81], s[54:55]
    s_mov_b64 exec, s[50:51]
    s_and_b64 s[82:83], s[50:51], s[80:81]
    s_cbranch_scc1 L2_c151
L2_d151:
    v_mov_b64 v[84:85], v[68:69]
    v_mov_b32 v7, v92
    v_mov_b64 v[86:87], v[72:73]
    s_mov_b64 exec, -1
    s_or_b64 s[80:81], s[80:81], s[50:51]
    s_and_b64 exec, s[84:85], s[80:81]
    v_mfma_f32_4x4x4_16b_bf16 v[76:79], v[12:13], v[84:85], 0
    v_mov_b32 v94, v7
    s_andn2_b64 s[80:81], s[80:81], s[84:85]
    v_mfma_f32_4x4x4_16b_bf16 v[76:79], v[10:11], v[86:87], v[76:79]
    s_mov_b64 exec, -1
    ds_read_b64 v[70:71], v95 offset:65408
    ds_read_b64 v[68:69], v94 offset:65408
    s_waitcnt lgkmcnt(1)
    v_mfma_f32_4x4x4_16b_bf16 v[80:83], v[10:11], v[70:71], v[80:83]
    s_waitcnt lgkmcnt(0)
    v_mfma_f32_4x4x4_16b_bf16 v[76:79], v[10:11], v[68:69], v[76:79]
    s_nop 2
    v_cvt_pk_bf16_f32 v80, v80, v81
    v_cvt_pk_bf16_f32 v81, v82, v83
    ds_wrxchg_rtn_b64 v[74:75], v95, v[80:81] offset:65408
    v_cvt_pk_bf16_f32 v76, v76, v77
    v_cvt_pk_bf16_f32 v77, v78, v79
    ds_wrxchg_rtn_b64 v[72:73], v94, v[76:77] offset:65408
    s_waitcnt lgkmcnt(0)
    v_cmpx_ne_u64 vcc, v[74:75], v[70:71]
    s_and_b64 s[82:83], vcc, s[80:81]
    s_cbranch_scc1 L2_c152
L2_d152:
    v_mov_b64 v[84:85], v[70:71]
    v_mov_b32 v7, v95
    v_mov_b64 v[86:87], v[74:75]
    s_mov_b64 exec, -1
    s_or_b64 s[80:81], s[80:81], vcc
    v_cmpx_ne_u64 vcc, v[72:73], v[68:69]
    s_and_b64 s[82:83], vcc, s[80:81]
    s_cbranch_scc1 L2_c153
L2_d153:
    v_mov_b64 v[84:85], v[68:69]
    v_mov_b32 v7, v94
    v_mov_b64 v[86:87], v[72:73]
    s_mov_b64 exec, -1
    s_or_b64 s[80:81], s[80:81], vcc
    s_mov_b64 exec, s[80:81]
    ds_read_b64 v[68:69], v7 offset:65408
    v_mfma_f32_4x4x4_16b_bf16 v[76:79], v[12:13], v[84:85], 0
    s_nop 1
    v_mfma_f32_4x4x4_16b_bf16 v[76:79], v[10:11], v[86:87], v[76:79]
    s_waitcnt lgkmcnt(0)
    s_nop 0
    v_mfma_f32_4x4x4_16b_bf16 v[76:79], v[10:11], v[68:69], v[76:79]
    v_mov_b64 v[84:85], v[68:69]
    s_nop 3
    v_cvt_pk_bf16_f32 v76, v76, v77
    v_cvt_pk_bf16_f32 v77, v78, v79
    ds_wrxchg_rtn_b64 v[86:87], v7, v[76:77] offset:65408
    s_waitcnt lgkmcnt(0)
    v_cmp_ne_u64 s[80:81], v[86:87], v[84:85]
    s_mov_b64 exec, s[80:81]
    s_nop 1
    v_mfma_f32_4x4x4_16b_bf16 v[88:91], v[12:13], v[84:85], 0
    s_nop 1
    v_mfma_f32_4x4x4_16b_bf16 v[88:91], v[10:11], v[86:87], v[88:91]
    s_nop 4
    v_cvt_pk_bf16_f32 v88, v88, v89
    v_cvt_pk_bf16_f32 v89, v90, v91
    ds_pk_add_bf16 v7, v88 offset:65408
    ds_pk_add_bf16 v7, v89 offset:65412
    s_mov_b64 exec, -1
    s_load_dwordx2 s[4:5], s[0:1], 88
    v_add_u32 v123, 0x4000, v122
    s_lshl_b32 s50, s96, 16
    s_and_b32 s51, s96, 0xffff0000
    s_lshl_b32 s52, s97, 16
    s_and_b32 s53, s97, 0xffff0000
    s_lshl_b32 s54, s98, 16
    s_and_b32 s55, s98, 0xffff0000
    s_lshl_b32 s56, s99, 16
    s_and_b32 s57, s99, 0xffff0000
    s_waitcnt vmcnt(0) lgkmcnt(0)
    s_barrier
    s_add_u32 s8, s30, 0xec46000
    s_addc_u32 s9, s31, 0
    s_mov_b32 s10, 0x8000
    s_mov_b32 s11, 0x20000
    s_mov_b32 s12, s4
    s_mov_b32 s13, s5
    s_mov_b32 s14, 0x4e2000
    s_mov_b32 s15, 0x20000
    s_add_u32 s20, s30, 0xd845000
    s_addc_u32 s21, s31, 0
    s_mov_b32 s22, 0x1400000
    s_mov_b32 s23, 0x20000
    s_lshl2_add_u32 s4, s34, s33
    s_mul_i32 s4, s4, 81920
    s_add_u32 s3, s33, 1
    s_and_b32 s3, s3, 3
    s_mul_i32 s36, s3, 20000
    s_add_u32 s36, s36, 81920
    s_mul_i32 s40, s3, 20480
    s_add_u32 s40, s40, s4
    s_lshl2_add_u32 s3, s34, s3
    s_mul_i32 s3, s3, 81920
    s_mul_i32 s44, s33, 20480
    s_add_u32 s44, s44, s3
    s_add_u32 s3, s33, 2
    s_and_b32 s3, s3, 3
    s_mul_i32 s37, s3, 20000
    s_add_u32 s37, s37, 81920
    s_mul_i32 s41, s3, 20480
    s_add_u32 s41, s41, s4
    s_lshl2_add_u32 s3, s34, s3
    s_mul_i32 s3, s3, 81920
    s_mul_i32 s45, s33, 20480
    s_add_u32 s45, s45, s3
    s_add_u32 s3, s33, 3
    s_and_b32 s3, s3, 3
    s_mul_i32 s38, s3, 20000
    s_add_u32 s38, s38, 81920
    s_mul_i32 s42, s3, 20480
    s_add_u32 s42, s42, s4
    s_lshl2_add_u32 s3, s34, s3
    s_mul_i32 s3, s3, 81920
    s_mul_i32 s46, s33, 20480
    s_add_u32 s46, s46, s3
    v_add_u32 v104, s36, v122
    ds_read_b128 v[16:19], v104
    v_add_u32 v104, s37, v122
    ds_read_b128 v[20:23], v104
    v_add_u32 v104, s38, v122
    ds_read_b128 v[24:27], v104
    s_waitcnt lgkmcnt(2)
    buffer_store_dwordx4 v[16:19], v122, s[20:23], s40 offen sc1
    s_waitcnt lgkmcnt(1)
    buffer_store_dwordx4 v[20:23], v122, s[20:23], s41 offen sc1
    s_waitcnt lgkmcnt(0)
    buffer_store_dwordx4 v[24:27], v122, s[20:23], s42 offen sc1
    s_cmp_ge_u32 s32, 4
    s_cbranch_scc1 L2_g0
    v_add_u32 v104, s36, v123
    ds_read_b128 v[36:39], v104
    v_add_u32 v104, s37, v123
    ds_read_b128 v[40:43], v104
    v_add_u32 v104, s38, v123
    ds_read_b128 v[44:47], v104
    s_waitcnt lgkmcnt(2)
    buffer_store_dwordx4 v[36:39], v123, s[20:23], s40 offen sc1
    s_waitcnt lgkmcnt(1)
    buffer_store_dwordx4 v[40:43], v123, s[20:23], s41 offen sc1
    s_waitcnt lgkmcnt(0)
    buffer_store_dwordx4 v[44:47], v123, s[20:23], s42 offen sc1
L2_g0:
    v_lshlrev_b32 v80, 16, v116
    v_subrev_f32 v60, s50, v80
    v_subrev_f32 v61, s51, v80
    v_subrev_f32 v62, s52, v80
    v_subrev_f32 v63, s53, v80
    v_subrev_f32 v64, s54, v80
    v_subrev_f32 v65, s55, v80
    v_subrev_f32 v66, s56, v80
    v_subrev_f32 v67, s57, v80
    v_cvt_pk_bf16_f32 v68, v60, v61
    v_cvt_pk_bf16_f32 v69, v62, v63
    v_cvt_pk_bf16_f32 v70, v64, v65
    v_cvt_pk_bf16_f32 v71, v66, v67
    v_lshlrev_b32 v60, 16, v68
    v_and_b32 v61, 0xffff0000, v68
    v_lshlrev_b32 v62, 16, v69
    v_and_b32 v63, 0xffff0000, v69
    v_lshlrev_b32 v64, 16, v70
    v_and_b32 v65, 0xffff0000, v70
    v_lshlrev_b32 v66, 16, v71
    v_and_b32 v67, 0xffff0000, v71
    v_mul_f32 v60, v60, v60
    v_mul_f32 v61, v61, v61
    v_mul_f32 v62, v62, v62
    v_mul_f32 v63, v63, v63
    v_mul_f32 v64, v64, v64
    v_mul_f32 v65, v65, v65
    v_mul_f32 v66, v66, v66
    v_mul_f32 v67, v67, v67
    v_cvt_pk_bf16_f32 v68, v60, v61
    v_cvt_pk_bf16_f32 v69, v62, v63
    v_cvt_pk_bf16_f32 v70, v64, v65
    v_cvt_pk_bf16_f32 v71, v66, v67
    v_lshlrev_b32 v60, 16, v68
    v_and_b32 v61, 0xffff0000, v68
    v_lshlrev_b32 v62, 16, v69
    v_and_b32 v63, 0xffff0000, v69
    v_lshlrev_b32 v64, 16, v70
    v_and_b32 v65, 0xffff0000, v70
    v_lshlrev_b32 v66, 16, v71
    v_and_b32 v67, 0xffff0000, v71
    v_mul_f32 v60, 0xc1200000, v60
    v_mul_f32 v61, 0xc1200000, v61
    v_mul_f32 v62, 0xc1200000, v62
    v_mul_f32 v63, 0xc1200000, v63
    v_mul_f32 v64, 0xc1200000, v64
    v_mul_f32 v65, 0xc1200000, v65
    v_mul_f32 v66, 0xc1200000, v66
    v_mul_f32 v67, 0xc1200000, v67
    v_cvt_pk_bf16_f32 v68, v60, v61
    v_cvt_pk_bf16_f32 v69, v62, v63
    v_cvt_pk_bf16_f32 v70, v64, v65
    v_cvt_pk_bf16_f32 v71, v66, v67
    v_lshlrev_b32 v60, 16, v68
    v_and_b32 v61, 0xffff0000, v68
    v_lshlrev_b32 v62, 16, v69
    v_and_b32 v63, 0xffff0000, v69
    v_lshlrev_b32 v64, 16, v70
    v_and_b32 v65, 0xffff0000, v70
    v_lshlrev_b32 v66, 16, v71
    v_and_b32 v67, 0xffff0000, v71
    v_mul_f32 v60, 0x3fb8aa3b, v60
    v_mul_f32 v61, 0x3fb8aa3b, v61
    v_mul_f32 v62, 0x3fb8aa3b, v62
    v_mul_f32 v63, 0x3fb8aa3b, v63
    v_mul_f32 v64, 0x3fb8aa3b, v64
    v_mul_f32 v65, 0x3fb8aa3b, v65
    v_mul_f32 v66, 0x3fb8aa3b, v66
    v_mul_f32 v67, 0x3fb8aa3b, v67
    v_exp_f32 v60, v60
    v_exp_f32 v61, v61
    v_exp_f32 v62, v62
    v_exp_f32 v63, v63
    v_exp_f32 v64, v64
    v_exp_f32 v65, v65
    v_exp_f32 v66, v66
    v_exp_f32 v67, v67
    v_cvt_pk_bf16_f32 v72, v60, v61
    v_cvt_pk_bf16_f32 v73, v62, v63
    v_cvt_pk_bf16_f32 v74, v64, v65
    v_cvt_pk_bf16_f32 v75, v66, v67
    v_and_b32 v84, 0xffff0000, v116
    v_subrev_f32 v60, s50, v84
    v_subrev_f32 v61, s51, v84
    v_subrev_f32 v62, s52, v84
    v_subrev_f32 v63, s53, v84
    v_subrev_f32 v64, s54, v84
    v_subrev_f32 v65, s55, v84
    v_subrev_f32 v66, s56, v84
    v_subrev_f32 v67, s57, v84
    v_cvt_pk_bf16_f32 v68, v60, v61
    v_cvt_pk_bf16_f32 v69, v62, v63
    v_cvt_pk_bf16_f32 v70, v64, v65
    v_cvt_pk_bf16_f32 v71, v66, v67
    v_lshlrev_b32 v60, 16, v68
    v_and_b32 v61, 0xffff0000, v68
    v_lshlrev_b32 v62, 16, v69
    v_and_b32 v63, 0xffff0000, v69
    v_lshlrev_b32 v64, 16, v70
    v_and_b32 v65, 0xffff0000, v70
    v_lshlrev_b32 v66, 16, v71
    v_and_b32 v67, 0xffff0000, v71
    v_mul_f32 v60, v60, v60
    v_mul_f32 v61, v61, v61
    v_mul_f32 v62, v62, v62
    v_mul_f32 v63, v63, v63
    v_mul_f32 v64, v64, v64
    v_mul_f32 v65, v65, v65
    v_mul_f32 v66, v66, v66
    v_mul_f32 v67, v67, v67
    v_cvt_pk_bf16_f32 v68, v60, v61
    v_cvt_pk_bf16_f32 v69, v62, v63
    v_cvt_pk_bf16_f32 v70, v64, v65
    v_cvt_pk_bf16_f32 v71, v66, v67
    v_lshlrev_b32 v60, 16, v68
    v_and_b32 v61, 0xffff0000, v68
    v_lshlrev_b32 v62, 16, v69
    v_and_b32 v63, 0xffff0000, v69
    v_lshlrev_b32 v64, 16, v70
    v_and_b32 v65, 0xffff0000, v70
    v_lshlrev_b32 v66, 16, v71
    v_and_b32 v67, 0xffff0000, v71
    v_mul_f32 v60, 0xc1200000, v60
    v_mul_f32 v61, 0xc1200000, v61
    v_mul_f32 v62, 0xc1200000, v62
    v_mul_f32 v63, 0xc1200000, v63
    v_mul_f32 v64, 0xc1200000, v64
    v_mul_f32 v65, 0xc1200000, v65
    v_mul_f32 v66, 0xc1200000, v66
    v_mul_f32 v67, 0xc1200000, v67
    v_cvt_pk_bf16_f32 v68, v60, v61
    v_cvt_pk_bf16_f32 v69, v62, v63
    v_cvt_pk_bf16_f32 v70, v64, v65
    v_cvt_pk_bf16_f32 v71, v66, v67
    v_lshlrev_b32 v60, 16, v68
    v_and_b32 v61, 0xffff0000, v68
    v_lshlrev_b32 v62, 16, v69
    v_and_b32 v63, 0xffff0000, v69
    v_lshlrev_b32 v64, 16, v70
    v_and_b32 v65, 0xffff0000, v70
    v_lshlrev_b32 v66, 16, v71
    v_and_b32 v67, 0xffff0000, v71
    v_mul_f32 v60, 0x3fb8aa3b, v60
    v_mul_f32 v61, 0x3fb8aa3b, v61
    v_mul_f32 v62, 0x3fb8aa3b, v62
    v_mul_f32 v63, 0x3fb8aa3b, v63
    v_mul_f32 v64, 0x3fb8aa3b, v64
    v_mul_f32 v65, 0x3fb8aa3b, v65
    v_mul_f32 v66, 0x3fb8aa3b, v66
    v_mul_f32 v67, 0x3fb8aa3b, v67
    v_exp_f32 v60, v60
    v_exp_f32 v61, v61
    v_exp_f32 v62, v62
    v_exp_f32 v63, v63
    v_exp_f32 v64, v64
    v_exp_f32 v65, v65
    v_exp_f32 v66, v66
    v_exp_f32 v67, v67
    v_cvt_pk_bf16_f32 v76, v60, v61
    v_cvt_pk_bf16_f32 v77, v62, v63
    v_cvt_pk_bf16_f32 v78, v64, v65
    v_cvt_pk_bf16_f32 v79, v66, v67
    v_mfma_f32_4x4x4_16b_bf16 v[80:83], v[48:49], v[72:73], 0
    v_mfma_f32_4x4x4_16b_bf16 v[88:91], v[52:53], v[72:73], 0
    v_mfma_f32_4x4x4_16b_bf16 v[84:87], v[48:49], v[76:77], 0
    v_mfma_f32_4x4x4_16b_bf16 v[92:95], v[52:53], v[76:77], 0
    v_mfma_f32_4x4x4_16b_bf16 v[80:83], v[50:51], v[74:75], v[80:83]
    v_mfma_f32_4x4x4_16b_bf16 v[88:91], v[54:55], v[74:75], v[88:91]
    v_mfma_f32_4x4x4_16b_bf16 v[84:87], v[50:51], v[78:79], v[84:87]
    v_mfma_f32_4x4x4_16b_bf16 v[92:95], v[54:55], v[78:79], v[92:95]
    s_lshl_b32 s3, s34, 9
    s_lshl_b32 s4, s33, 7
    s_add_u32 s4, s4, s3
    v_mov_b32 v104, 1
    v_and_b32 v105, 0x3f0, v122
    v_lshlrev_b32 v105, 3, v105
    v_add_u32 v106, 81920, v118
    ds_read_b128 v[32:35], v106
    v_add_u32 v106, 81920, v119
    ds_read_b128 v[60:63], v106
    s_waitcnt vmcnt(0)
    s_barrier
    s_cmp_lg_u32 s32, 0
    s_cbranch_scc1 L2_f2
    s_mov_b64 exec, 1
    buffer_store_dword v104, off, s[8:11], s4 sc1
    s_mov_b64 exec, 15
    s_bitset0_b64 exec, s33
L2_f3:
    buffer_load_dword v104, v105, s[8:11], s3 offen sc1
    s_waitcnt vmcnt(0)
    v_cmp_ne_u32 vcc, 1, v104
    s_cbranch_vccnz L2_f3s
    s_mov_b64 exec, -1
L2_f2:
    s_barrier
    buffer_load_dwordx4 v[36:39], v122, s[20:23], s44 offen sc1
    buffer_load_dwordx4 v[40:43], v122, s[20:23], s45 offen sc1
    buffer_load_dwordx4 v[44:47], v122, s[20:23], s46 offen sc1
    s_cmp_ge_u32 s32, 4
    s_cbranch_scc1 L2_f5
    buffer_load_dwordx4 v[64:67], v123, s[20:23], s44 offen sc1
    buffer_load_dwordx4 v[68:71], v123, s[20:23], s45 offen sc1
    buffer_load_dwordx4 v[72:75], v123, s[20:23], s46 offen sc1
    v_lshlrev_b32 v16, 16, v117
    v_subrev_f32 v96, s50, v16
    v_subrev_f32 v97, s51, v16
    v_subrev_f32 v98, s52, v16
    v_subrev_f32 v99, s53, v16
    v_subrev_f32 v100, s54, v16
    v_subrev_f32 v101, s55, v16
    v_subrev_f32 v102, s56, v16
    v_subrev_f32 v103, s57, v16
    v_cvt_pk_bf16_f32 v0, v96, v97
    v_cvt_pk_bf16_f32 v1, v98, v99
    v_cvt_pk_bf16_f32 v2, v100, v101
    v_cvt_pk_bf16_f32 v3, v102, v103
    v_lshlrev_b32 v96, 16, v0
    v_and_b32 v97, 0xffff0000, v0
    v_lshlrev_b32 v98, 16, v1
    v_and_b32 v99, 0xffff0000, v1
    v_lshlrev_b32 v100, 16, v2
    v_and_b32 v101, 0xffff0000, v2
    v_lshlrev_b32 v102, 16, v3
    v_and_b32 v103, 0xffff0000, v3
    v_mul_f32 v96, v96, v96
    v_mul_f32 v97, v97, v97
    v_mul_f32 v98, v98, v98
    v_mul_f32 v99, v99, v99
    v_mul_f32 v100, v100, v100
    v_mul_f32 v101, v101, v101
    v_mul_f32 v102, v102, v102
    v_mul_f32 v103, v103, v103
    v_cvt_pk_bf16_f32 v0, v96, v97
    v_cvt_pk_bf16_f32 v1, v98, v99
    v_cvt_pk_bf16_f32 v2, v100, v101
    v_cvt_pk_bf16_f32 v3, v102, v103
    v_lshlrev_b32 v96, 16, v0
    v_and_b32 v97, 0xffff0000, v0
    v_lshlrev_b32 v98, 16, v1
    v_and_b32 v99, 0xffff0000, v1
    v_lshlrev_b32 v100, 16, v2
    v_and_b32 v101, 0xffff0000, v2
    v_lshlrev_b32 v102, 16, v3
    v_and_b32 v103, 0xffff0000, v3
    v_mul_f32 v96, 0xc1200000, v96
    v_mul_f32 v97, 0xc1200000, v97
    v_mul_f32 v98, 0xc1200000, v98
    v_mul_f32 v99, 0xc1200000, v99
    v_mul_f32 v100, 0xc1200000, v100
    v_mul_f32 v101, 0xc1200000, v101
    v_mul_f32 v102, 0xc1200000, v102
    v_mul_f32 v103, 0xc1200000, v103
    v_cvt_pk_bf16_f32 v0, v96, v97
    v_cvt_pk_bf16_f32 v1, v98, v99
    v_cvt_pk_bf16_f32 v2, v100, v101
    v_cvt_pk_bf16_f32 v3, v102, v103
    v_lshlrev_b32 v96, 16, v0
    v_and_b32 v97, 0xffff0000, v0
    v_lshlrev_b32 v98, 16, v1
    v_and_b32 v99, 0xffff0000, v1
    v_lshlrev_b32 v100, 16, v2
    v_and_b32 v101, 0xffff0000, v2
    v_lshlrev_b32 v102, 16, v3
    v_and_b32 v103, 0xffff0000, v3
    v_mul_f32 v96, 0x3fb8aa3b, v96
    v_mul_f32 v97, 0x3fb8aa3b, v97
    v_mul_f32 v98, 0x3fb8aa3b, v98
    v_mul_f32 v99, 0x3fb8aa3b, v99
    v_mul_f32 v100, 0x3fb8aa3b, v100
    v_mul_f32 v101, 0x3fb8aa3b, v101
    v_mul_f32 v102, 0x3fb8aa3b, v102
    v_mul_f32 v103, 0x3fb8aa3b, v103
    v_exp_f32 v96, v96
    v_exp_f32 v97, v97
    v_exp_f32 v98, v98
    v_exp_f32 v99, v99
    v_exp_f32 v100, v100
    v_exp_f32 v101, v101
    v_exp_f32 v102, v102
    v_exp_f32 v103, v103
    v_cvt_pk_bf16_f32 v104, v96, v97
    v_cvt_pk_bf16_f32 v105, v98, v99
    v_cvt_pk_bf16_f32 v106, v100, v101
    v_cvt_pk_bf16_f32 v107, v102, v103
    v_and_b32 v20, 0xffff0000, v117
    v_subrev_f32 v96, s50, v20
    v_subrev_f32 v97, s51, v20
    v_subrev_f32 v98, s52, v20
    v_subrev_f32 v99, s53, v20
    v_subrev_f32 v100, s54, v20
    v_subrev_f32 v101, s55, v20
    v_subrev_f32 v102, s56, v20
    v_subrev_f32 v103, s57, v20
    v_cvt_pk_bf16_f32 v0, v96, v97
    v_cvt_pk_bf16_f32 v1, v98, v99
    v_cvt_pk_bf16_f32 v2, v100, v101
    v_cvt_pk_bf16_f32 v3, v102, v103
    v_lshlrev_b32 v96, 16, v0
    v_and_b32 v97, 0xffff0000, v0
    v_lshlrev_b32 v98, 16, v1
    v_and_b32 v99, 0xffff0000, v1
    v_lshlrev_b32 v100, 16, v2
    v_and_b32 v101, 0xffff0000, v2
    v_lshlrev_b32 v102, 16, v3
    v_and_b32 v103, 0xffff0000, v3
    v_mul_f32 v96, v96, v96
    v_mul_f32 v97, v97, v97
    v_mul_f32 v98, v98, v98
    v_mul_f32 v99, v99, v99
    v_mul_f32 v100, v100, v100
    v_mul_f32 v101, v101, v101
    v_mul_f32 v102, v102, v102
    v_mul_f32 v103, v103, v103
    v_cvt_pk_bf16_f32 v0, v96, v97
    v_cvt_pk_bf16_f32 v1, v98, v99
    v_cvt_pk_bf16_f32 v2, v100, v101
    v_cvt_pk_bf16_f32 v3, v102, v103
    v_lshlrev_b32 v96, 16, v0
    v_and_b32 v97, 0xffff0000, v0
    v_lshlrev_b32 v98, 16, v1
    v_and_b32 v99, 0xffff0000, v1
    v_lshlrev_b32 v100, 16, v2
    v_and_b32 v101, 0xffff0000, v2
    v_lshlrev_b32 v102, 16, v3
    v_and_b32 v103, 0xffff0000, v3
    v_mul_f32 v96, 0xc1200000, v96
    v_mul_f32 v97, 0xc1200000, v97
    v_mul_f32 v98, 0xc1200000, v98
    v_mul_f32 v99, 0xc1200000, v99
    v_mul_f32 v100, 0xc1200000, v100
    v_mul_f32 v101, 0xc1200000, v101
    v_mul_f32 v102, 0xc1200000, v102
    v_mul_f32 v103, 0xc1200000, v103
    v_cvt_pk_bf16_f32 v0, v96, v97
    v_cvt_pk_bf16_f32 v1, v98, v99
    v_cvt_pk_bf16_f32 v2, v100, v101
    v_cvt_pk_bf16_f32 v3, v102, v103
    v_lshlrev_b32 v96, 16, v0
    v_and_b32 v97, 0xffff0000, v0
    v_lshlrev_b32 v98, 16, v1
    v_and_b32 v99, 0xffff0000, v1
    v_lshlrev_b32 v100, 16, v2
    v_and_b32 v101, 0xffff0000, v2
    v_lshlrev_b32 v102, 16, v3
    v_and_b32 v103, 0xffff0000, v3
    v_mul_f32 v96, 0x3fb8aa3b, v96
    v_mul_f32 v97, 0x3fb8aa3b, v97
    v_mul_f32 v98, 0x3fb8aa3b, v98
    v_mul_f32 v99, 0x3fb8aa3b, v99
    v_mul_f32 v100, 0x3fb8aa3b, v100
    v_mul_f32 v101, 0x3fb8aa3b, v101
    v_mul_f32 v102, 0x3fb8aa3b, v102
    v_mul_f32 v103, 0x3fb8aa3b, v103
    v_exp_f32 v96, v96
    v_exp_f32 v97, v97
    v_exp_f32 v98, v98
    v_exp_f32 v99, v99
    v_exp_f32 v100, v100
    v_exp_f32 v101, v101
    v_exp_f32 v102, v102
    v_exp_f32 v103, v103
    v_cvt_pk_bf16_f32 v76, v96, v97
    v_cvt_pk_bf16_f32 v77, v98, v99
    v_cvt_pk_bf16_f32 v78, v100, v101
    v_cvt_pk_bf16_f32 v79, v102, v103
    v_mfma_f32_4x4x4_16b_bf16 v[16:19], v[48:49], v[104:105], 0
    v_mfma_f32_4x4x4_16b_bf16 v[24:27], v[52:53], v[104:105], 0
    v_mfma_f32_4x4x4_16b_bf16 v[20:23], v[48:49], v[76:77], 0
    v_mfma_f32_4x4x4_16b_bf16 v[28:31], v[52:53], v[76:77], 0
    v_mfma_f32_4x4x4_16b_bf16 v[16:19], v[50:51], v[106:107], v[16:19]
    v_mfma_f32_4x4x4_16b_bf16 v[24:27], v[54:55], v[106:107], v[24:27]
    v_mfma_f32_4x4x4_16b_bf16 v[20:23], v[50:51], v[78:79], v[20:23]
    v_mfma_f32_4x4x4_16b_bf16 v[28:31], v[54:55], v[78:79], v[28:31]
L2_f5:
    s_waitcnt vmcnt(0) lgkmcnt(0)
    v_mfma_f32_4x4x4_16b_bf16 v[96:99], v[10:11], v[32:33], 0
    v_mfma_f32_4x4x4_16b_bf16 v[100:103], v[10:11], v[34:35], 0
    s_nop 0
    v_mfma_f32_4x4x4_16b_bf16 v[96:99], v[10:11], v[36:37], v[96:99]
    v_mfma_f32_4x4x4_16b_bf16 v[100:103], v[10:11], v[38:39], v[100:103]
    s_nop 0
    v_mfma_f32_4x4x4_16b_bf16 v[96:99], v[10:11], v[40:41], v[96:99]
    v_mfma_f32_4x4x4_16b_bf16 v[100:103], v[10:11], v[42:43], v[100:103]
    s_nop 0
    v_mfma_f32_4x4x4_16b_bf16 v[96:99], v[10:11], v[44:45], v[96:99]
    v_mfma_f32_4x4x4_16b_bf16 v[100:103], v[10:11], v[46:47], v[100:103]
    s_nop 3
    v_mul_f32 v96, v96, v80
    v_mul_f32 v97, v97, v81
    v_mul_f32 v98, v98, v82
    v_mul_f32 v99, v99, v83
    v_cvt_pk_bf16_f32 v32, v96, v97
    v_cvt_pk_bf16_f32 v33, v98, v99
    v_mul_f32 v100, v100, v84
    v_mul_f32 v101, v101, v85
    v_mul_f32 v102, v102, v86
    v_mul_f32 v103, v103, v87
    v_cvt_pk_bf16_f32 v34, v100, v101
    v_cvt_pk_bf16_f32 v35, v102, v103
    v_mfma_f32_4x4x4_16b_bf16 v[80:83], v[56:57], v[32:33], 0
    s_nop 0
    v_mfma_f32_4x4x4_16b_bf16 v[84:87], v[56:57], v[34:35], 0
    s_nop 2
    v_mul_f32 v80, v80, v88
    v_mul_f32 v81, v81, v89
    v_mul_f32 v82, v82, v90
    v_mul_f32 v83, v83, v91
    v_mul_f32 v84, v84, v92
    v_mul_f32 v85, v85, v93
    v_mul_f32 v86, v86, v94
    v_mul_f32 v87, v87, v95
    v_mfma_f32_4x4x4_16b_bf16 v[96:99], v[10:11], v[108:109], v[80:83]
    s_nop 0
    v_mfma_f32_4x4x4_16b_bf16 v[100:103], v[10:11], v[110:111], v[84:87]
    s_nop 2
    v_cvt_pk_bf16_f32 v36, v96, v97
    v_cvt_pk_bf16_f32 v37, v98, v99
    v_cvt_pk_bf16_f32 v38, v100, v101
    v_cvt_pk_bf16_f32 v39, v102, v103
    buffer_store_dwordx4 v[36:39], v120, s[12:15], 0 offen nt
    s_cmp_ge_u32 s32, 4
    s_cbranch_scc1 L2_f6
    v_mfma_f32_4x4x4_16b_bf16 v[96:99], v[10:11], v[60:61], 0
    v_mfma_f32_4x4x4_16b_bf16 v[100:103], v[10:11], v[62:63], 0
    s_nop 0
    v_mfma_f32_4x4x4_16b_bf16 v[96:99], v[10:11], v[64:65], v[96:99]
    v_mfma_f32_4x4x4_16b_bf16 v[100:103], v[10:11], v[66:67], v[100:103]
    s_nop 0
    v_mfma_f32_4x4x4_16b_bf16 v[96:99], v[10:11], v[68:69], v[96:99]
    v_mfma_f32_4x4x4_16b_bf16 v[100:103], v[10:11], v[70:71], v[100:103]
    s_nop 0
    v_mfma_f32_4x4x4_16b_bf16 v[96:99], v[10:11], v[72:73], v[96:99]
    v_mfma_f32_4x4x4_16b_bf16 v[100:103], v[10:11], v[74:75], v[100:103]
    s_nop 3
    v_mul_f32 v96, v96, v16
    v_mul_f32 v97, v97, v17
    v_mul_f32 v98, v98, v18
    v_mul_f32 v99, v99, v19
    v_cvt_pk_bf16_f32 v60, v96, v97
    v_cvt_pk_bf16_f32 v61, v98, v99
    v_mul_f32 v100, v100, v20
    v_mul_f32 v101, v101, v21
    v_mul_f32 v102, v102, v22
    v_mul_f32 v103, v103, v23
    v_cvt_pk_bf16_f32 v62, v100, v101
    v_cvt_pk_bf16_f32 v63, v102, v103
    v_mfma_f32_4x4x4_16b_bf16 v[16:19], v[56:57], v[60:61], 0
    s_nop 0
    v_mfma_f32_4x4x4_16b_bf16 v[20:23], v[56:57], v[62:63], 0
    s_nop 2
    v_mul_f32 v16, v16, v24
    v_mul_f32 v17, v17, v25
    v_mul_f32 v18, v18, v26
    v_mul_f32 v19, v19, v27
    v_mul_f32 v20, v20, v28
    v_mul_f32 v21, v21, v29
    v_mul_f32 v22, v22, v30
    v_mul_f32 v23, v23, v31
    v_mfma_f32_4x4x4_16b_bf16 v[96:99], v[10:11], v[112:113], v[16:19]
    s_nop 0
    v_mfma_f32_4x4x4_16b_bf16 v[100:103], v[10:11], v[114:115], v[20:23]
    s_nop 2
    v_cvt_pk_bf16_f32 v64, v96, v97
    v_cvt_pk_bf16_f32 v65, v98, v99
    v_cvt_pk_bf16_f32 v66, v100, v101
    v_cvt_pk_bf16_f32 v67, v102, v103
    buffer_store_dwordx4 v[64:67], v121, s[12:15], 0 offen nt
L2_f6:
L2_end:
    s_endpgm
L2_slow:
    s_lshr_b32 s35, s42, 2
    s_lshl_b32 s50, s32, 4
    s_and_b32 s3, s42, 3
    s_lshl_b32 s53, s3, 3
    s_add_u32 s53, s53, s39
    s_and_b32 s3, s35, 2
    s_lshl_b32 s3, s3, 1
    s_add_u32 s53, s53, s3
    s_and_b32 s54, s35, 1
    s_lshl_b32 s54, s54, 4
L2_sl_seg:
    s_mul_i32 s55, s50, 173056
    s_and_b32 s3, s50, 3
    s_lshl_b32 s3, s3, 5
    s_add_u32 s3, s3, s55
    s_add_u32 s3, s3, s53
    buffer_load_dword v104, off, s[12:15], s3 sc1
    buffer_load_dword v105, off, s[12:15], s3 offset:32 sc1
    s_waitcnt vmcnt(0)
    v_readfirstlane_b32 s51, v104
    v_readfirstlane_b32 s52, v105
    s_lshr_b32 s51, s51, s54
    s_and_b32 s51, s51, 0xffff
    s_lshr_b32 s52, s52, s54
    s_and_b32 s52, s52, 0xffff
L2_sl_rec:
    s_cmp_ge_u32 s51, s52
    s_cbranch_scc1 L2_sl_next
    v_mbcnt_lo_u32_b32 v102, -1, 0
    v_mbcnt_hi_u32_b32 v102, -1, v102
    v_add_u32 v102, s51, v102
    v_and_b32 v103, -4, v102
    v_lshl_add_u32 v104, v102, 2, v103
    v_lshl_add_u32 v105, v103, 2, v102
    v_cmp_gt_u32 vcc, s52, v102
    s_mov_b64 exec, vcc
    buffer_load_dword v106, v104, s[8:11], s55 offen
    buffer_load_ubyte v107, v105, s[8:11], s55 offen offset:16
    s_waitcnt vmcnt(0)
    v_lshrrev_b32 v98, 14, v106
    v_and_b32 v98, v5, v98
    ds_read_b64 v[100:101], v98
    v_perm_b32 v97, v106, v107, s44
    v_and_b32 v96, v5, v106
    v_bitop3_b32 v103, v106, 0.5, -0.5 bitop3:0xa8
    v_bitop3_b32 v97, v6, v97, v103 bitop3:0xca
    s_waitcnt lgkmcnt(0)
    v_mfma_f32_4x4x4_16b_bf16 v[88:91], v[8:9], v[100:101], 0
    s_nop 4
    v_mul_f32 v88, v97, v88
    v_mul_f32 v89, v97, v89
    v_mul_f32 v90, v97, v90
    v_mul_f32 v91, v97, v91
    v_cvt_pk_bf16_f32 v88, v88, v89
    v_cvt_pk_bf16_f32 v89, v90, v91
    ds_pk_add_bf16 v96, v88 offset:65408
    ds_pk_add_bf16 v96, v89 offset:65412
    s_mov_b64 exec, -1
    s_add_u32 s51, s51, 64
    s_branch L2_sl_rec
L2_sl_next:
    s_add_u32 s50, s50, 1
    s_and_b32 s3, s50, 15
    s_cbranch_scc1 L2_sl_seg
    s_add_u32 s50, s50, 240
    s_cmp_lt_u32 s50, 1280
    s_cbranch_scc1 L2_sl_seg
    s_waitcnt lgkmcnt(0)
    s_cmp_eq_u32 s42, 0
    s_cbranch_scc1 L2_ret0
    s_cmp_eq_u32 s42, 1
    s_cbranch_scc1 L2_ret1
    s_cmp_eq_u32 s42, 14
    s_cbranch_scc1 L2_ret6
    s_cmp_eq_u32 s42, 15
    s_cbranch_scc1 L2_ret7
    s_and_b32 s3, s42, 3
    s_cmp_eq_u32 s3, 2
    s_cbranch_scc1 L2_ret2
    s_cmp_eq_u32 s3, 3
    s_cbranch_scc1 L2_ret3
    s_cmp_eq_u32 s3, 0
    s_cbranch_scc1 L2_ret4
    s_branch L2_ret5
L2_p1s:
    s_sleep 32
    s_branch L2_p1
L2_xo3:
    v_cmp_lt_u32 vcc, 20, v99
    s_mov_b32 s101, 1
    s_cbranch_vccz L2_xp3
    v_cmp_lt_u32 vcc, 32, v99
    v_cmp_lt_u32 s[58:59], 31, v88
    s_mov_b32 s101, 2
    s_or_b64 vcc, vcc, s[58:59]
    s_cbranch_scc0 L2_xp3
    s_mov_b32 s37, 0x10000
    s_branch L2_xp3
L2_xa4:
    s_cmp_eq_u32 s101, 1
    s_cbranch_scc1 L2_xc4
    v_lshlrev_b32 v89, 0, v96
    v_add_u32 v90, 140, v97
    v_bitop3_b32 v90, v89, v45, v90 bitop3:0x6a
    ds_write_b32 v98, v90 offset:28
    v_lshlrev_b32 v89, 4, v96
    v_add_u32 v90, 120, v97
    v_bitop3_b32 v90, v89, v45, v90 bitop3:0x6a
    ds_write_b32 v98, v90 offset:24
    v_lshlrev_b32 v89, 8, v96
    v_add_u32 v90, 100, v97
    v_bitop3_b32 v90, v89, v45, v90 bitop3:0x6a
    ds_write_b32 v98, v90 offset:20
L2_xc4:
    v_lshlrev_b32 v89, 12, v96
    v_add_u32 v90, 80, v97
    v_bitop3_b32 v90, v89, v45, v90 bitop3:0x6a
    ds_write_b32 v98, v90 offset:16
    s_branch L2_xb4
L2_xe4:
    v_cmp_lt_u32 vcc, 32, v99
    v_cmp_lt_u32 s[58:59], 31, v88
    v_lshrrev_b32 v89, 16, v96
    v_add_u32 v97, 80, v97
    s_or_b64 vcc, vcc, s[58:59]
    s_cbranch_scc1 L2_xs4
    v_lshlrev_b32 v89, v1, v89
    v_and_b32 v89, v45, v89
    v_cmp_ne_u32 vcc, 0, v89
    v_xor_b32 v90, v97, v89
    s_add_u32 s3, s37, s38
    v_mbcnt_lo_u32_b32 v98, vcc_lo, 0
    v_mbcnt_hi_u32_b32 v98, vcc_hi, v98
    s_bcnt1_i32_b64 s41, vcc
    v_lshl_add_u32 v98, v98, 2, s3
    s_lshl2_add_u32 s37, s41, s37
    s_mov_b64 exec, vcc
    ds_write_b32 v98, v90
    s_mov_b64 exec, -1
    s_branch L2_xr4
L2_xs4:
    s_waitcnt lgkmcnt(0)
    s_mov_b32 s37, 0x10000
    s_branch L2_xw4
L2_xf4:
    s_cmp_gt_u32 s37, 1024
    s_cbranch_scc1 L2_xt4
    s_cmp_lt_u32 s37, 768
    s_cbranch_scc1 L2_xl4
    ds_read_b32 v32, v44 offset:896
    s_add_u32 s3, s42, 0
    s_bitset1_b32 s43, s3
    s_branch L2_xg4
L2_xl4:
    s_waitcnt lgkmcnt(0)
    v_mov_b32 v31, -1
    s_cmp_ge_u32 s37, 512
    s_cbranch_scc1 L2_xg4
    v_mov_b32 v39, -1
    s_cmp_ge_u32 s37, 256
    s_cbranch_scc1 L2_xg4
    v_mov_b32 v27, -1
    s_branch L2_xg4
L2_xt4:
    s_waitcnt lgkmcnt(0)
    v_mov_b32 v21, -1
    v_mov_b32 v27, -1
    v_mov_b32 v39, -1
    v_mov_b32 v31, -1
    s_add_u32 s3, s42, 0
    s_bitset1_b32 s36, s3
    s_branch L2_xg4
L2_xo5:
    v_cmp_lt_u32 vcc, 20, v99
    s_mov_b32 s101, 1
    s_cbranch_vccz L2_xp5
    v_cmp_lt_u32 vcc, 32, v99
    v_cmp_lt_u32 s[58:59], 31, v88
    s_mov_b32 s101, 2
    s_or_b64 vcc, vcc, s[58:59]
    s_cbranch_scc0 L2_xp5
    s_mov_b32 s37, 0x10000
    s_branch L2_xp5
L2_xa6:
    s_cmp_eq_u32 s101, 1
    s_cbranch_scc1 L2_xc6
    v_lshlrev_b32 v89, 0, v96
    v_add_u32 v90, 140, v97
    v_bitop3_b32 v90, v89, v45, v90 bitop3:0x6a
    ds_write_b32 v98, v90 offset:28
    v_lshlrev_b32 v89, 4, v96
    v_add_u32 v90, 120, v97
    v_bitop3_b32 v90, v89, v45, v90 bitop3:0x6a
    ds_write_b32 v98, v90 offset:24
    v_lshlrev_b32 v89, 8, v96
    v_add_u32 v90, 100, v97
    v_bitop3_b32 v90, v89, v45, v90 bitop3:0x6a
    ds_write_b32 v98, v90 offset:20
L2_xc6:
    v_lshlrev_b32 v89, 12, v96
    v_add_u32 v90, 80, v97
    v_bitop3_b32 v90, v89, v45, v90 bitop3:0x6a
    ds_write_b32 v98, v90 offset:16
    s_branch L2_xb6
L2_xe6:
    v_cmp_lt_u32 vcc, 32, v99
    v_cmp_lt_u32 s[58:59], 31, v88
    v_lshrrev_b32 v89, 16, v96
    v_add_u32 v97, 80, v97
    s_or_b64 vcc, vcc, s[58:59]
    s_cbranch_scc1 L2_xs6
    v_lshlrev_b32 v89, v1, v89
    v_and_b32 v89, v45, v89
    v_cmp_ne_u32 vcc, 0, v89
    v_xor_b32 v90, v97, v89
    s_add_u32 s3, s37, s38
    v_mbcnt_lo_u32_b32 v98, vcc_lo, 0
    v_mbcnt_hi_u32_b32 v98, vcc_hi, v98
    s_bcnt1_i32_b64 s41, vcc
    v_lshl_add_u32 v98, v98, 2, s3
    s_lshl2_add_u32 s37, s41, s37
    s_mov_b64 exec, vcc
    ds_write_b32 v98, v90
    s_mov_b64 exec, -1
    s_branch L2_xr6
L2_xs6:
    s_waitcnt lgkmcnt(0)
    s_mov_b32 s37, 0x10000
    s_branch L2_xw6
L2_xf6:
    s_cmp_gt_u32 s37, 1024
    s_cbranch_scc1 L2_xt6
    s_cmp_lt_u32 s37, 768
    s_cbranch_scc1 L2_xl6
    ds_read_b32 v33, v44 offset:896
    s_add_u32 s3, s42, 1
    s_bitset1_b32 s43, s3
    s_branch L2_xg6
L2_xl6:
    s_waitcnt lgkmcnt(0)
    v_mov_b32 v42, -1
    s_cmp_ge_u32 s37, 512
    s_cbranch_scc1 L2_xg6
    v_mov_b32 v43, -1
    s_cmp_ge_u32 s37, 256
    s_cbranch_scc1 L2_xg6
    v_mov_b32 v41, -1
    s_branch L2_xg6
L2_xt6:
    s_waitcnt lgkmcnt(0)
    v_mov_b32 v40, -1
    v_mov_b32 v41, -1
    v_mov_b32 v43, -1
    v_mov_b32 v42, -1
    s_add_u32 s3, s42, 1
    s_bitset1_b32 s36, s3
    s_branch L2_xg6
L2_p2s:
    s_sleep 8
    s_branch L2_p2
L2_oa7:
    v_and_b32 v47, 0x0fffffff, v32
    buffer_load_dword v78, v47, s[8:11], 0 offen offset:16
    s_mov_b64 exec, s[6:7]
    v_add_u32 v47, 8, v47
    v_lshrrev_b32 v32, 2, v32
    s_mov_b64 exec, -1
    buffer_load_dwordx2 v[76:77], v47, s[8:11], 0 offen
    s_branch L2_ob7
L2_oa8:
    s_waitcnt vmcnt(0)
    s_mov_b64 exec, s[6:7]
    v_lshrrev_b32 v78, 16, v78
    s_mov_b64 exec, -1
    v_and_b32 v46, 0x10000000, v32
    v_cmpx_eq_u32 vcc, 0, v46
    v_lshrrev_b32 v47, 14, v76
    v_and_b32 v47, v5, v47
    ds_read_b64 v[96:97], v47
    v_perm_b32 v98, v76, v78, s44
    v_bitop3_b32 v99, v76, 0.5, -0.5 bitop3:0xa8
    v_bitop3_b32 v98, v6, v98, v99 bitop3:0xca
    v_and_b32 v47, v5, v76
    s_waitcnt lgkmcnt(0)
    v_mfma_f32_4x4x4_16b_bf16 v[88:91], v[8:9], v[96:97], 0
    s_nop 4
    v_mul_f32 v88, v98, v88
    v_mul_f32 v89, v98, v89
    v_mul_f32 v90, v98, v90
    v_mul_f32 v91, v98, v91
    v_cvt_pk_bf16_f32 v88, v88, v89
    v_cvt_pk_bf16_f32 v89, v90, v91
    ds_pk_add_bf16 v47, v88 offset:65408
    ds_pk_add_bf16 v47, v89 offset:65412
    s_mov_b64 exec, -1
    v_and_b32 v46, 0x20000000, v32
    v_cmpx_eq_u32 vcc, 0, v46
    v_lshrrev_b32 v47, 14, v77
    v_and_b32 v47, v5, v47
    ds_read_b64 v[96:97], v47
    v_perm_b32 v98, v77, v78, s45
    v_bitop3_b32 v99, v77, 0.5, -0.5 bitop3:0xa8
    v_bitop3_b32 v98, v6, v98, v99 bitop3:0xca
    v_and_b32 v47, v5, v77
    s_waitcnt lgkmcnt(0)
    v_mfma_f32_4x4x4_16b_bf16 v[88:91], v[8:9], v[96:97], 0
    s_nop 4
    v_mul_f32 v88, v98, v88
    v_mul_f32 v89, v98, v89
    v_mul_f32 v90, v98, v90
    v_mul_f32 v91, v98, v91
    v_cvt_pk_bf16_f32 v88, v88, v89
    v_cvt_pk_bf16_f32 v89, v90, v91
    ds_pk_add_bf16 v47, v88 offset:65408
    ds_pk_add_bf16 v47, v89 offset:65412
    s_mov_b64 exec, -1
    s_branch L2_ob8
L2_c9:
    s_lshl_b64 s[52:53], s[82:83], 1
    s_andn2_b64 s[52:53], s[52:53], s[80:81]
    s_andn2_b64 s[52:53], s[52:53], s[54:55]
    s_or_b64 s[80:81], s[80:81], s[52:53]
    s_not_b64 vcc, s[52:53]
    s_mov_b64 exec, -1
    v_cndmask_b32_dpp v84, v84, v84, vcc wave_shr:1 row_mask:0xf bank_mask:0xf
    v_cndmask_b32_dpp v85, v85, v85, vcc wave_shr:1 row_mask:0xf bank_mask:0xf
    s_lshr_b64 s[52:53], s[52:53], 1
    v_cndmask_b32_dpp v86, v86, v86, vcc wave_shr:1 row_mask:0xf bank_mask:0xf
    v_cndmask_b32_dpp v87, v87, v87, vcc wave_shr:1 row_mask:0xf bank_mask:0xf
    s_andn2_b64 s[82:83], s[82:83], s[52:53]
    v_cndmask_b32_dpp v7, v7, v7, vcc wave_shr:1 row_mask:0xf bank_mask:0xf
    s_mov_b64 exec, s[54:55]
    s_cbranch_scc0 L2_d9
    s_mov_b64 exec, s[82:83]
    s_nop 1
    v_mfma_f32_4x4x4_16b_bf16 v[88:91], v[12:13], v[84:85], 0
    s_nop 1
    v_mfma_f32_4x4x4_16b_bf16 v[88:91], v[10:11], v[86:87], v[88:91]
    s_nop 4
    v_cvt_pk_bf16_f32 v88, v88, v89
    v_cvt_pk_bf16_f32 v89, v90, v91
    ds_pk_add_bf16 v7, v88 offset:65408
    ds_pk_add_bf16 v7, v89 offset:65412
    s_mov_b64 exec, s[54:55]
    s_branch L2_d9
L2_c10:
    s_lshl_b64 s[52:53], s[82:83], 1
    s_andn2_b64 s[52:53], s[52:53], s[80:81]
    s_andn2_b64 s[52:53], s[52:53], s[50:51]
    s_or_b64 s[80:81], s[80:81], s[52:53]
    s_not_b64 vcc, s[52:53]
    s_mov_b64 exec, -1
    v_cndmask_b32_dpp v84, v84, v84, vcc wave_shr:1 row_mask:0xf bank_mask:0xf
    v_cndmask_b32_dpp v85, v85, v85, vcc wave_shr:1 row_mask:0xf bank_mask:0xf
    s_lshr_b64 s[52:53], s[52:53], 1
    v_cndmask_b32_dpp v86, v86, v86, vcc wave_shr:1 row_mask:0xf bank_mask:0xf
    v_cndmask_b32_dpp v87, v87, v87, vcc wave_shr:1 row_mask:0xf bank_mask:0xf
    s_andn2_b64 s[82:83], s[82:83], s[52:53]
    v_cndmask_b32_dpp v7, v7, v7, vcc wave_shr:1 row_mask:0xf bank_mask:0xf
    s_mov_b64 exec, s[50:51]
    s_cbranch_scc0 L2_d10
    s_mov_b64 exec, s[82:83]
    s_nop 1
    v_mfma_f32_4x4x4_16b_bf16 v[88:91], v[12:13], v[84:85], 0
    s_nop 1
    v_mfma_f32_4x4x4_16b_bf16 v[88:91], v[10:11], v[86:87], v[88:91]
    s_nop 4
    v_cvt_pk_bf16_f32 v88, v88, v89
    v_cvt_pk_bf16_f32 v89, v90, v91
    ds_pk_add_bf16 v7, v88 offset:65408
    ds_pk_add_bf16 v7, v89 offset:65412
    s_mov_b64 exec, s[50:51]
    s_branch L2_d10
L2_c13:
    s_lshl_b64 s[52:53], s[82:83], 1
    s_andn2_b64 s[52:53], s[52:53], s[80:81]
    s_andn2_b64 s[52:53], s[52:53], s[54:55]
    s_or_b64 s[80:81], s[80:81], s[52:53]
    s_not_b64 vcc, s[52:53]
    s_mov_b64 exec, -1
    v_cndmask_b32_dpp v84, v84, v84, vcc wave_shr:1 row_mask:0xf bank_mask:0xf
    v_cndmask_b32_dpp v85, v85, v85, vcc wave_shr:1 row_mask:0xf bank_mask:0xf
    s_lshr_b64 s[52:53], s[52:53], 1
    v_cndmask_b32_dpp v86, v86, v86, vcc wave_shr:1 row_mask:0xf bank_mask:0xf
    v_cndmask_b32_dpp v87, v87, v87, vcc wave_shr:1 row_mask:0xf bank_mask:0xf
    s_andn2_b64 s[82:83], s[82:83], s[52:53]
    v_cndmask_b32_dpp v7, v7, v7, vcc wave_shr:1 row_mask:0xf bank_mask:0xf
    s_mov_b64 exec, s[54:55]
    s_cbranch_scc0 L2_d13
    s_mov_b64 exec, s[82:83]
    s_nop 1
    v_mfma_f32_4x4x4_16b_bf16 v[88:91], v[12:13], v[84:85], 0
    s_nop 1
    v_mfma_f32_4x4x4_16b_bf16 v[88:91], v[10:11], v[86:87], v[88:91]
    s_nop 4
    v_cvt_pk_bf16_f32 v88, v88, v89
    v_cvt_pk_bf16_f32 v89, v90, v91
    ds_pk_add_bf16 v7, v88 offset:65408
    ds_pk_add_bf16 v7, v89 offset:65412
    s_mov_b64 exec, s[54:55]
    s_branch L2_d13
L2_c14:
    s_lshl_b64 s[52:53], s[82:83], 1
    s_andn2_b64 s[52:53], s[52:53], s[80:81]
    s_andn2_b64 s[52:53], s[52:53], s[50:51]
    s_or_b64 s[80:81], s[80:81], s[52:53]
    s_not_b64 vcc, s[52:53]
    s_mov_b64 exec, -1
    v_cndmask_b32_dpp v84, v84, v84, vcc wave_shr:1 row_mask:0xf bank_mask:0xf
    v_cndmask_b32_dpp v85, v85, v85, vcc wave_shr:1 row_mask:0xf bank_mask:0xf
    s_lshr_b64 s[52:53], s[52:53], 1
    v_cndmask_b32_dpp v86, v86, v86, vcc wave_shr:1 row_mask:0xf bank_mask:0xf
    v_cndmask_b32_dpp v87, v87, v87, vcc wave_shr:1 row_mask:0xf bank_mask:0xf
    s_andn2_b64 s[82:83], s[82:83], s[52:53]
    v_cndmask_b32_dpp v7, v7, v7, vcc wave_shr:1 row_mask:0xf bank_mask:0xf
    s_mov_b64 exec, s[50:51]
    s_cbranch_scc0 L2_d14
    s_mov_b64 exec, s[82:83]
    s_nop 1
    v_mfma_f32_4x4x4_16b_bf16 v[88:91], v[12:13], v[84:85], 0
    s_nop 1
    v_mfma_f32_4x4x4_16b_bf16 v[88:91], v[10:11], v[86:87], v[88:91]
    s_nop 4
    v_cvt_pk_bf16_f32 v88, v88, v89
    v_cvt_pk_bf16_f32 v89, v90, v91
    ds_pk_add_bf16 v7, v88 offset:65408
    ds_pk_add_bf16 v7, v89 offset:65412
    s_mov_b64 exec, s[50:51]
    s_branch L2_d14
L2_xo16:
    v_cmp_lt_u32 vcc, 20, v99
    s_mov_b32 s101, 1
    s_cbranch_vccz L2_xp16
    v_cmp_lt_u32 vcc, 32, v99
    v_cmp_lt_u32 s[58:59], 31, v88
    s_mov_b32 s101, 2
    s_or_b64 vcc, vcc, s[58:59]
    s_cbranch_scc0 L2_xp16
    s_mov_b32 s37, 0x10000
    s_branch L2_xp16
L2_c17:
    s_lshl_b64 s[52:53], s[82:83], 1
    s_andn2_b64 s[52:53], s[52:53], s[80:81]
    s_andn2_b64 s[52:53], s[52:53], s[54:55]
    s_or_b64 s[80:81], s[80:81], s[52:53]
    s_not_b64 vcc, s[52:53]
    s_mov_b64 exec, -1
    v_cndmask_b32_dpp v84, v84, v84, vcc wave_shr:1 row_mask:0xf bank_mask:0xf
    v_cndmask_b32_dpp v85, v85, v85, vcc wave_shr:1 row_mask:0xf bank_mask:0xf
    s_lshr_b64 s[52:53], s[52:53], 1
    v_cndmask_b32_dpp v86, v86, v86, vcc wave_shr:1 row_mask:0xf bank_mask:0xf
    v_cndmask_b32_dpp v87, v87, v87, vcc wave_shr:1 row_mask:0xf bank_mask:0xf
    s_andn2_b64 s[82:83], s[82:83], s[52:53]
    v_cndmask_b32_dpp v7, v7, v7, vcc wave_shr:1 row_mask:0xf bank_mask:0xf
    s_mov_b64 exec, s[54:55]
    s_cbranch_scc0 L2_d17
    s_mov_b64 exec, s[82:83]
    s_nop 1
    v_mfma_f32_4x4x4_16b_bf16 v[88:91], v[12:13], v[84:85], 0
    s_nop 1
    v_mfma_f32_4x4x4_16b_bf16 v[88:91], v[10:11], v[86:87], v[88:91]
    s_nop 4
    v_cvt_pk_bf16_f32 v88, v88, v89
    v_cvt_pk_bf16_f32 v89, v90, v91
    ds_pk_add_bf16 v7, v88 offset:65408
    ds_pk_add_bf16 v7, v89 offset:65412
    s_mov_b64 exec, s[54:55]
    s_branch L2_d17
L2_c18:
    s_lshl_b64 s[52:53], s[82:83], 1
    s_andn2_b64 s[52:53], s[52:53], s[80:81]
    s_andn2_b64 s[52:53], s[52:53], s[50:51]
    s_or_b64 s[80:81], s[80:81], s[52:53]
    s_not_b64 vcc, s[52:53]
    s_mov_b64 exec, -1
    v_cndmask_b32_dpp v84, v84, v84, vcc wave_shr:1 row_mask:0xf bank_mask:0xf
    v_cndmask_b32_dpp v85, v85, v85, vcc wave_shr:1 row_mask:0xf bank_mask:0xf
    s_lshr_b64 s[52:53], s[52:53], 1
    v_cndmask_b32_dpp v86, v86, v86, vcc wave_shr:1 row_mask:0xf bank_mask:0xf
    v_cndmask_b32_dpp v87, v87, v87, vcc wave_shr:1 row_mask:0xf bank_mask:0xf
    s_andn2_b64 s[82:83], s[82:83], s[52:53]
    v_cndmask_b32_dpp v7, v7, v7, vcc wave_shr:1 row_mask:0xf bank_mask:0xf
    s_mov_b64 exec, s[50:51]
    s_cbranch_scc0 L2_d18
    s_mov_b64 exec, s[82:83]
    s_nop 1
    v_mfma_f32_4x4x4_16b_bf16 v[88:91], v[12:13], v[84:85], 0
    s_nop 1
    v_mfma_f32_4x4x4_16b_bf16 v[88:91], v[10:11], v[86:87], v[88:91]
    s_nop 4
    v_cvt_pk_bf16_f32 v88, v88, v89
    v_cvt_pk_bf16_f32 v89, v90, v91
    ds_pk_add_bf16 v7, v88 offset:65408
    ds_pk_add_bf16 v7, v89 offset:65412
    s_mov_b64 exec, s[50:51]
    s_branch L2_d18
L2_c21:
    s_lshl_b64 s[52:53], s[82:83], 1
    s_andn2_b64 s[52:53], s[52:53], s[80:81]
    s_andn2_b64 s[52:53], s[52:53], s[54:55]
    s_or_b64 s[80:81], s[80:81], s[52:53]
    s_not_b64 vcc, s[52:53]
    s_mov_b64 exec, -1
    v_cndmask_b32_dpp v84, v84, v84, vcc wave_shr:1 row_mask:0xf bank_mask:0xf
    v_cndmask_b32_dpp v85, v85, v85, vcc wave_shr:1 row_mask:0xf bank_mask:0xf
    s_lshr_b64 s[52:53], s[52:53], 1
    v_cndmask_b32_dpp v86, v86, v86, vcc wave_shr:1 row_mask:0xf bank_mask:0xf
    v_cndmask_b32_dpp v87, v87, v87, vcc wave_shr:1 row_mask:0xf bank_mask:0xf
    s_andn2_b64 s[82:83], s[82:83], s[52:53]
    v_cndmask_b32_dpp v7, v7, v7, vcc wave_shr:1 row_mask:0xf bank_mask:0xf
    s_mov_b64 exec, s[54:55]
    s_cbranch_scc0 L2_d21
    s_mov_b64 exec, s[82:83]
    s_nop 1
    v_mfma_f32_4x4x4_16b_bf16 v[88:91], v[12:13], v[84:85], 0
    s_nop 1
    v_mfma_f32_4x4x4_16b_bf16 v[88:91], v[10:11], v[86:87], v[88:91]
    s_nop 4
    v_cvt_pk_bf16_f32 v88, v88, v89
    v_cvt_pk_bf16_f32 v89, v90, v91
    ds_pk_add_bf16 v7, v88 offset:65408
    ds_pk_add_bf16 v7, v89 offset:65412
    s_mov_b64 exec, s[54:55]
    s_branch L2_d21
L2_c22:
    s_lshl_b64 s[52:53], s[82:83], 1
    s_andn2_b64 s[52:53], s[52:53], s[80:81]
    s_andn2_b64 s[52:53], s[52:53], s[50:51]
    s_or_b64 s[80:81], s[80:81], s[52:53]
    s_not_b64 vcc, s[52:53]
    s_mov_b64 exec, -1
    v_cndmask_b32_dpp v84, v84, v84, vcc wave_shr:1 row_mask:0xf bank_mask:0xf
    v_cndmask_b32_dpp v85, v85, v85, vcc wave_shr:1 row_mask:0xf bank_mask:0xf
    s_lshr_b64 s[52:53], s[52:53], 1
    v_cndmask_b32_dpp v86, v86, v86, vcc wave_shr:1 row_mask:0xf bank_mask:0xf
    v_cndmask_b32_dpp v87, v87, v87, vcc wave_shr:1 row_mask:0xf bank_mask:0xf
    s_andn2_b64 s[82:83], s[82:83], s[52:53]
    v_cndmask_b32_dpp v7, v7, v7, vcc wave_shr:1 row_mask:0xf bank_mask:0xf
    s_mov_b64 exec, s[50:51]
    s_cbranch_scc0 L2_d22
    s_mov_b64 exec, s[82:83]
    s_nop 1
    v_mfma_f32_4x4x4_16b_bf16 v[88:91], v[12:13], v[84:85], 0
    s_nop 1
    v_mfma_f32_4x4x4_16b_bf16 v[88:91], v[10:11], v[86:87], v[88:91]
    s_nop 4
    v_cvt_pk_bf16_f32 v88, v88, v89
    v_cvt_pk_bf16_f32 v89, v90, v91
    ds_pk_add_bf16 v7, v88 offset:65408
    ds_pk_add_bf16 v7, v89 offset:65412
    s_mov_b64 exec, s[50:51]
    s_branch L2_d22
L2_c23:
    s_lshl_b64 s[52:53], s[82:83], 1
    s_andn2_b64 s[52:53], s[52:53], s[80:81]
    s_andn2_b64 s[52:53], s[52:53], s[54:55]
    s_or_b64 s[80:81], s[80:81], s[52:53]
    s_not_b64 vcc, s[52:53]
    s_mov_b64 exec, -1
    v_cndmask_b32_dpp v84, v84, v84, vcc wave_shr:1 row_mask:0xf bank_mask:0xf
    v_cndmask_b32_dpp v85, v85, v85, vcc wave_shr:1 row_mask:0xf bank_mask:0xf
    s_lshr_b64 s[52:53], s[52:53], 1
    v_cndmask_b32_dpp v86, v86, v86, vcc wave_shr:1 row_mask:0xf bank_mask:0xf
    v_cndmask_b32_dpp v87, v87, v87, vcc wave_shr:1 row_mask:0xf bank_mask:0xf
    s_andn2_b64 s[82:83], s[82:83], s[52:53]
    v_cndmask_b32_dpp v7, v7, v7, vcc wave_shr:1 row_mask:0xf bank_mask:0xf
    s_mov_b64 exec, s[54:55]
    s_cbranch_scc0 L2_d23
    s_mov_b64 exec, s[82:83]
    s_nop 1
    v_mfma_f32_4x4x4_16b_bf16 v[88:91], v[12:13], v[84:85], 0
    s_nop 1
    v_mfma_f32_4x4x4_16b_bf16 v[88:91], v[10:11], v[86:87], v[88:91]
    s_nop 4
    v_cvt_pk_bf16_f32 v88, v88, v89
    v_cvt_pk_bf16_f32 v89, v90, v91
    ds_pk_add_bf16 v7, v88 offset:65408
    ds_pk_add_bf16 v7, v89 offset:65412
    s_mov_b64 exec, s[54:55]
    s_branch L2_d23
L2_c24:
    s_lshl_b64 s[52:53], s[82:83], 1
    s_andn2_b64 s[52:53], s[52:53], s[80:81]
    s_andn2_b64 s[52:53], s[52:53], s[50:51]
    s_or_b64 s[80:81], s[80:81], s[52:53]
    s_not_b64 vcc, s[52:53]
    s_mov_b64 exec, -1
    v_cndmask_b32_dpp v84, v84, v84, vcc wave_shr:1 row_mask:0xf bank_mask:0xf
    v_cndmask_b32_dpp v85, v85, v85, vcc wave_shr:1 row_mask:0xf bank_mask:0xf
    s_lshr_b64 s[52:53], s[52:53], 1
    v_cndmask_b32_dpp v86, v86, v86, vcc wave_shr:1 row_mask:0xf bank_mask:0xf
    v_cndmask_b32_dpp v87, v87, v87, vcc wave_shr:1 row_mask:0xf bank_mask:0xf
    s_andn2_b64 s[82:83], s[82:83], s[52:53]
    v_cndmask_b32_dpp v7, v7, v7, vcc wave_shr:1 row_mask:0xf bank_mask:0xf
    s_mov_b64 exec, s[50:51]
    s_cbranch_scc0 L2_d24
    s_mov_b64 exec, s[82:83]
    s_nop 1
    v_mfma_f32_4x4x4_16b_bf16 v[88:91], v[12:13], v[84:85], 0
    s_nop 1
    v_mfma_f32_4x4x4_16b_bf16 v[88:91], v[10:11], v[86:87], v[88:91]
    s_nop 4
    v_cvt_pk_bf16_f32 v88, v88, v89
    v_cvt_pk_bf16_f32 v89, v90, v91
    ds_pk_add_bf16 v7, v88 offset:65408
    ds_pk_add_bf16 v7, v89 offset:65412
    s_mov_b64 exec, s[50:51]
    s_branch L2_d24
L2_xa25:
    s_cmp_eq_u32 s101, 1
    s_cbranch_scc1 L2_xc25
    v_lshlrev_b32 v89, 0, v96
    v_add_u32 v90, 140, v97
    v_bitop3_b32 v90, v89, v45, v90 bitop3:0x6a
    ds_write_b32 v98, v90 offset:28
    v_lshlrev_b32 v89, 4, v96
    v_add_u32 v90, 120, v97
    v_bitop3_b32 v90, v89, v45, v90 bitop3:0x6a
    ds_write_b32 v98, v90 offset:24
    v_lshlrev_b32 v89, 8, v96
    v_add_u32 v90, 100, v97
    v_bitop3_b32 v90, v89, v45, v90 bitop3:0x6a
    ds_write_b32 v98, v90 offset:20
L2_xc25:
    v_lshlrev_b32 v89, 12, v96
    v_add_u32 v90, 80, v97
    v_bitop3_b32 v90, v89, v45, v90 bitop3:0x6a
    ds_write_b32 v98, v90 offset:16
    s_branch L2_xb25
L2_xe25:
    v_cmp_lt_u32 vcc, 32, v99
    v_cmp_lt_u32 s[58:59], 31, v88
    v_lshrrev_b32 v89, 16, v96
    v_add_u32 v97, 80, v97
    s_or_b64 vcc, vcc, s[58:59]
    s_cbranch_scc1 L2_xs25
    v_lshlrev_b32 v89, v1, v89
    v_and_b32 v89, v45, v89
    v_cmp_ne_u32 vcc, 0, v89
    v_xor_b32 v90, v97, v89
    s_add_u32 s3, s37, s38
    v_mbcnt_lo_u32_b32 v98, vcc_lo, 0
    v_mbcnt_hi_u32_b32 v98, vcc_hi, v98
    s_bcnt1_i32_b64 s41, vcc
    v_lshl_add_u32 v98, v98, 2, s3
    s_lshl2_add_u32 s37, s41, s37
    s_mov_b64 exec, vcc
    ds_write_b32 v98, v90
    s_mov_b64 exec, -1
    s_branch L2_xr25
L2_xs25:
    s_waitcnt lgkmcnt(0)
    s_mov_b32 s37, 0x10000
    s_branch L2_xw25
L2_c26:
    s_lshl_b64 s[52:53], s[82:83], 1
    s_andn2_b64 s[52:53], s[52:53], s[80:81]
    s_andn2_b64 s[52:53], s[52:53], s[54:55]
    s_or_b64 s[80:81], s[80:81], s[52:53]
    s_not_b64 vcc, s[52:53]
    s_mov_b64 exec, -1
    v_cndmask_b32_dpp v84, v84, v84, vcc wave_shr:1 row_mask:0xf bank_mask:0xf
    v_cndmask_b32_dpp v85, v85, v85, vcc wave_shr:1 row_mask:0xf bank_mask:0xf
    s_lshr_b64 s[52:53], s[52:53], 1
    v_cndmask_b32_dpp v86, v86, v86, vcc wave_shr:1 row_mask:0xf bank_mask:0xf
    v_cndmask_b32_dpp v87, v87, v87, vcc wave_shr:1 row_mask:0xf bank_mask:0xf
    s_andn2_b64 s[82:83], s[82:83], s[52:53]
    v_cndmask_b32_dpp v7, v7, v7, vcc wave_shr:1 row_mask:0xf bank_mask:0xf
    s_mov_b64 exec, s[54:55]
    s_cbranch_scc0 L2_d26
    s_mov_b64 exec, s[82:83]
    s_nop 1
    v_mfma_f32_4x4x4_16b_bf16 v[88:91], v[12:13], v[84:85], 0
    s_nop 1
    v_mfma_f32_4x4x4_16b_bf16 v[88:91], v[10:11], v[86:87], v[88:91]
    s_nop 4
    v_cvt_pk_bf16_f32 v88, v88, v89
    v_cvt_pk_bf16_f32 v89, v90, v91
    ds_pk_add_bf16 v7, v88 offset:65408
    ds_pk_add_bf16 v7, v89 offset:65412
    s_mov_b64 exec, s[54:55]
    s_branch L2_d26
L2_c27:
    s_lshl_b64 s[52:53], s[82:83], 1
    s_andn2_b64 s[52:53], s[52:53], s[80:81]
    s_andn2_b64 s[52:53], s[52:53], s[50:51]
    s_or_b64 s[80:81], s[80:81], s[52:53]
    s_not_b64 vcc, s[52:53]
    s_mov_b64 exec, -1
    v_cndmask_b32_dpp v84, v84, v84, vcc wave_shr:1 row_mask:0xf bank_mask:0xf
    v_cndmask_b32_dpp v85, v85, v85, vcc wave_shr:1 row_mask:0xf bank_mask:0xf
    s_lshr_b64 s[52:53], s[52:53], 1
    v_cndmask_b32_dpp v86, v86, v86, vcc wave_shr:1 row_mask:0xf bank_mask:0xf
    v_cndmask_b32_dpp v87, v87, v87, vcc wave_shr:1 row_mask:0xf bank_mask:0xf
    s_andn2_b64 s[82:83], s[82:83], s[52:53]
    v_cndmask_b32_dpp v7, v7, v7, vcc wave_shr:1 row_mask:0xf bank_mask:0xf
    s_mov_b64 exec, s[50:51]
    s_cbranch_scc0 L2_d27
    s_mov_b64 exec, s[82:83]
    s_nop 1
    v_mfma_f32_4x4x4_16b_bf16 v[88:91], v[12:13], v[84:85], 0
    s_nop 1
    v_mfma_f32_4x4x4_16b_bf16 v[88:91], v[10:11], v[86:87], v[88:91]
    s_nop 4
    v_cvt_pk_bf16_f32 v88, v88, v89
    v_cvt_pk_bf16_f32 v89, v90, v91
    ds_pk_add_bf16 v7, v88 offset:65408
    ds_pk_add_bf16 v7, v89 offset:65412
    s_mov_b64 exec, s[50:51]
    s_branch L2_d27
L2_xf25:
    s_cmp_gt_u32 s37, 1024
    s_cbranch_scc1 L2_xt25
    s_cmp_lt_u32 s37, 768
    s_cbranch_scc1 L2_xl25
    ds_read_b32 v32, v44 offset:896
    s_add_u32 s3, s42, 2
    s_bitset1_b32 s43, s3
    s_branch L2_xg25
L2_xl25:
    s_waitcnt lgkmcnt(0)
    v_mov_b32 v31, -1
    s_cmp_ge_u32 s37, 512
    s_cbranch_scc1 L2_xg25
    v_mov_b32 v39, -1
    s_cmp_ge_u32 s37, 256
    s_cbranch_scc1 L2_xg25
    v_mov_b32 v27, -1
    s_branch L2_xg25
L2_xt25:
    s_waitcnt lgkmcnt(0)
    v_mov_b32 v21, -1
    v_mov_b32 v27, -1
    v_mov_b32 v39, -1
    v_mov_b32 v31, -1
    s_add_u32 s3, s42, 2
    s_bitset1_b32 s36, s3
    s_branch L2_xg25
L2_oa28:
    v_and_b32 v47, 0x0fffffff, v33
    buffer_load_dword v114, v47, s[8:11], 0 offen offset:16
    s_mov_b64 exec, s[6:7]
    v_add_u32 v47, 8, v47
    v_lshrrev_b32 v33, 2, v33
    s_mov_b64 exec, -1
    buffer_load_dwordx2 v[112:113], v47, s[8:11], 0 offen
    s_branch L2_ob28
L2_c29:
    s_lshl_b64 s[52:53], s[82:83], 1
    s_andn2_b64 s[52:53], s[52:53], s[80:81]
    s_andn2_b64 s[52:53], s[52:53], s[54:55]
    s_or_b64 s[80:81], s[80:81], s[52:53]
    s_not_b64 vcc, s[52:53]
    s_mov_b64 exec, -1
    v_cndmask_b32_dpp v84, v84, v84, vcc wave_shr:1 row_mask:0xf bank_mask:0xf
    v_cndmask_b32_dpp v85, v85, v85, vcc wave_shr:1 row_mask:0xf bank_mask:0xf
    s_lshr_b64 s[52:53], s[52:53], 1
    v_cndmask_b32_dpp v86, v86, v86, vcc wave_shr:1 row_mask:0xf bank_mask:0xf
    v_cndmask_b32_dpp v87, v87, v87, vcc wave_shr:1 row_mask:0xf bank_mask:0xf
    s_andn2_b64 s[82:83], s[82:83], s[52:53]
    v_cndmask_b32_dpp v7, v7, v7, vcc wave_shr:1 row_mask:0xf bank_mask:0xf
    s_mov_b64 exec, s[54:55]
    s_cbranch_scc0 L2_d29
    s_mov_b64 exec, s[82:83]
    s_nop 1
    v_mfma_f32_4x4x4_16b_bf16 v[88:91], v[12:13], v[84:85], 0
    s_nop 1
    v_mfma_f32_4x4x4_16b_bf16 v[88:91], v[10:11], v[86:87], v[88:91]
    s_nop 4
    v_cvt_pk_bf16_f32 v88, v88, v89
    v_cvt_pk_bf16_f32 v89, v90, v91
    ds_pk_add_bf16 v7, v88 offset:65408
    ds_pk_add_bf16 v7, v89 offset:65412
    s_mov_b64 exec, s[54:55]
    s_branch L2_d29
L2_c30:
    s_lshl_b64 s[52:53], s[82:83], 1
    s_andn2_b64 s[52:53], s[52:53], s[80:81]
    s_andn2_b64 s[52:53], s[52:53], s[50:51]
    s_or_b64 s[80:81], s[80:81], s[52:53]
    s_not_b64 vcc, s[52:53]
    s_mov_b64 exec, -1
    v_cndmask_b32_dpp v84, v84, v84, vcc wave_shr:1 row_mask:0xf bank_mask:0xf
    v_cndmask_b32_dpp v85, v85, v85, vcc wave_shr:1 row_mask:0xf bank_mask:0xf
    s_lshr_b64 s[52:53], s[52:53], 1
    v_cndmask_b32_dpp v86, v86, v86, vcc wave_shr:1 row_mask:0xf bank_mask:0xf
    v_cndmask_b32_dpp v87, v87, v87, vcc wave_shr:1 row_mask:0xf bank_mask:0xf
    s_andn2_b64 s[82:83], s[82:83], s[52:53]
    v_cndmask_b32_dpp v7, v7, v7, vcc wave_shr:1 row_mask:0xf bank_mask:0xf
    s_mov_b64 exec, s[50:51]
    s_cbranch_scc0 L2_d30
    s_mov_b64 exec, s[82:83]
    s_nop 1
    v_mfma_f32_4x4x4_16b_bf16 v[88:91], v[12:13], v[84:85], 0
    s_nop 1
    v_mfma_f32_4x4x4_16b_bf16 v[88:91], v[10:11], v[86:87], v[88:91]
    s_nop 4
    v_cvt_pk_bf16_f32 v88, v88, v89
    v_cvt_pk_bf16_f32 v89, v90, v91
    ds_pk_add_bf16 v7, v88 offset:65408
    ds_pk_add_bf16 v7, v89 offset:65412
    s_mov_b64 exec, s[50:51]
    s_branch L2_d30
L2_c31:
    s_lshl_b64 s[52:53], s[82:83], 1
    s_andn2_b64 s[52:53], s[52:53], s[80:81]
    s_andn2_b64 s[52:53], s[52:53], s[54:55]
    s_or_b64 s[80:81], s[80:81], s[52:53]
    s_not_b64 vcc, s[52:53]
    s_mov_b64 exec, -1
    v_cndmask_b32_dpp v84, v84, v84, vcc wave_shr:1 row_mask:0xf bank_mask:0xf
    v_cndmask_b32_dpp v85, v85, v85, vcc wave_shr:1 row_mask:0xf bank_mask:0xf
    s_lshr_b64 s[52:53], s[52:53], 1
    v_cndmask_b32_dpp v86, v86, v86, vcc wave_shr:1 row_mask:0xf bank_mask:0xf
    v_cndmask_b32_dpp v87, v87, v87, vcc wave_shr:1 row_mask:0xf bank_mask:0xf
    s_andn2_b64 s[82:83], s[82:83], s[52:53]
    v_cndmask_b32_dpp v7, v7, v7, vcc wave_shr:1 row_mask:0xf bank_mask:0xf
    s_mov_b64 exec, s[54:55]
    s_cbranch_scc0 L2_d31
    s_mov_b64 exec, s[82:83]
    s_nop 1
    v_mfma_f32_4x4x4_16b_bf16 v[88:91], v[12:13], v[84:85], 0
    s_nop 1
    v_mfma_f32_4x4x4_16b_bf16 v[88:91], v[10:11], v[86:87], v[88:91]
    s_nop 4
    v_cvt_pk_bf16_f32 v88, v88, v89
    v_cvt_pk_bf16_f32 v89, v90, v91
    ds_pk_add_bf16 v7, v88 offset:65408
    ds_pk_add_bf16 v7, v89 offset:65412
    s_mov_b64 exec, s[54:55]
    s_branch L2_d31
L2_c32:
    s_lshl_b64 s[52:53], s[82:83], 1
    s_andn2_b64 s[52:53], s[52:53], s[80:81]
    s_andn2_b64 s[52:53], s[52:53], s[50:51]
    s_or_b64 s[80:81], s[80:81], s[52:53]
    s_not_b64 vcc, s[52:53]
    s_mov_b64 exec, -1
    v_cndmask_b32_dpp v84, v84, v84, vcc wave_shr:1 row_mask:0xf bank_mask:0xf
    v_cndmask_b32_dpp v85, v85, v85, vcc wave_shr:1 row_mask:0xf bank_mask:0xf
    s_lshr_b64 s[52:53], s[52:53], 1
    v_cndmask_b32_dpp v86, v86, v86, vcc wave_shr:1 row_mask:0xf bank_mask:0xf
    v_cndmask_b32_dpp v87, v87, v87, vcc wave_shr:1 row_mask:0xf bank_mask:0xf
    s_andn2_b64 s[82:83], s[82:83], s[52:53]
    v_cndmask_b32_dpp v7, v7, v7, vcc wave_shr:1 row_mask:0xf bank_mask:0xf
    s_mov_b64 exec, s[50:51]
    s_cbranch_scc0 L2_d32
    s_mov_b64 exec, s[82:83]
    s_nop 1
    v_mfma_f32_4x4x4_16b_bf16 v[88:91], v[12:13], v[84:85], 0
    s_nop 1
    v_mfma_f32_4x4x4_16b_bf16 v[88:91], v[10:11], v[86:87], v[88:91]
    s_nop 4
    v_cvt_pk_bf16_f32 v88, v88, v89
    v_cvt_pk_bf16_f32 v89, v90, v91
    ds_pk_add_bf16 v7, v88 offset:65408
    ds_pk_add_bf16 v7, v89 offset:65412
    s_mov_b64 exec, s[50:51]
    s_branch L2_d32
L2_c33:
    s_lshl_b64 s[52:53], s[82:83], 1
    s_andn2_b64 s[52:53], s[52:53], s[80:81]
    s_andn2_b64 s[52:53], s[52:53], s[54:55]
    s_or_b64 s[80:81], s[80:81], s[52:53]
    s_not_b64 vcc, s[52:53]
    s_mov_b64 exec, -1
    v_cndmask_b32_dpp v84, v84, v84, vcc wave_shr:1 row_mask:0xf bank_mask:0xf
    v_cndmask_b32_dpp v85, v85, v85, vcc wave_shr:1 row_mask:0xf bank_mask:0xf
    s_lshr_b64 s[52:53], s[52:53], 1
    v_cndmask_b32_dpp v86, v86, v86, vcc wave_shr:1 row_mask:0xf bank_mask:0xf
    v_cndmask_b32_dpp v87, v87, v87, vcc wave_shr:1 row_mask:0xf bank_mask:0xf
    s_andn2_b64 s[82:83], s[82:83], s[52:53]
    v_cndmask_b32_dpp v7, v7, v7, vcc wave_shr:1 row_mask:0xf bank_mask:0xf
    s_mov_b64 exec, s[54:55]
    s_cbranch_scc0 L2_d33
    s_mov_b64 exec, s[82:83]
    s_nop 1
    v_mfma_f32_4x4x4_16b_bf16 v[88:91], v[12:13], v[84:85], 0
    s_nop 1
    v_mfma_f32_4x4x4_16b_bf16 v[88:91], v[10:11], v[86:87], v[88:91]
    s_nop 4
    v_cvt_pk_bf16_f32 v88, v88, v89
    v_cvt_pk_bf16_f32 v89, v90, v91
    ds_pk_add_bf16 v7, v88 offset:65408
    ds_pk_add_bf16 v7, v89 offset:65412
    s_mov_b64 exec, s[54:55]
    s_branch L2_d33
L2_c34:
    s_lshl_b64 s[52:53], s[82:83], 1
    s_andn2_b64 s[52:53], s[52:53], s[80:81]
    s_andn2_b64 s[52:53], s[52:53], s[50:51]
    s_or_b64 s[80:81], s[80:81], s[52:53]
    s_not_b64 vcc, s[52:53]
    s_mov_b64 exec, -1
    v_cndmask_b32_dpp v84, v84, v84, vcc wave_shr:1 row_mask:0xf bank_mask:0xf
    v_cndmask_b32_dpp v85, v85, v85, vcc wave_shr:1 row_mask:0xf bank_mask:0xf
    s_lshr_b64 s[52:53], s[52:53], 1
    v_cndmask_b32_dpp v86, v86, v86, vcc wave_shr:1 row_mask:0xf bank_mask:0xf
    v_cndmask_b32_dpp v87, v87, v87, vcc wave_shr:1 row_mask:0xf bank_mask:0xf
    s_andn2_b64 s[82:83], s[82:83], s[52:53]
    v_cndmask_b32_dpp v7, v7, v7, vcc wave_shr:1 row_mask:0xf bank_mask:0xf
    s_mov_b64 exec, s[50:51]
    s_cbranch_scc0 L2_d34
    s_mov_b64 exec, s[82:83]
    s_nop 1
    v_mfma_f32_4x4x4_16b_bf16 v[88:91], v[12:13], v[84:85], 0
    s_nop 1
    v_mfma_f32_4x4x4_16b_bf16 v[88:91], v[10:11], v[86:87], v[88:91]
    s_nop 4
    v_cvt_pk_bf16_f32 v88, v88, v89
    v_cvt_pk_bf16_f32 v89, v90, v91
    ds_pk_add_bf16 v7, v88 offset:65408
    ds_pk_add_bf16 v7, v89 offset:65412
    s_mov_b64 exec, s[50:51]
    s_branch L2_d34
L2_oa35:
    s_waitcnt vmcnt(3)
    s_mov_b64 exec, s[6:7]
    v_lshrrev_b32 v114, 16, v114
    s_mov_b64 exec, -1
    v_and_b32 v46, 0x10000000, v33
    v_cmpx_eq_u32 vcc, 0, v46
    v_lshrrev_b32 v47, 14, v112
    v_and_b32 v47, v5, v47
    ds_read_b64 v[96:97], v47
    v_perm_b32 v98, v112, v114, s44
    v_bitop3_b32 v99, v112, 0.5, -0.5 bitop3:0xa8
    v_bitop3_b32 v98, v6, v98, v99 bitop3:0xca
    v_and_b32 v47, v5, v112
    s_waitcnt lgkmcnt(0)
    v_mfma_f32_4x4x4_16b_bf16 v[88:91], v[8:9], v[96:97], 0
    s_nop 4
    v_mul_f32 v88, v98, v88
    v_mul_f32 v89, v98, v89
    v_mul_f32 v90, v98, v90
    v_mul_f32 v91, v98, v91
    v_cvt_pk_bf16_f32 v88, v88, v89
    v_cvt_pk_bf16_f32 v89, v90, v91
    ds_pk_add_bf16 v47, v88 offset:65408
    ds_pk_add_bf16 v47, v89 offset:65412
    s_mov_b64 exec, -1
    v_and_b32 v46, 0x20000000, v33
    v_cmpx_eq_u32 vcc, 0, v46
    v_lshrrev_b32 v47, 14, v113
    v_and_b32 v47, v5, v47
    ds_read_b64 v[96:97], v47
    v_perm_b32 v98, v113, v114, s45
    v_bitop3_b32 v99, v113, 0.5, -0.5 bitop3:0xa8
    v_bitop3_b32 v98, v6, v98, v99 bitop3:0xca
    v_and_b32 v47, v5, v113
    s_waitcnt lgkmcnt(0)
    v_mfma_f32_4x4x4_16b_bf16 v[88:91], v[8:9], v[96:97], 0
    s_nop 4
    v_mul_f32 v88, v98, v88
    v_mul_f32 v89, v98, v89
    v_mul_f32 v90, v98, v90
    v_mul_f32 v91, v98, v91
    v_cvt_pk_bf16_f32 v88, v88, v89
    v_cvt_pk_bf16_f32 v89, v90, v91
    ds_pk_add_bf16 v47, v88 offset:65408
    ds_pk_add_bf16 v47, v89 offset:65412
    s_mov_b64 exec, -1
    s_branch L2_ob35
L2_xo36:
    v_cmp_lt_u32 vcc, 20, v99
    s_mov_b32 s101, 1
    s_cbranch_vccz L2_xp36
    v_cmp_lt_u32 vcc, 32, v99
    v_cmp_lt_u32 s[58:59], 31, v88
    s_mov_b32 s101, 2
    s_or_b64 vcc, vcc, s[58:59]
    s_cbranch_scc0 L2_xp36
    s_mov_b32 s37, 0x10000
    s_branch L2_xp36
L2_c37:
    s_lshl_b64 s[52:53], s[82:83], 1
    s_andn2_b64 s[52:53], s[52:53], s[80:81]
    s_andn2_b64 s[52:53], s[52:53], s[54:55]
    s_or_b64 s[80:81], s[80:81], s[52:53]
    s_not_b64 vcc, s[52:53]
    s_mov_b64 exec, -1
    v_cndmask_b32_dpp v84, v84, v84, vcc wave_shr:1 row_mask:0xf bank_mask:0xf
    v_cndmask_b32_dpp v85, v85, v85, vcc wave_shr:1 row_mask:0xf bank_mask:0xf
    s_lshr_b64 s[52:53], s[52:53], 1
    v_cndmask_b32_dpp v86, v86, v86, vcc wave_shr:1 row_mask:0xf bank_mask:0xf
    v_cndmask_b32_dpp v87, v87, v87, vcc wave_shr:1 row_mask:0xf bank_mask:0xf
    s_andn2_b64 s[82:83], s[82:83], s[52:53]
    v_cndmask_b32_dpp v7, v7, v7, vcc wave_shr:1 row_mask:0xf bank_mask:0xf
    s_mov_b64 exec, s[54:55]
    s_cbranch_scc0 L2_d37
    s_mov_b64 exec, s[82:83]
    s_nop 1
    v_mfma_f32_4x4x4_16b_bf16 v[88:91], v[12:13], v[84:85], 0
    s_nop 1
    v_mfma_f32_4x4x4_16b_bf16 v[88:91], v[10:11], v[86:87], v[88:91]
    s_nop 4
    v_cvt_pk_bf16_f32 v88, v88, v89
    v_cvt_pk_bf16_f32 v89, v90, v91
    ds_pk_add_bf16 v7, v88 offset:65408
    ds_pk_add_bf16 v7, v89 offset:65412
    s_mov_b64 exec, s[54:55]
    s_branch L2_d37
L2_c38:
    s_lshl_b64 s[52:53], s[82:83], 1
    s_andn2_b64 s[52:53], s[52:53], s[80:81]
    s_andn2_b64 s[52:53], s[52:53], s[50:51]
    s_or_b64 s[80:81], s[80:81], s[52:53]
    s_not_b64 vcc, s[52:53]
    s_mov_b64 exec, -1
    v_cndmask_b32_dpp v84, v84, v84, vcc wave_shr:1 row_mask:0xf bank_mask:0xf
    v_cndmask_b32_dpp v85, v85, v85, vcc wave_shr:1 row_mask:0xf bank_mask:0xf
    s_lshr_b64 s[52:53], s[52:53], 1
    v_cndmask_b32_dpp v86, v86, v86, vcc wave_shr:1 row_mask:0xf bank_mask:0xf
    v_cndmask_b32_dpp v87, v87, v87, vcc wave_shr:1 row_mask:0xf bank_mask:0xf
    s_andn2_b64 s[82:83], s[82:83], s[52:53]
    v_cndmask_b32_dpp v7, v7, v7, vcc wave_shr:1 row_mask:0xf bank_mask:0xf
    s_mov_b64 exec, s[50:51]
    s_cbranch_scc0 L2_d38
    s_mov_b64 exec, s[82:83]
    s_nop 1
    v_mfma_f32_4x4x4_16b_bf16 v[88:91], v[12:13], v[84:85], 0
    s_nop 1
    v_mfma_f32_4x4x4_16b_bf16 v[88:91], v[10:11], v[86:87], v[88:91]
    s_nop 4
    v_cvt_pk_bf16_f32 v88, v88, v89
    v_cvt_pk_bf16_f32 v89, v90, v91
    ds_pk_add_bf16 v7, v88 offset:65408
    ds_pk_add_bf16 v7, v89 offset:65412
    s_mov_b64 exec, s[50:51]
    s_branch L2_d38
L2_c39:
    s_lshl_b64 s[52:53], s[82:83], 1
    s_andn2_b64 s[52:53], s[52:53], s[80:81]
    s_andn2_b64 s[52:53], s[52:53], s[54:55]
    s_or_b64 s[80:81], s[80:81], s[52:53]
    s_not_b64 vcc, s[52:53]
    s_mov_b64 exec, -1
    v_cndmask_b32_dpp v84, v84, v84, vcc wave_shr:1 row_mask:0xf bank_mask:0xf
    v_cndmask_b32_dpp v85, v85, v85, vcc wave_shr:1 row_mask:0xf bank_mask:0xf
    s_lshr_b64 s[52:53], s[52:53], 1
    v_cndmask_b32_dpp v86, v86, v86, vcc wave_shr:1 row_mask:0xf bank_mask:0xf
    v_cndmask_b32_dpp v87, v87, v87, vcc wave_shr:1 row_mask:0xf bank_mask:0xf
    s_andn2_b64 s[82:83], s[82:83], s[52:53]
    v_cndmask_b32_dpp v7, v7, v7, vcc wave_shr:1 row_mask:0xf bank_mask:0xf
    s_mov_b64 exec, s[54:55]
    s_cbranch_scc0 L2_d39
    s_mov_b64 exec, s[82:83]
    s_nop 1
    v_mfma_f32_4x4x4_16b_bf16 v[88:91], v[12:13], v[84:85], 0
    s_nop 1
    v_mfma_f32_4x4x4_16b_bf16 v[88:91], v[10:11], v[86:87], v[88:91]
    s_nop 4
    v_cvt_pk_bf16_f32 v88, v88, v89
    v_cvt_pk_bf16_f32 v89, v90, v91
    ds_pk_add_bf16 v7, v88 offset:65408
    ds_pk_add_bf16 v7, v89 offset:65412
    s_mov_b64 exec, s[54:55]
    s_branch L2_d39
L2_c40:
    s_lshl_b64 s[52:53], s[82:83], 1
    s_andn2_b64 s[52:53], s[52:53], s[80:81]
    s_andn2_b64 s[52:53], s[52:53], s[50:51]
    s_or_b64 s[80:81], s[80:81], s[52:53]
    s_not_b64 vcc, s[52:53]
    s_mov_b64 exec, -1
    v_cndmask_b32_dpp v84, v84, v84, vcc wave_shr:1 row_mask:0xf bank_mask:0xf
    v_cndmask_b32_dpp v85, v85, v85, vcc wave_shr:1 row_mask:0xf bank_mask:0xf
    s_lshr_b64 s[52:53], s[52:53], 1
    v_cndmask_b32_dpp v86, v86, v86, vcc wave_shr:1 row_mask:0xf bank_mask:0xf
    v_cndmask_b32_dpp v87, v87, v87, vcc wave_shr:1 row_mask:0xf bank_mask:0xf
    s_andn2_b64 s[82:83], s[82:83], s[52:53]
    v_cndmask_b32_dpp v7, v7, v7, vcc wave_shr:1 row_mask:0xf bank_mask:0xf
    s_mov_b64 exec, s[50:51]
    s_cbranch_scc0 L2_d40
    s_mov_b64 exec, s[82:83]
    s_nop 1
    v_mfma_f32_4x4x4_16b_bf16 v[88:91], v[12:13], v[84:85], 0
    s_nop 1
    v_mfma_f32_4x4x4_16b_bf16 v[88:91], v[10:11], v[86:87], v[88:91]
    s_nop 4
    v_cvt_pk_bf16_f32 v88, v88, v89
    v_cvt_pk_bf16_f32 v89, v90, v91
    ds_pk_add_bf16 v7, v88 offset:65408
    ds_pk_add_bf16 v7, v89 offset:65412
    s_mov_b64 exec, s[50:51]
    s_branch L2_d40
L2_c41:
    s_lshl_b64 s[52:53], s[82:83], 1
    s_andn2_b64 s[52:53], s[52:53], s[80:81]
    s_andn2_b64 s[52:53], s[52:53], s[54:55]
    s_or_b64 s[80:81], s[80:81], s[52:53]
    s_not_b64 vcc, s[52:53]
    s_mov_b64 exec, -1
    v_cndmask_b32_dpp v84, v84, v84, vcc wave_shr:1 row_mask:0xf bank_mask:0xf
    v_cndmask_b32_dpp v85, v85, v85, vcc wave_shr:1 row_mask:0xf bank_mask:0xf
    s_lshr_b64 s[52:53], s[52:53], 1
    v_cndmask_b32_dpp v86, v86, v86, vcc wave_shr:1 row_mask:0xf bank_mask:0xf
    v_cndmask_b32_dpp v87, v87, v87, vcc wave_shr:1 row_mask:0xf bank_mask:0xf
    s_andn2_b64 s[82:83], s[82:83], s[52:53]
    v_cndmask_b32_dpp v7, v7, v7, vcc wave_shr:1 row_mask:0xf bank_mask:0xf
    s_mov_b64 exec, s[54:55]
    s_cbranch_scc0 L2_d41
    s_mov_b64 exec, s[82:83]
    s_nop 1
    v_mfma_f32_4x4x4_16b_bf16 v[88:91], v[12:13], v[84:85], 0
    s_nop 1
    v_mfma_f32_4x4x4_16b_bf16 v[88:91], v[10:11], v[86:87], v[88:91]
    s_nop 4
    v_cvt_pk_bf16_f32 v88, v88, v89
    v_cvt_pk_bf16_f32 v89, v90, v91
    ds_pk_add_bf16 v7, v88 offset:65408
    ds_pk_add_bf16 v7, v89 offset:65412
    s_mov_b64 exec, s[54:55]
    s_branch L2_d41
L2_c42:
    s_lshl_b64 s[52:53], s[82:83], 1
    s_andn2_b64 s[52:53], s[52:53], s[80:81]
    s_andn2_b64 s[52:53], s[52:53], s[50:51]
    s_or_b64 s[80:81], s[80:81], s[52:53]
    s_not_b64 vcc, s[52:53]
    s_mov_b64 exec, -1
    v_cndmask_b32_dpp v84, v84, v84, vcc wave_shr:1 row_mask:0xf bank_mask:0xf
    v_cndmask_b32_dpp v85, v85, v85, vcc wave_shr:1 row_mask:0xf bank_mask:0xf
    s_lshr_b64 s[52:53], s[52:53], 1
    v_cndmask_b32_dpp v86, v86, v86, vcc wave_shr:1 row_mask:0xf bank_mask:0xf
    v_cndmask_b32_dpp v87, v87, v87, vcc wave_shr:1 row_mask:0xf bank_mask:0xf
    s_andn2_b64 s[82:83], s[82:83], s[52:53]
    v_cndmask_b32_dpp v7, v7, v7, vcc wave_shr:1 row_mask:0xf bank_mask:0xf
    s_mov_b64 exec, s[50:51]
    s_cbranch_scc0 L2_d42
    s_mov_b64 exec, s[82:83]
    s_nop 1
    v_mfma_f32_4x4x4_16b_bf16 v[88:91], v[12:13], v[84:85], 0
    s_nop 1
    v_mfma_f32_4x4x4_16b_bf16 v[88:91], v[10:11], v[86:87], v[88:91]
    s_nop 4
    v_cvt_pk_bf16_f32 v88, v88, v89
    v_cvt_pk_bf16_f32 v89, v90, v91
    ds_pk_add_bf16 v7, v88 offset:65408
    ds_pk_add_bf16 v7, v89 offset:65412
    s_mov_b64 exec, s[50:51]
    s_branch L2_d42
L2_xa43:
    s_cmp_eq_u32 s101, 1
    s_cbranch_scc1 L2_xc43
    v_lshlrev_b32 v89, 0, v96
    v_add_u32 v90, 140, v97
    v_bitop3_b32 v90, v89, v45, v90 bitop3:0x6a
    ds_write_b32 v98, v90 offset:28
    v_lshlrev_b32 v89, 4, v96
    v_add_u32 v90, 120, v97
    v_bitop3_b32 v90, v89, v45, v90 bitop3:0x6a
    ds_write_b32 v98, v90 offset:24
    v_lshlrev_b32 v89, 8, v96
    v_add_u32 v90, 100, v97
    v_bitop3_b32 v90, v89, v45, v90 bitop3:0x6a
    ds_write_b32 v98, v90 offset:20
L2_xc43:
    v_lshlrev_b32 v89, 12, v96
    v_add_u32 v90, 80, v97
    v_bitop3_b32 v90, v89, v45, v90 bitop3:0x6a
    ds_write_b32 v98, v90 offset:16
    s_branch L2_xb43
L2_xe43:
    v_cmp_lt_u32 vcc, 32, v99
    v_cmp_lt_u32 s[58:59], 31, v88
    v_lshrrev_b32 v89, 16, v96
    v_add_u32 v97, 80, v97
    s_or_b64 vcc, vcc, s[58:59]
    s_cbranch_scc1 L2_xs43
    v_lshlrev_b32 v89, v1, v89
    v_and_b32 v89, v45, v89
    v_cmp_ne_u32 vcc, 0, v89
    v_xor_b32 v90, v97, v89
    s_add_u32 s3, s37, s38
    v_mbcnt_lo_u32_b32 v98, vcc_lo, 0
    v_mbcnt_hi_u32_b32 v98, vcc_hi, v98
    s_bcnt1_i32_b64 s41, vcc
    v_lshl_add_u32 v98, v98, 2, s3
    s_lshl2_add_u32 s37, s41, s37
    s_mov_b64 exec, vcc
    ds_write_b32 v98, v90
    s_mov_b64 exec, -1
    s_branch L2_xr43
L2_xs43:
    s_waitcnt lgkmcnt(0)
    s_mov_b32 s37, 0x10000
    s_branch L2_xw43
L2_c44:
    s_lshl_b64 s[52:53], s[82:83], 1
    s_andn2_b64 s[52:53], s[52:53], s[80:81]
    s_andn2_b64 s[52:53], s[52:53], s[54:55]
    s_or_b64 s[80:81], s[80:81], s[52:53]
    s_not_b64 vcc, s[52:53]
    s_mov_b64 exec, -1
    v_cndmask_b32_dpp v84, v84, v84, vcc wave_shr:1 row_mask:0xf bank_mask:0xf
    v_cndmask_b32_dpp v85, v85, v85, vcc wave_shr:1 row_mask:0xf bank_mask:0xf
    s_lshr_b64 s[52:53], s[52:53], 1
    v_cndmask_b32_dpp v86, v86, v86, vcc wave_shr:1 row_mask:0xf bank_mask:0xf
    v_cndmask_b32_dpp v87, v87, v87, vcc wave_shr:1 row_mask:0xf bank_mask:0xf
    s_andn2_b64 s[82:83], s[82:83], s[52:53]
    v_cndmask_b32_dpp v7, v7, v7, vcc wave_shr:1 row_mask:0xf bank_mask:0xf
    s_mov_b64 exec, s[54:55]
    s_cbranch_scc0 L2_d44
    s_mov_b64 exec, s[82:83]
    s_nop 1
    v_mfma_f32_4x4x4_16b_bf16 v[88:91], v[12:13], v[84:85], 0
    s_nop 1
    v_mfma_f32_4x4x4_16b_bf16 v[88:91], v[10:11], v[86:87], v[88:91]
    s_nop 4
    v_cvt_pk_bf16_f32 v88, v88, v89
    v_cvt_pk_bf16_f32 v89, v90, v91
    ds_pk_add_bf16 v7, v88 offset:65408
    ds_pk_add_bf16 v7, v89 offset:65412
    s_mov_b64 exec, s[54:55]
    s_branch L2_d44
L2_c45:
    s_lshl_b64 s[52:53], s[82:83], 1
    s_andn2_b64 s[52:53], s[52:53], s[80:81]
    s_andn2_b64 s[52:53], s[52:53], s[50:51]
    s_or_b64 s[80:81], s[80:81], s[52:53]
    s_not_b64 vcc, s[52:53]
    s_mov_b64 exec, -1
    v_cndmask_b32_dpp v84, v84, v84, vcc wave_shr:1 row_mask:0xf bank_mask:0xf
    v_cndmask_b32_dpp v85, v85, v85, vcc wave_shr:1 row_mask:0xf bank_mask:0xf
    s_lshr_b64 s[52:53], s[52:53], 1
    v_cndmask_b32_dpp v86, v86, v86, vcc wave_shr:1 row_mask:0xf bank_mask:0xf
    v_cndmask_b32_dpp v87, v87, v87, vcc wave_shr:1 row_mask:0xf bank_mask:0xf
    s_andn2_b64 s[82:83], s[82:83], s[52:53]
    v_cndmask_b32_dpp v7, v7, v7, vcc wave_shr:1 row_mask:0xf bank_mask:0xf
    s_mov_b64 exec, s[50:51]
    s_cbranch_scc0 L2_d45
    s_mov_b64 exec, s[82:83]
    s_nop 1
    v_mfma_f32_4x4x4_16b_bf16 v[88:91], v[12:13], v[84:85], 0
    s_nop 1
    v_mfma_f32_4x4x4_16b_bf16 v[88:91], v[10:11], v[86:87], v[88:91]
    s_nop 4
    v_cvt_pk_bf16_f32 v88, v88, v89
    v_cvt_pk_bf16_f32 v89, v90, v91
    ds_pk_add_bf16 v7, v88 offset:65408
    ds_pk_add_bf16 v7, v89 offset:65412
    s_mov_b64 exec, s[50:51]
    s_branch L2_d45
L2_xf43:
    s_cmp_gt_u32 s37, 1024
    s_cbranch_scc1 L2_xt43
    s_cmp_lt_u32 s37, 768
    s_cbranch_scc1 L2_xl43
    ds_read_b32 v33, v44 offset:896
    s_add_u32 s3, s42, 2
    s_bitset1_b32 s43, s3
    s_branch L2_xg43
L2_xl43:
    s_waitcnt lgkmcnt(0)
    v_mov_b32 v42, -1
    s_cmp_ge_u32 s37, 512
    s_cbranch_scc1 L2_xg43
    v_mov_b32 v43, -1
    s_cmp_ge_u32 s37, 256
    s_cbranch_scc1 L2_xg43
    v_mov_b32 v41, -1
    s_branch L2_xg43
L2_xt43:
    s_waitcnt lgkmcnt(0)
    v_mov_b32 v40, -1
    v_mov_b32 v41, -1
    v_mov_b32 v43, -1
    v_mov_b32 v42, -1
    s_add_u32 s3, s42, 2
    s_bitset1_b32 s36, s3
    s_branch L2_xg43
L2_oa46:
    v_and_b32 v47, 0x0fffffff, v32
    buffer_load_dword v114, v47, s[8:11], 0 offen offset:16
    s_mov_b64 exec, s[6:7]
    v_add_u32 v47, 8, v47
    v_lshrrev_b32 v32, 2, v32
    s_mov_b64 exec, -1
    buffer_load_dwordx2 v[112:113], v47, s[8:11], 0 offen
    s_branch L2_ob46
L2_c47:
    s_lshl_b64 s[52:53], s[82:83], 1
    s_andn2_b64 s[52:53], s[52:53], s[80:81]
    s_andn2_b64 s[52:53], s[52:53], s[54:55]
    s_or_b64 s[80:81], s[80:81], s[52:53]
    s_not_b64 vcc, s[52:53]
    s_mov_b64 exec, -1
    v_cndmask_b32_dpp v84, v84, v84, vcc wave_shr:1 row_mask:0xf bank_mask:0xf
    v_cndmask_b32_dpp v85, v85, v85, vcc wave_shr:1 row_mask:0xf bank_mask:0xf
    s_lshr_b64 s[52:53], s[52:53], 1
    v_cndmask_b32_dpp v86, v86, v86, vcc wave_shr:1 row_mask:0xf bank_mask:0xf
    v_cndmask_b32_dpp v87, v87, v87, vcc wave_shr:1 row_mask:0xf bank_mask:0xf
    s_andn2_b64 s[82:83], s[82:83], s[52:53]
    v_cndmask_b32_dpp v7, v7, v7, vcc wave_shr:1 row_mask:0xf bank_mask:0xf
    s_mov_b64 exec, s[54:55]
    s_cbranch_scc0 L2_d47
    s_mov_b64 exec, s[82:83]
    s_nop 1
    v_mfma_f32_4x4x4_16b_bf16 v[88:91], v[12:13], v[84:85], 0
    s_nop 1
    v_mfma_f32_4x4x4_16b_bf16 v[88:91], v[10:11], v[86:87], v[88:91]
    s_nop 4
    v_cvt_pk_bf16_f32 v88, v88, v89
    v_cvt_pk_bf16_f32 v89, v90, v91
    ds_pk_add_bf16 v7, v88 offset:65408
    ds_pk_add_bf16 v7, v89 offset:65412
    s_mov_b64 exec, s[54:55]
    s_branch L2_d47
L2_c48:
    s_lshl_b64 s[52:53], s[82:83], 1
    s_andn2_b64 s[52:53], s[52:53], s[80:81]
    s_andn2_b64 s[52:53], s[52:53], s[50:51]
    s_or_b64 s[80:81], s[80:81], s[52:53]
    s_not_b64 vcc, s[52:53]
    s_mov_b64 exec, -1
    v_cndmask_b32_dpp v84, v84, v84, vcc wave_shr:1 row_mask:0xf bank_mask:0xf
    v_cndmask_b32_dpp v85, v85, v85, vcc wave_shr:1 row_mask:0xf bank_mask:0xf
    s_lshr_b64 s[52:53], s[52:53], 1
    v_cndmask_b32_dpp v86, v86, v86, vcc wave_shr:1 row_mask:0xf bank_mask:0xf
    v_cndmask_b32_dpp v87, v87, v87, vcc wave_shr:1 row_mask:0xf bank_mask:0xf
    s_andn2_b64 s[82:83], s[82:83], s[52:53]
    v_cndmask_b32_dpp v7, v7, v7, vcc wave_shr:1 row_mask:0xf bank_mask:0xf
    s_mov_b64 exec, s[50:51]
    s_cbranch_scc0 L2_d48
    s_mov_b64 exec, s[82:83]
    s_nop 1
    v_mfma_f32_4x4x4_16b_bf16 v[88:91], v[12:13], v[84:85], 0
    s_nop 1
    v_mfma_f32_4x4x4_16b_bf16 v[88:91], v[10:11], v[86:87], v[88:91]
    s_nop 4
    v_cvt_pk_bf16_f32 v88, v88, v89
    v_cvt_pk_bf16_f32 v89, v90, v91
    ds_pk_add_bf16 v7, v88 offset:65408
    ds_pk_add_bf16 v7, v89 offset:65412
    s_mov_b64 exec, s[50:51]
    s_branch L2_d48
L2_c49:
    s_lshl_b64 s[52:53], s[82:83], 1
    s_andn2_b64 s[52:53], s[52:53], s[80:81]
    s_andn2_b64 s[52:53], s[52:53], s[54:55]
    s_or_b64 s[80:81], s[80:81], s[52:53]
    s_not_b64 vcc, s[52:53]
    s_mov_b64 exec, -1
    v_cndmask_b32_dpp v84, v84, v84, vcc wave_shr:1 row_mask:0xf bank_mask:0xf
    v_cndmask_b32_dpp v85, v85, v85, vcc wave_shr:1 row_mask:0xf bank_mask:0xf
    s_lshr_b64 s[52:53], s[52:53], 1
    v_cndmask_b32_dpp v86, v86, v86, vcc wave_shr:1 row_mask:0xf bank_mask:0xf
    v_cndmask_b32_dpp v87, v87, v87, vcc wave_shr:1 row_mask:0xf bank_mask:0xf
    s_andn2_b64 s[82:83], s[82:83], s[52:53]
    v_cndmask_b32_dpp v7, v7, v7, vcc wave_shr:1 row_mask:0xf bank_mask:0xf
    s_mov_b64 exec, s[54:55]
    s_cbranch_scc0 L2_d49
    s_mov_b64 exec, s[82:83]
    s_nop 1
    v_mfma_f32_4x4x4_16b_bf16 v[88:91], v[12:13], v[84:85], 0
    s_nop 1
    v_mfma_f32_4x4x4_16b_bf16 v[88:91], v[10:11], v[86:87], v[88:91]
    s_nop 4
    v_cvt_pk_bf16_f32 v88, v88, v89
    v_cvt_pk_bf16_f32 v89, v90, v91
    ds_pk_add_bf16 v7, v88 offset:65408
    ds_pk_add_bf16 v7, v89 offset:65412
    s_mov_b64 exec, s[54:55]
    s_branch L2_d49
L2_c50:
    s_lshl_b64 s[52:53], s[82:83], 1
    s_andn2_b64 s[52:53], s[52:53], s[80:81]
    s_andn2_b64 s[52:53], s[52:53], s[50:51]
    s_or_b64 s[80:81], s[80:81], s[52:53]
    s_not_b64 vcc, s[52:53]
    s_mov_b64 exec, -1
    v_cndmask_b32_dpp v84, v84, v84, vcc wave_shr:1 row_mask:0xf bank_mask:0xf
    v_cndmask_b32_dpp v85, v85, v85, vcc wave_shr:1 row_mask:0xf bank_mask:0xf
    s_lshr_b64 s[52:53], s[52:53], 1
    v_cndmask_b32_dpp v86, v86, v86, vcc wave_shr:1 row_mask:0xf bank_mask:0xf
    v_cndmask_b32_dpp v87, v87, v87, vcc wave_shr:1 row_mask:0xf bank_mask:0xf
    s_andn2_b64 s[82:83], s[82:83], s[52:53]
    v_cndmask_b32_dpp v7, v7, v7, vcc wave_shr:1 row_mask:0xf bank_mask:0xf
    s_mov_b64 exec, s[50:51]
    s_cbranch_scc0 L2_d50
    s_mov_b64 exec, s[82:83]
    s_nop 1
    v_mfma_f32_4x4x4_16b_bf16 v[88:91], v[12:13], v[84:85], 0
    s_nop 1
    v_mfma_f32_4x4x4_16b_bf16 v[88:91], v[10:11], v[86:87], v[88:91]
    s_nop 4
    v_cvt_pk_bf16_f32 v88, v88, v89
    v_cvt_pk_bf16_f32 v89, v90, v91
    ds_pk_add_bf16 v7, v88 offset:65408
    ds_pk_add_bf16 v7, v89 offset:65412
    s_mov_b64 exec, s[50:51]
    s_branch L2_d50
L2_c51:
    s_lshl_b64 s[52:53], s[82:83], 1
    s_andn2_b64 s[52:53], s[52:53], s[80:81]
    s_andn2_b64 s[52:53], s[52:53], s[54:55]
    s_or_b64 s[80:81], s[80:81], s[52:53]
    s_not_b64 vcc, s[52:53]
    s_mov_b64 exec, -1
    v_cndmask_b32_dpp v84, v84, v84, vcc wave_shr:1 row_mask:0xf bank_mask:0xf
    v_cndmask_b32_dpp v85, v85, v85, vcc wave_shr:1 row_mask:0xf bank_mask:0xf
    s_lshr_b64 s[52:53], s[52:53], 1
    v_cndmask_b32_dpp v86, v86, v86, vcc wave_shr:1 row_mask:0xf bank_mask:0xf
    v_cndmask_b32_dpp v87, v87, v87, vcc wave_shr:1 row_mask:0xf bank_mask:0xf
    s_andn2_b64 s[82:83], s[82:83], s[52:53]
    v_cndmask_b32_dpp v7, v7, v7, vcc wave_shr:1 row_mask:0xf bank_mask:0xf
    s_mov_b64 exec, s[54:55]
    s_cbranch_scc0 L2_d51
    s_mov_b64 exec, s[82:83]
    s_nop 1
    v_mfma_f32_4x4x4_16b_bf16 v[88:91], v[12:13], v[84:85], 0
    s_nop 1
    v_mfma_f32_4x4x4_16b_bf16 v[88:91], v[10:11], v[86:87], v[88:91]
    s_nop 4
    v_cvt_pk_bf16_f32 v88, v88, v89
    v_cvt_pk_bf16_f32 v89, v90, v91
    ds_pk_add_bf16 v7, v88 offset:65408
    ds_pk_add_bf16 v7, v89 offset:65412
    s_mov_b64 exec, s[54:55]
    s_branch L2_d51
L2_c52:
    s_lshl_b64 s[52:53], s[82:83], 1
    s_andn2_b64 s[52:53], s[52:53], s[80:81]
    s_andn2_b64 s[52:53], s[52:53], s[50:51]
    s_or_b64 s[80:81], s[80:81], s[52:53]
    s_not_b64 vcc, s[52:53]
    s_mov_b64 exec, -1
    v_cndmask_b32_dpp v84, v84, v84, vcc wave_shr:1 row_mask:0xf bank_mask:0xf
    v_cndmask_b32_dpp v85, v85, v85, vcc wave_shr:1 row_mask:0xf bank_mask:0xf
    s_lshr_b64 s[52:53], s[52:53], 1
    v_cndmask_b32_dpp v86, v86, v86, vcc wave_shr:1 row_mask:0xf bank_mask:0xf
    v_cndmask_b32_dpp v87, v87, v87, vcc wave_shr:1 row_mask:0xf bank_mask:0xf
    s_andn2_b64 s[82:83], s[82:83], s[52:53]
    v_cndmask_b32_dpp v7, v7, v7, vcc wave_shr:1 row_mask:0xf bank_mask:0xf
    s_mov_b64 exec, s[50:51]
    s_cbranch_scc0 L2_d52
    s_mov_b64 exec, s[82:83]
    s_nop 1
    v_mfma_f32_4x4x4_16b_bf16 v[88:91], v[12:13], v[84:85], 0
    s_nop 1
    v_mfma_f32_4x4x4_16b_bf16 v[88:91], v[10:11], v[86:87], v[88:91]
    s_nop 4
    v_cvt_pk_bf16_f32 v88, v88, v89
    v_cvt_pk_bf16_f32 v89, v90, v91
    ds_pk_add_bf16 v7, v88 offset:65408
    ds_pk_add_bf16 v7, v89 offset:65412
    s_mov_b64 exec, s[50:51]
    s_branch L2_d52
L2_oa53:
    s_waitcnt vmcnt(3)
    s_mov_b64 exec, s[6:7]
    v_lshrrev_b32 v114, 16, v114
    s_mov_b64 exec, -1
    v_and_b32 v46, 0x10000000, v32
    v_cmpx_eq_u32 vcc, 0, v46
    v_lshrrev_b32 v47, 14, v112
    v_and_b32 v47, v5, v47
    ds_read_b64 v[96:97], v47
    v_perm_b32 v98, v112, v114, s44
    v_bitop3_b32 v99, v112, 0.5, -0.5 bitop3:0xa8
    v_bitop3_b32 v98, v6, v98, v99 bitop3:0xca
    v_and_b32 v47, v5, v112
    s_waitcnt lgkmcnt(0)
    v_mfma_f32_4x4x4_16b_bf16 v[88:91], v[8:9], v[96:97], 0
    s_nop 4
    v_mul_f32 v88, v98, v88
    v_mul_f32 v89, v98, v89
    v_mul_f32 v90, v98, v90
    v_mul_f32 v91, v98, v91
    v_cvt_pk_bf16_f32 v88, v88, v89
    v_cvt_pk_bf16_f32 v89, v90, v91
    ds_pk_add_bf16 v47, v88 offset:65408
    ds_pk_add_bf16 v47, v89 offset:65412
    s_mov_b64 exec, -1
    v_and_b32 v46, 0x20000000, v32
    v_cmpx_eq_u32 vcc, 0, v46
    v_lshrrev_b32 v47, 14, v113
    v_and_b32 v47, v5, v47
    ds_read_b64 v[96:97], v47
    v_perm_b32 v98, v113, v114, s45
    v_bitop3_b32 v99, v113, 0.5, -0.5 bitop3:0xa8
    v_bitop3_b32 v98, v6, v98, v99 bitop3:0xca
    v_and_b32 v47, v5, v113
    s_waitcnt lgkmcnt(0)
    v_mfma_f32_4x4x4_16b_bf16 v[88:91], v[8:9], v[96:97], 0
    s_nop 4
    v_mul_f32 v88, v98, v88
    v_mul_f32 v89, v98, v89
    v_mul_f32 v90, v98, v90
    v_mul_f32 v91, v98, v91
    v_cvt_pk_bf16_f32 v88, v88, v89
    v_cvt_pk_bf16_f32 v89, v90, v91
    ds_pk_add_bf16 v47, v88 offset:65408
    ds_pk_add_bf16 v47, v89 offset:65412
    s_mov_b64 exec, -1
    s_branch L2_ob53
L2_xo54:
    v_cmp_lt_u32 vcc, 20, v99
    s_mov_b32 s101, 1
    s_cbranch_vccz L2_xp54
    v_cmp_lt_u32 vcc, 32, v99
    v_cmp_lt_u32 s[58:59], 31, v88
    s_mov_b32 s101, 2
    s_or_b64 vcc, vcc, s[58:59]
    s_cbranch_scc0 L2_xp54
    s_mov_b32 s37, 0x10000
    s_branch L2_xp54
L2_c55:
    s_lshl_b64 s[52:53], s[82:83], 1
    s_andn2_b64 s[52:53], s[52:53], s[80:81]
    s_andn2_b64 s[52:53], s[52:53], s[54:55]
    s_or_b64 s[80:81], s[80:81], s[52:53]
    s_not_b64 vcc, s[52:53]
    s_mov_b64 exec, -1
    v_cndmask_b32_dpp v84, v84, v84, vcc wave_shr:1 row_mask:0xf bank_mask:0xf
    v_cndmask_b32_dpp v85, v85, v85, vcc wave_shr:1 row_mask:0xf bank_mask:0xf
    s_lshr_b64 s[52:53], s[52:53], 1
    v_cndmask_b32_dpp v86, v86, v86, vcc wave_shr:1 row_mask:0xf bank_mask:0xf
    v_cndmask_b32_dpp v87, v87, v87, vcc wave_shr:1 row_mask:0xf bank_mask:0xf
    s_andn2_b64 s[82:83], s[82:83], s[52:53]
    v_cndmask_b32_dpp v7, v7, v7, vcc wave_shr:1 row_mask:0xf bank_mask:0xf
    s_mov_b64 exec, s[54:55]
    s_cbranch_scc0 L2_d55
    s_mov_b64 exec, s[82:83]
    s_nop 1
    v_mfma_f32_4x4x4_16b_bf16 v[88:91], v[12:13], v[84:85], 0
    s_nop 1
    v_mfma_f32_4x4x4_16b_bf16 v[88:91], v[10:11], v[86:87], v[88:91]
    s_nop 4
    v_cvt_pk_bf16_f32 v88, v88, v89
    v_cvt_pk_bf16_f32 v89, v90, v91
    ds_pk_add_bf16 v7, v88 offset:65408
    ds_pk_add_bf16 v7, v89 offset:65412
    s_mov_b64 exec, s[54:55]
    s_branch L2_d55
L2_c56:
    s_lshl_b64 s[52:53], s[82:83], 1
    s_andn2_b64 s[52:53], s[52:53], s[80:81]
    s_andn2_b64 s[52:53], s[52:53], s[50:51]
    s_or_b64 s[80:81], s[80:81], s[52:53]
    s_not_b64 vcc, s[52:53]
    s_mov_b64 exec, -1
    v_cndmask_b32_dpp v84, v84, v84, vcc wave_shr:1 row_mask:0xf bank_mask:0xf
    v_cndmask_b32_dpp v85, v85, v85, vcc wave_shr:1 row_mask:0xf bank_mask:0xf
    s_lshr_b64 s[52:53], s[52:53], 1
    v_cndmask_b32_dpp v86, v86, v86, vcc wave_shr:1 row_mask:0xf bank_mask:0xf
    v_cndmask_b32_dpp v87, v87, v87, vcc wave_shr:1 row_mask:0xf bank_mask:0xf
    s_andn2_b64 s[82:83], s[82:83], s[52:53]
    v_cndmask_b32_dpp v7, v7, v7, vcc wave_shr:1 row_mask:0xf bank_mask:0xf
    s_mov_b64 exec, s[50:51]
    s_cbranch_scc0 L2_d56
    s_mov_b64 exec, s[82:83]
    s_nop 1
    v_mfma_f32_4x4x4_16b_bf16 v[88:91], v[12:13], v[84:85], 0
    s_nop 1
    v_mfma_f32_4x4x4_16b_bf16 v[88:91], v[10:11], v[86:87], v[88:91]
    s_nop 4
    v_cvt_pk_bf16_f32 v88, v88, v89
    v_cvt_pk_bf16_f32 v89, v90, v91
    ds_pk_add_bf16 v7, v88 offset:65408
    ds_pk_add_bf16 v7, v89 offset:65412
    s_mov_b64 exec, s[50:51]
    s_branch L2_d56
L2_c57:
    s_lshl_b64 s[52:53], s[82:83], 1
    s_andn2_b64 s[52:53], s[52:53], s[80:81]
    s_andn2_b64 s[52:53], s[52:53], s[54:55]
    s_or_b64 s[80:81], s[80:81], s[52:53]
    s_not_b64 vcc, s[52:53]
    s_mov_b64 exec, -1
    v_cndmask_b32_dpp v84, v84, v84, vcc wave_shr:1 row_mask:0xf bank_mask:0xf
    v_cndmask_b32_dpp v85, v85, v85, vcc wave_shr:1 row_mask:0xf bank_mask:0xf
    s_lshr_b64 s[52:53], s[52:53], 1
    v_cndmask_b32_dpp v86, v86, v86, vcc wave_shr:1 row_mask:0xf bank_mask:0xf
    v_cndmask_b32_dpp v87, v87, v87, vcc wave_shr:1 row_mask:0xf bank_mask:0xf
    s_andn2_b64 s[82:83], s[82:83], s[52:53]
    v_cndmask_b32_dpp v7, v7, v7, vcc wave_shr:1 row_mask:0xf bank_mask:0xf
    s_mov_b64 exec, s[54:55]
    s_cbranch_scc0 L2_d57
    s_mov_b64 exec, s[82:83]
    s_nop 1
    v_mfma_f32_4x4x4_16b_bf16 v[88:91], v[12:13], v[84:85], 0
    s_nop 1
    v_mfma_f32_4x4x4_16b_bf16 v[88:91], v[10:11], v[86:87], v[88:91]
    s_nop 4
    v_cvt_pk_bf16_f32 v88, v88, v89
    v_cvt_pk_bf16_f32 v89, v90, v91
    ds_pk_add_bf16 v7, v88 offset:65408
    ds_pk_add_bf16 v7, v89 offset:65412
    s_mov_b64 exec, s[54:55]
    s_branch L2_d57
L2_c58:
    s_lshl_b64 s[52:53], s[82:83], 1
    s_andn2_b64 s[52:53], s[52:53], s[80:81]
    s_andn2_b64 s[52:53], s[52:53], s[50:51]
    s_or_b64 s[80:81], s[80:81], s[52:53]
    s_not_b64 vcc, s[52:53]
    s_mov_b64 exec, -1
    v_cndmask_b32_dpp v84, v84, v84, vcc wave_shr:1 row_mask:0xf bank_mask:0xf
    v_cndmask_b32_dpp v85, v85, v85, vcc wave_shr:1 row_mask:0xf bank_mask:0xf
    s_lshr_b64 s[52:53], s[52:53], 1
    v_cndmask_b32_dpp v86, v86, v86, vcc wave_shr:1 row_mask:0xf bank_mask:0xf
    v_cndmask_b32_dpp v87, v87, v87, vcc wave_shr:1 row_mask:0xf bank_mask:0xf
    s_andn2_b64 s[82:83], s[82:83], s[52:53]
    v_cndmask_b32_dpp v7, v7, v7, vcc wave_shr:1 row_mask:0xf bank_mask:0xf
    s_mov_b64 exec, s[50:51]
    s_cbranch_scc0 L2_d58
    s_mov_b64 exec, s[82:83]
    s_nop 1
    v_mfma_f32_4x4x4_16b_bf16 v[88:91], v[12:13], v[84:85], 0
    s_nop 1
    v_mfma_f32_4x4x4_16b_bf16 v[88:91], v[10:11], v[86:87], v[88:91]
    s_nop 4
    v_cvt_pk_bf16_f32 v88, v88, v89
    v_cvt_pk_bf16_f32 v89, v90, v91
    ds_pk_add_bf16 v7, v88 offset:65408
    ds_pk_add_bf16 v7, v89 offset:65412
    s_mov_b64 exec, s[50:51]
    s_branch L2_d58
L2_c59:
    s_lshl_b64 s[52:53], s[82:83], 1
    s_andn2_b64 s[52:53], s[52:53], s[80:81]
    s_andn2_b64 s[52:53], s[52:53], s[54:55]
    s_or_b64 s[80:81], s[80:81], s[52:53]
    s_not_b64 vcc, s[52:53]
    s_mov_b64 exec, -1
    v_cndmask_b32_dpp v84, v84, v84, vcc wave_shr:1 row_mask:0xf bank_mask:0xf
    v_cndmask_b32_dpp v85, v85, v85, vcc wave_shr:1 row_mask:0xf bank_mask:0xf
    s_lshr_b64 s[52:53], s[52:53], 1
    v_cndmask_b32_dpp v86, v86, v86, vcc wave_shr:1 row_mask:0xf bank_mask:0xf
    v_cndmask_b32_dpp v87, v87, v87, vcc wave_shr:1 row_mask:0xf bank_mask:0xf
    s_andn2_b64 s[82:83], s[82:83], s[52:53]
    v_cndmask_b32_dpp v7, v7, v7, vcc wave_shr:1 row_mask:0xf bank_mask:0xf
    s_mov_b64 exec, s[54:55]
    s_cbranch_scc0 L2_d59
    s_mov_b64 exec, s[82:83]
    s_nop 1
    v_mfma_f32_4x4x4_16b_bf16 v[88:91], v[12:13], v[84:85], 0
    s_nop 1
    v_mfma_f32_4x4x4_16b_bf16 v[88:91], v[10:11], v[86:87], v[88:91]
    s_nop 4
    v_cvt_pk_bf16_f32 v88, v88, v89
    v_cvt_pk_bf16_f32 v89, v90, v91
    ds_pk_add_bf16 v7, v88 offset:65408
    ds_pk_add_bf16 v7, v89 offset:65412
    s_mov_b64 exec, s[54:55]
    s_branch L2_d59
L2_c60:
    s_lshl_b64 s[52:53], s[82:83], 1
    s_andn2_b64 s[52:53], s[52:53], s[80:81]
    s_andn2_b64 s[52:53], s[52:53], s[50:51]
    s_or_b64 s[80:81], s[80:81], s[52:53]
    s_not_b64 vcc, s[52:53]
    s_mov_b64 exec, -1
    v_cndmask_b32_dpp v84, v84, v84, vcc wave_shr:1 row_mask:0xf bank_mask:0xf
    v_cndmask_b32_dpp v85, v85, v85, vcc wave_shr:1 row_mask:0xf bank_mask:0xf
    s_lshr_b64 s[52:53], s[52:53], 1
    v_cndmask_b32_dpp v86, v86, v86, vcc wave_shr:1 row_mask:0xf bank_mask:0xf
    v_cndmask_b32_dpp v87, v87, v87, vcc wave_shr:1 row_mask:0xf bank_mask:0xf
    s_andn2_b64 s[82:83], s[82:83], s[52:53]
    v_cndmask_b32_dpp v7, v7, v7, vcc wave_shr:1 row_mask:0xf bank_mask:0xf
    s_mov_b64 exec, s[50:51]
    s_cbranch_scc0 L2_d60
    s_mov_b64 exec, s[82:83]
    s_nop 1
    v_mfma_f32_4x4x4_16b_bf16 v[88:91], v[12:13], v[84:85], 0
    s_nop 1
    v_mfma_f32_4x4x4_16b_bf16 v[88:91], v[10:11], v[86:87], v[88:91]
    s_nop 4
    v_cvt_pk_bf16_f32 v88, v88, v89
    v_cvt_pk_bf16_f32 v89, v90, v91
    ds_pk_add_bf16 v7, v88 offset:65408
    ds_pk_add_bf16 v7, v89 offset:65412
    s_mov_b64 exec, s[50:51]
    s_branch L2_d60
L2_xa61:
    s_cmp_eq_u32 s101, 1
    s_cbranch_scc1 L2_xc61
    v_lshlrev_b32 v89, 0, v96
    v_add_u32 v90, 140, v97
    v_bitop3_b32 v90, v89, v45, v90 bitop3:0x6a
    ds_write_b32 v98, v90 offset:28
    v_lshlrev_b32 v89, 4, v96
    v_add_u32 v90, 120, v97
    v_bitop3_b32 v90, v89, v45, v90 bitop3:0x6a
    ds_write_b32 v98, v90 offset:24
    v_lshlrev_b32 v89, 8, v96
    v_add_u32 v90, 100, v97
    v_bitop3_b32 v90, v89, v45, v90 bitop3:0x6a
    ds_write_b32 v98, v90 offset:20
L2_xc61:
    v_lshlrev_b32 v89, 12, v96
    v_add_u32 v90, 80, v97
    v_bitop3_b32 v90, v89, v45, v90 bitop3:0x6a
    ds_write_b32 v98, v90 offset:16
    s_branch L2_xb61
L2_xe61:
    v_cmp_lt_u32 vcc, 32, v99
    v_cmp_lt_u32 s[58:59], 31, v88
    v_lshrrev_b32 v89, 16, v96
    v_add_u32 v97, 80, v97
    s_or_b64 vcc, vcc, s[58:59]
    s_cbranch_scc1 L2_xs61
    v_lshlrev_b32 v89, v1, v89
    v_and_b32 v89, v45, v89
    v_cmp_ne_u32 vcc, 0, v89
    v_xor_b32 v90, v97, v89
    s_add_u32 s3, s37, s38
    v_mbcnt_lo_u32_b32 v98, vcc_lo, 0
    v_mbcnt_hi_u32_b32 v98, vcc_hi, v98
    s_bcnt1_i32_b64 s41, vcc
    v_lshl_add_u32 v98, v98, 2, s3
    s_lshl2_add_u32 s37, s41, s37
    s_mov_b64 exec, vcc
    ds_write_b32 v98, v90
    s_mov_b64 exec, -1
    s_branch L2_xr61
L2_xs61:
    s_waitcnt lgkmcnt(0)
    s_mov_b32 s37, 0x10000
    s_branch L2_xw61
L2_c62:
    s_lshl_b64 s[52:53], s[82:83], 1
    s_andn2_b64 s[52:53], s[52:53], s[80:81]
    s_andn2_b64 s[52:53], s[52:53], s[54:55]
    s_or_b64 s[80:81], s[80:81], s[52:53]
    s_not_b64 vcc, s[52:53]
    s_mov_b64 exec, -1
    v_cndmask_b32_dpp v84, v84, v84, vcc wave_shr:1 row_mask:0xf bank_mask:0xf
    v_cndmask_b32_dpp v85, v85, v85, vcc wave_shr:1 row_mask:0xf bank_mask:0xf
    s_lshr_b64 s[52:53], s[52:53], 1
    v_cndmask_b32_dpp v86, v86, v86, vcc wave_shr:1 row_mask:0xf bank_mask:0xf
    v_cndmask_b32_dpp v87, v87, v87, vcc wave_shr:1 row_mask:0xf bank_mask:0xf
    s_andn2_b64 s[82:83], s[82:83], s[52:53]
    v_cndmask_b32_dpp v7, v7, v7, vcc wave_shr:1 row_mask:0xf bank_mask:0xf
    s_mov_b64 exec, s[54:55]
    s_cbranch_scc0 L2_d62
    s_mov_b64 exec, s[82:83]
    s_nop 1
    v_mfma_f32_4x4x4_16b_bf16 v[88:91], v[12:13], v[84:85], 0
    s_nop 1
    v_mfma_f32_4x4x4_16b_bf16 v[88:91], v[10:11], v[86:87], v[88:91]
    s_nop 4
    v_cvt_pk_bf16_f32 v88, v88, v89
    v_cvt_pk_bf16_f32 v89, v90, v91
    ds_pk_add_bf16 v7, v88 offset:65408
    ds_pk_add_bf16 v7, v89 offset:65412
    s_mov_b64 exec, s[54:55]
    s_branch L2_d62
L2_c63:
    s_lshl_b64 s[52:53], s[82:83], 1
    s_andn2_b64 s[52:53], s[52:53], s[80:81]
    s_andn2_b64 s[52:53], s[52:53], s[50:51]
    s_or_b64 s[80:81], s[80:81], s[52:53]
    s_not_b64 vcc, s[52:53]
    s_mov_b64 exec, -1
    v_cndmask_b32_dpp v84, v84, v84, vcc wave_shr:1 row_mask:0xf bank_mask:0xf
    v_cndmask_b32_dpp v85, v85, v85, vcc wave_shr:1 row_mask:0xf bank_mask:0xf
    s_lshr_b64 s[52:53], s[52:53], 1
    v_cndmask_b32_dpp v86, v86, v86, vcc wave_shr:1 row_mask:0xf bank_mask:0xf
    v_cndmask_b32_dpp v87, v87, v87, vcc wave_shr:1 row_mask:0xf bank_mask:0xf
    s_andn2_b64 s[82:83], s[82:83], s[52:53]
    v_cndmask_b32_dpp v7, v7, v7, vcc wave_shr:1 row_mask:0xf bank_mask:0xf
    s_mov_b64 exec, s[50:51]
    s_cbranch_scc0 L2_d63
    s_mov_b64 exec, s[82:83]
    s_nop 1
    v_mfma_f32_4x4x4_16b_bf16 v[88:91], v[12:13], v[84:85], 0
    s_nop 1
    v_mfma_f32_4x4x4_16b_bf16 v[88:91], v[10:11], v[86:87], v[88:91]
    s_nop 4
    v_cvt_pk_bf16_f32 v88, v88, v89
    v_cvt_pk_bf16_f32 v89, v90, v91
    ds_pk_add_bf16 v7, v88 offset:65408
    ds_pk_add_bf16 v7, v89 offset:65412
    s_mov_b64 exec, s[50:51]
    s_branch L2_d63
L2_xf61:
    s_cmp_gt_u32 s37, 1024
    s_cbranch_scc1 L2_xt61
    s_cmp_lt_u32 s37, 768
    s_cbranch_scc1 L2_xl61
    ds_read_b32 v32, v44 offset:896
    s_add_u32 s3, s42, 2
    s_bitset1_b32 s43, s3
    s_branch L2_xg61
L2_xl61:
    s_waitcnt lgkmcnt(0)
    v_mov_b32 v31, -1
    s_cmp_ge_u32 s37, 512
    s_cbranch_scc1 L2_xg61
    v_mov_b32 v39, -1
    s_cmp_ge_u32 s37, 256
    s_cbranch_scc1 L2_xg61
    v_mov_b32 v27, -1
    s_branch L2_xg61
L2_xt61:
    s_waitcnt lgkmcnt(0)
    v_mov_b32 v21, -1
    v_mov_b32 v27, -1
    v_mov_b32 v39, -1
    v_mov_b32 v31, -1
    s_add_u32 s3, s42, 2
    s_bitset1_b32 s36, s3
    s_branch L2_xg61
L2_oa64:
    v_and_b32 v47, 0x0fffffff, v33
    buffer_load_dword v114, v47, s[8:11], 0 offen offset:16
    s_mov_b64 exec, s[6:7]
    v_add_u32 v47, 8, v47
    v_lshrrev_b32 v33, 2, v33
    s_mov_b64 exec, -1
    buffer_load_dwordx2 v[112:113], v47, s[8:11], 0 offen
    s_branch L2_ob64
L2_c65:
    s_lshl_b64 s[52:53], s[82:83], 1
    s_andn2_b64 s[52:53], s[52:53], s[80:81]
    s_andn2_b64 s[52:53], s[52:53], s[54:55]
    s_or_b64 s[80:81], s[80:81], s[52:53]
    s_not_b64 vcc, s[52:53]
    s_mov_b64 exec, -1
    v_cndmask_b32_dpp v84, v84, v84, vcc wave_shr:1 row_mask:0xf bank_mask:0xf
    v_cndmask_b32_dpp v85, v85, v85, vcc wave_shr:1 row_mask:0xf bank_mask:0xf
    s_lshr_b64 s[52:53], s[52:53], 1
    v_cndmask_b32_dpp v86, v86, v86, vcc wave_shr:1 row_mask:0xf bank_mask:0xf
    v_cndmask_b32_dpp v87, v87, v87, vcc wave_shr:1 row_mask:0xf bank_mask:0xf
    s_andn2_b64 s[82:83], s[82:83], s[52:53]
    v_cndmask_b32_dpp v7, v7, v7, vcc wave_shr:1 row_mask:0xf bank_mask:0xf
    s_mov_b64 exec, s[54:55]
    s_cbranch_scc0 L2_d65
    s_mov_b64 exec, s[82:83]
    s_nop 1
    v_mfma_f32_4x4x4_16b_bf16 v[88:91], v[12:13], v[84:85], 0
    s_nop 1
    v_mfma_f32_4x4x4_16b_bf16 v[88:91], v[10:11], v[86:87], v[88:91]
    s_nop 4
    v_cvt_pk_bf16_f32 v88, v88, v89
    v_cvt_pk_bf16_f32 v89, v90, v91
    ds_pk_add_bf16 v7, v88 offset:65408
    ds_pk_add_bf16 v7, v89 offset:65412
    s_mov_b64 exec, s[54:55]
    s_branch L2_d65
L2_c66:
    s_lshl_b64 s[52:53], s[82:83], 1
    s_andn2_b64 s[52:53], s[52:53], s[80:81]
    s_andn2_b64 s[52:53], s[52:53], s[50:51]
    s_or_b64 s[80:81], s[80:81], s[52:53]
    s_not_b64 vcc, s[52:53]
    s_mov_b64 exec, -1
    v_cndmask_b32_dpp v84, v84, v84, vcc wave_shr:1 row_mask:0xf bank_mask:0xf
    v_cndmask_b32_dpp v85, v85, v85, vcc wave_shr:1 row_mask:0xf bank_mask:0xf
    s_lshr_b64 s[52:53], s[52:53], 1
    v_cndmask_b32_dpp v86, v86, v86, vcc wave_shr:1 row_mask:0xf bank_mask:0xf
    v_cndmask_b32_dpp v87, v87, v87, vcc wave_shr:1 row_mask:0xf bank_mask:0xf
    s_andn2_b64 s[82:83], s[82:83], s[52:53]
    v_cndmask_b32_dpp v7, v7, v7, vcc wave_shr:1 row_mask:0xf bank_mask:0xf
    s_mov_b64 exec, s[50:51]
    s_cbranch_scc0 L2_d66
    s_mov_b64 exec, s[82:83]
    s_nop 1
    v_mfma_f32_4x4x4_16b_bf16 v[88:91], v[12:13], v[84:85], 0
    s_nop 1
    v_mfma_f32_4x4x4_16b_bf16 v[88:91], v[10:11], v[86:87], v[88:91]
    s_nop 4
    v_cvt_pk_bf16_f32 v88, v88, v89
    v_cvt_pk_bf16_f32 v89, v90, v91
    ds_pk_add_bf16 v7, v88 offset:65408
    ds_pk_add_bf16 v7, v89 offset:65412
    s_mov_b64 exec, s[50:51]
    s_branch L2_d66
L2_c67:
    s_lshl_b64 s[52:53], s[82:83], 1
    s_andn2_b64 s[52:53], s[52:53], s[80:81]
    s_andn2_b64 s[52:53], s[52:53], s[54:55]
    s_or_b64 s[80:81], s[80:81], s[52:53]
    s_not_b64 vcc, s[52:53]
    s_mov_b64 exec, -1
    v_cndmask_b32_dpp v84, v84, v84, vcc wave_shr:1 row_mask:0xf bank_mask:0xf
    v_cndmask_b32_dpp v85, v85, v85, vcc wave_shr:1 row_mask:0xf bank_mask:0xf
    s_lshr_b64 s[52:53], s[52:53], 1
    v_cndmask_b32_dpp v86, v86, v86, vcc wave_shr:1 row_mask:0xf bank_mask:0xf
    v_cndmask_b32_dpp v87, v87, v87, vcc wave_shr:1 row_mask:0xf bank_mask:0xf
    s_andn2_b64 s[82:83], s[82:83], s[52:53]
    v_cndmask_b32_dpp v7, v7, v7, vcc wave_shr:1 row_mask:0xf bank_mask:0xf
    s_mov_b64 exec, s[54:55]
    s_cbranch_scc0 L2_d67
    s_mov_b64 exec, s[82:83]
    s_nop 1
    v_mfma_f32_4x4x4_16b_bf16 v[88:91], v[12:13], v[84:85], 0
    s_nop 1
    v_mfma_f32_4x4x4_16b_bf16 v[88:91], v[10:11], v[86:87], v[88:91]
    s_nop 4
    v_cvt_pk_bf16_f32 v88, v88, v89
    v_cvt_pk_bf16_f32 v89, v90, v91
    ds_pk_add_bf16 v7, v88 offset:65408
    ds_pk_add_bf16 v7, v89 offset:65412
    s_mov_b64 exec, s[54:55]
    s_branch L2_d67
L2_c68:
    s_lshl_b64 s[52:53], s[82:83], 1
    s_andn2_b64 s[52:53], s[52:53], s[80:81]
    s_andn2_b64 s[52:53], s[52:53], s[50:51]
    s_or_b64 s[80:81], s[80:81], s[52:53]
    s_not_b64 vcc, s[52:53]
    s_mov_b64 exec, -1
    v_cndmask_b32_dpp v84, v84, v84, vcc wave_shr:1 row_mask:0xf bank_mask:0xf
    v_cndmask_b32_dpp v85, v85, v85, vcc wave_shr:1 row_mask:0xf bank_mask:0xf
    s_lshr_b64 s[52:53], s[52:53], 1
    v_cndmask_b32_dpp v86, v86, v86, vcc wave_shr:1 row_mask:0xf bank_mask:0xf
    v_cndmask_b32_dpp v87, v87, v87, vcc wave_shr:1 row_mask:0xf bank_mask:0xf
    s_andn2_b64 s[82:83], s[82:83], s[52:53]
    v_cndmask_b32_dpp v7, v7, v7, vcc wave_shr:1 row_mask:0xf bank_mask:0xf
    s_mov_b64 exec, s[50:51]
    s_cbranch_scc0 L2_d68
    s_mov_b64 exec, s[82:83]
    s_nop 1
    v_mfma_f32_4x4x4_16b_bf16 v[88:91], v[12:13], v[84:85], 0
    s_nop 1
    v_mfma_f32_4x4x4_16b_bf16 v[88:91], v[10:11], v[86:87], v[88:91]
    s_nop 4
    v_cvt_pk_bf16_f32 v88, v88, v89
    v_cvt_pk_bf16_f32 v89, v90, v91
    ds_pk_add_bf16 v7, v88 offset:65408
    ds_pk_add_bf16 v7, v89 offset:65412
    s_mov_b64 exec, s[50:51]
    s_branch L2_d68
L2_c69:
    s_lshl_b64 s[52:53], s[82:83], 1
    s_andn2_b64 s[52:53], s[52:53], s[80:81]
    s_andn2_b64 s[52:53], s[52:53], s[54:55]
    s_or_b64 s[80:81], s[80:81], s[52:53]
    s_not_b64 vcc, s[52:53]
    s_mov_b64 exec, -1
    v_cndmask_b32_dpp v84, v84, v84, vcc wave_shr:1 row_mask:0xf bank_mask:0xf
    v_cndmask_b32_dpp v85, v85, v85, vcc wave_shr:1 row_mask:0xf bank_mask:0xf
    s_lshr_b64 s[52:53], s[52:53], 1
    v_cndmask_b32_dpp v86, v86, v86, vcc wave_shr:1 row_mask:0xf bank_mask:0xf
    v_cndmask_b32_dpp v87, v87, v87, vcc wave_shr:1 row_mask:0xf bank_mask:0xf
    s_andn2_b64 s[82:83], s[82:83], s[52:53]
    v_cndmask_b32_dpp v7, v7, v7, vcc wave_shr:1 row_mask:0xf bank_mask:0xf
    s_mov_b64 exec, s[54:55]
    s_cbranch_scc0 L2_d69
    s_mov_b64 exec, s[82:83]
    s_nop 1
    v_mfma_f32_4x4x4_16b_bf16 v[88:91], v[12:13], v[84:85], 0
    s_nop 1
    v_mfma_f32_4x4x4_16b_bf16 v[88:91], v[10:11], v[86:87], v[88:91]
    s_nop 4
    v_cvt_pk_bf16_f32 v88, v88, v89
    v_cvt_pk_bf16_f32 v89, v90, v91
    ds_pk_add_bf16 v7, v88 offset:65408
    ds_pk_add_bf16 v7, v89 offset:65412
    s_mov_b64 exec, s[54:55]
    s_branch L2_d69
L2_c70:
    s_lshl_b64 s[52:53], s[82:83], 1
    s_andn2_b64 s[52:53], s[52:53], s[80:81]
    s_andn2_b64 s[52:53], s[52:53], s[50:51]
    s_or_b64 s[80:81], s[80:81], s[52:53]
    s_not_b64 vcc, s[52:53]
    s_mov_b64 exec, -1
    v_cndmask_b32_dpp v84, v84, v84, vcc wave_shr:1 row_mask:0xf bank_mask:0xf
    v_cndmask_b32_dpp v85, v85, v85, vcc wave_shr:1 row_mask:0xf bank_mask:0xf
    s_lshr_b64 s[52:53], s[52:53], 1
    v_cndmask_b32_dpp v86, v86, v86, vcc wave_shr:1 row_mask:0xf bank_mask:0xf
    v_cndmask_b32_dpp v87, v87, v87, vcc wave_shr:1 row_mask:0xf bank_mask:0xf
    s_andn2_b64 s[82:83], s[82:83], s[52:53]
    v_cndmask_b32_dpp v7, v7, v7, vcc wave_shr:1 row_mask:0xf bank_mask:0xf
    s_mov_b64 exec, s[50:51]
    s_cbranch_scc0 L2_d70
    s_mov_b64 exec, s[82:83]
    s_nop 1
    v_mfma_f32_4x4x4_16b_bf16 v[88:91], v[12:13], v[84:85], 0
    s_nop 1
    v_mfma_f32_4x4x4_16b_bf16 v[88:91], v[10:11], v[86:87], v[88:91]
    s_nop 4
    v_cvt_pk_bf16_f32 v88, v88, v89
    v_cvt_pk_bf16_f32 v89, v90, v91
    ds_pk_add_bf16 v7, v88 offset:65408
    ds_pk_add_bf16 v7, v89 offset:65412
    s_mov_b64 exec, s[50:51]
    s_branch L2_d70
L2_oa71:
    s_waitcnt vmcnt(3)
    s_mov_b64 exec, s[6:7]
    v_lshrrev_b32 v114, 16, v114
    s_mov_b64 exec, -1
    v_and_b32 v46, 0x10000000, v33
    v_cmpx_eq_u32 vcc, 0, v46
    v_lshrrev_b32 v47, 14, v112
    v_and_b32 v47, v5, v47
    ds_read_b64 v[96:97], v47
    v_perm_b32 v98, v112, v114, s44
    v_bitop3_b32 v99, v112, 0.5, -0.5 bitop3:0xa8
    v_bitop3_b32 v98, v6, v98, v99 bitop3:0xca
    v_and_b32 v47, v5, v112
    s_waitcnt lgkmcnt(0)
    v_mfma_f32_4x4x4_16b_bf16 v[88:91], v[8:9], v[96:97], 0
    s_nop 4
    v_mul_f32 v88, v98, v88
    v_mul_f32 v89, v98, v89
    v_mul_f32 v90, v98, v90
    v_mul_f32 v91, v98, v91
    v_cvt_pk_bf16_f32 v88, v88, v89
    v_cvt_pk_bf16_f32 v89, v90, v91
    ds_pk_add_bf16 v47, v88 offset:65408
    ds_pk_add_bf16 v47, v89 offset:65412
    s_mov_b64 exec, -1
    v_and_b32 v46, 0x20000000, v33
    v_cmpx_eq_u32 vcc, 0, v46
    v_lshrrev_b32 v47, 14, v113
    v_and_b32 v47, v5, v47
    ds_read_b64 v[96:97], v47
    v_perm_b32 v98, v113, v114, s45
    v_bitop3_b32 v99, v113, 0.5, -0.5 bitop3:0xa8
    v_bitop3_b32 v98, v6, v98, v99 bitop3:0xca
    v_and_b32 v47, v5, v113
    s_waitcnt lgkmcnt(0)
    v_mfma_f32_4x4x4_16b_bf16 v[88:91], v[8:9], v[96:97], 0
    s_nop 4
    v_mul_f32 v88, v98, v88
    v_mul_f32 v89, v98, v89
    v_mul_f32 v90, v98, v90
    v_mul_f32 v91, v98, v91
    v_cvt_pk_bf16_f32 v88, v88, v89
    v_cvt_pk_bf16_f32 v89, v90, v91
    ds_pk_add_bf16 v47, v88 offset:65408
    ds_pk_add_bf16 v47, v89 offset:65412
    s_mov_b64 exec, -1
    s_branch L2_ob71
L2_xo72:
    v_cmp_lt_u32 vcc, 20, v99
    s_mov_b32 s101, 1
    s_cbranch_vccz L2_xp72
    v_cmp_lt_u32 vcc, 32, v99
    v_cmp_lt_u32 s[58:59], 31, v88
    s_mov_b32 s101, 2
    s_or_b64 vcc, vcc, s[58:59]
    s_cbranch_scc0 L2_xp72
    s_mov_b32 s37, 0x10000
    s_branch L2_xp72
L2_c73:
    s_lshl_b64 s[52:53], s[82:83], 1
    s_andn2_b64 s[52:53], s[52:53], s[80:81]
    s_andn2_b64 s[52:53], s[52:53], s[54:55]
    s_or_b64 s[80:81], s[80:81], s[52:53]
    s_not_b64 vcc, s[52:53]
    s_mov_b64 exec, -1
    v_cndmask_b32_dpp v84, v84, v84, vcc wave_shr:1 row_mask:0xf bank_mask:0xf
    v_cndmask_b32_dpp v85, v85, v85, vcc wave_shr:1 row_mask:0xf bank_mask:0xf
    s_lshr_b64 s[52:53], s[52:53], 1
    v_cndmask_b32_dpp v86, v86, v86, vcc wave_shr:1 row_mask:0xf bank_mask:0xf
    v_cndmask_b32_dpp v87, v87, v87, vcc wave_shr:1 row_mask:0xf bank_mask:0xf
    s_andn2_b64 s[82:83], s[82:83], s[52:53]
    v_cndmask_b32_dpp v7, v7, v7, vcc wave_shr:1 row_mask:0xf bank_mask:0xf
    s_mov_b64 exec, s[54:55]
    s_cbranch_scc0 L2_d73
    s_mov_b64 exec, s[82:83]
    s_nop 1
    v_mfma_f32_4x4x4_16b_bf16 v[88:91], v[12:13], v[84:85], 0
    s_nop 1
    v_mfma_f32_4x4x4_16b_bf16 v[88:91], v[10:11], v[86:87], v[88:91]
    s_nop 4
    v_cvt_pk_bf16_f32 v88, v88, v89
    v_cvt_pk_bf16_f32 v89, v90, v91
    ds_pk_add_bf16 v7, v88 offset:65408
    ds_pk_add_bf16 v7, v89 offset:65412
    s_mov_b64 exec, s[54:55]
    s_branch L2_d73
L2_c74:
    s_lshl_b64 s[52:53], s[82:83], 1
    s_andn2_b64 s[52:53], s[52:53], s[80:81]
    s_andn2_b64 s[52:53], s[52:53], s[50:51]
    s_or_b64 s[80:81], s[80:81], s[52:53]
    s_not_b64 vcc, s[52:53]
    s_mov_b64 exec, -1
    v_cndmask_b32_dpp v84, v84, v84, vcc wave_shr:1 row_mask:0xf bank_mask:0xf
    v_cndmask_b32_dpp v85, v85, v85, vcc wave_shr:1 row_mask:0xf bank_mask:0xf
    s_lshr_b64 s[52:53], s[52:53], 1
    v_cndmask_b32_dpp v86, v86, v86, vcc wave_shr:1 row_mask:0xf bank_mask:0xf
    v_cndmask_b32_dpp v87, v87, v87, vcc wave_shr:1 row_mask:0xf bank_mask:0xf
    s_andn2_b64 s[82:83], s[82:83], s[52:53]
    v_cndmask_b32_dpp v7, v7, v7, vcc wave_shr:1 row_mask:0xf bank_mask:0xf
    s_mov_b64 exec, s[50:51]
    s_cbranch_scc0 L2_d74
    s_mov_b64 exec, s[82:83]
    s_nop 1
    v_mfma_f32_4x4x4_16b_bf16 v[88:91], v[12:13], v[84:85], 0
    s_nop 1
    v_mfma_f32_4x4x4_16b_bf16 v[88:91], v[10:11], v[86:87], v[88:91]
    s_nop 4
    v_cvt_pk_bf16_f32 v88, v88, v89
    v_cvt_pk_bf16_f32 v89, v90, v91
    ds_pk_add_bf16 v7, v88 offset:65408
    ds_pk_add_bf16 v7, v89 offset:65412
    s_mov_b64 exec, s[50:51]
    s_branch L2_d74
L2_c75:
    s_lshl_b64 s[52:53], s[82:83], 1
    s_andn2_b64 s[52:53], s[52:53], s[80:81]
    s_andn2_b64 s[52:53], s[52:53], s[54:55]
    s_or_b64 s[80:81], s[80:81], s[52:53]
    s_not_b64 vcc, s[52:53]
    s_mov_b64 exec, -1
    v_cndmask_b32_dpp v84, v84, v84, vcc wave_shr:1 row_mask:0xf bank_mask:0xf
    v_cndmask_b32_dpp v85, v85, v85, vcc wave_shr:1 row_mask:0xf bank_mask:0xf
    s_lshr_b64 s[52:53], s[52:53], 1
    v_cndmask_b32_dpp v86, v86, v86, vcc wave_shr:1 row_mask:0xf bank_mask:0xf
    v_cndmask_b32_dpp v87, v87, v87, vcc wave_shr:1 row_mask:0xf bank_mask:0xf
    s_andn2_b64 s[82:83], s[82:83], s[52:53]
    v_cndmask_b32_dpp v7, v7, v7, vcc wave_shr:1 row_mask:0xf bank_mask:0xf
    s_mov_b64 exec, s[54:55]
    s_cbranch_scc0 L2_d75
    s_mov_b64 exec, s[82:83]
    s_nop 1
    v_mfma_f32_4x4x4_16b_bf16 v[88:91], v[12:13], v[84:85], 0
    s_nop 1
    v_mfma_f32_4x4x4_16b_bf16 v[88:91], v[10:11], v[86:87], v[88:91]
    s_nop 4
    v_cvt_pk_bf16_f32 v88, v88, v89
    v_cvt_pk_bf16_f32 v89, v90, v91
    ds_pk_add_bf16 v7, v88 offset:65408
    ds_pk_add_bf16 v7, v89 offset:65412
    s_mov_b64 exec, s[54:55]
    s_branch L2_d75
L2_c76:
    s_lshl_b64 s[52:53], s[82:83], 1
    s_andn2_b64 s[52:53], s[52:53], s[80:81]
    s_andn2_b64 s[52:53], s[52:53], s[50:51]
    s_or_b64 s[80:81], s[80:81], s[52:53]
    s_not_b64 vcc, s[52:53]
    s_mov_b64 exec, -1
    v_cndmask_b32_dpp v84, v84, v84, vcc wave_shr:1 row_mask:0xf bank_mask:0xf
    v_cndmask_b32_dpp v85, v85, v85, vcc wave_shr:1 row_mask:0xf bank_mask:0xf
    s_lshr_b64 s[52:53], s[52:53], 1
    v_cndmask_b32_dpp v86, v86, v86, vcc wave_shr:1 row_mask:0xf bank_mask:0xf
    v_cndmask_b32_dpp v87, v87, v87, vcc wave_shr:1 row_mask:0xf bank_mask:0xf
    s_andn2_b64 s[82:83], s[82:83], s[52:53]
    v_cndmask_b32_dpp v7, v7, v7, vcc wave_shr:1 row_mask:0xf bank_mask:0xf
    s_mov_b64 exec, s[50:51]
    s_cbranch_scc0 L2_d76
    s_mov_b64 exec, s[82:83]
    s_nop 1
    v_mfma_f32_4x4x4_16b_bf16 v[88:91], v[12:13], v[84:85], 0
    s_nop 1
    v_mfma_f32_4x4x4_16b_bf16 v[88:91], v[10:11], v[86:87], v[88:91]
    s_nop 4
    v_cvt_pk_bf16_f32 v88, v88, v89
    v_cvt_pk_bf16_f32 v89, v90, v91
    ds_pk_add_bf16 v7, v88 offset:65408
    ds_pk_add_bf16 v7, v89 offset:65412
    s_mov_b64 exec, s[50:51]
    s_branch L2_d76
L2_c77:
    s_lshl_b64 s[52:53], s[82:83], 1
    s_andn2_b64 s[52:53], s[52:53], s[80:81]
    s_andn2_b64 s[52:53], s[52:53], s[54:55]
    s_or_b64 s[80:81], s[80:81], s[52:53]
    s_not_b64 vcc, s[52:53]
    s_mov_b64 exec, -1
    v_cndmask_b32_dpp v84, v84, v84, vcc wave_shr:1 row_mask:0xf bank_mask:0xf
    v_cndmask_b32_dpp v85, v85, v85, vcc wave_shr:1 row_mask:0xf bank_mask:0xf
    s_lshr_b64 s[52:53], s[52:53], 1
    v_cndmask_b32_dpp v86, v86, v86, vcc wave_shr:1 row_mask:0xf bank_mask:0xf
    v_cndmask_b32_dpp v87, v87, v87, vcc wave_shr:1 row_mask:0xf bank_mask:0xf
    s_andn2_b64 s[82:83], s[82:83], s[52:53]
    v_cndmask_b32_dpp v7, v7, v7, vcc wave_shr:1 row_mask:0xf bank_mask:0xf
    s_mov_b64 exec, s[54:55]
    s_cbranch_scc0 L2_d77
    s_mov_b64 exec, s[82:83]
    s_nop 1
    v_mfma_f32_4x4x4_16b_bf16 v[88:91], v[12:13], v[84:85], 0
    s_nop 1
    v_mfma_f32_4x4x4_16b_bf16 v[88:91], v[10:11], v[86:87], v[88:91]
    s_nop 4
    v_cvt_pk_bf16_f32 v88, v88, v89
    v_cvt_pk_bf16_f32 v89, v90, v91
    ds_pk_add_bf16 v7, v88 offset:65408
    ds_pk_add_bf16 v7, v89 offset:65412
    s_mov_b64 exec, s[54:55]
    s_branch L2_d77
L2_c78:
    s_lshl_b64 s[52:53], s[82:83], 1
    s_andn2_b64 s[52:53], s[52:53], s[80:81]
    s_andn2_b64 s[52:53], s[52:53], s[50:51]
    s_or_b64 s[80:81], s[80:81], s[52:53]
    s_not_b64 vcc, s[52:53]
    s_mov_b64 exec, -1
    v_cndmask_b32_dpp v84, v84, v84, vcc wave_shr:1 row_mask:0xf bank_mask:0xf
    v_cndmask_b32_dpp v85, v85, v85, vcc wave_shr:1 row_mask:0xf bank_mask:0xf
    s_lshr_b64 s[52:53], s[52:53], 1
    v_cndmask_b32_dpp v86, v86, v86, vcc wave_shr:1 row_mask:0xf bank_mask:0xf
    v_cndmask_b32_dpp v87, v87, v87, vcc wave_shr:1 row_mask:0xf bank_mask:0xf
    s_andn2_b64 s[82:83], s[82:83], s[52:53]
    v_cndmask_b32_dpp v7, v7, v7, vcc wave_shr:1 row_mask:0xf bank_mask:0xf
    s_mov_b64 exec, s[50:51]
    s_cbranch_scc0 L2_d78
    s_mov_b64 exec, s[82:83]
    s_nop 1
    v_mfma_f32_4x4x4_16b_bf16 v[88:91], v[12:13], v[84:85], 0
    s_nop 1
    v_mfma_f32_4x4x4_16b_bf16 v[88:91], v[10:11], v[86:87], v[88:91]
    s_nop 4
    v_cvt_pk_bf16_f32 v88, v88, v89
    v_cvt_pk_bf16_f32 v89, v90, v91
    ds_pk_add_bf16 v7, v88 offset:65408
    ds_pk_add_bf16 v7, v89 offset:65412
    s_mov_b64 exec, s[50:51]
    s_branch L2_d78
L2_xa79:
    s_cmp_eq_u32 s101, 1
    s_cbranch_scc1 L2_xc79
    v_lshlrev_b32 v89, 0, v96
    v_add_u32 v90, 140, v97
    v_bitop3_b32 v90, v89, v45, v90 bitop3:0x6a
    ds_write_b32 v98, v90 offset:28
    v_lshlrev_b32 v89, 4, v96
    v_add_u32 v90, 120, v97
    v_bitop3_b32 v90, v89, v45, v90 bitop3:0x6a
    ds_write_b32 v98, v90 offset:24
    v_lshlrev_b32 v89, 8, v96
    v_add_u32 v90, 100, v97
    v_bitop3_b32 v90, v89, v45, v90 bitop3:0x6a
    ds_write_b32 v98, v90 offset:20
L2_xc79:
    v_lshlrev_b32 v89, 12, v96
    v_add_u32 v90, 80, v97
    v_bitop3_b32 v90, v89, v45, v90 bitop3:0x6a
    ds_write_b32 v98, v90 offset:16
    s_branch L2_xb79
L2_xe79:
    v_cmp_lt_u32 vcc, 32, v99
    v_cmp_lt_u32 s[58:59], 31, v88
    v_lshrrev_b32 v89, 16, v96
    v_add_u32 v97, 80, v97
    s_or_b64 vcc, vcc, s[58:59]
    s_cbranch_scc1 L2_xs79
    v_lshlrev_b32 v89, v1, v89
    v_and_b32 v89, v45, v89
    v_cmp_ne_u32 vcc, 0, v89
    v_xor_b32 v90, v97, v89
    s_add_u32 s3, s37, s38
    v_mbcnt_lo_u32_b32 v98, vcc_lo, 0
    v_mbcnt_hi_u32_b32 v98, vcc_hi, v98
    s_bcnt1_i32_b64 s41, vcc
    v_lshl_add_u32 v98, v98, 2, s3
    s_lshl2_add_u32 s37, s41, s37
    s_mov_b64 exec, vcc
    ds_write_b32 v98, v90
    s_mov_b64 exec, -1
    s_branch L2_xr79
L2_xs79:
    s_waitcnt lgkmcnt(0)
    s_mov_b32 s37, 0x10000
    s_branch L2_xw79
L2_c80:
    s_lshl_b64 s[52:53], s[82:83], 1
    s_andn2_b64 s[52:53], s[52:53], s[80:81]
    s_andn2_b64 s[52:53], s[52:53], s[54:55]
    s_or_b64 s[80:81], s[80:81], s[52:53]
    s_not_b64 vcc, s[52:53]
    s_mov_b64 exec, -1
    v_cndmask_b32_dpp v84, v84, v84, vcc wave_shr:1 row_mask:0xf bank_mask:0xf
    v_cndmask_b32_dpp v85, v85, v85, vcc wave_shr:1 row_mask:0xf bank_mask:0xf
    s_lshr_b64 s[52:53], s[52:53], 1
    v_cndmask_b32_dpp v86, v86, v86, vcc wave_shr:1 row_mask:0xf bank_mask:0xf
    v_cndmask_b32_dpp v87, v87, v87, vcc wave_shr:1 row_mask:0xf bank_mask:0xf
    s_andn2_b64 s[82:83], s[82:83], s[52:53]
    v_cndmask_b32_dpp v7, v7, v7, vcc wave_shr:1 row_mask:0xf bank_mask:0xf
    s_mov_b64 exec, s[54:55]
    s_cbranch_scc0 L2_d80
    s_mov_b64 exec, s[82:83]
    s_nop 1
    v_mfma_f32_4x4x4_16b_bf16 v[88:91], v[12:13], v[84:85], 0
    s_nop 1
    v_mfma_f32_4x4x4_16b_bf16 v[88:91], v[10:11], v[86:87], v[88:91]
    s_nop 4
    v_cvt_pk_bf16_f32 v88, v88, v89
    v_cvt_pk_bf16_f32 v89, v90, v91
    ds_pk_add_bf16 v7, v88 offset:65408
    ds_pk_add_bf16 v7, v89 offset:65412
    s_mov_b64 exec, s[54:55]
    s_branch L2_d80
L2_c81:
    s_lshl_b64 s[52:53], s[82:83], 1
    s_andn2_b64 s[52:53], s[52:53], s[80:81]
    s_andn2_b64 s[52:53], s[52:53], s[50:51]
    s_or_b64 s[80:81], s[80:81], s[52:53]
    s_not_b64 vcc, s[52:53]
    s_mov_b64 exec, -1
    v_cndmask_b32_dpp v84, v84, v84, vcc wave_shr:1 row_mask:0xf bank_mask:0xf
    v_cndmask_b32_dpp v85, v85, v85, vcc wave_shr:1 row_mask:0xf bank_mask:0xf
    s_lshr_b64 s[52:53], s[52:53], 1
    v_cndmask_b32_dpp v86, v86, v86, vcc wave_shr:1 row_mask:0xf bank_mask:0xf
    v_cndmask_b32_dpp v87, v87, v87, vcc wave_shr:1 row_mask:0xf bank_mask:0xf
    s_andn2_b64 s[82:83], s[82:83], s[52:53]
    v_cndmask_b32_dpp v7, v7, v7, vcc wave_shr:1 row_mask:0xf bank_mask:0xf
    s_mov_b64 exec, s[50:51]
    s_cbranch_scc0 L2_d81
    s_mov_b64 exec, s[82:83]
    s_nop 1
    v_mfma_f32_4x4x4_16b_bf16 v[88:91], v[12:13], v[84:85], 0
    s_nop 1
    v_mfma_f32_4x4x4_16b_bf16 v[88:91], v[10:11], v[86:87], v[88:91]
    s_nop 4
    v_cvt_pk_bf16_f32 v88, v88, v89
    v_cvt_pk_bf16_f32 v89, v90, v91
    ds_pk_add_bf16 v7, v88 offset:65408
    ds_pk_add_bf16 v7, v89 offset:65412
    s_mov_b64 exec, s[50:51]
    s_branch L2_d81
L2_xf79:
    s_cmp_gt_u32 s37, 1024
    s_cbranch_scc1 L2_xt79
    s_cmp_lt_u32 s37, 768
    s_cbranch_scc1 L2_xl79
    ds_read_b32 v33, v44 offset:896
    s_add_u32 s3, s42, 2
    s_bitset1_b32 s43, s3
    s_branch L2_xg79
L2_xl79:
    s_waitcnt lgkmcnt(0)
    v_mov_b32 v42, -1
    s_cmp_ge_u32 s37, 512
    s_cbranch_scc1 L2_xg79
    v_mov_b32 v43, -1
    s_cmp_ge_u32 s37, 256
    s_cbranch_scc1 L2_xg79
    v_mov_b32 v41, -1
    s_branch L2_xg79
L2_xt79:
    s_waitcnt lgkmcnt(0)
    v_mov_b32 v40, -1
    v_mov_b32 v41, -1
    v_mov_b32 v43, -1
    v_mov_b32 v42, -1
    s_add_u32 s3, s42, 2
    s_bitset1_b32 s36, s3
    s_branch L2_xg79
L2_oa82:
    v_and_b32 v47, 0x0fffffff, v32
    buffer_load_dword v114, v47, s[8:11], 0 offen offset:16
    s_mov_b64 exec, s[6:7]
    v_add_u32 v47, 8, v47
    v_lshrrev_b32 v32, 2, v32
    s_mov_b64 exec, -1
    buffer_load_dwordx2 v[112:113], v47, s[8:11], 0 offen
    s_branch L2_ob82
L2_c83:
    s_lshl_b64 s[52:53], s[82:83], 1
    s_andn2_b64 s[52:53], s[52:53], s[80:81]
    s_andn2_b64 s[52:53], s[52:53], s[54:55]
    s_or_b64 s[80:81], s[80:81], s[52:53]
    s_not_b64 vcc, s[52:53]
    s_mov_b64 exec, -1
    v_cndmask_b32_dpp v84, v84, v84, vcc wave_shr:1 row_mask:0xf bank_mask:0xf
    v_cndmask_b32_dpp v85, v85, v85, vcc wave_shr:1 row_mask:0xf bank_mask:0xf
    s_lshr_b64 s[52:53], s[52:53], 1
    v_cndmask_b32_dpp v86, v86, v86, vcc wave_shr:1 row_mask:0xf bank_mask:0xf
    v_cndmask_b32_dpp v87, v87, v87, vcc wave_shr:1 row_mask:0xf bank_mask:0xf
    s_andn2_b64 s[82:83], s[82:83], s[52:53]
    v_cndmask_b32_dpp v7, v7, v7, vcc wave_shr:1 row_mask:0xf bank_mask:0xf
    s_mov_b64 exec, s[54:55]
    s_cbranch_scc0 L2_d83
    s_mov_b64 exec, s[82:83]
    s_nop 1
    v_mfma_f32_4x4x4_16b_bf16 v[88:91], v[12:13], v[84:85], 0
    s_nop 1
    v_mfma_f32_4x4x4_16b_bf16 v[88:91], v[10:11], v[86:87], v[88:91]
    s_nop 4
    v_cvt_pk_bf16_f32 v88, v88, v89
    v_cvt_pk_bf16_f32 v89, v90, v91
    ds_pk_add_bf16 v7, v88 offset:65408
    ds_pk_add_bf16 v7, v89 offset:65412
    s_mov_b64 exec, s[54:55]
    s_branch L2_d83
L2_c84:
    s_lshl_b64 s[52:53], s[82:83], 1
    s_andn2_b64 s[52:53], s[52:53], s[80:81]
    s_andn2_b64 s[52:53], s[52:53], s[50:51]
    s_or_b64 s[80:81], s[80:81], s[52:53]
    s_not_b64 vcc, s[52:53]
    s_mov_b64 exec, -1
    v_cndmask_b32_dpp v84, v84, v84, vcc wave_shr:1 row_mask:0xf bank_mask:0xf
    v_cndmask_b32_dpp v85, v85, v85, vcc wave_shr:1 row_mask:0xf bank_mask:0xf
    s_lshr_b64 s[52:53], s[52:53], 1
    v_cndmask_b32_dpp v86, v86, v86, vcc wave_shr:1 row_mask:0xf bank_mask:0xf
    v_cndmask_b32_dpp v87, v87, v87, vcc wave_shr:1 row_mask:0xf bank_mask:0xf
    s_andn2_b64 s[82:83], s[82:83], s[52:53]
    v_cndmask_b32_dpp v7, v7, v7, vcc wave_shr:1 row_mask:0xf bank_mask:0xf
    s_mov_b64 exec, s[50:51]
    s_cbranch_scc0 L2_d84
    s_mov_b64 exec, s[82:83]
    s_nop 1
    v_mfma_f32_4x4x4_16b_bf16 v[88:91], v[12:13], v[84:85], 0
    s_nop 1
    v_mfma_f32_4x4x4_16b_bf16 v[88:91], v[10:11], v[86:87], v[88:91]
    s_nop 4
    v_cvt_pk_bf16_f32 v88, v88, v89
    v_cvt_pk_bf16_f32 v89, v90, v91
    ds_pk_add_bf16 v7, v88 offset:65408
    ds_pk_add_bf16 v7, v89 offset:65412
    s_mov_b64 exec, s[50:51]
    s_branch L2_d84
L2_c85:
    s_lshl_b64 s[52:53], s[82:83], 1
    s_andn2_b64 s[52:53], s[52:53], s[80:81]
    s_andn2_b64 s[52:53], s[52:53], s[54:55]
    s_or_b64 s[80:81], s[80:81], s[52:53]
    s_not_b64 vcc, s[52:53]
    s_mov_b64 exec, -1
    v_cndmask_b32_dpp v84, v84, v84, vcc wave_shr:1 row_mask:0xf bank_mask:0xf
    v_cndmask_b32_dpp v85, v85, v85, vcc wave_shr:1 row_mask:0xf bank_mask:0xf
    s_lshr_b64 s[52:53], s[52:53], 1
    v_cndmask_b32_dpp v86, v86, v86, vcc wave_shr:1 row_mask:0xf bank_mask:0xf
    v_cndmask_b32_dpp v87, v87, v87, vcc wave_shr:1 row_mask:0xf bank_mask:0xf
    s_andn2_b64 s[82:83], s[82:83], s[52:53]
    v_cndmask_b32_dpp v7, v7, v7, vcc wave_shr:1 row_mask:0xf bank_mask:0xf
    s_mov_b64 exec, s[54:55]
    s_cbranch_scc0 L2_d85
    s_mov_b64 exec, s[82:83]
    s_nop 1
    v_mfma_f32_4x4x4_16b_bf16 v[88:91], v[12:13], v[84:85], 0
    s_nop 1
    v_mfma_f32_4x4x4_16b_bf16 v[88:91], v[10:11], v[86:87], v[88:91]
    s_nop 4
    v_cvt_pk_bf16_f32 v88, v88, v89
    v_cvt_pk_bf16_f32 v89, v90, v91
    ds_pk_add_bf16 v7, v88 offset:65408
    ds_pk_add_bf16 v7, v89 offset:65412
    s_mov_b64 exec, s[54:55]
    s_branch L2_d85
L2_c86:
    s_lshl_b64 s[52:53], s[82:83], 1
    s_andn2_b64 s[52:53], s[52:53], s[80:81]
    s_andn2_b64 s[52:53], s[52:53], s[50:51]
    s_or_b64 s[80:81], s[80:81], s[52:53]
    s_not_b64 vcc, s[52:53]
    s_mov_b64 exec, -1
    v_cndmask_b32_dpp v84, v84, v84, vcc wave_shr:1 row_mask:0xf bank_mask:0xf
    v_cndmask_b32_dpp v85, v85, v85, vcc wave_shr:1 row_mask:0xf bank_mask:0xf
    s_lshr_b64 s[52:53], s[52:53], 1
    v_cndmask_b32_dpp v86, v86, v86, vcc wave_shr:1 row_mask:0xf bank_mask:0xf
    v_cndmask_b32_dpp v87, v87, v87, vcc wave_shr:1 row_mask:0xf bank_mask:0xf
    s_andn2_b64 s[82:83], s[82:83], s[52:53]
    v_cndmask_b32_dpp v7, v7, v7, vcc wave_shr:1 row_mask:0xf bank_mask:0xf
    s_mov_b64 exec, s[50:51]
    s_cbranch_scc0 L2_d86
    s_mov_b64 exec, s[82:83]
    s_nop 1
    v_mfma_f32_4x4x4_16b_bf16 v[88:91], v[12:13], v[84:85], 0
    s_nop 1
    v_mfma_f32_4x4x4_16b_bf16 v[88:91], v[10:11], v[86:87], v[88:91]
    s_nop 4
    v_cvt_pk_bf16_f32 v88, v88, v89
    v_cvt_pk_bf16_f32 v89, v90, v91
    ds_pk_add_bf16 v7, v88 offset:65408
    ds_pk_add_bf16 v7, v89 offset:65412
    s_mov_b64 exec, s[50:51]
    s_branch L2_d86
L2_c87:
    s_lshl_b64 s[52:53], s[82:83], 1
    s_andn2_b64 s[52:53], s[52:53], s[80:81]
    s_andn2_b64 s[52:53], s[52:53], s[54:55]
    s_or_b64 s[80:81], s[80:81], s[52:53]
    s_not_b64 vcc, s[52:53]
    s_mov_b64 exec, -1
    v_cndmask_b32_dpp v84, v84, v84, vcc wave_shr:1 row_mask:0xf bank_mask:0xf
    v_cndmask_b32_dpp v85, v85, v85, vcc wave_shr:1 row_mask:0xf bank_mask:0xf
    s_lshr_b64 s[52:53], s[52:53], 1
    v_cndmask_b32_dpp v86, v86, v86, vcc wave_shr:1 row_mask:0xf bank_mask:0xf
    v_cndmask_b32_dpp v87, v87, v87, vcc wave_shr:1 row_mask:0xf bank_mask:0xf
    s_andn2_b64 s[82:83], s[82:83], s[52:53]
    v_cndmask_b32_dpp v7, v7, v7, vcc wave_shr:1 row_mask:0xf bank_mask:0xf
    s_mov_b64 exec, s[54:55]
    s_cbranch_scc0 L2_d87
    s_mov_b64 exec, s[82:83]
    s_nop 1
    v_mfma_f32_4x4x4_16b_bf16 v[88:91], v[12:13], v[84:85], 0
    s_nop 1
    v_mfma_f32_4x4x4_16b_bf16 v[88:91], v[10:11], v[86:87], v[88:91]
    s_nop 4
    v_cvt_pk_bf16_f32 v88, v88, v89
    v_cvt_pk_bf16_f32 v89, v90, v91
    ds_pk_add_bf16 v7, v88 offset:65408
    ds_pk_add_bf16 v7, v89 offset:65412
    s_mov_b64 exec, s[54:55]
    s_branch L2_d87
L2_c88:
    s_lshl_b64 s[52:53], s[82:83], 1
    s_andn2_b64 s[52:53], s[52:53], s[80:81]
    s_andn2_b64 s[52:53], s[52:53], s[50:51]
    s_or_b64 s[80:81], s[80:81], s[52:53]
    s_not_b64 vcc, s[52:53]
    s_mov_b64 exec, -1
    v_cndmask_b32_dpp v84, v84, v84, vcc wave_shr:1 row_mask:0xf bank_mask:0xf
    v_cndmask_b32_dpp v85, v85, v85, vcc wave_shr:1 row_mask:0xf bank_mask:0xf
    s_lshr_b64 s[52:53], s[52:53], 1
    v_cndmask_b32_dpp v86, v86, v86, vcc wave_shr:1 row_mask:0xf bank_mask:0xf
    v_cndmask_b32_dpp v87, v87, v87, vcc wave_shr:1 row_mask:0xf bank_mask:0xf
    s_andn2_b64 s[82:83], s[82:83], s[52:53]
    v_cndmask_b32_dpp v7, v7, v7, vcc wave_shr:1 row_mask:0xf bank_mask:0xf
    s_mov_b64 exec, s[50:51]
    s_cbranch_scc0 L2_d88
    s_mov_b64 exec, s[82:83]
    s_nop 1
    v_mfma_f32_4x4x4_16b_bf16 v[88:91], v[12:13], v[84:85], 0
    s_nop 1
    v_mfma_f32_4x4x4_16b_bf16 v[88:91], v[10:11], v[86:87], v[88:91]
    s_nop 4
    v_cvt_pk_bf16_f32 v88, v88, v89
    v_cvt_pk_bf16_f32 v89, v90, v91
    ds_pk_add_bf16 v7, v88 offset:65408
    ds_pk_add_bf16 v7, v89 offset:65412
    s_mov_b64 exec, s[50:51]
    s_branch L2_d88
L2_oa89:
    s_waitcnt vmcnt(3)
    s_mov_b64 exec, s[6:7]
    v_lshrrev_b32 v114, 16, v114
    s_mov_b64 exec, -1
    v_and_b32 v46, 0x10000000, v32
    v_cmpx_eq_u32 vcc, 0, v46
    v_lshrrev_b32 v47, 14, v112
    v_and_b32 v47, v5, v47
    ds_read_b64 v[96:97], v47
    v_perm_b32 v98, v112, v114, s44
    v_bitop3_b32 v99, v112, 0.5, -0.5 bitop3:0xa8
    v_bitop3_b32 v98, v6, v98, v99 bitop3:0xca
    v_and_b32 v47, v5, v112
    s_waitcnt lgkmcnt(0)
    v_mfma_f32_4x4x4_16b_bf16 v[88:91], v[8:9], v[96:97], 0
    s_nop 4
    v_mul_f32 v88, v98, v88
    v_mul_f32 v89, v98, v89
    v_mul_f32 v90, v98, v90
    v_mul_f32 v91, v98, v91
    v_cvt_pk_bf16_f32 v88, v88, v89
    v_cvt_pk_bf16_f32 v89, v90, v91
    ds_pk_add_bf16 v47, v88 offset:65408
    ds_pk_add_bf16 v47, v89 offset:65412
    s_mov_b64 exec, -1
    v_and_b32 v46, 0x20000000, v32
    v_cmpx_eq_u32 vcc, 0, v46
    v_lshrrev_b32 v47, 14, v113
    v_and_b32 v47, v5, v47
    ds_read_b64 v[96:97], v47
    v_perm_b32 v98, v113, v114, s45
    v_bitop3_b32 v99, v113, 0.5, -0.5 bitop3:0xa8
    v_bitop3_b32 v98, v6, v98, v99 bitop3:0xca
    v_and_b32 v47, v5, v113
    s_waitcnt lgkmcnt(0)
    v_mfma_f32_4x4x4_16b_bf16 v[88:91], v[8:9], v[96:97], 0
    s_nop 4
    v_mul_f32 v88, v98, v88
    v_mul_f32 v89, v98, v89
    v_mul_f32 v90, v98, v90
    v_mul_f32 v91, v98, v91
    v_cvt_pk_bf16_f32 v88, v88, v89
    v_cvt_pk_bf16_f32 v89, v90, v91
    ds_pk_add_bf16 v47, v88 offset:65408
    ds_pk_add_bf16 v47, v89 offset:65412
    s_mov_b64 exec, -1
    s_branch L2_ob89
L2_xo90:
    v_cmp_lt_u32 vcc, 20, v99
    s_mov_b32 s101, 1
    s_cbranch_vccz L2_xp90
    v_cmp_lt_u32 vcc, 32, v99
    v_cmp_lt_u32 s[58:59], 31, v88
    s_mov_b32 s101, 2
    s_or_b64 vcc, vcc, s[58:59]
    s_cbranch_scc0 L2_xp90
    s_mov_b32 s37, 0x10000
    s_branch L2_xp90
L2_c91:
    s_lshl_b64 s[52:53], s[82:83], 1
    s_andn2_b64 s[52:53], s[52:53], s[80:81]
    s_andn2_b64 s[52:53], s[52:53], s[54:55]
    s_or_b64 s[80:81], s[80:81], s[52:53]
    s_not_b64 vcc, s[52:53]
    s_mov_b64 exec, -1
    v_cndmask_b32_dpp v84, v84, v84, vcc wave_shr:1 row_mask:0xf bank_mask:0xf
    v_cndmask_b32_dpp v85, v85, v85, vcc wave_shr:1 row_mask:0xf bank_mask:0xf
    s_lshr_b64 s[52:53], s[52:53], 1
    v_cndmask_b32_dpp v86, v86, v86, vcc wave_shr:1 row_mask:0xf bank_mask:0xf
    v_cndmask_b32_dpp v87, v87, v87, vcc wave_shr:1 row_mask:0xf bank_mask:0xf
    s_andn2_b64 s[82:83], s[82:83], s[52:53]
    v_cndmask_b32_dpp v7, v7, v7, vcc wave_shr:1 row_mask:0xf bank_mask:0xf
    s_mov_b64 exec, s[54:55]
    s_cbranch_scc0 L2_d91
    s_mov_b64 exec, s[82:83]
    s_nop 1
    v_mfma_f32_4x4x4_16b_bf16 v[88:91], v[12:13], v[84:85], 0
    s_nop 1
    v_mfma_f32_4x4x4_16b_bf16 v[88:91], v[10:11], v[86:87], v[88:91]
    s_nop 4
    v_cvt_pk_bf16_f32 v88, v88, v89
    v_cvt_pk_bf16_f32 v89, v90, v91
    ds_pk_add_bf16 v7, v88 offset:65408
    ds_pk_add_bf16 v7, v89 offset:65412
    s_mov_b64 exec, s[54:55]
    s_branch L2_d91
L2_c92:
    s_lshl_b64 s[52:53], s[82:83], 1
    s_andn2_b64 s[52:53], s[52:53], s[80:81]
    s_andn2_b64 s[52:53], s[52:53], s[50:51]
    s_or_b64 s[80:81], s[80:81], s[52:53]
    s_not_b64 vcc, s[52:53]
    s_mov_b64 exec, -1
    v_cndmask_b32_dpp v84, v84, v84, vcc wave_shr:1 row_mask:0xf bank_mask:0xf
    v_cndmask_b32_dpp v85, v85, v85, vcc wave_shr:1 row_mask:0xf bank_mask:0xf
    s_lshr_b64 s[52:53], s[52:53], 1
    v_cndmask_b32_dpp v86, v86, v86, vcc wave_shr:1 row_mask:0xf bank_mask:0xf
    v_cndmask_b32_dpp v87, v87, v87, vcc wave_shr:1 row_mask:0xf bank_mask:0xf
    s_andn2_b64 s[82:83], s[82:83], s[52:53]
    v_cndmask_b32_dpp v7, v7, v7, vcc wave_shr:1 row_mask:0xf bank_mask:0xf
    s_mov_b64 exec, s[50:51]
    s_cbranch_scc0 L2_d92
    s_mov_b64 exec, s[82:83]
    s_nop 1
    v_mfma_f32_4x4x4_16b_bf16 v[88:91], v[12:13], v[84:85], 0
    s_nop 1
    v_mfma_f32_4x4x4_16b_bf16 v[88:91], v[10:11], v[86:87], v[88:91]
    s_nop 4
    v_cvt_pk_bf16_f32 v88, v88, v89
    v_cvt_pk_bf16_f32 v89, v90, v91
    ds_pk_add_bf16 v7, v88 offset:65408
    ds_pk_add_bf16 v7, v89 offset:65412
    s_mov_b64 exec, s[50:51]
    s_branch L2_d92
L2_c93:
    s_lshl_b64 s[52:53], s[82:83], 1
    s_andn2_b64 s[52:53], s[52:53], s[80:81]
    s_andn2_b64 s[52:53], s[52:53], s[54:55]
    s_or_b64 s[80:81], s[80:81], s[52:53]
    s_not_b64 vcc, s[52:53]
    s_mov_b64 exec, -1
    v_cndmask_b32_dpp v84, v84, v84, vcc wave_shr:1 row_mask:0xf bank_mask:0xf
    v_cndmask_b32_dpp v85, v85, v85, vcc wave_shr:1 row_mask:0xf bank_mask:0xf
    s_lshr_b64 s[52:53], s[52:53], 1
    v_cndmask_b32_dpp v86, v86, v86, vcc wave_shr:1 row_mask:0xf bank_mask:0xf
    v_cndmask_b32_dpp v87, v87, v87, vcc wave_shr:1 row_mask:0xf bank_mask:0xf
    s_andn2_b64 s[82:83], s[82:83], s[52:53]
    v_cndmask_b32_dpp v7, v7, v7, vcc wave_shr:1 row_mask:0xf bank_mask:0xf
    s_mov_b64 exec, s[54:55]
    s_cbranch_scc0 L2_d93
    s_mov_b64 exec, s[82:83]
    s_nop 1
    v_mfma_f32_4x4x4_16b_bf16 v[88:91], v[12:13], v[84:85], 0
    s_nop 1
    v_mfma_f32_4x4x4_16b_bf16 v[88:91], v[10:11], v[86:87], v[88:91]
    s_nop 4
    v_cvt_pk_bf16_f32 v88, v88, v89
    v_cvt_pk_bf16_f32 v89, v90, v91
    ds_pk_add_bf16 v7, v88 offset:65408
    ds_pk_add_bf16 v7, v89 offset:65412
    s_mov_b64 exec, s[54:55]
    s_branch L2_d93
L2_c94:
    s_lshl_b64 s[52:53], s[82:83], 1
    s_andn2_b64 s[52:53], s[52:53], s[80:81]
    s_andn2_b64 s[52:53], s[52:53], s[50:51]
    s_or_b64 s[80:81], s[80:81], s[52:53]
    s_not_b64 vcc, s[52:53]
    s_mov_b64 exec, -1
    v_cndmask_b32_dpp v84, v84, v84, vcc wave_shr:1 row_mask:0xf bank_mask:0xf
    v_cndmask_b32_dpp v85, v85, v85, vcc wave_shr:1 row_mask:0xf bank_mask:0xf
    s_lshr_b64 s[52:53], s[52:53], 1
    v_cndmask_b32_dpp v86, v86, v86, vcc wave_shr:1 row_mask:0xf bank_mask:0xf
    v_cndmask_b32_dpp v87, v87, v87, vcc wave_shr:1 row_mask:0xf bank_mask:0xf
    s_andn2_b64 s[82:83], s[82:83], s[52:53]
    v_cndmask_b32_dpp v7, v7, v7, vcc wave_shr:1 row_mask:0xf bank_mask:0xf
    s_mov_b64 exec, s[50:51]
    s_cbranch_scc0 L2_d94
    s_mov_b64 exec, s[82:83]
    s_nop 1
    v_mfma_f32_4x4x4_16b_bf16 v[88:91], v[12:13], v[84:85], 0
    s_nop 1
    v_mfma_f32_4x4x4_16b_bf16 v[88:91], v[10:11], v[86:87], v[88:91]
    s_nop 4
    v_cvt_pk_bf16_f32 v88, v88, v89
    v_cvt_pk_bf16_f32 v89, v90, v91
    ds_pk_add_bf16 v7, v88 offset:65408
    ds_pk_add_bf16 v7, v89 offset:65412
    s_mov_b64 exec, s[50:51]
    s_branch L2_d94
L2_c95:
    s_lshl_b64 s[52:53], s[82:83], 1
    s_andn2_b64 s[52:53], s[52:53], s[80:81]
    s_andn2_b64 s[52:53], s[52:53], s[54:55]
    s_or_b64 s[80:81], s[80:81], s[52:53]
    s_not_b64 vcc, s[52:53]
    s_mov_b64 exec, -1
    v_cndmask_b32_dpp v84, v84, v84, vcc wave_shr:1 row_mask:0xf bank_mask:0xf
    v_cndmask_b32_dpp v85, v85, v85, vcc wave_shr:1 row_mask:0xf bank_mask:0xf
    s_lshr_b64 s[52:53], s[52:53], 1
    v_cndmask_b32_dpp v86, v86, v86, vcc wave_shr:1 row_mask:0xf bank_mask:0xf
    v_cndmask_b32_dpp v87, v87, v87, vcc wave_shr:1 row_mask:0xf bank_mask:0xf
    s_andn2_b64 s[82:83], s[82:83], s[52:53]
    v_cndmask_b32_dpp v7, v7, v7, vcc wave_shr:1 row_mask:0xf bank_mask:0xf
    s_mov_b64 exec, s[54:55]
    s_cbranch_scc0 L2_d95
    s_mov_b64 exec, s[82:83]
    s_nop 1
    v_mfma_f32_4x4x4_16b_bf16 v[88:91], v[12:13], v[84:85], 0
    s_nop 1
    v_mfma_f32_4x4x4_16b_bf16 v[88:91], v[10:11], v[86:87], v[88:91]
    s_nop 4
    v_cvt_pk_bf16_f32 v88, v88, v89
    v_cvt_pk_bf16_f32 v89, v90, v91
    ds_pk_add_bf16 v7, v88 offset:65408
    ds_pk_add_bf16 v7, v89 offset:65412
    s_mov_b64 exec, s[54:55]
    s_branch L2_d95
L2_c96:
    s_lshl_b64 s[52:53], s[82:83], 1
    s_andn2_b64 s[52:53], s[52:53], s[80:81]
    s_andn2_b64 s[52:53], s[52:53], s[50:51]
    s_or_b64 s[80:81], s[80:81], s[52:53]
    s_not_b64 vcc, s[52:53]
    s_mov_b64 exec, -1
    v_cndmask_b32_dpp v84, v84, v84, vcc wave_shr:1 row_mask:0xf bank_mask:0xf
    v_cndmask_b32_dpp v85, v85, v85, vcc wave_shr:1 row_mask:0xf bank_mask:0xf
    s_lshr_b64 s[52:53], s[52:53], 1
    v_cndmask_b32_dpp v86, v86, v86, vcc wave_shr:1 row_mask:0xf bank_mask:0xf
    v_cndmask_b32_dpp v87, v87, v87, vcc wave_shr:1 row_mask:0xf bank_mask:0xf
    s_andn2_b64 s[82:83], s[82:83], s[52:53]
    v_cndmask_b32_dpp v7, v7, v7, vcc wave_shr:1 row_mask:0xf bank_mask:0xf
    s_mov_b64 exec, s[50:51]
    s_cbranch_scc0 L2_d96
    s_mov_b64 exec, s[82:83]
    s_nop 1
    v_mfma_f32_4x4x4_16b_bf16 v[88:91], v[12:13], v[84:85], 0
    s_nop 1
    v_mfma_f32_4x4x4_16b_bf16 v[88:91], v[10:11], v[86:87], v[88:91]
    s_nop 4
    v_cvt_pk_bf16_f32 v88, v88, v89
    v_cvt_pk_bf16_f32 v89, v90, v91
    ds_pk_add_bf16 v7, v88 offset:65408
    ds_pk_add_bf16 v7, v89 offset:65412
    s_mov_b64 exec, s[50:51]
    s_branch L2_d96
L2_xa97:
    s_cmp_eq_u32 s101, 1
    s_cbranch_scc1 L2_xc97
    v_lshlrev_b32 v89, 0, v96
    v_add_u32 v90, 140, v97
    v_bitop3_b32 v90, v89, v45, v90 bitop3:0x6a
    ds_write_b32 v98, v90 offset:28
    v_lshlrev_b32 v89, 4, v96
    v_add_u32 v90, 120, v97
    v_bitop3_b32 v90, v89, v45, v90 bitop3:0x6a
    ds_write_b32 v98, v90 offset:24
    v_lshlrev_b32 v89, 8, v96
    v_add_u32 v90, 100, v97
    v_bitop3_b32 v90, v89, v45, v90 bitop3:0x6a
    ds_write_b32 v98, v90 offset:20
L2_xc97:
    v_lshlrev_b32 v89, 12, v96
    v_add_u32 v90, 80, v97
    v_bitop3_b32 v90, v89, v45, v90 bitop3:0x6a
    ds_write_b32 v98, v90 offset:16
    s_branch L2_xb97
L2_xe97:
    v_cmp_lt_u32 vcc, 32, v99
    v_cmp_lt_u32 s[58:59], 31, v88
    v_lshrrev_b32 v89, 16, v96
    v_add_u32 v97, 80, v97
    s_or_b64 vcc, vcc, s[58:59]
    s_cbranch_scc1 L2_xs97
    v_lshlrev_b32 v89, v1, v89
    v_and_b32 v89, v45, v89
    v_cmp_ne_u32 vcc, 0, v89
    v_xor_b32 v90, v97, v89
    s_add_u32 s3, s37, s38
    v_mbcnt_lo_u32_b32 v98, vcc_lo, 0
    v_mbcnt_hi_u32_b32 v98, vcc_hi, v98
    s_bcnt1_i32_b64 s41, vcc
    v_lshl_add_u32 v98, v98, 2, s3
    s_lshl2_add_u32 s37, s41, s37
    s_mov_b64 exec, vcc
    ds_write_b32 v98, v90
    s_mov_b64 exec, -1
    s_branch L2_xr97
L2_xs97:
    s_waitcnt lgkmcnt(0)
    s_mov_b32 s37, 0x10000
    s_branch L2_xw97
L2_c98:
    s_lshl_b64 s[52:53], s[82:83], 1
    s_andn2_b64 s[52:53], s[52:53], s[80:81]
    s_andn2_b64 s[52:53], s[52:53], s[54:55]
    s_or_b64 s[80:81], s[80:81], s[52:53]
    s_not_b64 vcc, s[52:53]
    s_mov_b64 exec, -1
    v_cndmask_b32_dpp v84, v84, v84, vcc wave_shr:1 row_mask:0xf bank_mask:0xf
    v_cndmask_b32_dpp v85, v85, v85, vcc wave_shr:1 row_mask:0xf bank_mask:0xf
    s_lshr_b64 s[52:53], s[52:53], 1
    v_cndmask_b32_dpp v86, v86, v86, vcc wave_shr:1 row_mask:0xf bank_mask:0xf
    v_cndmask_b32_dpp v87, v87, v87, vcc wave_shr:1 row_mask:0xf bank_mask:0xf
    s_andn2_b64 s[82:83], s[82:83], s[52:53]
    v_cndmask_b32_dpp v7, v7, v7, vcc wave_shr:1 row_mask:0xf bank_mask:0xf
    s_mov_b64 exec, s[54:55]
    s_cbranch_scc0 L2_d98
    s_mov_b64 exec, s[82:83]
    s_nop 1
    v_mfma_f32_4x4x4_16b_bf16 v[88:91], v[12:13], v[84:85], 0
    s_nop 1
    v_mfma_f32_4x4x4_16b_bf16 v[88:91], v[10:11], v[86:87], v[88:91]
    s_nop 4
    v_cvt_pk_bf16_f32 v88, v88, v89
    v_cvt_pk_bf16_f32 v89, v90, v91
    ds_pk_add_bf16 v7, v88 offset:65408
    ds_pk_add_bf16 v7, v89 offset:65412
    s_mov_b64 exec, s[54:55]
    s_branch L2_d98
L2_c99:
    s_lshl_b64 s[52:53], s[82:83], 1
    s_andn2_b64 s[52:53], s[52:53], s[80:81]
    s_andn2_b64 s[52:53], s[52:53], s[50:51]
    s_or_b64 s[80:81], s[80:81], s[52:53]
    s_not_b64 vcc, s[52:53]
    s_mov_b64 exec, -1
    v_cndmask_b32_dpp v84, v84, v84, vcc wave_shr:1 row_mask:0xf bank_mask:0xf
    v_cndmask_b32_dpp v85, v85, v85, vcc wave_shr:1 row_mask:0xf bank_mask:0xf
    s_lshr_b64 s[52:53], s[52:53], 1
    v_cndmask_b32_dpp v86, v86, v86, vcc wave_shr:1 row_mask:0xf bank_mask:0xf
    v_cndmask_b32_dpp v87, v87, v87, vcc wave_shr:1 row_mask:0xf bank_mask:0xf
    s_andn2_b64 s[82:83], s[82:83], s[52:53]
    v_cndmask_b32_dpp v7, v7, v7, vcc wave_shr:1 row_mask:0xf bank_mask:0xf
    s_mov_b64 exec, s[50:51]
    s_cbranch_scc0 L2_d99
    s_mov_b64 exec, s[82:83]
    s_nop 1
    v_mfma_f32_4x4x4_16b_bf16 v[88:91], v[12:13], v[84:85], 0
    s_nop 1
    v_mfma_f32_4x4x4_16b_bf16 v[88:91], v[10:11], v[86:87], v[88:91]
    s_nop 4
    v_cvt_pk_bf16_f32 v88, v88, v89
    v_cvt_pk_bf16_f32 v89, v90, v91
    ds_pk_add_bf16 v7, v88 offset:65408
    ds_pk_add_bf16 v7, v89 offset:65412
    s_mov_b64 exec, s[50:51]
    s_branch L2_d99
L2_xf97:
    s_cmp_gt_u32 s37, 1024
    s_cbranch_scc1 L2_xt97
    s_cmp_lt_u32 s37, 768
    s_cbranch_scc1 L2_xl97
    ds_read_b32 v32, v44 offset:896
    s_add_u32 s3, s42, 2
    s_bitset1_b32 s43, s3
    s_branch L2_xg97
L2_xl97:
    s_waitcnt lgkmcnt(0)
    v_mov_b32 v31, -1
    s_cmp_ge_u32 s37, 512
    s_cbranch_scc1 L2_xg97
    v_mov_b32 v39, -1
    s_cmp_ge_u32 s37, 256
    s_cbranch_scc1 L2_xg97
    v_mov_b32 v27, -1
    s_branch L2_xg97
L2_xt97:
    s_waitcnt lgkmcnt(0)
    v_mov_b32 v21, -1
    v_mov_b32 v27, -1
    v_mov_b32 v39, -1
    v_mov_b32 v31, -1
    s_add_u32 s3, s42, 2
    s_bitset1_b32 s36, s3
    s_branch L2_xg97
L2_oa100:
    v_and_b32 v47, 0x0fffffff, v33
    buffer_load_dword v114, v47, s[8:11], 0 offen offset:16
    s_mov_b64 exec, s[6:7]
    v_add_u32 v47, 8, v47
    v_lshrrev_b32 v33, 2, v33
    s_mov_b64 exec, -1
    buffer_load_dwordx2 v[112:113], v47, s[8:11], 0 offen
    s_branch L2_ob100
L2_c101:
    s_lshl_b64 s[52:53], s[82:83], 1
    s_andn2_b64 s[52:53], s[52:53], s[80:81]
    s_andn2_b64 s[52:53], s[52:53], s[54:55]
    s_or_b64 s[80:81], s[80:81], s[52:53]
    s_not_b64 vcc, s[52:53]
    s_mov_b64 exec, -1
    v_cndmask_b32_dpp v84, v84, v84, vcc wave_shr:1 row_mask:0xf bank_mask:0xf
    v_cndmask_b32_dpp v85, v85, v85, vcc wave_shr:1 row_mask:0xf bank_mask:0xf
    s_lshr_b64 s[52:53], s[52:53], 1
    v_cndmask_b32_dpp v86, v86, v86, vcc wave_shr:1 row_mask:0xf bank_mask:0xf
    v_cndmask_b32_dpp v87, v87, v87, vcc wave_shr:1 row_mask:0xf bank_mask:0xf
    s_andn2_b64 s[82:83], s[82:83], s[52:53]
    v_cndmask_b32_dpp v7, v7, v7, vcc wave_shr:1 row_mask:0xf bank_mask:0xf
    s_mov_b64 exec, s[54:55]
    s_cbranch_scc0 L2_d101
    s_mov_b64 exec, s[82:83]
    s_nop 1
    v_mfma_f32_4x4x4_16b_bf16 v[88:91], v[12:13], v[84:85], 0
    s_nop 1
    v_mfma_f32_4x4x4_16b_bf16 v[88:91], v[10:11], v[86:87], v[88:91]
    s_nop 4
    v_cvt_pk_bf16_f32 v88, v88, v89
    v_cvt_pk_bf16_f32 v89, v90, v91
    ds_pk_add_bf16 v7, v88 offset:65408
    ds_pk_add_bf16 v7, v89 offset:65412
    s_mov_b64 exec, s[54:55]
    s_branch L2_d101
L2_c102:
    s_lshl_b64 s[52:53], s[82:83], 1
    s_andn2_b64 s[52:53], s[52:53], s[80:81]
    s_andn2_b64 s[52:53], s[52:53], s[50:51]
    s_or_b64 s[80:81], s[80:81], s[52:53]
    s_not_b64 vcc, s[52:53]
    s_mov_b64 exec, -1
    v_cndmask_b32_dpp v84, v84, v84, vcc wave_shr:1 row_mask:0xf bank_mask:0xf
    v_cndmask_b32_dpp v85, v85, v85, vcc wave_shr:1 row_mask:0xf bank_mask:0xf
    s_lshr_b64 s[52:53], s[52:53], 1
    v_cndmask_b32_dpp v86, v86, v86, vcc wave_shr:1 row_mask:0xf bank_mask:0xf
    v_cndmask_b32_dpp v87, v87, v87, vcc wave_shr:1 row_mask:0xf bank_mask:0xf
    s_andn2_b64 s[82:83], s[82:83], s[52:53]
    v_cndmask_b32_dpp v7, v7, v7, vcc wave_shr:1 row_mask:0xf bank_mask:0xf
    s_mov_b64 exec, s[50:51]
    s_cbranch_scc0 L2_d102
    s_mov_b64 exec, s[82:83]
    s_nop 1
    v_mfma_f32_4x4x4_16b_bf16 v[88:91], v[12:13], v[84:85], 0
    s_nop 1
    v_mfma_f32_4x4x4_16b_bf16 v[88:91], v[10:11], v[86:87], v[88:91]
    s_nop 4
    v_cvt_pk_bf16_f32 v88, v88, v89
    v_cvt_pk_bf16_f32 v89, v90, v91
    ds_pk_add_bf16 v7, v88 offset:65408
    ds_pk_add_bf16 v7, v89 offset:65412
    s_mov_b64 exec, s[50:51]
    s_branch L2_d102
L2_c103:
    s_lshl_b64 s[52:53], s[82:83], 1
    s_andn2_b64 s[52:53], s[52:53], s[80:81]
    s_andn2_b64 s[52:53], s[52:53], s[54:55]
    s_or_b64 s[80:81], s[80:81], s[52:53]
    s_not_b64 vcc, s[52:53]
    s_mov_b64 exec, -1
    v_cndmask_b32_dpp v84, v84, v84, vcc wave_shr:1 row_mask:0xf bank_mask:0xf
    v_cndmask_b32_dpp v85, v85, v85, vcc wave_shr:1 row_mask:0xf bank_mask:0xf
    s_lshr_b64 s[52:53], s[52:53], 1
    v_cndmask_b32_dpp v86, v86, v86, vcc wave_shr:1 row_mask:0xf bank_mask:0xf
    v_cndmask_b32_dpp v87, v87, v87, vcc wave_shr:1 row_mask:0xf bank_mask:0xf
    s_andn2_b64 s[82:83], s[82:83], s[52:53]
    v_cndmask_b32_dpp v7, v7, v7, vcc wave_shr:1 row_mask:0xf bank_mask:0xf
    s_mov_b64 exec, s[54:55]
    s_cbranch_scc0 L2_d103
    s_mov_b64 exec, s[82:83]
    s_nop 1
    v_mfma_f32_4x4x4_16b_bf16 v[88:91], v[12:13], v[84:85], 0
    s_nop 1
    v_mfma_f32_4x4x4_16b_bf16 v[88:91], v[10:11], v[86:87], v[88:91]
    s_nop 4
    v_cvt_pk_bf16_f32 v88, v88, v89
    v_cvt_pk_bf16_f32 v89, v90, v91
    ds_pk_add_bf16 v7, v88 offset:65408
    ds_pk_add_bf16 v7, v89 offset:65412
    s_mov_b64 exec, s[54:55]
    s_branch L2_d103
L2_c104:
    s_lshl_b64 s[52:53], s[82:83], 1
    s_andn2_b64 s[52:53], s[52:53], s[80:81]
    s_andn2_b64 s[52:53], s[52:53], s[50:51]
    s_or_b64 s[80:81], s[80:81], s[52:53]
    s_not_b64 vcc, s[52:53]
    s_mov_b64 exec, -1
    v_cndmask_b32_dpp v84, v84, v84, vcc wave_shr:1 row_mask:0xf bank_mask:0xf
    v_cndmask_b32_dpp v85, v85, v85, vcc wave_shr:1 row_mask:0xf bank_mask:0xf
    s_lshr_b64 s[52:53], s[52:53], 1
    v_cndmask_b32_dpp v86, v86, v86, vcc wave_shr:1 row_mask:0xf bank_mask:0xf
    v_cndmask_b32_dpp v87, v87, v87, vcc wave_shr:1 row_mask:0xf bank_mask:0xf
    s_andn2_b64 s[82:83], s[82:83], s[52:53]
    v_cndmask_b32_dpp v7, v7, v7, vcc wave_shr:1 row_mask:0xf bank_mask:0xf
    s_mov_b64 exec, s[50:51]
    s_cbranch_scc0 L2_d104
    s_mov_b64 exec, s[82:83]
    s_nop 1
    v_mfma_f32_4x4x4_16b_bf16 v[88:91], v[12:13], v[84:85], 0
    s_nop 1
    v_mfma_f32_4x4x4_16b_bf16 v[88:91], v[10:11], v[86:87], v[88:91]
    s_nop 4
    v_cvt_pk_bf16_f32 v88, v88, v89
    v_cvt_pk_bf16_f32 v89, v90, v91
    ds_pk_add_bf16 v7, v88 offset:65408
    ds_pk_add_bf16 v7, v89 offset:65412
    s_mov_b64 exec, s[50:51]
    s_branch L2_d104
L2_c105:
    s_lshl_b64 s[52:53], s[82:83], 1
    s_andn2_b64 s[52:53], s[52:53], s[80:81]
    s_andn2_b64 s[52:53], s[52:53], s[54:55]
    s_or_b64 s[80:81], s[80:81], s[52:53]
    s_not_b64 vcc, s[52:53]
    s_mov_b64 exec, -1
    v_cndmask_b32_dpp v84, v84, v84, vcc wave_shr:1 row_mask:0xf bank_mask:0xf
    v_cndmask_b32_dpp v85, v85, v85, vcc wave_shr:1 row_mask:0xf bank_mask:0xf
    s_lshr_b64 s[52:53], s[52:53], 1
    v_cndmask_b32_dpp v86, v86, v86, vcc wave_shr:1 row_mask:0xf bank_mask:0xf
    v_cndmask_b32_dpp v87, v87, v87, vcc wave_shr:1 row_mask:0xf bank_mask:0xf
    s_andn2_b64 s[82:83], s[82:83], s[52:53]
    v_cndmask_b32_dpp v7, v7, v7, vcc wave_shr:1 row_mask:0xf bank_mask:0xf
    s_mov_b64 exec, s[54:55]
    s_cbranch_scc0 L2_d105
    s_mov_b64 exec, s[82:83]
    s_nop 1
    v_mfma_f32_4x4x4_16b_bf16 v[88:91], v[12:13], v[84:85], 0
    s_nop 1
    v_mfma_f32_4x4x4_16b_bf16 v[88:91], v[10:11], v[86:87], v[88:91]
    s_nop 4
    v_cvt_pk_bf16_f32 v88, v88, v89
    v_cvt_pk_bf16_f32 v89, v90, v91
    ds_pk_add_bf16 v7, v88 offset:65408
    ds_pk_add_bf16 v7, v89 offset:65412
    s_mov_b64 exec, s[54:55]
    s_branch L2_d105
L2_c106:
    s_lshl_b64 s[52:53], s[82:83], 1
    s_andn2_b64 s[52:53], s[52:53], s[80:81]
    s_andn2_b64 s[52:53], s[52:53], s[50:51]
    s_or_b64 s[80:81], s[80:81], s[52:53]
    s_not_b64 vcc, s[52:53]
    s_mov_b64 exec, -1
    v_cndmask_b32_dpp v84, v84, v84, vcc wave_shr:1 row_mask:0xf bank_mask:0xf
    v_cndmask_b32_dpp v85, v85, v85, vcc wave_shr:1 row_mask:0xf bank_mask:0xf
    s_lshr_b64 s[52:53], s[52:53], 1
    v_cndmask_b32_dpp v86, v86, v86, vcc wave_shr:1 row_mask:0xf bank_mask:0xf
    v_cndmask_b32_dpp v87, v87, v87, vcc wave_shr:1 row_mask:0xf bank_mask:0xf
    s_andn2_b64 s[82:83], s[82:83], s[52:53]
    v_cndmask_b32_dpp v7, v7, v7, vcc wave_shr:1 row_mask:0xf bank_mask:0xf
    s_mov_b64 exec, s[50:51]
    s_cbranch_scc0 L2_d106
    s_mov_b64 exec, s[82:83]
    s_nop 1
    v_mfma_f32_4x4x4_16b_bf16 v[88:91], v[12:13], v[84:85], 0
    s_nop 1
    v_mfma_f32_4x4x4_16b_bf16 v[88:91], v[10:11], v[86:87], v[88:91]
    s_nop 4
    v_cvt_pk_bf16_f32 v88, v88, v89
    v_cvt_pk_bf16_f32 v89, v90, v91
    ds_pk_add_bf16 v7, v88 offset:65408
    ds_pk_add_bf16 v7, v89 offset:65412
    s_mov_b64 exec, s[50:51]
    s_branch L2_d106
L2_oa107:
    s_waitcnt vmcnt(3)
    s_mov_b64 exec, s[6:7]
    v_lshrrev_b32 v114, 16, v114
    s_mov_b64 exec, -1
    v_and_b32 v46, 0x10000000, v33
    v_cmpx_eq_u32 vcc, 0, v46
    v_lshrrev_b32 v47, 14, v112
    v_and_b32 v47, v5, v47
    ds_read_b64 v[96:97], v47
    v_perm_b32 v98, v112, v114, s44
    v_bitop3_b32 v99, v112, 0.5, -0.5 bitop3:0xa8
    v_bitop3_b32 v98, v6, v98, v99 bitop3:0xca
    v_and_b32 v47, v5, v112
    s_waitcnt lgkmcnt(0)
    v_mfma_f32_4x4x4_16b_bf16 v[88:91], v[8:9], v[96:97], 0
    s_nop 4
    v_mul_f32 v88, v98, v88
    v_mul_f32 v89, v98, v89
    v_mul_f32 v90, v98, v90
    v_mul_f32 v91, v98, v91
    v_cvt_pk_bf16_f32 v88, v88, v89
    v_cvt_pk_bf16_f32 v89, v90, v91
    ds_pk_add_bf16 v47, v88 offset:65408
    ds_pk_add_bf16 v47, v89 offset:65412
    s_mov_b64 exec, -1
    v_and_b32 v46, 0x20000000, v33
    v_cmpx_eq_u32 vcc, 0, v46
    v_lshrrev_b32 v47, 14, v113
    v_and_b32 v47, v5, v47
    ds_read_b64 v[96:97], v47
    v_perm_b32 v98, v113, v114, s45
    v_bitop3_b32 v99, v113, 0.5, -0.5 bitop3:0xa8
    v_bitop3_b32 v98, v6, v98, v99 bitop3:0xca
    v_and_b32 v47, v5, v113
    s_waitcnt lgkmcnt(0)
    v_mfma_f32_4x4x4_16b_bf16 v[88:91], v[8:9], v[96:97], 0
    s_nop 4
    v_mul_f32 v88, v98, v88
    v_mul_f32 v89, v98, v89
    v_mul_f32 v90, v98, v90
    v_mul_f32 v91, v98, v91
    v_cvt_pk_bf16_f32 v88, v88, v89
    v_cvt_pk_bf16_f32 v89, v90, v91
    ds_pk_add_bf16 v47, v88 offset:65408
    ds_pk_add_bf16 v47, v89 offset:65412
    s_mov_b64 exec, -1
    s_branch L2_ob107
L2_xo108:
    v_cmp_lt_u32 vcc, 20, v99
    s_mov_b32 s101, 1
    s_cbranch_vccz L2_xp108
    v_cmp_lt_u32 vcc, 32, v99
    v_cmp_lt_u32 s[58:59], 31, v88
    s_mov_b32 s101, 2
    s_or_b64 vcc, vcc, s[58:59]
    s_cbranch_scc0 L2_xp108
    s_mov_b32 s37, 0x10000
    s_branch L2_xp108
L2_c109:
    s_lshl_b64 s[52:53], s[82:83], 1
    s_andn2_b64 s[52:53], s[52:53], s[80:81]
    s_andn2_b64 s[52:53], s[52:53], s[54:55]
    s_or_b64 s[80:81], s[80:81], s[52:53]
    s_not_b64 vcc, s[52:53]
    s_mov_b64 exec, -1
    v_cndmask_b32_dpp v84, v84, v84, vcc wave_shr:1 row_mask:0xf bank_mask:0xf
    v_cndmask_b32_dpp v85, v85, v85, vcc wave_shr:1 row_mask:0xf bank_mask:0xf
    s_lshr_b64 s[52:53], s[52:53], 1
    v_cndmask_b32_dpp v86, v86, v86, vcc wave_shr:1 row_mask:0xf bank_mask:0xf
    v_cndmask_b32_dpp v87, v87, v87, vcc wave_shr:1 row_mask:0xf bank_mask:0xf
    s_andn2_b64 s[82:83], s[82:83], s[52:53]
    v_cndmask_b32_dpp v7, v7, v7, vcc wave_shr:1 row_mask:0xf bank_mask:0xf
    s_mov_b64 exec, s[54:55]
    s_cbranch_scc0 L2_d109
    s_mov_b64 exec, s[82:83]
    s_nop 1
    v_mfma_f32_4x4x4_16b_bf16 v[88:91], v[12:13], v[84:85], 0
    s_nop 1
    v_mfma_f32_4x4x4_16b_bf16 v[88:91], v[10:11], v[86:87], v[88:91]
    s_nop 4
    v_cvt_pk_bf16_f32 v88, v88, v89
    v_cvt_pk_bf16_f32 v89, v90, v91
    ds_pk_add_bf16 v7, v88 offset:65408
    ds_pk_add_bf16 v7, v89 offset:65412
    s_mov_b64 exec, s[54:55]
    s_branch L2_d109
L2_c110:
    s_lshl_b64 s[52:53], s[82:83], 1
    s_andn2_b64 s[52:53], s[52:53], s[80:81]
    s_andn2_b64 s[52:53], s[52:53], s[50:51]
    s_or_b64 s[80:81], s[80:81], s[52:53]
    s_not_b64 vcc, s[52:53]
    s_mov_b64 exec, -1
    v_cndmask_b32_dpp v84, v84, v84, vcc wave_shr:1 row_mask:0xf bank_mask:0xf
    v_cndmask_b32_dpp v85, v85, v85, vcc wave_shr:1 row_mask:0xf bank_mask:0xf
    s_lshr_b64 s[52:53], s[52:53], 1
    v_cndmask_b32_dpp v86, v86, v86, vcc wave_shr:1 row_mask:0xf bank_mask:0xf
    v_cndmask_b32_dpp v87, v87, v87, vcc wave_shr:1 row_mask:0xf bank_mask:0xf
    s_andn2_b64 s[82:83], s[82:83], s[52:53]
    v_cndmask_b32_dpp v7, v7, v7, vcc wave_shr:1 row_mask:0xf bank_mask:0xf
    s_mov_b64 exec, s[50:51]
    s_cbranch_scc0 L2_d110
    s_mov_b64 exec, s[82:83]
    s_nop 1
    v_mfma_f32_4x4x4_16b_bf16 v[88:91], v[12:13], v[84:85], 0
    s_nop 1
    v_mfma_f32_4x4x4_16b_bf16 v[88:91], v[10:11], v[86:87], v[88:91]
    s_nop 4
    v_cvt_pk_bf16_f32 v88, v88, v89
    v_cvt_pk_bf16_f32 v89, v90, v91
    ds_pk_add_bf16 v7, v88 offset:65408
    ds_pk_add_bf16 v7, v89 offset:65412
    s_mov_b64 exec, s[50:51]
    s_branch L2_d110
L2_c111:
    s_lshl_b64 s[52:53], s[82:83], 1
    s_andn2_b64 s[52:53], s[52:53], s[80:81]
    s_andn2_b64 s[52:53], s[52:53], s[54:55]
    s_or_b64 s[80:81], s[80:81], s[52:53]
    s_not_b64 vcc, s[52:53]
    s_mov_b64 exec, -1
    v_cndmask_b32_dpp v84, v84, v84, vcc wave_shr:1 row_mask:0xf bank_mask:0xf
    v_cndmask_b32_dpp v85, v85, v85, vcc wave_shr:1 row_mask:0xf bank_mask:0xf
    s_lshr_b64 s[52:53], s[52:53], 1
    v_cndmask_b32_dpp v86, v86, v86, vcc wave_shr:1 row_mask:0xf bank_mask:0xf
    v_cndmask_b32_dpp v87, v87, v87, vcc wave_shr:1 row_mask:0xf bank_mask:0xf
    s_andn2_b64 s[82:83], s[82:83], s[52:53]
    v_cndmask_b32_dpp v7, v7, v7, vcc wave_shr:1 row_mask:0xf bank_mask:0xf
    s_mov_b64 exec, s[54:55]
    s_cbranch_scc0 L2_d111
    s_mov_b64 exec, s[82:83]
    s_nop 1
    v_mfma_f32_4x4x4_16b_bf16 v[88:91], v[12:13], v[84:85], 0
    s_nop 1
    v_mfma_f32_4x4x4_16b_bf16 v[88:91], v[10:11], v[86:87], v[88:91]
    s_nop 4
    v_cvt_pk_bf16_f32 v88, v88, v89
    v_cvt_pk_bf16_f32 v89, v90, v91
    ds_pk_add_bf16 v7, v88 offset:65408
    ds_pk_add_bf16 v7, v89 offset:65412
    s_mov_b64 exec, s[54:55]
    s_branch L2_d111
L2_c112:
    s_lshl_b64 s[52:53], s[82:83], 1
    s_andn2_b64 s[52:53], s[52:53], s[80:81]
    s_andn2_b64 s[52:53], s[52:53], s[50:51]
    s_or_b64 s[80:81], s[80:81], s[52:53]
    s_not_b64 vcc, s[52:53]
    s_mov_b64 exec, -1
    v_cndmask_b32_dpp v84, v84, v84, vcc wave_shr:1 row_mask:0xf bank_mask:0xf
    v_cndmask_b32_dpp v85, v85, v85, vcc wave_shr:1 row_mask:0xf bank_mask:0xf
    s_lshr_b64 s[52:53], s[52:53], 1
    v_cndmask_b32_dpp v86, v86, v86, vcc wave_shr:1 row_mask:0xf bank_mask:0xf
    v_cndmask_b32_dpp v87, v87, v87, vcc wave_shr:1 row_mask:0xf bank_mask:0xf
    s_andn2_b64 s[82:83], s[82:83], s[52:53]
    v_cndmask_b32_dpp v7, v7, v7, vcc wave_shr:1 row_mask:0xf bank_mask:0xf
    s_mov_b64 exec, s[50:51]
    s_cbranch_scc0 L2_d112
    s_mov_b64 exec, s[82:83]
    s_nop 1
    v_mfma_f32_4x4x4_16b_bf16 v[88:91], v[12:13], v[84:85], 0
    s_nop 1
    v_mfma_f32_4x4x4_16b_bf16 v[88:91], v[10:11], v[86:87], v[88:91]
    s_nop 4
    v_cvt_pk_bf16_f32 v88, v88, v89
    v_cvt_pk_bf16_f32 v89, v90, v91
    ds_pk_add_bf16 v7, v88 offset:65408
    ds_pk_add_bf16 v7, v89 offset:65412
    s_mov_b64 exec, s[50:51]
    s_branch L2_d112
L2_c113:
    s_lshl_b64 s[52:53], s[82:83], 1
    s_andn2_b64 s[52:53], s[52:53], s[80:81]
    s_andn2_b64 s[52:53], s[52:53], s[54:55]
    s_or_b64 s[80:81], s[80:81], s[52:53]
    s_not_b64 vcc, s[52:53]
    s_mov_b64 exec, -1
    v_cndmask_b32_dpp v84, v84, v84, vcc wave_shr:1 row_mask:0xf bank_mask:0xf
    v_cndmask_b32_dpp v85, v85, v85, vcc wave_shr:1 row_mask:0xf bank_mask:0xf
    s_lshr_b64 s[52:53], s[52:53], 1
    v_cndmask_b32_dpp v86, v86, v86, vcc wave_shr:1 row_mask:0xf bank_mask:0xf
    v_cndmask_b32_dpp v87, v87, v87, vcc wave_shr:1 row_mask:0xf bank_mask:0xf
    s_andn2_b64 s[82:83], s[82:83], s[52:53]
    v_cndmask_b32_dpp v7, v7, v7, vcc wave_shr:1 row_mask:0xf bank_mask:0xf
    s_mov_b64 exec, s[54:55]
    s_cbranch_scc0 L2_d113
    s_mov_b64 exec, s[82:83]
    s_nop 1
    v_mfma_f32_4x4x4_16b_bf16 v[88:91], v[12:13], v[84:85], 0
    s_nop 1
    v_mfma_f32_4x4x4_16b_bf16 v[88:91], v[10:11], v[86:87], v[88:91]
    s_nop 4
    v_cvt_pk_bf16_f32 v88, v88, v89
    v_cvt_pk_bf16_f32 v89, v90, v91
    ds_pk_add_bf16 v7, v88 offset:65408
    ds_pk_add_bf16 v7, v89 offset:65412
    s_mov_b64 exec, s[54:55]
    s_branch L2_d113
L2_c114:
    s_lshl_b64 s[52:53], s[82:83], 1
    s_andn2_b64 s[52:53], s[52:53], s[80:81]
    s_andn2_b64 s[52:53], s[52:53], s[50:51]
    s_or_b64 s[80:81], s[80:81], s[52:53]
    s_not_b64 vcc, s[52:53]
    s_mov_b64 exec, -1
    v_cndmask_b32_dpp v84, v84, v84, vcc wave_shr:1 row_mask:0xf bank_mask:0xf
    v_cndmask_b32_dpp v85, v85, v85, vcc wave_shr:1 row_mask:0xf bank_mask:0xf
    s_lshr_b64 s[52:53], s[52:53], 1
    v_cndmask_b32_dpp v86, v86, v86, vcc wave_shr:1 row_mask:0xf bank_mask:0xf
    v_cndmask_b32_dpp v87, v87, v87, vcc wave_shr:1 row_mask:0xf bank_mask:0xf
    s_andn2_b64 s[82:83], s[82:83], s[52:53]
    v_cndmask_b32_dpp v7, v7, v7, vcc wave_shr:1 row_mask:0xf bank_mask:0xf
    s_mov_b64 exec, s[50:51]
    s_cbranch_scc0 L2_d114
    s_mov_b64 exec, s[82:83]
    s_nop 1
    v_mfma_f32_4x4x4_16b_bf16 v[88:91], v[12:13], v[84:85], 0
    s_nop 1
    v_mfma_f32_4x4x4_16b_bf16 v[88:91], v[10:11], v[86:87], v[88:91]
    s_nop 4
    v_cvt_pk_bf16_f32 v88, v88, v89
    v_cvt_pk_bf16_f32 v89, v90, v91
    ds_pk_add_bf16 v7, v88 offset:65408
    ds_pk_add_bf16 v7, v89 offset:65412
    s_mov_b64 exec, s[50:51]
    s_branch L2_d114
L2_xa115:
    s_cmp_eq_u32 s101, 1
    s_cbranch_scc1 L2_xc115
    v_lshlrev_b32 v89, 0, v96
    v_add_u32 v90, 140, v97
    v_bitop3_b32 v90, v89, v45, v90 bitop3:0x6a
    ds_write_b32 v98, v90 offset:28
    v_lshlrev_b32 v89, 4, v96
    v_add_u32 v90, 120, v97
    v_bitop3_b32 v90, v89, v45, v90 bitop3:0x6a
    ds_write_b32 v98, v90 offset:24
    v_lshlrev_b32 v89, 8, v96
    v_add_u32 v90, 100, v97
    v_bitop3_b32 v90, v89, v45, v90 bitop3:0x6a
    ds_write_b32 v98, v90 offset:20
L2_xc115:
    v_lshlrev_b32 v89, 12, v96
    v_add_u32 v90, 80, v97
    v_bitop3_b32 v90, v89, v45, v90 bitop3:0x6a
    ds_write_b32 v98, v90 offset:16
    s_branch L2_xb115
L2_xe115:
    v_cmp_lt_u32 vcc, 32, v99
    v_cmp_lt_u32 s[58:59], 31, v88
    v_lshrrev_b32 v89, 16, v96
    v_add_u32 v97, 80, v97
    s_or_b64 vcc, vcc, s[58:59]
    s_cbranch_scc1 L2_xs115
    v_lshlrev_b32 v89, v1, v89
    v_and_b32 v89, v45, v89
    v_cmp_ne_u32 vcc, 0, v89
    v_xor_b32 v90, v97, v89
    s_add_u32 s3, s37, s38
    v_mbcnt_lo_u32_b32 v98, vcc_lo, 0
    v_mbcnt_hi_u32_b32 v98, vcc_hi, v98
    s_bcnt1_i32_b64 s41, vcc
    v_lshl_add_u32 v98, v98, 2, s3
    s_lshl2_add_u32 s37, s41, s37
    s_mov_b64 exec, vcc
    ds_write_b32 v98, v90
    s_mov_b64 exec, -1
    s_branch L2_xr115
L2_xs115:
    s_waitcnt lgkmcnt(0)
    s_mov_b32 s37, 0x10000
    s_branch L2_xw115
L2_c116:
    s_lshl_b64 s[52:53], s[82:83], 1
    s_andn2_b64 s[52:53], s[52:53], s[80:81]
    s_andn2_b64 s[52:53], s[52:53], s[54:55]
    s_or_b64 s[80:81], s[80:81], s[52:53]
    s_not_b64 vcc, s[52:53]
    s_mov_b64 exec, -1
    v_cndmask_b32_dpp v84, v84, v84, vcc wave_shr:1 row_mask:0xf bank_mask:0xf
    v_cndmask_b32_dpp v85, v85, v85, vcc wave_shr:1 row_mask:0xf bank_mask:0xf
    s_lshr_b64 s[52:53], s[52:53], 1
    v_cndmask_b32_dpp v86, v86, v86, vcc wave_shr:1 row_mask:0xf bank_mask:0xf
    v_cndmask_b32_dpp v87, v87, v87, vcc wave_shr:1 row_mask:0xf bank_mask:0xf
    s_andn2_b64 s[82:83], s[82:83], s[52:53]
    v_cndmask_b32_dpp v7, v7, v7, vcc wave_shr:1 row_mask:0xf bank_mask:0xf
    s_mov_b64 exec, s[54:55]
    s_cbranch_scc0 L2_d116
    s_mov_b64 exec, s[82:83]
    s_nop 1
    v_mfma_f32_4x4x4_16b_bf16 v[88:91], v[12:13], v[84:85], 0
    s_nop 1
    v_mfma_f32_4x4x4_16b_bf16 v[88:91], v[10:11], v[86:87], v[88:91]
    s_nop 4
    v_cvt_pk_bf16_f32 v88, v88, v89
    v_cvt_pk_bf16_f32 v89, v90, v91
    ds_pk_add_bf16 v7, v88 offset:65408
    ds_pk_add_bf16 v7, v89 offset:65412
    s_mov_b64 exec, s[54:55]
    s_branch L2_d116
L2_c117:
    s_lshl_b64 s[52:53], s[82:83], 1
    s_andn2_b64 s[52:53], s[52:53], s[80:81]
    s_andn2_b64 s[52:53], s[52:53], s[50:51]
    s_or_b64 s[80:81], s[80:81], s[52:53]
    s_not_b64 vcc, s[52:53]
    s_mov_b64 exec, -1
    v_cndmask_b32_dpp v84, v84, v84, vcc wave_shr:1 row_mask:0xf bank_mask:0xf
    v_cndmask_b32_dpp v85, v85, v85, vcc wave_shr:1 row_mask:0xf bank_mask:0xf
    s_lshr_b64 s[52:53], s[52:53], 1
    v_cndmask_b32_dpp v86, v86, v86, vcc wave_shr:1 row_mask:0xf bank_mask:0xf
    v_cndmask_b32_dpp v87, v87, v87, vcc wave_shr:1 row_mask:0xf bank_mask:0xf
    s_andn2_b64 s[82:83], s[82:83], s[52:53]
    v_cndmask_b32_dpp v7, v7, v7, vcc wave_shr:1 row_mask:0xf bank_mask:0xf
    s_mov_b64 exec, s[50:51]
    s_cbranch_scc0 L2_d117
    s_mov_b64 exec, s[82:83]
    s_nop 1
    v_mfma_f32_4x4x4_16b_bf16 v[88:91], v[12:13], v[84:85], 0
    s_nop 1
    v_mfma_f32_4x4x4_16b_bf16 v[88:91], v[10:11], v[86:87], v[88:91]
    s_nop 4
    v_cvt_pk_bf16_f32 v88, v88, v89
    v_cvt_pk_bf16_f32 v89, v90, v91
    ds_pk_add_bf16 v7, v88 offset:65408
    ds_pk_add_bf16 v7, v89 offset:65412
    s_mov_b64 exec, s[50:51]
    s_branch L2_d117
L2_xf115:
    s_cmp_gt_u32 s37, 1024
    s_cbranch_scc1 L2_xt115
    s_cmp_lt_u32 s37, 768
    s_cbranch_scc1 L2_xl115
    ds_read_b32 v33, v44 offset:896
    s_add_u32 s3, s42, 2
    s_bitset1_b32 s43, s3
    s_branch L2_xg115
L2_xl115:
    s_waitcnt lgkmcnt(0)
    v_mov_b32 v42, -1
    s_cmp_ge_u32 s37, 512
    s_cbranch_scc1 L2_xg115
    v_mov_b32 v43, -1
    s_cmp_ge_u32 s37, 256
    s_cbranch_scc1 L2_xg115
    v_mov_b32 v41, -1
    s_branch L2_xg115
L2_xt115:
    s_waitcnt lgkmcnt(0)
    v_mov_b32 v40, -1
    v_mov_b32 v41, -1
    v_mov_b32 v43, -1
    v_mov_b32 v42, -1
    s_add_u32 s3, s42, 2
    s_bitset1_b32 s36, s3
    s_branch L2_xg115
L2_oa118:
    v_and_b32 v47, 0x0fffffff, v32
    buffer_load_dword v114, v47, s[8:11], 0 offen offset:16
    s_mov_b64 exec, s[6:7]
    v_add_u32 v47, 8, v47
    v_lshrrev_b32 v32, 2, v32
    s_mov_b64 exec, -1
    buffer_load_dwordx2 v[112:113], v47, s[8:11], 0 offen
    s_branch L2_ob118
L2_c119:
    s_lshl_b64 s[52:53], s[82:83], 1
    s_andn2_b64 s[52:53], s[52:53], s[80:81]
    s_andn2_b64 s[52:53], s[52:53], s[54:55]
    s_or_b64 s[80:81], s[80:81], s[52:53]
    s_not_b64 vcc, s[52:53]
    s_mov_b64 exec, -1
    v_cndmask_b32_dpp v84, v84, v84, vcc wave_shr:1 row_mask:0xf bank_mask:0xf
    v_cndmask_b32_dpp v85, v85, v85, vcc wave_shr:1 row_mask:0xf bank_mask:0xf
    s_lshr_b64 s[52:53], s[52:53], 1
    v_cndmask_b32_dpp v86, v86, v86, vcc wave_shr:1 row_mask:0xf bank_mask:0xf
    v_cndmask_b32_dpp v87, v87, v87, vcc wave_shr:1 row_mask:0xf bank_mask:0xf
    s_andn2_b64 s[82:83], s[82:83], s[52:53]
    v_cndmask_b32_dpp v7, v7, v7, vcc wave_shr:1 row_mask:0xf bank_mask:0xf
    s_mov_b64 exec, s[54:55]
    s_cbranch_scc0 L2_d119
    s_mov_b64 exec, s[82:83]
    s_nop 1
    v_mfma_f32_4x4x4_16b_bf16 v[88:91], v[12:13], v[84:85], 0
    s_nop 1
    v_mfma_f32_4x4x4_16b_bf16 v[88:91], v[10:11], v[86:87], v[88:91]
    s_nop 4
    v_cvt_pk_bf16_f32 v88, v88, v89
    v_cvt_pk_bf16_f32 v89, v90, v91
    ds_pk_add_bf16 v7, v88 offset:65408
    ds_pk_add_bf16 v7, v89 offset:65412
    s_mov_b64 exec, s[54:55]
    s_branch L2_d119
L2_c120:
    s_lshl_b64 s[52:53], s[82:83], 1
    s_andn2_b64 s[52:53], s[52:53], s[80:81]
    s_andn2_b64 s[52:53], s[52:53], s[50:51]
    s_or_b64 s[80:81], s[80:81], s[52:53]
    s_not_b64 vcc, s[52:53]
    s_mov_b64 exec, -1
    v_cndmask_b32_dpp v84, v84, v84, vcc wave_shr:1 row_mask:0xf bank_mask:0xf
    v_cndmask_b32_dpp v85, v85, v85, vcc wave_shr:1 row_mask:0xf bank_mask:0xf
    s_lshr_b64 s[52:53], s[52:53], 1
    v_cndmask_b32_dpp v86, v86, v86, vcc wave_shr:1 row_mask:0xf bank_mask:0xf
    v_cndmask_b32_dpp v87, v87, v87, vcc wave_shr:1 row_mask:0xf bank_mask:0xf
    s_andn2_b64 s[82:83], s[82:83], s[52:53]
    v_cndmask_b32_dpp v7, v7, v7, vcc wave_shr:1 row_mask:0xf bank_mask:0xf
    s_mov_b64 exec, s[50:51]
    s_cbranch_scc0 L2_d120
    s_mov_b64 exec, s[82:83]
    s_nop 1
    v_mfma_f32_4x4x4_16b_bf16 v[88:91], v[12:13], v[84:85], 0
    s_nop 1
    v_mfma_f32_4x4x4_16b_bf16 v[88:91], v[10:11], v[86:87], v[88:91]
    s_nop 4
    v_cvt_pk_bf16_f32 v88, v88, v89
    v_cvt_pk_bf16_f32 v89, v90, v91
    ds_pk_add_bf16 v7, v88 offset:65408
    ds_pk_add_bf16 v7, v89 offset:65412
    s_mov_b64 exec, s[50:51]
    s_branch L2_d120
L2_c121:
    s_lshl_b64 s[52:53], s[82:83], 1
    s_andn2_b64 s[52:53], s[52:53], s[80:81]
    s_andn2_b64 s[52:53], s[52:53], s[54:55]
    s_or_b64 s[80:81], s[80:81], s[52:53]
    s_not_b64 vcc, s[52:53]
    s_mov_b64 exec, -1
    v_cndmask_b32_dpp v84, v84, v84, vcc wave_shr:1 row_mask:0xf bank_mask:0xf
    v_cndmask_b32_dpp v85, v85, v85, vcc wave_shr:1 row_mask:0xf bank_mask:0xf
    s_lshr_b64 s[52:53], s[52:53], 1
    v_cndmask_b32_dpp v86, v86, v86, vcc wave_shr:1 row_mask:0xf bank_mask:0xf
    v_cndmask_b32_dpp v87, v87, v87, vcc wave_shr:1 row_mask:0xf bank_mask:0xf
    s_andn2_b64 s[82:83], s[82:83], s[52:53]
    v_cndmask_b32_dpp v7, v7, v7, vcc wave_shr:1 row_mask:0xf bank_mask:0xf
    s_mov_b64 exec, s[54:55]
    s_cbranch_scc0 L2_d121
    s_mov_b64 exec, s[82:83]
    s_nop 1
    v_mfma_f32_4x4x4_16b_bf16 v[88:91], v[12:13], v[84:85], 0
    s_nop 1
    v_mfma_f32_4x4x4_16b_bf16 v[88:91], v[10:11], v[86:87], v[88:91]
    s_nop 4
    v_cvt_pk_bf16_f32 v88, v88, v89
    v_cvt_pk_bf16_f32 v89, v90, v91
    ds_pk_add_bf16 v7, v88 offset:65408
    ds_pk_add_bf16 v7, v89 offset:65412
    s_mov_b64 exec, s[54:55]
    s_branch L2_d121
L2_c122:
    s_lshl_b64 s[52:53], s[82:83], 1
    s_andn2_b64 s[52:53], s[52:53], s[80:81]
    s_andn2_b64 s[52:53], s[52:53], s[50:51]
    s_or_b64 s[80:81], s[80:81], s[52:53]
    s_not_b64 vcc, s[52:53]
    s_mov_b64 exec, -1
    v_cndmask_b32_dpp v84, v84, v84, vcc wave_shr:1 row_mask:0xf bank_mask:0xf
    v_cndmask_b32_dpp v85, v85, v85, vcc wave_shr:1 row_mask:0xf bank_mask:0xf
    s_lshr_b64 s[52:53], s[52:53], 1
    v_cndmask_b32_dpp v86, v86, v86, vcc wave_shr:1 row_mask:0xf bank_mask:0xf
    v_cndmask_b32_dpp v87, v87, v87, vcc wave_shr:1 row_mask:0xf bank_mask:0xf
    s_andn2_b64 s[82:83], s[82:83], s[52:53]
    v_cndmask_b32_dpp v7, v7, v7, vcc wave_shr:1 row_mask:0xf bank_mask:0xf
    s_mov_b64 exec, s[50:51]
    s_cbranch_scc0 L2_d122
    s_mov_b64 exec, s[82:83]
    s_nop 1
    v_mfma_f32_4x4x4_16b_bf16 v[88:91], v[12:13], v[84:85], 0
    s_nop 1
    v_mfma_f32_4x4x4_16b_bf16 v[88:91], v[10:11], v[86:87], v[88:91]
    s_nop 4
    v_cvt_pk_bf16_f32 v88, v88, v89
    v_cvt_pk_bf16_f32 v89, v90, v91
    ds_pk_add_bf16 v7, v88 offset:65408
    ds_pk_add_bf16 v7, v89 offset:65412
    s_mov_b64 exec, s[50:51]
    s_branch L2_d122
L2_c123:
    s_lshl_b64 s[52:53], s[82:83], 1
    s_andn2_b64 s[52:53], s[52:53], s[80:81]
    s_andn2_b64 s[52:53], s[52:53], s[54:55]
    s_or_b64 s[80:81], s[80:81], s[52:53]
    s_not_b64 vcc, s[52:53]
    s_mov_b64 exec, -1
    v_cndmask_b32_dpp v84, v84, v84, vcc wave_shr:1 row_mask:0xf bank_mask:0xf
    v_cndmask_b32_dpp v85, v85, v85, vcc wave_shr:1 row_mask:0xf bank_mask:0xf
    s_lshr_b64 s[52:53], s[52:53], 1
    v_cndmask_b32_dpp v86, v86, v86, vcc wave_shr:1 row_mask:0xf bank_mask:0xf
    v_cndmask_b32_dpp v87, v87, v87, vcc wave_shr:1 row_mask:0xf bank_mask:0xf
    s_andn2_b64 s[82:83], s[82:83], s[52:53]
    v_cndmask_b32_dpp v7, v7, v7, vcc wave_shr:1 row_mask:0xf bank_mask:0xf
    s_mov_b64 exec, s[54:55]
    s_cbranch_scc0 L2_d123
    s_mov_b64 exec, s[82:83]
    s_nop 1
    v_mfma_f32_4x4x4_16b_bf16 v[88:91], v[12:13], v[84:85], 0
    s_nop 1
    v_mfma_f32_4x4x4_16b_bf16 v[88:91], v[10:11], v[86:87], v[88:91]
    s_nop 4
    v_cvt_pk_bf16_f32 v88, v88, v89
    v_cvt_pk_bf16_f32 v89, v90, v91
    ds_pk_add_bf16 v7, v88 offset:65408
    ds_pk_add_bf16 v7, v89 offset:65412
    s_mov_b64 exec, s[54:55]
    s_branch L2_d123
L2_c124:
    s_lshl_b64 s[52:53], s[82:83], 1
    s_andn2_b64 s[52:53], s[52:53], s[80:81]
    s_andn2_b64 s[52:53], s[52:53], s[50:51]
    s_or_b64 s[80:81], s[80:81], s[52:53]
    s_not_b64 vcc, s[52:53]
    s_mov_b64 exec, -1
    v_cndmask_b32_dpp v84, v84, v84, vcc wave_shr:1 row_mask:0xf bank_mask:0xf
    v_cndmask_b32_dpp v85, v85, v85, vcc wave_shr:1 row_mask:0xf bank_mask:0xf
    s_lshr_b64 s[52:53], s[52:53], 1
    v_cndmask_b32_dpp v86, v86, v86, vcc wave_shr:1 row_mask:0xf bank_mask:0xf
    v_cndmask_b32_dpp v87, v87, v87, vcc wave_shr:1 row_mask:0xf bank_mask:0xf
    s_andn2_b64 s[82:83], s[82:83], s[52:53]
    v_cndmask_b32_dpp v7, v7, v7, vcc wave_shr:1 row_mask:0xf bank_mask:0xf
    s_mov_b64 exec, s[50:51]
    s_cbranch_scc0 L2_d124
    s_mov_b64 exec, s[82:83]
    s_nop 1
    v_mfma_f32_4x4x4_16b_bf16 v[88:91], v[12:13], v[84:85], 0
    s_nop 1
    v_mfma_f32_4x4x4_16b_bf16 v[88:91], v[10:11], v[86:87], v[88:91]
    s_nop 4
    v_cvt_pk_bf16_f32 v88, v88, v89
    v_cvt_pk_bf16_f32 v89, v90, v91
    ds_pk_add_bf16 v7, v88 offset:65408
    ds_pk_add_bf16 v7, v89 offset:65412
    s_mov_b64 exec, s[50:51]
    s_branch L2_d124
L2_oa125:
    s_waitcnt vmcnt(3)
    s_mov_b64 exec, s[6:7]
    v_lshrrev_b32 v114, 16, v114
    s_mov_b64 exec, -1
    v_and_b32 v46, 0x10000000, v32
    v_cmpx_eq_u32 vcc, 0, v46
    v_lshrrev_b32 v47, 14, v112
    v_and_b32 v47, v5, v47
    ds_read_b64 v[96:97], v47
    v_perm_b32 v98, v112, v114, s44
    v_bitop3_b32 v99, v112, 0.5, -0.5 bitop3:0xa8
    v_bitop3_b32 v98, v6, v98, v99 bitop3:0xca
    v_and_b32 v47, v5, v112
    s_waitcnt lgkmcnt(0)
    v_mfma_f32_4x4x4_16b_bf16 v[88:91], v[8:9], v[96:97], 0
    s_nop 4
    v_mul_f32 v88, v98, v88
    v_mul_f32 v89, v98, v89
    v_mul_f32 v90, v98, v90
    v_mul_f32 v91, v98, v91
    v_cvt_pk_bf16_f32 v88, v88, v89
    v_cvt_pk_bf16_f32 v89, v90, v91
    ds_pk_add_bf16 v47, v88 offset:65408
    ds_pk_add_bf16 v47, v89 offset:65412
    s_mov_b64 exec, -1
    v_and_b32 v46, 0x20000000, v32
    v_cmpx_eq_u32 vcc, 0, v46
    v_lshrrev_b32 v47, 14, v113
    v_and_b32 v47, v5, v47
    ds_read_b64 v[96:97], v47
    v_perm_b32 v98, v113, v114, s45
    v_bitop3_b32 v99, v113, 0.5, -0.5 bitop3:0xa8
    v_bitop3_b32 v98, v6, v98, v99 bitop3:0xca
    v_and_b32 v47, v5, v113
    s_waitcnt lgkmcnt(0)
    v_mfma_f32_4x4x4_16b_bf16 v[88:91], v[8:9], v[96:97], 0
    s_nop 4
    v_mul_f32 v88, v98, v88
    v_mul_f32 v89, v98, v89
    v_mul_f32 v90, v98, v90
    v_mul_f32 v91, v98, v91
    v_cvt_pk_bf16_f32 v88, v88, v89
    v_cvt_pk_bf16_f32 v89, v90, v91
    ds_pk_add_bf16 v47, v88 offset:65408
    ds_pk_add_bf16 v47, v89 offset:65412
    s_mov_b64 exec, -1
    s_branch L2_ob125
L2_c126:
    s_lshl_b64 s[52:53], s[82:83], 1
    s_andn2_b64 s[52:53], s[52:53], s[80:81]
    s_andn2_b64 s[52:53], s[52:53], s[54:55]
    s_or_b64 s[80:81], s[80:81], s[52:53]
    s_not_b64 vcc, s[52:53]
    s_mov_b64 exec, -1
    v_cndmask_b32_dpp v84, v84, v84, vcc wave_shr:1 row_mask:0xf bank_mask:0xf
    v_cndmask_b32_dpp v85, v85, v85, vcc wave_shr:1 row_mask:0xf bank_mask:0xf
    s_lshr_b64 s[52:53], s[52:53], 1
    v_cndmask_b32_dpp v86, v86, v86, vcc wave_shr:1 row_mask:0xf bank_mask:0xf
    v_cndmask_b32_dpp v87, v87, v87, vcc wave_shr:1 row_mask:0xf bank_mask:0xf
    s_andn2_b64 s[82:83], s[82:83], s[52:53]
    v_cndmask_b32_dpp v7, v7, v7, vcc wave_shr:1 row_mask:0xf bank_mask:0xf
    s_mov_b64 exec, s[54:55]
    s_cbranch_scc0 L2_d126
    s_mov_b64 exec, s[82:83]
    s_nop 1
    v_mfma_f32_4x4x4_16b_bf16 v[88:91], v[12:13], v[84:85], 0
    s_nop 1
    v_mfma_f32_4x4x4_16b_bf16 v[88:91], v[10:11], v[86:87], v[88:91]
    s_nop 4
    v_cvt_pk_bf16_f32 v88, v88, v89
    v_cvt_pk_bf16_f32 v89, v90, v91
    ds_pk_add_bf16 v7, v88 offset:65408
    ds_pk_add_bf16 v7, v89 offset:65412
    s_mov_b64 exec, s[54:55]
    s_branch L2_d126
L2_c127:
    s_lshl_b64 s[52:53], s[82:83], 1
    s_andn2_b64 s[52:53], s[52:53], s[80:81]
    s_andn2_b64 s[52:53], s[52:53], s[50:51]
    s_or_b64 s[80:81], s[80:81], s[52:53]
    s_not_b64 vcc, s[52:53]
    s_mov_b64 exec, -1
    v_cndmask_b32_dpp v84, v84, v84, vcc wave_shr:1 row_mask:0xf bank_mask:0xf
    v_cndmask_b32_dpp v85, v85, v85, vcc wave_shr:1 row_mask:0xf bank_mask:0xf
    s_lshr_b64 s[52:53], s[52:53], 1
    v_cndmask_b32_dpp v86, v86, v86, vcc wave_shr:1 row_mask:0xf bank_mask:0xf
    v_cndmask_b32_dpp v87, v87, v87, vcc wave_shr:1 row_mask:0xf bank_mask:0xf
    s_andn2_b64 s[82:83], s[82:83], s[52:53]
    v_cndmask_b32_dpp v7, v7, v7, vcc wave_shr:1 row_mask:0xf bank_mask:0xf
    s_mov_b64 exec, s[50:51]
    s_cbranch_scc0 L2_d127
    s_mov_b64 exec, s[82:83]
    s_nop 1
    v_mfma_f32_4x4x4_16b_bf16 v[88:91], v[12:13], v[84:85], 0
    s_nop 1
    v_mfma_f32_4x4x4_16b_bf16 v[88:91], v[10:11], v[86:87], v[88:91]
    s_nop 4
    v_cvt_pk_bf16_f32 v88, v88, v89
    v_cvt_pk_bf16_f32 v89, v90, v91
    ds_pk_add_bf16 v7, v88 offset:65408
    ds_pk_add_bf16 v7, v89 offset:65412
    s_mov_b64 exec, s[50:51]
    s_branch L2_d127
L2_c128:
    s_lshl_b64 s[52:53], s[82:83], 1
    s_andn2_b64 s[52:53], s[52:53], s[80:81]
    s_andn2_b64 s[52:53], s[52:53], s[54:55]
    s_or_b64 s[80:81], s[80:81], s[52:53]
    s_not_b64 vcc, s[52:53]
    s_mov_b64 exec, -1
    v_cndmask_b32_dpp v84, v84, v84, vcc wave_shr:1 row_mask:0xf bank_mask:0xf
    v_cndmask_b32_dpp v85, v85, v85, vcc wave_shr:1 row_mask:0xf bank_mask:0xf
    s_lshr_b64 s[52:53], s[52:53], 1
    v_cndmask_b32_dpp v86, v86, v86, vcc wave_shr:1 row_mask:0xf bank_mask:0xf
    v_cndmask_b32_dpp v87, v87, v87, vcc wave_shr:1 row_mask:0xf bank_mask:0xf
    s_andn2_b64 s[82:83], s[82:83], s[52:53]
    v_cndmask_b32_dpp v7, v7, v7, vcc wave_shr:1 row_mask:0xf bank_mask:0xf
    s_mov_b64 exec, s[54:55]
    s_cbranch_scc0 L2_d128
    s_mov_b64 exec, s[82:83]
    s_nop 1
    v_mfma_f32_4x4x4_16b_bf16 v[88:91], v[12:13], v[84:85], 0
    s_nop 1
    v_mfma_f32_4x4x4_16b_bf16 v[88:91], v[10:11], v[86:87], v[88:91]
    s_nop 4
    v_cvt_pk_bf16_f32 v88, v88, v89
    v_cvt_pk_bf16_f32 v89, v90, v91
    ds_pk_add_bf16 v7, v88 offset:65408
    ds_pk_add_bf16 v7, v89 offset:65412
    s_mov_b64 exec, s[54:55]
    s_branch L2_d128
L2_c129:
    s_lshl_b64 s[52:53], s[82:83], 1
    s_andn2_b64 s[52:53], s[52:53], s[80:81]
    s_andn2_b64 s[52:53], s[52:53], s[50:51]
    s_or_b64 s[80:81], s[80:81], s[52:53]
    s_not_b64 vcc, s[52:53]
    s_mov_b64 exec, -1
    v_cndmask_b32_dpp v84, v84, v84, vcc wave_shr:1 row_mask:0xf bank_mask:0xf
    v_cndmask_b32_dpp v85, v85, v85, vcc wave_shr:1 row_mask:0xf bank_mask:0xf
    s_lshr_b64 s[52:53], s[52:53], 1
    v_cndmask_b32_dpp v86, v86, v86, vcc wave_shr:1 row_mask:0xf bank_mask:0xf
    v_cndmask_b32_dpp v87, v87, v87, vcc wave_shr:1 row_mask:0xf bank_mask:0xf
    s_andn2_b64 s[82:83], s[82:83], s[52:53]
    v_cndmask_b32_dpp v7, v7, v7, vcc wave_shr:1 row_mask:0xf bank_mask:0xf
    s_mov_b64 exec, s[50:51]
    s_cbranch_scc0 L2_d129
    s_mov_b64 exec, s[82:83]
    s_nop 1
    v_mfma_f32_4x4x4_16b_bf16 v[88:91], v[12:13], v[84:85], 0
    s_nop 1
    v_mfma_f32_4x4x4_16b_bf16 v[88:91], v[10:11], v[86:87], v[88:91]
    s_nop 4
    v_cvt_pk_bf16_f32 v88, v88, v89
    v_cvt_pk_bf16_f32 v89, v90, v91
    ds_pk_add_bf16 v7, v88 offset:65408
    ds_pk_add_bf16 v7, v89 offset:65412
    s_mov_b64 exec, s[50:51]
    s_branch L2_d129
L2_c130:
    s_lshl_b64 s[52:53], s[82:83], 1
    s_andn2_b64 s[52:53], s[52:53], s[80:81]
    s_andn2_b64 s[52:53], s[52:53], s[54:55]
    s_or_b64 s[80:81], s[80:81], s[52:53]
    s_not_b64 vcc, s[52:53]
    s_mov_b64 exec, -1
    v_cndmask_b32_dpp v84, v84, v84, vcc wave_shr:1 row_mask:0xf bank_mask:0xf
    v_cndmask_b32_dpp v85, v85, v85, vcc wave_shr:1 row_mask:0xf bank_mask:0xf
    s_lshr_b64 s[52:53], s[52:53], 1
    v_cndmask_b32_dpp v86, v86, v86, vcc wave_shr:1 row_mask:0xf bank_mask:0xf
    v_cndmask_b32_dpp v87, v87, v87, vcc wave_shr:1 row_mask:0xf bank_mask:0xf
    s_andn2_b64 s[82:83], s[82:83], s[52:53]
    v_cndmask_b32_dpp v7, v7, v7, vcc wave_shr:1 row_mask:0xf bank_mask:0xf
    s_mov_b64 exec, s[54:55]
    s_cbranch_scc0 L2_d130
    s_mov_b64 exec, s[82:83]
    s_nop 1
    v_mfma_f32_4x4x4_16b_bf16 v[88:91], v[12:13], v[84:85], 0
    s_nop 1
    v_mfma_f32_4x4x4_16b_bf16 v[88:91], v[10:11], v[86:87], v[88:91]
    s_nop 4
    v_cvt_pk_bf16_f32 v88, v88, v89
    v_cvt_pk_bf16_f32 v89, v90, v91
    ds_pk_add_bf16 v7, v88 offset:65408
    ds_pk_add_bf16 v7, v89 offset:65412
    s_mov_b64 exec, s[54:55]
    s_branch L2_d130
L2_c131:
    s_lshl_b64 s[52:53], s[82:83], 1
    s_andn2_b64 s[52:53], s[52:53], s[80:81]
    s_andn2_b64 s[52:53], s[52:53], s[50:51]
    s_or_b64 s[80:81], s[80:81], s[52:53]
    s_not_b64 vcc, s[52:53]
    s_mov_b64 exec, -1
    v_cndmask_b32_dpp v84, v84, v84, vcc wave_shr:1 row_mask:0xf bank_mask:0xf
    v_cndmask_b32_dpp v85, v85, v85, vcc wave_shr:1 row_mask:0xf bank_mask:0xf
    s_lshr_b64 s[52:53], s[52:53], 1
    v_cndmask_b32_dpp v86, v86, v86, vcc wave_shr:1 row_mask:0xf bank_mask:0xf
    v_cndmask_b32_dpp v87, v87, v87, vcc wave_shr:1 row_mask:0xf bank_mask:0xf
    s_andn2_b64 s[82:83], s[82:83], s[52:53]
    v_cndmask_b32_dpp v7, v7, v7, vcc wave_shr:1 row_mask:0xf bank_mask:0xf
    s_mov_b64 exec, s[50:51]
    s_cbranch_scc0 L2_d131
    s_mov_b64 exec, s[82:83]
    s_nop 1
    v_mfma_f32_4x4x4_16b_bf16 v[88:91], v[12:13], v[84:85], 0
    s_nop 1
    v_mfma_f32_4x4x4_16b_bf16 v[88:91], v[10:11], v[86:87], v[88:91]
    s_nop 4
    v_cvt_pk_bf16_f32 v88, v88, v89
    v_cvt_pk_bf16_f32 v89, v90, v91
    ds_pk_add_bf16 v7, v88 offset:65408
    ds_pk_add_bf16 v7, v89 offset:65412
    s_mov_b64 exec, s[50:51]
    s_branch L2_d131
L2_c132:
    s_lshl_b64 s[52:53], s[82:83], 1
    s_andn2_b64 s[52:53], s[52:53], s[80:81]
    s_andn2_b64 s[52:53], s[52:53], s[54:55]
    s_or_b64 s[80:81], s[80:81], s[52:53]
    s_not_b64 vcc, s[52:53]
    s_mov_b64 exec, -1
    v_cndmask_b32_dpp v84, v84, v84, vcc wave_shr:1 row_mask:0xf bank_mask:0xf
    v_cndmask_b32_dpp v85, v85, v85, vcc wave_shr:1 row_mask:0xf bank_mask:0xf
    s_lshr_b64 s[52:53], s[52:53], 1
    v_cndmask_b32_dpp v86, v86, v86, vcc wave_shr:1 row_mask:0xf bank_mask:0xf
    v_cndmask_b32_dpp v87, v87, v87, vcc wave_shr:1 row_mask:0xf bank_mask:0xf
    s_andn2_b64 s[82:83], s[82:83], s[52:53]
    v_cndmask_b32_dpp v7, v7, v7, vcc wave_shr:1 row_mask:0xf bank_mask:0xf
    s_mov_b64 exec, s[54:55]
    s_cbranch_scc0 L2_d132
    s_mov_b64 exec, s[82:83]
    s_nop 1
    v_mfma_f32_4x4x4_16b_bf16 v[88:91], v[12:13], v[84:85], 0
    s_nop 1
    v_mfma_f32_4x4x4_16b_bf16 v[88:91], v[10:11], v[86:87], v[88:91]
    s_nop 4
    v_cvt_pk_bf16_f32 v88, v88, v89
    v_cvt_pk_bf16_f32 v89, v90, v91
    ds_pk_add_bf16 v7, v88 offset:65408
    ds_pk_add_bf16 v7, v89 offset:65412
    s_mov_b64 exec, s[54:55]
    s_branch L2_d132
L2_c133:
    s_lshl_b64 s[52:53], s[82:83], 1
    s_andn2_b64 s[52:53], s[52:53], s[80:81]
    s_andn2_b64 s[52:53], s[52:53], s[50:51]
    s_or_b64 s[80:81], s[80:81], s[52:53]
    s_not_b64 vcc, s[52:53]
    s_mov_b64 exec, -1
    v_cndmask_b32_dpp v84, v84, v84, vcc wave_shr:1 row_mask:0xf bank_mask:0xf
    v_cndmask_b32_dpp v85, v85, v85, vcc wave_shr:1 row_mask:0xf bank_mask:0xf
    s_lshr_b64 s[52:53], s[52:53], 1
    v_cndmask_b32_dpp v86, v86, v86, vcc wave_shr:1 row_mask:0xf bank_mask:0xf
    v_cndmask_b32_dpp v87, v87, v87, vcc wave_shr:1 row_mask:0xf bank_mask:0xf
    s_andn2_b64 s[82:83], s[82:83], s[52:53]
    v_cndmask_b32_dpp v7, v7, v7, vcc wave_shr:1 row_mask:0xf bank_mask:0xf
    s_mov_b64 exec, s[50:51]
    s_cbranch_scc0 L2_d133
    s_mov_b64 exec, s[82:83]
    s_nop 1
    v_mfma_f32_4x4x4_16b_bf16 v[88:91], v[12:13], v[84:85], 0
    s_nop 1
    v_mfma_f32_4x4x4_16b_bf16 v[88:91], v[10:11], v[86:87], v[88:91]
    s_nop 4
    v_cvt_pk_bf16_f32 v88, v88, v89
    v_cvt_pk_bf16_f32 v89, v90, v91
    ds_pk_add_bf16 v7, v88 offset:65408
    ds_pk_add_bf16 v7, v89 offset:65412
    s_mov_b64 exec, s[50:51]
    s_branch L2_d133
L2_oa134:
    v_and_b32 v47, 0x0fffffff, v33
    buffer_load_dword v114, v47, s[8:11], 0 offen offset:16
    s_mov_b64 exec, s[6:7]
    v_add_u32 v47, 8, v47
    v_lshrrev_b32 v33, 2, v33
    s_mov_b64 exec, -1
    buffer_load_dwordx2 v[112:113], v47, s[8:11], 0 offen
    s_branch L2_ob134
L2_c135:
    s_lshl_b64 s[52:53], s[82:83], 1
    s_andn2_b64 s[52:53], s[52:53], s[80:81]
    s_andn2_b64 s[52:53], s[52:53], s[54:55]
    s_or_b64 s[80:81], s[80:81], s[52:53]
    s_not_b64 vcc, s[52:53]
    s_mov_b64 exec, -1
    v_cndmask_b32_dpp v84, v84, v84, vcc wave_shr:1 row_mask:0xf bank_mask:0xf
    v_cndmask_b32_dpp v85, v85, v85, vcc wave_shr:1 row_mask:0xf bank_mask:0xf
    s_lshr_b64 s[52:53], s[52:53], 1
    v_cndmask_b32_dpp v86, v86, v86, vcc wave_shr:1 row_mask:0xf bank_mask:0xf
    v_cndmask_b32_dpp v87, v87, v87, vcc wave_shr:1 row_mask:0xf bank_mask:0xf
    s_andn2_b64 s[82:83], s[82:83], s[52:53]
    v_cndmask_b32_dpp v7, v7, v7, vcc wave_shr:1 row_mask:0xf bank_mask:0xf
    s_mov_b64 exec, s[54:55]
    s_cbranch_scc0 L2_d135
    s_mov_b64 exec, s[82:83]
    s_nop 1
    v_mfma_f32_4x4x4_16b_bf16 v[88:91], v[12:13], v[84:85], 0
    s_nop 1
    v_mfma_f32_4x4x4_16b_bf16 v[88:91], v[10:11], v[86:87], v[88:91]
    s_nop 4
    v_cvt_pk_bf16_f32 v88, v88, v89
    v_cvt_pk_bf16_f32 v89, v90, v91
    ds_pk_add_bf16 v7, v88 offset:65408
    ds_pk_add_bf16 v7, v89 offset:65412
    s_mov_b64 exec, s[54:55]
    s_branch L2_d135
L2_c136:
    s_lshl_b64 s[52:53], s[82:83], 1
    s_andn2_b64 s[52:53], s[52:53], s[80:81]
    s_andn2_b64 s[52:53], s[52:53], s[50:51]
    s_or_b64 s[80:81], s[80:81], s[52:53]
    s_not_b64 vcc, s[52:53]
    s_mov_b64 exec, -1
    v_cndmask_b32_dpp v84, v84, v84, vcc wave_shr:1 row_mask:0xf bank_mask:0xf
    v_cndmask_b32_dpp v85, v85, v85, vcc wave_shr:1 row_mask:0xf bank_mask:0xf
    s_lshr_b64 s[52:53], s[52:53], 1
    v_cndmask_b32_dpp v86, v86, v86, vcc wave_shr:1 row_mask:0xf bank_mask:0xf
    v_cndmask_b32_dpp v87, v87, v87, vcc wave_shr:1 row_mask:0xf bank_mask:0xf
    s_andn2_b64 s[82:83], s[82:83], s[52:53]
    v_cndmask_b32_dpp v7, v7, v7, vcc wave_shr:1 row_mask:0xf bank_mask:0xf
    s_mov_b64 exec, s[50:51]
    s_cbranch_scc0 L2_d136
    s_mov_b64 exec, s[82:83]
    s_nop 1
    v_mfma_f32_4x4x4_16b_bf16 v[88:91], v[12:13], v[84:85], 0
    s_nop 1
    v_mfma_f32_4x4x4_16b_bf16 v[88:91], v[10:11], v[86:87], v[88:91]
    s_nop 4
    v_cvt_pk_bf16_f32 v88, v88, v89
    v_cvt_pk_bf16_f32 v89, v90, v91
    ds_pk_add_bf16 v7, v88 offset:65408
    ds_pk_add_bf16 v7, v89 offset:65412
    s_mov_b64 exec, s[50:51]
    s_branch L2_d136
L2_c137:
    s_lshl_b64 s[52:53], s[82:83], 1
    s_andn2_b64 s[52:53], s[52:53], s[80:81]
    s_andn2_b64 s[52:53], s[52:53], s[54:55]
    s_or_b64 s[80:81], s[80:81], s[52:53]
    s_not_b64 vcc, s[52:53]
    s_mov_b64 exec, -1
    v_cndmask_b32_dpp v84, v84, v84, vcc wave_shr:1 row_mask:0xf bank_mask:0xf
    v_cndmask_b32_dpp v85, v85, v85, vcc wave_shr:1 row_mask:0xf bank_mask:0xf
    s_lshr_b64 s[52:53], s[52:53], 1
    v_cndmask_b32_dpp v86, v86, v86, vcc wave_shr:1 row_mask:0xf bank_mask:0xf
    v_cndmask_b32_dpp v87, v87, v87, vcc wave_shr:1 row_mask:0xf bank_mask:0xf
    s_andn2_b64 s[82:83], s[82:83], s[52:53]
    v_cndmask_b32_dpp v7, v7, v7, vcc wave_shr:1 row_mask:0xf bank_mask:0xf
    s_mov_b64 exec, s[54:55]
    s_cbranch_scc0 L2_d137
    s_mov_b64 exec, s[82:83]
    s_nop 1
    v_mfma_f32_4x4x4_16b_bf16 v[88:91], v[12:13], v[84:85], 0
    s_nop 1
    v_mfma_f32_4x4x4_16b_bf16 v[88:91], v[10:11], v[86:87], v[88:91]
    s_nop 4
    v_cvt_pk_bf16_f32 v88, v88, v89
    v_cvt_pk_bf16_f32 v89, v90, v91
    ds_pk_add_bf16 v7, v88 offset:65408
    ds_pk_add_bf16 v7, v89 offset:65412
    s_mov_b64 exec, s[54:55]
    s_branch L2_d137
L2_c138:
    s_lshl_b64 s[52:53], s[82:83], 1
    s_andn2_b64 s[52:53], s[52:53], s[80:81]
    s_andn2_b64 s[52:53], s[52:53], s[50:51]
    s_or_b64 s[80:81], s[80:81], s[52:53]
    s_not_b64 vcc, s[52:53]
    s_mov_b64 exec, -1
    v_cndmask_b32_dpp v84, v84, v84, vcc wave_shr:1 row_mask:0xf bank_mask:0xf
    v_cndmask_b32_dpp v85, v85, v85, vcc wave_shr:1 row_mask:0xf bank_mask:0xf
    s_lshr_b64 s[52:53], s[52:53], 1
    v_cndmask_b32_dpp v86, v86, v86, vcc wave_shr:1 row_mask:0xf bank_mask:0xf
    v_cndmask_b32_dpp v87, v87, v87, vcc wave_shr:1 row_mask:0xf bank_mask:0xf
    s_andn2_b64 s[82:83], s[82:83], s[52:53]
    v_cndmask_b32_dpp v7, v7, v7, vcc wave_shr:1 row_mask:0xf bank_mask:0xf
    s_mov_b64 exec, s[50:51]
    s_cbranch_scc0 L2_d138
    s_mov_b64 exec, s[82:83]
    s_nop 1
    v_mfma_f32_4x4x4_16b_bf16 v[88:91], v[12:13], v[84:85], 0
    s_nop 1
    v_mfma_f32_4x4x4_16b_bf16 v[88:91], v[10:11], v[86:87], v[88:91]
    s_nop 4
    v_cvt_pk_bf16_f32 v88, v88, v89
    v_cvt_pk_bf16_f32 v89, v90, v91
    ds_pk_add_bf16 v7, v88 offset:65408
    ds_pk_add_bf16 v7, v89 offset:65412
    s_mov_b64 exec, s[50:51]
    s_branch L2_d138
L2_c139:
    s_lshl_b64 s[52:53], s[82:83], 1
    s_andn2_b64 s[52:53], s[52:53], s[80:81]
    s_andn2_b64 s[52:53], s[52:53], s[54:55]
    s_or_b64 s[80:81], s[80:81], s[52:53]
    s_not_b64 vcc, s[52:53]
    s_mov_b64 exec, -1
    v_cndmask_b32_dpp v84, v84, v84, vcc wave_shr:1 row_mask:0xf bank_mask:0xf
    v_cndmask_b32_dpp v85, v85, v85, vcc wave_shr:1 row_mask:0xf bank_mask:0xf
    s_lshr_b64 s[52:53], s[52:53], 1
    v_cndmask_b32_dpp v86, v86, v86, vcc wave_shr:1 row_mask:0xf bank_mask:0xf
    v_cndmask_b32_dpp v87, v87, v87, vcc wave_shr:1 row_mask:0xf bank_mask:0xf
    s_andn2_b64 s[82:83], s[82:83], s[52:53]
    v_cndmask_b32_dpp v7, v7, v7, vcc wave_shr:1 row_mask:0xf bank_mask:0xf
    s_mov_b64 exec, s[54:55]
    s_cbranch_scc0 L2_d139
    s_mov_b64 exec, s[82:83]
    s_nop 1
    v_mfma_f32_4x4x4_16b_bf16 v[88:91], v[12:13], v[84:85], 0
    s_nop 1
    v_mfma_f32_4x4x4_16b_bf16 v[88:91], v[10:11], v[86:87], v[88:91]
    s_nop 4
    v_cvt_pk_bf16_f32 v88, v88, v89
    v_cvt_pk_bf16_f32 v89, v90, v91
    ds_pk_add_bf16 v7, v88 offset:65408
    ds_pk_add_bf16 v7, v89 offset:65412
    s_mov_b64 exec, s[54:55]
    s_branch L2_d139
L2_c140:
    s_lshl_b64 s[52:53], s[82:83], 1
    s_andn2_b64 s[52:53], s[52:53], s[80:81]
    s_andn2_b64 s[52:53], s[52:53], s[50:51]
    s_or_b64 s[80:81], s[80:81], s[52:53]
    s_not_b64 vcc, s[52:53]
    s_mov_b64 exec, -1
    v_cndmask_b32_dpp v84, v84, v84, vcc wave_shr:1 row_mask:0xf bank_mask:0xf
    v_cndmask_b32_dpp v85, v85, v85, vcc wave_shr:1 row_mask:0xf bank_mask:0xf
    s_lshr_b64 s[52:53], s[52:53], 1
    v_cndmask_b32_dpp v86, v86, v86, vcc wave_shr:1 row_mask:0xf bank_mask:0xf
    v_cndmask_b32_dpp v87, v87, v87, vcc wave_shr:1 row_mask:0xf bank_mask:0xf
    s_andn2_b64 s[82:83], s[82:83], s[52:53]
    v_cndmask_b32_dpp v7, v7, v7, vcc wave_shr:1 row_mask:0xf bank_mask:0xf
    s_mov_b64 exec, s[50:51]
    s_cbranch_scc0 L2_d140
    s_mov_b64 exec, s[82:83]
    s_nop 1
    v_mfma_f32_4x4x4_16b_bf16 v[88:91], v[12:13], v[84:85], 0
    s_nop 1
    v_mfma_f32_4x4x4_16b_bf16 v[88:91], v[10:11], v[86:87], v[88:91]
    s_nop 4
    v_cvt_pk_bf16_f32 v88, v88, v89
    v_cvt_pk_bf16_f32 v89, v90, v91
    ds_pk_add_bf16 v7, v88 offset:65408
    ds_pk_add_bf16 v7, v89 offset:65412
    s_mov_b64 exec, s[50:51]
    s_branch L2_d140
L2_oa141:
    s_waitcnt vmcnt(0)
    s_mov_b64 exec, s[6:7]
    v_lshrrev_b32 v114, 16, v114
    s_mov_b64 exec, -1
    v_and_b32 v46, 0x10000000, v33
    v_cmpx_eq_u32 vcc, 0, v46
    v_lshrrev_b32 v47, 14, v112
    v_and_b32 v47, v5, v47
    ds_read_b64 v[96:97], v47
    v_perm_b32 v98, v112, v114, s44
    v_bitop3_b32 v99, v112, 0.5, -0.5 bitop3:0xa8
    v_bitop3_b32 v98, v6, v98, v99 bitop3:0xca
    v_and_b32 v47, v5, v112
    s_waitcnt lgkmcnt(0)
    v_mfma_f32_4x4x4_16b_bf16 v[88:91], v[8:9], v[96:97], 0
    s_nop 4
    v_mul_f32 v88, v98, v88
    v_mul_f32 v89, v98, v89
    v_mul_f32 v90, v98, v90
    v_mul_f32 v91, v98, v91
    v_cvt_pk_bf16_f32 v88, v88, v89
    v_cvt_pk_bf16_f32 v89, v90, v91
    ds_pk_add_bf16 v47, v88 offset:65408
    ds_pk_add_bf16 v47, v89 offset:65412
    s_mov_b64 exec, -1
    v_and_b32 v46, 0x20000000, v33
    v_cmpx_eq_u32 vcc, 0, v46
    v_lshrrev_b32 v47, 14, v113
    v_and_b32 v47, v5, v47
    ds_read_b64 v[96:97], v47
    v_perm_b32 v98, v113, v114, s45
    v_bitop3_b32 v99, v113, 0.5, -0.5 bitop3:0xa8
    v_bitop3_b32 v98, v6, v98, v99 bitop3:0xca
    v_and_b32 v47, v5, v113
    s_waitcnt lgkmcnt(0)
    v_mfma_f32_4x4x4_16b_bf16 v[88:91], v[8:9], v[96:97], 0
    s_nop 4
    v_mul_f32 v88, v98, v88
    v_mul_f32 v89, v98, v89
    v_mul_f32 v90, v98, v90
    v_mul_f32 v91, v98, v91
    v_cvt_pk_bf16_f32 v88, v88, v89
    v_cvt_pk_bf16_f32 v89, v90, v91
    ds_pk_add_bf16 v47, v88 offset:65408
    ds_pk_add_bf16 v47, v89 offset:65412
    s_mov_b64 exec, -1
    s_branch L2_ob141
L2_c142:
    s_lshl_b64 s[52:53], s[82:83], 1
    s_andn2_b64 s[52:53], s[52:53], s[80:81]
    s_andn2_b64 s[52:53], s[52:53], s[54:55]
    s_or_b64 s[80:81], s[80:81], s[52:53]
    s_not_b64 vcc, s[52:53]
    s_mov_b64 exec, -1
    v_cndmask_b32_dpp v84, v84, v84, vcc wave_shr:1 row_mask:0xf bank_mask:0xf
    v_cndmask_b32_dpp v85, v85, v85, vcc wave_shr:1 row_mask:0xf bank_mask:0xf
    s_lshr_b64 s[52:53], s[52:53], 1
    v_cndmask_b32_dpp v86, v86, v86, vcc wave_shr:1 row_mask:0xf bank_mask:0xf
    v_cndmask_b32_dpp v87, v87, v87, vcc wave_shr:1 row_mask:0xf bank_mask:0xf
    s_andn2_b64 s[82:83], s[82:83], s[52:53]
    v_cndmask_b32_dpp v7, v7, v7, vcc wave_shr:1 row_mask:0xf bank_mask:0xf
    s_mov_b64 exec, s[54:55]
    s_cbranch_scc0 L2_d142
    s_mov_b64 exec, s[82:83]
    s_nop 1
    v_mfma_f32_4x4x4_16b_bf16 v[88:91], v[12:13], v[84:85], 0
    s_nop 1
    v_mfma_f32_4x4x4_16b_bf16 v[88:91], v[10:11], v[86:87], v[88:91]
    s_nop 4
    v_cvt_pk_bf16_f32 v88, v88, v89
    v_cvt_pk_bf16_f32 v89, v90, v91
    ds_pk_add_bf16 v7, v88 offset:65408
    ds_pk_add_bf16 v7, v89 offset:65412
    s_mov_b64 exec, s[54:55]
    s_branch L2_d142
L2_c143:
    s_lshl_b64 s[52:53], s[82:83], 1
    s_andn2_b64 s[52:53], s[52:53], s[80:81]
    s_andn2_b64 s[52:53], s[52:53], s[50:51]
    s_or_b64 s[80:81], s[80:81], s[52:53]
    s_not_b64 vcc, s[52:53]
    s_mov_b64 exec, -1
    v_cndmask_b32_dpp v84, v84, v84, vcc wave_shr:1 row_mask:0xf bank_mask:0xf
    v_cndmask_b32_dpp v85, v85, v85, vcc wave_shr:1 row_mask:0xf bank_mask:0xf
    s_lshr_b64 s[52:53], s[52:53], 1
    v_cndmask_b32_dpp v86, v86, v86, vcc wave_shr:1 row_mask:0xf bank_mask:0xf
    v_cndmask_b32_dpp v87, v87, v87, vcc wave_shr:1 row_mask:0xf bank_mask:0xf
    s_andn2_b64 s[82:83], s[82:83], s[52:53]
    v_cndmask_b32_dpp v7, v7, v7, vcc wave_shr:1 row_mask:0xf bank_mask:0xf
    s_mov_b64 exec, s[50:51]
    s_cbranch_scc0 L2_d143
    s_mov_b64 exec, s[82:83]
    s_nop 1
    v_mfma_f32_4x4x4_16b_bf16 v[88:91], v[12:13], v[84:85], 0
    s_nop 1
    v_mfma_f32_4x4x4_16b_bf16 v[88:91], v[10:11], v[86:87], v[88:91]
    s_nop 4
    v_cvt_pk_bf16_f32 v88, v88, v89
    v_cvt_pk_bf16_f32 v89, v90, v91
    ds_pk_add_bf16 v7, v88 offset:65408
    ds_pk_add_bf16 v7, v89 offset:65412
    s_mov_b64 exec, s[50:51]
    s_branch L2_d143
L2_c144:
    s_lshl_b64 s[52:53], s[82:83], 1
    s_andn2_b64 s[52:53], s[52:53], s[80:81]
    s_andn2_b64 s[52:53], s[52:53], s[54:55]
    s_or_b64 s[80:81], s[80:81], s[52:53]
    s_not_b64 vcc, s[52:53]
    s_mov_b64 exec, -1
    v_cndmask_b32_dpp v84, v84, v84, vcc wave_shr:1 row_mask:0xf bank_mask:0xf
    v_cndmask_b32_dpp v85, v85, v85, vcc wave_shr:1 row_mask:0xf bank_mask:0xf
    s_lshr_b64 s[52:53], s[52:53], 1
    v_cndmask_b32_dpp v86, v86, v86, vcc wave_shr:1 row_mask:0xf bank_mask:0xf
    v_cndmask_b32_dpp v87, v87, v87, vcc wave_shr:1 row_mask:0xf bank_mask:0xf
    s_andn2_b64 s[82:83], s[82:83], s[52:53]
    v_cndmask_b32_dpp v7, v7, v7, vcc wave_shr:1 row_mask:0xf bank_mask:0xf
    s_mov_b64 exec, s[54:55]
    s_cbranch_scc0 L2_d144
    s_mov_b64 exec, s[82:83]
    s_nop 1
    v_mfma_f32_4x4x4_16b_bf16 v[88:91], v[12:13], v[84:85], 0
    s_nop 1
    v_mfma_f32_4x4x4_16b_bf16 v[88:91], v[10:11], v[86:87], v[88:91]
    s_nop 4
    v_cvt_pk_bf16_f32 v88, v88, v89
    v_cvt_pk_bf16_f32 v89, v90, v91
    ds_pk_add_bf16 v7, v88 offset:65408
    ds_pk_add_bf16 v7, v89 offset:65412
    s_mov_b64 exec, s[54:55]
    s_branch L2_d144
L2_c145:
    s_lshl_b64 s[52:53], s[82:83], 1
    s_andn2_b64 s[52:53], s[52:53], s[80:81]
    s_andn2_b64 s[52:53], s[52:53], s[50:51]
    s_or_b64 s[80:81], s[80:81], s[52:53]
    s_not_b64 vcc, s[52:53]
    s_mov_b64 exec, -1
    v_cndmask_b32_dpp v84, v84, v84, vcc wave_shr:1 row_mask:0xf bank_mask:0xf
    v_cndmask_b32_dpp v85, v85, v85, vcc wave_shr:1 row_mask:0xf bank_mask:0xf
    s_lshr_b64 s[52:53], s[52:53], 1
    v_cndmask_b32_dpp v86, v86, v86, vcc wave_shr:1 row_mask:0xf bank_mask:0xf
    v_cndmask_b32_dpp v87, v87, v87, vcc wave_shr:1 row_mask:0xf bank_mask:0xf
    s_andn2_b64 s[82:83], s[82:83], s[52:53]
    v_cndmask_b32_dpp v7, v7, v7, vcc wave_shr:1 row_mask:0xf bank_mask:0xf
    s_mov_b64 exec, s[50:51]
    s_cbranch_scc0 L2_d145
    s_mov_b64 exec, s[82:83]
    s_nop 1
    v_mfma_f32_4x4x4_16b_bf16 v[88:91], v[12:13], v[84:85], 0
    s_nop 1
    v_mfma_f32_4x4x4_16b_bf16 v[88:91], v[10:11], v[86:87], v[88:91]
    s_nop 4
    v_cvt_pk_bf16_f32 v88, v88, v89
    v_cvt_pk_bf16_f32 v89, v90, v91
    ds_pk_add_bf16 v7, v88 offset:65408
    ds_pk_add_bf16 v7, v89 offset:65412
    s_mov_b64 exec, s[50:51]
    s_branch L2_d145
L2_c146:
    s_lshl_b64 s[52:53], s[82:83], 1
    s_andn2_b64 s[52:53], s[52:53], s[80:81]
    s_andn2_b64 s[52:53], s[52:53], s[54:55]
    s_or_b64 s[80:81], s[80:81], s[52:53]
    s_not_b64 vcc, s[52:53]
    s_mov_b64 exec, -1
    v_cndmask_b32_dpp v84, v84, v84, vcc wave_shr:1 row_mask:0xf bank_mask:0xf
    v_cndmask_b32_dpp v85, v85, v85, vcc wave_shr:1 row_mask:0xf bank_mask:0xf
    s_lshr_b64 s[52:53], s[52:53], 1
    v_cndmask_b32_dpp v86, v86, v86, vcc wave_shr:1 row_mask:0xf bank_mask:0xf
    v_cndmask_b32_dpp v87, v87, v87, vcc wave_shr:1 row_mask:0xf bank_mask:0xf
    s_andn2_b64 s[82:83], s[82:83], s[52:53]
    v_cndmask_b32_dpp v7, v7, v7, vcc wave_shr:1 row_mask:0xf bank_mask:0xf
    s_mov_b64 exec, s[54:55]
    s_cbranch_scc0 L2_d146
    s_mov_b64 exec, s[82:83]
    s_nop 1
    v_mfma_f32_4x4x4_16b_bf16 v[88:91], v[12:13], v[84:85], 0
    s_nop 1
    v_mfma_f32_4x4x4_16b_bf16 v[88:91], v[10:11], v[86:87], v[88:91]
    s_nop 4
    v_cvt_pk_bf16_f32 v88, v88, v89
    v_cvt_pk_bf16_f32 v89, v90, v91
    ds_pk_add_bf16 v7, v88 offset:65408
    ds_pk_add_bf16 v7, v89 offset:65412
    s_mov_b64 exec, s[54:55]
    s_branch L2_d146
L2_c147:
    s_lshl_b64 s[52:53], s[82:83], 1
    s_andn2_b64 s[52:53], s[52:53], s[80:81]
    s_andn2_b64 s[52:53], s[52:53], s[50:51]
    s_or_b64 s[80:81], s[80:81], s[52:53]
    s_not_b64 vcc, s[52:53]
    s_mov_b64 exec, -1
    v_cndmask_b32_dpp v84, v84, v84, vcc wave_shr:1 row_mask:0xf bank_mask:0xf
    v_cndmask_b32_dpp v85, v85, v85, vcc wave_shr:1 row_mask:0xf bank_mask:0xf
    s_lshr_b64 s[52:53], s[52:53], 1
    v_cndmask_b32_dpp v86, v86, v86, vcc wave_shr:1 row_mask:0xf bank_mask:0xf
    v_cndmask_b32_dpp v87, v87, v87, vcc wave_shr:1 row_mask:0xf bank_mask:0xf
    s_andn2_b64 s[82:83], s[82:83], s[52:53]
    v_cndmask_b32_dpp v7, v7, v7, vcc wave_shr:1 row_mask:0xf bank_mask:0xf
    s_mov_b64 exec, s[50:51]
    s_cbranch_scc0 L2_d147
    s_mov_b64 exec, s[82:83]
    s_nop 1
    v_mfma_f32_4x4x4_16b_bf16 v[88:91], v[12:13], v[84:85], 0
    s_nop 1
    v_mfma_f32_4x4x4_16b_bf16 v[88:91], v[10:11], v[86:87], v[88:91]
    s_nop 4
    v_cvt_pk_bf16_f32 v88, v88, v89
    v_cvt_pk_bf16_f32 v89, v90, v91
    ds_pk_add_bf16 v7, v88 offset:65408
    ds_pk_add_bf16 v7, v89 offset:65412
    s_mov_b64 exec, s[50:51]
    s_branch L2_d147
L2_c148:
    s_lshl_b64 s[52:53], s[82:83], 1
    s_andn2_b64 s[52:53], s[52:53], s[80:81]
    s_andn2_b64 s[52:53], s[52:53], s[54:55]
    s_or_b64 s[80:81], s[80:81], s[52:53]
    s_not_b64 vcc, s[52:53]
    s_mov_b64 exec, -1
    v_cndmask_b32_dpp v84, v84, v84, vcc wave_shr:1 row_mask:0xf bank_mask:0xf
    v_cndmask_b32_dpp v85, v85, v85, vcc wave_shr:1 row_mask:0xf bank_mask:0xf
    s_lshr_b64 s[52:53], s[52:53], 1
    v_cndmask_b32_dpp v86, v86, v86, vcc wave_shr:1 row_mask:0xf bank_mask:0xf
    v_cndmask_b32_dpp v87, v87, v87, vcc wave_shr:1 row_mask:0xf bank_mask:0xf
    s_andn2_b64 s[82:83], s[82:83], s[52:53]
    v_cndmask_b32_dpp v7, v7, v7, vcc wave_shr:1 row_mask:0xf bank_mask:0xf
    s_mov_b64 exec, s[54:55]
    s_cbranch_scc0 L2_d148
    s_mov_b64 exec, s[82:83]
    s_nop 1
    v_mfma_f32_4x4x4_16b_bf16 v[88:91], v[12:13], v[84:85], 0
    s_nop 1
    v_mfma_f32_4x4x4_16b_bf16 v[88:91], v[10:11], v[86:87], v[88:91]
    s_nop 4
    v_cvt_pk_bf16_f32 v88, v88, v89
    v_cvt_pk_bf16_f32 v89, v90, v91
    ds_pk_add_bf16 v7, v88 offset:65408
    ds_pk_add_bf16 v7, v89 offset:65412
    s_mov_b64 exec, s[54:55]
    s_branch L2_d148
L2_c149:
    s_lshl_b64 s[52:53], s[82:83], 1
    s_andn2_b64 s[52:53], s[52:53], s[80:81]
    s_andn2_b64 s[52:53], s[52:53], s[50:51]
    s_or_b64 s[80:81], s[80:81], s[52:53]
    s_not_b64 vcc, s[52:53]
    s_mov_b64 exec, -1
    v_cndmask_b32_dpp v84, v84, v84, vcc wave_shr:1 row_mask:0xf bank_mask:0xf
    v_cndmask_b32_dpp v85, v85, v85, vcc wave_shr:1 row_mask:0xf bank_mask:0xf
    s_lshr_b64 s[52:53], s[52:53], 1
    v_cndmask_b32_dpp v86, v86, v86, vcc wave_shr:1 row_mask:0xf bank_mask:0xf
    v_cndmask_b32_dpp v87, v87, v87, vcc wave_shr:1 row_mask:0xf bank_mask:0xf
    s_andn2_b64 s[82:83], s[82:83], s[52:53]
    v_cndmask_b32_dpp v7, v7, v7, vcc wave_shr:1 row_mask:0xf bank_mask:0xf
    s_mov_b64 exec, s[50:51]
    s_cbranch_scc0 L2_d149
    s_mov_b64 exec, s[82:83]
    s_nop 1
    v_mfma_f32_4x4x4_16b_bf16 v[88:91], v[12:13], v[84:85], 0
    s_nop 1
    v_mfma_f32_4x4x4_16b_bf16 v[88:91], v[10:11], v[86:87], v[88:91]
    s_nop 4
    v_cvt_pk_bf16_f32 v88, v88, v89
    v_cvt_pk_bf16_f32 v89, v90, v91
    ds_pk_add_bf16 v7, v88 offset:65408
    ds_pk_add_bf16 v7, v89 offset:65412
    s_mov_b64 exec, s[50:51]
    s_branch L2_d149
L2_c150:
    s_lshl_b64 s[52:53], s[82:83], 1
    s_andn2_b64 s[52:53], s[52:53], s[80:81]
    s_andn2_b64 s[52:53], s[52:53], s[54:55]
    s_or_b64 s[80:81], s[80:81], s[52:53]
    s_not_b64 vcc, s[52:53]
    s_mov_b64 exec, -1
    v_cndmask_b32_dpp v84, v84, v84, vcc wave_shr:1 row_mask:0xf bank_mask:0xf
    v_cndmask_b32_dpp v85, v85, v85, vcc wave_shr:1 row_mask:0xf bank_mask:0xf
    s_lshr_b64 s[52:53], s[52:53], 1
    v_cndmask_b32_dpp v86, v86, v86, vcc wave_shr:1 row_mask:0xf bank_mask:0xf
    v_cndmask_b32_dpp v87, v87, v87, vcc wave_shr:1 row_mask:0xf bank_mask:0xf
    s_andn2_b64 s[82:83], s[82:83], s[52:53]
    v_cndmask_b32_dpp v7, v7, v7, vcc wave_shr:1 row_mask:0xf bank_mask:0xf
    s_mov_b64 exec, s[54:55]
    s_cbranch_scc0 L2_d150
    s_mov_b64 exec, s[82:83]
    s_nop 1
    v_mfma_f32_4x4x4_16b_bf16 v[88:91], v[12:13], v[84:85], 0
    s_nop 1
    v_mfma_f32_4x4x4_16b_bf16 v[88:91], v[10:11], v[86:87], v[88:91]
    s_nop 4
    v_cvt_pk_bf16_f32 v88, v88, v89
    v_cvt_pk_bf16_f32 v89, v90, v91
    ds_pk_add_bf16 v7, v88 offset:65408
    ds_pk_add_bf16 v7, v89 offset:65412
    s_mov_b64 exec, s[54:55]
    s_branch L2_d150
L2_c151:
    s_lshl_b64 s[52:53], s[82:83], 1
    s_andn2_b64 s[52:53], s[52:53], s[80:81]
    s_andn2_b64 s[52:53], s[52:53], s[50:51]
    s_or_b64 s[80:81], s[80:81], s[52:53]
    s_not_b64 vcc, s[52:53]
    s_mov_b64 exec, -1
    v_cndmask_b32_dpp v84, v84, v84, vcc wave_shr:1 row_mask:0xf bank_mask:0xf
    v_cndmask_b32_dpp v85, v85, v85, vcc wave_shr:1 row_mask:0xf bank_mask:0xf
    s_lshr_b64 s[52:53], s[52:53], 1
    v_cndmask_b32_dpp v86, v86, v86, vcc wave_shr:1 row_mask:0xf bank_mask:0xf
    v_cndmask_b32_dpp v87, v87, v87, vcc wave_shr:1 row_mask:0xf bank_mask:0xf
    s_andn2_b64 s[82:83], s[82:83], s[52:53]
    v_cndmask_b32_dpp v7, v7, v7, vcc wave_shr:1 row_mask:0xf bank_mask:0xf
    s_mov_b64 exec, s[50:51]
    s_cbranch_scc0 L2_d151
    s_mov_b64 exec, s[82:83]
    s_nop 1
    v_mfma_f32_4x4x4_16b_bf16 v[88:91], v[12:13], v[84:85], 0
    s_nop 1
    v_mfma_f32_4x4x4_16b_bf16 v[88:91], v[10:11], v[86:87], v[88:91]
    s_nop 4
    v_cvt_pk_bf16_f32 v88, v88, v89
    v_cvt_pk_bf16_f32 v89, v90, v91
    ds_pk_add_bf16 v7, v88 offset:65408
    ds_pk_add_bf16 v7, v89 offset:65412
    s_mov_b64 exec, s[50:51]
    s_branch L2_d151
L2_c152:
    s_mov_b64 s[50:51], vcc
    s_lshl_b64 s[52:53], s[82:83], 1
    s_andn2_b64 s[52:53], s[52:53], s[80:81]
    s_andn2_b64 s[52:53], s[52:53], s[50:51]
    s_or_b64 s[80:81], s[80:81], s[52:53]
    s_not_b64 vcc, s[52:53]
    s_mov_b64 exec, -1
    v_cndmask_b32_dpp v84, v84, v84, vcc wave_shr:1 row_mask:0xf bank_mask:0xf
    v_cndmask_b32_dpp v85, v85, v85, vcc wave_shr:1 row_mask:0xf bank_mask:0xf
    s_lshr_b64 s[52:53], s[52:53], 1
    v_cndmask_b32_dpp v86, v86, v86, vcc wave_shr:1 row_mask:0xf bank_mask:0xf
    v_cndmask_b32_dpp v87, v87, v87, vcc wave_shr:1 row_mask:0xf bank_mask:0xf
    s_andn2_b64 s[82:83], s[82:83], s[52:53]
    v_cndmask_b32_dpp v7, v7, v7, vcc wave_shr:1 row_mask:0xf bank_mask:0xf
    s_mov_b64 vcc, s[50:51]
    s_mov_b64 exec, s[50:51]
    s_cbranch_scc0 L2_d152
    s_mov_b64 exec, s[82:83]
    s_nop 1
    v_mfma_f32_4x4x4_16b_bf16 v[88:91], v[12:13], v[84:85], 0
    s_nop 1
    v_mfma_f32_4x4x4_16b_bf16 v[88:91], v[10:11], v[86:87], v[88:91]
    s_nop 4
    v_cvt_pk_bf16_f32 v88, v88, v89
    v_cvt_pk_bf16_f32 v89, v90, v91
    ds_pk_add_bf16 v7, v88 offset:65408
    ds_pk_add_bf16 v7, v89 offset:65412
    s_mov_b64 exec, vcc
    s_branch L2_d152
L2_c153:
    s_mov_b64 s[50:51], vcc
    s_lshl_b64 s[52:53], s[82:83], 1
    s_andn2_b64 s[52:53], s[52:53], s[80:81]
    s_andn2_b64 s[52:53], s[52:53], s[50:51]
    s_or_b64 s[80:81], s[80:81], s[52:53]
    s_not_b64 vcc, s[52:53]
    s_mov_b64 exec, -1
    v_cndmask_b32_dpp v84, v84, v84, vcc wave_shr:1 row_mask:0xf bank_mask:0xf
    v_cndmask_b32_dpp v85, v85, v85, vcc wave_shr:1 row_mask:0xf bank_mask:0xf
    s_lshr_b64 s[52:53], s[52:53], 1
    v_cndmask_b32_dpp v86, v86, v86, vcc wave_shr:1 row_mask:0xf bank_mask:0xf
    v_cndmask_b32_dpp v87, v87, v87, vcc wave_shr:1 row_mask:0xf bank_mask:0xf
    s_andn2_b64 s[82:83], s[82:83], s[52:53]
    v_cndmask_b32_dpp v7, v7, v7, vcc wave_shr:1 row_mask:0xf bank_mask:0xf
    s_mov_b64 vcc, s[50:51]
    s_mov_b64 exec, s[50:51]
    s_cbranch_scc0 L2_d153
    s_mov_b64 exec, s[82:83]
    s_nop 1
    v_mfma_f32_4x4x4_16b_bf16 v[88:91], v[12:13], v[84:85], 0
    s_nop 1
    v_mfma_f32_4x4x4_16b_bf16 v[88:91], v[10:11], v[86:87], v[88:91]
    s_nop 4
    v_cvt_pk_bf16_f32 v88, v88, v89
    v_cvt_pk_bf16_f32 v89, v90, v91
    ds_pk_add_bf16 v7, v88 offset:65408
    ds_pk_add_bf16 v7, v89 offset:65412
    s_mov_b64 exec, vcc
    s_branch L2_d153
L2_f3s:
    s_branch L2_f3
.section .rodata,"a"
.p2align 6
.amdhsa_kernel gather_scatter__molecular_angular_gemnet__graph_kernel
  .amdhsa_next_free_vgpr 128
  .amdhsa_next_free_sgpr 102
  .amdhsa_accum_offset 128
  .amdhsa_group_segment_fixed_size 0
  .amdhsa_kernarg_size 112
  .amdhsa_user_sgpr_count 2
  .amdhsa_user_sgpr_kernarg_segment_ptr 1
  .amdhsa_system_sgpr_workgroup_id_x 1
  .amdhsa_float_denorm_mode_32 3
.end_amdhsa_kernel
```

```asm
; @launch grid=(256,1,1) block=(1024,1,1) lds=163840
.amdgcn_target "amdgcn-amd-amdhsa--gfx950"
.text
.globl gather_scatter__molecular_angular_gemnet__graph_kernel
.p2align 8
.type gather_scatter__molecular_angular_gemnet__graph_kernel,@function
gather_scatter__molecular_angular_gemnet__graph_kernel:
    s_cmp_ge_u32 s2, 256
    s_cbranch_scc0 L1_go
    s_endpgm
L1_go:
    s_load_dwordx4 s[4:7], s[0:1], 8
    s_load_dwordx2 s[28:29], s[0:1], 32
    s_load_dwordx2 s[30:31], s[0:1], 104
    s_load_dwordx2 s[56:57], s[0:1], 96
    s_load_dwordx2 s[86:87], s[0:1], 0
    s_load_dwordx4 s[60:63], s[0:1], 56
    s_load_dwordx4 s[64:67], s[0:1], 72
    v_lshrrev_b32 v7, 6, v0
    v_lshlrev_b32 v1, 3, v0
    v_readfirstlane_b32 s32, v7
    v_lshlrev_b32 v0, 4, v0
    v_and_b32 v1, 0x1f8, v1
    v_lshlrev_b32 v15, 1, v1
    s_lshr_b32 s3, s32, 1
    s_and_b32 s44, s32, 1
    s_lshl_b32 s44, s44, 3
    s_or_b32 s3, s3, s44
    s_lshl_b32 s3, s3, 10
    s_lshl_b32 s96, s2, 14
    s_add_u32 s96, s96, s3
    s_lshr_b32 s3, s32, 1
    s_and_b32 s44, s32, 1
    s_lshl_b32 s44, s44, 3
    s_or_b32 s3, s3, s44
    s_lshl_b32 s3, s3, 10
    s_lshl_b32 s97, s2, 14
    s_add_u32 s97, s97, s3
    s_lshr_b32 s3, s32, 1
    s_and_b32 s44, s32, 1
    s_lshl_b32 s44, s44, 3
    s_or_b32 s3, s3, s44
    s_lshl_b32 s3, s3, 10
    s_lshl_b32 s98, s2, 14
    s_add_u32 s98, s98, s3
    s_lshr_b32 s3, s32, 1
    s_and_b32 s44, s32, 1
    s_lshl_b32 s44, s44, 3
    s_or_b32 s3, s3, s44
    s_lshl_b32 s3, s3, 10
    s_lshl_b32 s99, s2, 14
    s_add_u32 s99, s99, s3
    s_waitcnt lgkmcnt(0)
    s_mov_b32 s8, s4
    s_mov_b32 s9, s5
    s_mov_b32 s10, 0x9c40000
    s_mov_b32 s11, 0x20000
    s_mov_b32 s12, s6
    s_mov_b32 s13, s7
    s_mov_b32 s14, 0x9c40000
    s_mov_b32 s15, 0x20000
    s_mov_b32 s16, s28
    s_mov_b32 s17, s29
    s_mov_b32 s18, 0x4e20000
    s_mov_b32 s19, 0x20000
    s_mov_b32 s68, s62
    s_mov_b32 s69, s63
    s_mov_b32 s70, 0x40
    s_mov_b32 s71, 0x20000
    s_mov_b32 s72, s60
    s_mov_b32 s73, s61
    s_mov_b32 s74, 0x40
    s_mov_b32 s75, 0x20000
    s_mov_b32 s20, s66
    s_mov_b32 s21, s67
    s_mov_b32 s22, 0x20
    s_mov_b32 s23, 0x20000
    s_mov_b32 s80, s64
    s_mov_b32 s81, s65
    s_mov_b32 s82, 0x20
    s_mov_b32 s83, 0x20000
    s_add_u32 s24, s30, 0xec54000
    s_addc_u32 s25, s31, 0
    s_mov_b32 s26, 0x100
    s_mov_b32 s27, 0x20000
    v_lshrrev_b32 v2, 3, v0
    v_and_b32 v2, 6, v2
    v_lshlrev_b32 v3, 2, v0
    s_lshl_b32 s3, s32, 8
    s_add_u32 s3, s3, s2
    s_cmp_lg_u32 s3, 254
    s_cbranch_scc1 L1_wt
    buffer_load_ushort v96, v2, s[68:71], 0 offen offset:0
    buffer_load_ushort v108, v2, s[68:71], 0 offen offset:8
    buffer_load_ushort v97, v2, s[68:71], 0 offen offset:16
    buffer_load_ushort v109, v2, s[68:71], 0 offen offset:24
    buffer_load_ushort v98, v2, s[68:71], 0 offen offset:32
    buffer_load_ushort v110, v2, s[68:71], 0 offen offset:40
    buffer_load_ushort v99, v2, s[68:71], 0 offen offset:48
    buffer_load_ushort v111, v2, s[68:71], 0 offen offset:56
    buffer_load_ushort v100, v2, s[72:75], 0 offen offset:0
    buffer_load_ushort v112, v2, s[72:75], 0 offen offset:8
    buffer_load_ushort v101, v2, s[72:75], 0 offen offset:16
    buffer_load_ushort v113, v2, s[72:75], 0 offen offset:24
    buffer_load_ushort v102, v2, s[72:75], 0 offen offset:32
    buffer_load_ushort v114, v2, s[72:75], 0 offen offset:40
    buffer_load_ushort v103, v2, s[72:75], 0 offen offset:48
    buffer_load_ushort v115, v2, s[72:75], 0 offen offset:56
    buffer_load_ushort v104, v2, s[20:23], 0 offen offset:0
    buffer_load_ushort v116, v2, s[20:23], 0 offen offset:8
    buffer_load_ushort v105, v2, s[20:23], 0 offen offset:16
    buffer_load_ushort v117, v2, s[20:23], 0 offen offset:24
    buffer_load_ushort v106, v2, s[80:83], 0 offen offset:0
    buffer_load_ushort v118, v2, s[80:83], 0 offen offset:8
    buffer_load_ushort v107, v2, s[80:83], 0 offen offset:16
    buffer_load_ushort v119, v2, s[80:83], 0 offen offset:24
    s_waitcnt vmcnt(0)
    v_lshl_or_b32 v96, v108, 16, v96
    v_lshl_or_b32 v97, v109, 16, v97
    v_lshl_or_b32 v98, v110, 16, v98
    v_lshl_or_b32 v99, v111, 16, v99
    v_lshl_or_b32 v100, v112, 16, v100
    v_lshl_or_b32 v101, v113, 16, v101
    v_lshl_or_b32 v102, v114, 16, v102
    v_lshl_or_b32 v103, v115, 16, v103
    v_lshl_or_b32 v104, v116, 16, v104
    v_lshl_or_b32 v105, v117, 16, v105
    v_lshl_or_b32 v106, v118, 16, v106
    v_lshl_or_b32 v107, v119, 16, v107
    buffer_store_dwordx4 v[96:99], v3, s[24:27], 0 offen offset:0 sc1
    buffer_store_dwordx4 v[100:103], v3, s[24:27], 0 offen offset:16 sc1
    buffer_store_dwordx4 v[104:107], v3, s[24:27], 0 offen offset:32 sc1
L1_wt:
    s_nop 1
    s_add_u32 s44, s96, 0x0
    v_lshlrev_b32 v16, 1, v1
    buffer_load_dwordx4 v[16:19], v16, s[8:11], s44 offen nt
    s_add_u32 s45, s96, 0x0
    v_lshlrev_b32 v20, 1, v1
    buffer_load_dwordx4 v[20:23], v20, s[12:15], s45 offen nt
    s_add_u32 s46, s96, 0x0
    s_lshr_b32 s46, s46, 1
    buffer_load_dwordx2 v[24:25], v1, s[16:19], s46 offen nt
    s_add_u32 s47, s97, 0x400000
    s_lshr_b32 s47, s47, 1
    buffer_load_dwordx2 v[26:27], v1, s[16:19], s47 offen nt
    s_add_u32 s44, s97, 0x400000
    v_lshlrev_b32 v28, 1, v1
    buffer_load_dwordx4 v[28:31], v28, s[8:11], s44 offen nt
    s_add_u32 s45, s97, 0x400000
    v_lshlrev_b32 v32, 1, v1
    buffer_load_dwordx4 v[32:35], v32, s[12:15], s45 offen nt
    s_add_u32 s46, s98, 0x800000
    v_lshlrev_b32 v36, 1, v1
    buffer_load_dwordx4 v[36:39], v36, s[8:11], s46 offen nt
    s_add_u32 s47, s98, 0x800000
    v_lshlrev_b32 v40, 1, v1
    buffer_load_dwordx4 v[40:43], v40, s[12:15], s47 offen nt
    s_add_u32 s44, s98, 0x800000
    s_lshr_b32 s44, s44, 1
    buffer_load_dwordx2 v[44:45], v1, s[16:19], s44 offen nt
    s_add_u32 s45, s99, 0xc00000
    s_lshr_b32 s45, s45, 1
    buffer_load_dwordx2 v[46:47], v1, s[16:19], s45 offen nt
    s_mov_b32 s20, s30
    s_mov_b32 s21, s31
    s_mov_b32 s22, 0xd344000
    s_mov_b32 s23, 0x20000
    s_add_u32 s24, s30, 0x2c000
    s_addc_u32 s25, s31, 0
    s_mov_b32 s26, 0xd318000
    s_mov_b32 s27, 0x20000
    s_add_u32 s3, s32, 0
    s_mul_i32 s4, s3, 205
    s_lshr_b32 s4, s4, 10
    s_mul_i32 s5, s4, 5
    s_sub_u32 s5, s3, s5
    s_lshl_b32 s5, s5, 5
    s_add_u32 s4, s4, s5
    s_sub_u32 s4, s4, s32
    s_lshl_b32 s72, s4, 10
    s_add_u32 s3, s32, 16
    s_mul_i32 s4, s3, 205
    s_lshr_b32 s4, s4, 10
    s_mul_i32 s5, s4, 5
    s_sub_u32 s5, s3, s5
    s_lshl_b32 s5, s5, 5
    s_add_u32 s4, s4, s5
    s_sub_u32 s4, s4, s32
    s_lshl_b32 s73, s4, 10
    s_add_u32 s3, s32, 32
    s_mul_i32 s4, s3, 205
    s_lshr_b32 s4, s4, 10
    s_mul_i32 s5, s4, 5
    s_sub_u32 s5, s3, s5
    s_lshl_b32 s5, s5, 5
    s_add_u32 s4, s4, s5
    s_sub_u32 s4, s4, s32
    s_lshl_b32 s85, s4, 10
    s_add_u32 s3, s32, 48
    s_mul_i32 s4, s3, 205
    s_lshr_b32 s4, s4, 10
    s_mul_i32 s5, s4, 5
    s_sub_u32 s5, s3, s5
    s_lshl_b32 s5, s5, 5
    s_add_u32 s4, s4, s5
    s_sub_u32 s4, s4, s32
    s_lshl_b32 s91, s4, 10
    s_add_u32 s3, s32, 64
    s_mul_i32 s4, s3, 205
    s_lshr_b32 s4, s4, 10
    s_mul_i32 s5, s4, 5
    s_sub_u32 s5, s3, s5
    s_lshl_b32 s5, s5, 5
    s_add_u32 s4, s4, s5
    s_sub_u32 s4, s4, s32
    s_lshl_b32 s93, s4, 10
    s_mov_b32 s80, s86
    s_mov_b32 s81, s87
    s_mov_b32 s82, 0x4e2000
    s_mov_b32 s83, 0x20000
    s_mul_i32 s35, s2, 173056
    s_and_b32 s37, s32, 3
    s_lshl_b32 s37, s37, 3
    s_mov_b32 s36, s37
    s_lshr_b32 s37, s32, 2
    s_mul_i32 s37, s37, 2080
    s_add_u32 s36, s36, s37
    s_and_b32 s37, s2, 3
    s_lshl_b32 s37, s37, 5
    s_add_u32 s36, s36, s37
    s_mul_i32 s4, s2, 5
    s_add_u32 s4, s4, 8192
    s_lshl_b32 s38, s4, 14
    s_lshl_b32 s39, s4, 13
    v_mov_b32 v2, 1
    v_mov_b32 v4, 0x80000007
    v_mov_b32 v5, 0xfc
    v_mov_b32 v6, 0x78
    s_mov_b32 s40, 16512
    s_mov_b32 s55, -10000
    s_mov_b32 s41, 0x010c0c01
    s_mov_b32 s42, 0x030c0c03
    v_mov_b32 v8, 0
    v_mov_b32 v9, 0
    v_mov_b32 v10, 0
    v_mov_b32 v11, 0
    ds_write_b128 v0, v[8:11]
    s_add_u32 s60, s30, 0xec5d000
    s_addc_u32 s61, s31, 0
    s_mov_b32 s62, 0x8000
    s_mov_b32 s63, 0x20000
    s_mov_b64 s[66:67], s[56:57]
    s_lshl_b32 s57, s2, 7
    s_add_u32 s68, s30, 0xec55000
    s_addc_u32 s69, s31, 0
    s_mov_b32 s70, 0x80
    s_mov_b32 s71, 0x20000
    s_lshl_b32 s3, s2, 7
    s_add_u32 s68, s68, s3
    s_addc_u32 s69, s69, 0
    s_cmp_lg_u32 s32, 0
    s_cbranch_scc1 L1_fl
    buffer_store_dwordx4 v[8:11], v0, s[68:71], 0 offen sc1
    s_mov_b64 exec, 0xff
    buffer_store_dwordx4 v[8:11], v0, s[60:63], s57 offen sc1
    s_mov_b64 exec, -1
L1_fl:
    s_waitcnt lgkmcnt(0)
    s_barrier
    s_setprio 3
    s_add_u32 s46, s99, 0xc00000
    v_lshlrev_b32 v48, 1, v1
    buffer_load_dwordx4 v[48:51], v48, s[8:11], s46 offen nt
    s_add_u32 s47, s99, 0xc00000
    v_lshlrev_b32 v52, 1, v1
    buffer_load_dwordx4 v[52:55], v52, s[12:15], s47 offen nt
    s_waitcnt vmcnt(8)
    v_lshlrev_b32 v7, 16, v24
    v_and_b32 v8, 0xffff0000, v24
    v_lshlrev_b32 v9, 16, v25
    v_and_b32 v10, 0xffff0000, v25
    v_mul_f32 v7, 0.15915494, v7
    v_mul_f32 v8, 0.15915494, v8
    v_mul_f32 v9, 0.15915494, v9
    v_mul_f32 v10, 0.15915494, v10
    v_mul_hi_u32_u24 v14, 429497, v16
    v_lshrrev_b32 v12, 3, v20
    v_cos_f32 v7, v7
    v_lshlrev_b16 v13, 3, v20
    v_mad_i32_i24 v11, v14, s55, v16
    v_bitop3_b32 v12, v6, v13, v12 bitop3:0xca
    v_lshl_add_u32 v11, v11, 17, s40
    v_lshlrev_b16 v14, 8, v14
    v_lshrrev_b32 v13, 2, v20
    v_add_u32 v16, v12, v11
    v_bitop3_b32 v20, v5, v13, v14 bitop3:0xea
    ds_add_u32 v20, v2
    v_mul_hi_u32_u24 v14, 429497, v17
    v_lshrrev_b32 v12, 3, v21
    v_cos_f32 v8, v8
    v_lshlrev_b16 v13, 3, v21
    v_mad_i32_i24 v11, v14, s55, v17
    v_bitop3_b32 v12, v6, v13, v12 bitop3:0xca
    v_lshl_add_u32 v11, v11, 17, s40
    v_lshlrev_b16 v14, 8, v14
    v_lshrrev_b32 v13, 2, v21
    v_add_u32 v17, v12, v11
    v_bitop3_b32 v21, v5, v13, v14 bitop3:0xea
    ds_add_u32 v21, v2
    v_cvt_pk_bf16_f32 v24, v7, v8
    v_perm_b32 v12, v24, v24, s41
    v_bitop3_b32 v16, v4, v12, v16 bitop3:0xca
    v_perm_b32 v13, v24, v24, s42
    v_bitop3_b32 v17, v4, v13, v17 bitop3:0xca
    v_mul_hi_u32_u24 v14, 429497, v18
    v_lshrrev_b32 v12, 3, v22
    v_cos_f32 v9, v9
    v_lshlrev_b16 v13, 3, v22
    v_mad_i32_i24 v11, v14, s55, v18
    v_bitop3_b32 v12, v6, v13, v12 bitop3:0xca
    v_lshl_add_u32 v11, v11, 17, s40
    v_lshlrev_b16 v14, 8, v14
    v_lshrrev_b32 v13, 2, v22
    v_add_u32 v18, v12, v11
    v_bitop3_b32 v22, v5, v13, v14 bitop3:0xea
    ds_add_u32 v22, v2
    v_mul_hi_u32_u24 v14, 429497, v19
    v_lshrrev_b32 v12, 3, v23
    v_cos_f32 v10, v10
    v_lshlrev_b16 v13, 3, v23
    v_mad_i32_i24 v11, v14, s55, v19
    v_bitop3_b32 v12, v6, v13, v12 bitop3:0xca
    v_lshl_add_u32 v11, v11, 17, s40
    v_lshlrev_b16 v14, 8, v14
    v_lshrrev_b32 v13, 2, v23
    v_add_u32 v19, v12, v11
    v_bitop3_b32 v23, v5, v13, v14 bitop3:0xea
    ds_add_u32 v23, v2
    v_cvt_pk_bf16_f32 v25, v9, v10
    v_perm_b32 v12, v25, v25, s41
    v_bitop3_b32 v18, v4, v12, v18 bitop3:0xca
    v_perm_b32 v13, v25, v25, s42
    v_bitop3_b32 v19, v4, v13, v19 bitop3:0xca
    s_add_u32 s44, s96, 0x1000000
    v_lshlrev_b32 v56, 1, v1
    buffer_load_dwordx4 v[56:59], v56, s[8:11], s44 offen nt
    s_add_u32 s45, s96, 0x1000000
    v_lshlrev_b32 v60, 1, v1
    buffer_load_dwordx4 v[60:63], v60, s[12:15], s45 offen nt
    s_add_u32 s46, s96, 0x1000000
    s_lshr_b32 s46, s46, 1
    buffer_load_dwordx2 v[64:65], v1, s[16:19], s46 offen nt
    s_add_u32 s47, s97, 0x1400000
    s_lshr_b32 s47, s47, 1
    buffer_load_dwordx2 v[66:67], v1, s[16:19], s47 offen nt
    s_waitcnt vmcnt(10)
    v_lshlrev_b32 v7, 16, v26
    v_and_b32 v8, 0xffff0000, v26
    v_lshlrev_b32 v9, 16, v27
    v_and_b32 v10, 0xffff0000, v27
    v_mul_f32 v7, 0.15915494, v7
    v_mul_f32 v8, 0.15915494, v8
    v_mul_f32 v9, 0.15915494, v9
    v_mul_f32 v10, 0.15915494, v10
    v_mul_hi_u32_u24 v14, 429497, v28
    v_lshrrev_b32 v12, 3, v32
    v_cos_f32 v7, v7
    v_lshlrev_b16 v13, 3, v32
    v_mad_i32_i24 v11, v14, s55, v28
    v_bitop3_b32 v12, v6, v13, v12 bitop3:0xca
    v_lshl_add_u32 v11, v11, 17, s40
    v_lshlrev_b16 v14, 8, v14
    v_lshrrev_b32 v13, 2, v32
    v_add_u32 v28, v12, v11
    v_bitop3_b32 v32, v5, v13, v14 bitop3:0xea
    ds_add_u32 v32, v2
    v_mul_hi_u32_u24 v14, 429497, v29
    v_lshrrev_b32 v12, 3, v33
    v_cos_f32 v8, v8
    v_lshlrev_b16 v13, 3, v33
    v_mad_i32_i24 v11, v14, s55, v29
    v_bitop3_b32 v12, v6, v13, v12 bitop3:0xca
    v_lshl_add_u32 v11, v11, 17, s40
    v_lshlrev_b16 v14, 8, v14
    v_lshrrev_b32 v13, 2, v33
    v_add_u32 v29, v12, v11
    v_bitop3_b32 v33, v5, v13, v14 bitop3:0xea
    ds_add_u32 v33, v2
    v_cvt_pk_bf16_f32 v26, v7, v8
    v_perm_b32 v12, v26, v26, s41
    v_bitop3_b32 v28, v4, v12, v28 bitop3:0xca
    v_perm_b32 v13, v26, v26, s42
    v_bitop3_b32 v29, v4, v13, v29 bitop3:0xca
    v_mul_hi_u32_u24 v14, 429497, v30
    v_lshrrev_b32 v12, 3, v34
    v_cos_f32 v9, v9
    v_lshlrev_b16 v13, 3, v34
    v_mad_i32_i24 v11, v14, s55, v30
    v_bitop3_b32 v12, v6, v13, v12 bitop3:0xca
    v_lshl_add_u32 v11, v11, 17, s40
    v_lshlrev_b16 v14, 8, v14
    v_lshrrev_b32 v13, 2, v34
    v_add_u32 v30, v12, v11
    v_bitop3_b32 v34, v5, v13, v14 bitop3:0xea
    ds_add_u32 v34, v2
    v_mul_hi_u32_u24 v14, 429497, v31
    v_lshrrev_b32 v12, 3, v35
    v_cos_f32 v10, v10
    v_lshlrev_b16 v13, 3, v35
    v_mad_i32_i24 v11, v14, s55, v31
    v_bitop3_b32 v12, v6, v13, v12 bitop3:0xca
    v_lshl_add_u32 v11, v11, 17, s40
    v_lshlrev_b16 v14, 8, v14
    v_lshrrev_b32 v13, 2, v35
    v_add_u32 v31, v12, v11
    v_bitop3_b32 v35, v5, v13, v14 bitop3:0xea
    ds_add_u32 v35, v2
    v_cvt_pk_bf16_f32 v27, v9, v10
    v_perm_b32 v12, v27, v27, s41
    v_bitop3_b32 v30, v4, v12, v30 bitop3:0xca
    v_perm_b32 v13, v27, v27, s42
    v_bitop3_b32 v31, v4, v13, v31 bitop3:0xca
    s_setprio 2
    s_add_u32 s44, s97, 0x1400000
    v_lshlrev_b32 v68, 1, v1
    buffer_load_dwordx4 v[68:71], v68, s[8:11], s44 offen nt
    s_add_u32 s45, s97, 0x1400000
    v_lshlrev_b32 v72, 1, v1
    buffer_load_dwordx4 v[72:75], v72, s[12:15], s45 offen nt
    s_waitcnt vmcnt(8)
    v_lshlrev_b32 v7, 16, v44
    v_and_b32 v8, 0xffff0000, v44
    v_lshlrev_b32 v9, 16, v45
    v_and_b32 v10, 0xffff0000, v45
    v_mul_f32 v7, 0.15915494, v7
    v_mul_f32 v8, 0.15915494, v8
    v_mul_f32 v9, 0.15915494, v9
    v_mul_f32 v10, 0.15915494, v10
    v_mul_hi_u32_u24 v14, 429497, v36
    v_lshrrev_b32 v12, 3, v40
    v_cos_f32 v7, v7
    v_lshlrev_b16 v13, 3, v40
    v_mad_i32_i24 v11, v14, s55, v36
    v_bitop3_b32 v12, v6, v13, v12 bitop3:0xca
    v_lshl_add_u32 v11, v11, 17, s40
    v_lshlrev_b16 v14, 8, v14
    v_lshrrev_b32 v13, 2, v40
    v_add_u32 v36, v12, v11
    v_bitop3_b32 v40, v5, v13, v14 bitop3:0xea
    ds_add_u32 v40, v2
    v_mul_hi_u32_u24 v14, 429497, v37
    v_lshrrev_b32 v12, 3, v41
    v_cos_f32 v8, v8
    v_lshlrev_b16 v13, 3, v41
    v_mad_i32_i24 v11, v14, s55, v37
    v_bitop3_b32 v12, v6, v13, v12 bitop3:0xca
    v_lshl_add_u32 v11, v11, 17, s40
    v_lshlrev_b16 v14, 8, v14
    v_lshrrev_b32 v13, 2, v41
    v_add_u32 v37, v12, v11
    v_bitop3_b32 v41, v5, v13, v14 bitop3:0xea
    ds_add_u32 v41, v2
    v_cvt_pk_bf16_f32 v44, v7, v8
    v_perm_b32 v12, v44, v44, s41
    v_bitop3_b32 v36, v4, v12, v36 bitop3:0xca
    v_perm_b32 v13, v44, v44, s42
    v_bitop3_b32 v37, v4, v13, v37 bitop3:0xca
    v_mul_hi_u32_u24 v14, 429497, v38
    v_lshrrev_b32 v12, 3, v42
    v_cos_f32 v9, v9
    v_lshlrev_b16 v13, 3, v42
    v_mad_i32_i24 v11, v14, s55, v38
    v_bitop3_b32 v12, v6, v13, v12 bitop3:0xca
    v_lshl_add_u32 v11, v11, 17, s40
    v_lshlrev_b16 v14, 8, v14
    v_lshrrev_b32 v13, 2, v42
    v_add_u32 v38, v12, v11
    v_bitop3_b32 v42, v5, v13, v14 bitop3:0xea
    ds_add_u32 v42, v2
    v_mul_hi_u32_u24 v14, 429497, v39
    v_lshrrev_b32 v12, 3, v43
    v_cos_f32 v10, v10
    v_lshlrev_b16 v13, 3, v43
    v_mad_i32_i24 v11, v14, s55, v39
    v_bitop3_b32 v12, v6, v13, v12 bitop3:0xca
    v_lshl_add_u32 v11, v11, 17, s40
    v_lshlrev_b16 v14, 8, v14
    v_lshrrev_b32 v13, 2, v43
    v_add_u32 v39, v12, v11
    v_bitop3_b32 v43, v5, v13, v14 bitop3:0xea
    ds_add_u32 v43, v2
    v_cvt_pk_bf16_f32 v45, v9, v10
    v_perm_b32 v12, v45, v45, s41
    v_bitop3_b32 v38, v4, v12, v38 bitop3:0xca
    v_perm_b32 v13, v45, v45, s42
    v_bitop3_b32 v39, v4, v13, v39 bitop3:0xca
    s_add_u32 s46, s98, 0x1800000
    v_lshlrev_b32 v76, 1, v1
    buffer_load_dwordx4 v[76:79], v76, s[8:11], s46 offen nt
    s_add_u32 s47, s98, 0x1800000
    v_lshlrev_b32 v80, 1, v1
    buffer_load_dwordx4 v[80:83], v80, s[12:15], s47 offen nt
    s_add_u32 s44, s98, 0x1800000
    s_lshr_b32 s44, s44, 1
    buffer_load_dwordx2 v[84:85], v1, s[16:19], s44 offen nt
    s_add_u32 s45, s99, 0x1c00000
    s_lshr_b32 s45, s45, 1
    buffer_load_dwordx2 v[86:87], v1, s[16:19], s45 offen nt
    s_waitcnt vmcnt(10)
    v_lshlrev_b32 v7, 16, v46
    v_and_b32 v8, 0xffff0000, v46
    v_lshlrev_b32 v9, 16, v47
    v_and_b32 v10, 0xffff0000, v47
    v_mul_f32 v7, 0.15915494, v7
    v_mul_f32 v8, 0.15915494, v8
    v_mul_f32 v9, 0.15915494, v9
    v_mul_f32 v10, 0.15915494, v10
    v_mul_hi_u32_u24 v14, 429497, v48
    v_lshrrev_b32 v12, 3, v52
    v_cos_f32 v7, v7
    v_lshlrev_b16 v13, 3, v52
    v_mad_i32_i24 v11, v14, s55, v48
    v_bitop3_b32 v12, v6, v13, v12 bitop3:0xca
    v_lshl_add_u32 v11, v11, 17, s40
    v_lshlrev_b16 v14, 8, v14
    v_lshrrev_b32 v13, 2, v52
    v_add_u32 v48, v12, v11
    v_bitop3_b32 v52, v5, v13, v14 bitop3:0xea
    ds_add_u32 v52, v2
    v_mul_hi_u32_u24 v14, 429497, v49
    v_lshrrev_b32 v12, 3, v53
    v_cos_f32 v8, v8
    v_lshlrev_b16 v13, 3, v53
    v_mad_i32_i24 v11, v14, s55, v49
    v_bitop3_b32 v12, v6, v13, v12 bitop3:0xca
    v_lshl_add_u32 v11, v11, 17, s40
    v_lshlrev_b16 v14, 8, v14
    v_lshrrev_b32 v13, 2, v53
    v_add_u32 v49, v12, v11
    v_bitop3_b32 v53, v5, v13, v14 bitop3:0xea
    ds_add_u32 v53, v2
    v_cvt_pk_bf16_f32 v46, v7, v8
    v_perm_b32 v12, v46, v46, s41
    v_bitop3_b32 v48, v4, v12, v48 bitop3:0xca
    v_perm_b32 v13, v46, v46, s42
    v_bitop3_b32 v49, v4, v13, v49 bitop3:0xca
    v_mul_hi_u32_u24 v14, 429497, v50
    v_lshrrev_b32 v12, 3, v54
    v_cos_f32 v9, v9
    v_lshlrev_b16 v13, 3, v54
    v_mad_i32_i24 v11, v14, s55, v50
    v_bitop3_b32 v12, v6, v13, v12 bitop3:0xca
    v_lshl_add_u32 v11, v11, 17, s40
    v_lshlrev_b16 v14, 8, v14
    v_lshrrev_b32 v13, 2, v54
    v_add_u32 v50, v12, v11
    v_bitop3_b32 v54, v5, v13, v14 bitop3:0xea
    ds_add_u32 v54, v2
    v_mul_hi_u32_u24 v14, 429497, v51
    v_lshrrev_b32 v12, 3, v55
    v_cos_f32 v10, v10
    v_lshlrev_b16 v13, 3, v55
    v_mad_i32_i24 v11, v14, s55, v51
    v_bitop3_b32 v12, v6, v13, v12 bitop3:0xca
    v_lshl_add_u32 v11, v11, 17, s40
    v_lshlrev_b16 v14, 8, v14
    v_lshrrev_b32 v13, 2, v55
    v_add_u32 v51, v12, v11
    v_bitop3_b32 v55, v5, v13, v14 bitop3:0xea
    ds_add_u32 v55, v2
    v_cvt_pk_bf16_f32 v47, v9, v10
    v_perm_b32 v12, v47, v47, s41
    v_bitop3_b32 v50, v4, v12, v50 bitop3:0xca
    v_perm_b32 v13, v47, v47, s42
    v_bitop3_b32 v51, v4, v13, v51 bitop3:0xca
    s_setprio 1
    s_add_u32 s46, s99, 0x1c00000
    v_lshlrev_b32 v88, 1, v1
    buffer_load_dwordx4 v[88:91], v88, s[8:11], s46 offen nt
    s_add_u32 s47, s99, 0x1c00000
    v_lshlrev_b32 v92, 1, v1
    buffer_load_dwordx4 v[92:95], v92, s[12:15], s47 offen nt
    s_waitcnt vmcnt(8)
    v_lshlrev_b32 v7, 16, v64
    v_and_b32 v8, 0xffff0000, v64
    v_lshlrev_b32 v9, 16, v65
    v_and_b32 v10, 0xffff0000, v65
    v_mul_f32 v7, 0.15915494, v7
    v_mul_f32 v8, 0.15915494, v8
    v_mul_f32 v9, 0.15915494, v9
    v_mul_f32 v10, 0.15915494, v10
    v_mul_hi_u32_u24 v14, 429497, v56
    v_lshrrev_b32 v12, 3, v60
    v_cos_f32 v7, v7
    v_lshlrev_b16 v13, 3, v60
    v_mad_i32_i24 v11, v14, s55, v56
    v_bitop3_b32 v12, v6, v13, v12 bitop3:0xca
    v_lshl_add_u32 v11, v11, 17, s40
    v_lshlrev_b16 v14, 8, v14
    v_lshrrev_b32 v13, 2, v60
    v_add_u32 v56, v12, v11
    v_bitop3_b32 v60, v5, v13, v14 bitop3:0xea
    ds_add_u32 v60, v2
    v_mul_hi_u32_u24 v14, 429497, v57
    v_lshrrev_b32 v12, 3, v61
    v_cos_f32 v8, v8
    v_lshlrev_b16 v13, 3, v61
    v_mad_i32_i24 v11, v14, s55, v57
    v_bitop3_b32 v12, v6, v13, v12 bitop3:0xca
    v_lshl_add_u32 v11, v11, 17, s40
    v_lshlrev_b16 v14, 8, v14
    v_lshrrev_b32 v13, 2, v61
    v_add_u32 v57, v12, v11
    v_bitop3_b32 v61, v5, v13, v14 bitop3:0xea
    ds_add_u32 v61, v2
    v_cvt_pk_bf16_f32 v64, v7, v8
    v_perm_b32 v12, v64, v64, s41
    v_bitop3_b32 v56, v4, v12, v56 bitop3:0xca
    v_perm_b32 v13, v64, v64, s42
    v_bitop3_b32 v57, v4, v13, v57 bitop3:0xca
    v_mul_hi_u32_u24 v14, 429497, v58
    v_lshrrev_b32 v12, 3, v62
    v_cos_f32 v9, v9
    v_lshlrev_b16 v13, 3, v62
    v_mad_i32_i24 v11, v14, s55, v58
    v_bitop3_b32 v12, v6, v13, v12 bitop3:0xca
    v_lshl_add_u32 v11, v11, 17, s40
    v_lshlrev_b16 v14, 8, v14
    v_lshrrev_b32 v13, 2, v62
    v_add_u32 v58, v12, v11
    v_bitop3_b32 v62, v5, v13, v14 bitop3:0xea
    ds_add_u32 v62, v2
    v_mul_hi_u32_u24 v14, 429497, v59
    v_lshrrev_b32 v12, 3, v63
    v_cos_f32 v10, v10
    v_lshlrev_b16 v13, 3, v63
    v_mad_i32_i24 v11, v14, s55, v59
    v_bitop3_b32 v12, v6, v13, v12 bitop3:0xca
    v_lshl_add_u32 v11, v11, 17, s40
    v_lshlrev_b16 v14, 8, v14
    v_lshrrev_b32 v13, 2, v63
    v_add_u32 v59, v12, v11
    v_bitop3_b32 v63, v5, v13, v14 bitop3:0xea
    ds_add_u32 v63, v2
    v_cvt_pk_bf16_f32 v65, v9, v10
    v_perm_b32 v12, v65, v65, s41
    v_bitop3_b32 v58, v4, v12, v58 bitop3:0xca
    v_perm_b32 v13, v65, v65, s42
    v_bitop3_b32 v59, v4, v13, v59 bitop3:0xca
    s_add_u32 s44, s96, 0x2000000
    v_lshlrev_b32 v96, 1, v1
    buffer_load_dwordx4 v[96:99], v96, s[8:11], s44 offen nt
    s_add_u32 s45, s96, 0x2000000
    v_lshlrev_b32 v104, 1, v1
    buffer_load_dwordx4 v[104:107], v104, s[12:15], s45 offen nt
    s_add_u32 s46, s96, 0x2000000
    s_lshr_b32 s46, s46, 1
    buffer_load_dwordx2 v[108:109], v1, s[16:19], s46 offen nt
    s_add_u32 s47, s97, 0x2400000
    s_lshr_b32 s47, s47, 1
    buffer_load_dwordx2 v[110:111], v1, s[16:19], s47 offen nt
    s_waitcnt vmcnt(10)
    v_lshlrev_b32 v7, 16, v66
    v_and_b32 v8, 0xffff0000, v66
    v_lshlrev_b32 v9, 16, v67
    v_and_b32 v10, 0xffff0000, v67
    v_mul_f32 v7, 0.15915494, v7
    v_mul_f32 v8, 0.15915494, v8
    v_mul_f32 v9, 0.15915494, v9
    v_mul_f32 v10, 0.15915494, v10
    v_mul_hi_u32_u24 v14, 429497, v68
    v_lshrrev_b32 v12, 3, v72
    v_cos_f32 v7, v7
    v_lshlrev_b16 v13, 3, v72
    v_mad_i32_i24 v11, v14, s55, v68
    v_bitop3_b32 v12, v6, v13, v12 bitop3:0xca
    v_lshl_add_u32 v11, v11, 17, s40
    v_lshlrev_b16 v14, 8, v14
    v_lshrrev_b32 v13, 2, v72
    v_add_u32 v68, v12, v11
    v_bitop3_b32 v72, v5, v13, v14 bitop3:0xea
    ds_add_u32 v72, v2
    v_mul_hi_u32_u24 v14, 429497, v69
    v_lshrrev_b32 v12, 3, v73
    v_cos_f32 v8, v8
    v_lshlrev_b16 v13, 3, v73
    v_mad_i32_i24 v11, v14, s55, v69
    v_bitop3_b32 v12, v6, v13, v12 bitop3:0xca
    v_lshl_add_u32 v11, v11, 17, s40
    v_lshlrev_b16 v14, 8, v14
    v_lshrrev_b32 v13, 2, v73
    v_add_u32 v69, v12, v11
    v_bitop3_b32 v73, v5, v13, v14 bitop3:0xea
    ds_add_u32 v73, v2
    v_cvt_pk_bf16_f32 v66, v7, v8
    v_perm_b32 v12, v66, v66, s41
    v_bitop3_b32 v68, v4, v12, v68 bitop3:0xca
    v_perm_b32 v13, v66, v66, s42
    v_bitop3_b32 v69, v4, v13, v69 bitop3:0xca
    v_mul_hi_u32_u24 v14, 429497, v70
    v_lshrrev_b32 v12, 3, v74
    v_cos_f32 v9, v9
    v_lshlrev_b16 v13, 3, v74
    v_mad_i32_i24 v11, v14, s55, v70
    v_bitop3_b32 v12, v6, v13, v12 bitop3:0xca
    v_lshl_add_u32 v11, v11, 17, s40
    v_lshlrev_b16 v14, 8, v14
    v_lshrrev_b32 v13, 2, v74
    v_add_u32 v70, v12, v11
    v_bitop3_b32 v74, v5, v13, v14 bitop3:0xea
    ds_add_u32 v74, v2
    v_mul_hi_u32_u24 v14, 429497, v71
    v_lshrrev_b32 v12, 3, v75
    v_cos_f32 v10, v10
    v_lshlrev_b16 v13, 3, v75
    v_mad_i32_i24 v11, v14, s55, v71
    v_bitop3_b32 v12, v6, v13, v12 bitop3:0xca
    v_lshl_add_u32 v11, v11, 17, s40
    v_lshlrev_b16 v14, 8, v14
    v_lshrrev_b32 v13, 2, v75
    v_add_u32 v71, v12, v11
    v_bitop3_b32 v75, v5, v13, v14 bitop3:0xea
    ds_add_u32 v75, v2
    v_cvt_pk_bf16_f32 v67, v9, v10
    v_perm_b32 v12, v67, v67, s41
    v_bitop3_b32 v70, v4, v12, v70 bitop3:0xca
    v_perm_b32 v13, v67, v67, s42
    v_bitop3_b32 v71, v4, v13, v71 bitop3:0xca
    s_setprio 0
    s_add_u32 s44, s97, 0x2400000
    v_lshlrev_b32 v100, 1, v1
    buffer_load_dwordx4 v[100:103], v100, s[8:11], s44 offen nt
    s_waitcnt vmcnt(7)
    v_lshlrev_b32 v7, 16, v84
    v_and_b32 v8, 0xffff0000, v84
    v_lshlrev_b32 v9, 16, v85
    v_and_b32 v10, 0xffff0000, v85
    v_mul_f32 v7, 0.15915494, v7
    v_mul_f32 v8, 0.15915494, v8
    v_mul_f32 v9, 0.15915494, v9
    v_mul_f32 v10, 0.15915494, v10
    v_mul_hi_u32_u24 v14, 429497, v76
    v_lshrrev_b32 v12, 3, v80
    v_cos_f32 v7, v7
    v_lshlrev_b16 v13, 3, v80
    v_mad_i32_i24 v11, v14, s55, v76
    v_bitop3_b32 v12, v6, v13, v12 bitop3:0xca
    v_lshl_add_u32 v11, v11, 17, s40
    v_lshlrev_b16 v14, 8, v14
    v_lshrrev_b32 v13, 2, v80
    v_add_u32 v76, v12, v11
    v_bitop3_b32 v80, v5, v13, v14 bitop3:0xea
    ds_add_u32 v80, v2
    v_mul_hi_u32_u24 v14, 429497, v77
    v_lshrrev_b32 v12, 3, v81
    v_cos_f32 v8, v8
    v_lshlrev_b16 v13, 3, v81
    v_mad_i32_i24 v11, v14, s55, v77
    v_bitop3_b32 v12, v6, v13, v12 bitop3:0xca
    v_lshl_add_u32 v11, v11, 17, s40
    v_lshlrev_b16 v14, 8, v14
    v_lshrrev_b32 v13, 2, v81
    v_add_u32 v77, v12, v11
    v_bitop3_b32 v81, v5, v13, v14 bitop3:0xea
    ds_add_u32 v81, v2
    v_cvt_pk_bf16_f32 v84, v7, v8
    v_perm_b32 v12, v84, v84, s41
    v_bitop3_b32 v76, v4, v12, v76 bitop3:0xca
    v_perm_b32 v13, v84, v84, s42
    v_bitop3_b32 v77, v4, v13, v77 bitop3:0xca
    v_mul_hi_u32_u24 v14, 429497, v78
    v_lshrrev_b32 v12, 3, v82
    v_cos_f32 v9, v9
    v_lshlrev_b16 v13, 3, v82
    v_mad_i32_i24 v11, v14, s55, v78
    v_bitop3_b32 v12, v6, v13, v12 bitop3:0xca
    v_lshl_add_u32 v11, v11, 17, s40
    v_lshlrev_b16 v14, 8, v14
    v_lshrrev_b32 v13, 2, v82
    v_add_u32 v78, v12, v11
    v_bitop3_b32 v82, v5, v13, v14 bitop3:0xea
    ds_add_u32 v82, v2
    v_mul_hi_u32_u24 v14, 429497, v79
    v_lshrrev_b32 v12, 3, v83
    v_cos_f32 v10, v10
    v_lshlrev_b16 v13, 3, v83
    v_mad_i32_i24 v11, v14, s55, v79
    v_bitop3_b32 v12, v6, v13, v12 bitop3:0xca
    v_lshl_add_u32 v11, v11, 17, s40
    v_lshlrev_b16 v14, 8, v14
    v_lshrrev_b32 v13, 2, v83
    v_add_u32 v79, v12, v11
    v_bitop3_b32 v83, v5, v13, v14 bitop3:0xea
    ds_add_u32 v83, v2
    v_cvt_pk_bf16_f32 v85, v9, v10
    v_perm_b32 v12, v85, v85, s41
    v_bitop3_b32 v78, v4, v12, v78 bitop3:0xca
    v_perm_b32 v13, v85, v85, s42
    v_bitop3_b32 v79, v4, v13, v79 bitop3:0xca
    s_waitcnt vmcnt(5)
    v_lshlrev_b32 v7, 16, v86
    v_and_b32 v8, 0xffff0000, v86
    v_lshlrev_b32 v9, 16, v87
    v_and_b32 v10, 0xffff0000, v87
    v_mul_f32 v7, 0.15915494, v7
    v_mul_f32 v8, 0.15915494, v8
    v_mul_f32 v9, 0.15915494, v9
    v_mul_f32 v10, 0.15915494, v10
    v_mul_hi_u32_u24 v14, 429497, v88
    v_lshrrev_b32 v12, 3, v92
    v_cos_f32 v7, v7
    v_lshlrev_b16 v13, 3, v92
    v_mad_i32_i24 v11, v14, s55, v88
    v_bitop3_b32 v12, v6, v13, v12 bitop3:0xca
    v_lshl_add_u32 v11, v11, 17, s40
    v_lshlrev_b16 v14, 8, v14
    v_lshrrev_b32 v13, 2, v92
    v_add_u32 v88, v12, v11
    v_bitop3_b32 v92, v5, v13, v14 bitop3:0xea
    ds_add_u32 v92, v2
    v_mul_hi_u32_u24 v14, 429497, v89
    v_lshrrev_b32 v12, 3, v93
    v_cos_f32 v8, v8
    v_lshlrev_b16 v13, 3, v93
    v_mad_i32_i24 v11, v14, s55, v89
    v_bitop3_b32 v12, v6, v13, v12 bitop3:0xca
    v_lshl_add_u32 v11, v11, 17, s40
    v_lshlrev_b16 v14, 8, v14
    v_lshrrev_b32 v13, 2, v93
    v_add_u32 v89, v12, v11
    v_bitop3_b32 v93, v5, v13, v14 bitop3:0xea
    ds_add_u32 v93, v2
    v_cvt_pk_bf16_f32 v86, v7, v8
    v_perm_b32 v12, v86, v86, s41
    v_bitop3_b32 v88, v4, v12, v88 bitop3:0xca
    v_perm_b32 v13, v86, v86, s42
    v_bitop3_b32 v89, v4, v13, v89 bitop3:0xca
    v_mul_hi_u32_u24 v14, 429497, v90
    v_lshrrev_b32 v12, 3, v94
    v_cos_f32 v9, v9
    v_lshlrev_b16 v13, 3, v94
    v_mad_i32_i24 v11, v14, s55, v90
    v_bitop3_b32 v12, v6, v13, v12 bitop3:0xca
    v_lshl_add_u32 v11, v11, 17, s40
    v_lshlrev_b16 v14, 8, v14
    v_lshrrev_b32 v13, 2, v94
    v_add_u32 v90, v12, v11
    v_bitop3_b32 v94, v5, v13, v14 bitop3:0xea
    ds_add_u32 v94, v2
    v_mul_hi_u32_u24 v14, 429497, v91
    v_lshrrev_b32 v12, 3, v95
    v_cos_f32 v10, v10
    v_lshlrev_b16 v13, 3, v95
    v_mad_i32_i24 v11, v14, s55, v91
    v_bitop3_b32 v12, v6, v13, v12 bitop3:0xca
    v_lshl_add_u32 v11, v11, 17, s40
    v_lshlrev_b16 v14, 8, v14
    v_lshrrev_b32 v13, 2, v95
    v_add_u32 v91, v12, v11
    v_bitop3_b32 v95, v5, v13, v14 bitop3:0xea
    ds_add_u32 v95, v2
    v_cvt_pk_bf16_f32 v87, v9, v10
    v_perm_b32 v12, v87, v87, s41
    v_bitop3_b32 v90, v4, v12, v90 bitop3:0xca
    v_perm_b32 v13, v87, v87, s42
    v_bitop3_b32 v91, v4, v13, v91 bitop3:0xca
    v_lshrrev_b32 v8, 2, v0
    v_and_b32 v7, 0x3c00, v0
    v_bitop3_b32 v7, v5, v8, v7 bitop3:0xea
    s_waitcnt lgkmcnt(0)
    s_barrier
    ds_read2st64_b32 v[8:9], v7 offset0:0 offset1:1
    ds_read2st64_b32 v[10:11], v7 offset0:2 offset1:3
    s_add_u32 s45, s97, 0x2400000
    v_lshlrev_b32 v112, 1, v1
    buffer_load_dwordx4 v[112:115], v112, s[12:15], s45 offen nt
    s_waitcnt lgkmcnt(0)
    v_lshl_or_b32 v12, v9, 16, v8
    v_lshl_or_b32 v13, v11, 16, v10
    v_mov_b32 v14, v12
    v_mov_b32 v15, v13
    s_nop 0
    v_add_u32_dpp v14, v14, v14 row_shr:1 row_mask:0xf bank_mask:0xf bound_ctrl:1
    v_add_u32_dpp v15, v15, v15 row_shr:1 row_mask:0xf bank_mask:0xf bound_ctrl:1
    s_nop 0
    v_add_u32_dpp v14, v14, v14 row_shr:2 row_mask:0xf bank_mask:0xf bound_ctrl:1
    v_add_u32_dpp v15, v15, v15 row_shr:2 row_mask:0xf bank_mask:0xf bound_ctrl:1
    s_nop 0
    v_add_u32_dpp v14, v14, v14 row_shr:4 row_mask:0xf bank_mask:0xf bound_ctrl:1
    v_add_u32_dpp v15, v15, v15 row_shr:4 row_mask:0xf bank_mask:0xf bound_ctrl:1
    s_nop 0
    v_add_u32_dpp v14, v14, v14 row_shr:8 row_mask:0xf bank_mask:0xf bound_ctrl:1
    v_add_u32_dpp v15, v15, v15 row_shr:8 row_mask:0xf bank_mask:0xf bound_ctrl:1
    s_nop 0
    v_add_u32_dpp v14, v14, v14 row_bcast:15 row_mask:0xa bank_mask:0xf
    v_add_u32_dpp v15, v15, v15 row_bcast:15 row_mask:0xa bank_mask:0xf
    s_nop 0
    v_add_u32_dpp v14, v14, v14 row_bcast:31 row_mask:0xc bank_mask:0xf
    v_add_u32_dpp v15, v15, v15 row_bcast:31 row_mask:0xc bank_mask:0xf
    v_readlane_b32 s48, v14, 63
    v_readlane_b32 s49, v15, 63
    s_lshl_b32 s54, s32, 2
    v_mov_b32 v8, s54
    s_and_b32 s50, s48, 0xffff
    s_lshr_b32 s51, s48, 16
    s_and_b32 s52, s49, 0xffff
    s_lshr_b32 s53, s49, 16
    s_add_u32 s51, s51, s50
    s_add_u32 s52, s52, s51
    s_add_u32 s53, s53, s52
    v_mov_b32 v9, s53
    s_mov_b64 exec, 1
    ds_write_b32 v8, v9 offset:16384
    s_mov_b64 exec, -1
    v_and_b32 v8, 60, v7
    s_waitcnt lgkmcnt(0)
    s_barrier
    ds_read_b32 v9, v8 offset:16384
    s_waitcnt lgkmcnt(0)
    v_add_u32_dpp v9, v9, v9 row_shr:1 row_mask:0xf bank_mask:0xf bound_ctrl:1
    s_nop 1
    v_add_u32_dpp v9, v9, v9 row_shr:2 row_mask:0xf bank_mask:0xf bound_ctrl:1
    s_nop 1
    v_add_u32_dpp v9, v9, v9 row_shr:4 row_mask:0xf bank_mask:0xf bound_ctrl:1
    s_nop 1
    v_add_u32_dpp v9, v9, v9 row_shr:8 row_mask:0xf bank_mask:0xf bound_ctrl:1
    s_nop 0
    v_readlane_b32 s54, v9, s32
    s_sub_u32 s54, s54, s53
    s_add_u32 s50, s50, s54
    s_add_u32 s51, s51, s54
    s_add_u32 s52, s52, s54
    s_pack_ll_b32_b16 s48, s54, s50
    s_pack_ll_b32_b16 s49, s51, s52
    v_add_u32 v14, s48, v14
    v_add_u32 v15, s49, v15
    v_sub_u32 v12, v14, v12
    v_sub_u32 v13, v15, v13
    v_and_b32 v8, 0xffff, v12
    v_lshrrev_b32 v9, 16, v12
    v_and_b32 v10, 0xffff, v13
    v_lshrrev_b32 v11, 16, v13
    ds_write2st64_b32 v7, v8, v9 offset0:0 offset1:1
    ds_write2st64_b32 v7, v10, v11 offset0:2 offset1:3
    v_and_b32 v8, 0x3f0, v0
    v_lshl_add_u32 v8, v8, 1, s36
    ds_write_b64 v8, v[12:13] offset:20480
    s_bitset0_b64 exec, 63
    s_not_b64 exec, exec
    ds_write_b64 v8, v[14:15] offset:20512
    s_mov_b64 exec, -1
    s_waitcnt lgkmcnt(0)
    s_barrier
    s_setprio 3
    ds_add_rtn_u32 v20, v20, v2
    ds_add_rtn_u32 v21, v21, v2
    ds_add_rtn_u32 v22, v22, v2
    ds_add_rtn_u32 v23, v23, v2
    ds_read_b128 v[12:15], v0 offset:20480
    v_cmp_gt_u32 vcc, 8448, v0
    ds_add_rtn_u32 v32, v32, v2
    ds_add_rtn_u32 v33, v33, v2
    ds_add_rtn_u32 v34, v34, v2
    ds_add_rtn_u32 v35, v35, v2
    s_setprio 2
    ds_add_rtn_u32 v40, v40, v2
    ds_add_rtn_u32 v41, v41, v2
    ds_add_rtn_u32 v42, v42, v2
    ds_add_rtn_u32 v43, v43, v2
    s_waitcnt lgkmcnt(8)
    s_cbranch_vccz L1_p1
    s_add_u32 s46, s35, 0x0
    s_mov_b64 exec, vcc
    buffer_store_dwordx4 v[12:15], v0, s[24:27], s46 offen sc1
    s_mov_b64 exec, -1
L1_p1:
    s_add_u32 s47, s98, 0x2800000
    v_lshlrev_b32 v116, 1, v1
    buffer_load_dwordx4 v[116:119], v116, s[8:11], s47 offen nt
    ds_add_rtn_u32 v52, v52, v2
    ds_add_rtn_u32 v53, v53, v2
    ds_add_rtn_u32 v54, v54, v2
    ds_add_rtn_u32 v55, v55, v2
    s_setprio 1
    ds_add_rtn_u32 v60, v60, v2
    ds_add_rtn_u32 v61, v61, v2
    ds_add_rtn_u32 v62, v62, v2
    ds_add_rtn_u32 v63, v63, v2
    ds_add_rtn_u32 v72, v72, v2
    ds_add_rtn_u32 v73, v73, v2
    ds_add_rtn_u32 v74, v74, v2
    ds_add_rtn_u32 v75, v75, v2
    s_add_u32 s44, s98, 0x2800000
    v_lshlrev_b32 v120, 1, v1
    buffer_load_dwordx4 v[120:123], v120, s[12:15], s44 offen nt
    s_setprio 0
    ds_add_rtn_u32 v80, v80, v2
    ds_add_rtn_u32 v81, v81, v2
    ds_add_rtn_u32 v82, v82, v2
    ds_add_rtn_u32 v83, v83, v2
    ds_add_rtn_u32 v92, v92, v2
    ds_add_rtn_u32 v93, v93, v2
    ds_add_rtn_u32 v94, v94, v2
    ds_add_rtn_u32 v95, v95, v2
    s_waitcnt lgkmcnt(0)
    s_barrier
    s_setprio 3
    v_and_b32 v7, -4, v20
    v_lshl_add_u32 v8, v20, 2, v7
    ds_write_b32 v8, v16
    v_lshl_add_u32 v7, v7, 2, v20
    ds_write_b8 v7, v24 offset:16
    v_and_b32 v9, -4, v21
    v_lshl_add_u32 v10, v21, 2, v9
    ds_write_b32 v10, v17
    v_lshl_add_u32 v9, v9, 2, v21
    ds_write_b8_d16_hi v9, v24 offset:16
    v_and_b32 v7, -4, v22
    v_lshl_add_u32 v8, v22, 2, v7
    ds_write_b32 v8, v18
    v_lshl_add_u32 v7, v7, 2, v22
    ds_write_b8 v7, v25 offset:16
    v_and_b32 v9, -4, v23
    v_lshl_add_u32 v10, v23, 2, v9
    ds_write_b32 v10, v19
    v_lshl_add_u32 v9, v9, 2, v23
    ds_write_b8_d16_hi v9, v25 offset:16
    s_add_u32 s45, s98, 0x2800000
    s_lshr_b32 s45, s45, 1
    buffer_load_dwordx2 v[124:125], v1, s[16:19], s45 offen nt
    s_add_u32 s46, s99, 0x2c00000
    s_lshr_b32 s46, s46, 1
    buffer_load_dwordx2 v[126:127], v1, s[16:19], s46 offen nt
    s_add_u32 s47, s99, 0x2c00000
    v_lshlrev_b32 v16, 1, v1
    buffer_load_dwordx4 v[16:19], v16, s[8:11], s47 offen nt
    v_and_b32 v7, -4, v32
    v_lshl_add_u32 v8, v32, 2, v7
    ds_write_b32 v8, v28
    v_lshl_add_u32 v7, v7, 2, v32
    ds_write_b8 v7, v26 offset:16
    v_and_b32 v9, -4, v33
    v_lshl_add_u32 v10, v33, 2, v9
    ds_write_b32 v10, v29
    v_lshl_add_u32 v9, v9, 2, v33
    ds_write_b8_d16_hi v9, v26 offset:16
    v_and_b32 v7, -4, v34
    v_lshl_add_u32 v8, v34, 2, v7
    ds_write_b32 v8, v30
    v_lshl_add_u32 v7, v7, 2, v34
    ds_write_b8 v7, v27 offset:16
    v_and_b32 v9, -4, v35
    v_lshl_add_u32 v10, v35, 2, v9
    ds_write_b32 v10, v31
    v_lshl_add_u32 v9, v9, 2, v35
    ds_write_b8_d16_hi v9, v27 offset:16
    s_add_u32 s44, s99, 0x2c00000
    v_lshlrev_b32 v20, 1, v1
    buffer_load_dwordx4 v[20:23], v20, s[12:15], s44 offen nt
    s_setprio 2
    v_and_b32 v7, -4, v40
    v_lshl_add_u32 v8, v40, 2, v7
    ds_write_b32 v8, v36
    v_lshl_add_u32 v7, v7, 2, v40
    ds_write_b8 v7, v44 offset:16
    v_and_b32 v9, -4, v41
    v_lshl_add_u32 v10, v41, 2, v9
    ds_write_b32 v10, v37
    v_lshl_add_u32 v9, v9, 2, v41
    ds_write_b8_d16_hi v9, v44 offset:16
    v_and_b32 v7, -4, v42
    v_lshl_add_u32 v8, v42, 2, v7
    ds_write_b32 v8, v38
    v_lshl_add_u32 v7, v7, 2, v42
    ds_write_b8 v7, v45 offset:16
    v_and_b32 v9, -4, v43
    v_lshl_add_u32 v10, v43, 2, v9
    ds_write_b32 v10, v39
    v_lshl_add_u32 v9, v9, 2, v43
    ds_write_b8_d16_hi v9, v45 offset:16
    s_add_u32 s45, s96, 0x3000000
    v_lshlrev_b32 v28, 1, v1
    buffer_load_dwordx4 v[28:31], v28, s[8:11], s45 offen nt
    s_add_u32 s46, s96, 0x3000000
    v_lshlrev_b32 v32, 1, v1
    buffer_load_dwordx4 v[32:35], v32, s[12:15], s46 offen nt
    v_and_b32 v7, -4, v52
    v_lshl_add_u32 v8, v52, 2, v7
    ds_write_b32 v8, v48
    v_lshl_add_u32 v7, v7, 2, v52
    ds_write_b8 v7, v46 offset:16
    v_and_b32 v9, -4, v53
    v_lshl_add_u32 v10, v53, 2, v9
    ds_write_b32 v10, v49
    v_lshl_add_u32 v9, v9, 2, v53
    ds_write_b8_d16_hi v9, v46 offset:16
    v_and_b32 v7, -4, v54
    v_lshl_add_u32 v8, v54, 2, v7
    ds_write_b32 v8, v50
    v_lshl_add_u32 v7, v7, 2, v54
    ds_write_b8 v7, v47 offset:16
    v_and_b32 v9, -4, v55
    v_lshl_add_u32 v10, v55, 2, v9
    ds_write_b32 v10, v51
    v_lshl_add_u32 v9, v9, 2, v55
    ds_write_b8_d16_hi v9, v47 offset:16
    s_add_u32 s47, s96, 0x3000000
    s_lshr_b32 s47, s47, 1
    buffer_load_dwordx2 v[24:25], v1, s[16:19], s47 offen nt
    s_add_u32 s44, s97, 0x3400000
    s_lshr_b32 s44, s44, 1
    buffer_load_dwordx2 v[26:27], v1, s[16:19], s44 offen nt
    s_setprio 1
    v_and_b32 v7, -4, v60
    v_lshl_add_u32 v8, v60, 2, v7
    ds_write_b32 v8, v56
    v_lshl_add_u32 v7, v7, 2, v60
    ds_write_b8 v7, v64 offset:16
    v_and_b32 v9, -4, v61
    v_lshl_add_u32 v10, v61, 2, v9
    ds_write_b32 v10, v57
    v_lshl_add_u32 v9, v9, 2, v61
    ds_write_b8_d16_hi v9, v64 offset:16
    v_and_b32 v7, -4, v62
    v_lshl_add_u32 v8, v62, 2, v7
    ds_write_b32 v8, v58
    v_lshl_add_u32 v7, v7, 2, v62
    ds_write_b8 v7, v65 offset:16
    v_and_b32 v9, -4, v63
    v_lshl_add_u32 v10, v63, 2, v9
    ds_write_b32 v10, v59
    v_lshl_add_u32 v9, v9, 2, v63
    ds_write_b8_d16_hi v9, v65 offset:16
    s_add_u32 s45, s97, 0x3400000
    v_lshlrev_b32 v36, 1, v1
    buffer_load_dwordx4 v[36:39], v36, s[8:11], s45 offen nt
    v_and_b32 v7, -4, v72
    v_lshl_add_u32 v8, v72, 2, v7
    ds_write_b32 v8, v68
    v_lshl_add_u32 v7, v7, 2, v72
    ds_write_b8 v7, v66 offset:16
    v_and_b32 v9, -4, v73
    v_lshl_add_u32 v10, v73, 2, v9
    ds_write_b32 v10, v69
    v_lshl_add_u32 v9, v9, 2, v73
    ds_write_b8_d16_hi v9, v66 offset:16
    v_and_b32 v7, -4, v74
    v_lshl_add_u32 v8, v74, 2, v7
    ds_write_b32 v8, v70
    v_lshl_add_u32 v7, v7, 2, v74
    ds_write_b8 v7, v67 offset:16
    v_and_b32 v9, -4, v75
    v_lshl_add_u32 v10, v75, 2, v9
    ds_write_b32 v10, v71
    v_lshl_add_u32 v9, v9, 2, v75
    ds_write_b8_d16_hi v9, v67 offset:16
    s_add_u32 s46, s97, 0x3400000
    v_lshlrev_b32 v40, 1, v1
    buffer_load_dwordx4 v[40:43], v40, s[12:15], s46 offen nt
    s_add_u32 s47, s98, 0x3800000
    v_lshlrev_b32 v48, 1, v1
    buffer_load_dwordx4 v[48:51], v48, s[8:11], s47 offen nt
    s_setprio 0
    v_and_b32 v7, -4, v80
    v_lshl_add_u32 v8, v80, 2, v7
    ds_write_b32 v8, v76
    v_lshl_add_u32 v7, v7, 2, v80
    ds_write_b8 v7, v84 offset:16
    v_and_b32 v9, -4, v81
    v_lshl_add_u32 v10, v81, 2, v9
    ds_write_b32 v10, v77
    v_lshl_add_u32 v9, v9, 2, v81
    ds_write_b8_d16_hi v9, v84 offset:16
    v_and_b32 v7, -4, v82
    v_lshl_add_u32 v8, v82, 2, v7
    ds_write_b32 v8, v78
    v_lshl_add_u32 v7, v7, 2, v82
    ds_write_b8 v7, v85 offset:16
    v_and_b32 v9, -4, v83
    v_lshl_add_u32 v10, v83, 2, v9
    ds_write_b32 v10, v79
    v_lshl_add_u32 v9, v9, 2, v83
    ds_write_b8_d16_hi v9, v85 offset:16
    s_add_u32 s44, s98, 0x3800000
    v_lshlrev_b32 v52, 1, v1
    buffer_load_dwordx4 v[52:55], v52, s[12:15], s44 offen nt
    v_and_b32 v7, -4, v92
    v_lshl_add_u32 v8, v92, 2, v7
    ds_write_b32 v8, v88
    v_lshl_add_u32 v7, v7, 2, v92
    ds_write_b8 v7, v86 offset:16
    v_and_b32 v9, -4, v93
    v_lshl_add_u32 v10, v93, 2, v9
    ds_write_b32 v10, v89
    v_lshl_add_u32 v9, v9, 2, v93
    ds_write_b8_d16_hi v9, v86 offset:16
    v_and_b32 v7, -4, v94
    v_lshl_add_u32 v8, v94, 2, v7
    ds_write_b32 v8, v90
    v_lshl_add_u32 v7, v7, 2, v94
    ds_write_b8 v7, v87 offset:16
    v_and_b32 v9, -4, v95
    v_lshl_add_u32 v10, v95, 2, v9
    ds_write_b32 v10, v91
    v_lshl_add_u32 v9, v9, 2, v95
    ds_write_b8_d16_hi v9, v87 offset:16
    s_add_u32 s45, s98, 0x3800000
    s_lshr_b32 s45, s45, 1
    buffer_load_dwordx2 v[44:45], v1, s[16:19], s45 offen nt
    s_add_u32 s46, s99, 0x3c00000
    s_lshr_b32 s46, s46, 1
    buffer_load_dwordx2 v[46:47], v1, s[16:19], s46 offen nt
    v_add_u32 v7, s72, v0
    v_add_u32 v12, s73, v0
    v_add_u32 v13, s85, v0
    v_add_u32 v14, s91, v0
    v_add_u32 v15, s93, v0
    s_min_i32 s3, s72, s73
    s_min_i32 s3, s3, s85
    s_min_i32 s3, s3, s91
    s_min_i32 s3, s3, s93
    v_add_u32 v3, s3, v0
    v_mov_b32 v8, 0
    v_mov_b32 v9, 0
    v_mov_b32 v10, 0
    v_mov_b32 v11, 0
    s_waitcnt lgkmcnt(0)
    s_barrier
    ds_read_b128 v[56:59], v7 offset:0
    ds_read_b128 v[60:63], v12 offset:0
    ds_read_b128 v[68:71], v13 offset:0
    ds_read_b128 v[72:75], v14 offset:0
    ds_read_b128 v[64:67], v15 offset:0
    ds_write_b128 v3, v[8:11]
    ds_read_b128 v[76:79], v7 offset:16384
    ds_read_b128 v[80:83], v12 offset:16384
    ds_read_b128 v[88:91], v13 offset:16384
    ds_read_b128 v[92:95], v14 offset:16384
    ds_read_b128 v[84:87], v15 offset:16384
    s_waitcnt lgkmcnt(0)
    s_barrier
    s_setprio 3
    s_add_u32 s47, s35, 0x4000
    s_add_u32 s47, s47, s72
    buffer_store_dwordx4 v[56:59], v0, s[20:23], s47 offen sc1
    s_add_u32 s44, s99, 0x3c00000
    s_nop 0
    v_lshlrev_b32 v56, 1, v1
    buffer_load_dwordx4 v[56:59], v56, s[8:11], s44 offen nt
    s_add_u32 s45, s35, 0x4000
    s_add_u32 s45, s45, s73
    buffer_store_dwordx4 v[60:63], v0, s[20:23], s45 offen sc1
    s_add_u32 s46, s99, 0x3c00000
    s_nop 0
    v_lshlrev_b32 v60, 1, v1
    buffer_load_dwordx4 v[60:63], v60, s[12:15], s46 offen nt
    s_waitcnt vmcnt(22)
    v_lshlrev_b32 v7, 16, v108
    v_and_b32 v8, 0xffff0000, v108
    v_lshlrev_b32 v9, 16, v109
    v_and_b32 v10, 0xffff0000, v109
    v_mul_f32 v7, 0.15915494, v7
    v_mul_f32 v8, 0.15915494, v8
    v_mul_f32 v9, 0.15915494, v9
    v_mul_f32 v10, 0.15915494, v10
    v_mul_hi_u32_u24 v14, 429497, v96
    v_lshrrev_b32 v12, 3, v104
    v_cos_f32 v7, v7
    v_lshlrev_b16 v13, 3, v104
    v_mad_i32_i24 v11, v14, s55, v96
    v_bitop3_b32 v12, v6, v13, v12 bitop3:0xca
    v_lshl_add_u32 v11, v11, 17, s40
    v_lshlrev_b16 v14, 8, v14
    v_lshrrev_b32 v13, 2, v104
    v_add_u32 v96, v12, v11
    v_bitop3_b32 v104, v5, v13, v14 bitop3:0xea
    ds_add_u32 v104, v2
    v_mul_hi_u32_u24 v14, 429497, v97
    v_lshrrev_b32 v12, 3, v105
    v_cos_f32 v8, v8
    v_lshlrev_b16 v13, 3, v105
    v_mad_i32_i24 v11, v14, s55, v97
    v_bitop3_b32 v12, v6, v13, v12 bitop3:0xca
    v_lshl_add_u32 v11, v11, 17, s40
    v_lshlrev_b16 v14, 8, v14
    v_lshrrev_b32 v13, 2, v105
    v_add_u32 v97, v12, v11
    v_bitop3_b32 v105, v5, v13, v14 bitop3:0xea
    ds_add_u32 v105, v2
    v_cvt_pk_bf16_f32 v108, v7, v8
    v_perm_b32 v12, v108, v108, s41
    v_bitop3_b32 v96, v4, v12, v96 bitop3:0xca
    v_perm_b32 v13, v108, v108, s42
    v_bitop3_b32 v97, v4, v13, v97 bitop3:0xca
    v_mul_hi_u32_u24 v14, 429497, v98
    v_lshrrev_b32 v12, 3, v106
    v_cos_f32 v9, v9
    v_lshlrev_b16 v13, 3, v106
    v_mad_i32_i24 v11, v14, s55, v98
    v_bitop3_b32 v12, v6, v13, v12 bitop3:0xca
    v_lshl_add_u32 v11, v11, 17, s40
    v_lshlrev_b16 v14, 8, v14
    v_lshrrev_b32 v13, 2, v106
    v_add_u32 v98, v12, v11
    v_bitop3_b32 v106, v5, v13, v14 bitop3:0xea
    ds_add_u32 v106, v2
    v_mul_hi_u32_u24 v14, 429497, v99
    v_lshrrev_b32 v12, 3, v107
    v_cos_f32 v10, v10
    v_lshlrev_b16 v13, 3, v107
    v_mad_i32_i24 v11, v14, s55, v99
    v_bitop3_b32 v12, v6, v13, v12 bitop3:0xca
    v_lshl_add_u32 v11, v11, 17, s40
    v_lshlrev_b16 v14, 8, v14
    v_lshrrev_b32 v13, 2, v107
    v_add_u32 v99, v12, v11
    v_bitop3_b32 v107, v5, v13, v14 bitop3:0xea
    ds_add_u32 v107, v2
    v_cvt_pk_bf16_f32 v109, v9, v10
    v_perm_b32 v12, v109, v109, s41
    v_bitop3_b32 v98, v4, v12, v98 bitop3:0xca
    v_perm_b32 v13, v109, v109, s42
    v_bitop3_b32 v99, v4, v13, v99 bitop3:0xca
    s_waitcnt vmcnt(20)
    v_lshlrev_b32 v7, 16, v110
    v_and_b32 v8, 0xffff0000, v110
    v_lshlrev_b32 v9, 16, v111
    v_and_b32 v10, 0xffff0000, v111
    v_mul_f32 v7, 0.15915494, v7
    v_mul_f32 v8, 0.15915494, v8
    v_mul_f32 v9, 0.15915494, v9
    v_mul_f32 v10, 0.15915494, v10
    v_mul_hi_u32_u24 v14, 429497, v100
    v_lshrrev_b32 v12, 3, v112
    v_cos_f32 v7, v7
    v_lshlrev_b16 v13, 3, v112
    v_mad_i32_i24 v11, v14, s55, v100
    v_bitop3_b32 v12, v6, v13, v12 bitop3:0xca
    v_lshl_add_u32 v11, v11, 17, s40
    v_lshlrev_b16 v14, 8, v14
    v_lshrrev_b32 v13, 2, v112
    v_add_u32 v100, v12, v11
    v_bitop3_b32 v112, v5, v13, v14 bitop3:0xea
    ds_add_u32 v112, v2
    v_mul_hi_u32_u24 v14, 429497, v101
    v_lshrrev_b32 v12, 3, v113
    v_cos_f32 v8, v8
    v_lshlrev_b16 v13, 3, v113
    v_mad_i32_i24 v11, v14, s55, v101
    v_bitop3_b32 v12, v6, v13, v12 bitop3:0xca
    v_lshl_add_u32 v11, v11, 17, s40
    v_lshlrev_b16 v14, 8, v14
    v_lshrrev_b32 v13, 2, v113
    v_add_u32 v101, v12, v11
    v_bitop3_b32 v113, v5, v13, v14 bitop3:0xea
    ds_add_u32 v113, v2
    v_cvt_pk_bf16_f32 v110, v7, v8
    v_perm_b32 v12, v110, v110, s41
    v_bitop3_b32 v100, v4, v12, v100 bitop3:0xca
    v_perm_b32 v13, v110, v110, s42
    v_bitop3_b32 v101, v4, v13, v101 bitop3:0xca
    v_mul_hi_u32_u24 v14, 429497, v102
    v_lshrrev_b32 v12, 3, v114
    v_cos_f32 v9, v9
    v_lshlrev_b16 v13, 3, v114
    v_mad_i32_i24 v11, v14, s55, v102
    v_bitop3_b32 v12, v6, v13, v12 bitop3:0xca
    v_lshl_add_u32 v11, v11, 17, s40
    v_lshlrev_b16 v14, 8, v14
    v_lshrrev_b32 v13, 2, v114
    v_add_u32 v102, v12, v11
    v_bitop3_b32 v114, v5, v13, v14 bitop3:0xea
    ds_add_u32 v114, v2
    v_mul_hi_u32_u24 v14, 429497, v103
    v_lshrrev_b32 v12, 3, v115
    v_cos_f32 v10, v10
    v_lshlrev_b16 v13, 3, v115
    v_mad_i32_i24 v11, v14, s55, v103
    v_bitop3_b32 v12, v6, v13, v12 bitop3:0xca
    v_lshl_add_u32 v11, v11, 17, s40
    v_lshlrev_b16 v14, 8, v14
    v_lshrrev_b32 v13, 2, v115
    v_add_u32 v103, v12, v11
    v_bitop3_b32 v115, v5, v13, v14 bitop3:0xea
    ds_add_u32 v115, v2
    v_cvt_pk_bf16_f32 v111, v9, v10
    v_perm_b32 v12, v111, v111, s41
    v_bitop3_b32 v102, v4, v12, v102 bitop3:0xca
    v_perm_b32 v13, v111, v111, s42
    v_bitop3_b32 v103, v4, v13, v103 bitop3:0xca
    s_setprio 2
    s_waitcnt vmcnt(16)
    v_lshlrev_b32 v7, 16, v124
    v_and_b32 v8, 0xffff0000, v124
    v_lshlrev_b32 v9, 16, v125
    v_and_b32 v10, 0xffff0000, v125
    v_mul_f32 v7, 0.15915494, v7
    v_mul_f32 v8, 0.15915494, v8
    v_mul_f32 v9, 0.15915494, v9
    v_mul_f32 v10, 0.15915494, v10
    v_mul_hi_u32_u24 v14, 429497, v116
    v_lshrrev_b32 v12, 3, v120
    v_cos_f32 v7, v7
    v_lshlrev_b16 v13, 3, v120
    v_mad_i32_i24 v11, v14, s55, v116
    v_bitop3_b32 v12, v6, v13, v12 bitop3:0xca
    v_lshl_add_u32 v11, v11, 17, s40
    v_lshlrev_b16 v14, 8, v14
    v_lshrrev_b32 v13, 2, v120
    v_add_u32 v116, v12, v11
    v_bitop3_b32 v120, v5, v13, v14 bitop3:0xea
    ds_add_u32 v120, v2
    v_mul_hi_u32_u24 v14, 429497, v117
    v_lshrrev_b32 v12, 3, v121
    v_cos_f32 v8, v8
    v_lshlrev_b16 v13, 3, v121
    v_mad_i32_i24 v11, v14, s55, v117
    v_bitop3_b32 v12, v6, v13, v12 bitop3:0xca
    v_lshl_add_u32 v11, v11, 17, s40
    v_lshlrev_b16 v14, 8, v14
    v_lshrrev_b32 v13, 2, v121
    v_add_u32 v117, v12, v11
    v_bitop3_b32 v121, v5, v13, v14 bitop3:0xea
    ds_add_u32 v121, v2
    v_cvt_pk_bf16_f32 v124, v7, v8
    v_perm_b32 v12, v124, v124, s41
    v_bitop3_b32 v116, v4, v12, v116 bitop3:0xca
    v_perm_b32 v13, v124, v124, s42
    v_bitop3_b32 v117, v4, v13, v117 bitop3:0xca
    v_mul_hi_u32_u24 v14, 429497, v118
    v_lshrrev_b32 v12, 3, v122
    v_cos_f32 v9, v9
    v_lshlrev_b16 v13, 3, v122
    v_mad_i32_i24 v11, v14, s55, v118
    v_bitop3_b32 v12, v6, v13, v12 bitop3:0xca
    v_lshl_add_u32 v11, v11, 17, s40
    v_lshlrev_b16 v14, 8, v14
    v_lshrrev_b32 v13, 2, v122
    v_add_u32 v118, v12, v11
    v_bitop3_b32 v122, v5, v13, v14 bitop3:0xea
    ds_add_u32 v122, v2
    v_mul_hi_u32_u24 v14, 429497, v119
    v_lshrrev_b32 v12, 3, v123
    v_cos_f32 v10, v10
    v_lshlrev_b16 v13, 3, v123
    v_mad_i32_i24 v11, v14, s55, v119
    v_bitop3_b32 v12, v6, v13, v12 bitop3:0xca
    v_lshl_add_u32 v11, v11, 17, s40
    v_lshlrev_b16 v14, 8, v14
    v_lshrrev_b32 v13, 2, v123
    v_add_u32 v119, v12, v11
    v_bitop3_b32 v123, v5, v13, v14 bitop3:0xea
    ds_add_u32 v123, v2
    v_cvt_pk_bf16_f32 v125, v9, v10
    v_perm_b32 v12, v125, v125, s41
    v_bitop3_b32 v118, v4, v12, v118 bitop3:0xca
    v_perm_b32 v13, v125, v125, s42
    v_bitop3_b32 v119, v4, v13, v119 bitop3:0xca
    s_add_u32 s47, s35, 0x4000
    s_add_u32 s47, s47, s85
    buffer_store_dwordx4 v[68:71], v0, s[20:23], s47 offen sc1
    s_add_u32 s44, s96, 0x4000000
    s_nop 0
    v_lshlrev_b32 v68, 1, v1
    buffer_load_dwordx4 v[68:71], v68, s[8:11], s44 offen nt
    s_waitcnt vmcnt(16)
    v_lshlrev_b32 v7, 16, v126
    v_and_b32 v8, 0xffff0000, v126
    v_lshlrev_b32 v9, 16, v127
    v_and_b32 v10, 0xffff0000, v127
    v_mul_f32 v7, 0.15915494, v7
    v_mul_f32 v8, 0.15915494, v8
    v_mul_f32 v9, 0.15915494, v9
    v_mul_f32 v10, 0.15915494, v10
    v_mul_hi_u32_u24 v14, 429497, v16
    v_lshrrev_b32 v12, 3, v20
    v_cos_f32 v7, v7
    v_lshlrev_b16 v13, 3, v20
    v_mad_i32_i24 v11, v14, s55, v16
    v_bitop3_b32 v12, v6, v13, v12 bitop3:0xca
    v_lshl_add_u32 v11, v11, 17, s40
    v_lshlrev_b16 v14, 8, v14
    v_lshrrev_b32 v13, 2, v20
    v_add_u32 v16, v12, v11
    v_bitop3_b32 v20, v5, v13, v14 bitop3:0xea
    ds_add_u32 v20, v2
    v_mul_hi_u32_u24 v14, 429497, v17
    v_lshrrev_b32 v12, 3, v21
    v_cos_f32 v8, v8
    v_lshlrev_b16 v13, 3, v21
    v_mad_i32_i24 v11, v14, s55, v17
    v_bitop3_b32 v12, v6, v13, v12 bitop3:0xca
    v_lshl_add_u32 v11, v11, 17, s40
    v_lshlrev_b16 v14, 8, v14
    v_lshrrev_b32 v13, 2, v21
    v_add_u32 v17, v12, v11
    v_bitop3_b32 v21, v5, v13, v14 bitop3:0xea
    ds_add_u32 v21, v2
    v_cvt_pk_bf16_f32 v126, v7, v8
    v_perm_b32 v12, v126, v126, s41
    v_bitop3_b32 v16, v4, v12, v16 bitop3:0xca
    v_perm_b32 v13, v126, v126, s42
    v_bitop3_b32 v17, v4, v13, v17 bitop3:0xca
    v_mul_hi_u32_u24 v14, 429497, v18
    v_lshrrev_b32 v12, 3, v22
    v_cos_f32 v9, v9
    v_lshlrev_b16 v13, 3, v22
    v_mad_i32_i24 v11, v14, s55, v18
    v_bitop3_b32 v12, v6, v13, v12 bitop3:0xca
    v_lshl_add_u32 v11, v11, 17, s40
    v_lshlrev_b16 v14, 8, v14
    v_lshrrev_b32 v13, 2, v22
    v_add_u32 v18, v12, v11
    v_bitop3_b32 v22, v5, v13, v14 bitop3:0xea
    ds_add_u32 v22, v2
    v_mul_hi_u32_u24 v14, 429497, v19
    v_lshrrev_b32 v12, 3, v23
    v_cos_f32 v10, v10
    v_lshlrev_b16 v13, 3, v23
    v_mad_i32_i24 v11, v14, s55, v19
    v_bitop3_b32 v12, v6, v13, v12 bitop3:0xca
    v_lshl_add_u32 v11, v11, 17, s40
    v_lshlrev_b16 v14, 8, v14
    v_lshrrev_b32 v13, 2, v23
    v_add_u32 v19, v12, v11
    v_bitop3_b32 v23, v5, v13, v14 bitop3:0xea
    ds_add_u32 v23, v2
    v_cvt_pk_bf16_f32 v127, v9, v10
    v_perm_b32 v12, v127, v127, s41
    v_bitop3_b32 v18, v4, v12, v18 bitop3:0xca
    v_perm_b32 v13, v127, v127, s42
    v_bitop3_b32 v19, v4, v13, v19 bitop3:0xca
    s_setprio 1
    s_waitcnt vmcnt(12)
    v_lshlrev_b32 v7, 16, v24
    v_and_b32 v8, 0xffff0000, v24
    v_lshlrev_b32 v9, 16, v25
    v_and_b32 v10, 0xffff0000, v25
    v_mul_f32 v7, 0.15915494, v7
    v_mul_f32 v8, 0.15915494, v8
    v_mul_f32 v9, 0.15915494, v9
    v_mul_f32 v10, 0.15915494, v10
    v_mul_hi_u32_u24 v14, 429497, v28
    v_lshrrev_b32 v12, 3, v32
    v_cos_f32 v7, v7
    v_lshlrev_b16 v13, 3, v32
    v_mad_i32_i24 v11, v14, s55, v28
    v_bitop3_b32 v12, v6, v13, v12 bitop3:0xca
    v_lshl_add_u32 v11, v11, 17, s40
    v_lshlrev_b16 v14, 8, v14
    v_lshrrev_b32 v13, 2, v32
    v_add_u32 v28, v12, v11
    v_bitop3_b32 v32, v5, v13, v14 bitop3:0xea
    ds_add_u32 v32, v2
    v_mul_hi_u32_u24 v14, 429497, v29
    v_lshrrev_b32 v12, 3, v33
    v_cos_f32 v8, v8
    v_lshlrev_b16 v13, 3, v33
    v_mad_i32_i24 v11, v14, s55, v29
    v_bitop3_b32 v12, v6, v13, v12 bitop3:0xca
    v_lshl_add_u32 v11, v11, 17, s40
    v_lshlrev_b16 v14, 8, v14
    v_lshrrev_b32 v13, 2, v33
    v_add_u32 v29, v12, v11
    v_bitop3_b32 v33, v5, v13, v14 bitop3:0xea
    ds_add_u32 v33, v2
    v_cvt_pk_bf16_f32 v24, v7, v8
    v_perm_b32 v12, v24, v24, s41
    v_bitop3_b32 v28, v4, v12, v28 bitop3:0xca
    v_perm_b32 v13, v24, v24, s42
    v_bitop3_b32 v29, v4, v13, v29 bitop3:0xca
    v_mul_hi_u32_u24 v14, 429497, v30
    v_lshrrev_b32 v12, 3, v34
    v_cos_f32 v9, v9
    v_lshlrev_b16 v13, 3, v34
    v_mad_i32_i24 v11, v14, s55, v30
    v_bitop3_b32 v12, v6, v13, v12 bitop3:0xca
    v_lshl_add_u32 v11, v11, 17, s40
    v_lshlrev_b16 v14, 8, v14
    v_lshrrev_b32 v13, 2, v34
    v_add_u32 v30, v12, v11
    v_bitop3_b32 v34, v5, v13, v14 bitop3:0xea
    ds_add_u32 v34, v2
    v_mul_hi_u32_u24 v14, 429497, v31
    v_lshrrev_b32 v12, 3, v35
    v_cos_f32 v10, v10
    v_lshlrev_b16 v13, 3, v35
    v_mad_i32_i24 v11, v14, s55, v31
    v_bitop3_b32 v12, v6, v13, v12 bitop3:0xca
    v_lshl_add_u32 v11, v11, 17, s40
    v_lshlrev_b16 v14, 8, v14
    v_lshrrev_b32 v13, 2, v35
    v_add_u32 v31, v12, v11
    v_bitop3_b32 v35, v5, v13, v14 bitop3:0xea
    ds_add_u32 v35, v2
    v_cvt_pk_bf16_f32 v25, v9, v10
    v_perm_b32 v12, v25, v25, s41
    v_bitop3_b32 v30, v4, v12, v30 bitop3:0xca
    v_perm_b32 v13, v25, v25, s42
    v_bitop3_b32 v31, v4, v13, v31 bitop3:0xca
    s_waitcnt vmcnt(10)
    v_lshlrev_b32 v7, 16, v26
    v_and_b32 v8, 0xffff0000, v26
    v_lshlrev_b32 v9, 16, v27
    v_and_b32 v10, 0xffff0000, v27
    v_mul_f32 v7, 0.15915494, v7
    v_mul_f32 v8, 0.15915494, v8
    v_mul_f32 v9, 0.15915494, v9
    v_mul_f32 v10, 0.15915494, v10
    v_mul_hi_u32_u24 v14, 429497, v36
    v_lshrrev_b32 v12, 3, v40
    v_cos_f32 v7, v7
    v_lshlrev_b16 v13, 3, v40
    v_mad_i32_i24 v11, v14, s55, v36
    v_bitop3_b32 v12, v6, v13, v12 bitop3:0xca
    v_lshl_add_u32 v11, v11, 17, s40
    v_lshlrev_b16 v14, 8, v14
    v_lshrrev_b32 v13, 2, v40
    v_add_u32 v36, v12, v11
    v_bitop3_b32 v40, v5, v13, v14 bitop3:0xea
    ds_add_u32 v40, v2
    v_mul_hi_u32_u24 v14, 429497, v37
    v_lshrrev_b32 v12, 3, v41
    v_cos_f32 v8, v8
    v_lshlrev_b16 v13, 3, v41
    v_mad_i32_i24 v11, v14, s55, v37
    v_bitop3_b32 v12, v6, v13, v12 bitop3:0xca
    v_lshl_add_u32 v11, v11, 17, s40
    v_lshlrev_b16 v14, 8, v14
    v_lshrrev_b32 v13, 2, v41
    v_add_u32 v37, v12, v11
    v_bitop3_b32 v41, v5, v13, v14 bitop3:0xea
    ds_add_u32 v41, v2
    v_cvt_pk_bf16_f32 v26, v7, v8
    v_perm_b32 v12, v26, v26, s41
    v_bitop3_b32 v36, v4, v12, v36 bitop3:0xca
    v_perm_b32 v13, v26, v26, s42
    v_bitop3_b32 v37, v4, v13, v37 bitop3:0xca
    v_mul_hi_u32_u24 v14, 429497, v38
    v_lshrrev_b32 v12, 3, v42
    v_cos_f32 v9, v9
    v_lshlrev_b16 v13, 3, v42
    v_mad_i32_i24 v11, v14, s55, v38
    v_bitop3_b32 v12, v6, v13, v12 bitop3:0xca
    v_lshl_add_u32 v11, v11, 17, s40
    v_lshlrev_b16 v14, 8, v14
    v_lshrrev_b32 v13, 2, v42
    v_add_u32 v38, v12, v11
    v_bitop3_b32 v42, v5, v13, v14 bitop3:0xea
    ds_add_u32 v42, v2
    v_mul_hi_u32_u24 v14, 429497, v39
    v_lshrrev_b32 v12, 3, v43
    v_cos_f32 v10, v10
    v_lshlrev_b16 v13, 3, v43
    v_mad_i32_i24 v11, v14, s55, v39
    v_bitop3_b32 v12, v6, v13, v12 bitop3:0xca
    v_lshl_add_u32 v11, v11, 17, s40
    v_lshlrev_b16 v14, 8, v14
    v_lshrrev_b32 v13, 2, v43
    v_add_u32 v39, v12, v11
    v_bitop3_b32 v43, v5, v13, v14 bitop3:0xea
    ds_add_u32 v43, v2
    v_cvt_pk_bf16_f32 v27, v9, v10
    v_perm_b32 v12, v27, v27, s41
    v_bitop3_b32 v38, v4, v12, v38 bitop3:0xca
    v_perm_b32 v13, v27, v27, s42
    v_bitop3_b32 v39, v4, v13, v39 bitop3:0xca
    s_setprio 0
    s_add_u32 s45, s35, 0x4000
    s_add_u32 s45, s45, s91
    buffer_store_dwordx4 v[72:75], v0, s[20:23], s45 offen sc1
    s_add_u32 s46, s96, 0x4000000
    s_nop 0
    v_lshlrev_b32 v72, 1, v1
    buffer_load_dwordx4 v[72:75], v72, s[12:15], s46 offen nt
    s_waitcnt vmcnt(8)
    v_lshlrev_b32 v7, 16, v44
    v_and_b32 v8, 0xffff0000, v44
    v_lshlrev_b32 v9, 16, v45
    v_and_b32 v10, 0xffff0000, v45
    v_mul_f32 v7, 0.15915494, v7
    v_mul_f32 v8, 0.15915494, v8
    v_mul_f32 v9, 0.15915494, v9
    v_mul_f32 v10, 0.15915494, v10
    v_mul_hi_u32_u24 v14, 429497, v48
    v_lshrrev_b32 v12, 3, v52
    v_cos_f32 v7, v7
    v_lshlrev_b16 v13, 3, v52
    v_mad_i32_i24 v11, v14, s55, v48
    v_bitop3_b32 v12, v6, v13, v12 bitop3:0xca
    v_lshl_add_u32 v11, v11, 17, s40
    v_lshlrev_b16 v14, 8, v14
    v_lshrrev_b32 v13, 2, v52
    v_add_u32 v48, v12, v11
    v_bitop3_b32 v52, v5, v13, v14 bitop3:0xea
    ds_add_u32 v52, v2
    v_mul_hi_u32_u24 v14, 429497, v49
    v_lshrrev_b32 v12, 3, v53
    v_cos_f32 v8, v8
    v_lshlrev_b16 v13, 3, v53
    v_mad_i32_i24 v11, v14, s55, v49
    v_bitop3_b32 v12, v6, v13, v12 bitop3:0xca
    v_lshl_add_u32 v11, v11, 17, s40
    v_lshlrev_b16 v14, 8, v14
    v_lshrrev_b32 v13, 2, v53
    v_add_u32 v49, v12, v11
    v_bitop3_b32 v53, v5, v13, v14 bitop3:0xea
    ds_add_u32 v53, v2
    v_cvt_pk_bf16_f32 v44, v7, v8
    v_perm_b32 v12, v44, v44, s41
    v_bitop3_b32 v48, v4, v12, v48 bitop3:0xca
    v_perm_b32 v13, v44, v44, s42
    v_bitop3_b32 v49, v4, v13, v49 bitop3:0xca
    v_mul_hi_u32_u24 v14, 429497, v50
    v_lshrrev_b32 v12, 3, v54
    v_cos_f32 v9, v9
    v_lshlrev_b16 v13, 3, v54
    v_mad_i32_i24 v11, v14, s55, v50
    v_bitop3_b32 v12, v6, v13, v12 bitop3:0xca
    v_lshl_add_u32 v11, v11, 17, s40
    v_lshlrev_b16 v14, 8, v14
    v_lshrrev_b32 v13, 2, v54
    v_add_u32 v50, v12, v11
    v_bitop3_b32 v54, v5, v13, v14 bitop3:0xea
    ds_add_u32 v54, v2
    v_mul_hi_u32_u24 v14, 429497, v51
    v_lshrrev_b32 v12, 3, v55
    v_cos_f32 v10, v10
    v_lshlrev_b16 v13, 3, v55
    v_mad_i32_i24 v11, v14, s55, v51
    v_bitop3_b32 v12, v6, v13, v12 bitop3:0xca
    v_lshl_add_u32 v11, v11, 17, s40
    v_lshlrev_b16 v14, 8, v14
    v_lshrrev_b32 v13, 2, v55
    v_add_u32 v51, v12, v11
    v_bitop3_b32 v55, v5, v13, v14 bitop3:0xea
    ds_add_u32 v55, v2
    v_cvt_pk_bf16_f32 v45, v9, v10
    v_perm_b32 v12, v45, v45, s41
    v_bitop3_b32 v50, v4, v12, v50 bitop3:0xca
    v_perm_b32 v13, v45, v45, s42
    v_bitop3_b32 v51, v4, v13, v51 bitop3:0xca
    s_waitcnt vmcnt(4)
    v_lshlrev_b32 v7, 16, v46
    v_and_b32 v8, 0xffff0000, v46
    v_lshlrev_b32 v9, 16, v47
    v_and_b32 v10, 0xffff0000, v47
    v_mul_f32 v7, 0.15915494, v7
    v_mul_f32 v8, 0.15915494, v8
    v_mul_f32 v9, 0.15915494, v9
    v_mul_f32 v10, 0.15915494, v10
    v_mul_hi_u32_u24 v14, 429497, v56
    v_lshrrev_b32 v12, 3, v60
    v_cos_f32 v7, v7
    v_lshlrev_b16 v13, 3, v60
    v_mad_i32_i24 v11, v14, s55, v56
    v_bitop3_b32 v12, v6, v13, v12 bitop3:0xca
    v_lshl_add_u32 v11, v11, 17, s40
    v_lshlrev_b16 v14, 8, v14
    v_lshrrev_b32 v13, 2, v60
    v_add_u32 v56, v12, v11
    v_bitop3_b32 v60, v5, v13, v14 bitop3:0xea
    ds_add_u32 v60, v2
    v_mul_hi_u32_u24 v14, 429497, v57
    v_lshrrev_b32 v12, 3, v61
    v_cos_f32 v8, v8
    v_lshlrev_b16 v13, 3, v61
    v_mad_i32_i24 v11, v14, s55, v57
    v_bitop3_b32 v12, v6, v13, v12 bitop3:0xca
    v_lshl_add_u32 v11, v11, 17, s40
    v_lshlrev_b16 v14, 8, v14
    v_lshrrev_b32 v13, 2, v61
    v_add_u32 v57, v12, v11
    v_bitop3_b32 v61, v5, v13, v14 bitop3:0xea
    ds_add_u32 v61, v2
    v_cvt_pk_bf16_f32 v46, v7, v8
    v_perm_b32 v12, v46, v46, s41
    v_bitop3_b32 v56, v4, v12, v56 bitop3:0xca
    v_perm_b32 v13, v46, v46, s42
    v_bitop3_b32 v57, v4, v13, v57 bitop3:0xca
    v_mul_hi_u32_u24 v14, 429497, v58
    v_lshrrev_b32 v12, 3, v62
    v_cos_f32 v9, v9
    v_lshlrev_b16 v13, 3, v62
    v_mad_i32_i24 v11, v14, s55, v58
    v_bitop3_b32 v12, v6, v13, v12 bitop3:0xca
    v_lshl_add_u32 v11, v11, 17, s40
    v_lshlrev_b16 v14, 8, v14
    v_lshrrev_b32 v13, 2, v62
    v_add_u32 v58, v12, v11
    v_bitop3_b32 v62, v5, v13, v14 bitop3:0xea
    ds_add_u32 v62, v2
    v_mul_hi_u32_u24 v14, 429497, v59
    v_lshrrev_b32 v12, 3, v63
    v_cos_f32 v10, v10
    v_lshlrev_b16 v13, 3, v63
    v_mad_i32_i24 v11, v14, s55, v59
    v_bitop3_b32 v12, v6, v13, v12 bitop3:0xca
    v_lshl_add_u32 v11, v11, 17, s40
    v_lshlrev_b16 v14, 8, v14
    v_lshrrev_b32 v13, 2, v63
    v_add_u32 v59, v12, v11
    v_bitop3_b32 v63, v5, v13, v14 bitop3:0xea
    ds_add_u32 v63, v2
    v_cvt_pk_bf16_f32 v47, v9, v10
    v_perm_b32 v12, v47, v47, s41
    v_bitop3_b32 v58, v4, v12, v58 bitop3:0xca
    v_perm_b32 v13, v47, v47, s42
    v_bitop3_b32 v59, v4, v13, v59 bitop3:0xca
    v_lshrrev_b32 v8, 2, v0
    v_and_b32 v7, 0x3c00, v0
    v_bitop3_b32 v7, v5, v8, v7 bitop3:0xea
    s_waitcnt lgkmcnt(0)
    s_barrier
    ds_read2st64_b32 v[8:9], v7 offset0:0 offset1:1
    ds_read2st64_b32 v[10:11], v7 offset0:2 offset1:3
    s_add_u32 s47, s35, 0x4000
    s_add_u32 s47, s47, s93
    buffer_store_dwordx4 v[64:67], v0, s[20:23], s47 offen sc1
    s_add_u32 s44, s96, 0x4000000
    s_lshr_b32 s44, s44, 1
    buffer_load_dwordx2 v[64:65], v1, s[16:19], s44 offen nt
    s_add_u32 s45, s97, 0x4400000
    s_lshr_b32 s45, s45, 1
    buffer_load_dwordx2 v[66:67], v1, s[16:19], s45 offen nt
    s_waitcnt lgkmcnt(0)
    v_lshl_or_b32 v12, v9, 16, v8
    v_lshl_or_b32 v13, v11, 16, v10
    v_mov_b32 v14, v12
    v_mov_b32 v15, v13
    s_nop 0
    v_add_u32_dpp v14, v14, v14 row_shr:1 row_mask:0xf bank_mask:0xf bound_ctrl:1
    v_add_u32_dpp v15, v15, v15 row_shr:1 row_mask:0xf bank_mask:0xf bound_ctrl:1
    s_nop 0
    v_add_u32_dpp v14, v14, v14 row_shr:2 row_mask:0xf bank_mask:0xf bound_ctrl:1
    v_add_u32_dpp v15, v15, v15 row_shr:2 row_mask:0xf bank_mask:0xf bound_ctrl:1
    s_nop 0
    v_add_u32_dpp v14, v14, v14 row_shr:4 row_mask:0xf bank_mask:0xf bound_ctrl:1
    v_add_u32_dpp v15, v15, v15 row_shr:4 row_mask:0xf bank_mask:0xf bound_ctrl:1
    s_nop 0
    v_add_u32_dpp v14, v14, v14 row_shr:8 row_mask:0xf bank_mask:0xf bound_ctrl:1
    v_add_u32_dpp v15, v15, v15 row_shr:8 row_mask:0xf bank_mask:0xf bound_ctrl:1
    s_nop 0
    v_add_u32_dpp v14, v14, v14 row_bcast:15 row_mask:0xa bank_mask:0xf
    v_add_u32_dpp v15, v15, v15 row_bcast:15 row_mask:0xa bank_mask:0xf
    s_nop 0
    v_add_u32_dpp v14, v14, v14 row_bcast:31 row_mask:0xc bank_mask:0xf
    v_add_u32_dpp v15, v15, v15 row_bcast:31 row_mask:0xc bank_mask:0xf
    v_readlane_b32 s48, v14, 63
    v_readlane_b32 s49, v15, 63
    s_lshl_b32 s54, s32, 2
    v_mov_b32 v8, s54
    s_and_b32 s50, s48, 0xffff
    s_lshr_b32 s51, s48, 16
    s_and_b32 s52, s49, 0xffff
    s_lshr_b32 s53, s49, 16
    s_add_u32 s51, s51, s50
    s_add_u32 s52, s52, s51
    s_add_u32 s53, s53, s52
    v_mov_b32 v9, s53
    s_mov_b64 exec, 1
    ds_write_b32 v8, v9 offset:16384
    s_mov_b64 exec, -1
    v_and_b32 v8, 60, v7
    s_waitcnt lgkmcnt(0)
    s_barrier
    ds_read_b32 v9, v8 offset:16384
    s_waitcnt lgkmcnt(0)
    v_add_u32_dpp v9, v9, v9 row_shr:1 row_mask:0xf bank_mask:0xf bound_ctrl:1
    s_nop 1
    v_add_u32_dpp v9, v9, v9 row_shr:2 row_mask:0xf bank_mask:0xf bound_ctrl:1
    s_nop 1
    v_add_u32_dpp v9, v9, v9 row_shr:4 row_mask:0xf bank_mask:0xf bound_ctrl:1
    s_nop 1
    v_add_u32_dpp v9, v9, v9 row_shr:8 row_mask:0xf bank_mask:0xf bound_ctrl:1
    s_nop 0
    v_readlane_b32 s54, v9, s32
    s_sub_u32 s54, s54, s53
    s_add_u32 s50, s50, s54
    s_add_u32 s51, s51, s54
    s_add_u32 s52, s52, s54
    s_pack_ll_b32_b16 s48, s54, s50
    s_pack_ll_b32_b16 s49, s51, s52
    v_add_u32 v14, s48, v14
    v_add_u32 v15, s49, v15
    v_sub_u32 v12, v14, v12
    v_sub_u32 v13, v15, v13
    v_and_b32 v8, 0xffff, v12
    v_lshrrev_b32 v9, 16, v12
    v_and_b32 v10, 0xffff, v13
    v_lshrrev_b32 v11, 16, v13
    ds_write2st64_b32 v7, v8, v9 offset0:0 offset1:1
    ds_write2st64_b32 v7, v10, v11 offset0:2 offset1:3
    v_and_b32 v8, 0x3f0, v0
    v_lshl_add_u32 v8, v8, 1, s36
    ds_write_b64 v8, v[12:13] offset:20480
    s_bitset0_b64 exec, 63
    s_not_b64 exec, exec
    ds_write_b64 v8, v[14:15] offset:20512
    s_mov_b64 exec, -1
    s_waitcnt lgkmcnt(0)
    s_barrier
    s_setprio 3
    ds_add_rtn_u32 v104, v104, v2
    ds_add_rtn_u32 v105, v105, v2
    ds_add_rtn_u32 v106, v106, v2
    ds_add_rtn_u32 v107, v107, v2
    ds_read_b128 v[12:15], v0 offset:20480
    v_cmp_gt_u32 vcc, 8448, v0
    ds_add_rtn_u32 v112, v112, v2
    ds_add_rtn_u32 v113, v113, v2
    ds_add_rtn_u32 v114, v114, v2
    ds_add_rtn_u32 v115, v115, v2
    s_setprio 2
    ds_add_rtn_u32 v120, v120, v2
    ds_add_rtn_u32 v121, v121, v2
    ds_add_rtn_u32 v122, v122, v2
    ds_add_rtn_u32 v123, v123, v2
    s_waitcnt lgkmcnt(8)
    s_cbranch_vccz L1_p2
    s_add_u32 s46, s35, 0x2a40000
    s_mov_b64 exec, vcc
    buffer_store_dwordx4 v[12:15], v0, s[24:27], s46 offen sc1
    s_mov_b64 exec, -1
L1_p2:
    s_add_u32 s47, s35, 0x8000
    s_add_u32 s47, s47, s72
    buffer_store_dwordx4 v[76:79], v0, s[20:23], s47 offen sc1
    s_add_u32 s44, s97, 0x4400000
    s_nop 0
    v_lshlrev_b32 v76, 1, v1
    buffer_load_dwordx4 v[76:79], v76, s[8:11], s44 offen nt
    ds_add_rtn_u32 v20, v20, v2
    ds_add_rtn_u32 v21, v21, v2
    ds_add_rtn_u32 v22, v22, v2
    ds_add_rtn_u32 v23, v23, v2
    s_setprio 1
    ds_add_rtn_u32 v32, v32, v2
    ds_add_rtn_u32 v33, v33, v2
    ds_add_rtn_u32 v34, v34, v2
    ds_add_rtn_u32 v35, v35, v2
    ds_add_rtn_u32 v40, v40, v2
    ds_add_rtn_u32 v41, v41, v2
    ds_add_rtn_u32 v42, v42, v2
    ds_add_rtn_u32 v43, v43, v2
    s_add_u32 s45, s35, 0x8000
    s_add_u32 s45, s45, s73
    buffer_store_dwordx4 v[80:83], v0, s[20:23], s45 offen sc1
    s_add_u32 s46, s97, 0x4400000
    s_nop 0
    v_lshlrev_b32 v80, 1, v1
    buffer_load_dwordx4 v[80:83], v80, s[12:15], s46 offen nt
    s_setprio 0
    ds_add_rtn_u32 v52, v52, v2
    ds_add_rtn_u32 v53, v53, v2
    ds_add_rtn_u32 v54, v54, v2
    ds_add_rtn_u32 v55, v55, v2
    ds_add_rtn_u32 v60, v60, v2
    ds_add_rtn_u32 v61, v61, v2
    ds_add_rtn_u32 v62, v62, v2
    ds_add_rtn_u32 v63, v63, v2
    s_waitcnt lgkmcnt(0)
    s_barrier
    s_setprio 3
    v_and_b32 v7, -4, v104
    v_lshl_add_u32 v8, v104, 2, v7
    ds_write_b32 v8, v96
    v_lshl_add_u32 v7, v7, 2, v104
    ds_write_b8 v7, v108 offset:16
    v_and_b32 v9, -4, v105
    v_lshl_add_u32 v10, v105, 2, v9
    ds_write_b32 v10, v97
    v_lshl_add_u32 v9, v9, 2, v105
    ds_write_b8_d16_hi v9, v108 offset:16
    v_and_b32 v7, -4, v106
    v_lshl_add_u32 v8, v106, 2, v7
    ds_write_b32 v8, v98
    v_lshl_add_u32 v7, v7, 2, v106
    ds_write_b8 v7, v109 offset:16
    v_and_b32 v9, -4, v107
    v_lshl_add_u32 v10, v107, 2, v9
    ds_write_b32 v10, v99
    v_lshl_add_u32 v9, v9, 2, v107
    ds_write_b8_d16_hi v9, v109 offset:16
    s_add_u32 s47, s35, 0x8000
    s_add_u32 s47, s47, s85
    buffer_store_dwordx4 v[88:91], v0, s[20:23], s47 offen sc1
    s_add_u32 s44, s98, 0x4800000
    v_lshlrev_b32 v96, 1, v1
    buffer_load_dwordx4 v[96:99], v96, s[8:11], s44 offen nt
    s_add_u32 s45, s98, 0x4800000
    v_lshlrev_b32 v104, 1, v1
    buffer_load_dwordx4 v[104:107], v104, s[12:15], s45 offen nt
    v_and_b32 v7, -4, v112
    v_lshl_add_u32 v8, v112, 2, v7
    ds_write_b32 v8, v100
    v_lshl_add_u32 v7, v7, 2, v112
    ds_write_b8 v7, v110 offset:16
    v_and_b32 v9, -4, v113
    v_lshl_add_u32 v10, v113, 2, v9
    ds_write_b32 v10, v101
    v_lshl_add_u32 v9, v9, 2, v113
    ds_write_b8_d16_hi v9, v110 offset:16
    v_and_b32 v7, -4, v114
    v_lshl_add_u32 v8, v114, 2, v7
    ds_write_b32 v8, v102
    v_lshl_add_u32 v7, v7, 2, v114
    ds_write_b8 v7, v111 offset:16
    v_and_b32 v9, -4, v115
    v_lshl_add_u32 v10, v115, 2, v9
    ds_write_b32 v10, v103
    v_lshl_add_u32 v9, v9, 2, v115
    ds_write_b8_d16_hi v9, v111 offset:16
    s_add_u32 s46, s98, 0x4800000
    s_lshr_b32 s46, s46, 1
    buffer_load_dwordx2 v[88:89], v1, s[16:19], s46 offen nt
    s_add_u32 s47, s99, 0x4c00000
    s_lshr_b32 s47, s47, 1
    buffer_load_dwordx2 v[90:91], v1, s[16:19], s47 offen nt
    s_add_u32 s44, s99, 0x4c00000
    v_lshlrev_b32 v100, 1, v1
    buffer_load_dwordx4 v[100:103], v100, s[8:11], s44 offen nt
    s_setprio 2
    v_and_b32 v7, -4, v120
    v_lshl_add_u32 v8, v120, 2, v7
    ds_write_b32 v8, v116
    v_lshl_add_u32 v7, v7, 2, v120
    ds_write_b8 v7, v124 offset:16
    v_and_b32 v9, -4, v121
    v_lshl_add_u32 v10, v121, 2, v9
    ds_write_b32 v10, v117
    v_lshl_add_u32 v9, v9, 2, v121
    ds_write_b8_d16_hi v9, v124 offset:16
    v_and_b32 v7, -4, v122
    v_lshl_add_u32 v8, v122, 2, v7
    ds_write_b32 v8, v118
    v_lshl_add_u32 v7, v7, 2, v122
    ds_write_b8 v7, v125 offset:16
    v_and_b32 v9, -4, v123
    v_lshl_add_u32 v10, v123, 2, v9
    ds_write_b32 v10, v119
    v_lshl_add_u32 v9, v9, 2, v123
    ds_write_b8_d16_hi v9, v125 offset:16
    s_add_u32 s45, s35, 0x8000
    s_add_u32 s45, s45, s91
    buffer_store_dwordx4 v[92:95], v0, s[20:23], s45 offen sc1
    s_add_u32 s46, s99, 0x4c00000
    v_lshlrev_b32 v112, 1, v1
    buffer_load_dwordx4 v[112:115], v112, s[12:15], s46 offen nt
    v_and_b32 v7, -4, v20
    v_lshl_add_u32 v8, v20, 2, v7
    ds_write_b32 v8, v16
    v_lshl_add_u32 v7, v7, 2, v20
    ds_write_b8 v7, v126 offset:16
    v_and_b32 v9, -4, v21
    v_lshl_add_u32 v10, v21, 2, v9
    ds_write_b32 v10, v17
    v_lshl_add_u32 v9, v9, 2, v21
    ds_write_b8_d16_hi v9, v126 offset:16
    v_and_b32 v7, -4, v22
    v_lshl_add_u32 v8, v22, 2, v7
    ds_write_b32 v8, v18
    v_lshl_add_u32 v7, v7, 2, v22
    ds_write_b8 v7, v127 offset:16
    v_and_b32 v9, -4, v23
    v_lshl_add_u32 v10, v23, 2, v9
    ds_write_b32 v10, v19
    v_lshl_add_u32 v9, v9, 2, v23
    ds_write_b8_d16_hi v9, v127 offset:16
    s_add_u32 s47, s96, 0x5000000
    v_lshlrev_b32 v108, 1, v1
    buffer_load_dwordx4 v[108:111], v108, s[8:11], s47 offen nt
    s_add_u32 s44, s96, 0x5000000
    v_lshlrev_b32 v116, 1, v1
    buffer_load_dwordx4 v[116:119], v116, s[12:15], s44 offen nt
    s_setprio 1
    v_and_b32 v7, -4, v32
    v_lshl_add_u32 v8, v32, 2, v7
    ds_write_b32 v8, v28
    v_lshl_add_u32 v7, v7, 2, v32
    ds_write_b8 v7, v24 offset:16
    v_and_b32 v9, -4, v33
    v_lshl_add_u32 v10, v33, 2, v9
    ds_write_b32 v10, v29
    v_lshl_add_u32 v9, v9, 2, v33
    ds_write_b8_d16_hi v9, v24 offset:16
    v_and_b32 v7, -4, v34
    v_lshl_add_u32 v8, v34, 2, v7
    ds_write_b32 v8, v30
    v_lshl_add_u32 v7, v7, 2, v34
    ds_write_b8 v7, v25 offset:16
    v_and_b32 v9, -4, v35
    v_lshl_add_u32 v10, v35, 2, v9
    ds_write_b32 v10, v31
    v_lshl_add_u32 v9, v9, 2, v35
    ds_write_b8_d16_hi v9, v25 offset:16
    s_add_u32 s45, s96, 0x5000000
    s_lshr_b32 s45, s45, 1
    buffer_load_dwordx2 v[120:121], v1, s[16:19], s45 offen nt
    s_add_u32 s46, s97, 0x5400000
    s_lshr_b32 s46, s46, 1
    buffer_load_dwordx2 v[122:123], v1, s[16:19], s46 offen nt
    s_add_u32 s47, s97, 0x5400000
    v_lshlrev_b32 v92, 1, v1
    buffer_load_dwordx4 v[92:95], v92, s[8:11], s47 offen nt
    v_and_b32 v7, -4, v40
    v_lshl_add_u32 v8, v40, 2, v7
    ds_write_b32 v8, v36
    v_lshl_add_u32 v7, v7, 2, v40
    ds_write_b8 v7, v26 offset:16
    v_and_b32 v9, -4, v41
    v_lshl_add_u32 v10, v41, 2, v9
    ds_write_b32 v10, v37
    v_lshl_add_u32 v9, v9, 2, v41
    ds_write_b8_d16_hi v9, v26 offset:16
    v_and_b32 v7, -4, v42
    v_lshl_add_u32 v8, v42, 2, v7
    ds_write_b32 v8, v38
    v_lshl_add_u32 v7, v7, 2, v42
    ds_write_b8 v7, v27 offset:16
    v_and_b32 v9, -4, v43
    v_lshl_add_u32 v10, v43, 2, v9
    ds_write_b32 v10, v39
    v_lshl_add_u32 v9, v9, 2, v43
    ds_write_b8_d16_hi v9, v27 offset:16
    s_add_u32 s44, s35, 0x8000
    s_add_u32 s44, s44, s93
    buffer_store_dwordx4 v[84:87], v0, s[20:23], s44 offen sc1
    s_add_u32 s45, s97, 0x5400000
    v_lshlrev_b32 v16, 1, v1
    buffer_load_dwordx4 v[16:19], v16, s[12:15], s45 offen nt
    s_setprio 0
    v_and_b32 v7, -4, v52
    v_lshl_add_u32 v8, v52, 2, v7
    ds_write_b32 v8, v48
    v_lshl_add_u32 v7, v7, 2, v52
    ds_write_b8 v7, v44 offset:16
    v_and_b32 v9, -4, v53
    v_lshl_add_u32 v10, v53, 2, v9
    ds_write_b32 v10, v49
    v_lshl_add_u32 v9, v9, 2, v53
    ds_write_b8_d16_hi v9, v44 offset:16
    v_and_b32 v7, -4, v54
    v_lshl_add_u32 v8, v54, 2, v7
    ds_write_b32 v8, v50
    v_lshl_add_u32 v7, v7, 2, v54
    ds_write_b8 v7, v45 offset:16
    v_and_b32 v9, -4, v55
    v_lshl_add_u32 v10, v55, 2, v9
    ds_write_b32 v10, v51
    v_lshl_add_u32 v9, v9, 2, v55
    ds_write_b8_d16_hi v9, v45 offset:16
    s_add_u32 s46, s98, 0x5800000
    v_lshlrev_b32 v20, 1, v1
    buffer_load_dwordx4 v[20:23], v20, s[8:11], s46 offen nt
    s_add_u32 s47, s98, 0x5800000
    v_lshlrev_b32 v124, 1, v1
    buffer_load_dwordx4 v[124:127], v124, s[12:15], s47 offen nt
    v_and_b32 v7, -4, v60
    v_lshl_add_u32 v8, v60, 2, v7
    ds_write_b32 v8, v56
    v_lshl_add_u32 v7, v7, 2, v60
    ds_write_b8 v7, v46 offset:16
    v_and_b32 v9, -4, v61
    v_lshl_add_u32 v10, v61, 2, v9
    ds_write_b32 v10, v57
    v_lshl_add_u32 v9, v9, 2, v61
    ds_write_b8_d16_hi v9, v46 offset:16
    v_and_b32 v7, -4, v62
    v_lshl_add_u32 v8, v62, 2, v7
    ds_write_b32 v8, v58
    v_lshl_add_u32 v7, v7, 2, v62
    ds_write_b8 v7, v47 offset:16
    v_and_b32 v9, -4, v63
    v_lshl_add_u32 v10, v63, 2, v9
    ds_write_b32 v10, v59
    v_lshl_add_u32 v9, v9, 2, v63
    ds_write_b8_d16_hi v9, v47 offset:16
    s_add_u32 s44, s98, 0x5800000
    s_lshr_b32 s44, s44, 1
    buffer_load_dwordx2 v[28:29], v1, s[16:19], s44 offen nt
    s_add_u32 s45, s99, 0x5c00000
    s_lshr_b32 s45, s45, 1
    buffer_load_dwordx2 v[30:31], v1, s[16:19], s45 offen nt
    v_add_u32 v7, s72, v0
    v_add_u32 v12, s73, v0
    v_add_u32 v13, s85, v0
    v_add_u32 v14, s91, v0
    v_add_u32 v15, s93, v0
    s_min_i32 s3, s72, s73
    s_min_i32 s3, s3, s85
    s_min_i32 s3, s3, s91
    s_min_i32 s3, s3, s93
    v_add_u32 v3, s3, v0
    v_mov_b32 v8, 0
    v_mov_b32 v9, 0
    v_mov_b32 v10, 0
    v_mov_b32 v11, 0
    s_waitcnt lgkmcnt(0)
    s_barrier
    ds_read_b128 v[32:35], v7 offset:0
    ds_read_b128 v[36:39], v12 offset:0
    ds_read_b128 v[40:43], v13 offset:0
    ds_read_b128 v[24:27], v14 offset:0
    ds_read_b128 v[84:87], v15 offset:0
    ds_write_b128 v3, v[8:11]
    ds_read_b128 v[48:51], v7 offset:16384
    ds_read_b128 v[52:55], v12 offset:16384
    ds_read_b128 v[56:59], v13 offset:16384
    ds_read_b128 v[60:63], v14 offset:16384
    ds_read_b128 v[44:47], v15 offset:16384
    s_waitcnt lgkmcnt(0)
    s_barrier
    s_setprio 3
    s_add_u32 s46, s35, 0x2a44000
    s_add_u32 s46, s46, s72
    buffer_store_dwordx4 v[32:35], v0, s[20:23], s46 offen sc1
    s_add_u32 s47, s99, 0x5c00000
    s_nop 0
    v_lshlrev_b32 v32, 1, v1
    buffer_load_dwordx4 v[32:35], v32, s[8:11], s47 offen nt
    s_add_u32 s44, s35, 0x2a44000
    s_add_u32 s44, s44, s73
    buffer_store_dwordx4 v[36:39], v0, s[20:23], s44 offen sc1
    s_add_u32 s45, s99, 0x5c00000
    s_nop 0
    v_lshlrev_b32 v36, 1, v1
    buffer_load_dwordx4 v[36:39], v36, s[12:15], s45 offen nt
    s_waitcnt vmcnt(27)
    v_lshlrev_b32 v7, 16, v64
    v_and_b32 v8, 0xffff0000, v64
    v_lshlrev_b32 v9, 16, v65
    v_and_b32 v10, 0xffff0000, v65
    v_mul_f32 v7, 0.15915494, v7
    v_mul_f32 v8, 0.15915494, v8
    v_mul_f32 v9, 0.15915494, v9
    v_mul_f32 v10, 0.15915494, v10
    v_mul_hi_u32_u24 v14, 429497, v68
    v_lshrrev_b32 v12, 3, v72
    v_cos_f32 v7, v7
    v_lshlrev_b16 v13, 3, v72
    v_mad_i32_i24 v11, v14, s55, v68
    v_bitop3_b32 v12, v6, v13, v12 bitop3:0xca
    v_lshl_add_u32 v11, v11, 17, s40
    v_lshlrev_b16 v14, 8, v14
    v_lshrrev_b32 v13, 2, v72
    v_add_u32 v68, v12, v11
    v_bitop3_b32 v72, v5, v13, v14 bitop3:0xea
    ds_add_u32 v72, v2
    v_mul_hi_u32_u24 v14, 429497, v69
    v_lshrrev_b32 v12, 3, v73
    v_cos_f32 v8, v8
    v_lshlrev_b16 v13, 3, v73
    v_mad_i32_i24 v11, v14, s55, v69
    v_bitop3_b32 v12, v6, v13, v12 bitop3:0xca
    v_lshl_add_u32 v11, v11, 17, s40
    v_lshlrev_b16 v14, 8, v14
    v_lshrrev_b32 v13, 2, v73
    v_add_u32 v69, v12, v11
    v_bitop3_b32 v73, v5, v13, v14 bitop3:0xea
    ds_add_u32 v73, v2
    v_cvt_pk_bf16_f32 v64, v7, v8
    v_perm_b32 v12, v64, v64, s41
    v_bitop3_b32 v68, v4, v12, v68 bitop3:0xca
    v_perm_b32 v13, v64, v64, s42
    v_bitop3_b32 v69, v4, v13, v69 bitop3:0xca
    v_mul_hi_u32_u24 v14, 429497, v70
    v_lshrrev_b32 v12, 3, v74
    v_cos_f32 v9, v9
    v_lshlrev_b16 v13, 3, v74
    v_mad_i32_i24 v11, v14, s55, v70
    v_bitop3_b32 v12, v6, v13, v12 bitop3:0xca
    v_lshl_add_u32 v11, v11, 17, s40
    v_lshlrev_b16 v14, 8, v14
    v_lshrrev_b32 v13, 2, v74
    v_add_u32 v70, v12, v11
    v_bitop3_b32 v74, v5, v13, v14 bitop3:0xea
    ds_add_u32 v74, v2
    v_mul_hi_u32_u24 v14, 429497, v71
    v_lshrrev_b32 v12, 3, v75
    v_cos_f32 v10, v10
    v_lshlrev_b16 v13, 3, v75
    v_mad_i32_i24 v11, v14, s55, v71
    v_bitop3_b32 v12, v6, v13, v12 bitop3:0xca
    v_lshl_add_u32 v11, v11, 17, s40
    v_lshlrev_b16 v14, 8, v14
    v_lshrrev_b32 v13, 2, v75
    v_add_u32 v71, v12, v11
    v_bitop3_b32 v75, v5, v13, v14 bitop3:0xea
    ds_add_u32 v75, v2
    v_cvt_pk_bf16_f32 v65, v9, v10
    v_perm_b32 v12, v65, v65, s41
    v_bitop3_b32 v70, v4, v12, v70 bitop3:0xca
    v_perm_b32 v13, v65, v65, s42
    v_bitop3_b32 v71, v4, v13, v71 bitop3:0xca
    s_waitcnt vmcnt(23)
    v_lshlrev_b32 v7, 16, v66
    v_and_b32 v8, 0xffff0000, v66
    v_lshlrev_b32 v9, 16, v67
    v_and_b32 v10, 0xffff0000, v67
    v_mul_f32 v7, 0.15915494, v7
    v_mul_f32 v8, 0.15915494, v8
    v_mul_f32 v9, 0.15915494, v9
    v_mul_f32 v10, 0.15915494, v10
    v_mul_hi_u32_u24 v14, 429497, v76
    v_lshrrev_b32 v12, 3, v80
    v_cos_f32 v7, v7
    v_lshlrev_b16 v13, 3, v80
    v_mad_i32_i24 v11, v14, s55, v76
    v_bitop3_b32 v12, v6, v13, v12 bitop3:0xca
    v_lshl_add_u32 v11, v11, 17, s40
    v_lshlrev_b16 v14, 8, v14
    v_lshrrev_b32 v13, 2, v80
    v_add_u32 v76, v12, v11
    v_bitop3_b32 v80, v5, v13, v14 bitop3:0xea
    ds_add_u32 v80, v2
    v_mul_hi_u32_u24 v14, 429497, v77
    v_lshrrev_b32 v12, 3, v81
    v_cos_f32 v8, v8
    v_lshlrev_b16 v13, 3, v81
    v_mad_i32_i24 v11, v14, s55, v77
    v_bitop3_b32 v12, v6, v13, v12 bitop3:0xca
    v_lshl_add_u32 v11, v11, 17, s40
    v_lshlrev_b16 v14, 8, v14
    v_lshrrev_b32 v13, 2, v81
    v_add_u32 v77, v12, v11
    v_bitop3_b32 v81, v5, v13, v14 bitop3:0xea
    ds_add_u32 v81, v2
    v_cvt_pk_bf16_f32 v66, v7, v8
    v_perm_b32 v12, v66, v66, s41
    v_bitop3_b32 v76, v4, v12, v76 bitop3:0xca
    v_perm_b32 v13, v66, v66, s42
    v_bitop3_b32 v77, v4, v13, v77 bitop3:0xca
    v_mul_hi_u32_u24 v14, 429497, v78
    v_lshrrev_b32 v12, 3, v82
    v_cos_f32 v9, v9
    v_lshlrev_b16 v13, 3, v82
    v_mad_i32_i24 v11, v14, s55, v78
    v_bitop3_b32 v12, v6, v13, v12 bitop3:0xca
    v_lshl_add_u32 v11, v11, 17, s40
    v_lshlrev_b16 v14, 8, v14
    v_lshrrev_b32 v13, 2, v82
    v_add_u32 v78, v12, v11
    v_bitop3_b32 v82, v5, v13, v14 bitop3:0xea
    ds_add_u32 v82, v2
    v_mul_hi_u32_u24 v14, 429497, v79
    v_lshrrev_b32 v12, 3, v83
    v_cos_f32 v10, v10
    v_lshlrev_b16 v13, 3, v83
    v_mad_i32_i24 v11, v14, s55, v79
    v_bitop3_b32 v12, v6, v13, v12 bitop3:0xca
    v_lshl_add_u32 v11, v11, 17, s40
    v_lshlrev_b16 v14, 8, v14
    v_lshrrev_b32 v13, 2, v83
    v_add_u32 v79, v12, v11
    v_bitop3_b32 v83, v5, v13, v14 bitop3:0xea
    ds_add_u32 v83, v2
    v_cvt_pk_bf16_f32 v67, v9, v10
    v_perm_b32 v12, v67, v67, s41
    v_bitop3_b32 v78, v4, v12, v78 bitop3:0xca
    v_perm_b32 v13, v67, v67, s42
    v_bitop3_b32 v79, v4, v13, v79 bitop3:0xca
    s_setprio 2
    s_waitcnt vmcnt(18)
    v_lshlrev_b32 v7, 16, v88
    v_and_b32 v8, 0xffff0000, v88
    v_lshlrev_b32 v9, 16, v89
    v_and_b32 v10, 0xffff0000, v89
    v_mul_f32 v7, 0.15915494, v7
    v_mul_f32 v8, 0.15915494, v8
    v_mul_f32 v9, 0.15915494, v9
    v_mul_f32 v10, 0.15915494, v10
    v_mul_hi_u32_u24 v14, 429497, v96
    v_lshrrev_b32 v12, 3, v104
    v_cos_f32 v7, v7
    v_lshlrev_b16 v13, 3, v104
    v_mad_i32_i24 v11, v14, s55, v96
    v_bitop3_b32 v12, v6, v13, v12 bitop3:0xca
    v_lshl_add_u32 v11, v11, 17, s40
    v_lshlrev_b16 v14, 8, v14
    v_lshrrev_b32 v13, 2, v104
    v_add_u32 v96, v12, v11
    v_bitop3_b32 v104, v5, v13, v14 bitop3:0xea
    ds_add_u32 v104, v2
    v_mul_hi_u32_u24 v14, 429497, v97
    v_lshrrev_b32 v12, 3, v105
    v_cos_f32 v8, v8
    v_lshlrev_b16 v13, 3, v105
    v_mad_i32_i24 v11, v14, s55, v97
    v_bitop3_b32 v12, v6, v13, v12 bitop3:0xca
    v_lshl_add_u32 v11, v11, 17, s40
    v_lshlrev_b16 v14, 8, v14
    v_lshrrev_b32 v13, 2, v105
    v_add_u32 v97, v12, v11
    v_bitop3_b32 v105, v5, v13, v14 bitop3:0xea
    ds_add_u32 v105, v2
    v_cvt_pk_bf16_f32 v88, v7, v8
    v_perm_b32 v12, v88, v88, s41
    v_bitop3_b32 v96, v4, v12, v96 bitop3:0xca
    v_perm_b32 v13, v88, v88, s42
    v_bitop3_b32 v97, v4, v13, v97 bitop3:0xca
    v_mul_hi_u32_u24 v14, 429497, v98
    v_lshrrev_b32 v12, 3, v106
    v_cos_f32 v9, v9
    v_lshlrev_b16 v13, 3, v106
    v_mad_i32_i24 v11, v14, s55, v98
    v_bitop3_b32 v12, v6, v13, v12 bitop3:0xca
    v_lshl_add_u32 v11, v11, 17, s40
    v_lshlrev_b16 v14, 8, v14
    v_lshrrev_b32 v13, 2, v106
    v_add_u32 v98, v12, v11
    v_bitop3_b32 v106, v5, v13, v14 bitop3:0xea
    ds_add_u32 v106, v2
    v_mul_hi_u32_u24 v14, 429497, v99
    v_lshrrev_b32 v12, 3, v107
    v_cos_f32 v10, v10
    v_lshlrev_b16 v13, 3, v107
    v_mad_i32_i24 v11, v14, s55, v99
    v_bitop3_b32 v12, v6, v13, v12 bitop3:0xca
    v_lshl_add_u32 v11, v11, 17, s40
    v_lshlrev_b16 v14, 8, v14
    v_lshrrev_b32 v13, 2, v107
    v_add_u32 v99, v12, v11
    v_bitop3_b32 v107, v5, v13, v14 bitop3:0xea
    ds_add_u32 v107, v2
    v_cvt_pk_bf16_f32 v89, v9, v10
    v_perm_b32 v12, v89, v89, s41
    v_bitop3_b32 v98, v4, v12, v98 bitop3:0xca
    v_perm_b32 v13, v89, v89, s42
    v_bitop3_b32 v99, v4, v13, v99 bitop3:0xca
    s_add_u32 s46, s35, 0x2a44000
    s_add_u32 s46, s46, s85
    buffer_store_dwordx4 v[40:43], v0, s[20:23], s46 offen sc1
    s_add_u32 s47, s96, 0x6000000
    s_nop 0
    v_lshlrev_b32 v40, 1, v1
    buffer_load_dwordx4 v[40:43], v40, s[8:11], s47 offen nt
    s_waitcnt vmcnt(17)
    v_lshlrev_b32 v7, 16, v90
    v_and_b32 v8, 0xffff0000, v90
    v_lshlrev_b32 v9, 16, v91
    v_and_b32 v10, 0xffff0000, v91
    v_mul_f32 v7, 0.15915494, v7
    v_mul_f32 v8, 0.15915494, v8
    v_mul_f32 v9, 0.15915494, v9
    v_mul_f32 v10, 0.15915494, v10
    v_mul_hi_u32_u24 v14, 429497, v100
    v_lshrrev_b32 v12, 3, v112
    v_cos_f32 v7, v7
    v_lshlrev_b16 v13, 3, v112
    v_mad_i32_i24 v11, v14, s55, v100
    v_bitop3_b32 v12, v6, v13, v12 bitop3:0xca
    v_lshl_add_u32 v11, v11, 17, s40
    v_lshlrev_b16 v14, 8, v14
    v_lshrrev_b32 v13, 2, v112
    v_add_u32 v100, v12, v11
    v_bitop3_b32 v112, v5, v13, v14 bitop3:0xea
    ds_add_u32 v112, v2
    v_mul_hi_u32_u24 v14, 429497, v101
    v_lshrrev_b32 v12, 3, v113
    v_cos_f32 v8, v8
    v_lshlrev_b16 v13, 3, v113
    v_mad_i32_i24 v11, v14, s55, v101
    v_bitop3_b32 v12, v6, v13, v12 bitop3:0xca
    v_lshl_add_u32 v11, v11, 17, s40
    v_lshlrev_b16 v14, 8, v14
    v_lshrrev_b32 v13, 2, v113
    v_add_u32 v101, v12, v11
    v_bitop3_b32 v113, v5, v13, v14 bitop3:0xea
    ds_add_u32 v113, v2
    v_cvt_pk_bf16_f32 v90, v7, v8
    v_perm_b32 v12, v90, v90, s41
    v_bitop3_b32 v100, v4, v12, v100 bitop3:0xca
    v_perm_b32 v13, v90, v90, s42
    v_bitop3_b32 v101, v4, v13, v101 bitop3:0xca
    v_mul_hi_u32_u24 v14, 429497, v102
    v_lshrrev_b32 v12, 3, v114
    v_cos_f32 v9, v9
    v_lshlrev_b16 v13, 3, v114
    v_mad_i32_i24 v11, v14, s55, v102
    v_bitop3_b32 v12, v6, v13, v12 bitop3:0xca
    v_lshl_add_u32 v11, v11, 17, s40
    v_lshlrev_b16 v14, 8, v14
    v_lshrrev_b32 v13, 2, v114
    v_add_u32 v102, v12, v11
    v_bitop3_b32 v114, v5, v13, v14 bitop3:0xea
    ds_add_u32 v114, v2
    v_mul_hi_u32_u24 v14, 429497, v103
    v_lshrrev_b32 v12, 3, v115
    v_cos_f32 v10, v10
    v_lshlrev_b16 v13, 3, v115
    v_mad_i32_i24 v11, v14, s55, v103
    v_bitop3_b32 v12, v6, v13, v12 bitop3:0xca
    v_lshl_add_u32 v11, v11, 17, s40
    v_lshlrev_b16 v14, 8, v14
    v_lshrrev_b32 v13, 2, v115
    v_add_u32 v103, v12, v11
    v_bitop3_b32 v115, v5, v13, v14 bitop3:0xea
    ds_add_u32 v115, v2
    v_cvt_pk_bf16_f32 v91, v9, v10
    v_perm_b32 v12, v91, v91, s41
    v_bitop3_b32 v102, v4, v12, v102 bitop3:0xca
    v_perm_b32 v13, v91, v91, s42
    v_bitop3_b32 v103, v4, v13, v103 bitop3:0xca
    s_setprio 1
    s_waitcnt vmcnt(13)
    v_lshlrev_b32 v7, 16, v120
    v_and_b32 v8, 0xffff0000, v120
    v_lshlrev_b32 v9, 16, v121
    v_and_b32 v10, 0xffff0000, v121
    v_mul_f32 v7, 0.15915494, v7
    v_mul_f32 v8, 0.15915494, v8
    v_mul_f32 v9, 0.15915494, v9
    v_mul_f32 v10, 0.15915494, v10
    v_mul_hi_u32_u24 v14, 429497, v108
    v_lshrrev_b32 v12, 3, v116
    v_cos_f32 v7, v7
    v_lshlrev_b16 v13, 3, v116
    v_mad_i32_i24 v11, v14, s55, v108
    v_bitop3_b32 v12, v6, v13, v12 bitop3:0xca
    v_lshl_add_u32 v11, v11, 17, s40
    v_lshlrev_b16 v14, 8, v14
    v_lshrrev_b32 v13, 2, v116
    v_add_u32 v108, v12, v11
    v_bitop3_b32 v116, v5, v13, v14 bitop3:0xea
    ds_add_u32 v116, v2
    v_mul_hi_u32_u24 v14, 429497, v109
    v_lshrrev_b32 v12, 3, v117
    v_cos_f32 v8, v8
    v_lshlrev_b16 v13, 3, v117
    v_mad_i32_i24 v11, v14, s55, v109
    v_bitop3_b32 v12, v6, v13, v12 bitop3:0xca
    v_lshl_add_u32 v11, v11, 17, s40
    v_lshlrev_b16 v14, 8, v14
    v_lshrrev_b32 v13, 2, v117
    v_add_u32 v109, v12, v11
    v_bitop3_b32 v117, v5, v13, v14 bitop3:0xea
    ds_add_u32 v117, v2
    v_cvt_pk_bf16_f32 v120, v7, v8
    v_perm_b32 v12, v120, v120, s41
    v_bitop3_b32 v108, v4, v12, v108 bitop3:0xca
    v_perm_b32 v13, v120, v120, s42
    v_bitop3_b32 v109, v4, v13, v109 bitop3:0xca
    v_mul_hi_u32_u24 v14, 429497, v110
    v_lshrrev_b32 v12, 3, v118
    v_cos_f32 v9, v9
    v_lshlrev_b16 v13, 3, v118
    v_mad_i32_i24 v11, v14, s55, v110
    v_bitop3_b32 v12, v6, v13, v12 bitop3:0xca
    v_lshl_add_u32 v11, v11, 17, s40
    v_lshlrev_b16 v14, 8, v14
    v_lshrrev_b32 v13, 2, v118
    v_add_u32 v110, v12, v11
    v_bitop3_b32 v118, v5, v13, v14 bitop3:0xea
    ds_add_u32 v118, v2
    v_mul_hi_u32_u24 v14, 429497, v111
    v_lshrrev_b32 v12, 3, v119
    v_cos_f32 v10, v10
    v_lshlrev_b16 v13, 3, v119
    v_mad_i32_i24 v11, v14, s55, v111
    v_bitop3_b32 v12, v6, v13, v12 bitop3:0xca
    v_lshl_add_u32 v11, v11, 17, s40
    v_lshlrev_b16 v14, 8, v14
    v_lshrrev_b32 v13, 2, v119
    v_add_u32 v111, v12, v11
    v_bitop3_b32 v119, v5, v13, v14 bitop3:0xea
    ds_add_u32 v119, v2
    v_cvt_pk_bf16_f32 v121, v9, v10
    v_perm_b32 v12, v121, v121, s41
    v_bitop3_b32 v110, v4, v12, v110 bitop3:0xca
    v_perm_b32 v13, v121, v121, s42
    v_bitop3_b32 v111, v4, v13, v111 bitop3:0xca
    s_waitcnt vmcnt(10)
    v_lshlrev_b32 v7, 16, v122
    v_and_b32 v8, 0xffff0000, v122
    v_lshlrev_b32 v9, 16, v123
    v_and_b32 v10, 0xffff0000, v123
    v_mul_f32 v7, 0.15915494, v7
    v_mul_f32 v8, 0.15915494, v8
    v_mul_f32 v9, 0.15915494, v9
    v_mul_f32 v10, 0.15915494, v10
    v_mul_hi_u32_u24 v14, 429497, v92
    v_lshrrev_b32 v12, 3, v16
    v_cos_f32 v7, v7
    v_lshlrev_b16 v13, 3, v16
    v_mad_i32_i24 v11, v14, s55, v92
    v_bitop3_b32 v12, v6, v13, v12 bitop3:0xca
    v_lshl_add_u32 v11, v11, 17, s40
    v_lshlrev_b16 v14, 8, v14
    v_lshrrev_b32 v13, 2, v16
    v_add_u32 v92, v12, v11
    v_bitop3_b32 v16, v5, v13, v14 bitop3:0xea
    ds_add_u32 v16, v2
    v_mul_hi_u32_u24 v14, 429497, v93
    v_lshrrev_b32 v12, 3, v17
    v_cos_f32 v8, v8
    v_lshlrev_b16 v13, 3, v17
    v_mad_i32_i24 v11, v14, s55, v93
    v_bitop3_b32 v12, v6, v13, v12 bitop3:0xca
    v_lshl_add_u32 v11, v11, 17, s40
    v_lshlrev_b16 v14, 8, v14
    v_lshrrev_b32 v13, 2, v17
    v_add_u32 v93, v12, v11
    v_bitop3_b32 v17, v5, v13, v14 bitop3:0xea
    ds_add_u32 v17, v2
    v_cvt_pk_bf16_f32 v122, v7, v8
    v_perm_b32 v12, v122, v122, s41
    v_bitop3_b32 v92, v4, v12, v92 bitop3:0xca
    v_perm_b32 v13, v122, v122, s42
    v_bitop3_b32 v93, v4, v13, v93 bitop3:0xca
    v_mul_hi_u32_u24 v14, 429497, v94
    v_lshrrev_b32 v12, 3, v18
    v_cos_f32 v9, v9
    v_lshlrev_b16 v13, 3, v18
    v_mad_i32_i24 v11, v14, s55, v94
    v_bitop3_b32 v12, v6, v13, v12 bitop3:0xca
    v_lshl_add_u32 v11, v11, 17, s40
    v_lshlrev_b16 v14, 8, v14
    v_lshrrev_b32 v13, 2, v18
    v_add_u32 v94, v12, v11
    v_bitop3_b32 v18, v5, v13, v14 bitop3:0xea
    ds_add_u32 v18, v2
    v_mul_hi_u32_u24 v14, 429497, v95
    v_lshrrev_b32 v12, 3, v19
    v_cos_f32 v10, v10
    v_lshlrev_b16 v13, 3, v19
    v_mad_i32_i24 v11, v14, s55, v95
    v_bitop3_b32 v12, v6, v13, v12 bitop3:0xca
    v_lshl_add_u32 v11, v11, 17, s40
    v_lshlrev_b16 v14, 8, v14
    v_lshrrev_b32 v13, 2, v19
    v_add_u32 v95, v12, v11
    v_bitop3_b32 v19, v5, v13, v14 bitop3:0xea
    ds_add_u32 v19, v2
    v_cvt_pk_bf16_f32 v123, v9, v10
    v_perm_b32 v12, v123, v123, s41
    v_bitop3_b32 v94, v4, v12, v94 bitop3:0xca
    v_perm_b32 v13, v123, v123, s42
    v_bitop3_b32 v95, v4, v13, v95 bitop3:0xca
    s_setprio 0
    s_add_u32 s44, s35, 0x2a44000
    s_add_u32 s44, s44, s91
    buffer_store_dwordx4 v[24:27], v0, s[20:23], s44 offen sc1
    s_add_u32 s45, s96, 0x6000000
    s_nop 0
    v_lshlrev_b32 v24, 1, v1
    buffer_load_dwordx4 v[24:27], v24, s[12:15], s45 offen nt
    s_waitcnt vmcnt(8)
    v_lshlrev_b32 v7, 16, v28
    v_and_b32 v8, 0xffff0000, v28
    v_lshlrev_b32 v9, 16, v29
    v_and_b32 v10, 0xffff0000, v29
    v_mul_f32 v7, 0.15915494, v7
    v_mul_f32 v8, 0.15915494, v8
    v_mul_f32 v9, 0.15915494, v9
    v_mul_f32 v10, 0.15915494, v10
    v_mul_hi_u32_u24 v14, 429497, v20
    v_lshrrev_b32 v12, 3, v124
    v_cos_f32 v7, v7
    v_lshlrev_b16 v13, 3, v124
    v_mad_i32_i24 v11, v14, s55, v20
    v_bitop3_b32 v12, v6, v13, v12 bitop3:0xca
    v_lshl_add_u32 v11, v11, 17, s40
    v_lshlrev_b16 v14, 8, v14
    v_lshrrev_b32 v13, 2, v124
    v_add_u32 v20, v12, v11
    v_bitop3_b32 v124, v5, v13, v14 bitop3:0xea
    ds_add_u32 v124, v2
    v_mul_hi_u32_u24 v14, 429497, v21
    v_lshrrev_b32 v12, 3, v125
    v_cos_f32 v8, v8
    v_lshlrev_b16 v13, 3, v125
    v_mad_i32_i24 v11, v14, s55, v21
    v_bitop3_b32 v12, v6, v13, v12 bitop3:0xca
    v_lshl_add_u32 v11, v11, 17, s40
    v_lshlrev_b16 v14, 8, v14
    v_lshrrev_b32 v13, 2, v125
    v_add_u32 v21, v12, v11
    v_bitop3_b32 v125, v5, v13, v14 bitop3:0xea
    ds_add_u32 v125, v2
    v_cvt_pk_bf16_f32 v28, v7, v8
    v_perm_b32 v12, v28, v28, s41
    v_bitop3_b32 v20, v4, v12, v20 bitop3:0xca
    v_perm_b32 v13, v28, v28, s42
    v_bitop3_b32 v21, v4, v13, v21 bitop3:0xca
    v_mul_hi_u32_u24 v14, 429497, v22
    v_lshrrev_b32 v12, 3, v126
    v_cos_f32 v9, v9
    v_lshlrev_b16 v13, 3, v126
    v_mad_i32_i24 v11, v14, s55, v22
    v_bitop3_b32 v12, v6, v13, v12 bitop3:0xca
    v_lshl_add_u32 v11, v11, 17, s40
    v_lshlrev_b16 v14, 8, v14
    v_lshrrev_b32 v13, 2, v126
    v_add_u32 v22, v12, v11
    v_bitop3_b32 v126, v5, v13, v14 bitop3:0xea
    ds_add_u32 v126, v2
    v_mul_hi_u32_u24 v14, 429497, v23
    v_lshrrev_b32 v12, 3, v127
    v_cos_f32 v10, v10
    v_lshlrev_b16 v13, 3, v127
    v_mad_i32_i24 v11, v14, s55, v23
    v_bitop3_b32 v12, v6, v13, v12 bitop3:0xca
    v_lshl_add_u32 v11, v11, 17, s40
    v_lshlrev_b16 v14, 8, v14
    v_lshrrev_b32 v13, 2, v127
    v_add_u32 v23, v12, v11
    v_bitop3_b32 v127, v5, v13, v14 bitop3:0xea
    ds_add_u32 v127, v2
    v_cvt_pk_bf16_f32 v29, v9, v10
    v_perm_b32 v12, v29, v29, s41
    v_bitop3_b32 v22, v4, v12, v22 bitop3:0xca
    v_perm_b32 v13, v29, v29, s42
    v_bitop3_b32 v23, v4, v13, v23 bitop3:0xca
    s_waitcnt vmcnt(4)
    v_lshlrev_b32 v7, 16, v30
    v_and_b32 v8, 0xffff0000, v30
    v_lshlrev_b32 v9, 16, v31
    v_and_b32 v10, 0xffff0000, v31
    v_mul_f32 v7, 0.15915494, v7
    v_mul_f32 v8, 0.15915494, v8
    v_mul_f32 v9, 0.15915494, v9
    v_mul_f32 v10, 0.15915494, v10
    v_mul_hi_u32_u24 v14, 429497, v32
    v_lshrrev_b32 v12, 3, v36
    v_cos_f32 v7, v7
    v_lshlrev_b16 v13, 3, v36
    v_mad_i32_i24 v11, v14, s55, v32
    v_bitop3_b32 v12, v6, v13, v12 bitop3:0xca
    v_lshl_add_u32 v11, v11, 17, s40
    v_lshlrev_b16 v14, 8, v14
    v_lshrrev_b32 v13, 2, v36
    v_add_u32 v32, v12, v11
    v_bitop3_b32 v36, v5, v13, v14 bitop3:0xea
    ds_add_u32 v36, v2
    v_mul_hi_u32_u24 v14, 429497, v33
    v_lshrrev_b32 v12, 3, v37
    v_cos_f32 v8, v8
    v_lshlrev_b16 v13, 3, v37
    v_mad_i32_i24 v11, v14, s55, v33
    v_bitop3_b32 v12, v6, v13, v12 bitop3:0xca
    v_lshl_add_u32 v11, v11, 17, s40
    v_lshlrev_b16 v14, 8, v14
    v_lshrrev_b32 v13, 2, v37
    v_add_u32 v33, v12, v11
    v_bitop3_b32 v37, v5, v13, v14 bitop3:0xea
    ds_add_u32 v37, v2
    v_cvt_pk_bf16_f32 v30, v7, v8
    v_perm_b32 v12, v30, v30, s41
    v_bitop3_b32 v32, v4, v12, v32 bitop3:0xca
    v_perm_b32 v13, v30, v30, s42
    v_bitop3_b32 v33, v4, v13, v33 bitop3:0xca
    v_mul_hi_u32_u24 v14, 429497, v34
    v_lshrrev_b32 v12, 3, v38
    v_cos_f32 v9, v9
    v_lshlrev_b16 v13, 3, v38
    v_mad_i32_i24 v11, v14, s55, v34
    v_bitop3_b32 v12, v6, v13, v12 bitop3:0xca
    v_lshl_add_u32 v11, v11, 17, s40
    v_lshlrev_b16 v14, 8, v14
    v_lshrrev_b32 v13, 2, v38
    v_add_u32 v34, v12, v11
    v_bitop3_b32 v38, v5, v13, v14 bitop3:0xea
    ds_add_u32 v38, v2
    v_mul_hi_u32_u24 v14, 429497, v35
    v_lshrrev_b32 v12, 3, v39
    v_cos_f32 v10, v10
    v_lshlrev_b16 v13, 3, v39
    v_mad_i32_i24 v11, v14, s55, v35
    v_bitop3_b32 v12, v6, v13, v12 bitop3:0xca
    v_lshl_add_u32 v11, v11, 17, s40
    v_lshlrev_b16 v14, 8, v14
    v_lshrrev_b32 v13, 2, v39
    v_add_u32 v35, v12, v11
    v_bitop3_b32 v39, v5, v13, v14 bitop3:0xea
    ds_add_u32 v39, v2
    v_cvt_pk_bf16_f32 v31, v9, v10
    v_perm_b32 v12, v31, v31, s41
    v_bitop3_b32 v34, v4, v12, v34 bitop3:0xca
    v_perm_b32 v13, v31, v31, s42
    v_bitop3_b32 v35, v4, v13, v35 bitop3:0xca
    v_lshrrev_b32 v8, 2, v0
    v_and_b32 v7, 0x3c00, v0
    v_bitop3_b32 v7, v5, v8, v7 bitop3:0xea
    s_waitcnt lgkmcnt(0)
    s_barrier
    ds_read2st64_b32 v[8:9], v7 offset0:0 offset1:1
    ds_read2st64_b32 v[10:11], v7 offset0:2 offset1:3
    s_add_u32 s46, s35, 0x2a44000
    s_add_u32 s46, s46, s93
    buffer_store_dwordx4 v[84:87], v0, s[20:23], s46 offen sc1
    s_add_u32 s47, s96, 0x6000000
    s_lshr_b32 s47, s47, 1
    buffer_load_dwordx2 v[84:85], v1, s[16:19], s47 offen nt
    s_add_u32 s44, s97, 0x6400000
    s_lshr_b32 s44, s44, 1
    buffer_load_dwordx2 v[86:87], v1, s[16:19], s44 offen nt
    s_waitcnt lgkmcnt(0)
    v_lshl_or_b32 v12, v9, 16, v8
    v_lshl_or_b32 v13, v11, 16, v10
    v_mov_b32 v14, v12
    v_mov_b32 v15, v13
    s_nop 0
    v_add_u32_dpp v14, v14, v14 row_shr:1 row_mask:0xf bank_mask:0xf bound_ctrl:1
    v_add_u32_dpp v15, v15, v15 row_shr:1 row_mask:0xf bank_mask:0xf bound_ctrl:1
    s_nop 0
    v_add_u32_dpp v14, v14, v14 row_shr:2 row_mask:0xf bank_mask:0xf bound_ctrl:1
    v_add_u32_dpp v15, v15, v15 row_shr:2 row_mask:0xf bank_mask:0xf bound_ctrl:1
    s_nop 0
    v_add_u32_dpp v14, v14, v14 row_shr:4 row_mask:0xf bank_mask:0xf bound_ctrl:1
    v_add_u32_dpp v15, v15, v15 row_shr:4 row_mask:0xf bank_mask:0xf bound_ctrl:1
    s_nop 0
    v_add_u32_dpp v14, v14, v14 row_shr:8 row_mask:0xf bank_mask:0xf bound_ctrl:1
    v_add_u32_dpp v15, v15, v15 row_shr:8 row_mask:0xf bank_mask:0xf bound_ctrl:1
    s_nop 0
    v_add_u32_dpp v14, v14, v14 row_bcast:15 row_mask:0xa bank_mask:0xf
    v_add_u32_dpp v15, v15, v15 row_bcast:15 row_mask:0xa bank_mask:0xf
    s_nop 0
    v_add_u32_dpp v14, v14, v14 row_bcast:31 row_mask:0xc bank_mask:0xf
    v_add_u32_dpp v15, v15, v15 row_bcast:31 row_mask:0xc bank_mask:0xf
    v_readlane_b32 s48, v14, 63
    v_readlane_b32 s49, v15, 63
    s_lshl_b32 s54, s32, 2
    v_mov_b32 v8, s54
    s_and_b32 s50, s48, 0xffff
    s_lshr_b32 s51, s48, 16
    s_and_b32 s52, s49, 0xffff
    s_lshr_b32 s53, s49, 16
    s_add_u32 s51, s51, s50
    s_add_u32 s52, s52, s51
    s_add_u32 s53, s53, s52
    v_mov_b32 v9, s53
    s_mov_b64 exec, 1
    ds_write_b32 v8, v9 offset:16384
    s_mov_b64 exec, -1
    v_and_b32 v8, 60, v7
    s_waitcnt lgkmcnt(0)
    s_barrier
    ds_read_b32 v9, v8 offset:16384
    s_waitcnt lgkmcnt(0)
    v_add_u32_dpp v9, v9, v9 row_shr:1 row_mask:0xf bank_mask:0xf bound_ctrl:1
    s_nop 1
    v_add_u32_dpp v9, v9, v9 row_shr:2 row_mask:0xf bank_mask:0xf bound_ctrl:1
    s_nop 1
    v_add_u32_dpp v9, v9, v9 row_shr:4 row_mask:0xf bank_mask:0xf bound_ctrl:1
    s_nop 1
    v_add_u32_dpp v9, v9, v9 row_shr:8 row_mask:0xf bank_mask:0xf bound_ctrl:1
    s_nop 0
    v_readlane_b32 s54, v9, s32
    s_sub_u32 s54, s54, s53
    s_add_u32 s50, s50, s54
    s_add_u32 s51, s51, s54
    s_add_u32 s52, s52, s54
    s_pack_ll_b32_b16 s48, s54, s50
    s_pack_ll_b32_b16 s49, s51, s52
    v_add_u32 v14, s48, v14
    v_add_u32 v15, s49, v15
    v_sub_u32 v12, v14, v12
    v_sub_u32 v13, v15, v13
    v_and_b32 v8, 0xffff, v12
    v_lshrrev_b32 v9, 16, v12
    v_and_b32 v10, 0xffff, v13
    v_lshrrev_b32 v11, 16, v13
    ds_write2st64_b32 v7, v8, v9 offset0:0 offset1:1
    ds_write2st64_b32 v7, v10, v11 offset0:2 offset1:3
    v_and_b32 v8, 0x3f0, v0
    v_lshl_add_u32 v8, v8, 1, s36
    ds_write_b64 v8, v[12:13] offset:20480
    s_bitset0_b64 exec, 63
    s_not_b64 exec, exec
    ds_write_b64 v8, v[14:15] offset:20512
    s_mov_b64 exec, -1
    s_waitcnt lgkmcnt(0)
    s_barrier
    s_setprio 3
    ds_add_rtn_u32 v72, v72, v2
    ds_add_rtn_u32 v73, v73, v2
    ds_add_rtn_u32 v74, v74, v2
    ds_add_rtn_u32 v75, v75, v2
    ds_read_b128 v[12:15], v0 offset:20480
    v_cmp_gt_u32 vcc, 8448, v0
    ds_add_rtn_u32 v80, v80, v2
    ds_add_rtn_u32 v81, v81, v2
    ds_add_rtn_u32 v82, v82, v2
    ds_add_rtn_u32 v83, v83, v2
    s_setprio 2
    ds_add_rtn_u32 v104, v104, v2
    ds_add_rtn_u32 v105, v105, v2
    ds_add_rtn_u32 v106, v106, v2
    ds_add_rtn_u32 v107, v107, v2
    s_waitcnt lgkmcnt(8)
    s_cbranch_vccz L1_p3
    s_add_u32 s45, s35, 0x5480000
    s_mov_b64 exec, vcc
    buffer_store_dwordx4 v[12:15], v0, s[24:27], s45 offen sc1
    s_mov_b64 exec, -1
L1_p3:
    s_add_u32 s46, s35, 0x2a48000
    s_add_u32 s46, s46, s72
    buffer_store_dwordx4 v[48:51], v0, s[20:23], s46 offen sc1
    s_add_u32 s47, s97, 0x6400000
    s_nop 0
    v_lshlrev_b32 v48, 1, v1
    buffer_load_dwordx4 v[48:51], v48, s[8:11], s47 offen nt
    ds_add_rtn_u32 v112, v112, v2
    ds_add_rtn_u32 v113, v113, v2
    ds_add_rtn_u32 v114, v114, v2
    ds_add_rtn_u32 v115, v115, v2
    s_setprio 1
    ds_add_rtn_u32 v116, v116, v2
    ds_add_rtn_u32 v117, v117, v2
    ds_add_rtn_u32 v118, v118, v2
    ds_add_rtn_u32 v119, v119, v2
    ds_add_rtn_u32 v16, v16, v2
    ds_add_rtn_u32 v17, v17, v2
    ds_add_rtn_u32 v18, v18, v2
    ds_add_rtn_u32 v19, v19, v2
    s_add_u32 s44, s35, 0x2a48000
    s_add_u32 s44, s44, s73
    buffer_store_dwordx4 v[52:55], v0, s[20:23], s44 offen sc1
    s_add_u32 s45, s97, 0x6400000
    s_nop 0
    v_lshlrev_b32 v52, 1, v1
    buffer_load_dwordx4 v[52:55], v52, s[12:15], s45 offen nt
    s_setprio 0
    ds_add_rtn_u32 v124, v124, v2
    ds_add_rtn_u32 v125, v125, v2
    ds_add_rtn_u32 v126, v126, v2
    ds_add_rtn_u32 v127, v127, v2
    ds_add_rtn_u32 v36, v36, v2
    ds_add_rtn_u32 v37, v37, v2
    ds_add_rtn_u32 v38, v38, v2
    ds_add_rtn_u32 v39, v39, v2
    s_waitcnt lgkmcnt(0)
    s_barrier
    s_setprio 3
    v_and_b32 v7, -4, v72
    v_lshl_add_u32 v8, v72, 2, v7
    ds_write_b32 v8, v68
    v_lshl_add_u32 v7, v7, 2, v72
    ds_write_b8 v7, v64 offset:16
    v_and_b32 v9, -4, v73
    v_lshl_add_u32 v10, v73, 2, v9
    ds_write_b32 v10, v69
    v_lshl_add_u32 v9, v9, 2, v73
    ds_write_b8_d16_hi v9, v64 offset:16
    v_and_b32 v7, -4, v74
    v_lshl_add_u32 v8, v74, 2, v7
    ds_write_b32 v8, v70
    v_lshl_add_u32 v7, v7, 2, v74
    ds_write_b8 v7, v65 offset:16
    v_and_b32 v9, -4, v75
    v_lshl_add_u32 v10, v75, 2, v9
    ds_write_b32 v10, v71
    v_lshl_add_u32 v9, v9, 2, v75
    ds_write_b8_d16_hi v9, v65 offset:16
    s_add_u32 s46, s35, 0x2a48000
    s_add_u32 s46, s46, s85
    buffer_store_dwordx4 v[56:59], v0, s[20:23], s46 offen sc1
    s_add_u32 s47, s98, 0x6800000
    v_lshlrev_b32 v68, 1, v1
    buffer_load_dwordx4 v[68:71], v68, s[8:11], s47 offen nt
    s_add_u32 s44, s98, 0x6800000
    v_lshlrev_b32 v72, 1, v1
    buffer_load_dwordx4 v[72:75], v72, s[12:15], s44 offen nt
    v_and_b32 v7, -4, v80
    v_lshl_add_u32 v8, v80, 2, v7
    ds_write_b32 v8, v76
    v_lshl_add_u32 v7, v7, 2, v80
    ds_write_b8 v7, v66 offset:16
    v_and_b32 v9, -4, v81
    v_lshl_add_u32 v10, v81, 2, v9
    ds_write_b32 v10, v77
    v_lshl_add_u32 v9, v9, 2, v81
    ds_write_b8_d16_hi v9, v66 offset:16
    v_and_b32 v7, -4, v82
    v_lshl_add_u32 v8, v82, 2, v7
    ds_write_b32 v8, v78
    v_lshl_add_u32 v7, v7, 2, v82
    ds_write_b8 v7, v67 offset:16
    v_and_b32 v9, -4, v83
    v_lshl_add_u32 v10, v83, 2, v9
    ds_write_b32 v10, v79
    v_lshl_add_u32 v9, v9, 2, v83
    ds_write_b8_d16_hi v9, v67 offset:16
    s_add_u32 s45, s98, 0x6800000
    s_lshr_b32 s45, s45, 1
    buffer_load_dwordx2 v[56:57], v1, s[16:19], s45 offen nt
    s_add_u32 s46, s99, 0x6c00000
    s_lshr_b32 s46, s46, 1
    buffer_load_dwordx2 v[58:59], v1, s[16:19], s46 offen nt
    s_add_u32 s47, s99, 0x6c00000
    v_lshlrev_b32 v76, 1, v1
    buffer_load_dwordx4 v[76:79], v76, s[8:11], s47 offen nt
    s_setprio 2
    v_and_b32 v7, -4, v104
    v_lshl_add_u32 v8, v104, 2, v7
    ds_write_b32 v8, v96
    v_lshl_add_u32 v7, v7, 2, v104
    ds_write_b8 v7, v88 offset:16
    v_and_b32 v9, -4, v105
    v_lshl_add_u32 v10, v105, 2, v9
    ds_write_b32 v10, v97
    v_lshl_add_u32 v9, v9, 2, v105
    ds_write_b8_d16_hi v9, v88 offset:16
    v_and_b32 v7, -4, v106
    v_lshl_add_u32 v8, v106, 2, v7
    ds_write_b32 v8, v98
    v_lshl_add_u32 v7, v7, 2, v106
    ds_write_b8 v7, v89 offset:16
    v_and_b32 v9, -4, v107
    v_lshl_add_u32 v10, v107, 2, v9
    ds_write_b32 v10, v99
    v_lshl_add_u32 v9, v9, 2, v107
    ds_write_b8_d16_hi v9, v89 offset:16
    s_add_u32 s44, s35, 0x2a48000
    s_add_u32 s44, s44, s91
    buffer_store_dwordx4 v[60:63], v0, s[20:23], s44 offen sc1
    s_add_u32 s45, s99, 0x6c00000
    v_lshlrev_b32 v80, 1, v1
    buffer_load_dwordx4 v[80:83], v80, s[12:15], s45 offen nt
    v_and_b32 v7, -4, v112
    v_lshl_add_u32 v8, v112, 2, v7
    ds_write_b32 v8, v100
    v_lshl_add_u32 v7, v7, 2, v112
    ds_write_b8 v7, v90 offset:16
    v_and_b32 v9, -4, v113
    v_lshl_add_u32 v10, v113, 2, v9
    ds_write_b32 v10, v101
    v_lshl_add_u32 v9, v9, 2, v113
    ds_write_b8_d16_hi v9, v90 offset:16
    v_and_b32 v7, -4, v114
    v_lshl_add_u32 v8, v114, 2, v7
    ds_write_b32 v8, v102
    v_lshl_add_u32 v7, v7, 2, v114
    ds_write_b8 v7, v91 offset:16
    v_and_b32 v9, -4, v115
    v_lshl_add_u32 v10, v115, 2, v9
    ds_write_b32 v10, v103
    v_lshl_add_u32 v9, v9, 2, v115
    ds_write_b8_d16_hi v9, v91 offset:16
    s_add_u32 s46, s96, 0x7000000
    v_lshlrev_b32 v64, 1, v1
    buffer_load_dwordx4 v[64:67], v64, s[8:11], s46 offen nt
    s_add_u32 s47, s96, 0x7000000
    v_lshlrev_b32 v96, 1, v1
    buffer_load_dwordx4 v[96:99], v96, s[12:15], s47 offen nt
    s_setprio 1
    v_and_b32 v7, -4, v116
    v_lshl_add_u32 v8, v116, 2, v7
    ds_write_b32 v8, v108
    v_lshl_add_u32 v7, v7, 2, v116
    ds_write_b8 v7, v120 offset:16
    v_and_b32 v9, -4, v117
    v_lshl_add_u32 v10, v117, 2, v9
    ds_write_b32 v10, v109
    v_lshl_add_u32 v9, v9, 2, v117
    ds_write_b8_d16_hi v9, v120 offset:16
    v_and_b32 v7, -4, v118
    v_lshl_add_u32 v8, v118, 2, v7
    ds_write_b32 v8, v110
    v_lshl_add_u32 v7, v7, 2, v118
    ds_write_b8 v7, v121 offset:16
    v_and_b32 v9, -4, v119
    v_lshl_add_u32 v10, v119, 2, v9
    ds_write_b32 v10, v111
    v_lshl_add_u32 v9, v9, 2, v119
    ds_write_b8_d16_hi v9, v121 offset:16
    s_add_u32 s44, s96, 0x7000000
    s_lshr_b32 s44, s44, 1
    buffer_load_dwordx2 v[104:105], v1, s[16:19], s44 offen nt
    s_add_u32 s45, s97, 0x7400000
    s_lshr_b32 s45, s45, 1
    buffer_load_dwordx2 v[106:107], v1, s[16:19], s45 offen nt
    s_add_u32 s46, s97, 0x7400000
    v_lshlrev_b32 v60, 1, v1
    buffer_load_dwordx4 v[60:63], v60, s[8:11], s46 offen nt
    v_and_b32 v7, -4, v16
    v_lshl_add_u32 v8, v16, 2, v7
    ds_write_b32 v8, v92
    v_lshl_add_u32 v7, v7, 2, v16
    ds_write_b8 v7, v122 offset:16
    v_and_b32 v9, -4, v17
    v_lshl_add_u32 v10, v17, 2, v9
    ds_write_b32 v10, v93
    v_lshl_add_u32 v9, v9, 2, v17
    ds_write_b8_d16_hi v9, v122 offset:16
    v_and_b32 v7, -4, v18
    v_lshl_add_u32 v8, v18, 2, v7
    ds_write_b32 v8, v94
    v_lshl_add_u32 v7, v7, 2, v18
    ds_write_b8 v7, v123 offset:16
    v_and_b32 v9, -4, v19
    v_lshl_add_u32 v10, v19, 2, v9
    ds_write_b32 v10, v95
    v_lshl_add_u32 v9, v9, 2, v19
    ds_write_b8_d16_hi v9, v123 offset:16
    s_add_u32 s47, s35, 0x2a48000
    s_add_u32 s47, s47, s93
    buffer_store_dwordx4 v[44:47], v0, s[20:23], s47 offen sc1
    s_add_u32 s44, s97, 0x7400000
    v_lshlrev_b32 v100, 1, v1
    buffer_load_dwordx4 v[100:103], v100, s[12:15], s44 offen nt
    s_setprio 0
    v_and_b32 v7, -4, v124
    v_lshl_add_u32 v8, v124, 2, v7
    ds_write_b32 v8, v20
    v_lshl_add_u32 v7, v7, 2, v124
    ds_write_b8 v7, v28 offset:16
    v_and_b32 v9, -4, v125
    v_lshl_add_u32 v10, v125, 2, v9
    ds_write_b32 v10, v21
    v_lshl_add_u32 v9, v9, 2, v125
    ds_write_b8_d16_hi v9, v28 offset:16
    v_and_b32 v7, -4, v126
    v_lshl_add_u32 v8, v126, 2, v7
    ds_write_b32 v8, v22
    v_lshl_add_u32 v7, v7, 2, v126
    ds_write_b8 v7, v29 offset:16
    v_and_b32 v9, -4, v127
    v_lshl_add_u32 v10, v127, 2, v9
    ds_write_b32 v10, v23
    v_lshl_add_u32 v9, v9, 2, v127
    ds_write_b8_d16_hi v9, v29 offset:16
    s_add_u32 s45, s98, 0x7800000
    v_lshlrev_b32 v112, 1, v1
    buffer_load_dwordx4 v[112:115], v112, s[8:11], s45 offen nt
    s_add_u32 s46, s98, 0x7800000
    v_lshlrev_b32 v88, 1, v1
    buffer_load_dwordx4 v[88:91], v88, s[12:15], s46 offen nt
    v_and_b32 v7, -4, v36
    v_lshl_add_u32 v8, v36, 2, v7
    ds_write_b32 v8, v32
    v_lshl_add_u32 v7, v7, 2, v36
    ds_write_b8 v7, v30 offset:16
    v_and_b32 v9, -4, v37
    v_lshl_add_u32 v10, v37, 2, v9
    ds_write_b32 v10, v33
    v_lshl_add_u32 v9, v9, 2, v37
    ds_write_b8_d16_hi v9, v30 offset:16
    v_and_b32 v7, -4, v38
    v_lshl_add_u32 v8, v38, 2, v7
    ds_write_b32 v8, v34
    v_lshl_add_u32 v7, v7, 2, v38
    ds_write_b8 v7, v31 offset:16
    v_and_b32 v9, -4, v39
    v_lshl_add_u32 v10, v39, 2, v9
    ds_write_b32 v10, v35
    v_lshl_add_u32 v9, v9, 2, v39
    ds_write_b8_d16_hi v9, v31 offset:16
    s_add_u32 s47, s98, 0x7800000
    s_lshr_b32 s47, s47, 1
    buffer_load_dwordx2 v[108:109], v1, s[16:19], s47 offen nt
    s_add_u32 s44, s99, 0x7c00000
    s_lshr_b32 s44, s44, 1
    buffer_load_dwordx2 v[110:111], v1, s[16:19], s44 offen nt
    v_add_u32 v7, s72, v0
    v_add_u32 v12, s73, v0
    v_add_u32 v13, s85, v0
    v_add_u32 v14, s91, v0
    v_add_u32 v15, s93, v0
    s_min_i32 s3, s72, s73
    s_min_i32 s3, s3, s85
    s_min_i32 s3, s3, s91
    s_min_i32 s3, s3, s93
    v_add_u32 v3, s3, v0
    v_mov_b32 v8, 0
    v_mov_b32 v9, 0
    v_mov_b32 v10, 0
    v_mov_b32 v11, 0
    s_waitcnt lgkmcnt(0)
    s_barrier
    ds_read_b128 v[116:119], v7 offset:0
    ds_read_b128 v[92:95], v12 offset:0
    ds_read_b128 v[16:19], v13 offset:0
    ds_read_b128 v[120:123], v14 offset:0
    ds_read_b128 v[44:47], v15 offset:0
    ds_write_b128 v3, v[8:11]
    ds_read_b128 v[20:23], v7 offset:16384
    ds_read_b128 v[124:127], v12 offset:16384
    ds_read_b128 v[32:35], v13 offset:16384
    ds_read_b128 v[36:39], v14 offset:16384
    ds_read_b128 v[28:31], v15 offset:16384
    s_waitcnt lgkmcnt(0)
    s_barrier
    s_setprio 3
    s_add_u32 s45, s35, 0x5484000
    s_add_u32 s45, s45, s72
    buffer_store_dwordx4 v[116:119], v0, s[20:23], s45 offen sc1
    s_add_u32 s46, s99, 0x7c00000
    s_nop 0
    v_lshlrev_b32 v116, 1, v1
    buffer_load_dwordx4 v[116:119], v116, s[8:11], s46 offen nt
    s_add_u32 s47, s35, 0x5484000
    s_add_u32 s47, s47, s73
    buffer_store_dwordx4 v[92:95], v0, s[20:23], s47 offen sc1
    s_add_u32 s44, s99, 0x7c00000
    s_nop 0
    v_lshlrev_b32 v92, 1, v1
    buffer_load_dwordx4 v[92:95], v92, s[12:15], s44 offen nt
    s_waitcnt vmcnt(27)
    v_lshlrev_b32 v7, 16, v84
    v_and_b32 v8, 0xffff0000, v84
    v_lshlrev_b32 v9, 16, v85
    v_and_b32 v10, 0xffff0000, v85
    v_mul_f32 v7, 0.15915494, v7
    v_mul_f32 v8, 0.15915494, v8
    v_mul_f32 v9, 0.15915494, v9
    v_mul_f32 v10, 0.15915494, v10
    v_mul_hi_u32_u24 v14, 429497, v40
    v_lshrrev_b32 v12, 3, v24
    v_cos_f32 v7, v7
    v_lshlrev_b16 v13, 3, v24
    v_mad_i32_i24 v11, v14, s55, v40
    v_bitop3_b32 v12, v6, v13, v12 bitop3:0xca
    v_lshl_add_u32 v11, v11, 17, s40
    v_lshlrev_b16 v14, 8, v14
    v_lshrrev_b32 v13, 2, v24
    v_add_u32 v40, v12, v11
    v_bitop3_b32 v24, v5, v13, v14 bitop3:0xea
    ds_add_u32 v24, v2
    v_mul_hi_u32_u24 v14, 429497, v41
    v_lshrrev_b32 v12, 3, v25
    v_cos_f32 v8, v8
    v_lshlrev_b16 v13, 3, v25
    v_mad_i32_i24 v11, v14, s55, v41
    v_bitop3_b32 v12, v6, v13, v12 bitop3:0xca
    v_lshl_add_u32 v11, v11, 17, s40
    v_lshlrev_b16 v14, 8, v14
    v_lshrrev_b32 v13, 2, v25
    v_add_u32 v41, v12, v11
    v_bitop3_b32 v25, v5, v13, v14 bitop3:0xea
    ds_add_u32 v25, v2
    v_cvt_pk_bf16_f32 v84, v7, v8
    v_perm_b32 v12, v84, v84, s41
    v_bitop3_b32 v40, v4, v12, v40 bitop3:0xca
    v_perm_b32 v13, v84, v84, s42
    v_bitop3_b32 v41, v4, v13, v41 bitop3:0xca
    v_mul_hi_u32_u24 v14, 429497, v42
    v_lshrrev_b32 v12, 3, v26
    v_cos_f32 v9, v9
    v_lshlrev_b16 v13, 3, v26
    v_mad_i32_i24 v11, v14, s55, v42
    v_bitop3_b32 v12, v6, v13, v12 bitop3:0xca
    v_lshl_add_u32 v11, v11, 17, s40
    v_lshlrev_b16 v14, 8, v14
    v_lshrrev_b32 v13, 2, v26
    v_add_u32 v42, v12, v11
    v_bitop3_b32 v26, v5, v13, v14 bitop3:0xea
    ds_add_u32 v26, v2
    v_mul_hi_u32_u24 v14, 429497, v43
    v_lshrrev_b32 v12, 3, v27
    v_cos_f32 v10, v10
    v_lshlrev_b16 v13, 3, v27
    v_mad_i32_i24 v11, v14, s55, v43
    v_bitop3_b32 v12, v6, v13, v12 bitop3:0xca
    v_lshl_add_u32 v11, v11, 17, s40
    v_lshlrev_b16 v14, 8, v14
    v_lshrrev_b32 v13, 2, v27
    v_add_u32 v43, v12, v11
    v_bitop3_b32 v27, v5, v13, v14 bitop3:0xea
    ds_add_u32 v27, v2
    v_cvt_pk_bf16_f32 v85, v9, v10
    v_perm_b32 v12, v85, v85, s41
    v_bitop3_b32 v42, v4, v12, v42 bitop3:0xca
    v_perm_b32 v13, v85, v85, s42
    v_bitop3_b32 v43, v4, v13, v43 bitop3:0xca
    s_waitcnt vmcnt(23)
    v_lshlrev_b32 v7, 16, v86
    v_and_b32 v8, 0xffff0000, v86
    v_lshlrev_b32 v9, 16, v87
    v_and_b32 v10, 0xffff0000, v87
    v_mul_f32 v7, 0.15915494, v7
    v_mul_f32 v8, 0.15915494, v8
    v_mul_f32 v9, 0.15915494, v9
    v_mul_f32 v10, 0.15915494, v10
    v_mul_hi_u32_u24 v14, 429497, v48
    v_lshrrev_b32 v12, 3, v52
    v_cos_f32 v7, v7
    v_lshlrev_b16 v13, 3, v52
    v_mad_i32_i24 v11, v14, s55, v48
    v_bitop3_b32 v12, v6, v13, v12 bitop3:0xca
    v_lshl_add_u32 v11, v11, 17, s40
    v_lshlrev_b16 v14, 8, v14
    v_lshrrev_b32 v13, 2, v52
    v_add_u32 v48, v12, v11
    v_bitop3_b32 v52, v5, v13, v14 bitop3:0xea
    ds_add_u32 v52, v2
    v_mul_hi_u32_u24 v14, 429497, v49
    v_lshrrev_b32 v12, 3, v53
    v_cos_f32 v8, v8
    v_lshlrev_b16 v13, 3, v53
    v_mad_i32_i24 v11, v14, s55, v49
    v_bitop3_b32 v12, v6, v13, v12 bitop3:0xca
    v_lshl_add_u32 v11, v11, 17, s40
    v_lshlrev_b16 v14, 8, v14
    v_lshrrev_b32 v13, 2, v53
    v_add_u32 v49, v12, v11
    v_bitop3_b32 v53, v5, v13, v14 bitop3:0xea
    ds_add_u32 v53, v2
    v_cvt_pk_bf16_f32 v86, v7, v8
    v_perm_b32 v12, v86, v86, s41
    v_bitop3_b32 v48, v4, v12, v48 bitop3:0xca
    v_perm_b32 v13, v86, v86, s42
    v_bitop3_b32 v49, v4, v13, v49 bitop3:0xca
    v_mul_hi_u32_u24 v14, 429497, v50
    v_lshrrev_b32 v12, 3, v54
    v_cos_f32 v9, v9
    v_lshlrev_b16 v13, 3, v54
    v_mad_i32_i24 v11, v14, s55, v50
    v_bitop3_b32 v12, v6, v13, v12 bitop3:0xca
    v_lshl_add_u32 v11, v11, 17, s40
    v_lshlrev_b16 v14, 8, v14
    v_lshrrev_b32 v13, 2, v54
    v_add_u32 v50, v12, v11
    v_bitop3_b32 v54, v5, v13, v14 bitop3:0xea
    ds_add_u32 v54, v2
    v_mul_hi_u32_u24 v14, 429497, v51
    v_lshrrev_b32 v12, 3, v55
    v_cos_f32 v10, v10
    v_lshlrev_b16 v13, 3, v55
    v_mad_i32_i24 v11, v14, s55, v51
    v_bitop3_b32 v12, v6, v13, v12 bitop3:0xca
    v_lshl_add_u32 v11, v11, 17, s40
    v_lshlrev_b16 v14, 8, v14
    v_lshrrev_b32 v13, 2, v55
    v_add_u32 v51, v12, v11
    v_bitop3_b32 v55, v5, v13, v14 bitop3:0xea
    ds_add_u32 v55, v2
    v_cvt_pk_bf16_f32 v87, v9, v10
    v_perm_b32 v12, v87, v87, s41
    v_bitop3_b32 v50, v4, v12, v50 bitop3:0xca
    v_perm_b32 v13, v87, v87, s42
    v_bitop3_b32 v51, v4, v13, v51 bitop3:0xca
    s_setprio 2
    s_waitcnt vmcnt(18)
    v_lshlrev_b32 v7, 16, v56
    v_and_b32 v8, 0xffff0000, v56
    v_lshlrev_b32 v9, 16, v57
    v_and_b32 v10, 0xffff0000, v57
    v_mul_f32 v7, 0.15915494, v7
    v_mul_f32 v8, 0.15915494, v8
    v_mul_f32 v9, 0.15915494, v9
    v_mul_f32 v10, 0.15915494, v10
    v_mul_hi_u32_u24 v14, 429497, v68
    v_lshrrev_b32 v12, 3, v72
    v_cos_f32 v7, v7
    v_lshlrev_b16 v13, 3, v72
    v_mad_i32_i24 v11, v14, s55, v68
    v_bitop3_b32 v12, v6, v13, v12 bitop3:0xca
    v_lshl_add_u32 v11, v11, 17, s40
    v_lshlrev_b16 v14, 8, v14
    v_lshrrev_b32 v13, 2, v72
    v_add_u32 v68, v12, v11
    v_bitop3_b32 v72, v5, v13, v14 bitop3:0xea
    ds_add_u32 v72, v2
    v_mul_hi_u32_u24 v14, 429497, v69
    v_lshrrev_b32 v12, 3, v73
    v_cos_f32 v8, v8
    v_lshlrev_b16 v13, 3, v73
    v_mad_i32_i24 v11, v14, s55, v69
    v_bitop3_b32 v12, v6, v13, v12 bitop3:0xca
    v_lshl_add_u32 v11, v11, 17, s40
    v_lshlrev_b16 v14, 8, v14
    v_lshrrev_b32 v13, 2, v73
    v_add_u32 v69, v12, v11
    v_bitop3_b32 v73, v5, v13, v14 bitop3:0xea
    ds_add_u32 v73, v2
    v_cvt_pk_bf16_f32 v56, v7, v8
    v_perm_b32 v12, v56, v56, s41
    v_bitop3_b32 v68, v4, v12, v68 bitop3:0xca
    v_perm_b32 v13, v56, v56, s42
    v_bitop3_b32 v69, v4, v13, v69 bitop3:0xca
    v_mul_hi_u32_u24 v14, 429497, v70
    v_lshrrev_b32 v12, 3, v74
    v_cos_f32 v9, v9
    v_lshlrev_b16 v13, 3, v74
    v_mad_i32_i24 v11, v14, s55, v70
    v_bitop3_b32 v12, v6, v13, v12 bitop3:0xca
    v_lshl_add_u32 v11, v11, 17, s40
    v_lshlrev_b16 v14, 8, v14
    v_lshrrev_b32 v13, 2, v74
    v_add_u32 v70, v12, v11
    v_bitop3_b32 v74, v5, v13, v14 bitop3:0xea
    ds_add_u32 v74, v2
    v_mul_hi_u32_u24 v14, 429497, v71
    v_lshrrev_b32 v12, 3, v75
    v_cos_f32 v10, v10
    v_lshlrev_b16 v13, 3, v75
    v_mad_i32_i24 v11, v14, s55, v71
    v_bitop3_b32 v12, v6, v13, v12 bitop3:0xca
    v_lshl_add_u32 v11, v11, 17, s40
    v_lshlrev_b16 v14, 8, v14
    v_lshrrev_b32 v13, 2, v75
    v_add_u32 v71, v12, v11
    v_bitop3_b32 v75, v5, v13, v14 bitop3:0xea
    ds_add_u32 v75, v2
    v_cvt_pk_bf16_f32 v57, v9, v10
    v_perm_b32 v12, v57, v57, s41
    v_bitop3_b32 v70, v4, v12, v70 bitop3:0xca
    v_perm_b32 v13, v57, v57, s42
    v_bitop3_b32 v71, v4, v13, v71 bitop3:0xca
    s_add_u32 s45, s35, 0x5484000
    s_add_u32 s45, s45, s85
    buffer_store_dwordx4 v[16:19], v0, s[20:23], s45 offen sc1
    s_add_u32 s46, s96, 0x8000000
    s_nop 0
    v_lshlrev_b32 v16, 1, v1
    buffer_load_dwordx4 v[16:19], v16, s[8:11], s46 offen nt
    s_waitcnt vmcnt(17)
    v_lshlrev_b32 v7, 16, v58
    v_and_b32 v8, 0xffff0000, v58
    v_lshlrev_b32 v9, 16, v59
    v_and_b32 v10, 0xffff0000, v59
    v_mul_f32 v7, 0.15915494, v7
    v_mul_f32 v8, 0.15915494, v8
    v_mul_f32 v9, 0.15915494, v9
    v_mul_f32 v10, 0.15915494, v10
    v_mul_hi_u32_u24 v14, 429497, v76
    v_lshrrev_b32 v12, 3, v80
    v_cos_f32 v7, v7
    v_lshlrev_b16 v13, 3, v80
    v_mad_i32_i24 v11, v14, s55, v76
    v_bitop3_b32 v12, v6, v13, v12 bitop3:0xca
    v_lshl_add_u32 v11, v11, 17, s40
    v_lshlrev_b16 v14, 8, v14
    v_lshrrev_b32 v13, 2, v80
    v_add_u32 v76, v12, v11
    v_bitop3_b32 v80, v5, v13, v14 bitop3:0xea
    ds_add_u32 v80, v2
    v_mul_hi_u32_u24 v14, 429497, v77
    v_lshrrev_b32 v12, 3, v81
    v_cos_f32 v8, v8
    v_lshlrev_b16 v13, 3, v81
    v_mad_i32_i24 v11, v14, s55, v77
    v_bitop3_b32 v12, v6, v13, v12 bitop3:0xca
    v_lshl_add_u32 v11, v11, 17, s40
    v_lshlrev_b16 v14, 8, v14
    v_lshrrev_b32 v13, 2, v81
    v_add_u32 v77, v12, v11
    v_bitop3_b32 v81, v5, v13, v14 bitop3:0xea
    ds_add_u32 v81, v2
    v_cvt_pk_bf16_f32 v58, v7, v8
    v_perm_b32 v12, v58, v58, s41
    v_bitop3_b32 v76, v4, v12, v76 bitop3:0xca
    v_perm_b32 v13, v58, v58, s42
    v_bitop3_b32 v77, v4, v13, v77 bitop3:0xca
    v_mul_hi_u32_u24 v14, 429497, v78
    v_lshrrev_b32 v12, 3, v82
    v_cos_f32 v9, v9
    v_lshlrev_b16 v13, 3, v82
    v_mad_i32_i24 v11, v14, s55, v78
    v_bitop3_b32 v12, v6, v13, v12 bitop3:0xca
    v_lshl_add_u32 v11, v11, 17, s40
    v_lshlrev_b16 v14, 8, v14
    v_lshrrev_b32 v13, 2, v82
    v_add_u32 v78, v12, v11
    v_bitop3_b32 v82, v5, v13, v14 bitop3:0xea
    ds_add_u32 v82, v2
    v_mul_hi_u32_u24 v14, 429497, v79
    v_lshrrev_b32 v12, 3, v83
    v_cos_f32 v10, v10
    v_lshlrev_b16 v13, 3, v83
    v_mad_i32_i24 v11, v14, s55, v79
    v_bitop3_b32 v12, v6, v13, v12 bitop3:0xca
    v_lshl_add_u32 v11, v11, 17, s40
    v_lshlrev_b16 v14, 8, v14
    v_lshrrev_b32 v13, 2, v83
    v_add_u32 v79, v12, v11
    v_bitop3_b32 v83, v5, v13, v14 bitop3:0xea
    ds_add_u32 v83, v2
    v_cvt_pk_bf16_f32 v59, v9, v10
    v_perm_b32 v12, v59, v59, s41
    v_bitop3_b32 v78, v4, v12, v78 bitop3:0xca
    v_perm_b32 v13, v59, v59, s42
    v_bitop3_b32 v79, v4, v13, v79 bitop3:0xca
    s_setprio 1
    s_waitcnt vmcnt(13)
    v_lshlrev_b32 v7, 16, v104
    v_and_b32 v8, 0xffff0000, v104
    v_lshlrev_b32 v9, 16, v105
    v_and_b32 v10, 0xffff0000, v105
    v_mul_f32 v7, 0.15915494, v7
    v_mul_f32 v8, 0.15915494, v8
    v_mul_f32 v9, 0.15915494, v9
    v_mul_f32 v10, 0.15915494, v10
    v_mul_hi_u32_u24 v14, 429497, v64
    v_lshrrev_b32 v12, 3, v96
    v_cos_f32 v7, v7
    v_lshlrev_b16 v13, 3, v96
    v_mad_i32_i24 v11, v14, s55, v64
    v_bitop3_b32 v12, v6, v13, v12 bitop3:0xca
    v_lshl_add_u32 v11, v11, 17, s40
    v_lshlrev_b16 v14, 8, v14
    v_lshrrev_b32 v13, 2, v96
    v_add_u32 v64, v12, v11
    v_bitop3_b32 v96, v5, v13, v14 bitop3:0xea
    ds_add_u32 v96, v2
    v_mul_hi_u32_u24 v14, 429497, v65
    v_lshrrev_b32 v12, 3, v97
    v_cos_f32 v8, v8
    v_lshlrev_b16 v13, 3, v97
    v_mad_i32_i24 v11, v14, s55, v65
    v_bitop3_b32 v12, v6, v13, v12 bitop3:0xca
    v_lshl_add_u32 v11, v11, 17, s40
    v_lshlrev_b16 v14, 8, v14
    v_lshrrev_b32 v13, 2, v97
    v_add_u32 v65, v12, v11
    v_bitop3_b32 v97, v5, v13, v14 bitop3:0xea
    ds_add_u32 v97, v2
    v_cvt_pk_bf16_f32 v104, v7, v8
    v_perm_b32 v12, v104, v104, s41
    v_bitop3_b32 v64, v4, v12, v64 bitop3:0xca
    v_perm_b32 v13, v104, v104, s42
    v_bitop3_b32 v65, v4, v13, v65 bitop3:0xca
    v_mul_hi_u32_u24 v14, 429497, v66
    v_lshrrev_b32 v12, 3, v98
    v_cos_f32 v9, v9
    v_lshlrev_b16 v13, 3, v98
    v_mad_i32_i24 v11, v14, s55, v66
    v_bitop3_b32 v12, v6, v13, v12 bitop3:0xca
    v_lshl_add_u32 v11, v11, 17, s40
    v_lshlrev_b16 v14, 8, v14
    v_lshrrev_b32 v13, 2, v98
    v_add_u32 v66, v12, v11
    v_bitop3_b32 v98, v5, v13, v14 bitop3:0xea
    ds_add_u32 v98, v2
    v_mul_hi_u32_u24 v14, 429497, v67
    v_lshrrev_b32 v12, 3, v99
    v_cos_f32 v10, v10
    v_lshlrev_b16 v13, 3, v99
    v_mad_i32_i24 v11, v14, s55, v67
    v_bitop3_b32 v12, v6, v13, v12 bitop3:0xca
    v_lshl_add_u32 v11, v11, 17, s40
    v_lshlrev_b16 v14, 8, v14
    v_lshrrev_b32 v13, 2, v99
    v_add_u32 v67, v12, v11
    v_bitop3_b32 v99, v5, v13, v14 bitop3:0xea
    ds_add_u32 v99, v2
    v_cvt_pk_bf16_f32 v105, v9, v10
    v_perm_b32 v12, v105, v105, s41
    v_bitop3_b32 v66, v4, v12, v66 bitop3:0xca
    v_perm_b32 v13, v105, v105, s42
    v_bitop3_b32 v67, v4, v13, v67 bitop3:0xca
    s_mov_b32 s68, s66
    s_mov_b32 s69, s67
    s_mov_b32 s70, 0x100
    s_mov_b32 s71, 0x20000
    v_mov_b32 v3, 1
    s_cmp_lg_u32 s32, 15
    s_cbranch_scc1 L1_tk
    s_mov_b64 exec, 1
    s_and_b32 s3, s2, 1
    s_lshl_b32 s3, s3, 7
    buffer_atomic_add v3, off, s[68:71], s3 sc0
    s_mov_b64 exec, -1
L1_tk:
    s_waitcnt vmcnt(10)
    v_lshlrev_b32 v7, 16, v106
    v_and_b32 v8, 0xffff0000, v106
    v_lshlrev_b32 v9, 16, v107
    v_and_b32 v10, 0xffff0000, v107
    v_mul_f32 v7, 0.15915494, v7
    v_mul_f32 v8, 0.15915494, v8
    v_mul_f32 v9, 0.15915494, v9
    v_mul_f32 v10, 0.15915494, v10
    v_mul_hi_u32_u24 v14, 429497, v60
    v_lshrrev_b32 v12, 3, v100
    v_cos_f32 v7, v7
    v_lshlrev_b16 v13, 3, v100
    v_mad_i32_i24 v11, v14, s55, v60
    v_bitop3_b32 v12, v6, v13, v12 bitop3:0xca
    v_lshl_add_u32 v11, v11, 17, s40
    v_lshlrev_b16 v14, 8, v14
    v_lshrrev_b32 v13, 2, v100
    v_add_u32 v60, v12, v11
    v_bitop3_b32 v100, v5, v13, v14 bitop3:0xea
    ds_add_u32 v100, v2
    v_mul_hi_u32_u24 v14, 429497, v61
    v_lshrrev_b32 v12, 3, v101
    v_cos_f32 v8, v8
    v_lshlrev_b16 v13, 3, v101
    v_mad_i32_i24 v11, v14, s55, v61
    v_bitop3_b32 v12, v6, v13, v12 bitop3:0xca
    v_lshl_add_u32 v11, v11, 17, s40
    v_lshlrev_b16 v14, 8, v14
    v_lshrrev_b32 v13, 2, v101
    v_add_u32 v61, v12, v11
    v_bitop3_b32 v101, v5, v13, v14 bitop3:0xea
    ds_add_u32 v101, v2
    v_cvt_pk_bf16_f32 v106, v7, v8
    v_perm_b32 v12, v106, v106, s41
    v_bitop3_b32 v60, v4, v12, v60 bitop3:0xca
    v_perm_b32 v13, v106, v106, s42
    v_bitop3_b32 v61, v4, v13, v61 bitop3:0xca
    v_mul_hi_u32_u24 v14, 429497, v62
    v_lshrrev_b32 v12, 3, v102
    v_cos_f32 v9, v9
    v_lshlrev_b16 v13, 3, v102
    v_mad_i32_i24 v11, v14, s55, v62
    v_bitop3_b32 v12, v6, v13, v12 bitop3:0xca
    v_lshl_add_u32 v11, v11, 17, s40
    v_lshlrev_b16 v14, 8, v14
    v_lshrrev_b32 v13, 2, v102
    v_add_u32 v62, v12, v11
    v_bitop3_b32 v102, v5, v13, v14 bitop3:0xea
    ds_add_u32 v102, v2
    v_mul_hi_u32_u24 v14, 429497, v63
    v_lshrrev_b32 v12, 3, v103
    v_cos_f32 v10, v10
    v_lshlrev_b16 v13, 3, v103
    v_mad_i32_i24 v11, v14, s55, v63
    v_bitop3_b32 v12, v6, v13, v12 bitop3:0xca
    v_lshl_add_u32 v11, v11, 17, s40
    v_lshlrev_b16 v14, 8, v14
    v_lshrrev_b32 v13, 2, v103
    v_add_u32 v63, v12, v11
    v_bitop3_b32 v103, v5, v13, v14 bitop3:0xea
    ds_add_u32 v103, v2
    v_cvt_pk_bf16_f32 v107, v9, v10
    v_perm_b32 v12, v107, v107, s41
    v_bitop3_b32 v62, v4, v12, v62 bitop3:0xca
    v_perm_b32 v13, v107, v107, s42
    v_bitop3_b32 v63, v4, v13, v63 bitop3:0xca
    s_setprio 0
    s_add_u32 s47, s35, 0x5484000
    s_add_u32 s47, s47, s91
    buffer_store_dwordx4 v[120:123], v0, s[20:23], s47 offen sc1
    s_add_u32 s44, s96, 0x8000000
    s_nop 0
    v_lshlrev_b32 v120, 1, v1
    buffer_load_dwordx4 v[120:123], v120, s[12:15], s44 offen nt
    s_waitcnt vmcnt(8)
    v_lshlrev_b32 v7, 16, v108
    v_and_b32 v8, 0xffff0000, v108
    v_lshlrev_b32 v9, 16, v109
    v_and_b32 v10, 0xffff0000, v109
    v_mul_f32 v7, 0.15915494, v7
    v_mul_f32 v8, 0.15915494, v8
    v_mul_f32 v9, 0.15915494, v9
    v_mul_f32 v10, 0.15915494, v10
    v_mul_hi_u32_u24 v14, 429497, v112
    v_lshrrev_b32 v12, 3, v88
    v_cos_f32 v7, v7
    v_lshlrev_b16 v13, 3, v88
    v_mad_i32_i24 v11, v14, s55, v112
    v_bitop3_b32 v12, v6, v13, v12 bitop3:0xca
    v_lshl_add_u32 v11, v11, 17, s40
    v_lshlrev_b16 v14, 8, v14
    v_lshrrev_b32 v13, 2, v88
    v_add_u32 v112, v12, v11
    v_bitop3_b32 v88, v5, v13, v14 bitop3:0xea
    ds_add_u32 v88, v2
    v_mul_hi_u32_u24 v14, 429497, v113
    v_lshrrev_b32 v12, 3, v89
    v_cos_f32 v8, v8
    v_lshlrev_b16 v13, 3, v89
    v_mad_i32_i24 v11, v14, s55, v113
    v_bitop3_b32 v12, v6, v13, v12 bitop3:0xca
    v_lshl_add_u32 v11, v11, 17, s40
    v_lshlrev_b16 v14, 8, v14
    v_lshrrev_b32 v13, 2, v89
    v_add_u32 v113, v12, v11
    v_bitop3_b32 v89, v5, v13, v14 bitop3:0xea
    ds_add_u32 v89, v2
    v_cvt_pk_bf16_f32 v108, v7, v8
    v_perm_b32 v12, v108, v108, s41
    v_bitop3_b32 v112, v4, v12, v112 bitop3:0xca
    v_perm_b32 v13, v108, v108, s42
    v_bitop3_b32 v113, v4, v13, v113 bitop3:0xca
    v_mul_hi_u32_u24 v14, 429497, v114
    v_lshrrev_b32 v12, 3, v90
    v_cos_f32 v9, v9
    v_lshlrev_b16 v13, 3, v90
    v_mad_i32_i24 v11, v14, s55, v114
    v_bitop3_b32 v12, v6, v13, v12 bitop3:0xca
    v_lshl_add_u32 v11, v11, 17, s40
    v_lshlrev_b16 v14, 8, v14
    v_lshrrev_b32 v13, 2, v90
    v_add_u32 v114, v12, v11
    v_bitop3_b32 v90, v5, v13, v14 bitop3:0xea
    ds_add_u32 v90, v2
    v_mul_hi_u32_u24 v14, 429497, v115
    v_lshrrev_b32 v12, 3, v91
    v_cos_f32 v10, v10
    v_lshlrev_b16 v13, 3, v91
    v_mad_i32_i24 v11, v14, s55, v115
    v_bitop3_b32 v12, v6, v13, v12 bitop3:0xca
    v_lshl_add_u32 v11, v11, 17, s40
    v_lshlrev_b16 v14, 8, v14
    v_lshrrev_b32 v13, 2, v91
    v_add_u32 v115, v12, v11
    v_bitop3_b32 v91, v5, v13, v14 bitop3:0xea
    ds_add_u32 v91, v2
    v_cvt_pk_bf16_f32 v109, v9, v10
    v_perm_b32 v12, v109, v109, s41
    v_bitop3_b32 v114, v4, v12, v114 bitop3:0xca
    v_perm_b32 v13, v109, v109, s42
    v_bitop3_b32 v115, v4, v13, v115 bitop3:0xca
    s_waitcnt vmcnt(4)
    v_lshlrev_b32 v7, 16, v110
    v_and_b32 v8, 0xffff0000, v110
    v_lshlrev_b32 v9, 16, v111
    v_and_b32 v10, 0xffff0000, v111
    v_mul_f32 v7, 0.15915494, v7
    v_mul_f32 v8, 0.15915494, v8
    v_mul_f32 v9, 0.15915494, v9
    v_mul_f32 v10, 0.15915494, v10
    v_mul_hi_u32_u24 v14, 429497, v116
    v_lshrrev_b32 v12, 3, v92
    v_cos_f32 v7, v7
    v_lshlrev_b16 v13, 3, v92
    v_mad_i32_i24 v11, v14, s55, v116
    v_bitop3_b32 v12, v6, v13, v12 bitop3:0xca
    v_lshl_add_u32 v11, v11, 17, s40
    v_lshlrev_b16 v14, 8, v14
    v_lshrrev_b32 v13, 2, v92
    v_add_u32 v116, v12, v11
    v_bitop3_b32 v92, v5, v13, v14 bitop3:0xea
    ds_add_u32 v92, v2
    v_mul_hi_u32_u24 v14, 429497, v117
    v_lshrrev_b32 v12, 3, v93
    v_cos_f32 v8, v8
    v_lshlrev_b16 v13, 3, v93
    v_mad_i32_i24 v11, v14, s55, v117
    v_bitop3_b32 v12, v6, v13, v12 bitop3:0xca
    v_lshl_add_u32 v11, v11, 17, s40
    v_lshlrev_b16 v14, 8, v14
    v_lshrrev_b32 v13, 2, v93
    v_add_u32 v117, v12, v11
    v_bitop3_b32 v93, v5, v13, v14 bitop3:0xea
    ds_add_u32 v93, v2
    v_cvt_pk_bf16_f32 v110, v7, v8
    v_perm_b32 v12, v110, v110, s41
    v_bitop3_b32 v116, v4, v12, v116 bitop3:0xca
    v_perm_b32 v13, v110, v110, s42
    v_bitop3_b32 v117, v4, v13, v117 bitop3:0xca
    v_mul_hi_u32_u24 v14, 429497, v118
    v_lshrrev_b32 v12, 3, v94
    v_cos_f32 v9, v9
    v_lshlrev_b16 v13, 3, v94
    v_mad_i32_i24 v11, v14, s55, v118
    v_bitop3_b32 v12, v6, v13, v12 bitop3:0xca
    v_lshl_add_u32 v11, v11, 17, s40
    v_lshlrev_b16 v14, 8, v14
    v_lshrrev_b32 v13, 2, v94
    v_add_u32 v118, v12, v11
    v_bitop3_b32 v94, v5, v13, v14 bitop3:0xea
    ds_add_u32 v94, v2
    v_mul_hi_u32_u24 v14, 429497, v119
    v_lshrrev_b32 v12, 3, v95
    v_cos_f32 v10, v10
    v_lshlrev_b16 v13, 3, v95
    v_mad_i32_i24 v11, v14, s55, v119
    v_bitop3_b32 v12, v6, v13, v12 bitop3:0xca
    v_lshl_add_u32 v11, v11, 17, s40
    v_lshlrev_b16 v14, 8, v14
    v_lshrrev_b32 v13, 2, v95
    v_add_u32 v119, v12, v11
    v_bitop3_b32 v95, v5, v13, v14 bitop3:0xea
    ds_add_u32 v95, v2
    v_cvt_pk_bf16_f32 v111, v9, v10
    v_perm_b32 v12, v111, v111, s41
    v_bitop3_b32 v118, v4, v12, v118 bitop3:0xca
    v_perm_b32 v13, v111, v111, s42
    v_bitop3_b32 v119, v4, v13, v119 bitop3:0xca
    v_lshrrev_b32 v8, 2, v0
    v_and_b32 v7, 0x3c00, v0
    v_bitop3_b32 v7, v5, v8, v7 bitop3:0xea
    s_waitcnt lgkmcnt(0)
    s_barrier
    ds_read2st64_b32 v[8:9], v7 offset0:0 offset1:1
    ds_read2st64_b32 v[10:11], v7 offset0:2 offset1:3
    s_add_u32 s45, s35, 0x5484000
    s_add_u32 s45, s45, s93
    buffer_store_dwordx4 v[44:47], v0, s[20:23], s45 offen sc1
    s_add_u32 s46, s96, 0x8000000
    s_lshr_b32 s46, s46, 1
    buffer_load_dwordx2 v[44:45], v1, s[16:19], s46 offen nt
    s_add_u32 s47, s97, 0x8400000
    s_lshr_b32 s47, s47, 1
    buffer_load_dwordx2 v[46:47], v1, s[16:19], s47 offen nt
    s_waitcnt lgkmcnt(0)
    v_lshl_or_b32 v12, v9, 16, v8
    v_lshl_or_b32 v13, v11, 16, v10
    v_mov_b32 v14, v12
    v_mov_b32 v15, v13
    s_nop 0
    v_add_u32_dpp v14, v14, v14 row_shr:1 row_mask:0xf bank_mask:0xf bound_ctrl:1
    v_add_u32_dpp v15, v15, v15 row_shr:1 row_mask:0xf bank_mask:0xf bound_ctrl:1
    s_nop 0
    v_add_u32_dpp v14, v14, v14 row_shr:2 row_mask:0xf bank_mask:0xf bound_ctrl:1
    v_add_u32_dpp v15, v15, v15 row_shr:2 row_mask:0xf bank_mask:0xf bound_ctrl:1
    s_nop 0
    v_add_u32_dpp v14, v14, v14 row_shr:4 row_mask:0xf bank_mask:0xf bound_ctrl:1
    v_add_u32_dpp v15, v15, v15 row_shr:4 row_mask:0xf bank_mask:0xf bound_ctrl:1
    s_nop 0
    v_add_u32_dpp v14, v14, v14 row_shr:8 row_mask:0xf bank_mask:0xf bound_ctrl:1
    v_add_u32_dpp v15, v15, v15 row_shr:8 row_mask:0xf bank_mask:0xf bound_ctrl:1
    s_nop 0
    v_add_u32_dpp v14, v14, v14 row_bcast:15 row_mask:0xa bank_mask:0xf
    v_add_u32_dpp v15, v15, v15 row_bcast:15 row_mask:0xa bank_mask:0xf
    s_nop 0
    v_add_u32_dpp v14, v14, v14 row_bcast:31 row_mask:0xc bank_mask:0xf
    v_add_u32_dpp v15, v15, v15 row_bcast:31 row_mask:0xc bank_mask:0xf
    v_readlane_b32 s48, v14, 63
    v_readlane_b32 s49, v15, 63
    s_lshl_b32 s54, s32, 2
    v_mov_b32 v8, s54
    s_and_b32 s50, s48, 0xffff
    s_lshr_b32 s51, s48, 16
    s_and_b32 s52, s49, 0xffff
    s_lshr_b32 s53, s49, 16
    s_add_u32 s51, s51, s50
    s_add_u32 s52, s52, s51
    s_add_u32 s53, s53, s52
    v_mov_b32 v9, s53
    s_mov_b64 exec, 1
    ds_write_b32 v8, v9 offset:16384
    s_cmp_lg_u32 s32, 15
    s_cbranch_scc1 L1_tk2
    s_waitcnt vmcnt(3)
L1_tk2:
    ds_write_b32 v8, v3 offset:16448
    s_mov_b64 exec, -1
    v_and_b32 v8, 60, v7
    s_waitcnt lgkmcnt(0)
    s_barrier
    ds_read_b32 v9, v8 offset:16384
    ds_read_b32 v10, v8 offset:16448
    s_waitcnt lgkmcnt(0)
    v_readlane_b32 s84, v10, 15
    s_and_b32 s3, s2, 1
    s_lshl_b32 s3, s3, 7
    s_add_u32 s84, s84, s3
    s_and_b32 s4, s84, 127
    s_lshl_b32 s6, s32, 10
    s_mov_b32 s43, 5
    s_bitcmp1_b32 s2, 0
    s_cselect_b32 s5, 128, 0
    s_mov_b32 s7, 128
    s_cselect_b32 s7, 120, s7
    s_add_u32 s5, s5, s4
    s_add_u32 s5, s5, 9472
    s_lshl_b32 s5, s5, 14
    s_add_u32 s38, s5, s6
    s_cmp_lt_u32 s4, s7
    s_addc_u32 s43, s43, 0
    s_bitcmp1_b32 s2, 0
    s_cselect_b32 s5, 112, 0
    s_mov_b32 s7, 112
    s_cselect_b32 s7, 96, s7
    s_add_u32 s5, s5, s4
    s_add_u32 s5, s5, 9720
    s_lshl_b32 s5, s5, 14
    s_add_u32 s39, s5, s6
    s_cmp_lt_u32 s4, s7
    s_addc_u32 s43, s43, 0
    s_bitcmp1_b32 s2, 0
    s_cselect_b32 s5, 72, 0
    s_mov_b32 s7, 72
    s_cselect_b32 s7, 0, s7
    s_add_u32 s5, s5, s4
    s_add_u32 s5, s5, 9928
    s_lshl_b32 s5, s5, 14
    s_add_u32 s58, s5, s6
    s_cmp_lt_u32 s4, s7
    s_addc_u32 s43, s43, 0
    v_add_u32_dpp v9, v9, v9 row_shr:1 row_mask:0xf bank_mask:0xf bound_ctrl:1
    s_nop 1
    v_add_u32_dpp v9, v9, v9 row_shr:2 row_mask:0xf bank_mask:0xf bound_ctrl:1
    s_nop 1
    v_add_u32_dpp v9, v9, v9 row_shr:4 row_mask:0xf bank_mask:0xf bound_ctrl:1
    s_nop 1
    v_add_u32_dpp v9, v9, v9 row_shr:8 row_mask:0xf bank_mask:0xf bound_ctrl:1
    s_nop 0
    v_readlane_b32 s54, v9, s32
    s_sub_u32 s54, s54, s53
    s_add_u32 s50, s50, s54
    s_add_u32 s51, s51, s54
    s_add_u32 s52, s52, s54
    s_pack_ll_b32_b16 s48, s54, s50
    s_pack_ll_b32_b16 s49, s51, s52
    v_add_u32 v14, s48, v14
    v_add_u32 v15, s49, v15
    v_sub_u32 v12, v14, v12
    v_sub_u32 v13, v15, v13
    v_and_b32 v8, 0xffff, v12
    v_lshrrev_b32 v9, 16, v12
    v_and_b32 v10, 0xffff, v13
    v_lshrrev_b32 v11, 16, v13
    ds_write2st64_b32 v7, v8, v9 offset0:0 offset1:1
    ds_write2st64_b32 v7, v10, v11 offset0:2 offset1:3
    v_and_b32 v8, 0x3f0, v0
    v_lshl_add_u32 v8, v8, 1, s36
    ds_write_b64 v8, v[12:13] offset:20480
    s_bitset0_b64 exec, 63
    s_not_b64 exec, exec
    ds_write_b64 v8, v[14:15] offset:20512
    s_mov_b64 exec, -1
    s_waitcnt lgkmcnt(0)
    s_barrier
    s_setprio 3
    ds_add_rtn_u32 v24, v24, v2
    ds_add_rtn_u32 v25, v25, v2
    ds_add_rtn_u32 v26, v26, v2
    ds_add_rtn_u32 v27, v27, v2
    ds_read_b128 v[12:15], v0 offset:20480
    v_cmp_gt_u32 vcc, 8448, v0
    ds_add_rtn_u32 v52, v52, v2
    ds_add_rtn_u32 v53, v53, v2
    ds_add_rtn_u32 v54, v54, v2
    ds_add_rtn_u32 v55, v55, v2
    s_setprio 2
    ds_add_rtn_u32 v72, v72, v2
    ds_add_rtn_u32 v73, v73, v2
    ds_add_rtn_u32 v74, v74, v2
    ds_add_rtn_u32 v75, v75, v2
    s_waitcnt lgkmcnt(8)
    s_cbranch_vccz L1_p4
    s_add_u32 s44, s35, 0x7ec0000
    s_mov_b64 exec, vcc
    buffer_store_dwordx4 v[12:15], v0, s[24:27], s44 offen sc1
    s_mov_b64 exec, -1
L1_p4:
    s_add_u32 s45, s35, 0x5488000
    s_add_u32 s45, s45, s72
    buffer_store_dwordx4 v[20:23], v0, s[20:23], s45 offen sc1
    s_add_u32 s46, s97, 0x8400000
    s_nop 0
    v_lshlrev_b32 v20, 1, v1
    buffer_load_dwordx4 v[20:23], v20, s[8:11], s46 offen nt
    ds_add_rtn_u32 v80, v80, v2
    ds_add_rtn_u32 v81, v81, v2
    ds_add_rtn_u32 v82, v82, v2
    ds_add_rtn_u32 v83, v83, v2
    s_setprio 1
    ds_add_rtn_u32 v96, v96, v2
    ds_add_rtn_u32 v97, v97, v2
    ds_add_rtn_u32 v98, v98, v2
    ds_add_rtn_u32 v99, v99, v2
    ds_add_rtn_u32 v100, v100, v2
    ds_add_rtn_u32 v101, v101, v2
    ds_add_rtn_u32 v102, v102, v2
    ds_add_rtn_u32 v103, v103, v2
    s_add_u32 s47, s35, 0x5488000
    s_add_u32 s47, s47, s73
    buffer_store_dwordx4 v[124:127], v0, s[20:23], s47 offen sc1
    s_add_u32 s44, s97, 0x8400000
    s_nop 0
    v_lshlrev_b32 v124, 1, v1
    buffer_load_dwordx4 v[124:127], v124, s[12:15], s44 offen nt
    s_setprio 0
    ds_add_rtn_u32 v88, v88, v2
    ds_add_rtn_u32 v89, v89, v2
    ds_add_rtn_u32 v90, v90, v2
    ds_add_rtn_u32 v91, v91, v2
    ds_add_rtn_u32 v92, v92, v2
    ds_add_rtn_u32 v93, v93, v2
    ds_add_rtn_u32 v94, v94, v2
    ds_add_rtn_u32 v95, v95, v2
    s_waitcnt lgkmcnt(0)
    s_barrier
    s_setprio 3
    v_and_b32 v7, -4, v24
    v_lshl_add_u32 v8, v24, 2, v7
    ds_write_b32 v8, v40
    v_lshl_add_u32 v7, v7, 2, v24
    ds_write_b8 v7, v84 offset:16
    v_and_b32 v9, -4, v25
    v_lshl_add_u32 v10, v25, 2, v9
    ds_write_b32 v10, v41
    v_lshl_add_u32 v9, v9, 2, v25
    ds_write_b8_d16_hi v9, v84 offset:16
    v_and_b32 v7, -4, v26
    v_lshl_add_u32 v8, v26, 2, v7
    ds_write_b32 v8, v42
    v_lshl_add_u32 v7, v7, 2, v26
    ds_write_b8 v7, v85 offset:16
    v_and_b32 v9, -4, v27
    v_lshl_add_u32 v10, v27, 2, v9
    ds_write_b32 v10, v43
    v_lshl_add_u32 v9, v9, 2, v27
    ds_write_b8_d16_hi v9, v85 offset:16
    s_add_u32 s45, s35, 0x5488000
    s_add_u32 s45, s45, s85
    buffer_store_dwordx4 v[32:35], v0, s[20:23], s45 offen sc1
    s_add_u32 s46, s98, 0x8800000
    v_lshlrev_b32 v40, 1, v1
    buffer_load_dwordx4 v[40:43], v40, s[8:11], s46 offen nt
    s_add_u32 s47, s98, 0x8800000
    v_lshlrev_b32 v24, 1, v1
    buffer_load_dwordx4 v[24:27], v24, s[12:15], s47 offen nt
    v_and_b32 v7, -4, v52
    v_lshl_add_u32 v8, v52, 2, v7
    ds_write_b32 v8, v48
    v_lshl_add_u32 v7, v7, 2, v52
    ds_write_b8 v7, v86 offset:16
    v_and_b32 v9, -4, v53
    v_lshl_add_u32 v10, v53, 2, v9
    ds_write_b32 v10, v49
    v_lshl_add_u32 v9, v9, 2, v53
    ds_write_b8_d16_hi v9, v86 offset:16
    v_and_b32 v7, -4, v54
    v_lshl_add_u32 v8, v54, 2, v7
    ds_write_b32 v8, v50
    v_lshl_add_u32 v7, v7, 2, v54
    ds_write_b8 v7, v87 offset:16
    v_and_b32 v9, -4, v55
    v_lshl_add_u32 v10, v55, 2, v9
    ds_write_b32 v10, v51
    v_lshl_add_u32 v9, v9, 2, v55
    ds_write_b8_d16_hi v9, v87 offset:16
    s_add_u32 s44, s98, 0x8800000
    s_lshr_b32 s44, s44, 1
    buffer_load_dwordx2 v[32:33], v1, s[16:19], s44 offen nt
    s_add_u32 s45, s99, 0x8c00000
    s_lshr_b32 s45, s45, 1
    buffer_load_dwordx2 v[34:35], v1, s[16:19], s45 offen nt
    s_add_u32 s46, s99, 0x8c00000
    v_lshlrev_b32 v48, 1, v1
    buffer_load_dwordx4 v[48:51], v48, s[8:11], s46 offen nt
    s_setprio 2
    v_and_b32 v7, -4, v72
    v_lshl_add_u32 v8, v72, 2, v7
    ds_write_b32 v8, v68
    v_lshl_add_u32 v7, v7, 2, v72
    ds_write_b8 v7, v56 offset:16
    v_and_b32 v9, -4, v73
    v_lshl_add_u32 v10, v73, 2, v9
    ds_write_b32 v10, v69
    v_lshl_add_u32 v9, v9, 2, v73
    ds_write_b8_d16_hi v9, v56 offset:16
    v_and_b32 v7, -4, v74
    v_lshl_add_u32 v8, v74, 2, v7
    ds_write_b32 v8, v70
    v_lshl_add_u32 v7, v7, 2, v74
    ds_write_b8 v7, v57 offset:16
    v_and_b32 v9, -4, v75
    v_lshl_add_u32 v10, v75, 2, v9
    ds_write_b32 v10, v71
    v_lshl_add_u32 v9, v9, 2, v75
    ds_write_b8_d16_hi v9, v57 offset:16
    s_add_u32 s47, s35, 0x5488000
    s_add_u32 s47, s47, s91
    buffer_store_dwordx4 v[36:39], v0, s[20:23], s47 offen sc1
    s_add_u32 s44, s99, 0x8c00000
    v_lshlrev_b32 v52, 1, v1
    buffer_load_dwordx4 v[52:55], v52, s[12:15], s44 offen nt
    v_and_b32 v7, -4, v80
    v_lshl_add_u32 v8, v80, 2, v7
    ds_write_b32 v8, v76
    v_lshl_add_u32 v7, v7, 2, v80
    ds_write_b8 v7, v58 offset:16
    v_and_b32 v9, -4, v81
    v_lshl_add_u32 v10, v81, 2, v9
    ds_write_b32 v10, v77
    v_lshl_add_u32 v9, v9, 2, v81
    ds_write_b8_d16_hi v9, v58 offset:16
    v_and_b32 v7, -4, v82
    v_lshl_add_u32 v8, v82, 2, v7
    ds_write_b32 v8, v78
    v_lshl_add_u32 v7, v7, 2, v82
    ds_write_b8 v7, v59 offset:16
    v_and_b32 v9, -4, v83
    v_lshl_add_u32 v10, v83, 2, v9
    ds_write_b32 v10, v79
    v_lshl_add_u32 v9, v9, 2, v83
    ds_write_b8_d16_hi v9, v59 offset:16
    s_add_u32 s45, s96, 0x9000000
    v_lshlrev_b32 v84, 1, v1
    buffer_load_dwordx4 v[84:87], v84, s[8:11], s45 offen nt
    s_add_u32 s46, s96, 0x9000000
    v_lshlrev_b32 v68, 1, v1
    buffer_load_dwordx4 v[68:71], v68, s[12:15], s46 offen nt
    s_setprio 1
    v_and_b32 v7, -4, v96
    v_lshl_add_u32 v8, v96, 2, v7
    ds_write_b32 v8, v64
    v_lshl_add_u32 v7, v7, 2, v96
    ds_write_b8 v7, v104 offset:16
    v_and_b32 v9, -4, v97
    v_lshl_add_u32 v10, v97, 2, v9
    ds_write_b32 v10, v65
    v_lshl_add_u32 v9, v9, 2, v97
    ds_write_b8_d16_hi v9, v104 offset:16
    v_and_b32 v7, -4, v98
    v_lshl_add_u32 v8, v98, 2, v7
    ds_write_b32 v8, v66
    v_lshl_add_u32 v7, v7, 2, v98
    ds_write_b8 v7, v105 offset:16
    v_and_b32 v9, -4, v99
    v_lshl_add_u32 v10, v99, 2, v9
    ds_write_b32 v10, v67
    v_lshl_add_u32 v9, v9, 2, v99
    ds_write_b8_d16_hi v9, v105 offset:16
    s_add_u32 s47, s96, 0x9000000
    s_lshr_b32 s47, s47, 1
    buffer_load_dwordx2 v[72:73], v1, s[16:19], s47 offen nt
    s_cmp_le_u32 s43, 5
    s_cselect_b32 s18, 0, s18
    s_add_u32 s44, s38, 0x0
    s_lshr_b32 s44, s44, 1
    buffer_load_dwordx2 v[74:75], v1, s[16:19], s44 offen nt
    s_cmp_le_u32 s43, 5
    s_cselect_b32 s10, 0, s10
    s_add_u32 s45, s38, 0x0
    v_lshlrev_b32 v36, 1, v1
    buffer_load_dwordx4 v[36:39], v36, s[8:11], s45 offen nt
    v_and_b32 v7, -4, v100
    v_lshl_add_u32 v8, v100, 2, v7
    ds_write_b32 v8, v60
    v_lshl_add_u32 v7, v7, 2, v100
    ds_write_b8 v7, v106 offset:16
    v_and_b32 v9, -4, v101
    v_lshl_add_u32 v10, v101, 2, v9
    ds_write_b32 v10, v61
    v_lshl_add_u32 v9, v9, 2, v101
    ds_write_b8_d16_hi v9, v106 offset:16
    v_and_b32 v7, -4, v102
    v_lshl_add_u32 v8, v102, 2, v7
    ds_write_b32 v8, v62
    v_lshl_add_u32 v7, v7, 2, v102
    ds_write_b8 v7, v107 offset:16
    v_and_b32 v9, -4, v103
    v_lshl_add_u32 v10, v103, 2, v9
    ds_write_b32 v10, v63
    v_lshl_add_u32 v9, v9, 2, v103
    ds_write_b8_d16_hi v9, v107 offset:16
    s_add_u32 s46, s35, 0x5488000
    s_add_u32 s46, s46, s93
    buffer_store_dwordx4 v[28:31], v0, s[20:23], s46 offen sc1
    s_cmp_le_u32 s43, 5
    s_cselect_b32 s14, 0, s14
    s_add_u32 s47, s38, 0x0
    v_lshlrev_b32 v76, 1, v1
    buffer_load_dwordx4 v[76:79], v76, s[12:15], s47 offen nt
    s_setprio 0
    v_and_b32 v7, -4, v88
    v_lshl_add_u32 v8, v88, 2, v7
    ds_write_b32 v8, v112
    v_lshl_add_u32 v7, v7, 2, v88
    ds_write_b8 v7, v108 offset:16
    v_and_b32 v9, -4, v89
    v_lshl_add_u32 v10, v89, 2, v9
    ds_write_b32 v10, v113
    v_lshl_add_u32 v9, v9, 2, v89
    ds_write_b8_d16_hi v9, v108 offset:16
    v_and_b32 v7, -4, v90
    v_lshl_add_u32 v8, v90, 2, v7
    ds_write_b32 v8, v114
    v_lshl_add_u32 v7, v7, 2, v90
    ds_write_b8 v7, v109 offset:16
    v_and_b32 v9, -4, v91
    v_lshl_add_u32 v10, v91, 2, v9
    ds_write_b32 v10, v115
    v_lshl_add_u32 v9, v9, 2, v91
    ds_write_b8_d16_hi v9, v109 offset:16
    s_cmp_le_u32 s43, 6
    s_cselect_b32 s10, 0, s10
    s_add_u32 s44, s39, 0x0
    v_lshlrev_b32 v80, 1, v1
    buffer_load_dwordx4 v[80:83], v80, s[8:11], s44 offen nt
    s_cmp_le_u32 s43, 6
    s_cselect_b32 s14, 0, s14
    s_add_u32 s45, s39, 0x0
    v_lshlrev_b32 v56, 1, v1
    buffer_load_dwordx4 v[56:59], v56, s[12:15], s45 offen nt
    v_and_b32 v7, -4, v92
    v_lshl_add_u32 v8, v92, 2, v7
    ds_write_b32 v8, v116
    v_lshl_add_u32 v7, v7, 2, v92
    ds_write_b8 v7, v110 offset:16
    v_and_b32 v9, -4, v93
    v_lshl_add_u32 v10, v93, 2, v9
    ds_write_b32 v10, v117
    v_lshl_add_u32 v9, v9, 2, v93
    ds_write_b8_d16_hi v9, v110 offset:16
    v_and_b32 v7, -4, v94
    v_lshl_add_u32 v8, v94, 2, v7
    ds_write_b32 v8, v118
    v_lshl_add_u32 v7, v7, 2, v94
    ds_write_b8 v7, v111 offset:16
    v_and_b32 v9, -4, v95
    v_lshl_add_u32 v10, v95, 2, v9
    ds_write_b32 v10, v119
    v_lshl_add_u32 v9, v9, 2, v95
    ds_write_b8_d16_hi v9, v111 offset:16
    s_cmp_le_u32 s43, 6
    s_cselect_b32 s18, 0, s18
    s_add_u32 s46, s39, 0x0
    s_lshr_b32 s46, s46, 1
    buffer_load_dwordx2 v[64:65], v1, s[16:19], s46 offen nt
    s_cmp_le_u32 s43, 7
    s_cselect_b32 s18, 0, s18
    s_add_u32 s47, s58, 0x0
    s_lshr_b32 s47, s47, 1
    buffer_load_dwordx2 v[66:67], v1, s[16:19], s47 offen nt
    v_add_u32 v7, s72, v0
    v_add_u32 v12, s73, v0
    v_add_u32 v13, s85, v0
    v_add_u32 v14, s91, v0
    v_add_u32 v15, s93, v0
    s_min_i32 s3, s72, s73
    s_min_i32 s3, s3, s85
    s_min_i32 s3, s3, s91
    s_min_i32 s3, s3, s93
    v_add_u32 v3, s3, v0
    v_mov_b32 v8, 0
    v_mov_b32 v9, 0
    v_mov_b32 v10, 0
    v_mov_b32 v11, 0
    s_waitcnt lgkmcnt(0)
    s_barrier
    ds_read_b128 v[96:99], v7 offset:0
    ds_read_b128 v[60:63], v12 offset:0
    ds_read_b128 v[100:103], v13 offset:0
    ds_read_b128 v[104:107], v14 offset:0
    ds_read_b128 v[28:31], v15 offset:0
    ds_write_b128 v3, v[8:11]
    ds_read_b128 v[112:115], v7 offset:16384
    ds_read_b128 v[88:91], v12 offset:16384
    ds_read_b128 v[116:119], v13 offset:16384
    ds_read_b128 v[92:95], v14 offset:16384
    ds_read_b128 v[108:111], v15 offset:16384
    s_waitcnt lgkmcnt(0)
    s_barrier
    v_lshlrev_b32 v3, 3, v0
    v_and_b32 v3, 0x80, v3
    s_cmp_lg_u32 s32, 15
    s_cbranch_scc1 L2_k0
    s_mov_b64 exec, 3
    buffer_load_dword v3, v3, s[68:71], 0 offen sc1
    s_mov_b64 exec, -1
L2_k0:
    s_add_u32 s44, s35, 0x7ec4000
    s_add_u32 s44, s44, s72
    buffer_store_dwordx4 v[96:99], v0, s[20:23], s44 offen sc1
    s_cmp_le_u32 s43, 7
    s_cselect_b32 s10, 0, s10
    s_add_u32 s45, s58, 0x0
    v_lshlrev_b32 v96, 1, v1
    buffer_load_dwordx4 v[96:99], v96, s[8:11], s45 offen nt
    s_add_u32 s46, s35, 0x7ec4000
    s_add_u32 s46, s46, s73
    buffer_store_dwordx4 v[60:63], v0, s[20:23], s46 offen sc1
    s_cmp_le_u32 s43, 7
    s_cselect_b32 s14, 0, s14
    s_add_u32 s47, s58, 0x0
    v_lshlrev_b32 v60, 1, v1
    buffer_load_dwordx4 v[60:63], v60, s[12:15], s47 offen nt
    s_setprio 3
    s_waitcnt vmcnt(27)
    v_lshlrev_b32 v7, 16, v44
    v_and_b32 v8, 0xffff0000, v44
    v_lshlrev_b32 v9, 16, v45
    v_and_b32 v10, 0xffff0000, v45
    v_mul_f32 v7, 0.15915494, v7
    v_mul_f32 v8, 0.15915494, v8
    v_mul_f32 v9, 0.15915494, v9
    v_mul_f32 v10, 0.15915494, v10
    v_mul_hi_u32_u24 v14, 429497, v16
    v_lshrrev_b32 v12, 3, v120
    v_cos_f32 v7, v7
    v_lshlrev_b16 v13, 3, v120
    v_mad_i32_i24 v11, v14, s55, v16
    v_bitop3_b32 v12, v6, v13, v12 bitop3:0xca
    v_lshl_add_u32 v11, v11, 17, s40
    v_lshlrev_b16 v14, 8, v14
    v_lshrrev_b32 v13, 2, v120
    v_add_u32 v16, v12, v11
    v_bitop3_b32 v120, v5, v13, v14 bitop3:0xea
    ds_add_u32 v120, v2
    v_mul_hi_u32_u24 v14, 429497, v17
    v_lshrrev_b32 v12, 3, v121
    v_cos_f32 v8, v8
    v_lshlrev_b16 v13, 3, v121
    v_mad_i32_i24 v11, v14, s55, v17
    v_bitop3_b32 v12, v6, v13, v12 bitop3:0xca
    v_lshl_add_u32 v11, v11, 17, s40
    v_lshlrev_b16 v14, 8, v14
    v_lshrrev_b32 v13, 2, v121
    v_add_u32 v17, v12, v11
    v_bitop3_b32 v121, v5, v13, v14 bitop3:0xea
    ds_add_u32 v121, v2
    v_cvt_pk_bf16_f32 v44, v7, v8
    v_perm_b32 v12, v44, v44, s41
    v_bitop3_b32 v16, v4, v12, v16 bitop3:0xca
    v_perm_b32 v13, v44, v44, s42
    v_bitop3_b32 v17, v4, v13, v17 bitop3:0xca
    v_mul_hi_u32_u24 v14, 429497, v18
    v_lshrrev_b32 v12, 3, v122
    v_cos_f32 v9, v9
    v_lshlrev_b16 v13, 3, v122
    v_mad_i32_i24 v11, v14, s55, v18
    v_bitop3_b32 v12, v6, v13, v12 bitop3:0xca
    v_lshl_add_u32 v11, v11, 17, s40
    v_lshlrev_b16 v14, 8, v14
    v_lshrrev_b32 v13, 2, v122
    v_add_u32 v18, v12, v11
    v_bitop3_b32 v122, v5, v13, v14 bitop3:0xea
    ds_add_u32 v122, v2
    v_mul_hi_u32_u24 v14, 429497, v19
    v_lshrrev_b32 v12, 3, v123
    v_cos_f32 v10, v10
    v_lshlrev_b16 v13, 3, v123
    v_mad_i32_i24 v11, v14, s55, v19
    v_bitop3_b32 v12, v6, v13, v12 bitop3:0xca
    v_lshl_add_u32 v11, v11, 17, s40
    v_lshlrev_b16 v14, 8, v14
    v_lshrrev_b32 v13, 2, v123
    v_add_u32 v19, v12, v11
    v_bitop3_b32 v123, v5, v13, v14 bitop3:0xea
    ds_add_u32 v123, v2
    v_cvt_pk_bf16_f32 v45, v9, v10
    v_perm_b32 v12, v45, v45, s41
    v_bitop3_b32 v18, v4, v12, v18 bitop3:0xca
    v_perm_b32 v13, v45, v45, s42
    v_bitop3_b32 v19, v4, v13, v19 bitop3:0xca
    s_waitcnt vmcnt(23)
    v_lshlrev_b32 v7, 16, v46
    v_and_b32 v8, 0xffff0000, v46
    v_lshlrev_b32 v9, 16, v47
    v_and_b32 v10, 0xffff0000, v47
    v_mul_f32 v7, 0.15915494, v7
    v_mul_f32 v8, 0.15915494, v8
    v_mul_f32 v9, 0.15915494, v9
    v_mul_f32 v10, 0.15915494, v10
    v_mul_hi_u32_u24 v14, 429497, v20
    v_lshrrev_b32 v12, 3, v124
    v_cos_f32 v7, v7
    v_lshlrev_b16 v13, 3, v124
    v_mad_i32_i24 v11, v14, s55, v20
    v_bitop3_b32 v12, v6, v13, v12 bitop3:0xca
    v_lshl_add_u32 v11, v11, 17, s40
    v_lshlrev_b16 v14, 8, v14
    v_lshrrev_b32 v13, 2, v124
    v_add_u32 v20, v12, v11
    v_bitop3_b32 v124, v5, v13, v14 bitop3:0xea
    ds_add_u32 v124, v2
    v_mul_hi_u32_u24 v14, 429497, v21
    v_lshrrev_b32 v12, 3, v125
    v_cos_f32 v8, v8
    v_lshlrev_b16 v13, 3, v125
    v_mad_i32_i24 v11, v14, s55, v21
    v_bitop3_b32 v12, v6, v13, v12 bitop3:0xca
    v_lshl_add_u32 v11, v11, 17, s40
    v_lshlrev_b16 v14, 8, v14
    v_lshrrev_b32 v13, 2, v125
    v_add_u32 v21, v12, v11
    v_bitop3_b32 v125, v5, v13, v14 bitop3:0xea
    ds_add_u32 v125, v2
    v_cvt_pk_bf16_f32 v46, v7, v8
    v_perm_b32 v12, v46, v46, s41
    v_bitop3_b32 v20, v4, v12, v20 bitop3:0xca
    v_perm_b32 v13, v46, v46, s42
    v_bitop3_b32 v21, v4, v13, v21 bitop3:0xca
    v_mul_hi_u32_u24 v14, 429497, v22
    v_lshrrev_b32 v12, 3, v126
    v_cos_f32 v9, v9
    v_lshlrev_b16 v13, 3, v126
    v_mad_i32_i24 v11, v14, s55, v22
    v_bitop3_b32 v12, v6, v13, v12 bitop3:0xca
    v_lshl_add_u32 v11, v11, 17, s40
    v_lshlrev_b16 v14, 8, v14
    v_lshrrev_b32 v13, 2, v126
    v_add_u32 v22, v12, v11
    v_bitop3_b32 v126, v5, v13, v14 bitop3:0xea
    ds_add_u32 v126, v2
    v_mul_hi_u32_u24 v14, 429497, v23
    v_lshrrev_b32 v12, 3, v127
    v_cos_f32 v10, v10
    v_lshlrev_b16 v13, 3, v127
    v_mad_i32_i24 v11, v14, s55, v23
    v_bitop3_b32 v12, v6, v13, v12 bitop3:0xca
    v_lshl_add_u32 v11, v11, 17, s40
    v_lshlrev_b16 v14, 8, v14
    v_lshrrev_b32 v13, 2, v127
    v_add_u32 v23, v12, v11
    v_bitop3_b32 v127, v5, v13, v14 bitop3:0xea
    ds_add_u32 v127, v2
    v_cvt_pk_bf16_f32 v47, v9, v10
    v_perm_b32 v12, v47, v47, s41
    v_bitop3_b32 v22, v4, v12, v22 bitop3:0xca
    v_perm_b32 v13, v47, v47, s42
    v_bitop3_b32 v23, v4, v13, v23 bitop3:0xca
    s_setprio 2
    s_add_u32 s44, s35, 0x7ec4000
    s_add_u32 s44, s44, s85
    buffer_store_dwordx4 v[100:103], v0, s[20:23], s44 offen sc1
    s_waitcnt vmcnt(19)
    v_lshlrev_b32 v7, 16, v32
    v_and_b32 v8, 0xffff0000, v32
    v_lshlrev_b32 v9, 16, v33
    v_and_b32 v10, 0xffff0000, v33
    v_mul_f32 v7, 0.15915494, v7
    v_mul_f32 v8, 0.15915494, v8
    v_mul_f32 v9, 0.15915494, v9
    v_mul_f32 v10, 0.15915494, v10
    v_mul_hi_u32_u24 v14, 429497, v40
    v_lshrrev_b32 v12, 3, v24
    v_cos_f32 v7, v7
    v_lshlrev_b16 v13, 3, v24
    v_mad_i32_i24 v11, v14, s55, v40
    v_bitop3_b32 v12, v6, v13, v12 bitop3:0xca
    v_lshl_add_u32 v11, v11, 17, s40
    v_lshlrev_b16 v14, 8, v14
    v_lshrrev_b32 v13, 2, v24
    v_add_u32 v40, v12, v11
    v_bitop3_b32 v24, v5, v13, v14 bitop3:0xea
    ds_add_u32 v24, v2
    v_mul_hi_u32_u24 v14, 429497, v41
    v_lshrrev_b32 v12, 3, v25
    v_cos_f32 v8, v8
    v_lshlrev_b16 v13, 3, v25
    v_mad_i32_i24 v11, v14, s55, v41
    v_bitop3_b32 v12, v6, v13, v12 bitop3:0xca
    v_lshl_add_u32 v11, v11, 17, s40
    v_lshlrev_b16 v14, 8, v14
    v_lshrrev_b32 v13, 2, v25
    v_add_u32 v41, v12, v11
    v_bitop3_b32 v25, v5, v13, v14 bitop3:0xea
    ds_add_u32 v25, v2
    v_cvt_pk_bf16_f32 v32, v7, v8
    v_perm_b32 v12, v32, v32, s41
    v_bitop3_b32 v40, v4, v12, v40 bitop3:0xca
    v_perm_b32 v13, v32, v32, s42
    v_bitop3_b32 v41, v4, v13, v41 bitop3:0xca
    v_mul_hi_u32_u24 v14, 429497, v42
    v_lshrrev_b32 v12, 3, v26
    v_cos_f32 v9, v9
    v_lshlrev_b16 v13, 3, v26
    v_mad_i32_i24 v11, v14, s55, v42
    v_bitop3_b32 v12, v6, v13, v12 bitop3:0xca
    v_lshl_add_u32 v11, v11, 17, s40
    v_lshlrev_b16 v14, 8, v14
    v_lshrrev_b32 v13, 2, v26
    v_add_u32 v42, v12, v11
    v_bitop3_b32 v26, v5, v13, v14 bitop3:0xea
    ds_add_u32 v26, v2
    v_mul_hi_u32_u24 v14, 429497, v43
    v_lshrrev_b32 v12, 3, v27
    v_cos_f32 v10, v10
    v_lshlrev_b16 v13, 3, v27
    v_mad_i32_i24 v11, v14, s55, v43
    v_bitop3_b32 v12, v6, v13, v12 bitop3:0xca
    v_lshl_add_u32 v11, v11, 17, s40
    v_lshlrev_b16 v14, 8, v14
    v_lshrrev_b32 v13, 2, v27
    v_add_u32 v43, v12, v11
    v_bitop3_b32 v27, v5, v13, v14 bitop3:0xea
    ds_add_u32 v27, v2
    v_cvt_pk_bf16_f32 v33, v9, v10
    v_perm_b32 v12, v33, v33, s41
    v_bitop3_b32 v42, v4, v12, v42 bitop3:0xca
    v_perm_b32 v13, v33, v33, s42
    v_bitop3_b32 v43, v4, v13, v43 bitop3:0xca
    s_waitcnt vmcnt(16)
    v_lshlrev_b32 v7, 16, v34
    v_and_b32 v8, 0xffff0000, v34
    v_lshlrev_b32 v9, 16, v35
    v_and_b32 v10, 0xffff0000, v35
    v_mul_f32 v7, 0.15915494, v7
    v_mul_f32 v8, 0.15915494, v8
    v_mul_f32 v9, 0.15915494, v9
    v_mul_f32 v10, 0.15915494, v10
    v_mul_hi_u32_u24 v14, 429497, v48
    v_lshrrev_b32 v12, 3, v52
    v_cos_f32 v7, v7
    v_lshlrev_b16 v13, 3, v52
    v_mad_i32_i24 v11, v14, s55, v48
    v_bitop3_b32 v12, v6, v13, v12 bitop3:0xca
    v_lshl_add_u32 v11, v11, 17, s40
    v_lshlrev_b16 v14, 8, v14
    v_lshrrev_b32 v13, 2, v52
    v_add_u32 v48, v12, v11
    v_bitop3_b32 v52, v5, v13, v14 bitop3:0xea
    ds_add_u32 v52, v2
    v_mul_hi_u32_u24 v14, 429497, v49
    v_lshrrev_b32 v12, 3, v53
    v_cos_f32 v8, v8
    v_lshlrev_b16 v13, 3, v53
    v_mad_i32_i24 v11, v14, s55, v49
    v_bitop3_b32 v12, v6, v13, v12 bitop3:0xca
    v_lshl_add_u32 v11, v11, 17, s40
    v_lshlrev_b16 v14, 8, v14
    v_lshrrev_b32 v13, 2, v53
    v_add_u32 v49, v12, v11
    v_bitop3_b32 v53, v5, v13, v14 bitop3:0xea
    ds_add_u32 v53, v2
    v_cvt_pk_bf16_f32 v34, v7, v8
    v_perm_b32 v12, v34, v34, s41
    v_bitop3_b32 v48, v4, v12, v48 bitop3:0xca
    v_perm_b32 v13, v34, v34, s42
    v_bitop3_b32 v49, v4, v13, v49 bitop3:0xca
    v_mul_hi_u32_u24 v14, 429497, v50
    v_lshrrev_b32 v12, 3, v54
    v_cos_f32 v9, v9
    v_lshlrev_b16 v13, 3, v54
    v_mad_i32_i24 v11, v14, s55, v50
    v_bitop3_b32 v12, v6, v13, v12 bitop3:0xca
    v_lshl_add_u32 v11, v11, 17, s40
    v_lshlrev_b16 v14, 8, v14
    v_lshrrev_b32 v13, 2, v54
    v_add_u32 v50, v12, v11
    v_bitop3_b32 v54, v5, v13, v14 bitop3:0xea
    ds_add_u32 v54, v2
    v_mul_hi_u32_u24 v14, 429497, v51
    v_lshrrev_b32 v12, 3, v55
    v_cos_f32 v10, v10
    v_lshlrev_b16 v13, 3, v55
    v_mad_i32_i24 v11, v14, s55, v51
    v_bitop3_b32 v12, v6, v13, v12 bitop3:0xca
    v_lshl_add_u32 v11, v11, 17, s40
    v_lshlrev_b16 v14, 8, v14
    v_lshrrev_b32 v13, 2, v55
    v_add_u32 v51, v12, v11
    v_bitop3_b32 v55, v5, v13, v14 bitop3:0xea
    ds_add_u32 v55, v2
    v_cvt_pk_bf16_f32 v35, v9, v10
    v_perm_b32 v12, v35, v35, s41
    v_bitop3_b32 v50, v4, v12, v50 bitop3:0xca
    v_perm_b32 v13, v35, v35, s42
    v_bitop3_b32 v51, v4, v13, v51 bitop3:0xca
    s_setprio 1
    s_waitcnt vmcnt(12)
    v_lshlrev_b32 v7, 16, v72
    v_and_b32 v8, 0xffff0000, v72
    v_lshlrev_b32 v9, 16, v73
    v_and_b32 v10, 0xffff0000, v73
    v_mul_f32 v7, 0.15915494, v7
    v_mul_f32 v8, 0.15915494, v8
    v_mul_f32 v9, 0.15915494, v9
    v_mul_f32 v10, 0.15915494, v10
    v_mul_hi_u32_u24 v14, 429497, v84
    v_lshrrev_b32 v12, 3, v68
    v_cos_f32 v7, v7
    v_lshlrev_b16 v13, 3, v68
    v_mad_i32_i24 v11, v14, s55, v84
    v_bitop3_b32 v12, v6, v13, v12 bitop3:0xca
    v_lshl_add_u32 v11, v11, 17, s40
    v_lshlrev_b16 v14, 8, v14
    v_lshrrev_b32 v13, 2, v68
    v_add_u32 v84, v12, v11
    v_bitop3_b32 v68, v5, v13, v14 bitop3:0xea
    ds_add_u32 v68, v2
    v_mul_hi_u32_u24 v14, 429497, v85
    v_lshrrev_b32 v12, 3, v69
    v_cos_f32 v8, v8
    v_lshlrev_b16 v13, 3, v69
    v_mad_i32_i24 v11, v14, s55, v85
    v_bitop3_b32 v12, v6, v13, v12 bitop3:0xca
    v_lshl_add_u32 v11, v11, 17, s40
    v_lshlrev_b16 v14, 8, v14
    v_lshrrev_b32 v13, 2, v69
    v_add_u32 v85, v12, v11
    v_bitop3_b32 v69, v5, v13, v14 bitop3:0xea
    ds_add_u32 v69, v2
    v_cvt_pk_bf16_f32 v72, v7, v8
    v_perm_b32 v12, v72, v72, s41
    v_bitop3_b32 v84, v4, v12, v84 bitop3:0xca
    v_perm_b32 v13, v72, v72, s42
    v_bitop3_b32 v85, v4, v13, v85 bitop3:0xca
    v_mul_hi_u32_u24 v14, 429497, v86
    v_lshrrev_b32 v12, 3, v70
    v_cos_f32 v9, v9
    v_lshlrev_b16 v13, 3, v70
    v_mad_i32_i24 v11, v14, s55, v86
    v_bitop3_b32 v12, v6, v13, v12 bitop3:0xca
    v_lshl_add_u32 v11, v11, 17, s40
    v_lshlrev_b16 v14, 8, v14
    v_lshrrev_b32 v13, 2, v70
    v_add_u32 v86, v12, v11
    v_bitop3_b32 v70, v5, v13, v14 bitop3:0xea
    ds_add_u32 v70, v2
    v_mul_hi_u32_u24 v14, 429497, v87
    v_lshrrev_b32 v12, 3, v71
    v_cos_f32 v10, v10
    v_lshlrev_b16 v13, 3, v71
    v_mad_i32_i24 v11, v14, s55, v87
    v_bitop3_b32 v12, v6, v13, v12 bitop3:0xca
    v_lshl_add_u32 v11, v11, 17, s40
    v_lshlrev_b16 v14, 8, v14
    v_lshrrev_b32 v13, 2, v71
    v_add_u32 v87, v12, v11
    v_bitop3_b32 v71, v5, v13, v14 bitop3:0xea
    ds_add_u32 v71, v2
    v_cvt_pk_bf16_f32 v73, v9, v10
    v_perm_b32 v12, v73, v73, s41
    v_bitop3_b32 v86, v4, v12, v86 bitop3:0xca
    v_perm_b32 v13, v73, v73, s42
    v_bitop3_b32 v87, v4, v13, v87 bitop3:0xca
    s_add_u32 s45, s35, 0x7ec4000
    s_add_u32 s45, s45, s91
    buffer_store_dwordx4 v[104:107], v0, s[20:23], s45 offen sc1
    s_waitcnt vmcnt(10)
    s_cmp_le_u32 s43, 5
    s_cbranch_scc1 L1_s5
    v_lshlrev_b32 v7, 16, v74
    v_and_b32 v8, 0xffff0000, v74
    v_lshlrev_b32 v9, 16, v75
    v_and_b32 v10, 0xffff0000, v75
    v_mul_f32 v7, 0.15915494, v7
    v_mul_f32 v8, 0.15915494, v8
    v_mul_f32 v9, 0.15915494, v9
    v_mul_f32 v10, 0.15915494, v10
    v_mul_hi_u32_u24 v14, 429497, v36
    v_lshrrev_b32 v12, 3, v76
    v_cos_f32 v7, v7
    v_lshlrev_b16 v13, 3, v76
    v_mad_i32_i24 v11, v14, s55, v36
    v_bitop3_b32 v12, v6, v13, v12 bitop3:0xca
    v_lshl_add_u32 v11, v11, 17, s40
    v_lshlrev_b16 v14, 8, v14
    v_lshrrev_b32 v13, 2, v76
    v_add_u32 v36, v12, v11
    v_bitop3_b32 v76, v5, v13, v14 bitop3:0xea
    ds_add_u32 v76, v2
    v_mul_hi_u32_u24 v14, 429497, v37
    v_lshrrev_b32 v12, 3, v77
    v_cos_f32 v8, v8
    v_lshlrev_b16 v13, 3, v77
    v_mad_i32_i24 v11, v14, s55, v37
    v_bitop3_b32 v12, v6, v13, v12 bitop3:0xca
    v_lshl_add_u32 v11, v11, 17, s40
    v_lshlrev_b16 v14, 8, v14
    v_lshrrev_b32 v13, 2, v77
    v_add_u32 v37, v12, v11
    v_bitop3_b32 v77, v5, v13, v14 bitop3:0xea
    ds_add_u32 v77, v2
    v_cvt_pk_bf16_f32 v74, v7, v8
    v_perm_b32 v12, v74, v74, s41
    v_bitop3_b32 v36, v4, v12, v36 bitop3:0xca
    v_perm_b32 v13, v74, v74, s42
    v_bitop3_b32 v37, v4, v13, v37 bitop3:0xca
    v_mul_hi_u32_u24 v14, 429497, v38
    v_lshrrev_b32 v12, 3, v78
    v_cos_f32 v9, v9
    v_lshlrev_b16 v13, 3, v78
    v_mad_i32_i24 v11, v14, s55, v38
    v_bitop3_b32 v12, v6, v13, v12 bitop3:0xca
    v_lshl_add_u32 v11, v11, 17, s40
    v_lshlrev_b16 v14, 8, v14
    v_lshrrev_b32 v13, 2, v78
    v_add_u32 v38, v12, v11
    v_bitop3_b32 v78, v5, v13, v14 bitop3:0xea
    ds_add_u32 v78, v2
    v_mul_hi_u32_u24 v14, 429497, v39
    v_lshrrev_b32 v12, 3, v79
    v_cos_f32 v10, v10
    v_lshlrev_b16 v13, 3, v79
    v_mad_i32_i24 v11, v14, s55, v39
    v_bitop3_b32 v12, v6, v13, v12 bitop3:0xca
    v_lshl_add_u32 v11, v11, 17, s40
    v_lshlrev_b16 v14, 8, v14
    v_lshrrev_b32 v13, 2, v79
    v_add_u32 v39, v12, v11
    v_bitop3_b32 v79, v5, v13, v14 bitop3:0xea
    ds_add_u32 v79, v2
    v_cvt_pk_bf16_f32 v75, v9, v10
    v_perm_b32 v12, v75, v75, s41
    v_bitop3_b32 v38, v4, v12, v38 bitop3:0xca
    v_perm_b32 v13, v75, v75, s42
    v_bitop3_b32 v39, v4, v13, v39 bitop3:0xca
L1_s5:
    s_setprio 0
    s_waitcnt vmcnt(6)
    s_cmp_le_u32 s43, 6
    s_cbranch_scc1 L1_s6
    v_lshlrev_b32 v7, 16, v64
    v_and_b32 v8, 0xffff0000, v64
    v_lshlrev_b32 v9, 16, v65
    v_and_b32 v10, 0xffff0000, v65
    v_mul_f32 v7, 0.15915494, v7
    v_mul_f32 v8, 0.15915494, v8
    v_mul_f32 v9, 0.15915494, v9
    v_mul_f32 v10, 0.15915494, v10
    v_mul_hi_u32_u24 v14, 429497, v80
    v_lshrrev_b32 v12, 3, v56
    v_cos_f32 v7, v7
    v_lshlrev_b16 v13, 3, v56
    v_mad_i32_i24 v11, v14, s55, v80
    v_bitop3_b32 v12, v6, v13, v12 bitop3:0xca
    v_lshl_add_u32 v11, v11, 17, s40
    v_lshlrev_b16 v14, 8, v14
    v_lshrrev_b32 v13, 2, v56
    v_add_u32 v80, v12, v11
    v_bitop3_b32 v56, v5, v13, v14 bitop3:0xea
    ds_add_u32 v56, v2
    v_mul_hi_u32_u24 v14, 429497, v81
    v_lshrrev_b32 v12, 3, v57
    v_cos_f32 v8, v8
    v_lshlrev_b16 v13, 3, v57
    v_mad_i32_i24 v11, v14, s55, v81
    v_bitop3_b32 v12, v6, v13, v12 bitop3:0xca
    v_lshl_add_u32 v11, v11, 17, s40
    v_lshlrev_b16 v14, 8, v14
    v_lshrrev_b32 v13, 2, v57
    v_add_u32 v81, v12, v11
    v_bitop3_b32 v57, v5, v13, v14 bitop3:0xea
    ds_add_u32 v57, v2
    v_cvt_pk_bf16_f32 v64, v7, v8
    v_perm_b32 v12, v64, v64, s41
    v_bitop3_b32 v80, v4, v12, v80 bitop3:0xca
    v_perm_b32 v13, v64, v64, s42
    v_bitop3_b32 v81, v4, v13, v81 bitop3:0xca
    v_mul_hi_u32_u24 v14, 429497, v82
    v_lshrrev_b32 v12, 3, v58
    v_cos_f32 v9, v9
    v_lshlrev_b16 v13, 3, v58
    v_mad_i32_i24 v11, v14, s55, v82
    v_bitop3_b32 v12, v6, v13, v12 bitop3:0xca
    v_lshl_add_u32 v11, v11, 17, s40
    v_lshlrev_b16 v14, 8, v14
    v_lshrrev_b32 v13, 2, v58
    v_add_u32 v82, v12, v11
    v_bitop3_b32 v58, v5, v13, v14 bitop3:0xea
    ds_add_u32 v58, v2
    v_mul_hi_u32_u24 v14, 429497, v83
    v_lshrrev_b32 v12, 3, v59
    v_cos_f32 v10, v10
    v_lshlrev_b16 v13, 3, v59
    v_mad_i32_i24 v11, v14, s55, v83
    v_bitop3_b32 v12, v6, v13, v12 bitop3:0xca
    v_lshl_add_u32 v11, v11, 17, s40
    v_lshlrev_b16 v14, 8, v14
    v_lshrrev_b32 v13, 2, v59
    v_add_u32 v83, v12, v11
    v_bitop3_b32 v59, v5, v13, v14 bitop3:0xea
    ds_add_u32 v59, v2
    v_cvt_pk_bf16_f32 v65, v9, v10
    v_perm_b32 v12, v65, v65, s41
    v_bitop3_b32 v82, v4, v12, v82 bitop3:0xca
    v_perm_b32 v13, v65, v65, s42
    v_bitop3_b32 v83, v4, v13, v83 bitop3:0xca
L1_s6:
    s_waitcnt vmcnt(2)
    s_cmp_le_u32 s43, 7
    s_cbranch_scc1 L1_s7
    v_lshlrev_b32 v7, 16, v66
    v_and_b32 v8, 0xffff0000, v66
    v_lshlrev_b32 v9, 16, v67
    v_and_b32 v10, 0xffff0000, v67
    v_mul_f32 v7, 0.15915494, v7
    v_mul_f32 v8, 0.15915494, v8
    v_mul_f32 v9, 0.15915494, v9
    v_mul_f32 v10, 0.15915494, v10
    v_mul_hi_u32_u24 v14, 429497, v96
    v_lshrrev_b32 v12, 3, v60
    v_cos_f32 v7, v7
    v_lshlrev_b16 v13, 3, v60
    v_mad_i32_i24 v11, v14, s55, v96
    v_bitop3_b32 v12, v6, v13, v12 bitop3:0xca
    v_lshl_add_u32 v11, v11, 17, s40
    v_lshlrev_b16 v14, 8, v14
    v_lshrrev_b32 v13, 2, v60
    v_add_u32 v96, v12, v11
    v_bitop3_b32 v60, v5, v13, v14 bitop3:0xea
    ds_add_u32 v60, v2
    v_mul_hi_u32_u24 v14, 429497, v97
    v_lshrrev_b32 v12, 3, v61
    v_cos_f32 v8, v8
    v_lshlrev_b16 v13, 3, v61
    v_mad_i32_i24 v11, v14, s55, v97
    v_bitop3_b32 v12, v6, v13, v12 bitop3:0xca
    v_lshl_add_u32 v11, v11, 17, s40
    v_lshlrev_b16 v14, 8, v14
    v_lshrrev_b32 v13, 2, v61
    v_add_u32 v97, v12, v11
    v_bitop3_b32 v61, v5, v13, v14 bitop3:0xea
    ds_add_u32 v61, v2
    v_cvt_pk_bf16_f32 v66, v7, v8
    v_perm_b32 v12, v66, v66, s41
    v_bitop3_b32 v96, v4, v12, v96 bitop3:0xca
    v_perm_b32 v13, v66, v66, s42
    v_bitop3_b32 v97, v4, v13, v97 bitop3:0xca
    v_mul_hi_u32_u24 v14, 429497, v98
    v_lshrrev_b32 v12, 3, v62
    v_cos_f32 v9, v9
    v_lshlrev_b16 v13, 3, v62
    v_mad_i32_i24 v11, v14, s55, v98
    v_bitop3_b32 v12, v6, v13, v12 bitop3:0xca
    v_lshl_add_u32 v11, v11, 17, s40
    v_lshlrev_b16 v14, 8, v14
    v_lshrrev_b32 v13, 2, v62
    v_add_u32 v98, v12, v11
    v_bitop3_b32 v62, v5, v13, v14 bitop3:0xea
    ds_add_u32 v62, v2
    v_mul_hi_u32_u24 v14, 429497, v99
    v_lshrrev_b32 v12, 3, v63
    v_cos_f32 v10, v10
    v_lshlrev_b16 v13, 3, v63
    v_mad_i32_i24 v11, v14, s55, v99
    v_bitop3_b32 v12, v6, v13, v12 bitop3:0xca
    v_lshl_add_u32 v11, v11, 17, s40
    v_lshlrev_b16 v14, 8, v14
    v_lshrrev_b32 v13, 2, v63
    v_add_u32 v99, v12, v11
    v_bitop3_b32 v63, v5, v13, v14 bitop3:0xea
    ds_add_u32 v63, v2
    v_cvt_pk_bf16_f32 v67, v9, v10
    v_perm_b32 v12, v67, v67, s41
    v_bitop3_b32 v98, v4, v12, v98 bitop3:0xca
    v_perm_b32 v13, v67, v67, s42
    v_bitop3_b32 v99, v4, v13, v99 bitop3:0xca
L1_s7:
    v_lshrrev_b32 v8, 2, v0
    v_and_b32 v7, 0x3c00, v0
    v_bitop3_b32 v7, v5, v8, v7 bitop3:0xea
    s_waitcnt lgkmcnt(0)
    s_barrier
    ds_read2st64_b32 v[8:9], v7 offset0:0 offset1:1
    ds_read2st64_b32 v[10:11], v7 offset0:2 offset1:3
    s_add_u32 s46, s35, 0x7ec4000
    s_add_u32 s46, s46, s93
    buffer_store_dwordx4 v[28:31], v0, s[20:23], s46 offen sc1
    s_waitcnt lgkmcnt(0)
    v_lshl_or_b32 v12, v9, 16, v8
    v_lshl_or_b32 v13, v11, 16, v10
    v_mov_b32 v14, v12
    v_mov_b32 v15, v13
    s_nop 0
    v_add_u32_dpp v14, v14, v14 row_shr:1 row_mask:0xf bank_mask:0xf bound_ctrl:1
    v_add_u32_dpp v15, v15, v15 row_shr:1 row_mask:0xf bank_mask:0xf bound_ctrl:1
    s_nop 0
    v_add_u32_dpp v14, v14, v14 row_shr:2 row_mask:0xf bank_mask:0xf bound_ctrl:1
    v_add_u32_dpp v15, v15, v15 row_shr:2 row_mask:0xf bank_mask:0xf bound_ctrl:1
    s_nop 0
    v_add_u32_dpp v14, v14, v14 row_shr:4 row_mask:0xf bank_mask:0xf bound_ctrl:1
    v_add_u32_dpp v15, v15, v15 row_shr:4 row_mask:0xf bank_mask:0xf bound_ctrl:1
    s_nop 0
    v_add_u32_dpp v14, v14, v14 row_shr:8 row_mask:0xf bank_mask:0xf bound_ctrl:1
    v_add_u32_dpp v15, v15, v15 row_shr:8 row_mask:0xf bank_mask:0xf bound_ctrl:1
    s_nop 0
    v_add_u32_dpp v14, v14, v14 row_bcast:15 row_mask:0xa bank_mask:0xf
    v_add_u32_dpp v15, v15, v15 row_bcast:15 row_mask:0xa bank_mask:0xf
    s_nop 0
    v_add_u32_dpp v14, v14, v14 row_bcast:31 row_mask:0xc bank_mask:0xf
    v_add_u32_dpp v15, v15, v15 row_bcast:31 row_mask:0xc bank_mask:0xf
    v_readlane_b32 s48, v14, 63
    v_readlane_b32 s49, v15, 63
    s_lshl_b32 s54, s32, 2
    v_mov_b32 v8, s54
    s_and_b32 s50, s48, 0xffff
    s_lshr_b32 s51, s48, 16
    s_and_b32 s52, s49, 0xffff
    s_lshr_b32 s53, s49, 16
    s_add_u32 s51, s51, s50
    s_add_u32 s52, s52, s51
    s_add_u32 s53, s53, s52
    v_mov_b32 v9, s53
    v_and_b32_dpp v3, v3, v3 quad_perm:[1,0,3,2] row_mask:0xf bank_mask:0xf
    s_mov_b64 exec, 1
    ds_write_b32 v8, v9 offset:16384
    ds_write_b32 v8, v3 offset:16448
    s_mov_b64 exec, -1
    v_and_b32 v8, 60, v7
    s_waitcnt lgkmcnt(0)
    s_barrier
    ds_read_b32 v9, v8 offset:16384
    ds_read_b32 v10, v8 offset:16448
    s_waitcnt lgkmcnt(0)
    v_readlane_b32 s56, v10, 15
    s_xor_b32 s56, s56, 0x80
    v_add_u32_dpp v9, v9, v9 row_shr:1 row_mask:0xf bank_mask:0xf bound_ctrl:1
    s_nop 1
    v_add_u32_dpp v9, v9, v9 row_shr:2 row_mask:0xf bank_mask:0xf bound_ctrl:1
    s_nop 1
    v_add_u32_dpp v9, v9, v9 row_shr:4 row_mask:0xf bank_mask:0xf bound_ctrl:1
    s_nop 1
    v_add_u32_dpp v9, v9, v9 row_shr:8 row_mask:0xf bank_mask:0xf bound_ctrl:1
    s_nop 0
    v_readlane_b32 s54, v9, s32
    s_sub_u32 s54, s54, s53
    s_add_u32 s50, s50, s54
    s_add_u32 s51, s51, s54
    s_add_u32 s52, s52, s54
    s_pack_ll_b32_b16 s48, s54, s50
    s_pack_ll_b32_b16 s49, s51, s52
    v_add_u32 v14, s48, v14
    v_add_u32 v15, s49, v15
    v_sub_u32 v12, v14, v12
    v_sub_u32 v13, v15, v13
    v_and_b32 v8, 0xffff, v12
    v_lshrrev_b32 v9, 16, v12
    v_and_b32 v10, 0xffff, v13
    v_lshrrev_b32 v11, 16, v13
    ds_write2st64_b32 v7, v8, v9 offset0:0 offset1:1
    ds_write2st64_b32 v7, v10, v11 offset0:2 offset1:3
    v_and_b32 v8, 0x3f0, v0
    v_lshl_add_u32 v8, v8, 1, s36
    ds_write_b64 v8, v[12:13] offset:20480
    s_bitset0_b64 exec, 63
    s_not_b64 exec, exec
    ds_write_b64 v8, v[14:15] offset:20512
    s_mov_b64 exec, -1
    s_waitcnt lgkmcnt(0)
    s_barrier
    s_setprio 3
    ds_add_rtn_u32 v120, v120, v2
    ds_add_rtn_u32 v121, v121, v2
    ds_add_rtn_u32 v122, v122, v2
    ds_add_rtn_u32 v123, v123, v2
    ds_read_b128 v[12:15], v0 offset:20480
    v_cmp_gt_u32 vcc, 8448, v0
    ds_add_rtn_u32 v124, v124, v2
    ds_add_rtn_u32 v125, v125, v2
    ds_add_rtn_u32 v126, v126, v2
    ds_add_rtn_u32 v127, v127, v2
    s_setprio 2
    ds_add_rtn_u32 v24, v24, v2
    ds_add_rtn_u32 v25, v25, v2
    ds_add_rtn_u32 v26, v26, v2
    ds_add_rtn_u32 v27, v27, v2
    s_waitcnt lgkmcnt(8)
    s_cbranch_vccz L1_p8
    s_add_u32 s47, s35, 0xa900000
    s_mov_b64 exec, vcc
    buffer_store_dwordx4 v[12:15], v0, s[24:27], s47 offen sc1
    s_mov_b64 exec, -1
L1_p8:
    s_add_u32 s44, s35, 0x7ec8000
    s_add_u32 s44, s44, s72
    buffer_store_dwordx4 v[112:115], v0, s[20:23], s44 offen sc1
    ds_add_rtn_u32 v52, v52, v2
    ds_add_rtn_u32 v53, v53, v2
    ds_add_rtn_u32 v54, v54, v2
    ds_add_rtn_u32 v55, v55, v2
    s_load_dwordx2 s[28:29], s[0:1], 0
    s_load_dwordx2 s[50:51], s[0:1], 40
    s_load_dwordx2 s[52:53], s[0:1], 24
    s_setprio 1
    ds_add_rtn_u32 v68, v68, v2
    ds_add_rtn_u32 v69, v69, v2
    ds_add_rtn_u32 v70, v70, v2
    ds_add_rtn_u32 v71, v71, v2
    s_cmp_le_u32 s43, 5
    s_cbranch_scc1 L1_s9
    ds_add_rtn_u32 v76, v76, v2
    ds_add_rtn_u32 v77, v77, v2
    ds_add_rtn_u32 v78, v78, v2
    ds_add_rtn_u32 v79, v79, v2
L1_s9:
    s_add_u32 s45, s35, 0x7ec8000
    s_add_u32 s45, s45, s73
    buffer_store_dwordx4 v[88:91], v0, s[20:23], s45 offen sc1
    s_setprio 0
    s_cmp_le_u32 s43, 6
    s_cbranch_scc1 L1_s10
    ds_add_rtn_u32 v56, v56, v2
    ds_add_rtn_u32 v57, v57, v2
    ds_add_rtn_u32 v58, v58, v2
    ds_add_rtn_u32 v59, v59, v2
L1_s10:
    s_cmp_le_u32 s43, 7
    s_cbranch_scc1 L1_s11
    ds_add_rtn_u32 v60, v60, v2
    ds_add_rtn_u32 v61, v61, v2
    ds_add_rtn_u32 v62, v62, v2
    ds_add_rtn_u32 v63, v63, v2
L1_s11:
    s_waitcnt lgkmcnt(0)
    s_barrier
    s_load_dwordx4 s[96:99], s[50:51], 0
    s_mov_b64 s[4:5], s[52:53]
    s_bfe_u32 s33, s2, 0x20001
    s_and_b32 s34, s2, 1
    s_lshl_b32 s34, s34, 5
    s_lshr_b32 s3, s2, 3
    s_add_u32 s34, s34, s3
    s_mul_i32 s39, s33, 2080
    s_lshl_b32 s3, s34, 5
    s_add_u32 s39, s39, s3
    s_mul_i32 s40, s33, 1310720
    s_add_u32 s40, s40, 0x50000
    s_lshl_b32 s38, s32, 11
    s_mul_i32 s100, s32, 3072
    s_add_u32 s8, s30, 0x4000
    s_addc_u32 s9, s31, 0
    s_mov_b32 s10, 0xd340000
    s_mov_b32 s11, 0x20000
    s_add_u32 s12, s30, 0x2c000
    s_addc_u32 s13, s31, 0
    s_mov_b32 s14, 0xd318000
    s_mov_b32 s15, 0x20000
    s_mov_b32 s16, s64
    s_mov_b32 s17, s65
    s_mov_b32 s18, 0x20
    s_mov_b32 s19, 0x20000
    s_mov_b32 s24, s28
    s_mov_b32 s25, s29
    s_mov_b32 s26, 0x4e2000
    s_mov_b32 s27, 0x20000
    s_setprio 3
    v_and_b32 v7, -4, v120
    v_lshl_add_u32 v8, v120, 2, v7
    ds_write_b32 v8, v16
    v_lshl_add_u32 v7, v7, 2, v120
    ds_write_b8 v7, v44 offset:16
    v_and_b32 v9, -4, v121
    v_lshl_add_u32 v10, v121, 2, v9
    ds_write_b32 v10, v17
    v_lshl_add_u32 v9, v9, 2, v121
    ds_write_b8_d16_hi v9, v44 offset:16
    v_and_b32 v7, -4, v122
    v_lshl_add_u32 v8, v122, 2, v7
    ds_write_b32 v8, v18
    v_lshl_add_u32 v7, v7, 2, v122
    ds_write_b8 v7, v45 offset:16
    v_and_b32 v9, -4, v123
    v_lshl_add_u32 v10, v123, 2, v9
    ds_write_b32 v10, v19
    v_lshl_add_u32 v9, v9, 2, v123
    ds_write_b8_d16_hi v9, v45 offset:16
    s_add_u32 s46, s35, 0x7ec8000
    s_add_u32 s46, s46, s85
    buffer_store_dwordx4 v[116:119], v0, s[20:23], s46 offen sc1
    v_and_b32 v13, 0x3f0, v0
    v_and_b32 v14, 0x300, v13
    v_bfe_u32 v15, v13, 4, 4
    s_lshl_b32 s3, s32, 4
    v_add3_u32 v14, v14, v15, s3
    v_mul_u32_u24 v2, 173056, v14
    v_lshrrev_b32 v14, 6, v13
    s_add_u32 s3, s3, 0x400
    v_add_u32 v14, s3, v14
    v_mul_u32_u24 v4, 173056, v14
    v_and_b32 v14, 3, v14
    v_and_b32 v15, 0x30, v13
    v_lshl_add_u32 v14, v14, 5, v15
    v_add_u32 v6, v14, v4
    v_lshl_add_u32 v5, v15, 1, v2
    v_lshrrev_b32 v14, 3, v15
    buffer_load_ushort v100, v14, s[16:19], 0 offen offset:0
    buffer_load_ushort v101, v14, s[16:19], 0 offen offset:8
    buffer_load_ushort v102, v14, s[16:19], 0 offen offset:16
    buffer_load_ushort v103, v14, s[16:19], 0 offen offset:24
    s_mul_i32 s3, s32, 5120
    v_add_u32 v3, s3, v13
    v_lshrrev_b32 v14, 2, v13
    v_add_u32 v14, s38, v14
    v_and_b32 v7, -4, v124
    v_lshl_add_u32 v8, v124, 2, v7
    ds_write_b32 v8, v20
    v_lshl_add_u32 v7, v7, 2, v124
    ds_write_b8 v7, v46 offset:16
    v_and_b32 v9, -4, v125
    v_lshl_add_u32 v10, v125, 2, v9
    ds_write_b32 v10, v21
    v_lshl_add_u32 v9, v9, 2, v125
    ds_write_b8_d16_hi v9, v46 offset:16
    v_and_b32 v7, -4, v126
    v_lshl_add_u32 v8, v126, 2, v7
    ds_write_b32 v8, v22
    v_lshl_add_u32 v7, v7, 2, v126
    ds_write_b8 v7, v47 offset:16
    v_and_b32 v9, -4, v127
    v_lshl_add_u32 v10, v127, 2, v9
    ds_write_b32 v10, v23
    v_lshl_add_u32 v9, v9, 2, v127
    ds_write_b8_d16_hi v9, v47 offset:16
    v_lshrrev_b32 v11, 2, v0
    v_and_b32 v11, 0xfc, v11
    s_cmp_ge_u32 s84, 128
    s_cselect_b32 s82, 0, s82
    s_mul_i32 s3, s84, 40
    s_add_u32 s3, s3, s32
    s_mul_i32 s76, s3, 52429
    s_lshr_b32 s76, s76, 22
    s_mul_i32 s74, s76, 80
    s_sub_u32 s3, s3, s74
    s_mul_i32 s74, s3, 205
    s_lshr_b32 s74, s74, 10
    s_mul_i32 s75, s74, 5
    s_sub_u32 s75, s3, s75
    s_lshl_b32 s48, s74, 1
    s_add_u32 s48, s48, s75
    s_add_u32 s49, s48, s74
    s_add_u32 s49, s49, 30
    s_cmp_lt_u32 s75, 2
    s_cselect_b32 s48, s48, s49
    s_lshl_b32 s48, s48, 10
    s_mul_i32 s49, s76, 80000
    s_add_u32 s48, s48, s49
    buffer_load_dword v104, v11, s[80:83], s48 offen offset:0
    buffer_load_dword v105, v11, s[80:83], s48 offen offset:256
    buffer_load_dword v106, v11, s[80:83], s48 offen offset:512
    buffer_load_dword v107, v11, s[80:83], s48 offen offset:768
    s_mul_i32 s3, s84, 40
    s_add_u32 s3, s3, s32
    s_add_u32 s3, s3, 16
    s_mul_i32 s76, s3, 52429
    s_lshr_b32 s76, s76, 22
    s_mul_i32 s74, s76, 80
    s_sub_u32 s3, s3, s74
    s_mul_i32 s74, s3, 205
    s_lshr_b32 s74, s74, 10
    s_mul_i32 s75, s74, 5
    s_sub_u32 s75, s3, s75
    s_lshl_b32 s48, s74, 1
    s_add_u32 s48, s48, s75
    s_add_u32 s49, s48, s74
    s_add_u32 s49, s49, 30
    s_cmp_lt_u32 s75, 2
    s_cselect_b32 s48, s48, s49
    s_lshl_b32 s48, s48, 10
    s_mul_i32 s49, s76, 80000
    s_add_u32 s48, s48, s49
    buffer_load_dword v28, v11, s[80:83], s48 offen offset:0
    buffer_load_dword v29, v11, s[80:83], s48 offen offset:256
    buffer_load_dword v30, v11, s[80:83], s48 offen offset:512
    buffer_load_dword v31, v11, s[80:83], s48 offen offset:768
    s_mul_i32 s3, s84, 40
    s_add_u32 s3, s3, s32
    s_add_u32 s3, s3, 32
    s_mul_i32 s76, s3, 52429
    s_lshr_b32 s76, s76, 22
    s_mul_i32 s74, s76, 80
    s_sub_u32 s3, s3, s74
    s_cmp_ge_u32 s32, 8
    s_cselect_b32 s82, 0, s82
    s_mul_i32 s74, s3, 205
    s_lshr_b32 s74, s74, 10
    s_mul_i32 s75, s74, 5
    s_sub_u32 s75, s3, s75
    s_lshl_b32 s48, s74, 1
    s_add_u32 s48, s48, s75
    s_add_u32 s49, s48, s74
    s_add_u32 s49, s49, 30
    s_cmp_lt_u32 s75, 2
    s_cselect_b32 s48, s48, s49
    s_lshl_b32 s48, s48, 10
    s_mul_i32 s49, s76, 80000
    s_add_u32 s48, s48, s49
    buffer_load_dword v112, v11, s[80:83], s48 offen offset:0
    buffer_load_dword v113, v11, s[80:83], s48 offen offset:256
    buffer_load_dword v114, v11, s[80:83], s48 offen offset:512
    buffer_load_dword v115, v11, s[80:83], s48 offen offset:768
    s_setprio 2
    v_and_b32 v7, -4, v24
    v_lshl_add_u32 v8, v24, 2, v7
    ds_write_b32 v8, v40
    v_lshl_add_u32 v7, v7, 2, v24
    ds_write_b8 v7, v32 offset:16
    v_and_b32 v9, -4, v25
    v_lshl_add_u32 v10, v25, 2, v9
    ds_write_b32 v10, v41
    v_lshl_add_u32 v9, v9, 2, v25
    ds_write_b8_d16_hi v9, v32 offset:16
    v_and_b32 v7, -4, v26
    v_lshl_add_u32 v8, v26, 2, v7
    ds_write_b32 v8, v42
    v_lshl_add_u32 v7, v7, 2, v26
    ds_write_b8 v7, v33 offset:16
    v_and_b32 v9, -4, v27
    v_lshl_add_u32 v10, v27, 2, v9
    ds_write_b32 v10, v43
    v_lshl_add_u32 v9, v9, 2, v27
    ds_write_b8_d16_hi v9, v33 offset:16
    s_add_u32 s47, s35, 0x7ec8000
    s_add_u32 s47, s47, s91
    buffer_store_dwordx4 v[92:95], v0, s[20:23], s47 offen sc1
    v_and_b32 v7, -4, v52
    v_lshl_add_u32 v8, v52, 2, v7
    ds_write_b32 v8, v48
    v_lshl_add_u32 v7, v7, 2, v52
    ds_write_b8 v7, v34 offset:16
    v_and_b32 v9, -4, v53
    v_lshl_add_u32 v10, v53, 2, v9
    ds_write_b32 v10, v49
    v_lshl_add_u32 v9, v9, 2, v53
    ds_write_b8_d16_hi v9, v34 offset:16
    v_and_b32 v7, -4, v54
    v_lshl_add_u32 v8, v54, 2, v7
    ds_write_b32 v8, v50
    v_lshl_add_u32 v7, v7, 2, v54
    ds_write_b8 v7, v35 offset:16
    v_and_b32 v9, -4, v55
    v_lshl_add_u32 v10, v55, 2, v9
    ds_write_b32 v10, v51
    v_lshl_add_u32 v9, v9, 2, v55
    ds_write_b8_d16_hi v9, v35 offset:16
    s_setprio 1
    v_and_b32 v7, -4, v68
    v_lshl_add_u32 v8, v68, 2, v7
    ds_write_b32 v8, v84
    v_lshl_add_u32 v7, v7, 2, v68
    ds_write_b8 v7, v72 offset:16
    v_and_b32 v9, -4, v69
    v_lshl_add_u32 v10, v69, 2, v9
    ds_write_b32 v10, v85
    v_lshl_add_u32 v9, v9, 2, v69
    ds_write_b8_d16_hi v9, v72 offset:16
    v_and_b32 v7, -4, v70
    v_lshl_add_u32 v8, v70, 2, v7
    ds_write_b32 v8, v86
    v_lshl_add_u32 v7, v7, 2, v70
    ds_write_b8 v7, v73 offset:16
    v_and_b32 v9, -4, v71
    v_lshl_add_u32 v10, v71, 2, v9
    ds_write_b32 v10, v87
    v_lshl_add_u32 v9, v9, 2, v71
    ds_write_b8_d16_hi v9, v73 offset:16
    s_cmp_le_u32 s43, 5
    s_cbranch_scc1 L1_s12
    v_and_b32 v7, -4, v76
    v_lshl_add_u32 v8, v76, 2, v7
    ds_write_b32 v8, v36
    v_lshl_add_u32 v7, v7, 2, v76
    ds_write_b8 v7, v74 offset:16
    v_and_b32 v9, -4, v77
    v_lshl_add_u32 v10, v77, 2, v9
    ds_write_b32 v10, v37
    v_lshl_add_u32 v9, v9, 2, v77
    ds_write_b8_d16_hi v9, v74 offset:16
    v_and_b32 v7, -4, v78
    v_lshl_add_u32 v8, v78, 2, v7
    ds_write_b32 v8, v38
    v_lshl_add_u32 v7, v7, 2, v78
    ds_write_b8 v7, v75 offset:16
    v_and_b32 v9, -4, v79
    v_lshl_add_u32 v10, v79, 2, v9
    ds_write_b32 v10, v39
    v_lshl_add_u32 v9, v9, 2, v79
    ds_write_b8_d16_hi v9, v75 offset:16
L1_s12:
    s_add_u32 s44, s35, 0x7ec8000
    s_add_u32 s44, s44, s93
    buffer_store_dwordx4 v[108:111], v0, s[20:23], s44 offen sc1
    s_setprio 0
    s_cmp_le_u32 s43, 6
    s_cbranch_scc1 L1_s13
    v_and_b32 v7, -4, v56
    v_lshl_add_u32 v8, v56, 2, v7
    ds_write_b32 v8, v80
    v_lshl_add_u32 v7, v7, 2, v56
    ds_write_b8 v7, v64 offset:16
    v_and_b32 v9, -4, v57
    v_lshl_add_u32 v10, v57, 2, v9
    ds_write_b32 v10, v81
    v_lshl_add_u32 v9, v9, 2, v57
    ds_write_b8_d16_hi v9, v64 offset:16
    v_and_b32 v7, -4, v58
    v_lshl_add_u32 v8, v58, 2, v7
    ds_write_b32 v8, v82
    v_lshl_add_u32 v7, v7, 2, v58
    ds_write_b8 v7, v65 offset:16
    v_and_b32 v9, -4, v59
    v_lshl_add_u32 v10, v59, 2, v9
    ds_write_b32 v10, v83
    v_lshl_add_u32 v9, v9, 2, v59
    ds_write_b8_d16_hi v9, v65 offset:16
L1_s13:
    s_add_u32 s80, s30, 0xd344000
    s_addc_u32 s81, s31, 0
    s_mov_b32 s82, 0xa000
    s_mov_b32 s83, 0x20000
    s_min_u32 s3, s84, 127
    s_mul_i32 s3, s3, 40960
    s_add_u32 s80, s80, s3
    s_addc_u32 s81, s81, 0
    s_cmp_ge_u32 s84, 128
    s_cselect_b32 s82, 0, s82
    s_waitcnt vmcnt(2)
    v_add_u32 v11, 0, v0
    buffer_store_dwordx4 v[104:107], v11, s[80:83], 0 offen sc1
    v_add_u32 v11, 16384, v0
    buffer_store_dwordx4 v[28:31], v11, s[80:83], 0 offen sc1
    v_add_u32 v11, 32768, v0
    buffer_store_dwordx4 v[112:115], v11, s[80:83], 0 offen sc1
    s_cmp_le_u32 s43, 7
    s_cbranch_scc1 L1_s14
    v_and_b32 v7, -4, v60
    v_lshl_add_u32 v8, v60, 2, v7
    ds_write_b32 v8, v96
    v_lshl_add_u32 v7, v7, 2, v60
    ds_write_b8 v7, v66 offset:16
    v_and_b32 v9, -4, v61
    v_lshl_add_u32 v10, v61, 2, v9
    ds_write_b32 v10, v97
    v_lshl_add_u32 v9, v9, 2, v61
    ds_write_b8_d16_hi v9, v66 offset:16
    v_and_b32 v7, -4, v62
    v_lshl_add_u32 v8, v62, 2, v7
    ds_write_b32 v8, v98
    v_lshl_add_u32 v7, v7, 2, v62
    ds_write_b8 v7, v67 offset:16
    v_and_b32 v9, -4, v63
    v_lshl_add_u32 v10, v63, 2, v9
    ds_write_b32 v10, v99
    v_lshl_add_u32 v9, v9, 2, v63
    ds_write_b8_d16_hi v9, v67 offset:16
L1_s14:
    v_add_u32 v7, 0x10000, v0
    v_add_u32 v12, 0x20000, v0
    s_waitcnt lgkmcnt(0)
    s_barrier
    ds_read_b128 v[24:27], v0 offset:0
    ds_read_b128 v[28:31], v0 offset:16384
    ds_read_b128 v[32:35], v0 offset:32768
    ds_read_b128 v[36:39], v0 offset:49152
    ds_read_b128 v[76:79], v7 offset:0
    ds_read_b128 v[80:83], v7 offset:16384
    ds_read_b128 v[84:87], v7 offset:32768
    ds_read_b128 v[104:107], v7 offset:49152
    ds_read_b128 v[68:71], v12 offset:0
    ds_read_b128 v[72:75], v12 offset:16384
    s_cmp_lg_u32 s32, 0
    s_cbranch_scc1 L2_sg1
    s_mov_b32 exec_hi, 0
    v_mov_b32 v11, 1
    buffer_store_dword v11, v14, s[60:63], s57 offen sc1
    s_mov_b64 exec, -1
L2_sg1:
    s_waitcnt lgkmcnt(9)
    s_add_u32 s45, s35, 0xa904000
    buffer_store_dwordx4 v[24:27], v0, s[20:23], s45 offen sc1
    s_waitcnt lgkmcnt(8)
    s_add_u32 s46, s35, 0xa908000
    buffer_store_dwordx4 v[28:31], v0, s[20:23], s46 offen sc1
    s_waitcnt lgkmcnt(7)
    s_add_u32 s47, s35, 0xa90c000
    buffer_store_dwordx4 v[32:35], v0, s[20:23], s47 offen sc1
    s_waitcnt lgkmcnt(6)
    s_add_u32 s44, s35, 0xa910000
    buffer_store_dwordx4 v[36:39], v0, s[20:23], s44 offen sc1
    s_waitcnt lgkmcnt(5)
    s_add_u32 s45, s35, 0xa914000
    buffer_store_dwordx4 v[76:79], v0, s[20:23], s45 offen sc1
    s_waitcnt lgkmcnt(4)
    s_add_u32 s46, s35, 0xa918000
    buffer_store_dwordx4 v[80:83], v0, s[20:23], s46 offen sc1
    s_waitcnt lgkmcnt(3)
    s_add_u32 s47, s35, 0xa91c000
    buffer_store_dwordx4 v[84:87], v0, s[20:23], s47 offen sc1
    s_waitcnt lgkmcnt(2)
    s_cmp_le_u32 s43, 5
    s_cbranch_scc1 L1_q15
    s_add_u32 s44, s35, 0xa920000
    buffer_store_dwordx4 v[104:107], v0, s[20:23], s44 offen sc1
L1_q15:
    s_waitcnt lgkmcnt(1)
    s_cmp_le_u32 s43, 6
    s_cbranch_scc1 L1_q16
    s_add_u32 s45, s35, 0xa924000
    buffer_store_dwordx4 v[68:71], v0, s[20:23], s45 offen sc1
L1_q16:
    s_waitcnt lgkmcnt(0)
    s_cmp_le_u32 s43, 7
    s_cbranch_scc1 L1_q17
    s_add_u32 s46, s35, 0xa928000
    buffer_store_dwordx4 v[72:75], v0, s[20:23], s46 offen sc1
L1_q17:
    s_waitcnt lgkmcnt(0)
    s_setprio 3
    v_mov_b32 v92, v0
    v_mov_b32 v93, v6
    v_mov_b32 v94, v13
    v_mov_b32 v95, v5
    v_mov_b32 v0, v14
    v_lshl_add_u32 v7, v13, 3, s38
    v_lshrrev_b32 v16, 2, v15
    v_mad_u32_u24 v4, v16, 5, v4
    v_or_b32 v4, 0xf0000000, v4
    v_or_b32 v2, 0xf0000000, v2
    v_sub_u32 v1, 28, v16
    v_lshrrev_b32 v17, 2, v16
    v_and_b32 v18, 3, v17
    v_lshlrev_b32 v18, 4, v18
    v_mov_b32 v10, 0x3f80
    v_mov_b32 v11, 0
    v_lshlrev_b64 v[10:11], v18, v[10:11]
    v_and_b32 v18, 3, v17
    v_lshlrev_b32 v18, 4, v18
    v_mov_b32 v12, 0xbf80
    v_mov_b32 v13, 0
    v_lshlrev_b64 v[12:13], v18, v[12:13]
    v_mov_b32 v45, 0xf0000000
    v_add_u32 v44, s38, v0
    v_lshrrev_b32 v44, 1, v44
    v_and_b32 v44, -4, v44
    v_mov_b32 v5, 0x1fff8
    v_mov_b32 v6, 0x07ff0000
    v_mov_b32 v16, 0
    v_mov_b32 v17, 0
    v_mov_b32 v18, 0
    v_mov_b32 v19, 0
    v_add_u32 v20, 81920, v92
    v_add_u32 v21, 0x10000, v20
    s_setprio 1
    s_setprio 2
    s_mov_b32 s44, 0x4000c0c
    s_mov_b32 s45, 0x4010c0c
    s_mov_b32 s46, 0x4020c0c
    s_mov_b32 s47, 0x4030c0c
    s_mov_b32 s36, 0
    s_mov_b32 s43, 0
    s_mov_b32 s42, 0
    s_mov_b64 s[80:81], 0
    s_mov_b64 s[48:49], 0
    s_add_u32 s16, s30, 0xd344000
    s_addc_u32 s17, s31, 0
    s_mov_b32 s18, 0x500000
    s_mov_b32 s19, 0x20000
    v_mov_b32 v68, 0
    v_mov_b32 v69, 0
    v_mov_b32 v70, 0
    v_mov_b32 v71, 0
    v_mov_b32 v72, 0
    v_mov_b32 v73, 0
    v_mov_b32 v74, 0
    v_mov_b32 v75, 0
    s_waitcnt vmcnt(0)
    v_lshl_or_b32 v8, v101, 16, v100
    v_lshl_or_b32 v9, v103, 16, v102
    s_barrier
    s_cmp_lg_u32 s32, 0
    s_cbranch_scc1 L2_sg2
    s_mov_b32 exec_hi, 0
    v_mov_b32 v88, 2
    buffer_store_dword v88, v0, s[60:63], s57 offen sc1
    s_mov_b64 exec, -1
L2_sg2:
    s_mov_b64 s[84:85], 0
    s_mul_i32 s3, s33, 1280000
    s_add_u32 s3, s3, s100
    s_add_u32 s3, s3, 32768
    buffer_load_dwordx4 v[124:127], v94, s[24:27], s3 offen offset:2048
    s_mul_i32 s3, s33, 1280000
    s_add_u32 s3, s3, s100
    s_add_u32 s3, s3, 32768
    buffer_load_dwordx4 v[116:119], v94, s[24:27], s3 offen offset:0
    s_mul_i32 s3, s33, 1280000
    s_add_u32 s3, s3, s100
    s_add_u32 s3, s3, 32768
    buffer_load_dwordx4 v[120:123], v94, s[24:27], s3 offen offset:1024
    s_mul_i32 s3, s33, 1280000
    s_add_u32 s3, s3, s38
    s_add_u32 s3, s3, 0
    buffer_load_dwordx4 v[108:111], v94, s[24:27], s3 offen offset:0
    s_mul_i32 s3, s33, 1280000
    s_add_u32 s3, s3, s38
    s_add_u32 s3, s3, 0
    buffer_load_dwordx4 v[112:115], v94, s[24:27], s3 offen offset:1024
    ds_write_b128 v20, v[16:19] offset:0
    ds_write_b128 v20, v[16:19] offset:16384
    ds_write_b128 v20, v[16:19] offset:32768
    ds_write_b128 v20, v[16:19] offset:49152
    ds_write_b128 v21, v[16:19]
    s_cmp_eq_u32 s56, 0
    s_cbranch_scc1 L2_e3
    v_lshlrev_b32 v16, 3, v94
    v_and_b32 v16, 0x80, v16
L2_e4:
    buffer_load_dword v88, v16, s[68:71], 0 offen sc1
    s_waitcnt vmcnt(0)
    v_cmp_gt_u32 vcc, 0x80, v88
    s_cbranch_vccnz L2_e4
L2_e3:
    s_mov_b64 exec, 0xffff
L2_p1:
    buffer_load_dword v88, v7, s[60:63], 0 offen sc1
    s_waitcnt vmcnt(0)
    v_cmpx_gt_u32 vcc, 1, v88
    s_cbranch_vccnz L2_p1
    s_mov_b64 exec, -1
    v_cmp_gt_u32 vcc, 2, v88
    s_and_b32 s56, vcc_lo, 0xffff
    buffer_load_dwordx4 v[48:51], v95, s[12:15], s39 offen offset:0
    buffer_load_dwordx4 v[56:59], v95, s[12:15], s39 offen offset:32
    buffer_load_dwordx4 v[52:55], v95, s[12:15], s39 offen offset:16
    buffer_load_dwordx4 v[60:63], v95, s[12:15], s39 offen offset:48
    buffer_load_dwordx4 v[64:67], v93, s[12:15], s39 offen
    s_waitcnt vmcnt(0)
    v_sub_u16 v88, v56, v48
    v_and_b32 v89, 3, v48
    v_add3_u32 v99, v88, v89, 3
    v_and_b32 v99, -4, v99
    v_max_u32 v99, 4, v99
    v_and_b32 v97, 0xfffc, v48
    v_bfm_b32 v96, v88, v89
    v_add_u32_dpp v91, v99, v99 row_shr:1 row_mask:0xf bank_mask:0xf bound_ctrl:1
    v_mad_u32_u24 v97, v97, 5, v2
    v_cmp_lt_u32 vcc, 16, v99
    v_add_u32_dpp v91, v91, v91 row_shr:2 row_mask:0xf bank_mask:0xf bound_ctrl:1
    v_sub_u32 v98, s38, v99
    v_lshrrev_b64 v[48:49], 16, v[48:49]
    v_add_u32_dpp v91, v91, v91 row_shr:4 row_mask:0xf bank_mask:0xf bound_ctrl:1
    v_lshrrev_b64 v[56:57], 16, v[56:57]
    s_mov_b32 s101, 0
    v_add_u32_dpp v91, v91, v91 row_shr:8 row_mask:0xf bank_mask:0xf bound_ctrl:1
    s_nop 1
    v_add_u32_dpp v91, v91, v91 row_bcast:15 row_mask:0xa bank_mask:0xf
    s_nop 1
    v_add_u32_dpp v91, v91, v91 row_bcast:31 row_mask:0xc bank_mask:0xf
    v_add_u32 v98, v98, v91
    v_readlane_b32 s37, v91, 63
    s_cbranch_vccnz L2_xo3
L2_xp3:
    s_cmp_gt_u32 s37, 1024
    s_cbranch_scc1 L2_xs4
    s_cmp_lg_u32 s101, 0
    s_cbranch_scc1 L2_xa4
L2_xb4:
    v_lshlrev_b32 v89, 16, v96
    v_add_u32 v90, 60, v97
    v_bitop3_b32 v90, v89, v45, v90 bitop3:0x6a
    ds_write_b32 v98, v90 offset:12
    v_lshlrev_b32 v89, 20, v96
    v_add_u32 v90, 40, v97
    v_bitop3_b32 v90, v89, v45, v90 bitop3:0x6a
    ds_write_b32 v98, v90 offset:8
    v_lshlrev_b32 v89, 24, v96
    v_add_u32 v90, 20, v97
    v_bitop3_b32 v90, v89, v45, v90 bitop3:0x6a
    ds_write_b32 v98, v90 offset:4
    v_lshlrev_b32 v89, 28, v96
    v_bitop3_b32 v90, v89, v45, v97 bitop3:0x6a
    ds_write_b32 v98, v90 offset:0
    v_mov_b32_dpp v91, v64 quad_perm:[0,0,0,0] row_mask:0xf bank_mask:0xf
    v_and_b32 v89, 3, v91
    v_and_b32 v97, 0xfffc, v91
    v_sub_u16_dpp v88, v64, v91 quad_perm:[2,2,2,2] row_mask:0xf bank_mask:0xf
    v_mad_u32_u24 v97, v97, 5, v4
    v_add_u32 v99, v88, v89
    v_bfm_b32 v96, v88, v89
    v_cmp_lt_u32 s[58:59], 16, v99
    v_lshlrev_b32 v89, v1, v96
    v_and_b32 v89, v45, v89
    v_cmp_ne_u32 vcc, 0, v89
    v_xor_b32 v90, v97, v89
    s_add_u32 s3, s37, s38
    v_mbcnt_lo_u32_b32 v98, vcc_lo, 0
    v_mbcnt_hi_u32_b32 v98, vcc_hi, v98
    s_bcnt1_i32_b64 s41, vcc
    v_lshl_add_u32 v98, v98, 2, s3
    s_lshl2_add_u32 s37, s41, s37
    s_mov_b64 exec, vcc
    ds_write_b32 v98, v90
    s_mov_b64 exec, -1
    s_cmp_lg_u64 s[58:59], 0
    s_cbranch_scc1 L2_xe4
L2_xr4:
    v_add_u32 v98, s37, v0
    v_mov_b32 v90, -1
    ds_write_b32 v98, v90
L2_xw4:
    ds_read_b32 v21, v0 offset:0
    ds_read_b32 v27, v0 offset:256
    ds_read_b32 v31, v44 offset:768
    ds_read_b32 v39, v0 offset:512
    s_sub_u32 s3, s37, 768
    s_cmp_gt_u32 s3, 128
    s_cbranch_scc1 L2_xf4
L2_xg4:
    v_sub_u16 v88, v58, v50
    v_and_b32 v89, 3, v50
    v_add3_u32 v99, v88, v89, 3
    v_and_b32 v99, -4, v99
    v_max_u32 v99, 4, v99
    v_and_b32 v97, 0xfffc, v50
    v_bfm_b32 v96, v88, v89
    v_add_u32_dpp v91, v99, v99 row_shr:1 row_mask:0xf bank_mask:0xf bound_ctrl:1
    v_mad_u32_u24 v97, v97, 5, v2
    v_cmp_lt_u32 vcc, 16, v99
    v_add_u32_dpp v91, v91, v91 row_shr:2 row_mask:0xf bank_mask:0xf bound_ctrl:1
    v_sub_u32 v98, s38, v99
    v_lshrrev_b64 v[50:51], 16, v[50:51]
    v_add_u32_dpp v91, v91, v91 row_shr:4 row_mask:0xf bank_mask:0xf bound_ctrl:1
    v_lshrrev_b64 v[58:59], 16, v[58:59]
    s_mov_b32 s101, 0
    v_add_u32_dpp v91, v91, v91 row_shr:8 row_mask:0xf bank_mask:0xf bound_ctrl:1
    s_nop 1
    v_add_u32_dpp v91, v91, v91 row_bcast:15 row_mask:0xa bank_mask:0xf
    s_nop 1
    v_add_u32_dpp v91, v91, v91 row_bcast:31 row_mask:0xc bank_mask:0xf
    v_add_u32 v98, v98, v91
    v_readlane_b32 s37, v91, 63
    s_cbranch_vccnz L2_xo5
L2_xp5:
    s_waitcnt lgkmcnt(0)
    s_cmp_gt_u32 s37, 1024
    s_cbranch_scc1 L2_xs6
    s_cmp_lg_u32 s101, 0
    s_cbranch_scc1 L2_xa6
L2_xb6:
    v_lshlrev_b32 v89, 16, v96
    v_add_u32 v90, 60, v97
    v_bitop3_b32 v90, v89, v45, v90 bitop3:0x6a
    ds_write_b32 v98, v90 offset:12
    v_lshlrev_b32 v89, 20, v96
    v_add_u32 v90, 40, v97
    v_bitop3_b32 v90, v89, v45, v90 bitop3:0x6a
    ds_write_b32 v98, v90 offset:8
    v_lshlrev_b32 v89, 24, v96
    v_add_u32 v90, 20, v97
    v_bitop3_b32 v90, v89, v45, v90 bitop3:0x6a
    ds_write_b32 v98, v90 offset:4
    v_lshlrev_b32 v89, 28, v96
    v_bitop3_b32 v90, v89, v45, v97 bitop3:0x6a
    ds_write_b32 v98, v90 offset:0
    v_mov_b32_dpp v91, v66 quad_perm:[0,0,0,0] row_mask:0xf bank_mask:0xf
    v_and_b32 v89, 3, v91
    v_and_b32 v97, 0xfffc, v91
    v_sub_u16_dpp v88, v66, v91 quad_perm:[2,2,2,2] row_mask:0xf bank_mask:0xf
    v_mad_u32_u24 v97, v97, 5, v4
    v_add_u32 v99, v88, v89
    v_bfm_b32 v96, v88, v89
    v_cmp_lt_u32 s[58:59], 16, v99
    v_lshlrev_b32 v89, v1, v96
    v_and_b32 v89, v45, v89
    v_cmp_ne_u32 vcc, 0, v89
    v_xor_b32 v90, v97, v89
    s_add_u32 s3, s37, s38
    v_mbcnt_lo_u32_b32 v98, vcc_lo, 0
    v_mbcnt_hi_u32_b32 v98, vcc_hi, v98
    s_bcnt1_i32_b64 s41, vcc
    v_lshl_add_u32 v98, v98, 2, s3
    s_lshl2_add_u32 s37, s41, s37
    s_mov_b64 exec, vcc
    ds_write_b32 v98, v90
    s_mov_b64 exec, -1
    s_cmp_lg_u64 s[58:59], 0
    s_cbranch_scc1 L2_xe6
L2_xr6:
    v_add_u32 v98, s37, v0
    v_mov_b32 v90, -1
    ds_write_b32 v98, v90
L2_xw6:
    ds_read_b32 v40, v0 offset:0
    ds_read_b32 v41, v0 offset:256
    ds_read_b32 v42, v44 offset:768
    ds_read_b32 v43, v0 offset:512
    s_sub_u32 s3, s37, 768
    s_cmp_gt_u32 s3, 128
    s_cbranch_scc1 L2_xf6
L2_xg6:
    v_subrev_u32 v88, s38, v3
    ds_write_b128 v88, v[124:127] offset:34816
    v_subrev_u32 v88, s38, v3
    ds_write_b128 v88, v[116:119] offset:32768
    v_subrev_u32 v88, s38, v3
    ds_write_b128 v88, v[120:123] offset:33792
    v_subrev_u32 v88, s100, v3
    ds_write_b128 v88, v[108:111] offset:0
    v_subrev_u32 v88, s100, v3
    ds_write_b128 v88, v[112:115] offset:1024
    s_cmp_eq_u32 s56, 0
    s_cbranch_scc1 L2_e2
    s_mov_b32 exec_lo, s56
    s_mov_b32 exec_hi, 0
    buffer_load_dword v88, v7, s[60:63], 0 offen sc1
    s_mov_b64 exec, -1
    s_waitcnt vmcnt(0)
    v_cmp_gt_u32 vcc, 2, v88
    s_and_b32 s56, vcc_lo, s56
    s_cbranch_scc0 L2_e2
    s_mul_i32 s3, s33, 1280000
    s_add_u32 s3, s3, s100
    s_add_u32 s3, s3, 352768
    buffer_load_dwordx4 v[124:127], v94, s[24:27], s3 offen offset:2048
    s_mul_i32 s3, s33, 1280000
    s_add_u32 s3, s3, s100
    s_add_u32 s3, s3, 352768
    buffer_load_dwordx4 v[116:119], v94, s[24:27], s3 offen offset:0
    s_mul_i32 s3, s33, 1280000
    s_add_u32 s3, s3, s100
    s_add_u32 s3, s3, 352768
    buffer_load_dwordx4 v[120:123], v94, s[24:27], s3 offen offset:1024
    s_mul_i32 s3, s33, 1280000
    s_add_u32 s3, s3, s38
    s_add_u32 s3, s3, 320000
    buffer_load_dwordx4 v[108:111], v94, s[24:27], s3 offen offset:0
    s_mul_i32 s3, s33, 1280000
    s_add_u32 s3, s3, s38
    s_add_u32 s3, s3, 320000
    buffer_load_dwordx4 v[112:115], v94, s[24:27], s3 offen offset:1024
    s_mov_b32 exec_lo, s56
    s_mov_b32 exec_hi, 0
L2_p2:
    buffer_load_dword v88, v7, s[60:63], 0 offen sc1
    s_waitcnt vmcnt(0)
    v_cmpx_gt_u32 vcc, 2, v88
    s_cbranch_vccnz L2_p2
    s_mov_b64 exec, -1
L2_e2:
    s_mov_b32 s6, 0xaaaaaaaa
    s_mov_b32 s7, 0xaaaaaaaa
    v_and_b32 v47, 0x0fffffff, v21
    buffer_load_dwordx2 v[16:17], v47, s[8:11], 0 offen
    buffer_load_dwordx3 v[18:20], v47, s[8:11], 0 offen offset:8
    s_setprio 1
    v_and_b32 v47, 0x0fffffff, v27
    buffer_load_dwordx2 v[22:23], v47, s[8:11], 0 offen
    buffer_load_dwordx3 v[24:26], v47, s[8:11], 0 offen offset:8
    s_waitcnt lgkmcnt(0)
    s_barrier
    s_bitcmp1_b32 s36, s42
    s_cbranch_scc1 L2_slow
L2_ret0:
    s_setprio 3
    s_bitcmp1_b32 s43, s42
    s_cbranch_scc1 L2_oa7
L2_ob7:
    s_bitcmp1_b32 s43, s42
    s_cbranch_scc1 L2_oa8
L2_ob8:
    s_waitcnt vmcnt(2)
    v_and_b32 v46, 0x20000000, v21
    v_lshrrev_b32 v47, 14, v17
    v_bitop3_b32 v47, v47, v5, v46 bitop3:0xea
    ds_read_b64 v[102:103], v47
    v_bitop3_b32 v93, v17, v5, v46 bitop3:0xea
    v_and_b32 v46, 0x10000000, v21
    v_lshrrev_b32 v47, 14, v16
    v_bitop3_b32 v47, v47, v5, v46 bitop3:0xea
    ds_read_b64 v[100:101], v47
    v_bitop3_b32 v92, v16, v5, v46 bitop3:0xea
    v_perm_b32 v15, v17, v20, s45
    v_bitop3_b32 v46, v17, 0.5, -0.5 bitop3:0xa8
    v_perm_b32 v14, v16, v20, s44
    v_bitop3_b32 v47, v16, 0.5, -0.5 bitop3:0xa8
    v_bitop3_b32 v15, v6, v15, v46 bitop3:0xca
    v_bitop3_b32 v14, v6, v14, v47 bitop3:0xca
    s_waitcnt lgkmcnt(0)
    v_mfma_f32_4x4x4_16b_bf16 v[80:83], v[8:9], v[102:103], 0
    v_mfma_f32_4x4x4_16b_bf16 v[76:79], v[8:9], v[100:101], 0
    v_cmp_lt_u32 s[84:85], v5, v92
    s_nop 2
    v_pk_mul_f32 v[80:81], v[80:81], v[14:15] op_sel:[0,1] op_sel_hi:[1,1]
    v_pk_mul_f32 v[82:83], v[82:83], v[14:15] op_sel:[0,1] op_sel_hi:[1,1]
    v_pk_mul_f32 v[76:77], v[76:77], v[14:15] op_sel:[0,0] op_sel_hi:[1,0]
    v_pk_mul_f32 v[78:79], v[78:79], v[14:15] op_sel:[0,0] op_sel_hi:[1,0]
    v_and_b32 v47, 0x0fffffff, v39
    buffer_load_dwordx2 v[34:35], v47, s[8:11], 0 offen
    buffer_load_dwordx3 v[36:38], v47, s[8:11], 0 offen offset:8
    v_and_b32 v46, 0x80000000, v21
    v_lshrrev_b32 v47, 14, v19
    v_bitop3_b32 v47, v47, v5, v46 bitop3:0xea
    ds_read_b64 v[106:107], v47
    v_and_b32 v99, 0x40000000, v21
    v_lshrrev_b32 v47, 14, v18
    v_bitop3_b32 v47, v47, v5, v99 bitop3:0xea
    ds_read_b64 v[104:105], v47
    v_cmp_ne_u64 s[50:51], v[72:73], v[68:69]
    v_cmpx_ne_u64 s[54:55], v[74:75], v[70:71]
    s_and_b64 s[82:83], s[54:55], s[80:81]
    s_cbranch_scc1 L2_c9
L2_d9:
    v_mov_b64 v[84:85], v[70:71]
    v_mov_b32 v7, v95
    v_mov_b64 v[86:87], v[74:75]
    s_or_b64 s[80:81], s[80:81], s[54:55]
    s_mov_b64 exec, s[50:51]
    s_and_b64 s[82:83], s[50:51], s[80:81]
    s_cbranch_scc1 L2_c10
L2_d10:
    v_mov_b64 v[84:85], v[68:69]
    v_mov_b32 v7, v94
    v_mov_b64 v[86:87], v[72:73]
    s_mov_b64 exec, -1
    s_or_b64 s[80:81], s[80:81], s[50:51]
    s_and_b64 exec, s[84:85], s[80:81]
    v_mfma_f32_4x4x4_16b_bf16 v[76:79], v[12:13], v[84:85], 0
    v_mov_b32 v92, v7
    s_andn2_b64 s[80:81], s[80:81], s[84:85]
    v_mfma_f32_4x4x4_16b_bf16 v[76:79], v[10:11], v[86:87], v[76:79]
    s_mov_b64 exec, -1
    ds_read_b64 v[70:71], v93 offset:65408
    ds_read_b64 v[68:69], v92 offset:65408
    v_bitop3_b32 v94, v18, v5, v99 bitop3:0xea
    v_bitop3_b32 v95, v19, v5, v46 bitop3:0xea
    v_perm_b32 v15, v19, v20, s47
    v_bitop3_b32 v46, v19, 0.5, -0.5 bitop3:0xa8
    v_perm_b32 v14, v18, v20, s46
    v_bitop3_b32 v47, v18, 0.5, -0.5 bitop3:0xa8
    v_bitop3_b32 v15, v6, v15, v46 bitop3:0xca
    v_bitop3_b32 v14, v6, v14, v47 bitop3:0xca
    s_waitcnt lgkmcnt(1)
    v_mfma_f32_4x4x4_16b_bf16 v[80:83], v[10:11], v[70:71], v[80:83]
    s_waitcnt lgkmcnt(0)
    v_mfma_f32_4x4x4_16b_bf16 v[76:79], v[10:11], v[68:69], v[76:79]
    s_nop 2
    v_cvt_pk_bf16_f32 v80, v80, v81
    v_cvt_pk_bf16_f32 v81, v82, v83
    ds_wrxchg_rtn_b64 v[74:75], v93, v[80:81] offset:65408
    v_cvt_pk_bf16_f32 v76, v76, v77
    v_cvt_pk_bf16_f32 v77, v78, v79
    ds_wrxchg_rtn_b64 v[72:73], v92, v[76:77] offset:65408
    s_setprio 2
    v_mfma_f32_4x4x4_16b_bf16 v[80:83], v[8:9], v[106:107], 0
    v_mfma_f32_4x4x4_16b_bf16 v[76:79], v[8:9], v[104:105], 0
    v_cmp_lt_u32 s[48:49], v5, v95
    s_nop 2
    v_pk_mul_f32 v[80:81], v[80:81], v[14:15] op_sel:[0,1] op_sel_hi:[1,1]
    v_pk_mul_f32 v[82:83], v[82:83], v[14:15] op_sel:[0,1] op_sel_hi:[1,1]
    v_pk_mul_f32 v[76:77], v[76:77], v[14:15] op_sel:[0,0] op_sel_hi:[1,0]
    v_pk_mul_f32 v[78:79], v[78:79], v[14:15] op_sel:[0,0] op_sel_hi:[1,0]
    v_and_b32 v47, 0x0fffffff, v31
    buffer_load_dword v30, v47, s[8:11], 0 offen offset:16
    s_mov_b64 exec, s[6:7]
    v_add_u32 v47, 8, v47
    v_lshrrev_b32 v31, 2, v31
    s_mov_b64 exec, -1
    buffer_load_dwordx2 v[28:29], v47, s[8:11], 0 offen
    v_and_b32 v47, 0x3f0, v3
    s_cmp_lg_u32 s56, 0
    s_cbranch_scc1 L2_m11
    s_mul_i32 s3, s33, 1280000
    s_add_u32 s3, s3, s100
    s_add_u32 s3, s3, 352768
    buffer_load_dwordx4 v[124:127], v47, s[24:27], s3 offen offset:2048
L2_m11:
    v_and_b32 v47, 0x3f0, v3
    s_cmp_lg_u32 s56, 0
    s_cbranch_scc1 L2_m12
    s_mul_i32 s3, s33, 1280000
    s_add_u32 s3, s3, s100
    s_add_u32 s3, s3, 352768
    buffer_load_dwordx4 v[116:119], v47, s[24:27], s3 offen offset:0
L2_m12:
    s_waitcnt vmcnt(4)
    v_and_b32 v46, 0x20000000, v27
    v_lshrrev_b32 v47, 14, v23
    v_bitop3_b32 v47, v47, v5, v46 bitop3:0xea
    ds_read_b64 v[102:103], v47
    v_and_b32 v99, 0x10000000, v27
    v_lshrrev_b32 v47, 14, v22
    v_bitop3_b32 v47, v47, v5, v99 bitop3:0xea
    ds_read_b64 v[100:101], v47
    s_waitcnt lgkmcnt(2)
    v_cmp_ne_u64 s[50:51], v[72:73], v[68:69]
    v_cmpx_ne_u64 s[54:55], v[74:75], v[70:71]
    s_and_b64 s[82:83], s[54:55], s[80:81]
    s_cbranch_scc1 L2_c13
L2_d13:
    v_mov_b64 v[84:85], v[70:71]
    v_mov_b32 v7, v93
    v_mov_b64 v[86:87], v[74:75]
    s_or_b64 s[80:81], s[80:81], s[54:55]
    s_mov_b64 exec, s[50:51]
    s_and_b64 s[82:83], s[50:51], s[80:81]
    s_cbranch_scc1 L2_c14
L2_d14:
    v_mov_b64 v[84:85], v[68:69]
    v_mov_b32 v7, v92
    v_mov_b64 v[86:87], v[72:73]
    s_mov_b64 exec, -1
    s_or_b64 s[80:81], s[80:81], s[50:51]
    s_and_b64 exec, s[48:49], s[80:81]
    v_mfma_f32_4x4x4_16b_bf16 v[80:83], v[12:13], v[84:85], 0
    v_mov_b32 v95, v7
    s_andn2_b64 s[80:81], s[80:81], s[48:49]
    v_mfma_f32_4x4x4_16b_bf16 v[80:83], v[10:11], v[86:87], v[80:83]
    s_mov_b64 exec, -1
    ds_read_b64 v[70:71], v95 offset:65408
    ds_read_b64 v[68:69], v94 offset:65408
    v_bitop3_b32 v92, v22, v5, v99 bitop3:0xea
    v_bitop3_b32 v93, v23, v5, v46 bitop3:0xea
    v_perm_b32 v15, v23, v26, s45
    v_bitop3_b32 v46, v23, 0.5, -0.5 bitop3:0xa8
    v_perm_b32 v14, v22, v26, s44
    v_bitop3_b32 v47, v22, 0.5, -0.5 bitop3:0xa8
    v_bitop3_b32 v15, v6, v15, v46 bitop3:0xca
    v_bitop3_b32 v14, v6, v14, v47 bitop3:0xca
    s_waitcnt lgkmcnt(1)
    v_mfma_f32_4x4x4_16b_bf16 v[80:83], v[10:11], v[70:71], v[80:83]
    s_waitcnt lgkmcnt(0)
    v_mfma_f32_4x4x4_16b_bf16 v[76:79], v[10:11], v[68:69], v[76:79]
    s_nop 2
    v_cvt_pk_bf16_f32 v80, v80, v81
    v_cvt_pk_bf16_f32 v81, v82, v83
    ds_wrxchg_rtn_b64 v[74:75], v95, v[80:81] offset:65408
    v_cvt_pk_bf16_f32 v76, v76, v77
    v_cvt_pk_bf16_f32 v77, v78, v79
    ds_wrxchg_rtn_b64 v[72:73], v94, v[76:77] offset:65408
    s_setprio 1
    v_mfma_f32_4x4x4_16b_bf16 v[80:83], v[8:9], v[102:103], 0
    v_mfma_f32_4x4x4_16b_bf16 v[76:79], v[8:9], v[100:101], 0
    s_nop 3
    v_pk_mul_f32 v[80:81], v[80:81], v[14:15] op_sel:[0,1] op_sel_hi:[1,1]
    v_pk_mul_f32 v[82:83], v[82:83], v[14:15] op_sel:[0,1] op_sel_hi:[1,1]
    v_pk_mul_f32 v[76:77], v[76:77], v[14:15] op_sel:[0,0] op_sel_hi:[1,0]
    v_pk_mul_f32 v[78:79], v[78:79], v[14:15] op_sel:[0,0] op_sel_hi:[1,0]
    v_and_b32 v47, 0x3f0, v3
    s_cmp_lg_u32 s56, 0
    s_cbranch_scc1 L2_m15
    s_mul_i32 s3, s33, 1280000
    s_add_u32 s3, s3, s100
    s_add_u32 s3, s3, 352768
    buffer_load_dwordx4 v[120:123], v47, s[24:27], s3 offen offset:1024
L2_m15:
    v_sub_u16 v88, v60, v52
    v_and_b32 v89, 3, v52
    v_add3_u32 v99, v88, v89, 3
    v_and_b32 v99, -4, v99
    v_max_u32 v99, 4, v99
    v_and_b32 v97, 0xfffc, v52
    v_bfm_b32 v96, v88, v89
    v_add_u32_dpp v91, v99, v99 row_shr:1 row_mask:0xf bank_mask:0xf bound_ctrl:1
    v_mad_u32_u24 v97, v97, 5, v2
    v_cmp_lt_u32 vcc, 16, v99
    v_add_u32_dpp v91, v91, v91 row_shr:2 row_mask:0xf bank_mask:0xf bound_ctrl:1
    v_sub_u32 v98, s38, v99
    v_lshrrev_b64 v[52:53], 16, v[52:53]
    v_add_u32_dpp v91, v91, v91 row_shr:4 row_mask:0xf bank_mask:0xf bound_ctrl:1
    v_lshrrev_b64 v[60:61], 16, v[60:61]
    s_mov_b32 s101, 0
    v_add_u32_dpp v91, v91, v91 row_shr:8 row_mask:0xf bank_mask:0xf bound_ctrl:1
    s_nop 1
    v_add_u32_dpp v91, v91, v91 row_bcast:15 row_mask:0xa bank_mask:0xf
    s_nop 1
    v_add_u32_dpp v91, v91, v91 row_bcast:31 row_mask:0xc bank_mask:0xf
    v_add_u32 v98, v98, v91
    v_readlane_b32 s37, v91, 63
    s_cbranch_vccnz L2_xo16
L2_xp16:
    v_and_b32 v46, 0x80000000, v27
    v_lshrrev_b32 v47, 14, v25
    v_bitop3_b32 v47, v47, v5, v46 bitop3:0xea
    ds_read_b64 v[106:107], v47
    v_and_b32 v99, 0x40000000, v27
    v_lshrrev_b32 v47, 14, v24
    v_bitop3_b32 v47, v47, v5, v99 bitop3:0xea
    ds_read_b64 v[104:105], v47
    s_waitcnt lgkmcnt(2)
    v_cmp_ne_u64 s[50:51], v[72:73], v[68:69]
    v_cmpx_ne_u64 s[54:55], v[74:75], v[70:71]
    s_and_b64 s[82:83], s[54:55], s[80:81]
    s_cbranch_scc1 L2_c17
L2_d17:
    v_mov_b64 v[84:85], v[70:71]
    v_mov_b32 v7, v95
    v_mov_b64 v[86:87], v[74:75]
    s_or_b64 s[80:81], s[80:81], s[54:55]
    s_mov_b64 exec, s[50:51]
    s_and_b64 s[82:83], s[50:51], s[80:81]
    s_cbranch_scc1 L2_c18
L2_d18:
    v_mov_b64 v[84:85], v[68:69]
    v_mov_b32 v7, v94
    v_mov_b64 v[86:87], v[72:73]
    s_mov_b64 exec, -1
    s_or_b64 s[80:81], s[80:81], s[50:51]
    ds_read_b64 v[70:71], v93 offset:65408
    ds_read_b64 v[68:69], v92 offset:65408
    v_bitop3_b32 v94, v24, v5, v99 bitop3:0xea
    v_bitop3_b32 v95, v25, v5, v46 bitop3:0xea
    v_perm_b32 v15, v25, v26, s47
    v_bitop3_b32 v46, v25, 0.5, -0.5 bitop3:0xa8
    v_perm_b32 v14, v24, v26, s46
    v_bitop3_b32 v47, v24, 0.5, -0.5 bitop3:0xa8
    v_bitop3_b32 v15, v6, v15, v46 bitop3:0xca
    v_bitop3_b32 v14, v6, v14, v47 bitop3:0xca
    s_waitcnt lgkmcnt(1)
    v_mfma_f32_4x4x4_16b_bf16 v[80:83], v[10:11], v[70:71], v[80:83]
    s_waitcnt lgkmcnt(0)
    v_mfma_f32_4x4x4_16b_bf16 v[76:79], v[10:11], v[68:69], v[76:79]
    s_nop 2
    v_cvt_pk_bf16_f32 v80, v80, v81
    v_cvt_pk_bf16_f32 v81, v82, v83
    ds_wrxchg_rtn_b64 v[74:75], v93, v[80:81] offset:65408
    v_cvt_pk_bf16_f32 v76, v76, v77
    v_cvt_pk_bf16_f32 v77, v78, v79
    ds_wrxchg_rtn_b64 v[72:73], v92, v[76:77] offset:65408
    v_mfma_f32_4x4x4_16b_bf16 v[80:83], v[8:9], v[106:107], 0
    v_mfma_f32_4x4x4_16b_bf16 v[76:79], v[8:9], v[104:105], 0
    v_cmp_lt_u32 s[84:85], v5, v94
    s_nop 2
    v_pk_mul_f32 v[80:81], v[80:81], v[14:15] op_sel:[0,1] op_sel_hi:[1,1]
    v_pk_mul_f32 v[82:83], v[82:83], v[14:15] op_sel:[0,1] op_sel_hi:[1,1]
    v_pk_mul_f32 v[76:77], v[76:77], v[14:15] op_sel:[0,0] op_sel_hi:[1,0]
    v_pk_mul_f32 v[78:79], v[78:79], v[14:15] op_sel:[0,0] op_sel_hi:[1,0]
    v_and_b32 v47, 0x3f0, v3
    s_cmp_lg_u32 s56, 0
    s_cbranch_scc1 L2_m19
    s_mul_i32 s3, s33, 1280000
    s_add_u32 s3, s3, s38
    s_add_u32 s3, s3, 320000
    buffer_load_dwordx4 v[108:111], v47, s[24:27], s3 offen offset:0
L2_m19:
    v_and_b32 v47, 0x3f0, v3
    s_cmp_lg_u32 s56, 0
    s_cbranch_scc1 L2_m20
    s_mul_i32 s3, s33, 1280000
    s_add_u32 s3, s3, s38
    s_add_u32 s3, s3, 320000
    buffer_load_dwordx4 v[112:115], v47, s[24:27], s3 offen offset:1024
L2_m20:
    v_and_b32 v47, 0x0fffffff, v40
    buffer_load_dwordx2 v[16:17], v47, s[8:11], 0 offen
    buffer_load_dwordx3 v[18:20], v47, s[8:11], 0 offen offset:8
    s_waitcnt vmcnt(2)
    s_mov_b64 exec, s[6:7]
    v_lshrrev_b32 v30, 16, v30
    s_mov_b64 exec, -1
    v_and_b32 v46, 0x20000000, v31
    v_lshrrev_b32 v47, 14, v29
    v_bitop3_b32 v47, v47, v5, v46 bitop3:0xea
    ds_read_b64 v[102:103], v47
    v_and_b32 v99, 0x10000000, v31
    v_lshrrev_b32 v47, 14, v28
    v_bitop3_b32 v47, v47, v5, v99 bitop3:0xea
    ds_read_b64 v[100:101], v47
    s_waitcnt lgkmcnt(2)
    v_cmp_ne_u64 s[50:51], v[72:73], v[68:69]
    v_cmpx_ne_u64 s[54:55], v[74:75], v[70:71]
    s_and_b64 s[82:83], s[54:55], s[80:81]
    s_cbranch_scc1 L2_c21
L2_d21:
    v_mov_b64 v[84:85], v[70:71]
    v_mov_b32 v7, v93
    v_mov_b64 v[86:87], v[74:75]
    s_or_b64 s[80:81], s[80:81], s[54:55]
    s_mov_b64 exec, s[50:51]
    s_and_b64 s[82:83], s[50:51], s[80:81]
    s_cbranch_scc1 L2_c22
L2_d22:
    v_mov_b64 v[84:85], v[68:69]
    v_mov_b32 v7, v92
    v_mov_b64 v[86:87], v[72:73]
    s_mov_b64 exec, -1
    s_or_b64 s[80:81], s[80:81], s[50:51]
    s_and_b64 exec, s[84:85], s[80:81]
    v_mfma_f32_4x4x4_16b_bf16 v[76:79], v[12:13], v[84:85], 0
    v_mov_b32 v94, v7
    s_andn2_b64 s[80:81], s[80:81], s[84:85]
    v_mfma_f32_4x4x4_16b_bf16 v[76:79], v[10:11], v[86:87], v[76:79]
    s_mov_b64 exec, -1
    ds_read_b64 v[70:71], v95 offset:65408
    ds_read_b64 v[68:69], v94 offset:65408
    v_bitop3_b32 v92, v28, v5, v99 bitop3:0xea
    v_bitop3_b32 v93, v29, v5, v46 bitop3:0xea
    v_perm_b32 v15, v29, v30, s45
    v_bitop3_b32 v46, v29, 0.5, -0.5 bitop3:0xa8
    v_perm_b32 v14, v28, v30, s44
    v_bitop3_b32 v47, v28, 0.5, -0.5 bitop3:0xa8
    v_bitop3_b32 v15, v6, v15, v46 bitop3:0xca
    v_bitop3_b32 v14, v6, v14, v47 bitop3:0xca
    s_waitcnt lgkmcnt(1)
    v_mfma_f32_4x4x4_16b_bf16 v[80:83], v[10:11], v[70:71], v[80:83]
    s_waitcnt lgkmcnt(0)
    v_mfma_f32_4x4x4_16b_bf16 v[76:79], v[10:11], v[68:69], v[76:79]
    s_nop 2
    v_cvt_pk_bf16_f32 v80, v80, v81
    v_cvt_pk_bf16_f32 v81, v82, v83
    ds_wrxchg_rtn_b64 v[74:75], v95, v[80:81] offset:65408
    v_cvt_pk_bf16_f32 v76, v76, v77
    v_cvt_pk_bf16_f32 v77, v78, v79
    ds_wrxchg_rtn_b64 v[72:73], v94, v[76:77] offset:65408
    s_setprio 0
    v_mfma_f32_4x4x4_16b_bf16 v[80:83], v[8:9], v[102:103], 0
    v_mfma_f32_4x4x4_16b_bf16 v[76:79], v[8:9], v[100:101], 0
    v_cmp_lt_u32 s[48:49], v5, v93
    s_nop 2
    v_pk_mul_f32 v[80:81], v[80:81], v[14:15] op_sel:[0,1] op_sel_hi:[1,1]
    v_pk_mul_f32 v[82:83], v[82:83], v[14:15] op_sel:[0,1] op_sel_hi:[1,1]
    v_pk_mul_f32 v[76:77], v[76:77], v[14:15] op_sel:[0,0] op_sel_hi:[1,0]
    v_pk_mul_f32 v[78:79], v[78:79], v[14:15] op_sel:[0,0] op_sel_hi:[1,0]
    s_add_u32 s40, s40, 0x50000
    v_and_b32 v47, 0x0fffffff, v41
    buffer_load_dwordx2 v[22:23], v47, s[8:11], 0 offen
    buffer_load_dwordx3 v[24:26], v47, s[8:11], 0 offen offset:8
    v_and_b32 v46, 0x80000000, v39
    v_lshrrev_b32 v47, 14, v37
    v_bitop3_b32 v47, v47, v5, v46 bitop3:0xea
    ds_read_b64 v[102:103], v47
    v_and_b32 v99, 0x40000000, v39
    v_lshrrev_b32 v47, 14, v36
    v_bitop3_b32 v47, v47, v5, v99 bitop3:0xea
    ds_read_b64 v[100:101], v47
    v_and_b32 v46, 0x20000000, v39
    v_lshrrev_b32 v47, 14, v35
    v_bitop3_b32 v47, v47, v5, v46 bitop3:0xea
    ds_read_b64 v[106:107], v47
    v_and_b32 v99, 0x10000000, v39
    v_lshrrev_b32 v47, 14, v34
    v_bitop3_b32 v47, v47, v5, v99 bitop3:0xea
    ds_read_b64 v[104:105], v47
    s_waitcnt lgkmcnt(4)
    v_cmp_ne_u64 s[50:51], v[72:73], v[68:69]
    v_cmpx_ne_u64 s[54:55], v[74:75], v[70:71]
    s_and_b64 s[82:83], s[54:55], s[80:81]
    s_cbranch_scc1 L2_c23
L2_d23:
    v_mov_b64 v[84:85], v[70:71]
    v_mov_b32 v7, v95
    v_mov_b64 v[86:87], v[74:75]
    s_or_b64 s[80:81], s[80:81], s[54:55]
    s_mov_b64 exec, s[50:51]
    s_and_b64 s[82:83], s[50:51], s[80:81]
    s_cbranch_scc1 L2_c24
L2_d24:
    v_mov_b64 v[84:85], v[68:69]
    v_mov_b32 v7, v94
    v_mov_b64 v[86:87], v[72:73]
    s_mov_b64 exec, -1
    s_or_b64 s[80:81], s[80:81], s[50:51]
    s_and_b64 exec, s[48:49], s[80:81]
    v_mfma_f32_4x4x4_16b_bf16 v[80:83], v[12:13], v[84:85], 0
    v_mov_b32 v93, v7
    s_andn2_b64 s[80:81], s[80:81], s[48:49]
    v_mfma_f32_4x4x4_16b_bf16 v[80:83], v[10:11], v[86:87], v[80:83]
    s_mov_b64 exec, -1
    ds_read_b64 v[70:71], v93 offset:65408
    ds_read_b64 v[68:69], v92 offset:65408
    v_bitop3_b32 v94, v34, v5, v99 bitop3:0xea
    v_bitop3_b32 v95, v35, v5, v46 bitop3:0xea
    v_perm_b32 v15, v35, v38, s45
    v_bitop3_b32 v46, v35, 0.5, -0.5 bitop3:0xa8
    v_perm_b32 v14, v34, v38, s44
    v_bitop3_b32 v47, v34, 0.5, -0.5 bitop3:0xa8
    v_bitop3_b32 v15, v6, v15, v46 bitop3:0xca
    v_bitop3_b32 v14, v6, v14, v47 bitop3:0xca
    s_waitcnt lgkmcnt(1)
    v_mfma_f32_4x4x4_16b_bf16 v[80:83], v[10:11], v[70:71], v[80:83]
    s_waitcnt lgkmcnt(0)
    v_mfma_f32_4x4x4_16b_bf16 v[76:79], v[10:11], v[68:69], v[76:79]
    s_nop 2
    v_cvt_pk_bf16_f32 v80, v80, v81
    v_cvt_pk_bf16_f32 v81, v82, v83
    ds_wrxchg_rtn_b64 v[74:75], v93, v[80:81] offset:65408
    v_cvt_pk_bf16_f32 v76, v76, v77
    v_cvt_pk_bf16_f32 v77, v78, v79
    ds_wrxchg_rtn_b64 v[72:73], v92, v[76:77] offset:65408
    s_barrier
    s_setprio 3
    s_waitcnt vmcnt(4)
    v_subrev_u32 v88, s38, v3
    ds_write_b128 v88, v[124:127] offset:34816
    s_add_u32 s3, s40, 4096
    buffer_load_dwordx4 v[124:127], v3, s[16:19], s3 offen sc1
    s_waitcnt vmcnt(5)
    v_subrev_u32 v88, s38, v3
    ds_write_b128 v88, v[116:119] offset:32768
    buffer_load_dwordx4 v[116:119], v3, s[16:19], s40 offen offset:2048 sc1
    s_waitcnt vmcnt(6)
    v_subrev_u32 v88, s38, v3
    ds_write_b128 v88, v[120:123] offset:33792
    buffer_load_dwordx4 v[120:123], v3, s[16:19], s40 offen offset:3072 sc1
    v_mfma_f32_4x4x4_16b_bf16 v[80:83], v[8:9], v[106:107], 0
    v_mfma_f32_4x4x4_16b_bf16 v[76:79], v[8:9], v[104:105], 0
    s_nop 3
    v_pk_mul_f32 v[80:81], v[80:81], v[14:15] op_sel:[0,1] op_sel_hi:[1,1]
    v_pk_mul_f32 v[82:83], v[82:83], v[14:15] op_sel:[0,1] op_sel_hi:[1,1]
    v_pk_mul_f32 v[76:77], v[76:77], v[14:15] op_sel:[0,0] op_sel_hi:[1,0]
    v_pk_mul_f32 v[78:79], v[78:79], v[14:15] op_sel:[0,0] op_sel_hi:[1,0]
    v_and_b32 v47, 0x0fffffff, v42
    buffer_load_dword v30, v47, s[8:11], 0 offen offset:16
    s_mov_b64 exec, s[6:7]
    v_add_u32 v47, 8, v47
    v_lshrrev_b32 v42, 2, v42
    s_mov_b64 exec, -1
    buffer_load_dwordx2 v[28:29], v47, s[8:11], 0 offen
    s_cmp_gt_u32 s37, 1024
    s_cbranch_scc1 L2_xs25
    s_cmp_lg_u32 s101, 0
    s_cbranch_scc1 L2_xa25
L2_xb25:
    v_lshlrev_b32 v89, 16, v96
    v_add_u32 v90, 60, v97
    v_bitop3_b32 v90, v89, v45, v90 bitop3:0x6a
    ds_write_b32 v98, v90 offset:12
    v_lshlrev_b32 v89, 20, v96
    v_add_u32 v90, 40, v97
    v_bitop3_b32 v90, v89, v45, v90 bitop3:0x6a
    ds_write_b32 v98, v90 offset:8
    v_lshlrev_b32 v89, 24, v96
    v_add_u32 v90, 20, v97
    v_bitop3_b32 v90, v89, v45, v90 bitop3:0x6a
    ds_write_b32 v98, v90 offset:4
    v_lshlrev_b32 v89, 28, v96
    v_bitop3_b32 v90, v89, v45, v97 bitop3:0x6a
    ds_write_b32 v98, v90 offset:0
    v_mov_b32_dpp v91, v64 quad_perm:[1,1,1,1] row_mask:0xf bank_mask:0xf
    v_and_b32 v89, 3, v91
    v_and_b32 v97, 0xfffc, v91
    v_sub_u16_dpp v88, v64, v91 quad_perm:[3,3,3,3] row_mask:0xf bank_mask:0xf
    v_mad_u32_u24 v97, v97, 5, v4
    v_add_u32 v99, v88, v89
    v_bfm_b32 v96, v88, v89
    v_cmp_lt_u32 s[58:59], 16, v99
    v_lshlrev_b32 v89, v1, v96
    v_and_b32 v89, v45, v89
    v_cmp_ne_u32 vcc, 0, v89
    v_xor_b32 v90, v97, v89
    s_add_u32 s3, s37, s38
    v_mbcnt_lo_u32_b32 v98, vcc_lo, 0
    v_mbcnt_hi_u32_b32 v98, vcc_hi, v98
    s_bcnt1_i32_b64 s41, vcc
    v_lshl_add_u32 v98, v98, 2, s3
    s_lshl2_add_u32 s37, s41, s37
    s_mov_b64 exec, vcc
    ds_write_b32 v98, v90
    s_mov_b64 exec, -1
    s_cmp_lg_u64 s[58:59], 0
    s_cbranch_scc1 L2_xe25
L2_xr25:
    v_add_u32 v98, s37, v0
    v_mov_b32 v90, -1
    ds_write_b32 v98, v90
L2_xw25:
    s_setprio 2
    s_waitcnt lgkmcnt(9)
    v_cmp_ne_u64 s[50:51], v[72:73], v[68:69]
    v_cmpx_ne_u64 s[54:55], v[74:75], v[70:71]
    s_and_b64 s[82:83], s[54:55], s[80:81]
    s_cbranch_scc1 L2_c26
L2_d26:
    v_mov_b64 v[84:85], v[70:71]
    v_mov_b32 v7, v93
    v_mov_b64 v[86:87], v[74:75]
    s_or_b64 s[80:81], s[80:81], s[54:55]
    s_mov_b64 exec, s[50:51]
    s_and_b64 s[82:83], s[50:51], s[80:81]
    s_cbranch_scc1 L2_c27
L2_d27:
    v_mov_b64 v[84:85], v[68:69]
    v_mov_b32 v7, v92
    v_mov_b64 v[86:87], v[72:73]
    s_mov_b64 exec, -1
    s_or_b64 s[80:81], s[80:81], s[50:51]
    ds_read_b64 v[70:71], v95 offset:65408
    ds_read_b64 v[68:69], v94 offset:65408
    v_and_b32 v46, 0x40000000, v39
    v_bitop3_b32 v92, v36, v5, v46 bitop3:0xea
    v_and_b32 v46, 0x80000000, v39
    v_bitop3_b32 v93, v37, v5, v46 bitop3:0xea
    v_perm_b32 v15, v37, v38, s47
    v_bitop3_b32 v46, v37, 0.5, -0.5 bitop3:0xa8
    v_perm_b32 v14, v36, v38, s46
    v_bitop3_b32 v47, v36, 0.5, -0.5 bitop3:0xa8
    v_bitop3_b32 v15, v6, v15, v46 bitop3:0xca
    v_bitop3_b32 v14, v6, v14, v47 bitop3:0xca
    s_setprio 1
    s_waitcnt lgkmcnt(1)
    v_mfma_f32_4x4x4_16b_bf16 v[80:83], v[10:11], v[70:71], v[80:83]
    s_waitcnt lgkmcnt(0)
    v_mfma_f32_4x4x4_16b_bf16 v[76:79], v[10:11], v[68:69], v[76:79]
    s_nop 2
    v_cvt_pk_bf16_f32 v80, v80, v81
    v_cvt_pk_bf16_f32 v81, v82, v83
    ds_wrxchg_rtn_b64 v[74:75], v95, v[80:81] offset:65408
    v_cvt_pk_bf16_f32 v76, v76, v77
    v_cvt_pk_bf16_f32 v77, v78, v79
    ds_wrxchg_rtn_b64 v[72:73], v94, v[76:77] offset:65408
    ds_read_b32 v21, v0 offset:0
    ds_read_b32 v27, v0 offset:256
    ds_read_b32 v31, v44 offset:768
    ds_read_b32 v39, v0 offset:512
    s_sub_u32 s3, s37, 768
    s_cmp_gt_u32 s3, 128
    s_cbranch_scc1 L2_xf25
L2_xg25:
    v_and_b32 v88, 0x0fffffff, v43
    buffer_load_dwordx2 v[34:35], v88, s[8:11], 0 offen
    buffer_load_dwordx3 v[36:38], v88, s[8:11], 0 offen offset:8
    s_setprio 0
    s_waitcnt vmcnt(11)
    v_subrev_u32 v88, s100, v3
    ds_write_b128 v88, v[108:111] offset:0
    s_waitcnt vmcnt(11)
    v_subrev_u32 v88, s100, v3
    ds_write_b128 v88, v[112:115] offset:1024
    v_mfma_f32_4x4x4_16b_bf16 v[80:83], v[8:9], v[102:103], 0
    v_mfma_f32_4x4x4_16b_bf16 v[76:79], v[8:9], v[100:101], 0
    v_cmp_lt_u32 s[84:85], v5, v92
    s_nop 2
    v_pk_mul_f32 v[80:81], v[80:81], v[14:15] op_sel:[0,1] op_sel_hi:[1,1]
    v_pk_mul_f32 v[82:83], v[82:83], v[14:15] op_sel:[0,1] op_sel_hi:[1,1]
    v_pk_mul_f32 v[76:77], v[76:77], v[14:15] op_sel:[0,0] op_sel_hi:[1,0]
    v_pk_mul_f32 v[78:79], v[78:79], v[14:15] op_sel:[0,0] op_sel_hi:[1,0]
    s_add_u32 s42, s42, 1
    s_waitcnt lgkmcnt(0)
    s_add_u32 s24, s30, 0xec54000
    s_addc_u32 s25, s31, 0
    s_mov_b32 s26, 0x100
    s_mov_b32 s27, 0x20000
    s_barrier
    s_bitcmp1_b32 s36, s42
    s_cbranch_scc1 L2_slow
L2_ret1:
    s_setprio 3
    s_bitcmp1_b32 s43, s42
    s_cbranch_scc1 L2_oa28
L2_ob28:
    s_waitcnt vmcnt(9)
    v_and_b32 v46, 0x20000000, v40
    v_lshrrev_b32 v47, 14, v17
    v_bitop3_b32 v47, v47, v5, v46 bitop3:0xea
    ds_read_b64 v[106:107], v47
    v_and_b32 v99, 0x10000000, v40
    v_lshrrev_b32 v47, 14, v16
    v_bitop3_b32 v47, v47, v5, v99 bitop3:0xea
    ds_read_b64 v[104:105], v47
    v_cmp_ne_u64 s[50:51], v[72:73], v[68:69]
    v_cmpx_ne_u64 s[54:55], v[74:75], v[70:71]
    s_and_b64 s[82:83], s[54:55], s[80:81]
    s_cbranch_scc1 L2_c29
L2_d29:
    v_mov_b64 v[84:85], v[70:71]
    v_mov_b32 v7, v95
    v_mov_b64 v[86:87], v[74:75]
    s_or_b64 s[80:81], s[80:81], s[54:55]
    s_mov_b64 exec, s[50:51]
    s_and_b64 s[82:83], s[50:51], s[80:81]
    s_cbranch_scc1 L2_c30
L2_d30:
    v_mov_b64 v[84:85], v[68:69]
    v_mov_b32 v7, v94
    v_mov_b64 v[86:87], v[72:73]
    s_mov_b64 exec, -1
    s_or_b64 s[80:81], s[80:81], s[50:51]
    s_and_b64 exec, s[84:85], s[80:81]
    v_mfma_f32_4x4x4_16b_bf16 v[76:79], v[12:13], v[84:85], 0
    v_mov_b32 v92, v7
    s_andn2_b64 s[80:81], s[80:81], s[84:85]
    v_mfma_f32_4x4x4_16b_bf16 v[76:79], v[10:11], v[86:87], v[76:79]
    s_mov_b64 exec, -1
    ds_read_b64 v[70:71], v93 offset:65408
    ds_read_b64 v[68:69], v92 offset:65408
    v_bitop3_b32 v94, v16, v5, v99 bitop3:0xea
    v_bitop3_b32 v95, v17, v5, v46 bitop3:0xea
    v_perm_b32 v15, v17, v20, s45
    v_bitop3_b32 v46, v17, 0.5, -0.5 bitop3:0xa8
    v_perm_b32 v14, v16, v20, s44
    v_bitop3_b32 v47, v16, 0.5, -0.5 bitop3:0xa8
    v_bitop3_b32 v15, v6, v15, v46 bitop3:0xca
    v_bitop3_b32 v14, v6, v14, v47 bitop3:0xca
    s_waitcnt lgkmcnt(1)
    v_mfma_f32_4x4x4_16b_bf16 v[80:83], v[10:11], v[70:71], v[80:83]
    s_waitcnt lgkmcnt(0)
    v_mfma_f32_4x4x4_16b_bf16 v[76:79], v[10:11], v[68:69], v[76:79]
    s_nop 2
    v_cvt_pk_bf16_f32 v80, v80, v81
    v_cvt_pk_bf16_f32 v81, v82, v83
    ds_wrxchg_rtn_b64 v[74:75], v93, v[80:81] offset:65408
    v_cvt_pk_bf16_f32 v76, v76, v77
    v_cvt_pk_bf16_f32 v77, v78, v79
    ds_wrxchg_rtn_b64 v[72:73], v92, v[76:77] offset:65408
    v_mfma_f32_4x4x4_16b_bf16 v[80:83], v[8:9], v[106:107], 0
    v_mfma_f32_4x4x4_16b_bf16 v[76:79], v[8:9], v[104:105], 0
    v_cmp_lt_u32 s[84:85], v5, v94
    s_nop 2
    v_pk_mul_f32 v[80:81], v[80:81], v[14:15] op_sel:[0,1] op_sel_hi:[1,1]
    v_pk_mul_f32 v[82:83], v[82:83], v[14:15] op_sel:[0,1] op_sel_hi:[1,1]
    v_pk_mul_f32 v[76:77], v[76:77], v[14:15] op_sel:[0,0] op_sel_hi:[1,0]
    v_pk_mul_f32 v[78:79], v[78:79], v[14:15] op_sel:[0,0] op_sel_hi:[1,0]
    buffer_load_dwordx4 v[108:111], v3, s[16:19], s40 offen offset:0 sc1
    v_and_b32 v46, 0x80000000, v40
    v_lshrrev_b32 v47, 14, v19
    v_bitop3_b32 v47, v47, v5, v46 bitop3:0xea
    ds_read_b64 v[102:103], v47
    v_and_b32 v99, 0x40000000, v40
    v_lshrrev_b32 v47, 14, v18
    v_bitop3_b32 v47, v47, v5, v99 bitop3:0xea
    ds_read_b64 v[100:101], v47
    s_waitcnt lgkmcnt(2)
    v_cmp_ne_u64 s[50:51], v[72:73], v[68:69]
    v_cmpx_ne_u64 s[54:55], v[74:75], v[70:71]
    s_and_b64 s[82:83], s[54:55], s[80:81]
    s_cbranch_scc1 L2_c31
L2_d31:
    v_mov_b64 v[84:85], v[70:71]
    v_mov_b32 v7, v93
    v_mov_b64 v[86:87], v[74:75]
    s_or_b64 s[80:81], s[80:81], s[54:55]
    s_mov_b64 exec, s[50:51]
    s_and_b64 s[82:83], s[50:51], s[80:81]
    s_cbranch_scc1 L2_c32
L2_d32:
    v_mov_b64 v[84:85], v[68:69]
    v_mov_b32 v7, v92
    v_mov_b64 v[86:87], v[72:73]
    s_mov_b64 exec, -1
    s_or_b64 s[80:81], s[80:81], s[50:51]
    s_and_b64 exec, s[84:85], s[80:81]
    v_mfma_f32_4x4x4_16b_bf16 v[76:79], v[12:13], v[84:85], 0
    v_mov_b32 v94, v7
    s_andn2_b64 s[80:81], s[80:81], s[84:85]
    v_mfma_f32_4x4x4_16b_bf16 v[76:79], v[10:11], v[86:87], v[76:79]
    s_mov_b64 exec, -1
    ds_read_b64 v[70:71], v95 offset:65408
    ds_read_b64 v[68:69], v94 offset:65408
    v_bitop3_b32 v92, v18, v5, v99 bitop3:0xea
    v_bitop3_b32 v93, v19, v5, v46 bitop3:0xea
    v_perm_b32 v15, v19, v20, s47
    v_bitop3_b32 v46, v19, 0.5, -0.5 bitop3:0xa8
    v_perm_b32 v14, v18, v20, s46
    v_bitop3_b32 v47, v18, 0.5, -0.5 bitop3:0xa8
    v_bitop3_b32 v15, v6, v15, v46 bitop3:0xca
    v_bitop3_b32 v14, v6, v14, v47 bitop3:0xca
    s_waitcnt lgkmcnt(1)
    v_mfma_f32_4x4x4_16b_bf16 v[80:83], v[10:11], v[70:71], v[80:83]
    s_waitcnt lgkmcnt(0)
    v_mfma_f32_4x4x4_16b_bf16 v[76:79], v[10:11], v[68:69], v[76:79]
    s_nop 2
    v_cvt_pk_bf16_f32 v80, v80, v81
    v_cvt_pk_bf16_f32 v81, v82, v83
    ds_wrxchg_rtn_b64 v[74:75], v95, v[80:81] offset:65408
    v_cvt_pk_bf16_f32 v76, v76, v77
    v_cvt_pk_bf16_f32 v77, v78, v79
    ds_wrxchg_rtn_b64 v[72:73], v94, v[76:77] offset:65408
    v_and_b32 v88, 0x0fffffff, v21
    buffer_load_dwordx2 v[16:17], v88, s[8:11], 0 offen
    buffer_load_dwordx3 v[18:20], v88, s[8:11], 0 offen offset:8
    s_setprio 2
    v_mfma_f32_4x4x4_16b_bf16 v[80:83], v[8:9], v[102:103], 0
    v_mfma_f32_4x4x4_16b_bf16 v[76:79], v[8:9], v[100:101], 0
    v_cmp_lt_u32 s[48:49], v5, v93
    s_nop 2
    v_pk_mul_f32 v[80:81], v[80:81], v[14:15] op_sel:[0,1] op_sel_hi:[1,1]
    v_pk_mul_f32 v[82:83], v[82:83], v[14:15] op_sel:[0,1] op_sel_hi:[1,1]
    v_pk_mul_f32 v[76:77], v[76:77], v[14:15] op_sel:[0,0] op_sel_hi:[1,0]
    v_pk_mul_f32 v[78:79], v[78:79], v[14:15] op_sel:[0,0] op_sel_hi:[1,0]
    s_waitcnt vmcnt(10)
    v_and_b32 v46, 0x20000000, v41
    v_lshrrev_b32 v47, 14, v23
    v_bitop3_b32 v47, v47, v5, v46 bitop3:0xea
    ds_read_b64 v[106:107], v47
    v_and_b32 v99, 0x10000000, v41
    v_lshrrev_b32 v47, 14, v22
    v_bitop3_b32 v47, v47, v5, v99 bitop3:0xea
    ds_read_b64 v[104:105], v47
    s_waitcnt lgkmcnt(2)
    v_cmp_ne_u64 s[50:51], v[72:73], v[68:69]
    v_cmpx_ne_u64 s[54:55], v[74:75], v[70:71]
    s_and_b64 s[82:83], s[54:55], s[80:81]
    s_cbranch_scc1 L2_c33
L2_d33:
    v_mov_b64 v[84:85], v[70:71]
    v_mov_b32 v7, v95
    v_mov_b64 v[86:87], v[74:75]
    s_or_b64 s[80:81], s[80:81], s[54:55]
    s_mov_b64 exec, s[50:51]
    s_and_b64 s[82:83], s[50:51], s[80:81]
    s_cbranch_scc1 L2_c34
L2_d34:
    v_mov_b64 v[84:85], v[68:69]
    v_mov_b32 v7, v94
    v_mov_b64 v[86:87], v[72:73]
    s_mov_b64 exec, -1
    s_or_b64 s[80:81], s[80:81], s[50:51]
    s_and_b64 exec, s[48:49], s[80:81]
    v_mfma_f32_4x4x4_16b_bf16 v[80:83], v[12:13], v[84:85], 0
    v_mov_b32 v93, v7
    s_andn2_b64 s[80:81], s[80:81], s[48:49]
    v_mfma_f32_4x4x4_16b_bf16 v[80:83], v[10:11], v[86:87], v[80:83]
    s_mov_b64 exec, -1
    ds_read_b64 v[70:71], v93 offset:65408
    ds_read_b64 v[68:69], v92 offset:65408
    v_bitop3_b32 v94, v22, v5, v99 bitop3:0xea
    v_bitop3_b32 v95, v23, v5, v46 bitop3:0xea
    v_perm_b32 v15, v23, v26, s45
    v_bitop3_b32 v46, v23, 0.5, -0.5 bitop3:0xa8
    v_perm_b32 v14, v22, v26, s44
    v_bitop3_b32 v47, v22, 0.5, -0.5 bitop3:0xa8
    v_bitop3_b32 v15, v6, v15, v46 bitop3:0xca
    v_bitop3_b32 v14, v6, v14, v47 bitop3:0xca
    s_waitcnt lgkmcnt(1)
    v_mfma_f32_4x4x4_16b_bf16 v[80:83], v[10:11], v[70:71], v[80:83]
    s_waitcnt lgkmcnt(0)
    v_mfma_f32_4x4x4_16b_bf16 v[76:79], v[10:11], v[68:69], v[76:79]
    s_nop 2
    v_cvt_pk_bf16_f32 v80, v80, v81
    v_cvt_pk_bf16_f32 v81, v82, v83
    ds_wrxchg_rtn_b64 v[74:75], v93, v[80:81] offset:65408
    v_cvt_pk_bf16_f32 v76, v76, v77
    v_cvt_pk_bf16_f32 v77, v78, v79
    ds_wrxchg_rtn_b64 v[72:73], v92, v[76:77] offset:65408
    s_setprio 1
    v_mfma_f32_4x4x4_16b_bf16 v[80:83], v[8:9], v[106:107], 0
    v_mfma_f32_4x4x4_16b_bf16 v[76:79], v[8:9], v[104:105], 0
    s_nop 3
    v_pk_mul_f32 v[80:81], v[80:81], v[14:15] op_sel:[0,1] op_sel_hi:[1,1]
    v_pk_mul_f32 v[82:83], v[82:83], v[14:15] op_sel:[0,1] op_sel_hi:[1,1]
    v_pk_mul_f32 v[76:77], v[76:77], v[14:15] op_sel:[0,0] op_sel_hi:[1,0]
    v_pk_mul_f32 v[78:79], v[78:79], v[14:15] op_sel:[0,0] op_sel_hi:[1,0]
    s_bitcmp1_b32 s43, s42
    s_cbranch_scc1 L2_oa35
L2_ob35:
    buffer_load_dwordx4 v[112:115], v3, s[16:19], s40 offen offset:1024 sc1
    v_sub_u16 v88, v62, v54
    v_and_b32 v89, 3, v54
    v_add3_u32 v99, v88, v89, 3
    v_and_b32 v99, -4, v99
    v_max_u32 v99, 4, v99
    v_and_b32 v97, 0xfffc, v54
    v_bfm_b32 v96, v88, v89
    v_add_u32_dpp v91, v99, v99 row_shr:1 row_mask:0xf bank_mask:0xf bound_ctrl:1
    v_mad_u32_u24 v97, v97, 5, v2
    v_cmp_lt_u32 vcc, 16, v99
    v_add_u32_dpp v91, v91, v91 row_shr:2 row_mask:0xf bank_mask:0xf bound_ctrl:1
    v_sub_u32 v98, s38, v99
    v_lshrrev_b64 v[54:55], 16, v[54:55]
    v_add_u32_dpp v91, v91, v91 row_shr:4 row_mask:0xf bank_mask:0xf bound_ctrl:1
    v_lshrrev_b64 v[62:63], 16, v[62:63]
    s_mov_b32 s101, 0
    v_add_u32_dpp v91, v91, v91 row_shr:8 row_mask:0xf bank_mask:0xf bound_ctrl:1
    s_nop 1
    v_add_u32_dpp v91, v91, v91 row_bcast:15 row_mask:0xa bank_mask:0xf
    s_nop 1
    v_add_u32_dpp v91, v91, v91 row_bcast:31 row_mask:0xc bank_mask:0xf
    v_add_u32 v98, v98, v91
    v_readlane_b32 s37, v91, 63
    s_cbranch_vccnz L2_xo36
L2_xp36:
    v_and_b32 v46, 0x80000000, v41
    v_lshrrev_b32 v47, 14, v25
    v_bitop3_b32 v47, v47, v5, v46 bitop3:0xea
    ds_read_b64 v[102:103], v47
    v_and_b32 v99, 0x40000000, v41
    v_lshrrev_b32 v47, 14, v24
    v_bitop3_b32 v47, v47, v5, v99 bitop3:0xea
    ds_read_b64 v[100:101], v47
    s_waitcnt lgkmcnt(2)
    v_cmp_ne_u64 s[50:51], v[72:73], v[68:69]
    v_cmpx_ne_u64 s[54:55], v[74:75], v[70:71]
    s_and_b64 s[82:83], s[54:55], s[80:81]
    s_cbranch_scc1 L2_c37
L2_d37:
    v_mov_b64 v[84:85], v[70:71]
    v_mov_b32 v7, v93
    v_mov_b64 v[86:87], v[74:75]
    s_or_b64 s[80:81], s[80:81], s[54:55]
    s_mov_b64 exec, s[50:51]
    s_and_b64 s[82:83], s[50:51], s[80:81]
    s_cbranch_scc1 L2_c38
L2_d38:
    v_mov_b64 v[84:85], v[68:69]
    v_mov_b32 v7, v92
    v_mov_b64 v[86:87], v[72:73]
    s_mov_b64 exec, -1
    s_or_b64 s[80:81], s[80:81], s[50:51]
    ds_read_b64 v[70:71], v95 offset:65408
    ds_read_b64 v[68:69], v94 offset:65408
    v_bitop3_b32 v92, v24, v5, v99 bitop3:0xea
    v_bitop3_b32 v93, v25, v5, v46 bitop3:0xea
    v_perm_b32 v15, v25, v26, s47
    v_bitop3_b32 v46, v25, 0.5, -0.5 bitop3:0xa8
    v_perm_b32 v14, v24, v26, s46
    v_bitop3_b32 v47, v24, 0.5, -0.5 bitop3:0xa8
    v_bitop3_b32 v15, v6, v15, v46 bitop3:0xca
    v_bitop3_b32 v14, v6, v14, v47 bitop3:0xca
    s_waitcnt lgkmcnt(1)
    v_mfma_f32_4x4x4_16b_bf16 v[80:83], v[10:11], v[70:71], v[80:83]
    s_waitcnt lgkmcnt(0)
    v_mfma_f32_4x4x4_16b_bf16 v[76:79], v[10:11], v[68:69], v[76:79]
    s_nop 2
    v_cvt_pk_bf16_f32 v80, v80, v81
    v_cvt_pk_bf16_f32 v81, v82, v83
    ds_wrxchg_rtn_b64 v[74:75], v95, v[80:81] offset:65408
    v_cvt_pk_bf16_f32 v76, v76, v77
    v_cvt_pk_bf16_f32 v77, v78, v79
    ds_wrxchg_rtn_b64 v[72:73], v94, v[76:77] offset:65408
    v_and_b32 v88, 0x0fffffff, v27
    buffer_load_dwordx2 v[22:23], v88, s[8:11], 0 offen
    buffer_load_dwordx3 v[24:26], v88, s[8:11], 0 offen offset:8
    v_mfma_f32_4x4x4_16b_bf16 v[80:83], v[8:9], v[102:103], 0
    v_mfma_f32_4x4x4_16b_bf16 v[76:79], v[8:9], v[100:101], 0
    v_cmp_lt_u32 s[84:85], v5, v92
    s_nop 2
    v_pk_mul_f32 v[80:81], v[80:81], v[14:15] op_sel:[0,1] op_sel_hi:[1,1]
    v_pk_mul_f32 v[82:83], v[82:83], v[14:15] op_sel:[0,1] op_sel_hi:[1,1]
    v_pk_mul_f32 v[76:77], v[76:77], v[14:15] op_sel:[0,0] op_sel_hi:[1,0]
    v_pk_mul_f32 v[78:79], v[78:79], v[14:15] op_sel:[0,0] op_sel_hi:[1,0]
    s_waitcnt vmcnt(8)
    s_mov_b64 exec, s[6:7]
    v_lshrrev_b32 v30, 16, v30
    s_mov_b64 exec, -1
    v_and_b32 v46, 0x20000000, v42
    v_lshrrev_b32 v47, 14, v29
    v_bitop3_b32 v47, v47, v5, v46 bitop3:0xea
    ds_read_b64 v[106:107], v47
    v_and_b32 v99, 0x10000000, v42
    v_lshrrev_b32 v47, 14, v28
    v_bitop3_b32 v47, v47, v5, v99 bitop3:0xea
    ds_read_b64 v[104:105], v47
    s_waitcnt lgkmcnt(2)
    v_cmp_ne_u64 s[50:51], v[72:73], v[68:69]
    v_cmpx_ne_u64 s[54:55], v[74:75], v[70:71]
    s_and_b64 s[82:83], s[54:55], s[80:81]
    s_cbranch_scc1 L2_c39
L2_d39:
    v_mov_b64 v[84:85], v[70:71]
    v_mov_b32 v7, v95
    v_mov_b64 v[86:87], v[74:75]
    s_or_b64 s[80:81], s[80:81], s[54:55]
    s_mov_b64 exec, s[50:51]
    s_and_b64 s[82:83], s[50:51], s[80:81]
    s_cbranch_scc1 L2_c40
L2_d40:
    v_mov_b64 v[84:85], v[68:69]
    v_mov_b32 v7, v94
    v_mov_b64 v[86:87], v[72:73]
    s_mov_b64 exec, -1
    s_or_b64 s[80:81], s[80:81], s[50:51]
    s_and_b64 exec, s[84:85], s[80:81]
    v_mfma_f32_4x4x4_16b_bf16 v[76:79], v[12:13], v[84:85], 0
    v_mov_b32 v92, v7
    s_andn2_b64 s[80:81], s[80:81], s[84:85]
    v_mfma_f32_4x4x4_16b_bf16 v[76:79], v[10:11], v[86:87], v[76:79]
    s_mov_b64 exec, -1
    ds_read_b64 v[70:71], v93 offset:65408
    ds_read_b64 v[68:69], v92 offset:65408
    v_bitop3_b32 v94, v28, v5, v99 bitop3:0xea
    v_bitop3_b32 v95, v29, v5, v46 bitop3:0xea
    v_perm_b32 v15, v29, v30, s45
    v_bitop3_b32 v46, v29, 0.5, -0.5 bitop3:0xa8
    v_perm_b32 v14, v28, v30, s44
    v_bitop3_b32 v47, v28, 0.5, -0.5 bitop3:0xa8
    v_bitop3_b32 v15, v6, v15, v46 bitop3:0xca
    v_bitop3_b32 v14, v6, v14, v47 bitop3:0xca
    s_waitcnt lgkmcnt(1)
    v_mfma_f32_4x4x4_16b_bf16 v[80:83], v[10:11], v[70:71], v[80:83]
    s_waitcnt lgkmcnt(0)
    v_mfma_f32_4x4x4_16b_bf16 v[76:79], v[10:11], v[68:69], v[76:79]
    s_nop 2
    v_cvt_pk_bf16_f32 v80, v80, v81
    v_cvt_pk_bf16_f32 v81, v82, v83
    ds_wrxchg_rtn_b64 v[74:75], v93, v[80:81] offset:65408
    v_cvt_pk_bf16_f32 v76, v76, v77
    v_cvt_pk_bf16_f32 v77, v78, v79
    ds_wrxchg_rtn_b64 v[72:73], v92, v[76:77] offset:65408
    s_setprio 0
    v_mfma_f32_4x4x4_16b_bf16 v[80:83], v[8:9], v[106:107], 0
    v_mfma_f32_4x4x4_16b_bf16 v[76:79], v[8:9], v[104:105], 0
    v_cmp_lt_u32 s[48:49], v5, v95
    s_nop 2
    v_pk_mul_f32 v[80:81], v[80:81], v[14:15] op_sel:[0,1] op_sel_hi:[1,1]
    v_pk_mul_f32 v[82:83], v[82:83], v[14:15] op_sel:[0,1] op_sel_hi:[1,1]
    v_pk_mul_f32 v[76:77], v[76:77], v[14:15] op_sel:[0,0] op_sel_hi:[1,0]
    v_pk_mul_f32 v[78:79], v[78:79], v[14:15] op_sel:[0,0] op_sel_hi:[1,0]
    s_add_u32 s40, s40, 0x50000
    v_and_b32 v47, 0x0fffffff, v31
    buffer_load_dword v30, v47, s[8:11], 0 offen offset:16
    s_mov_b64 exec, s[6:7]
    v_add_u32 v47, 8, v47
    v_lshrrev_b32 v31, 2, v31
    s_mov_b64 exec, -1
    buffer_load_dwordx2 v[28:29], v47, s[8:11], 0 offen
    s_waitcnt vmcnt(8)
    v_and_b32 v46, 0x80000000, v43
    v_lshrrev_b32 v47, 14, v37
    v_bitop3_b32 v47, v47, v5, v46 bitop3:0xea
    ds_read_b64 v[106:107], v47
    v_and_b32 v99, 0x40000000, v43
    v_lshrrev_b32 v47, 14, v36
    v_bitop3_b32 v47, v47, v5, v99 bitop3:0xea
    ds_read_b64 v[104:105], v47
    v_and_b32 v46, 0x20000000, v43
    v_lshrrev_b32 v47, 14, v35
    v_bitop3_b32 v47, v47, v5, v46 bitop3:0xea
    ds_read_b64 v[102:103], v47
    v_and_b32 v99, 0x10000000, v43
    v_lshrrev_b32 v47, 14, v34
    v_bitop3_b32 v47, v47, v5, v99 bitop3:0xea
    ds_read_b64 v[100:101], v47
    s_waitcnt lgkmcnt(4)
    v_cmp_ne_u64 s[50:51], v[72:73], v[68:69]
    v_cmpx_ne_u64 s[54:55], v[74:75], v[70:71]
    s_and_b64 s[82:83], s[54:55], s[80:81]
    s_cbranch_scc1 L2_c41
L2_d41:
    v_mov_b64 v[84:85], v[70:71]
    v_mov_b32 v7, v93
    v_mov_b64 v[86:87], v[74:75]
    s_or_b64 s[80:81], s[80:81], s[54:55]
    s_mov_b64 exec, s[50:51]
    s_and_b64 s[82:83], s[50:51], s[80:81]
    s_cbranch_scc1 L2_c42
L2_d42:
    v_mov_b64 v[84:85], v[68:69]
    v_mov_b32 v7, v92
    v_mov_b64 v[86:87], v[72:73]
    s_mov_b64 exec, -1
    s_or_b64 s[80:81], s[80:81], s[50:51]
    s_and_b64 exec, s[48:49], s[80:81]
    v_mfma_f32_4x4x4_16b_bf16 v[80:83], v[12:13], v[84:85], 0
    v_mov_b32 v95, v7
    s_andn2_b64 s[80:81], s[80:81], s[48:49]
    v_mfma_f32_4x4x4_16b_bf16 v[80:83], v[10:11], v[86:87], v[80:83]
    s_mov_b64 exec, -1
    ds_read_b64 v[70:71], v95 offset:65408
    ds_read_b64 v[68:69], v94 offset:65408
    v_bitop3_b32 v92, v34, v5, v99 bitop3:0xea
    v_bitop3_b32 v93, v35, v5, v46 bitop3:0xea
    v_perm_b32 v15, v35, v38, s45
    v_bitop3_b32 v46, v35, 0.5, -0.5 bitop3:0xa8
    v_perm_b32 v14, v34, v38, s44
    v_bitop3_b32 v47, v34, 0.5, -0.5 bitop3:0xa8
    v_bitop3_b32 v15, v6, v15, v46 bitop3:0xca
    v_bitop3_b32 v14, v6, v14, v47 bitop3:0xca
    s_waitcnt lgkmcnt(1)
    v_mfma_f32_4x4x4_16b_bf16 v[80:83], v[10:11], v[70:71], v[80:83]
    s_waitcnt lgkmcnt(0)
    v_mfma_f32_4x4x4_16b_bf16 v[76:79], v[10:11], v[68:69], v[76:79]
    s_nop 2
    v_cvt_pk_bf16_f32 v80, v80, v81
    v_cvt_pk_bf16_f32 v81, v82, v83
    ds_wrxchg_rtn_b64 v[74:75], v95, v[80:81] offset:65408
    v_cvt_pk_bf16_f32 v76, v76, v77
    v_cvt_pk_bf16_f32 v77, v78, v79
    ds_wrxchg_rtn_b64 v[72:73], v94, v[76:77] offset:65408
    s_barrier
    s_setprio 3
    s_mov_b32 m0, s100
    s_nop 0
    ds_write_addtid_b32 v124 offset:34816
    ds_write_addtid_b32 v125 offset:35072
    ds_write_addtid_b32 v126 offset:35328
    ds_write_addtid_b32 v127 offset:35584
    s_add_u32 s3, s40, 4096
    buffer_load_dwordx4 v[124:127], v3, s[16:19], s3 offen sc1
    ds_write_addtid_b32 v116 offset:32768
    ds_write_addtid_b32 v117 offset:33024
    ds_write_addtid_b32 v118 offset:33280
    ds_write_addtid_b32 v119 offset:33536
    buffer_load_dwordx4 v[116:119], v3, s[16:19], s40 offen offset:2048 sc1
    ds_write_addtid_b32 v120 offset:33792
    ds_write_addtid_b32 v121 offset:34048
    ds_write_addtid_b32 v122 offset:34304
    ds_write_addtid_b32 v123 offset:34560
    buffer_load_dwordx4 v[120:123], v3, s[16:19], s40 offen offset:3072 sc1
    v_mfma_f32_4x4x4_16b_bf16 v[80:83], v[8:9], v[102:103], 0
    v_mfma_f32_4x4x4_16b_bf16 v[76:79], v[8:9], v[100:101], 0
    s_nop 3
    v_pk_mul_f32 v[80:81], v[80:81], v[14:15] op_sel:[0,1] op_sel_hi:[1,1]
    v_pk_mul_f32 v[82:83], v[82:83], v[14:15] op_sel:[0,1] op_sel_hi:[1,1]
    v_pk_mul_f32 v[76:77], v[76:77], v[14:15] op_sel:[0,0] op_sel_hi:[1,0]
    v_pk_mul_f32 v[78:79], v[78:79], v[14:15] op_sel:[0,0] op_sel_hi:[1,0]
    s_cmp_gt_u32 s37, 1024
    s_cbranch_scc1 L2_xs43
    s_cmp_lg_u32 s101, 0
    s_cbranch_scc1 L2_xa43
L2_xb43:
    v_lshlrev_b32 v89, 16, v96
    v_add_u32 v90, 60, v97
    v_bitop3_b32 v90, v89, v45, v90 bitop3:0x6a
    ds_write_b32 v98, v90 offset:12
    v_lshlrev_b32 v89, 20, v96
    v_add_u32 v90, 40, v97
    v_bitop3_b32 v90, v89, v45, v90 bitop3:0x6a
    ds_write_b32 v98, v90 offset:8
    v_lshlrev_b32 v89, 24, v96
    v_add_u32 v90, 20, v97
    v_bitop3_b32 v90, v89, v45, v90 bitop3:0x6a
    ds_write_b32 v98, v90 offset:4
    v_lshlrev_b32 v89, 28, v96
    v_bitop3_b32 v90, v89, v45, v97 bitop3:0x6a
    ds_write_b32 v98, v90 offset:0
    v_mov_b32_dpp v91, v66 quad_perm:[1,1,1,1] row_mask:0xf bank_mask:0xf
    v_and_b32 v89, 3, v91
    v_and_b32 v97, 0xfffc, v91
    v_sub_u16_dpp v88, v66, v91 quad_perm:[3,3,3,3] row_mask:0xf bank_mask:0xf
    v_mad_u32_u24 v97, v97, 5, v4
    v_add_u32 v99, v88, v89
    v_bfm_b32 v96, v88, v89
    v_cmp_lt_u32 s[58:59], 16, v99
    v_lshlrev_b32 v89, v1, v96
    v_and_b32 v89, v45, v89
    v_cmp_ne_u32 vcc, 0, v89
    v_xor_b32 v90, v97, v89
    s_add_u32 s3, s37, s38
    v_mbcnt_lo_u32_b32 v98, vcc_lo, 0
    v_mbcnt_hi_u32_b32 v98, vcc_hi, v98
    s_bcnt1_i32_b64 s41, vcc
    v_lshl_add_u32 v98, v98, 2, s3
    s_lshl2_add_u32 s37, s41, s37
    s_mov_b64 exec, vcc
    ds_write_b32 v98, v90
    s_mov_b64 exec, -1
    s_cmp_lg_u64 s[58:59], 0
    s_cbranch_scc1 L2_xe43
L2_xr43:
    v_add_u32 v98, s37, v0
    v_mov_b32 v90, -1
    ds_write_b32 v98, v90
L2_xw43:
    s_setprio 2
    s_waitcnt lgkmcnt(14)
    v_cmp_ne_u64 s[50:51], v[72:73], v[68:69]
    v_cmpx_ne_u64 s[54:55], v[74:75], v[70:71]
    s_and_b64 s[82:83], s[54:55], s[80:81]
    s_cbranch_scc1 L2_c44
L2_d44:
    v_mov_b64 v[84:85], v[70:71]
    v_mov_b32 v7, v95
    v_mov_b64 v[86:87], v[74:75]
    s_or_b64 s[80:81], s[80:81], s[54:55]
    s_mov_b64 exec, s[50:51]
    s_and_b64 s[82:83], s[50:51], s[80:81]
    s_cbranch_scc1 L2_c45
L2_d45:
    v_mov_b64 v[84:85], v[68:69]
    v_mov_b32 v7, v94
    v_mov_b64 v[86:87], v[72:73]
    s_mov_b64 exec, -1
    s_or_b64 s[80:81], s[80:81], s[50:51]
    ds_read_b64 v[70:71], v93 offset:65408
    ds_read_b64 v[68:69], v92 offset:65408
    v_and_b32 v46, 0x40000000, v43
    v_bitop3_b32 v94, v36, v5, v46 bitop3:0xea
    v_and_b32 v46, 0x80000000, v43
    v_bitop3_b32 v95, v37, v5, v46 bitop3:0xea
    v_perm_b32 v15, v37, v38, s47
    v_bitop3_b32 v46, v37, 0.5, -0.5 bitop3:0xa8
    v_perm_b32 v14, v36, v38, s46
    v_bitop3_b32 v47, v36, 0.5, -0.5 bitop3:0xa8
    v_bitop3_b32 v15, v6, v15, v46 bitop3:0xca
    v_bitop3_b32 v14, v6, v14, v47 bitop3:0xca
    s_setprio 1
    s_waitcnt lgkmcnt(1)
    v_mfma_f32_4x4x4_16b_bf16 v[80:83], v[10:11], v[70:71], v[80:83]
    s_waitcnt lgkmcnt(0)
    v_mfma_f32_4x4x4_16b_bf16 v[76:79], v[10:11], v[68:69], v[76:79]
    s_nop 2
    v_cvt_pk_bf16_f32 v80, v80, v81
    v_cvt_pk_bf16_f32 v81, v82, v83
    ds_wrxchg_rtn_b64 v[74:75], v93, v[80:81] offset:65408
    v_cvt_pk_bf16_f32 v76, v76, v77
    v_cvt_pk_bf16_f32 v77, v78, v79
    ds_wrxchg_rtn_b64 v[72:73], v92, v[76:77] offset:65408
    ds_read_b32 v40, v0 offset:0
    ds_read_b32 v41, v0 offset:256
    ds_read_b32 v42, v44 offset:768
    ds_read_b32 v43, v0 offset:512
    s_sub_u32 s3, s37, 768
    s_cmp_gt_u32 s3, 128
    s_cbranch_scc1 L2_xf43
L2_xg43:
    v_lshrrev_b64 v[64:65], 16, v[64:65]
    v_lshrrev_b64 v[66:67], 16, v[66:67]
    v_and_b32 v88, 0x0fffffff, v39
    buffer_load_dwordx2 v[34:35], v88, s[8:11], 0 offen
    buffer_load_dwordx3 v[36:38], v88, s[8:11], 0 offen offset:8
    s_setprio 0
    s_waitcnt vmcnt(12)
    s_mov_b32 m0, s38
    s_nop 0
    ds_write_addtid_b32 v108 offset:0
    ds_write_addtid_b32 v109 offset:256
    ds_write_addtid_b32 v110 offset:512
    ds_write_addtid_b32 v111 offset:768
    s_waitcnt vmcnt(9)
    ds_write_addtid_b32 v112 offset:1024
    ds_write_addtid_b32 v113 offset:1280
    ds_write_addtid_b32 v114 offset:1536
    ds_write_addtid_b32 v115 offset:1792
    v_mfma_f32_4x4x4_16b_bf16 v[80:83], v[8:9], v[106:107], 0
    v_mfma_f32_4x4x4_16b_bf16 v[76:79], v[8:9], v[104:105], 0
    v_cmp_lt_u32 s[84:85], v5, v94
    s_nop 2
    v_pk_mul_f32 v[80:81], v[80:81], v[14:15] op_sel:[0,1] op_sel_hi:[1,1]
    v_pk_mul_f32 v[82:83], v[82:83], v[14:15] op_sel:[0,1] op_sel_hi:[1,1]
    v_pk_mul_f32 v[76:77], v[76:77], v[14:15] op_sel:[0,0] op_sel_hi:[1,0]
    v_pk_mul_f32 v[78:79], v[78:79], v[14:15] op_sel:[0,0] op_sel_hi:[1,0]
    s_add_u32 s42, s42, 1
    s_waitcnt lgkmcnt(0)
L2_loop:
    s_barrier
    s_bitcmp1_b32 s36, s42
    s_cbranch_scc1 L2_slow
L2_ret2:
    s_setprio 3
    s_bitcmp1_b32 s43, s42
    s_cbranch_scc1 L2_oa46
L2_ob46:
    v_and_b32 v46, 0x20000000, v21
    v_lshrrev_b32 v47, 14, v17
    v_bitop3_b32 v47, v47, v5, v46 bitop3:0xea
    ds_read_b64 v[102:103], v47
    v_and_b32 v99, 0x10000000, v21
    v_lshrrev_b32 v47, 14, v16
    v_bitop3_b32 v47, v47, v5, v99 bitop3:0xea
    ds_read_b64 v[100:101], v47
    v_cmp_ne_u64 s[50:51], v[72:73], v[68:69]
    v_cmpx_ne_u64 s[54:55], v[74:75], v[70:71]
    s_and_b64 s[82:83], s[54:55], s[80:81]
    s_cbranch_scc1 L2_c47
L2_d47:
    v_mov_b64 v[84:85], v[70:71]
    v_mov_b32 v7, v93
    v_mov_b64 v[86:87], v[74:75]
    s_or_b64 s[80:81], s[80:81], s[54:55]
    s_mov_b64 exec, s[50:51]
    s_and_b64 s[82:83], s[50:51], s[80:81]
    s_cbranch_scc1 L2_c48
L2_d48:
    v_mov_b64 v[84:85], v[68:69]
    v_mov_b32 v7, v92
    v_mov_b64 v[86:87], v[72:73]
    s_mov_b64 exec, -1
    s_or_b64 s[80:81], s[80:81], s[50:51]
    s_and_b64 exec, s[84:85], s[80:81]
    v_mfma_f32_4x4x4_16b_bf16 v[76:79], v[12:13], v[84:85], 0
    v_mov_b32 v94, v7
    s_andn2_b64 s[80:81], s[80:81], s[84:85]
    v_mfma_f32_4x4x4_16b_bf16 v[76:79], v[10:11], v[86:87], v[76:79]
    s_mov_b64 exec, -1
    ds_read_b64 v[70:71], v95 offset:65408
    ds_read_b64 v[68:69], v94 offset:65408
    v_bitop3_b32 v92, v16, v5, v99 bitop3:0xea
    v_bitop3_b32 v93, v17, v5, v46 bitop3:0xea
    v_perm_b32 v15, v17, v20, s45
    v_bitop3_b32 v46, v17, 0.5, -0.5 bitop3:0xa8
    v_perm_b32 v14, v16, v20, s44
    v_bitop3_b32 v47, v16, 0.5, -0.5 bitop3:0xa8
    v_bitop3_b32 v15, v6, v15, v46 bitop3:0xca
    v_bitop3_b32 v14, v6, v14, v47 bitop3:0xca
    s_waitcnt lgkmcnt(1)
    v_mfma_f32_4x4x4_16b_bf16 v[80:83], v[10:11], v[70:71], v[80:83]
    s_waitcnt lgkmcnt(0)
    v_mfma_f32_4x4x4_16b_bf16 v[76:79], v[10:11], v[68:69], v[76:79]
    s_nop 2
    v_cvt_pk_bf16_f32 v80, v80, v81
    v_cvt_pk_bf16_f32 v81, v82, v83
    ds_wrxchg_rtn_b64 v[74:75], v95, v[80:81] offset:65408
    v_cvt_pk_bf16_f32 v76, v76, v77
    v_cvt_pk_bf16_f32 v77, v78, v79
    ds_wrxchg_rtn_b64 v[72:73], v94, v[76:77] offset:65408
    v_mfma_f32_4x4x4_16b_bf16 v[80:83], v[8:9], v[102:103], 0
    v_mfma_f32_4x4x4_16b_bf16 v[76:79], v[8:9], v[100:101], 0
    v_cmp_lt_u32 s[84:85], v5, v92
    s_nop 2
    v_pk_mul_f32 v[80:81], v[80:81], v[14:15] op_sel:[0,1] op_sel_hi:[1,1]
    v_pk_mul_f32 v[82:83], v[82:83], v[14:15] op_sel:[0,1] op_sel_hi:[1,1]
    v_pk_mul_f32 v[76:77], v[76:77], v[14:15] op_sel:[0,0] op_sel_hi:[1,0]
    v_pk_mul_f32 v[78:79], v[78:79], v[14:15] op_sel:[0,0] op_sel_hi:[1,0]
    buffer_load_dwordx4 v[108:111], v3, s[16:19], s40 offen offset:0 sc1
    v_and_b32 v46, 0x80000000, v21
    v_lshrrev_b32 v47, 14, v19
    v_bitop3_b32 v47, v47, v5, v46 bitop3:0xea
    ds_read_b64 v[106:107], v47
    v_and_b32 v99, 0x40000000, v21
    v_lshrrev_b32 v47, 14, v18
    v_bitop3_b32 v47, v47, v5, v99 bitop3:0xea
    ds_read_b64 v[104:105], v47
    s_waitcnt lgkmcnt(2)
    v_cmp_ne_u64 s[50:51], v[72:73], v[68:69]
    v_cmpx_ne_u64 s[54:55], v[74:75], v[70:71]
    s_and_b64 s[82:83], s[54:55], s[80:81]
    s_cbranch_scc1 L2_c49
L2_d49:
    v_mov_b64 v[84:85], v[70:71]
    v_mov_b32 v7, v95
    v_mov_b64 v[86:87], v[74:75]
    s_or_b64 s[80:81], s[80:81], s[54:55]
    s_mov_b64 exec, s[50:51]
    s_and_b64 s[82:83], s[50:51], s[80:81]
    s_cbranch_scc1 L2_c50
L2_d50:
    v_mov_b64 v[84:85], v[68:69]
    v_mov_b32 v7, v94
    v_mov_b64 v[86:87], v[72:73]
    s_mov_b64 exec, -1
    s_or_b64 s[80:81], s[80:81], s[50:51]
    s_and_b64 exec, s[84:85], s[80:81]
    v_mfma_f32_4x4x4_16b_bf16 v[76:79], v[12:13], v[84:85], 0
    v_mov_b32 v92, v7
    s_andn2_b64 s[80:81], s[80:81], s[84:85]
    v_mfma_f32_4x4x4_16b_bf16 v[76:79], v[10:11], v[86:87], v[76:79]
    s_mov_b64 exec, -1
    ds_read_b64 v[70:71], v93 offset:65408
    ds_read_b64 v[68:69], v92 offset:65408
    v_bitop3_b32 v94, v18, v5, v99 bitop3:0xea
    v_bitop3_b32 v95, v19, v5, v46 bitop3:0xea
    v_perm_b32 v15, v19, v20, s47
    v_bitop3_b32 v46, v19, 0.5, -0.5 bitop3:0xa8
    v_perm_b32 v14, v18, v20, s46
    v_bitop3_b32 v47, v18, 0.5, -0.5 bitop3:0xa8
    v_bitop3_b32 v15, v6, v15, v46 bitop3:0xca
    v_bitop3_b32 v14, v6, v14, v47 bitop3:0xca
    s_waitcnt lgkmcnt(1)
    v_mfma_f32_4x4x4_16b_bf16 v[80:83], v[10:11], v[70:71], v[80:83]
    s_waitcnt lgkmcnt(0)
    v_mfma_f32_4x4x4_16b_bf16 v[76:79], v[10:11], v[68:69], v[76:79]
    s_nop 2
    v_cvt_pk_bf16_f32 v80, v80, v81
    v_cvt_pk_bf16_f32 v81, v82, v83
    ds_wrxchg_rtn_b64 v[74:75], v93, v[80:81] offset:65408
    v_cvt_pk_bf16_f32 v76, v76, v77
    v_cvt_pk_bf16_f32 v77, v78, v79
    ds_wrxchg_rtn_b64 v[72:73], v92, v[76:77] offset:65408
    v_and_b32 v88, 0x0fffffff, v40
    buffer_load_dwordx2 v[16:17], v88, s[8:11], 0 offen
    buffer_load_dwordx3 v[18:20], v88, s[8:11], 0 offen offset:8
    s_setprio 2
    v_mfma_f32_4x4x4_16b_bf16 v[80:83], v[8:9], v[106:107], 0
    v_mfma_f32_4x4x4_16b_bf16 v[76:79], v[8:9], v[104:105], 0
    v_cmp_lt_u32 s[48:49], v5, v95
    s_nop 2
    v_pk_mul_f32 v[80:81], v[80:81], v[14:15] op_sel:[0,1] op_sel_hi:[1,1]
    v_pk_mul_f32 v[82:83], v[82:83], v[14:15] op_sel:[0,1] op_sel_hi:[1,1]
    v_pk_mul_f32 v[76:77], v[76:77], v[14:15] op_sel:[0,0] op_sel_hi:[1,0]
    v_pk_mul_f32 v[78:79], v[78:79], v[14:15] op_sel:[0,0] op_sel_hi:[1,0]
    s_waitcnt vmcnt(10)
    v_and_b32 v46, 0x20000000, v27
    v_lshrrev_b32 v47, 14, v23
    v_bitop3_b32 v47, v47, v5, v46 bitop3:0xea
    ds_read_b64 v[102:103], v47
    v_and_b32 v99, 0x10000000, v27
    v_lshrrev_b32 v47, 14, v22
    v_bitop3_b32 v47, v47, v5, v99 bitop3:0xea
    ds_read_b64 v[100:101], v47
    s_waitcnt lgkmcnt(2)
    v_cmp_ne_u64 s[50:51], v[72:73], v[68:69]
    v_cmpx_ne_u64 s[54:55], v[74:75], v[70:71]
    s_and_b64 s[82:83], s[54:55], s[80:81]
    s_cbranch_scc1 L2_c51
L2_d51:
    v_mov_b64 v[84:85], v[70:71]
    v_mov_b32 v7, v93
    v_mov_b64 v[86:87], v[74:75]
    s_or_b64 s[80:81], s[80:81], s[54:55]
    s_mov_b64 exec, s[50:51]
    s_and_b64 s[82:83], s[50:51], s[80:81]
    s_cbranch_scc1 L2_c52
L2_d52:
    v_mov_b64 v[84:85], v[68:69]
    v_mov_b32 v7, v92
    v_mov_b64 v[86:87], v[72:73]
    s_mov_b64 exec, -1
    s_or_b64 s[80:81], s[80:81], s[50:51]
    s_and_b64 exec, s[48:49], s[80:81]
    v_mfma_f32_4x4x4_16b_bf16 v[80:83], v[12:13], v[84:85], 0
    v_mov_b32 v95, v7
    s_andn2_b64 s[80:81], s[80:81], s[48:49]
    v_mfma_f32_4x4x4_16b_bf16 v[80:83], v[10:11], v[86:87], v[80:83]
    s_mov_b64 exec, -1
    ds_read_b64 v[70:71], v95 offset:65408
    ds_read_b64 v[68:69], v94 offset:65408
    v_bitop3_b32 v92, v22, v5, v99 bitop3:0xea
    v_bitop3_b32 v93, v23, v5, v46 bitop3:0xea
    v_perm_b32 v15, v23, v26, s45
    v_bitop3_b32 v46, v23, 0.5, -0.5 bitop3:0xa8
    v_perm_b32 v14, v22, v26, s44
    v_bitop3_b32 v47, v22, 0.5, -0.5 bitop3:0xa8
    v_bitop3_b32 v15, v6, v15, v46 bitop3:0xca
    v_bitop3_b32 v14, v6, v14, v47 bitop3:0xca
    s_waitcnt lgkmcnt(1)
    v_mfma_f32_4x4x4_16b_bf16 v[80:83], v[10:11], v[70:71], v[80:83]
    s_waitcnt lgkmcnt(0)
    v_mfma_f32_4x4x4_16b_bf16 v[76:79], v[10:11], v[68:69], v[76:79]
    s_nop 2
    v_cvt_pk_bf16_f32 v80, v80, v81
    v_cvt_pk_bf16_f32 v81, v82, v83
    ds_wrxchg_rtn_b64 v[74:75], v95, v[80:81] offset:65408
    v_cvt_pk_bf16_f32 v76, v76, v77
    v_cvt_pk_bf16_f32 v77, v78, v79
    ds_wrxchg_rtn_b64 v[72:73], v94, v[76:77] offset:65408
    s_setprio 1
    v_mfma_f32_4x4x4_16b_bf16 v[80:83], v[8:9], v[102:103], 0
    v_mfma_f32_4x4x4_16b_bf16 v[76:79], v[8:9], v[100:101], 0
    s_nop 3
    v_pk_mul_f32 v[80:81], v[80:81], v[14:15] op_sel:[0,1] op_sel_hi:[1,1]
    v_pk_mul_f32 v[82:83], v[82:83], v[14:15] op_sel:[0,1] op_sel_hi:[1,1]
    v_pk_mul_f32 v[76:77], v[76:77], v[14:15] op_sel:[0,0] op_sel_hi:[1,0]
    v_pk_mul_f32 v[78:79], v[78:79], v[14:15] op_sel:[0,0] op_sel_hi:[1,0]
    s_bitcmp1_b32 s43, s42
    s_cbranch_scc1 L2_oa53
L2_ob53:
    buffer_load_dwordx4 v[112:115], v3, s[16:19], s40 offen offset:1024 sc1
    v_sub_u16 v88, v56, v48
    v_and_b32 v89, 3, v48
    v_add3_u32 v99, v88, v89, 3
    v_and_b32 v99, -4, v99
    v_max_u32 v99, 4, v99
    v_and_b32 v97, 0xfffc, v48
    v_bfm_b32 v96, v88, v89
    v_add_u32_dpp v91, v99, v99 row_shr:1 row_mask:0xf bank_mask:0xf bound_ctrl:1
    v_mad_u32_u24 v97, v97, 5, v2
    v_cmp_lt_u32 vcc, 16, v99
    v_add_u32_dpp v91, v91, v91 row_shr:2 row_mask:0xf bank_mask:0xf bound_ctrl:1
    v_sub_u32 v98, s38, v99
    v_lshrrev_b64 v[48:49], 16, v[48:49]
    v_add_u32_dpp v91, v91, v91 row_shr:4 row_mask:0xf bank_mask:0xf bound_ctrl:1
    v_lshrrev_b64 v[56:57], 16, v[56:57]
    s_mov_b32 s101, 0
    v_add_u32_dpp v91, v91, v91 row_shr:8 row_mask:0xf bank_mask:0xf bound_ctrl:1
    s_nop 1
    v_add_u32_dpp v91, v91, v91 row_bcast:15 row_mask:0xa bank_mask:0xf
    s_nop 1
    v_add_u32_dpp v91, v91, v91 row_bcast:31 row_mask:0xc bank_mask:0xf
    v_add_u32 v98, v98, v91
    v_readlane_b32 s37, v91, 63
    s_cbranch_vccnz L2_xo54
L2_xp54:
    v_and_b32 v46, 0x80000000, v27
    v_lshrrev_b32 v47, 14, v25
    v_bitop3_b32 v47, v47, v5, v46 bitop3:0xea
    ds_read_b64 v[106:107], v47
    v_and_b32 v99, 0x40000000, v27
    v_lshrrev_b32 v47, 14, v24
    v_bitop3_b32 v47, v47, v5, v99 bitop3:0xea
    ds_read_b64 v[104:105], v47
    s_waitcnt lgkmcnt(2)
    v_cmp_ne_u64 s[50:51], v[72:73], v[68:69]
    v_cmpx_ne_u64 s[54:55], v[74:75], v[70:71]
    s_and_b64 s[82:83], s[54:55], s[80:81]
    s_cbranch_scc1 L2_c55
L2_d55:
    v_mov_b64 v[84:85], v[70:71]
    v_mov_b32 v7, v95
    v_mov_b64 v[86:87], v[74:75]
    s_or_b64 s[80:81], s[80:81], s[54:55]
    s_mov_b64 exec, s[50:51]
    s_and_b64 s[82:83], s[50:51], s[80:81]
    s_cbranch_scc1 L2_c56
L2_d56:
    v_mov_b64 v[84:85], v[68:69]
    v_mov_b32 v7, v94
    v_mov_b64 v[86:87], v[72:73]
    s_mov_b64 exec, -1
    s_or_b64 s[80:81], s[80:81], s[50:51]
    ds_read_b64 v[70:71], v93 offset:65408
    ds_read_b64 v[68:69], v92 offset:65408
    v_bitop3_b32 v94, v24, v5, v99 bitop3:0xea
    v_bitop3_b32 v95, v25, v5, v46 bitop3:0xea
    v_perm_b32 v15, v25, v26, s47
    v_bitop3_b32 v46, v25, 0.5, -0.5 bitop3:0xa8
    v_perm_b32 v14, v24, v26, s46
    v_bitop3_b32 v47, v24, 0.5, -0.5 bitop3:0xa8
    v_bitop3_b32 v15, v6, v15, v46 bitop3:0xca
    v_bitop3_b32 v14, v6, v14, v47 bitop3:0xca
    s_waitcnt lgkmcnt(1)
    v_mfma_f32_4x4x4_16b_bf16 v[80:83], v[10:11], v[70:71], v[80:83]
    s_waitcnt lgkmcnt(0)
    v_mfma_f32_4x4x4_16b_bf16 v[76:79], v[10:11], v[68:69], v[76:79]
    s_nop 2
    v_cvt_pk_bf16_f32 v80, v80, v81
    v_cvt_pk_bf16_f32 v81, v82, v83
    ds_wrxchg_rtn_b64 v[74:75], v93, v[80:81] offset:65408
    v_cvt_pk_bf16_f32 v76, v76, v77
    v_cvt_pk_bf16_f32 v77, v78, v79
    ds_wrxchg_rtn_b64 v[72:73], v92, v[76:77] offset:65408
    v_and_b32 v88, 0x0fffffff, v41
    buffer_load_dwordx2 v[22:23], v88, s[8:11], 0 offen
    buffer_load_dwordx3 v[24:26], v88, s[8:11], 0 offen offset:8
    v_mfma_f32_4x4x4_16b_bf16 v[80:83], v[8:9], v[106:107], 0
    v_mfma_f32_4x4x4_16b_bf16 v[76:79], v[8:9], v[104:105], 0
    v_cmp_lt_u32 s[84:85], v5, v94
    s_nop 2
    v_pk_mul_f32 v[80:81], v[80:81], v[14:15] op_sel:[0,1] op_sel_hi:[1,1]
    v_pk_mul_f32 v[82:83], v[82:83], v[14:15] op_sel:[0,1] op_sel_hi:[1,1]
    v_pk_mul_f32 v[76:77], v[76:77], v[14:15] op_sel:[0,0] op_sel_hi:[1,0]
    v_pk_mul_f32 v[78:79], v[78:79], v[14:15] op_sel:[0,0] op_sel_hi:[1,0]
    s_waitcnt vmcnt(11)
    s_mov_b64 exec, s[6:7]
    v_lshrrev_b32 v30, 16, v30
    s_mov_b64 exec, -1
    v_and_b32 v46, 0x20000000, v31
    v_lshrrev_b32 v47, 14, v29
    v_bitop3_b32 v47, v47, v5, v46 bitop3:0xea
    ds_read_b64 v[102:103], v47
    v_and_b32 v99, 0x10000000, v31
    v_lshrrev_b32 v47, 14, v28
    v_bitop3_b32 v47, v47, v5, v99 bitop3:0xea
    ds_read_b64 v[100:101], v47
    s_waitcnt lgkmcnt(2)
    v_cmp_ne_u64 s[50:51], v[72:73], v[68:69]
    v_cmpx_ne_u64 s[54:55], v[74:75], v[70:71]
    s_and_b64 s[82:83], s[54:55], s[80:81]
    s_cbranch_scc1 L2_c57
L2_d57:
    v_mov_b64 v[84:85], v[70:71]
    v_mov_b32 v7, v93
    v_mov_b64 v[86:87], v[74:75]
    s_or_b64 s[80:81], s[80:81], s[54:55]
    s_mov_b64 exec, s[50:51]
    s_and_b64 s[82:83], s[50:51], s[80:81]
    s_cbranch_scc1 L2_c58
L2_d58:
    v_mov_b64 v[84:85], v[68:69]
    v_mov_b32 v7, v92
    v_mov_b64 v[86:87], v[72:73]
    s_mov_b64 exec, -1
    s_or_b64 s[80:81], s[80:81], s[50:51]
    s_and_b64 exec, s[84:85], s[80:81]
    v_mfma_f32_4x4x4_16b_bf16 v[76:79], v[12:13], v[84:85], 0
    v_mov_b32 v94, v7
    s_andn2_b64 s[80:81], s[80:81], s[84:85]
    v_mfma_f32_4x4x4_16b_bf16 v[76:79], v[10:11], v[86:87], v[76:79]
    s_mov_b64 exec, -1
    ds_read_b64 v[70:71], v95 offset:65408
    ds_read_b64 v[68:69], v94 offset:65408
    v_bitop3_b32 v92, v28, v5, v99 bitop3:0xea
    v_bitop3_b32 v93, v29, v5, v46 bitop3:0xea
    v_perm_b32 v15, v29, v30, s45
    v_bitop3_b32 v46, v29, 0.5, -0.5 bitop3:0xa8
    v_perm_b32 v14, v28, v30, s44
    v_bitop3_b32 v47, v28, 0.5, -0.5 bitop3:0xa8
    v_bitop3_b32 v15, v6, v15, v46 bitop3:0xca
    v_bitop3_b32 v14, v6, v14, v47 bitop3:0xca
    s_waitcnt lgkmcnt(1)
    v_mfma_f32_4x4x4_16b_bf16 v[80:83], v[10:11], v[70:71], v[80:83]
    s_waitcnt lgkmcnt(0)
    v_mfma_f32_4x4x4_16b_bf16 v[76:79], v[10:11], v[68:69], v[76:79]
    s_nop 2
    v_cvt_pk_bf16_f32 v80, v80, v81
    v_cvt_pk_bf16_f32 v81, v82, v83
    ds_wrxchg_rtn_b64 v[74:75], v95, v[80:81] offset:65408
    v_cvt_pk_bf16_f32 v76, v76, v77
    v_cvt_pk_bf16_f32 v77, v78, v79
    ds_wrxchg_rtn_b64 v[72:73], v94, v[76:77] offset:65408
    s_setprio 0
    v_mfma_f32_4x4x4_16b_bf16 v[80:83], v[8:9], v[102:103], 0
    v_mfma_f32_4x4x4_16b_bf16 v[76:79], v[8:9], v[100:101], 0
    v_cmp_lt_u32 s[48:49], v5, v93
    s_nop 2
    v_pk_mul_f32 v[80:81], v[80:81], v[14:15] op_sel:[0,1] op_sel_hi:[1,1]
    v_pk_mul_f32 v[82:83], v[82:83], v[14:15] op_sel:[0,1] op_sel_hi:[1,1]
    v_pk_mul_f32 v[76:77], v[76:77], v[14:15] op_sel:[0,0] op_sel_hi:[1,0]
    v_pk_mul_f32 v[78:79], v[78:79], v[14:15] op_sel:[0,0] op_sel_hi:[1,0]
    s_add_u32 s40, s40, 0xfff24000
    v_and_b32 v47, 0x0fffffff, v42
    buffer_load_dword v30, v47, s[8:11], 0 offen offset:16
    s_mov_b64 exec, s[6:7]
    v_add_u32 v47, 8, v47
    v_lshrrev_b32 v42, 2, v42
    s_mov_b64 exec, -1
    buffer_load_dwordx2 v[28:29], v47, s[8:11], 0 offen
    s_waitcnt vmcnt(8)
    v_and_b32 v46, 0x80000000, v39
    v_lshrrev_b32 v47, 14, v37
    v_bitop3_b32 v47, v47, v5, v46 bitop3:0xea
    ds_read_b64 v[102:103], v47
    v_and_b32 v99, 0x40000000, v39
    v_lshrrev_b32 v47, 14, v36
    v_bitop3_b32 v47, v47, v5, v99 bitop3:0xea
    ds_read_b64 v[100:101], v47
    v_and_b32 v46, 0x20000000, v39
    v_lshrrev_b32 v47, 14, v35
    v_bitop3_b32 v47, v47, v5, v46 bitop3:0xea
    ds_read_b64 v[106:107], v47
    v_and_b32 v99, 0x10000000, v39
    v_lshrrev_b32 v47, 14, v34
    v_bitop3_b32 v47, v47, v5, v99 bitop3:0xea
    ds_read_b64 v[104:105], v47
    s_waitcnt lgkmcnt(4)
    v_cmp_ne_u64 s[50:51], v[72:73], v[68:69]
    v_cmpx_ne_u64 s[54:55], v[74:75], v[70:71]
    s_and_b64 s[82:83], s[54:55], s[80:81]
    s_cbranch_scc1 L2_c59
L2_d59:
    v_mov_b64 v[84:85], v[70:71]
    v_mov_b32 v7, v95
    v_mov_b64 v[86:87], v[74:75]
    s_or_b64 s[80:81], s[80:81], s[54:55]
    s_mov_b64 exec, s[50:51]
    s_and_b64 s[82:83], s[50:51], s[80:81]
    s_cbranch_scc1 L2_c60
L2_d60:
    v_mov_b64 v[84:85], v[68:69]
    v_mov_b32 v7, v94
    v_mov_b64 v[86:87], v[72:73]
    s_mov_b64 exec, -1
    s_or_b64 s[80:81], s[80:81], s[50:51]
    s_and_b64 exec, s[48:49], s[80:81]
    v_mfma_f32_4x4x4_16b_bf16 v[80:83], v[12:13], v[84:85], 0
    v_mov_b32 v93, v7
    s_andn2_b64 s[80:81], s[80:81], s[48:49]
    v_mfma_f32_4x4x4_16b_bf16 v[80:83], v[10:11], v[86:87], v[80:83]
    s_mov_b64 exec, -1
    ds_read_b64 v[70:71], v93 offset:65408
    ds_read_b64 v[68:69], v92 offset:65408
    v_bitop3_b32 v94, v34, v5, v99 bitop3:0xea
    v_bitop3_b32 v95, v35, v5, v46 bitop3:0xea
    v_perm_b32 v15, v35, v38, s45
    v_bitop3_b32 v46, v35, 0.5, -0.5 bitop3:0xa8
    v_perm_b32 v14, v34, v38, s44
    v_bitop3_b32 v47, v34, 0.5, -0.5 bitop3:0xa8
    v_bitop3_b32 v15, v6, v15, v46 bitop3:0xca
    v_bitop3_b32 v14, v6, v14, v47 bitop3:0xca
    s_waitcnt lgkmcnt(1)
    v_mfma_f32_4x4x4_16b_bf16 v[80:83], v[10:11], v[70:71], v[80:83]
    s_waitcnt lgkmcnt(0)
    v_mfma_f32_4x4x4_16b_bf16 v[76:79], v[10:11], v[68:69], v[76:79]
    s_nop 2
    v_cvt_pk_bf16_f32 v80, v80, v81
    v_cvt_pk_bf16_f32 v81, v82, v83
    ds_wrxchg_rtn_b64 v[74:75], v93, v[80:81] offset:65408
    v_cvt_pk_bf16_f32 v76, v76, v77
    v_cvt_pk_bf16_f32 v77, v78, v79
    ds_wrxchg_rtn_b64 v[72:73], v92, v[76:77] offset:65408
    s_barrier
    s_setprio 3
    s_mov_b32 m0, s100
    s_nop 0
    ds_write_addtid_b32 v124 offset:34816
    ds_write_addtid_b32 v125 offset:35072
    ds_write_addtid_b32 v126 offset:35328
    ds_write_addtid_b32 v127 offset:35584
    s_add_u32 s3, s40, 4096
    buffer_load_dwordx4 v[124:127], v3, s[16:19], s3 offen sc1
    ds_write_addtid_b32 v116 offset:32768
    ds_write_addtid_b32 v117 offset:33024
    ds_write_addtid_b32 v118 offset:33280
    ds_write_addtid_b32 v119 offset:33536
    buffer_load_dwordx4 v[116:119], v3, s[16:19], s40 offen offset:2048 sc1
    ds_write_addtid_b32 v120 offset:33792
    ds_write_addtid_b32 v121 offset:34048
    ds_write_addtid_b32 v122 offset:34304
    ds_write_addtid_b32 v123 offset:34560
    buffer_load_dwordx4 v[120:123], v3, s[16:19], s40 offen offset:3072 sc1
    v_mfma_f32_4x4x4_16b_bf16 v[80:83], v[8:9], v[106:107], 0
    v_mfma_f32_4x4x4_16b_bf16 v[76:79], v[8:9], v[104:105], 0
    s_nop 3
    v_pk_mul_f32 v[80:81], v[80:81], v[14:15] op_sel:[0,1] op_sel_hi:[1,1]
    v_pk_mul_f32 v[82:83], v[82:83], v[14:15] op_sel:[0,1] op_sel_hi:[1,1]
    v_pk_mul_f32 v[76:77], v[76:77], v[14:15] op_sel:[0,0] op_sel_hi:[1,0]
    v_pk_mul_f32 v[78:79], v[78:79], v[14:15] op_sel:[0,0] op_sel_hi:[1,0]
    s_cmp_gt_u32 s37, 1024
    s_cbranch_scc1 L2_xs61
    s_cmp_lg_u32 s101, 0
    s_cbranch_scc1 L2_xa61
L2_xb61:
    v_lshlrev_b32 v89, 16, v96
    v_add_u32 v90, 60, v97
    v_bitop3_b32 v90, v89, v45, v90 bitop3:0x6a
    ds_write_b32 v98, v90 offset:12
    v_lshlrev_b32 v89, 20, v96
    v_add_u32 v90, 40, v97
    v_bitop3_b32 v90, v89, v45, v90 bitop3:0x6a
    ds_write_b32 v98, v90 offset:8
    v_lshlrev_b32 v89, 24, v96
    v_add_u32 v90, 20, v97
    v_bitop3_b32 v90, v89, v45, v90 bitop3:0x6a
    ds_write_b32 v98, v90 offset:4
    v_lshlrev_b32 v89, 28, v96
    v_bitop3_b32 v90, v89, v45, v97 bitop3:0x6a
    ds_write_b32 v98, v90 offset:0
    v_mov_b32_dpp v91, v64 quad_perm:[0,0,0,0] row_mask:0xf bank_mask:0xf
    v_and_b32 v89, 3, v91
    v_and_b32 v97, 0xfffc, v91
    v_sub_u16_dpp v88, v64, v91 quad_perm:[2,2,2,2] row_mask:0xf bank_mask:0xf
    v_mad_u32_u24 v97, v97, 5, v4
    v_add_u32 v99, v88, v89
    v_bfm_b32 v96, v88, v89
    v_cmp_lt_u32 s[58:59], 16, v99
    v_lshlrev_b32 v89, v1, v96
    v_and_b32 v89, v45, v89
    v_cmp_ne_u32 vcc, 0, v89
    v_xor_b32 v90, v97, v89
    s_add_u32 s3, s37, s38
    v_mbcnt_lo_u32_b32 v98, vcc_lo, 0
    v_mbcnt_hi_u32_b32 v98, vcc_hi, v98
    s_bcnt1_i32_b64 s41, vcc
    v_lshl_add_u32 v98, v98, 2, s3
    s_lshl2_add_u32 s37, s41, s37
    s_mov_b64 exec, vcc
    ds_write_b32 v98, v90
    s_mov_b64 exec, -1
    s_cmp_lg_u64 s[58:59], 0
    s_cbranch_scc1 L2_xe61
L2_xr61:
    v_add_u32 v98, s37, v0
    v_mov_b32 v90, -1
    ds_write_b32 v98, v90
L2_xw61:
    s_setprio 2
    s_waitcnt lgkmcnt(14)
    v_cmp_ne_u64 s[50:51], v[72:73], v[68:69]
    v_cmpx_ne_u64 s[54:55], v[74:75], v[70:71]
    s_and_b64 s[82:83], s[54:55], s[80:81]
    s_cbranch_scc1 L2_c62
L2_d62:
    v_mov_b64 v[84:85], v[70:71]
    v_mov_b32 v7, v93
    v_mov_b64 v[86:87], v[74:75]
    s_or_b64 s[80:81], s[80:81], s[54:55]
    s_mov_b64 exec, s[50:51]
    s_and_b64 s[82:83], s[50:51], s[80:81]
    s_cbranch_scc1 L2_c63
L2_d63:
    v_mov_b64 v[84:85], v[68:69]
    v_mov_b32 v7, v92
    v_mov_b64 v[86:87], v[72:73]
    s_mov_b64 exec, -1
    s_or_b64 s[80:81], s[80:81], s[50:51]
    ds_read_b64 v[70:71], v95 offset:65408
    ds_read_b64 v[68:69], v94 offset:65408
    v_and_b32 v46, 0x40000000, v39
    v_bitop3_b32 v92, v36, v5, v46 bitop3:0xea
    v_and_b32 v46, 0x80000000, v39
    v_bitop3_b32 v93, v37, v5, v46 bitop3:0xea
    v_perm_b32 v15, v37, v38, s47
    v_bitop3_b32 v46, v37, 0.5, -0.5 bitop3:0xa8
    v_perm_b32 v14, v36, v38, s46
    v_bitop3_b32 v47, v36, 0.5, -0.5 bitop3:0xa8
    v_bitop3_b32 v15, v6, v15, v46 bitop3:0xca
    v_bitop3_b32 v14, v6, v14, v47 bitop3:0xca
    s_setprio 1
    s_waitcnt lgkmcnt(1)
    v_mfma_f32_4x4x4_16b_bf16 v[80:83], v[10:11], v[70:71], v[80:83]
    s_waitcnt lgkmcnt(0)
    v_mfma_f32_4x4x4_16b_bf16 v[76:79], v[10:11], v[68:69], v[76:79]
    s_nop 2
    v_cvt_pk_bf16_f32 v80, v80, v81
    v_cvt_pk_bf16_f32 v81, v82, v83
    ds_wrxchg_rtn_b64 v[74:75], v95, v[80:81] offset:65408
    v_cvt_pk_bf16_f32 v76, v76, v77
    v_cvt_pk_bf16_f32 v77, v78, v79
    ds_wrxchg_rtn_b64 v[72:73], v94, v[76:77] offset:65408
    ds_read_b32 v21, v0 offset:0
    ds_read_b32 v27, v0 offset:256
    ds_read_b32 v31, v44 offset:768
    ds_read_b32 v39, v0 offset:512
    s_sub_u32 s3, s37, 768
    s_cmp_gt_u32 s3, 128
    s_cbranch_scc1 L2_xf61
L2_xg61:
    v_and_b32 v88, 0x0fffffff, v43
    buffer_load_dwordx2 v[34:35], v88, s[8:11], 0 offen
    buffer_load_dwordx3 v[36:38], v88, s[8:11], 0 offen offset:8
    s_setprio 0
    s_waitcnt vmcnt(12)
    s_mov_b32 m0, s38
    s_nop 0
    ds_write_addtid_b32 v108 offset:0
    ds_write_addtid_b32 v109 offset:256
    ds_write_addtid_b32 v110 offset:512
    ds_write_addtid_b32 v111 offset:768
    s_waitcnt vmcnt(9)
    ds_write_addtid_b32 v112 offset:1024
    ds_write_addtid_b32 v113 offset:1280
    ds_write_addtid_b32 v114 offset:1536
    ds_write_addtid_b32 v115 offset:1792
    v_mfma_f32_4x4x4_16b_bf16 v[80:83], v[8:9], v[102:103], 0
    v_mfma_f32_4x4x4_16b_bf16 v[76:79], v[8:9], v[100:101], 0
    v_cmp_lt_u32 s[84:85], v5, v92
    s_nop 2
    v_pk_mul_f32 v[80:81], v[80:81], v[14:15] op_sel:[0,1] op_sel_hi:[1,1]
    v_pk_mul_f32 v[82:83], v[82:83], v[14:15] op_sel:[0,1] op_sel_hi:[1,1]
    v_pk_mul_f32 v[76:77], v[76:77], v[14:15] op_sel:[0,0] op_sel_hi:[1,0]
    v_pk_mul_f32 v[78:79], v[78:79], v[14:15] op_sel:[0,0] op_sel_hi:[1,0]
    s_add_u32 s42, s42, 1
    s_waitcnt lgkmcnt(0)
    s_barrier
    s_bitcmp1_b32 s36, s42
    s_cbranch_scc1 L2_slow
L2_ret3:
    s_setprio 3
    s_bitcmp1_b32 s43, s42
    s_cbranch_scc1 L2_oa64
L2_ob64:
    v_and_b32 v46, 0x20000000, v40
    v_lshrrev_b32 v47, 14, v17
    v_bitop3_b32 v47, v47, v5, v46 bitop3:0xea
    ds_read_b64 v[106:107], v47
    v_and_b32 v99, 0x10000000, v40
    v_lshrrev_b32 v47, 14, v16
    v_bitop3_b32 v47, v47, v5, v99 bitop3:0xea
    ds_read_b64 v[104:105], v47
    v_cmp_ne_u64 s[50:51], v[72:73], v[68:69]
    v_cmpx_ne_u64 s[54:55], v[74:75], v[70:71]
    s_and_b64 s[82:83], s[54:55], s[80:81]
    s_cbranch_scc1 L2_c65
L2_d65:
    v_mov_b64 v[84:85], v[70:71]
    v_mov_b32 v7, v95
    v_mov_b64 v[86:87], v[74:75]
    s_or_b64 s[80:81], s[80:81], s[54:55]
    s_mov_b64 exec, s[50:51]
    s_and_b64 s[82:83], s[50:51], s[80:81]
    s_cbranch_scc1 L2_c66
L2_d66:
    v_mov_b64 v[84:85], v[68:69]
    v_mov_b32 v7, v94
    v_mov_b64 v[86:87], v[72:73]
    s_mov_b64 exec, -1
    s_or_b64 s[80:81], s[80:81], s[50:51]
    s_and_b64 exec, s[84:85], s[80:81]
    v_mfma_f32_4x4x4_16b_bf16 v[76:79], v[12:13], v[84:85], 0
    v_mov_b32 v92, v7
    s_andn2_b64 s[80:81], s[80:81], s[84:85]
    v_mfma_f32_4x4x4_16b_bf16 v[76:79], v[10:11], v[86:87], v[76:79]
    s_mov_b64 exec, -1
    ds_read_b64 v[70:71], v93 offset:65408
    ds_read_b64 v[68:69], v92 offset:65408
    v_bitop3_b32 v94, v16, v5, v99 bitop3:0xea
    v_bitop3_b32 v95, v17, v5, v46 bitop3:0xea
    v_perm_b32 v15, v17, v20, s45
    v_bitop3_b32 v46, v17, 0.5, -0.5 bitop3:0xa8
    v_perm_b32 v14, v16, v20, s44
    v_bitop3_b32 v47, v16, 0.5, -0.5 bitop3:0xa8
    v_bitop3_b32 v15, v6, v15, v46 bitop3:0xca
    v_bitop3_b32 v14, v6, v14, v47 bitop3:0xca
    s_waitcnt lgkmcnt(1)
    v_mfma_f32_4x4x4_16b_bf16 v[80:83], v[10:11], v[70:71], v[80:83]
    s_waitcnt lgkmcnt(0)
    v_mfma_f32_4x4x4_16b_bf16 v[76:79], v[10:11], v[68:69], v[76:79]
    s_nop 2
    v_cvt_pk_bf16_f32 v80, v80, v81
    v_cvt_pk_bf16_f32 v81, v82, v83
    ds_wrxchg_rtn_b64 v[74:75], v93, v[80:81] offset:65408
    v_cvt_pk_bf16_f32 v76, v76, v77
    v_cvt_pk_bf16_f32 v77, v78, v79
    ds_wrxchg_rtn_b64 v[72:73], v92, v[76:77] offset:65408
    v_mfma_f32_4x4x4_16b_bf16 v[80:83], v[8:9], v[106:107], 0
    v_mfma_f32_4x4x4_16b_bf16 v[76:79], v[8:9], v[104:105], 0
    v_cmp_lt_u32 s[84:85], v5, v94
    s_nop 2
    v_pk_mul_f32 v[80:81], v[80:81], v[14:15] op_sel:[0,1] op_sel_hi:[1,1]
    v_pk_mul_f32 v[82:83], v[82:83], v[14:15] op_sel:[0,1] op_sel_hi:[1,1]
    v_pk_mul_f32 v[76:77], v[76:77], v[14:15] op_sel:[0,0] op_sel_hi:[1,0]
    v_pk_mul_f32 v[78:79], v[78:79], v[14:15] op_sel:[0,0] op_sel_hi:[1,0]
    buffer_load_dwordx4 v[108:111], v3, s[16:19], s40 offen offset:0 sc1
    v_and_b32 v46, 0x80000000, v40
    v_lshrrev_b32 v47, 14, v19
    v_bitop3_b32 v47, v47, v5, v46 bitop3:0xea
    ds_read_b64 v[102:103], v47
    v_and_b32 v99, 0x40000000, v40
    v_lshrrev_b32 v47, 14, v18
    v_bitop3_b32 v47, v47, v5, v99 bitop3:0xea
    ds_read_b64 v[100:101], v47
    s_waitcnt lgkmcnt(2)
    v_cmp_ne_u64 s[50:51], v[72:73], v[68:69]
    v_cmpx_ne_u64 s[54:55], v[74:75], v[70:71]
    s_and_b64 s[82:83], s[54:55], s[80:81]
    s_cbranch_scc1 L2_c67
L2_d67:
    v_mov_b64 v[84:85], v[70:71]
    v_mov_b32 v7, v93
    v_mov_b64 v[86:87], v[74:75]
    s_or_b64 s[80:81], s[80:81], s[54:55]
    s_mov_b64 exec, s[50:51]
    s_and_b64 s[82:83], s[50:51], s[80:81]
    s_cbranch_scc1 L2_c68
L2_d68:
    v_mov_b64 v[84:85], v[68:69]
    v_mov_b32 v7, v92
    v_mov_b64 v[86:87], v[72:73]
    s_mov_b64 exec, -1
    s_or_b64 s[80:81], s[80:81], s[50:51]
    s_and_b64 exec, s[84:85], s[80:81]
    v_mfma_f32_4x4x4_16b_bf16 v[76:79], v[12:13], v[84:85], 0
    v_mov_b32 v94, v7
    s_andn2_b64 s[80:81], s[80:81], s[84:85]
    v_mfma_f32_4x4x4_16b_bf16 v[76:79], v[10:11], v[86:87], v[76:79]
    s_mov_b64 exec, -1
    ds_read_b64 v[70:71], v95 offset:65408
    ds_read_b64 v[68:69], v94 offset:65408
    v_bitop3_b32 v92, v18, v5, v99 bitop3:0xea
    v_bitop3_b32 v93, v19, v5, v46 bitop3:0xea
    v_perm_b32 v15, v19, v20, s47
    v_bitop3_b32 v46, v19, 0.5, -0.5 bitop3:0xa8
    v_perm_b32 v14, v18, v20, s46
    v_bitop3_b32 v47, v18, 0.5, -0.5 bitop3:0xa8
    v_bitop3_b32 v15, v6, v15, v46 bitop3:0xca
    v_bitop3_b32 v14, v6, v14, v47 bitop3:0xca
    s_waitcnt lgkmcnt(1)
    v_mfma_f32_4x4x4_16b_bf16 v[80:83], v[10:11], v[70:71], v[80:83]
    s_waitcnt lgkmcnt(0)
    v_mfma_f32_4x4x4_16b_bf16 v[76:79], v[10:11], v[68:69], v[76:79]
    s_nop 2
    v_cvt_pk_bf16_f32 v80, v80, v81
    v_cvt_pk_bf16_f32 v81, v82, v83
    ds_wrxchg_rtn_b64 v[74:75], v95, v[80:81] offset:65408
    v_cvt_pk_bf16_f32 v76, v76, v77
    v_cvt_pk_bf16_f32 v77, v78, v79
    ds_wrxchg_rtn_b64 v[72:73], v94, v[76:77] offset:65408
    v_and_b32 v88, 0x0fffffff, v21
    buffer_load_dwordx2 v[16:17], v88, s[8:11], 0 offen
    buffer_load_dwordx3 v[18:20], v88, s[8:11], 0 offen offset:8
    s_setprio 2
    v_mfma_f32_4x4x4_16b_bf16 v[80:83], v[8:9], v[102:103], 0
    v_mfma_f32_4x4x4_16b_bf16 v[76:79], v[8:9], v[100:101], 0
    v_cmp_lt_u32 s[48:49], v5, v93
    s_nop 2
    v_pk_mul_f32 v[80:81], v[80:81], v[14:15] op_sel:[0,1] op_sel_hi:[1,1]
    v_pk_mul_f32 v[82:83], v[82:83], v[14:15] op_sel:[0,1] op_sel_hi:[1,1]
    v_pk_mul_f32 v[76:77], v[76:77], v[14:15] op_sel:[0,0] op_sel_hi:[1,0]
    v_pk_mul_f32 v[78:79], v[78:79], v[14:15] op_sel:[0,0] op_sel_hi:[1,0]
    s_waitcnt vmcnt(10)
    v_and_b32 v46, 0x20000000, v41
    v_lshrrev_b32 v47, 14, v23
    v_bitop3_b32 v47, v47, v5, v46 bitop3:0xea
    ds_read_b64 v[106:107], v47
    v_and_b32 v99, 0x10000000, v41
    v_lshrrev_b32 v47, 14, v22
    v_bitop3_b32 v47, v47, v5, v99 bitop3:0xea
    ds_read_b64 v[104:105], v47
    s_waitcnt lgkmcnt(2)
    v_cmp_ne_u64 s[50:51], v[72:73], v[68:69]
    v_cmpx_ne_u64 s[54:55], v[74:75], v[70:71]
    s_and_b64 s[82:83], s[54:55], s[80:81]
    s_cbranch_scc1 L2_c69
L2_d69:
    v_mov_b64 v[84:85], v[70:71]
    v_mov_b32 v7, v95
    v_mov_b64 v[86:87], v[74:75]
    s_or_b64 s[80:81], s[80:81], s[54:55]
    s_mov_b64 exec, s[50:51]
    s_and_b64 s[82:83], s[50:51], s[80:81]
    s_cbranch_scc1 L2_c70
L2_d70:
    v_mov_b64 v[84:85], v[68:69]
    v_mov_b32 v7, v94
    v_mov_b64 v[86:87], v[72:73]
    s_mov_b64 exec, -1
    s_or_b64 s[80:81], s[80:81], s[50:51]
    s_and_b64 exec, s[48:49], s[80:81]
    v_mfma_f32_4x4x4_16b_bf16 v[80:83], v[12:13], v[84:85], 0
    v_mov_b32 v93, v7
    s_andn2_b64 s[80:81], s[80:81], s[48:49]
    v_mfma_f32_4x4x4_16b_bf16 v[80:83], v[10:11], v[86:87], v[80:83]
    s_mov_b64 exec, -1
    ds_read_b64 v[70:71], v93 offset:65408
    ds_read_b64 v[68:69], v92 offset:65408
    v_bitop3_b32 v94, v22, v5, v99 bitop3:0xea
    v_bitop3_b32 v95, v23, v5, v46 bitop3:0xea
    v_perm_b32 v15, v23, v26, s45
    v_bitop3_b32 v46, v23, 0.5, -0.5 bitop3:0xa8
    v_perm_b32 v14, v22, v26, s44
    v_bitop3_b32 v47, v22, 0.5, -0.5 bitop3:0xa8
    v_bitop3_b32 v15, v6, v15, v46 bitop3:0xca
    v_bitop3_b32 v14, v6, v14, v47 bitop3:0xca
    s_waitcnt lgkmcnt(1)
    v_mfma_f32_4x4x4_16b_bf16 v[80:83], v[10:11], v[70:71], v[80:83]
    s_waitcnt lgkmcnt(0)
    v_mfma_f32_4x4x4_16b_bf16 v[76:79], v[10:11], v[68:69], v[76:79]
    s_nop 2
    v_cvt_pk_bf16_f32 v80, v80, v81
    v_cvt_pk_bf16_f32 v81, v82, v83
    ds_wrxchg_rtn_b64 v[74:75], v93, v[80:81] offset:65408
    v_cvt_pk_bf16_f32 v76, v76, v77
    v_cvt_pk_bf16_f32 v77, v78, v79
    ds_wrxchg_rtn_b64 v[72:73], v92, v[76:77] offset:65408
    s_setprio 1
    v_mfma_f32_4x4x4_16b_bf16 v[80:83], v[8:9], v[106:107], 0
    v_mfma_f32_4x4x4_16b_bf16 v[76:79], v[8:9], v[104:105], 0
    s_nop 3
    v_pk_mul_f32 v[80:81], v[80:81], v[14:15] op_sel:[0,1] op_sel_hi:[1,1]
    v_pk_mul_f32 v[82:83], v[82:83], v[14:15] op_sel:[0,1] op_sel_hi:[1,1]
    v_pk_mul_f32 v[76:77], v[76:77], v[14:15] op_sel:[0,0] op_sel_hi:[1,0]
    v_pk_mul_f32 v[78:79], v[78:79], v[14:15] op_sel:[0,0] op_sel_hi:[1,0]
    s_bitcmp1_b32 s43, s42
    s_cbranch_scc1 L2_oa71
L2_ob71:
    buffer_load_dwordx4 v[112:115], v3, s[16:19], s40 offen offset:1024 sc1
    v_sub_u16 v88, v58, v50
    v_and_b32 v89, 3, v50
    v_add3_u32 v99, v88, v89, 3
    v_and_b32 v99, -4, v99
    v_max_u32 v99, 4, v99
    v_and_b32 v97, 0xfffc, v50
    v_bfm_b32 v96, v88, v89
    v_add_u32_dpp v91, v99, v99 row_shr:1 row_mask:0xf bank_mask:0xf bound_ctrl:1
    v_mad_u32_u24 v97, v97, 5, v2
    v_cmp_lt_u32 vcc, 16, v99
    v_add_u32_dpp v91, v91, v91 row_shr:2 row_mask:0xf bank_mask:0xf bound_ctrl:1
    v_sub_u32 v98, s38, v99
    v_lshrrev_b64 v[50:51], 16, v[50:51]
    v_add_u32_dpp v91, v91, v91 row_shr:4 row_mask:0xf bank_mask:0xf bound_ctrl:1
    v_lshrrev_b64 v[58:59], 16, v[58:59]
    s_mov_b32 s101, 0
    v_add_u32_dpp v91, v91, v91 row_shr:8 row_mask:0xf bank_mask:0xf bound_ctrl:1
    s_nop 1
    v_add_u32_dpp v91, v91, v91 row_bcast:15 row_mask:0xa bank_mask:0xf
    s_nop 1
    v_add_u32_dpp v91, v91, v91 row_bcast:31 row_mask:0xc bank_mask:0xf
    v_add_u32 v98, v98, v91
    v_readlane_b32 s37, v91, 63
    s_cbranch_vccnz L2_xo72
L2_xp72:
    v_and_b32 v46, 0x80000000, v41
    v_lshrrev_b32 v47, 14, v25
    v_bitop3_b32 v47, v47, v5, v46 bitop3:0xea
    ds_read_b64 v[102:103], v47
    v_and_b32 v99, 0x40000000, v41
    v_lshrrev_b32 v47, 14, v24
    v_bitop3_b32 v47, v47, v5, v99 bitop3:0xea
    ds_read_b64 v[100:101], v47
    s_waitcnt lgkmcnt(2)
    v_cmp_ne_u64 s[50:51], v[72:73], v[68:69]
    v_cmpx_ne_u64 s[54:55], v[74:75], v[70:71]
    s_and_b64 s[82:83], s[54:55], s[80:81]
    s_cbranch_scc1 L2_c73
L2_d73:
    v_mov_b64 v[84:85], v[70:71]
    v_mov_b32 v7, v93
    v_mov_b64 v[86:87], v[74:75]
    s_or_b64 s[80:81], s[80:81], s[54:55]
    s_mov_b64 exec, s[50:51]
    s_and_b64 s[82:83], s[50:51], s[80:81]
    s_cbranch_scc1 L2_c74
L2_d74:
    v_mov_b64 v[84:85], v[68:69]
    v_mov_b32 v7, v92
    v_mov_b64 v[86:87], v[72:73]
    s_mov_b64 exec, -1
    s_or_b64 s[80:81], s[80:81], s[50:51]
    ds_read_b64 v[70:71], v95 offset:65408
    ds_read_b64 v[68:69], v94 offset:65408
    v_bitop3_b32 v92, v24, v5, v99 bitop3:0xea
    v_bitop3_b32 v93, v25, v5, v46 bitop3:0xea
    v_perm_b32 v15, v25, v26, s47
    v_bitop3_b32 v46, v25, 0.5, -0.5 bitop3:0xa8
    v_perm_b32 v14, v24, v26, s46
    v_bitop3_b32 v47, v24, 0.5, -0.5 bitop3:0xa8
    v_bitop3_b32 v15, v6, v15, v46 bitop3:0xca
    v_bitop3_b32 v14, v6, v14, v47 bitop3:0xca
    s_waitcnt lgkmcnt(1)
    v_mfma_f32_4x4x4_16b_bf16 v[80:83], v[10:11], v[70:71], v[80:83]
    s_waitcnt lgkmcnt(0)
    v_mfma_f32_4x4x4_16b_bf16 v[76:79], v[10:11], v[68:69], v[76:79]
    s_nop 2
    v_cvt_pk_bf16_f32 v80, v80, v81
    v_cvt_pk_bf16_f32 v81, v82, v83
    ds_wrxchg_rtn_b64 v[74:75], v95, v[80:81] offset:65408
    v_cvt_pk_bf16_f32 v76, v76, v77
    v_cvt_pk_bf16_f32 v77, v78, v79
    ds_wrxchg_rtn_b64 v[72:73], v94, v[76:77] offset:65408
    v_and_b32 v88, 0x0fffffff, v27
    buffer_load_dwordx2 v[22:23], v88, s[8:11], 0 offen
    buffer_load_dwordx3 v[24:26], v88, s[8:11], 0 offen offset:8
    v_mfma_f32_4x4x4_16b_bf16 v[80:83], v[8:9], v[102:103], 0
    v_mfma_f32_4x4x4_16b_bf16 v[76:79], v[8:9], v[100:101], 0
    v_cmp_lt_u32 s[84:85], v5, v92
    s_nop 2
    v_pk_mul_f32 v[80:81], v[80:81], v[14:15] op_sel:[0,1] op_sel_hi:[1,1]
    v_pk_mul_f32 v[82:83], v[82:83], v[14:15] op_sel:[0,1] op_sel_hi:[1,1]
    v_pk_mul_f32 v[76:77], v[76:77], v[14:15] op_sel:[0,0] op_sel_hi:[1,0]
    v_pk_mul_f32 v[78:79], v[78:79], v[14:15] op_sel:[0,0] op_sel_hi:[1,0]
    s_waitcnt vmcnt(11)
    s_mov_b64 exec, s[6:7]
    v_lshrrev_b32 v30, 16, v30
    s_mov_b64 exec, -1
    v_and_b32 v46, 0x20000000, v42
    v_lshrrev_b32 v47, 14, v29
    v_bitop3_b32 v47, v47, v5, v46 bitop3:0xea
    ds_read_b64 v[106:107], v47
    v_and_b32 v99, 0x10000000, v42
    v_lshrrev_b32 v47, 14, v28
    v_bitop3_b32 v47, v47, v5, v99 bitop3:0xea
    ds_read_b64 v[104:105], v47
    s_waitcnt lgkmcnt(2)
    v_cmp_ne_u64 s[50:51], v[72:73], v[68:69]
    v_cmpx_ne_u64 s[54:55], v[74:75], v[70:71]
    s_and_b64 s[82:83], s[54:55], s[80:81]
    s_cbranch_scc1 L2_c75
L2_d75:
    v_mov_b64 v[84:85], v[70:71]
    v_mov_b32 v7, v95
    v_mov_b64 v[86:87], v[74:75]
    s_or_b64 s[80:81], s[80:81], s[54:55]
    s_mov_b64 exec, s[50:51]
    s_and_b64 s[82:83], s[50:51], s[80:81]
    s_cbranch_scc1 L2_c76
L2_d76:
    v_mov_b64 v[84:85], v[68:69]
    v_mov_b32 v7, v94
    v_mov_b64 v[86:87], v[72:73]
    s_mov_b64 exec, -1
    s_or_b64 s[80:81], s[80:81], s[50:51]
    s_and_b64 exec, s[84:85], s[80:81]
    v_mfma_f32_4x4x4_16b_bf16 v[76:79], v[12:13], v[84:85], 0
    v_mov_b32 v92, v7
    s_andn2_b64 s[80:81], s[80:81], s[84:85]
    v_mfma_f32_4x4x4_16b_bf16 v[76:79], v[10:11], v[86:87], v[76:79]
    s_mov_b64 exec, -1
    ds_read_b64 v[70:71], v93 offset:65408
    ds_read_b64 v[68:69], v92 offset:65408
    v_bitop3_b32 v94, v28, v5, v99 bitop3:0xea
    v_bitop3_b32 v95, v29, v5, v46 bitop3:0xea
    v_perm_b32 v15, v29, v30, s45
    v_bitop3_b32 v46, v29, 0.5, -0.5 bitop3:0xa8
    v_perm_b32 v14, v28, v30, s44
    v_bitop3_b32 v47, v28, 0.5, -0.5 bitop3:0xa8
    v_bitop3_b32 v15, v6, v15, v46 bitop3:0xca
    v_bitop3_b32 v14, v6, v14, v47 bitop3:0xca
    s_waitcnt lgkmcnt(1)
    v_mfma_f32_4x4x4_16b_bf16 v[80:83], v[10:11], v[70:71], v[80:83]
    s_waitcnt lgkmcnt(0)
    v_mfma_f32_4x4x4_16b_bf16 v[76:79], v[10:11], v[68:69], v[76:79]
    s_nop 2
    v_cvt_pk_bf16_f32 v80, v80, v81
    v_cvt_pk_bf16_f32 v81, v82, v83
    ds_wrxchg_rtn_b64 v[74:75], v93, v[80:81] offset:65408
    v_cvt_pk_bf16_f32 v76, v76, v77
    v_cvt_pk_bf16_f32 v77, v78, v79
    ds_wrxchg_rtn_b64 v[72:73], v92, v[76:77] offset:65408
    s_setprio 0
    v_mfma_f32_4x4x4_16b_bf16 v[80:83], v[8:9], v[106:107], 0
    v_mfma_f32_4x4x4_16b_bf16 v[76:79], v[8:9], v[104:105], 0
    v_cmp_lt_u32 s[48:49], v5, v95
    s_nop 2
    v_pk_mul_f32 v[80:81], v[80:81], v[14:15] op_sel:[0,1] op_sel_hi:[1,1]
    v_pk_mul_f32 v[82:83], v[82:83], v[14:15] op_sel:[0,1] op_sel_hi:[1,1]
    v_pk_mul_f32 v[76:77], v[76:77], v[14:15] op_sel:[0,0] op_sel_hi:[1,0]
    v_pk_mul_f32 v[78:79], v[78:79], v[14:15] op_sel:[0,0] op_sel_hi:[1,0]
    s_add_u32 s40, s40, 0x50000
    v_and_b32 v47, 0x0fffffff, v31
    buffer_load_dword v30, v47, s[8:11], 0 offen offset:16
    s_mov_b64 exec, s[6:7]
    v_add_u32 v47, 8, v47
    v_lshrrev_b32 v31, 2, v31
    s_mov_b64 exec, -1
    buffer_load_dwordx2 v[28:29], v47, s[8:11], 0 offen
    s_waitcnt vmcnt(8)
    v_and_b32 v46, 0x80000000, v43
    v_lshrrev_b32 v47, 14, v37
    v_bitop3_b32 v47, v47, v5, v46 bitop3:0xea
    ds_read_b64 v[106:107], v47
    v_and_b32 v99, 0x40000000, v43
    v_lshrrev_b32 v47, 14, v36
    v_bitop3_b32 v47, v47, v5, v99 bitop3:0xea
    ds_read_b64 v[104:105], v47
    v_and_b32 v46, 0x20000000, v43
    v_lshrrev_b32 v47, 14, v35
    v_bitop3_b32 v47, v47, v5, v46 bitop3:0xea
    ds_read_b64 v[102:103], v47
    v_and_b32 v99, 0x10000000, v43
    v_lshrrev_b32 v47, 14, v34
    v_bitop3_b32 v47, v47, v5, v99 bitop3:0xea
    ds_read_b64 v[100:101], v47
    s_waitcnt lgkmcnt(4)
    v_cmp_ne_u64 s[50:51], v[72:73], v[68:69]
    v_cmpx_ne_u64 s[54:55], v[74:75], v[70:71]
    s_and_b64 s[82:83], s[54:55], s[80:81]
    s_cbranch_scc1 L2_c77
L2_d77:
    v_mov_b64 v[84:85], v[70:71]
    v_mov_b32 v7, v93
    v_mov_b64 v[86:87], v[74:75]
    s_or_b64 s[80:81], s[80:81], s[54:55]
    s_mov_b64 exec, s[50:51]
    s_and_b64 s[82:83], s[50:51], s[80:81]
    s_cbranch_scc1 L2_c78
L2_d78:
    v_mov_b64 v[84:85], v[68:69]
    v_mov_b32 v7, v92
    v_mov_b64 v[86:87], v[72:73]
    s_mov_b64 exec, -1
    s_or_b64 s[80:81], s[80:81], s[50:51]
    s_and_b64 exec, s[48:49], s[80:81]
    v_mfma_f32_4x4x4_16b_bf16 v[80:83], v[12:13], v[84:85], 0
    v_mov_b32 v95, v7
    s_andn2_b64 s[80:81], s[80:81], s[48:49]
    v_mfma_f32_4x4x4_16b_bf16 v[80:83], v[10:11], v[86:87], v[80:83]
    s_mov_b64 exec, -1
    ds_read_b64 v[70:71], v95 offset:65408
    ds_read_b64 v[68:69], v94 offset:65408
    v_bitop3_b32 v92, v34, v5, v99 bitop3:0xea
    v_bitop3_b32 v93, v35, v5, v46 bitop3:0xea
    v_perm_b32 v15, v35, v38, s45
    v_bitop3_b32 v46, v35, 0.5, -0.5 bitop3:0xa8
    v_perm_b32 v14, v34, v38, s44
    v_bitop3_b32 v47, v34, 0.5, -0.5 bitop3:0xa8
    v_bitop3_b32 v15, v6, v15, v46 bitop3:0xca
    v_bitop3_b32 v14, v6, v14, v47 bitop3:0xca
    s_waitcnt lgkmcnt(1)
    v_mfma_f32_4x4x4_16b_bf16 v[80:83], v[10:11], v[70:71], v[80:83]
    s_waitcnt lgkmcnt(0)
    v_mfma_f32_4x4x4_16b_bf16 v[76:79], v[10:11], v[68:69], v[76:79]
    s_nop 2
    v_cvt_pk_bf16_f32 v80, v80, v81
    v_cvt_pk_bf16_f32 v81, v82, v83
    ds_wrxchg_rtn_b64 v[74:75], v95, v[80:81] offset:65408
    v_cvt_pk_bf16_f32 v76, v76, v77
    v_cvt_pk_bf16_f32 v77, v78, v79
    ds_wrxchg_rtn_b64 v[72:73], v94, v[76:77] offset:65408
    s_barrier
    s_setprio 3
    s_mov_b32 m0, s100
    s_nop 0
    ds_write_addtid_b32 v124 offset:34816
    ds_write_addtid_b32 v125 offset:35072
    ds_write_addtid_b32 v126 offset:35328
    ds_write_addtid_b32 v127 offset:35584
    s_add_u32 s3, s40, 4096
    buffer_load_dwordx4 v[124:127], v3, s[16:19], s3 offen sc1
    ds_write_addtid_b32 v116 offset:32768
    ds_write_addtid_b32 v117 offset:33024
    ds_write_addtid_b32 v118 offset:33280
    ds_write_addtid_b32 v119 offset:33536
    buffer_load_dwordx4 v[116:119], v3, s[16:19], s40 offen offset:2048 sc1
    ds_write_addtid_b32 v120 offset:33792
    ds_write_addtid_b32 v121 offset:34048
    ds_write_addtid_b32 v122 offset:34304
    ds_write_addtid_b32 v123 offset:34560
    buffer_load_dwordx4 v[120:123], v3, s[16:19], s40 offen offset:3072 sc1
    v_mfma_f32_4x4x4_16b_bf16 v[80:83], v[8:9], v[102:103], 0
    v_mfma_f32_4x4x4_16b_bf16 v[76:79], v[8:9], v[100:101], 0
    s_nop 3
    v_pk_mul_f32 v[80:81], v[80:81], v[14:15] op_sel:[0,1] op_sel_hi:[1,1]
    v_pk_mul_f32 v[82:83], v[82:83], v[14:15] op_sel:[0,1] op_sel_hi:[1,1]
    v_pk_mul_f32 v[76:77], v[76:77], v[14:15] op_sel:[0,0] op_sel_hi:[1,0]
    v_pk_mul_f32 v[78:79], v[78:79], v[14:15] op_sel:[0,0] op_sel_hi:[1,0]
    s_cmp_gt_u32 s37, 1024
    s_cbranch_scc1 L2_xs79
    s_cmp_lg_u32 s101, 0
    s_cbranch_scc1 L2_xa79
L2_xb79:
    v_lshlrev_b32 v89, 16, v96
    v_add_u32 v90, 60, v97
    v_bitop3_b32 v90, v89, v45, v90 bitop3:0x6a
    ds_write_b32 v98, v90 offset:12
    v_lshlrev_b32 v89, 20, v96
    v_add_u32 v90, 40, v97
    v_bitop3_b32 v90, v89, v45, v90 bitop3:0x6a
    ds_write_b32 v98, v90 offset:8
    v_lshlrev_b32 v89, 24, v96
    v_add_u32 v90, 20, v97
    v_bitop3_b32 v90, v89, v45, v90 bitop3:0x6a
    ds_write_b32 v98, v90 offset:4
    v_lshlrev_b32 v89, 28, v96
    v_bitop3_b32 v90, v89, v45, v97 bitop3:0x6a
    ds_write_b32 v98, v90 offset:0
    v_mov_b32_dpp v91, v66 quad_perm:[0,0,0,0] row_mask:0xf bank_mask:0xf
    v_and_b32 v89, 3, v91
    v_and_b32 v97, 0xfffc, v91
    v_sub_u16_dpp v88, v66, v91 quad_perm:[2,2,2,2] row_mask:0xf bank_mask:0xf
    v_mad_u32_u24 v97, v97, 5, v4
    v_add_u32 v99, v88, v89
    v_bfm_b32 v96, v88, v89
    v_cmp_lt_u32 s[58:59], 16, v99
    v_lshlrev_b32 v89, v1, v96
    v_and_b32 v89, v45, v89
    v_cmp_ne_u32 vcc, 0, v89
    v_xor_b32 v90, v97, v89
    s_add_u32 s3, s37, s38
    v_mbcnt_lo_u32_b32 v98, vcc_lo, 0
    v_mbcnt_hi_u32_b32 v98, vcc_hi, v98
    s_bcnt1_i32_b64 s41, vcc
    v_lshl_add_u32 v98, v98, 2, s3
    s_lshl2_add_u32 s37, s41, s37
    s_mov_b64 exec, vcc
    ds_write_b32 v98, v90
    s_mov_b64 exec, -1
    s_cmp_lg_u64 s[58:59], 0
    s_cbranch_scc1 L2_xe79
L2_xr79:
    v_add_u32 v98, s37, v0
    v_mov_b32 v90, -1
    ds_write_b32 v98, v90
L2_xw79:
    s_setprio 2
    s_waitcnt lgkmcnt(14)
    v_cmp_ne_u64 s[50:51], v[72:73], v[68:69]
    v_cmpx_ne_u64 s[54:55], v[74:75], v[70:71]
    s_and_b64 s[82:83], s[54:55], s[80:81]
    s_cbranch_scc1 L2_c80
L2_d80:
    v_mov_b64 v[84:85], v[70:71]
    v_mov_b32 v7, v95
    v_mov_b64 v[86:87], v[74:75]
    s_or_b64 s[80:81], s[80:81], s[54:55]
    s_mov_b64 exec, s[50:51]
    s_and_b64 s[82:83], s[50:51], s[80:81]
    s_cbranch_scc1 L2_c81
L2_d81:
    v_mov_b64 v[84:85], v[68:69]
    v_mov_b32 v7, v94
    v_mov_b64 v[86:87], v[72:73]
    s_mov_b64 exec, -1
    s_or_b64 s[80:81], s[80:81], s[50:51]
    ds_read_b64 v[70:71], v93 offset:65408
    ds_read_b64 v[68:69], v92 offset:65408
    v_and_b32 v46, 0x40000000, v43
    v_bitop3_b32 v94, v36, v5, v46 bitop3:0xea
    v_and_b32 v46, 0x80000000, v43
    v_bitop3_b32 v95, v37, v5, v46 bitop3:0xea
    v_perm_b32 v15, v37, v38, s47
    v_bitop3_b32 v46, v37, 0.5, -0.5 bitop3:0xa8
    v_perm_b32 v14, v36, v38, s46
    v_bitop3_b32 v47, v36, 0.5, -0.5 bitop3:0xa8
    v_bitop3_b32 v15, v6, v15, v46 bitop3:0xca
    v_bitop3_b32 v14, v6, v14, v47 bitop3:0xca
    s_setprio 1
    s_waitcnt lgkmcnt(1)
    v_mfma_f32_4x4x4_16b_bf16 v[80:83], v[10:11], v[70:71], v[80:83]
    s_waitcnt lgkmcnt(0)
    v_mfma_f32_4x4x4_16b_bf16 v[76:79], v[10:11], v[68:69], v[76:79]
    s_nop 2
    v_cvt_pk_bf16_f32 v80, v80, v81
    v_cvt_pk_bf16_f32 v81, v82, v83
    ds_wrxchg_rtn_b64 v[74:75], v93, v[80:81] offset:65408
    v_cvt_pk_bf16_f32 v76, v76, v77
    v_cvt_pk_bf16_f32 v77, v78, v79
    ds_wrxchg_rtn_b64 v[72:73], v92, v[76:77] offset:65408
    ds_read_b32 v40, v0 offset:0
    ds_read_b32 v41, v0 offset:256
    ds_read_b32 v42, v44 offset:768
    ds_read_b32 v43, v0 offset:512
    s_sub_u32 s3, s37, 768
    s_cmp_gt_u32 s3, 128
    s_cbranch_scc1 L2_xf79
L2_xg79:
    v_and_b32 v88, 0x0fffffff, v39
    buffer_load_dwordx2 v[34:35], v88, s[8:11], 0 offen
    buffer_load_dwordx3 v[36:38], v88, s[8:11], 0 offen offset:8
    s_setprio 0
    s_waitcnt vmcnt(12)
    s_mov_b32 m0, s38
    s_nop 0
    ds_write_addtid_b32 v108 offset:0
    ds_write_addtid_b32 v109 offset:256
    ds_write_addtid_b32 v110 offset:512
    ds_write_addtid_b32 v111 offset:768
    s_waitcnt vmcnt(9)
    ds_write_addtid_b32 v112 offset:1024
    ds_write_addtid_b32 v113 offset:1280
    ds_write_addtid_b32 v114 offset:1536
    ds_write_addtid_b32 v115 offset:1792
    v_mfma_f32_4x4x4_16b_bf16 v[80:83], v[8:9], v[106:107], 0
    v_mfma_f32_4x4x4_16b_bf16 v[76:79], v[8:9], v[104:105], 0
    v_cmp_lt_u32 s[84:85], v5, v94
    s_nop 2
    v_pk_mul_f32 v[80:81], v[80:81], v[14:15] op_sel:[0,1] op_sel_hi:[1,1]
    v_pk_mul_f32 v[82:83], v[82:83], v[14:15] op_sel:[0,1] op_sel_hi:[1,1]
    v_pk_mul_f32 v[76:77], v[76:77], v[14:15] op_sel:[0,0] op_sel_hi:[1,0]
    v_pk_mul_f32 v[78:79], v[78:79], v[14:15] op_sel:[0,0] op_sel_hi:[1,0]
    s_add_u32 s42, s42, 1
    s_waitcnt lgkmcnt(0)
    s_barrier
    s_bitcmp1_b32 s36, s42
    s_cbranch_scc1 L2_slow
L2_ret4:
    s_setprio 3
    s_bitcmp1_b32 s43, s42
    s_cbranch_scc1 L2_oa82
L2_ob82:
    v_and_b32 v46, 0x20000000, v21
    v_lshrrev_b32 v47, 14, v17
    v_bitop3_b32 v47, v47, v5, v46 bitop3:0xea
    ds_read_b64 v[102:103], v47
    v_and_b32 v99, 0x10000000, v21
    v_lshrrev_b32 v47, 14, v16
    v_bitop3_b32 v47, v47, v5, v99 bitop3:0xea
    ds_read_b64 v[100:101], v47
    v_cmp_ne_u64 s[50:51], v[72:73], v[68:69]
    v_cmpx_ne_u64 s[54:55], v[74:75], v[70:71]
    s_and_b64 s[82:83], s[54:55], s[80:81]
    s_cbranch_scc1 L2_c83
L2_d83:
    v_mov_b64 v[84:85], v[70:71]
    v_mov_b32 v7, v93
    v_mov_b64 v[86:87], v[74:75]
    s_or_b64 s[80:81], s[80:81], s[54:55]
    s_mov_b64 exec, s[50:51]
    s_and_b64 s[82:83], s[50:51], s[80:81]
    s_cbranch_scc1 L2_c84
L2_d84:
    v_mov_b64 v[84:85], v[68:69]
    v_mov_b32 v7, v92
    v_mov_b64 v[86:87], v[72:73]
    s_mov_b64 exec, -1
    s_or_b64 s[80:81], s[80:81], s[50:51]
    s_and_b64 exec, s[84:85], s[80:81]
    v_mfma_f32_4x4x4_16b_bf16 v[76:79], v[12:13], v[84:85], 0
    v_mov_b32 v94, v7
    s_andn2_b64 s[80:81], s[80:81], s[84:85]
    v_mfma_f32_4x4x4_16b_bf16 v[76:79], v[10:11], v[86:87], v[76:79]
    s_mov_b64 exec, -1
    ds_read_b64 v[70:71], v95 offset:65408
    ds_read_b64 v[68:69], v94 offset:65408
    v_bitop3_b32 v92, v16, v5, v99 bitop3:0xea
    v_bitop3_b32 v93, v17, v5, v46 bitop3:0xea
    v_perm_b32 v15, v17, v20, s45
    v_bitop3_b32 v46, v17, 0.5, -0.5 bitop3:0xa8
    v_perm_b32 v14, v16, v20, s44
    v_bitop3_b32 v47, v16, 0.5, -0.5 bitop3:0xa8
    v_bitop3_b32 v15, v6, v15, v46 bitop3:0xca
    v_bitop3_b32 v14, v6, v14, v47 bitop3:0xca
    s_waitcnt lgkmcnt(1)
    v_mfma_f32_4x4x4_16b_bf16 v[80:83], v[10:11], v[70:71], v[80:83]
    s_waitcnt lgkmcnt(0)
    v_mfma_f32_4x4x4_16b_bf16 v[76:79], v[10:11], v[68:69], v[76:79]
    s_nop 2
    v_cvt_pk_bf16_f32 v80, v80, v81
    v_cvt_pk_bf16_f32 v81, v82, v83
    ds_wrxchg_rtn_b64 v[74:75], v95, v[80:81] offset:65408
    v_cvt_pk_bf16_f32 v76, v76, v77
    v_cvt_pk_bf16_f32 v77, v78, v79
    ds_wrxchg_rtn_b64 v[72:73], v94, v[76:77] offset:65408
    v_mfma_f32_4x4x4_16b_bf16 v[80:83], v[8:9], v[102:103], 0
    v_mfma_f32_4x4x4_16b_bf16 v[76:79], v[8:9], v[100:101], 0
    v_cmp_lt_u32 s[84:85], v5, v92
    s_nop 2
    v_pk_mul_f32 v[80:81], v[80:81], v[14:15] op_sel:[0,1] op_sel_hi:[1,1]
    v_pk_mul_f32 v[82:83], v[82:83], v[14:15] op_sel:[0,1] op_sel_hi:[1,1]
    v_pk_mul_f32 v[76:77], v[76:77], v[14:15] op_sel:[0,0] op_sel_hi:[1,0]
    v_pk_mul_f32 v[78:79], v[78:79], v[14:15] op_sel:[0,0] op_sel_hi:[1,0]
    buffer_load_dwordx4 v[108:111], v3, s[16:19], s40 offen offset:0 sc1
    v_and_b32 v46, 0x80000000, v21
    v_lshrrev_b32 v47, 14, v19
    v_bitop3_b32 v47, v47, v5, v46 bitop3:0xea
    ds_read_b64 v[106:107], v47
    v_and_b32 v99, 0x40000000, v21
    v_lshrrev_b32 v47, 14, v18
    v_bitop3_b32 v47, v47, v5, v99 bitop3:0xea
    ds_read_b64 v[104:105], v47
    s_waitcnt lgkmcnt(2)
    v_cmp_ne_u64 s[50:51], v[72:73], v[68:69]
    v_cmpx_ne_u64 s[54:55], v[74:75], v[70:71]
    s_and_b64 s[82:83], s[54:55], s[80:81]
    s_cbranch_scc1 L2_c85
L2_d85:
    v_mov_b64 v[84:85], v[70:71]
    v_mov_b32 v7, v95
    v_mov_b64 v[86:87], v[74:75]
    s_or_b64 s[80:81], s[80:81], s[54:55]
    s_mov_b64 exec, s[50:51]
    s_and_b64 s[82:83], s[50:51], s[80:81]
    s_cbranch_scc1 L2_c86
L2_d86:
    v_mov_b64 v[84:85], v[68:69]
    v_mov_b32 v7, v94
    v_mov_b64 v[86:87], v[72:73]
    s_mov_b64 exec, -1
    s_or_b64 s[80:81], s[80:81], s[50:51]
    s_and_b64 exec, s[84:85], s[80:81]
    v_mfma_f32_4x4x4_16b_bf16 v[76:79], v[12:13], v[84:85], 0
    v_mov_b32 v92, v7
    s_andn2_b64 s[80:81], s[80:81], s[84:85]
    v_mfma_f32_4x4x4_16b_bf16 v[76:79], v[10:11], v[86:87], v[76:79]
    s_mov_b64 exec, -1
    ds_read_b64 v[70:71], v93 offset:65408
    ds_read_b64 v[68:69], v92 offset:65408
    v_bitop3_b32 v94, v18, v5, v99 bitop3:0xea
    v_bitop3_b32 v95, v19, v5, v46 bitop3:0xea
    v_perm_b32 v15, v19, v20, s47
    v_bitop3_b32 v46, v19, 0.5, -0.5 bitop3:0xa8
    v_perm_b32 v14, v18, v20, s46
    v_bitop3_b32 v47, v18, 0.5, -0.5 bitop3:0xa8
    v_bitop3_b32 v15, v6, v15, v46 bitop3:0xca
    v_bitop3_b32 v14, v6, v14, v47 bitop3:0xca
    s_waitcnt lgkmcnt(1)
    v_mfma_f32_4x4x4_16b_bf16 v[80:83], v[10:11], v[70:71], v[80:83]
    s_waitcnt lgkmcnt(0)
    v_mfma_f32_4x4x4_16b_bf16 v[76:79], v[10:11], v[68:69], v[76:79]
    s_nop 2
    v_cvt_pk_bf16_f32 v80, v80, v81
    v_cvt_pk_bf16_f32 v81, v82, v83
    ds_wrxchg_rtn_b64 v[74:75], v93, v[80:81] offset:65408
    v_cvt_pk_bf16_f32 v76, v76, v77
    v_cvt_pk_bf16_f32 v77, v78, v79
    ds_wrxchg_rtn_b64 v[72:73], v92, v[76:77] offset:65408
    v_and_b32 v88, 0x0fffffff, v40
    buffer_load_dwordx2 v[16:17], v88, s[8:11], 0 offen
    buffer_load_dwordx3 v[18:20], v88, s[8:11], 0 offen offset:8
    s_setprio 2
    v_mfma_f32_4x4x4_16b_bf16 v[80:83], v[8:9], v[106:107], 0
    v_mfma_f32_4x4x4_16b_bf16 v[76:79], v[8:9], v[104:105], 0
    v_cmp_lt_u32 s[48:49], v5, v95
    s_nop 2
    v_pk_mul_f32 v[80:81], v[80:81], v[14:15] op_sel:[0,1] op_sel_hi:[1,1]
    v_pk_mul_f32 v[82:83], v[82:83], v[14:15] op_sel:[0,1] op_sel_hi:[1,1]
    v_pk_mul_f32 v[76:77], v[76:77], v[14:15] op_sel:[0,0] op_sel_hi:[1,0]
    v_pk_mul_f32 v[78:79], v[78:79], v[14:15] op_sel:[0,0] op_sel_hi:[1,0]
    s_waitcnt vmcnt(10)
    v_and_b32 v46, 0x20000000, v27
    v_lshrrev_b32 v47, 14, v23
    v_bitop3_b32 v47, v47, v5, v46 bitop3:0xea
    ds_read_b64 v[102:103], v47
    v_and_b32 v99, 0x10000000, v27
    v_lshrrev_b32 v47, 14, v22
    v_bitop3_b32 v47, v47, v5, v99 bitop3:0xea
    ds_read_b64 v[100:101], v47
    s_waitcnt lgkmcnt(2)
    v_cmp_ne_u64 s[50:51], v[72:73], v[68:69]
    v_cmpx_ne_u64 s[54:55], v[74:75], v[70:71]
    s_and_b64 s[82:83], s[54:55], s[80:81]
    s_cbranch_scc1 L2_c87
L2_d87:
    v_mov_b64 v[84:85], v[70:71]
    v_mov_b32 v7, v93
    v_mov_b64 v[86:87], v[74:75]
    s_or_b64 s[80:81], s[80:81], s[54:55]
    s_mov_b64 exec, s[50:51]
    s_and_b64 s[82:83], s[50:51], s[80:81]
    s_cbranch_scc1 L2_c88
L2_d88:
    v_mov_b64 v[84:85], v[68:69]
    v_mov_b32 v7, v92
    v_mov_b64 v[86:87], v[72:73]
    s_mov_b64 exec, -1
    s_or_b64 s[80:81], s[80:81], s[50:51]
    s_and_b64 exec, s[48:49], s[80:81]
    v_mfma_f32_4x4x4_16b_bf16 v[80:83], v[12:13], v[84:85], 0
    v_mov_b32 v95, v7
    s_andn2_b64 s[80:81], s[80:81], s[48:49]
    v_mfma_f32_4x4x4_16b_bf16 v[80:83], v[10:11], v[86:87], v[80:83]
    s_mov_b64 exec, -1
    ds_read_b64 v[70:71], v95 offset:65408
    ds_read_b64 v[68:69], v94 offset:65408
    v_bitop3_b32 v92, v22, v5, v99 bitop3:0xea
    v_bitop3_b32 v93, v23, v5, v46 bitop3:0xea
    v_perm_b32 v15, v23, v26, s45
    v_bitop3_b32 v46, v23, 0.5, -0.5 bitop3:0xa8
    v_perm_b32 v14, v22, v26, s44
    v_bitop3_b32 v47, v22, 0.5, -0.5 bitop3:0xa8
    v_bitop3_b32 v15, v6, v15, v46 bitop3:0xca
    v_bitop3_b32 v14, v6, v14, v47 bitop3:0xca
    s_waitcnt lgkmcnt(1)
    v_mfma_f32_4x4x4_16b_bf16 v[80:83], v[10:11], v[70:71], v[80:83]
    s_waitcnt lgkmcnt(0)
    v_mfma_f32_4x4x4_16b_bf16 v[76:79], v[10:11], v[68:69], v[76:79]
    s_nop 2
    v_cvt_pk_bf16_f32 v80, v80, v81
    v_cvt_pk_bf16_f32 v81, v82, v83
    ds_wrxchg_rtn_b64 v[74:75], v95, v[80:81] offset:65408
    v_cvt_pk_bf16_f32 v76, v76, v77
    v_cvt_pk_bf16_f32 v77, v78, v79
    ds_wrxchg_rtn_b64 v[72:73], v94, v[76:77] offset:65408
    s_setprio 1
    v_mfma_f32_4x4x4_16b_bf16 v[80:83], v[8:9], v[102:103], 0
    v_mfma_f32_4x4x4_16b_bf16 v[76:79], v[8:9], v[100:101], 0
    s_nop 3
    v_pk_mul_f32 v[80:81], v[80:81], v[14:15] op_sel:[0,1] op_sel_hi:[1,1]
    v_pk_mul_f32 v[82:83], v[82:83], v[14:15] op_sel:[0,1] op_sel_hi:[1,1]
    v_pk_mul_f32 v[76:77], v[76:77], v[14:15] op_sel:[0,0] op_sel_hi:[1,0]
    v_pk_mul_f32 v[78:79], v[78:79], v[14:15] op_sel:[0,0] op_sel_hi:[1,0]
    s_bitcmp1_b32 s43, s42
    s_cbranch_scc1 L2_oa89
L2_ob89:
    buffer_load_dwordx4 v[112:115], v3, s[16:19], s40 offen offset:1024 sc1
    v_sub_u16 v88, v60, v52
    v_and_b32 v89, 3, v52
    v_add3_u32 v99, v88, v89, 3
    v_and_b32 v99, -4, v99
    v_max_u32 v99, 4, v99
    v_and_b32 v97, 0xfffc, v52
    v_bfm_b32 v96, v88, v89
    v_add_u32_dpp v91, v99, v99 row_shr:1 row_mask:0xf bank_mask:0xf bound_ctrl:1
    v_mad_u32_u24 v97, v97, 5, v2
    v_cmp_lt_u32 vcc, 16, v99
    v_add_u32_dpp v91, v91, v91 row_shr:2 row_mask:0xf bank_mask:0xf bound_ctrl:1
    v_sub_u32 v98, s38, v99
    v_lshrrev_b64 v[52:53], 16, v[52:53]
    v_add_u32_dpp v91, v91, v91 row_shr:4 row_mask:0xf bank_mask:0xf bound_ctrl:1
    v_lshrrev_b64 v[60:61], 16, v[60:61]
    s_mov_b32 s101, 0
    v_add_u32_dpp v91, v91, v91 row_shr:8 row_mask:0xf bank_mask:0xf bound_ctrl:1
    s_nop 1
    v_add_u32_dpp v91, v91, v91 row_bcast:15 row_mask:0xa bank_mask:0xf
    s_nop 1
    v_add_u32_dpp v91, v91, v91 row_bcast:31 row_mask:0xc bank_mask:0xf
    v_add_u32 v98, v98, v91
    v_readlane_b32 s37, v91, 63
    s_cbranch_vccnz L2_xo90
L2_xp90:
    v_and_b32 v46, 0x80000000, v27
    v_lshrrev_b32 v47, 14, v25
    v_bitop3_b32 v47, v47, v5, v46 bitop3:0xea
    ds_read_b64 v[106:107], v47
    v_and_b32 v99, 0x40000000, v27
    v_lshrrev_b32 v47, 14, v24
    v_bitop3_b32 v47, v47, v5, v99 bitop3:0xea
    ds_read_b64 v[104:105], v47
    s_waitcnt lgkmcnt(2)
    v_cmp_ne_u64 s[50:51], v[72:73], v[68:69]
    v_cmpx_ne_u64 s[54:55], v[74:75], v[70:71]
    s_and_b64 s[82:83], s[54:55], s[80:81]
    s_cbranch_scc1 L2_c91
L2_d91:
    v_mov_b64 v[84:85], v[70:71]
    v_mov_b32 v7, v95
    v_mov_b64 v[86:87], v[74:75]
    s_or_b64 s[80:81], s[80:81], s[54:55]
    s_mov_b64 exec, s[50:51]
    s_and_b64 s[82:83], s[50:51], s[80:81]
    s_cbranch_scc1 L2_c92
L2_d92:
    v_mov_b64 v[84:85], v[68:69]
    v_mov_b32 v7, v94
    v_mov_b64 v[86:87], v[72:73]
    s_mov_b64 exec, -1
    s_or_b64 s[80:81], s[80:81], s[50:51]
    ds_read_b64 v[70:71], v93 offset:65408
    ds_read_b64 v[68:69], v92 offset:65408
    v_bitop3_b32 v94, v24, v5, v99 bitop3:0xea
    v_bitop3_b32 v95, v25, v5, v46 bitop3:0xea
    v_perm_b32 v15, v25, v26, s47
    v_bitop3_b32 v46, v25, 0.5, -0.5 bitop3:0xa8
    v_perm_b32 v14, v24, v26, s46
    v_bitop3_b32 v47, v24, 0.5, -0.5 bitop3:0xa8
    v_bitop3_b32 v15, v6, v15, v46 bitop3:0xca
    v_bitop3_b32 v14, v6, v14, v47 bitop3:0xca
    s_waitcnt lgkmcnt(1)
    v_mfma_f32_4x4x4_16b_bf16 v[80:83], v[10:11], v[70:71], v[80:83]
    s_waitcnt lgkmcnt(0)
    v_mfma_f32_4x4x4_16b_bf16 v[76:79], v[10:11], v[68:69], v[76:79]
    s_nop 2
    v_cvt_pk_bf16_f32 v80, v80, v81
    v_cvt_pk_bf16_f32 v81, v82, v83
    ds_wrxchg_rtn_b64 v[74:75], v93, v[80:81] offset:65408
    v_cvt_pk_bf16_f32 v76, v76, v77
    v_cvt_pk_bf16_f32 v77, v78, v79
    ds_wrxchg_rtn_b64 v[72:73], v92, v[76:77] offset:65408
    v_and_b32 v88, 0x0fffffff, v41
    buffer_load_dwordx2 v[22:23], v88, s[8:11], 0 offen
    buffer_load_dwordx3 v[24:26], v88, s[8:11], 0 offen offset:8
    v_mfma_f32_4x4x4_16b_bf16 v[80:83], v[8:9], v[106:107], 0
    v_mfma_f32_4x4x4_16b_bf16 v[76:79], v[8:9], v[104:105], 0
    v_cmp_lt_u32 s[84:85], v5, v94
    s_nop 2
    v_pk_mul_f32 v[80:81], v[80:81], v[14:15] op_sel:[0,1] op_sel_hi:[1,1]
    v_pk_mul_f32 v[82:83], v[82:83], v[14:15] op_sel:[0,1] op_sel_hi:[1,1]
    v_pk_mul_f32 v[76:77], v[76:77], v[14:15] op_sel:[0,0] op_sel_hi:[1,0]
    v_pk_mul_f32 v[78:79], v[78:79], v[14:15] op_sel:[0,0] op_sel_hi:[1,0]
    s_waitcnt vmcnt(11)
    s_mov_b64 exec, s[6:7]
    v_lshrrev_b32 v30, 16, v30
    s_mov_b64 exec, -1
    v_and_b32 v46, 0x20000000, v31
    v_lshrrev_b32 v47, 14, v29
    v_bitop3_b32 v47, v47, v5, v46 bitop3:0xea
    ds_read_b64 v[102:103], v47
    v_and_b32 v99, 0x10000000, v31
    v_lshrrev_b32 v47, 14, v28
    v_bitop3_b32 v47, v47, v5, v99 bitop3:0xea
    ds_read_b64 v[100:101], v47
    s_waitcnt lgkmcnt(2)
    v_cmp_ne_u64 s[50:51], v[72:73], v[68:69]
    v_cmpx_ne_u64 s[54:55], v[74:75], v[70:71]
    s_and_b64 s[82:83], s[54:55], s[80:81]
    s_cbranch_scc1 L2_c93
L2_d93:
    v_mov_b64 v[84:85], v[70:71]
    v_mov_b32 v7, v93
    v_mov_b64 v[86:87], v[74:75]
    s_or_b64 s[80:81], s[80:81], s[54:55]
    s_mov_b64 exec, s[50:51]
    s_and_b64 s[82:83], s[50:51], s[80:81]
    s_cbranch_scc1 L2_c94
L2_d94:
    v_mov_b64 v[84:85], v[68:69]
    v_mov_b32 v7, v92
    v_mov_b64 v[86:87], v[72:73]
    s_mov_b64 exec, -1
    s_or_b64 s[80:81], s[80:81], s[50:51]
    s_and_b64 exec, s[84:85], s[80:81]
    v_mfma_f32_4x4x4_16b_bf16 v[76:79], v[12:13], v[84:85], 0
    v_mov_b32 v94, v7
    s_andn2_b64 s[80:81], s[80:81], s[84:85]
    v_mfma_f32_4x4x4_16b_bf16 v[76:79], v[10:11], v[86:87], v[76:79]
    s_mov_b64 exec, -1
    ds_read_b64 v[70:71], v95 offset:65408
    ds_read_b64 v[68:69], v94 offset:65408
    v_bitop3_b32 v92, v28, v5, v99 bitop3:0xea
    v_bitop3_b32 v93, v29, v5, v46 bitop3:0xea
    v_perm_b32 v15, v29, v30, s45
    v_bitop3_b32 v46, v29, 0.5, -0.5 bitop3:0xa8
    v_perm_b32 v14, v28, v30, s44
    v_bitop3_b32 v47, v28, 0.5, -0.5 bitop3:0xa8
    v_bitop3_b32 v15, v6, v15, v46 bitop3:0xca
    v_bitop3_b32 v14, v6, v14, v47 bitop3:0xca
    s_waitcnt lgkmcnt(1)
    v_mfma_f32_4x4x4_16b_bf16 v[80:83], v[10:11], v[70:71], v[80:83]
    s_waitcnt lgkmcnt(0)
    v_mfma_f32_4x4x4_16b_bf16 v[76:79], v[10:11], v[68:69], v[76:79]
    s_nop 2
    v_cvt_pk_bf16_f32 v80, v80, v81
    v_cvt_pk_bf16_f32 v81, v82, v83
    ds_wrxchg_rtn_b64 v[74:75], v95, v[80:81] offset:65408
    v_cvt_pk_bf16_f32 v76, v76, v77
    v_cvt_pk_bf16_f32 v77, v78, v79
    ds_wrxchg_rtn_b64 v[72:73], v94, v[76:77] offset:65408
    s_setprio 0
    v_mfma_f32_4x4x4_16b_bf16 v[80:83], v[8:9], v[102:103], 0
    v_mfma_f32_4x4x4_16b_bf16 v[76:79], v[8:9], v[100:101], 0
    v_cmp_lt_u32 s[48:49], v5, v93
    s_nop 2
    v_pk_mul_f32 v[80:81], v[80:81], v[14:15] op_sel:[0,1] op_sel_hi:[1,1]
    v_pk_mul_f32 v[82:83], v[82:83], v[14:15] op_sel:[0,1] op_sel_hi:[1,1]
    v_pk_mul_f32 v[76:77], v[76:77], v[14:15] op_sel:[0,0] op_sel_hi:[1,0]
    v_pk_mul_f32 v[78:79], v[78:79], v[14:15] op_sel:[0,0] op_sel_hi:[1,0]
    s_add_u32 s40, s40, 0x50000
    v_and_b32 v47, 0x0fffffff, v42
    buffer_load_dword v30, v47, s[8:11], 0 offen offset:16
    s_mov_b64 exec, s[6:7]
    v_add_u32 v47, 8, v47
    v_lshrrev_b32 v42, 2, v42
    s_mov_b64 exec, -1
    buffer_load_dwordx2 v[28:29], v47, s[8:11], 0 offen
    s_waitcnt vmcnt(8)
    v_and_b32 v46, 0x80000000, v39
    v_lshrrev_b32 v47, 14, v37
    v_bitop3_b32 v47, v47, v5, v46 bitop3:0xea
    ds_read_b64 v[102:103], v47
    v_and_b32 v99, 0x40000000, v39
    v_lshrrev_b32 v47, 14, v36
    v_bitop3_b32 v47, v47, v5, v99 bitop3:0xea
    ds_read_b64 v[100:101], v47
    v_and_b32 v46, 0x20000000, v39
    v_lshrrev_b32 v47, 14, v35
    v_bitop3_b32 v47, v47, v5, v46 bitop3:0xea
    ds_read_b64 v[106:107], v47
    v_and_b32 v99, 0x10000000, v39
    v_lshrrev_b32 v47, 14, v34
    v_bitop3_b32 v47, v47, v5, v99 bitop3:0xea
    ds_read_b64 v[104:105], v47
    s_waitcnt lgkmcnt(4)
    v_cmp_ne_u64 s[50:51], v[72:73], v[68:69]
    v_cmpx_ne_u64 s[54:55], v[74:75], v[70:71]
    s_and_b64 s[82:83], s[54:55], s[80:81]
    s_cbranch_scc1 L2_c95
L2_d95:
    v_mov_b64 v[84:85], v[70:71]
    v_mov_b32 v7, v95
    v_mov_b64 v[86:87], v[74:75]
    s_or_b64 s[80:81], s[80:81], s[54:55]
    s_mov_b64 exec, s[50:51]
    s_and_b64 s[82:83], s[50:51], s[80:81]
    s_cbranch_scc1 L2_c96
L2_d96:
    v_mov_b64 v[84:85], v[68:69]
    v_mov_b32 v7, v94
    v_mov_b64 v[86:87], v[72:73]
    s_mov_b64 exec, -1
    s_or_b64 s[80:81], s[80:81], s[50:51]
    s_and_b64 exec, s[48:49], s[80:81]
    v_mfma_f32_4x4x4_16b_bf16 v[80:83], v[12:13], v[84:85], 0
    v_mov_b32 v93, v7
    s_andn2_b64 s[80:81], s[80:81], s[48:49]
    v_mfma_f32_4x4x4_16b_bf16 v[80:83], v[10:11], v[86:87], v[80:83]
    s_mov_b64 exec, -1
    ds_read_b64 v[70:71], v93 offset:65408
    ds_read_b64 v[68:69], v92 offset:65408
    v_bitop3_b32 v94, v34, v5, v99 bitop3:0xea
    v_bitop3_b32 v95, v35, v5, v46 bitop3:0xea
    v_perm_b32 v15, v35, v38, s45
    v_bitop3_b32 v46, v35, 0.5, -0.5 bitop3:0xa8
    v_perm_b32 v14, v34, v38, s44
    v_bitop3_b32 v47, v34, 0.5, -0.5 bitop3:0xa8
    v_bitop3_b32 v15, v6, v15, v46 bitop3:0xca
    v_bitop3_b32 v14, v6, v14, v47 bitop3:0xca
    s_waitcnt lgkmcnt(1)
    v_mfma_f32_4x4x4_16b_bf16 v[80:83], v[10:11], v[70:71], v[80:83]
    s_waitcnt lgkmcnt(0)
    v_mfma_f32_4x4x4_16b_bf16 v[76:79], v[10:11], v[68:69], v[76:79]
    s_nop 2
    v_cvt_pk_bf16_f32 v80, v80, v81
    v_cvt_pk_bf16_f32 v81, v82, v83
    ds_wrxchg_rtn_b64 v[74:75], v93, v[80:81] offset:65408
    v_cvt_pk_bf16_f32 v76, v76, v77
    v_cvt_pk_bf16_f32 v77, v78, v79
    ds_wrxchg_rtn_b64 v[72:73], v92, v[76:77] offset:65408
    s_barrier
    s_setprio 3
    s_mov_b32 m0, s100
    s_nop 0
    ds_write_addtid_b32 v124 offset:34816
    ds_write_addtid_b32 v125 offset:35072
    ds_write_addtid_b32 v126 offset:35328
    ds_write_addtid_b32 v127 offset:35584
    s_add_u32 s3, s40, 4096
    buffer_load_dwordx4 v[124:127], v3, s[16:19], s3 offen sc1
    ds_write_addtid_b32 v116 offset:32768
    ds_write_addtid_b32 v117 offset:33024
    ds_write_addtid_b32 v118 offset:33280
    ds_write_addtid_b32 v119 offset:33536
    buffer_load_dwordx4 v[116:119], v3, s[16:19], s40 offen offset:2048 sc1
    ds_write_addtid_b32 v120 offset:33792
    ds_write_addtid_b32 v121 offset:34048
    ds_write_addtid_b32 v122 offset:34304
    ds_write_addtid_b32 v123 offset:34560
    buffer_load_dwordx4 v[120:123], v3, s[16:19], s40 offen offset:3072 sc1
    v_mfma_f32_4x4x4_16b_bf16 v[80:83], v[8:9], v[106:107], 0
    v_mfma_f32_4x4x4_16b_bf16 v[76:79], v[8:9], v[104:105], 0
    s_nop 3
    v_pk_mul_f32 v[80:81], v[80:81], v[14:15] op_sel:[0,1] op_sel_hi:[1,1]
    v_pk_mul_f32 v[82:83], v[82:83], v[14:15] op_sel:[0,1] op_sel_hi:[1,1]
    v_pk_mul_f32 v[76:77], v[76:77], v[14:15] op_sel:[0,0] op_sel_hi:[1,0]
    v_pk_mul_f32 v[78:79], v[78:79], v[14:15] op_sel:[0,0] op_sel_hi:[1,0]
    s_cmp_gt_u32 s37, 1024
    s_cbranch_scc1 L2_xs97
    s_cmp_lg_u32 s101, 0
    s_cbranch_scc1 L2_xa97
L2_xb97:
    v_lshlrev_b32 v89, 16, v96
    v_add_u32 v90, 60, v97
    v_bitop3_b32 v90, v89, v45, v90 bitop3:0x6a
    ds_write_b32 v98, v90 offset:12
    v_lshlrev_b32 v89, 20, v96
    v_add_u32 v90, 40, v97
    v_bitop3_b32 v90, v89, v45, v90 bitop3:0x6a
    ds_write_b32 v98, v90 offset:8
    v_lshlrev_b32 v89, 24, v96
    v_add_u32 v90, 20, v97
    v_bitop3_b32 v90, v89, v45, v90 bitop3:0x6a
    ds_write_b32 v98, v90 offset:4
    v_lshlrev_b32 v89, 28, v96
    v_bitop3_b32 v90, v89, v45, v97 bitop3:0x6a
    ds_write_b32 v98, v90 offset:0
    v_mov_b32_dpp v91, v64 quad_perm:[1,1,1,1] row_mask:0xf bank_mask:0xf
    v_and_b32 v89, 3, v91
    v_and_b32 v97, 0xfffc, v91
    v_sub_u16_dpp v88, v64, v91 quad_perm:[3,3,3,3] row_mask:0xf bank_mask:0xf
    v_mad_u32_u24 v97, v97, 5, v4
    v_add_u32 v99, v88, v89
    v_bfm_b32 v96, v88, v89
    v_cmp_lt_u32 s[58:59], 16, v99
    v_lshlrev_b32 v89, v1, v96
    v_and_b32 v89, v45, v89
    v_cmp_ne_u32 vcc, 0, v89
    v_xor_b32 v90, v97, v89
    s_add_u32 s3, s37, s38
    v_mbcnt_lo_u32_b32 v98, vcc_lo, 0
    v_mbcnt_hi_u32_b32 v98, vcc_hi, v98
    s_bcnt1_i32_b64 s41, vcc
    v_lshl_add_u32 v98, v98, 2, s3
    s_lshl2_add_u32 s37, s41, s37
    s_mov_b64 exec, vcc
    ds_write_b32 v98, v90
    s_mov_b64 exec, -1
    s_cmp_lg_u64 s[58:59], 0
    s_cbranch_scc1 L2_xe97
L2_xr97:
    v_add_u32 v98, s37, v0
    v_mov_b32 v90, -1
    ds_write_b32 v98, v90
L2_xw97:
    s_setprio 2
    s_waitcnt lgkmcnt(14)
    v_cmp_ne_u64 s[50:51], v[72:73], v[68:69]
    v_cmpx_ne_u64 s[54:55], v[74:75], v[70:71]
    s_and_b64 s[82:83], s[54:55], s[80:81]
    s_cbranch_scc1 L2_c98
L2_d98:
    v_mov_b64 v[84:85], v[70:71]
    v_mov_b32 v7, v93
    v_mov_b64 v[86:87], v[74:75]
    s_or_b64 s[80:81], s[80:81], s[54:55]
    s_mov_b64 exec, s[50:51]
    s_and_b64 s[82:83], s[50:51], s[80:81]
    s_cbranch_scc1 L2_c99
L2_d99:
    v_mov_b64 v[84:85], v[68:69]
    v_mov_b32 v7, v92
    v_mov_b64 v[86:87], v[72:73]
    s_mov_b64 exec, -1
    s_or_b64 s[80:81], s[80:81], s[50:51]
    ds_read_b64 v[70:71], v95 offset:65408
    ds_read_b64 v[68:69], v94 offset:65408
    v_and_b32 v46, 0x40000000, v39
    v_bitop3_b32 v92, v36, v5, v46 bitop3:0xea
    v_and_b32 v46, 0x80000000, v39
    v_bitop3_b32 v93, v37, v5, v46 bitop3:0xea
    v_perm_b32 v15, v37, v38, s47
    v_bitop3_b32 v46, v37, 0.5, -0.5 bitop3:0xa8
    v_perm_b32 v14, v36, v38, s46
    v_bitop3_b32 v47, v36, 0.5, -0.5 bitop3:0xa8
    v_bitop3_b32 v15, v6, v15, v46 bitop3:0xca
    v_bitop3_b32 v14, v6, v14, v47 bitop3:0xca
    s_setprio 1
    s_waitcnt lgkmcnt(1)
    v_mfma_f32_4x4x4_16b_bf16 v[80:83], v[10:11], v[70:71], v[80:83]
    s_waitcnt lgkmcnt(0)
    v_mfma_f32_4x4x4_16b_bf16 v[76:79], v[10:11], v[68:69], v[76:79]
    s_nop 2
    v_cvt_pk_bf16_f32 v80, v80, v81
    v_cvt_pk_bf16_f32 v81, v82, v83
    ds_wrxchg_rtn_b64 v[74:75], v95, v[80:81] offset:65408
    v_cvt_pk_bf16_f32 v76, v76, v77
    v_cvt_pk_bf16_f32 v77, v78, v79
    ds_wrxchg_rtn_b64 v[72:73], v94, v[76:77] offset:65408
    ds_read_b32 v21, v0 offset:0
    ds_read_b32 v27, v0 offset:256
    ds_read_b32 v31, v44 offset:768
    ds_read_b32 v39, v0 offset:512
    s_sub_u32 s3, s37, 768
    s_cmp_gt_u32 s3, 128
    s_cbranch_scc1 L2_xf97
L2_xg97:
    v_and_b32 v88, 0x0fffffff, v43
    buffer_load_dwordx2 v[34:35], v88, s[8:11], 0 offen
    buffer_load_dwordx3 v[36:38], v88, s[8:11], 0 offen offset:8
    s_setprio 0
    s_waitcnt vmcnt(12)
    s_mov_b32 m0, s38
    s_nop 0
    ds_write_addtid_b32 v108 offset:0
    ds_write_addtid_b32 v109 offset:256
    ds_write_addtid_b32 v110 offset:512
    ds_write_addtid_b32 v111 offset:768
    s_waitcnt vmcnt(9)
    ds_write_addtid_b32 v112 offset:1024
    ds_write_addtid_b32 v113 offset:1280
    ds_write_addtid_b32 v114 offset:1536
    ds_write_addtid_b32 v115 offset:1792
    v_mfma_f32_4x4x4_16b_bf16 v[80:83], v[8:9], v[102:103], 0
    v_mfma_f32_4x4x4_16b_bf16 v[76:79], v[8:9], v[100:101], 0
    v_cmp_lt_u32 s[84:85], v5, v92
    s_nop 2
    v_pk_mul_f32 v[80:81], v[80:81], v[14:15] op_sel:[0,1] op_sel_hi:[1,1]
    v_pk_mul_f32 v[82:83], v[82:83], v[14:15] op_sel:[0,1] op_sel_hi:[1,1]
    v_pk_mul_f32 v[76:77], v[76:77], v[14:15] op_sel:[0,0] op_sel_hi:[1,0]
    v_pk_mul_f32 v[78:79], v[78:79], v[14:15] op_sel:[0,0] op_sel_hi:[1,0]
    s_add_u32 s42, s42, 1
    s_waitcnt lgkmcnt(0)
    s_barrier
    s_bitcmp1_b32 s36, s42
    s_cbranch_scc1 L2_slow
L2_ret5:
    s_setprio 3
    s_bitcmp1_b32 s43, s42
    s_cbranch_scc1 L2_oa100
L2_ob100:
    v_and_b32 v46, 0x20000000, v40
    v_lshrrev_b32 v47, 14, v17
    v_bitop3_b32 v47, v47, v5, v46 bitop3:0xea
    ds_read_b64 v[106:107], v47
    v_and_b32 v99, 0x10000000, v40
    v_lshrrev_b32 v47, 14, v16
    v_bitop3_b32 v47, v47, v5, v99 bitop3:0xea
    ds_read_b64 v[104:105], v47
    v_cmp_ne_u64 s[50:51], v[72:73], v[68:69]
    v_cmpx_ne_u64 s[54:55], v[74:75], v[70:71]
    s_and_b64 s[82:83], s[54:55], s[80:81]
    s_cbranch_scc1 L2_c101
L2_d101:
    v_mov_b64 v[84:85], v[70:71]
    v_mov_b32 v7, v95
    v_mov_b64 v[86:87], v[74:75]
    s_or_b64 s[80:81], s[80:81], s[54:55]
    s_mov_b64 exec, s[50:51]
    s_and_b64 s[82:83], s[50:51], s[80:81]
    s_cbranch_scc1 L2_c102
L2_d102:
    v_mov_b64 v[84:85], v[68:69]
    v_mov_b32 v7, v94
    v_mov_b64 v[86:87], v[72:73]
    s_mov_b64 exec, -1
    s_or_b64 s[80:81], s[80:81], s[50:51]
    s_and_b64 exec, s[84:85], s[80:81]
    v_mfma_f32_4x4x4_16b_bf16 v[76:79], v[12:13], v[84:85], 0
    v_mov_b32 v92, v7
    s_andn2_b64 s[80:81], s[80:81], s[84:85]
    v_mfma_f32_4x4x4_16b_bf16 v[76:79], v[10:11], v[86:87], v[76:79]
    s_mov_b64 exec, -1
    ds_read_b64 v[70:71], v93 offset:65408
    ds_read_b64 v[68:69], v92 offset:65408
    v_bitop3_b32 v94, v16, v5, v99 bitop3:0xea
    v_bitop3_b32 v95, v17, v5, v46 bitop3:0xea
    v_perm_b32 v15, v17, v20, s45
    v_bitop3_b32 v46, v17, 0.5, -0.5 bitop3:0xa8
    v_perm_b32 v14, v16, v20, s44
    v_bitop3_b32 v47, v16, 0.5, -0.5 bitop3:0xa8
    v_bitop3_b32 v15, v6, v15, v46 bitop3:0xca
    v_bitop3_b32 v14, v6, v14, v47 bitop3:0xca
    s_waitcnt lgkmcnt(1)
    v_mfma_f32_4x4x4_16b_bf16 v[80:83], v[10:11], v[70:71], v[80:83]
    s_waitcnt lgkmcnt(0)
    v_mfma_f32_4x4x4_16b_bf16 v[76:79], v[10:11], v[68:69], v[76:79]
    s_nop 2
    v_cvt_pk_bf16_f32 v80, v80, v81
    v_cvt_pk_bf16_f32 v81, v82, v83
    ds_wrxchg_rtn_b64 v[74:75], v93, v[80:81] offset:65408
    v_cvt_pk_bf16_f32 v76, v76, v77
    v_cvt_pk_bf16_f32 v77, v78, v79
    ds_wrxchg_rtn_b64 v[72:73], v92, v[76:77] offset:65408
    v_mfma_f32_4x4x4_16b_bf16 v[80:83], v[8:9], v[106:107], 0
    v_mfma_f32_4x4x4_16b_bf16 v[76:79], v[8:9], v[104:105], 0
    v_cmp_lt_u32 s[84:85], v5, v94
    s_nop 2
    v_pk_mul_f32 v[80:81], v[80:81], v[14:15] op_sel:[0,1] op_sel_hi:[1,1]
    v_pk_mul_f32 v[82:83], v[82:83], v[14:15] op_sel:[0,1] op_sel_hi:[1,1]
    v_pk_mul_f32 v[76:77], v[76:77], v[14:15] op_sel:[0,0] op_sel_hi:[1,0]
    v_pk_mul_f32 v[78:79], v[78:79], v[14:15] op_sel:[0,0] op_sel_hi:[1,0]
    buffer_load_dwordx4 v[108:111], v3, s[16:19], s40 offen offset:0 sc1
    v_and_b32 v46, 0x80000000, v40
    v_lshrrev_b32 v47, 14, v19
    v_bitop3_b32 v47, v47, v5, v46 bitop3:0xea
    ds_read_b64 v[102:103], v47
    v_and_b32 v99, 0x40000000, v40
    v_lshrrev_b32 v47, 14, v18
    v_bitop3_b32 v47, v47, v5, v99 bitop3:0xea
    ds_read_b64 v[100:101], v47
    s_waitcnt lgkmcnt(2)
    v_cmp_ne_u64 s[50:51], v[72:73], v[68:69]
    v_cmpx_ne_u64 s[54:55], v[74:75], v[70:71]
    s_and_b64 s[82:83], s[54:55], s[80:81]
    s_cbranch_scc1 L2_c103
L2_d103:
    v_mov_b64 v[84:85], v[70:71]
    v_mov_b32 v7, v93
    v_mov_b64 v[86:87], v[74:75]
    s_or_b64 s[80:81], s[80:81], s[54:55]
    s_mov_b64 exec, s[50:51]
    s_and_b64 s[82:83], s[50:51], s[80:81]
    s_cbranch_scc1 L2_c104
L2_d104:
    v_mov_b64 v[84:85], v[68:69]
    v_mov_b32 v7, v92
    v_mov_b64 v[86:87], v[72:73]
    s_mov_b64 exec, -1
    s_or_b64 s[80:81], s[80:81], s[50:51]
    s_and_b64 exec, s[84:85], s[80:81]
    v_mfma_f32_4x4x4_16b_bf16 v[76:79], v[12:13], v[84:85], 0
    v_mov_b32 v94, v7
    s_andn2_b64 s[80:81], s[80:81], s[84:85]
    v_mfma_f32_4x4x4_16b_bf16 v[76:79], v[10:11], v[86:87], v[76:79]
    s_mov_b64 exec, -1
    ds_read_b64 v[70:71], v95 offset:65408
    ds_read_b64 v[68:69], v94 offset:65408
    v_bitop3_b32 v92, v18, v5, v99 bitop3:0xea
    v_bitop3_b32 v93, v19, v5, v46 bitop3:0xea
    v_perm_b32 v15, v19, v20, s47
    v_bitop3_b32 v46, v19, 0.5, -0.5 bitop3:0xa8
    v_perm_b32 v14, v18, v20, s46
    v_bitop3_b32 v47, v18, 0.5, -0.5 bitop3:0xa8
    v_bitop3_b32 v15, v6, v15, v46 bitop3:0xca
    v_bitop3_b32 v14, v6, v14, v47 bitop3:0xca
    s_waitcnt lgkmcnt(1)
    v_mfma_f32_4x4x4_16b_bf16 v[80:83], v[10:11], v[70:71], v[80:83]
    s_waitcnt lgkmcnt(0)
    v_mfma_f32_4x4x4_16b_bf16 v[76:79], v[10:11], v[68:69], v[76:79]
    s_nop 2
    v_cvt_pk_bf16_f32 v80, v80, v81
    v_cvt_pk_bf16_f32 v81, v82, v83
    ds_wrxchg_rtn_b64 v[74:75], v95, v[80:81] offset:65408
    v_cvt_pk_bf16_f32 v76, v76, v77
    v_cvt_pk_bf16_f32 v77, v78, v79
    ds_wrxchg_rtn_b64 v[72:73], v94, v[76:77] offset:65408
    v_and_b32 v88, 0x0fffffff, v21
    buffer_load_dwordx2 v[16:17], v88, s[8:11], 0 offen
    buffer_load_dwordx3 v[18:20], v88, s[8:11], 0 offen offset:8
    s_setprio 2
    v_mfma_f32_4x4x4_16b_bf16 v[80:83], v[8:9], v[102:103], 0
    v_mfma_f32_4x4x4_16b_bf16 v[76:79], v[8:9], v[100:101], 0
    v_cmp_lt_u32 s[48:49], v5, v93
    s_nop 2
    v_pk_mul_f32 v[80:81], v[80:81], v[14:15] op_sel:[0,1] op_sel_hi:[1,1]
    v_pk_mul_f32 v[82:83], v[82:83], v[14:15] op_sel:[0,1] op_sel_hi:[1,1]
    v_pk_mul_f32 v[76:77], v[76:77], v[14:15] op_sel:[0,0] op_sel_hi:[1,0]
    v_pk_mul_f32 v[78:79], v[78:79], v[14:15] op_sel:[0,0] op_sel_hi:[1,0]
    s_waitcnt vmcnt(10)
    v_and_b32 v46, 0x20000000, v41
    v_lshrrev_b32 v47, 14, v23
    v_bitop3_b32 v47, v47, v5, v46 bitop3:0xea
    ds_read_b64 v[106:107], v47
    v_and_b32 v99, 0x10000000, v41
    v_lshrrev_b32 v47, 14, v22
    v_bitop3_b32 v47, v47, v5, v99 bitop3:0xea
    ds_read_b64 v[104:105], v47
    s_waitcnt lgkmcnt(2)
    v_cmp_ne_u64 s[50:51], v[72:73], v[68:69]
    v_cmpx_ne_u64 s[54:55], v[74:75], v[70:71]
    s_and_b64 s[82:83], s[54:55], s[80:81]
    s_cbranch_scc1 L2_c105
L2_d105:
    v_mov_b64 v[84:85], v[70:71]
    v_mov_b32 v7, v95
    v_mov_b64 v[86:87], v[74:75]
    s_or_b64 s[80:81], s[80:81], s[54:55]
    s_mov_b64 exec, s[50:51]
    s_and_b64 s[82:83], s[50:51], s[80:81]
    s_cbranch_scc1 L2_c106
L2_d106:
    v_mov_b64 v[84:85], v[68:69]
    v_mov_b32 v7, v94
    v_mov_b64 v[86:87], v[72:73]
    s_mov_b64 exec, -1
    s_or_b64 s[80:81], s[80:81], s[50:51]
    s_and_b64 exec, s[48:49], s[80:81]
    v_mfma_f32_4x4x4_16b_bf16 v[80:83], v[12:13], v[84:85], 0
    v_mov_b32 v93, v7
    s_andn2_b64 s[80:81], s[80:81], s[48:49]
    v_mfma_f32_4x4x4_16b_bf16 v[80:83], v[10:11], v[86:87], v[80:83]
    s_mov_b64 exec, -1
    ds_read_b64 v[70:71], v93 offset:65408
    ds_read_b64 v[68:69], v92 offset:65408
    v_bitop3_b32 v94, v22, v5, v99 bitop3:0xea
    v_bitop3_b32 v95, v23, v5, v46 bitop3:0xea
    v_perm_b32 v15, v23, v26, s45
    v_bitop3_b32 v46, v23, 0.5, -0.5 bitop3:0xa8
    v_perm_b32 v14, v22, v26, s44
    v_bitop3_b32 v47, v22, 0.5, -0.5 bitop3:0xa8
    v_bitop3_b32 v15, v6, v15, v46 bitop3:0xca
    v_bitop3_b32 v14, v6, v14, v47 bitop3:0xca
    s_waitcnt lgkmcnt(1)
    v_mfma_f32_4x4x4_16b_bf16 v[80:83], v[10:11], v[70:71], v[80:83]
    s_waitcnt lgkmcnt(0)
    v_mfma_f32_4x4x4_16b_bf16 v[76:79], v[10:11], v[68:69], v[76:79]
    s_nop 2
    v_cvt_pk_bf16_f32 v80, v80, v81
    v_cvt_pk_bf16_f32 v81, v82, v83
    ds_wrxchg_rtn_b64 v[74:75], v93, v[80:81] offset:65408
    v_cvt_pk_bf16_f32 v76, v76, v77
    v_cvt_pk_bf16_f32 v77, v78, v79
    ds_wrxchg_rtn_b64 v[72:73], v92, v[76:77] offset:65408
    s_setprio 1
    v_mfma_f32_4x4x4_16b_bf16 v[80:83], v[8:9], v[106:107], 0
    v_mfma_f32_4x4x4_16b_bf16 v[76:79], v[8:9], v[104:105], 0
    s_nop 3
    v_pk_mul_f32 v[80:81], v[80:81], v[14:15] op_sel:[0,1] op_sel_hi:[1,1]
    v_pk_mul_f32 v[82:83], v[82:83], v[14:15] op_sel:[0,1] op_sel_hi:[1,1]
    v_pk_mul_f32 v[76:77], v[76:77], v[14:15] op_sel:[0,0] op_sel_hi:[1,0]
    v_pk_mul_f32 v[78:79], v[78:79], v[14:15] op_sel:[0,0] op_sel_hi:[1,0]
    s_bitcmp1_b32 s43, s42
    s_cbranch_scc1 L2_oa107
L2_ob107:
    buffer_load_dwordx4 v[112:115], v3, s[16:19], s40 offen offset:1024 sc1
    v_sub_u16 v88, v62, v54
    v_and_b32 v89, 3, v54
    v_add3_u32 v99, v88, v89, 3
    v_and_b32 v99, -4, v99
    v_max_u32 v99, 4, v99
    v_and_b32 v97, 0xfffc, v54
    v_bfm_b32 v96, v88, v89
    v_add_u32_dpp v91, v99, v99 row_shr:1 row_mask:0xf bank_mask:0xf bound_ctrl:1
    v_mad_u32_u24 v97, v97, 5, v2
    v_cmp_lt_u32 vcc, 16, v99
    v_add_u32_dpp v91, v91, v91 row_shr:2 row_mask:0xf bank_mask:0xf bound_ctrl:1
    v_sub_u32 v98, s38, v99
    v_lshrrev_b64 v[54:55], 16, v[54:55]
    v_add_u32_dpp v91, v91, v91 row_shr:4 row_mask:0xf bank_mask:0xf bound_ctrl:1
    v_lshrrev_b64 v[62:63], 16, v[62:63]
    s_mov_b32 s101, 0
    v_add_u32_dpp v91, v91, v91 row_shr:8 row_mask:0xf bank_mask:0xf bound_ctrl:1
    s_nop 1
    v_add_u32_dpp v91, v91, v91 row_bcast:15 row_mask:0xa bank_mask:0xf
    s_nop 1
    v_add_u32_dpp v91, v91, v91 row_bcast:31 row_mask:0xc bank_mask:0xf
    v_add_u32 v98, v98, v91
    v_readlane_b32 s37, v91, 63
    s_cbranch_vccnz L2_xo108
L2_xp108:
    v_and_b32 v46, 0x80000000, v41
    v_lshrrev_b32 v47, 14, v25
    v_bitop3_b32 v47, v47, v5, v46 bitop3:0xea
    ds_read_b64 v[102:103], v47
    v_and_b32 v99, 0x40000000, v41
    v_lshrrev_b32 v47, 14, v24
    v_bitop3_b32 v47, v47, v5, v99 bitop3:0xea
    ds_read_b64 v[100:101], v47
    s_waitcnt lgkmcnt(2)
    v_cmp_ne_u64 s[50:51], v[72:73], v[68:69]
    v_cmpx_ne_u64 s[54:55], v[74:75], v[70:71]
    s_and_b64 s[82:83], s[54:55], s[80:81]
    s_cbranch_scc1 L2_c109
L2_d109:
    v_mov_b64 v[84:85], v[70:71]
    v_mov_b32 v7, v93
    v_mov_b64 v[86:87], v[74:75]
    s_or_b64 s[80:81], s[80:81], s[54:55]
    s_mov_b64 exec, s[50:51]
    s_and_b64 s[82:83], s[50:51], s[80:81]
    s_cbranch_scc1 L2_c110
L2_d110:
    v_mov_b64 v[84:85], v[68:69]
    v_mov_b32 v7, v92
    v_mov_b64 v[86:87], v[72:73]
    s_mov_b64 exec, -1
    s_or_b64 s[80:81], s[80:81], s[50:51]
    ds_read_b64 v[70:71], v95 offset:65408
    ds_read_b64 v[68:69], v94 offset:65408
    v_bitop3_b32 v92, v24, v5, v99 bitop3:0xea
    v_bitop3_b32 v93, v25, v5, v46 bitop3:0xea
    v_perm_b32 v15, v25, v26, s47
    v_bitop3_b32 v46, v25, 0.5, -0.5 bitop3:0xa8
    v_perm_b32 v14, v24, v26, s46
    v_bitop3_b32 v47, v24, 0.5, -0.5 bitop3:0xa8
    v_bitop3_b32 v15, v6, v15, v46 bitop3:0xca
    v_bitop3_b32 v14, v6, v14, v47 bitop3:0xca
    s_waitcnt lgkmcnt(1)
    v_mfma_f32_4x4x4_16b_bf16 v[80:83], v[10:11], v[70:71], v[80:83]
    s_waitcnt lgkmcnt(0)
    v_mfma_f32_4x4x4_16b_bf16 v[76:79], v[10:11], v[68:69], v[76:79]
    s_nop 2
    v_cvt_pk_bf16_f32 v80, v80, v81
    v_cvt_pk_bf16_f32 v81, v82, v83
    ds_wrxchg_rtn_b64 v[74:75], v95, v[80:81] offset:65408
    v_cvt_pk_bf16_f32 v76, v76, v77
    v_cvt_pk_bf16_f32 v77, v78, v79
    ds_wrxchg_rtn_b64 v[72:73], v94, v[76:77] offset:65408
    v_and_b32 v88, 0x0fffffff, v27
    buffer_load_dwordx2 v[22:23], v88, s[8:11], 0 offen
    buffer_load_dwordx3 v[24:26], v88, s[8:11], 0 offen offset:8
    v_mfma_f32_4x4x4_16b_bf16 v[80:83], v[8:9], v[102:103], 0
    v_mfma_f32_4x4x4_16b_bf16 v[76:79], v[8:9], v[100:101], 0
    v_cmp_lt_u32 s[84:85], v5, v92
    s_nop 2
    v_pk_mul_f32 v[80:81], v[80:81], v[14:15] op_sel:[0,1] op_sel_hi:[1,1]
    v_pk_mul_f32 v[82:83], v[82:83], v[14:15] op_sel:[0,1] op_sel_hi:[1,1]
    v_pk_mul_f32 v[76:77], v[76:77], v[14:15] op_sel:[0,0] op_sel_hi:[1,0]
    v_pk_mul_f32 v[78:79], v[78:79], v[14:15] op_sel:[0,0] op_sel_hi:[1,0]
    s_waitcnt vmcnt(11)
    s_mov_b64 exec, s[6:7]
    v_lshrrev_b32 v30, 16, v30
    s_mov_b64 exec, -1
    v_and_b32 v46, 0x20000000, v42
    v_lshrrev_b32 v47, 14, v29
    v_bitop3_b32 v47, v47, v5, v46 bitop3:0xea
    ds_read_b64 v[106:107], v47
    v_and_b32 v99, 0x10000000, v42
    v_lshrrev_b32 v47, 14, v28
    v_bitop3_b32 v47, v47, v5, v99 bitop3:0xea
    ds_read_b64 v[104:105], v47
    s_waitcnt lgkmcnt(2)
    v_cmp_ne_u64 s[50:51], v[72:73], v[68:69]
    v_cmpx_ne_u64 s[54:55], v[74:75], v[70:71]
    s_and_b64 s[82:83], s[54:55], s[80:81]
    s_cbranch_scc1 L2_c111
L2_d111:
    v_mov_b64 v[84:85], v[70:71]
    v_mov_b32 v7, v95
    v_mov_b64 v[86:87], v[74:75]
    s_or_b64 s[80:81], s[80:81], s[54:55]
    s_mov_b64 exec, s[50:51]
    s_and_b64 s[82:83], s[50:51], s[80:81]
    s_cbranch_scc1 L2_c112
L2_d112:
    v_mov_b64 v[84:85], v[68:69]
    v_mov_b32 v7, v94
    v_mov_b64 v[86:87], v[72:73]
    s_mov_b64 exec, -1
    s_or_b64 s[80:81], s[80:81], s[50:51]
    s_and_b64 exec, s[84:85], s[80:81]
    v_mfma_f32_4x4x4_16b_bf16 v[76:79], v[12:13], v[84:85], 0
    v_mov_b32 v92, v7
    s_andn2_b64 s[80:81], s[80:81], s[84:85]
    v_mfma_f32_4x4x4_16b_bf16 v[76:79], v[10:11], v[86:87], v[76:79]
    s_mov_b64 exec, -1
    ds_read_b64 v[70:71], v93 offset:65408
    ds_read_b64 v[68:69], v92 offset:65408
    v_bitop3_b32 v94, v28, v5, v99 bitop3:0xea
    v_bitop3_b32 v95, v29, v5, v46 bitop3:0xea
    v_perm_b32 v15, v29, v30, s45
    v_bitop3_b32 v46, v29, 0.5, -0.5 bitop3:0xa8
    v_perm_b32 v14, v28, v30, s44
    v_bitop3_b32 v47, v28, 0.5, -0.5 bitop3:0xa8
    v_bitop3_b32 v15, v6, v15, v46 bitop3:0xca
    v_bitop3_b32 v14, v6, v14, v47 bitop3:0xca
    s_waitcnt lgkmcnt(1)
    v_mfma_f32_4x4x4_16b_bf16 v[80:83], v[10:11], v[70:71], v[80:83]
    s_waitcnt lgkmcnt(0)
    v_mfma_f32_4x4x4_16b_bf16 v[76:79], v[10:11], v[68:69], v[76:79]
    s_nop 2
    v_cvt_pk_bf16_f32 v80, v80, v81
    v_cvt_pk_bf16_f32 v81, v82, v83
    ds_wrxchg_rtn_b64 v[74:75], v93, v[80:81] offset:65408
    v_cvt_pk_bf16_f32 v76, v76, v77
    v_cvt_pk_bf16_f32 v77, v78, v79
    ds_wrxchg_rtn_b64 v[72:73], v92, v[76:77] offset:65408
    s_setprio 0
    v_mfma_f32_4x4x4_16b_bf16 v[80:83], v[8:9], v[106:107], 0
    v_mfma_f32_4x4x4_16b_bf16 v[76:79], v[8:9], v[104:105], 0
    v_cmp_lt_u32 s[48:49], v5, v95
    s_nop 2
    v_pk_mul_f32 v[80:81], v[80:81], v[14:15] op_sel:[0,1] op_sel_hi:[1,1]
    v_pk_mul_f32 v[82:83], v[82:83], v[14:15] op_sel:[0,1] op_sel_hi:[1,1]
    v_pk_mul_f32 v[76:77], v[76:77], v[14:15] op_sel:[0,0] op_sel_hi:[1,0]
    v_pk_mul_f32 v[78:79], v[78:79], v[14:15] op_sel:[0,0] op_sel_hi:[1,0]
    s_add_u32 s40, s40, 0x50000
    v_and_b32 v47, 0x0fffffff, v31
    buffer_load_dword v30, v47, s[8:11], 0 offen offset:16
    s_mov_b64 exec, s[6:7]
    v_add_u32 v47, 8, v47
    v_lshrrev_b32 v31, 2, v31
    s_mov_b64 exec, -1
    buffer_load_dwordx2 v[28:29], v47, s[8:11], 0 offen
    s_waitcnt vmcnt(8)
    v_and_b32 v46, 0x80000000, v43
    v_lshrrev_b32 v47, 14, v37
    v_bitop3_b32 v47, v47, v5, v46 bitop3:0xea
    ds_read_b64 v[106:107], v47
    v_and_b32 v99, 0x40000000, v43
    v_lshrrev_b32 v47, 14, v36
    v_bitop3_b32 v47, v47, v5, v99 bitop3:0xea
    ds_read_b64 v[104:105], v47
    v_and_b32 v46, 0x20000000, v43
    v_lshrrev_b32 v47, 14, v35
    v_bitop3_b32 v47, v47, v5, v46 bitop3:0xea
    ds_read_b64 v[102:103], v47
    v_and_b32 v99, 0x10000000, v43
    v_lshrrev_b32 v47, 14, v34
    v_bitop3_b32 v47, v47, v5, v99 bitop3:0xea
    ds_read_b64 v[100:101], v47
    s_waitcnt lgkmcnt(4)
    v_cmp_ne_u64 s[50:51], v[72:73], v[68:69]
    v_cmpx_ne_u64 s[54:55], v[74:75], v[70:71]
    s_and_b64 s[82:83], s[54:55], s[80:81]
    s_cbranch_scc1 L2_c113
L2_d113:
    v_mov_b64 v[84:85], v[70:71]
    v_mov_b32 v7, v93
    v_mov_b64 v[86:87], v[74:75]
    s_or_b64 s[80:81], s[80:81], s[54:55]
    s_mov_b64 exec, s[50:51]
    s_and_b64 s[82:83], s[50:51], s[80:81]
    s_cbranch_scc1 L2_c114
L2_d114:
    v_mov_b64 v[84:85], v[68:69]
    v_mov_b32 v7, v92
    v_mov_b64 v[86:87], v[72:73]
    s_mov_b64 exec, -1
    s_or_b64 s[80:81], s[80:81], s[50:51]
    s_and_b64 exec, s[48:49], s[80:81]
    v_mfma_f32_4x4x4_16b_bf16 v[80:83], v[12:13], v[84:85], 0
    v_mov_b32 v95, v7
    s_andn2_b64 s[80:81], s[80:81], s[48:49]
    v_mfma_f32_4x4x4_16b_bf16 v[80:83], v[10:11], v[86:87], v[80:83]
    s_mov_b64 exec, -1
    ds_read_b64 v[70:71], v95 offset:65408
    ds_read_b64 v[68:69], v94 offset:65408
    v_bitop3_b32 v92, v34, v5, v99 bitop3:0xea
    v_bitop3_b32 v93, v35, v5, v46 bitop3:0xea
    v_perm_b32 v15, v35, v38, s45
    v_bitop3_b32 v46, v35, 0.5, -0.5 bitop3:0xa8
    v_perm_b32 v14, v34, v38, s44
    v_bitop3_b32 v47, v34, 0.5, -0.5 bitop3:0xa8
    v_bitop3_b32 v15, v6, v15, v46 bitop3:0xca
    v_bitop3_b32 v14, v6, v14, v47 bitop3:0xca
    s_waitcnt lgkmcnt(1)
    v_mfma_f32_4x4x4_16b_bf16 v[80:83], v[10:11], v[70:71], v[80:83]
    s_waitcnt lgkmcnt(0)
    v_mfma_f32_4x4x4_16b_bf16 v[76:79], v[10:11], v[68:69], v[76:79]
    s_nop 2
    v_cvt_pk_bf16_f32 v80, v80, v81
    v_cvt_pk_bf16_f32 v81, v82, v83
    ds_wrxchg_rtn_b64 v[74:75], v95, v[80:81] offset:65408
    v_cvt_pk_bf16_f32 v76, v76, v77
    v_cvt_pk_bf16_f32 v77, v78, v79
    ds_wrxchg_rtn_b64 v[72:73], v94, v[76:77] offset:65408
    s_barrier
    s_setprio 3
    s_mov_b32 m0, s100
    s_nop 0
    ds_write_addtid_b32 v124 offset:34816
    ds_write_addtid_b32 v125 offset:35072
    ds_write_addtid_b32 v126 offset:35328
    ds_write_addtid_b32 v127 offset:35584
    s_add_u32 s3, s40, 4096
    buffer_load_dwordx4 v[124:127], v3, s[16:19], s3 offen sc1
    ds_write_addtid_b32 v116 offset:32768
    ds_write_addtid_b32 v117 offset:33024
    ds_write_addtid_b32 v118 offset:33280
    ds_write_addtid_b32 v119 offset:33536
    buffer_load_dwordx4 v[116:119], v3, s[16:19], s40 offen offset:2048 sc1
    ds_write_addtid_b32 v120 offset:33792
    ds_write_addtid_b32 v121 offset:34048
    ds_write_addtid_b32 v122 offset:34304
    ds_write_addtid_b32 v123 offset:34560
    buffer_load_dwordx4 v[120:123], v3, s[16:19], s40 offen offset:3072 sc1
    v_mfma_f32_4x4x4_16b_bf16 v[80:83], v[8:9], v[102:103], 0
    v_mfma_f32_4x4x4_16b_bf16 v[76:79], v[8:9], v[100:101], 0
    s_nop 3
    v_pk_mul_f32 v[80:81], v[80:81], v[14:15] op_sel:[0,1] op_sel_hi:[1,1]
    v_pk_mul_f32 v[82:83], v[82:83], v[14:15] op_sel:[0,1] op_sel_hi:[1,1]
    v_pk_mul_f32 v[76:77], v[76:77], v[14:15] op_sel:[0,0] op_sel_hi:[1,0]
    v_pk_mul_f32 v[78:79], v[78:79], v[14:15] op_sel:[0,0] op_sel_hi:[1,0]
    s_cmp_gt_u32 s37, 1024
    s_cbranch_scc1 L2_xs115
    s_cmp_lg_u32 s101, 0
    s_cbranch_scc1 L2_xa115
L2_xb115:
    v_lshlrev_b32 v89, 16, v96
    v_add_u32 v90, 60, v97
    v_bitop3_b32 v90, v89, v45, v90 bitop3:0x6a
    ds_write_b32 v98, v90 offset:12
    v_lshlrev_b32 v89, 20, v96
    v_add_u32 v90, 40, v97
    v_bitop3_b32 v90, v89, v45, v90 bitop3:0x6a
    ds_write_b32 v98, v90 offset:8
    v_lshlrev_b32 v89, 24, v96
    v_add_u32 v90, 20, v97
    v_bitop3_b32 v90, v89, v45, v90 bitop3:0x6a
    ds_write_b32 v98, v90 offset:4
    v_lshlrev_b32 v89, 28, v96
    v_bitop3_b32 v90, v89, v45, v97 bitop3:0x6a
    ds_write_b32 v98, v90 offset:0
    v_mov_b32_dpp v91, v66 quad_perm:[1,1,1,1] row_mask:0xf bank_mask:0xf
    v_and_b32 v89, 3, v91
    v_and_b32 v97, 0xfffc, v91
    v_sub_u16_dpp v88, v66, v91 quad_perm:[3,3,3,3] row_mask:0xf bank_mask:0xf
    v_mad_u32_u24 v97, v97, 5, v4
    v_add_u32 v99, v88, v89
    v_bfm_b32 v96, v88, v89
    v_cmp_lt_u32 s[58:59], 16, v99
    v_lshlrev_b32 v89, v1, v96
    v_and_b32 v89, v45, v89
    v_cmp_ne_u32 vcc, 0, v89
    v_xor_b32 v90, v97, v89
    s_add_u32 s3, s37, s38
    v_mbcnt_lo_u32_b32 v98, vcc_lo, 0
    v_mbcnt_hi_u32_b32 v98, vcc_hi, v98
    s_bcnt1_i32_b64 s41, vcc
    v_lshl_add_u32 v98, v98, 2, s3
    s_lshl2_add_u32 s37, s41, s37
    s_mov_b64 exec, vcc
    ds_write_b32 v98, v90
    s_mov_b64 exec, -1
    s_cmp_lg_u64 s[58:59], 0
    s_cbranch_scc1 L2_xe115
L2_xr115:
    v_add_u32 v98, s37, v0
    v_mov_b32 v90, -1
    ds_write_b32 v98, v90
L2_xw115:
    s_setprio 2
    s_waitcnt lgkmcnt(14)
    v_cmp_ne_u64 s[50:51], v[72:73], v[68:69]
    v_cmpx_ne_u64 s[54:55], v[74:75], v[70:71]
    s_and_b64 s[82:83], s[54:55], s[80:81]
    s_cbranch_scc1 L2_c116
L2_d116:
    v_mov_b64 v[84:85], v[70:71]
    v_mov_b32 v7, v95
    v_mov_b64 v[86:87], v[74:75]
    s_or_b64 s[80:81], s[80:81], s[54:55]
    s_mov_b64 exec, s[50:51]
    s_and_b64 s[82:83], s[50:51], s[80:81]
    s_cbranch_scc1 L2_c117
L2_d117:
    v_mov_b64 v[84:85], v[68:69]
    v_mov_b32 v7, v94
    v_mov_b64 v[86:87], v[72:73]
    s_mov_b64 exec, -1
    s_or_b64 s[80:81], s[80:81], s[50:51]
    ds_read_b64 v[70:71], v93 offset:65408
    ds_read_b64 v[68:69], v92 offset:65408
    v_and_b32 v46, 0x40000000, v43
    v_bitop3_b32 v94, v36, v5, v46 bitop3:0xea
    v_and_b32 v46, 0x80000000, v43
    v_bitop3_b32 v95, v37, v5, v46 bitop3:0xea
    v_perm_b32 v15, v37, v38, s47
    v_bitop3_b32 v46, v37, 0.5, -0.5 bitop3:0xa8
    v_perm_b32 v14, v36, v38, s46
    v_bitop3_b32 v47, v36, 0.5, -0.5 bitop3:0xa8
    v_bitop3_b32 v15, v6, v15, v46 bitop3:0xca
    v_bitop3_b32 v14, v6, v14, v47 bitop3:0xca
    s_setprio 1
    s_waitcnt lgkmcnt(1)
    v_mfma_f32_4x4x4_16b_bf16 v[80:83], v[10:11], v[70:71], v[80:83]
    s_waitcnt lgkmcnt(0)
    v_mfma_f32_4x4x4_16b_bf16 v[76:79], v[10:11], v[68:69], v[76:79]
    s_nop 2
    v_cvt_pk_bf16_f32 v80, v80, v81
    v_cvt_pk_bf16_f32 v81, v82, v83
    ds_wrxchg_rtn_b64 v[74:75], v93, v[80:81] offset:65408
    v_cvt_pk_bf16_f32 v76, v76, v77
    v_cvt_pk_bf16_f32 v77, v78, v79
    ds_wrxchg_rtn_b64 v[72:73], v92, v[76:77] offset:65408
    ds_read_b32 v40, v0 offset:0
    ds_read_b32 v41, v0 offset:256
    ds_read_b32 v42, v44 offset:768
    ds_read_b32 v43, v0 offset:512
    s_sub_u32 s3, s37, 768
    s_cmp_gt_u32 s3, 128
    s_cbranch_scc1 L2_xf115
L2_xg115:
    v_lshrrev_b64 v[64:65], 16, v[64:65]
    v_lshrrev_b64 v[66:67], 16, v[66:67]
    v_and_b32 v88, 0x0fffffff, v39
    buffer_load_dwordx2 v[34:35], v88, s[8:11], 0 offen
    buffer_load_dwordx3 v[36:38], v88, s[8:11], 0 offen offset:8
    s_setprio 0
    s_waitcnt vmcnt(12)
    s_mov_b32 m0, s38
    s_nop 0
    ds_write_addtid_b32 v108 offset:0
    ds_write_addtid_b32 v109 offset:256
    ds_write_addtid_b32 v110 offset:512
    ds_write_addtid_b32 v111 offset:768
    s_waitcnt vmcnt(9)
    ds_write_addtid_b32 v112 offset:1024
    ds_write_addtid_b32 v113 offset:1280
    ds_write_addtid_b32 v114 offset:1536
    ds_write_addtid_b32 v115 offset:1792
    v_mfma_f32_4x4x4_16b_bf16 v[80:83], v[8:9], v[106:107], 0
    v_mfma_f32_4x4x4_16b_bf16 v[76:79], v[8:9], v[104:105], 0
    v_cmp_lt_u32 s[84:85], v5, v94
    s_nop 2
    v_pk_mul_f32 v[80:81], v[80:81], v[14:15] op_sel:[0,1] op_sel_hi:[1,1]
    v_pk_mul_f32 v[82:83], v[82:83], v[14:15] op_sel:[0,1] op_sel_hi:[1,1]
    v_pk_mul_f32 v[76:77], v[76:77], v[14:15] op_sel:[0,0] op_sel_hi:[1,0]
    v_pk_mul_f32 v[78:79], v[78:79], v[14:15] op_sel:[0,0] op_sel_hi:[1,0]
    s_add_u32 s42, s42, 1
    s_waitcnt lgkmcnt(0)
    s_cmp_lg_u32 s42, 14
    s_cbranch_scc1 L2_loop
    s_barrier
    s_bitcmp1_b32 s36, s42
    s_cbranch_scc1 L2_slow
L2_ret6:
    s_setprio 3
    s_bitcmp1_b32 s43, s42
    s_cbranch_scc1 L2_oa118
L2_ob118:
    v_and_b32 v46, 0x20000000, v21
    v_lshrrev_b32 v47, 14, v17
    v_bitop3_b32 v47, v47, v5, v46 bitop3:0xea
    ds_read_b64 v[102:103], v47
    v_and_b32 v99, 0x10000000, v21
    v_lshrrev_b32 v47, 14, v16
    v_bitop3_b32 v47, v47, v5, v99 bitop3:0xea
    ds_read_b64 v[100:101], v47
    v_cmp_ne_u64 s[50:51], v[72:73], v[68:69]
    v_cmpx_ne_u64 s[54:55], v[74:75], v[70:71]
    s_and_b64 s[82:83], s[54:55], s[80:81]
    s_cbranch_scc1 L2_c119
L2_d119:
    v_mov_b64 v[84:85], v[70:71]
    v_mov_b32 v7, v93
    v_mov_b64 v[86:87], v[74:75]
    s_or_b64 s[80:81], s[80:81], s[54:55]
    s_mov_b64 exec, s[50:51]
    s_and_b64 s[82:83], s[50:51], s[80:81]
    s_cbranch_scc1 L2_c120
L2_d120:
    v_mov_b64 v[84:85], v[68:69]
    v_mov_b32 v7, v92
    v_mov_b64 v[86:87], v[72:73]
    s_mov_b64 exec, -1
    s_or_b64 s[80:81], s[80:81], s[50:51]
    s_and_b64 exec, s[84:85], s[80:81]
    v_mfma_f32_4x4x4_16b_bf16 v[76:79], v[12:13], v[84:85], 0
    v_mov_b32 v94, v7
    s_andn2_b64 s[80:81], s[80:81], s[84:85]
    v_mfma_f32_4x4x4_16b_bf16 v[76:79], v[10:11], v[86:87], v[76:79]
    s_mov_b64 exec, -1
    ds_read_b64 v[70:71], v95 offset:65408
    ds_read_b64 v[68:69], v94 offset:65408
    v_bitop3_b32 v92, v16, v5, v99 bitop3:0xea
    v_bitop3_b32 v93, v17, v5, v46 bitop3:0xea
    v_perm_b32 v15, v17, v20, s45
    v_bitop3_b32 v46, v17, 0.5, -0.5 bitop3:0xa8
    v_perm_b32 v14, v16, v20, s44
    v_bitop3_b32 v47, v16, 0.5, -0.5 bitop3:0xa8
    v_bitop3_b32 v15, v6, v15, v46 bitop3:0xca
    v_bitop3_b32 v14, v6, v14, v47 bitop3:0xca
    s_waitcnt lgkmcnt(1)
    v_mfma_f32_4x4x4_16b_bf16 v[80:83], v[10:11], v[70:71], v[80:83]
    s_waitcnt lgkmcnt(0)
    v_mfma_f32_4x4x4_16b_bf16 v[76:79], v[10:11], v[68:69], v[76:79]
    s_nop 2
    v_cvt_pk_bf16_f32 v80, v80, v81
    v_cvt_pk_bf16_f32 v81, v82, v83
    ds_wrxchg_rtn_b64 v[74:75], v95, v[80:81] offset:65408
    v_cvt_pk_bf16_f32 v76, v76, v77
    v_cvt_pk_bf16_f32 v77, v78, v79
    ds_wrxchg_rtn_b64 v[72:73], v94, v[76:77] offset:65408
    v_mfma_f32_4x4x4_16b_bf16 v[80:83], v[8:9], v[102:103], 0
    v_mfma_f32_4x4x4_16b_bf16 v[76:79], v[8:9], v[100:101], 0
    v_cmp_lt_u32 s[84:85], v5, v92
    s_nop 2
    v_pk_mul_f32 v[80:81], v[80:81], v[14:15] op_sel:[0,1] op_sel_hi:[1,1]
    v_pk_mul_f32 v[82:83], v[82:83], v[14:15] op_sel:[0,1] op_sel_hi:[1,1]
    v_pk_mul_f32 v[76:77], v[76:77], v[14:15] op_sel:[0,0] op_sel_hi:[1,0]
    v_pk_mul_f32 v[78:79], v[78:79], v[14:15] op_sel:[0,0] op_sel_hi:[1,0]
    buffer_load_dwordx4 v[108:111], v3, s[16:19], s40 offen offset:0 sc1
    v_and_b32 v46, 0x80000000, v21
    v_lshrrev_b32 v47, 14, v19
    v_bitop3_b32 v47, v47, v5, v46 bitop3:0xea
    ds_read_b64 v[106:107], v47
    v_and_b32 v99, 0x40000000, v21
    v_lshrrev_b32 v47, 14, v18
    v_bitop3_b32 v47, v47, v5, v99 bitop3:0xea
    ds_read_b64 v[104:105], v47
    s_waitcnt lgkmcnt(2)
    v_cmp_ne_u64 s[50:51], v[72:73], v[68:69]
    v_cmpx_ne_u64 s[54:55], v[74:75], v[70:71]
    s_and_b64 s[82:83], s[54:55], s[80:81]
    s_cbranch_scc1 L2_c121
L2_d121:
    v_mov_b64 v[84:85], v[70:71]
    v_mov_b32 v7, v95
    v_mov_b64 v[86:87], v[74:75]
    s_or_b64 s[80:81], s[80:81], s[54:55]
    s_mov_b64 exec, s[50:51]
    s_and_b64 s[82:83], s[50:51], s[80:81]
    s_cbranch_scc1 L2_c122
L2_d122:
    v_mov_b64 v[84:85], v[68:69]
    v_mov_b32 v7, v94
    v_mov_b64 v[86:87], v[72:73]
    s_mov_b64 exec, -1
    s_or_b64 s[80:81], s[80:81], s[50:51]
    s_and_b64 exec, s[84:85], s[80:81]
    v_mfma_f32_4x4x4_16b_bf16 v[76:79], v[12:13], v[84:85], 0
    v_mov_b32 v92, v7
    s_andn2_b64 s[80:81], s[80:81], s[84:85]
    v_mfma_f32_4x4x4_16b_bf16 v[76:79], v[10:11], v[86:87], v[76:79]
    s_mov_b64 exec, -1
    ds_read_b64 v[70:71], v93 offset:65408
    ds_read_b64 v[68:69], v92 offset:65408
    v_bitop3_b32 v94, v18, v5, v99 bitop3:0xea
    v_bitop3_b32 v95, v19, v5, v46 bitop3:0xea
    v_perm_b32 v15, v19, v20, s47
    v_bitop3_b32 v46, v19, 0.5, -0.5 bitop3:0xa8
    v_perm_b32 v14, v18, v20, s46
    v_bitop3_b32 v47, v18, 0.5, -0.5 bitop3:0xa8
    v_bitop3_b32 v15, v6, v15, v46 bitop3:0xca
    v_bitop3_b32 v14, v6, v14, v47 bitop3:0xca
    s_waitcnt lgkmcnt(1)
    v_mfma_f32_4x4x4_16b_bf16 v[80:83], v[10:11], v[70:71], v[80:83]
    s_waitcnt lgkmcnt(0)
    v_mfma_f32_4x4x4_16b_bf16 v[76:79], v[10:11], v[68:69], v[76:79]
    s_nop 2
    v_cvt_pk_bf16_f32 v80, v80, v81
    v_cvt_pk_bf16_f32 v81, v82, v83
    ds_wrxchg_rtn_b64 v[74:75], v93, v[80:81] offset:65408
    v_cvt_pk_bf16_f32 v76, v76, v77
    v_cvt_pk_bf16_f32 v77, v78, v79
    ds_wrxchg_rtn_b64 v[72:73], v92, v[76:77] offset:65408
    v_and_b32 v88, 0x0fffffff, v40
    buffer_load_dwordx2 v[16:17], v88, s[8:11], 0 offen
    buffer_load_dwordx3 v[18:20], v88, s[8:11], 0 offen offset:8
    s_setprio 2
    v_mfma_f32_4x4x4_16b_bf16 v[80:83], v[8:9], v[106:107], 0
    v_mfma_f32_4x4x4_16b_bf16 v[76:79], v[8:9], v[104:105], 0
    v_cmp_lt_u32 s[48:49], v5, v95
    s_nop 2
    v_pk_mul_f32 v[80:81], v[80:81], v[14:15] op_sel:[0,1] op_sel_hi:[1,1]
    v_pk_mul_f32 v[82:83], v[82:83], v[14:15] op_sel:[0,1] op_sel_hi:[1,1]
    v_pk_mul_f32 v[76:77], v[76:77], v[14:15] op_sel:[0,0] op_sel_hi:[1,0]
    v_pk_mul_f32 v[78:79], v[78:79], v[14:15] op_sel:[0,0] op_sel_hi:[1,0]
    s_waitcnt vmcnt(10)
    v_and_b32 v46, 0x20000000, v27
    v_lshrrev_b32 v47, 14, v23
    v_bitop3_b32 v47, v47, v5, v46 bitop3:0xea
    ds_read_b64 v[102:103], v47
    v_and_b32 v99, 0x10000000, v27
    v_lshrrev_b32 v47, 14, v22
    v_bitop3_b32 v47, v47, v5, v99 bitop3:0xea
    ds_read_b64 v[100:101], v47
    s_waitcnt lgkmcnt(2)
    v_cmp_ne_u64 s[50:51], v[72:73], v[68:69]
    v_cmpx_ne_u64 s[54:55], v[74:75], v[70:71]
    s_and_b64 s[82:83], s[54:55], s[80:81]
    s_cbranch_scc1 L2_c123
L2_d123:
    v_mov_b64 v[84:85], v[70:71]
    v_mov_b32 v7, v93
    v_mov_b64 v[86:87], v[74:75]
    s_or_b64 s[80:81], s[80:81], s[54:55]
    s_mov_b64 exec, s[50:51]
    s_and_b64 s[82:83], s[50:51], s[80:81]
    s_cbranch_scc1 L2_c124
L2_d124:
    v_mov_b64 v[84:85], v[68:69]
    v_mov_b32 v7, v92
    v_mov_b64 v[86:87], v[72:73]
    s_mov_b64 exec, -1
    s_or_b64 s[80:81], s[80:81], s[50:51]
    s_and_b64 exec, s[48:49], s[80:81]
    v_mfma_f32_4x4x4_16b_bf16 v[80:83], v[12:13], v[84:85], 0
    v_mov_b32 v95, v7
    s_andn2_b64 s[80:81], s[80:81], s[48:49]
    v_mfma_f32_4x4x4_16b_bf16 v[80:83], v[10:11], v[86:87], v[80:83]
    s_mov_b64 exec, -1
    ds_read_b64 v[70:71], v95 offset:65408
    ds_read_b64 v[68:69], v94 offset:65408
    v_bitop3_b32 v92, v22, v5, v99 bitop3:0xea
    v_bitop3_b32 v93, v23, v5, v46 bitop3:0xea
    v_perm_b32 v15, v23, v26, s45
    v_bitop3_b32 v46, v23, 0.5, -0.5 bitop3:0xa8
    v_perm_b32 v14, v22, v26, s44
    v_bitop3_b32 v47, v22, 0.5, -0.5 bitop3:0xa8
    v_bitop3_b32 v15, v6, v15, v46 bitop3:0xca
    v_bitop3_b32 v14, v6, v14, v47 bitop3:0xca
    s_waitcnt lgkmcnt(1)
    v_mfma_f32_4x4x4_16b_bf16 v[80:83], v[10:11], v[70:71], v[80:83]
    s_waitcnt lgkmcnt(0)
    v_mfma_f32_4x4x4_16b_bf16 v[76:79], v[10:11], v[68:69], v[76:79]
    s_nop 2
    v_cvt_pk_bf16_f32 v80, v80, v81
    v_cvt_pk_bf16_f32 v81, v82, v83
    ds_wrxchg_rtn_b64 v[74:75], v95, v[80:81] offset:65408
    v_cvt_pk_bf16_f32 v76, v76, v77
    v_cvt_pk_bf16_f32 v77, v78, v79
    ds_wrxchg_rtn_b64 v[72:73], v94, v[76:77] offset:65408
    s_setprio 1
    v_mfma_f32_4x4x4_16b_bf16 v[80:83], v[8:9], v[102:103], 0
    v_mfma_f32_4x4x4_16b_bf16 v[76:79], v[8:9], v[100:101], 0
    s_nop 3
    v_pk_mul_f32 v[80:81], v[80:81], v[14:15] op_sel:[0,1] op_sel_hi:[1,1]
    v_pk_mul_f32 v[82:83], v[82:83], v[14:15] op_sel:[0,1] op_sel_hi:[1,1]
    v_pk_mul_f32 v[76:77], v[76:77], v[14:15] op_sel:[0,0] op_sel_hi:[1,0]
    v_pk_mul_f32 v[78:79], v[78:79], v[14:15] op_sel:[0,0] op_sel_hi:[1,0]
    s_bitcmp1_b32 s43, s42
    s_cbranch_scc1 L2_oa125
L2_ob125:
    buffer_load_dwordx4 v[112:115], v3, s[16:19], s40 offen offset:1024 sc1
    v_and_b32 v46, 0x80000000, v27
    v_lshrrev_b32 v47, 14, v25
    v_bitop3_b32 v47, v47, v5, v46 bitop3:0xea
    ds_read_b64 v[106:107], v47
    v_and_b32 v99, 0x40000000, v27
    v_lshrrev_b32 v47, 14, v24
    v_bitop3_b32 v47, v47, v5, v99 bitop3:0xea
    ds_read_b64 v[104:105], v47
    s_waitcnt lgkmcnt(2)
    v_cmp_ne_u64 s[50:51], v[72:73], v[68:69]
    v_cmpx_ne_u64 s[54:55], v[74:75], v[70:71]
    s_and_b64 s[82:83], s[54:55], s[80:81]
    s_cbranch_scc1 L2_c126
L2_d126:
    v_mov_b64 v[84:85], v[70:71]
    v_mov_b32 v7, v95
    v_mov_b64 v[86:87], v[74:75]
    s_or_b64 s[80:81], s[80:81], s[54:55]
    s_mov_b64 exec, s[50:51]
    s_and_b64 s[82:83], s[50:51], s[80:81]
    s_cbranch_scc1 L2_c127
L2_d127:
    v_mov_b64 v[84:85], v[68:69]
    v_mov_b32 v7, v94
    v_mov_b64 v[86:87], v[72:73]
    s_mov_b64 exec, -1
    s_or_b64 s[80:81], s[80:81], s[50:51]
    ds_read_b64 v[70:71], v93 offset:65408
    ds_read_b64 v[68:69], v92 offset:65408
    v_bitop3_b32 v94, v24, v5, v99 bitop3:0xea
    v_bitop3_b32 v95, v25, v5, v46 bitop3:0xea
    v_perm_b32 v15, v25, v26, s47
    v_bitop3_b32 v46, v25, 0.5, -0.5 bitop3:0xa8
    v_perm_b32 v14, v24, v26, s46
    v_bitop3_b32 v47, v24, 0.5, -0.5 bitop3:0xa8
    v_bitop3_b32 v15, v6, v15, v46 bitop3:0xca
    v_bitop3_b32 v14, v6, v14, v47 bitop3:0xca
    s_waitcnt lgkmcnt(1)
    v_mfma_f32_4x4x4_16b_bf16 v[80:83], v[10:11], v[70:71], v[80:83]
    s_waitcnt lgkmcnt(0)
    v_mfma_f32_4x4x4_16b_bf16 v[76:79], v[10:11], v[68:69], v[76:79]
    s_nop 2
    v_cvt_pk_bf16_f32 v80, v80, v81
    v_cvt_pk_bf16_f32 v81, v82, v83
    ds_wrxchg_rtn_b64 v[74:75], v93, v[80:81] offset:65408
    v_cvt_pk_bf16_f32 v76, v76, v77
    v_cvt_pk_bf16_f32 v77, v78, v79
    ds_wrxchg_rtn_b64 v[72:73], v92, v[76:77] offset:65408
    v_and_b32 v88, 0x0fffffff, v41
    buffer_load_dwordx2 v[22:23], v88, s[8:11], 0 offen
    buffer_load_dwordx3 v[24:26], v88, s[8:11], 0 offen offset:8
    v_mfma_f32_4x4x4_16b_bf16 v[80:83], v[8:9], v[106:107], 0
    v_mfma_f32_4x4x4_16b_bf16 v[76:79], v[8:9], v[104:105], 0
    v_cmp_lt_u32 s[84:85], v5, v94
    s_nop 2
    v_pk_mul_f32 v[80:81], v[80:81], v[14:15] op_sel:[0,1] op_sel_hi:[1,1]
    v_pk_mul_f32 v[82:83], v[82:83], v[14:15] op_sel:[0,1] op_sel_hi:[1,1]
    v_pk_mul_f32 v[76:77], v[76:77], v[14:15] op_sel:[0,0] op_sel_hi:[1,0]
    v_pk_mul_f32 v[78:79], v[78:79], v[14:15] op_sel:[0,0] op_sel_hi:[1,0]
    s_waitcnt vmcnt(11)
    s_mov_b64 exec, s[6:7]
    v_lshrrev_b32 v30, 16, v30
    s_mov_b64 exec, -1
    v_and_b32 v46, 0x20000000, v31
    v_lshrrev_b32 v47, 14, v29
    v_bitop3_b32 v47, v47, v5, v46 bitop3:0xea
    ds_read_b64 v[102:103], v47
    v_and_b32 v99, 0x10000000, v31
    v_lshrrev_b32 v47, 14, v28
    v_bitop3_b32 v47, v47, v5, v99 bitop3:0xea
    ds_read_b64 v[100:101], v47
    s_waitcnt lgkmcnt(2)
    v_cmp_ne_u64 s[50:51], v[72:73], v[68:69]
    v_cmpx_ne_u64 s[54:55], v[74:75], v[70:71]
    s_and_b64 s[82:83], s[54:55], s[80:81]
    s_cbranch_scc1 L2_c128
L2_d128:
    v_mov_b64 v[84:85], v[70:71]
    v_mov_b32 v7, v93
    v_mov_b64 v[86:87], v[74:75]
    s_or_b64 s[80:81], s[80:81], s[54:55]
    s_mov_b64 exec, s[50:51]
    s_and_b64 s[82:83], s[50:51], s[80:81]
    s_cbranch_scc1 L2_c129
L2_d129:
    v_mov_b64 v[84:85], v[68:69]
    v_mov_b32 v7, v92
    v_mov_b64 v[86:87], v[72:73]
    s_mov_b64 exec, -1
    s_or_b64 s[80:81], s[80:81], s[50:51]
    s_and_b64 exec, s[84:85], s[80:81]
    v_mfma_f32_4x4x4_16b_bf16 v[76:79], v[12:13], v[84:85], 0
    v_mov_b32 v94, v7
    s_andn2_b64 s[80:81], s[80:81], s[84:85]
    v_mfma_f32_4x4x4_16b_bf16 v[76:79], v[10:11], v[86:87], v[76:79]
    s_mov_b64 exec, -1
    ds_read_b64 v[70:71], v95 offset:65408
    ds_read_b64 v[68:69], v94 offset:65408
    v_bitop3_b32 v92, v28, v5, v99 bitop3:0xea
    v_bitop3_b32 v93, v29, v5, v46 bitop3:0xea
    v_perm_b32 v15, v29, v30, s45
    v_bitop3_b32 v46, v29, 0.5, -0.5 bitop3:0xa8
    v_perm_b32 v14, v28, v30, s44
    v_bitop3_b32 v47, v28, 0.5, -0.5 bitop3:0xa8
    v_bitop3_b32 v15, v6, v15, v46 bitop3:0xca
    v_bitop3_b32 v14, v6, v14, v47 bitop3:0xca
    s_waitcnt lgkmcnt(1)
    v_mfma_f32_4x4x4_16b_bf16 v[80:83], v[10:11], v[70:71], v[80:83]
    s_waitcnt lgkmcnt(0)
    v_mfma_f32_4x4x4_16b_bf16 v[76:79], v[10:11], v[68:69], v[76:79]
    s_nop 2
    v_cvt_pk_bf16_f32 v80, v80, v81
    v_cvt_pk_bf16_f32 v81, v82, v83
    ds_wrxchg_rtn_b64 v[74:75], v95, v[80:81] offset:65408
    v_cvt_pk_bf16_f32 v76, v76, v77
    v_cvt_pk_bf16_f32 v77, v78, v79
    ds_wrxchg_rtn_b64 v[72:73], v94, v[76:77] offset:65408
    s_setprio 0
    v_mfma_f32_4x4x4_16b_bf16 v[80:83], v[8:9], v[102:103], 0
    v_mfma_f32_4x4x4_16b_bf16 v[76:79], v[8:9], v[100:101], 0
    v_cmp_lt_u32 s[48:49], v5, v93
    s_nop 2
    v_pk_mul_f32 v[80:81], v[80:81], v[14:15] op_sel:[0,1] op_sel_hi:[1,1]
    v_pk_mul_f32 v[82:83], v[82:83], v[14:15] op_sel:[0,1] op_sel_hi:[1,1]
    v_pk_mul_f32 v[76:77], v[76:77], v[14:15] op_sel:[0,0] op_sel_hi:[1,0]
    v_pk_mul_f32 v[78:79], v[78:79], v[14:15] op_sel:[0,0] op_sel_hi:[1,0]
    s_add_u32 s40, s40, 0xfff24000
    v_and_b32 v47, 0x0fffffff, v42
    buffer_load_dword v30, v47, s[8:11], 0 offen offset:16
    s_mov_b64 exec, s[6:7]
    v_add_u32 v47, 8, v47
    v_lshrrev_b32 v42, 2, v42
    s_mov_b64 exec, -1
    buffer_load_dwordx2 v[28:29], v47, s[8:11], 0 offen
    s_waitcnt vmcnt(8)
    v_and_b32 v46, 0x80000000, v39
    v_lshrrev_b32 v47, 14, v37
    v_bitop3_b32 v47, v47, v5, v46 bitop3:0xea
    ds_read_b64 v[102:103], v47
    v_and_b32 v99, 0x40000000, v39
    v_lshrrev_b32 v47, 14, v36
    v_bitop3_b32 v47, v47, v5, v99 bitop3:0xea
    ds_read_b64 v[100:101], v47
    v_and_b32 v46, 0x20000000, v39
    v_lshrrev_b32 v47, 14, v35
    v_bitop3_b32 v47, v47, v5, v46 bitop3:0xea
    ds_read_b64 v[106:107], v47
    v_and_b32 v99, 0x10000000, v39
    v_lshrrev_b32 v47, 14, v34
    v_bitop3_b32 v47, v47, v5, v99 bitop3:0xea
    ds_read_b64 v[104:105], v47
    s_waitcnt lgkmcnt(4)
    v_cmp_ne_u64 s[50:51], v[72:73], v[68:69]
    v_cmpx_ne_u64 s[54:55], v[74:75], v[70:71]
    s_and_b64 s[82:83], s[54:55], s[80:81]
    s_cbranch_scc1 L2_c130
L2_d130:
    v_mov_b64 v[84:85], v[70:71]
    v_mov_b32 v7, v95
    v_mov_b64 v[86:87], v[74:75]
    s_or_b64 s[80:81], s[80:81], s[54:55]
    s_mov_b64 exec, s[50:51]
    s_and_b64 s[82:83], s[50:51], s[80:81]
    s_cbranch_scc1 L2_c131
L2_d131:
    v_mov_b64 v[84:85], v[68:69]
    v_mov_b32 v7, v94
    v_mov_b64 v[86:87], v[72:73]
    s_mov_b64 exec, -1
    s_or_b64 s[80:81], s[80:81], s[50:51]
    s_and_b64 exec, s[48:49], s[80:81]
    v_mfma_f32_4x4x4_16b_bf16 v[80:83], v[12:13], v[84:85], 0
    v_mov_b32 v93, v7
    s_andn2_b64 s[80:81], s[80:81], s[48:49]
    v_mfma_f32_4x4x4_16b_bf16 v[80:83], v[10:11], v[86:87], v[80:83]
    s_mov_b64 exec, -1
    ds_read_b64 v[70:71], v93 offset:65408
    ds_read_b64 v[68:69], v92 offset:65408
    v_bitop3_b32 v94, v34, v5, v99 bitop3:0xea
    v_bitop3_b32 v95, v35, v5, v46 bitop3:0xea
    v_perm_b32 v15, v35, v38, s45
    v_bitop3_b32 v46, v35, 0.5, -0.5 bitop3:0xa8
    v_perm_b32 v14, v34, v38, s44
    v_bitop3_b32 v47, v34, 0.5, -0.5 bitop3:0xa8
    v_bitop3_b32 v15, v6, v15, v46 bitop3:0xca
    v_bitop3_b32 v14, v6, v14, v47 bitop3:0xca
    s_waitcnt lgkmcnt(1)
    v_mfma_f32_4x4x4_16b_bf16 v[80:83], v[10:11], v[70:71], v[80:83]
    s_waitcnt lgkmcnt(0)
    v_mfma_f32_4x4x4_16b_bf16 v[76:79], v[10:11], v[68:69], v[76:79]
    s_nop 2
    v_cvt_pk_bf16_f32 v80, v80, v81
    v_cvt_pk_bf16_f32 v81, v82, v83
    ds_wrxchg_rtn_b64 v[74:75], v93, v[80:81] offset:65408
    v_cvt_pk_bf16_f32 v76, v76, v77
    v_cvt_pk_bf16_f32 v77, v78, v79
    ds_wrxchg_rtn_b64 v[72:73], v92, v[76:77] offset:65408
    s_barrier
    s_setprio 3
    s_mov_b32 m0, s100
    s_nop 0
    ds_write_addtid_b32 v124 offset:34816
    ds_write_addtid_b32 v125 offset:35072
    ds_write_addtid_b32 v126 offset:35328
    ds_write_addtid_b32 v127 offset:35584
    ds_write_addtid_b32 v116 offset:32768
    ds_write_addtid_b32 v117 offset:33024
    ds_write_addtid_b32 v118 offset:33280
    ds_write_addtid_b32 v119 offset:33536
    ds_write_addtid_b32 v120 offset:33792
    ds_write_addtid_b32 v121 offset:34048
    ds_write_addtid_b32 v122 offset:34304
    ds_write_addtid_b32 v123 offset:34560
    v_mfma_f32_4x4x4_16b_bf16 v[80:83], v[8:9], v[106:107], 0
    v_mfma_f32_4x4x4_16b_bf16 v[76:79], v[8:9], v[104:105], 0
    s_nop 3
    v_pk_mul_f32 v[80:81], v[80:81], v[14:15] op_sel:[0,1] op_sel_hi:[1,1]
    v_pk_mul_f32 v[82:83], v[82:83], v[14:15] op_sel:[0,1] op_sel_hi:[1,1]
    v_pk_mul_f32 v[76:77], v[76:77], v[14:15] op_sel:[0,0] op_sel_hi:[1,0]
    v_pk_mul_f32 v[78:79], v[78:79], v[14:15] op_sel:[0,0] op_sel_hi:[1,0]
    s_setprio 2
    s_waitcnt lgkmcnt(12)
    v_cmp_ne_u64 s[50:51], v[72:73], v[68:69]
    v_cmpx_ne_u64 s[54:55], v[74:75], v[70:71]
    s_and_b64 s[82:83], s[54:55], s[80:81]
    s_cbranch_scc1 L2_c132
L2_d132:
    v_mov_b64 v[84:85], v[70:71]
    v_mov_b32 v7, v93
    v_mov_b64 v[86:87], v[74:75]
    s_or_b64 s[80:81], s[80:81], s[54:55]
    s_mov_b64 exec, s[50:51]
    s_and_b64 s[82:83], s[50:51], s[80:81]
    s_cbranch_scc1 L2_c133
L2_d133:
    v_mov_b64 v[84:85], v[68:69]
    v_mov_b32 v7, v92
    v_mov_b64 v[86:87], v[72:73]
    s_mov_b64 exec, -1
    s_or_b64 s[80:81], s[80:81], s[50:51]
    ds_read_b64 v[70:71], v95 offset:65408
    ds_read_b64 v[68:69], v94 offset:65408
    v_and_b32 v46, 0x40000000, v39
    v_bitop3_b32 v92, v36, v5, v46 bitop3:0xea
    v_and_b32 v46, 0x80000000, v39
    v_bitop3_b32 v93, v37, v5, v46 bitop3:0xea
    v_perm_b32 v15, v37, v38, s47
    v_bitop3_b32 v46, v37, 0.5, -0.5 bitop3:0xa8
    v_perm_b32 v14, v36, v38, s46
    v_bitop3_b32 v47, v36, 0.5, -0.5 bitop3:0xa8
    v_bitop3_b32 v15, v6, v15, v46 bitop3:0xca
    v_bitop3_b32 v14, v6, v14, v47 bitop3:0xca
    s_setprio 1
    s_waitcnt lgkmcnt(1)
    v_mfma_f32_4x4x4_16b_bf16 v[80:83], v[10:11], v[70:71], v[80:83]
    s_waitcnt lgkmcnt(0)
    v_mfma_f32_4x4x4_16b_bf16 v[76:79], v[10:11], v[68:69], v[76:79]
    s_nop 2
    v_cvt_pk_bf16_f32 v80, v80, v81
    v_cvt_pk_bf16_f32 v81, v82, v83
    ds_wrxchg_rtn_b64 v[74:75], v95, v[80:81] offset:65408
    v_cvt_pk_bf16_f32 v76, v76, v77
    v_cvt_pk_bf16_f32 v77, v78, v79
    ds_wrxchg_rtn_b64 v[72:73], v94, v[76:77] offset:65408
    v_and_b32 v88, 0x0fffffff, v43
    buffer_load_dwordx2 v[34:35], v88, s[8:11], 0 offen
    buffer_load_dwordx3 v[36:38], v88, s[8:11], 0 offen offset:8
    s_setprio 0
    s_waitcnt vmcnt(9)
    s_mov_b32 m0, s38
    s_nop 0
    ds_write_addtid_b32 v108 offset:0
    ds_write_addtid_b32 v109 offset:256
    ds_write_addtid_b32 v110 offset:512
    ds_write_addtid_b32 v111 offset:768
    s_waitcnt vmcnt(6)
    ds_write_addtid_b32 v112 offset:1024
    ds_write_addtid_b32 v113 offset:1280
    ds_write_addtid_b32 v114 offset:1536
    ds_write_addtid_b32 v115 offset:1792
    v_mfma_f32_4x4x4_16b_bf16 v[80:83], v[8:9], v[102:103], 0
    v_mfma_f32_4x4x4_16b_bf16 v[76:79], v[8:9], v[100:101], 0
    v_cmp_lt_u32 s[84:85], v5, v92
    s_nop 2
    v_pk_mul_f32 v[80:81], v[80:81], v[14:15] op_sel:[0,1] op_sel_hi:[1,1]
    v_pk_mul_f32 v[82:83], v[82:83], v[14:15] op_sel:[0,1] op_sel_hi:[1,1]
    v_pk_mul_f32 v[76:77], v[76:77], v[14:15] op_sel:[0,0] op_sel_hi:[1,0]
    v_pk_mul_f32 v[78:79], v[78:79], v[14:15] op_sel:[0,0] op_sel_hi:[1,0]
    s_add_u32 s42, s42, 1
    s_waitcnt lgkmcnt(0)
    s_barrier
    s_bitcmp1_b32 s36, s42
    s_cbranch_scc1 L2_slow
L2_ret7:
    s_setprio 3
    s_bitcmp1_b32 s43, s42
    s_cbranch_scc1 L2_oa134
L2_ob134:
    v_and_b32 v46, 0x20000000, v40
    v_lshrrev_b32 v47, 14, v17
    v_bitop3_b32 v47, v47, v5, v46 bitop3:0xea
    ds_read_b64 v[106:107], v47
    v_and_b32 v99, 0x10000000, v40
    v_lshrrev_b32 v47, 14, v16
    v_bitop3_b32 v47, v47, v5, v99 bitop3:0xea
    ds_read_b64 v[104:105], v47
    v_cmp_ne_u64 s[50:51], v[72:73], v[68:69]
    v_cmpx_ne_u64 s[54:55], v[74:75], v[70:71]
    s_and_b64 s[82:83], s[54:55], s[80:81]
    s_cbranch_scc1 L2_c135
L2_d135:
    v_mov_b64 v[84:85], v[70:71]
    v_mov_b32 v7, v95
    v_mov_b64 v[86:87], v[74:75]
    s_or_b64 s[80:81], s[80:81], s[54:55]
    s_mov_b64 exec, s[50:51]
    s_and_b64 s[82:83], s[50:51], s[80:81]
    s_cbranch_scc1 L2_c136
L2_d136:
    v_mov_b64 v[84:85], v[68:69]
    v_mov_b32 v7, v94
    v_mov_b64 v[86:87], v[72:73]
    s_mov_b64 exec, -1
    s_or_b64 s[80:81], s[80:81], s[50:51]
    s_and_b64 exec, s[84:85], s[80:81]
    v_mfma_f32_4x4x4_16b_bf16 v[76:79], v[12:13], v[84:85], 0
    v_mov_b32 v92, v7
    s_andn2_b64 s[80:81], s[80:81], s[84:85]
    v_mfma_f32_4x4x4_16b_bf16 v[76:79], v[10:11], v[86:87], v[76:79]
    s_mov_b64 exec, -1
    ds_read_b64 v[70:71], v93 offset:65408
    ds_read_b64 v[68:69], v92 offset:65408
    v_bitop3_b32 v94, v16, v5, v99 bitop3:0xea
    v_bitop3_b32 v95, v17, v5, v46 bitop3:0xea
    v_perm_b32 v15, v17, v20, s45
    v_bitop3_b32 v46, v17, 0.5, -0.5 bitop3:0xa8
    v_perm_b32 v14, v16, v20, s44
    v_bitop3_b32 v47, v16, 0.5, -0.5 bitop3:0xa8
    v_bitop3_b32 v15, v6, v15, v46 bitop3:0xca
    v_bitop3_b32 v14, v6, v14, v47 bitop3:0xca
    s_waitcnt lgkmcnt(1)
    v_mfma_f32_4x4x4_16b_bf16 v[80:83], v[10:11], v[70:71], v[80:83]
    s_waitcnt lgkmcnt(0)
    v_mfma_f32_4x4x4_16b_bf16 v[76:79], v[10:11], v[68:69], v[76:79]
    s_nop 2
    v_cvt_pk_bf16_f32 v80, v80, v81
    v_cvt_pk_bf16_f32 v81, v82, v83
    ds_wrxchg_rtn_b64 v[74:75], v93, v[80:81] offset:65408
    v_cvt_pk_bf16_f32 v76, v76, v77
    v_cvt_pk_bf16_f32 v77, v78, v79
    ds_wrxchg_rtn_b64 v[72:73], v92, v[76:77] offset:65408
    v_mfma_f32_4x4x4_16b_bf16 v[80:83], v[8:9], v[106:107], 0
    v_mfma_f32_4x4x4_16b_bf16 v[76:79], v[8:9], v[104:105], 0
    v_cmp_lt_u32 s[84:85], v5, v94
    s_nop 2
    v_pk_mul_f32 v[80:81], v[80:81], v[14:15] op_sel:[0,1] op_sel_hi:[1,1]
    v_pk_mul_f32 v[82:83], v[82:83], v[14:15] op_sel:[0,1] op_sel_hi:[1,1]
    v_pk_mul_f32 v[76:77], v[76:77], v[14:15] op_sel:[0,0] op_sel_hi:[1,0]
    v_pk_mul_f32 v[78:79], v[78:79], v[14:15] op_sel:[0,0] op_sel_hi:[1,0]
    v_and_b32 v46, 0x80000000, v40
    v_lshrrev_b32 v47, 14, v19
    v_bitop3_b32 v47, v47, v5, v46 bitop3:0xea
    ds_read_b64 v[102:103], v47
    v_and_b32 v99, 0x40000000, v40
    v_lshrrev_b32 v47, 14, v18
    v_bitop3_b32 v47, v47, v5, v99 bitop3:0xea
    ds_read_b64 v[100:101], v47
    s_waitcnt lgkmcnt(2)
    v_cmp_ne_u64 s[50:51], v[72:73], v[68:69]
    v_cmpx_ne_u64 s[54:55], v[74:75], v[70:71]
    s_and_b64 s[82:83], s[54:55], s[80:81]
    s_cbranch_scc1 L2_c137
L2_d137:
    v_mov_b64 v[84:85], v[70:71]
    v_mov_b32 v7, v93
    v_mov_b64 v[86:87], v[74:75]
    s_or_b64 s[80:81], s[80:81], s[54:55]
    s_mov_b64 exec, s[50:51]
    s_and_b64 s[82:83], s[50:51], s[80:81]
    s_cbranch_scc1 L2_c138
L2_d138:
    v_mov_b64 v[84:85], v[68:69]
    v_mov_b32 v7, v92
    v_mov_b64 v[86:87], v[72:73]
    s_mov_b64 exec, -1
    s_or_b64 s[80:81], s[80:81], s[50:51]
    s_and_b64 exec, s[84:85], s[80:81]
    v_mfma_f32_4x4x4_16b_bf16 v[76:79], v[12:13], v[84:85], 0
    v_mov_b32 v94, v7
    s_andn2_b64 s[80:81], s[80:81], s[84:85]
    v_mfma_f32_4x4x4_16b_bf16 v[76:79], v[10:11], v[86:87], v[76:79]
    s_mov_b64 exec, -1
    ds_read_b64 v[70:71], v95 offset:65408
    ds_read_b64 v[68:69], v94 offset:65408
    v_bitop3_b32 v92, v18, v5, v99 bitop3:0xea
    v_bitop3_b32 v93, v19, v5, v46 bitop3:0xea
    v_perm_b32 v15, v19, v20, s47
    v_bitop3_b32 v46, v19, 0.5, -0.5 bitop3:0xa8
    v_perm_b32 v14, v18, v20, s46
    v_bitop3_b32 v47, v18, 0.5, -0.5 bitop3:0xa8
    v_bitop3_b32 v15, v6, v15, v46 bitop3:0xca
    v_bitop3_b32 v14, v6, v14, v47 bitop3:0xca
    s_waitcnt lgkmcnt(1)
    v_mfma_f32_4x4x4_16b_bf16 v[80:83], v[10:11], v[70:71], v[80:83]
    s_waitcnt lgkmcnt(0)
    v_mfma_f32_4x4x4_16b_bf16 v[76:79], v[10:11], v[68:69], v[76:79]
    s_nop 2
    v_cvt_pk_bf16_f32 v80, v80, v81
    v_cvt_pk_bf16_f32 v81, v82, v83
    ds_wrxchg_rtn_b64 v[74:75], v95, v[80:81] offset:65408
    v_cvt_pk_bf16_f32 v76, v76, v77
    v_cvt_pk_bf16_f32 v77, v78, v79
    ds_wrxchg_rtn_b64 v[72:73], v94, v[76:77] offset:65408
    s_setprio 2
    v_mfma_f32_4x4x4_16b_bf16 v[80:83], v[8:9], v[102:103], 0
    v_mfma_f32_4x4x4_16b_bf16 v[76:79], v[8:9], v[100:101], 0
    v_cmp_lt_u32 s[48:49], v5, v93
    s_nop 2
    v_pk_mul_f32 v[80:81], v[80:81], v[14:15] op_sel:[0,1] op_sel_hi:[1,1]
    v_pk_mul_f32 v[82:83], v[82:83], v[14:15] op_sel:[0,1] op_sel_hi:[1,1]
    v_pk_mul_f32 v[76:77], v[76:77], v[14:15] op_sel:[0,0] op_sel_hi:[1,0]
    v_pk_mul_f32 v[78:79], v[78:79], v[14:15] op_sel:[0,0] op_sel_hi:[1,0]
    s_waitcnt vmcnt(4)
    v_and_b32 v46, 0x20000000, v41
    v_lshrrev_b32 v47, 14, v23
    v_bitop3_b32 v47, v47, v5, v46 bitop3:0xea
    ds_read_b64 v[106:107], v47
    v_and_b32 v99, 0x10000000, v41
    v_lshrrev_b32 v47, 14, v22
    v_bitop3_b32 v47, v47, v5, v99 bitop3:0xea
    ds_read_b64 v[104:105], v47
    s_waitcnt lgkmcnt(2)
    v_cmp_ne_u64 s[50:51], v[72:73], v[68:69]
    v_cmpx_ne_u64 s[54:55], v[74:75], v[70:71]
    s_and_b64 s[82:83], s[54:55], s[80:81]
    s_cbranch_scc1 L2_c139
L2_d139:
    v_mov_b64 v[84:85], v[70:71]
    v_mov_b32 v7, v95
    v_mov_b64 v[86:87], v[74:75]
    s_or_b64 s[80:81], s[80:81], s[54:55]
    s_mov_b64 exec, s[50:51]
    s_and_b64 s[82:83], s[50:51], s[80:81]
    s_cbranch_scc1 L2_c140
L2_d140:
    v_mov_b64 v[84:85], v[68:69]
    v_mov_b32 v7, v94
    v_mov_b64 v[86:87], v[72:73]
    s_mov_b64 exec, -1
    s_or_b64 s[80:81], s[80:81], s[50:51]
    s_and_b64 exec, s[48:49], s[80:81]
    v_mfma_f32_4x4x4_16b_bf16 v[80:83], v[12:13], v[84:85], 0
    v_mov_b32 v93, v7
    s_andn2_b64 s[80:81], s[80:81], s[48:49]
    v_mfma_f32_4x4x4_16b_bf16 v[80:83], v[10:11], v[86:87], v[80:83]
    s_mov_b64 exec, -1
    ds_read_b64 v[70:71], v93 offset:65408
    ds_read_b64 v[68:69], v92 offset:65408
    v_bitop3_b32 v94, v22, v5, v99 bitop3:0xea
    v_bitop3_b32 v95, v23, v5, v46 bitop3:0xea
    v_perm_b32 v15, v23, v26, s45
    v_bitop3_b32 v46, v23, 0.5, -0.5 bitop3:0xa8
    v_perm_b32 v14, v22, v26, s44
    v_bitop3_b32 v47, v22, 0.5, -0.5 bitop3:0xa8
    v_bitop3_b32 v15, v6, v15, v46 bitop3:0xca
    v_bitop3_b32 v14, v6, v14, v47 bitop3:0xca
    s_waitcnt lgkmcnt(1)
    v_mfma_f32_4x4x4_16b_bf16 v[80:83], v[10:11], v[70:71], v[80:83]
    s_waitcnt lgkmcnt(0)
    v_mfma_f32_4x4x4_16b_bf16 v[76:79], v[10:11], v[68:69], v[76:79]
    s_nop 2
    v_cvt_pk_bf16_f32 v80, v80, v81
    v_cvt_pk_bf16_f32 v81, v82, v83
    ds_wrxchg_rtn_b64 v[74:75], v93, v[80:81] offset:65408
    v_cvt_pk_bf16_f32 v76, v76, v77
    v_cvt_pk_bf16_f32 v77, v78, v79
    ds_wrxchg_rtn_b64 v[72:73], v92, v[76:77] offset:65408
    s_setprio 1
    v_mfma_f32_4x4x4_16b_bf16 v[80:83], v[8:9], v[106:107], 0
    v_mfma_f32_4x4x4_16b_bf16 v[76:79], v[8:9], v[104:105], 0
    s_nop 3
    v_pk_mul_f32 v[80:81], v[80:81], v[14:15] op_sel:[0,1] op_sel_hi:[1,1]
    v_pk_mul_f32 v[82:83], v[82:83], v[14:15] op_sel:[0,1] op_sel_hi:[1,1]
    v_pk_mul_f32 v[76:77], v[76:77], v[14:15] op_sel:[0,0] op_sel_hi:[1,0]
    v_pk_mul_f32 v[78:79], v[78:79], v[14:15] op_sel:[0,0] op_sel_hi:[1,0]
    s_bitcmp1_b32 s43, s42
    s_cbranch_scc1 L2_oa141
L2_ob141:
    v_and_b32 v46, 0x80000000, v41
    v_lshrrev_b32 v47, 14, v25
    v_bitop3_b32 v47, v47, v5, v46 bitop3:0xea
    ds_read_b64 v[102:103], v47
    v_and_b32 v99, 0x40000000, v41
    v_lshrrev_b32 v47, 14, v24
    v_bitop3_b32 v47, v47, v5, v99 bitop3:0xea
    ds_read_b64 v[100:101], v47
    s_waitcnt lgkmcnt(2)
    v_cmp_ne_u64 s[50:51], v[72:73], v[68:69]
    v_cmpx_ne_u64 s[54:55], v[74:75], v[70:71]
    s_and_b64 s[82:83], s[54:55], s[80:81]
    s_cbranch_scc1 L2_c142
L2_d142:
    v_mov_b64 v[84:85], v[70:71]
    v_mov_b32 v7, v93
    v_mov_b64 v[86:87], v[74:75]
    s_or_b64 s[80:81], s[80:81], s[54:55]
    s_mov_b64 exec, s[50:51]
    s_and_b64 s[82:83], s[50:51], s[80:81]
    s_cbranch_scc1 L2_c143
L2_d143:
    v_mov_b64 v[84:85], v[68:69]
    v_mov_b32 v7, v92
    v_mov_b64 v[86:87], v[72:73]
    s_mov_b64 exec, -1
    s_or_b64 s[80:81], s[80:81], s[50:51]
    ds_read_b64 v[70:71], v95 offset:65408
    ds_read_b64 v[68:69], v94 offset:65408
    v_bitop3_b32 v92, v24, v5, v99 bitop3:0xea
    v_bitop3_b32 v93, v25, v5, v46 bitop3:0xea
    v_perm_b32 v15, v25, v26, s47
    v_bitop3_b32 v46, v25, 0.5, -0.5 bitop3:0xa8
    v_perm_b32 v14, v24, v26, s46
    v_bitop3_b32 v47, v24, 0.5, -0.5 bitop3:0xa8
    v_bitop3_b32 v15, v6, v15, v46 bitop3:0xca
    v_bitop3_b32 v14, v6, v14, v47 bitop3:0xca
    s_waitcnt lgkmcnt(1)
    v_mfma_f32_4x4x4_16b_bf16 v[80:83], v[10:11], v[70:71], v[80:83]
    s_waitcnt lgkmcnt(0)
    v_mfma_f32_4x4x4_16b_bf16 v[76:79], v[10:11], v[68:69], v[76:79]
    s_nop 2
    v_cvt_pk_bf16_f32 v80, v80, v81
    v_cvt_pk_bf16_f32 v81, v82, v83
    ds_wrxchg_rtn_b64 v[74:75], v95, v[80:81] offset:65408
    v_cvt_pk_bf16_f32 v76, v76, v77
    v_cvt_pk_bf16_f32 v77, v78, v79
    ds_wrxchg_rtn_b64 v[72:73], v94, v[76:77] offset:65408
    v_mfma_f32_4x4x4_16b_bf16 v[80:83], v[8:9], v[102:103], 0
    v_mfma_f32_4x4x4_16b_bf16 v[76:79], v[8:9], v[100:101], 0
    v_cmp_lt_u32 s[84:85], v5, v92
    s_nop 2
    v_pk_mul_f32 v[80:81], v[80:81], v[14:15] op_sel:[0,1] op_sel_hi:[1,1]
    v_pk_mul_f32 v[82:83], v[82:83], v[14:15] op_sel:[0,1] op_sel_hi:[1,1]
    v_pk_mul_f32 v[76:77], v[76:77], v[14:15] op_sel:[0,0] op_sel_hi:[1,0]
    v_pk_mul_f32 v[78:79], v[78:79], v[14:15] op_sel:[0,0] op_sel_hi:[1,0]
    s_lshl_b32 s3, s32, 12
    v_subrev_u32 v122, s3, v3
    s_mul_i32 s3, s33, 20000
    v_add_u32 v118, s3, v122
    v_add_u32 v119, 0x4000, v118
    s_lshl_b32 s3, s34, 7
    v_lshrrev_b32 v123, 7, v118
    v_and_b32 v120, 0x70, v118
    v_lshl_add_u32 v120, v123, 13, v120
    v_add_u32 v120, s3, v120
    v_lshrrev_b32 v123, 7, v119
    v_and_b32 v121, 0x70, v119
    v_lshl_add_u32 v121, v123, 13, v121
    v_add_u32 v121, s3, v121
    v_cmp_le_u32 vcc, 3616, v122
    s_mov_b64 exec, vcc
    v_mov_b32 v119, 2.0
    v_mov_b32 v121, 2.0
    s_mov_b64 exec, -1
    v_and_b32 v123, 0x30, v122
    v_lshlrev_b32 v123, 2, v123
    buffer_load_dwordx4 v[48:51], v123, s[24:27], 0 offen
    buffer_load_dwordx4 v[52:55], v123, s[24:27], 0 offen offset:16
    buffer_load_dwordx2 v[56:57], v123, s[24:27], 0 offen offset:32
    s_mov_b32 s12, s4
    s_mov_b32 s13, s5
    s_mov_b32 s14, 0x138800
    s_mov_b32 s15, 0x20000
    s_mov_b32 s16, s28
    s_mov_b32 s17, s29
    s_mov_b32 s18, 0x4e2000
    s_mov_b32 s19, 0x20000
    v_lshrrev_b32 v123, 2, v120
    buffer_load_dword v116, v123, s[12:15], 0 offen
    buffer_load_dwordx4 v[108:111], v120, s[16:19], 0 offen
    v_lshrrev_b32 v123, 2, v121
    buffer_load_dword v117, v123, s[12:15], 0 offen
    buffer_load_dwordx4 v[112:115], v121, s[16:19], 0 offen
    s_waitcnt vmcnt(9)
    s_mov_b64 exec, s[6:7]
    v_lshrrev_b32 v30, 16, v30
    s_mov_b64 exec, -1
    v_and_b32 v46, 0x20000000, v42
    v_lshrrev_b32 v47, 14, v29
    v_bitop3_b32 v47, v47, v5, v46 bitop3:0xea
    ds_read_b64 v[106:107], v47
    v_and_b32 v99, 0x10000000, v42
    v_lshrrev_b32 v47, 14, v28
    v_bitop3_b32 v47, v47, v5, v99 bitop3:0xea
    ds_read_b64 v[104:105], v47
    s_waitcnt lgkmcnt(2)
    v_cmp_ne_u64 s[50:51], v[72:73], v[68:69]
    v_cmpx_ne_u64 s[54:55], v[74:75], v[70:71]
    s_and_b64 s[82:83], s[54:55], s[80:81]
    s_cbranch_scc1 L2_c144
L2_d144:
    v_mov_b64 v[84:85], v[70:71]
    v_mov_b32 v7, v95
    v_mov_b64 v[86:87], v[74:75]
    s_or_b64 s[80:81], s[80:81], s[54:55]
    s_mov_b64 exec, s[50:51]
    s_and_b64 s[82:83], s[50:51], s[80:81]
    s_cbranch_scc1 L2_c145
L2_d145:
    v_mov_b64 v[84:85], v[68:69]
    v_mov_b32 v7, v94
    v_mov_b64 v[86:87], v[72:73]
    s_mov_b64 exec, -1
    s_or_b64 s[80:81], s[80:81], s[50:51]
    s_and_b64 exec, s[84:85], s[80:81]
    v_mfma_f32_4x4x4_16b_bf16 v[76:79], v[12:13], v[84:85], 0
    v_mov_b32 v92, v7
    s_andn2_b64 s[80:81], s[80:81], s[84:85]
    v_mfma_f32_4x4x4_16b_bf16 v[76:79], v[10:11], v[86:87], v[76:79]
    s_mov_b64 exec, -1
    ds_read_b64 v[70:71], v93 offset:65408
    ds_read_b64 v[68:69], v92 offset:65408
    v_bitop3_b32 v94, v28, v5, v99 bitop3:0xea
    v_bitop3_b32 v95, v29, v5, v46 bitop3:0xea
    v_perm_b32 v15, v29, v30, s45
    v_bitop3_b32 v46, v29, 0.5, -0.5 bitop3:0xa8
    v_perm_b32 v14, v28, v30, s44
    v_bitop3_b32 v47, v28, 0.5, -0.5 bitop3:0xa8
    v_bitop3_b32 v15, v6, v15, v46 bitop3:0xca
    v_bitop3_b32 v14, v6, v14, v47 bitop3:0xca
    s_waitcnt lgkmcnt(1)
    v_mfma_f32_4x4x4_16b_bf16 v[80:83], v[10:11], v[70:71], v[80:83]
    s_waitcnt lgkmcnt(0)
    v_mfma_f32_4x4x4_16b_bf16 v[76:79], v[10:11], v[68:69], v[76:79]
    s_nop 2
    v_cvt_pk_bf16_f32 v80, v80, v81
    v_cvt_pk_bf16_f32 v81, v82, v83
    ds_wrxchg_rtn_b64 v[74:75], v93, v[80:81] offset:65408
    v_cvt_pk_bf16_f32 v76, v76, v77
    v_cvt_pk_bf16_f32 v77, v78, v79
    ds_wrxchg_rtn_b64 v[72:73], v92, v[76:77] offset:65408
    s_setprio 0
    v_mfma_f32_4x4x4_16b_bf16 v[80:83], v[8:9], v[106:107], 0
    v_mfma_f32_4x4x4_16b_bf16 v[76:79], v[8:9], v[104:105], 0
    v_cmp_lt_u32 s[48:49], v5, v95
    s_nop 2
    v_pk_mul_f32 v[80:81], v[80:81], v[14:15] op_sel:[0,1] op_sel_hi:[1,1]
    v_pk_mul_f32 v[82:83], v[82:83], v[14:15] op_sel:[0,1] op_sel_hi:[1,1]
    v_pk_mul_f32 v[76:77], v[76:77], v[14:15] op_sel:[0,0] op_sel_hi:[1,0]
    v_pk_mul_f32 v[78:79], v[78:79], v[14:15] op_sel:[0,0] op_sel_hi:[1,0]
    s_waitcnt vmcnt(7)
    v_and_b32 v46, 0x80000000, v43
    v_lshrrev_b32 v47, 14, v37
    v_bitop3_b32 v47, v47, v5, v46 bitop3:0xea
    ds_read_b64 v[106:107], v47
    v_and_b32 v99, 0x40000000, v43
    v_lshrrev_b32 v47, 14, v36
    v_bitop3_b32 v47, v47, v5, v99 bitop3:0xea
    ds_read_b64 v[104:105], v47
    v_and_b32 v46, 0x20000000, v43
    v_lshrrev_b32 v47, 14, v35
    v_bitop3_b32 v47, v47, v5, v46 bitop3:0xea
    ds_read_b64 v[102:103], v47
    v_and_b32 v99, 0x10000000, v43
    v_lshrrev_b32 v47, 14, v34
    v_bitop3_b32 v47, v47, v5, v99 bitop3:0xea
    ds_read_b64 v[100:101], v47
    s_waitcnt lgkmcnt(4)
    v_cmp_ne_u64 s[50:51], v[72:73], v[68:69]
    v_cmpx_ne_u64 s[54:55], v[74:75], v[70:71]
    s_and_b64 s[82:83], s[54:55], s[80:81]
    s_cbranch_scc1 L2_c146
L2_d146:
    v_mov_b64 v[84:85], v[70:71]
    v_mov_b32 v7, v93
    v_mov_b64 v[86:87], v[74:75]
    s_or_b64 s[80:81], s[80:81], s[54:55]
    s_mov_b64 exec, s[50:51]
    s_and_b64 s[82:83], s[50:51], s[80:81]
    s_cbranch_scc1 L2_c147
L2_d147:
    v_mov_b64 v[84:85], v[68:69]
    v_mov_b32 v7, v92
    v_mov_b64 v[86:87], v[72:73]
    s_mov_b64 exec, -1
    s_or_b64 s[80:81], s[80:81], s[50:51]
    s_and_b64 exec, s[48:49], s[80:81]
    v_mfma_f32_4x4x4_16b_bf16 v[80:83], v[12:13], v[84:85], 0
    v_mov_b32 v95, v7
    s_andn2_b64 s[80:81], s[80:81], s[48:49]
    v_mfma_f32_4x4x4_16b_bf16 v[80:83], v[10:11], v[86:87], v[80:83]
    s_mov_b64 exec, -1
    ds_read_b64 v[70:71], v95 offset:65408
    ds_read_b64 v[68:69], v94 offset:65408
    v_bitop3_b32 v92, v34, v5, v99 bitop3:0xea
    v_bitop3_b32 v93, v35, v5, v46 bitop3:0xea
    v_perm_b32 v15, v35, v38, s45
    v_bitop3_b32 v46, v35, 0.5, -0.5 bitop3:0xa8
    v_perm_b32 v14, v34, v38, s44
    v_bitop3_b32 v47, v34, 0.5, -0.5 bitop3:0xa8
    v_bitop3_b32 v15, v6, v15, v46 bitop3:0xca
    v_bitop3_b32 v14, v6, v14, v47 bitop3:0xca
    s_waitcnt lgkmcnt(1)
    v_mfma_f32_4x4x4_16b_bf16 v[80:83], v[10:11], v[70:71], v[80:83]
    s_waitcnt lgkmcnt(0)
    v_mfma_f32_4x4x4_16b_bf16 v[76:79], v[10:11], v[68:69], v[76:79]
    s_nop 2
    v_cvt_pk_bf16_f32 v80, v80, v81
    v_cvt_pk_bf16_f32 v81, v82, v83
    ds_wrxchg_rtn_b64 v[74:75], v95, v[80:81] offset:65408
    v_cvt_pk_bf16_f32 v76, v76, v77
    v_cvt_pk_bf16_f32 v77, v78, v79
    ds_wrxchg_rtn_b64 v[72:73], v94, v[76:77] offset:65408
    v_mfma_f32_4x4x4_16b_bf16 v[80:83], v[8:9], v[102:103], 0
    v_mfma_f32_4x4x4_16b_bf16 v[76:79], v[8:9], v[100:101], 0
    s_nop 3
    v_pk_mul_f32 v[80:81], v[80:81], v[14:15] op_sel:[0,1] op_sel_hi:[1,1]
    v_pk_mul_f32 v[82:83], v[82:83], v[14:15] op_sel:[0,1] op_sel_hi:[1,1]
    v_pk_mul_f32 v[76:77], v[76:77], v[14:15] op_sel:[0,0] op_sel_hi:[1,0]
    v_pk_mul_f32 v[78:79], v[78:79], v[14:15] op_sel:[0,0] op_sel_hi:[1,0]
    s_waitcnt lgkmcnt(0)
    v_cmp_ne_u64 s[50:51], v[72:73], v[68:69]
    v_cmpx_ne_u64 s[54:55], v[74:75], v[70:71]
    s_and_b64 s[82:83], s[54:55], s[80:81]
    s_cbranch_scc1 L2_c148
L2_d148:
    v_mov_b64 v[84:85], v[70:71]
    v_mov_b32 v7, v95
    v_mov_b64 v[86:87], v[74:75]
    s_or_b64 s[80:81], s[80:81], s[54:55]
    s_mov_b64 exec, s[50:51]
    s_and_b64 s[82:83], s[50:51], s[80:81]
    s_cbranch_scc1 L2_c149
L2_d149:
    v_mov_b64 v[84:85], v[68:69]
    v_mov_b32 v7, v94
    v_mov_b64 v[86:87], v[72:73]
    s_mov_b64 exec, -1
    s_or_b64 s[80:81], s[80:81], s[50:51]
    ds_read_b64 v[70:71], v93 offset:65408
    ds_read_b64 v[68:69], v92 offset:65408
    v_and_b32 v46, 0x40000000, v43
    v_bitop3_b32 v94, v36, v5, v46 bitop3:0xea
    v_and_b32 v46, 0x80000000, v43
    v_bitop3_b32 v95, v37, v5, v46 bitop3:0xea
    v_perm_b32 v15, v37, v38, s47
    v_bitop3_b32 v46, v37, 0.5, -0.5 bitop3:0xa8
    v_perm_b32 v14, v36, v38, s46
    v_bitop3_b32 v47, v36, 0.5, -0.5 bitop3:0xa8
    v_bitop3_b32 v15, v6, v15, v46 bitop3:0xca
    v_bitop3_b32 v14, v6, v14, v47 bitop3:0xca
    s_waitcnt lgkmcnt(1)
    v_mfma_f32_4x4x4_16b_bf16 v[80:83], v[10:11], v[70:71], v[80:83]
    s_waitcnt lgkmcnt(0)
    v_mfma_f32_4x4x4_16b_bf16 v[76:79], v[10:11], v[68:69], v[76:79]
    s_nop 2
    v_cvt_pk_bf16_f32 v80, v80, v81
    v_cvt_pk_bf16_f32 v81, v82, v83
    ds_wrxchg_rtn_b64 v[74:75], v93, v[80:81] offset:65408
    v_cvt_pk_bf16_f32 v76, v76, v77
    v_cvt_pk_bf16_f32 v77, v78, v79
    ds_wrxchg_rtn_b64 v[72:73], v92, v[76:77] offset:65408
    v_mfma_f32_4x4x4_16b_bf16 v[80:83], v[8:9], v[106:107], 0
    v_mfma_f32_4x4x4_16b_bf16 v[76:79], v[8:9], v[104:105], 0
    v_cmp_lt_u32 s[84:85], v5, v94
    s_nop 2
    v_pk_mul_f32 v[80:81], v[80:81], v[14:15] op_sel:[0,1] op_sel_hi:[1,1]
    v_pk_mul_f32 v[82:83], v[82:83], v[14:15] op_sel:[0,1] op_sel_hi:[1,1]
    v_pk_mul_f32 v[76:77], v[76:77], v[14:15] op_sel:[0,0] op_sel_hi:[1,0]
    v_pk_mul_f32 v[78:79], v[78:79], v[14:15] op_sel:[0,0] op_sel_hi:[1,0]
    s_waitcnt lgkmcnt(0)
    v_cmp_ne_u64 s[50:51], v[72:73], v[68:69]
    v_cmpx_ne_u64 s[54:55], v[74:75], v[70:71]
    s_and_b64 s[82:83], s[54:55], s[80:81]
    s_cbranch_scc1 L2_c150
L2_d150:
    v_mov_b64 v[84:85], v[70:71]
    v_mov_b32 v7, v93
    v_mov_b64 v[86:87], v[74:75]
    s_or_b64 s[80:81], s[80:81], s[54:55]
    s_mov_b64 exec, s[50:51]
    s_and_b64 s[82:83], s[50:51], s[80:81]
    s_cbranch_scc1 L2_c151
L2_d151:
    v_mov_b64 v[84:85], v[68:69]
    v_mov_b32 v7, v92
    v_mov_b64 v[86:87], v[72:73]
    s_mov_b64 exec, -1
    s_or_b64 s[80:81], s[80:81], s[50:51]
    s_and_b64 exec, s[84:85], s[80:81]
    v_mfma_f32_4x4x4_16b_bf16 v[76:79], v[12:13], v[84:85], 0
    v_mov_b32 v94, v7
    s_andn2_b64 s[80:81], s[80:81], s[84:85]
    v_mfma_f32_4x4x4_16b_bf16 v[76:79], v[10:11], v[86:87], v[76:79]
    s_mov_b64 exec, -1
    ds_read_b64 v[70:71], v95 offset:65408
    ds_read_b64 v[68:69], v94 offset:65408
    s_waitcnt lgkmcnt(1)
    v_mfma_f32_4x4x4_16b_bf16 v[80:83], v[10:11], v[70:71], v[80:83]
    s_waitcnt lgkmcnt(0)
    v_mfma_f32_4x4x4_16b_bf16 v[76:79], v[10:11], v[68:69], v[76:79]
    s_nop 2
    v_cvt_pk_bf16_f32 v80, v80, v81
    v_cvt_pk_bf16_f32 v81, v82, v83
    ds_wrxchg_rtn_b64 v[74:75], v95, v[80:81] offset:65408
    v_cvt_pk_bf16_f32 v76, v76, v77
    v_cvt_pk_bf16_f32 v77, v78, v79
    ds_wrxchg_rtn_b64 v[72:73], v94, v[76:77] offset:65408
    s_waitcnt lgkmcnt(0)
    v_cmpx_ne_u64 vcc, v[74:75], v[70:71]
    s_and_b64 s[82:83], vcc, s[80:81]
    s_cbranch_scc1 L2_c152
L2_d152:
    v_mov_b64 v[84:85], v[70:71]
    v_mov_b32 v7, v95
    v_mov_b64 v[86:87], v[74:75]
    s_mov_b64 exec, -1
    s_or_b64 s[80:81], s[80:81], vcc
    v_cmpx_ne_u64 vcc, v[72:73], v[68:69]
    s_and_b64 s[82:83], vcc, s[80:81]
    s_cbranch_scc1 L2_c153
L2_d153:
    v_mov_b64 v[84:85], v[68:69]
    v_mov_b32 v7, v94
    v_mov_b64 v[86:87], v[72:73]
    s_mov_b64 exec, -1
    s_or_b64 s[80:81], s[80:81], vcc
    s_mov_b64 exec, s[80:81]
    ds_read_b64 v[68:69], v7 offset:65408
    v_mfma_f32_4x4x4_16b_bf16 v[76:79], v[12:13], v[84:85], 0
    s_nop 1
    v_mfma_f32_4x4x4_16b_bf16 v[76:79], v[10:11], v[86:87], v[76:79]
    s_waitcnt lgkmcnt(0)
    s_nop 0
    v_mfma_f32_4x4x4_16b_bf16 v[76:79], v[10:11], v[68:69], v[76:79]
    v_mov_b64 v[84:85], v[68:69]
    s_nop 3
    v_cvt_pk_bf16_f32 v76, v76, v77
    v_cvt_pk_bf16_f32 v77, v78, v79
    ds_wrxchg_rtn_b64 v[86:87], v7, v[76:77] offset:65408
    s_waitcnt lgkmcnt(0)
    v_cmp_ne_u64 s[80:81], v[86:87], v[84:85]
    s_mov_b64 exec, s[80:81]
    s_nop 1
    v_mfma_f32_4x4x4_16b_bf16 v[88:91], v[12:13], v[84:85], 0
    s_nop 1
    v_mfma_f32_4x4x4_16b_bf16 v[88:91], v[10:11], v[86:87], v[88:91]
    s_nop 4
    v_cvt_pk_bf16_f32 v88, v88, v89
    v_cvt_pk_bf16_f32 v89, v90, v91
    ds_pk_add_bf16 v7, v88 offset:65408
    ds_pk_add_bf16 v7, v89 offset:65412
    s_mov_b64 exec, -1
    s_load_dwordx2 s[4:5], s[0:1], 88
    v_add_u32 v123, 0x4000, v122
    s_lshl_b32 s50, s96, 16
    s_and_b32 s51, s96, 0xffff0000
    s_lshl_b32 s52, s97, 16
    s_and_b32 s53, s97, 0xffff0000
    s_lshl_b32 s54, s98, 16
    s_and_b32 s55, s98, 0xffff0000
    s_lshl_b32 s56, s99, 16
    s_and_b32 s57, s99, 0xffff0000
    s_waitcnt vmcnt(0) lgkmcnt(0)
    s_barrier
    s_add_u32 s8, s30, 0xec55000
    s_addc_u32 s9, s31, 0
    s_mov_b32 s10, 0x8000
    s_mov_b32 s11, 0x20000
    s_mov_b32 s12, s4
    s_mov_b32 s13, s5
    s_mov_b32 s14, 0x4e2000
    s_mov_b32 s15, 0x20000
    s_add_u32 s20, s30, 0xd854000
    s_addc_u32 s21, s31, 0
    s_mov_b32 s22, 0x1400000
    s_mov_b32 s23, 0x20000
    s_lshl2_add_u32 s4, s34, s33
    s_mul_i32 s4, s4, 81920
    s_add_u32 s3, s33, 1
    s_and_b32 s3, s3, 3
    s_mul_i32 s36, s3, 20000
    s_add_u32 s36, s36, 81920
    s_mul_i32 s40, s3, 20480
    s_add_u32 s40, s40, s4
    s_lshl2_add_u32 s3, s34, s3
    s_mul_i32 s3, s3, 81920
    s_mul_i32 s44, s33, 20480
    s_add_u32 s44, s44, s3
    s_add_u32 s3, s33, 2
    s_and_b32 s3, s3, 3
    s_mul_i32 s37, s3, 20000
    s_add_u32 s37, s37, 81920
    s_mul_i32 s41, s3, 20480
    s_add_u32 s41, s41, s4
    s_lshl2_add_u32 s3, s34, s3
    s_mul_i32 s3, s3, 81920
    s_mul_i32 s45, s33, 20480
    s_add_u32 s45, s45, s3
    s_add_u32 s3, s33, 3
    s_and_b32 s3, s3, 3
    s_mul_i32 s38, s3, 20000
    s_add_u32 s38, s38, 81920
    s_mul_i32 s42, s3, 20480
    s_add_u32 s42, s42, s4
    s_lshl2_add_u32 s3, s34, s3
    s_mul_i32 s3, s3, 81920
    s_mul_i32 s46, s33, 20480
    s_add_u32 s46, s46, s3
    v_add_u32 v104, s36, v122
    ds_read_b128 v[16:19], v104
    v_add_u32 v104, s37, v122
    ds_read_b128 v[20:23], v104
    v_add_u32 v104, s38, v122
    ds_read_b128 v[24:27], v104
    s_waitcnt lgkmcnt(2)
    buffer_store_dwordx4 v[16:19], v122, s[20:23], s40 offen sc1
    s_waitcnt lgkmcnt(1)
    buffer_store_dwordx4 v[20:23], v122, s[20:23], s41 offen sc1
    s_waitcnt lgkmcnt(0)
    buffer_store_dwordx4 v[24:27], v122, s[20:23], s42 offen sc1
    s_cmp_ge_u32 s32, 4
    s_cbranch_scc1 L2_g0
    v_add_u32 v104, s36, v123
    ds_read_b128 v[36:39], v104
    v_add_u32 v104, s37, v123
    ds_read_b128 v[40:43], v104
    v_add_u32 v104, s38, v123
    ds_read_b128 v[44:47], v104
    s_waitcnt lgkmcnt(2)
    buffer_store_dwordx4 v[36:39], v123, s[20:23], s40 offen sc1
    s_waitcnt lgkmcnt(1)
    buffer_store_dwordx4 v[40:43], v123, s[20:23], s41 offen sc1
    s_waitcnt lgkmcnt(0)
    buffer_store_dwordx4 v[44:47], v123, s[20:23], s42 offen sc1
L2_g0:
    v_lshlrev_b32 v80, 16, v116
    v_subrev_f32 v60, s50, v80
    v_subrev_f32 v61, s51, v80
    v_subrev_f32 v62, s52, v80
    v_subrev_f32 v63, s53, v80
    v_subrev_f32 v64, s54, v80
    v_subrev_f32 v65, s55, v80
    v_subrev_f32 v66, s56, v80
    v_subrev_f32 v67, s57, v80
    v_cvt_pk_bf16_f32 v68, v60, v61
    v_cvt_pk_bf16_f32 v69, v62, v63
    v_cvt_pk_bf16_f32 v70, v64, v65
    v_cvt_pk_bf16_f32 v71, v66, v67
    v_lshlrev_b32 v60, 16, v68
    v_and_b32 v61, 0xffff0000, v68
    v_lshlrev_b32 v62, 16, v69
    v_and_b32 v63, 0xffff0000, v69
    v_lshlrev_b32 v64, 16, v70
    v_and_b32 v65, 0xffff0000, v70
    v_lshlrev_b32 v66, 16, v71
    v_and_b32 v67, 0xffff0000, v71
    v_mul_f32 v60, v60, v60
    v_mul_f32 v61, v61, v61
    v_mul_f32 v62, v62, v62
    v_mul_f32 v63, v63, v63
    v_mul_f32 v64, v64, v64
    v_mul_f32 v65, v65, v65
    v_mul_f32 v66, v66, v66
    v_mul_f32 v67, v67, v67
    v_cvt_pk_bf16_f32 v68, v60, v61
    v_cvt_pk_bf16_f32 v69, v62, v63
    v_cvt_pk_bf16_f32 v70, v64, v65
    v_cvt_pk_bf16_f32 v71, v66, v67
    v_lshlrev_b32 v60, 16, v68
    v_and_b32 v61, 0xffff0000, v68
    v_lshlrev_b32 v62, 16, v69
    v_and_b32 v63, 0xffff0000, v69
    v_lshlrev_b32 v64, 16, v70
    v_and_b32 v65, 0xffff0000, v70
    v_lshlrev_b32 v66, 16, v71
    v_and_b32 v67, 0xffff0000, v71
    v_mul_f32 v60, 0xc1200000, v60
    v_mul_f32 v61, 0xc1200000, v61
    v_mul_f32 v62, 0xc1200000, v62
    v_mul_f32 v63, 0xc1200000, v63
    v_mul_f32 v64, 0xc1200000, v64
    v_mul_f32 v65, 0xc1200000, v65
    v_mul_f32 v66, 0xc1200000, v66
    v_mul_f32 v67, 0xc1200000, v67
    v_cvt_pk_bf16_f32 v68, v60, v61
    v_cvt_pk_bf16_f32 v69, v62, v63
    v_cvt_pk_bf16_f32 v70, v64, v65
    v_cvt_pk_bf16_f32 v71, v66, v67
    v_lshlrev_b32 v60, 16, v68
    v_and_b32 v61, 0xffff0000, v68
    v_lshlrev_b32 v62, 16, v69
    v_and_b32 v63, 0xffff0000, v69
    v_lshlrev_b32 v64, 16, v70
    v_and_b32 v65, 0xffff0000, v70
    v_lshlrev_b32 v66, 16, v71
    v_and_b32 v67, 0xffff0000, v71
    v_mul_f32 v60, 0x3fb8aa3b, v60
    v_mul_f32 v61, 0x3fb8aa3b, v61
    v_mul_f32 v62, 0x3fb8aa3b, v62
    v_mul_f32 v63, 0x3fb8aa3b, v63
    v_mul_f32 v64, 0x3fb8aa3b, v64
    v_mul_f32 v65, 0x3fb8aa3b, v65
    v_mul_f32 v66, 0x3fb8aa3b, v66
    v_mul_f32 v67, 0x3fb8aa3b, v67
    v_exp_f32 v60, v60
    v_exp_f32 v61, v61
    v_exp_f32 v62, v62
    v_exp_f32 v63, v63
    v_exp_f32 v64, v64
    v_exp_f32 v65, v65
    v_exp_f32 v66, v66
    v_exp_f32 v67, v67
    v_cvt_pk_bf16_f32 v72, v60, v61
    v_cvt_pk_bf16_f32 v73, v62, v63
    v_cvt_pk_bf16_f32 v74, v64, v65
    v_cvt_pk_bf16_f32 v75, v66, v67
    v_and_b32 v84, 0xffff0000, v116
    v_subrev_f32 v60, s50, v84
    v_subrev_f32 v61, s51, v84
    v_subrev_f32 v62, s52, v84
    v_subrev_f32 v63, s53, v84
    v_subrev_f32 v64, s54, v84
    v_subrev_f32 v65, s55, v84
    v_subrev_f32 v66, s56, v84
    v_subrev_f32 v67, s57, v84
    v_cvt_pk_bf16_f32 v68, v60, v61
    v_cvt_pk_bf16_f32 v69, v62, v63
    v_cvt_pk_bf16_f32 v70, v64, v65
    v_cvt_pk_bf16_f32 v71, v66, v67
    v_lshlrev_b32 v60, 16, v68
    v_and_b32 v61, 0xffff0000, v68
    v_lshlrev_b32 v62, 16, v69
    v_and_b32 v63, 0xffff0000, v69
    v_lshlrev_b32 v64, 16, v70
    v_and_b32 v65, 0xffff0000, v70
    v_lshlrev_b32 v66, 16, v71
    v_and_b32 v67, 0xffff0000, v71
    v_mul_f32 v60, v60, v60
    v_mul_f32 v61, v61, v61
    v_mul_f32 v62, v62, v62
    v_mul_f32 v63, v63, v63
    v_mul_f32 v64, v64, v64
    v_mul_f32 v65, v65, v65
    v_mul_f32 v66, v66, v66
    v_mul_f32 v67, v67, v67
    v_cvt_pk_bf16_f32 v68, v60, v61
    v_cvt_pk_bf16_f32 v69, v62, v63
    v_cvt_pk_bf16_f32 v70, v64, v65
    v_cvt_pk_bf16_f32 v71, v66, v67
    v_lshlrev_b32 v60, 16, v68
    v_and_b32 v61, 0xffff0000, v68
    v_lshlrev_b32 v62, 16, v69
    v_and_b32 v63, 0xffff0000, v69
    v_lshlrev_b32 v64, 16, v70
    v_and_b32 v65, 0xffff0000, v70
    v_lshlrev_b32 v66, 16, v71
    v_and_b32 v67, 0xffff0000, v71
    v_mul_f32 v60, 0xc1200000, v60
    v_mul_f32 v61, 0xc1200000, v61
    v_mul_f32 v62, 0xc1200000, v62
    v_mul_f32 v63, 0xc1200000, v63
    v_mul_f32 v64, 0xc1200000, v64
    v_mul_f32 v65, 0xc1200000, v65
    v_mul_f32 v66, 0xc1200000, v66
    v_mul_f32 v67, 0xc1200000, v67
    v_cvt_pk_bf16_f32 v68, v60, v61
    v_cvt_pk_bf16_f32 v69, v62, v63
    v_cvt_pk_bf16_f32 v70, v64, v65
    v_cvt_pk_bf16_f32 v71, v66, v67
    v_lshlrev_b32 v60, 16, v68
    v_and_b32 v61, 0xffff0000, v68
    v_lshlrev_b32 v62, 16, v69
    v_and_b32 v63, 0xffff0000, v69
    v_lshlrev_b32 v64, 16, v70
    v_and_b32 v65, 0xffff0000, v70
    v_lshlrev_b32 v66, 16, v71
    v_and_b32 v67, 0xffff0000, v71
    v_mul_f32 v60, 0x3fb8aa3b, v60
    v_mul_f32 v61, 0x3fb8aa3b, v61
    v_mul_f32 v62, 0x3fb8aa3b, v62
    v_mul_f32 v63, 0x3fb8aa3b, v63
    v_mul_f32 v64, 0x3fb8aa3b, v64
    v_mul_f32 v65, 0x3fb8aa3b, v65
    v_mul_f32 v66, 0x3fb8aa3b, v66
    v_mul_f32 v67, 0x3fb8aa3b, v67
    v_exp_f32 v60, v60
    v_exp_f32 v61, v61
    v_exp_f32 v62, v62
    v_exp_f32 v63, v63
    v_exp_f32 v64, v64
    v_exp_f32 v65, v65
    v_exp_f32 v66, v66
    v_exp_f32 v67, v67
    v_cvt_pk_bf16_f32 v76, v60, v61
    v_cvt_pk_bf16_f32 v77, v62, v63
    v_cvt_pk_bf16_f32 v78, v64, v65
    v_cvt_pk_bf16_f32 v79, v66, v67
    v_mfma_f32_4x4x4_16b_bf16 v[80:83], v[48:49], v[72:73], 0
    v_mfma_f32_4x4x4_16b_bf16 v[88:91], v[52:53], v[72:73], 0
    v_mfma_f32_4x4x4_16b_bf16 v[84:87], v[48:49], v[76:77], 0
    v_mfma_f32_4x4x4_16b_bf16 v[92:95], v[52:53], v[76:77], 0
    v_mfma_f32_4x4x4_16b_bf16 v[80:83], v[50:51], v[74:75], v[80:83]
    v_mfma_f32_4x4x4_16b_bf16 v[88:91], v[54:55], v[74:75], v[88:91]
    v_mfma_f32_4x4x4_16b_bf16 v[84:87], v[50:51], v[78:79], v[84:87]
    v_mfma_f32_4x4x4_16b_bf16 v[92:95], v[54:55], v[78:79], v[92:95]
    s_lshl_b32 s3, s34, 9
    s_lshl_b32 s4, s33, 7
    s_add_u32 s4, s4, s3
    v_mov_b32 v104, 1
    v_and_b32 v105, 0x3f0, v122
    v_lshlrev_b32 v105, 3, v105
    v_add_u32 v106, 81920, v118
    ds_read_b128 v[32:35], v106
    v_add_u32 v106, 81920, v119
    ds_read_b128 v[60:63], v106
    s_waitcnt vmcnt(0)
    s_barrier
    s_cmp_lg_u32 s32, 0
    s_cbranch_scc1 L2_f2
    s_mov_b64 exec, 1
    buffer_store_dword v104, off, s[8:11], s4 sc1
    s_mov_b64 exec, 15
    s_bitset0_b64 exec, s33
L2_f3:
    buffer_load_dword v104, v105, s[8:11], s3 offen sc1
    s_waitcnt vmcnt(0)
    v_cmp_ne_u32 vcc, 1, v104
    s_cbranch_vccnz L2_f3s
    s_mov_b64 exec, -1
L2_f2:
    s_barrier
    buffer_load_dwordx4 v[36:39], v122, s[20:23], s44 offen sc1
    buffer_load_dwordx4 v[40:43], v122, s[20:23], s45 offen sc1
    buffer_load_dwordx4 v[44:47], v122, s[20:23], s46 offen sc1
    s_cmp_ge_u32 s32, 4
    s_cbranch_scc1 L2_f5
    buffer_load_dwordx4 v[64:67], v123, s[20:23], s44 offen sc1
    buffer_load_dwordx4 v[68:71], v123, s[20:23], s45 offen sc1
    buffer_load_dwordx4 v[72:75], v123, s[20:23], s46 offen sc1
    v_lshlrev_b32 v16, 16, v117
    v_subrev_f32 v96, s50, v16
    v_subrev_f32 v97, s51, v16
    v_subrev_f32 v98, s52, v16
    v_subrev_f32 v99, s53, v16
    v_subrev_f32 v100, s54, v16
    v_subrev_f32 v101, s55, v16
    v_subrev_f32 v102, s56, v16
    v_subrev_f32 v103, s57, v16
    v_cvt_pk_bf16_f32 v0, v96, v97
    v_cvt_pk_bf16_f32 v1, v98, v99
    v_cvt_pk_bf16_f32 v2, v100, v101
    v_cvt_pk_bf16_f32 v3, v102, v103
    v_lshlrev_b32 v96, 16, v0
    v_and_b32 v97, 0xffff0000, v0
    v_lshlrev_b32 v98, 16, v1
    v_and_b32 v99, 0xffff0000, v1
    v_lshlrev_b32 v100, 16, v2
    v_and_b32 v101, 0xffff0000, v2
    v_lshlrev_b32 v102, 16, v3
    v_and_b32 v103, 0xffff0000, v3
    v_mul_f32 v96, v96, v96
    v_mul_f32 v97, v97, v97
    v_mul_f32 v98, v98, v98
    v_mul_f32 v99, v99, v99
    v_mul_f32 v100, v100, v100
    v_mul_f32 v101, v101, v101
    v_mul_f32 v102, v102, v102
    v_mul_f32 v103, v103, v103
    v_cvt_pk_bf16_f32 v0, v96, v97
    v_cvt_pk_bf16_f32 v1, v98, v99
    v_cvt_pk_bf16_f32 v2, v100, v101
    v_cvt_pk_bf16_f32 v3, v102, v103
    v_lshlrev_b32 v96, 16, v0
    v_and_b32 v97, 0xffff0000, v0
    v_lshlrev_b32 v98, 16, v1
    v_and_b32 v99, 0xffff0000, v1
    v_lshlrev_b32 v100, 16, v2
    v_and_b32 v101, 0xffff0000, v2
    v_lshlrev_b32 v102, 16, v3
    v_and_b32 v103, 0xffff0000, v3
    v_mul_f32 v96, 0xc1200000, v96
    v_mul_f32 v97, 0xc1200000, v97
    v_mul_f32 v98, 0xc1200000, v98
    v_mul_f32 v99, 0xc1200000, v99
    v_mul_f32 v100, 0xc1200000, v100
    v_mul_f32 v101, 0xc1200000, v101
    v_mul_f32 v102, 0xc1200000, v102
    v_mul_f32 v103, 0xc1200000, v103
    v_cvt_pk_bf16_f32 v0, v96, v97
    v_cvt_pk_bf16_f32 v1, v98, v99
    v_cvt_pk_bf16_f32 v2, v100, v101
    v_cvt_pk_bf16_f32 v3, v102, v103
    v_lshlrev_b32 v96, 16, v0
    v_and_b32 v97, 0xffff0000, v0
    v_lshlrev_b32 v98, 16, v1
    v_and_b32 v99, 0xffff0000, v1
    v_lshlrev_b32 v100, 16, v2
    v_and_b32 v101, 0xffff0000, v2
    v_lshlrev_b32 v102, 16, v3
    v_and_b32 v103, 0xffff0000, v3
    v_mul_f32 v96, 0x3fb8aa3b, v96
    v_mul_f32 v97, 0x3fb8aa3b, v97
    v_mul_f32 v98, 0x3fb8aa3b, v98
    v_mul_f32 v99, 0x3fb8aa3b, v99
    v_mul_f32 v100, 0x3fb8aa3b, v100
    v_mul_f32 v101, 0x3fb8aa3b, v101
    v_mul_f32 v102, 0x3fb8aa3b, v102
    v_mul_f32 v103, 0x3fb8aa3b, v103
    v_exp_f32 v96, v96
    v_exp_f32 v97, v97
    v_exp_f32 v98, v98
    v_exp_f32 v99, v99
    v_exp_f32 v100, v100
    v_exp_f32 v101, v101
    v_exp_f32 v102, v102
    v_exp_f32 v103, v103
    v_cvt_pk_bf16_f32 v104, v96, v97
    v_cvt_pk_bf16_f32 v105, v98, v99
    v_cvt_pk_bf16_f32 v106, v100, v101
    v_cvt_pk_bf16_f32 v107, v102, v103
    v_and_b32 v20, 0xffff0000, v117
    v_subrev_f32 v96, s50, v20
    v_subrev_f32 v97, s51, v20
    v_subrev_f32 v98, s52, v20
    v_subrev_f32 v99, s53, v20
    v_subrev_f32 v100, s54, v20
    v_subrev_f32 v101, s55, v20
    v_subrev_f32 v102, s56, v20
    v_subrev_f32 v103, s57, v20
    v_cvt_pk_bf16_f32 v0, v96, v97
    v_cvt_pk_bf16_f32 v1, v98, v99
    v_cvt_pk_bf16_f32 v2, v100, v101
    v_cvt_pk_bf16_f32 v3, v102, v103
    v_lshlrev_b32 v96, 16, v0
    v_and_b32 v97, 0xffff0000, v0
    v_lshlrev_b32 v98, 16, v1
    v_and_b32 v99, 0xffff0000, v1
    v_lshlrev_b32 v100, 16, v2
    v_and_b32 v101, 0xffff0000, v2
    v_lshlrev_b32 v102, 16, v3
    v_and_b32 v103, 0xffff0000, v3
    v_mul_f32 v96, v96, v96
    v_mul_f32 v97, v97, v97
    v_mul_f32 v98, v98, v98
    v_mul_f32 v99, v99, v99
    v_mul_f32 v100, v100, v100
    v_mul_f32 v101, v101, v101
    v_mul_f32 v102, v102, v102
    v_mul_f32 v103, v103, v103
    v_cvt_pk_bf16_f32 v0, v96, v97
    v_cvt_pk_bf16_f32 v1, v98, v99
    v_cvt_pk_bf16_f32 v2, v100, v101
    v_cvt_pk_bf16_f32 v3, v102, v103
    v_lshlrev_b32 v96, 16, v0
    v_and_b32 v97, 0xffff0000, v0
    v_lshlrev_b32 v98, 16, v1
    v_and_b32 v99, 0xffff0000, v1
    v_lshlrev_b32 v100, 16, v2
    v_and_b32 v101, 0xffff0000, v2
    v_lshlrev_b32 v102, 16, v3
    v_and_b32 v103, 0xffff0000, v3
    v_mul_f32 v96, 0xc1200000, v96
    v_mul_f32 v97, 0xc1200000, v97
    v_mul_f32 v98, 0xc1200000, v98
    v_mul_f32 v99, 0xc1200000, v99
    v_mul_f32 v100, 0xc1200000, v100
    v_mul_f32 v101, 0xc1200000, v101
    v_mul_f32 v102, 0xc1200000, v102
    v_mul_f32 v103, 0xc1200000, v103
    v_cvt_pk_bf16_f32 v0, v96, v97
    v_cvt_pk_bf16_f32 v1, v98, v99
    v_cvt_pk_bf16_f32 v2, v100, v101
    v_cvt_pk_bf16_f32 v3, v102, v103
    v_lshlrev_b32 v96, 16, v0
    v_and_b32 v97, 0xffff0000, v0
    v_lshlrev_b32 v98, 16, v1
    v_and_b32 v99, 0xffff0000, v1
    v_lshlrev_b32 v100, 16, v2
    v_and_b32 v101, 0xffff0000, v2
    v_lshlrev_b32 v102, 16, v3
    v_and_b32 v103, 0xffff0000, v3
    v_mul_f32 v96, 0x3fb8aa3b, v96
    v_mul_f32 v97, 0x3fb8aa3b, v97
    v_mul_f32 v98, 0x3fb8aa3b, v98
    v_mul_f32 v99, 0x3fb8aa3b, v99
    v_mul_f32 v100, 0x3fb8aa3b, v100
    v_mul_f32 v101, 0x3fb8aa3b, v101
    v_mul_f32 v102, 0x3fb8aa3b, v102
    v_mul_f32 v103, 0x3fb8aa3b, v103
    v_exp_f32 v96, v96
    v_exp_f32 v97, v97
    v_exp_f32 v98, v98
    v_exp_f32 v99, v99
    v_exp_f32 v100, v100
    v_exp_f32 v101, v101
    v_exp_f32 v102, v102
    v_exp_f32 v103, v103
    v_cvt_pk_bf16_f32 v76, v96, v97
    v_cvt_pk_bf16_f32 v77, v98, v99
    v_cvt_pk_bf16_f32 v78, v100, v101
    v_cvt_pk_bf16_f32 v79, v102, v103
    v_mfma_f32_4x4x4_16b_bf16 v[16:19], v[48:49], v[104:105], 0
    v_mfma_f32_4x4x4_16b_bf16 v[24:27], v[52:53], v[104:105], 0
    v_mfma_f32_4x4x4_16b_bf16 v[20:23], v[48:49], v[76:77], 0
    v_mfma_f32_4x4x4_16b_bf16 v[28:31], v[52:53], v[76:77], 0
    v_mfma_f32_4x4x4_16b_bf16 v[16:19], v[50:51], v[106:107], v[16:19]
    v_mfma_f32_4x4x4_16b_bf16 v[24:27], v[54:55], v[106:107], v[24:27]
    v_mfma_f32_4x4x4_16b_bf16 v[20:23], v[50:51], v[78:79], v[20:23]
    v_mfma_f32_4x4x4_16b_bf16 v[28:31], v[54:55], v[78:79], v[28:31]
L2_f5:
    s_waitcnt vmcnt(0) lgkmcnt(0)
    v_mfma_f32_4x4x4_16b_bf16 v[96:99], v[10:11], v[32:33], 0
    v_mfma_f32_4x4x4_16b_bf16 v[100:103], v[10:11], v[34:35], 0
    s_nop 0
    v_mfma_f32_4x4x4_16b_bf16 v[96:99], v[10:11], v[36:37], v[96:99]
    v_mfma_f32_4x4x4_16b_bf16 v[100:103], v[10:11], v[38:39], v[100:103]
    s_nop 0
    v_mfma_f32_4x4x4_16b_bf16 v[96:99], v[10:11], v[40:41], v[96:99]
    v_mfma_f32_4x4x4_16b_bf16 v[100:103], v[10:11], v[42:43], v[100:103]
    s_nop 0
    v_mfma_f32_4x4x4_16b_bf16 v[96:99], v[10:11], v[44:45], v[96:99]
    v_mfma_f32_4x4x4_16b_bf16 v[100:103], v[10:11], v[46:47], v[100:103]
    s_nop 3
    v_mul_f32 v96, v96, v80
    v_mul_f32 v97, v97, v81
    v_mul_f32 v98, v98, v82
    v_mul_f32 v99, v99, v83
    v_cvt_pk_bf16_f32 v32, v96, v97
    v_cvt_pk_bf16_f32 v33, v98, v99
    v_mul_f32 v100, v100, v84
    v_mul_f32 v101, v101, v85
    v_mul_f32 v102, v102, v86
    v_mul_f32 v103, v103, v87
    v_cvt_pk_bf16_f32 v34, v100, v101
    v_cvt_pk_bf16_f32 v35, v102, v103
    v_mfma_f32_4x4x4_16b_bf16 v[80:83], v[56:57], v[32:33], 0
    s_nop 0
    v_mfma_f32_4x4x4_16b_bf16 v[84:87], v[56:57], v[34:35], 0
    s_nop 2
    v_mul_f32 v80, v80, v88
    v_mul_f32 v81, v81, v89
    v_mul_f32 v82, v82, v90
    v_mul_f32 v83, v83, v91
    v_mul_f32 v84, v84, v92
    v_mul_f32 v85, v85, v93
    v_mul_f32 v86, v86, v94
    v_mul_f32 v87, v87, v95
    v_mfma_f32_4x4x4_16b_bf16 v[96:99], v[10:11], v[108:109], v[80:83]
    s_nop 0
    v_mfma_f32_4x4x4_16b_bf16 v[100:103], v[10:11], v[110:111], v[84:87]
    s_nop 2
    v_cvt_pk_bf16_f32 v36, v96, v97
    v_cvt_pk_bf16_f32 v37, v98, v99
    v_cvt_pk_bf16_f32 v38, v100, v101
    v_cvt_pk_bf16_f32 v39, v102, v103
    buffer_store_dwordx4 v[36:39], v120, s[12:15], 0 offen nt
    s_cmp_ge_u32 s32, 4
    s_cbranch_scc1 L2_f6
    v_mfma_f32_4x4x4_16b_bf16 v[96:99], v[10:11], v[60:61], 0
    v_mfma_f32_4x4x4_16b_bf16 v[100:103], v[10:11], v[62:63], 0
    s_nop 0
    v_mfma_f32_4x4x4_16b_bf16 v[96:99], v[10:11], v[64:65], v[96:99]
    v_mfma_f32_4x4x4_16b_bf16 v[100:103], v[10:11], v[66:67], v[100:103]
    s_nop 0
    v_mfma_f32_4x4x4_16b_bf16 v[96:99], v[10:11], v[68:69], v[96:99]
    v_mfma_f32_4x4x4_16b_bf16 v[100:103], v[10:11], v[70:71], v[100:103]
    s_nop 0
    v_mfma_f32_4x4x4_16b_bf16 v[96:99], v[10:11], v[72:73], v[96:99]
    v_mfma_f32_4x4x4_16b_bf16 v[100:103], v[10:11], v[74:75], v[100:103]
    s_nop 3
    v_mul_f32 v96, v96, v16
    v_mul_f32 v97, v97, v17
    v_mul_f32 v98, v98, v18
    v_mul_f32 v99, v99, v19
    v_cvt_pk_bf16_f32 v60, v96, v97
    v_cvt_pk_bf16_f32 v61, v98, v99
    v_mul_f32 v100, v100, v20
    v_mul_f32 v101, v101, v21
    v_mul_f32 v102, v102, v22
    v_mul_f32 v103, v103, v23
    v_cvt_pk_bf16_f32 v62, v100, v101
    v_cvt_pk_bf16_f32 v63, v102, v103
    v_mfma_f32_4x4x4_16b_bf16 v[16:19], v[56:57], v[60:61], 0
    s_nop 0
    v_mfma_f32_4x4x4_16b_bf16 v[20:23], v[56:57], v[62:63], 0
    s_nop 2
    v_mul_f32 v16, v16, v24
    v_mul_f32 v17, v17, v25
    v_mul_f32 v18, v18, v26
    v_mul_f32 v19, v19, v27
    v_mul_f32 v20, v20, v28
    v_mul_f32 v21, v21, v29
    v_mul_f32 v22, v22, v30
    v_mul_f32 v23, v23, v31
    v_mfma_f32_4x4x4_16b_bf16 v[96:99], v[10:11], v[112:113], v[16:19]
    s_nop 0
    v_mfma_f32_4x4x4_16b_bf16 v[100:103], v[10:11], v[114:115], v[20:23]
    s_nop 2
    v_cvt_pk_bf16_f32 v64, v96, v97
    v_cvt_pk_bf16_f32 v65, v98, v99
    v_cvt_pk_bf16_f32 v66, v100, v101
    v_cvt_pk_bf16_f32 v67, v102, v103
    buffer_store_dwordx4 v[64:67], v121, s[12:15], 0 offen nt
L2_f6:
L2_end:
    s_endpgm
L2_slow:
    s_lshr_b32 s35, s42, 2
    s_lshl_b32 s50, s32, 4
    s_and_b32 s3, s42, 3
    s_lshl_b32 s53, s3, 3
    s_add_u32 s53, s53, s39
    s_and_b32 s3, s35, 2
    s_lshl_b32 s3, s3, 1
    s_add_u32 s53, s53, s3
    s_and_b32 s54, s35, 1
    s_lshl_b32 s54, s54, 4
L2_sl_seg:
    s_mul_i32 s55, s50, 173056
    s_and_b32 s3, s50, 3
    s_lshl_b32 s3, s3, 5
    s_add_u32 s3, s3, s55
    s_add_u32 s3, s3, s53
    buffer_load_dword v104, off, s[12:15], s3 sc1
    buffer_load_dword v105, off, s[12:15], s3 offset:32 sc1
    s_waitcnt vmcnt(0)
    v_readfirstlane_b32 s51, v104
    v_readfirstlane_b32 s52, v105
    s_lshr_b32 s51, s51, s54
    s_and_b32 s51, s51, 0xffff
    s_lshr_b32 s52, s52, s54
    s_and_b32 s52, s52, 0xffff
L2_sl_rec:
    s_cmp_ge_u32 s51, s52
    s_cbranch_scc1 L2_sl_next
    v_mbcnt_lo_u32_b32 v102, -1, 0
    v_mbcnt_hi_u32_b32 v102, -1, v102
    v_add_u32 v102, s51, v102
    v_and_b32 v103, -4, v102
    v_lshl_add_u32 v104, v102, 2, v103
    v_lshl_add_u32 v105, v103, 2, v102
    v_cmp_gt_u32 vcc, s52, v102
    s_mov_b64 exec, vcc
    buffer_load_dword v106, v104, s[8:11], s55 offen
    buffer_load_ubyte v107, v105, s[8:11], s55 offen offset:16
    s_waitcnt vmcnt(0)
    v_lshrrev_b32 v98, 14, v106
    v_and_b32 v98, v5, v98
    ds_read_b64 v[100:101], v98
    v_perm_b32 v97, v106, v107, s44
    v_and_b32 v96, v5, v106
    v_bitop3_b32 v103, v106, 0.5, -0.5 bitop3:0xa8
    v_bitop3_b32 v97, v6, v97, v103 bitop3:0xca
    s_waitcnt lgkmcnt(0)
    v_mfma_f32_4x4x4_16b_bf16 v[88:91], v[8:9], v[100:101], 0
    s_nop 4
    v_mul_f32 v88, v97, v88
    v_mul_f32 v89, v97, v89
    v_mul_f32 v90, v97, v90
    v_mul_f32 v91, v97, v91
    v_cvt_pk_bf16_f32 v88, v88, v89
    v_cvt_pk_bf16_f32 v89, v90, v91
    ds_pk_add_bf16 v96, v88 offset:65408
    ds_pk_add_bf16 v96, v89 offset:65412
    s_mov_b64 exec, -1
    s_add_u32 s51, s51, 64
    s_branch L2_sl_rec
L2_sl_next:
    s_add_u32 s50, s50, 1
    s_and_b32 s3, s50, 15
    s_cbranch_scc1 L2_sl_seg
    s_add_u32 s50, s50, 240
    s_cmp_lt_u32 s50, 1280
    s_cbranch_scc1 L2_sl_seg
    s_waitcnt lgkmcnt(0)
    s_cmp_eq_u32 s42, 0
    s_cbranch_scc1 L2_ret0
    s_cmp_eq_u32 s42, 1
    s_cbranch_scc1 L2_ret1
    s_cmp_eq_u32 s42, 14
    s_cbranch_scc1 L2_ret6
    s_cmp_eq_u32 s42, 15
    s_cbranch_scc1 L2_ret7
    s_and_b32 s3, s42, 3
    s_cmp_eq_u32 s3, 2
    s_cbranch_scc1 L2_ret2
    s_cmp_eq_u32 s3, 3
    s_cbranch_scc1 L2_ret3
    s_cmp_eq_u32 s3, 0
    s_cbranch_scc1 L2_ret4
    s_branch L2_ret5
L2_xo3:
    v_cmp_lt_u32 vcc, 20, v99
    s_mov_b32 s101, 1
    s_cbranch_vccz L2_xp3
    v_cmp_lt_u32 vcc, 32, v99
    v_cmp_lt_u32 s[58:59], 31, v88
    s_mov_b32 s101, 2
    s_or_b64 vcc, vcc, s[58:59]
    s_cbranch_scc0 L2_xp3
    s_mov_b32 s37, 0x10000
    s_branch L2_xp3
L2_xa4:
    s_cmp_eq_u32 s101, 1
    s_cbranch_scc1 L2_xc4
    v_lshlrev_b32 v89, 0, v96
    v_add_u32 v90, 140, v97
    v_bitop3_b32 v90, v89, v45, v90 bitop3:0x6a
    ds_write_b32 v98, v90 offset:28
    v_lshlrev_b32 v89, 4, v96
    v_add_u32 v90, 120, v97
    v_bitop3_b32 v90, v89, v45, v90 bitop3:0x6a
    ds_write_b32 v98, v90 offset:24
    v_lshlrev_b32 v89, 8, v96
    v_add_u32 v90, 100, v97
    v_bitop3_b32 v90, v89, v45, v90 bitop3:0x6a
    ds_write_b32 v98, v90 offset:20
L2_xc4:
    v_lshlrev_b32 v89, 12, v96
    v_add_u32 v90, 80, v97
    v_bitop3_b32 v90, v89, v45, v90 bitop3:0x6a
    ds_write_b32 v98, v90 offset:16
    s_branch L2_xb4
L2_xe4:
    v_cmp_lt_u32 vcc, 32, v99
    v_cmp_lt_u32 s[58:59], 31, v88
    v_lshrrev_b32 v89, 16, v96
    v_add_u32 v97, 80, v97
    s_or_b64 vcc, vcc, s[58:59]
    s_cbranch_scc1 L2_xs4
    v_lshlrev_b32 v89, v1, v89
    v_and_b32 v89, v45, v89
    v_cmp_ne_u32 vcc, 0, v89
    v_xor_b32 v90, v97, v89
    s_add_u32 s3, s37, s38
    v_mbcnt_lo_u32_b32 v98, vcc_lo, 0
    v_mbcnt_hi_u32_b32 v98, vcc_hi, v98
    s_bcnt1_i32_b64 s41, vcc
    v_lshl_add_u32 v98, v98, 2, s3
    s_lshl2_add_u32 s37, s41, s37
    s_mov_b64 exec, vcc
    ds_write_b32 v98, v90
    s_mov_b64 exec, -1
    s_branch L2_xr4
L2_xs4:
    s_waitcnt lgkmcnt(0)
    s_mov_b32 s37, 0x10000
    s_branch L2_xw4
L2_xf4:
    s_cmp_gt_u32 s37, 1024
    s_cbranch_scc1 L2_xt4
    s_cmp_lt_u32 s37, 768
    s_cbranch_scc1 L2_xl4
    ds_read_b32 v32, v44 offset:896
    s_add_u32 s3, s42, 0
    s_bitset1_b32 s43, s3
    s_branch L2_xg4
L2_xl4:
    s_waitcnt lgkmcnt(0)
    v_mov_b32 v31, -1
    s_cmp_ge_u32 s37, 512
    s_cbranch_scc1 L2_xg4
    v_mov_b32 v39, -1
    s_cmp_ge_u32 s37, 256
    s_cbranch_scc1 L2_xg4
    v_mov_b32 v27, -1
    s_branch L2_xg4
L2_xt4:
    s_waitcnt lgkmcnt(0)
    v_mov_b32 v21, -1
    v_mov_b32 v27, -1
    v_mov_b32 v39, -1
    v_mov_b32 v31, -1
    s_add_u32 s3, s42, 0
    s_bitset1_b32 s36, s3
    s_branch L2_xg4
L2_xo5:
    v_cmp_lt_u32 vcc, 20, v99
    s_mov_b32 s101, 1
    s_cbranch_vccz L2_xp5
    v_cmp_lt_u32 vcc, 32, v99
    v_cmp_lt_u32 s[58:59], 31, v88
    s_mov_b32 s101, 2
    s_or_b64 vcc, vcc, s[58:59]
    s_cbranch_scc0 L2_xp5
    s_mov_b32 s37, 0x10000
    s_branch L2_xp5
L2_xa6:
    s_cmp_eq_u32 s101, 1
    s_cbranch_scc1 L2_xc6
    v_lshlrev_b32 v89, 0, v96
    v_add_u32 v90, 140, v97
    v_bitop3_b32 v90, v89, v45, v90 bitop3:0x6a
    ds_write_b32 v98, v90 offset:28
    v_lshlrev_b32 v89, 4, v96
    v_add_u32 v90, 120, v97
    v_bitop3_b32 v90, v89, v45, v90 bitop3:0x6a
    ds_write_b32 v98, v90 offset:24
    v_lshlrev_b32 v89, 8, v96
    v_add_u32 v90, 100, v97
    v_bitop3_b32 v90, v89, v45, v90 bitop3:0x6a
    ds_write_b32 v98, v90 offset:20
L2_xc6:
    v_lshlrev_b32 v89, 12, v96
    v_add_u32 v90, 80, v97
    v_bitop3_b32 v90, v89, v45, v90 bitop3:0x6a
    ds_write_b32 v98, v90 offset:16
    s_branch L2_xb6
L2_xe6:
    v_cmp_lt_u32 vcc, 32, v99
    v_cmp_lt_u32 s[58:59], 31, v88
    v_lshrrev_b32 v89, 16, v96
    v_add_u32 v97, 80, v97
    s_or_b64 vcc, vcc, s[58:59]
    s_cbranch_scc1 L2_xs6
    v_lshlrev_b32 v89, v1, v89
    v_and_b32 v89, v45, v89
    v_cmp_ne_u32 vcc, 0, v89
    v_xor_b32 v90, v97, v89
    s_add_u32 s3, s37, s38
    v_mbcnt_lo_u32_b32 v98, vcc_lo, 0
    v_mbcnt_hi_u32_b32 v98, vcc_hi, v98
    s_bcnt1_i32_b64 s41, vcc
    v_lshl_add_u32 v98, v98, 2, s3
    s_lshl2_add_u32 s37, s41, s37
    s_mov_b64 exec, vcc
    ds_write_b32 v98, v90
    s_mov_b64 exec, -1
    s_branch L2_xr6
L2_xs6:
    s_waitcnt lgkmcnt(0)
    s_mov_b32 s37, 0x10000
    s_branch L2_xw6
L2_xf6:
    s_cmp_gt_u32 s37, 1024
    s_cbranch_scc1 L2_xt6
    s_cmp_lt_u32 s37, 768
    s_cbranch_scc1 L2_xl6
    ds_read_b32 v33, v44 offset:896
    s_add_u32 s3, s42, 1
    s_bitset1_b32 s43, s3
    s_branch L2_xg6
L2_xl6:
    s_waitcnt lgkmcnt(0)
    v_mov_b32 v42, -1
    s_cmp_ge_u32 s37, 512
    s_cbranch_scc1 L2_xg6
    v_mov_b32 v43, -1
    s_cmp_ge_u32 s37, 256
    s_cbranch_scc1 L2_xg6
    v_mov_b32 v41, -1
    s_branch L2_xg6
L2_xt6:
    s_waitcnt lgkmcnt(0)
    v_mov_b32 v40, -1
    v_mov_b32 v41, -1
    v_mov_b32 v43, -1
    v_mov_b32 v42, -1
    s_add_u32 s3, s42, 1
    s_bitset1_b32 s36, s3
    s_branch L2_xg6
L2_oa7:
    v_and_b32 v47, 0x0fffffff, v32
    buffer_load_dword v78, v47, s[8:11], 0 offen offset:16
    s_mov_b64 exec, s[6:7]
    v_add_u32 v47, 8, v47
    v_lshrrev_b32 v32, 2, v32
    s_mov_b64 exec, -1
    buffer_load_dwordx2 v[76:77], v47, s[8:11], 0 offen
    s_branch L2_ob7
L2_oa8:
    s_waitcnt vmcnt(0)
    s_mov_b64 exec, s[6:7]
    v_lshrrev_b32 v78, 16, v78
    s_mov_b64 exec, -1
    v_and_b32 v46, 0x10000000, v32
    v_cmpx_eq_u32 vcc, 0, v46
    v_lshrrev_b32 v47, 14, v76
    v_and_b32 v47, v5, v47
    ds_read_b64 v[96:97], v47
    v_perm_b32 v98, v76, v78, s44
    v_bitop3_b32 v99, v76, 0.5, -0.5 bitop3:0xa8
    v_bitop3_b32 v98, v6, v98, v99 bitop3:0xca
    v_and_b32 v47, v5, v76
    s_waitcnt lgkmcnt(0)
    v_mfma_f32_4x4x4_16b_bf16 v[88:91], v[8:9], v[96:97], 0
    s_nop 4
    v_mul_f32 v88, v98, v88
    v_mul_f32 v89, v98, v89
    v_mul_f32 v90, v98, v90
    v_mul_f32 v91, v98, v91
    v_cvt_pk_bf16_f32 v88, v88, v89
    v_cvt_pk_bf16_f32 v89, v90, v91
    ds_pk_add_bf16 v47, v88 offset:65408
    ds_pk_add_bf16 v47, v89 offset:65412
    s_mov_b64 exec, -1
    v_and_b32 v46, 0x20000000, v32
    v_cmpx_eq_u32 vcc, 0, v46
    v_lshrrev_b32 v47, 14, v77
    v_and_b32 v47, v5, v47
    ds_read_b64 v[96:97], v47
    v_perm_b32 v98, v77, v78, s45
    v_bitop3_b32 v99, v77, 0.5, -0.5 bitop3:0xa8
    v_bitop3_b32 v98, v6, v98, v99 bitop3:0xca
    v_and_b32 v47, v5, v77
    s_waitcnt lgkmcnt(0)
    v_mfma_f32_4x4x4_16b_bf16 v[88:91], v[8:9], v[96:97], 0
    s_nop 4
    v_mul_f32 v88, v98, v88
    v_mul_f32 v89, v98, v89
    v_mul_f32 v90, v98, v90
    v_mul_f32 v91, v98, v91
    v_cvt_pk_bf16_f32 v88, v88, v89
    v_cvt_pk_bf16_f32 v89, v90, v91
    ds_pk_add_bf16 v47, v88 offset:65408
    ds_pk_add_bf16 v47, v89 offset:65412
    s_mov_b64 exec, -1
    s_branch L2_ob8
L2_c9:
    s_lshl_b64 s[52:53], s[82:83], 1
    s_andn2_b64 s[52:53], s[52:53], s[80:81]
    s_andn2_b64 s[52:53], s[52:53], s[54:55]
    s_or_b64 s[80:81], s[80:81], s[52:53]
    s_not_b64 vcc, s[52:53]
    s_mov_b64 exec, -1
    v_cndmask_b32_dpp v84, v84, v84, vcc wave_shr:1 row_mask:0xf bank_mask:0xf
    v_cndmask_b32_dpp v85, v85, v85, vcc wave_shr:1 row_mask:0xf bank_mask:0xf
    s_lshr_b64 s[52:53], s[52:53], 1
    v_cndmask_b32_dpp v86, v86, v86, vcc wave_shr:1 row_mask:0xf bank_mask:0xf
    v_cndmask_b32_dpp v87, v87, v87, vcc wave_shr:1 row_mask:0xf bank_mask:0xf
    s_andn2_b64 s[82:83], s[82:83], s[52:53]
    v_cndmask_b32_dpp v7, v7, v7, vcc wave_shr:1 row_mask:0xf bank_mask:0xf
    s_mov_b64 exec, s[54:55]
    s_cbranch_scc0 L2_d9
    s_mov_b64 exec, s[82:83]
    s_nop 1
    v_mfma_f32_4x4x4_16b_bf16 v[88:91], v[12:13], v[84:85], 0
    s_nop 1
    v_mfma_f32_4x4x4_16b_bf16 v[88:91], v[10:11], v[86:87], v[88:91]
    s_nop 4
    v_cvt_pk_bf16_f32 v88, v88, v89
    v_cvt_pk_bf16_f32 v89, v90, v91
    ds_pk_add_bf16 v7, v88 offset:65408
    ds_pk_add_bf16 v7, v89 offset:65412
    s_mov_b64 exec, s[54:55]
    s_branch L2_d9
L2_c10:
    s_lshl_b64 s[52:53], s[82:83], 1
    s_andn2_b64 s[52:53], s[52:53], s[80:81]
    s_andn2_b64 s[52:53], s[52:53], s[50:51]
    s_or_b64 s[80:81], s[80:81], s[52:53]
    s_not_b64 vcc, s[52:53]
    s_mov_b64 exec, -1
    v_cndmask_b32_dpp v84, v84, v84, vcc wave_shr:1 row_mask:0xf bank_mask:0xf
    v_cndmask_b32_dpp v85, v85, v85, vcc wave_shr:1 row_mask:0xf bank_mask:0xf
    s_lshr_b64 s[52:53], s[52:53], 1
    v_cndmask_b32_dpp v86, v86, v86, vcc wave_shr:1 row_mask:0xf bank_mask:0xf
    v_cndmask_b32_dpp v87, v87, v87, vcc wave_shr:1 row_mask:0xf bank_mask:0xf
    s_andn2_b64 s[82:83], s[82:83], s[52:53]
    v_cndmask_b32_dpp v7, v7, v7, vcc wave_shr:1 row_mask:0xf bank_mask:0xf
    s_mov_b64 exec, s[50:51]
    s_cbranch_scc0 L2_d10
    s_mov_b64 exec, s[82:83]
    s_nop 1
    v_mfma_f32_4x4x4_16b_bf16 v[88:91], v[12:13], v[84:85], 0
    s_nop 1
    v_mfma_f32_4x4x4_16b_bf16 v[88:91], v[10:11], v[86:87], v[88:91]
    s_nop 4
    v_cvt_pk_bf16_f32 v88, v88, v89
    v_cvt_pk_bf16_f32 v89, v90, v91
    ds_pk_add_bf16 v7, v88 offset:65408
    ds_pk_add_bf16 v7, v89 offset:65412
    s_mov_b64 exec, s[50:51]
    s_branch L2_d10
L2_c13:
    s_lshl_b64 s[52:53], s[82:83], 1
    s_andn2_b64 s[52:53], s[52:53], s[80:81]
    s_andn2_b64 s[52:53], s[52:53], s[54:55]
    s_or_b64 s[80:81], s[80:81], s[52:53]
    s_not_b64 vcc, s[52:53]
    s_mov_b64 exec, -1
    v_cndmask_b32_dpp v84, v84, v84, vcc wave_shr:1 row_mask:0xf bank_mask:0xf
    v_cndmask_b32_dpp v85, v85, v85, vcc wave_shr:1 row_mask:0xf bank_mask:0xf
    s_lshr_b64 s[52:53], s[52:53], 1
    v_cndmask_b32_dpp v86, v86, v86, vcc wave_shr:1 row_mask:0xf bank_mask:0xf
    v_cndmask_b32_dpp v87, v87, v87, vcc wave_shr:1 row_mask:0xf bank_mask:0xf
    s_andn2_b64 s[82:83], s[82:83], s[52:53]
    v_cndmask_b32_dpp v7, v7, v7, vcc wave_shr:1 row_mask:0xf bank_mask:0xf
    s_mov_b64 exec, s[54:55]
    s_cbranch_scc0 L2_d13
    s_mov_b64 exec, s[82:83]
    s_nop 1
    v_mfma_f32_4x4x4_16b_bf16 v[88:91], v[12:13], v[84:85], 0
    s_nop 1
    v_mfma_f32_4x4x4_16b_bf16 v[88:91], v[10:11], v[86:87], v[88:91]
    s_nop 4
    v_cvt_pk_bf16_f32 v88, v88, v89
    v_cvt_pk_bf16_f32 v89, v90, v91
    ds_pk_add_bf16 v7, v88 offset:65408
    ds_pk_add_bf16 v7, v89 offset:65412
    s_mov_b64 exec, s[54:55]
    s_branch L2_d13
L2_c14:
    s_lshl_b64 s[52:53], s[82:83], 1
    s_andn2_b64 s[52:53], s[52:53], s[80:81]
    s_andn2_b64 s[52:53], s[52:53], s[50:51]
    s_or_b64 s[80:81], s[80:81], s[52:53]
    s_not_b64 vcc, s[52:53]
    s_mov_b64 exec, -1
    v_cndmask_b32_dpp v84, v84, v84, vcc wave_shr:1 row_mask:0xf bank_mask:0xf
    v_cndmask_b32_dpp v85, v85, v85, vcc wave_shr:1 row_mask:0xf bank_mask:0xf
    s_lshr_b64 s[52:53], s[52:53], 1
    v_cndmask_b32_dpp v86, v86, v86, vcc wave_shr:1 row_mask:0xf bank_mask:0xf
    v_cndmask_b32_dpp v87, v87, v87, vcc wave_shr:1 row_mask:0xf bank_mask:0xf
    s_andn2_b64 s[82:83], s[82:83], s[52:53]
    v_cndmask_b32_dpp v7, v7, v7, vcc wave_shr:1 row_mask:0xf bank_mask:0xf
    s_mov_b64 exec, s[50:51]
    s_cbranch_scc0 L2_d14
    s_mov_b64 exec, s[82:83]
    s_nop 1
    v_mfma_f32_4x4x4_16b_bf16 v[88:91], v[12:13], v[84:85], 0
    s_nop 1
    v_mfma_f32_4x4x4_16b_bf16 v[88:91], v[10:11], v[86:87], v[88:91]
    s_nop 4
    v_cvt_pk_bf16_f32 v88, v88, v89
    v_cvt_pk_bf16_f32 v89, v90, v91
    ds_pk_add_bf16 v7, v88 offset:65408
    ds_pk_add_bf16 v7, v89 offset:65412
    s_mov_b64 exec, s[50:51]
    s_branch L2_d14
L2_xo16:
    v_cmp_lt_u32 vcc, 20, v99
    s_mov_b32 s101, 1
    s_cbranch_vccz L2_xp16
    v_cmp_lt_u32 vcc, 32, v99
    v_cmp_lt_u32 s[58:59], 31, v88
    s_mov_b32 s101, 2
    s_or_b64 vcc, vcc, s[58:59]
    s_cbranch_scc0 L2_xp16
    s_mov_b32 s37, 0x10000
    s_branch L2_xp16
L2_c17:
    s_lshl_b64 s[52:53], s[82:83], 1
    s_andn2_b64 s[52:53], s[52:53], s[80:81]
    s_andn2_b64 s[52:53], s[52:53], s[54:55]
    s_or_b64 s[80:81], s[80:81], s[52:53]
    s_not_b64 vcc, s[52:53]
    s_mov_b64 exec, -1
    v_cndmask_b32_dpp v84, v84, v84, vcc wave_shr:1 row_mask:0xf bank_mask:0xf
    v_cndmask_b32_dpp v85, v85, v85, vcc wave_shr:1 row_mask:0xf bank_mask:0xf
    s_lshr_b64 s[52:53], s[52:53], 1
    v_cndmask_b32_dpp v86, v86, v86, vcc wave_shr:1 row_mask:0xf bank_mask:0xf
    v_cndmask_b32_dpp v87, v87, v87, vcc wave_shr:1 row_mask:0xf bank_mask:0xf
    s_andn2_b64 s[82:83], s[82:83], s[52:53]
    v_cndmask_b32_dpp v7, v7, v7, vcc wave_shr:1 row_mask:0xf bank_mask:0xf
    s_mov_b64 exec, s[54:55]
    s_cbranch_scc0 L2_d17
    s_mov_b64 exec, s[82:83]
    s_nop 1
    v_mfma_f32_4x4x4_16b_bf16 v[88:91], v[12:13], v[84:85], 0
    s_nop 1
    v_mfma_f32_4x4x4_16b_bf16 v[88:91], v[10:11], v[86:87], v[88:91]
    s_nop 4
    v_cvt_pk_bf16_f32 v88, v88, v89
    v_cvt_pk_bf16_f32 v89, v90, v91
    ds_pk_add_bf16 v7, v88 offset:65408
    ds_pk_add_bf16 v7, v89 offset:65412
    s_mov_b64 exec, s[54:55]
    s_branch L2_d17
L2_c18:
    s_lshl_b64 s[52:53], s[82:83], 1
    s_andn2_b64 s[52:53], s[52:53], s[80:81]
    s_andn2_b64 s[52:53], s[52:53], s[50:51]
    s_or_b64 s[80:81], s[80:81], s[52:53]
    s_not_b64 vcc, s[52:53]
    s_mov_b64 exec, -1
    v_cndmask_b32_dpp v84, v84, v84, vcc wave_shr:1 row_mask:0xf bank_mask:0xf
    v_cndmask_b32_dpp v85, v85, v85, vcc wave_shr:1 row_mask:0xf bank_mask:0xf
    s_lshr_b64 s[52:53], s[52:53], 1
    v_cndmask_b32_dpp v86, v86, v86, vcc wave_shr:1 row_mask:0xf bank_mask:0xf
    v_cndmask_b32_dpp v87, v87, v87, vcc wave_shr:1 row_mask:0xf bank_mask:0xf
    s_andn2_b64 s[82:83], s[82:83], s[52:53]
    v_cndmask_b32_dpp v7, v7, v7, vcc wave_shr:1 row_mask:0xf bank_mask:0xf
    s_mov_b64 exec, s[50:51]
    s_cbranch_scc0 L2_d18
    s_mov_b64 exec, s[82:83]
    s_nop 1
    v_mfma_f32_4x4x4_16b_bf16 v[88:91], v[12:13], v[84:85], 0
    s_nop 1
    v_mfma_f32_4x4x4_16b_bf16 v[88:91], v[10:11], v[86:87], v[88:91]
    s_nop 4
    v_cvt_pk_bf16_f32 v88, v88, v89
    v_cvt_pk_bf16_f32 v89, v90, v91
    ds_pk_add_bf16 v7, v88 offset:65408
    ds_pk_add_bf16 v7, v89 offset:65412
    s_mov_b64 exec, s[50:51]
    s_branch L2_d18
L2_c21:
    s_lshl_b64 s[52:53], s[82:83], 1
    s_andn2_b64 s[52:53], s[52:53], s[80:81]
    s_andn2_b64 s[52:53], s[52:53], s[54:55]
    s_or_b64 s[80:81], s[80:81], s[52:53]
    s_not_b64 vcc, s[52:53]
    s_mov_b64 exec, -1
    v_cndmask_b32_dpp v84, v84, v84, vcc wave_shr:1 row_mask:0xf bank_mask:0xf
    v_cndmask_b32_dpp v85, v85, v85, vcc wave_shr:1 row_mask:0xf bank_mask:0xf
    s_lshr_b64 s[52:53], s[52:53], 1
    v_cndmask_b32_dpp v86, v86, v86, vcc wave_shr:1 row_mask:0xf bank_mask:0xf
    v_cndmask_b32_dpp v87, v87, v87, vcc wave_shr:1 row_mask:0xf bank_mask:0xf
    s_andn2_b64 s[82:83], s[82:83], s[52:53]
    v_cndmask_b32_dpp v7, v7, v7, vcc wave_shr:1 row_mask:0xf bank_mask:0xf
    s_mov_b64 exec, s[54:55]
    s_cbranch_scc0 L2_d21
    s_mov_b64 exec, s[82:83]
    s_nop 1
    v_mfma_f32_4x4x4_16b_bf16 v[88:91], v[12:13], v[84:85], 0
    s_nop 1
    v_mfma_f32_4x4x4_16b_bf16 v[88:91], v[10:11], v[86:87], v[88:91]
    s_nop 4
    v_cvt_pk_bf16_f32 v88, v88, v89
    v_cvt_pk_bf16_f32 v89, v90, v91
    ds_pk_add_bf16 v7, v88 offset:65408
    ds_pk_add_bf16 v7, v89 offset:65412
    s_mov_b64 exec, s[54:55]
    s_branch L2_d21
L2_c22:
    s_lshl_b64 s[52:53], s[82:83], 1
    s_andn2_b64 s[52:53], s[52:53], s[80:81]
    s_andn2_b64 s[52:53], s[52:53], s[50:51]
    s_or_b64 s[80:81], s[80:81], s[52:53]
    s_not_b64 vcc, s[52:53]
    s_mov_b64 exec, -1
    v_cndmask_b32_dpp v84, v84, v84, vcc wave_shr:1 row_mask:0xf bank_mask:0xf
    v_cndmask_b32_dpp v85, v85, v85, vcc wave_shr:1 row_mask:0xf bank_mask:0xf
    s_lshr_b64 s[52:53], s[52:53], 1
    v_cndmask_b32_dpp v86, v86, v86, vcc wave_shr:1 row_mask:0xf bank_mask:0xf
    v_cndmask_b32_dpp v87, v87, v87, vcc wave_shr:1 row_mask:0xf bank_mask:0xf
    s_andn2_b64 s[82:83], s[82:83], s[52:53]
    v_cndmask_b32_dpp v7, v7, v7, vcc wave_shr:1 row_mask:0xf bank_mask:0xf
    s_mov_b64 exec, s[50:51]
    s_cbranch_scc0 L2_d22
    s_mov_b64 exec, s[82:83]
    s_nop 1
    v_mfma_f32_4x4x4_16b_bf16 v[88:91], v[12:13], v[84:85], 0
    s_nop 1
    v_mfma_f32_4x4x4_16b_bf16 v[88:91], v[10:11], v[86:87], v[88:91]
    s_nop 4
    v_cvt_pk_bf16_f32 v88, v88, v89
    v_cvt_pk_bf16_f32 v89, v90, v91
    ds_pk_add_bf16 v7, v88 offset:65408
    ds_pk_add_bf16 v7, v89 offset:65412
    s_mov_b64 exec, s[50:51]
    s_branch L2_d22
L2_c23:
    s_lshl_b64 s[52:53], s[82:83], 1
    s_andn2_b64 s[52:53], s[52:53], s[80:81]
    s_andn2_b64 s[52:53], s[52:53], s[54:55]
    s_or_b64 s[80:81], s[80:81], s[52:53]
    s_not_b64 vcc, s[52:53]
    s_mov_b64 exec, -1
    v_cndmask_b32_dpp v84, v84, v84, vcc wave_shr:1 row_mask:0xf bank_mask:0xf
    v_cndmask_b32_dpp v85, v85, v85, vcc wave_shr:1 row_mask:0xf bank_mask:0xf
    s_lshr_b64 s[52:53], s[52:53], 1
    v_cndmask_b32_dpp v86, v86, v86, vcc wave_shr:1 row_mask:0xf bank_mask:0xf
    v_cndmask_b32_dpp v87, v87, v87, vcc wave_shr:1 row_mask:0xf bank_mask:0xf
    s_andn2_b64 s[82:83], s[82:83], s[52:53]
    v_cndmask_b32_dpp v7, v7, v7, vcc wave_shr:1 row_mask:0xf bank_mask:0xf
    s_mov_b64 exec, s[54:55]
    s_cbranch_scc0 L2_d23
    s_mov_b64 exec, s[82:83]
    s_nop 1
    v_mfma_f32_4x4x4_16b_bf16 v[88:91], v[12:13], v[84:85], 0
    s_nop 1
    v_mfma_f32_4x4x4_16b_bf16 v[88:91], v[10:11], v[86:87], v[88:91]
    s_nop 4
    v_cvt_pk_bf16_f32 v88, v88, v89
    v_cvt_pk_bf16_f32 v89, v90, v91
    ds_pk_add_bf16 v7, v88 offset:65408
    ds_pk_add_bf16 v7, v89 offset:65412
    s_mov_b64 exec, s[54:55]
    s_branch L2_d23
L2_c24:
    s_lshl_b64 s[52:53], s[82:83], 1
    s_andn2_b64 s[52:53], s[52:53], s[80:81]
    s_andn2_b64 s[52:53], s[52:53], s[50:51]
    s_or_b64 s[80:81], s[80:81], s[52:53]
    s_not_b64 vcc, s[52:53]
    s_mov_b64 exec, -1
    v_cndmask_b32_dpp v84, v84, v84, vcc wave_shr:1 row_mask:0xf bank_mask:0xf
    v_cndmask_b32_dpp v85, v85, v85, vcc wave_shr:1 row_mask:0xf bank_mask:0xf
    s_lshr_b64 s[52:53], s[52:53], 1
    v_cndmask_b32_dpp v86, v86, v86, vcc wave_shr:1 row_mask:0xf bank_mask:0xf
    v_cndmask_b32_dpp v87, v87, v87, vcc wave_shr:1 row_mask:0xf bank_mask:0xf
    s_andn2_b64 s[82:83], s[82:83], s[52:53]
    v_cndmask_b32_dpp v7, v7, v7, vcc wave_shr:1 row_mask:0xf bank_mask:0xf
    s_mov_b64 exec, s[50:51]
    s_cbranch_scc0 L2_d24
    s_mov_b64 exec, s[82:83]
    s_nop 1
    v_mfma_f32_4x4x4_16b_bf16 v[88:91], v[12:13], v[84:85], 0
    s_nop 1
    v_mfma_f32_4x4x4_16b_bf16 v[88:91], v[10:11], v[86:87], v[88:91]
    s_nop 4
    v_cvt_pk_bf16_f32 v88, v88, v89
    v_cvt_pk_bf16_f32 v89, v90, v91
    ds_pk_add_bf16 v7, v88 offset:65408
    ds_pk_add_bf16 v7, v89 offset:65412
    s_mov_b64 exec, s[50:51]
    s_branch L2_d24
L2_xa25:
    s_cmp_eq_u32 s101, 1
    s_cbranch_scc1 L2_xc25
    v_lshlrev_b32 v89, 0, v96
    v_add_u32 v90, 140, v97
    v_bitop3_b32 v90, v89, v45, v90 bitop3:0x6a
    ds_write_b32 v98, v90 offset:28
    v_lshlrev_b32 v89, 4, v96
    v_add_u32 v90, 120, v97
    v_bitop3_b32 v90, v89, v45, v90 bitop3:0x6a
    ds_write_b32 v98, v90 offset:24
    v_lshlrev_b32 v89, 8, v96
    v_add_u32 v90, 100, v97
    v_bitop3_b32 v90, v89, v45, v90 bitop3:0x6a
    ds_write_b32 v98, v90 offset:20
L2_xc25:
    v_lshlrev_b32 v89, 12, v96
    v_add_u32 v90, 80, v97
    v_bitop3_b32 v90, v89, v45, v90 bitop3:0x6a
    ds_write_b32 v98, v90 offset:16
    s_branch L2_xb25
L2_xe25:
    v_cmp_lt_u32 vcc, 32, v99
    v_cmp_lt_u32 s[58:59], 31, v88
    v_lshrrev_b32 v89, 16, v96
    v_add_u32 v97, 80, v97
    s_or_b64 vcc, vcc, s[58:59]
    s_cbranch_scc1 L2_xs25
    v_lshlrev_b32 v89, v1, v89
    v_and_b32 v89, v45, v89
    v_cmp_ne_u32 vcc, 0, v89
    v_xor_b32 v90, v97, v89
    s_add_u32 s3, s37, s38
    v_mbcnt_lo_u32_b32 v98, vcc_lo, 0
    v_mbcnt_hi_u32_b32 v98, vcc_hi, v98
    s_bcnt1_i32_b64 s41, vcc
    v_lshl_add_u32 v98, v98, 2, s3
    s_lshl2_add_u32 s37, s41, s37
    s_mov_b64 exec, vcc
    ds_write_b32 v98, v90
    s_mov_b64 exec, -1
    s_branch L2_xr25
L2_xs25:
    s_waitcnt lgkmcnt(0)
    s_mov_b32 s37, 0x10000
    s_branch L2_xw25
L2_c26:
    s_lshl_b64 s[52:53], s[82:83], 1
    s_andn2_b64 s[52:53], s[52:53], s[80:81]
    s_andn2_b64 s[52:53], s[52:53], s[54:55]
    s_or_b64 s[80:81], s[80:81], s[52:53]
    s_not_b64 vcc, s[52:53]
    s_mov_b64 exec, -1
    v_cndmask_b32_dpp v84, v84, v84, vcc wave_shr:1 row_mask:0xf bank_mask:0xf
    v_cndmask_b32_dpp v85, v85, v85, vcc wave_shr:1 row_mask:0xf bank_mask:0xf
    s_lshr_b64 s[52:53], s[52:53], 1
    v_cndmask_b32_dpp v86, v86, v86, vcc wave_shr:1 row_mask:0xf bank_mask:0xf
    v_cndmask_b32_dpp v87, v87, v87, vcc wave_shr:1 row_mask:0xf bank_mask:0xf
    s_andn2_b64 s[82:83], s[82:83], s[52:53]
    v_cndmask_b32_dpp v7, v7, v7, vcc wave_shr:1 row_mask:0xf bank_mask:0xf
    s_mov_b64 exec, s[54:55]
    s_cbranch_scc0 L2_d26
    s_mov_b64 exec, s[82:83]
    s_nop 1
    v_mfma_f32_4x4x4_16b_bf16 v[88:91], v[12:13], v[84:85], 0
    s_nop 1
    v_mfma_f32_4x4x4_16b_bf16 v[88:91], v[10:11], v[86:87], v[88:91]
    s_nop 4
    v_cvt_pk_bf16_f32 v88, v88, v89
    v_cvt_pk_bf16_f32 v89, v90, v91
    ds_pk_add_bf16 v7, v88 offset:65408
    ds_pk_add_bf16 v7, v89 offset:65412
    s_mov_b64 exec, s[54:55]
    s_branch L2_d26
L2_c27:
    s_lshl_b64 s[52:53], s[82:83], 1
    s_andn2_b64 s[52:53], s[52:53], s[80:81]
    s_andn2_b64 s[52:53], s[52:53], s[50:51]
    s_or_b64 s[80:81], s[80:81], s[52:53]
    s_not_b64 vcc, s[52:53]
    s_mov_b64 exec, -1
    v_cndmask_b32_dpp v84, v84, v84, vcc wave_shr:1 row_mask:0xf bank_mask:0xf
    v_cndmask_b32_dpp v85, v85, v85, vcc wave_shr:1 row_mask:0xf bank_mask:0xf
    s_lshr_b64 s[52:53], s[52:53], 1
    v_cndmask_b32_dpp v86, v86, v86, vcc wave_shr:1 row_mask:0xf bank_mask:0xf
    v_cndmask_b32_dpp v87, v87, v87, vcc wave_shr:1 row_mask:0xf bank_mask:0xf
    s_andn2_b64 s[82:83], s[82:83], s[52:53]
    v_cndmask_b32_dpp v7, v7, v7, vcc wave_shr:1 row_mask:0xf bank_mask:0xf
    s_mov_b64 exec, s[50:51]
    s_cbranch_scc0 L2_d27
    s_mov_b64 exec, s[82:83]
    s_nop 1
    v_mfma_f32_4x4x4_16b_bf16 v[88:91], v[12:13], v[84:85], 0
    s_nop 1
    v_mfma_f32_4x4x4_16b_bf16 v[88:91], v[10:11], v[86:87], v[88:91]
    s_nop 4
    v_cvt_pk_bf16_f32 v88, v88, v89
    v_cvt_pk_bf16_f32 v89, v90, v91
    ds_pk_add_bf16 v7, v88 offset:65408
    ds_pk_add_bf16 v7, v89 offset:65412
    s_mov_b64 exec, s[50:51]
    s_branch L2_d27
L2_xf25:
    s_cmp_gt_u32 s37, 1024
    s_cbranch_scc1 L2_xt25
    s_cmp_lt_u32 s37, 768
    s_cbranch_scc1 L2_xl25
    ds_read_b32 v32, v44 offset:896
    s_add_u32 s3, s42, 2
    s_bitset1_b32 s43, s3
    s_branch L2_xg25
L2_xl25:
    s_waitcnt lgkmcnt(0)
    v_mov_b32 v31, -1
    s_cmp_ge_u32 s37, 512
    s_cbranch_scc1 L2_xg25
    v_mov_b32 v39, -1
    s_cmp_ge_u32 s37, 256
    s_cbranch_scc1 L2_xg25
    v_mov_b32 v27, -1
    s_branch L2_xg25
L2_xt25:
    s_waitcnt lgkmcnt(0)
    v_mov_b32 v21, -1
    v_mov_b32 v27, -1
    v_mov_b32 v39, -1
    v_mov_b32 v31, -1
    s_add_u32 s3, s42, 2
    s_bitset1_b32 s36, s3
    s_branch L2_xg25
L2_oa28:
    v_and_b32 v47, 0x0fffffff, v33
    buffer_load_dword v114, v47, s[8:11], 0 offen offset:16
    s_mov_b64 exec, s[6:7]
    v_add_u32 v47, 8, v47
    v_lshrrev_b32 v33, 2, v33
    s_mov_b64 exec, -1
    buffer_load_dwordx2 v[112:113], v47, s[8:11], 0 offen
    s_branch L2_ob28
L2_c29:
    s_lshl_b64 s[52:53], s[82:83], 1
    s_andn2_b64 s[52:53], s[52:53], s[80:81]
    s_andn2_b64 s[52:53], s[52:53], s[54:55]
    s_or_b64 s[80:81], s[80:81], s[52:53]
    s_not_b64 vcc, s[52:53]
    s_mov_b64 exec, -1
    v_cndmask_b32_dpp v84, v84, v84, vcc wave_shr:1 row_mask:0xf bank_mask:0xf
    v_cndmask_b32_dpp v85, v85, v85, vcc wave_shr:1 row_mask:0xf bank_mask:0xf
    s_lshr_b64 s[52:53], s[52:53], 1
    v_cndmask_b32_dpp v86, v86, v86, vcc wave_shr:1 row_mask:0xf bank_mask:0xf
    v_cndmask_b32_dpp v87, v87, v87, vcc wave_shr:1 row_mask:0xf bank_mask:0xf
    s_andn2_b64 s[82:83], s[82:83], s[52:53]
    v_cndmask_b32_dpp v7, v7, v7, vcc wave_shr:1 row_mask:0xf bank_mask:0xf
    s_mov_b64 exec, s[54:55]
    s_cbranch_scc0 L2_d29
    s_mov_b64 exec, s[82:83]
    s_nop 1
    v_mfma_f32_4x4x4_16b_bf16 v[88:91], v[12:13], v[84:85], 0
    s_nop 1
    v_mfma_f32_4x4x4_16b_bf16 v[88:91], v[10:11], v[86:87], v[88:91]
    s_nop 4
    v_cvt_pk_bf16_f32 v88, v88, v89
    v_cvt_pk_bf16_f32 v89, v90, v91
    ds_pk_add_bf16 v7, v88 offset:65408
    ds_pk_add_bf16 v7, v89 offset:65412
    s_mov_b64 exec, s[54:55]
    s_branch L2_d29
L2_c30:
    s_lshl_b64 s[52:53], s[82:83], 1
    s_andn2_b64 s[52:53], s[52:53], s[80:81]
    s_andn2_b64 s[52:53], s[52:53], s[50:51]
    s_or_b64 s[80:81], s[80:81], s[52:53]
    s_not_b64 vcc, s[52:53]
    s_mov_b64 exec, -1
    v_cndmask_b32_dpp v84, v84, v84, vcc wave_shr:1 row_mask:0xf bank_mask:0xf
    v_cndmask_b32_dpp v85, v85, v85, vcc wave_shr:1 row_mask:0xf bank_mask:0xf
    s_lshr_b64 s[52:53], s[52:53], 1
    v_cndmask_b32_dpp v86, v86, v86, vcc wave_shr:1 row_mask:0xf bank_mask:0xf
    v_cndmask_b32_dpp v87, v87, v87, vcc wave_shr:1 row_mask:0xf bank_mask:0xf
    s_andn2_b64 s[82:83], s[82:83], s[52:53]
    v_cndmask_b32_dpp v7, v7, v7, vcc wave_shr:1 row_mask:0xf bank_mask:0xf
    s_mov_b64 exec, s[50:51]
    s_cbranch_scc0 L2_d30
    s_mov_b64 exec, s[82:83]
    s_nop 1
    v_mfma_f32_4x4x4_16b_bf16 v[88:91], v[12:13], v[84:85], 0
    s_nop 1
    v_mfma_f32_4x4x4_16b_bf16 v[88:91], v[10:11], v[86:87], v[88:91]
    s_nop 4
    v_cvt_pk_bf16_f32 v88, v88, v89
    v_cvt_pk_bf16_f32 v89, v90, v91
    ds_pk_add_bf16 v7, v88 offset:65408
    ds_pk_add_bf16 v7, v89 offset:65412
    s_mov_b64 exec, s[50:51]
    s_branch L2_d30
L2_c31:
    s_lshl_b64 s[52:53], s[82:83], 1
    s_andn2_b64 s[52:53], s[52:53], s[80:81]
    s_andn2_b64 s[52:53], s[52:53], s[54:55]
    s_or_b64 s[80:81], s[80:81], s[52:53]
    s_not_b64 vcc, s[52:53]
    s_mov_b64 exec, -1
    v_cndmask_b32_dpp v84, v84, v84, vcc wave_shr:1 row_mask:0xf bank_mask:0xf
    v_cndmask_b32_dpp v85, v85, v85, vcc wave_shr:1 row_mask:0xf bank_mask:0xf
    s_lshr_b64 s[52:53], s[52:53], 1
    v_cndmask_b32_dpp v86, v86, v86, vcc wave_shr:1 row_mask:0xf bank_mask:0xf
    v_cndmask_b32_dpp v87, v87, v87, vcc wave_shr:1 row_mask:0xf bank_mask:0xf
    s_andn2_b64 s[82:83], s[82:83], s[52:53]
    v_cndmask_b32_dpp v7, v7, v7, vcc wave_shr:1 row_mask:0xf bank_mask:0xf
    s_mov_b64 exec, s[54:55]
    s_cbranch_scc0 L2_d31
    s_mov_b64 exec, s[82:83]
    s_nop 1
    v_mfma_f32_4x4x4_16b_bf16 v[88:91], v[12:13], v[84:85], 0
    s_nop 1
    v_mfma_f32_4x4x4_16b_bf16 v[88:91], v[10:11], v[86:87], v[88:91]
    s_nop 4
    v_cvt_pk_bf16_f32 v88, v88, v89
    v_cvt_pk_bf16_f32 v89, v90, v91
    ds_pk_add_bf16 v7, v88 offset:65408
    ds_pk_add_bf16 v7, v89 offset:65412
    s_mov_b64 exec, s[54:55]
    s_branch L2_d31
L2_c32:
    s_lshl_b64 s[52:53], s[82:83], 1
    s_andn2_b64 s[52:53], s[52:53], s[80:81]
    s_andn2_b64 s[52:53], s[52:53], s[50:51]
    s_or_b64 s[80:81], s[80:81], s[52:53]
    s_not_b64 vcc, s[52:53]
    s_mov_b64 exec, -1
    v_cndmask_b32_dpp v84, v84, v84, vcc wave_shr:1 row_mask:0xf bank_mask:0xf
    v_cndmask_b32_dpp v85, v85, v85, vcc wave_shr:1 row_mask:0xf bank_mask:0xf
    s_lshr_b64 s[52:53], s[52:53], 1
    v_cndmask_b32_dpp v86, v86, v86, vcc wave_shr:1 row_mask:0xf bank_mask:0xf
    v_cndmask_b32_dpp v87, v87, v87, vcc wave_shr:1 row_mask:0xf bank_mask:0xf
    s_andn2_b64 s[82:83], s[82:83], s[52:53]
    v_cndmask_b32_dpp v7, v7, v7, vcc wave_shr:1 row_mask:0xf bank_mask:0xf
    s_mov_b64 exec, s[50:51]
    s_cbranch_scc0 L2_d32
    s_mov_b64 exec, s[82:83]
    s_nop 1
    v_mfma_f32_4x4x4_16b_bf16 v[88:91], v[12:13], v[84:85], 0
    s_nop 1
    v_mfma_f32_4x4x4_16b_bf16 v[88:91], v[10:11], v[86:87], v[88:91]
    s_nop 4
    v_cvt_pk_bf16_f32 v88, v88, v89
    v_cvt_pk_bf16_f32 v89, v90, v91
    ds_pk_add_bf16 v7, v88 offset:65408
    ds_pk_add_bf16 v7, v89 offset:65412
    s_mov_b64 exec, s[50:51]
    s_branch L2_d32
L2_c33:
    s_lshl_b64 s[52:53], s[82:83], 1
    s_andn2_b64 s[52:53], s[52:53], s[80:81]
    s_andn2_b64 s[52:53], s[52:53], s[54:55]
    s_or_b64 s[80:81], s[80:81], s[52:53]
    s_not_b64 vcc, s[52:53]
    s_mov_b64 exec, -1
    v_cndmask_b32_dpp v84, v84, v84, vcc wave_shr:1 row_mask:0xf bank_mask:0xf
    v_cndmask_b32_dpp v85, v85, v85, vcc wave_shr:1 row_mask:0xf bank_mask:0xf
    s_lshr_b64 s[52:53], s[52:53], 1
    v_cndmask_b32_dpp v86, v86, v86, vcc wave_shr:1 row_mask:0xf bank_mask:0xf
    v_cndmask_b32_dpp v87, v87, v87, vcc wave_shr:1 row_mask:0xf bank_mask:0xf
    s_andn2_b64 s[82:83], s[82:83], s[52:53]
    v_cndmask_b32_dpp v7, v7, v7, vcc wave_shr:1 row_mask:0xf bank_mask:0xf
    s_mov_b64 exec, s[54:55]
    s_cbranch_scc0 L2_d33
    s_mov_b64 exec, s[82:83]
    s_nop 1
    v_mfma_f32_4x4x4_16b_bf16 v[88:91], v[12:13], v[84:85], 0
    s_nop 1
    v_mfma_f32_4x4x4_16b_bf16 v[88:91], v[10:11], v[86:87], v[88:91]
    s_nop 4
    v_cvt_pk_bf16_f32 v88, v88, v89
    v_cvt_pk_bf16_f32 v89, v90, v91
    ds_pk_add_bf16 v7, v88 offset:65408
    ds_pk_add_bf16 v7, v89 offset:65412
    s_mov_b64 exec, s[54:55]
    s_branch L2_d33
L2_c34:
    s_lshl_b64 s[52:53], s[82:83], 1
    s_andn2_b64 s[52:53], s[52:53], s[80:81]
    s_andn2_b64 s[52:53], s[52:53], s[50:51]
    s_or_b64 s[80:81], s[80:81], s[52:53]
    s_not_b64 vcc, s[52:53]
    s_mov_b64 exec, -1
    v_cndmask_b32_dpp v84, v84, v84, vcc wave_shr:1 row_mask:0xf bank_mask:0xf
    v_cndmask_b32_dpp v85, v85, v85, vcc wave_shr:1 row_mask:0xf bank_mask:0xf
    s_lshr_b64 s[52:53], s[52:53], 1
    v_cndmask_b32_dpp v86, v86, v86, vcc wave_shr:1 row_mask:0xf bank_mask:0xf
    v_cndmask_b32_dpp v87, v87, v87, vcc wave_shr:1 row_mask:0xf bank_mask:0xf
    s_andn2_b64 s[82:83], s[82:83], s[52:53]
    v_cndmask_b32_dpp v7, v7, v7, vcc wave_shr:1 row_mask:0xf bank_mask:0xf
    s_mov_b64 exec, s[50:51]
    s_cbranch_scc0 L2_d34
    s_mov_b64 exec, s[82:83]
    s_nop 1
    v_mfma_f32_4x4x4_16b_bf16 v[88:91], v[12:13], v[84:85], 0
    s_nop 1
    v_mfma_f32_4x4x4_16b_bf16 v[88:91], v[10:11], v[86:87], v[88:91]
    s_nop 4
    v_cvt_pk_bf16_f32 v88, v88, v89
    v_cvt_pk_bf16_f32 v89, v90, v91
    ds_pk_add_bf16 v7, v88 offset:65408
    ds_pk_add_bf16 v7, v89 offset:65412
    s_mov_b64 exec, s[50:51]
    s_branch L2_d34
L2_oa35:
    s_waitcnt vmcnt(3)
    s_mov_b64 exec, s[6:7]
    v_lshrrev_b32 v114, 16, v114
    s_mov_b64 exec, -1
    v_and_b32 v46, 0x10000000, v33
    v_cmpx_eq_u32 vcc, 0, v46
    v_lshrrev_b32 v47, 14, v112
    v_and_b32 v47, v5, v47
    ds_read_b64 v[96:97], v47
    v_perm_b32 v98, v112, v114, s44
    v_bitop3_b32 v99, v112, 0.5, -0.5 bitop3:0xa8
    v_bitop3_b32 v98, v6, v98, v99 bitop3:0xca
    v_and_b32 v47, v5, v112
    s_waitcnt lgkmcnt(0)
    v_mfma_f32_4x4x4_16b_bf16 v[88:91], v[8:9], v[96:97], 0
    s_nop 4
    v_mul_f32 v88, v98, v88
    v_mul_f32 v89, v98, v89
    v_mul_f32 v90, v98, v90
    v_mul_f32 v91, v98, v91
    v_cvt_pk_bf16_f32 v88, v88, v89
    v_cvt_pk_bf16_f32 v89, v90, v91
    ds_pk_add_bf16 v47, v88 offset:65408
    ds_pk_add_bf16 v47, v89 offset:65412
    s_mov_b64 exec, -1
    v_and_b32 v46, 0x20000000, v33
    v_cmpx_eq_u32 vcc, 0, v46
    v_lshrrev_b32 v47, 14, v113
    v_and_b32 v47, v5, v47
    ds_read_b64 v[96:97], v47
    v_perm_b32 v98, v113, v114, s45
    v_bitop3_b32 v99, v113, 0.5, -0.5 bitop3:0xa8
    v_bitop3_b32 v98, v6, v98, v99 bitop3:0xca
    v_and_b32 v47, v5, v113
    s_waitcnt lgkmcnt(0)
    v_mfma_f32_4x4x4_16b_bf16 v[88:91], v[8:9], v[96:97], 0
    s_nop 4
    v_mul_f32 v88, v98, v88
    v_mul_f32 v89, v98, v89
    v_mul_f32 v90, v98, v90
    v_mul_f32 v91, v98, v91
    v_cvt_pk_bf16_f32 v88, v88, v89
    v_cvt_pk_bf16_f32 v89, v90, v91
    ds_pk_add_bf16 v47, v88 offset:65408
    ds_pk_add_bf16 v47, v89 offset:65412
    s_mov_b64 exec, -1
    s_branch L2_ob35
L2_xo36:
    v_cmp_lt_u32 vcc, 20, v99
    s_mov_b32 s101, 1
    s_cbranch_vccz L2_xp36
    v_cmp_lt_u32 vcc, 32, v99
    v_cmp_lt_u32 s[58:59], 31, v88
    s_mov_b32 s101, 2
    s_or_b64 vcc, vcc, s[58:59]
    s_cbranch_scc0 L2_xp36
    s_mov_b32 s37, 0x10000
    s_branch L2_xp36
L2_c37:
    s_lshl_b64 s[52:53], s[82:83], 1
    s_andn2_b64 s[52:53], s[52:53], s[80:81]
    s_andn2_b64 s[52:53], s[52:53], s[54:55]
    s_or_b64 s[80:81], s[80:81], s[52:53]
    s_not_b64 vcc, s[52:53]
    s_mov_b64 exec, -1
    v_cndmask_b32_dpp v84, v84, v84, vcc wave_shr:1 row_mask:0xf bank_mask:0xf
    v_cndmask_b32_dpp v85, v85, v85, vcc wave_shr:1 row_mask:0xf bank_mask:0xf
    s_lshr_b64 s[52:53], s[52:53], 1
    v_cndmask_b32_dpp v86, v86, v86, vcc wave_shr:1 row_mask:0xf bank_mask:0xf
    v_cndmask_b32_dpp v87, v87, v87, vcc wave_shr:1 row_mask:0xf bank_mask:0xf
    s_andn2_b64 s[82:83], s[82:83], s[52:53]
    v_cndmask_b32_dpp v7, v7, v7, vcc wave_shr:1 row_mask:0xf bank_mask:0xf
    s_mov_b64 exec, s[54:55]
    s_cbranch_scc0 L2_d37
    s_mov_b64 exec, s[82:83]
    s_nop 1
    v_mfma_f32_4x4x4_16b_bf16 v[88:91], v[12:13], v[84:85], 0
    s_nop 1
    v_mfma_f32_4x4x4_16b_bf16 v[88:91], v[10:11], v[86:87], v[88:91]
    s_nop 4
    v_cvt_pk_bf16_f32 v88, v88, v89
    v_cvt_pk_bf16_f32 v89, v90, v91
    ds_pk_add_bf16 v7, v88 offset:65408
    ds_pk_add_bf16 v7, v89 offset:65412
    s_mov_b64 exec, s[54:55]
    s_branch L2_d37
L2_c38:
    s_lshl_b64 s[52:53], s[82:83], 1
    s_andn2_b64 s[52:53], s[52:53], s[80:81]
    s_andn2_b64 s[52:53], s[52:53], s[50:51]
    s_or_b64 s[80:81], s[80:81], s[52:53]
    s_not_b64 vcc, s[52:53]
    s_mov_b64 exec, -1
    v_cndmask_b32_dpp v84, v84, v84, vcc wave_shr:1 row_mask:0xf bank_mask:0xf
    v_cndmask_b32_dpp v85, v85, v85, vcc wave_shr:1 row_mask:0xf bank_mask:0xf
    s_lshr_b64 s[52:53], s[52:53], 1
    v_cndmask_b32_dpp v86, v86, v86, vcc wave_shr:1 row_mask:0xf bank_mask:0xf
    v_cndmask_b32_dpp v87, v87, v87, vcc wave_shr:1 row_mask:0xf bank_mask:0xf
    s_andn2_b64 s[82:83], s[82:83], s[52:53]
    v_cndmask_b32_dpp v7, v7, v7, vcc wave_shr:1 row_mask:0xf bank_mask:0xf
    s_mov_b64 exec, s[50:51]
    s_cbranch_scc0 L2_d38
    s_mov_b64 exec, s[82:83]
    s_nop 1
    v_mfma_f32_4x4x4_16b_bf16 v[88:91], v[12:13], v[84:85], 0
    s_nop 1
    v_mfma_f32_4x4x4_16b_bf16 v[88:91], v[10:11], v[86:87], v[88:91]
    s_nop 4
    v_cvt_pk_bf16_f32 v88, v88, v89
    v_cvt_pk_bf16_f32 v89, v90, v91
    ds_pk_add_bf16 v7, v88 offset:65408
    ds_pk_add_bf16 v7, v89 offset:65412
    s_mov_b64 exec, s[50:51]
    s_branch L2_d38
L2_c39:
    s_lshl_b64 s[52:53], s[82:83], 1
    s_andn2_b64 s[52:53], s[52:53], s[80:81]
    s_andn2_b64 s[52:53], s[52:53], s[54:55]
    s_or_b64 s[80:81], s[80:81], s[52:53]
    s_not_b64 vcc, s[52:53]
    s_mov_b64 exec, -1
    v_cndmask_b32_dpp v84, v84, v84, vcc wave_shr:1 row_mask:0xf bank_mask:0xf
    v_cndmask_b32_dpp v85, v85, v85, vcc wave_shr:1 row_mask:0xf bank_mask:0xf
    s_lshr_b64 s[52:53], s[52:53], 1
    v_cndmask_b32_dpp v86, v86, v86, vcc wave_shr:1 row_mask:0xf bank_mask:0xf
    v_cndmask_b32_dpp v87, v87, v87, vcc wave_shr:1 row_mask:0xf bank_mask:0xf
    s_andn2_b64 s[82:83], s[82:83], s[52:53]
    v_cndmask_b32_dpp v7, v7, v7, vcc wave_shr:1 row_mask:0xf bank_mask:0xf
    s_mov_b64 exec, s[54:55]
    s_cbranch_scc0 L2_d39
    s_mov_b64 exec, s[82:83]
    s_nop 1
    v_mfma_f32_4x4x4_16b_bf16 v[88:91], v[12:13], v[84:85], 0
    s_nop 1
    v_mfma_f32_4x4x4_16b_bf16 v[88:91], v[10:11], v[86:87], v[88:91]
    s_nop 4
    v_cvt_pk_bf16_f32 v88, v88, v89
    v_cvt_pk_bf16_f32 v89, v90, v91
    ds_pk_add_bf16 v7, v88 offset:65408
    ds_pk_add_bf16 v7, v89 offset:65412
    s_mov_b64 exec, s[54:55]
    s_branch L2_d39
L2_c40:
    s_lshl_b64 s[52:53], s[82:83], 1
    s_andn2_b64 s[52:53], s[52:53], s[80:81]
    s_andn2_b64 s[52:53], s[52:53], s[50:51]
    s_or_b64 s[80:81], s[80:81], s[52:53]
    s_not_b64 vcc, s[52:53]
    s_mov_b64 exec, -1
    v_cndmask_b32_dpp v84, v84, v84, vcc wave_shr:1 row_mask:0xf bank_mask:0xf
    v_cndmask_b32_dpp v85, v85, v85, vcc wave_shr:1 row_mask:0xf bank_mask:0xf
    s_lshr_b64 s[52:53], s[52:53], 1
    v_cndmask_b32_dpp v86, v86, v86, vcc wave_shr:1 row_mask:0xf bank_mask:0xf
    v_cndmask_b32_dpp v87, v87, v87, vcc wave_shr:1 row_mask:0xf bank_mask:0xf
    s_andn2_b64 s[82:83], s[82:83], s[52:53]
    v_cndmask_b32_dpp v7, v7, v7, vcc wave_shr:1 row_mask:0xf bank_mask:0xf
    s_mov_b64 exec, s[50:51]
    s_cbranch_scc0 L2_d40
    s_mov_b64 exec, s[82:83]
    s_nop 1
    v_mfma_f32_4x4x4_16b_bf16 v[88:91], v[12:13], v[84:85], 0
    s_nop 1
    v_mfma_f32_4x4x4_16b_bf16 v[88:91], v[10:11], v[86:87], v[88:91]
    s_nop 4
    v_cvt_pk_bf16_f32 v88, v88, v89
    v_cvt_pk_bf16_f32 v89, v90, v91
    ds_pk_add_bf16 v7, v88 offset:65408
    ds_pk_add_bf16 v7, v89 offset:65412
    s_mov_b64 exec, s[50:51]
    s_branch L2_d40
L2_c41:
    s_lshl_b64 s[52:53], s[82:83], 1
    s_andn2_b64 s[52:53], s[52:53], s[80:81]
    s_andn2_b64 s[52:53], s[52:53], s[54:55]
    s_or_b64 s[80:81], s[80:81], s[52:53]
    s_not_b64 vcc, s[52:53]
    s_mov_b64 exec, -1
    v_cndmask_b32_dpp v84, v84, v84, vcc wave_shr:1 row_mask:0xf bank_mask:0xf
    v_cndmask_b32_dpp v85, v85, v85, vcc wave_shr:1 row_mask:0xf bank_mask:0xf
    s_lshr_b64 s[52:53], s[52:53], 1
    v_cndmask_b32_dpp v86, v86, v86, vcc wave_shr:1 row_mask:0xf bank_mask:0xf
    v_cndmask_b32_dpp v87, v87, v87, vcc wave_shr:1 row_mask:0xf bank_mask:0xf
    s_andn2_b64 s[82:83], s[82:83], s[52:53]
    v_cndmask_b32_dpp v7, v7, v7, vcc wave_shr:1 row_mask:0xf bank_mask:0xf
    s_mov_b64 exec, s[54:55]
    s_cbranch_scc0 L2_d41
    s_mov_b64 exec, s[82:83]
    s_nop 1
    v_mfma_f32_4x4x4_16b_bf16 v[88:91], v[12:13], v[84:85], 0
    s_nop 1
    v_mfma_f32_4x4x4_16b_bf16 v[88:91], v[10:11], v[86:87], v[88:91]
    s_nop 4
    v_cvt_pk_bf16_f32 v88, v88, v89
    v_cvt_pk_bf16_f32 v89, v90, v91
    ds_pk_add_bf16 v7, v88 offset:65408
    ds_pk_add_bf16 v7, v89 offset:65412
    s_mov_b64 exec, s[54:55]
    s_branch L2_d41
L2_c42:
    s_lshl_b64 s[52:53], s[82:83], 1
    s_andn2_b64 s[52:53], s[52:53], s[80:81]
    s_andn2_b64 s[52:53], s[52:53], s[50:51]
    s_or_b64 s[80:81], s[80:81], s[52:53]
    s_not_b64 vcc, s[52:53]
    s_mov_b64 exec, -1
    v_cndmask_b32_dpp v84, v84, v84, vcc wave_shr:1 row_mask:0xf bank_mask:0xf
    v_cndmask_b32_dpp v85, v85, v85, vcc wave_shr:1 row_mask:0xf bank_mask:0xf
    s_lshr_b64 s[52:53], s[52:53], 1
    v_cndmask_b32_dpp v86, v86, v86, vcc wave_shr:1 row_mask:0xf bank_mask:0xf
    v_cndmask_b32_dpp v87, v87, v87, vcc wave_shr:1 row_mask:0xf bank_mask:0xf
    s_andn2_b64 s[82:83], s[82:83], s[52:53]
    v_cndmask_b32_dpp v7, v7, v7, vcc wave_shr:1 row_mask:0xf bank_mask:0xf
    s_mov_b64 exec, s[50:51]
    s_cbranch_scc0 L2_d42
    s_mov_b64 exec, s[82:83]
    s_nop 1
    v_mfma_f32_4x4x4_16b_bf16 v[88:91], v[12:13], v[84:85], 0
    s_nop 1
    v_mfma_f32_4x4x4_16b_bf16 v[88:91], v[10:11], v[86:87], v[88:91]
    s_nop 4
    v_cvt_pk_bf16_f32 v88, v88, v89
    v_cvt_pk_bf16_f32 v89, v90, v91
    ds_pk_add_bf16 v7, v88 offset:65408
    ds_pk_add_bf16 v7, v89 offset:65412
    s_mov_b64 exec, s[50:51]
    s_branch L2_d42
L2_xa43:
    s_cmp_eq_u32 s101, 1
    s_cbranch_scc1 L2_xc43
    v_lshlrev_b32 v89, 0, v96
    v_add_u32 v90, 140, v97
    v_bitop3_b32 v90, v89, v45, v90 bitop3:0x6a
    ds_write_b32 v98, v90 offset:28
    v_lshlrev_b32 v89, 4, v96
    v_add_u32 v90, 120, v97
    v_bitop3_b32 v90, v89, v45, v90 bitop3:0x6a
    ds_write_b32 v98, v90 offset:24
    v_lshlrev_b32 v89, 8, v96
    v_add_u32 v90, 100, v97
    v_bitop3_b32 v90, v89, v45, v90 bitop3:0x6a
    ds_write_b32 v98, v90 offset:20
L2_xc43:
    v_lshlrev_b32 v89, 12, v96
    v_add_u32 v90, 80, v97
    v_bitop3_b32 v90, v89, v45, v90 bitop3:0x6a
    ds_write_b32 v98, v90 offset:16
    s_branch L2_xb43
L2_xe43:
    v_cmp_lt_u32 vcc, 32, v99
    v_cmp_lt_u32 s[58:59], 31, v88
    v_lshrrev_b32 v89, 16, v96
    v_add_u32 v97, 80, v97
    s_or_b64 vcc, vcc, s[58:59]
    s_cbranch_scc1 L2_xs43
    v_lshlrev_b32 v89, v1, v89
    v_and_b32 v89, v45, v89
    v_cmp_ne_u32 vcc, 0, v89
    v_xor_b32 v90, v97, v89
    s_add_u32 s3, s37, s38
    v_mbcnt_lo_u32_b32 v98, vcc_lo, 0
    v_mbcnt_hi_u32_b32 v98, vcc_hi, v98
    s_bcnt1_i32_b64 s41, vcc
    v_lshl_add_u32 v98, v98, 2, s3
    s_lshl2_add_u32 s37, s41, s37
    s_mov_b64 exec, vcc
    ds_write_b32 v98, v90
    s_mov_b64 exec, -1
    s_branch L2_xr43
L2_xs43:
    s_waitcnt lgkmcnt(0)
    s_mov_b32 s37, 0x10000
    s_branch L2_xw43
L2_c44:
    s_lshl_b64 s[52:53], s[82:83], 1
    s_andn2_b64 s[52:53], s[52:53], s[80:81]
    s_andn2_b64 s[52:53], s[52:53], s[54:55]
    s_or_b64 s[80:81], s[80:81], s[52:53]
    s_not_b64 vcc, s[52:53]
    s_mov_b64 exec, -1
    v_cndmask_b32_dpp v84, v84, v84, vcc wave_shr:1 row_mask:0xf bank_mask:0xf
    v_cndmask_b32_dpp v85, v85, v85, vcc wave_shr:1 row_mask:0xf bank_mask:0xf
    s_lshr_b64 s[52:53], s[52:53], 1
    v_cndmask_b32_dpp v86, v86, v86, vcc wave_shr:1 row_mask:0xf bank_mask:0xf
    v_cndmask_b32_dpp v87, v87, v87, vcc wave_shr:1 row_mask:0xf bank_mask:0xf
    s_andn2_b64 s[82:83], s[82:83], s[52:53]
    v_cndmask_b32_dpp v7, v7, v7, vcc wave_shr:1 row_mask:0xf bank_mask:0xf
    s_mov_b64 exec, s[54:55]
    s_cbranch_scc0 L2_d44
    s_mov_b64 exec, s[82:83]
    s_nop 1
    v_mfma_f32_4x4x4_16b_bf16 v[88:91], v[12:13], v[84:85], 0
    s_nop 1
    v_mfma_f32_4x4x4_16b_bf16 v[88:91], v[10:11], v[86:87], v[88:91]
    s_nop 4
    v_cvt_pk_bf16_f32 v88, v88, v89
    v_cvt_pk_bf16_f32 v89, v90, v91
    ds_pk_add_bf16 v7, v88 offset:65408
    ds_pk_add_bf16 v7, v89 offset:65412
    s_mov_b64 exec, s[54:55]
    s_branch L2_d44
L2_c45:
    s_lshl_b64 s[52:53], s[82:83], 1
    s_andn2_b64 s[52:53], s[52:53], s[80:81]
    s_andn2_b64 s[52:53], s[52:53], s[50:51]
    s_or_b64 s[80:81], s[80:81], s[52:53]
    s_not_b64 vcc, s[52:53]
    s_mov_b64 exec, -1
    v_cndmask_b32_dpp v84, v84, v84, vcc wave_shr:1 row_mask:0xf bank_mask:0xf
    v_cndmask_b32_dpp v85, v85, v85, vcc wave_shr:1 row_mask:0xf bank_mask:0xf
    s_lshr_b64 s[52:53], s[52:53], 1
    v_cndmask_b32_dpp v86, v86, v86, vcc wave_shr:1 row_mask:0xf bank_mask:0xf
    v_cndmask_b32_dpp v87, v87, v87, vcc wave_shr:1 row_mask:0xf bank_mask:0xf
    s_andn2_b64 s[82:83], s[82:83], s[52:53]
    v_cndmask_b32_dpp v7, v7, v7, vcc wave_shr:1 row_mask:0xf bank_mask:0xf
    s_mov_b64 exec, s[50:51]
    s_cbranch_scc0 L2_d45
    s_mov_b64 exec, s[82:83]
    s_nop 1
    v_mfma_f32_4x4x4_16b_bf16 v[88:91], v[12:13], v[84:85], 0
    s_nop 1
    v_mfma_f32_4x4x4_16b_bf16 v[88:91], v[10:11], v[86:87], v[88:91]
    s_nop 4
    v_cvt_pk_bf16_f32 v88, v88, v89
    v_cvt_pk_bf16_f32 v89, v90, v91
    ds_pk_add_bf16 v7, v88 offset:65408
    ds_pk_add_bf16 v7, v89 offset:65412
    s_mov_b64 exec, s[50:51]
    s_branch L2_d45
L2_xf43:
    s_cmp_gt_u32 s37, 1024
    s_cbranch_scc1 L2_xt43
    s_cmp_lt_u32 s37, 768
    s_cbranch_scc1 L2_xl43
    ds_read_b32 v33, v44 offset:896
    s_add_u32 s3, s42, 2
    s_bitset1_b32 s43, s3
    s_branch L2_xg43
L2_xl43:
    s_waitcnt lgkmcnt(0)
    v_mov_b32 v42, -1
    s_cmp_ge_u32 s37, 512
    s_cbranch_scc1 L2_xg43
    v_mov_b32 v43, -1
    s_cmp_ge_u32 s37, 256
    s_cbranch_scc1 L2_xg43
    v_mov_b32 v41, -1
    s_branch L2_xg43
L2_xt43:
    s_waitcnt lgkmcnt(0)
    v_mov_b32 v40, -1
    v_mov_b32 v41, -1
    v_mov_b32 v43, -1
    v_mov_b32 v42, -1
    s_add_u32 s3, s42, 2
    s_bitset1_b32 s36, s3
    s_branch L2_xg43
L2_oa46:
    v_and_b32 v47, 0x0fffffff, v32
    buffer_load_dword v114, v47, s[8:11], 0 offen offset:16
    s_mov_b64 exec, s[6:7]
    v_add_u32 v47, 8, v47
    v_lshrrev_b32 v32, 2, v32
    s_mov_b64 exec, -1
    buffer_load_dwordx2 v[112:113], v47, s[8:11], 0 offen
    s_branch L2_ob46
L2_c47:
    s_lshl_b64 s[52:53], s[82:83], 1
    s_andn2_b64 s[52:53], s[52:53], s[80:81]
    s_andn2_b64 s[52:53], s[52:53], s[54:55]
    s_or_b64 s[80:81], s[80:81], s[52:53]
    s_not_b64 vcc, s[52:53]
    s_mov_b64 exec, -1
    v_cndmask_b32_dpp v84, v84, v84, vcc wave_shr:1 row_mask:0xf bank_mask:0xf
    v_cndmask_b32_dpp v85, v85, v85, vcc wave_shr:1 row_mask:0xf bank_mask:0xf
    s_lshr_b64 s[52:53], s[52:53], 1
    v_cndmask_b32_dpp v86, v86, v86, vcc wave_shr:1 row_mask:0xf bank_mask:0xf
    v_cndmask_b32_dpp v87, v87, v87, vcc wave_shr:1 row_mask:0xf bank_mask:0xf
    s_andn2_b64 s[82:83], s[82:83], s[52:53]
    v_cndmask_b32_dpp v7, v7, v7, vcc wave_shr:1 row_mask:0xf bank_mask:0xf
    s_mov_b64 exec, s[54:55]
    s_cbranch_scc0 L2_d47
    s_mov_b64 exec, s[82:83]
    s_nop 1
    v_mfma_f32_4x4x4_16b_bf16 v[88:91], v[12:13], v[84:85], 0
    s_nop 1
    v_mfma_f32_4x4x4_16b_bf16 v[88:91], v[10:11], v[86:87], v[88:91]
    s_nop 4
    v_cvt_pk_bf16_f32 v88, v88, v89
    v_cvt_pk_bf16_f32 v89, v90, v91
    ds_pk_add_bf16 v7, v88 offset:65408
    ds_pk_add_bf16 v7, v89 offset:65412
    s_mov_b64 exec, s[54:55]
    s_branch L2_d47
L2_c48:
    s_lshl_b64 s[52:53], s[82:83], 1
    s_andn2_b64 s[52:53], s[52:53], s[80:81]
    s_andn2_b64 s[52:53], s[52:53], s[50:51]
    s_or_b64 s[80:81], s[80:81], s[52:53]
    s_not_b64 vcc, s[52:53]
    s_mov_b64 exec, -1
    v_cndmask_b32_dpp v84, v84, v84, vcc wave_shr:1 row_mask:0xf bank_mask:0xf
    v_cndmask_b32_dpp v85, v85, v85, vcc wave_shr:1 row_mask:0xf bank_mask:0xf
    s_lshr_b64 s[52:53], s[52:53], 1
    v_cndmask_b32_dpp v86, v86, v86, vcc wave_shr:1 row_mask:0xf bank_mask:0xf
    v_cndmask_b32_dpp v87, v87, v87, vcc wave_shr:1 row_mask:0xf bank_mask:0xf
    s_andn2_b64 s[82:83], s[82:83], s[52:53]
    v_cndmask_b32_dpp v7, v7, v7, vcc wave_shr:1 row_mask:0xf bank_mask:0xf
    s_mov_b64 exec, s[50:51]
    s_cbranch_scc0 L2_d48
    s_mov_b64 exec, s[82:83]
    s_nop 1
    v_mfma_f32_4x4x4_16b_bf16 v[88:91], v[12:13], v[84:85], 0
    s_nop 1
    v_mfma_f32_4x4x4_16b_bf16 v[88:91], v[10:11], v[86:87], v[88:91]
    s_nop 4
    v_cvt_pk_bf16_f32 v88, v88, v89
    v_cvt_pk_bf16_f32 v89, v90, v91
    ds_pk_add_bf16 v7, v88 offset:65408
    ds_pk_add_bf16 v7, v89 offset:65412
    s_mov_b64 exec, s[50:51]
    s_branch L2_d48
L2_c49:
    s_lshl_b64 s[52:53], s[82:83], 1
    s_andn2_b64 s[52:53], s[52:53], s[80:81]
    s_andn2_b64 s[52:53], s[52:53], s[54:55]
    s_or_b64 s[80:81], s[80:81], s[52:53]
    s_not_b64 vcc, s[52:53]
    s_mov_b64 exec, -1
    v_cndmask_b32_dpp v84, v84, v84, vcc wave_shr:1 row_mask:0xf bank_mask:0xf
    v_cndmask_b32_dpp v85, v85, v85, vcc wave_shr:1 row_mask:0xf bank_mask:0xf
    s_lshr_b64 s[52:53], s[52:53], 1
    v_cndmask_b32_dpp v86, v86, v86, vcc wave_shr:1 row_mask:0xf bank_mask:0xf
    v_cndmask_b32_dpp v87, v87, v87, vcc wave_shr:1 row_mask:0xf bank_mask:0xf
    s_andn2_b64 s[82:83], s[82:83], s[52:53]
    v_cndmask_b32_dpp v7, v7, v7, vcc wave_shr:1 row_mask:0xf bank_mask:0xf
    s_mov_b64 exec, s[54:55]
    s_cbranch_scc0 L2_d49
    s_mov_b64 exec, s[82:83]
    s_nop 1
    v_mfma_f32_4x4x4_16b_bf16 v[88:91], v[12:13], v[84:85], 0
    s_nop 1
    v_mfma_f32_4x4x4_16b_bf16 v[88:91], v[10:11], v[86:87], v[88:91]
    s_nop 4
    v_cvt_pk_bf16_f32 v88, v88, v89
    v_cvt_pk_bf16_f32 v89, v90, v91
    ds_pk_add_bf16 v7, v88 offset:65408
    ds_pk_add_bf16 v7, v89 offset:65412
    s_mov_b64 exec, s[54:55]
    s_branch L2_d49
L2_c50:
    s_lshl_b64 s[52:53], s[82:83], 1
    s_andn2_b64 s[52:53], s[52:53], s[80:81]
    s_andn2_b64 s[52:53], s[52:53], s[50:51]
    s_or_b64 s[80:81], s[80:81], s[52:53]
    s_not_b64 vcc, s[52:53]
    s_mov_b64 exec, -1
    v_cndmask_b32_dpp v84, v84, v84, vcc wave_shr:1 row_mask:0xf bank_mask:0xf
    v_cndmask_b32_dpp v85, v85, v85, vcc wave_shr:1 row_mask:0xf bank_mask:0xf
    s_lshr_b64 s[52:53], s[52:53], 1
    v_cndmask_b32_dpp v86, v86, v86, vcc wave_shr:1 row_mask:0xf bank_mask:0xf
    v_cndmask_b32_dpp v87, v87, v87, vcc wave_shr:1 row_mask:0xf bank_mask:0xf
    s_andn2_b64 s[82:83], s[82:83], s[52:53]
    v_cndmask_b32_dpp v7, v7, v7, vcc wave_shr:1 row_mask:0xf bank_mask:0xf
    s_mov_b64 exec, s[50:51]
    s_cbranch_scc0 L2_d50
    s_mov_b64 exec, s[82:83]
    s_nop 1
    v_mfma_f32_4x4x4_16b_bf16 v[88:91], v[12:13], v[84:85], 0
    s_nop 1
    v_mfma_f32_4x4x4_16b_bf16 v[88:91], v[10:11], v[86:87], v[88:91]
    s_nop 4
    v_cvt_pk_bf16_f32 v88, v88, v89
    v_cvt_pk_bf16_f32 v89, v90, v91
    ds_pk_add_bf16 v7, v88 offset:65408
    ds_pk_add_bf16 v7, v89 offset:65412
    s_mov_b64 exec, s[50:51]
    s_branch L2_d50
L2_c51:
    s_lshl_b64 s[52:53], s[82:83], 1
    s_andn2_b64 s[52:53], s[52:53], s[80:81]
    s_andn2_b64 s[52:53], s[52:53], s[54:55]
    s_or_b64 s[80:81], s[80:81], s[52:53]
    s_not_b64 vcc, s[52:53]
    s_mov_b64 exec, -1
    v_cndmask_b32_dpp v84, v84, v84, vcc wave_shr:1 row_mask:0xf bank_mask:0xf
    v_cndmask_b32_dpp v85, v85, v85, vcc wave_shr:1 row_mask:0xf bank_mask:0xf
    s_lshr_b64 s[52:53], s[52:53], 1
    v_cndmask_b32_dpp v86, v86, v86, vcc wave_shr:1 row_mask:0xf bank_mask:0xf
    v_cndmask_b32_dpp v87, v87, v87, vcc wave_shr:1 row_mask:0xf bank_mask:0xf
    s_andn2_b64 s[82:83], s[82:83], s[52:53]
    v_cndmask_b32_dpp v7, v7, v7, vcc wave_shr:1 row_mask:0xf bank_mask:0xf
    s_mov_b64 exec, s[54:55]
    s_cbranch_scc0 L2_d51
    s_mov_b64 exec, s[82:83]
    s_nop 1
    v_mfma_f32_4x4x4_16b_bf16 v[88:91], v[12:13], v[84:85], 0
    s_nop 1
    v_mfma_f32_4x4x4_16b_bf16 v[88:91], v[10:11], v[86:87], v[88:91]
    s_nop 4
    v_cvt_pk_bf16_f32 v88, v88, v89
    v_cvt_pk_bf16_f32 v89, v90, v91
    ds_pk_add_bf16 v7, v88 offset:65408
    ds_pk_add_bf16 v7, v89 offset:65412
    s_mov_b64 exec, s[54:55]
    s_branch L2_d51
L2_c52:
    s_lshl_b64 s[52:53], s[82:83], 1
    s_andn2_b64 s[52:53], s[52:53], s[80:81]
    s_andn2_b64 s[52:53], s[52:53], s[50:51]
    s_or_b64 s[80:81], s[80:81], s[52:53]
    s_not_b64 vcc, s[52:53]
    s_mov_b64 exec, -1
    v_cndmask_b32_dpp v84, v84, v84, vcc wave_shr:1 row_mask:0xf bank_mask:0xf
    v_cndmask_b32_dpp v85, v85, v85, vcc wave_shr:1 row_mask:0xf bank_mask:0xf
    s_lshr_b64 s[52:53], s[52:53], 1
    v_cndmask_b32_dpp v86, v86, v86, vcc wave_shr:1 row_mask:0xf bank_mask:0xf
    v_cndmask_b32_dpp v87, v87, v87, vcc wave_shr:1 row_mask:0xf bank_mask:0xf
    s_andn2_b64 s[82:83], s[82:83], s[52:53]
    v_cndmask_b32_dpp v7, v7, v7, vcc wave_shr:1 row_mask:0xf bank_mask:0xf
    s_mov_b64 exec, s[50:51]
    s_cbranch_scc0 L2_d52
    s_mov_b64 exec, s[82:83]
    s_nop 1
    v_mfma_f32_4x4x4_16b_bf16 v[88:91], v[12:13], v[84:85], 0
    s_nop 1
    v_mfma_f32_4x4x4_16b_bf16 v[88:91], v[10:11], v[86:87], v[88:91]
    s_nop 4
    v_cvt_pk_bf16_f32 v88, v88, v89
    v_cvt_pk_bf16_f32 v89, v90, v91
    ds_pk_add_bf16 v7, v88 offset:65408
    ds_pk_add_bf16 v7, v89 offset:65412
    s_mov_b64 exec, s[50:51]
    s_branch L2_d52
L2_oa53:
    s_waitcnt vmcnt(3)
    s_mov_b64 exec, s[6:7]
    v_lshrrev_b32 v114, 16, v114
    s_mov_b64 exec, -1
    v_and_b32 v46, 0x10000000, v32
    v_cmpx_eq_u32 vcc, 0, v46
    v_lshrrev_b32 v47, 14, v112
    v_and_b32 v47, v5, v47
    ds_read_b64 v[96:97], v47
    v_perm_b32 v98, v112, v114, s44
    v_bitop3_b32 v99, v112, 0.5, -0.5 bitop3:0xa8
    v_bitop3_b32 v98, v6, v98, v99 bitop3:0xca
    v_and_b32 v47, v5, v112
    s_waitcnt lgkmcnt(0)
    v_mfma_f32_4x4x4_16b_bf16 v[88:91], v[8:9], v[96:97], 0
    s_nop 4
    v_mul_f32 v88, v98, v88
    v_mul_f32 v89, v98, v89
    v_mul_f32 v90, v98, v90
    v_mul_f32 v91, v98, v91
    v_cvt_pk_bf16_f32 v88, v88, v89
    v_cvt_pk_bf16_f32 v89, v90, v91
    ds_pk_add_bf16 v47, v88 offset:65408
    ds_pk_add_bf16 v47, v89 offset:65412
    s_mov_b64 exec, -1
    v_and_b32 v46, 0x20000000, v32
    v_cmpx_eq_u32 vcc, 0, v46
    v_lshrrev_b32 v47, 14, v113
    v_and_b32 v47, v5, v47
    ds_read_b64 v[96:97], v47
    v_perm_b32 v98, v113, v114, s45
    v_bitop3_b32 v99, v113, 0.5, -0.5 bitop3:0xa8
    v_bitop3_b32 v98, v6, v98, v99 bitop3:0xca
    v_and_b32 v47, v5, v113
    s_waitcnt lgkmcnt(0)
    v_mfma_f32_4x4x4_16b_bf16 v[88:91], v[8:9], v[96:97], 0
    s_nop 4
    v_mul_f32 v88, v98, v88
    v_mul_f32 v89, v98, v89
    v_mul_f32 v90, v98, v90
    v_mul_f32 v91, v98, v91
    v_cvt_pk_bf16_f32 v88, v88, v89
    v_cvt_pk_bf16_f32 v89, v90, v91
    ds_pk_add_bf16 v47, v88 offset:65408
    ds_pk_add_bf16 v47, v89 offset:65412
    s_mov_b64 exec, -1
    s_branch L2_ob53
L2_xo54:
    v_cmp_lt_u32 vcc, 20, v99
    s_mov_b32 s101, 1
    s_cbranch_vccz L2_xp54
    v_cmp_lt_u32 vcc, 32, v99
    v_cmp_lt_u32 s[58:59], 31, v88
    s_mov_b32 s101, 2
    s_or_b64 vcc, vcc, s[58:59]
    s_cbranch_scc0 L2_xp54
    s_mov_b32 s37, 0x10000
    s_branch L2_xp54
L2_c55:
    s_lshl_b64 s[52:53], s[82:83], 1
    s_andn2_b64 s[52:53], s[52:53], s[80:81]
    s_andn2_b64 s[52:53], s[52:53], s[54:55]
    s_or_b64 s[80:81], s[80:81], s[52:53]
    s_not_b64 vcc, s[52:53]
    s_mov_b64 exec, -1
    v_cndmask_b32_dpp v84, v84, v84, vcc wave_shr:1 row_mask:0xf bank_mask:0xf
    v_cndmask_b32_dpp v85, v85, v85, vcc wave_shr:1 row_mask:0xf bank_mask:0xf
    s_lshr_b64 s[52:53], s[52:53], 1
    v_cndmask_b32_dpp v86, v86, v86, vcc wave_shr:1 row_mask:0xf bank_mask:0xf
    v_cndmask_b32_dpp v87, v87, v87, vcc wave_shr:1 row_mask:0xf bank_mask:0xf
    s_andn2_b64 s[82:83], s[82:83], s[52:53]
    v_cndmask_b32_dpp v7, v7, v7, vcc wave_shr:1 row_mask:0xf bank_mask:0xf
    s_mov_b64 exec, s[54:55]
    s_cbranch_scc0 L2_d55
    s_mov_b64 exec, s[82:83]
    s_nop 1
    v_mfma_f32_4x4x4_16b_bf16 v[88:91], v[12:13], v[84:85], 0
    s_nop 1
    v_mfma_f32_4x4x4_16b_bf16 v[88:91], v[10:11], v[86:87], v[88:91]
    s_nop 4
    v_cvt_pk_bf16_f32 v88, v88, v89
    v_cvt_pk_bf16_f32 v89, v90, v91
    ds_pk_add_bf16 v7, v88 offset:65408
    ds_pk_add_bf16 v7, v89 offset:65412
    s_mov_b64 exec, s[54:55]
    s_branch L2_d55
L2_c56:
    s_lshl_b64 s[52:53], s[82:83], 1
    s_andn2_b64 s[52:53], s[52:53], s[80:81]
    s_andn2_b64 s[52:53], s[52:53], s[50:51]
    s_or_b64 s[80:81], s[80:81], s[52:53]
    s_not_b64 vcc, s[52:53]
    s_mov_b64 exec, -1
    v_cndmask_b32_dpp v84, v84, v84, vcc wave_shr:1 row_mask:0xf bank_mask:0xf
    v_cndmask_b32_dpp v85, v85, v85, vcc wave_shr:1 row_mask:0xf bank_mask:0xf
    s_lshr_b64 s[52:53], s[52:53], 1
    v_cndmask_b32_dpp v86, v86, v86, vcc wave_shr:1 row_mask:0xf bank_mask:0xf
    v_cndmask_b32_dpp v87, v87, v87, vcc wave_shr:1 row_mask:0xf bank_mask:0xf
    s_andn2_b64 s[82:83], s[82:83], s[52:53]
    v_cndmask_b32_dpp v7, v7, v7, vcc wave_shr:1 row_mask:0xf bank_mask:0xf
    s_mov_b64 exec, s[50:51]
    s_cbranch_scc0 L2_d56
    s_mov_b64 exec, s[82:83]
    s_nop 1
    v_mfma_f32_4x4x4_16b_bf16 v[88:91], v[12:13], v[84:85], 0
    s_nop 1
    v_mfma_f32_4x4x4_16b_bf16 v[88:91], v[10:11], v[86:87], v[88:91]
    s_nop 4
    v_cvt_pk_bf16_f32 v88, v88, v89
    v_cvt_pk_bf16_f32 v89, v90, v91
    ds_pk_add_bf16 v7, v88 offset:65408
    ds_pk_add_bf16 v7, v89 offset:65412
    s_mov_b64 exec, s[50:51]
    s_branch L2_d56
L2_c57:
    s_lshl_b64 s[52:53], s[82:83], 1
    s_andn2_b64 s[52:53], s[52:53], s[80:81]
    s_andn2_b64 s[52:53], s[52:53], s[54:55]
    s_or_b64 s[80:81], s[80:81], s[52:53]
    s_not_b64 vcc, s[52:53]
    s_mov_b64 exec, -1
    v_cndmask_b32_dpp v84, v84, v84, vcc wave_shr:1 row_mask:0xf bank_mask:0xf
    v_cndmask_b32_dpp v85, v85, v85, vcc wave_shr:1 row_mask:0xf bank_mask:0xf
    s_lshr_b64 s[52:53], s[52:53], 1
    v_cndmask_b32_dpp v86, v86, v86, vcc wave_shr:1 row_mask:0xf bank_mask:0xf
    v_cndmask_b32_dpp v87, v87, v87, vcc wave_shr:1 row_mask:0xf bank_mask:0xf
    s_andn2_b64 s[82:83], s[82:83], s[52:53]
    v_cndmask_b32_dpp v7, v7, v7, vcc wave_shr:1 row_mask:0xf bank_mask:0xf
    s_mov_b64 exec, s[54:55]
    s_cbranch_scc0 L2_d57
    s_mov_b64 exec, s[82:83]
    s_nop 1
    v_mfma_f32_4x4x4_16b_bf16 v[88:91], v[12:13], v[84:85], 0
    s_nop 1
    v_mfma_f32_4x4x4_16b_bf16 v[88:91], v[10:11], v[86:87], v[88:91]
    s_nop 4
    v_cvt_pk_bf16_f32 v88, v88, v89
    v_cvt_pk_bf16_f32 v89, v90, v91
    ds_pk_add_bf16 v7, v88 offset:65408
    ds_pk_add_bf16 v7, v89 offset:65412
    s_mov_b64 exec, s[54:55]
    s_branch L2_d57
L2_c58:
    s_lshl_b64 s[52:53], s[82:83], 1
    s_andn2_b64 s[52:53], s[52:53], s[80:81]
    s_andn2_b64 s[52:53], s[52:53], s[50:51]
    s_or_b64 s[80:81], s[80:81], s[52:53]
    s_not_b64 vcc, s[52:53]
    s_mov_b64 exec, -1
    v_cndmask_b32_dpp v84, v84, v84, vcc wave_shr:1 row_mask:0xf bank_mask:0xf
    v_cndmask_b32_dpp v85, v85, v85, vcc wave_shr:1 row_mask:0xf bank_mask:0xf
    s_lshr_b64 s[52:53], s[52:53], 1
    v_cndmask_b32_dpp v86, v86, v86, vcc wave_shr:1 row_mask:0xf bank_mask:0xf
    v_cndmask_b32_dpp v87, v87, v87, vcc wave_shr:1 row_mask:0xf bank_mask:0xf
    s_andn2_b64 s[82:83], s[82:83], s[52:53]
    v_cndmask_b32_dpp v7, v7, v7, vcc wave_shr:1 row_mask:0xf bank_mask:0xf
    s_mov_b64 exec, s[50:51]
    s_cbranch_scc0 L2_d58
    s_mov_b64 exec, s[82:83]
    s_nop 1
    v_mfma_f32_4x4x4_16b_bf16 v[88:91], v[12:13], v[84:85], 0
    s_nop 1
    v_mfma_f32_4x4x4_16b_bf16 v[88:91], v[10:11], v[86:87], v[88:91]
    s_nop 4
    v_cvt_pk_bf16_f32 v88, v88, v89
    v_cvt_pk_bf16_f32 v89, v90, v91
    ds_pk_add_bf16 v7, v88 offset:65408
    ds_pk_add_bf16 v7, v89 offset:65412
    s_mov_b64 exec, s[50:51]
    s_branch L2_d58
L2_c59:
    s_lshl_b64 s[52:53], s[82:83], 1
    s_andn2_b64 s[52:53], s[52:53], s[80:81]
    s_andn2_b64 s[52:53], s[52:53], s[54:55]
    s_or_b64 s[80:81], s[80:81], s[52:53]
    s_not_b64 vcc, s[52:53]
    s_mov_b64 exec, -1
    v_cndmask_b32_dpp v84, v84, v84, vcc wave_shr:1 row_mask:0xf bank_mask:0xf
    v_cndmask_b32_dpp v85, v85, v85, vcc wave_shr:1 row_mask:0xf bank_mask:0xf
    s_lshr_b64 s[52:53], s[52:53], 1
    v_cndmask_b32_dpp v86, v86, v86, vcc wave_shr:1 row_mask:0xf bank_mask:0xf
    v_cndmask_b32_dpp v87, v87, v87, vcc wave_shr:1 row_mask:0xf bank_mask:0xf
    s_andn2_b64 s[82:83], s[82:83], s[52:53]
    v_cndmask_b32_dpp v7, v7, v7, vcc wave_shr:1 row_mask:0xf bank_mask:0xf
    s_mov_b64 exec, s[54:55]
    s_cbranch_scc0 L2_d59
    s_mov_b64 exec, s[82:83]
    s_nop 1
    v_mfma_f32_4x4x4_16b_bf16 v[88:91], v[12:13], v[84:85], 0
    s_nop 1
    v_mfma_f32_4x4x4_16b_bf16 v[88:91], v[10:11], v[86:87], v[88:91]
    s_nop 4
    v_cvt_pk_bf16_f32 v88, v88, v89
    v_cvt_pk_bf16_f32 v89, v90, v91
    ds_pk_add_bf16 v7, v88 offset:65408
    ds_pk_add_bf16 v7, v89 offset:65412
    s_mov_b64 exec, s[54:55]
    s_branch L2_d59
L2_c60:
    s_lshl_b64 s[52:53], s[82:83], 1
    s_andn2_b64 s[52:53], s[52:53], s[80:81]
    s_andn2_b64 s[52:53], s[52:53], s[50:51]
    s_or_b64 s[80:81], s[80:81], s[52:53]
    s_not_b64 vcc, s[52:53]
    s_mov_b64 exec, -1
    v_cndmask_b32_dpp v84, v84, v84, vcc wave_shr:1 row_mask:0xf bank_mask:0xf
    v_cndmask_b32_dpp v85, v85, v85, vcc wave_shr:1 row_mask:0xf bank_mask:0xf
    s_lshr_b64 s[52:53], s[52:53], 1
    v_cndmask_b32_dpp v86, v86, v86, vcc wave_shr:1 row_mask:0xf bank_mask:0xf
    v_cndmask_b32_dpp v87, v87, v87, vcc wave_shr:1 row_mask:0xf bank_mask:0xf
    s_andn2_b64 s[82:83], s[82:83], s[52:53]
    v_cndmask_b32_dpp v7, v7, v7, vcc wave_shr:1 row_mask:0xf bank_mask:0xf
    s_mov_b64 exec, s[50:51]
    s_cbranch_scc0 L2_d60
    s_mov_b64 exec, s[82:83]
    s_nop 1
    v_mfma_f32_4x4x4_16b_bf16 v[88:91], v[12:13], v[84:85], 0
    s_nop 1
    v_mfma_f32_4x4x4_16b_bf16 v[88:91], v[10:11], v[86:87], v[88:91]
    s_nop 4
    v_cvt_pk_bf16_f32 v88, v88, v89
    v_cvt_pk_bf16_f32 v89, v90, v91
    ds_pk_add_bf16 v7, v88 offset:65408
    ds_pk_add_bf16 v7, v89 offset:65412
    s_mov_b64 exec, s[50:51]
    s_branch L2_d60
L2_xa61:
    s_cmp_eq_u32 s101, 1
    s_cbranch_scc1 L2_xc61
    v_lshlrev_b32 v89, 0, v96
    v_add_u32 v90, 140, v97
    v_bitop3_b32 v90, v89, v45, v90 bitop3:0x6a
    ds_write_b32 v98, v90 offset:28
    v_lshlrev_b32 v89, 4, v96
    v_add_u32 v90, 120, v97
    v_bitop3_b32 v90, v89, v45, v90 bitop3:0x6a
    ds_write_b32 v98, v90 offset:24
    v_lshlrev_b32 v89, 8, v96
    v_add_u32 v90, 100, v97
    v_bitop3_b32 v90, v89, v45, v90 bitop3:0x6a
    ds_write_b32 v98, v90 offset:20
L2_xc61:
    v_lshlrev_b32 v89, 12, v96
    v_add_u32 v90, 80, v97
    v_bitop3_b32 v90, v89, v45, v90 bitop3:0x6a
    ds_write_b32 v98, v90 offset:16
    s_branch L2_xb61
L2_xe61:
    v_cmp_lt_u32 vcc, 32, v99
    v_cmp_lt_u32 s[58:59], 31, v88
    v_lshrrev_b32 v89, 16, v96
    v_add_u32 v97, 80, v97
    s_or_b64 vcc, vcc, s[58:59]
    s_cbranch_scc1 L2_xs61
    v_lshlrev_b32 v89, v1, v89
    v_and_b32 v89, v45, v89
    v_cmp_ne_u32 vcc, 0, v89
    v_xor_b32 v90, v97, v89
    s_add_u32 s3, s37, s38
    v_mbcnt_lo_u32_b32 v98, vcc_lo, 0
    v_mbcnt_hi_u32_b32 v98, vcc_hi, v98
    s_bcnt1_i32_b64 s41, vcc
    v_lshl_add_u32 v98, v98, 2, s3
    s_lshl2_add_u32 s37, s41, s37
    s_mov_b64 exec, vcc
    ds_write_b32 v98, v90
    s_mov_b64 exec, -1
    s_branch L2_xr61
L2_xs61:
    s_waitcnt lgkmcnt(0)
    s_mov_b32 s37, 0x10000
    s_branch L2_xw61
L2_c62:
    s_lshl_b64 s[52:53], s[82:83], 1
    s_andn2_b64 s[52:53], s[52:53], s[80:81]
    s_andn2_b64 s[52:53], s[52:53], s[54:55]
    s_or_b64 s[80:81], s[80:81], s[52:53]
    s_not_b64 vcc, s[52:53]
    s_mov_b64 exec, -1
    v_cndmask_b32_dpp v84, v84, v84, vcc wave_shr:1 row_mask:0xf bank_mask:0xf
    v_cndmask_b32_dpp v85, v85, v85, vcc wave_shr:1 row_mask:0xf bank_mask:0xf
    s_lshr_b64 s[52:53], s[52:53], 1
    v_cndmask_b32_dpp v86, v86, v86, vcc wave_shr:1 row_mask:0xf bank_mask:0xf
    v_cndmask_b32_dpp v87, v87, v87, vcc wave_shr:1 row_mask:0xf bank_mask:0xf
    s_andn2_b64 s[82:83], s[82:83], s[52:53]
    v_cndmask_b32_dpp v7, v7, v7, vcc wave_shr:1 row_mask:0xf bank_mask:0xf
    s_mov_b64 exec, s[54:55]
    s_cbranch_scc0 L2_d62
    s_mov_b64 exec, s[82:83]
    s_nop 1
    v_mfma_f32_4x4x4_16b_bf16 v[88:91], v[12:13], v[84:85], 0
    s_nop 1
    v_mfma_f32_4x4x4_16b_bf16 v[88:91], v[10:11], v[86:87], v[88:91]
    s_nop 4
    v_cvt_pk_bf16_f32 v88, v88, v89
    v_cvt_pk_bf16_f32 v89, v90, v91
    ds_pk_add_bf16 v7, v88 offset:65408
    ds_pk_add_bf16 v7, v89 offset:65412
    s_mov_b64 exec, s[54:55]
    s_branch L2_d62
L2_c63:
    s_lshl_b64 s[52:53], s[82:83], 1
    s_andn2_b64 s[52:53], s[52:53], s[80:81]
    s_andn2_b64 s[52:53], s[52:53], s[50:51]
    s_or_b64 s[80:81], s[80:81], s[52:53]
    s_not_b64 vcc, s[52:53]
    s_mov_b64 exec, -1
    v_cndmask_b32_dpp v84, v84, v84, vcc wave_shr:1 row_mask:0xf bank_mask:0xf
    v_cndmask_b32_dpp v85, v85, v85, vcc wave_shr:1 row_mask:0xf bank_mask:0xf
    s_lshr_b64 s[52:53], s[52:53], 1
    v_cndmask_b32_dpp v86, v86, v86, vcc wave_shr:1 row_mask:0xf bank_mask:0xf
    v_cndmask_b32_dpp v87, v87, v87, vcc wave_shr:1 row_mask:0xf bank_mask:0xf
    s_andn2_b64 s[82:83], s[82:83], s[52:53]
    v_cndmask_b32_dpp v7, v7, v7, vcc wave_shr:1 row_mask:0xf bank_mask:0xf
    s_mov_b64 exec, s[50:51]
    s_cbranch_scc0 L2_d63
    s_mov_b64 exec, s[82:83]
    s_nop 1
    v_mfma_f32_4x4x4_16b_bf16 v[88:91], v[12:13], v[84:85], 0
    s_nop 1
    v_mfma_f32_4x4x4_16b_bf16 v[88:91], v[10:11], v[86:87], v[88:91]
    s_nop 4
    v_cvt_pk_bf16_f32 v88, v88, v89
    v_cvt_pk_bf16_f32 v89, v90, v91
    ds_pk_add_bf16 v7, v88 offset:65408
    ds_pk_add_bf16 v7, v89 offset:65412
    s_mov_b64 exec, s[50:51]
    s_branch L2_d63
L2_xf61:
    s_cmp_gt_u32 s37, 1024
    s_cbranch_scc1 L2_xt61
    s_cmp_lt_u32 s37, 768
    s_cbranch_scc1 L2_xl61
    ds_read_b32 v32, v44 offset:896
    s_add_u32 s3, s42, 2
    s_bitset1_b32 s43, s3
    s_branch L2_xg61
L2_xl61:
    s_waitcnt lgkmcnt(0)
    v_mov_b32 v31, -1
    s_cmp_ge_u32 s37, 512
    s_cbranch_scc1 L2_xg61
    v_mov_b32 v39, -1
    s_cmp_ge_u32 s37, 256
    s_cbranch_scc1 L2_xg61
    v_mov_b32 v27, -1
    s_branch L2_xg61
L2_xt61:
    s_waitcnt lgkmcnt(0)
    v_mov_b32 v21, -1
    v_mov_b32 v27, -1
    v_mov_b32 v39, -1
    v_mov_b32 v31, -1
    s_add_u32 s3, s42, 2
    s_bitset1_b32 s36, s3
    s_branch L2_xg61
L2_oa64:
    v_and_b32 v47, 0x0fffffff, v33
    buffer_load_dword v114, v47, s[8:11], 0 offen offset:16
    s_mov_b64 exec, s[6:7]
    v_add_u32 v47, 8, v47
    v_lshrrev_b32 v33, 2, v33
    s_mov_b64 exec, -1
    buffer_load_dwordx2 v[112:113], v47, s[8:11], 0 offen
    s_branch L2_ob64
L2_c65:
    s_lshl_b64 s[52:53], s[82:83], 1
    s_andn2_b64 s[52:53], s[52:53], s[80:81]
    s_andn2_b64 s[52:53], s[52:53], s[54:55]
    s_or_b64 s[80:81], s[80:81], s[52:53]
    s_not_b64 vcc, s[52:53]
    s_mov_b64 exec, -1
    v_cndmask_b32_dpp v84, v84, v84, vcc wave_shr:1 row_mask:0xf bank_mask:0xf
    v_cndmask_b32_dpp v85, v85, v85, vcc wave_shr:1 row_mask:0xf bank_mask:0xf
    s_lshr_b64 s[52:53], s[52:53], 1
    v_cndmask_b32_dpp v86, v86, v86, vcc wave_shr:1 row_mask:0xf bank_mask:0xf
    v_cndmask_b32_dpp v87, v87, v87, vcc wave_shr:1 row_mask:0xf bank_mask:0xf
    s_andn2_b64 s[82:83], s[82:83], s[52:53]
    v_cndmask_b32_dpp v7, v7, v7, vcc wave_shr:1 row_mask:0xf bank_mask:0xf
    s_mov_b64 exec, s[54:55]
    s_cbranch_scc0 L2_d65
    s_mov_b64 exec, s[82:83]
    s_nop 1
    v_mfma_f32_4x4x4_16b_bf16 v[88:91], v[12:13], v[84:85], 0
    s_nop 1
    v_mfma_f32_4x4x4_16b_bf16 v[88:91], v[10:11], v[86:87], v[88:91]
    s_nop 4
    v_cvt_pk_bf16_f32 v88, v88, v89
    v_cvt_pk_bf16_f32 v89, v90, v91
    ds_pk_add_bf16 v7, v88 offset:65408
    ds_pk_add_bf16 v7, v89 offset:65412
    s_mov_b64 exec, s[54:55]
    s_branch L2_d65
L2_c66:
    s_lshl_b64 s[52:53], s[82:83], 1
    s_andn2_b64 s[52:53], s[52:53], s[80:81]
    s_andn2_b64 s[52:53], s[52:53], s[50:51]
    s_or_b64 s[80:81], s[80:81], s[52:53]
    s_not_b64 vcc, s[52:53]
    s_mov_b64 exec, -1
    v_cndmask_b32_dpp v84, v84, v84, vcc wave_shr:1 row_mask:0xf bank_mask:0xf
    v_cndmask_b32_dpp v85, v85, v85, vcc wave_shr:1 row_mask:0xf bank_mask:0xf
    s_lshr_b64 s[52:53], s[52:53], 1
    v_cndmask_b32_dpp v86, v86, v86, vcc wave_shr:1 row_mask:0xf bank_mask:0xf
    v_cndmask_b32_dpp v87, v87, v87, vcc wave_shr:1 row_mask:0xf bank_mask:0xf
    s_andn2_b64 s[82:83], s[82:83], s[52:53]
    v_cndmask_b32_dpp v7, v7, v7, vcc wave_shr:1 row_mask:0xf bank_mask:0xf
    s_mov_b64 exec, s[50:51]
    s_cbranch_scc0 L2_d66
    s_mov_b64 exec, s[82:83]
    s_nop 1
    v_mfma_f32_4x4x4_16b_bf16 v[88:91], v[12:13], v[84:85], 0
    s_nop 1
    v_mfma_f32_4x4x4_16b_bf16 v[88:91], v[10:11], v[86:87], v[88:91]
    s_nop 4
    v_cvt_pk_bf16_f32 v88, v88, v89
    v_cvt_pk_bf16_f32 v89, v90, v91
    ds_pk_add_bf16 v7, v88 offset:65408
    ds_pk_add_bf16 v7, v89 offset:65412
    s_mov_b64 exec, s[50:51]
    s_branch L2_d66
L2_c67:
    s_lshl_b64 s[52:53], s[82:83], 1
    s_andn2_b64 s[52:53], s[52:53], s[80:81]
    s_andn2_b64 s[52:53], s[52:53], s[54:55]
    s_or_b64 s[80:81], s[80:81], s[52:53]
    s_not_b64 vcc, s[52:53]
    s_mov_b64 exec, -1
    v_cndmask_b32_dpp v84, v84, v84, vcc wave_shr:1 row_mask:0xf bank_mask:0xf
    v_cndmask_b32_dpp v85, v85, v85, vcc wave_shr:1 row_mask:0xf bank_mask:0xf
    s_lshr_b64 s[52:53], s[52:53], 1
    v_cndmask_b32_dpp v86, v86, v86, vcc wave_shr:1 row_mask:0xf bank_mask:0xf
    v_cndmask_b32_dpp v87, v87, v87, vcc wave_shr:1 row_mask:0xf bank_mask:0xf
    s_andn2_b64 s[82:83], s[82:83], s[52:53]
    v_cndmask_b32_dpp v7, v7, v7, vcc wave_shr:1 row_mask:0xf bank_mask:0xf
    s_mov_b64 exec, s[54:55]
    s_cbranch_scc0 L2_d67
    s_mov_b64 exec, s[82:83]
    s_nop 1
    v_mfma_f32_4x4x4_16b_bf16 v[88:91], v[12:13], v[84:85], 0
    s_nop 1
    v_mfma_f32_4x4x4_16b_bf16 v[88:91], v[10:11], v[86:87], v[88:91]
    s_nop 4
    v_cvt_pk_bf16_f32 v88, v88, v89
    v_cvt_pk_bf16_f32 v89, v90, v91
    ds_pk_add_bf16 v7, v88 offset:65408
    ds_pk_add_bf16 v7, v89 offset:65412
    s_mov_b64 exec, s[54:55]
    s_branch L2_d67
L2_c68:
    s_lshl_b64 s[52:53], s[82:83], 1
    s_andn2_b64 s[52:53], s[52:53], s[80:81]
    s_andn2_b64 s[52:53], s[52:53], s[50:51]
    s_or_b64 s[80:81], s[80:81], s[52:53]
    s_not_b64 vcc, s[52:53]
    s_mov_b64 exec, -1
    v_cndmask_b32_dpp v84, v84, v84, vcc wave_shr:1 row_mask:0xf bank_mask:0xf
    v_cndmask_b32_dpp v85, v85, v85, vcc wave_shr:1 row_mask:0xf bank_mask:0xf
    s_lshr_b64 s[52:53], s[52:53], 1
    v_cndmask_b32_dpp v86, v86, v86, vcc wave_shr:1 row_mask:0xf bank_mask:0xf
    v_cndmask_b32_dpp v87, v87, v87, vcc wave_shr:1 row_mask:0xf bank_mask:0xf
    s_andn2_b64 s[82:83], s[82:83], s[52:53]
    v_cndmask_b32_dpp v7, v7, v7, vcc wave_shr:1 row_mask:0xf bank_mask:0xf
    s_mov_b64 exec, s[50:51]
    s_cbranch_scc0 L2_d68
    s_mov_b64 exec, s[82:83]
    s_nop 1
    v_mfma_f32_4x4x4_16b_bf16 v[88:91], v[12:13], v[84:85], 0
    s_nop 1
    v_mfma_f32_4x4x4_16b_bf16 v[88:91], v[10:11], v[86:87], v[88:91]
    s_nop 4
    v_cvt_pk_bf16_f32 v88, v88, v89
    v_cvt_pk_bf16_f32 v89, v90, v91
    ds_pk_add_bf16 v7, v88 offset:65408
    ds_pk_add_bf16 v7, v89 offset:65412
    s_mov_b64 exec, s[50:51]
    s_branch L2_d68
L2_c69:
    s_lshl_b64 s[52:53], s[82:83], 1
    s_andn2_b64 s[52:53], s[52:53], s[80:81]
    s_andn2_b64 s[52:53], s[52:53], s[54:55]
    s_or_b64 s[80:81], s[80:81], s[52:53]
    s_not_b64 vcc, s[52:53]
    s_mov_b64 exec, -1
    v_cndmask_b32_dpp v84, v84, v84, vcc wave_shr:1 row_mask:0xf bank_mask:0xf
    v_cndmask_b32_dpp v85, v85, v85, vcc wave_shr:1 row_mask:0xf bank_mask:0xf
    s_lshr_b64 s[52:53], s[52:53], 1
    v_cndmask_b32_dpp v86, v86, v86, vcc wave_shr:1 row_mask:0xf bank_mask:0xf
    v_cndmask_b32_dpp v87, v87, v87, vcc wave_shr:1 row_mask:0xf bank_mask:0xf
    s_andn2_b64 s[82:83], s[82:83], s[52:53]
    v_cndmask_b32_dpp v7, v7, v7, vcc wave_shr:1 row_mask:0xf bank_mask:0xf
    s_mov_b64 exec, s[54:55]
    s_cbranch_scc0 L2_d69
    s_mov_b64 exec, s[82:83]
    s_nop 1
    v_mfma_f32_4x4x4_16b_bf16 v[88:91], v[12:13], v[84:85], 0
    s_nop 1
    v_mfma_f32_4x4x4_16b_bf16 v[88:91], v[10:11], v[86:87], v[88:91]
    s_nop 4
    v_cvt_pk_bf16_f32 v88, v88, v89
    v_cvt_pk_bf16_f32 v89, v90, v91
    ds_pk_add_bf16 v7, v88 offset:65408
    ds_pk_add_bf16 v7, v89 offset:65412
    s_mov_b64 exec, s[54:55]
    s_branch L2_d69
L2_c70:
    s_lshl_b64 s[52:53], s[82:83], 1
    s_andn2_b64 s[52:53], s[52:53], s[80:81]
    s_andn2_b64 s[52:53], s[52:53], s[50:51]
    s_or_b64 s[80:81], s[80:81], s[52:53]
    s_not_b64 vcc, s[52:53]
    s_mov_b64 exec, -1
    v_cndmask_b32_dpp v84, v84, v84, vcc wave_shr:1 row_mask:0xf bank_mask:0xf
    v_cndmask_b32_dpp v85, v85, v85, vcc wave_shr:1 row_mask:0xf bank_mask:0xf
    s_lshr_b64 s[52:53], s[52:53], 1
    v_cndmask_b32_dpp v86, v86, v86, vcc wave_shr:1 row_mask:0xf bank_mask:0xf
    v_cndmask_b32_dpp v87, v87, v87, vcc wave_shr:1 row_mask:0xf bank_mask:0xf
    s_andn2_b64 s[82:83], s[82:83], s[52:53]
    v_cndmask_b32_dpp v7, v7, v7, vcc wave_shr:1 row_mask:0xf bank_mask:0xf
    s_mov_b64 exec, s[50:51]
    s_cbranch_scc0 L2_d70
    s_mov_b64 exec, s[82:83]
    s_nop 1
    v_mfma_f32_4x4x4_16b_bf16 v[88:91], v[12:13], v[84:85], 0
    s_nop 1
    v_mfma_f32_4x4x4_16b_bf16 v[88:91], v[10:11], v[86:87], v[88:91]
    s_nop 4
    v_cvt_pk_bf16_f32 v88, v88, v89
    v_cvt_pk_bf16_f32 v89, v90, v91
    ds_pk_add_bf16 v7, v88 offset:65408
    ds_pk_add_bf16 v7, v89 offset:65412
    s_mov_b64 exec, s[50:51]
    s_branch L2_d70
L2_oa71:
    s_waitcnt vmcnt(3)
    s_mov_b64 exec, s[6:7]
    v_lshrrev_b32 v114, 16, v114
    s_mov_b64 exec, -1
    v_and_b32 v46, 0x10000000, v33
    v_cmpx_eq_u32 vcc, 0, v46
    v_lshrrev_b32 v47, 14, v112
    v_and_b32 v47, v5, v47
    ds_read_b64 v[96:97], v47
    v_perm_b32 v98, v112, v114, s44
    v_bitop3_b32 v99, v112, 0.5, -0.5 bitop3:0xa8
    v_bitop3_b32 v98, v6, v98, v99 bitop3:0xca
    v_and_b32 v47, v5, v112
    s_waitcnt lgkmcnt(0)
    v_mfma_f32_4x4x4_16b_bf16 v[88:91], v[8:9], v[96:97], 0
    s_nop 4
    v_mul_f32 v88, v98, v88
    v_mul_f32 v89, v98, v89
    v_mul_f32 v90, v98, v90
    v_mul_f32 v91, v98, v91
    v_cvt_pk_bf16_f32 v88, v88, v89
    v_cvt_pk_bf16_f32 v89, v90, v91
    ds_pk_add_bf16 v47, v88 offset:65408
    ds_pk_add_bf16 v47, v89 offset:65412
    s_mov_b64 exec, -1
    v_and_b32 v46, 0x20000000, v33
    v_cmpx_eq_u32 vcc, 0, v46
    v_lshrrev_b32 v47, 14, v113
    v_and_b32 v47, v5, v47
    ds_read_b64 v[96:97], v47
    v_perm_b32 v98, v113, v114, s45
    v_bitop3_b32 v99, v113, 0.5, -0.5 bitop3:0xa8
    v_bitop3_b32 v98, v6, v98, v99 bitop3:0xca
    v_and_b32 v47, v5, v113
    s_waitcnt lgkmcnt(0)
    v_mfma_f32_4x4x4_16b_bf16 v[88:91], v[8:9], v[96:97], 0
    s_nop 4
    v_mul_f32 v88, v98, v88
    v_mul_f32 v89, v98, v89
    v_mul_f32 v90, v98, v90
    v_mul_f32 v91, v98, v91
    v_cvt_pk_bf16_f32 v88, v88, v89
    v_cvt_pk_bf16_f32 v89, v90, v91
    ds_pk_add_bf16 v47, v88 offset:65408
    ds_pk_add_bf16 v47, v89 offset:65412
    s_mov_b64 exec, -1
    s_branch L2_ob71
L2_xo72:
    v_cmp_lt_u32 vcc, 20, v99
    s_mov_b32 s101, 1
    s_cbranch_vccz L2_xp72
    v_cmp_lt_u32 vcc, 32, v99
    v_cmp_lt_u32 s[58:59], 31, v88
    s_mov_b32 s101, 2
    s_or_b64 vcc, vcc, s[58:59]
    s_cbranch_scc0 L2_xp72
    s_mov_b32 s37, 0x10000
    s_branch L2_xp72
L2_c73:
    s_lshl_b64 s[52:53], s[82:83], 1
    s_andn2_b64 s[52:53], s[52:53], s[80:81]
    s_andn2_b64 s[52:53], s[52:53], s[54:55]
    s_or_b64 s[80:81], s[80:81], s[52:53]
    s_not_b64 vcc, s[52:53]
    s_mov_b64 exec, -1
    v_cndmask_b32_dpp v84, v84, v84, vcc wave_shr:1 row_mask:0xf bank_mask:0xf
    v_cndmask_b32_dpp v85, v85, v85, vcc wave_shr:1 row_mask:0xf bank_mask:0xf
    s_lshr_b64 s[52:53], s[52:53], 1
    v_cndmask_b32_dpp v86, v86, v86, vcc wave_shr:1 row_mask:0xf bank_mask:0xf
    v_cndmask_b32_dpp v87, v87, v87, vcc wave_shr:1 row_mask:0xf bank_mask:0xf
    s_andn2_b64 s[82:83], s[82:83], s[52:53]
    v_cndmask_b32_dpp v7, v7, v7, vcc wave_shr:1 row_mask:0xf bank_mask:0xf
    s_mov_b64 exec, s[54:55]
    s_cbranch_scc0 L2_d73
    s_mov_b64 exec, s[82:83]
    s_nop 1
    v_mfma_f32_4x4x4_16b_bf16 v[88:91], v[12:13], v[84:85], 0
    s_nop 1
    v_mfma_f32_4x4x4_16b_bf16 v[88:91], v[10:11], v[86:87], v[88:91]
    s_nop 4
    v_cvt_pk_bf16_f32 v88, v88, v89
    v_cvt_pk_bf16_f32 v89, v90, v91
    ds_pk_add_bf16 v7, v88 offset:65408
    ds_pk_add_bf16 v7, v89 offset:65412
    s_mov_b64 exec, s[54:55]
    s_branch L2_d73
L2_c74:
    s_lshl_b64 s[52:53], s[82:83], 1
    s_andn2_b64 s[52:53], s[52:53], s[80:81]
    s_andn2_b64 s[52:53], s[52:53], s[50:51]
    s_or_b64 s[80:81], s[80:81], s[52:53]
    s_not_b64 vcc, s[52:53]
    s_mov_b64 exec, -1
    v_cndmask_b32_dpp v84, v84, v84, vcc wave_shr:1 row_mask:0xf bank_mask:0xf
    v_cndmask_b32_dpp v85, v85, v85, vcc wave_shr:1 row_mask:0xf bank_mask:0xf
    s_lshr_b64 s[52:53], s[52:53], 1
    v_cndmask_b32_dpp v86, v86, v86, vcc wave_shr:1 row_mask:0xf bank_mask:0xf
    v_cndmask_b32_dpp v87, v87, v87, vcc wave_shr:1 row_mask:0xf bank_mask:0xf
    s_andn2_b64 s[82:83], s[82:83], s[52:53]
    v_cndmask_b32_dpp v7, v7, v7, vcc wave_shr:1 row_mask:0xf bank_mask:0xf
    s_mov_b64 exec, s[50:51]
    s_cbranch_scc0 L2_d74
    s_mov_b64 exec, s[82:83]
    s_nop 1
    v_mfma_f32_4x4x4_16b_bf16 v[88:91], v[12:13], v[84:85], 0
    s_nop 1
    v_mfma_f32_4x4x4_16b_bf16 v[88:91], v[10:11], v[86:87], v[88:91]
    s_nop 4
    v_cvt_pk_bf16_f32 v88, v88, v89
    v_cvt_pk_bf16_f32 v89, v90, v91
    ds_pk_add_bf16 v7, v88 offset:65408
    ds_pk_add_bf16 v7, v89 offset:65412
    s_mov_b64 exec, s[50:51]
    s_branch L2_d74
L2_c75:
    s_lshl_b64 s[52:53], s[82:83], 1
    s_andn2_b64 s[52:53], s[52:53], s[80:81]
    s_andn2_b64 s[52:53], s[52:53], s[54:55]
    s_or_b64 s[80:81], s[80:81], s[52:53]
    s_not_b64 vcc, s[52:53]
    s_mov_b64 exec, -1
    v_cndmask_b32_dpp v84, v84, v84, vcc wave_shr:1 row_mask:0xf bank_mask:0xf
    v_cndmask_b32_dpp v85, v85, v85, vcc wave_shr:1 row_mask:0xf bank_mask:0xf
    s_lshr_b64 s[52:53], s[52:53], 1
    v_cndmask_b32_dpp v86, v86, v86, vcc wave_shr:1 row_mask:0xf bank_mask:0xf
    v_cndmask_b32_dpp v87, v87, v87, vcc wave_shr:1 row_mask:0xf bank_mask:0xf
    s_andn2_b64 s[82:83], s[82:83], s[52:53]
    v_cndmask_b32_dpp v7, v7, v7, vcc wave_shr:1 row_mask:0xf bank_mask:0xf
    s_mov_b64 exec, s[54:55]
    s_cbranch_scc0 L2_d75
    s_mov_b64 exec, s[82:83]
    s_nop 1
    v_mfma_f32_4x4x4_16b_bf16 v[88:91], v[12:13], v[84:85], 0
    s_nop 1
    v_mfma_f32_4x4x4_16b_bf16 v[88:91], v[10:11], v[86:87], v[88:91]
    s_nop 4
    v_cvt_pk_bf16_f32 v88, v88, v89
    v_cvt_pk_bf16_f32 v89, v90, v91
    ds_pk_add_bf16 v7, v88 offset:65408
    ds_pk_add_bf16 v7, v89 offset:65412
    s_mov_b64 exec, s[54:55]
    s_branch L2_d75
L2_c76:
    s_lshl_b64 s[52:53], s[82:83], 1
    s_andn2_b64 s[52:53], s[52:53], s[80:81]
    s_andn2_b64 s[52:53], s[52:53], s[50:51]
    s_or_b64 s[80:81], s[80:81], s[52:53]
    s_not_b64 vcc, s[52:53]
    s_mov_b64 exec, -1
    v_cndmask_b32_dpp v84, v84, v84, vcc wave_shr:1 row_mask:0xf bank_mask:0xf
    v_cndmask_b32_dpp v85, v85, v85, vcc wave_shr:1 row_mask:0xf bank_mask:0xf
    s_lshr_b64 s[52:53], s[52:53], 1
    v_cndmask_b32_dpp v86, v86, v86, vcc wave_shr:1 row_mask:0xf bank_mask:0xf
    v_cndmask_b32_dpp v87, v87, v87, vcc wave_shr:1 row_mask:0xf bank_mask:0xf
    s_andn2_b64 s[82:83], s[82:83], s[52:53]
    v_cndmask_b32_dpp v7, v7, v7, vcc wave_shr:1 row_mask:0xf bank_mask:0xf
    s_mov_b64 exec, s[50:51]
    s_cbranch_scc0 L2_d76
    s_mov_b64 exec, s[82:83]
    s_nop 1
    v_mfma_f32_4x4x4_16b_bf16 v[88:91], v[12:13], v[84:85], 0
    s_nop 1
    v_mfma_f32_4x4x4_16b_bf16 v[88:91], v[10:11], v[86:87], v[88:91]
    s_nop 4
    v_cvt_pk_bf16_f32 v88, v88, v89
    v_cvt_pk_bf16_f32 v89, v90, v91
    ds_pk_add_bf16 v7, v88 offset:65408
    ds_pk_add_bf16 v7, v89 offset:65412
    s_mov_b64 exec, s[50:51]
    s_branch L2_d76
L2_c77:
    s_lshl_b64 s[52:53], s[82:83], 1
    s_andn2_b64 s[52:53], s[52:53], s[80:81]
    s_andn2_b64 s[52:53], s[52:53], s[54:55]
    s_or_b64 s[80:81], s[80:81], s[52:53]
    s_not_b64 vcc, s[52:53]
    s_mov_b64 exec, -1
    v_cndmask_b32_dpp v84, v84, v84, vcc wave_shr:1 row_mask:0xf bank_mask:0xf
    v_cndmask_b32_dpp v85, v85, v85, vcc wave_shr:1 row_mask:0xf bank_mask:0xf
    s_lshr_b64 s[52:53], s[52:53], 1
    v_cndmask_b32_dpp v86, v86, v86, vcc wave_shr:1 row_mask:0xf bank_mask:0xf
    v_cndmask_b32_dpp v87, v87, v87, vcc wave_shr:1 row_mask:0xf bank_mask:0xf
    s_andn2_b64 s[82:83], s[82:83], s[52:53]
    v_cndmask_b32_dpp v7, v7, v7, vcc wave_shr:1 row_mask:0xf bank_mask:0xf
    s_mov_b64 exec, s[54:55]
    s_cbranch_scc0 L2_d77
    s_mov_b64 exec, s[82:83]
    s_nop 1
    v_mfma_f32_4x4x4_16b_bf16 v[88:91], v[12:13], v[84:85], 0
    s_nop 1
    v_mfma_f32_4x4x4_16b_bf16 v[88:91], v[10:11], v[86:87], v[88:91]
    s_nop 4
    v_cvt_pk_bf16_f32 v88, v88, v89
    v_cvt_pk_bf16_f32 v89, v90, v91
    ds_pk_add_bf16 v7, v88 offset:65408
    ds_pk_add_bf16 v7, v89 offset:65412
    s_mov_b64 exec, s[54:55]
    s_branch L2_d77
L2_c78:
    s_lshl_b64 s[52:53], s[82:83], 1
    s_andn2_b64 s[52:53], s[52:53], s[80:81]
    s_andn2_b64 s[52:53], s[52:53], s[50:51]
    s_or_b64 s[80:81], s[80:81], s[52:53]
    s_not_b64 vcc, s[52:53]
    s_mov_b64 exec, -1
    v_cndmask_b32_dpp v84, v84, v84, vcc wave_shr:1 row_mask:0xf bank_mask:0xf
    v_cndmask_b32_dpp v85, v85, v85, vcc wave_shr:1 row_mask:0xf bank_mask:0xf
    s_lshr_b64 s[52:53], s[52:53], 1
    v_cndmask_b32_dpp v86, v86, v86, vcc wave_shr:1 row_mask:0xf bank_mask:0xf
    v_cndmask_b32_dpp v87, v87, v87, vcc wave_shr:1 row_mask:0xf bank_mask:0xf
    s_andn2_b64 s[82:83], s[82:83], s[52:53]
    v_cndmask_b32_dpp v7, v7, v7, vcc wave_shr:1 row_mask:0xf bank_mask:0xf
    s_mov_b64 exec, s[50:51]
    s_cbranch_scc0 L2_d78
    s_mov_b64 exec, s[82:83]
    s_nop 1
    v_mfma_f32_4x4x4_16b_bf16 v[88:91], v[12:13], v[84:85], 0
    s_nop 1
    v_mfma_f32_4x4x4_16b_bf16 v[88:91], v[10:11], v[86:87], v[88:91]
    s_nop 4
    v_cvt_pk_bf16_f32 v88, v88, v89
    v_cvt_pk_bf16_f32 v89, v90, v91
    ds_pk_add_bf16 v7, v88 offset:65408
    ds_pk_add_bf16 v7, v89 offset:65412
    s_mov_b64 exec, s[50:51]
    s_branch L2_d78
L2_xa79:
    s_cmp_eq_u32 s101, 1
    s_cbranch_scc1 L2_xc79
    v_lshlrev_b32 v89, 0, v96
    v_add_u32 v90, 140, v97
    v_bitop3_b32 v90, v89, v45, v90 bitop3:0x6a
    ds_write_b32 v98, v90 offset:28
    v_lshlrev_b32 v89, 4, v96
    v_add_u32 v90, 120, v97
    v_bitop3_b32 v90, v89, v45, v90 bitop3:0x6a
    ds_write_b32 v98, v90 offset:24
    v_lshlrev_b32 v89, 8, v96
    v_add_u32 v90, 100, v97
    v_bitop3_b32 v90, v89, v45, v90 bitop3:0x6a
    ds_write_b32 v98, v90 offset:20
L2_xc79:
    v_lshlrev_b32 v89, 12, v96
    v_add_u32 v90, 80, v97
    v_bitop3_b32 v90, v89, v45, v90 bitop3:0x6a
    ds_write_b32 v98, v90 offset:16
    s_branch L2_xb79
L2_xe79:
    v_cmp_lt_u32 vcc, 32, v99
    v_cmp_lt_u32 s[58:59], 31, v88
    v_lshrrev_b32 v89, 16, v96
    v_add_u32 v97, 80, v97
    s_or_b64 vcc, vcc, s[58:59]
    s_cbranch_scc1 L2_xs79
    v_lshlrev_b32 v89, v1, v89
    v_and_b32 v89, v45, v89
    v_cmp_ne_u32 vcc, 0, v89
    v_xor_b32 v90, v97, v89
    s_add_u32 s3, s37, s38
    v_mbcnt_lo_u32_b32 v98, vcc_lo, 0
    v_mbcnt_hi_u32_b32 v98, vcc_hi, v98
    s_bcnt1_i32_b64 s41, vcc
    v_lshl_add_u32 v98, v98, 2, s3
    s_lshl2_add_u32 s37, s41, s37
    s_mov_b64 exec, vcc
    ds_write_b32 v98, v90
    s_mov_b64 exec, -1
    s_branch L2_xr79
L2_xs79:
    s_waitcnt lgkmcnt(0)
    s_mov_b32 s37, 0x10000
    s_branch L2_xw79
L2_c80:
    s_lshl_b64 s[52:53], s[82:83], 1
    s_andn2_b64 s[52:53], s[52:53], s[80:81]
    s_andn2_b64 s[52:53], s[52:53], s[54:55]
    s_or_b64 s[80:81], s[80:81], s[52:53]
    s_not_b64 vcc, s[52:53]
    s_mov_b64 exec, -1
    v_cndmask_b32_dpp v84, v84, v84, vcc wave_shr:1 row_mask:0xf bank_mask:0xf
    v_cndmask_b32_dpp v85, v85, v85, vcc wave_shr:1 row_mask:0xf bank_mask:0xf
    s_lshr_b64 s[52:53], s[52:53], 1
    v_cndmask_b32_dpp v86, v86, v86, vcc wave_shr:1 row_mask:0xf bank_mask:0xf
    v_cndmask_b32_dpp v87, v87, v87, vcc wave_shr:1 row_mask:0xf bank_mask:0xf
    s_andn2_b64 s[82:83], s[82:83], s[52:53]
    v_cndmask_b32_dpp v7, v7, v7, vcc wave_shr:1 row_mask:0xf bank_mask:0xf
    s_mov_b64 exec, s[54:55]
    s_cbranch_scc0 L2_d80
    s_mov_b64 exec, s[82:83]
    s_nop 1
    v_mfma_f32_4x4x4_16b_bf16 v[88:91], v[12:13], v[84:85], 0
    s_nop 1
    v_mfma_f32_4x4x4_16b_bf16 v[88:91], v[10:11], v[86:87], v[88:91]
    s_nop 4
    v_cvt_pk_bf16_f32 v88, v88, v89
    v_cvt_pk_bf16_f32 v89, v90, v91
    ds_pk_add_bf16 v7, v88 offset:65408
    ds_pk_add_bf16 v7, v89 offset:65412
    s_mov_b64 exec, s[54:55]
    s_branch L2_d80
L2_c81:
    s_lshl_b64 s[52:53], s[82:83], 1
    s_andn2_b64 s[52:53], s[52:53], s[80:81]
    s_andn2_b64 s[52:53], s[52:53], s[50:51]
    s_or_b64 s[80:81], s[80:81], s[52:53]
    s_not_b64 vcc, s[52:53]
    s_mov_b64 exec, -1
    v_cndmask_b32_dpp v84, v84, v84, vcc wave_shr:1 row_mask:0xf bank_mask:0xf
    v_cndmask_b32_dpp v85, v85, v85, vcc wave_shr:1 row_mask:0xf bank_mask:0xf
    s_lshr_b64 s[52:53], s[52:53], 1
    v_cndmask_b32_dpp v86, v86, v86, vcc wave_shr:1 row_mask:0xf bank_mask:0xf
    v_cndmask_b32_dpp v87, v87, v87, vcc wave_shr:1 row_mask:0xf bank_mask:0xf
    s_andn2_b64 s[82:83], s[82:83], s[52:53]
    v_cndmask_b32_dpp v7, v7, v7, vcc wave_shr:1 row_mask:0xf bank_mask:0xf
    s_mov_b64 exec, s[50:51]
    s_cbranch_scc0 L2_d81
    s_mov_b64 exec, s[82:83]
    s_nop 1
    v_mfma_f32_4x4x4_16b_bf16 v[88:91], v[12:13], v[84:85], 0
    s_nop 1
    v_mfma_f32_4x4x4_16b_bf16 v[88:91], v[10:11], v[86:87], v[88:91]
    s_nop 4
    v_cvt_pk_bf16_f32 v88, v88, v89
    v_cvt_pk_bf16_f32 v89, v90, v91
    ds_pk_add_bf16 v7, v88 offset:65408
    ds_pk_add_bf16 v7, v89 offset:65412
    s_mov_b64 exec, s[50:51]
    s_branch L2_d81
L2_xf79:
    s_cmp_gt_u32 s37, 1024
    s_cbranch_scc1 L2_xt79
    s_cmp_lt_u32 s37, 768
    s_cbranch_scc1 L2_xl79
    ds_read_b32 v33, v44 offset:896
    s_add_u32 s3, s42, 2
    s_bitset1_b32 s43, s3
    s_branch L2_xg79
L2_xl79:
    s_waitcnt lgkmcnt(0)
    v_mov_b32 v42, -1
    s_cmp_ge_u32 s37, 512
    s_cbranch_scc1 L2_xg79
    v_mov_b32 v43, -1
    s_cmp_ge_u32 s37, 256
    s_cbranch_scc1 L2_xg79
    v_mov_b32 v41, -1
    s_branch L2_xg79
L2_xt79:
    s_waitcnt lgkmcnt(0)
    v_mov_b32 v40, -1
    v_mov_b32 v41, -1
    v_mov_b32 v43, -1
    v_mov_b32 v42, -1
    s_add_u32 s3, s42, 2
    s_bitset1_b32 s36, s3
    s_branch L2_xg79
L2_oa82:
    v_and_b32 v47, 0x0fffffff, v32
    buffer_load_dword v114, v47, s[8:11], 0 offen offset:16
    s_mov_b64 exec, s[6:7]
    v_add_u32 v47, 8, v47
    v_lshrrev_b32 v32, 2, v32
    s_mov_b64 exec, -1
    buffer_load_dwordx2 v[112:113], v47, s[8:11], 0 offen
    s_branch L2_ob82
L2_c83:
    s_lshl_b64 s[52:53], s[82:83], 1
    s_andn2_b64 s[52:53], s[52:53], s[80:81]
    s_andn2_b64 s[52:53], s[52:53], s[54:55]
    s_or_b64 s[80:81], s[80:81], s[52:53]
    s_not_b64 vcc, s[52:53]
    s_mov_b64 exec, -1
    v_cndmask_b32_dpp v84, v84, v84, vcc wave_shr:1 row_mask:0xf bank_mask:0xf
    v_cndmask_b32_dpp v85, v85, v85, vcc wave_shr:1 row_mask:0xf bank_mask:0xf
    s_lshr_b64 s[52:53], s[52:53], 1
    v_cndmask_b32_dpp v86, v86, v86, vcc wave_shr:1 row_mask:0xf bank_mask:0xf
    v_cndmask_b32_dpp v87, v87, v87, vcc wave_shr:1 row_mask:0xf bank_mask:0xf
    s_andn2_b64 s[82:83], s[82:83], s[52:53]
    v_cndmask_b32_dpp v7, v7, v7, vcc wave_shr:1 row_mask:0xf bank_mask:0xf
    s_mov_b64 exec, s[54:55]
    s_cbranch_scc0 L2_d83
    s_mov_b64 exec, s[82:83]
    s_nop 1
    v_mfma_f32_4x4x4_16b_bf16 v[88:91], v[12:13], v[84:85], 0
    s_nop 1
    v_mfma_f32_4x4x4_16b_bf16 v[88:91], v[10:11], v[86:87], v[88:91]
    s_nop 4
    v_cvt_pk_bf16_f32 v88, v88, v89
    v_cvt_pk_bf16_f32 v89, v90, v91
    ds_pk_add_bf16 v7, v88 offset:65408
    ds_pk_add_bf16 v7, v89 offset:65412
    s_mov_b64 exec, s[54:55]
    s_branch L2_d83
L2_c84:
    s_lshl_b64 s[52:53], s[82:83], 1
    s_andn2_b64 s[52:53], s[52:53], s[80:81]
    s_andn2_b64 s[52:53], s[52:53], s[50:51]
    s_or_b64 s[80:81], s[80:81], s[52:53]
    s_not_b64 vcc, s[52:53]
    s_mov_b64 exec, -1
    v_cndmask_b32_dpp v84, v84, v84, vcc wave_shr:1 row_mask:0xf bank_mask:0xf
    v_cndmask_b32_dpp v85, v85, v85, vcc wave_shr:1 row_mask:0xf bank_mask:0xf
    s_lshr_b64 s[52:53], s[52:53], 1
    v_cndmask_b32_dpp v86, v86, v86, vcc wave_shr:1 row_mask:0xf bank_mask:0xf
    v_cndmask_b32_dpp v87, v87, v87, vcc wave_shr:1 row_mask:0xf bank_mask:0xf
    s_andn2_b64 s[82:83], s[82:83], s[52:53]
    v_cndmask_b32_dpp v7, v7, v7, vcc wave_shr:1 row_mask:0xf bank_mask:0xf
    s_mov_b64 exec, s[50:51]
    s_cbranch_scc0 L2_d84
    s_mov_b64 exec, s[82:83]
    s_nop 1
    v_mfma_f32_4x4x4_16b_bf16 v[88:91], v[12:13], v[84:85], 0
    s_nop 1
    v_mfma_f32_4x4x4_16b_bf16 v[88:91], v[10:11], v[86:87], v[88:91]
    s_nop 4
    v_cvt_pk_bf16_f32 v88, v88, v89
    v_cvt_pk_bf16_f32 v89, v90, v91
    ds_pk_add_bf16 v7, v88 offset:65408
    ds_pk_add_bf16 v7, v89 offset:65412
    s_mov_b64 exec, s[50:51]
    s_branch L2_d84
L2_c85:
    s_lshl_b64 s[52:53], s[82:83], 1
    s_andn2_b64 s[52:53], s[52:53], s[80:81]
    s_andn2_b64 s[52:53], s[52:53], s[54:55]
    s_or_b64 s[80:81], s[80:81], s[52:53]
    s_not_b64 vcc, s[52:53]
    s_mov_b64 exec, -1
    v_cndmask_b32_dpp v84, v84, v84, vcc wave_shr:1 row_mask:0xf bank_mask:0xf
    v_cndmask_b32_dpp v85, v85, v85, vcc wave_shr:1 row_mask:0xf bank_mask:0xf
    s_lshr_b64 s[52:53], s[52:53], 1
    v_cndmask_b32_dpp v86, v86, v86, vcc wave_shr:1 row_mask:0xf bank_mask:0xf
    v_cndmask_b32_dpp v87, v87, v87, vcc wave_shr:1 row_mask:0xf bank_mask:0xf
    s_andn2_b64 s[82:83], s[82:83], s[52:53]
    v_cndmask_b32_dpp v7, v7, v7, vcc wave_shr:1 row_mask:0xf bank_mask:0xf
    s_mov_b64 exec, s[54:55]
    s_cbranch_scc0 L2_d85
    s_mov_b64 exec, s[82:83]
    s_nop 1
    v_mfma_f32_4x4x4_16b_bf16 v[88:91], v[12:13], v[84:85], 0
    s_nop 1
    v_mfma_f32_4x4x4_16b_bf16 v[88:91], v[10:11], v[86:87], v[88:91]
    s_nop 4
    v_cvt_pk_bf16_f32 v88, v88, v89
    v_cvt_pk_bf16_f32 v89, v90, v91
    ds_pk_add_bf16 v7, v88 offset:65408
    ds_pk_add_bf16 v7, v89 offset:65412
    s_mov_b64 exec, s[54:55]
    s_branch L2_d85
L2_c86:
    s_lshl_b64 s[52:53], s[82:83], 1
    s_andn2_b64 s[52:53], s[52:53], s[80:81]
    s_andn2_b64 s[52:53], s[52:53], s[50:51]
    s_or_b64 s[80:81], s[80:81], s[52:53]
    s_not_b64 vcc, s[52:53]
    s_mov_b64 exec, -1
    v_cndmask_b32_dpp v84, v84, v84, vcc wave_shr:1 row_mask:0xf bank_mask:0xf
    v_cndmask_b32_dpp v85, v85, v85, vcc wave_shr:1 row_mask:0xf bank_mask:0xf
    s_lshr_b64 s[52:53], s[52:53], 1
    v_cndmask_b32_dpp v86, v86, v86, vcc wave_shr:1 row_mask:0xf bank_mask:0xf
    v_cndmask_b32_dpp v87, v87, v87, vcc wave_shr:1 row_mask:0xf bank_mask:0xf
    s_andn2_b64 s[82:83], s[82:83], s[52:53]
    v_cndmask_b32_dpp v7, v7, v7, vcc wave_shr:1 row_mask:0xf bank_mask:0xf
    s_mov_b64 exec, s[50:51]
    s_cbranch_scc0 L2_d86
    s_mov_b64 exec, s[82:83]
    s_nop 1
    v_mfma_f32_4x4x4_16b_bf16 v[88:91], v[12:13], v[84:85], 0
    s_nop 1
    v_mfma_f32_4x4x4_16b_bf16 v[88:91], v[10:11], v[86:87], v[88:91]
    s_nop 4
    v_cvt_pk_bf16_f32 v88, v88, v89
    v_cvt_pk_bf16_f32 v89, v90, v91
    ds_pk_add_bf16 v7, v88 offset:65408
    ds_pk_add_bf16 v7, v89 offset:65412
    s_mov_b64 exec, s[50:51]
    s_branch L2_d86
L2_c87:
    s_lshl_b64 s[52:53], s[82:83], 1
    s_andn2_b64 s[52:53], s[52:53], s[80:81]
    s_andn2_b64 s[52:53], s[52:53], s[54:55]
    s_or_b64 s[80:81], s[80:81], s[52:53]
    s_not_b64 vcc, s[52:53]
    s_mov_b64 exec, -1
    v_cndmask_b32_dpp v84, v84, v84, vcc wave_shr:1 row_mask:0xf bank_mask:0xf
    v_cndmask_b32_dpp v85, v85, v85, vcc wave_shr:1 row_mask:0xf bank_mask:0xf
    s_lshr_b64 s[52:53], s[52:53], 1
    v_cndmask_b32_dpp v86, v86, v86, vcc wave_shr:1 row_mask:0xf bank_mask:0xf
    v_cndmask_b32_dpp v87, v87, v87, vcc wave_shr:1 row_mask:0xf bank_mask:0xf
    s_andn2_b64 s[82:83], s[82:83], s[52:53]
    v_cndmask_b32_dpp v7, v7, v7, vcc wave_shr:1 row_mask:0xf bank_mask:0xf
    s_mov_b64 exec, s[54:55]
    s_cbranch_scc0 L2_d87
    s_mov_b64 exec, s[82:83]
    s_nop 1
    v_mfma_f32_4x4x4_16b_bf16 v[88:91], v[12:13], v[84:85], 0
    s_nop 1
    v_mfma_f32_4x4x4_16b_bf16 v[88:91], v[10:11], v[86:87], v[88:91]
    s_nop 4
    v_cvt_pk_bf16_f32 v88, v88, v89
    v_cvt_pk_bf16_f32 v89, v90, v91
    ds_pk_add_bf16 v7, v88 offset:65408
    ds_pk_add_bf16 v7, v89 offset:65412
    s_mov_b64 exec, s[54:55]
    s_branch L2_d87
L2_c88:
    s_lshl_b64 s[52:53], s[82:83], 1
    s_andn2_b64 s[52:53], s[52:53], s[80:81]
    s_andn2_b64 s[52:53], s[52:53], s[50:51]
    s_or_b64 s[80:81], s[80:81], s[52:53]
    s_not_b64 vcc, s[52:53]
    s_mov_b64 exec, -1
    v_cndmask_b32_dpp v84, v84, v84, vcc wave_shr:1 row_mask:0xf bank_mask:0xf
    v_cndmask_b32_dpp v85, v85, v85, vcc wave_shr:1 row_mask:0xf bank_mask:0xf
    s_lshr_b64 s[52:53], s[52:53], 1
    v_cndmask_b32_dpp v86, v86, v86, vcc wave_shr:1 row_mask:0xf bank_mask:0xf
    v_cndmask_b32_dpp v87, v87, v87, vcc wave_shr:1 row_mask:0xf bank_mask:0xf
    s_andn2_b64 s[82:83], s[82:83], s[52:53]
    v_cndmask_b32_dpp v7, v7, v7, vcc wave_shr:1 row_mask:0xf bank_mask:0xf
    s_mov_b64 exec, s[50:51]
    s_cbranch_scc0 L2_d88
    s_mov_b64 exec, s[82:83]
    s_nop 1
    v_mfma_f32_4x4x4_16b_bf16 v[88:91], v[12:13], v[84:85], 0
    s_nop 1
    v_mfma_f32_4x4x4_16b_bf16 v[88:91], v[10:11], v[86:87], v[88:91]
    s_nop 4
    v_cvt_pk_bf16_f32 v88, v88, v89
    v_cvt_pk_bf16_f32 v89, v90, v91
    ds_pk_add_bf16 v7, v88 offset:65408
    ds_pk_add_bf16 v7, v89 offset:65412
    s_mov_b64 exec, s[50:51]
    s_branch L2_d88
L2_oa89:
    s_waitcnt vmcnt(3)
    s_mov_b64 exec, s[6:7]
    v_lshrrev_b32 v114, 16, v114
    s_mov_b64 exec, -1
    v_and_b32 v46, 0x10000000, v32
    v_cmpx_eq_u32 vcc, 0, v46
    v_lshrrev_b32 v47, 14, v112
    v_and_b32 v47, v5, v47
    ds_read_b64 v[96:97], v47
    v_perm_b32 v98, v112, v114, s44
    v_bitop3_b32 v99, v112, 0.5, -0.5 bitop3:0xa8
    v_bitop3_b32 v98, v6, v98, v99 bitop3:0xca
    v_and_b32 v47, v5, v112
    s_waitcnt lgkmcnt(0)
    v_mfma_f32_4x4x4_16b_bf16 v[88:91], v[8:9], v[96:97], 0
    s_nop 4
    v_mul_f32 v88, v98, v88
    v_mul_f32 v89, v98, v89
    v_mul_f32 v90, v98, v90
    v_mul_f32 v91, v98, v91
    v_cvt_pk_bf16_f32 v88, v88, v89
    v_cvt_pk_bf16_f32 v89, v90, v91
    ds_pk_add_bf16 v47, v88 offset:65408
    ds_pk_add_bf16 v47, v89 offset:65412
    s_mov_b64 exec, -1
    v_and_b32 v46, 0x20000000, v32
    v_cmpx_eq_u32 vcc, 0, v46
    v_lshrrev_b32 v47, 14, v113
    v_and_b32 v47, v5, v47
    ds_read_b64 v[96:97], v47
    v_perm_b32 v98, v113, v114, s45
    v_bitop3_b32 v99, v113, 0.5, -0.5 bitop3:0xa8
    v_bitop3_b32 v98, v6, v98, v99 bitop3:0xca
    v_and_b32 v47, v5, v113
    s_waitcnt lgkmcnt(0)
    v_mfma_f32_4x4x4_16b_bf16 v[88:91], v[8:9], v[96:97], 0
    s_nop 4
    v_mul_f32 v88, v98, v88
    v_mul_f32 v89, v98, v89
    v_mul_f32 v90, v98, v90
    v_mul_f32 v91, v98, v91
    v_cvt_pk_bf16_f32 v88, v88, v89
    v_cvt_pk_bf16_f32 v89, v90, v91
    ds_pk_add_bf16 v47, v88 offset:65408
    ds_pk_add_bf16 v47, v89 offset:65412
    s_mov_b64 exec, -1
    s_branch L2_ob89
L2_xo90:
    v_cmp_lt_u32 vcc, 20, v99
    s_mov_b32 s101, 1
    s_cbranch_vccz L2_xp90
    v_cmp_lt_u32 vcc, 32, v99
    v_cmp_lt_u32 s[58:59], 31, v88
    s_mov_b32 s101, 2
    s_or_b64 vcc, vcc, s[58:59]
    s_cbranch_scc0 L2_xp90
    s_mov_b32 s37, 0x10000
    s_branch L2_xp90
L2_c91:
    s_lshl_b64 s[52:53], s[82:83], 1
    s_andn2_b64 s[52:53], s[52:53], s[80:81]
    s_andn2_b64 s[52:53], s[52:53], s[54:55]
    s_or_b64 s[80:81], s[80:81], s[52:53]
    s_not_b64 vcc, s[52:53]
    s_mov_b64 exec, -1
    v_cndmask_b32_dpp v84, v84, v84, vcc wave_shr:1 row_mask:0xf bank_mask:0xf
    v_cndmask_b32_dpp v85, v85, v85, vcc wave_shr:1 row_mask:0xf bank_mask:0xf
    s_lshr_b64 s[52:53], s[52:53], 1
    v_cndmask_b32_dpp v86, v86, v86, vcc wave_shr:1 row_mask:0xf bank_mask:0xf
    v_cndmask_b32_dpp v87, v87, v87, vcc wave_shr:1 row_mask:0xf bank_mask:0xf
    s_andn2_b64 s[82:83], s[82:83], s[52:53]
    v_cndmask_b32_dpp v7, v7, v7, vcc wave_shr:1 row_mask:0xf bank_mask:0xf
    s_mov_b64 exec, s[54:55]
    s_cbranch_scc0 L2_d91
    s_mov_b64 exec, s[82:83]
    s_nop 1
    v_mfma_f32_4x4x4_16b_bf16 v[88:91], v[12:13], v[84:85], 0
    s_nop 1
    v_mfma_f32_4x4x4_16b_bf16 v[88:91], v[10:11], v[86:87], v[88:91]
    s_nop 4
    v_cvt_pk_bf16_f32 v88, v88, v89
    v_cvt_pk_bf16_f32 v89, v90, v91
    ds_pk_add_bf16 v7, v88 offset:65408
    ds_pk_add_bf16 v7, v89 offset:65412
    s_mov_b64 exec, s[54:55]
    s_branch L2_d91
L2_c92:
    s_lshl_b64 s[52:53], s[82:83], 1
    s_andn2_b64 s[52:53], s[52:53], s[80:81]
    s_andn2_b64 s[52:53], s[52:53], s[50:51]
    s_or_b64 s[80:81], s[80:81], s[52:53]
    s_not_b64 vcc, s[52:53]
    s_mov_b64 exec, -1
    v_cndmask_b32_dpp v84, v84, v84, vcc wave_shr:1 row_mask:0xf bank_mask:0xf
    v_cndmask_b32_dpp v85, v85, v85, vcc wave_shr:1 row_mask:0xf bank_mask:0xf
    s_lshr_b64 s[52:53], s[52:53], 1
    v_cndmask_b32_dpp v86, v86, v86, vcc wave_shr:1 row_mask:0xf bank_mask:0xf
    v_cndmask_b32_dpp v87, v87, v87, vcc wave_shr:1 row_mask:0xf bank_mask:0xf
    s_andn2_b64 s[82:83], s[82:83], s[52:53]
    v_cndmask_b32_dpp v7, v7, v7, vcc wave_shr:1 row_mask:0xf bank_mask:0xf
    s_mov_b64 exec, s[50:51]
    s_cbranch_scc0 L2_d92
    s_mov_b64 exec, s[82:83]
    s_nop 1
    v_mfma_f32_4x4x4_16b_bf16 v[88:91], v[12:13], v[84:85], 0
    s_nop 1
    v_mfma_f32_4x4x4_16b_bf16 v[88:91], v[10:11], v[86:87], v[88:91]
    s_nop 4
    v_cvt_pk_bf16_f32 v88, v88, v89
    v_cvt_pk_bf16_f32 v89, v90, v91
    ds_pk_add_bf16 v7, v88 offset:65408
    ds_pk_add_bf16 v7, v89 offset:65412
    s_mov_b64 exec, s[50:51]
    s_branch L2_d92
L2_c93:
    s_lshl_b64 s[52:53], s[82:83], 1
    s_andn2_b64 s[52:53], s[52:53], s[80:81]
    s_andn2_b64 s[52:53], s[52:53], s[54:55]
    s_or_b64 s[80:81], s[80:81], s[52:53]
    s_not_b64 vcc, s[52:53]
    s_mov_b64 exec, -1
    v_cndmask_b32_dpp v84, v84, v84, vcc wave_shr:1 row_mask:0xf bank_mask:0xf
    v_cndmask_b32_dpp v85, v85, v85, vcc wave_shr:1 row_mask:0xf bank_mask:0xf
    s_lshr_b64 s[52:53], s[52:53], 1
    v_cndmask_b32_dpp v86, v86, v86, vcc wave_shr:1 row_mask:0xf bank_mask:0xf
    v_cndmask_b32_dpp v87, v87, v87, vcc wave_shr:1 row_mask:0xf bank_mask:0xf
    s_andn2_b64 s[82:83], s[82:83], s[52:53]
    v_cndmask_b32_dpp v7, v7, v7, vcc wave_shr:1 row_mask:0xf bank_mask:0xf
    s_mov_b64 exec, s[54:55]
    s_cbranch_scc0 L2_d93
    s_mov_b64 exec, s[82:83]
    s_nop 1
    v_mfma_f32_4x4x4_16b_bf16 v[88:91], v[12:13], v[84:85], 0
    s_nop 1
    v_mfma_f32_4x4x4_16b_bf16 v[88:91], v[10:11], v[86:87], v[88:91]
    s_nop 4
    v_cvt_pk_bf16_f32 v88, v88, v89
    v_cvt_pk_bf16_f32 v89, v90, v91
    ds_pk_add_bf16 v7, v88 offset:65408
    ds_pk_add_bf16 v7, v89 offset:65412
    s_mov_b64 exec, s[54:55]
    s_branch L2_d93
L2_c94:
    s_lshl_b64 s[52:53], s[82:83], 1
    s_andn2_b64 s[52:53], s[52:53], s[80:81]
    s_andn2_b64 s[52:53], s[52:53], s[50:51]
    s_or_b64 s[80:81], s[80:81], s[52:53]
    s_not_b64 vcc, s[52:53]
    s_mov_b64 exec, -1
    v_cndmask_b32_dpp v84, v84, v84, vcc wave_shr:1 row_mask:0xf bank_mask:0xf
    v_cndmask_b32_dpp v85, v85, v85, vcc wave_shr:1 row_mask:0xf bank_mask:0xf
    s_lshr_b64 s[52:53], s[52:53], 1
    v_cndmask_b32_dpp v86, v86, v86, vcc wave_shr:1 row_mask:0xf bank_mask:0xf
    v_cndmask_b32_dpp v87, v87, v87, vcc wave_shr:1 row_mask:0xf bank_mask:0xf
    s_andn2_b64 s[82:83], s[82:83], s[52:53]
    v_cndmask_b32_dpp v7, v7, v7, vcc wave_shr:1 row_mask:0xf bank_mask:0xf
    s_mov_b64 exec, s[50:51]
    s_cbranch_scc0 L2_d94
    s_mov_b64 exec, s[82:83]
    s_nop 1
    v_mfma_f32_4x4x4_16b_bf16 v[88:91], v[12:13], v[84:85], 0
    s_nop 1
    v_mfma_f32_4x4x4_16b_bf16 v[88:91], v[10:11], v[86:87], v[88:91]
    s_nop 4
    v_cvt_pk_bf16_f32 v88, v88, v89
    v_cvt_pk_bf16_f32 v89, v90, v91
    ds_pk_add_bf16 v7, v88 offset:65408
    ds_pk_add_bf16 v7, v89 offset:65412
    s_mov_b64 exec, s[50:51]
    s_branch L2_d94
L2_c95:
    s_lshl_b64 s[52:53], s[82:83], 1
    s_andn2_b64 s[52:53], s[52:53], s[80:81]
    s_andn2_b64 s[52:53], s[52:53], s[54:55]
    s_or_b64 s[80:81], s[80:81], s[52:53]
    s_not_b64 vcc, s[52:53]
    s_mov_b64 exec, -1
    v_cndmask_b32_dpp v84, v84, v84, vcc wave_shr:1 row_mask:0xf bank_mask:0xf
    v_cndmask_b32_dpp v85, v85, v85, vcc wave_shr:1 row_mask:0xf bank_mask:0xf
    s_lshr_b64 s[52:53], s[52:53], 1
    v_cndmask_b32_dpp v86, v86, v86, vcc wave_shr:1 row_mask:0xf bank_mask:0xf
    v_cndmask_b32_dpp v87, v87, v87, vcc wave_shr:1 row_mask:0xf bank_mask:0xf
    s_andn2_b64 s[82:83], s[82:83], s[52:53]
    v_cndmask_b32_dpp v7, v7, v7, vcc wave_shr:1 row_mask:0xf bank_mask:0xf
    s_mov_b64 exec, s[54:55]
    s_cbranch_scc0 L2_d95
    s_mov_b64 exec, s[82:83]
    s_nop 1
    v_mfma_f32_4x4x4_16b_bf16 v[88:91], v[12:13], v[84:85], 0
    s_nop 1
    v_mfma_f32_4x4x4_16b_bf16 v[88:91], v[10:11], v[86:87], v[88:91]
    s_nop 4
    v_cvt_pk_bf16_f32 v88, v88, v89
    v_cvt_pk_bf16_f32 v89, v90, v91
    ds_pk_add_bf16 v7, v88 offset:65408
    ds_pk_add_bf16 v7, v89 offset:65412
    s_mov_b64 exec, s[54:55]
    s_branch L2_d95
L2_c96:
    s_lshl_b64 s[52:53], s[82:83], 1
    s_andn2_b64 s[52:53], s[52:53], s[80:81]
    s_andn2_b64 s[52:53], s[52:53], s[50:51]
    s_or_b64 s[80:81], s[80:81], s[52:53]
    s_not_b64 vcc, s[52:53]
    s_mov_b64 exec, -1
    v_cndmask_b32_dpp v84, v84, v84, vcc wave_shr:1 row_mask:0xf bank_mask:0xf
    v_cndmask_b32_dpp v85, v85, v85, vcc wave_shr:1 row_mask:0xf bank_mask:0xf
    s_lshr_b64 s[52:53], s[52:53], 1
    v_cndmask_b32_dpp v86, v86, v86, vcc wave_shr:1 row_mask:0xf bank_mask:0xf
    v_cndmask_b32_dpp v87, v87, v87, vcc wave_shr:1 row_mask:0xf bank_mask:0xf
    s_andn2_b64 s[82:83], s[82:83], s[52:53]
    v_cndmask_b32_dpp v7, v7, v7, vcc wave_shr:1 row_mask:0xf bank_mask:0xf
    s_mov_b64 exec, s[50:51]
    s_cbranch_scc0 L2_d96
    s_mov_b64 exec, s[82:83]
    s_nop 1
    v_mfma_f32_4x4x4_16b_bf16 v[88:91], v[12:13], v[84:85], 0
    s_nop 1
    v_mfma_f32_4x4x4_16b_bf16 v[88:91], v[10:11], v[86:87], v[88:91]
    s_nop 4
    v_cvt_pk_bf16_f32 v88, v88, v89
    v_cvt_pk_bf16_f32 v89, v90, v91
    ds_pk_add_bf16 v7, v88 offset:65408
    ds_pk_add_bf16 v7, v89 offset:65412
    s_mov_b64 exec, s[50:51]
    s_branch L2_d96
L2_xa97:
    s_cmp_eq_u32 s101, 1
    s_cbranch_scc1 L2_xc97
    v_lshlrev_b32 v89, 0, v96
    v_add_u32 v90, 140, v97
    v_bitop3_b32 v90, v89, v45, v90 bitop3:0x6a
    ds_write_b32 v98, v90 offset:28
    v_lshlrev_b32 v89, 4, v96
    v_add_u32 v90, 120, v97
    v_bitop3_b32 v90, v89, v45, v90 bitop3:0x6a
    ds_write_b32 v98, v90 offset:24
    v_lshlrev_b32 v89, 8, v96
    v_add_u32 v90, 100, v97
    v_bitop3_b32 v90, v89, v45, v90 bitop3:0x6a
    ds_write_b32 v98, v90 offset:20
L2_xc97:
    v_lshlrev_b32 v89, 12, v96
    v_add_u32 v90, 80, v97
    v_bitop3_b32 v90, v89, v45, v90 bitop3:0x6a
    ds_write_b32 v98, v90 offset:16
    s_branch L2_xb97
L2_xe97:
    v_cmp_lt_u32 vcc, 32, v99
    v_cmp_lt_u32 s[58:59], 31, v88
    v_lshrrev_b32 v89, 16, v96
    v_add_u32 v97, 80, v97
    s_or_b64 vcc, vcc, s[58:59]
    s_cbranch_scc1 L2_xs97
    v_lshlrev_b32 v89, v1, v89
    v_and_b32 v89, v45, v89
    v_cmp_ne_u32 vcc, 0, v89
    v_xor_b32 v90, v97, v89
    s_add_u32 s3, s37, s38
    v_mbcnt_lo_u32_b32 v98, vcc_lo, 0
    v_mbcnt_hi_u32_b32 v98, vcc_hi, v98
    s_bcnt1_i32_b64 s41, vcc
    v_lshl_add_u32 v98, v98, 2, s3
    s_lshl2_add_u32 s37, s41, s37
    s_mov_b64 exec, vcc
    ds_write_b32 v98, v90
    s_mov_b64 exec, -1
    s_branch L2_xr97
L2_xs97:
    s_waitcnt lgkmcnt(0)
    s_mov_b32 s37, 0x10000
    s_branch L2_xw97
L2_c98:
    s_lshl_b64 s[52:53], s[82:83], 1
    s_andn2_b64 s[52:53], s[52:53], s[80:81]
    s_andn2_b64 s[52:53], s[52:53], s[54:55]
    s_or_b64 s[80:81], s[80:81], s[52:53]
    s_not_b64 vcc, s[52:53]
    s_mov_b64 exec, -1
    v_cndmask_b32_dpp v84, v84, v84, vcc wave_shr:1 row_mask:0xf bank_mask:0xf
    v_cndmask_b32_dpp v85, v85, v85, vcc wave_shr:1 row_mask:0xf bank_mask:0xf
    s_lshr_b64 s[52:53], s[52:53], 1
    v_cndmask_b32_dpp v86, v86, v86, vcc wave_shr:1 row_mask:0xf bank_mask:0xf
    v_cndmask_b32_dpp v87, v87, v87, vcc wave_shr:1 row_mask:0xf bank_mask:0xf
    s_andn2_b64 s[82:83], s[82:83], s[52:53]
    v_cndmask_b32_dpp v7, v7, v7, vcc wave_shr:1 row_mask:0xf bank_mask:0xf
    s_mov_b64 exec, s[54:55]
    s_cbranch_scc0 L2_d98
    s_mov_b64 exec, s[82:83]
    s_nop 1
    v_mfma_f32_4x4x4_16b_bf16 v[88:91], v[12:13], v[84:85], 0
    s_nop 1
    v_mfma_f32_4x4x4_16b_bf16 v[88:91], v[10:11], v[86:87], v[88:91]
    s_nop 4
    v_cvt_pk_bf16_f32 v88, v88, v89
    v_cvt_pk_bf16_f32 v89, v90, v91
    ds_pk_add_bf16 v7, v88 offset:65408
    ds_pk_add_bf16 v7, v89 offset:65412
    s_mov_b64 exec, s[54:55]
    s_branch L2_d98
L2_c99:
    s_lshl_b64 s[52:53], s[82:83], 1
    s_andn2_b64 s[52:53], s[52:53], s[80:81]
    s_andn2_b64 s[52:53], s[52:53], s[50:51]
    s_or_b64 s[80:81], s[80:81], s[52:53]
    s_not_b64 vcc, s[52:53]
    s_mov_b64 exec, -1
    v_cndmask_b32_dpp v84, v84, v84, vcc wave_shr:1 row_mask:0xf bank_mask:0xf
    v_cndmask_b32_dpp v85, v85, v85, vcc wave_shr:1 row_mask:0xf bank_mask:0xf
    s_lshr_b64 s[52:53], s[52:53], 1
    v_cndmask_b32_dpp v86, v86, v86, vcc wave_shr:1 row_mask:0xf bank_mask:0xf
    v_cndmask_b32_dpp v87, v87, v87, vcc wave_shr:1 row_mask:0xf bank_mask:0xf
    s_andn2_b64 s[82:83], s[82:83], s[52:53]
    v_cndmask_b32_dpp v7, v7, v7, vcc wave_shr:1 row_mask:0xf bank_mask:0xf
    s_mov_b64 exec, s[50:51]
    s_cbranch_scc0 L2_d99
    s_mov_b64 exec, s[82:83]
    s_nop 1
    v_mfma_f32_4x4x4_16b_bf16 v[88:91], v[12:13], v[84:85], 0
    s_nop 1
    v_mfma_f32_4x4x4_16b_bf16 v[88:91], v[10:11], v[86:87], v[88:91]
    s_nop 4
    v_cvt_pk_bf16_f32 v88, v88, v89
    v_cvt_pk_bf16_f32 v89, v90, v91
    ds_pk_add_bf16 v7, v88 offset:65408
    ds_pk_add_bf16 v7, v89 offset:65412
    s_mov_b64 exec, s[50:51]
    s_branch L2_d99
L2_xf97:
    s_cmp_gt_u32 s37, 1024
    s_cbranch_scc1 L2_xt97
    s_cmp_lt_u32 s37, 768
    s_cbranch_scc1 L2_xl97
    ds_read_b32 v32, v44 offset:896
    s_add_u32 s3, s42, 2
    s_bitset1_b32 s43, s3
    s_branch L2_xg97
L2_xl97:
    s_waitcnt lgkmcnt(0)
    v_mov_b32 v31, -1
    s_cmp_ge_u32 s37, 512
    s_cbranch_scc1 L2_xg97
    v_mov_b32 v39, -1
    s_cmp_ge_u32 s37, 256
    s_cbranch_scc1 L2_xg97
    v_mov_b32 v27, -1
    s_branch L2_xg97
L2_xt97:
    s_waitcnt lgkmcnt(0)
    v_mov_b32 v21, -1
    v_mov_b32 v27, -1
    v_mov_b32 v39, -1
    v_mov_b32 v31, -1
    s_add_u32 s3, s42, 2
    s_bitset1_b32 s36, s3
    s_branch L2_xg97
L2_oa100:
    v_and_b32 v47, 0x0fffffff, v33
    buffer_load_dword v114, v47, s[8:11], 0 offen offset:16
    s_mov_b64 exec, s[6:7]
    v_add_u32 v47, 8, v47
    v_lshrrev_b32 v33, 2, v33
    s_mov_b64 exec, -1
    buffer_load_dwordx2 v[112:113], v47, s[8:11], 0 offen
    s_branch L2_ob100
L2_c101:
    s_lshl_b64 s[52:53], s[82:83], 1
    s_andn2_b64 s[52:53], s[52:53], s[80:81]
    s_andn2_b64 s[52:53], s[52:53], s[54:55]
    s_or_b64 s[80:81], s[80:81], s[52:53]
    s_not_b64 vcc, s[52:53]
    s_mov_b64 exec, -1
    v_cndmask_b32_dpp v84, v84, v84, vcc wave_shr:1 row_mask:0xf bank_mask:0xf
    v_cndmask_b32_dpp v85, v85, v85, vcc wave_shr:1 row_mask:0xf bank_mask:0xf
    s_lshr_b64 s[52:53], s[52:53], 1
    v_cndmask_b32_dpp v86, v86, v86, vcc wave_shr:1 row_mask:0xf bank_mask:0xf
    v_cndmask_b32_dpp v87, v87, v87, vcc wave_shr:1 row_mask:0xf bank_mask:0xf
    s_andn2_b64 s[82:83], s[82:83], s[52:53]
    v_cndmask_b32_dpp v7, v7, v7, vcc wave_shr:1 row_mask:0xf bank_mask:0xf
    s_mov_b64 exec, s[54:55]
    s_cbranch_scc0 L2_d101
    s_mov_b64 exec, s[82:83]
    s_nop 1
    v_mfma_f32_4x4x4_16b_bf16 v[88:91], v[12:13], v[84:85], 0
    s_nop 1
    v_mfma_f32_4x4x4_16b_bf16 v[88:91], v[10:11], v[86:87], v[88:91]
    s_nop 4
    v_cvt_pk_bf16_f32 v88, v88, v89
    v_cvt_pk_bf16_f32 v89, v90, v91
    ds_pk_add_bf16 v7, v88 offset:65408
    ds_pk_add_bf16 v7, v89 offset:65412
    s_mov_b64 exec, s[54:55]
    s_branch L2_d101
L2_c102:
    s_lshl_b64 s[52:53], s[82:83], 1
    s_andn2_b64 s[52:53], s[52:53], s[80:81]
    s_andn2_b64 s[52:53], s[52:53], s[50:51]
    s_or_b64 s[80:81], s[80:81], s[52:53]
    s_not_b64 vcc, s[52:53]
    s_mov_b64 exec, -1
    v_cndmask_b32_dpp v84, v84, v84, vcc wave_shr:1 row_mask:0xf bank_mask:0xf
    v_cndmask_b32_dpp v85, v85, v85, vcc wave_shr:1 row_mask:0xf bank_mask:0xf
    s_lshr_b64 s[52:53], s[52:53], 1
    v_cndmask_b32_dpp v86, v86, v86, vcc wave_shr:1 row_mask:0xf bank_mask:0xf
    v_cndmask_b32_dpp v87, v87, v87, vcc wave_shr:1 row_mask:0xf bank_mask:0xf
    s_andn2_b64 s[82:83], s[82:83], s[52:53]
    v_cndmask_b32_dpp v7, v7, v7, vcc wave_shr:1 row_mask:0xf bank_mask:0xf
    s_mov_b64 exec, s[50:51]
    s_cbranch_scc0 L2_d102
    s_mov_b64 exec, s[82:83]
    s_nop 1
    v_mfma_f32_4x4x4_16b_bf16 v[88:91], v[12:13], v[84:85], 0
    s_nop 1
    v_mfma_f32_4x4x4_16b_bf16 v[88:91], v[10:11], v[86:87], v[88:91]
    s_nop 4
    v_cvt_pk_bf16_f32 v88, v88, v89
    v_cvt_pk_bf16_f32 v89, v90, v91
    ds_pk_add_bf16 v7, v88 offset:65408
    ds_pk_add_bf16 v7, v89 offset:65412
    s_mov_b64 exec, s[50:51]
    s_branch L2_d102
L2_c103:
    s_lshl_b64 s[52:53], s[82:83], 1
    s_andn2_b64 s[52:53], s[52:53], s[80:81]
    s_andn2_b64 s[52:53], s[52:53], s[54:55]
    s_or_b64 s[80:81], s[80:81], s[52:53]
    s_not_b64 vcc, s[52:53]
    s_mov_b64 exec, -1
    v_cndmask_b32_dpp v84, v84, v84, vcc wave_shr:1 row_mask:0xf bank_mask:0xf
    v_cndmask_b32_dpp v85, v85, v85, vcc wave_shr:1 row_mask:0xf bank_mask:0xf
    s_lshr_b64 s[52:53], s[52:53], 1
    v_cndmask_b32_dpp v86, v86, v86, vcc wave_shr:1 row_mask:0xf bank_mask:0xf
    v_cndmask_b32_dpp v87, v87, v87, vcc wave_shr:1 row_mask:0xf bank_mask:0xf
    s_andn2_b64 s[82:83], s[82:83], s[52:53]
    v_cndmask_b32_dpp v7, v7, v7, vcc wave_shr:1 row_mask:0xf bank_mask:0xf
    s_mov_b64 exec, s[54:55]
    s_cbranch_scc0 L2_d103
    s_mov_b64 exec, s[82:83]
    s_nop 1
    v_mfma_f32_4x4x4_16b_bf16 v[88:91], v[12:13], v[84:85], 0
    s_nop 1
    v_mfma_f32_4x4x4_16b_bf16 v[88:91], v[10:11], v[86:87], v[88:91]
    s_nop 4
    v_cvt_pk_bf16_f32 v88, v88, v89
    v_cvt_pk_bf16_f32 v89, v90, v91
    ds_pk_add_bf16 v7, v88 offset:65408
    ds_pk_add_bf16 v7, v89 offset:65412
    s_mov_b64 exec, s[54:55]
    s_branch L2_d103
L2_c104:
    s_lshl_b64 s[52:53], s[82:83], 1
    s_andn2_b64 s[52:53], s[52:53], s[80:81]
    s_andn2_b64 s[52:53], s[52:53], s[50:51]
    s_or_b64 s[80:81], s[80:81], s[52:53]
    s_not_b64 vcc, s[52:53]
    s_mov_b64 exec, -1
    v_cndmask_b32_dpp v84, v84, v84, vcc wave_shr:1 row_mask:0xf bank_mask:0xf
    v_cndmask_b32_dpp v85, v85, v85, vcc wave_shr:1 row_mask:0xf bank_mask:0xf
    s_lshr_b64 s[52:53], s[52:53], 1
    v_cndmask_b32_dpp v86, v86, v86, vcc wave_shr:1 row_mask:0xf bank_mask:0xf
    v_cndmask_b32_dpp v87, v87, v87, vcc wave_shr:1 row_mask:0xf bank_mask:0xf
    s_andn2_b64 s[82:83], s[82:83], s[52:53]
    v_cndmask_b32_dpp v7, v7, v7, vcc wave_shr:1 row_mask:0xf bank_mask:0xf
    s_mov_b64 exec, s[50:51]
    s_cbranch_scc0 L2_d104
    s_mov_b64 exec, s[82:83]
    s_nop 1
    v_mfma_f32_4x4x4_16b_bf16 v[88:91], v[12:13], v[84:85], 0
    s_nop 1
    v_mfma_f32_4x4x4_16b_bf16 v[88:91], v[10:11], v[86:87], v[88:91]
    s_nop 4
    v_cvt_pk_bf16_f32 v88, v88, v89
    v_cvt_pk_bf16_f32 v89, v90, v91
    ds_pk_add_bf16 v7, v88 offset:65408
    ds_pk_add_bf16 v7, v89 offset:65412
    s_mov_b64 exec, s[50:51]
    s_branch L2_d104
L2_c105:
    s_lshl_b64 s[52:53], s[82:83], 1
    s_andn2_b64 s[52:53], s[52:53], s[80:81]
    s_andn2_b64 s[52:53], s[52:53], s[54:55]
    s_or_b64 s[80:81], s[80:81], s[52:53]
    s_not_b64 vcc, s[52:53]
    s_mov_b64 exec, -1
    v_cndmask_b32_dpp v84, v84, v84, vcc wave_shr:1 row_mask:0xf bank_mask:0xf
    v_cndmask_b32_dpp v85, v85, v85, vcc wave_shr:1 row_mask:0xf bank_mask:0xf
    s_lshr_b64 s[52:53], s[52:53], 1
    v_cndmask_b32_dpp v86, v86, v86, vcc wave_shr:1 row_mask:0xf bank_mask:0xf
    v_cndmask_b32_dpp v87, v87, v87, vcc wave_shr:1 row_mask:0xf bank_mask:0xf
    s_andn2_b64 s[82:83], s[82:83], s[52:53]
    v_cndmask_b32_dpp v7, v7, v7, vcc wave_shr:1 row_mask:0xf bank_mask:0xf
    s_mov_b64 exec, s[54:55]
    s_cbranch_scc0 L2_d105
    s_mov_b64 exec, s[82:83]
    s_nop 1
    v_mfma_f32_4x4x4_16b_bf16 v[88:91], v[12:13], v[84:85], 0
    s_nop 1
    v_mfma_f32_4x4x4_16b_bf16 v[88:91], v[10:11], v[86:87], v[88:91]
    s_nop 4
    v_cvt_pk_bf16_f32 v88, v88, v89
    v_cvt_pk_bf16_f32 v89, v90, v91
    ds_pk_add_bf16 v7, v88 offset:65408
    ds_pk_add_bf16 v7, v89 offset:65412
    s_mov_b64 exec, s[54:55]
    s_branch L2_d105
L2_c106:
    s_lshl_b64 s[52:53], s[82:83], 1
    s_andn2_b64 s[52:53], s[52:53], s[80:81]
    s_andn2_b64 s[52:53], s[52:53], s[50:51]
    s_or_b64 s[80:81], s[80:81], s[52:53]
    s_not_b64 vcc, s[52:53]
    s_mov_b64 exec, -1
    v_cndmask_b32_dpp v84, v84, v84, vcc wave_shr:1 row_mask:0xf bank_mask:0xf
    v_cndmask_b32_dpp v85, v85, v85, vcc wave_shr:1 row_mask:0xf bank_mask:0xf
    s_lshr_b64 s[52:53], s[52:53], 1
    v_cndmask_b32_dpp v86, v86, v86, vcc wave_shr:1 row_mask:0xf bank_mask:0xf
    v_cndmask_b32_dpp v87, v87, v87, vcc wave_shr:1 row_mask:0xf bank_mask:0xf
    s_andn2_b64 s[82:83], s[82:83], s[52:53]
    v_cndmask_b32_dpp v7, v7, v7, vcc wave_shr:1 row_mask:0xf bank_mask:0xf
    s_mov_b64 exec, s[50:51]
    s_cbranch_scc0 L2_d106
    s_mov_b64 exec, s[82:83]
    s_nop 1
    v_mfma_f32_4x4x4_16b_bf16 v[88:91], v[12:13], v[84:85], 0
    s_nop 1
    v_mfma_f32_4x4x4_16b_bf16 v[88:91], v[10:11], v[86:87], v[88:91]
    s_nop 4
    v_cvt_pk_bf16_f32 v88, v88, v89
    v_cvt_pk_bf16_f32 v89, v90, v91
    ds_pk_add_bf16 v7, v88 offset:65408
    ds_pk_add_bf16 v7, v89 offset:65412
    s_mov_b64 exec, s[50:51]
    s_branch L2_d106
L2_oa107:
    s_waitcnt vmcnt(3)
    s_mov_b64 exec, s[6:7]
    v_lshrrev_b32 v114, 16, v114
    s_mov_b64 exec, -1
    v_and_b32 v46, 0x10000000, v33
    v_cmpx_eq_u32 vcc, 0, v46
    v_lshrrev_b32 v47, 14, v112
    v_and_b32 v47, v5, v47
    ds_read_b64 v[96:97], v47
    v_perm_b32 v98, v112, v114, s44
    v_bitop3_b32 v99, v112, 0.5, -0.5 bitop3:0xa8
    v_bitop3_b32 v98, v6, v98, v99 bitop3:0xca
    v_and_b32 v47, v5, v112
    s_waitcnt lgkmcnt(0)
    v_mfma_f32_4x4x4_16b_bf16 v[88:91], v[8:9], v[96:97], 0
    s_nop 4
    v_mul_f32 v88, v98, v88
    v_mul_f32 v89, v98, v89
    v_mul_f32 v90, v98, v90
    v_mul_f32 v91, v98, v91
    v_cvt_pk_bf16_f32 v88, v88, v89
    v_cvt_pk_bf16_f32 v89, v90, v91
    ds_pk_add_bf16 v47, v88 offset:65408
    ds_pk_add_bf16 v47, v89 offset:65412
    s_mov_b64 exec, -1
    v_and_b32 v46, 0x20000000, v33
    v_cmpx_eq_u32 vcc, 0, v46
    v_lshrrev_b32 v47, 14, v113
    v_and_b32 v47, v5, v47
    ds_read_b64 v[96:97], v47
    v_perm_b32 v98, v113, v114, s45
    v_bitop3_b32 v99, v113, 0.5, -0.5 bitop3:0xa8
    v_bitop3_b32 v98, v6, v98, v99 bitop3:0xca
    v_and_b32 v47, v5, v113
    s_waitcnt lgkmcnt(0)
    v_mfma_f32_4x4x4_16b_bf16 v[88:91], v[8:9], v[96:97], 0
    s_nop 4
    v_mul_f32 v88, v98, v88
    v_mul_f32 v89, v98, v89
    v_mul_f32 v90, v98, v90
    v_mul_f32 v91, v98, v91
    v_cvt_pk_bf16_f32 v88, v88, v89
    v_cvt_pk_bf16_f32 v89, v90, v91
    ds_pk_add_bf16 v47, v88 offset:65408
    ds_pk_add_bf16 v47, v89 offset:65412
    s_mov_b64 exec, -1
    s_branch L2_ob107
L2_xo108:
    v_cmp_lt_u32 vcc, 20, v99
    s_mov_b32 s101, 1
    s_cbranch_vccz L2_xp108
    v_cmp_lt_u32 vcc, 32, v99
    v_cmp_lt_u32 s[58:59], 31, v88
    s_mov_b32 s101, 2
    s_or_b64 vcc, vcc, s[58:59]
    s_cbranch_scc0 L2_xp108
    s_mov_b32 s37, 0x10000
    s_branch L2_xp108
L2_c109:
    s_lshl_b64 s[52:53], s[82:83], 1
    s_andn2_b64 s[52:53], s[52:53], s[80:81]
    s_andn2_b64 s[52:53], s[52:53], s[54:55]
    s_or_b64 s[80:81], s[80:81], s[52:53]
    s_not_b64 vcc, s[52:53]
    s_mov_b64 exec, -1
    v_cndmask_b32_dpp v84, v84, v84, vcc wave_shr:1 row_mask:0xf bank_mask:0xf
    v_cndmask_b32_dpp v85, v85, v85, vcc wave_shr:1 row_mask:0xf bank_mask:0xf
    s_lshr_b64 s[52:53], s[52:53], 1
    v_cndmask_b32_dpp v86, v86, v86, vcc wave_shr:1 row_mask:0xf bank_mask:0xf
    v_cndmask_b32_dpp v87, v87, v87, vcc wave_shr:1 row_mask:0xf bank_mask:0xf
    s_andn2_b64 s[82:83], s[82:83], s[52:53]
    v_cndmask_b32_dpp v7, v7, v7, vcc wave_shr:1 row_mask:0xf bank_mask:0xf
    s_mov_b64 exec, s[54:55]
    s_cbranch_scc0 L2_d109
    s_mov_b64 exec, s[82:83]
    s_nop 1
    v_mfma_f32_4x4x4_16b_bf16 v[88:91], v[12:13], v[84:85], 0
    s_nop 1
    v_mfma_f32_4x4x4_16b_bf16 v[88:91], v[10:11], v[86:87], v[88:91]
    s_nop 4
    v_cvt_pk_bf16_f32 v88, v88, v89
    v_cvt_pk_bf16_f32 v89, v90, v91
    ds_pk_add_bf16 v7, v88 offset:65408
    ds_pk_add_bf16 v7, v89 offset:65412
    s_mov_b64 exec, s[54:55]
    s_branch L2_d109
L2_c110:
    s_lshl_b64 s[52:53], s[82:83], 1
    s_andn2_b64 s[52:53], s[52:53], s[80:81]
    s_andn2_b64 s[52:53], s[52:53], s[50:51]
    s_or_b64 s[80:81], s[80:81], s[52:53]
    s_not_b64 vcc, s[52:53]
    s_mov_b64 exec, -1
    v_cndmask_b32_dpp v84, v84, v84, vcc wave_shr:1 row_mask:0xf bank_mask:0xf
    v_cndmask_b32_dpp v85, v85, v85, vcc wave_shr:1 row_mask:0xf bank_mask:0xf
    s_lshr_b64 s[52:53], s[52:53], 1
    v_cndmask_b32_dpp v86, v86, v86, vcc wave_shr:1 row_mask:0xf bank_mask:0xf
    v_cndmask_b32_dpp v87, v87, v87, vcc wave_shr:1 row_mask:0xf bank_mask:0xf
    s_andn2_b64 s[82:83], s[82:83], s[52:53]
    v_cndmask_b32_dpp v7, v7, v7, vcc wave_shr:1 row_mask:0xf bank_mask:0xf
    s_mov_b64 exec, s[50:51]
    s_cbranch_scc0 L2_d110
    s_mov_b64 exec, s[82:83]
    s_nop 1
    v_mfma_f32_4x4x4_16b_bf16 v[88:91], v[12:13], v[84:85], 0
    s_nop 1
    v_mfma_f32_4x4x4_16b_bf16 v[88:91], v[10:11], v[86:87], v[88:91]
    s_nop 4
    v_cvt_pk_bf16_f32 v88, v88, v89
    v_cvt_pk_bf16_f32 v89, v90, v91
    ds_pk_add_bf16 v7, v88 offset:65408
    ds_pk_add_bf16 v7, v89 offset:65412
    s_mov_b64 exec, s[50:51]
    s_branch L2_d110
L2_c111:
    s_lshl_b64 s[52:53], s[82:83], 1
    s_andn2_b64 s[52:53], s[52:53], s[80:81]
    s_andn2_b64 s[52:53], s[52:53], s[54:55]
    s_or_b64 s[80:81], s[80:81], s[52:53]
    s_not_b64 vcc, s[52:53]
    s_mov_b64 exec, -1
    v_cndmask_b32_dpp v84, v84, v84, vcc wave_shr:1 row_mask:0xf bank_mask:0xf
    v_cndmask_b32_dpp v85, v85, v85, vcc wave_shr:1 row_mask:0xf bank_mask:0xf
    s_lshr_b64 s[52:53], s[52:53], 1
    v_cndmask_b32_dpp v86, v86, v86, vcc wave_shr:1 row_mask:0xf bank_mask:0xf
    v_cndmask_b32_dpp v87, v87, v87, vcc wave_shr:1 row_mask:0xf bank_mask:0xf
    s_andn2_b64 s[82:83], s[82:83], s[52:53]
    v_cndmask_b32_dpp v7, v7, v7, vcc wave_shr:1 row_mask:0xf bank_mask:0xf
    s_mov_b64 exec, s[54:55]
    s_cbranch_scc0 L2_d111
    s_mov_b64 exec, s[82:83]
    s_nop 1
    v_mfma_f32_4x4x4_16b_bf16 v[88:91], v[12:13], v[84:85], 0
    s_nop 1
    v_mfma_f32_4x4x4_16b_bf16 v[88:91], v[10:11], v[86:87], v[88:91]
    s_nop 4
    v_cvt_pk_bf16_f32 v88, v88, v89
    v_cvt_pk_bf16_f32 v89, v90, v91
    ds_pk_add_bf16 v7, v88 offset:65408
    ds_pk_add_bf16 v7, v89 offset:65412
    s_mov_b64 exec, s[54:55]
    s_branch L2_d111
L2_c112:
    s_lshl_b64 s[52:53], s[82:83], 1
    s_andn2_b64 s[52:53], s[52:53], s[80:81]
    s_andn2_b64 s[52:53], s[52:53], s[50:51]
    s_or_b64 s[80:81], s[80:81], s[52:53]
    s_not_b64 vcc, s[52:53]
    s_mov_b64 exec, -1
    v_cndmask_b32_dpp v84, v84, v84, vcc wave_shr:1 row_mask:0xf bank_mask:0xf
    v_cndmask_b32_dpp v85, v85, v85, vcc wave_shr:1 row_mask:0xf bank_mask:0xf
    s_lshr_b64 s[52:53], s[52:53], 1
    v_cndmask_b32_dpp v86, v86, v86, vcc wave_shr:1 row_mask:0xf bank_mask:0xf
    v_cndmask_b32_dpp v87, v87, v87, vcc wave_shr:1 row_mask:0xf bank_mask:0xf
    s_andn2_b64 s[82:83], s[82:83], s[52:53]
    v_cndmask_b32_dpp v7, v7, v7, vcc wave_shr:1 row_mask:0xf bank_mask:0xf
    s_mov_b64 exec, s[50:51]
    s_cbranch_scc0 L2_d112
    s_mov_b64 exec, s[82:83]
    s_nop 1
    v_mfma_f32_4x4x4_16b_bf16 v[88:91], v[12:13], v[84:85], 0
    s_nop 1
    v_mfma_f32_4x4x4_16b_bf16 v[88:91], v[10:11], v[86:87], v[88:91]
    s_nop 4
    v_cvt_pk_bf16_f32 v88, v88, v89
    v_cvt_pk_bf16_f32 v89, v90, v91
    ds_pk_add_bf16 v7, v88 offset:65408
    ds_pk_add_bf16 v7, v89 offset:65412
    s_mov_b64 exec, s[50:51]
    s_branch L2_d112
L2_c113:
    s_lshl_b64 s[52:53], s[82:83], 1
    s_andn2_b64 s[52:53], s[52:53], s[80:81]
    s_andn2_b64 s[52:53], s[52:53], s[54:55]
    s_or_b64 s[80:81], s[80:81], s[52:53]
    s_not_b64 vcc, s[52:53]
    s_mov_b64 exec, -1
    v_cndmask_b32_dpp v84, v84, v84, vcc wave_shr:1 row_mask:0xf bank_mask:0xf
    v_cndmask_b32_dpp v85, v85, v85, vcc wave_shr:1 row_mask:0xf bank_mask:0xf
    s_lshr_b64 s[52:53], s[52:53], 1
    v_cndmask_b32_dpp v86, v86, v86, vcc wave_shr:1 row_mask:0xf bank_mask:0xf
    v_cndmask_b32_dpp v87, v87, v87, vcc wave_shr:1 row_mask:0xf bank_mask:0xf
    s_andn2_b64 s[82:83], s[82:83], s[52:53]
    v_cndmask_b32_dpp v7, v7, v7, vcc wave_shr:1 row_mask:0xf bank_mask:0xf
    s_mov_b64 exec, s[54:55]
    s_cbranch_scc0 L2_d113
    s_mov_b64 exec, s[82:83]
    s_nop 1
    v_mfma_f32_4x4x4_16b_bf16 v[88:91], v[12:13], v[84:85], 0
    s_nop 1
    v_mfma_f32_4x4x4_16b_bf16 v[88:91], v[10:11], v[86:87], v[88:91]
    s_nop 4
    v_cvt_pk_bf16_f32 v88, v88, v89
    v_cvt_pk_bf16_f32 v89, v90, v91
    ds_pk_add_bf16 v7, v88 offset:65408
    ds_pk_add_bf16 v7, v89 offset:65412
    s_mov_b64 exec, s[54:55]
    s_branch L2_d113
L2_c114:
    s_lshl_b64 s[52:53], s[82:83], 1
    s_andn2_b64 s[52:53], s[52:53], s[80:81]
    s_andn2_b64 s[52:53], s[52:53], s[50:51]
    s_or_b64 s[80:81], s[80:81], s[52:53]
    s_not_b64 vcc, s[52:53]
    s_mov_b64 exec, -1
    v_cndmask_b32_dpp v84, v84, v84, vcc wave_shr:1 row_mask:0xf bank_mask:0xf
    v_cndmask_b32_dpp v85, v85, v85, vcc wave_shr:1 row_mask:0xf bank_mask:0xf
    s_lshr_b64 s[52:53], s[52:53], 1
    v_cndmask_b32_dpp v86, v86, v86, vcc wave_shr:1 row_mask:0xf bank_mask:0xf
    v_cndmask_b32_dpp v87, v87, v87, vcc wave_shr:1 row_mask:0xf bank_mask:0xf
    s_andn2_b64 s[82:83], s[82:83], s[52:53]
    v_cndmask_b32_dpp v7, v7, v7, vcc wave_shr:1 row_mask:0xf bank_mask:0xf
    s_mov_b64 exec, s[50:51]
    s_cbranch_scc0 L2_d114
    s_mov_b64 exec, s[82:83]
    s_nop 1
    v_mfma_f32_4x4x4_16b_bf16 v[88:91], v[12:13], v[84:85], 0
    s_nop 1
    v_mfma_f32_4x4x4_16b_bf16 v[88:91], v[10:11], v[86:87], v[88:91]
    s_nop 4
    v_cvt_pk_bf16_f32 v88, v88, v89
    v_cvt_pk_bf16_f32 v89, v90, v91
    ds_pk_add_bf16 v7, v88 offset:65408
    ds_pk_add_bf16 v7, v89 offset:65412
    s_mov_b64 exec, s[50:51]
    s_branch L2_d114
L2_xa115:
    s_cmp_eq_u32 s101, 1
    s_cbranch_scc1 L2_xc115
    v_lshlrev_b32 v89, 0, v96
    v_add_u32 v90, 140, v97
    v_bitop3_b32 v90, v89, v45, v90 bitop3:0x6a
    ds_write_b32 v98, v90 offset:28
    v_lshlrev_b32 v89, 4, v96
    v_add_u32 v90, 120, v97
    v_bitop3_b32 v90, v89, v45, v90 bitop3:0x6a
    ds_write_b32 v98, v90 offset:24
    v_lshlrev_b32 v89, 8, v96
    v_add_u32 v90, 100, v97
    v_bitop3_b32 v90, v89, v45, v90 bitop3:0x6a
    ds_write_b32 v98, v90 offset:20
L2_xc115:
    v_lshlrev_b32 v89, 12, v96
    v_add_u32 v90, 80, v97
    v_bitop3_b32 v90, v89, v45, v90 bitop3:0x6a
    ds_write_b32 v98, v90 offset:16
    s_branch L2_xb115
L2_xe115:
    v_cmp_lt_u32 vcc, 32, v99
    v_cmp_lt_u32 s[58:59], 31, v88
    v_lshrrev_b32 v89, 16, v96
    v_add_u32 v97, 80, v97
    s_or_b64 vcc, vcc, s[58:59]
    s_cbranch_scc1 L2_xs115
    v_lshlrev_b32 v89, v1, v89
    v_and_b32 v89, v45, v89
    v_cmp_ne_u32 vcc, 0, v89
    v_xor_b32 v90, v97, v89
    s_add_u32 s3, s37, s38
    v_mbcnt_lo_u32_b32 v98, vcc_lo, 0
    v_mbcnt_hi_u32_b32 v98, vcc_hi, v98
    s_bcnt1_i32_b64 s41, vcc
    v_lshl_add_u32 v98, v98, 2, s3
    s_lshl2_add_u32 s37, s41, s37
    s_mov_b64 exec, vcc
    ds_write_b32 v98, v90
    s_mov_b64 exec, -1
    s_branch L2_xr115
L2_xs115:
    s_waitcnt lgkmcnt(0)
    s_mov_b32 s37, 0x10000
    s_branch L2_xw115
L2_c116:
    s_lshl_b64 s[52:53], s[82:83], 1
    s_andn2_b64 s[52:53], s[52:53], s[80:81]
    s_andn2_b64 s[52:53], s[52:53], s[54:55]
    s_or_b64 s[80:81], s[80:81], s[52:53]
    s_not_b64 vcc, s[52:53]
    s_mov_b64 exec, -1
    v_cndmask_b32_dpp v84, v84, v84, vcc wave_shr:1 row_mask:0xf bank_mask:0xf
    v_cndmask_b32_dpp v85, v85, v85, vcc wave_shr:1 row_mask:0xf bank_mask:0xf
    s_lshr_b64 s[52:53], s[52:53], 1
    v_cndmask_b32_dpp v86, v86, v86, vcc wave_shr:1 row_mask:0xf bank_mask:0xf
    v_cndmask_b32_dpp v87, v87, v87, vcc wave_shr:1 row_mask:0xf bank_mask:0xf
    s_andn2_b64 s[82:83], s[82:83], s[52:53]
    v_cndmask_b32_dpp v7, v7, v7, vcc wave_shr:1 row_mask:0xf bank_mask:0xf
    s_mov_b64 exec, s[54:55]
    s_cbranch_scc0 L2_d116
    s_mov_b64 exec, s[82:83]
    s_nop 1
    v_mfma_f32_4x4x4_16b_bf16 v[88:91], v[12:13], v[84:85], 0
    s_nop 1
    v_mfma_f32_4x4x4_16b_bf16 v[88:91], v[10:11], v[86:87], v[88:91]
    s_nop 4
    v_cvt_pk_bf16_f32 v88, v88, v89
    v_cvt_pk_bf16_f32 v89, v90, v91
    ds_pk_add_bf16 v7, v88 offset:65408
    ds_pk_add_bf16 v7, v89 offset:65412
    s_mov_b64 exec, s[54:55]
    s_branch L2_d116
L2_c117:
    s_lshl_b64 s[52:53], s[82:83], 1
    s_andn2_b64 s[52:53], s[52:53], s[80:81]
    s_andn2_b64 s[52:53], s[52:53], s[50:51]
    s_or_b64 s[80:81], s[80:81], s[52:53]
    s_not_b64 vcc, s[52:53]
    s_mov_b64 exec, -1
    v_cndmask_b32_dpp v84, v84, v84, vcc wave_shr:1 row_mask:0xf bank_mask:0xf
    v_cndmask_b32_dpp v85, v85, v85, vcc wave_shr:1 row_mask:0xf bank_mask:0xf
    s_lshr_b64 s[52:53], s[52:53], 1
    v_cndmask_b32_dpp v86, v86, v86, vcc wave_shr:1 row_mask:0xf bank_mask:0xf
    v_cndmask_b32_dpp v87, v87, v87, vcc wave_shr:1 row_mask:0xf bank_mask:0xf
    s_andn2_b64 s[82:83], s[82:83], s[52:53]
    v_cndmask_b32_dpp v7, v7, v7, vcc wave_shr:1 row_mask:0xf bank_mask:0xf
    s_mov_b64 exec, s[50:51]
    s_cbranch_scc0 L2_d117
    s_mov_b64 exec, s[82:83]
    s_nop 1
    v_mfma_f32_4x4x4_16b_bf16 v[88:91], v[12:13], v[84:85], 0
    s_nop 1
    v_mfma_f32_4x4x4_16b_bf16 v[88:91], v[10:11], v[86:87], v[88:91]
    s_nop 4
    v_cvt_pk_bf16_f32 v88, v88, v89
    v_cvt_pk_bf16_f32 v89, v90, v91
    ds_pk_add_bf16 v7, v88 offset:65408
    ds_pk_add_bf16 v7, v89 offset:65412
    s_mov_b64 exec, s[50:51]
    s_branch L2_d117
L2_xf115:
    s_cmp_gt_u32 s37, 1024
    s_cbranch_scc1 L2_xt115
    s_cmp_lt_u32 s37, 768
    s_cbranch_scc1 L2_xl115
    ds_read_b32 v33, v44 offset:896
    s_add_u32 s3, s42, 2
    s_bitset1_b32 s43, s3
    s_branch L2_xg115
L2_xl115:
    s_waitcnt lgkmcnt(0)
    v_mov_b32 v42, -1
    s_cmp_ge_u32 s37, 512
    s_cbranch_scc1 L2_xg115
    v_mov_b32 v43, -1
    s_cmp_ge_u32 s37, 256
    s_cbranch_scc1 L2_xg115
    v_mov_b32 v41, -1
    s_branch L2_xg115
L2_xt115:
    s_waitcnt lgkmcnt(0)
    v_mov_b32 v40, -1
    v_mov_b32 v41, -1
    v_mov_b32 v43, -1
    v_mov_b32 v42, -1
    s_add_u32 s3, s42, 2
    s_bitset1_b32 s36, s3
    s_branch L2_xg115
L2_oa118:
    v_and_b32 v47, 0x0fffffff, v32
    buffer_load_dword v114, v47, s[8:11], 0 offen offset:16
    s_mov_b64 exec, s[6:7]
    v_add_u32 v47, 8, v47
    v_lshrrev_b32 v32, 2, v32
    s_mov_b64 exec, -1
    buffer_load_dwordx2 v[112:113], v47, s[8:11], 0 offen
    s_branch L2_ob118
L2_c119:
    s_lshl_b64 s[52:53], s[82:83], 1
    s_andn2_b64 s[52:53], s[52:53], s[80:81]
    s_andn2_b64 s[52:53], s[52:53], s[54:55]
    s_or_b64 s[80:81], s[80:81], s[52:53]
    s_not_b64 vcc, s[52:53]
    s_mov_b64 exec, -1
    v_cndmask_b32_dpp v84, v84, v84, vcc wave_shr:1 row_mask:0xf bank_mask:0xf
    v_cndmask_b32_dpp v85, v85, v85, vcc wave_shr:1 row_mask:0xf bank_mask:0xf
    s_lshr_b64 s[52:53], s[52:53], 1
    v_cndmask_b32_dpp v86, v86, v86, vcc wave_shr:1 row_mask:0xf bank_mask:0xf
    v_cndmask_b32_dpp v87, v87, v87, vcc wave_shr:1 row_mask:0xf bank_mask:0xf
    s_andn2_b64 s[82:83], s[82:83], s[52:53]
    v_cndmask_b32_dpp v7, v7, v7, vcc wave_shr:1 row_mask:0xf bank_mask:0xf
    s_mov_b64 exec, s[54:55]
    s_cbranch_scc0 L2_d119
    s_mov_b64 exec, s[82:83]
    s_nop 1
    v_mfma_f32_4x4x4_16b_bf16 v[88:91], v[12:13], v[84:85], 0
    s_nop 1
    v_mfma_f32_4x4x4_16b_bf16 v[88:91], v[10:11], v[86:87], v[88:91]
    s_nop 4
    v_cvt_pk_bf16_f32 v88, v88, v89
    v_cvt_pk_bf16_f32 v89, v90, v91
    ds_pk_add_bf16 v7, v88 offset:65408
    ds_pk_add_bf16 v7, v89 offset:65412
    s_mov_b64 exec, s[54:55]
    s_branch L2_d119
L2_c120:
    s_lshl_b64 s[52:53], s[82:83], 1
    s_andn2_b64 s[52:53], s[52:53], s[80:81]
    s_andn2_b64 s[52:53], s[52:53], s[50:51]
    s_or_b64 s[80:81], s[80:81], s[52:53]
    s_not_b64 vcc, s[52:53]
    s_mov_b64 exec, -1
    v_cndmask_b32_dpp v84, v84, v84, vcc wave_shr:1 row_mask:0xf bank_mask:0xf
    v_cndmask_b32_dpp v85, v85, v85, vcc wave_shr:1 row_mask:0xf bank_mask:0xf
    s_lshr_b64 s[52:53], s[52:53], 1
    v_cndmask_b32_dpp v86, v86, v86, vcc wave_shr:1 row_mask:0xf bank_mask:0xf
    v_cndmask_b32_dpp v87, v87, v87, vcc wave_shr:1 row_mask:0xf bank_mask:0xf
    s_andn2_b64 s[82:83], s[82:83], s[52:53]
    v_cndmask_b32_dpp v7, v7, v7, vcc wave_shr:1 row_mask:0xf bank_mask:0xf
    s_mov_b64 exec, s[50:51]
    s_cbranch_scc0 L2_d120
    s_mov_b64 exec, s[82:83]
    s_nop 1
    v_mfma_f32_4x4x4_16b_bf16 v[88:91], v[12:13], v[84:85], 0
    s_nop 1
    v_mfma_f32_4x4x4_16b_bf16 v[88:91], v[10:11], v[86:87], v[88:91]
    s_nop 4
    v_cvt_pk_bf16_f32 v88, v88, v89
    v_cvt_pk_bf16_f32 v89, v90, v91
    ds_pk_add_bf16 v7, v88 offset:65408
    ds_pk_add_bf16 v7, v89 offset:65412
    s_mov_b64 exec, s[50:51]
    s_branch L2_d120
L2_c121:
    s_lshl_b64 s[52:53], s[82:83], 1
    s_andn2_b64 s[52:53], s[52:53], s[80:81]
    s_andn2_b64 s[52:53], s[52:53], s[54:55]
    s_or_b64 s[80:81], s[80:81], s[52:53]
    s_not_b64 vcc, s[52:53]
    s_mov_b64 exec, -1
    v_cndmask_b32_dpp v84, v84, v84, vcc wave_shr:1 row_mask:0xf bank_mask:0xf
    v_cndmask_b32_dpp v85, v85, v85, vcc wave_shr:1 row_mask:0xf bank_mask:0xf
    s_lshr_b64 s[52:53], s[52:53], 1
    v_cndmask_b32_dpp v86, v86, v86, vcc wave_shr:1 row_mask:0xf bank_mask:0xf
    v_cndmask_b32_dpp v87, v87, v87, vcc wave_shr:1 row_mask:0xf bank_mask:0xf
    s_andn2_b64 s[82:83], s[82:83], s[52:53]
    v_cndmask_b32_dpp v7, v7, v7, vcc wave_shr:1 row_mask:0xf bank_mask:0xf
    s_mov_b64 exec, s[54:55]
    s_cbranch_scc0 L2_d121
    s_mov_b64 exec, s[82:83]
    s_nop 1
    v_mfma_f32_4x4x4_16b_bf16 v[88:91], v[12:13], v[84:85], 0
    s_nop 1
    v_mfma_f32_4x4x4_16b_bf16 v[88:91], v[10:11], v[86:87], v[88:91]
    s_nop 4
    v_cvt_pk_bf16_f32 v88, v88, v89
    v_cvt_pk_bf16_f32 v89, v90, v91
    ds_pk_add_bf16 v7, v88 offset:65408
    ds_pk_add_bf16 v7, v89 offset:65412
    s_mov_b64 exec, s[54:55]
    s_branch L2_d121
L2_c122:
    s_lshl_b64 s[52:53], s[82:83], 1
    s_andn2_b64 s[52:53], s[52:53], s[80:81]
    s_andn2_b64 s[52:53], s[52:53], s[50:51]
    s_or_b64 s[80:81], s[80:81], s[52:53]
    s_not_b64 vcc, s[52:53]
    s_mov_b64 exec, -1
    v_cndmask_b32_dpp v84, v84, v84, vcc wave_shr:1 row_mask:0xf bank_mask:0xf
    v_cndmask_b32_dpp v85, v85, v85, vcc wave_shr:1 row_mask:0xf bank_mask:0xf
    s_lshr_b64 s[52:53], s[52:53], 1
    v_cndmask_b32_dpp v86, v86, v86, vcc wave_shr:1 row_mask:0xf bank_mask:0xf
    v_cndmask_b32_dpp v87, v87, v87, vcc wave_shr:1 row_mask:0xf bank_mask:0xf
    s_andn2_b64 s[82:83], s[82:83], s[52:53]
    v_cndmask_b32_dpp v7, v7, v7, vcc wave_shr:1 row_mask:0xf bank_mask:0xf
    s_mov_b64 exec, s[50:51]
    s_cbranch_scc0 L2_d122
    s_mov_b64 exec, s[82:83]
    s_nop 1
    v_mfma_f32_4x4x4_16b_bf16 v[88:91], v[12:13], v[84:85], 0
    s_nop 1
    v_mfma_f32_4x4x4_16b_bf16 v[88:91], v[10:11], v[86:87], v[88:91]
    s_nop 4
    v_cvt_pk_bf16_f32 v88, v88, v89
    v_cvt_pk_bf16_f32 v89, v90, v91
    ds_pk_add_bf16 v7, v88 offset:65408
    ds_pk_add_bf16 v7, v89 offset:65412
    s_mov_b64 exec, s[50:51]
    s_branch L2_d122
L2_c123:
    s_lshl_b64 s[52:53], s[82:83], 1
    s_andn2_b64 s[52:53], s[52:53], s[80:81]
    s_andn2_b64 s[52:53], s[52:53], s[54:55]
    s_or_b64 s[80:81], s[80:81], s[52:53]
    s_not_b64 vcc, s[52:53]
    s_mov_b64 exec, -1
    v_cndmask_b32_dpp v84, v84, v84, vcc wave_shr:1 row_mask:0xf bank_mask:0xf
    v_cndmask_b32_dpp v85, v85, v85, vcc wave_shr:1 row_mask:0xf bank_mask:0xf
    s_lshr_b64 s[52:53], s[52:53], 1
    v_cndmask_b32_dpp v86, v86, v86, vcc wave_shr:1 row_mask:0xf bank_mask:0xf
    v_cndmask_b32_dpp v87, v87, v87, vcc wave_shr:1 row_mask:0xf bank_mask:0xf
    s_andn2_b64 s[82:83], s[82:83], s[52:53]
    v_cndmask_b32_dpp v7, v7, v7, vcc wave_shr:1 row_mask:0xf bank_mask:0xf
    s_mov_b64 exec, s[54:55]
    s_cbranch_scc0 L2_d123
    s_mov_b64 exec, s[82:83]
    s_nop 1
    v_mfma_f32_4x4x4_16b_bf16 v[88:91], v[12:13], v[84:85], 0
    s_nop 1
    v_mfma_f32_4x4x4_16b_bf16 v[88:91], v[10:11], v[86:87], v[88:91]
    s_nop 4
    v_cvt_pk_bf16_f32 v88, v88, v89
    v_cvt_pk_bf16_f32 v89, v90, v91
    ds_pk_add_bf16 v7, v88 offset:65408
    ds_pk_add_bf16 v7, v89 offset:65412
    s_mov_b64 exec, s[54:55]
    s_branch L2_d123
L2_c124:
    s_lshl_b64 s[52:53], s[82:83], 1
    s_andn2_b64 s[52:53], s[52:53], s[80:81]
    s_andn2_b64 s[52:53], s[52:53], s[50:51]
    s_or_b64 s[80:81], s[80:81], s[52:53]
    s_not_b64 vcc, s[52:53]
    s_mov_b64 exec, -1
    v_cndmask_b32_dpp v84, v84, v84, vcc wave_shr:1 row_mask:0xf bank_mask:0xf
    v_cndmask_b32_dpp v85, v85, v85, vcc wave_shr:1 row_mask:0xf bank_mask:0xf
    s_lshr_b64 s[52:53], s[52:53], 1
    v_cndmask_b32_dpp v86, v86, v86, vcc wave_shr:1 row_mask:0xf bank_mask:0xf
    v_cndmask_b32_dpp v87, v87, v87, vcc wave_shr:1 row_mask:0xf bank_mask:0xf
    s_andn2_b64 s[82:83], s[82:83], s[52:53]
    v_cndmask_b32_dpp v7, v7, v7, vcc wave_shr:1 row_mask:0xf bank_mask:0xf
    s_mov_b64 exec, s[50:51]
    s_cbranch_scc0 L2_d124
    s_mov_b64 exec, s[82:83]
    s_nop 1
    v_mfma_f32_4x4x4_16b_bf16 v[88:91], v[12:13], v[84:85], 0
    s_nop 1
    v_mfma_f32_4x4x4_16b_bf16 v[88:91], v[10:11], v[86:87], v[88:91]
    s_nop 4
    v_cvt_pk_bf16_f32 v88, v88, v89
    v_cvt_pk_bf16_f32 v89, v90, v91
    ds_pk_add_bf16 v7, v88 offset:65408
    ds_pk_add_bf16 v7, v89 offset:65412
    s_mov_b64 exec, s[50:51]
    s_branch L2_d124
L2_oa125:
    s_waitcnt vmcnt(3)
    s_mov_b64 exec, s[6:7]
    v_lshrrev_b32 v114, 16, v114
    s_mov_b64 exec, -1
    v_and_b32 v46, 0x10000000, v32
    v_cmpx_eq_u32 vcc, 0, v46
    v_lshrrev_b32 v47, 14, v112
    v_and_b32 v47, v5, v47
    ds_read_b64 v[96:97], v47
    v_perm_b32 v98, v112, v114, s44
    v_bitop3_b32 v99, v112, 0.5, -0.5 bitop3:0xa8
    v_bitop3_b32 v98, v6, v98, v99 bitop3:0xca
    v_and_b32 v47, v5, v112
    s_waitcnt lgkmcnt(0)
    v_mfma_f32_4x4x4_16b_bf16 v[88:91], v[8:9], v[96:97], 0
    s_nop 4
    v_mul_f32 v88, v98, v88
    v_mul_f32 v89, v98, v89
    v_mul_f32 v90, v98, v90
    v_mul_f32 v91, v98, v91
    v_cvt_pk_bf16_f32 v88, v88, v89
    v_cvt_pk_bf16_f32 v89, v90, v91
    ds_pk_add_bf16 v47, v88 offset:65408
    ds_pk_add_bf16 v47, v89 offset:65412
    s_mov_b64 exec, -1
    v_and_b32 v46, 0x20000000, v32
    v_cmpx_eq_u32 vcc, 0, v46
    v_lshrrev_b32 v47, 14, v113
    v_and_b32 v47, v5, v47
    ds_read_b64 v[96:97], v47
    v_perm_b32 v98, v113, v114, s45
    v_bitop3_b32 v99, v113, 0.5, -0.5 bitop3:0xa8
    v_bitop3_b32 v98, v6, v98, v99 bitop3:0xca
    v_and_b32 v47, v5, v113
    s_waitcnt lgkmcnt(0)
    v_mfma_f32_4x4x4_16b_bf16 v[88:91], v[8:9], v[96:97], 0
    s_nop 4
    v_mul_f32 v88, v98, v88
    v_mul_f32 v89, v98, v89
    v_mul_f32 v90, v98, v90
    v_mul_f32 v91, v98, v91
    v_cvt_pk_bf16_f32 v88, v88, v89
    v_cvt_pk_bf16_f32 v89, v90, v91
    ds_pk_add_bf16 v47, v88 offset:65408
    ds_pk_add_bf16 v47, v89 offset:65412
    s_mov_b64 exec, -1
    s_branch L2_ob125
L2_c126:
    s_lshl_b64 s[52:53], s[82:83], 1
    s_andn2_b64 s[52:53], s[52:53], s[80:81]
    s_andn2_b64 s[52:53], s[52:53], s[54:55]
    s_or_b64 s[80:81], s[80:81], s[52:53]
    s_not_b64 vcc, s[52:53]
    s_mov_b64 exec, -1
    v_cndmask_b32_dpp v84, v84, v84, vcc wave_shr:1 row_mask:0xf bank_mask:0xf
    v_cndmask_b32_dpp v85, v85, v85, vcc wave_shr:1 row_mask:0xf bank_mask:0xf
    s_lshr_b64 s[52:53], s[52:53], 1
    v_cndmask_b32_dpp v86, v86, v86, vcc wave_shr:1 row_mask:0xf bank_mask:0xf
    v_cndmask_b32_dpp v87, v87, v87, vcc wave_shr:1 row_mask:0xf bank_mask:0xf
    s_andn2_b64 s[82:83], s[82:83], s[52:53]
    v_cndmask_b32_dpp v7, v7, v7, vcc wave_shr:1 row_mask:0xf bank_mask:0xf
    s_mov_b64 exec, s[54:55]
    s_cbranch_scc0 L2_d126
    s_mov_b64 exec, s[82:83]
    s_nop 1
    v_mfma_f32_4x4x4_16b_bf16 v[88:91], v[12:13], v[84:85], 0
    s_nop 1
    v_mfma_f32_4x4x4_16b_bf16 v[88:91], v[10:11], v[86:87], v[88:91]
    s_nop 4
    v_cvt_pk_bf16_f32 v88, v88, v89
    v_cvt_pk_bf16_f32 v89, v90, v91
    ds_pk_add_bf16 v7, v88 offset:65408
    ds_pk_add_bf16 v7, v89 offset:65412
    s_mov_b64 exec, s[54:55]
    s_branch L2_d126
L2_c127:
    s_lshl_b64 s[52:53], s[82:83], 1
    s_andn2_b64 s[52:53], s[52:53], s[80:81]
    s_andn2_b64 s[52:53], s[52:53], s[50:51]
    s_or_b64 s[80:81], s[80:81], s[52:53]
    s_not_b64 vcc, s[52:53]
    s_mov_b64 exec, -1
    v_cndmask_b32_dpp v84, v84, v84, vcc wave_shr:1 row_mask:0xf bank_mask:0xf
    v_cndmask_b32_dpp v85, v85, v85, vcc wave_shr:1 row_mask:0xf bank_mask:0xf
    s_lshr_b64 s[52:53], s[52:53], 1
    v_cndmask_b32_dpp v86, v86, v86, vcc wave_shr:1 row_mask:0xf bank_mask:0xf
    v_cndmask_b32_dpp v87, v87, v87, vcc wave_shr:1 row_mask:0xf bank_mask:0xf
    s_andn2_b64 s[82:83], s[82:83], s[52:53]
    v_cndmask_b32_dpp v7, v7, v7, vcc wave_shr:1 row_mask:0xf bank_mask:0xf
    s_mov_b64 exec, s[50:51]
    s_cbranch_scc0 L2_d127
    s_mov_b64 exec, s[82:83]
    s_nop 1
    v_mfma_f32_4x4x4_16b_bf16 v[88:91], v[12:13], v[84:85], 0
    s_nop 1
    v_mfma_f32_4x4x4_16b_bf16 v[88:91], v[10:11], v[86:87], v[88:91]
    s_nop 4
    v_cvt_pk_bf16_f32 v88, v88, v89
    v_cvt_pk_bf16_f32 v89, v90, v91
    ds_pk_add_bf16 v7, v88 offset:65408
    ds_pk_add_bf16 v7, v89 offset:65412
    s_mov_b64 exec, s[50:51]
    s_branch L2_d127
L2_c128:
    s_lshl_b64 s[52:53], s[82:83], 1
    s_andn2_b64 s[52:53], s[52:53], s[80:81]
    s_andn2_b64 s[52:53], s[52:53], s[54:55]
    s_or_b64 s[80:81], s[80:81], s[52:53]
    s_not_b64 vcc, s[52:53]
    s_mov_b64 exec, -1
    v_cndmask_b32_dpp v84, v84, v84, vcc wave_shr:1 row_mask:0xf bank_mask:0xf
    v_cndmask_b32_dpp v85, v85, v85, vcc wave_shr:1 row_mask:0xf bank_mask:0xf
    s_lshr_b64 s[52:53], s[52:53], 1
    v_cndmask_b32_dpp v86, v86, v86, vcc wave_shr:1 row_mask:0xf bank_mask:0xf
    v_cndmask_b32_dpp v87, v87, v87, vcc wave_shr:1 row_mask:0xf bank_mask:0xf
    s_andn2_b64 s[82:83], s[82:83], s[52:53]
    v_cndmask_b32_dpp v7, v7, v7, vcc wave_shr:1 row_mask:0xf bank_mask:0xf
    s_mov_b64 exec, s[54:55]
    s_cbranch_scc0 L2_d128
    s_mov_b64 exec, s[82:83]
    s_nop 1
    v_mfma_f32_4x4x4_16b_bf16 v[88:91], v[12:13], v[84:85], 0
    s_nop 1
    v_mfma_f32_4x4x4_16b_bf16 v[88:91], v[10:11], v[86:87], v[88:91]
    s_nop 4
    v_cvt_pk_bf16_f32 v88, v88, v89
    v_cvt_pk_bf16_f32 v89, v90, v91
    ds_pk_add_bf16 v7, v88 offset:65408
    ds_pk_add_bf16 v7, v89 offset:65412
    s_mov_b64 exec, s[54:55]
    s_branch L2_d128
L2_c129:
    s_lshl_b64 s[52:53], s[82:83], 1
    s_andn2_b64 s[52:53], s[52:53], s[80:81]
    s_andn2_b64 s[52:53], s[52:53], s[50:51]
    s_or_b64 s[80:81], s[80:81], s[52:53]
    s_not_b64 vcc, s[52:53]
    s_mov_b64 exec, -1
    v_cndmask_b32_dpp v84, v84, v84, vcc wave_shr:1 row_mask:0xf bank_mask:0xf
    v_cndmask_b32_dpp v85, v85, v85, vcc wave_shr:1 row_mask:0xf bank_mask:0xf
    s_lshr_b64 s[52:53], s[52:53], 1
    v_cndmask_b32_dpp v86, v86, v86, vcc wave_shr:1 row_mask:0xf bank_mask:0xf
    v_cndmask_b32_dpp v87, v87, v87, vcc wave_shr:1 row_mask:0xf bank_mask:0xf
    s_andn2_b64 s[82:83], s[82:83], s[52:53]
    v_cndmask_b32_dpp v7, v7, v7, vcc wave_shr:1 row_mask:0xf bank_mask:0xf
    s_mov_b64 exec, s[50:51]
    s_cbranch_scc0 L2_d129
    s_mov_b64 exec, s[82:83]
    s_nop 1
    v_mfma_f32_4x4x4_16b_bf16 v[88:91], v[12:13], v[84:85], 0
    s_nop 1
    v_mfma_f32_4x4x4_16b_bf16 v[88:91], v[10:11], v[86:87], v[88:91]
    s_nop 4
    v_cvt_pk_bf16_f32 v88, v88, v89
    v_cvt_pk_bf16_f32 v89, v90, v91
    ds_pk_add_bf16 v7, v88 offset:65408
    ds_pk_add_bf16 v7, v89 offset:65412
    s_mov_b64 exec, s[50:51]
    s_branch L2_d129
L2_c130:
    s_lshl_b64 s[52:53], s[82:83], 1
    s_andn2_b64 s[52:53], s[52:53], s[80:81]
    s_andn2_b64 s[52:53], s[52:53], s[54:55]
    s_or_b64 s[80:81], s[80:81], s[52:53]
    s_not_b64 vcc, s[52:53]
    s_mov_b64 exec, -1
    v_cndmask_b32_dpp v84, v84, v84, vcc wave_shr:1 row_mask:0xf bank_mask:0xf
    v_cndmask_b32_dpp v85, v85, v85, vcc wave_shr:1 row_mask:0xf bank_mask:0xf
    s_lshr_b64 s[52:53], s[52:53], 1
    v_cndmask_b32_dpp v86, v86, v86, vcc wave_shr:1 row_mask:0xf bank_mask:0xf
    v_cndmask_b32_dpp v87, v87, v87, vcc wave_shr:1 row_mask:0xf bank_mask:0xf
    s_andn2_b64 s[82:83], s[82:83], s[52:53]
    v_cndmask_b32_dpp v7, v7, v7, vcc wave_shr:1 row_mask:0xf bank_mask:0xf
    s_mov_b64 exec, s[54:55]
    s_cbranch_scc0 L2_d130
    s_mov_b64 exec, s[82:83]
    s_nop 1
    v_mfma_f32_4x4x4_16b_bf16 v[88:91], v[12:13], v[84:85], 0
    s_nop 1
    v_mfma_f32_4x4x4_16b_bf16 v[88:91], v[10:11], v[86:87], v[88:91]
    s_nop 4
    v_cvt_pk_bf16_f32 v88, v88, v89
    v_cvt_pk_bf16_f32 v89, v90, v91
    ds_pk_add_bf16 v7, v88 offset:65408
    ds_pk_add_bf16 v7, v89 offset:65412
    s_mov_b64 exec, s[54:55]
    s_branch L2_d130
L2_c131:
    s_lshl_b64 s[52:53], s[82:83], 1
    s_andn2_b64 s[52:53], s[52:53], s[80:81]
    s_andn2_b64 s[52:53], s[52:53], s[50:51]
    s_or_b64 s[80:81], s[80:81], s[52:53]
    s_not_b64 vcc, s[52:53]
    s_mov_b64 exec, -1
    v_cndmask_b32_dpp v84, v84, v84, vcc wave_shr:1 row_mask:0xf bank_mask:0xf
    v_cndmask_b32_dpp v85, v85, v85, vcc wave_shr:1 row_mask:0xf bank_mask:0xf
    s_lshr_b64 s[52:53], s[52:53], 1
    v_cndmask_b32_dpp v86, v86, v86, vcc wave_shr:1 row_mask:0xf bank_mask:0xf
    v_cndmask_b32_dpp v87, v87, v87, vcc wave_shr:1 row_mask:0xf bank_mask:0xf
    s_andn2_b64 s[82:83], s[82:83], s[52:53]
    v_cndmask_b32_dpp v7, v7, v7, vcc wave_shr:1 row_mask:0xf bank_mask:0xf
    s_mov_b64 exec, s[50:51]
    s_cbranch_scc0 L2_d131
    s_mov_b64 exec, s[82:83]
    s_nop 1
    v_mfma_f32_4x4x4_16b_bf16 v[88:91], v[12:13], v[84:85], 0
    s_nop 1
    v_mfma_f32_4x4x4_16b_bf16 v[88:91], v[10:11], v[86:87], v[88:91]
    s_nop 4
    v_cvt_pk_bf16_f32 v88, v88, v89
    v_cvt_pk_bf16_f32 v89, v90, v91
    ds_pk_add_bf16 v7, v88 offset:65408
    ds_pk_add_bf16 v7, v89 offset:65412
    s_mov_b64 exec, s[50:51]
    s_branch L2_d131
L2_c132:
    s_lshl_b64 s[52:53], s[82:83], 1
    s_andn2_b64 s[52:53], s[52:53], s[80:81]
    s_andn2_b64 s[52:53], s[52:53], s[54:55]
    s_or_b64 s[80:81], s[80:81], s[52:53]
    s_not_b64 vcc, s[52:53]
    s_mov_b64 exec, -1
    v_cndmask_b32_dpp v84, v84, v84, vcc wave_shr:1 row_mask:0xf bank_mask:0xf
    v_cndmask_b32_dpp v85, v85, v85, vcc wave_shr:1 row_mask:0xf bank_mask:0xf
    s_lshr_b64 s[52:53], s[52:53], 1
    v_cndmask_b32_dpp v86, v86, v86, vcc wave_shr:1 row_mask:0xf bank_mask:0xf
    v_cndmask_b32_dpp v87, v87, v87, vcc wave_shr:1 row_mask:0xf bank_mask:0xf
    s_andn2_b64 s[82:83], s[82:83], s[52:53]
    v_cndmask_b32_dpp v7, v7, v7, vcc wave_shr:1 row_mask:0xf bank_mask:0xf
    s_mov_b64 exec, s[54:55]
    s_cbranch_scc0 L2_d132
    s_mov_b64 exec, s[82:83]
    s_nop 1
    v_mfma_f32_4x4x4_16b_bf16 v[88:91], v[12:13], v[84:85], 0
    s_nop 1
    v_mfma_f32_4x4x4_16b_bf16 v[88:91], v[10:11], v[86:87], v[88:91]
    s_nop 4
    v_cvt_pk_bf16_f32 v88, v88, v89
    v_cvt_pk_bf16_f32 v89, v90, v91
    ds_pk_add_bf16 v7, v88 offset:65408
    ds_pk_add_bf16 v7, v89 offset:65412
    s_mov_b64 exec, s[54:55]
    s_branch L2_d132
L2_c133:
    s_lshl_b64 s[52:53], s[82:83], 1
    s_andn2_b64 s[52:53], s[52:53], s[80:81]
    s_andn2_b64 s[52:53], s[52:53], s[50:51]
    s_or_b64 s[80:81], s[80:81], s[52:53]
    s_not_b64 vcc, s[52:53]
    s_mov_b64 exec, -1
    v_cndmask_b32_dpp v84, v84, v84, vcc wave_shr:1 row_mask:0xf bank_mask:0xf
    v_cndmask_b32_dpp v85, v85, v85, vcc wave_shr:1 row_mask:0xf bank_mask:0xf
    s_lshr_b64 s[52:53], s[52:53], 1
    v_cndmask_b32_dpp v86, v86, v86, vcc wave_shr:1 row_mask:0xf bank_mask:0xf
    v_cndmask_b32_dpp v87, v87, v87, vcc wave_shr:1 row_mask:0xf bank_mask:0xf
    s_andn2_b64 s[82:83], s[82:83], s[52:53]
    v_cndmask_b32_dpp v7, v7, v7, vcc wave_shr:1 row_mask:0xf bank_mask:0xf
    s_mov_b64 exec, s[50:51]
    s_cbranch_scc0 L2_d133
    s_mov_b64 exec, s[82:83]
    s_nop 1
    v_mfma_f32_4x4x4_16b_bf16 v[88:91], v[12:13], v[84:85], 0
    s_nop 1
    v_mfma_f32_4x4x4_16b_bf16 v[88:91], v[10:11], v[86:87], v[88:91]
    s_nop 4
    v_cvt_pk_bf16_f32 v88, v88, v89
    v_cvt_pk_bf16_f32 v89, v90, v91
    ds_pk_add_bf16 v7, v88 offset:65408
    ds_pk_add_bf16 v7, v89 offset:65412
    s_mov_b64 exec, s[50:51]
    s_branch L2_d133
L2_oa134:
    v_and_b32 v47, 0x0fffffff, v33
    buffer_load_dword v114, v47, s[8:11], 0 offen offset:16
    s_mov_b64 exec, s[6:7]
    v_add_u32 v47, 8, v47
    v_lshrrev_b32 v33, 2, v33
    s_mov_b64 exec, -1
    buffer_load_dwordx2 v[112:113], v47, s[8:11], 0 offen
    s_branch L2_ob134
L2_c135:
    s_lshl_b64 s[52:53], s[82:83], 1
    s_andn2_b64 s[52:53], s[52:53], s[80:81]
    s_andn2_b64 s[52:53], s[52:53], s[54:55]
    s_or_b64 s[80:81], s[80:81], s[52:53]
    s_not_b64 vcc, s[52:53]
    s_mov_b64 exec, -1
    v_cndmask_b32_dpp v84, v84, v84, vcc wave_shr:1 row_mask:0xf bank_mask:0xf
    v_cndmask_b32_dpp v85, v85, v85, vcc wave_shr:1 row_mask:0xf bank_mask:0xf
    s_lshr_b64 s[52:53], s[52:53], 1
    v_cndmask_b32_dpp v86, v86, v86, vcc wave_shr:1 row_mask:0xf bank_mask:0xf
    v_cndmask_b32_dpp v87, v87, v87, vcc wave_shr:1 row_mask:0xf bank_mask:0xf
    s_andn2_b64 s[82:83], s[82:83], s[52:53]
    v_cndmask_b32_dpp v7, v7, v7, vcc wave_shr:1 row_mask:0xf bank_mask:0xf
    s_mov_b64 exec, s[54:55]
    s_cbranch_scc0 L2_d135
    s_mov_b64 exec, s[82:83]
    s_nop 1
    v_mfma_f32_4x4x4_16b_bf16 v[88:91], v[12:13], v[84:85], 0
    s_nop 1
    v_mfma_f32_4x4x4_16b_bf16 v[88:91], v[10:11], v[86:87], v[88:91]
    s_nop 4
    v_cvt_pk_bf16_f32 v88, v88, v89
    v_cvt_pk_bf16_f32 v89, v90, v91
    ds_pk_add_bf16 v7, v88 offset:65408
    ds_pk_add_bf16 v7, v89 offset:65412
    s_mov_b64 exec, s[54:55]
    s_branch L2_d135
L2_c136:
    s_lshl_b64 s[52:53], s[82:83], 1
    s_andn2_b64 s[52:53], s[52:53], s[80:81]
    s_andn2_b64 s[52:53], s[52:53], s[50:51]
    s_or_b64 s[80:81], s[80:81], s[52:53]
    s_not_b64 vcc, s[52:53]
    s_mov_b64 exec, -1
    v_cndmask_b32_dpp v84, v84, v84, vcc wave_shr:1 row_mask:0xf bank_mask:0xf
    v_cndmask_b32_dpp v85, v85, v85, vcc wave_shr:1 row_mask:0xf bank_mask:0xf
    s_lshr_b64 s[52:53], s[52:53], 1
    v_cndmask_b32_dpp v86, v86, v86, vcc wave_shr:1 row_mask:0xf bank_mask:0xf
    v_cndmask_b32_dpp v87, v87, v87, vcc wave_shr:1 row_mask:0xf bank_mask:0xf
    s_andn2_b64 s[82:83], s[82:83], s[52:53]
    v_cndmask_b32_dpp v7, v7, v7, vcc wave_shr:1 row_mask:0xf bank_mask:0xf
    s_mov_b64 exec, s[50:51]
    s_cbranch_scc0 L2_d136
    s_mov_b64 exec, s[82:83]
    s_nop 1
    v_mfma_f32_4x4x4_16b_bf16 v[88:91], v[12:13], v[84:85], 0
    s_nop 1
    v_mfma_f32_4x4x4_16b_bf16 v[88:91], v[10:11], v[86:87], v[88:91]
    s_nop 4
    v_cvt_pk_bf16_f32 v88, v88, v89
    v_cvt_pk_bf16_f32 v89, v90, v91
    ds_pk_add_bf16 v7, v88 offset:65408
    ds_pk_add_bf16 v7, v89 offset:65412
    s_mov_b64 exec, s[50:51]
    s_branch L2_d136
L2_c137:
    s_lshl_b64 s[52:53], s[82:83], 1
    s_andn2_b64 s[52:53], s[52:53], s[80:81]
    s_andn2_b64 s[52:53], s[52:53], s[54:55]
    s_or_b64 s[80:81], s[80:81], s[52:53]
    s_not_b64 vcc, s[52:53]
    s_mov_b64 exec, -1
    v_cndmask_b32_dpp v84, v84, v84, vcc wave_shr:1 row_mask:0xf bank_mask:0xf
    v_cndmask_b32_dpp v85, v85, v85, vcc wave_shr:1 row_mask:0xf bank_mask:0xf
    s_lshr_b64 s[52:53], s[52:53], 1
    v_cndmask_b32_dpp v86, v86, v86, vcc wave_shr:1 row_mask:0xf bank_mask:0xf
    v_cndmask_b32_dpp v87, v87, v87, vcc wave_shr:1 row_mask:0xf bank_mask:0xf
    s_andn2_b64 s[82:83], s[82:83], s[52:53]
    v_cndmask_b32_dpp v7, v7, v7, vcc wave_shr:1 row_mask:0xf bank_mask:0xf
    s_mov_b64 exec, s[54:55]
    s_cbranch_scc0 L2_d137
    s_mov_b64 exec, s[82:83]
    s_nop 1
    v_mfma_f32_4x4x4_16b_bf16 v[88:91], v[12:13], v[84:85], 0
    s_nop 1
    v_mfma_f32_4x4x4_16b_bf16 v[88:91], v[10:11], v[86:87], v[88:91]
    s_nop 4
    v_cvt_pk_bf16_f32 v88, v88, v89
    v_cvt_pk_bf16_f32 v89, v90, v91
    ds_pk_add_bf16 v7, v88 offset:65408
    ds_pk_add_bf16 v7, v89 offset:65412
    s_mov_b64 exec, s[54:55]
    s_branch L2_d137
L2_c138:
    s_lshl_b64 s[52:53], s[82:83], 1
    s_andn2_b64 s[52:53], s[52:53], s[80:81]
    s_andn2_b64 s[52:53], s[52:53], s[50:51]
    s_or_b64 s[80:81], s[80:81], s[52:53]
    s_not_b64 vcc, s[52:53]
    s_mov_b64 exec, -1
    v_cndmask_b32_dpp v84, v84, v84, vcc wave_shr:1 row_mask:0xf bank_mask:0xf
    v_cndmask_b32_dpp v85, v85, v85, vcc wave_shr:1 row_mask:0xf bank_mask:0xf
    s_lshr_b64 s[52:53], s[52:53], 1
    v_cndmask_b32_dpp v86, v86, v86, vcc wave_shr:1 row_mask:0xf bank_mask:0xf
    v_cndmask_b32_dpp v87, v87, v87, vcc wave_shr:1 row_mask:0xf bank_mask:0xf
    s_andn2_b64 s[82:83], s[82:83], s[52:53]
    v_cndmask_b32_dpp v7, v7, v7, vcc wave_shr:1 row_mask:0xf bank_mask:0xf
    s_mov_b64 exec, s[50:51]
    s_cbranch_scc0 L2_d138
    s_mov_b64 exec, s[82:83]
    s_nop 1
    v_mfma_f32_4x4x4_16b_bf16 v[88:91], v[12:13], v[84:85], 0
    s_nop 1
    v_mfma_f32_4x4x4_16b_bf16 v[88:91], v[10:11], v[86:87], v[88:91]
    s_nop 4
    v_cvt_pk_bf16_f32 v88, v88, v89
    v_cvt_pk_bf16_f32 v89, v90, v91
    ds_pk_add_bf16 v7, v88 offset:65408
    ds_pk_add_bf16 v7, v89 offset:65412
    s_mov_b64 exec, s[50:51]
    s_branch L2_d138
L2_c139:
    s_lshl_b64 s[52:53], s[82:83], 1
    s_andn2_b64 s[52:53], s[52:53], s[80:81]
    s_andn2_b64 s[52:53], s[52:53], s[54:55]
    s_or_b64 s[80:81], s[80:81], s[52:53]
    s_not_b64 vcc, s[52:53]
    s_mov_b64 exec, -1
    v_cndmask_b32_dpp v84, v84, v84, vcc wave_shr:1 row_mask:0xf bank_mask:0xf
    v_cndmask_b32_dpp v85, v85, v85, vcc wave_shr:1 row_mask:0xf bank_mask:0xf
    s_lshr_b64 s[52:53], s[52:53], 1
    v_cndmask_b32_dpp v86, v86, v86, vcc wave_shr:1 row_mask:0xf bank_mask:0xf
    v_cndmask_b32_dpp v87, v87, v87, vcc wave_shr:1 row_mask:0xf bank_mask:0xf
    s_andn2_b64 s[82:83], s[82:83], s[52:53]
    v_cndmask_b32_dpp v7, v7, v7, vcc wave_shr:1 row_mask:0xf bank_mask:0xf
    s_mov_b64 exec, s[54:55]
    s_cbranch_scc0 L2_d139
    s_mov_b64 exec, s[82:83]
    s_nop 1
    v_mfma_f32_4x4x4_16b_bf16 v[88:91], v[12:13], v[84:85], 0
    s_nop 1
    v_mfma_f32_4x4x4_16b_bf16 v[88:91], v[10:11], v[86:87], v[88:91]
    s_nop 4
    v_cvt_pk_bf16_f32 v88, v88, v89
    v_cvt_pk_bf16_f32 v89, v90, v91
    ds_pk_add_bf16 v7, v88 offset:65408
    ds_pk_add_bf16 v7, v89 offset:65412
    s_mov_b64 exec, s[54:55]
    s_branch L2_d139
L2_c140:
    s_lshl_b64 s[52:53], s[82:83], 1
    s_andn2_b64 s[52:53], s[52:53], s[80:81]
    s_andn2_b64 s[52:53], s[52:53], s[50:51]
    s_or_b64 s[80:81], s[80:81], s[52:53]
    s_not_b64 vcc, s[52:53]
    s_mov_b64 exec, -1
    v_cndmask_b32_dpp v84, v84, v84, vcc wave_shr:1 row_mask:0xf bank_mask:0xf
    v_cndmask_b32_dpp v85, v85, v85, vcc wave_shr:1 row_mask:0xf bank_mask:0xf
    s_lshr_b64 s[52:53], s[52:53], 1
    v_cndmask_b32_dpp v86, v86, v86, vcc wave_shr:1 row_mask:0xf bank_mask:0xf
    v_cndmask_b32_dpp v87, v87, v87, vcc wave_shr:1 row_mask:0xf bank_mask:0xf
    s_andn2_b64 s[82:83], s[82:83], s[52:53]
    v_cndmask_b32_dpp v7, v7, v7, vcc wave_shr:1 row_mask:0xf bank_mask:0xf
    s_mov_b64 exec, s[50:51]
    s_cbranch_scc0 L2_d140
    s_mov_b64 exec, s[82:83]
    s_nop 1
    v_mfma_f32_4x4x4_16b_bf16 v[88:91], v[12:13], v[84:85], 0
    s_nop 1
    v_mfma_f32_4x4x4_16b_bf16 v[88:91], v[10:11], v[86:87], v[88:91]
    s_nop 4
    v_cvt_pk_bf16_f32 v88, v88, v89
    v_cvt_pk_bf16_f32 v89, v90, v91
    ds_pk_add_bf16 v7, v88 offset:65408
    ds_pk_add_bf16 v7, v89 offset:65412
    s_mov_b64 exec, s[50:51]
    s_branch L2_d140
L2_oa141:
    s_waitcnt vmcnt(0)
    s_mov_b64 exec, s[6:7]
    v_lshrrev_b32 v114, 16, v114
    s_mov_b64 exec, -1
    v_and_b32 v46, 0x10000000, v33
    v_cmpx_eq_u32 vcc, 0, v46
    v_lshrrev_b32 v47, 14, v112
    v_and_b32 v47, v5, v47
    ds_read_b64 v[96:97], v47
    v_perm_b32 v98, v112, v114, s44
    v_bitop3_b32 v99, v112, 0.5, -0.5 bitop3:0xa8
    v_bitop3_b32 v98, v6, v98, v99 bitop3:0xca
    v_and_b32 v47, v5, v112
    s_waitcnt lgkmcnt(0)
    v_mfma_f32_4x4x4_16b_bf16 v[88:91], v[8:9], v[96:97], 0
    s_nop 4
    v_mul_f32 v88, v98, v88
    v_mul_f32 v89, v98, v89
    v_mul_f32 v90, v98, v90
    v_mul_f32 v91, v98, v91
    v_cvt_pk_bf16_f32 v88, v88, v89
    v_cvt_pk_bf16_f32 v89, v90, v91
    ds_pk_add_bf16 v47, v88 offset:65408
    ds_pk_add_bf16 v47, v89 offset:65412
    s_mov_b64 exec, -1
    v_and_b32 v46, 0x20000000, v33
    v_cmpx_eq_u32 vcc, 0, v46
    v_lshrrev_b32 v47, 14, v113
    v_and_b32 v47, v5, v47
    ds_read_b64 v[96:97], v47
    v_perm_b32 v98, v113, v114, s45
    v_bitop3_b32 v99, v113, 0.5, -0.5 bitop3:0xa8
    v_bitop3_b32 v98, v6, v98, v99 bitop3:0xca
    v_and_b32 v47, v5, v113
    s_waitcnt lgkmcnt(0)
    v_mfma_f32_4x4x4_16b_bf16 v[88:91], v[8:9], v[96:97], 0
    s_nop 4
    v_mul_f32 v88, v98, v88
    v_mul_f32 v89, v98, v89
    v_mul_f32 v90, v98, v90
    v_mul_f32 v91, v98, v91
    v_cvt_pk_bf16_f32 v88, v88, v89
    v_cvt_pk_bf16_f32 v89, v90, v91
    ds_pk_add_bf16 v47, v88 offset:65408
    ds_pk_add_bf16 v47, v89 offset:65412
    s_mov_b64 exec, -1
    s_branch L2_ob141
L2_c142:
    s_lshl_b64 s[52:53], s[82:83], 1
    s_andn2_b64 s[52:53], s[52:53], s[80:81]
    s_andn2_b64 s[52:53], s[52:53], s[54:55]
    s_or_b64 s[80:81], s[80:81], s[52:53]
    s_not_b64 vcc, s[52:53]
    s_mov_b64 exec, -1
    v_cndmask_b32_dpp v84, v84, v84, vcc wave_shr:1 row_mask:0xf bank_mask:0xf
    v_cndmask_b32_dpp v85, v85, v85, vcc wave_shr:1 row_mask:0xf bank_mask:0xf
    s_lshr_b64 s[52:53], s[52:53], 1
    v_cndmask_b32_dpp v86, v86, v86, vcc wave_shr:1 row_mask:0xf bank_mask:0xf
    v_cndmask_b32_dpp v87, v87, v87, vcc wave_shr:1 row_mask:0xf bank_mask:0xf
    s_andn2_b64 s[82:83], s[82:83], s[52:53]
    v_cndmask_b32_dpp v7, v7, v7, vcc wave_shr:1 row_mask:0xf bank_mask:0xf
    s_mov_b64 exec, s[54:55]
    s_cbranch_scc0 L2_d142
    s_mov_b64 exec, s[82:83]
    s_nop 1
    v_mfma_f32_4x4x4_16b_bf16 v[88:91], v[12:13], v[84:85], 0
    s_nop 1
    v_mfma_f32_4x4x4_16b_bf16 v[88:91], v[10:11], v[86:87], v[88:91]
    s_nop 4
    v_cvt_pk_bf16_f32 v88, v88, v89
    v_cvt_pk_bf16_f32 v89, v90, v91
    ds_pk_add_bf16 v7, v88 offset:65408
    ds_pk_add_bf16 v7, v89 offset:65412
    s_mov_b64 exec, s[54:55]
    s_branch L2_d142
L2_c143:
    s_lshl_b64 s[52:53], s[82:83], 1
    s_andn2_b64 s[52:53], s[52:53], s[80:81]
    s_andn2_b64 s[52:53], s[52:53], s[50:51]
    s_or_b64 s[80:81], s[80:81], s[52:53]
    s_not_b64 vcc, s[52:53]
    s_mov_b64 exec, -1
    v_cndmask_b32_dpp v84, v84, v84, vcc wave_shr:1 row_mask:0xf bank_mask:0xf
    v_cndmask_b32_dpp v85, v85, v85, vcc wave_shr:1 row_mask:0xf bank_mask:0xf
    s_lshr_b64 s[52:53], s[52:53], 1
    v_cndmask_b32_dpp v86, v86, v86, vcc wave_shr:1 row_mask:0xf bank_mask:0xf
    v_cndmask_b32_dpp v87, v87, v87, vcc wave_shr:1 row_mask:0xf bank_mask:0xf
    s_andn2_b64 s[82:83], s[82:83], s[52:53]
    v_cndmask_b32_dpp v7, v7, v7, vcc wave_shr:1 row_mask:0xf bank_mask:0xf
    s_mov_b64 exec, s[50:51]
    s_cbranch_scc0 L2_d143
    s_mov_b64 exec, s[82:83]
    s_nop 1
    v_mfma_f32_4x4x4_16b_bf16 v[88:91], v[12:13], v[84:85], 0
    s_nop 1
    v_mfma_f32_4x4x4_16b_bf16 v[88:91], v[10:11], v[86:87], v[88:91]
    s_nop 4
    v_cvt_pk_bf16_f32 v88, v88, v89
    v_cvt_pk_bf16_f32 v89, v90, v91
    ds_pk_add_bf16 v7, v88 offset:65408
    ds_pk_add_bf16 v7, v89 offset:65412
    s_mov_b64 exec, s[50:51]
    s_branch L2_d143
L2_c144:
    s_lshl_b64 s[52:53], s[82:83], 1
    s_andn2_b64 s[52:53], s[52:53], s[80:81]
    s_andn2_b64 s[52:53], s[52:53], s[54:55]
    s_or_b64 s[80:81], s[80:81], s[52:53]
    s_not_b64 vcc, s[52:53]
    s_mov_b64 exec, -1
    v_cndmask_b32_dpp v84, v84, v84, vcc wave_shr:1 row_mask:0xf bank_mask:0xf
    v_cndmask_b32_dpp v85, v85, v85, vcc wave_shr:1 row_mask:0xf bank_mask:0xf
    s_lshr_b64 s[52:53], s[52:53], 1
    v_cndmask_b32_dpp v86, v86, v86, vcc wave_shr:1 row_mask:0xf bank_mask:0xf
    v_cndmask_b32_dpp v87, v87, v87, vcc wave_shr:1 row_mask:0xf bank_mask:0xf
    s_andn2_b64 s[82:83], s[82:83], s[52:53]
    v_cndmask_b32_dpp v7, v7, v7, vcc wave_shr:1 row_mask:0xf bank_mask:0xf
    s_mov_b64 exec, s[54:55]
    s_cbranch_scc0 L2_d144
    s_mov_b64 exec, s[82:83]
    s_nop 1
    v_mfma_f32_4x4x4_16b_bf16 v[88:91], v[12:13], v[84:85], 0
    s_nop 1
    v_mfma_f32_4x4x4_16b_bf16 v[88:91], v[10:11], v[86:87], v[88:91]
    s_nop 4
    v_cvt_pk_bf16_f32 v88, v88, v89
    v_cvt_pk_bf16_f32 v89, v90, v91
    ds_pk_add_bf16 v7, v88 offset:65408
    ds_pk_add_bf16 v7, v89 offset:65412
    s_mov_b64 exec, s[54:55]
    s_branch L2_d144
L2_c145:
    s_lshl_b64 s[52:53], s[82:83], 1
    s_andn2_b64 s[52:53], s[52:53], s[80:81]
    s_andn2_b64 s[52:53], s[52:53], s[50:51]
    s_or_b64 s[80:81], s[80:81], s[52:53]
    s_not_b64 vcc, s[52:53]
    s_mov_b64 exec, -1
    v_cndmask_b32_dpp v84, v84, v84, vcc wave_shr:1 row_mask:0xf bank_mask:0xf
    v_cndmask_b32_dpp v85, v85, v85, vcc wave_shr:1 row_mask:0xf bank_mask:0xf
    s_lshr_b64 s[52:53], s[52:53], 1
    v_cndmask_b32_dpp v86, v86, v86, vcc wave_shr:1 row_mask:0xf bank_mask:0xf
    v_cndmask_b32_dpp v87, v87, v87, vcc wave_shr:1 row_mask:0xf bank_mask:0xf
    s_andn2_b64 s[82:83], s[82:83], s[52:53]
    v_cndmask_b32_dpp v7, v7, v7, vcc wave_shr:1 row_mask:0xf bank_mask:0xf
    s_mov_b64 exec, s[50:51]
    s_cbranch_scc0 L2_d145
    s_mov_b64 exec, s[82:83]
    s_nop 1
    v_mfma_f32_4x4x4_16b_bf16 v[88:91], v[12:13], v[84:85], 0
    s_nop 1
    v_mfma_f32_4x4x4_16b_bf16 v[88:91], v[10:11], v[86:87], v[88:91]
    s_nop 4
    v_cvt_pk_bf16_f32 v88, v88, v89
    v_cvt_pk_bf16_f32 v89, v90, v91
    ds_pk_add_bf16 v7, v88 offset:65408
    ds_pk_add_bf16 v7, v89 offset:65412
    s_mov_b64 exec, s[50:51]
    s_branch L2_d145
L2_c146:
    s_lshl_b64 s[52:53], s[82:83], 1
    s_andn2_b64 s[52:53], s[52:53], s[80:81]
    s_andn2_b64 s[52:53], s[52:53], s[54:55]
    s_or_b64 s[80:81], s[80:81], s[52:53]
    s_not_b64 vcc, s[52:53]
    s_mov_b64 exec, -1
    v_cndmask_b32_dpp v84, v84, v84, vcc wave_shr:1 row_mask:0xf bank_mask:0xf
    v_cndmask_b32_dpp v85, v85, v85, vcc wave_shr:1 row_mask:0xf bank_mask:0xf
    s_lshr_b64 s[52:53], s[52:53], 1
    v_cndmask_b32_dpp v86, v86, v86, vcc wave_shr:1 row_mask:0xf bank_mask:0xf
    v_cndmask_b32_dpp v87, v87, v87, vcc wave_shr:1 row_mask:0xf bank_mask:0xf
    s_andn2_b64 s[82:83], s[82:83], s[52:53]
    v_cndmask_b32_dpp v7, v7, v7, vcc wave_shr:1 row_mask:0xf bank_mask:0xf
    s_mov_b64 exec, s[54:55]
    s_cbranch_scc0 L2_d146
    s_mov_b64 exec, s[82:83]
    s_nop 1
    v_mfma_f32_4x4x4_16b_bf16 v[88:91], v[12:13], v[84:85], 0
    s_nop 1
    v_mfma_f32_4x4x4_16b_bf16 v[88:91], v[10:11], v[86:87], v[88:91]
    s_nop 4
    v_cvt_pk_bf16_f32 v88, v88, v89
    v_cvt_pk_bf16_f32 v89, v90, v91
    ds_pk_add_bf16 v7, v88 offset:65408
    ds_pk_add_bf16 v7, v89 offset:65412
    s_mov_b64 exec, s[54:55]
    s_branch L2_d146
L2_c147:
    s_lshl_b64 s[52:53], s[82:83], 1
    s_andn2_b64 s[52:53], s[52:53], s[80:81]
    s_andn2_b64 s[52:53], s[52:53], s[50:51]
    s_or_b64 s[80:81], s[80:81], s[52:53]
    s_not_b64 vcc, s[52:53]
    s_mov_b64 exec, -1
    v_cndmask_b32_dpp v84, v84, v84, vcc wave_shr:1 row_mask:0xf bank_mask:0xf
    v_cndmask_b32_dpp v85, v85, v85, vcc wave_shr:1 row_mask:0xf bank_mask:0xf
    s_lshr_b64 s[52:53], s[52:53], 1
    v_cndmask_b32_dpp v86, v86, v86, vcc wave_shr:1 row_mask:0xf bank_mask:0xf
    v_cndmask_b32_dpp v87, v87, v87, vcc wave_shr:1 row_mask:0xf bank_mask:0xf
    s_andn2_b64 s[82:83], s[82:83], s[52:53]
    v_cndmask_b32_dpp v7, v7, v7, vcc wave_shr:1 row_mask:0xf bank_mask:0xf
    s_mov_b64 exec, s[50:51]
    s_cbranch_scc0 L2_d147
    s_mov_b64 exec, s[82:83]
    s_nop 1
    v_mfma_f32_4x4x4_16b_bf16 v[88:91], v[12:13], v[84:85], 0
    s_nop 1
    v_mfma_f32_4x4x4_16b_bf16 v[88:91], v[10:11], v[86:87], v[88:91]
    s_nop 4
    v_cvt_pk_bf16_f32 v88, v88, v89
    v_cvt_pk_bf16_f32 v89, v90, v91
    ds_pk_add_bf16 v7, v88 offset:65408
    ds_pk_add_bf16 v7, v89 offset:65412
    s_mov_b64 exec, s[50:51]
    s_branch L2_d147
L2_c148:
    s_lshl_b64 s[52:53], s[82:83], 1
    s_andn2_b64 s[52:53], s[52:53], s[80:81]
    s_andn2_b64 s[52:53], s[52:53], s[54:55]
    s_or_b64 s[80:81], s[80:81], s[52:53]
    s_not_b64 vcc, s[52:53]
    s_mov_b64 exec, -1
    v_cndmask_b32_dpp v84, v84, v84, vcc wave_shr:1 row_mask:0xf bank_mask:0xf
    v_cndmask_b32_dpp v85, v85, v85, vcc wave_shr:1 row_mask:0xf bank_mask:0xf
    s_lshr_b64 s[52:53], s[52:53], 1
    v_cndmask_b32_dpp v86, v86, v86, vcc wave_shr:1 row_mask:0xf bank_mask:0xf
    v_cndmask_b32_dpp v87, v87, v87, vcc wave_shr:1 row_mask:0xf bank_mask:0xf
    s_andn2_b64 s[82:83], s[82:83], s[52:53]
    v_cndmask_b32_dpp v7, v7, v7, vcc wave_shr:1 row_mask:0xf bank_mask:0xf
    s_mov_b64 exec, s[54:55]
    s_cbranch_scc0 L2_d148
    s_mov_b64 exec, s[82:83]
    s_nop 1
    v_mfma_f32_4x4x4_16b_bf16 v[88:91], v[12:13], v[84:85], 0
    s_nop 1
    v_mfma_f32_4x4x4_16b_bf16 v[88:91], v[10:11], v[86:87], v[88:91]
    s_nop 4
    v_cvt_pk_bf16_f32 v88, v88, v89
    v_cvt_pk_bf16_f32 v89, v90, v91
    ds_pk_add_bf16 v7, v88 offset:65408
    ds_pk_add_bf16 v7, v89 offset:65412
    s_mov_b64 exec, s[54:55]
    s_branch L2_d148
L2_c149:
    s_lshl_b64 s[52:53], s[82:83], 1
    s_andn2_b64 s[52:53], s[52:53], s[80:81]
    s_andn2_b64 s[52:53], s[52:53], s[50:51]
    s_or_b64 s[80:81], s[80:81], s[52:53]
    s_not_b64 vcc, s[52:53]
    s_mov_b64 exec, -1
    v_cndmask_b32_dpp v84, v84, v84, vcc wave_shr:1 row_mask:0xf bank_mask:0xf
    v_cndmask_b32_dpp v85, v85, v85, vcc wave_shr:1 row_mask:0xf bank_mask:0xf
    s_lshr_b64 s[52:53], s[52:53], 1
    v_cndmask_b32_dpp v86, v86, v86, vcc wave_shr:1 row_mask:0xf bank_mask:0xf
    v_cndmask_b32_dpp v87, v87, v87, vcc wave_shr:1 row_mask:0xf bank_mask:0xf
    s_andn2_b64 s[82:83], s[82:83], s[52:53]
    v_cndmask_b32_dpp v7, v7, v7, vcc wave_shr:1 row_mask:0xf bank_mask:0xf
    s_mov_b64 exec, s[50:51]
    s_cbranch_scc0 L2_d149
    s_mov_b64 exec, s[82:83]
    s_nop 1
    v_mfma_f32_4x4x4_16b_bf16 v[88:91], v[12:13], v[84:85], 0
    s_nop 1
    v_mfma_f32_4x4x4_16b_bf16 v[88:91], v[10:11], v[86:87], v[88:91]
    s_nop 4
    v_cvt_pk_bf16_f32 v88, v88, v89
    v_cvt_pk_bf16_f32 v89, v90, v91
    ds_pk_add_bf16 v7, v88 offset:65408
    ds_pk_add_bf16 v7, v89 offset:65412
    s_mov_b64 exec, s[50:51]
    s_branch L2_d149
L2_c150:
    s_lshl_b64 s[52:53], s[82:83], 1
    s_andn2_b64 s[52:53], s[52:53], s[80:81]
    s_andn2_b64 s[52:53], s[52:53], s[54:55]
    s_or_b64 s[80:81], s[80:81], s[52:53]
    s_not_b64 vcc, s[52:53]
    s_mov_b64 exec, -1
    v_cndmask_b32_dpp v84, v84, v84, vcc wave_shr:1 row_mask:0xf bank_mask:0xf
    v_cndmask_b32_dpp v85, v85, v85, vcc wave_shr:1 row_mask:0xf bank_mask:0xf
    s_lshr_b64 s[52:53], s[52:53], 1
    v_cndmask_b32_dpp v86, v86, v86, vcc wave_shr:1 row_mask:0xf bank_mask:0xf
    v_cndmask_b32_dpp v87, v87, v87, vcc wave_shr:1 row_mask:0xf bank_mask:0xf
    s_andn2_b64 s[82:83], s[82:83], s[52:53]
    v_cndmask_b32_dpp v7, v7, v7, vcc wave_shr:1 row_mask:0xf bank_mask:0xf
    s_mov_b64 exec, s[54:55]
    s_cbranch_scc0 L2_d150
    s_mov_b64 exec, s[82:83]
    s_nop 1
    v_mfma_f32_4x4x4_16b_bf16 v[88:91], v[12:13], v[84:85], 0
    s_nop 1
    v_mfma_f32_4x4x4_16b_bf16 v[88:91], v[10:11], v[86:87], v[88:91]
    s_nop 4
    v_cvt_pk_bf16_f32 v88, v88, v89
    v_cvt_pk_bf16_f32 v89, v90, v91
    ds_pk_add_bf16 v7, v88 offset:65408
    ds_pk_add_bf16 v7, v89 offset:65412
    s_mov_b64 exec, s[54:55]
    s_branch L2_d150
L2_c151:
    s_lshl_b64 s[52:53], s[82:83], 1
    s_andn2_b64 s[52:53], s[52:53], s[80:81]
    s_andn2_b64 s[52:53], s[52:53], s[50:51]
    s_or_b64 s[80:81], s[80:81], s[52:53]
    s_not_b64 vcc, s[52:53]
    s_mov_b64 exec, -1
    v_cndmask_b32_dpp v84, v84, v84, vcc wave_shr:1 row_mask:0xf bank_mask:0xf
    v_cndmask_b32_dpp v85, v85, v85, vcc wave_shr:1 row_mask:0xf bank_mask:0xf
    s_lshr_b64 s[52:53], s[52:53], 1
    v_cndmask_b32_dpp v86, v86, v86, vcc wave_shr:1 row_mask:0xf bank_mask:0xf
    v_cndmask_b32_dpp v87, v87, v87, vcc wave_shr:1 row_mask:0xf bank_mask:0xf
    s_andn2_b64 s[82:83], s[82:83], s[52:53]
    v_cndmask_b32_dpp v7, v7, v7, vcc wave_shr:1 row_mask:0xf bank_mask:0xf
    s_mov_b64 exec, s[50:51]
    s_cbranch_scc0 L2_d151
    s_mov_b64 exec, s[82:83]
    s_nop 1
    v_mfma_f32_4x4x4_16b_bf16 v[88:91], v[12:13], v[84:85], 0
    s_nop 1
    v_mfma_f32_4x4x4_16b_bf16 v[88:91], v[10:11], v[86:87], v[88:91]
    s_nop 4
    v_cvt_pk_bf16_f32 v88, v88, v89
    v_cvt_pk_bf16_f32 v89, v90, v91
    ds_pk_add_bf16 v7, v88 offset:65408
    ds_pk_add_bf16 v7, v89 offset:65412
    s_mov_b64 exec, s[50:51]
    s_branch L2_d151
L2_c152:
    s_mov_b64 s[50:51], vcc
    s_lshl_b64 s[52:53], s[82:83], 1
    s_andn2_b64 s[52:53], s[52:53], s[80:81]
    s_andn2_b64 s[52:53], s[52:53], s[50:51]
    s_or_b64 s[80:81], s[80:81], s[52:53]
    s_not_b64 vcc, s[52:53]
    s_mov_b64 exec, -1
    v_cndmask_b32_dpp v84, v84, v84, vcc wave_shr:1 row_mask:0xf bank_mask:0xf
    v_cndmask_b32_dpp v85, v85, v85, vcc wave_shr:1 row_mask:0xf bank_mask:0xf
    s_lshr_b64 s[52:53], s[52:53], 1
    v_cndmask_b32_dpp v86, v86, v86, vcc wave_shr:1 row_mask:0xf bank_mask:0xf
    v_cndmask_b32_dpp v87, v87, v87, vcc wave_shr:1 row_mask:0xf bank_mask:0xf
    s_andn2_b64 s[82:83], s[82:83], s[52:53]
    v_cndmask_b32_dpp v7, v7, v7, vcc wave_shr:1 row_mask:0xf bank_mask:0xf
    s_mov_b64 vcc, s[50:51]
    s_mov_b64 exec, s[50:51]
    s_cbranch_scc0 L2_d152
    s_mov_b64 exec, s[82:83]
    s_nop 1
    v_mfma_f32_4x4x4_16b_bf16 v[88:91], v[12:13], v[84:85], 0
    s_nop 1
    v_mfma_f32_4x4x4_16b_bf16 v[88:91], v[10:11], v[86:87], v[88:91]
    s_nop 4
    v_cvt_pk_bf16_f32 v88, v88, v89
    v_cvt_pk_bf16_f32 v89, v90, v91
    ds_pk_add_bf16 v7, v88 offset:65408
    ds_pk_add_bf16 v7, v89 offset:65412
    s_mov_b64 exec, vcc
    s_branch L2_d152
L2_c153:
    s_mov_b64 s[50:51], vcc
    s_lshl_b64 s[52:53], s[82:83], 1
    s_andn2_b64 s[52:53], s[52:53], s[80:81]
    s_andn2_b64 s[52:53], s[52:53], s[50:51]
    s_or_b64 s[80:81], s[80:81], s[52:53]
    s_not_b64 vcc, s[52:53]
    s_mov_b64 exec, -1
    v_cndmask_b32_dpp v84, v84, v84, vcc wave_shr:1 row_mask:0xf bank_mask:0xf
    v_cndmask_b32_dpp v85, v85, v85, vcc wave_shr:1 row_mask:0xf bank_mask:0xf
    s_lshr_b64 s[52:53], s[52:53], 1
    v_cndmask_b32_dpp v86, v86, v86, vcc wave_shr:1 row_mask:0xf bank_mask:0xf
    v_cndmask_b32_dpp v87, v87, v87, vcc wave_shr:1 row_mask:0xf bank_mask:0xf
    s_andn2_b64 s[82:83], s[82:83], s[52:53]
    v_cndmask_b32_dpp v7, v7, v7, vcc wave_shr:1 row_mask:0xf bank_mask:0xf
    s_mov_b64 vcc, s[50:51]
    s_mov_b64 exec, s[50:51]
    s_cbranch_scc0 L2_d153
    s_mov_b64 exec, s[82:83]
    s_nop 1
    v_mfma_f32_4x4x4_16b_bf16 v[88:91], v[12:13], v[84:85], 0
    s_nop 1
    v_mfma_f32_4x4x4_16b_bf16 v[88:91], v[10:11], v[86:87], v[88:91]
    s_nop 4
    v_cvt_pk_bf16_f32 v88, v88, v89
    v_cvt_pk_bf16_f32 v89, v90, v91
    ds_pk_add_bf16 v7, v88 offset:65408
    ds_pk_add_bf16 v7, v89 offset:65412
    s_mov_b64 exec, vcc
    s_branch L2_d153
L2_f3s:
    s_branch L2_f3
.section .rodata,"a"
.p2align 6
.amdhsa_kernel gather_scatter__molecular_angular_gemnet__graph_kernel
  .amdhsa_next_free_vgpr 128
  .amdhsa_next_free_sgpr 102
  .amdhsa_accum_offset 128
  .amdhsa_group_segment_fixed_size 0
  .amdhsa_kernarg_size 112
  .amdhsa_user_sgpr_count 2
  .amdhsa_user_sgpr_kernarg_segment_ptr 1
  .amdhsa_system_sgpr_workgroup_id_x 1
  .amdhsa_float_denorm_mode_32 3
.end_amdhsa_kernel
```

```asm
; @launch grid=(256,1,1) block=(1024,1,1) lds=163840
.amdgcn_target "amdgcn-amd-amdhsa--gfx950"
.text
.globl gather_scatter__molecular_angular_gemnet__graph_kernel
.p2align 8
.type gather_scatter__molecular_angular_gemnet__graph_kernel,@function
gather_scatter__molecular_angular_gemnet__graph_kernel:
    s_cmp_ge_u32 s2, 256
    s_cbranch_scc0 L1_go
    s_endpgm
L1_go:
    s_load_dwordx4 s[4:7], s[0:1], 8
    s_load_dwordx2 s[28:29], s[0:1], 32
    s_load_dwordx2 s[30:31], s[0:1], 104
    s_load_dwordx2 s[56:57], s[0:1], 96
    s_load_dwordx2 s[86:87], s[0:1], 0
    s_load_dwordx4 s[60:63], s[0:1], 56
    s_load_dwordx4 s[64:67], s[0:1], 72
    v_lshrrev_b32 v7, 6, v0
    v_lshlrev_b32 v1, 3, v0
    v_readfirstlane_b32 s32, v7
    v_lshlrev_b32 v0, 4, v0
    v_and_b32 v1, 0x1f8, v1
    v_lshlrev_b32 v15, 1, v1
    s_lshr_b32 s3, s32, 1
    s_and_b32 s44, s32, 1
    s_lshl_b32 s44, s44, 3
    s_or_b32 s3, s3, s44
    s_lshl_b32 s3, s3, 10
    s_lshl_b32 s96, s2, 14
    s_add_u32 s96, s96, s3
    s_lshr_b32 s3, s32, 1
    s_and_b32 s44, s32, 1
    s_lshl_b32 s44, s44, 3
    s_or_b32 s3, s3, s44
    s_lshl_b32 s3, s3, 10
    s_lshl_b32 s97, s2, 14
    s_add_u32 s97, s97, s3
    s_lshr_b32 s3, s32, 1
    s_and_b32 s44, s32, 1
    s_lshl_b32 s44, s44, 3
    s_or_b32 s3, s3, s44
    s_lshl_b32 s3, s3, 10
    s_lshl_b32 s98, s2, 14
    s_add_u32 s98, s98, s3
    s_lshr_b32 s3, s32, 1
    s_and_b32 s44, s32, 1
    s_lshl_b32 s44, s44, 3
    s_or_b32 s3, s3, s44
    s_lshl_b32 s3, s3, 10
    s_lshl_b32 s99, s2, 14
    s_add_u32 s99, s99, s3
    s_waitcnt lgkmcnt(0)
    s_mov_b32 s8, s4
    s_mov_b32 s9, s5
    s_mov_b32 s10, 0x9c40000
    s_mov_b32 s11, 0x20000
    s_mov_b32 s12, s6
    s_mov_b32 s13, s7
    s_mov_b32 s14, 0x9c40000
    s_mov_b32 s15, 0x20000
    s_mov_b32 s16, s28
    s_mov_b32 s17, s29
    s_mov_b32 s18, 0x4e20000
    s_mov_b32 s19, 0x20000
    s_mov_b32 s68, s62
    s_mov_b32 s69, s63
    s_mov_b32 s70, 0x40
    s_mov_b32 s71, 0x20000
    s_mov_b32 s72, s60
    s_mov_b32 s73, s61
    s_mov_b32 s74, 0x40
    s_mov_b32 s75, 0x20000
    s_mov_b32 s20, s66
    s_mov_b32 s21, s67
    s_mov_b32 s22, 0x20
    s_mov_b32 s23, 0x20000
    s_mov_b32 s80, s64
    s_mov_b32 s81, s65
    s_mov_b32 s82, 0x20
    s_mov_b32 s83, 0x20000
    s_add_u32 s24, s30, 0xec54000
    s_addc_u32 s25, s31, 0
    s_mov_b32 s26, 0x100
    s_mov_b32 s27, 0x20000
    v_lshrrev_b32 v2, 3, v0
    v_and_b32 v2, 6, v2
    v_lshlrev_b32 v3, 2, v0
    s_lshl_b32 s3, s32, 8
    s_add_u32 s3, s3, s2
    s_cmp_lg_u32 s3, 254
    s_cbranch_scc1 L1_wt
    buffer_load_ushort v96, v2, s[68:71], 0 offen offset:0
    buffer_load_ushort v108, v2, s[68:71], 0 offen offset:8
    buffer_load_ushort v97, v2, s[68:71], 0 offen offset:16
    buffer_load_ushort v109, v2, s[68:71], 0 offen offset:24
    buffer_load_ushort v98, v2, s[68:71], 0 offen offset:32
    buffer_load_ushort v110, v2, s[68:71], 0 offen offset:40
    buffer_load_ushort v99, v2, s[68:71], 0 offen offset:48
    buffer_load_ushort v111, v2, s[68:71], 0 offen offset:56
    buffer_load_ushort v100, v2, s[72:75], 0 offen offset:0
    buffer_load_ushort v112, v2, s[72:75], 0 offen offset:8
    buffer_load_ushort v101, v2, s[72:75], 0 offen offset:16
    buffer_load_ushort v113, v2, s[72:75], 0 offen offset:24
    buffer_load_ushort v102, v2, s[72:75], 0 offen offset:32
    buffer_load_ushort v114, v2, s[72:75], 0 offen offset:40
    buffer_load_ushort v103, v2, s[72:75], 0 offen offset:48
    buffer_load_ushort v115, v2, s[72:75], 0 offen offset:56
    buffer_load_ushort v104, v2, s[20:23], 0 offen offset:0
    buffer_load_ushort v116, v2, s[20:23], 0 offen offset:8
    buffer_load_ushort v105, v2, s[20:23], 0 offen offset:16
    buffer_load_ushort v117, v2, s[20:23], 0 offen offset:24
    buffer_load_ushort v106, v2, s[80:83], 0 offen offset:0
    buffer_load_ushort v118, v2, s[80:83], 0 offen offset:8
    buffer_load_ushort v107, v2, s[80:83], 0 offen offset:16
    buffer_load_ushort v119, v2, s[80:83], 0 offen offset:24
    s_waitcnt vmcnt(0)
    v_lshl_or_b32 v96, v108, 16, v96
    v_lshl_or_b32 v97, v109, 16, v97
    v_lshl_or_b32 v98, v110, 16, v98
    v_lshl_or_b32 v99, v111, 16, v99
    v_lshl_or_b32 v100, v112, 16, v100
    v_lshl_or_b32 v101, v113, 16, v101
    v_lshl_or_b32 v102, v114, 16, v102
    v_lshl_or_b32 v103, v115, 16, v103
    v_lshl_or_b32 v104, v116, 16, v104
    v_lshl_or_b32 v105, v117, 16, v105
    v_lshl_or_b32 v106, v118, 16, v106
    v_lshl_or_b32 v107, v119, 16, v107
    buffer_store_dwordx4 v[96:99], v3, s[24:27], 0 offen offset:0 sc1
    buffer_store_dwordx4 v[100:103], v3, s[24:27], 0 offen offset:16 sc1
    buffer_store_dwordx4 v[104:107], v3, s[24:27], 0 offen offset:32 sc1
L1_wt:
    s_nop 1
    s_add_u32 s44, s96, 0x0
    v_lshlrev_b32 v16, 1, v1
    buffer_load_dwordx4 v[16:19], v16, s[8:11], s44 offen nt
    s_add_u32 s45, s96, 0x0
    v_lshlrev_b32 v20, 1, v1
    buffer_load_dwordx4 v[20:23], v20, s[12:15], s45 offen nt
    s_add_u32 s46, s96, 0x0
    s_lshr_b32 s46, s46, 1
    buffer_load_dwordx2 v[24:25], v1, s[16:19], s46 offen nt
    s_add_u32 s47, s97, 0x400000
    s_lshr_b32 s47, s47, 1
    buffer_load_dwordx2 v[26:27], v1, s[16:19], s47 offen nt
    s_add_u32 s44, s97, 0x400000
    v_lshlrev_b32 v28, 1, v1
    buffer_load_dwordx4 v[28:31], v28, s[8:11], s44 offen nt
    s_add_u32 s45, s97, 0x400000
    v_lshlrev_b32 v32, 1, v1
    buffer_load_dwordx4 v[32:35], v32, s[12:15], s45 offen nt
    s_add_u32 s46, s98, 0x800000
    v_lshlrev_b32 v36, 1, v1
    buffer_load_dwordx4 v[36:39], v36, s[8:11], s46 offen nt
    s_add_u32 s47, s98, 0x800000
    v_lshlrev_b32 v40, 1, v1
    buffer_load_dwordx4 v[40:43], v40, s[12:15], s47 offen nt
    s_add_u32 s44, s98, 0x800000
    s_lshr_b32 s44, s44, 1
    buffer_load_dwordx2 v[44:45], v1, s[16:19], s44 offen nt
    s_add_u32 s45, s99, 0xc00000
    s_lshr_b32 s45, s45, 1
    buffer_load_dwordx2 v[46:47], v1, s[16:19], s45 offen nt
    s_mov_b32 s20, s30
    s_mov_b32 s21, s31
    s_mov_b32 s22, 0xd344000
    s_mov_b32 s23, 0x20000
    s_add_u32 s24, s30, 0x2c000
    s_addc_u32 s25, s31, 0
    s_mov_b32 s26, 0xd318000
    s_mov_b32 s27, 0x20000
    s_add_u32 s3, s32, 0
    s_mul_i32 s4, s3, 205
    s_lshr_b32 s4, s4, 10
    s_mul_i32 s5, s4, 5
    s_sub_u32 s5, s3, s5
    s_lshl_b32 s5, s5, 5
    s_add_u32 s4, s4, s5
    s_sub_u32 s4, s4, s32
    s_lshl_b32 s72, s4, 10
    s_add_u32 s3, s32, 16
    s_mul_i32 s4, s3, 205
    s_lshr_b32 s4, s4, 10
    s_mul_i32 s5, s4, 5
    s_sub_u32 s5, s3, s5
    s_lshl_b32 s5, s5, 5
    s_add_u32 s4, s4, s5
    s_sub_u32 s4, s4, s32
    s_lshl_b32 s73, s4, 10
    s_add_u32 s3, s32, 32
    s_mul_i32 s4, s3, 205
    s_lshr_b32 s4, s4, 10
    s_mul_i32 s5, s4, 5
    s_sub_u32 s5, s3, s5
    s_lshl_b32 s5, s5, 5
    s_add_u32 s4, s4, s5
    s_sub_u32 s4, s4, s32
    s_lshl_b32 s85, s4, 10
    s_add_u32 s3, s32, 48
    s_mul_i32 s4, s3, 205
    s_lshr_b32 s4, s4, 10
    s_mul_i32 s5, s4, 5
    s_sub_u32 s5, s3, s5
    s_lshl_b32 s5, s5, 5
    s_add_u32 s4, s4, s5
    s_sub_u32 s4, s4, s32
    s_lshl_b32 s91, s4, 10
    s_add_u32 s3, s32, 64
    s_mul_i32 s4, s3, 205
    s_lshr_b32 s4, s4, 10
    s_mul_i32 s5, s4, 5
    s_sub_u32 s5, s3, s5
    s_lshl_b32 s5, s5, 5
    s_add_u32 s4, s4, s5
    s_sub_u32 s4, s4, s32
    s_lshl_b32 s93, s4, 10
    s_mov_b32 s80, s86
    s_mov_b32 s81, s87
    s_mov_b32 s82, 0x4e2000
    s_mov_b32 s83, 0x20000
    s_mul_i32 s35, s2, 173056
    s_and_b32 s37, s32, 3
    s_lshl_b32 s37, s37, 3
    s_mov_b32 s36, s37
    s_lshr_b32 s37, s32, 2
    s_mul_i32 s37, s37, 2080
    s_add_u32 s36, s36, s37
    s_and_b32 s37, s2, 3
    s_lshl_b32 s37, s37, 5
    s_add_u32 s36, s36, s37
    s_mul_i32 s4, s2, 5
    s_add_u32 s4, s4, 8192
    s_lshl_b32 s38, s4, 14
    s_lshl_b32 s39, s4, 13
    v_mov_b32 v2, 1
    v_mov_b32 v4, 0x80000007
    v_mov_b32 v5, 0xfc
    v_mov_b32 v6, 0x78
    s_mov_b32 s40, 16512
    s_mov_b32 s55, -10000
    s_mov_b32 s41, 0x010c0c01
    s_mov_b32 s42, 0x030c0c03
    v_mov_b32 v8, 0
    v_mov_b32 v9, 0
    v_mov_b32 v10, 0
    v_mov_b32 v11, 0
    ds_write_b128 v0, v[8:11]
    s_add_u32 s60, s30, 0xec5d000
    s_addc_u32 s61, s31, 0
    s_mov_b32 s62, 0x8000
    s_mov_b32 s63, 0x20000
    s_mov_b64 s[66:67], s[56:57]
    s_lshl_b32 s57, s2, 7
    s_add_u32 s68, s30, 0xec55000
    s_addc_u32 s69, s31, 0
    s_mov_b32 s70, 0x80
    s_mov_b32 s71, 0x20000
    s_lshl_b32 s3, s2, 7
    s_add_u32 s68, s68, s3
    s_addc_u32 s69, s69, 0
    s_cmp_lg_u32 s32, 0
    s_cbranch_scc1 L1_fl
    buffer_store_dwordx4 v[8:11], v0, s[68:71], 0 offen sc1
    s_mov_b64 exec, 0xff
    buffer_store_dwordx4 v[8:11], v0, s[60:63], s57 offen sc1
    s_mov_b64 exec, -1
L1_fl:
    s_waitcnt lgkmcnt(0)
    s_barrier
    s_setprio 3
    s_add_u32 s46, s99, 0xc00000
    v_lshlrev_b32 v48, 1, v1
    buffer_load_dwordx4 v[48:51], v48, s[8:11], s46 offen nt
    s_add_u32 s47, s99, 0xc00000
    v_lshlrev_b32 v52, 1, v1
    buffer_load_dwordx4 v[52:55], v52, s[12:15], s47 offen nt
    s_waitcnt vmcnt(8)
    v_lshlrev_b32 v7, 16, v24
    v_and_b32 v8, 0xffff0000, v24
    v_lshlrev_b32 v9, 16, v25
    v_and_b32 v10, 0xffff0000, v25
    v_mul_f32 v7, 0.15915494, v7
    v_mul_f32 v8, 0.15915494, v8
    v_mul_f32 v9, 0.15915494, v9
    v_mul_f32 v10, 0.15915494, v10
    v_mul_hi_u32_u24 v14, 429497, v16
    v_lshrrev_b32 v12, 3, v20
    v_cos_f32 v7, v7
    v_lshlrev_b16 v13, 3, v20
    v_mad_i32_i24 v11, v14, s55, v16
    v_bitop3_b32 v12, v6, v13, v12 bitop3:0xca
    v_lshl_add_u32 v11, v11, 17, s40
    v_lshlrev_b16 v14, 8, v14
    v_lshrrev_b32 v13, 2, v20
    v_add_u32 v16, v12, v11
    v_bitop3_b32 v20, v5, v13, v14 bitop3:0xea
    ds_add_u32 v20, v2
    v_mul_hi_u32_u24 v14, 429497, v17
    v_lshrrev_b32 v12, 3, v21
    v_cos_f32 v8, v8
    v_lshlrev_b16 v13, 3, v21
    v_mad_i32_i24 v11, v14, s55, v17
    v_bitop3_b32 v12, v6, v13, v12 bitop3:0xca
    v_lshl_add_u32 v11, v11, 17, s40
    v_lshlrev_b16 v14, 8, v14
    v_lshrrev_b32 v13, 2, v21
    v_add_u32 v17, v12, v11
    v_bitop3_b32 v21, v5, v13, v14 bitop3:0xea
    ds_add_u32 v21, v2
    v_cvt_pk_bf16_f32 v24, v7, v8
    v_perm_b32 v12, v24, v24, s41
    v_bitop3_b32 v16, v4, v12, v16 bitop3:0xca
    v_perm_b32 v13, v24, v24, s42
    v_bitop3_b32 v17, v4, v13, v17 bitop3:0xca
    v_mul_hi_u32_u24 v14, 429497, v18
    v_lshrrev_b32 v12, 3, v22
    v_cos_f32 v9, v9
    v_lshlrev_b16 v13, 3, v22
    v_mad_i32_i24 v11, v14, s55, v18
    v_bitop3_b32 v12, v6, v13, v12 bitop3:0xca
    v_lshl_add_u32 v11, v11, 17, s40
    v_lshlrev_b16 v14, 8, v14
    v_lshrrev_b32 v13, 2, v22
    v_add_u32 v18, v12, v11
    v_bitop3_b32 v22, v5, v13, v14 bitop3:0xea
    ds_add_u32 v22, v2
    v_mul_hi_u32_u24 v14, 429497, v19
    v_lshrrev_b32 v12, 3, v23
    v_cos_f32 v10, v10
    v_lshlrev_b16 v13, 3, v23
    v_mad_i32_i24 v11, v14, s55, v19
    v_bitop3_b32 v12, v6, v13, v12 bitop3:0xca
    v_lshl_add_u32 v11, v11, 17, s40
    v_lshlrev_b16 v14, 8, v14
    v_lshrrev_b32 v13, 2, v23
    v_add_u32 v19, v12, v11
    v_bitop3_b32 v23, v5, v13, v14 bitop3:0xea
    ds_add_u32 v23, v2
    v_cvt_pk_bf16_f32 v25, v9, v10
    v_perm_b32 v12, v25, v25, s41
    v_bitop3_b32 v18, v4, v12, v18 bitop3:0xca
    v_perm_b32 v13, v25, v25, s42
    v_bitop3_b32 v19, v4, v13, v19 bitop3:0xca
    s_add_u32 s44, s96, 0x1000000
    v_lshlrev_b32 v56, 1, v1
    buffer_load_dwordx4 v[56:59], v56, s[8:11], s44 offen nt
    s_add_u32 s45, s96, 0x1000000
    v_lshlrev_b32 v60, 1, v1
    buffer_load_dwordx4 v[60:63], v60, s[12:15], s45 offen nt
    s_add_u32 s46, s96, 0x1000000
    s_lshr_b32 s46, s46, 1
    buffer_load_dwordx2 v[64:65], v1, s[16:19], s46 offen nt
    s_add_u32 s47, s97, 0x1400000
    s_lshr_b32 s47, s47, 1
    buffer_load_dwordx2 v[66:67], v1, s[16:19], s47 offen nt
    s_waitcnt vmcnt(10)
    v_lshlrev_b32 v7, 16, v26
    v_and_b32 v8, 0xffff0000, v26
    v_lshlrev_b32 v9, 16, v27
    v_and_b32 v10, 0xffff0000, v27
    v_mul_f32 v7, 0.15915494, v7
    v_mul_f32 v8, 0.15915494, v8
    v_mul_f32 v9, 0.15915494, v9
    v_mul_f32 v10, 0.15915494, v10
    v_mul_hi_u32_u24 v14, 429497, v28
    v_lshrrev_b32 v12, 3, v32
    v_cos_f32 v7, v7
    v_lshlrev_b16 v13, 3, v32
    v_mad_i32_i24 v11, v14, s55, v28
    v_bitop3_b32 v12, v6, v13, v12 bitop3:0xca
    v_lshl_add_u32 v11, v11, 17, s40
    v_lshlrev_b16 v14, 8, v14
    v_lshrrev_b32 v13, 2, v32
    v_add_u32 v28, v12, v11
    v_bitop3_b32 v32, v5, v13, v14 bitop3:0xea
    ds_add_u32 v32, v2
    v_mul_hi_u32_u24 v14, 429497, v29
    v_lshrrev_b32 v12, 3, v33
    v_cos_f32 v8, v8
    v_lshlrev_b16 v13, 3, v33
    v_mad_i32_i24 v11, v14, s55, v29
    v_bitop3_b32 v12, v6, v13, v12 bitop3:0xca
    v_lshl_add_u32 v11, v11, 17, s40
    v_lshlrev_b16 v14, 8, v14
    v_lshrrev_b32 v13, 2, v33
    v_add_u32 v29, v12, v11
    v_bitop3_b32 v33, v5, v13, v14 bitop3:0xea
    ds_add_u32 v33, v2
    v_cvt_pk_bf16_f32 v26, v7, v8
    v_perm_b32 v12, v26, v26, s41
    v_bitop3_b32 v28, v4, v12, v28 bitop3:0xca
    v_perm_b32 v13, v26, v26, s42
    v_bitop3_b32 v29, v4, v13, v29 bitop3:0xca
    v_mul_hi_u32_u24 v14, 429497, v30
    v_lshrrev_b32 v12, 3, v34
    v_cos_f32 v9, v9
    v_lshlrev_b16 v13, 3, v34
    v_mad_i32_i24 v11, v14, s55, v30
    v_bitop3_b32 v12, v6, v13, v12 bitop3:0xca
    v_lshl_add_u32 v11, v11, 17, s40
    v_lshlrev_b16 v14, 8, v14
    v_lshrrev_b32 v13, 2, v34
    v_add_u32 v30, v12, v11
    v_bitop3_b32 v34, v5, v13, v14 bitop3:0xea
    ds_add_u32 v34, v2
    v_mul_hi_u32_u24 v14, 429497, v31
    v_lshrrev_b32 v12, 3, v35
    v_cos_f32 v10, v10
    v_lshlrev_b16 v13, 3, v35
    v_mad_i32_i24 v11, v14, s55, v31
    v_bitop3_b32 v12, v6, v13, v12 bitop3:0xca
    v_lshl_add_u32 v11, v11, 17, s40
    v_lshlrev_b16 v14, 8, v14
    v_lshrrev_b32 v13, 2, v35
    v_add_u32 v31, v12, v11
    v_bitop3_b32 v35, v5, v13, v14 bitop3:0xea
    ds_add_u32 v35, v2
    v_cvt_pk_bf16_f32 v27, v9, v10
    v_perm_b32 v12, v27, v27, s41
    v_bitop3_b32 v30, v4, v12, v30 bitop3:0xca
    v_perm_b32 v13, v27, v27, s42
    v_bitop3_b32 v31, v4, v13, v31 bitop3:0xca
    s_setprio 2
    s_add_u32 s44, s97, 0x1400000
    v_lshlrev_b32 v68, 1, v1
    buffer_load_dwordx4 v[68:71], v68, s[8:11], s44 offen nt
    s_add_u32 s45, s97, 0x1400000
    v_lshlrev_b32 v72, 1, v1
    buffer_load_dwordx4 v[72:75], v72, s[12:15], s45 offen nt
    s_waitcnt vmcnt(8)
    v_lshlrev_b32 v7, 16, v44
    v_and_b32 v8, 0xffff0000, v44
    v_lshlrev_b32 v9, 16, v45
    v_and_b32 v10, 0xffff0000, v45
    v_mul_f32 v7, 0.15915494, v7
    v_mul_f32 v8, 0.15915494, v8
    v_mul_f32 v9, 0.15915494, v9
    v_mul_f32 v10, 0.15915494, v10
    v_mul_hi_u32_u24 v14, 429497, v36
    v_lshrrev_b32 v12, 3, v40
    v_cos_f32 v7, v7
    v_lshlrev_b16 v13, 3, v40
    v_mad_i32_i24 v11, v14, s55, v36
    v_bitop3_b32 v12, v6, v13, v12 bitop3:0xca
    v_lshl_add_u32 v11, v11, 17, s40
    v_lshlrev_b16 v14, 8, v14
    v_lshrrev_b32 v13, 2, v40
    v_add_u32 v36, v12, v11
    v_bitop3_b32 v40, v5, v13, v14 bitop3:0xea
    ds_add_u32 v40, v2
    v_mul_hi_u32_u24 v14, 429497, v37
    v_lshrrev_b32 v12, 3, v41
    v_cos_f32 v8, v8
    v_lshlrev_b16 v13, 3, v41
    v_mad_i32_i24 v11, v14, s55, v37
    v_bitop3_b32 v12, v6, v13, v12 bitop3:0xca
    v_lshl_add_u32 v11, v11, 17, s40
    v_lshlrev_b16 v14, 8, v14
    v_lshrrev_b32 v13, 2, v41
    v_add_u32 v37, v12, v11
    v_bitop3_b32 v41, v5, v13, v14 bitop3:0xea
    ds_add_u32 v41, v2
    v_cvt_pk_bf16_f32 v44, v7, v8
    v_perm_b32 v12, v44, v44, s41
    v_bitop3_b32 v36, v4, v12, v36 bitop3:0xca
    v_perm_b32 v13, v44, v44, s42
    v_bitop3_b32 v37, v4, v13, v37 bitop3:0xca
    v_mul_hi_u32_u24 v14, 429497, v38
    v_lshrrev_b32 v12, 3, v42
    v_cos_f32 v9, v9
    v_lshlrev_b16 v13, 3, v42
    v_mad_i32_i24 v11, v14, s55, v38
    v_bitop3_b32 v12, v6, v13, v12 bitop3:0xca
    v_lshl_add_u32 v11, v11, 17, s40
    v_lshlrev_b16 v14, 8, v14
    v_lshrrev_b32 v13, 2, v42
    v_add_u32 v38, v12, v11
    v_bitop3_b32 v42, v5, v13, v14 bitop3:0xea
    ds_add_u32 v42, v2
    v_mul_hi_u32_u24 v14, 429497, v39
    v_lshrrev_b32 v12, 3, v43
    v_cos_f32 v10, v10
    v_lshlrev_b16 v13, 3, v43
    v_mad_i32_i24 v11, v14, s55, v39
    v_bitop3_b32 v12, v6, v13, v12 bitop3:0xca
    v_lshl_add_u32 v11, v11, 17, s40
    v_lshlrev_b16 v14, 8, v14
    v_lshrrev_b32 v13, 2, v43
    v_add_u32 v39, v12, v11
    v_bitop3_b32 v43, v5, v13, v14 bitop3:0xea
    ds_add_u32 v43, v2
    v_cvt_pk_bf16_f32 v45, v9, v10
    v_perm_b32 v12, v45, v45, s41
    v_bitop3_b32 v38, v4, v12, v38 bitop3:0xca
    v_perm_b32 v13, v45, v45, s42
    v_bitop3_b32 v39, v4, v13, v39 bitop3:0xca
    s_add_u32 s46, s98, 0x1800000
    v_lshlrev_b32 v76, 1, v1
    buffer_load_dwordx4 v[76:79], v76, s[8:11], s46 offen nt
    s_add_u32 s47, s98, 0x1800000
    v_lshlrev_b32 v80, 1, v1
    buffer_load_dwordx4 v[80:83], v80, s[12:15], s47 offen nt
    s_add_u32 s44, s98, 0x1800000
    s_lshr_b32 s44, s44, 1
    buffer_load_dwordx2 v[84:85], v1, s[16:19], s44 offen nt
    s_add_u32 s45, s99, 0x1c00000
    s_lshr_b32 s45, s45, 1
    buffer_load_dwordx2 v[86:87], v1, s[16:19], s45 offen nt
    s_waitcnt vmcnt(10)
    v_lshlrev_b32 v7, 16, v46
    v_and_b32 v8, 0xffff0000, v46
    v_lshlrev_b32 v9, 16, v47
    v_and_b32 v10, 0xffff0000, v47
    v_mul_f32 v7, 0.15915494, v7
    v_mul_f32 v8, 0.15915494, v8
    v_mul_f32 v9, 0.15915494, v9
    v_mul_f32 v10, 0.15915494, v10
    v_mul_hi_u32_u24 v14, 429497, v48
    v_lshrrev_b32 v12, 3, v52
    v_cos_f32 v7, v7
    v_lshlrev_b16 v13, 3, v52
    v_mad_i32_i24 v11, v14, s55, v48
    v_bitop3_b32 v12, v6, v13, v12 bitop3:0xca
    v_lshl_add_u32 v11, v11, 17, s40
    v_lshlrev_b16 v14, 8, v14
    v_lshrrev_b32 v13, 2, v52
    v_add_u32 v48, v12, v11
    v_bitop3_b32 v52, v5, v13, v14 bitop3:0xea
    ds_add_u32 v52, v2
    v_mul_hi_u32_u24 v14, 429497, v49
    v_lshrrev_b32 v12, 3, v53
    v_cos_f32 v8, v8
    v_lshlrev_b16 v13, 3, v53
    v_mad_i32_i24 v11, v14, s55, v49
    v_bitop3_b32 v12, v6, v13, v12 bitop3:0xca
    v_lshl_add_u32 v11, v11, 17, s40
    v_lshlrev_b16 v14, 8, v14
    v_lshrrev_b32 v13, 2, v53
    v_add_u32 v49, v12, v11
    v_bitop3_b32 v53, v5, v13, v14 bitop3:0xea
    ds_add_u32 v53, v2
    v_cvt_pk_bf16_f32 v46, v7, v8
    v_perm_b32 v12, v46, v46, s41
    v_bitop3_b32 v48, v4, v12, v48 bitop3:0xca
    v_perm_b32 v13, v46, v46, s42
    v_bitop3_b32 v49, v4, v13, v49 bitop3:0xca
    v_mul_hi_u32_u24 v14, 429497, v50
    v_lshrrev_b32 v12, 3, v54
    v_cos_f32 v9, v9
    v_lshlrev_b16 v13, 3, v54
    v_mad_i32_i24 v11, v14, s55, v50
    v_bitop3_b32 v12, v6, v13, v12 bitop3:0xca
    v_lshl_add_u32 v11, v11, 17, s40
    v_lshlrev_b16 v14, 8, v14
    v_lshrrev_b32 v13, 2, v54
    v_add_u32 v50, v12, v11
    v_bitop3_b32 v54, v5, v13, v14 bitop3:0xea
    ds_add_u32 v54, v2
    v_mul_hi_u32_u24 v14, 429497, v51
    v_lshrrev_b32 v12, 3, v55
    v_cos_f32 v10, v10
    v_lshlrev_b16 v13, 3, v55
    v_mad_i32_i24 v11, v14, s55, v51
    v_bitop3_b32 v12, v6, v13, v12 bitop3:0xca
    v_lshl_add_u32 v11, v11, 17, s40
    v_lshlrev_b16 v14, 8, v14
    v_lshrrev_b32 v13, 2, v55
    v_add_u32 v51, v12, v11
    v_bitop3_b32 v55, v5, v13, v14 bitop3:0xea
    ds_add_u32 v55, v2
    v_cvt_pk_bf16_f32 v47, v9, v10
    v_perm_b32 v12, v47, v47, s41
    v_bitop3_b32 v50, v4, v12, v50 bitop3:0xca
    v_perm_b32 v13, v47, v47, s42
    v_bitop3_b32 v51, v4, v13, v51 bitop3:0xca
    s_setprio 1
    s_add_u32 s46, s99, 0x1c00000
    v_lshlrev_b32 v88, 1, v1
    buffer_load_dwordx4 v[88:91], v88, s[8:11], s46 offen nt
    s_add_u32 s47, s99, 0x1c00000
    v_lshlrev_b32 v92, 1, v1
    buffer_load_dwordx4 v[92:95], v92, s[12:15], s47 offen nt
    s_waitcnt vmcnt(8)
    v_lshlrev_b32 v7, 16, v64
    v_and_b32 v8, 0xffff0000, v64
    v_lshlrev_b32 v9, 16, v65
    v_and_b32 v10, 0xffff0000, v65
    v_mul_f32 v7, 0.15915494, v7
    v_mul_f32 v8, 0.15915494, v8
    v_mul_f32 v9, 0.15915494, v9
    v_mul_f32 v10, 0.15915494, v10
    v_mul_hi_u32_u24 v14, 429497, v56
    v_lshrrev_b32 v12, 3, v60
    v_cos_f32 v7, v7
    v_lshlrev_b16 v13, 3, v60
    v_mad_i32_i24 v11, v14, s55, v56
    v_bitop3_b32 v12, v6, v13, v12 bitop3:0xca
    v_lshl_add_u32 v11, v11, 17, s40
    v_lshlrev_b16 v14, 8, v14
    v_lshrrev_b32 v13, 2, v60
    v_add_u32 v56, v12, v11
    v_bitop3_b32 v60, v5, v13, v14 bitop3:0xea
    ds_add_u32 v60, v2
    v_mul_hi_u32_u24 v14, 429497, v57
    v_lshrrev_b32 v12, 3, v61
    v_cos_f32 v8, v8
    v_lshlrev_b16 v13, 3, v61
    v_mad_i32_i24 v11, v14, s55, v57
    v_bitop3_b32 v12, v6, v13, v12 bitop3:0xca
    v_lshl_add_u32 v11, v11, 17, s40
    v_lshlrev_b16 v14, 8, v14
    v_lshrrev_b32 v13, 2, v61
    v_add_u32 v57, v12, v11
    v_bitop3_b32 v61, v5, v13, v14 bitop3:0xea
    ds_add_u32 v61, v2
    v_cvt_pk_bf16_f32 v64, v7, v8
    v_perm_b32 v12, v64, v64, s41
    v_bitop3_b32 v56, v4, v12, v56 bitop3:0xca
    v_perm_b32 v13, v64, v64, s42
    v_bitop3_b32 v57, v4, v13, v57 bitop3:0xca
    v_mul_hi_u32_u24 v14, 429497, v58
    v_lshrrev_b32 v12, 3, v62
    v_cos_f32 v9, v9
    v_lshlrev_b16 v13, 3, v62
    v_mad_i32_i24 v11, v14, s55, v58
    v_bitop3_b32 v12, v6, v13, v12 bitop3:0xca
    v_lshl_add_u32 v11, v11, 17, s40
    v_lshlrev_b16 v14, 8, v14
    v_lshrrev_b32 v13, 2, v62
    v_add_u32 v58, v12, v11
    v_bitop3_b32 v62, v5, v13, v14 bitop3:0xea
    ds_add_u32 v62, v2
    v_mul_hi_u32_u24 v14, 429497, v59
    v_lshrrev_b32 v12, 3, v63
    v_cos_f32 v10, v10
    v_lshlrev_b16 v13, 3, v63
    v_mad_i32_i24 v11, v14, s55, v59
    v_bitop3_b32 v12, v6, v13, v12 bitop3:0xca
    v_lshl_add_u32 v11, v11, 17, s40
    v_lshlrev_b16 v14, 8, v14
    v_lshrrev_b32 v13, 2, v63
    v_add_u32 v59, v12, v11
    v_bitop3_b32 v63, v5, v13, v14 bitop3:0xea
    ds_add_u32 v63, v2
    v_cvt_pk_bf16_f32 v65, v9, v10
    v_perm_b32 v12, v65, v65, s41
    v_bitop3_b32 v58, v4, v12, v58 bitop3:0xca
    v_perm_b32 v13, v65, v65, s42
    v_bitop3_b32 v59, v4, v13, v59 bitop3:0xca
    s_add_u32 s44, s96, 0x2000000
    v_lshlrev_b32 v96, 1, v1
    buffer_load_dwordx4 v[96:99], v96, s[8:11], s44 offen nt
    s_add_u32 s45, s96, 0x2000000
    v_lshlrev_b32 v104, 1, v1
    buffer_load_dwordx4 v[104:107], v104, s[12:15], s45 offen nt
    s_add_u32 s46, s96, 0x2000000
    s_lshr_b32 s46, s46, 1
    buffer_load_dwordx2 v[108:109], v1, s[16:19], s46 offen nt
    s_add_u32 s47, s97, 0x2400000
    s_lshr_b32 s47, s47, 1
    buffer_load_dwordx2 v[110:111], v1, s[16:19], s47 offen nt
    s_waitcnt vmcnt(10)
    v_lshlrev_b32 v7, 16, v66
    v_and_b32 v8, 0xffff0000, v66
    v_lshlrev_b32 v9, 16, v67
    v_and_b32 v10, 0xffff0000, v67
    v_mul_f32 v7, 0.15915494, v7
    v_mul_f32 v8, 0.15915494, v8
    v_mul_f32 v9, 0.15915494, v9
    v_mul_f32 v10, 0.15915494, v10
    v_mul_hi_u32_u24 v14, 429497, v68
    v_lshrrev_b32 v12, 3, v72
    v_cos_f32 v7, v7
    v_lshlrev_b16 v13, 3, v72
    v_mad_i32_i24 v11, v14, s55, v68
    v_bitop3_b32 v12, v6, v13, v12 bitop3:0xca
    v_lshl_add_u32 v11, v11, 17, s40
    v_lshlrev_b16 v14, 8, v14
    v_lshrrev_b32 v13, 2, v72
    v_add_u32 v68, v12, v11
    v_bitop3_b32 v72, v5, v13, v14 bitop3:0xea
    ds_add_u32 v72, v2
    v_mul_hi_u32_u24 v14, 429497, v69
    v_lshrrev_b32 v12, 3, v73
    v_cos_f32 v8, v8
    v_lshlrev_b16 v13, 3, v73
    v_mad_i32_i24 v11, v14, s55, v69
    v_bitop3_b32 v12, v6, v13, v12 bitop3:0xca
    v_lshl_add_u32 v11, v11, 17, s40
    v_lshlrev_b16 v14, 8, v14
    v_lshrrev_b32 v13, 2, v73
    v_add_u32 v69, v12, v11
    v_bitop3_b32 v73, v5, v13, v14 bitop3:0xea
    ds_add_u32 v73, v2
    v_cvt_pk_bf16_f32 v66, v7, v8
    v_perm_b32 v12, v66, v66, s41
    v_bitop3_b32 v68, v4, v12, v68 bitop3:0xca
    v_perm_b32 v13, v66, v66, s42
    v_bitop3_b32 v69, v4, v13, v69 bitop3:0xca
    v_mul_hi_u32_u24 v14, 429497, v70
    v_lshrrev_b32 v12, 3, v74
    v_cos_f32 v9, v9
    v_lshlrev_b16 v13, 3, v74
    v_mad_i32_i24 v11, v14, s55, v70
    v_bitop3_b32 v12, v6, v13, v12 bitop3:0xca
    v_lshl_add_u32 v11, v11, 17, s40
    v_lshlrev_b16 v14, 8, v14
    v_lshrrev_b32 v13, 2, v74
    v_add_u32 v70, v12, v11
    v_bitop3_b32 v74, v5, v13, v14 bitop3:0xea
    ds_add_u32 v74, v2
    v_mul_hi_u32_u24 v14, 429497, v71
    v_lshrrev_b32 v12, 3, v75
    v_cos_f32 v10, v10
    v_lshlrev_b16 v13, 3, v75
    v_mad_i32_i24 v11, v14, s55, v71
    v_bitop3_b32 v12, v6, v13, v12 bitop3:0xca
    v_lshl_add_u32 v11, v11, 17, s40
    v_lshlrev_b16 v14, 8, v14
    v_lshrrev_b32 v13, 2, v75
    v_add_u32 v71, v12, v11
    v_bitop3_b32 v75, v5, v13, v14 bitop3:0xea
    ds_add_u32 v75, v2
    v_cvt_pk_bf16_f32 v67, v9, v10
    v_perm_b32 v12, v67, v67, s41
    v_bitop3_b32 v70, v4, v12, v70 bitop3:0xca
    v_perm_b32 v13, v67, v67, s42
    v_bitop3_b32 v71, v4, v13, v71 bitop3:0xca
    s_setprio 0
    s_add_u32 s44, s97, 0x2400000
    v_lshlrev_b32 v100, 1, v1
    buffer_load_dwordx4 v[100:103], v100, s[8:11], s44 offen nt
    s_waitcnt vmcnt(7)
    v_lshlrev_b32 v7, 16, v84
    v_and_b32 v8, 0xffff0000, v84
    v_lshlrev_b32 v9, 16, v85
    v_and_b32 v10, 0xffff0000, v85
    v_mul_f32 v7, 0.15915494, v7
    v_mul_f32 v8, 0.15915494, v8
    v_mul_f32 v9, 0.15915494, v9
    v_mul_f32 v10, 0.15915494, v10
    v_mul_hi_u32_u24 v14, 429497, v76
    v_lshrrev_b32 v12, 3, v80
    v_cos_f32 v7, v7
    v_lshlrev_b16 v13, 3, v80
    v_mad_i32_i24 v11, v14, s55, v76
    v_bitop3_b32 v12, v6, v13, v12 bitop3:0xca
    v_lshl_add_u32 v11, v11, 17, s40
    v_lshlrev_b16 v14, 8, v14
    v_lshrrev_b32 v13, 2, v80
    v_add_u32 v76, v12, v11
    v_bitop3_b32 v80, v5, v13, v14 bitop3:0xea
    ds_add_u32 v80, v2
    v_mul_hi_u32_u24 v14, 429497, v77
    v_lshrrev_b32 v12, 3, v81
    v_cos_f32 v8, v8
    v_lshlrev_b16 v13, 3, v81
    v_mad_i32_i24 v11, v14, s55, v77
    v_bitop3_b32 v12, v6, v13, v12 bitop3:0xca
    v_lshl_add_u32 v11, v11, 17, s40
    v_lshlrev_b16 v14, 8, v14
    v_lshrrev_b32 v13, 2, v81
    v_add_u32 v77, v12, v11
    v_bitop3_b32 v81, v5, v13, v14 bitop3:0xea
    ds_add_u32 v81, v2
    v_cvt_pk_bf16_f32 v84, v7, v8
    v_perm_b32 v12, v84, v84, s41
    v_bitop3_b32 v76, v4, v12, v76 bitop3:0xca
    v_perm_b32 v13, v84, v84, s42
    v_bitop3_b32 v77, v4, v13, v77 bitop3:0xca
    v_mul_hi_u32_u24 v14, 429497, v78
    v_lshrrev_b32 v12, 3, v82
    v_cos_f32 v9, v9
    v_lshlrev_b16 v13, 3, v82
    v_mad_i32_i24 v11, v14, s55, v78
    v_bitop3_b32 v12, v6, v13, v12 bitop3:0xca
    v_lshl_add_u32 v11, v11, 17, s40
    v_lshlrev_b16 v14, 8, v14
    v_lshrrev_b32 v13, 2, v82
    v_add_u32 v78, v12, v11
    v_bitop3_b32 v82, v5, v13, v14 bitop3:0xea
    ds_add_u32 v82, v2
    v_mul_hi_u32_u24 v14, 429497, v79
    v_lshrrev_b32 v12, 3, v83
    v_cos_f32 v10, v10
    v_lshlrev_b16 v13, 3, v83
    v_mad_i32_i24 v11, v14, s55, v79
    v_bitop3_b32 v12, v6, v13, v12 bitop3:0xca
    v_lshl_add_u32 v11, v11, 17, s40
    v_lshlrev_b16 v14, 8, v14
    v_lshrrev_b32 v13, 2, v83
    v_add_u32 v79, v12, v11
    v_bitop3_b32 v83, v5, v13, v14 bitop3:0xea
    ds_add_u32 v83, v2
    v_cvt_pk_bf16_f32 v85, v9, v10
    v_perm_b32 v12, v85, v85, s41
    v_bitop3_b32 v78, v4, v12, v78 bitop3:0xca
    v_perm_b32 v13, v85, v85, s42
    v_bitop3_b32 v79, v4, v13, v79 bitop3:0xca
    s_waitcnt vmcnt(5)
    v_lshlrev_b32 v7, 16, v86
    v_and_b32 v8, 0xffff0000, v86
    v_lshlrev_b32 v9, 16, v87
    v_and_b32 v10, 0xffff0000, v87
    v_mul_f32 v7, 0.15915494, v7
    v_mul_f32 v8, 0.15915494, v8
    v_mul_f32 v9, 0.15915494, v9
    v_mul_f32 v10, 0.15915494, v10
    v_mul_hi_u32_u24 v14, 429497, v88
    v_lshrrev_b32 v12, 3, v92
    v_cos_f32 v7, v7
    v_lshlrev_b16 v13, 3, v92
    v_mad_i32_i24 v11, v14, s55, v88
    v_bitop3_b32 v12, v6, v13, v12 bitop3:0xca
    v_lshl_add_u32 v11, v11, 17, s40
    v_lshlrev_b16 v14, 8, v14
    v_lshrrev_b32 v13, 2, v92
    v_add_u32 v88, v12, v11
    v_bitop3_b32 v92, v5, v13, v14 bitop3:0xea
    ds_add_u32 v92, v2
    v_mul_hi_u32_u24 v14, 429497, v89
    v_lshrrev_b32 v12, 3, v93
    v_cos_f32 v8, v8
    v_lshlrev_b16 v13, 3, v93
    v_mad_i32_i24 v11, v14, s55, v89
    v_bitop3_b32 v12, v6, v13, v12 bitop3:0xca
    v_lshl_add_u32 v11, v11, 17, s40
    v_lshlrev_b16 v14, 8, v14
    v_lshrrev_b32 v13, 2, v93
    v_add_u32 v89, v12, v11
    v_bitop3_b32 v93, v5, v13, v14 bitop3:0xea
    ds_add_u32 v93, v2
    v_cvt_pk_bf16_f32 v86, v7, v8
    v_perm_b32 v12, v86, v86, s41
    v_bitop3_b32 v88, v4, v12, v88 bitop3:0xca
    v_perm_b32 v13, v86, v86, s42
    v_bitop3_b32 v89, v4, v13, v89 bitop3:0xca
    v_mul_hi_u32_u24 v14, 429497, v90
    v_lshrrev_b32 v12, 3, v94
    v_cos_f32 v9, v9
    v_lshlrev_b16 v13, 3, v94
    v_mad_i32_i24 v11, v14, s55, v90
    v_bitop3_b32 v12, v6, v13, v12 bitop3:0xca
    v_lshl_add_u32 v11, v11, 17, s40
    v_lshlrev_b16 v14, 8, v14
    v_lshrrev_b32 v13, 2, v94
    v_add_u32 v90, v12, v11
    v_bitop3_b32 v94, v5, v13, v14 bitop3:0xea
    ds_add_u32 v94, v2
    v_mul_hi_u32_u24 v14, 429497, v91
    v_lshrrev_b32 v12, 3, v95
    v_cos_f32 v10, v10
    v_lshlrev_b16 v13, 3, v95
    v_mad_i32_i24 v11, v14, s55, v91
    v_bitop3_b32 v12, v6, v13, v12 bitop3:0xca
    v_lshl_add_u32 v11, v11, 17, s40
    v_lshlrev_b16 v14, 8, v14
    v_lshrrev_b32 v13, 2, v95
    v_add_u32 v91, v12, v11
    v_bitop3_b32 v95, v5, v13, v14 bitop3:0xea
    ds_add_u32 v95, v2
    v_cvt_pk_bf16_f32 v87, v9, v10
    v_perm_b32 v12, v87, v87, s41
    v_bitop3_b32 v90, v4, v12, v90 bitop3:0xca
    v_perm_b32 v13, v87, v87, s42
    v_bitop3_b32 v91, v4, v13, v91 bitop3:0xca
    v_lshrrev_b32 v8, 2, v0
    v_and_b32 v7, 0x3c00, v0
    v_bitop3_b32 v7, v5, v8, v7 bitop3:0xea
    s_waitcnt lgkmcnt(0)
    s_barrier
    ds_read2st64_b32 v[8:9], v7 offset0:0 offset1:1
    ds_read2st64_b32 v[10:11], v7 offset0:2 offset1:3
    s_add_u32 s45, s97, 0x2400000
    v_lshlrev_b32 v112, 1, v1
    buffer_load_dwordx4 v[112:115], v112, s[12:15], s45 offen nt
    s_waitcnt lgkmcnt(0)
    v_lshl_or_b32 v12, v9, 16, v8
    v_lshl_or_b32 v13, v11, 16, v10
    v_mov_b32 v14, v12
    v_mov_b32 v15, v13
    s_nop 0
    v_add_u32_dpp v14, v14, v14 row_shr:1 row_mask:0xf bank_mask:0xf bound_ctrl:1
    v_add_u32_dpp v15, v15, v15 row_shr:1 row_mask:0xf bank_mask:0xf bound_ctrl:1
    s_nop 0
    v_add_u32_dpp v14, v14, v14 row_shr:2 row_mask:0xf bank_mask:0xf bound_ctrl:1
    v_add_u32_dpp v15, v15, v15 row_shr:2 row_mask:0xf bank_mask:0xf bound_ctrl:1
    s_nop 0
    v_add_u32_dpp v14, v14, v14 row_shr:4 row_mask:0xf bank_mask:0xf bound_ctrl:1
    v_add_u32_dpp v15, v15, v15 row_shr:4 row_mask:0xf bank_mask:0xf bound_ctrl:1
    s_nop 0
    v_add_u32_dpp v14, v14, v14 row_shr:8 row_mask:0xf bank_mask:0xf bound_ctrl:1
    v_add_u32_dpp v15, v15, v15 row_shr:8 row_mask:0xf bank_mask:0xf bound_ctrl:1
    s_nop 0
    v_add_u32_dpp v14, v14, v14 row_bcast:15 row_mask:0xa bank_mask:0xf
    v_add_u32_dpp v15, v15, v15 row_bcast:15 row_mask:0xa bank_mask:0xf
    s_nop 0
    v_add_u32_dpp v14, v14, v14 row_bcast:31 row_mask:0xc bank_mask:0xf
    v_add_u32_dpp v15, v15, v15 row_bcast:31 row_mask:0xc bank_mask:0xf
    v_readlane_b32 s48, v14, 63
    v_readlane_b32 s49, v15, 63
    s_lshl_b32 s54, s32, 2
    v_mov_b32 v8, s54
    s_and_b32 s50, s48, 0xffff
    s_lshr_b32 s51, s48, 16
    s_and_b32 s52, s49, 0xffff
    s_lshr_b32 s53, s49, 16
    s_add_u32 s51, s51, s50
    s_add_u32 s52, s52, s51
    s_add_u32 s53, s53, s52
    v_mov_b32 v9, s53
    s_mov_b64 exec, 1
    ds_write_b32 v8, v9 offset:16384
    s_mov_b64 exec, -1
    v_and_b32 v8, 60, v7
    s_waitcnt lgkmcnt(0)
    s_barrier
    ds_read_b32 v9, v8 offset:16384
    s_waitcnt lgkmcnt(0)
    v_add_u32_dpp v9, v9, v9 row_shr:1 row_mask:0xf bank_mask:0xf bound_ctrl:1
    s_nop 1
    v_add_u32_dpp v9, v9, v9 row_shr:2 row_mask:0xf bank_mask:0xf bound_ctrl:1
    s_nop 1
    v_add_u32_dpp v9, v9, v9 row_shr:4 row_mask:0xf bank_mask:0xf bound_ctrl:1
    s_nop 1
    v_add_u32_dpp v9, v9, v9 row_shr:8 row_mask:0xf bank_mask:0xf bound_ctrl:1
    s_nop 0
    v_readlane_b32 s54, v9, s32
    s_sub_u32 s54, s54, s53
    s_add_u32 s50, s50, s54
    s_add_u32 s51, s51, s54
    s_add_u32 s52, s52, s54
    s_pack_ll_b32_b16 s48, s54, s50
    s_pack_ll_b32_b16 s49, s51, s52
    v_add_u32 v14, s48, v14
    v_add_u32 v15, s49, v15
    v_sub_u32 v12, v14, v12
    v_sub_u32 v13, v15, v13
    v_and_b32 v8, 0xffff, v12
    v_lshrrev_b32 v9, 16, v12
    v_and_b32 v10, 0xffff, v13
    v_lshrrev_b32 v11, 16, v13
    ds_write2st64_b32 v7, v8, v9 offset0:0 offset1:1
    ds_write2st64_b32 v7, v10, v11 offset0:2 offset1:3
    v_and_b32 v8, 0x3f0, v0
    v_lshl_add_u32 v8, v8, 1, s36
    ds_write_b64 v8, v[12:13] offset:20480
    s_bitset0_b64 exec, 63
    s_not_b64 exec, exec
    ds_write_b64 v8, v[14:15] offset:20512
    s_mov_b64 exec, -1
    s_waitcnt lgkmcnt(0)
    s_barrier
    s_setprio 3
    ds_add_rtn_u32 v20, v20, v2
    ds_add_rtn_u32 v21, v21, v2
    ds_add_rtn_u32 v22, v22, v2
    ds_add_rtn_u32 v23, v23, v2
    ds_read_b128 v[12:15], v0 offset:20480
    v_cmp_gt_u32 vcc, 8448, v0
    s_add_u32 s46, s98, 0x2800000
    v_lshlrev_b32 v116, 1, v1
    buffer_load_dwordx4 v[116:119], v116, s[8:11], s46 offen nt
    ds_add_rtn_u32 v32, v32, v2
    ds_add_rtn_u32 v33, v33, v2
    ds_add_rtn_u32 v34, v34, v2
    ds_add_rtn_u32 v35, v35, v2
    s_setprio 2
    ds_add_rtn_u32 v40, v40, v2
    ds_add_rtn_u32 v41, v41, v2
    ds_add_rtn_u32 v42, v42, v2
    ds_add_rtn_u32 v43, v43, v2
    s_waitcnt lgkmcnt(8)
    s_cbranch_vccz L1_p1
    s_add_u32 s47, s35, 0x0
    s_mov_b64 exec, vcc
    buffer_store_dwordx4 v[12:15], v0, s[24:27], s47 offen sc1
    s_mov_b64 exec, -1
L1_p1:
    s_add_u32 s44, s98, 0x2800000
    v_lshlrev_b32 v120, 1, v1
    buffer_load_dwordx4 v[120:123], v120, s[12:15], s44 offen nt
    ds_add_rtn_u32 v52, v52, v2
    ds_add_rtn_u32 v53, v53, v2
    ds_add_rtn_u32 v54, v54, v2
    ds_add_rtn_u32 v55, v55, v2
    s_setprio 1
    ds_add_rtn_u32 v60, v60, v2
    ds_add_rtn_u32 v61, v61, v2
    ds_add_rtn_u32 v62, v62, v2
    ds_add_rtn_u32 v63, v63, v2
    ds_add_rtn_u32 v72, v72, v2
    ds_add_rtn_u32 v73, v73, v2
    ds_add_rtn_u32 v74, v74, v2
    ds_add_rtn_u32 v75, v75, v2
    s_add_u32 s45, s98, 0x2800000
    s_lshr_b32 s45, s45, 1
    buffer_load_dwordx2 v[124:125], v1, s[16:19], s45 offen nt
    s_add_u32 s46, s99, 0x2c00000
    s_lshr_b32 s46, s46, 1
    buffer_load_dwordx2 v[126:127], v1, s[16:19], s46 offen nt
    s_setprio 0
    ds_add_rtn_u32 v80, v80, v2
    ds_add_rtn_u32 v81, v81, v2
    ds_add_rtn_u32 v82, v82, v2
    ds_add_rtn_u32 v83, v83, v2
    ds_add_rtn_u32 v92, v92, v2
    ds_add_rtn_u32 v93, v93, v2
    ds_add_rtn_u32 v94, v94, v2
    ds_add_rtn_u32 v95, v95, v2
    s_waitcnt lgkmcnt(0)
    s_barrier
    s_setprio 3
    v_and_b32 v7, -4, v20
    v_lshl_add_u32 v8, v20, 2, v7
    ds_write_b32 v8, v16
    v_lshl_add_u32 v7, v7, 2, v20
    ds_write_b8 v7, v24 offset:16
    v_and_b32 v9, -4, v21
    v_lshl_add_u32 v10, v21, 2, v9
    ds_write_b32 v10, v17
    v_lshl_add_u32 v9, v9, 2, v21
    ds_write_b8_d16_hi v9, v24 offset:16
    v_and_b32 v7, -4, v22
    v_lshl_add_u32 v8, v22, 2, v7
    ds_write_b32 v8, v18
    v_lshl_add_u32 v7, v7, 2, v22
    ds_write_b8 v7, v25 offset:16
    v_and_b32 v9, -4, v23
    v_lshl_add_u32 v10, v23, 2, v9
    ds_write_b32 v10, v19
    v_lshl_add_u32 v9, v9, 2, v23
    ds_write_b8_d16_hi v9, v25 offset:16
    s_add_u32 s47, s99, 0x2c00000
    v_lshlrev_b32 v16, 1, v1
    buffer_load_dwordx4 v[16:19], v16, s[8:11], s47 offen nt
    s_add_u32 s44, s99, 0x2c00000
    v_lshlrev_b32 v20, 1, v1
    buffer_load_dwordx4 v[20:23], v20, s[12:15], s44 offen nt
    v_and_b32 v7, -4, v32
    v_lshl_add_u32 v8, v32, 2, v7
    ds_write_b32 v8, v28
    v_lshl_add_u32 v7, v7, 2, v32
    ds_write_b8 v7, v26 offset:16
    v_and_b32 v9, -4, v33
    v_lshl_add_u32 v10, v33, 2, v9
    ds_write_b32 v10, v29
    v_lshl_add_u32 v9, v9, 2, v33
    ds_write_b8_d16_hi v9, v26 offset:16
    v_and_b32 v7, -4, v34
    v_lshl_add_u32 v8, v34, 2, v7
    ds_write_b32 v8, v30
    v_lshl_add_u32 v7, v7, 2, v34
    ds_write_b8 v7, v27 offset:16
    v_and_b32 v9, -4, v35
    v_lshl_add_u32 v10, v35, 2, v9
    ds_write_b32 v10, v31
    v_lshl_add_u32 v9, v9, 2, v35
    ds_write_b8_d16_hi v9, v27 offset:16
    s_add_u32 s45, s96, 0x3000000
    v_lshlrev_b32 v28, 1, v1
    buffer_load_dwordx4 v[28:31], v28, s[8:11], s45 offen nt
    s_waitcnt vmcnt(9)
    v_lshlrev_b32 v7, 16, v108
    v_and_b32 v8, 0xffff0000, v108
    v_lshlrev_b32 v9, 16, v109
    v_and_b32 v10, 0xffff0000, v109
    v_mul_f32 v7, 0.15915494, v7
    v_mul_f32 v8, 0.15915494, v8
    v_mul_f32 v9, 0.15915494, v9
    v_mul_f32 v10, 0.15915494, v10
    v_mul_hi_u32_u24 v14, 429497, v96
    v_lshrrev_b32 v12, 3, v104
    v_cos_f32 v7, v7
    v_lshlrev_b16 v13, 3, v104
    v_mad_i32_i24 v11, v14, s55, v96
    v_bitop3_b32 v12, v6, v13, v12 bitop3:0xca
    v_lshl_add_u32 v11, v11, 17, s40
    v_lshlrev_b16 v14, 8, v14
    v_lshrrev_b32 v13, 2, v104
    v_add_u32 v96, v12, v11
    v_bitop3_b32 v104, v5, v13, v14 bitop3:0xea
    v_mul_hi_u32_u24 v14, 429497, v97
    v_lshrrev_b32 v12, 3, v105
    v_cos_f32 v8, v8
    v_lshlrev_b16 v13, 3, v105
    v_mad_i32_i24 v11, v14, s55, v97
    v_bitop3_b32 v12, v6, v13, v12 bitop3:0xca
    v_lshl_add_u32 v11, v11, 17, s40
    v_lshlrev_b16 v14, 8, v14
    v_lshrrev_b32 v13, 2, v105
    v_add_u32 v97, v12, v11
    v_bitop3_b32 v105, v5, v13, v14 bitop3:0xea
    v_cvt_pk_bf16_f32 v108, v7, v8
    v_perm_b32 v12, v108, v108, s41
    v_bitop3_b32 v96, v4, v12, v96 bitop3:0xca
    v_perm_b32 v13, v108, v108, s42
    v_bitop3_b32 v97, v4, v13, v97 bitop3:0xca
    v_mul_hi_u32_u24 v14, 429497, v98
    v_lshrrev_b32 v12, 3, v106
    v_cos_f32 v9, v9
    v_lshlrev_b16 v13, 3, v106
    v_mad_i32_i24 v11, v14, s55, v98
    v_bitop3_b32 v12, v6, v13, v12 bitop3:0xca
    v_lshl_add_u32 v11, v11, 17, s40
    v_lshlrev_b16 v14, 8, v14
    v_lshrrev_b32 v13, 2, v106
    v_add_u32 v98, v12, v11
    v_bitop3_b32 v106, v5, v13, v14 bitop3:0xea
    v_mul_hi_u32_u24 v14, 429497, v99
    v_lshrrev_b32 v12, 3, v107
    v_cos_f32 v10, v10
    v_lshlrev_b16 v13, 3, v107
    v_mad_i32_i24 v11, v14, s55, v99
    v_bitop3_b32 v12, v6, v13, v12 bitop3:0xca
    v_lshl_add_u32 v11, v11, 17, s40
    v_lshlrev_b16 v14, 8, v14
    v_lshrrev_b32 v13, 2, v107
    v_add_u32 v99, v12, v11
    v_bitop3_b32 v107, v5, v13, v14 bitop3:0xea
    v_cvt_pk_bf16_f32 v109, v9, v10
    v_perm_b32 v12, v109, v109, s41
    v_bitop3_b32 v98, v4, v12, v98 bitop3:0xca
    v_perm_b32 v13, v109, v109, s42
    v_bitop3_b32 v99, v4, v13, v99 bitop3:0xca
    s_setprio 2
    v_and_b32 v7, -4, v40
    v_lshl_add_u32 v8, v40, 2, v7
    ds_write_b32 v8, v36
    v_lshl_add_u32 v7, v7, 2, v40
    ds_write_b8 v7, v44 offset:16
    v_and_b32 v9, -4, v41
    v_lshl_add_u32 v10, v41, 2, v9
    ds_write_b32 v10, v37
    v_lshl_add_u32 v9, v9, 2, v41
    ds_write_b8_d16_hi v9, v44 offset:16
    v_and_b32 v7, -4, v42
    v_lshl_add_u32 v8, v42, 2, v7
    ds_write_b32 v8, v38
    v_lshl_add_u32 v7, v7, 2, v42
    ds_write_b8 v7, v45 offset:16
    v_and_b32 v9, -4, v43
    v_lshl_add_u32 v10, v43, 2, v9
    ds_write_b32 v10, v39
    v_lshl_add_u32 v9, v9, 2, v43
    ds_write_b8_d16_hi v9, v45 offset:16
    s_add_u32 s46, s96, 0x3000000
    v_lshlrev_b32 v32, 1, v1
    buffer_load_dwordx4 v[32:35], v32, s[12:15], s46 offen nt
    s_waitcnt vmcnt(8)
    v_lshlrev_b32 v7, 16, v110
    v_and_b32 v8, 0xffff0000, v110
    v_lshlrev_b32 v9, 16, v111
    v_and_b32 v10, 0xffff0000, v111
    v_mul_f32 v7, 0.15915494, v7
    v_mul_f32 v8, 0.15915494, v8
    v_mul_f32 v9, 0.15915494, v9
    v_mul_f32 v10, 0.15915494, v10
    v_mul_hi_u32_u24 v14, 429497, v100
    v_lshrrev_b32 v12, 3, v112
    v_cos_f32 v7, v7
    v_lshlrev_b16 v13, 3, v112
    v_mad_i32_i24 v11, v14, s55, v100
    v_bitop3_b32 v12, v6, v13, v12 bitop3:0xca
    v_lshl_add_u32 v11, v11, 17, s40
    v_lshlrev_b16 v14, 8, v14
    v_lshrrev_b32 v13, 2, v112
    v_add_u32 v100, v12, v11
    v_bitop3_b32 v112, v5, v13, v14 bitop3:0xea
    v_mul_hi_u32_u24 v14, 429497, v101
    v_lshrrev_b32 v12, 3, v113
    v_cos_f32 v8, v8
    v_lshlrev_b16 v13, 3, v113
    v_mad_i32_i24 v11, v14, s55, v101
    v_bitop3_b32 v12, v6, v13, v12 bitop3:0xca
    v_lshl_add_u32 v11, v11, 17, s40
    v_lshlrev_b16 v14, 8, v14
    v_lshrrev_b32 v13, 2, v113
    v_add_u32 v101, v12, v11
    v_bitop3_b32 v113, v5, v13, v14 bitop3:0xea
    v_cvt_pk_bf16_f32 v110, v7, v8
    v_perm_b32 v12, v110, v110, s41
    v_bitop3_b32 v100, v4, v12, v100 bitop3:0xca
    v_perm_b32 v13, v110, v110, s42
    v_bitop3_b32 v101, v4, v13, v101 bitop3:0xca
    v_mul_hi_u32_u24 v14, 429497, v102
    v_lshrrev_b32 v12, 3, v114
    v_cos_f32 v9, v9
    v_lshlrev_b16 v13, 3, v114
    v_mad_i32_i24 v11, v14, s55, v102
    v_bitop3_b32 v12, v6, v13, v12 bitop3:0xca
    v_lshl_add_u32 v11, v11, 17, s40
    v_lshlrev_b16 v14, 8, v14
    v_lshrrev_b32 v13, 2, v114
    v_add_u32 v102, v12, v11
    v_bitop3_b32 v114, v5, v13, v14 bitop3:0xea
    v_mul_hi_u32_u24 v14, 429497, v103
    v_lshrrev_b32 v12, 3, v115
    v_cos_f32 v10, v10
    v_lshlrev_b16 v13, 3, v115
    v_mad_i32_i24 v11, v14, s55, v103
    v_bitop3_b32 v12, v6, v13, v12 bitop3:0xca
    v_lshl_add_u32 v11, v11, 17, s40
    v_lshlrev_b16 v14, 8, v14
    v_lshrrev_b32 v13, 2, v115
    v_add_u32 v103, v12, v11
    v_bitop3_b32 v115, v5, v13, v14 bitop3:0xea
    v_cvt_pk_bf16_f32 v111, v9, v10
    v_perm_b32 v12, v111, v111, s41
    v_bitop3_b32 v102, v4, v12, v102 bitop3:0xca
    v_perm_b32 v13, v111, v111, s42
    v_bitop3_b32 v103, v4, v13, v103 bitop3:0xca
    v_and_b32 v7, -4, v52
    v_lshl_add_u32 v8, v52, 2, v7
    ds_write_b32 v8, v48
    v_lshl_add_u32 v7, v7, 2, v52
    ds_write_b8 v7, v46 offset:16
    v_and_b32 v9, -4, v53
    v_lshl_add_u32 v10, v53, 2, v9
    ds_write_b32 v10, v49
    v_lshl_add_u32 v9, v9, 2, v53
    ds_write_b8_d16_hi v9, v46 offset:16
    v_and_b32 v7, -4, v54
    v_lshl_add_u32 v8, v54, 2, v7
    ds_write_b32 v8, v50
    v_lshl_add_u32 v7, v7, 2, v54
    ds_write_b8 v7, v47 offset:16
    v_and_b32 v9, -4, v55
    v_lshl_add_u32 v10, v55, 2, v9
    ds_write_b32 v10, v51
    v_lshl_add_u32 v9, v9, 2, v55
    ds_write_b8_d16_hi v9, v47 offset:16
    s_add_u32 s47, s96, 0x3000000
    s_lshr_b32 s47, s47, 1
    buffer_load_dwordx2 v[24:25], v1, s[16:19], s47 offen nt
    s_add_u32 s44, s97, 0x3400000
    s_lshr_b32 s44, s44, 1
    buffer_load_dwordx2 v[26:27], v1, s[16:19], s44 offen nt
    s_waitcnt vmcnt(6)
    v_lshlrev_b32 v7, 16, v124
    v_and_b32 v8, 0xffff0000, v124
    v_lshlrev_b32 v9, 16, v125
    v_and_b32 v10, 0xffff0000, v125
    v_mul_f32 v7, 0.15915494, v7
    v_mul_f32 v8, 0.15915494, v8
    v_mul_f32 v9, 0.15915494, v9
    v_mul_f32 v10, 0.15915494, v10
    v_mul_hi_u32_u24 v14, 429497, v116
    v_lshrrev_b32 v12, 3, v120
    v_cos_f32 v7, v7
    v_lshlrev_b16 v13, 3, v120
    v_mad_i32_i24 v11, v14, s55, v116
    v_bitop3_b32 v12, v6, v13, v12 bitop3:0xca
    v_lshl_add_u32 v11, v11, 17, s40
    v_lshlrev_b16 v14, 8, v14
    v_lshrrev_b32 v13, 2, v120
    v_add_u32 v116, v12, v11
    v_bitop3_b32 v120, v5, v13, v14 bitop3:0xea
    v_mul_hi_u32_u24 v14, 429497, v117
    v_lshrrev_b32 v12, 3, v121
    v_cos_f32 v8, v8
    v_lshlrev_b16 v13, 3, v121
    v_mad_i32_i24 v11, v14, s55, v117
    v_bitop3_b32 v12, v6, v13, v12 bitop3:0xca
    v_lshl_add_u32 v11, v11, 17, s40
    v_lshlrev_b16 v14, 8, v14
    v_lshrrev_b32 v13, 2, v121
    v_add_u32 v117, v12, v11
    v_bitop3_b32 v121, v5, v13, v14 bitop3:0xea
    v_cvt_pk_bf16_f32 v124, v7, v8
    v_perm_b32 v12, v124, v124, s41
    v_bitop3_b32 v116, v4, v12, v116 bitop3:0xca
    v_perm_b32 v13, v124, v124, s42
    v_bitop3_b32 v117, v4, v13, v117 bitop3:0xca
    v_mul_hi_u32_u24 v14, 429497, v118
    v_lshrrev_b32 v12, 3, v122
    v_cos_f32 v9, v9
    v_lshlrev_b16 v13, 3, v122
    v_mad_i32_i24 v11, v14, s55, v118
    v_bitop3_b32 v12, v6, v13, v12 bitop3:0xca
    v_lshl_add_u32 v11, v11, 17, s40
    v_lshlrev_b16 v14, 8, v14
    v_lshrrev_b32 v13, 2, v122
    v_add_u32 v118, v12, v11
    v_bitop3_b32 v122, v5, v13, v14 bitop3:0xea
    v_mul_hi_u32_u24 v14, 429497, v119
    v_lshrrev_b32 v12, 3, v123
    v_cos_f32 v10, v10
    v_lshlrev_b16 v13, 3, v123
    v_mad_i32_i24 v11, v14, s55, v119
    v_bitop3_b32 v12, v6, v13, v12 bitop3:0xca
    v_lshl_add_u32 v11, v11, 17, s40
    v_lshlrev_b16 v14, 8, v14
    v_lshrrev_b32 v13, 2, v123
    v_add_u32 v119, v12, v11
    v_bitop3_b32 v123, v5, v13, v14 bitop3:0xea
    v_cvt_pk_bf16_f32 v125, v9, v10
    v_perm_b32 v12, v125, v125, s41
    v_bitop3_b32 v118, v4, v12, v118 bitop3:0xca
    v_perm_b32 v13, v125, v125, s42
    v_bitop3_b32 v119, v4, v13, v119 bitop3:0xca
    s_setprio 1
    v_and_b32 v7, -4, v60
    v_lshl_add_u32 v8, v60, 2, v7
    ds_write_b32 v8, v56
    v_lshl_add_u32 v7, v7, 2, v60
    ds_write_b8 v7, v64 offset:16
    v_and_b32 v9, -4, v61
    v_lshl_add_u32 v10, v61, 2, v9
    ds_write_b32 v10, v57
    v_lshl_add_u32 v9, v9, 2, v61
    ds_write_b8_d16_hi v9, v64 offset:16
    v_and_b32 v7, -4, v62
    v_lshl_add_u32 v8, v62, 2, v7
    ds_write_b32 v8, v58
    v_lshl_add_u32 v7, v7, 2, v62
    ds_write_b8 v7, v65 offset:16
    v_and_b32 v9, -4, v63
    v_lshl_add_u32 v10, v63, 2, v9
    ds_write_b32 v10, v59
    v_lshl_add_u32 v9, v9, 2, v63
    ds_write_b8_d16_hi v9, v65 offset:16
    s_add_u32 s45, s97, 0x3400000
    v_lshlrev_b32 v36, 1, v1
    buffer_load_dwordx4 v[36:39], v36, s[8:11], s45 offen nt
    s_add_u32 s46, s97, 0x3400000
    v_lshlrev_b32 v40, 1, v1
    buffer_load_dwordx4 v[40:43], v40, s[12:15], s46 offen nt
    v_and_b32 v7, -4, v72
    v_lshl_add_u32 v8, v72, 2, v7
    ds_write_b32 v8, v68
    v_lshl_add_u32 v7, v7, 2, v72
    ds_write_b8 v7, v66 offset:16
    v_and_b32 v9, -4, v73
    v_lshl_add_u32 v10, v73, 2, v9
    ds_write_b32 v10, v69
    v_lshl_add_u32 v9, v9, 2, v73
    ds_write_b8_d16_hi v9, v66 offset:16
    v_and_b32 v7, -4, v74
    v_lshl_add_u32 v8, v74, 2, v7
    ds_write_b32 v8, v70
    v_lshl_add_u32 v7, v7, 2, v74
    ds_write_b8 v7, v67 offset:16
    v_and_b32 v9, -4, v75
    v_lshl_add_u32 v10, v75, 2, v9
    ds_write_b32 v10, v71
    v_lshl_add_u32 v9, v9, 2, v75
    ds_write_b8_d16_hi v9, v67 offset:16
    s_add_u32 s47, s98, 0x3800000
    v_lshlrev_b32 v48, 1, v1
    buffer_load_dwordx4 v[48:51], v48, s[8:11], s47 offen nt
    s_waitcnt vmcnt(7)
    v_lshlrev_b32 v7, 16, v126
    v_and_b32 v8, 0xffff0000, v126
    v_lshlrev_b32 v9, 16, v127
    v_and_b32 v10, 0xffff0000, v127
    v_mul_f32 v7, 0.15915494, v7
    v_mul_f32 v8, 0.15915494, v8
    v_mul_f32 v9, 0.15915494, v9
    v_mul_f32 v10, 0.15915494, v10
    v_mul_hi_u32_u24 v14, 429497, v16
    v_lshrrev_b32 v12, 3, v20
    v_cos_f32 v7, v7
    v_lshlrev_b16 v13, 3, v20
    v_mad_i32_i24 v11, v14, s55, v16
    v_bitop3_b32 v12, v6, v13, v12 bitop3:0xca
    v_lshl_add_u32 v11, v11, 17, s40
    v_lshlrev_b16 v14, 8, v14
    v_lshrrev_b32 v13, 2, v20
    v_add_u32 v16, v12, v11
    v_bitop3_b32 v20, v5, v13, v14 bitop3:0xea
    v_mul_hi_u32_u24 v14, 429497, v17
    v_lshrrev_b32 v12, 3, v21
    v_cos_f32 v8, v8
    v_lshlrev_b16 v13, 3, v21
    v_mad_i32_i24 v11, v14, s55, v17
    v_bitop3_b32 v12, v6, v13, v12 bitop3:0xca
    v_lshl_add_u32 v11, v11, 17, s40
    v_lshlrev_b16 v14, 8, v14
    v_lshrrev_b32 v13, 2, v21
    v_add_u32 v17, v12, v11
    v_bitop3_b32 v21, v5, v13, v14 bitop3:0xea
    v_cvt_pk_bf16_f32 v126, v7, v8
    v_perm_b32 v12, v126, v126, s41
    v_bitop3_b32 v16, v4, v12, v16 bitop3:0xca
    v_perm_b32 v13, v126, v126, s42
    v_bitop3_b32 v17, v4, v13, v17 bitop3:0xca
    v_mul_hi_u32_u24 v14, 429497, v18
    v_lshrrev_b32 v12, 3, v22
    v_cos_f32 v9, v9
    v_lshlrev_b16 v13, 3, v22
    v_mad_i32_i24 v11, v14, s55, v18
    v_bitop3_b32 v12, v6, v13, v12 bitop3:0xca
    v_lshl_add_u32 v11, v11, 17, s40
    v_lshlrev_b16 v14, 8, v14
    v_lshrrev_b32 v13, 2, v22
    v_add_u32 v18, v12, v11
    v_bitop3_b32 v22, v5, v13, v14 bitop3:0xea
    v_mul_hi_u32_u24 v14, 429497, v19
    v_lshrrev_b32 v12, 3, v23
    v_cos_f32 v10, v10
    v_lshlrev_b16 v13, 3, v23
    v_mad_i32_i24 v11, v14, s55, v19
    v_bitop3_b32 v12, v6, v13, v12 bitop3:0xca
    v_lshl_add_u32 v11, v11, 17, s40
    v_lshlrev_b16 v14, 8, v14
    v_lshrrev_b32 v13, 2, v23
    v_add_u32 v19, v12, v11
    v_bitop3_b32 v23, v5, v13, v14 bitop3:0xea
    v_cvt_pk_bf16_f32 v127, v9, v10
    v_perm_b32 v12, v127, v127, s41
    v_bitop3_b32 v18, v4, v12, v18 bitop3:0xca
    v_perm_b32 v13, v127, v127, s42
    v_bitop3_b32 v19, v4, v13, v19 bitop3:0xca
    s_setprio 0
    v_and_b32 v7, -4, v80
    v_lshl_add_u32 v8, v80, 2, v7
    ds_write_b32 v8, v76
    v_lshl_add_u32 v7, v7, 2, v80
    ds_write_b8 v7, v84 offset:16
    v_and_b32 v9, -4, v81
    v_lshl_add_u32 v10, v81, 2, v9
    ds_write_b32 v10, v77
    v_lshl_add_u32 v9, v9, 2, v81
    ds_write_b8_d16_hi v9, v84 offset:16
    v_and_b32 v7, -4, v82
    v_lshl_add_u32 v8, v82, 2, v7
    ds_write_b32 v8, v78
    v_lshl_add_u32 v7, v7, 2, v82
    ds_write_b8 v7, v85 offset:16
    v_and_b32 v9, -4, v83
    v_lshl_add_u32 v10, v83, 2, v9
    ds_write_b32 v10, v79
    v_lshl_add_u32 v9, v9, 2, v83
    ds_write_b8_d16_hi v9, v85 offset:16
    s_add_u32 s44, s98, 0x3800000
    v_lshlrev_b32 v52, 1, v1
    buffer_load_dwordx4 v[52:55], v52, s[12:15], s44 offen nt
    s_waitcnt vmcnt(4)
    v_lshlrev_b32 v7, 16, v24
    v_and_b32 v8, 0xffff0000, v24
    v_lshlrev_b32 v9, 16, v25
    v_and_b32 v10, 0xffff0000, v25
    v_mul_f32 v7, 0.15915494, v7
    v_mul_f32 v8, 0.15915494, v8
    v_mul_f32 v9, 0.15915494, v9
    v_mul_f32 v10, 0.15915494, v10
    v_mul_hi_u32_u24 v14, 429497, v28
    v_lshrrev_b32 v12, 3, v32
    v_cos_f32 v7, v7
    v_lshlrev_b16 v13, 3, v32
    v_mad_i32_i24 v11, v14, s55, v28
    v_bitop3_b32 v12, v6, v13, v12 bitop3:0xca
    v_lshl_add_u32 v11, v11, 17, s40
    v_lshlrev_b16 v14, 8, v14
    v_lshrrev_b32 v13, 2, v32
    v_add_u32 v28, v12, v11
    v_bitop3_b32 v32, v5, v13, v14 bitop3:0xea
    v_mul_hi_u32_u24 v14, 429497, v29
    v_lshrrev_b32 v12, 3, v33
    v_cos_f32 v8, v8
    v_lshlrev_b16 v13, 3, v33
    v_mad_i32_i24 v11, v14, s55, v29
    v_bitop3_b32 v12, v6, v13, v12 bitop3:0xca
    v_lshl_add_u32 v11, v11, 17, s40
    v_lshlrev_b16 v14, 8, v14
    v_lshrrev_b32 v13, 2, v33
    v_add_u32 v29, v12, v11
    v_bitop3_b32 v33, v5, v13, v14 bitop3:0xea
    v_cvt_pk_bf16_f32 v24, v7, v8
    v_perm_b32 v12, v24, v24, s41
    v_bitop3_b32 v28, v4, v12, v28 bitop3:0xca
    v_perm_b32 v13, v24, v24, s42
    v_bitop3_b32 v29, v4, v13, v29 bitop3:0xca
    v_mul_hi_u32_u24 v14, 429497, v30
    v_lshrrev_b32 v12, 3, v34
    v_cos_f32 v9, v9
    v_lshlrev_b16 v13, 3, v34
    v_mad_i32_i24 v11, v14, s55, v30
    v_bitop3_b32 v12, v6, v13, v12 bitop3:0xca
    v_lshl_add_u32 v11, v11, 17, s40
    v_lshlrev_b16 v14, 8, v14
    v_lshrrev_b32 v13, 2, v34
    v_add_u32 v30, v12, v11
    v_bitop3_b32 v34, v5, v13, v14 bitop3:0xea
    v_mul_hi_u32_u24 v14, 429497, v31
    v_lshrrev_b32 v12, 3, v35
    v_cos_f32 v10, v10
    v_lshlrev_b16 v13, 3, v35
    v_mad_i32_i24 v11, v14, s55, v31
    v_bitop3_b32 v12, v6, v13, v12 bitop3:0xca
    v_lshl_add_u32 v11, v11, 17, s40
    v_lshlrev_b16 v14, 8, v14
    v_lshrrev_b32 v13, 2, v35
    v_add_u32 v31, v12, v11
    v_bitop3_b32 v35, v5, v13, v14 bitop3:0xea
    v_cvt_pk_bf16_f32 v25, v9, v10
    v_perm_b32 v12, v25, v25, s41
    v_bitop3_b32 v30, v4, v12, v30 bitop3:0xca
    v_perm_b32 v13, v25, v25, s42
    v_bitop3_b32 v31, v4, v13, v31 bitop3:0xca
    v_and_b32 v7, -4, v92
    v_lshl_add_u32 v8, v92, 2, v7
    ds_write_b32 v8, v88
    v_lshl_add_u32 v7, v7, 2, v92
    ds_write_b8 v7, v86 offset:16
    v_and_b32 v9, -4, v93
    v_lshl_add_u32 v10, v93, 2, v9
    ds_write_b32 v10, v89
    v_lshl_add_u32 v9, v9, 2, v93
    ds_write_b8_d16_hi v9, v86 offset:16
    v_and_b32 v7, -4, v94
    v_lshl_add_u32 v8, v94, 2, v7
    ds_write_b32 v8, v90
    v_lshl_add_u32 v7, v7, 2, v94
    ds_write_b8 v7, v87 offset:16
    v_and_b32 v9, -4, v95
    v_lshl_add_u32 v10, v95, 2, v9
    ds_write_b32 v10, v91
    v_lshl_add_u32 v9, v9, 2, v95
    ds_write_b8_d16_hi v9, v87 offset:16
    s_add_u32 s45, s98, 0x3800000
    s_lshr_b32 s45, s45, 1
    buffer_load_dwordx2 v[44:45], v1, s[16:19], s45 offen nt
    s_add_u32 s46, s99, 0x3c00000
    s_lshr_b32 s46, s46, 1
    buffer_load_dwordx2 v[46:47], v1, s[16:19], s46 offen nt
    s_waitcnt vmcnt(4)
    v_lshlrev_b32 v7, 16, v26
    v_and_b32 v8, 0xffff0000, v26
    v_lshlrev_b32 v9, 16, v27
    v_and_b32 v10, 0xffff0000, v27
    v_mul_f32 v7, 0.15915494, v7
    v_mul_f32 v8, 0.15915494, v8
    v_mul_f32 v9, 0.15915494, v9
    v_mul_f32 v10, 0.15915494, v10
    v_mul_hi_u32_u24 v14, 429497, v36
    v_lshrrev_b32 v12, 3, v40
    v_cos_f32 v7, v7
    v_lshlrev_b16 v13, 3, v40
    v_mad_i32_i24 v11, v14, s55, v36
    v_bitop3_b32 v12, v6, v13, v12 bitop3:0xca
    v_lshl_add_u32 v11, v11, 17, s40
    v_lshlrev_b16 v14, 8, v14
    v_lshrrev_b32 v13, 2, v40
    v_add_u32 v36, v12, v11
    v_bitop3_b32 v40, v5, v13, v14 bitop3:0xea
    v_mul_hi_u32_u24 v14, 429497, v37
    v_lshrrev_b32 v12, 3, v41
    v_cos_f32 v8, v8
    v_lshlrev_b16 v13, 3, v41
    v_mad_i32_i24 v11, v14, s55, v37
    v_bitop3_b32 v12, v6, v13, v12 bitop3:0xca
    v_lshl_add_u32 v11, v11, 17, s40
    v_lshlrev_b16 v14, 8, v14
    v_lshrrev_b32 v13, 2, v41
    v_add_u32 v37, v12, v11
    v_bitop3_b32 v41, v5, v13, v14 bitop3:0xea
    v_cvt_pk_bf16_f32 v26, v7, v8
    v_perm_b32 v12, v26, v26, s41
    v_bitop3_b32 v36, v4, v12, v36 bitop3:0xca
    v_perm_b32 v13, v26, v26, s42
    v_bitop3_b32 v37, v4, v13, v37 bitop3:0xca
    v_mul_hi_u32_u24 v14, 429497, v38
    v_lshrrev_b32 v12, 3, v42
    v_cos_f32 v9, v9
    v_lshlrev_b16 v13, 3, v42
    v_mad_i32_i24 v11, v14, s55, v38
    v_bitop3_b32 v12, v6, v13, v12 bitop3:0xca
    v_lshl_add_u32 v11, v11, 17, s40
    v_lshlrev_b16 v14, 8, v14
    v_lshrrev_b32 v13, 2, v42
    v_add_u32 v38, v12, v11
    v_bitop3_b32 v42, v5, v13, v14 bitop3:0xea
    v_mul_hi_u32_u24 v14, 429497, v39
    v_lshrrev_b32 v12, 3, v43
    v_cos_f32 v10, v10
    v_lshlrev_b16 v13, 3, v43
    v_mad_i32_i24 v11, v14, s55, v39
    v_bitop3_b32 v12, v6, v13, v12 bitop3:0xca
    v_lshl_add_u32 v11, v11, 17, s40
    v_lshlrev_b16 v14, 8, v14
    v_lshrrev_b32 v13, 2, v43
    v_add_u32 v39, v12, v11
    v_bitop3_b32 v43, v5, v13, v14 bitop3:0xea
    v_cvt_pk_bf16_f32 v27, v9, v10
    v_perm_b32 v12, v27, v27, s41
    v_bitop3_b32 v38, v4, v12, v38 bitop3:0xca
    v_perm_b32 v13, v27, v27, s42
    v_bitop3_b32 v39, v4, v13, v39 bitop3:0xca
    v_add_u32 v7, s72, v0
    v_add_u32 v12, s73, v0
    v_add_u32 v13, s85, v0
    v_add_u32 v14, s91, v0
    v_add_u32 v15, s93, v0
    s_min_i32 s3, s72, s73
    s_min_i32 s3, s3, s85
    s_min_i32 s3, s3, s91
    s_min_i32 s3, s3, s93
    v_add_u32 v3, s3, v0
    v_mov_b32 v8, 0
    v_mov_b32 v9, 0
    v_mov_b32 v10, 0
    v_mov_b32 v11, 0
    s_waitcnt lgkmcnt(0)
    s_barrier
    ds_read_b128 v[56:59], v7 offset:0
    ds_read_b128 v[60:63], v12 offset:0
    ds_read_b128 v[68:71], v13 offset:0
    ds_read_b128 v[72:75], v14 offset:0
    ds_read_b128 v[64:67], v15 offset:0
    ds_write_b128 v3, v[8:11]
    ds_read_b128 v[76:79], v7 offset:16384
    ds_read_b128 v[80:83], v12 offset:16384
    ds_read_b128 v[88:91], v13 offset:16384
    ds_read_b128 v[92:95], v14 offset:16384
    ds_read_b128 v[84:87], v15 offset:16384
    s_waitcnt lgkmcnt(0)
    s_barrier
    s_setprio 3
    s_add_u32 s47, s35, 0x4000
    s_add_u32 s47, s47, s72
    buffer_store_dwordx4 v[56:59], v0, s[20:23], s47 offen sc1
    s_add_u32 s44, s99, 0x3c00000
    s_nop 0
    v_lshlrev_b32 v56, 1, v1
    buffer_load_dwordx4 v[56:59], v56, s[8:11], s44 offen nt
    s_add_u32 s45, s35, 0x4000
    s_add_u32 s45, s45, s73
    buffer_store_dwordx4 v[60:63], v0, s[20:23], s45 offen sc1
    s_add_u32 s46, s99, 0x3c00000
    s_nop 0
    v_lshlrev_b32 v60, 1, v1
    buffer_load_dwordx4 v[60:63], v60, s[12:15], s46 offen nt
    ds_add_u32 v104, v2
    ds_add_u32 v105, v2
    ds_add_u32 v106, v2
    ds_add_u32 v107, v2
    ds_add_u32 v112, v2
    ds_add_u32 v113, v2
    ds_add_u32 v114, v2
    ds_add_u32 v115, v2
    s_setprio 2
    ds_add_u32 v120, v2
    ds_add_u32 v121, v2
    ds_add_u32 v122, v2
    ds_add_u32 v123, v2
    ds_add_u32 v20, v2
    ds_add_u32 v21, v2
    ds_add_u32 v22, v2
    ds_add_u32 v23, v2
    s_setprio 1
    s_add_u32 s47, s35, 0x4000
    s_add_u32 s47, s47, s85
    buffer_store_dwordx4 v[68:71], v0, s[20:23], s47 offen sc1
    s_add_u32 s44, s96, 0x4000000
    s_nop 0
    v_lshlrev_b32 v68, 1, v1
    buffer_load_dwordx4 v[68:71], v68, s[8:11], s44 offen nt
    ds_add_u32 v32, v2
    ds_add_u32 v33, v2
    ds_add_u32 v34, v2
    ds_add_u32 v35, v2
    ds_add_u32 v40, v2
    ds_add_u32 v41, v2
    ds_add_u32 v42, v2
    ds_add_u32 v43, v2
    s_setprio 0
    s_waitcnt vmcnt(6)
    v_lshlrev_b32 v7, 16, v44
    v_and_b32 v8, 0xffff0000, v44
    v_lshlrev_b32 v9, 16, v45
    v_and_b32 v10, 0xffff0000, v45
    v_mul_f32 v7, 0.15915494, v7
    v_mul_f32 v8, 0.15915494, v8
    v_mul_f32 v9, 0.15915494, v9
    v_mul_f32 v10, 0.15915494, v10
    v_mul_hi_u32_u24 v14, 429497, v48
    v_lshrrev_b32 v12, 3, v52
    v_cos_f32 v7, v7
    v_lshlrev_b16 v13, 3, v52
    v_mad_i32_i24 v11, v14, s55, v48
    v_bitop3_b32 v12, v6, v13, v12 bitop3:0xca
    v_lshl_add_u32 v11, v11, 17, s40
    v_lshlrev_b16 v14, 8, v14
    v_lshrrev_b32 v13, 2, v52
    v_add_u32 v48, v12, v11
    v_bitop3_b32 v52, v5, v13, v14 bitop3:0xea
    ds_add_u32 v52, v2
    v_mul_hi_u32_u24 v14, 429497, v49
    v_lshrrev_b32 v12, 3, v53
    v_cos_f32 v8, v8
    v_lshlrev_b16 v13, 3, v53
    v_mad_i32_i24 v11, v14, s55, v49
    v_bitop3_b32 v12, v6, v13, v12 bitop3:0xca
    v_lshl_add_u32 v11, v11, 17, s40
    v_lshlrev_b16 v14, 8, v14
    v_lshrrev_b32 v13, 2, v53
    v_add_u32 v49, v12, v11
    v_bitop3_b32 v53, v5, v13, v14 bitop3:0xea
    ds_add_u32 v53, v2
    v_cvt_pk_bf16_f32 v44, v7, v8
    v_perm_b32 v12, v44, v44, s41
    v_bitop3_b32 v48, v4, v12, v48 bitop3:0xca
    v_perm_b32 v13, v44, v44, s42
    v_bitop3_b32 v49, v4, v13, v49 bitop3:0xca
    v_mul_hi_u32_u24 v14, 429497, v50
    v_lshrrev_b32 v12, 3, v54
    v_cos_f32 v9, v9
    v_lshlrev_b16 v13, 3, v54
    v_mad_i32_i24 v11, v14, s55, v50
    v_bitop3_b32 v12, v6, v13, v12 bitop3:0xca
    v_lshl_add_u32 v11, v11, 17, s40
    v_lshlrev_b16 v14, 8, v14
    v_lshrrev_b32 v13, 2, v54
    v_add_u32 v50, v12, v11
    v_bitop3_b32 v54, v5, v13, v14 bitop3:0xea
    ds_add_u32 v54, v2
    v_mul_hi_u32_u24 v14, 429497, v51
    v_lshrrev_b32 v12, 3, v55
    v_cos_f32 v10, v10
    v_lshlrev_b16 v13, 3, v55
    v_mad_i32_i24 v11, v14, s55, v51
    v_bitop3_b32 v12, v6, v13, v12 bitop3:0xca
    v_lshl_add_u32 v11, v11, 17, s40
    v_lshlrev_b16 v14, 8, v14
    v_lshrrev_b32 v13, 2, v55
    v_add_u32 v51, v12, v11
    v_bitop3_b32 v55, v5, v13, v14 bitop3:0xea
    ds_add_u32 v55, v2
    v_cvt_pk_bf16_f32 v45, v9, v10
    v_perm_b32 v12, v45, v45, s41
    v_bitop3_b32 v50, v4, v12, v50 bitop3:0xca
    v_perm_b32 v13, v45, v45, s42
    v_bitop3_b32 v51, v4, v13, v51 bitop3:0xca
    s_waitcnt vmcnt(2)
    v_lshlrev_b32 v7, 16, v46
    v_and_b32 v8, 0xffff0000, v46
    v_lshlrev_b32 v9, 16, v47
    v_and_b32 v10, 0xffff0000, v47
    v_mul_f32 v7, 0.15915494, v7
    v_mul_f32 v8, 0.15915494, v8
    v_mul_f32 v9, 0.15915494, v9
    v_mul_f32 v10, 0.15915494, v10
    v_mul_hi_u32_u24 v14, 429497, v56
    v_lshrrev_b32 v12, 3, v60
    v_cos_f32 v7, v7
    v_lshlrev_b16 v13, 3, v60
    v_mad_i32_i24 v11, v14, s55, v56
    v_bitop3_b32 v12, v6, v13, v12 bitop3:0xca
    v_lshl_add_u32 v11, v11, 17, s40
    v_lshlrev_b16 v14, 8, v14
    v_lshrrev_b32 v13, 2, v60
    v_add_u32 v56, v12, v11
    v_bitop3_b32 v60, v5, v13, v14 bitop3:0xea
    ds_add_u32 v60, v2
    v_mul_hi_u32_u24 v14, 429497, v57
    v_lshrrev_b32 v12, 3, v61
    v_cos_f32 v8, v8
    v_lshlrev_b16 v13, 3, v61
    v_mad_i32_i24 v11, v14, s55, v57
    v_bitop3_b32 v12, v6, v13, v12 bitop3:0xca
    v_lshl_add_u32 v11, v11, 17, s40
    v_lshlrev_b16 v14, 8, v14
    v_lshrrev_b32 v13, 2, v61
    v_add_u32 v57, v12, v11
    v_bitop3_b32 v61, v5, v13, v14 bitop3:0xea
    ds_add_u32 v61, v2
    v_cvt_pk_bf16_f32 v46, v7, v8
    v_perm_b32 v12, v46, v46, s41
    v_bitop3_b32 v56, v4, v12, v56 bitop3:0xca
    v_perm_b32 v13, v46, v46, s42
    v_bitop3_b32 v57, v4, v13, v57 bitop3:0xca
    v_mul_hi_u32_u24 v14, 429497, v58
    v_lshrrev_b32 v12, 3, v62
    v_cos_f32 v9, v9
    v_lshlrev_b16 v13, 3, v62
    v_mad_i32_i24 v11, v14, s55, v58
    v_bitop3_b32 v12, v6, v13, v12 bitop3:0xca
    v_lshl_add_u32 v11, v11, 17, s40
    v_lshlrev_b16 v14, 8, v14
    v_lshrrev_b32 v13, 2, v62
    v_add_u32 v58, v12, v11
    v_bitop3_b32 v62, v5, v13, v14 bitop3:0xea
    ds_add_u32 v62, v2
    v_mul_hi_u32_u24 v14, 429497, v59
    v_lshrrev_b32 v12, 3, v63
    v_cos_f32 v10, v10
    v_lshlrev_b16 v13, 3, v63
    v_mad_i32_i24 v11, v14, s55, v59
    v_bitop3_b32 v12, v6, v13, v12 bitop3:0xca
    v_lshl_add_u32 v11, v11, 17, s40
    v_lshlrev_b16 v14, 8, v14
    v_lshrrev_b32 v13, 2, v63
    v_add_u32 v59, v12, v11
    v_bitop3_b32 v63, v5, v13, v14 bitop3:0xea
    ds_add_u32 v63, v2
    v_cvt_pk_bf16_f32 v47, v9, v10
    v_perm_b32 v12, v47, v47, s41
    v_bitop3_b32 v58, v4, v12, v58 bitop3:0xca
    v_perm_b32 v13, v47, v47, s42
    v_bitop3_b32 v59, v4, v13, v59 bitop3:0xca
    v_lshrrev_b32 v8, 2, v0
    v_and_b32 v7, 0x3c00, v0
    v_bitop3_b32 v7, v5, v8, v7 bitop3:0xea
    s_waitcnt lgkmcnt(0)
    s_barrier
    ds_read2st64_b32 v[8:9], v7 offset0:0 offset1:1
    ds_read2st64_b32 v[10:11], v7 offset0:2 offset1:3
    s_add_u32 s45, s35, 0x4000
    s_add_u32 s45, s45, s91
    buffer_store_dwordx4 v[72:75], v0, s[20:23], s45 offen sc1
    s_add_u32 s46, s96, 0x4000000
    s_nop 0
    v_lshlrev_b32 v72, 1, v1
    buffer_load_dwordx4 v[72:75], v72, s[12:15], s46 offen nt
    s_waitcnt lgkmcnt(0)
    v_lshl_or_b32 v12, v9, 16, v8
    v_lshl_or_b32 v13, v11, 16, v10
    v_mov_b32 v14, v12
    v_mov_b32 v15, v13
    s_nop 0
    v_add_u32_dpp v14, v14, v14 row_shr:1 row_mask:0xf bank_mask:0xf bound_ctrl:1
    v_add_u32_dpp v15, v15, v15 row_shr:1 row_mask:0xf bank_mask:0xf bound_ctrl:1
    s_nop 0
    v_add_u32_dpp v14, v14, v14 row_shr:2 row_mask:0xf bank_mask:0xf bound_ctrl:1
    v_add_u32_dpp v15, v15, v15 row_shr:2 row_mask:0xf bank_mask:0xf bound_ctrl:1
    s_nop 0
    v_add_u32_dpp v14, v14, v14 row_shr:4 row_mask:0xf bank_mask:0xf bound_ctrl:1
    v_add_u32_dpp v15, v15, v15 row_shr:4 row_mask:0xf bank_mask:0xf bound_ctrl:1
    s_nop 0
    v_add_u32_dpp v14, v14, v14 row_shr:8 row_mask:0xf bank_mask:0xf bound_ctrl:1
    v_add_u32_dpp v15, v15, v15 row_shr:8 row_mask:0xf bank_mask:0xf bound_ctrl:1
    s_nop 0
    v_add_u32_dpp v14, v14, v14 row_bcast:15 row_mask:0xa bank_mask:0xf
    v_add_u32_dpp v15, v15, v15 row_bcast:15 row_mask:0xa bank_mask:0xf
    s_nop 0
    v_add_u32_dpp v14, v14, v14 row_bcast:31 row_mask:0xc bank_mask:0xf
    v_add_u32_dpp v15, v15, v15 row_bcast:31 row_mask:0xc bank_mask:0xf
    v_readlane_b32 s48, v14, 63
    v_readlane_b32 s49, v15, 63
    s_lshl_b32 s54, s32, 2
    v_mov_b32 v8, s54
    s_and_b32 s50, s48, 0xffff
    s_lshr_b32 s51, s48, 16
    s_and_b32 s52, s49, 0xffff
    s_lshr_b32 s53, s49, 16
    s_add_u32 s51, s51, s50
    s_add_u32 s52, s52, s51
    s_add_u32 s53, s53, s52
    v_mov_b32 v9, s53
    s_mov_b64 exec, 1
    ds_write_b32 v8, v9 offset:16384
    s_mov_b64 exec, -1
    v_and_b32 v8, 60, v7
    s_waitcnt lgkmcnt(0)
    s_barrier
    ds_read_b32 v9, v8 offset:16384
    s_waitcnt lgkmcnt(0)
    v_add_u32_dpp v9, v9, v9 row_shr:1 row_mask:0xf bank_mask:0xf bound_ctrl:1
    s_nop 1
    v_add_u32_dpp v9, v9, v9 row_shr:2 row_mask:0xf bank_mask:0xf bound_ctrl:1
    s_nop 1
    v_add_u32_dpp v9, v9, v9 row_shr:4 row_mask:0xf bank_mask:0xf bound_ctrl:1
    s_nop 1
    v_add_u32_dpp v9, v9, v9 row_shr:8 row_mask:0xf bank_mask:0xf bound_ctrl:1
    s_nop 0
    v_readlane_b32 s54, v9, s32
    s_sub_u32 s54, s54, s53
    s_add_u32 s50, s50, s54
    s_add_u32 s51, s51, s54
    s_add_u32 s52, s52, s54
    s_pack_ll_b32_b16 s48, s54, s50
    s_pack_ll_b32_b16 s49, s51, s52
    v_add_u32 v14, s48, v14
    v_add_u32 v15, s49, v15
    v_sub_u32 v12, v14, v12
    v_sub_u32 v13, v15, v13
    v_and_b32 v8, 0xffff, v12
    v_lshrrev_b32 v9, 16, v12
    v_and_b32 v10, 0xffff, v13
    v_lshrrev_b32 v11, 16, v13
    ds_write2st64_b32 v7, v8, v9 offset0:0 offset1:1
    ds_write2st64_b32 v7, v10, v11 offset0:2 offset1:3
    v_and_b32 v8, 0x3f0, v0
    v_lshl_add_u32 v8, v8, 1, s36
    ds_write_b64 v8, v[12:13] offset:20480
    s_bitset0_b64 exec, 63
    s_not_b64 exec, exec
    ds_write_b64 v8, v[14:15] offset:20512
    s_mov_b64 exec, -1
    s_waitcnt lgkmcnt(0)
    s_barrier
    s_setprio 3
    ds_add_rtn_u32 v104, v104, v2
    ds_add_rtn_u32 v105, v105, v2
    ds_add_rtn_u32 v106, v106, v2
    ds_add_rtn_u32 v107, v107, v2
    ds_read_b128 v[12:15], v0 offset:20480
    v_cmp_gt_u32 vcc, 8448, v0
    s_add_u32 s47, s35, 0x4000
    s_add_u32 s47, s47, s93
    buffer_store_dwordx4 v[64:67], v0, s[20:23], s47 offen sc1
    s_add_u32 s44, s96, 0x4000000
    s_lshr_b32 s44, s44, 1
    buffer_load_dwordx2 v[64:65], v1, s[16:19], s44 offen nt
    s_add_u32 s45, s97, 0x4400000
    s_lshr_b32 s45, s45, 1
    buffer_load_dwordx2 v[66:67], v1, s[16:19], s45 offen nt
    ds_add_rtn_u32 v112, v112, v2
    ds_add_rtn_u32 v113, v113, v2
    ds_add_rtn_u32 v114, v114, v2
    ds_add_rtn_u32 v115, v115, v2
    s_setprio 2
    ds_add_rtn_u32 v120, v120, v2
    ds_add_rtn_u32 v121, v121, v2
    ds_add_rtn_u32 v122, v122, v2
    ds_add_rtn_u32 v123, v123, v2
    s_waitcnt lgkmcnt(8)
    s_cbranch_vccz L1_p2
    s_add_u32 s46, s35, 0x2a40000
    s_mov_b64 exec, vcc
    buffer_store_dwordx4 v[12:15], v0, s[24:27], s46 offen sc1
    s_mov_b64 exec, -1
L1_p2:
    s_add_u32 s47, s35, 0x8000
    s_add_u32 s47, s47, s72
    buffer_store_dwordx4 v[76:79], v0, s[20:23], s47 offen sc1
    s_add_u32 s44, s97, 0x4400000
    s_nop 0
    v_lshlrev_b32 v76, 1, v1
    buffer_load_dwordx4 v[76:79], v76, s[8:11], s44 offen nt
    ds_add_rtn_u32 v20, v20, v2
    ds_add_rtn_u32 v21, v21, v2
    ds_add_rtn_u32 v22, v22, v2
    ds_add_rtn_u32 v23, v23, v2
    s_setprio 1
    ds_add_rtn_u32 v32, v32, v2
    ds_add_rtn_u32 v33, v33, v2
    ds_add_rtn_u32 v34, v34, v2
    ds_add_rtn_u32 v35, v35, v2
    ds_add_rtn_u32 v40, v40, v2
    ds_add_rtn_u32 v41, v41, v2
    ds_add_rtn_u32 v42, v42, v2
    ds_add_rtn_u32 v43, v43, v2
    s_add_u32 s45, s35, 0x8000
    s_add_u32 s45, s45, s73
    buffer_store_dwordx4 v[80:83], v0, s[20:23], s45 offen sc1
    s_add_u32 s46, s97, 0x4400000
    s_nop 0
    v_lshlrev_b32 v80, 1, v1
    buffer_load_dwordx4 v[80:83], v80, s[12:15], s46 offen nt
    s_setprio 0
    ds_add_rtn_u32 v52, v52, v2
    ds_add_rtn_u32 v53, v53, v2
    ds_add_rtn_u32 v54, v54, v2
    ds_add_rtn_u32 v55, v55, v2
    ds_add_rtn_u32 v60, v60, v2
    ds_add_rtn_u32 v61, v61, v2
    ds_add_rtn_u32 v62, v62, v2
    ds_add_rtn_u32 v63, v63, v2
    s_waitcnt lgkmcnt(0)
    s_barrier
    s_setprio 3
    v_and_b32 v7, -4, v104
    v_lshl_add_u32 v8, v104, 2, v7
    ds_write_b32 v8, v96
    v_lshl_add_u32 v7, v7, 2, v104
    ds_write_b8 v7, v108 offset:16
    v_and_b32 v9, -4, v105
    v_lshl_add_u32 v10, v105, 2, v9
    ds_write_b32 v10, v97
    v_lshl_add_u32 v9, v9, 2, v105
    ds_write_b8_d16_hi v9, v108 offset:16
    v_and_b32 v7, -4, v106
    v_lshl_add_u32 v8, v106, 2, v7
    ds_write_b32 v8, v98
    v_lshl_add_u32 v7, v7, 2, v106
    ds_write_b8 v7, v109 offset:16
    v_and_b32 v9, -4, v107
    v_lshl_add_u32 v10, v107, 2, v9
    ds_write_b32 v10, v99
    v_lshl_add_u32 v9, v9, 2, v107
    ds_write_b8_d16_hi v9, v109 offset:16
    s_add_u32 s47, s35, 0x8000
    s_add_u32 s47, s47, s85
    buffer_store_dwordx4 v[88:91], v0, s[20:23], s47 offen sc1
    s_add_u32 s44, s98, 0x4800000
    v_lshlrev_b32 v96, 1, v1
    buffer_load_dwordx4 v[96:99], v96, s[8:11], s44 offen nt
    s_add_u32 s45, s98, 0x4800000
    v_lshlrev_b32 v104, 1, v1
    buffer_load_dwordx4 v[104:107], v104, s[12:15], s45 offen nt
    v_and_b32 v7, -4, v112
    v_lshl_add_u32 v8, v112, 2, v7
    ds_write_b32 v8, v100
    v_lshl_add_u32 v7, v7, 2, v112
    ds_write_b8 v7, v110 offset:16
    v_and_b32 v9, -4, v113
    v_lshl_add_u32 v10, v113, 2, v9
    ds_write_b32 v10, v101
    v_lshl_add_u32 v9, v9, 2, v113
    ds_write_b8_d16_hi v9, v110 offset:16
    v_and_b32 v7, -4, v114
    v_lshl_add_u32 v8, v114, 2, v7
    ds_write_b32 v8, v102
    v_lshl_add_u32 v7, v7, 2, v114
    ds_write_b8 v7, v111 offset:16
    v_and_b32 v9, -4, v115
    v_lshl_add_u32 v10, v115, 2, v9
    ds_write_b32 v10, v103
    v_lshl_add_u32 v9, v9, 2, v115
    ds_write_b8_d16_hi v9, v111 offset:16
    s_add_u32 s46, s98, 0x4800000
    s_lshr_b32 s46, s46, 1
    buffer_load_dwordx2 v[88:89], v1, s[16:19], s46 offen nt
    s_add_u32 s47, s99, 0x4c00000
    s_lshr_b32 s47, s47, 1
    buffer_load_dwordx2 v[90:91], v1, s[16:19], s47 offen nt
    s_add_u32 s44, s99, 0x4c00000
    v_lshlrev_b32 v100, 1, v1
    buffer_load_dwordx4 v[100:103], v100, s[8:11], s44 offen nt
    s_waitcnt vmcnt(10)
    v_lshlrev_b32 v7, 16, v64
    v_and_b32 v8, 0xffff0000, v64
    v_lshlrev_b32 v9, 16, v65
    v_and_b32 v10, 0xffff0000, v65
    v_mul_f32 v7, 0.15915494, v7
    v_mul_f32 v8, 0.15915494, v8
    v_mul_f32 v9, 0.15915494, v9
    v_mul_f32 v10, 0.15915494, v10
    v_mul_hi_u32_u24 v14, 429497, v68
    v_lshrrev_b32 v12, 3, v72
    v_cos_f32 v7, v7
    v_lshlrev_b16 v13, 3, v72
    v_mad_i32_i24 v11, v14, s55, v68
    v_bitop3_b32 v12, v6, v13, v12 bitop3:0xca
    v_lshl_add_u32 v11, v11, 17, s40
    v_lshlrev_b16 v14, 8, v14
    v_lshrrev_b32 v13, 2, v72
    v_add_u32 v68, v12, v11
    v_bitop3_b32 v72, v5, v13, v14 bitop3:0xea
    v_mul_hi_u32_u24 v14, 429497, v69
    v_lshrrev_b32 v12, 3, v73
    v_cos_f32 v8, v8
    v_lshlrev_b16 v13, 3, v73
    v_mad_i32_i24 v11, v14, s55, v69
    v_bitop3_b32 v12, v6, v13, v12 bitop3:0xca
    v_lshl_add_u32 v11, v11, 17, s40
    v_lshlrev_b16 v14, 8, v14
    v_lshrrev_b32 v13, 2, v73
    v_add_u32 v69, v12, v11
    v_bitop3_b32 v73, v5, v13, v14 bitop3:0xea
    v_cvt_pk_bf16_f32 v64, v7, v8
    v_perm_b32 v12, v64, v64, s41
    v_bitop3_b32 v68, v4, v12, v68 bitop3:0xca
    v_perm_b32 v13, v64, v64, s42
    v_bitop3_b32 v69, v4, v13, v69 bitop3:0xca
    v_mul_hi_u32_u24 v14, 429497, v70
    v_lshrrev_b32 v12, 3, v74
    v_cos_f32 v9, v9
    v_lshlrev_b16 v13, 3, v74
    v_mad_i32_i24 v11, v14, s55, v70
    v_bitop3_b32 v12, v6, v13, v12 bitop3:0xca
    v_lshl_add_u32 v11, v11, 17, s40
    v_lshlrev_b16 v14, 8, v14
    v_lshrrev_b32 v13, 2, v74
    v_add_u32 v70, v12, v11
    v_bitop3_b32 v74, v5, v13, v14 bitop3:0xea
    v_mul_hi_u32_u24 v14, 429497, v71
    v_lshrrev_b32 v12, 3, v75
    v_cos_f32 v10, v10
    v_lshlrev_b16 v13, 3, v75
    v_mad_i32_i24 v11, v14, s55, v71
    v_bitop3_b32 v12, v6, v13, v12 bitop3:0xca
    v_lshl_add_u32 v11, v11, 17, s40
    v_lshlrev_b16 v14, 8, v14
    v_lshrrev_b32 v13, 2, v75
    v_add_u32 v71, v12, v11
    v_bitop3_b32 v75, v5, v13, v14 bitop3:0xea
    v_cvt_pk_bf16_f32 v65, v9, v10
    v_perm_b32 v12, v65, v65, s41
    v_bitop3_b32 v70, v4, v12, v70 bitop3:0xca
    v_perm_b32 v13, v65, v65, s42
    v_bitop3_b32 v71, v4, v13, v71 bitop3:0xca
    s_setprio 2
    v_and_b32 v7, -4, v120
    v_lshl_add_u32 v8, v120, 2, v7
    ds_write_b32 v8, v116
    v_lshl_add_u32 v7, v7, 2, v120
    ds_write_b8 v7, v124 offset:16
    v_and_b32 v9, -4, v121
    v_lshl_add_u32 v10, v121, 2, v9
    ds_write_b32 v10, v117
    v_lshl_add_u32 v9, v9, 2, v121
    ds_write_b8_d16_hi v9, v124 offset:16
    v_and_b32 v7, -4, v122
    v_lshl_add_u32 v8, v122, 2, v7
    ds_write_b32 v8, v118
    v_lshl_add_u32 v7, v7, 2, v122
    ds_write_b8 v7, v125 offset:16
    v_and_b32 v9, -4, v123
    v_lshl_add_u32 v10, v123, 2, v9
    ds_write_b32 v10, v119
    v_lshl_add_u32 v9, v9, 2, v123
    ds_write_b8_d16_hi v9, v125 offset:16
    s_add_u32 s45, s35, 0x8000
    s_add_u32 s45, s45, s91
    buffer_store_dwordx4 v[92:95], v0, s[20:23], s45 offen sc1
    s_add_u32 s46, s99, 0x4c00000
    v_lshlrev_b32 v112, 1, v1
    buffer_load_dwordx4 v[112:115], v112, s[12:15], s46 offen nt
    s_waitcnt vmcnt(8)
    v_lshlrev_b32 v7, 16, v66
    v_and_b32 v8, 0xffff0000, v66
    v_lshlrev_b32 v9, 16, v67
    v_and_b32 v10, 0xffff0000, v67
    v_mul_f32 v7, 0.15915494, v7
    v_mul_f32 v8, 0.15915494, v8
    v_mul_f32 v9, 0.15915494, v9
    v_mul_f32 v10, 0.15915494, v10
    v_mul_hi_u32_u24 v14, 429497, v76
    v_lshrrev_b32 v12, 3, v80
    v_cos_f32 v7, v7
    v_lshlrev_b16 v13, 3, v80
    v_mad_i32_i24 v11, v14, s55, v76
    v_bitop3_b32 v12, v6, v13, v12 bitop3:0xca
    v_lshl_add_u32 v11, v11, 17, s40
    v_lshlrev_b16 v14, 8, v14
    v_lshrrev_b32 v13, 2, v80
    v_add_u32 v76, v12, v11
    v_bitop3_b32 v80, v5, v13, v14 bitop3:0xea
    v_mul_hi_u32_u24 v14, 429497, v77
    v_lshrrev_b32 v12, 3, v81
    v_cos_f32 v8, v8
    v_lshlrev_b16 v13, 3, v81
    v_mad_i32_i24 v11, v14, s55, v77
    v_bitop3_b32 v12, v6, v13, v12 bitop3:0xca
    v_lshl_add_u32 v11, v11, 17, s40
    v_lshlrev_b16 v14, 8, v14
    v_lshrrev_b32 v13, 2, v81
    v_add_u32 v77, v12, v11
    v_bitop3_b32 v81, v5, v13, v14 bitop3:0xea
    v_cvt_pk_bf16_f32 v66, v7, v8
    v_perm_b32 v12, v66, v66, s41
    v_bitop3_b32 v76, v4, v12, v76 bitop3:0xca
    v_perm_b32 v13, v66, v66, s42
    v_bitop3_b32 v77, v4, v13, v77 bitop3:0xca
    v_mul_hi_u32_u24 v14, 429497, v78
    v_lshrrev_b32 v12, 3, v82
    v_cos_f32 v9, v9
    v_lshlrev_b16 v13, 3, v82
    v_mad_i32_i24 v11, v14, s55, v78
    v_bitop3_b32 v12, v6, v13, v12 bitop3:0xca
    v_lshl_add_u32 v11, v11, 17, s40
    v_lshlrev_b16 v14, 8, v14
    v_lshrrev_b32 v13, 2, v82
    v_add_u32 v78, v12, v11
    v_bitop3_b32 v82, v5, v13, v14 bitop3:0xea
    v_mul_hi_u32_u24 v14, 429497, v79
    v_lshrrev_b32 v12, 3, v83
    v_cos_f32 v10, v10
    v_lshlrev_b16 v13, 3, v83
    v_mad_i32_i24 v11, v14, s55, v79
    v_bitop3_b32 v12, v6, v13, v12 bitop3:0xca
    v_lshl_add_u32 v11, v11, 17, s40
    v_lshlrev_b16 v14, 8, v14
    v_lshrrev_b32 v13, 2, v83
    v_add_u32 v79, v12, v11
    v_bitop3_b32 v83, v5, v13, v14 bitop3:0xea
    v_cvt_pk_bf16_f32 v67, v9, v10
    v_perm_b32 v12, v67, v67, s41
    v_bitop3_b32 v78, v4, v12, v78 bitop3:0xca
    v_perm_b32 v13, v67, v67, s42
    v_bitop3_b32 v79, v4, v13, v79 bitop3:0xca
    v_and_b32 v7, -4, v20
    v_lshl_add_u32 v8, v20, 2, v7
    ds_write_b32 v8, v16
    v_lshl_add_u32 v7, v7, 2, v20
    ds_write_b8 v7, v126 offset:16
    v_and_b32 v9, -4, v21
    v_lshl_add_u32 v10, v21, 2, v9
    ds_write_b32 v10, v17
    v_lshl_add_u32 v9, v9, 2, v21
    ds_write_b8_d16_hi v9, v126 offset:16
    v_and_b32 v7, -4, v22
    v_lshl_add_u32 v8, v22, 2, v7
    ds_write_b32 v8, v18
    v_lshl_add_u32 v7, v7, 2, v22
    ds_write_b8 v7, v127 offset:16
    v_and_b32 v9, -4, v23
    v_lshl_add_u32 v10, v23, 2, v9
    ds_write_b32 v10, v19
    v_lshl_add_u32 v9, v9, 2, v23
    ds_write_b8_d16_hi v9, v127 offset:16
    s_add_u32 s47, s96, 0x5000000
    v_lshlrev_b32 v108, 1, v1
    buffer_load_dwordx4 v[108:111], v108, s[8:11], s47 offen nt
    s_add_u32 s44, s96, 0x5000000
    v_lshlrev_b32 v116, 1, v1
    buffer_load_dwordx4 v[116:119], v116, s[12:15], s44 offen nt
    s_waitcnt vmcnt(5)
    v_lshlrev_b32 v7, 16, v88
    v_and_b32 v8, 0xffff0000, v88
    v_lshlrev_b32 v9, 16, v89
    v_and_b32 v10, 0xffff0000, v89
    v_mul_f32 v7, 0.15915494, v7
    v_mul_f32 v8, 0.15915494, v8
    v_mul_f32 v9, 0.15915494, v9
    v_mul_f32 v10, 0.15915494, v10
    v_mul_hi_u32_u24 v14, 429497, v96
    v_lshrrev_b32 v12, 3, v104
    v_cos_f32 v7, v7
    v_lshlrev_b16 v13, 3, v104
    v_mad_i32_i24 v11, v14, s55, v96
    v_bitop3_b32 v12, v6, v13, v12 bitop3:0xca
    v_lshl_add_u32 v11, v11, 17, s40
    v_lshlrev_b16 v14, 8, v14
    v_lshrrev_b32 v13, 2, v104
    v_add_u32 v96, v12, v11
    v_bitop3_b32 v104, v5, v13, v14 bitop3:0xea
    v_mul_hi_u32_u24 v14, 429497, v97
    v_lshrrev_b32 v12, 3, v105
    v_cos_f32 v8, v8
    v_lshlrev_b16 v13, 3, v105
    v_mad_i32_i24 v11, v14, s55, v97
    v_bitop3_b32 v12, v6, v13, v12 bitop3:0xca
    v_lshl_add_u32 v11, v11, 17, s40
    v_lshlrev_b16 v14, 8, v14
    v_lshrrev_b32 v13, 2, v105
    v_add_u32 v97, v12, v11
    v_bitop3_b32 v105, v5, v13, v14 bitop3:0xea
    v_cvt_pk_bf16_f32 v88, v7, v8
    v_perm_b32 v12, v88, v88, s41
    v_bitop3_b32 v96, v4, v12, v96 bitop3:0xca
    v_perm_b32 v13, v88, v88, s42
    v_bitop3_b32 v97, v4, v13, v97 bitop3:0xca
    v_mul_hi_u32_u24 v14, 429497, v98
    v_lshrrev_b32 v12, 3, v106
    v_cos_f32 v9, v9
    v_lshlrev_b16 v13, 3, v106
    v_mad_i32_i24 v11, v14, s55, v98
    v_bitop3_b32 v12, v6, v13, v12 bitop3:0xca
    v_lshl_add_u32 v11, v11, 17, s40
    v_lshlrev_b16 v14, 8, v14
    v_lshrrev_b32 v13, 2, v106
    v_add_u32 v98, v12, v11
    v_bitop3_b32 v106, v5, v13, v14 bitop3:0xea
    v_mul_hi_u32_u24 v14, 429497, v99
    v_lshrrev_b32 v12, 3, v107
    v_cos_f32 v10, v10
    v_lshlrev_b16 v13, 3, v107
    v_mad_i32_i24 v11, v14, s55, v99
    v_bitop3_b32 v12, v6, v13, v12 bitop3:0xca
    v_lshl_add_u32 v11, v11, 17, s40
    v_lshlrev_b16 v14, 8, v14
    v_lshrrev_b32 v13, 2, v107
    v_add_u32 v99, v12, v11
    v_bitop3_b32 v107, v5, v13, v14 bitop3:0xea
    v_cvt_pk_bf16_f32 v89, v9, v10
    v_perm_b32 v12, v89, v89, s41
    v_bitop3_b32 v98, v4, v12, v98 bitop3:0xca
    v_perm_b32 v13, v89, v89, s42
    v_bitop3_b32 v99, v4, v13, v99 bitop3:0xca
    s_setprio 1
    v_and_b32 v7, -4, v32
    v_lshl_add_u32 v8, v32, 2, v7
    ds_write_b32 v8, v28
    v_lshl_add_u32 v7, v7, 2, v32
    ds_write_b8 v7, v24 offset:16
    v_and_b32 v9, -4, v33
    v_lshl_add_u32 v10, v33, 2, v9
    ds_write_b32 v10, v29
    v_lshl_add_u32 v9, v9, 2, v33
    ds_write_b8_d16_hi v9, v24 offset:16
    v_and_b32 v7, -4, v34
    v_lshl_add_u32 v8, v34, 2, v7
    ds_write_b32 v8, v30
    v_lshl_add_u32 v7, v7, 2, v34
    ds_write_b8 v7, v25 offset:16
    v_and_b32 v9, -4, v35
    v_lshl_add_u32 v10, v35, 2, v9
    ds_write_b32 v10, v31
    v_lshl_add_u32 v9, v9, 2, v35
    ds_write_b8_d16_hi v9, v25 offset:16
    s_add_u32 s45, s96, 0x5000000
    s_lshr_b32 s45, s45, 1
    buffer_load_dwordx2 v[120:121], v1, s[16:19], s45 offen nt
    s_add_u32 s46, s97, 0x5400000
    s_lshr_b32 s46, s46, 1
    buffer_load_dwordx2 v[122:123], v1, s[16:19], s46 offen nt
    s_add_u32 s47, s97, 0x5400000
    v_lshlrev_b32 v92, 1, v1
    buffer_load_dwordx4 v[92:95], v92, s[8:11], s47 offen nt
    v_and_b32 v7, -4, v40
    v_lshl_add_u32 v8, v40, 2, v7
    ds_write_b32 v8, v36
    v_lshl_add_u32 v7, v7, 2, v40
    ds_write_b8 v7, v26 offset:16
    v_and_b32 v9, -4, v41
    v_lshl_add_u32 v10, v41, 2, v9
    ds_write_b32 v10, v37
    v_lshl_add_u32 v9, v9, 2, v41
    ds_write_b8_d16_hi v9, v26 offset:16
    v_and_b32 v7, -4, v42
    v_lshl_add_u32 v8, v42, 2, v7
    ds_write_b32 v8, v38
    v_lshl_add_u32 v7, v7, 2, v42
    ds_write_b8 v7, v27 offset:16
    v_and_b32 v9, -4, v43
    v_lshl_add_u32 v10, v43, 2, v9
    ds_write_b32 v10, v39
    v_lshl_add_u32 v9, v9, 2, v43
    ds_write_b8_d16_hi v9, v27 offset:16
    s_add_u32 s44, s35, 0x8000
    s_add_u32 s44, s44, s93
    buffer_store_dwordx4 v[84:87], v0, s[20:23], s44 offen sc1
    s_add_u32 s45, s97, 0x5400000
    v_lshlrev_b32 v16, 1, v1
    buffer_load_dwordx4 v[16:19], v16, s[12:15], s45 offen nt
    s_waitcnt vmcnt(7)
    v_lshlrev_b32 v7, 16, v90
    v_and_b32 v8, 0xffff0000, v90
    v_lshlrev_b32 v9, 16, v91
    v_and_b32 v10, 0xffff0000, v91
    v_mul_f32 v7, 0.15915494, v7
    v_mul_f32 v8, 0.15915494, v8
    v_mul_f32 v9, 0.15915494, v9
    v_mul_f32 v10, 0.15915494, v10
    v_mul_hi_u32_u24 v14, 429497, v100
    v_lshrrev_b32 v12, 3, v112
    v_cos_f32 v7, v7
    v_lshlrev_b16 v13, 3, v112
    v_mad_i32_i24 v11, v14, s55, v100
    v_bitop3_b32 v12, v6, v13, v12 bitop3:0xca
    v_lshl_add_u32 v11, v11, 17, s40
    v_lshlrev_b16 v14, 8, v14
    v_lshrrev_b32 v13, 2, v112
    v_add_u32 v100, v12, v11
    v_bitop3_b32 v112, v5, v13, v14 bitop3:0xea
    v_mul_hi_u32_u24 v14, 429497, v101
    v_lshrrev_b32 v12, 3, v113
    v_cos_f32 v8, v8
    v_lshlrev_b16 v13, 3, v113
    v_mad_i32_i24 v11, v14, s55, v101
    v_bitop3_b32 v12, v6, v13, v12 bitop3:0xca
    v_lshl_add_u32 v11, v11, 17, s40
    v_lshlrev_b16 v14, 8, v14
    v_lshrrev_b32 v13, 2, v113
    v_add_u32 v101, v12, v11
    v_bitop3_b32 v113, v5, v13, v14 bitop3:0xea
    v_cvt_pk_bf16_f32 v90, v7, v8
    v_perm_b32 v12, v90, v90, s41
    v_bitop3_b32 v100, v4, v12, v100 bitop3:0xca
    v_perm_b32 v13, v90, v90, s42
    v_bitop3_b32 v101, v4, v13, v101 bitop3:0xca
    v_mul_hi_u32_u24 v14, 429497, v102
    v_lshrrev_b32 v12, 3, v114
    v_cos_f32 v9, v9
    v_lshlrev_b16 v13, 3, v114
    v_mad_i32_i24 v11, v14, s55, v102
    v_bitop3_b32 v12, v6, v13, v12 bitop3:0xca
    v_lshl_add_u32 v11, v11, 17, s40
    v_lshlrev_b16 v14, 8, v14
    v_lshrrev_b32 v13, 2, v114
    v_add_u32 v102, v12, v11
    v_bitop3_b32 v114, v5, v13, v14 bitop3:0xea
    v_mul_hi_u32_u24 v14, 429497, v103
    v_lshrrev_b32 v12, 3, v115
    v_cos_f32 v10, v10
    v_lshlrev_b16 v13, 3, v115
    v_mad_i32_i24 v11, v14, s55, v103
    v_bitop3_b32 v12, v6, v13, v12 bitop3:0xca
    v_lshl_add_u32 v11, v11, 17, s40
    v_lshlrev_b16 v14, 8, v14
    v_lshrrev_b32 v13, 2, v115
    v_add_u32 v103, v12, v11
    v_bitop3_b32 v115, v5, v13, v14 bitop3:0xea
    v_cvt_pk_bf16_f32 v91, v9, v10
    v_perm_b32 v12, v91, v91, s41
    v_bitop3_b32 v102, v4, v12, v102 bitop3:0xca
    v_perm_b32 v13, v91, v91, s42
    v_bitop3_b32 v103, v4, v13, v103 bitop3:0xca
    s_setprio 0
    v_and_b32 v7, -4, v52
    v_lshl_add_u32 v8, v52, 2, v7
    ds_write_b32 v8, v48
    v_lshl_add_u32 v7, v7, 2, v52
    ds_write_b8 v7, v44 offset:16
    v_and_b32 v9, -4, v53
    v_lshl_add_u32 v10, v53, 2, v9
    ds_write_b32 v10, v49
    v_lshl_add_u32 v9, v9, 2, v53
    ds_write_b8_d16_hi v9, v44 offset:16
    v_and_b32 v7, -4, v54
    v_lshl_add_u32 v8, v54, 2, v7
    ds_write_b32 v8, v50
    v_lshl_add_u32 v7, v7, 2, v54
    ds_write_b8 v7, v45 offset:16
    v_and_b32 v9, -4, v55
    v_lshl_add_u32 v10, v55, 2, v9
    ds_write_b32 v10, v51
    v_lshl_add_u32 v9, v9, 2, v55
    ds_write_b8_d16_hi v9, v45 offset:16
    s_add_u32 s46, s98, 0x5800000
    v_lshlrev_b32 v20, 1, v1
    buffer_load_dwordx4 v[20:23], v20, s[8:11], s46 offen nt
    s_add_u32 s47, s98, 0x5800000
    v_lshlrev_b32 v124, 1, v1
    buffer_load_dwordx4 v[124:127], v124, s[12:15], s47 offen nt
    s_waitcnt vmcnt(5)
    v_lshlrev_b32 v7, 16, v120
    v_and_b32 v8, 0xffff0000, v120
    v_lshlrev_b32 v9, 16, v121
    v_and_b32 v10, 0xffff0000, v121
    v_mul_f32 v7, 0.15915494, v7
    v_mul_f32 v8, 0.15915494, v8
    v_mul_f32 v9, 0.15915494, v9
    v_mul_f32 v10, 0.15915494, v10
    v_mul_hi_u32_u24 v14, 429497, v108
    v_lshrrev_b32 v12, 3, v116
    v_cos_f32 v7, v7
    v_lshlrev_b16 v13, 3, v116
    v_mad_i32_i24 v11, v14, s55, v108
    v_bitop3_b32 v12, v6, v13, v12 bitop3:0xca
    v_lshl_add_u32 v11, v11, 17, s40
    v_lshlrev_b16 v14, 8, v14
    v_lshrrev_b32 v13, 2, v116
    v_add_u32 v108, v12, v11
    v_bitop3_b32 v116, v5, v13, v14 bitop3:0xea
    v_mul_hi_u32_u24 v14, 429497, v109
    v_lshrrev_b32 v12, 3, v117
    v_cos_f32 v8, v8
    v_lshlrev_b16 v13, 3, v117
    v_mad_i32_i24 v11, v14, s55, v109
    v_bitop3_b32 v12, v6, v13, v12 bitop3:0xca
    v_lshl_add_u32 v11, v11, 17, s40
    v_lshlrev_b16 v14, 8, v14
    v_lshrrev_b32 v13, 2, v117
    v_add_u32 v109, v12, v11
    v_bitop3_b32 v117, v5, v13, v14 bitop3:0xea
    v_cvt_pk_bf16_f32 v120, v7, v8
    v_perm_b32 v12, v120, v120, s41
    v_bitop3_b32 v108, v4, v12, v108 bitop3:0xca
    v_perm_b32 v13, v120, v120, s42
    v_bitop3_b32 v109, v4, v13, v109 bitop3:0xca
    v_mul_hi_u32_u24 v14, 429497, v110
    v_lshrrev_b32 v12, 3, v118
    v_cos_f32 v9, v9
    v_lshlrev_b16 v13, 3, v118
    v_mad_i32_i24 v11, v14, s55, v110
    v_bitop3_b32 v12, v6, v13, v12 bitop3:0xca
    v_lshl_add_u32 v11, v11, 17, s40
    v_lshlrev_b16 v14, 8, v14
    v_lshrrev_b32 v13, 2, v118
    v_add_u32 v110, v12, v11
    v_bitop3_b32 v118, v5, v13, v14 bitop3:0xea
    v_mul_hi_u32_u24 v14, 429497, v111
    v_lshrrev_b32 v12, 3, v119
    v_cos_f32 v10, v10
    v_lshlrev_b16 v13, 3, v119
    v_mad_i32_i24 v11, v14, s55, v111
    v_bitop3_b32 v12, v6, v13, v12 bitop3:0xca
    v_lshl_add_u32 v11, v11, 17, s40
    v_lshlrev_b16 v14, 8, v14
    v_lshrrev_b32 v13, 2, v119
    v_add_u32 v111, v12, v11
    v_bitop3_b32 v119, v5, v13, v14 bitop3:0xea
    v_cvt_pk_bf16_f32 v121, v9, v10
    v_perm_b32 v12, v121, v121, s41
    v_bitop3_b32 v110, v4, v12, v110 bitop3:0xca
    v_perm_b32 v13, v121, v121, s42
    v_bitop3_b32 v111, v4, v13, v111 bitop3:0xca
    v_and_b32 v7, -4, v60
    v_lshl_add_u32 v8, v60, 2, v7
    ds_write_b32 v8, v56
    v_lshl_add_u32 v7, v7, 2, v60
    ds_write_b8 v7, v46 offset:16
    v_and_b32 v9, -4, v61
    v_lshl_add_u32 v10, v61, 2, v9
    ds_write_b32 v10, v57
    v_lshl_add_u32 v9, v9, 2, v61
    ds_write_b8_d16_hi v9, v46 offset:16
    v_and_b32 v7, -4, v62
    v_lshl_add_u32 v8, v62, 2, v7
    ds_write_b32 v8, v58
    v_lshl_add_u32 v7, v7, 2, v62
    ds_write_b8 v7, v47 offset:16
    v_and_b32 v9, -4, v63
    v_lshl_add_u32 v10, v63, 2, v9
    ds_write_b32 v10, v59
    v_lshl_add_u32 v9, v9, 2, v63
    ds_write_b8_d16_hi v9, v47 offset:16
    s_add_u32 s44, s98, 0x5800000
    s_lshr_b32 s44, s44, 1
    buffer_load_dwordx2 v[28:29], v1, s[16:19], s44 offen nt
    s_add_u32 s45, s99, 0x5c00000
    s_lshr_b32 s45, s45, 1
    buffer_load_dwordx2 v[30:31], v1, s[16:19], s45 offen nt
    s_waitcnt vmcnt(4)
    v_lshlrev_b32 v7, 16, v122
    v_and_b32 v8, 0xffff0000, v122
    v_lshlrev_b32 v9, 16, v123
    v_and_b32 v10, 0xffff0000, v123
    v_mul_f32 v7, 0.15915494, v7
    v_mul_f32 v8, 0.15915494, v8
    v_mul_f32 v9, 0.15915494, v9
    v_mul_f32 v10, 0.15915494, v10
    v_mul_hi_u32_u24 v14, 429497, v92
    v_lshrrev_b32 v12, 3, v16
    v_cos_f32 v7, v7
    v_lshlrev_b16 v13, 3, v16
    v_mad_i32_i24 v11, v14, s55, v92
    v_bitop3_b32 v12, v6, v13, v12 bitop3:0xca
    v_lshl_add_u32 v11, v11, 17, s40
    v_lshlrev_b16 v14, 8, v14
    v_lshrrev_b32 v13, 2, v16
    v_add_u32 v92, v12, v11
    v_bitop3_b32 v16, v5, v13, v14 bitop3:0xea
    v_mul_hi_u32_u24 v14, 429497, v93
    v_lshrrev_b32 v12, 3, v17
    v_cos_f32 v8, v8
    v_lshlrev_b16 v13, 3, v17
    v_mad_i32_i24 v11, v14, s55, v93
    v_bitop3_b32 v12, v6, v13, v12 bitop3:0xca
    v_lshl_add_u32 v11, v11, 17, s40
    v_lshlrev_b16 v14, 8, v14
    v_lshrrev_b32 v13, 2, v17
    v_add_u32 v93, v12, v11
    v_bitop3_b32 v17, v5, v13, v14 bitop3:0xea
    v_cvt_pk_bf16_f32 v122, v7, v8
    v_perm_b32 v12, v122, v122, s41
    v_bitop3_b32 v92, v4, v12, v92 bitop3:0xca
    v_perm_b32 v13, v122, v122, s42
    v_bitop3_b32 v93, v4, v13, v93 bitop3:0xca
    v_mul_hi_u32_u24 v14, 429497, v94
    v_lshrrev_b32 v12, 3, v18
    v_cos_f32 v9, v9
    v_lshlrev_b16 v13, 3, v18
    v_mad_i32_i24 v11, v14, s55, v94
    v_bitop3_b32 v12, v6, v13, v12 bitop3:0xca
    v_lshl_add_u32 v11, v11, 17, s40
    v_lshlrev_b16 v14, 8, v14
    v_lshrrev_b32 v13, 2, v18
    v_add_u32 v94, v12, v11
    v_bitop3_b32 v18, v5, v13, v14 bitop3:0xea
    v_mul_hi_u32_u24 v14, 429497, v95
    v_lshrrev_b32 v12, 3, v19
    v_cos_f32 v10, v10
    v_lshlrev_b16 v13, 3, v19
    v_mad_i32_i24 v11, v14, s55, v95
    v_bitop3_b32 v12, v6, v13, v12 bitop3:0xca
    v_lshl_add_u32 v11, v11, 17, s40
    v_lshlrev_b16 v14, 8, v14
    v_lshrrev_b32 v13, 2, v19
    v_add_u32 v95, v12, v11
    v_bitop3_b32 v19, v5, v13, v14 bitop3:0xea
    v_cvt_pk_bf16_f32 v123, v9, v10
    v_perm_b32 v12, v123, v123, s41
    v_bitop3_b32 v94, v4, v12, v94 bitop3:0xca
    v_perm_b32 v13, v123, v123, s42
    v_bitop3_b32 v95, v4, v13, v95 bitop3:0xca
    v_add_u32 v7, s72, v0
    v_add_u32 v12, s73, v0
    v_add_u32 v13, s85, v0
    v_add_u32 v14, s91, v0
    v_add_u32 v15, s93, v0
    s_min_i32 s3, s72, s73
    s_min_i32 s3, s3, s85
    s_min_i32 s3, s3, s91
    s_min_i32 s3, s3, s93
    v_add_u32 v3, s3, v0
    v_mov_b32 v8, 0
    v_mov_b32 v9, 0
    v_mov_b32 v10, 0
    v_mov_b32 v11, 0
    s_waitcnt lgkmcnt(0)
    s_barrier
    ds_read_b128 v[32:35], v7 offset:0
    ds_read_b128 v[36:39], v12 offset:0
    ds_read_b128 v[40:43], v13 offset:0
    ds_read_b128 v[24:27], v14 offset:0
    ds_read_b128 v[84:87], v15 offset:0
    ds_write_b128 v3, v[8:11]
    ds_read_b128 v[48:51], v7 offset:16384
    ds_read_b128 v[52:55], v12 offset:16384
    ds_read_b128 v[56:59], v13 offset:16384
    ds_read_b128 v[60:63], v14 offset:16384
    ds_read_b128 v[44:47], v15 offset:16384
    s_waitcnt lgkmcnt(0)
    s_barrier
    s_setprio 3
    s_add_u32 s46, s35, 0x2a44000
    s_add_u32 s46, s46, s72
    buffer_store_dwordx4 v[32:35], v0, s[20:23], s46 offen sc1
    s_add_u32 s47, s99, 0x5c00000
    s_nop 0
    v_lshlrev_b32 v32, 1, v1
    buffer_load_dwordx4 v[32:35], v32, s[8:11], s47 offen nt
    s_add_u32 s44, s35, 0x2a44000
    s_add_u32 s44, s44, s73
    buffer_store_dwordx4 v[36:39], v0, s[20:23], s44 offen sc1
    s_add_u32 s45, s99, 0x5c00000
    s_nop 0
    v_lshlrev_b32 v36, 1, v1
    buffer_load_dwordx4 v[36:39], v36, s[12:15], s45 offen nt
    ds_add_u32 v72, v2
    ds_add_u32 v73, v2
    ds_add_u32 v74, v2
    ds_add_u32 v75, v2
    ds_add_u32 v80, v2
    ds_add_u32 v81, v2
    ds_add_u32 v82, v2
    ds_add_u32 v83, v2
    s_setprio 2
    ds_add_u32 v104, v2
    ds_add_u32 v105, v2
    ds_add_u32 v106, v2
    ds_add_u32 v107, v2
    ds_add_u32 v112, v2
    ds_add_u32 v113, v2
    ds_add_u32 v114, v2
    ds_add_u32 v115, v2
    s_setprio 1
    s_add_u32 s46, s35, 0x2a44000
    s_add_u32 s46, s46, s85
    buffer_store_dwordx4 v[40:43], v0, s[20:23], s46 offen sc1
    s_add_u32 s47, s96, 0x6000000
    s_nop 0
    v_lshlrev_b32 v40, 1, v1
    buffer_load_dwordx4 v[40:43], v40, s[8:11], s47 offen nt
    ds_add_u32 v116, v2
    ds_add_u32 v117, v2
    ds_add_u32 v118, v2
    ds_add_u32 v119, v2
    ds_add_u32 v16, v2
    ds_add_u32 v17, v2
    ds_add_u32 v18, v2
    ds_add_u32 v19, v2
    s_setprio 0
    s_waitcnt vmcnt(6)
    v_lshlrev_b32 v7, 16, v28
    v_and_b32 v8, 0xffff0000, v28
    v_lshlrev_b32 v9, 16, v29
    v_and_b32 v10, 0xffff0000, v29
    v_mul_f32 v7, 0.15915494, v7
    v_mul_f32 v8, 0.15915494, v8
    v_mul_f32 v9, 0.15915494, v9
    v_mul_f32 v10, 0.15915494, v10
    v_mul_hi_u32_u24 v14, 429497, v20
    v_lshrrev_b32 v12, 3, v124
    v_cos_f32 v7, v7
    v_lshlrev_b16 v13, 3, v124
    v_mad_i32_i24 v11, v14, s55, v20
    v_bitop3_b32 v12, v6, v13, v12 bitop3:0xca
    v_lshl_add_u32 v11, v11, 17, s40
    v_lshlrev_b16 v14, 8, v14
    v_lshrrev_b32 v13, 2, v124
    v_add_u32 v20, v12, v11
    v_bitop3_b32 v124, v5, v13, v14 bitop3:0xea
    ds_add_u32 v124, v2
    v_mul_hi_u32_u24 v14, 429497, v21
    v_lshrrev_b32 v12, 3, v125
    v_cos_f32 v8, v8
    v_lshlrev_b16 v13, 3, v125
    v_mad_i32_i24 v11, v14, s55, v21
    v_bitop3_b32 v12, v6, v13, v12 bitop3:0xca
    v_lshl_add_u32 v11, v11, 17, s40
    v_lshlrev_b16 v14, 8, v14
    v_lshrrev_b32 v13, 2, v125
    v_add_u32 v21, v12, v11
    v_bitop3_b32 v125, v5, v13, v14 bitop3:0xea
    ds_add_u32 v125, v2
    v_cvt_pk_bf16_f32 v28, v7, v8
    v_perm_b32 v12, v28, v28, s41
    v_bitop3_b32 v20, v4, v12, v20 bitop3:0xca
    v_perm_b32 v13, v28, v28, s42
    v_bitop3_b32 v21, v4, v13, v21 bitop3:0xca
    v_mul_hi_u32_u24 v14, 429497, v22
    v_lshrrev_b32 v12, 3, v126
    v_cos_f32 v9, v9
    v_lshlrev_b16 v13, 3, v126
    v_mad_i32_i24 v11, v14, s55, v22
    v_bitop3_b32 v12, v6, v13, v12 bitop3:0xca
    v_lshl_add_u32 v11, v11, 17, s40
    v_lshlrev_b16 v14, 8, v14
    v_lshrrev_b32 v13, 2, v126
    v_add_u32 v22, v12, v11
    v_bitop3_b32 v126, v5, v13, v14 bitop3:0xea
    ds_add_u32 v126, v2
    v_mul_hi_u32_u24 v14, 429497, v23
    v_lshrrev_b32 v12, 3, v127
    v_cos_f32 v10, v10
    v_lshlrev_b16 v13, 3, v127
    v_mad_i32_i24 v11, v14, s55, v23
    v_bitop3_b32 v12, v6, v13, v12 bitop3:0xca
    v_lshl_add_u32 v11, v11, 17, s40
    v_lshlrev_b16 v14, 8, v14
    v_lshrrev_b32 v13, 2, v127
    v_add_u32 v23, v12, v11
    v_bitop3_b32 v127, v5, v13, v14 bitop3:0xea
    ds_add_u32 v127, v2
    v_cvt_pk_bf16_f32 v29, v9, v10
    v_perm_b32 v12, v29, v29, s41
    v_bitop3_b32 v22, v4, v12, v22 bitop3:0xca
    v_perm_b32 v13, v29, v29, s42
    v_bitop3_b32 v23, v4, v13, v23 bitop3:0xca
    s_waitcnt vmcnt(2)
    v_lshlrev_b32 v7, 16, v30
    v_and_b32 v8, 0xffff0000, v30
    v_lshlrev_b32 v9, 16, v31
    v_and_b32 v10, 0xffff0000, v31
    v_mul_f32 v7, 0.15915494, v7
    v_mul_f32 v8, 0.15915494, v8
    v_mul_f32 v9, 0.15915494, v9
    v_mul_f32 v10, 0.15915494, v10
    v_mul_hi_u32_u24 v14, 429497, v32
    v_lshrrev_b32 v12, 3, v36
    v_cos_f32 v7, v7
    v_lshlrev_b16 v13, 3, v36
    v_mad_i32_i24 v11, v14, s55, v32
    v_bitop3_b32 v12, v6, v13, v12 bitop3:0xca
    v_lshl_add_u32 v11, v11, 17, s40
    v_lshlrev_b16 v14, 8, v14
    v_lshrrev_b32 v13, 2, v36
    v_add_u32 v32, v12, v11
    v_bitop3_b32 v36, v5, v13, v14 bitop3:0xea
    ds_add_u32 v36, v2
    v_mul_hi_u32_u24 v14, 429497, v33
    v_lshrrev_b32 v12, 3, v37
    v_cos_f32 v8, v8
    v_lshlrev_b16 v13, 3, v37
    v_mad_i32_i24 v11, v14, s55, v33
    v_bitop3_b32 v12, v6, v13, v12 bitop3:0xca
    v_lshl_add_u32 v11, v11, 17, s40
    v_lshlrev_b16 v14, 8, v14
    v_lshrrev_b32 v13, 2, v37
    v_add_u32 v33, v12, v11
    v_bitop3_b32 v37, v5, v13, v14 bitop3:0xea
    ds_add_u32 v37, v2
    v_cvt_pk_bf16_f32 v30, v7, v8
    v_perm_b32 v12, v30, v30, s41
    v_bitop3_b32 v32, v4, v12, v32 bitop3:0xca
    v_perm_b32 v13, v30, v30, s42
    v_bitop3_b32 v33, v4, v13, v33 bitop3:0xca
    v_mul_hi_u32_u24 v14, 429497, v34
    v_lshrrev_b32 v12, 3, v38
    v_cos_f32 v9, v9
    v_lshlrev_b16 v13, 3, v38
    v_mad_i32_i24 v11, v14, s55, v34
    v_bitop3_b32 v12, v6, v13, v12 bitop3:0xca
    v_lshl_add_u32 v11, v11, 17, s40
    v_lshlrev_b16 v14, 8, v14
    v_lshrrev_b32 v13, 2, v38
    v_add_u32 v34, v12, v11
    v_bitop3_b32 v38, v5, v13, v14 bitop3:0xea
    ds_add_u32 v38, v2
    v_mul_hi_u32_u24 v14, 429497, v35
    v_lshrrev_b32 v12, 3, v39
    v_cos_f32 v10, v10
    v_lshlrev_b16 v13, 3, v39
    v_mad_i32_i24 v11, v14, s55, v35
    v_bitop3_b32 v12, v6, v13, v12 bitop3:0xca
    v_lshl_add_u32 v11, v11, 17, s40
    v_lshlrev_b16 v14, 8, v14
    v_lshrrev_b32 v13, 2, v39
    v_add_u32 v35, v12, v11
    v_bitop3_b32 v39, v5, v13, v14 bitop3:0xea
    ds_add_u32 v39, v2
    v_cvt_pk_bf16_f32 v31, v9, v10
    v_perm_b32 v12, v31, v31, s41
    v_bitop3_b32 v34, v4, v12, v34 bitop3:0xca
    v_perm_b32 v13, v31, v31, s42
    v_bitop3_b32 v35, v4, v13, v35 bitop3:0xca
    v_lshrrev_b32 v8, 2, v0
    v_and_b32 v7, 0x3c00, v0
    v_bitop3_b32 v7, v5, v8, v7 bitop3:0xea
    s_waitcnt lgkmcnt(0)
    s_barrier
    ds_read2st64_b32 v[8:9], v7 offset0:0 offset1:1
    ds_read2st64_b32 v[10:11], v7 offset0:2 offset1:3
    s_add_u32 s44, s35, 0x2a44000
    s_add_u32 s44, s44, s91
    buffer_store_dwordx4 v[24:27], v0, s[20:23], s44 offen sc1
    s_add_u32 s45, s96, 0x6000000
    s_nop 0
    v_lshlrev_b32 v24, 1, v1
    buffer_load_dwordx4 v[24:27], v24, s[12:15], s45 offen nt
    s_waitcnt lgkmcnt(0)
    v_lshl_or_b32 v12, v9, 16, v8
    v_lshl_or_b32 v13, v11, 16, v10
    v_mov_b32 v14, v12
    v_mov_b32 v15, v13
    s_nop 0
    v_add_u32_dpp v14, v14, v14 row_shr:1 row_mask:0xf bank_mask:0xf bound_ctrl:1
    v_add_u32_dpp v15, v15, v15 row_shr:1 row_mask:0xf bank_mask:0xf bound_ctrl:1
    s_nop 0
    v_add_u32_dpp v14, v14, v14 row_shr:2 row_mask:0xf bank_mask:0xf bound_ctrl:1
    v_add_u32_dpp v15, v15, v15 row_shr:2 row_mask:0xf bank_mask:0xf bound_ctrl:1
    s_nop 0
    v_add_u32_dpp v14, v14, v14 row_shr:4 row_mask:0xf bank_mask:0xf bound_ctrl:1
    v_add_u32_dpp v15, v15, v15 row_shr:4 row_mask:0xf bank_mask:0xf bound_ctrl:1
    s_nop 0
    v_add_u32_dpp v14, v14, v14 row_shr:8 row_mask:0xf bank_mask:0xf bound_ctrl:1
    v_add_u32_dpp v15, v15, v15 row_shr:8 row_mask:0xf bank_mask:0xf bound_ctrl:1
    s_nop 0
    v_add_u32_dpp v14, v14, v14 row_bcast:15 row_mask:0xa bank_mask:0xf
    v_add_u32_dpp v15, v15, v15 row_bcast:15 row_mask:0xa bank_mask:0xf
    s_nop 0
    v_add_u32_dpp v14, v14, v14 row_bcast:31 row_mask:0xc bank_mask:0xf
    v_add_u32_dpp v15, v15, v15 row_bcast:31 row_mask:0xc bank_mask:0xf
    v_readlane_b32 s48, v14, 63
    v_readlane_b32 s49, v15, 63
    s_lshl_b32 s54, s32, 2
    v_mov_b32 v8, s54
    s_and_b32 s50, s48, 0xffff
    s_lshr_b32 s51, s48, 16
    s_and_b32 s52, s49, 0xffff
    s_lshr_b32 s53, s49, 16
    s_add_u32 s51, s51, s50
    s_add_u32 s52, s52, s51
    s_add_u32 s53, s53, s52
    v_mov_b32 v9, s53
    s_mov_b64 exec, 1
    ds_write_b32 v8, v9 offset:16384
    s_mov_b64 exec, -1
    v_and_b32 v8, 60, v7
    s_waitcnt lgkmcnt(0)
    s_barrier
    ds_read_b32 v9, v8 offset:16384
    s_waitcnt lgkmcnt(0)
    v_add_u32_dpp v9, v9, v9 row_shr:1 row_mask:0xf bank_mask:0xf bound_ctrl:1
    s_nop 1
    v_add_u32_dpp v9, v9, v9 row_shr:2 row_mask:0xf bank_mask:0xf bound_ctrl:1
    s_nop 1
    v_add_u32_dpp v9, v9, v9 row_shr:4 row_mask:0xf bank_mask:0xf bound_ctrl:1
    s_nop 1
    v_add_u32_dpp v9, v9, v9 row_shr:8 row_mask:0xf bank_mask:0xf bound_ctrl:1
    s_nop 0
    v_readlane_b32 s54, v9, s32
    s_sub_u32 s54, s54, s53
    s_add_u32 s50, s50, s54
    s_add_u32 s51, s51, s54
    s_add_u32 s52, s52, s54
    s_pack_ll_b32_b16 s48, s54, s50
    s_pack_ll_b32_b16 s49, s51, s52
    v_add_u32 v14, s48, v14
    v_add_u32 v15, s49, v15
    v_sub_u32 v12, v14, v12
    v_sub_u32 v13, v15, v13
    v_and_b32 v8, 0xffff, v12
    v_lshrrev_b32 v9, 16, v12
    v_and_b32 v10, 0xffff, v13
    v_lshrrev_b32 v11, 16, v13
    ds_write2st64_b32 v7, v8, v9 offset0:0 offset1:1
    ds_write2st64_b32 v7, v10, v11 offset0:2 offset1:3
    v_and_b32 v8, 0x3f0, v0
    v_lshl_add_u32 v8, v8, 1, s36
    ds_write_b64 v8, v[12:13] offset:20480
    s_bitset0_b64 exec, 63
    s_not_b64 exec, exec
    ds_write_b64 v8, v[14:15] offset:20512
    s_mov_b64 exec, -1
    s_waitcnt lgkmcnt(0)
    s_barrier
    s_setprio 3
    ds_add_rtn_u32 v72, v72, v2
    ds_add_rtn_u32 v73, v73, v2
    ds_add_rtn_u32 v74, v74, v2
    ds_add_rtn_u32 v75, v75, v2
    ds_read_b128 v[12:15], v0 offset:20480
    v_cmp_gt_u32 vcc, 8448, v0
    s_add_u32 s46, s35, 0x2a44000
    s_add_u32 s46, s46, s93
    buffer_store_dwordx4 v[84:87], v0, s[20:23], s46 offen sc1
    s_add_u32 s47, s96, 0x6000000
    s_lshr_b32 s47, s47, 1
    buffer_load_dwordx2 v[84:85], v1, s[16:19], s47 offen nt
    s_add_u32 s44, s97, 0x6400000
    s_lshr_b32 s44, s44, 1
    buffer_load_dwordx2 v[86:87], v1, s[16:19], s44 offen nt
    ds_add_rtn_u32 v80, v80, v2
    ds_add_rtn_u32 v81, v81, v2
    ds_add_rtn_u32 v82, v82, v2
    ds_add_rtn_u32 v83, v83, v2
    s_setprio 2
    ds_add_rtn_u32 v104, v104, v2
    ds_add_rtn_u32 v105, v105, v2
    ds_add_rtn_u32 v106, v106, v2
    ds_add_rtn_u32 v107, v107, v2
    s_waitcnt lgkmcnt(8)
    s_cbranch_vccz L1_p3
    s_add_u32 s45, s35, 0x5480000
    s_mov_b64 exec, vcc
    buffer_store_dwordx4 v[12:15], v0, s[24:27], s45 offen sc1
    s_mov_b64 exec, -1
L1_p3:
    s_add_u32 s46, s35, 0x2a48000
    s_add_u32 s46, s46, s72
    buffer_store_dwordx4 v[48:51], v0, s[20:23], s46 offen sc1
    s_add_u32 s47, s97, 0x6400000
    s_nop 0
    v_lshlrev_b32 v48, 1, v1
    buffer_load_dwordx4 v[48:51], v48, s[8:11], s47 offen nt
    ds_add_rtn_u32 v112, v112, v2
    ds_add_rtn_u32 v113, v113, v2
    ds_add_rtn_u32 v114, v114, v2
    ds_add_rtn_u32 v115, v115, v2
    s_setprio 1
    ds_add_rtn_u32 v116, v116, v2
    ds_add_rtn_u32 v117, v117, v2
    ds_add_rtn_u32 v118, v118, v2
    ds_add_rtn_u32 v119, v119, v2
    ds_add_rtn_u32 v16, v16, v2
    ds_add_rtn_u32 v17, v17, v2
    ds_add_rtn_u32 v18, v18, v2
    ds_add_rtn_u32 v19, v19, v2
    s_add_u32 s44, s35, 0x2a48000
    s_add_u32 s44, s44, s73
    buffer_store_dwordx4 v[52:55], v0, s[20:23], s44 offen sc1
    s_add_u32 s45, s97, 0x6400000
    s_nop 0
    v_lshlrev_b32 v52, 1, v1
    buffer_load_dwordx4 v[52:55], v52, s[12:15], s45 offen nt
    s_setprio 0
    ds_add_rtn_u32 v124, v124, v2
    ds_add_rtn_u32 v125, v125, v2
    ds_add_rtn_u32 v126, v126, v2
    ds_add_rtn_u32 v127, v127, v2
    ds_add_rtn_u32 v36, v36, v2
    ds_add_rtn_u32 v37, v37, v2
    ds_add_rtn_u32 v38, v38, v2
    ds_add_rtn_u32 v39, v39, v2
    s_waitcnt lgkmcnt(0)
    s_barrier
    s_setprio 3
    v_and_b32 v7, -4, v72
    v_lshl_add_u32 v8, v72, 2, v7
    ds_write_b32 v8, v68
    v_lshl_add_u32 v7, v7, 2, v72
    ds_write_b8 v7, v64 offset:16
    v_and_b32 v9, -4, v73
    v_lshl_add_u32 v10, v73, 2, v9
    ds_write_b32 v10, v69
    v_lshl_add_u32 v9, v9, 2, v73
    ds_write_b8_d16_hi v9, v64 offset:16
    v_and_b32 v7, -4, v74
    v_lshl_add_u32 v8, v74, 2, v7
    ds_write_b32 v8, v70
    v_lshl_add_u32 v7, v7, 2, v74
    ds_write_b8 v7, v65 offset:16
    v_and_b32 v9, -4, v75
    v_lshl_add_u32 v10, v75, 2, v9
    ds_write_b32 v10, v71
    v_lshl_add_u32 v9, v9, 2, v75
    ds_write_b8_d16_hi v9, v65 offset:16
    s_add_u32 s46, s35, 0x2a48000
    s_add_u32 s46, s46, s85
    buffer_store_dwordx4 v[56:59], v0, s[20:23], s46 offen sc1
    s_add_u32 s47, s98, 0x6800000
    v_lshlrev_b32 v68, 1, v1
    buffer_load_dwordx4 v[68:71], v68, s[8:11], s47 offen nt
    s_add_u32 s44, s98, 0x6800000
    v_lshlrev_b32 v72, 1, v1
    buffer_load_dwordx4 v[72:75], v72, s[12:15], s44 offen nt
    v_and_b32 v7, -4, v80
    v_lshl_add_u32 v8, v80, 2, v7
    ds_write_b32 v8, v76
    v_lshl_add_u32 v7, v7, 2, v80
    ds_write_b8 v7, v66 offset:16
    v_and_b32 v9, -4, v81
    v_lshl_add_u32 v10, v81, 2, v9
    ds_write_b32 v10, v77
    v_lshl_add_u32 v9, v9, 2, v81
    ds_write_b8_d16_hi v9, v66 offset:16
    v_and_b32 v7, -4, v82
    v_lshl_add_u32 v8, v82, 2, v7
    ds_write_b32 v8, v78
    v_lshl_add_u32 v7, v7, 2, v82
    ds_write_b8 v7, v67 offset:16
    v_and_b32 v9, -4, v83
    v_lshl_add_u32 v10, v83, 2, v9
    ds_write_b32 v10, v79
    v_lshl_add_u32 v9, v9, 2, v83
    ds_write_b8_d16_hi v9, v67 offset:16
    s_add_u32 s45, s98, 0x6800000
    s_lshr_b32 s45, s45, 1
    buffer_load_dwordx2 v[56:57], v1, s[16:19], s45 offen nt
    s_add_u32 s46, s99, 0x6c00000
    s_lshr_b32 s46, s46, 1
    buffer_load_dwordx2 v[58:59], v1, s[16:19], s46 offen nt
    s_add_u32 s47, s99, 0x6c00000
    v_lshlrev_b32 v76, 1, v1
    buffer_load_dwordx4 v[76:79], v76, s[8:11], s47 offen nt
    s_waitcnt vmcnt(10)
    v_lshlrev_b32 v7, 16, v84
    v_and_b32 v8, 0xffff0000, v84
    v_lshlrev_b32 v9, 16, v85
    v_and_b32 v10, 0xffff0000, v85
    v_mul_f32 v7, 0.15915494, v7
    v_mul_f32 v8, 0.15915494, v8
    v_mul_f32 v9, 0.15915494, v9
    v_mul_f32 v10, 0.15915494, v10
    v_mul_hi_u32_u24 v14, 429497, v40
    v_lshrrev_b32 v12, 3, v24
    v_cos_f32 v7, v7
    v_lshlrev_b16 v13, 3, v24
    v_mad_i32_i24 v11, v14, s55, v40
    v_bitop3_b32 v12, v6, v13, v12 bitop3:0xca
    v_lshl_add_u32 v11, v11, 17, s40
    v_lshlrev_b16 v14, 8, v14
    v_lshrrev_b32 v13, 2, v24
    v_add_u32 v40, v12, v11
    v_bitop3_b32 v24, v5, v13, v14 bitop3:0xea
    v_mul_hi_u32_u24 v14, 429497, v41
    v_lshrrev_b32 v12, 3, v25
    v_cos_f32 v8, v8
    v_lshlrev_b16 v13, 3, v25
    v_mad_i32_i24 v11, v14, s55, v41
    v_bitop3_b32 v12, v6, v13, v12 bitop3:0xca
    v_lshl_add_u32 v11, v11, 17, s40
    v_lshlrev_b16 v14, 8, v14
    v_lshrrev_b32 v13, 2, v25
    v_add_u32 v41, v12, v11
    v_bitop3_b32 v25, v5, v13, v14 bitop3:0xea
    v_cvt_pk_bf16_f32 v84, v7, v8
    v_perm_b32 v12, v84, v84, s41
    v_bitop3_b32 v40, v4, v12, v40 bitop3:0xca
    v_perm_b32 v13, v84, v84, s42
    v_bitop3_b32 v41, v4, v13, v41 bitop3:0xca
    v_mul_hi_u32_u24 v14, 429497, v42
    v_lshrrev_b32 v12, 3, v26
    v_cos_f32 v9, v9
    v_lshlrev_b16 v13, 3, v26
    v_mad_i32_i24 v11, v14, s55, v42
    v_bitop3_b32 v12, v6, v13, v12 bitop3:0xca
    v_lshl_add_u32 v11, v11, 17, s40
    v_lshlrev_b16 v14, 8, v14
    v_lshrrev_b32 v13, 2, v26
    v_add_u32 v42, v12, v11
    v_bitop3_b32 v26, v5, v13, v14 bitop3:0xea
    v_mul_hi_u32_u24 v14, 429497, v43
    v_lshrrev_b32 v12, 3, v27
    v_cos_f32 v10, v10
    v_lshlrev_b16 v13, 3, v27
    v_mad_i32_i24 v11, v14, s55, v43
    v_bitop3_b32 v12, v6, v13, v12 bitop3:0xca
    v_lshl_add_u32 v11, v11, 17, s40
    v_lshlrev_b16 v14, 8, v14
    v_lshrrev_b32 v13, 2, v27
    v_add_u32 v43, v12, v11
    v_bitop3_b32 v27, v5, v13, v14 bitop3:0xea
    v_cvt_pk_bf16_f32 v85, v9, v10
    v_perm_b32 v12, v85, v85, s41
    v_bitop3_b32 v42, v4, v12, v42 bitop3:0xca
    v_perm_b32 v13, v85, v85, s42
    v_bitop3_b32 v43, v4, v13, v43 bitop3:0xca
    s_setprio 2
    v_and_b32 v7, -4, v104
    v_lshl_add_u32 v8, v104, 2, v7
    ds_write_b32 v8, v96
    v_lshl_add_u32 v7, v7, 2, v104
    ds_write_b8 v7, v88 offset:16
    v_and_b32 v9, -4, v105
    v_lshl_add_u32 v10, v105, 2, v9
    ds_write_b32 v10, v97
    v_lshl_add_u32 v9, v9, 2, v105
    ds_write_b8_d16_hi v9, v88 offset:16
    v_and_b32 v7, -4, v106
    v_lshl_add_u32 v8, v106, 2, v7
    ds_write_b32 v8, v98
    v_lshl_add_u32 v7, v7, 2, v106
    ds_write_b8 v7, v89 offset:16
    v_and_b32 v9, -4, v107
    v_lshl_add_u32 v10, v107, 2, v9
    ds_write_b32 v10, v99
    v_lshl_add_u32 v9, v9, 2, v107
    ds_write_b8_d16_hi v9, v89 offset:16
    s_add_u32 s44, s35, 0x2a48000
    s_add_u32 s44, s44, s91
    buffer_store_dwordx4 v[60:63], v0, s[20:23], s44 offen sc1
    s_add_u32 s45, s99, 0x6c00000
    v_lshlrev_b32 v80, 1, v1
    buffer_load_dwordx4 v[80:83], v80, s[12:15], s45 offen nt
    s_waitcnt vmcnt(8)
    v_lshlrev_b32 v7, 16, v86
    v_and_b32 v8, 0xffff0000, v86
    v_lshlrev_b32 v9, 16, v87
    v_and_b32 v10, 0xffff0000, v87
    v_mul_f32 v7, 0.15915494, v7
    v_mul_f32 v8, 0.15915494, v8
    v_mul_f32 v9, 0.15915494, v9
    v_mul_f32 v10, 0.15915494, v10
    v_mul_hi_u32_u24 v14, 429497, v48
    v_lshrrev_b32 v12, 3, v52
    v_cos_f32 v7, v7
    v_lshlrev_b16 v13, 3, v52
    v_mad_i32_i24 v11, v14, s55, v48
    v_bitop3_b32 v12, v6, v13, v12 bitop3:0xca
    v_lshl_add_u32 v11, v11, 17, s40
    v_lshlrev_b16 v14, 8, v14
    v_lshrrev_b32 v13, 2, v52
    v_add_u32 v48, v12, v11
    v_bitop3_b32 v52, v5, v13, v14 bitop3:0xea
    v_mul_hi_u32_u24 v14, 429497, v49
    v_lshrrev_b32 v12, 3, v53
    v_cos_f32 v8, v8
    v_lshlrev_b16 v13, 3, v53
    v_mad_i32_i24 v11, v14, s55, v49
    v_bitop3_b32 v12, v6, v13, v12 bitop3:0xca
    v_lshl_add_u32 v11, v11, 17, s40
    v_lshlrev_b16 v14, 8, v14
    v_lshrrev_b32 v13, 2, v53
    v_add_u32 v49, v12, v11
    v_bitop3_b32 v53, v5, v13, v14 bitop3:0xea
    v_cvt_pk_bf16_f32 v86, v7, v8
    v_perm_b32 v12, v86, v86, s41
    v_bitop3_b32 v48, v4, v12, v48 bitop3:0xca
    v_perm_b32 v13, v86, v86, s42
    v_bitop3_b32 v49, v4, v13, v49 bitop3:0xca
    v_mul_hi_u32_u24 v14, 429497, v50
    v_lshrrev_b32 v12, 3, v54
    v_cos_f32 v9, v9
    v_lshlrev_b16 v13, 3, v54
    v_mad_i32_i24 v11, v14, s55, v50
    v_bitop3_b32 v12, v6, v13, v12 bitop3:0xca
    v_lshl_add_u32 v11, v11, 17, s40
    v_lshlrev_b16 v14, 8, v14
    v_lshrrev_b32 v13, 2, v54
    v_add_u32 v50, v12, v11
    v_bitop3_b32 v54, v5, v13, v14 bitop3:0xea
    v_mul_hi_u32_u24 v14, 429497, v51
    v_lshrrev_b32 v12, 3, v55
    v_cos_f32 v10, v10
    v_lshlrev_b16 v13, 3, v55
    v_mad_i32_i24 v11, v14, s55, v51
    v_bitop3_b32 v12, v6, v13, v12 bitop3:0xca
    v_lshl_add_u32 v11, v11, 17, s40
    v_lshlrev_b16 v14, 8, v14
    v_lshrrev_b32 v13, 2, v55
    v_add_u32 v51, v12, v11
    v_bitop3_b32 v55, v5, v13, v14 bitop3:0xea
    v_cvt_pk_bf16_f32 v87, v9, v10
    v_perm_b32 v12, v87, v87, s41
    v_bitop3_b32 v50, v4, v12, v50 bitop3:0xca
    v_perm_b32 v13, v87, v87, s42
    v_bitop3_b32 v51, v4, v13, v51 bitop3:0xca
    v_and_b32 v7, -4, v112
    v_lshl_add_u32 v8, v112, 2, v7
    ds_write_b32 v8, v100
    v_lshl_add_u32 v7, v7, 2, v112
    ds_write_b8 v7, v90 offset:16
    v_and_b32 v9, -4, v113
    v_lshl_add_u32 v10, v113, 2, v9
    ds_write_b32 v10, v101
    v_lshl_add_u32 v9, v9, 2, v113
    ds_write_b8_d16_hi v9, v90 offset:16
    v_and_b32 v7, -4, v114
    v_lshl_add_u32 v8, v114, 2, v7
    ds_write_b32 v8, v102
    v_lshl_add_u32 v7, v7, 2, v114
    ds_write_b8 v7, v91 offset:16
    v_and_b32 v9, -4, v115
    v_lshl_add_u32 v10, v115, 2, v9
    ds_write_b32 v10, v103
    v_lshl_add_u32 v9, v9, 2, v115
    ds_write_b8_d16_hi v9, v91 offset:16
    s_add_u32 s46, s96, 0x7000000
    v_lshlrev_b32 v64, 1, v1
    buffer_load_dwordx4 v[64:67], v64, s[8:11], s46 offen nt
    s_add_u32 s47, s96, 0x7000000
    v_lshlrev_b32 v96, 1, v1
    buffer_load_dwordx4 v[96:99], v96, s[12:15], s47 offen nt
    s_waitcnt vmcnt(5)
    v_lshlrev_b32 v7, 16, v56
    v_and_b32 v8, 0xffff0000, v56
    v_lshlrev_b32 v9, 16, v57
    v_and_b32 v10, 0xffff0000, v57
    v_mul_f32 v7, 0.15915494, v7
    v_mul_f32 v8, 0.15915494, v8
    v_mul_f32 v9, 0.15915494, v9
    v_mul_f32 v10, 0.15915494, v10
    v_mul_hi_u32_u24 v14, 429497, v68
    v_lshrrev_b32 v12, 3, v72
    v_cos_f32 v7, v7
    v_lshlrev_b16 v13, 3, v72
    v_mad_i32_i24 v11, v14, s55, v68
    v_bitop3_b32 v12, v6, v13, v12 bitop3:0xca
    v_lshl_add_u32 v11, v11, 17, s40
    v_lshlrev_b16 v14, 8, v14
    v_lshrrev_b32 v13, 2, v72
    v_add_u32 v68, v12, v11
    v_bitop3_b32 v72, v5, v13, v14 bitop3:0xea
    v_mul_hi_u32_u24 v14, 429497, v69
    v_lshrrev_b32 v12, 3, v73
    v_cos_f32 v8, v8
    v_lshlrev_b16 v13, 3, v73
    v_mad_i32_i24 v11, v14, s55, v69
    v_bitop3_b32 v12, v6, v13, v12 bitop3:0xca
    v_lshl_add_u32 v11, v11, 17, s40
    v_lshlrev_b16 v14, 8, v14
    v_lshrrev_b32 v13, 2, v73
    v_add_u32 v69, v12, v11
    v_bitop3_b32 v73, v5, v13, v14 bitop3:0xea
    v_cvt_pk_bf16_f32 v56, v7, v8
    v_perm_b32 v12, v56, v56, s41
    v_bitop3_b32 v68, v4, v12, v68 bitop3:0xca
    v_perm_b32 v13, v56, v56, s42
    v_bitop3_b32 v69, v4, v13, v69 bitop3:0xca
    v_mul_hi_u32_u24 v14, 429497, v70
    v_lshrrev_b32 v12, 3, v74
    v_cos_f32 v9, v9
    v_lshlrev_b16 v13, 3, v74
    v_mad_i32_i24 v11, v14, s55, v70
    v_bitop3_b32 v12, v6, v13, v12 bitop3:0xca
    v_lshl_add_u32 v11, v11, 17, s40
    v_lshlrev_b16 v14, 8, v14
    v_lshrrev_b32 v13, 2, v74
    v_add_u32 v70, v12, v11
    v_bitop3_b32 v74, v5, v13, v14 bitop3:0xea
    v_mul_hi_u32_u24 v14, 429497, v71
    v_lshrrev_b32 v12, 3, v75
    v_cos_f32 v10, v10
    v_lshlrev_b16 v13, 3, v75
    v_mad_i32_i24 v11, v14, s55, v71
    v_bitop3_b32 v12, v6, v13, v12 bitop3:0xca
    v_lshl_add_u32 v11, v11, 17, s40
    v_lshlrev_b16 v14, 8, v14
    v_lshrrev_b32 v13, 2, v75
    v_add_u32 v71, v12, v11
    v_bitop3_b32 v75, v5, v13, v14 bitop3:0xea
    v_cvt_pk_bf16_f32 v57, v9, v10
    v_perm_b32 v12, v57, v57, s41
    v_bitop3_b32 v70, v4, v12, v70 bitop3:0xca
    v_perm_b32 v13, v57, v57, s42
    v_bitop3_b32 v71, v4, v13, v71 bitop3:0xca
    s_setprio 1
    v_and_b32 v7, -4, v116
    v_lshl_add_u32 v8, v116, 2, v7
    ds_write_b32 v8, v108
    v_lshl_add_u32 v7, v7, 2, v116
    ds_write_b8 v7, v120 offset:16
    v_and_b32 v9, -4, v117
    v_lshl_add_u32 v10, v117, 2, v9
    ds_write_b32 v10, v109
    v_lshl_add_u32 v9, v9, 2, v117
    ds_write_b8_d16_hi v9, v120 offset:16
    v_and_b32 v7, -4, v118
    v_lshl_add_u32 v8, v118, 2, v7
    ds_write_b32 v8, v110
    v_lshl_add_u32 v7, v7, 2, v118
    ds_write_b8 v7, v121 offset:16
    v_and_b32 v9, -4, v119
    v_lshl_add_u32 v10, v119, 2, v9
    ds_write_b32 v10, v111
    v_lshl_add_u32 v9, v9, 2, v119
    ds_write_b8_d16_hi v9, v121 offset:16
    s_add_u32 s44, s96, 0x7000000
    s_lshr_b32 s44, s44, 1
    buffer_load_dwordx2 v[104:105], v1, s[16:19], s44 offen nt
    s_add_u32 s45, s97, 0x7400000
    s_lshr_b32 s45, s45, 1
    buffer_load_dwordx2 v[106:107], v1, s[16:19], s45 offen nt
    s_add_u32 s46, s97, 0x7400000
    v_lshlrev_b32 v60, 1, v1
    buffer_load_dwordx4 v[60:63], v60, s[8:11], s46 offen nt
    v_and_b32 v7, -4, v16
    v_lshl_add_u32 v8, v16, 2, v7
    ds_write_b32 v8, v92
    v_lshl_add_u32 v7, v7, 2, v16
    ds_write_b8 v7, v122 offset:16
    v_and_b32 v9, -4, v17
    v_lshl_add_u32 v10, v17, 2, v9
    ds_write_b32 v10, v93
    v_lshl_add_u32 v9, v9, 2, v17
    ds_write_b8_d16_hi v9, v122 offset:16
    v_and_b32 v7, -4, v18
    v_lshl_add_u32 v8, v18, 2, v7
    ds_write_b32 v8, v94
    v_lshl_add_u32 v7, v7, 2, v18
    ds_write_b8 v7, v123 offset:16
    v_and_b32 v9, -4, v19
    v_lshl_add_u32 v10, v19, 2, v9
    ds_write_b32 v10, v95
    v_lshl_add_u32 v9, v9, 2, v19
    ds_write_b8_d16_hi v9, v123 offset:16
    s_add_u32 s47, s35, 0x2a48000
    s_add_u32 s47, s47, s93
    buffer_store_dwordx4 v[44:47], v0, s[20:23], s47 offen sc1
    s_add_u32 s44, s97, 0x7400000
    v_lshlrev_b32 v100, 1, v1
    buffer_load_dwordx4 v[100:103], v100, s[12:15], s44 offen nt
    s_waitcnt vmcnt(7)
    v_lshlrev_b32 v7, 16, v58
    v_and_b32 v8, 0xffff0000, v58
    v_lshlrev_b32 v9, 16, v59
    v_and_b32 v10, 0xffff0000, v59
    v_mul_f32 v7, 0.15915494, v7
    v_mul_f32 v8, 0.15915494, v8
    v_mul_f32 v9, 0.15915494, v9
    v_mul_f32 v10, 0.15915494, v10
    v_mul_hi_u32_u24 v14, 429497, v76
    v_lshrrev_b32 v12, 3, v80
    v_cos_f32 v7, v7
    v_lshlrev_b16 v13, 3, v80
    v_mad_i32_i24 v11, v14, s55, v76
    v_bitop3_b32 v12, v6, v13, v12 bitop3:0xca
    v_lshl_add_u32 v11, v11, 17, s40
    v_lshlrev_b16 v14, 8, v14
    v_lshrrev_b32 v13, 2, v80
    v_add_u32 v76, v12, v11
    v_bitop3_b32 v80, v5, v13, v14 bitop3:0xea
    v_mul_hi_u32_u24 v14, 429497, v77
    v_lshrrev_b32 v12, 3, v81
    v_cos_f32 v8, v8
    v_lshlrev_b16 v13, 3, v81
    v_mad_i32_i24 v11, v14, s55, v77
    v_bitop3_b32 v12, v6, v13, v12 bitop3:0xca
    v_lshl_add_u32 v11, v11, 17, s40
    v_lshlrev_b16 v14, 8, v14
    v_lshrrev_b32 v13, 2, v81
    v_add_u32 v77, v12, v11
    v_bitop3_b32 v81, v5, v13, v14 bitop3:0xea
    v_cvt_pk_bf16_f32 v58, v7, v8
    v_perm_b32 v12, v58, v58, s41
    v_bitop3_b32 v76, v4, v12, v76 bitop3:0xca
    v_perm_b32 v13, v58, v58, s42
    v_bitop3_b32 v77, v4, v13, v77 bitop3:0xca
    v_mul_hi_u32_u24 v14, 429497, v78
    v_lshrrev_b32 v12, 3, v82
    v_cos_f32 v9, v9
    v_lshlrev_b16 v13, 3, v82
    v_mad_i32_i24 v11, v14, s55, v78
    v_bitop3_b32 v12, v6, v13, v12 bitop3:0xca
    v_lshl_add_u32 v11, v11, 17, s40
    v_lshlrev_b16 v14, 8, v14
    v_lshrrev_b32 v13, 2, v82
    v_add_u32 v78, v12, v11
    v_bitop3_b32 v82, v5, v13, v14 bitop3:0xea
    v_mul_hi_u32_u24 v14, 429497, v79
    v_lshrrev_b32 v12, 3, v83
    v_cos_f32 v10, v10
    v_lshlrev_b16 v13, 3, v83
    v_mad_i32_i24 v11, v14, s55, v79
    v_bitop3_b32 v12, v6, v13, v12 bitop3:0xca
    v_lshl_add_u32 v11, v11, 17, s40
    v_lshlrev_b16 v14, 8, v14
    v_lshrrev_b32 v13, 2, v83
    v_add_u32 v79, v12, v11
    v_bitop3_b32 v83, v5, v13, v14 bitop3:0xea
    v_cvt_pk_bf16_f32 v59, v9, v10
    v_perm_b32 v12, v59, v59, s41
    v_bitop3_b32 v78, v4, v12, v78 bitop3:0xca
    v_perm_b32 v13, v59, v59, s42
    v_bitop3_b32 v79, v4, v13, v79 bitop3:0xca
    s_setprio 0
    v_and_b32 v7, -4, v124
    v_lshl_add_u32 v8, v124, 2, v7
    ds_write_b32 v8, v20
    v_lshl_add_u32 v7, v7, 2, v124
    ds_write_b8 v7, v28 offset:16
    v_and_b32 v9, -4, v125
    v_lshl_add_u32 v10, v125, 2, v9
    ds_write_b32 v10, v21
    v_lshl_add_u32 v9, v9, 2, v125
    ds_write_b8_d16_hi v9, v28 offset:16
    v_and_b32 v7, -4, v126
    v_lshl_add_u32 v8, v126, 2, v7
    ds_write_b32 v8, v22
    v_lshl_add_u32 v7, v7, 2, v126
    ds_write_b8 v7, v29 offset:16
    v_and_b32 v9, -4, v127
    v_lshl_add_u32 v10, v127, 2, v9
    ds_write_b32 v10, v23
    v_lshl_add_u32 v9, v9, 2, v127
    ds_write_b8_d16_hi v9, v29 offset:16
    s_add_u32 s45, s98, 0x7800000
    v_lshlrev_b32 v112, 1, v1
    buffer_load_dwordx4 v[112:115], v112, s[8:11], s45 offen nt
    s_add_u32 s46, s98, 0x7800000
    v_lshlrev_b32 v88, 1, v1
    buffer_load_dwordx4 v[88:91], v88, s[12:15], s46 offen nt
    s_waitcnt vmcnt(5)
    v_lshlrev_b32 v7, 16, v104
    v_and_b32 v8, 0xffff0000, v104
    v_lshlrev_b32 v9, 16, v105
    v_and_b32 v10, 0xffff0000, v105
    v_mul_f32 v7, 0.15915494, v7
    v_mul_f32 v8, 0.15915494, v8
    v_mul_f32 v9, 0.15915494, v9
    v_mul_f32 v10, 0.15915494, v10
    v_mul_hi_u32_u24 v14, 429497, v64
    v_lshrrev_b32 v12, 3, v96
    v_cos_f32 v7, v7
    v_lshlrev_b16 v13, 3, v96
    v_mad_i32_i24 v11, v14, s55, v64
    v_bitop3_b32 v12, v6, v13, v12 bitop3:0xca
    v_lshl_add_u32 v11, v11, 17, s40
    v_lshlrev_b16 v14, 8, v14
    v_lshrrev_b32 v13, 2, v96
    v_add_u32 v64, v12, v11
    v_bitop3_b32 v96, v5, v13, v14 bitop3:0xea
    v_mul_hi_u32_u24 v14, 429497, v65
    v_lshrrev_b32 v12, 3, v97
    v_cos_f32 v8, v8
    v_lshlrev_b16 v13, 3, v97
    v_mad_i32_i24 v11, v14, s55, v65
    v_bitop3_b32 v12, v6, v13, v12 bitop3:0xca
    v_lshl_add_u32 v11, v11, 17, s40
    v_lshlrev_b16 v14, 8, v14
    v_lshrrev_b32 v13, 2, v97
    v_add_u32 v65, v12, v11
    v_bitop3_b32 v97, v5, v13, v14 bitop3:0xea
    v_cvt_pk_bf16_f32 v104, v7, v8
    v_perm_b32 v12, v104, v104, s41
    v_bitop3_b32 v64, v4, v12, v64 bitop3:0xca
    v_perm_b32 v13, v104, v104, s42
    v_bitop3_b32 v65, v4, v13, v65 bitop3:0xca
    v_mul_hi_u32_u24 v14, 429497, v66
    v_lshrrev_b32 v12, 3, v98
    v_cos_f32 v9, v9
    v_lshlrev_b16 v13, 3, v98
    v_mad_i32_i24 v11, v14, s55, v66
    v_bitop3_b32 v12, v6, v13, v12 bitop3:0xca
    v_lshl_add_u32 v11, v11, 17, s40
    v_lshlrev_b16 v14, 8, v14
    v_lshrrev_b32 v13, 2, v98
    v_add_u32 v66, v12, v11
    v_bitop3_b32 v98, v5, v13, v14 bitop3:0xea
    v_mul_hi_u32_u24 v14, 429497, v67
    v_lshrrev_b32 v12, 3, v99
    v_cos_f32 v10, v10
    v_lshlrev_b16 v13, 3, v99
    v_mad_i32_i24 v11, v14, s55, v67
    v_bitop3_b32 v12, v6, v13, v12 bitop3:0xca
    v_lshl_add_u32 v11, v11, 17, s40
    v_lshlrev_b16 v14, 8, v14
    v_lshrrev_b32 v13, 2, v99
    v_add_u32 v67, v12, v11
    v_bitop3_b32 v99, v5, v13, v14 bitop3:0xea
    v_cvt_pk_bf16_f32 v105, v9, v10
    v_perm_b32 v12, v105, v105, s41
    v_bitop3_b32 v66, v4, v12, v66 bitop3:0xca
    v_perm_b32 v13, v105, v105, s42
    v_bitop3_b32 v67, v4, v13, v67 bitop3:0xca
    v_and_b32 v7, -4, v36
    v_lshl_add_u32 v8, v36, 2, v7
    ds_write_b32 v8, v32
    v_lshl_add_u32 v7, v7, 2, v36
    ds_write_b8 v7, v30 offset:16
    v_and_b32 v9, -4, v37
    v_lshl_add_u32 v10, v37, 2, v9
    ds_write_b32 v10, v33
    v_lshl_add_u32 v9, v9, 2, v37
    ds_write_b8_d16_hi v9, v30 offset:16
    v_and_b32 v7, -4, v38
    v_lshl_add_u32 v8, v38, 2, v7
    ds_write_b32 v8, v34
    v_lshl_add_u32 v7, v7, 2, v38
    ds_write_b8 v7, v31 offset:16
    v_and_b32 v9, -4, v39
    v_lshl_add_u32 v10, v39, 2, v9
    ds_write_b32 v10, v35
    v_lshl_add_u32 v9, v9, 2, v39
    ds_write_b8_d16_hi v9, v31 offset:16
    s_add_u32 s47, s98, 0x7800000
    s_lshr_b32 s47, s47, 1
    buffer_load_dwordx2 v[108:109], v1, s[16:19], s47 offen nt
    s_add_u32 s44, s99, 0x7c00000
    s_lshr_b32 s44, s44, 1
    buffer_load_dwordx2 v[110:111], v1, s[16:19], s44 offen nt
    s_waitcnt vmcnt(4)
    v_lshlrev_b32 v7, 16, v106
    v_and_b32 v8, 0xffff0000, v106
    v_lshlrev_b32 v9, 16, v107
    v_and_b32 v10, 0xffff0000, v107
    v_mul_f32 v7, 0.15915494, v7
    v_mul_f32 v8, 0.15915494, v8
    v_mul_f32 v9, 0.15915494, v9
    v_mul_f32 v10, 0.15915494, v10
    v_mul_hi_u32_u24 v14, 429497, v60
    v_lshrrev_b32 v12, 3, v100
    v_cos_f32 v7, v7
    v_lshlrev_b16 v13, 3, v100
    v_mad_i32_i24 v11, v14, s55, v60
    v_bitop3_b32 v12, v6, v13, v12 bitop3:0xca
    v_lshl_add_u32 v11, v11, 17, s40
    v_lshlrev_b16 v14, 8, v14
    v_lshrrev_b32 v13, 2, v100
    v_add_u32 v60, v12, v11
    v_bitop3_b32 v100, v5, v13, v14 bitop3:0xea
    v_mul_hi_u32_u24 v14, 429497, v61
    v_lshrrev_b32 v12, 3, v101
    v_cos_f32 v8, v8
    v_lshlrev_b16 v13, 3, v101
    v_mad_i32_i24 v11, v14, s55, v61
    v_bitop3_b32 v12, v6, v13, v12 bitop3:0xca
    v_lshl_add_u32 v11, v11, 17, s40
    v_lshlrev_b16 v14, 8, v14
    v_lshrrev_b32 v13, 2, v101
    v_add_u32 v61, v12, v11
    v_bitop3_b32 v101, v5, v13, v14 bitop3:0xea
    v_cvt_pk_bf16_f32 v106, v7, v8
    v_perm_b32 v12, v106, v106, s41
    v_bitop3_b32 v60, v4, v12, v60 bitop3:0xca
    v_perm_b32 v13, v106, v106, s42
    v_bitop3_b32 v61, v4, v13, v61 bitop3:0xca
    v_mul_hi_u32_u24 v14, 429497, v62
    v_lshrrev_b32 v12, 3, v102
    v_cos_f32 v9, v9
    v_lshlrev_b16 v13, 3, v102
    v_mad_i32_i24 v11, v14, s55, v62
    v_bitop3_b32 v12, v6, v13, v12 bitop3:0xca
    v_lshl_add_u32 v11, v11, 17, s40
    v_lshlrev_b16 v14, 8, v14
    v_lshrrev_b32 v13, 2, v102
    v_add_u32 v62, v12, v11
    v_bitop3_b32 v102, v5, v13, v14 bitop3:0xea
    v_mul_hi_u32_u24 v14, 429497, v63
    v_lshrrev_b32 v12, 3, v103
    v_cos_f32 v10, v10
    v_lshlrev_b16 v13, 3, v103
    v_mad_i32_i24 v11, v14, s55, v63
    v_bitop3_b32 v12, v6, v13, v12 bitop3:0xca
    v_lshl_add_u32 v11, v11, 17, s40
    v_lshlrev_b16 v14, 8, v14
    v_lshrrev_b32 v13, 2, v103
    v_add_u32 v63, v12, v11
    v_bitop3_b32 v103, v5, v13, v14 bitop3:0xea
    v_cvt_pk_bf16_f32 v107, v9, v10
    v_perm_b32 v12, v107, v107, s41
    v_bitop3_b32 v62, v4, v12, v62 bitop3:0xca
    v_perm_b32 v13, v107, v107, s42
    v_bitop3_b32 v63, v4, v13, v63 bitop3:0xca
    v_add_u32 v7, s72, v0
    v_add_u32 v12, s73, v0
    v_add_u32 v13, s85, v0
    v_add_u32 v14, s91, v0
    v_add_u32 v15, s93, v0
    s_min_i32 s3, s72, s73
    s_min_i32 s3, s3, s85
    s_min_i32 s3, s3, s91
    s_min_i32 s3, s3, s93
    v_add_u32 v3, s3, v0
    v_mov_b32 v8, 0
    v_mov_b32 v9, 0
    v_mov_b32 v10, 0
    v_mov_b32 v11, 0
    s_waitcnt lgkmcnt(0)
    s_barrier
    ds_read_b128 v[116:119], v7 offset:0
    ds_read_b128 v[92:95], v12 offset:0
    ds_read_b128 v[16:19], v13 offset:0
    ds_read_b128 v[120:123], v14 offset:0
    ds_read_b128 v[44:47], v15 offset:0
    ds_write_b128 v3, v[8:11]
    ds_read_b128 v[20:23], v7 offset:16384
    ds_read_b128 v[124:127], v12 offset:16384
    ds_read_b128 v[32:35], v13 offset:16384
    ds_read_b128 v[36:39], v14 offset:16384
    ds_read_b128 v[28:31], v15 offset:16384
    s_waitcnt lgkmcnt(0)
    s_barrier
    s_setprio 3
    s_add_u32 s45, s35, 0x5484000
    s_add_u32 s45, s45, s72
    buffer_store_dwordx4 v[116:119], v0, s[20:23], s45 offen sc1
    s_add_u32 s46, s99, 0x7c00000
    s_nop 0
    v_lshlrev_b32 v116, 1, v1
    buffer_load_dwordx4 v[116:119], v116, s[8:11], s46 offen nt
    s_add_u32 s47, s35, 0x5484000
    s_add_u32 s47, s47, s73
    buffer_store_dwordx4 v[92:95], v0, s[20:23], s47 offen sc1
    s_add_u32 s44, s99, 0x7c00000
    s_nop 0
    v_lshlrev_b32 v92, 1, v1
    buffer_load_dwordx4 v[92:95], v92, s[12:15], s44 offen nt
    ds_add_u32 v24, v2
    ds_add_u32 v25, v2
    ds_add_u32 v26, v2
    ds_add_u32 v27, v2
    ds_add_u32 v52, v2
    ds_add_u32 v53, v2
    ds_add_u32 v54, v2
    ds_add_u32 v55, v2
    s_setprio 2
    ds_add_u32 v72, v2
    ds_add_u32 v73, v2
    ds_add_u32 v74, v2
    ds_add_u32 v75, v2
    ds_add_u32 v80, v2
    ds_add_u32 v81, v2
    ds_add_u32 v82, v2
    ds_add_u32 v83, v2
    s_setprio 1
    s_add_u32 s45, s35, 0x5484000
    s_add_u32 s45, s45, s85
    buffer_store_dwordx4 v[16:19], v0, s[20:23], s45 offen sc1
    s_add_u32 s46, s96, 0x8000000
    s_nop 0
    v_lshlrev_b32 v16, 1, v1
    buffer_load_dwordx4 v[16:19], v16, s[8:11], s46 offen nt
    ds_add_u32 v96, v2
    ds_add_u32 v97, v2
    ds_add_u32 v98, v2
    ds_add_u32 v99, v2
    s_mov_b32 s68, s66
    s_mov_b32 s69, s67
    s_mov_b32 s70, 0x100
    s_mov_b32 s71, 0x20000
    v_mov_b32 v3, 1
    s_cmp_lg_u32 s32, 15
    s_cbranch_scc1 L1_tk
    s_mov_b64 exec, 1
    s_and_b32 s3, s2, 1
    s_lshl_b32 s3, s3, 7
    buffer_atomic_add v3, off, s[68:71], s3 sc0
    s_mov_b64 exec, -1
L1_tk:
    ds_add_u32 v100, v2
    ds_add_u32 v101, v2
    ds_add_u32 v102, v2
    ds_add_u32 v103, v2
    s_setprio 0
    s_waitcnt vmcnt(6)
    v_lshlrev_b32 v7, 16, v108
    v_and_b32 v8, 0xffff0000, v108
    v_lshlrev_b32 v9, 16, v109
    v_and_b32 v10, 0xffff0000, v109
    v_mul_f32 v7, 0.15915494, v7
    v_mul_f32 v8, 0.15915494, v8
    v_mul_f32 v9, 0.15915494, v9
    v_mul_f32 v10, 0.15915494, v10
    v_mul_hi_u32_u24 v14, 429497, v112
    v_lshrrev_b32 v12, 3, v88
    v_cos_f32 v7, v7
    v_lshlrev_b16 v13, 3, v88
    v_mad_i32_i24 v11, v14, s55, v112
    v_bitop3_b32 v12, v6, v13, v12 bitop3:0xca
    v_lshl_add_u32 v11, v11, 17, s40
    v_lshlrev_b16 v14, 8, v14
    v_lshrrev_b32 v13, 2, v88
    v_add_u32 v112, v12, v11
    v_bitop3_b32 v88, v5, v13, v14 bitop3:0xea
    ds_add_u32 v88, v2
    v_mul_hi_u32_u24 v14, 429497, v113
    v_lshrrev_b32 v12, 3, v89
    v_cos_f32 v8, v8
    v_lshlrev_b16 v13, 3, v89
    v_mad_i32_i24 v11, v14, s55, v113
    v_bitop3_b32 v12, v6, v13, v12 bitop3:0xca
    v_lshl_add_u32 v11, v11, 17, s40
    v_lshlrev_b16 v14, 8, v14
    v_lshrrev_b32 v13, 2, v89
    v_add_u32 v113, v12, v11
    v_bitop3_b32 v89, v5, v13, v14 bitop3:0xea
    ds_add_u32 v89, v2
    v_cvt_pk_bf16_f32 v108, v7, v8
    v_perm_b32 v12, v108, v108, s41
    v_bitop3_b32 v112, v4, v12, v112 bitop3:0xca
    v_perm_b32 v13, v108, v108, s42
    v_bitop3_b32 v113, v4, v13, v113 bitop3:0xca
    v_mul_hi_u32_u24 v14, 429497, v114
    v_lshrrev_b32 v12, 3, v90
    v_cos_f32 v9, v9
    v_lshlrev_b16 v13, 3, v90
    v_mad_i32_i24 v11, v14, s55, v114
    v_bitop3_b32 v12, v6, v13, v12 bitop3:0xca
    v_lshl_add_u32 v11, v11, 17, s40
    v_lshlrev_b16 v14, 8, v14
    v_lshrrev_b32 v13, 2, v90
    v_add_u32 v114, v12, v11
    v_bitop3_b32 v90, v5, v13, v14 bitop3:0xea
    ds_add_u32 v90, v2
    v_mul_hi_u32_u24 v14, 429497, v115
    v_lshrrev_b32 v12, 3, v91
    v_cos_f32 v10, v10
    v_lshlrev_b16 v13, 3, v91
    v_mad_i32_i24 v11, v14, s55, v115
    v_bitop3_b32 v12, v6, v13, v12 bitop3:0xca
    v_lshl_add_u32 v11, v11, 17, s40
    v_lshlrev_b16 v14, 8, v14
    v_lshrrev_b32 v13, 2, v91
    v_add_u32 v115, v12, v11
    v_bitop3_b32 v91, v5, v13, v14 bitop3:0xea
    ds_add_u32 v91, v2
    v_cvt_pk_bf16_f32 v109, v9, v10
    v_perm_b32 v12, v109, v109, s41
    v_bitop3_b32 v114, v4, v12, v114 bitop3:0xca
    v_perm_b32 v13, v109, v109, s42
    v_bitop3_b32 v115, v4, v13, v115 bitop3:0xca
    s_waitcnt vmcnt(2)
    v_lshlrev_b32 v7, 16, v110
    v_and_b32 v8, 0xffff0000, v110
    v_lshlrev_b32 v9, 16, v111
    v_and_b32 v10, 0xffff0000, v111
    v_mul_f32 v7, 0.15915494, v7
    v_mul_f32 v8, 0.15915494, v8
    v_mul_f32 v9, 0.15915494, v9
    v_mul_f32 v10, 0.15915494, v10
    v_mul_hi_u32_u24 v14, 429497, v116
    v_lshrrev_b32 v12, 3, v92
    v_cos_f32 v7, v7
    v_lshlrev_b16 v13, 3, v92
    v_mad_i32_i24 v11, v14, s55, v116
    v_bitop3_b32 v12, v6, v13, v12 bitop3:0xca
    v_lshl_add_u32 v11, v11, 17, s40
    v_lshlrev_b16 v14, 8, v14
    v_lshrrev_b32 v13, 2, v92
    v_add_u32 v116, v12, v11
    v_bitop3_b32 v92, v5, v13, v14 bitop3:0xea
    ds_add_u32 v92, v2
    v_mul_hi_u32_u24 v14, 429497, v117
    v_lshrrev_b32 v12, 3, v93
    v_cos_f32 v8, v8
    v_lshlrev_b16 v13, 3, v93
    v_mad_i32_i24 v11, v14, s55, v117
    v_bitop3_b32 v12, v6, v13, v12 bitop3:0xca
    v_lshl_add_u32 v11, v11, 17, s40
    v_lshlrev_b16 v14, 8, v14
    v_lshrrev_b32 v13, 2, v93
    v_add_u32 v117, v12, v11
    v_bitop3_b32 v93, v5, v13, v14 bitop3:0xea
    ds_add_u32 v93, v2
    v_cvt_pk_bf16_f32 v110, v7, v8
    v_perm_b32 v12, v110, v110, s41
    v_bitop3_b32 v116, v4, v12, v116 bitop3:0xca
    v_perm_b32 v13, v110, v110, s42
    v_bitop3_b32 v117, v4, v13, v117 bitop3:0xca
    v_mul_hi_u32_u24 v14, 429497, v118
    v_lshrrev_b32 v12, 3, v94
    v_cos_f32 v9, v9
    v_lshlrev_b16 v13, 3, v94
    v_mad_i32_i24 v11, v14, s55, v118
    v_bitop3_b32 v12, v6, v13, v12 bitop3:0xca
    v_lshl_add_u32 v11, v11, 17, s40
    v_lshlrev_b16 v14, 8, v14
    v_lshrrev_b32 v13, 2, v94
    v_add_u32 v118, v12, v11
    v_bitop3_b32 v94, v5, v13, v14 bitop3:0xea
    ds_add_u32 v94, v2
    v_mul_hi_u32_u24 v14, 429497, v119
    v_lshrrev_b32 v12, 3, v95
    v_cos_f32 v10, v10
    v_lshlrev_b16 v13, 3, v95
    v_mad_i32_i24 v11, v14, s55, v119
    v_bitop3_b32 v12, v6, v13, v12 bitop3:0xca
    v_lshl_add_u32 v11, v11, 17, s40
    v_lshlrev_b16 v14, 8, v14
    v_lshrrev_b32 v13, 2, v95
    v_add_u32 v119, v12, v11
    v_bitop3_b32 v95, v5, v13, v14 bitop3:0xea
    ds_add_u32 v95, v2
    v_cvt_pk_bf16_f32 v111, v9, v10
    v_perm_b32 v12, v111, v111, s41
    v_bitop3_b32 v118, v4, v12, v118 bitop3:0xca
    v_perm_b32 v13, v111, v111, s42
    v_bitop3_b32 v119, v4, v13, v119 bitop3:0xca
    v_lshrrev_b32 v8, 2, v0
    v_and_b32 v7, 0x3c00, v0
    v_bitop3_b32 v7, v5, v8, v7 bitop3:0xea
    s_waitcnt lgkmcnt(0)
    s_barrier
    ds_read2st64_b32 v[8:9], v7 offset0:0 offset1:1
    ds_read2st64_b32 v[10:11], v7 offset0:2 offset1:3
    s_add_u32 s47, s35, 0x5484000
    s_add_u32 s47, s47, s91
    buffer_store_dwordx4 v[120:123], v0, s[20:23], s47 offen sc1
    s_add_u32 s44, s96, 0x8000000
    s_nop 0
    v_lshlrev_b32 v120, 1, v1
    buffer_load_dwordx4 v[120:123], v120, s[12:15], s44 offen nt
    s_waitcnt lgkmcnt(0)
    v_lshl_or_b32 v12, v9, 16, v8
    v_lshl_or_b32 v13, v11, 16, v10
    v_mov_b32 v14, v12
    v_mov_b32 v15, v13
    s_nop 0
    v_add_u32_dpp v14, v14, v14 row_shr:1 row_mask:0xf bank_mask:0xf bound_ctrl:1
    v_add_u32_dpp v15, v15, v15 row_shr:1 row_mask:0xf bank_mask:0xf bound_ctrl:1
    s_nop 0
    v_add_u32_dpp v14, v14, v14 row_shr:2 row_mask:0xf bank_mask:0xf bound_ctrl:1
    v_add_u32_dpp v15, v15, v15 row_shr:2 row_mask:0xf bank_mask:0xf bound_ctrl:1
    s_nop 0
    v_add_u32_dpp v14, v14, v14 row_shr:4 row_mask:0xf bank_mask:0xf bound_ctrl:1
    v_add_u32_dpp v15, v15, v15 row_shr:4 row_mask:0xf bank_mask:0xf bound_ctrl:1
    s_nop 0
    v_add_u32_dpp v14, v14, v14 row_shr:8 row_mask:0xf bank_mask:0xf bound_ctrl:1
    v_add_u32_dpp v15, v15, v15 row_shr:8 row_mask:0xf bank_mask:0xf bound_ctrl:1
    s_nop 0
    v_add_u32_dpp v14, v14, v14 row_bcast:15 row_mask:0xa bank_mask:0xf
    v_add_u32_dpp v15, v15, v15 row_bcast:15 row_mask:0xa bank_mask:0xf
    s_nop 0
    v_add_u32_dpp v14, v14, v14 row_bcast:31 row_mask:0xc bank_mask:0xf
    v_add_u32_dpp v15, v15, v15 row_bcast:31 row_mask:0xc bank_mask:0xf
    v_readlane_b32 s48, v14, 63
    v_readlane_b32 s49, v15, 63
    s_lshl_b32 s54, s32, 2
    v_mov_b32 v8, s54
    s_and_b32 s50, s48, 0xffff
    s_lshr_b32 s51, s48, 16
    s_and_b32 s52, s49, 0xffff
    s_lshr_b32 s53, s49, 16
    s_add_u32 s51, s51, s50
    s_add_u32 s52, s52, s51
    s_add_u32 s53, s53, s52
    v_mov_b32 v9, s53
    s_mov_b64 exec, 1
    ds_write_b32 v8, v9 offset:16384
    s_cmp_lg_u32 s32, 15
    s_cbranch_scc1 L1_tk2
    s_waitcnt vmcnt(1)
L1_tk2:
    ds_write_b32 v8, v3 offset:16448
    s_mov_b64 exec, -1
    v_and_b32 v8, 60, v7
    s_waitcnt lgkmcnt(0)
    s_barrier
    ds_read_b32 v9, v8 offset:16384
    ds_read_b32 v10, v8 offset:16448
    s_waitcnt lgkmcnt(0)
    v_readlane_b32 s84, v10, 15
    s_and_b32 s3, s2, 1
    s_lshl_b32 s3, s3, 7
    s_add_u32 s84, s84, s3
    s_and_b32 s4, s84, 127
    s_lshl_b32 s6, s32, 10
    s_mov_b32 s43, 5
    s_bitcmp1_b32 s2, 0
    s_cselect_b32 s5, 128, 0
    s_mov_b32 s7, 128
    s_cselect_b32 s7, 124, s7
    s_add_u32 s5, s5, s4
    s_add_u32 s5, s5, 9472
    s_lshl_b32 s5, s5, 14
    s_add_u32 s38, s5, s6
    s_cmp_lt_u32 s4, s7
    s_addc_u32 s43, s43, 0
    s_bitcmp1_b32 s2, 0
    s_cselect_b32 s5, 112, 0
    s_mov_b32 s7, 112
    s_cselect_b32 s7, 100, s7
    s_add_u32 s5, s5, s4
    s_add_u32 s5, s5, 9724
    s_lshl_b32 s5, s5, 14
    s_add_u32 s39, s5, s6
    s_cmp_lt_u32 s4, s7
    s_addc_u32 s43, s43, 0
    s_bitcmp1_b32 s2, 0
    s_cselect_b32 s5, 64, 0
    s_mov_b32 s7, 64
    s_cselect_b32 s7, 0, s7
    s_add_u32 s5, s5, s4
    s_add_u32 s5, s5, 9936
    s_lshl_b32 s5, s5, 14
    s_add_u32 s58, s5, s6
    s_cmp_lt_u32 s4, s7
    s_addc_u32 s43, s43, 0
    v_add_u32_dpp v9, v9, v9 row_shr:1 row_mask:0xf bank_mask:0xf bound_ctrl:1
    s_nop 1
    v_add_u32_dpp v9, v9, v9 row_shr:2 row_mask:0xf bank_mask:0xf bound_ctrl:1
    s_nop 1
    v_add_u32_dpp v9, v9, v9 row_shr:4 row_mask:0xf bank_mask:0xf bound_ctrl:1
    s_nop 1
    v_add_u32_dpp v9, v9, v9 row_shr:8 row_mask:0xf bank_mask:0xf bound_ctrl:1
    s_nop 0
    v_readlane_b32 s54, v9, s32
    s_sub_u32 s54, s54, s53
    s_add_u32 s50, s50, s54
    s_add_u32 s51, s51, s54
    s_add_u32 s52, s52, s54
    s_pack_ll_b32_b16 s48, s54, s50
    s_pack_ll_b32_b16 s49, s51, s52
    v_add_u32 v14, s48, v14
    v_add_u32 v15, s49, v15
    v_sub_u32 v12, v14, v12
    v_sub_u32 v13, v15, v13
    v_and_b32 v8, 0xffff, v12
    v_lshrrev_b32 v9, 16, v12
    v_and_b32 v10, 0xffff, v13
    v_lshrrev_b32 v11, 16, v13
    ds_write2st64_b32 v7, v8, v9 offset0:0 offset1:1
    ds_write2st64_b32 v7, v10, v11 offset0:2 offset1:3
    v_and_b32 v8, 0x3f0, v0
    v_lshl_add_u32 v8, v8, 1, s36
    ds_write_b64 v8, v[12:13] offset:20480
    s_bitset0_b64 exec, 63
    s_not_b64 exec, exec
    ds_write_b64 v8, v[14:15] offset:20512
    s_mov_b64 exec, -1
    s_waitcnt lgkmcnt(0)
    s_barrier
    s_setprio 3
    ds_add_rtn_u32 v24, v24, v2
    ds_add_rtn_u32 v25, v25, v2
    ds_add_rtn_u32 v26, v26, v2
    ds_add_rtn_u32 v27, v27, v2
    ds_read_b128 v[12:15], v0 offset:20480
    v_cmp_gt_u32 vcc, 8448, v0
    s_add_u32 s45, s35, 0x5484000
    s_add_u32 s45, s45, s93
    buffer_store_dwordx4 v[44:47], v0, s[20:23], s45 offen sc1
    s_add_u32 s46, s96, 0x8000000
    s_lshr_b32 s46, s46, 1
    buffer_load_dwordx2 v[44:45], v1, s[16:19], s46 offen nt
    s_add_u32 s47, s97, 0x8400000
    s_lshr_b32 s47, s47, 1
    buffer_load_dwordx2 v[46:47], v1, s[16:19], s47 offen nt
    ds_add_rtn_u32 v52, v52, v2
    ds_add_rtn_u32 v53, v53, v2
    ds_add_rtn_u32 v54, v54, v2
    ds_add_rtn_u32 v55, v55, v2
    s_setprio 2
    ds_add_rtn_u32 v72, v72, v2
    ds_add_rtn_u32 v73, v73, v2
    ds_add_rtn_u32 v74, v74, v2
    ds_add_rtn_u32 v75, v75, v2
    s_waitcnt lgkmcnt(8)
    s_cbranch_vccz L1_p4
    s_add_u32 s44, s35, 0x7ec0000
    s_mov_b64 exec, vcc
    buffer_store_dwordx4 v[12:15], v0, s[24:27], s44 offen sc1
    s_mov_b64 exec, -1
L1_p4:
    s_add_u32 s45, s35, 0x5488000
    s_add_u32 s45, s45, s72
    buffer_store_dwordx4 v[20:23], v0, s[20:23], s45 offen sc1
    s_add_u32 s46, s97, 0x8400000
    s_nop 0
    v_lshlrev_b32 v20, 1, v1
    buffer_load_dwordx4 v[20:23], v20, s[8:11], s46 offen nt
    ds_add_rtn_u32 v80, v80, v2
    ds_add_rtn_u32 v81, v81, v2
    ds_add_rtn_u32 v82, v82, v2
    ds_add_rtn_u32 v83, v83, v2
    s_setprio 1
    ds_add_rtn_u32 v96, v96, v2
    ds_add_rtn_u32 v97, v97, v2
    ds_add_rtn_u32 v98, v98, v2
    ds_add_rtn_u32 v99, v99, v2
    ds_add_rtn_u32 v100, v100, v2
    ds_add_rtn_u32 v101, v101, v2
    ds_add_rtn_u32 v102, v102, v2
    ds_add_rtn_u32 v103, v103, v2
    s_add_u32 s47, s35, 0x5488000
    s_add_u32 s47, s47, s73
    buffer_store_dwordx4 v[124:127], v0, s[20:23], s47 offen sc1
    s_add_u32 s44, s97, 0x8400000
    s_nop 0
    v_lshlrev_b32 v124, 1, v1
    buffer_load_dwordx4 v[124:127], v124, s[12:15], s44 offen nt
    s_setprio 0
    ds_add_rtn_u32 v88, v88, v2
    ds_add_rtn_u32 v89, v89, v2
    ds_add_rtn_u32 v90, v90, v2
    ds_add_rtn_u32 v91, v91, v2
    ds_add_rtn_u32 v92, v92, v2
    ds_add_rtn_u32 v93, v93, v2
    ds_add_rtn_u32 v94, v94, v2
    ds_add_rtn_u32 v95, v95, v2
    s_waitcnt lgkmcnt(0)
    s_barrier
    s_setprio 3
    v_and_b32 v7, -4, v24
    v_lshl_add_u32 v8, v24, 2, v7
    ds_write_b32 v8, v40
    v_lshl_add_u32 v7, v7, 2, v24
    ds_write_b8 v7, v84 offset:16
    v_and_b32 v9, -4, v25
    v_lshl_add_u32 v10, v25, 2, v9
    ds_write_b32 v10, v41
    v_lshl_add_u32 v9, v9, 2, v25
    ds_write_b8_d16_hi v9, v84 offset:16
    v_and_b32 v7, -4, v26
    v_lshl_add_u32 v8, v26, 2, v7
    ds_write_b32 v8, v42
    v_lshl_add_u32 v7, v7, 2, v26
    ds_write_b8 v7, v85 offset:16
    v_and_b32 v9, -4, v27
    v_lshl_add_u32 v10, v27, 2, v9
    ds_write_b32 v10, v43
    v_lshl_add_u32 v9, v9, 2, v27
    ds_write_b8_d16_hi v9, v85 offset:16
    s_add_u32 s45, s35, 0x5488000
    s_add_u32 s45, s45, s85
    buffer_store_dwordx4 v[32:35], v0, s[20:23], s45 offen sc1
    s_add_u32 s46, s98, 0x8800000
    v_lshlrev_b32 v40, 1, v1
    buffer_load_dwordx4 v[40:43], v40, s[8:11], s46 offen nt
    s_add_u32 s47, s98, 0x8800000
    v_lshlrev_b32 v24, 1, v1
    buffer_load_dwordx4 v[24:27], v24, s[12:15], s47 offen nt
    v_and_b32 v7, -4, v52
    v_lshl_add_u32 v8, v52, 2, v7
    ds_write_b32 v8, v48
    v_lshl_add_u32 v7, v7, 2, v52
    ds_write_b8 v7, v86 offset:16
    v_and_b32 v9, -4, v53
    v_lshl_add_u32 v10, v53, 2, v9
    ds_write_b32 v10, v49
    v_lshl_add_u32 v9, v9, 2, v53
    ds_write_b8_d16_hi v9, v86 offset:16
    v_and_b32 v7, -4, v54
    v_lshl_add_u32 v8, v54, 2, v7
    ds_write_b32 v8, v50
    v_lshl_add_u32 v7, v7, 2, v54
    ds_write_b8 v7, v87 offset:16
    v_and_b32 v9, -4, v55
    v_lshl_add_u32 v10, v55, 2, v9
    ds_write_b32 v10, v51
    v_lshl_add_u32 v9, v9, 2, v55
    ds_write_b8_d16_hi v9, v87 offset:16
    s_add_u32 s44, s98, 0x8800000
    s_lshr_b32 s44, s44, 1
    buffer_load_dwordx2 v[32:33], v1, s[16:19], s44 offen nt
    s_add_u32 s45, s99, 0x8c00000
    s_lshr_b32 s45, s45, 1
    buffer_load_dwordx2 v[34:35], v1, s[16:19], s45 offen nt
    s_add_u32 s46, s99, 0x8c00000
    v_lshlrev_b32 v48, 1, v1
    buffer_load_dwordx4 v[48:51], v48, s[8:11], s46 offen nt
    s_waitcnt vmcnt(10)
    v_lshlrev_b32 v7, 16, v44
    v_and_b32 v8, 0xffff0000, v44
    v_lshlrev_b32 v9, 16, v45
    v_and_b32 v10, 0xffff0000, v45
    v_mul_f32 v7, 0.15915494, v7
    v_mul_f32 v8, 0.15915494, v8
    v_mul_f32 v9, 0.15915494, v9
    v_mul_f32 v10, 0.15915494, v10
    v_mul_hi_u32_u24 v14, 429497, v16
    v_lshrrev_b32 v12, 3, v120
    v_cos_f32 v7, v7
    v_lshlrev_b16 v13, 3, v120
    v_mad_i32_i24 v11, v14, s55, v16
    v_bitop3_b32 v12, v6, v13, v12 bitop3:0xca
    v_lshl_add_u32 v11, v11, 17, s40
    v_lshlrev_b16 v14, 8, v14
    v_lshrrev_b32 v13, 2, v120
    v_add_u32 v16, v12, v11
    v_bitop3_b32 v120, v5, v13, v14 bitop3:0xea
    v_mul_hi_u32_u24 v14, 429497, v17
    v_lshrrev_b32 v12, 3, v121
    v_cos_f32 v8, v8
    v_lshlrev_b16 v13, 3, v121
    v_mad_i32_i24 v11, v14, s55, v17
    v_bitop3_b32 v12, v6, v13, v12 bitop3:0xca
    v_lshl_add_u32 v11, v11, 17, s40
    v_lshlrev_b16 v14, 8, v14
    v_lshrrev_b32 v13, 2, v121
    v_add_u32 v17, v12, v11
    v_bitop3_b32 v121, v5, v13, v14 bitop3:0xea
    v_cvt_pk_bf16_f32 v44, v7, v8
    v_perm_b32 v12, v44, v44, s41
    v_bitop3_b32 v16, v4, v12, v16 bitop3:0xca
    v_perm_b32 v13, v44, v44, s42
    v_bitop3_b32 v17, v4, v13, v17 bitop3:0xca
    v_mul_hi_u32_u24 v14, 429497, v18
    v_lshrrev_b32 v12, 3, v122
    v_cos_f32 v9, v9
    v_lshlrev_b16 v13, 3, v122
    v_mad_i32_i24 v11, v14, s55, v18
    v_bitop3_b32 v12, v6, v13, v12 bitop3:0xca
    v_lshl_add_u32 v11, v11, 17, s40
    v_lshlrev_b16 v14, 8, v14
    v_lshrrev_b32 v13, 2, v122
    v_add_u32 v18, v12, v11
    v_bitop3_b32 v122, v5, v13, v14 bitop3:0xea
    v_mul_hi_u32_u24 v14, 429497, v19
    v_lshrrev_b32 v12, 3, v123
    v_cos_f32 v10, v10
    v_lshlrev_b16 v13, 3, v123
    v_mad_i32_i24 v11, v14, s55, v19
    v_bitop3_b32 v12, v6, v13, v12 bitop3:0xca
    v_lshl_add_u32 v11, v11, 17, s40
    v_lshlrev_b16 v14, 8, v14
    v_lshrrev_b32 v13, 2, v123
    v_add_u32 v19, v12, v11
    v_bitop3_b32 v123, v5, v13, v14 bitop3:0xea
    v_cvt_pk_bf16_f32 v45, v9, v10
    v_perm_b32 v12, v45, v45, s41
    v_bitop3_b32 v18, v4, v12, v18 bitop3:0xca
    v_perm_b32 v13, v45, v45, s42
    v_bitop3_b32 v19, v4, v13, v19 bitop3:0xca
    s_setprio 2
    v_and_b32 v7, -4, v72
    v_lshl_add_u32 v8, v72, 2, v7
    ds_write_b32 v8, v68
    v_lshl_add_u32 v7, v7, 2, v72
    ds_write_b8 v7, v56 offset:16
    v_and_b32 v9, -4, v73
    v_lshl_add_u32 v10, v73, 2, v9
    ds_write_b32 v10, v69
    v_lshl_add_u32 v9, v9, 2, v73
    ds_write_b8_d16_hi v9, v56 offset:16
    v_and_b32 v7, -4, v74
    v_lshl_add_u32 v8, v74, 2, v7
    ds_write_b32 v8, v70
    v_lshl_add_u32 v7, v7, 2, v74
    ds_write_b8 v7, v57 offset:16
    v_and_b32 v9, -4, v75
    v_lshl_add_u32 v10, v75, 2, v9
    ds_write_b32 v10, v71
    v_lshl_add_u32 v9, v9, 2, v75
    ds_write_b8_d16_hi v9, v57 offset:16
    s_add_u32 s47, s35, 0x5488000
    s_add_u32 s47, s47, s91
    buffer_store_dwordx4 v[36:39], v0, s[20:23], s47 offen sc1
    s_add_u32 s44, s99, 0x8c00000
    v_lshlrev_b32 v52, 1, v1
    buffer_load_dwordx4 v[52:55], v52, s[12:15], s44 offen nt
    s_waitcnt vmcnt(8)
    v_lshlrev_b32 v7, 16, v46
    v_and_b32 v8, 0xffff0000, v46
    v_lshlrev_b32 v9, 16, v47
    v_and_b32 v10, 0xffff0000, v47
    v_mul_f32 v7, 0.15915494, v7
    v_mul_f32 v8, 0.15915494, v8
    v_mul_f32 v9, 0.15915494, v9
    v_mul_f32 v10, 0.15915494, v10
    v_mul_hi_u32_u24 v14, 429497, v20
    v_lshrrev_b32 v12, 3, v124
    v_cos_f32 v7, v7
    v_lshlrev_b16 v13, 3, v124
    v_mad_i32_i24 v11, v14, s55, v20
    v_bitop3_b32 v12, v6, v13, v12 bitop3:0xca
    v_lshl_add_u32 v11, v11, 17, s40
    v_lshlrev_b16 v14, 8, v14
    v_lshrrev_b32 v13, 2, v124
    v_add_u32 v20, v12, v11
    v_bitop3_b32 v124, v5, v13, v14 bitop3:0xea
    v_mul_hi_u32_u24 v14, 429497, v21
    v_lshrrev_b32 v12, 3, v125
    v_cos_f32 v8, v8
    v_lshlrev_b16 v13, 3, v125
    v_mad_i32_i24 v11, v14, s55, v21
    v_bitop3_b32 v12, v6, v13, v12 bitop3:0xca
    v_lshl_add_u32 v11, v11, 17, s40
    v_lshlrev_b16 v14, 8, v14
    v_lshrrev_b32 v13, 2, v125
    v_add_u32 v21, v12, v11
    v_bitop3_b32 v125, v5, v13, v14 bitop3:0xea
    v_cvt_pk_bf16_f32 v46, v7, v8
    v_perm_b32 v12, v46, v46, s41
    v_bitop3_b32 v20, v4, v12, v20 bitop3:0xca
    v_perm_b32 v13, v46, v46, s42
    v_bitop3_b32 v21, v4, v13, v21 bitop3:0xca
    v_mul_hi_u32_u24 v14, 429497, v22
    v_lshrrev_b32 v12, 3, v126
    v_cos_f32 v9, v9
    v_lshlrev_b16 v13, 3, v126
    v_mad_i32_i24 v11, v14, s55, v22
    v_bitop3_b32 v12, v6, v13, v12 bitop3:0xca
    v_lshl_add_u32 v11, v11, 17, s40
    v_lshlrev_b16 v14, 8, v14
    v_lshrrev_b32 v13, 2, v126
    v_add_u32 v22, v12, v11
    v_bitop3_b32 v126, v5, v13, v14 bitop3:0xea
    v_mul_hi_u32_u24 v14, 429497, v23
    v_lshrrev_b32 v12, 3, v127
    v_cos_f32 v10, v10
    v_lshlrev_b16 v13, 3, v127
    v_mad_i32_i24 v11, v14, s55, v23
    v_bitop3_b32 v12, v6, v13, v12 bitop3:0xca
    v_lshl_add_u32 v11, v11, 17, s40
    v_lshlrev_b16 v14, 8, v14
    v_lshrrev_b32 v13, 2, v127
    v_add_u32 v23, v12, v11
    v_bitop3_b32 v127, v5, v13, v14 bitop3:0xea
    v_cvt_pk_bf16_f32 v47, v9, v10
    v_perm_b32 v12, v47, v47, s41
    v_bitop3_b32 v22, v4, v12, v22 bitop3:0xca
    v_perm_b32 v13, v47, v47, s42
    v_bitop3_b32 v23, v4, v13, v23 bitop3:0xca
    v_and_b32 v7, -4, v80
    v_lshl_add_u32 v8, v80, 2, v7
    ds_write_b32 v8, v76
    v_lshl_add_u32 v7, v7, 2, v80
    ds_write_b8 v7, v58 offset:16
    v_and_b32 v9, -4, v81
    v_lshl_add_u32 v10, v81, 2, v9
    ds_write_b32 v10, v77
    v_lshl_add_u32 v9, v9, 2, v81
    ds_write_b8_d16_hi v9, v58 offset:16
    v_and_b32 v7, -4, v82
    v_lshl_add_u32 v8, v82, 2, v7
    ds_write_b32 v8, v78
    v_lshl_add_u32 v7, v7, 2, v82
    ds_write_b8 v7, v59 offset:16
    v_and_b32 v9, -4, v83
    v_lshl_add_u32 v10, v83, 2, v9
    ds_write_b32 v10, v79
    v_lshl_add_u32 v9, v9, 2, v83
    ds_write_b8_d16_hi v9, v59 offset:16
    s_add_u32 s45, s96, 0x9000000
    v_lshlrev_b32 v84, 1, v1
    buffer_load_dwordx4 v[84:87], v84, s[8:11], s45 offen nt
    s_add_u32 s46, s96, 0x9000000
    v_lshlrev_b32 v68, 1, v1
    buffer_load_dwordx4 v[68:71], v68, s[12:15], s46 offen nt
    s_waitcnt vmcnt(5)
    v_lshlrev_b32 v7, 16, v32
    v_and_b32 v8, 0xffff0000, v32
    v_lshlrev_b32 v9, 16, v33
    v_and_b32 v10, 0xffff0000, v33
    v_mul_f32 v7, 0.15915494, v7
    v_mul_f32 v8, 0.15915494, v8
    v_mul_f32 v9, 0.15915494, v9
    v_mul_f32 v10, 0.15915494, v10
    v_mul_hi_u32_u24 v14, 429497, v40
    v_lshrrev_b32 v12, 3, v24
    v_cos_f32 v7, v7
    v_lshlrev_b16 v13, 3, v24
    v_mad_i32_i24 v11, v14, s55, v40
    v_bitop3_b32 v12, v6, v13, v12 bitop3:0xca
    v_lshl_add_u32 v11, v11, 17, s40
    v_lshlrev_b16 v14, 8, v14
    v_lshrrev_b32 v13, 2, v24
    v_add_u32 v40, v12, v11
    v_bitop3_b32 v24, v5, v13, v14 bitop3:0xea
    v_mul_hi_u32_u24 v14, 429497, v41
    v_lshrrev_b32 v12, 3, v25
    v_cos_f32 v8, v8
    v_lshlrev_b16 v13, 3, v25
    v_mad_i32_i24 v11, v14, s55, v41
    v_bitop3_b32 v12, v6, v13, v12 bitop3:0xca
    v_lshl_add_u32 v11, v11, 17, s40
    v_lshlrev_b16 v14, 8, v14
    v_lshrrev_b32 v13, 2, v25
    v_add_u32 v41, v12, v11
    v_bitop3_b32 v25, v5, v13, v14 bitop3:0xea
    v_cvt_pk_bf16_f32 v32, v7, v8
    v_perm_b32 v12, v32, v32, s41
    v_bitop3_b32 v40, v4, v12, v40 bitop3:0xca
    v_perm_b32 v13, v32, v32, s42
    v_bitop3_b32 v41, v4, v13, v41 bitop3:0xca
    v_mul_hi_u32_u24 v14, 429497, v42
    v_lshrrev_b32 v12, 3, v26
    v_cos_f32 v9, v9
    v_lshlrev_b16 v13, 3, v26
    v_mad_i32_i24 v11, v14, s55, v42
    v_bitop3_b32 v12, v6, v13, v12 bitop3:0xca
    v_lshl_add_u32 v11, v11, 17, s40
    v_lshlrev_b16 v14, 8, v14
    v_lshrrev_b32 v13, 2, v26
    v_add_u32 v42, v12, v11
    v_bitop3_b32 v26, v5, v13, v14 bitop3:0xea
    v_mul_hi_u32_u24 v14, 429497, v43
    v_lshrrev_b32 v12, 3, v27
    v_cos_f32 v10, v10
    v_lshlrev_b16 v13, 3, v27
    v_mad_i32_i24 v11, v14, s55, v43
    v_bitop3_b32 v12, v6, v13, v12 bitop3:0xca
    v_lshl_add_u32 v11, v11, 17, s40
    v_lshlrev_b16 v14, 8, v14
    v_lshrrev_b32 v13, 2, v27
    v_add_u32 v43, v12, v11
    v_bitop3_b32 v27, v5, v13, v14 bitop3:0xea
    v_cvt_pk_bf16_f32 v33, v9, v10
    v_perm_b32 v12, v33, v33, s41
    v_bitop3_b32 v42, v4, v12, v42 bitop3:0xca
    v_perm_b32 v13, v33, v33, s42
    v_bitop3_b32 v43, v4, v13, v43 bitop3:0xca
    s_setprio 1
    v_and_b32 v7, -4, v96
    v_lshl_add_u32 v8, v96, 2, v7
    ds_write_b32 v8, v64
    v_lshl_add_u32 v7, v7, 2, v96
    ds_write_b8 v7, v104 offset:16
    v_and_b32 v9, -4, v97
    v_lshl_add_u32 v10, v97, 2, v9
    ds_write_b32 v10, v65
    v_lshl_add_u32 v9, v9, 2, v97
    ds_write_b8_d16_hi v9, v104 offset:16
    v_and_b32 v7, -4, v98
    v_lshl_add_u32 v8, v98, 2, v7
    ds_write_b32 v8, v66
    v_lshl_add_u32 v7, v7, 2, v98
    ds_write_b8 v7, v105 offset:16
    v_and_b32 v9, -4, v99
    v_lshl_add_u32 v10, v99, 2, v9
    ds_write_b32 v10, v67
    v_lshl_add_u32 v9, v9, 2, v99
    ds_write_b8_d16_hi v9, v105 offset:16
    s_add_u32 s47, s96, 0x9000000
    s_lshr_b32 s47, s47, 1
    buffer_load_dwordx2 v[72:73], v1, s[16:19], s47 offen nt
    s_cmp_le_u32 s43, 5
    s_cselect_b32 s18, 0, s18
    s_add_u32 s44, s38, 0x0
    s_lshr_b32 s44, s44, 1
    buffer_load_dwordx2 v[74:75], v1, s[16:19], s44 offen nt
    s_cmp_le_u32 s43, 5
    s_cselect_b32 s10, 0, s10
    s_add_u32 s45, s38, 0x0
    v_lshlrev_b32 v36, 1, v1
    buffer_load_dwordx4 v[36:39], v36, s[8:11], s45 offen nt
    v_and_b32 v7, -4, v100
    v_lshl_add_u32 v8, v100, 2, v7
    ds_write_b32 v8, v60
    v_lshl_add_u32 v7, v7, 2, v100
    ds_write_b8 v7, v106 offset:16
    v_and_b32 v9, -4, v101
    v_lshl_add_u32 v10, v101, 2, v9
    ds_write_b32 v10, v61
    v_lshl_add_u32 v9, v9, 2, v101
    ds_write_b8_d16_hi v9, v106 offset:16
    v_and_b32 v7, -4, v102
    v_lshl_add_u32 v8, v102, 2, v7
    ds_write_b32 v8, v62
    v_lshl_add_u32 v7, v7, 2, v102
    ds_write_b8 v7, v107 offset:16
    v_and_b32 v9, -4, v103
    v_lshl_add_u32 v10, v103, 2, v9
    ds_write_b32 v10, v63
    v_lshl_add_u32 v9, v9, 2, v103
    ds_write_b8_d16_hi v9, v107 offset:16
    s_add_u32 s46, s35, 0x5488000
    s_add_u32 s46, s46, s93
    buffer_store_dwordx4 v[28:31], v0, s[20:23], s46 offen sc1
    s_cmp_le_u32 s43, 5
    s_cselect_b32 s14, 0, s14
    s_add_u32 s47, s38, 0x0
    v_lshlrev_b32 v76, 1, v1
    buffer_load_dwordx4 v[76:79], v76, s[12:15], s47 offen nt
    s_waitcnt vmcnt(7)
    v_lshlrev_b32 v7, 16, v34
    v_and_b32 v8, 0xffff0000, v34
    v_lshlrev_b32 v9, 16, v35
    v_and_b32 v10, 0xffff0000, v35
    v_mul_f32 v7, 0.15915494, v7
    v_mul_f32 v8, 0.15915494, v8
    v_mul_f32 v9, 0.15915494, v9
    v_mul_f32 v10, 0.15915494, v10
    v_mul_hi_u32_u24 v14, 429497, v48
    v_lshrrev_b32 v12, 3, v52
    v_cos_f32 v7, v7
    v_lshlrev_b16 v13, 3, v52
    v_mad_i32_i24 v11, v14, s55, v48
    v_bitop3_b32 v12, v6, v13, v12 bitop3:0xca
    v_lshl_add_u32 v11, v11, 17, s40
    v_lshlrev_b16 v14, 8, v14
    v_lshrrev_b32 v13, 2, v52
    v_add_u32 v48, v12, v11
    v_bitop3_b32 v52, v5, v13, v14 bitop3:0xea
    v_mul_hi_u32_u24 v14, 429497, v49
    v_lshrrev_b32 v12, 3, v53
    v_cos_f32 v8, v8
    v_lshlrev_b16 v13, 3, v53
    v_mad_i32_i24 v11, v14, s55, v49
    v_bitop3_b32 v12, v6, v13, v12 bitop3:0xca
    v_lshl_add_u32 v11, v11, 17, s40
    v_lshlrev_b16 v14, 8, v14
    v_lshrrev_b32 v13, 2, v53
    v_add_u32 v49, v12, v11
    v_bitop3_b32 v53, v5, v13, v14 bitop3:0xea
    v_cvt_pk_bf16_f32 v34, v7, v8
    v_perm_b32 v12, v34, v34, s41
    v_bitop3_b32 v48, v4, v12, v48 bitop3:0xca
    v_perm_b32 v13, v34, v34, s42
    v_bitop3_b32 v49, v4, v13, v49 bitop3:0xca
    v_mul_hi_u32_u24 v14, 429497, v50
    v_lshrrev_b32 v12, 3, v54
    v_cos_f32 v9, v9
    v_lshlrev_b16 v13, 3, v54
    v_mad_i32_i24 v11, v14, s55, v50
    v_bitop3_b32 v12, v6, v13, v12 bitop3:0xca
    v_lshl_add_u32 v11, v11, 17, s40
    v_lshlrev_b16 v14, 8, v14
    v_lshrrev_b32 v13, 2, v54
    v_add_u32 v50, v12, v11
    v_bitop3_b32 v54, v5, v13, v14 bitop3:0xea
    v_mul_hi_u32_u24 v14, 429497, v51
    v_lshrrev_b32 v12, 3, v55
    v_cos_f32 v10, v10
    v_lshlrev_b16 v13, 3, v55
    v_mad_i32_i24 v11, v14, s55, v51
    v_bitop3_b32 v12, v6, v13, v12 bitop3:0xca
    v_lshl_add_u32 v11, v11, 17, s40
    v_lshlrev_b16 v14, 8, v14
    v_lshrrev_b32 v13, 2, v55
    v_add_u32 v51, v12, v11
    v_bitop3_b32 v55, v5, v13, v14 bitop3:0xea
    v_cvt_pk_bf16_f32 v35, v9, v10
    v_perm_b32 v12, v35, v35, s41
    v_bitop3_b32 v50, v4, v12, v50 bitop3:0xca
    v_perm_b32 v13, v35, v35, s42
    v_bitop3_b32 v51, v4, v13, v51 bitop3:0xca
    s_setprio 0
    v_and_b32 v7, -4, v88
    v_lshl_add_u32 v8, v88, 2, v7
    ds_write_b32 v8, v112
    v_lshl_add_u32 v7, v7, 2, v88
    ds_write_b8 v7, v108 offset:16
    v_and_b32 v9, -4, v89
    v_lshl_add_u32 v10, v89, 2, v9
    ds_write_b32 v10, v113
    v_lshl_add_u32 v9, v9, 2, v89
    ds_write_b8_d16_hi v9, v108 offset:16
    v_and_b32 v7, -4, v90
    v_lshl_add_u32 v8, v90, 2, v7
    ds_write_b32 v8, v114
    v_lshl_add_u32 v7, v7, 2, v90
    ds_write_b8 v7, v109 offset:16
    v_and_b32 v9, -4, v91
    v_lshl_add_u32 v10, v91, 2, v9
    ds_write_b32 v10, v115
    v_lshl_add_u32 v9, v9, 2, v91
    ds_write_b8_d16_hi v9, v109 offset:16
    s_cmp_le_u32 s43, 6
    s_cselect_b32 s10, 0, s10
    s_add_u32 s44, s39, 0x0
    v_lshlrev_b32 v80, 1, v1
    buffer_load_dwordx4 v[80:83], v80, s[8:11], s44 offen nt
    s_cmp_le_u32 s43, 6
    s_cselect_b32 s14, 0, s14
    s_add_u32 s45, s39, 0x0
    v_lshlrev_b32 v56, 1, v1
    buffer_load_dwordx4 v[56:59], v56, s[12:15], s45 offen nt
    s_waitcnt vmcnt(5)
    v_lshlrev_b32 v7, 16, v72
    v_and_b32 v8, 0xffff0000, v72
    v_lshlrev_b32 v9, 16, v73
    v_and_b32 v10, 0xffff0000, v73
    v_mul_f32 v7, 0.15915494, v7
    v_mul_f32 v8, 0.15915494, v8
    v_mul_f32 v9, 0.15915494, v9
    v_mul_f32 v10, 0.15915494, v10
    v_mul_hi_u32_u24 v14, 429497, v84
    v_lshrrev_b32 v12, 3, v68
    v_cos_f32 v7, v7
    v_lshlrev_b16 v13, 3, v68
    v_mad_i32_i24 v11, v14, s55, v84
    v_bitop3_b32 v12, v6, v13, v12 bitop3:0xca
    v_lshl_add_u32 v11, v11, 17, s40
    v_lshlrev_b16 v14, 8, v14
    v_lshrrev_b32 v13, 2, v68
    v_add_u32 v84, v12, v11
    v_bitop3_b32 v68, v5, v13, v14 bitop3:0xea
    v_mul_hi_u32_u24 v14, 429497, v85
    v_lshrrev_b32 v12, 3, v69
    v_cos_f32 v8, v8
    v_lshlrev_b16 v13, 3, v69
    v_mad_i32_i24 v11, v14, s55, v85
    v_bitop3_b32 v12, v6, v13, v12 bitop3:0xca
    v_lshl_add_u32 v11, v11, 17, s40
    v_lshlrev_b16 v14, 8, v14
    v_lshrrev_b32 v13, 2, v69
    v_add_u32 v85, v12, v11
    v_bitop3_b32 v69, v5, v13, v14 bitop3:0xea
    v_cvt_pk_bf16_f32 v72, v7, v8
    v_perm_b32 v12, v72, v72, s41
    v_bitop3_b32 v84, v4, v12, v84 bitop3:0xca
    v_perm_b32 v13, v72, v72, s42
    v_bitop3_b32 v85, v4, v13, v85 bitop3:0xca
    v_mul_hi_u32_u24 v14, 429497, v86
    v_lshrrev_b32 v12, 3, v70
    v_cos_f32 v9, v9
    v_lshlrev_b16 v13, 3, v70
    v_mad_i32_i24 v11, v14, s55, v86
    v_bitop3_b32 v12, v6, v13, v12 bitop3:0xca
    v_lshl_add_u32 v11, v11, 17, s40
    v_lshlrev_b16 v14, 8, v14
    v_lshrrev_b32 v13, 2, v70
    v_add_u32 v86, v12, v11
    v_bitop3_b32 v70, v5, v13, v14 bitop3:0xea
    v_mul_hi_u32_u24 v14, 429497, v87
    v_lshrrev_b32 v12, 3, v71
    v_cos_f32 v10, v10
    v_lshlrev_b16 v13, 3, v71
    v_mad_i32_i24 v11, v14, s55, v87
    v_bitop3_b32 v12, v6, v13, v12 bitop3:0xca
    v_lshl_add_u32 v11, v11, 17, s40
    v_lshlrev_b16 v14, 8, v14
    v_lshrrev_b32 v13, 2, v71
    v_add_u32 v87, v12, v11
    v_bitop3_b32 v71, v5, v13, v14 bitop3:0xea
    v_cvt_pk_bf16_f32 v73, v9, v10
    v_perm_b32 v12, v73, v73, s41
    v_bitop3_b32 v86, v4, v12, v86 bitop3:0xca
    v_perm_b32 v13, v73, v73, s42
    v_bitop3_b32 v87, v4, v13, v87 bitop3:0xca
    v_and_b32 v7, -4, v92
    v_lshl_add_u32 v8, v92, 2, v7
    ds_write_b32 v8, v116
    v_lshl_add_u32 v7, v7, 2, v92
    ds_write_b8 v7, v110 offset:16
    v_and_b32 v9, -4, v93
    v_lshl_add_u32 v10, v93, 2, v9
    ds_write_b32 v10, v117
    v_lshl_add_u32 v9, v9, 2, v93
    ds_write_b8_d16_hi v9, v110 offset:16
    v_and_b32 v7, -4, v94
    v_lshl_add_u32 v8, v94, 2, v7
    ds_write_b32 v8, v118
    v_lshl_add_u32 v7, v7, 2, v94
    ds_write_b8 v7, v111 offset:16
    v_and_b32 v9, -4, v95
    v_lshl_add_u32 v10, v95, 2, v9
    ds_write_b32 v10, v119
    v_lshl_add_u32 v9, v9, 2, v95
    ds_write_b8_d16_hi v9, v111 offset:16
    s_cmp_le_u32 s43, 6
    s_cselect_b32 s18, 0, s18
    s_add_u32 s46, s39, 0x0
    s_lshr_b32 s46, s46, 1
    buffer_load_dwordx2 v[64:65], v1, s[16:19], s46 offen nt
    s_cmp_le_u32 s43, 7
    s_cselect_b32 s18, 0, s18
    s_add_u32 s47, s58, 0x0
    s_lshr_b32 s47, s47, 1
    buffer_load_dwordx2 v[66:67], v1, s[16:19], s47 offen nt
    s_waitcnt vmcnt(4)
    s_cmp_le_u32 s43, 5
    s_cbranch_scc1 L1_s5
    v_lshlrev_b32 v7, 16, v74
    v_and_b32 v8, 0xffff0000, v74
    v_lshlrev_b32 v9, 16, v75
    v_and_b32 v10, 0xffff0000, v75
    v_mul_f32 v7, 0.15915494, v7
    v_mul_f32 v8, 0.15915494, v8
    v_mul_f32 v9, 0.15915494, v9
    v_mul_f32 v10, 0.15915494, v10
    v_mul_hi_u32_u24 v14, 429497, v36
    v_lshrrev_b32 v12, 3, v76
    v_cos_f32 v7, v7
    v_lshlrev_b16 v13, 3, v76
    v_mad_i32_i24 v11, v14, s55, v36
    v_bitop3_b32 v12, v6, v13, v12 bitop3:0xca
    v_lshl_add_u32 v11, v11, 17, s40
    v_lshlrev_b16 v14, 8, v14
    v_lshrrev_b32 v13, 2, v76
    v_add_u32 v36, v12, v11
    v_bitop3_b32 v76, v5, v13, v14 bitop3:0xea
    v_mul_hi_u32_u24 v14, 429497, v37
    v_lshrrev_b32 v12, 3, v77
    v_cos_f32 v8, v8
    v_lshlrev_b16 v13, 3, v77
    v_mad_i32_i24 v11, v14, s55, v37
    v_bitop3_b32 v12, v6, v13, v12 bitop3:0xca
    v_lshl_add_u32 v11, v11, 17, s40
    v_lshlrev_b16 v14, 8, v14
    v_lshrrev_b32 v13, 2, v77
    v_add_u32 v37, v12, v11
    v_bitop3_b32 v77, v5, v13, v14 bitop3:0xea
    v_cvt_pk_bf16_f32 v74, v7, v8
    v_perm_b32 v12, v74, v74, s41
    v_bitop3_b32 v36, v4, v12, v36 bitop3:0xca
    v_perm_b32 v13, v74, v74, s42
    v_bitop3_b32 v37, v4, v13, v37 bitop3:0xca
    v_mul_hi_u32_u24 v14, 429497, v38
    v_lshrrev_b32 v12, 3, v78
    v_cos_f32 v9, v9
    v_lshlrev_b16 v13, 3, v78
    v_mad_i32_i24 v11, v14, s55, v38
    v_bitop3_b32 v12, v6, v13, v12 bitop3:0xca
    v_lshl_add_u32 v11, v11, 17, s40
    v_lshlrev_b16 v14, 8, v14
    v_lshrrev_b32 v13, 2, v78
    v_add_u32 v38, v12, v11
    v_bitop3_b32 v78, v5, v13, v14 bitop3:0xea
    v_mul_hi_u32_u24 v14, 429497, v39
    v_lshrrev_b32 v12, 3, v79
    v_cos_f32 v10, v10
    v_lshlrev_b16 v13, 3, v79
    v_mad_i32_i24 v11, v14, s55, v39
    v_bitop3_b32 v12, v6, v13, v12 bitop3:0xca
    v_lshl_add_u32 v11, v11, 17, s40
    v_lshlrev_b16 v14, 8, v14
    v_lshrrev_b32 v13, 2, v79
    v_add_u32 v39, v12, v11
    v_bitop3_b32 v79, v5, v13, v14 bitop3:0xea
    v_cvt_pk_bf16_f32 v75, v9, v10
    v_perm_b32 v12, v75, v75, s41
    v_bitop3_b32 v38, v4, v12, v38 bitop3:0xca
    v_perm_b32 v13, v75, v75, s42
    v_bitop3_b32 v39, v4, v13, v39 bitop3:0xca
L1_s5:
    v_add_u32 v7, s72, v0
    v_add_u32 v12, s73, v0
    v_add_u32 v13, s85, v0
    v_add_u32 v14, s91, v0
    v_add_u32 v15, s93, v0
    s_min_i32 s3, s72, s73
    s_min_i32 s3, s3, s85
    s_min_i32 s3, s3, s91
    s_min_i32 s3, s3, s93
    v_add_u32 v3, s3, v0
    v_mov_b32 v8, 0
    v_mov_b32 v9, 0
    v_mov_b32 v10, 0
    v_mov_b32 v11, 0
    s_waitcnt lgkmcnt(0)
    s_barrier
    ds_read_b128 v[96:99], v7 offset:0
    ds_read_b128 v[60:63], v12 offset:0
    ds_read_b128 v[100:103], v13 offset:0
    ds_read_b128 v[104:107], v14 offset:0
    ds_read_b128 v[28:31], v15 offset:0
    ds_write_b128 v3, v[8:11]
    ds_read_b128 v[112:115], v7 offset:16384
    ds_read_b128 v[88:91], v12 offset:16384
    ds_read_b128 v[116:119], v13 offset:16384
    ds_read_b128 v[92:95], v14 offset:16384
    ds_read_b128 v[108:111], v15 offset:16384
    s_waitcnt lgkmcnt(0)
    s_barrier
    v_lshlrev_b32 v3, 3, v0
    v_and_b32 v3, 0x80, v3
    s_cmp_lg_u32 s32, 15
    s_cbranch_scc1 L2_k0
    s_mov_b64 exec, 3
    buffer_load_dword v3, v3, s[68:71], 0 offen sc1
    s_mov_b64 exec, -1
L2_k0:
    s_add_u32 s44, s35, 0x7ec4000
    s_add_u32 s44, s44, s72
    buffer_store_dwordx4 v[96:99], v0, s[20:23], s44 offen sc1
    s_cmp_le_u32 s43, 7
    s_cselect_b32 s10, 0, s10
    s_add_u32 s45, s58, 0x0
    v_lshlrev_b32 v96, 1, v1
    buffer_load_dwordx4 v[96:99], v96, s[8:11], s45 offen nt
    s_add_u32 s46, s35, 0x7ec4000
    s_add_u32 s46, s46, s73
    buffer_store_dwordx4 v[60:63], v0, s[20:23], s46 offen sc1
    s_cmp_le_u32 s43, 7
    s_cselect_b32 s14, 0, s14
    s_add_u32 s47, s58, 0x0
    v_lshlrev_b32 v60, 1, v1
    buffer_load_dwordx4 v[60:63], v60, s[12:15], s47 offen nt
    s_setprio 3
    ds_add_u32 v120, v2
    ds_add_u32 v121, v2
    ds_add_u32 v122, v2
    ds_add_u32 v123, v2
    ds_add_u32 v124, v2
    ds_add_u32 v125, v2
    ds_add_u32 v126, v2
    ds_add_u32 v127, v2
    s_setprio 2
    s_add_u32 s44, s35, 0x7ec4000
    s_add_u32 s44, s44, s85
    buffer_store_dwordx4 v[100:103], v0, s[20:23], s44 offen sc1
    ds_add_u32 v24, v2
    ds_add_u32 v25, v2
    ds_add_u32 v26, v2
    ds_add_u32 v27, v2
    ds_add_u32 v52, v2
    ds_add_u32 v53, v2
    ds_add_u32 v54, v2
    ds_add_u32 v55, v2
    s_setprio 1
    ds_add_u32 v68, v2
    ds_add_u32 v69, v2
    ds_add_u32 v70, v2
    ds_add_u32 v71, v2
    s_add_u32 s45, s35, 0x7ec4000
    s_add_u32 s45, s45, s91
    buffer_store_dwordx4 v[104:107], v0, s[20:23], s45 offen sc1
    s_cmp_le_u32 s43, 5
    s_cbranch_scc1 L1_s6
    ds_add_u32 v76, v2
    ds_add_u32 v77, v2
    ds_add_u32 v78, v2
    ds_add_u32 v79, v2
L1_s6:
    s_setprio 0
    s_waitcnt vmcnt(6)
    s_cmp_le_u32 s43, 6
    s_cbranch_scc1 L1_s7
    v_lshlrev_b32 v7, 16, v64
    v_and_b32 v8, 0xffff0000, v64
    v_lshlrev_b32 v9, 16, v65
    v_and_b32 v10, 0xffff0000, v65
    v_mul_f32 v7, 0.15915494, v7
    v_mul_f32 v8, 0.15915494, v8
    v_mul_f32 v9, 0.15915494, v9
    v_mul_f32 v10, 0.15915494, v10
    v_mul_hi_u32_u24 v14, 429497, v80
    v_lshrrev_b32 v12, 3, v56
    v_cos_f32 v7, v7
    v_lshlrev_b16 v13, 3, v56
    v_mad_i32_i24 v11, v14, s55, v80
    v_bitop3_b32 v12, v6, v13, v12 bitop3:0xca
    v_lshl_add_u32 v11, v11, 17, s40
    v_lshlrev_b16 v14, 8, v14
    v_lshrrev_b32 v13, 2, v56
    v_add_u32 v80, v12, v11
    v_bitop3_b32 v56, v5, v13, v14 bitop3:0xea
    ds_add_u32 v56, v2
    v_mul_hi_u32_u24 v14, 429497, v81
    v_lshrrev_b32 v12, 3, v57
    v_cos_f32 v8, v8
    v_lshlrev_b16 v13, 3, v57
    v_mad_i32_i24 v11, v14, s55, v81
    v_bitop3_b32 v12, v6, v13, v12 bitop3:0xca
    v_lshl_add_u32 v11, v11, 17, s40
    v_lshlrev_b16 v14, 8, v14
    v_lshrrev_b32 v13, 2, v57
    v_add_u32 v81, v12, v11
    v_bitop3_b32 v57, v5, v13, v14 bitop3:0xea
    ds_add_u32 v57, v2
    v_cvt_pk_bf16_f32 v64, v7, v8
    v_perm_b32 v12, v64, v64, s41
    v_bitop3_b32 v80, v4, v12, v80 bitop3:0xca
    v_perm_b32 v13, v64, v64, s42
    v_bitop3_b32 v81, v4, v13, v81 bitop3:0xca
    v_mul_hi_u32_u24 v14, 429497, v82
    v_lshrrev_b32 v12, 3, v58
    v_cos_f32 v9, v9
    v_lshlrev_b16 v13, 3, v58
    v_mad_i32_i24 v11, v14, s55, v82
    v_bitop3_b32 v12, v6, v13, v12 bitop3:0xca
    v_lshl_add_u32 v11, v11, 17, s40
    v_lshlrev_b16 v14, 8, v14
    v_lshrrev_b32 v13, 2, v58
    v_add_u32 v82, v12, v11
    v_bitop3_b32 v58, v5, v13, v14 bitop3:0xea
    ds_add_u32 v58, v2
    v_mul_hi_u32_u24 v14, 429497, v83
    v_lshrrev_b32 v12, 3, v59
    v_cos_f32 v10, v10
    v_lshlrev_b16 v13, 3, v59
    v_mad_i32_i24 v11, v14, s55, v83
    v_bitop3_b32 v12, v6, v13, v12 bitop3:0xca
    v_lshl_add_u32 v11, v11, 17, s40
    v_lshlrev_b16 v14, 8, v14
    v_lshrrev_b32 v13, 2, v59
    v_add_u32 v83, v12, v11
    v_bitop3_b32 v59, v5, v13, v14 bitop3:0xea
    ds_add_u32 v59, v2
    v_cvt_pk_bf16_f32 v65, v9, v10
    v_perm_b32 v12, v65, v65, s41
    v_bitop3_b32 v82, v4, v12, v82 bitop3:0xca
    v_perm_b32 v13, v65, v65, s42
    v_bitop3_b32 v83, v4, v13, v83 bitop3:0xca
L1_s7:
    s_waitcnt vmcnt(2)
    s_cmp_le_u32 s43, 7
    s_cbranch_scc1 L1_s8
    v_lshlrev_b32 v7, 16, v66
    v_and_b32 v8, 0xffff0000, v66
    v_lshlrev_b32 v9, 16, v67
    v_and_b32 v10, 0xffff0000, v67
    v_mul_f32 v7, 0.15915494, v7
    v_mul_f32 v8, 0.15915494, v8
    v_mul_f32 v9, 0.15915494, v9
    v_mul_f32 v10, 0.15915494, v10
    v_mul_hi_u32_u24 v14, 429497, v96
    v_lshrrev_b32 v12, 3, v60
    v_cos_f32 v7, v7
    v_lshlrev_b16 v13, 3, v60
    v_mad_i32_i24 v11, v14, s55, v96
    v_bitop3_b32 v12, v6, v13, v12 bitop3:0xca
    v_lshl_add_u32 v11, v11, 17, s40
    v_lshlrev_b16 v14, 8, v14
    v_lshrrev_b32 v13, 2, v60
    v_add_u32 v96, v12, v11
    v_bitop3_b32 v60, v5, v13, v14 bitop3:0xea
    ds_add_u32 v60, v2
    v_mul_hi_u32_u24 v14, 429497, v97
    v_lshrrev_b32 v12, 3, v61
    v_cos_f32 v8, v8
    v_lshlrev_b16 v13, 3, v61
    v_mad_i32_i24 v11, v14, s55, v97
    v_bitop3_b32 v12, v6, v13, v12 bitop3:0xca
    v_lshl_add_u32 v11, v11, 17, s40
    v_lshlrev_b16 v14, 8, v14
    v_lshrrev_b32 v13, 2, v61
    v_add_u32 v97, v12, v11
    v_bitop3_b32 v61, v5, v13, v14 bitop3:0xea
    ds_add_u32 v61, v2
    v_cvt_pk_bf16_f32 v66, v7, v8
    v_perm_b32 v12, v66, v66, s41
    v_bitop3_b32 v96, v4, v12, v96 bitop3:0xca
    v_perm_b32 v13, v66, v66, s42
    v_bitop3_b32 v97, v4, v13, v97 bitop3:0xca
    v_mul_hi_u32_u24 v14, 429497, v98
    v_lshrrev_b32 v12, 3, v62
    v_cos_f32 v9, v9
    v_lshlrev_b16 v13, 3, v62
    v_mad_i32_i24 v11, v14, s55, v98
    v_bitop3_b32 v12, v6, v13, v12 bitop3:0xca
    v_lshl_add_u32 v11, v11, 17, s40
    v_lshlrev_b16 v14, 8, v14
    v_lshrrev_b32 v13, 2, v62
    v_add_u32 v98, v12, v11
    v_bitop3_b32 v62, v5, v13, v14 bitop3:0xea
    ds_add_u32 v62, v2
    v_mul_hi_u32_u24 v14, 429497, v99
    v_lshrrev_b32 v12, 3, v63
    v_cos_f32 v10, v10
    v_lshlrev_b16 v13, 3, v63
    v_mad_i32_i24 v11, v14, s55, v99
    v_bitop3_b32 v12, v6, v13, v12 bitop3:0xca
    v_lshl_add_u32 v11, v11, 17, s40
    v_lshlrev_b16 v14, 8, v14
    v_lshrrev_b32 v13, 2, v63
    v_add_u32 v99, v12, v11
    v_bitop3_b32 v63, v5, v13, v14 bitop3:0xea
    ds_add_u32 v63, v2
    v_cvt_pk_bf16_f32 v67, v9, v10
    v_perm_b32 v12, v67, v67, s41
    v_bitop3_b32 v98, v4, v12, v98 bitop3:0xca
    v_perm_b32 v13, v67, v67, s42
    v_bitop3_b32 v99, v4, v13, v99 bitop3:0xca
L1_s8:
    v_lshrrev_b32 v8, 2, v0
    v_and_b32 v7, 0x3c00, v0
    v_bitop3_b32 v7, v5, v8, v7 bitop3:0xea
    s_waitcnt lgkmcnt(0)
    s_barrier
    ds_read2st64_b32 v[8:9], v7 offset0:0 offset1:1
    ds_read2st64_b32 v[10:11], v7 offset0:2 offset1:3
    s_add_u32 s46, s35, 0x7ec4000
    s_add_u32 s46, s46, s93
    buffer_store_dwordx4 v[28:31], v0, s[20:23], s46 offen sc1
    s_waitcnt lgkmcnt(0)
    v_lshl_or_b32 v12, v9, 16, v8
    v_lshl_or_b32 v13, v11, 16, v10
    v_mov_b32 v14, v12
    v_mov_b32 v15, v13
    s_nop 0
    v_add_u32_dpp v14, v14, v14 row_shr:1 row_mask:0xf bank_mask:0xf bound_ctrl:1
    v_add_u32_dpp v15, v15, v15 row_shr:1 row_mask:0xf bank_mask:0xf bound_ctrl:1
    s_nop 0
    v_add_u32_dpp v14, v14, v14 row_shr:2 row_mask:0xf bank_mask:0xf bound_ctrl:1
    v_add_u32_dpp v15, v15, v15 row_shr:2 row_mask:0xf bank_mask:0xf bound_ctrl:1
    s_nop 0
    v_add_u32_dpp v14, v14, v14 row_shr:4 row_mask:0xf bank_mask:0xf bound_ctrl:1
    v_add_u32_dpp v15, v15, v15 row_shr:4 row_mask:0xf bank_mask:0xf bound_ctrl:1
    s_nop 0
    v_add_u32_dpp v14, v14, v14 row_shr:8 row_mask:0xf bank_mask:0xf bound_ctrl:1
    v_add_u32_dpp v15, v15, v15 row_shr:8 row_mask:0xf bank_mask:0xf bound_ctrl:1
    s_nop 0
    v_add_u32_dpp v14, v14, v14 row_bcast:15 row_mask:0xa bank_mask:0xf
    v_add_u32_dpp v15, v15, v15 row_bcast:15 row_mask:0xa bank_mask:0xf
    s_nop 0
    v_add_u32_dpp v14, v14, v14 row_bcast:31 row_mask:0xc bank_mask:0xf
    v_add_u32_dpp v15, v15, v15 row_bcast:31 row_mask:0xc bank_mask:0xf
    v_readlane_b32 s48, v14, 63
    v_readlane_b32 s49, v15, 63
    s_lshl_b32 s54, s32, 2
    v_mov_b32 v8, s54
    s_and_b32 s50, s48, 0xffff
    s_lshr_b32 s51, s48, 16
    s_and_b32 s52, s49, 0xffff
    s_lshr_b32 s53, s49, 16
    s_add_u32 s51, s51, s50
    s_add_u32 s52, s52, s51
    s_add_u32 s53, s53, s52
    v_mov_b32 v9, s53
    v_and_b32_dpp v3, v3, v3 quad_perm:[1,0,3,2] row_mask:0xf bank_mask:0xf
    s_mov_b64 exec, 1
    ds_write_b32 v8, v9 offset:16384
    ds_write_b32 v8, v3 offset:16448
    s_mov_b64 exec, -1
    v_and_b32 v8, 60, v7
    s_waitcnt lgkmcnt(0)
    s_barrier
    ds_read_b32 v9, v8 offset:16384
    ds_read_b32 v10, v8 offset:16448
    s_waitcnt lgkmcnt(0)
    v_readlane_b32 s56, v10, 15
    s_xor_b32 s56, s56, 0x80
    v_add_u32_dpp v9, v9, v9 row_shr:1 row_mask:0xf bank_mask:0xf bound_ctrl:1
    s_nop 1
    v_add_u32_dpp v9, v9, v9 row_shr:2 row_mask:0xf bank_mask:0xf bound_ctrl:1
    s_nop 1
    v_add_u32_dpp v9, v9, v9 row_shr:4 row_mask:0xf bank_mask:0xf bound_ctrl:1
    s_nop 1
    v_add_u32_dpp v9, v9, v9 row_shr:8 row_mask:0xf bank_mask:0xf bound_ctrl:1
    s_nop 0
    v_readlane_b32 s54, v9, s32
    s_sub_u32 s54, s54, s53
    s_add_u32 s50, s50, s54
    s_add_u32 s51, s51, s54
    s_add_u32 s52, s52, s54
    s_pack_ll_b32_b16 s48, s54, s50
    s_pack_ll_b32_b16 s49, s51, s52
    v_add_u32 v14, s48, v14
    v_add_u32 v15, s49, v15
    v_sub_u32 v12, v14, v12
    v_sub_u32 v13, v15, v13
    v_and_b32 v8, 0xffff, v12
    v_lshrrev_b32 v9, 16, v12
    v_and_b32 v10, 0xffff, v13
    v_lshrrev_b32 v11, 16, v13
    ds_write2st64_b32 v7, v8, v9 offset0:0 offset1:1
    ds_write2st64_b32 v7, v10, v11 offset0:2 offset1:3
    v_and_b32 v8, 0x3f0, v0
    v_lshl_add_u32 v8, v8, 1, s36
    ds_write_b64 v8, v[12:13] offset:20480
    s_bitset0_b64 exec, 63
    s_not_b64 exec, exec
    ds_write_b64 v8, v[14:15] offset:20512
    s_mov_b64 exec, -1
    s_waitcnt lgkmcnt(0)
    s_barrier
    s_setprio 3
    ds_add_rtn_u32 v120, v120, v2
    ds_add_rtn_u32 v121, v121, v2
    ds_add_rtn_u32 v122, v122, v2
    ds_add_rtn_u32 v123, v123, v2
    ds_read_b128 v[12:15], v0 offset:20480
    v_cmp_gt_u32 vcc, 8448, v0
    ds_add_rtn_u32 v124, v124, v2
    ds_add_rtn_u32 v125, v125, v2
    ds_add_rtn_u32 v126, v126, v2
    ds_add_rtn_u32 v127, v127, v2
    s_setprio 2
    ds_add_rtn_u32 v24, v24, v2
    ds_add_rtn_u32 v25, v25, v2
    ds_add_rtn_u32 v26, v26, v2
    ds_add_rtn_u32 v27, v27, v2
    s_waitcnt lgkmcnt(8)
    s_cbranch_vccz L1_p9
    s_add_u32 s47, s35, 0xa900000
    s_mov_b64 exec, vcc
    buffer_store_dwordx4 v[12:15], v0, s[24:27], s47 offen sc1
    s_mov_b64 exec, -1
L1_p9:
    s_add_u32 s44, s35, 0x7ec8000
    s_add_u32 s44, s44, s72
    buffer_store_dwordx4 v[112:115], v0, s[20:23], s44 offen sc1
    ds_add_rtn_u32 v52, v52, v2
    ds_add_rtn_u32 v53, v53, v2
    ds_add_rtn_u32 v54, v54, v2
    ds_add_rtn_u32 v55, v55, v2
    s_load_dwordx2 s[28:29], s[0:1], 0
    s_load_dwordx2 s[50:51], s[0:1], 40
    s_load_dwordx2 s[52:53], s[0:1], 24
    s_setprio 1
    ds_add_rtn_u32 v68, v68, v2
    ds_add_rtn_u32 v69, v69, v2
    ds_add_rtn_u32 v70, v70, v2
    ds_add_rtn_u32 v71, v71, v2
    s_cmp_le_u32 s43, 5
    s_cbranch_scc1 L1_s10
    ds_add_rtn_u32 v76, v76, v2
    ds_add_rtn_u32 v77, v77, v2
    ds_add_rtn_u32 v78, v78, v2
    ds_add_rtn_u32 v79, v79, v2
L1_s10:
    s_add_u32 s45, s35, 0x7ec8000
    s_add_u32 s45, s45, s73
    buffer_store_dwordx4 v[88:91], v0, s[20:23], s45 offen sc1
    s_setprio 0
    s_cmp_le_u32 s43, 6
    s_cbranch_scc1 L1_s11
    ds_add_rtn_u32 v56, v56, v2
    ds_add_rtn_u32 v57, v57, v2
    ds_add_rtn_u32 v58, v58, v2
    ds_add_rtn_u32 v59, v59, v2
L1_s11:
    s_cmp_le_u32 s43, 7
    s_cbranch_scc1 L1_s12
    ds_add_rtn_u32 v60, v60, v2
    ds_add_rtn_u32 v61, v61, v2
    ds_add_rtn_u32 v62, v62, v2
    ds_add_rtn_u32 v63, v63, v2
L1_s12:
    s_waitcnt lgkmcnt(0)
    s_barrier
    s_load_dwordx4 s[96:99], s[50:51], 0
    s_mov_b64 s[4:5], s[52:53]
    s_bfe_u32 s33, s2, 0x20001
    s_and_b32 s34, s2, 1
    s_lshl_b32 s34, s34, 5
    s_lshr_b32 s3, s2, 3
    s_add_u32 s34, s34, s3
    s_mul_i32 s39, s33, 2080
    s_lshl_b32 s3, s34, 5
    s_add_u32 s39, s39, s3
    s_mul_i32 s40, s33, 1310720
    s_add_u32 s40, s40, 0x50000
    s_lshl_b32 s38, s32, 11
    s_mul_i32 s100, s32, 3072
    s_add_u32 s8, s30, 0x4000
    s_addc_u32 s9, s31, 0
    s_mov_b32 s10, 0xd340000
    s_mov_b32 s11, 0x20000
    s_add_u32 s12, s30, 0x2c000
    s_addc_u32 s13, s31, 0
    s_mov_b32 s14, 0xd318000
    s_mov_b32 s15, 0x20000
    s_mov_b32 s16, s64
    s_mov_b32 s17, s65
    s_mov_b32 s18, 0x20
    s_mov_b32 s19, 0x20000
    s_mov_b32 s24, s28
    s_mov_b32 s25, s29
    s_mov_b32 s26, 0x4e2000
    s_mov_b32 s27, 0x20000
    s_setprio 3
    v_and_b32 v7, -4, v120
    v_lshl_add_u32 v8, v120, 2, v7
    ds_write_b32 v8, v16
    v_lshl_add_u32 v7, v7, 2, v120
    ds_write_b8 v7, v44 offset:16
    v_and_b32 v9, -4, v121
    v_lshl_add_u32 v10, v121, 2, v9
    ds_write_b32 v10, v17
    v_lshl_add_u32 v9, v9, 2, v121
    ds_write_b8_d16_hi v9, v44 offset:16
    v_and_b32 v7, -4, v122
    v_lshl_add_u32 v8, v122, 2, v7
    ds_write_b32 v8, v18
    v_lshl_add_u32 v7, v7, 2, v122
    ds_write_b8 v7, v45 offset:16
    v_and_b32 v9, -4, v123
    v_lshl_add_u32 v10, v123, 2, v9
    ds_write_b32 v10, v19
    v_lshl_add_u32 v9, v9, 2, v123
    ds_write_b8_d16_hi v9, v45 offset:16
    s_add_u32 s46, s35, 0x7ec8000
    s_add_u32 s46, s46, s85
    buffer_store_dwordx4 v[116:119], v0, s[20:23], s46 offen sc1
    v_and_b32 v13, 0x3f0, v0
    v_and_b32 v14, 0x300, v13
    v_bfe_u32 v15, v13, 4, 4
    s_lshl_b32 s3, s32, 4
    v_add3_u32 v14, v14, v15, s3
    v_mul_u32_u24 v2, 173056, v14
    v_lshrrev_b32 v14, 6, v13
    s_add_u32 s3, s3, 0x400
    v_add_u32 v14, s3, v14
    v_mul_u32_u24 v4, 173056, v14
    v_and_b32 v14, 3, v14
    v_and_b32 v15, 0x30, v13
    v_lshl_add_u32 v14, v14, 5, v15
    v_add_u32 v6, v14, v4
    v_lshl_add_u32 v5, v15, 1, v2
    v_lshrrev_b32 v14, 3, v15
    buffer_load_ushort v100, v14, s[16:19], 0 offen offset:0
    buffer_load_ushort v101, v14, s[16:19], 0 offen offset:8
    buffer_load_ushort v102, v14, s[16:19], 0 offen offset:16
    buffer_load_ushort v103, v14, s[16:19], 0 offen offset:24
    s_mul_i32 s3, s32, 5120
    v_add_u32 v3, s3, v13
    v_lshrrev_b32 v14, 2, v13
    v_add_u32 v14, s38, v14
    v_and_b32 v7, -4, v124
    v_lshl_add_u32 v8, v124, 2, v7
    ds_write_b32 v8, v20
    v_lshl_add_u32 v7, v7, 2, v124
    ds_write_b8 v7, v46 offset:16
    v_and_b32 v9, -4, v125
    v_lshl_add_u32 v10, v125, 2, v9
    ds_write_b32 v10, v21
    v_lshl_add_u32 v9, v9, 2, v125
    ds_write_b8_d16_hi v9, v46 offset:16
    v_and_b32 v7, -4, v126
    v_lshl_add_u32 v8, v126, 2, v7
    ds_write_b32 v8, v22
    v_lshl_add_u32 v7, v7, 2, v126
    ds_write_b8 v7, v47 offset:16
    v_and_b32 v9, -4, v127
    v_lshl_add_u32 v10, v127, 2, v9
    ds_write_b32 v10, v23
    v_lshl_add_u32 v9, v9, 2, v127
    ds_write_b8_d16_hi v9, v47 offset:16
    v_lshrrev_b32 v11, 2, v0
    v_and_b32 v11, 0xfc, v11
    s_cmp_ge_u32 s84, 128
    s_cselect_b32 s82, 0, s82
    s_mul_i32 s3, s84, 40
    s_add_u32 s3, s3, s32
    s_mul_i32 s76, s3, 52429
    s_lshr_b32 s76, s76, 22
    s_mul_i32 s74, s76, 80
    s_sub_u32 s3, s3, s74
    s_mul_i32 s74, s3, 205
    s_lshr_b32 s74, s74, 10
    s_mul_i32 s75, s74, 5
    s_sub_u32 s75, s3, s75
    s_lshl_b32 s48, s74, 1
    s_add_u32 s48, s48, s75
    s_add_u32 s49, s48, s74
    s_add_u32 s49, s49, 30
    s_cmp_lt_u32 s75, 2
    s_cselect_b32 s48, s48, s49
    s_lshl_b32 s48, s48, 10
    s_mul_i32 s49, s76, 80000
    s_add_u32 s48, s48, s49
    buffer_load_dword v104, v11, s[80:83], s48 offen offset:0
    buffer_load_dword v105, v11, s[80:83], s48 offen offset:256
    buffer_load_dword v106, v11, s[80:83], s48 offen offset:512
    buffer_load_dword v107, v11, s[80:83], s48 offen offset:768
    s_mul_i32 s3, s84, 40
    s_add_u32 s3, s3, s32
    s_add_u32 s3, s3, 16
    s_mul_i32 s76, s3, 52429
    s_lshr_b32 s76, s76, 22
    s_mul_i32 s74, s76, 80
    s_sub_u32 s3, s3, s74
    s_mul_i32 s74, s3, 205
    s_lshr_b32 s74, s74, 10
    s_mul_i32 s75, s74, 5
    s_sub_u32 s75, s3, s75
    s_lshl_b32 s48, s74, 1
    s_add_u32 s48, s48, s75
    s_add_u32 s49, s48, s74
    s_add_u32 s49, s49, 30
    s_cmp_lt_u32 s75, 2
    s_cselect_b32 s48, s48, s49
    s_lshl_b32 s48, s48, 10
    s_mul_i32 s49, s76, 80000
    s_add_u32 s48, s48, s49
    buffer_load_dword v28, v11, s[80:83], s48 offen offset:0
    buffer_load_dword v29, v11, s[80:83], s48 offen offset:256
    buffer_load_dword v30, v11, s[80:83], s48 offen offset:512
    buffer_load_dword v31, v11, s[80:83], s48 offen offset:768
    s_mul_i32 s3, s84, 40
    s_add_u32 s3, s3, s32
    s_add_u32 s3, s3, 32
    s_mul_i32 s76, s3, 52429
    s_lshr_b32 s76, s76, 22
    s_mul_i32 s74, s76, 80
    s_sub_u32 s3, s3, s74
    s_cmp_ge_u32 s32, 8
    s_cselect_b32 s82, 0, s82
    s_mul_i32 s74, s3, 205
    s_lshr_b32 s74, s74, 10
    s_mul_i32 s75, s74, 5
    s_sub_u32 s75, s3, s75
    s_lshl_b32 s48, s74, 1
    s_add_u32 s48, s48, s75
    s_add_u32 s49, s48, s74
    s_add_u32 s49, s49, 30
    s_cmp_lt_u32 s75, 2
    s_cselect_b32 s48, s48, s49
    s_lshl_b32 s48, s48, 10
    s_mul_i32 s49, s76, 80000
    s_add_u32 s48, s48, s49
    buffer_load_dword v112, v11, s[80:83], s48 offen offset:0
    buffer_load_dword v113, v11, s[80:83], s48 offen offset:256
    buffer_load_dword v114, v11, s[80:83], s48 offen offset:512
    buffer_load_dword v115, v11, s[80:83], s48 offen offset:768
    s_setprio 2
    v_and_b32 v7, -4, v24
    v_lshl_add_u32 v8, v24, 2, v7
    ds_write_b32 v8, v40
    v_lshl_add_u32 v7, v7, 2, v24
    ds_write_b8 v7, v32 offset:16
    v_and_b32 v9, -4, v25
    v_lshl_add_u32 v10, v25, 2, v9
    ds_write_b32 v10, v41
    v_lshl_add_u32 v9, v9, 2, v25
    ds_write_b8_d16_hi v9, v32 offset:16
    v_and_b32 v7, -4, v26
    v_lshl_add_u32 v8, v26, 2, v7
    ds_write_b32 v8, v42
    v_lshl_add_u32 v7, v7, 2, v26
    ds_write_b8 v7, v33 offset:16
    v_and_b32 v9, -4, v27
    v_lshl_add_u32 v10, v27, 2, v9
    ds_write_b32 v10, v43
    v_lshl_add_u32 v9, v9, 2, v27
    ds_write_b8_d16_hi v9, v33 offset:16
    s_add_u32 s47, s35, 0x7ec8000
    s_add_u32 s47, s47, s91
    buffer_store_dwordx4 v[92:95], v0, s[20:23], s47 offen sc1
    v_and_b32 v7, -4, v52
    v_lshl_add_u32 v8, v52, 2, v7
    ds_write_b32 v8, v48
    v_lshl_add_u32 v7, v7, 2, v52
    ds_write_b8 v7, v34 offset:16
    v_and_b32 v9, -4, v53
    v_lshl_add_u32 v10, v53, 2, v9
    ds_write_b32 v10, v49
    v_lshl_add_u32 v9, v9, 2, v53
    ds_write_b8_d16_hi v9, v34 offset:16
    v_and_b32 v7, -4, v54
    v_lshl_add_u32 v8, v54, 2, v7
    ds_write_b32 v8, v50
    v_lshl_add_u32 v7, v7, 2, v54
    ds_write_b8 v7, v35 offset:16
    v_and_b32 v9, -4, v55
    v_lshl_add_u32 v10, v55, 2, v9
    ds_write_b32 v10, v51
    v_lshl_add_u32 v9, v9, 2, v55
    ds_write_b8_d16_hi v9, v35 offset:16
    s_setprio 1
    v_and_b32 v7, -4, v68
    v_lshl_add_u32 v8, v68, 2, v7
    ds_write_b32 v8, v84
    v_lshl_add_u32 v7, v7, 2, v68
    ds_write_b8 v7, v72 offset:16
    v_and_b32 v9, -4, v69
    v_lshl_add_u32 v10, v69, 2, v9
    ds_write_b32 v10, v85
    v_lshl_add_u32 v9, v9, 2, v69
    ds_write_b8_d16_hi v9, v72 offset:16
    v_and_b32 v7, -4, v70
    v_lshl_add_u32 v8, v70, 2, v7
    ds_write_b32 v8, v86
    v_lshl_add_u32 v7, v7, 2, v70
    ds_write_b8 v7, v73 offset:16
    v_and_b32 v9, -4, v71
    v_lshl_add_u32 v10, v71, 2, v9
    ds_write_b32 v10, v87
    v_lshl_add_u32 v9, v9, 2, v71
    ds_write_b8_d16_hi v9, v73 offset:16
    s_cmp_le_u32 s43, 5
    s_cbranch_scc1 L1_s13
    v_and_b32 v7, -4, v76
    v_lshl_add_u32 v8, v76, 2, v7
    ds_write_b32 v8, v36
    v_lshl_add_u32 v7, v7, 2, v76
    ds_write_b8 v7, v74 offset:16
    v_and_b32 v9, -4, v77
    v_lshl_add_u32 v10, v77, 2, v9
    ds_write_b32 v10, v37
    v_lshl_add_u32 v9, v9, 2, v77
    ds_write_b8_d16_hi v9, v74 offset:16
    v_and_b32 v7, -4, v78
    v_lshl_add_u32 v8, v78, 2, v7
    ds_write_b32 v8, v38
    v_lshl_add_u32 v7, v7, 2, v78
    ds_write_b8 v7, v75 offset:16
    v_and_b32 v9, -4, v79
    v_lshl_add_u32 v10, v79, 2, v9
    ds_write_b32 v10, v39
    v_lshl_add_u32 v9, v9, 2, v79
    ds_write_b8_d16_hi v9, v75 offset:16
L1_s13:
    s_add_u32 s44, s35, 0x7ec8000
    s_add_u32 s44, s44, s93
    buffer_store_dwordx4 v[108:111], v0, s[20:23], s44 offen sc1
    s_setprio 0
    s_cmp_le_u32 s43, 6
    s_cbranch_scc1 L1_s14
    v_and_b32 v7, -4, v56
    v_lshl_add_u32 v8, v56, 2, v7
    ds_write_b32 v8, v80
    v_lshl_add_u32 v7, v7, 2, v56
    ds_write_b8 v7, v64 offset:16
    v_and_b32 v9, -4, v57
    v_lshl_add_u32 v10, v57, 2, v9
    ds_write_b32 v10, v81
    v_lshl_add_u32 v9, v9, 2, v57
    ds_write_b8_d16_hi v9, v64 offset:16
    v_and_b32 v7, -4, v58
    v_lshl_add_u32 v8, v58, 2, v7
    ds_write_b32 v8, v82
    v_lshl_add_u32 v7, v7, 2, v58
    ds_write_b8 v7, v65 offset:16
    v_and_b32 v9, -4, v59
    v_lshl_add_u32 v10, v59, 2, v9
    ds_write_b32 v10, v83
    v_lshl_add_u32 v9, v9, 2, v59
    ds_write_b8_d16_hi v9, v65 offset:16
L1_s14:
    s_add_u32 s80, s30, 0xd344000
    s_addc_u32 s81, s31, 0
    s_mov_b32 s82, 0xa000
    s_mov_b32 s83, 0x20000
    s_min_u32 s3, s84, 127
    s_mul_i32 s3, s3, 40960
    s_add_u32 s80, s80, s3
    s_addc_u32 s81, s81, 0
    s_cmp_ge_u32 s84, 128
    s_cselect_b32 s82, 0, s82
    s_waitcnt vmcnt(2)
    v_add_u32 v11, 0, v0
    buffer_store_dwordx4 v[104:107], v11, s[80:83], 0 offen sc1
    v_add_u32 v11, 16384, v0
    buffer_store_dwordx4 v[28:31], v11, s[80:83], 0 offen sc1
    v_add_u32 v11, 32768, v0
    buffer_store_dwordx4 v[112:115], v11, s[80:83], 0 offen sc1
    s_cmp_le_u32 s43, 7
    s_cbranch_scc1 L1_s15
    v_and_b32 v7, -4, v60
    v_lshl_add_u32 v8, v60, 2, v7
    ds_write_b32 v8, v96
    v_lshl_add_u32 v7, v7, 2, v60
    ds_write_b8 v7, v66 offset:16
    v_and_b32 v9, -4, v61
    v_lshl_add_u32 v10, v61, 2, v9
    ds_write_b32 v10, v97
    v_lshl_add_u32 v9, v9, 2, v61
    ds_write_b8_d16_hi v9, v66 offset:16
    v_and_b32 v7, -4, v62
    v_lshl_add_u32 v8, v62, 2, v7
    ds_write_b32 v8, v98
    v_lshl_add_u32 v7, v7, 2, v62
    ds_write_b8 v7, v67 offset:16
    v_and_b32 v9, -4, v63
    v_lshl_add_u32 v10, v63, 2, v9
    ds_write_b32 v10, v99
    v_lshl_add_u32 v9, v9, 2, v63
    ds_write_b8_d16_hi v9, v67 offset:16
L1_s15:
    v_add_u32 v7, 0x10000, v0
    v_add_u32 v12, 0x20000, v0
    s_waitcnt lgkmcnt(0)
    s_barrier
    ds_read_b128 v[24:27], v0 offset:0
    ds_read_b128 v[28:31], v0 offset:16384
    ds_read_b128 v[32:35], v0 offset:32768
    ds_read_b128 v[36:39], v0 offset:49152
    ds_read_b128 v[76:79], v7 offset:0
    ds_read_b128 v[80:83], v7 offset:16384
    ds_read_b128 v[84:87], v7 offset:32768
    ds_read_b128 v[104:107], v7 offset:49152
    ds_read_b128 v[68:71], v12 offset:0
    ds_read_b128 v[72:75], v12 offset:16384
    s_cmp_lg_u32 s32, 0
    s_cbranch_scc1 L2_sg1
    s_mov_b32 exec_hi, 0
    v_mov_b32 v11, 1
    buffer_store_dword v11, v14, s[60:63], s57 offen sc1
    s_mov_b64 exec, -1
L2_sg1:
    s_waitcnt lgkmcnt(9)
    s_add_u32 s45, s35, 0xa904000
    buffer_store_dwordx4 v[24:27], v0, s[20:23], s45 offen sc1
    s_waitcnt lgkmcnt(8)
    s_add_u32 s46, s35, 0xa908000
    buffer_store_dwordx4 v[28:31], v0, s[20:23], s46 offen sc1
    s_waitcnt lgkmcnt(7)
    s_add_u32 s47, s35, 0xa90c000
    buffer_store_dwordx4 v[32:35], v0, s[20:23], s47 offen sc1
    s_waitcnt lgkmcnt(6)
    s_add_u32 s44, s35, 0xa910000
    buffer_store_dwordx4 v[36:39], v0, s[20:23], s44 offen sc1
    s_waitcnt lgkmcnt(5)
    s_add_u32 s45, s35, 0xa914000
    buffer_store_dwordx4 v[76:79], v0, s[20:23], s45 offen sc1
    s_waitcnt lgkmcnt(4)
    s_add_u32 s46, s35, 0xa918000
    buffer_store_dwordx4 v[80:83], v0, s[20:23], s46 offen sc1
    s_waitcnt lgkmcnt(3)
    s_add_u32 s47, s35, 0xa91c000
    buffer_store_dwordx4 v[84:87], v0, s[20:23], s47 offen sc1
    s_waitcnt lgkmcnt(2)
    s_cmp_le_u32 s43, 5
    s_cbranch_scc1 L1_q16
    s_add_u32 s44, s35, 0xa920000
    buffer_store_dwordx4 v[104:107], v0, s[20:23], s44 offen sc1
L1_q16:
    s_waitcnt lgkmcnt(1)
    s_cmp_le_u32 s43, 6
    s_cbranch_scc1 L1_q17
    s_add_u32 s45, s35, 0xa924000
    buffer_store_dwordx4 v[68:71], v0, s[20:23], s45 offen sc1
L1_q17:
    s_waitcnt lgkmcnt(0)
    s_cmp_le_u32 s43, 7
    s_cbranch_scc1 L1_q18
    s_add_u32 s46, s35, 0xa928000
    buffer_store_dwordx4 v[72:75], v0, s[20:23], s46 offen sc1
L1_q18:
    s_waitcnt lgkmcnt(0)
    s_setprio 3
    v_mov_b32 v92, v0
    v_mov_b32 v93, v6
    v_mov_b32 v94, v13
    v_mov_b32 v95, v5
    v_mov_b32 v0, v14
    v_lshl_add_u32 v7, v13, 3, s38
    v_lshrrev_b32 v16, 2, v15
    v_mad_u32_u24 v4, v16, 5, v4
    v_or_b32 v4, 0xf0000000, v4
    v_or_b32 v2, 0xf0000000, v2
    v_sub_u32 v1, 28, v16
    v_lshrrev_b32 v17, 2, v16
    v_and_b32 v18, 3, v17
    v_lshlrev_b32 v18, 4, v18
    v_mov_b32 v10, 0x3f80
    v_mov_b32 v11, 0
    v_lshlrev_b64 v[10:11], v18, v[10:11]
    v_and_b32 v18, 3, v17
    v_lshlrev_b32 v18, 4, v18
    v_mov_b32 v12, 0xbf80
    v_mov_b32 v13, 0
    v_lshlrev_b64 v[12:13], v18, v[12:13]
    v_mov_b32 v45, 0xf0000000
    v_add_u32 v44, s38, v0
    v_lshrrev_b32 v44, 1, v44
    v_and_b32 v44, -4, v44
    v_mov_b32 v5, 0x1fff8
    v_mov_b32 v6, 0x07ff0000
    v_mov_b32 v16, 0
    v_mov_b32 v17, 0
    v_mov_b32 v18, 0
    v_mov_b32 v19, 0
    v_add_u32 v20, 81920, v92
    v_add_u32 v21, 0x10000, v20
    s_setprio 1
    s_setprio 2
    s_mov_b32 s44, 0x4000c0c
    s_mov_b32 s45, 0x4010c0c
    s_mov_b32 s46, 0x4020c0c
    s_mov_b32 s47, 0x4030c0c
    s_mov_b32 s36, 0
    s_mov_b32 s43, 0
    s_mov_b32 s42, 0
    s_mov_b64 s[80:81], 0
    s_mov_b64 s[48:49], 0
    s_add_u32 s16, s30, 0xd344000
    s_addc_u32 s17, s31, 0
    s_mov_b32 s18, 0x500000
    s_mov_b32 s19, 0x20000
    v_mov_b32 v68, 0
    v_mov_b32 v69, 0
    v_mov_b32 v70, 0
    v_mov_b32 v71, 0
    v_mov_b32 v72, 0
    v_mov_b32 v73, 0
    v_mov_b32 v74, 0
    v_mov_b32 v75, 0
    s_waitcnt vmcnt(0)
    v_lshl_or_b32 v8, v101, 16, v100
    v_lshl_or_b32 v9, v103, 16, v102
    s_barrier
    s_cmp_lg_u32 s32, 0
    s_cbranch_scc1 L2_sg2
    s_mov_b32 exec_hi, 0
    v_mov_b32 v88, 2
    buffer_store_dword v88, v0, s[60:63], s57 offen sc1
    s_mov_b64 exec, -1
L2_sg2:
    s_mov_b64 s[84:85], 0
    s_mul_i32 s3, s33, 1280000
    s_add_u32 s3, s3, s100
    s_add_u32 s3, s3, 32768
    buffer_load_dwordx4 v[124:127], v94, s[24:27], s3 offen offset:2048
    s_mul_i32 s3, s33, 1280000
    s_add_u32 s3, s3, s100
    s_add_u32 s3, s3, 32768
    buffer_load_dwordx4 v[116:119], v94, s[24:27], s3 offen offset:0
    s_mul_i32 s3, s33, 1280000
    s_add_u32 s3, s3, s100
    s_add_u32 s3, s3, 32768
    buffer_load_dwordx4 v[120:123], v94, s[24:27], s3 offen offset:1024
    s_mul_i32 s3, s33, 1280000
    s_add_u32 s3, s3, s38
    s_add_u32 s3, s3, 0
    buffer_load_dwordx4 v[108:111], v94, s[24:27], s3 offen offset:0
    s_mul_i32 s3, s33, 1280000
    s_add_u32 s3, s3, s38
    s_add_u32 s3, s3, 0
    buffer_load_dwordx4 v[112:115], v94, s[24:27], s3 offen offset:1024
    ds_write_b128 v20, v[16:19] offset:0
    ds_write_b128 v20, v[16:19] offset:16384
    ds_write_b128 v20, v[16:19] offset:32768
    ds_write_b128 v20, v[16:19] offset:49152
    ds_write_b128 v21, v[16:19]
    s_cmp_eq_u32 s56, 0
    s_cbranch_scc1 L2_e3
    v_lshlrev_b32 v16, 3, v94
    v_and_b32 v16, 0x80, v16
L2_e4:
    buffer_load_dword v88, v16, s[68:71], 0 offen sc1
    s_waitcnt vmcnt(0)
    v_cmp_gt_u32 vcc, 0x80, v88
    s_cbranch_vccnz L2_e4
L2_e3:
    s_mov_b64 exec, 0xffff
L2_p1:
    buffer_load_dword v88, v7, s[60:63], 0 offen sc1
    s_waitcnt vmcnt(0)
    v_cmpx_gt_u32 vcc, 1, v88
    s_cbranch_vccnz L2_p1
    s_mov_b64 exec, -1
    v_cmp_gt_u32 vcc, 2, v88
    s_and_b32 s56, vcc_lo, 0xffff
    buffer_load_dwordx4 v[48:51], v95, s[12:15], s39 offen offset:0
    buffer_load_dwordx4 v[56:59], v95, s[12:15], s39 offen offset:32
    buffer_load_dwordx4 v[52:55], v95, s[12:15], s39 offen offset:16
    buffer_load_dwordx4 v[60:63], v95, s[12:15], s39 offen offset:48
    buffer_load_dwordx4 v[64:67], v93, s[12:15], s39 offen
    s_waitcnt vmcnt(0)
    v_sub_u16 v88, v56, v48
    v_and_b32 v89, 3, v48
    v_add3_u32 v99, v88, v89, 3
    v_and_b32 v99, -4, v99
    v_max_u32 v99, 4, v99
    v_and_b32 v97, 0xfffc, v48
    v_bfm_b32 v96, v88, v89
    v_add_u32_dpp v91, v99, v99 row_shr:1 row_mask:0xf bank_mask:0xf bound_ctrl:1
    v_mad_u32_u24 v97, v97, 5, v2
    v_cmp_lt_u32 vcc, 16, v99
    v_add_u32_dpp v91, v91, v91 row_shr:2 row_mask:0xf bank_mask:0xf bound_ctrl:1
    v_sub_u32 v98, s38, v99
    v_lshrrev_b64 v[48:49], 16, v[48:49]
    v_add_u32_dpp v91, v91, v91 row_shr:4 row_mask:0xf bank_mask:0xf bound_ctrl:1
    v_lshrrev_b64 v[56:57], 16, v[56:57]
    s_mov_b32 s101, 0
    v_add_u32_dpp v91, v91, v91 row_shr:8 row_mask:0xf bank_mask:0xf bound_ctrl:1
    s_nop 1
    v_add_u32_dpp v91, v91, v91 row_bcast:15 row_mask:0xa bank_mask:0xf
    s_nop 1
    v_add_u32_dpp v91, v91, v91 row_bcast:31 row_mask:0xc bank_mask:0xf
    v_add_u32 v98, v98, v91
    v_readlane_b32 s37, v91, 63
    s_cbranch_vccnz L2_xo3
L2_xp3:
    s_cmp_gt_u32 s37, 1024
    s_cbranch_scc1 L2_xs4
    s_cmp_lg_u32 s101, 0
    s_cbranch_scc1 L2_xa4
L2_xb4:
    v_lshlrev_b32 v89, 16, v96
    v_add_u32 v90, 60, v97
    v_bitop3_b32 v90, v89, v45, v90 bitop3:0x6a
    ds_write_b32 v98, v90 offset:12
    v_lshlrev_b32 v89, 20, v96
    v_add_u32 v90, 40, v97
    v_bitop3_b32 v90, v89, v45, v90 bitop3:0x6a
    ds_write_b32 v98, v90 offset:8
    v_lshlrev_b32 v89, 24, v96
    v_add_u32 v90, 20, v97
    v_bitop3_b32 v90, v89, v45, v90 bitop3:0x6a
    ds_write_b32 v98, v90 offset:4
    v_lshlrev_b32 v89, 28, v96
    v_bitop3_b32 v90, v89, v45, v97 bitop3:0x6a
    ds_write_b32 v98, v90 offset:0
    v_mov_b32_dpp v91, v64 quad_perm:[0,0,0,0] row_mask:0xf bank_mask:0xf
    v_and_b32 v89, 3, v91
    v_and_b32 v97, 0xfffc, v91
    v_sub_u16_dpp v88, v64, v91 quad_perm:[2,2,2,2] row_mask:0xf bank_mask:0xf
    v_mad_u32_u24 v97, v97, 5, v4
    v_add_u32 v99, v88, v89
    v_bfm_b32 v96, v88, v89
    v_cmp_lt_u32 s[58:59], 16, v99
    v_lshlrev_b32 v89, v1, v96
    v_and_b32 v89, v45, v89
    v_cmp_ne_u32 vcc, 0, v89
    v_xor_b32 v90, v97, v89
    s_add_u32 s3, s37, s38
    v_mbcnt_lo_u32_b32 v98, vcc_lo, 0
    v_mbcnt_hi_u32_b32 v98, vcc_hi, v98
    s_bcnt1_i32_b64 s41, vcc
    v_lshl_add_u32 v98, v98, 2, s3
    s_lshl2_add_u32 s37, s41, s37
    s_mov_b64 exec, vcc
    ds_write_b32 v98, v90
    s_mov_b64 exec, -1
    s_cmp_lg_u64 s[58:59], 0
    s_cbranch_scc1 L2_xe4
L2_xr4:
    v_add_u32 v98, s37, v0
    v_mov_b32 v90, -1
    ds_write_b32 v98, v90
L2_xw4:
    ds_read_b32 v21, v0 offset:0
    ds_read_b32 v27, v0 offset:256
    ds_read_b32 v31, v44 offset:768
    ds_read_b32 v39, v0 offset:512
    s_sub_u32 s3, s37, 768
    s_cmp_gt_u32 s3, 128
    s_cbranch_scc1 L2_xf4
L2_xg4:
    v_sub_u16 v88, v58, v50
    v_and_b32 v89, 3, v50
    v_add3_u32 v99, v88, v89, 3
    v_and_b32 v99, -4, v99
    v_max_u32 v99, 4, v99
    v_and_b32 v97, 0xfffc, v50
    v_bfm_b32 v96, v88, v89
    v_add_u32_dpp v91, v99, v99 row_shr:1 row_mask:0xf bank_mask:0xf bound_ctrl:1
    v_mad_u32_u24 v97, v97, 5, v2
    v_cmp_lt_u32 vcc, 16, v99
    v_add_u32_dpp v91, v91, v91 row_shr:2 row_mask:0xf bank_mask:0xf bound_ctrl:1
    v_sub_u32 v98, s38, v99
    v_lshrrev_b64 v[50:51], 16, v[50:51]
    v_add_u32_dpp v91, v91, v91 row_shr:4 row_mask:0xf bank_mask:0xf bound_ctrl:1
    v_lshrrev_b64 v[58:59], 16, v[58:59]
    s_mov_b32 s101, 0
    v_add_u32_dpp v91, v91, v91 row_shr:8 row_mask:0xf bank_mask:0xf bound_ctrl:1
    s_nop 1
    v_add_u32_dpp v91, v91, v91 row_bcast:15 row_mask:0xa bank_mask:0xf
    s_nop 1
    v_add_u32_dpp v91, v91, v91 row_bcast:31 row_mask:0xc bank_mask:0xf
    v_add_u32 v98, v98, v91
    v_readlane_b32 s37, v91, 63
    s_cbranch_vccnz L2_xo5
L2_xp5:
    s_waitcnt lgkmcnt(0)
    s_cmp_gt_u32 s37, 1024
    s_cbranch_scc1 L2_xs6
    s_cmp_lg_u32 s101, 0
    s_cbranch_scc1 L2_xa6
L2_xb6:
    v_lshlrev_b32 v89, 16, v96
    v_add_u32 v90, 60, v97
    v_bitop3_b32 v90, v89, v45, v90 bitop3:0x6a
    ds_write_b32 v98, v90 offset:12
    v_lshlrev_b32 v89, 20, v96
    v_add_u32 v90, 40, v97
    v_bitop3_b32 v90, v89, v45, v90 bitop3:0x6a
    ds_write_b32 v98, v90 offset:8
    v_lshlrev_b32 v89, 24, v96
    v_add_u32 v90, 20, v97
    v_bitop3_b32 v90, v89, v45, v90 bitop3:0x6a
    ds_write_b32 v98, v90 offset:4
    v_lshlrev_b32 v89, 28, v96
    v_bitop3_b32 v90, v89, v45, v97 bitop3:0x6a
    ds_write_b32 v98, v90 offset:0
    v_mov_b32_dpp v91, v66 quad_perm:[0,0,0,0] row_mask:0xf bank_mask:0xf
    v_and_b32 v89, 3, v91
    v_and_b32 v97, 0xfffc, v91
    v_sub_u16_dpp v88, v66, v91 quad_perm:[2,2,2,2] row_mask:0xf bank_mask:0xf
    v_mad_u32_u24 v97, v97, 5, v4
    v_add_u32 v99, v88, v89
    v_bfm_b32 v96, v88, v89
    v_cmp_lt_u32 s[58:59], 16, v99
    v_lshlrev_b32 v89, v1, v96
    v_and_b32 v89, v45, v89
    v_cmp_ne_u32 vcc, 0, v89
    v_xor_b32 v90, v97, v89
    s_add_u32 s3, s37, s38
    v_mbcnt_lo_u32_b32 v98, vcc_lo, 0
    v_mbcnt_hi_u32_b32 v98, vcc_hi, v98
    s_bcnt1_i32_b64 s41, vcc
    v_lshl_add_u32 v98, v98, 2, s3
    s_lshl2_add_u32 s37, s41, s37
    s_mov_b64 exec, vcc
    ds_write_b32 v98, v90
    s_mov_b64 exec, -1
    s_cmp_lg_u64 s[58:59], 0
    s_cbranch_scc1 L2_xe6
L2_xr6:
    v_add_u32 v98, s37, v0
    v_mov_b32 v90, -1
    ds_write_b32 v98, v90
L2_xw6:
    ds_read_b32 v40, v0 offset:0
    ds_read_b32 v41, v0 offset:256
    ds_read_b32 v42, v44 offset:768
    ds_read_b32 v43, v0 offset:512
    s_sub_u32 s3, s37, 768
    s_cmp_gt_u32 s3, 128
    s_cbranch_scc1 L2_xf6
L2_xg6:
    v_subrev_u32 v88, s38, v3
    ds_write_b128 v88, v[124:127] offset:34816
    v_subrev_u32 v88, s38, v3
    ds_write_b128 v88, v[116:119] offset:32768
    v_subrev_u32 v88, s38, v3
    ds_write_b128 v88, v[120:123] offset:33792
    v_subrev_u32 v88, s100, v3
    ds_write_b128 v88, v[108:111] offset:0
    v_subrev_u32 v88, s100, v3
    ds_write_b128 v88, v[112:115] offset:1024
    s_cmp_eq_u32 s56, 0
    s_cbranch_scc1 L2_e2
    s_mov_b32 exec_lo, s56
    s_mov_b32 exec_hi, 0
    buffer_load_dword v88, v7, s[60:63], 0 offen sc1
    s_mov_b64 exec, -1
    s_waitcnt vmcnt(0)
    v_cmp_gt_u32 vcc, 2, v88
    s_and_b32 s56, vcc_lo, s56
    s_cbranch_scc0 L2_e2
    s_mul_i32 s3, s33, 1280000
    s_add_u32 s3, s3, s100
    s_add_u32 s3, s3, 352768
    buffer_load_dwordx4 v[124:127], v94, s[24:27], s3 offen offset:2048
    s_mul_i32 s3, s33, 1280000
    s_add_u32 s3, s3, s100
    s_add_u32 s3, s3, 352768
    buffer_load_dwordx4 v[116:119], v94, s[24:27], s3 offen offset:0
    s_mul_i32 s3, s33, 1280000
    s_add_u32 s3, s3, s100
    s_add_u32 s3, s3, 352768
    buffer_load_dwordx4 v[120:123], v94, s[24:27], s3 offen offset:1024
    s_mul_i32 s3, s33, 1280000
    s_add_u32 s3, s3, s38
    s_add_u32 s3, s3, 320000
    buffer_load_dwordx4 v[108:111], v94, s[24:27], s3 offen offset:0
    s_mul_i32 s3, s33, 1280000
    s_add_u32 s3, s3, s38
    s_add_u32 s3, s3, 320000
    buffer_load_dwordx4 v[112:115], v94, s[24:27], s3 offen offset:1024
    s_mov_b32 exec_lo, s56
    s_mov_b32 exec_hi, 0
L2_p2:
    buffer_load_dword v88, v7, s[60:63], 0 offen sc1
    s_waitcnt vmcnt(0)
    v_cmpx_gt_u32 vcc, 2, v88
    s_cbranch_vccnz L2_p2
    s_mov_b64 exec, -1
L2_e2:
    s_mov_b32 s6, 0xaaaaaaaa
    s_mov_b32 s7, 0xaaaaaaaa
    v_and_b32 v47, 0x0fffffff, v21
    buffer_load_dwordx2 v[16:17], v47, s[8:11], 0 offen
    buffer_load_dwordx3 v[18:20], v47, s[8:11], 0 offen offset:8
    s_setprio 1
    v_and_b32 v47, 0x0fffffff, v27
    buffer_load_dwordx2 v[22:23], v47, s[8:11], 0 offen
    buffer_load_dwordx3 v[24:26], v47, s[8:11], 0 offen offset:8
    s_waitcnt lgkmcnt(0)
    s_barrier
    s_bitcmp1_b32 s36, s42
    s_cbranch_scc1 L2_slow
L2_ret0:
    s_setprio 3
    s_bitcmp1_b32 s43, s42
    s_cbranch_scc1 L2_oa7
L2_ob7:
    s_bitcmp1_b32 s43, s42
    s_cbranch_scc1 L2_oa8
L2_ob8:
    s_waitcnt vmcnt(2)
    v_and_b32 v46, 0x20000000, v21
    v_lshrrev_b32 v47, 14, v17
    v_bitop3_b32 v47, v47, v5, v46 bitop3:0xea
    ds_read_b64 v[102:103], v47
    v_bitop3_b32 v93, v17, v5, v46 bitop3:0xea
    v_and_b32 v46, 0x10000000, v21
    v_lshrrev_b32 v47, 14, v16
    v_bitop3_b32 v47, v47, v5, v46 bitop3:0xea
    ds_read_b64 v[100:101], v47
    v_bitop3_b32 v92, v16, v5, v46 bitop3:0xea
    v_perm_b32 v15, v17, v20, s45
    v_bitop3_b32 v46, v17, 0.5, -0.5 bitop3:0xa8
    v_perm_b32 v14, v16, v20, s44
    v_bitop3_b32 v47, v16, 0.5, -0.5 bitop3:0xa8
    v_bitop3_b32 v15, v6, v15, v46 bitop3:0xca
    v_bitop3_b32 v14, v6, v14, v47 bitop3:0xca
    s_waitcnt lgkmcnt(0)
    v_mfma_f32_4x4x4_16b_bf16 v[80:83], v[8:9], v[102:103], 0
    v_mfma_f32_4x4x4_16b_bf16 v[76:79], v[8:9], v[100:101], 0
    v_cmp_lt_u32 s[84:85], v5, v92
    s_nop 2
    v_pk_mul_f32 v[80:81], v[80:81], v[14:15] op_sel:[0,1] op_sel_hi:[1,1]
    v_pk_mul_f32 v[82:83], v[82:83], v[14:15] op_sel:[0,1] op_sel_hi:[1,1]
    v_pk_mul_f32 v[76:77], v[76:77], v[14:15] op_sel:[0,0] op_sel_hi:[1,0]
    v_pk_mul_f32 v[78:79], v[78:79], v[14:15] op_sel:[0,0] op_sel_hi:[1,0]
    v_and_b32 v47, 0x0fffffff, v39
    buffer_load_dwordx2 v[34:35], v47, s[8:11], 0 offen
    buffer_load_dwordx3 v[36:38], v47, s[8:11], 0 offen offset:8
    v_and_b32 v46, 0x80000000, v21
    v_lshrrev_b32 v47, 14, v19
    v_bitop3_b32 v47, v47, v5, v46 bitop3:0xea
    ds_read_b64 v[106:107], v47
    v_and_b32 v99, 0x40000000, v21
    v_lshrrev_b32 v47, 14, v18
    v_bitop3_b32 v47, v47, v5, v99 bitop3:0xea
    ds_read_b64 v[104:105], v47
    v_cmp_ne_u64 s[50:51], v[72:73], v[68:69]
    v_cmpx_ne_u64 s[54:55], v[74:75], v[70:71]
    s_and_b64 s[82:83], s[54:55], s[80:81]
    s_cbranch_scc1 L2_c9
L2_d9:
    v_mov_b64 v[84:85], v[70:71]
    v_mov_b32 v7, v95
    v_mov_b64 v[86:87], v[74:75]
    s_or_b64 s[80:81], s[80:81], s[54:55]
    s_mov_b64 exec, s[50:51]
    s_and_b64 s[82:83], s[50:51], s[80:81]
    s_cbranch_scc1 L2_c10
L2_d10:
    v_mov_b64 v[84:85], v[68:69]
    v_mov_b32 v7, v94
    v_mov_b64 v[86:87], v[72:73]
    s_mov_b64 exec, -1
    s_or_b64 s[80:81], s[80:81], s[50:51]
    s_and_b64 exec, s[84:85], s[80:81]
    v_mfma_f32_4x4x4_16b_bf16 v[76:79], v[12:13], v[84:85], 0
    v_mov_b32 v92, v7
    s_andn2_b64 s[80:81], s[80:81], s[84:85]
    v_mfma_f32_4x4x4_16b_bf16 v[76:79], v[10:11], v[86:87], v[76:79]
    s_mov_b64 exec, -1
    ds_read_b64 v[70:71], v93 offset:65408
    ds_read_b64 v[68:69], v92 offset:65408
    v_bitop3_b32 v94, v18, v5, v99 bitop3:0xea
    v_bitop3_b32 v95, v19, v5, v46 bitop3:0xea
    v_perm_b32 v15, v19, v20, s47
    v_bitop3_b32 v46, v19, 0.5, -0.5 bitop3:0xa8
    v_perm_b32 v14, v18, v20, s46
    v_bitop3_b32 v47, v18, 0.5, -0.5 bitop3:0xa8
    v_bitop3_b32 v15, v6, v15, v46 bitop3:0xca
    v_bitop3_b32 v14, v6, v14, v47 bitop3:0xca
    s_waitcnt lgkmcnt(1)
    v_mfma_f32_4x4x4_16b_bf16 v[80:83], v[10:11], v[70:71], v[80:83]
    s_waitcnt lgkmcnt(0)
    v_mfma_f32_4x4x4_16b_bf16 v[76:79], v[10:11], v[68:69], v[76:79]
    s_nop 2
    v_cvt_pk_bf16_f32 v80, v80, v81
    v_cvt_pk_bf16_f32 v81, v82, v83
    ds_wrxchg_rtn_b64 v[74:75], v93, v[80:81] offset:65408
    v_cvt_pk_bf16_f32 v76, v76, v77
    v_cvt_pk_bf16_f32 v77, v78, v79
    ds_wrxchg_rtn_b64 v[72:73], v92, v[76:77] offset:65408
    s_setprio 2
    v_mfma_f32_4x4x4_16b_bf16 v[80:83], v[8:9], v[106:107], 0
    v_mfma_f32_4x4x4_16b_bf16 v[76:79], v[8:9], v[104:105], 0
    v_cmp_lt_u32 s[48:49], v5, v95
    s_nop 2
    v_pk_mul_f32 v[80:81], v[80:81], v[14:15] op_sel:[0,1] op_sel_hi:[1,1]
    v_pk_mul_f32 v[82:83], v[82:83], v[14:15] op_sel:[0,1] op_sel_hi:[1,1]
    v_pk_mul_f32 v[76:77], v[76:77], v[14:15] op_sel:[0,0] op_sel_hi:[1,0]
    v_pk_mul_f32 v[78:79], v[78:79], v[14:15] op_sel:[0,0] op_sel_hi:[1,0]
    v_and_b32 v47, 0x0fffffff, v31
    buffer_load_dword v30, v47, s[8:11], 0 offen offset:16
    s_mov_b64 exec, s[6:7]
    v_add_u32 v47, 8, v47
    v_lshrrev_b32 v31, 2, v31
    s_mov_b64 exec, -1
    buffer_load_dwordx2 v[28:29], v47, s[8:11], 0 offen
    v_and_b32 v47, 0x3f0, v3
    s_cmp_lg_u32 s56, 0
    s_cbranch_scc1 L2_m11
    s_mul_i32 s3, s33, 1280000
    s_add_u32 s3, s3, s100
    s_add_u32 s3, s3, 352768
    buffer_load_dwordx4 v[124:127], v47, s[24:27], s3 offen offset:2048
L2_m11:
    v_and_b32 v47, 0x3f0, v3
    s_cmp_lg_u32 s56, 0
    s_cbranch_scc1 L2_m12
    s_mul_i32 s3, s33, 1280000
    s_add_u32 s3, s3, s100
    s_add_u32 s3, s3, 352768
    buffer_load_dwordx4 v[116:119], v47, s[24:27], s3 offen offset:0
L2_m12:
    s_waitcnt vmcnt(4)
    v_and_b32 v46, 0x20000000, v27
    v_lshrrev_b32 v47, 14, v23
    v_bitop3_b32 v47, v47, v5, v46 bitop3:0xea
    ds_read_b64 v[102:103], v47
    v_and_b32 v99, 0x10000000, v27
    v_lshrrev_b32 v47, 14, v22
    v_bitop3_b32 v47, v47, v5, v99 bitop3:0xea
    ds_read_b64 v[100:101], v47
    s_waitcnt lgkmcnt(2)
    v_cmp_ne_u64 s[50:51], v[72:73], v[68:69]
    v_cmpx_ne_u64 s[54:55], v[74:75], v[70:71]
    s_and_b64 s[82:83], s[54:55], s[80:81]
    s_cbranch_scc1 L2_c13
L2_d13:
    v_mov_b64 v[84:85], v[70:71]
    v_mov_b32 v7, v93
    v_mov_b64 v[86:87], v[74:75]
    s_or_b64 s[80:81], s[80:81], s[54:55]
    s_mov_b64 exec, s[50:51]
    s_and_b64 s[82:83], s[50:51], s[80:81]
    s_cbranch_scc1 L2_c14
L2_d14:
    v_mov_b64 v[84:85], v[68:69]
    v_mov_b32 v7, v92
    v_mov_b64 v[86:87], v[72:73]
    s_mov_b64 exec, -1
    s_or_b64 s[80:81], s[80:81], s[50:51]
    s_and_b64 exec, s[48:49], s[80:81]
    v_mfma_f32_4x4x4_16b_bf16 v[80:83], v[12:13], v[84:85], 0
    v_mov_b32 v95, v7
    s_andn2_b64 s[80:81], s[80:81], s[48:49]
    v_mfma_f32_4x4x4_16b_bf16 v[80:83], v[10:11], v[86:87], v[80:83]
    s_mov_b64 exec, -1
    ds_read_b64 v[70:71], v95 offset:65408
    ds_read_b64 v[68:69], v94 offset:65408
    v_bitop3_b32 v92, v22, v5, v99 bitop3:0xea
    v_bitop3_b32 v93, v23, v5, v46 bitop3:0xea
    v_perm_b32 v15, v23, v26, s45
    v_bitop3_b32 v46, v23, 0.5, -0.5 bitop3:0xa8
    v_perm_b32 v14, v22, v26, s44
    v_bitop3_b32 v47, v22, 0.5, -0.5 bitop3:0xa8
    v_bitop3_b32 v15, v6, v15, v46 bitop3:0xca
    v_bitop3_b32 v14, v6, v14, v47 bitop3:0xca
    s_waitcnt lgkmcnt(1)
    v_mfma_f32_4x4x4_16b_bf16 v[80:83], v[10:11], v[70:71], v[80:83]
    s_waitcnt lgkmcnt(0)
    v_mfma_f32_4x4x4_16b_bf16 v[76:79], v[10:11], v[68:69], v[76:79]
    s_nop 2
    v_cvt_pk_bf16_f32 v80, v80, v81
    v_cvt_pk_bf16_f32 v81, v82, v83
    ds_wrxchg_rtn_b64 v[74:75], v95, v[80:81] offset:65408
    v_cvt_pk_bf16_f32 v76, v76, v77
    v_cvt_pk_bf16_f32 v77, v78, v79
    ds_wrxchg_rtn_b64 v[72:73], v94, v[76:77] offset:65408
    s_setprio 1
    v_mfma_f32_4x4x4_16b_bf16 v[80:83], v[8:9], v[102:103], 0
    v_mfma_f32_4x4x4_16b_bf16 v[76:79], v[8:9], v[100:101], 0
    s_nop 3
    v_pk_mul_f32 v[80:81], v[80:81], v[14:15] op_sel:[0,1] op_sel_hi:[1,1]
    v_pk_mul_f32 v[82:83], v[82:83], v[14:15] op_sel:[0,1] op_sel_hi:[1,1]
    v_pk_mul_f32 v[76:77], v[76:77], v[14:15] op_sel:[0,0] op_sel_hi:[1,0]
    v_pk_mul_f32 v[78:79], v[78:79], v[14:15] op_sel:[0,0] op_sel_hi:[1,0]
    v_and_b32 v47, 0x3f0, v3
    s_cmp_lg_u32 s56, 0
    s_cbranch_scc1 L2_m15
    s_mul_i32 s3, s33, 1280000
    s_add_u32 s3, s3, s100
    s_add_u32 s3, s3, 352768
    buffer_load_dwordx4 v[120:123], v47, s[24:27], s3 offen offset:1024
L2_m15:
    v_sub_u16 v88, v60, v52
    v_and_b32 v89, 3, v52
    v_add3_u32 v99, v88, v89, 3
    v_and_b32 v99, -4, v99
    v_max_u32 v99, 4, v99
    v_and_b32 v97, 0xfffc, v52
    v_bfm_b32 v96, v88, v89
    v_add_u32_dpp v91, v99, v99 row_shr:1 row_mask:0xf bank_mask:0xf bound_ctrl:1
    v_mad_u32_u24 v97, v97, 5, v2
    v_cmp_lt_u32 vcc, 16, v99
    v_add_u32_dpp v91, v91, v91 row_shr:2 row_mask:0xf bank_mask:0xf bound_ctrl:1
    v_sub_u32 v98, s38, v99
    v_lshrrev_b64 v[52:53], 16, v[52:53]
    v_add_u32_dpp v91, v91, v91 row_shr:4 row_mask:0xf bank_mask:0xf bound_ctrl:1
    v_lshrrev_b64 v[60:61], 16, v[60:61]
    s_mov_b32 s101, 0
    v_add_u32_dpp v91, v91, v91 row_shr:8 row_mask:0xf bank_mask:0xf bound_ctrl:1
    s_nop 1
    v_add_u32_dpp v91, v91, v91 row_bcast:15 row_mask:0xa bank_mask:0xf
    s_nop 1
    v_add_u32_dpp v91, v91, v91 row_bcast:31 row_mask:0xc bank_mask:0xf
    v_add_u32 v98, v98, v91
    v_readlane_b32 s37, v91, 63
    s_cbranch_vccnz L2_xo16
L2_xp16:
    v_and_b32 v46, 0x80000000, v27
    v_lshrrev_b32 v47, 14, v25
    v_bitop3_b32 v47, v47, v5, v46 bitop3:0xea
    ds_read_b64 v[106:107], v47
    v_and_b32 v99, 0x40000000, v27
    v_lshrrev_b32 v47, 14, v24
    v_bitop3_b32 v47, v47, v5, v99 bitop3:0xea
    ds_read_b64 v[104:105], v47
    s_waitcnt lgkmcnt(2)
    v_cmp_ne_u64 s[50:51], v[72:73], v[68:69]
    v_cmpx_ne_u64 s[54:55], v[74:75], v[70:71]
    s_and_b64 s[82:83], s[54:55], s[80:81]
    s_cbranch_scc1 L2_c17
L2_d17:
    v_mov_b64 v[84:85], v[70:71]
    v_mov_b32 v7, v95
    v_mov_b64 v[86:87], v[74:75]
    s_or_b64 s[80:81], s[80:81], s[54:55]
    s_mov_b64 exec, s[50:51]
    s_and_b64 s[82:83], s[50:51], s[80:81]
    s_cbranch_scc1 L2_c18
L2_d18:
    v_mov_b64 v[84:85], v[68:69]
    v_mov_b32 v7, v94
    v_mov_b64 v[86:87], v[72:73]
    s_mov_b64 exec, -1
    s_or_b64 s[80:81], s[80:81], s[50:51]
    ds_read_b64 v[70:71], v93 offset:65408
    ds_read_b64 v[68:69], v92 offset:65408
    v_bitop3_b32 v94, v24, v5, v99 bitop3:0xea
    v_bitop3_b32 v95, v25, v5, v46 bitop3:0xea
    v_perm_b32 v15, v25, v26, s47
    v_bitop3_b32 v46, v25, 0.5, -0.5 bitop3:0xa8
    v_perm_b32 v14, v24, v26, s46
    v_bitop3_b32 v47, v24, 0.5, -0.5 bitop3:0xa8
    v_bitop3_b32 v15, v6, v15, v46 bitop3:0xca
    v_bitop3_b32 v14, v6, v14, v47 bitop3:0xca
    s_waitcnt lgkmcnt(1)
    v_mfma_f32_4x4x4_16b_bf16 v[80:83], v[10:11], v[70:71], v[80:83]
    s_waitcnt lgkmcnt(0)
    v_mfma_f32_4x4x4_16b_bf16 v[76:79], v[10:11], v[68:69], v[76:79]
    s_nop 2
    v_cvt_pk_bf16_f32 v80, v80, v81
    v_cvt_pk_bf16_f32 v81, v82, v83
    ds_wrxchg_rtn_b64 v[74:75], v93, v[80:81] offset:65408
    v_cvt_pk_bf16_f32 v76, v76, v77
    v_cvt_pk_bf16_f32 v77, v78, v79
    ds_wrxchg_rtn_b64 v[72:73], v92, v[76:77] offset:65408
    v_mfma_f32_4x4x4_16b_bf16 v[80:83], v[8:9], v[106:107], 0
    v_mfma_f32_4x4x4_16b_bf16 v[76:79], v[8:9], v[104:105], 0
    v_cmp_lt_u32 s[84:85], v5, v94
    s_nop 2
    v_pk_mul_f32 v[80:81], v[80:81], v[14:15] op_sel:[0,1] op_sel_hi:[1,1]
    v_pk_mul_f32 v[82:83], v[82:83], v[14:15] op_sel:[0,1] op_sel_hi:[1,1]
    v_pk_mul_f32 v[76:77], v[76:77], v[14:15] op_sel:[0,0] op_sel_hi:[1,0]
    v_pk_mul_f32 v[78:79], v[78:79], v[14:15] op_sel:[0,0] op_sel_hi:[1,0]
    v_and_b32 v47, 0x3f0, v3
    s_cmp_lg_u32 s56, 0
    s_cbranch_scc1 L2_m19
    s_mul_i32 s3, s33, 1280000
    s_add_u32 s3, s3, s38
    s_add_u32 s3, s3, 320000
    buffer_load_dwordx4 v[108:111], v47, s[24:27], s3 offen offset:0
L2_m19:
    v_and_b32 v47, 0x3f0, v3
    s_cmp_lg_u32 s56, 0
    s_cbranch_scc1 L2_m20
    s_mul_i32 s3, s33, 1280000
    s_add_u32 s3, s3, s38
    s_add_u32 s3, s3, 320000
    buffer_load_dwordx4 v[112:115], v47, s[24:27], s3 offen offset:1024
L2_m20:
    v_and_b32 v47, 0x0fffffff, v40
    buffer_load_dwordx2 v[16:17], v47, s[8:11], 0 offen
    buffer_load_dwordx3 v[18:20], v47, s[8:11], 0 offen offset:8
    s_waitcnt vmcnt(2)
    s_mov_b64 exec, s[6:7]
    v_lshrrev_b32 v30, 16, v30
    s_mov_b64 exec, -1
    v_and_b32 v46, 0x20000000, v31
    v_lshrrev_b32 v47, 14, v29
    v_bitop3_b32 v47, v47, v5, v46 bitop3:0xea
    ds_read_b64 v[102:103], v47
    v_and_b32 v99, 0x10000000, v31
    v_lshrrev_b32 v47, 14, v28
    v_bitop3_b32 v47, v47, v5, v99 bitop3:0xea
    ds_read_b64 v[100:101], v47
    s_waitcnt lgkmcnt(2)
    v_cmp_ne_u64 s[50:51], v[72:73], v[68:69]
    v_cmpx_ne_u64 s[54:55], v[74:75], v[70:71]
    s_and_b64 s[82:83], s[54:55], s[80:81]
    s_cbranch_scc1 L2_c21
L2_d21:
    v_mov_b64 v[84:85], v[70:71]
    v_mov_b32 v7, v93
    v_mov_b64 v[86:87], v[74:75]
    s_or_b64 s[80:81], s[80:81], s[54:55]
    s_mov_b64 exec, s[50:51]
    s_and_b64 s[82:83], s[50:51], s[80:81]
    s_cbranch_scc1 L2_c22
L2_d22:
    v_mov_b64 v[84:85], v[68:69]
    v_mov_b32 v7, v92
    v_mov_b64 v[86:87], v[72:73]
    s_mov_b64 exec, -1
    s_or_b64 s[80:81], s[80:81], s[50:51]
    s_and_b64 exec, s[84:85], s[80:81]
    v_mfma_f32_4x4x4_16b_bf16 v[76:79], v[12:13], v[84:85], 0
    v_mov_b32 v94, v7
    s_andn2_b64 s[80:81], s[80:81], s[84:85]
    v_mfma_f32_4x4x4_16b_bf16 v[76:79], v[10:11], v[86:87], v[76:79]
    s_mov_b64 exec, -1
    ds_read_b64 v[70:71], v95 offset:65408
    ds_read_b64 v[68:69], v94 offset:65408
    v_bitop3_b32 v92, v28, v5, v99 bitop3:0xea
    v_bitop3_b32 v93, v29, v5, v46 bitop3:0xea
    v_perm_b32 v15, v29, v30, s45
    v_bitop3_b32 v46, v29, 0.5, -0.5 bitop3:0xa8
    v_perm_b32 v14, v28, v30, s44
    v_bitop3_b32 v47, v28, 0.5, -0.5 bitop3:0xa8
    v_bitop3_b32 v15, v6, v15, v46 bitop3:0xca
    v_bitop3_b32 v14, v6, v14, v47 bitop3:0xca
    s_waitcnt lgkmcnt(1)
    v_mfma_f32_4x4x4_16b_bf16 v[80:83], v[10:11], v[70:71], v[80:83]
    s_waitcnt lgkmcnt(0)
    v_mfma_f32_4x4x4_16b_bf16 v[76:79], v[10:11], v[68:69], v[76:79]
    s_nop 2
    v_cvt_pk_bf16_f32 v80, v80, v81
    v_cvt_pk_bf16_f32 v81, v82, v83
    ds_wrxchg_rtn_b64 v[74:75], v95, v[80:81] offset:65408
    v_cvt_pk_bf16_f32 v76, v76, v77
    v_cvt_pk_bf16_f32 v77, v78, v79
    ds_wrxchg_rtn_b64 v[72:73], v94, v[76:77] offset:65408
    s_setprio 0
    v_mfma_f32_4x4x4_16b_bf16 v[80:83], v[8:9], v[102:103], 0
    v_mfma_f32_4x4x4_16b_bf16 v[76:79], v[8:9], v[100:101], 0
    v_cmp_lt_u32 s[48:49], v5, v93
    s_nop 2
    v_pk_mul_f32 v[80:81], v[80:81], v[14:15] op_sel:[0,1] op_sel_hi:[1,1]
    v_pk_mul_f32 v[82:83], v[82:83], v[14:15] op_sel:[0,1] op_sel_hi:[1,1]
    v_pk_mul_f32 v[76:77], v[76:77], v[14:15] op_sel:[0,0] op_sel_hi:[1,0]
    v_pk_mul_f32 v[78:79], v[78:79], v[14:15] op_sel:[0,0] op_sel_hi:[1,0]
    s_add_u32 s40, s40, 0x50000
    v_and_b32 v47, 0x0fffffff, v41
    buffer_load_dwordx2 v[22:23], v47, s[8:11], 0 offen
    buffer_load_dwordx3 v[24:26], v47, s[8:11], 0 offen offset:8
    v_and_b32 v46, 0x80000000, v39
    v_lshrrev_b32 v47, 14, v37
    v_bitop3_b32 v47, v47, v5, v46 bitop3:0xea
    ds_read_b64 v[102:103], v47
    v_and_b32 v99, 0x40000000, v39
    v_lshrrev_b32 v47, 14, v36
    v_bitop3_b32 v47, v47, v5, v99 bitop3:0xea
    ds_read_b64 v[100:101], v47
    v_and_b32 v46, 0x20000000, v39
    v_lshrrev_b32 v47, 14, v35
    v_bitop3_b32 v47, v47, v5, v46 bitop3:0xea
    ds_read_b64 v[106:107], v47
    v_and_b32 v99, 0x10000000, v39
    v_lshrrev_b32 v47, 14, v34
    v_bitop3_b32 v47, v47, v5, v99 bitop3:0xea
    ds_read_b64 v[104:105], v47
    s_waitcnt lgkmcnt(4)
    v_cmp_ne_u64 s[50:51], v[72:73], v[68:69]
    v_cmpx_ne_u64 s[54:55], v[74:75], v[70:71]
    s_and_b64 s[82:83], s[54:55], s[80:81]
    s_cbranch_scc1 L2_c23
L2_d23:
    v_mov_b64 v[84:85], v[70:71]
    v_mov_b32 v7, v95
    v_mov_b64 v[86:87], v[74:75]
    s_or_b64 s[80:81], s[80:81], s[54:55]
    s_mov_b64 exec, s[50:51]
    s_and_b64 s[82:83], s[50:51], s[80:81]
    s_cbranch_scc1 L2_c24
L2_d24:
    v_mov_b64 v[84:85], v[68:69]
    v_mov_b32 v7, v94
    v_mov_b64 v[86:87], v[72:73]
    s_mov_b64 exec, -1
    s_or_b64 s[80:81], s[80:81], s[50:51]
    s_and_b64 exec, s[48:49], s[80:81]
    v_mfma_f32_4x4x4_16b_bf16 v[80:83], v[12:13], v[84:85], 0
    v_mov_b32 v93, v7
    s_andn2_b64 s[80:81], s[80:81], s[48:49]
    v_mfma_f32_4x4x4_16b_bf16 v[80:83], v[10:11], v[86:87], v[80:83]
    s_mov_b64 exec, -1
    ds_read_b64 v[70:71], v93 offset:65408
    ds_read_b64 v[68:69], v92 offset:65408
    v_bitop3_b32 v94, v34, v5, v99 bitop3:0xea
    v_bitop3_b32 v95, v35, v5, v46 bitop3:0xea
    v_perm_b32 v15, v35, v38, s45
    v_bitop3_b32 v46, v35, 0.5, -0.5 bitop3:0xa8
    v_perm_b32 v14, v34, v38, s44
    v_bitop3_b32 v47, v34, 0.5, -0.5 bitop3:0xa8
    v_bitop3_b32 v15, v6, v15, v46 bitop3:0xca
    v_bitop3_b32 v14, v6, v14, v47 bitop3:0xca
    s_waitcnt lgkmcnt(1)
    v_mfma_f32_4x4x4_16b_bf16 v[80:83], v[10:11], v[70:71], v[80:83]
    s_waitcnt lgkmcnt(0)
    v_mfma_f32_4x4x4_16b_bf16 v[76:79], v[10:11], v[68:69], v[76:79]
    s_nop 2
    v_cvt_pk_bf16_f32 v80, v80, v81
    v_cvt_pk_bf16_f32 v81, v82, v83
    ds_wrxchg_rtn_b64 v[74:75], v93, v[80:81] offset:65408
    v_cvt_pk_bf16_f32 v76, v76, v77
    v_cvt_pk_bf16_f32 v77, v78, v79
    ds_wrxchg_rtn_b64 v[72:73], v92, v[76:77] offset:65408
    s_barrier
    s_setprio 3
    s_waitcnt vmcnt(4)
    v_subrev_u32 v88, s38, v3
    ds_write_b128 v88, v[124:127] offset:34816
    s_add_u32 s3, s40, 4096
    buffer_load_dwordx4 v[124:127], v3, s[16:19], s3 offen sc1
    s_waitcnt vmcnt(5)
    v_subrev_u32 v88, s38, v3
    ds_write_b128 v88, v[116:119] offset:32768
    buffer_load_dwordx4 v[116:119], v3, s[16:19], s40 offen offset:2048 sc1
    s_waitcnt vmcnt(6)
    v_subrev_u32 v88, s38, v3
    ds_write_b128 v88, v[120:123] offset:33792
    buffer_load_dwordx4 v[120:123], v3, s[16:19], s40 offen offset:3072 sc1
    v_mfma_f32_4x4x4_16b_bf16 v[80:83], v[8:9], v[106:107], 0
    v_mfma_f32_4x4x4_16b_bf16 v[76:79], v[8:9], v[104:105], 0
    s_nop 3
    v_pk_mul_f32 v[80:81], v[80:81], v[14:15] op_sel:[0,1] op_sel_hi:[1,1]
    v_pk_mul_f32 v[82:83], v[82:83], v[14:15] op_sel:[0,1] op_sel_hi:[1,1]
    v_pk_mul_f32 v[76:77], v[76:77], v[14:15] op_sel:[0,0] op_sel_hi:[1,0]
    v_pk_mul_f32 v[78:79], v[78:79], v[14:15] op_sel:[0,0] op_sel_hi:[1,0]
    v_and_b32 v47, 0x0fffffff, v42
    buffer_load_dword v30, v47, s[8:11], 0 offen offset:16
    s_mov_b64 exec, s[6:7]
    v_add_u32 v47, 8, v47
    v_lshrrev_b32 v42, 2, v42
    s_mov_b64 exec, -1
    buffer_load_dwordx2 v[28:29], v47, s[8:11], 0 offen
    s_cmp_gt_u32 s37, 1024
    s_cbranch_scc1 L2_xs25
    s_cmp_lg_u32 s101, 0
    s_cbranch_scc1 L2_xa25
L2_xb25:
    v_lshlrev_b32 v89, 16, v96
    v_add_u32 v90, 60, v97
    v_bitop3_b32 v90, v89, v45, v90 bitop3:0x6a
    ds_write_b32 v98, v90 offset:12
    v_lshlrev_b32 v89, 20, v96
    v_add_u32 v90, 40, v97
    v_bitop3_b32 v90, v89, v45, v90 bitop3:0x6a
    ds_write_b32 v98, v90 offset:8
    v_lshlrev_b32 v89, 24, v96
    v_add_u32 v90, 20, v97
    v_bitop3_b32 v90, v89, v45, v90 bitop3:0x6a
    ds_write_b32 v98, v90 offset:4
    v_lshlrev_b32 v89, 28, v96
    v_bitop3_b32 v90, v89, v45, v97 bitop3:0x6a
    ds_write_b32 v98, v90 offset:0
    v_mov_b32_dpp v91, v64 quad_perm:[1,1,1,1] row_mask:0xf bank_mask:0xf
    v_and_b32 v89, 3, v91
    v_and_b32 v97, 0xfffc, v91
    v_sub_u16_dpp v88, v64, v91 quad_perm:[3,3,3,3] row_mask:0xf bank_mask:0xf
    v_mad_u32_u24 v97, v97, 5, v4
    v_add_u32 v99, v88, v89
    v_bfm_b32 v96, v88, v89
    v_cmp_lt_u32 s[58:59], 16, v99
    v_lshlrev_b32 v89, v1, v96
    v_and_b32 v89, v45, v89
    v_cmp_ne_u32 vcc, 0, v89
    v_xor_b32 v90, v97, v89
    s_add_u32 s3, s37, s38
    v_mbcnt_lo_u32_b32 v98, vcc_lo, 0
    v_mbcnt_hi_u32_b32 v98, vcc_hi, v98
    s_bcnt1_i32_b64 s41, vcc
    v_lshl_add_u32 v98, v98, 2, s3
    s_lshl2_add_u32 s37, s41, s37
    s_mov_b64 exec, vcc
    ds_write_b32 v98, v90
    s_mov_b64 exec, -1
    s_cmp_lg_u64 s[58:59], 0
    s_cbranch_scc1 L2_xe25
L2_xr25:
    v_add_u32 v98, s37, v0
    v_mov_b32 v90, -1
    ds_write_b32 v98, v90
L2_xw25:
    s_setprio 2
    s_waitcnt lgkmcnt(9)
    v_cmp_ne_u64 s[50:51], v[72:73], v[68:69]
    v_cmpx_ne_u64 s[54:55], v[74:75], v[70:71]
    s_and_b64 s[82:83], s[54:55], s[80:81]
    s_cbranch_scc1 L2_c26
L2_d26:
    v_mov_b64 v[84:85], v[70:71]
    v_mov_b32 v7, v93
    v_mov_b64 v[86:87], v[74:75]
    s_or_b64 s[80:81], s[80:81], s[54:55]
    s_mov_b64 exec, s[50:51]
    s_and_b64 s[82:83], s[50:51], s[80:81]
    s_cbranch_scc1 L2_c27
L2_d27:
    v_mov_b64 v[84:85], v[68:69]
    v_mov_b32 v7, v92
    v_mov_b64 v[86:87], v[72:73]
    s_mov_b64 exec, -1
    s_or_b64 s[80:81], s[80:81], s[50:51]
    ds_read_b64 v[70:71], v95 offset:65408
    ds_read_b64 v[68:69], v94 offset:65408
    v_and_b32 v46, 0x40000000, v39
    v_bitop3_b32 v92, v36, v5, v46 bitop3:0xea
    v_and_b32 v46, 0x80000000, v39
    v_bitop3_b32 v93, v37, v5, v46 bitop3:0xea
    v_perm_b32 v15, v37, v38, s47
    v_bitop3_b32 v46, v37, 0.5, -0.5 bitop3:0xa8
    v_perm_b32 v14, v36, v38, s46
    v_bitop3_b32 v47, v36, 0.5, -0.5 bitop3:0xa8
    v_bitop3_b32 v15, v6, v15, v46 bitop3:0xca
    v_bitop3_b32 v14, v6, v14, v47 bitop3:0xca
    s_setprio 1
    s_waitcnt lgkmcnt(1)
    v_mfma_f32_4x4x4_16b_bf16 v[80:83], v[10:11], v[70:71], v[80:83]
    s_waitcnt lgkmcnt(0)
    v_mfma_f32_4x4x4_16b_bf16 v[76:79], v[10:11], v[68:69], v[76:79]
    s_nop 2
    v_cvt_pk_bf16_f32 v80, v80, v81
    v_cvt_pk_bf16_f32 v81, v82, v83
    ds_wrxchg_rtn_b64 v[74:75], v95, v[80:81] offset:65408
    v_cvt_pk_bf16_f32 v76, v76, v77
    v_cvt_pk_bf16_f32 v77, v78, v79
    ds_wrxchg_rtn_b64 v[72:73], v94, v[76:77] offset:65408
    ds_read_b32 v21, v0 offset:0
    ds_read_b32 v27, v0 offset:256
    ds_read_b32 v31, v44 offset:768
    ds_read_b32 v39, v0 offset:512
    s_sub_u32 s3, s37, 768
    s_cmp_gt_u32 s3, 128
    s_cbranch_scc1 L2_xf25
L2_xg25:
    v_and_b32 v88, 0x0fffffff, v43
    buffer_load_dwordx2 v[34:35], v88, s[8:11], 0 offen
    buffer_load_dwordx3 v[36:38], v88, s[8:11], 0 offen offset:8
    s_setprio 0
    s_waitcnt vmcnt(11)
    v_subrev_u32 v88, s100, v3
    ds_write_b128 v88, v[108:111] offset:0
    s_waitcnt vmcnt(11)
    v_subrev_u32 v88, s100, v3
    ds_write_b128 v88, v[112:115] offset:1024
    v_mfma_f32_4x4x4_16b_bf16 v[80:83], v[8:9], v[102:103], 0
    v_mfma_f32_4x4x4_16b_bf16 v[76:79], v[8:9], v[100:101], 0
    v_cmp_lt_u32 s[84:85], v5, v92
    s_nop 2
    v_pk_mul_f32 v[80:81], v[80:81], v[14:15] op_sel:[0,1] op_sel_hi:[1,1]
    v_pk_mul_f32 v[82:83], v[82:83], v[14:15] op_sel:[0,1] op_sel_hi:[1,1]
    v_pk_mul_f32 v[76:77], v[76:77], v[14:15] op_sel:[0,0] op_sel_hi:[1,0]
    v_pk_mul_f32 v[78:79], v[78:79], v[14:15] op_sel:[0,0] op_sel_hi:[1,0]
    s_add_u32 s42, s42, 1
    s_waitcnt lgkmcnt(0)
    s_add_u32 s24, s30, 0xec54000
    s_addc_u32 s25, s31, 0
    s_mov_b32 s26, 0x100
    s_mov_b32 s27, 0x20000
    s_barrier
    s_bitcmp1_b32 s36, s42
    s_cbranch_scc1 L2_slow
L2_ret1:
    s_setprio 3
    s_bitcmp1_b32 s43, s42
    s_cbranch_scc1 L2_oa28
L2_ob28:
    s_waitcnt vmcnt(9)
    v_and_b32 v46, 0x20000000, v40
    v_lshrrev_b32 v47, 14, v17
    v_bitop3_b32 v47, v47, v5, v46 bitop3:0xea
    ds_read_b64 v[106:107], v47
    v_and_b32 v99, 0x10000000, v40
    v_lshrrev_b32 v47, 14, v16
    v_bitop3_b32 v47, v47, v5, v99 bitop3:0xea
    ds_read_b64 v[104:105], v47
    v_cmp_ne_u64 s[50:51], v[72:73], v[68:69]
    v_cmpx_ne_u64 s[54:55], v[74:75], v[70:71]
    s_and_b64 s[82:83], s[54:55], s[80:81]
    s_cbranch_scc1 L2_c29
L2_d29:
    v_mov_b64 v[84:85], v[70:71]
    v_mov_b32 v7, v95
    v_mov_b64 v[86:87], v[74:75]
    s_or_b64 s[80:81], s[80:81], s[54:55]
    s_mov_b64 exec, s[50:51]
    s_and_b64 s[82:83], s[50:51], s[80:81]
    s_cbranch_scc1 L2_c30
L2_d30:
    v_mov_b64 v[84:85], v[68:69]
    v_mov_b32 v7, v94
    v_mov_b64 v[86:87], v[72:73]
    s_mov_b64 exec, -1
    s_or_b64 s[80:81], s[80:81], s[50:51]
    s_and_b64 exec, s[84:85], s[80:81]
    v_mfma_f32_4x4x4_16b_bf16 v[76:79], v[12:13], v[84:85], 0
    v_mov_b32 v92, v7
    s_andn2_b64 s[80:81], s[80:81], s[84:85]
    v_mfma_f32_4x4x4_16b_bf16 v[76:79], v[10:11], v[86:87], v[76:79]
    s_mov_b64 exec, -1
    ds_read_b64 v[70:71], v93 offset:65408
    ds_read_b64 v[68:69], v92 offset:65408
    v_bitop3_b32 v94, v16, v5, v99 bitop3:0xea
    v_bitop3_b32 v95, v17, v5, v46 bitop3:0xea
    v_perm_b32 v15, v17, v20, s45
    v_bitop3_b32 v46, v17, 0.5, -0.5 bitop3:0xa8
    v_perm_b32 v14, v16, v20, s44
    v_bitop3_b32 v47, v16, 0.5, -0.5 bitop3:0xa8
    v_bitop3_b32 v15, v6, v15, v46 bitop3:0xca
    v_bitop3_b32 v14, v6, v14, v47 bitop3:0xca
    s_waitcnt lgkmcnt(1)
    v_mfma_f32_4x4x4_16b_bf16 v[80:83], v[10:11], v[70:71], v[80:83]
    s_waitcnt lgkmcnt(0)
    v_mfma_f32_4x4x4_16b_bf16 v[76:79], v[10:11], v[68:69], v[76:79]
    s_nop 2
    v_cvt_pk_bf16_f32 v80, v80, v81
    v_cvt_pk_bf16_f32 v81, v82, v83
    ds_wrxchg_rtn_b64 v[74:75], v93, v[80:81] offset:65408
    v_cvt_pk_bf16_f32 v76, v76, v77
    v_cvt_pk_bf16_f32 v77, v78, v79
    ds_wrxchg_rtn_b64 v[72:73], v92, v[76:77] offset:65408
    v_mfma_f32_4x4x4_16b_bf16 v[80:83], v[8:9], v[106:107], 0
    v_mfma_f32_4x4x4_16b_bf16 v[76:79], v[8:9], v[104:105], 0
    v_cmp_lt_u32 s[84:85], v5, v94
    s_nop 2
    v_pk_mul_f32 v[80:81], v[80:81], v[14:15] op_sel:[0,1] op_sel_hi:[1,1]
    v_pk_mul_f32 v[82:83], v[82:83], v[14:15] op_sel:[0,1] op_sel_hi:[1,1]
    v_pk_mul_f32 v[76:77], v[76:77], v[14:15] op_sel:[0,0] op_sel_hi:[1,0]
    v_pk_mul_f32 v[78:79], v[78:79], v[14:15] op_sel:[0,0] op_sel_hi:[1,0]
    buffer_load_dwordx4 v[108:111], v3, s[16:19], s40 offen offset:0 sc1
    v_and_b32 v46, 0x80000000, v40
    v_lshrrev_b32 v47, 14, v19
    v_bitop3_b32 v47, v47, v5, v46 bitop3:0xea
    ds_read_b64 v[102:103], v47
    v_and_b32 v99, 0x40000000, v40
    v_lshrrev_b32 v47, 14, v18
    v_bitop3_b32 v47, v47, v5, v99 bitop3:0xea
    ds_read_b64 v[100:101], v47
    s_waitcnt lgkmcnt(2)
    v_cmp_ne_u64 s[50:51], v[72:73], v[68:69]
    v_cmpx_ne_u64 s[54:55], v[74:75], v[70:71]
    s_and_b64 s[82:83], s[54:55], s[80:81]
    s_cbranch_scc1 L2_c31
L2_d31:
    v_mov_b64 v[84:85], v[70:71]
    v_mov_b32 v7, v93
    v_mov_b64 v[86:87], v[74:75]
    s_or_b64 s[80:81], s[80:81], s[54:55]
    s_mov_b64 exec, s[50:51]
    s_and_b64 s[82:83], s[50:51], s[80:81]
    s_cbranch_scc1 L2_c32
L2_d32:
    v_mov_b64 v[84:85], v[68:69]
    v_mov_b32 v7, v92
    v_mov_b64 v[86:87], v[72:73]
    s_mov_b64 exec, -1
    s_or_b64 s[80:81], s[80:81], s[50:51]
    s_and_b64 exec, s[84:85], s[80:81]
    v_mfma_f32_4x4x4_16b_bf16 v[76:79], v[12:13], v[84:85], 0
    v_mov_b32 v94, v7
    s_andn2_b64 s[80:81], s[80:81], s[84:85]
    v_mfma_f32_4x4x4_16b_bf16 v[76:79], v[10:11], v[86:87], v[76:79]
    s_mov_b64 exec, -1
    ds_read_b64 v[70:71], v95 offset:65408
    ds_read_b64 v[68:69], v94 offset:65408
    v_bitop3_b32 v92, v18, v5, v99 bitop3:0xea
    v_bitop3_b32 v93, v19, v5, v46 bitop3:0xea
    v_perm_b32 v15, v19, v20, s47
    v_bitop3_b32 v46, v19, 0.5, -0.5 bitop3:0xa8
    v_perm_b32 v14, v18, v20, s46
    v_bitop3_b32 v47, v18, 0.5, -0.5 bitop3:0xa8
    v_bitop3_b32 v15, v6, v15, v46 bitop3:0xca
    v_bitop3_b32 v14, v6, v14, v47 bitop3:0xca
    s_waitcnt lgkmcnt(1)
    v_mfma_f32_4x4x4_16b_bf16 v[80:83], v[10:11], v[70:71], v[80:83]
    s_waitcnt lgkmcnt(0)
    v_mfma_f32_4x4x4_16b_bf16 v[76:79], v[10:11], v[68:69], v[76:79]
    s_nop 2
    v_cvt_pk_bf16_f32 v80, v80, v81
    v_cvt_pk_bf16_f32 v81, v82, v83
    ds_wrxchg_rtn_b64 v[74:75], v95, v[80:81] offset:65408
    v_cvt_pk_bf16_f32 v76, v76, v77
    v_cvt_pk_bf16_f32 v77, v78, v79
    ds_wrxchg_rtn_b64 v[72:73], v94, v[76:77] offset:65408
    v_and_b32 v88, 0x0fffffff, v21
    buffer_load_dwordx2 v[16:17], v88, s[8:11], 0 offen
    buffer_load_dwordx3 v[18:20], v88, s[8:11], 0 offen offset:8
    s_setprio 2
    v_mfma_f32_4x4x4_16b_bf16 v[80:83], v[8:9], v[102:103], 0
    v_mfma_f32_4x4x4_16b_bf16 v[76:79], v[8:9], v[100:101], 0
    v_cmp_lt_u32 s[48:49], v5, v93
    s_nop 2
    v_pk_mul_f32 v[80:81], v[80:81], v[14:15] op_sel:[0,1] op_sel_hi:[1,1]
    v_pk_mul_f32 v[82:83], v[82:83], v[14:15] op_sel:[0,1] op_sel_hi:[1,1]
    v_pk_mul_f32 v[76:77], v[76:77], v[14:15] op_sel:[0,0] op_sel_hi:[1,0]
    v_pk_mul_f32 v[78:79], v[78:79], v[14:15] op_sel:[0,0] op_sel_hi:[1,0]
    s_waitcnt vmcnt(10)
    v_and_b32 v46, 0x20000000, v41
    v_lshrrev_b32 v47, 14, v23
    v_bitop3_b32 v47, v47, v5, v46 bitop3:0xea
    ds_read_b64 v[106:107], v47
    v_and_b32 v99, 0x10000000, v41
    v_lshrrev_b32 v47, 14, v22
    v_bitop3_b32 v47, v47, v5, v99 bitop3:0xea
    ds_read_b64 v[104:105], v47
    s_waitcnt lgkmcnt(2)
    v_cmp_ne_u64 s[50:51], v[72:73], v[68:69]
    v_cmpx_ne_u64 s[54:55], v[74:75], v[70:71]
    s_and_b64 s[82:83], s[54:55], s[80:81]
    s_cbranch_scc1 L2_c33
L2_d33:
    v_mov_b64 v[84:85], v[70:71]
    v_mov_b32 v7, v95
    v_mov_b64 v[86:87], v[74:75]
    s_or_b64 s[80:81], s[80:81], s[54:55]
    s_mov_b64 exec, s[50:51]
    s_and_b64 s[82:83], s[50:51], s[80:81]
    s_cbranch_scc1 L2_c34
L2_d34:
    v_mov_b64 v[84:85], v[68:69]
    v_mov_b32 v7, v94
    v_mov_b64 v[86:87], v[72:73]
    s_mov_b64 exec, -1
    s_or_b64 s[80:81], s[80:81], s[50:51]
    s_and_b64 exec, s[48:49], s[80:81]
    v_mfma_f32_4x4x4_16b_bf16 v[80:83], v[12:13], v[84:85], 0
    v_mov_b32 v93, v7
    s_andn2_b64 s[80:81], s[80:81], s[48:49]
    v_mfma_f32_4x4x4_16b_bf16 v[80:83], v[10:11], v[86:87], v[80:83]
    s_mov_b64 exec, -1
    ds_read_b64 v[70:71], v93 offset:65408
    ds_read_b64 v[68:69], v92 offset:65408
    v_bitop3_b32 v94, v22, v5, v99 bitop3:0xea
    v_bitop3_b32 v95, v23, v5, v46 bitop3:0xea
    v_perm_b32 v15, v23, v26, s45
    v_bitop3_b32 v46, v23, 0.5, -0.5 bitop3:0xa8
    v_perm_b32 v14, v22, v26, s44
    v_bitop3_b32 v47, v22, 0.5, -0.5 bitop3:0xa8
    v_bitop3_b32 v15, v6, v15, v46 bitop3:0xca
    v_bitop3_b32 v14, v6, v14, v47 bitop3:0xca
    s_waitcnt lgkmcnt(1)
    v_mfma_f32_4x4x4_16b_bf16 v[80:83], v[10:11], v[70:71], v[80:83]
    s_waitcnt lgkmcnt(0)
    v_mfma_f32_4x4x4_16b_bf16 v[76:79], v[10:11], v[68:69], v[76:79]
    s_nop 2
    v_cvt_pk_bf16_f32 v80, v80, v81
    v_cvt_pk_bf16_f32 v81, v82, v83
    ds_wrxchg_rtn_b64 v[74:75], v93, v[80:81] offset:65408
    v_cvt_pk_bf16_f32 v76, v76, v77
    v_cvt_pk_bf16_f32 v77, v78, v79
    ds_wrxchg_rtn_b64 v[72:73], v92, v[76:77] offset:65408
    s_setprio 1
    v_mfma_f32_4x4x4_16b_bf16 v[80:83], v[8:9], v[106:107], 0
    v_mfma_f32_4x4x4_16b_bf16 v[76:79], v[8:9], v[104:105], 0
    s_nop 3
    v_pk_mul_f32 v[80:81], v[80:81], v[14:15] op_sel:[0,1] op_sel_hi:[1,1]
    v_pk_mul_f32 v[82:83], v[82:83], v[14:15] op_sel:[0,1] op_sel_hi:[1,1]
    v_pk_mul_f32 v[76:77], v[76:77], v[14:15] op_sel:[0,0] op_sel_hi:[1,0]
    v_pk_mul_f32 v[78:79], v[78:79], v[14:15] op_sel:[0,0] op_sel_hi:[1,0]
    s_bitcmp1_b32 s43, s42
    s_cbranch_scc1 L2_oa35
L2_ob35:
    buffer_load_dwordx4 v[112:115], v3, s[16:19], s40 offen offset:1024 sc1
    v_sub_u16 v88, v62, v54
    v_and_b32 v89, 3, v54
    v_add3_u32 v99, v88, v89, 3
    v_and_b32 v99, -4, v99
    v_max_u32 v99, 4, v99
    v_and_b32 v97, 0xfffc, v54
    v_bfm_b32 v96, v88, v89
    v_add_u32_dpp v91, v99, v99 row_shr:1 row_mask:0xf bank_mask:0xf bound_ctrl:1
    v_mad_u32_u24 v97, v97, 5, v2
    v_cmp_lt_u32 vcc, 16, v99
    v_add_u32_dpp v91, v91, v91 row_shr:2 row_mask:0xf bank_mask:0xf bound_ctrl:1
    v_sub_u32 v98, s38, v99
    v_lshrrev_b64 v[54:55], 16, v[54:55]
    v_add_u32_dpp v91, v91, v91 row_shr:4 row_mask:0xf bank_mask:0xf bound_ctrl:1
    v_lshrrev_b64 v[62:63], 16, v[62:63]
    s_mov_b32 s101, 0
    v_add_u32_dpp v91, v91, v91 row_shr:8 row_mask:0xf bank_mask:0xf bound_ctrl:1
    s_nop 1
    v_add_u32_dpp v91, v91, v91 row_bcast:15 row_mask:0xa bank_mask:0xf
    s_nop 1
    v_add_u32_dpp v91, v91, v91 row_bcast:31 row_mask:0xc bank_mask:0xf
    v_add_u32 v98, v98, v91
    v_readlane_b32 s37, v91, 63
    s_cbranch_vccnz L2_xo36
L2_xp36:
    v_and_b32 v46, 0x80000000, v41
    v_lshrrev_b32 v47, 14, v25
    v_bitop3_b32 v47, v47, v5, v46 bitop3:0xea
    ds_read_b64 v[102:103], v47
    v_and_b32 v99, 0x40000000, v41
    v_lshrrev_b32 v47, 14, v24
    v_bitop3_b32 v47, v47, v5, v99 bitop3:0xea
    ds_read_b64 v[100:101], v47
    s_waitcnt lgkmcnt(2)
    v_cmp_ne_u64 s[50:51], v[72:73], v[68:69]
    v_cmpx_ne_u64 s[54:55], v[74:75], v[70:71]
    s_and_b64 s[82:83], s[54:55], s[80:81]
    s_cbranch_scc1 L2_c37
L2_d37:
    v_mov_b64 v[84:85], v[70:71]
    v_mov_b32 v7, v93
    v_mov_b64 v[86:87], v[74:75]
    s_or_b64 s[80:81], s[80:81], s[54:55]
    s_mov_b64 exec, s[50:51]
    s_and_b64 s[82:83], s[50:51], s[80:81]
    s_cbranch_scc1 L2_c38
L2_d38:
    v_mov_b64 v[84:85], v[68:69]
    v_mov_b32 v7, v92
    v_mov_b64 v[86:87], v[72:73]
    s_mov_b64 exec, -1
    s_or_b64 s[80:81], s[80:81], s[50:51]
    ds_read_b64 v[70:71], v95 offset:65408
    ds_read_b64 v[68:69], v94 offset:65408
    v_bitop3_b32 v92, v24, v5, v99 bitop3:0xea
    v_bitop3_b32 v93, v25, v5, v46 bitop3:0xea
    v_perm_b32 v15, v25, v26, s47
    v_bitop3_b32 v46, v25, 0.5, -0.5 bitop3:0xa8
    v_perm_b32 v14, v24, v26, s46
    v_bitop3_b32 v47, v24, 0.5, -0.5 bitop3:0xa8
    v_bitop3_b32 v15, v6, v15, v46 bitop3:0xca
    v_bitop3_b32 v14, v6, v14, v47 bitop3:0xca
    s_waitcnt lgkmcnt(1)
    v_mfma_f32_4x4x4_16b_bf16 v[80:83], v[10:11], v[70:71], v[80:83]
    s_waitcnt lgkmcnt(0)
    v_mfma_f32_4x4x4_16b_bf16 v[76:79], v[10:11], v[68:69], v[76:79]
    s_nop 2
    v_cvt_pk_bf16_f32 v80, v80, v81
    v_cvt_pk_bf16_f32 v81, v82, v83
    ds_wrxchg_rtn_b64 v[74:75], v95, v[80:81] offset:65408
    v_cvt_pk_bf16_f32 v76, v76, v77
    v_cvt_pk_bf16_f32 v77, v78, v79
    ds_wrxchg_rtn_b64 v[72:73], v94, v[76:77] offset:65408
    v_and_b32 v88, 0x0fffffff, v27
    buffer_load_dwordx2 v[22:23], v88, s[8:11], 0 offen
    buffer_load_dwordx3 v[24:26], v88, s[8:11], 0 offen offset:8
    v_mfma_f32_4x4x4_16b_bf16 v[80:83], v[8:9], v[102:103], 0
    v_mfma_f32_4x4x4_16b_bf16 v[76:79], v[8:9], v[100:101], 0
    v_cmp_lt_u32 s[84:85], v5, v92
    s_nop 2
    v_pk_mul_f32 v[80:81], v[80:81], v[14:15] op_sel:[0,1] op_sel_hi:[1,1]
    v_pk_mul_f32 v[82:83], v[82:83], v[14:15] op_sel:[0,1] op_sel_hi:[1,1]
    v_pk_mul_f32 v[76:77], v[76:77], v[14:15] op_sel:[0,0] op_sel_hi:[1,0]
    v_pk_mul_f32 v[78:79], v[78:79], v[14:15] op_sel:[0,0] op_sel_hi:[1,0]
    s_waitcnt vmcnt(8)
    s_mov_b64 exec, s[6:7]
    v_lshrrev_b32 v30, 16, v30
    s_mov_b64 exec, -1
    v_and_b32 v46, 0x20000000, v42
    v_lshrrev_b32 v47, 14, v29
    v_bitop3_b32 v47, v47, v5, v46 bitop3:0xea
    ds_read_b64 v[106:107], v47
    v_and_b32 v99, 0x10000000, v42
    v_lshrrev_b32 v47, 14, v28
    v_bitop3_b32 v47, v47, v5, v99 bitop3:0xea
    ds_read_b64 v[104:105], v47
    s_waitcnt lgkmcnt(2)
    v_cmp_ne_u64 s[50:51], v[72:73], v[68:69]
    v_cmpx_ne_u64 s[54:55], v[74:75], v[70:71]
    s_and_b64 s[82:83], s[54:55], s[80:81]
    s_cbranch_scc1 L2_c39
L2_d39:
    v_mov_b64 v[84:85], v[70:71]
    v_mov_b32 v7, v95
    v_mov_b64 v[86:87], v[74:75]
    s_or_b64 s[80:81], s[80:81], s[54:55]
    s_mov_b64 exec, s[50:51]
    s_and_b64 s[82:83], s[50:51], s[80:81]
    s_cbranch_scc1 L2_c40
L2_d40:
    v_mov_b64 v[84:85], v[68:69]
    v_mov_b32 v7, v94
    v_mov_b64 v[86:87], v[72:73]
    s_mov_b64 exec, -1
    s_or_b64 s[80:81], s[80:81], s[50:51]
    s_and_b64 exec, s[84:85], s[80:81]
    v_mfma_f32_4x4x4_16b_bf16 v[76:79], v[12:13], v[84:85], 0
    v_mov_b32 v92, v7
    s_andn2_b64 s[80:81], s[80:81], s[84:85]
    v_mfma_f32_4x4x4_16b_bf16 v[76:79], v[10:11], v[86:87], v[76:79]
    s_mov_b64 exec, -1
    ds_read_b64 v[70:71], v93 offset:65408
    ds_read_b64 v[68:69], v92 offset:65408
    v_bitop3_b32 v94, v28, v5, v99 bitop3:0xea
    v_bitop3_b32 v95, v29, v5, v46 bitop3:0xea
    v_perm_b32 v15, v29, v30, s45
    v_bitop3_b32 v46, v29, 0.5, -0.5 bitop3:0xa8
    v_perm_b32 v14, v28, v30, s44
    v_bitop3_b32 v47, v28, 0.5, -0.5 bitop3:0xa8
    v_bitop3_b32 v15, v6, v15, v46 bitop3:0xca
    v_bitop3_b32 v14, v6, v14, v47 bitop3:0xca
    s_waitcnt lgkmcnt(1)
    v_mfma_f32_4x4x4_16b_bf16 v[80:83], v[10:11], v[70:71], v[80:83]
    s_waitcnt lgkmcnt(0)
    v_mfma_f32_4x4x4_16b_bf16 v[76:79], v[10:11], v[68:69], v[76:79]
    s_nop 2
    v_cvt_pk_bf16_f32 v80, v80, v81
    v_cvt_pk_bf16_f32 v81, v82, v83
    ds_wrxchg_rtn_b64 v[74:75], v93, v[80:81] offset:65408
    v_cvt_pk_bf16_f32 v76, v76, v77
    v_cvt_pk_bf16_f32 v77, v78, v79
    ds_wrxchg_rtn_b64 v[72:73], v92, v[76:77] offset:65408
    s_setprio 0
    v_mfma_f32_4x4x4_16b_bf16 v[80:83], v[8:9], v[106:107], 0
    v_mfma_f32_4x4x4_16b_bf16 v[76:79], v[8:9], v[104:105], 0
    v_cmp_lt_u32 s[48:49], v5, v95
    s_nop 2
    v_pk_mul_f32 v[80:81], v[80:81], v[14:15] op_sel:[0,1] op_sel_hi:[1,1]
    v_pk_mul_f32 v[82:83], v[82:83], v[14:15] op_sel:[0,1] op_sel_hi:[1,1]
    v_pk_mul_f32 v[76:77], v[76:77], v[14:15] op_sel:[0,0] op_sel_hi:[1,0]
    v_pk_mul_f32 v[78:79], v[78:79], v[14:15] op_sel:[0,0] op_sel_hi:[1,0]
    s_add_u32 s40, s40, 0x50000
    v_and_b32 v47, 0x0fffffff, v31
    buffer_load_dword v30, v47, s[8:11], 0 offen offset:16
    s_mov_b64 exec, s[6:7]
    v_add_u32 v47, 8, v47
    v_lshrrev_b32 v31, 2, v31
    s_mov_b64 exec, -1
    buffer_load_dwordx2 v[28:29], v47, s[8:11], 0 offen
    s_waitcnt vmcnt(8)
    v_and_b32 v46, 0x80000000, v43
    v_lshrrev_b32 v47, 14, v37
    v_bitop3_b32 v47, v47, v5, v46 bitop3:0xea
    ds_read_b64 v[106:107], v47
    v_and_b32 v99, 0x40000000, v43
    v_lshrrev_b32 v47, 14, v36
    v_bitop3_b32 v47, v47, v5, v99 bitop3:0xea
    ds_read_b64 v[104:105], v47
    v_and_b32 v46, 0x20000000, v43
    v_lshrrev_b32 v47, 14, v35
    v_bitop3_b32 v47, v47, v5, v46 bitop3:0xea
    ds_read_b64 v[102:103], v47
    v_and_b32 v99, 0x10000000, v43
    v_lshrrev_b32 v47, 14, v34
    v_bitop3_b32 v47, v47, v5, v99 bitop3:0xea
    ds_read_b64 v[100:101], v47
    s_waitcnt lgkmcnt(4)
    v_cmp_ne_u64 s[50:51], v[72:73], v[68:69]
    v_cmpx_ne_u64 s[54:55], v[74:75], v[70:71]
    s_and_b64 s[82:83], s[54:55], s[80:81]
    s_cbranch_scc1 L2_c41
L2_d41:
    v_mov_b64 v[84:85], v[70:71]
    v_mov_b32 v7, v93
    v_mov_b64 v[86:87], v[74:75]
    s_or_b64 s[80:81], s[80:81], s[54:55]
    s_mov_b64 exec, s[50:51]
    s_and_b64 s[82:83], s[50:51], s[80:81]
    s_cbranch_scc1 L2_c42
L2_d42:
    v_mov_b64 v[84:85], v[68:69]
    v_mov_b32 v7, v92
    v_mov_b64 v[86:87], v[72:73]
    s_mov_b64 exec, -1
    s_or_b64 s[80:81], s[80:81], s[50:51]
    s_and_b64 exec, s[48:49], s[80:81]
    v_mfma_f32_4x4x4_16b_bf16 v[80:83], v[12:13], v[84:85], 0
    v_mov_b32 v95, v7
    s_andn2_b64 s[80:81], s[80:81], s[48:49]
    v_mfma_f32_4x4x4_16b_bf16 v[80:83], v[10:11], v[86:87], v[80:83]
    s_mov_b64 exec, -1
    ds_read_b64 v[70:71], v95 offset:65408
    ds_read_b64 v[68:69], v94 offset:65408
    v_bitop3_b32 v92, v34, v5, v99 bitop3:0xea
    v_bitop3_b32 v93, v35, v5, v46 bitop3:0xea
    v_perm_b32 v15, v35, v38, s45
    v_bitop3_b32 v46, v35, 0.5, -0.5 bitop3:0xa8
    v_perm_b32 v14, v34, v38, s44
    v_bitop3_b32 v47, v34, 0.5, -0.5 bitop3:0xa8
    v_bitop3_b32 v15, v6, v15, v46 bitop3:0xca
    v_bitop3_b32 v14, v6, v14, v47 bitop3:0xca
    s_waitcnt lgkmcnt(1)
    v_mfma_f32_4x4x4_16b_bf16 v[80:83], v[10:11], v[70:71], v[80:83]
    s_waitcnt lgkmcnt(0)
    v_mfma_f32_4x4x4_16b_bf16 v[76:79], v[10:11], v[68:69], v[76:79]
    s_nop 2
    v_cvt_pk_bf16_f32 v80, v80, v81
    v_cvt_pk_bf16_f32 v81, v82, v83
    ds_wrxchg_rtn_b64 v[74:75], v95, v[80:81] offset:65408
    v_cvt_pk_bf16_f32 v76, v76, v77
    v_cvt_pk_bf16_f32 v77, v78, v79
    ds_wrxchg_rtn_b64 v[72:73], v94, v[76:77] offset:65408
    s_barrier
    s_setprio 3
    s_mov_b32 m0, s100
    s_nop 0
    ds_write_addtid_b32 v124 offset:34816
    ds_write_addtid_b32 v125 offset:35072
    ds_write_addtid_b32 v126 offset:35328
    ds_write_addtid_b32 v127 offset:35584
    s_add_u32 s3, s40, 4096
    buffer_load_dwordx4 v[124:127], v3, s[16:19], s3 offen sc1
    ds_write_addtid_b32 v116 offset:32768
    ds_write_addtid_b32 v117 offset:33024
    ds_write_addtid_b32 v118 offset:33280
    ds_write_addtid_b32 v119 offset:33536
    buffer_load_dwordx4 v[116:119], v3, s[16:19], s40 offen offset:2048 sc1
    ds_write_addtid_b32 v120 offset:33792
    ds_write_addtid_b32 v121 offset:34048
    ds_write_addtid_b32 v122 offset:34304
    ds_write_addtid_b32 v123 offset:34560
    buffer_load_dwordx4 v[120:123], v3, s[16:19], s40 offen offset:3072 sc1
    v_mfma_f32_4x4x4_16b_bf16 v[80:83], v[8:9], v[102:103], 0
    v_mfma_f32_4x4x4_16b_bf16 v[76:79], v[8:9], v[100:101], 0
    s_nop 3
    v_pk_mul_f32 v[80:81], v[80:81], v[14:15] op_sel:[0,1] op_sel_hi:[1,1]
    v_pk_mul_f32 v[82:83], v[82:83], v[14:15] op_sel:[0,1] op_sel_hi:[1,1]
    v_pk_mul_f32 v[76:77], v[76:77], v[14:15] op_sel:[0,0] op_sel_hi:[1,0]
    v_pk_mul_f32 v[78:79], v[78:79], v[14:15] op_sel:[0,0] op_sel_hi:[1,0]
    s_cmp_gt_u32 s37, 1024
    s_cbranch_scc1 L2_xs43
    s_cmp_lg_u32 s101, 0
    s_cbranch_scc1 L2_xa43
L2_xb43:
    v_lshlrev_b32 v89, 16, v96
    v_add_u32 v90, 60, v97
    v_bitop3_b32 v90, v89, v45, v90 bitop3:0x6a
    ds_write_b32 v98, v90 offset:12
    v_lshlrev_b32 v89, 20, v96
    v_add_u32 v90, 40, v97
    v_bitop3_b32 v90, v89, v45, v90 bitop3:0x6a
    ds_write_b32 v98, v90 offset:8
    v_lshlrev_b32 v89, 24, v96
    v_add_u32 v90, 20, v97
    v_bitop3_b32 v90, v89, v45, v90 bitop3:0x6a
    ds_write_b32 v98, v90 offset:4
    v_lshlrev_b32 v89, 28, v96
    v_bitop3_b32 v90, v89, v45, v97 bitop3:0x6a
    ds_write_b32 v98, v90 offset:0
    v_mov_b32_dpp v91, v66 quad_perm:[1,1,1,1] row_mask:0xf bank_mask:0xf
    v_and_b32 v89, 3, v91
    v_and_b32 v97, 0xfffc, v91
    v_sub_u16_dpp v88, v66, v91 quad_perm:[3,3,3,3] row_mask:0xf bank_mask:0xf
    v_mad_u32_u24 v97, v97, 5, v4
    v_add_u32 v99, v88, v89
    v_bfm_b32 v96, v88, v89
    v_cmp_lt_u32 s[58:59], 16, v99
    v_lshlrev_b32 v89, v1, v96
    v_and_b32 v89, v45, v89
    v_cmp_ne_u32 vcc, 0, v89
    v_xor_b32 v90, v97, v89
    s_add_u32 s3, s37, s38
    v_mbcnt_lo_u32_b32 v98, vcc_lo, 0
    v_mbcnt_hi_u32_b32 v98, vcc_hi, v98
    s_bcnt1_i32_b64 s41, vcc
    v_lshl_add_u32 v98, v98, 2, s3
    s_lshl2_add_u32 s37, s41, s37
    s_mov_b64 exec, vcc
    ds_write_b32 v98, v90
    s_mov_b64 exec, -1
    s_cmp_lg_u64 s[58:59], 0
    s_cbranch_scc1 L2_xe43
L2_xr43:
    v_add_u32 v98, s37, v0
    v_mov_b32 v90, -1
    ds_write_b32 v98, v90
L2_xw43:
    s_setprio 2
    s_waitcnt lgkmcnt(14)
    v_cmp_ne_u64 s[50:51], v[72:73], v[68:69]
    v_cmpx_ne_u64 s[54:55], v[74:75], v[70:71]
    s_and_b64 s[82:83], s[54:55], s[80:81]
    s_cbranch_scc1 L2_c44
L2_d44:
    v_mov_b64 v[84:85], v[70:71]
    v_mov_b32 v7, v95
    v_mov_b64 v[86:87], v[74:75]
    s_or_b64 s[80:81], s[80:81], s[54:55]
    s_mov_b64 exec, s[50:51]
    s_and_b64 s[82:83], s[50:51], s[80:81]
    s_cbranch_scc1 L2_c45
L2_d45:
    v_mov_b64 v[84:85], v[68:69]
    v_mov_b32 v7, v94
    v_mov_b64 v[86:87], v[72:73]
    s_mov_b64 exec, -1
    s_or_b64 s[80:81], s[80:81], s[50:51]
    ds_read_b64 v[70:71], v93 offset:65408
    ds_read_b64 v[68:69], v92 offset:65408
    v_and_b32 v46, 0x40000000, v43
    v_bitop3_b32 v94, v36, v5, v46 bitop3:0xea
    v_and_b32 v46, 0x80000000, v43
    v_bitop3_b32 v95, v37, v5, v46 bitop3:0xea
    v_perm_b32 v15, v37, v38, s47
    v_bitop3_b32 v46, v37, 0.5, -0.5 bitop3:0xa8
    v_perm_b32 v14, v36, v38, s46
    v_bitop3_b32 v47, v36, 0.5, -0.5 bitop3:0xa8
    v_bitop3_b32 v15, v6, v15, v46 bitop3:0xca
    v_bitop3_b32 v14, v6, v14, v47 bitop3:0xca
    s_setprio 1
    s_waitcnt lgkmcnt(1)
    v_mfma_f32_4x4x4_16b_bf16 v[80:83], v[10:11], v[70:71], v[80:83]
    s_waitcnt lgkmcnt(0)
    v_mfma_f32_4x4x4_16b_bf16 v[76:79], v[10:11], v[68:69], v[76:79]
    s_nop 2
    v_cvt_pk_bf16_f32 v80, v80, v81
    v_cvt_pk_bf16_f32 v81, v82, v83
    ds_wrxchg_rtn_b64 v[74:75], v93, v[80:81] offset:65408
    v_cvt_pk_bf16_f32 v76, v76, v77
    v_cvt_pk_bf16_f32 v77, v78, v79
    ds_wrxchg_rtn_b64 v[72:73], v92, v[76:77] offset:65408
    ds_read_b32 v40, v0 offset:0
    ds_read_b32 v41, v0 offset:256
    ds_read_b32 v42, v44 offset:768
    ds_read_b32 v43, v0 offset:512
    s_sub_u32 s3, s37, 768
    s_cmp_gt_u32 s3, 128
    s_cbranch_scc1 L2_xf43
L2_xg43:
    v_lshrrev_b64 v[64:65], 16, v[64:65]
    v_lshrrev_b64 v[66:67], 16, v[66:67]
    v_and_b32 v88, 0x0fffffff, v39
    buffer_load_dwordx2 v[34:35], v88, s[8:11], 0 offen
    buffer_load_dwordx3 v[36:38], v88, s[8:11], 0 offen offset:8
    s_setprio 0
    s_waitcnt vmcnt(12)
    s_mov_b32 m0, s38
    s_nop 0
    ds_write_addtid_b32 v108 offset:0
    ds_write_addtid_b32 v109 offset:256
    ds_write_addtid_b32 v110 offset:512
    ds_write_addtid_b32 v111 offset:768
    s_waitcnt vmcnt(9)
    ds_write_addtid_b32 v112 offset:1024
    ds_write_addtid_b32 v113 offset:1280
    ds_write_addtid_b32 v114 offset:1536
    ds_write_addtid_b32 v115 offset:1792
    v_mfma_f32_4x4x4_16b_bf16 v[80:83], v[8:9], v[106:107], 0
    v_mfma_f32_4x4x4_16b_bf16 v[76:79], v[8:9], v[104:105], 0
    v_cmp_lt_u32 s[84:85], v5, v94
    s_nop 2
    v_pk_mul_f32 v[80:81], v[80:81], v[14:15] op_sel:[0,1] op_sel_hi:[1,1]
    v_pk_mul_f32 v[82:83], v[82:83], v[14:15] op_sel:[0,1] op_sel_hi:[1,1]
    v_pk_mul_f32 v[76:77], v[76:77], v[14:15] op_sel:[0,0] op_sel_hi:[1,0]
    v_pk_mul_f32 v[78:79], v[78:79], v[14:15] op_sel:[0,0] op_sel_hi:[1,0]
    s_add_u32 s42, s42, 1
    s_waitcnt lgkmcnt(0)
L2_loop:
    s_barrier
    s_bitcmp1_b32 s36, s42
    s_cbranch_scc1 L2_slow
L2_ret2:
    s_setprio 3
    s_bitcmp1_b32 s43, s42
    s_cbranch_scc1 L2_oa46
L2_ob46:
    v_and_b32 v46, 0x20000000, v21
    v_lshrrev_b32 v47, 14, v17
    v_bitop3_b32 v47, v47, v5, v46 bitop3:0xea
    ds_read_b64 v[102:103], v47
    v_and_b32 v99, 0x10000000, v21
    v_lshrrev_b32 v47, 14, v16
    v_bitop3_b32 v47, v47, v5, v99 bitop3:0xea
    ds_read_b64 v[100:101], v47
    v_cmp_ne_u64 s[50:51], v[72:73], v[68:69]
    v_cmpx_ne_u64 s[54:55], v[74:75], v[70:71]
    s_and_b64 s[82:83], s[54:55], s[80:81]
    s_cbranch_scc1 L2_c47
L2_d47:
    v_mov_b64 v[84:85], v[70:71]
    v_mov_b32 v7, v93
    v_mov_b64 v[86:87], v[74:75]
    s_or_b64 s[80:81], s[80:81], s[54:55]
    s_mov_b64 exec, s[50:51]
    s_and_b64 s[82:83], s[50:51], s[80:81]
    s_cbranch_scc1 L2_c48
L2_d48:
    v_mov_b64 v[84:85], v[68:69]
    v_mov_b32 v7, v92
    v_mov_b64 v[86:87], v[72:73]
    s_mov_b64 exec, -1
    s_or_b64 s[80:81], s[80:81], s[50:51]
    s_and_b64 exec, s[84:85], s[80:81]
    v_mfma_f32_4x4x4_16b_bf16 v[76:79], v[12:13], v[84:85], 0
    v_mov_b32 v94, v7
    s_andn2_b64 s[80:81], s[80:81], s[84:85]
    v_mfma_f32_4x4x4_16b_bf16 v[76:79], v[10:11], v[86:87], v[76:79]
    s_mov_b64 exec, -1
    ds_read_b64 v[70:71], v95 offset:65408
    ds_read_b64 v[68:69], v94 offset:65408
    v_bitop3_b32 v92, v16, v5, v99 bitop3:0xea
    v_bitop3_b32 v93, v17, v5, v46 bitop3:0xea
    v_perm_b32 v15, v17, v20, s45
    v_bitop3_b32 v46, v17, 0.5, -0.5 bitop3:0xa8
    v_perm_b32 v14, v16, v20, s44
    v_bitop3_b32 v47, v16, 0.5, -0.5 bitop3:0xa8
    v_bitop3_b32 v15, v6, v15, v46 bitop3:0xca
    v_bitop3_b32 v14, v6, v14, v47 bitop3:0xca
    s_waitcnt lgkmcnt(1)
    v_mfma_f32_4x4x4_16b_bf16 v[80:83], v[10:11], v[70:71], v[80:83]
    s_waitcnt lgkmcnt(0)
    v_mfma_f32_4x4x4_16b_bf16 v[76:79], v[10:11], v[68:69], v[76:79]
    s_nop 2
    v_cvt_pk_bf16_f32 v80, v80, v81
    v_cvt_pk_bf16_f32 v81, v82, v83
    ds_wrxchg_rtn_b64 v[74:75], v95, v[80:81] offset:65408
    v_cvt_pk_bf16_f32 v76, v76, v77
    v_cvt_pk_bf16_f32 v77, v78, v79
    ds_wrxchg_rtn_b64 v[72:73], v94, v[76:77] offset:65408
    v_mfma_f32_4x4x4_16b_bf16 v[80:83], v[8:9], v[102:103], 0
    v_mfma_f32_4x4x4_16b_bf16 v[76:79], v[8:9], v[100:101], 0
    v_cmp_lt_u32 s[84:85], v5, v92
    s_nop 2
    v_pk_mul_f32 v[80:81], v[80:81], v[14:15] op_sel:[0,1] op_sel_hi:[1,1]
    v_pk_mul_f32 v[82:83], v[82:83], v[14:15] op_sel:[0,1] op_sel_hi:[1,1]
    v_pk_mul_f32 v[76:77], v[76:77], v[14:15] op_sel:[0,0] op_sel_hi:[1,0]
    v_pk_mul_f32 v[78:79], v[78:79], v[14:15] op_sel:[0,0] op_sel_hi:[1,0]
    buffer_load_dwordx4 v[108:111], v3, s[16:19], s40 offen offset:0 sc1
    v_and_b32 v46, 0x80000000, v21
    v_lshrrev_b32 v47, 14, v19
    v_bitop3_b32 v47, v47, v5, v46 bitop3:0xea
    ds_read_b64 v[106:107], v47
    v_and_b32 v99, 0x40000000, v21
    v_lshrrev_b32 v47, 14, v18
    v_bitop3_b32 v47, v47, v5, v99 bitop3:0xea
    ds_read_b64 v[104:105], v47
    s_waitcnt lgkmcnt(2)
    v_cmp_ne_u64 s[50:51], v[72:73], v[68:69]
    v_cmpx_ne_u64 s[54:55], v[74:75], v[70:71]
    s_and_b64 s[82:83], s[54:55], s[80:81]
    s_cbranch_scc1 L2_c49
L2_d49:
    v_mov_b64 v[84:85], v[70:71]
    v_mov_b32 v7, v95
    v_mov_b64 v[86:87], v[74:75]
    s_or_b64 s[80:81], s[80:81], s[54:55]
    s_mov_b64 exec, s[50:51]
    s_and_b64 s[82:83], s[50:51], s[80:81]
    s_cbranch_scc1 L2_c50
L2_d50:
    v_mov_b64 v[84:85], v[68:69]
    v_mov_b32 v7, v94
    v_mov_b64 v[86:87], v[72:73]
    s_mov_b64 exec, -1
    s_or_b64 s[80:81], s[80:81], s[50:51]
    s_and_b64 exec, s[84:85], s[80:81]
    v_mfma_f32_4x4x4_16b_bf16 v[76:79], v[12:13], v[84:85], 0
    v_mov_b32 v92, v7
    s_andn2_b64 s[80:81], s[80:81], s[84:85]
    v_mfma_f32_4x4x4_16b_bf16 v[76:79], v[10:11], v[86:87], v[76:79]
    s_mov_b64 exec, -1
    ds_read_b64 v[70:71], v93 offset:65408
    ds_read_b64 v[68:69], v92 offset:65408
    v_bitop3_b32 v94, v18, v5, v99 bitop3:0xea
    v_bitop3_b32 v95, v19, v5, v46 bitop3:0xea
    v_perm_b32 v15, v19, v20, s47
    v_bitop3_b32 v46, v19, 0.5, -0.5 bitop3:0xa8
    v_perm_b32 v14, v18, v20, s46
    v_bitop3_b32 v47, v18, 0.5, -0.5 bitop3:0xa8
    v_bitop3_b32 v15, v6, v15, v46 bitop3:0xca
    v_bitop3_b32 v14, v6, v14, v47 bitop3:0xca
    s_waitcnt lgkmcnt(1)
    v_mfma_f32_4x4x4_16b_bf16 v[80:83], v[10:11], v[70:71], v[80:83]
    s_waitcnt lgkmcnt(0)
    v_mfma_f32_4x4x4_16b_bf16 v[76:79], v[10:11], v[68:69], v[76:79]
    s_nop 2
    v_cvt_pk_bf16_f32 v80, v80, v81
    v_cvt_pk_bf16_f32 v81, v82, v83
    ds_wrxchg_rtn_b64 v[74:75], v93, v[80:81] offset:65408
    v_cvt_pk_bf16_f32 v76, v76, v77
    v_cvt_pk_bf16_f32 v77, v78, v79
    ds_wrxchg_rtn_b64 v[72:73], v92, v[76:77] offset:65408
    v_and_b32 v88, 0x0fffffff, v40
    buffer_load_dwordx2 v[16:17], v88, s[8:11], 0 offen
    buffer_load_dwordx3 v[18:20], v88, s[8:11], 0 offen offset:8
    s_setprio 2
    v_mfma_f32_4x4x4_16b_bf16 v[80:83], v[8:9], v[106:107], 0
    v_mfma_f32_4x4x4_16b_bf16 v[76:79], v[8:9], v[104:105], 0
    v_cmp_lt_u32 s[48:49], v5, v95
    s_nop 2
    v_pk_mul_f32 v[80:81], v[80:81], v[14:15] op_sel:[0,1] op_sel_hi:[1,1]
    v_pk_mul_f32 v[82:83], v[82:83], v[14:15] op_sel:[0,1] op_sel_hi:[1,1]
    v_pk_mul_f32 v[76:77], v[76:77], v[14:15] op_sel:[0,0] op_sel_hi:[1,0]
    v_pk_mul_f32 v[78:79], v[78:79], v[14:15] op_sel:[0,0] op_sel_hi:[1,0]
    s_waitcnt vmcnt(10)
    v_and_b32 v46, 0x20000000, v27
    v_lshrrev_b32 v47, 14, v23
    v_bitop3_b32 v47, v47, v5, v46 bitop3:0xea
    ds_read_b64 v[102:103], v47
    v_and_b32 v99, 0x10000000, v27
    v_lshrrev_b32 v47, 14, v22
    v_bitop3_b32 v47, v47, v5, v99 bitop3:0xea
    ds_read_b64 v[100:101], v47
    s_waitcnt lgkmcnt(2)
    v_cmp_ne_u64 s[50:51], v[72:73], v[68:69]
    v_cmpx_ne_u64 s[54:55], v[74:75], v[70:71]
    s_and_b64 s[82:83], s[54:55], s[80:81]
    s_cbranch_scc1 L2_c51
L2_d51:
    v_mov_b64 v[84:85], v[70:71]
    v_mov_b32 v7, v93
    v_mov_b64 v[86:87], v[74:75]
    s_or_b64 s[80:81], s[80:81], s[54:55]
    s_mov_b64 exec, s[50:51]
    s_and_b64 s[82:83], s[50:51], s[80:81]
    s_cbranch_scc1 L2_c52
L2_d52:
    v_mov_b64 v[84:85], v[68:69]
    v_mov_b32 v7, v92
    v_mov_b64 v[86:87], v[72:73]
    s_mov_b64 exec, -1
    s_or_b64 s[80:81], s[80:81], s[50:51]
    s_and_b64 exec, s[48:49], s[80:81]
    v_mfma_f32_4x4x4_16b_bf16 v[80:83], v[12:13], v[84:85], 0
    v_mov_b32 v95, v7
    s_andn2_b64 s[80:81], s[80:81], s[48:49]
    v_mfma_f32_4x4x4_16b_bf16 v[80:83], v[10:11], v[86:87], v[80:83]
    s_mov_b64 exec, -1
    ds_read_b64 v[70:71], v95 offset:65408
    ds_read_b64 v[68:69], v94 offset:65408
    v_bitop3_b32 v92, v22, v5, v99 bitop3:0xea
    v_bitop3_b32 v93, v23, v5, v46 bitop3:0xea
    v_perm_b32 v15, v23, v26, s45
    v_bitop3_b32 v46, v23, 0.5, -0.5 bitop3:0xa8
    v_perm_b32 v14, v22, v26, s44
    v_bitop3_b32 v47, v22, 0.5, -0.5 bitop3:0xa8
    v_bitop3_b32 v15, v6, v15, v46 bitop3:0xca
    v_bitop3_b32 v14, v6, v14, v47 bitop3:0xca
    s_waitcnt lgkmcnt(1)
    v_mfma_f32_4x4x4_16b_bf16 v[80:83], v[10:11], v[70:71], v[80:83]
    s_waitcnt lgkmcnt(0)
    v_mfma_f32_4x4x4_16b_bf16 v[76:79], v[10:11], v[68:69], v[76:79]
    s_nop 2
    v_cvt_pk_bf16_f32 v80, v80, v81
    v_cvt_pk_bf16_f32 v81, v82, v83
    ds_wrxchg_rtn_b64 v[74:75], v95, v[80:81] offset:65408
    v_cvt_pk_bf16_f32 v76, v76, v77
    v_cvt_pk_bf16_f32 v77, v78, v79
    ds_wrxchg_rtn_b64 v[72:73], v94, v[76:77] offset:65408
    s_setprio 1
    v_mfma_f32_4x4x4_16b_bf16 v[80:83], v[8:9], v[102:103], 0
    v_mfma_f32_4x4x4_16b_bf16 v[76:79], v[8:9], v[100:101], 0
    s_nop 3
    v_pk_mul_f32 v[80:81], v[80:81], v[14:15] op_sel:[0,1] op_sel_hi:[1,1]
    v_pk_mul_f32 v[82:83], v[82:83], v[14:15] op_sel:[0,1] op_sel_hi:[1,1]
    v_pk_mul_f32 v[76:77], v[76:77], v[14:15] op_sel:[0,0] op_sel_hi:[1,0]
    v_pk_mul_f32 v[78:79], v[78:79], v[14:15] op_sel:[0,0] op_sel_hi:[1,0]
    s_bitcmp1_b32 s43, s42
    s_cbranch_scc1 L2_oa53
L2_ob53:
    buffer_load_dwordx4 v[112:115], v3, s[16:19], s40 offen offset:1024 sc1
    v_sub_u16 v88, v56, v48
    v_and_b32 v89, 3, v48
    v_add3_u32 v99, v88, v89, 3
    v_and_b32 v99, -4, v99
    v_max_u32 v99, 4, v99
    v_and_b32 v97, 0xfffc, v48
    v_bfm_b32 v96, v88, v89
    v_add_u32_dpp v91, v99, v99 row_shr:1 row_mask:0xf bank_mask:0xf bound_ctrl:1
    v_mad_u32_u24 v97, v97, 5, v2
    v_cmp_lt_u32 vcc, 16, v99
    v_add_u32_dpp v91, v91, v91 row_shr:2 row_mask:0xf bank_mask:0xf bound_ctrl:1
    v_sub_u32 v98, s38, v99
    v_lshrrev_b64 v[48:49], 16, v[48:49]
    v_add_u32_dpp v91, v91, v91 row_shr:4 row_mask:0xf bank_mask:0xf bound_ctrl:1
    v_lshrrev_b64 v[56:57], 16, v[56:57]
    s_mov_b32 s101, 0
    v_add_u32_dpp v91, v91, v91 row_shr:8 row_mask:0xf bank_mask:0xf bound_ctrl:1
    s_nop 1
    v_add_u32_dpp v91, v91, v91 row_bcast:15 row_mask:0xa bank_mask:0xf
    s_nop 1
    v_add_u32_dpp v91, v91, v91 row_bcast:31 row_mask:0xc bank_mask:0xf
    v_add_u32 v98, v98, v91
    v_readlane_b32 s37, v91, 63
    s_cbranch_vccnz L2_xo54
L2_xp54:
    v_and_b32 v46, 0x80000000, v27
    v_lshrrev_b32 v47, 14, v25
    v_bitop3_b32 v47, v47, v5, v46 bitop3:0xea
    ds_read_b64 v[106:107], v47
    v_and_b32 v99, 0x40000000, v27
    v_lshrrev_b32 v47, 14, v24
    v_bitop3_b32 v47, v47, v5, v99 bitop3:0xea
    ds_read_b64 v[104:105], v47
    s_waitcnt lgkmcnt(2)
    v_cmp_ne_u64 s[50:51], v[72:73], v[68:69]
    v_cmpx_ne_u64 s[54:55], v[74:75], v[70:71]
    s_and_b64 s[82:83], s[54:55], s[80:81]
    s_cbranch_scc1 L2_c55
L2_d55:
    v_mov_b64 v[84:85], v[70:71]
    v_mov_b32 v7, v95
    v_mov_b64 v[86:87], v[74:75]
    s_or_b64 s[80:81], s[80:81], s[54:55]
    s_mov_b64 exec, s[50:51]
    s_and_b64 s[82:83], s[50:51], s[80:81]
    s_cbranch_scc1 L2_c56
L2_d56:
    v_mov_b64 v[84:85], v[68:69]
    v_mov_b32 v7, v94
    v_mov_b64 v[86:87], v[72:73]
    s_mov_b64 exec, -1
    s_or_b64 s[80:81], s[80:81], s[50:51]
    ds_read_b64 v[70:71], v93 offset:65408
    ds_read_b64 v[68:69], v92 offset:65408
    v_bitop3_b32 v94, v24, v5, v99 bitop3:0xea
    v_bitop3_b32 v95, v25, v5, v46 bitop3:0xea
    v_perm_b32 v15, v25, v26, s47
    v_bitop3_b32 v46, v25, 0.5, -0.5 bitop3:0xa8
    v_perm_b32 v14, v24, v26, s46
    v_bitop3_b32 v47, v24, 0.5, -0.5 bitop3:0xa8
    v_bitop3_b32 v15, v6, v15, v46 bitop3:0xca
    v_bitop3_b32 v14, v6, v14, v47 bitop3:0xca
    s_waitcnt lgkmcnt(1)
    v_mfma_f32_4x4x4_16b_bf16 v[80:83], v[10:11], v[70:71], v[80:83]
    s_waitcnt lgkmcnt(0)
    v_mfma_f32_4x4x4_16b_bf16 v[76:79], v[10:11], v[68:69], v[76:79]
    s_nop 2
    v_cvt_pk_bf16_f32 v80, v80, v81
    v_cvt_pk_bf16_f32 v81, v82, v83
    ds_wrxchg_rtn_b64 v[74:75], v93, v[80:81] offset:65408
    v_cvt_pk_bf16_f32 v76, v76, v77
    v_cvt_pk_bf16_f32 v77, v78, v79
    ds_wrxchg_rtn_b64 v[72:73], v92, v[76:77] offset:65408
    v_and_b32 v88, 0x0fffffff, v41
    buffer_load_dwordx2 v[22:23], v88, s[8:11], 0 offen
    buffer_load_dwordx3 v[24:26], v88, s[8:11], 0 offen offset:8
    v_mfma_f32_4x4x4_16b_bf16 v[80:83], v[8:9], v[106:107], 0
    v_mfma_f32_4x4x4_16b_bf16 v[76:79], v[8:9], v[104:105], 0
    v_cmp_lt_u32 s[84:85], v5, v94
    s_nop 2
    v_pk_mul_f32 v[80:81], v[80:81], v[14:15] op_sel:[0,1] op_sel_hi:[1,1]
    v_pk_mul_f32 v[82:83], v[82:83], v[14:15] op_sel:[0,1] op_sel_hi:[1,1]
    v_pk_mul_f32 v[76:77], v[76:77], v[14:15] op_sel:[0,0] op_sel_hi:[1,0]
    v_pk_mul_f32 v[78:79], v[78:79], v[14:15] op_sel:[0,0] op_sel_hi:[1,0]
    s_waitcnt vmcnt(11)
    s_mov_b64 exec, s[6:7]
    v_lshrrev_b32 v30, 16, v30
    s_mov_b64 exec, -1
    v_and_b32 v46, 0x20000000, v31
    v_lshrrev_b32 v47, 14, v29
    v_bitop3_b32 v47, v47, v5, v46 bitop3:0xea
    ds_read_b64 v[102:103], v47
    v_and_b32 v99, 0x10000000, v31
    v_lshrrev_b32 v47, 14, v28
    v_bitop3_b32 v47, v47, v5, v99 bitop3:0xea
    ds_read_b64 v[100:101], v47
    s_waitcnt lgkmcnt(2)
    v_cmp_ne_u64 s[50:51], v[72:73], v[68:69]
    v_cmpx_ne_u64 s[54:55], v[74:75], v[70:71]
    s_and_b64 s[82:83], s[54:55], s[80:81]
    s_cbranch_scc1 L2_c57
L2_d57:
    v_mov_b64 v[84:85], v[70:71]
    v_mov_b32 v7, v93
    v_mov_b64 v[86:87], v[74:75]
    s_or_b64 s[80:81], s[80:81], s[54:55]
    s_mov_b64 exec, s[50:51]
    s_and_b64 s[82:83], s[50:51], s[80:81]
    s_cbranch_scc1 L2_c58
L2_d58:
    v_mov_b64 v[84:85], v[68:69]
    v_mov_b32 v7, v92
    v_mov_b64 v[86:87], v[72:73]
    s_mov_b64 exec, -1
    s_or_b64 s[80:81], s[80:81], s[50:51]
    s_and_b64 exec, s[84:85], s[80:81]
    v_mfma_f32_4x4x4_16b_bf16 v[76:79], v[12:13], v[84:85], 0
    v_mov_b32 v94, v7
    s_andn2_b64 s[80:81], s[80:81], s[84:85]
    v_mfma_f32_4x4x4_16b_bf16 v[76:79], v[10:11], v[86:87], v[76:79]
    s_mov_b64 exec, -1
    ds_read_b64 v[70:71], v95 offset:65408
    ds_read_b64 v[68:69], v94 offset:65408
    v_bitop3_b32 v92, v28, v5, v99 bitop3:0xea
    v_bitop3_b32 v93, v29, v5, v46 bitop3:0xea
    v_perm_b32 v15, v29, v30, s45
    v_bitop3_b32 v46, v29, 0.5, -0.5 bitop3:0xa8
    v_perm_b32 v14, v28, v30, s44
    v_bitop3_b32 v47, v28, 0.5, -0.5 bitop3:0xa8
    v_bitop3_b32 v15, v6, v15, v46 bitop3:0xca
    v_bitop3_b32 v14, v6, v14, v47 bitop3:0xca
    s_waitcnt lgkmcnt(1)
    v_mfma_f32_4x4x4_16b_bf16 v[80:83], v[10:11], v[70:71], v[80:83]
    s_waitcnt lgkmcnt(0)
    v_mfma_f32_4x4x4_16b_bf16 v[76:79], v[10:11], v[68:69], v[76:79]
    s_nop 2
    v_cvt_pk_bf16_f32 v80, v80, v81
    v_cvt_pk_bf16_f32 v81, v82, v83
    ds_wrxchg_rtn_b64 v[74:75], v95, v[80:81] offset:65408
    v_cvt_pk_bf16_f32 v76, v76, v77
    v_cvt_pk_bf16_f32 v77, v78, v79
    ds_wrxchg_rtn_b64 v[72:73], v94, v[76:77] offset:65408
    s_setprio 0
    v_mfma_f32_4x4x4_16b_bf16 v[80:83], v[8:9], v[102:103], 0
    v_mfma_f32_4x4x4_16b_bf16 v[76:79], v[8:9], v[100:101], 0
    v_cmp_lt_u32 s[48:49], v5, v93
    s_nop 2
    v_pk_mul_f32 v[80:81], v[80:81], v[14:15] op_sel:[0,1] op_sel_hi:[1,1]
    v_pk_mul_f32 v[82:83], v[82:83], v[14:15] op_sel:[0,1] op_sel_hi:[1,1]
    v_pk_mul_f32 v[76:77], v[76:77], v[14:15] op_sel:[0,0] op_sel_hi:[1,0]
    v_pk_mul_f32 v[78:79], v[78:79], v[14:15] op_sel:[0,0] op_sel_hi:[1,0]
    s_add_u32 s40, s40, 0xfff24000
    v_and_b32 v47, 0x0fffffff, v42
    buffer_load_dword v30, v47, s[8:11], 0 offen offset:16
    s_mov_b64 exec, s[6:7]
    v_add_u32 v47, 8, v47
    v_lshrrev_b32 v42, 2, v42
    s_mov_b64 exec, -1
    buffer_load_dwordx2 v[28:29], v47, s[8:11], 0 offen
    s_waitcnt vmcnt(8)
    v_and_b32 v46, 0x80000000, v39
    v_lshrrev_b32 v47, 14, v37
    v_bitop3_b32 v47, v47, v5, v46 bitop3:0xea
    ds_read_b64 v[102:103], v47
    v_and_b32 v99, 0x40000000, v39
    v_lshrrev_b32 v47, 14, v36
    v_bitop3_b32 v47, v47, v5, v99 bitop3:0xea
    ds_read_b64 v[100:101], v47
    v_and_b32 v46, 0x20000000, v39
    v_lshrrev_b32 v47, 14, v35
    v_bitop3_b32 v47, v47, v5, v46 bitop3:0xea
    ds_read_b64 v[106:107], v47
    v_and_b32 v99, 0x10000000, v39
    v_lshrrev_b32 v47, 14, v34
    v_bitop3_b32 v47, v47, v5, v99 bitop3:0xea
    ds_read_b64 v[104:105], v47
    s_waitcnt lgkmcnt(4)
    v_cmp_ne_u64 s[50:51], v[72:73], v[68:69]
    v_cmpx_ne_u64 s[54:55], v[74:75], v[70:71]
    s_and_b64 s[82:83], s[54:55], s[80:81]
    s_cbranch_scc1 L2_c59
L2_d59:
    v_mov_b64 v[84:85], v[70:71]
    v_mov_b32 v7, v95
    v_mov_b64 v[86:87], v[74:75]
    s_or_b64 s[80:81], s[80:81], s[54:55]
    s_mov_b64 exec, s[50:51]
    s_and_b64 s[82:83], s[50:51], s[80:81]
    s_cbranch_scc1 L2_c60
L2_d60:
    v_mov_b64 v[84:85], v[68:69]
    v_mov_b32 v7, v94
    v_mov_b64 v[86:87], v[72:73]
    s_mov_b64 exec, -1
    s_or_b64 s[80:81], s[80:81], s[50:51]
    s_and_b64 exec, s[48:49], s[80:81]
    v_mfma_f32_4x4x4_16b_bf16 v[80:83], v[12:13], v[84:85], 0
    v_mov_b32 v93, v7
    s_andn2_b64 s[80:81], s[80:81], s[48:49]
    v_mfma_f32_4x4x4_16b_bf16 v[80:83], v[10:11], v[86:87], v[80:83]
    s_mov_b64 exec, -1
    ds_read_b64 v[70:71], v93 offset:65408
    ds_read_b64 v[68:69], v92 offset:65408
    v_bitop3_b32 v94, v34, v5, v99 bitop3:0xea
    v_bitop3_b32 v95, v35, v5, v46 bitop3:0xea
    v_perm_b32 v15, v35, v38, s45
    v_bitop3_b32 v46, v35, 0.5, -0.5 bitop3:0xa8
    v_perm_b32 v14, v34, v38, s44
    v_bitop3_b32 v47, v34, 0.5, -0.5 bitop3:0xa8
    v_bitop3_b32 v15, v6, v15, v46 bitop3:0xca
    v_bitop3_b32 v14, v6, v14, v47 bitop3:0xca
    s_waitcnt lgkmcnt(1)
    v_mfma_f32_4x4x4_16b_bf16 v[80:83], v[10:11], v[70:71], v[80:83]
    s_waitcnt lgkmcnt(0)
    v_mfma_f32_4x4x4_16b_bf16 v[76:79], v[10:11], v[68:69], v[76:79]
    s_nop 2
    v_cvt_pk_bf16_f32 v80, v80, v81
    v_cvt_pk_bf16_f32 v81, v82, v83
    ds_wrxchg_rtn_b64 v[74:75], v93, v[80:81] offset:65408
    v_cvt_pk_bf16_f32 v76, v76, v77
    v_cvt_pk_bf16_f32 v77, v78, v79
    ds_wrxchg_rtn_b64 v[72:73], v92, v[76:77] offset:65408
    s_barrier
    s_setprio 3
    s_mov_b32 m0, s100
    s_nop 0
    ds_write_addtid_b32 v124 offset:34816
    ds_write_addtid_b32 v125 offset:35072
    ds_write_addtid_b32 v126 offset:35328
    ds_write_addtid_b32 v127 offset:35584
    s_add_u32 s3, s40, 4096
    buffer_load_dwordx4 v[124:127], v3, s[16:19], s3 offen sc1
    ds_write_addtid_b32 v116 offset:32768
    ds_write_addtid_b32 v117 offset:33024
    ds_write_addtid_b32 v118 offset:33280
    ds_write_addtid_b32 v119 offset:33536
    buffer_load_dwordx4 v[116:119], v3, s[16:19], s40 offen offset:2048 sc1
    ds_write_addtid_b32 v120 offset:33792
    ds_write_addtid_b32 v121 offset:34048
    ds_write_addtid_b32 v122 offset:34304
    ds_write_addtid_b32 v123 offset:34560
    buffer_load_dwordx4 v[120:123], v3, s[16:19], s40 offen offset:3072 sc1
    v_mfma_f32_4x4x4_16b_bf16 v[80:83], v[8:9], v[106:107], 0
    v_mfma_f32_4x4x4_16b_bf16 v[76:79], v[8:9], v[104:105], 0
    s_nop 3
    v_pk_mul_f32 v[80:81], v[80:81], v[14:15] op_sel:[0,1] op_sel_hi:[1,1]
    v_pk_mul_f32 v[82:83], v[82:83], v[14:15] op_sel:[0,1] op_sel_hi:[1,1]
    v_pk_mul_f32 v[76:77], v[76:77], v[14:15] op_sel:[0,0] op_sel_hi:[1,0]
    v_pk_mul_f32 v[78:79], v[78:79], v[14:15] op_sel:[0,0] op_sel_hi:[1,0]
    s_cmp_gt_u32 s37, 1024
    s_cbranch_scc1 L2_xs61
    s_cmp_lg_u32 s101, 0
    s_cbranch_scc1 L2_xa61
L2_xb61:
    v_lshlrev_b32 v89, 16, v96
    v_add_u32 v90, 60, v97
    v_bitop3_b32 v90, v89, v45, v90 bitop3:0x6a
    ds_write_b32 v98, v90 offset:12
    v_lshlrev_b32 v89, 20, v96
    v_add_u32 v90, 40, v97
    v_bitop3_b32 v90, v89, v45, v90 bitop3:0x6a
    ds_write_b32 v98, v90 offset:8
    v_lshlrev_b32 v89, 24, v96
    v_add_u32 v90, 20, v97
    v_bitop3_b32 v90, v89, v45, v90 bitop3:0x6a
    ds_write_b32 v98, v90 offset:4
    v_lshlrev_b32 v89, 28, v96
    v_bitop3_b32 v90, v89, v45, v97 bitop3:0x6a
    ds_write_b32 v98, v90 offset:0
    v_mov_b32_dpp v91, v64 quad_perm:[0,0,0,0] row_mask:0xf bank_mask:0xf
    v_and_b32 v89, 3, v91
    v_and_b32 v97, 0xfffc, v91
    v_sub_u16_dpp v88, v64, v91 quad_perm:[2,2,2,2] row_mask:0xf bank_mask:0xf
    v_mad_u32_u24 v97, v97, 5, v4
    v_add_u32 v99, v88, v89
    v_bfm_b32 v96, v88, v89
    v_cmp_lt_u32 s[58:59], 16, v99
    v_lshlrev_b32 v89, v1, v96
    v_and_b32 v89, v45, v89
    v_cmp_ne_u32 vcc, 0, v89
    v_xor_b32 v90, v97, v89
    s_add_u32 s3, s37, s38
    v_mbcnt_lo_u32_b32 v98, vcc_lo, 0
    v_mbcnt_hi_u32_b32 v98, vcc_hi, v98
    s_bcnt1_i32_b64 s41, vcc
    v_lshl_add_u32 v98, v98, 2, s3
    s_lshl2_add_u32 s37, s41, s37
    s_mov_b64 exec, vcc
    ds_write_b32 v98, v90
    s_mov_b64 exec, -1
    s_cmp_lg_u64 s[58:59], 0
    s_cbranch_scc1 L2_xe61
L2_xr61:
    v_add_u32 v98, s37, v0
    v_mov_b32 v90, -1
    ds_write_b32 v98, v90
L2_xw61:
    s_setprio 2
    s_waitcnt lgkmcnt(14)
    v_cmp_ne_u64 s[50:51], v[72:73], v[68:69]
    v_cmpx_ne_u64 s[54:55], v[74:75], v[70:71]
    s_and_b64 s[82:83], s[54:55], s[80:81]
    s_cbranch_scc1 L2_c62
L2_d62:
    v_mov_b64 v[84:85], v[70:71]
    v_mov_b32 v7, v93
    v_mov_b64 v[86:87], v[74:75]
    s_or_b64 s[80:81], s[80:81], s[54:55]
    s_mov_b64 exec, s[50:51]
    s_and_b64 s[82:83], s[50:51], s[80:81]
    s_cbranch_scc1 L2_c63
L2_d63:
    v_mov_b64 v[84:85], v[68:69]
    v_mov_b32 v7, v92
    v_mov_b64 v[86:87], v[72:73]
    s_mov_b64 exec, -1
    s_or_b64 s[80:81], s[80:81], s[50:51]
    ds_read_b64 v[70:71], v95 offset:65408
    ds_read_b64 v[68:69], v94 offset:65408
    v_and_b32 v46, 0x40000000, v39
    v_bitop3_b32 v92, v36, v5, v46 bitop3:0xea
    v_and_b32 v46, 0x80000000, v39
    v_bitop3_b32 v93, v37, v5, v46 bitop3:0xea
    v_perm_b32 v15, v37, v38, s47
    v_bitop3_b32 v46, v37, 0.5, -0.5 bitop3:0xa8
    v_perm_b32 v14, v36, v38, s46
    v_bitop3_b32 v47, v36, 0.5, -0.5 bitop3:0xa8
    v_bitop3_b32 v15, v6, v15, v46 bitop3:0xca
    v_bitop3_b32 v14, v6, v14, v47 bitop3:0xca
    s_setprio 1
    s_waitcnt lgkmcnt(1)
    v_mfma_f32_4x4x4_16b_bf16 v[80:83], v[10:11], v[70:71], v[80:83]
    s_waitcnt lgkmcnt(0)
    v_mfma_f32_4x4x4_16b_bf16 v[76:79], v[10:11], v[68:69], v[76:79]
    s_nop 2
    v_cvt_pk_bf16_f32 v80, v80, v81
    v_cvt_pk_bf16_f32 v81, v82, v83
    ds_wrxchg_rtn_b64 v[74:75], v95, v[80:81] offset:65408
    v_cvt_pk_bf16_f32 v76, v76, v77
    v_cvt_pk_bf16_f32 v77, v78, v79
    ds_wrxchg_rtn_b64 v[72:73], v94, v[76:77] offset:65408
    ds_read_b32 v21, v0 offset:0
    ds_read_b32 v27, v0 offset:256
    ds_read_b32 v31, v44 offset:768
    ds_read_b32 v39, v0 offset:512
    s_sub_u32 s3, s37, 768
    s_cmp_gt_u32 s3, 128
    s_cbranch_scc1 L2_xf61
L2_xg61:
    v_and_b32 v88, 0x0fffffff, v43
    buffer_load_dwordx2 v[34:35], v88, s[8:11], 0 offen
    buffer_load_dwordx3 v[36:38], v88, s[8:11], 0 offen offset:8
    s_setprio 0
    s_waitcnt vmcnt(12)
    s_mov_b32 m0, s38
    s_nop 0
    ds_write_addtid_b32 v108 offset:0
    ds_write_addtid_b32 v109 offset:256
    ds_write_addtid_b32 v110 offset:512
    ds_write_addtid_b32 v111 offset:768
    s_waitcnt vmcnt(9)
    ds_write_addtid_b32 v112 offset:1024
    ds_write_addtid_b32 v113 offset:1280
    ds_write_addtid_b32 v114 offset:1536
    ds_write_addtid_b32 v115 offset:1792
    v_mfma_f32_4x4x4_16b_bf16 v[80:83], v[8:9], v[102:103], 0
    v_mfma_f32_4x4x4_16b_bf16 v[76:79], v[8:9], v[100:101], 0
    v_cmp_lt_u32 s[84:85], v5, v92
    s_nop 2
    v_pk_mul_f32 v[80:81], v[80:81], v[14:15] op_sel:[0,1] op_sel_hi:[1,1]
    v_pk_mul_f32 v[82:83], v[82:83], v[14:15] op_sel:[0,1] op_sel_hi:[1,1]
    v_pk_mul_f32 v[76:77], v[76:77], v[14:15] op_sel:[0,0] op_sel_hi:[1,0]
    v_pk_mul_f32 v[78:79], v[78:79], v[14:15] op_sel:[0,0] op_sel_hi:[1,0]
    s_add_u32 s42, s42, 1
    s_waitcnt lgkmcnt(0)
    s_barrier
    s_bitcmp1_b32 s36, s42
    s_cbranch_scc1 L2_slow
L2_ret3:
    s_setprio 3
    s_bitcmp1_b32 s43, s42
    s_cbranch_scc1 L2_oa64
L2_ob64:
    v_and_b32 v46, 0x20000000, v40
    v_lshrrev_b32 v47, 14, v17
    v_bitop3_b32 v47, v47, v5, v46 bitop3:0xea
    ds_read_b64 v[106:107], v47
    v_and_b32 v99, 0x10000000, v40
    v_lshrrev_b32 v47, 14, v16
    v_bitop3_b32 v47, v47, v5, v99 bitop3:0xea
    ds_read_b64 v[104:105], v47
    v_cmp_ne_u64 s[50:51], v[72:73], v[68:69]
    v_cmpx_ne_u64 s[54:55], v[74:75], v[70:71]
    s_and_b64 s[82:83], s[54:55], s[80:81]
    s_cbranch_scc1 L2_c65
L2_d65:
    v_mov_b64 v[84:85], v[70:71]
    v_mov_b32 v7, v95
    v_mov_b64 v[86:87], v[74:75]
    s_or_b64 s[80:81], s[80:81], s[54:55]
    s_mov_b64 exec, s[50:51]
    s_and_b64 s[82:83], s[50:51], s[80:81]
    s_cbranch_scc1 L2_c66
L2_d66:
    v_mov_b64 v[84:85], v[68:69]
    v_mov_b32 v7, v94
    v_mov_b64 v[86:87], v[72:73]
    s_mov_b64 exec, -1
    s_or_b64 s[80:81], s[80:81], s[50:51]
    s_and_b64 exec, s[84:85], s[80:81]
    v_mfma_f32_4x4x4_16b_bf16 v[76:79], v[12:13], v[84:85], 0
    v_mov_b32 v92, v7
    s_andn2_b64 s[80:81], s[80:81], s[84:85]
    v_mfma_f32_4x4x4_16b_bf16 v[76:79], v[10:11], v[86:87], v[76:79]
    s_mov_b64 exec, -1
    ds_read_b64 v[70:71], v93 offset:65408
    ds_read_b64 v[68:69], v92 offset:65408
    v_bitop3_b32 v94, v16, v5, v99 bitop3:0xea
    v_bitop3_b32 v95, v17, v5, v46 bitop3:0xea
    v_perm_b32 v15, v17, v20, s45
    v_bitop3_b32 v46, v17, 0.5, -0.5 bitop3:0xa8
    v_perm_b32 v14, v16, v20, s44
    v_bitop3_b32 v47, v16, 0.5, -0.5 bitop3:0xa8
    v_bitop3_b32 v15, v6, v15, v46 bitop3:0xca
    v_bitop3_b32 v14, v6, v14, v47 bitop3:0xca
    s_waitcnt lgkmcnt(1)
    v_mfma_f32_4x4x4_16b_bf16 v[80:83], v[10:11], v[70:71], v[80:83]
    s_waitcnt lgkmcnt(0)
    v_mfma_f32_4x4x4_16b_bf16 v[76:79], v[10:11], v[68:69], v[76:79]
    s_nop 2
    v_cvt_pk_bf16_f32 v80, v80, v81
    v_cvt_pk_bf16_f32 v81, v82, v83
    ds_wrxchg_rtn_b64 v[74:75], v93, v[80:81] offset:65408
    v_cvt_pk_bf16_f32 v76, v76, v77
    v_cvt_pk_bf16_f32 v77, v78, v79
    ds_wrxchg_rtn_b64 v[72:73], v92, v[76:77] offset:65408
    v_mfma_f32_4x4x4_16b_bf16 v[80:83], v[8:9], v[106:107], 0
    v_mfma_f32_4x4x4_16b_bf16 v[76:79], v[8:9], v[104:105], 0
    v_cmp_lt_u32 s[84:85], v5, v94
    s_nop 2
    v_pk_mul_f32 v[80:81], v[80:81], v[14:15] op_sel:[0,1] op_sel_hi:[1,1]
    v_pk_mul_f32 v[82:83], v[82:83], v[14:15] op_sel:[0,1] op_sel_hi:[1,1]
    v_pk_mul_f32 v[76:77], v[76:77], v[14:15] op_sel:[0,0] op_sel_hi:[1,0]
    v_pk_mul_f32 v[78:79], v[78:79], v[14:15] op_sel:[0,0] op_sel_hi:[1,0]
    buffer_load_dwordx4 v[108:111], v3, s[16:19], s40 offen offset:0 sc1
    v_and_b32 v46, 0x80000000, v40
    v_lshrrev_b32 v47, 14, v19
    v_bitop3_b32 v47, v47, v5, v46 bitop3:0xea
    ds_read_b64 v[102:103], v47
    v_and_b32 v99, 0x40000000, v40
    v_lshrrev_b32 v47, 14, v18
    v_bitop3_b32 v47, v47, v5, v99 bitop3:0xea
    ds_read_b64 v[100:101], v47
    s_waitcnt lgkmcnt(2)
    v_cmp_ne_u64 s[50:51], v[72:73], v[68:69]
    v_cmpx_ne_u64 s[54:55], v[74:75], v[70:71]
    s_and_b64 s[82:83], s[54:55], s[80:81]
    s_cbranch_scc1 L2_c67
L2_d67:
    v_mov_b64 v[84:85], v[70:71]
    v_mov_b32 v7, v93
    v_mov_b64 v[86:87], v[74:75]
    s_or_b64 s[80:81], s[80:81], s[54:55]
    s_mov_b64 exec, s[50:51]
    s_and_b64 s[82:83], s[50:51], s[80:81]
    s_cbranch_scc1 L2_c68
L2_d68:
    v_mov_b64 v[84:85], v[68:69]
    v_mov_b32 v7, v92
    v_mov_b64 v[86:87], v[72:73]
    s_mov_b64 exec, -1
    s_or_b64 s[80:81], s[80:81], s[50:51]
    s_and_b64 exec, s[84:85], s[80:81]
    v_mfma_f32_4x4x4_16b_bf16 v[76:79], v[12:13], v[84:85], 0
    v_mov_b32 v94, v7
    s_andn2_b64 s[80:81], s[80:81], s[84:85]
    v_mfma_f32_4x4x4_16b_bf16 v[76:79], v[10:11], v[86:87], v[76:79]
    s_mov_b64 exec, -1
    ds_read_b64 v[70:71], v95 offset:65408
    ds_read_b64 v[68:69], v94 offset:65408
    v_bitop3_b32 v92, v18, v5, v99 bitop3:0xea
    v_bitop3_b32 v93, v19, v5, v46 bitop3:0xea
    v_perm_b32 v15, v19, v20, s47
    v_bitop3_b32 v46, v19, 0.5, -0.5 bitop3:0xa8
    v_perm_b32 v14, v18, v20, s46
    v_bitop3_b32 v47, v18, 0.5, -0.5 bitop3:0xa8
    v_bitop3_b32 v15, v6, v15, v46 bitop3:0xca
    v_bitop3_b32 v14, v6, v14, v47 bitop3:0xca
    s_waitcnt lgkmcnt(1)
    v_mfma_f32_4x4x4_16b_bf16 v[80:83], v[10:11], v[70:71], v[80:83]
    s_waitcnt lgkmcnt(0)
    v_mfma_f32_4x4x4_16b_bf16 v[76:79], v[10:11], v[68:69], v[76:79]
    s_nop 2
    v_cvt_pk_bf16_f32 v80, v80, v81
    v_cvt_pk_bf16_f32 v81, v82, v83
    ds_wrxchg_rtn_b64 v[74:75], v95, v[80:81] offset:65408
    v_cvt_pk_bf16_f32 v76, v76, v77
    v_cvt_pk_bf16_f32 v77, v78, v79
    ds_wrxchg_rtn_b64 v[72:73], v94, v[76:77] offset:65408
    v_and_b32 v88, 0x0fffffff, v21
    buffer_load_dwordx2 v[16:17], v88, s[8:11], 0 offen
    buffer_load_dwordx3 v[18:20], v88, s[8:11], 0 offen offset:8
    s_setprio 2
    v_mfma_f32_4x4x4_16b_bf16 v[80:83], v[8:9], v[102:103], 0
    v_mfma_f32_4x4x4_16b_bf16 v[76:79], v[8:9], v[100:101], 0
    v_cmp_lt_u32 s[48:49], v5, v93
    s_nop 2
    v_pk_mul_f32 v[80:81], v[80:81], v[14:15] op_sel:[0,1] op_sel_hi:[1,1]
    v_pk_mul_f32 v[82:83], v[82:83], v[14:15] op_sel:[0,1] op_sel_hi:[1,1]
    v_pk_mul_f32 v[76:77], v[76:77], v[14:15] op_sel:[0,0] op_sel_hi:[1,0]
    v_pk_mul_f32 v[78:79], v[78:79], v[14:15] op_sel:[0,0] op_sel_hi:[1,0]
    s_waitcnt vmcnt(10)
    v_and_b32 v46, 0x20000000, v41
    v_lshrrev_b32 v47, 14, v23
    v_bitop3_b32 v47, v47, v5, v46 bitop3:0xea
    ds_read_b64 v[106:107], v47
    v_and_b32 v99, 0x10000000, v41
    v_lshrrev_b32 v47, 14, v22
    v_bitop3_b32 v47, v47, v5, v99 bitop3:0xea
    ds_read_b64 v[104:105], v47
    s_waitcnt lgkmcnt(2)
    v_cmp_ne_u64 s[50:51], v[72:73], v[68:69]
    v_cmpx_ne_u64 s[54:55], v[74:75], v[70:71]
    s_and_b64 s[82:83], s[54:55], s[80:81]
    s_cbranch_scc1 L2_c69
L2_d69:
    v_mov_b64 v[84:85], v[70:71]
    v_mov_b32 v7, v95
    v_mov_b64 v[86:87], v[74:75]
    s_or_b64 s[80:81], s[80:81], s[54:55]
    s_mov_b64 exec, s[50:51]
    s_and_b64 s[82:83], s[50:51], s[80:81]
    s_cbranch_scc1 L2_c70
L2_d70:
    v_mov_b64 v[84:85], v[68:69]
    v_mov_b32 v7, v94
    v_mov_b64 v[86:87], v[72:73]
    s_mov_b64 exec, -1
    s_or_b64 s[80:81], s[80:81], s[50:51]
    s_and_b64 exec, s[48:49], s[80:81]
    v_mfma_f32_4x4x4_16b_bf16 v[80:83], v[12:13], v[84:85], 0
    v_mov_b32 v93, v7
    s_andn2_b64 s[80:81], s[80:81], s[48:49]
    v_mfma_f32_4x4x4_16b_bf16 v[80:83], v[10:11], v[86:87], v[80:83]
    s_mov_b64 exec, -1
    ds_read_b64 v[70:71], v93 offset:65408
    ds_read_b64 v[68:69], v92 offset:65408
    v_bitop3_b32 v94, v22, v5, v99 bitop3:0xea
    v_bitop3_b32 v95, v23, v5, v46 bitop3:0xea
    v_perm_b32 v15, v23, v26, s45
    v_bitop3_b32 v46, v23, 0.5, -0.5 bitop3:0xa8
    v_perm_b32 v14, v22, v26, s44
    v_bitop3_b32 v47, v22, 0.5, -0.5 bitop3:0xa8
    v_bitop3_b32 v15, v6, v15, v46 bitop3:0xca
    v_bitop3_b32 v14, v6, v14, v47 bitop3:0xca
    s_waitcnt lgkmcnt(1)
    v_mfma_f32_4x4x4_16b_bf16 v[80:83], v[10:11], v[70:71], v[80:83]
    s_waitcnt lgkmcnt(0)
    v_mfma_f32_4x4x4_16b_bf16 v[76:79], v[10:11], v[68:69], v[76:79]
    s_nop 2
    v_cvt_pk_bf16_f32 v80, v80, v81
    v_cvt_pk_bf16_f32 v81, v82, v83
    ds_wrxchg_rtn_b64 v[74:75], v93, v[80:81] offset:65408
    v_cvt_pk_bf16_f32 v76, v76, v77
    v_cvt_pk_bf16_f32 v77, v78, v79
    ds_wrxchg_rtn_b64 v[72:73], v92, v[76:77] offset:65408
    s_setprio 1
    v_mfma_f32_4x4x4_16b_bf16 v[80:83], v[8:9], v[106:107], 0
    v_mfma_f32_4x4x4_16b_bf16 v[76:79], v[8:9], v[104:105], 0
    s_nop 3
    v_pk_mul_f32 v[80:81], v[80:81], v[14:15] op_sel:[0,1] op_sel_hi:[1,1]
    v_pk_mul_f32 v[82:83], v[82:83], v[14:15] op_sel:[0,1] op_sel_hi:[1,1]
    v_pk_mul_f32 v[76:77], v[76:77], v[14:15] op_sel:[0,0] op_sel_hi:[1,0]
    v_pk_mul_f32 v[78:79], v[78:79], v[14:15] op_sel:[0,0] op_sel_hi:[1,0]
    s_bitcmp1_b32 s43, s42
    s_cbranch_scc1 L2_oa71
L2_ob71:
    buffer_load_dwordx4 v[112:115], v3, s[16:19], s40 offen offset:1024 sc1
    v_sub_u16 v88, v58, v50
    v_and_b32 v89, 3, v50
    v_add3_u32 v99, v88, v89, 3
    v_and_b32 v99, -4, v99
    v_max_u32 v99, 4, v99
    v_and_b32 v97, 0xfffc, v50
    v_bfm_b32 v96, v88, v89
    v_add_u32_dpp v91, v99, v99 row_shr:1 row_mask:0xf bank_mask:0xf bound_ctrl:1
    v_mad_u32_u24 v97, v97, 5, v2
    v_cmp_lt_u32 vcc, 16, v99
    v_add_u32_dpp v91, v91, v91 row_shr:2 row_mask:0xf bank_mask:0xf bound_ctrl:1
    v_sub_u32 v98, s38, v99
    v_lshrrev_b64 v[50:51], 16, v[50:51]
    v_add_u32_dpp v91, v91, v91 row_shr:4 row_mask:0xf bank_mask:0xf bound_ctrl:1
    v_lshrrev_b64 v[58:59], 16, v[58:59]
    s_mov_b32 s101, 0
    v_add_u32_dpp v91, v91, v91 row_shr:8 row_mask:0xf bank_mask:0xf bound_ctrl:1
    s_nop 1
    v_add_u32_dpp v91, v91, v91 row_bcast:15 row_mask:0xa bank_mask:0xf
    s_nop 1
    v_add_u32_dpp v91, v91, v91 row_bcast:31 row_mask:0xc bank_mask:0xf
    v_add_u32 v98, v98, v91
    v_readlane_b32 s37, v91, 63
    s_cbranch_vccnz L2_xo72
L2_xp72:
    v_and_b32 v46, 0x80000000, v41
    v_lshrrev_b32 v47, 14, v25
    v_bitop3_b32 v47, v47, v5, v46 bitop3:0xea
    ds_read_b64 v[102:103], v47
    v_and_b32 v99, 0x40000000, v41
    v_lshrrev_b32 v47, 14, v24
    v_bitop3_b32 v47, v47, v5, v99 bitop3:0xea
    ds_read_b64 v[100:101], v47
    s_waitcnt lgkmcnt(2)
    v_cmp_ne_u64 s[50:51], v[72:73], v[68:69]
    v_cmpx_ne_u64 s[54:55], v[74:75], v[70:71]
    s_and_b64 s[82:83], s[54:55], s[80:81]
    s_cbranch_scc1 L2_c73
L2_d73:
    v_mov_b64 v[84:85], v[70:71]
    v_mov_b32 v7, v93
    v_mov_b64 v[86:87], v[74:75]
    s_or_b64 s[80:81], s[80:81], s[54:55]
    s_mov_b64 exec, s[50:51]
    s_and_b64 s[82:83], s[50:51], s[80:81]
    s_cbranch_scc1 L2_c74
L2_d74:
    v_mov_b64 v[84:85], v[68:69]
    v_mov_b32 v7, v92
    v_mov_b64 v[86:87], v[72:73]
    s_mov_b64 exec, -1
    s_or_b64 s[80:81], s[80:81], s[50:51]
    ds_read_b64 v[70:71], v95 offset:65408
    ds_read_b64 v[68:69], v94 offset:65408
    v_bitop3_b32 v92, v24, v5, v99 bitop3:0xea
    v_bitop3_b32 v93, v25, v5, v46 bitop3:0xea
    v_perm_b32 v15, v25, v26, s47
    v_bitop3_b32 v46, v25, 0.5, -0.5 bitop3:0xa8
    v_perm_b32 v14, v24, v26, s46
    v_bitop3_b32 v47, v24, 0.5, -0.5 bitop3:0xa8
    v_bitop3_b32 v15, v6, v15, v46 bitop3:0xca
    v_bitop3_b32 v14, v6, v14, v47 bitop3:0xca
    s_waitcnt lgkmcnt(1)
    v_mfma_f32_4x4x4_16b_bf16 v[80:83], v[10:11], v[70:71], v[80:83]
    s_waitcnt lgkmcnt(0)
    v_mfma_f32_4x4x4_16b_bf16 v[76:79], v[10:11], v[68:69], v[76:79]
    s_nop 2
    v_cvt_pk_bf16_f32 v80, v80, v81
    v_cvt_pk_bf16_f32 v81, v82, v83
    ds_wrxchg_rtn_b64 v[74:75], v95, v[80:81] offset:65408
    v_cvt_pk_bf16_f32 v76, v76, v77
    v_cvt_pk_bf16_f32 v77, v78, v79
    ds_wrxchg_rtn_b64 v[72:73], v94, v[76:77] offset:65408
    v_and_b32 v88, 0x0fffffff, v27
    buffer_load_dwordx2 v[22:23], v88, s[8:11], 0 offen
    buffer_load_dwordx3 v[24:26], v88, s[8:11], 0 offen offset:8
    v_mfma_f32_4x4x4_16b_bf16 v[80:83], v[8:9], v[102:103], 0
    v_mfma_f32_4x4x4_16b_bf16 v[76:79], v[8:9], v[100:101], 0
    v_cmp_lt_u32 s[84:85], v5, v92
    s_nop 2
    v_pk_mul_f32 v[80:81], v[80:81], v[14:15] op_sel:[0,1] op_sel_hi:[1,1]
    v_pk_mul_f32 v[82:83], v[82:83], v[14:15] op_sel:[0,1] op_sel_hi:[1,1]
    v_pk_mul_f32 v[76:77], v[76:77], v[14:15] op_sel:[0,0] op_sel_hi:[1,0]
    v_pk_mul_f32 v[78:79], v[78:79], v[14:15] op_sel:[0,0] op_sel_hi:[1,0]
    s_waitcnt vmcnt(11)
    s_mov_b64 exec, s[6:7]
    v_lshrrev_b32 v30, 16, v30
    s_mov_b64 exec, -1
    v_and_b32 v46, 0x20000000, v42
    v_lshrrev_b32 v47, 14, v29
    v_bitop3_b32 v47, v47, v5, v46 bitop3:0xea
    ds_read_b64 v[106:107], v47
    v_and_b32 v99, 0x10000000, v42
    v_lshrrev_b32 v47, 14, v28
    v_bitop3_b32 v47, v47, v5, v99 bitop3:0xea
    ds_read_b64 v[104:105], v47
    s_waitcnt lgkmcnt(2)
    v_cmp_ne_u64 s[50:51], v[72:73], v[68:69]
    v_cmpx_ne_u64 s[54:55], v[74:75], v[70:71]
    s_and_b64 s[82:83], s[54:55], s[80:81]
    s_cbranch_scc1 L2_c75
L2_d75:
    v_mov_b64 v[84:85], v[70:71]
    v_mov_b32 v7, v95
    v_mov_b64 v[86:87], v[74:75]
    s_or_b64 s[80:81], s[80:81], s[54:55]
    s_mov_b64 exec, s[50:51]
    s_and_b64 s[82:83], s[50:51], s[80:81]
    s_cbranch_scc1 L2_c76
L2_d76:
    v_mov_b64 v[84:85], v[68:69]
    v_mov_b32 v7, v94
    v_mov_b64 v[86:87], v[72:73]
    s_mov_b64 exec, -1
    s_or_b64 s[80:81], s[80:81], s[50:51]
    s_and_b64 exec, s[84:85], s[80:81]
    v_mfma_f32_4x4x4_16b_bf16 v[76:79], v[12:13], v[84:85], 0
    v_mov_b32 v92, v7
    s_andn2_b64 s[80:81], s[80:81], s[84:85]
    v_mfma_f32_4x4x4_16b_bf16 v[76:79], v[10:11], v[86:87], v[76:79]
    s_mov_b64 exec, -1
    ds_read_b64 v[70:71], v93 offset:65408
    ds_read_b64 v[68:69], v92 offset:65408
    v_bitop3_b32 v94, v28, v5, v99 bitop3:0xea
    v_bitop3_b32 v95, v29, v5, v46 bitop3:0xea
    v_perm_b32 v15, v29, v30, s45
    v_bitop3_b32 v46, v29, 0.5, -0.5 bitop3:0xa8
    v_perm_b32 v14, v28, v30, s44
    v_bitop3_b32 v47, v28, 0.5, -0.5 bitop3:0xa8
    v_bitop3_b32 v15, v6, v15, v46 bitop3:0xca
    v_bitop3_b32 v14, v6, v14, v47 bitop3:0xca
    s_waitcnt lgkmcnt(1)
    v_mfma_f32_4x4x4_16b_bf16 v[80:83], v[10:11], v[70:71], v[80:83]
    s_waitcnt lgkmcnt(0)
    v_mfma_f32_4x4x4_16b_bf16 v[76:79], v[10:11], v[68:69], v[76:79]
    s_nop 2
    v_cvt_pk_bf16_f32 v80, v80, v81
    v_cvt_pk_bf16_f32 v81, v82, v83
    ds_wrxchg_rtn_b64 v[74:75], v93, v[80:81] offset:65408
    v_cvt_pk_bf16_f32 v76, v76, v77
    v_cvt_pk_bf16_f32 v77, v78, v79
    ds_wrxchg_rtn_b64 v[72:73], v92, v[76:77] offset:65408
    s_setprio 0
    v_mfma_f32_4x4x4_16b_bf16 v[80:83], v[8:9], v[106:107], 0
    v_mfma_f32_4x4x4_16b_bf16 v[76:79], v[8:9], v[104:105], 0
    v_cmp_lt_u32 s[48:49], v5, v95
    s_nop 2
    v_pk_mul_f32 v[80:81], v[80:81], v[14:15] op_sel:[0,1] op_sel_hi:[1,1]
    v_pk_mul_f32 v[82:83], v[82:83], v[14:15] op_sel:[0,1] op_sel_hi:[1,1]
    v_pk_mul_f32 v[76:77], v[76:77], v[14:15] op_sel:[0,0] op_sel_hi:[1,0]
    v_pk_mul_f32 v[78:79], v[78:79], v[14:15] op_sel:[0,0] op_sel_hi:[1,0]
    s_add_u32 s40, s40, 0x50000
    v_and_b32 v47, 0x0fffffff, v31
    buffer_load_dword v30, v47, s[8:11], 0 offen offset:16
    s_mov_b64 exec, s[6:7]
    v_add_u32 v47, 8, v47
    v_lshrrev_b32 v31, 2, v31
    s_mov_b64 exec, -1
    buffer_load_dwordx2 v[28:29], v47, s[8:11], 0 offen
    s_waitcnt vmcnt(8)
    v_and_b32 v46, 0x80000000, v43
    v_lshrrev_b32 v47, 14, v37
    v_bitop3_b32 v47, v47, v5, v46 bitop3:0xea
    ds_read_b64 v[106:107], v47
    v_and_b32 v99, 0x40000000, v43
    v_lshrrev_b32 v47, 14, v36
    v_bitop3_b32 v47, v47, v5, v99 bitop3:0xea
    ds_read_b64 v[104:105], v47
    v_and_b32 v46, 0x20000000, v43
    v_lshrrev_b32 v47, 14, v35
    v_bitop3_b32 v47, v47, v5, v46 bitop3:0xea
    ds_read_b64 v[102:103], v47
    v_and_b32 v99, 0x10000000, v43
    v_lshrrev_b32 v47, 14, v34
    v_bitop3_b32 v47, v47, v5, v99 bitop3:0xea
    ds_read_b64 v[100:101], v47
    s_waitcnt lgkmcnt(4)
    v_cmp_ne_u64 s[50:51], v[72:73], v[68:69]
    v_cmpx_ne_u64 s[54:55], v[74:75], v[70:71]
    s_and_b64 s[82:83], s[54:55], s[80:81]
    s_cbranch_scc1 L2_c77
L2_d77:
    v_mov_b64 v[84:85], v[70:71]
    v_mov_b32 v7, v93
    v_mov_b64 v[86:87], v[74:75]
    s_or_b64 s[80:81], s[80:81], s[54:55]
    s_mov_b64 exec, s[50:51]
    s_and_b64 s[82:83], s[50:51], s[80:81]
    s_cbranch_scc1 L2_c78
L2_d78:
    v_mov_b64 v[84:85], v[68:69]
    v_mov_b32 v7, v92
    v_mov_b64 v[86:87], v[72:73]
    s_mov_b64 exec, -1
    s_or_b64 s[80:81], s[80:81], s[50:51]
    s_and_b64 exec, s[48:49], s[80:81]
    v_mfma_f32_4x4x4_16b_bf16 v[80:83], v[12:13], v[84:85], 0
    v_mov_b32 v95, v7
    s_andn2_b64 s[80:81], s[80:81], s[48:49]
    v_mfma_f32_4x4x4_16b_bf16 v[80:83], v[10:11], v[86:87], v[80:83]
    s_mov_b64 exec, -1
    ds_read_b64 v[70:71], v95 offset:65408
    ds_read_b64 v[68:69], v94 offset:65408
    v_bitop3_b32 v92, v34, v5, v99 bitop3:0xea
    v_bitop3_b32 v93, v35, v5, v46 bitop3:0xea
    v_perm_b32 v15, v35, v38, s45
    v_bitop3_b32 v46, v35, 0.5, -0.5 bitop3:0xa8
    v_perm_b32 v14, v34, v38, s44
    v_bitop3_b32 v47, v34, 0.5, -0.5 bitop3:0xa8
    v_bitop3_b32 v15, v6, v15, v46 bitop3:0xca
    v_bitop3_b32 v14, v6, v14, v47 bitop3:0xca
    s_waitcnt lgkmcnt(1)
    v_mfma_f32_4x4x4_16b_bf16 v[80:83], v[10:11], v[70:71], v[80:83]
    s_waitcnt lgkmcnt(0)
    v_mfma_f32_4x4x4_16b_bf16 v[76:79], v[10:11], v[68:69], v[76:79]
    s_nop 2
    v_cvt_pk_bf16_f32 v80, v80, v81
    v_cvt_pk_bf16_f32 v81, v82, v83
    ds_wrxchg_rtn_b64 v[74:75], v95, v[80:81] offset:65408
    v_cvt_pk_bf16_f32 v76, v76, v77
    v_cvt_pk_bf16_f32 v77, v78, v79
    ds_wrxchg_rtn_b64 v[72:73], v94, v[76:77] offset:65408
    s_barrier
    s_setprio 3
    s_mov_b32 m0, s100
    s_nop 0
    ds_write_addtid_b32 v124 offset:34816
    ds_write_addtid_b32 v125 offset:35072
    ds_write_addtid_b32 v126 offset:35328
    ds_write_addtid_b32 v127 offset:35584
    s_add_u32 s3, s40, 4096
    buffer_load_dwordx4 v[124:127], v3, s[16:19], s3 offen sc1
    ds_write_addtid_b32 v116 offset:32768
    ds_write_addtid_b32 v117 offset:33024
    ds_write_addtid_b32 v118 offset:33280
    ds_write_addtid_b32 v119 offset:33536
    buffer_load_dwordx4 v[116:119], v3, s[16:19], s40 offen offset:2048 sc1
    ds_write_addtid_b32 v120 offset:33792
    ds_write_addtid_b32 v121 offset:34048
    ds_write_addtid_b32 v122 offset:34304
    ds_write_addtid_b32 v123 offset:34560
    buffer_load_dwordx4 v[120:123], v3, s[16:19], s40 offen offset:3072 sc1
    v_mfma_f32_4x4x4_16b_bf16 v[80:83], v[8:9], v[102:103], 0
    v_mfma_f32_4x4x4_16b_bf16 v[76:79], v[8:9], v[100:101], 0
    s_nop 3
    v_pk_mul_f32 v[80:81], v[80:81], v[14:15] op_sel:[0,1] op_sel_hi:[1,1]
    v_pk_mul_f32 v[82:83], v[82:83], v[14:15] op_sel:[0,1] op_sel_hi:[1,1]
    v_pk_mul_f32 v[76:77], v[76:77], v[14:15] op_sel:[0,0] op_sel_hi:[1,0]
    v_pk_mul_f32 v[78:79], v[78:79], v[14:15] op_sel:[0,0] op_sel_hi:[1,0]
    s_cmp_gt_u32 s37, 1024
    s_cbranch_scc1 L2_xs79
    s_cmp_lg_u32 s101, 0
    s_cbranch_scc1 L2_xa79
L2_xb79:
    v_lshlrev_b32 v89, 16, v96
    v_add_u32 v90, 60, v97
    v_bitop3_b32 v90, v89, v45, v90 bitop3:0x6a
    ds_write_b32 v98, v90 offset:12
    v_lshlrev_b32 v89, 20, v96
    v_add_u32 v90, 40, v97
    v_bitop3_b32 v90, v89, v45, v90 bitop3:0x6a
    ds_write_b32 v98, v90 offset:8
    v_lshlrev_b32 v89, 24, v96
    v_add_u32 v90, 20, v97
    v_bitop3_b32 v90, v89, v45, v90 bitop3:0x6a
    ds_write_b32 v98, v90 offset:4
    v_lshlrev_b32 v89, 28, v96
    v_bitop3_b32 v90, v89, v45, v97 bitop3:0x6a
    ds_write_b32 v98, v90 offset:0
    v_mov_b32_dpp v91, v66 quad_perm:[0,0,0,0] row_mask:0xf bank_mask:0xf
    v_and_b32 v89, 3, v91
    v_and_b32 v97, 0xfffc, v91
    v_sub_u16_dpp v88, v66, v91 quad_perm:[2,2,2,2] row_mask:0xf bank_mask:0xf
    v_mad_u32_u24 v97, v97, 5, v4
    v_add_u32 v99, v88, v89
    v_bfm_b32 v96, v88, v89
    v_cmp_lt_u32 s[58:59], 16, v99
    v_lshlrev_b32 v89, v1, v96
    v_and_b32 v89, v45, v89
    v_cmp_ne_u32 vcc, 0, v89
    v_xor_b32 v90, v97, v89
    s_add_u32 s3, s37, s38
    v_mbcnt_lo_u32_b32 v98, vcc_lo, 0
    v_mbcnt_hi_u32_b32 v98, vcc_hi, v98
    s_bcnt1_i32_b64 s41, vcc
    v_lshl_add_u32 v98, v98, 2, s3
    s_lshl2_add_u32 s37, s41, s37
    s_mov_b64 exec, vcc
    ds_write_b32 v98, v90
    s_mov_b64 exec, -1
    s_cmp_lg_u64 s[58:59], 0
    s_cbranch_scc1 L2_xe79
L2_xr79:
    v_add_u32 v98, s37, v0
    v_mov_b32 v90, -1
    ds_write_b32 v98, v90
L2_xw79:
    s_setprio 2
    s_waitcnt lgkmcnt(14)
    v_cmp_ne_u64 s[50:51], v[72:73], v[68:69]
    v_cmpx_ne_u64 s[54:55], v[74:75], v[70:71]
    s_and_b64 s[82:83], s[54:55], s[80:81]
    s_cbranch_scc1 L2_c80
L2_d80:
    v_mov_b64 v[84:85], v[70:71]
    v_mov_b32 v7, v95
    v_mov_b64 v[86:87], v[74:75]
    s_or_b64 s[80:81], s[80:81], s[54:55]
    s_mov_b64 exec, s[50:51]
    s_and_b64 s[82:83], s[50:51], s[80:81]
    s_cbranch_scc1 L2_c81
L2_d81:
    v_mov_b64 v[84:85], v[68:69]
    v_mov_b32 v7, v94
    v_mov_b64 v[86:87], v[72:73]
    s_mov_b64 exec, -1
    s_or_b64 s[80:81], s[80:81], s[50:51]
    ds_read_b64 v[70:71], v93 offset:65408
    ds_read_b64 v[68:69], v92 offset:65408
    v_and_b32 v46, 0x40000000, v43
    v_bitop3_b32 v94, v36, v5, v46 bitop3:0xea
    v_and_b32 v46, 0x80000000, v43
    v_bitop3_b32 v95, v37, v5, v46 bitop3:0xea
    v_perm_b32 v15, v37, v38, s47
    v_bitop3_b32 v46, v37, 0.5, -0.5 bitop3:0xa8
    v_perm_b32 v14, v36, v38, s46
    v_bitop3_b32 v47, v36, 0.5, -0.5 bitop3:0xa8
    v_bitop3_b32 v15, v6, v15, v46 bitop3:0xca
    v_bitop3_b32 v14, v6, v14, v47 bitop3:0xca
    s_setprio 1
    s_waitcnt lgkmcnt(1)
    v_mfma_f32_4x4x4_16b_bf16 v[80:83], v[10:11], v[70:71], v[80:83]
    s_waitcnt lgkmcnt(0)
    v_mfma_f32_4x4x4_16b_bf16 v[76:79], v[10:11], v[68:69], v[76:79]
    s_nop 2
    v_cvt_pk_bf16_f32 v80, v80, v81
    v_cvt_pk_bf16_f32 v81, v82, v83
    ds_wrxchg_rtn_b64 v[74:75], v93, v[80:81] offset:65408
    v_cvt_pk_bf16_f32 v76, v76, v77
    v_cvt_pk_bf16_f32 v77, v78, v79
    ds_wrxchg_rtn_b64 v[72:73], v92, v[76:77] offset:65408
    ds_read_b32 v40, v0 offset:0
    ds_read_b32 v41, v0 offset:256
    ds_read_b32 v42, v44 offset:768
    ds_read_b32 v43, v0 offset:512
    s_sub_u32 s3, s37, 768
    s_cmp_gt_u32 s3, 128
    s_cbranch_scc1 L2_xf79
L2_xg79:
    v_and_b32 v88, 0x0fffffff, v39
    buffer_load_dwordx2 v[34:35], v88, s[8:11], 0 offen
    buffer_load_dwordx3 v[36:38], v88, s[8:11], 0 offen offset:8
    s_setprio 0
    s_waitcnt vmcnt(12)
    s_mov_b32 m0, s38
    s_nop 0
    ds_write_addtid_b32 v108 offset:0
    ds_write_addtid_b32 v109 offset:256
    ds_write_addtid_b32 v110 offset:512
    ds_write_addtid_b32 v111 offset:768
    s_waitcnt vmcnt(9)
    ds_write_addtid_b32 v112 offset:1024
    ds_write_addtid_b32 v113 offset:1280
    ds_write_addtid_b32 v114 offset:1536
    ds_write_addtid_b32 v115 offset:1792
    v_mfma_f32_4x4x4_16b_bf16 v[80:83], v[8:9], v[106:107], 0
    v_mfma_f32_4x4x4_16b_bf16 v[76:79], v[8:9], v[104:105], 0
    v_cmp_lt_u32 s[84:85], v5, v94
    s_nop 2
    v_pk_mul_f32 v[80:81], v[80:81], v[14:15] op_sel:[0,1] op_sel_hi:[1,1]
    v_pk_mul_f32 v[82:83], v[82:83], v[14:15] op_sel:[0,1] op_sel_hi:[1,1]
    v_pk_mul_f32 v[76:77], v[76:77], v[14:15] op_sel:[0,0] op_sel_hi:[1,0]
    v_pk_mul_f32 v[78:79], v[78:79], v[14:15] op_sel:[0,0] op_sel_hi:[1,0]
    s_add_u32 s42, s42, 1
    s_waitcnt lgkmcnt(0)
    s_barrier
    s_bitcmp1_b32 s36, s42
    s_cbranch_scc1 L2_slow
L2_ret4:
    s_setprio 3
    s_bitcmp1_b32 s43, s42
    s_cbranch_scc1 L2_oa82
L2_ob82:
    v_and_b32 v46, 0x20000000, v21
    v_lshrrev_b32 v47, 14, v17
    v_bitop3_b32 v47, v47, v5, v46 bitop3:0xea
    ds_read_b64 v[102:103], v47
    v_and_b32 v99, 0x10000000, v21
    v_lshrrev_b32 v47, 14, v16
    v_bitop3_b32 v47, v47, v5, v99 bitop3:0xea
    ds_read_b64 v[100:101], v47
    v_cmp_ne_u64 s[50:51], v[72:73], v[68:69]
    v_cmpx_ne_u64 s[54:55], v[74:75], v[70:71]
    s_and_b64 s[82:83], s[54:55], s[80:81]
    s_cbranch_scc1 L2_c83
L2_d83:
    v_mov_b64 v[84:85], v[70:71]
    v_mov_b32 v7, v93
    v_mov_b64 v[86:87], v[74:75]
    s_or_b64 s[80:81], s[80:81], s[54:55]
    s_mov_b64 exec, s[50:51]
    s_and_b64 s[82:83], s[50:51], s[80:81]
    s_cbranch_scc1 L2_c84
L2_d84:
    v_mov_b64 v[84:85], v[68:69]
    v_mov_b32 v7, v92
    v_mov_b64 v[86:87], v[72:73]
    s_mov_b64 exec, -1
    s_or_b64 s[80:81], s[80:81], s[50:51]
    s_and_b64 exec, s[84:85], s[80:81]
    v_mfma_f32_4x4x4_16b_bf16 v[76:79], v[12:13], v[84:85], 0
    v_mov_b32 v94, v7
    s_andn2_b64 s[80:81], s[80:81], s[84:85]
    v_mfma_f32_4x4x4_16b_bf16 v[76:79], v[10:11], v[86:87], v[76:79]
    s_mov_b64 exec, -1
    ds_read_b64 v[70:71], v95 offset:65408
    ds_read_b64 v[68:69], v94 offset:65408
    v_bitop3_b32 v92, v16, v5, v99 bitop3:0xea
    v_bitop3_b32 v93, v17, v5, v46 bitop3:0xea
    v_perm_b32 v15, v17, v20, s45
    v_bitop3_b32 v46, v17, 0.5, -0.5 bitop3:0xa8
    v_perm_b32 v14, v16, v20, s44
    v_bitop3_b32 v47, v16, 0.5, -0.5 bitop3:0xa8
    v_bitop3_b32 v15, v6, v15, v46 bitop3:0xca
    v_bitop3_b32 v14, v6, v14, v47 bitop3:0xca
    s_waitcnt lgkmcnt(1)
    v_mfma_f32_4x4x4_16b_bf16 v[80:83], v[10:11], v[70:71], v[80:83]
    s_waitcnt lgkmcnt(0)
    v_mfma_f32_4x4x4_16b_bf16 v[76:79], v[10:11], v[68:69], v[76:79]
    s_nop 2
    v_cvt_pk_bf16_f32 v80, v80, v81
    v_cvt_pk_bf16_f32 v81, v82, v83
    ds_wrxchg_rtn_b64 v[74:75], v95, v[80:81] offset:65408
    v_cvt_pk_bf16_f32 v76, v76, v77
    v_cvt_pk_bf16_f32 v77, v78, v79
    ds_wrxchg_rtn_b64 v[72:73], v94, v[76:77] offset:65408
    v_mfma_f32_4x4x4_16b_bf16 v[80:83], v[8:9], v[102:103], 0
    v_mfma_f32_4x4x4_16b_bf16 v[76:79], v[8:9], v[100:101], 0
    v_cmp_lt_u32 s[84:85], v5, v92
    s_nop 2
    v_pk_mul_f32 v[80:81], v[80:81], v[14:15] op_sel:[0,1] op_sel_hi:[1,1]
    v_pk_mul_f32 v[82:83], v[82:83], v[14:15] op_sel:[0,1] op_sel_hi:[1,1]
    v_pk_mul_f32 v[76:77], v[76:77], v[14:15] op_sel:[0,0] op_sel_hi:[1,0]
    v_pk_mul_f32 v[78:79], v[78:79], v[14:15] op_sel:[0,0] op_sel_hi:[1,0]
    buffer_load_dwordx4 v[108:111], v3, s[16:19], s40 offen offset:0 sc1
    v_and_b32 v46, 0x80000000, v21
    v_lshrrev_b32 v47, 14, v19
    v_bitop3_b32 v47, v47, v5, v46 bitop3:0xea
    ds_read_b64 v[106:107], v47
    v_and_b32 v99, 0x40000000, v21
    v_lshrrev_b32 v47, 14, v18
    v_bitop3_b32 v47, v47, v5, v99 bitop3:0xea
    ds_read_b64 v[104:105], v47
    s_waitcnt lgkmcnt(2)
    v_cmp_ne_u64 s[50:51], v[72:73], v[68:69]
    v_cmpx_ne_u64 s[54:55], v[74:75], v[70:71]
    s_and_b64 s[82:83], s[54:55], s[80:81]
    s_cbranch_scc1 L2_c85
L2_d85:
    v_mov_b64 v[84:85], v[70:71]
    v_mov_b32 v7, v95
    v_mov_b64 v[86:87], v[74:75]
    s_or_b64 s[80:81], s[80:81], s[54:55]
    s_mov_b64 exec, s[50:51]
    s_and_b64 s[82:83], s[50:51], s[80:81]
    s_cbranch_scc1 L2_c86
L2_d86:
    v_mov_b64 v[84:85], v[68:69]
    v_mov_b32 v7, v94
    v_mov_b64 v[86:87], v[72:73]
    s_mov_b64 exec, -1
    s_or_b64 s[80:81], s[80:81], s[50:51]
    s_and_b64 exec, s[84:85], s[80:81]
    v_mfma_f32_4x4x4_16b_bf16 v[76:79], v[12:13], v[84:85], 0
    v_mov_b32 v92, v7
    s_andn2_b64 s[80:81], s[80:81], s[84:85]
    v_mfma_f32_4x4x4_16b_bf16 v[76:79], v[10:11], v[86:87], v[76:79]
    s_mov_b64 exec, -1
    ds_read_b64 v[70:71], v93 offset:65408
    ds_read_b64 v[68:69], v92 offset:65408
    v_bitop3_b32 v94, v18, v5, v99 bitop3:0xea
    v_bitop3_b32 v95, v19, v5, v46 bitop3:0xea
    v_perm_b32 v15, v19, v20, s47
    v_bitop3_b32 v46, v19, 0.5, -0.5 bitop3:0xa8
    v_perm_b32 v14, v18, v20, s46
    v_bitop3_b32 v47, v18, 0.5, -0.5 bitop3:0xa8
    v_bitop3_b32 v15, v6, v15, v46 bitop3:0xca
    v_bitop3_b32 v14, v6, v14, v47 bitop3:0xca
    s_waitcnt lgkmcnt(1)
    v_mfma_f32_4x4x4_16b_bf16 v[80:83], v[10:11], v[70:71], v[80:83]
    s_waitcnt lgkmcnt(0)
    v_mfma_f32_4x4x4_16b_bf16 v[76:79], v[10:11], v[68:69], v[76:79]
    s_nop 2
    v_cvt_pk_bf16_f32 v80, v80, v81
    v_cvt_pk_bf16_f32 v81, v82, v83
    ds_wrxchg_rtn_b64 v[74:75], v93, v[80:81] offset:65408
    v_cvt_pk_bf16_f32 v76, v76, v77
    v_cvt_pk_bf16_f32 v77, v78, v79
    ds_wrxchg_rtn_b64 v[72:73], v92, v[76:77] offset:65408
    v_and_b32 v88, 0x0fffffff, v40
    buffer_load_dwordx2 v[16:17], v88, s[8:11], 0 offen
    buffer_load_dwordx3 v[18:20], v88, s[8:11], 0 offen offset:8
    s_setprio 2
    v_mfma_f32_4x4x4_16b_bf16 v[80:83], v[8:9], v[106:107], 0
    v_mfma_f32_4x4x4_16b_bf16 v[76:79], v[8:9], v[104:105], 0
    v_cmp_lt_u32 s[48:49], v5, v95
    s_nop 2
    v_pk_mul_f32 v[80:81], v[80:81], v[14:15] op_sel:[0,1] op_sel_hi:[1,1]
    v_pk_mul_f32 v[82:83], v[82:83], v[14:15] op_sel:[0,1] op_sel_hi:[1,1]
    v_pk_mul_f32 v[76:77], v[76:77], v[14:15] op_sel:[0,0] op_sel_hi:[1,0]
    v_pk_mul_f32 v[78:79], v[78:79], v[14:15] op_sel:[0,0] op_sel_hi:[1,0]
    s_waitcnt vmcnt(10)
    v_and_b32 v46, 0x20000000, v27
    v_lshrrev_b32 v47, 14, v23
    v_bitop3_b32 v47, v47, v5, v46 bitop3:0xea
    ds_read_b64 v[102:103], v47
    v_and_b32 v99, 0x10000000, v27
    v_lshrrev_b32 v47, 14, v22
    v_bitop3_b32 v47, v47, v5, v99 bitop3:0xea
    ds_read_b64 v[100:101], v47
    s_waitcnt lgkmcnt(2)
    v_cmp_ne_u64 s[50:51], v[72:73], v[68:69]
    v_cmpx_ne_u64 s[54:55], v[74:75], v[70:71]
    s_and_b64 s[82:83], s[54:55], s[80:81]
    s_cbranch_scc1 L2_c87
L2_d87:
    v_mov_b64 v[84:85], v[70:71]
    v_mov_b32 v7, v93
    v_mov_b64 v[86:87], v[74:75]
    s_or_b64 s[80:81], s[80:81], s[54:55]
    s_mov_b64 exec, s[50:51]
    s_and_b64 s[82:83], s[50:51], s[80:81]
    s_cbranch_scc1 L2_c88
L2_d88:
    v_mov_b64 v[84:85], v[68:69]
    v_mov_b32 v7, v92
    v_mov_b64 v[86:87], v[72:73]
    s_mov_b64 exec, -1
    s_or_b64 s[80:81], s[80:81], s[50:51]
    s_and_b64 exec, s[48:49], s[80:81]
    v_mfma_f32_4x4x4_16b_bf16 v[80:83], v[12:13], v[84:85], 0
    v_mov_b32 v95, v7
    s_andn2_b64 s[80:81], s[80:81], s[48:49]
    v_mfma_f32_4x4x4_16b_bf16 v[80:83], v[10:11], v[86:87], v[80:83]
    s_mov_b64 exec, -1
    ds_read_b64 v[70:71], v95 offset:65408
    ds_read_b64 v[68:69], v94 offset:65408
    v_bitop3_b32 v92, v22, v5, v99 bitop3:0xea
    v_bitop3_b32 v93, v23, v5, v46 bitop3:0xea
    v_perm_b32 v15, v23, v26, s45
    v_bitop3_b32 v46, v23, 0.5, -0.5 bitop3:0xa8
    v_perm_b32 v14, v22, v26, s44
    v_bitop3_b32 v47, v22, 0.5, -0.5 bitop3:0xa8
    v_bitop3_b32 v15, v6, v15, v46 bitop3:0xca
    v_bitop3_b32 v14, v6, v14, v47 bitop3:0xca
    s_waitcnt lgkmcnt(1)
    v_mfma_f32_4x4x4_16b_bf16 v[80:83], v[10:11], v[70:71], v[80:83]
    s_waitcnt lgkmcnt(0)
    v_mfma_f32_4x4x4_16b_bf16 v[76:79], v[10:11], v[68:69], v[76:79]
    s_nop 2
    v_cvt_pk_bf16_f32 v80, v80, v81
    v_cvt_pk_bf16_f32 v81, v82, v83
    ds_wrxchg_rtn_b64 v[74:75], v95, v[80:81] offset:65408
    v_cvt_pk_bf16_f32 v76, v76, v77
    v_cvt_pk_bf16_f32 v77, v78, v79
    ds_wrxchg_rtn_b64 v[72:73], v94, v[76:77] offset:65408
    s_setprio 1
    v_mfma_f32_4x4x4_16b_bf16 v[80:83], v[8:9], v[102:103], 0
    v_mfma_f32_4x4x4_16b_bf16 v[76:79], v[8:9], v[100:101], 0
    s_nop 3
    v_pk_mul_f32 v[80:81], v[80:81], v[14:15] op_sel:[0,1] op_sel_hi:[1,1]
    v_pk_mul_f32 v[82:83], v[82:83], v[14:15] op_sel:[0,1] op_sel_hi:[1,1]
    v_pk_mul_f32 v[76:77], v[76:77], v[14:15] op_sel:[0,0] op_sel_hi:[1,0]
    v_pk_mul_f32 v[78:79], v[78:79], v[14:15] op_sel:[0,0] op_sel_hi:[1,0]
    s_bitcmp1_b32 s43, s42
    s_cbranch_scc1 L2_oa89
L2_ob89:
    buffer_load_dwordx4 v[112:115], v3, s[16:19], s40 offen offset:1024 sc1
    v_sub_u16 v88, v60, v52
    v_and_b32 v89, 3, v52
    v_add3_u32 v99, v88, v89, 3
    v_and_b32 v99, -4, v99
    v_max_u32 v99, 4, v99
    v_and_b32 v97, 0xfffc, v52
    v_bfm_b32 v96, v88, v89
    v_add_u32_dpp v91, v99, v99 row_shr:1 row_mask:0xf bank_mask:0xf bound_ctrl:1
    v_mad_u32_u24 v97, v97, 5, v2
    v_cmp_lt_u32 vcc, 16, v99
    v_add_u32_dpp v91, v91, v91 row_shr:2 row_mask:0xf bank_mask:0xf bound_ctrl:1
    v_sub_u32 v98, s38, v99
    v_lshrrev_b64 v[52:53], 16, v[52:53]
    v_add_u32_dpp v91, v91, v91 row_shr:4 row_mask:0xf bank_mask:0xf bound_ctrl:1
    v_lshrrev_b64 v[60:61], 16, v[60:61]
    s_mov_b32 s101, 0
    v_add_u32_dpp v91, v91, v91 row_shr:8 row_mask:0xf bank_mask:0xf bound_ctrl:1
    s_nop 1
    v_add_u32_dpp v91, v91, v91 row_bcast:15 row_mask:0xa bank_mask:0xf
    s_nop 1
    v_add_u32_dpp v91, v91, v91 row_bcast:31 row_mask:0xc bank_mask:0xf
    v_add_u32 v98, v98, v91
    v_readlane_b32 s37, v91, 63
    s_cbranch_vccnz L2_xo90
L2_xp90:
    v_and_b32 v46, 0x80000000, v27
    v_lshrrev_b32 v47, 14, v25
    v_bitop3_b32 v47, v47, v5, v46 bitop3:0xea
    ds_read_b64 v[106:107], v47
    v_and_b32 v99, 0x40000000, v27
    v_lshrrev_b32 v47, 14, v24
    v_bitop3_b32 v47, v47, v5, v99 bitop3:0xea
    ds_read_b64 v[104:105], v47
    s_waitcnt lgkmcnt(2)
    v_cmp_ne_u64 s[50:51], v[72:73], v[68:69]
    v_cmpx_ne_u64 s[54:55], v[74:75], v[70:71]
    s_and_b64 s[82:83], s[54:55], s[80:81]
    s_cbranch_scc1 L2_c91
L2_d91:
    v_mov_b64 v[84:85], v[70:71]
    v_mov_b32 v7, v95
    v_mov_b64 v[86:87], v[74:75]
    s_or_b64 s[80:81], s[80:81], s[54:55]
    s_mov_b64 exec, s[50:51]
    s_and_b64 s[82:83], s[50:51], s[80:81]
    s_cbranch_scc1 L2_c92
L2_d92:
    v_mov_b64 v[84:85], v[68:69]
    v_mov_b32 v7, v94
    v_mov_b64 v[86:87], v[72:73]
    s_mov_b64 exec, -1
    s_or_b64 s[80:81], s[80:81], s[50:51]
    ds_read_b64 v[70:71], v93 offset:65408
    ds_read_b64 v[68:69], v92 offset:65408
    v_bitop3_b32 v94, v24, v5, v99 bitop3:0xea
    v_bitop3_b32 v95, v25, v5, v46 bitop3:0xea
    v_perm_b32 v15, v25, v26, s47
    v_bitop3_b32 v46, v25, 0.5, -0.5 bitop3:0xa8
    v_perm_b32 v14, v24, v26, s46
    v_bitop3_b32 v47, v24, 0.5, -0.5 bitop3:0xa8
    v_bitop3_b32 v15, v6, v15, v46 bitop3:0xca
    v_bitop3_b32 v14, v6, v14, v47 bitop3:0xca
    s_waitcnt lgkmcnt(1)
    v_mfma_f32_4x4x4_16b_bf16 v[80:83], v[10:11], v[70:71], v[80:83]
    s_waitcnt lgkmcnt(0)
    v_mfma_f32_4x4x4_16b_bf16 v[76:79], v[10:11], v[68:69], v[76:79]
    s_nop 2
    v_cvt_pk_bf16_f32 v80, v80, v81
    v_cvt_pk_bf16_f32 v81, v82, v83
    ds_wrxchg_rtn_b64 v[74:75], v93, v[80:81] offset:65408
    v_cvt_pk_bf16_f32 v76, v76, v77
    v_cvt_pk_bf16_f32 v77, v78, v79
    ds_wrxchg_rtn_b64 v[72:73], v92, v[76:77] offset:65408
    v_and_b32 v88, 0x0fffffff, v41
    buffer_load_dwordx2 v[22:23], v88, s[8:11], 0 offen
    buffer_load_dwordx3 v[24:26], v88, s[8:11], 0 offen offset:8
    v_mfma_f32_4x4x4_16b_bf16 v[80:83], v[8:9], v[106:107], 0
    v_mfma_f32_4x4x4_16b_bf16 v[76:79], v[8:9], v[104:105], 0
    v_cmp_lt_u32 s[84:85], v5, v94
    s_nop 2
    v_pk_mul_f32 v[80:81], v[80:81], v[14:15] op_sel:[0,1] op_sel_hi:[1,1]
    v_pk_mul_f32 v[82:83], v[82:83], v[14:15] op_sel:[0,1] op_sel_hi:[1,1]
    v_pk_mul_f32 v[76:77], v[76:77], v[14:15] op_sel:[0,0] op_sel_hi:[1,0]
    v_pk_mul_f32 v[78:79], v[78:79], v[14:15] op_sel:[0,0] op_sel_hi:[1,0]
    s_waitcnt vmcnt(11)
    s_mov_b64 exec, s[6:7]
    v_lshrrev_b32 v30, 16, v30
    s_mov_b64 exec, -1
    v_and_b32 v46, 0x20000000, v31
    v_lshrrev_b32 v47, 14, v29
    v_bitop3_b32 v47, v47, v5, v46 bitop3:0xea
    ds_read_b64 v[102:103], v47
    v_and_b32 v99, 0x10000000, v31
    v_lshrrev_b32 v47, 14, v28
    v_bitop3_b32 v47, v47, v5, v99 bitop3:0xea
    ds_read_b64 v[100:101], v47
    s_waitcnt lgkmcnt(2)
    v_cmp_ne_u64 s[50:51], v[72:73], v[68:69]
    v_cmpx_ne_u64 s[54:55], v[74:75], v[70:71]
    s_and_b64 s[82:83], s[54:55], s[80:81]
    s_cbranch_scc1 L2_c93
L2_d93:
    v_mov_b64 v[84:85], v[70:71]
    v_mov_b32 v7, v93
    v_mov_b64 v[86:87], v[74:75]
    s_or_b64 s[80:81], s[80:81], s[54:55]
    s_mov_b64 exec, s[50:51]
    s_and_b64 s[82:83], s[50:51], s[80:81]
    s_cbranch_scc1 L2_c94
L2_d94:
    v_mov_b64 v[84:85], v[68:69]
    v_mov_b32 v7, v92
    v_mov_b64 v[86:87], v[72:73]
    s_mov_b64 exec, -1
    s_or_b64 s[80:81], s[80:81], s[50:51]
    s_and_b64 exec, s[84:85], s[80:81]
    v_mfma_f32_4x4x4_16b_bf16 v[76:79], v[12:13], v[84:85], 0
    v_mov_b32 v94, v7
    s_andn2_b64 s[80:81], s[80:81], s[84:85]
    v_mfma_f32_4x4x4_16b_bf16 v[76:79], v[10:11], v[86:87], v[76:79]
    s_mov_b64 exec, -1
    ds_read_b64 v[70:71], v95 offset:65408
    ds_read_b64 v[68:69], v94 offset:65408
    v_bitop3_b32 v92, v28, v5, v99 bitop3:0xea
    v_bitop3_b32 v93, v29, v5, v46 bitop3:0xea
    v_perm_b32 v15, v29, v30, s45
    v_bitop3_b32 v46, v29, 0.5, -0.5 bitop3:0xa8
    v_perm_b32 v14, v28, v30, s44
    v_bitop3_b32 v47, v28, 0.5, -0.5 bitop3:0xa8
    v_bitop3_b32 v15, v6, v15, v46 bitop3:0xca
    v_bitop3_b32 v14, v6, v14, v47 bitop3:0xca
    s_waitcnt lgkmcnt(1)
    v_mfma_f32_4x4x4_16b_bf16 v[80:83], v[10:11], v[70:71], v[80:83]
    s_waitcnt lgkmcnt(0)
    v_mfma_f32_4x4x4_16b_bf16 v[76:79], v[10:11], v[68:69], v[76:79]
    s_nop 2
    v_cvt_pk_bf16_f32 v80, v80, v81
    v_cvt_pk_bf16_f32 v81, v82, v83
    ds_wrxchg_rtn_b64 v[74:75], v95, v[80:81] offset:65408
    v_cvt_pk_bf16_f32 v76, v76, v77
    v_cvt_pk_bf16_f32 v77, v78, v79
    ds_wrxchg_rtn_b64 v[72:73], v94, v[76:77] offset:65408
    s_setprio 0
    v_mfma_f32_4x4x4_16b_bf16 v[80:83], v[8:9], v[102:103], 0
    v_mfma_f32_4x4x4_16b_bf16 v[76:79], v[8:9], v[100:101], 0
    v_cmp_lt_u32 s[48:49], v5, v93
    s_nop 2
    v_pk_mul_f32 v[80:81], v[80:81], v[14:15] op_sel:[0,1] op_sel_hi:[1,1]
    v_pk_mul_f32 v[82:83], v[82:83], v[14:15] op_sel:[0,1] op_sel_hi:[1,1]
    v_pk_mul_f32 v[76:77], v[76:77], v[14:15] op_sel:[0,0] op_sel_hi:[1,0]
    v_pk_mul_f32 v[78:79], v[78:79], v[14:15] op_sel:[0,0] op_sel_hi:[1,0]
    s_add_u32 s40, s40, 0x50000
    v_and_b32 v47, 0x0fffffff, v42
    buffer_load_dword v30, v47, s[8:11], 0 offen offset:16
    s_mov_b64 exec, s[6:7]
    v_add_u32 v47, 8, v47
    v_lshrrev_b32 v42, 2, v42
    s_mov_b64 exec, -1
    buffer_load_dwordx2 v[28:29], v47, s[8:11], 0 offen
    s_waitcnt vmcnt(8)
    v_and_b32 v46, 0x80000000, v39
    v_lshrrev_b32 v47, 14, v37
    v_bitop3_b32 v47, v47, v5, v46 bitop3:0xea
    ds_read_b64 v[102:103], v47
    v_and_b32 v99, 0x40000000, v39
    v_lshrrev_b32 v47, 14, v36
    v_bitop3_b32 v47, v47, v5, v99 bitop3:0xea
    ds_read_b64 v[100:101], v47
    v_and_b32 v46, 0x20000000, v39
    v_lshrrev_b32 v47, 14, v35
    v_bitop3_b32 v47, v47, v5, v46 bitop3:0xea
    ds_read_b64 v[106:107], v47
    v_and_b32 v99, 0x10000000, v39
    v_lshrrev_b32 v47, 14, v34
    v_bitop3_b32 v47, v47, v5, v99 bitop3:0xea
    ds_read_b64 v[104:105], v47
    s_waitcnt lgkmcnt(4)
    v_cmp_ne_u64 s[50:51], v[72:73], v[68:69]
    v_cmpx_ne_u64 s[54:55], v[74:75], v[70:71]
    s_and_b64 s[82:83], s[54:55], s[80:81]
    s_cbranch_scc1 L2_c95
L2_d95:
    v_mov_b64 v[84:85], v[70:71]
    v_mov_b32 v7, v95
    v_mov_b64 v[86:87], v[74:75]
    s_or_b64 s[80:81], s[80:81], s[54:55]
    s_mov_b64 exec, s[50:51]
    s_and_b64 s[82:83], s[50:51], s[80:81]
    s_cbranch_scc1 L2_c96
L2_d96:
    v_mov_b64 v[84:85], v[68:69]
    v_mov_b32 v7, v94
    v_mov_b64 v[86:87], v[72:73]
    s_mov_b64 exec, -1
    s_or_b64 s[80:81], s[80:81], s[50:51]
    s_and_b64 exec, s[48:49], s[80:81]
    v_mfma_f32_4x4x4_16b_bf16 v[80:83], v[12:13], v[84:85], 0
    v_mov_b32 v93, v7
    s_andn2_b64 s[80:81], s[80:81], s[48:49]
    v_mfma_f32_4x4x4_16b_bf16 v[80:83], v[10:11], v[86:87], v[80:83]
    s_mov_b64 exec, -1
    ds_read_b64 v[70:71], v93 offset:65408
    ds_read_b64 v[68:69], v92 offset:65408
    v_bitop3_b32 v94, v34, v5, v99 bitop3:0xea
    v_bitop3_b32 v95, v35, v5, v46 bitop3:0xea
    v_perm_b32 v15, v35, v38, s45
    v_bitop3_b32 v46, v35, 0.5, -0.5 bitop3:0xa8
    v_perm_b32 v14, v34, v38, s44
    v_bitop3_b32 v47, v34, 0.5, -0.5 bitop3:0xa8
    v_bitop3_b32 v15, v6, v15, v46 bitop3:0xca
    v_bitop3_b32 v14, v6, v14, v47 bitop3:0xca
    s_waitcnt lgkmcnt(1)
    v_mfma_f32_4x4x4_16b_bf16 v[80:83], v[10:11], v[70:71], v[80:83]
    s_waitcnt lgkmcnt(0)
    v_mfma_f32_4x4x4_16b_bf16 v[76:79], v[10:11], v[68:69], v[76:79]
    s_nop 2
    v_cvt_pk_bf16_f32 v80, v80, v81
    v_cvt_pk_bf16_f32 v81, v82, v83
    ds_wrxchg_rtn_b64 v[74:75], v93, v[80:81] offset:65408
    v_cvt_pk_bf16_f32 v76, v76, v77
    v_cvt_pk_bf16_f32 v77, v78, v79
    ds_wrxchg_rtn_b64 v[72:73], v92, v[76:77] offset:65408
    s_barrier
    s_setprio 3
    s_mov_b32 m0, s100
    s_nop 0
    ds_write_addtid_b32 v124 offset:34816
    ds_write_addtid_b32 v125 offset:35072
    ds_write_addtid_b32 v126 offset:35328
    ds_write_addtid_b32 v127 offset:35584
    s_add_u32 s3, s40, 4096
    buffer_load_dwordx4 v[124:127], v3, s[16:19], s3 offen sc1
    ds_write_addtid_b32 v116 offset:32768
    ds_write_addtid_b32 v117 offset:33024
    ds_write_addtid_b32 v118 offset:33280
    ds_write_addtid_b32 v119 offset:33536
    buffer_load_dwordx4 v[116:119], v3, s[16:19], s40 offen offset:2048 sc1
    ds_write_addtid_b32 v120 offset:33792
    ds_write_addtid_b32 v121 offset:34048
    ds_write_addtid_b32 v122 offset:34304
    ds_write_addtid_b32 v123 offset:34560
    buffer_load_dwordx4 v[120:123], v3, s[16:19], s40 offen offset:3072 sc1
    v_mfma_f32_4x4x4_16b_bf16 v[80:83], v[8:9], v[106:107], 0
    v_mfma_f32_4x4x4_16b_bf16 v[76:79], v[8:9], v[104:105], 0
    s_nop 3
    v_pk_mul_f32 v[80:81], v[80:81], v[14:15] op_sel:[0,1] op_sel_hi:[1,1]
    v_pk_mul_f32 v[82:83], v[82:83], v[14:15] op_sel:[0,1] op_sel_hi:[1,1]
    v_pk_mul_f32 v[76:77], v[76:77], v[14:15] op_sel:[0,0] op_sel_hi:[1,0]
    v_pk_mul_f32 v[78:79], v[78:79], v[14:15] op_sel:[0,0] op_sel_hi:[1,0]
    s_cmp_gt_u32 s37, 1024
    s_cbranch_scc1 L2_xs97
    s_cmp_lg_u32 s101, 0
    s_cbranch_scc1 L2_xa97
L2_xb97:
    v_lshlrev_b32 v89, 16, v96
    v_add_u32 v90, 60, v97
    v_bitop3_b32 v90, v89, v45, v90 bitop3:0x6a
    ds_write_b32 v98, v90 offset:12
    v_lshlrev_b32 v89, 20, v96
    v_add_u32 v90, 40, v97
    v_bitop3_b32 v90, v89, v45, v90 bitop3:0x6a
    ds_write_b32 v98, v90 offset:8
    v_lshlrev_b32 v89, 24, v96
    v_add_u32 v90, 20, v97
    v_bitop3_b32 v90, v89, v45, v90 bitop3:0x6a
    ds_write_b32 v98, v90 offset:4
    v_lshlrev_b32 v89, 28, v96
    v_bitop3_b32 v90, v89, v45, v97 bitop3:0x6a
    ds_write_b32 v98, v90 offset:0
    v_mov_b32_dpp v91, v64 quad_perm:[1,1,1,1] row_mask:0xf bank_mask:0xf
    v_and_b32 v89, 3, v91
    v_and_b32 v97, 0xfffc, v91
    v_sub_u16_dpp v88, v64, v91 quad_perm:[3,3,3,3] row_mask:0xf bank_mask:0xf
    v_mad_u32_u24 v97, v97, 5, v4
    v_add_u32 v99, v88, v89
    v_bfm_b32 v96, v88, v89
    v_cmp_lt_u32 s[58:59], 16, v99
    v_lshlrev_b32 v89, v1, v96
    v_and_b32 v89, v45, v89
    v_cmp_ne_u32 vcc, 0, v89
    v_xor_b32 v90, v97, v89
    s_add_u32 s3, s37, s38
    v_mbcnt_lo_u32_b32 v98, vcc_lo, 0
    v_mbcnt_hi_u32_b32 v98, vcc_hi, v98
    s_bcnt1_i32_b64 s41, vcc
    v_lshl_add_u32 v98, v98, 2, s3
    s_lshl2_add_u32 s37, s41, s37
    s_mov_b64 exec, vcc
    ds_write_b32 v98, v90
    s_mov_b64 exec, -1
    s_cmp_lg_u64 s[58:59], 0
    s_cbranch_scc1 L2_xe97
L2_xr97:
    v_add_u32 v98, s37, v0
    v_mov_b32 v90, -1
    ds_write_b32 v98, v90
L2_xw97:
    s_setprio 2
    s_waitcnt lgkmcnt(14)
    v_cmp_ne_u64 s[50:51], v[72:73], v[68:69]
    v_cmpx_ne_u64 s[54:55], v[74:75], v[70:71]
    s_and_b64 s[82:83], s[54:55], s[80:81]
    s_cbranch_scc1 L2_c98
L2_d98:
    v_mov_b64 v[84:85], v[70:71]
    v_mov_b32 v7, v93
    v_mov_b64 v[86:87], v[74:75]
    s_or_b64 s[80:81], s[80:81], s[54:55]
    s_mov_b64 exec, s[50:51]
    s_and_b64 s[82:83], s[50:51], s[80:81]
    s_cbranch_scc1 L2_c99
L2_d99:
    v_mov_b64 v[84:85], v[68:69]
    v_mov_b32 v7, v92
    v_mov_b64 v[86:87], v[72:73]
    s_mov_b64 exec, -1
    s_or_b64 s[80:81], s[80:81], s[50:51]
    ds_read_b64 v[70:71], v95 offset:65408
    ds_read_b64 v[68:69], v94 offset:65408
    v_and_b32 v46, 0x40000000, v39
    v_bitop3_b32 v92, v36, v5, v46 bitop3:0xea
    v_and_b32 v46, 0x80000000, v39
    v_bitop3_b32 v93, v37, v5, v46 bitop3:0xea
    v_perm_b32 v15, v37, v38, s47
    v_bitop3_b32 v46, v37, 0.5, -0.5 bitop3:0xa8
    v_perm_b32 v14, v36, v38, s46
    v_bitop3_b32 v47, v36, 0.5, -0.5 bitop3:0xa8
    v_bitop3_b32 v15, v6, v15, v46 bitop3:0xca
    v_bitop3_b32 v14, v6, v14, v47 bitop3:0xca
    s_setprio 1
    s_waitcnt lgkmcnt(1)
    v_mfma_f32_4x4x4_16b_bf16 v[80:83], v[10:11], v[70:71], v[80:83]
    s_waitcnt lgkmcnt(0)
    v_mfma_f32_4x4x4_16b_bf16 v[76:79], v[10:11], v[68:69], v[76:79]
    s_nop 2
    v_cvt_pk_bf16_f32 v80, v80, v81
    v_cvt_pk_bf16_f32 v81, v82, v83
    ds_wrxchg_rtn_b64 v[74:75], v95, v[80:81] offset:65408
    v_cvt_pk_bf16_f32 v76, v76, v77
    v_cvt_pk_bf16_f32 v77, v78, v79
    ds_wrxchg_rtn_b64 v[72:73], v94, v[76:77] offset:65408
    ds_read_b32 v21, v0 offset:0
    ds_read_b32 v27, v0 offset:256
    ds_read_b32 v31, v44 offset:768
    ds_read_b32 v39, v0 offset:512
    s_sub_u32 s3, s37, 768
    s_cmp_gt_u32 s3, 128
    s_cbranch_scc1 L2_xf97
L2_xg97:
    v_and_b32 v88, 0x0fffffff, v43
    buffer_load_dwordx2 v[34:35], v88, s[8:11], 0 offen
    buffer_load_dwordx3 v[36:38], v88, s[8:11], 0 offen offset:8
    s_setprio 0
    s_waitcnt vmcnt(12)
    s_mov_b32 m0, s38
    s_nop 0
    ds_write_addtid_b32 v108 offset:0
    ds_write_addtid_b32 v109 offset:256
    ds_write_addtid_b32 v110 offset:512
    ds_write_addtid_b32 v111 offset:768
    s_waitcnt vmcnt(9)
    ds_write_addtid_b32 v112 offset:1024
    ds_write_addtid_b32 v113 offset:1280
    ds_write_addtid_b32 v114 offset:1536
    ds_write_addtid_b32 v115 offset:1792
    v_mfma_f32_4x4x4_16b_bf16 v[80:83], v[8:9], v[102:103], 0
    v_mfma_f32_4x4x4_16b_bf16 v[76:79], v[8:9], v[100:101], 0
    v_cmp_lt_u32 s[84:85], v5, v92
    s_nop 2
    v_pk_mul_f32 v[80:81], v[80:81], v[14:15] op_sel:[0,1] op_sel_hi:[1,1]
    v_pk_mul_f32 v[82:83], v[82:83], v[14:15] op_sel:[0,1] op_sel_hi:[1,1]
    v_pk_mul_f32 v[76:77], v[76:77], v[14:15] op_sel:[0,0] op_sel_hi:[1,0]
    v_pk_mul_f32 v[78:79], v[78:79], v[14:15] op_sel:[0,0] op_sel_hi:[1,0]
    s_add_u32 s42, s42, 1
    s_waitcnt lgkmcnt(0)
    s_barrier
    s_bitcmp1_b32 s36, s42
    s_cbranch_scc1 L2_slow
L2_ret5:
    s_setprio 3
    s_bitcmp1_b32 s43, s42
    s_cbranch_scc1 L2_oa100
L2_ob100:
    v_and_b32 v46, 0x20000000, v40
    v_lshrrev_b32 v47, 14, v17
    v_bitop3_b32 v47, v47, v5, v46 bitop3:0xea
    ds_read_b64 v[106:107], v47
    v_and_b32 v99, 0x10000000, v40
    v_lshrrev_b32 v47, 14, v16
    v_bitop3_b32 v47, v47, v5, v99 bitop3:0xea
    ds_read_b64 v[104:105], v47
    v_cmp_ne_u64 s[50:51], v[72:73], v[68:69]
    v_cmpx_ne_u64 s[54:55], v[74:75], v[70:71]
    s_and_b64 s[82:83], s[54:55], s[80:81]
    s_cbranch_scc1 L2_c101
L2_d101:
    v_mov_b64 v[84:85], v[70:71]
    v_mov_b32 v7, v95
    v_mov_b64 v[86:87], v[74:75]
    s_or_b64 s[80:81], s[80:81], s[54:55]
    s_mov_b64 exec, s[50:51]
    s_and_b64 s[82:83], s[50:51], s[80:81]
    s_cbranch_scc1 L2_c102
L2_d102:
    v_mov_b64 v[84:85], v[68:69]
    v_mov_b32 v7, v94
    v_mov_b64 v[86:87], v[72:73]
    s_mov_b64 exec, -1
    s_or_b64 s[80:81], s[80:81], s[50:51]
    s_and_b64 exec, s[84:85], s[80:81]
    v_mfma_f32_4x4x4_16b_bf16 v[76:79], v[12:13], v[84:85], 0
    v_mov_b32 v92, v7
    s_andn2_b64 s[80:81], s[80:81], s[84:85]
    v_mfma_f32_4x4x4_16b_bf16 v[76:79], v[10:11], v[86:87], v[76:79]
    s_mov_b64 exec, -1
    ds_read_b64 v[70:71], v93 offset:65408
    ds_read_b64 v[68:69], v92 offset:65408
    v_bitop3_b32 v94, v16, v5, v99 bitop3:0xea
    v_bitop3_b32 v95, v17, v5, v46 bitop3:0xea
    v_perm_b32 v15, v17, v20, s45
    v_bitop3_b32 v46, v17, 0.5, -0.5 bitop3:0xa8
    v_perm_b32 v14, v16, v20, s44
    v_bitop3_b32 v47, v16, 0.5, -0.5 bitop3:0xa8
    v_bitop3_b32 v15, v6, v15, v46 bitop3:0xca
    v_bitop3_b32 v14, v6, v14, v47 bitop3:0xca
    s_waitcnt lgkmcnt(1)
    v_mfma_f32_4x4x4_16b_bf16 v[80:83], v[10:11], v[70:71], v[80:83]
    s_waitcnt lgkmcnt(0)
    v_mfma_f32_4x4x4_16b_bf16 v[76:79], v[10:11], v[68:69], v[76:79]
    s_nop 2
    v_cvt_pk_bf16_f32 v80, v80, v81
    v_cvt_pk_bf16_f32 v81, v82, v83
    ds_wrxchg_rtn_b64 v[74:75], v93, v[80:81] offset:65408
    v_cvt_pk_bf16_f32 v76, v76, v77
    v_cvt_pk_bf16_f32 v77, v78, v79
    ds_wrxchg_rtn_b64 v[72:73], v92, v[76:77] offset:65408
    v_mfma_f32_4x4x4_16b_bf16 v[80:83], v[8:9], v[106:107], 0
    v_mfma_f32_4x4x4_16b_bf16 v[76:79], v[8:9], v[104:105], 0
    v_cmp_lt_u32 s[84:85], v5, v94
    s_nop 2
    v_pk_mul_f32 v[80:81], v[80:81], v[14:15] op_sel:[0,1] op_sel_hi:[1,1]
    v_pk_mul_f32 v[82:83], v[82:83], v[14:15] op_sel:[0,1] op_sel_hi:[1,1]
    v_pk_mul_f32 v[76:77], v[76:77], v[14:15] op_sel:[0,0] op_sel_hi:[1,0]
    v_pk_mul_f32 v[78:79], v[78:79], v[14:15] op_sel:[0,0] op_sel_hi:[1,0]
    buffer_load_dwordx4 v[108:111], v3, s[16:19], s40 offen offset:0 sc1
    v_and_b32 v46, 0x80000000, v40
    v_lshrrev_b32 v47, 14, v19
    v_bitop3_b32 v47, v47, v5, v46 bitop3:0xea
    ds_read_b64 v[102:103], v47
    v_and_b32 v99, 0x40000000, v40
    v_lshrrev_b32 v47, 14, v18
    v_bitop3_b32 v47, v47, v5, v99 bitop3:0xea
    ds_read_b64 v[100:101], v47
    s_waitcnt lgkmcnt(2)
    v_cmp_ne_u64 s[50:51], v[72:73], v[68:69]
    v_cmpx_ne_u64 s[54:55], v[74:75], v[70:71]
    s_and_b64 s[82:83], s[54:55], s[80:81]
    s_cbranch_scc1 L2_c103
L2_d103:
    v_mov_b64 v[84:85], v[70:71]
    v_mov_b32 v7, v93
    v_mov_b64 v[86:87], v[74:75]
    s_or_b64 s[80:81], s[80:81], s[54:55]
    s_mov_b64 exec, s[50:51]
    s_and_b64 s[82:83], s[50:51], s[80:81]
    s_cbranch_scc1 L2_c104
L2_d104:
    v_mov_b64 v[84:85], v[68:69]
    v_mov_b32 v7, v92
    v_mov_b64 v[86:87], v[72:73]
    s_mov_b64 exec, -1
    s_or_b64 s[80:81], s[80:81], s[50:51]
    s_and_b64 exec, s[84:85], s[80:81]
    v_mfma_f32_4x4x4_16b_bf16 v[76:79], v[12:13], v[84:85], 0
    v_mov_b32 v94, v7
    s_andn2_b64 s[80:81], s[80:81], s[84:85]
    v_mfma_f32_4x4x4_16b_bf16 v[76:79], v[10:11], v[86:87], v[76:79]
    s_mov_b64 exec, -1
    ds_read_b64 v[70:71], v95 offset:65408
    ds_read_b64 v[68:69], v94 offset:65408
    v_bitop3_b32 v92, v18, v5, v99 bitop3:0xea
    v_bitop3_b32 v93, v19, v5, v46 bitop3:0xea
    v_perm_b32 v15, v19, v20, s47
    v_bitop3_b32 v46, v19, 0.5, -0.5 bitop3:0xa8
    v_perm_b32 v14, v18, v20, s46
    v_bitop3_b32 v47, v18, 0.5, -0.5 bitop3:0xa8
    v_bitop3_b32 v15, v6, v15, v46 bitop3:0xca
    v_bitop3_b32 v14, v6, v14, v47 bitop3:0xca
    s_waitcnt lgkmcnt(1)
    v_mfma_f32_4x4x4_16b_bf16 v[80:83], v[10:11], v[70:71], v[80:83]
    s_waitcnt lgkmcnt(0)
    v_mfma_f32_4x4x4_16b_bf16 v[76:79], v[10:11], v[68:69], v[76:79]
    s_nop 2
    v_cvt_pk_bf16_f32 v80, v80, v81
    v_cvt_pk_bf16_f32 v81, v82, v83
    ds_wrxchg_rtn_b64 v[74:75], v95, v[80:81] offset:65408
    v_cvt_pk_bf16_f32 v76, v76, v77
    v_cvt_pk_bf16_f32 v77, v78, v79
    ds_wrxchg_rtn_b64 v[72:73], v94, v[76:77] offset:65408
    v_and_b32 v88, 0x0fffffff, v21
    buffer_load_dwordx2 v[16:17], v88, s[8:11], 0 offen
    buffer_load_dwordx3 v[18:20], v88, s[8:11], 0 offen offset:8
    s_setprio 2
    v_mfma_f32_4x4x4_16b_bf16 v[80:83], v[8:9], v[102:103], 0
    v_mfma_f32_4x4x4_16b_bf16 v[76:79], v[8:9], v[100:101], 0
    v_cmp_lt_u32 s[48:49], v5, v93
    s_nop 2
    v_pk_mul_f32 v[80:81], v[80:81], v[14:15] op_sel:[0,1] op_sel_hi:[1,1]
    v_pk_mul_f32 v[82:83], v[82:83], v[14:15] op_sel:[0,1] op_sel_hi:[1,1]
    v_pk_mul_f32 v[76:77], v[76:77], v[14:15] op_sel:[0,0] op_sel_hi:[1,0]
    v_pk_mul_f32 v[78:79], v[78:79], v[14:15] op_sel:[0,0] op_sel_hi:[1,0]
    s_waitcnt vmcnt(10)
    v_and_b32 v46, 0x20000000, v41
    v_lshrrev_b32 v47, 14, v23
    v_bitop3_b32 v47, v47, v5, v46 bitop3:0xea
    ds_read_b64 v[106:107], v47
    v_and_b32 v99, 0x10000000, v41
    v_lshrrev_b32 v47, 14, v22
    v_bitop3_b32 v47, v47, v5, v99 bitop3:0xea
    ds_read_b64 v[104:105], v47
    s_waitcnt lgkmcnt(2)
    v_cmp_ne_u64 s[50:51], v[72:73], v[68:69]
    v_cmpx_ne_u64 s[54:55], v[74:75], v[70:71]
    s_and_b64 s[82:83], s[54:55], s[80:81]
    s_cbranch_scc1 L2_c105
L2_d105:
    v_mov_b64 v[84:85], v[70:71]
    v_mov_b32 v7, v95
    v_mov_b64 v[86:87], v[74:75]
    s_or_b64 s[80:81], s[80:81], s[54:55]
    s_mov_b64 exec, s[50:51]
    s_and_b64 s[82:83], s[50:51], s[80:81]
    s_cbranch_scc1 L2_c106
L2_d106:
    v_mov_b64 v[84:85], v[68:69]
    v_mov_b32 v7, v94
    v_mov_b64 v[86:87], v[72:73]
    s_mov_b64 exec, -1
    s_or_b64 s[80:81], s[80:81], s[50:51]
    s_and_b64 exec, s[48:49], s[80:81]
    v_mfma_f32_4x4x4_16b_bf16 v[80:83], v[12:13], v[84:85], 0
    v_mov_b32 v93, v7
    s_andn2_b64 s[80:81], s[80:81], s[48:49]
    v_mfma_f32_4x4x4_16b_bf16 v[80:83], v[10:11], v[86:87], v[80:83]
    s_mov_b64 exec, -1
    ds_read_b64 v[70:71], v93 offset:65408
    ds_read_b64 v[68:69], v92 offset:65408
    v_bitop3_b32 v94, v22, v5, v99 bitop3:0xea
    v_bitop3_b32 v95, v23, v5, v46 bitop3:0xea
    v_perm_b32 v15, v23, v26, s45
    v_bitop3_b32 v46, v23, 0.5, -0.5 bitop3:0xa8
    v_perm_b32 v14, v22, v26, s44
    v_bitop3_b32 v47, v22, 0.5, -0.5 bitop3:0xa8
    v_bitop3_b32 v15, v6, v15, v46 bitop3:0xca
    v_bitop3_b32 v14, v6, v14, v47 bitop3:0xca
    s_waitcnt lgkmcnt(1)
    v_mfma_f32_4x4x4_16b_bf16 v[80:83], v[10:11], v[70:71], v[80:83]
    s_waitcnt lgkmcnt(0)
    v_mfma_f32_4x4x4_16b_bf16 v[76:79], v[10:11], v[68:69], v[76:79]
    s_nop 2
    v_cvt_pk_bf16_f32 v80, v80, v81
    v_cvt_pk_bf16_f32 v81, v82, v83
    ds_wrxchg_rtn_b64 v[74:75], v93, v[80:81] offset:65408
    v_cvt_pk_bf16_f32 v76, v76, v77
    v_cvt_pk_bf16_f32 v77, v78, v79
    ds_wrxchg_rtn_b64 v[72:73], v92, v[76:77] offset:65408
    s_setprio 1
    v_mfma_f32_4x4x4_16b_bf16 v[80:83], v[8:9], v[106:107], 0
    v_mfma_f32_4x4x4_16b_bf16 v[76:79], v[8:9], v[104:105], 0
    s_nop 3
    v_pk_mul_f32 v[80:81], v[80:81], v[14:15] op_sel:[0,1] op_sel_hi:[1,1]
    v_pk_mul_f32 v[82:83], v[82:83], v[14:15] op_sel:[0,1] op_sel_hi:[1,1]
    v_pk_mul_f32 v[76:77], v[76:77], v[14:15] op_sel:[0,0] op_sel_hi:[1,0]
    v_pk_mul_f32 v[78:79], v[78:79], v[14:15] op_sel:[0,0] op_sel_hi:[1,0]
    s_bitcmp1_b32 s43, s42
    s_cbranch_scc1 L2_oa107
L2_ob107:
    buffer_load_dwordx4 v[112:115], v3, s[16:19], s40 offen offset:1024 sc1
    v_sub_u16 v88, v62, v54
    v_and_b32 v89, 3, v54
    v_add3_u32 v99, v88, v89, 3
    v_and_b32 v99, -4, v99
    v_max_u32 v99, 4, v99
    v_and_b32 v97, 0xfffc, v54
    v_bfm_b32 v96, v88, v89
    v_add_u32_dpp v91, v99, v99 row_shr:1 row_mask:0xf bank_mask:0xf bound_ctrl:1
    v_mad_u32_u24 v97, v97, 5, v2
    v_cmp_lt_u32 vcc, 16, v99
    v_add_u32_dpp v91, v91, v91 row_shr:2 row_mask:0xf bank_mask:0xf bound_ctrl:1
    v_sub_u32 v98, s38, v99
    v_lshrrev_b64 v[54:55], 16, v[54:55]
    v_add_u32_dpp v91, v91, v91 row_shr:4 row_mask:0xf bank_mask:0xf bound_ctrl:1
    v_lshrrev_b64 v[62:63], 16, v[62:63]
    s_mov_b32 s101, 0
    v_add_u32_dpp v91, v91, v91 row_shr:8 row_mask:0xf bank_mask:0xf bound_ctrl:1
    s_nop 1
    v_add_u32_dpp v91, v91, v91 row_bcast:15 row_mask:0xa bank_mask:0xf
    s_nop 1
    v_add_u32_dpp v91, v91, v91 row_bcast:31 row_mask:0xc bank_mask:0xf
    v_add_u32 v98, v98, v91
    v_readlane_b32 s37, v91, 63
    s_cbranch_vccnz L2_xo108
L2_xp108:
    v_and_b32 v46, 0x80000000, v41
    v_lshrrev_b32 v47, 14, v25
    v_bitop3_b32 v47, v47, v5, v46 bitop3:0xea
    ds_read_b64 v[102:103], v47
    v_and_b32 v99, 0x40000000, v41
    v_lshrrev_b32 v47, 14, v24
    v_bitop3_b32 v47, v47, v5, v99 bitop3:0xea
    ds_read_b64 v[100:101], v47
    s_waitcnt lgkmcnt(2)
    v_cmp_ne_u64 s[50:51], v[72:73], v[68:69]
    v_cmpx_ne_u64 s[54:55], v[74:75], v[70:71]
    s_and_b64 s[82:83], s[54:55], s[80:81]
    s_cbranch_scc1 L2_c109
L2_d109:
    v_mov_b64 v[84:85], v[70:71]
    v_mov_b32 v7, v93
    v_mov_b64 v[86:87], v[74:75]
    s_or_b64 s[80:81], s[80:81], s[54:55]
    s_mov_b64 exec, s[50:51]
    s_and_b64 s[82:83], s[50:51], s[80:81]
    s_cbranch_scc1 L2_c110
L2_d110:
    v_mov_b64 v[84:85], v[68:69]
    v_mov_b32 v7, v92
    v_mov_b64 v[86:87], v[72:73]
    s_mov_b64 exec, -1
    s_or_b64 s[80:81], s[80:81], s[50:51]
    ds_read_b64 v[70:71], v95 offset:65408
    ds_read_b64 v[68:69], v94 offset:65408
    v_bitop3_b32 v92, v24, v5, v99 bitop3:0xea
    v_bitop3_b32 v93, v25, v5, v46 bitop3:0xea
    v_perm_b32 v15, v25, v26, s47
    v_bitop3_b32 v46, v25, 0.5, -0.5 bitop3:0xa8
    v_perm_b32 v14, v24, v26, s46
    v_bitop3_b32 v47, v24, 0.5, -0.5 bitop3:0xa8
    v_bitop3_b32 v15, v6, v15, v46 bitop3:0xca
    v_bitop3_b32 v14, v6, v14, v47 bitop3:0xca
    s_waitcnt lgkmcnt(1)
    v_mfma_f32_4x4x4_16b_bf16 v[80:83], v[10:11], v[70:71], v[80:83]
    s_waitcnt lgkmcnt(0)
    v_mfma_f32_4x4x4_16b_bf16 v[76:79], v[10:11], v[68:69], v[76:79]
    s_nop 2
    v_cvt_pk_bf16_f32 v80, v80, v81
    v_cvt_pk_bf16_f32 v81, v82, v83
    ds_wrxchg_rtn_b64 v[74:75], v95, v[80:81] offset:65408
    v_cvt_pk_bf16_f32 v76, v76, v77
    v_cvt_pk_bf16_f32 v77, v78, v79
    ds_wrxchg_rtn_b64 v[72:73], v94, v[76:77] offset:65408
    v_and_b32 v88, 0x0fffffff, v27
    buffer_load_dwordx2 v[22:23], v88, s[8:11], 0 offen
    buffer_load_dwordx3 v[24:26], v88, s[8:11], 0 offen offset:8
    v_mfma_f32_4x4x4_16b_bf16 v[80:83], v[8:9], v[102:103], 0
    v_mfma_f32_4x4x4_16b_bf16 v[76:79], v[8:9], v[100:101], 0
    v_cmp_lt_u32 s[84:85], v5, v92
    s_nop 2
    v_pk_mul_f32 v[80:81], v[80:81], v[14:15] op_sel:[0,1] op_sel_hi:[1,1]
    v_pk_mul_f32 v[82:83], v[82:83], v[14:15] op_sel:[0,1] op_sel_hi:[1,1]
    v_pk_mul_f32 v[76:77], v[76:77], v[14:15] op_sel:[0,0] op_sel_hi:[1,0]
    v_pk_mul_f32 v[78:79], v[78:79], v[14:15] op_sel:[0,0] op_sel_hi:[1,0]
    s_waitcnt vmcnt(11)
    s_mov_b64 exec, s[6:7]
    v_lshrrev_b32 v30, 16, v30
    s_mov_b64 exec, -1
    v_and_b32 v46, 0x20000000, v42
    v_lshrrev_b32 v47, 14, v29
    v_bitop3_b32 v47, v47, v5, v46 bitop3:0xea
    ds_read_b64 v[106:107], v47
    v_and_b32 v99, 0x10000000, v42
    v_lshrrev_b32 v47, 14, v28
    v_bitop3_b32 v47, v47, v5, v99 bitop3:0xea
    ds_read_b64 v[104:105], v47
    s_waitcnt lgkmcnt(2)
    v_cmp_ne_u64 s[50:51], v[72:73], v[68:69]
    v_cmpx_ne_u64 s[54:55], v[74:75], v[70:71]
    s_and_b64 s[82:83], s[54:55], s[80:81]
    s_cbranch_scc1 L2_c111
L2_d111:
    v_mov_b64 v[84:85], v[70:71]
    v_mov_b32 v7, v95
    v_mov_b64 v[86:87], v[74:75]
    s_or_b64 s[80:81], s[80:81], s[54:55]
    s_mov_b64 exec, s[50:51]
    s_and_b64 s[82:83], s[50:51], s[80:81]
    s_cbranch_scc1 L2_c112
L2_d112:
    v_mov_b64 v[84:85], v[68:69]
    v_mov_b32 v7, v94
    v_mov_b64 v[86:87], v[72:73]
    s_mov_b64 exec, -1
    s_or_b64 s[80:81], s[80:81], s[50:51]
    s_and_b64 exec, s[84:85], s[80:81]
    v_mfma_f32_4x4x4_16b_bf16 v[76:79], v[12:13], v[84:85], 0
    v_mov_b32 v92, v7
    s_andn2_b64 s[80:81], s[80:81], s[84:85]
    v_mfma_f32_4x4x4_16b_bf16 v[76:79], v[10:11], v[86:87], v[76:79]
    s_mov_b64 exec, -1
    ds_read_b64 v[70:71], v93 offset:65408
    ds_read_b64 v[68:69], v92 offset:65408
    v_bitop3_b32 v94, v28, v5, v99 bitop3:0xea
    v_bitop3_b32 v95, v29, v5, v46 bitop3:0xea
    v_perm_b32 v15, v29, v30, s45
    v_bitop3_b32 v46, v29, 0.5, -0.5 bitop3:0xa8
    v_perm_b32 v14, v28, v30, s44
    v_bitop3_b32 v47, v28, 0.5, -0.5 bitop3:0xa8
    v_bitop3_b32 v15, v6, v15, v46 bitop3:0xca
    v_bitop3_b32 v14, v6, v14, v47 bitop3:0xca
    s_waitcnt lgkmcnt(1)
    v_mfma_f32_4x4x4_16b_bf16 v[80:83], v[10:11], v[70:71], v[80:83]
    s_waitcnt lgkmcnt(0)
    v_mfma_f32_4x4x4_16b_bf16 v[76:79], v[10:11], v[68:69], v[76:79]
    s_nop 2
    v_cvt_pk_bf16_f32 v80, v80, v81
    v_cvt_pk_bf16_f32 v81, v82, v83
    ds_wrxchg_rtn_b64 v[74:75], v93, v[80:81] offset:65408
    v_cvt_pk_bf16_f32 v76, v76, v77
    v_cvt_pk_bf16_f32 v77, v78, v79
    ds_wrxchg_rtn_b64 v[72:73], v92, v[76:77] offset:65408
    s_setprio 0
    v_mfma_f32_4x4x4_16b_bf16 v[80:83], v[8:9], v[106:107], 0
    v_mfma_f32_4x4x4_16b_bf16 v[76:79], v[8:9], v[104:105], 0
    v_cmp_lt_u32 s[48:49], v5, v95
    s_nop 2
    v_pk_mul_f32 v[80:81], v[80:81], v[14:15] op_sel:[0,1] op_sel_hi:[1,1]
    v_pk_mul_f32 v[82:83], v[82:83], v[14:15] op_sel:[0,1] op_sel_hi:[1,1]
    v_pk_mul_f32 v[76:77], v[76:77], v[14:15] op_sel:[0,0] op_sel_hi:[1,0]
    v_pk_mul_f32 v[78:79], v[78:79], v[14:15] op_sel:[0,0] op_sel_hi:[1,0]
    s_add_u32 s40, s40, 0x50000
    v_and_b32 v47, 0x0fffffff, v31
    buffer_load_dword v30, v47, s[8:11], 0 offen offset:16
    s_mov_b64 exec, s[6:7]
    v_add_u32 v47, 8, v47
    v_lshrrev_b32 v31, 2, v31
    s_mov_b64 exec, -1
    buffer_load_dwordx2 v[28:29], v47, s[8:11], 0 offen
    s_waitcnt vmcnt(8)
    v_and_b32 v46, 0x80000000, v43
    v_lshrrev_b32 v47, 14, v37
    v_bitop3_b32 v47, v47, v5, v46 bitop3:0xea
    ds_read_b64 v[106:107], v47
    v_and_b32 v99, 0x40000000, v43
    v_lshrrev_b32 v47, 14, v36
    v_bitop3_b32 v47, v47, v5, v99 bitop3:0xea
    ds_read_b64 v[104:105], v47
    v_and_b32 v46, 0x20000000, v43
    v_lshrrev_b32 v47, 14, v35
    v_bitop3_b32 v47, v47, v5, v46 bitop3:0xea
    ds_read_b64 v[102:103], v47
    v_and_b32 v99, 0x10000000, v43
    v_lshrrev_b32 v47, 14, v34
    v_bitop3_b32 v47, v47, v5, v99 bitop3:0xea
    ds_read_b64 v[100:101], v47
    s_waitcnt lgkmcnt(4)
    v_cmp_ne_u64 s[50:51], v[72:73], v[68:69]
    v_cmpx_ne_u64 s[54:55], v[74:75], v[70:71]
    s_and_b64 s[82:83], s[54:55], s[80:81]
    s_cbranch_scc1 L2_c113
L2_d113:
    v_mov_b64 v[84:85], v[70:71]
    v_mov_b32 v7, v93
    v_mov_b64 v[86:87], v[74:75]
    s_or_b64 s[80:81], s[80:81], s[54:55]
    s_mov_b64 exec, s[50:51]
    s_and_b64 s[82:83], s[50:51], s[80:81]
    s_cbranch_scc1 L2_c114
L2_d114:
    v_mov_b64 v[84:85], v[68:69]
    v_mov_b32 v7, v92
    v_mov_b64 v[86:87], v[72:73]
    s_mov_b64 exec, -1
    s_or_b64 s[80:81], s[80:81], s[50:51]
    s_and_b64 exec, s[48:49], s[80:81]
    v_mfma_f32_4x4x4_16b_bf16 v[80:83], v[12:13], v[84:85], 0
    v_mov_b32 v95, v7
    s_andn2_b64 s[80:81], s[80:81], s[48:49]
    v_mfma_f32_4x4x4_16b_bf16 v[80:83], v[10:11], v[86:87], v[80:83]
    s_mov_b64 exec, -1
    ds_read_b64 v[70:71], v95 offset:65408
    ds_read_b64 v[68:69], v94 offset:65408
    v_bitop3_b32 v92, v34, v5, v99 bitop3:0xea
    v_bitop3_b32 v93, v35, v5, v46 bitop3:0xea
    v_perm_b32 v15, v35, v38, s45
    v_bitop3_b32 v46, v35, 0.5, -0.5 bitop3:0xa8
    v_perm_b32 v14, v34, v38, s44
    v_bitop3_b32 v47, v34, 0.5, -0.5 bitop3:0xa8
    v_bitop3_b32 v15, v6, v15, v46 bitop3:0xca
    v_bitop3_b32 v14, v6, v14, v47 bitop3:0xca
    s_waitcnt lgkmcnt(1)
    v_mfma_f32_4x4x4_16b_bf16 v[80:83], v[10:11], v[70:71], v[80:83]
    s_waitcnt lgkmcnt(0)
    v_mfma_f32_4x4x4_16b_bf16 v[76:79], v[10:11], v[68:69], v[76:79]
    s_nop 2
    v_cvt_pk_bf16_f32 v80, v80, v81
    v_cvt_pk_bf16_f32 v81, v82, v83
    ds_wrxchg_rtn_b64 v[74:75], v95, v[80:81] offset:65408
    v_cvt_pk_bf16_f32 v76, v76, v77
    v_cvt_pk_bf16_f32 v77, v78, v79
    ds_wrxchg_rtn_b64 v[72:73], v94, v[76:77] offset:65408
    s_barrier
    s_setprio 3
    s_mov_b32 m0, s100
    s_nop 0
    ds_write_addtid_b32 v124 offset:34816
    ds_write_addtid_b32 v125 offset:35072
    ds_write_addtid_b32 v126 offset:35328
    ds_write_addtid_b32 v127 offset:35584
    s_add_u32 s3, s40, 4096
    buffer_load_dwordx4 v[124:127], v3, s[16:19], s3 offen sc1
    ds_write_addtid_b32 v116 offset:32768
    ds_write_addtid_b32 v117 offset:33024
    ds_write_addtid_b32 v118 offset:33280
    ds_write_addtid_b32 v119 offset:33536
    buffer_load_dwordx4 v[116:119], v3, s[16:19], s40 offen offset:2048 sc1
    ds_write_addtid_b32 v120 offset:33792
    ds_write_addtid_b32 v121 offset:34048
    ds_write_addtid_b32 v122 offset:34304
    ds_write_addtid_b32 v123 offset:34560
    buffer_load_dwordx4 v[120:123], v3, s[16:19], s40 offen offset:3072 sc1
    v_mfma_f32_4x4x4_16b_bf16 v[80:83], v[8:9], v[102:103], 0
    v_mfma_f32_4x4x4_16b_bf16 v[76:79], v[8:9], v[100:101], 0
    s_nop 3
    v_pk_mul_f32 v[80:81], v[80:81], v[14:15] op_sel:[0,1] op_sel_hi:[1,1]
    v_pk_mul_f32 v[82:83], v[82:83], v[14:15] op_sel:[0,1] op_sel_hi:[1,1]
    v_pk_mul_f32 v[76:77], v[76:77], v[14:15] op_sel:[0,0] op_sel_hi:[1,0]
    v_pk_mul_f32 v[78:79], v[78:79], v[14:15] op_sel:[0,0] op_sel_hi:[1,0]
    s_cmp_gt_u32 s37, 1024
    s_cbranch_scc1 L2_xs115
    s_cmp_lg_u32 s101, 0
    s_cbranch_scc1 L2_xa115
L2_xb115:
    v_lshlrev_b32 v89, 16, v96
    v_add_u32 v90, 60, v97
    v_bitop3_b32 v90, v89, v45, v90 bitop3:0x6a
    ds_write_b32 v98, v90 offset:12
    v_lshlrev_b32 v89, 20, v96
    v_add_u32 v90, 40, v97
    v_bitop3_b32 v90, v89, v45, v90 bitop3:0x6a
    ds_write_b32 v98, v90 offset:8
    v_lshlrev_b32 v89, 24, v96
    v_add_u32 v90, 20, v97
    v_bitop3_b32 v90, v89, v45, v90 bitop3:0x6a
    ds_write_b32 v98, v90 offset:4
    v_lshlrev_b32 v89, 28, v96
    v_bitop3_b32 v90, v89, v45, v97 bitop3:0x6a
    ds_write_b32 v98, v90 offset:0
    v_mov_b32_dpp v91, v66 quad_perm:[1,1,1,1] row_mask:0xf bank_mask:0xf
    v_and_b32 v89, 3, v91
    v_and_b32 v97, 0xfffc, v91
    v_sub_u16_dpp v88, v66, v91 quad_perm:[3,3,3,3] row_mask:0xf bank_mask:0xf
    v_mad_u32_u24 v97, v97, 5, v4
    v_add_u32 v99, v88, v89
    v_bfm_b32 v96, v88, v89
    v_cmp_lt_u32 s[58:59], 16, v99
    v_lshlrev_b32 v89, v1, v96
    v_and_b32 v89, v45, v89
    v_cmp_ne_u32 vcc, 0, v89
    v_xor_b32 v90, v97, v89
    s_add_u32 s3, s37, s38
    v_mbcnt_lo_u32_b32 v98, vcc_lo, 0
    v_mbcnt_hi_u32_b32 v98, vcc_hi, v98
    s_bcnt1_i32_b64 s41, vcc
    v_lshl_add_u32 v98, v98, 2, s3
    s_lshl2_add_u32 s37, s41, s37
    s_mov_b64 exec, vcc
    ds_write_b32 v98, v90
    s_mov_b64 exec, -1
    s_cmp_lg_u64 s[58:59], 0
    s_cbranch_scc1 L2_xe115
L2_xr115:
    v_add_u32 v98, s37, v0
    v_mov_b32 v90, -1
    ds_write_b32 v98, v90
L2_xw115:
    s_setprio 2
    s_waitcnt lgkmcnt(14)
    v_cmp_ne_u64 s[50:51], v[72:73], v[68:69]
    v_cmpx_ne_u64 s[54:55], v[74:75], v[70:71]
    s_and_b64 s[82:83], s[54:55], s[80:81]
    s_cbranch_scc1 L2_c116
L2_d116:
    v_mov_b64 v[84:85], v[70:71]
    v_mov_b32 v7, v95
    v_mov_b64 v[86:87], v[74:75]
    s_or_b64 s[80:81], s[80:81], s[54:55]
    s_mov_b64 exec, s[50:51]
    s_and_b64 s[82:83], s[50:51], s[80:81]
    s_cbranch_scc1 L2_c117
L2_d117:
    v_mov_b64 v[84:85], v[68:69]
    v_mov_b32 v7, v94
    v_mov_b64 v[86:87], v[72:73]
    s_mov_b64 exec, -1
    s_or_b64 s[80:81], s[80:81], s[50:51]
    ds_read_b64 v[70:71], v93 offset:65408
    ds_read_b64 v[68:69], v92 offset:65408
    v_and_b32 v46, 0x40000000, v43
    v_bitop3_b32 v94, v36, v5, v46 bitop3:0xea
    v_and_b32 v46, 0x80000000, v43
    v_bitop3_b32 v95, v37, v5, v46 bitop3:0xea
    v_perm_b32 v15, v37, v38, s47
    v_bitop3_b32 v46, v37, 0.5, -0.5 bitop3:0xa8
    v_perm_b32 v14, v36, v38, s46
    v_bitop3_b32 v47, v36, 0.5, -0.5 bitop3:0xa8
    v_bitop3_b32 v15, v6, v15, v46 bitop3:0xca
    v_bitop3_b32 v14, v6, v14, v47 bitop3:0xca
    s_setprio 1
    s_waitcnt lgkmcnt(1)
    v_mfma_f32_4x4x4_16b_bf16 v[80:83], v[10:11], v[70:71], v[80:83]
    s_waitcnt lgkmcnt(0)
    v_mfma_f32_4x4x4_16b_bf16 v[76:79], v[10:11], v[68:69], v[76:79]
    s_nop 2
    v_cvt_pk_bf16_f32 v80, v80, v81
    v_cvt_pk_bf16_f32 v81, v82, v83
    ds_wrxchg_rtn_b64 v[74:75], v93, v[80:81] offset:65408
    v_cvt_pk_bf16_f32 v76, v76, v77
    v_cvt_pk_bf16_f32 v77, v78, v79
    ds_wrxchg_rtn_b64 v[72:73], v92, v[76:77] offset:65408
    ds_read_b32 v40, v0 offset:0
    ds_read_b32 v41, v0 offset:256
    ds_read_b32 v42, v44 offset:768
    ds_read_b32 v43, v0 offset:512
    s_sub_u32 s3, s37, 768
    s_cmp_gt_u32 s3, 128
    s_cbranch_scc1 L2_xf115
L2_xg115:
    v_lshrrev_b64 v[64:65], 16, v[64:65]
    v_lshrrev_b64 v[66:67], 16, v[66:67]
    v_and_b32 v88, 0x0fffffff, v39
    buffer_load_dwordx2 v[34:35], v88, s[8:11], 0 offen
    buffer_load_dwordx3 v[36:38], v88, s[8:11], 0 offen offset:8
    s_setprio 0
    s_waitcnt vmcnt(12)
    s_mov_b32 m0, s38
    s_nop 0
    ds_write_addtid_b32 v108 offset:0
    ds_write_addtid_b32 v109 offset:256
    ds_write_addtid_b32 v110 offset:512
    ds_write_addtid_b32 v111 offset:768
    s_waitcnt vmcnt(9)
    ds_write_addtid_b32 v112 offset:1024
    ds_write_addtid_b32 v113 offset:1280
    ds_write_addtid_b32 v114 offset:1536
    ds_write_addtid_b32 v115 offset:1792
    v_mfma_f32_4x4x4_16b_bf16 v[80:83], v[8:9], v[106:107], 0
    v_mfma_f32_4x4x4_16b_bf16 v[76:79], v[8:9], v[104:105], 0
    v_cmp_lt_u32 s[84:85], v5, v94
    s_nop 2
    v_pk_mul_f32 v[80:81], v[80:81], v[14:15] op_sel:[0,1] op_sel_hi:[1,1]
    v_pk_mul_f32 v[82:83], v[82:83], v[14:15] op_sel:[0,1] op_sel_hi:[1,1]
    v_pk_mul_f32 v[76:77], v[76:77], v[14:15] op_sel:[0,0] op_sel_hi:[1,0]
    v_pk_mul_f32 v[78:79], v[78:79], v[14:15] op_sel:[0,0] op_sel_hi:[1,0]
    s_add_u32 s42, s42, 1
    s_waitcnt lgkmcnt(0)
    s_cmp_lg_u32 s42, 14
    s_cbranch_scc1 L2_loop
    s_barrier
    s_bitcmp1_b32 s36, s42
    s_cbranch_scc1 L2_slow
L2_ret6:
    s_setprio 3
    s_bitcmp1_b32 s43, s42
    s_cbranch_scc1 L2_oa118
L2_ob118:
    v_and_b32 v46, 0x20000000, v21
    v_lshrrev_b32 v47, 14, v17
    v_bitop3_b32 v47, v47, v5, v46 bitop3:0xea
    ds_read_b64 v[102:103], v47
    v_and_b32 v99, 0x10000000, v21
    v_lshrrev_b32 v47, 14, v16
    v_bitop3_b32 v47, v47, v5, v99 bitop3:0xea
    ds_read_b64 v[100:101], v47
    v_cmp_ne_u64 s[50:51], v[72:73], v[68:69]
    v_cmpx_ne_u64 s[54:55], v[74:75], v[70:71]
    s_and_b64 s[82:83], s[54:55], s[80:81]
    s_cbranch_scc1 L2_c119
L2_d119:
    v_mov_b64 v[84:85], v[70:71]
    v_mov_b32 v7, v93
    v_mov_b64 v[86:87], v[74:75]
    s_or_b64 s[80:81], s[80:81], s[54:55]
    s_mov_b64 exec, s[50:51]
    s_and_b64 s[82:83], s[50:51], s[80:81]
    s_cbranch_scc1 L2_c120
L2_d120:
    v_mov_b64 v[84:85], v[68:69]
    v_mov_b32 v7, v92
    v_mov_b64 v[86:87], v[72:73]
    s_mov_b64 exec, -1
    s_or_b64 s[80:81], s[80:81], s[50:51]
    s_and_b64 exec, s[84:85], s[80:81]
    v_mfma_f32_4x4x4_16b_bf16 v[76:79], v[12:13], v[84:85], 0
    v_mov_b32 v94, v7
    s_andn2_b64 s[80:81], s[80:81], s[84:85]
    v_mfma_f32_4x4x4_16b_bf16 v[76:79], v[10:11], v[86:87], v[76:79]
    s_mov_b64 exec, -1
    ds_read_b64 v[70:71], v95 offset:65408
    ds_read_b64 v[68:69], v94 offset:65408
    v_bitop3_b32 v92, v16, v5, v99 bitop3:0xea
    v_bitop3_b32 v93, v17, v5, v46 bitop3:0xea
    v_perm_b32 v15, v17, v20, s45
    v_bitop3_b32 v46, v17, 0.5, -0.5 bitop3:0xa8
    v_perm_b32 v14, v16, v20, s44
    v_bitop3_b32 v47, v16, 0.5, -0.5 bitop3:0xa8
    v_bitop3_b32 v15, v6, v15, v46 bitop3:0xca
    v_bitop3_b32 v14, v6, v14, v47 bitop3:0xca
    s_waitcnt lgkmcnt(1)
    v_mfma_f32_4x4x4_16b_bf16 v[80:83], v[10:11], v[70:71], v[80:83]
    s_waitcnt lgkmcnt(0)
    v_mfma_f32_4x4x4_16b_bf16 v[76:79], v[10:11], v[68:69], v[76:79]
    s_nop 2
    v_cvt_pk_bf16_f32 v80, v80, v81
    v_cvt_pk_bf16_f32 v81, v82, v83
    ds_wrxchg_rtn_b64 v[74:75], v95, v[80:81] offset:65408
    v_cvt_pk_bf16_f32 v76, v76, v77
    v_cvt_pk_bf16_f32 v77, v78, v79
    ds_wrxchg_rtn_b64 v[72:73], v94, v[76:77] offset:65408
    v_mfma_f32_4x4x4_16b_bf16 v[80:83], v[8:9], v[102:103], 0
    v_mfma_f32_4x4x4_16b_bf16 v[76:79], v[8:9], v[100:101], 0
    v_cmp_lt_u32 s[84:85], v5, v92
    s_nop 2
    v_pk_mul_f32 v[80:81], v[80:81], v[14:15] op_sel:[0,1] op_sel_hi:[1,1]
    v_pk_mul_f32 v[82:83], v[82:83], v[14:15] op_sel:[0,1] op_sel_hi:[1,1]
    v_pk_mul_f32 v[76:77], v[76:77], v[14:15] op_sel:[0,0] op_sel_hi:[1,0]
    v_pk_mul_f32 v[78:79], v[78:79], v[14:15] op_sel:[0,0] op_sel_hi:[1,0]
    buffer_load_dwordx4 v[108:111], v3, s[16:19], s40 offen offset:0 sc1
    v_and_b32 v46, 0x80000000, v21
    v_lshrrev_b32 v47, 14, v19
    v_bitop3_b32 v47, v47, v5, v46 bitop3:0xea
    ds_read_b64 v[106:107], v47
    v_and_b32 v99, 0x40000000, v21
    v_lshrrev_b32 v47, 14, v18
    v_bitop3_b32 v47, v47, v5, v99 bitop3:0xea
    ds_read_b64 v[104:105], v47
    s_waitcnt lgkmcnt(2)
    v_cmp_ne_u64 s[50:51], v[72:73], v[68:69]
    v_cmpx_ne_u64 s[54:55], v[74:75], v[70:71]
    s_and_b64 s[82:83], s[54:55], s[80:81]
    s_cbranch_scc1 L2_c121
L2_d121:
    v_mov_b64 v[84:85], v[70:71]
    v_mov_b32 v7, v95
    v_mov_b64 v[86:87], v[74:75]
    s_or_b64 s[80:81], s[80:81], s[54:55]
    s_mov_b64 exec, s[50:51]
    s_and_b64 s[82:83], s[50:51], s[80:81]
    s_cbranch_scc1 L2_c122
L2_d122:
    v_mov_b64 v[84:85], v[68:69]
    v_mov_b32 v7, v94
    v_mov_b64 v[86:87], v[72:73]
    s_mov_b64 exec, -1
    s_or_b64 s[80:81], s[80:81], s[50:51]
    s_and_b64 exec, s[84:85], s[80:81]
    v_mfma_f32_4x4x4_16b_bf16 v[76:79], v[12:13], v[84:85], 0
    v_mov_b32 v92, v7
    s_andn2_b64 s[80:81], s[80:81], s[84:85]
    v_mfma_f32_4x4x4_16b_bf16 v[76:79], v[10:11], v[86:87], v[76:79]
    s_mov_b64 exec, -1
    ds_read_b64 v[70:71], v93 offset:65408
    ds_read_b64 v[68:69], v92 offset:65408
    v_bitop3_b32 v94, v18, v5, v99 bitop3:0xea
    v_bitop3_b32 v95, v19, v5, v46 bitop3:0xea
    v_perm_b32 v15, v19, v20, s47
    v_bitop3_b32 v46, v19, 0.5, -0.5 bitop3:0xa8
    v_perm_b32 v14, v18, v20, s46
    v_bitop3_b32 v47, v18, 0.5, -0.5 bitop3:0xa8
    v_bitop3_b32 v15, v6, v15, v46 bitop3:0xca
    v_bitop3_b32 v14, v6, v14, v47 bitop3:0xca
    s_waitcnt lgkmcnt(1)
    v_mfma_f32_4x4x4_16b_bf16 v[80:83], v[10:11], v[70:71], v[80:83]
    s_waitcnt lgkmcnt(0)
    v_mfma_f32_4x4x4_16b_bf16 v[76:79], v[10:11], v[68:69], v[76:79]
    s_nop 2
    v_cvt_pk_bf16_f32 v80, v80, v81
    v_cvt_pk_bf16_f32 v81, v82, v83
    ds_wrxchg_rtn_b64 v[74:75], v93, v[80:81] offset:65408
    v_cvt_pk_bf16_f32 v76, v76, v77
    v_cvt_pk_bf16_f32 v77, v78, v79
    ds_wrxchg_rtn_b64 v[72:73], v92, v[76:77] offset:65408
    v_and_b32 v88, 0x0fffffff, v40
    buffer_load_dwordx2 v[16:17], v88, s[8:11], 0 offen
    buffer_load_dwordx3 v[18:20], v88, s[8:11], 0 offen offset:8
    s_setprio 2
    v_mfma_f32_4x4x4_16b_bf16 v[80:83], v[8:9], v[106:107], 0
    v_mfma_f32_4x4x4_16b_bf16 v[76:79], v[8:9], v[104:105], 0
    v_cmp_lt_u32 s[48:49], v5, v95
    s_nop 2
    v_pk_mul_f32 v[80:81], v[80:81], v[14:15] op_sel:[0,1] op_sel_hi:[1,1]
    v_pk_mul_f32 v[82:83], v[82:83], v[14:15] op_sel:[0,1] op_sel_hi:[1,1]
    v_pk_mul_f32 v[76:77], v[76:77], v[14:15] op_sel:[0,0] op_sel_hi:[1,0]
    v_pk_mul_f32 v[78:79], v[78:79], v[14:15] op_sel:[0,0] op_sel_hi:[1,0]
    s_waitcnt vmcnt(10)
    v_and_b32 v46, 0x20000000, v27
    v_lshrrev_b32 v47, 14, v23
    v_bitop3_b32 v47, v47, v5, v46 bitop3:0xea
    ds_read_b64 v[102:103], v47
    v_and_b32 v99, 0x10000000, v27
    v_lshrrev_b32 v47, 14, v22
    v_bitop3_b32 v47, v47, v5, v99 bitop3:0xea
    ds_read_b64 v[100:101], v47
    s_waitcnt lgkmcnt(2)
    v_cmp_ne_u64 s[50:51], v[72:73], v[68:69]
    v_cmpx_ne_u64 s[54:55], v[74:75], v[70:71]
    s_and_b64 s[82:83], s[54:55], s[80:81]
    s_cbranch_scc1 L2_c123
L2_d123:
    v_mov_b64 v[84:85], v[70:71]
    v_mov_b32 v7, v93
    v_mov_b64 v[86:87], v[74:75]
    s_or_b64 s[80:81], s[80:81], s[54:55]
    s_mov_b64 exec, s[50:51]
    s_and_b64 s[82:83], s[50:51], s[80:81]
    s_cbranch_scc1 L2_c124
L2_d124:
    v_mov_b64 v[84:85], v[68:69]
    v_mov_b32 v7, v92
    v_mov_b64 v[86:87], v[72:73]
    s_mov_b64 exec, -1
    s_or_b64 s[80:81], s[80:81], s[50:51]
    s_and_b64 exec, s[48:49], s[80:81]
    v_mfma_f32_4x4x4_16b_bf16 v[80:83], v[12:13], v[84:85], 0
    v_mov_b32 v95, v7
    s_andn2_b64 s[80:81], s[80:81], s[48:49]
    v_mfma_f32_4x4x4_16b_bf16 v[80:83], v[10:11], v[86:87], v[80:83]
    s_mov_b64 exec, -1
    ds_read_b64 v[70:71], v95 offset:65408
    ds_read_b64 v[68:69], v94 offset:65408
    v_bitop3_b32 v92, v22, v5, v99 bitop3:0xea
    v_bitop3_b32 v93, v23, v5, v46 bitop3:0xea
    v_perm_b32 v15, v23, v26, s45
    v_bitop3_b32 v46, v23, 0.5, -0.5 bitop3:0xa8
    v_perm_b32 v14, v22, v26, s44
    v_bitop3_b32 v47, v22, 0.5, -0.5 bitop3:0xa8
    v_bitop3_b32 v15, v6, v15, v46 bitop3:0xca
    v_bitop3_b32 v14, v6, v14, v47 bitop3:0xca
    s_waitcnt lgkmcnt(1)
    v_mfma_f32_4x4x4_16b_bf16 v[80:83], v[10:11], v[70:71], v[80:83]
    s_waitcnt lgkmcnt(0)
    v_mfma_f32_4x4x4_16b_bf16 v[76:79], v[10:11], v[68:69], v[76:79]
    s_nop 2
    v_cvt_pk_bf16_f32 v80, v80, v81
    v_cvt_pk_bf16_f32 v81, v82, v83
    ds_wrxchg_rtn_b64 v[74:75], v95, v[80:81] offset:65408
    v_cvt_pk_bf16_f32 v76, v76, v77
    v_cvt_pk_bf16_f32 v77, v78, v79
    ds_wrxchg_rtn_b64 v[72:73], v94, v[76:77] offset:65408
    s_setprio 1
    v_mfma_f32_4x4x4_16b_bf16 v[80:83], v[8:9], v[102:103], 0
    v_mfma_f32_4x4x4_16b_bf16 v[76:79], v[8:9], v[100:101], 0
    s_nop 3
    v_pk_mul_f32 v[80:81], v[80:81], v[14:15] op_sel:[0,1] op_sel_hi:[1,1]
    v_pk_mul_f32 v[82:83], v[82:83], v[14:15] op_sel:[0,1] op_sel_hi:[1,1]
    v_pk_mul_f32 v[76:77], v[76:77], v[14:15] op_sel:[0,0] op_sel_hi:[1,0]
    v_pk_mul_f32 v[78:79], v[78:79], v[14:15] op_sel:[0,0] op_sel_hi:[1,0]
    s_bitcmp1_b32 s43, s42
    s_cbranch_scc1 L2_oa125
L2_ob125:
    buffer_load_dwordx4 v[112:115], v3, s[16:19], s40 offen offset:1024 sc1
    v_and_b32 v46, 0x80000000, v27
    v_lshrrev_b32 v47, 14, v25
    v_bitop3_b32 v47, v47, v5, v46 bitop3:0xea
    ds_read_b64 v[106:107], v47
    v_and_b32 v99, 0x40000000, v27
    v_lshrrev_b32 v47, 14, v24
    v_bitop3_b32 v47, v47, v5, v99 bitop3:0xea
    ds_read_b64 v[104:105], v47
    s_waitcnt lgkmcnt(2)
    v_cmp_ne_u64 s[50:51], v[72:73], v[68:69]
    v_cmpx_ne_u64 s[54:55], v[74:75], v[70:71]
    s_and_b64 s[82:83], s[54:55], s[80:81]
    s_cbranch_scc1 L2_c126
L2_d126:
    v_mov_b64 v[84:85], v[70:71]
    v_mov_b32 v7, v95
    v_mov_b64 v[86:87], v[74:75]
    s_or_b64 s[80:81], s[80:81], s[54:55]
    s_mov_b64 exec, s[50:51]
    s_and_b64 s[82:83], s[50:51], s[80:81]
    s_cbranch_scc1 L2_c127
L2_d127:
    v_mov_b64 v[84:85], v[68:69]
    v_mov_b32 v7, v94
    v_mov_b64 v[86:87], v[72:73]
    s_mov_b64 exec, -1
    s_or_b64 s[80:81], s[80:81], s[50:51]
    ds_read_b64 v[70:71], v93 offset:65408
    ds_read_b64 v[68:69], v92 offset:65408
    v_bitop3_b32 v94, v24, v5, v99 bitop3:0xea
    v_bitop3_b32 v95, v25, v5, v46 bitop3:0xea
    v_perm_b32 v15, v25, v26, s47
    v_bitop3_b32 v46, v25, 0.5, -0.5 bitop3:0xa8
    v_perm_b32 v14, v24, v26, s46
    v_bitop3_b32 v47, v24, 0.5, -0.5 bitop3:0xa8
    v_bitop3_b32 v15, v6, v15, v46 bitop3:0xca
    v_bitop3_b32 v14, v6, v14, v47 bitop3:0xca
    s_waitcnt lgkmcnt(1)
    v_mfma_f32_4x4x4_16b_bf16 v[80:83], v[10:11], v[70:71], v[80:83]
    s_waitcnt lgkmcnt(0)
    v_mfma_f32_4x4x4_16b_bf16 v[76:79], v[10:11], v[68:69], v[76:79]
    s_nop 2
    v_cvt_pk_bf16_f32 v80, v80, v81
    v_cvt_pk_bf16_f32 v81, v82, v83
    ds_wrxchg_rtn_b64 v[74:75], v93, v[80:81] offset:65408
    v_cvt_pk_bf16_f32 v76, v76, v77
    v_cvt_pk_bf16_f32 v77, v78, v79
    ds_wrxchg_rtn_b64 v[72:73], v92, v[76:77] offset:65408
    v_and_b32 v88, 0x0fffffff, v41
    buffer_load_dwordx2 v[22:23], v88, s[8:11], 0 offen
    buffer_load_dwordx3 v[24:26], v88, s[8:11], 0 offen offset:8
    v_mfma_f32_4x4x4_16b_bf16 v[80:83], v[8:9], v[106:107], 0
    v_mfma_f32_4x4x4_16b_bf16 v[76:79], v[8:9], v[104:105], 0
    v_cmp_lt_u32 s[84:85], v5, v94
    s_nop 2
    v_pk_mul_f32 v[80:81], v[80:81], v[14:15] op_sel:[0,1] op_sel_hi:[1,1]
    v_pk_mul_f32 v[82:83], v[82:83], v[14:15] op_sel:[0,1] op_sel_hi:[1,1]
    v_pk_mul_f32 v[76:77], v[76:77], v[14:15] op_sel:[0,0] op_sel_hi:[1,0]
    v_pk_mul_f32 v[78:79], v[78:79], v[14:15] op_sel:[0,0] op_sel_hi:[1,0]
    s_waitcnt vmcnt(11)
    s_mov_b64 exec, s[6:7]
    v_lshrrev_b32 v30, 16, v30
    s_mov_b64 exec, -1
    v_and_b32 v46, 0x20000000, v31
    v_lshrrev_b32 v47, 14, v29
    v_bitop3_b32 v47, v47, v5, v46 bitop3:0xea
    ds_read_b64 v[102:103], v47
    v_and_b32 v99, 0x10000000, v31
    v_lshrrev_b32 v47, 14, v28
    v_bitop3_b32 v47, v47, v5, v99 bitop3:0xea
    ds_read_b64 v[100:101], v47
    s_waitcnt lgkmcnt(2)
    v_cmp_ne_u64 s[50:51], v[72:73], v[68:69]
    v_cmpx_ne_u64 s[54:55], v[74:75], v[70:71]
    s_and_b64 s[82:83], s[54:55], s[80:81]
    s_cbranch_scc1 L2_c128
L2_d128:
    v_mov_b64 v[84:85], v[70:71]
    v_mov_b32 v7, v93
    v_mov_b64 v[86:87], v[74:75]
    s_or_b64 s[80:81], s[80:81], s[54:55]
    s_mov_b64 exec, s[50:51]
    s_and_b64 s[82:83], s[50:51], s[80:81]
    s_cbranch_scc1 L2_c129
L2_d129:
    v_mov_b64 v[84:85], v[68:69]
    v_mov_b32 v7, v92
    v_mov_b64 v[86:87], v[72:73]
    s_mov_b64 exec, -1
    s_or_b64 s[80:81], s[80:81], s[50:51]
    s_and_b64 exec, s[84:85], s[80:81]
    v_mfma_f32_4x4x4_16b_bf16 v[76:79], v[12:13], v[84:85], 0
    v_mov_b32 v94, v7
    s_andn2_b64 s[80:81], s[80:81], s[84:85]
    v_mfma_f32_4x4x4_16b_bf16 v[76:79], v[10:11], v[86:87], v[76:79]
    s_mov_b64 exec, -1
    ds_read_b64 v[70:71], v95 offset:65408
    ds_read_b64 v[68:69], v94 offset:65408
    v_bitop3_b32 v92, v28, v5, v99 bitop3:0xea
    v_bitop3_b32 v93, v29, v5, v46 bitop3:0xea
    v_perm_b32 v15, v29, v30, s45
    v_bitop3_b32 v46, v29, 0.5, -0.5 bitop3:0xa8
    v_perm_b32 v14, v28, v30, s44
    v_bitop3_b32 v47, v28, 0.5, -0.5 bitop3:0xa8
    v_bitop3_b32 v15, v6, v15, v46 bitop3:0xca
    v_bitop3_b32 v14, v6, v14, v47 bitop3:0xca
    s_waitcnt lgkmcnt(1)
    v_mfma_f32_4x4x4_16b_bf16 v[80:83], v[10:11], v[70:71], v[80:83]
    s_waitcnt lgkmcnt(0)
    v_mfma_f32_4x4x4_16b_bf16 v[76:79], v[10:11], v[68:69], v[76:79]
    s_nop 2
    v_cvt_pk_bf16_f32 v80, v80, v81
    v_cvt_pk_bf16_f32 v81, v82, v83
    ds_wrxchg_rtn_b64 v[74:75], v95, v[80:81] offset:65408
    v_cvt_pk_bf16_f32 v76, v76, v77
    v_cvt_pk_bf16_f32 v77, v78, v79
    ds_wrxchg_rtn_b64 v[72:73], v94, v[76:77] offset:65408
    s_setprio 0
    v_mfma_f32_4x4x4_16b_bf16 v[80:83], v[8:9], v[102:103], 0
    v_mfma_f32_4x4x4_16b_bf16 v[76:79], v[8:9], v[100:101], 0
    v_cmp_lt_u32 s[48:49], v5, v93
    s_nop 2
    v_pk_mul_f32 v[80:81], v[80:81], v[14:15] op_sel:[0,1] op_sel_hi:[1,1]
    v_pk_mul_f32 v[82:83], v[82:83], v[14:15] op_sel:[0,1] op_sel_hi:[1,1]
    v_pk_mul_f32 v[76:77], v[76:77], v[14:15] op_sel:[0,0] op_sel_hi:[1,0]
    v_pk_mul_f32 v[78:79], v[78:79], v[14:15] op_sel:[0,0] op_sel_hi:[1,0]
    s_add_u32 s40, s40, 0xfff24000
    v_and_b32 v47, 0x0fffffff, v42
    buffer_load_dword v30, v47, s[8:11], 0 offen offset:16
    s_mov_b64 exec, s[6:7]
    v_add_u32 v47, 8, v47
    v_lshrrev_b32 v42, 2, v42
    s_mov_b64 exec, -1
    buffer_load_dwordx2 v[28:29], v47, s[8:11], 0 offen
    s_waitcnt vmcnt(8)
    v_and_b32 v46, 0x80000000, v39
    v_lshrrev_b32 v47, 14, v37
    v_bitop3_b32 v47, v47, v5, v46 bitop3:0xea
    ds_read_b64 v[102:103], v47
    v_and_b32 v99, 0x40000000, v39
    v_lshrrev_b32 v47, 14, v36
    v_bitop3_b32 v47, v47, v5, v99 bitop3:0xea
    ds_read_b64 v[100:101], v47
    v_and_b32 v46, 0x20000000, v39
    v_lshrrev_b32 v47, 14, v35
    v_bitop3_b32 v47, v47, v5, v46 bitop3:0xea
    ds_read_b64 v[106:107], v47
    v_and_b32 v99, 0x10000000, v39
    v_lshrrev_b32 v47, 14, v34
    v_bitop3_b32 v47, v47, v5, v99 bitop3:0xea
    ds_read_b64 v[104:105], v47
    s_waitcnt lgkmcnt(4)
    v_cmp_ne_u64 s[50:51], v[72:73], v[68:69]
    v_cmpx_ne_u64 s[54:55], v[74:75], v[70:71]
    s_and_b64 s[82:83], s[54:55], s[80:81]
    s_cbranch_scc1 L2_c130
L2_d130:
    v_mov_b64 v[84:85], v[70:71]
    v_mov_b32 v7, v95
    v_mov_b64 v[86:87], v[74:75]
    s_or_b64 s[80:81], s[80:81], s[54:55]
    s_mov_b64 exec, s[50:51]
    s_and_b64 s[82:83], s[50:51], s[80:81]
    s_cbranch_scc1 L2_c131
L2_d131:
    v_mov_b64 v[84:85], v[68:69]
    v_mov_b32 v7, v94
    v_mov_b64 v[86:87], v[72:73]
    s_mov_b64 exec, -1
    s_or_b64 s[80:81], s[80:81], s[50:51]
    s_and_b64 exec, s[48:49], s[80:81]
    v_mfma_f32_4x4x4_16b_bf16 v[80:83], v[12:13], v[84:85], 0
    v_mov_b32 v93, v7
    s_andn2_b64 s[80:81], s[80:81], s[48:49]
    v_mfma_f32_4x4x4_16b_bf16 v[80:83], v[10:11], v[86:87], v[80:83]
    s_mov_b64 exec, -1
    ds_read_b64 v[70:71], v93 offset:65408
    ds_read_b64 v[68:69], v92 offset:65408
    v_bitop3_b32 v94, v34, v5, v99 bitop3:0xea
    v_bitop3_b32 v95, v35, v5, v46 bitop3:0xea
    v_perm_b32 v15, v35, v38, s45
    v_bitop3_b32 v46, v35, 0.5, -0.5 bitop3:0xa8
    v_perm_b32 v14, v34, v38, s44
    v_bitop3_b32 v47, v34, 0.5, -0.5 bitop3:0xa8
    v_bitop3_b32 v15, v6, v15, v46 bitop3:0xca
    v_bitop3_b32 v14, v6, v14, v47 bitop3:0xca
    s_waitcnt lgkmcnt(1)
    v_mfma_f32_4x4x4_16b_bf16 v[80:83], v[10:11], v[70:71], v[80:83]
    s_waitcnt lgkmcnt(0)
    v_mfma_f32_4x4x4_16b_bf16 v[76:79], v[10:11], v[68:69], v[76:79]
    s_nop 2
    v_cvt_pk_bf16_f32 v80, v80, v81
    v_cvt_pk_bf16_f32 v81, v82, v83
    ds_wrxchg_rtn_b64 v[74:75], v93, v[80:81] offset:65408
    v_cvt_pk_bf16_f32 v76, v76, v77
    v_cvt_pk_bf16_f32 v77, v78, v79
    ds_wrxchg_rtn_b64 v[72:73], v92, v[76:77] offset:65408
    s_barrier
    s_setprio 3
    s_mov_b32 m0, s100
    s_nop 0
    ds_write_addtid_b32 v124 offset:34816
    ds_write_addtid_b32 v125 offset:35072
    ds_write_addtid_b32 v126 offset:35328
    ds_write_addtid_b32 v127 offset:35584
    ds_write_addtid_b32 v116 offset:32768
    ds_write_addtid_b32 v117 offset:33024
    ds_write_addtid_b32 v118 offset:33280
    ds_write_addtid_b32 v119 offset:33536
    ds_write_addtid_b32 v120 offset:33792
    ds_write_addtid_b32 v121 offset:34048
    ds_write_addtid_b32 v122 offset:34304
    ds_write_addtid_b32 v123 offset:34560
    v_mfma_f32_4x4x4_16b_bf16 v[80:83], v[8:9], v[106:107], 0
    v_mfma_f32_4x4x4_16b_bf16 v[76:79], v[8:9], v[104:105], 0
    s_nop 3
    v_pk_mul_f32 v[80:81], v[80:81], v[14:15] op_sel:[0,1] op_sel_hi:[1,1]
    v_pk_mul_f32 v[82:83], v[82:83], v[14:15] op_sel:[0,1] op_sel_hi:[1,1]
    v_pk_mul_f32 v[76:77], v[76:77], v[14:15] op_sel:[0,0] op_sel_hi:[1,0]
    v_pk_mul_f32 v[78:79], v[78:79], v[14:15] op_sel:[0,0] op_sel_hi:[1,0]
    s_setprio 2
    s_waitcnt lgkmcnt(12)
    v_cmp_ne_u64 s[50:51], v[72:73], v[68:69]
    v_cmpx_ne_u64 s[54:55], v[74:75], v[70:71]
    s_and_b64 s[82:83], s[54:55], s[80:81]
    s_cbranch_scc1 L2_c132
L2_d132:
    v_mov_b64 v[84:85], v[70:71]
    v_mov_b32 v7, v93
    v_mov_b64 v[86:87], v[74:75]
    s_or_b64 s[80:81], s[80:81], s[54:55]
    s_mov_b64 exec, s[50:51]
    s_and_b64 s[82:83], s[50:51], s[80:81]
    s_cbranch_scc1 L2_c133
L2_d133:
    v_mov_b64 v[84:85], v[68:69]
    v_mov_b32 v7, v92
    v_mov_b64 v[86:87], v[72:73]
    s_mov_b64 exec, -1
    s_or_b64 s[80:81], s[80:81], s[50:51]
    ds_read_b64 v[70:71], v95 offset:65408
    ds_read_b64 v[68:69], v94 offset:65408
    v_and_b32 v46, 0x40000000, v39
    v_bitop3_b32 v92, v36, v5, v46 bitop3:0xea
    v_and_b32 v46, 0x80000000, v39
    v_bitop3_b32 v93, v37, v5, v46 bitop3:0xea
    v_perm_b32 v15, v37, v38, s47
    v_bitop3_b32 v46, v37, 0.5, -0.5 bitop3:0xa8
    v_perm_b32 v14, v36, v38, s46
    v_bitop3_b32 v47, v36, 0.5, -0.5 bitop3:0xa8
    v_bitop3_b32 v15, v6, v15, v46 bitop3:0xca
    v_bitop3_b32 v14, v6, v14, v47 bitop3:0xca
    s_setprio 1
    s_waitcnt lgkmcnt(1)
    v_mfma_f32_4x4x4_16b_bf16 v[80:83], v[10:11], v[70:71], v[80:83]
    s_waitcnt lgkmcnt(0)
    v_mfma_f32_4x4x4_16b_bf16 v[76:79], v[10:11], v[68:69], v[76:79]
    s_nop 2
    v_cvt_pk_bf16_f32 v80, v80, v81
    v_cvt_pk_bf16_f32 v81, v82, v83
    ds_wrxchg_rtn_b64 v[74:75], v95, v[80:81] offset:65408
    v_cvt_pk_bf16_f32 v76, v76, v77
    v_cvt_pk_bf16_f32 v77, v78, v79
    ds_wrxchg_rtn_b64 v[72:73], v94, v[76:77] offset:65408
    v_and_b32 v88, 0x0fffffff, v43
    buffer_load_dwordx2 v[34:35], v88, s[8:11], 0 offen
    buffer_load_dwordx3 v[36:38], v88, s[8:11], 0 offen offset:8
    s_setprio 0
    s_waitcnt vmcnt(9)
    s_mov_b32 m0, s38
    s_nop 0
    ds_write_addtid_b32 v108 offset:0
    ds_write_addtid_b32 v109 offset:256
    ds_write_addtid_b32 v110 offset:512
    ds_write_addtid_b32 v111 offset:768
    s_waitcnt vmcnt(6)
    ds_write_addtid_b32 v112 offset:1024
    ds_write_addtid_b32 v113 offset:1280
    ds_write_addtid_b32 v114 offset:1536
    ds_write_addtid_b32 v115 offset:1792
    v_mfma_f32_4x4x4_16b_bf16 v[80:83], v[8:9], v[102:103], 0
    v_mfma_f32_4x4x4_16b_bf16 v[76:79], v[8:9], v[100:101], 0
    v_cmp_lt_u32 s[84:85], v5, v92
    s_nop 2
    v_pk_mul_f32 v[80:81], v[80:81], v[14:15] op_sel:[0,1] op_sel_hi:[1,1]
    v_pk_mul_f32 v[82:83], v[82:83], v[14:15] op_sel:[0,1] op_sel_hi:[1,1]
    v_pk_mul_f32 v[76:77], v[76:77], v[14:15] op_sel:[0,0] op_sel_hi:[1,0]
    v_pk_mul_f32 v[78:79], v[78:79], v[14:15] op_sel:[0,0] op_sel_hi:[1,0]
    s_add_u32 s42, s42, 1
    s_waitcnt lgkmcnt(0)
    s_barrier
    s_bitcmp1_b32 s36, s42
    s_cbranch_scc1 L2_slow
L2_ret7:
    s_setprio 3
    s_bitcmp1_b32 s43, s42
    s_cbranch_scc1 L2_oa134
L2_ob134:
    v_and_b32 v46, 0x20000000, v40
    v_lshrrev_b32 v47, 14, v17
    v_bitop3_b32 v47, v47, v5, v46 bitop3:0xea
    ds_read_b64 v[106:107], v47
    v_and_b32 v99, 0x10000000, v40
    v_lshrrev_b32 v47, 14, v16
    v_bitop3_b32 v47, v47, v5, v99 bitop3:0xea
    ds_read_b64 v[104:105], v47
    v_cmp_ne_u64 s[50:51], v[72:73], v[68:69]
    v_cmpx_ne_u64 s[54:55], v[74:75], v[70:71]
    s_and_b64 s[82:83], s[54:55], s[80:81]
    s_cbranch_scc1 L2_c135
L2_d135:
    v_mov_b64 v[84:85], v[70:71]
    v_mov_b32 v7, v95
    v_mov_b64 v[86:87], v[74:75]
    s_or_b64 s[80:81], s[80:81], s[54:55]
    s_mov_b64 exec, s[50:51]
    s_and_b64 s[82:83], s[50:51], s[80:81]
    s_cbranch_scc1 L2_c136
L2_d136:
    v_mov_b64 v[84:85], v[68:69]
    v_mov_b32 v7, v94
    v_mov_b64 v[86:87], v[72:73]
    s_mov_b64 exec, -1
    s_or_b64 s[80:81], s[80:81], s[50:51]
    s_and_b64 exec, s[84:85], s[80:81]
    v_mfma_f32_4x4x4_16b_bf16 v[76:79], v[12:13], v[84:85], 0
    v_mov_b32 v92, v7
    s_andn2_b64 s[80:81], s[80:81], s[84:85]
    v_mfma_f32_4x4x4_16b_bf16 v[76:79], v[10:11], v[86:87], v[76:79]
    s_mov_b64 exec, -1
    ds_read_b64 v[70:71], v93 offset:65408
    ds_read_b64 v[68:69], v92 offset:65408
    v_bitop3_b32 v94, v16, v5, v99 bitop3:0xea
    v_bitop3_b32 v95, v17, v5, v46 bitop3:0xea
    v_perm_b32 v15, v17, v20, s45
    v_bitop3_b32 v46, v17, 0.5, -0.5 bitop3:0xa8
    v_perm_b32 v14, v16, v20, s44
    v_bitop3_b32 v47, v16, 0.5, -0.5 bitop3:0xa8
    v_bitop3_b32 v15, v6, v15, v46 bitop3:0xca
    v_bitop3_b32 v14, v6, v14, v47 bitop3:0xca
    s_waitcnt lgkmcnt(1)
    v_mfma_f32_4x4x4_16b_bf16 v[80:83], v[10:11], v[70:71], v[80:83]
    s_waitcnt lgkmcnt(0)
    v_mfma_f32_4x4x4_16b_bf16 v[76:79], v[10:11], v[68:69], v[76:79]
    s_nop 2
    v_cvt_pk_bf16_f32 v80, v80, v81
    v_cvt_pk_bf16_f32 v81, v82, v83
    ds_wrxchg_rtn_b64 v[74:75], v93, v[80:81] offset:65408
    v_cvt_pk_bf16_f32 v76, v76, v77
    v_cvt_pk_bf16_f32 v77, v78, v79
    ds_wrxchg_rtn_b64 v[72:73], v92, v[76:77] offset:65408
    v_mfma_f32_4x4x4_16b_bf16 v[80:83], v[8:9], v[106:107], 0
    v_mfma_f32_4x4x4_16b_bf16 v[76:79], v[8:9], v[104:105], 0
    v_cmp_lt_u32 s[84:85], v5, v94
    s_nop 2
    v_pk_mul_f32 v[80:81], v[80:81], v[14:15] op_sel:[0,1] op_sel_hi:[1,1]
    v_pk_mul_f32 v[82:83], v[82:83], v[14:15] op_sel:[0,1] op_sel_hi:[1,1]
    v_pk_mul_f32 v[76:77], v[76:77], v[14:15] op_sel:[0,0] op_sel_hi:[1,0]
    v_pk_mul_f32 v[78:79], v[78:79], v[14:15] op_sel:[0,0] op_sel_hi:[1,0]
    v_and_b32 v46, 0x80000000, v40
    v_lshrrev_b32 v47, 14, v19
    v_bitop3_b32 v47, v47, v5, v46 bitop3:0xea
    ds_read_b64 v[102:103], v47
    v_and_b32 v99, 0x40000000, v40
    v_lshrrev_b32 v47, 14, v18
    v_bitop3_b32 v47, v47, v5, v99 bitop3:0xea
    ds_read_b64 v[100:101], v47
    s_waitcnt lgkmcnt(2)
    v_cmp_ne_u64 s[50:51], v[72:73], v[68:69]
    v_cmpx_ne_u64 s[54:55], v[74:75], v[70:71]
    s_and_b64 s[82:83], s[54:55], s[80:81]
    s_cbranch_scc1 L2_c137
L2_d137:
    v_mov_b64 v[84:85], v[70:71]
    v_mov_b32 v7, v93
    v_mov_b64 v[86:87], v[74:75]
    s_or_b64 s[80:81], s[80:81], s[54:55]
    s_mov_b64 exec, s[50:51]
    s_and_b64 s[82:83], s[50:51], s[80:81]
    s_cbranch_scc1 L2_c138
L2_d138:
    v_mov_b64 v[84:85], v[68:69]
    v_mov_b32 v7, v92
    v_mov_b64 v[86:87], v[72:73]
    s_mov_b64 exec, -1
    s_or_b64 s[80:81], s[80:81], s[50:51]
    s_and_b64 exec, s[84:85], s[80:81]
    v_mfma_f32_4x4x4_16b_bf16 v[76:79], v[12:13], v[84:85], 0
    v_mov_b32 v94, v7
    s_andn2_b64 s[80:81], s[80:81], s[84:85]
    v_mfma_f32_4x4x4_16b_bf16 v[76:79], v[10:11], v[86:87], v[76:79]
    s_mov_b64 exec, -1
    ds_read_b64 v[70:71], v95 offset:65408
    ds_read_b64 v[68:69], v94 offset:65408
    v_bitop3_b32 v92, v18, v5, v99 bitop3:0xea
    v_bitop3_b32 v93, v19, v5, v46 bitop3:0xea
    v_perm_b32 v15, v19, v20, s47
    v_bitop3_b32 v46, v19, 0.5, -0.5 bitop3:0xa8
    v_perm_b32 v14, v18, v20, s46
    v_bitop3_b32 v47, v18, 0.5, -0.5 bitop3:0xa8
    v_bitop3_b32 v15, v6, v15, v46 bitop3:0xca
    v_bitop3_b32 v14, v6, v14, v47 bitop3:0xca
    s_waitcnt lgkmcnt(1)
    v_mfma_f32_4x4x4_16b_bf16 v[80:83], v[10:11], v[70:71], v[80:83]
    s_waitcnt lgkmcnt(0)
    v_mfma_f32_4x4x4_16b_bf16 v[76:79], v[10:11], v[68:69], v[76:79]
    s_nop 2
    v_cvt_pk_bf16_f32 v80, v80, v81
    v_cvt_pk_bf16_f32 v81, v82, v83
    ds_wrxchg_rtn_b64 v[74:75], v95, v[80:81] offset:65408
    v_cvt_pk_bf16_f32 v76, v76, v77
    v_cvt_pk_bf16_f32 v77, v78, v79
    ds_wrxchg_rtn_b64 v[72:73], v94, v[76:77] offset:65408
    s_setprio 2
    v_mfma_f32_4x4x4_16b_bf16 v[80:83], v[8:9], v[102:103], 0
    v_mfma_f32_4x4x4_16b_bf16 v[76:79], v[8:9], v[100:101], 0
    v_cmp_lt_u32 s[48:49], v5, v93
    s_nop 2
    v_pk_mul_f32 v[80:81], v[80:81], v[14:15] op_sel:[0,1] op_sel_hi:[1,1]
    v_pk_mul_f32 v[82:83], v[82:83], v[14:15] op_sel:[0,1] op_sel_hi:[1,1]
    v_pk_mul_f32 v[76:77], v[76:77], v[14:15] op_sel:[0,0] op_sel_hi:[1,0]
    v_pk_mul_f32 v[78:79], v[78:79], v[14:15] op_sel:[0,0] op_sel_hi:[1,0]
    s_waitcnt vmcnt(4)
    v_and_b32 v46, 0x20000000, v41
    v_lshrrev_b32 v47, 14, v23
    v_bitop3_b32 v47, v47, v5, v46 bitop3:0xea
    ds_read_b64 v[106:107], v47
    v_and_b32 v99, 0x10000000, v41
    v_lshrrev_b32 v47, 14, v22
    v_bitop3_b32 v47, v47, v5, v99 bitop3:0xea
    ds_read_b64 v[104:105], v47
    s_waitcnt lgkmcnt(2)
    v_cmp_ne_u64 s[50:51], v[72:73], v[68:69]
    v_cmpx_ne_u64 s[54:55], v[74:75], v[70:71]
    s_and_b64 s[82:83], s[54:55], s[80:81]
    s_cbranch_scc1 L2_c139
L2_d139:
    v_mov_b64 v[84:85], v[70:71]
    v_mov_b32 v7, v95
    v_mov_b64 v[86:87], v[74:75]
    s_or_b64 s[80:81], s[80:81], s[54:55]
    s_mov_b64 exec, s[50:51]
    s_and_b64 s[82:83], s[50:51], s[80:81]
    s_cbranch_scc1 L2_c140
L2_d140:
    v_mov_b64 v[84:85], v[68:69]
    v_mov_b32 v7, v94
    v_mov_b64 v[86:87], v[72:73]
    s_mov_b64 exec, -1
    s_or_b64 s[80:81], s[80:81], s[50:51]
    s_and_b64 exec, s[48:49], s[80:81]
    v_mfma_f32_4x4x4_16b_bf16 v[80:83], v[12:13], v[84:85], 0
    v_mov_b32 v93, v7
    s_andn2_b64 s[80:81], s[80:81], s[48:49]
    v_mfma_f32_4x4x4_16b_bf16 v[80:83], v[10:11], v[86:87], v[80:83]
    s_mov_b64 exec, -1
    ds_read_b64 v[70:71], v93 offset:65408
    ds_read_b64 v[68:69], v92 offset:65408
    v_bitop3_b32 v94, v22, v5, v99 bitop3:0xea
    v_bitop3_b32 v95, v23, v5, v46 bitop3:0xea
    v_perm_b32 v15, v23, v26, s45
    v_bitop3_b32 v46, v23, 0.5, -0.5 bitop3:0xa8
    v_perm_b32 v14, v22, v26, s44
    v_bitop3_b32 v47, v22, 0.5, -0.5 bitop3:0xa8
    v_bitop3_b32 v15, v6, v15, v46 bitop3:0xca
    v_bitop3_b32 v14, v6, v14, v47 bitop3:0xca
    s_waitcnt lgkmcnt(1)
    v_mfma_f32_4x4x4_16b_bf16 v[80:83], v[10:11], v[70:71], v[80:83]
    s_waitcnt lgkmcnt(0)
    v_mfma_f32_4x4x4_16b_bf16 v[76:79], v[10:11], v[68:69], v[76:79]
    s_nop 2
    v_cvt_pk_bf16_f32 v80, v80, v81
    v_cvt_pk_bf16_f32 v81, v82, v83
    ds_wrxchg_rtn_b64 v[74:75], v93, v[80:81] offset:65408
    v_cvt_pk_bf16_f32 v76, v76, v77
    v_cvt_pk_bf16_f32 v77, v78, v79
    ds_wrxchg_rtn_b64 v[72:73], v92, v[76:77] offset:65408
    s_setprio 1
    v_mfma_f32_4x4x4_16b_bf16 v[80:83], v[8:9], v[106:107], 0
    v_mfma_f32_4x4x4_16b_bf16 v[76:79], v[8:9], v[104:105], 0
    s_nop 3
    v_pk_mul_f32 v[80:81], v[80:81], v[14:15] op_sel:[0,1] op_sel_hi:[1,1]
    v_pk_mul_f32 v[82:83], v[82:83], v[14:15] op_sel:[0,1] op_sel_hi:[1,1]
    v_pk_mul_f32 v[76:77], v[76:77], v[14:15] op_sel:[0,0] op_sel_hi:[1,0]
    v_pk_mul_f32 v[78:79], v[78:79], v[14:15] op_sel:[0,0] op_sel_hi:[1,0]
    s_bitcmp1_b32 s43, s42
    s_cbranch_scc1 L2_oa141
L2_ob141:
    v_and_b32 v46, 0x80000000, v41
    v_lshrrev_b32 v47, 14, v25
    v_bitop3_b32 v47, v47, v5, v46 bitop3:0xea
    ds_read_b64 v[102:103], v47
    v_and_b32 v99, 0x40000000, v41
    v_lshrrev_b32 v47, 14, v24
    v_bitop3_b32 v47, v47, v5, v99 bitop3:0xea
    ds_read_b64 v[100:101], v47
    s_waitcnt lgkmcnt(2)
    v_cmp_ne_u64 s[50:51], v[72:73], v[68:69]
    v_cmpx_ne_u64 s[54:55], v[74:75], v[70:71]
    s_and_b64 s[82:83], s[54:55], s[80:81]
    s_cbranch_scc1 L2_c142
L2_d142:
    v_mov_b64 v[84:85], v[70:71]
    v_mov_b32 v7, v93
    v_mov_b64 v[86:87], v[74:75]
    s_or_b64 s[80:81], s[80:81], s[54:55]
    s_mov_b64 exec, s[50:51]
    s_and_b64 s[82:83], s[50:51], s[80:81]
    s_cbranch_scc1 L2_c143
L2_d143:
    v_mov_b64 v[84:85], v[68:69]
    v_mov_b32 v7, v92
    v_mov_b64 v[86:87], v[72:73]
    s_mov_b64 exec, -1
    s_or_b64 s[80:81], s[80:81], s[50:51]
    ds_read_b64 v[70:71], v95 offset:65408
    ds_read_b64 v[68:69], v94 offset:65408
    v_bitop3_b32 v92, v24, v5, v99 bitop3:0xea
    v_bitop3_b32 v93, v25, v5, v46 bitop3:0xea
    v_perm_b32 v15, v25, v26, s47
    v_bitop3_b32 v46, v25, 0.5, -0.5 bitop3:0xa8
    v_perm_b32 v14, v24, v26, s46
    v_bitop3_b32 v47, v24, 0.5, -0.5 bitop3:0xa8
    v_bitop3_b32 v15, v6, v15, v46 bitop3:0xca
    v_bitop3_b32 v14, v6, v14, v47 bitop3:0xca
    s_waitcnt lgkmcnt(1)
    v_mfma_f32_4x4x4_16b_bf16 v[80:83], v[10:11], v[70:71], v[80:83]
    s_waitcnt lgkmcnt(0)
    v_mfma_f32_4x4x4_16b_bf16 v[76:79], v[10:11], v[68:69], v[76:79]
    s_nop 2
    v_cvt_pk_bf16_f32 v80, v80, v81
    v_cvt_pk_bf16_f32 v81, v82, v83
    ds_wrxchg_rtn_b64 v[74:75], v95, v[80:81] offset:65408
    v_cvt_pk_bf16_f32 v76, v76, v77
    v_cvt_pk_bf16_f32 v77, v78, v79
    ds_wrxchg_rtn_b64 v[72:73], v94, v[76:77] offset:65408
    v_mfma_f32_4x4x4_16b_bf16 v[80:83], v[8:9], v[102:103], 0
    v_mfma_f32_4x4x4_16b_bf16 v[76:79], v[8:9], v[100:101], 0
    v_cmp_lt_u32 s[84:85], v5, v92
    s_nop 2
    v_pk_mul_f32 v[80:81], v[80:81], v[14:15] op_sel:[0,1] op_sel_hi:[1,1]
    v_pk_mul_f32 v[82:83], v[82:83], v[14:15] op_sel:[0,1] op_sel_hi:[1,1]
    v_pk_mul_f32 v[76:77], v[76:77], v[14:15] op_sel:[0,0] op_sel_hi:[1,0]
    v_pk_mul_f32 v[78:79], v[78:79], v[14:15] op_sel:[0,0] op_sel_hi:[1,0]
    s_lshl_b32 s3, s32, 12
    v_subrev_u32 v122, s3, v3
    s_mul_i32 s3, s33, 20000
    v_add_u32 v118, s3, v122
    v_add_u32 v119, 0x4000, v118
    s_lshl_b32 s3, s34, 7
    v_lshrrev_b32 v123, 7, v118
    v_and_b32 v120, 0x70, v118
    v_lshl_add_u32 v120, v123, 13, v120
    v_add_u32 v120, s3, v120
    v_lshrrev_b32 v123, 7, v119
    v_and_b32 v121, 0x70, v119
    v_lshl_add_u32 v121, v123, 13, v121
    v_add_u32 v121, s3, v121
    v_cmp_le_u32 vcc, 3616, v122
    s_mov_b64 exec, vcc
    v_mov_b32 v119, 2.0
    v_mov_b32 v121, 2.0
    s_mov_b64 exec, -1
    v_and_b32 v123, 0x30, v122
    v_lshlrev_b32 v123, 2, v123
    buffer_load_dwordx4 v[48:51], v123, s[24:27], 0 offen
    buffer_load_dwordx4 v[52:55], v123, s[24:27], 0 offen offset:16
    buffer_load_dwordx2 v[56:57], v123, s[24:27], 0 offen offset:32
    s_mov_b32 s12, s4
    s_mov_b32 s13, s5
    s_mov_b32 s14, 0x138800
    s_mov_b32 s15, 0x20000
    s_mov_b32 s16, s28
    s_mov_b32 s17, s29
    s_mov_b32 s18, 0x4e2000
    s_mov_b32 s19, 0x20000
    v_lshrrev_b32 v123, 2, v120
    buffer_load_dword v116, v123, s[12:15], 0 offen
    buffer_load_dwordx4 v[108:111], v120, s[16:19], 0 offen
    v_lshrrev_b32 v123, 2, v121
    buffer_load_dword v117, v123, s[12:15], 0 offen
    buffer_load_dwordx4 v[112:115], v121, s[16:19], 0 offen
    s_waitcnt vmcnt(9)
    s_mov_b64 exec, s[6:7]
    v_lshrrev_b32 v30, 16, v30
    s_mov_b64 exec, -1
    v_and_b32 v46, 0x20000000, v42
    v_lshrrev_b32 v47, 14, v29
    v_bitop3_b32 v47, v47, v5, v46 bitop3:0xea
    ds_read_b64 v[106:107], v47
    v_and_b32 v99, 0x10000000, v42
    v_lshrrev_b32 v47, 14, v28
    v_bitop3_b32 v47, v47, v5, v99 bitop3:0xea
    ds_read_b64 v[104:105], v47
    s_waitcnt lgkmcnt(2)
    v_cmp_ne_u64 s[50:51], v[72:73], v[68:69]
    v_cmpx_ne_u64 s[54:55], v[74:75], v[70:71]
    s_and_b64 s[82:83], s[54:55], s[80:81]
    s_cbranch_scc1 L2_c144
L2_d144:
    v_mov_b64 v[84:85], v[70:71]
    v_mov_b32 v7, v95
    v_mov_b64 v[86:87], v[74:75]
    s_or_b64 s[80:81], s[80:81], s[54:55]
    s_mov_b64 exec, s[50:51]
    s_and_b64 s[82:83], s[50:51], s[80:81]
    s_cbranch_scc1 L2_c145
L2_d145:
    v_mov_b64 v[84:85], v[68:69]
    v_mov_b32 v7, v94
    v_mov_b64 v[86:87], v[72:73]
    s_mov_b64 exec, -1
    s_or_b64 s[80:81], s[80:81], s[50:51]
    s_and_b64 exec, s[84:85], s[80:81]
    v_mfma_f32_4x4x4_16b_bf16 v[76:79], v[12:13], v[84:85], 0
    v_mov_b32 v92, v7
    s_andn2_b64 s[80:81], s[80:81], s[84:85]
    v_mfma_f32_4x4x4_16b_bf16 v[76:79], v[10:11], v[86:87], v[76:79]
    s_mov_b64 exec, -1
    ds_read_b64 v[70:71], v93 offset:65408
    ds_read_b64 v[68:69], v92 offset:65408
    v_bitop3_b32 v94, v28, v5, v99 bitop3:0xea
    v_bitop3_b32 v95, v29, v5, v46 bitop3:0xea
    v_perm_b32 v15, v29, v30, s45
    v_bitop3_b32 v46, v29, 0.5, -0.5 bitop3:0xa8
    v_perm_b32 v14, v28, v30, s44
    v_bitop3_b32 v47, v28, 0.5, -0.5 bitop3:0xa8
    v_bitop3_b32 v15, v6, v15, v46 bitop3:0xca
    v_bitop3_b32 v14, v6, v14, v47 bitop3:0xca
    s_waitcnt lgkmcnt(1)
    v_mfma_f32_4x4x4_16b_bf16 v[80:83], v[10:11], v[70:71], v[80:83]
    s_waitcnt lgkmcnt(0)
    v_mfma_f32_4x4x4_16b_bf16 v[76:79], v[10:11], v[68:69], v[76:79]
    s_nop 2
    v_cvt_pk_bf16_f32 v80, v80, v81
    v_cvt_pk_bf16_f32 v81, v82, v83
    ds_wrxchg_rtn_b64 v[74:75], v93, v[80:81] offset:65408
    v_cvt_pk_bf16_f32 v76, v76, v77
    v_cvt_pk_bf16_f32 v77, v78, v79
    ds_wrxchg_rtn_b64 v[72:73], v92, v[76:77] offset:65408
    s_setprio 0
    v_mfma_f32_4x4x4_16b_bf16 v[80:83], v[8:9], v[106:107], 0
    v_mfma_f32_4x4x4_16b_bf16 v[76:79], v[8:9], v[104:105], 0
    v_cmp_lt_u32 s[48:49], v5, v95
    s_nop 2
    v_pk_mul_f32 v[80:81], v[80:81], v[14:15] op_sel:[0,1] op_sel_hi:[1,1]
    v_pk_mul_f32 v[82:83], v[82:83], v[14:15] op_sel:[0,1] op_sel_hi:[1,1]
    v_pk_mul_f32 v[76:77], v[76:77], v[14:15] op_sel:[0,0] op_sel_hi:[1,0]
    v_pk_mul_f32 v[78:79], v[78:79], v[14:15] op_sel:[0,0] op_sel_hi:[1,0]
    s_waitcnt vmcnt(7)
    v_and_b32 v46, 0x80000000, v43
    v_lshrrev_b32 v47, 14, v37
    v_bitop3_b32 v47, v47, v5, v46 bitop3:0xea
    ds_read_b64 v[106:107], v47
    v_and_b32 v99, 0x40000000, v43
    v_lshrrev_b32 v47, 14, v36
    v_bitop3_b32 v47, v47, v5, v99 bitop3:0xea
    ds_read_b64 v[104:105], v47
    v_and_b32 v46, 0x20000000, v43
    v_lshrrev_b32 v47, 14, v35
    v_bitop3_b32 v47, v47, v5, v46 bitop3:0xea
    ds_read_b64 v[102:103], v47
    v_and_b32 v99, 0x10000000, v43
    v_lshrrev_b32 v47, 14, v34
    v_bitop3_b32 v47, v47, v5, v99 bitop3:0xea
    ds_read_b64 v[100:101], v47
    s_waitcnt lgkmcnt(4)
    v_cmp_ne_u64 s[50:51], v[72:73], v[68:69]
    v_cmpx_ne_u64 s[54:55], v[74:75], v[70:71]
    s_and_b64 s[82:83], s[54:55], s[80:81]
    s_cbranch_scc1 L2_c146
L2_d146:
    v_mov_b64 v[84:85], v[70:71]
    v_mov_b32 v7, v93
    v_mov_b64 v[86:87], v[74:75]
    s_or_b64 s[80:81], s[80:81], s[54:55]
    s_mov_b64 exec, s[50:51]
    s_and_b64 s[82:83], s[50:51], s[80:81]
    s_cbranch_scc1 L2_c147
L2_d147:
    v_mov_b64 v[84:85], v[68:69]
    v_mov_b32 v7, v92
    v_mov_b64 v[86:87], v[72:73]
    s_mov_b64 exec, -1
    s_or_b64 s[80:81], s[80:81], s[50:51]
    s_and_b64 exec, s[48:49], s[80:81]
    v_mfma_f32_4x4x4_16b_bf16 v[80:83], v[12:13], v[84:85], 0
    v_mov_b32 v95, v7
    s_andn2_b64 s[80:81], s[80:81], s[48:49]
    v_mfma_f32_4x4x4_16b_bf16 v[80:83], v[10:11], v[86:87], v[80:83]
    s_mov_b64 exec, -1
    ds_read_b64 v[70:71], v95 offset:65408
    ds_read_b64 v[68:69], v94 offset:65408
    v_bitop3_b32 v92, v34, v5, v99 bitop3:0xea
    v_bitop3_b32 v93, v35, v5, v46 bitop3:0xea
    v_perm_b32 v15, v35, v38, s45
    v_bitop3_b32 v46, v35, 0.5, -0.5 bitop3:0xa8
    v_perm_b32 v14, v34, v38, s44
    v_bitop3_b32 v47, v34, 0.5, -0.5 bitop3:0xa8
    v_bitop3_b32 v15, v6, v15, v46 bitop3:0xca
    v_bitop3_b32 v14, v6, v14, v47 bitop3:0xca
    s_waitcnt lgkmcnt(1)
    v_mfma_f32_4x4x4_16b_bf16 v[80:83], v[10:11], v[70:71], v[80:83]
    s_waitcnt lgkmcnt(0)
    v_mfma_f32_4x4x4_16b_bf16 v[76:79], v[10:11], v[68:69], v[76:79]
    s_nop 2
    v_cvt_pk_bf16_f32 v80, v80, v81
    v_cvt_pk_bf16_f32 v81, v82, v83
    ds_wrxchg_rtn_b64 v[74:75], v95, v[80:81] offset:65408
    v_cvt_pk_bf16_f32 v76, v76, v77
    v_cvt_pk_bf16_f32 v77, v78, v79
    ds_wrxchg_rtn_b64 v[72:73], v94, v[76:77] offset:65408
    v_mfma_f32_4x4x4_16b_bf16 v[80:83], v[8:9], v[102:103], 0
    v_mfma_f32_4x4x4_16b_bf16 v[76:79], v[8:9], v[100:101], 0
    s_nop 3
    v_pk_mul_f32 v[80:81], v[80:81], v[14:15] op_sel:[0,1] op_sel_hi:[1,1]
    v_pk_mul_f32 v[82:83], v[82:83], v[14:15] op_sel:[0,1] op_sel_hi:[1,1]
    v_pk_mul_f32 v[76:77], v[76:77], v[14:15] op_sel:[0,0] op_sel_hi:[1,0]
    v_pk_mul_f32 v[78:79], v[78:79], v[14:15] op_sel:[0,0] op_sel_hi:[1,0]
    s_waitcnt lgkmcnt(0)
    v_cmp_ne_u64 s[50:51], v[72:73], v[68:69]
    v_cmpx_ne_u64 s[54:55], v[74:75], v[70:71]
    s_and_b64 s[82:83], s[54:55], s[80:81]
    s_cbranch_scc1 L2_c148
L2_d148:
    v_mov_b64 v[84:85], v[70:71]
    v_mov_b32 v7, v95
    v_mov_b64 v[86:87], v[74:75]
    s_or_b64 s[80:81], s[80:81], s[54:55]
    s_mov_b64 exec, s[50:51]
    s_and_b64 s[82:83], s[50:51], s[80:81]
    s_cbranch_scc1 L2_c149
L2_d149:
    v_mov_b64 v[84:85], v[68:69]
    v_mov_b32 v7, v94
    v_mov_b64 v[86:87], v[72:73]
    s_mov_b64 exec, -1
    s_or_b64 s[80:81], s[80:81], s[50:51]
    ds_read_b64 v[70:71], v93 offset:65408
    ds_read_b64 v[68:69], v92 offset:65408
    v_and_b32 v46, 0x40000000, v43
    v_bitop3_b32 v94, v36, v5, v46 bitop3:0xea
    v_and_b32 v46, 0x80000000, v43
    v_bitop3_b32 v95, v37, v5, v46 bitop3:0xea
    v_perm_b32 v15, v37, v38, s47
    v_bitop3_b32 v46, v37, 0.5, -0.5 bitop3:0xa8
    v_perm_b32 v14, v36, v38, s46
    v_bitop3_b32 v47, v36, 0.5, -0.5 bitop3:0xa8
    v_bitop3_b32 v15, v6, v15, v46 bitop3:0xca
    v_bitop3_b32 v14, v6, v14, v47 bitop3:0xca
    s_waitcnt lgkmcnt(1)
    v_mfma_f32_4x4x4_16b_bf16 v[80:83], v[10:11], v[70:71], v[80:83]
    s_waitcnt lgkmcnt(0)
    v_mfma_f32_4x4x4_16b_bf16 v[76:79], v[10:11], v[68:69], v[76:79]
    s_nop 2
    v_cvt_pk_bf16_f32 v80, v80, v81
    v_cvt_pk_bf16_f32 v81, v82, v83
    ds_wrxchg_rtn_b64 v[74:75], v93, v[80:81] offset:65408
    v_cvt_pk_bf16_f32 v76, v76, v77
    v_cvt_pk_bf16_f32 v77, v78, v79
    ds_wrxchg_rtn_b64 v[72:73], v92, v[76:77] offset:65408
    v_mfma_f32_4x4x4_16b_bf16 v[80:83], v[8:9], v[106:107], 0
    v_mfma_f32_4x4x4_16b_bf16 v[76:79], v[8:9], v[104:105], 0
    v_cmp_lt_u32 s[84:85], v5, v94
    s_nop 2
    v_pk_mul_f32 v[80:81], v[80:81], v[14:15] op_sel:[0,1] op_sel_hi:[1,1]
    v_pk_mul_f32 v[82:83], v[82:83], v[14:15] op_sel:[0,1] op_sel_hi:[1,1]
    v_pk_mul_f32 v[76:77], v[76:77], v[14:15] op_sel:[0,0] op_sel_hi:[1,0]
    v_pk_mul_f32 v[78:79], v[78:79], v[14:15] op_sel:[0,0] op_sel_hi:[1,0]
    s_waitcnt lgkmcnt(0)
    v_cmp_ne_u64 s[50:51], v[72:73], v[68:69]
    v_cmpx_ne_u64 s[54:55], v[74:75], v[70:71]
    s_and_b64 s[82:83], s[54:55], s[80:81]
    s_cbranch_scc1 L2_c150
L2_d150:
    v_mov_b64 v[84:85], v[70:71]
    v_mov_b32 v7, v93
    v_mov_b64 v[86:87], v[74:75]
    s_or_b64 s[80:81], s[80:81], s[54:55]
    s_mov_b64 exec, s[50:51]
    s_and_b64 s[82:83], s[50:51], s[80:81]
    s_cbranch_scc1 L2_c151
L2_d151:
    v_mov_b64 v[84:85], v[68:69]
    v_mov_b32 v7, v92
    v_mov_b64 v[86:87], v[72:73]
    s_mov_b64 exec, -1
    s_or_b64 s[80:81], s[80:81], s[50:51]
    s_and_b64 exec, s[84:85], s[80:81]
    v_mfma_f32_4x4x4_16b_bf16 v[76:79], v[12:13], v[84:85], 0
    v_mov_b32 v94, v7
    s_andn2_b64 s[80:81], s[80:81], s[84:85]
    v_mfma_f32_4x4x4_16b_bf16 v[76:79], v[10:11], v[86:87], v[76:79]
    s_mov_b64 exec, -1
    ds_read_b64 v[70:71], v95 offset:65408
    ds_read_b64 v[68:69], v94 offset:65408
    s_waitcnt lgkmcnt(1)
    v_mfma_f32_4x4x4_16b_bf16 v[80:83], v[10:11], v[70:71], v[80:83]
    s_waitcnt lgkmcnt(0)
    v_mfma_f32_4x4x4_16b_bf16 v[76:79], v[10:11], v[68:69], v[76:79]
    s_nop 2
    v_cvt_pk_bf16_f32 v80, v80, v81
    v_cvt_pk_bf16_f32 v81, v82, v83
    ds_wrxchg_rtn_b64 v[74:75], v95, v[80:81] offset:65408
    v_cvt_pk_bf16_f32 v76, v76, v77
    v_cvt_pk_bf16_f32 v77, v78, v79
    ds_wrxchg_rtn_b64 v[72:73], v94, v[76:77] offset:65408
    s_waitcnt lgkmcnt(0)
    v_cmpx_ne_u64 vcc, v[74:75], v[70:71]
    s_and_b64 s[82:83], vcc, s[80:81]
    s_cbranch_scc1 L2_c152
L2_d152:
    v_mov_b64 v[84:85], v[70:71]
    v_mov_b32 v7, v95
    v_mov_b64 v[86:87], v[74:75]
    s_mov_b64 exec, -1
    s_or_b64 s[80:81], s[80:81], vcc
    v_cmpx_ne_u64 vcc, v[72:73], v[68:69]
    s_and_b64 s[82:83], vcc, s[80:81]
    s_cbranch_scc1 L2_c153
L2_d153:
    v_mov_b64 v[84:85], v[68:69]
    v_mov_b32 v7, v94
    v_mov_b64 v[86:87], v[72:73]
    s_mov_b64 exec, -1
    s_or_b64 s[80:81], s[80:81], vcc
    s_mov_b64 exec, s[80:81]
    ds_read_b64 v[68:69], v7 offset:65408
    v_mfma_f32_4x4x4_16b_bf16 v[76:79], v[12:13], v[84:85], 0
    s_nop 1
    v_mfma_f32_4x4x4_16b_bf16 v[76:79], v[10:11], v[86:87], v[76:79]
    s_waitcnt lgkmcnt(0)
    s_nop 0
    v_mfma_f32_4x4x4_16b_bf16 v[76:79], v[10:11], v[68:69], v[76:79]
    v_mov_b64 v[84:85], v[68:69]
    s_nop 3
    v_cvt_pk_bf16_f32 v76, v76, v77
    v_cvt_pk_bf16_f32 v77, v78, v79
    ds_wrxchg_rtn_b64 v[86:87], v7, v[76:77] offset:65408
    s_waitcnt lgkmcnt(0)
    v_cmp_ne_u64 s[80:81], v[86:87], v[84:85]
    s_mov_b64 exec, s[80:81]
    s_nop 1
    v_mfma_f32_4x4x4_16b_bf16 v[88:91], v[12:13], v[84:85], 0
    s_nop 1
    v_mfma_f32_4x4x4_16b_bf16 v[88:91], v[10:11], v[86:87], v[88:91]
    s_nop 4
    v_cvt_pk_bf16_f32 v88, v88, v89
    v_cvt_pk_bf16_f32 v89, v90, v91
    ds_pk_add_bf16 v7, v88 offset:65408
    ds_pk_add_bf16 v7, v89 offset:65412
    s_mov_b64 exec, -1
    s_load_dwordx2 s[4:5], s[0:1], 88
    v_add_u32 v123, 0x4000, v122
    s_lshl_b32 s50, s96, 16
    s_and_b32 s51, s96, 0xffff0000
    s_lshl_b32 s52, s97, 16
    s_and_b32 s53, s97, 0xffff0000
    s_lshl_b32 s54, s98, 16
    s_and_b32 s55, s98, 0xffff0000
    s_lshl_b32 s56, s99, 16
    s_and_b32 s57, s99, 0xffff0000
    s_waitcnt vmcnt(0) lgkmcnt(0)
    s_barrier
    s_add_u32 s8, s30, 0xec55000
    s_addc_u32 s9, s31, 0
    s_mov_b32 s10, 0x8000
    s_mov_b32 s11, 0x20000
    s_mov_b32 s12, s4
    s_mov_b32 s13, s5
    s_mov_b32 s14, 0x4e2000
    s_mov_b32 s15, 0x20000
    s_add_u32 s20, s30, 0xd854000
    s_addc_u32 s21, s31, 0
    s_mov_b32 s22, 0x1400000
    s_mov_b32 s23, 0x20000
    s_lshl2_add_u32 s4, s34, s33
    s_mul_i32 s4, s4, 81920
    s_add_u32 s3, s33, 1
    s_and_b32 s3, s3, 3
    s_mul_i32 s36, s3, 20000
    s_add_u32 s36, s36, 81920
    s_mul_i32 s40, s3, 20480
    s_add_u32 s40, s40, s4
    s_lshl2_add_u32 s3, s34, s3
    s_mul_i32 s3, s3, 81920
    s_mul_i32 s44, s33, 20480
    s_add_u32 s44, s44, s3
    s_add_u32 s3, s33, 2
    s_and_b32 s3, s3, 3
    s_mul_i32 s37, s3, 20000
    s_add_u32 s37, s37, 81920
    s_mul_i32 s41, s3, 20480
    s_add_u32 s41, s41, s4
    s_lshl2_add_u32 s3, s34, s3
    s_mul_i32 s3, s3, 81920
    s_mul_i32 s45, s33, 20480
    s_add_u32 s45, s45, s3
    s_add_u32 s3, s33, 3
    s_and_b32 s3, s3, 3
    s_mul_i32 s38, s3, 20000
    s_add_u32 s38, s38, 81920
    s_mul_i32 s42, s3, 20480
    s_add_u32 s42, s42, s4
    s_lshl2_add_u32 s3, s34, s3
    s_mul_i32 s3, s3, 81920
    s_mul_i32 s46, s33, 20480
    s_add_u32 s46, s46, s3
    v_add_u32 v104, s36, v122
    ds_read_b128 v[16:19], v104
    v_add_u32 v104, s37, v122
    ds_read_b128 v[20:23], v104
    v_add_u32 v104, s38, v122
    ds_read_b128 v[24:27], v104
    s_waitcnt lgkmcnt(2)
    buffer_store_dwordx4 v[16:19], v122, s[20:23], s40 offen sc1
    s_waitcnt lgkmcnt(1)
    buffer_store_dwordx4 v[20:23], v122, s[20:23], s41 offen sc1
    s_waitcnt lgkmcnt(0)
    buffer_store_dwordx4 v[24:27], v122, s[20:23], s42 offen sc1
    s_cmp_ge_u32 s32, 4
    s_cbranch_scc1 L2_g0
    v_add_u32 v104, s36, v123
    ds_read_b128 v[36:39], v104
    v_add_u32 v104, s37, v123
    ds_read_b128 v[40:43], v104
    v_add_u32 v104, s38, v123
    ds_read_b128 v[44:47], v104
    s_waitcnt lgkmcnt(2)
    buffer_store_dwordx4 v[36:39], v123, s[20:23], s40 offen sc1
    s_waitcnt lgkmcnt(1)
    buffer_store_dwordx4 v[40:43], v123, s[20:23], s41 offen sc1
    s_waitcnt lgkmcnt(0)
    buffer_store_dwordx4 v[44:47], v123, s[20:23], s42 offen sc1
L2_g0:
    v_lshlrev_b32 v80, 16, v116
    v_subrev_f32 v60, s50, v80
    v_subrev_f32 v61, s51, v80
    v_subrev_f32 v62, s52, v80
    v_subrev_f32 v63, s53, v80
    v_subrev_f32 v64, s54, v80
    v_subrev_f32 v65, s55, v80
    v_subrev_f32 v66, s56, v80
    v_subrev_f32 v67, s57, v80
    v_cvt_pk_bf16_f32 v68, v60, v61
    v_cvt_pk_bf16_f32 v69, v62, v63
    v_cvt_pk_bf16_f32 v70, v64, v65
    v_cvt_pk_bf16_f32 v71, v66, v67
    v_lshlrev_b32 v60, 16, v68
    v_and_b32 v61, 0xffff0000, v68
    v_lshlrev_b32 v62, 16, v69
    v_and_b32 v63, 0xffff0000, v69
    v_lshlrev_b32 v64, 16, v70
    v_and_b32 v65, 0xffff0000, v70
    v_lshlrev_b32 v66, 16, v71
    v_and_b32 v67, 0xffff0000, v71
    v_mul_f32 v60, v60, v60
    v_mul_f32 v61, v61, v61
    v_mul_f32 v62, v62, v62
    v_mul_f32 v63, v63, v63
    v_mul_f32 v64, v64, v64
    v_mul_f32 v65, v65, v65
    v_mul_f32 v66, v66, v66
    v_mul_f32 v67, v67, v67
    v_cvt_pk_bf16_f32 v68, v60, v61
    v_cvt_pk_bf16_f32 v69, v62, v63
    v_cvt_pk_bf16_f32 v70, v64, v65
    v_cvt_pk_bf16_f32 v71, v66, v67
    v_lshlrev_b32 v60, 16, v68
    v_and_b32 v61, 0xffff0000, v68
    v_lshlrev_b32 v62, 16, v69
    v_and_b32 v63, 0xffff0000, v69
    v_lshlrev_b32 v64, 16, v70
    v_and_b32 v65, 0xffff0000, v70
    v_lshlrev_b32 v66, 16, v71
    v_and_b32 v67, 0xffff0000, v71
    v_mul_f32 v60, 0xc1200000, v60
    v_mul_f32 v61, 0xc1200000, v61
    v_mul_f32 v62, 0xc1200000, v62
    v_mul_f32 v63, 0xc1200000, v63
    v_mul_f32 v64, 0xc1200000, v64
    v_mul_f32 v65, 0xc1200000, v65
    v_mul_f32 v66, 0xc1200000, v66
    v_mul_f32 v67, 0xc1200000, v67
    v_cvt_pk_bf16_f32 v68, v60, v61
    v_cvt_pk_bf16_f32 v69, v62, v63
    v_cvt_pk_bf16_f32 v70, v64, v65
    v_cvt_pk_bf16_f32 v71, v66, v67
    v_lshlrev_b32 v60, 16, v68
    v_and_b32 v61, 0xffff0000, v68
    v_lshlrev_b32 v62, 16, v69
    v_and_b32 v63, 0xffff0000, v69
    v_lshlrev_b32 v64, 16, v70
    v_and_b32 v65, 0xffff0000, v70
    v_lshlrev_b32 v66, 16, v71
    v_and_b32 v67, 0xffff0000, v71
    v_mul_f32 v60, 0x3fb8aa3b, v60
    v_mul_f32 v61, 0x3fb8aa3b, v61
    v_mul_f32 v62, 0x3fb8aa3b, v62
    v_mul_f32 v63, 0x3fb8aa3b, v63
    v_mul_f32 v64, 0x3fb8aa3b, v64
    v_mul_f32 v65, 0x3fb8aa3b, v65
    v_mul_f32 v66, 0x3fb8aa3b, v66
    v_mul_f32 v67, 0x3fb8aa3b, v67
    v_exp_f32 v60, v60
    v_exp_f32 v61, v61
    v_exp_f32 v62, v62
    v_exp_f32 v63, v63
    v_exp_f32 v64, v64
    v_exp_f32 v65, v65
    v_exp_f32 v66, v66
    v_exp_f32 v67, v67
    v_cvt_pk_bf16_f32 v72, v60, v61
    v_cvt_pk_bf16_f32 v73, v62, v63
    v_cvt_pk_bf16_f32 v74, v64, v65
    v_cvt_pk_bf16_f32 v75, v66, v67
    v_and_b32 v84, 0xffff0000, v116
    v_subrev_f32 v60, s50, v84
    v_subrev_f32 v61, s51, v84
    v_subrev_f32 v62, s52, v84
    v_subrev_f32 v63, s53, v84
    v_subrev_f32 v64, s54, v84
    v_subrev_f32 v65, s55, v84
    v_subrev_f32 v66, s56, v84
    v_subrev_f32 v67, s57, v84
    v_cvt_pk_bf16_f32 v68, v60, v61
    v_cvt_pk_bf16_f32 v69, v62, v63
    v_cvt_pk_bf16_f32 v70, v64, v65
    v_cvt_pk_bf16_f32 v71, v66, v67
    v_lshlrev_b32 v60, 16, v68
    v_and_b32 v61, 0xffff0000, v68
    v_lshlrev_b32 v62, 16, v69
    v_and_b32 v63, 0xffff0000, v69
    v_lshlrev_b32 v64, 16, v70
    v_and_b32 v65, 0xffff0000, v70
    v_lshlrev_b32 v66, 16, v71
    v_and_b32 v67, 0xffff0000, v71
    v_mul_f32 v60, v60, v60
    v_mul_f32 v61, v61, v61
    v_mul_f32 v62, v62, v62
    v_mul_f32 v63, v63, v63
    v_mul_f32 v64, v64, v64
    v_mul_f32 v65, v65, v65
    v_mul_f32 v66, v66, v66
    v_mul_f32 v67, v67, v67
    v_cvt_pk_bf16_f32 v68, v60, v61
    v_cvt_pk_bf16_f32 v69, v62, v63
    v_cvt_pk_bf16_f32 v70, v64, v65
    v_cvt_pk_bf16_f32 v71, v66, v67
    v_lshlrev_b32 v60, 16, v68
    v_and_b32 v61, 0xffff0000, v68
    v_lshlrev_b32 v62, 16, v69
    v_and_b32 v63, 0xffff0000, v69
    v_lshlrev_b32 v64, 16, v70
    v_and_b32 v65, 0xffff0000, v70
    v_lshlrev_b32 v66, 16, v71
    v_and_b32 v67, 0xffff0000, v71
    v_mul_f32 v60, 0xc1200000, v60
    v_mul_f32 v61, 0xc1200000, v61
    v_mul_f32 v62, 0xc1200000, v62
    v_mul_f32 v63, 0xc1200000, v63
    v_mul_f32 v64, 0xc1200000, v64
    v_mul_f32 v65, 0xc1200000, v65
    v_mul_f32 v66, 0xc1200000, v66
    v_mul_f32 v67, 0xc1200000, v67
    v_cvt_pk_bf16_f32 v68, v60, v61
    v_cvt_pk_bf16_f32 v69, v62, v63
    v_cvt_pk_bf16_f32 v70, v64, v65
    v_cvt_pk_bf16_f32 v71, v66, v67
    v_lshlrev_b32 v60, 16, v68
    v_and_b32 v61, 0xffff0000, v68
    v_lshlrev_b32 v62, 16, v69
    v_and_b32 v63, 0xffff0000, v69
    v_lshlrev_b32 v64, 16, v70
    v_and_b32 v65, 0xffff0000, v70
    v_lshlrev_b32 v66, 16, v71
    v_and_b32 v67, 0xffff0000, v71
    v_mul_f32 v60, 0x3fb8aa3b, v60
    v_mul_f32 v61, 0x3fb8aa3b, v61
    v_mul_f32 v62, 0x3fb8aa3b, v62
    v_mul_f32 v63, 0x3fb8aa3b, v63
    v_mul_f32 v64, 0x3fb8aa3b, v64
    v_mul_f32 v65, 0x3fb8aa3b, v65
    v_mul_f32 v66, 0x3fb8aa3b, v66
    v_mul_f32 v67, 0x3fb8aa3b, v67
    v_exp_f32 v60, v60
    v_exp_f32 v61, v61
    v_exp_f32 v62, v62
    v_exp_f32 v63, v63
    v_exp_f32 v64, v64
    v_exp_f32 v65, v65
    v_exp_f32 v66, v66
    v_exp_f32 v67, v67
    v_cvt_pk_bf16_f32 v76, v60, v61
    v_cvt_pk_bf16_f32 v77, v62, v63
    v_cvt_pk_bf16_f32 v78, v64, v65
    v_cvt_pk_bf16_f32 v79, v66, v67
    v_mfma_f32_4x4x4_16b_bf16 v[80:83], v[48:49], v[72:73], 0
    v_mfma_f32_4x4x4_16b_bf16 v[88:91], v[52:53], v[72:73], 0
    v_mfma_f32_4x4x4_16b_bf16 v[84:87], v[48:49], v[76:77], 0
    v_mfma_f32_4x4x4_16b_bf16 v[92:95], v[52:53], v[76:77], 0
    v_mfma_f32_4x4x4_16b_bf16 v[80:83], v[50:51], v[74:75], v[80:83]
    v_mfma_f32_4x4x4_16b_bf16 v[88:91], v[54:55], v[74:75], v[88:91]
    v_mfma_f32_4x4x4_16b_bf16 v[84:87], v[50:51], v[78:79], v[84:87]
    v_mfma_f32_4x4x4_16b_bf16 v[92:95], v[54:55], v[78:79], v[92:95]
    s_lshl_b32 s3, s34, 9
    s_lshl_b32 s4, s33, 7
    s_add_u32 s4, s4, s3
    v_mov_b32 v104, 1
    v_and_b32 v105, 0x3f0, v122
    v_lshlrev_b32 v105, 3, v105
    v_add_u32 v106, 81920, v118
    ds_read_b128 v[32:35], v106
    v_add_u32 v106, 81920, v119
    ds_read_b128 v[60:63], v106
    s_waitcnt vmcnt(0)
    s_barrier
    s_cmp_lg_u32 s32, 0
    s_cbranch_scc1 L2_f2
    s_mov_b64 exec, 1
    buffer_store_dword v104, off, s[8:11], s4 sc1
    s_mov_b64 exec, 15
    s_bitset0_b64 exec, s33
L2_f3:
    buffer_load_dword v104, v105, s[8:11], s3 offen sc1
    s_waitcnt vmcnt(0)
    v_cmp_ne_u32 vcc, 1, v104
    s_cbranch_vccnz L2_f3s
    s_mov_b64 exec, -1
L2_f2:
    s_barrier
    buffer_load_dwordx4 v[36:39], v122, s[20:23], s44 offen sc1
    buffer_load_dwordx4 v[40:43], v122, s[20:23], s45 offen sc1
    buffer_load_dwordx4 v[44:47], v122, s[20:23], s46 offen sc1
    s_cmp_ge_u32 s32, 4
    s_cbranch_scc1 L2_f5
    buffer_load_dwordx4 v[64:67], v123, s[20:23], s44 offen sc1
    buffer_load_dwordx4 v[68:71], v123, s[20:23], s45 offen sc1
    buffer_load_dwordx4 v[72:75], v123, s[20:23], s46 offen sc1
    v_lshlrev_b32 v16, 16, v117
    v_subrev_f32 v96, s50, v16
    v_subrev_f32 v97, s51, v16
    v_subrev_f32 v98, s52, v16
    v_subrev_f32 v99, s53, v16
    v_subrev_f32 v100, s54, v16
    v_subrev_f32 v101, s55, v16
    v_subrev_f32 v102, s56, v16
    v_subrev_f32 v103, s57, v16
    v_cvt_pk_bf16_f32 v0, v96, v97
    v_cvt_pk_bf16_f32 v1, v98, v99
    v_cvt_pk_bf16_f32 v2, v100, v101
    v_cvt_pk_bf16_f32 v3, v102, v103
    v_lshlrev_b32 v96, 16, v0
    v_and_b32 v97, 0xffff0000, v0
    v_lshlrev_b32 v98, 16, v1
    v_and_b32 v99, 0xffff0000, v1
    v_lshlrev_b32 v100, 16, v2
    v_and_b32 v101, 0xffff0000, v2
    v_lshlrev_b32 v102, 16, v3
    v_and_b32 v103, 0xffff0000, v3
    v_mul_f32 v96, v96, v96
    v_mul_f32 v97, v97, v97
    v_mul_f32 v98, v98, v98
    v_mul_f32 v99, v99, v99
    v_mul_f32 v100, v100, v100
    v_mul_f32 v101, v101, v101
    v_mul_f32 v102, v102, v102
    v_mul_f32 v103, v103, v103
    v_cvt_pk_bf16_f32 v0, v96, v97
    v_cvt_pk_bf16_f32 v1, v98, v99
    v_cvt_pk_bf16_f32 v2, v100, v101
    v_cvt_pk_bf16_f32 v3, v102, v103
    v_lshlrev_b32 v96, 16, v0
    v_and_b32 v97, 0xffff0000, v0
    v_lshlrev_b32 v98, 16, v1
    v_and_b32 v99, 0xffff0000, v1
    v_lshlrev_b32 v100, 16, v2
    v_and_b32 v101, 0xffff0000, v2
    v_lshlrev_b32 v102, 16, v3
    v_and_b32 v103, 0xffff0000, v3
    v_mul_f32 v96, 0xc1200000, v96
    v_mul_f32 v97, 0xc1200000, v97
    v_mul_f32 v98, 0xc1200000, v98
    v_mul_f32 v99, 0xc1200000, v99
    v_mul_f32 v100, 0xc1200000, v100
    v_mul_f32 v101, 0xc1200000, v101
    v_mul_f32 v102, 0xc1200000, v102
    v_mul_f32 v103, 0xc1200000, v103
    v_cvt_pk_bf16_f32 v0, v96, v97
    v_cvt_pk_bf16_f32 v1, v98, v99
    v_cvt_pk_bf16_f32 v2, v100, v101
    v_cvt_pk_bf16_f32 v3, v102, v103
    v_lshlrev_b32 v96, 16, v0
    v_and_b32 v97, 0xffff0000, v0
    v_lshlrev_b32 v98, 16, v1
    v_and_b32 v99, 0xffff0000, v1
    v_lshlrev_b32 v100, 16, v2
    v_and_b32 v101, 0xffff0000, v2
    v_lshlrev_b32 v102, 16, v3
    v_and_b32 v103, 0xffff0000, v3
    v_mul_f32 v96, 0x3fb8aa3b, v96
    v_mul_f32 v97, 0x3fb8aa3b, v97
    v_mul_f32 v98, 0x3fb8aa3b, v98
    v_mul_f32 v99, 0x3fb8aa3b, v99
    v_mul_f32 v100, 0x3fb8aa3b, v100
    v_mul_f32 v101, 0x3fb8aa3b, v101
    v_mul_f32 v102, 0x3fb8aa3b, v102
    v_mul_f32 v103, 0x3fb8aa3b, v103
    v_exp_f32 v96, v96
    v_exp_f32 v97, v97
    v_exp_f32 v98, v98
    v_exp_f32 v99, v99
    v_exp_f32 v100, v100
    v_exp_f32 v101, v101
    v_exp_f32 v102, v102
    v_exp_f32 v103, v103
    v_cvt_pk_bf16_f32 v104, v96, v97
    v_cvt_pk_bf16_f32 v105, v98, v99
    v_cvt_pk_bf16_f32 v106, v100, v101
    v_cvt_pk_bf16_f32 v107, v102, v103
    v_and_b32 v20, 0xffff0000, v117
    v_subrev_f32 v96, s50, v20
    v_subrev_f32 v97, s51, v20
    v_subrev_f32 v98, s52, v20
    v_subrev_f32 v99, s53, v20
    v_subrev_f32 v100, s54, v20
    v_subrev_f32 v101, s55, v20
    v_subrev_f32 v102, s56, v20
    v_subrev_f32 v103, s57, v20
    v_cvt_pk_bf16_f32 v0, v96, v97
    v_cvt_pk_bf16_f32 v1, v98, v99
    v_cvt_pk_bf16_f32 v2, v100, v101
    v_cvt_pk_bf16_f32 v3, v102, v103
    v_lshlrev_b32 v96, 16, v0
    v_and_b32 v97, 0xffff0000, v0
    v_lshlrev_b32 v98, 16, v1
    v_and_b32 v99, 0xffff0000, v1
    v_lshlrev_b32 v100, 16, v2
    v_and_b32 v101, 0xffff0000, v2
    v_lshlrev_b32 v102, 16, v3
    v_and_b32 v103, 0xffff0000, v3
    v_mul_f32 v96, v96, v96
    v_mul_f32 v97, v97, v97
    v_mul_f32 v98, v98, v98
    v_mul_f32 v99, v99, v99
    v_mul_f32 v100, v100, v100
    v_mul_f32 v101, v101, v101
    v_mul_f32 v102, v102, v102
    v_mul_f32 v103, v103, v103
    v_cvt_pk_bf16_f32 v0, v96, v97
    v_cvt_pk_bf16_f32 v1, v98, v99
    v_cvt_pk_bf16_f32 v2, v100, v101
    v_cvt_pk_bf16_f32 v3, v102, v103
    v_lshlrev_b32 v96, 16, v0
    v_and_b32 v97, 0xffff0000, v0
    v_lshlrev_b32 v98, 16, v1
    v_and_b32 v99, 0xffff0000, v1
    v_lshlrev_b32 v100, 16, v2
    v_and_b32 v101, 0xffff0000, v2
    v_lshlrev_b32 v102, 16, v3
    v_and_b32 v103, 0xffff0000, v3
    v_mul_f32 v96, 0xc1200000, v96
    v_mul_f32 v97, 0xc1200000, v97
    v_mul_f32 v98, 0xc1200000, v98
    v_mul_f32 v99, 0xc1200000, v99
    v_mul_f32 v100, 0xc1200000, v100
    v_mul_f32 v101, 0xc1200000, v101
    v_mul_f32 v102, 0xc1200000, v102
    v_mul_f32 v103, 0xc1200000, v103
    v_cvt_pk_bf16_f32 v0, v96, v97
    v_cvt_pk_bf16_f32 v1, v98, v99
    v_cvt_pk_bf16_f32 v2, v100, v101
    v_cvt_pk_bf16_f32 v3, v102, v103
    v_lshlrev_b32 v96, 16, v0
    v_and_b32 v97, 0xffff0000, v0
    v_lshlrev_b32 v98, 16, v1
    v_and_b32 v99, 0xffff0000, v1
    v_lshlrev_b32 v100, 16, v2
    v_and_b32 v101, 0xffff0000, v2
    v_lshlrev_b32 v102, 16, v3
    v_and_b32 v103, 0xffff0000, v3
    v_mul_f32 v96, 0x3fb8aa3b, v96
    v_mul_f32 v97, 0x3fb8aa3b, v97
    v_mul_f32 v98, 0x3fb8aa3b, v98
    v_mul_f32 v99, 0x3fb8aa3b, v99
    v_mul_f32 v100, 0x3fb8aa3b, v100
    v_mul_f32 v101, 0x3fb8aa3b, v101
    v_mul_f32 v102, 0x3fb8aa3b, v102
    v_mul_f32 v103, 0x3fb8aa3b, v103
    v_exp_f32 v96, v96
    v_exp_f32 v97, v97
    v_exp_f32 v98, v98
    v_exp_f32 v99, v99
    v_exp_f32 v100, v100
    v_exp_f32 v101, v101
    v_exp_f32 v102, v102
    v_exp_f32 v103, v103
    v_cvt_pk_bf16_f32 v76, v96, v97
    v_cvt_pk_bf16_f32 v77, v98, v99
    v_cvt_pk_bf16_f32 v78, v100, v101
    v_cvt_pk_bf16_f32 v79, v102, v103
    v_mfma_f32_4x4x4_16b_bf16 v[16:19], v[48:49], v[104:105], 0
    v_mfma_f32_4x4x4_16b_bf16 v[24:27], v[52:53], v[104:105], 0
    v_mfma_f32_4x4x4_16b_bf16 v[20:23], v[48:49], v[76:77], 0
    v_mfma_f32_4x4x4_16b_bf16 v[28:31], v[52:53], v[76:77], 0
    v_mfma_f32_4x4x4_16b_bf16 v[16:19], v[50:51], v[106:107], v[16:19]
    v_mfma_f32_4x4x4_16b_bf16 v[24:27], v[54:55], v[106:107], v[24:27]
    v_mfma_f32_4x4x4_16b_bf16 v[20:23], v[50:51], v[78:79], v[20:23]
    v_mfma_f32_4x4x4_16b_bf16 v[28:31], v[54:55], v[78:79], v[28:31]
L2_f5:
    s_waitcnt vmcnt(0) lgkmcnt(0)
    v_mfma_f32_4x4x4_16b_bf16 v[96:99], v[10:11], v[32:33], 0
    v_mfma_f32_4x4x4_16b_bf16 v[100:103], v[10:11], v[34:35], 0
    s_nop 0
    v_mfma_f32_4x4x4_16b_bf16 v[96:99], v[10:11], v[36:37], v[96:99]
    v_mfma_f32_4x4x4_16b_bf16 v[100:103], v[10:11], v[38:39], v[100:103]
    s_nop 0
    v_mfma_f32_4x4x4_16b_bf16 v[96:99], v[10:11], v[40:41], v[96:99]
    v_mfma_f32_4x4x4_16b_bf16 v[100:103], v[10:11], v[42:43], v[100:103]
    s_nop 0
    v_mfma_f32_4x4x4_16b_bf16 v[96:99], v[10:11], v[44:45], v[96:99]
    v_mfma_f32_4x4x4_16b_bf16 v[100:103], v[10:11], v[46:47], v[100:103]
    s_nop 3
    v_mul_f32 v96, v96, v80
    v_mul_f32 v97, v97, v81
    v_mul_f32 v98, v98, v82
    v_mul_f32 v99, v99, v83
    v_cvt_pk_bf16_f32 v32, v96, v97
    v_cvt_pk_bf16_f32 v33, v98, v99
    v_mul_f32 v100, v100, v84
    v_mul_f32 v101, v101, v85
    v_mul_f32 v102, v102, v86
    v_mul_f32 v103, v103, v87
    v_cvt_pk_bf16_f32 v34, v100, v101
    v_cvt_pk_bf16_f32 v35, v102, v103
    v_mfma_f32_4x4x4_16b_bf16 v[80:83], v[56:57], v[32:33], 0
    s_nop 0
    v_mfma_f32_4x4x4_16b_bf16 v[84:87], v[56:57], v[34:35], 0
    s_nop 2
    v_mul_f32 v80, v80, v88
    v_mul_f32 v81, v81, v89
    v_mul_f32 v82, v82, v90
    v_mul_f32 v83, v83, v91
    v_mul_f32 v84, v84, v92
    v_mul_f32 v85, v85, v93
    v_mul_f32 v86, v86, v94
    v_mul_f32 v87, v87, v95
    v_mfma_f32_4x4x4_16b_bf16 v[96:99], v[10:11], v[108:109], v[80:83]
    s_nop 0
    v_mfma_f32_4x4x4_16b_bf16 v[100:103], v[10:11], v[110:111], v[84:87]
    s_nop 2
    v_cvt_pk_bf16_f32 v36, v96, v97
    v_cvt_pk_bf16_f32 v37, v98, v99
    v_cvt_pk_bf16_f32 v38, v100, v101
    v_cvt_pk_bf16_f32 v39, v102, v103
    buffer_store_dwordx4 v[36:39], v120, s[12:15], 0 offen nt
    s_cmp_ge_u32 s32, 4
    s_cbranch_scc1 L2_f6
    v_mfma_f32_4x4x4_16b_bf16 v[96:99], v[10:11], v[60:61], 0
    v_mfma_f32_4x4x4_16b_bf16 v[100:103], v[10:11], v[62:63], 0
    s_nop 0
    v_mfma_f32_4x4x4_16b_bf16 v[96:99], v[10:11], v[64:65], v[96:99]
    v_mfma_f32_4x4x4_16b_bf16 v[100:103], v[10:11], v[66:67], v[100:103]
    s_nop 0
    v_mfma_f32_4x4x4_16b_bf16 v[96:99], v[10:11], v[68:69], v[96:99]
    v_mfma_f32_4x4x4_16b_bf16 v[100:103], v[10:11], v[70:71], v[100:103]
    s_nop 0
    v_mfma_f32_4x4x4_16b_bf16 v[96:99], v[10:11], v[72:73], v[96:99]
    v_mfma_f32_4x4x4_16b_bf16 v[100:103], v[10:11], v[74:75], v[100:103]
    s_nop 3
    v_mul_f32 v96, v96, v16
    v_mul_f32 v97, v97, v17
    v_mul_f32 v98, v98, v18
    v_mul_f32 v99, v99, v19
    v_cvt_pk_bf16_f32 v60, v96, v97
    v_cvt_pk_bf16_f32 v61, v98, v99
    v_mul_f32 v100, v100, v20
    v_mul_f32 v101, v101, v21
    v_mul_f32 v102, v102, v22
    v_mul_f32 v103, v103, v23
    v_cvt_pk_bf16_f32 v62, v100, v101
    v_cvt_pk_bf16_f32 v63, v102, v103
    v_mfma_f32_4x4x4_16b_bf16 v[16:19], v[56:57], v[60:61], 0
    s_nop 0
    v_mfma_f32_4x4x4_16b_bf16 v[20:23], v[56:57], v[62:63], 0
    s_nop 2
    v_mul_f32 v16, v16, v24
    v_mul_f32 v17, v17, v25
    v_mul_f32 v18, v18, v26
    v_mul_f32 v19, v19, v27
    v_mul_f32 v20, v20, v28
    v_mul_f32 v21, v21, v29
    v_mul_f32 v22, v22, v30
    v_mul_f32 v23, v23, v31
    v_mfma_f32_4x4x4_16b_bf16 v[96:99], v[10:11], v[112:113], v[16:19]
    s_nop 0
    v_mfma_f32_4x4x4_16b_bf16 v[100:103], v[10:11], v[114:115], v[20:23]
    s_nop 2
    v_cvt_pk_bf16_f32 v64, v96, v97
    v_cvt_pk_bf16_f32 v65, v98, v99
    v_cvt_pk_bf16_f32 v66, v100, v101
    v_cvt_pk_bf16_f32 v67, v102, v103
    buffer_store_dwordx4 v[64:67], v121, s[12:15], 0 offen nt
L2_f6:
L2_end:
    s_endpgm
L2_slow:
    s_lshr_b32 s35, s42, 2
    s_lshl_b32 s50, s32, 4
    s_and_b32 s3, s42, 3
    s_lshl_b32 s53, s3, 3
    s_add_u32 s53, s53, s39
    s_and_b32 s3, s35, 2
    s_lshl_b32 s3, s3, 1
    s_add_u32 s53, s53, s3
    s_and_b32 s54, s35, 1
    s_lshl_b32 s54, s54, 4
L2_sl_seg:
    s_mul_i32 s55, s50, 173056
    s_and_b32 s3, s50, 3
    s_lshl_b32 s3, s3, 5
    s_add_u32 s3, s3, s55
    s_add_u32 s3, s3, s53
    buffer_load_dword v104, off, s[12:15], s3 sc1
    buffer_load_dword v105, off, s[12:15], s3 offset:32 sc1
    s_waitcnt vmcnt(0)
    v_readfirstlane_b32 s51, v104
    v_readfirstlane_b32 s52, v105
    s_lshr_b32 s51, s51, s54
    s_and_b32 s51, s51, 0xffff
    s_lshr_b32 s52, s52, s54
    s_and_b32 s52, s52, 0xffff
L2_sl_rec:
    s_cmp_ge_u32 s51, s52
    s_cbranch_scc1 L2_sl_next
    v_mbcnt_lo_u32_b32 v102, -1, 0
    v_mbcnt_hi_u32_b32 v102, -1, v102
    v_add_u32 v102, s51, v102
    v_and_b32 v103, -4, v102
    v_lshl_add_u32 v104, v102, 2, v103
    v_lshl_add_u32 v105, v103, 2, v102
    v_cmp_gt_u32 vcc, s52, v102
    s_mov_b64 exec, vcc
    buffer_load_dword v106, v104, s[8:11], s55 offen
    buffer_load_ubyte v107, v105, s[8:11], s55 offen offset:16
    s_waitcnt vmcnt(0)
    v_lshrrev_b32 v98, 14, v106
    v_and_b32 v98, v5, v98
    ds_read_b64 v[100:101], v98
    v_perm_b32 v97, v106, v107, s44
    v_and_b32 v96, v5, v106
    v_bitop3_b32 v103, v106, 0.5, -0.5 bitop3:0xa8
    v_bitop3_b32 v97, v6, v97, v103 bitop3:0xca
    s_waitcnt lgkmcnt(0)
    v_mfma_f32_4x4x4_16b_bf16 v[88:91], v[8:9], v[100:101], 0
    s_nop 4
    v_mul_f32 v88, v97, v88
    v_mul_f32 v89, v97, v89
    v_mul_f32 v90, v97, v90
    v_mul_f32 v91, v97, v91
    v_cvt_pk_bf16_f32 v88, v88, v89
    v_cvt_pk_bf16_f32 v89, v90, v91
    ds_pk_add_bf16 v96, v88 offset:65408
    ds_pk_add_bf16 v96, v89 offset:65412
    s_mov_b64 exec, -1
    s_add_u32 s51, s51, 64
    s_branch L2_sl_rec
L2_sl_next:
    s_add_u32 s50, s50, 1
    s_and_b32 s3, s50, 15
    s_cbranch_scc1 L2_sl_seg
    s_add_u32 s50, s50, 240
    s_cmp_lt_u32 s50, 1280
    s_cbranch_scc1 L2_sl_seg
    s_waitcnt lgkmcnt(0)
    s_cmp_eq_u32 s42, 0
    s_cbranch_scc1 L2_ret0
    s_cmp_eq_u32 s42, 1
    s_cbranch_scc1 L2_ret1
    s_cmp_eq_u32 s42, 14
    s_cbranch_scc1 L2_ret6
    s_cmp_eq_u32 s42, 15
    s_cbranch_scc1 L2_ret7
    s_and_b32 s3, s42, 3
    s_cmp_eq_u32 s3, 2
    s_cbranch_scc1 L2_ret2
    s_cmp_eq_u32 s3, 3
    s_cbranch_scc1 L2_ret3
    s_cmp_eq_u32 s3, 0
    s_cbranch_scc1 L2_ret4
    s_branch L2_ret5
L2_xo3:
    v_cmp_lt_u32 vcc, 20, v99
    s_mov_b32 s101, 1
    s_cbranch_vccz L2_xp3
    v_cmp_lt_u32 vcc, 32, v99
    v_cmp_lt_u32 s[58:59], 31, v88
    s_mov_b32 s101, 2
    s_or_b64 vcc, vcc, s[58:59]
    s_cbranch_scc0 L2_xp3
    s_mov_b32 s37, 0x10000
    s_branch L2_xp3
L2_xa4:
    s_cmp_eq_u32 s101, 1
    s_cbranch_scc1 L2_xc4
    v_lshlrev_b32 v89, 0, v96
    v_add_u32 v90, 140, v97
    v_bitop3_b32 v90, v89, v45, v90 bitop3:0x6a
    ds_write_b32 v98, v90 offset:28
    v_lshlrev_b32 v89, 4, v96
    v_add_u32 v90, 120, v97
    v_bitop3_b32 v90, v89, v45, v90 bitop3:0x6a
    ds_write_b32 v98, v90 offset:24
    v_lshlrev_b32 v89, 8, v96
    v_add_u32 v90, 100, v97
    v_bitop3_b32 v90, v89, v45, v90 bitop3:0x6a
    ds_write_b32 v98, v90 offset:20
L2_xc4:
    v_lshlrev_b32 v89, 12, v96
    v_add_u32 v90, 80, v97
    v_bitop3_b32 v90, v89, v45, v90 bitop3:0x6a
    ds_write_b32 v98, v90 offset:16
    s_branch L2_xb4
L2_xe4:
    v_cmp_lt_u32 vcc, 32, v99
    v_cmp_lt_u32 s[58:59], 31, v88
    v_lshrrev_b32 v89, 16, v96
    v_add_u32 v97, 80, v97
    s_or_b64 vcc, vcc, s[58:59]
    s_cbranch_scc1 L2_xs4
    v_lshlrev_b32 v89, v1, v89
    v_and_b32 v89, v45, v89
    v_cmp_ne_u32 vcc, 0, v89
    v_xor_b32 v90, v97, v89
    s_add_u32 s3, s37, s38
    v_mbcnt_lo_u32_b32 v98, vcc_lo, 0
    v_mbcnt_hi_u32_b32 v98, vcc_hi, v98
    s_bcnt1_i32_b64 s41, vcc
    v_lshl_add_u32 v98, v98, 2, s3
    s_lshl2_add_u32 s37, s41, s37
    s_mov_b64 exec, vcc
    ds_write_b32 v98, v90
    s_mov_b64 exec, -1
    s_branch L2_xr4
L2_xs4:
    s_waitcnt lgkmcnt(0)
    s_mov_b32 s37, 0x10000
    s_branch L2_xw4
L2_xf4:
    s_cmp_gt_u32 s37, 1024
    s_cbranch_scc1 L2_xt4
    s_cmp_lt_u32 s37, 768
    s_cbranch_scc1 L2_xl4
    ds_read_b32 v32, v44 offset:896
    s_add_u32 s3, s42, 0
    s_bitset1_b32 s43, s3
    s_branch L2_xg4
L2_xl4:
    s_waitcnt lgkmcnt(0)
    v_mov_b32 v31, -1
    s_cmp_ge_u32 s37, 512
    s_cbranch_scc1 L2_xg4
    v_mov_b32 v39, -1
    s_cmp_ge_u32 s37, 256
    s_cbranch_scc1 L2_xg4
    v_mov_b32 v27, -1
    s_branch L2_xg4
L2_xt4:
    s_waitcnt lgkmcnt(0)
    v_mov_b32 v21, -1
    v_mov_b32 v27, -1
    v_mov_b32 v39, -1
    v_mov_b32 v31, -1
    s_add_u32 s3, s42, 0
    s_bitset1_b32 s36, s3
    s_branch L2_xg4
L2_xo5:
    v_cmp_lt_u32 vcc, 20, v99
    s_mov_b32 s101, 1
    s_cbranch_vccz L2_xp5
    v_cmp_lt_u32 vcc, 32, v99
    v_cmp_lt_u32 s[58:59], 31, v88
    s_mov_b32 s101, 2
    s_or_b64 vcc, vcc, s[58:59]
    s_cbranch_scc0 L2_xp5
    s_mov_b32 s37, 0x10000
    s_branch L2_xp5
L2_xa6:
    s_cmp_eq_u32 s101, 1
    s_cbranch_scc1 L2_xc6
    v_lshlrev_b32 v89, 0, v96
    v_add_u32 v90, 140, v97
    v_bitop3_b32 v90, v89, v45, v90 bitop3:0x6a
    ds_write_b32 v98, v90 offset:28
    v_lshlrev_b32 v89, 4, v96
    v_add_u32 v90, 120, v97
    v_bitop3_b32 v90, v89, v45, v90 bitop3:0x6a
    ds_write_b32 v98, v90 offset:24
    v_lshlrev_b32 v89, 8, v96
    v_add_u32 v90, 100, v97
    v_bitop3_b32 v90, v89, v45, v90 bitop3:0x6a
    ds_write_b32 v98, v90 offset:20
L2_xc6:
    v_lshlrev_b32 v89, 12, v96
    v_add_u32 v90, 80, v97
    v_bitop3_b32 v90, v89, v45, v90 bitop3:0x6a
    ds_write_b32 v98, v90 offset:16
    s_branch L2_xb6
L2_xe6:
    v_cmp_lt_u32 vcc, 32, v99
    v_cmp_lt_u32 s[58:59], 31, v88
    v_lshrrev_b32 v89, 16, v96
    v_add_u32 v97, 80, v97
    s_or_b64 vcc, vcc, s[58:59]
    s_cbranch_scc1 L2_xs6
    v_lshlrev_b32 v89, v1, v89
    v_and_b32 v89, v45, v89
    v_cmp_ne_u32 vcc, 0, v89
    v_xor_b32 v90, v97, v89
    s_add_u32 s3, s37, s38
    v_mbcnt_lo_u32_b32 v98, vcc_lo, 0
    v_mbcnt_hi_u32_b32 v98, vcc_hi, v98
    s_bcnt1_i32_b64 s41, vcc
    v_lshl_add_u32 v98, v98, 2, s3
    s_lshl2_add_u32 s37, s41, s37
    s_mov_b64 exec, vcc
    ds_write_b32 v98, v90
    s_mov_b64 exec, -1
    s_branch L2_xr6
L2_xs6:
    s_waitcnt lgkmcnt(0)
    s_mov_b32 s37, 0x10000
    s_branch L2_xw6
L2_xf6:
    s_cmp_gt_u32 s37, 1024
    s_cbranch_scc1 L2_xt6
    s_cmp_lt_u32 s37, 768
    s_cbranch_scc1 L2_xl6
    ds_read_b32 v33, v44 offset:896
    s_add_u32 s3, s42, 1
    s_bitset1_b32 s43, s3
    s_branch L2_xg6
L2_xl6:
    s_waitcnt lgkmcnt(0)
    v_mov_b32 v42, -1
    s_cmp_ge_u32 s37, 512
    s_cbranch_scc1 L2_xg6
    v_mov_b32 v43, -1
    s_cmp_ge_u32 s37, 256
    s_cbranch_scc1 L2_xg6
    v_mov_b32 v41, -1
    s_branch L2_xg6
L2_xt6:
    s_waitcnt lgkmcnt(0)
    v_mov_b32 v40, -1
    v_mov_b32 v41, -1
    v_mov_b32 v43, -1
    v_mov_b32 v42, -1
    s_add_u32 s3, s42, 1
    s_bitset1_b32 s36, s3
    s_branch L2_xg6
L2_oa7:
    v_and_b32 v47, 0x0fffffff, v32
    buffer_load_dword v78, v47, s[8:11], 0 offen offset:16
    s_mov_b64 exec, s[6:7]
    v_add_u32 v47, 8, v47
    v_lshrrev_b32 v32, 2, v32
    s_mov_b64 exec, -1
    buffer_load_dwordx2 v[76:77], v47, s[8:11], 0 offen
    s_branch L2_ob7
L2_oa8:
    s_waitcnt vmcnt(0)
    s_mov_b64 exec, s[6:7]
    v_lshrrev_b32 v78, 16, v78
    s_mov_b64 exec, -1
    v_and_b32 v46, 0x10000000, v32
    v_cmpx_eq_u32 vcc, 0, v46
    v_lshrrev_b32 v47, 14, v76
    v_and_b32 v47, v5, v47
    ds_read_b64 v[96:97], v47
    v_perm_b32 v98, v76, v78, s44
    v_bitop3_b32 v99, v76, 0.5, -0.5 bitop3:0xa8
    v_bitop3_b32 v98, v6, v98, v99 bitop3:0xca
    v_and_b32 v47, v5, v76
    s_waitcnt lgkmcnt(0)
    v_mfma_f32_4x4x4_16b_bf16 v[88:91], v[8:9], v[96:97], 0
    s_nop 4
    v_mul_f32 v88, v98, v88
    v_mul_f32 v89, v98, v89
    v_mul_f32 v90, v98, v90
    v_mul_f32 v91, v98, v91
    v_cvt_pk_bf16_f32 v88, v88, v89
    v_cvt_pk_bf16_f32 v89, v90, v91
    ds_pk_add_bf16 v47, v88 offset:65408
    ds_pk_add_bf16 v47, v89 offset:65412
    s_mov_b64 exec, -1
    v_and_b32 v46, 0x20000000, v32
    v_cmpx_eq_u32 vcc, 0, v46
    v_lshrrev_b32 v47, 14, v77
    v_and_b32 v47, v5, v47
    ds_read_b64 v[96:97], v47
    v_perm_b32 v98, v77, v78, s45
    v_bitop3_b32 v99, v77, 0.5, -0.5 bitop3:0xa8
    v_bitop3_b32 v98, v6, v98, v99 bitop3:0xca
    v_and_b32 v47, v5, v77
    s_waitcnt lgkmcnt(0)
    v_mfma_f32_4x4x4_16b_bf16 v[88:91], v[8:9], v[96:97], 0
    s_nop 4
    v_mul_f32 v88, v98, v88
    v_mul_f32 v89, v98, v89
    v_mul_f32 v90, v98, v90
    v_mul_f32 v91, v98, v91
    v_cvt_pk_bf16_f32 v88, v88, v89
    v_cvt_pk_bf16_f32 v89, v90, v91
    ds_pk_add_bf16 v47, v88 offset:65408
    ds_pk_add_bf16 v47, v89 offset:65412
    s_mov_b64 exec, -1
    s_branch L2_ob8
L2_c9:
    s_lshl_b64 s[52:53], s[82:83], 1
    s_andn2_b64 s[52:53], s[52:53], s[80:81]
    s_andn2_b64 s[52:53], s[52:53], s[54:55]
    s_or_b64 s[80:81], s[80:81], s[52:53]
    s_not_b64 vcc, s[52:53]
    s_mov_b64 exec, -1
    v_cndmask_b32_dpp v84, v84, v84, vcc wave_shr:1 row_mask:0xf bank_mask:0xf
    v_cndmask_b32_dpp v85, v85, v85, vcc wave_shr:1 row_mask:0xf bank_mask:0xf
    s_lshr_b64 s[52:53], s[52:53], 1
    v_cndmask_b32_dpp v86, v86, v86, vcc wave_shr:1 row_mask:0xf bank_mask:0xf
    v_cndmask_b32_dpp v87, v87, v87, vcc wave_shr:1 row_mask:0xf bank_mask:0xf
    s_andn2_b64 s[82:83], s[82:83], s[52:53]
    v_cndmask_b32_dpp v7, v7, v7, vcc wave_shr:1 row_mask:0xf bank_mask:0xf
    s_mov_b64 exec, s[54:55]
    s_cbranch_scc0 L2_d9
    s_mov_b64 exec, s[82:83]
    s_nop 1
    v_mfma_f32_4x4x4_16b_bf16 v[88:91], v[12:13], v[84:85], 0
    s_nop 1
    v_mfma_f32_4x4x4_16b_bf16 v[88:91], v[10:11], v[86:87], v[88:91]
    s_nop 4
    v_cvt_pk_bf16_f32 v88, v88, v89
    v_cvt_pk_bf16_f32 v89, v90, v91
    ds_pk_add_bf16 v7, v88 offset:65408
    ds_pk_add_bf16 v7, v89 offset:65412
    s_mov_b64 exec, s[54:55]
    s_branch L2_d9
L2_c10:
    s_lshl_b64 s[52:53], s[82:83], 1
    s_andn2_b64 s[52:53], s[52:53], s[80:81]
    s_andn2_b64 s[52:53], s[52:53], s[50:51]
    s_or_b64 s[80:81], s[80:81], s[52:53]
    s_not_b64 vcc, s[52:53]
    s_mov_b64 exec, -1
    v_cndmask_b32_dpp v84, v84, v84, vcc wave_shr:1 row_mask:0xf bank_mask:0xf
    v_cndmask_b32_dpp v85, v85, v85, vcc wave_shr:1 row_mask:0xf bank_mask:0xf
    s_lshr_b64 s[52:53], s[52:53], 1
    v_cndmask_b32_dpp v86, v86, v86, vcc wave_shr:1 row_mask:0xf bank_mask:0xf
    v_cndmask_b32_dpp v87, v87, v87, vcc wave_shr:1 row_mask:0xf bank_mask:0xf
    s_andn2_b64 s[82:83], s[82:83], s[52:53]
    v_cndmask_b32_dpp v7, v7, v7, vcc wave_shr:1 row_mask:0xf bank_mask:0xf
    s_mov_b64 exec, s[50:51]
    s_cbranch_scc0 L2_d10
    s_mov_b64 exec, s[82:83]
    s_nop 1
    v_mfma_f32_4x4x4_16b_bf16 v[88:91], v[12:13], v[84:85], 0
    s_nop 1
    v_mfma_f32_4x4x4_16b_bf16 v[88:91], v[10:11], v[86:87], v[88:91]
    s_nop 4
    v_cvt_pk_bf16_f32 v88, v88, v89
    v_cvt_pk_bf16_f32 v89, v90, v91
    ds_pk_add_bf16 v7, v88 offset:65408
    ds_pk_add_bf16 v7, v89 offset:65412
    s_mov_b64 exec, s[50:51]
    s_branch L2_d10
L2_c13:
    s_lshl_b64 s[52:53], s[82:83], 1
    s_andn2_b64 s[52:53], s[52:53], s[80:81]
    s_andn2_b64 s[52:53], s[52:53], s[54:55]
    s_or_b64 s[80:81], s[80:81], s[52:53]
    s_not_b64 vcc, s[52:53]
    s_mov_b64 exec, -1
    v_cndmask_b32_dpp v84, v84, v84, vcc wave_shr:1 row_mask:0xf bank_mask:0xf
    v_cndmask_b32_dpp v85, v85, v85, vcc wave_shr:1 row_mask:0xf bank_mask:0xf
    s_lshr_b64 s[52:53], s[52:53], 1
    v_cndmask_b32_dpp v86, v86, v86, vcc wave_shr:1 row_mask:0xf bank_mask:0xf
    v_cndmask_b32_dpp v87, v87, v87, vcc wave_shr:1 row_mask:0xf bank_mask:0xf
    s_andn2_b64 s[82:83], s[82:83], s[52:53]
    v_cndmask_b32_dpp v7, v7, v7, vcc wave_shr:1 row_mask:0xf bank_mask:0xf
    s_mov_b64 exec, s[54:55]
    s_cbranch_scc0 L2_d13
    s_mov_b64 exec, s[82:83]
    s_nop 1
    v_mfma_f32_4x4x4_16b_bf16 v[88:91], v[12:13], v[84:85], 0
    s_nop 1
    v_mfma_f32_4x4x4_16b_bf16 v[88:91], v[10:11], v[86:87], v[88:91]
    s_nop 4
    v_cvt_pk_bf16_f32 v88, v88, v89
    v_cvt_pk_bf16_f32 v89, v90, v91
    ds_pk_add_bf16 v7, v88 offset:65408
    ds_pk_add_bf16 v7, v89 offset:65412
    s_mov_b64 exec, s[54:55]
    s_branch L2_d13
L2_c14:
    s_lshl_b64 s[52:53], s[82:83], 1
    s_andn2_b64 s[52:53], s[52:53], s[80:81]
    s_andn2_b64 s[52:53], s[52:53], s[50:51]
    s_or_b64 s[80:81], s[80:81], s[52:53]
    s_not_b64 vcc, s[52:53]
    s_mov_b64 exec, -1
    v_cndmask_b32_dpp v84, v84, v84, vcc wave_shr:1 row_mask:0xf bank_mask:0xf
    v_cndmask_b32_dpp v85, v85, v85, vcc wave_shr:1 row_mask:0xf bank_mask:0xf
    s_lshr_b64 s[52:53], s[52:53], 1
    v_cndmask_b32_dpp v86, v86, v86, vcc wave_shr:1 row_mask:0xf bank_mask:0xf
    v_cndmask_b32_dpp v87, v87, v87, vcc wave_shr:1 row_mask:0xf bank_mask:0xf
    s_andn2_b64 s[82:83], s[82:83], s[52:53]
    v_cndmask_b32_dpp v7, v7, v7, vcc wave_shr:1 row_mask:0xf bank_mask:0xf
    s_mov_b64 exec, s[50:51]
    s_cbranch_scc0 L2_d14
    s_mov_b64 exec, s[82:83]
    s_nop 1
    v_mfma_f32_4x4x4_16b_bf16 v[88:91], v[12:13], v[84:85], 0
    s_nop 1
    v_mfma_f32_4x4x4_16b_bf16 v[88:91], v[10:11], v[86:87], v[88:91]
    s_nop 4
    v_cvt_pk_bf16_f32 v88, v88, v89
    v_cvt_pk_bf16_f32 v89, v90, v91
    ds_pk_add_bf16 v7, v88 offset:65408
    ds_pk_add_bf16 v7, v89 offset:65412
    s_mov_b64 exec, s[50:51]
    s_branch L2_d14
L2_xo16:
    v_cmp_lt_u32 vcc, 20, v99
    s_mov_b32 s101, 1
    s_cbranch_vccz L2_xp16
    v_cmp_lt_u32 vcc, 32, v99
    v_cmp_lt_u32 s[58:59], 31, v88
    s_mov_b32 s101, 2
    s_or_b64 vcc, vcc, s[58:59]
    s_cbranch_scc0 L2_xp16
    s_mov_b32 s37, 0x10000
    s_branch L2_xp16
L2_c17:
    s_lshl_b64 s[52:53], s[82:83], 1
    s_andn2_b64 s[52:53], s[52:53], s[80:81]
    s_andn2_b64 s[52:53], s[52:53], s[54:55]
    s_or_b64 s[80:81], s[80:81], s[52:53]
    s_not_b64 vcc, s[52:53]
    s_mov_b64 exec, -1
    v_cndmask_b32_dpp v84, v84, v84, vcc wave_shr:1 row_mask:0xf bank_mask:0xf
    v_cndmask_b32_dpp v85, v85, v85, vcc wave_shr:1 row_mask:0xf bank_mask:0xf
    s_lshr_b64 s[52:53], s[52:53], 1
    v_cndmask_b32_dpp v86, v86, v86, vcc wave_shr:1 row_mask:0xf bank_mask:0xf
    v_cndmask_b32_dpp v87, v87, v87, vcc wave_shr:1 row_mask:0xf bank_mask:0xf
    s_andn2_b64 s[82:83], s[82:83], s[52:53]
    v_cndmask_b32_dpp v7, v7, v7, vcc wave_shr:1 row_mask:0xf bank_mask:0xf
    s_mov_b64 exec, s[54:55]
    s_cbranch_scc0 L2_d17
    s_mov_b64 exec, s[82:83]
    s_nop 1
    v_mfma_f32_4x4x4_16b_bf16 v[88:91], v[12:13], v[84:85], 0
    s_nop 1
    v_mfma_f32_4x4x4_16b_bf16 v[88:91], v[10:11], v[86:87], v[88:91]
    s_nop 4
    v_cvt_pk_bf16_f32 v88, v88, v89
    v_cvt_pk_bf16_f32 v89, v90, v91
    ds_pk_add_bf16 v7, v88 offset:65408
    ds_pk_add_bf16 v7, v89 offset:65412
    s_mov_b64 exec, s[54:55]
    s_branch L2_d17
L2_c18:
    s_lshl_b64 s[52:53], s[82:83], 1
    s_andn2_b64 s[52:53], s[52:53], s[80:81]
    s_andn2_b64 s[52:53], s[52:53], s[50:51]
    s_or_b64 s[80:81], s[80:81], s[52:53]
    s_not_b64 vcc, s[52:53]
    s_mov_b64 exec, -1
    v_cndmask_b32_dpp v84, v84, v84, vcc wave_shr:1 row_mask:0xf bank_mask:0xf
    v_cndmask_b32_dpp v85, v85, v85, vcc wave_shr:1 row_mask:0xf bank_mask:0xf
    s_lshr_b64 s[52:53], s[52:53], 1
    v_cndmask_b32_dpp v86, v86, v86, vcc wave_shr:1 row_mask:0xf bank_mask:0xf
    v_cndmask_b32_dpp v87, v87, v87, vcc wave_shr:1 row_mask:0xf bank_mask:0xf
    s_andn2_b64 s[82:83], s[82:83], s[52:53]
    v_cndmask_b32_dpp v7, v7, v7, vcc wave_shr:1 row_mask:0xf bank_mask:0xf
    s_mov_b64 exec, s[50:51]
    s_cbranch_scc0 L2_d18
    s_mov_b64 exec, s[82:83]
    s_nop 1
    v_mfma_f32_4x4x4_16b_bf16 v[88:91], v[12:13], v[84:85], 0
    s_nop 1
    v_mfma_f32_4x4x4_16b_bf16 v[88:91], v[10:11], v[86:87], v[88:91]
    s_nop 4
    v_cvt_pk_bf16_f32 v88, v88, v89
    v_cvt_pk_bf16_f32 v89, v90, v91
    ds_pk_add_bf16 v7, v88 offset:65408
    ds_pk_add_bf16 v7, v89 offset:65412
    s_mov_b64 exec, s[50:51]
    s_branch L2_d18
L2_c21:
    s_lshl_b64 s[52:53], s[82:83], 1
    s_andn2_b64 s[52:53], s[52:53], s[80:81]
    s_andn2_b64 s[52:53], s[52:53], s[54:55]
    s_or_b64 s[80:81], s[80:81], s[52:53]
    s_not_b64 vcc, s[52:53]
    s_mov_b64 exec, -1
    v_cndmask_b32_dpp v84, v84, v84, vcc wave_shr:1 row_mask:0xf bank_mask:0xf
    v_cndmask_b32_dpp v85, v85, v85, vcc wave_shr:1 row_mask:0xf bank_mask:0xf
    s_lshr_b64 s[52:53], s[52:53], 1
    v_cndmask_b32_dpp v86, v86, v86, vcc wave_shr:1 row_mask:0xf bank_mask:0xf
    v_cndmask_b32_dpp v87, v87, v87, vcc wave_shr:1 row_mask:0xf bank_mask:0xf
    s_andn2_b64 s[82:83], s[82:83], s[52:53]
    v_cndmask_b32_dpp v7, v7, v7, vcc wave_shr:1 row_mask:0xf bank_mask:0xf
    s_mov_b64 exec, s[54:55]
    s_cbranch_scc0 L2_d21
    s_mov_b64 exec, s[82:83]
    s_nop 1
    v_mfma_f32_4x4x4_16b_bf16 v[88:91], v[12:13], v[84:85], 0
    s_nop 1
    v_mfma_f32_4x4x4_16b_bf16 v[88:91], v[10:11], v[86:87], v[88:91]
    s_nop 4
    v_cvt_pk_bf16_f32 v88, v88, v89
    v_cvt_pk_bf16_f32 v89, v90, v91
    ds_pk_add_bf16 v7, v88 offset:65408
    ds_pk_add_bf16 v7, v89 offset:65412
    s_mov_b64 exec, s[54:55]
    s_branch L2_d21
L2_c22:
    s_lshl_b64 s[52:53], s[82:83], 1
    s_andn2_b64 s[52:53], s[52:53], s[80:81]
    s_andn2_b64 s[52:53], s[52:53], s[50:51]
    s_or_b64 s[80:81], s[80:81], s[52:53]
    s_not_b64 vcc, s[52:53]
    s_mov_b64 exec, -1
    v_cndmask_b32_dpp v84, v84, v84, vcc wave_shr:1 row_mask:0xf bank_mask:0xf
    v_cndmask_b32_dpp v85, v85, v85, vcc wave_shr:1 row_mask:0xf bank_mask:0xf
    s_lshr_b64 s[52:53], s[52:53], 1
    v_cndmask_b32_dpp v86, v86, v86, vcc wave_shr:1 row_mask:0xf bank_mask:0xf
    v_cndmask_b32_dpp v87, v87, v87, vcc wave_shr:1 row_mask:0xf bank_mask:0xf
    s_andn2_b64 s[82:83], s[82:83], s[52:53]
    v_cndmask_b32_dpp v7, v7, v7, vcc wave_shr:1 row_mask:0xf bank_mask:0xf
    s_mov_b64 exec, s[50:51]
    s_cbranch_scc0 L2_d22
    s_mov_b64 exec, s[82:83]
    s_nop 1
    v_mfma_f32_4x4x4_16b_bf16 v[88:91], v[12:13], v[84:85], 0
    s_nop 1
    v_mfma_f32_4x4x4_16b_bf16 v[88:91], v[10:11], v[86:87], v[88:91]
    s_nop 4
    v_cvt_pk_bf16_f32 v88, v88, v89
    v_cvt_pk_bf16_f32 v89, v90, v91
    ds_pk_add_bf16 v7, v88 offset:65408
    ds_pk_add_bf16 v7, v89 offset:65412
    s_mov_b64 exec, s[50:51]
    s_branch L2_d22
L2_c23:
    s_lshl_b64 s[52:53], s[82:83], 1
    s_andn2_b64 s[52:53], s[52:53], s[80:81]
    s_andn2_b64 s[52:53], s[52:53], s[54:55]
    s_or_b64 s[80:81], s[80:81], s[52:53]
    s_not_b64 vcc, s[52:53]
    s_mov_b64 exec, -1
    v_cndmask_b32_dpp v84, v84, v84, vcc wave_shr:1 row_mask:0xf bank_mask:0xf
    v_cndmask_b32_dpp v85, v85, v85, vcc wave_shr:1 row_mask:0xf bank_mask:0xf
    s_lshr_b64 s[52:53], s[52:53], 1
    v_cndmask_b32_dpp v86, v86, v86, vcc wave_shr:1 row_mask:0xf bank_mask:0xf
    v_cndmask_b32_dpp v87, v87, v87, vcc wave_shr:1 row_mask:0xf bank_mask:0xf
    s_andn2_b64 s[82:83], s[82:83], s[52:53]
    v_cndmask_b32_dpp v7, v7, v7, vcc wave_shr:1 row_mask:0xf bank_mask:0xf
    s_mov_b64 exec, s[54:55]
    s_cbranch_scc0 L2_d23
    s_mov_b64 exec, s[82:83]
    s_nop 1
    v_mfma_f32_4x4x4_16b_bf16 v[88:91], v[12:13], v[84:85], 0
    s_nop 1
    v_mfma_f32_4x4x4_16b_bf16 v[88:91], v[10:11], v[86:87], v[88:91]
    s_nop 4
    v_cvt_pk_bf16_f32 v88, v88, v89
    v_cvt_pk_bf16_f32 v89, v90, v91
    ds_pk_add_bf16 v7, v88 offset:65408
    ds_pk_add_bf16 v7, v89 offset:65412
    s_mov_b64 exec, s[54:55]
    s_branch L2_d23
L2_c24:
    s_lshl_b64 s[52:53], s[82:83], 1
    s_andn2_b64 s[52:53], s[52:53], s[80:81]
    s_andn2_b64 s[52:53], s[52:53], s[50:51]
    s_or_b64 s[80:81], s[80:81], s[52:53]
    s_not_b64 vcc, s[52:53]
    s_mov_b64 exec, -1
    v_cndmask_b32_dpp v84, v84, v84, vcc wave_shr:1 row_mask:0xf bank_mask:0xf
    v_cndmask_b32_dpp v85, v85, v85, vcc wave_shr:1 row_mask:0xf bank_mask:0xf
    s_lshr_b64 s[52:53], s[52:53], 1
    v_cndmask_b32_dpp v86, v86, v86, vcc wave_shr:1 row_mask:0xf bank_mask:0xf
    v_cndmask_b32_dpp v87, v87, v87, vcc wave_shr:1 row_mask:0xf bank_mask:0xf
    s_andn2_b64 s[82:83], s[82:83], s[52:53]
    v_cndmask_b32_dpp v7, v7, v7, vcc wave_shr:1 row_mask:0xf bank_mask:0xf
    s_mov_b64 exec, s[50:51]
    s_cbranch_scc0 L2_d24
    s_mov_b64 exec, s[82:83]
    s_nop 1
    v_mfma_f32_4x4x4_16b_bf16 v[88:91], v[12:13], v[84:85], 0
    s_nop 1
    v_mfma_f32_4x4x4_16b_bf16 v[88:91], v[10:11], v[86:87], v[88:91]
    s_nop 4
    v_cvt_pk_bf16_f32 v88, v88, v89
    v_cvt_pk_bf16_f32 v89, v90, v91
    ds_pk_add_bf16 v7, v88 offset:65408
    ds_pk_add_bf16 v7, v89 offset:65412
    s_mov_b64 exec, s[50:51]
    s_branch L2_d24
L2_xa25:
    s_cmp_eq_u32 s101, 1
    s_cbranch_scc1 L2_xc25
    v_lshlrev_b32 v89, 0, v96
    v_add_u32 v90, 140, v97
    v_bitop3_b32 v90, v89, v45, v90 bitop3:0x6a
    ds_write_b32 v98, v90 offset:28
    v_lshlrev_b32 v89, 4, v96
    v_add_u32 v90, 120, v97
    v_bitop3_b32 v90, v89, v45, v90 bitop3:0x6a
    ds_write_b32 v98, v90 offset:24
    v_lshlrev_b32 v89, 8, v96
    v_add_u32 v90, 100, v97
    v_bitop3_b32 v90, v89, v45, v90 bitop3:0x6a
    ds_write_b32 v98, v90 offset:20
L2_xc25:
    v_lshlrev_b32 v89, 12, v96
    v_add_u32 v90, 80, v97
    v_bitop3_b32 v90, v89, v45, v90 bitop3:0x6a
    ds_write_b32 v98, v90 offset:16
    s_branch L2_xb25
L2_xe25:
    v_cmp_lt_u32 vcc, 32, v99
    v_cmp_lt_u32 s[58:59], 31, v88
    v_lshrrev_b32 v89, 16, v96
    v_add_u32 v97, 80, v97
    s_or_b64 vcc, vcc, s[58:59]
    s_cbranch_scc1 L2_xs25
    v_lshlrev_b32 v89, v1, v89
    v_and_b32 v89, v45, v89
    v_cmp_ne_u32 vcc, 0, v89
    v_xor_b32 v90, v97, v89
    s_add_u32 s3, s37, s38
    v_mbcnt_lo_u32_b32 v98, vcc_lo, 0
    v_mbcnt_hi_u32_b32 v98, vcc_hi, v98
    s_bcnt1_i32_b64 s41, vcc
    v_lshl_add_u32 v98, v98, 2, s3
    s_lshl2_add_u32 s37, s41, s37
    s_mov_b64 exec, vcc
    ds_write_b32 v98, v90
    s_mov_b64 exec, -1
    s_branch L2_xr25
L2_xs25:
    s_waitcnt lgkmcnt(0)
    s_mov_b32 s37, 0x10000
    s_branch L2_xw25
L2_c26:
    s_lshl_b64 s[52:53], s[82:83], 1
    s_andn2_b64 s[52:53], s[52:53], s[80:81]
    s_andn2_b64 s[52:53], s[52:53], s[54:55]
    s_or_b64 s[80:81], s[80:81], s[52:53]
    s_not_b64 vcc, s[52:53]
    s_mov_b64 exec, -1
    v_cndmask_b32_dpp v84, v84, v84, vcc wave_shr:1 row_mask:0xf bank_mask:0xf
    v_cndmask_b32_dpp v85, v85, v85, vcc wave_shr:1 row_mask:0xf bank_mask:0xf
    s_lshr_b64 s[52:53], s[52:53], 1
    v_cndmask_b32_dpp v86, v86, v86, vcc wave_shr:1 row_mask:0xf bank_mask:0xf
    v_cndmask_b32_dpp v87, v87, v87, vcc wave_shr:1 row_mask:0xf bank_mask:0xf
    s_andn2_b64 s[82:83], s[82:83], s[52:53]
    v_cndmask_b32_dpp v7, v7, v7, vcc wave_shr:1 row_mask:0xf bank_mask:0xf
    s_mov_b64 exec, s[54:55]
    s_cbranch_scc0 L2_d26
    s_mov_b64 exec, s[82:83]
    s_nop 1
    v_mfma_f32_4x4x4_16b_bf16 v[88:91], v[12:13], v[84:85], 0
    s_nop 1
    v_mfma_f32_4x4x4_16b_bf16 v[88:91], v[10:11], v[86:87], v[88:91]
    s_nop 4
    v_cvt_pk_bf16_f32 v88, v88, v89
    v_cvt_pk_bf16_f32 v89, v90, v91
    ds_pk_add_bf16 v7, v88 offset:65408
    ds_pk_add_bf16 v7, v89 offset:65412
    s_mov_b64 exec, s[54:55]
    s_branch L2_d26
L2_c27:
    s_lshl_b64 s[52:53], s[82:83], 1
    s_andn2_b64 s[52:53], s[52:53], s[80:81]
    s_andn2_b64 s[52:53], s[52:53], s[50:51]
    s_or_b64 s[80:81], s[80:81], s[52:53]
    s_not_b64 vcc, s[52:53]
    s_mov_b64 exec, -1
    v_cndmask_b32_dpp v84, v84, v84, vcc wave_shr:1 row_mask:0xf bank_mask:0xf
    v_cndmask_b32_dpp v85, v85, v85, vcc wave_shr:1 row_mask:0xf bank_mask:0xf
    s_lshr_b64 s[52:53], s[52:53], 1
    v_cndmask_b32_dpp v86, v86, v86, vcc wave_shr:1 row_mask:0xf bank_mask:0xf
    v_cndmask_b32_dpp v87, v87, v87, vcc wave_shr:1 row_mask:0xf bank_mask:0xf
    s_andn2_b64 s[82:83], s[82:83], s[52:53]
    v_cndmask_b32_dpp v7, v7, v7, vcc wave_shr:1 row_mask:0xf bank_mask:0xf
    s_mov_b64 exec, s[50:51]
    s_cbranch_scc0 L2_d27
    s_mov_b64 exec, s[82:83]
    s_nop 1
    v_mfma_f32_4x4x4_16b_bf16 v[88:91], v[12:13], v[84:85], 0
    s_nop 1
    v_mfma_f32_4x4x4_16b_bf16 v[88:91], v[10:11], v[86:87], v[88:91]
    s_nop 4
    v_cvt_pk_bf16_f32 v88, v88, v89
    v_cvt_pk_bf16_f32 v89, v90, v91
    ds_pk_add_bf16 v7, v88 offset:65408
    ds_pk_add_bf16 v7, v89 offset:65412
    s_mov_b64 exec, s[50:51]
    s_branch L2_d27
L2_xf25:
    s_cmp_gt_u32 s37, 1024
    s_cbranch_scc1 L2_xt25
    s_cmp_lt_u32 s37, 768
    s_cbranch_scc1 L2_xl25
    ds_read_b32 v32, v44 offset:896
    s_add_u32 s3, s42, 2
    s_bitset1_b32 s43, s3
    s_branch L2_xg25
L2_xl25:
    s_waitcnt lgkmcnt(0)
    v_mov_b32 v31, -1
    s_cmp_ge_u32 s37, 512
    s_cbranch_scc1 L2_xg25
    v_mov_b32 v39, -1
    s_cmp_ge_u32 s37, 256
    s_cbranch_scc1 L2_xg25
    v_mov_b32 v27, -1
    s_branch L2_xg25
L2_xt25:
    s_waitcnt lgkmcnt(0)
    v_mov_b32 v21, -1
    v_mov_b32 v27, -1
    v_mov_b32 v39, -1
    v_mov_b32 v31, -1
    s_add_u32 s3, s42, 2
    s_bitset1_b32 s36, s3
    s_branch L2_xg25
L2_oa28:
    v_and_b32 v47, 0x0fffffff, v33
    buffer_load_dword v114, v47, s[8:11], 0 offen offset:16
    s_mov_b64 exec, s[6:7]
    v_add_u32 v47, 8, v47
    v_lshrrev_b32 v33, 2, v33
    s_mov_b64 exec, -1
    buffer_load_dwordx2 v[112:113], v47, s[8:11], 0 offen
    s_branch L2_ob28
L2_c29:
    s_lshl_b64 s[52:53], s[82:83], 1
    s_andn2_b64 s[52:53], s[52:53], s[80:81]
    s_andn2_b64 s[52:53], s[52:53], s[54:55]
    s_or_b64 s[80:81], s[80:81], s[52:53]
    s_not_b64 vcc, s[52:53]
    s_mov_b64 exec, -1
    v_cndmask_b32_dpp v84, v84, v84, vcc wave_shr:1 row_mask:0xf bank_mask:0xf
    v_cndmask_b32_dpp v85, v85, v85, vcc wave_shr:1 row_mask:0xf bank_mask:0xf
    s_lshr_b64 s[52:53], s[52:53], 1
    v_cndmask_b32_dpp v86, v86, v86, vcc wave_shr:1 row_mask:0xf bank_mask:0xf
    v_cndmask_b32_dpp v87, v87, v87, vcc wave_shr:1 row_mask:0xf bank_mask:0xf
    s_andn2_b64 s[82:83], s[82:83], s[52:53]
    v_cndmask_b32_dpp v7, v7, v7, vcc wave_shr:1 row_mask:0xf bank_mask:0xf
    s_mov_b64 exec, s[54:55]
    s_cbranch_scc0 L2_d29
    s_mov_b64 exec, s[82:83]
    s_nop 1
    v_mfma_f32_4x4x4_16b_bf16 v[88:91], v[12:13], v[84:85], 0
    s_nop 1
    v_mfma_f32_4x4x4_16b_bf16 v[88:91], v[10:11], v[86:87], v[88:91]
    s_nop 4
    v_cvt_pk_bf16_f32 v88, v88, v89
    v_cvt_pk_bf16_f32 v89, v90, v91
    ds_pk_add_bf16 v7, v88 offset:65408
    ds_pk_add_bf16 v7, v89 offset:65412
    s_mov_b64 exec, s[54:55]
    s_branch L2_d29
L2_c30:
    s_lshl_b64 s[52:53], s[82:83], 1
    s_andn2_b64 s[52:53], s[52:53], s[80:81]
    s_andn2_b64 s[52:53], s[52:53], s[50:51]
    s_or_b64 s[80:81], s[80:81], s[52:53]
    s_not_b64 vcc, s[52:53]
    s_mov_b64 exec, -1
    v_cndmask_b32_dpp v84, v84, v84, vcc wave_shr:1 row_mask:0xf bank_mask:0xf
    v_cndmask_b32_dpp v85, v85, v85, vcc wave_shr:1 row_mask:0xf bank_mask:0xf
    s_lshr_b64 s[52:53], s[52:53], 1
    v_cndmask_b32_dpp v86, v86, v86, vcc wave_shr:1 row_mask:0xf bank_mask:0xf
    v_cndmask_b32_dpp v87, v87, v87, vcc wave_shr:1 row_mask:0xf bank_mask:0xf
    s_andn2_b64 s[82:83], s[82:83], s[52:53]
    v_cndmask_b32_dpp v7, v7, v7, vcc wave_shr:1 row_mask:0xf bank_mask:0xf
    s_mov_b64 exec, s[50:51]
    s_cbranch_scc0 L2_d30
    s_mov_b64 exec, s[82:83]
    s_nop 1
    v_mfma_f32_4x4x4_16b_bf16 v[88:91], v[12:13], v[84:85], 0
    s_nop 1
    v_mfma_f32_4x4x4_16b_bf16 v[88:91], v[10:11], v[86:87], v[88:91]
    s_nop 4
    v_cvt_pk_bf16_f32 v88, v88, v89
    v_cvt_pk_bf16_f32 v89, v90, v91
    ds_pk_add_bf16 v7, v88 offset:65408
    ds_pk_add_bf16 v7, v89 offset:65412
    s_mov_b64 exec, s[50:51]
    s_branch L2_d30
L2_c31:
    s_lshl_b64 s[52:53], s[82:83], 1
    s_andn2_b64 s[52:53], s[52:53], s[80:81]
    s_andn2_b64 s[52:53], s[52:53], s[54:55]
    s_or_b64 s[80:81], s[80:81], s[52:53]
    s_not_b64 vcc, s[52:53]
    s_mov_b64 exec, -1
    v_cndmask_b32_dpp v84, v84, v84, vcc wave_shr:1 row_mask:0xf bank_mask:0xf
    v_cndmask_b32_dpp v85, v85, v85, vcc wave_shr:1 row_mask:0xf bank_mask:0xf
    s_lshr_b64 s[52:53], s[52:53], 1
    v_cndmask_b32_dpp v86, v86, v86, vcc wave_shr:1 row_mask:0xf bank_mask:0xf
    v_cndmask_b32_dpp v87, v87, v87, vcc wave_shr:1 row_mask:0xf bank_mask:0xf
    s_andn2_b64 s[82:83], s[82:83], s[52:53]
    v_cndmask_b32_dpp v7, v7, v7, vcc wave_shr:1 row_mask:0xf bank_mask:0xf
    s_mov_b64 exec, s[54:55]
    s_cbranch_scc0 L2_d31
    s_mov_b64 exec, s[82:83]
    s_nop 1
    v_mfma_f32_4x4x4_16b_bf16 v[88:91], v[12:13], v[84:85], 0
    s_nop 1
    v_mfma_f32_4x4x4_16b_bf16 v[88:91], v[10:11], v[86:87], v[88:91]
    s_nop 4
    v_cvt_pk_bf16_f32 v88, v88, v89
    v_cvt_pk_bf16_f32 v89, v90, v91
    ds_pk_add_bf16 v7, v88 offset:65408
    ds_pk_add_bf16 v7, v89 offset:65412
    s_mov_b64 exec, s[54:55]
    s_branch L2_d31
L2_c32:
    s_lshl_b64 s[52:53], s[82:83], 1
    s_andn2_b64 s[52:53], s[52:53], s[80:81]
    s_andn2_b64 s[52:53], s[52:53], s[50:51]
    s_or_b64 s[80:81], s[80:81], s[52:53]
    s_not_b64 vcc, s[52:53]
    s_mov_b64 exec, -1
    v_cndmask_b32_dpp v84, v84, v84, vcc wave_shr:1 row_mask:0xf bank_mask:0xf
    v_cndmask_b32_dpp v85, v85, v85, vcc wave_shr:1 row_mask:0xf bank_mask:0xf
    s_lshr_b64 s[52:53], s[52:53], 1
    v_cndmask_b32_dpp v86, v86, v86, vcc wave_shr:1 row_mask:0xf bank_mask:0xf
    v_cndmask_b32_dpp v87, v87, v87, vcc wave_shr:1 row_mask:0xf bank_mask:0xf
    s_andn2_b64 s[82:83], s[82:83], s[52:53]
    v_cndmask_b32_dpp v7, v7, v7, vcc wave_shr:1 row_mask:0xf bank_mask:0xf
    s_mov_b64 exec, s[50:51]
    s_cbranch_scc0 L2_d32
    s_mov_b64 exec, s[82:83]
    s_nop 1
    v_mfma_f32_4x4x4_16b_bf16 v[88:91], v[12:13], v[84:85], 0
    s_nop 1
    v_mfma_f32_4x4x4_16b_bf16 v[88:91], v[10:11], v[86:87], v[88:91]
    s_nop 4
    v_cvt_pk_bf16_f32 v88, v88, v89
    v_cvt_pk_bf16_f32 v89, v90, v91
    ds_pk_add_bf16 v7, v88 offset:65408
    ds_pk_add_bf16 v7, v89 offset:65412
    s_mov_b64 exec, s[50:51]
    s_branch L2_d32
L2_c33:
    s_lshl_b64 s[52:53], s[82:83], 1
    s_andn2_b64 s[52:53], s[52:53], s[80:81]
    s_andn2_b64 s[52:53], s[52:53], s[54:55]
    s_or_b64 s[80:81], s[80:81], s[52:53]
    s_not_b64 vcc, s[52:53]
    s_mov_b64 exec, -1
    v_cndmask_b32_dpp v84, v84, v84, vcc wave_shr:1 row_mask:0xf bank_mask:0xf
    v_cndmask_b32_dpp v85, v85, v85, vcc wave_shr:1 row_mask:0xf bank_mask:0xf
    s_lshr_b64 s[52:53], s[52:53], 1
    v_cndmask_b32_dpp v86, v86, v86, vcc wave_shr:1 row_mask:0xf bank_mask:0xf
    v_cndmask_b32_dpp v87, v87, v87, vcc wave_shr:1 row_mask:0xf bank_mask:0xf
    s_andn2_b64 s[82:83], s[82:83], s[52:53]
    v_cndmask_b32_dpp v7, v7, v7, vcc wave_shr:1 row_mask:0xf bank_mask:0xf
    s_mov_b64 exec, s[54:55]
    s_cbranch_scc0 L2_d33
    s_mov_b64 exec, s[82:83]
    s_nop 1
    v_mfma_f32_4x4x4_16b_bf16 v[88:91], v[12:13], v[84:85], 0
    s_nop 1
    v_mfma_f32_4x4x4_16b_bf16 v[88:91], v[10:11], v[86:87], v[88:91]
    s_nop 4
    v_cvt_pk_bf16_f32 v88, v88, v89
    v_cvt_pk_bf16_f32 v89, v90, v91
    ds_pk_add_bf16 v7, v88 offset:65408
    ds_pk_add_bf16 v7, v89 offset:65412
    s_mov_b64 exec, s[54:55]
    s_branch L2_d33
L2_c34:
    s_lshl_b64 s[52:53], s[82:83], 1
    s_andn2_b64 s[52:53], s[52:53], s[80:81]
    s_andn2_b64 s[52:53], s[52:53], s[50:51]
    s_or_b64 s[80:81], s[80:81], s[52:53]
    s_not_b64 vcc, s[52:53]
    s_mov_b64 exec, -1
    v_cndmask_b32_dpp v84, v84, v84, vcc wave_shr:1 row_mask:0xf bank_mask:0xf
    v_cndmask_b32_dpp v85, v85, v85, vcc wave_shr:1 row_mask:0xf bank_mask:0xf
    s_lshr_b64 s[52:53], s[52:53], 1
    v_cndmask_b32_dpp v86, v86, v86, vcc wave_shr:1 row_mask:0xf bank_mask:0xf
    v_cndmask_b32_dpp v87, v87, v87, vcc wave_shr:1 row_mask:0xf bank_mask:0xf
    s_andn2_b64 s[82:83], s[82:83], s[52:53]
    v_cndmask_b32_dpp v7, v7, v7, vcc wave_shr:1 row_mask:0xf bank_mask:0xf
    s_mov_b64 exec, s[50:51]
    s_cbranch_scc0 L2_d34
    s_mov_b64 exec, s[82:83]
    s_nop 1
    v_mfma_f32_4x4x4_16b_bf16 v[88:91], v[12:13], v[84:85], 0
    s_nop 1
    v_mfma_f32_4x4x4_16b_bf16 v[88:91], v[10:11], v[86:87], v[88:91]
    s_nop 4
    v_cvt_pk_bf16_f32 v88, v88, v89
    v_cvt_pk_bf16_f32 v89, v90, v91
    ds_pk_add_bf16 v7, v88 offset:65408
    ds_pk_add_bf16 v7, v89 offset:65412
    s_mov_b64 exec, s[50:51]
    s_branch L2_d34
L2_oa35:
    s_waitcnt vmcnt(3)
    s_mov_b64 exec, s[6:7]
    v_lshrrev_b32 v114, 16, v114
    s_mov_b64 exec, -1
    v_and_b32 v46, 0x10000000, v33
    v_cmpx_eq_u32 vcc, 0, v46
    v_lshrrev_b32 v47, 14, v112
    v_and_b32 v47, v5, v47
    ds_read_b64 v[96:97], v47
    v_perm_b32 v98, v112, v114, s44
    v_bitop3_b32 v99, v112, 0.5, -0.5 bitop3:0xa8
    v_bitop3_b32 v98, v6, v98, v99 bitop3:0xca
    v_and_b32 v47, v5, v112
    s_waitcnt lgkmcnt(0)
    v_mfma_f32_4x4x4_16b_bf16 v[88:91], v[8:9], v[96:97], 0
    s_nop 4
    v_mul_f32 v88, v98, v88
    v_mul_f32 v89, v98, v89
    v_mul_f32 v90, v98, v90
    v_mul_f32 v91, v98, v91
    v_cvt_pk_bf16_f32 v88, v88, v89
    v_cvt_pk_bf16_f32 v89, v90, v91
    ds_pk_add_bf16 v47, v88 offset:65408
    ds_pk_add_bf16 v47, v89 offset:65412
    s_mov_b64 exec, -1
    v_and_b32 v46, 0x20000000, v33
    v_cmpx_eq_u32 vcc, 0, v46
    v_lshrrev_b32 v47, 14, v113
    v_and_b32 v47, v5, v47
    ds_read_b64 v[96:97], v47
    v_perm_b32 v98, v113, v114, s45
    v_bitop3_b32 v99, v113, 0.5, -0.5 bitop3:0xa8
    v_bitop3_b32 v98, v6, v98, v99 bitop3:0xca
    v_and_b32 v47, v5, v113
    s_waitcnt lgkmcnt(0)
    v_mfma_f32_4x4x4_16b_bf16 v[88:91], v[8:9], v[96:97], 0
    s_nop 4
    v_mul_f32 v88, v98, v88
    v_mul_f32 v89, v98, v89
    v_mul_f32 v90, v98, v90
    v_mul_f32 v91, v98, v91
    v_cvt_pk_bf16_f32 v88, v88, v89
    v_cvt_pk_bf16_f32 v89, v90, v91
    ds_pk_add_bf16 v47, v88 offset:65408
    ds_pk_add_bf16 v47, v89 offset:65412
    s_mov_b64 exec, -1
    s_branch L2_ob35
L2_xo36:
    v_cmp_lt_u32 vcc, 20, v99
    s_mov_b32 s101, 1
    s_cbranch_vccz L2_xp36
    v_cmp_lt_u32 vcc, 32, v99
    v_cmp_lt_u32 s[58:59], 31, v88
    s_mov_b32 s101, 2
    s_or_b64 vcc, vcc, s[58:59]
    s_cbranch_scc0 L2_xp36
    s_mov_b32 s37, 0x10000
    s_branch L2_xp36
L2_c37:
    s_lshl_b64 s[52:53], s[82:83], 1
    s_andn2_b64 s[52:53], s[52:53], s[80:81]
    s_andn2_b64 s[52:53], s[52:53], s[54:55]
    s_or_b64 s[80:81], s[80:81], s[52:53]
    s_not_b64 vcc, s[52:53]
    s_mov_b64 exec, -1
    v_cndmask_b32_dpp v84, v84, v84, vcc wave_shr:1 row_mask:0xf bank_mask:0xf
    v_cndmask_b32_dpp v85, v85, v85, vcc wave_shr:1 row_mask:0xf bank_mask:0xf
    s_lshr_b64 s[52:53], s[52:53], 1
    v_cndmask_b32_dpp v86, v86, v86, vcc wave_shr:1 row_mask:0xf bank_mask:0xf
    v_cndmask_b32_dpp v87, v87, v87, vcc wave_shr:1 row_mask:0xf bank_mask:0xf
    s_andn2_b64 s[82:83], s[82:83], s[52:53]
    v_cndmask_b32_dpp v7, v7, v7, vcc wave_shr:1 row_mask:0xf bank_mask:0xf
    s_mov_b64 exec, s[54:55]
    s_cbranch_scc0 L2_d37
    s_mov_b64 exec, s[82:83]
    s_nop 1
    v_mfma_f32_4x4x4_16b_bf16 v[88:91], v[12:13], v[84:85], 0
    s_nop 1
    v_mfma_f32_4x4x4_16b_bf16 v[88:91], v[10:11], v[86:87], v[88:91]
    s_nop 4
    v_cvt_pk_bf16_f32 v88, v88, v89
    v_cvt_pk_bf16_f32 v89, v90, v91
    ds_pk_add_bf16 v7, v88 offset:65408
    ds_pk_add_bf16 v7, v89 offset:65412
    s_mov_b64 exec, s[54:55]
    s_branch L2_d37
L2_c38:
    s_lshl_b64 s[52:53], s[82:83], 1
    s_andn2_b64 s[52:53], s[52:53], s[80:81]
    s_andn2_b64 s[52:53], s[52:53], s[50:51]
    s_or_b64 s[80:81], s[80:81], s[52:53]
    s_not_b64 vcc, s[52:53]
    s_mov_b64 exec, -1
    v_cndmask_b32_dpp v84, v84, v84, vcc wave_shr:1 row_mask:0xf bank_mask:0xf
    v_cndmask_b32_dpp v85, v85, v85, vcc wave_shr:1 row_mask:0xf bank_mask:0xf
    s_lshr_b64 s[52:53], s[52:53], 1
    v_cndmask_b32_dpp v86, v86, v86, vcc wave_shr:1 row_mask:0xf bank_mask:0xf
    v_cndmask_b32_dpp v87, v87, v87, vcc wave_shr:1 row_mask:0xf bank_mask:0xf
    s_andn2_b64 s[82:83], s[82:83], s[52:53]
    v_cndmask_b32_dpp v7, v7, v7, vcc wave_shr:1 row_mask:0xf bank_mask:0xf
    s_mov_b64 exec, s[50:51]
    s_cbranch_scc0 L2_d38
    s_mov_b64 exec, s[82:83]
    s_nop 1
    v_mfma_f32_4x4x4_16b_bf16 v[88:91], v[12:13], v[84:85], 0
    s_nop 1
    v_mfma_f32_4x4x4_16b_bf16 v[88:91], v[10:11], v[86:87], v[88:91]
    s_nop 4
    v_cvt_pk_bf16_f32 v88, v88, v89
    v_cvt_pk_bf16_f32 v89, v90, v91
    ds_pk_add_bf16 v7, v88 offset:65408
    ds_pk_add_bf16 v7, v89 offset:65412
    s_mov_b64 exec, s[50:51]
    s_branch L2_d38
L2_c39:
    s_lshl_b64 s[52:53], s[82:83], 1
    s_andn2_b64 s[52:53], s[52:53], s[80:81]
    s_andn2_b64 s[52:53], s[52:53], s[54:55]
    s_or_b64 s[80:81], s[80:81], s[52:53]
    s_not_b64 vcc, s[52:53]
    s_mov_b64 exec, -1
    v_cndmask_b32_dpp v84, v84, v84, vcc wave_shr:1 row_mask:0xf bank_mask:0xf
    v_cndmask_b32_dpp v85, v85, v85, vcc wave_shr:1 row_mask:0xf bank_mask:0xf
    s_lshr_b64 s[52:53], s[52:53], 1
    v_cndmask_b32_dpp v86, v86, v86, vcc wave_shr:1 row_mask:0xf bank_mask:0xf
    v_cndmask_b32_dpp v87, v87, v87, vcc wave_shr:1 row_mask:0xf bank_mask:0xf
    s_andn2_b64 s[82:83], s[82:83], s[52:53]
    v_cndmask_b32_dpp v7, v7, v7, vcc wave_shr:1 row_mask:0xf bank_mask:0xf
    s_mov_b64 exec, s[54:55]
    s_cbranch_scc0 L2_d39
    s_mov_b64 exec, s[82:83]
    s_nop 1
    v_mfma_f32_4x4x4_16b_bf16 v[88:91], v[12:13], v[84:85], 0
    s_nop 1
    v_mfma_f32_4x4x4_16b_bf16 v[88:91], v[10:11], v[86:87], v[88:91]
    s_nop 4
    v_cvt_pk_bf16_f32 v88, v88, v89
    v_cvt_pk_bf16_f32 v89, v90, v91
    ds_pk_add_bf16 v7, v88 offset:65408
    ds_pk_add_bf16 v7, v89 offset:65412
    s_mov_b64 exec, s[54:55]
    s_branch L2_d39
L2_c40:
    s_lshl_b64 s[52:53], s[82:83], 1
    s_andn2_b64 s[52:53], s[52:53], s[80:81]
    s_andn2_b64 s[52:53], s[52:53], s[50:51]
    s_or_b64 s[80:81], s[80:81], s[52:53]
    s_not_b64 vcc, s[52:53]
    s_mov_b64 exec, -1
    v_cndmask_b32_dpp v84, v84, v84, vcc wave_shr:1 row_mask:0xf bank_mask:0xf
    v_cndmask_b32_dpp v85, v85, v85, vcc wave_shr:1 row_mask:0xf bank_mask:0xf
    s_lshr_b64 s[52:53], s[52:53], 1
    v_cndmask_b32_dpp v86, v86, v86, vcc wave_shr:1 row_mask:0xf bank_mask:0xf
    v_cndmask_b32_dpp v87, v87, v87, vcc wave_shr:1 row_mask:0xf bank_mask:0xf
    s_andn2_b64 s[82:83], s[82:83], s[52:53]
    v_cndmask_b32_dpp v7, v7, v7, vcc wave_shr:1 row_mask:0xf bank_mask:0xf
    s_mov_b64 exec, s[50:51]
    s_cbranch_scc0 L2_d40
    s_mov_b64 exec, s[82:83]
    s_nop 1
    v_mfma_f32_4x4x4_16b_bf16 v[88:91], v[12:13], v[84:85], 0
    s_nop 1
    v_mfma_f32_4x4x4_16b_bf16 v[88:91], v[10:11], v[86:87], v[88:91]
    s_nop 4
    v_cvt_pk_bf16_f32 v88, v88, v89
    v_cvt_pk_bf16_f32 v89, v90, v91
    ds_pk_add_bf16 v7, v88 offset:65408
    ds_pk_add_bf16 v7, v89 offset:65412
    s_mov_b64 exec, s[50:51]
    s_branch L2_d40
L2_c41:
    s_lshl_b64 s[52:53], s[82:83], 1
    s_andn2_b64 s[52:53], s[52:53], s[80:81]
    s_andn2_b64 s[52:53], s[52:53], s[54:55]
    s_or_b64 s[80:81], s[80:81], s[52:53]
    s_not_b64 vcc, s[52:53]
    s_mov_b64 exec, -1
    v_cndmask_b32_dpp v84, v84, v84, vcc wave_shr:1 row_mask:0xf bank_mask:0xf
    v_cndmask_b32_dpp v85, v85, v85, vcc wave_shr:1 row_mask:0xf bank_mask:0xf
    s_lshr_b64 s[52:53], s[52:53], 1
    v_cndmask_b32_dpp v86, v86, v86, vcc wave_shr:1 row_mask:0xf bank_mask:0xf
    v_cndmask_b32_dpp v87, v87, v87, vcc wave_shr:1 row_mask:0xf bank_mask:0xf
    s_andn2_b64 s[82:83], s[82:83], s[52:53]
    v_cndmask_b32_dpp v7, v7, v7, vcc wave_shr:1 row_mask:0xf bank_mask:0xf
    s_mov_b64 exec, s[54:55]
    s_cbranch_scc0 L2_d41
    s_mov_b64 exec, s[82:83]
    s_nop 1
    v_mfma_f32_4x4x4_16b_bf16 v[88:91], v[12:13], v[84:85], 0
    s_nop 1
    v_mfma_f32_4x4x4_16b_bf16 v[88:91], v[10:11], v[86:87], v[88:91]
    s_nop 4
    v_cvt_pk_bf16_f32 v88, v88, v89
    v_cvt_pk_bf16_f32 v89, v90, v91
    ds_pk_add_bf16 v7, v88 offset:65408
    ds_pk_add_bf16 v7, v89 offset:65412
    s_mov_b64 exec, s[54:55]
    s_branch L2_d41
L2_c42:
    s_lshl_b64 s[52:53], s[82:83], 1
    s_andn2_b64 s[52:53], s[52:53], s[80:81]
    s_andn2_b64 s[52:53], s[52:53], s[50:51]
    s_or_b64 s[80:81], s[80:81], s[52:53]
    s_not_b64 vcc, s[52:53]
    s_mov_b64 exec, -1
    v_cndmask_b32_dpp v84, v84, v84, vcc wave_shr:1 row_mask:0xf bank_mask:0xf
    v_cndmask_b32_dpp v85, v85, v85, vcc wave_shr:1 row_mask:0xf bank_mask:0xf
    s_lshr_b64 s[52:53], s[52:53], 1
    v_cndmask_b32_dpp v86, v86, v86, vcc wave_shr:1 row_mask:0xf bank_mask:0xf
    v_cndmask_b32_dpp v87, v87, v87, vcc wave_shr:1 row_mask:0xf bank_mask:0xf
    s_andn2_b64 s[82:83], s[82:83], s[52:53]
    v_cndmask_b32_dpp v7, v7, v7, vcc wave_shr:1 row_mask:0xf bank_mask:0xf
    s_mov_b64 exec, s[50:51]
    s_cbranch_scc0 L2_d42
    s_mov_b64 exec, s[82:83]
    s_nop 1
    v_mfma_f32_4x4x4_16b_bf16 v[88:91], v[12:13], v[84:85], 0
    s_nop 1
    v_mfma_f32_4x4x4_16b_bf16 v[88:91], v[10:11], v[86:87], v[88:91]
    s_nop 4
    v_cvt_pk_bf16_f32 v88, v88, v89
    v_cvt_pk_bf16_f32 v89, v90, v91
    ds_pk_add_bf16 v7, v88 offset:65408
    ds_pk_add_bf16 v7, v89 offset:65412
    s_mov_b64 exec, s[50:51]
    s_branch L2_d42
L2_xa43:
    s_cmp_eq_u32 s101, 1
    s_cbranch_scc1 L2_xc43
    v_lshlrev_b32 v89, 0, v96
    v_add_u32 v90, 140, v97
    v_bitop3_b32 v90, v89, v45, v90 bitop3:0x6a
    ds_write_b32 v98, v90 offset:28
    v_lshlrev_b32 v89, 4, v96
    v_add_u32 v90, 120, v97
    v_bitop3_b32 v90, v89, v45, v90 bitop3:0x6a
    ds_write_b32 v98, v90 offset:24
    v_lshlrev_b32 v89, 8, v96
    v_add_u32 v90, 100, v97
    v_bitop3_b32 v90, v89, v45, v90 bitop3:0x6a
    ds_write_b32 v98, v90 offset:20
L2_xc43:
    v_lshlrev_b32 v89, 12, v96
    v_add_u32 v90, 80, v97
    v_bitop3_b32 v90, v89, v45, v90 bitop3:0x6a
    ds_write_b32 v98, v90 offset:16
    s_branch L2_xb43
L2_xe43:
    v_cmp_lt_u32 vcc, 32, v99
    v_cmp_lt_u32 s[58:59], 31, v88
    v_lshrrev_b32 v89, 16, v96
    v_add_u32 v97, 80, v97
    s_or_b64 vcc, vcc, s[58:59]
    s_cbranch_scc1 L2_xs43
    v_lshlrev_b32 v89, v1, v89
    v_and_b32 v89, v45, v89
    v_cmp_ne_u32 vcc, 0, v89
    v_xor_b32 v90, v97, v89
    s_add_u32 s3, s37, s38
    v_mbcnt_lo_u32_b32 v98, vcc_lo, 0
    v_mbcnt_hi_u32_b32 v98, vcc_hi, v98
    s_bcnt1_i32_b64 s41, vcc
    v_lshl_add_u32 v98, v98, 2, s3
    s_lshl2_add_u32 s37, s41, s37
    s_mov_b64 exec, vcc
    ds_write_b32 v98, v90
    s_mov_b64 exec, -1
    s_branch L2_xr43
L2_xs43:
    s_waitcnt lgkmcnt(0)
    s_mov_b32 s37, 0x10000
    s_branch L2_xw43
L2_c44:
    s_lshl_b64 s[52:53], s[82:83], 1
    s_andn2_b64 s[52:53], s[52:53], s[80:81]
    s_andn2_b64 s[52:53], s[52:53], s[54:55]
    s_or_b64 s[80:81], s[80:81], s[52:53]
    s_not_b64 vcc, s[52:53]
    s_mov_b64 exec, -1
    v_cndmask_b32_dpp v84, v84, v84, vcc wave_shr:1 row_mask:0xf bank_mask:0xf
    v_cndmask_b32_dpp v85, v85, v85, vcc wave_shr:1 row_mask:0xf bank_mask:0xf
    s_lshr_b64 s[52:53], s[52:53], 1
    v_cndmask_b32_dpp v86, v86, v86, vcc wave_shr:1 row_mask:0xf bank_mask:0xf
    v_cndmask_b32_dpp v87, v87, v87, vcc wave_shr:1 row_mask:0xf bank_mask:0xf
    s_andn2_b64 s[82:83], s[82:83], s[52:53]
    v_cndmask_b32_dpp v7, v7, v7, vcc wave_shr:1 row_mask:0xf bank_mask:0xf
    s_mov_b64 exec, s[54:55]
    s_cbranch_scc0 L2_d44
    s_mov_b64 exec, s[82:83]
    s_nop 1
    v_mfma_f32_4x4x4_16b_bf16 v[88:91], v[12:13], v[84:85], 0
    s_nop 1
    v_mfma_f32_4x4x4_16b_bf16 v[88:91], v[10:11], v[86:87], v[88:91]
    s_nop 4
    v_cvt_pk_bf16_f32 v88, v88, v89
    v_cvt_pk_bf16_f32 v89, v90, v91
    ds_pk_add_bf16 v7, v88 offset:65408
    ds_pk_add_bf16 v7, v89 offset:65412
    s_mov_b64 exec, s[54:55]
    s_branch L2_d44
L2_c45:
    s_lshl_b64 s[52:53], s[82:83], 1
    s_andn2_b64 s[52:53], s[52:53], s[80:81]
    s_andn2_b64 s[52:53], s[52:53], s[50:51]
    s_or_b64 s[80:81], s[80:81], s[52:53]
    s_not_b64 vcc, s[52:53]
    s_mov_b64 exec, -1
    v_cndmask_b32_dpp v84, v84, v84, vcc wave_shr:1 row_mask:0xf bank_mask:0xf
    v_cndmask_b32_dpp v85, v85, v85, vcc wave_shr:1 row_mask:0xf bank_mask:0xf
    s_lshr_b64 s[52:53], s[52:53], 1
    v_cndmask_b32_dpp v86, v86, v86, vcc wave_shr:1 row_mask:0xf bank_mask:0xf
    v_cndmask_b32_dpp v87, v87, v87, vcc wave_shr:1 row_mask:0xf bank_mask:0xf
    s_andn2_b64 s[82:83], s[82:83], s[52:53]
    v_cndmask_b32_dpp v7, v7, v7, vcc wave_shr:1 row_mask:0xf bank_mask:0xf
    s_mov_b64 exec, s[50:51]
    s_cbranch_scc0 L2_d45
    s_mov_b64 exec, s[82:83]
    s_nop 1
    v_mfma_f32_4x4x4_16b_bf16 v[88:91], v[12:13], v[84:85], 0
    s_nop 1
    v_mfma_f32_4x4x4_16b_bf16 v[88:91], v[10:11], v[86:87], v[88:91]
    s_nop 4
    v_cvt_pk_bf16_f32 v88, v88, v89
    v_cvt_pk_bf16_f32 v89, v90, v91
    ds_pk_add_bf16 v7, v88 offset:65408
    ds_pk_add_bf16 v7, v89 offset:65412
    s_mov_b64 exec, s[50:51]
    s_branch L2_d45
L2_xf43:
    s_cmp_gt_u32 s37, 1024
    s_cbranch_scc1 L2_xt43
    s_cmp_lt_u32 s37, 768
    s_cbranch_scc1 L2_xl43
    ds_read_b32 v33, v44 offset:896
    s_add_u32 s3, s42, 2
    s_bitset1_b32 s43, s3
    s_branch L2_xg43
L2_xl43:
    s_waitcnt lgkmcnt(0)
    v_mov_b32 v42, -1
    s_cmp_ge_u32 s37, 512
    s_cbranch_scc1 L2_xg43
    v_mov_b32 v43, -1
    s_cmp_ge_u32 s37, 256
    s_cbranch_scc1 L2_xg43
    v_mov_b32 v41, -1
    s_branch L2_xg43
L2_xt43:
    s_waitcnt lgkmcnt(0)
    v_mov_b32 v40, -1
    v_mov_b32 v41, -1
    v_mov_b32 v43, -1
    v_mov_b32 v42, -1
    s_add_u32 s3, s42, 2
    s_bitset1_b32 s36, s3
    s_branch L2_xg43
L2_oa46:
    v_and_b32 v47, 0x0fffffff, v32
    buffer_load_dword v114, v47, s[8:11], 0 offen offset:16
    s_mov_b64 exec, s[6:7]
    v_add_u32 v47, 8, v47
    v_lshrrev_b32 v32, 2, v32
    s_mov_b64 exec, -1
    buffer_load_dwordx2 v[112:113], v47, s[8:11], 0 offen
    s_branch L2_ob46
L2_c47:
    s_lshl_b64 s[52:53], s[82:83], 1
    s_andn2_b64 s[52:53], s[52:53], s[80:81]
    s_andn2_b64 s[52:53], s[52:53], s[54:55]
    s_or_b64 s[80:81], s[80:81], s[52:53]
    s_not_b64 vcc, s[52:53]
    s_mov_b64 exec, -1
    v_cndmask_b32_dpp v84, v84, v84, vcc wave_shr:1 row_mask:0xf bank_mask:0xf
    v_cndmask_b32_dpp v85, v85, v85, vcc wave_shr:1 row_mask:0xf bank_mask:0xf
    s_lshr_b64 s[52:53], s[52:53], 1
    v_cndmask_b32_dpp v86, v86, v86, vcc wave_shr:1 row_mask:0xf bank_mask:0xf
    v_cndmask_b32_dpp v87, v87, v87, vcc wave_shr:1 row_mask:0xf bank_mask:0xf
    s_andn2_b64 s[82:83], s[82:83], s[52:53]
    v_cndmask_b32_dpp v7, v7, v7, vcc wave_shr:1 row_mask:0xf bank_mask:0xf
    s_mov_b64 exec, s[54:55]
    s_cbranch_scc0 L2_d47
    s_mov_b64 exec, s[82:83]
    s_nop 1
    v_mfma_f32_4x4x4_16b_bf16 v[88:91], v[12:13], v[84:85], 0
    s_nop 1
    v_mfma_f32_4x4x4_16b_bf16 v[88:91], v[10:11], v[86:87], v[88:91]
    s_nop 4
    v_cvt_pk_bf16_f32 v88, v88, v89
    v_cvt_pk_bf16_f32 v89, v90, v91
    ds_pk_add_bf16 v7, v88 offset:65408
    ds_pk_add_bf16 v7, v89 offset:65412
    s_mov_b64 exec, s[54:55]
    s_branch L2_d47
L2_c48:
    s_lshl_b64 s[52:53], s[82:83], 1
    s_andn2_b64 s[52:53], s[52:53], s[80:81]
    s_andn2_b64 s[52:53], s[52:53], s[50:51]
    s_or_b64 s[80:81], s[80:81], s[52:53]
    s_not_b64 vcc, s[52:53]
    s_mov_b64 exec, -1
    v_cndmask_b32_dpp v84, v84, v84, vcc wave_shr:1 row_mask:0xf bank_mask:0xf
    v_cndmask_b32_dpp v85, v85, v85, vcc wave_shr:1 row_mask:0xf bank_mask:0xf
    s_lshr_b64 s[52:53], s[52:53], 1
    v_cndmask_b32_dpp v86, v86, v86, vcc wave_shr:1 row_mask:0xf bank_mask:0xf
    v_cndmask_b32_dpp v87, v87, v87, vcc wave_shr:1 row_mask:0xf bank_mask:0xf
    s_andn2_b64 s[82:83], s[82:83], s[52:53]
    v_cndmask_b32_dpp v7, v7, v7, vcc wave_shr:1 row_mask:0xf bank_mask:0xf
    s_mov_b64 exec, s[50:51]
    s_cbranch_scc0 L2_d48
    s_mov_b64 exec, s[82:83]
    s_nop 1
    v_mfma_f32_4x4x4_16b_bf16 v[88:91], v[12:13], v[84:85], 0
    s_nop 1
    v_mfma_f32_4x4x4_16b_bf16 v[88:91], v[10:11], v[86:87], v[88:91]
    s_nop 4
    v_cvt_pk_bf16_f32 v88, v88, v89
    v_cvt_pk_bf16_f32 v89, v90, v91
    ds_pk_add_bf16 v7, v88 offset:65408
    ds_pk_add_bf16 v7, v89 offset:65412
    s_mov_b64 exec, s[50:51]
    s_branch L2_d48
L2_c49:
    s_lshl_b64 s[52:53], s[82:83], 1
    s_andn2_b64 s[52:53], s[52:53], s[80:81]
    s_andn2_b64 s[52:53], s[52:53], s[54:55]
    s_or_b64 s[80:81], s[80:81], s[52:53]
    s_not_b64 vcc, s[52:53]
    s_mov_b64 exec, -1
    v_cndmask_b32_dpp v84, v84, v84, vcc wave_shr:1 row_mask:0xf bank_mask:0xf
    v_cndmask_b32_dpp v85, v85, v85, vcc wave_shr:1 row_mask:0xf bank_mask:0xf
    s_lshr_b64 s[52:53], s[52:53], 1
    v_cndmask_b32_dpp v86, v86, v86, vcc wave_shr:1 row_mask:0xf bank_mask:0xf
    v_cndmask_b32_dpp v87, v87, v87, vcc wave_shr:1 row_mask:0xf bank_mask:0xf
    s_andn2_b64 s[82:83], s[82:83], s[52:53]
    v_cndmask_b32_dpp v7, v7, v7, vcc wave_shr:1 row_mask:0xf bank_mask:0xf
    s_mov_b64 exec, s[54:55]
    s_cbranch_scc0 L2_d49
    s_mov_b64 exec, s[82:83]
    s_nop 1
    v_mfma_f32_4x4x4_16b_bf16 v[88:91], v[12:13], v[84:85], 0
    s_nop 1
    v_mfma_f32_4x4x4_16b_bf16 v[88:91], v[10:11], v[86:87], v[88:91]
    s_nop 4
    v_cvt_pk_bf16_f32 v88, v88, v89
    v_cvt_pk_bf16_f32 v89, v90, v91
    ds_pk_add_bf16 v7, v88 offset:65408
    ds_pk_add_bf16 v7, v89 offset:65412
    s_mov_b64 exec, s[54:55]
    s_branch L2_d49
L2_c50:
    s_lshl_b64 s[52:53], s[82:83], 1
    s_andn2_b64 s[52:53], s[52:53], s[80:81]
    s_andn2_b64 s[52:53], s[52:53], s[50:51]
    s_or_b64 s[80:81], s[80:81], s[52:53]
    s_not_b64 vcc, s[52:53]
    s_mov_b64 exec, -1
    v_cndmask_b32_dpp v84, v84, v84, vcc wave_shr:1 row_mask:0xf bank_mask:0xf
    v_cndmask_b32_dpp v85, v85, v85, vcc wave_shr:1 row_mask:0xf bank_mask:0xf
    s_lshr_b64 s[52:53], s[52:53], 1
    v_cndmask_b32_dpp v86, v86, v86, vcc wave_shr:1 row_mask:0xf bank_mask:0xf
    v_cndmask_b32_dpp v87, v87, v87, vcc wave_shr:1 row_mask:0xf bank_mask:0xf
    s_andn2_b64 s[82:83], s[82:83], s[52:53]
    v_cndmask_b32_dpp v7, v7, v7, vcc wave_shr:1 row_mask:0xf bank_mask:0xf
    s_mov_b64 exec, s[50:51]
    s_cbranch_scc0 L2_d50
    s_mov_b64 exec, s[82:83]
    s_nop 1
    v_mfma_f32_4x4x4_16b_bf16 v[88:91], v[12:13], v[84:85], 0
    s_nop 1
    v_mfma_f32_4x4x4_16b_bf16 v[88:91], v[10:11], v[86:87], v[88:91]
    s_nop 4
    v_cvt_pk_bf16_f32 v88, v88, v89
    v_cvt_pk_bf16_f32 v89, v90, v91
    ds_pk_add_bf16 v7, v88 offset:65408
    ds_pk_add_bf16 v7, v89 offset:65412
    s_mov_b64 exec, s[50:51]
    s_branch L2_d50
L2_c51:
    s_lshl_b64 s[52:53], s[82:83], 1
    s_andn2_b64 s[52:53], s[52:53], s[80:81]
    s_andn2_b64 s[52:53], s[52:53], s[54:55]
    s_or_b64 s[80:81], s[80:81], s[52:53]
    s_not_b64 vcc, s[52:53]
    s_mov_b64 exec, -1
    v_cndmask_b32_dpp v84, v84, v84, vcc wave_shr:1 row_mask:0xf bank_mask:0xf
    v_cndmask_b32_dpp v85, v85, v85, vcc wave_shr:1 row_mask:0xf bank_mask:0xf
    s_lshr_b64 s[52:53], s[52:53], 1
    v_cndmask_b32_dpp v86, v86, v86, vcc wave_shr:1 row_mask:0xf bank_mask:0xf
    v_cndmask_b32_dpp v87, v87, v87, vcc wave_shr:1 row_mask:0xf bank_mask:0xf
    s_andn2_b64 s[82:83], s[82:83], s[52:53]
    v_cndmask_b32_dpp v7, v7, v7, vcc wave_shr:1 row_mask:0xf bank_mask:0xf
    s_mov_b64 exec, s[54:55]
    s_cbranch_scc0 L2_d51
    s_mov_b64 exec, s[82:83]
    s_nop 1
    v_mfma_f32_4x4x4_16b_bf16 v[88:91], v[12:13], v[84:85], 0
    s_nop 1
    v_mfma_f32_4x4x4_16b_bf16 v[88:91], v[10:11], v[86:87], v[88:91]
    s_nop 4
    v_cvt_pk_bf16_f32 v88, v88, v89
    v_cvt_pk_bf16_f32 v89, v90, v91
    ds_pk_add_bf16 v7, v88 offset:65408
    ds_pk_add_bf16 v7, v89 offset:65412
    s_mov_b64 exec, s[54:55]
    s_branch L2_d51
L2_c52:
    s_lshl_b64 s[52:53], s[82:83], 1
    s_andn2_b64 s[52:53], s[52:53], s[80:81]
    s_andn2_b64 s[52:53], s[52:53], s[50:51]
    s_or_b64 s[80:81], s[80:81], s[52:53]
    s_not_b64 vcc, s[52:53]
    s_mov_b64 exec, -1
    v_cndmask_b32_dpp v84, v84, v84, vcc wave_shr:1 row_mask:0xf bank_mask:0xf
    v_cndmask_b32_dpp v85, v85, v85, vcc wave_shr:1 row_mask:0xf bank_mask:0xf
    s_lshr_b64 s[52:53], s[52:53], 1
    v_cndmask_b32_dpp v86, v86, v86, vcc wave_shr:1 row_mask:0xf bank_mask:0xf
    v_cndmask_b32_dpp v87, v87, v87, vcc wave_shr:1 row_mask:0xf bank_mask:0xf
    s_andn2_b64 s[82:83], s[82:83], s[52:53]
    v_cndmask_b32_dpp v7, v7, v7, vcc wave_shr:1 row_mask:0xf bank_mask:0xf
    s_mov_b64 exec, s[50:51]
    s_cbranch_scc0 L2_d52
    s_mov_b64 exec, s[82:83]
    s_nop 1
    v_mfma_f32_4x4x4_16b_bf16 v[88:91], v[12:13], v[84:85], 0
    s_nop 1
    v_mfma_f32_4x4x4_16b_bf16 v[88:91], v[10:11], v[86:87], v[88:91]
    s_nop 4
    v_cvt_pk_bf16_f32 v88, v88, v89
    v_cvt_pk_bf16_f32 v89, v90, v91
    ds_pk_add_bf16 v7, v88 offset:65408
    ds_pk_add_bf16 v7, v89 offset:65412
    s_mov_b64 exec, s[50:51]
    s_branch L2_d52
L2_oa53:
    s_waitcnt vmcnt(3)
    s_mov_b64 exec, s[6:7]
    v_lshrrev_b32 v114, 16, v114
    s_mov_b64 exec, -1
    v_and_b32 v46, 0x10000000, v32
    v_cmpx_eq_u32 vcc, 0, v46
    v_lshrrev_b32 v47, 14, v112
    v_and_b32 v47, v5, v47
    ds_read_b64 v[96:97], v47
    v_perm_b32 v98, v112, v114, s44
    v_bitop3_b32 v99, v112, 0.5, -0.5 bitop3:0xa8
    v_bitop3_b32 v98, v6, v98, v99 bitop3:0xca
    v_and_b32 v47, v5, v112
    s_waitcnt lgkmcnt(0)
    v_mfma_f32_4x4x4_16b_bf16 v[88:91], v[8:9], v[96:97], 0
    s_nop 4
    v_mul_f32 v88, v98, v88
    v_mul_f32 v89, v98, v89
    v_mul_f32 v90, v98, v90
    v_mul_f32 v91, v98, v91
    v_cvt_pk_bf16_f32 v88, v88, v89
    v_cvt_pk_bf16_f32 v89, v90, v91
    ds_pk_add_bf16 v47, v88 offset:65408
    ds_pk_add_bf16 v47, v89 offset:65412
    s_mov_b64 exec, -1
    v_and_b32 v46, 0x20000000, v32
    v_cmpx_eq_u32 vcc, 0, v46
    v_lshrrev_b32 v47, 14, v113
    v_and_b32 v47, v5, v47
    ds_read_b64 v[96:97], v47
    v_perm_b32 v98, v113, v114, s45
    v_bitop3_b32 v99, v113, 0.5, -0.5 bitop3:0xa8
    v_bitop3_b32 v98, v6, v98, v99 bitop3:0xca
    v_and_b32 v47, v5, v113
    s_waitcnt lgkmcnt(0)
    v_mfma_f32_4x4x4_16b_bf16 v[88:91], v[8:9], v[96:97], 0
    s_nop 4
    v_mul_f32 v88, v98, v88
    v_mul_f32 v89, v98, v89
    v_mul_f32 v90, v98, v90
    v_mul_f32 v91, v98, v91
    v_cvt_pk_bf16_f32 v88, v88, v89
    v_cvt_pk_bf16_f32 v89, v90, v91
    ds_pk_add_bf16 v47, v88 offset:65408
    ds_pk_add_bf16 v47, v89 offset:65412
    s_mov_b64 exec, -1
    s_branch L2_ob53
L2_xo54:
    v_cmp_lt_u32 vcc, 20, v99
    s_mov_b32 s101, 1
    s_cbranch_vccz L2_xp54
    v_cmp_lt_u32 vcc, 32, v99
    v_cmp_lt_u32 s[58:59], 31, v88
    s_mov_b32 s101, 2
    s_or_b64 vcc, vcc, s[58:59]
    s_cbranch_scc0 L2_xp54
    s_mov_b32 s37, 0x10000
    s_branch L2_xp54
L2_c55:
    s_lshl_b64 s[52:53], s[82:83], 1
    s_andn2_b64 s[52:53], s[52:53], s[80:81]
    s_andn2_b64 s[52:53], s[52:53], s[54:55]
    s_or_b64 s[80:81], s[80:81], s[52:53]
    s_not_b64 vcc, s[52:53]
    s_mov_b64 exec, -1
    v_cndmask_b32_dpp v84, v84, v84, vcc wave_shr:1 row_mask:0xf bank_mask:0xf
    v_cndmask_b32_dpp v85, v85, v85, vcc wave_shr:1 row_mask:0xf bank_mask:0xf
    s_lshr_b64 s[52:53], s[52:53], 1
    v_cndmask_b32_dpp v86, v86, v86, vcc wave_shr:1 row_mask:0xf bank_mask:0xf
    v_cndmask_b32_dpp v87, v87, v87, vcc wave_shr:1 row_mask:0xf bank_mask:0xf
    s_andn2_b64 s[82:83], s[82:83], s[52:53]
    v_cndmask_b32_dpp v7, v7, v7, vcc wave_shr:1 row_mask:0xf bank_mask:0xf
    s_mov_b64 exec, s[54:55]
    s_cbranch_scc0 L2_d55
    s_mov_b64 exec, s[82:83]
    s_nop 1
    v_mfma_f32_4x4x4_16b_bf16 v[88:91], v[12:13], v[84:85], 0
    s_nop 1
    v_mfma_f32_4x4x4_16b_bf16 v[88:91], v[10:11], v[86:87], v[88:91]
    s_nop 4
    v_cvt_pk_bf16_f32 v88, v88, v89
    v_cvt_pk_bf16_f32 v89, v90, v91
    ds_pk_add_bf16 v7, v88 offset:65408
    ds_pk_add_bf16 v7, v89 offset:65412
    s_mov_b64 exec, s[54:55]
    s_branch L2_d55
L2_c56:
    s_lshl_b64 s[52:53], s[82:83], 1
    s_andn2_b64 s[52:53], s[52:53], s[80:81]
    s_andn2_b64 s[52:53], s[52:53], s[50:51]
    s_or_b64 s[80:81], s[80:81], s[52:53]
    s_not_b64 vcc, s[52:53]
    s_mov_b64 exec, -1
    v_cndmask_b32_dpp v84, v84, v84, vcc wave_shr:1 row_mask:0xf bank_mask:0xf
    v_cndmask_b32_dpp v85, v85, v85, vcc wave_shr:1 row_mask:0xf bank_mask:0xf
    s_lshr_b64 s[52:53], s[52:53], 1
    v_cndmask_b32_dpp v86, v86, v86, vcc wave_shr:1 row_mask:0xf bank_mask:0xf
    v_cndmask_b32_dpp v87, v87, v87, vcc wave_shr:1 row_mask:0xf bank_mask:0xf
    s_andn2_b64 s[82:83], s[82:83], s[52:53]
    v_cndmask_b32_dpp v7, v7, v7, vcc wave_shr:1 row_mask:0xf bank_mask:0xf
    s_mov_b64 exec, s[50:51]
    s_cbranch_scc0 L2_d56
    s_mov_b64 exec, s[82:83]
    s_nop 1
    v_mfma_f32_4x4x4_16b_bf16 v[88:91], v[12:13], v[84:85], 0
    s_nop 1
    v_mfma_f32_4x4x4_16b_bf16 v[88:91], v[10:11], v[86:87], v[88:91]
    s_nop 4
    v_cvt_pk_bf16_f32 v88, v88, v89
    v_cvt_pk_bf16_f32 v89, v90, v91
    ds_pk_add_bf16 v7, v88 offset:65408
    ds_pk_add_bf16 v7, v89 offset:65412
    s_mov_b64 exec, s[50:51]
    s_branch L2_d56
L2_c57:
    s_lshl_b64 s[52:53], s[82:83], 1
    s_andn2_b64 s[52:53], s[52:53], s[80:81]
    s_andn2_b64 s[52:53], s[52:53], s[54:55]
    s_or_b64 s[80:81], s[80:81], s[52:53]
    s_not_b64 vcc, s[52:53]
    s_mov_b64 exec, -1
    v_cndmask_b32_dpp v84, v84, v84, vcc wave_shr:1 row_mask:0xf bank_mask:0xf
    v_cndmask_b32_dpp v85, v85, v85, vcc wave_shr:1 row_mask:0xf bank_mask:0xf
    s_lshr_b64 s[52:53], s[52:53], 1
    v_cndmask_b32_dpp v86, v86, v86, vcc wave_shr:1 row_mask:0xf bank_mask:0xf
    v_cndmask_b32_dpp v87, v87, v87, vcc wave_shr:1 row_mask:0xf bank_mask:0xf
    s_andn2_b64 s[82:83], s[82:83], s[52:53]
    v_cndmask_b32_dpp v7, v7, v7, vcc wave_shr:1 row_mask:0xf bank_mask:0xf
    s_mov_b64 exec, s[54:55]
    s_cbranch_scc0 L2_d57
    s_mov_b64 exec, s[82:83]
    s_nop 1
    v_mfma_f32_4x4x4_16b_bf16 v[88:91], v[12:13], v[84:85], 0
    s_nop 1
    v_mfma_f32_4x4x4_16b_bf16 v[88:91], v[10:11], v[86:87], v[88:91]
    s_nop 4
    v_cvt_pk_bf16_f32 v88, v88, v89
    v_cvt_pk_bf16_f32 v89, v90, v91
    ds_pk_add_bf16 v7, v88 offset:65408
    ds_pk_add_bf16 v7, v89 offset:65412
    s_mov_b64 exec, s[54:55]
    s_branch L2_d57
L2_c58:
    s_lshl_b64 s[52:53], s[82:83], 1
    s_andn2_b64 s[52:53], s[52:53], s[80:81]
    s_andn2_b64 s[52:53], s[52:53], s[50:51]
    s_or_b64 s[80:81], s[80:81], s[52:53]
    s_not_b64 vcc, s[52:53]
    s_mov_b64 exec, -1
    v_cndmask_b32_dpp v84, v84, v84, vcc wave_shr:1 row_mask:0xf bank_mask:0xf
    v_cndmask_b32_dpp v85, v85, v85, vcc wave_shr:1 row_mask:0xf bank_mask:0xf
    s_lshr_b64 s[52:53], s[52:53], 1
    v_cndmask_b32_dpp v86, v86, v86, vcc wave_shr:1 row_mask:0xf bank_mask:0xf
    v_cndmask_b32_dpp v87, v87, v87, vcc wave_shr:1 row_mask:0xf bank_mask:0xf
    s_andn2_b64 s[82:83], s[82:83], s[52:53]
    v_cndmask_b32_dpp v7, v7, v7, vcc wave_shr:1 row_mask:0xf bank_mask:0xf
    s_mov_b64 exec, s[50:51]
    s_cbranch_scc0 L2_d58
    s_mov_b64 exec, s[82:83]
    s_nop 1
    v_mfma_f32_4x4x4_16b_bf16 v[88:91], v[12:13], v[84:85], 0
    s_nop 1
    v_mfma_f32_4x4x4_16b_bf16 v[88:91], v[10:11], v[86:87], v[88:91]
    s_nop 4
    v_cvt_pk_bf16_f32 v88, v88, v89
    v_cvt_pk_bf16_f32 v89, v90, v91
    ds_pk_add_bf16 v7, v88 offset:65408
    ds_pk_add_bf16 v7, v89 offset:65412
    s_mov_b64 exec, s[50:51]
    s_branch L2_d58
L2_c59:
    s_lshl_b64 s[52:53], s[82:83], 1
    s_andn2_b64 s[52:53], s[52:53], s[80:81]
    s_andn2_b64 s[52:53], s[52:53], s[54:55]
    s_or_b64 s[80:81], s[80:81], s[52:53]
    s_not_b64 vcc, s[52:53]
    s_mov_b64 exec, -1
    v_cndmask_b32_dpp v84, v84, v84, vcc wave_shr:1 row_mask:0xf bank_mask:0xf
    v_cndmask_b32_dpp v85, v85, v85, vcc wave_shr:1 row_mask:0xf bank_mask:0xf
    s_lshr_b64 s[52:53], s[52:53], 1
    v_cndmask_b32_dpp v86, v86, v86, vcc wave_shr:1 row_mask:0xf bank_mask:0xf
    v_cndmask_b32_dpp v87, v87, v87, vcc wave_shr:1 row_mask:0xf bank_mask:0xf
    s_andn2_b64 s[82:83], s[82:83], s[52:53]
    v_cndmask_b32_dpp v7, v7, v7, vcc wave_shr:1 row_mask:0xf bank_mask:0xf
    s_mov_b64 exec, s[54:55]
    s_cbranch_scc0 L2_d59
    s_mov_b64 exec, s[82:83]
    s_nop 1
    v_mfma_f32_4x4x4_16b_bf16 v[88:91], v[12:13], v[84:85], 0
    s_nop 1
    v_mfma_f32_4x4x4_16b_bf16 v[88:91], v[10:11], v[86:87], v[88:91]
    s_nop 4
    v_cvt_pk_bf16_f32 v88, v88, v89
    v_cvt_pk_bf16_f32 v89, v90, v91
    ds_pk_add_bf16 v7, v88 offset:65408
    ds_pk_add_bf16 v7, v89 offset:65412
    s_mov_b64 exec, s[54:55]
    s_branch L2_d59
L2_c60:
    s_lshl_b64 s[52:53], s[82:83], 1
    s_andn2_b64 s[52:53], s[52:53], s[80:81]
    s_andn2_b64 s[52:53], s[52:53], s[50:51]
    s_or_b64 s[80:81], s[80:81], s[52:53]
    s_not_b64 vcc, s[52:53]
    s_mov_b64 exec, -1
    v_cndmask_b32_dpp v84, v84, v84, vcc wave_shr:1 row_mask:0xf bank_mask:0xf
    v_cndmask_b32_dpp v85, v85, v85, vcc wave_shr:1 row_mask:0xf bank_mask:0xf
    s_lshr_b64 s[52:53], s[52:53], 1
    v_cndmask_b32_dpp v86, v86, v86, vcc wave_shr:1 row_mask:0xf bank_mask:0xf
    v_cndmask_b32_dpp v87, v87, v87, vcc wave_shr:1 row_mask:0xf bank_mask:0xf
    s_andn2_b64 s[82:83], s[82:83], s[52:53]
    v_cndmask_b32_dpp v7, v7, v7, vcc wave_shr:1 row_mask:0xf bank_mask:0xf
    s_mov_b64 exec, s[50:51]
    s_cbranch_scc0 L2_d60
    s_mov_b64 exec, s[82:83]
    s_nop 1
    v_mfma_f32_4x4x4_16b_bf16 v[88:91], v[12:13], v[84:85], 0
    s_nop 1
    v_mfma_f32_4x4x4_16b_bf16 v[88:91], v[10:11], v[86:87], v[88:91]
    s_nop 4
    v_cvt_pk_bf16_f32 v88, v88, v89
    v_cvt_pk_bf16_f32 v89, v90, v91
    ds_pk_add_bf16 v7, v88 offset:65408
    ds_pk_add_bf16 v7, v89 offset:65412
    s_mov_b64 exec, s[50:51]
    s_branch L2_d60
L2_xa61:
    s_cmp_eq_u32 s101, 1
    s_cbranch_scc1 L2_xc61
    v_lshlrev_b32 v89, 0, v96
    v_add_u32 v90, 140, v97
    v_bitop3_b32 v90, v89, v45, v90 bitop3:0x6a
    ds_write_b32 v98, v90 offset:28
    v_lshlrev_b32 v89, 4, v96
    v_add_u32 v90, 120, v97
    v_bitop3_b32 v90, v89, v45, v90 bitop3:0x6a
    ds_write_b32 v98, v90 offset:24
    v_lshlrev_b32 v89, 8, v96
    v_add_u32 v90, 100, v97
    v_bitop3_b32 v90, v89, v45, v90 bitop3:0x6a
    ds_write_b32 v98, v90 offset:20
L2_xc61:
    v_lshlrev_b32 v89, 12, v96
    v_add_u32 v90, 80, v97
    v_bitop3_b32 v90, v89, v45, v90 bitop3:0x6a
    ds_write_b32 v98, v90 offset:16
    s_branch L2_xb61
L2_xe61:
    v_cmp_lt_u32 vcc, 32, v99
    v_cmp_lt_u32 s[58:59], 31, v88
    v_lshrrev_b32 v89, 16, v96
    v_add_u32 v97, 80, v97
    s_or_b64 vcc, vcc, s[58:59]
    s_cbranch_scc1 L2_xs61
    v_lshlrev_b32 v89, v1, v89
    v_and_b32 v89, v45, v89
    v_cmp_ne_u32 vcc, 0, v89
    v_xor_b32 v90, v97, v89
    s_add_u32 s3, s37, s38
    v_mbcnt_lo_u32_b32 v98, vcc_lo, 0
    v_mbcnt_hi_u32_b32 v98, vcc_hi, v98
    s_bcnt1_i32_b64 s41, vcc
    v_lshl_add_u32 v98, v98, 2, s3
    s_lshl2_add_u32 s37, s41, s37
    s_mov_b64 exec, vcc
    ds_write_b32 v98, v90
    s_mov_b64 exec, -1
    s_branch L2_xr61
L2_xs61:
    s_waitcnt lgkmcnt(0)
    s_mov_b32 s37, 0x10000
    s_branch L2_xw61
L2_c62:
    s_lshl_b64 s[52:53], s[82:83], 1
    s_andn2_b64 s[52:53], s[52:53], s[80:81]
    s_andn2_b64 s[52:53], s[52:53], s[54:55]
    s_or_b64 s[80:81], s[80:81], s[52:53]
    s_not_b64 vcc, s[52:53]
    s_mov_b64 exec, -1
    v_cndmask_b32_dpp v84, v84, v84, vcc wave_shr:1 row_mask:0xf bank_mask:0xf
    v_cndmask_b32_dpp v85, v85, v85, vcc wave_shr:1 row_mask:0xf bank_mask:0xf
    s_lshr_b64 s[52:53], s[52:53], 1
    v_cndmask_b32_dpp v86, v86, v86, vcc wave_shr:1 row_mask:0xf bank_mask:0xf
    v_cndmask_b32_dpp v87, v87, v87, vcc wave_shr:1 row_mask:0xf bank_mask:0xf
    s_andn2_b64 s[82:83], s[82:83], s[52:53]
    v_cndmask_b32_dpp v7, v7, v7, vcc wave_shr:1 row_mask:0xf bank_mask:0xf
    s_mov_b64 exec, s[54:55]
    s_cbranch_scc0 L2_d62
    s_mov_b64 exec, s[82:83]
    s_nop 1
    v_mfma_f32_4x4x4_16b_bf16 v[88:91], v[12:13], v[84:85], 0
    s_nop 1
    v_mfma_f32_4x4x4_16b_bf16 v[88:91], v[10:11], v[86:87], v[88:91]
    s_nop 4
    v_cvt_pk_bf16_f32 v88, v88, v89
    v_cvt_pk_bf16_f32 v89, v90, v91
    ds_pk_add_bf16 v7, v88 offset:65408
    ds_pk_add_bf16 v7, v89 offset:65412
    s_mov_b64 exec, s[54:55]
    s_branch L2_d62
L2_c63:
    s_lshl_b64 s[52:53], s[82:83], 1
    s_andn2_b64 s[52:53], s[52:53], s[80:81]
    s_andn2_b64 s[52:53], s[52:53], s[50:51]
    s_or_b64 s[80:81], s[80:81], s[52:53]
    s_not_b64 vcc, s[52:53]
    s_mov_b64 exec, -1
    v_cndmask_b32_dpp v84, v84, v84, vcc wave_shr:1 row_mask:0xf bank_mask:0xf
    v_cndmask_b32_dpp v85, v85, v85, vcc wave_shr:1 row_mask:0xf bank_mask:0xf
    s_lshr_b64 s[52:53], s[52:53], 1
    v_cndmask_b32_dpp v86, v86, v86, vcc wave_shr:1 row_mask:0xf bank_mask:0xf
    v_cndmask_b32_dpp v87, v87, v87, vcc wave_shr:1 row_mask:0xf bank_mask:0xf
    s_andn2_b64 s[82:83], s[82:83], s[52:53]
    v_cndmask_b32_dpp v7, v7, v7, vcc wave_shr:1 row_mask:0xf bank_mask:0xf
    s_mov_b64 exec, s[50:51]
    s_cbranch_scc0 L2_d63
    s_mov_b64 exec, s[82:83]
    s_nop 1
    v_mfma_f32_4x4x4_16b_bf16 v[88:91], v[12:13], v[84:85], 0
    s_nop 1
    v_mfma_f32_4x4x4_16b_bf16 v[88:91], v[10:11], v[86:87], v[88:91]
    s_nop 4
    v_cvt_pk_bf16_f32 v88, v88, v89
    v_cvt_pk_bf16_f32 v89, v90, v91
    ds_pk_add_bf16 v7, v88 offset:65408
    ds_pk_add_bf16 v7, v89 offset:65412
    s_mov_b64 exec, s[50:51]
    s_branch L2_d63
L2_xf61:
    s_cmp_gt_u32 s37, 1024
    s_cbranch_scc1 L2_xt61
    s_cmp_lt_u32 s37, 768
    s_cbranch_scc1 L2_xl61
    ds_read_b32 v32, v44 offset:896
    s_add_u32 s3, s42, 2
    s_bitset1_b32 s43, s3
    s_branch L2_xg61
L2_xl61:
    s_waitcnt lgkmcnt(0)
    v_mov_b32 v31, -1
    s_cmp_ge_u32 s37, 512
    s_cbranch_scc1 L2_xg61
    v_mov_b32 v39, -1
    s_cmp_ge_u32 s37, 256
    s_cbranch_scc1 L2_xg61
    v_mov_b32 v27, -1
    s_branch L2_xg61
L2_xt61:
    s_waitcnt lgkmcnt(0)
    v_mov_b32 v21, -1
    v_mov_b32 v27, -1
    v_mov_b32 v39, -1
    v_mov_b32 v31, -1
    s_add_u32 s3, s42, 2
    s_bitset1_b32 s36, s3
    s_branch L2_xg61
L2_oa64:
    v_and_b32 v47, 0x0fffffff, v33
    buffer_load_dword v114, v47, s[8:11], 0 offen offset:16
    s_mov_b64 exec, s[6:7]
    v_add_u32 v47, 8, v47
    v_lshrrev_b32 v33, 2, v33
    s_mov_b64 exec, -1
    buffer_load_dwordx2 v[112:113], v47, s[8:11], 0 offen
    s_branch L2_ob64
L2_c65:
    s_lshl_b64 s[52:53], s[82:83], 1
    s_andn2_b64 s[52:53], s[52:53], s[80:81]
    s_andn2_b64 s[52:53], s[52:53], s[54:55]
    s_or_b64 s[80:81], s[80:81], s[52:53]
    s_not_b64 vcc, s[52:53]
    s_mov_b64 exec, -1
    v_cndmask_b32_dpp v84, v84, v84, vcc wave_shr:1 row_mask:0xf bank_mask:0xf
    v_cndmask_b32_dpp v85, v85, v85, vcc wave_shr:1 row_mask:0xf bank_mask:0xf
    s_lshr_b64 s[52:53], s[52:53], 1
    v_cndmask_b32_dpp v86, v86, v86, vcc wave_shr:1 row_mask:0xf bank_mask:0xf
    v_cndmask_b32_dpp v87, v87, v87, vcc wave_shr:1 row_mask:0xf bank_mask:0xf
    s_andn2_b64 s[82:83], s[82:83], s[52:53]
    v_cndmask_b32_dpp v7, v7, v7, vcc wave_shr:1 row_mask:0xf bank_mask:0xf
    s_mov_b64 exec, s[54:55]
    s_cbranch_scc0 L2_d65
    s_mov_b64 exec, s[82:83]
    s_nop 1
    v_mfma_f32_4x4x4_16b_bf16 v[88:91], v[12:13], v[84:85], 0
    s_nop 1
    v_mfma_f32_4x4x4_16b_bf16 v[88:91], v[10:11], v[86:87], v[88:91]
    s_nop 4
    v_cvt_pk_bf16_f32 v88, v88, v89
    v_cvt_pk_bf16_f32 v89, v90, v91
    ds_pk_add_bf16 v7, v88 offset:65408
    ds_pk_add_bf16 v7, v89 offset:65412
    s_mov_b64 exec, s[54:55]
    s_branch L2_d65
L2_c66:
    s_lshl_b64 s[52:53], s[82:83], 1
    s_andn2_b64 s[52:53], s[52:53], s[80:81]
    s_andn2_b64 s[52:53], s[52:53], s[50:51]
    s_or_b64 s[80:81], s[80:81], s[52:53]
    s_not_b64 vcc, s[52:53]
    s_mov_b64 exec, -1
    v_cndmask_b32_dpp v84, v84, v84, vcc wave_shr:1 row_mask:0xf bank_mask:0xf
    v_cndmask_b32_dpp v85, v85, v85, vcc wave_shr:1 row_mask:0xf bank_mask:0xf
    s_lshr_b64 s[52:53], s[52:53], 1
    v_cndmask_b32_dpp v86, v86, v86, vcc wave_shr:1 row_mask:0xf bank_mask:0xf
    v_cndmask_b32_dpp v87, v87, v87, vcc wave_shr:1 row_mask:0xf bank_mask:0xf
    s_andn2_b64 s[82:83], s[82:83], s[52:53]
    v_cndmask_b32_dpp v7, v7, v7, vcc wave_shr:1 row_mask:0xf bank_mask:0xf
    s_mov_b64 exec, s[50:51]
    s_cbranch_scc0 L2_d66
    s_mov_b64 exec, s[82:83]
    s_nop 1
    v_mfma_f32_4x4x4_16b_bf16 v[88:91], v[12:13], v[84:85], 0
    s_nop 1
    v_mfma_f32_4x4x4_16b_bf16 v[88:91], v[10:11], v[86:87], v[88:91]
    s_nop 4
    v_cvt_pk_bf16_f32 v88, v88, v89
    v_cvt_pk_bf16_f32 v89, v90, v91
    ds_pk_add_bf16 v7, v88 offset:65408
    ds_pk_add_bf16 v7, v89 offset:65412
    s_mov_b64 exec, s[50:51]
    s_branch L2_d66
L2_c67:
    s_lshl_b64 s[52:53], s[82:83], 1
    s_andn2_b64 s[52:53], s[52:53], s[80:81]
    s_andn2_b64 s[52:53], s[52:53], s[54:55]
    s_or_b64 s[80:81], s[80:81], s[52:53]
    s_not_b64 vcc, s[52:53]
    s_mov_b64 exec, -1
    v_cndmask_b32_dpp v84, v84, v84, vcc wave_shr:1 row_mask:0xf bank_mask:0xf
    v_cndmask_b32_dpp v85, v85, v85, vcc wave_shr:1 row_mask:0xf bank_mask:0xf
    s_lshr_b64 s[52:53], s[52:53], 1
    v_cndmask_b32_dpp v86, v86, v86, vcc wave_shr:1 row_mask:0xf bank_mask:0xf
    v_cndmask_b32_dpp v87, v87, v87, vcc wave_shr:1 row_mask:0xf bank_mask:0xf
    s_andn2_b64 s[82:83], s[82:83], s[52:53]
    v_cndmask_b32_dpp v7, v7, v7, vcc wave_shr:1 row_mask:0xf bank_mask:0xf
    s_mov_b64 exec, s[54:55]
    s_cbranch_scc0 L2_d67
    s_mov_b64 exec, s[82:83]
    s_nop 1
    v_mfma_f32_4x4x4_16b_bf16 v[88:91], v[12:13], v[84:85], 0
    s_nop 1
    v_mfma_f32_4x4x4_16b_bf16 v[88:91], v[10:11], v[86:87], v[88:91]
    s_nop 4
    v_cvt_pk_bf16_f32 v88, v88, v89
    v_cvt_pk_bf16_f32 v89, v90, v91
    ds_pk_add_bf16 v7, v88 offset:65408
    ds_pk_add_bf16 v7, v89 offset:65412
    s_mov_b64 exec, s[54:55]
    s_branch L2_d67
L2_c68:
    s_lshl_b64 s[52:53], s[82:83], 1
    s_andn2_b64 s[52:53], s[52:53], s[80:81]
    s_andn2_b64 s[52:53], s[52:53], s[50:51]
    s_or_b64 s[80:81], s[80:81], s[52:53]
    s_not_b64 vcc, s[52:53]
    s_mov_b64 exec, -1
    v_cndmask_b32_dpp v84, v84, v84, vcc wave_shr:1 row_mask:0xf bank_mask:0xf
    v_cndmask_b32_dpp v85, v85, v85, vcc wave_shr:1 row_mask:0xf bank_mask:0xf
    s_lshr_b64 s[52:53], s[52:53], 1
    v_cndmask_b32_dpp v86, v86, v86, vcc wave_shr:1 row_mask:0xf bank_mask:0xf
    v_cndmask_b32_dpp v87, v87, v87, vcc wave_shr:1 row_mask:0xf bank_mask:0xf
    s_andn2_b64 s[82:83], s[82:83], s[52:53]
    v_cndmask_b32_dpp v7, v7, v7, vcc wave_shr:1 row_mask:0xf bank_mask:0xf
    s_mov_b64 exec, s[50:51]
    s_cbranch_scc0 L2_d68
    s_mov_b64 exec, s[82:83]
    s_nop 1
    v_mfma_f32_4x4x4_16b_bf16 v[88:91], v[12:13], v[84:85], 0
    s_nop 1
    v_mfma_f32_4x4x4_16b_bf16 v[88:91], v[10:11], v[86:87], v[88:91]
    s_nop 4
    v_cvt_pk_bf16_f32 v88, v88, v89
    v_cvt_pk_bf16_f32 v89, v90, v91
    ds_pk_add_bf16 v7, v88 offset:65408
    ds_pk_add_bf16 v7, v89 offset:65412
    s_mov_b64 exec, s[50:51]
    s_branch L2_d68
L2_c69:
    s_lshl_b64 s[52:53], s[82:83], 1
    s_andn2_b64 s[52:53], s[52:53], s[80:81]
    s_andn2_b64 s[52:53], s[52:53], s[54:55]
    s_or_b64 s[80:81], s[80:81], s[52:53]
    s_not_b64 vcc, s[52:53]
    s_mov_b64 exec, -1
    v_cndmask_b32_dpp v84, v84, v84, vcc wave_shr:1 row_mask:0xf bank_mask:0xf
    v_cndmask_b32_dpp v85, v85, v85, vcc wave_shr:1 row_mask:0xf bank_mask:0xf
    s_lshr_b64 s[52:53], s[52:53], 1
    v_cndmask_b32_dpp v86, v86, v86, vcc wave_shr:1 row_mask:0xf bank_mask:0xf
    v_cndmask_b32_dpp v87, v87, v87, vcc wave_shr:1 row_mask:0xf bank_mask:0xf
    s_andn2_b64 s[82:83], s[82:83], s[52:53]
    v_cndmask_b32_dpp v7, v7, v7, vcc wave_shr:1 row_mask:0xf bank_mask:0xf
    s_mov_b64 exec, s[54:55]
    s_cbranch_scc0 L2_d69
    s_mov_b64 exec, s[82:83]
    s_nop 1
    v_mfma_f32_4x4x4_16b_bf16 v[88:91], v[12:13], v[84:85], 0
    s_nop 1
    v_mfma_f32_4x4x4_16b_bf16 v[88:91], v[10:11], v[86:87], v[88:91]
    s_nop 4
    v_cvt_pk_bf16_f32 v88, v88, v89
    v_cvt_pk_bf16_f32 v89, v90, v91
    ds_pk_add_bf16 v7, v88 offset:65408
    ds_pk_add_bf16 v7, v89 offset:65412
    s_mov_b64 exec, s[54:55]
    s_branch L2_d69
L2_c70:
    s_lshl_b64 s[52:53], s[82:83], 1
    s_andn2_b64 s[52:53], s[52:53], s[80:81]
    s_andn2_b64 s[52:53], s[52:53], s[50:51]
    s_or_b64 s[80:81], s[80:81], s[52:53]
    s_not_b64 vcc, s[52:53]
    s_mov_b64 exec, -1
    v_cndmask_b32_dpp v84, v84, v84, vcc wave_shr:1 row_mask:0xf bank_mask:0xf
    v_cndmask_b32_dpp v85, v85, v85, vcc wave_shr:1 row_mask:0xf bank_mask:0xf
    s_lshr_b64 s[52:53], s[52:53], 1
    v_cndmask_b32_dpp v86, v86, v86, vcc wave_shr:1 row_mask:0xf bank_mask:0xf
    v_cndmask_b32_dpp v87, v87, v87, vcc wave_shr:1 row_mask:0xf bank_mask:0xf
    s_andn2_b64 s[82:83], s[82:83], s[52:53]
    v_cndmask_b32_dpp v7, v7, v7, vcc wave_shr:1 row_mask:0xf bank_mask:0xf
    s_mov_b64 exec, s[50:51]
    s_cbranch_scc0 L2_d70
    s_mov_b64 exec, s[82:83]
    s_nop 1
    v_mfma_f32_4x4x4_16b_bf16 v[88:91], v[12:13], v[84:85], 0
    s_nop 1
    v_mfma_f32_4x4x4_16b_bf16 v[88:91], v[10:11], v[86:87], v[88:91]
    s_nop 4
    v_cvt_pk_bf16_f32 v88, v88, v89
    v_cvt_pk_bf16_f32 v89, v90, v91
    ds_pk_add_bf16 v7, v88 offset:65408
    ds_pk_add_bf16 v7, v89 offset:65412
    s_mov_b64 exec, s[50:51]
    s_branch L2_d70
L2_oa71:
    s_waitcnt vmcnt(3)
    s_mov_b64 exec, s[6:7]
    v_lshrrev_b32 v114, 16, v114
    s_mov_b64 exec, -1
    v_and_b32 v46, 0x10000000, v33
    v_cmpx_eq_u32 vcc, 0, v46
    v_lshrrev_b32 v47, 14, v112
    v_and_b32 v47, v5, v47
    ds_read_b64 v[96:97], v47
    v_perm_b32 v98, v112, v114, s44
    v_bitop3_b32 v99, v112, 0.5, -0.5 bitop3:0xa8
    v_bitop3_b32 v98, v6, v98, v99 bitop3:0xca
    v_and_b32 v47, v5, v112
    s_waitcnt lgkmcnt(0)
    v_mfma_f32_4x4x4_16b_bf16 v[88:91], v[8:9], v[96:97], 0
    s_nop 4
    v_mul_f32 v88, v98, v88
    v_mul_f32 v89, v98, v89
    v_mul_f32 v90, v98, v90
    v_mul_f32 v91, v98, v91
    v_cvt_pk_bf16_f32 v88, v88, v89
    v_cvt_pk_bf16_f32 v89, v90, v91
    ds_pk_add_bf16 v47, v88 offset:65408
    ds_pk_add_bf16 v47, v89 offset:65412
    s_mov_b64 exec, -1
    v_and_b32 v46, 0x20000000, v33
    v_cmpx_eq_u32 vcc, 0, v46
    v_lshrrev_b32 v47, 14, v113
    v_and_b32 v47, v5, v47
    ds_read_b64 v[96:97], v47
    v_perm_b32 v98, v113, v114, s45
    v_bitop3_b32 v99, v113, 0.5, -0.5 bitop3:0xa8
    v_bitop3_b32 v98, v6, v98, v99 bitop3:0xca
    v_and_b32 v47, v5, v113
    s_waitcnt lgkmcnt(0)
    v_mfma_f32_4x4x4_16b_bf16 v[88:91], v[8:9], v[96:97], 0
    s_nop 4
    v_mul_f32 v88, v98, v88
    v_mul_f32 v89, v98, v89
    v_mul_f32 v90, v98, v90
    v_mul_f32 v91, v98, v91
    v_cvt_pk_bf16_f32 v88, v88, v89
    v_cvt_pk_bf16_f32 v89, v90, v91
    ds_pk_add_bf16 v47, v88 offset:65408
    ds_pk_add_bf16 v47, v89 offset:65412
    s_mov_b64 exec, -1
    s_branch L2_ob71
L2_xo72:
    v_cmp_lt_u32 vcc, 20, v99
    s_mov_b32 s101, 1
    s_cbranch_vccz L2_xp72
    v_cmp_lt_u32 vcc, 32, v99
    v_cmp_lt_u32 s[58:59], 31, v88
    s_mov_b32 s101, 2
    s_or_b64 vcc, vcc, s[58:59]
    s_cbranch_scc0 L2_xp72
    s_mov_b32 s37, 0x10000
    s_branch L2_xp72
L2_c73:
    s_lshl_b64 s[52:53], s[82:83], 1
    s_andn2_b64 s[52:53], s[52:53], s[80:81]
    s_andn2_b64 s[52:53], s[52:53], s[54:55]
    s_or_b64 s[80:81], s[80:81], s[52:53]
    s_not_b64 vcc, s[52:53]
    s_mov_b64 exec, -1
    v_cndmask_b32_dpp v84, v84, v84, vcc wave_shr:1 row_mask:0xf bank_mask:0xf
    v_cndmask_b32_dpp v85, v85, v85, vcc wave_shr:1 row_mask:0xf bank_mask:0xf
    s_lshr_b64 s[52:53], s[52:53], 1
    v_cndmask_b32_dpp v86, v86, v86, vcc wave_shr:1 row_mask:0xf bank_mask:0xf
    v_cndmask_b32_dpp v87, v87, v87, vcc wave_shr:1 row_mask:0xf bank_mask:0xf
    s_andn2_b64 s[82:83], s[82:83], s[52:53]
    v_cndmask_b32_dpp v7, v7, v7, vcc wave_shr:1 row_mask:0xf bank_mask:0xf
    s_mov_b64 exec, s[54:55]
    s_cbranch_scc0 L2_d73
    s_mov_b64 exec, s[82:83]
    s_nop 1
    v_mfma_f32_4x4x4_16b_bf16 v[88:91], v[12:13], v[84:85], 0
    s_nop 1
    v_mfma_f32_4x4x4_16b_bf16 v[88:91], v[10:11], v[86:87], v[88:91]
    s_nop 4
    v_cvt_pk_bf16_f32 v88, v88, v89
    v_cvt_pk_bf16_f32 v89, v90, v91
    ds_pk_add_bf16 v7, v88 offset:65408
    ds_pk_add_bf16 v7, v89 offset:65412
    s_mov_b64 exec, s[54:55]
    s_branch L2_d73
L2_c74:
    s_lshl_b64 s[52:53], s[82:83], 1
    s_andn2_b64 s[52:53], s[52:53], s[80:81]
    s_andn2_b64 s[52:53], s[52:53], s[50:51]
    s_or_b64 s[80:81], s[80:81], s[52:53]
    s_not_b64 vcc, s[52:53]
    s_mov_b64 exec, -1
    v_cndmask_b32_dpp v84, v84, v84, vcc wave_shr:1 row_mask:0xf bank_mask:0xf
    v_cndmask_b32_dpp v85, v85, v85, vcc wave_shr:1 row_mask:0xf bank_mask:0xf
    s_lshr_b64 s[52:53], s[52:53], 1
    v_cndmask_b32_dpp v86, v86, v86, vcc wave_shr:1 row_mask:0xf bank_mask:0xf
    v_cndmask_b32_dpp v87, v87, v87, vcc wave_shr:1 row_mask:0xf bank_mask:0xf
    s_andn2_b64 s[82:83], s[82:83], s[52:53]
    v_cndmask_b32_dpp v7, v7, v7, vcc wave_shr:1 row_mask:0xf bank_mask:0xf
    s_mov_b64 exec, s[50:51]
    s_cbranch_scc0 L2_d74
    s_mov_b64 exec, s[82:83]
    s_nop 1
    v_mfma_f32_4x4x4_16b_bf16 v[88:91], v[12:13], v[84:85], 0
    s_nop 1
    v_mfma_f32_4x4x4_16b_bf16 v[88:91], v[10:11], v[86:87], v[88:91]
    s_nop 4
    v_cvt_pk_bf16_f32 v88, v88, v89
    v_cvt_pk_bf16_f32 v89, v90, v91
    ds_pk_add_bf16 v7, v88 offset:65408
    ds_pk_add_bf16 v7, v89 offset:65412
    s_mov_b64 exec, s[50:51]
    s_branch L2_d74
L2_c75:
    s_lshl_b64 s[52:53], s[82:83], 1
    s_andn2_b64 s[52:53], s[52:53], s[80:81]
    s_andn2_b64 s[52:53], s[52:53], s[54:55]
    s_or_b64 s[80:81], s[80:81], s[52:53]
    s_not_b64 vcc, s[52:53]
    s_mov_b64 exec, -1
    v_cndmask_b32_dpp v84, v84, v84, vcc wave_shr:1 row_mask:0xf bank_mask:0xf
    v_cndmask_b32_dpp v85, v85, v85, vcc wave_shr:1 row_mask:0xf bank_mask:0xf
    s_lshr_b64 s[52:53], s[52:53], 1
    v_cndmask_b32_dpp v86, v86, v86, vcc wave_shr:1 row_mask:0xf bank_mask:0xf
    v_cndmask_b32_dpp v87, v87, v87, vcc wave_shr:1 row_mask:0xf bank_mask:0xf
    s_andn2_b64 s[82:83], s[82:83], s[52:53]
    v_cndmask_b32_dpp v7, v7, v7, vcc wave_shr:1 row_mask:0xf bank_mask:0xf
    s_mov_b64 exec, s[54:55]
    s_cbranch_scc0 L2_d75
    s_mov_b64 exec, s[82:83]
    s_nop 1
    v_mfma_f32_4x4x4_16b_bf16 v[88:91], v[12:13], v[84:85], 0
    s_nop 1
    v_mfma_f32_4x4x4_16b_bf16 v[88:91], v[10:11], v[86:87], v[88:91]
    s_nop 4
    v_cvt_pk_bf16_f32 v88, v88, v89
    v_cvt_pk_bf16_f32 v89, v90, v91
    ds_pk_add_bf16 v7, v88 offset:65408
    ds_pk_add_bf16 v7, v89 offset:65412
    s_mov_b64 exec, s[54:55]
    s_branch L2_d75
L2_c76:
    s_lshl_b64 s[52:53], s[82:83], 1
    s_andn2_b64 s[52:53], s[52:53], s[80:81]
    s_andn2_b64 s[52:53], s[52:53], s[50:51]
    s_or_b64 s[80:81], s[80:81], s[52:53]
    s_not_b64 vcc, s[52:53]
    s_mov_b64 exec, -1
    v_cndmask_b32_dpp v84, v84, v84, vcc wave_shr:1 row_mask:0xf bank_mask:0xf
    v_cndmask_b32_dpp v85, v85, v85, vcc wave_shr:1 row_mask:0xf bank_mask:0xf
    s_lshr_b64 s[52:53], s[52:53], 1
    v_cndmask_b32_dpp v86, v86, v86, vcc wave_shr:1 row_mask:0xf bank_mask:0xf
    v_cndmask_b32_dpp v87, v87, v87, vcc wave_shr:1 row_mask:0xf bank_mask:0xf
    s_andn2_b64 s[82:83], s[82:83], s[52:53]
    v_cndmask_b32_dpp v7, v7, v7, vcc wave_shr:1 row_mask:0xf bank_mask:0xf
    s_mov_b64 exec, s[50:51]
    s_cbranch_scc0 L2_d76
    s_mov_b64 exec, s[82:83]
    s_nop 1
    v_mfma_f32_4x4x4_16b_bf16 v[88:91], v[12:13], v[84:85], 0
    s_nop 1
    v_mfma_f32_4x4x4_16b_bf16 v[88:91], v[10:11], v[86:87], v[88:91]
    s_nop 4
    v_cvt_pk_bf16_f32 v88, v88, v89
    v_cvt_pk_bf16_f32 v89, v90, v91
    ds_pk_add_bf16 v7, v88 offset:65408
    ds_pk_add_bf16 v7, v89 offset:65412
    s_mov_b64 exec, s[50:51]
    s_branch L2_d76
L2_c77:
    s_lshl_b64 s[52:53], s[82:83], 1
    s_andn2_b64 s[52:53], s[52:53], s[80:81]
    s_andn2_b64 s[52:53], s[52:53], s[54:55]
    s_or_b64 s[80:81], s[80:81], s[52:53]
    s_not_b64 vcc, s[52:53]
    s_mov_b64 exec, -1
    v_cndmask_b32_dpp v84, v84, v84, vcc wave_shr:1 row_mask:0xf bank_mask:0xf
    v_cndmask_b32_dpp v85, v85, v85, vcc wave_shr:1 row_mask:0xf bank_mask:0xf
    s_lshr_b64 s[52:53], s[52:53], 1
    v_cndmask_b32_dpp v86, v86, v86, vcc wave_shr:1 row_mask:0xf bank_mask:0xf
    v_cndmask_b32_dpp v87, v87, v87, vcc wave_shr:1 row_mask:0xf bank_mask:0xf
    s_andn2_b64 s[82:83], s[82:83], s[52:53]
    v_cndmask_b32_dpp v7, v7, v7, vcc wave_shr:1 row_mask:0xf bank_mask:0xf
    s_mov_b64 exec, s[54:55]
    s_cbranch_scc0 L2_d77
    s_mov_b64 exec, s[82:83]
    s_nop 1
    v_mfma_f32_4x4x4_16b_bf16 v[88:91], v[12:13], v[84:85], 0
    s_nop 1
    v_mfma_f32_4x4x4_16b_bf16 v[88:91], v[10:11], v[86:87], v[88:91]
    s_nop 4
    v_cvt_pk_bf16_f32 v88, v88, v89
    v_cvt_pk_bf16_f32 v89, v90, v91
    ds_pk_add_bf16 v7, v88 offset:65408
    ds_pk_add_bf16 v7, v89 offset:65412
    s_mov_b64 exec, s[54:55]
    s_branch L2_d77
L2_c78:
    s_lshl_b64 s[52:53], s[82:83], 1
    s_andn2_b64 s[52:53], s[52:53], s[80:81]
    s_andn2_b64 s[52:53], s[52:53], s[50:51]
    s_or_b64 s[80:81], s[80:81], s[52:53]
    s_not_b64 vcc, s[52:53]
    s_mov_b64 exec, -1
    v_cndmask_b32_dpp v84, v84, v84, vcc wave_shr:1 row_mask:0xf bank_mask:0xf
    v_cndmask_b32_dpp v85, v85, v85, vcc wave_shr:1 row_mask:0xf bank_mask:0xf
    s_lshr_b64 s[52:53], s[52:53], 1
    v_cndmask_b32_dpp v86, v86, v86, vcc wave_shr:1 row_mask:0xf bank_mask:0xf
    v_cndmask_b32_dpp v87, v87, v87, vcc wave_shr:1 row_mask:0xf bank_mask:0xf
    s_andn2_b64 s[82:83], s[82:83], s[52:53]
    v_cndmask_b32_dpp v7, v7, v7, vcc wave_shr:1 row_mask:0xf bank_mask:0xf
    s_mov_b64 exec, s[50:51]
    s_cbranch_scc0 L2_d78
    s_mov_b64 exec, s[82:83]
    s_nop 1
    v_mfma_f32_4x4x4_16b_bf16 v[88:91], v[12:13], v[84:85], 0
    s_nop 1
    v_mfma_f32_4x4x4_16b_bf16 v[88:91], v[10:11], v[86:87], v[88:91]
    s_nop 4
    v_cvt_pk_bf16_f32 v88, v88, v89
    v_cvt_pk_bf16_f32 v89, v90, v91
    ds_pk_add_bf16 v7, v88 offset:65408
    ds_pk_add_bf16 v7, v89 offset:65412
    s_mov_b64 exec, s[50:51]
    s_branch L2_d78
L2_xa79:
    s_cmp_eq_u32 s101, 1
    s_cbranch_scc1 L2_xc79
    v_lshlrev_b32 v89, 0, v96
    v_add_u32 v90, 140, v97
    v_bitop3_b32 v90, v89, v45, v90 bitop3:0x6a
    ds_write_b32 v98, v90 offset:28
    v_lshlrev_b32 v89, 4, v96
    v_add_u32 v90, 120, v97
    v_bitop3_b32 v90, v89, v45, v90 bitop3:0x6a
    ds_write_b32 v98, v90 offset:24
    v_lshlrev_b32 v89, 8, v96
    v_add_u32 v90, 100, v97
    v_bitop3_b32 v90, v89, v45, v90 bitop3:0x6a
    ds_write_b32 v98, v90 offset:20
L2_xc79:
    v_lshlrev_b32 v89, 12, v96
    v_add_u32 v90, 80, v97
    v_bitop3_b32 v90, v89, v45, v90 bitop3:0x6a
    ds_write_b32 v98, v90 offset:16
    s_branch L2_xb79
L2_xe79:
    v_cmp_lt_u32 vcc, 32, v99
    v_cmp_lt_u32 s[58:59], 31, v88
    v_lshrrev_b32 v89, 16, v96
    v_add_u32 v97, 80, v97
    s_or_b64 vcc, vcc, s[58:59]
    s_cbranch_scc1 L2_xs79
    v_lshlrev_b32 v89, v1, v89
    v_and_b32 v89, v45, v89
    v_cmp_ne_u32 vcc, 0, v89
    v_xor_b32 v90, v97, v89
    s_add_u32 s3, s37, s38
    v_mbcnt_lo_u32_b32 v98, vcc_lo, 0
    v_mbcnt_hi_u32_b32 v98, vcc_hi, v98
    s_bcnt1_i32_b64 s41, vcc
    v_lshl_add_u32 v98, v98, 2, s3
    s_lshl2_add_u32 s37, s41, s37
    s_mov_b64 exec, vcc
    ds_write_b32 v98, v90
    s_mov_b64 exec, -1
    s_branch L2_xr79
L2_xs79:
    s_waitcnt lgkmcnt(0)
    s_mov_b32 s37, 0x10000
    s_branch L2_xw79
L2_c80:
    s_lshl_b64 s[52:53], s[82:83], 1
    s_andn2_b64 s[52:53], s[52:53], s[80:81]
    s_andn2_b64 s[52:53], s[52:53], s[54:55]
    s_or_b64 s[80:81], s[80:81], s[52:53]
    s_not_b64 vcc, s[52:53]
    s_mov_b64 exec, -1
    v_cndmask_b32_dpp v84, v84, v84, vcc wave_shr:1 row_mask:0xf bank_mask:0xf
    v_cndmask_b32_dpp v85, v85, v85, vcc wave_shr:1 row_mask:0xf bank_mask:0xf
    s_lshr_b64 s[52:53], s[52:53], 1
    v_cndmask_b32_dpp v86, v86, v86, vcc wave_shr:1 row_mask:0xf bank_mask:0xf
    v_cndmask_b32_dpp v87, v87, v87, vcc wave_shr:1 row_mask:0xf bank_mask:0xf
    s_andn2_b64 s[82:83], s[82:83], s[52:53]
    v_cndmask_b32_dpp v7, v7, v7, vcc wave_shr:1 row_mask:0xf bank_mask:0xf
    s_mov_b64 exec, s[54:55]
    s_cbranch_scc0 L2_d80
    s_mov_b64 exec, s[82:83]
    s_nop 1
    v_mfma_f32_4x4x4_16b_bf16 v[88:91], v[12:13], v[84:85], 0
    s_nop 1
    v_mfma_f32_4x4x4_16b_bf16 v[88:91], v[10:11], v[86:87], v[88:91]
    s_nop 4
    v_cvt_pk_bf16_f32 v88, v88, v89
    v_cvt_pk_bf16_f32 v89, v90, v91
    ds_pk_add_bf16 v7, v88 offset:65408
    ds_pk_add_bf16 v7, v89 offset:65412
    s_mov_b64 exec, s[54:55]
    s_branch L2_d80
L2_c81:
    s_lshl_b64 s[52:53], s[82:83], 1
    s_andn2_b64 s[52:53], s[52:53], s[80:81]
    s_andn2_b64 s[52:53], s[52:53], s[50:51]
    s_or_b64 s[80:81], s[80:81], s[52:53]
    s_not_b64 vcc, s[52:53]
    s_mov_b64 exec, -1
    v_cndmask_b32_dpp v84, v84, v84, vcc wave_shr:1 row_mask:0xf bank_mask:0xf
    v_cndmask_b32_dpp v85, v85, v85, vcc wave_shr:1 row_mask:0xf bank_mask:0xf
    s_lshr_b64 s[52:53], s[52:53], 1
    v_cndmask_b32_dpp v86, v86, v86, vcc wave_shr:1 row_mask:0xf bank_mask:0xf
    v_cndmask_b32_dpp v87, v87, v87, vcc wave_shr:1 row_mask:0xf bank_mask:0xf
    s_andn2_b64 s[82:83], s[82:83], s[52:53]
    v_cndmask_b32_dpp v7, v7, v7, vcc wave_shr:1 row_mask:0xf bank_mask:0xf
    s_mov_b64 exec, s[50:51]
    s_cbranch_scc0 L2_d81
    s_mov_b64 exec, s[82:83]
    s_nop 1
    v_mfma_f32_4x4x4_16b_bf16 v[88:91], v[12:13], v[84:85], 0
    s_nop 1
    v_mfma_f32_4x4x4_16b_bf16 v[88:91], v[10:11], v[86:87], v[88:91]
    s_nop 4
    v_cvt_pk_bf16_f32 v88, v88, v89
    v_cvt_pk_bf16_f32 v89, v90, v91
    ds_pk_add_bf16 v7, v88 offset:65408
    ds_pk_add_bf16 v7, v89 offset:65412
    s_mov_b64 exec, s[50:51]
    s_branch L2_d81
L2_xf79:
    s_cmp_gt_u32 s37, 1024
    s_cbranch_scc1 L2_xt79
    s_cmp_lt_u32 s37, 768
    s_cbranch_scc1 L2_xl79
    ds_read_b32 v33, v44 offset:896
    s_add_u32 s3, s42, 2
    s_bitset1_b32 s43, s3
    s_branch L2_xg79
L2_xl79:
    s_waitcnt lgkmcnt(0)
    v_mov_b32 v42, -1
    s_cmp_ge_u32 s37, 512
    s_cbranch_scc1 L2_xg79
    v_mov_b32 v43, -1
    s_cmp_ge_u32 s37, 256
    s_cbranch_scc1 L2_xg79
    v_mov_b32 v41, -1
    s_branch L2_xg79
L2_xt79:
    s_waitcnt lgkmcnt(0)
    v_mov_b32 v40, -1
    v_mov_b32 v41, -1
    v_mov_b32 v43, -1
    v_mov_b32 v42, -1
    s_add_u32 s3, s42, 2
    s_bitset1_b32 s36, s3
    s_branch L2_xg79
L2_oa82:
    v_and_b32 v47, 0x0fffffff, v32
    buffer_load_dword v114, v47, s[8:11], 0 offen offset:16
    s_mov_b64 exec, s[6:7]
    v_add_u32 v47, 8, v47
    v_lshrrev_b32 v32, 2, v32
    s_mov_b64 exec, -1
    buffer_load_dwordx2 v[112:113], v47, s[8:11], 0 offen
    s_branch L2_ob82
L2_c83:
    s_lshl_b64 s[52:53], s[82:83], 1
    s_andn2_b64 s[52:53], s[52:53], s[80:81]
    s_andn2_b64 s[52:53], s[52:53], s[54:55]
    s_or_b64 s[80:81], s[80:81], s[52:53]
    s_not_b64 vcc, s[52:53]
    s_mov_b64 exec, -1
    v_cndmask_b32_dpp v84, v84, v84, vcc wave_shr:1 row_mask:0xf bank_mask:0xf
    v_cndmask_b32_dpp v85, v85, v85, vcc wave_shr:1 row_mask:0xf bank_mask:0xf
    s_lshr_b64 s[52:53], s[52:53], 1
    v_cndmask_b32_dpp v86, v86, v86, vcc wave_shr:1 row_mask:0xf bank_mask:0xf
    v_cndmask_b32_dpp v87, v87, v87, vcc wave_shr:1 row_mask:0xf bank_mask:0xf
    s_andn2_b64 s[82:83], s[82:83], s[52:53]
    v_cndmask_b32_dpp v7, v7, v7, vcc wave_shr:1 row_mask:0xf bank_mask:0xf
    s_mov_b64 exec, s[54:55]
    s_cbranch_scc0 L2_d83
    s_mov_b64 exec, s[82:83]
    s_nop 1
    v_mfma_f32_4x4x4_16b_bf16 v[88:91], v[12:13], v[84:85], 0
    s_nop 1
    v_mfma_f32_4x4x4_16b_bf16 v[88:91], v[10:11], v[86:87], v[88:91]
    s_nop 4
    v_cvt_pk_bf16_f32 v88, v88, v89
    v_cvt_pk_bf16_f32 v89, v90, v91
    ds_pk_add_bf16 v7, v88 offset:65408
    ds_pk_add_bf16 v7, v89 offset:65412
    s_mov_b64 exec, s[54:55]
    s_branch L2_d83
L2_c84:
    s_lshl_b64 s[52:53], s[82:83], 1
    s_andn2_b64 s[52:53], s[52:53], s[80:81]
    s_andn2_b64 s[52:53], s[52:53], s[50:51]
    s_or_b64 s[80:81], s[80:81], s[52:53]
    s_not_b64 vcc, s[52:53]
    s_mov_b64 exec, -1
    v_cndmask_b32_dpp v84, v84, v84, vcc wave_shr:1 row_mask:0xf bank_mask:0xf
    v_cndmask_b32_dpp v85, v85, v85, vcc wave_shr:1 row_mask:0xf bank_mask:0xf
    s_lshr_b64 s[52:53], s[52:53], 1
    v_cndmask_b32_dpp v86, v86, v86, vcc wave_shr:1 row_mask:0xf bank_mask:0xf
    v_cndmask_b32_dpp v87, v87, v87, vcc wave_shr:1 row_mask:0xf bank_mask:0xf
    s_andn2_b64 s[82:83], s[82:83], s[52:53]
    v_cndmask_b32_dpp v7, v7, v7, vcc wave_shr:1 row_mask:0xf bank_mask:0xf
    s_mov_b64 exec, s[50:51]
    s_cbranch_scc0 L2_d84
    s_mov_b64 exec, s[82:83]
    s_nop 1
    v_mfma_f32_4x4x4_16b_bf16 v[88:91], v[12:13], v[84:85], 0
    s_nop 1
    v_mfma_f32_4x4x4_16b_bf16 v[88:91], v[10:11], v[86:87], v[88:91]
    s_nop 4
    v_cvt_pk_bf16_f32 v88, v88, v89
    v_cvt_pk_bf16_f32 v89, v90, v91
    ds_pk_add_bf16 v7, v88 offset:65408
    ds_pk_add_bf16 v7, v89 offset:65412
    s_mov_b64 exec, s[50:51]
    s_branch L2_d84
L2_c85:
    s_lshl_b64 s[52:53], s[82:83], 1
    s_andn2_b64 s[52:53], s[52:53], s[80:81]
    s_andn2_b64 s[52:53], s[52:53], s[54:55]
    s_or_b64 s[80:81], s[80:81], s[52:53]
    s_not_b64 vcc, s[52:53]
    s_mov_b64 exec, -1
    v_cndmask_b32_dpp v84, v84, v84, vcc wave_shr:1 row_mask:0xf bank_mask:0xf
    v_cndmask_b32_dpp v85, v85, v85, vcc wave_shr:1 row_mask:0xf bank_mask:0xf
    s_lshr_b64 s[52:53], s[52:53], 1
    v_cndmask_b32_dpp v86, v86, v86, vcc wave_shr:1 row_mask:0xf bank_mask:0xf
    v_cndmask_b32_dpp v87, v87, v87, vcc wave_shr:1 row_mask:0xf bank_mask:0xf
    s_andn2_b64 s[82:83], s[82:83], s[52:53]
    v_cndmask_b32_dpp v7, v7, v7, vcc wave_shr:1 row_mask:0xf bank_mask:0xf
    s_mov_b64 exec, s[54:55]
    s_cbranch_scc0 L2_d85
    s_mov_b64 exec, s[82:83]
    s_nop 1
    v_mfma_f32_4x4x4_16b_bf16 v[88:91], v[12:13], v[84:85], 0
    s_nop 1
    v_mfma_f32_4x4x4_16b_bf16 v[88:91], v[10:11], v[86:87], v[88:91]
    s_nop 4
    v_cvt_pk_bf16_f32 v88, v88, v89
    v_cvt_pk_bf16_f32 v89, v90, v91
    ds_pk_add_bf16 v7, v88 offset:65408
    ds_pk_add_bf16 v7, v89 offset:65412
    s_mov_b64 exec, s[54:55]
    s_branch L2_d85
L2_c86:
    s_lshl_b64 s[52:53], s[82:83], 1
    s_andn2_b64 s[52:53], s[52:53], s[80:81]
    s_andn2_b64 s[52:53], s[52:53], s[50:51]
    s_or_b64 s[80:81], s[80:81], s[52:53]
    s_not_b64 vcc, s[52:53]
    s_mov_b64 exec, -1
    v_cndmask_b32_dpp v84, v84, v84, vcc wave_shr:1 row_mask:0xf bank_mask:0xf
    v_cndmask_b32_dpp v85, v85, v85, vcc wave_shr:1 row_mask:0xf bank_mask:0xf
    s_lshr_b64 s[52:53], s[52:53], 1
    v_cndmask_b32_dpp v86, v86, v86, vcc wave_shr:1 row_mask:0xf bank_mask:0xf
    v_cndmask_b32_dpp v87, v87, v87, vcc wave_shr:1 row_mask:0xf bank_mask:0xf
    s_andn2_b64 s[82:83], s[82:83], s[52:53]
    v_cndmask_b32_dpp v7, v7, v7, vcc wave_shr:1 row_mask:0xf bank_mask:0xf
    s_mov_b64 exec, s[50:51]
    s_cbranch_scc0 L2_d86
    s_mov_b64 exec, s[82:83]
    s_nop 1
    v_mfma_f32_4x4x4_16b_bf16 v[88:91], v[12:13], v[84:85], 0
    s_nop 1
    v_mfma_f32_4x4x4_16b_bf16 v[88:91], v[10:11], v[86:87], v[88:91]
    s_nop 4
    v_cvt_pk_bf16_f32 v88, v88, v89
    v_cvt_pk_bf16_f32 v89, v90, v91
    ds_pk_add_bf16 v7, v88 offset:65408
    ds_pk_add_bf16 v7, v89 offset:65412
    s_mov_b64 exec, s[50:51]
    s_branch L2_d86
L2_c87:
    s_lshl_b64 s[52:53], s[82:83], 1
    s_andn2_b64 s[52:53], s[52:53], s[80:81]
    s_andn2_b64 s[52:53], s[52:53], s[54:55]
    s_or_b64 s[80:81], s[80:81], s[52:53]
    s_not_b64 vcc, s[52:53]
    s_mov_b64 exec, -1
    v_cndmask_b32_dpp v84, v84, v84, vcc wave_shr:1 row_mask:0xf bank_mask:0xf
    v_cndmask_b32_dpp v85, v85, v85, vcc wave_shr:1 row_mask:0xf bank_mask:0xf
    s_lshr_b64 s[52:53], s[52:53], 1
    v_cndmask_b32_dpp v86, v86, v86, vcc wave_shr:1 row_mask:0xf bank_mask:0xf
    v_cndmask_b32_dpp v87, v87, v87, vcc wave_shr:1 row_mask:0xf bank_mask:0xf
    s_andn2_b64 s[82:83], s[82:83], s[52:53]
    v_cndmask_b32_dpp v7, v7, v7, vcc wave_shr:1 row_mask:0xf bank_mask:0xf
    s_mov_b64 exec, s[54:55]
    s_cbranch_scc0 L2_d87
    s_mov_b64 exec, s[82:83]
    s_nop 1
    v_mfma_f32_4x4x4_16b_bf16 v[88:91], v[12:13], v[84:85], 0
    s_nop 1
    v_mfma_f32_4x4x4_16b_bf16 v[88:91], v[10:11], v[86:87], v[88:91]
    s_nop 4
    v_cvt_pk_bf16_f32 v88, v88, v89
    v_cvt_pk_bf16_f32 v89, v90, v91
    ds_pk_add_bf16 v7, v88 offset:65408
    ds_pk_add_bf16 v7, v89 offset:65412
    s_mov_b64 exec, s[54:55]
    s_branch L2_d87
L2_c88:
    s_lshl_b64 s[52:53], s[82:83], 1
    s_andn2_b64 s[52:53], s[52:53], s[80:81]
    s_andn2_b64 s[52:53], s[52:53], s[50:51]
    s_or_b64 s[80:81], s[80:81], s[52:53]
    s_not_b64 vcc, s[52:53]
    s_mov_b64 exec, -1
    v_cndmask_b32_dpp v84, v84, v84, vcc wave_shr:1 row_mask:0xf bank_mask:0xf
    v_cndmask_b32_dpp v85, v85, v85, vcc wave_shr:1 row_mask:0xf bank_mask:0xf
    s_lshr_b64 s[52:53], s[52:53], 1
    v_cndmask_b32_dpp v86, v86, v86, vcc wave_shr:1 row_mask:0xf bank_mask:0xf
    v_cndmask_b32_dpp v87, v87, v87, vcc wave_shr:1 row_mask:0xf bank_mask:0xf
    s_andn2_b64 s[82:83], s[82:83], s[52:53]
    v_cndmask_b32_dpp v7, v7, v7, vcc wave_shr:1 row_mask:0xf bank_mask:0xf
    s_mov_b64 exec, s[50:51]
    s_cbranch_scc0 L2_d88
    s_mov_b64 exec, s[82:83]
    s_nop 1
    v_mfma_f32_4x4x4_16b_bf16 v[88:91], v[12:13], v[84:85], 0
    s_nop 1
    v_mfma_f32_4x4x4_16b_bf16 v[88:91], v[10:11], v[86:87], v[88:91]
    s_nop 4
    v_cvt_pk_bf16_f32 v88, v88, v89
    v_cvt_pk_bf16_f32 v89, v90, v91
    ds_pk_add_bf16 v7, v88 offset:65408
    ds_pk_add_bf16 v7, v89 offset:65412
    s_mov_b64 exec, s[50:51]
    s_branch L2_d88
L2_oa89:
    s_waitcnt vmcnt(3)
    s_mov_b64 exec, s[6:7]
    v_lshrrev_b32 v114, 16, v114
    s_mov_b64 exec, -1
    v_and_b32 v46, 0x10000000, v32
    v_cmpx_eq_u32 vcc, 0, v46
    v_lshrrev_b32 v47, 14, v112
    v_and_b32 v47, v5, v47
    ds_read_b64 v[96:97], v47
    v_perm_b32 v98, v112, v114, s44
    v_bitop3_b32 v99, v112, 0.5, -0.5 bitop3:0xa8
    v_bitop3_b32 v98, v6, v98, v99 bitop3:0xca
    v_and_b32 v47, v5, v112
    s_waitcnt lgkmcnt(0)
    v_mfma_f32_4x4x4_16b_bf16 v[88:91], v[8:9], v[96:97], 0
    s_nop 4
    v_mul_f32 v88, v98, v88
    v_mul_f32 v89, v98, v89
    v_mul_f32 v90, v98, v90
    v_mul_f32 v91, v98, v91
    v_cvt_pk_bf16_f32 v88, v88, v89
    v_cvt_pk_bf16_f32 v89, v90, v91
    ds_pk_add_bf16 v47, v88 offset:65408
    ds_pk_add_bf16 v47, v89 offset:65412
    s_mov_b64 exec, -1
    v_and_b32 v46, 0x20000000, v32
    v_cmpx_eq_u32 vcc, 0, v46
    v_lshrrev_b32 v47, 14, v113
    v_and_b32 v47, v5, v47
    ds_read_b64 v[96:97], v47
    v_perm_b32 v98, v113, v114, s45
    v_bitop3_b32 v99, v113, 0.5, -0.5 bitop3:0xa8
    v_bitop3_b32 v98, v6, v98, v99 bitop3:0xca
    v_and_b32 v47, v5, v113
    s_waitcnt lgkmcnt(0)
    v_mfma_f32_4x4x4_16b_bf16 v[88:91], v[8:9], v[96:97], 0
    s_nop 4
    v_mul_f32 v88, v98, v88
    v_mul_f32 v89, v98, v89
    v_mul_f32 v90, v98, v90
    v_mul_f32 v91, v98, v91
    v_cvt_pk_bf16_f32 v88, v88, v89
    v_cvt_pk_bf16_f32 v89, v90, v91
    ds_pk_add_bf16 v47, v88 offset:65408
    ds_pk_add_bf16 v47, v89 offset:65412
    s_mov_b64 exec, -1
    s_branch L2_ob89
L2_xo90:
    v_cmp_lt_u32 vcc, 20, v99
    s_mov_b32 s101, 1
    s_cbranch_vccz L2_xp90
    v_cmp_lt_u32 vcc, 32, v99
    v_cmp_lt_u32 s[58:59], 31, v88
    s_mov_b32 s101, 2
    s_or_b64 vcc, vcc, s[58:59]
    s_cbranch_scc0 L2_xp90
    s_mov_b32 s37, 0x10000
    s_branch L2_xp90
L2_c91:
    s_lshl_b64 s[52:53], s[82:83], 1
    s_andn2_b64 s[52:53], s[52:53], s[80:81]
    s_andn2_b64 s[52:53], s[52:53], s[54:55]
    s_or_b64 s[80:81], s[80:81], s[52:53]
    s_not_b64 vcc, s[52:53]
    s_mov_b64 exec, -1
    v_cndmask_b32_dpp v84, v84, v84, vcc wave_shr:1 row_mask:0xf bank_mask:0xf
    v_cndmask_b32_dpp v85, v85, v85, vcc wave_shr:1 row_mask:0xf bank_mask:0xf
    s_lshr_b64 s[52:53], s[52:53], 1
    v_cndmask_b32_dpp v86, v86, v86, vcc wave_shr:1 row_mask:0xf bank_mask:0xf
    v_cndmask_b32_dpp v87, v87, v87, vcc wave_shr:1 row_mask:0xf bank_mask:0xf
    s_andn2_b64 s[82:83], s[82:83], s[52:53]
    v_cndmask_b32_dpp v7, v7, v7, vcc wave_shr:1 row_mask:0xf bank_mask:0xf
    s_mov_b64 exec, s[54:55]
    s_cbranch_scc0 L2_d91
    s_mov_b64 exec, s[82:83]
    s_nop 1
    v_mfma_f32_4x4x4_16b_bf16 v[88:91], v[12:13], v[84:85], 0
    s_nop 1
    v_mfma_f32_4x4x4_16b_bf16 v[88:91], v[10:11], v[86:87], v[88:91]
    s_nop 4
    v_cvt_pk_bf16_f32 v88, v88, v89
    v_cvt_pk_bf16_f32 v89, v90, v91
    ds_pk_add_bf16 v7, v88 offset:65408
    ds_pk_add_bf16 v7, v89 offset:65412
    s_mov_b64 exec, s[54:55]
    s_branch L2_d91
L2_c92:
    s_lshl_b64 s[52:53], s[82:83], 1
    s_andn2_b64 s[52:53], s[52:53], s[80:81]
    s_andn2_b64 s[52:53], s[52:53], s[50:51]
    s_or_b64 s[80:81], s[80:81], s[52:53]
    s_not_b64 vcc, s[52:53]
    s_mov_b64 exec, -1
    v_cndmask_b32_dpp v84, v84, v84, vcc wave_shr:1 row_mask:0xf bank_mask:0xf
    v_cndmask_b32_dpp v85, v85, v85, vcc wave_shr:1 row_mask:0xf bank_mask:0xf
    s_lshr_b64 s[52:53], s[52:53], 1
    v_cndmask_b32_dpp v86, v86, v86, vcc wave_shr:1 row_mask:0xf bank_mask:0xf
    v_cndmask_b32_dpp v87, v87, v87, vcc wave_shr:1 row_mask:0xf bank_mask:0xf
    s_andn2_b64 s[82:83], s[82:83], s[52:53]
    v_cndmask_b32_dpp v7, v7, v7, vcc wave_shr:1 row_mask:0xf bank_mask:0xf
    s_mov_b64 exec, s[50:51]
    s_cbranch_scc0 L2_d92
    s_mov_b64 exec, s[82:83]
    s_nop 1
    v_mfma_f32_4x4x4_16b_bf16 v[88:91], v[12:13], v[84:85], 0
    s_nop 1
    v_mfma_f32_4x4x4_16b_bf16 v[88:91], v[10:11], v[86:87], v[88:91]
    s_nop 4
    v_cvt_pk_bf16_f32 v88, v88, v89
    v_cvt_pk_bf16_f32 v89, v90, v91
    ds_pk_add_bf16 v7, v88 offset:65408
    ds_pk_add_bf16 v7, v89 offset:65412
    s_mov_b64 exec, s[50:51]
    s_branch L2_d92
L2_c93:
    s_lshl_b64 s[52:53], s[82:83], 1
    s_andn2_b64 s[52:53], s[52:53], s[80:81]
    s_andn2_b64 s[52:53], s[52:53], s[54:55]
    s_or_b64 s[80:81], s[80:81], s[52:53]
    s_not_b64 vcc, s[52:53]
    s_mov_b64 exec, -1
    v_cndmask_b32_dpp v84, v84, v84, vcc wave_shr:1 row_mask:0xf bank_mask:0xf
    v_cndmask_b32_dpp v85, v85, v85, vcc wave_shr:1 row_mask:0xf bank_mask:0xf
    s_lshr_b64 s[52:53], s[52:53], 1
    v_cndmask_b32_dpp v86, v86, v86, vcc wave_shr:1 row_mask:0xf bank_mask:0xf
    v_cndmask_b32_dpp v87, v87, v87, vcc wave_shr:1 row_mask:0xf bank_mask:0xf
    s_andn2_b64 s[82:83], s[82:83], s[52:53]
    v_cndmask_b32_dpp v7, v7, v7, vcc wave_shr:1 row_mask:0xf bank_mask:0xf
    s_mov_b64 exec, s[54:55]
    s_cbranch_scc0 L2_d93
    s_mov_b64 exec, s[82:83]
    s_nop 1
    v_mfma_f32_4x4x4_16b_bf16 v[88:91], v[12:13], v[84:85], 0
    s_nop 1
    v_mfma_f32_4x4x4_16b_bf16 v[88:91], v[10:11], v[86:87], v[88:91]
    s_nop 4
    v_cvt_pk_bf16_f32 v88, v88, v89
    v_cvt_pk_bf16_f32 v89, v90, v91
    ds_pk_add_bf16 v7, v88 offset:65408
    ds_pk_add_bf16 v7, v89 offset:65412
    s_mov_b64 exec, s[54:55]
    s_branch L2_d93
L2_c94:
    s_lshl_b64 s[52:53], s[82:83], 1
    s_andn2_b64 s[52:53], s[52:53], s[80:81]
    s_andn2_b64 s[52:53], s[52:53], s[50:51]
    s_or_b64 s[80:81], s[80:81], s[52:53]
    s_not_b64 vcc, s[52:53]
    s_mov_b64 exec, -1
    v_cndmask_b32_dpp v84, v84, v84, vcc wave_shr:1 row_mask:0xf bank_mask:0xf
    v_cndmask_b32_dpp v85, v85, v85, vcc wave_shr:1 row_mask:0xf bank_mask:0xf
    s_lshr_b64 s[52:53], s[52:53], 1
    v_cndmask_b32_dpp v86, v86, v86, vcc wave_shr:1 row_mask:0xf bank_mask:0xf
    v_cndmask_b32_dpp v87, v87, v87, vcc wave_shr:1 row_mask:0xf bank_mask:0xf
    s_andn2_b64 s[82:83], s[82:83], s[52:53]
    v_cndmask_b32_dpp v7, v7, v7, vcc wave_shr:1 row_mask:0xf bank_mask:0xf
    s_mov_b64 exec, s[50:51]
    s_cbranch_scc0 L2_d94
    s_mov_b64 exec, s[82:83]
    s_nop 1
    v_mfma_f32_4x4x4_16b_bf16 v[88:91], v[12:13], v[84:85], 0
    s_nop 1
    v_mfma_f32_4x4x4_16b_bf16 v[88:91], v[10:11], v[86:87], v[88:91]
    s_nop 4
    v_cvt_pk_bf16_f32 v88, v88, v89
    v_cvt_pk_bf16_f32 v89, v90, v91
    ds_pk_add_bf16 v7, v88 offset:65408
    ds_pk_add_bf16 v7, v89 offset:65412
    s_mov_b64 exec, s[50:51]
    s_branch L2_d94
L2_c95:
    s_lshl_b64 s[52:53], s[82:83], 1
    s_andn2_b64 s[52:53], s[52:53], s[80:81]
    s_andn2_b64 s[52:53], s[52:53], s[54:55]
    s_or_b64 s[80:81], s[80:81], s[52:53]
    s_not_b64 vcc, s[52:53]
    s_mov_b64 exec, -1
    v_cndmask_b32_dpp v84, v84, v84, vcc wave_shr:1 row_mask:0xf bank_mask:0xf
    v_cndmask_b32_dpp v85, v85, v85, vcc wave_shr:1 row_mask:0xf bank_mask:0xf
    s_lshr_b64 s[52:53], s[52:53], 1
    v_cndmask_b32_dpp v86, v86, v86, vcc wave_shr:1 row_mask:0xf bank_mask:0xf
    v_cndmask_b32_dpp v87, v87, v87, vcc wave_shr:1 row_mask:0xf bank_mask:0xf
    s_andn2_b64 s[82:83], s[82:83], s[52:53]
    v_cndmask_b32_dpp v7, v7, v7, vcc wave_shr:1 row_mask:0xf bank_mask:0xf
    s_mov_b64 exec, s[54:55]
    s_cbranch_scc0 L2_d95
    s_mov_b64 exec, s[82:83]
    s_nop 1
    v_mfma_f32_4x4x4_16b_bf16 v[88:91], v[12:13], v[84:85], 0
    s_nop 1
    v_mfma_f32_4x4x4_16b_bf16 v[88:91], v[10:11], v[86:87], v[88:91]
    s_nop 4
    v_cvt_pk_bf16_f32 v88, v88, v89
    v_cvt_pk_bf16_f32 v89, v90, v91
    ds_pk_add_bf16 v7, v88 offset:65408
    ds_pk_add_bf16 v7, v89 offset:65412
    s_mov_b64 exec, s[54:55]
    s_branch L2_d95
L2_c96:
    s_lshl_b64 s[52:53], s[82:83], 1
    s_andn2_b64 s[52:53], s[52:53], s[80:81]
    s_andn2_b64 s[52:53], s[52:53], s[50:51]
    s_or_b64 s[80:81], s[80:81], s[52:53]
    s_not_b64 vcc, s[52:53]
    s_mov_b64 exec, -1
    v_cndmask_b32_dpp v84, v84, v84, vcc wave_shr:1 row_mask:0xf bank_mask:0xf
    v_cndmask_b32_dpp v85, v85, v85, vcc wave_shr:1 row_mask:0xf bank_mask:0xf
    s_lshr_b64 s[52:53], s[52:53], 1
    v_cndmask_b32_dpp v86, v86, v86, vcc wave_shr:1 row_mask:0xf bank_mask:0xf
    v_cndmask_b32_dpp v87, v87, v87, vcc wave_shr:1 row_mask:0xf bank_mask:0xf
    s_andn2_b64 s[82:83], s[82:83], s[52:53]
    v_cndmask_b32_dpp v7, v7, v7, vcc wave_shr:1 row_mask:0xf bank_mask:0xf
    s_mov_b64 exec, s[50:51]
    s_cbranch_scc0 L2_d96
    s_mov_b64 exec, s[82:83]
    s_nop 1
    v_mfma_f32_4x4x4_16b_bf16 v[88:91], v[12:13], v[84:85], 0
    s_nop 1
    v_mfma_f32_4x4x4_16b_bf16 v[88:91], v[10:11], v[86:87], v[88:91]
    s_nop 4
    v_cvt_pk_bf16_f32 v88, v88, v89
    v_cvt_pk_bf16_f32 v89, v90, v91
    ds_pk_add_bf16 v7, v88 offset:65408
    ds_pk_add_bf16 v7, v89 offset:65412
    s_mov_b64 exec, s[50:51]
    s_branch L2_d96
L2_xa97:
    s_cmp_eq_u32 s101, 1
    s_cbranch_scc1 L2_xc97
    v_lshlrev_b32 v89, 0, v96
    v_add_u32 v90, 140, v97
    v_bitop3_b32 v90, v89, v45, v90 bitop3:0x6a
    ds_write_b32 v98, v90 offset:28
    v_lshlrev_b32 v89, 4, v96
    v_add_u32 v90, 120, v97
    v_bitop3_b32 v90, v89, v45, v90 bitop3:0x6a
    ds_write_b32 v98, v90 offset:24
    v_lshlrev_b32 v89, 8, v96
    v_add_u32 v90, 100, v97
    v_bitop3_b32 v90, v89, v45, v90 bitop3:0x6a
    ds_write_b32 v98, v90 offset:20
L2_xc97:
    v_lshlrev_b32 v89, 12, v96
    v_add_u32 v90, 80, v97
    v_bitop3_b32 v90, v89, v45, v90 bitop3:0x6a
    ds_write_b32 v98, v90 offset:16
    s_branch L2_xb97
L2_xe97:
    v_cmp_lt_u32 vcc, 32, v99
    v_cmp_lt_u32 s[58:59], 31, v88
    v_lshrrev_b32 v89, 16, v96
    v_add_u32 v97, 80, v97
    s_or_b64 vcc, vcc, s[58:59]
    s_cbranch_scc1 L2_xs97
    v_lshlrev_b32 v89, v1, v89
    v_and_b32 v89, v45, v89
    v_cmp_ne_u32 vcc, 0, v89
    v_xor_b32 v90, v97, v89
    s_add_u32 s3, s37, s38
    v_mbcnt_lo_u32_b32 v98, vcc_lo, 0
    v_mbcnt_hi_u32_b32 v98, vcc_hi, v98
    s_bcnt1_i32_b64 s41, vcc
    v_lshl_add_u32 v98, v98, 2, s3
    s_lshl2_add_u32 s37, s41, s37
    s_mov_b64 exec, vcc
    ds_write_b32 v98, v90
    s_mov_b64 exec, -1
    s_branch L2_xr97
L2_xs97:
    s_waitcnt lgkmcnt(0)
    s_mov_b32 s37, 0x10000
    s_branch L2_xw97
L2_c98:
    s_lshl_b64 s[52:53], s[82:83], 1
    s_andn2_b64 s[52:53], s[52:53], s[80:81]
    s_andn2_b64 s[52:53], s[52:53], s[54:55]
    s_or_b64 s[80:81], s[80:81], s[52:53]
    s_not_b64 vcc, s[52:53]
    s_mov_b64 exec, -1
    v_cndmask_b32_dpp v84, v84, v84, vcc wave_shr:1 row_mask:0xf bank_mask:0xf
    v_cndmask_b32_dpp v85, v85, v85, vcc wave_shr:1 row_mask:0xf bank_mask:0xf
    s_lshr_b64 s[52:53], s[52:53], 1
    v_cndmask_b32_dpp v86, v86, v86, vcc wave_shr:1 row_mask:0xf bank_mask:0xf
    v_cndmask_b32_dpp v87, v87, v87, vcc wave_shr:1 row_mask:0xf bank_mask:0xf
    s_andn2_b64 s[82:83], s[82:83], s[52:53]
    v_cndmask_b32_dpp v7, v7, v7, vcc wave_shr:1 row_mask:0xf bank_mask:0xf
    s_mov_b64 exec, s[54:55]
    s_cbranch_scc0 L2_d98
    s_mov_b64 exec, s[82:83]
    s_nop 1
    v_mfma_f32_4x4x4_16b_bf16 v[88:91], v[12:13], v[84:85], 0
    s_nop 1
    v_mfma_f32_4x4x4_16b_bf16 v[88:91], v[10:11], v[86:87], v[88:91]
    s_nop 4
    v_cvt_pk_bf16_f32 v88, v88, v89
    v_cvt_pk_bf16_f32 v89, v90, v91
    ds_pk_add_bf16 v7, v88 offset:65408
    ds_pk_add_bf16 v7, v89 offset:65412
    s_mov_b64 exec, s[54:55]
    s_branch L2_d98
L2_c99:
    s_lshl_b64 s[52:53], s[82:83], 1
    s_andn2_b64 s[52:53], s[52:53], s[80:81]
    s_andn2_b64 s[52:53], s[52:53], s[50:51]
    s_or_b64 s[80:81], s[80:81], s[52:53]
    s_not_b64 vcc, s[52:53]
    s_mov_b64 exec, -1
    v_cndmask_b32_dpp v84, v84, v84, vcc wave_shr:1 row_mask:0xf bank_mask:0xf
    v_cndmask_b32_dpp v85, v85, v85, vcc wave_shr:1 row_mask:0xf bank_mask:0xf
    s_lshr_b64 s[52:53], s[52:53], 1
    v_cndmask_b32_dpp v86, v86, v86, vcc wave_shr:1 row_mask:0xf bank_mask:0xf
    v_cndmask_b32_dpp v87, v87, v87, vcc wave_shr:1 row_mask:0xf bank_mask:0xf
    s_andn2_b64 s[82:83], s[82:83], s[52:53]
    v_cndmask_b32_dpp v7, v7, v7, vcc wave_shr:1 row_mask:0xf bank_mask:0xf
    s_mov_b64 exec, s[50:51]
    s_cbranch_scc0 L2_d99
    s_mov_b64 exec, s[82:83]
    s_nop 1
    v_mfma_f32_4x4x4_16b_bf16 v[88:91], v[12:13], v[84:85], 0
    s_nop 1
    v_mfma_f32_4x4x4_16b_bf16 v[88:91], v[10:11], v[86:87], v[88:91]
    s_nop 4
    v_cvt_pk_bf16_f32 v88, v88, v89
    v_cvt_pk_bf16_f32 v89, v90, v91
    ds_pk_add_bf16 v7, v88 offset:65408
    ds_pk_add_bf16 v7, v89 offset:65412
    s_mov_b64 exec, s[50:51]
    s_branch L2_d99
L2_xf97:
    s_cmp_gt_u32 s37, 1024
    s_cbranch_scc1 L2_xt97
    s_cmp_lt_u32 s37, 768
    s_cbranch_scc1 L2_xl97
    ds_read_b32 v32, v44 offset:896
    s_add_u32 s3, s42, 2
    s_bitset1_b32 s43, s3
    s_branch L2_xg97
L2_xl97:
    s_waitcnt lgkmcnt(0)
    v_mov_b32 v31, -1
    s_cmp_ge_u32 s37, 512
    s_cbranch_scc1 L2_xg97
    v_mov_b32 v39, -1
    s_cmp_ge_u32 s37, 256
    s_cbranch_scc1 L2_xg97
    v_mov_b32 v27, -1
    s_branch L2_xg97
L2_xt97:
    s_waitcnt lgkmcnt(0)
    v_mov_b32 v21, -1
    v_mov_b32 v27, -1
    v_mov_b32 v39, -1
    v_mov_b32 v31, -1
    s_add_u32 s3, s42, 2
    s_bitset1_b32 s36, s3
    s_branch L2_xg97
L2_oa100:
    v_and_b32 v47, 0x0fffffff, v33
    buffer_load_dword v114, v47, s[8:11], 0 offen offset:16
    s_mov_b64 exec, s[6:7]
    v_add_u32 v47, 8, v47
    v_lshrrev_b32 v33, 2, v33
    s_mov_b64 exec, -1
    buffer_load_dwordx2 v[112:113], v47, s[8:11], 0 offen
    s_branch L2_ob100
L2_c101:
    s_lshl_b64 s[52:53], s[82:83], 1
    s_andn2_b64 s[52:53], s[52:53], s[80:81]
    s_andn2_b64 s[52:53], s[52:53], s[54:55]
    s_or_b64 s[80:81], s[80:81], s[52:53]
    s_not_b64 vcc, s[52:53]
    s_mov_b64 exec, -1
    v_cndmask_b32_dpp v84, v84, v84, vcc wave_shr:1 row_mask:0xf bank_mask:0xf
    v_cndmask_b32_dpp v85, v85, v85, vcc wave_shr:1 row_mask:0xf bank_mask:0xf
    s_lshr_b64 s[52:53], s[52:53], 1
    v_cndmask_b32_dpp v86, v86, v86, vcc wave_shr:1 row_mask:0xf bank_mask:0xf
    v_cndmask_b32_dpp v87, v87, v87, vcc wave_shr:1 row_mask:0xf bank_mask:0xf
    s_andn2_b64 s[82:83], s[82:83], s[52:53]
    v_cndmask_b32_dpp v7, v7, v7, vcc wave_shr:1 row_mask:0xf bank_mask:0xf
    s_mov_b64 exec, s[54:55]
    s_cbranch_scc0 L2_d101
    s_mov_b64 exec, s[82:83]
    s_nop 1
    v_mfma_f32_4x4x4_16b_bf16 v[88:91], v[12:13], v[84:85], 0
    s_nop 1
    v_mfma_f32_4x4x4_16b_bf16 v[88:91], v[10:11], v[86:87], v[88:91]
    s_nop 4
    v_cvt_pk_bf16_f32 v88, v88, v89
    v_cvt_pk_bf16_f32 v89, v90, v91
    ds_pk_add_bf16 v7, v88 offset:65408
    ds_pk_add_bf16 v7, v89 offset:65412
    s_mov_b64 exec, s[54:55]
    s_branch L2_d101
L2_c102:
    s_lshl_b64 s[52:53], s[82:83], 1
    s_andn2_b64 s[52:53], s[52:53], s[80:81]
    s_andn2_b64 s[52:53], s[52:53], s[50:51]
    s_or_b64 s[80:81], s[80:81], s[52:53]
    s_not_b64 vcc, s[52:53]
    s_mov_b64 exec, -1
    v_cndmask_b32_dpp v84, v84, v84, vcc wave_shr:1 row_mask:0xf bank_mask:0xf
    v_cndmask_b32_dpp v85, v85, v85, vcc wave_shr:1 row_mask:0xf bank_mask:0xf
    s_lshr_b64 s[52:53], s[52:53], 1
    v_cndmask_b32_dpp v86, v86, v86, vcc wave_shr:1 row_mask:0xf bank_mask:0xf
    v_cndmask_b32_dpp v87, v87, v87, vcc wave_shr:1 row_mask:0xf bank_mask:0xf
    s_andn2_b64 s[82:83], s[82:83], s[52:53]
    v_cndmask_b32_dpp v7, v7, v7, vcc wave_shr:1 row_mask:0xf bank_mask:0xf
    s_mov_b64 exec, s[50:51]
    s_cbranch_scc0 L2_d102
    s_mov_b64 exec, s[82:83]
    s_nop 1
    v_mfma_f32_4x4x4_16b_bf16 v[88:91], v[12:13], v[84:85], 0
    s_nop 1
    v_mfma_f32_4x4x4_16b_bf16 v[88:91], v[10:11], v[86:87], v[88:91]
    s_nop 4
    v_cvt_pk_bf16_f32 v88, v88, v89
    v_cvt_pk_bf16_f32 v89, v90, v91
    ds_pk_add_bf16 v7, v88 offset:65408
    ds_pk_add_bf16 v7, v89 offset:65412
    s_mov_b64 exec, s[50:51]
    s_branch L2_d102
L2_c103:
    s_lshl_b64 s[52:53], s[82:83], 1
    s_andn2_b64 s[52:53], s[52:53], s[80:81]
    s_andn2_b64 s[52:53], s[52:53], s[54:55]
    s_or_b64 s[80:81], s[80:81], s[52:53]
    s_not_b64 vcc, s[52:53]
    s_mov_b64 exec, -1
    v_cndmask_b32_dpp v84, v84, v84, vcc wave_shr:1 row_mask:0xf bank_mask:0xf
    v_cndmask_b32_dpp v85, v85, v85, vcc wave_shr:1 row_mask:0xf bank_mask:0xf
    s_lshr_b64 s[52:53], s[52:53], 1
    v_cndmask_b32_dpp v86, v86, v86, vcc wave_shr:1 row_mask:0xf bank_mask:0xf
    v_cndmask_b32_dpp v87, v87, v87, vcc wave_shr:1 row_mask:0xf bank_mask:0xf
    s_andn2_b64 s[82:83], s[82:83], s[52:53]
    v_cndmask_b32_dpp v7, v7, v7, vcc wave_shr:1 row_mask:0xf bank_mask:0xf
    s_mov_b64 exec, s[54:55]
    s_cbranch_scc0 L2_d103
    s_mov_b64 exec, s[82:83]
    s_nop 1
    v_mfma_f32_4x4x4_16b_bf16 v[88:91], v[12:13], v[84:85], 0
    s_nop 1
    v_mfma_f32_4x4x4_16b_bf16 v[88:91], v[10:11], v[86:87], v[88:91]
    s_nop 4
    v_cvt_pk_bf16_f32 v88, v88, v89
    v_cvt_pk_bf16_f32 v89, v90, v91
    ds_pk_add_bf16 v7, v88 offset:65408
    ds_pk_add_bf16 v7, v89 offset:65412
    s_mov_b64 exec, s[54:55]
    s_branch L2_d103
L2_c104:
    s_lshl_b64 s[52:53], s[82:83], 1
    s_andn2_b64 s[52:53], s[52:53], s[80:81]
    s_andn2_b64 s[52:53], s[52:53], s[50:51]
    s_or_b64 s[80:81], s[80:81], s[52:53]
    s_not_b64 vcc, s[52:53]
    s_mov_b64 exec, -1
    v_cndmask_b32_dpp v84, v84, v84, vcc wave_shr:1 row_mask:0xf bank_mask:0xf
    v_cndmask_b32_dpp v85, v85, v85, vcc wave_shr:1 row_mask:0xf bank_mask:0xf
    s_lshr_b64 s[52:53], s[52:53], 1
    v_cndmask_b32_dpp v86, v86, v86, vcc wave_shr:1 row_mask:0xf bank_mask:0xf
    v_cndmask_b32_dpp v87, v87, v87, vcc wave_shr:1 row_mask:0xf bank_mask:0xf
    s_andn2_b64 s[82:83], s[82:83], s[52:53]
    v_cndmask_b32_dpp v7, v7, v7, vcc wave_shr:1 row_mask:0xf bank_mask:0xf
    s_mov_b64 exec, s[50:51]
    s_cbranch_scc0 L2_d104
    s_mov_b64 exec, s[82:83]
    s_nop 1
    v_mfma_f32_4x4x4_16b_bf16 v[88:91], v[12:13], v[84:85], 0
    s_nop 1
    v_mfma_f32_4x4x4_16b_bf16 v[88:91], v[10:11], v[86:87], v[88:91]
    s_nop 4
    v_cvt_pk_bf16_f32 v88, v88, v89
    v_cvt_pk_bf16_f32 v89, v90, v91
    ds_pk_add_bf16 v7, v88 offset:65408
    ds_pk_add_bf16 v7, v89 offset:65412
    s_mov_b64 exec, s[50:51]
    s_branch L2_d104
L2_c105:
    s_lshl_b64 s[52:53], s[82:83], 1
    s_andn2_b64 s[52:53], s[52:53], s[80:81]
    s_andn2_b64 s[52:53], s[52:53], s[54:55]
    s_or_b64 s[80:81], s[80:81], s[52:53]
    s_not_b64 vcc, s[52:53]
    s_mov_b64 exec, -1
    v_cndmask_b32_dpp v84, v84, v84, vcc wave_shr:1 row_mask:0xf bank_mask:0xf
    v_cndmask_b32_dpp v85, v85, v85, vcc wave_shr:1 row_mask:0xf bank_mask:0xf
    s_lshr_b64 s[52:53], s[52:53], 1
    v_cndmask_b32_dpp v86, v86, v86, vcc wave_shr:1 row_mask:0xf bank_mask:0xf
    v_cndmask_b32_dpp v87, v87, v87, vcc wave_shr:1 row_mask:0xf bank_mask:0xf
    s_andn2_b64 s[82:83], s[82:83], s[52:53]
    v_cndmask_b32_dpp v7, v7, v7, vcc wave_shr:1 row_mask:0xf bank_mask:0xf
    s_mov_b64 exec, s[54:55]
    s_cbranch_scc0 L2_d105
    s_mov_b64 exec, s[82:83]
    s_nop 1
    v_mfma_f32_4x4x4_16b_bf16 v[88:91], v[12:13], v[84:85], 0
    s_nop 1
    v_mfma_f32_4x4x4_16b_bf16 v[88:91], v[10:11], v[86:87], v[88:91]
    s_nop 4
    v_cvt_pk_bf16_f32 v88, v88, v89
    v_cvt_pk_bf16_f32 v89, v90, v91
    ds_pk_add_bf16 v7, v88 offset:65408
    ds_pk_add_bf16 v7, v89 offset:65412
    s_mov_b64 exec, s[54:55]
    s_branch L2_d105
L2_c106:
    s_lshl_b64 s[52:53], s[82:83], 1
    s_andn2_b64 s[52:53], s[52:53], s[80:81]
    s_andn2_b64 s[52:53], s[52:53], s[50:51]
    s_or_b64 s[80:81], s[80:81], s[52:53]
    s_not_b64 vcc, s[52:53]
    s_mov_b64 exec, -1
    v_cndmask_b32_dpp v84, v84, v84, vcc wave_shr:1 row_mask:0xf bank_mask:0xf
    v_cndmask_b32_dpp v85, v85, v85, vcc wave_shr:1 row_mask:0xf bank_mask:0xf
    s_lshr_b64 s[52:53], s[52:53], 1
    v_cndmask_b32_dpp v86, v86, v86, vcc wave_shr:1 row_mask:0xf bank_mask:0xf
    v_cndmask_b32_dpp v87, v87, v87, vcc wave_shr:1 row_mask:0xf bank_mask:0xf
    s_andn2_b64 s[82:83], s[82:83], s[52:53]
    v_cndmask_b32_dpp v7, v7, v7, vcc wave_shr:1 row_mask:0xf bank_mask:0xf
    s_mov_b64 exec, s[50:51]
    s_cbranch_scc0 L2_d106
    s_mov_b64 exec, s[82:83]
    s_nop 1
    v_mfma_f32_4x4x4_16b_bf16 v[88:91], v[12:13], v[84:85], 0
    s_nop 1
    v_mfma_f32_4x4x4_16b_bf16 v[88:91], v[10:11], v[86:87], v[88:91]
    s_nop 4
    v_cvt_pk_bf16_f32 v88, v88, v89
    v_cvt_pk_bf16_f32 v89, v90, v91
    ds_pk_add_bf16 v7, v88 offset:65408
    ds_pk_add_bf16 v7, v89 offset:65412
    s_mov_b64 exec, s[50:51]
    s_branch L2_d106
L2_oa107:
    s_waitcnt vmcnt(3)
    s_mov_b64 exec, s[6:7]
    v_lshrrev_b32 v114, 16, v114
    s_mov_b64 exec, -1
    v_and_b32 v46, 0x10000000, v33
    v_cmpx_eq_u32 vcc, 0, v46
    v_lshrrev_b32 v47, 14, v112
    v_and_b32 v47, v5, v47
    ds_read_b64 v[96:97], v47
    v_perm_b32 v98, v112, v114, s44
    v_bitop3_b32 v99, v112, 0.5, -0.5 bitop3:0xa8
    v_bitop3_b32 v98, v6, v98, v99 bitop3:0xca
    v_and_b32 v47, v5, v112
    s_waitcnt lgkmcnt(0)
    v_mfma_f32_4x4x4_16b_bf16 v[88:91], v[8:9], v[96:97], 0
    s_nop 4
    v_mul_f32 v88, v98, v88
    v_mul_f32 v89, v98, v89
    v_mul_f32 v90, v98, v90
    v_mul_f32 v91, v98, v91
    v_cvt_pk_bf16_f32 v88, v88, v89
    v_cvt_pk_bf16_f32 v89, v90, v91
    ds_pk_add_bf16 v47, v88 offset:65408
    ds_pk_add_bf16 v47, v89 offset:65412
    s_mov_b64 exec, -1
    v_and_b32 v46, 0x20000000, v33
    v_cmpx_eq_u32 vcc, 0, v46
    v_lshrrev_b32 v47, 14, v113
    v_and_b32 v47, v5, v47
    ds_read_b64 v[96:97], v47
    v_perm_b32 v98, v113, v114, s45
    v_bitop3_b32 v99, v113, 0.5, -0.5 bitop3:0xa8
    v_bitop3_b32 v98, v6, v98, v99 bitop3:0xca
    v_and_b32 v47, v5, v113
    s_waitcnt lgkmcnt(0)
    v_mfma_f32_4x4x4_16b_bf16 v[88:91], v[8:9], v[96:97], 0
    s_nop 4
    v_mul_f32 v88, v98, v88
    v_mul_f32 v89, v98, v89
    v_mul_f32 v90, v98, v90
    v_mul_f32 v91, v98, v91
    v_cvt_pk_bf16_f32 v88, v88, v89
    v_cvt_pk_bf16_f32 v89, v90, v91
    ds_pk_add_bf16 v47, v88 offset:65408
    ds_pk_add_bf16 v47, v89 offset:65412
    s_mov_b64 exec, -1
    s_branch L2_ob107
L2_xo108:
    v_cmp_lt_u32 vcc, 20, v99
    s_mov_b32 s101, 1
    s_cbranch_vccz L2_xp108
    v_cmp_lt_u32 vcc, 32, v99
    v_cmp_lt_u32 s[58:59], 31, v88
    s_mov_b32 s101, 2
    s_or_b64 vcc, vcc, s[58:59]
    s_cbranch_scc0 L2_xp108
    s_mov_b32 s37, 0x10000
    s_branch L2_xp108
L2_c109:
    s_lshl_b64 s[52:53], s[82:83], 1
    s_andn2_b64 s[52:53], s[52:53], s[80:81]
    s_andn2_b64 s[52:53], s[52:53], s[54:55]
    s_or_b64 s[80:81], s[80:81], s[52:53]
    s_not_b64 vcc, s[52:53]
    s_mov_b64 exec, -1
    v_cndmask_b32_dpp v84, v84, v84, vcc wave_shr:1 row_mask:0xf bank_mask:0xf
    v_cndmask_b32_dpp v85, v85, v85, vcc wave_shr:1 row_mask:0xf bank_mask:0xf
    s_lshr_b64 s[52:53], s[52:53], 1
    v_cndmask_b32_dpp v86, v86, v86, vcc wave_shr:1 row_mask:0xf bank_mask:0xf
    v_cndmask_b32_dpp v87, v87, v87, vcc wave_shr:1 row_mask:0xf bank_mask:0xf
    s_andn2_b64 s[82:83], s[82:83], s[52:53]
    v_cndmask_b32_dpp v7, v7, v7, vcc wave_shr:1 row_mask:0xf bank_mask:0xf
    s_mov_b64 exec, s[54:55]
    s_cbranch_scc0 L2_d109
    s_mov_b64 exec, s[82:83]
    s_nop 1
    v_mfma_f32_4x4x4_16b_bf16 v[88:91], v[12:13], v[84:85], 0
    s_nop 1
    v_mfma_f32_4x4x4_16b_bf16 v[88:91], v[10:11], v[86:87], v[88:91]
    s_nop 4
    v_cvt_pk_bf16_f32 v88, v88, v89
    v_cvt_pk_bf16_f32 v89, v90, v91
    ds_pk_add_bf16 v7, v88 offset:65408
    ds_pk_add_bf16 v7, v89 offset:65412
    s_mov_b64 exec, s[54:55]
    s_branch L2_d109
L2_c110:
    s_lshl_b64 s[52:53], s[82:83], 1
    s_andn2_b64 s[52:53], s[52:53], s[80:81]
    s_andn2_b64 s[52:53], s[52:53], s[50:51]
    s_or_b64 s[80:81], s[80:81], s[52:53]
    s_not_b64 vcc, s[52:53]
    s_mov_b64 exec, -1
    v_cndmask_b32_dpp v84, v84, v84, vcc wave_shr:1 row_mask:0xf bank_mask:0xf
    v_cndmask_b32_dpp v85, v85, v85, vcc wave_shr:1 row_mask:0xf bank_mask:0xf
    s_lshr_b64 s[52:53], s[52:53], 1
    v_cndmask_b32_dpp v86, v86, v86, vcc wave_shr:1 row_mask:0xf bank_mask:0xf
    v_cndmask_b32_dpp v87, v87, v87, vcc wave_shr:1 row_mask:0xf bank_mask:0xf
    s_andn2_b64 s[82:83], s[82:83], s[52:53]
    v_cndmask_b32_dpp v7, v7, v7, vcc wave_shr:1 row_mask:0xf bank_mask:0xf
    s_mov_b64 exec, s[50:51]
    s_cbranch_scc0 L2_d110
    s_mov_b64 exec, s[82:83]
    s_nop 1
    v_mfma_f32_4x4x4_16b_bf16 v[88:91], v[12:13], v[84:85], 0
    s_nop 1
    v_mfma_f32_4x4x4_16b_bf16 v[88:91], v[10:11], v[86:87], v[88:91]
    s_nop 4
    v_cvt_pk_bf16_f32 v88, v88, v89
    v_cvt_pk_bf16_f32 v89, v90, v91
    ds_pk_add_bf16 v7, v88 offset:65408
    ds_pk_add_bf16 v7, v89 offset:65412
    s_mov_b64 exec, s[50:51]
    s_branch L2_d110
L2_c111:
    s_lshl_b64 s[52:53], s[82:83], 1
    s_andn2_b64 s[52:53], s[52:53], s[80:81]
    s_andn2_b64 s[52:53], s[52:53], s[54:55]
    s_or_b64 s[80:81], s[80:81], s[52:53]
    s_not_b64 vcc, s[52:53]
    s_mov_b64 exec, -1
    v_cndmask_b32_dpp v84, v84, v84, vcc wave_shr:1 row_mask:0xf bank_mask:0xf
    v_cndmask_b32_dpp v85, v85, v85, vcc wave_shr:1 row_mask:0xf bank_mask:0xf
    s_lshr_b64 s[52:53], s[52:53], 1
    v_cndmask_b32_dpp v86, v86, v86, vcc wave_shr:1 row_mask:0xf bank_mask:0xf
    v_cndmask_b32_dpp v87, v87, v87, vcc wave_shr:1 row_mask:0xf bank_mask:0xf
    s_andn2_b64 s[82:83], s[82:83], s[52:53]
    v_cndmask_b32_dpp v7, v7, v7, vcc wave_shr:1 row_mask:0xf bank_mask:0xf
    s_mov_b64 exec, s[54:55]
    s_cbranch_scc0 L2_d111
    s_mov_b64 exec, s[82:83]
    s_nop 1
    v_mfma_f32_4x4x4_16b_bf16 v[88:91], v[12:13], v[84:85], 0
    s_nop 1
    v_mfma_f32_4x4x4_16b_bf16 v[88:91], v[10:11], v[86:87], v[88:91]
    s_nop 4
    v_cvt_pk_bf16_f32 v88, v88, v89
    v_cvt_pk_bf16_f32 v89, v90, v91
    ds_pk_add_bf16 v7, v88 offset:65408
    ds_pk_add_bf16 v7, v89 offset:65412
    s_mov_b64 exec, s[54:55]
    s_branch L2_d111
L2_c112:
    s_lshl_b64 s[52:53], s[82:83], 1
    s_andn2_b64 s[52:53], s[52:53], s[80:81]
    s_andn2_b64 s[52:53], s[52:53], s[50:51]
    s_or_b64 s[80:81], s[80:81], s[52:53]
    s_not_b64 vcc, s[52:53]
    s_mov_b64 exec, -1
    v_cndmask_b32_dpp v84, v84, v84, vcc wave_shr:1 row_mask:0xf bank_mask:0xf
    v_cndmask_b32_dpp v85, v85, v85, vcc wave_shr:1 row_mask:0xf bank_mask:0xf
    s_lshr_b64 s[52:53], s[52:53], 1
    v_cndmask_b32_dpp v86, v86, v86, vcc wave_shr:1 row_mask:0xf bank_mask:0xf
    v_cndmask_b32_dpp v87, v87, v87, vcc wave_shr:1 row_mask:0xf bank_mask:0xf
    s_andn2_b64 s[82:83], s[82:83], s[52:53]
    v_cndmask_b32_dpp v7, v7, v7, vcc wave_shr:1 row_mask:0xf bank_mask:0xf
    s_mov_b64 exec, s[50:51]
    s_cbranch_scc0 L2_d112
    s_mov_b64 exec, s[82:83]
    s_nop 1
    v_mfma_f32_4x4x4_16b_bf16 v[88:91], v[12:13], v[84:85], 0
    s_nop 1
    v_mfma_f32_4x4x4_16b_bf16 v[88:91], v[10:11], v[86:87], v[88:91]
    s_nop 4
    v_cvt_pk_bf16_f32 v88, v88, v89
    v_cvt_pk_bf16_f32 v89, v90, v91
    ds_pk_add_bf16 v7, v88 offset:65408
    ds_pk_add_bf16 v7, v89 offset:65412
    s_mov_b64 exec, s[50:51]
    s_branch L2_d112
L2_c113:
    s_lshl_b64 s[52:53], s[82:83], 1
    s_andn2_b64 s[52:53], s[52:53], s[80:81]
    s_andn2_b64 s[52:53], s[52:53], s[54:55]
    s_or_b64 s[80:81], s[80:81], s[52:53]
    s_not_b64 vcc, s[52:53]
    s_mov_b64 exec, -1
    v_cndmask_b32_dpp v84, v84, v84, vcc wave_shr:1 row_mask:0xf bank_mask:0xf
    v_cndmask_b32_dpp v85, v85, v85, vcc wave_shr:1 row_mask:0xf bank_mask:0xf
    s_lshr_b64 s[52:53], s[52:53], 1
    v_cndmask_b32_dpp v86, v86, v86, vcc wave_shr:1 row_mask:0xf bank_mask:0xf
    v_cndmask_b32_dpp v87, v87, v87, vcc wave_shr:1 row_mask:0xf bank_mask:0xf
    s_andn2_b64 s[82:83], s[82:83], s[52:53]
    v_cndmask_b32_dpp v7, v7, v7, vcc wave_shr:1 row_mask:0xf bank_mask:0xf
    s_mov_b64 exec, s[54:55]
    s_cbranch_scc0 L2_d113
    s_mov_b64 exec, s[82:83]
    s_nop 1
    v_mfma_f32_4x4x4_16b_bf16 v[88:91], v[12:13], v[84:85], 0
    s_nop 1
    v_mfma_f32_4x4x4_16b_bf16 v[88:91], v[10:11], v[86:87], v[88:91]
    s_nop 4
    v_cvt_pk_bf16_f32 v88, v88, v89
    v_cvt_pk_bf16_f32 v89, v90, v91
    ds_pk_add_bf16 v7, v88 offset:65408
    ds_pk_add_bf16 v7, v89 offset:65412
    s_mov_b64 exec, s[54:55]
    s_branch L2_d113
L2_c114:
    s_lshl_b64 s[52:53], s[82:83], 1
    s_andn2_b64 s[52:53], s[52:53], s[80:81]
    s_andn2_b64 s[52:53], s[52:53], s[50:51]
    s_or_b64 s[80:81], s[80:81], s[52:53]
    s_not_b64 vcc, s[52:53]
    s_mov_b64 exec, -1
    v_cndmask_b32_dpp v84, v84, v84, vcc wave_shr:1 row_mask:0xf bank_mask:0xf
    v_cndmask_b32_dpp v85, v85, v85, vcc wave_shr:1 row_mask:0xf bank_mask:0xf
    s_lshr_b64 s[52:53], s[52:53], 1
    v_cndmask_b32_dpp v86, v86, v86, vcc wave_shr:1 row_mask:0xf bank_mask:0xf
    v_cndmask_b32_dpp v87, v87, v87, vcc wave_shr:1 row_mask:0xf bank_mask:0xf
    s_andn2_b64 s[82:83], s[82:83], s[52:53]
    v_cndmask_b32_dpp v7, v7, v7, vcc wave_shr:1 row_mask:0xf bank_mask:0xf
    s_mov_b64 exec, s[50:51]
    s_cbranch_scc0 L2_d114
    s_mov_b64 exec, s[82:83]
    s_nop 1
    v_mfma_f32_4x4x4_16b_bf16 v[88:91], v[12:13], v[84:85], 0
    s_nop 1
    v_mfma_f32_4x4x4_16b_bf16 v[88:91], v[10:11], v[86:87], v[88:91]
    s_nop 4
    v_cvt_pk_bf16_f32 v88, v88, v89
    v_cvt_pk_bf16_f32 v89, v90, v91
    ds_pk_add_bf16 v7, v88 offset:65408
    ds_pk_add_bf16 v7, v89 offset:65412
    s_mov_b64 exec, s[50:51]
    s_branch L2_d114
L2_xa115:
    s_cmp_eq_u32 s101, 1
    s_cbranch_scc1 L2_xc115
    v_lshlrev_b32 v89, 0, v96
    v_add_u32 v90, 140, v97
    v_bitop3_b32 v90, v89, v45, v90 bitop3:0x6a
    ds_write_b32 v98, v90 offset:28
    v_lshlrev_b32 v89, 4, v96
    v_add_u32 v90, 120, v97
    v_bitop3_b32 v90, v89, v45, v90 bitop3:0x6a
    ds_write_b32 v98, v90 offset:24
    v_lshlrev_b32 v89, 8, v96
    v_add_u32 v90, 100, v97
    v_bitop3_b32 v90, v89, v45, v90 bitop3:0x6a
    ds_write_b32 v98, v90 offset:20
L2_xc115:
    v_lshlrev_b32 v89, 12, v96
    v_add_u32 v90, 80, v97
    v_bitop3_b32 v90, v89, v45, v90 bitop3:0x6a
    ds_write_b32 v98, v90 offset:16
    s_branch L2_xb115
L2_xe115:
    v_cmp_lt_u32 vcc, 32, v99
    v_cmp_lt_u32 s[58:59], 31, v88
    v_lshrrev_b32 v89, 16, v96
    v_add_u32 v97, 80, v97
    s_or_b64 vcc, vcc, s[58:59]
    s_cbranch_scc1 L2_xs115
    v_lshlrev_b32 v89, v1, v89
    v_and_b32 v89, v45, v89
    v_cmp_ne_u32 vcc, 0, v89
    v_xor_b32 v90, v97, v89
    s_add_u32 s3, s37, s38
    v_mbcnt_lo_u32_b32 v98, vcc_lo, 0
    v_mbcnt_hi_u32_b32 v98, vcc_hi, v98
    s_bcnt1_i32_b64 s41, vcc
    v_lshl_add_u32 v98, v98, 2, s3
    s_lshl2_add_u32 s37, s41, s37
    s_mov_b64 exec, vcc
    ds_write_b32 v98, v90
    s_mov_b64 exec, -1
    s_branch L2_xr115
L2_xs115:
    s_waitcnt lgkmcnt(0)
    s_mov_b32 s37, 0x10000
    s_branch L2_xw115
L2_c116:
    s_lshl_b64 s[52:53], s[82:83], 1
    s_andn2_b64 s[52:53], s[52:53], s[80:81]
    s_andn2_b64 s[52:53], s[52:53], s[54:55]
    s_or_b64 s[80:81], s[80:81], s[52:53]
    s_not_b64 vcc, s[52:53]
    s_mov_b64 exec, -1
    v_cndmask_b32_dpp v84, v84, v84, vcc wave_shr:1 row_mask:0xf bank_mask:0xf
    v_cndmask_b32_dpp v85, v85, v85, vcc wave_shr:1 row_mask:0xf bank_mask:0xf
    s_lshr_b64 s[52:53], s[52:53], 1
    v_cndmask_b32_dpp v86, v86, v86, vcc wave_shr:1 row_mask:0xf bank_mask:0xf
    v_cndmask_b32_dpp v87, v87, v87, vcc wave_shr:1 row_mask:0xf bank_mask:0xf
    s_andn2_b64 s[82:83], s[82:83], s[52:53]
    v_cndmask_b32_dpp v7, v7, v7, vcc wave_shr:1 row_mask:0xf bank_mask:0xf
    s_mov_b64 exec, s[54:55]
    s_cbranch_scc0 L2_d116
    s_mov_b64 exec, s[82:83]
    s_nop 1
    v_mfma_f32_4x4x4_16b_bf16 v[88:91], v[12:13], v[84:85], 0
    s_nop 1
    v_mfma_f32_4x4x4_16b_bf16 v[88:91], v[10:11], v[86:87], v[88:91]
    s_nop 4
    v_cvt_pk_bf16_f32 v88, v88, v89
    v_cvt_pk_bf16_f32 v89, v90, v91
    ds_pk_add_bf16 v7, v88 offset:65408
    ds_pk_add_bf16 v7, v89 offset:65412
    s_mov_b64 exec, s[54:55]
    s_branch L2_d116
L2_c117:
    s_lshl_b64 s[52:53], s[82:83], 1
    s_andn2_b64 s[52:53], s[52:53], s[80:81]
    s_andn2_b64 s[52:53], s[52:53], s[50:51]
    s_or_b64 s[80:81], s[80:81], s[52:53]
    s_not_b64 vcc, s[52:53]
    s_mov_b64 exec, -1
    v_cndmask_b32_dpp v84, v84, v84, vcc wave_shr:1 row_mask:0xf bank_mask:0xf
    v_cndmask_b32_dpp v85, v85, v85, vcc wave_shr:1 row_mask:0xf bank_mask:0xf
    s_lshr_b64 s[52:53], s[52:53], 1
    v_cndmask_b32_dpp v86, v86, v86, vcc wave_shr:1 row_mask:0xf bank_mask:0xf
    v_cndmask_b32_dpp v87, v87, v87, vcc wave_shr:1 row_mask:0xf bank_mask:0xf
    s_andn2_b64 s[82:83], s[82:83], s[52:53]
    v_cndmask_b32_dpp v7, v7, v7, vcc wave_shr:1 row_mask:0xf bank_mask:0xf
    s_mov_b64 exec, s[50:51]
    s_cbranch_scc0 L2_d117
    s_mov_b64 exec, s[82:83]
    s_nop 1
    v_mfma_f32_4x4x4_16b_bf16 v[88:91], v[12:13], v[84:85], 0
    s_nop 1
    v_mfma_f32_4x4x4_16b_bf16 v[88:91], v[10:11], v[86:87], v[88:91]
    s_nop 4
    v_cvt_pk_bf16_f32 v88, v88, v89
    v_cvt_pk_bf16_f32 v89, v90, v91
    ds_pk_add_bf16 v7, v88 offset:65408
    ds_pk_add_bf16 v7, v89 offset:65412
    s_mov_b64 exec, s[50:51]
    s_branch L2_d117
L2_xf115:
    s_cmp_gt_u32 s37, 1024
    s_cbranch_scc1 L2_xt115
    s_cmp_lt_u32 s37, 768
    s_cbranch_scc1 L2_xl115
    ds_read_b32 v33, v44 offset:896
    s_add_u32 s3, s42, 2
    s_bitset1_b32 s43, s3
    s_branch L2_xg115
L2_xl115:
    s_waitcnt lgkmcnt(0)
    v_mov_b32 v42, -1
    s_cmp_ge_u32 s37, 512
    s_cbranch_scc1 L2_xg115
    v_mov_b32 v43, -1
    s_cmp_ge_u32 s37, 256
    s_cbranch_scc1 L2_xg115
    v_mov_b32 v41, -1
    s_branch L2_xg115
L2_xt115:
    s_waitcnt lgkmcnt(0)
    v_mov_b32 v40, -1
    v_mov_b32 v41, -1
    v_mov_b32 v43, -1
    v_mov_b32 v42, -1
    s_add_u32 s3, s42, 2
    s_bitset1_b32 s36, s3
    s_branch L2_xg115
L2_oa118:
    v_and_b32 v47, 0x0fffffff, v32
    buffer_load_dword v114, v47, s[8:11], 0 offen offset:16
    s_mov_b64 exec, s[6:7]
    v_add_u32 v47, 8, v47
    v_lshrrev_b32 v32, 2, v32
    s_mov_b64 exec, -1
    buffer_load_dwordx2 v[112:113], v47, s[8:11], 0 offen
    s_branch L2_ob118
L2_c119:
    s_lshl_b64 s[52:53], s[82:83], 1
    s_andn2_b64 s[52:53], s[52:53], s[80:81]
    s_andn2_b64 s[52:53], s[52:53], s[54:55]
    s_or_b64 s[80:81], s[80:81], s[52:53]
    s_not_b64 vcc, s[52:53]
    s_mov_b64 exec, -1
    v_cndmask_b32_dpp v84, v84, v84, vcc wave_shr:1 row_mask:0xf bank_mask:0xf
    v_cndmask_b32_dpp v85, v85, v85, vcc wave_shr:1 row_mask:0xf bank_mask:0xf
    s_lshr_b64 s[52:53], s[52:53], 1
    v_cndmask_b32_dpp v86, v86, v86, vcc wave_shr:1 row_mask:0xf bank_mask:0xf
    v_cndmask_b32_dpp v87, v87, v87, vcc wave_shr:1 row_mask:0xf bank_mask:0xf
    s_andn2_b64 s[82:83], s[82:83], s[52:53]
    v_cndmask_b32_dpp v7, v7, v7, vcc wave_shr:1 row_mask:0xf bank_mask:0xf
    s_mov_b64 exec, s[54:55]
    s_cbranch_scc0 L2_d119
    s_mov_b64 exec, s[82:83]
    s_nop 1
    v_mfma_f32_4x4x4_16b_bf16 v[88:91], v[12:13], v[84:85], 0
    s_nop 1
    v_mfma_f32_4x4x4_16b_bf16 v[88:91], v[10:11], v[86:87], v[88:91]
    s_nop 4
    v_cvt_pk_bf16_f32 v88, v88, v89
    v_cvt_pk_bf16_f32 v89, v90, v91
    ds_pk_add_bf16 v7, v88 offset:65408
    ds_pk_add_bf16 v7, v89 offset:65412
    s_mov_b64 exec, s[54:55]
    s_branch L2_d119
L2_c120:
    s_lshl_b64 s[52:53], s[82:83], 1
    s_andn2_b64 s[52:53], s[52:53], s[80:81]
    s_andn2_b64 s[52:53], s[52:53], s[50:51]
    s_or_b64 s[80:81], s[80:81], s[52:53]
    s_not_b64 vcc, s[52:53]
    s_mov_b64 exec, -1
    v_cndmask_b32_dpp v84, v84, v84, vcc wave_shr:1 row_mask:0xf bank_mask:0xf
    v_cndmask_b32_dpp v85, v85, v85, vcc wave_shr:1 row_mask:0xf bank_mask:0xf
    s_lshr_b64 s[52:53], s[52:53], 1
    v_cndmask_b32_dpp v86, v86, v86, vcc wave_shr:1 row_mask:0xf bank_mask:0xf
    v_cndmask_b32_dpp v87, v87, v87, vcc wave_shr:1 row_mask:0xf bank_mask:0xf
    s_andn2_b64 s[82:83], s[82:83], s[52:53]
    v_cndmask_b32_dpp v7, v7, v7, vcc wave_shr:1 row_mask:0xf bank_mask:0xf
    s_mov_b64 exec, s[50:51]
    s_cbranch_scc0 L2_d120
    s_mov_b64 exec, s[82:83]
    s_nop 1
    v_mfma_f32_4x4x4_16b_bf16 v[88:91], v[12:13], v[84:85], 0
    s_nop 1
    v_mfma_f32_4x4x4_16b_bf16 v[88:91], v[10:11], v[86:87], v[88:91]
    s_nop 4
    v_cvt_pk_bf16_f32 v88, v88, v89
    v_cvt_pk_bf16_f32 v89, v90, v91
    ds_pk_add_bf16 v7, v88 offset:65408
    ds_pk_add_bf16 v7, v89 offset:65412
    s_mov_b64 exec, s[50:51]
    s_branch L2_d120
L2_c121:
    s_lshl_b64 s[52:53], s[82:83], 1
    s_andn2_b64 s[52:53], s[52:53], s[80:81]
    s_andn2_b64 s[52:53], s[52:53], s[54:55]
    s_or_b64 s[80:81], s[80:81], s[52:53]
    s_not_b64 vcc, s[52:53]
    s_mov_b64 exec, -1
    v_cndmask_b32_dpp v84, v84, v84, vcc wave_shr:1 row_mask:0xf bank_mask:0xf
    v_cndmask_b32_dpp v85, v85, v85, vcc wave_shr:1 row_mask:0xf bank_mask:0xf
    s_lshr_b64 s[52:53], s[52:53], 1
    v_cndmask_b32_dpp v86, v86, v86, vcc wave_shr:1 row_mask:0xf bank_mask:0xf
    v_cndmask_b32_dpp v87, v87, v87, vcc wave_shr:1 row_mask:0xf bank_mask:0xf
    s_andn2_b64 s[82:83], s[82:83], s[52:53]
    v_cndmask_b32_dpp v7, v7, v7, vcc wave_shr:1 row_mask:0xf bank_mask:0xf
    s_mov_b64 exec, s[54:55]
    s_cbranch_scc0 L2_d121
    s_mov_b64 exec, s[82:83]
    s_nop 1
    v_mfma_f32_4x4x4_16b_bf16 v[88:91], v[12:13], v[84:85], 0
    s_nop 1
    v_mfma_f32_4x4x4_16b_bf16 v[88:91], v[10:11], v[86:87], v[88:91]
    s_nop 4
    v_cvt_pk_bf16_f32 v88, v88, v89
    v_cvt_pk_bf16_f32 v89, v90, v91
    ds_pk_add_bf16 v7, v88 offset:65408
    ds_pk_add_bf16 v7, v89 offset:65412
    s_mov_b64 exec, s[54:55]
    s_branch L2_d121
L2_c122:
    s_lshl_b64 s[52:53], s[82:83], 1
    s_andn2_b64 s[52:53], s[52:53], s[80:81]
    s_andn2_b64 s[52:53], s[52:53], s[50:51]
    s_or_b64 s[80:81], s[80:81], s[52:53]
    s_not_b64 vcc, s[52:53]
    s_mov_b64 exec, -1
    v_cndmask_b32_dpp v84, v84, v84, vcc wave_shr:1 row_mask:0xf bank_mask:0xf
    v_cndmask_b32_dpp v85, v85, v85, vcc wave_shr:1 row_mask:0xf bank_mask:0xf
    s_lshr_b64 s[52:53], s[52:53], 1
    v_cndmask_b32_dpp v86, v86, v86, vcc wave_shr:1 row_mask:0xf bank_mask:0xf
    v_cndmask_b32_dpp v87, v87, v87, vcc wave_shr:1 row_mask:0xf bank_mask:0xf
    s_andn2_b64 s[82:83], s[82:83], s[52:53]
    v_cndmask_b32_dpp v7, v7, v7, vcc wave_shr:1 row_mask:0xf bank_mask:0xf
    s_mov_b64 exec, s[50:51]
    s_cbranch_scc0 L2_d122
    s_mov_b64 exec, s[82:83]
    s_nop 1
    v_mfma_f32_4x4x4_16b_bf16 v[88:91], v[12:13], v[84:85], 0
    s_nop 1
    v_mfma_f32_4x4x4_16b_bf16 v[88:91], v[10:11], v[86:87], v[88:91]
    s_nop 4
    v_cvt_pk_bf16_f32 v88, v88, v89
    v_cvt_pk_bf16_f32 v89, v90, v91
    ds_pk_add_bf16 v7, v88 offset:65408
    ds_pk_add_bf16 v7, v89 offset:65412
    s_mov_b64 exec, s[50:51]
    s_branch L2_d122
L2_c123:
    s_lshl_b64 s[52:53], s[82:83], 1
    s_andn2_b64 s[52:53], s[52:53], s[80:81]
    s_andn2_b64 s[52:53], s[52:53], s[54:55]
    s_or_b64 s[80:81], s[80:81], s[52:53]
    s_not_b64 vcc, s[52:53]
    s_mov_b64 exec, -1
    v_cndmask_b32_dpp v84, v84, v84, vcc wave_shr:1 row_mask:0xf bank_mask:0xf
    v_cndmask_b32_dpp v85, v85, v85, vcc wave_shr:1 row_mask:0xf bank_mask:0xf
    s_lshr_b64 s[52:53], s[52:53], 1
    v_cndmask_b32_dpp v86, v86, v86, vcc wave_shr:1 row_mask:0xf bank_mask:0xf
    v_cndmask_b32_dpp v87, v87, v87, vcc wave_shr:1 row_mask:0xf bank_mask:0xf
    s_andn2_b64 s[82:83], s[82:83], s[52:53]
    v_cndmask_b32_dpp v7, v7, v7, vcc wave_shr:1 row_mask:0xf bank_mask:0xf
    s_mov_b64 exec, s[54:55]
    s_cbranch_scc0 L2_d123
    s_mov_b64 exec, s[82:83]
    s_nop 1
    v_mfma_f32_4x4x4_16b_bf16 v[88:91], v[12:13], v[84:85], 0
    s_nop 1
    v_mfma_f32_4x4x4_16b_bf16 v[88:91], v[10:11], v[86:87], v[88:91]
    s_nop 4
    v_cvt_pk_bf16_f32 v88, v88, v89
    v_cvt_pk_bf16_f32 v89, v90, v91
    ds_pk_add_bf16 v7, v88 offset:65408
    ds_pk_add_bf16 v7, v89 offset:65412
    s_mov_b64 exec, s[54:55]
    s_branch L2_d123
L2_c124:
    s_lshl_b64 s[52:53], s[82:83], 1
    s_andn2_b64 s[52:53], s[52:53], s[80:81]
    s_andn2_b64 s[52:53], s[52:53], s[50:51]
    s_or_b64 s[80:81], s[80:81], s[52:53]
    s_not_b64 vcc, s[52:53]
    s_mov_b64 exec, -1
    v_cndmask_b32_dpp v84, v84, v84, vcc wave_shr:1 row_mask:0xf bank_mask:0xf
    v_cndmask_b32_dpp v85, v85, v85, vcc wave_shr:1 row_mask:0xf bank_mask:0xf
    s_lshr_b64 s[52:53], s[52:53], 1
    v_cndmask_b32_dpp v86, v86, v86, vcc wave_shr:1 row_mask:0xf bank_mask:0xf
    v_cndmask_b32_dpp v87, v87, v87, vcc wave_shr:1 row_mask:0xf bank_mask:0xf
    s_andn2_b64 s[82:83], s[82:83], s[52:53]
    v_cndmask_b32_dpp v7, v7, v7, vcc wave_shr:1 row_mask:0xf bank_mask:0xf
    s_mov_b64 exec, s[50:51]
    s_cbranch_scc0 L2_d124
    s_mov_b64 exec, s[82:83]
    s_nop 1
    v_mfma_f32_4x4x4_16b_bf16 v[88:91], v[12:13], v[84:85], 0
    s_nop 1
    v_mfma_f32_4x4x4_16b_bf16 v[88:91], v[10:11], v[86:87], v[88:91]
    s_nop 4
    v_cvt_pk_bf16_f32 v88, v88, v89
    v_cvt_pk_bf16_f32 v89, v90, v91
    ds_pk_add_bf16 v7, v88 offset:65408
    ds_pk_add_bf16 v7, v89 offset:65412
    s_mov_b64 exec, s[50:51]
    s_branch L2_d124
L2_oa125:
    s_waitcnt vmcnt(3)
    s_mov_b64 exec, s[6:7]
    v_lshrrev_b32 v114, 16, v114
    s_mov_b64 exec, -1
    v_and_b32 v46, 0x10000000, v32
    v_cmpx_eq_u32 vcc, 0, v46
    v_lshrrev_b32 v47, 14, v112
    v_and_b32 v47, v5, v47
    ds_read_b64 v[96:97], v47
    v_perm_b32 v98, v112, v114, s44
    v_bitop3_b32 v99, v112, 0.5, -0.5 bitop3:0xa8
    v_bitop3_b32 v98, v6, v98, v99 bitop3:0xca
    v_and_b32 v47, v5, v112
    s_waitcnt lgkmcnt(0)
    v_mfma_f32_4x4x4_16b_bf16 v[88:91], v[8:9], v[96:97], 0
    s_nop 4
    v_mul_f32 v88, v98, v88
    v_mul_f32 v89, v98, v89
    v_mul_f32 v90, v98, v90
    v_mul_f32 v91, v98, v91
    v_cvt_pk_bf16_f32 v88, v88, v89
    v_cvt_pk_bf16_f32 v89, v90, v91
    ds_pk_add_bf16 v47, v88 offset:65408
    ds_pk_add_bf16 v47, v89 offset:65412
    s_mov_b64 exec, -1
    v_and_b32 v46, 0x20000000, v32
    v_cmpx_eq_u32 vcc, 0, v46
    v_lshrrev_b32 v47, 14, v113
    v_and_b32 v47, v5, v47
    ds_read_b64 v[96:97], v47
    v_perm_b32 v98, v113, v114, s45
    v_bitop3_b32 v99, v113, 0.5, -0.5 bitop3:0xa8
    v_bitop3_b32 v98, v6, v98, v99 bitop3:0xca
    v_and_b32 v47, v5, v113
    s_waitcnt lgkmcnt(0)
    v_mfma_f32_4x4x4_16b_bf16 v[88:91], v[8:9], v[96:97], 0
    s_nop 4
    v_mul_f32 v88, v98, v88
    v_mul_f32 v89, v98, v89
    v_mul_f32 v90, v98, v90
    v_mul_f32 v91, v98, v91
    v_cvt_pk_bf16_f32 v88, v88, v89
    v_cvt_pk_bf16_f32 v89, v90, v91
    ds_pk_add_bf16 v47, v88 offset:65408
    ds_pk_add_bf16 v47, v89 offset:65412
    s_mov_b64 exec, -1
    s_branch L2_ob125
L2_c126:
    s_lshl_b64 s[52:53], s[82:83], 1
    s_andn2_b64 s[52:53], s[52:53], s[80:81]
    s_andn2_b64 s[52:53], s[52:53], s[54:55]
    s_or_b64 s[80:81], s[80:81], s[52:53]
    s_not_b64 vcc, s[52:53]
    s_mov_b64 exec, -1
    v_cndmask_b32_dpp v84, v84, v84, vcc wave_shr:1 row_mask:0xf bank_mask:0xf
    v_cndmask_b32_dpp v85, v85, v85, vcc wave_shr:1 row_mask:0xf bank_mask:0xf
    s_lshr_b64 s[52:53], s[52:53], 1
    v_cndmask_b32_dpp v86, v86, v86, vcc wave_shr:1 row_mask:0xf bank_mask:0xf
    v_cndmask_b32_dpp v87, v87, v87, vcc wave_shr:1 row_mask:0xf bank_mask:0xf
    s_andn2_b64 s[82:83], s[82:83], s[52:53]
    v_cndmask_b32_dpp v7, v7, v7, vcc wave_shr:1 row_mask:0xf bank_mask:0xf
    s_mov_b64 exec, s[54:55]
    s_cbranch_scc0 L2_d126
    s_mov_b64 exec, s[82:83]
    s_nop 1
    v_mfma_f32_4x4x4_16b_bf16 v[88:91], v[12:13], v[84:85], 0
    s_nop 1
    v_mfma_f32_4x4x4_16b_bf16 v[88:91], v[10:11], v[86:87], v[88:91]
    s_nop 4
    v_cvt_pk_bf16_f32 v88, v88, v89
    v_cvt_pk_bf16_f32 v89, v90, v91
    ds_pk_add_bf16 v7, v88 offset:65408
    ds_pk_add_bf16 v7, v89 offset:65412
    s_mov_b64 exec, s[54:55]
    s_branch L2_d126
L2_c127:
    s_lshl_b64 s[52:53], s[82:83], 1
    s_andn2_b64 s[52:53], s[52:53], s[80:81]
    s_andn2_b64 s[52:53], s[52:53], s[50:51]
    s_or_b64 s[80:81], s[80:81], s[52:53]
    s_not_b64 vcc, s[52:53]
    s_mov_b64 exec, -1
    v_cndmask_b32_dpp v84, v84, v84, vcc wave_shr:1 row_mask:0xf bank_mask:0xf
    v_cndmask_b32_dpp v85, v85, v85, vcc wave_shr:1 row_mask:0xf bank_mask:0xf
    s_lshr_b64 s[52:53], s[52:53], 1
    v_cndmask_b32_dpp v86, v86, v86, vcc wave_shr:1 row_mask:0xf bank_mask:0xf
    v_cndmask_b32_dpp v87, v87, v87, vcc wave_shr:1 row_mask:0xf bank_mask:0xf
    s_andn2_b64 s[82:83], s[82:83], s[52:53]
    v_cndmask_b32_dpp v7, v7, v7, vcc wave_shr:1 row_mask:0xf bank_mask:0xf
    s_mov_b64 exec, s[50:51]
    s_cbranch_scc0 L2_d127
    s_mov_b64 exec, s[82:83]
    s_nop 1
    v_mfma_f32_4x4x4_16b_bf16 v[88:91], v[12:13], v[84:85], 0
    s_nop 1
    v_mfma_f32_4x4x4_16b_bf16 v[88:91], v[10:11], v[86:87], v[88:91]
    s_nop 4
    v_cvt_pk_bf16_f32 v88, v88, v89
    v_cvt_pk_bf16_f32 v89, v90, v91
    ds_pk_add_bf16 v7, v88 offset:65408
    ds_pk_add_bf16 v7, v89 offset:65412
    s_mov_b64 exec, s[50:51]
    s_branch L2_d127
L2_c128:
    s_lshl_b64 s[52:53], s[82:83], 1
    s_andn2_b64 s[52:53], s[52:53], s[80:81]
    s_andn2_b64 s[52:53], s[52:53], s[54:55]
    s_or_b64 s[80:81], s[80:81], s[52:53]
    s_not_b64 vcc, s[52:53]
    s_mov_b64 exec, -1
    v_cndmask_b32_dpp v84, v84, v84, vcc wave_shr:1 row_mask:0xf bank_mask:0xf
    v_cndmask_b32_dpp v85, v85, v85, vcc wave_shr:1 row_mask:0xf bank_mask:0xf
    s_lshr_b64 s[52:53], s[52:53], 1
    v_cndmask_b32_dpp v86, v86, v86, vcc wave_shr:1 row_mask:0xf bank_mask:0xf
    v_cndmask_b32_dpp v87, v87, v87, vcc wave_shr:1 row_mask:0xf bank_mask:0xf
    s_andn2_b64 s[82:83], s[82:83], s[52:53]
    v_cndmask_b32_dpp v7, v7, v7, vcc wave_shr:1 row_mask:0xf bank_mask:0xf
    s_mov_b64 exec, s[54:55]
    s_cbranch_scc0 L2_d128
    s_mov_b64 exec, s[82:83]
    s_nop 1
    v_mfma_f32_4x4x4_16b_bf16 v[88:91], v[12:13], v[84:85], 0
    s_nop 1
    v_mfma_f32_4x4x4_16b_bf16 v[88:91], v[10:11], v[86:87], v[88:91]
    s_nop 4
    v_cvt_pk_bf16_f32 v88, v88, v89
    v_cvt_pk_bf16_f32 v89, v90, v91
    ds_pk_add_bf16 v7, v88 offset:65408
    ds_pk_add_bf16 v7, v89 offset:65412
    s_mov_b64 exec, s[54:55]
    s_branch L2_d128
L2_c129:
    s_lshl_b64 s[52:53], s[82:83], 1
    s_andn2_b64 s[52:53], s[52:53], s[80:81]
    s_andn2_b64 s[52:53], s[52:53], s[50:51]
    s_or_b64 s[80:81], s[80:81], s[52:53]
    s_not_b64 vcc, s[52:53]
    s_mov_b64 exec, -1
    v_cndmask_b32_dpp v84, v84, v84, vcc wave_shr:1 row_mask:0xf bank_mask:0xf
    v_cndmask_b32_dpp v85, v85, v85, vcc wave_shr:1 row_mask:0xf bank_mask:0xf
    s_lshr_b64 s[52:53], s[52:53], 1
    v_cndmask_b32_dpp v86, v86, v86, vcc wave_shr:1 row_mask:0xf bank_mask:0xf
    v_cndmask_b32_dpp v87, v87, v87, vcc wave_shr:1 row_mask:0xf bank_mask:0xf
    s_andn2_b64 s[82:83], s[82:83], s[52:53]
    v_cndmask_b32_dpp v7, v7, v7, vcc wave_shr:1 row_mask:0xf bank_mask:0xf
    s_mov_b64 exec, s[50:51]
    s_cbranch_scc0 L2_d129
    s_mov_b64 exec, s[82:83]
    s_nop 1
    v_mfma_f32_4x4x4_16b_bf16 v[88:91], v[12:13], v[84:85], 0
    s_nop 1
    v_mfma_f32_4x4x4_16b_bf16 v[88:91], v[10:11], v[86:87], v[88:91]
    s_nop 4
    v_cvt_pk_bf16_f32 v88, v88, v89
    v_cvt_pk_bf16_f32 v89, v90, v91
    ds_pk_add_bf16 v7, v88 offset:65408
    ds_pk_add_bf16 v7, v89 offset:65412
    s_mov_b64 exec, s[50:51]
    s_branch L2_d129
L2_c130:
    s_lshl_b64 s[52:53], s[82:83], 1
    s_andn2_b64 s[52:53], s[52:53], s[80:81]
    s_andn2_b64 s[52:53], s[52:53], s[54:55]
    s_or_b64 s[80:81], s[80:81], s[52:53]
    s_not_b64 vcc, s[52:53]
    s_mov_b64 exec, -1
    v_cndmask_b32_dpp v84, v84, v84, vcc wave_shr:1 row_mask:0xf bank_mask:0xf
    v_cndmask_b32_dpp v85, v85, v85, vcc wave_shr:1 row_mask:0xf bank_mask:0xf
    s_lshr_b64 s[52:53], s[52:53], 1
    v_cndmask_b32_dpp v86, v86, v86, vcc wave_shr:1 row_mask:0xf bank_mask:0xf
    v_cndmask_b32_dpp v87, v87, v87, vcc wave_shr:1 row_mask:0xf bank_mask:0xf
    s_andn2_b64 s[82:83], s[82:83], s[52:53]
    v_cndmask_b32_dpp v7, v7, v7, vcc wave_shr:1 row_mask:0xf bank_mask:0xf
    s_mov_b64 exec, s[54:55]
    s_cbranch_scc0 L2_d130
    s_mov_b64 exec, s[82:83]
    s_nop 1
    v_mfma_f32_4x4x4_16b_bf16 v[88:91], v[12:13], v[84:85], 0
    s_nop 1
    v_mfma_f32_4x4x4_16b_bf16 v[88:91], v[10:11], v[86:87], v[88:91]
    s_nop 4
    v_cvt_pk_bf16_f32 v88, v88, v89
    v_cvt_pk_bf16_f32 v89, v90, v91
    ds_pk_add_bf16 v7, v88 offset:65408
    ds_pk_add_bf16 v7, v89 offset:65412
    s_mov_b64 exec, s[54:55]
    s_branch L2_d130
L2_c131:
    s_lshl_b64 s[52:53], s[82:83], 1
    s_andn2_b64 s[52:53], s[52:53], s[80:81]
    s_andn2_b64 s[52:53], s[52:53], s[50:51]
    s_or_b64 s[80:81], s[80:81], s[52:53]
    s_not_b64 vcc, s[52:53]
    s_mov_b64 exec, -1
    v_cndmask_b32_dpp v84, v84, v84, vcc wave_shr:1 row_mask:0xf bank_mask:0xf
    v_cndmask_b32_dpp v85, v85, v85, vcc wave_shr:1 row_mask:0xf bank_mask:0xf
    s_lshr_b64 s[52:53], s[52:53], 1
    v_cndmask_b32_dpp v86, v86, v86, vcc wave_shr:1 row_mask:0xf bank_mask:0xf
    v_cndmask_b32_dpp v87, v87, v87, vcc wave_shr:1 row_mask:0xf bank_mask:0xf
    s_andn2_b64 s[82:83], s[82:83], s[52:53]
    v_cndmask_b32_dpp v7, v7, v7, vcc wave_shr:1 row_mask:0xf bank_mask:0xf
    s_mov_b64 exec, s[50:51]
    s_cbranch_scc0 L2_d131
    s_mov_b64 exec, s[82:83]
    s_nop 1
    v_mfma_f32_4x4x4_16b_bf16 v[88:91], v[12:13], v[84:85], 0
    s_nop 1
    v_mfma_f32_4x4x4_16b_bf16 v[88:91], v[10:11], v[86:87], v[88:91]
    s_nop 4
    v_cvt_pk_bf16_f32 v88, v88, v89
    v_cvt_pk_bf16_f32 v89, v90, v91
    ds_pk_add_bf16 v7, v88 offset:65408
    ds_pk_add_bf16 v7, v89 offset:65412
    s_mov_b64 exec, s[50:51]
    s_branch L2_d131
L2_c132:
    s_lshl_b64 s[52:53], s[82:83], 1
    s_andn2_b64 s[52:53], s[52:53], s[80:81]
    s_andn2_b64 s[52:53], s[52:53], s[54:55]
    s_or_b64 s[80:81], s[80:81], s[52:53]
    s_not_b64 vcc, s[52:53]
    s_mov_b64 exec, -1
    v_cndmask_b32_dpp v84, v84, v84, vcc wave_shr:1 row_mask:0xf bank_mask:0xf
    v_cndmask_b32_dpp v85, v85, v85, vcc wave_shr:1 row_mask:0xf bank_mask:0xf
    s_lshr_b64 s[52:53], s[52:53], 1
    v_cndmask_b32_dpp v86, v86, v86, vcc wave_shr:1 row_mask:0xf bank_mask:0xf
    v_cndmask_b32_dpp v87, v87, v87, vcc wave_shr:1 row_mask:0xf bank_mask:0xf
    s_andn2_b64 s[82:83], s[82:83], s[52:53]
    v_cndmask_b32_dpp v7, v7, v7, vcc wave_shr:1 row_mask:0xf bank_mask:0xf
    s_mov_b64 exec, s[54:55]
    s_cbranch_scc0 L2_d132
    s_mov_b64 exec, s[82:83]
    s_nop 1
    v_mfma_f32_4x4x4_16b_bf16 v[88:91], v[12:13], v[84:85], 0
    s_nop 1
    v_mfma_f32_4x4x4_16b_bf16 v[88:91], v[10:11], v[86:87], v[88:91]
    s_nop 4
    v_cvt_pk_bf16_f32 v88, v88, v89
    v_cvt_pk_bf16_f32 v89, v90, v91
    ds_pk_add_bf16 v7, v88 offset:65408
    ds_pk_add_bf16 v7, v89 offset:65412
    s_mov_b64 exec, s[54:55]
    s_branch L2_d132
L2_c133:
    s_lshl_b64 s[52:53], s[82:83], 1
    s_andn2_b64 s[52:53], s[52:53], s[80:81]
    s_andn2_b64 s[52:53], s[52:53], s[50:51]
    s_or_b64 s[80:81], s[80:81], s[52:53]
    s_not_b64 vcc, s[52:53]
    s_mov_b64 exec, -1
    v_cndmask_b32_dpp v84, v84, v84, vcc wave_shr:1 row_mask:0xf bank_mask:0xf
    v_cndmask_b32_dpp v85, v85, v85, vcc wave_shr:1 row_mask:0xf bank_mask:0xf
    s_lshr_b64 s[52:53], s[52:53], 1
    v_cndmask_b32_dpp v86, v86, v86, vcc wave_shr:1 row_mask:0xf bank_mask:0xf
    v_cndmask_b32_dpp v87, v87, v87, vcc wave_shr:1 row_mask:0xf bank_mask:0xf
    s_andn2_b64 s[82:83], s[82:83], s[52:53]
    v_cndmask_b32_dpp v7, v7, v7, vcc wave_shr:1 row_mask:0xf bank_mask:0xf
    s_mov_b64 exec, s[50:51]
    s_cbranch_scc0 L2_d133
    s_mov_b64 exec, s[82:83]
    s_nop 1
    v_mfma_f32_4x4x4_16b_bf16 v[88:91], v[12:13], v[84:85], 0
    s_nop 1
    v_mfma_f32_4x4x4_16b_bf16 v[88:91], v[10:11], v[86:87], v[88:91]
    s_nop 4
    v_cvt_pk_bf16_f32 v88, v88, v89
    v_cvt_pk_bf16_f32 v89, v90, v91
    ds_pk_add_bf16 v7, v88 offset:65408
    ds_pk_add_bf16 v7, v89 offset:65412
    s_mov_b64 exec, s[50:51]
    s_branch L2_d133
L2_oa134:
    v_and_b32 v47, 0x0fffffff, v33
    buffer_load_dword v114, v47, s[8:11], 0 offen offset:16
    s_mov_b64 exec, s[6:7]
    v_add_u32 v47, 8, v47
    v_lshrrev_b32 v33, 2, v33
    s_mov_b64 exec, -1
    buffer_load_dwordx2 v[112:113], v47, s[8:11], 0 offen
    s_branch L2_ob134
L2_c135:
    s_lshl_b64 s[52:53], s[82:83], 1
    s_andn2_b64 s[52:53], s[52:53], s[80:81]
    s_andn2_b64 s[52:53], s[52:53], s[54:55]
    s_or_b64 s[80:81], s[80:81], s[52:53]
    s_not_b64 vcc, s[52:53]
    s_mov_b64 exec, -1
    v_cndmask_b32_dpp v84, v84, v84, vcc wave_shr:1 row_mask:0xf bank_mask:0xf
    v_cndmask_b32_dpp v85, v85, v85, vcc wave_shr:1 row_mask:0xf bank_mask:0xf
    s_lshr_b64 s[52:53], s[52:53], 1
    v_cndmask_b32_dpp v86, v86, v86, vcc wave_shr:1 row_mask:0xf bank_mask:0xf
    v_cndmask_b32_dpp v87, v87, v87, vcc wave_shr:1 row_mask:0xf bank_mask:0xf
    s_andn2_b64 s[82:83], s[82:83], s[52:53]
    v_cndmask_b32_dpp v7, v7, v7, vcc wave_shr:1 row_mask:0xf bank_mask:0xf
    s_mov_b64 exec, s[54:55]
    s_cbranch_scc0 L2_d135
    s_mov_b64 exec, s[82:83]
    s_nop 1
    v_mfma_f32_4x4x4_16b_bf16 v[88:91], v[12:13], v[84:85], 0
    s_nop 1
    v_mfma_f32_4x4x4_16b_bf16 v[88:91], v[10:11], v[86:87], v[88:91]
    s_nop 4
    v_cvt_pk_bf16_f32 v88, v88, v89
    v_cvt_pk_bf16_f32 v89, v90, v91
    ds_pk_add_bf16 v7, v88 offset:65408
    ds_pk_add_bf16 v7, v89 offset:65412
    s_mov_b64 exec, s[54:55]
    s_branch L2_d135
L2_c136:
    s_lshl_b64 s[52:53], s[82:83], 1
    s_andn2_b64 s[52:53], s[52:53], s[80:81]
    s_andn2_b64 s[52:53], s[52:53], s[50:51]
    s_or_b64 s[80:81], s[80:81], s[52:53]
    s_not_b64 vcc, s[52:53]
    s_mov_b64 exec, -1
    v_cndmask_b32_dpp v84, v84, v84, vcc wave_shr:1 row_mask:0xf bank_mask:0xf
    v_cndmask_b32_dpp v85, v85, v85, vcc wave_shr:1 row_mask:0xf bank_mask:0xf
    s_lshr_b64 s[52:53], s[52:53], 1
    v_cndmask_b32_dpp v86, v86, v86, vcc wave_shr:1 row_mask:0xf bank_mask:0xf
    v_cndmask_b32_dpp v87, v87, v87, vcc wave_shr:1 row_mask:0xf bank_mask:0xf
    s_andn2_b64 s[82:83], s[82:83], s[52:53]
    v_cndmask_b32_dpp v7, v7, v7, vcc wave_shr:1 row_mask:0xf bank_mask:0xf
    s_mov_b64 exec, s[50:51]
    s_cbranch_scc0 L2_d136
    s_mov_b64 exec, s[82:83]
    s_nop 1
    v_mfma_f32_4x4x4_16b_bf16 v[88:91], v[12:13], v[84:85], 0
    s_nop 1
    v_mfma_f32_4x4x4_16b_bf16 v[88:91], v[10:11], v[86:87], v[88:91]
    s_nop 4
    v_cvt_pk_bf16_f32 v88, v88, v89
    v_cvt_pk_bf16_f32 v89, v90, v91
    ds_pk_add_bf16 v7, v88 offset:65408
    ds_pk_add_bf16 v7, v89 offset:65412
    s_mov_b64 exec, s[50:51]
    s_branch L2_d136
L2_c137:
    s_lshl_b64 s[52:53], s[82:83], 1
    s_andn2_b64 s[52:53], s[52:53], s[80:81]
    s_andn2_b64 s[52:53], s[52:53], s[54:55]
    s_or_b64 s[80:81], s[80:81], s[52:53]
    s_not_b64 vcc, s[52:53]
    s_mov_b64 exec, -1
    v_cndmask_b32_dpp v84, v84, v84, vcc wave_shr:1 row_mask:0xf bank_mask:0xf
    v_cndmask_b32_dpp v85, v85, v85, vcc wave_shr:1 row_mask:0xf bank_mask:0xf
    s_lshr_b64 s[52:53], s[52:53], 1
    v_cndmask_b32_dpp v86, v86, v86, vcc wave_shr:1 row_mask:0xf bank_mask:0xf
    v_cndmask_b32_dpp v87, v87, v87, vcc wave_shr:1 row_mask:0xf bank_mask:0xf
    s_andn2_b64 s[82:83], s[82:83], s[52:53]
    v_cndmask_b32_dpp v7, v7, v7, vcc wave_shr:1 row_mask:0xf bank_mask:0xf
    s_mov_b64 exec, s[54:55]
    s_cbranch_scc0 L2_d137
    s_mov_b64 exec, s[82:83]
    s_nop 1
    v_mfma_f32_4x4x4_16b_bf16 v[88:91], v[12:13], v[84:85], 0
    s_nop 1
    v_mfma_f32_4x4x4_16b_bf16 v[88:91], v[10:11], v[86:87], v[88:91]
    s_nop 4
    v_cvt_pk_bf16_f32 v88, v88, v89
    v_cvt_pk_bf16_f32 v89, v90, v91
    ds_pk_add_bf16 v7, v88 offset:65408
    ds_pk_add_bf16 v7, v89 offset:65412
    s_mov_b64 exec, s[54:55]
    s_branch L2_d137
L2_c138:
    s_lshl_b64 s[52:53], s[82:83], 1
    s_andn2_b64 s[52:53], s[52:53], s[80:81]
    s_andn2_b64 s[52:53], s[52:53], s[50:51]
    s_or_b64 s[80:81], s[80:81], s[52:53]
    s_not_b64 vcc, s[52:53]
    s_mov_b64 exec, -1
    v_cndmask_b32_dpp v84, v84, v84, vcc wave_shr:1 row_mask:0xf bank_mask:0xf
    v_cndmask_b32_dpp v85, v85, v85, vcc wave_shr:1 row_mask:0xf bank_mask:0xf
    s_lshr_b64 s[52:53], s[52:53], 1
    v_cndmask_b32_dpp v86, v86, v86, vcc wave_shr:1 row_mask:0xf bank_mask:0xf
    v_cndmask_b32_dpp v87, v87, v87, vcc wave_shr:1 row_mask:0xf bank_mask:0xf
    s_andn2_b64 s[82:83], s[82:83], s[52:53]
    v_cndmask_b32_dpp v7, v7, v7, vcc wave_shr:1 row_mask:0xf bank_mask:0xf
    s_mov_b64 exec, s[50:51]
    s_cbranch_scc0 L2_d138
    s_mov_b64 exec, s[82:83]
    s_nop 1
    v_mfma_f32_4x4x4_16b_bf16 v[88:91], v[12:13], v[84:85], 0
    s_nop 1
    v_mfma_f32_4x4x4_16b_bf16 v[88:91], v[10:11], v[86:87], v[88:91]
    s_nop 4
    v_cvt_pk_bf16_f32 v88, v88, v89
    v_cvt_pk_bf16_f32 v89, v90, v91
    ds_pk_add_bf16 v7, v88 offset:65408
    ds_pk_add_bf16 v7, v89 offset:65412
    s_mov_b64 exec, s[50:51]
    s_branch L2_d138
L2_c139:
    s_lshl_b64 s[52:53], s[82:83], 1
    s_andn2_b64 s[52:53], s[52:53], s[80:81]
    s_andn2_b64 s[52:53], s[52:53], s[54:55]
    s_or_b64 s[80:81], s[80:81], s[52:53]
    s_not_b64 vcc, s[52:53]
    s_mov_b64 exec, -1
    v_cndmask_b32_dpp v84, v84, v84, vcc wave_shr:1 row_mask:0xf bank_mask:0xf
    v_cndmask_b32_dpp v85, v85, v85, vcc wave_shr:1 row_mask:0xf bank_mask:0xf
    s_lshr_b64 s[52:53], s[52:53], 1
    v_cndmask_b32_dpp v86, v86, v86, vcc wave_shr:1 row_mask:0xf bank_mask:0xf
    v_cndmask_b32_dpp v87, v87, v87, vcc wave_shr:1 row_mask:0xf bank_mask:0xf
    s_andn2_b64 s[82:83], s[82:83], s[52:53]
    v_cndmask_b32_dpp v7, v7, v7, vcc wave_shr:1 row_mask:0xf bank_mask:0xf
    s_mov_b64 exec, s[54:55]
    s_cbranch_scc0 L2_d139
    s_mov_b64 exec, s[82:83]
    s_nop 1
    v_mfma_f32_4x4x4_16b_bf16 v[88:91], v[12:13], v[84:85], 0
    s_nop 1
    v_mfma_f32_4x4x4_16b_bf16 v[88:91], v[10:11], v[86:87], v[88:91]
    s_nop 4
    v_cvt_pk_bf16_f32 v88, v88, v89
    v_cvt_pk_bf16_f32 v89, v90, v91
    ds_pk_add_bf16 v7, v88 offset:65408
    ds_pk_add_bf16 v7, v89 offset:65412
    s_mov_b64 exec, s[54:55]
    s_branch L2_d139
L2_c140:
    s_lshl_b64 s[52:53], s[82:83], 1
    s_andn2_b64 s[52:53], s[52:53], s[80:81]
    s_andn2_b64 s[52:53], s[52:53], s[50:51]
    s_or_b64 s[80:81], s[80:81], s[52:53]
    s_not_b64 vcc, s[52:53]
    s_mov_b64 exec, -1
    v_cndmask_b32_dpp v84, v84, v84, vcc wave_shr:1 row_mask:0xf bank_mask:0xf
    v_cndmask_b32_dpp v85, v85, v85, vcc wave_shr:1 row_mask:0xf bank_mask:0xf
    s_lshr_b64 s[52:53], s[52:53], 1
    v_cndmask_b32_dpp v86, v86, v86, vcc wave_shr:1 row_mask:0xf bank_mask:0xf
    v_cndmask_b32_dpp v87, v87, v87, vcc wave_shr:1 row_mask:0xf bank_mask:0xf
    s_andn2_b64 s[82:83], s[82:83], s[52:53]
    v_cndmask_b32_dpp v7, v7, v7, vcc wave_shr:1 row_mask:0xf bank_mask:0xf
    s_mov_b64 exec, s[50:51]
    s_cbranch_scc0 L2_d140
    s_mov_b64 exec, s[82:83]
    s_nop 1
    v_mfma_f32_4x4x4_16b_bf16 v[88:91], v[12:13], v[84:85], 0
    s_nop 1
    v_mfma_f32_4x4x4_16b_bf16 v[88:91], v[10:11], v[86:87], v[88:91]
    s_nop 4
    v_cvt_pk_bf16_f32 v88, v88, v89
    v_cvt_pk_bf16_f32 v89, v90, v91
    ds_pk_add_bf16 v7, v88 offset:65408
    ds_pk_add_bf16 v7, v89 offset:65412
    s_mov_b64 exec, s[50:51]
    s_branch L2_d140
L2_oa141:
    s_waitcnt vmcnt(0)
    s_mov_b64 exec, s[6:7]
    v_lshrrev_b32 v114, 16, v114
    s_mov_b64 exec, -1
    v_and_b32 v46, 0x10000000, v33
    v_cmpx_eq_u32 vcc, 0, v46
    v_lshrrev_b32 v47, 14, v112
    v_and_b32 v47, v5, v47
    ds_read_b64 v[96:97], v47
    v_perm_b32 v98, v112, v114, s44
    v_bitop3_b32 v99, v112, 0.5, -0.5 bitop3:0xa8
    v_bitop3_b32 v98, v6, v98, v99 bitop3:0xca
    v_and_b32 v47, v5, v112
    s_waitcnt lgkmcnt(0)
    v_mfma_f32_4x4x4_16b_bf16 v[88:91], v[8:9], v[96:97], 0
    s_nop 4
    v_mul_f32 v88, v98, v88
    v_mul_f32 v89, v98, v89
    v_mul_f32 v90, v98, v90
    v_mul_f32 v91, v98, v91
    v_cvt_pk_bf16_f32 v88, v88, v89
    v_cvt_pk_bf16_f32 v89, v90, v91
    ds_pk_add_bf16 v47, v88 offset:65408
    ds_pk_add_bf16 v47, v89 offset:65412
    s_mov_b64 exec, -1
    v_and_b32 v46, 0x20000000, v33
    v_cmpx_eq_u32 vcc, 0, v46
    v_lshrrev_b32 v47, 14, v113
    v_and_b32 v47, v5, v47
    ds_read_b64 v[96:97], v47
    v_perm_b32 v98, v113, v114, s45
    v_bitop3_b32 v99, v113, 0.5, -0.5 bitop3:0xa8
    v_bitop3_b32 v98, v6, v98, v99 bitop3:0xca
    v_and_b32 v47, v5, v113
    s_waitcnt lgkmcnt(0)
    v_mfma_f32_4x4x4_16b_bf16 v[88:91], v[8:9], v[96:97], 0
    s_nop 4
    v_mul_f32 v88, v98, v88
    v_mul_f32 v89, v98, v89
    v_mul_f32 v90, v98, v90
    v_mul_f32 v91, v98, v91
    v_cvt_pk_bf16_f32 v88, v88, v89
    v_cvt_pk_bf16_f32 v89, v90, v91
    ds_pk_add_bf16 v47, v88 offset:65408
    ds_pk_add_bf16 v47, v89 offset:65412
    s_mov_b64 exec, -1
    s_branch L2_ob141
L2_c142:
    s_lshl_b64 s[52:53], s[82:83], 1
    s_andn2_b64 s[52:53], s[52:53], s[80:81]
    s_andn2_b64 s[52:53], s[52:53], s[54:55]
    s_or_b64 s[80:81], s[80:81], s[52:53]
    s_not_b64 vcc, s[52:53]
    s_mov_b64 exec, -1
    v_cndmask_b32_dpp v84, v84, v84, vcc wave_shr:1 row_mask:0xf bank_mask:0xf
    v_cndmask_b32_dpp v85, v85, v85, vcc wave_shr:1 row_mask:0xf bank_mask:0xf
    s_lshr_b64 s[52:53], s[52:53], 1
    v_cndmask_b32_dpp v86, v86, v86, vcc wave_shr:1 row_mask:0xf bank_mask:0xf
    v_cndmask_b32_dpp v87, v87, v87, vcc wave_shr:1 row_mask:0xf bank_mask:0xf
    s_andn2_b64 s[82:83], s[82:83], s[52:53]
    v_cndmask_b32_dpp v7, v7, v7, vcc wave_shr:1 row_mask:0xf bank_mask:0xf
    s_mov_b64 exec, s[54:55]
    s_cbranch_scc0 L2_d142
    s_mov_b64 exec, s[82:83]
    s_nop 1
    v_mfma_f32_4x4x4_16b_bf16 v[88:91], v[12:13], v[84:85], 0
    s_nop 1
    v_mfma_f32_4x4x4_16b_bf16 v[88:91], v[10:11], v[86:87], v[88:91]
    s_nop 4
    v_cvt_pk_bf16_f32 v88, v88, v89
    v_cvt_pk_bf16_f32 v89, v90, v91
    ds_pk_add_bf16 v7, v88 offset:65408
    ds_pk_add_bf16 v7, v89 offset:65412
    s_mov_b64 exec, s[54:55]
    s_branch L2_d142
L2_c143:
    s_lshl_b64 s[52:53], s[82:83], 1
    s_andn2_b64 s[52:53], s[52:53], s[80:81]
    s_andn2_b64 s[52:53], s[52:53], s[50:51]
    s_or_b64 s[80:81], s[80:81], s[52:53]
    s_not_b64 vcc, s[52:53]
    s_mov_b64 exec, -1
    v_cndmask_b32_dpp v84, v84, v84, vcc wave_shr:1 row_mask:0xf bank_mask:0xf
    v_cndmask_b32_dpp v85, v85, v85, vcc wave_shr:1 row_mask:0xf bank_mask:0xf
    s_lshr_b64 s[52:53], s[52:53], 1
    v_cndmask_b32_dpp v86, v86, v86, vcc wave_shr:1 row_mask:0xf bank_mask:0xf
    v_cndmask_b32_dpp v87, v87, v87, vcc wave_shr:1 row_mask:0xf bank_mask:0xf
    s_andn2_b64 s[82:83], s[82:83], s[52:53]
    v_cndmask_b32_dpp v7, v7, v7, vcc wave_shr:1 row_mask:0xf bank_mask:0xf
    s_mov_b64 exec, s[50:51]
    s_cbranch_scc0 L2_d143
    s_mov_b64 exec, s[82:83]
    s_nop 1
    v_mfma_f32_4x4x4_16b_bf16 v[88:91], v[12:13], v[84:85], 0
    s_nop 1
    v_mfma_f32_4x4x4_16b_bf16 v[88:91], v[10:11], v[86:87], v[88:91]
    s_nop 4
    v_cvt_pk_bf16_f32 v88, v88, v89
    v_cvt_pk_bf16_f32 v89, v90, v91
    ds_pk_add_bf16 v7, v88 offset:65408
    ds_pk_add_bf16 v7, v89 offset:65412
    s_mov_b64 exec, s[50:51]
    s_branch L2_d143
L2_c144:
    s_lshl_b64 s[52:53], s[82:83], 1
    s_andn2_b64 s[52:53], s[52:53], s[80:81]
    s_andn2_b64 s[52:53], s[52:53], s[54:55]
    s_or_b64 s[80:81], s[80:81], s[52:53]
    s_not_b64 vcc, s[52:53]
    s_mov_b64 exec, -1
    v_cndmask_b32_dpp v84, v84, v84, vcc wave_shr:1 row_mask:0xf bank_mask:0xf
    v_cndmask_b32_dpp v85, v85, v85, vcc wave_shr:1 row_mask:0xf bank_mask:0xf
    s_lshr_b64 s[52:53], s[52:53], 1
    v_cndmask_b32_dpp v86, v86, v86, vcc wave_shr:1 row_mask:0xf bank_mask:0xf
    v_cndmask_b32_dpp v87, v87, v87, vcc wave_shr:1 row_mask:0xf bank_mask:0xf
    s_andn2_b64 s[82:83], s[82:83], s[52:53]
    v_cndmask_b32_dpp v7, v7, v7, vcc wave_shr:1 row_mask:0xf bank_mask:0xf
    s_mov_b64 exec, s[54:55]
    s_cbranch_scc0 L2_d144
    s_mov_b64 exec, s[82:83]
    s_nop 1
    v_mfma_f32_4x4x4_16b_bf16 v[88:91], v[12:13], v[84:85], 0
    s_nop 1
    v_mfma_f32_4x4x4_16b_bf16 v[88:91], v[10:11], v[86:87], v[88:91]
    s_nop 4
    v_cvt_pk_bf16_f32 v88, v88, v89
    v_cvt_pk_bf16_f32 v89, v90, v91
    ds_pk_add_bf16 v7, v88 offset:65408
    ds_pk_add_bf16 v7, v89 offset:65412
    s_mov_b64 exec, s[54:55]
    s_branch L2_d144
L2_c145:
    s_lshl_b64 s[52:53], s[82:83], 1
    s_andn2_b64 s[52:53], s[52:53], s[80:81]
    s_andn2_b64 s[52:53], s[52:53], s[50:51]
    s_or_b64 s[80:81], s[80:81], s[52:53]
    s_not_b64 vcc, s[52:53]
    s_mov_b64 exec, -1
    v_cndmask_b32_dpp v84, v84, v84, vcc wave_shr:1 row_mask:0xf bank_mask:0xf
    v_cndmask_b32_dpp v85, v85, v85, vcc wave_shr:1 row_mask:0xf bank_mask:0xf
    s_lshr_b64 s[52:53], s[52:53], 1
    v_cndmask_b32_dpp v86, v86, v86, vcc wave_shr:1 row_mask:0xf bank_mask:0xf
    v_cndmask_b32_dpp v87, v87, v87, vcc wave_shr:1 row_mask:0xf bank_mask:0xf
    s_andn2_b64 s[82:83], s[82:83], s[52:53]
    v_cndmask_b32_dpp v7, v7, v7, vcc wave_shr:1 row_mask:0xf bank_mask:0xf
    s_mov_b64 exec, s[50:51]
    s_cbranch_scc0 L2_d145
    s_mov_b64 exec, s[82:83]
    s_nop 1
    v_mfma_f32_4x4x4_16b_bf16 v[88:91], v[12:13], v[84:85], 0
    s_nop 1
    v_mfma_f32_4x4x4_16b_bf16 v[88:91], v[10:11], v[86:87], v[88:91]
    s_nop 4
    v_cvt_pk_bf16_f32 v88, v88, v89
    v_cvt_pk_bf16_f32 v89, v90, v91
    ds_pk_add_bf16 v7, v88 offset:65408
    ds_pk_add_bf16 v7, v89 offset:65412
    s_mov_b64 exec, s[50:51]
    s_branch L2_d145
L2_c146:
    s_lshl_b64 s[52:53], s[82:83], 1
    s_andn2_b64 s[52:53], s[52:53], s[80:81]
    s_andn2_b64 s[52:53], s[52:53], s[54:55]
    s_or_b64 s[80:81], s[80:81], s[52:53]
    s_not_b64 vcc, s[52:53]
    s_mov_b64 exec, -1
    v_cndmask_b32_dpp v84, v84, v84, vcc wave_shr:1 row_mask:0xf bank_mask:0xf
    v_cndmask_b32_dpp v85, v85, v85, vcc wave_shr:1 row_mask:0xf bank_mask:0xf
    s_lshr_b64 s[52:53], s[52:53], 1
    v_cndmask_b32_dpp v86, v86, v86, vcc wave_shr:1 row_mask:0xf bank_mask:0xf
    v_cndmask_b32_dpp v87, v87, v87, vcc wave_shr:1 row_mask:0xf bank_mask:0xf
    s_andn2_b64 s[82:83], s[82:83], s[52:53]
    v_cndmask_b32_dpp v7, v7, v7, vcc wave_shr:1 row_mask:0xf bank_mask:0xf
    s_mov_b64 exec, s[54:55]
    s_cbranch_scc0 L2_d146
    s_mov_b64 exec, s[82:83]
    s_nop 1
    v_mfma_f32_4x4x4_16b_bf16 v[88:91], v[12:13], v[84:85], 0
    s_nop 1
    v_mfma_f32_4x4x4_16b_bf16 v[88:91], v[10:11], v[86:87], v[88:91]
    s_nop 4
    v_cvt_pk_bf16_f32 v88, v88, v89
    v_cvt_pk_bf16_f32 v89, v90, v91
    ds_pk_add_bf16 v7, v88 offset:65408
    ds_pk_add_bf16 v7, v89 offset:65412
    s_mov_b64 exec, s[54:55]
    s_branch L2_d146
L2_c147:
    s_lshl_b64 s[52:53], s[82:83], 1
    s_andn2_b64 s[52:53], s[52:53], s[80:81]
    s_andn2_b64 s[52:53], s[52:53], s[50:51]
    s_or_b64 s[80:81], s[80:81], s[52:53]
    s_not_b64 vcc, s[52:53]
    s_mov_b64 exec, -1
    v_cndmask_b32_dpp v84, v84, v84, vcc wave_shr:1 row_mask:0xf bank_mask:0xf
    v_cndmask_b32_dpp v85, v85, v85, vcc wave_shr:1 row_mask:0xf bank_mask:0xf
    s_lshr_b64 s[52:53], s[52:53], 1
    v_cndmask_b32_dpp v86, v86, v86, vcc wave_shr:1 row_mask:0xf bank_mask:0xf
    v_cndmask_b32_dpp v87, v87, v87, vcc wave_shr:1 row_mask:0xf bank_mask:0xf
    s_andn2_b64 s[82:83], s[82:83], s[52:53]
    v_cndmask_b32_dpp v7, v7, v7, vcc wave_shr:1 row_mask:0xf bank_mask:0xf
    s_mov_b64 exec, s[50:51]
    s_cbranch_scc0 L2_d147
    s_mov_b64 exec, s[82:83]
    s_nop 1
    v_mfma_f32_4x4x4_16b_bf16 v[88:91], v[12:13], v[84:85], 0
    s_nop 1
    v_mfma_f32_4x4x4_16b_bf16 v[88:91], v[10:11], v[86:87], v[88:91]
    s_nop 4
    v_cvt_pk_bf16_f32 v88, v88, v89
    v_cvt_pk_bf16_f32 v89, v90, v91
    ds_pk_add_bf16 v7, v88 offset:65408
    ds_pk_add_bf16 v7, v89 offset:65412
    s_mov_b64 exec, s[50:51]
    s_branch L2_d147
L2_c148:
    s_lshl_b64 s[52:53], s[82:83], 1
    s_andn2_b64 s[52:53], s[52:53], s[80:81]
    s_andn2_b64 s[52:53], s[52:53], s[54:55]
    s_or_b64 s[80:81], s[80:81], s[52:53]
    s_not_b64 vcc, s[52:53]
    s_mov_b64 exec, -1
    v_cndmask_b32_dpp v84, v84, v84, vcc wave_shr:1 row_mask:0xf bank_mask:0xf
    v_cndmask_b32_dpp v85, v85, v85, vcc wave_shr:1 row_mask:0xf bank_mask:0xf
    s_lshr_b64 s[52:53], s[52:53], 1
    v_cndmask_b32_dpp v86, v86, v86, vcc wave_shr:1 row_mask:0xf bank_mask:0xf
    v_cndmask_b32_dpp v87, v87, v87, vcc wave_shr:1 row_mask:0xf bank_mask:0xf
    s_andn2_b64 s[82:83], s[82:83], s[52:53]
    v_cndmask_b32_dpp v7, v7, v7, vcc wave_shr:1 row_mask:0xf bank_mask:0xf
    s_mov_b64 exec, s[54:55]
    s_cbranch_scc0 L2_d148
    s_mov_b64 exec, s[82:83]
    s_nop 1
    v_mfma_f32_4x4x4_16b_bf16 v[88:91], v[12:13], v[84:85], 0
    s_nop 1
    v_mfma_f32_4x4x4_16b_bf16 v[88:91], v[10:11], v[86:87], v[88:91]
    s_nop 4
    v_cvt_pk_bf16_f32 v88, v88, v89
    v_cvt_pk_bf16_f32 v89, v90, v91
    ds_pk_add_bf16 v7, v88 offset:65408
    ds_pk_add_bf16 v7, v89 offset:65412
    s_mov_b64 exec, s[54:55]
    s_branch L2_d148
L2_c149:
    s_lshl_b64 s[52:53], s[82:83], 1
    s_andn2_b64 s[52:53], s[52:53], s[80:81]
    s_andn2_b64 s[52:53], s[52:53], s[50:51]
    s_or_b64 s[80:81], s[80:81], s[52:53]
    s_not_b64 vcc, s[52:53]
    s_mov_b64 exec, -1
    v_cndmask_b32_dpp v84, v84, v84, vcc wave_shr:1 row_mask:0xf bank_mask:0xf
    v_cndmask_b32_dpp v85, v85, v85, vcc wave_shr:1 row_mask:0xf bank_mask:0xf
    s_lshr_b64 s[52:53], s[52:53], 1
    v_cndmask_b32_dpp v86, v86, v86, vcc wave_shr:1 row_mask:0xf bank_mask:0xf
    v_cndmask_b32_dpp v87, v87, v87, vcc wave_shr:1 row_mask:0xf bank_mask:0xf
    s_andn2_b64 s[82:83], s[82:83], s[52:53]
    v_cndmask_b32_dpp v7, v7, v7, vcc wave_shr:1 row_mask:0xf bank_mask:0xf
    s_mov_b64 exec, s[50:51]
    s_cbranch_scc0 L2_d149
    s_mov_b64 exec, s[82:83]
    s_nop 1
    v_mfma_f32_4x4x4_16b_bf16 v[88:91], v[12:13], v[84:85], 0
    s_nop 1
    v_mfma_f32_4x4x4_16b_bf16 v[88:91], v[10:11], v[86:87], v[88:91]
    s_nop 4
    v_cvt_pk_bf16_f32 v88, v88, v89
    v_cvt_pk_bf16_f32 v89, v90, v91
    ds_pk_add_bf16 v7, v88 offset:65408
    ds_pk_add_bf16 v7, v89 offset:65412
    s_mov_b64 exec, s[50:51]
    s_branch L2_d149
L2_c150:
    s_lshl_b64 s[52:53], s[82:83], 1
    s_andn2_b64 s[52:53], s[52:53], s[80:81]
    s_andn2_b64 s[52:53], s[52:53], s[54:55]
    s_or_b64 s[80:81], s[80:81], s[52:53]
    s_not_b64 vcc, s[52:53]
    s_mov_b64 exec, -1
    v_cndmask_b32_dpp v84, v84, v84, vcc wave_shr:1 row_mask:0xf bank_mask:0xf
    v_cndmask_b32_dpp v85, v85, v85, vcc wave_shr:1 row_mask:0xf bank_mask:0xf
    s_lshr_b64 s[52:53], s[52:53], 1
    v_cndmask_b32_dpp v86, v86, v86, vcc wave_shr:1 row_mask:0xf bank_mask:0xf
    v_cndmask_b32_dpp v87, v87, v87, vcc wave_shr:1 row_mask:0xf bank_mask:0xf
    s_andn2_b64 s[82:83], s[82:83], s[52:53]
    v_cndmask_b32_dpp v7, v7, v7, vcc wave_shr:1 row_mask:0xf bank_mask:0xf
    s_mov_b64 exec, s[54:55]
    s_cbranch_scc0 L2_d150
    s_mov_b64 exec, s[82:83]
    s_nop 1
    v_mfma_f32_4x4x4_16b_bf16 v[88:91], v[12:13], v[84:85], 0
    s_nop 1
    v_mfma_f32_4x4x4_16b_bf16 v[88:91], v[10:11], v[86:87], v[88:91]
    s_nop 4
    v_cvt_pk_bf16_f32 v88, v88, v89
    v_cvt_pk_bf16_f32 v89, v90, v91
    ds_pk_add_bf16 v7, v88 offset:65408
    ds_pk_add_bf16 v7, v89 offset:65412
    s_mov_b64 exec, s[54:55]
    s_branch L2_d150
L2_c151:
    s_lshl_b64 s[52:53], s[82:83], 1
    s_andn2_b64 s[52:53], s[52:53], s[80:81]
    s_andn2_b64 s[52:53], s[52:53], s[50:51]
    s_or_b64 s[80:81], s[80:81], s[52:53]
    s_not_b64 vcc, s[52:53]
    s_mov_b64 exec, -1
    v_cndmask_b32_dpp v84, v84, v84, vcc wave_shr:1 row_mask:0xf bank_mask:0xf
    v_cndmask_b32_dpp v85, v85, v85, vcc wave_shr:1 row_mask:0xf bank_mask:0xf
    s_lshr_b64 s[52:53], s[52:53], 1
    v_cndmask_b32_dpp v86, v86, v86, vcc wave_shr:1 row_mask:0xf bank_mask:0xf
    v_cndmask_b32_dpp v87, v87, v87, vcc wave_shr:1 row_mask:0xf bank_mask:0xf
    s_andn2_b64 s[82:83], s[82:83], s[52:53]
    v_cndmask_b32_dpp v7, v7, v7, vcc wave_shr:1 row_mask:0xf bank_mask:0xf
    s_mov_b64 exec, s[50:51]
    s_cbranch_scc0 L2_d151
    s_mov_b64 exec, s[82:83]
    s_nop 1
    v_mfma_f32_4x4x4_16b_bf16 v[88:91], v[12:13], v[84:85], 0
    s_nop 1
    v_mfma_f32_4x4x4_16b_bf16 v[88:91], v[10:11], v[86:87], v[88:91]
    s_nop 4
    v_cvt_pk_bf16_f32 v88, v88, v89
    v_cvt_pk_bf16_f32 v89, v90, v91
    ds_pk_add_bf16 v7, v88 offset:65408
    ds_pk_add_bf16 v7, v89 offset:65412
    s_mov_b64 exec, s[50:51]
    s_branch L2_d151
L2_c152:
    s_mov_b64 s[50:51], vcc
    s_lshl_b64 s[52:53], s[82:83], 1
    s_andn2_b64 s[52:53], s[52:53], s[80:81]
    s_andn2_b64 s[52:53], s[52:53], s[50:51]
    s_or_b64 s[80:81], s[80:81], s[52:53]
    s_not_b64 vcc, s[52:53]
    s_mov_b64 exec, -1
    v_cndmask_b32_dpp v84, v84, v84, vcc wave_shr:1 row_mask:0xf bank_mask:0xf
    v_cndmask_b32_dpp v85, v85, v85, vcc wave_shr:1 row_mask:0xf bank_mask:0xf
    s_lshr_b64 s[52:53], s[52:53], 1
    v_cndmask_b32_dpp v86, v86, v86, vcc wave_shr:1 row_mask:0xf bank_mask:0xf
    v_cndmask_b32_dpp v87, v87, v87, vcc wave_shr:1 row_mask:0xf bank_mask:0xf
    s_andn2_b64 s[82:83], s[82:83], s[52:53]
    v_cndmask_b32_dpp v7, v7, v7, vcc wave_shr:1 row_mask:0xf bank_mask:0xf
    s_mov_b64 vcc, s[50:51]
    s_mov_b64 exec, s[50:51]
    s_cbranch_scc0 L2_d152
    s_mov_b64 exec, s[82:83]
    s_nop 1
    v_mfma_f32_4x4x4_16b_bf16 v[88:91], v[12:13], v[84:85], 0
    s_nop 1
    v_mfma_f32_4x4x4_16b_bf16 v[88:91], v[10:11], v[86:87], v[88:91]
    s_nop 4
    v_cvt_pk_bf16_f32 v88, v88, v89
    v_cvt_pk_bf16_f32 v89, v90, v91
    ds_pk_add_bf16 v7, v88 offset:65408
    ds_pk_add_bf16 v7, v89 offset:65412
    s_mov_b64 exec, vcc
    s_branch L2_d152
L2_c153:
    s_mov_b64 s[50:51], vcc
    s_lshl_b64 s[52:53], s[82:83], 1
    s_andn2_b64 s[52:53], s[52:53], s[80:81]
    s_andn2_b64 s[52:53], s[52:53], s[50:51]
    s_or_b64 s[80:81], s[80:81], s[52:53]
    s_not_b64 vcc, s[52:53]
    s_mov_b64 exec, -1
    v_cndmask_b32_dpp v84, v84, v84, vcc wave_shr:1 row_mask:0xf bank_mask:0xf
    v_cndmask_b32_dpp v85, v85, v85, vcc wave_shr:1 row_mask:0xf bank_mask:0xf
    s_lshr_b64 s[52:53], s[52:53], 1
    v_cndmask_b32_dpp v86, v86, v86, vcc wave_shr:1 row_mask:0xf bank_mask:0xf
    v_cndmask_b32_dpp v87, v87, v87, vcc wave_shr:1 row_mask:0xf bank_mask:0xf
    s_andn2_b64 s[82:83], s[82:83], s[52:53]
    v_cndmask_b32_dpp v7, v7, v7, vcc wave_shr:1 row_mask:0xf bank_mask:0xf
    s_mov_b64 vcc, s[50:51]
    s_mov_b64 exec, s[50:51]
    s_cbranch_scc0 L2_d153
    s_mov_b64 exec, s[82:83]
    s_nop 1
    v_mfma_f32_4x4x4_16b_bf16 v[88:91], v[12:13], v[84:85], 0
    s_nop 1
    v_mfma_f32_4x4x4_16b_bf16 v[88:91], v[10:11], v[86:87], v[88:91]
    s_nop 4
    v_cvt_pk_bf16_f32 v88, v88, v89
    v_cvt_pk_bf16_f32 v89, v90, v91
    ds_pk_add_bf16 v7, v88 offset:65408
    ds_pk_add_bf16 v7, v89 offset:65412
    s_mov_b64 exec, vcc
    s_branch L2_d153
L2_f3s:
    s_branch L2_f3
.section .rodata,"a"
.p2align 6
.amdhsa_kernel gather_scatter__molecular_angular_gemnet__graph_kernel
  .amdhsa_next_free_vgpr 128
  .amdhsa_next_free_sgpr 102
  .amdhsa_accum_offset 128
  .amdhsa_group_segment_fixed_size 0
  .amdhsa_kernarg_size 112
  .amdhsa_user_sgpr_count 2
  .amdhsa_user_sgpr_kernarg_segment_ptr 1
  .amdhsa_system_sgpr_workgroup_id_x 1
  .amdhsa_float_denorm_mode_32 3
.end_amdhsa_kernel
```

```asm
; @launch grid=(256,1,1) block=(1024,1,1) lds=163840
.amdgcn_target "amdgcn-amd-amdhsa--gfx950"
.text
.globl gather_scatter__molecular_angular_gemnet__graph_kernel
.p2align 8
.type gather_scatter__molecular_angular_gemnet__graph_kernel,@function
gather_scatter__molecular_angular_gemnet__graph_kernel:
    s_cmp_ge_u32 s2, 256
    s_cbranch_scc0 L1_go
    s_endpgm
L1_go:
    s_load_dwordx4 s[4:7], s[0:1], 8
    s_load_dwordx2 s[28:29], s[0:1], 32
    s_load_dwordx2 s[30:31], s[0:1], 104
    s_load_dwordx2 s[56:57], s[0:1], 96
    s_load_dwordx2 s[86:87], s[0:1], 0
    s_load_dwordx4 s[60:63], s[0:1], 56
    s_load_dwordx4 s[64:67], s[0:1], 72
    v_lshrrev_b32 v7, 6, v0
    v_lshlrev_b32 v1, 3, v0
    v_readfirstlane_b32 s32, v7
    v_lshlrev_b32 v0, 4, v0
    v_and_b32 v1, 0x1f8, v1
    v_lshlrev_b32 v15, 1, v1
    s_lshr_b32 s3, s32, 1
    s_and_b32 s44, s32, 1
    s_lshl_b32 s44, s44, 3
    s_or_b32 s3, s3, s44
    s_lshl_b32 s3, s3, 10
    s_lshl_b32 s96, s2, 14
    s_add_u32 s96, s96, s3
    s_lshr_b32 s3, s32, 1
    s_and_b32 s44, s32, 1
    s_lshl_b32 s44, s44, 3
    s_or_b32 s3, s3, s44
    s_lshl_b32 s3, s3, 10
    s_lshl_b32 s97, s2, 14
    s_add_u32 s97, s97, s3
    s_lshr_b32 s3, s32, 1
    s_and_b32 s44, s32, 1
    s_lshl_b32 s44, s44, 3
    s_or_b32 s3, s3, s44
    s_lshl_b32 s3, s3, 10
    s_lshl_b32 s98, s2, 14
    s_add_u32 s98, s98, s3
    s_lshr_b32 s3, s32, 1
    s_and_b32 s44, s32, 1
    s_lshl_b32 s44, s44, 3
    s_or_b32 s3, s3, s44
    s_lshl_b32 s3, s3, 10
    s_lshl_b32 s99, s2, 14
    s_add_u32 s99, s99, s3
    s_waitcnt lgkmcnt(0)
    s_mov_b32 s8, s4
    s_mov_b32 s9, s5
    s_mov_b32 s10, 0x9c40000
    s_mov_b32 s11, 0x20000
    s_mov_b32 s12, s6
    s_mov_b32 s13, s7
    s_mov_b32 s14, 0x9c40000
    s_mov_b32 s15, 0x20000
    s_mov_b32 s16, s28
    s_mov_b32 s17, s29
    s_mov_b32 s18, 0x4e20000
    s_mov_b32 s19, 0x20000
    s_mov_b32 s68, s62
    s_mov_b32 s69, s63
    s_mov_b32 s70, 0x40
    s_mov_b32 s71, 0x20000
    s_mov_b32 s72, s60
    s_mov_b32 s73, s61
    s_mov_b32 s74, 0x40
    s_mov_b32 s75, 0x20000
    s_mov_b32 s20, s66
    s_mov_b32 s21, s67
    s_mov_b32 s22, 0x20
    s_mov_b32 s23, 0x20000
    s_mov_b32 s80, s64
    s_mov_b32 s81, s65
    s_mov_b32 s82, 0x20
    s_mov_b32 s83, 0x20000
    s_add_u32 s24, s30, 0xec54000
    s_addc_u32 s25, s31, 0
    s_mov_b32 s26, 0x100
    s_mov_b32 s27, 0x20000
    v_lshrrev_b32 v2, 3, v0
    v_and_b32 v2, 6, v2
    v_lshlrev_b32 v3, 2, v0
    s_lshl_b32 s3, s32, 8
    s_add_u32 s3, s3, s2
    s_cmp_lg_u32 s3, 254
    s_cbranch_scc1 L1_wt
    buffer_load_ushort v96, v2, s[68:71], 0 offen offset:0
    buffer_load_ushort v108, v2, s[68:71], 0 offen offset:8
    buffer_load_ushort v97, v2, s[68:71], 0 offen offset:16
    buffer_load_ushort v109, v2, s[68:71], 0 offen offset:24
    buffer_load_ushort v98, v2, s[68:71], 0 offen offset:32
    buffer_load_ushort v110, v2, s[68:71], 0 offen offset:40
    buffer_load_ushort v99, v2, s[68:71], 0 offen offset:48
    buffer_load_ushort v111, v2, s[68:71], 0 offen offset:56
    buffer_load_ushort v100, v2, s[72:75], 0 offen offset:0
    buffer_load_ushort v112, v2, s[72:75], 0 offen offset:8
    buffer_load_ushort v101, v2, s[72:75], 0 offen offset:16
    buffer_load_ushort v113, v2, s[72:75], 0 offen offset:24
    buffer_load_ushort v102, v2, s[72:75], 0 offen offset:32
    buffer_load_ushort v114, v2, s[72:75], 0 offen offset:40
    buffer_load_ushort v103, v2, s[72:75], 0 offen offset:48
    buffer_load_ushort v115, v2, s[72:75], 0 offen offset:56
    buffer_load_ushort v104, v2, s[20:23], 0 offen offset:0
    buffer_load_ushort v116, v2, s[20:23], 0 offen offset:8
    buffer_load_ushort v105, v2, s[20:23], 0 offen offset:16
    buffer_load_ushort v117, v2, s[20:23], 0 offen offset:24
    buffer_load_ushort v106, v2, s[80:83], 0 offen offset:0
    buffer_load_ushort v118, v2, s[80:83], 0 offen offset:8
    buffer_load_ushort v107, v2, s[80:83], 0 offen offset:16
    buffer_load_ushort v119, v2, s[80:83], 0 offen offset:24
    s_waitcnt vmcnt(0)
    v_lshl_or_b32 v96, v108, 16, v96
    v_lshl_or_b32 v97, v109, 16, v97
    v_lshl_or_b32 v98, v110, 16, v98
    v_lshl_or_b32 v99, v111, 16, v99
    v_lshl_or_b32 v100, v112, 16, v100
    v_lshl_or_b32 v101, v113, 16, v101
    v_lshl_or_b32 v102, v114, 16, v102
    v_lshl_or_b32 v103, v115, 16, v103
    v_lshl_or_b32 v104, v116, 16, v104
    v_lshl_or_b32 v105, v117, 16, v105
    v_lshl_or_b32 v106, v118, 16, v106
    v_lshl_or_b32 v107, v119, 16, v107
    buffer_store_dwordx4 v[96:99], v3, s[24:27], 0 offen offset:0 sc1
    buffer_store_dwordx4 v[100:103], v3, s[24:27], 0 offen offset:16 sc1
    buffer_store_dwordx4 v[104:107], v3, s[24:27], 0 offen offset:32 sc1
L1_wt:
    s_nop 1
    s_add_u32 s44, s96, 0x0
    v_lshlrev_b32 v16, 1, v1
    buffer_load_dwordx4 v[16:19], v16, s[8:11], s44 offen nt
    s_add_u32 s45, s96, 0x0
    v_lshlrev_b32 v20, 1, v1
    buffer_load_dwordx4 v[20:23], v20, s[12:15], s45 offen nt
    s_add_u32 s46, s96, 0x0
    s_lshr_b32 s46, s46, 1
    buffer_load_dwordx2 v[24:25], v1, s[16:19], s46 offen nt
    s_add_u32 s47, s97, 0x400000
    s_lshr_b32 s47, s47, 1
    buffer_load_dwordx2 v[26:27], v1, s[16:19], s47 offen nt
    s_add_u32 s44, s97, 0x400000
    v_lshlrev_b32 v28, 1, v1
    buffer_load_dwordx4 v[28:31], v28, s[8:11], s44 offen nt
    s_add_u32 s45, s97, 0x400000
    v_lshlrev_b32 v32, 1, v1
    buffer_load_dwordx4 v[32:35], v32, s[12:15], s45 offen nt
    s_add_u32 s46, s98, 0x800000
    v_lshlrev_b32 v36, 1, v1
    buffer_load_dwordx4 v[36:39], v36, s[8:11], s46 offen nt
    s_add_u32 s47, s98, 0x800000
    v_lshlrev_b32 v40, 1, v1
    buffer_load_dwordx4 v[40:43], v40, s[12:15], s47 offen nt
    s_add_u32 s44, s98, 0x800000
    s_lshr_b32 s44, s44, 1
    buffer_load_dwordx2 v[44:45], v1, s[16:19], s44 offen nt
    s_add_u32 s45, s99, 0xc00000
    s_lshr_b32 s45, s45, 1
    buffer_load_dwordx2 v[46:47], v1, s[16:19], s45 offen nt
    s_mov_b32 s20, s30
    s_mov_b32 s21, s31
    s_mov_b32 s22, 0xd344000
    s_mov_b32 s23, 0x20000
    s_add_u32 s24, s30, 0x2c000
    s_addc_u32 s25, s31, 0
    s_mov_b32 s26, 0xd318000
    s_mov_b32 s27, 0x20000
    s_add_u32 s3, s32, 0
    s_mul_i32 s4, s3, 205
    s_lshr_b32 s4, s4, 10
    s_mul_i32 s5, s4, 5
    s_sub_u32 s5, s3, s5
    s_lshl_b32 s5, s5, 5
    s_add_u32 s4, s4, s5
    s_sub_u32 s4, s4, s32
    s_lshl_b32 s72, s4, 10
    s_add_u32 s3, s32, 16
    s_mul_i32 s4, s3, 205
    s_lshr_b32 s4, s4, 10
    s_mul_i32 s5, s4, 5
    s_sub_u32 s5, s3, s5
    s_lshl_b32 s5, s5, 5
    s_add_u32 s4, s4, s5
    s_sub_u32 s4, s4, s32
    s_lshl_b32 s73, s4, 10
    s_add_u32 s3, s32, 32
    s_mul_i32 s4, s3, 205
    s_lshr_b32 s4, s4, 10
    s_mul_i32 s5, s4, 5
    s_sub_u32 s5, s3, s5
    s_lshl_b32 s5, s5, 5
    s_add_u32 s4, s4, s5
    s_sub_u32 s4, s4, s32
    s_lshl_b32 s85, s4, 10
    s_add_u32 s3, s32, 48
    s_mul_i32 s4, s3, 205
    s_lshr_b32 s4, s4, 10
    s_mul_i32 s5, s4, 5
    s_sub_u32 s5, s3, s5
    s_lshl_b32 s5, s5, 5
    s_add_u32 s4, s4, s5
    s_sub_u32 s4, s4, s32
    s_lshl_b32 s91, s4, 10
    s_add_u32 s3, s32, 64
    s_mul_i32 s4, s3, 205
    s_lshr_b32 s4, s4, 10
    s_mul_i32 s5, s4, 5
    s_sub_u32 s5, s3, s5
    s_lshl_b32 s5, s5, 5
    s_add_u32 s4, s4, s5
    s_sub_u32 s4, s4, s32
    s_lshl_b32 s93, s4, 10
    s_mov_b32 s80, s86
    s_mov_b32 s81, s87
    s_mov_b32 s82, 0x4e2000
    s_mov_b32 s83, 0x20000
    s_mul_i32 s35, s2, 173056
    s_and_b32 s37, s32, 3
    s_lshl_b32 s37, s37, 3
    s_mov_b32 s36, s37
    s_lshr_b32 s37, s32, 2
    s_mul_i32 s37, s37, 2080
    s_add_u32 s36, s36, s37
    s_and_b32 s37, s2, 3
    s_lshl_b32 s37, s37, 5
    s_add_u32 s36, s36, s37
    s_mul_i32 s4, s2, 5
    s_add_u32 s4, s4, 8192
    s_lshl_b32 s38, s4, 14
    s_lshl_b32 s39, s4, 13
    v_mov_b32 v2, 1
    v_mov_b32 v4, 0x80000007
    v_mov_b32 v5, 0xfc
    v_mov_b32 v6, 0x78
    s_mov_b32 s40, 16512
    s_mov_b32 s55, -10000
    s_mov_b32 s41, 0x010c0c01
    s_mov_b32 s42, 0x030c0c03
    v_mov_b32 v8, 0
    v_mov_b32 v9, 0
    v_mov_b32 v10, 0
    v_mov_b32 v11, 0
    ds_write_b128 v0, v[8:11]
    s_add_u32 s60, s30, 0xec5d000
    s_addc_u32 s61, s31, 0
    s_mov_b32 s62, 0x8000
    s_mov_b32 s63, 0x20000
    s_mov_b64 s[66:67], s[56:57]
    s_lshl_b32 s57, s2, 7
    s_add_u32 s68, s30, 0xec55000
    s_addc_u32 s69, s31, 0
    s_mov_b32 s70, 0x80
    s_mov_b32 s71, 0x20000
    s_lshl_b32 s3, s2, 7
    s_add_u32 s68, s68, s3
    s_addc_u32 s69, s69, 0
    s_cmp_lg_u32 s32, 0
    s_cbranch_scc1 L1_fl
    buffer_store_dwordx4 v[8:11], v0, s[68:71], 0 offen sc1
    s_mov_b64 exec, 0xff
    buffer_store_dwordx4 v[8:11], v0, s[60:63], s57 offen sc1
    s_mov_b64 exec, -1
L1_fl:
    s_waitcnt lgkmcnt(0)
    s_barrier
    s_setprio 3
    s_add_u32 s46, s99, 0xc00000
    v_lshlrev_b32 v48, 1, v1
    buffer_load_dwordx4 v[48:51], v48, s[8:11], s46 offen nt
    s_add_u32 s47, s99, 0xc00000
    v_lshlrev_b32 v52, 1, v1
    buffer_load_dwordx4 v[52:55], v52, s[12:15], s47 offen nt
    s_waitcnt vmcnt(8)
    v_lshlrev_b32 v7, 16, v24
    v_and_b32 v8, 0xffff0000, v24
    v_lshlrev_b32 v9, 16, v25
    v_and_b32 v10, 0xffff0000, v25
    v_mul_f32 v7, 0.15915494, v7
    v_mul_f32 v8, 0.15915494, v8
    v_mul_f32 v9, 0.15915494, v9
    v_mul_f32 v10, 0.15915494, v10
    v_mul_hi_u32_u24 v14, 429497, v16
    v_lshrrev_b32 v12, 3, v20
    v_cos_f32 v7, v7
    v_lshlrev_b16 v13, 3, v20
    v_mad_i32_i24 v11, v14, s55, v16
    v_bitop3_b32 v12, v6, v13, v12 bitop3:0xca
    v_lshl_add_u32 v11, v11, 17, s40
    v_lshlrev_b16 v14, 8, v14
    v_lshrrev_b32 v13, 2, v20
    v_add_u32 v16, v12, v11
    v_bitop3_b32 v20, v5, v13, v14 bitop3:0xea
    ds_add_u32 v20, v2
    v_mul_hi_u32_u24 v14, 429497, v17
    v_lshrrev_b32 v12, 3, v21
    v_cos_f32 v8, v8
    v_lshlrev_b16 v13, 3, v21
    v_mad_i32_i24 v11, v14, s55, v17
    v_bitop3_b32 v12, v6, v13, v12 bitop3:0xca
    v_lshl_add_u32 v11, v11, 17, s40
    v_lshlrev_b16 v14, 8, v14
    v_lshrrev_b32 v13, 2, v21
    v_add_u32 v17, v12, v11
    v_bitop3_b32 v21, v5, v13, v14 bitop3:0xea
    ds_add_u32 v21, v2
    v_cvt_pk_bf16_f32 v24, v7, v8
    v_perm_b32 v12, v24, v24, s41
    v_bitop3_b32 v16, v4, v12, v16 bitop3:0xca
    v_perm_b32 v13, v24, v24, s42
    v_bitop3_b32 v17, v4, v13, v17 bitop3:0xca
    v_mul_hi_u32_u24 v14, 429497, v18
    v_lshrrev_b32 v12, 3, v22
    v_cos_f32 v9, v9
    v_lshlrev_b16 v13, 3, v22
    v_mad_i32_i24 v11, v14, s55, v18
    v_bitop3_b32 v12, v6, v13, v12 bitop3:0xca
    v_lshl_add_u32 v11, v11, 17, s40
    v_lshlrev_b16 v14, 8, v14
    v_lshrrev_b32 v13, 2, v22
    v_add_u32 v18, v12, v11
    v_bitop3_b32 v22, v5, v13, v14 bitop3:0xea
    ds_add_u32 v22, v2
    v_mul_hi_u32_u24 v14, 429497, v19
    v_lshrrev_b32 v12, 3, v23
    v_cos_f32 v10, v10
    v_lshlrev_b16 v13, 3, v23
    v_mad_i32_i24 v11, v14, s55, v19
    v_bitop3_b32 v12, v6, v13, v12 bitop3:0xca
    v_lshl_add_u32 v11, v11, 17, s40
    v_lshlrev_b16 v14, 8, v14
    v_lshrrev_b32 v13, 2, v23
    v_add_u32 v19, v12, v11
    v_bitop3_b32 v23, v5, v13, v14 bitop3:0xea
    ds_add_u32 v23, v2
    v_cvt_pk_bf16_f32 v25, v9, v10
    v_perm_b32 v12, v25, v25, s41
    v_bitop3_b32 v18, v4, v12, v18 bitop3:0xca
    v_perm_b32 v13, v25, v25, s42
    v_bitop3_b32 v19, v4, v13, v19 bitop3:0xca
    s_add_u32 s44, s96, 0x1000000
    v_lshlrev_b32 v56, 1, v1
    buffer_load_dwordx4 v[56:59], v56, s[8:11], s44 offen nt
    s_add_u32 s45, s96, 0x1000000
    v_lshlrev_b32 v60, 1, v1
    buffer_load_dwordx4 v[60:63], v60, s[12:15], s45 offen nt
    s_add_u32 s46, s96, 0x1000000
    s_lshr_b32 s46, s46, 1
    buffer_load_dwordx2 v[64:65], v1, s[16:19], s46 offen nt
    s_add_u32 s47, s97, 0x1400000
    s_lshr_b32 s47, s47, 1
    buffer_load_dwordx2 v[66:67], v1, s[16:19], s47 offen nt
    s_waitcnt vmcnt(10)
    v_lshlrev_b32 v7, 16, v26
    v_and_b32 v8, 0xffff0000, v26
    v_lshlrev_b32 v9, 16, v27
    v_and_b32 v10, 0xffff0000, v27
    v_mul_f32 v7, 0.15915494, v7
    v_mul_f32 v8, 0.15915494, v8
    v_mul_f32 v9, 0.15915494, v9
    v_mul_f32 v10, 0.15915494, v10
    v_mul_hi_u32_u24 v14, 429497, v28
    v_lshrrev_b32 v12, 3, v32
    v_cos_f32 v7, v7
    v_lshlrev_b16 v13, 3, v32
    v_mad_i32_i24 v11, v14, s55, v28
    v_bitop3_b32 v12, v6, v13, v12 bitop3:0xca
    v_lshl_add_u32 v11, v11, 17, s40
    v_lshlrev_b16 v14, 8, v14
    v_lshrrev_b32 v13, 2, v32
    v_add_u32 v28, v12, v11
    v_bitop3_b32 v32, v5, v13, v14 bitop3:0xea
    ds_add_u32 v32, v2
    v_mul_hi_u32_u24 v14, 429497, v29
    v_lshrrev_b32 v12, 3, v33
    v_cos_f32 v8, v8
    v_lshlrev_b16 v13, 3, v33
    v_mad_i32_i24 v11, v14, s55, v29
    v_bitop3_b32 v12, v6, v13, v12 bitop3:0xca
    v_lshl_add_u32 v11, v11, 17, s40
    v_lshlrev_b16 v14, 8, v14
    v_lshrrev_b32 v13, 2, v33
    v_add_u32 v29, v12, v11
    v_bitop3_b32 v33, v5, v13, v14 bitop3:0xea
    ds_add_u32 v33, v2
    v_cvt_pk_bf16_f32 v26, v7, v8
    v_perm_b32 v12, v26, v26, s41
    v_bitop3_b32 v28, v4, v12, v28 bitop3:0xca
    v_perm_b32 v13, v26, v26, s42
    v_bitop3_b32 v29, v4, v13, v29 bitop3:0xca
    v_mul_hi_u32_u24 v14, 429497, v30
    v_lshrrev_b32 v12, 3, v34
    v_cos_f32 v9, v9
    v_lshlrev_b16 v13, 3, v34
    v_mad_i32_i24 v11, v14, s55, v30
    v_bitop3_b32 v12, v6, v13, v12 bitop3:0xca
    v_lshl_add_u32 v11, v11, 17, s40
    v_lshlrev_b16 v14, 8, v14
    v_lshrrev_b32 v13, 2, v34
    v_add_u32 v30, v12, v11
    v_bitop3_b32 v34, v5, v13, v14 bitop3:0xea
    ds_add_u32 v34, v2
    v_mul_hi_u32_u24 v14, 429497, v31
    v_lshrrev_b32 v12, 3, v35
    v_cos_f32 v10, v10
    v_lshlrev_b16 v13, 3, v35
    v_mad_i32_i24 v11, v14, s55, v31
    v_bitop3_b32 v12, v6, v13, v12 bitop3:0xca
    v_lshl_add_u32 v11, v11, 17, s40
    v_lshlrev_b16 v14, 8, v14
    v_lshrrev_b32 v13, 2, v35
    v_add_u32 v31, v12, v11
    v_bitop3_b32 v35, v5, v13, v14 bitop3:0xea
    ds_add_u32 v35, v2
    v_cvt_pk_bf16_f32 v27, v9, v10
    v_perm_b32 v12, v27, v27, s41
    v_bitop3_b32 v30, v4, v12, v30 bitop3:0xca
    v_perm_b32 v13, v27, v27, s42
    v_bitop3_b32 v31, v4, v13, v31 bitop3:0xca
    s_setprio 2
    s_add_u32 s44, s97, 0x1400000
    v_lshlrev_b32 v68, 1, v1
    buffer_load_dwordx4 v[68:71], v68, s[8:11], s44 offen nt
    s_add_u32 s45, s97, 0x1400000
    v_lshlrev_b32 v72, 1, v1
    buffer_load_dwordx4 v[72:75], v72, s[12:15], s45 offen nt
    s_waitcnt vmcnt(8)
    v_lshlrev_b32 v7, 16, v44
    v_and_b32 v8, 0xffff0000, v44
    v_lshlrev_b32 v9, 16, v45
    v_and_b32 v10, 0xffff0000, v45
    v_mul_f32 v7, 0.15915494, v7
    v_mul_f32 v8, 0.15915494, v8
    v_mul_f32 v9, 0.15915494, v9
    v_mul_f32 v10, 0.15915494, v10
    v_mul_hi_u32_u24 v14, 429497, v36
    v_lshrrev_b32 v12, 3, v40
    v_cos_f32 v7, v7
    v_lshlrev_b16 v13, 3, v40
    v_mad_i32_i24 v11, v14, s55, v36
    v_bitop3_b32 v12, v6, v13, v12 bitop3:0xca
    v_lshl_add_u32 v11, v11, 17, s40
    v_lshlrev_b16 v14, 8, v14
    v_lshrrev_b32 v13, 2, v40
    v_add_u32 v36, v12, v11
    v_bitop3_b32 v40, v5, v13, v14 bitop3:0xea
    ds_add_u32 v40, v2
    v_mul_hi_u32_u24 v14, 429497, v37
    v_lshrrev_b32 v12, 3, v41
    v_cos_f32 v8, v8
    v_lshlrev_b16 v13, 3, v41
    v_mad_i32_i24 v11, v14, s55, v37
    v_bitop3_b32 v12, v6, v13, v12 bitop3:0xca
    v_lshl_add_u32 v11, v11, 17, s40
    v_lshlrev_b16 v14, 8, v14
    v_lshrrev_b32 v13, 2, v41
    v_add_u32 v37, v12, v11
    v_bitop3_b32 v41, v5, v13, v14 bitop3:0xea
    ds_add_u32 v41, v2
    v_cvt_pk_bf16_f32 v44, v7, v8
    v_perm_b32 v12, v44, v44, s41
    v_bitop3_b32 v36, v4, v12, v36 bitop3:0xca
    v_perm_b32 v13, v44, v44, s42
    v_bitop3_b32 v37, v4, v13, v37 bitop3:0xca
    v_mul_hi_u32_u24 v14, 429497, v38
    v_lshrrev_b32 v12, 3, v42
    v_cos_f32 v9, v9
    v_lshlrev_b16 v13, 3, v42
    v_mad_i32_i24 v11, v14, s55, v38
    v_bitop3_b32 v12, v6, v13, v12 bitop3:0xca
    v_lshl_add_u32 v11, v11, 17, s40
    v_lshlrev_b16 v14, 8, v14
    v_lshrrev_b32 v13, 2, v42
    v_add_u32 v38, v12, v11
    v_bitop3_b32 v42, v5, v13, v14 bitop3:0xea
    ds_add_u32 v42, v2
    v_mul_hi_u32_u24 v14, 429497, v39
    v_lshrrev_b32 v12, 3, v43
    v_cos_f32 v10, v10
    v_lshlrev_b16 v13, 3, v43
    v_mad_i32_i24 v11, v14, s55, v39
    v_bitop3_b32 v12, v6, v13, v12 bitop3:0xca
    v_lshl_add_u32 v11, v11, 17, s40
    v_lshlrev_b16 v14, 8, v14
    v_lshrrev_b32 v13, 2, v43
    v_add_u32 v39, v12, v11
    v_bitop3_b32 v43, v5, v13, v14 bitop3:0xea
    ds_add_u32 v43, v2
    v_cvt_pk_bf16_f32 v45, v9, v10
    v_perm_b32 v12, v45, v45, s41
    v_bitop3_b32 v38, v4, v12, v38 bitop3:0xca
    v_perm_b32 v13, v45, v45, s42
    v_bitop3_b32 v39, v4, v13, v39 bitop3:0xca
    s_add_u32 s46, s98, 0x1800000
    v_lshlrev_b32 v76, 1, v1
    buffer_load_dwordx4 v[76:79], v76, s[8:11], s46 offen nt
    s_add_u32 s47, s98, 0x1800000
    v_lshlrev_b32 v80, 1, v1
    buffer_load_dwordx4 v[80:83], v80, s[12:15], s47 offen nt
    s_add_u32 s44, s98, 0x1800000
    s_lshr_b32 s44, s44, 1
    buffer_load_dwordx2 v[84:85], v1, s[16:19], s44 offen nt
    s_add_u32 s45, s99, 0x1c00000
    s_lshr_b32 s45, s45, 1
    buffer_load_dwordx2 v[86:87], v1, s[16:19], s45 offen nt
    s_waitcnt vmcnt(10)
    v_lshlrev_b32 v7, 16, v46
    v_and_b32 v8, 0xffff0000, v46
    v_lshlrev_b32 v9, 16, v47
    v_and_b32 v10, 0xffff0000, v47
    v_mul_f32 v7, 0.15915494, v7
    v_mul_f32 v8, 0.15915494, v8
    v_mul_f32 v9, 0.15915494, v9
    v_mul_f32 v10, 0.15915494, v10
    v_mul_hi_u32_u24 v14, 429497, v48
    v_lshrrev_b32 v12, 3, v52
    v_cos_f32 v7, v7
    v_lshlrev_b16 v13, 3, v52
    v_mad_i32_i24 v11, v14, s55, v48
    v_bitop3_b32 v12, v6, v13, v12 bitop3:0xca
    v_lshl_add_u32 v11, v11, 17, s40
    v_lshlrev_b16 v14, 8, v14
    v_lshrrev_b32 v13, 2, v52
    v_add_u32 v48, v12, v11
    v_bitop3_b32 v52, v5, v13, v14 bitop3:0xea
    ds_add_u32 v52, v2
    v_mul_hi_u32_u24 v14, 429497, v49
    v_lshrrev_b32 v12, 3, v53
    v_cos_f32 v8, v8
    v_lshlrev_b16 v13, 3, v53
    v_mad_i32_i24 v11, v14, s55, v49
    v_bitop3_b32 v12, v6, v13, v12 bitop3:0xca
    v_lshl_add_u32 v11, v11, 17, s40
    v_lshlrev_b16 v14, 8, v14
    v_lshrrev_b32 v13, 2, v53
    v_add_u32 v49, v12, v11
    v_bitop3_b32 v53, v5, v13, v14 bitop3:0xea
    ds_add_u32 v53, v2
    v_cvt_pk_bf16_f32 v46, v7, v8
    v_perm_b32 v12, v46, v46, s41
    v_bitop3_b32 v48, v4, v12, v48 bitop3:0xca
    v_perm_b32 v13, v46, v46, s42
    v_bitop3_b32 v49, v4, v13, v49 bitop3:0xca
    v_mul_hi_u32_u24 v14, 429497, v50
    v_lshrrev_b32 v12, 3, v54
    v_cos_f32 v9, v9
    v_lshlrev_b16 v13, 3, v54
    v_mad_i32_i24 v11, v14, s55, v50
    v_bitop3_b32 v12, v6, v13, v12 bitop3:0xca
    v_lshl_add_u32 v11, v11, 17, s40
    v_lshlrev_b16 v14, 8, v14
    v_lshrrev_b32 v13, 2, v54
    v_add_u32 v50, v12, v11
    v_bitop3_b32 v54, v5, v13, v14 bitop3:0xea
    ds_add_u32 v54, v2
    v_mul_hi_u32_u24 v14, 429497, v51
    v_lshrrev_b32 v12, 3, v55
    v_cos_f32 v10, v10
    v_lshlrev_b16 v13, 3, v55
    v_mad_i32_i24 v11, v14, s55, v51
    v_bitop3_b32 v12, v6, v13, v12 bitop3:0xca
    v_lshl_add_u32 v11, v11, 17, s40
    v_lshlrev_b16 v14, 8, v14
    v_lshrrev_b32 v13, 2, v55
    v_add_u32 v51, v12, v11
    v_bitop3_b32 v55, v5, v13, v14 bitop3:0xea
    ds_add_u32 v55, v2
    v_cvt_pk_bf16_f32 v47, v9, v10
    v_perm_b32 v12, v47, v47, s41
    v_bitop3_b32 v50, v4, v12, v50 bitop3:0xca
    v_perm_b32 v13, v47, v47, s42
    v_bitop3_b32 v51, v4, v13, v51 bitop3:0xca
    s_setprio 1
    s_add_u32 s46, s99, 0x1c00000
    v_lshlrev_b32 v88, 1, v1
    buffer_load_dwordx4 v[88:91], v88, s[8:11], s46 offen nt
    s_add_u32 s47, s99, 0x1c00000
    v_lshlrev_b32 v92, 1, v1
    buffer_load_dwordx4 v[92:95], v92, s[12:15], s47 offen nt
    s_waitcnt vmcnt(8)
    v_lshlrev_b32 v7, 16, v64
    v_and_b32 v8, 0xffff0000, v64
    v_lshlrev_b32 v9, 16, v65
    v_and_b32 v10, 0xffff0000, v65
    v_mul_f32 v7, 0.15915494, v7
    v_mul_f32 v8, 0.15915494, v8
    v_mul_f32 v9, 0.15915494, v9
    v_mul_f32 v10, 0.15915494, v10
    v_mul_hi_u32_u24 v14, 429497, v56
    v_lshrrev_b32 v12, 3, v60
    v_cos_f32 v7, v7
    v_lshlrev_b16 v13, 3, v60
    v_mad_i32_i24 v11, v14, s55, v56
    v_bitop3_b32 v12, v6, v13, v12 bitop3:0xca
    v_lshl_add_u32 v11, v11, 17, s40
    v_lshlrev_b16 v14, 8, v14
    v_lshrrev_b32 v13, 2, v60
    v_add_u32 v56, v12, v11
    v_bitop3_b32 v60, v5, v13, v14 bitop3:0xea
    ds_add_u32 v60, v2
    v_mul_hi_u32_u24 v14, 429497, v57
    v_lshrrev_b32 v12, 3, v61
    v_cos_f32 v8, v8
    v_lshlrev_b16 v13, 3, v61
    v_mad_i32_i24 v11, v14, s55, v57
    v_bitop3_b32 v12, v6, v13, v12 bitop3:0xca
    v_lshl_add_u32 v11, v11, 17, s40
    v_lshlrev_b16 v14, 8, v14
    v_lshrrev_b32 v13, 2, v61
    v_add_u32 v57, v12, v11
    v_bitop3_b32 v61, v5, v13, v14 bitop3:0xea
    ds_add_u32 v61, v2
    v_cvt_pk_bf16_f32 v64, v7, v8
    v_perm_b32 v12, v64, v64, s41
    v_bitop3_b32 v56, v4, v12, v56 bitop3:0xca
    v_perm_b32 v13, v64, v64, s42
    v_bitop3_b32 v57, v4, v13, v57 bitop3:0xca
    v_mul_hi_u32_u24 v14, 429497, v58
    v_lshrrev_b32 v12, 3, v62
    v_cos_f32 v9, v9
    v_lshlrev_b16 v13, 3, v62
    v_mad_i32_i24 v11, v14, s55, v58
    v_bitop3_b32 v12, v6, v13, v12 bitop3:0xca
    v_lshl_add_u32 v11, v11, 17, s40
    v_lshlrev_b16 v14, 8, v14
    v_lshrrev_b32 v13, 2, v62
    v_add_u32 v58, v12, v11
    v_bitop3_b32 v62, v5, v13, v14 bitop3:0xea
    ds_add_u32 v62, v2
    v_mul_hi_u32_u24 v14, 429497, v59
    v_lshrrev_b32 v12, 3, v63
    v_cos_f32 v10, v10
    v_lshlrev_b16 v13, 3, v63
    v_mad_i32_i24 v11, v14, s55, v59
    v_bitop3_b32 v12, v6, v13, v12 bitop3:0xca
    v_lshl_add_u32 v11, v11, 17, s40
    v_lshlrev_b16 v14, 8, v14
    v_lshrrev_b32 v13, 2, v63
    v_add_u32 v59, v12, v11
    v_bitop3_b32 v63, v5, v13, v14 bitop3:0xea
    ds_add_u32 v63, v2
    v_cvt_pk_bf16_f32 v65, v9, v10
    v_perm_b32 v12, v65, v65, s41
    v_bitop3_b32 v58, v4, v12, v58 bitop3:0xca
    v_perm_b32 v13, v65, v65, s42
    v_bitop3_b32 v59, v4, v13, v59 bitop3:0xca
    s_add_u32 s44, s96, 0x2000000
    v_lshlrev_b32 v96, 1, v1
    buffer_load_dwordx4 v[96:99], v96, s[8:11], s44 offen nt
    s_add_u32 s45, s96, 0x2000000
    v_lshlrev_b32 v104, 1, v1
    buffer_load_dwordx4 v[104:107], v104, s[12:15], s45 offen nt
    s_add_u32 s46, s96, 0x2000000
    s_lshr_b32 s46, s46, 1
    buffer_load_dwordx2 v[108:109], v1, s[16:19], s46 offen nt
    s_add_u32 s47, s97, 0x2400000
    s_lshr_b32 s47, s47, 1
    buffer_load_dwordx2 v[110:111], v1, s[16:19], s47 offen nt
    s_waitcnt vmcnt(10)
    v_lshlrev_b32 v7, 16, v66
    v_and_b32 v8, 0xffff0000, v66
    v_lshlrev_b32 v9, 16, v67
    v_and_b32 v10, 0xffff0000, v67
    v_mul_f32 v7, 0.15915494, v7
    v_mul_f32 v8, 0.15915494, v8
    v_mul_f32 v9, 0.15915494, v9
    v_mul_f32 v10, 0.15915494, v10
    v_mul_hi_u32_u24 v14, 429497, v68
    v_lshrrev_b32 v12, 3, v72
    v_cos_f32 v7, v7
    v_lshlrev_b16 v13, 3, v72
    v_mad_i32_i24 v11, v14, s55, v68
    v_bitop3_b32 v12, v6, v13, v12 bitop3:0xca
    v_lshl_add_u32 v11, v11, 17, s40
    v_lshlrev_b16 v14, 8, v14
    v_lshrrev_b32 v13, 2, v72
    v_add_u32 v68, v12, v11
    v_bitop3_b32 v72, v5, v13, v14 bitop3:0xea
    ds_add_u32 v72, v2
    v_mul_hi_u32_u24 v14, 429497, v69
    v_lshrrev_b32 v12, 3, v73
    v_cos_f32 v8, v8
    v_lshlrev_b16 v13, 3, v73
    v_mad_i32_i24 v11, v14, s55, v69
    v_bitop3_b32 v12, v6, v13, v12 bitop3:0xca
    v_lshl_add_u32 v11, v11, 17, s40
    v_lshlrev_b16 v14, 8, v14
    v_lshrrev_b32 v13, 2, v73
    v_add_u32 v69, v12, v11
    v_bitop3_b32 v73, v5, v13, v14 bitop3:0xea
    ds_add_u32 v73, v2
    v_cvt_pk_bf16_f32 v66, v7, v8
    v_perm_b32 v12, v66, v66, s41
    v_bitop3_b32 v68, v4, v12, v68 bitop3:0xca
    v_perm_b32 v13, v66, v66, s42
    v_bitop3_b32 v69, v4, v13, v69 bitop3:0xca
    v_mul_hi_u32_u24 v14, 429497, v70
    v_lshrrev_b32 v12, 3, v74
    v_cos_f32 v9, v9
    v_lshlrev_b16 v13, 3, v74
    v_mad_i32_i24 v11, v14, s55, v70
    v_bitop3_b32 v12, v6, v13, v12 bitop3:0xca
    v_lshl_add_u32 v11, v11, 17, s40
    v_lshlrev_b16 v14, 8, v14
    v_lshrrev_b32 v13, 2, v74
    v_add_u32 v70, v12, v11
    v_bitop3_b32 v74, v5, v13, v14 bitop3:0xea
    ds_add_u32 v74, v2
    v_mul_hi_u32_u24 v14, 429497, v71
    v_lshrrev_b32 v12, 3, v75
    v_cos_f32 v10, v10
    v_lshlrev_b16 v13, 3, v75
    v_mad_i32_i24 v11, v14, s55, v71
    v_bitop3_b32 v12, v6, v13, v12 bitop3:0xca
    v_lshl_add_u32 v11, v11, 17, s40
    v_lshlrev_b16 v14, 8, v14
    v_lshrrev_b32 v13, 2, v75
    v_add_u32 v71, v12, v11
    v_bitop3_b32 v75, v5, v13, v14 bitop3:0xea
    ds_add_u32 v75, v2
    v_cvt_pk_bf16_f32 v67, v9, v10
    v_perm_b32 v12, v67, v67, s41
    v_bitop3_b32 v70, v4, v12, v70 bitop3:0xca
    v_perm_b32 v13, v67, v67, s42
    v_bitop3_b32 v71, v4, v13, v71 bitop3:0xca
    s_setprio 0
    s_add_u32 s44, s97, 0x2400000
    v_lshlrev_b32 v100, 1, v1
    buffer_load_dwordx4 v[100:103], v100, s[8:11], s44 offen nt
    s_waitcnt vmcnt(7)
    v_lshlrev_b32 v7, 16, v84
    v_and_b32 v8, 0xffff0000, v84
    v_lshlrev_b32 v9, 16, v85
    v_and_b32 v10, 0xffff0000, v85
    v_mul_f32 v7, 0.15915494, v7
    v_mul_f32 v8, 0.15915494, v8
    v_mul_f32 v9, 0.15915494, v9
    v_mul_f32 v10, 0.15915494, v10
    v_mul_hi_u32_u24 v14, 429497, v76
    v_lshrrev_b32 v12, 3, v80
    v_cos_f32 v7, v7
    v_lshlrev_b16 v13, 3, v80
    v_mad_i32_i24 v11, v14, s55, v76
    v_bitop3_b32 v12, v6, v13, v12 bitop3:0xca
    v_lshl_add_u32 v11, v11, 17, s40
    v_lshlrev_b16 v14, 8, v14
    v_lshrrev_b32 v13, 2, v80
    v_add_u32 v76, v12, v11
    v_bitop3_b32 v80, v5, v13, v14 bitop3:0xea
    ds_add_u32 v80, v2
    v_mul_hi_u32_u24 v14, 429497, v77
    v_lshrrev_b32 v12, 3, v81
    v_cos_f32 v8, v8
    v_lshlrev_b16 v13, 3, v81
    v_mad_i32_i24 v11, v14, s55, v77
    v_bitop3_b32 v12, v6, v13, v12 bitop3:0xca
    v_lshl_add_u32 v11, v11, 17, s40
    v_lshlrev_b16 v14, 8, v14
    v_lshrrev_b32 v13, 2, v81
    v_add_u32 v77, v12, v11
    v_bitop3_b32 v81, v5, v13, v14 bitop3:0xea
    ds_add_u32 v81, v2
    v_cvt_pk_bf16_f32 v84, v7, v8
    v_perm_b32 v12, v84, v84, s41
    v_bitop3_b32 v76, v4, v12, v76 bitop3:0xca
    v_perm_b32 v13, v84, v84, s42
    v_bitop3_b32 v77, v4, v13, v77 bitop3:0xca
    v_mul_hi_u32_u24 v14, 429497, v78
    v_lshrrev_b32 v12, 3, v82
    v_cos_f32 v9, v9
    v_lshlrev_b16 v13, 3, v82
    v_mad_i32_i24 v11, v14, s55, v78
    v_bitop3_b32 v12, v6, v13, v12 bitop3:0xca
    v_lshl_add_u32 v11, v11, 17, s40
    v_lshlrev_b16 v14, 8, v14
    v_lshrrev_b32 v13, 2, v82
    v_add_u32 v78, v12, v11
    v_bitop3_b32 v82, v5, v13, v14 bitop3:0xea
    ds_add_u32 v82, v2
    v_mul_hi_u32_u24 v14, 429497, v79
    v_lshrrev_b32 v12, 3, v83
    v_cos_f32 v10, v10
    v_lshlrev_b16 v13, 3, v83
    v_mad_i32_i24 v11, v14, s55, v79
    v_bitop3_b32 v12, v6, v13, v12 bitop3:0xca
    v_lshl_add_u32 v11, v11, 17, s40
    v_lshlrev_b16 v14, 8, v14
    v_lshrrev_b32 v13, 2, v83
    v_add_u32 v79, v12, v11
    v_bitop3_b32 v83, v5, v13, v14 bitop3:0xea
    ds_add_u32 v83, v2
    v_cvt_pk_bf16_f32 v85, v9, v10
    v_perm_b32 v12, v85, v85, s41
    v_bitop3_b32 v78, v4, v12, v78 bitop3:0xca
    v_perm_b32 v13, v85, v85, s42
    v_bitop3_b32 v79, v4, v13, v79 bitop3:0xca
    s_waitcnt vmcnt(5)
    v_lshlrev_b32 v7, 16, v86
    v_and_b32 v8, 0xffff0000, v86
    v_lshlrev_b32 v9, 16, v87
    v_and_b32 v10, 0xffff0000, v87
    v_mul_f32 v7, 0.15915494, v7
    v_mul_f32 v8, 0.15915494, v8
    v_mul_f32 v9, 0.15915494, v9
    v_mul_f32 v10, 0.15915494, v10
    v_mul_hi_u32_u24 v14, 429497, v88
    v_lshrrev_b32 v12, 3, v92
    v_cos_f32 v7, v7
    v_lshlrev_b16 v13, 3, v92
    v_mad_i32_i24 v11, v14, s55, v88
    v_bitop3_b32 v12, v6, v13, v12 bitop3:0xca
    v_lshl_add_u32 v11, v11, 17, s40
    v_lshlrev_b16 v14, 8, v14
    v_lshrrev_b32 v13, 2, v92
    v_add_u32 v88, v12, v11
    v_bitop3_b32 v92, v5, v13, v14 bitop3:0xea
    ds_add_u32 v92, v2
    v_mul_hi_u32_u24 v14, 429497, v89
    v_lshrrev_b32 v12, 3, v93
    v_cos_f32 v8, v8
    v_lshlrev_b16 v13, 3, v93
    v_mad_i32_i24 v11, v14, s55, v89
    v_bitop3_b32 v12, v6, v13, v12 bitop3:0xca
    v_lshl_add_u32 v11, v11, 17, s40
    v_lshlrev_b16 v14, 8, v14
    v_lshrrev_b32 v13, 2, v93
    v_add_u32 v89, v12, v11
    v_bitop3_b32 v93, v5, v13, v14 bitop3:0xea
    ds_add_u32 v93, v2
    v_cvt_pk_bf16_f32 v86, v7, v8
    v_perm_b32 v12, v86, v86, s41
    v_bitop3_b32 v88, v4, v12, v88 bitop3:0xca
    v_perm_b32 v13, v86, v86, s42
    v_bitop3_b32 v89, v4, v13, v89 bitop3:0xca
    v_mul_hi_u32_u24 v14, 429497, v90
    v_lshrrev_b32 v12, 3, v94
    v_cos_f32 v9, v9
    v_lshlrev_b16 v13, 3, v94
    v_mad_i32_i24 v11, v14, s55, v90
    v_bitop3_b32 v12, v6, v13, v12 bitop3:0xca
    v_lshl_add_u32 v11, v11, 17, s40
    v_lshlrev_b16 v14, 8, v14
    v_lshrrev_b32 v13, 2, v94
    v_add_u32 v90, v12, v11
    v_bitop3_b32 v94, v5, v13, v14 bitop3:0xea
    ds_add_u32 v94, v2
    v_mul_hi_u32_u24 v14, 429497, v91
    v_lshrrev_b32 v12, 3, v95
    v_cos_f32 v10, v10
    v_lshlrev_b16 v13, 3, v95
    v_mad_i32_i24 v11, v14, s55, v91
    v_bitop3_b32 v12, v6, v13, v12 bitop3:0xca
    v_lshl_add_u32 v11, v11, 17, s40
    v_lshlrev_b16 v14, 8, v14
    v_lshrrev_b32 v13, 2, v95
    v_add_u32 v91, v12, v11
    v_bitop3_b32 v95, v5, v13, v14 bitop3:0xea
    ds_add_u32 v95, v2
    v_cvt_pk_bf16_f32 v87, v9, v10
    v_perm_b32 v12, v87, v87, s41
    v_bitop3_b32 v90, v4, v12, v90 bitop3:0xca
    v_perm_b32 v13, v87, v87, s42
    v_bitop3_b32 v91, v4, v13, v91 bitop3:0xca
    v_lshrrev_b32 v8, 2, v0
    v_and_b32 v7, 0x3c00, v0
    v_bitop3_b32 v7, v5, v8, v7 bitop3:0xea
    s_waitcnt lgkmcnt(0)
    s_barrier
    ds_read2st64_b32 v[8:9], v7 offset0:0 offset1:1
    ds_read2st64_b32 v[10:11], v7 offset0:2 offset1:3
    s_add_u32 s45, s97, 0x2400000
    v_lshlrev_b32 v112, 1, v1
    buffer_load_dwordx4 v[112:115], v112, s[12:15], s45 offen nt
    s_waitcnt lgkmcnt(0)
    v_lshl_or_b32 v12, v9, 16, v8
    v_lshl_or_b32 v13, v11, 16, v10
    v_mov_b32 v14, v12
    v_mov_b32 v15, v13
    s_nop 0
    v_add_u32_dpp v14, v14, v14 row_shr:1 row_mask:0xf bank_mask:0xf bound_ctrl:1
    v_add_u32_dpp v15, v15, v15 row_shr:1 row_mask:0xf bank_mask:0xf bound_ctrl:1
    s_nop 0
    v_add_u32_dpp v14, v14, v14 row_shr:2 row_mask:0xf bank_mask:0xf bound_ctrl:1
    v_add_u32_dpp v15, v15, v15 row_shr:2 row_mask:0xf bank_mask:0xf bound_ctrl:1
    s_nop 0
    v_add_u32_dpp v14, v14, v14 row_shr:4 row_mask:0xf bank_mask:0xf bound_ctrl:1
    v_add_u32_dpp v15, v15, v15 row_shr:4 row_mask:0xf bank_mask:0xf bound_ctrl:1
    s_nop 0
    v_add_u32_dpp v14, v14, v14 row_shr:8 row_mask:0xf bank_mask:0xf bound_ctrl:1
    v_add_u32_dpp v15, v15, v15 row_shr:8 row_mask:0xf bank_mask:0xf bound_ctrl:1
    s_nop 0
    v_add_u32_dpp v14, v14, v14 row_bcast:15 row_mask:0xa bank_mask:0xf
    v_add_u32_dpp v15, v15, v15 row_bcast:15 row_mask:0xa bank_mask:0xf
    s_nop 0
    v_add_u32_dpp v14, v14, v14 row_bcast:31 row_mask:0xc bank_mask:0xf
    v_add_u32_dpp v15, v15, v15 row_bcast:31 row_mask:0xc bank_mask:0xf
    v_readlane_b32 s48, v14, 63
    v_readlane_b32 s49, v15, 63
    s_lshl_b32 s54, s32, 2
    v_mov_b32 v8, s54
    s_and_b32 s50, s48, 0xffff
    s_lshr_b32 s51, s48, 16
    s_and_b32 s52, s49, 0xffff
    s_lshr_b32 s53, s49, 16
    s_add_u32 s51, s51, s50
    s_add_u32 s52, s52, s51
    s_add_u32 s53, s53, s52
    v_mov_b32 v9, s53
    s_mov_b64 exec, 1
    ds_write_b32 v8, v9 offset:16384
    s_mov_b64 exec, -1
    v_and_b32 v8, 60, v7
    s_waitcnt lgkmcnt(0)
    s_barrier
    ds_read_b32 v9, v8 offset:16384
    s_waitcnt lgkmcnt(0)
    v_add_u32_dpp v9, v9, v9 row_shr:1 row_mask:0xf bank_mask:0xf bound_ctrl:1
    s_nop 1
    v_add_u32_dpp v9, v9, v9 row_shr:2 row_mask:0xf bank_mask:0xf bound_ctrl:1
    s_nop 1
    v_add_u32_dpp v9, v9, v9 row_shr:4 row_mask:0xf bank_mask:0xf bound_ctrl:1
    s_nop 1
    v_add_u32_dpp v9, v9, v9 row_shr:8 row_mask:0xf bank_mask:0xf bound_ctrl:1
    s_nop 0
    v_readlane_b32 s54, v9, s32
    s_sub_u32 s54, s54, s53
    s_add_u32 s50, s50, s54
    s_add_u32 s51, s51, s54
    s_add_u32 s52, s52, s54
    s_pack_ll_b32_b16 s48, s54, s50
    s_pack_ll_b32_b16 s49, s51, s52
    v_add_u32 v14, s48, v14
    v_add_u32 v15, s49, v15
    v_sub_u32 v12, v14, v12
    v_sub_u32 v13, v15, v13
    v_and_b32 v8, 0xffff, v12
    v_lshrrev_b32 v9, 16, v12
    v_and_b32 v10, 0xffff, v13
    v_lshrrev_b32 v11, 16, v13
    ds_write2st64_b32 v7, v8, v9 offset0:0 offset1:1
    ds_write2st64_b32 v7, v10, v11 offset0:2 offset1:3
    v_and_b32 v8, 0x3f0, v0
    v_lshl_add_u32 v8, v8, 1, s36
    ds_write_b64 v8, v[12:13] offset:20480
    s_bitset0_b64 exec, 63
    s_not_b64 exec, exec
    ds_write_b64 v8, v[14:15] offset:20512
    s_mov_b64 exec, -1
    s_waitcnt lgkmcnt(0)
    s_barrier
    s_setprio 3
    ds_add_rtn_u32 v20, v20, v2
    ds_add_rtn_u32 v21, v21, v2
    ds_add_rtn_u32 v22, v22, v2
    ds_add_rtn_u32 v23, v23, v2
    ds_read_b128 v[12:15], v0 offset:20480
    v_cmp_gt_u32 vcc, 8448, v0
    s_add_u32 s46, s98, 0x2800000
    v_lshlrev_b32 v116, 1, v1
    buffer_load_dwordx4 v[116:119], v116, s[8:11], s46 offen nt
    ds_add_rtn_u32 v32, v32, v2
    ds_add_rtn_u32 v33, v33, v2
    ds_add_rtn_u32 v34, v34, v2
    ds_add_rtn_u32 v35, v35, v2
    s_setprio 2
    ds_add_rtn_u32 v40, v40, v2
    ds_add_rtn_u32 v41, v41, v2
    ds_add_rtn_u32 v42, v42, v2
    ds_add_rtn_u32 v43, v43, v2
    s_waitcnt lgkmcnt(8)
    s_cbranch_vccz L1_p1
    s_add_u32 s47, s35, 0x0
    s_mov_b64 exec, vcc
    buffer_store_dwordx4 v[12:15], v0, s[24:27], s47 offen sc1
    s_mov_b64 exec, -1
L1_p1:
    s_add_u32 s44, s98, 0x2800000
    v_lshlrev_b32 v120, 1, v1
    buffer_load_dwordx4 v[120:123], v120, s[12:15], s44 offen nt
    ds_add_rtn_u32 v52, v52, v2
    ds_add_rtn_u32 v53, v53, v2
    ds_add_rtn_u32 v54, v54, v2
    ds_add_rtn_u32 v55, v55, v2
    s_setprio 1
    ds_add_rtn_u32 v60, v60, v2
    ds_add_rtn_u32 v61, v61, v2
    ds_add_rtn_u32 v62, v62, v2
    ds_add_rtn_u32 v63, v63, v2
    ds_add_rtn_u32 v72, v72, v2
    ds_add_rtn_u32 v73, v73, v2
    ds_add_rtn_u32 v74, v74, v2
    ds_add_rtn_u32 v75, v75, v2
    s_add_u32 s45, s98, 0x2800000
    s_lshr_b32 s45, s45, 1
    buffer_load_dwordx2 v[124:125], v1, s[16:19], s45 offen nt
    s_add_u32 s46, s99, 0x2c00000
    s_lshr_b32 s46, s46, 1
    buffer_load_dwordx2 v[126:127], v1, s[16:19], s46 offen nt
    s_setprio 0
    ds_add_rtn_u32 v80, v80, v2
    ds_add_rtn_u32 v81, v81, v2
    ds_add_rtn_u32 v82, v82, v2
    ds_add_rtn_u32 v83, v83, v2
    ds_add_rtn_u32 v92, v92, v2
    ds_add_rtn_u32 v93, v93, v2
    ds_add_rtn_u32 v94, v94, v2
    ds_add_rtn_u32 v95, v95, v2
    s_waitcnt lgkmcnt(0)
    s_barrier
    s_setprio 3
    v_and_b32 v7, -4, v20
    v_lshl_add_u32 v8, v20, 2, v7
    ds_write_b32 v8, v16
    v_lshl_add_u32 v7, v7, 2, v20
    ds_write_b8 v7, v24 offset:16
    v_and_b32 v9, -4, v21
    v_lshl_add_u32 v10, v21, 2, v9
    ds_write_b32 v10, v17
    v_lshl_add_u32 v9, v9, 2, v21
    ds_write_b8_d16_hi v9, v24 offset:16
    v_and_b32 v7, -4, v22
    v_lshl_add_u32 v8, v22, 2, v7
    ds_write_b32 v8, v18
    v_lshl_add_u32 v7, v7, 2, v22
    ds_write_b8 v7, v25 offset:16
    v_and_b32 v9, -4, v23
    v_lshl_add_u32 v10, v23, 2, v9
    ds_write_b32 v10, v19
    v_lshl_add_u32 v9, v9, 2, v23
    ds_write_b8_d16_hi v9, v25 offset:16
    s_add_u32 s47, s99, 0x2c00000
    v_lshlrev_b32 v16, 1, v1
    buffer_load_dwordx4 v[16:19], v16, s[8:11], s47 offen nt
    s_add_u32 s44, s99, 0x2c00000
    v_lshlrev_b32 v20, 1, v1
    buffer_load_dwordx4 v[20:23], v20, s[12:15], s44 offen nt
    v_and_b32 v7, -4, v32
    v_lshl_add_u32 v8, v32, 2, v7
    ds_write_b32 v8, v28
    v_lshl_add_u32 v7, v7, 2, v32
    ds_write_b8 v7, v26 offset:16
    v_and_b32 v9, -4, v33
    v_lshl_add_u32 v10, v33, 2, v9
    ds_write_b32 v10, v29
    v_lshl_add_u32 v9, v9, 2, v33
    ds_write_b8_d16_hi v9, v26 offset:16
    v_and_b32 v7, -4, v34
    v_lshl_add_u32 v8, v34, 2, v7
    ds_write_b32 v8, v30
    v_lshl_add_u32 v7, v7, 2, v34
    ds_write_b8 v7, v27 offset:16
    v_and_b32 v9, -4, v35
    v_lshl_add_u32 v10, v35, 2, v9
    ds_write_b32 v10, v31
    v_lshl_add_u32 v9, v9, 2, v35
    ds_write_b8_d16_hi v9, v27 offset:16
    s_add_u32 s45, s96, 0x3000000
    v_lshlrev_b32 v28, 1, v1
    buffer_load_dwordx4 v[28:31], v28, s[8:11], s45 offen nt
    s_waitcnt vmcnt(9)
    v_lshlrev_b32 v7, 16, v108
    v_and_b32 v8, 0xffff0000, v108
    v_lshlrev_b32 v9, 16, v109
    v_and_b32 v10, 0xffff0000, v109
    v_mul_f32 v7, 0.15915494, v7
    v_mul_f32 v8, 0.15915494, v8
    v_mul_f32 v9, 0.15915494, v9
    v_mul_f32 v10, 0.15915494, v10
    v_mul_hi_u32_u24 v14, 429497, v96
    v_lshrrev_b32 v12, 3, v104
    v_cos_f32 v7, v7
    v_lshlrev_b16 v13, 3, v104
    v_mad_i32_i24 v11, v14, s55, v96
    v_bitop3_b32 v12, v6, v13, v12 bitop3:0xca
    v_lshl_add_u32 v11, v11, 17, s40
    v_lshlrev_b16 v14, 8, v14
    v_lshrrev_b32 v13, 2, v104
    v_add_u32 v96, v12, v11
    v_bitop3_b32 v104, v5, v13, v14 bitop3:0xea
    v_mul_hi_u32_u24 v14, 429497, v97
    v_lshrrev_b32 v12, 3, v105
    v_cos_f32 v8, v8
    v_lshlrev_b16 v13, 3, v105
    v_mad_i32_i24 v11, v14, s55, v97
    v_bitop3_b32 v12, v6, v13, v12 bitop3:0xca
    v_lshl_add_u32 v11, v11, 17, s40
    v_lshlrev_b16 v14, 8, v14
    v_lshrrev_b32 v13, 2, v105
    v_add_u32 v97, v12, v11
    v_bitop3_b32 v105, v5, v13, v14 bitop3:0xea
    v_cvt_pk_bf16_f32 v108, v7, v8
    v_perm_b32 v12, v108, v108, s41
    v_bitop3_b32 v96, v4, v12, v96 bitop3:0xca
    v_perm_b32 v13, v108, v108, s42
    v_bitop3_b32 v97, v4, v13, v97 bitop3:0xca
    v_mul_hi_u32_u24 v14, 429497, v98
    v_lshrrev_b32 v12, 3, v106
    v_cos_f32 v9, v9
    v_lshlrev_b16 v13, 3, v106
    v_mad_i32_i24 v11, v14, s55, v98
    v_bitop3_b32 v12, v6, v13, v12 bitop3:0xca
    v_lshl_add_u32 v11, v11, 17, s40
    v_lshlrev_b16 v14, 8, v14
    v_lshrrev_b32 v13, 2, v106
    v_add_u32 v98, v12, v11
    v_bitop3_b32 v106, v5, v13, v14 bitop3:0xea
    v_mul_hi_u32_u24 v14, 429497, v99
    v_lshrrev_b32 v12, 3, v107
    v_cos_f32 v10, v10
    v_lshlrev_b16 v13, 3, v107
    v_mad_i32_i24 v11, v14, s55, v99
    v_bitop3_b32 v12, v6, v13, v12 bitop3:0xca
    v_lshl_add_u32 v11, v11, 17, s40
    v_lshlrev_b16 v14, 8, v14
    v_lshrrev_b32 v13, 2, v107
    v_add_u32 v99, v12, v11
    v_bitop3_b32 v107, v5, v13, v14 bitop3:0xea
    v_cvt_pk_bf16_f32 v109, v9, v10
    v_perm_b32 v12, v109, v109, s41
    v_bitop3_b32 v98, v4, v12, v98 bitop3:0xca
    v_perm_b32 v13, v109, v109, s42
    v_bitop3_b32 v99, v4, v13, v99 bitop3:0xca
    s_setprio 2
    v_and_b32 v7, -4, v40
    v_lshl_add_u32 v8, v40, 2, v7
    ds_write_b32 v8, v36
    v_lshl_add_u32 v7, v7, 2, v40
    ds_write_b8 v7, v44 offset:16
    v_and_b32 v9, -4, v41
    v_lshl_add_u32 v10, v41, 2, v9
    ds_write_b32 v10, v37
    v_lshl_add_u32 v9, v9, 2, v41
    ds_write_b8_d16_hi v9, v44 offset:16
    v_and_b32 v7, -4, v42
    v_lshl_add_u32 v8, v42, 2, v7
    ds_write_b32 v8, v38
    v_lshl_add_u32 v7, v7, 2, v42
    ds_write_b8 v7, v45 offset:16
    v_and_b32 v9, -4, v43
    v_lshl_add_u32 v10, v43, 2, v9
    ds_write_b32 v10, v39
    v_lshl_add_u32 v9, v9, 2, v43
    ds_write_b8_d16_hi v9, v45 offset:16
    s_add_u32 s46, s96, 0x3000000
    v_lshlrev_b32 v32, 1, v1
    buffer_load_dwordx4 v[32:35], v32, s[12:15], s46 offen nt
    s_waitcnt vmcnt(8)
    v_lshlrev_b32 v7, 16, v110
    v_and_b32 v8, 0xffff0000, v110
    v_lshlrev_b32 v9, 16, v111
    v_and_b32 v10, 0xffff0000, v111
    v_mul_f32 v7, 0.15915494, v7
    v_mul_f32 v8, 0.15915494, v8
    v_mul_f32 v9, 0.15915494, v9
    v_mul_f32 v10, 0.15915494, v10
    v_mul_hi_u32_u24 v14, 429497, v100
    v_lshrrev_b32 v12, 3, v112
    v_cos_f32 v7, v7
    v_lshlrev_b16 v13, 3, v112
    v_mad_i32_i24 v11, v14, s55, v100
    v_bitop3_b32 v12, v6, v13, v12 bitop3:0xca
    v_lshl_add_u32 v11, v11, 17, s40
    v_lshlrev_b16 v14, 8, v14
    v_lshrrev_b32 v13, 2, v112
    v_add_u32 v100, v12, v11
    v_bitop3_b32 v112, v5, v13, v14 bitop3:0xea
    v_mul_hi_u32_u24 v14, 429497, v101
    v_lshrrev_b32 v12, 3, v113
    v_cos_f32 v8, v8
    v_lshlrev_b16 v13, 3, v113
    v_mad_i32_i24 v11, v14, s55, v101
    v_bitop3_b32 v12, v6, v13, v12 bitop3:0xca
    v_lshl_add_u32 v11, v11, 17, s40
    v_lshlrev_b16 v14, 8, v14
    v_lshrrev_b32 v13, 2, v113
    v_add_u32 v101, v12, v11
    v_bitop3_b32 v113, v5, v13, v14 bitop3:0xea
    v_cvt_pk_bf16_f32 v110, v7, v8
    v_perm_b32 v12, v110, v110, s41
    v_bitop3_b32 v100, v4, v12, v100 bitop3:0xca
    v_perm_b32 v13, v110, v110, s42
    v_bitop3_b32 v101, v4, v13, v101 bitop3:0xca
    v_mul_hi_u32_u24 v14, 429497, v102
    v_lshrrev_b32 v12, 3, v114
    v_cos_f32 v9, v9
    v_lshlrev_b16 v13, 3, v114
    v_mad_i32_i24 v11, v14, s55, v102
    v_bitop3_b32 v12, v6, v13, v12 bitop3:0xca
    v_lshl_add_u32 v11, v11, 17, s40
    v_lshlrev_b16 v14, 8, v14
    v_lshrrev_b32 v13, 2, v114
    v_add_u32 v102, v12, v11
    v_bitop3_b32 v114, v5, v13, v14 bitop3:0xea
    v_mul_hi_u32_u24 v14, 429497, v103
    v_lshrrev_b32 v12, 3, v115
    v_cos_f32 v10, v10
    v_lshlrev_b16 v13, 3, v115
    v_mad_i32_i24 v11, v14, s55, v103
    v_bitop3_b32 v12, v6, v13, v12 bitop3:0xca
    v_lshl_add_u32 v11, v11, 17, s40
    v_lshlrev_b16 v14, 8, v14
    v_lshrrev_b32 v13, 2, v115
    v_add_u32 v103, v12, v11
    v_bitop3_b32 v115, v5, v13, v14 bitop3:0xea
    v_cvt_pk_bf16_f32 v111, v9, v10
    v_perm_b32 v12, v111, v111, s41
    v_bitop3_b32 v102, v4, v12, v102 bitop3:0xca
    v_perm_b32 v13, v111, v111, s42
    v_bitop3_b32 v103, v4, v13, v103 bitop3:0xca
    v_and_b32 v7, -4, v52
    v_lshl_add_u32 v8, v52, 2, v7
    ds_write_b32 v8, v48
    v_lshl_add_u32 v7, v7, 2, v52
    ds_write_b8 v7, v46 offset:16
    v_and_b32 v9, -4, v53
    v_lshl_add_u32 v10, v53, 2, v9
    ds_write_b32 v10, v49
    v_lshl_add_u32 v9, v9, 2, v53
    ds_write_b8_d16_hi v9, v46 offset:16
    v_and_b32 v7, -4, v54
    v_lshl_add_u32 v8, v54, 2, v7
    ds_write_b32 v8, v50
    v_lshl_add_u32 v7, v7, 2, v54
    ds_write_b8 v7, v47 offset:16
    v_and_b32 v9, -4, v55
    v_lshl_add_u32 v10, v55, 2, v9
    ds_write_b32 v10, v51
    v_lshl_add_u32 v9, v9, 2, v55
    ds_write_b8_d16_hi v9, v47 offset:16
    s_add_u32 s47, s96, 0x3000000
    s_lshr_b32 s47, s47, 1
    buffer_load_dwordx2 v[24:25], v1, s[16:19], s47 offen nt
    s_add_u32 s44, s97, 0x3400000
    s_lshr_b32 s44, s44, 1
    buffer_load_dwordx2 v[26:27], v1, s[16:19], s44 offen nt
    s_waitcnt vmcnt(6)
    v_lshlrev_b32 v7, 16, v124
    v_and_b32 v8, 0xffff0000, v124
    v_lshlrev_b32 v9, 16, v125
    v_and_b32 v10, 0xffff0000, v125
    v_mul_f32 v7, 0.15915494, v7
    v_mul_f32 v8, 0.15915494, v8
    v_mul_f32 v9, 0.15915494, v9
    v_mul_f32 v10, 0.15915494, v10
    v_mul_hi_u32_u24 v14, 429497, v116
    v_lshrrev_b32 v12, 3, v120
    v_cos_f32 v7, v7
    v_lshlrev_b16 v13, 3, v120
    v_mad_i32_i24 v11, v14, s55, v116
    v_bitop3_b32 v12, v6, v13, v12 bitop3:0xca
    v_lshl_add_u32 v11, v11, 17, s40
    v_lshlrev_b16 v14, 8, v14
    v_lshrrev_b32 v13, 2, v120
    v_add_u32 v116, v12, v11
    v_bitop3_b32 v120, v5, v13, v14 bitop3:0xea
    v_mul_hi_u32_u24 v14, 429497, v117
    v_lshrrev_b32 v12, 3, v121
    v_cos_f32 v8, v8
    v_lshlrev_b16 v13, 3, v121
    v_mad_i32_i24 v11, v14, s55, v117
    v_bitop3_b32 v12, v6, v13, v12 bitop3:0xca
    v_lshl_add_u32 v11, v11, 17, s40
    v_lshlrev_b16 v14, 8, v14
    v_lshrrev_b32 v13, 2, v121
    v_add_u32 v117, v12, v11
    v_bitop3_b32 v121, v5, v13, v14 bitop3:0xea
    v_cvt_pk_bf16_f32 v124, v7, v8
    v_perm_b32 v12, v124, v124, s41
    v_bitop3_b32 v116, v4, v12, v116 bitop3:0xca
    v_perm_b32 v13, v124, v124, s42
    v_bitop3_b32 v117, v4, v13, v117 bitop3:0xca
    v_mul_hi_u32_u24 v14, 429497, v118
    v_lshrrev_b32 v12, 3, v122
    v_cos_f32 v9, v9
    v_lshlrev_b16 v13, 3, v122
    v_mad_i32_i24 v11, v14, s55, v118
    v_bitop3_b32 v12, v6, v13, v12 bitop3:0xca
    v_lshl_add_u32 v11, v11, 17, s40
    v_lshlrev_b16 v14, 8, v14
    v_lshrrev_b32 v13, 2, v122
    v_add_u32 v118, v12, v11
    v_bitop3_b32 v122, v5, v13, v14 bitop3:0xea
    v_mul_hi_u32_u24 v14, 429497, v119
    v_lshrrev_b32 v12, 3, v123
    v_cos_f32 v10, v10
    v_lshlrev_b16 v13, 3, v123
    v_mad_i32_i24 v11, v14, s55, v119
    v_bitop3_b32 v12, v6, v13, v12 bitop3:0xca
    v_lshl_add_u32 v11, v11, 17, s40
    v_lshlrev_b16 v14, 8, v14
    v_lshrrev_b32 v13, 2, v123
    v_add_u32 v119, v12, v11
    v_bitop3_b32 v123, v5, v13, v14 bitop3:0xea
    v_cvt_pk_bf16_f32 v125, v9, v10
    v_perm_b32 v12, v125, v125, s41
    v_bitop3_b32 v118, v4, v12, v118 bitop3:0xca
    v_perm_b32 v13, v125, v125, s42
    v_bitop3_b32 v119, v4, v13, v119 bitop3:0xca
    s_setprio 1
    v_and_b32 v7, -4, v60
    v_lshl_add_u32 v8, v60, 2, v7
    ds_write_b32 v8, v56
    v_lshl_add_u32 v7, v7, 2, v60
    ds_write_b8 v7, v64 offset:16
    v_and_b32 v9, -4, v61
    v_lshl_add_u32 v10, v61, 2, v9
    ds_write_b32 v10, v57
    v_lshl_add_u32 v9, v9, 2, v61
    ds_write_b8_d16_hi v9, v64 offset:16
    v_and_b32 v7, -4, v62
    v_lshl_add_u32 v8, v62, 2, v7
    ds_write_b32 v8, v58
    v_lshl_add_u32 v7, v7, 2, v62
    ds_write_b8 v7, v65 offset:16
    v_and_b32 v9, -4, v63
    v_lshl_add_u32 v10, v63, 2, v9
    ds_write_b32 v10, v59
    v_lshl_add_u32 v9, v9, 2, v63
    ds_write_b8_d16_hi v9, v65 offset:16
    s_add_u32 s45, s97, 0x3400000
    v_lshlrev_b32 v36, 1, v1
    buffer_load_dwordx4 v[36:39], v36, s[8:11], s45 offen nt
    s_add_u32 s46, s97, 0x3400000
    v_lshlrev_b32 v40, 1, v1
    buffer_load_dwordx4 v[40:43], v40, s[12:15], s46 offen nt
    v_and_b32 v7, -4, v72
    v_lshl_add_u32 v8, v72, 2, v7
    ds_write_b32 v8, v68
    v_lshl_add_u32 v7, v7, 2, v72
    ds_write_b8 v7, v66 offset:16
    v_and_b32 v9, -4, v73
    v_lshl_add_u32 v10, v73, 2, v9
    ds_write_b32 v10, v69
    v_lshl_add_u32 v9, v9, 2, v73
    ds_write_b8_d16_hi v9, v66 offset:16
    v_and_b32 v7, -4, v74
    v_lshl_add_u32 v8, v74, 2, v7
    ds_write_b32 v8, v70
    v_lshl_add_u32 v7, v7, 2, v74
    ds_write_b8 v7, v67 offset:16
    v_and_b32 v9, -4, v75
    v_lshl_add_u32 v10, v75, 2, v9
    ds_write_b32 v10, v71
    v_lshl_add_u32 v9, v9, 2, v75
    ds_write_b8_d16_hi v9, v67 offset:16
    s_add_u32 s47, s98, 0x3800000
    v_lshlrev_b32 v48, 1, v1
    buffer_load_dwordx4 v[48:51], v48, s[8:11], s47 offen nt
    s_waitcnt vmcnt(7)
    v_lshlrev_b32 v7, 16, v126
    v_and_b32 v8, 0xffff0000, v126
    v_lshlrev_b32 v9, 16, v127
    v_and_b32 v10, 0xffff0000, v127
    v_mul_f32 v7, 0.15915494, v7
    v_mul_f32 v8, 0.15915494, v8
    v_mul_f32 v9, 0.15915494, v9
    v_mul_f32 v10, 0.15915494, v10
    v_mul_hi_u32_u24 v14, 429497, v16
    v_lshrrev_b32 v12, 3, v20
    v_cos_f32 v7, v7
    v_lshlrev_b16 v13, 3, v20
    v_mad_i32_i24 v11, v14, s55, v16
    v_bitop3_b32 v12, v6, v13, v12 bitop3:0xca
    v_lshl_add_u32 v11, v11, 17, s40
    v_lshlrev_b16 v14, 8, v14
    v_lshrrev_b32 v13, 2, v20
    v_add_u32 v16, v12, v11
    v_bitop3_b32 v20, v5, v13, v14 bitop3:0xea
    v_mul_hi_u32_u24 v14, 429497, v17
    v_lshrrev_b32 v12, 3, v21
    v_cos_f32 v8, v8
    v_lshlrev_b16 v13, 3, v21
    v_mad_i32_i24 v11, v14, s55, v17
    v_bitop3_b32 v12, v6, v13, v12 bitop3:0xca
    v_lshl_add_u32 v11, v11, 17, s40
    v_lshlrev_b16 v14, 8, v14
    v_lshrrev_b32 v13, 2, v21
    v_add_u32 v17, v12, v11
    v_bitop3_b32 v21, v5, v13, v14 bitop3:0xea
    v_cvt_pk_bf16_f32 v126, v7, v8
    v_perm_b32 v12, v126, v126, s41
    v_bitop3_b32 v16, v4, v12, v16 bitop3:0xca
    v_perm_b32 v13, v126, v126, s42
    v_bitop3_b32 v17, v4, v13, v17 bitop3:0xca
    v_mul_hi_u32_u24 v14, 429497, v18
    v_lshrrev_b32 v12, 3, v22
    v_cos_f32 v9, v9
    v_lshlrev_b16 v13, 3, v22
    v_mad_i32_i24 v11, v14, s55, v18
    v_bitop3_b32 v12, v6, v13, v12 bitop3:0xca
    v_lshl_add_u32 v11, v11, 17, s40
    v_lshlrev_b16 v14, 8, v14
    v_lshrrev_b32 v13, 2, v22
    v_add_u32 v18, v12, v11
    v_bitop3_b32 v22, v5, v13, v14 bitop3:0xea
    v_mul_hi_u32_u24 v14, 429497, v19
    v_lshrrev_b32 v12, 3, v23
    v_cos_f32 v10, v10
    v_lshlrev_b16 v13, 3, v23
    v_mad_i32_i24 v11, v14, s55, v19
    v_bitop3_b32 v12, v6, v13, v12 bitop3:0xca
    v_lshl_add_u32 v11, v11, 17, s40
    v_lshlrev_b16 v14, 8, v14
    v_lshrrev_b32 v13, 2, v23
    v_add_u32 v19, v12, v11
    v_bitop3_b32 v23, v5, v13, v14 bitop3:0xea
    v_cvt_pk_bf16_f32 v127, v9, v10
    v_perm_b32 v12, v127, v127, s41
    v_bitop3_b32 v18, v4, v12, v18 bitop3:0xca
    v_perm_b32 v13, v127, v127, s42
    v_bitop3_b32 v19, v4, v13, v19 bitop3:0xca
    s_setprio 0
    v_and_b32 v7, -4, v80
    v_lshl_add_u32 v8, v80, 2, v7
    ds_write_b32 v8, v76
    v_lshl_add_u32 v7, v7, 2, v80
    ds_write_b8 v7, v84 offset:16
    v_and_b32 v9, -4, v81
    v_lshl_add_u32 v10, v81, 2, v9
    ds_write_b32 v10, v77
    v_lshl_add_u32 v9, v9, 2, v81
    ds_write_b8_d16_hi v9, v84 offset:16
    v_and_b32 v7, -4, v82
    v_lshl_add_u32 v8, v82, 2, v7
    ds_write_b32 v8, v78
    v_lshl_add_u32 v7, v7, 2, v82
    ds_write_b8 v7, v85 offset:16
    v_and_b32 v9, -4, v83
    v_lshl_add_u32 v10, v83, 2, v9
    ds_write_b32 v10, v79
    v_lshl_add_u32 v9, v9, 2, v83
    ds_write_b8_d16_hi v9, v85 offset:16
    s_add_u32 s44, s98, 0x3800000
    v_lshlrev_b32 v52, 1, v1
    buffer_load_dwordx4 v[52:55], v52, s[12:15], s44 offen nt
    s_waitcnt vmcnt(4)
    v_lshlrev_b32 v7, 16, v24
    v_and_b32 v8, 0xffff0000, v24
    v_lshlrev_b32 v9, 16, v25
    v_and_b32 v10, 0xffff0000, v25
    v_mul_f32 v7, 0.15915494, v7
    v_mul_f32 v8, 0.15915494, v8
    v_mul_f32 v9, 0.15915494, v9
    v_mul_f32 v10, 0.15915494, v10
    v_mul_hi_u32_u24 v14, 429497, v28
    v_lshrrev_b32 v12, 3, v32
    v_cos_f32 v7, v7
    v_lshlrev_b16 v13, 3, v32
    v_mad_i32_i24 v11, v14, s55, v28
    v_bitop3_b32 v12, v6, v13, v12 bitop3:0xca
    v_lshl_add_u32 v11, v11, 17, s40
    v_lshlrev_b16 v14, 8, v14
    v_lshrrev_b32 v13, 2, v32
    v_add_u32 v28, v12, v11
    v_bitop3_b32 v32, v5, v13, v14 bitop3:0xea
    v_mul_hi_u32_u24 v14, 429497, v29
    v_lshrrev_b32 v12, 3, v33
    v_cos_f32 v8, v8
    v_lshlrev_b16 v13, 3, v33
    v_mad_i32_i24 v11, v14, s55, v29
    v_bitop3_b32 v12, v6, v13, v12 bitop3:0xca
    v_lshl_add_u32 v11, v11, 17, s40
    v_lshlrev_b16 v14, 8, v14
    v_lshrrev_b32 v13, 2, v33
    v_add_u32 v29, v12, v11
    v_bitop3_b32 v33, v5, v13, v14 bitop3:0xea
    v_cvt_pk_bf16_f32 v24, v7, v8
    v_perm_b32 v12, v24, v24, s41
    v_bitop3_b32 v28, v4, v12, v28 bitop3:0xca
    v_perm_b32 v13, v24, v24, s42
    v_bitop3_b32 v29, v4, v13, v29 bitop3:0xca
    v_mul_hi_u32_u24 v14, 429497, v30
    v_lshrrev_b32 v12, 3, v34
    v_cos_f32 v9, v9
    v_lshlrev_b16 v13, 3, v34
    v_mad_i32_i24 v11, v14, s55, v30
    v_bitop3_b32 v12, v6, v13, v12 bitop3:0xca
    v_lshl_add_u32 v11, v11, 17, s40
    v_lshlrev_b16 v14, 8, v14
    v_lshrrev_b32 v13, 2, v34
    v_add_u32 v30, v12, v11
    v_bitop3_b32 v34, v5, v13, v14 bitop3:0xea
    v_mul_hi_u32_u24 v14, 429497, v31
    v_lshrrev_b32 v12, 3, v35
    v_cos_f32 v10, v10
    v_lshlrev_b16 v13, 3, v35
    v_mad_i32_i24 v11, v14, s55, v31
    v_bitop3_b32 v12, v6, v13, v12 bitop3:0xca
    v_lshl_add_u32 v11, v11, 17, s40
    v_lshlrev_b16 v14, 8, v14
    v_lshrrev_b32 v13, 2, v35
    v_add_u32 v31, v12, v11
    v_bitop3_b32 v35, v5, v13, v14 bitop3:0xea
    v_cvt_pk_bf16_f32 v25, v9, v10
    v_perm_b32 v12, v25, v25, s41
    v_bitop3_b32 v30, v4, v12, v30 bitop3:0xca
    v_perm_b32 v13, v25, v25, s42
    v_bitop3_b32 v31, v4, v13, v31 bitop3:0xca
    v_and_b32 v7, -4, v92
    v_lshl_add_u32 v8, v92, 2, v7
    ds_write_b32 v8, v88
    v_lshl_add_u32 v7, v7, 2, v92
    ds_write_b8 v7, v86 offset:16
    v_and_b32 v9, -4, v93
    v_lshl_add_u32 v10, v93, 2, v9
    ds_write_b32 v10, v89
    v_lshl_add_u32 v9, v9, 2, v93
    ds_write_b8_d16_hi v9, v86 offset:16
    v_and_b32 v7, -4, v94
    v_lshl_add_u32 v8, v94, 2, v7
    ds_write_b32 v8, v90
    v_lshl_add_u32 v7, v7, 2, v94
    ds_write_b8 v7, v87 offset:16
    v_and_b32 v9, -4, v95
    v_lshl_add_u32 v10, v95, 2, v9
    ds_write_b32 v10, v91
    v_lshl_add_u32 v9, v9, 2, v95
    ds_write_b8_d16_hi v9, v87 offset:16
    s_add_u32 s45, s98, 0x3800000
    s_lshr_b32 s45, s45, 1
    buffer_load_dwordx2 v[44:45], v1, s[16:19], s45 offen nt
    s_add_u32 s46, s99, 0x3c00000
    s_lshr_b32 s46, s46, 1
    buffer_load_dwordx2 v[46:47], v1, s[16:19], s46 offen nt
    s_waitcnt vmcnt(4)
    v_lshlrev_b32 v7, 16, v26
    v_and_b32 v8, 0xffff0000, v26
    v_lshlrev_b32 v9, 16, v27
    v_and_b32 v10, 0xffff0000, v27
    v_mul_f32 v7, 0.15915494, v7
    v_mul_f32 v8, 0.15915494, v8
    v_mul_f32 v9, 0.15915494, v9
    v_mul_f32 v10, 0.15915494, v10
    v_mul_hi_u32_u24 v14, 429497, v36
    v_lshrrev_b32 v12, 3, v40
    v_cos_f32 v7, v7
    v_lshlrev_b16 v13, 3, v40
    v_mad_i32_i24 v11, v14, s55, v36
    v_bitop3_b32 v12, v6, v13, v12 bitop3:0xca
    v_lshl_add_u32 v11, v11, 17, s40
    v_lshlrev_b16 v14, 8, v14
    v_lshrrev_b32 v13, 2, v40
    v_add_u32 v36, v12, v11
    v_bitop3_b32 v40, v5, v13, v14 bitop3:0xea
    v_mul_hi_u32_u24 v14, 429497, v37
    v_lshrrev_b32 v12, 3, v41
    v_cos_f32 v8, v8
    v_lshlrev_b16 v13, 3, v41
    v_mad_i32_i24 v11, v14, s55, v37
    v_bitop3_b32 v12, v6, v13, v12 bitop3:0xca
    v_lshl_add_u32 v11, v11, 17, s40
    v_lshlrev_b16 v14, 8, v14
    v_lshrrev_b32 v13, 2, v41
    v_add_u32 v37, v12, v11
    v_bitop3_b32 v41, v5, v13, v14 bitop3:0xea
    v_cvt_pk_bf16_f32 v26, v7, v8
    v_perm_b32 v12, v26, v26, s41
    v_bitop3_b32 v36, v4, v12, v36 bitop3:0xca
    v_perm_b32 v13, v26, v26, s42
    v_bitop3_b32 v37, v4, v13, v37 bitop3:0xca
    v_mul_hi_u32_u24 v14, 429497, v38
    v_lshrrev_b32 v12, 3, v42
    v_cos_f32 v9, v9
    v_lshlrev_b16 v13, 3, v42
    v_mad_i32_i24 v11, v14, s55, v38
    v_bitop3_b32 v12, v6, v13, v12 bitop3:0xca
    v_lshl_add_u32 v11, v11, 17, s40
    v_lshlrev_b16 v14, 8, v14
    v_lshrrev_b32 v13, 2, v42
    v_add_u32 v38, v12, v11
    v_bitop3_b32 v42, v5, v13, v14 bitop3:0xea
    v_mul_hi_u32_u24 v14, 429497, v39
    v_lshrrev_b32 v12, 3, v43
    v_cos_f32 v10, v10
    v_lshlrev_b16 v13, 3, v43
    v_mad_i32_i24 v11, v14, s55, v39
    v_bitop3_b32 v12, v6, v13, v12 bitop3:0xca
    v_lshl_add_u32 v11, v11, 17, s40
    v_lshlrev_b16 v14, 8, v14
    v_lshrrev_b32 v13, 2, v43
    v_add_u32 v39, v12, v11
    v_bitop3_b32 v43, v5, v13, v14 bitop3:0xea
    v_cvt_pk_bf16_f32 v27, v9, v10
    v_perm_b32 v12, v27, v27, s41
    v_bitop3_b32 v38, v4, v12, v38 bitop3:0xca
    v_perm_b32 v13, v27, v27, s42
    v_bitop3_b32 v39, v4, v13, v39 bitop3:0xca
    v_add_u32 v7, s72, v0
    v_add_u32 v12, s73, v0
    v_add_u32 v13, s85, v0
    v_add_u32 v14, s91, v0
    v_add_u32 v15, s93, v0
    s_min_i32 s3, s72, s73
    s_min_i32 s3, s3, s85
    s_min_i32 s3, s3, s91
    s_min_i32 s3, s3, s93
    v_add_u32 v3, s3, v0
    v_mov_b32 v8, 0
    v_mov_b32 v9, 0
    v_mov_b32 v10, 0
    v_mov_b32 v11, 0
    s_waitcnt lgkmcnt(0)
    s_barrier
    ds_read_b128 v[56:59], v7 offset:0
    ds_read_b128 v[60:63], v12 offset:0
    ds_read_b128 v[68:71], v13 offset:0
    ds_read_b128 v[72:75], v14 offset:0
    ds_read_b128 v[64:67], v15 offset:0
    ds_write_b128 v3, v[8:11]
    ds_read_b128 v[76:79], v7 offset:16384
    ds_read_b128 v[80:83], v12 offset:16384
    ds_read_b128 v[88:91], v13 offset:16384
    ds_read_b128 v[92:95], v14 offset:16384
    ds_read_b128 v[84:87], v15 offset:16384
    s_waitcnt lgkmcnt(0)
    s_barrier
    s_setprio 3
    s_add_u32 s47, s35, 0x4000
    s_add_u32 s47, s47, s72
    buffer_store_dwordx4 v[56:59], v0, s[20:23], s47 offen sc1
    s_add_u32 s44, s99, 0x3c00000
    s_nop 0
    v_lshlrev_b32 v56, 1, v1
    buffer_load_dwordx4 v[56:59], v56, s[8:11], s44 offen nt
    s_add_u32 s45, s35, 0x4000
    s_add_u32 s45, s45, s73
    buffer_store_dwordx4 v[60:63], v0, s[20:23], s45 offen sc1
    s_add_u32 s46, s99, 0x3c00000
    s_nop 0
    v_lshlrev_b32 v60, 1, v1
    buffer_load_dwordx4 v[60:63], v60, s[12:15], s46 offen nt
    ds_add_u32 v104, v2
    ds_add_u32 v105, v2
    ds_add_u32 v106, v2
    ds_add_u32 v107, v2
    ds_add_u32 v112, v2
    ds_add_u32 v113, v2
    ds_add_u32 v114, v2
    ds_add_u32 v115, v2
    s_setprio 2
    ds_add_u32 v120, v2
    ds_add_u32 v121, v2
    ds_add_u32 v122, v2
    ds_add_u32 v123, v2
    ds_add_u32 v20, v2
    ds_add_u32 v21, v2
    ds_add_u32 v22, v2
    ds_add_u32 v23, v2
    s_setprio 1
    s_add_u32 s47, s35, 0x4000
    s_add_u32 s47, s47, s85
    buffer_store_dwordx4 v[68:71], v0, s[20:23], s47 offen sc1
    s_add_u32 s44, s96, 0x4000000
    s_nop 0
    v_lshlrev_b32 v68, 1, v1
    buffer_load_dwordx4 v[68:71], v68, s[8:11], s44 offen nt
    ds_add_u32 v32, v2
    ds_add_u32 v33, v2
    ds_add_u32 v34, v2
    ds_add_u32 v35, v2
    ds_add_u32 v40, v2
    ds_add_u32 v41, v2
    ds_add_u32 v42, v2
    ds_add_u32 v43, v2
    s_setprio 0
    s_waitcnt vmcnt(6)
    v_lshlrev_b32 v7, 16, v44
    v_and_b32 v8, 0xffff0000, v44
    v_lshlrev_b32 v9, 16, v45
    v_and_b32 v10, 0xffff0000, v45
    v_mul_f32 v7, 0.15915494, v7
    v_mul_f32 v8, 0.15915494, v8
    v_mul_f32 v9, 0.15915494, v9
    v_mul_f32 v10, 0.15915494, v10
    v_mul_hi_u32_u24 v14, 429497, v48
    v_lshrrev_b32 v12, 3, v52
    v_cos_f32 v7, v7
    v_lshlrev_b16 v13, 3, v52
    v_mad_i32_i24 v11, v14, s55, v48
    v_bitop3_b32 v12, v6, v13, v12 bitop3:0xca
    v_lshl_add_u32 v11, v11, 17, s40
    v_lshlrev_b16 v14, 8, v14
    v_lshrrev_b32 v13, 2, v52
    v_add_u32 v48, v12, v11
    v_bitop3_b32 v52, v5, v13, v14 bitop3:0xea
    ds_add_u32 v52, v2
    v_mul_hi_u32_u24 v14, 429497, v49
    v_lshrrev_b32 v12, 3, v53
    v_cos_f32 v8, v8
    v_lshlrev_b16 v13, 3, v53
    v_mad_i32_i24 v11, v14, s55, v49
    v_bitop3_b32 v12, v6, v13, v12 bitop3:0xca
    v_lshl_add_u32 v11, v11, 17, s40
    v_lshlrev_b16 v14, 8, v14
    v_lshrrev_b32 v13, 2, v53
    v_add_u32 v49, v12, v11
    v_bitop3_b32 v53, v5, v13, v14 bitop3:0xea
    ds_add_u32 v53, v2
    v_cvt_pk_bf16_f32 v44, v7, v8
    v_perm_b32 v12, v44, v44, s41
    v_bitop3_b32 v48, v4, v12, v48 bitop3:0xca
    v_perm_b32 v13, v44, v44, s42
    v_bitop3_b32 v49, v4, v13, v49 bitop3:0xca
    v_mul_hi_u32_u24 v14, 429497, v50
    v_lshrrev_b32 v12, 3, v54
    v_cos_f32 v9, v9
    v_lshlrev_b16 v13, 3, v54
    v_mad_i32_i24 v11, v14, s55, v50
    v_bitop3_b32 v12, v6, v13, v12 bitop3:0xca
    v_lshl_add_u32 v11, v11, 17, s40
    v_lshlrev_b16 v14, 8, v14
    v_lshrrev_b32 v13, 2, v54
    v_add_u32 v50, v12, v11
    v_bitop3_b32 v54, v5, v13, v14 bitop3:0xea
    ds_add_u32 v54, v2
    v_mul_hi_u32_u24 v14, 429497, v51
    v_lshrrev_b32 v12, 3, v55
    v_cos_f32 v10, v10
    v_lshlrev_b16 v13, 3, v55
    v_mad_i32_i24 v11, v14, s55, v51
    v_bitop3_b32 v12, v6, v13, v12 bitop3:0xca
    v_lshl_add_u32 v11, v11, 17, s40
    v_lshlrev_b16 v14, 8, v14
    v_lshrrev_b32 v13, 2, v55
    v_add_u32 v51, v12, v11
    v_bitop3_b32 v55, v5, v13, v14 bitop3:0xea
    ds_add_u32 v55, v2
    v_cvt_pk_bf16_f32 v45, v9, v10
    v_perm_b32 v12, v45, v45, s41
    v_bitop3_b32 v50, v4, v12, v50 bitop3:0xca
    v_perm_b32 v13, v45, v45, s42
    v_bitop3_b32 v51, v4, v13, v51 bitop3:0xca
    s_waitcnt vmcnt(2)
    v_lshlrev_b32 v7, 16, v46
    v_and_b32 v8, 0xffff0000, v46
    v_lshlrev_b32 v9, 16, v47
    v_and_b32 v10, 0xffff0000, v47
    v_mul_f32 v7, 0.15915494, v7
    v_mul_f32 v8, 0.15915494, v8
    v_mul_f32 v9, 0.15915494, v9
    v_mul_f32 v10, 0.15915494, v10
    v_mul_hi_u32_u24 v14, 429497, v56
    v_lshrrev_b32 v12, 3, v60
    v_cos_f32 v7, v7
    v_lshlrev_b16 v13, 3, v60
    v_mad_i32_i24 v11, v14, s55, v56
    v_bitop3_b32 v12, v6, v13, v12 bitop3:0xca
    v_lshl_add_u32 v11, v11, 17, s40
    v_lshlrev_b16 v14, 8, v14
    v_lshrrev_b32 v13, 2, v60
    v_add_u32 v56, v12, v11
    v_bitop3_b32 v60, v5, v13, v14 bitop3:0xea
    ds_add_u32 v60, v2
    v_mul_hi_u32_u24 v14, 429497, v57
    v_lshrrev_b32 v12, 3, v61
    v_cos_f32 v8, v8
    v_lshlrev_b16 v13, 3, v61
    v_mad_i32_i24 v11, v14, s55, v57
    v_bitop3_b32 v12, v6, v13, v12 bitop3:0xca
    v_lshl_add_u32 v11, v11, 17, s40
    v_lshlrev_b16 v14, 8, v14
    v_lshrrev_b32 v13, 2, v61
    v_add_u32 v57, v12, v11
    v_bitop3_b32 v61, v5, v13, v14 bitop3:0xea
    ds_add_u32 v61, v2
    v_cvt_pk_bf16_f32 v46, v7, v8
    v_perm_b32 v12, v46, v46, s41
    v_bitop3_b32 v56, v4, v12, v56 bitop3:0xca
    v_perm_b32 v13, v46, v46, s42
    v_bitop3_b32 v57, v4, v13, v57 bitop3:0xca
    v_mul_hi_u32_u24 v14, 429497, v58
    v_lshrrev_b32 v12, 3, v62
    v_cos_f32 v9, v9
    v_lshlrev_b16 v13, 3, v62
    v_mad_i32_i24 v11, v14, s55, v58
    v_bitop3_b32 v12, v6, v13, v12 bitop3:0xca
    v_lshl_add_u32 v11, v11, 17, s40
    v_lshlrev_b16 v14, 8, v14
    v_lshrrev_b32 v13, 2, v62
    v_add_u32 v58, v12, v11
    v_bitop3_b32 v62, v5, v13, v14 bitop3:0xea
    ds_add_u32 v62, v2
    v_mul_hi_u32_u24 v14, 429497, v59
    v_lshrrev_b32 v12, 3, v63
    v_cos_f32 v10, v10
    v_lshlrev_b16 v13, 3, v63
    v_mad_i32_i24 v11, v14, s55, v59
    v_bitop3_b32 v12, v6, v13, v12 bitop3:0xca
    v_lshl_add_u32 v11, v11, 17, s40
    v_lshlrev_b16 v14, 8, v14
    v_lshrrev_b32 v13, 2, v63
    v_add_u32 v59, v12, v11
    v_bitop3_b32 v63, v5, v13, v14 bitop3:0xea
    ds_add_u32 v63, v2
    v_cvt_pk_bf16_f32 v47, v9, v10
    v_perm_b32 v12, v47, v47, s41
    v_bitop3_b32 v58, v4, v12, v58 bitop3:0xca
    v_perm_b32 v13, v47, v47, s42
    v_bitop3_b32 v59, v4, v13, v59 bitop3:0xca
    v_lshrrev_b32 v8, 2, v0
    v_and_b32 v7, 0x3c00, v0
    v_bitop3_b32 v7, v5, v8, v7 bitop3:0xea
    s_waitcnt lgkmcnt(0)
    s_barrier
    ds_read2st64_b32 v[8:9], v7 offset0:0 offset1:1
    ds_read2st64_b32 v[10:11], v7 offset0:2 offset1:3
    s_add_u32 s45, s35, 0x4000
    s_add_u32 s45, s45, s91
    buffer_store_dwordx4 v[72:75], v0, s[20:23], s45 offen sc1
    s_add_u32 s46, s96, 0x4000000
    s_nop 0
    v_lshlrev_b32 v72, 1, v1
    buffer_load_dwordx4 v[72:75], v72, s[12:15], s46 offen nt
    s_waitcnt lgkmcnt(0)
    v_lshl_or_b32 v12, v9, 16, v8
    v_lshl_or_b32 v13, v11, 16, v10
    v_mov_b32 v14, v12
    v_mov_b32 v15, v13
    s_nop 0
    v_add_u32_dpp v14, v14, v14 row_shr:1 row_mask:0xf bank_mask:0xf bound_ctrl:1
    v_add_u32_dpp v15, v15, v15 row_shr:1 row_mask:0xf bank_mask:0xf bound_ctrl:1
    s_nop 0
    v_add_u32_dpp v14, v14, v14 row_shr:2 row_mask:0xf bank_mask:0xf bound_ctrl:1
    v_add_u32_dpp v15, v15, v15 row_shr:2 row_mask:0xf bank_mask:0xf bound_ctrl:1
    s_nop 0
    v_add_u32_dpp v14, v14, v14 row_shr:4 row_mask:0xf bank_mask:0xf bound_ctrl:1
    v_add_u32_dpp v15, v15, v15 row_shr:4 row_mask:0xf bank_mask:0xf bound_ctrl:1
    s_nop 0
    v_add_u32_dpp v14, v14, v14 row_shr:8 row_mask:0xf bank_mask:0xf bound_ctrl:1
    v_add_u32_dpp v15, v15, v15 row_shr:8 row_mask:0xf bank_mask:0xf bound_ctrl:1
    s_nop 0
    v_add_u32_dpp v14, v14, v14 row_bcast:15 row_mask:0xa bank_mask:0xf
    v_add_u32_dpp v15, v15, v15 row_bcast:15 row_mask:0xa bank_mask:0xf
    s_nop 0
    v_add_u32_dpp v14, v14, v14 row_bcast:31 row_mask:0xc bank_mask:0xf
    v_add_u32_dpp v15, v15, v15 row_bcast:31 row_mask:0xc bank_mask:0xf
    v_readlane_b32 s48, v14, 63
    v_readlane_b32 s49, v15, 63
    s_lshl_b32 s54, s32, 2
    v_mov_b32 v8, s54
    s_and_b32 s50, s48, 0xffff
    s_lshr_b32 s51, s48, 16
    s_and_b32 s52, s49, 0xffff
    s_lshr_b32 s53, s49, 16
    s_add_u32 s51, s51, s50
    s_add_u32 s52, s52, s51
    s_add_u32 s53, s53, s52
    v_mov_b32 v9, s53
    s_mov_b64 exec, 1
    ds_write_b32 v8, v9 offset:16384
    s_mov_b64 exec, -1
    v_and_b32 v8, 60, v7
    s_waitcnt lgkmcnt(0)
    s_barrier
    ds_read_b32 v9, v8 offset:16384
    s_waitcnt lgkmcnt(0)
    v_add_u32_dpp v9, v9, v9 row_shr:1 row_mask:0xf bank_mask:0xf bound_ctrl:1
    s_nop 1
    v_add_u32_dpp v9, v9, v9 row_shr:2 row_mask:0xf bank_mask:0xf bound_ctrl:1
    s_nop 1
    v_add_u32_dpp v9, v9, v9 row_shr:4 row_mask:0xf bank_mask:0xf bound_ctrl:1
    s_nop 1
    v_add_u32_dpp v9, v9, v9 row_shr:8 row_mask:0xf bank_mask:0xf bound_ctrl:1
    s_nop 0
    v_readlane_b32 s54, v9, s32
    s_sub_u32 s54, s54, s53
    s_add_u32 s50, s50, s54
    s_add_u32 s51, s51, s54
    s_add_u32 s52, s52, s54
    s_pack_ll_b32_b16 s48, s54, s50
    s_pack_ll_b32_b16 s49, s51, s52
    v_add_u32 v14, s48, v14
    v_add_u32 v15, s49, v15
    v_sub_u32 v12, v14, v12
    v_sub_u32 v13, v15, v13
    v_and_b32 v8, 0xffff, v12
    v_lshrrev_b32 v9, 16, v12
    v_and_b32 v10, 0xffff, v13
    v_lshrrev_b32 v11, 16, v13
    ds_write2st64_b32 v7, v8, v9 offset0:0 offset1:1
    ds_write2st64_b32 v7, v10, v11 offset0:2 offset1:3
    v_and_b32 v8, 0x3f0, v0
    v_lshl_add_u32 v8, v8, 1, s36
    ds_write_b64 v8, v[12:13] offset:20480
    s_bitset0_b64 exec, 63
    s_not_b64 exec, exec
    ds_write_b64 v8, v[14:15] offset:20512
    s_mov_b64 exec, -1
    s_waitcnt lgkmcnt(0)
    s_barrier
    s_setprio 3
    ds_add_rtn_u32 v104, v104, v2
    ds_add_rtn_u32 v105, v105, v2
    ds_add_rtn_u32 v106, v106, v2
    ds_add_rtn_u32 v107, v107, v2
    ds_read_b128 v[12:15], v0 offset:20480
    v_cmp_gt_u32 vcc, 8448, v0
    s_add_u32 s47, s35, 0x4000
    s_add_u32 s47, s47, s93
    buffer_store_dwordx4 v[64:67], v0, s[20:23], s47 offen sc1
    s_add_u32 s44, s96, 0x4000000
    s_lshr_b32 s44, s44, 1
    buffer_load_dwordx2 v[64:65], v1, s[16:19], s44 offen nt
    s_add_u32 s45, s97, 0x4400000
    s_lshr_b32 s45, s45, 1
    buffer_load_dwordx2 v[66:67], v1, s[16:19], s45 offen nt
    ds_add_rtn_u32 v112, v112, v2
    ds_add_rtn_u32 v113, v113, v2
    ds_add_rtn_u32 v114, v114, v2
    ds_add_rtn_u32 v115, v115, v2
    s_setprio 2
    ds_add_rtn_u32 v120, v120, v2
    ds_add_rtn_u32 v121, v121, v2
    ds_add_rtn_u32 v122, v122, v2
    ds_add_rtn_u32 v123, v123, v2
    s_waitcnt lgkmcnt(8)
    s_cbranch_vccz L1_p2
    s_add_u32 s46, s35, 0x2a40000
    s_mov_b64 exec, vcc
    buffer_store_dwordx4 v[12:15], v0, s[24:27], s46 offen sc1
    s_mov_b64 exec, -1
L1_p2:
    s_add_u32 s47, s35, 0x8000
    s_add_u32 s47, s47, s72
    buffer_store_dwordx4 v[76:79], v0, s[20:23], s47 offen sc1
    s_add_u32 s44, s97, 0x4400000
    s_nop 0
    v_lshlrev_b32 v76, 1, v1
    buffer_load_dwordx4 v[76:79], v76, s[8:11], s44 offen nt
    ds_add_rtn_u32 v20, v20, v2
    ds_add_rtn_u32 v21, v21, v2
    ds_add_rtn_u32 v22, v22, v2
    ds_add_rtn_u32 v23, v23, v2
    s_setprio 1
    ds_add_rtn_u32 v32, v32, v2
    ds_add_rtn_u32 v33, v33, v2
    ds_add_rtn_u32 v34, v34, v2
    ds_add_rtn_u32 v35, v35, v2
    ds_add_rtn_u32 v40, v40, v2
    ds_add_rtn_u32 v41, v41, v2
    ds_add_rtn_u32 v42, v42, v2
    ds_add_rtn_u32 v43, v43, v2
    s_add_u32 s45, s35, 0x8000
    s_add_u32 s45, s45, s73
    buffer_store_dwordx4 v[80:83], v0, s[20:23], s45 offen sc1
    s_add_u32 s46, s97, 0x4400000
    s_nop 0
    v_lshlrev_b32 v80, 1, v1
    buffer_load_dwordx4 v[80:83], v80, s[12:15], s46 offen nt
    s_setprio 0
    ds_add_rtn_u32 v52, v52, v2
    ds_add_rtn_u32 v53, v53, v2
    ds_add_rtn_u32 v54, v54, v2
    ds_add_rtn_u32 v55, v55, v2
    ds_add_rtn_u32 v60, v60, v2
    ds_add_rtn_u32 v61, v61, v2
    ds_add_rtn_u32 v62, v62, v2
    ds_add_rtn_u32 v63, v63, v2
    s_waitcnt lgkmcnt(0)
    s_barrier
    s_setprio 3
    v_and_b32 v7, -4, v104
    v_lshl_add_u32 v8, v104, 2, v7
    ds_write_b32 v8, v96
    v_lshl_add_u32 v7, v7, 2, v104
    ds_write_b8 v7, v108 offset:16
    v_and_b32 v9, -4, v105
    v_lshl_add_u32 v10, v105, 2, v9
    ds_write_b32 v10, v97
    v_lshl_add_u32 v9, v9, 2, v105
    ds_write_b8_d16_hi v9, v108 offset:16
    v_and_b32 v7, -4, v106
    v_lshl_add_u32 v8, v106, 2, v7
    ds_write_b32 v8, v98
    v_lshl_add_u32 v7, v7, 2, v106
    ds_write_b8 v7, v109 offset:16
    v_and_b32 v9, -4, v107
    v_lshl_add_u32 v10, v107, 2, v9
    ds_write_b32 v10, v99
    v_lshl_add_u32 v9, v9, 2, v107
    ds_write_b8_d16_hi v9, v109 offset:16
    s_add_u32 s47, s35, 0x8000
    s_add_u32 s47, s47, s85
    buffer_store_dwordx4 v[88:91], v0, s[20:23], s47 offen sc1
    s_add_u32 s44, s98, 0x4800000
    v_lshlrev_b32 v96, 1, v1
    buffer_load_dwordx4 v[96:99], v96, s[8:11], s44 offen nt
    s_add_u32 s45, s98, 0x4800000
    v_lshlrev_b32 v104, 1, v1
    buffer_load_dwordx4 v[104:107], v104, s[12:15], s45 offen nt
    v_and_b32 v7, -4, v112
    v_lshl_add_u32 v8, v112, 2, v7
    ds_write_b32 v8, v100
    v_lshl_add_u32 v7, v7, 2, v112
    ds_write_b8 v7, v110 offset:16
    v_and_b32 v9, -4, v113
    v_lshl_add_u32 v10, v113, 2, v9
    ds_write_b32 v10, v101
    v_lshl_add_u32 v9, v9, 2, v113
    ds_write_b8_d16_hi v9, v110 offset:16
    v_and_b32 v7, -4, v114
    v_lshl_add_u32 v8, v114, 2, v7
    ds_write_b32 v8, v102
    v_lshl_add_u32 v7, v7, 2, v114
    ds_write_b8 v7, v111 offset:16
    v_and_b32 v9, -4, v115
    v_lshl_add_u32 v10, v115, 2, v9
    ds_write_b32 v10, v103
    v_lshl_add_u32 v9, v9, 2, v115
    ds_write_b8_d16_hi v9, v111 offset:16
    s_add_u32 s46, s98, 0x4800000
    s_lshr_b32 s46, s46, 1
    buffer_load_dwordx2 v[88:89], v1, s[16:19], s46 offen nt
    s_add_u32 s47, s99, 0x4c00000
    s_lshr_b32 s47, s47, 1
    buffer_load_dwordx2 v[90:91], v1, s[16:19], s47 offen nt
    s_add_u32 s44, s99, 0x4c00000
    v_lshlrev_b32 v100, 1, v1
    buffer_load_dwordx4 v[100:103], v100, s[8:11], s44 offen nt
    s_waitcnt vmcnt(10)
    v_lshlrev_b32 v7, 16, v64
    v_and_b32 v8, 0xffff0000, v64
    v_lshlrev_b32 v9, 16, v65
    v_and_b32 v10, 0xffff0000, v65
    v_mul_f32 v7, 0.15915494, v7
    v_mul_f32 v8, 0.15915494, v8
    v_mul_f32 v9, 0.15915494, v9
    v_mul_f32 v10, 0.15915494, v10
    v_mul_hi_u32_u24 v14, 429497, v68
    v_lshrrev_b32 v12, 3, v72
    v_cos_f32 v7, v7
    v_lshlrev_b16 v13, 3, v72
    v_mad_i32_i24 v11, v14, s55, v68
    v_bitop3_b32 v12, v6, v13, v12 bitop3:0xca
    v_lshl_add_u32 v11, v11, 17, s40
    v_lshlrev_b16 v14, 8, v14
    v_lshrrev_b32 v13, 2, v72
    v_add_u32 v68, v12, v11
    v_bitop3_b32 v72, v5, v13, v14 bitop3:0xea
    v_mul_hi_u32_u24 v14, 429497, v69
    v_lshrrev_b32 v12, 3, v73
    v_cos_f32 v8, v8
    v_lshlrev_b16 v13, 3, v73
    v_mad_i32_i24 v11, v14, s55, v69
    v_bitop3_b32 v12, v6, v13, v12 bitop3:0xca
    v_lshl_add_u32 v11, v11, 17, s40
    v_lshlrev_b16 v14, 8, v14
    v_lshrrev_b32 v13, 2, v73
    v_add_u32 v69, v12, v11
    v_bitop3_b32 v73, v5, v13, v14 bitop3:0xea
    v_cvt_pk_bf16_f32 v64, v7, v8
    v_perm_b32 v12, v64, v64, s41
    v_bitop3_b32 v68, v4, v12, v68 bitop3:0xca
    v_perm_b32 v13, v64, v64, s42
    v_bitop3_b32 v69, v4, v13, v69 bitop3:0xca
    v_mul_hi_u32_u24 v14, 429497, v70
    v_lshrrev_b32 v12, 3, v74
    v_cos_f32 v9, v9
    v_lshlrev_b16 v13, 3, v74
    v_mad_i32_i24 v11, v14, s55, v70
    v_bitop3_b32 v12, v6, v13, v12 bitop3:0xca
    v_lshl_add_u32 v11, v11, 17, s40
    v_lshlrev_b16 v14, 8, v14
    v_lshrrev_b32 v13, 2, v74
    v_add_u32 v70, v12, v11
    v_bitop3_b32 v74, v5, v13, v14 bitop3:0xea
    v_mul_hi_u32_u24 v14, 429497, v71
    v_lshrrev_b32 v12, 3, v75
    v_cos_f32 v10, v10
    v_lshlrev_b16 v13, 3, v75
    v_mad_i32_i24 v11, v14, s55, v71
    v_bitop3_b32 v12, v6, v13, v12 bitop3:0xca
    v_lshl_add_u32 v11, v11, 17, s40
    v_lshlrev_b16 v14, 8, v14
    v_lshrrev_b32 v13, 2, v75
    v_add_u32 v71, v12, v11
    v_bitop3_b32 v75, v5, v13, v14 bitop3:0xea
    v_cvt_pk_bf16_f32 v65, v9, v10
    v_perm_b32 v12, v65, v65, s41
    v_bitop3_b32 v70, v4, v12, v70 bitop3:0xca
    v_perm_b32 v13, v65, v65, s42
    v_bitop3_b32 v71, v4, v13, v71 bitop3:0xca
    s_setprio 2
    v_and_b32 v7, -4, v120
    v_lshl_add_u32 v8, v120, 2, v7
    ds_write_b32 v8, v116
    v_lshl_add_u32 v7, v7, 2, v120
    ds_write_b8 v7, v124 offset:16
    v_and_b32 v9, -4, v121
    v_lshl_add_u32 v10, v121, 2, v9
    ds_write_b32 v10, v117
    v_lshl_add_u32 v9, v9, 2, v121
    ds_write_b8_d16_hi v9, v124 offset:16
    v_and_b32 v7, -4, v122
    v_lshl_add_u32 v8, v122, 2, v7
    ds_write_b32 v8, v118
    v_lshl_add_u32 v7, v7, 2, v122
    ds_write_b8 v7, v125 offset:16
    v_and_b32 v9, -4, v123
    v_lshl_add_u32 v10, v123, 2, v9
    ds_write_b32 v10, v119
    v_lshl_add_u32 v9, v9, 2, v123
    ds_write_b8_d16_hi v9, v125 offset:16
    s_add_u32 s45, s35, 0x8000
    s_add_u32 s45, s45, s91
    buffer_store_dwordx4 v[92:95], v0, s[20:23], s45 offen sc1
    s_add_u32 s46, s99, 0x4c00000
    v_lshlrev_b32 v112, 1, v1
    buffer_load_dwordx4 v[112:115], v112, s[12:15], s46 offen nt
    s_waitcnt vmcnt(8)
    v_lshlrev_b32 v7, 16, v66
    v_and_b32 v8, 0xffff0000, v66
    v_lshlrev_b32 v9, 16, v67
    v_and_b32 v10, 0xffff0000, v67
    v_mul_f32 v7, 0.15915494, v7
    v_mul_f32 v8, 0.15915494, v8
    v_mul_f32 v9, 0.15915494, v9
    v_mul_f32 v10, 0.15915494, v10
    v_mul_hi_u32_u24 v14, 429497, v76
    v_lshrrev_b32 v12, 3, v80
    v_cos_f32 v7, v7
    v_lshlrev_b16 v13, 3, v80
    v_mad_i32_i24 v11, v14, s55, v76
    v_bitop3_b32 v12, v6, v13, v12 bitop3:0xca
    v_lshl_add_u32 v11, v11, 17, s40
    v_lshlrev_b16 v14, 8, v14
    v_lshrrev_b32 v13, 2, v80
    v_add_u32 v76, v12, v11
    v_bitop3_b32 v80, v5, v13, v14 bitop3:0xea
    v_mul_hi_u32_u24 v14, 429497, v77
    v_lshrrev_b32 v12, 3, v81
    v_cos_f32 v8, v8
    v_lshlrev_b16 v13, 3, v81
    v_mad_i32_i24 v11, v14, s55, v77
    v_bitop3_b32 v12, v6, v13, v12 bitop3:0xca
    v_lshl_add_u32 v11, v11, 17, s40
    v_lshlrev_b16 v14, 8, v14
    v_lshrrev_b32 v13, 2, v81
    v_add_u32 v77, v12, v11
    v_bitop3_b32 v81, v5, v13, v14 bitop3:0xea
    v_cvt_pk_bf16_f32 v66, v7, v8
    v_perm_b32 v12, v66, v66, s41
    v_bitop3_b32 v76, v4, v12, v76 bitop3:0xca
    v_perm_b32 v13, v66, v66, s42
    v_bitop3_b32 v77, v4, v13, v77 bitop3:0xca
    v_mul_hi_u32_u24 v14, 429497, v78
    v_lshrrev_b32 v12, 3, v82
    v_cos_f32 v9, v9
    v_lshlrev_b16 v13, 3, v82
    v_mad_i32_i24 v11, v14, s55, v78
    v_bitop3_b32 v12, v6, v13, v12 bitop3:0xca
    v_lshl_add_u32 v11, v11, 17, s40
    v_lshlrev_b16 v14, 8, v14
    v_lshrrev_b32 v13, 2, v82
    v_add_u32 v78, v12, v11
    v_bitop3_b32 v82, v5, v13, v14 bitop3:0xea
    v_mul_hi_u32_u24 v14, 429497, v79
    v_lshrrev_b32 v12, 3, v83
    v_cos_f32 v10, v10
    v_lshlrev_b16 v13, 3, v83
    v_mad_i32_i24 v11, v14, s55, v79
    v_bitop3_b32 v12, v6, v13, v12 bitop3:0xca
    v_lshl_add_u32 v11, v11, 17, s40
    v_lshlrev_b16 v14, 8, v14
    v_lshrrev_b32 v13, 2, v83
    v_add_u32 v79, v12, v11
    v_bitop3_b32 v83, v5, v13, v14 bitop3:0xea
    v_cvt_pk_bf16_f32 v67, v9, v10
    v_perm_b32 v12, v67, v67, s41
    v_bitop3_b32 v78, v4, v12, v78 bitop3:0xca
    v_perm_b32 v13, v67, v67, s42
    v_bitop3_b32 v79, v4, v13, v79 bitop3:0xca
    v_and_b32 v7, -4, v20
    v_lshl_add_u32 v8, v20, 2, v7
    ds_write_b32 v8, v16
    v_lshl_add_u32 v7, v7, 2, v20
    ds_write_b8 v7, v126 offset:16
    v_and_b32 v9, -4, v21
    v_lshl_add_u32 v10, v21, 2, v9
    ds_write_b32 v10, v17
    v_lshl_add_u32 v9, v9, 2, v21
    ds_write_b8_d16_hi v9, v126 offset:16
    v_and_b32 v7, -4, v22
    v_lshl_add_u32 v8, v22, 2, v7
    ds_write_b32 v8, v18
    v_lshl_add_u32 v7, v7, 2, v22
    ds_write_b8 v7, v127 offset:16
    v_and_b32 v9, -4, v23
    v_lshl_add_u32 v10, v23, 2, v9
    ds_write_b32 v10, v19
    v_lshl_add_u32 v9, v9, 2, v23
    ds_write_b8_d16_hi v9, v127 offset:16
    s_add_u32 s47, s96, 0x5000000
    v_lshlrev_b32 v108, 1, v1
    buffer_load_dwordx4 v[108:111], v108, s[8:11], s47 offen nt
    s_add_u32 s44, s96, 0x5000000
    v_lshlrev_b32 v116, 1, v1
    buffer_load_dwordx4 v[116:119], v116, s[12:15], s44 offen nt
    s_waitcnt vmcnt(5)
    v_lshlrev_b32 v7, 16, v88
    v_and_b32 v8, 0xffff0000, v88
    v_lshlrev_b32 v9, 16, v89
    v_and_b32 v10, 0xffff0000, v89
    v_mul_f32 v7, 0.15915494, v7
    v_mul_f32 v8, 0.15915494, v8
    v_mul_f32 v9, 0.15915494, v9
    v_mul_f32 v10, 0.15915494, v10
    v_mul_hi_u32_u24 v14, 429497, v96
    v_lshrrev_b32 v12, 3, v104
    v_cos_f32 v7, v7
    v_lshlrev_b16 v13, 3, v104
    v_mad_i32_i24 v11, v14, s55, v96
    v_bitop3_b32 v12, v6, v13, v12 bitop3:0xca
    v_lshl_add_u32 v11, v11, 17, s40
    v_lshlrev_b16 v14, 8, v14
    v_lshrrev_b32 v13, 2, v104
    v_add_u32 v96, v12, v11
    v_bitop3_b32 v104, v5, v13, v14 bitop3:0xea
    v_mul_hi_u32_u24 v14, 429497, v97
    v_lshrrev_b32 v12, 3, v105
    v_cos_f32 v8, v8
    v_lshlrev_b16 v13, 3, v105
    v_mad_i32_i24 v11, v14, s55, v97
    v_bitop3_b32 v12, v6, v13, v12 bitop3:0xca
    v_lshl_add_u32 v11, v11, 17, s40
    v_lshlrev_b16 v14, 8, v14
    v_lshrrev_b32 v13, 2, v105
    v_add_u32 v97, v12, v11
    v_bitop3_b32 v105, v5, v13, v14 bitop3:0xea
    v_cvt_pk_bf16_f32 v88, v7, v8
    v_perm_b32 v12, v88, v88, s41
    v_bitop3_b32 v96, v4, v12, v96 bitop3:0xca
    v_perm_b32 v13, v88, v88, s42
    v_bitop3_b32 v97, v4, v13, v97 bitop3:0xca
    v_mul_hi_u32_u24 v14, 429497, v98
    v_lshrrev_b32 v12, 3, v106
    v_cos_f32 v9, v9
    v_lshlrev_b16 v13, 3, v106
    v_mad_i32_i24 v11, v14, s55, v98
    v_bitop3_b32 v12, v6, v13, v12 bitop3:0xca
    v_lshl_add_u32 v11, v11, 17, s40
    v_lshlrev_b16 v14, 8, v14
    v_lshrrev_b32 v13, 2, v106
    v_add_u32 v98, v12, v11
    v_bitop3_b32 v106, v5, v13, v14 bitop3:0xea
    v_mul_hi_u32_u24 v14, 429497, v99
    v_lshrrev_b32 v12, 3, v107
    v_cos_f32 v10, v10
    v_lshlrev_b16 v13, 3, v107
    v_mad_i32_i24 v11, v14, s55, v99
    v_bitop3_b32 v12, v6, v13, v12 bitop3:0xca
    v_lshl_add_u32 v11, v11, 17, s40
    v_lshlrev_b16 v14, 8, v14
    v_lshrrev_b32 v13, 2, v107
    v_add_u32 v99, v12, v11
    v_bitop3_b32 v107, v5, v13, v14 bitop3:0xea
    v_cvt_pk_bf16_f32 v89, v9, v10
    v_perm_b32 v12, v89, v89, s41
    v_bitop3_b32 v98, v4, v12, v98 bitop3:0xca
    v_perm_b32 v13, v89, v89, s42
    v_bitop3_b32 v99, v4, v13, v99 bitop3:0xca
    s_setprio 1
    v_and_b32 v7, -4, v32
    v_lshl_add_u32 v8, v32, 2, v7
    ds_write_b32 v8, v28
    v_lshl_add_u32 v7, v7, 2, v32
    ds_write_b8 v7, v24 offset:16
    v_and_b32 v9, -4, v33
    v_lshl_add_u32 v10, v33, 2, v9
    ds_write_b32 v10, v29
    v_lshl_add_u32 v9, v9, 2, v33
    ds_write_b8_d16_hi v9, v24 offset:16
    v_and_b32 v7, -4, v34
    v_lshl_add_u32 v8, v34, 2, v7
    ds_write_b32 v8, v30
    v_lshl_add_u32 v7, v7, 2, v34
    ds_write_b8 v7, v25 offset:16
    v_and_b32 v9, -4, v35
    v_lshl_add_u32 v10, v35, 2, v9
    ds_write_b32 v10, v31
    v_lshl_add_u32 v9, v9, 2, v35
    ds_write_b8_d16_hi v9, v25 offset:16
    s_add_u32 s45, s96, 0x5000000
    s_lshr_b32 s45, s45, 1
    buffer_load_dwordx2 v[120:121], v1, s[16:19], s45 offen nt
    s_add_u32 s46, s97, 0x5400000
    s_lshr_b32 s46, s46, 1
    buffer_load_dwordx2 v[122:123], v1, s[16:19], s46 offen nt
    s_add_u32 s47, s97, 0x5400000
    v_lshlrev_b32 v92, 1, v1
    buffer_load_dwordx4 v[92:95], v92, s[8:11], s47 offen nt
    v_and_b32 v7, -4, v40
    v_lshl_add_u32 v8, v40, 2, v7
    ds_write_b32 v8, v36
    v_lshl_add_u32 v7, v7, 2, v40
    ds_write_b8 v7, v26 offset:16
    v_and_b32 v9, -4, v41
    v_lshl_add_u32 v10, v41, 2, v9
    ds_write_b32 v10, v37
    v_lshl_add_u32 v9, v9, 2, v41
    ds_write_b8_d16_hi v9, v26 offset:16
    v_and_b32 v7, -4, v42
    v_lshl_add_u32 v8, v42, 2, v7
    ds_write_b32 v8, v38
    v_lshl_add_u32 v7, v7, 2, v42
    ds_write_b8 v7, v27 offset:16
    v_and_b32 v9, -4, v43
    v_lshl_add_u32 v10, v43, 2, v9
    ds_write_b32 v10, v39
    v_lshl_add_u32 v9, v9, 2, v43
    ds_write_b8_d16_hi v9, v27 offset:16
    s_add_u32 s44, s35, 0x8000
    s_add_u32 s44, s44, s93
    buffer_store_dwordx4 v[84:87], v0, s[20:23], s44 offen sc1
    s_add_u32 s45, s97, 0x5400000
    v_lshlrev_b32 v16, 1, v1
    buffer_load_dwordx4 v[16:19], v16, s[12:15], s45 offen nt
    s_waitcnt vmcnt(7)
    v_lshlrev_b32 v7, 16, v90
    v_and_b32 v8, 0xffff0000, v90
    v_lshlrev_b32 v9, 16, v91
    v_and_b32 v10, 0xffff0000, v91
    v_mul_f32 v7, 0.15915494, v7
    v_mul_f32 v8, 0.15915494, v8
    v_mul_f32 v9, 0.15915494, v9
    v_mul_f32 v10, 0.15915494, v10
    v_mul_hi_u32_u24 v14, 429497, v100
    v_lshrrev_b32 v12, 3, v112
    v_cos_f32 v7, v7
    v_lshlrev_b16 v13, 3, v112
    v_mad_i32_i24 v11, v14, s55, v100
    v_bitop3_b32 v12, v6, v13, v12 bitop3:0xca
    v_lshl_add_u32 v11, v11, 17, s40
    v_lshlrev_b16 v14, 8, v14
    v_lshrrev_b32 v13, 2, v112
    v_add_u32 v100, v12, v11
    v_bitop3_b32 v112, v5, v13, v14 bitop3:0xea
    v_mul_hi_u32_u24 v14, 429497, v101
    v_lshrrev_b32 v12, 3, v113
    v_cos_f32 v8, v8
    v_lshlrev_b16 v13, 3, v113
    v_mad_i32_i24 v11, v14, s55, v101
    v_bitop3_b32 v12, v6, v13, v12 bitop3:0xca
    v_lshl_add_u32 v11, v11, 17, s40
    v_lshlrev_b16 v14, 8, v14
    v_lshrrev_b32 v13, 2, v113
    v_add_u32 v101, v12, v11
    v_bitop3_b32 v113, v5, v13, v14 bitop3:0xea
    v_cvt_pk_bf16_f32 v90, v7, v8
    v_perm_b32 v12, v90, v90, s41
    v_bitop3_b32 v100, v4, v12, v100 bitop3:0xca
    v_perm_b32 v13, v90, v90, s42
    v_bitop3_b32 v101, v4, v13, v101 bitop3:0xca
    v_mul_hi_u32_u24 v14, 429497, v102
    v_lshrrev_b32 v12, 3, v114
    v_cos_f32 v9, v9
    v_lshlrev_b16 v13, 3, v114
    v_mad_i32_i24 v11, v14, s55, v102
    v_bitop3_b32 v12, v6, v13, v12 bitop3:0xca
    v_lshl_add_u32 v11, v11, 17, s40
    v_lshlrev_b16 v14, 8, v14
    v_lshrrev_b32 v13, 2, v114
    v_add_u32 v102, v12, v11
    v_bitop3_b32 v114, v5, v13, v14 bitop3:0xea
    v_mul_hi_u32_u24 v14, 429497, v103
    v_lshrrev_b32 v12, 3, v115
    v_cos_f32 v10, v10
    v_lshlrev_b16 v13, 3, v115
    v_mad_i32_i24 v11, v14, s55, v103
    v_bitop3_b32 v12, v6, v13, v12 bitop3:0xca
    v_lshl_add_u32 v11, v11, 17, s40
    v_lshlrev_b16 v14, 8, v14
    v_lshrrev_b32 v13, 2, v115
    v_add_u32 v103, v12, v11
    v_bitop3_b32 v115, v5, v13, v14 bitop3:0xea
    v_cvt_pk_bf16_f32 v91, v9, v10
    v_perm_b32 v12, v91, v91, s41
    v_bitop3_b32 v102, v4, v12, v102 bitop3:0xca
    v_perm_b32 v13, v91, v91, s42
    v_bitop3_b32 v103, v4, v13, v103 bitop3:0xca
    s_setprio 0
    v_and_b32 v7, -4, v52
    v_lshl_add_u32 v8, v52, 2, v7
    ds_write_b32 v8, v48
    v_lshl_add_u32 v7, v7, 2, v52
    ds_write_b8 v7, v44 offset:16
    v_and_b32 v9, -4, v53
    v_lshl_add_u32 v10, v53, 2, v9
    ds_write_b32 v10, v49
    v_lshl_add_u32 v9, v9, 2, v53
    ds_write_b8_d16_hi v9, v44 offset:16
    v_and_b32 v7, -4, v54
    v_lshl_add_u32 v8, v54, 2, v7
    ds_write_b32 v8, v50
    v_lshl_add_u32 v7, v7, 2, v54
    ds_write_b8 v7, v45 offset:16
    v_and_b32 v9, -4, v55
    v_lshl_add_u32 v10, v55, 2, v9
    ds_write_b32 v10, v51
    v_lshl_add_u32 v9, v9, 2, v55
    ds_write_b8_d16_hi v9, v45 offset:16
    s_add_u32 s46, s98, 0x5800000
    v_lshlrev_b32 v20, 1, v1
    buffer_load_dwordx4 v[20:23], v20, s[8:11], s46 offen nt
    s_add_u32 s47, s98, 0x5800000
    v_lshlrev_b32 v124, 1, v1
    buffer_load_dwordx4 v[124:127], v124, s[12:15], s47 offen nt
    s_waitcnt vmcnt(5)
    v_lshlrev_b32 v7, 16, v120
    v_and_b32 v8, 0xffff0000, v120
    v_lshlrev_b32 v9, 16, v121
    v_and_b32 v10, 0xffff0000, v121
    v_mul_f32 v7, 0.15915494, v7
    v_mul_f32 v8, 0.15915494, v8
    v_mul_f32 v9, 0.15915494, v9
    v_mul_f32 v10, 0.15915494, v10
    v_mul_hi_u32_u24 v14, 429497, v108
    v_lshrrev_b32 v12, 3, v116
    v_cos_f32 v7, v7
    v_lshlrev_b16 v13, 3, v116
    v_mad_i32_i24 v11, v14, s55, v108
    v_bitop3_b32 v12, v6, v13, v12 bitop3:0xca
    v_lshl_add_u32 v11, v11, 17, s40
    v_lshlrev_b16 v14, 8, v14
    v_lshrrev_b32 v13, 2, v116
    v_add_u32 v108, v12, v11
    v_bitop3_b32 v116, v5, v13, v14 bitop3:0xea
    v_mul_hi_u32_u24 v14, 429497, v109
    v_lshrrev_b32 v12, 3, v117
    v_cos_f32 v8, v8
    v_lshlrev_b16 v13, 3, v117
    v_mad_i32_i24 v11, v14, s55, v109
    v_bitop3_b32 v12, v6, v13, v12 bitop3:0xca
    v_lshl_add_u32 v11, v11, 17, s40
    v_lshlrev_b16 v14, 8, v14
    v_lshrrev_b32 v13, 2, v117
    v_add_u32 v109, v12, v11
    v_bitop3_b32 v117, v5, v13, v14 bitop3:0xea
    v_cvt_pk_bf16_f32 v120, v7, v8
    v_perm_b32 v12, v120, v120, s41
    v_bitop3_b32 v108, v4, v12, v108 bitop3:0xca
    v_perm_b32 v13, v120, v120, s42
    v_bitop3_b32 v109, v4, v13, v109 bitop3:0xca
    v_mul_hi_u32_u24 v14, 429497, v110
    v_lshrrev_b32 v12, 3, v118
    v_cos_f32 v9, v9
    v_lshlrev_b16 v13, 3, v118
    v_mad_i32_i24 v11, v14, s55, v110
    v_bitop3_b32 v12, v6, v13, v12 bitop3:0xca
    v_lshl_add_u32 v11, v11, 17, s40
    v_lshlrev_b16 v14, 8, v14
    v_lshrrev_b32 v13, 2, v118
    v_add_u32 v110, v12, v11
    v_bitop3_b32 v118, v5, v13, v14 bitop3:0xea
    v_mul_hi_u32_u24 v14, 429497, v111
    v_lshrrev_b32 v12, 3, v119
    v_cos_f32 v10, v10
    v_lshlrev_b16 v13, 3, v119
    v_mad_i32_i24 v11, v14, s55, v111
    v_bitop3_b32 v12, v6, v13, v12 bitop3:0xca
    v_lshl_add_u32 v11, v11, 17, s40
    v_lshlrev_b16 v14, 8, v14
    v_lshrrev_b32 v13, 2, v119
    v_add_u32 v111, v12, v11
    v_bitop3_b32 v119, v5, v13, v14 bitop3:0xea
    v_cvt_pk_bf16_f32 v121, v9, v10
    v_perm_b32 v12, v121, v121, s41
    v_bitop3_b32 v110, v4, v12, v110 bitop3:0xca
    v_perm_b32 v13, v121, v121, s42
    v_bitop3_b32 v111, v4, v13, v111 bitop3:0xca
    v_and_b32 v7, -4, v60
    v_lshl_add_u32 v8, v60, 2, v7
    ds_write_b32 v8, v56
    v_lshl_add_u32 v7, v7, 2, v60
    ds_write_b8 v7, v46 offset:16
    v_and_b32 v9, -4, v61
    v_lshl_add_u32 v10, v61, 2, v9
    ds_write_b32 v10, v57
    v_lshl_add_u32 v9, v9, 2, v61
    ds_write_b8_d16_hi v9, v46 offset:16
    v_and_b32 v7, -4, v62
    v_lshl_add_u32 v8, v62, 2, v7
    ds_write_b32 v8, v58
    v_lshl_add_u32 v7, v7, 2, v62
    ds_write_b8 v7, v47 offset:16
    v_and_b32 v9, -4, v63
    v_lshl_add_u32 v10, v63, 2, v9
    ds_write_b32 v10, v59
    v_lshl_add_u32 v9, v9, 2, v63
    ds_write_b8_d16_hi v9, v47 offset:16
    s_add_u32 s44, s98, 0x5800000
    s_lshr_b32 s44, s44, 1
    buffer_load_dwordx2 v[28:29], v1, s[16:19], s44 offen nt
    s_add_u32 s45, s99, 0x5c00000
    s_lshr_b32 s45, s45, 1
    buffer_load_dwordx2 v[30:31], v1, s[16:19], s45 offen nt
    s_waitcnt vmcnt(4)
    v_lshlrev_b32 v7, 16, v122
    v_and_b32 v8, 0xffff0000, v122
    v_lshlrev_b32 v9, 16, v123
    v_and_b32 v10, 0xffff0000, v123
    v_mul_f32 v7, 0.15915494, v7
    v_mul_f32 v8, 0.15915494, v8
    v_mul_f32 v9, 0.15915494, v9
    v_mul_f32 v10, 0.15915494, v10
    v_mul_hi_u32_u24 v14, 429497, v92
    v_lshrrev_b32 v12, 3, v16
    v_cos_f32 v7, v7
    v_lshlrev_b16 v13, 3, v16
    v_mad_i32_i24 v11, v14, s55, v92
    v_bitop3_b32 v12, v6, v13, v12 bitop3:0xca
    v_lshl_add_u32 v11, v11, 17, s40
    v_lshlrev_b16 v14, 8, v14
    v_lshrrev_b32 v13, 2, v16
    v_add_u32 v92, v12, v11
    v_bitop3_b32 v16, v5, v13, v14 bitop3:0xea
    v_mul_hi_u32_u24 v14, 429497, v93
    v_lshrrev_b32 v12, 3, v17
    v_cos_f32 v8, v8
    v_lshlrev_b16 v13, 3, v17
    v_mad_i32_i24 v11, v14, s55, v93
    v_bitop3_b32 v12, v6, v13, v12 bitop3:0xca
    v_lshl_add_u32 v11, v11, 17, s40
    v_lshlrev_b16 v14, 8, v14
    v_lshrrev_b32 v13, 2, v17
    v_add_u32 v93, v12, v11
    v_bitop3_b32 v17, v5, v13, v14 bitop3:0xea
    v_cvt_pk_bf16_f32 v122, v7, v8
    v_perm_b32 v12, v122, v122, s41
    v_bitop3_b32 v92, v4, v12, v92 bitop3:0xca
    v_perm_b32 v13, v122, v122, s42
    v_bitop3_b32 v93, v4, v13, v93 bitop3:0xca
    v_mul_hi_u32_u24 v14, 429497, v94
    v_lshrrev_b32 v12, 3, v18
    v_cos_f32 v9, v9
    v_lshlrev_b16 v13, 3, v18
    v_mad_i32_i24 v11, v14, s55, v94
    v_bitop3_b32 v12, v6, v13, v12 bitop3:0xca
    v_lshl_add_u32 v11, v11, 17, s40
    v_lshlrev_b16 v14, 8, v14
    v_lshrrev_b32 v13, 2, v18
    v_add_u32 v94, v12, v11
    v_bitop3_b32 v18, v5, v13, v14 bitop3:0xea
    v_mul_hi_u32_u24 v14, 429497, v95
    v_lshrrev_b32 v12, 3, v19
    v_cos_f32 v10, v10
    v_lshlrev_b16 v13, 3, v19
    v_mad_i32_i24 v11, v14, s55, v95
    v_bitop3_b32 v12, v6, v13, v12 bitop3:0xca
    v_lshl_add_u32 v11, v11, 17, s40
    v_lshlrev_b16 v14, 8, v14
    v_lshrrev_b32 v13, 2, v19
    v_add_u32 v95, v12, v11
    v_bitop3_b32 v19, v5, v13, v14 bitop3:0xea
    v_cvt_pk_bf16_f32 v123, v9, v10
    v_perm_b32 v12, v123, v123, s41
    v_bitop3_b32 v94, v4, v12, v94 bitop3:0xca
    v_perm_b32 v13, v123, v123, s42
    v_bitop3_b32 v95, v4, v13, v95 bitop3:0xca
    v_add_u32 v7, s72, v0
    v_add_u32 v12, s73, v0
    v_add_u32 v13, s85, v0
    v_add_u32 v14, s91, v0
    v_add_u32 v15, s93, v0
    s_min_i32 s3, s72, s73
    s_min_i32 s3, s3, s85
    s_min_i32 s3, s3, s91
    s_min_i32 s3, s3, s93
    v_add_u32 v3, s3, v0
    v_mov_b32 v8, 0
    v_mov_b32 v9, 0
    v_mov_b32 v10, 0
    v_mov_b32 v11, 0
    s_waitcnt lgkmcnt(0)
    s_barrier
    ds_read_b128 v[32:35], v7 offset:0
    ds_read_b128 v[36:39], v12 offset:0
    ds_read_b128 v[40:43], v13 offset:0
    ds_read_b128 v[24:27], v14 offset:0
    ds_read_b128 v[84:87], v15 offset:0
    ds_write_b128 v3, v[8:11]
    ds_read_b128 v[48:51], v7 offset:16384
    ds_read_b128 v[52:55], v12 offset:16384
    ds_read_b128 v[56:59], v13 offset:16384
    ds_read_b128 v[60:63], v14 offset:16384
    ds_read_b128 v[44:47], v15 offset:16384
    s_waitcnt lgkmcnt(0)
    s_barrier
    s_setprio 3
    s_add_u32 s46, s35, 0x2a44000
    s_add_u32 s46, s46, s72
    buffer_store_dwordx4 v[32:35], v0, s[20:23], s46 offen sc1
    s_add_u32 s47, s99, 0x5c00000
    s_nop 0
    v_lshlrev_b32 v32, 1, v1
    buffer_load_dwordx4 v[32:35], v32, s[8:11], s47 offen nt
    s_add_u32 s44, s35, 0x2a44000
    s_add_u32 s44, s44, s73
    buffer_store_dwordx4 v[36:39], v0, s[20:23], s44 offen sc1
    s_add_u32 s45, s99, 0x5c00000
    s_nop 0
    v_lshlrev_b32 v36, 1, v1
    buffer_load_dwordx4 v[36:39], v36, s[12:15], s45 offen nt
    ds_add_u32 v72, v2
    ds_add_u32 v73, v2
    ds_add_u32 v74, v2
    ds_add_u32 v75, v2
    ds_add_u32 v80, v2
    ds_add_u32 v81, v2
    ds_add_u32 v82, v2
    ds_add_u32 v83, v2
    s_setprio 2
    ds_add_u32 v104, v2
    ds_add_u32 v105, v2
    ds_add_u32 v106, v2
    ds_add_u32 v107, v2
    ds_add_u32 v112, v2
    ds_add_u32 v113, v2
    ds_add_u32 v114, v2
    ds_add_u32 v115, v2
    s_setprio 1
    s_add_u32 s46, s35, 0x2a44000
    s_add_u32 s46, s46, s85
    buffer_store_dwordx4 v[40:43], v0, s[20:23], s46 offen sc1
    s_add_u32 s47, s96, 0x6000000
    s_nop 0
    v_lshlrev_b32 v40, 1, v1
    buffer_load_dwordx4 v[40:43], v40, s[8:11], s47 offen nt
    ds_add_u32 v116, v2
    ds_add_u32 v117, v2
    ds_add_u32 v118, v2
    ds_add_u32 v119, v2
    ds_add_u32 v16, v2
    ds_add_u32 v17, v2
    ds_add_u32 v18, v2
    ds_add_u32 v19, v2
    s_setprio 0
    s_waitcnt vmcnt(6)
    v_lshlrev_b32 v7, 16, v28
    v_and_b32 v8, 0xffff0000, v28
    v_lshlrev_b32 v9, 16, v29
    v_and_b32 v10, 0xffff0000, v29
    v_mul_f32 v7, 0.15915494, v7
    v_mul_f32 v8, 0.15915494, v8
    v_mul_f32 v9, 0.15915494, v9
    v_mul_f32 v10, 0.15915494, v10
    v_mul_hi_u32_u24 v14, 429497, v20
    v_lshrrev_b32 v12, 3, v124
    v_cos_f32 v7, v7
    v_lshlrev_b16 v13, 3, v124
    v_mad_i32_i24 v11, v14, s55, v20
    v_bitop3_b32 v12, v6, v13, v12 bitop3:0xca
    v_lshl_add_u32 v11, v11, 17, s40
    v_lshlrev_b16 v14, 8, v14
    v_lshrrev_b32 v13, 2, v124
    v_add_u32 v20, v12, v11
    v_bitop3_b32 v124, v5, v13, v14 bitop3:0xea
    ds_add_u32 v124, v2
    v_mul_hi_u32_u24 v14, 429497, v21
    v_lshrrev_b32 v12, 3, v125
    v_cos_f32 v8, v8
    v_lshlrev_b16 v13, 3, v125
    v_mad_i32_i24 v11, v14, s55, v21
    v_bitop3_b32 v12, v6, v13, v12 bitop3:0xca
    v_lshl_add_u32 v11, v11, 17, s40
    v_lshlrev_b16 v14, 8, v14
    v_lshrrev_b32 v13, 2, v125
    v_add_u32 v21, v12, v11
    v_bitop3_b32 v125, v5, v13, v14 bitop3:0xea
    ds_add_u32 v125, v2
    v_cvt_pk_bf16_f32 v28, v7, v8
    v_perm_b32 v12, v28, v28, s41
    v_bitop3_b32 v20, v4, v12, v20 bitop3:0xca
    v_perm_b32 v13, v28, v28, s42
    v_bitop3_b32 v21, v4, v13, v21 bitop3:0xca
    v_mul_hi_u32_u24 v14, 429497, v22
    v_lshrrev_b32 v12, 3, v126
    v_cos_f32 v9, v9
    v_lshlrev_b16 v13, 3, v126
    v_mad_i32_i24 v11, v14, s55, v22
    v_bitop3_b32 v12, v6, v13, v12 bitop3:0xca
    v_lshl_add_u32 v11, v11, 17, s40
    v_lshlrev_b16 v14, 8, v14
    v_lshrrev_b32 v13, 2, v126
    v_add_u32 v22, v12, v11
    v_bitop3_b32 v126, v5, v13, v14 bitop3:0xea
    ds_add_u32 v126, v2
    v_mul_hi_u32_u24 v14, 429497, v23
    v_lshrrev_b32 v12, 3, v127
    v_cos_f32 v10, v10
    v_lshlrev_b16 v13, 3, v127
    v_mad_i32_i24 v11, v14, s55, v23
    v_bitop3_b32 v12, v6, v13, v12 bitop3:0xca
    v_lshl_add_u32 v11, v11, 17, s40
    v_lshlrev_b16 v14, 8, v14
    v_lshrrev_b32 v13, 2, v127
    v_add_u32 v23, v12, v11
    v_bitop3_b32 v127, v5, v13, v14 bitop3:0xea
    ds_add_u32 v127, v2
    v_cvt_pk_bf16_f32 v29, v9, v10
    v_perm_b32 v12, v29, v29, s41
    v_bitop3_b32 v22, v4, v12, v22 bitop3:0xca
    v_perm_b32 v13, v29, v29, s42
    v_bitop3_b32 v23, v4, v13, v23 bitop3:0xca
    s_waitcnt vmcnt(2)
    v_lshlrev_b32 v7, 16, v30
    v_and_b32 v8, 0xffff0000, v30
    v_lshlrev_b32 v9, 16, v31
    v_and_b32 v10, 0xffff0000, v31
    v_mul_f32 v7, 0.15915494, v7
    v_mul_f32 v8, 0.15915494, v8
    v_mul_f32 v9, 0.15915494, v9
    v_mul_f32 v10, 0.15915494, v10
    v_mul_hi_u32_u24 v14, 429497, v32
    v_lshrrev_b32 v12, 3, v36
    v_cos_f32 v7, v7
    v_lshlrev_b16 v13, 3, v36
    v_mad_i32_i24 v11, v14, s55, v32
    v_bitop3_b32 v12, v6, v13, v12 bitop3:0xca
    v_lshl_add_u32 v11, v11, 17, s40
    v_lshlrev_b16 v14, 8, v14
    v_lshrrev_b32 v13, 2, v36
    v_add_u32 v32, v12, v11
    v_bitop3_b32 v36, v5, v13, v14 bitop3:0xea
    ds_add_u32 v36, v2
    v_mul_hi_u32_u24 v14, 429497, v33
    v_lshrrev_b32 v12, 3, v37
    v_cos_f32 v8, v8
    v_lshlrev_b16 v13, 3, v37
    v_mad_i32_i24 v11, v14, s55, v33
    v_bitop3_b32 v12, v6, v13, v12 bitop3:0xca
    v_lshl_add_u32 v11, v11, 17, s40
    v_lshlrev_b16 v14, 8, v14
    v_lshrrev_b32 v13, 2, v37
    v_add_u32 v33, v12, v11
    v_bitop3_b32 v37, v5, v13, v14 bitop3:0xea
    ds_add_u32 v37, v2
    v_cvt_pk_bf16_f32 v30, v7, v8
    v_perm_b32 v12, v30, v30, s41
    v_bitop3_b32 v32, v4, v12, v32 bitop3:0xca
    v_perm_b32 v13, v30, v30, s42
    v_bitop3_b32 v33, v4, v13, v33 bitop3:0xca
    v_mul_hi_u32_u24 v14, 429497, v34
    v_lshrrev_b32 v12, 3, v38
    v_cos_f32 v9, v9
    v_lshlrev_b16 v13, 3, v38
    v_mad_i32_i24 v11, v14, s55, v34
    v_bitop3_b32 v12, v6, v13, v12 bitop3:0xca
    v_lshl_add_u32 v11, v11, 17, s40
    v_lshlrev_b16 v14, 8, v14
    v_lshrrev_b32 v13, 2, v38
    v_add_u32 v34, v12, v11
    v_bitop3_b32 v38, v5, v13, v14 bitop3:0xea
    ds_add_u32 v38, v2
    v_mul_hi_u32_u24 v14, 429497, v35
    v_lshrrev_b32 v12, 3, v39
    v_cos_f32 v10, v10
    v_lshlrev_b16 v13, 3, v39
    v_mad_i32_i24 v11, v14, s55, v35
    v_bitop3_b32 v12, v6, v13, v12 bitop3:0xca
    v_lshl_add_u32 v11, v11, 17, s40
    v_lshlrev_b16 v14, 8, v14
    v_lshrrev_b32 v13, 2, v39
    v_add_u32 v35, v12, v11
    v_bitop3_b32 v39, v5, v13, v14 bitop3:0xea
    ds_add_u32 v39, v2
    v_cvt_pk_bf16_f32 v31, v9, v10
    v_perm_b32 v12, v31, v31, s41
    v_bitop3_b32 v34, v4, v12, v34 bitop3:0xca
    v_perm_b32 v13, v31, v31, s42
    v_bitop3_b32 v35, v4, v13, v35 bitop3:0xca
    v_lshrrev_b32 v8, 2, v0
    v_and_b32 v7, 0x3c00, v0
    v_bitop3_b32 v7, v5, v8, v7 bitop3:0xea
    s_waitcnt lgkmcnt(0)
    s_barrier
    ds_read2st64_b32 v[8:9], v7 offset0:0 offset1:1
    ds_read2st64_b32 v[10:11], v7 offset0:2 offset1:3
    s_add_u32 s44, s35, 0x2a44000
    s_add_u32 s44, s44, s91
    buffer_store_dwordx4 v[24:27], v0, s[20:23], s44 offen sc1
    s_add_u32 s45, s96, 0x6000000
    s_nop 0
    v_lshlrev_b32 v24, 1, v1
    buffer_load_dwordx4 v[24:27], v24, s[12:15], s45 offen nt
    s_waitcnt lgkmcnt(0)
    v_lshl_or_b32 v12, v9, 16, v8
    v_lshl_or_b32 v13, v11, 16, v10
    v_mov_b32 v14, v12
    v_mov_b32 v15, v13
    s_nop 0
    v_add_u32_dpp v14, v14, v14 row_shr:1 row_mask:0xf bank_mask:0xf bound_ctrl:1
    v_add_u32_dpp v15, v15, v15 row_shr:1 row_mask:0xf bank_mask:0xf bound_ctrl:1
    s_nop 0
    v_add_u32_dpp v14, v14, v14 row_shr:2 row_mask:0xf bank_mask:0xf bound_ctrl:1
    v_add_u32_dpp v15, v15, v15 row_shr:2 row_mask:0xf bank_mask:0xf bound_ctrl:1
    s_nop 0
    v_add_u32_dpp v14, v14, v14 row_shr:4 row_mask:0xf bank_mask:0xf bound_ctrl:1
    v_add_u32_dpp v15, v15, v15 row_shr:4 row_mask:0xf bank_mask:0xf bound_ctrl:1
    s_nop 0
    v_add_u32_dpp v14, v14, v14 row_shr:8 row_mask:0xf bank_mask:0xf bound_ctrl:1
    v_add_u32_dpp v15, v15, v15 row_shr:8 row_mask:0xf bank_mask:0xf bound_ctrl:1
    s_nop 0
    v_add_u32_dpp v14, v14, v14 row_bcast:15 row_mask:0xa bank_mask:0xf
    v_add_u32_dpp v15, v15, v15 row_bcast:15 row_mask:0xa bank_mask:0xf
    s_nop 0
    v_add_u32_dpp v14, v14, v14 row_bcast:31 row_mask:0xc bank_mask:0xf
    v_add_u32_dpp v15, v15, v15 row_bcast:31 row_mask:0xc bank_mask:0xf
    v_readlane_b32 s48, v14, 63
    v_readlane_b32 s49, v15, 63
    s_lshl_b32 s54, s32, 2
    v_mov_b32 v8, s54
    s_and_b32 s50, s48, 0xffff
    s_lshr_b32 s51, s48, 16
    s_and_b32 s52, s49, 0xffff
    s_lshr_b32 s53, s49, 16
    s_add_u32 s51, s51, s50
    s_add_u32 s52, s52, s51
    s_add_u32 s53, s53, s52
    v_mov_b32 v9, s53
    s_mov_b64 exec, 1
    ds_write_b32 v8, v9 offset:16384
    s_mov_b64 exec, -1
    v_and_b32 v8, 60, v7
    s_waitcnt lgkmcnt(0)
    s_barrier
    ds_read_b32 v9, v8 offset:16384
    s_waitcnt lgkmcnt(0)
    v_add_u32_dpp v9, v9, v9 row_shr:1 row_mask:0xf bank_mask:0xf bound_ctrl:1
    s_nop 1
    v_add_u32_dpp v9, v9, v9 row_shr:2 row_mask:0xf bank_mask:0xf bound_ctrl:1
    s_nop 1
    v_add_u32_dpp v9, v9, v9 row_shr:4 row_mask:0xf bank_mask:0xf bound_ctrl:1
    s_nop 1
    v_add_u32_dpp v9, v9, v9 row_shr:8 row_mask:0xf bank_mask:0xf bound_ctrl:1
    s_nop 0
    v_readlane_b32 s54, v9, s32
    s_sub_u32 s54, s54, s53
    s_add_u32 s50, s50, s54
    s_add_u32 s51, s51, s54
    s_add_u32 s52, s52, s54
    s_pack_ll_b32_b16 s48, s54, s50
    s_pack_ll_b32_b16 s49, s51, s52
    v_add_u32 v14, s48, v14
    v_add_u32 v15, s49, v15
    v_sub_u32 v12, v14, v12
    v_sub_u32 v13, v15, v13
    v_and_b32 v8, 0xffff, v12
    v_lshrrev_b32 v9, 16, v12
    v_and_b32 v10, 0xffff, v13
    v_lshrrev_b32 v11, 16, v13
    ds_write2st64_b32 v7, v8, v9 offset0:0 offset1:1
    ds_write2st64_b32 v7, v10, v11 offset0:2 offset1:3
    v_and_b32 v8, 0x3f0, v0
    v_lshl_add_u32 v8, v8, 1, s36
    ds_write_b64 v8, v[12:13] offset:20480
    s_bitset0_b64 exec, 63
    s_not_b64 exec, exec
    ds_write_b64 v8, v[14:15] offset:20512
    s_mov_b64 exec, -1
    s_waitcnt lgkmcnt(0)
    s_barrier
    s_setprio 3
    ds_add_rtn_u32 v72, v72, v2
    ds_add_rtn_u32 v73, v73, v2
    ds_add_rtn_u32 v74, v74, v2
    ds_add_rtn_u32 v75, v75, v2
    ds_read_b128 v[12:15], v0 offset:20480
    v_cmp_gt_u32 vcc, 8448, v0
    s_add_u32 s46, s35, 0x2a44000
    s_add_u32 s46, s46, s93
    buffer_store_dwordx4 v[84:87], v0, s[20:23], s46 offen sc1
    s_add_u32 s47, s96, 0x6000000
    s_lshr_b32 s47, s47, 1
    buffer_load_dwordx2 v[84:85], v1, s[16:19], s47 offen nt
    s_add_u32 s44, s97, 0x6400000
    s_lshr_b32 s44, s44, 1
    buffer_load_dwordx2 v[86:87], v1, s[16:19], s44 offen nt
    ds_add_rtn_u32 v80, v80, v2
    ds_add_rtn_u32 v81, v81, v2
    ds_add_rtn_u32 v82, v82, v2
    ds_add_rtn_u32 v83, v83, v2
    s_setprio 2
    ds_add_rtn_u32 v104, v104, v2
    ds_add_rtn_u32 v105, v105, v2
    ds_add_rtn_u32 v106, v106, v2
    ds_add_rtn_u32 v107, v107, v2
    s_waitcnt lgkmcnt(8)
    s_cbranch_vccz L1_p3
    s_add_u32 s45, s35, 0x5480000
    s_mov_b64 exec, vcc
    buffer_store_dwordx4 v[12:15], v0, s[24:27], s45 offen sc1
    s_mov_b64 exec, -1
L1_p3:
    s_add_u32 s46, s35, 0x2a48000
    s_add_u32 s46, s46, s72
    buffer_store_dwordx4 v[48:51], v0, s[20:23], s46 offen sc1
    s_add_u32 s47, s97, 0x6400000
    s_nop 0
    v_lshlrev_b32 v48, 1, v1
    buffer_load_dwordx4 v[48:51], v48, s[8:11], s47 offen nt
    ds_add_rtn_u32 v112, v112, v2
    ds_add_rtn_u32 v113, v113, v2
    ds_add_rtn_u32 v114, v114, v2
    ds_add_rtn_u32 v115, v115, v2
    s_setprio 1
    ds_add_rtn_u32 v116, v116, v2
    ds_add_rtn_u32 v117, v117, v2
    ds_add_rtn_u32 v118, v118, v2
    ds_add_rtn_u32 v119, v119, v2
    ds_add_rtn_u32 v16, v16, v2
    ds_add_rtn_u32 v17, v17, v2
    ds_add_rtn_u32 v18, v18, v2
    ds_add_rtn_u32 v19, v19, v2
    s_add_u32 s44, s35, 0x2a48000
    s_add_u32 s44, s44, s73
    buffer_store_dwordx4 v[52:55], v0, s[20:23], s44 offen sc1
    s_add_u32 s45, s97, 0x6400000
    s_nop 0
    v_lshlrev_b32 v52, 1, v1
    buffer_load_dwordx4 v[52:55], v52, s[12:15], s45 offen nt
    s_setprio 0
    ds_add_rtn_u32 v124, v124, v2
    ds_add_rtn_u32 v125, v125, v2
    ds_add_rtn_u32 v126, v126, v2
    ds_add_rtn_u32 v127, v127, v2
    ds_add_rtn_u32 v36, v36, v2
    ds_add_rtn_u32 v37, v37, v2
    ds_add_rtn_u32 v38, v38, v2
    ds_add_rtn_u32 v39, v39, v2
    s_waitcnt lgkmcnt(0)
    s_barrier
    s_setprio 3
    v_and_b32 v7, -4, v72
    v_lshl_add_u32 v8, v72, 2, v7
    ds_write_b32 v8, v68
    v_lshl_add_u32 v7, v7, 2, v72
    ds_write_b8 v7, v64 offset:16
    v_and_b32 v9, -4, v73
    v_lshl_add_u32 v10, v73, 2, v9
    ds_write_b32 v10, v69
    v_lshl_add_u32 v9, v9, 2, v73
    ds_write_b8_d16_hi v9, v64 offset:16
    v_and_b32 v7, -4, v74
    v_lshl_add_u32 v8, v74, 2, v7
    ds_write_b32 v8, v70
    v_lshl_add_u32 v7, v7, 2, v74
    ds_write_b8 v7, v65 offset:16
    v_and_b32 v9, -4, v75
    v_lshl_add_u32 v10, v75, 2, v9
    ds_write_b32 v10, v71
    v_lshl_add_u32 v9, v9, 2, v75
    ds_write_b8_d16_hi v9, v65 offset:16
    s_add_u32 s46, s35, 0x2a48000
    s_add_u32 s46, s46, s85
    buffer_store_dwordx4 v[56:59], v0, s[20:23], s46 offen sc1
    s_add_u32 s47, s98, 0x6800000
    v_lshlrev_b32 v68, 1, v1
    buffer_load_dwordx4 v[68:71], v68, s[8:11], s47 offen nt
    s_add_u32 s44, s98, 0x6800000
    v_lshlrev_b32 v72, 1, v1
    buffer_load_dwordx4 v[72:75], v72, s[12:15], s44 offen nt
    v_and_b32 v7, -4, v80
    v_lshl_add_u32 v8, v80, 2, v7
    ds_write_b32 v8, v76
    v_lshl_add_u32 v7, v7, 2, v80
    ds_write_b8 v7, v66 offset:16
    v_and_b32 v9, -4, v81
    v_lshl_add_u32 v10, v81, 2, v9
    ds_write_b32 v10, v77
    v_lshl_add_u32 v9, v9, 2, v81
    ds_write_b8_d16_hi v9, v66 offset:16
    v_and_b32 v7, -4, v82
    v_lshl_add_u32 v8, v82, 2, v7
    ds_write_b32 v8, v78
    v_lshl_add_u32 v7, v7, 2, v82
    ds_write_b8 v7, v67 offset:16
    v_and_b32 v9, -4, v83
    v_lshl_add_u32 v10, v83, 2, v9
    ds_write_b32 v10, v79
    v_lshl_add_u32 v9, v9, 2, v83
    ds_write_b8_d16_hi v9, v67 offset:16
    s_add_u32 s45, s98, 0x6800000
    s_lshr_b32 s45, s45, 1
    buffer_load_dwordx2 v[56:57], v1, s[16:19], s45 offen nt
    s_add_u32 s46, s99, 0x6c00000
    s_lshr_b32 s46, s46, 1
    buffer_load_dwordx2 v[58:59], v1, s[16:19], s46 offen nt
    s_add_u32 s47, s99, 0x6c00000
    v_lshlrev_b32 v76, 1, v1
    buffer_load_dwordx4 v[76:79], v76, s[8:11], s47 offen nt
    s_waitcnt vmcnt(10)
    v_lshlrev_b32 v7, 16, v84
    v_and_b32 v8, 0xffff0000, v84
    v_lshlrev_b32 v9, 16, v85
    v_and_b32 v10, 0xffff0000, v85
    v_mul_f32 v7, 0.15915494, v7
    v_mul_f32 v8, 0.15915494, v8
    v_mul_f32 v9, 0.15915494, v9
    v_mul_f32 v10, 0.15915494, v10
    v_mul_hi_u32_u24 v14, 429497, v40
    v_lshrrev_b32 v12, 3, v24
    v_cos_f32 v7, v7
    v_lshlrev_b16 v13, 3, v24
    v_mad_i32_i24 v11, v14, s55, v40
    v_bitop3_b32 v12, v6, v13, v12 bitop3:0xca
    v_lshl_add_u32 v11, v11, 17, s40
    v_lshlrev_b16 v14, 8, v14
    v_lshrrev_b32 v13, 2, v24
    v_add_u32 v40, v12, v11
    v_bitop3_b32 v24, v5, v13, v14 bitop3:0xea
    v_mul_hi_u32_u24 v14, 429497, v41
    v_lshrrev_b32 v12, 3, v25
    v_cos_f32 v8, v8
    v_lshlrev_b16 v13, 3, v25
    v_mad_i32_i24 v11, v14, s55, v41
    v_bitop3_b32 v12, v6, v13, v12 bitop3:0xca
    v_lshl_add_u32 v11, v11, 17, s40
    v_lshlrev_b16 v14, 8, v14
    v_lshrrev_b32 v13, 2, v25
    v_add_u32 v41, v12, v11
    v_bitop3_b32 v25, v5, v13, v14 bitop3:0xea
    v_cvt_pk_bf16_f32 v84, v7, v8
    v_perm_b32 v12, v84, v84, s41
    v_bitop3_b32 v40, v4, v12, v40 bitop3:0xca
    v_perm_b32 v13, v84, v84, s42
    v_bitop3_b32 v41, v4, v13, v41 bitop3:0xca
    v_mul_hi_u32_u24 v14, 429497, v42
    v_lshrrev_b32 v12, 3, v26
    v_cos_f32 v9, v9
    v_lshlrev_b16 v13, 3, v26
    v_mad_i32_i24 v11, v14, s55, v42
    v_bitop3_b32 v12, v6, v13, v12 bitop3:0xca
    v_lshl_add_u32 v11, v11, 17, s40
    v_lshlrev_b16 v14, 8, v14
    v_lshrrev_b32 v13, 2, v26
    v_add_u32 v42, v12, v11
    v_bitop3_b32 v26, v5, v13, v14 bitop3:0xea
    v_mul_hi_u32_u24 v14, 429497, v43
    v_lshrrev_b32 v12, 3, v27
    v_cos_f32 v10, v10
    v_lshlrev_b16 v13, 3, v27
    v_mad_i32_i24 v11, v14, s55, v43
    v_bitop3_b32 v12, v6, v13, v12 bitop3:0xca
    v_lshl_add_u32 v11, v11, 17, s40
    v_lshlrev_b16 v14, 8, v14
    v_lshrrev_b32 v13, 2, v27
    v_add_u32 v43, v12, v11
    v_bitop3_b32 v27, v5, v13, v14 bitop3:0xea
    v_cvt_pk_bf16_f32 v85, v9, v10
    v_perm_b32 v12, v85, v85, s41
    v_bitop3_b32 v42, v4, v12, v42 bitop3:0xca
    v_perm_b32 v13, v85, v85, s42
    v_bitop3_b32 v43, v4, v13, v43 bitop3:0xca
    s_setprio 2
    v_and_b32 v7, -4, v104
    v_lshl_add_u32 v8, v104, 2, v7
    ds_write_b32 v8, v96
    v_lshl_add_u32 v7, v7, 2, v104
    ds_write_b8 v7, v88 offset:16
    v_and_b32 v9, -4, v105
    v_lshl_add_u32 v10, v105, 2, v9
    ds_write_b32 v10, v97
    v_lshl_add_u32 v9, v9, 2, v105
    ds_write_b8_d16_hi v9, v88 offset:16
    v_and_b32 v7, -4, v106
    v_lshl_add_u32 v8, v106, 2, v7
    ds_write_b32 v8, v98
    v_lshl_add_u32 v7, v7, 2, v106
    ds_write_b8 v7, v89 offset:16
    v_and_b32 v9, -4, v107
    v_lshl_add_u32 v10, v107, 2, v9
    ds_write_b32 v10, v99
    v_lshl_add_u32 v9, v9, 2, v107
    ds_write_b8_d16_hi v9, v89 offset:16
    s_add_u32 s44, s35, 0x2a48000
    s_add_u32 s44, s44, s91
    buffer_store_dwordx4 v[60:63], v0, s[20:23], s44 offen sc1
    s_add_u32 s45, s99, 0x6c00000
    v_lshlrev_b32 v80, 1, v1
    buffer_load_dwordx4 v[80:83], v80, s[12:15], s45 offen nt
    s_waitcnt vmcnt(8)
    v_lshlrev_b32 v7, 16, v86
    v_and_b32 v8, 0xffff0000, v86
    v_lshlrev_b32 v9, 16, v87
    v_and_b32 v10, 0xffff0000, v87
    v_mul_f32 v7, 0.15915494, v7
    v_mul_f32 v8, 0.15915494, v8
    v_mul_f32 v9, 0.15915494, v9
    v_mul_f32 v10, 0.15915494, v10
    v_mul_hi_u32_u24 v14, 429497, v48
    v_lshrrev_b32 v12, 3, v52
    v_cos_f32 v7, v7
    v_lshlrev_b16 v13, 3, v52
    v_mad_i32_i24 v11, v14, s55, v48
    v_bitop3_b32 v12, v6, v13, v12 bitop3:0xca
    v_lshl_add_u32 v11, v11, 17, s40
    v_lshlrev_b16 v14, 8, v14
    v_lshrrev_b32 v13, 2, v52
    v_add_u32 v48, v12, v11
    v_bitop3_b32 v52, v5, v13, v14 bitop3:0xea
    v_mul_hi_u32_u24 v14, 429497, v49
    v_lshrrev_b32 v12, 3, v53
    v_cos_f32 v8, v8
    v_lshlrev_b16 v13, 3, v53
    v_mad_i32_i24 v11, v14, s55, v49
    v_bitop3_b32 v12, v6, v13, v12 bitop3:0xca
    v_lshl_add_u32 v11, v11, 17, s40
    v_lshlrev_b16 v14, 8, v14
    v_lshrrev_b32 v13, 2, v53
    v_add_u32 v49, v12, v11
    v_bitop3_b32 v53, v5, v13, v14 bitop3:0xea
    v_cvt_pk_bf16_f32 v86, v7, v8
    v_perm_b32 v12, v86, v86, s41
    v_bitop3_b32 v48, v4, v12, v48 bitop3:0xca
    v_perm_b32 v13, v86, v86, s42
    v_bitop3_b32 v49, v4, v13, v49 bitop3:0xca
    v_mul_hi_u32_u24 v14, 429497, v50
    v_lshrrev_b32 v12, 3, v54
    v_cos_f32 v9, v9
    v_lshlrev_b16 v13, 3, v54
    v_mad_i32_i24 v11, v14, s55, v50
    v_bitop3_b32 v12, v6, v13, v12 bitop3:0xca
    v_lshl_add_u32 v11, v11, 17, s40
    v_lshlrev_b16 v14, 8, v14
    v_lshrrev_b32 v13, 2, v54
    v_add_u32 v50, v12, v11
    v_bitop3_b32 v54, v5, v13, v14 bitop3:0xea
    v_mul_hi_u32_u24 v14, 429497, v51
    v_lshrrev_b32 v12, 3, v55
    v_cos_f32 v10, v10
    v_lshlrev_b16 v13, 3, v55
    v_mad_i32_i24 v11, v14, s55, v51
    v_bitop3_b32 v12, v6, v13, v12 bitop3:0xca
    v_lshl_add_u32 v11, v11, 17, s40
    v_lshlrev_b16 v14, 8, v14
    v_lshrrev_b32 v13, 2, v55
    v_add_u32 v51, v12, v11
    v_bitop3_b32 v55, v5, v13, v14 bitop3:0xea
    v_cvt_pk_bf16_f32 v87, v9, v10
    v_perm_b32 v12, v87, v87, s41
    v_bitop3_b32 v50, v4, v12, v50 bitop3:0xca
    v_perm_b32 v13, v87, v87, s42
    v_bitop3_b32 v51, v4, v13, v51 bitop3:0xca
    v_and_b32 v7, -4, v112
    v_lshl_add_u32 v8, v112, 2, v7
    ds_write_b32 v8, v100
    v_lshl_add_u32 v7, v7, 2, v112
    ds_write_b8 v7, v90 offset:16
    v_and_b32 v9, -4, v113
    v_lshl_add_u32 v10, v113, 2, v9
    ds_write_b32 v10, v101
    v_lshl_add_u32 v9, v9, 2, v113
    ds_write_b8_d16_hi v9, v90 offset:16
    v_and_b32 v7, -4, v114
    v_lshl_add_u32 v8, v114, 2, v7
    ds_write_b32 v8, v102
    v_lshl_add_u32 v7, v7, 2, v114
    ds_write_b8 v7, v91 offset:16
    v_and_b32 v9, -4, v115
    v_lshl_add_u32 v10, v115, 2, v9
    ds_write_b32 v10, v103
    v_lshl_add_u32 v9, v9, 2, v115
    ds_write_b8_d16_hi v9, v91 offset:16
    s_add_u32 s46, s96, 0x7000000
    v_lshlrev_b32 v64, 1, v1
    buffer_load_dwordx4 v[64:67], v64, s[8:11], s46 offen nt
    s_add_u32 s47, s96, 0x7000000
    v_lshlrev_b32 v96, 1, v1
    buffer_load_dwordx4 v[96:99], v96, s[12:15], s47 offen nt
    s_waitcnt vmcnt(5)
    v_lshlrev_b32 v7, 16, v56
    v_and_b32 v8, 0xffff0000, v56
    v_lshlrev_b32 v9, 16, v57
    v_and_b32 v10, 0xffff0000, v57
    v_mul_f32 v7, 0.15915494, v7
    v_mul_f32 v8, 0.15915494, v8
    v_mul_f32 v9, 0.15915494, v9
    v_mul_f32 v10, 0.15915494, v10
    v_mul_hi_u32_u24 v14, 429497, v68
    v_lshrrev_b32 v12, 3, v72
    v_cos_f32 v7, v7
    v_lshlrev_b16 v13, 3, v72
    v_mad_i32_i24 v11, v14, s55, v68
    v_bitop3_b32 v12, v6, v13, v12 bitop3:0xca
    v_lshl_add_u32 v11, v11, 17, s40
    v_lshlrev_b16 v14, 8, v14
    v_lshrrev_b32 v13, 2, v72
    v_add_u32 v68, v12, v11
    v_bitop3_b32 v72, v5, v13, v14 bitop3:0xea
    v_mul_hi_u32_u24 v14, 429497, v69
    v_lshrrev_b32 v12, 3, v73
    v_cos_f32 v8, v8
    v_lshlrev_b16 v13, 3, v73
    v_mad_i32_i24 v11, v14, s55, v69
    v_bitop3_b32 v12, v6, v13, v12 bitop3:0xca
    v_lshl_add_u32 v11, v11, 17, s40
    v_lshlrev_b16 v14, 8, v14
    v_lshrrev_b32 v13, 2, v73
    v_add_u32 v69, v12, v11
    v_bitop3_b32 v73, v5, v13, v14 bitop3:0xea
    v_cvt_pk_bf16_f32 v56, v7, v8
    v_perm_b32 v12, v56, v56, s41
    v_bitop3_b32 v68, v4, v12, v68 bitop3:0xca
    v_perm_b32 v13, v56, v56, s42
    v_bitop3_b32 v69, v4, v13, v69 bitop3:0xca
    v_mul_hi_u32_u24 v14, 429497, v70
    v_lshrrev_b32 v12, 3, v74
    v_cos_f32 v9, v9
    v_lshlrev_b16 v13, 3, v74
    v_mad_i32_i24 v11, v14, s55, v70
    v_bitop3_b32 v12, v6, v13, v12 bitop3:0xca
    v_lshl_add_u32 v11, v11, 17, s40
    v_lshlrev_b16 v14, 8, v14
    v_lshrrev_b32 v13, 2, v74
    v_add_u32 v70, v12, v11
    v_bitop3_b32 v74, v5, v13, v14 bitop3:0xea
    v_mul_hi_u32_u24 v14, 429497, v71
    v_lshrrev_b32 v12, 3, v75
    v_cos_f32 v10, v10
    v_lshlrev_b16 v13, 3, v75
    v_mad_i32_i24 v11, v14, s55, v71
    v_bitop3_b32 v12, v6, v13, v12 bitop3:0xca
    v_lshl_add_u32 v11, v11, 17, s40
    v_lshlrev_b16 v14, 8, v14
    v_lshrrev_b32 v13, 2, v75
    v_add_u32 v71, v12, v11
    v_bitop3_b32 v75, v5, v13, v14 bitop3:0xea
    v_cvt_pk_bf16_f32 v57, v9, v10
    v_perm_b32 v12, v57, v57, s41
    v_bitop3_b32 v70, v4, v12, v70 bitop3:0xca
    v_perm_b32 v13, v57, v57, s42
    v_bitop3_b32 v71, v4, v13, v71 bitop3:0xca
    s_setprio 1
    v_and_b32 v7, -4, v116
    v_lshl_add_u32 v8, v116, 2, v7
    ds_write_b32 v8, v108
    v_lshl_add_u32 v7, v7, 2, v116
    ds_write_b8 v7, v120 offset:16
    v_and_b32 v9, -4, v117
    v_lshl_add_u32 v10, v117, 2, v9
    ds_write_b32 v10, v109
    v_lshl_add_u32 v9, v9, 2, v117
    ds_write_b8_d16_hi v9, v120 offset:16
    v_and_b32 v7, -4, v118
    v_lshl_add_u32 v8, v118, 2, v7
    ds_write_b32 v8, v110
    v_lshl_add_u32 v7, v7, 2, v118
    ds_write_b8 v7, v121 offset:16
    v_and_b32 v9, -4, v119
    v_lshl_add_u32 v10, v119, 2, v9
    ds_write_b32 v10, v111
    v_lshl_add_u32 v9, v9, 2, v119
    ds_write_b8_d16_hi v9, v121 offset:16
    s_add_u32 s44, s96, 0x7000000
    s_lshr_b32 s44, s44, 1
    buffer_load_dwordx2 v[104:105], v1, s[16:19], s44 offen nt
    s_add_u32 s45, s97, 0x7400000
    s_lshr_b32 s45, s45, 1
    buffer_load_dwordx2 v[106:107], v1, s[16:19], s45 offen nt
    s_add_u32 s46, s97, 0x7400000
    v_lshlrev_b32 v60, 1, v1
    buffer_load_dwordx4 v[60:63], v60, s[8:11], s46 offen nt
    v_and_b32 v7, -4, v16
    v_lshl_add_u32 v8, v16, 2, v7
    ds_write_b32 v8, v92
    v_lshl_add_u32 v7, v7, 2, v16
    ds_write_b8 v7, v122 offset:16
    v_and_b32 v9, -4, v17
    v_lshl_add_u32 v10, v17, 2, v9
    ds_write_b32 v10, v93
    v_lshl_add_u32 v9, v9, 2, v17
    ds_write_b8_d16_hi v9, v122 offset:16
    v_and_b32 v7, -4, v18
    v_lshl_add_u32 v8, v18, 2, v7
    ds_write_b32 v8, v94
    v_lshl_add_u32 v7, v7, 2, v18
    ds_write_b8 v7, v123 offset:16
    v_and_b32 v9, -4, v19
    v_lshl_add_u32 v10, v19, 2, v9
    ds_write_b32 v10, v95
    v_lshl_add_u32 v9, v9, 2, v19
    ds_write_b8_d16_hi v9, v123 offset:16
    s_add_u32 s47, s35, 0x2a48000
    s_add_u32 s47, s47, s93
    buffer_store_dwordx4 v[44:47], v0, s[20:23], s47 offen sc1
    s_add_u32 s44, s97, 0x7400000
    v_lshlrev_b32 v100, 1, v1
    buffer_load_dwordx4 v[100:103], v100, s[12:15], s44 offen nt
    s_waitcnt vmcnt(7)
    v_lshlrev_b32 v7, 16, v58
    v_and_b32 v8, 0xffff0000, v58
    v_lshlrev_b32 v9, 16, v59
    v_and_b32 v10, 0xffff0000, v59
    v_mul_f32 v7, 0.15915494, v7
    v_mul_f32 v8, 0.15915494, v8
    v_mul_f32 v9, 0.15915494, v9
    v_mul_f32 v10, 0.15915494, v10
    v_mul_hi_u32_u24 v14, 429497, v76
    v_lshrrev_b32 v12, 3, v80
    v_cos_f32 v7, v7
    v_lshlrev_b16 v13, 3, v80
    v_mad_i32_i24 v11, v14, s55, v76
    v_bitop3_b32 v12, v6, v13, v12 bitop3:0xca
    v_lshl_add_u32 v11, v11, 17, s40
    v_lshlrev_b16 v14, 8, v14
    v_lshrrev_b32 v13, 2, v80
    v_add_u32 v76, v12, v11
    v_bitop3_b32 v80, v5, v13, v14 bitop3:0xea
    v_mul_hi_u32_u24 v14, 429497, v77
    v_lshrrev_b32 v12, 3, v81
    v_cos_f32 v8, v8
    v_lshlrev_b16 v13, 3, v81
    v_mad_i32_i24 v11, v14, s55, v77
    v_bitop3_b32 v12, v6, v13, v12 bitop3:0xca
    v_lshl_add_u32 v11, v11, 17, s40
    v_lshlrev_b16 v14, 8, v14
    v_lshrrev_b32 v13, 2, v81
    v_add_u32 v77, v12, v11
    v_bitop3_b32 v81, v5, v13, v14 bitop3:0xea
    v_cvt_pk_bf16_f32 v58, v7, v8
    v_perm_b32 v12, v58, v58, s41
    v_bitop3_b32 v76, v4, v12, v76 bitop3:0xca
    v_perm_b32 v13, v58, v58, s42
    v_bitop3_b32 v77, v4, v13, v77 bitop3:0xca
    v_mul_hi_u32_u24 v14, 429497, v78
    v_lshrrev_b32 v12, 3, v82
    v_cos_f32 v9, v9
    v_lshlrev_b16 v13, 3, v82
    v_mad_i32_i24 v11, v14, s55, v78
    v_bitop3_b32 v12, v6, v13, v12 bitop3:0xca
    v_lshl_add_u32 v11, v11, 17, s40
    v_lshlrev_b16 v14, 8, v14
    v_lshrrev_b32 v13, 2, v82
    v_add_u32 v78, v12, v11
    v_bitop3_b32 v82, v5, v13, v14 bitop3:0xea
    v_mul_hi_u32_u24 v14, 429497, v79
    v_lshrrev_b32 v12, 3, v83
    v_cos_f32 v10, v10
    v_lshlrev_b16 v13, 3, v83
    v_mad_i32_i24 v11, v14, s55, v79
    v_bitop3_b32 v12, v6, v13, v12 bitop3:0xca
    v_lshl_add_u32 v11, v11, 17, s40
    v_lshlrev_b16 v14, 8, v14
    v_lshrrev_b32 v13, 2, v83
    v_add_u32 v79, v12, v11
    v_bitop3_b32 v83, v5, v13, v14 bitop3:0xea
    v_cvt_pk_bf16_f32 v59, v9, v10
    v_perm_b32 v12, v59, v59, s41
    v_bitop3_b32 v78, v4, v12, v78 bitop3:0xca
    v_perm_b32 v13, v59, v59, s42
    v_bitop3_b32 v79, v4, v13, v79 bitop3:0xca
    s_setprio 0
    v_and_b32 v7, -4, v124
    v_lshl_add_u32 v8, v124, 2, v7
    ds_write_b32 v8, v20
    v_lshl_add_u32 v7, v7, 2, v124
    ds_write_b8 v7, v28 offset:16
    v_and_b32 v9, -4, v125
    v_lshl_add_u32 v10, v125, 2, v9
    ds_write_b32 v10, v21
    v_lshl_add_u32 v9, v9, 2, v125
    ds_write_b8_d16_hi v9, v28 offset:16
    v_and_b32 v7, -4, v126
    v_lshl_add_u32 v8, v126, 2, v7
    ds_write_b32 v8, v22
    v_lshl_add_u32 v7, v7, 2, v126
    ds_write_b8 v7, v29 offset:16
    v_and_b32 v9, -4, v127
    v_lshl_add_u32 v10, v127, 2, v9
    ds_write_b32 v10, v23
    v_lshl_add_u32 v9, v9, 2, v127
    ds_write_b8_d16_hi v9, v29 offset:16
    s_add_u32 s45, s98, 0x7800000
    v_lshlrev_b32 v112, 1, v1
    buffer_load_dwordx4 v[112:115], v112, s[8:11], s45 offen nt
    s_add_u32 s46, s98, 0x7800000
    v_lshlrev_b32 v88, 1, v1
    buffer_load_dwordx4 v[88:91], v88, s[12:15], s46 offen nt
    s_waitcnt vmcnt(5)
    v_lshlrev_b32 v7, 16, v104
    v_and_b32 v8, 0xffff0000, v104
    v_lshlrev_b32 v9, 16, v105
    v_and_b32 v10, 0xffff0000, v105
    v_mul_f32 v7, 0.15915494, v7
    v_mul_f32 v8, 0.15915494, v8
    v_mul_f32 v9, 0.15915494, v9
    v_mul_f32 v10, 0.15915494, v10
    v_mul_hi_u32_u24 v14, 429497, v64
    v_lshrrev_b32 v12, 3, v96
    v_cos_f32 v7, v7
    v_lshlrev_b16 v13, 3, v96
    v_mad_i32_i24 v11, v14, s55, v64
    v_bitop3_b32 v12, v6, v13, v12 bitop3:0xca
    v_lshl_add_u32 v11, v11, 17, s40
    v_lshlrev_b16 v14, 8, v14
    v_lshrrev_b32 v13, 2, v96
    v_add_u32 v64, v12, v11
    v_bitop3_b32 v96, v5, v13, v14 bitop3:0xea
    v_mul_hi_u32_u24 v14, 429497, v65
    v_lshrrev_b32 v12, 3, v97
    v_cos_f32 v8, v8
    v_lshlrev_b16 v13, 3, v97
    v_mad_i32_i24 v11, v14, s55, v65
    v_bitop3_b32 v12, v6, v13, v12 bitop3:0xca
    v_lshl_add_u32 v11, v11, 17, s40
    v_lshlrev_b16 v14, 8, v14
    v_lshrrev_b32 v13, 2, v97
    v_add_u32 v65, v12, v11
    v_bitop3_b32 v97, v5, v13, v14 bitop3:0xea
    v_cvt_pk_bf16_f32 v104, v7, v8
    v_perm_b32 v12, v104, v104, s41
    v_bitop3_b32 v64, v4, v12, v64 bitop3:0xca
    v_perm_b32 v13, v104, v104, s42
    v_bitop3_b32 v65, v4, v13, v65 bitop3:0xca
    v_mul_hi_u32_u24 v14, 429497, v66
    v_lshrrev_b32 v12, 3, v98
    v_cos_f32 v9, v9
    v_lshlrev_b16 v13, 3, v98
    v_mad_i32_i24 v11, v14, s55, v66
    v_bitop3_b32 v12, v6, v13, v12 bitop3:0xca
    v_lshl_add_u32 v11, v11, 17, s40
    v_lshlrev_b16 v14, 8, v14
    v_lshrrev_b32 v13, 2, v98
    v_add_u32 v66, v12, v11
    v_bitop3_b32 v98, v5, v13, v14 bitop3:0xea
    v_mul_hi_u32_u24 v14, 429497, v67
    v_lshrrev_b32 v12, 3, v99
    v_cos_f32 v10, v10
    v_lshlrev_b16 v13, 3, v99
    v_mad_i32_i24 v11, v14, s55, v67
    v_bitop3_b32 v12, v6, v13, v12 bitop3:0xca
    v_lshl_add_u32 v11, v11, 17, s40
    v_lshlrev_b16 v14, 8, v14
    v_lshrrev_b32 v13, 2, v99
    v_add_u32 v67, v12, v11
    v_bitop3_b32 v99, v5, v13, v14 bitop3:0xea
    v_cvt_pk_bf16_f32 v105, v9, v10
    v_perm_b32 v12, v105, v105, s41
    v_bitop3_b32 v66, v4, v12, v66 bitop3:0xca
    v_perm_b32 v13, v105, v105, s42
    v_bitop3_b32 v67, v4, v13, v67 bitop3:0xca
    v_and_b32 v7, -4, v36
    v_lshl_add_u32 v8, v36, 2, v7
    ds_write_b32 v8, v32
    v_lshl_add_u32 v7, v7, 2, v36
    ds_write_b8 v7, v30 offset:16
    v_and_b32 v9, -4, v37
    v_lshl_add_u32 v10, v37, 2, v9
    ds_write_b32 v10, v33
    v_lshl_add_u32 v9, v9, 2, v37
    ds_write_b8_d16_hi v9, v30 offset:16
    v_and_b32 v7, -4, v38
    v_lshl_add_u32 v8, v38, 2, v7
    ds_write_b32 v8, v34
    v_lshl_add_u32 v7, v7, 2, v38
    ds_write_b8 v7, v31 offset:16
    v_and_b32 v9, -4, v39
    v_lshl_add_u32 v10, v39, 2, v9
    ds_write_b32 v10, v35
    v_lshl_add_u32 v9, v9, 2, v39
    ds_write_b8_d16_hi v9, v31 offset:16
    s_add_u32 s47, s98, 0x7800000
    s_lshr_b32 s47, s47, 1
    buffer_load_dwordx2 v[108:109], v1, s[16:19], s47 offen nt
    s_add_u32 s44, s99, 0x7c00000
    s_lshr_b32 s44, s44, 1
    buffer_load_dwordx2 v[110:111], v1, s[16:19], s44 offen nt
    s_waitcnt vmcnt(4)
    v_lshlrev_b32 v7, 16, v106
    v_and_b32 v8, 0xffff0000, v106
    v_lshlrev_b32 v9, 16, v107
    v_and_b32 v10, 0xffff0000, v107
    v_mul_f32 v7, 0.15915494, v7
    v_mul_f32 v8, 0.15915494, v8
    v_mul_f32 v9, 0.15915494, v9
    v_mul_f32 v10, 0.15915494, v10
    v_mul_hi_u32_u24 v14, 429497, v60
    v_lshrrev_b32 v12, 3, v100
    v_cos_f32 v7, v7
    v_lshlrev_b16 v13, 3, v100
    v_mad_i32_i24 v11, v14, s55, v60
    v_bitop3_b32 v12, v6, v13, v12 bitop3:0xca
    v_lshl_add_u32 v11, v11, 17, s40
    v_lshlrev_b16 v14, 8, v14
    v_lshrrev_b32 v13, 2, v100
    v_add_u32 v60, v12, v11
    v_bitop3_b32 v100, v5, v13, v14 bitop3:0xea
    v_mul_hi_u32_u24 v14, 429497, v61
    v_lshrrev_b32 v12, 3, v101
    v_cos_f32 v8, v8
    v_lshlrev_b16 v13, 3, v101
    v_mad_i32_i24 v11, v14, s55, v61
    v_bitop3_b32 v12, v6, v13, v12 bitop3:0xca
    v_lshl_add_u32 v11, v11, 17, s40
    v_lshlrev_b16 v14, 8, v14
    v_lshrrev_b32 v13, 2, v101
    v_add_u32 v61, v12, v11
    v_bitop3_b32 v101, v5, v13, v14 bitop3:0xea
    v_cvt_pk_bf16_f32 v106, v7, v8
    v_perm_b32 v12, v106, v106, s41
    v_bitop3_b32 v60, v4, v12, v60 bitop3:0xca
    v_perm_b32 v13, v106, v106, s42
    v_bitop3_b32 v61, v4, v13, v61 bitop3:0xca
    v_mul_hi_u32_u24 v14, 429497, v62
    v_lshrrev_b32 v12, 3, v102
    v_cos_f32 v9, v9
    v_lshlrev_b16 v13, 3, v102
    v_mad_i32_i24 v11, v14, s55, v62
    v_bitop3_b32 v12, v6, v13, v12 bitop3:0xca
    v_lshl_add_u32 v11, v11, 17, s40
    v_lshlrev_b16 v14, 8, v14
    v_lshrrev_b32 v13, 2, v102
    v_add_u32 v62, v12, v11
    v_bitop3_b32 v102, v5, v13, v14 bitop3:0xea
    v_mul_hi_u32_u24 v14, 429497, v63
    v_lshrrev_b32 v12, 3, v103
    v_cos_f32 v10, v10
    v_lshlrev_b16 v13, 3, v103
    v_mad_i32_i24 v11, v14, s55, v63
    v_bitop3_b32 v12, v6, v13, v12 bitop3:0xca
    v_lshl_add_u32 v11, v11, 17, s40
    v_lshlrev_b16 v14, 8, v14
    v_lshrrev_b32 v13, 2, v103
    v_add_u32 v63, v12, v11
    v_bitop3_b32 v103, v5, v13, v14 bitop3:0xea
    v_cvt_pk_bf16_f32 v107, v9, v10
    v_perm_b32 v12, v107, v107, s41
    v_bitop3_b32 v62, v4, v12, v62 bitop3:0xca
    v_perm_b32 v13, v107, v107, s42
    v_bitop3_b32 v63, v4, v13, v63 bitop3:0xca
    v_add_u32 v7, s72, v0
    v_add_u32 v12, s73, v0
    v_add_u32 v13, s85, v0
    v_add_u32 v14, s91, v0
    v_add_u32 v15, s93, v0
    s_min_i32 s3, s72, s73
    s_min_i32 s3, s3, s85
    s_min_i32 s3, s3, s91
    s_min_i32 s3, s3, s93
    v_add_u32 v3, s3, v0
    v_mov_b32 v8, 0
    v_mov_b32 v9, 0
    v_mov_b32 v10, 0
    v_mov_b32 v11, 0
    s_waitcnt lgkmcnt(0)
    s_barrier
    ds_read_b128 v[116:119], v7 offset:0
    ds_read_b128 v[92:95], v12 offset:0
    ds_read_b128 v[16:19], v13 offset:0
    ds_read_b128 v[120:123], v14 offset:0
    ds_read_b128 v[44:47], v15 offset:0
    ds_write_b128 v3, v[8:11]
    ds_read_b128 v[20:23], v7 offset:16384
    ds_read_b128 v[124:127], v12 offset:16384
    ds_read_b128 v[32:35], v13 offset:16384
    ds_read_b128 v[36:39], v14 offset:16384
    ds_read_b128 v[28:31], v15 offset:16384
    s_waitcnt lgkmcnt(0)
    s_barrier
    s_setprio 3
    s_add_u32 s45, s35, 0x5484000
    s_add_u32 s45, s45, s72
    buffer_store_dwordx4 v[116:119], v0, s[20:23], s45 offen sc1
    s_add_u32 s46, s99, 0x7c00000
    s_nop 0
    v_lshlrev_b32 v116, 1, v1
    buffer_load_dwordx4 v[116:119], v116, s[8:11], s46 offen nt
    s_add_u32 s47, s35, 0x5484000
    s_add_u32 s47, s47, s73
    buffer_store_dwordx4 v[92:95], v0, s[20:23], s47 offen sc1
    s_add_u32 s44, s99, 0x7c00000
    s_nop 0
    v_lshlrev_b32 v92, 1, v1
    buffer_load_dwordx4 v[92:95], v92, s[12:15], s44 offen nt
    ds_add_u32 v24, v2
    ds_add_u32 v25, v2
    ds_add_u32 v26, v2
    ds_add_u32 v27, v2
    ds_add_u32 v52, v2
    ds_add_u32 v53, v2
    ds_add_u32 v54, v2
    ds_add_u32 v55, v2
    s_setprio 2
    ds_add_u32 v72, v2
    ds_add_u32 v73, v2
    ds_add_u32 v74, v2
    ds_add_u32 v75, v2
    ds_add_u32 v80, v2
    ds_add_u32 v81, v2
    ds_add_u32 v82, v2
    ds_add_u32 v83, v2
    s_setprio 1
    s_add_u32 s45, s35, 0x5484000
    s_add_u32 s45, s45, s85
    buffer_store_dwordx4 v[16:19], v0, s[20:23], s45 offen sc1
    s_add_u32 s46, s96, 0x8000000
    s_nop 0
    v_lshlrev_b32 v16, 1, v1
    buffer_load_dwordx4 v[16:19], v16, s[8:11], s46 offen nt
    ds_add_u32 v96, v2
    ds_add_u32 v97, v2
    ds_add_u32 v98, v2
    ds_add_u32 v99, v2
    s_mov_b32 s68, s66
    s_mov_b32 s69, s67
    s_mov_b32 s70, 0x100
    s_mov_b32 s71, 0x20000
    v_mov_b32 v3, 1
    s_cmp_lg_u32 s32, 15
    s_cbranch_scc1 L1_tk
    s_mov_b64 exec, 1
    s_and_b32 s3, s2, 1
    s_lshl_b32 s3, s3, 7
    buffer_atomic_add v3, off, s[68:71], s3 sc0
    s_mov_b64 exec, -1
L1_tk:
    ds_add_u32 v100, v2
    ds_add_u32 v101, v2
    ds_add_u32 v102, v2
    ds_add_u32 v103, v2
    s_setprio 0
    s_waitcnt vmcnt(6)
    v_lshlrev_b32 v7, 16, v108
    v_and_b32 v8, 0xffff0000, v108
    v_lshlrev_b32 v9, 16, v109
    v_and_b32 v10, 0xffff0000, v109
    v_mul_f32 v7, 0.15915494, v7
    v_mul_f32 v8, 0.15915494, v8
    v_mul_f32 v9, 0.15915494, v9
    v_mul_f32 v10, 0.15915494, v10
    v_mul_hi_u32_u24 v14, 429497, v112
    v_lshrrev_b32 v12, 3, v88
    v_cos_f32 v7, v7
    v_lshlrev_b16 v13, 3, v88
    v_mad_i32_i24 v11, v14, s55, v112
    v_bitop3_b32 v12, v6, v13, v12 bitop3:0xca
    v_lshl_add_u32 v11, v11, 17, s40
    v_lshlrev_b16 v14, 8, v14
    v_lshrrev_b32 v13, 2, v88
    v_add_u32 v112, v12, v11
    v_bitop3_b32 v88, v5, v13, v14 bitop3:0xea
    ds_add_u32 v88, v2
    v_mul_hi_u32_u24 v14, 429497, v113
    v_lshrrev_b32 v12, 3, v89
    v_cos_f32 v8, v8
    v_lshlrev_b16 v13, 3, v89
    v_mad_i32_i24 v11, v14, s55, v113
    v_bitop3_b32 v12, v6, v13, v12 bitop3:0xca
    v_lshl_add_u32 v11, v11, 17, s40
    v_lshlrev_b16 v14, 8, v14
    v_lshrrev_b32 v13, 2, v89
    v_add_u32 v113, v12, v11
    v_bitop3_b32 v89, v5, v13, v14 bitop3:0xea
    ds_add_u32 v89, v2
    v_cvt_pk_bf16_f32 v108, v7, v8
    v_perm_b32 v12, v108, v108, s41
    v_bitop3_b32 v112, v4, v12, v112 bitop3:0xca
    v_perm_b32 v13, v108, v108, s42
    v_bitop3_b32 v113, v4, v13, v113 bitop3:0xca
    v_mul_hi_u32_u24 v14, 429497, v114
    v_lshrrev_b32 v12, 3, v90
    v_cos_f32 v9, v9
    v_lshlrev_b16 v13, 3, v90
    v_mad_i32_i24 v11, v14, s55, v114
    v_bitop3_b32 v12, v6, v13, v12 bitop3:0xca
    v_lshl_add_u32 v11, v11, 17, s40
    v_lshlrev_b16 v14, 8, v14
    v_lshrrev_b32 v13, 2, v90
    v_add_u32 v114, v12, v11
    v_bitop3_b32 v90, v5, v13, v14 bitop3:0xea
    ds_add_u32 v90, v2
    v_mul_hi_u32_u24 v14, 429497, v115
    v_lshrrev_b32 v12, 3, v91
    v_cos_f32 v10, v10
    v_lshlrev_b16 v13, 3, v91
    v_mad_i32_i24 v11, v14, s55, v115
    v_bitop3_b32 v12, v6, v13, v12 bitop3:0xca
    v_lshl_add_u32 v11, v11, 17, s40
    v_lshlrev_b16 v14, 8, v14
    v_lshrrev_b32 v13, 2, v91
    v_add_u32 v115, v12, v11
    v_bitop3_b32 v91, v5, v13, v14 bitop3:0xea
    ds_add_u32 v91, v2
    v_cvt_pk_bf16_f32 v109, v9, v10
    v_perm_b32 v12, v109, v109, s41
    v_bitop3_b32 v114, v4, v12, v114 bitop3:0xca
    v_perm_b32 v13, v109, v109, s42
    v_bitop3_b32 v115, v4, v13, v115 bitop3:0xca
    s_waitcnt vmcnt(2)
    v_lshlrev_b32 v7, 16, v110
    v_and_b32 v8, 0xffff0000, v110
    v_lshlrev_b32 v9, 16, v111
    v_and_b32 v10, 0xffff0000, v111
    v_mul_f32 v7, 0.15915494, v7
    v_mul_f32 v8, 0.15915494, v8
    v_mul_f32 v9, 0.15915494, v9
    v_mul_f32 v10, 0.15915494, v10
    v_mul_hi_u32_u24 v14, 429497, v116
    v_lshrrev_b32 v12, 3, v92
    v_cos_f32 v7, v7
    v_lshlrev_b16 v13, 3, v92
    v_mad_i32_i24 v11, v14, s55, v116
    v_bitop3_b32 v12, v6, v13, v12 bitop3:0xca
    v_lshl_add_u32 v11, v11, 17, s40
    v_lshlrev_b16 v14, 8, v14
    v_lshrrev_b32 v13, 2, v92
    v_add_u32 v116, v12, v11
    v_bitop3_b32 v92, v5, v13, v14 bitop3:0xea
    ds_add_u32 v92, v2
    v_mul_hi_u32_u24 v14, 429497, v117
    v_lshrrev_b32 v12, 3, v93
    v_cos_f32 v8, v8
    v_lshlrev_b16 v13, 3, v93
    v_mad_i32_i24 v11, v14, s55, v117
    v_bitop3_b32 v12, v6, v13, v12 bitop3:0xca
    v_lshl_add_u32 v11, v11, 17, s40
    v_lshlrev_b16 v14, 8, v14
    v_lshrrev_b32 v13, 2, v93
    v_add_u32 v117, v12, v11
    v_bitop3_b32 v93, v5, v13, v14 bitop3:0xea
    ds_add_u32 v93, v2
    v_cvt_pk_bf16_f32 v110, v7, v8
    v_perm_b32 v12, v110, v110, s41
    v_bitop3_b32 v116, v4, v12, v116 bitop3:0xca
    v_perm_b32 v13, v110, v110, s42
    v_bitop3_b32 v117, v4, v13, v117 bitop3:0xca
    v_mul_hi_u32_u24 v14, 429497, v118
    v_lshrrev_b32 v12, 3, v94
    v_cos_f32 v9, v9
    v_lshlrev_b16 v13, 3, v94
    v_mad_i32_i24 v11, v14, s55, v118
    v_bitop3_b32 v12, v6, v13, v12 bitop3:0xca
    v_lshl_add_u32 v11, v11, 17, s40
    v_lshlrev_b16 v14, 8, v14
    v_lshrrev_b32 v13, 2, v94
    v_add_u32 v118, v12, v11
    v_bitop3_b32 v94, v5, v13, v14 bitop3:0xea
    ds_add_u32 v94, v2
    v_mul_hi_u32_u24 v14, 429497, v119
    v_lshrrev_b32 v12, 3, v95
    v_cos_f32 v10, v10
    v_lshlrev_b16 v13, 3, v95
    v_mad_i32_i24 v11, v14, s55, v119
    v_bitop3_b32 v12, v6, v13, v12 bitop3:0xca
    v_lshl_add_u32 v11, v11, 17, s40
    v_lshlrev_b16 v14, 8, v14
    v_lshrrev_b32 v13, 2, v95
    v_add_u32 v119, v12, v11
    v_bitop3_b32 v95, v5, v13, v14 bitop3:0xea
    ds_add_u32 v95, v2
    v_cvt_pk_bf16_f32 v111, v9, v10
    v_perm_b32 v12, v111, v111, s41
    v_bitop3_b32 v118, v4, v12, v118 bitop3:0xca
    v_perm_b32 v13, v111, v111, s42
    v_bitop3_b32 v119, v4, v13, v119 bitop3:0xca
    v_lshrrev_b32 v8, 2, v0
    v_and_b32 v7, 0x3c00, v0
    v_bitop3_b32 v7, v5, v8, v7 bitop3:0xea
    s_waitcnt lgkmcnt(0)
    s_barrier
    ds_read2st64_b32 v[8:9], v7 offset0:0 offset1:1
    ds_read2st64_b32 v[10:11], v7 offset0:2 offset1:3
    s_add_u32 s47, s35, 0x5484000
    s_add_u32 s47, s47, s91
    buffer_store_dwordx4 v[120:123], v0, s[20:23], s47 offen sc1
    s_add_u32 s44, s96, 0x8000000
    s_nop 0
    v_lshlrev_b32 v120, 1, v1
    buffer_load_dwordx4 v[120:123], v120, s[12:15], s44 offen nt
    s_waitcnt lgkmcnt(0)
    v_lshl_or_b32 v12, v9, 16, v8
    v_lshl_or_b32 v13, v11, 16, v10
    v_mov_b32 v14, v12
    v_mov_b32 v15, v13
    s_nop 0
    v_add_u32_dpp v14, v14, v14 row_shr:1 row_mask:0xf bank_mask:0xf bound_ctrl:1
    v_add_u32_dpp v15, v15, v15 row_shr:1 row_mask:0xf bank_mask:0xf bound_ctrl:1
    s_nop 0
    v_add_u32_dpp v14, v14, v14 row_shr:2 row_mask:0xf bank_mask:0xf bound_ctrl:1
    v_add_u32_dpp v15, v15, v15 row_shr:2 row_mask:0xf bank_mask:0xf bound_ctrl:1
    s_nop 0
    v_add_u32_dpp v14, v14, v14 row_shr:4 row_mask:0xf bank_mask:0xf bound_ctrl:1
    v_add_u32_dpp v15, v15, v15 row_shr:4 row_mask:0xf bank_mask:0xf bound_ctrl:1
    s_nop 0
    v_add_u32_dpp v14, v14, v14 row_shr:8 row_mask:0xf bank_mask:0xf bound_ctrl:1
    v_add_u32_dpp v15, v15, v15 row_shr:8 row_mask:0xf bank_mask:0xf bound_ctrl:1
    s_nop 0
    v_add_u32_dpp v14, v14, v14 row_bcast:15 row_mask:0xa bank_mask:0xf
    v_add_u32_dpp v15, v15, v15 row_bcast:15 row_mask:0xa bank_mask:0xf
    s_nop 0
    v_add_u32_dpp v14, v14, v14 row_bcast:31 row_mask:0xc bank_mask:0xf
    v_add_u32_dpp v15, v15, v15 row_bcast:31 row_mask:0xc bank_mask:0xf
    v_readlane_b32 s48, v14, 63
    v_readlane_b32 s49, v15, 63
    s_lshl_b32 s54, s32, 2
    v_mov_b32 v8, s54
    s_and_b32 s50, s48, 0xffff
    s_lshr_b32 s51, s48, 16
    s_and_b32 s52, s49, 0xffff
    s_lshr_b32 s53, s49, 16
    s_add_u32 s51, s51, s50
    s_add_u32 s52, s52, s51
    s_add_u32 s53, s53, s52
    v_mov_b32 v9, s53
    s_mov_b64 exec, 1
    ds_write_b32 v8, v9 offset:16384
    s_cmp_lg_u32 s32, 15
    s_cbranch_scc1 L1_tk2
    s_waitcnt vmcnt(1)
L1_tk2:
    ds_write_b32 v8, v3 offset:16448
    s_mov_b64 exec, -1
    v_and_b32 v8, 60, v7
    s_waitcnt lgkmcnt(0)
    s_barrier
    ds_read_b32 v9, v8 offset:16384
    ds_read_b32 v10, v8 offset:16448
    s_waitcnt lgkmcnt(0)
    v_readlane_b32 s84, v10, 15
    s_and_b32 s3, s2, 1
    s_lshl_b32 s3, s3, 7
    s_add_u32 s84, s84, s3
    s_and_b32 s4, s84, 127
    s_lshl_b32 s6, s32, 10
    s_mov_b32 s43, 5
    s_bitcmp1_b32 s2, 0
    s_cselect_b32 s5, 128, 0
    s_mov_b32 s7, 128
    s_cselect_b32 s7, 124, s7
    s_add_u32 s5, s5, s4
    s_add_u32 s5, s5, 9472
    s_lshl_b32 s5, s5, 14
    s_add_u32 s38, s5, s6
    s_cmp_lt_u32 s4, s7
    s_addc_u32 s43, s43, 0
    s_bitcmp1_b32 s2, 0
    s_cselect_b32 s5, 112, 0
    s_mov_b32 s7, 112
    s_cselect_b32 s7, 100, s7
    s_add_u32 s5, s5, s4
    s_add_u32 s5, s5, 9724
    s_lshl_b32 s5, s5, 14
    s_add_u32 s39, s5, s6
    s_cmp_lt_u32 s4, s7
    s_addc_u32 s43, s43, 0
    s_bitcmp1_b32 s2, 0
    s_cselect_b32 s5, 64, 0
    s_mov_b32 s7, 64
    s_cselect_b32 s7, 0, s7
    s_add_u32 s5, s5, s4
    s_add_u32 s5, s5, 9936
    s_lshl_b32 s5, s5, 14
    s_add_u32 s58, s5, s6
    s_cmp_lt_u32 s4, s7
    s_addc_u32 s43, s43, 0
    v_add_u32_dpp v9, v9, v9 row_shr:1 row_mask:0xf bank_mask:0xf bound_ctrl:1
    s_nop 1
    v_add_u32_dpp v9, v9, v9 row_shr:2 row_mask:0xf bank_mask:0xf bound_ctrl:1
    s_nop 1
    v_add_u32_dpp v9, v9, v9 row_shr:4 row_mask:0xf bank_mask:0xf bound_ctrl:1
    s_nop 1
    v_add_u32_dpp v9, v9, v9 row_shr:8 row_mask:0xf bank_mask:0xf bound_ctrl:1
    s_nop 0
    v_readlane_b32 s54, v9, s32
    s_sub_u32 s54, s54, s53
    s_add_u32 s50, s50, s54
    s_add_u32 s51, s51, s54
    s_add_u32 s52, s52, s54
    s_pack_ll_b32_b16 s48, s54, s50
    s_pack_ll_b32_b16 s49, s51, s52
    v_add_u32 v14, s48, v14
    v_add_u32 v15, s49, v15
    v_sub_u32 v12, v14, v12
    v_sub_u32 v13, v15, v13
    v_and_b32 v8, 0xffff, v12
    v_lshrrev_b32 v9, 16, v12
    v_and_b32 v10, 0xffff, v13
    v_lshrrev_b32 v11, 16, v13
    ds_write2st64_b32 v7, v8, v9 offset0:0 offset1:1
    ds_write2st64_b32 v7, v10, v11 offset0:2 offset1:3
    v_and_b32 v8, 0x3f0, v0
    v_lshl_add_u32 v8, v8, 1, s36
    ds_write_b64 v8, v[12:13] offset:20480
    s_bitset0_b64 exec, 63
    s_not_b64 exec, exec
    ds_write_b64 v8, v[14:15] offset:20512
    s_mov_b64 exec, -1
    s_waitcnt lgkmcnt(0)
    s_barrier
    s_setprio 3
    ds_add_rtn_u32 v24, v24, v2
    ds_add_rtn_u32 v25, v25, v2
    ds_add_rtn_u32 v26, v26, v2
    ds_add_rtn_u32 v27, v27, v2
    ds_read_b128 v[12:15], v0 offset:20480
    v_cmp_gt_u32 vcc, 8448, v0
    s_add_u32 s45, s35, 0x5484000
    s_add_u32 s45, s45, s93
    buffer_store_dwordx4 v[44:47], v0, s[20:23], s45 offen sc1
    s_add_u32 s46, s96, 0x8000000
    s_lshr_b32 s46, s46, 1
    buffer_load_dwordx2 v[44:45], v1, s[16:19], s46 offen nt
    s_add_u32 s47, s97, 0x8400000
    s_lshr_b32 s47, s47, 1
    buffer_load_dwordx2 v[46:47], v1, s[16:19], s47 offen nt
    ds_add_rtn_u32 v52, v52, v2
    ds_add_rtn_u32 v53, v53, v2
    ds_add_rtn_u32 v54, v54, v2
    ds_add_rtn_u32 v55, v55, v2
    s_setprio 2
    ds_add_rtn_u32 v72, v72, v2
    ds_add_rtn_u32 v73, v73, v2
    ds_add_rtn_u32 v74, v74, v2
    ds_add_rtn_u32 v75, v75, v2
    s_waitcnt lgkmcnt(8)
    s_cbranch_vccz L1_p4
    s_add_u32 s44, s35, 0x7ec0000
    s_mov_b64 exec, vcc
    buffer_store_dwordx4 v[12:15], v0, s[24:27], s44 offen sc1
    s_mov_b64 exec, -1
L1_p4:
    s_add_u32 s45, s35, 0x5488000
    s_add_u32 s45, s45, s72
    buffer_store_dwordx4 v[20:23], v0, s[20:23], s45 offen sc1
    s_add_u32 s46, s97, 0x8400000
    s_nop 0
    v_lshlrev_b32 v20, 1, v1
    buffer_load_dwordx4 v[20:23], v20, s[8:11], s46 offen nt
    ds_add_rtn_u32 v80, v80, v2
    ds_add_rtn_u32 v81, v81, v2
    ds_add_rtn_u32 v82, v82, v2
    ds_add_rtn_u32 v83, v83, v2
    s_setprio 1
    ds_add_rtn_u32 v96, v96, v2
    ds_add_rtn_u32 v97, v97, v2
    ds_add_rtn_u32 v98, v98, v2
    ds_add_rtn_u32 v99, v99, v2
    ds_add_rtn_u32 v100, v100, v2
    ds_add_rtn_u32 v101, v101, v2
    ds_add_rtn_u32 v102, v102, v2
    ds_add_rtn_u32 v103, v103, v2
    s_add_u32 s47, s35, 0x5488000
    s_add_u32 s47, s47, s73
    buffer_store_dwordx4 v[124:127], v0, s[20:23], s47 offen sc1
    s_add_u32 s44, s97, 0x8400000
    s_nop 0
    v_lshlrev_b32 v124, 1, v1
    buffer_load_dwordx4 v[124:127], v124, s[12:15], s44 offen nt
    s_setprio 0
    ds_add_rtn_u32 v88, v88, v2
    ds_add_rtn_u32 v89, v89, v2
    ds_add_rtn_u32 v90, v90, v2
    ds_add_rtn_u32 v91, v91, v2
    ds_add_rtn_u32 v92, v92, v2
    ds_add_rtn_u32 v93, v93, v2
    ds_add_rtn_u32 v94, v94, v2
    ds_add_rtn_u32 v95, v95, v2
    s_waitcnt lgkmcnt(0)
    s_barrier
    s_setprio 3
    v_and_b32 v7, -4, v24
    v_lshl_add_u32 v8, v24, 2, v7
    ds_write_b32 v8, v40
    v_lshl_add_u32 v7, v7, 2, v24
    ds_write_b8 v7, v84 offset:16
    v_and_b32 v9, -4, v25
    v_lshl_add_u32 v10, v25, 2, v9
    ds_write_b32 v10, v41
    v_lshl_add_u32 v9, v9, 2, v25
    ds_write_b8_d16_hi v9, v84 offset:16
    v_and_b32 v7, -4, v26
    v_lshl_add_u32 v8, v26, 2, v7
    ds_write_b32 v8, v42
    v_lshl_add_u32 v7, v7, 2, v26
    ds_write_b8 v7, v85 offset:16
    v_and_b32 v9, -4, v27
    v_lshl_add_u32 v10, v27, 2, v9
    ds_write_b32 v10, v43
    v_lshl_add_u32 v9, v9, 2, v27
    ds_write_b8_d16_hi v9, v85 offset:16
    s_add_u32 s45, s35, 0x5488000
    s_add_u32 s45, s45, s85
    buffer_store_dwordx4 v[32:35], v0, s[20:23], s45 offen sc1
    s_add_u32 s46, s98, 0x8800000
    v_lshlrev_b32 v40, 1, v1
    buffer_load_dwordx4 v[40:43], v40, s[8:11], s46 offen nt
    s_add_u32 s47, s98, 0x8800000
    v_lshlrev_b32 v24, 1, v1
    buffer_load_dwordx4 v[24:27], v24, s[12:15], s47 offen nt
    v_and_b32 v7, -4, v52
    v_lshl_add_u32 v8, v52, 2, v7
    ds_write_b32 v8, v48
    v_lshl_add_u32 v7, v7, 2, v52
    ds_write_b8 v7, v86 offset:16
    v_and_b32 v9, -4, v53
    v_lshl_add_u32 v10, v53, 2, v9
    ds_write_b32 v10, v49
    v_lshl_add_u32 v9, v9, 2, v53
    ds_write_b8_d16_hi v9, v86 offset:16
    v_and_b32 v7, -4, v54
    v_lshl_add_u32 v8, v54, 2, v7
    ds_write_b32 v8, v50
    v_lshl_add_u32 v7, v7, 2, v54
    ds_write_b8 v7, v87 offset:16
    v_and_b32 v9, -4, v55
    v_lshl_add_u32 v10, v55, 2, v9
    ds_write_b32 v10, v51
    v_lshl_add_u32 v9, v9, 2, v55
    ds_write_b8_d16_hi v9, v87 offset:16
    s_add_u32 s44, s98, 0x8800000
    s_lshr_b32 s44, s44, 1
    buffer_load_dwordx2 v[32:33], v1, s[16:19], s44 offen nt
    s_add_u32 s45, s99, 0x8c00000
    s_lshr_b32 s45, s45, 1
    buffer_load_dwordx2 v[34:35], v1, s[16:19], s45 offen nt
    s_add_u32 s46, s99, 0x8c00000
    v_lshlrev_b32 v48, 1, v1
    buffer_load_dwordx4 v[48:51], v48, s[8:11], s46 offen nt
    s_waitcnt vmcnt(10)
    v_lshlrev_b32 v7, 16, v44
    v_and_b32 v8, 0xffff0000, v44
    v_lshlrev_b32 v9, 16, v45
    v_and_b32 v10, 0xffff0000, v45
    v_mul_f32 v7, 0.15915494, v7
    v_mul_f32 v8, 0.15915494, v8
    v_mul_f32 v9, 0.15915494, v9
    v_mul_f32 v10, 0.15915494, v10
    v_mul_hi_u32_u24 v14, 429497, v16
    v_lshrrev_b32 v12, 3, v120
    v_cos_f32 v7, v7
    v_lshlrev_b16 v13, 3, v120
    v_mad_i32_i24 v11, v14, s55, v16
    v_bitop3_b32 v12, v6, v13, v12 bitop3:0xca
    v_lshl_add_u32 v11, v11, 17, s40
    v_lshlrev_b16 v14, 8, v14
    v_lshrrev_b32 v13, 2, v120
    v_add_u32 v16, v12, v11
    v_bitop3_b32 v120, v5, v13, v14 bitop3:0xea
    v_mul_hi_u32_u24 v14, 429497, v17
    v_lshrrev_b32 v12, 3, v121
    v_cos_f32 v8, v8
    v_lshlrev_b16 v13, 3, v121
    v_mad_i32_i24 v11, v14, s55, v17
    v_bitop3_b32 v12, v6, v13, v12 bitop3:0xca
    v_lshl_add_u32 v11, v11, 17, s40
    v_lshlrev_b16 v14, 8, v14
    v_lshrrev_b32 v13, 2, v121
    v_add_u32 v17, v12, v11
    v_bitop3_b32 v121, v5, v13, v14 bitop3:0xea
    v_cvt_pk_bf16_f32 v44, v7, v8
    v_perm_b32 v12, v44, v44, s41
    v_bitop3_b32 v16, v4, v12, v16 bitop3:0xca
    v_perm_b32 v13, v44, v44, s42
    v_bitop3_b32 v17, v4, v13, v17 bitop3:0xca
    v_mul_hi_u32_u24 v14, 429497, v18
    v_lshrrev_b32 v12, 3, v122
    v_cos_f32 v9, v9
    v_lshlrev_b16 v13, 3, v122
    v_mad_i32_i24 v11, v14, s55, v18
    v_bitop3_b32 v12, v6, v13, v12 bitop3:0xca
    v_lshl_add_u32 v11, v11, 17, s40
    v_lshlrev_b16 v14, 8, v14
    v_lshrrev_b32 v13, 2, v122
    v_add_u32 v18, v12, v11
    v_bitop3_b32 v122, v5, v13, v14 bitop3:0xea
    v_mul_hi_u32_u24 v14, 429497, v19
    v_lshrrev_b32 v12, 3, v123
    v_cos_f32 v10, v10
    v_lshlrev_b16 v13, 3, v123
    v_mad_i32_i24 v11, v14, s55, v19
    v_bitop3_b32 v12, v6, v13, v12 bitop3:0xca
    v_lshl_add_u32 v11, v11, 17, s40
    v_lshlrev_b16 v14, 8, v14
    v_lshrrev_b32 v13, 2, v123
    v_add_u32 v19, v12, v11
    v_bitop3_b32 v123, v5, v13, v14 bitop3:0xea
    v_cvt_pk_bf16_f32 v45, v9, v10
    v_perm_b32 v12, v45, v45, s41
    v_bitop3_b32 v18, v4, v12, v18 bitop3:0xca
    v_perm_b32 v13, v45, v45, s42
    v_bitop3_b32 v19, v4, v13, v19 bitop3:0xca
    s_setprio 2
    v_and_b32 v7, -4, v72
    v_lshl_add_u32 v8, v72, 2, v7
    ds_write_b32 v8, v68
    v_lshl_add_u32 v7, v7, 2, v72
    ds_write_b8 v7, v56 offset:16
    v_and_b32 v9, -4, v73
    v_lshl_add_u32 v10, v73, 2, v9
    ds_write_b32 v10, v69
    v_lshl_add_u32 v9, v9, 2, v73
    ds_write_b8_d16_hi v9, v56 offset:16
    v_and_b32 v7, -4, v74
    v_lshl_add_u32 v8, v74, 2, v7
    ds_write_b32 v8, v70
    v_lshl_add_u32 v7, v7, 2, v74
    ds_write_b8 v7, v57 offset:16
    v_and_b32 v9, -4, v75
    v_lshl_add_u32 v10, v75, 2, v9
    ds_write_b32 v10, v71
    v_lshl_add_u32 v9, v9, 2, v75
    ds_write_b8_d16_hi v9, v57 offset:16
    s_add_u32 s47, s35, 0x5488000
    s_add_u32 s47, s47, s91
    buffer_store_dwordx4 v[36:39], v0, s[20:23], s47 offen sc1
    s_add_u32 s44, s99, 0x8c00000
    v_lshlrev_b32 v52, 1, v1
    buffer_load_dwordx4 v[52:55], v52, s[12:15], s44 offen nt
    s_waitcnt vmcnt(8)
    v_lshlrev_b32 v7, 16, v46
    v_and_b32 v8, 0xffff0000, v46
    v_lshlrev_b32 v9, 16, v47
    v_and_b32 v10, 0xffff0000, v47
    v_mul_f32 v7, 0.15915494, v7
    v_mul_f32 v8, 0.15915494, v8
    v_mul_f32 v9, 0.15915494, v9
    v_mul_f32 v10, 0.15915494, v10
    v_mul_hi_u32_u24 v14, 429497, v20
    v_lshrrev_b32 v12, 3, v124
    v_cos_f32 v7, v7
    v_lshlrev_b16 v13, 3, v124
    v_mad_i32_i24 v11, v14, s55, v20
    v_bitop3_b32 v12, v6, v13, v12 bitop3:0xca
    v_lshl_add_u32 v11, v11, 17, s40
    v_lshlrev_b16 v14, 8, v14
    v_lshrrev_b32 v13, 2, v124
    v_add_u32 v20, v12, v11
    v_bitop3_b32 v124, v5, v13, v14 bitop3:0xea
    v_mul_hi_u32_u24 v14, 429497, v21
    v_lshrrev_b32 v12, 3, v125
    v_cos_f32 v8, v8
    v_lshlrev_b16 v13, 3, v125
    v_mad_i32_i24 v11, v14, s55, v21
    v_bitop3_b32 v12, v6, v13, v12 bitop3:0xca
    v_lshl_add_u32 v11, v11, 17, s40
    v_lshlrev_b16 v14, 8, v14
    v_lshrrev_b32 v13, 2, v125
    v_add_u32 v21, v12, v11
    v_bitop3_b32 v125, v5, v13, v14 bitop3:0xea
    v_cvt_pk_bf16_f32 v46, v7, v8
    v_perm_b32 v12, v46, v46, s41
    v_bitop3_b32 v20, v4, v12, v20 bitop3:0xca
    v_perm_b32 v13, v46, v46, s42
    v_bitop3_b32 v21, v4, v13, v21 bitop3:0xca
    v_mul_hi_u32_u24 v14, 429497, v22
    v_lshrrev_b32 v12, 3, v126
    v_cos_f32 v9, v9
    v_lshlrev_b16 v13, 3, v126
    v_mad_i32_i24 v11, v14, s55, v22
    v_bitop3_b32 v12, v6, v13, v12 bitop3:0xca
    v_lshl_add_u32 v11, v11, 17, s40
    v_lshlrev_b16 v14, 8, v14
    v_lshrrev_b32 v13, 2, v126
    v_add_u32 v22, v12, v11
    v_bitop3_b32 v126, v5, v13, v14 bitop3:0xea
    v_mul_hi_u32_u24 v14, 429497, v23
    v_lshrrev_b32 v12, 3, v127
    v_cos_f32 v10, v10
    v_lshlrev_b16 v13, 3, v127
    v_mad_i32_i24 v11, v14, s55, v23
    v_bitop3_b32 v12, v6, v13, v12 bitop3:0xca
    v_lshl_add_u32 v11, v11, 17, s40
    v_lshlrev_b16 v14, 8, v14
    v_lshrrev_b32 v13, 2, v127
    v_add_u32 v23, v12, v11
    v_bitop3_b32 v127, v5, v13, v14 bitop3:0xea
    v_cvt_pk_bf16_f32 v47, v9, v10
    v_perm_b32 v12, v47, v47, s41
    v_bitop3_b32 v22, v4, v12, v22 bitop3:0xca
    v_perm_b32 v13, v47, v47, s42
    v_bitop3_b32 v23, v4, v13, v23 bitop3:0xca
    v_and_b32 v7, -4, v80
    v_lshl_add_u32 v8, v80, 2, v7
    ds_write_b32 v8, v76
    v_lshl_add_u32 v7, v7, 2, v80
    ds_write_b8 v7, v58 offset:16
    v_and_b32 v9, -4, v81
    v_lshl_add_u32 v10, v81, 2, v9
    ds_write_b32 v10, v77
    v_lshl_add_u32 v9, v9, 2, v81
    ds_write_b8_d16_hi v9, v58 offset:16
    v_and_b32 v7, -4, v82
    v_lshl_add_u32 v8, v82, 2, v7
    ds_write_b32 v8, v78
    v_lshl_add_u32 v7, v7, 2, v82
    ds_write_b8 v7, v59 offset:16
    v_and_b32 v9, -4, v83
    v_lshl_add_u32 v10, v83, 2, v9
    ds_write_b32 v10, v79
    v_lshl_add_u32 v9, v9, 2, v83
    ds_write_b8_d16_hi v9, v59 offset:16
    s_add_u32 s45, s96, 0x9000000
    v_lshlrev_b32 v84, 1, v1
    buffer_load_dwordx4 v[84:87], v84, s[8:11], s45 offen nt
    s_add_u32 s46, s96, 0x9000000
    v_lshlrev_b32 v68, 1, v1
    buffer_load_dwordx4 v[68:71], v68, s[12:15], s46 offen nt
    s_waitcnt vmcnt(5)
    v_lshlrev_b32 v7, 16, v32
    v_and_b32 v8, 0xffff0000, v32
    v_lshlrev_b32 v9, 16, v33
    v_and_b32 v10, 0xffff0000, v33
    v_mul_f32 v7, 0.15915494, v7
    v_mul_f32 v8, 0.15915494, v8
    v_mul_f32 v9, 0.15915494, v9
    v_mul_f32 v10, 0.15915494, v10
    v_mul_hi_u32_u24 v14, 429497, v40
    v_lshrrev_b32 v12, 3, v24
    v_cos_f32 v7, v7
    v_lshlrev_b16 v13, 3, v24
    v_mad_i32_i24 v11, v14, s55, v40
    v_bitop3_b32 v12, v6, v13, v12 bitop3:0xca
    v_lshl_add_u32 v11, v11, 17, s40
    v_lshlrev_b16 v14, 8, v14
    v_lshrrev_b32 v13, 2, v24
    v_add_u32 v40, v12, v11
    v_bitop3_b32 v24, v5, v13, v14 bitop3:0xea
    v_mul_hi_u32_u24 v14, 429497, v41
    v_lshrrev_b32 v12, 3, v25
    v_cos_f32 v8, v8
    v_lshlrev_b16 v13, 3, v25
    v_mad_i32_i24 v11, v14, s55, v41
    v_bitop3_b32 v12, v6, v13, v12 bitop3:0xca
    v_lshl_add_u32 v11, v11, 17, s40
    v_lshlrev_b16 v14, 8, v14
    v_lshrrev_b32 v13, 2, v25
    v_add_u32 v41, v12, v11
    v_bitop3_b32 v25, v5, v13, v14 bitop3:0xea
    v_cvt_pk_bf16_f32 v32, v7, v8
    v_perm_b32 v12, v32, v32, s41
    v_bitop3_b32 v40, v4, v12, v40 bitop3:0xca
    v_perm_b32 v13, v32, v32, s42
    v_bitop3_b32 v41, v4, v13, v41 bitop3:0xca
    v_mul_hi_u32_u24 v14, 429497, v42
    v_lshrrev_b32 v12, 3, v26
    v_cos_f32 v9, v9
    v_lshlrev_b16 v13, 3, v26
    v_mad_i32_i24 v11, v14, s55, v42
    v_bitop3_b32 v12, v6, v13, v12 bitop3:0xca
    v_lshl_add_u32 v11, v11, 17, s40
    v_lshlrev_b16 v14, 8, v14
    v_lshrrev_b32 v13, 2, v26
    v_add_u32 v42, v12, v11
    v_bitop3_b32 v26, v5, v13, v14 bitop3:0xea
    v_mul_hi_u32_u24 v14, 429497, v43
    v_lshrrev_b32 v12, 3, v27
    v_cos_f32 v10, v10
    v_lshlrev_b16 v13, 3, v27
    v_mad_i32_i24 v11, v14, s55, v43
    v_bitop3_b32 v12, v6, v13, v12 bitop3:0xca
    v_lshl_add_u32 v11, v11, 17, s40
    v_lshlrev_b16 v14, 8, v14
    v_lshrrev_b32 v13, 2, v27
    v_add_u32 v43, v12, v11
    v_bitop3_b32 v27, v5, v13, v14 bitop3:0xea
    v_cvt_pk_bf16_f32 v33, v9, v10
    v_perm_b32 v12, v33, v33, s41
    v_bitop3_b32 v42, v4, v12, v42 bitop3:0xca
    v_perm_b32 v13, v33, v33, s42
    v_bitop3_b32 v43, v4, v13, v43 bitop3:0xca
    s_setprio 1
    v_and_b32 v7, -4, v96
    v_lshl_add_u32 v8, v96, 2, v7
    ds_write_b32 v8, v64
    v_lshl_add_u32 v7, v7, 2, v96
    ds_write_b8 v7, v104 offset:16
    v_and_b32 v9, -4, v97
    v_lshl_add_u32 v10, v97, 2, v9
    ds_write_b32 v10, v65
    v_lshl_add_u32 v9, v9, 2, v97
    ds_write_b8_d16_hi v9, v104 offset:16
    v_and_b32 v7, -4, v98
    v_lshl_add_u32 v8, v98, 2, v7
    ds_write_b32 v8, v66
    v_lshl_add_u32 v7, v7, 2, v98
    ds_write_b8 v7, v105 offset:16
    v_and_b32 v9, -4, v99
    v_lshl_add_u32 v10, v99, 2, v9
    ds_write_b32 v10, v67
    v_lshl_add_u32 v9, v9, 2, v99
    ds_write_b8_d16_hi v9, v105 offset:16
    s_add_u32 s47, s96, 0x9000000
    s_lshr_b32 s47, s47, 1
    buffer_load_dwordx2 v[72:73], v1, s[16:19], s47 offen nt
    s_cmp_le_u32 s43, 5
    s_cselect_b32 s18, 0, s18
    s_add_u32 s44, s38, 0x0
    s_lshr_b32 s44, s44, 1
    buffer_load_dwordx2 v[74:75], v1, s[16:19], s44 offen nt
    s_cmp_le_u32 s43, 5
    s_cselect_b32 s10, 0, s10
    s_add_u32 s45, s38, 0x0
    v_lshlrev_b32 v36, 1, v1
    buffer_load_dwordx4 v[36:39], v36, s[8:11], s45 offen nt
    v_and_b32 v7, -4, v100
    v_lshl_add_u32 v8, v100, 2, v7
    ds_write_b32 v8, v60
    v_lshl_add_u32 v7, v7, 2, v100
    ds_write_b8 v7, v106 offset:16
    v_and_b32 v9, -4, v101
    v_lshl_add_u32 v10, v101, 2, v9
    ds_write_b32 v10, v61
    v_lshl_add_u32 v9, v9, 2, v101
    ds_write_b8_d16_hi v9, v106 offset:16
    v_and_b32 v7, -4, v102
    v_lshl_add_u32 v8, v102, 2, v7
    ds_write_b32 v8, v62
    v_lshl_add_u32 v7, v7, 2, v102
    ds_write_b8 v7, v107 offset:16
    v_and_b32 v9, -4, v103
    v_lshl_add_u32 v10, v103, 2, v9
    ds_write_b32 v10, v63
    v_lshl_add_u32 v9, v9, 2, v103
    ds_write_b8_d16_hi v9, v107 offset:16
    s_add_u32 s46, s35, 0x5488000
    s_add_u32 s46, s46, s93
    buffer_store_dwordx4 v[28:31], v0, s[20:23], s46 offen sc1
    s_cmp_le_u32 s43, 5
    s_cselect_b32 s14, 0, s14
    s_add_u32 s47, s38, 0x0
    v_lshlrev_b32 v76, 1, v1
    buffer_load_dwordx4 v[76:79], v76, s[12:15], s47 offen nt
    s_waitcnt vmcnt(7)
    v_lshlrev_b32 v7, 16, v34
    v_and_b32 v8, 0xffff0000, v34
    v_lshlrev_b32 v9, 16, v35
    v_and_b32 v10, 0xffff0000, v35
    v_mul_f32 v7, 0.15915494, v7
    v_mul_f32 v8, 0.15915494, v8
    v_mul_f32 v9, 0.15915494, v9
    v_mul_f32 v10, 0.15915494, v10
    v_mul_hi_u32_u24 v14, 429497, v48
    v_lshrrev_b32 v12, 3, v52
    v_cos_f32 v7, v7
    v_lshlrev_b16 v13, 3, v52
    v_mad_i32_i24 v11, v14, s55, v48
    v_bitop3_b32 v12, v6, v13, v12 bitop3:0xca
    v_lshl_add_u32 v11, v11, 17, s40
    v_lshlrev_b16 v14, 8, v14
    v_lshrrev_b32 v13, 2, v52
    v_add_u32 v48, v12, v11
    v_bitop3_b32 v52, v5, v13, v14 bitop3:0xea
    v_mul_hi_u32_u24 v14, 429497, v49
    v_lshrrev_b32 v12, 3, v53
    v_cos_f32 v8, v8
    v_lshlrev_b16 v13, 3, v53
    v_mad_i32_i24 v11, v14, s55, v49
    v_bitop3_b32 v12, v6, v13, v12 bitop3:0xca
    v_lshl_add_u32 v11, v11, 17, s40
    v_lshlrev_b16 v14, 8, v14
    v_lshrrev_b32 v13, 2, v53
    v_add_u32 v49, v12, v11
    v_bitop3_b32 v53, v5, v13, v14 bitop3:0xea
    v_cvt_pk_bf16_f32 v34, v7, v8
    v_perm_b32 v12, v34, v34, s41
    v_bitop3_b32 v48, v4, v12, v48 bitop3:0xca
    v_perm_b32 v13, v34, v34, s42
    v_bitop3_b32 v49, v4, v13, v49 bitop3:0xca
    v_mul_hi_u32_u24 v14, 429497, v50
    v_lshrrev_b32 v12, 3, v54
    v_cos_f32 v9, v9
    v_lshlrev_b16 v13, 3, v54
    v_mad_i32_i24 v11, v14, s55, v50
    v_bitop3_b32 v12, v6, v13, v12 bitop3:0xca
    v_lshl_add_u32 v11, v11, 17, s40
    v_lshlrev_b16 v14, 8, v14
    v_lshrrev_b32 v13, 2, v54
    v_add_u32 v50, v12, v11
    v_bitop3_b32 v54, v5, v13, v14 bitop3:0xea
    v_mul_hi_u32_u24 v14, 429497, v51
    v_lshrrev_b32 v12, 3, v55
    v_cos_f32 v10, v10
    v_lshlrev_b16 v13, 3, v55
    v_mad_i32_i24 v11, v14, s55, v51
    v_bitop3_b32 v12, v6, v13, v12 bitop3:0xca
    v_lshl_add_u32 v11, v11, 17, s40
    v_lshlrev_b16 v14, 8, v14
    v_lshrrev_b32 v13, 2, v55
    v_add_u32 v51, v12, v11
    v_bitop3_b32 v55, v5, v13, v14 bitop3:0xea
    v_cvt_pk_bf16_f32 v35, v9, v10
    v_perm_b32 v12, v35, v35, s41
    v_bitop3_b32 v50, v4, v12, v50 bitop3:0xca
    v_perm_b32 v13, v35, v35, s42
    v_bitop3_b32 v51, v4, v13, v51 bitop3:0xca
    s_setprio 0
    v_and_b32 v7, -4, v88
    v_lshl_add_u32 v8, v88, 2, v7
    ds_write_b32 v8, v112
    v_lshl_add_u32 v7, v7, 2, v88
    ds_write_b8 v7, v108 offset:16
    v_and_b32 v9, -4, v89
    v_lshl_add_u32 v10, v89, 2, v9
    ds_write_b32 v10, v113
    v_lshl_add_u32 v9, v9, 2, v89
    ds_write_b8_d16_hi v9, v108 offset:16
    v_and_b32 v7, -4, v90
    v_lshl_add_u32 v8, v90, 2, v7
    ds_write_b32 v8, v114
    v_lshl_add_u32 v7, v7, 2, v90
    ds_write_b8 v7, v109 offset:16
    v_and_b32 v9, -4, v91
    v_lshl_add_u32 v10, v91, 2, v9
    ds_write_b32 v10, v115
    v_lshl_add_u32 v9, v9, 2, v91
    ds_write_b8_d16_hi v9, v109 offset:16
    s_cmp_le_u32 s43, 6
    s_cselect_b32 s10, 0, s10
    s_add_u32 s44, s39, 0x0
    v_lshlrev_b32 v80, 1, v1
    buffer_load_dwordx4 v[80:83], v80, s[8:11], s44 offen nt
    s_cmp_le_u32 s43, 6
    s_cselect_b32 s14, 0, s14
    s_add_u32 s45, s39, 0x0
    v_lshlrev_b32 v56, 1, v1
    buffer_load_dwordx4 v[56:59], v56, s[12:15], s45 offen nt
    s_waitcnt vmcnt(5)
    v_lshlrev_b32 v7, 16, v72
    v_and_b32 v8, 0xffff0000, v72
    v_lshlrev_b32 v9, 16, v73
    v_and_b32 v10, 0xffff0000, v73
    v_mul_f32 v7, 0.15915494, v7
    v_mul_f32 v8, 0.15915494, v8
    v_mul_f32 v9, 0.15915494, v9
    v_mul_f32 v10, 0.15915494, v10
    v_mul_hi_u32_u24 v14, 429497, v84
    v_lshrrev_b32 v12, 3, v68
    v_cos_f32 v7, v7
    v_lshlrev_b16 v13, 3, v68
    v_mad_i32_i24 v11, v14, s55, v84
    v_bitop3_b32 v12, v6, v13, v12 bitop3:0xca
    v_lshl_add_u32 v11, v11, 17, s40
    v_lshlrev_b16 v14, 8, v14
    v_lshrrev_b32 v13, 2, v68
    v_add_u32 v84, v12, v11
    v_bitop3_b32 v68, v5, v13, v14 bitop3:0xea
    v_mul_hi_u32_u24 v14, 429497, v85
    v_lshrrev_b32 v12, 3, v69
    v_cos_f32 v8, v8
    v_lshlrev_b16 v13, 3, v69
    v_mad_i32_i24 v11, v14, s55, v85
    v_bitop3_b32 v12, v6, v13, v12 bitop3:0xca
    v_lshl_add_u32 v11, v11, 17, s40
    v_lshlrev_b16 v14, 8, v14
    v_lshrrev_b32 v13, 2, v69
    v_add_u32 v85, v12, v11
    v_bitop3_b32 v69, v5, v13, v14 bitop3:0xea
    v_cvt_pk_bf16_f32 v72, v7, v8
    v_perm_b32 v12, v72, v72, s41
    v_bitop3_b32 v84, v4, v12, v84 bitop3:0xca
    v_perm_b32 v13, v72, v72, s42
    v_bitop3_b32 v85, v4, v13, v85 bitop3:0xca
    v_mul_hi_u32_u24 v14, 429497, v86
    v_lshrrev_b32 v12, 3, v70
    v_cos_f32 v9, v9
    v_lshlrev_b16 v13, 3, v70
    v_mad_i32_i24 v11, v14, s55, v86
    v_bitop3_b32 v12, v6, v13, v12 bitop3:0xca
    v_lshl_add_u32 v11, v11, 17, s40
    v_lshlrev_b16 v14, 8, v14
    v_lshrrev_b32 v13, 2, v70
    v_add_u32 v86, v12, v11
    v_bitop3_b32 v70, v5, v13, v14 bitop3:0xea
    v_mul_hi_u32_u24 v14, 429497, v87
    v_lshrrev_b32 v12, 3, v71
    v_cos_f32 v10, v10
    v_lshlrev_b16 v13, 3, v71
    v_mad_i32_i24 v11, v14, s55, v87
    v_bitop3_b32 v12, v6, v13, v12 bitop3:0xca
    v_lshl_add_u32 v11, v11, 17, s40
    v_lshlrev_b16 v14, 8, v14
    v_lshrrev_b32 v13, 2, v71
    v_add_u32 v87, v12, v11
    v_bitop3_b32 v71, v5, v13, v14 bitop3:0xea
    v_cvt_pk_bf16_f32 v73, v9, v10
    v_perm_b32 v12, v73, v73, s41
    v_bitop3_b32 v86, v4, v12, v86 bitop3:0xca
    v_perm_b32 v13, v73, v73, s42
    v_bitop3_b32 v87, v4, v13, v87 bitop3:0xca
    v_and_b32 v7, -4, v92
    v_lshl_add_u32 v8, v92, 2, v7
    ds_write_b32 v8, v116
    v_lshl_add_u32 v7, v7, 2, v92
    ds_write_b8 v7, v110 offset:16
    v_and_b32 v9, -4, v93
    v_lshl_add_u32 v10, v93, 2, v9
    ds_write_b32 v10, v117
    v_lshl_add_u32 v9, v9, 2, v93
    ds_write_b8_d16_hi v9, v110 offset:16
    v_and_b32 v7, -4, v94
    v_lshl_add_u32 v8, v94, 2, v7
    ds_write_b32 v8, v118
    v_lshl_add_u32 v7, v7, 2, v94
    ds_write_b8 v7, v111 offset:16
    v_and_b32 v9, -4, v95
    v_lshl_add_u32 v10, v95, 2, v9
    ds_write_b32 v10, v119
    v_lshl_add_u32 v9, v9, 2, v95
    ds_write_b8_d16_hi v9, v111 offset:16
    s_cmp_le_u32 s43, 6
    s_cselect_b32 s18, 0, s18
    s_add_u32 s46, s39, 0x0
    s_lshr_b32 s46, s46, 1
    buffer_load_dwordx2 v[64:65], v1, s[16:19], s46 offen nt
    s_cmp_le_u32 s43, 7
    s_cselect_b32 s18, 0, s18
    s_add_u32 s47, s58, 0x0
    s_lshr_b32 s47, s47, 1
    buffer_load_dwordx2 v[66:67], v1, s[16:19], s47 offen nt
    s_waitcnt vmcnt(4)
    s_cmp_le_u32 s43, 5
    s_cbranch_scc1 L1_s5
    v_lshlrev_b32 v7, 16, v74
    v_and_b32 v8, 0xffff0000, v74
    v_lshlrev_b32 v9, 16, v75
    v_and_b32 v10, 0xffff0000, v75
    v_mul_f32 v7, 0.15915494, v7
    v_mul_f32 v8, 0.15915494, v8
    v_mul_f32 v9, 0.15915494, v9
    v_mul_f32 v10, 0.15915494, v10
    v_mul_hi_u32_u24 v14, 429497, v36
    v_lshrrev_b32 v12, 3, v76
    v_cos_f32 v7, v7
    v_lshlrev_b16 v13, 3, v76
    v_mad_i32_i24 v11, v14, s55, v36
    v_bitop3_b32 v12, v6, v13, v12 bitop3:0xca
    v_lshl_add_u32 v11, v11, 17, s40
    v_lshlrev_b16 v14, 8, v14
    v_lshrrev_b32 v13, 2, v76
    v_add_u32 v36, v12, v11
    v_bitop3_b32 v76, v5, v13, v14 bitop3:0xea
    v_mul_hi_u32_u24 v14, 429497, v37
    v_lshrrev_b32 v12, 3, v77
    v_cos_f32 v8, v8
    v_lshlrev_b16 v13, 3, v77
    v_mad_i32_i24 v11, v14, s55, v37
    v_bitop3_b32 v12, v6, v13, v12 bitop3:0xca
    v_lshl_add_u32 v11, v11, 17, s40
    v_lshlrev_b16 v14, 8, v14
    v_lshrrev_b32 v13, 2, v77
    v_add_u32 v37, v12, v11
    v_bitop3_b32 v77, v5, v13, v14 bitop3:0xea
    v_cvt_pk_bf16_f32 v74, v7, v8
    v_perm_b32 v12, v74, v74, s41
    v_bitop3_b32 v36, v4, v12, v36 bitop3:0xca
    v_perm_b32 v13, v74, v74, s42
    v_bitop3_b32 v37, v4, v13, v37 bitop3:0xca
    v_mul_hi_u32_u24 v14, 429497, v38
    v_lshrrev_b32 v12, 3, v78
    v_cos_f32 v9, v9
    v_lshlrev_b16 v13, 3, v78
    v_mad_i32_i24 v11, v14, s55, v38
    v_bitop3_b32 v12, v6, v13, v12 bitop3:0xca
    v_lshl_add_u32 v11, v11, 17, s40
    v_lshlrev_b16 v14, 8, v14
    v_lshrrev_b32 v13, 2, v78
    v_add_u32 v38, v12, v11
    v_bitop3_b32 v78, v5, v13, v14 bitop3:0xea
    v_mul_hi_u32_u24 v14, 429497, v39
    v_lshrrev_b32 v12, 3, v79
    v_cos_f32 v10, v10
    v_lshlrev_b16 v13, 3, v79
    v_mad_i32_i24 v11, v14, s55, v39
    v_bitop3_b32 v12, v6, v13, v12 bitop3:0xca
    v_lshl_add_u32 v11, v11, 17, s40
    v_lshlrev_b16 v14, 8, v14
    v_lshrrev_b32 v13, 2, v79
    v_add_u32 v39, v12, v11
    v_bitop3_b32 v79, v5, v13, v14 bitop3:0xea
    v_cvt_pk_bf16_f32 v75, v9, v10
    v_perm_b32 v12, v75, v75, s41
    v_bitop3_b32 v38, v4, v12, v38 bitop3:0xca
    v_perm_b32 v13, v75, v75, s42
    v_bitop3_b32 v39, v4, v13, v39 bitop3:0xca
L1_s5:
    v_add_u32 v7, s72, v0
    v_add_u32 v12, s73, v0
    v_add_u32 v13, s85, v0
    v_add_u32 v14, s91, v0
    v_add_u32 v15, s93, v0
    s_min_i32 s3, s72, s73
    s_min_i32 s3, s3, s85
    s_min_i32 s3, s3, s91
    s_min_i32 s3, s3, s93
    v_add_u32 v3, s3, v0
    v_mov_b32 v8, 0
    v_mov_b32 v9, 0
    v_mov_b32 v10, 0
    v_mov_b32 v11, 0
    s_waitcnt lgkmcnt(0)
    s_barrier
    ds_read_b128 v[96:99], v7 offset:0
    ds_read_b128 v[60:63], v12 offset:0
    ds_read_b128 v[100:103], v13 offset:0
    ds_read_b128 v[104:107], v14 offset:0
    ds_read_b128 v[28:31], v15 offset:0
    ds_write_b128 v3, v[8:11]
    ds_read_b128 v[112:115], v7 offset:16384
    ds_read_b128 v[88:91], v12 offset:16384
    ds_read_b128 v[116:119], v13 offset:16384
    ds_read_b128 v[92:95], v14 offset:16384
    ds_read_b128 v[108:111], v15 offset:16384
    s_waitcnt lgkmcnt(0)
    s_barrier
    v_lshlrev_b32 v3, 3, v0
    v_and_b32 v3, 0x80, v3
    s_cmp_lg_u32 s32, 15
    s_cbranch_scc1 L2_k0
    s_mov_b64 exec, 3
    buffer_load_dword v3, v3, s[68:71], 0 offen sc1
    s_mov_b64 exec, -1
L2_k0:
    s_add_u32 s44, s35, 0x7ec4000
    s_add_u32 s44, s44, s72
    buffer_store_dwordx4 v[96:99], v0, s[20:23], s44 offen sc1
    s_cmp_le_u32 s43, 7
    s_cselect_b32 s10, 0, s10
    s_add_u32 s45, s58, 0x0
    v_lshlrev_b32 v96, 1, v1
    buffer_load_dwordx4 v[96:99], v96, s[8:11], s45 offen nt
    s_add_u32 s46, s35, 0x7ec4000
    s_add_u32 s46, s46, s73
    buffer_store_dwordx4 v[60:63], v0, s[20:23], s46 offen sc1
    s_cmp_le_u32 s43, 7
    s_cselect_b32 s14, 0, s14
    s_add_u32 s47, s58, 0x0
    v_lshlrev_b32 v60, 1, v1
    buffer_load_dwordx4 v[60:63], v60, s[12:15], s47 offen nt
    s_setprio 3
    ds_add_u32 v120, v2
    ds_add_u32 v121, v2
    ds_add_u32 v122, v2
    ds_add_u32 v123, v2
    ds_add_u32 v124, v2
    ds_add_u32 v125, v2
    ds_add_u32 v126, v2
    ds_add_u32 v127, v2
    s_setprio 2
    s_add_u32 s44, s35, 0x7ec4000
    s_add_u32 s44, s44, s85
    buffer_store_dwordx4 v[100:103], v0, s[20:23], s44 offen sc1
    ds_add_u32 v24, v2
    ds_add_u32 v25, v2
    ds_add_u32 v26, v2
    ds_add_u32 v27, v2
    ds_add_u32 v52, v2
    ds_add_u32 v53, v2
    ds_add_u32 v54, v2
    ds_add_u32 v55, v2
    s_setprio 1
    ds_add_u32 v68, v2
    ds_add_u32 v69, v2
    ds_add_u32 v70, v2
    ds_add_u32 v71, v2
    s_add_u32 s45, s35, 0x7ec4000
    s_add_u32 s45, s45, s91
    buffer_store_dwordx4 v[104:107], v0, s[20:23], s45 offen sc1
    s_cmp_le_u32 s43, 5
    s_cbranch_scc1 L1_s6
    ds_add_u32 v76, v2
    ds_add_u32 v77, v2
    ds_add_u32 v78, v2
    ds_add_u32 v79, v2
L1_s6:
    s_setprio 0
    s_waitcnt vmcnt(6)
    s_cmp_le_u32 s43, 6
    s_cbranch_scc1 L1_s7
    v_lshlrev_b32 v7, 16, v64
    v_and_b32 v8, 0xffff0000, v64
    v_lshlrev_b32 v9, 16, v65
    v_and_b32 v10, 0xffff0000, v65
    v_mul_f32 v7, 0.15915494, v7
    v_mul_f32 v8, 0.15915494, v8
    v_mul_f32 v9, 0.15915494, v9
    v_mul_f32 v10, 0.15915494, v10
    v_mul_hi_u32_u24 v14, 429497, v80
    v_lshrrev_b32 v12, 3, v56
    v_cos_f32 v7, v7
    v_lshlrev_b16 v13, 3, v56
    v_mad_i32_i24 v11, v14, s55, v80
    v_bitop3_b32 v12, v6, v13, v12 bitop3:0xca
    v_lshl_add_u32 v11, v11, 17, s40
    v_lshlrev_b16 v14, 8, v14
    v_lshrrev_b32 v13, 2, v56
    v_add_u32 v80, v12, v11
    v_bitop3_b32 v56, v5, v13, v14 bitop3:0xea
    ds_add_u32 v56, v2
    v_mul_hi_u32_u24 v14, 429497, v81
    v_lshrrev_b32 v12, 3, v57
    v_cos_f32 v8, v8
    v_lshlrev_b16 v13, 3, v57
    v_mad_i32_i24 v11, v14, s55, v81
    v_bitop3_b32 v12, v6, v13, v12 bitop3:0xca
    v_lshl_add_u32 v11, v11, 17, s40
    v_lshlrev_b16 v14, 8, v14
    v_lshrrev_b32 v13, 2, v57
    v_add_u32 v81, v12, v11
    v_bitop3_b32 v57, v5, v13, v14 bitop3:0xea
    ds_add_u32 v57, v2
    v_cvt_pk_bf16_f32 v64, v7, v8
    v_perm_b32 v12, v64, v64, s41
    v_bitop3_b32 v80, v4, v12, v80 bitop3:0xca
    v_perm_b32 v13, v64, v64, s42
    v_bitop3_b32 v81, v4, v13, v81 bitop3:0xca
    v_mul_hi_u32_u24 v14, 429497, v82
    v_lshrrev_b32 v12, 3, v58
    v_cos_f32 v9, v9
    v_lshlrev_b16 v13, 3, v58
    v_mad_i32_i24 v11, v14, s55, v82
    v_bitop3_b32 v12, v6, v13, v12 bitop3:0xca
    v_lshl_add_u32 v11, v11, 17, s40
    v_lshlrev_b16 v14, 8, v14
    v_lshrrev_b32 v13, 2, v58
    v_add_u32 v82, v12, v11
    v_bitop3_b32 v58, v5, v13, v14 bitop3:0xea
    ds_add_u32 v58, v2
    v_mul_hi_u32_u24 v14, 429497, v83
    v_lshrrev_b32 v12, 3, v59
    v_cos_f32 v10, v10
    v_lshlrev_b16 v13, 3, v59
    v_mad_i32_i24 v11, v14, s55, v83
    v_bitop3_b32 v12, v6, v13, v12 bitop3:0xca
    v_lshl_add_u32 v11, v11, 17, s40
    v_lshlrev_b16 v14, 8, v14
    v_lshrrev_b32 v13, 2, v59
    v_add_u32 v83, v12, v11
    v_bitop3_b32 v59, v5, v13, v14 bitop3:0xea
    ds_add_u32 v59, v2
    v_cvt_pk_bf16_f32 v65, v9, v10
    v_perm_b32 v12, v65, v65, s41
    v_bitop3_b32 v82, v4, v12, v82 bitop3:0xca
    v_perm_b32 v13, v65, v65, s42
    v_bitop3_b32 v83, v4, v13, v83 bitop3:0xca
L1_s7:
    s_waitcnt vmcnt(2)
    s_cmp_le_u32 s43, 7
    s_cbranch_scc1 L1_s8
    v_lshlrev_b32 v7, 16, v66
    v_and_b32 v8, 0xffff0000, v66
    v_lshlrev_b32 v9, 16, v67
    v_and_b32 v10, 0xffff0000, v67
    v_mul_f32 v7, 0.15915494, v7
    v_mul_f32 v8, 0.15915494, v8
    v_mul_f32 v9, 0.15915494, v9
    v_mul_f32 v10, 0.15915494, v10
    v_mul_hi_u32_u24 v14, 429497, v96
    v_lshrrev_b32 v12, 3, v60
    v_cos_f32 v7, v7
    v_lshlrev_b16 v13, 3, v60
    v_mad_i32_i24 v11, v14, s55, v96
    v_bitop3_b32 v12, v6, v13, v12 bitop3:0xca
    v_lshl_add_u32 v11, v11, 17, s40
    v_lshlrev_b16 v14, 8, v14
    v_lshrrev_b32 v13, 2, v60
    v_add_u32 v96, v12, v11
    v_bitop3_b32 v60, v5, v13, v14 bitop3:0xea
    ds_add_u32 v60, v2
    v_mul_hi_u32_u24 v14, 429497, v97
    v_lshrrev_b32 v12, 3, v61
    v_cos_f32 v8, v8
    v_lshlrev_b16 v13, 3, v61
    v_mad_i32_i24 v11, v14, s55, v97
    v_bitop3_b32 v12, v6, v13, v12 bitop3:0xca
    v_lshl_add_u32 v11, v11, 17, s40
    v_lshlrev_b16 v14, 8, v14
    v_lshrrev_b32 v13, 2, v61
    v_add_u32 v97, v12, v11
    v_bitop3_b32 v61, v5, v13, v14 bitop3:0xea
    ds_add_u32 v61, v2
    v_cvt_pk_bf16_f32 v66, v7, v8
    v_perm_b32 v12, v66, v66, s41
    v_bitop3_b32 v96, v4, v12, v96 bitop3:0xca
    v_perm_b32 v13, v66, v66, s42
    v_bitop3_b32 v97, v4, v13, v97 bitop3:0xca
    v_mul_hi_u32_u24 v14, 429497, v98
    v_lshrrev_b32 v12, 3, v62
    v_cos_f32 v9, v9
    v_lshlrev_b16 v13, 3, v62
    v_mad_i32_i24 v11, v14, s55, v98
    v_bitop3_b32 v12, v6, v13, v12 bitop3:0xca
    v_lshl_add_u32 v11, v11, 17, s40
    v_lshlrev_b16 v14, 8, v14
    v_lshrrev_b32 v13, 2, v62
    v_add_u32 v98, v12, v11
    v_bitop3_b32 v62, v5, v13, v14 bitop3:0xea
    ds_add_u32 v62, v2
    v_mul_hi_u32_u24 v14, 429497, v99
    v_lshrrev_b32 v12, 3, v63
    v_cos_f32 v10, v10
    v_lshlrev_b16 v13, 3, v63
    v_mad_i32_i24 v11, v14, s55, v99
    v_bitop3_b32 v12, v6, v13, v12 bitop3:0xca
    v_lshl_add_u32 v11, v11, 17, s40
    v_lshlrev_b16 v14, 8, v14
    v_lshrrev_b32 v13, 2, v63
    v_add_u32 v99, v12, v11
    v_bitop3_b32 v63, v5, v13, v14 bitop3:0xea
    ds_add_u32 v63, v2
    v_cvt_pk_bf16_f32 v67, v9, v10
    v_perm_b32 v12, v67, v67, s41
    v_bitop3_b32 v98, v4, v12, v98 bitop3:0xca
    v_perm_b32 v13, v67, v67, s42
    v_bitop3_b32 v99, v4, v13, v99 bitop3:0xca
L1_s8:
    v_lshrrev_b32 v8, 2, v0
    v_and_b32 v7, 0x3c00, v0
    v_bitop3_b32 v7, v5, v8, v7 bitop3:0xea
    s_waitcnt lgkmcnt(0)
    s_barrier
    ds_read2st64_b32 v[8:9], v7 offset0:0 offset1:1
    ds_read2st64_b32 v[10:11], v7 offset0:2 offset1:3
    s_waitcnt lgkmcnt(0)
    v_lshl_or_b32 v12, v9, 16, v8
    v_lshl_or_b32 v13, v11, 16, v10
    v_mov_b32 v14, v12
    v_mov_b32 v15, v13
    s_nop 0
    v_add_u32_dpp v14, v14, v14 row_shr:1 row_mask:0xf bank_mask:0xf bound_ctrl:1
    v_add_u32_dpp v15, v15, v15 row_shr:1 row_mask:0xf bank_mask:0xf bound_ctrl:1
    s_nop 0
    v_add_u32_dpp v14, v14, v14 row_shr:2 row_mask:0xf bank_mask:0xf bound_ctrl:1
    v_add_u32_dpp v15, v15, v15 row_shr:2 row_mask:0xf bank_mask:0xf bound_ctrl:1
    s_nop 0
    v_add_u32_dpp v14, v14, v14 row_shr:4 row_mask:0xf bank_mask:0xf bound_ctrl:1
    v_add_u32_dpp v15, v15, v15 row_shr:4 row_mask:0xf bank_mask:0xf bound_ctrl:1
    s_nop 0
    v_add_u32_dpp v14, v14, v14 row_shr:8 row_mask:0xf bank_mask:0xf bound_ctrl:1
    v_add_u32_dpp v15, v15, v15 row_shr:8 row_mask:0xf bank_mask:0xf bound_ctrl:1
    s_nop 0
    v_add_u32_dpp v14, v14, v14 row_bcast:15 row_mask:0xa bank_mask:0xf
    v_add_u32_dpp v15, v15, v15 row_bcast:15 row_mask:0xa bank_mask:0xf
    s_nop 0
    v_add_u32_dpp v14, v14, v14 row_bcast:31 row_mask:0xc bank_mask:0xf
    v_add_u32_dpp v15, v15, v15 row_bcast:31 row_mask:0xc bank_mask:0xf
    v_readlane_b32 s48, v14, 63
    v_readlane_b32 s49, v15, 63
    s_lshl_b32 s54, s32, 2
    v_mov_b32 v8, s54
    s_and_b32 s50, s48, 0xffff
    s_lshr_b32 s51, s48, 16
    s_and_b32 s52, s49, 0xffff
    s_lshr_b32 s53, s49, 16
    s_add_u32 s51, s51, s50
    s_add_u32 s52, s52, s51
    s_add_u32 s53, s53, s52
    v_mov_b32 v9, s53
    v_and_b32_dpp v3, v3, v3 quad_perm:[1,0,3,2] row_mask:0xf bank_mask:0xf
    s_mov_b64 exec, 1
    ds_write_b32 v8, v9 offset:16384
    ds_write_b32 v8, v3 offset:16448
    s_mov_b64 exec, -1
    v_and_b32 v8, 60, v7
    s_waitcnt lgkmcnt(0)
    s_barrier
    ds_read_b32 v9, v8 offset:16384
    ds_read_b32 v10, v8 offset:16448
    s_waitcnt lgkmcnt(0)
    v_readlane_b32 s56, v10, 15
    s_xor_b32 s56, s56, 0x80
    v_add_u32_dpp v9, v9, v9 row_shr:1 row_mask:0xf bank_mask:0xf bound_ctrl:1
    s_nop 1
    v_add_u32_dpp v9, v9, v9 row_shr:2 row_mask:0xf bank_mask:0xf bound_ctrl:1
    s_nop 1
    v_add_u32_dpp v9, v9, v9 row_shr:4 row_mask:0xf bank_mask:0xf bound_ctrl:1
    s_nop 1
    v_add_u32_dpp v9, v9, v9 row_shr:8 row_mask:0xf bank_mask:0xf bound_ctrl:1
    s_nop 0
    v_readlane_b32 s54, v9, s32
    s_sub_u32 s54, s54, s53
    s_add_u32 s50, s50, s54
    s_add_u32 s51, s51, s54
    s_add_u32 s52, s52, s54
    s_pack_ll_b32_b16 s48, s54, s50
    s_pack_ll_b32_b16 s49, s51, s52
    v_add_u32 v14, s48, v14
    v_add_u32 v15, s49, v15
    v_sub_u32 v12, v14, v12
    v_sub_u32 v13, v15, v13
    v_and_b32 v8, 0xffff, v12
    v_lshrrev_b32 v9, 16, v12
    v_and_b32 v10, 0xffff, v13
    v_lshrrev_b32 v11, 16, v13
    ds_write2st64_b32 v7, v8, v9 offset0:0 offset1:1
    ds_write2st64_b32 v7, v10, v11 offset0:2 offset1:3
    v_and_b32 v8, 0x3f0, v0
    v_lshl_add_u32 v8, v8, 1, s36
    ds_write_b64 v8, v[12:13] offset:20480
    s_bitset0_b64 exec, 63
    s_not_b64 exec, exec
    ds_write_b64 v8, v[14:15] offset:20512
    s_mov_b64 exec, -1
    s_waitcnt lgkmcnt(0)
    s_barrier
    s_setprio 3
    ds_add_rtn_u32 v120, v120, v2
    ds_add_rtn_u32 v121, v121, v2
    ds_add_rtn_u32 v122, v122, v2
    ds_add_rtn_u32 v123, v123, v2
    ds_read_b128 v[12:15], v0 offset:20480
    v_cmp_gt_u32 vcc, 8448, v0
    s_add_u32 s46, s35, 0x7ec4000
    s_add_u32 s46, s46, s93
    buffer_store_dwordx4 v[28:31], v0, s[20:23], s46 offen sc1
    ds_add_rtn_u32 v124, v124, v2
    ds_add_rtn_u32 v125, v125, v2
    ds_add_rtn_u32 v126, v126, v2
    ds_add_rtn_u32 v127, v127, v2
    s_setprio 2
    ds_add_rtn_u32 v24, v24, v2
    ds_add_rtn_u32 v25, v25, v2
    ds_add_rtn_u32 v26, v26, v2
    ds_add_rtn_u32 v27, v27, v2
    s_waitcnt lgkmcnt(8)
    s_cbranch_vccz L1_p9
    s_add_u32 s47, s35, 0xa900000
    s_mov_b64 exec, vcc
    buffer_store_dwordx4 v[12:15], v0, s[24:27], s47 offen sc1
    s_mov_b64 exec, -1
L1_p9:
    s_add_u32 s44, s35, 0x7ec8000
    s_add_u32 s44, s44, s72
    buffer_store_dwordx4 v[112:115], v0, s[20:23], s44 offen sc1
    ds_add_rtn_u32 v52, v52, v2
    ds_add_rtn_u32 v53, v53, v2
    ds_add_rtn_u32 v54, v54, v2
    ds_add_rtn_u32 v55, v55, v2
    s_load_dwordx2 s[28:29], s[0:1], 0
    s_load_dwordx2 s[50:51], s[0:1], 40
    s_load_dwordx2 s[52:53], s[0:1], 24
    s_setprio 1
    ds_add_rtn_u32 v68, v68, v2
    ds_add_rtn_u32 v69, v69, v2
    ds_add_rtn_u32 v70, v70, v2
    ds_add_rtn_u32 v71, v71, v2
    s_cmp_le_u32 s43, 5
    s_cbranch_scc1 L1_s10
    ds_add_rtn_u32 v76, v76, v2
    ds_add_rtn_u32 v77, v77, v2
    ds_add_rtn_u32 v78, v78, v2
    ds_add_rtn_u32 v79, v79, v2
L1_s10:
    s_add_u32 s45, s35, 0x7ec8000
    s_add_u32 s45, s45, s73
    buffer_store_dwordx4 v[88:91], v0, s[20:23], s45 offen sc1
    s_setprio 0
    s_cmp_le_u32 s43, 6
    s_cbranch_scc1 L1_s11
    ds_add_rtn_u32 v56, v56, v2
    ds_add_rtn_u32 v57, v57, v2
    ds_add_rtn_u32 v58, v58, v2
    ds_add_rtn_u32 v59, v59, v2
L1_s11:
    s_cmp_le_u32 s43, 7
    s_cbranch_scc1 L1_s12
    ds_add_rtn_u32 v60, v60, v2
    ds_add_rtn_u32 v61, v61, v2
    ds_add_rtn_u32 v62, v62, v2
    ds_add_rtn_u32 v63, v63, v2
L1_s12:
    s_waitcnt lgkmcnt(0)
    s_barrier
    s_load_dwordx4 s[96:99], s[50:51], 0
    s_mov_b64 s[4:5], s[52:53]
    s_bfe_u32 s33, s2, 0x20001
    s_and_b32 s34, s2, 1
    s_lshl_b32 s34, s34, 5
    s_lshr_b32 s3, s2, 3
    s_add_u32 s34, s34, s3
    s_mul_i32 s39, s33, 2080
    s_lshl_b32 s3, s34, 5
    s_add_u32 s39, s39, s3
    s_mul_i32 s40, s33, 1310720
    s_add_u32 s40, s40, 0x50000
    s_lshl_b32 s38, s32, 11
    s_mul_i32 s100, s32, 3072
    s_add_u32 s8, s30, 0x4000
    s_addc_u32 s9, s31, 0
    s_mov_b32 s10, 0xd340000
    s_mov_b32 s11, 0x20000
    s_add_u32 s12, s30, 0x2c000
    s_addc_u32 s13, s31, 0
    s_mov_b32 s14, 0xd318000
    s_mov_b32 s15, 0x20000
    s_mov_b32 s16, s64
    s_mov_b32 s17, s65
    s_mov_b32 s18, 0x20
    s_mov_b32 s19, 0x20000
    s_mov_b32 s24, s28
    s_mov_b32 s25, s29
    s_mov_b32 s26, 0x4e2000
    s_mov_b32 s27, 0x20000
    s_setprio 3
    v_and_b32 v7, -4, v120
    v_lshl_add_u32 v8, v120, 2, v7
    ds_write_b32 v8, v16
    v_lshl_add_u32 v7, v7, 2, v120
    ds_write_b8 v7, v44 offset:16
    v_and_b32 v9, -4, v121
    v_lshl_add_u32 v10, v121, 2, v9
    ds_write_b32 v10, v17
    v_lshl_add_u32 v9, v9, 2, v121
    ds_write_b8_d16_hi v9, v44 offset:16
    v_and_b32 v7, -4, v122
    v_lshl_add_u32 v8, v122, 2, v7
    ds_write_b32 v8, v18
    v_lshl_add_u32 v7, v7, 2, v122
    ds_write_b8 v7, v45 offset:16
    v_and_b32 v9, -4, v123
    v_lshl_add_u32 v10, v123, 2, v9
    ds_write_b32 v10, v19
    v_lshl_add_u32 v9, v9, 2, v123
    ds_write_b8_d16_hi v9, v45 offset:16
    s_add_u32 s46, s35, 0x7ec8000
    s_add_u32 s46, s46, s85
    buffer_store_dwordx4 v[116:119], v0, s[20:23], s46 offen sc1
    v_and_b32 v13, 0x3f0, v0
    v_and_b32 v14, 0x300, v13
    v_bfe_u32 v15, v13, 4, 4
    s_lshl_b32 s3, s32, 4
    v_add3_u32 v14, v14, v15, s3
    v_mul_u32_u24 v2, 173056, v14
    v_lshrrev_b32 v14, 6, v13
    s_add_u32 s3, s3, 0x400
    v_add_u32 v14, s3, v14
    v_mul_u32_u24 v4, 173056, v14
    v_and_b32 v14, 3, v14
    v_and_b32 v15, 0x30, v13
    v_lshl_add_u32 v14, v14, 5, v15
    v_add_u32 v6, v14, v4
    v_lshl_add_u32 v5, v15, 1, v2
    v_lshrrev_b32 v14, 3, v15
    buffer_load_ushort v100, v14, s[16:19], 0 offen offset:0
    buffer_load_ushort v101, v14, s[16:19], 0 offen offset:8
    buffer_load_ushort v102, v14, s[16:19], 0 offen offset:16
    buffer_load_ushort v103, v14, s[16:19], 0 offen offset:24
    s_mul_i32 s3, s32, 5120
    v_add_u32 v3, s3, v13
    v_lshrrev_b32 v14, 2, v13
    v_add_u32 v14, s38, v14
    v_and_b32 v7, -4, v124
    v_lshl_add_u32 v8, v124, 2, v7
    ds_write_b32 v8, v20
    v_lshl_add_u32 v7, v7, 2, v124
    ds_write_b8 v7, v46 offset:16
    v_and_b32 v9, -4, v125
    v_lshl_add_u32 v10, v125, 2, v9
    ds_write_b32 v10, v21
    v_lshl_add_u32 v9, v9, 2, v125
    ds_write_b8_d16_hi v9, v46 offset:16
    v_and_b32 v7, -4, v126
    v_lshl_add_u32 v8, v126, 2, v7
    ds_write_b32 v8, v22
    v_lshl_add_u32 v7, v7, 2, v126
    ds_write_b8 v7, v47 offset:16
    v_and_b32 v9, -4, v127
    v_lshl_add_u32 v10, v127, 2, v9
    ds_write_b32 v10, v23
    v_lshl_add_u32 v9, v9, 2, v127
    ds_write_b8_d16_hi v9, v47 offset:16
    s_setprio 2
    v_and_b32 v7, -4, v24
    v_lshl_add_u32 v8, v24, 2, v7
    ds_write_b32 v8, v40
    v_lshl_add_u32 v7, v7, 2, v24
    ds_write_b8 v7, v32 offset:16
    v_and_b32 v9, -4, v25
    v_lshl_add_u32 v10, v25, 2, v9
    ds_write_b32 v10, v41
    v_lshl_add_u32 v9, v9, 2, v25
    ds_write_b8_d16_hi v9, v32 offset:16
    v_and_b32 v7, -4, v26
    v_lshl_add_u32 v8, v26, 2, v7
    ds_write_b32 v8, v42
    v_lshl_add_u32 v7, v7, 2, v26
    ds_write_b8 v7, v33 offset:16
    v_and_b32 v9, -4, v27
    v_lshl_add_u32 v10, v27, 2, v9
    ds_write_b32 v10, v43
    v_lshl_add_u32 v9, v9, 2, v27
    ds_write_b8_d16_hi v9, v33 offset:16
    s_add_u32 s47, s35, 0x7ec8000
    s_add_u32 s47, s47, s91
    buffer_store_dwordx4 v[92:95], v0, s[20:23], s47 offen sc1
    v_lshrrev_b32 v11, 2, v0
    v_and_b32 v11, 0xfc, v11
    s_cmp_ge_u32 s84, 128
    s_cselect_b32 s82, 0, s82
    s_mul_i32 s3, s84, 40
    s_add_u32 s3, s3, s32
    s_mul_i32 s76, s3, 52429
    s_lshr_b32 s76, s76, 22
    s_mul_i32 s74, s76, 80
    s_sub_u32 s3, s3, s74
    s_mul_i32 s74, s3, 205
    s_lshr_b32 s74, s74, 10
    s_mul_i32 s75, s74, 5
    s_sub_u32 s75, s3, s75
    s_lshl_b32 s48, s74, 1
    s_add_u32 s48, s48, s75
    s_add_u32 s49, s48, s74
    s_add_u32 s49, s49, 30
    s_cmp_lt_u32 s75, 2
    s_cselect_b32 s48, s48, s49
    s_lshl_b32 s48, s48, 10
    s_mul_i32 s49, s76, 80000
    s_add_u32 s48, s48, s49
    buffer_load_dword v104, v11, s[80:83], s48 offen offset:0
    buffer_load_dword v105, v11, s[80:83], s48 offen offset:256
    buffer_load_dword v106, v11, s[80:83], s48 offen offset:512
    buffer_load_dword v107, v11, s[80:83], s48 offen offset:768
    s_mul_i32 s3, s84, 40
    s_add_u32 s3, s3, s32
    s_add_u32 s3, s3, 16
    s_mul_i32 s76, s3, 52429
    s_lshr_b32 s76, s76, 22
    s_mul_i32 s74, s76, 80
    s_sub_u32 s3, s3, s74
    s_mul_i32 s74, s3, 205
    s_lshr_b32 s74, s74, 10
    s_mul_i32 s75, s74, 5
    s_sub_u32 s75, s3, s75
    s_lshl_b32 s48, s74, 1
    s_add_u32 s48, s48, s75
    s_add_u32 s49, s48, s74
    s_add_u32 s49, s49, 30
    s_cmp_lt_u32 s75, 2
    s_cselect_b32 s48, s48, s49
    s_lshl_b32 s48, s48, 10
    s_mul_i32 s49, s76, 80000
    s_add_u32 s48, s48, s49
    buffer_load_dword v28, v11, s[80:83], s48 offen offset:0
    buffer_load_dword v29, v11, s[80:83], s48 offen offset:256
    buffer_load_dword v30, v11, s[80:83], s48 offen offset:512
    buffer_load_dword v31, v11, s[80:83], s48 offen offset:768
    s_mul_i32 s3, s84, 40
    s_add_u32 s3, s3, s32
    s_add_u32 s3, s3, 32
    s_mul_i32 s76, s3, 52429
    s_lshr_b32 s76, s76, 22
    s_mul_i32 s74, s76, 80
    s_sub_u32 s3, s3, s74
    s_cmp_ge_u32 s32, 8
    s_cselect_b32 s82, 0, s82
    s_mul_i32 s74, s3, 205
    s_lshr_b32 s74, s74, 10
    s_mul_i32 s75, s74, 5
    s_sub_u32 s75, s3, s75
    s_lshl_b32 s48, s74, 1
    s_add_u32 s48, s48, s75
    s_add_u32 s49, s48, s74
    s_add_u32 s49, s49, 30
    s_cmp_lt_u32 s75, 2
    s_cselect_b32 s48, s48, s49
    s_lshl_b32 s48, s48, 10
    s_mul_i32 s49, s76, 80000
    s_add_u32 s48, s48, s49
    buffer_load_dword v112, v11, s[80:83], s48 offen offset:0
    buffer_load_dword v113, v11, s[80:83], s48 offen offset:256
    buffer_load_dword v114, v11, s[80:83], s48 offen offset:512
    buffer_load_dword v115, v11, s[80:83], s48 offen offset:768
    v_and_b32 v7, -4, v52
    v_lshl_add_u32 v8, v52, 2, v7
    ds_write_b32 v8, v48
    v_lshl_add_u32 v7, v7, 2, v52
    ds_write_b8 v7, v34 offset:16
    v_and_b32 v9, -4, v53
    v_lshl_add_u32 v10, v53, 2, v9
    ds_write_b32 v10, v49
    v_lshl_add_u32 v9, v9, 2, v53
    ds_write_b8_d16_hi v9, v34 offset:16
    v_and_b32 v7, -4, v54
    v_lshl_add_u32 v8, v54, 2, v7
    ds_write_b32 v8, v50
    v_lshl_add_u32 v7, v7, 2, v54
    ds_write_b8 v7, v35 offset:16
    v_and_b32 v9, -4, v55
    v_lshl_add_u32 v10, v55, 2, v9
    ds_write_b32 v10, v51
    v_lshl_add_u32 v9, v9, 2, v55
    ds_write_b8_d16_hi v9, v35 offset:16
    s_setprio 1
    v_and_b32 v7, -4, v68
    v_lshl_add_u32 v8, v68, 2, v7
    ds_write_b32 v8, v84
    v_lshl_add_u32 v7, v7, 2, v68
    ds_write_b8 v7, v72 offset:16
    v_and_b32 v9, -4, v69
    v_lshl_add_u32 v10, v69, 2, v9
    ds_write_b32 v10, v85
    v_lshl_add_u32 v9, v9, 2, v69
    ds_write_b8_d16_hi v9, v72 offset:16
    v_and_b32 v7, -4, v70
    v_lshl_add_u32 v8, v70, 2, v7
    ds_write_b32 v8, v86
    v_lshl_add_u32 v7, v7, 2, v70
    ds_write_b8 v7, v73 offset:16
    v_and_b32 v9, -4, v71
    v_lshl_add_u32 v10, v71, 2, v9
    ds_write_b32 v10, v87
    v_lshl_add_u32 v9, v9, 2, v71
    ds_write_b8_d16_hi v9, v73 offset:16
    s_cmp_le_u32 s43, 5
    s_cbranch_scc1 L1_s13
    v_and_b32 v7, -4, v76
    v_lshl_add_u32 v8, v76, 2, v7
    ds_write_b32 v8, v36
    v_lshl_add_u32 v7, v7, 2, v76
    ds_write_b8 v7, v74 offset:16
    v_and_b32 v9, -4, v77
    v_lshl_add_u32 v10, v77, 2, v9
    ds_write_b32 v10, v37
    v_lshl_add_u32 v9, v9, 2, v77
    ds_write_b8_d16_hi v9, v74 offset:16
    v_and_b32 v7, -4, v78
    v_lshl_add_u32 v8, v78, 2, v7
    ds_write_b32 v8, v38
    v_lshl_add_u32 v7, v7, 2, v78
    ds_write_b8 v7, v75 offset:16
    v_and_b32 v9, -4, v79
    v_lshl_add_u32 v10, v79, 2, v9
    ds_write_b32 v10, v39
    v_lshl_add_u32 v9, v9, 2, v79
    ds_write_b8_d16_hi v9, v75 offset:16
L1_s13:
    s_add_u32 s44, s35, 0x7ec8000
    s_add_u32 s44, s44, s93
    buffer_store_dwordx4 v[108:111], v0, s[20:23], s44 offen sc1
    s_setprio 0
    s_cmp_le_u32 s43, 6
    s_cbranch_scc1 L1_s14
    v_and_b32 v7, -4, v56
    v_lshl_add_u32 v8, v56, 2, v7
    ds_write_b32 v8, v80
    v_lshl_add_u32 v7, v7, 2, v56
    ds_write_b8 v7, v64 offset:16
    v_and_b32 v9, -4, v57
    v_lshl_add_u32 v10, v57, 2, v9
    ds_write_b32 v10, v81
    v_lshl_add_u32 v9, v9, 2, v57
    ds_write_b8_d16_hi v9, v64 offset:16
    v_and_b32 v7, -4, v58
    v_lshl_add_u32 v8, v58, 2, v7
    ds_write_b32 v8, v82
    v_lshl_add_u32 v7, v7, 2, v58
    ds_write_b8 v7, v65 offset:16
    v_and_b32 v9, -4, v59
    v_lshl_add_u32 v10, v59, 2, v9
    ds_write_b32 v10, v83
    v_lshl_add_u32 v9, v9, 2, v59
    ds_write_b8_d16_hi v9, v65 offset:16
L1_s14:
    s_cmp_le_u32 s43, 7
    s_cbranch_scc1 L1_s15
    v_and_b32 v7, -4, v60
    v_lshl_add_u32 v8, v60, 2, v7
    ds_write_b32 v8, v96
    v_lshl_add_u32 v7, v7, 2, v60
    ds_write_b8 v7, v66 offset:16
    v_and_b32 v9, -4, v61
    v_lshl_add_u32 v10, v61, 2, v9
    ds_write_b32 v10, v97
    v_lshl_add_u32 v9, v9, 2, v61
    ds_write_b8_d16_hi v9, v66 offset:16
    v_and_b32 v7, -4, v62
    v_lshl_add_u32 v8, v62, 2, v7
    ds_write_b32 v8, v98
    v_lshl_add_u32 v7, v7, 2, v62
    ds_write_b8 v7, v67 offset:16
    v_and_b32 v9, -4, v63
    v_lshl_add_u32 v10, v63, 2, v9
    ds_write_b32 v10, v99
    v_lshl_add_u32 v9, v9, 2, v63
    ds_write_b8_d16_hi v9, v67 offset:16
L1_s15:
    s_add_u32 s80, s30, 0xd344000
    s_addc_u32 s81, s31, 0
    s_mov_b32 s82, 0xa000
    s_mov_b32 s83, 0x20000
    s_min_u32 s3, s84, 127
    s_mul_i32 s3, s3, 40960
    s_add_u32 s80, s80, s3
    s_addc_u32 s81, s81, 0
    s_cmp_ge_u32 s84, 128
    s_cselect_b32 s82, 0, s82
    s_waitcnt vmcnt(1)
    v_add_u32 v11, 0, v0
    buffer_store_dwordx4 v[104:107], v11, s[80:83], 0 offen sc1
    v_add_u32 v11, 16384, v0
    buffer_store_dwordx4 v[28:31], v11, s[80:83], 0 offen sc1
    v_add_u32 v11, 32768, v0
    buffer_store_dwordx4 v[112:115], v11, s[80:83], 0 offen sc1
    v_add_u32 v7, 0x10000, v0
    v_add_u32 v12, 0x20000, v0
    s_waitcnt lgkmcnt(0)
    s_barrier
    ds_read_b128 v[24:27], v0 offset:0
    ds_read_b128 v[28:31], v0 offset:16384
    ds_read_b128 v[32:35], v0 offset:32768
    ds_read_b128 v[36:39], v0 offset:49152
    ds_read_b128 v[76:79], v7 offset:0
    ds_read_b128 v[80:83], v7 offset:16384
    ds_read_b128 v[84:87], v7 offset:32768
    ds_read_b128 v[104:107], v7 offset:49152
    ds_read_b128 v[68:71], v12 offset:0
    ds_read_b128 v[72:75], v12 offset:16384
    s_cmp_lg_u32 s32, 0
    s_cbranch_scc1 L2_sg1
    s_mov_b32 exec_hi, 0
    v_mov_b32 v11, 1
    buffer_store_dword v11, v14, s[60:63], s57 offen sc1
    s_mov_b64 exec, -1
L2_sg1:
    s_waitcnt lgkmcnt(9)
    s_add_u32 s45, s35, 0xa904000
    buffer_store_dwordx4 v[24:27], v0, s[20:23], s45 offen sc1
    s_waitcnt lgkmcnt(8)
    s_add_u32 s46, s35, 0xa908000
    buffer_store_dwordx4 v[28:31], v0, s[20:23], s46 offen sc1
    s_waitcnt lgkmcnt(7)
    s_add_u32 s47, s35, 0xa90c000
    buffer_store_dwordx4 v[32:35], v0, s[20:23], s47 offen sc1
    s_waitcnt lgkmcnt(6)
    s_add_u32 s44, s35, 0xa910000
    buffer_store_dwordx4 v[36:39], v0, s[20:23], s44 offen sc1
    s_waitcnt lgkmcnt(5)
    s_add_u32 s45, s35, 0xa914000
    buffer_store_dwordx4 v[76:79], v0, s[20:23], s45 offen sc1
    s_waitcnt lgkmcnt(4)
    s_add_u32 s46, s35, 0xa918000
    buffer_store_dwordx4 v[80:83], v0, s[20:23], s46 offen sc1
    s_waitcnt lgkmcnt(3)
    s_add_u32 s47, s35, 0xa91c000
    buffer_store_dwordx4 v[84:87], v0, s[20:23], s47 offen sc1
    s_waitcnt lgkmcnt(2)
    s_cmp_le_u32 s43, 5
    s_cbranch_scc1 L1_q16
    s_add_u32 s44, s35, 0xa920000
    buffer_store_dwordx4 v[104:107], v0, s[20:23], s44 offen sc1
L1_q16:
    s_waitcnt lgkmcnt(1)
    s_cmp_le_u32 s43, 6
    s_cbranch_scc1 L1_q17
    s_add_u32 s45, s35, 0xa924000
    buffer_store_dwordx4 v[68:71], v0, s[20:23], s45 offen sc1
L1_q17:
    s_waitcnt lgkmcnt(0)
    s_cmp_le_u32 s43, 7
    s_cbranch_scc1 L1_q18
    s_add_u32 s46, s35, 0xa928000
    buffer_store_dwordx4 v[72:75], v0, s[20:23], s46 offen sc1
L1_q18:
    s_waitcnt lgkmcnt(0)
    s_setprio 3
    v_mov_b32 v92, v0
    v_mov_b32 v93, v6
    v_mov_b32 v94, v13
    v_mov_b32 v95, v5
    v_mov_b32 v0, v14
    v_lshl_add_u32 v7, v13, 3, s38
    v_lshrrev_b32 v16, 2, v15
    v_mad_u32_u24 v4, v16, 5, v4
    v_or_b32 v4, 0xf0000000, v4
    v_or_b32 v2, 0xf0000000, v2
    v_sub_u32 v1, 28, v16
    v_lshrrev_b32 v17, 2, v16
    v_and_b32 v18, 3, v17
    v_lshlrev_b32 v18, 4, v18
    v_mov_b32 v10, 0x3f80
    v_mov_b32 v11, 0
    v_lshlrev_b64 v[10:11], v18, v[10:11]
    v_and_b32 v18, 3, v17
    v_lshlrev_b32 v18, 4, v18
    v_mov_b32 v12, 0xbf80
    v_mov_b32 v13, 0
    v_lshlrev_b64 v[12:13], v18, v[12:13]
    v_mov_b32 v45, 0xf0000000
    v_add_u32 v44, s38, v0
    v_lshrrev_b32 v44, 1, v44
    v_and_b32 v44, -4, v44
    v_mov_b32 v5, 0x1fff8
    v_mov_b32 v6, 0x07ff0000
    v_mov_b32 v16, 0
    v_mov_b32 v17, 0
    v_mov_b32 v18, 0
    v_mov_b32 v19, 0
    v_add_u32 v20, 81920, v92
    v_add_u32 v21, 0x10000, v20
    s_setprio 1
    s_setprio 2
    s_mov_b32 s44, 0x4000c0c
    s_mov_b32 s45, 0x4010c0c
    s_mov_b32 s46, 0x4020c0c
    s_mov_b32 s47, 0x4030c0c
    s_mov_b32 s36, 0
    s_mov_b32 s43, 0
    s_mov_b32 s42, 0
    s_mov_b64 s[80:81], 0
    s_mov_b64 s[48:49], 0
    s_add_u32 s16, s30, 0xd344000
    s_addc_u32 s17, s31, 0
    s_mov_b32 s18, 0x500000
    s_mov_b32 s19, 0x20000
    v_mov_b32 v68, 0
    v_mov_b32 v69, 0
    v_mov_b32 v70, 0
    v_mov_b32 v71, 0
    v_mov_b32 v72, 0
    v_mov_b32 v73, 0
    v_mov_b32 v74, 0
    v_mov_b32 v75, 0
    s_waitcnt vmcnt(0)
    v_lshl_or_b32 v8, v101, 16, v100
    v_lshl_or_b32 v9, v103, 16, v102
    s_barrier
    s_cmp_lg_u32 s32, 0
    s_cbranch_scc1 L2_sg2
    s_mov_b32 exec_hi, 0
    v_mov_b32 v88, 2
    buffer_store_dword v88, v0, s[60:63], s57 offen sc1
    s_mov_b64 exec, -1
L2_sg2:
    s_mov_b64 s[84:85], 0
    s_mul_i32 s3, s33, 1280000
    s_add_u32 s3, s3, s100
    s_add_u32 s3, s3, 32768
    buffer_load_dwordx4 v[124:127], v94, s[24:27], s3 offen offset:2048
    s_mul_i32 s3, s33, 1280000
    s_add_u32 s3, s3, s100
    s_add_u32 s3, s3, 32768
    buffer_load_dwordx4 v[116:119], v94, s[24:27], s3 offen offset:0
    s_mul_i32 s3, s33, 1280000
    s_add_u32 s3, s3, s100
    s_add_u32 s3, s3, 32768
    buffer_load_dwordx4 v[120:123], v94, s[24:27], s3 offen offset:1024
    s_mul_i32 s3, s33, 1280000
    s_add_u32 s3, s3, s38
    s_add_u32 s3, s3, 0
    buffer_load_dwordx4 v[108:111], v94, s[24:27], s3 offen offset:0
    s_mul_i32 s3, s33, 1280000
    s_add_u32 s3, s3, s38
    s_add_u32 s3, s3, 0
    buffer_load_dwordx4 v[112:115], v94, s[24:27], s3 offen offset:1024
    ds_write_b128 v20, v[16:19] offset:0
    ds_write_b128 v20, v[16:19] offset:16384
    ds_write_b128 v20, v[16:19] offset:32768
    ds_write_b128 v20, v[16:19] offset:49152
    ds_write_b128 v21, v[16:19]
    s_cmp_eq_u32 s56, 0
    s_cbranch_scc1 L2_e3
    v_lshlrev_b32 v16, 3, v94
    v_and_b32 v16, 0x80, v16
L2_e4:
    buffer_load_dword v88, v16, s[68:71], 0 offen sc1
    s_waitcnt vmcnt(0)
    v_cmp_gt_u32 vcc, 0x80, v88
    s_cbranch_vccnz L2_e4
L2_e3:
    s_mov_b64 exec, 0xffff
L2_p1:
    buffer_load_dword v88, v7, s[60:63], 0 offen sc1
    s_waitcnt vmcnt(0)
    v_cmpx_gt_u32 vcc, 1, v88
    s_cbranch_vccnz L2_p1
    s_mov_b64 exec, -1
    v_cmp_gt_u32 vcc, 2, v88
    s_and_b32 s56, vcc_lo, 0xffff
    buffer_load_dwordx4 v[48:51], v95, s[12:15], s39 offen offset:0
    buffer_load_dwordx4 v[56:59], v95, s[12:15], s39 offen offset:32
    buffer_load_dwordx4 v[52:55], v95, s[12:15], s39 offen offset:16
    buffer_load_dwordx4 v[60:63], v95, s[12:15], s39 offen offset:48
    buffer_load_dwordx4 v[64:67], v93, s[12:15], s39 offen
    s_waitcnt vmcnt(0)
    v_sub_u16 v88, v56, v48
    v_and_b32 v89, 3, v48
    v_add3_u32 v99, v88, v89, 3
    v_and_b32 v99, -4, v99
    v_max_u32 v99, 4, v99
    v_and_b32 v97, 0xfffc, v48
    v_bfm_b32 v96, v88, v89
    v_add_u32_dpp v91, v99, v99 row_shr:1 row_mask:0xf bank_mask:0xf bound_ctrl:1
    v_mad_u32_u24 v97, v97, 5, v2
    v_cmp_lt_u32 vcc, 16, v99
    v_add_u32_dpp v91, v91, v91 row_shr:2 row_mask:0xf bank_mask:0xf bound_ctrl:1
    v_sub_u32 v98, s38, v99
    v_lshrrev_b64 v[48:49], 16, v[48:49]
    v_add_u32_dpp v91, v91, v91 row_shr:4 row_mask:0xf bank_mask:0xf bound_ctrl:1
    v_lshrrev_b64 v[56:57], 16, v[56:57]
    s_mov_b32 s101, 0
    v_add_u32_dpp v91, v91, v91 row_shr:8 row_mask:0xf bank_mask:0xf bound_ctrl:1
    s_nop 1
    v_add_u32_dpp v91, v91, v91 row_bcast:15 row_mask:0xa bank_mask:0xf
    s_nop 1
    v_add_u32_dpp v91, v91, v91 row_bcast:31 row_mask:0xc bank_mask:0xf
    v_add_u32 v98, v98, v91
    v_readlane_b32 s37, v91, 63
    s_cbranch_vccnz L2_xo3
L2_xp3:
    s_cmp_gt_u32 s37, 1024
    s_cbranch_scc1 L2_xs4
    s_cmp_lg_u32 s101, 0
    s_cbranch_scc1 L2_xa4
L2_xb4:
    v_lshlrev_b32 v89, 16, v96
    v_add_u32 v90, 60, v97
    v_bitop3_b32 v90, v89, v45, v90 bitop3:0x6a
    ds_write_b32 v98, v90 offset:12
    v_lshlrev_b32 v89, 20, v96
    v_add_u32 v90, 40, v97
    v_bitop3_b32 v90, v89, v45, v90 bitop3:0x6a
    ds_write_b32 v98, v90 offset:8
    v_lshlrev_b32 v89, 24, v96
    v_add_u32 v90, 20, v97
    v_bitop3_b32 v90, v89, v45, v90 bitop3:0x6a
    ds_write_b32 v98, v90 offset:4
    v_lshlrev_b32 v89, 28, v96
    v_bitop3_b32 v90, v89, v45, v97 bitop3:0x6a
    ds_write_b32 v98, v90 offset:0
    v_mov_b32_dpp v91, v64 quad_perm:[0,0,0,0] row_mask:0xf bank_mask:0xf
    v_and_b32 v89, 3, v91
    v_and_b32 v97, 0xfffc, v91
    v_sub_u16_dpp v88, v64, v91 quad_perm:[2,2,2,2] row_mask:0xf bank_mask:0xf
    v_mad_u32_u24 v97, v97, 5, v4
    v_add_u32 v99, v88, v89
    v_bfm_b32 v96, v88, v89
    v_cmp_lt_u32 s[58:59], 16, v99
    v_lshlrev_b32 v89, v1, v96
    v_and_b32 v89, v45, v89
    v_cmp_ne_u32 vcc, 0, v89
    v_xor_b32 v90, v97, v89
    s_add_u32 s3, s37, s38
    v_mbcnt_lo_u32_b32 v98, vcc_lo, 0
    v_mbcnt_hi_u32_b32 v98, vcc_hi, v98
    s_bcnt1_i32_b64 s41, vcc
    v_lshl_add_u32 v98, v98, 2, s3
    s_lshl2_add_u32 s37, s41, s37
    s_mov_b64 exec, vcc
    ds_write_b32 v98, v90
    s_mov_b64 exec, -1
    s_cmp_lg_u64 s[58:59], 0
    s_cbranch_scc1 L2_xe4
L2_xr4:
    v_add_u32 v98, s37, v0
    v_mov_b32 v90, -1
    ds_write_b32 v98, v90
L2_xw4:
    ds_read_b32 v21, v0 offset:0
    ds_read_b32 v27, v0 offset:256
    ds_read_b32 v31, v44 offset:768
    ds_read_b32 v39, v0 offset:512
    s_sub_u32 s3, s37, 768
    s_cmp_gt_u32 s3, 128
    s_cbranch_scc1 L2_xf4
L2_xg4:
    v_sub_u16 v88, v58, v50
    v_and_b32 v89, 3, v50
    v_add3_u32 v99, v88, v89, 3
    v_and_b32 v99, -4, v99
    v_max_u32 v99, 4, v99
    v_and_b32 v97, 0xfffc, v50
    v_bfm_b32 v96, v88, v89
    v_add_u32_dpp v91, v99, v99 row_shr:1 row_mask:0xf bank_mask:0xf bound_ctrl:1
    v_mad_u32_u24 v97, v97, 5, v2
    v_cmp_lt_u32 vcc, 16, v99
    v_add_u32_dpp v91, v91, v91 row_shr:2 row_mask:0xf bank_mask:0xf bound_ctrl:1
    v_sub_u32 v98, s38, v99
    v_lshrrev_b64 v[50:51], 16, v[50:51]
    v_add_u32_dpp v91, v91, v91 row_shr:4 row_mask:0xf bank_mask:0xf bound_ctrl:1
    v_lshrrev_b64 v[58:59], 16, v[58:59]
    s_mov_b32 s101, 0
    v_add_u32_dpp v91, v91, v91 row_shr:8 row_mask:0xf bank_mask:0xf bound_ctrl:1
    s_nop 1
    v_add_u32_dpp v91, v91, v91 row_bcast:15 row_mask:0xa bank_mask:0xf
    s_nop 1
    v_add_u32_dpp v91, v91, v91 row_bcast:31 row_mask:0xc bank_mask:0xf
    v_add_u32 v98, v98, v91
    v_readlane_b32 s37, v91, 63
    s_cbranch_vccnz L2_xo5
L2_xp5:
    s_waitcnt lgkmcnt(0)
    s_cmp_gt_u32 s37, 1024
    s_cbranch_scc1 L2_xs6
    s_cmp_lg_u32 s101, 0
    s_cbranch_scc1 L2_xa6
L2_xb6:
    v_lshlrev_b32 v89, 16, v96
    v_add_u32 v90, 60, v97
    v_bitop3_b32 v90, v89, v45, v90 bitop3:0x6a
    ds_write_b32 v98, v90 offset:12
    v_lshlrev_b32 v89, 20, v96
    v_add_u32 v90, 40, v97
    v_bitop3_b32 v90, v89, v45, v90 bitop3:0x6a
    ds_write_b32 v98, v90 offset:8
    v_lshlrev_b32 v89, 24, v96
    v_add_u32 v90, 20, v97
    v_bitop3_b32 v90, v89, v45, v90 bitop3:0x6a
    ds_write_b32 v98, v90 offset:4
    v_lshlrev_b32 v89, 28, v96
    v_bitop3_b32 v90, v89, v45, v97 bitop3:0x6a
    ds_write_b32 v98, v90 offset:0
    v_mov_b32_dpp v91, v66 quad_perm:[0,0,0,0] row_mask:0xf bank_mask:0xf
    v_and_b32 v89, 3, v91
    v_and_b32 v97, 0xfffc, v91
    v_sub_u16_dpp v88, v66, v91 quad_perm:[2,2,2,2] row_mask:0xf bank_mask:0xf
    v_mad_u32_u24 v97, v97, 5, v4
    v_add_u32 v99, v88, v89
    v_bfm_b32 v96, v88, v89
    v_cmp_lt_u32 s[58:59], 16, v99
    v_lshlrev_b32 v89, v1, v96
    v_and_b32 v89, v45, v89
    v_cmp_ne_u32 vcc, 0, v89
    v_xor_b32 v90, v97, v89
    s_add_u32 s3, s37, s38
    v_mbcnt_lo_u32_b32 v98, vcc_lo, 0
    v_mbcnt_hi_u32_b32 v98, vcc_hi, v98
    s_bcnt1_i32_b64 s41, vcc
    v_lshl_add_u32 v98, v98, 2, s3
    s_lshl2_add_u32 s37, s41, s37
    s_mov_b64 exec, vcc
    ds_write_b32 v98, v90
    s_mov_b64 exec, -1
    s_cmp_lg_u64 s[58:59], 0
    s_cbranch_scc1 L2_xe6
L2_xr6:
    v_add_u32 v98, s37, v0
    v_mov_b32 v90, -1
    ds_write_b32 v98, v90
L2_xw6:
    ds_read_b32 v40, v0 offset:0
    ds_read_b32 v41, v0 offset:256
    ds_read_b32 v42, v44 offset:768
    ds_read_b32 v43, v0 offset:512
    s_sub_u32 s3, s37, 768
    s_cmp_gt_u32 s3, 128
    s_cbranch_scc1 L2_xf6
L2_xg6:
    v_subrev_u32 v88, s38, v3
    ds_write_b128 v88, v[124:127] offset:34816
    v_subrev_u32 v88, s38, v3
    ds_write_b128 v88, v[116:119] offset:32768
    v_subrev_u32 v88, s38, v3
    ds_write_b128 v88, v[120:123] offset:33792
    v_subrev_u32 v88, s100, v3
    ds_write_b128 v88, v[108:111] offset:0
    v_subrev_u32 v88, s100, v3
    ds_write_b128 v88, v[112:115] offset:1024
    s_cmp_eq_u32 s56, 0
    s_cbranch_scc1 L2_e2
    s_mov_b32 exec_lo, s56
    s_mov_b32 exec_hi, 0
    buffer_load_dword v88, v7, s[60:63], 0 offen sc1
    s_mov_b64 exec, -1
    s_waitcnt vmcnt(0)
    v_cmp_gt_u32 vcc, 2, v88
    s_and_b32 s56, vcc_lo, s56
    s_cbranch_scc0 L2_e2
    s_mul_i32 s3, s33, 1280000
    s_add_u32 s3, s3, s100
    s_add_u32 s3, s3, 352768
    buffer_load_dwordx4 v[124:127], v94, s[24:27], s3 offen offset:2048
    s_mul_i32 s3, s33, 1280000
    s_add_u32 s3, s3, s100
    s_add_u32 s3, s3, 352768
    buffer_load_dwordx4 v[116:119], v94, s[24:27], s3 offen offset:0
    s_mul_i32 s3, s33, 1280000
    s_add_u32 s3, s3, s100
    s_add_u32 s3, s3, 352768
    buffer_load_dwordx4 v[120:123], v94, s[24:27], s3 offen offset:1024
    s_mul_i32 s3, s33, 1280000
    s_add_u32 s3, s3, s38
    s_add_u32 s3, s3, 320000
    buffer_load_dwordx4 v[108:111], v94, s[24:27], s3 offen offset:0
    s_mul_i32 s3, s33, 1280000
    s_add_u32 s3, s3, s38
    s_add_u32 s3, s3, 320000
    buffer_load_dwordx4 v[112:115], v94, s[24:27], s3 offen offset:1024
    s_mov_b32 exec_lo, s56
    s_mov_b32 exec_hi, 0
L2_p2:
    buffer_load_dword v88, v7, s[60:63], 0 offen sc1
    s_waitcnt vmcnt(0)
    v_cmpx_gt_u32 vcc, 2, v88
    s_cbranch_vccnz L2_p2
    s_mov_b64 exec, -1
L2_e2:
    s_mov_b32 s6, 0xaaaaaaaa
    s_mov_b32 s7, 0xaaaaaaaa
    v_and_b32 v47, 0x0fffffff, v21
    buffer_load_dwordx2 v[16:17], v47, s[8:11], 0 offen
    buffer_load_dwordx3 v[18:20], v47, s[8:11], 0 offen offset:8
    s_setprio 1
    v_and_b32 v47, 0x0fffffff, v27
    buffer_load_dwordx2 v[22:23], v47, s[8:11], 0 offen
    buffer_load_dwordx3 v[24:26], v47, s[8:11], 0 offen offset:8
    s_waitcnt lgkmcnt(0)
    s_barrier
    s_bitcmp1_b32 s36, s42
    s_cbranch_scc1 L2_slow
L2_ret0:
    s_setprio 3
    s_bitcmp1_b32 s43, s42
    s_cbranch_scc1 L2_oa7
L2_ob7:
    s_bitcmp1_b32 s43, s42
    s_cbranch_scc1 L2_oa8
L2_ob8:
    s_waitcnt vmcnt(2)
    v_and_b32 v46, 0x20000000, v21
    v_lshrrev_b32 v47, 14, v17
    v_bitop3_b32 v47, v47, v5, v46 bitop3:0xea
    ds_read_b64 v[102:103], v47
    v_bitop3_b32 v93, v17, v5, v46 bitop3:0xea
    v_and_b32 v46, 0x10000000, v21
    v_lshrrev_b32 v47, 14, v16
    v_bitop3_b32 v47, v47, v5, v46 bitop3:0xea
    ds_read_b64 v[100:101], v47
    v_bitop3_b32 v92, v16, v5, v46 bitop3:0xea
    v_perm_b32 v15, v17, v20, s45
    v_bitop3_b32 v46, v17, 0.5, -0.5 bitop3:0xa8
    v_perm_b32 v14, v16, v20, s44
    v_bitop3_b32 v47, v16, 0.5, -0.5 bitop3:0xa8
    v_bitop3_b32 v15, v6, v15, v46 bitop3:0xca
    v_bitop3_b32 v14, v6, v14, v47 bitop3:0xca
    s_waitcnt lgkmcnt(0)
    v_mfma_f32_4x4x4_16b_bf16 v[80:83], v[8:9], v[102:103], 0
    v_mfma_f32_4x4x4_16b_bf16 v[76:79], v[8:9], v[100:101], 0
    v_cmp_lt_u32 s[84:85], v5, v92
    s_nop 2
    v_pk_mul_f32 v[80:81], v[80:81], v[14:15] op_sel:[0,1] op_sel_hi:[1,1]
    v_pk_mul_f32 v[82:83], v[82:83], v[14:15] op_sel:[0,1] op_sel_hi:[1,1]
    v_pk_mul_f32 v[76:77], v[76:77], v[14:15] op_sel:[0,0] op_sel_hi:[1,0]
    v_pk_mul_f32 v[78:79], v[78:79], v[14:15] op_sel:[0,0] op_sel_hi:[1,0]
    v_and_b32 v47, 0x0fffffff, v39
    buffer_load_dwordx2 v[34:35], v47, s[8:11], 0 offen
    buffer_load_dwordx3 v[36:38], v47, s[8:11], 0 offen offset:8
    v_and_b32 v46, 0x80000000, v21
    v_lshrrev_b32 v47, 14, v19
    v_bitop3_b32 v47, v47, v5, v46 bitop3:0xea
    ds_read_b64 v[106:107], v47
    v_and_b32 v99, 0x40000000, v21
    v_lshrrev_b32 v47, 14, v18
    v_bitop3_b32 v47, v47, v5, v99 bitop3:0xea
    ds_read_b64 v[104:105], v47
    v_cmp_ne_u64 s[50:51], v[72:73], v[68:69]
    v_cmpx_ne_u64 s[54:55], v[74:75], v[70:71]
    s_and_b64 s[82:83], s[54:55], s[80:81]
    s_cbranch_scc1 L2_c9
L2_d9:
    v_mov_b64 v[84:85], v[70:71]
    v_mov_b32 v7, v95
    v_mov_b64 v[86:87], v[74:75]
    s_or_b64 s[80:81], s[80:81], s[54:55]
    s_mov_b64 exec, s[50:51]
    s_and_b64 s[82:83], s[50:51], s[80:81]
    s_cbranch_scc1 L2_c10
L2_d10:
    v_mov_b64 v[84:85], v[68:69]
    v_mov_b32 v7, v94
    v_mov_b64 v[86:87], v[72:73]
    s_mov_b64 exec, -1
    s_or_b64 s[80:81], s[80:81], s[50:51]
    s_and_b64 exec, s[84:85], s[80:81]
    v_mfma_f32_4x4x4_16b_bf16 v[76:79], v[12:13], v[84:85], 0
    v_mov_b32 v92, v7
    s_andn2_b64 s[80:81], s[80:81], s[84:85]
    v_mfma_f32_4x4x4_16b_bf16 v[76:79], v[10:11], v[86:87], v[76:79]
    s_mov_b64 exec, -1
    ds_read_b64 v[70:71], v93 offset:65408
    ds_read_b64 v[68:69], v92 offset:65408
    v_bitop3_b32 v94, v18, v5, v99 bitop3:0xea
    v_bitop3_b32 v95, v19, v5, v46 bitop3:0xea
    v_perm_b32 v15, v19, v20, s47
    v_bitop3_b32 v46, v19, 0.5, -0.5 bitop3:0xa8
    v_perm_b32 v14, v18, v20, s46
    v_bitop3_b32 v47, v18, 0.5, -0.5 bitop3:0xa8
    v_bitop3_b32 v15, v6, v15, v46 bitop3:0xca
    v_bitop3_b32 v14, v6, v14, v47 bitop3:0xca
    s_waitcnt lgkmcnt(1)
    v_mfma_f32_4x4x4_16b_bf16 v[80:83], v[10:11], v[70:71], v[80:83]
    s_waitcnt lgkmcnt(0)
    v_mfma_f32_4x4x4_16b_bf16 v[76:79], v[10:11], v[68:69], v[76:79]
    s_nop 2
    v_cvt_pk_bf16_f32 v80, v80, v81
    v_cvt_pk_bf16_f32 v81, v82, v83
    ds_wrxchg_rtn_b64 v[74:75], v93, v[80:81] offset:65408
    v_cvt_pk_bf16_f32 v76, v76, v77
    v_cvt_pk_bf16_f32 v77, v78, v79
    ds_wrxchg_rtn_b64 v[72:73], v92, v[76:77] offset:65408
    s_setprio 2
    v_mfma_f32_4x4x4_16b_bf16 v[80:83], v[8:9], v[106:107], 0
    v_mfma_f32_4x4x4_16b_bf16 v[76:79], v[8:9], v[104:105], 0
    v_cmp_lt_u32 s[48:49], v5, v95
    s_nop 2
    v_pk_mul_f32 v[80:81], v[80:81], v[14:15] op_sel:[0,1] op_sel_hi:[1,1]
    v_pk_mul_f32 v[82:83], v[82:83], v[14:15] op_sel:[0,1] op_sel_hi:[1,1]
    v_pk_mul_f32 v[76:77], v[76:77], v[14:15] op_sel:[0,0] op_sel_hi:[1,0]
    v_pk_mul_f32 v[78:79], v[78:79], v[14:15] op_sel:[0,0] op_sel_hi:[1,0]
    v_and_b32 v47, 0x0fffffff, v31
    buffer_load_dword v30, v47, s[8:11], 0 offen offset:16
    s_mov_b64 exec, s[6:7]
    v_add_u32 v47, 8, v47
    v_lshrrev_b32 v31, 2, v31
    s_mov_b64 exec, -1
    buffer_load_dwordx2 v[28:29], v47, s[8:11], 0 offen
    v_and_b32 v47, 0x3f0, v3
    s_cmp_lg_u32 s56, 0
    s_cbranch_scc1 L2_m11
    s_mul_i32 s3, s33, 1280000
    s_add_u32 s3, s3, s100
    s_add_u32 s3, s3, 352768
    buffer_load_dwordx4 v[124:127], v47, s[24:27], s3 offen offset:2048
L2_m11:
    v_and_b32 v47, 0x3f0, v3
    s_cmp_lg_u32 s56, 0
    s_cbranch_scc1 L2_m12
    s_mul_i32 s3, s33, 1280000
    s_add_u32 s3, s3, s100
    s_add_u32 s3, s3, 352768
    buffer_load_dwordx4 v[116:119], v47, s[24:27], s3 offen offset:0
L2_m12:
    s_waitcnt vmcnt(4)
    v_and_b32 v46, 0x20000000, v27
    v_lshrrev_b32 v47, 14, v23
    v_bitop3_b32 v47, v47, v5, v46 bitop3:0xea
    ds_read_b64 v[102:103], v47
    v_and_b32 v99, 0x10000000, v27
    v_lshrrev_b32 v47, 14, v22
    v_bitop3_b32 v47, v47, v5, v99 bitop3:0xea
    ds_read_b64 v[100:101], v47
    s_waitcnt lgkmcnt(2)
    v_cmp_ne_u64 s[50:51], v[72:73], v[68:69]
    v_cmpx_ne_u64 s[54:55], v[74:75], v[70:71]
    s_and_b64 s[82:83], s[54:55], s[80:81]
    s_cbranch_scc1 L2_c13
L2_d13:
    v_mov_b64 v[84:85], v[70:71]
    v_mov_b32 v7, v93
    v_mov_b64 v[86:87], v[74:75]
    s_or_b64 s[80:81], s[80:81], s[54:55]
    s_mov_b64 exec, s[50:51]
    s_and_b64 s[82:83], s[50:51], s[80:81]
    s_cbranch_scc1 L2_c14
L2_d14:
    v_mov_b64 v[84:85], v[68:69]
    v_mov_b32 v7, v92
    v_mov_b64 v[86:87], v[72:73]
    s_mov_b64 exec, -1
    s_or_b64 s[80:81], s[80:81], s[50:51]
    s_and_b64 exec, s[48:49], s[80:81]
    v_mfma_f32_4x4x4_16b_bf16 v[80:83], v[12:13], v[84:85], 0
    v_mov_b32 v95, v7
    s_andn2_b64 s[80:81], s[80:81], s[48:49]
    v_mfma_f32_4x4x4_16b_bf16 v[80:83], v[10:11], v[86:87], v[80:83]
    s_mov_b64 exec, -1
    ds_read_b64 v[70:71], v95 offset:65408
    ds_read_b64 v[68:69], v94 offset:65408
    v_bitop3_b32 v92, v22, v5, v99 bitop3:0xea
    v_bitop3_b32 v93, v23, v5, v46 bitop3:0xea
    v_perm_b32 v15, v23, v26, s45
    v_bitop3_b32 v46, v23, 0.5, -0.5 bitop3:0xa8
    v_perm_b32 v14, v22, v26, s44
    v_bitop3_b32 v47, v22, 0.5, -0.5 bitop3:0xa8
    v_bitop3_b32 v15, v6, v15, v46 bitop3:0xca
    v_bitop3_b32 v14, v6, v14, v47 bitop3:0xca
    s_waitcnt lgkmcnt(1)
    v_mfma_f32_4x4x4_16b_bf16 v[80:83], v[10:11], v[70:71], v[80:83]
    s_waitcnt lgkmcnt(0)
    v_mfma_f32_4x4x4_16b_bf16 v[76:79], v[10:11], v[68:69], v[76:79]
    s_nop 2
    v_cvt_pk_bf16_f32 v80, v80, v81
    v_cvt_pk_bf16_f32 v81, v82, v83
    ds_wrxchg_rtn_b64 v[74:75], v95, v[80:81] offset:65408
    v_cvt_pk_bf16_f32 v76, v76, v77
    v_cvt_pk_bf16_f32 v77, v78, v79
    ds_wrxchg_rtn_b64 v[72:73], v94, v[76:77] offset:65408
    s_setprio 1
    v_mfma_f32_4x4x4_16b_bf16 v[80:83], v[8:9], v[102:103], 0
    v_mfma_f32_4x4x4_16b_bf16 v[76:79], v[8:9], v[100:101], 0
    s_nop 3
    v_pk_mul_f32 v[80:81], v[80:81], v[14:15] op_sel:[0,1] op_sel_hi:[1,1]
    v_pk_mul_f32 v[82:83], v[82:83], v[14:15] op_sel:[0,1] op_sel_hi:[1,1]
    v_pk_mul_f32 v[76:77], v[76:77], v[14:15] op_sel:[0,0] op_sel_hi:[1,0]
    v_pk_mul_f32 v[78:79], v[78:79], v[14:15] op_sel:[0,0] op_sel_hi:[1,0]
    v_and_b32 v47, 0x3f0, v3
    s_cmp_lg_u32 s56, 0
    s_cbranch_scc1 L2_m15
    s_mul_i32 s3, s33, 1280000
    s_add_u32 s3, s3, s100
    s_add_u32 s3, s3, 352768
    buffer_load_dwordx4 v[120:123], v47, s[24:27], s3 offen offset:1024
L2_m15:
    v_sub_u16 v88, v60, v52
    v_and_b32 v89, 3, v52
    v_add3_u32 v99, v88, v89, 3
    v_and_b32 v99, -4, v99
    v_max_u32 v99, 4, v99
    v_and_b32 v97, 0xfffc, v52
    v_bfm_b32 v96, v88, v89
    v_add_u32_dpp v91, v99, v99 row_shr:1 row_mask:0xf bank_mask:0xf bound_ctrl:1
    v_mad_u32_u24 v97, v97, 5, v2
    v_cmp_lt_u32 vcc, 16, v99
    v_add_u32_dpp v91, v91, v91 row_shr:2 row_mask:0xf bank_mask:0xf bound_ctrl:1
    v_sub_u32 v98, s38, v99
    v_lshrrev_b64 v[52:53], 16, v[52:53]
    v_add_u32_dpp v91, v91, v91 row_shr:4 row_mask:0xf bank_mask:0xf bound_ctrl:1
    v_lshrrev_b64 v[60:61], 16, v[60:61]
    s_mov_b32 s101, 0
    v_add_u32_dpp v91, v91, v91 row_shr:8 row_mask:0xf bank_mask:0xf bound_ctrl:1
    s_nop 1
    v_add_u32_dpp v91, v91, v91 row_bcast:15 row_mask:0xa bank_mask:0xf
    s_nop 1
    v_add_u32_dpp v91, v91, v91 row_bcast:31 row_mask:0xc bank_mask:0xf
    v_add_u32 v98, v98, v91
    v_readlane_b32 s37, v91, 63
    s_cbranch_vccnz L2_xo16
L2_xp16:
    v_and_b32 v46, 0x80000000, v27
    v_lshrrev_b32 v47, 14, v25
    v_bitop3_b32 v47, v47, v5, v46 bitop3:0xea
    ds_read_b64 v[106:107], v47
    v_and_b32 v99, 0x40000000, v27
    v_lshrrev_b32 v47, 14, v24
    v_bitop3_b32 v47, v47, v5, v99 bitop3:0xea
    ds_read_b64 v[104:105], v47
    s_waitcnt lgkmcnt(2)
    v_cmp_ne_u64 s[50:51], v[72:73], v[68:69]
    v_cmpx_ne_u64 s[54:55], v[74:75], v[70:71]
    s_and_b64 s[82:83], s[54:55], s[80:81]
    s_cbranch_scc1 L2_c17
L2_d17:
    v_mov_b64 v[84:85], v[70:71]
    v_mov_b32 v7, v95
    v_mov_b64 v[86:87], v[74:75]
    s_or_b64 s[80:81], s[80:81], s[54:55]
    s_mov_b64 exec, s[50:51]
    s_and_b64 s[82:83], s[50:51], s[80:81]
    s_cbranch_scc1 L2_c18
L2_d18:
    v_mov_b64 v[84:85], v[68:69]
    v_mov_b32 v7, v94
    v_mov_b64 v[86:87], v[72:73]
    s_mov_b64 exec, -1
    s_or_b64 s[80:81], s[80:81], s[50:51]
    ds_read_b64 v[70:71], v93 offset:65408
    ds_read_b64 v[68:69], v92 offset:65408
    v_bitop3_b32 v94, v24, v5, v99 bitop3:0xea
    v_bitop3_b32 v95, v25, v5, v46 bitop3:0xea
    v_perm_b32 v15, v25, v26, s47
    v_bitop3_b32 v46, v25, 0.5, -0.5 bitop3:0xa8
    v_perm_b32 v14, v24, v26, s46
    v_bitop3_b32 v47, v24, 0.5, -0.5 bitop3:0xa8
    v_bitop3_b32 v15, v6, v15, v46 bitop3:0xca
    v_bitop3_b32 v14, v6, v14, v47 bitop3:0xca
    s_waitcnt lgkmcnt(1)
    v_mfma_f32_4x4x4_16b_bf16 v[80:83], v[10:11], v[70:71], v[80:83]
    s_waitcnt lgkmcnt(0)
    v_mfma_f32_4x4x4_16b_bf16 v[76:79], v[10:11], v[68:69], v[76:79]
    s_nop 2
    v_cvt_pk_bf16_f32 v80, v80, v81
    v_cvt_pk_bf16_f32 v81, v82, v83
    ds_wrxchg_rtn_b64 v[74:75], v93, v[80:81] offset:65408
    v_cvt_pk_bf16_f32 v76, v76, v77
    v_cvt_pk_bf16_f32 v77, v78, v79
    ds_wrxchg_rtn_b64 v[72:73], v92, v[76:77] offset:65408
    v_mfma_f32_4x4x4_16b_bf16 v[80:83], v[8:9], v[106:107], 0
    v_mfma_f32_4x4x4_16b_bf16 v[76:79], v[8:9], v[104:105], 0
    v_cmp_lt_u32 s[84:85], v5, v94
    s_nop 2
    v_pk_mul_f32 v[80:81], v[80:81], v[14:15] op_sel:[0,1] op_sel_hi:[1,1]
    v_pk_mul_f32 v[82:83], v[82:83], v[14:15] op_sel:[0,1] op_sel_hi:[1,1]
    v_pk_mul_f32 v[76:77], v[76:77], v[14:15] op_sel:[0,0] op_sel_hi:[1,0]
    v_pk_mul_f32 v[78:79], v[78:79], v[14:15] op_sel:[0,0] op_sel_hi:[1,0]
    v_and_b32 v47, 0x3f0, v3
    s_cmp_lg_u32 s56, 0
    s_cbranch_scc1 L2_m19
    s_mul_i32 s3, s33, 1280000
    s_add_u32 s3, s3, s38
    s_add_u32 s3, s3, 320000
    buffer_load_dwordx4 v[108:111], v47, s[24:27], s3 offen offset:0
L2_m19:
    v_and_b32 v47, 0x3f0, v3
    s_cmp_lg_u32 s56, 0
    s_cbranch_scc1 L2_m20
    s_mul_i32 s3, s33, 1280000
    s_add_u32 s3, s3, s38
    s_add_u32 s3, s3, 320000
    buffer_load_dwordx4 v[112:115], v47, s[24:27], s3 offen offset:1024
L2_m20:
    v_and_b32 v47, 0x0fffffff, v40
    buffer_load_dwordx2 v[16:17], v47, s[8:11], 0 offen
    buffer_load_dwordx3 v[18:20], v47, s[8:11], 0 offen offset:8
    s_waitcnt vmcnt(2)
    s_mov_b64 exec, s[6:7]
    v_lshrrev_b32 v30, 16, v30
    s_mov_b64 exec, -1
    v_and_b32 v46, 0x20000000, v31
    v_lshrrev_b32 v47, 14, v29
    v_bitop3_b32 v47, v47, v5, v46 bitop3:0xea
    ds_read_b64 v[102:103], v47
    v_and_b32 v99, 0x10000000, v31
    v_lshrrev_b32 v47, 14, v28
    v_bitop3_b32 v47, v47, v5, v99 bitop3:0xea
    ds_read_b64 v[100:101], v47
    s_waitcnt lgkmcnt(2)
    v_cmp_ne_u64 s[50:51], v[72:73], v[68:69]
    v_cmpx_ne_u64 s[54:55], v[74:75], v[70:71]
    s_and_b64 s[82:83], s[54:55], s[80:81]
    s_cbranch_scc1 L2_c21
L2_d21:
    v_mov_b64 v[84:85], v[70:71]
    v_mov_b32 v7, v93
    v_mov_b64 v[86:87], v[74:75]
    s_or_b64 s[80:81], s[80:81], s[54:55]
    s_mov_b64 exec, s[50:51]
    s_and_b64 s[82:83], s[50:51], s[80:81]
    s_cbranch_scc1 L2_c22
L2_d22:
    v_mov_b64 v[84:85], v[68:69]
    v_mov_b32 v7, v92
    v_mov_b64 v[86:87], v[72:73]
    s_mov_b64 exec, -1
    s_or_b64 s[80:81], s[80:81], s[50:51]
    s_and_b64 exec, s[84:85], s[80:81]
    v_mfma_f32_4x4x4_16b_bf16 v[76:79], v[12:13], v[84:85], 0
    v_mov_b32 v94, v7
    s_andn2_b64 s[80:81], s[80:81], s[84:85]
    v_mfma_f32_4x4x4_16b_bf16 v[76:79], v[10:11], v[86:87], v[76:79]
    s_mov_b64 exec, -1
    ds_read_b64 v[70:71], v95 offset:65408
    ds_read_b64 v[68:69], v94 offset:65408
    v_bitop3_b32 v92, v28, v5, v99 bitop3:0xea
    v_bitop3_b32 v93, v29, v5, v46 bitop3:0xea
    v_perm_b32 v15, v29, v30, s45
    v_bitop3_b32 v46, v29, 0.5, -0.5 bitop3:0xa8
    v_perm_b32 v14, v28, v30, s44
    v_bitop3_b32 v47, v28, 0.5, -0.5 bitop3:0xa8
    v_bitop3_b32 v15, v6, v15, v46 bitop3:0xca
    v_bitop3_b32 v14, v6, v14, v47 bitop3:0xca
    s_waitcnt lgkmcnt(1)
    v_mfma_f32_4x4x4_16b_bf16 v[80:83], v[10:11], v[70:71], v[80:83]
    s_waitcnt lgkmcnt(0)
    v_mfma_f32_4x4x4_16b_bf16 v[76:79], v[10:11], v[68:69], v[76:79]
    s_nop 2
    v_cvt_pk_bf16_f32 v80, v80, v81
    v_cvt_pk_bf16_f32 v81, v82, v83
    ds_wrxchg_rtn_b64 v[74:75], v95, v[80:81] offset:65408
    v_cvt_pk_bf16_f32 v76, v76, v77
    v_cvt_pk_bf16_f32 v77, v78, v79
    ds_wrxchg_rtn_b64 v[72:73], v94, v[76:77] offset:65408
    s_setprio 0
    v_mfma_f32_4x4x4_16b_bf16 v[80:83], v[8:9], v[102:103], 0
    v_mfma_f32_4x4x4_16b_bf16 v[76:79], v[8:9], v[100:101], 0
    v_cmp_lt_u32 s[48:49], v5, v93
    s_nop 2
    v_pk_mul_f32 v[80:81], v[80:81], v[14:15] op_sel:[0,1] op_sel_hi:[1,1]
    v_pk_mul_f32 v[82:83], v[82:83], v[14:15] op_sel:[0,1] op_sel_hi:[1,1]
    v_pk_mul_f32 v[76:77], v[76:77], v[14:15] op_sel:[0,0] op_sel_hi:[1,0]
    v_pk_mul_f32 v[78:79], v[78:79], v[14:15] op_sel:[0,0] op_sel_hi:[1,0]
    s_add_u32 s40, s40, 0x50000
    v_and_b32 v47, 0x0fffffff, v41
    buffer_load_dwordx2 v[22:23], v47, s[8:11], 0 offen
    buffer_load_dwordx3 v[24:26], v47, s[8:11], 0 offen offset:8
    v_and_b32 v46, 0x80000000, v39
    v_lshrrev_b32 v47, 14, v37
    v_bitop3_b32 v47, v47, v5, v46 bitop3:0xea
    ds_read_b64 v[102:103], v47
    v_and_b32 v99, 0x40000000, v39
    v_lshrrev_b32 v47, 14, v36
    v_bitop3_b32 v47, v47, v5, v99 bitop3:0xea
    ds_read_b64 v[100:101], v47
    v_and_b32 v46, 0x20000000, v39
    v_lshrrev_b32 v47, 14, v35
    v_bitop3_b32 v47, v47, v5, v46 bitop3:0xea
    ds_read_b64 v[106:107], v47
    v_and_b32 v99, 0x10000000, v39
    v_lshrrev_b32 v47, 14, v34
    v_bitop3_b32 v47, v47, v5, v99 bitop3:0xea
    ds_read_b64 v[104:105], v47
    s_waitcnt lgkmcnt(4)
    v_cmp_ne_u64 s[50:51], v[72:73], v[68:69]
    v_cmpx_ne_u64 s[54:55], v[74:75], v[70:71]
    s_and_b64 s[82:83], s[54:55], s[80:81]
    s_cbranch_scc1 L2_c23
L2_d23:
    v_mov_b64 v[84:85], v[70:71]
    v_mov_b32 v7, v95
    v_mov_b64 v[86:87], v[74:75]
    s_or_b64 s[80:81], s[80:81], s[54:55]
    s_mov_b64 exec, s[50:51]
    s_and_b64 s[82:83], s[50:51], s[80:81]
    s_cbranch_scc1 L2_c24
L2_d24:
    v_mov_b64 v[84:85], v[68:69]
    v_mov_b32 v7, v94
    v_mov_b64 v[86:87], v[72:73]
    s_mov_b64 exec, -1
    s_or_b64 s[80:81], s[80:81], s[50:51]
    s_and_b64 exec, s[48:49], s[80:81]
    v_mfma_f32_4x4x4_16b_bf16 v[80:83], v[12:13], v[84:85], 0
    v_mov_b32 v93, v7
    s_andn2_b64 s[80:81], s[80:81], s[48:49]
    v_mfma_f32_4x4x4_16b_bf16 v[80:83], v[10:11], v[86:87], v[80:83]
    s_mov_b64 exec, -1
    ds_read_b64 v[70:71], v93 offset:65408
    ds_read_b64 v[68:69], v92 offset:65408
    v_bitop3_b32 v94, v34, v5, v99 bitop3:0xea
    v_bitop3_b32 v95, v35, v5, v46 bitop3:0xea
    v_perm_b32 v15, v35, v38, s45
    v_bitop3_b32 v46, v35, 0.5, -0.5 bitop3:0xa8
    v_perm_b32 v14, v34, v38, s44
    v_bitop3_b32 v47, v34, 0.5, -0.5 bitop3:0xa8
    v_bitop3_b32 v15, v6, v15, v46 bitop3:0xca
    v_bitop3_b32 v14, v6, v14, v47 bitop3:0xca
    s_waitcnt lgkmcnt(1)
    v_mfma_f32_4x4x4_16b_bf16 v[80:83], v[10:11], v[70:71], v[80:83]
    s_waitcnt lgkmcnt(0)
    v_mfma_f32_4x4x4_16b_bf16 v[76:79], v[10:11], v[68:69], v[76:79]
    s_nop 2
    v_cvt_pk_bf16_f32 v80, v80, v81
    v_cvt_pk_bf16_f32 v81, v82, v83
    ds_wrxchg_rtn_b64 v[74:75], v93, v[80:81] offset:65408
    v_cvt_pk_bf16_f32 v76, v76, v77
    v_cvt_pk_bf16_f32 v77, v78, v79
    ds_wrxchg_rtn_b64 v[72:73], v92, v[76:77] offset:65408
    s_barrier
    s_setprio 3
    s_waitcnt vmcnt(4)
    v_subrev_u32 v88, s38, v3
    ds_write_b128 v88, v[124:127] offset:34816
    s_add_u32 s3, s40, 4096
    buffer_load_dwordx4 v[124:127], v3, s[16:19], s3 offen sc1
    s_waitcnt vmcnt(5)
    v_subrev_u32 v88, s38, v3
    ds_write_b128 v88, v[116:119] offset:32768
    buffer_load_dwordx4 v[116:119], v3, s[16:19], s40 offen offset:2048 sc1
    s_waitcnt vmcnt(6)
    v_subrev_u32 v88, s38, v3
    ds_write_b128 v88, v[120:123] offset:33792
    buffer_load_dwordx4 v[120:123], v3, s[16:19], s40 offen offset:3072 sc1
    v_mfma_f32_4x4x4_16b_bf16 v[80:83], v[8:9], v[106:107], 0
    v_mfma_f32_4x4x4_16b_bf16 v[76:79], v[8:9], v[104:105], 0
    s_nop 3
    v_pk_mul_f32 v[80:81], v[80:81], v[14:15] op_sel:[0,1] op_sel_hi:[1,1]
    v_pk_mul_f32 v[82:83], v[82:83], v[14:15] op_sel:[0,1] op_sel_hi:[1,1]
    v_pk_mul_f32 v[76:77], v[76:77], v[14:15] op_sel:[0,0] op_sel_hi:[1,0]
    v_pk_mul_f32 v[78:79], v[78:79], v[14:15] op_sel:[0,0] op_sel_hi:[1,0]
    v_and_b32 v47, 0x0fffffff, v42
    buffer_load_dword v30, v47, s[8:11], 0 offen offset:16
    s_mov_b64 exec, s[6:7]
    v_add_u32 v47, 8, v47
    v_lshrrev_b32 v42, 2, v42
    s_mov_b64 exec, -1
    buffer_load_dwordx2 v[28:29], v47, s[8:11], 0 offen
    s_cmp_gt_u32 s37, 1024
    s_cbranch_scc1 L2_xs25
    s_cmp_lg_u32 s101, 0
    s_cbranch_scc1 L2_xa25
L2_xb25:
    v_lshlrev_b32 v89, 16, v96
    v_add_u32 v90, 60, v97
    v_bitop3_b32 v90, v89, v45, v90 bitop3:0x6a
    ds_write_b32 v98, v90 offset:12
    v_lshlrev_b32 v89, 20, v96
    v_add_u32 v90, 40, v97
    v_bitop3_b32 v90, v89, v45, v90 bitop3:0x6a
    ds_write_b32 v98, v90 offset:8
    v_lshlrev_b32 v89, 24, v96
    v_add_u32 v90, 20, v97
    v_bitop3_b32 v90, v89, v45, v90 bitop3:0x6a
    ds_write_b32 v98, v90 offset:4
    v_lshlrev_b32 v89, 28, v96
    v_bitop3_b32 v90, v89, v45, v97 bitop3:0x6a
    ds_write_b32 v98, v90 offset:0
    v_mov_b32_dpp v91, v64 quad_perm:[1,1,1,1] row_mask:0xf bank_mask:0xf
    v_and_b32 v89, 3, v91
    v_and_b32 v97, 0xfffc, v91
    v_sub_u16_dpp v88, v64, v91 quad_perm:[3,3,3,3] row_mask:0xf bank_mask:0xf
    v_mad_u32_u24 v97, v97, 5, v4
    v_add_u32 v99, v88, v89
    v_bfm_b32 v96, v88, v89
    v_cmp_lt_u32 s[58:59], 16, v99
    v_lshlrev_b32 v89, v1, v96
    v_and_b32 v89, v45, v89
    v_cmp_ne_u32 vcc, 0, v89
    v_xor_b32 v90, v97, v89
    s_add_u32 s3, s37, s38
    v_mbcnt_lo_u32_b32 v98, vcc_lo, 0
    v_mbcnt_hi_u32_b32 v98, vcc_hi, v98
    s_bcnt1_i32_b64 s41, vcc
    v_lshl_add_u32 v98, v98, 2, s3
    s_lshl2_add_u32 s37, s41, s37
    s_mov_b64 exec, vcc
    ds_write_b32 v98, v90
    s_mov_b64 exec, -1
    s_cmp_lg_u64 s[58:59], 0
    s_cbranch_scc1 L2_xe25
L2_xr25:
    v_add_u32 v98, s37, v0
    v_mov_b32 v90, -1
    ds_write_b32 v98, v90
L2_xw25:
    s_setprio 2
    s_waitcnt lgkmcnt(9)
    v_cmp_ne_u64 s[50:51], v[72:73], v[68:69]
    v_cmpx_ne_u64 s[54:55], v[74:75], v[70:71]
    s_and_b64 s[82:83], s[54:55], s[80:81]
    s_cbranch_scc1 L2_c26
L2_d26:
    v_mov_b64 v[84:85], v[70:71]
    v_mov_b32 v7, v93
    v_mov_b64 v[86:87], v[74:75]
    s_or_b64 s[80:81], s[80:81], s[54:55]
    s_mov_b64 exec, s[50:51]
    s_and_b64 s[82:83], s[50:51], s[80:81]
    s_cbranch_scc1 L2_c27
L2_d27:
    v_mov_b64 v[84:85], v[68:69]
    v_mov_b32 v7, v92
    v_mov_b64 v[86:87], v[72:73]
    s_mov_b64 exec, -1
    s_or_b64 s[80:81], s[80:81], s[50:51]
    ds_read_b64 v[70:71], v95 offset:65408
    ds_read_b64 v[68:69], v94 offset:65408
    v_and_b32 v46, 0x40000000, v39
    v_bitop3_b32 v92, v36, v5, v46 bitop3:0xea
    v_and_b32 v46, 0x80000000, v39
    v_bitop3_b32 v93, v37, v5, v46 bitop3:0xea
    v_perm_b32 v15, v37, v38, s47
    v_bitop3_b32 v46, v37, 0.5, -0.5 bitop3:0xa8
    v_perm_b32 v14, v36, v38, s46
    v_bitop3_b32 v47, v36, 0.5, -0.5 bitop3:0xa8
    v_bitop3_b32 v15, v6, v15, v46 bitop3:0xca
    v_bitop3_b32 v14, v6, v14, v47 bitop3:0xca
    s_setprio 1
    s_waitcnt lgkmcnt(1)
    v_mfma_f32_4x4x4_16b_bf16 v[80:83], v[10:11], v[70:71], v[80:83]
    s_waitcnt lgkmcnt(0)
    v_mfma_f32_4x4x4_16b_bf16 v[76:79], v[10:11], v[68:69], v[76:79]
    s_nop 2
    v_cvt_pk_bf16_f32 v80, v80, v81
    v_cvt_pk_bf16_f32 v81, v82, v83
    ds_wrxchg_rtn_b64 v[74:75], v95, v[80:81] offset:65408
    v_cvt_pk_bf16_f32 v76, v76, v77
    v_cvt_pk_bf16_f32 v77, v78, v79
    ds_wrxchg_rtn_b64 v[72:73], v94, v[76:77] offset:65408
    ds_read_b32 v21, v0 offset:0
    ds_read_b32 v27, v0 offset:256
    ds_read_b32 v31, v44 offset:768
    ds_read_b32 v39, v0 offset:512
    s_sub_u32 s3, s37, 768
    s_cmp_gt_u32 s3, 128
    s_cbranch_scc1 L2_xf25
L2_xg25:
    v_and_b32 v88, 0x0fffffff, v43
    buffer_load_dwordx2 v[34:35], v88, s[8:11], 0 offen
    buffer_load_dwordx3 v[36:38], v88, s[8:11], 0 offen offset:8
    s_setprio 0
    s_waitcnt vmcnt(11)
    v_subrev_u32 v88, s100, v3
    ds_write_b128 v88, v[108:111] offset:0
    s_waitcnt vmcnt(11)
    v_subrev_u32 v88, s100, v3
    ds_write_b128 v88, v[112:115] offset:1024
    v_mfma_f32_4x4x4_16b_bf16 v[80:83], v[8:9], v[102:103], 0
    v_mfma_f32_4x4x4_16b_bf16 v[76:79], v[8:9], v[100:101], 0
    v_cmp_lt_u32 s[84:85], v5, v92
    s_nop 2
    v_pk_mul_f32 v[80:81], v[80:81], v[14:15] op_sel:[0,1] op_sel_hi:[1,1]
    v_pk_mul_f32 v[82:83], v[82:83], v[14:15] op_sel:[0,1] op_sel_hi:[1,1]
    v_pk_mul_f32 v[76:77], v[76:77], v[14:15] op_sel:[0,0] op_sel_hi:[1,0]
    v_pk_mul_f32 v[78:79], v[78:79], v[14:15] op_sel:[0,0] op_sel_hi:[1,0]
    s_add_u32 s42, s42, 1
    s_waitcnt lgkmcnt(0)
    s_add_u32 s24, s30, 0xec54000
    s_addc_u32 s25, s31, 0
    s_mov_b32 s26, 0x100
    s_mov_b32 s27, 0x20000
    s_barrier
    s_bitcmp1_b32 s36, s42
    s_cbranch_scc1 L2_slow
L2_ret1:
    s_setprio 3
    s_bitcmp1_b32 s43, s42
    s_cbranch_scc1 L2_oa28
L2_ob28:
    s_waitcnt vmcnt(9)
    v_and_b32 v46, 0x20000000, v40
    v_lshrrev_b32 v47, 14, v17
    v_bitop3_b32 v47, v47, v5, v46 bitop3:0xea
    ds_read_b64 v[106:107], v47
    v_and_b32 v99, 0x10000000, v40
    v_lshrrev_b32 v47, 14, v16
    v_bitop3_b32 v47, v47, v5, v99 bitop3:0xea
    ds_read_b64 v[104:105], v47
    v_cmp_ne_u64 s[50:51], v[72:73], v[68:69]
    v_cmpx_ne_u64 s[54:55], v[74:75], v[70:71]
    s_and_b64 s[82:83], s[54:55], s[80:81]
    s_cbranch_scc1 L2_c29
L2_d29:
    v_mov_b64 v[84:85], v[70:71]
    v_mov_b32 v7, v95
    v_mov_b64 v[86:87], v[74:75]
    s_or_b64 s[80:81], s[80:81], s[54:55]
    s_mov_b64 exec, s[50:51]
    s_and_b64 s[82:83], s[50:51], s[80:81]
    s_cbranch_scc1 L2_c30
L2_d30:
    v_mov_b64 v[84:85], v[68:69]
    v_mov_b32 v7, v94
    v_mov_b64 v[86:87], v[72:73]
    s_mov_b64 exec, -1
    s_or_b64 s[80:81], s[80:81], s[50:51]
    s_and_b64 exec, s[84:85], s[80:81]
    v_mfma_f32_4x4x4_16b_bf16 v[76:79], v[12:13], v[84:85], 0
    v_mov_b32 v92, v7
    s_andn2_b64 s[80:81], s[80:81], s[84:85]
    v_mfma_f32_4x4x4_16b_bf16 v[76:79], v[10:11], v[86:87], v[76:79]
    s_mov_b64 exec, -1
    ds_read_b64 v[70:71], v93 offset:65408
    ds_read_b64 v[68:69], v92 offset:65408
    v_bitop3_b32 v94, v16, v5, v99 bitop3:0xea
    v_bitop3_b32 v95, v17, v5, v46 bitop3:0xea
    v_perm_b32 v15, v17, v20, s45
    v_bitop3_b32 v46, v17, 0.5, -0.5 bitop3:0xa8
    v_perm_b32 v14, v16, v20, s44
    v_bitop3_b32 v47, v16, 0.5, -0.5 bitop3:0xa8
    v_bitop3_b32 v15, v6, v15, v46 bitop3:0xca
    v_bitop3_b32 v14, v6, v14, v47 bitop3:0xca
    s_waitcnt lgkmcnt(1)
    v_mfma_f32_4x4x4_16b_bf16 v[80:83], v[10:11], v[70:71], v[80:83]
    s_waitcnt lgkmcnt(0)
    v_mfma_f32_4x4x4_16b_bf16 v[76:79], v[10:11], v[68:69], v[76:79]
    s_nop 2
    v_cvt_pk_bf16_f32 v80, v80, v81
    v_cvt_pk_bf16_f32 v81, v82, v83
    ds_wrxchg_rtn_b64 v[74:75], v93, v[80:81] offset:65408
    v_cvt_pk_bf16_f32 v76, v76, v77
    v_cvt_pk_bf16_f32 v77, v78, v79
    ds_wrxchg_rtn_b64 v[72:73], v92, v[76:77] offset:65408
    v_mfma_f32_4x4x4_16b_bf16 v[80:83], v[8:9], v[106:107], 0
    v_mfma_f32_4x4x4_16b_bf16 v[76:79], v[8:9], v[104:105], 0
    v_cmp_lt_u32 s[84:85], v5, v94
    s_nop 2
    v_pk_mul_f32 v[80:81], v[80:81], v[14:15] op_sel:[0,1] op_sel_hi:[1,1]
    v_pk_mul_f32 v[82:83], v[82:83], v[14:15] op_sel:[0,1] op_sel_hi:[1,1]
    v_pk_mul_f32 v[76:77], v[76:77], v[14:15] op_sel:[0,0] op_sel_hi:[1,0]
    v_pk_mul_f32 v[78:79], v[78:79], v[14:15] op_sel:[0,0] op_sel_hi:[1,0]
    buffer_load_dwordx4 v[108:111], v3, s[16:19], s40 offen offset:0 sc1
    v_and_b32 v46, 0x80000000, v40
    v_lshrrev_b32 v47, 14, v19
    v_bitop3_b32 v47, v47, v5, v46 bitop3:0xea
    ds_read_b64 v[102:103], v47
    v_and_b32 v99, 0x40000000, v40
    v_lshrrev_b32 v47, 14, v18
    v_bitop3_b32 v47, v47, v5, v99 bitop3:0xea
    ds_read_b64 v[100:101], v47
    s_waitcnt lgkmcnt(2)
    v_cmp_ne_u64 s[50:51], v[72:73], v[68:69]
    v_cmpx_ne_u64 s[54:55], v[74:75], v[70:71]
    s_and_b64 s[82:83], s[54:55], s[80:81]
    s_cbranch_scc1 L2_c31
L2_d31:
    v_mov_b64 v[84:85], v[70:71]
    v_mov_b32 v7, v93
    v_mov_b64 v[86:87], v[74:75]
    s_or_b64 s[80:81], s[80:81], s[54:55]
    s_mov_b64 exec, s[50:51]
    s_and_b64 s[82:83], s[50:51], s[80:81]
    s_cbranch_scc1 L2_c32
L2_d32:
    v_mov_b64 v[84:85], v[68:69]
    v_mov_b32 v7, v92
    v_mov_b64 v[86:87], v[72:73]
    s_mov_b64 exec, -1
    s_or_b64 s[80:81], s[80:81], s[50:51]
    s_and_b64 exec, s[84:85], s[80:81]
    v_mfma_f32_4x4x4_16b_bf16 v[76:79], v[12:13], v[84:85], 0
    v_mov_b32 v94, v7
    s_andn2_b64 s[80:81], s[80:81], s[84:85]
    v_mfma_f32_4x4x4_16b_bf16 v[76:79], v[10:11], v[86:87], v[76:79]
    s_mov_b64 exec, -1
    ds_read_b64 v[70:71], v95 offset:65408
    ds_read_b64 v[68:69], v94 offset:65408
    v_bitop3_b32 v92, v18, v5, v99 bitop3:0xea
    v_bitop3_b32 v93, v19, v5, v46 bitop3:0xea
    v_perm_b32 v15, v19, v20, s47
    v_bitop3_b32 v46, v19, 0.5, -0.5 bitop3:0xa8
    v_perm_b32 v14, v18, v20, s46
    v_bitop3_b32 v47, v18, 0.5, -0.5 bitop3:0xa8
    v_bitop3_b32 v15, v6, v15, v46 bitop3:0xca
    v_bitop3_b32 v14, v6, v14, v47 bitop3:0xca
    s_waitcnt lgkmcnt(1)
    v_mfma_f32_4x4x4_16b_bf16 v[80:83], v[10:11], v[70:71], v[80:83]
    s_waitcnt lgkmcnt(0)
    v_mfma_f32_4x4x4_16b_bf16 v[76:79], v[10:11], v[68:69], v[76:79]
    s_nop 2
    v_cvt_pk_bf16_f32 v80, v80, v81
    v_cvt_pk_bf16_f32 v81, v82, v83
    ds_wrxchg_rtn_b64 v[74:75], v95, v[80:81] offset:65408
    v_cvt_pk_bf16_f32 v76, v76, v77
    v_cvt_pk_bf16_f32 v77, v78, v79
    ds_wrxchg_rtn_b64 v[72:73], v94, v[76:77] offset:65408
    v_and_b32 v88, 0x0fffffff, v21
    buffer_load_dwordx2 v[16:17], v88, s[8:11], 0 offen
    buffer_load_dwordx3 v[18:20], v88, s[8:11], 0 offen offset:8
    s_setprio 2
    v_mfma_f32_4x4x4_16b_bf16 v[80:83], v[8:9], v[102:103], 0
    v_mfma_f32_4x4x4_16b_bf16 v[76:79], v[8:9], v[100:101], 0
    v_cmp_lt_u32 s[48:49], v5, v93
    s_nop 2
    v_pk_mul_f32 v[80:81], v[80:81], v[14:15] op_sel:[0,1] op_sel_hi:[1,1]
    v_pk_mul_f32 v[82:83], v[82:83], v[14:15] op_sel:[0,1] op_sel_hi:[1,1]
    v_pk_mul_f32 v[76:77], v[76:77], v[14:15] op_sel:[0,0] op_sel_hi:[1,0]
    v_pk_mul_f32 v[78:79], v[78:79], v[14:15] op_sel:[0,0] op_sel_hi:[1,0]
    s_waitcnt vmcnt(10)
    v_and_b32 v46, 0x20000000, v41
    v_lshrrev_b32 v47, 14, v23
    v_bitop3_b32 v47, v47, v5, v46 bitop3:0xea
    ds_read_b64 v[106:107], v47
    v_and_b32 v99, 0x10000000, v41
    v_lshrrev_b32 v47, 14, v22
    v_bitop3_b32 v47, v47, v5, v99 bitop3:0xea
    ds_read_b64 v[104:105], v47
    s_waitcnt lgkmcnt(2)
    v_cmp_ne_u64 s[50:51], v[72:73], v[68:69]
    v_cmpx_ne_u64 s[54:55], v[74:75], v[70:71]
    s_and_b64 s[82:83], s[54:55], s[80:81]
    s_cbranch_scc1 L2_c33
L2_d33:
    v_mov_b64 v[84:85], v[70:71]
    v_mov_b32 v7, v95
    v_mov_b64 v[86:87], v[74:75]
    s_or_b64 s[80:81], s[80:81], s[54:55]
    s_mov_b64 exec, s[50:51]
    s_and_b64 s[82:83], s[50:51], s[80:81]
    s_cbranch_scc1 L2_c34
L2_d34:
    v_mov_b64 v[84:85], v[68:69]
    v_mov_b32 v7, v94
    v_mov_b64 v[86:87], v[72:73]
    s_mov_b64 exec, -1
    s_or_b64 s[80:81], s[80:81], s[50:51]
    s_and_b64 exec, s[48:49], s[80:81]
    v_mfma_f32_4x4x4_16b_bf16 v[80:83], v[12:13], v[84:85], 0
    v_mov_b32 v93, v7
    s_andn2_b64 s[80:81], s[80:81], s[48:49]
    v_mfma_f32_4x4x4_16b_bf16 v[80:83], v[10:11], v[86:87], v[80:83]
    s_mov_b64 exec, -1
    ds_read_b64 v[70:71], v93 offset:65408
    ds_read_b64 v[68:69], v92 offset:65408
    v_bitop3_b32 v94, v22, v5, v99 bitop3:0xea
    v_bitop3_b32 v95, v23, v5, v46 bitop3:0xea
    v_perm_b32 v15, v23, v26, s45
    v_bitop3_b32 v46, v23, 0.5, -0.5 bitop3:0xa8
    v_perm_b32 v14, v22, v26, s44
    v_bitop3_b32 v47, v22, 0.5, -0.5 bitop3:0xa8
    v_bitop3_b32 v15, v6, v15, v46 bitop3:0xca
    v_bitop3_b32 v14, v6, v14, v47 bitop3:0xca
    s_waitcnt lgkmcnt(1)
    v_mfma_f32_4x4x4_16b_bf16 v[80:83], v[10:11], v[70:71], v[80:83]
    s_waitcnt lgkmcnt(0)
    v_mfma_f32_4x4x4_16b_bf16 v[76:79], v[10:11], v[68:69], v[76:79]
    s_nop 2
    v_cvt_pk_bf16_f32 v80, v80, v81
    v_cvt_pk_bf16_f32 v81, v82, v83
    ds_wrxchg_rtn_b64 v[74:75], v93, v[80:81] offset:65408
    v_cvt_pk_bf16_f32 v76, v76, v77
    v_cvt_pk_bf16_f32 v77, v78, v79
    ds_wrxchg_rtn_b64 v[72:73], v92, v[76:77] offset:65408
    s_setprio 1
    v_mfma_f32_4x4x4_16b_bf16 v[80:83], v[8:9], v[106:107], 0
    v_mfma_f32_4x4x4_16b_bf16 v[76:79], v[8:9], v[104:105], 0
    s_nop 3
    v_pk_mul_f32 v[80:81], v[80:81], v[14:15] op_sel:[0,1] op_sel_hi:[1,1]
    v_pk_mul_f32 v[82:83], v[82:83], v[14:15] op_sel:[0,1] op_sel_hi:[1,1]
    v_pk_mul_f32 v[76:77], v[76:77], v[14:15] op_sel:[0,0] op_sel_hi:[1,0]
    v_pk_mul_f32 v[78:79], v[78:79], v[14:15] op_sel:[0,0] op_sel_hi:[1,0]
    s_bitcmp1_b32 s43, s42
    s_cbranch_scc1 L2_oa35
L2_ob35:
    buffer_load_dwordx4 v[112:115], v3, s[16:19], s40 offen offset:1024 sc1
    v_sub_u16 v88, v62, v54
    v_and_b32 v89, 3, v54
    v_add3_u32 v99, v88, v89, 3
    v_and_b32 v99, -4, v99
    v_max_u32 v99, 4, v99
    v_and_b32 v97, 0xfffc, v54
    v_bfm_b32 v96, v88, v89
    v_add_u32_dpp v91, v99, v99 row_shr:1 row_mask:0xf bank_mask:0xf bound_ctrl:1
    v_mad_u32_u24 v97, v97, 5, v2
    v_cmp_lt_u32 vcc, 16, v99
    v_add_u32_dpp v91, v91, v91 row_shr:2 row_mask:0xf bank_mask:0xf bound_ctrl:1
    v_sub_u32 v98, s38, v99
    v_lshrrev_b64 v[54:55], 16, v[54:55]
    v_add_u32_dpp v91, v91, v91 row_shr:4 row_mask:0xf bank_mask:0xf bound_ctrl:1
    v_lshrrev_b64 v[62:63], 16, v[62:63]
    s_mov_b32 s101, 0
    v_add_u32_dpp v91, v91, v91 row_shr:8 row_mask:0xf bank_mask:0xf bound_ctrl:1
    s_nop 1
    v_add_u32_dpp v91, v91, v91 row_bcast:15 row_mask:0xa bank_mask:0xf
    s_nop 1
    v_add_u32_dpp v91, v91, v91 row_bcast:31 row_mask:0xc bank_mask:0xf
    v_add_u32 v98, v98, v91
    v_readlane_b32 s37, v91, 63
    s_cbranch_vccnz L2_xo36
L2_xp36:
    v_and_b32 v46, 0x80000000, v41
    v_lshrrev_b32 v47, 14, v25
    v_bitop3_b32 v47, v47, v5, v46 bitop3:0xea
    ds_read_b64 v[102:103], v47
    v_and_b32 v99, 0x40000000, v41
    v_lshrrev_b32 v47, 14, v24
    v_bitop3_b32 v47, v47, v5, v99 bitop3:0xea
    ds_read_b64 v[100:101], v47
    s_waitcnt lgkmcnt(2)
    v_cmp_ne_u64 s[50:51], v[72:73], v[68:69]
    v_cmpx_ne_u64 s[54:55], v[74:75], v[70:71]
    s_and_b64 s[82:83], s[54:55], s[80:81]
    s_cbranch_scc1 L2_c37
L2_d37:
    v_mov_b64 v[84:85], v[70:71]
    v_mov_b32 v7, v93
    v_mov_b64 v[86:87], v[74:75]
    s_or_b64 s[80:81], s[80:81], s[54:55]
    s_mov_b64 exec, s[50:51]
    s_and_b64 s[82:83], s[50:51], s[80:81]
    s_cbranch_scc1 L2_c38
L2_d38:
    v_mov_b64 v[84:85], v[68:69]
    v_mov_b32 v7, v92
    v_mov_b64 v[86:87], v[72:73]
    s_mov_b64 exec, -1
    s_or_b64 s[80:81], s[80:81], s[50:51]
    ds_read_b64 v[70:71], v95 offset:65408
    ds_read_b64 v[68:69], v94 offset:65408
    v_bitop3_b32 v92, v24, v5, v99 bitop3:0xea
    v_bitop3_b32 v93, v25, v5, v46 bitop3:0xea
    v_perm_b32 v15, v25, v26, s47
    v_bitop3_b32 v46, v25, 0.5, -0.5 bitop3:0xa8
    v_perm_b32 v14, v24, v26, s46
    v_bitop3_b32 v47, v24, 0.5, -0.5 bitop3:0xa8
    v_bitop3_b32 v15, v6, v15, v46 bitop3:0xca
    v_bitop3_b32 v14, v6, v14, v47 bitop3:0xca
    s_waitcnt lgkmcnt(1)
    v_mfma_f32_4x4x4_16b_bf16 v[80:83], v[10:11], v[70:71], v[80:83]
    s_waitcnt lgkmcnt(0)
    v_mfma_f32_4x4x4_16b_bf16 v[76:79], v[10:11], v[68:69], v[76:79]
    s_nop 2
    v_cvt_pk_bf16_f32 v80, v80, v81
    v_cvt_pk_bf16_f32 v81, v82, v83
    ds_wrxchg_rtn_b64 v[74:75], v95, v[80:81] offset:65408
    v_cvt_pk_bf16_f32 v76, v76, v77
    v_cvt_pk_bf16_f32 v77, v78, v79
    ds_wrxchg_rtn_b64 v[72:73], v94, v[76:77] offset:65408
    v_and_b32 v88, 0x0fffffff, v27
    buffer_load_dwordx2 v[22:23], v88, s[8:11], 0 offen
    buffer_load_dwordx3 v[24:26], v88, s[8:11], 0 offen offset:8
    v_mfma_f32_4x4x4_16b_bf16 v[80:83], v[8:9], v[102:103], 0
    v_mfma_f32_4x4x4_16b_bf16 v[76:79], v[8:9], v[100:101], 0
    v_cmp_lt_u32 s[84:85], v5, v92
    s_nop 2
    v_pk_mul_f32 v[80:81], v[80:81], v[14:15] op_sel:[0,1] op_sel_hi:[1,1]
    v_pk_mul_f32 v[82:83], v[82:83], v[14:15] op_sel:[0,1] op_sel_hi:[1,1]
    v_pk_mul_f32 v[76:77], v[76:77], v[14:15] op_sel:[0,0] op_sel_hi:[1,0]
    v_pk_mul_f32 v[78:79], v[78:79], v[14:15] op_sel:[0,0] op_sel_hi:[1,0]
    s_waitcnt vmcnt(8)
    s_mov_b64 exec, s[6:7]
    v_lshrrev_b32 v30, 16, v30
    s_mov_b64 exec, -1
    v_and_b32 v46, 0x20000000, v42
    v_lshrrev_b32 v47, 14, v29
    v_bitop3_b32 v47, v47, v5, v46 bitop3:0xea
    ds_read_b64 v[106:107], v47
    v_and_b32 v99, 0x10000000, v42
    v_lshrrev_b32 v47, 14, v28
    v_bitop3_b32 v47, v47, v5, v99 bitop3:0xea
    ds_read_b64 v[104:105], v47
    s_waitcnt lgkmcnt(2)
    v_cmp_ne_u64 s[50:51], v[72:73], v[68:69]
    v_cmpx_ne_u64 s[54:55], v[74:75], v[70:71]
    s_and_b64 s[82:83], s[54:55], s[80:81]
    s_cbranch_scc1 L2_c39
L2_d39:
    v_mov_b64 v[84:85], v[70:71]
    v_mov_b32 v7, v95
    v_mov_b64 v[86:87], v[74:75]
    s_or_b64 s[80:81], s[80:81], s[54:55]
    s_mov_b64 exec, s[50:51]
    s_and_b64 s[82:83], s[50:51], s[80:81]
    s_cbranch_scc1 L2_c40
L2_d40:
    v_mov_b64 v[84:85], v[68:69]
    v_mov_b32 v7, v94
    v_mov_b64 v[86:87], v[72:73]
    s_mov_b64 exec, -1
    s_or_b64 s[80:81], s[80:81], s[50:51]
    s_and_b64 exec, s[84:85], s[80:81]
    v_mfma_f32_4x4x4_16b_bf16 v[76:79], v[12:13], v[84:85], 0
    v_mov_b32 v92, v7
    s_andn2_b64 s[80:81], s[80:81], s[84:85]
    v_mfma_f32_4x4x4_16b_bf16 v[76:79], v[10:11], v[86:87], v[76:79]
    s_mov_b64 exec, -1
    ds_read_b64 v[70:71], v93 offset:65408
    ds_read_b64 v[68:69], v92 offset:65408
    v_bitop3_b32 v94, v28, v5, v99 bitop3:0xea
    v_bitop3_b32 v95, v29, v5, v46 bitop3:0xea
    v_perm_b32 v15, v29, v30, s45
    v_bitop3_b32 v46, v29, 0.5, -0.5 bitop3:0xa8
    v_perm_b32 v14, v28, v30, s44
    v_bitop3_b32 v47, v28, 0.5, -0.5 bitop3:0xa8
    v_bitop3_b32 v15, v6, v15, v46 bitop3:0xca
    v_bitop3_b32 v14, v6, v14, v47 bitop3:0xca
    s_waitcnt lgkmcnt(1)
    v_mfma_f32_4x4x4_16b_bf16 v[80:83], v[10:11], v[70:71], v[80:83]
    s_waitcnt lgkmcnt(0)
    v_mfma_f32_4x4x4_16b_bf16 v[76:79], v[10:11], v[68:69], v[76:79]
    s_nop 2
    v_cvt_pk_bf16_f32 v80, v80, v81
    v_cvt_pk_bf16_f32 v81, v82, v83
    ds_wrxchg_rtn_b64 v[74:75], v93, v[80:81] offset:65408
    v_cvt_pk_bf16_f32 v76, v76, v77
    v_cvt_pk_bf16_f32 v77, v78, v79
    ds_wrxchg_rtn_b64 v[72:73], v92, v[76:77] offset:65408
    s_setprio 0
    v_mfma_f32_4x4x4_16b_bf16 v[80:83], v[8:9], v[106:107], 0
    v_mfma_f32_4x4x4_16b_bf16 v[76:79], v[8:9], v[104:105], 0
    v_cmp_lt_u32 s[48:49], v5, v95
    s_nop 2
    v_pk_mul_f32 v[80:81], v[80:81], v[14:15] op_sel:[0,1] op_sel_hi:[1,1]
    v_pk_mul_f32 v[82:83], v[82:83], v[14:15] op_sel:[0,1] op_sel_hi:[1,1]
    v_pk_mul_f32 v[76:77], v[76:77], v[14:15] op_sel:[0,0] op_sel_hi:[1,0]
    v_pk_mul_f32 v[78:79], v[78:79], v[14:15] op_sel:[0,0] op_sel_hi:[1,0]
    s_add_u32 s40, s40, 0x50000
    v_and_b32 v47, 0x0fffffff, v31
    buffer_load_dword v30, v47, s[8:11], 0 offen offset:16
    s_mov_b64 exec, s[6:7]
    v_add_u32 v47, 8, v47
    v_lshrrev_b32 v31, 2, v31
    s_mov_b64 exec, -1
    buffer_load_dwordx2 v[28:29], v47, s[8:11], 0 offen
    s_waitcnt vmcnt(8)
    v_and_b32 v46, 0x80000000, v43
    v_lshrrev_b32 v47, 14, v37
    v_bitop3_b32 v47, v47, v5, v46 bitop3:0xea
    ds_read_b64 v[106:107], v47
    v_and_b32 v99, 0x40000000, v43
    v_lshrrev_b32 v47, 14, v36
    v_bitop3_b32 v47, v47, v5, v99 bitop3:0xea
    ds_read_b64 v[104:105], v47
    v_and_b32 v46, 0x20000000, v43
    v_lshrrev_b32 v47, 14, v35
    v_bitop3_b32 v47, v47, v5, v46 bitop3:0xea
    ds_read_b64 v[102:103], v47
    v_and_b32 v99, 0x10000000, v43
    v_lshrrev_b32 v47, 14, v34
    v_bitop3_b32 v47, v47, v5, v99 bitop3:0xea
    ds_read_b64 v[100:101], v47
    s_waitcnt lgkmcnt(4)
    v_cmp_ne_u64 s[50:51], v[72:73], v[68:69]
    v_cmpx_ne_u64 s[54:55], v[74:75], v[70:71]
    s_and_b64 s[82:83], s[54:55], s[80:81]
    s_cbranch_scc1 L2_c41
L2_d41:
    v_mov_b64 v[84:85], v[70:71]
    v_mov_b32 v7, v93
    v_mov_b64 v[86:87], v[74:75]
    s_or_b64 s[80:81], s[80:81], s[54:55]
    s_mov_b64 exec, s[50:51]
    s_and_b64 s[82:83], s[50:51], s[80:81]
    s_cbranch_scc1 L2_c42
L2_d42:
    v_mov_b64 v[84:85], v[68:69]
    v_mov_b32 v7, v92
    v_mov_b64 v[86:87], v[72:73]
    s_mov_b64 exec, -1
    s_or_b64 s[80:81], s[80:81], s[50:51]
    s_and_b64 exec, s[48:49], s[80:81]
    v_mfma_f32_4x4x4_16b_bf16 v[80:83], v[12:13], v[84:85], 0
    v_mov_b32 v95, v7
    s_andn2_b64 s[80:81], s[80:81], s[48:49]
    v_mfma_f32_4x4x4_16b_bf16 v[80:83], v[10:11], v[86:87], v[80:83]
    s_mov_b64 exec, -1
    ds_read_b64 v[70:71], v95 offset:65408
    ds_read_b64 v[68:69], v94 offset:65408
    v_bitop3_b32 v92, v34, v5, v99 bitop3:0xea
    v_bitop3_b32 v93, v35, v5, v46 bitop3:0xea
    v_perm_b32 v15, v35, v38, s45
    v_bitop3_b32 v46, v35, 0.5, -0.5 bitop3:0xa8
    v_perm_b32 v14, v34, v38, s44
    v_bitop3_b32 v47, v34, 0.5, -0.5 bitop3:0xa8
    v_bitop3_b32 v15, v6, v15, v46 bitop3:0xca
    v_bitop3_b32 v14, v6, v14, v47 bitop3:0xca
    s_waitcnt lgkmcnt(1)
    v_mfma_f32_4x4x4_16b_bf16 v[80:83], v[10:11], v[70:71], v[80:83]
    s_waitcnt lgkmcnt(0)
    v_mfma_f32_4x4x4_16b_bf16 v[76:79], v[10:11], v[68:69], v[76:79]
    s_nop 2
    v_cvt_pk_bf16_f32 v80, v80, v81
    v_cvt_pk_bf16_f32 v81, v82, v83
    ds_wrxchg_rtn_b64 v[74:75], v95, v[80:81] offset:65408
    v_cvt_pk_bf16_f32 v76, v76, v77
    v_cvt_pk_bf16_f32 v77, v78, v79
    ds_wrxchg_rtn_b64 v[72:73], v94, v[76:77] offset:65408
    s_barrier
    s_setprio 3
    s_mov_b32 m0, s100
    s_nop 0
    ds_write_addtid_b32 v124 offset:34816
    ds_write_addtid_b32 v125 offset:35072
    ds_write_addtid_b32 v126 offset:35328
    ds_write_addtid_b32 v127 offset:35584
    s_add_u32 s3, s40, 4096
    buffer_load_dwordx4 v[124:127], v3, s[16:19], s3 offen sc1
    ds_write_addtid_b32 v116 offset:32768
    ds_write_addtid_b32 v117 offset:33024
    ds_write_addtid_b32 v118 offset:33280
    ds_write_addtid_b32 v119 offset:33536
    buffer_load_dwordx4 v[116:119], v3, s[16:19], s40 offen offset:2048 sc1
    ds_write_addtid_b32 v120 offset:33792
    ds_write_addtid_b32 v121 offset:34048
    ds_write_addtid_b32 v122 offset:34304
    ds_write_addtid_b32 v123 offset:34560
    buffer_load_dwordx4 v[120:123], v3, s[16:19], s40 offen offset:3072 sc1
    v_mfma_f32_4x4x4_16b_bf16 v[80:83], v[8:9], v[102:103], 0
    v_mfma_f32_4x4x4_16b_bf16 v[76:79], v[8:9], v[100:101], 0
    s_nop 3
    v_pk_mul_f32 v[80:81], v[80:81], v[14:15] op_sel:[0,1] op_sel_hi:[1,1]
    v_pk_mul_f32 v[82:83], v[82:83], v[14:15] op_sel:[0,1] op_sel_hi:[1,1]
    v_pk_mul_f32 v[76:77], v[76:77], v[14:15] op_sel:[0,0] op_sel_hi:[1,0]
    v_pk_mul_f32 v[78:79], v[78:79], v[14:15] op_sel:[0,0] op_sel_hi:[1,0]
    s_cmp_gt_u32 s37, 1024
    s_cbranch_scc1 L2_xs43
    s_cmp_lg_u32 s101, 0
    s_cbranch_scc1 L2_xa43
L2_xb43:
    v_lshlrev_b32 v89, 16, v96
    v_add_u32 v90, 60, v97
    v_bitop3_b32 v90, v89, v45, v90 bitop3:0x6a
    ds_write_b32 v98, v90 offset:12
    v_lshlrev_b32 v89, 20, v96
    v_add_u32 v90, 40, v97
    v_bitop3_b32 v90, v89, v45, v90 bitop3:0x6a
    ds_write_b32 v98, v90 offset:8
    v_lshlrev_b32 v89, 24, v96
    v_add_u32 v90, 20, v97
    v_bitop3_b32 v90, v89, v45, v90 bitop3:0x6a
    ds_write_b32 v98, v90 offset:4
    v_lshlrev_b32 v89, 28, v96
    v_bitop3_b32 v90, v89, v45, v97 bitop3:0x6a
    ds_write_b32 v98, v90 offset:0
    v_mov_b32_dpp v91, v66 quad_perm:[1,1,1,1] row_mask:0xf bank_mask:0xf
    v_and_b32 v89, 3, v91
    v_and_b32 v97, 0xfffc, v91
    v_sub_u16_dpp v88, v66, v91 quad_perm:[3,3,3,3] row_mask:0xf bank_mask:0xf
    v_mad_u32_u24 v97, v97, 5, v4
    v_add_u32 v99, v88, v89
    v_bfm_b32 v96, v88, v89
    v_cmp_lt_u32 s[58:59], 16, v99
    v_lshlrev_b32 v89, v1, v96
    v_and_b32 v89, v45, v89
    v_cmp_ne_u32 vcc, 0, v89
    v_xor_b32 v90, v97, v89
    s_add_u32 s3, s37, s38
    v_mbcnt_lo_u32_b32 v98, vcc_lo, 0
    v_mbcnt_hi_u32_b32 v98, vcc_hi, v98
    s_bcnt1_i32_b64 s41, vcc
    v_lshl_add_u32 v98, v98, 2, s3
    s_lshl2_add_u32 s37, s41, s37
    s_mov_b64 exec, vcc
    ds_write_b32 v98, v90
    s_mov_b64 exec, -1
    s_cmp_lg_u64 s[58:59], 0
    s_cbranch_scc1 L2_xe43
L2_xr43:
    v_add_u32 v98, s37, v0
    v_mov_b32 v90, -1
    ds_write_b32 v98, v90
L2_xw43:
    s_setprio 2
    s_waitcnt lgkmcnt(14)
    v_cmp_ne_u64 s[50:51], v[72:73], v[68:69]
    v_cmpx_ne_u64 s[54:55], v[74:75], v[70:71]
    s_and_b64 s[82:83], s[54:55], s[80:81]
    s_cbranch_scc1 L2_c44
L2_d44:
    v_mov_b64 v[84:85], v[70:71]
    v_mov_b32 v7, v95
    v_mov_b64 v[86:87], v[74:75]
    s_or_b64 s[80:81], s[80:81], s[54:55]
    s_mov_b64 exec, s[50:51]
    s_and_b64 s[82:83], s[50:51], s[80:81]
    s_cbranch_scc1 L2_c45
L2_d45:
    v_mov_b64 v[84:85], v[68:69]
    v_mov_b32 v7, v94
    v_mov_b64 v[86:87], v[72:73]
    s_mov_b64 exec, -1
    s_or_b64 s[80:81], s[80:81], s[50:51]
    ds_read_b64 v[70:71], v93 offset:65408
    ds_read_b64 v[68:69], v92 offset:65408
    v_and_b32 v46, 0x40000000, v43
    v_bitop3_b32 v94, v36, v5, v46 bitop3:0xea
    v_and_b32 v46, 0x80000000, v43
    v_bitop3_b32 v95, v37, v5, v46 bitop3:0xea
    v_perm_b32 v15, v37, v38, s47
    v_bitop3_b32 v46, v37, 0.5, -0.5 bitop3:0xa8
    v_perm_b32 v14, v36, v38, s46
    v_bitop3_b32 v47, v36, 0.5, -0.5 bitop3:0xa8
    v_bitop3_b32 v15, v6, v15, v46 bitop3:0xca
    v_bitop3_b32 v14, v6, v14, v47 bitop3:0xca
    s_setprio 1
    s_waitcnt lgkmcnt(1)
    v_mfma_f32_4x4x4_16b_bf16 v[80:83], v[10:11], v[70:71], v[80:83]
    s_waitcnt lgkmcnt(0)
    v_mfma_f32_4x4x4_16b_bf16 v[76:79], v[10:11], v[68:69], v[76:79]
    s_nop 2
    v_cvt_pk_bf16_f32 v80, v80, v81
    v_cvt_pk_bf16_f32 v81, v82, v83
    ds_wrxchg_rtn_b64 v[74:75], v93, v[80:81] offset:65408
    v_cvt_pk_bf16_f32 v76, v76, v77
    v_cvt_pk_bf16_f32 v77, v78, v79
    ds_wrxchg_rtn_b64 v[72:73], v92, v[76:77] offset:65408
    ds_read_b32 v40, v0 offset:0
    ds_read_b32 v41, v0 offset:256
    ds_read_b32 v42, v44 offset:768
    ds_read_b32 v43, v0 offset:512
    s_sub_u32 s3, s37, 768
    s_cmp_gt_u32 s3, 128
    s_cbranch_scc1 L2_xf43
L2_xg43:
    v_lshrrev_b64 v[64:65], 16, v[64:65]
    v_lshrrev_b64 v[66:67], 16, v[66:67]
    v_and_b32 v88, 0x0fffffff, v39
    buffer_load_dwordx2 v[34:35], v88, s[8:11], 0 offen
    buffer_load_dwordx3 v[36:38], v88, s[8:11], 0 offen offset:8
    s_setprio 0
    s_waitcnt vmcnt(12)
    s_mov_b32 m0, s38
    s_nop 0
    ds_write_addtid_b32 v108 offset:0
    ds_write_addtid_b32 v109 offset:256
    ds_write_addtid_b32 v110 offset:512
    ds_write_addtid_b32 v111 offset:768
    s_waitcnt vmcnt(9)
    ds_write_addtid_b32 v112 offset:1024
    ds_write_addtid_b32 v113 offset:1280
    ds_write_addtid_b32 v114 offset:1536
    ds_write_addtid_b32 v115 offset:1792
    v_mfma_f32_4x4x4_16b_bf16 v[80:83], v[8:9], v[106:107], 0
    v_mfma_f32_4x4x4_16b_bf16 v[76:79], v[8:9], v[104:105], 0
    v_cmp_lt_u32 s[84:85], v5, v94
    s_nop 2
    v_pk_mul_f32 v[80:81], v[80:81], v[14:15] op_sel:[0,1] op_sel_hi:[1,1]
    v_pk_mul_f32 v[82:83], v[82:83], v[14:15] op_sel:[0,1] op_sel_hi:[1,1]
    v_pk_mul_f32 v[76:77], v[76:77], v[14:15] op_sel:[0,0] op_sel_hi:[1,0]
    v_pk_mul_f32 v[78:79], v[78:79], v[14:15] op_sel:[0,0] op_sel_hi:[1,0]
    s_add_u32 s42, s42, 1
    s_waitcnt lgkmcnt(0)
L2_loop:
    s_barrier
    s_bitcmp1_b32 s36, s42
    s_cbranch_scc1 L2_slow
L2_ret2:
    s_setprio 3
    s_bitcmp1_b32 s43, s42
    s_cbranch_scc1 L2_oa46
L2_ob46:
    v_and_b32 v46, 0x20000000, v21
    v_lshrrev_b32 v47, 14, v17
    v_bitop3_b32 v47, v47, v5, v46 bitop3:0xea
    ds_read_b64 v[102:103], v47
    v_and_b32 v99, 0x10000000, v21
    v_lshrrev_b32 v47, 14, v16
    v_bitop3_b32 v47, v47, v5, v99 bitop3:0xea
    ds_read_b64 v[100:101], v47
    v_cmp_ne_u64 s[50:51], v[72:73], v[68:69]
    v_cmpx_ne_u64 s[54:55], v[74:75], v[70:71]
    s_and_b64 s[82:83], s[54:55], s[80:81]
    s_cbranch_scc1 L2_c47
L2_d47:
    v_mov_b64 v[84:85], v[70:71]
    v_mov_b32 v7, v93
    v_mov_b64 v[86:87], v[74:75]
    s_or_b64 s[80:81], s[80:81], s[54:55]
    s_mov_b64 exec, s[50:51]
    s_and_b64 s[82:83], s[50:51], s[80:81]
    s_cbranch_scc1 L2_c48
L2_d48:
    v_mov_b64 v[84:85], v[68:69]
    v_mov_b32 v7, v92
    v_mov_b64 v[86:87], v[72:73]
    s_mov_b64 exec, -1
    s_or_b64 s[80:81], s[80:81], s[50:51]
    s_and_b64 exec, s[84:85], s[80:81]
    v_mfma_f32_4x4x4_16b_bf16 v[76:79], v[12:13], v[84:85], 0
    v_mov_b32 v94, v7
    s_andn2_b64 s[80:81], s[80:81], s[84:85]
    v_mfma_f32_4x4x4_16b_bf16 v[76:79], v[10:11], v[86:87], v[76:79]
    s_mov_b64 exec, -1
    ds_read_b64 v[70:71], v95 offset:65408
    ds_read_b64 v[68:69], v94 offset:65408
    v_bitop3_b32 v92, v16, v5, v99 bitop3:0xea
    v_bitop3_b32 v93, v17, v5, v46 bitop3:0xea
    v_perm_b32 v15, v17, v20, s45
    v_bitop3_b32 v46, v17, 0.5, -0.5 bitop3:0xa8
    v_perm_b32 v14, v16, v20, s44
    v_bitop3_b32 v47, v16, 0.5, -0.5 bitop3:0xa8
    v_bitop3_b32 v15, v6, v15, v46 bitop3:0xca
    v_bitop3_b32 v14, v6, v14, v47 bitop3:0xca
    s_waitcnt lgkmcnt(1)
    v_mfma_f32_4x4x4_16b_bf16 v[80:83], v[10:11], v[70:71], v[80:83]
    s_waitcnt lgkmcnt(0)
    v_mfma_f32_4x4x4_16b_bf16 v[76:79], v[10:11], v[68:69], v[76:79]
    s_nop 2
    v_cvt_pk_bf16_f32 v80, v80, v81
    v_cvt_pk_bf16_f32 v81, v82, v83
    ds_wrxchg_rtn_b64 v[74:75], v95, v[80:81] offset:65408
    v_cvt_pk_bf16_f32 v76, v76, v77
    v_cvt_pk_bf16_f32 v77, v78, v79
    ds_wrxchg_rtn_b64 v[72:73], v94, v[76:77] offset:65408
    v_mfma_f32_4x4x4_16b_bf16 v[80:83], v[8:9], v[102:103], 0
    v_mfma_f32_4x4x4_16b_bf16 v[76:79], v[8:9], v[100:101], 0
    v_cmp_lt_u32 s[84:85], v5, v92
    s_nop 2
    v_pk_mul_f32 v[80:81], v[80:81], v[14:15] op_sel:[0,1] op_sel_hi:[1,1]
    v_pk_mul_f32 v[82:83], v[82:83], v[14:15] op_sel:[0,1] op_sel_hi:[1,1]
    v_pk_mul_f32 v[76:77], v[76:77], v[14:15] op_sel:[0,0] op_sel_hi:[1,0]
    v_pk_mul_f32 v[78:79], v[78:79], v[14:15] op_sel:[0,0] op_sel_hi:[1,0]
    buffer_load_dwordx4 v[108:111], v3, s[16:19], s40 offen offset:0 sc1
    v_and_b32 v46, 0x80000000, v21
    v_lshrrev_b32 v47, 14, v19
    v_bitop3_b32 v47, v47, v5, v46 bitop3:0xea
    ds_read_b64 v[106:107], v47
    v_and_b32 v99, 0x40000000, v21
    v_lshrrev_b32 v47, 14, v18
    v_bitop3_b32 v47, v47, v5, v99 bitop3:0xea
    ds_read_b64 v[104:105], v47
    s_waitcnt lgkmcnt(2)
    v_cmp_ne_u64 s[50:51], v[72:73], v[68:69]
    v_cmpx_ne_u64 s[54:55], v[74:75], v[70:71]
    s_and_b64 s[82:83], s[54:55], s[80:81]
    s_cbranch_scc1 L2_c49
L2_d49:
    v_mov_b64 v[84:85], v[70:71]
    v_mov_b32 v7, v95
    v_mov_b64 v[86:87], v[74:75]
    s_or_b64 s[80:81], s[80:81], s[54:55]
    s_mov_b64 exec, s[50:51]
    s_and_b64 s[82:83], s[50:51], s[80:81]
    s_cbranch_scc1 L2_c50
L2_d50:
    v_mov_b64 v[84:85], v[68:69]
    v_mov_b32 v7, v94
    v_mov_b64 v[86:87], v[72:73]
    s_mov_b64 exec, -1
    s_or_b64 s[80:81], s[80:81], s[50:51]
    s_and_b64 exec, s[84:85], s[80:81]
    v_mfma_f32_4x4x4_16b_bf16 v[76:79], v[12:13], v[84:85], 0
    v_mov_b32 v92, v7
    s_andn2_b64 s[80:81], s[80:81], s[84:85]
    v_mfma_f32_4x4x4_16b_bf16 v[76:79], v[10:11], v[86:87], v[76:79]
    s_mov_b64 exec, -1
    ds_read_b64 v[70:71], v93 offset:65408
    ds_read_b64 v[68:69], v92 offset:65408
    v_bitop3_b32 v94, v18, v5, v99 bitop3:0xea
    v_bitop3_b32 v95, v19, v5, v46 bitop3:0xea
    v_perm_b32 v15, v19, v20, s47
    v_bitop3_b32 v46, v19, 0.5, -0.5 bitop3:0xa8
    v_perm_b32 v14, v18, v20, s46
    v_bitop3_b32 v47, v18, 0.5, -0.5 bitop3:0xa8
    v_bitop3_b32 v15, v6, v15, v46 bitop3:0xca
    v_bitop3_b32 v14, v6, v14, v47 bitop3:0xca
    s_waitcnt lgkmcnt(1)
    v_mfma_f32_4x4x4_16b_bf16 v[80:83], v[10:11], v[70:71], v[80:83]
    s_waitcnt lgkmcnt(0)
    v_mfma_f32_4x4x4_16b_bf16 v[76:79], v[10:11], v[68:69], v[76:79]
    s_nop 2
    v_cvt_pk_bf16_f32 v80, v80, v81
    v_cvt_pk_bf16_f32 v81, v82, v83
    ds_wrxchg_rtn_b64 v[74:75], v93, v[80:81] offset:65408
    v_cvt_pk_bf16_f32 v76, v76, v77
    v_cvt_pk_bf16_f32 v77, v78, v79
    ds_wrxchg_rtn_b64 v[72:73], v92, v[76:77] offset:65408
    v_and_b32 v88, 0x0fffffff, v40
    buffer_load_dwordx2 v[16:17], v88, s[8:11], 0 offen
    buffer_load_dwordx3 v[18:20], v88, s[8:11], 0 offen offset:8
    s_setprio 2
    v_mfma_f32_4x4x4_16b_bf16 v[80:83], v[8:9], v[106:107], 0
    v_mfma_f32_4x4x4_16b_bf16 v[76:79], v[8:9], v[104:105], 0
    v_cmp_lt_u32 s[48:49], v5, v95
    s_nop 2
    v_pk_mul_f32 v[80:81], v[80:81], v[14:15] op_sel:[0,1] op_sel_hi:[1,1]
    v_pk_mul_f32 v[82:83], v[82:83], v[14:15] op_sel:[0,1] op_sel_hi:[1,1]
    v_pk_mul_f32 v[76:77], v[76:77], v[14:15] op_sel:[0,0] op_sel_hi:[1,0]
    v_pk_mul_f32 v[78:79], v[78:79], v[14:15] op_sel:[0,0] op_sel_hi:[1,0]
    s_waitcnt vmcnt(10)
    v_and_b32 v46, 0x20000000, v27
    v_lshrrev_b32 v47, 14, v23
    v_bitop3_b32 v47, v47, v5, v46 bitop3:0xea
    ds_read_b64 v[102:103], v47
    v_and_b32 v99, 0x10000000, v27
    v_lshrrev_b32 v47, 14, v22
    v_bitop3_b32 v47, v47, v5, v99 bitop3:0xea
    ds_read_b64 v[100:101], v47
    s_waitcnt lgkmcnt(2)
    v_cmp_ne_u64 s[50:51], v[72:73], v[68:69]
    v_cmpx_ne_u64 s[54:55], v[74:75], v[70:71]
    s_and_b64 s[82:83], s[54:55], s[80:81]
    s_cbranch_scc1 L2_c51
L2_d51:
    v_mov_b64 v[84:85], v[70:71]
    v_mov_b32 v7, v93
    v_mov_b64 v[86:87], v[74:75]
    s_or_b64 s[80:81], s[80:81], s[54:55]
    s_mov_b64 exec, s[50:51]
    s_and_b64 s[82:83], s[50:51], s[80:81]
    s_cbranch_scc1 L2_c52
L2_d52:
    v_mov_b64 v[84:85], v[68:69]
    v_mov_b32 v7, v92
    v_mov_b64 v[86:87], v[72:73]
    s_mov_b64 exec, -1
    s_or_b64 s[80:81], s[80:81], s[50:51]
    s_and_b64 exec, s[48:49], s[80:81]
    v_mfma_f32_4x4x4_16b_bf16 v[80:83], v[12:13], v[84:85], 0
    v_mov_b32 v95, v7
    s_andn2_b64 s[80:81], s[80:81], s[48:49]
    v_mfma_f32_4x4x4_16b_bf16 v[80:83], v[10:11], v[86:87], v[80:83]
    s_mov_b64 exec, -1
    ds_read_b64 v[70:71], v95 offset:65408
    ds_read_b64 v[68:69], v94 offset:65408
    v_bitop3_b32 v92, v22, v5, v99 bitop3:0xea
    v_bitop3_b32 v93, v23, v5, v46 bitop3:0xea
    v_perm_b32 v15, v23, v26, s45
    v_bitop3_b32 v46, v23, 0.5, -0.5 bitop3:0xa8
    v_perm_b32 v14, v22, v26, s44
    v_bitop3_b32 v47, v22, 0.5, -0.5 bitop3:0xa8
    v_bitop3_b32 v15, v6, v15, v46 bitop3:0xca
    v_bitop3_b32 v14, v6, v14, v47 bitop3:0xca
    s_waitcnt lgkmcnt(1)
    v_mfma_f32_4x4x4_16b_bf16 v[80:83], v[10:11], v[70:71], v[80:83]
    s_waitcnt lgkmcnt(0)
    v_mfma_f32_4x4x4_16b_bf16 v[76:79], v[10:11], v[68:69], v[76:79]
    s_nop 2
    v_cvt_pk_bf16_f32 v80, v80, v81
    v_cvt_pk_bf16_f32 v81, v82, v83
    ds_wrxchg_rtn_b64 v[74:75], v95, v[80:81] offset:65408
    v_cvt_pk_bf16_f32 v76, v76, v77
    v_cvt_pk_bf16_f32 v77, v78, v79
    ds_wrxchg_rtn_b64 v[72:73], v94, v[76:77] offset:65408
    s_setprio 1
    v_mfma_f32_4x4x4_16b_bf16 v[80:83], v[8:9], v[102:103], 0
    v_mfma_f32_4x4x4_16b_bf16 v[76:79], v[8:9], v[100:101], 0
    s_nop 3
    v_pk_mul_f32 v[80:81], v[80:81], v[14:15] op_sel:[0,1] op_sel_hi:[1,1]
    v_pk_mul_f32 v[82:83], v[82:83], v[14:15] op_sel:[0,1] op_sel_hi:[1,1]
    v_pk_mul_f32 v[76:77], v[76:77], v[14:15] op_sel:[0,0] op_sel_hi:[1,0]
    v_pk_mul_f32 v[78:79], v[78:79], v[14:15] op_sel:[0,0] op_sel_hi:[1,0]
    s_bitcmp1_b32 s43, s42
    s_cbranch_scc1 L2_oa53
L2_ob53:
    buffer_load_dwordx4 v[112:115], v3, s[16:19], s40 offen offset:1024 sc1
    v_sub_u16 v88, v56, v48
    v_and_b32 v89, 3, v48
    v_add3_u32 v99, v88, v89, 3
    v_and_b32 v99, -4, v99
    v_max_u32 v99, 4, v99
    v_and_b32 v97, 0xfffc, v48
    v_bfm_b32 v96, v88, v89
    v_add_u32_dpp v91, v99, v99 row_shr:1 row_mask:0xf bank_mask:0xf bound_ctrl:1
    v_mad_u32_u24 v97, v97, 5, v2
    v_cmp_lt_u32 vcc, 16, v99
    v_add_u32_dpp v91, v91, v91 row_shr:2 row_mask:0xf bank_mask:0xf bound_ctrl:1
    v_sub_u32 v98, s38, v99
    v_lshrrev_b64 v[48:49], 16, v[48:49]
    v_add_u32_dpp v91, v91, v91 row_shr:4 row_mask:0xf bank_mask:0xf bound_ctrl:1
    v_lshrrev_b64 v[56:57], 16, v[56:57]
    s_mov_b32 s101, 0
    v_add_u32_dpp v91, v91, v91 row_shr:8 row_mask:0xf bank_mask:0xf bound_ctrl:1
    s_nop 1
    v_add_u32_dpp v91, v91, v91 row_bcast:15 row_mask:0xa bank_mask:0xf
    s_nop 1
    v_add_u32_dpp v91, v91, v91 row_bcast:31 row_mask:0xc bank_mask:0xf
    v_add_u32 v98, v98, v91
    v_readlane_b32 s37, v91, 63
    s_cbranch_vccnz L2_xo54
L2_xp54:
    v_and_b32 v46, 0x80000000, v27
    v_lshrrev_b32 v47, 14, v25
    v_bitop3_b32 v47, v47, v5, v46 bitop3:0xea
    ds_read_b64 v[106:107], v47
    v_and_b32 v99, 0x40000000, v27
    v_lshrrev_b32 v47, 14, v24
    v_bitop3_b32 v47, v47, v5, v99 bitop3:0xea
    ds_read_b64 v[104:105], v47
    s_waitcnt lgkmcnt(2)
    v_cmp_ne_u64 s[50:51], v[72:73], v[68:69]
    v_cmpx_ne_u64 s[54:55], v[74:75], v[70:71]
    s_and_b64 s[82:83], s[54:55], s[80:81]
    s_cbranch_scc1 L2_c55
L2_d55:
    v_mov_b64 v[84:85], v[70:71]
    v_mov_b32 v7, v95
    v_mov_b64 v[86:87], v[74:75]
    s_or_b64 s[80:81], s[80:81], s[54:55]
    s_mov_b64 exec, s[50:51]
    s_and_b64 s[82:83], s[50:51], s[80:81]
    s_cbranch_scc1 L2_c56
L2_d56:
    v_mov_b64 v[84:85], v[68:69]
    v_mov_b32 v7, v94
    v_mov_b64 v[86:87], v[72:73]
    s_mov_b64 exec, -1
    s_or_b64 s[80:81], s[80:81], s[50:51]
    ds_read_b64 v[70:71], v93 offset:65408
    ds_read_b64 v[68:69], v92 offset:65408
    v_bitop3_b32 v94, v24, v5, v99 bitop3:0xea
    v_bitop3_b32 v95, v25, v5, v46 bitop3:0xea
    v_perm_b32 v15, v25, v26, s47
    v_bitop3_b32 v46, v25, 0.5, -0.5 bitop3:0xa8
    v_perm_b32 v14, v24, v26, s46
    v_bitop3_b32 v47, v24, 0.5, -0.5 bitop3:0xa8
    v_bitop3_b32 v15, v6, v15, v46 bitop3:0xca
    v_bitop3_b32 v14, v6, v14, v47 bitop3:0xca
    s_waitcnt lgkmcnt(1)
    v_mfma_f32_4x4x4_16b_bf16 v[80:83], v[10:11], v[70:71], v[80:83]
    s_waitcnt lgkmcnt(0)
    v_mfma_f32_4x4x4_16b_bf16 v[76:79], v[10:11], v[68:69], v[76:79]
    s_nop 2
    v_cvt_pk_bf16_f32 v80, v80, v81
    v_cvt_pk_bf16_f32 v81, v82, v83
    ds_wrxchg_rtn_b64 v[74:75], v93, v[80:81] offset:65408
    v_cvt_pk_bf16_f32 v76, v76, v77
    v_cvt_pk_bf16_f32 v77, v78, v79
    ds_wrxchg_rtn_b64 v[72:73], v92, v[76:77] offset:65408
    v_and_b32 v88, 0x0fffffff, v41
    buffer_load_dwordx2 v[22:23], v88, s[8:11], 0 offen
    buffer_load_dwordx3 v[24:26], v88, s[8:11], 0 offen offset:8
    v_mfma_f32_4x4x4_16b_bf16 v[80:83], v[8:9], v[106:107], 0
    v_mfma_f32_4x4x4_16b_bf16 v[76:79], v[8:9], v[104:105], 0
    v_cmp_lt_u32 s[84:85], v5, v94
    s_nop 2
    v_pk_mul_f32 v[80:81], v[80:81], v[14:15] op_sel:[0,1] op_sel_hi:[1,1]
    v_pk_mul_f32 v[82:83], v[82:83], v[14:15] op_sel:[0,1] op_sel_hi:[1,1]
    v_pk_mul_f32 v[76:77], v[76:77], v[14:15] op_sel:[0,0] op_sel_hi:[1,0]
    v_pk_mul_f32 v[78:79], v[78:79], v[14:15] op_sel:[0,0] op_sel_hi:[1,0]
    s_waitcnt vmcnt(11)
    s_mov_b64 exec, s[6:7]
    v_lshrrev_b32 v30, 16, v30
    s_mov_b64 exec, -1
    v_and_b32 v46, 0x20000000, v31
    v_lshrrev_b32 v47, 14, v29
    v_bitop3_b32 v47, v47, v5, v46 bitop3:0xea
    ds_read_b64 v[102:103], v47
    v_and_b32 v99, 0x10000000, v31
    v_lshrrev_b32 v47, 14, v28
    v_bitop3_b32 v47, v47, v5, v99 bitop3:0xea
    ds_read_b64 v[100:101], v47
    s_waitcnt lgkmcnt(2)
    v_cmp_ne_u64 s[50:51], v[72:73], v[68:69]
    v_cmpx_ne_u64 s[54:55], v[74:75], v[70:71]
    s_and_b64 s[82:83], s[54:55], s[80:81]
    s_cbranch_scc1 L2_c57
L2_d57:
    v_mov_b64 v[84:85], v[70:71]
    v_mov_b32 v7, v93
    v_mov_b64 v[86:87], v[74:75]
    s_or_b64 s[80:81], s[80:81], s[54:55]
    s_mov_b64 exec, s[50:51]
    s_and_b64 s[82:83], s[50:51], s[80:81]
    s_cbranch_scc1 L2_c58
L2_d58:
    v_mov_b64 v[84:85], v[68:69]
    v_mov_b32 v7, v92
    v_mov_b64 v[86:87], v[72:73]
    s_mov_b64 exec, -1
    s_or_b64 s[80:81], s[80:81], s[50:51]
    s_and_b64 exec, s[84:85], s[80:81]
    v_mfma_f32_4x4x4_16b_bf16 v[76:79], v[12:13], v[84:85], 0
    v_mov_b32 v94, v7
    s_andn2_b64 s[80:81], s[80:81], s[84:85]
    v_mfma_f32_4x4x4_16b_bf16 v[76:79], v[10:11], v[86:87], v[76:79]
    s_mov_b64 exec, -1
    ds_read_b64 v[70:71], v95 offset:65408
    ds_read_b64 v[68:69], v94 offset:65408
    v_bitop3_b32 v92, v28, v5, v99 bitop3:0xea
    v_bitop3_b32 v93, v29, v5, v46 bitop3:0xea
    v_perm_b32 v15, v29, v30, s45
    v_bitop3_b32 v46, v29, 0.5, -0.5 bitop3:0xa8
    v_perm_b32 v14, v28, v30, s44
    v_bitop3_b32 v47, v28, 0.5, -0.5 bitop3:0xa8
    v_bitop3_b32 v15, v6, v15, v46 bitop3:0xca
    v_bitop3_b32 v14, v6, v14, v47 bitop3:0xca
    s_waitcnt lgkmcnt(1)
    v_mfma_f32_4x4x4_16b_bf16 v[80:83], v[10:11], v[70:71], v[80:83]
    s_waitcnt lgkmcnt(0)
    v_mfma_f32_4x4x4_16b_bf16 v[76:79], v[10:11], v[68:69], v[76:79]
    s_nop 2
    v_cvt_pk_bf16_f32 v80, v80, v81
    v_cvt_pk_bf16_f32 v81, v82, v83
    ds_wrxchg_rtn_b64 v[74:75], v95, v[80:81] offset:65408
    v_cvt_pk_bf16_f32 v76, v76, v77
    v_cvt_pk_bf16_f32 v77, v78, v79
    ds_wrxchg_rtn_b64 v[72:73], v94, v[76:77] offset:65408
    s_setprio 0
    v_mfma_f32_4x4x4_16b_bf16 v[80:83], v[8:9], v[102:103], 0
    v_mfma_f32_4x4x4_16b_bf16 v[76:79], v[8:9], v[100:101], 0
    v_cmp_lt_u32 s[48:49], v5, v93
    s_nop 2
    v_pk_mul_f32 v[80:81], v[80:81], v[14:15] op_sel:[0,1] op_sel_hi:[1,1]
    v_pk_mul_f32 v[82:83], v[82:83], v[14:15] op_sel:[0,1] op_sel_hi:[1,1]
    v_pk_mul_f32 v[76:77], v[76:77], v[14:15] op_sel:[0,0] op_sel_hi:[1,0]
    v_pk_mul_f32 v[78:79], v[78:79], v[14:15] op_sel:[0,0] op_sel_hi:[1,0]
    s_add_u32 s40, s40, 0xfff24000
    v_and_b32 v47, 0x0fffffff, v42
    buffer_load_dword v30, v47, s[8:11], 0 offen offset:16
    s_mov_b64 exec, s[6:7]
    v_add_u32 v47, 8, v47
    v_lshrrev_b32 v42, 2, v42
    s_mov_b64 exec, -1
    buffer_load_dwordx2 v[28:29], v47, s[8:11], 0 offen
    s_waitcnt vmcnt(8)
    v_and_b32 v46, 0x80000000, v39
    v_lshrrev_b32 v47, 14, v37
    v_bitop3_b32 v47, v47, v5, v46 bitop3:0xea
    ds_read_b64 v[102:103], v47
    v_and_b32 v99, 0x40000000, v39
    v_lshrrev_b32 v47, 14, v36
    v_bitop3_b32 v47, v47, v5, v99 bitop3:0xea
    ds_read_b64 v[100:101], v47
    v_and_b32 v46, 0x20000000, v39
    v_lshrrev_b32 v47, 14, v35
    v_bitop3_b32 v47, v47, v5, v46 bitop3:0xea
    ds_read_b64 v[106:107], v47
    v_and_b32 v99, 0x10000000, v39
    v_lshrrev_b32 v47, 14, v34
    v_bitop3_b32 v47, v47, v5, v99 bitop3:0xea
    ds_read_b64 v[104:105], v47
    s_waitcnt lgkmcnt(4)
    v_cmp_ne_u64 s[50:51], v[72:73], v[68:69]
    v_cmpx_ne_u64 s[54:55], v[74:75], v[70:71]
    s_and_b64 s[82:83], s[54:55], s[80:81]
    s_cbranch_scc1 L2_c59
L2_d59:
    v_mov_b64 v[84:85], v[70:71]
    v_mov_b32 v7, v95
    v_mov_b64 v[86:87], v[74:75]
    s_or_b64 s[80:81], s[80:81], s[54:55]
    s_mov_b64 exec, s[50:51]
    s_and_b64 s[82:83], s[50:51], s[80:81]
    s_cbranch_scc1 L2_c60
L2_d60:
    v_mov_b64 v[84:85], v[68:69]
    v_mov_b32 v7, v94
    v_mov_b64 v[86:87], v[72:73]
    s_mov_b64 exec, -1
    s_or_b64 s[80:81], s[80:81], s[50:51]
    s_and_b64 exec, s[48:49], s[80:81]
    v_mfma_f32_4x4x4_16b_bf16 v[80:83], v[12:13], v[84:85], 0
    v_mov_b32 v93, v7
    s_andn2_b64 s[80:81], s[80:81], s[48:49]
    v_mfma_f32_4x4x4_16b_bf16 v[80:83], v[10:11], v[86:87], v[80:83]
    s_mov_b64 exec, -1
    ds_read_b64 v[70:71], v93 offset:65408
    ds_read_b64 v[68:69], v92 offset:65408
    v_bitop3_b32 v94, v34, v5, v99 bitop3:0xea
    v_bitop3_b32 v95, v35, v5, v46 bitop3:0xea
    v_perm_b32 v15, v35, v38, s45
    v_bitop3_b32 v46, v35, 0.5, -0.5 bitop3:0xa8
    v_perm_b32 v14, v34, v38, s44
    v_bitop3_b32 v47, v34, 0.5, -0.5 bitop3:0xa8
    v_bitop3_b32 v15, v6, v15, v46 bitop3:0xca
    v_bitop3_b32 v14, v6, v14, v47 bitop3:0xca
    s_waitcnt lgkmcnt(1)
    v_mfma_f32_4x4x4_16b_bf16 v[80:83], v[10:11], v[70:71], v[80:83]
    s_waitcnt lgkmcnt(0)
    v_mfma_f32_4x4x4_16b_bf16 v[76:79], v[10:11], v[68:69], v[76:79]
    s_nop 2
    v_cvt_pk_bf16_f32 v80, v80, v81
    v_cvt_pk_bf16_f32 v81, v82, v83
    ds_wrxchg_rtn_b64 v[74:75], v93, v[80:81] offset:65408
    v_cvt_pk_bf16_f32 v76, v76, v77
    v_cvt_pk_bf16_f32 v77, v78, v79
    ds_wrxchg_rtn_b64 v[72:73], v92, v[76:77] offset:65408
    s_barrier
    s_setprio 3
    s_mov_b32 m0, s100
    s_nop 0
    ds_write_addtid_b32 v124 offset:34816
    ds_write_addtid_b32 v125 offset:35072
    ds_write_addtid_b32 v126 offset:35328
    ds_write_addtid_b32 v127 offset:35584
    s_add_u32 s3, s40, 4096
    buffer_load_dwordx4 v[124:127], v3, s[16:19], s3 offen sc1
    ds_write_addtid_b32 v116 offset:32768
    ds_write_addtid_b32 v117 offset:33024
    ds_write_addtid_b32 v118 offset:33280
    ds_write_addtid_b32 v119 offset:33536
    buffer_load_dwordx4 v[116:119], v3, s[16:19], s40 offen offset:2048 sc1
    ds_write_addtid_b32 v120 offset:33792
    ds_write_addtid_b32 v121 offset:34048
    ds_write_addtid_b32 v122 offset:34304
    ds_write_addtid_b32 v123 offset:34560
    buffer_load_dwordx4 v[120:123], v3, s[16:19], s40 offen offset:3072 sc1
    v_mfma_f32_4x4x4_16b_bf16 v[80:83], v[8:9], v[106:107], 0
    v_mfma_f32_4x4x4_16b_bf16 v[76:79], v[8:9], v[104:105], 0
    s_nop 3
    v_pk_mul_f32 v[80:81], v[80:81], v[14:15] op_sel:[0,1] op_sel_hi:[1,1]
    v_pk_mul_f32 v[82:83], v[82:83], v[14:15] op_sel:[0,1] op_sel_hi:[1,1]
    v_pk_mul_f32 v[76:77], v[76:77], v[14:15] op_sel:[0,0] op_sel_hi:[1,0]
    v_pk_mul_f32 v[78:79], v[78:79], v[14:15] op_sel:[0,0] op_sel_hi:[1,0]
    s_cmp_gt_u32 s37, 1024
    s_cbranch_scc1 L2_xs61
    s_cmp_lg_u32 s101, 0
    s_cbranch_scc1 L2_xa61
L2_xb61:
    v_lshlrev_b32 v89, 16, v96
    v_add_u32 v90, 60, v97
    v_bitop3_b32 v90, v89, v45, v90 bitop3:0x6a
    ds_write_b32 v98, v90 offset:12
    v_lshlrev_b32 v89, 20, v96
    v_add_u32 v90, 40, v97
    v_bitop3_b32 v90, v89, v45, v90 bitop3:0x6a
    ds_write_b32 v98, v90 offset:8
    v_lshlrev_b32 v89, 24, v96
    v_add_u32 v90, 20, v97
    v_bitop3_b32 v90, v89, v45, v90 bitop3:0x6a
    ds_write_b32 v98, v90 offset:4
    v_lshlrev_b32 v89, 28, v96
    v_bitop3_b32 v90, v89, v45, v97 bitop3:0x6a
    ds_write_b32 v98, v90 offset:0
    v_mov_b32_dpp v91, v64 quad_perm:[0,0,0,0] row_mask:0xf bank_mask:0xf
    v_and_b32 v89, 3, v91
    v_and_b32 v97, 0xfffc, v91
    v_sub_u16_dpp v88, v64, v91 quad_perm:[2,2,2,2] row_mask:0xf bank_mask:0xf
    v_mad_u32_u24 v97, v97, 5, v4
    v_add_u32 v99, v88, v89
    v_bfm_b32 v96, v88, v89
    v_cmp_lt_u32 s[58:59], 16, v99
    v_lshlrev_b32 v89, v1, v96
    v_and_b32 v89, v45, v89
    v_cmp_ne_u32 vcc, 0, v89
    v_xor_b32 v90, v97, v89
    s_add_u32 s3, s37, s38
    v_mbcnt_lo_u32_b32 v98, vcc_lo, 0
    v_mbcnt_hi_u32_b32 v98, vcc_hi, v98
    s_bcnt1_i32_b64 s41, vcc
    v_lshl_add_u32 v98, v98, 2, s3
    s_lshl2_add_u32 s37, s41, s37
    s_mov_b64 exec, vcc
    ds_write_b32 v98, v90
    s_mov_b64 exec, -1
    s_cmp_lg_u64 s[58:59], 0
    s_cbranch_scc1 L2_xe61
L2_xr61:
    v_add_u32 v98, s37, v0
    v_mov_b32 v90, -1
    ds_write_b32 v98, v90
L2_xw61:
    s_setprio 2
    s_waitcnt lgkmcnt(14)
    v_cmp_ne_u64 s[50:51], v[72:73], v[68:69]
    v_cmpx_ne_u64 s[54:55], v[74:75], v[70:71]
    s_and_b64 s[82:83], s[54:55], s[80:81]
    s_cbranch_scc1 L2_c62
L2_d62:
    v_mov_b64 v[84:85], v[70:71]
    v_mov_b32 v7, v93
    v_mov_b64 v[86:87], v[74:75]
    s_or_b64 s[80:81], s[80:81], s[54:55]
    s_mov_b64 exec, s[50:51]
    s_and_b64 s[82:83], s[50:51], s[80:81]
    s_cbranch_scc1 L2_c63
L2_d63:
    v_mov_b64 v[84:85], v[68:69]
    v_mov_b32 v7, v92
    v_mov_b64 v[86:87], v[72:73]
    s_mov_b64 exec, -1
    s_or_b64 s[80:81], s[80:81], s[50:51]
    ds_read_b64 v[70:71], v95 offset:65408
    ds_read_b64 v[68:69], v94 offset:65408
    v_and_b32 v46, 0x40000000, v39
    v_bitop3_b32 v92, v36, v5, v46 bitop3:0xea
    v_and_b32 v46, 0x80000000, v39
    v_bitop3_b32 v93, v37, v5, v46 bitop3:0xea
    v_perm_b32 v15, v37, v38, s47
    v_bitop3_b32 v46, v37, 0.5, -0.5 bitop3:0xa8
    v_perm_b32 v14, v36, v38, s46
    v_bitop3_b32 v47, v36, 0.5, -0.5 bitop3:0xa8
    v_bitop3_b32 v15, v6, v15, v46 bitop3:0xca
    v_bitop3_b32 v14, v6, v14, v47 bitop3:0xca
    s_setprio 1
    s_waitcnt lgkmcnt(1)
    v_mfma_f32_4x4x4_16b_bf16 v[80:83], v[10:11], v[70:71], v[80:83]
    s_waitcnt lgkmcnt(0)
    v_mfma_f32_4x4x4_16b_bf16 v[76:79], v[10:11], v[68:69], v[76:79]
    s_nop 2
    v_cvt_pk_bf16_f32 v80, v80, v81
    v_cvt_pk_bf16_f32 v81, v82, v83
    ds_wrxchg_rtn_b64 v[74:75], v95, v[80:81] offset:65408
    v_cvt_pk_bf16_f32 v76, v76, v77
    v_cvt_pk_bf16_f32 v77, v78, v79
    ds_wrxchg_rtn_b64 v[72:73], v94, v[76:77] offset:65408
    ds_read_b32 v21, v0 offset:0
    ds_read_b32 v27, v0 offset:256
    ds_read_b32 v31, v44 offset:768
    ds_read_b32 v39, v0 offset:512
    s_sub_u32 s3, s37, 768
    s_cmp_gt_u32 s3, 128
    s_cbranch_scc1 L2_xf61
L2_xg61:
    v_and_b32 v88, 0x0fffffff, v43
    buffer_load_dwordx2 v[34:35], v88, s[8:11], 0 offen
    buffer_load_dwordx3 v[36:38], v88, s[8:11], 0 offen offset:8
    s_setprio 0
    s_waitcnt vmcnt(12)
    s_mov_b32 m0, s38
    s_nop 0
    ds_write_addtid_b32 v108 offset:0
    ds_write_addtid_b32 v109 offset:256
    ds_write_addtid_b32 v110 offset:512
    ds_write_addtid_b32 v111 offset:768
    s_waitcnt vmcnt(9)
    ds_write_addtid_b32 v112 offset:1024
    ds_write_addtid_b32 v113 offset:1280
    ds_write_addtid_b32 v114 offset:1536
    ds_write_addtid_b32 v115 offset:1792
    v_mfma_f32_4x4x4_16b_bf16 v[80:83], v[8:9], v[102:103], 0
    v_mfma_f32_4x4x4_16b_bf16 v[76:79], v[8:9], v[100:101], 0
    v_cmp_lt_u32 s[84:85], v5, v92
    s_nop 2
    v_pk_mul_f32 v[80:81], v[80:81], v[14:15] op_sel:[0,1] op_sel_hi:[1,1]
    v_pk_mul_f32 v[82:83], v[82:83], v[14:15] op_sel:[0,1] op_sel_hi:[1,1]
    v_pk_mul_f32 v[76:77], v[76:77], v[14:15] op_sel:[0,0] op_sel_hi:[1,0]
    v_pk_mul_f32 v[78:79], v[78:79], v[14:15] op_sel:[0,0] op_sel_hi:[1,0]
    s_add_u32 s42, s42, 1
    s_waitcnt lgkmcnt(0)
    s_barrier
    s_bitcmp1_b32 s36, s42
    s_cbranch_scc1 L2_slow
L2_ret3:
    s_setprio 3
    s_bitcmp1_b32 s43, s42
    s_cbranch_scc1 L2_oa64
L2_ob64:
    v_and_b32 v46, 0x20000000, v40
    v_lshrrev_b32 v47, 14, v17
    v_bitop3_b32 v47, v47, v5, v46 bitop3:0xea
    ds_read_b64 v[106:107], v47
    v_and_b32 v99, 0x10000000, v40
    v_lshrrev_b32 v47, 14, v16
    v_bitop3_b32 v47, v47, v5, v99 bitop3:0xea
    ds_read_b64 v[104:105], v47
    v_cmp_ne_u64 s[50:51], v[72:73], v[68:69]
    v_cmpx_ne_u64 s[54:55], v[74:75], v[70:71]
    s_and_b64 s[82:83], s[54:55], s[80:81]
    s_cbranch_scc1 L2_c65
L2_d65:
    v_mov_b64 v[84:85], v[70:71]
    v_mov_b32 v7, v95
    v_mov_b64 v[86:87], v[74:75]
    s_or_b64 s[80:81], s[80:81], s[54:55]
    s_mov_b64 exec, s[50:51]
    s_and_b64 s[82:83], s[50:51], s[80:81]
    s_cbranch_scc1 L2_c66
L2_d66:
    v_mov_b64 v[84:85], v[68:69]
    v_mov_b32 v7, v94
    v_mov_b64 v[86:87], v[72:73]
    s_mov_b64 exec, -1
    s_or_b64 s[80:81], s[80:81], s[50:51]
    s_and_b64 exec, s[84:85], s[80:81]
    v_mfma_f32_4x4x4_16b_bf16 v[76:79], v[12:13], v[84:85], 0
    v_mov_b32 v92, v7
    s_andn2_b64 s[80:81], s[80:81], s[84:85]
    v_mfma_f32_4x4x4_16b_bf16 v[76:79], v[10:11], v[86:87], v[76:79]
    s_mov_b64 exec, -1
    ds_read_b64 v[70:71], v93 offset:65408
    ds_read_b64 v[68:69], v92 offset:65408
    v_bitop3_b32 v94, v16, v5, v99 bitop3:0xea
    v_bitop3_b32 v95, v17, v5, v46 bitop3:0xea
    v_perm_b32 v15, v17, v20, s45
    v_bitop3_b32 v46, v17, 0.5, -0.5 bitop3:0xa8
    v_perm_b32 v14, v16, v20, s44
    v_bitop3_b32 v47, v16, 0.5, -0.5 bitop3:0xa8
    v_bitop3_b32 v15, v6, v15, v46 bitop3:0xca
    v_bitop3_b32 v14, v6, v14, v47 bitop3:0xca
    s_waitcnt lgkmcnt(1)
    v_mfma_f32_4x4x4_16b_bf16 v[80:83], v[10:11], v[70:71], v[80:83]
    s_waitcnt lgkmcnt(0)
    v_mfma_f32_4x4x4_16b_bf16 v[76:79], v[10:11], v[68:69], v[76:79]
    s_nop 2
    v_cvt_pk_bf16_f32 v80, v80, v81
    v_cvt_pk_bf16_f32 v81, v82, v83
    ds_wrxchg_rtn_b64 v[74:75], v93, v[80:81] offset:65408
    v_cvt_pk_bf16_f32 v76, v76, v77
    v_cvt_pk_bf16_f32 v77, v78, v79
    ds_wrxchg_rtn_b64 v[72:73], v92, v[76:77] offset:65408
    v_mfma_f32_4x4x4_16b_bf16 v[80:83], v[8:9], v[106:107], 0
    v_mfma_f32_4x4x4_16b_bf16 v[76:79], v[8:9], v[104:105], 0
    v_cmp_lt_u32 s[84:85], v5, v94
    s_nop 2
    v_pk_mul_f32 v[80:81], v[80:81], v[14:15] op_sel:[0,1] op_sel_hi:[1,1]
    v_pk_mul_f32 v[82:83], v[82:83], v[14:15] op_sel:[0,1] op_sel_hi:[1,1]
    v_pk_mul_f32 v[76:77], v[76:77], v[14:15] op_sel:[0,0] op_sel_hi:[1,0]
    v_pk_mul_f32 v[78:79], v[78:79], v[14:15] op_sel:[0,0] op_sel_hi:[1,0]
    buffer_load_dwordx4 v[108:111], v3, s[16:19], s40 offen offset:0 sc1
    v_and_b32 v46, 0x80000000, v40
    v_lshrrev_b32 v47, 14, v19
    v_bitop3_b32 v47, v47, v5, v46 bitop3:0xea
    ds_read_b64 v[102:103], v47
    v_and_b32 v99, 0x40000000, v40
    v_lshrrev_b32 v47, 14, v18
    v_bitop3_b32 v47, v47, v5, v99 bitop3:0xea
    ds_read_b64 v[100:101], v47
    s_waitcnt lgkmcnt(2)
    v_cmp_ne_u64 s[50:51], v[72:73], v[68:69]
    v_cmpx_ne_u64 s[54:55], v[74:75], v[70:71]
    s_and_b64 s[82:83], s[54:55], s[80:81]
    s_cbranch_scc1 L2_c67
L2_d67:
    v_mov_b64 v[84:85], v[70:71]
    v_mov_b32 v7, v93
    v_mov_b64 v[86:87], v[74:75]
    s_or_b64 s[80:81], s[80:81], s[54:55]
    s_mov_b64 exec, s[50:51]
    s_and_b64 s[82:83], s[50:51], s[80:81]
    s_cbranch_scc1 L2_c68
L2_d68:
    v_mov_b64 v[84:85], v[68:69]
    v_mov_b32 v7, v92
    v_mov_b64 v[86:87], v[72:73]
    s_mov_b64 exec, -1
    s_or_b64 s[80:81], s[80:81], s[50:51]
    s_and_b64 exec, s[84:85], s[80:81]
    v_mfma_f32_4x4x4_16b_bf16 v[76:79], v[12:13], v[84:85], 0
    v_mov_b32 v94, v7
    s_andn2_b64 s[80:81], s[80:81], s[84:85]
    v_mfma_f32_4x4x4_16b_bf16 v[76:79], v[10:11], v[86:87], v[76:79]
    s_mov_b64 exec, -1
    ds_read_b64 v[70:71], v95 offset:65408
    ds_read_b64 v[68:69], v94 offset:65408
    v_bitop3_b32 v92, v18, v5, v99 bitop3:0xea
    v_bitop3_b32 v93, v19, v5, v46 bitop3:0xea
    v_perm_b32 v15, v19, v20, s47
    v_bitop3_b32 v46, v19, 0.5, -0.5 bitop3:0xa8
    v_perm_b32 v14, v18, v20, s46
    v_bitop3_b32 v47, v18, 0.5, -0.5 bitop3:0xa8
    v_bitop3_b32 v15, v6, v15, v46 bitop3:0xca
    v_bitop3_b32 v14, v6, v14, v47 bitop3:0xca
    s_waitcnt lgkmcnt(1)
    v_mfma_f32_4x4x4_16b_bf16 v[80:83], v[10:11], v[70:71], v[80:83]
    s_waitcnt lgkmcnt(0)
    v_mfma_f32_4x4x4_16b_bf16 v[76:79], v[10:11], v[68:69], v[76:79]
    s_nop 2
    v_cvt_pk_bf16_f32 v80, v80, v81
    v_cvt_pk_bf16_f32 v81, v82, v83
    ds_wrxchg_rtn_b64 v[74:75], v95, v[80:81] offset:65408
    v_cvt_pk_bf16_f32 v76, v76, v77
    v_cvt_pk_bf16_f32 v77, v78, v79
    ds_wrxchg_rtn_b64 v[72:73], v94, v[76:77] offset:65408
    v_and_b32 v88, 0x0fffffff, v21
    buffer_load_dwordx2 v[16:17], v88, s[8:11], 0 offen
    buffer_load_dwordx3 v[18:20], v88, s[8:11], 0 offen offset:8
    s_setprio 2
    v_mfma_f32_4x4x4_16b_bf16 v[80:83], v[8:9], v[102:103], 0
    v_mfma_f32_4x4x4_16b_bf16 v[76:79], v[8:9], v[100:101], 0
    v_cmp_lt_u32 s[48:49], v5, v93
    s_nop 2
    v_pk_mul_f32 v[80:81], v[80:81], v[14:15] op_sel:[0,1] op_sel_hi:[1,1]
    v_pk_mul_f32 v[82:83], v[82:83], v[14:15] op_sel:[0,1] op_sel_hi:[1,1]
    v_pk_mul_f32 v[76:77], v[76:77], v[14:15] op_sel:[0,0] op_sel_hi:[1,0]
    v_pk_mul_f32 v[78:79], v[78:79], v[14:15] op_sel:[0,0] op_sel_hi:[1,0]
    s_waitcnt vmcnt(10)
    v_and_b32 v46, 0x20000000, v41
    v_lshrrev_b32 v47, 14, v23
    v_bitop3_b32 v47, v47, v5, v46 bitop3:0xea
    ds_read_b64 v[106:107], v47
    v_and_b32 v99, 0x10000000, v41
    v_lshrrev_b32 v47, 14, v22
    v_bitop3_b32 v47, v47, v5, v99 bitop3:0xea
    ds_read_b64 v[104:105], v47
    s_waitcnt lgkmcnt(2)
    v_cmp_ne_u64 s[50:51], v[72:73], v[68:69]
    v_cmpx_ne_u64 s[54:55], v[74:75], v[70:71]
    s_and_b64 s[82:83], s[54:55], s[80:81]
    s_cbranch_scc1 L2_c69
L2_d69:
    v_mov_b64 v[84:85], v[70:71]
    v_mov_b32 v7, v95
    v_mov_b64 v[86:87], v[74:75]
    s_or_b64 s[80:81], s[80:81], s[54:55]
    s_mov_b64 exec, s[50:51]
    s_and_b64 s[82:83], s[50:51], s[80:81]
    s_cbranch_scc1 L2_c70
L2_d70:
    v_mov_b64 v[84:85], v[68:69]
    v_mov_b32 v7, v94
    v_mov_b64 v[86:87], v[72:73]
    s_mov_b64 exec, -1
    s_or_b64 s[80:81], s[80:81], s[50:51]
    s_and_b64 exec, s[48:49], s[80:81]
    v_mfma_f32_4x4x4_16b_bf16 v[80:83], v[12:13], v[84:85], 0
    v_mov_b32 v93, v7
    s_andn2_b64 s[80:81], s[80:81], s[48:49]
    v_mfma_f32_4x4x4_16b_bf16 v[80:83], v[10:11], v[86:87], v[80:83]
    s_mov_b64 exec, -1
    ds_read_b64 v[70:71], v93 offset:65408
    ds_read_b64 v[68:69], v92 offset:65408
    v_bitop3_b32 v94, v22, v5, v99 bitop3:0xea
    v_bitop3_b32 v95, v23, v5, v46 bitop3:0xea
    v_perm_b32 v15, v23, v26, s45
    v_bitop3_b32 v46, v23, 0.5, -0.5 bitop3:0xa8
    v_perm_b32 v14, v22, v26, s44
    v_bitop3_b32 v47, v22, 0.5, -0.5 bitop3:0xa8
    v_bitop3_b32 v15, v6, v15, v46 bitop3:0xca
    v_bitop3_b32 v14, v6, v14, v47 bitop3:0xca
    s_waitcnt lgkmcnt(1)
    v_mfma_f32_4x4x4_16b_bf16 v[80:83], v[10:11], v[70:71], v[80:83]
    s_waitcnt lgkmcnt(0)
    v_mfma_f32_4x4x4_16b_bf16 v[76:79], v[10:11], v[68:69], v[76:79]
    s_nop 2
    v_cvt_pk_bf16_f32 v80, v80, v81
    v_cvt_pk_bf16_f32 v81, v82, v83
    ds_wrxchg_rtn_b64 v[74:75], v93, v[80:81] offset:65408
    v_cvt_pk_bf16_f32 v76, v76, v77
    v_cvt_pk_bf16_f32 v77, v78, v79
    ds_wrxchg_rtn_b64 v[72:73], v92, v[76:77] offset:65408
    s_setprio 1
    v_mfma_f32_4x4x4_16b_bf16 v[80:83], v[8:9], v[106:107], 0
    v_mfma_f32_4x4x4_16b_bf16 v[76:79], v[8:9], v[104:105], 0
    s_nop 3
    v_pk_mul_f32 v[80:81], v[80:81], v[14:15] op_sel:[0,1] op_sel_hi:[1,1]
    v_pk_mul_f32 v[82:83], v[82:83], v[14:15] op_sel:[0,1] op_sel_hi:[1,1]
    v_pk_mul_f32 v[76:77], v[76:77], v[14:15] op_sel:[0,0] op_sel_hi:[1,0]
    v_pk_mul_f32 v[78:79], v[78:79], v[14:15] op_sel:[0,0] op_sel_hi:[1,0]
    s_bitcmp1_b32 s43, s42
    s_cbranch_scc1 L2_oa71
L2_ob71:
    buffer_load_dwordx4 v[112:115], v3, s[16:19], s40 offen offset:1024 sc1
    v_sub_u16 v88, v58, v50
    v_and_b32 v89, 3, v50
    v_add3_u32 v99, v88, v89, 3
    v_and_b32 v99, -4, v99
    v_max_u32 v99, 4, v99
    v_and_b32 v97, 0xfffc, v50
    v_bfm_b32 v96, v88, v89
    v_add_u32_dpp v91, v99, v99 row_shr:1 row_mask:0xf bank_mask:0xf bound_ctrl:1
    v_mad_u32_u24 v97, v97, 5, v2
    v_cmp_lt_u32 vcc, 16, v99
    v_add_u32_dpp v91, v91, v91 row_shr:2 row_mask:0xf bank_mask:0xf bound_ctrl:1
    v_sub_u32 v98, s38, v99
    v_lshrrev_b64 v[50:51], 16, v[50:51]
    v_add_u32_dpp v91, v91, v91 row_shr:4 row_mask:0xf bank_mask:0xf bound_ctrl:1
    v_lshrrev_b64 v[58:59], 16, v[58:59]
    s_mov_b32 s101, 0
    v_add_u32_dpp v91, v91, v91 row_shr:8 row_mask:0xf bank_mask:0xf bound_ctrl:1
    s_nop 1
    v_add_u32_dpp v91, v91, v91 row_bcast:15 row_mask:0xa bank_mask:0xf
    s_nop 1
    v_add_u32_dpp v91, v91, v91 row_bcast:31 row_mask:0xc bank_mask:0xf
    v_add_u32 v98, v98, v91
    v_readlane_b32 s37, v91, 63
    s_cbranch_vccnz L2_xo72
L2_xp72:
    v_and_b32 v46, 0x80000000, v41
    v_lshrrev_b32 v47, 14, v25
    v_bitop3_b32 v47, v47, v5, v46 bitop3:0xea
    ds_read_b64 v[102:103], v47
    v_and_b32 v99, 0x40000000, v41
    v_lshrrev_b32 v47, 14, v24
    v_bitop3_b32 v47, v47, v5, v99 bitop3:0xea
    ds_read_b64 v[100:101], v47
    s_waitcnt lgkmcnt(2)
    v_cmp_ne_u64 s[50:51], v[72:73], v[68:69]
    v_cmpx_ne_u64 s[54:55], v[74:75], v[70:71]
    s_and_b64 s[82:83], s[54:55], s[80:81]
    s_cbranch_scc1 L2_c73
L2_d73:
    v_mov_b64 v[84:85], v[70:71]
    v_mov_b32 v7, v93
    v_mov_b64 v[86:87], v[74:75]
    s_or_b64 s[80:81], s[80:81], s[54:55]
    s_mov_b64 exec, s[50:51]
    s_and_b64 s[82:83], s[50:51], s[80:81]
    s_cbranch_scc1 L2_c74
L2_d74:
    v_mov_b64 v[84:85], v[68:69]
    v_mov_b32 v7, v92
    v_mov_b64 v[86:87], v[72:73]
    s_mov_b64 exec, -1
    s_or_b64 s[80:81], s[80:81], s[50:51]
    ds_read_b64 v[70:71], v95 offset:65408
    ds_read_b64 v[68:69], v94 offset:65408
    v_bitop3_b32 v92, v24, v5, v99 bitop3:0xea
    v_bitop3_b32 v93, v25, v5, v46 bitop3:0xea
    v_perm_b32 v15, v25, v26, s47
    v_bitop3_b32 v46, v25, 0.5, -0.5 bitop3:0xa8
    v_perm_b32 v14, v24, v26, s46
    v_bitop3_b32 v47, v24, 0.5, -0.5 bitop3:0xa8
    v_bitop3_b32 v15, v6, v15, v46 bitop3:0xca
    v_bitop3_b32 v14, v6, v14, v47 bitop3:0xca
    s_waitcnt lgkmcnt(1)
    v_mfma_f32_4x4x4_16b_bf16 v[80:83], v[10:11], v[70:71], v[80:83]
    s_waitcnt lgkmcnt(0)
    v_mfma_f32_4x4x4_16b_bf16 v[76:79], v[10:11], v[68:69], v[76:79]
    s_nop 2
    v_cvt_pk_bf16_f32 v80, v80, v81
    v_cvt_pk_bf16_f32 v81, v82, v83
    ds_wrxchg_rtn_b64 v[74:75], v95, v[80:81] offset:65408
    v_cvt_pk_bf16_f32 v76, v76, v77
    v_cvt_pk_bf16_f32 v77, v78, v79
    ds_wrxchg_rtn_b64 v[72:73], v94, v[76:77] offset:65408
    v_and_b32 v88, 0x0fffffff, v27
    buffer_load_dwordx2 v[22:23], v88, s[8:11], 0 offen
    buffer_load_dwordx3 v[24:26], v88, s[8:11], 0 offen offset:8
    v_mfma_f32_4x4x4_16b_bf16 v[80:83], v[8:9], v[102:103], 0
    v_mfma_f32_4x4x4_16b_bf16 v[76:79], v[8:9], v[100:101], 0
    v_cmp_lt_u32 s[84:85], v5, v92
    s_nop 2
    v_pk_mul_f32 v[80:81], v[80:81], v[14:15] op_sel:[0,1] op_sel_hi:[1,1]
    v_pk_mul_f32 v[82:83], v[82:83], v[14:15] op_sel:[0,1] op_sel_hi:[1,1]
    v_pk_mul_f32 v[76:77], v[76:77], v[14:15] op_sel:[0,0] op_sel_hi:[1,0]
    v_pk_mul_f32 v[78:79], v[78:79], v[14:15] op_sel:[0,0] op_sel_hi:[1,0]
    s_waitcnt vmcnt(11)
    s_mov_b64 exec, s[6:7]
    v_lshrrev_b32 v30, 16, v30
    s_mov_b64 exec, -1
    v_and_b32 v46, 0x20000000, v42
    v_lshrrev_b32 v47, 14, v29
    v_bitop3_b32 v47, v47, v5, v46 bitop3:0xea
    ds_read_b64 v[106:107], v47
    v_and_b32 v99, 0x10000000, v42
    v_lshrrev_b32 v47, 14, v28
    v_bitop3_b32 v47, v47, v5, v99 bitop3:0xea
    ds_read_b64 v[104:105], v47
    s_waitcnt lgkmcnt(2)
    v_cmp_ne_u64 s[50:51], v[72:73], v[68:69]
    v_cmpx_ne_u64 s[54:55], v[74:75], v[70:71]
    s_and_b64 s[82:83], s[54:55], s[80:81]
    s_cbranch_scc1 L2_c75
L2_d75:
    v_mov_b64 v[84:85], v[70:71]
    v_mov_b32 v7, v95
    v_mov_b64 v[86:87], v[74:75]
    s_or_b64 s[80:81], s[80:81], s[54:55]
    s_mov_b64 exec, s[50:51]
    s_and_b64 s[82:83], s[50:51], s[80:81]
    s_cbranch_scc1 L2_c76
L2_d76:
    v_mov_b64 v[84:85], v[68:69]
    v_mov_b32 v7, v94
    v_mov_b64 v[86:87], v[72:73]
    s_mov_b64 exec, -1
    s_or_b64 s[80:81], s[80:81], s[50:51]
    s_and_b64 exec, s[84:85], s[80:81]
    v_mfma_f32_4x4x4_16b_bf16 v[76:79], v[12:13], v[84:85], 0
    v_mov_b32 v92, v7
    s_andn2_b64 s[80:81], s[80:81], s[84:85]
    v_mfma_f32_4x4x4_16b_bf16 v[76:79], v[10:11], v[86:87], v[76:79]
    s_mov_b64 exec, -1
    ds_read_b64 v[70:71], v93 offset:65408
    ds_read_b64 v[68:69], v92 offset:65408
    v_bitop3_b32 v94, v28, v5, v99 bitop3:0xea
    v_bitop3_b32 v95, v29, v5, v46 bitop3:0xea
    v_perm_b32 v15, v29, v30, s45
    v_bitop3_b32 v46, v29, 0.5, -0.5 bitop3:0xa8
    v_perm_b32 v14, v28, v30, s44
    v_bitop3_b32 v47, v28, 0.5, -0.5 bitop3:0xa8
    v_bitop3_b32 v15, v6, v15, v46 bitop3:0xca
    v_bitop3_b32 v14, v6, v14, v47 bitop3:0xca
    s_waitcnt lgkmcnt(1)
    v_mfma_f32_4x4x4_16b_bf16 v[80:83], v[10:11], v[70:71], v[80:83]
    s_waitcnt lgkmcnt(0)
    v_mfma_f32_4x4x4_16b_bf16 v[76:79], v[10:11], v[68:69], v[76:79]
    s_nop 2
    v_cvt_pk_bf16_f32 v80, v80, v81
    v_cvt_pk_bf16_f32 v81, v82, v83
    ds_wrxchg_rtn_b64 v[74:75], v93, v[80:81] offset:65408
    v_cvt_pk_bf16_f32 v76, v76, v77
    v_cvt_pk_bf16_f32 v77, v78, v79
    ds_wrxchg_rtn_b64 v[72:73], v92, v[76:77] offset:65408
    s_setprio 0
    v_mfma_f32_4x4x4_16b_bf16 v[80:83], v[8:9], v[106:107], 0
    v_mfma_f32_4x4x4_16b_bf16 v[76:79], v[8:9], v[104:105], 0
    v_cmp_lt_u32 s[48:49], v5, v95
    s_nop 2
    v_pk_mul_f32 v[80:81], v[80:81], v[14:15] op_sel:[0,1] op_sel_hi:[1,1]
    v_pk_mul_f32 v[82:83], v[82:83], v[14:15] op_sel:[0,1] op_sel_hi:[1,1]
    v_pk_mul_f32 v[76:77], v[76:77], v[14:15] op_sel:[0,0] op_sel_hi:[1,0]
    v_pk_mul_f32 v[78:79], v[78:79], v[14:15] op_sel:[0,0] op_sel_hi:[1,0]
    s_add_u32 s40, s40, 0x50000
    v_and_b32 v47, 0x0fffffff, v31
    buffer_load_dword v30, v47, s[8:11], 0 offen offset:16
    s_mov_b64 exec, s[6:7]
    v_add_u32 v47, 8, v47
    v_lshrrev_b32 v31, 2, v31
    s_mov_b64 exec, -1
    buffer_load_dwordx2 v[28:29], v47, s[8:11], 0 offen
    s_waitcnt vmcnt(8)
    v_and_b32 v46, 0x80000000, v43
    v_lshrrev_b32 v47, 14, v37
    v_bitop3_b32 v47, v47, v5, v46 bitop3:0xea
    ds_read_b64 v[106:107], v47
    v_and_b32 v99, 0x40000000, v43
    v_lshrrev_b32 v47, 14, v36
    v_bitop3_b32 v47, v47, v5, v99 bitop3:0xea
    ds_read_b64 v[104:105], v47
    v_and_b32 v46, 0x20000000, v43
    v_lshrrev_b32 v47, 14, v35
    v_bitop3_b32 v47, v47, v5, v46 bitop3:0xea
    ds_read_b64 v[102:103], v47
    v_and_b32 v99, 0x10000000, v43
    v_lshrrev_b32 v47, 14, v34
    v_bitop3_b32 v47, v47, v5, v99 bitop3:0xea
    ds_read_b64 v[100:101], v47
    s_waitcnt lgkmcnt(4)
    v_cmp_ne_u64 s[50:51], v[72:73], v[68:69]
    v_cmpx_ne_u64 s[54:55], v[74:75], v[70:71]
    s_and_b64 s[82:83], s[54:55], s[80:81]
    s_cbranch_scc1 L2_c77
L2_d77:
    v_mov_b64 v[84:85], v[70:71]
    v_mov_b32 v7, v93
    v_mov_b64 v[86:87], v[74:75]
    s_or_b64 s[80:81], s[80:81], s[54:55]
    s_mov_b64 exec, s[50:51]
    s_and_b64 s[82:83], s[50:51], s[80:81]
    s_cbranch_scc1 L2_c78
L2_d78:
    v_mov_b64 v[84:85], v[68:69]
    v_mov_b32 v7, v92
    v_mov_b64 v[86:87], v[72:73]
    s_mov_b64 exec, -1
    s_or_b64 s[80:81], s[80:81], s[50:51]
    s_and_b64 exec, s[48:49], s[80:81]
    v_mfma_f32_4x4x4_16b_bf16 v[80:83], v[12:13], v[84:85], 0
    v_mov_b32 v95, v7
    s_andn2_b64 s[80:81], s[80:81], s[48:49]
    v_mfma_f32_4x4x4_16b_bf16 v[80:83], v[10:11], v[86:87], v[80:83]
    s_mov_b64 exec, -1
    ds_read_b64 v[70:71], v95 offset:65408
    ds_read_b64 v[68:69], v94 offset:65408
    v_bitop3_b32 v92, v34, v5, v99 bitop3:0xea
    v_bitop3_b32 v93, v35, v5, v46 bitop3:0xea
    v_perm_b32 v15, v35, v38, s45
    v_bitop3_b32 v46, v35, 0.5, -0.5 bitop3:0xa8
    v_perm_b32 v14, v34, v38, s44
    v_bitop3_b32 v47, v34, 0.5, -0.5 bitop3:0xa8
    v_bitop3_b32 v15, v6, v15, v46 bitop3:0xca
    v_bitop3_b32 v14, v6, v14, v47 bitop3:0xca
    s_waitcnt lgkmcnt(1)
    v_mfma_f32_4x4x4_16b_bf16 v[80:83], v[10:11], v[70:71], v[80:83]
    s_waitcnt lgkmcnt(0)
    v_mfma_f32_4x4x4_16b_bf16 v[76:79], v[10:11], v[68:69], v[76:79]
    s_nop 2
    v_cvt_pk_bf16_f32 v80, v80, v81
    v_cvt_pk_bf16_f32 v81, v82, v83
    ds_wrxchg_rtn_b64 v[74:75], v95, v[80:81] offset:65408
    v_cvt_pk_bf16_f32 v76, v76, v77
    v_cvt_pk_bf16_f32 v77, v78, v79
    ds_wrxchg_rtn_b64 v[72:73], v94, v[76:77] offset:65408
    s_barrier
    s_setprio 3
    s_mov_b32 m0, s100
    s_nop 0
    ds_write_addtid_b32 v124 offset:34816
    ds_write_addtid_b32 v125 offset:35072
    ds_write_addtid_b32 v126 offset:35328
    ds_write_addtid_b32 v127 offset:35584
    s_add_u32 s3, s40, 4096
    buffer_load_dwordx4 v[124:127], v3, s[16:19], s3 offen sc1
    ds_write_addtid_b32 v116 offset:32768
    ds_write_addtid_b32 v117 offset:33024
    ds_write_addtid_b32 v118 offset:33280
    ds_write_addtid_b32 v119 offset:33536
    buffer_load_dwordx4 v[116:119], v3, s[16:19], s40 offen offset:2048 sc1
    ds_write_addtid_b32 v120 offset:33792
    ds_write_addtid_b32 v121 offset:34048
    ds_write_addtid_b32 v122 offset:34304
    ds_write_addtid_b32 v123 offset:34560
    buffer_load_dwordx4 v[120:123], v3, s[16:19], s40 offen offset:3072 sc1
    v_mfma_f32_4x4x4_16b_bf16 v[80:83], v[8:9], v[102:103], 0
    v_mfma_f32_4x4x4_16b_bf16 v[76:79], v[8:9], v[100:101], 0
    s_nop 3
    v_pk_mul_f32 v[80:81], v[80:81], v[14:15] op_sel:[0,1] op_sel_hi:[1,1]
    v_pk_mul_f32 v[82:83], v[82:83], v[14:15] op_sel:[0,1] op_sel_hi:[1,1]
    v_pk_mul_f32 v[76:77], v[76:77], v[14:15] op_sel:[0,0] op_sel_hi:[1,0]
    v_pk_mul_f32 v[78:79], v[78:79], v[14:15] op_sel:[0,0] op_sel_hi:[1,0]
    s_cmp_gt_u32 s37, 1024
    s_cbranch_scc1 L2_xs79
    s_cmp_lg_u32 s101, 0
    s_cbranch_scc1 L2_xa79
L2_xb79:
    v_lshlrev_b32 v89, 16, v96
    v_add_u32 v90, 60, v97
    v_bitop3_b32 v90, v89, v45, v90 bitop3:0x6a
    ds_write_b32 v98, v90 offset:12
    v_lshlrev_b32 v89, 20, v96
    v_add_u32 v90, 40, v97
    v_bitop3_b32 v90, v89, v45, v90 bitop3:0x6a
    ds_write_b32 v98, v90 offset:8
    v_lshlrev_b32 v89, 24, v96
    v_add_u32 v90, 20, v97
    v_bitop3_b32 v90, v89, v45, v90 bitop3:0x6a
    ds_write_b32 v98, v90 offset:4
    v_lshlrev_b32 v89, 28, v96
    v_bitop3_b32 v90, v89, v45, v97 bitop3:0x6a
    ds_write_b32 v98, v90 offset:0
    v_mov_b32_dpp v91, v66 quad_perm:[0,0,0,0] row_mask:0xf bank_mask:0xf
    v_and_b32 v89, 3, v91
    v_and_b32 v97, 0xfffc, v91
    v_sub_u16_dpp v88, v66, v91 quad_perm:[2,2,2,2] row_mask:0xf bank_mask:0xf
    v_mad_u32_u24 v97, v97, 5, v4
    v_add_u32 v99, v88, v89
    v_bfm_b32 v96, v88, v89
    v_cmp_lt_u32 s[58:59], 16, v99
    v_lshlrev_b32 v89, v1, v96
    v_and_b32 v89, v45, v89
    v_cmp_ne_u32 vcc, 0, v89
    v_xor_b32 v90, v97, v89
    s_add_u32 s3, s37, s38
    v_mbcnt_lo_u32_b32 v98, vcc_lo, 0
    v_mbcnt_hi_u32_b32 v98, vcc_hi, v98
    s_bcnt1_i32_b64 s41, vcc
    v_lshl_add_u32 v98, v98, 2, s3
    s_lshl2_add_u32 s37, s41, s37
    s_mov_b64 exec, vcc
    ds_write_b32 v98, v90
    s_mov_b64 exec, -1
    s_cmp_lg_u64 s[58:59], 0
    s_cbranch_scc1 L2_xe79
L2_xr79:
    v_add_u32 v98, s37, v0
    v_mov_b32 v90, -1
    ds_write_b32 v98, v90
L2_xw79:
    s_setprio 2
    s_waitcnt lgkmcnt(14)
    v_cmp_ne_u64 s[50:51], v[72:73], v[68:69]
    v_cmpx_ne_u64 s[54:55], v[74:75], v[70:71]
    s_and_b64 s[82:83], s[54:55], s[80:81]
    s_cbranch_scc1 L2_c80
L2_d80:
    v_mov_b64 v[84:85], v[70:71]
    v_mov_b32 v7, v95
    v_mov_b64 v[86:87], v[74:75]
    s_or_b64 s[80:81], s[80:81], s[54:55]
    s_mov_b64 exec, s[50:51]
    s_and_b64 s[82:83], s[50:51], s[80:81]
    s_cbranch_scc1 L2_c81
L2_d81:
    v_mov_b64 v[84:85], v[68:69]
    v_mov_b32 v7, v94
    v_mov_b64 v[86:87], v[72:73]
    s_mov_b64 exec, -1
    s_or_b64 s[80:81], s[80:81], s[50:51]
    ds_read_b64 v[70:71], v93 offset:65408
    ds_read_b64 v[68:69], v92 offset:65408
    v_and_b32 v46, 0x40000000, v43
    v_bitop3_b32 v94, v36, v5, v46 bitop3:0xea
    v_and_b32 v46, 0x80000000, v43
    v_bitop3_b32 v95, v37, v5, v46 bitop3:0xea
    v_perm_b32 v15, v37, v38, s47
    v_bitop3_b32 v46, v37, 0.5, -0.5 bitop3:0xa8
    v_perm_b32 v14, v36, v38, s46
    v_bitop3_b32 v47, v36, 0.5, -0.5 bitop3:0xa8
    v_bitop3_b32 v15, v6, v15, v46 bitop3:0xca
    v_bitop3_b32 v14, v6, v14, v47 bitop3:0xca
    s_setprio 1
    s_waitcnt lgkmcnt(1)
    v_mfma_f32_4x4x4_16b_bf16 v[80:83], v[10:11], v[70:71], v[80:83]
    s_waitcnt lgkmcnt(0)
    v_mfma_f32_4x4x4_16b_bf16 v[76:79], v[10:11], v[68:69], v[76:79]
    s_nop 2
    v_cvt_pk_bf16_f32 v80, v80, v81
    v_cvt_pk_bf16_f32 v81, v82, v83
    ds_wrxchg_rtn_b64 v[74:75], v93, v[80:81] offset:65408
    v_cvt_pk_bf16_f32 v76, v76, v77
    v_cvt_pk_bf16_f32 v77, v78, v79
    ds_wrxchg_rtn_b64 v[72:73], v92, v[76:77] offset:65408
    ds_read_b32 v40, v0 offset:0
    ds_read_b32 v41, v0 offset:256
    ds_read_b32 v42, v44 offset:768
    ds_read_b32 v43, v0 offset:512
    s_sub_u32 s3, s37, 768
    s_cmp_gt_u32 s3, 128
    s_cbranch_scc1 L2_xf79
L2_xg79:
    v_and_b32 v88, 0x0fffffff, v39
    buffer_load_dwordx2 v[34:35], v88, s[8:11], 0 offen
    buffer_load_dwordx3 v[36:38], v88, s[8:11], 0 offen offset:8
    s_setprio 0
    s_waitcnt vmcnt(12)
    s_mov_b32 m0, s38
    s_nop 0
    ds_write_addtid_b32 v108 offset:0
    ds_write_addtid_b32 v109 offset:256
    ds_write_addtid_b32 v110 offset:512
    ds_write_addtid_b32 v111 offset:768
    s_waitcnt vmcnt(9)
    ds_write_addtid_b32 v112 offset:1024
    ds_write_addtid_b32 v113 offset:1280
    ds_write_addtid_b32 v114 offset:1536
    ds_write_addtid_b32 v115 offset:1792
    v_mfma_f32_4x4x4_16b_bf16 v[80:83], v[8:9], v[106:107], 0
    v_mfma_f32_4x4x4_16b_bf16 v[76:79], v[8:9], v[104:105], 0
    v_cmp_lt_u32 s[84:85], v5, v94
    s_nop 2
    v_pk_mul_f32 v[80:81], v[80:81], v[14:15] op_sel:[0,1] op_sel_hi:[1,1]
    v_pk_mul_f32 v[82:83], v[82:83], v[14:15] op_sel:[0,1] op_sel_hi:[1,1]
    v_pk_mul_f32 v[76:77], v[76:77], v[14:15] op_sel:[0,0] op_sel_hi:[1,0]
    v_pk_mul_f32 v[78:79], v[78:79], v[14:15] op_sel:[0,0] op_sel_hi:[1,0]
    s_add_u32 s42, s42, 1
    s_waitcnt lgkmcnt(0)
    s_barrier
    s_bitcmp1_b32 s36, s42
    s_cbranch_scc1 L2_slow
L2_ret4:
    s_setprio 3
    s_bitcmp1_b32 s43, s42
    s_cbranch_scc1 L2_oa82
L2_ob82:
    v_and_b32 v46, 0x20000000, v21
    v_lshrrev_b32 v47, 14, v17
    v_bitop3_b32 v47, v47, v5, v46 bitop3:0xea
    ds_read_b64 v[102:103], v47
    v_and_b32 v99, 0x10000000, v21
    v_lshrrev_b32 v47, 14, v16
    v_bitop3_b32 v47, v47, v5, v99 bitop3:0xea
    ds_read_b64 v[100:101], v47
    v_cmp_ne_u64 s[50:51], v[72:73], v[68:69]
    v_cmpx_ne_u64 s[54:55], v[74:75], v[70:71]
    s_and_b64 s[82:83], s[54:55], s[80:81]
    s_cbranch_scc1 L2_c83
L2_d83:
    v_mov_b64 v[84:85], v[70:71]
    v_mov_b32 v7, v93
    v_mov_b64 v[86:87], v[74:75]
    s_or_b64 s[80:81], s[80:81], s[54:55]
    s_mov_b64 exec, s[50:51]
    s_and_b64 s[82:83], s[50:51], s[80:81]
    s_cbranch_scc1 L2_c84
L2_d84:
    v_mov_b64 v[84:85], v[68:69]
    v_mov_b32 v7, v92
    v_mov_b64 v[86:87], v[72:73]
    s_mov_b64 exec, -1
    s_or_b64 s[80:81], s[80:81], s[50:51]
    s_and_b64 exec, s[84:85], s[80:81]
    v_mfma_f32_4x4x4_16b_bf16 v[76:79], v[12:13], v[84:85], 0
    v_mov_b32 v94, v7
    s_andn2_b64 s[80:81], s[80:81], s[84:85]
    v_mfma_f32_4x4x4_16b_bf16 v[76:79], v[10:11], v[86:87], v[76:79]
    s_mov_b64 exec, -1
    ds_read_b64 v[70:71], v95 offset:65408
    ds_read_b64 v[68:69], v94 offset:65408
    v_bitop3_b32 v92, v16, v5, v99 bitop3:0xea
    v_bitop3_b32 v93, v17, v5, v46 bitop3:0xea
    v_perm_b32 v15, v17, v20, s45
    v_bitop3_b32 v46, v17, 0.5, -0.5 bitop3:0xa8
    v_perm_b32 v14, v16, v20, s44
    v_bitop3_b32 v47, v16, 0.5, -0.5 bitop3:0xa8
    v_bitop3_b32 v15, v6, v15, v46 bitop3:0xca
    v_bitop3_b32 v14, v6, v14, v47 bitop3:0xca
    s_waitcnt lgkmcnt(1)
    v_mfma_f32_4x4x4_16b_bf16 v[80:83], v[10:11], v[70:71], v[80:83]
    s_waitcnt lgkmcnt(0)
    v_mfma_f32_4x4x4_16b_bf16 v[76:79], v[10:11], v[68:69], v[76:79]
    s_nop 2
    v_cvt_pk_bf16_f32 v80, v80, v81
    v_cvt_pk_bf16_f32 v81, v82, v83
    ds_wrxchg_rtn_b64 v[74:75], v95, v[80:81] offset:65408
    v_cvt_pk_bf16_f32 v76, v76, v77
    v_cvt_pk_bf16_f32 v77, v78, v79
    ds_wrxchg_rtn_b64 v[72:73], v94, v[76:77] offset:65408
    v_mfma_f32_4x4x4_16b_bf16 v[80:83], v[8:9], v[102:103], 0
    v_mfma_f32_4x4x4_16b_bf16 v[76:79], v[8:9], v[100:101], 0
    v_cmp_lt_u32 s[84:85], v5, v92
    s_nop 2
    v_pk_mul_f32 v[80:81], v[80:81], v[14:15] op_sel:[0,1] op_sel_hi:[1,1]
    v_pk_mul_f32 v[82:83], v[82:83], v[14:15] op_sel:[0,1] op_sel_hi:[1,1]
    v_pk_mul_f32 v[76:77], v[76:77], v[14:15] op_sel:[0,0] op_sel_hi:[1,0]
    v_pk_mul_f32 v[78:79], v[78:79], v[14:15] op_sel:[0,0] op_sel_hi:[1,0]
    buffer_load_dwordx4 v[108:111], v3, s[16:19], s40 offen offset:0 sc1
    v_and_b32 v46, 0x80000000, v21
    v_lshrrev_b32 v47, 14, v19
    v_bitop3_b32 v47, v47, v5, v46 bitop3:0xea
    ds_read_b64 v[106:107], v47
    v_and_b32 v99, 0x40000000, v21
    v_lshrrev_b32 v47, 14, v18
    v_bitop3_b32 v47, v47, v5, v99 bitop3:0xea
    ds_read_b64 v[104:105], v47
    s_waitcnt lgkmcnt(2)
    v_cmp_ne_u64 s[50:51], v[72:73], v[68:69]
    v_cmpx_ne_u64 s[54:55], v[74:75], v[70:71]
    s_and_b64 s[82:83], s[54:55], s[80:81]
    s_cbranch_scc1 L2_c85
L2_d85:
    v_mov_b64 v[84:85], v[70:71]
    v_mov_b32 v7, v95
    v_mov_b64 v[86:87], v[74:75]
    s_or_b64 s[80:81], s[80:81], s[54:55]
    s_mov_b64 exec, s[50:51]
    s_and_b64 s[82:83], s[50:51], s[80:81]
    s_cbranch_scc1 L2_c86
L2_d86:
    v_mov_b64 v[84:85], v[68:69]
    v_mov_b32 v7, v94
    v_mov_b64 v[86:87], v[72:73]
    s_mov_b64 exec, -1
    s_or_b64 s[80:81], s[80:81], s[50:51]
    s_and_b64 exec, s[84:85], s[80:81]
    v_mfma_f32_4x4x4_16b_bf16 v[76:79], v[12:13], v[84:85], 0
    v_mov_b32 v92, v7
    s_andn2_b64 s[80:81], s[80:81], s[84:85]
    v_mfma_f32_4x4x4_16b_bf16 v[76:79], v[10:11], v[86:87], v[76:79]
    s_mov_b64 exec, -1
    ds_read_b64 v[70:71], v93 offset:65408
    ds_read_b64 v[68:69], v92 offset:65408
    v_bitop3_b32 v94, v18, v5, v99 bitop3:0xea
    v_bitop3_b32 v95, v19, v5, v46 bitop3:0xea
    v_perm_b32 v15, v19, v20, s47
    v_bitop3_b32 v46, v19, 0.5, -0.5 bitop3:0xa8
    v_perm_b32 v14, v18, v20, s46
    v_bitop3_b32 v47, v18, 0.5, -0.5 bitop3:0xa8
    v_bitop3_b32 v15, v6, v15, v46 bitop3:0xca
    v_bitop3_b32 v14, v6, v14, v47 bitop3:0xca
    s_waitcnt lgkmcnt(1)
    v_mfma_f32_4x4x4_16b_bf16 v[80:83], v[10:11], v[70:71], v[80:83]
    s_waitcnt lgkmcnt(0)
    v_mfma_f32_4x4x4_16b_bf16 v[76:79], v[10:11], v[68:69], v[76:79]
    s_nop 2
    v_cvt_pk_bf16_f32 v80, v80, v81
    v_cvt_pk_bf16_f32 v81, v82, v83
    ds_wrxchg_rtn_b64 v[74:75], v93, v[80:81] offset:65408
    v_cvt_pk_bf16_f32 v76, v76, v77
    v_cvt_pk_bf16_f32 v77, v78, v79
    ds_wrxchg_rtn_b64 v[72:73], v92, v[76:77] offset:65408
    v_and_b32 v88, 0x0fffffff, v40
    buffer_load_dwordx2 v[16:17], v88, s[8:11], 0 offen
    buffer_load_dwordx3 v[18:20], v88, s[8:11], 0 offen offset:8
    s_setprio 2
    v_mfma_f32_4x4x4_16b_bf16 v[80:83], v[8:9], v[106:107], 0
    v_mfma_f32_4x4x4_16b_bf16 v[76:79], v[8:9], v[104:105], 0
    v_cmp_lt_u32 s[48:49], v5, v95
    s_nop 2
    v_pk_mul_f32 v[80:81], v[80:81], v[14:15] op_sel:[0,1] op_sel_hi:[1,1]
    v_pk_mul_f32 v[82:83], v[82:83], v[14:15] op_sel:[0,1] op_sel_hi:[1,1]
    v_pk_mul_f32 v[76:77], v[76:77], v[14:15] op_sel:[0,0] op_sel_hi:[1,0]
    v_pk_mul_f32 v[78:79], v[78:79], v[14:15] op_sel:[0,0] op_sel_hi:[1,0]
    s_waitcnt vmcnt(10)
    v_and_b32 v46, 0x20000000, v27
    v_lshrrev_b32 v47, 14, v23
    v_bitop3_b32 v47, v47, v5, v46 bitop3:0xea
    ds_read_b64 v[102:103], v47
    v_and_b32 v99, 0x10000000, v27
    v_lshrrev_b32 v47, 14, v22
    v_bitop3_b32 v47, v47, v5, v99 bitop3:0xea
    ds_read_b64 v[100:101], v47
    s_waitcnt lgkmcnt(2)
    v_cmp_ne_u64 s[50:51], v[72:73], v[68:69]
    v_cmpx_ne_u64 s[54:55], v[74:75], v[70:71]
    s_and_b64 s[82:83], s[54:55], s[80:81]
    s_cbranch_scc1 L2_c87
L2_d87:
    v_mov_b64 v[84:85], v[70:71]
    v_mov_b32 v7, v93
    v_mov_b64 v[86:87], v[74:75]
    s_or_b64 s[80:81], s[80:81], s[54:55]
    s_mov_b64 exec, s[50:51]
    s_and_b64 s[82:83], s[50:51], s[80:81]
    s_cbranch_scc1 L2_c88
L2_d88:
    v_mov_b64 v[84:85], v[68:69]
    v_mov_b32 v7, v92
    v_mov_b64 v[86:87], v[72:73]
    s_mov_b64 exec, -1
    s_or_b64 s[80:81], s[80:81], s[50:51]
    s_and_b64 exec, s[48:49], s[80:81]
    v_mfma_f32_4x4x4_16b_bf16 v[80:83], v[12:13], v[84:85], 0
    v_mov_b32 v95, v7
    s_andn2_b64 s[80:81], s[80:81], s[48:49]
    v_mfma_f32_4x4x4_16b_bf16 v[80:83], v[10:11], v[86:87], v[80:83]
    s_mov_b64 exec, -1
    ds_read_b64 v[70:71], v95 offset:65408
    ds_read_b64 v[68:69], v94 offset:65408
    v_bitop3_b32 v92, v22, v5, v99 bitop3:0xea
    v_bitop3_b32 v93, v23, v5, v46 bitop3:0xea
    v_perm_b32 v15, v23, v26, s45
    v_bitop3_b32 v46, v23, 0.5, -0.5 bitop3:0xa8
    v_perm_b32 v14, v22, v26, s44
    v_bitop3_b32 v47, v22, 0.5, -0.5 bitop3:0xa8
    v_bitop3_b32 v15, v6, v15, v46 bitop3:0xca
    v_bitop3_b32 v14, v6, v14, v47 bitop3:0xca
    s_waitcnt lgkmcnt(1)
    v_mfma_f32_4x4x4_16b_bf16 v[80:83], v[10:11], v[70:71], v[80:83]
    s_waitcnt lgkmcnt(0)
    v_mfma_f32_4x4x4_16b_bf16 v[76:79], v[10:11], v[68:69], v[76:79]
    s_nop 2
    v_cvt_pk_bf16_f32 v80, v80, v81
    v_cvt_pk_bf16_f32 v81, v82, v83
    ds_wrxchg_rtn_b64 v[74:75], v95, v[80:81] offset:65408
    v_cvt_pk_bf16_f32 v76, v76, v77
    v_cvt_pk_bf16_f32 v77, v78, v79
    ds_wrxchg_rtn_b64 v[72:73], v94, v[76:77] offset:65408
    s_setprio 1
    v_mfma_f32_4x4x4_16b_bf16 v[80:83], v[8:9], v[102:103], 0
    v_mfma_f32_4x4x4_16b_bf16 v[76:79], v[8:9], v[100:101], 0
    s_nop 3
    v_pk_mul_f32 v[80:81], v[80:81], v[14:15] op_sel:[0,1] op_sel_hi:[1,1]
    v_pk_mul_f32 v[82:83], v[82:83], v[14:15] op_sel:[0,1] op_sel_hi:[1,1]
    v_pk_mul_f32 v[76:77], v[76:77], v[14:15] op_sel:[0,0] op_sel_hi:[1,0]
    v_pk_mul_f32 v[78:79], v[78:79], v[14:15] op_sel:[0,0] op_sel_hi:[1,0]
    s_bitcmp1_b32 s43, s42
    s_cbranch_scc1 L2_oa89
L2_ob89:
    buffer_load_dwordx4 v[112:115], v3, s[16:19], s40 offen offset:1024 sc1
    v_sub_u16 v88, v60, v52
    v_and_b32 v89, 3, v52
    v_add3_u32 v99, v88, v89, 3
    v_and_b32 v99, -4, v99
    v_max_u32 v99, 4, v99
    v_and_b32 v97, 0xfffc, v52
    v_bfm_b32 v96, v88, v89
    v_add_u32_dpp v91, v99, v99 row_shr:1 row_mask:0xf bank_mask:0xf bound_ctrl:1
    v_mad_u32_u24 v97, v97, 5, v2
    v_cmp_lt_u32 vcc, 16, v99
    v_add_u32_dpp v91, v91, v91 row_shr:2 row_mask:0xf bank_mask:0xf bound_ctrl:1
    v_sub_u32 v98, s38, v99
    v_lshrrev_b64 v[52:53], 16, v[52:53]
    v_add_u32_dpp v91, v91, v91 row_shr:4 row_mask:0xf bank_mask:0xf bound_ctrl:1
    v_lshrrev_b64 v[60:61], 16, v[60:61]
    s_mov_b32 s101, 0
    v_add_u32_dpp v91, v91, v91 row_shr:8 row_mask:0xf bank_mask:0xf bound_ctrl:1
    s_nop 1
    v_add_u32_dpp v91, v91, v91 row_bcast:15 row_mask:0xa bank_mask:0xf
    s_nop 1
    v_add_u32_dpp v91, v91, v91 row_bcast:31 row_mask:0xc bank_mask:0xf
    v_add_u32 v98, v98, v91
    v_readlane_b32 s37, v91, 63
    s_cbranch_vccnz L2_xo90
L2_xp90:
    v_and_b32 v46, 0x80000000, v27
    v_lshrrev_b32 v47, 14, v25
    v_bitop3_b32 v47, v47, v5, v46 bitop3:0xea
    ds_read_b64 v[106:107], v47
    v_and_b32 v99, 0x40000000, v27
    v_lshrrev_b32 v47, 14, v24
    v_bitop3_b32 v47, v47, v5, v99 bitop3:0xea
    ds_read_b64 v[104:105], v47
    s_waitcnt lgkmcnt(2)
    v_cmp_ne_u64 s[50:51], v[72:73], v[68:69]
    v_cmpx_ne_u64 s[54:55], v[74:75], v[70:71]
    s_and_b64 s[82:83], s[54:55], s[80:81]
    s_cbranch_scc1 L2_c91
L2_d91:
    v_mov_b64 v[84:85], v[70:71]
    v_mov_b32 v7, v95
    v_mov_b64 v[86:87], v[74:75]
    s_or_b64 s[80:81], s[80:81], s[54:55]
    s_mov_b64 exec, s[50:51]
    s_and_b64 s[82:83], s[50:51], s[80:81]
    s_cbranch_scc1 L2_c92
L2_d92:
    v_mov_b64 v[84:85], v[68:69]
    v_mov_b32 v7, v94
    v_mov_b64 v[86:87], v[72:73]
    s_mov_b64 exec, -1
    s_or_b64 s[80:81], s[80:81], s[50:51]
    ds_read_b64 v[70:71], v93 offset:65408
    ds_read_b64 v[68:69], v92 offset:65408
    v_bitop3_b32 v94, v24, v5, v99 bitop3:0xea
    v_bitop3_b32 v95, v25, v5, v46 bitop3:0xea
    v_perm_b32 v15, v25, v26, s47
    v_bitop3_b32 v46, v25, 0.5, -0.5 bitop3:0xa8
    v_perm_b32 v14, v24, v26, s46
    v_bitop3_b32 v47, v24, 0.5, -0.5 bitop3:0xa8
    v_bitop3_b32 v15, v6, v15, v46 bitop3:0xca
    v_bitop3_b32 v14, v6, v14, v47 bitop3:0xca
    s_waitcnt lgkmcnt(1)
    v_mfma_f32_4x4x4_16b_bf16 v[80:83], v[10:11], v[70:71], v[80:83]
    s_waitcnt lgkmcnt(0)
    v_mfma_f32_4x4x4_16b_bf16 v[76:79], v[10:11], v[68:69], v[76:79]
    s_nop 2
    v_cvt_pk_bf16_f32 v80, v80, v81
    v_cvt_pk_bf16_f32 v81, v82, v83
    ds_wrxchg_rtn_b64 v[74:75], v93, v[80:81] offset:65408
    v_cvt_pk_bf16_f32 v76, v76, v77
    v_cvt_pk_bf16_f32 v77, v78, v79
    ds_wrxchg_rtn_b64 v[72:73], v92, v[76:77] offset:65408
    v_and_b32 v88, 0x0fffffff, v41
    buffer_load_dwordx2 v[22:23], v88, s[8:11], 0 offen
    buffer_load_dwordx3 v[24:26], v88, s[8:11], 0 offen offset:8
    v_mfma_f32_4x4x4_16b_bf16 v[80:83], v[8:9], v[106:107], 0
    v_mfma_f32_4x4x4_16b_bf16 v[76:79], v[8:9], v[104:105], 0
    v_cmp_lt_u32 s[84:85], v5, v94
    s_nop 2
    v_pk_mul_f32 v[80:81], v[80:81], v[14:15] op_sel:[0,1] op_sel_hi:[1,1]
    v_pk_mul_f32 v[82:83], v[82:83], v[14:15] op_sel:[0,1] op_sel_hi:[1,1]
    v_pk_mul_f32 v[76:77], v[76:77], v[14:15] op_sel:[0,0] op_sel_hi:[1,0]
    v_pk_mul_f32 v[78:79], v[78:79], v[14:15] op_sel:[0,0] op_sel_hi:[1,0]
    s_waitcnt vmcnt(11)
    s_mov_b64 exec, s[6:7]
    v_lshrrev_b32 v30, 16, v30
    s_mov_b64 exec, -1
    v_and_b32 v46, 0x20000000, v31
    v_lshrrev_b32 v47, 14, v29
    v_bitop3_b32 v47, v47, v5, v46 bitop3:0xea
    ds_read_b64 v[102:103], v47
    v_and_b32 v99, 0x10000000, v31
    v_lshrrev_b32 v47, 14, v28
    v_bitop3_b32 v47, v47, v5, v99 bitop3:0xea
    ds_read_b64 v[100:101], v47
    s_waitcnt lgkmcnt(2)
    v_cmp_ne_u64 s[50:51], v[72:73], v[68:69]
    v_cmpx_ne_u64 s[54:55], v[74:75], v[70:71]
    s_and_b64 s[82:83], s[54:55], s[80:81]
    s_cbranch_scc1 L2_c93
L2_d93:
    v_mov_b64 v[84:85], v[70:71]
    v_mov_b32 v7, v93
    v_mov_b64 v[86:87], v[74:75]
    s_or_b64 s[80:81], s[80:81], s[54:55]
    s_mov_b64 exec, s[50:51]
    s_and_b64 s[82:83], s[50:51], s[80:81]
    s_cbranch_scc1 L2_c94
L2_d94:
    v_mov_b64 v[84:85], v[68:69]
    v_mov_b32 v7, v92
    v_mov_b64 v[86:87], v[72:73]
    s_mov_b64 exec, -1
    s_or_b64 s[80:81], s[80:81], s[50:51]
    s_and_b64 exec, s[84:85], s[80:81]
    v_mfma_f32_4x4x4_16b_bf16 v[76:79], v[12:13], v[84:85], 0
    v_mov_b32 v94, v7
    s_andn2_b64 s[80:81], s[80:81], s[84:85]
    v_mfma_f32_4x4x4_16b_bf16 v[76:79], v[10:11], v[86:87], v[76:79]
    s_mov_b64 exec, -1
    ds_read_b64 v[70:71], v95 offset:65408
    ds_read_b64 v[68:69], v94 offset:65408
    v_bitop3_b32 v92, v28, v5, v99 bitop3:0xea
    v_bitop3_b32 v93, v29, v5, v46 bitop3:0xea
    v_perm_b32 v15, v29, v30, s45
    v_bitop3_b32 v46, v29, 0.5, -0.5 bitop3:0xa8
    v_perm_b32 v14, v28, v30, s44
    v_bitop3_b32 v47, v28, 0.5, -0.5 bitop3:0xa8
    v_bitop3_b32 v15, v6, v15, v46 bitop3:0xca
    v_bitop3_b32 v14, v6, v14, v47 bitop3:0xca
    s_waitcnt lgkmcnt(1)
    v_mfma_f32_4x4x4_16b_bf16 v[80:83], v[10:11], v[70:71], v[80:83]
    s_waitcnt lgkmcnt(0)
    v_mfma_f32_4x4x4_16b_bf16 v[76:79], v[10:11], v[68:69], v[76:79]
    s_nop 2
    v_cvt_pk_bf16_f32 v80, v80, v81
    v_cvt_pk_bf16_f32 v81, v82, v83
    ds_wrxchg_rtn_b64 v[74:75], v95, v[80:81] offset:65408
    v_cvt_pk_bf16_f32 v76, v76, v77
    v_cvt_pk_bf16_f32 v77, v78, v79
    ds_wrxchg_rtn_b64 v[72:73], v94, v[76:77] offset:65408
    s_setprio 0
    v_mfma_f32_4x4x4_16b_bf16 v[80:83], v[8:9], v[102:103], 0
    v_mfma_f32_4x4x4_16b_bf16 v[76:79], v[8:9], v[100:101], 0
    v_cmp_lt_u32 s[48:49], v5, v93
    s_nop 2
    v_pk_mul_f32 v[80:81], v[80:81], v[14:15] op_sel:[0,1] op_sel_hi:[1,1]
    v_pk_mul_f32 v[82:83], v[82:83], v[14:15] op_sel:[0,1] op_sel_hi:[1,1]
    v_pk_mul_f32 v[76:77], v[76:77], v[14:15] op_sel:[0,0] op_sel_hi:[1,0]
    v_pk_mul_f32 v[78:79], v[78:79], v[14:15] op_sel:[0,0] op_sel_hi:[1,0]
    s_add_u32 s40, s40, 0x50000
    v_and_b32 v47, 0x0fffffff, v42
    buffer_load_dword v30, v47, s[8:11], 0 offen offset:16
    s_mov_b64 exec, s[6:7]
    v_add_u32 v47, 8, v47
    v_lshrrev_b32 v42, 2, v42
    s_mov_b64 exec, -1
    buffer_load_dwordx2 v[28:29], v47, s[8:11], 0 offen
    s_waitcnt vmcnt(8)
    v_and_b32 v46, 0x80000000, v39
    v_lshrrev_b32 v47, 14, v37
    v_bitop3_b32 v47, v47, v5, v46 bitop3:0xea
    ds_read_b64 v[102:103], v47
    v_and_b32 v99, 0x40000000, v39
    v_lshrrev_b32 v47, 14, v36
    v_bitop3_b32 v47, v47, v5, v99 bitop3:0xea
    ds_read_b64 v[100:101], v47
    v_and_b32 v46, 0x20000000, v39
    v_lshrrev_b32 v47, 14, v35
    v_bitop3_b32 v47, v47, v5, v46 bitop3:0xea
    ds_read_b64 v[106:107], v47
    v_and_b32 v99, 0x10000000, v39
    v_lshrrev_b32 v47, 14, v34
    v_bitop3_b32 v47, v47, v5, v99 bitop3:0xea
    ds_read_b64 v[104:105], v47
    s_waitcnt lgkmcnt(4)
    v_cmp_ne_u64 s[50:51], v[72:73], v[68:69]
    v_cmpx_ne_u64 s[54:55], v[74:75], v[70:71]
    s_and_b64 s[82:83], s[54:55], s[80:81]
    s_cbranch_scc1 L2_c95
L2_d95:
    v_mov_b64 v[84:85], v[70:71]
    v_mov_b32 v7, v95
    v_mov_b64 v[86:87], v[74:75]
    s_or_b64 s[80:81], s[80:81], s[54:55]
    s_mov_b64 exec, s[50:51]
    s_and_b64 s[82:83], s[50:51], s[80:81]
    s_cbranch_scc1 L2_c96
L2_d96:
    v_mov_b64 v[84:85], v[68:69]
    v_mov_b32 v7, v94
    v_mov_b64 v[86:87], v[72:73]
    s_mov_b64 exec, -1
    s_or_b64 s[80:81], s[80:81], s[50:51]
    s_and_b64 exec, s[48:49], s[80:81]
    v_mfma_f32_4x4x4_16b_bf16 v[80:83], v[12:13], v[84:85], 0
    v_mov_b32 v93, v7
    s_andn2_b64 s[80:81], s[80:81], s[48:49]
    v_mfma_f32_4x4x4_16b_bf16 v[80:83], v[10:11], v[86:87], v[80:83]
    s_mov_b64 exec, -1
    ds_read_b64 v[70:71], v93 offset:65408
    ds_read_b64 v[68:69], v92 offset:65408
    v_bitop3_b32 v94, v34, v5, v99 bitop3:0xea
    v_bitop3_b32 v95, v35, v5, v46 bitop3:0xea
    v_perm_b32 v15, v35, v38, s45
    v_bitop3_b32 v46, v35, 0.5, -0.5 bitop3:0xa8
    v_perm_b32 v14, v34, v38, s44
    v_bitop3_b32 v47, v34, 0.5, -0.5 bitop3:0xa8
    v_bitop3_b32 v15, v6, v15, v46 bitop3:0xca
    v_bitop3_b32 v14, v6, v14, v47 bitop3:0xca
    s_waitcnt lgkmcnt(1)
    v_mfma_f32_4x4x4_16b_bf16 v[80:83], v[10:11], v[70:71], v[80:83]
    s_waitcnt lgkmcnt(0)
    v_mfma_f32_4x4x4_16b_bf16 v[76:79], v[10:11], v[68:69], v[76:79]
    s_nop 2
    v_cvt_pk_bf16_f32 v80, v80, v81
    v_cvt_pk_bf16_f32 v81, v82, v83
    ds_wrxchg_rtn_b64 v[74:75], v93, v[80:81] offset:65408
    v_cvt_pk_bf16_f32 v76, v76, v77
    v_cvt_pk_bf16_f32 v77, v78, v79
    ds_wrxchg_rtn_b64 v[72:73], v92, v[76:77] offset:65408
    s_barrier
    s_setprio 3
    s_mov_b32 m0, s100
    s_nop 0
    ds_write_addtid_b32 v124 offset:34816
    ds_write_addtid_b32 v125 offset:35072
    ds_write_addtid_b32 v126 offset:35328
    ds_write_addtid_b32 v127 offset:35584
    s_add_u32 s3, s40, 4096
    buffer_load_dwordx4 v[124:127], v3, s[16:19], s3 offen sc1
    ds_write_addtid_b32 v116 offset:32768
    ds_write_addtid_b32 v117 offset:33024
    ds_write_addtid_b32 v118 offset:33280
    ds_write_addtid_b32 v119 offset:33536
    buffer_load_dwordx4 v[116:119], v3, s[16:19], s40 offen offset:2048 sc1
    ds_write_addtid_b32 v120 offset:33792
    ds_write_addtid_b32 v121 offset:34048
    ds_write_addtid_b32 v122 offset:34304
    ds_write_addtid_b32 v123 offset:34560
    buffer_load_dwordx4 v[120:123], v3, s[16:19], s40 offen offset:3072 sc1
    v_mfma_f32_4x4x4_16b_bf16 v[80:83], v[8:9], v[106:107], 0
    v_mfma_f32_4x4x4_16b_bf16 v[76:79], v[8:9], v[104:105], 0
    s_nop 3
    v_pk_mul_f32 v[80:81], v[80:81], v[14:15] op_sel:[0,1] op_sel_hi:[1,1]
    v_pk_mul_f32 v[82:83], v[82:83], v[14:15] op_sel:[0,1] op_sel_hi:[1,1]
    v_pk_mul_f32 v[76:77], v[76:77], v[14:15] op_sel:[0,0] op_sel_hi:[1,0]
    v_pk_mul_f32 v[78:79], v[78:79], v[14:15] op_sel:[0,0] op_sel_hi:[1,0]
    s_cmp_gt_u32 s37, 1024
    s_cbranch_scc1 L2_xs97
    s_cmp_lg_u32 s101, 0
    s_cbranch_scc1 L2_xa97
L2_xb97:
    v_lshlrev_b32 v89, 16, v96
    v_add_u32 v90, 60, v97
    v_bitop3_b32 v90, v89, v45, v90 bitop3:0x6a
    ds_write_b32 v98, v90 offset:12
    v_lshlrev_b32 v89, 20, v96
    v_add_u32 v90, 40, v97
    v_bitop3_b32 v90, v89, v45, v90 bitop3:0x6a
    ds_write_b32 v98, v90 offset:8
    v_lshlrev_b32 v89, 24, v96
    v_add_u32 v90, 20, v97
    v_bitop3_b32 v90, v89, v45, v90 bitop3:0x6a
    ds_write_b32 v98, v90 offset:4
    v_lshlrev_b32 v89, 28, v96
    v_bitop3_b32 v90, v89, v45, v97 bitop3:0x6a
    ds_write_b32 v98, v90 offset:0
    v_mov_b32_dpp v91, v64 quad_perm:[1,1,1,1] row_mask:0xf bank_mask:0xf
    v_and_b32 v89, 3, v91
    v_and_b32 v97, 0xfffc, v91
    v_sub_u16_dpp v88, v64, v91 quad_perm:[3,3,3,3] row_mask:0xf bank_mask:0xf
    v_mad_u32_u24 v97, v97, 5, v4
    v_add_u32 v99, v88, v89
    v_bfm_b32 v96, v88, v89
    v_cmp_lt_u32 s[58:59], 16, v99
    v_lshlrev_b32 v89, v1, v96
    v_and_b32 v89, v45, v89
    v_cmp_ne_u32 vcc, 0, v89
    v_xor_b32 v90, v97, v89
    s_add_u32 s3, s37, s38
    v_mbcnt_lo_u32_b32 v98, vcc_lo, 0
    v_mbcnt_hi_u32_b32 v98, vcc_hi, v98
    s_bcnt1_i32_b64 s41, vcc
    v_lshl_add_u32 v98, v98, 2, s3
    s_lshl2_add_u32 s37, s41, s37
    s_mov_b64 exec, vcc
    ds_write_b32 v98, v90
    s_mov_b64 exec, -1
    s_cmp_lg_u64 s[58:59], 0
    s_cbranch_scc1 L2_xe97
L2_xr97:
    v_add_u32 v98, s37, v0
    v_mov_b32 v90, -1
    ds_write_b32 v98, v90
L2_xw97:
    s_setprio 2
    s_waitcnt lgkmcnt(14)
    v_cmp_ne_u64 s[50:51], v[72:73], v[68:69]
    v_cmpx_ne_u64 s[54:55], v[74:75], v[70:71]
    s_and_b64 s[82:83], s[54:55], s[80:81]
    s_cbranch_scc1 L2_c98
L2_d98:
    v_mov_b64 v[84:85], v[70:71]
    v_mov_b32 v7, v93
    v_mov_b64 v[86:87], v[74:75]
    s_or_b64 s[80:81], s[80:81], s[54:55]
    s_mov_b64 exec, s[50:51]
    s_and_b64 s[82:83], s[50:51], s[80:81]
    s_cbranch_scc1 L2_c99
L2_d99:
    v_mov_b64 v[84:85], v[68:69]
    v_mov_b32 v7, v92
    v_mov_b64 v[86:87], v[72:73]
    s_mov_b64 exec, -1
    s_or_b64 s[80:81], s[80:81], s[50:51]
    ds_read_b64 v[70:71], v95 offset:65408
    ds_read_b64 v[68:69], v94 offset:65408
    v_and_b32 v46, 0x40000000, v39
    v_bitop3_b32 v92, v36, v5, v46 bitop3:0xea
    v_and_b32 v46, 0x80000000, v39
    v_bitop3_b32 v93, v37, v5, v46 bitop3:0xea
    v_perm_b32 v15, v37, v38, s47
    v_bitop3_b32 v46, v37, 0.5, -0.5 bitop3:0xa8
    v_perm_b32 v14, v36, v38, s46
    v_bitop3_b32 v47, v36, 0.5, -0.5 bitop3:0xa8
    v_bitop3_b32 v15, v6, v15, v46 bitop3:0xca
    v_bitop3_b32 v14, v6, v14, v47 bitop3:0xca
    s_setprio 1
    s_waitcnt lgkmcnt(1)
    v_mfma_f32_4x4x4_16b_bf16 v[80:83], v[10:11], v[70:71], v[80:83]
    s_waitcnt lgkmcnt(0)
    v_mfma_f32_4x4x4_16b_bf16 v[76:79], v[10:11], v[68:69], v[76:79]
    s_nop 2
    v_cvt_pk_bf16_f32 v80, v80, v81
    v_cvt_pk_bf16_f32 v81, v82, v83
    ds_wrxchg_rtn_b64 v[74:75], v95, v[80:81] offset:65408
    v_cvt_pk_bf16_f32 v76, v76, v77
    v_cvt_pk_bf16_f32 v77, v78, v79
    ds_wrxchg_rtn_b64 v[72:73], v94, v[76:77] offset:65408
    ds_read_b32 v21, v0 offset:0
    ds_read_b32 v27, v0 offset:256
    ds_read_b32 v31, v44 offset:768
    ds_read_b32 v39, v0 offset:512
    s_sub_u32 s3, s37, 768
    s_cmp_gt_u32 s3, 128
    s_cbranch_scc1 L2_xf97
L2_xg97:
    v_and_b32 v88, 0x0fffffff, v43
    buffer_load_dwordx2 v[34:35], v88, s[8:11], 0 offen
    buffer_load_dwordx3 v[36:38], v88, s[8:11], 0 offen offset:8
    s_setprio 0
    s_waitcnt vmcnt(12)
    s_mov_b32 m0, s38
    s_nop 0
    ds_write_addtid_b32 v108 offset:0
    ds_write_addtid_b32 v109 offset:256
    ds_write_addtid_b32 v110 offset:512
    ds_write_addtid_b32 v111 offset:768
    s_waitcnt vmcnt(9)
    ds_write_addtid_b32 v112 offset:1024
    ds_write_addtid_b32 v113 offset:1280
    ds_write_addtid_b32 v114 offset:1536
    ds_write_addtid_b32 v115 offset:1792
    v_mfma_f32_4x4x4_16b_bf16 v[80:83], v[8:9], v[102:103], 0
    v_mfma_f32_4x4x4_16b_bf16 v[76:79], v[8:9], v[100:101], 0
    v_cmp_lt_u32 s[84:85], v5, v92
    s_nop 2
    v_pk_mul_f32 v[80:81], v[80:81], v[14:15] op_sel:[0,1] op_sel_hi:[1,1]
    v_pk_mul_f32 v[82:83], v[82:83], v[14:15] op_sel:[0,1] op_sel_hi:[1,1]
    v_pk_mul_f32 v[76:77], v[76:77], v[14:15] op_sel:[0,0] op_sel_hi:[1,0]
    v_pk_mul_f32 v[78:79], v[78:79], v[14:15] op_sel:[0,0] op_sel_hi:[1,0]
    s_add_u32 s42, s42, 1
    s_waitcnt lgkmcnt(0)
    s_barrier
    s_bitcmp1_b32 s36, s42
    s_cbranch_scc1 L2_slow
L2_ret5:
    s_setprio 3
    s_bitcmp1_b32 s43, s42
    s_cbranch_scc1 L2_oa100
L2_ob100:
    v_and_b32 v46, 0x20000000, v40
    v_lshrrev_b32 v47, 14, v17
    v_bitop3_b32 v47, v47, v5, v46 bitop3:0xea
    ds_read_b64 v[106:107], v47
    v_and_b32 v99, 0x10000000, v40
    v_lshrrev_b32 v47, 14, v16
    v_bitop3_b32 v47, v47, v5, v99 bitop3:0xea
    ds_read_b64 v[104:105], v47
    v_cmp_ne_u64 s[50:51], v[72:73], v[68:69]
    v_cmpx_ne_u64 s[54:55], v[74:75], v[70:71]
    s_and_b64 s[82:83], s[54:55], s[80:81]
    s_cbranch_scc1 L2_c101
L2_d101:
    v_mov_b64 v[84:85], v[70:71]
    v_mov_b32 v7, v95
    v_mov_b64 v[86:87], v[74:75]
    s_or_b64 s[80:81], s[80:81], s[54:55]
    s_mov_b64 exec, s[50:51]
    s_and_b64 s[82:83], s[50:51], s[80:81]
    s_cbranch_scc1 L2_c102
L2_d102:
    v_mov_b64 v[84:85], v[68:69]
    v_mov_b32 v7, v94
    v_mov_b64 v[86:87], v[72:73]
    s_mov_b64 exec, -1
    s_or_b64 s[80:81], s[80:81], s[50:51]
    s_and_b64 exec, s[84:85], s[80:81]
    v_mfma_f32_4x4x4_16b_bf16 v[76:79], v[12:13], v[84:85], 0
    v_mov_b32 v92, v7
    s_andn2_b64 s[80:81], s[80:81], s[84:85]
    v_mfma_f32_4x4x4_16b_bf16 v[76:79], v[10:11], v[86:87], v[76:79]
    s_mov_b64 exec, -1
    ds_read_b64 v[70:71], v93 offset:65408
    ds_read_b64 v[68:69], v92 offset:65408
    v_bitop3_b32 v94, v16, v5, v99 bitop3:0xea
    v_bitop3_b32 v95, v17, v5, v46 bitop3:0xea
    v_perm_b32 v15, v17, v20, s45
    v_bitop3_b32 v46, v17, 0.5, -0.5 bitop3:0xa8
    v_perm_b32 v14, v16, v20, s44
    v_bitop3_b32 v47, v16, 0.5, -0.5 bitop3:0xa8
    v_bitop3_b32 v15, v6, v15, v46 bitop3:0xca
    v_bitop3_b32 v14, v6, v14, v47 bitop3:0xca
    s_waitcnt lgkmcnt(1)
    v_mfma_f32_4x4x4_16b_bf16 v[80:83], v[10:11], v[70:71], v[80:83]
    s_waitcnt lgkmcnt(0)
    v_mfma_f32_4x4x4_16b_bf16 v[76:79], v[10:11], v[68:69], v[76:79]
    s_nop 2
    v_cvt_pk_bf16_f32 v80, v80, v81
    v_cvt_pk_bf16_f32 v81, v82, v83
    ds_wrxchg_rtn_b64 v[74:75], v93, v[80:81] offset:65408
    v_cvt_pk_bf16_f32 v76, v76, v77
    v_cvt_pk_bf16_f32 v77, v78, v79
    ds_wrxchg_rtn_b64 v[72:73], v92, v[76:77] offset:65408
    v_mfma_f32_4x4x4_16b_bf16 v[80:83], v[8:9], v[106:107], 0
    v_mfma_f32_4x4x4_16b_bf16 v[76:79], v[8:9], v[104:105], 0
    v_cmp_lt_u32 s[84:85], v5, v94
    s_nop 2
    v_pk_mul_f32 v[80:81], v[80:81], v[14:15] op_sel:[0,1] op_sel_hi:[1,1]
    v_pk_mul_f32 v[82:83], v[82:83], v[14:15] op_sel:[0,1] op_sel_hi:[1,1]
    v_pk_mul_f32 v[76:77], v[76:77], v[14:15] op_sel:[0,0] op_sel_hi:[1,0]
    v_pk_mul_f32 v[78:79], v[78:79], v[14:15] op_sel:[0,0] op_sel_hi:[1,0]
    buffer_load_dwordx4 v[108:111], v3, s[16:19], s40 offen offset:0 sc1
    v_and_b32 v46, 0x80000000, v40
    v_lshrrev_b32 v47, 14, v19
    v_bitop3_b32 v47, v47, v5, v46 bitop3:0xea
    ds_read_b64 v[102:103], v47
    v_and_b32 v99, 0x40000000, v40
    v_lshrrev_b32 v47, 14, v18
    v_bitop3_b32 v47, v47, v5, v99 bitop3:0xea
    ds_read_b64 v[100:101], v47
    s_waitcnt lgkmcnt(2)
    v_cmp_ne_u64 s[50:51], v[72:73], v[68:69]
    v_cmpx_ne_u64 s[54:55], v[74:75], v[70:71]
    s_and_b64 s[82:83], s[54:55], s[80:81]
    s_cbranch_scc1 L2_c103
L2_d103:
    v_mov_b64 v[84:85], v[70:71]
    v_mov_b32 v7, v93
    v_mov_b64 v[86:87], v[74:75]
    s_or_b64 s[80:81], s[80:81], s[54:55]
    s_mov_b64 exec, s[50:51]
    s_and_b64 s[82:83], s[50:51], s[80:81]
    s_cbranch_scc1 L2_c104
L2_d104:
    v_mov_b64 v[84:85], v[68:69]
    v_mov_b32 v7, v92
    v_mov_b64 v[86:87], v[72:73]
    s_mov_b64 exec, -1
    s_or_b64 s[80:81], s[80:81], s[50:51]
    s_and_b64 exec, s[84:85], s[80:81]
    v_mfma_f32_4x4x4_16b_bf16 v[76:79], v[12:13], v[84:85], 0
    v_mov_b32 v94, v7
    s_andn2_b64 s[80:81], s[80:81], s[84:85]
    v_mfma_f32_4x4x4_16b_bf16 v[76:79], v[10:11], v[86:87], v[76:79]
    s_mov_b64 exec, -1
    ds_read_b64 v[70:71], v95 offset:65408
    ds_read_b64 v[68:69], v94 offset:65408
    v_bitop3_b32 v92, v18, v5, v99 bitop3:0xea
    v_bitop3_b32 v93, v19, v5, v46 bitop3:0xea
    v_perm_b32 v15, v19, v20, s47
    v_bitop3_b32 v46, v19, 0.5, -0.5 bitop3:0xa8
    v_perm_b32 v14, v18, v20, s46
    v_bitop3_b32 v47, v18, 0.5, -0.5 bitop3:0xa8
    v_bitop3_b32 v15, v6, v15, v46 bitop3:0xca
    v_bitop3_b32 v14, v6, v14, v47 bitop3:0xca
    s_waitcnt lgkmcnt(1)
    v_mfma_f32_4x4x4_16b_bf16 v[80:83], v[10:11], v[70:71], v[80:83]
    s_waitcnt lgkmcnt(0)
    v_mfma_f32_4x4x4_16b_bf16 v[76:79], v[10:11], v[68:69], v[76:79]
    s_nop 2
    v_cvt_pk_bf16_f32 v80, v80, v81
    v_cvt_pk_bf16_f32 v81, v82, v83
    ds_wrxchg_rtn_b64 v[74:75], v95, v[80:81] offset:65408
    v_cvt_pk_bf16_f32 v76, v76, v77
    v_cvt_pk_bf16_f32 v77, v78, v79
    ds_wrxchg_rtn_b64 v[72:73], v94, v[76:77] offset:65408
    v_and_b32 v88, 0x0fffffff, v21
    buffer_load_dwordx2 v[16:17], v88, s[8:11], 0 offen
    buffer_load_dwordx3 v[18:20], v88, s[8:11], 0 offen offset:8
    s_setprio 2
    v_mfma_f32_4x4x4_16b_bf16 v[80:83], v[8:9], v[102:103], 0
    v_mfma_f32_4x4x4_16b_bf16 v[76:79], v[8:9], v[100:101], 0
    v_cmp_lt_u32 s[48:49], v5, v93
    s_nop 2
    v_pk_mul_f32 v[80:81], v[80:81], v[14:15] op_sel:[0,1] op_sel_hi:[1,1]
    v_pk_mul_f32 v[82:83], v[82:83], v[14:15] op_sel:[0,1] op_sel_hi:[1,1]
    v_pk_mul_f32 v[76:77], v[76:77], v[14:15] op_sel:[0,0] op_sel_hi:[1,0]
    v_pk_mul_f32 v[78:79], v[78:79], v[14:15] op_sel:[0,0] op_sel_hi:[1,0]
    s_waitcnt vmcnt(10)
    v_and_b32 v46, 0x20000000, v41
    v_lshrrev_b32 v47, 14, v23
    v_bitop3_b32 v47, v47, v5, v46 bitop3:0xea
    ds_read_b64 v[106:107], v47
    v_and_b32 v99, 0x10000000, v41
    v_lshrrev_b32 v47, 14, v22
    v_bitop3_b32 v47, v47, v5, v99 bitop3:0xea
    ds_read_b64 v[104:105], v47
    s_waitcnt lgkmcnt(2)
    v_cmp_ne_u64 s[50:51], v[72:73], v[68:69]
    v_cmpx_ne_u64 s[54:55], v[74:75], v[70:71]
    s_and_b64 s[82:83], s[54:55], s[80:81]
    s_cbranch_scc1 L2_c105
L2_d105:
    v_mov_b64 v[84:85], v[70:71]
    v_mov_b32 v7, v95
    v_mov_b64 v[86:87], v[74:75]
    s_or_b64 s[80:81], s[80:81], s[54:55]
    s_mov_b64 exec, s[50:51]
    s_and_b64 s[82:83], s[50:51], s[80:81]
    s_cbranch_scc1 L2_c106
L2_d106:
    v_mov_b64 v[84:85], v[68:69]
    v_mov_b32 v7, v94
    v_mov_b64 v[86:87], v[72:73]
    s_mov_b64 exec, -1
    s_or_b64 s[80:81], s[80:81], s[50:51]
    s_and_b64 exec, s[48:49], s[80:81]
    v_mfma_f32_4x4x4_16b_bf16 v[80:83], v[12:13], v[84:85], 0
    v_mov_b32 v93, v7
    s_andn2_b64 s[80:81], s[80:81], s[48:49]
    v_mfma_f32_4x4x4_16b_bf16 v[80:83], v[10:11], v[86:87], v[80:83]
    s_mov_b64 exec, -1
    ds_read_b64 v[70:71], v93 offset:65408
    ds_read_b64 v[68:69], v92 offset:65408
    v_bitop3_b32 v94, v22, v5, v99 bitop3:0xea
    v_bitop3_b32 v95, v23, v5, v46 bitop3:0xea
    v_perm_b32 v15, v23, v26, s45
    v_bitop3_b32 v46, v23, 0.5, -0.5 bitop3:0xa8
    v_perm_b32 v14, v22, v26, s44
    v_bitop3_b32 v47, v22, 0.5, -0.5 bitop3:0xa8
    v_bitop3_b32 v15, v6, v15, v46 bitop3:0xca
    v_bitop3_b32 v14, v6, v14, v47 bitop3:0xca
    s_waitcnt lgkmcnt(1)
    v_mfma_f32_4x4x4_16b_bf16 v[80:83], v[10:11], v[70:71], v[80:83]
    s_waitcnt lgkmcnt(0)
    v_mfma_f32_4x4x4_16b_bf16 v[76:79], v[10:11], v[68:69], v[76:79]
    s_nop 2
    v_cvt_pk_bf16_f32 v80, v80, v81
    v_cvt_pk_bf16_f32 v81, v82, v83
    ds_wrxchg_rtn_b64 v[74:75], v93, v[80:81] offset:65408
    v_cvt_pk_bf16_f32 v76, v76, v77
    v_cvt_pk_bf16_f32 v77, v78, v79
    ds_wrxchg_rtn_b64 v[72:73], v92, v[76:77] offset:65408
    s_setprio 1
    v_mfma_f32_4x4x4_16b_bf16 v[80:83], v[8:9], v[106:107], 0
    v_mfma_f32_4x4x4_16b_bf16 v[76:79], v[8:9], v[104:105], 0
    s_nop 3
    v_pk_mul_f32 v[80:81], v[80:81], v[14:15] op_sel:[0,1] op_sel_hi:[1,1]
    v_pk_mul_f32 v[82:83], v[82:83], v[14:15] op_sel:[0,1] op_sel_hi:[1,1]
    v_pk_mul_f32 v[76:77], v[76:77], v[14:15] op_sel:[0,0] op_sel_hi:[1,0]
    v_pk_mul_f32 v[78:79], v[78:79], v[14:15] op_sel:[0,0] op_sel_hi:[1,0]
    s_bitcmp1_b32 s43, s42
    s_cbranch_scc1 L2_oa107
L2_ob107:
    buffer_load_dwordx4 v[112:115], v3, s[16:19], s40 offen offset:1024 sc1
    v_sub_u16 v88, v62, v54
    v_and_b32 v89, 3, v54
    v_add3_u32 v99, v88, v89, 3
    v_and_b32 v99, -4, v99
    v_max_u32 v99, 4, v99
    v_and_b32 v97, 0xfffc, v54
    v_bfm_b32 v96, v88, v89
    v_add_u32_dpp v91, v99, v99 row_shr:1 row_mask:0xf bank_mask:0xf bound_ctrl:1
    v_mad_u32_u24 v97, v97, 5, v2
    v_cmp_lt_u32 vcc, 16, v99
    v_add_u32_dpp v91, v91, v91 row_shr:2 row_mask:0xf bank_mask:0xf bound_ctrl:1
    v_sub_u32 v98, s38, v99
    v_lshrrev_b64 v[54:55], 16, v[54:55]
    v_add_u32_dpp v91, v91, v91 row_shr:4 row_mask:0xf bank_mask:0xf bound_ctrl:1
    v_lshrrev_b64 v[62:63], 16, v[62:63]
    s_mov_b32 s101, 0
    v_add_u32_dpp v91, v91, v91 row_shr:8 row_mask:0xf bank_mask:0xf bound_ctrl:1
    s_nop 1
    v_add_u32_dpp v91, v91, v91 row_bcast:15 row_mask:0xa bank_mask:0xf
    s_nop 1
    v_add_u32_dpp v91, v91, v91 row_bcast:31 row_mask:0xc bank_mask:0xf
    v_add_u32 v98, v98, v91
    v_readlane_b32 s37, v91, 63
    s_cbranch_vccnz L2_xo108
L2_xp108:
    v_and_b32 v46, 0x80000000, v41
    v_lshrrev_b32 v47, 14, v25
    v_bitop3_b32 v47, v47, v5, v46 bitop3:0xea
    ds_read_b64 v[102:103], v47
    v_and_b32 v99, 0x40000000, v41
    v_lshrrev_b32 v47, 14, v24
    v_bitop3_b32 v47, v47, v5, v99 bitop3:0xea
    ds_read_b64 v[100:101], v47
    s_waitcnt lgkmcnt(2)
    v_cmp_ne_u64 s[50:51], v[72:73], v[68:69]
    v_cmpx_ne_u64 s[54:55], v[74:75], v[70:71]
    s_and_b64 s[82:83], s[54:55], s[80:81]
    s_cbranch_scc1 L2_c109
L2_d109:
    v_mov_b64 v[84:85], v[70:71]
    v_mov_b32 v7, v93
    v_mov_b64 v[86:87], v[74:75]
    s_or_b64 s[80:81], s[80:81], s[54:55]
    s_mov_b64 exec, s[50:51]
    s_and_b64 s[82:83], s[50:51], s[80:81]
    s_cbranch_scc1 L2_c110
L2_d110:
    v_mov_b64 v[84:85], v[68:69]
    v_mov_b32 v7, v92
    v_mov_b64 v[86:87], v[72:73]
    s_mov_b64 exec, -1
    s_or_b64 s[80:81], s[80:81], s[50:51]
    ds_read_b64 v[70:71], v95 offset:65408
    ds_read_b64 v[68:69], v94 offset:65408
    v_bitop3_b32 v92, v24, v5, v99 bitop3:0xea
    v_bitop3_b32 v93, v25, v5, v46 bitop3:0xea
    v_perm_b32 v15, v25, v26, s47
    v_bitop3_b32 v46, v25, 0.5, -0.5 bitop3:0xa8
    v_perm_b32 v14, v24, v26, s46
    v_bitop3_b32 v47, v24, 0.5, -0.5 bitop3:0xa8
    v_bitop3_b32 v15, v6, v15, v46 bitop3:0xca
    v_bitop3_b32 v14, v6, v14, v47 bitop3:0xca
    s_waitcnt lgkmcnt(1)
    v_mfma_f32_4x4x4_16b_bf16 v[80:83], v[10:11], v[70:71], v[80:83]
    s_waitcnt lgkmcnt(0)
    v_mfma_f32_4x4x4_16b_bf16 v[76:79], v[10:11], v[68:69], v[76:79]
    s_nop 2
    v_cvt_pk_bf16_f32 v80, v80, v81
    v_cvt_pk_bf16_f32 v81, v82, v83
    ds_wrxchg_rtn_b64 v[74:75], v95, v[80:81] offset:65408
    v_cvt_pk_bf16_f32 v76, v76, v77
    v_cvt_pk_bf16_f32 v77, v78, v79
    ds_wrxchg_rtn_b64 v[72:73], v94, v[76:77] offset:65408
    v_and_b32 v88, 0x0fffffff, v27
    buffer_load_dwordx2 v[22:23], v88, s[8:11], 0 offen
    buffer_load_dwordx3 v[24:26], v88, s[8:11], 0 offen offset:8
    v_mfma_f32_4x4x4_16b_bf16 v[80:83], v[8:9], v[102:103], 0
    v_mfma_f32_4x4x4_16b_bf16 v[76:79], v[8:9], v[100:101], 0
    v_cmp_lt_u32 s[84:85], v5, v92
    s_nop 2
    v_pk_mul_f32 v[80:81], v[80:81], v[14:15] op_sel:[0,1] op_sel_hi:[1,1]
    v_pk_mul_f32 v[82:83], v[82:83], v[14:15] op_sel:[0,1] op_sel_hi:[1,1]
    v_pk_mul_f32 v[76:77], v[76:77], v[14:15] op_sel:[0,0] op_sel_hi:[1,0]
    v_pk_mul_f32 v[78:79], v[78:79], v[14:15] op_sel:[0,0] op_sel_hi:[1,0]
    s_waitcnt vmcnt(11)
    s_mov_b64 exec, s[6:7]
    v_lshrrev_b32 v30, 16, v30
    s_mov_b64 exec, -1
    v_and_b32 v46, 0x20000000, v42
    v_lshrrev_b32 v47, 14, v29
    v_bitop3_b32 v47, v47, v5, v46 bitop3:0xea
    ds_read_b64 v[106:107], v47
    v_and_b32 v99, 0x10000000, v42
    v_lshrrev_b32 v47, 14, v28
    v_bitop3_b32 v47, v47, v5, v99 bitop3:0xea
    ds_read_b64 v[104:105], v47
    s_waitcnt lgkmcnt(2)
    v_cmp_ne_u64 s[50:51], v[72:73], v[68:69]
    v_cmpx_ne_u64 s[54:55], v[74:75], v[70:71]
    s_and_b64 s[82:83], s[54:55], s[80:81]
    s_cbranch_scc1 L2_c111
L2_d111:
    v_mov_b64 v[84:85], v[70:71]
    v_mov_b32 v7, v95
    v_mov_b64 v[86:87], v[74:75]
    s_or_b64 s[80:81], s[80:81], s[54:55]
    s_mov_b64 exec, s[50:51]
    s_and_b64 s[82:83], s[50:51], s[80:81]
    s_cbranch_scc1 L2_c112
L2_d112:
    v_mov_b64 v[84:85], v[68:69]
    v_mov_b32 v7, v94
    v_mov_b64 v[86:87], v[72:73]
    s_mov_b64 exec, -1
    s_or_b64 s[80:81], s[80:81], s[50:51]
    s_and_b64 exec, s[84:85], s[80:81]
    v_mfma_f32_4x4x4_16b_bf16 v[76:79], v[12:13], v[84:85], 0
    v_mov_b32 v92, v7
    s_andn2_b64 s[80:81], s[80:81], s[84:85]
    v_mfma_f32_4x4x4_16b_bf16 v[76:79], v[10:11], v[86:87], v[76:79]
    s_mov_b64 exec, -1
    ds_read_b64 v[70:71], v93 offset:65408
    ds_read_b64 v[68:69], v92 offset:65408
    v_bitop3_b32 v94, v28, v5, v99 bitop3:0xea
    v_bitop3_b32 v95, v29, v5, v46 bitop3:0xea
    v_perm_b32 v15, v29, v30, s45
    v_bitop3_b32 v46, v29, 0.5, -0.5 bitop3:0xa8
    v_perm_b32 v14, v28, v30, s44
    v_bitop3_b32 v47, v28, 0.5, -0.5 bitop3:0xa8
    v_bitop3_b32 v15, v6, v15, v46 bitop3:0xca
    v_bitop3_b32 v14, v6, v14, v47 bitop3:0xca
    s_waitcnt lgkmcnt(1)
    v_mfma_f32_4x4x4_16b_bf16 v[80:83], v[10:11], v[70:71], v[80:83]
    s_waitcnt lgkmcnt(0)
    v_mfma_f32_4x4x4_16b_bf16 v[76:79], v[10:11], v[68:69], v[76:79]
    s_nop 2
    v_cvt_pk_bf16_f32 v80, v80, v81
    v_cvt_pk_bf16_f32 v81, v82, v83
    ds_wrxchg_rtn_b64 v[74:75], v93, v[80:81] offset:65408
    v_cvt_pk_bf16_f32 v76, v76, v77
    v_cvt_pk_bf16_f32 v77, v78, v79
    ds_wrxchg_rtn_b64 v[72:73], v92, v[76:77] offset:65408
    s_setprio 0
    v_mfma_f32_4x4x4_16b_bf16 v[80:83], v[8:9], v[106:107], 0
    v_mfma_f32_4x4x4_16b_bf16 v[76:79], v[8:9], v[104:105], 0
    v_cmp_lt_u32 s[48:49], v5, v95
    s_nop 2
    v_pk_mul_f32 v[80:81], v[80:81], v[14:15] op_sel:[0,1] op_sel_hi:[1,1]
    v_pk_mul_f32 v[82:83], v[82:83], v[14:15] op_sel:[0,1] op_sel_hi:[1,1]
    v_pk_mul_f32 v[76:77], v[76:77], v[14:15] op_sel:[0,0] op_sel_hi:[1,0]
    v_pk_mul_f32 v[78:79], v[78:79], v[14:15] op_sel:[0,0] op_sel_hi:[1,0]
    s_add_u32 s40, s40, 0x50000
    v_and_b32 v47, 0x0fffffff, v31
    buffer_load_dword v30, v47, s[8:11], 0 offen offset:16
    s_mov_b64 exec, s[6:7]
    v_add_u32 v47, 8, v47
    v_lshrrev_b32 v31, 2, v31
    s_mov_b64 exec, -1
    buffer_load_dwordx2 v[28:29], v47, s[8:11], 0 offen
    s_waitcnt vmcnt(8)
    v_and_b32 v46, 0x80000000, v43
    v_lshrrev_b32 v47, 14, v37
    v_bitop3_b32 v47, v47, v5, v46 bitop3:0xea
    ds_read_b64 v[106:107], v47
    v_and_b32 v99, 0x40000000, v43
    v_lshrrev_b32 v47, 14, v36
    v_bitop3_b32 v47, v47, v5, v99 bitop3:0xea
    ds_read_b64 v[104:105], v47
    v_and_b32 v46, 0x20000000, v43
    v_lshrrev_b32 v47, 14, v35
    v_bitop3_b32 v47, v47, v5, v46 bitop3:0xea
    ds_read_b64 v[102:103], v47
    v_and_b32 v99, 0x10000000, v43
    v_lshrrev_b32 v47, 14, v34
    v_bitop3_b32 v47, v47, v5, v99 bitop3:0xea
    ds_read_b64 v[100:101], v47
    s_waitcnt lgkmcnt(4)
    v_cmp_ne_u64 s[50:51], v[72:73], v[68:69]
    v_cmpx_ne_u64 s[54:55], v[74:75], v[70:71]
    s_and_b64 s[82:83], s[54:55], s[80:81]
    s_cbranch_scc1 L2_c113
L2_d113:
    v_mov_b64 v[84:85], v[70:71]
    v_mov_b32 v7, v93
    v_mov_b64 v[86:87], v[74:75]
    s_or_b64 s[80:81], s[80:81], s[54:55]
    s_mov_b64 exec, s[50:51]
    s_and_b64 s[82:83], s[50:51], s[80:81]
    s_cbranch_scc1 L2_c114
L2_d114:
    v_mov_b64 v[84:85], v[68:69]
    v_mov_b32 v7, v92
    v_mov_b64 v[86:87], v[72:73]
    s_mov_b64 exec, -1
    s_or_b64 s[80:81], s[80:81], s[50:51]
    s_and_b64 exec, s[48:49], s[80:81]
    v_mfma_f32_4x4x4_16b_bf16 v[80:83], v[12:13], v[84:85], 0
    v_mov_b32 v95, v7
    s_andn2_b64 s[80:81], s[80:81], s[48:49]
    v_mfma_f32_4x4x4_16b_bf16 v[80:83], v[10:11], v[86:87], v[80:83]
    s_mov_b64 exec, -1
    ds_read_b64 v[70:71], v95 offset:65408
    ds_read_b64 v[68:69], v94 offset:65408
    v_bitop3_b32 v92, v34, v5, v99 bitop3:0xea
    v_bitop3_b32 v93, v35, v5, v46 bitop3:0xea
    v_perm_b32 v15, v35, v38, s45
    v_bitop3_b32 v46, v35, 0.5, -0.5 bitop3:0xa8
    v_perm_b32 v14, v34, v38, s44
    v_bitop3_b32 v47, v34, 0.5, -0.5 bitop3:0xa8
    v_bitop3_b32 v15, v6, v15, v46 bitop3:0xca
    v_bitop3_b32 v14, v6, v14, v47 bitop3:0xca
    s_waitcnt lgkmcnt(1)
    v_mfma_f32_4x4x4_16b_bf16 v[80:83], v[10:11], v[70:71], v[80:83]
    s_waitcnt lgkmcnt(0)
    v_mfma_f32_4x4x4_16b_bf16 v[76:79], v[10:11], v[68:69], v[76:79]
    s_nop 2
    v_cvt_pk_bf16_f32 v80, v80, v81
    v_cvt_pk_bf16_f32 v81, v82, v83
    ds_wrxchg_rtn_b64 v[74:75], v95, v[80:81] offset:65408
    v_cvt_pk_bf16_f32 v76, v76, v77
    v_cvt_pk_bf16_f32 v77, v78, v79
    ds_wrxchg_rtn_b64 v[72:73], v94, v[76:77] offset:65408
    s_barrier
    s_setprio 3
    s_mov_b32 m0, s100
    s_nop 0
    ds_write_addtid_b32 v124 offset:34816
    ds_write_addtid_b32 v125 offset:35072
    ds_write_addtid_b32 v126 offset:35328
    ds_write_addtid_b32 v127 offset:35584
    s_add_u32 s3, s40, 4096
    buffer_load_dwordx4 v[124:127], v3, s[16:19], s3 offen sc1
    ds_write_addtid_b32 v116 offset:32768
    ds_write_addtid_b32 v117 offset:33024
    ds_write_addtid_b32 v118 offset:33280
    ds_write_addtid_b32 v119 offset:33536
    buffer_load_dwordx4 v[116:119], v3, s[16:19], s40 offen offset:2048 sc1
    ds_write_addtid_b32 v120 offset:33792
    ds_write_addtid_b32 v121 offset:34048
    ds_write_addtid_b32 v122 offset:34304
    ds_write_addtid_b32 v123 offset:34560
    buffer_load_dwordx4 v[120:123], v3, s[16:19], s40 offen offset:3072 sc1
    v_mfma_f32_4x4x4_16b_bf16 v[80:83], v[8:9], v[102:103], 0
    v_mfma_f32_4x4x4_16b_bf16 v[76:79], v[8:9], v[100:101], 0
    s_nop 3
    v_pk_mul_f32 v[80:81], v[80:81], v[14:15] op_sel:[0,1] op_sel_hi:[1,1]
    v_pk_mul_f32 v[82:83], v[82:83], v[14:15] op_sel:[0,1] op_sel_hi:[1,1]
    v_pk_mul_f32 v[76:77], v[76:77], v[14:15] op_sel:[0,0] op_sel_hi:[1,0]
    v_pk_mul_f32 v[78:79], v[78:79], v[14:15] op_sel:[0,0] op_sel_hi:[1,0]
    s_cmp_gt_u32 s37, 1024
    s_cbranch_scc1 L2_xs115
    s_cmp_lg_u32 s101, 0
    s_cbranch_scc1 L2_xa115
L2_xb115:
    v_lshlrev_b32 v89, 16, v96
    v_add_u32 v90, 60, v97
    v_bitop3_b32 v90, v89, v45, v90 bitop3:0x6a
    ds_write_b32 v98, v90 offset:12
    v_lshlrev_b32 v89, 20, v96
    v_add_u32 v90, 40, v97
    v_bitop3_b32 v90, v89, v45, v90 bitop3:0x6a
    ds_write_b32 v98, v90 offset:8
    v_lshlrev_b32 v89, 24, v96
    v_add_u32 v90, 20, v97
    v_bitop3_b32 v90, v89, v45, v90 bitop3:0x6a
    ds_write_b32 v98, v90 offset:4
    v_lshlrev_b32 v89, 28, v96
    v_bitop3_b32 v90, v89, v45, v97 bitop3:0x6a
    ds_write_b32 v98, v90 offset:0
    v_mov_b32_dpp v91, v66 quad_perm:[1,1,1,1] row_mask:0xf bank_mask:0xf
    v_and_b32 v89, 3, v91
    v_and_b32 v97, 0xfffc, v91
    v_sub_u16_dpp v88, v66, v91 quad_perm:[3,3,3,3] row_mask:0xf bank_mask:0xf
    v_mad_u32_u24 v97, v97, 5, v4
    v_add_u32 v99, v88, v89
    v_bfm_b32 v96, v88, v89
    v_cmp_lt_u32 s[58:59], 16, v99
    v_lshlrev_b32 v89, v1, v96
    v_and_b32 v89, v45, v89
    v_cmp_ne_u32 vcc, 0, v89
    v_xor_b32 v90, v97, v89
    s_add_u32 s3, s37, s38
    v_mbcnt_lo_u32_b32 v98, vcc_lo, 0
    v_mbcnt_hi_u32_b32 v98, vcc_hi, v98
    s_bcnt1_i32_b64 s41, vcc
    v_lshl_add_u32 v98, v98, 2, s3
    s_lshl2_add_u32 s37, s41, s37
    s_mov_b64 exec, vcc
    ds_write_b32 v98, v90
    s_mov_b64 exec, -1
    s_cmp_lg_u64 s[58:59], 0
    s_cbranch_scc1 L2_xe115
L2_xr115:
    v_add_u32 v98, s37, v0
    v_mov_b32 v90, -1
    ds_write_b32 v98, v90
L2_xw115:
    s_setprio 2
    s_waitcnt lgkmcnt(14)
    v_cmp_ne_u64 s[50:51], v[72:73], v[68:69]
    v_cmpx_ne_u64 s[54:55], v[74:75], v[70:71]
    s_and_b64 s[82:83], s[54:55], s[80:81]
    s_cbranch_scc1 L2_c116
L2_d116:
    v_mov_b64 v[84:85], v[70:71]
    v_mov_b32 v7, v95
    v_mov_b64 v[86:87], v[74:75]
    s_or_b64 s[80:81], s[80:81], s[54:55]
    s_mov_b64 exec, s[50:51]
    s_and_b64 s[82:83], s[50:51], s[80:81]
    s_cbranch_scc1 L2_c117
L2_d117:
    v_mov_b64 v[84:85], v[68:69]
    v_mov_b32 v7, v94
    v_mov_b64 v[86:87], v[72:73]
    s_mov_b64 exec, -1
    s_or_b64 s[80:81], s[80:81], s[50:51]
    ds_read_b64 v[70:71], v93 offset:65408
    ds_read_b64 v[68:69], v92 offset:65408
    v_and_b32 v46, 0x40000000, v43
    v_bitop3_b32 v94, v36, v5, v46 bitop3:0xea
    v_and_b32 v46, 0x80000000, v43
    v_bitop3_b32 v95, v37, v5, v46 bitop3:0xea
    v_perm_b32 v15, v37, v38, s47
    v_bitop3_b32 v46, v37, 0.5, -0.5 bitop3:0xa8
    v_perm_b32 v14, v36, v38, s46
    v_bitop3_b32 v47, v36, 0.5, -0.5 bitop3:0xa8
    v_bitop3_b32 v15, v6, v15, v46 bitop3:0xca
    v_bitop3_b32 v14, v6, v14, v47 bitop3:0xca
    s_setprio 1
    s_waitcnt lgkmcnt(1)
    v_mfma_f32_4x4x4_16b_bf16 v[80:83], v[10:11], v[70:71], v[80:83]
    s_waitcnt lgkmcnt(0)
    v_mfma_f32_4x4x4_16b_bf16 v[76:79], v[10:11], v[68:69], v[76:79]
    s_nop 2
    v_cvt_pk_bf16_f32 v80, v80, v81
    v_cvt_pk_bf16_f32 v81, v82, v83
    ds_wrxchg_rtn_b64 v[74:75], v93, v[80:81] offset:65408
    v_cvt_pk_bf16_f32 v76, v76, v77
    v_cvt_pk_bf16_f32 v77, v78, v79
    ds_wrxchg_rtn_b64 v[72:73], v92, v[76:77] offset:65408
    ds_read_b32 v40, v0 offset:0
    ds_read_b32 v41, v0 offset:256
    ds_read_b32 v42, v44 offset:768
    ds_read_b32 v43, v0 offset:512
    s_sub_u32 s3, s37, 768
    s_cmp_gt_u32 s3, 128
    s_cbranch_scc1 L2_xf115
L2_xg115:
    v_lshrrev_b64 v[64:65], 16, v[64:65]
    v_lshrrev_b64 v[66:67], 16, v[66:67]
    v_and_b32 v88, 0x0fffffff, v39
    buffer_load_dwordx2 v[34:35], v88, s[8:11], 0 offen
    buffer_load_dwordx3 v[36:38], v88, s[8:11], 0 offen offset:8
    s_setprio 0
    s_waitcnt vmcnt(12)
    s_mov_b32 m0, s38
    s_nop 0
    ds_write_addtid_b32 v108 offset:0
    ds_write_addtid_b32 v109 offset:256
    ds_write_addtid_b32 v110 offset:512
    ds_write_addtid_b32 v111 offset:768
    s_waitcnt vmcnt(9)
    ds_write_addtid_b32 v112 offset:1024
    ds_write_addtid_b32 v113 offset:1280
    ds_write_addtid_b32 v114 offset:1536
    ds_write_addtid_b32 v115 offset:1792
    v_mfma_f32_4x4x4_16b_bf16 v[80:83], v[8:9], v[106:107], 0
    v_mfma_f32_4x4x4_16b_bf16 v[76:79], v[8:9], v[104:105], 0
    v_cmp_lt_u32 s[84:85], v5, v94
    s_nop 2
    v_pk_mul_f32 v[80:81], v[80:81], v[14:15] op_sel:[0,1] op_sel_hi:[1,1]
    v_pk_mul_f32 v[82:83], v[82:83], v[14:15] op_sel:[0,1] op_sel_hi:[1,1]
    v_pk_mul_f32 v[76:77], v[76:77], v[14:15] op_sel:[0,0] op_sel_hi:[1,0]
    v_pk_mul_f32 v[78:79], v[78:79], v[14:15] op_sel:[0,0] op_sel_hi:[1,0]
    s_add_u32 s42, s42, 1
    s_waitcnt lgkmcnt(0)
    s_cmp_lg_u32 s42, 14
    s_cbranch_scc1 L2_loop
    s_barrier
    s_bitcmp1_b32 s36, s42
    s_cbranch_scc1 L2_slow
L2_ret6:
    s_setprio 3
    s_bitcmp1_b32 s43, s42
    s_cbranch_scc1 L2_oa118
L2_ob118:
    v_and_b32 v46, 0x20000000, v21
    v_lshrrev_b32 v47, 14, v17
    v_bitop3_b32 v47, v47, v5, v46 bitop3:0xea
    ds_read_b64 v[102:103], v47
    v_and_b32 v99, 0x10000000, v21
    v_lshrrev_b32 v47, 14, v16
    v_bitop3_b32 v47, v47, v5, v99 bitop3:0xea
    ds_read_b64 v[100:101], v47
    v_cmp_ne_u64 s[50:51], v[72:73], v[68:69]
    v_cmpx_ne_u64 s[54:55], v[74:75], v[70:71]
    s_and_b64 s[82:83], s[54:55], s[80:81]
    s_cbranch_scc1 L2_c119
L2_d119:
    v_mov_b64 v[84:85], v[70:71]
    v_mov_b32 v7, v93
    v_mov_b64 v[86:87], v[74:75]
    s_or_b64 s[80:81], s[80:81], s[54:55]
    s_mov_b64 exec, s[50:51]
    s_and_b64 s[82:83], s[50:51], s[80:81]
    s_cbranch_scc1 L2_c120
L2_d120:
    v_mov_b64 v[84:85], v[68:69]
    v_mov_b32 v7, v92
    v_mov_b64 v[86:87], v[72:73]
    s_mov_b64 exec, -1
    s_or_b64 s[80:81], s[80:81], s[50:51]
    s_and_b64 exec, s[84:85], s[80:81]
    v_mfma_f32_4x4x4_16b_bf16 v[76:79], v[12:13], v[84:85], 0
    v_mov_b32 v94, v7
    s_andn2_b64 s[80:81], s[80:81], s[84:85]
    v_mfma_f32_4x4x4_16b_bf16 v[76:79], v[10:11], v[86:87], v[76:79]
    s_mov_b64 exec, -1
    ds_read_b64 v[70:71], v95 offset:65408
    ds_read_b64 v[68:69], v94 offset:65408
    v_bitop3_b32 v92, v16, v5, v99 bitop3:0xea
    v_bitop3_b32 v93, v17, v5, v46 bitop3:0xea
    v_perm_b32 v15, v17, v20, s45
    v_bitop3_b32 v46, v17, 0.5, -0.5 bitop3:0xa8
    v_perm_b32 v14, v16, v20, s44
    v_bitop3_b32 v47, v16, 0.5, -0.5 bitop3:0xa8
    v_bitop3_b32 v15, v6, v15, v46 bitop3:0xca
    v_bitop3_b32 v14, v6, v14, v47 bitop3:0xca
    s_waitcnt lgkmcnt(1)
    v_mfma_f32_4x4x4_16b_bf16 v[80:83], v[10:11], v[70:71], v[80:83]
    s_waitcnt lgkmcnt(0)
    v_mfma_f32_4x4x4_16b_bf16 v[76:79], v[10:11], v[68:69], v[76:79]
    s_nop 2
    v_cvt_pk_bf16_f32 v80, v80, v81
    v_cvt_pk_bf16_f32 v81, v82, v83
    ds_wrxchg_rtn_b64 v[74:75], v95, v[80:81] offset:65408
    v_cvt_pk_bf16_f32 v76, v76, v77
    v_cvt_pk_bf16_f32 v77, v78, v79
    ds_wrxchg_rtn_b64 v[72:73], v94, v[76:77] offset:65408
    v_mfma_f32_4x4x4_16b_bf16 v[80:83], v[8:9], v[102:103], 0
    v_mfma_f32_4x4x4_16b_bf16 v[76:79], v[8:9], v[100:101], 0
    v_cmp_lt_u32 s[84:85], v5, v92
    s_nop 2
    v_pk_mul_f32 v[80:81], v[80:81], v[14:15] op_sel:[0,1] op_sel_hi:[1,1]
    v_pk_mul_f32 v[82:83], v[82:83], v[14:15] op_sel:[0,1] op_sel_hi:[1,1]
    v_pk_mul_f32 v[76:77], v[76:77], v[14:15] op_sel:[0,0] op_sel_hi:[1,0]
    v_pk_mul_f32 v[78:79], v[78:79], v[14:15] op_sel:[0,0] op_sel_hi:[1,0]
    buffer_load_dwordx4 v[108:111], v3, s[16:19], s40 offen offset:0 sc1
    v_and_b32 v46, 0x80000000, v21
    v_lshrrev_b32 v47, 14, v19
    v_bitop3_b32 v47, v47, v5, v46 bitop3:0xea
    ds_read_b64 v[106:107], v47
    v_and_b32 v99, 0x40000000, v21
    v_lshrrev_b32 v47, 14, v18
    v_bitop3_b32 v47, v47, v5, v99 bitop3:0xea
    ds_read_b64 v[104:105], v47
    s_waitcnt lgkmcnt(2)
    v_cmp_ne_u64 s[50:51], v[72:73], v[68:69]
    v_cmpx_ne_u64 s[54:55], v[74:75], v[70:71]
    s_and_b64 s[82:83], s[54:55], s[80:81]
    s_cbranch_scc1 L2_c121
L2_d121:
    v_mov_b64 v[84:85], v[70:71]
    v_mov_b32 v7, v95
    v_mov_b64 v[86:87], v[74:75]
    s_or_b64 s[80:81], s[80:81], s[54:55]
    s_mov_b64 exec, s[50:51]
    s_and_b64 s[82:83], s[50:51], s[80:81]
    s_cbranch_scc1 L2_c122
L2_d122:
    v_mov_b64 v[84:85], v[68:69]
    v_mov_b32 v7, v94
    v_mov_b64 v[86:87], v[72:73]
    s_mov_b64 exec, -1
    s_or_b64 s[80:81], s[80:81], s[50:51]
    s_and_b64 exec, s[84:85], s[80:81]
    v_mfma_f32_4x4x4_16b_bf16 v[76:79], v[12:13], v[84:85], 0
    v_mov_b32 v92, v7
    s_andn2_b64 s[80:81], s[80:81], s[84:85]
    v_mfma_f32_4x4x4_16b_bf16 v[76:79], v[10:11], v[86:87], v[76:79]
    s_mov_b64 exec, -1
    ds_read_b64 v[70:71], v93 offset:65408
    ds_read_b64 v[68:69], v92 offset:65408
    v_bitop3_b32 v94, v18, v5, v99 bitop3:0xea
    v_bitop3_b32 v95, v19, v5, v46 bitop3:0xea
    v_perm_b32 v15, v19, v20, s47
    v_bitop3_b32 v46, v19, 0.5, -0.5 bitop3:0xa8
    v_perm_b32 v14, v18, v20, s46
    v_bitop3_b32 v47, v18, 0.5, -0.5 bitop3:0xa8
    v_bitop3_b32 v15, v6, v15, v46 bitop3:0xca
    v_bitop3_b32 v14, v6, v14, v47 bitop3:0xca
    s_waitcnt lgkmcnt(1)
    v_mfma_f32_4x4x4_16b_bf16 v[80:83], v[10:11], v[70:71], v[80:83]
    s_waitcnt lgkmcnt(0)
    v_mfma_f32_4x4x4_16b_bf16 v[76:79], v[10:11], v[68:69], v[76:79]
    s_nop 2
    v_cvt_pk_bf16_f32 v80, v80, v81
    v_cvt_pk_bf16_f32 v81, v82, v83
    ds_wrxchg_rtn_b64 v[74:75], v93, v[80:81] offset:65408
    v_cvt_pk_bf16_f32 v76, v76, v77
    v_cvt_pk_bf16_f32 v77, v78, v79
    ds_wrxchg_rtn_b64 v[72:73], v92, v[76:77] offset:65408
    v_and_b32 v88, 0x0fffffff, v40
    buffer_load_dwordx2 v[16:17], v88, s[8:11], 0 offen
    buffer_load_dwordx3 v[18:20], v88, s[8:11], 0 offen offset:8
    s_setprio 2
    v_mfma_f32_4x4x4_16b_bf16 v[80:83], v[8:9], v[106:107], 0
    v_mfma_f32_4x4x4_16b_bf16 v[76:79], v[8:9], v[104:105], 0
    v_cmp_lt_u32 s[48:49], v5, v95
    s_nop 2
    v_pk_mul_f32 v[80:81], v[80:81], v[14:15] op_sel:[0,1] op_sel_hi:[1,1]
    v_pk_mul_f32 v[82:83], v[82:83], v[14:15] op_sel:[0,1] op_sel_hi:[1,1]
    v_pk_mul_f32 v[76:77], v[76:77], v[14:15] op_sel:[0,0] op_sel_hi:[1,0]
    v_pk_mul_f32 v[78:79], v[78:79], v[14:15] op_sel:[0,0] op_sel_hi:[1,0]
    s_waitcnt vmcnt(10)
    v_and_b32 v46, 0x20000000, v27
    v_lshrrev_b32 v47, 14, v23
    v_bitop3_b32 v47, v47, v5, v46 bitop3:0xea
    ds_read_b64 v[102:103], v47
    v_and_b32 v99, 0x10000000, v27
    v_lshrrev_b32 v47, 14, v22
    v_bitop3_b32 v47, v47, v5, v99 bitop3:0xea
    ds_read_b64 v[100:101], v47
    s_waitcnt lgkmcnt(2)
    v_cmp_ne_u64 s[50:51], v[72:73], v[68:69]
    v_cmpx_ne_u64 s[54:55], v[74:75], v[70:71]
    s_and_b64 s[82:83], s[54:55], s[80:81]
    s_cbranch_scc1 L2_c123
L2_d123:
    v_mov_b64 v[84:85], v[70:71]
    v_mov_b32 v7, v93
    v_mov_b64 v[86:87], v[74:75]
    s_or_b64 s[80:81], s[80:81], s[54:55]
    s_mov_b64 exec, s[50:51]
    s_and_b64 s[82:83], s[50:51], s[80:81]
    s_cbranch_scc1 L2_c124
L2_d124:
    v_mov_b64 v[84:85], v[68:69]
    v_mov_b32 v7, v92
    v_mov_b64 v[86:87], v[72:73]
    s_mov_b64 exec, -1
    s_or_b64 s[80:81], s[80:81], s[50:51]
    s_and_b64 exec, s[48:49], s[80:81]
    v_mfma_f32_4x4x4_16b_bf16 v[80:83], v[12:13], v[84:85], 0
    v_mov_b32 v95, v7
    s_andn2_b64 s[80:81], s[80:81], s[48:49]
    v_mfma_f32_4x4x4_16b_bf16 v[80:83], v[10:11], v[86:87], v[80:83]
    s_mov_b64 exec, -1
    ds_read_b64 v[70:71], v95 offset:65408
    ds_read_b64 v[68:69], v94 offset:65408
    v_bitop3_b32 v92, v22, v5, v99 bitop3:0xea
    v_bitop3_b32 v93, v23, v5, v46 bitop3:0xea
    v_perm_b32 v15, v23, v26, s45
    v_bitop3_b32 v46, v23, 0.5, -0.5 bitop3:0xa8
    v_perm_b32 v14, v22, v26, s44
    v_bitop3_b32 v47, v22, 0.5, -0.5 bitop3:0xa8
    v_bitop3_b32 v15, v6, v15, v46 bitop3:0xca
    v_bitop3_b32 v14, v6, v14, v47 bitop3:0xca
    s_waitcnt lgkmcnt(1)
    v_mfma_f32_4x4x4_16b_bf16 v[80:83], v[10:11], v[70:71], v[80:83]
    s_waitcnt lgkmcnt(0)
    v_mfma_f32_4x4x4_16b_bf16 v[76:79], v[10:11], v[68:69], v[76:79]
    s_nop 2
    v_cvt_pk_bf16_f32 v80, v80, v81
    v_cvt_pk_bf16_f32 v81, v82, v83
    ds_wrxchg_rtn_b64 v[74:75], v95, v[80:81] offset:65408
    v_cvt_pk_bf16_f32 v76, v76, v77
    v_cvt_pk_bf16_f32 v77, v78, v79
    ds_wrxchg_rtn_b64 v[72:73], v94, v[76:77] offset:65408
    s_setprio 1
    v_mfma_f32_4x4x4_16b_bf16 v[80:83], v[8:9], v[102:103], 0
    v_mfma_f32_4x4x4_16b_bf16 v[76:79], v[8:9], v[100:101], 0
    s_nop 3
    v_pk_mul_f32 v[80:81], v[80:81], v[14:15] op_sel:[0,1] op_sel_hi:[1,1]
    v_pk_mul_f32 v[82:83], v[82:83], v[14:15] op_sel:[0,1] op_sel_hi:[1,1]
    v_pk_mul_f32 v[76:77], v[76:77], v[14:15] op_sel:[0,0] op_sel_hi:[1,0]
    v_pk_mul_f32 v[78:79], v[78:79], v[14:15] op_sel:[0,0] op_sel_hi:[1,0]
    s_bitcmp1_b32 s43, s42
    s_cbranch_scc1 L2_oa125
L2_ob125:
    buffer_load_dwordx4 v[112:115], v3, s[16:19], s40 offen offset:1024 sc1
    v_and_b32 v46, 0x80000000, v27
    v_lshrrev_b32 v47, 14, v25
    v_bitop3_b32 v47, v47, v5, v46 bitop3:0xea
    ds_read_b64 v[106:107], v47
    v_and_b32 v99, 0x40000000, v27
    v_lshrrev_b32 v47, 14, v24
    v_bitop3_b32 v47, v47, v5, v99 bitop3:0xea
    ds_read_b64 v[104:105], v47
    s_waitcnt lgkmcnt(2)
    v_cmp_ne_u64 s[50:51], v[72:73], v[68:69]
    v_cmpx_ne_u64 s[54:55], v[74:75], v[70:71]
    s_and_b64 s[82:83], s[54:55], s[80:81]
    s_cbranch_scc1 L2_c126
L2_d126:
    v_mov_b64 v[84:85], v[70:71]
    v_mov_b32 v7, v95
    v_mov_b64 v[86:87], v[74:75]
    s_or_b64 s[80:81], s[80:81], s[54:55]
    s_mov_b64 exec, s[50:51]
    s_and_b64 s[82:83], s[50:51], s[80:81]
    s_cbranch_scc1 L2_c127
L2_d127:
    v_mov_b64 v[84:85], v[68:69]
    v_mov_b32 v7, v94
    v_mov_b64 v[86:87], v[72:73]
    s_mov_b64 exec, -1
    s_or_b64 s[80:81], s[80:81], s[50:51]
    ds_read_b64 v[70:71], v93 offset:65408
    ds_read_b64 v[68:69], v92 offset:65408
    v_bitop3_b32 v94, v24, v5, v99 bitop3:0xea
    v_bitop3_b32 v95, v25, v5, v46 bitop3:0xea
    v_perm_b32 v15, v25, v26, s47
    v_bitop3_b32 v46, v25, 0.5, -0.5 bitop3:0xa8
    v_perm_b32 v14, v24, v26, s46
    v_bitop3_b32 v47, v24, 0.5, -0.5 bitop3:0xa8
    v_bitop3_b32 v15, v6, v15, v46 bitop3:0xca
    v_bitop3_b32 v14, v6, v14, v47 bitop3:0xca
    s_waitcnt lgkmcnt(1)
    v_mfma_f32_4x4x4_16b_bf16 v[80:83], v[10:11], v[70:71], v[80:83]
    s_waitcnt lgkmcnt(0)
    v_mfma_f32_4x4x4_16b_bf16 v[76:79], v[10:11], v[68:69], v[76:79]
    s_nop 2
    v_cvt_pk_bf16_f32 v80, v80, v81
    v_cvt_pk_bf16_f32 v81, v82, v83
    ds_wrxchg_rtn_b64 v[74:75], v93, v[80:81] offset:65408
    v_cvt_pk_bf16_f32 v76, v76, v77
    v_cvt_pk_bf16_f32 v77, v78, v79
    ds_wrxchg_rtn_b64 v[72:73], v92, v[76:77] offset:65408
    v_and_b32 v88, 0x0fffffff, v41
    buffer_load_dwordx2 v[22:23], v88, s[8:11], 0 offen
    buffer_load_dwordx3 v[24:26], v88, s[8:11], 0 offen offset:8
    v_mfma_f32_4x4x4_16b_bf16 v[80:83], v[8:9], v[106:107], 0
    v_mfma_f32_4x4x4_16b_bf16 v[76:79], v[8:9], v[104:105], 0
    v_cmp_lt_u32 s[84:85], v5, v94
    s_nop 2
    v_pk_mul_f32 v[80:81], v[80:81], v[14:15] op_sel:[0,1] op_sel_hi:[1,1]
    v_pk_mul_f32 v[82:83], v[82:83], v[14:15] op_sel:[0,1] op_sel_hi:[1,1]
    v_pk_mul_f32 v[76:77], v[76:77], v[14:15] op_sel:[0,0] op_sel_hi:[1,0]
    v_pk_mul_f32 v[78:79], v[78:79], v[14:15] op_sel:[0,0] op_sel_hi:[1,0]
    s_waitcnt vmcnt(11)
    s_mov_b64 exec, s[6:7]
    v_lshrrev_b32 v30, 16, v30
    s_mov_b64 exec, -1
    v_and_b32 v46, 0x20000000, v31
    v_lshrrev_b32 v47, 14, v29
    v_bitop3_b32 v47, v47, v5, v46 bitop3:0xea
    ds_read_b64 v[102:103], v47
    v_and_b32 v99, 0x10000000, v31
    v_lshrrev_b32 v47, 14, v28
    v_bitop3_b32 v47, v47, v5, v99 bitop3:0xea
    ds_read_b64 v[100:101], v47
    s_waitcnt lgkmcnt(2)
    v_cmp_ne_u64 s[50:51], v[72:73], v[68:69]
    v_cmpx_ne_u64 s[54:55], v[74:75], v[70:71]
    s_and_b64 s[82:83], s[54:55], s[80:81]
    s_cbranch_scc1 L2_c128
L2_d128:
    v_mov_b64 v[84:85], v[70:71]
    v_mov_b32 v7, v93
    v_mov_b64 v[86:87], v[74:75]
    s_or_b64 s[80:81], s[80:81], s[54:55]
    s_mov_b64 exec, s[50:51]
    s_and_b64 s[82:83], s[50:51], s[80:81]
    s_cbranch_scc1 L2_c129
L2_d129:
    v_mov_b64 v[84:85], v[68:69]
    v_mov_b32 v7, v92
    v_mov_b64 v[86:87], v[72:73]
    s_mov_b64 exec, -1
    s_or_b64 s[80:81], s[80:81], s[50:51]
    s_and_b64 exec, s[84:85], s[80:81]
    v_mfma_f32_4x4x4_16b_bf16 v[76:79], v[12:13], v[84:85], 0
    v_mov_b32 v94, v7
    s_andn2_b64 s[80:81], s[80:81], s[84:85]
    v_mfma_f32_4x4x4_16b_bf16 v[76:79], v[10:11], v[86:87], v[76:79]
    s_mov_b64 exec, -1
    ds_read_b64 v[70:71], v95 offset:65408
    ds_read_b64 v[68:69], v94 offset:65408
    v_bitop3_b32 v92, v28, v5, v99 bitop3:0xea
    v_bitop3_b32 v93, v29, v5, v46 bitop3:0xea
    v_perm_b32 v15, v29, v30, s45
    v_bitop3_b32 v46, v29, 0.5, -0.5 bitop3:0xa8
    v_perm_b32 v14, v28, v30, s44
    v_bitop3_b32 v47, v28, 0.5, -0.5 bitop3:0xa8
    v_bitop3_b32 v15, v6, v15, v46 bitop3:0xca
    v_bitop3_b32 v14, v6, v14, v47 bitop3:0xca
    s_waitcnt lgkmcnt(1)
    v_mfma_f32_4x4x4_16b_bf16 v[80:83], v[10:11], v[70:71], v[80:83]
    s_waitcnt lgkmcnt(0)
    v_mfma_f32_4x4x4_16b_bf16 v[76:79], v[10:11], v[68:69], v[76:79]
    s_nop 2
    v_cvt_pk_bf16_f32 v80, v80, v81
    v_cvt_pk_bf16_f32 v81, v82, v83
    ds_wrxchg_rtn_b64 v[74:75], v95, v[80:81] offset:65408
    v_cvt_pk_bf16_f32 v76, v76, v77
    v_cvt_pk_bf16_f32 v77, v78, v79
    ds_wrxchg_rtn_b64 v[72:73], v94, v[76:77] offset:65408
    s_setprio 0
    v_mfma_f32_4x4x4_16b_bf16 v[80:83], v[8:9], v[102:103], 0
    v_mfma_f32_4x4x4_16b_bf16 v[76:79], v[8:9], v[100:101], 0
    v_cmp_lt_u32 s[48:49], v5, v93
    s_nop 2
    v_pk_mul_f32 v[80:81], v[80:81], v[14:15] op_sel:[0,1] op_sel_hi:[1,1]
    v_pk_mul_f32 v[82:83], v[82:83], v[14:15] op_sel:[0,1] op_sel_hi:[1,1]
    v_pk_mul_f32 v[76:77], v[76:77], v[14:15] op_sel:[0,0] op_sel_hi:[1,0]
    v_pk_mul_f32 v[78:79], v[78:79], v[14:15] op_sel:[0,0] op_sel_hi:[1,0]
    s_add_u32 s40, s40, 0xfff24000
    v_and_b32 v47, 0x0fffffff, v42
    buffer_load_dword v30, v47, s[8:11], 0 offen offset:16
    s_mov_b64 exec, s[6:7]
    v_add_u32 v47, 8, v47
    v_lshrrev_b32 v42, 2, v42
    s_mov_b64 exec, -1
    buffer_load_dwordx2 v[28:29], v47, s[8:11], 0 offen
    s_waitcnt vmcnt(8)
    v_and_b32 v46, 0x80000000, v39
    v_lshrrev_b32 v47, 14, v37
    v_bitop3_b32 v47, v47, v5, v46 bitop3:0xea
    ds_read_b64 v[102:103], v47
    v_and_b32 v99, 0x40000000, v39
    v_lshrrev_b32 v47, 14, v36
    v_bitop3_b32 v47, v47, v5, v99 bitop3:0xea
    ds_read_b64 v[100:101], v47
    v_and_b32 v46, 0x20000000, v39
    v_lshrrev_b32 v47, 14, v35
    v_bitop3_b32 v47, v47, v5, v46 bitop3:0xea
    ds_read_b64 v[106:107], v47
    v_and_b32 v99, 0x10000000, v39
    v_lshrrev_b32 v47, 14, v34
    v_bitop3_b32 v47, v47, v5, v99 bitop3:0xea
    ds_read_b64 v[104:105], v47
    s_waitcnt lgkmcnt(4)
    v_cmp_ne_u64 s[50:51], v[72:73], v[68:69]
    v_cmpx_ne_u64 s[54:55], v[74:75], v[70:71]
    s_and_b64 s[82:83], s[54:55], s[80:81]
    s_cbranch_scc1 L2_c130
L2_d130:
    v_mov_b64 v[84:85], v[70:71]
    v_mov_b32 v7, v95
    v_mov_b64 v[86:87], v[74:75]
    s_or_b64 s[80:81], s[80:81], s[54:55]
    s_mov_b64 exec, s[50:51]
    s_and_b64 s[82:83], s[50:51], s[80:81]
    s_cbranch_scc1 L2_c131
L2_d131:
    v_mov_b64 v[84:85], v[68:69]
    v_mov_b32 v7, v94
    v_mov_b64 v[86:87], v[72:73]
    s_mov_b64 exec, -1
    s_or_b64 s[80:81], s[80:81], s[50:51]
    s_and_b64 exec, s[48:49], s[80:81]
    v_mfma_f32_4x4x4_16b_bf16 v[80:83], v[12:13], v[84:85], 0
    v_mov_b32 v93, v7
    s_andn2_b64 s[80:81], s[80:81], s[48:49]
    v_mfma_f32_4x4x4_16b_bf16 v[80:83], v[10:11], v[86:87], v[80:83]
    s_mov_b64 exec, -1
    ds_read_b64 v[70:71], v93 offset:65408
    ds_read_b64 v[68:69], v92 offset:65408
    v_bitop3_b32 v94, v34, v5, v99 bitop3:0xea
    v_bitop3_b32 v95, v35, v5, v46 bitop3:0xea
    v_perm_b32 v15, v35, v38, s45
    v_bitop3_b32 v46, v35, 0.5, -0.5 bitop3:0xa8
    v_perm_b32 v14, v34, v38, s44
    v_bitop3_b32 v47, v34, 0.5, -0.5 bitop3:0xa8
    v_bitop3_b32 v15, v6, v15, v46 bitop3:0xca
    v_bitop3_b32 v14, v6, v14, v47 bitop3:0xca
    s_waitcnt lgkmcnt(1)
    v_mfma_f32_4x4x4_16b_bf16 v[80:83], v[10:11], v[70:71], v[80:83]
    s_waitcnt lgkmcnt(0)
    v_mfma_f32_4x4x4_16b_bf16 v[76:79], v[10:11], v[68:69], v[76:79]
    s_nop 2
    v_cvt_pk_bf16_f32 v80, v80, v81
    v_cvt_pk_bf16_f32 v81, v82, v83
    ds_wrxchg_rtn_b64 v[74:75], v93, v[80:81] offset:65408
    v_cvt_pk_bf16_f32 v76, v76, v77
    v_cvt_pk_bf16_f32 v77, v78, v79
    ds_wrxchg_rtn_b64 v[72:73], v92, v[76:77] offset:65408
    s_barrier
    s_setprio 3
    s_mov_b32 m0, s100
    s_nop 0
    ds_write_addtid_b32 v124 offset:34816
    ds_write_addtid_b32 v125 offset:35072
    ds_write_addtid_b32 v126 offset:35328
    ds_write_addtid_b32 v127 offset:35584
    ds_write_addtid_b32 v116 offset:32768
    ds_write_addtid_b32 v117 offset:33024
    ds_write_addtid_b32 v118 offset:33280
    ds_write_addtid_b32 v119 offset:33536
    ds_write_addtid_b32 v120 offset:33792
    ds_write_addtid_b32 v121 offset:34048
    ds_write_addtid_b32 v122 offset:34304
    ds_write_addtid_b32 v123 offset:34560
    v_mfma_f32_4x4x4_16b_bf16 v[80:83], v[8:9], v[106:107], 0
    v_mfma_f32_4x4x4_16b_bf16 v[76:79], v[8:9], v[104:105], 0
    s_nop 3
    v_pk_mul_f32 v[80:81], v[80:81], v[14:15] op_sel:[0,1] op_sel_hi:[1,1]
    v_pk_mul_f32 v[82:83], v[82:83], v[14:15] op_sel:[0,1] op_sel_hi:[1,1]
    v_pk_mul_f32 v[76:77], v[76:77], v[14:15] op_sel:[0,0] op_sel_hi:[1,0]
    v_pk_mul_f32 v[78:79], v[78:79], v[14:15] op_sel:[0,0] op_sel_hi:[1,0]
    s_setprio 2
    s_waitcnt lgkmcnt(12)
    v_cmp_ne_u64 s[50:51], v[72:73], v[68:69]
    v_cmpx_ne_u64 s[54:55], v[74:75], v[70:71]
    s_and_b64 s[82:83], s[54:55], s[80:81]
    s_cbranch_scc1 L2_c132
L2_d132:
    v_mov_b64 v[84:85], v[70:71]
    v_mov_b32 v7, v93
    v_mov_b64 v[86:87], v[74:75]
    s_or_b64 s[80:81], s[80:81], s[54:55]
    s_mov_b64 exec, s[50:51]
    s_and_b64 s[82:83], s[50:51], s[80:81]
    s_cbranch_scc1 L2_c133
L2_d133:
    v_mov_b64 v[84:85], v[68:69]
    v_mov_b32 v7, v92
    v_mov_b64 v[86:87], v[72:73]
    s_mov_b64 exec, -1
    s_or_b64 s[80:81], s[80:81], s[50:51]
    ds_read_b64 v[70:71], v95 offset:65408
    ds_read_b64 v[68:69], v94 offset:65408
    v_and_b32 v46, 0x40000000, v39
    v_bitop3_b32 v92, v36, v5, v46 bitop3:0xea
    v_and_b32 v46, 0x80000000, v39
    v_bitop3_b32 v93, v37, v5, v46 bitop3:0xea
    v_perm_b32 v15, v37, v38, s47
    v_bitop3_b32 v46, v37, 0.5, -0.5 bitop3:0xa8
    v_perm_b32 v14, v36, v38, s46
    v_bitop3_b32 v47, v36, 0.5, -0.5 bitop3:0xa8
    v_bitop3_b32 v15, v6, v15, v46 bitop3:0xca
    v_bitop3_b32 v14, v6, v14, v47 bitop3:0xca
    s_setprio 1
    s_waitcnt lgkmcnt(1)
    v_mfma_f32_4x4x4_16b_bf16 v[80:83], v[10:11], v[70:71], v[80:83]
    s_waitcnt lgkmcnt(0)
    v_mfma_f32_4x4x4_16b_bf16 v[76:79], v[10:11], v[68:69], v[76:79]
    s_nop 2
    v_cvt_pk_bf16_f32 v80, v80, v81
    v_cvt_pk_bf16_f32 v81, v82, v83
    ds_wrxchg_rtn_b64 v[74:75], v95, v[80:81] offset:65408
    v_cvt_pk_bf16_f32 v76, v76, v77
    v_cvt_pk_bf16_f32 v77, v78, v79
    ds_wrxchg_rtn_b64 v[72:73], v94, v[76:77] offset:65408
    v_and_b32 v88, 0x0fffffff, v43
    buffer_load_dwordx2 v[34:35], v88, s[8:11], 0 offen
    buffer_load_dwordx3 v[36:38], v88, s[8:11], 0 offen offset:8
    s_setprio 0
    s_waitcnt vmcnt(9)
    s_mov_b32 m0, s38
    s_nop 0
    ds_write_addtid_b32 v108 offset:0
    ds_write_addtid_b32 v109 offset:256
    ds_write_addtid_b32 v110 offset:512
    ds_write_addtid_b32 v111 offset:768
    s_waitcnt vmcnt(6)
    ds_write_addtid_b32 v112 offset:1024
    ds_write_addtid_b32 v113 offset:1280
    ds_write_addtid_b32 v114 offset:1536
    ds_write_addtid_b32 v115 offset:1792
    v_mfma_f32_4x4x4_16b_bf16 v[80:83], v[8:9], v[102:103], 0
    v_mfma_f32_4x4x4_16b_bf16 v[76:79], v[8:9], v[100:101], 0
    v_cmp_lt_u32 s[84:85], v5, v92
    s_nop 2
    v_pk_mul_f32 v[80:81], v[80:81], v[14:15] op_sel:[0,1] op_sel_hi:[1,1]
    v_pk_mul_f32 v[82:83], v[82:83], v[14:15] op_sel:[0,1] op_sel_hi:[1,1]
    v_pk_mul_f32 v[76:77], v[76:77], v[14:15] op_sel:[0,0] op_sel_hi:[1,0]
    v_pk_mul_f32 v[78:79], v[78:79], v[14:15] op_sel:[0,0] op_sel_hi:[1,0]
    s_add_u32 s42, s42, 1
    s_waitcnt lgkmcnt(0)
    s_barrier
    s_bitcmp1_b32 s36, s42
    s_cbranch_scc1 L2_slow
L2_ret7:
    s_setprio 3
    s_bitcmp1_b32 s43, s42
    s_cbranch_scc1 L2_oa134
L2_ob134:
    v_and_b32 v46, 0x20000000, v40
    v_lshrrev_b32 v47, 14, v17
    v_bitop3_b32 v47, v47, v5, v46 bitop3:0xea
    ds_read_b64 v[106:107], v47
    v_and_b32 v99, 0x10000000, v40
    v_lshrrev_b32 v47, 14, v16
    v_bitop3_b32 v47, v47, v5, v99 bitop3:0xea
    ds_read_b64 v[104:105], v47
    v_cmp_ne_u64 s[50:51], v[72:73], v[68:69]
    v_cmpx_ne_u64 s[54:55], v[74:75], v[70:71]
    s_and_b64 s[82:83], s[54:55], s[80:81]
    s_cbranch_scc1 L2_c135
L2_d135:
    v_mov_b64 v[84:85], v[70:71]
    v_mov_b32 v7, v95
    v_mov_b64 v[86:87], v[74:75]
    s_or_b64 s[80:81], s[80:81], s[54:55]
    s_mov_b64 exec, s[50:51]
    s_and_b64 s[82:83], s[50:51], s[80:81]
    s_cbranch_scc1 L2_c136
L2_d136:
    v_mov_b64 v[84:85], v[68:69]
    v_mov_b32 v7, v94
    v_mov_b64 v[86:87], v[72:73]
    s_mov_b64 exec, -1
    s_or_b64 s[80:81], s[80:81], s[50:51]
    s_and_b64 exec, s[84:85], s[80:81]
    v_mfma_f32_4x4x4_16b_bf16 v[76:79], v[12:13], v[84:85], 0
    v_mov_b32 v92, v7
    s_andn2_b64 s[80:81], s[80:81], s[84:85]
    v_mfma_f32_4x4x4_16b_bf16 v[76:79], v[10:11], v[86:87], v[76:79]
    s_mov_b64 exec, -1
    ds_read_b64 v[70:71], v93 offset:65408
    ds_read_b64 v[68:69], v92 offset:65408
    v_bitop3_b32 v94, v16, v5, v99 bitop3:0xea
    v_bitop3_b32 v95, v17, v5, v46 bitop3:0xea
    v_perm_b32 v15, v17, v20, s45
    v_bitop3_b32 v46, v17, 0.5, -0.5 bitop3:0xa8
    v_perm_b32 v14, v16, v20, s44
    v_bitop3_b32 v47, v16, 0.5, -0.5 bitop3:0xa8
    v_bitop3_b32 v15, v6, v15, v46 bitop3:0xca
    v_bitop3_b32 v14, v6, v14, v47 bitop3:0xca
    s_waitcnt lgkmcnt(1)
    v_mfma_f32_4x4x4_16b_bf16 v[80:83], v[10:11], v[70:71], v[80:83]
    s_waitcnt lgkmcnt(0)
    v_mfma_f32_4x4x4_16b_bf16 v[76:79], v[10:11], v[68:69], v[76:79]
    s_nop 2
    v_cvt_pk_bf16_f32 v80, v80, v81
    v_cvt_pk_bf16_f32 v81, v82, v83
    ds_wrxchg_rtn_b64 v[74:75], v93, v[80:81] offset:65408
    v_cvt_pk_bf16_f32 v76, v76, v77
    v_cvt_pk_bf16_f32 v77, v78, v79
    ds_wrxchg_rtn_b64 v[72:73], v92, v[76:77] offset:65408
    v_mfma_f32_4x4x4_16b_bf16 v[80:83], v[8:9], v[106:107], 0
    v_mfma_f32_4x4x4_16b_bf16 v[76:79], v[8:9], v[104:105], 0
    v_cmp_lt_u32 s[84:85], v5, v94
    s_nop 2
    v_pk_mul_f32 v[80:81], v[80:81], v[14:15] op_sel:[0,1] op_sel_hi:[1,1]
    v_pk_mul_f32 v[82:83], v[82:83], v[14:15] op_sel:[0,1] op_sel_hi:[1,1]
    v_pk_mul_f32 v[76:77], v[76:77], v[14:15] op_sel:[0,0] op_sel_hi:[1,0]
    v_pk_mul_f32 v[78:79], v[78:79], v[14:15] op_sel:[0,0] op_sel_hi:[1,0]
    v_and_b32 v46, 0x80000000, v40
    v_lshrrev_b32 v47, 14, v19
    v_bitop3_b32 v47, v47, v5, v46 bitop3:0xea
    ds_read_b64 v[102:103], v47
    v_and_b32 v99, 0x40000000, v40
    v_lshrrev_b32 v47, 14, v18
    v_bitop3_b32 v47, v47, v5, v99 bitop3:0xea
    ds_read_b64 v[100:101], v47
    s_waitcnt lgkmcnt(2)
    v_cmp_ne_u64 s[50:51], v[72:73], v[68:69]
    v_cmpx_ne_u64 s[54:55], v[74:75], v[70:71]
    s_and_b64 s[82:83], s[54:55], s[80:81]
    s_cbranch_scc1 L2_c137
L2_d137:
    v_mov_b64 v[84:85], v[70:71]
    v_mov_b32 v7, v93
    v_mov_b64 v[86:87], v[74:75]
    s_or_b64 s[80:81], s[80:81], s[54:55]
    s_mov_b64 exec, s[50:51]
    s_and_b64 s[82:83], s[50:51], s[80:81]
    s_cbranch_scc1 L2_c138
L2_d138:
    v_mov_b64 v[84:85], v[68:69]
    v_mov_b32 v7, v92
    v_mov_b64 v[86:87], v[72:73]
    s_mov_b64 exec, -1
    s_or_b64 s[80:81], s[80:81], s[50:51]
    s_and_b64 exec, s[84:85], s[80:81]
    v_mfma_f32_4x4x4_16b_bf16 v[76:79], v[12:13], v[84:85], 0
    v_mov_b32 v94, v7
    s_andn2_b64 s[80:81], s[80:81], s[84:85]
    v_mfma_f32_4x4x4_16b_bf16 v[76:79], v[10:11], v[86:87], v[76:79]
    s_mov_b64 exec, -1
    ds_read_b64 v[70:71], v95 offset:65408
    ds_read_b64 v[68:69], v94 offset:65408
    v_bitop3_b32 v92, v18, v5, v99 bitop3:0xea
    v_bitop3_b32 v93, v19, v5, v46 bitop3:0xea
    v_perm_b32 v15, v19, v20, s47
    v_bitop3_b32 v46, v19, 0.5, -0.5 bitop3:0xa8
    v_perm_b32 v14, v18, v20, s46
    v_bitop3_b32 v47, v18, 0.5, -0.5 bitop3:0xa8
    v_bitop3_b32 v15, v6, v15, v46 bitop3:0xca
    v_bitop3_b32 v14, v6, v14, v47 bitop3:0xca
    s_waitcnt lgkmcnt(1)
    v_mfma_f32_4x4x4_16b_bf16 v[80:83], v[10:11], v[70:71], v[80:83]
    s_waitcnt lgkmcnt(0)
    v_mfma_f32_4x4x4_16b_bf16 v[76:79], v[10:11], v[68:69], v[76:79]
    s_nop 2
    v_cvt_pk_bf16_f32 v80, v80, v81
    v_cvt_pk_bf16_f32 v81, v82, v83
    ds_wrxchg_rtn_b64 v[74:75], v95, v[80:81] offset:65408
    v_cvt_pk_bf16_f32 v76, v76, v77
    v_cvt_pk_bf16_f32 v77, v78, v79
    ds_wrxchg_rtn_b64 v[72:73], v94, v[76:77] offset:65408
    s_setprio 2
    v_mfma_f32_4x4x4_16b_bf16 v[80:83], v[8:9], v[102:103], 0
    v_mfma_f32_4x4x4_16b_bf16 v[76:79], v[8:9], v[100:101], 0
    v_cmp_lt_u32 s[48:49], v5, v93
    s_nop 2
    v_pk_mul_f32 v[80:81], v[80:81], v[14:15] op_sel:[0,1] op_sel_hi:[1,1]
    v_pk_mul_f32 v[82:83], v[82:83], v[14:15] op_sel:[0,1] op_sel_hi:[1,1]
    v_pk_mul_f32 v[76:77], v[76:77], v[14:15] op_sel:[0,0] op_sel_hi:[1,0]
    v_pk_mul_f32 v[78:79], v[78:79], v[14:15] op_sel:[0,0] op_sel_hi:[1,0]
    s_waitcnt vmcnt(4)
    v_and_b32 v46, 0x20000000, v41
    v_lshrrev_b32 v47, 14, v23
    v_bitop3_b32 v47, v47, v5, v46 bitop3:0xea
    ds_read_b64 v[106:107], v47
    v_and_b32 v99, 0x10000000, v41
    v_lshrrev_b32 v47, 14, v22
    v_bitop3_b32 v47, v47, v5, v99 bitop3:0xea
    ds_read_b64 v[104:105], v47
    s_waitcnt lgkmcnt(2)
    v_cmp_ne_u64 s[50:51], v[72:73], v[68:69]
    v_cmpx_ne_u64 s[54:55], v[74:75], v[70:71]
    s_and_b64 s[82:83], s[54:55], s[80:81]
    s_cbranch_scc1 L2_c139
L2_d139:
    v_mov_b64 v[84:85], v[70:71]
    v_mov_b32 v7, v95
    v_mov_b64 v[86:87], v[74:75]
    s_or_b64 s[80:81], s[80:81], s[54:55]
    s_mov_b64 exec, s[50:51]
    s_and_b64 s[82:83], s[50:51], s[80:81]
    s_cbranch_scc1 L2_c140
L2_d140:
    v_mov_b64 v[84:85], v[68:69]
    v_mov_b32 v7, v94
    v_mov_b64 v[86:87], v[72:73]
    s_mov_b64 exec, -1
    s_or_b64 s[80:81], s[80:81], s[50:51]
    s_and_b64 exec, s[48:49], s[80:81]
    v_mfma_f32_4x4x4_16b_bf16 v[80:83], v[12:13], v[84:85], 0
    v_mov_b32 v93, v7
    s_andn2_b64 s[80:81], s[80:81], s[48:49]
    v_mfma_f32_4x4x4_16b_bf16 v[80:83], v[10:11], v[86:87], v[80:83]
    s_mov_b64 exec, -1
    ds_read_b64 v[70:71], v93 offset:65408
    ds_read_b64 v[68:69], v92 offset:65408
    v_bitop3_b32 v94, v22, v5, v99 bitop3:0xea
    v_bitop3_b32 v95, v23, v5, v46 bitop3:0xea
    v_perm_b32 v15, v23, v26, s45
    v_bitop3_b32 v46, v23, 0.5, -0.5 bitop3:0xa8
    v_perm_b32 v14, v22, v26, s44
    v_bitop3_b32 v47, v22, 0.5, -0.5 bitop3:0xa8
    v_bitop3_b32 v15, v6, v15, v46 bitop3:0xca
    v_bitop3_b32 v14, v6, v14, v47 bitop3:0xca
    s_waitcnt lgkmcnt(1)
    v_mfma_f32_4x4x4_16b_bf16 v[80:83], v[10:11], v[70:71], v[80:83]
    s_waitcnt lgkmcnt(0)
    v_mfma_f32_4x4x4_16b_bf16 v[76:79], v[10:11], v[68:69], v[76:79]
    s_nop 2
    v_cvt_pk_bf16_f32 v80, v80, v81
    v_cvt_pk_bf16_f32 v81, v82, v83
    ds_wrxchg_rtn_b64 v[74:75], v93, v[80:81] offset:65408
    v_cvt_pk_bf16_f32 v76, v76, v77
    v_cvt_pk_bf16_f32 v77, v78, v79
    ds_wrxchg_rtn_b64 v[72:73], v92, v[76:77] offset:65408
    s_setprio 1
    v_mfma_f32_4x4x4_16b_bf16 v[80:83], v[8:9], v[106:107], 0
    v_mfma_f32_4x4x4_16b_bf16 v[76:79], v[8:9], v[104:105], 0
    s_nop 3
    v_pk_mul_f32 v[80:81], v[80:81], v[14:15] op_sel:[0,1] op_sel_hi:[1,1]
    v_pk_mul_f32 v[82:83], v[82:83], v[14:15] op_sel:[0,1] op_sel_hi:[1,1]
    v_pk_mul_f32 v[76:77], v[76:77], v[14:15] op_sel:[0,0] op_sel_hi:[1,0]
    v_pk_mul_f32 v[78:79], v[78:79], v[14:15] op_sel:[0,0] op_sel_hi:[1,0]
    s_bitcmp1_b32 s43, s42
    s_cbranch_scc1 L2_oa141
L2_ob141:
    v_and_b32 v46, 0x80000000, v41
    v_lshrrev_b32 v47, 14, v25
    v_bitop3_b32 v47, v47, v5, v46 bitop3:0xea
    ds_read_b64 v[102:103], v47
    v_and_b32 v99, 0x40000000, v41
    v_lshrrev_b32 v47, 14, v24
    v_bitop3_b32 v47, v47, v5, v99 bitop3:0xea
    ds_read_b64 v[100:101], v47
    s_waitcnt lgkmcnt(2)
    v_cmp_ne_u64 s[50:51], v[72:73], v[68:69]
    v_cmpx_ne_u64 s[54:55], v[74:75], v[70:71]
    s_and_b64 s[82:83], s[54:55], s[80:81]
    s_cbranch_scc1 L2_c142
L2_d142:
    v_mov_b64 v[84:85], v[70:71]
    v_mov_b32 v7, v93
    v_mov_b64 v[86:87], v[74:75]
    s_or_b64 s[80:81], s[80:81], s[54:55]
    s_mov_b64 exec, s[50:51]
    s_and_b64 s[82:83], s[50:51], s[80:81]
    s_cbranch_scc1 L2_c143
L2_d143:
    v_mov_b64 v[84:85], v[68:69]
    v_mov_b32 v7, v92
    v_mov_b64 v[86:87], v[72:73]
    s_mov_b64 exec, -1
    s_or_b64 s[80:81], s[80:81], s[50:51]
    ds_read_b64 v[70:71], v95 offset:65408
    ds_read_b64 v[68:69], v94 offset:65408
    v_bitop3_b32 v92, v24, v5, v99 bitop3:0xea
    v_bitop3_b32 v93, v25, v5, v46 bitop3:0xea
    v_perm_b32 v15, v25, v26, s47
    v_bitop3_b32 v46, v25, 0.5, -0.5 bitop3:0xa8
    v_perm_b32 v14, v24, v26, s46
    v_bitop3_b32 v47, v24, 0.5, -0.5 bitop3:0xa8
    v_bitop3_b32 v15, v6, v15, v46 bitop3:0xca
    v_bitop3_b32 v14, v6, v14, v47 bitop3:0xca
    s_waitcnt lgkmcnt(1)
    v_mfma_f32_4x4x4_16b_bf16 v[80:83], v[10:11], v[70:71], v[80:83]
    s_waitcnt lgkmcnt(0)
    v_mfma_f32_4x4x4_16b_bf16 v[76:79], v[10:11], v[68:69], v[76:79]
    s_nop 2
    v_cvt_pk_bf16_f32 v80, v80, v81
    v_cvt_pk_bf16_f32 v81, v82, v83
    ds_wrxchg_rtn_b64 v[74:75], v95, v[80:81] offset:65408
    v_cvt_pk_bf16_f32 v76, v76, v77
    v_cvt_pk_bf16_f32 v77, v78, v79
    ds_wrxchg_rtn_b64 v[72:73], v94, v[76:77] offset:65408
    v_mfma_f32_4x4x4_16b_bf16 v[80:83], v[8:9], v[102:103], 0
    v_mfma_f32_4x4x4_16b_bf16 v[76:79], v[8:9], v[100:101], 0
    v_cmp_lt_u32 s[84:85], v5, v92
    s_nop 2
    v_pk_mul_f32 v[80:81], v[80:81], v[14:15] op_sel:[0,1] op_sel_hi:[1,1]
    v_pk_mul_f32 v[82:83], v[82:83], v[14:15] op_sel:[0,1] op_sel_hi:[1,1]
    v_pk_mul_f32 v[76:77], v[76:77], v[14:15] op_sel:[0,0] op_sel_hi:[1,0]
    v_pk_mul_f32 v[78:79], v[78:79], v[14:15] op_sel:[0,0] op_sel_hi:[1,0]
    s_lshl_b32 s3, s32, 12
    v_subrev_u32 v122, s3, v3
    s_mul_i32 s3, s33, 20000
    v_add_u32 v118, s3, v122
    v_add_u32 v119, 0x4000, v118
    s_lshl_b32 s3, s34, 7
    v_lshrrev_b32 v123, 7, v118
    v_and_b32 v120, 0x70, v118
    v_lshl_add_u32 v120, v123, 13, v120
    v_add_u32 v120, s3, v120
    v_lshrrev_b32 v123, 7, v119
    v_and_b32 v121, 0x70, v119
    v_lshl_add_u32 v121, v123, 13, v121
    v_add_u32 v121, s3, v121
    v_cmp_le_u32 vcc, 3616, v122
    s_mov_b64 exec, vcc
    v_mov_b32 v119, 2.0
    v_mov_b32 v121, 2.0
    s_mov_b64 exec, -1
    v_and_b32 v123, 0x30, v122
    v_lshlrev_b32 v123, 2, v123
    buffer_load_dwordx4 v[48:51], v123, s[24:27], 0 offen
    buffer_load_dwordx4 v[52:55], v123, s[24:27], 0 offen offset:16
    buffer_load_dwordx2 v[56:57], v123, s[24:27], 0 offen offset:32
    s_mov_b32 s12, s4
    s_mov_b32 s13, s5
    s_mov_b32 s14, 0x138800
    s_mov_b32 s15, 0x20000
    s_mov_b32 s16, s28
    s_mov_b32 s17, s29
    s_mov_b32 s18, 0x4e2000
    s_mov_b32 s19, 0x20000
    v_lshrrev_b32 v123, 2, v120
    buffer_load_dword v116, v123, s[12:15], 0 offen
    buffer_load_dwordx4 v[108:111], v120, s[16:19], 0 offen
    v_lshrrev_b32 v123, 2, v121
    buffer_load_dword v117, v123, s[12:15], 0 offen
    buffer_load_dwordx4 v[112:115], v121, s[16:19], 0 offen
    s_waitcnt vmcnt(9)
    s_mov_b64 exec, s[6:7]
    v_lshrrev_b32 v30, 16, v30
    s_mov_b64 exec, -1
    v_and_b32 v46, 0x20000000, v42
    v_lshrrev_b32 v47, 14, v29
    v_bitop3_b32 v47, v47, v5, v46 bitop3:0xea
    ds_read_b64 v[106:107], v47
    v_and_b32 v99, 0x10000000, v42
    v_lshrrev_b32 v47, 14, v28
    v_bitop3_b32 v47, v47, v5, v99 bitop3:0xea
    ds_read_b64 v[104:105], v47
    s_waitcnt lgkmcnt(2)
    v_cmp_ne_u64 s[50:51], v[72:73], v[68:69]
    v_cmpx_ne_u64 s[54:55], v[74:75], v[70:71]
    s_and_b64 s[82:83], s[54:55], s[80:81]
    s_cbranch_scc1 L2_c144
L2_d144:
    v_mov_b64 v[84:85], v[70:71]
    v_mov_b32 v7, v95
    v_mov_b64 v[86:87], v[74:75]
    s_or_b64 s[80:81], s[80:81], s[54:55]
    s_mov_b64 exec, s[50:51]
    s_and_b64 s[82:83], s[50:51], s[80:81]
    s_cbranch_scc1 L2_c145
L2_d145:
    v_mov_b64 v[84:85], v[68:69]
    v_mov_b32 v7, v94
    v_mov_b64 v[86:87], v[72:73]
    s_mov_b64 exec, -1
    s_or_b64 s[80:81], s[80:81], s[50:51]
    s_and_b64 exec, s[84:85], s[80:81]
    v_mfma_f32_4x4x4_16b_bf16 v[76:79], v[12:13], v[84:85], 0
    v_mov_b32 v92, v7
    s_andn2_b64 s[80:81], s[80:81], s[84:85]
    v_mfma_f32_4x4x4_16b_bf16 v[76:79], v[10:11], v[86:87], v[76:79]
    s_mov_b64 exec, -1
    ds_read_b64 v[70:71], v93 offset:65408
    ds_read_b64 v[68:69], v92 offset:65408
    v_bitop3_b32 v94, v28, v5, v99 bitop3:0xea
    v_bitop3_b32 v95, v29, v5, v46 bitop3:0xea
    v_perm_b32 v15, v29, v30, s45
    v_bitop3_b32 v46, v29, 0.5, -0.5 bitop3:0xa8
    v_perm_b32 v14, v28, v30, s44
    v_bitop3_b32 v47, v28, 0.5, -0.5 bitop3:0xa8
    v_bitop3_b32 v15, v6, v15, v46 bitop3:0xca
    v_bitop3_b32 v14, v6, v14, v47 bitop3:0xca
    s_waitcnt lgkmcnt(1)
    v_mfma_f32_4x4x4_16b_bf16 v[80:83], v[10:11], v[70:71], v[80:83]
    s_waitcnt lgkmcnt(0)
    v_mfma_f32_4x4x4_16b_bf16 v[76:79], v[10:11], v[68:69], v[76:79]
    s_nop 2
    v_cvt_pk_bf16_f32 v80, v80, v81
    v_cvt_pk_bf16_f32 v81, v82, v83
    ds_wrxchg_rtn_b64 v[74:75], v93, v[80:81] offset:65408
    v_cvt_pk_bf16_f32 v76, v76, v77
    v_cvt_pk_bf16_f32 v77, v78, v79
    ds_wrxchg_rtn_b64 v[72:73], v92, v[76:77] offset:65408
    s_setprio 0
    v_mfma_f32_4x4x4_16b_bf16 v[80:83], v[8:9], v[106:107], 0
    v_mfma_f32_4x4x4_16b_bf16 v[76:79], v[8:9], v[104:105], 0
    v_cmp_lt_u32 s[48:49], v5, v95
    s_nop 2
    v_pk_mul_f32 v[80:81], v[80:81], v[14:15] op_sel:[0,1] op_sel_hi:[1,1]
    v_pk_mul_f32 v[82:83], v[82:83], v[14:15] op_sel:[0,1] op_sel_hi:[1,1]
    v_pk_mul_f32 v[76:77], v[76:77], v[14:15] op_sel:[0,0] op_sel_hi:[1,0]
    v_pk_mul_f32 v[78:79], v[78:79], v[14:15] op_sel:[0,0] op_sel_hi:[1,0]
    s_waitcnt vmcnt(7)
    v_and_b32 v46, 0x80000000, v43
    v_lshrrev_b32 v47, 14, v37
    v_bitop3_b32 v47, v47, v5, v46 bitop3:0xea
    ds_read_b64 v[106:107], v47
    v_and_b32 v99, 0x40000000, v43
    v_lshrrev_b32 v47, 14, v36
    v_bitop3_b32 v47, v47, v5, v99 bitop3:0xea
    ds_read_b64 v[104:105], v47
    v_and_b32 v46, 0x20000000, v43
    v_lshrrev_b32 v47, 14, v35
    v_bitop3_b32 v47, v47, v5, v46 bitop3:0xea
    ds_read_b64 v[102:103], v47
    v_and_b32 v99, 0x10000000, v43
    v_lshrrev_b32 v47, 14, v34
    v_bitop3_b32 v47, v47, v5, v99 bitop3:0xea
    ds_read_b64 v[100:101], v47
    s_waitcnt lgkmcnt(4)
    v_cmp_ne_u64 s[50:51], v[72:73], v[68:69]
    v_cmpx_ne_u64 s[54:55], v[74:75], v[70:71]
    s_and_b64 s[82:83], s[54:55], s[80:81]
    s_cbranch_scc1 L2_c146
L2_d146:
    v_mov_b64 v[84:85], v[70:71]
    v_mov_b32 v7, v93
    v_mov_b64 v[86:87], v[74:75]
    s_or_b64 s[80:81], s[80:81], s[54:55]
    s_mov_b64 exec, s[50:51]
    s_and_b64 s[82:83], s[50:51], s[80:81]
    s_cbranch_scc1 L2_c147
L2_d147:
    v_mov_b64 v[84:85], v[68:69]
    v_mov_b32 v7, v92
    v_mov_b64 v[86:87], v[72:73]
    s_mov_b64 exec, -1
    s_or_b64 s[80:81], s[80:81], s[50:51]
    s_and_b64 exec, s[48:49], s[80:81]
    v_mfma_f32_4x4x4_16b_bf16 v[80:83], v[12:13], v[84:85], 0
    v_mov_b32 v95, v7
    s_andn2_b64 s[80:81], s[80:81], s[48:49]
    v_mfma_f32_4x4x4_16b_bf16 v[80:83], v[10:11], v[86:87], v[80:83]
    s_mov_b64 exec, -1
    ds_read_b64 v[70:71], v95 offset:65408
    ds_read_b64 v[68:69], v94 offset:65408
    v_bitop3_b32 v92, v34, v5, v99 bitop3:0xea
    v_bitop3_b32 v93, v35, v5, v46 bitop3:0xea
    v_perm_b32 v15, v35, v38, s45
    v_bitop3_b32 v46, v35, 0.5, -0.5 bitop3:0xa8
    v_perm_b32 v14, v34, v38, s44
    v_bitop3_b32 v47, v34, 0.5, -0.5 bitop3:0xa8
    v_bitop3_b32 v15, v6, v15, v46 bitop3:0xca
    v_bitop3_b32 v14, v6, v14, v47 bitop3:0xca
    s_waitcnt lgkmcnt(1)
    v_mfma_f32_4x4x4_16b_bf16 v[80:83], v[10:11], v[70:71], v[80:83]
    s_waitcnt lgkmcnt(0)
    v_mfma_f32_4x4x4_16b_bf16 v[76:79], v[10:11], v[68:69], v[76:79]
    s_nop 2
    v_cvt_pk_bf16_f32 v80, v80, v81
    v_cvt_pk_bf16_f32 v81, v82, v83
    ds_wrxchg_rtn_b64 v[74:75], v95, v[80:81] offset:65408
    v_cvt_pk_bf16_f32 v76, v76, v77
    v_cvt_pk_bf16_f32 v77, v78, v79
    ds_wrxchg_rtn_b64 v[72:73], v94, v[76:77] offset:65408
    v_mfma_f32_4x4x4_16b_bf16 v[80:83], v[8:9], v[102:103], 0
    v_mfma_f32_4x4x4_16b_bf16 v[76:79], v[8:9], v[100:101], 0
    s_nop 3
    v_pk_mul_f32 v[80:81], v[80:81], v[14:15] op_sel:[0,1] op_sel_hi:[1,1]
    v_pk_mul_f32 v[82:83], v[82:83], v[14:15] op_sel:[0,1] op_sel_hi:[1,1]
    v_pk_mul_f32 v[76:77], v[76:77], v[14:15] op_sel:[0,0] op_sel_hi:[1,0]
    v_pk_mul_f32 v[78:79], v[78:79], v[14:15] op_sel:[0,0] op_sel_hi:[1,0]
    s_waitcnt lgkmcnt(0)
    v_cmp_ne_u64 s[50:51], v[72:73], v[68:69]
    v_cmpx_ne_u64 s[54:55], v[74:75], v[70:71]
    s_and_b64 s[82:83], s[54:55], s[80:81]
    s_cbranch_scc1 L2_c148
L2_d148:
    v_mov_b64 v[84:85], v[70:71]
    v_mov_b32 v7, v95
    v_mov_b64 v[86:87], v[74:75]
    s_or_b64 s[80:81], s[80:81], s[54:55]
    s_mov_b64 exec, s[50:51]
    s_and_b64 s[82:83], s[50:51], s[80:81]
    s_cbranch_scc1 L2_c149
L2_d149:
    v_mov_b64 v[84:85], v[68:69]
    v_mov_b32 v7, v94
    v_mov_b64 v[86:87], v[72:73]
    s_mov_b64 exec, -1
    s_or_b64 s[80:81], s[80:81], s[50:51]
    ds_read_b64 v[70:71], v93 offset:65408
    ds_read_b64 v[68:69], v92 offset:65408
    v_and_b32 v46, 0x40000000, v43
    v_bitop3_b32 v94, v36, v5, v46 bitop3:0xea
    v_and_b32 v46, 0x80000000, v43
    v_bitop3_b32 v95, v37, v5, v46 bitop3:0xea
    v_perm_b32 v15, v37, v38, s47
    v_bitop3_b32 v46, v37, 0.5, -0.5 bitop3:0xa8
    v_perm_b32 v14, v36, v38, s46
    v_bitop3_b32 v47, v36, 0.5, -0.5 bitop3:0xa8
    v_bitop3_b32 v15, v6, v15, v46 bitop3:0xca
    v_bitop3_b32 v14, v6, v14, v47 bitop3:0xca
    s_waitcnt lgkmcnt(1)
    v_mfma_f32_4x4x4_16b_bf16 v[80:83], v[10:11], v[70:71], v[80:83]
    s_waitcnt lgkmcnt(0)
    v_mfma_f32_4x4x4_16b_bf16 v[76:79], v[10:11], v[68:69], v[76:79]
    s_nop 2
    v_cvt_pk_bf16_f32 v80, v80, v81
    v_cvt_pk_bf16_f32 v81, v82, v83
    ds_wrxchg_rtn_b64 v[74:75], v93, v[80:81] offset:65408
    v_cvt_pk_bf16_f32 v76, v76, v77
    v_cvt_pk_bf16_f32 v77, v78, v79
    ds_wrxchg_rtn_b64 v[72:73], v92, v[76:77] offset:65408
    v_mfma_f32_4x4x4_16b_bf16 v[80:83], v[8:9], v[106:107], 0
    v_mfma_f32_4x4x4_16b_bf16 v[76:79], v[8:9], v[104:105], 0
    v_cmp_lt_u32 s[84:85], v5, v94
    s_nop 2
    v_pk_mul_f32 v[80:81], v[80:81], v[14:15] op_sel:[0,1] op_sel_hi:[1,1]
    v_pk_mul_f32 v[82:83], v[82:83], v[14:15] op_sel:[0,1] op_sel_hi:[1,1]
    v_pk_mul_f32 v[76:77], v[76:77], v[14:15] op_sel:[0,0] op_sel_hi:[1,0]
    v_pk_mul_f32 v[78:79], v[78:79], v[14:15] op_sel:[0,0] op_sel_hi:[1,0]
    s_waitcnt lgkmcnt(0)
    v_cmp_ne_u64 s[50:51], v[72:73], v[68:69]
    v_cmpx_ne_u64 s[54:55], v[74:75], v[70:71]
    s_and_b64 s[82:83], s[54:55], s[80:81]
    s_cbranch_scc1 L2_c150
L2_d150:
    v_mov_b64 v[84:85], v[70:71]
    v_mov_b32 v7, v93
    v_mov_b64 v[86:87], v[74:75]
    s_or_b64 s[80:81], s[80:81], s[54:55]
    s_mov_b64 exec, s[50:51]
    s_and_b64 s[82:83], s[50:51], s[80:81]
    s_cbranch_scc1 L2_c151
L2_d151:
    v_mov_b64 v[84:85], v[68:69]
    v_mov_b32 v7, v92
    v_mov_b64 v[86:87], v[72:73]
    s_mov_b64 exec, -1
    s_or_b64 s[80:81], s[80:81], s[50:51]
    s_and_b64 exec, s[84:85], s[80:81]
    v_mfma_f32_4x4x4_16b_bf16 v[76:79], v[12:13], v[84:85], 0
    v_mov_b32 v94, v7
    s_andn2_b64 s[80:81], s[80:81], s[84:85]
    v_mfma_f32_4x4x4_16b_bf16 v[76:79], v[10:11], v[86:87], v[76:79]
    s_mov_b64 exec, -1
    ds_read_b64 v[70:71], v95 offset:65408
    ds_read_b64 v[68:69], v94 offset:65408
    s_waitcnt lgkmcnt(1)
    v_mfma_f32_4x4x4_16b_bf16 v[80:83], v[10:11], v[70:71], v[80:83]
    s_waitcnt lgkmcnt(0)
    v_mfma_f32_4x4x4_16b_bf16 v[76:79], v[10:11], v[68:69], v[76:79]
    s_nop 2
    v_cvt_pk_bf16_f32 v80, v80, v81
    v_cvt_pk_bf16_f32 v81, v82, v83
    ds_wrxchg_rtn_b64 v[74:75], v95, v[80:81] offset:65408
    v_cvt_pk_bf16_f32 v76, v76, v77
    v_cvt_pk_bf16_f32 v77, v78, v79
    ds_wrxchg_rtn_b64 v[72:73], v94, v[76:77] offset:65408
    s_waitcnt lgkmcnt(0)
    v_cmpx_ne_u64 vcc, v[74:75], v[70:71]
    s_and_b64 s[82:83], vcc, s[80:81]
    s_cbranch_scc1 L2_c152
L2_d152:
    v_mov_b64 v[84:85], v[70:71]
    v_mov_b32 v7, v95
    v_mov_b64 v[86:87], v[74:75]
    s_mov_b64 exec, -1
    s_or_b64 s[80:81], s[80:81], vcc
    v_cmpx_ne_u64 vcc, v[72:73], v[68:69]
    s_and_b64 s[82:83], vcc, s[80:81]
    s_cbranch_scc1 L2_c153
L2_d153:
    v_mov_b64 v[84:85], v[68:69]
    v_mov_b32 v7, v94
    v_mov_b64 v[86:87], v[72:73]
    s_mov_b64 exec, -1
    s_or_b64 s[80:81], s[80:81], vcc
    s_mov_b64 exec, s[80:81]
    ds_read_b64 v[68:69], v7 offset:65408
    v_mfma_f32_4x4x4_16b_bf16 v[76:79], v[12:13], v[84:85], 0
    s_nop 1
    v_mfma_f32_4x4x4_16b_bf16 v[76:79], v[10:11], v[86:87], v[76:79]
    s_waitcnt lgkmcnt(0)
    s_nop 0
    v_mfma_f32_4x4x4_16b_bf16 v[76:79], v[10:11], v[68:69], v[76:79]
    v_mov_b64 v[84:85], v[68:69]
    s_nop 3
    v_cvt_pk_bf16_f32 v76, v76, v77
    v_cvt_pk_bf16_f32 v77, v78, v79
    ds_wrxchg_rtn_b64 v[86:87], v7, v[76:77] offset:65408
    s_waitcnt lgkmcnt(0)
    v_cmp_ne_u64 s[80:81], v[86:87], v[84:85]
    s_mov_b64 exec, s[80:81]
    s_nop 1
    v_mfma_f32_4x4x4_16b_bf16 v[88:91], v[12:13], v[84:85], 0
    s_nop 1
    v_mfma_f32_4x4x4_16b_bf16 v[88:91], v[10:11], v[86:87], v[88:91]
    s_nop 4
    v_cvt_pk_bf16_f32 v88, v88, v89
    v_cvt_pk_bf16_f32 v89, v90, v91
    ds_pk_add_bf16 v7, v88 offset:65408
    ds_pk_add_bf16 v7, v89 offset:65412
    s_mov_b64 exec, -1
    s_load_dwordx2 s[4:5], s[0:1], 88
    v_add_u32 v123, 0x4000, v122
    s_lshl_b32 s50, s96, 16
    s_and_b32 s51, s96, 0xffff0000
    s_lshl_b32 s52, s97, 16
    s_and_b32 s53, s97, 0xffff0000
    s_lshl_b32 s54, s98, 16
    s_and_b32 s55, s98, 0xffff0000
    s_lshl_b32 s56, s99, 16
    s_and_b32 s57, s99, 0xffff0000
    s_waitcnt vmcnt(0) lgkmcnt(0)
    s_barrier
    s_add_u32 s8, s30, 0xec55000
    s_addc_u32 s9, s31, 0
    s_mov_b32 s10, 0x8000
    s_mov_b32 s11, 0x20000
    s_mov_b32 s12, s4
    s_mov_b32 s13, s5
    s_mov_b32 s14, 0x4e2000
    s_mov_b32 s15, 0x20000
    s_add_u32 s20, s30, 0xd854000
    s_addc_u32 s21, s31, 0
    s_mov_b32 s22, 0x1400000
    s_mov_b32 s23, 0x20000
    s_lshl2_add_u32 s4, s34, s33
    s_mul_i32 s4, s4, 81920
    s_add_u32 s3, s33, 1
    s_and_b32 s3, s3, 3
    s_mul_i32 s36, s3, 20000
    s_add_u32 s36, s36, 81920
    s_mul_i32 s40, s3, 20480
    s_add_u32 s40, s40, s4
    s_lshl2_add_u32 s3, s34, s3
    s_mul_i32 s3, s3, 81920
    s_mul_i32 s44, s33, 20480
    s_add_u32 s44, s44, s3
    s_add_u32 s3, s33, 2
    s_and_b32 s3, s3, 3
    s_mul_i32 s37, s3, 20000
    s_add_u32 s37, s37, 81920
    s_mul_i32 s41, s3, 20480
    s_add_u32 s41, s41, s4
    s_lshl2_add_u32 s3, s34, s3
    s_mul_i32 s3, s3, 81920
    s_mul_i32 s45, s33, 20480
    s_add_u32 s45, s45, s3
    s_add_u32 s3, s33, 3
    s_and_b32 s3, s3, 3
    s_mul_i32 s38, s3, 20000
    s_add_u32 s38, s38, 81920
    s_mul_i32 s42, s3, 20480
    s_add_u32 s42, s42, s4
    s_lshl2_add_u32 s3, s34, s3
    s_mul_i32 s3, s3, 81920
    s_mul_i32 s46, s33, 20480
    s_add_u32 s46, s46, s3
    v_add_u32 v104, s36, v122
    ds_read_b128 v[16:19], v104
    v_add_u32 v104, s37, v122
    ds_read_b128 v[20:23], v104
    v_add_u32 v104, s38, v122
    ds_read_b128 v[24:27], v104
    s_waitcnt lgkmcnt(2)
    buffer_store_dwordx4 v[16:19], v122, s[20:23], s40 offen sc1
    s_waitcnt lgkmcnt(1)
    buffer_store_dwordx4 v[20:23], v122, s[20:23], s41 offen sc1
    s_waitcnt lgkmcnt(0)
    buffer_store_dwordx4 v[24:27], v122, s[20:23], s42 offen sc1
    s_cmp_ge_u32 s32, 4
    s_cbranch_scc1 L2_g0
    v_add_u32 v104, s36, v123
    ds_read_b128 v[36:39], v104
    v_add_u32 v104, s37, v123
    ds_read_b128 v[40:43], v104
    v_add_u32 v104, s38, v123
    ds_read_b128 v[44:47], v104
    s_waitcnt lgkmcnt(2)
    buffer_store_dwordx4 v[36:39], v123, s[20:23], s40 offen sc1
    s_waitcnt lgkmcnt(1)
    buffer_store_dwordx4 v[40:43], v123, s[20:23], s41 offen sc1
    s_waitcnt lgkmcnt(0)
    buffer_store_dwordx4 v[44:47], v123, s[20:23], s42 offen sc1
L2_g0:
    v_lshlrev_b32 v80, 16, v116
    v_subrev_f32 v60, s50, v80
    v_subrev_f32 v61, s51, v80
    v_subrev_f32 v62, s52, v80
    v_subrev_f32 v63, s53, v80
    v_subrev_f32 v64, s54, v80
    v_subrev_f32 v65, s55, v80
    v_subrev_f32 v66, s56, v80
    v_subrev_f32 v67, s57, v80
    v_cvt_pk_bf16_f32 v68, v60, v61
    v_cvt_pk_bf16_f32 v69, v62, v63
    v_cvt_pk_bf16_f32 v70, v64, v65
    v_cvt_pk_bf16_f32 v71, v66, v67
    v_lshlrev_b32 v60, 16, v68
    v_and_b32 v61, 0xffff0000, v68
    v_lshlrev_b32 v62, 16, v69
    v_and_b32 v63, 0xffff0000, v69
    v_lshlrev_b32 v64, 16, v70
    v_and_b32 v65, 0xffff0000, v70
    v_lshlrev_b32 v66, 16, v71
    v_and_b32 v67, 0xffff0000, v71
    v_mul_f32 v60, v60, v60
    v_mul_f32 v61, v61, v61
    v_mul_f32 v62, v62, v62
    v_mul_f32 v63, v63, v63
    v_mul_f32 v64, v64, v64
    v_mul_f32 v65, v65, v65
    v_mul_f32 v66, v66, v66
    v_mul_f32 v67, v67, v67
    v_cvt_pk_bf16_f32 v68, v60, v61
    v_cvt_pk_bf16_f32 v69, v62, v63
    v_cvt_pk_bf16_f32 v70, v64, v65
    v_cvt_pk_bf16_f32 v71, v66, v67
    v_lshlrev_b32 v60, 16, v68
    v_and_b32 v61, 0xffff0000, v68
    v_lshlrev_b32 v62, 16, v69
    v_and_b32 v63, 0xffff0000, v69
    v_lshlrev_b32 v64, 16, v70
    v_and_b32 v65, 0xffff0000, v70
    v_lshlrev_b32 v66, 16, v71
    v_and_b32 v67, 0xffff0000, v71
    v_mul_f32 v60, 0xc1200000, v60
    v_mul_f32 v61, 0xc1200000, v61
    v_mul_f32 v62, 0xc1200000, v62
    v_mul_f32 v63, 0xc1200000, v63
    v_mul_f32 v64, 0xc1200000, v64
    v_mul_f32 v65, 0xc1200000, v65
    v_mul_f32 v66, 0xc1200000, v66
    v_mul_f32 v67, 0xc1200000, v67
    v_cvt_pk_bf16_f32 v68, v60, v61
    v_cvt_pk_bf16_f32 v69, v62, v63
    v_cvt_pk_bf16_f32 v70, v64, v65
    v_cvt_pk_bf16_f32 v71, v66, v67
    v_lshlrev_b32 v60, 16, v68
    v_and_b32 v61, 0xffff0000, v68
    v_lshlrev_b32 v62, 16, v69
    v_and_b32 v63, 0xffff0000, v69
    v_lshlrev_b32 v64, 16, v70
    v_and_b32 v65, 0xffff0000, v70
    v_lshlrev_b32 v66, 16, v71
    v_and_b32 v67, 0xffff0000, v71
    v_mul_f32 v60, 0x3fb8aa3b, v60
    v_mul_f32 v61, 0x3fb8aa3b, v61
    v_mul_f32 v62, 0x3fb8aa3b, v62
    v_mul_f32 v63, 0x3fb8aa3b, v63
    v_mul_f32 v64, 0x3fb8aa3b, v64
    v_mul_f32 v65, 0x3fb8aa3b, v65
    v_mul_f32 v66, 0x3fb8aa3b, v66
    v_mul_f32 v67, 0x3fb8aa3b, v67
    v_exp_f32 v60, v60
    v_exp_f32 v61, v61
    v_exp_f32 v62, v62
    v_exp_f32 v63, v63
    v_exp_f32 v64, v64
    v_exp_f32 v65, v65
    v_exp_f32 v66, v66
    v_exp_f32 v67, v67
    v_cvt_pk_bf16_f32 v72, v60, v61
    v_cvt_pk_bf16_f32 v73, v62, v63
    v_cvt_pk_bf16_f32 v74, v64, v65
    v_cvt_pk_bf16_f32 v75, v66, v67
    v_and_b32 v84, 0xffff0000, v116
    v_subrev_f32 v60, s50, v84
    v_subrev_f32 v61, s51, v84
    v_subrev_f32 v62, s52, v84
    v_subrev_f32 v63, s53, v84
    v_subrev_f32 v64, s54, v84
    v_subrev_f32 v65, s55, v84
    v_subrev_f32 v66, s56, v84
    v_subrev_f32 v67, s57, v84
    v_cvt_pk_bf16_f32 v68, v60, v61
    v_cvt_pk_bf16_f32 v69, v62, v63
    v_cvt_pk_bf16_f32 v70, v64, v65
    v_cvt_pk_bf16_f32 v71, v66, v67
    v_lshlrev_b32 v60, 16, v68
    v_and_b32 v61, 0xffff0000, v68
    v_lshlrev_b32 v62, 16, v69
    v_and_b32 v63, 0xffff0000, v69
    v_lshlrev_b32 v64, 16, v70
    v_and_b32 v65, 0xffff0000, v70
    v_lshlrev_b32 v66, 16, v71
    v_and_b32 v67, 0xffff0000, v71
    v_mul_f32 v60, v60, v60
    v_mul_f32 v61, v61, v61
    v_mul_f32 v62, v62, v62
    v_mul_f32 v63, v63, v63
    v_mul_f32 v64, v64, v64
    v_mul_f32 v65, v65, v65
    v_mul_f32 v66, v66, v66
    v_mul_f32 v67, v67, v67
    v_cvt_pk_bf16_f32 v68, v60, v61
    v_cvt_pk_bf16_f32 v69, v62, v63
    v_cvt_pk_bf16_f32 v70, v64, v65
    v_cvt_pk_bf16_f32 v71, v66, v67
    v_lshlrev_b32 v60, 16, v68
    v_and_b32 v61, 0xffff0000, v68
    v_lshlrev_b32 v62, 16, v69
    v_and_b32 v63, 0xffff0000, v69
    v_lshlrev_b32 v64, 16, v70
    v_and_b32 v65, 0xffff0000, v70
    v_lshlrev_b32 v66, 16, v71
    v_and_b32 v67, 0xffff0000, v71
    v_mul_f32 v60, 0xc1200000, v60
    v_mul_f32 v61, 0xc1200000, v61
    v_mul_f32 v62, 0xc1200000, v62
    v_mul_f32 v63, 0xc1200000, v63
    v_mul_f32 v64, 0xc1200000, v64
    v_mul_f32 v65, 0xc1200000, v65
    v_mul_f32 v66, 0xc1200000, v66
    v_mul_f32 v67, 0xc1200000, v67
    v_cvt_pk_bf16_f32 v68, v60, v61
    v_cvt_pk_bf16_f32 v69, v62, v63
    v_cvt_pk_bf16_f32 v70, v64, v65
    v_cvt_pk_bf16_f32 v71, v66, v67
    v_lshlrev_b32 v60, 16, v68
    v_and_b32 v61, 0xffff0000, v68
    v_lshlrev_b32 v62, 16, v69
    v_and_b32 v63, 0xffff0000, v69
    v_lshlrev_b32 v64, 16, v70
    v_and_b32 v65, 0xffff0000, v70
    v_lshlrev_b32 v66, 16, v71
    v_and_b32 v67, 0xffff0000, v71
    v_mul_f32 v60, 0x3fb8aa3b, v60
    v_mul_f32 v61, 0x3fb8aa3b, v61
    v_mul_f32 v62, 0x3fb8aa3b, v62
    v_mul_f32 v63, 0x3fb8aa3b, v63
    v_mul_f32 v64, 0x3fb8aa3b, v64
    v_mul_f32 v65, 0x3fb8aa3b, v65
    v_mul_f32 v66, 0x3fb8aa3b, v66
    v_mul_f32 v67, 0x3fb8aa3b, v67
    v_exp_f32 v60, v60
    v_exp_f32 v61, v61
    v_exp_f32 v62, v62
    v_exp_f32 v63, v63
    v_exp_f32 v64, v64
    v_exp_f32 v65, v65
    v_exp_f32 v66, v66
    v_exp_f32 v67, v67
    v_cvt_pk_bf16_f32 v76, v60, v61
    v_cvt_pk_bf16_f32 v77, v62, v63
    v_cvt_pk_bf16_f32 v78, v64, v65
    v_cvt_pk_bf16_f32 v79, v66, v67
    v_mfma_f32_4x4x4_16b_bf16 v[80:83], v[48:49], v[72:73], 0
    v_mfma_f32_4x4x4_16b_bf16 v[88:91], v[52:53], v[72:73], 0
    v_mfma_f32_4x4x4_16b_bf16 v[84:87], v[48:49], v[76:77], 0
    v_mfma_f32_4x4x4_16b_bf16 v[92:95], v[52:53], v[76:77], 0
    v_mfma_f32_4x4x4_16b_bf16 v[80:83], v[50:51], v[74:75], v[80:83]
    v_mfma_f32_4x4x4_16b_bf16 v[88:91], v[54:55], v[74:75], v[88:91]
    v_mfma_f32_4x4x4_16b_bf16 v[84:87], v[50:51], v[78:79], v[84:87]
    v_mfma_f32_4x4x4_16b_bf16 v[92:95], v[54:55], v[78:79], v[92:95]
    s_lshl_b32 s3, s34, 9
    s_lshl_b32 s4, s33, 7
    s_add_u32 s4, s4, s3
    v_mov_b32 v104, 1
    v_and_b32 v105, 0x3f0, v122
    v_lshlrev_b32 v105, 3, v105
    v_add_u32 v106, 81920, v118
    ds_read_b128 v[32:35], v106
    v_add_u32 v106, 81920, v119
    ds_read_b128 v[60:63], v106
    s_waitcnt vmcnt(0)
    s_barrier
    s_cmp_lg_u32 s32, 0
    s_cbranch_scc1 L2_f2
    s_mov_b64 exec, 1
    buffer_store_dword v104, off, s[8:11], s4 sc1
    s_mov_b64 exec, 15
    s_bitset0_b64 exec, s33
L2_f3:
    buffer_load_dword v104, v105, s[8:11], s3 offen sc1
    s_waitcnt vmcnt(0)
    v_cmp_ne_u32 vcc, 1, v104
    s_cbranch_vccnz L2_f3s
    s_mov_b64 exec, -1
L2_f2:
    s_barrier
    buffer_load_dwordx4 v[36:39], v122, s[20:23], s44 offen sc1
    buffer_load_dwordx4 v[40:43], v122, s[20:23], s45 offen sc1
    buffer_load_dwordx4 v[44:47], v122, s[20:23], s46 offen sc1
    s_cmp_ge_u32 s32, 4
    s_cbranch_scc1 L2_f5
    buffer_load_dwordx4 v[64:67], v123, s[20:23], s44 offen sc1
    buffer_load_dwordx4 v[68:71], v123, s[20:23], s45 offen sc1
    buffer_load_dwordx4 v[72:75], v123, s[20:23], s46 offen sc1
    v_lshlrev_b32 v16, 16, v117
    v_subrev_f32 v96, s50, v16
    v_subrev_f32 v97, s51, v16
    v_subrev_f32 v98, s52, v16
    v_subrev_f32 v99, s53, v16
    v_subrev_f32 v100, s54, v16
    v_subrev_f32 v101, s55, v16
    v_subrev_f32 v102, s56, v16
    v_subrev_f32 v103, s57, v16
    v_cvt_pk_bf16_f32 v0, v96, v97
    v_cvt_pk_bf16_f32 v1, v98, v99
    v_cvt_pk_bf16_f32 v2, v100, v101
    v_cvt_pk_bf16_f32 v3, v102, v103
    v_lshlrev_b32 v96, 16, v0
    v_and_b32 v97, 0xffff0000, v0
    v_lshlrev_b32 v98, 16, v1
    v_and_b32 v99, 0xffff0000, v1
    v_lshlrev_b32 v100, 16, v2
    v_and_b32 v101, 0xffff0000, v2
    v_lshlrev_b32 v102, 16, v3
    v_and_b32 v103, 0xffff0000, v3
    v_mul_f32 v96, v96, v96
    v_mul_f32 v97, v97, v97
    v_mul_f32 v98, v98, v98
    v_mul_f32 v99, v99, v99
    v_mul_f32 v100, v100, v100
    v_mul_f32 v101, v101, v101
    v_mul_f32 v102, v102, v102
    v_mul_f32 v103, v103, v103
    v_cvt_pk_bf16_f32 v0, v96, v97
    v_cvt_pk_bf16_f32 v1, v98, v99
    v_cvt_pk_bf16_f32 v2, v100, v101
    v_cvt_pk_bf16_f32 v3, v102, v103
    v_lshlrev_b32 v96, 16, v0
    v_and_b32 v97, 0xffff0000, v0
    v_lshlrev_b32 v98, 16, v1
    v_and_b32 v99, 0xffff0000, v1
    v_lshlrev_b32 v100, 16, v2
    v_and_b32 v101, 0xffff0000, v2
    v_lshlrev_b32 v102, 16, v3
    v_and_b32 v103, 0xffff0000, v3
    v_mul_f32 v96, 0xc1200000, v96
    v_mul_f32 v97, 0xc1200000, v97
    v_mul_f32 v98, 0xc1200000, v98
    v_mul_f32 v99, 0xc1200000, v99
    v_mul_f32 v100, 0xc1200000, v100
    v_mul_f32 v101, 0xc1200000, v101
    v_mul_f32 v102, 0xc1200000, v102
    v_mul_f32 v103, 0xc1200000, v103
    v_cvt_pk_bf16_f32 v0, v96, v97
    v_cvt_pk_bf16_f32 v1, v98, v99
    v_cvt_pk_bf16_f32 v2, v100, v101
    v_cvt_pk_bf16_f32 v3, v102, v103
    v_lshlrev_b32 v96, 16, v0
    v_and_b32 v97, 0xffff0000, v0
    v_lshlrev_b32 v98, 16, v1
    v_and_b32 v99, 0xffff0000, v1
    v_lshlrev_b32 v100, 16, v2
    v_and_b32 v101, 0xffff0000, v2
    v_lshlrev_b32 v102, 16, v3
    v_and_b32 v103, 0xffff0000, v3
    v_mul_f32 v96, 0x3fb8aa3b, v96
    v_mul_f32 v97, 0x3fb8aa3b, v97
    v_mul_f32 v98, 0x3fb8aa3b, v98
    v_mul_f32 v99, 0x3fb8aa3b, v99
    v_mul_f32 v100, 0x3fb8aa3b, v100
    v_mul_f32 v101, 0x3fb8aa3b, v101
    v_mul_f32 v102, 0x3fb8aa3b, v102
    v_mul_f32 v103, 0x3fb8aa3b, v103
    v_exp_f32 v96, v96
    v_exp_f32 v97, v97
    v_exp_f32 v98, v98
    v_exp_f32 v99, v99
    v_exp_f32 v100, v100
    v_exp_f32 v101, v101
    v_exp_f32 v102, v102
    v_exp_f32 v103, v103
    v_cvt_pk_bf16_f32 v104, v96, v97
    v_cvt_pk_bf16_f32 v105, v98, v99
    v_cvt_pk_bf16_f32 v106, v100, v101
    v_cvt_pk_bf16_f32 v107, v102, v103
    v_and_b32 v20, 0xffff0000, v117
    v_subrev_f32 v96, s50, v20
    v_subrev_f32 v97, s51, v20
    v_subrev_f32 v98, s52, v20
    v_subrev_f32 v99, s53, v20
    v_subrev_f32 v100, s54, v20
    v_subrev_f32 v101, s55, v20
    v_subrev_f32 v102, s56, v20
    v_subrev_f32 v103, s57, v20
    v_cvt_pk_bf16_f32 v0, v96, v97
    v_cvt_pk_bf16_f32 v1, v98, v99
    v_cvt_pk_bf16_f32 v2, v100, v101
    v_cvt_pk_bf16_f32 v3, v102, v103
    v_lshlrev_b32 v96, 16, v0
    v_and_b32 v97, 0xffff0000, v0
    v_lshlrev_b32 v98, 16, v1
    v_and_b32 v99, 0xffff0000, v1
    v_lshlrev_b32 v100, 16, v2
    v_and_b32 v101, 0xffff0000, v2
    v_lshlrev_b32 v102, 16, v3
    v_and_b32 v103, 0xffff0000, v3
    v_mul_f32 v96, v96, v96
    v_mul_f32 v97, v97, v97
    v_mul_f32 v98, v98, v98
    v_mul_f32 v99, v99, v99
    v_mul_f32 v100, v100, v100
    v_mul_f32 v101, v101, v101
    v_mul_f32 v102, v102, v102
    v_mul_f32 v103, v103, v103
    v_cvt_pk_bf16_f32 v0, v96, v97
    v_cvt_pk_bf16_f32 v1, v98, v99
    v_cvt_pk_bf16_f32 v2, v100, v101
    v_cvt_pk_bf16_f32 v3, v102, v103
    v_lshlrev_b32 v96, 16, v0
    v_and_b32 v97, 0xffff0000, v0
    v_lshlrev_b32 v98, 16, v1
    v_and_b32 v99, 0xffff0000, v1
    v_lshlrev_b32 v100, 16, v2
    v_and_b32 v101, 0xffff0000, v2
    v_lshlrev_b32 v102, 16, v3
    v_and_b32 v103, 0xffff0000, v3
    v_mul_f32 v96, 0xc1200000, v96
    v_mul_f32 v97, 0xc1200000, v97
    v_mul_f32 v98, 0xc1200000, v98
    v_mul_f32 v99, 0xc1200000, v99
    v_mul_f32 v100, 0xc1200000, v100
    v_mul_f32 v101, 0xc1200000, v101
    v_mul_f32 v102, 0xc1200000, v102
    v_mul_f32 v103, 0xc1200000, v103
    v_cvt_pk_bf16_f32 v0, v96, v97
    v_cvt_pk_bf16_f32 v1, v98, v99
    v_cvt_pk_bf16_f32 v2, v100, v101
    v_cvt_pk_bf16_f32 v3, v102, v103
    v_lshlrev_b32 v96, 16, v0
    v_and_b32 v97, 0xffff0000, v0
    v_lshlrev_b32 v98, 16, v1
    v_and_b32 v99, 0xffff0000, v1
    v_lshlrev_b32 v100, 16, v2
    v_and_b32 v101, 0xffff0000, v2
    v_lshlrev_b32 v102, 16, v3
    v_and_b32 v103, 0xffff0000, v3
    v_mul_f32 v96, 0x3fb8aa3b, v96
    v_mul_f32 v97, 0x3fb8aa3b, v97
    v_mul_f32 v98, 0x3fb8aa3b, v98
    v_mul_f32 v99, 0x3fb8aa3b, v99
    v_mul_f32 v100, 0x3fb8aa3b, v100
    v_mul_f32 v101, 0x3fb8aa3b, v101
    v_mul_f32 v102, 0x3fb8aa3b, v102
    v_mul_f32 v103, 0x3fb8aa3b, v103
    v_exp_f32 v96, v96
    v_exp_f32 v97, v97
    v_exp_f32 v98, v98
    v_exp_f32 v99, v99
    v_exp_f32 v100, v100
    v_exp_f32 v101, v101
    v_exp_f32 v102, v102
    v_exp_f32 v103, v103
    v_cvt_pk_bf16_f32 v76, v96, v97
    v_cvt_pk_bf16_f32 v77, v98, v99
    v_cvt_pk_bf16_f32 v78, v100, v101
    v_cvt_pk_bf16_f32 v79, v102, v103
    v_mfma_f32_4x4x4_16b_bf16 v[16:19], v[48:49], v[104:105], 0
    v_mfma_f32_4x4x4_16b_bf16 v[24:27], v[52:53], v[104:105], 0
    v_mfma_f32_4x4x4_16b_bf16 v[20:23], v[48:49], v[76:77], 0
    v_mfma_f32_4x4x4_16b_bf16 v[28:31], v[52:53], v[76:77], 0
    v_mfma_f32_4x4x4_16b_bf16 v[16:19], v[50:51], v[106:107], v[16:19]
    v_mfma_f32_4x4x4_16b_bf16 v[24:27], v[54:55], v[106:107], v[24:27]
    v_mfma_f32_4x4x4_16b_bf16 v[20:23], v[50:51], v[78:79], v[20:23]
    v_mfma_f32_4x4x4_16b_bf16 v[28:31], v[54:55], v[78:79], v[28:31]
L2_f5:
    s_waitcnt vmcnt(0) lgkmcnt(0)
    v_mfma_f32_4x4x4_16b_bf16 v[96:99], v[10:11], v[32:33], 0
    v_mfma_f32_4x4x4_16b_bf16 v[100:103], v[10:11], v[34:35], 0
    s_nop 0
    v_mfma_f32_4x4x4_16b_bf16 v[96:99], v[10:11], v[36:37], v[96:99]
    v_mfma_f32_4x4x4_16b_bf16 v[100:103], v[10:11], v[38:39], v[100:103]
    s_nop 0
    v_mfma_f32_4x4x4_16b_bf16 v[96:99], v[10:11], v[40:41], v[96:99]
    v_mfma_f32_4x4x4_16b_bf16 v[100:103], v[10:11], v[42:43], v[100:103]
    s_nop 0
    v_mfma_f32_4x4x4_16b_bf16 v[96:99], v[10:11], v[44:45], v[96:99]
    v_mfma_f32_4x4x4_16b_bf16 v[100:103], v[10:11], v[46:47], v[100:103]
    s_nop 3
    v_mul_f32 v96, v96, v80
    v_mul_f32 v97, v97, v81
    v_mul_f32 v98, v98, v82
    v_mul_f32 v99, v99, v83
    v_cvt_pk_bf16_f32 v32, v96, v97
    v_cvt_pk_bf16_f32 v33, v98, v99
    v_mul_f32 v100, v100, v84
    v_mul_f32 v101, v101, v85
    v_mul_f32 v102, v102, v86
    v_mul_f32 v103, v103, v87
    v_cvt_pk_bf16_f32 v34, v100, v101
    v_cvt_pk_bf16_f32 v35, v102, v103
    v_mfma_f32_4x4x4_16b_bf16 v[80:83], v[56:57], v[32:33], 0
    s_nop 0
    v_mfma_f32_4x4x4_16b_bf16 v[84:87], v[56:57], v[34:35], 0
    s_nop 2
    v_mul_f32 v80, v80, v88
    v_mul_f32 v81, v81, v89
    v_mul_f32 v82, v82, v90
    v_mul_f32 v83, v83, v91
    v_mul_f32 v84, v84, v92
    v_mul_f32 v85, v85, v93
    v_mul_f32 v86, v86, v94
    v_mul_f32 v87, v87, v95
    v_mfma_f32_4x4x4_16b_bf16 v[96:99], v[10:11], v[108:109], v[80:83]
    s_nop 0
    v_mfma_f32_4x4x4_16b_bf16 v[100:103], v[10:11], v[110:111], v[84:87]
    s_nop 2
    v_cvt_pk_bf16_f32 v36, v96, v97
    v_cvt_pk_bf16_f32 v37, v98, v99
    v_cvt_pk_bf16_f32 v38, v100, v101
    v_cvt_pk_bf16_f32 v39, v102, v103
    buffer_store_dwordx4 v[36:39], v120, s[12:15], 0 offen nt
    s_cmp_ge_u32 s32, 4
    s_cbranch_scc1 L2_f6
    v_mfma_f32_4x4x4_16b_bf16 v[96:99], v[10:11], v[60:61], 0
    v_mfma_f32_4x4x4_16b_bf16 v[100:103], v[10:11], v[62:63], 0
    s_nop 0
    v_mfma_f32_4x4x4_16b_bf16 v[96:99], v[10:11], v[64:65], v[96:99]
    v_mfma_f32_4x4x4_16b_bf16 v[100:103], v[10:11], v[66:67], v[100:103]
    s_nop 0
    v_mfma_f32_4x4x4_16b_bf16 v[96:99], v[10:11], v[68:69], v[96:99]
    v_mfma_f32_4x4x4_16b_bf16 v[100:103], v[10:11], v[70:71], v[100:103]
    s_nop 0
    v_mfma_f32_4x4x4_16b_bf16 v[96:99], v[10:11], v[72:73], v[96:99]
    v_mfma_f32_4x4x4_16b_bf16 v[100:103], v[10:11], v[74:75], v[100:103]
    s_nop 3
    v_mul_f32 v96, v96, v16
    v_mul_f32 v97, v97, v17
    v_mul_f32 v98, v98, v18
    v_mul_f32 v99, v99, v19
    v_cvt_pk_bf16_f32 v60, v96, v97
    v_cvt_pk_bf16_f32 v61, v98, v99
    v_mul_f32 v100, v100, v20
    v_mul_f32 v101, v101, v21
    v_mul_f32 v102, v102, v22
    v_mul_f32 v103, v103, v23
    v_cvt_pk_bf16_f32 v62, v100, v101
    v_cvt_pk_bf16_f32 v63, v102, v103
    v_mfma_f32_4x4x4_16b_bf16 v[16:19], v[56:57], v[60:61], 0
    s_nop 0
    v_mfma_f32_4x4x4_16b_bf16 v[20:23], v[56:57], v[62:63], 0
    s_nop 2
    v_mul_f32 v16, v16, v24
    v_mul_f32 v17, v17, v25
    v_mul_f32 v18, v18, v26
    v_mul_f32 v19, v19, v27
    v_mul_f32 v20, v20, v28
    v_mul_f32 v21, v21, v29
    v_mul_f32 v22, v22, v30
    v_mul_f32 v23, v23, v31
    v_mfma_f32_4x4x4_16b_bf16 v[96:99], v[10:11], v[112:113], v[16:19]
    s_nop 0
    v_mfma_f32_4x4x4_16b_bf16 v[100:103], v[10:11], v[114:115], v[20:23]
    s_nop 2
    v_cvt_pk_bf16_f32 v64, v96, v97
    v_cvt_pk_bf16_f32 v65, v98, v99
    v_cvt_pk_bf16_f32 v66, v100, v101
    v_cvt_pk_bf16_f32 v67, v102, v103
    buffer_store_dwordx4 v[64:67], v121, s[12:15], 0 offen nt
L2_f6:
L2_end:
    s_endpgm
L2_slow:
    s_lshr_b32 s35, s42, 2
    s_lshl_b32 s50, s32, 4
    s_and_b32 s3, s42, 3
    s_lshl_b32 s53, s3, 3
    s_add_u32 s53, s53, s39
    s_and_b32 s3, s35, 2
    s_lshl_b32 s3, s3, 1
    s_add_u32 s53, s53, s3
    s_and_b32 s54, s35, 1
    s_lshl_b32 s54, s54, 4
L2_sl_seg:
    s_mul_i32 s55, s50, 173056
    s_and_b32 s3, s50, 3
    s_lshl_b32 s3, s3, 5
    s_add_u32 s3, s3, s55
    s_add_u32 s3, s3, s53
    buffer_load_dword v104, off, s[12:15], s3 sc1
    buffer_load_dword v105, off, s[12:15], s3 offset:32 sc1
    s_waitcnt vmcnt(0)
    v_readfirstlane_b32 s51, v104
    v_readfirstlane_b32 s52, v105
    s_lshr_b32 s51, s51, s54
    s_and_b32 s51, s51, 0xffff
    s_lshr_b32 s52, s52, s54
    s_and_b32 s52, s52, 0xffff
L2_sl_rec:
    s_cmp_ge_u32 s51, s52
    s_cbranch_scc1 L2_sl_next
    v_mbcnt_lo_u32_b32 v102, -1, 0
    v_mbcnt_hi_u32_b32 v102, -1, v102
    v_add_u32 v102, s51, v102
    v_and_b32 v103, -4, v102
    v_lshl_add_u32 v104, v102, 2, v103
    v_lshl_add_u32 v105, v103, 2, v102
    v_cmp_gt_u32 vcc, s52, v102
    s_mov_b64 exec, vcc
    buffer_load_dword v106, v104, s[8:11], s55 offen
    buffer_load_ubyte v107, v105, s[8:11], s55 offen offset:16
    s_waitcnt vmcnt(0)
    v_lshrrev_b32 v98, 14, v106
    v_and_b32 v98, v5, v98
    ds_read_b64 v[100:101], v98
    v_perm_b32 v97, v106, v107, s44
    v_and_b32 v96, v5, v106
    v_bitop3_b32 v103, v106, 0.5, -0.5 bitop3:0xa8
    v_bitop3_b32 v97, v6, v97, v103 bitop3:0xca
    s_waitcnt lgkmcnt(0)
    v_mfma_f32_4x4x4_16b_bf16 v[88:91], v[8:9], v[100:101], 0
    s_nop 4
    v_mul_f32 v88, v97, v88
    v_mul_f32 v89, v97, v89
    v_mul_f32 v90, v97, v90
    v_mul_f32 v91, v97, v91
    v_cvt_pk_bf16_f32 v88, v88, v89
    v_cvt_pk_bf16_f32 v89, v90, v91
    ds_pk_add_bf16 v96, v88 offset:65408
    ds_pk_add_bf16 v96, v89 offset:65412
    s_mov_b64 exec, -1
    s_add_u32 s51, s51, 64
    s_branch L2_sl_rec
L2_sl_next:
    s_add_u32 s50, s50, 1
    s_and_b32 s3, s50, 15
    s_cbranch_scc1 L2_sl_seg
    s_add_u32 s50, s50, 240
    s_cmp_lt_u32 s50, 1280
    s_cbranch_scc1 L2_sl_seg
    s_waitcnt lgkmcnt(0)
    s_cmp_eq_u32 s42, 0
    s_cbranch_scc1 L2_ret0
    s_cmp_eq_u32 s42, 1
    s_cbranch_scc1 L2_ret1
    s_cmp_eq_u32 s42, 14
    s_cbranch_scc1 L2_ret6
    s_cmp_eq_u32 s42, 15
    s_cbranch_scc1 L2_ret7
    s_and_b32 s3, s42, 3
    s_cmp_eq_u32 s3, 2
    s_cbranch_scc1 L2_ret2
    s_cmp_eq_u32 s3, 3
    s_cbranch_scc1 L2_ret3
    s_cmp_eq_u32 s3, 0
    s_cbranch_scc1 L2_ret4
    s_branch L2_ret5
L2_xo3:
    v_cmp_lt_u32 vcc, 20, v99
    s_mov_b32 s101, 1
    s_cbranch_vccz L2_xp3
    v_cmp_lt_u32 vcc, 32, v99
    v_cmp_lt_u32 s[58:59], 31, v88
    s_mov_b32 s101, 2
    s_or_b64 vcc, vcc, s[58:59]
    s_cbranch_scc0 L2_xp3
    s_mov_b32 s37, 0x10000
    s_branch L2_xp3
L2_xa4:
    s_cmp_eq_u32 s101, 1
    s_cbranch_scc1 L2_xc4
    v_lshlrev_b32 v89, 0, v96
    v_add_u32 v90, 140, v97
    v_bitop3_b32 v90, v89, v45, v90 bitop3:0x6a
    ds_write_b32 v98, v90 offset:28
    v_lshlrev_b32 v89, 4, v96
    v_add_u32 v90, 120, v97
    v_bitop3_b32 v90, v89, v45, v90 bitop3:0x6a
    ds_write_b32 v98, v90 offset:24
    v_lshlrev_b32 v89, 8, v96
    v_add_u32 v90, 100, v97
    v_bitop3_b32 v90, v89, v45, v90 bitop3:0x6a
    ds_write_b32 v98, v90 offset:20
L2_xc4:
    v_lshlrev_b32 v89, 12, v96
    v_add_u32 v90, 80, v97
    v_bitop3_b32 v90, v89, v45, v90 bitop3:0x6a
    ds_write_b32 v98, v90 offset:16
    s_branch L2_xb4
L2_xe4:
    v_cmp_lt_u32 vcc, 32, v99
    v_cmp_lt_u32 s[58:59], 31, v88
    v_lshrrev_b32 v89, 16, v96
    v_add_u32 v97, 80, v97
    s_or_b64 vcc, vcc, s[58:59]
    s_cbranch_scc1 L2_xs4
    v_lshlrev_b32 v89, v1, v89
    v_and_b32 v89, v45, v89
    v_cmp_ne_u32 vcc, 0, v89
    v_xor_b32 v90, v97, v89
    s_add_u32 s3, s37, s38
    v_mbcnt_lo_u32_b32 v98, vcc_lo, 0
    v_mbcnt_hi_u32_b32 v98, vcc_hi, v98
    s_bcnt1_i32_b64 s41, vcc
    v_lshl_add_u32 v98, v98, 2, s3
    s_lshl2_add_u32 s37, s41, s37
    s_mov_b64 exec, vcc
    ds_write_b32 v98, v90
    s_mov_b64 exec, -1
    s_branch L2_xr4
L2_xs4:
    s_waitcnt lgkmcnt(0)
    s_mov_b32 s37, 0x10000
    s_branch L2_xw4
L2_xf4:
    s_cmp_gt_u32 s37, 1024
    s_cbranch_scc1 L2_xt4
    s_cmp_lt_u32 s37, 768
    s_cbranch_scc1 L2_xl4
    ds_read_b32 v32, v44 offset:896
    s_add_u32 s3, s42, 0
    s_bitset1_b32 s43, s3
    s_branch L2_xg4
L2_xl4:
    s_waitcnt lgkmcnt(0)
    v_mov_b32 v31, -1
    s_cmp_ge_u32 s37, 512
    s_cbranch_scc1 L2_xg4
    v_mov_b32 v39, -1
    s_cmp_ge_u32 s37, 256
    s_cbranch_scc1 L2_xg4
    v_mov_b32 v27, -1
    s_branch L2_xg4
L2_xt4:
    s_waitcnt lgkmcnt(0)
    v_mov_b32 v21, -1
    v_mov_b32 v27, -1
    v_mov_b32 v39, -1
    v_mov_b32 v31, -1
    s_add_u32 s3, s42, 0
    s_bitset1_b32 s36, s3
    s_branch L2_xg4
L2_xo5:
    v_cmp_lt_u32 vcc, 20, v99
    s_mov_b32 s101, 1
    s_cbranch_vccz L2_xp5
    v_cmp_lt_u32 vcc, 32, v99
    v_cmp_lt_u32 s[58:59], 31, v88
    s_mov_b32 s101, 2
    s_or_b64 vcc, vcc, s[58:59]
    s_cbranch_scc0 L2_xp5
    s_mov_b32 s37, 0x10000
    s_branch L2_xp5
L2_xa6:
    s_cmp_eq_u32 s101, 1
    s_cbranch_scc1 L2_xc6
    v_lshlrev_b32 v89, 0, v96
    v_add_u32 v90, 140, v97
    v_bitop3_b32 v90, v89, v45, v90 bitop3:0x6a
    ds_write_b32 v98, v90 offset:28
    v_lshlrev_b32 v89, 4, v96
    v_add_u32 v90, 120, v97
    v_bitop3_b32 v90, v89, v45, v90 bitop3:0x6a
    ds_write_b32 v98, v90 offset:24
    v_lshlrev_b32 v89, 8, v96
    v_add_u32 v90, 100, v97
    v_bitop3_b32 v90, v89, v45, v90 bitop3:0x6a
    ds_write_b32 v98, v90 offset:20
L2_xc6:
    v_lshlrev_b32 v89, 12, v96
    v_add_u32 v90, 80, v97
    v_bitop3_b32 v90, v89, v45, v90 bitop3:0x6a
    ds_write_b32 v98, v90 offset:16
    s_branch L2_xb6
L2_xe6:
    v_cmp_lt_u32 vcc, 32, v99
    v_cmp_lt_u32 s[58:59], 31, v88
    v_lshrrev_b32 v89, 16, v96
    v_add_u32 v97, 80, v97
    s_or_b64 vcc, vcc, s[58:59]
    s_cbranch_scc1 L2_xs6
    v_lshlrev_b32 v89, v1, v89
    v_and_b32 v89, v45, v89
    v_cmp_ne_u32 vcc, 0, v89
    v_xor_b32 v90, v97, v89
    s_add_u32 s3, s37, s38
    v_mbcnt_lo_u32_b32 v98, vcc_lo, 0
    v_mbcnt_hi_u32_b32 v98, vcc_hi, v98
    s_bcnt1_i32_b64 s41, vcc
    v_lshl_add_u32 v98, v98, 2, s3
    s_lshl2_add_u32 s37, s41, s37
    s_mov_b64 exec, vcc
    ds_write_b32 v98, v90
    s_mov_b64 exec, -1
    s_branch L2_xr6
L2_xs6:
    s_waitcnt lgkmcnt(0)
    s_mov_b32 s37, 0x10000
    s_branch L2_xw6
L2_xf6:
    s_cmp_gt_u32 s37, 1024
    s_cbranch_scc1 L2_xt6
    s_cmp_lt_u32 s37, 768
    s_cbranch_scc1 L2_xl6
    ds_read_b32 v33, v44 offset:896
    s_add_u32 s3, s42, 1
    s_bitset1_b32 s43, s3
    s_branch L2_xg6
L2_xl6:
    s_waitcnt lgkmcnt(0)
    v_mov_b32 v42, -1
    s_cmp_ge_u32 s37, 512
    s_cbranch_scc1 L2_xg6
    v_mov_b32 v43, -1
    s_cmp_ge_u32 s37, 256
    s_cbranch_scc1 L2_xg6
    v_mov_b32 v41, -1
    s_branch L2_xg6
L2_xt6:
    s_waitcnt lgkmcnt(0)
    v_mov_b32 v40, -1
    v_mov_b32 v41, -1
    v_mov_b32 v43, -1
    v_mov_b32 v42, -1
    s_add_u32 s3, s42, 1
    s_bitset1_b32 s36, s3
    s_branch L2_xg6
L2_oa7:
    v_and_b32 v47, 0x0fffffff, v32
    buffer_load_dword v78, v47, s[8:11], 0 offen offset:16
    s_mov_b64 exec, s[6:7]
    v_add_u32 v47, 8, v47
    v_lshrrev_b32 v32, 2, v32
    s_mov_b64 exec, -1
    buffer_load_dwordx2 v[76:77], v47, s[8:11], 0 offen
    s_branch L2_ob7
L2_oa8:
    s_waitcnt vmcnt(0)
    s_mov_b64 exec, s[6:7]
    v_lshrrev_b32 v78, 16, v78
    s_mov_b64 exec, -1
    v_and_b32 v46, 0x10000000, v32
    v_cmpx_eq_u32 vcc, 0, v46
    v_lshrrev_b32 v47, 14, v76
    v_and_b32 v47, v5, v47
    ds_read_b64 v[96:97], v47
    v_perm_b32 v98, v76, v78, s44
    v_bitop3_b32 v99, v76, 0.5, -0.5 bitop3:0xa8
    v_bitop3_b32 v98, v6, v98, v99 bitop3:0xca
    v_and_b32 v47, v5, v76
    s_waitcnt lgkmcnt(0)
    v_mfma_f32_4x4x4_16b_bf16 v[88:91], v[8:9], v[96:97], 0
    s_nop 4
    v_mul_f32 v88, v98, v88
    v_mul_f32 v89, v98, v89
    v_mul_f32 v90, v98, v90
    v_mul_f32 v91, v98, v91
    v_cvt_pk_bf16_f32 v88, v88, v89
    v_cvt_pk_bf16_f32 v89, v90, v91
    ds_pk_add_bf16 v47, v88 offset:65408
    ds_pk_add_bf16 v47, v89 offset:65412
    s_mov_b64 exec, -1
    v_and_b32 v46, 0x20000000, v32
    v_cmpx_eq_u32 vcc, 0, v46
    v_lshrrev_b32 v47, 14, v77
    v_and_b32 v47, v5, v47
    ds_read_b64 v[96:97], v47
    v_perm_b32 v98, v77, v78, s45
    v_bitop3_b32 v99, v77, 0.5, -0.5 bitop3:0xa8
    v_bitop3_b32 v98, v6, v98, v99 bitop3:0xca
    v_and_b32 v47, v5, v77
    s_waitcnt lgkmcnt(0)
    v_mfma_f32_4x4x4_16b_bf16 v[88:91], v[8:9], v[96:97], 0
    s_nop 4
    v_mul_f32 v88, v98, v88
    v_mul_f32 v89, v98, v89
    v_mul_f32 v90, v98, v90
    v_mul_f32 v91, v98, v91
    v_cvt_pk_bf16_f32 v88, v88, v89
    v_cvt_pk_bf16_f32 v89, v90, v91
    ds_pk_add_bf16 v47, v88 offset:65408
    ds_pk_add_bf16 v47, v89 offset:65412
    s_mov_b64 exec, -1
    s_branch L2_ob8
L2_c9:
    s_lshl_b64 s[52:53], s[82:83], 1
    s_andn2_b64 s[52:53], s[52:53], s[80:81]
    s_andn2_b64 s[52:53], s[52:53], s[54:55]
    s_or_b64 s[80:81], s[80:81], s[52:53]
    s_not_b64 vcc, s[52:53]
    s_mov_b64 exec, -1
    v_cndmask_b32_dpp v84, v84, v84, vcc wave_shr:1 row_mask:0xf bank_mask:0xf
    v_cndmask_b32_dpp v85, v85, v85, vcc wave_shr:1 row_mask:0xf bank_mask:0xf
    s_lshr_b64 s[52:53], s[52:53], 1
    v_cndmask_b32_dpp v86, v86, v86, vcc wave_shr:1 row_mask:0xf bank_mask:0xf
    v_cndmask_b32_dpp v87, v87, v87, vcc wave_shr:1 row_mask:0xf bank_mask:0xf
    s_andn2_b64 s[82:83], s[82:83], s[52:53]
    v_cndmask_b32_dpp v7, v7, v7, vcc wave_shr:1 row_mask:0xf bank_mask:0xf
    s_mov_b64 exec, s[54:55]
    s_cbranch_scc0 L2_d9
    s_mov_b64 exec, s[82:83]
    s_nop 1
    v_mfma_f32_4x4x4_16b_bf16 v[88:91], v[12:13], v[84:85], 0
    s_nop 1
    v_mfma_f32_4x4x4_16b_bf16 v[88:91], v[10:11], v[86:87], v[88:91]
    s_nop 4
    v_cvt_pk_bf16_f32 v88, v88, v89
    v_cvt_pk_bf16_f32 v89, v90, v91
    ds_pk_add_bf16 v7, v88 offset:65408
    ds_pk_add_bf16 v7, v89 offset:65412
    s_mov_b64 exec, s[54:55]
    s_branch L2_d9
L2_c10:
    s_lshl_b64 s[52:53], s[82:83], 1
    s_andn2_b64 s[52:53], s[52:53], s[80:81]
    s_andn2_b64 s[52:53], s[52:53], s[50:51]
    s_or_b64 s[80:81], s[80:81], s[52:53]
    s_not_b64 vcc, s[52:53]
    s_mov_b64 exec, -1
    v_cndmask_b32_dpp v84, v84, v84, vcc wave_shr:1 row_mask:0xf bank_mask:0xf
    v_cndmask_b32_dpp v85, v85, v85, vcc wave_shr:1 row_mask:0xf bank_mask:0xf
    s_lshr_b64 s[52:53], s[52:53], 1
    v_cndmask_b32_dpp v86, v86, v86, vcc wave_shr:1 row_mask:0xf bank_mask:0xf
    v_cndmask_b32_dpp v87, v87, v87, vcc wave_shr:1 row_mask:0xf bank_mask:0xf
    s_andn2_b64 s[82:83], s[82:83], s[52:53]
    v_cndmask_b32_dpp v7, v7, v7, vcc wave_shr:1 row_mask:0xf bank_mask:0xf
    s_mov_b64 exec, s[50:51]
    s_cbranch_scc0 L2_d10
    s_mov_b64 exec, s[82:83]
    s_nop 1
    v_mfma_f32_4x4x4_16b_bf16 v[88:91], v[12:13], v[84:85], 0
    s_nop 1
    v_mfma_f32_4x4x4_16b_bf16 v[88:91], v[10:11], v[86:87], v[88:91]
    s_nop 4
    v_cvt_pk_bf16_f32 v88, v88, v89
    v_cvt_pk_bf16_f32 v89, v90, v91
    ds_pk_add_bf16 v7, v88 offset:65408
    ds_pk_add_bf16 v7, v89 offset:65412
    s_mov_b64 exec, s[50:51]
    s_branch L2_d10
L2_c13:
    s_lshl_b64 s[52:53], s[82:83], 1
    s_andn2_b64 s[52:53], s[52:53], s[80:81]
    s_andn2_b64 s[52:53], s[52:53], s[54:55]
    s_or_b64 s[80:81], s[80:81], s[52:53]
    s_not_b64 vcc, s[52:53]
    s_mov_b64 exec, -1
    v_cndmask_b32_dpp v84, v84, v84, vcc wave_shr:1 row_mask:0xf bank_mask:0xf
    v_cndmask_b32_dpp v85, v85, v85, vcc wave_shr:1 row_mask:0xf bank_mask:0xf
    s_lshr_b64 s[52:53], s[52:53], 1
    v_cndmask_b32_dpp v86, v86, v86, vcc wave_shr:1 row_mask:0xf bank_mask:0xf
    v_cndmask_b32_dpp v87, v87, v87, vcc wave_shr:1 row_mask:0xf bank_mask:0xf
    s_andn2_b64 s[82:83], s[82:83], s[52:53]
    v_cndmask_b32_dpp v7, v7, v7, vcc wave_shr:1 row_mask:0xf bank_mask:0xf
    s_mov_b64 exec, s[54:55]
    s_cbranch_scc0 L2_d13
    s_mov_b64 exec, s[82:83]
    s_nop 1
    v_mfma_f32_4x4x4_16b_bf16 v[88:91], v[12:13], v[84:85], 0
    s_nop 1
    v_mfma_f32_4x4x4_16b_bf16 v[88:91], v[10:11], v[86:87], v[88:91]
    s_nop 4
    v_cvt_pk_bf16_f32 v88, v88, v89
    v_cvt_pk_bf16_f32 v89, v90, v91
    ds_pk_add_bf16 v7, v88 offset:65408
    ds_pk_add_bf16 v7, v89 offset:65412
    s_mov_b64 exec, s[54:55]
    s_branch L2_d13
L2_c14:
    s_lshl_b64 s[52:53], s[82:83], 1
    s_andn2_b64 s[52:53], s[52:53], s[80:81]
    s_andn2_b64 s[52:53], s[52:53], s[50:51]
    s_or_b64 s[80:81], s[80:81], s[52:53]
    s_not_b64 vcc, s[52:53]
    s_mov_b64 exec, -1
    v_cndmask_b32_dpp v84, v84, v84, vcc wave_shr:1 row_mask:0xf bank_mask:0xf
    v_cndmask_b32_dpp v85, v85, v85, vcc wave_shr:1 row_mask:0xf bank_mask:0xf
    s_lshr_b64 s[52:53], s[52:53], 1
    v_cndmask_b32_dpp v86, v86, v86, vcc wave_shr:1 row_mask:0xf bank_mask:0xf
    v_cndmask_b32_dpp v87, v87, v87, vcc wave_shr:1 row_mask:0xf bank_mask:0xf
    s_andn2_b64 s[82:83], s[82:83], s[52:53]
    v_cndmask_b32_dpp v7, v7, v7, vcc wave_shr:1 row_mask:0xf bank_mask:0xf
    s_mov_b64 exec, s[50:51]
    s_cbranch_scc0 L2_d14
    s_mov_b64 exec, s[82:83]
    s_nop 1
    v_mfma_f32_4x4x4_16b_bf16 v[88:91], v[12:13], v[84:85], 0
    s_nop 1
    v_mfma_f32_4x4x4_16b_bf16 v[88:91], v[10:11], v[86:87], v[88:91]
    s_nop 4
    v_cvt_pk_bf16_f32 v88, v88, v89
    v_cvt_pk_bf16_f32 v89, v90, v91
    ds_pk_add_bf16 v7, v88 offset:65408
    ds_pk_add_bf16 v7, v89 offset:65412
    s_mov_b64 exec, s[50:51]
    s_branch L2_d14
L2_xo16:
    v_cmp_lt_u32 vcc, 20, v99
    s_mov_b32 s101, 1
    s_cbranch_vccz L2_xp16
    v_cmp_lt_u32 vcc, 32, v99
    v_cmp_lt_u32 s[58:59], 31, v88
    s_mov_b32 s101, 2
    s_or_b64 vcc, vcc, s[58:59]
    s_cbranch_scc0 L2_xp16
    s_mov_b32 s37, 0x10000
    s_branch L2_xp16
L2_c17:
    s_lshl_b64 s[52:53], s[82:83], 1
    s_andn2_b64 s[52:53], s[52:53], s[80:81]
    s_andn2_b64 s[52:53], s[52:53], s[54:55]
    s_or_b64 s[80:81], s[80:81], s[52:53]
    s_not_b64 vcc, s[52:53]
    s_mov_b64 exec, -1
    v_cndmask_b32_dpp v84, v84, v84, vcc wave_shr:1 row_mask:0xf bank_mask:0xf
    v_cndmask_b32_dpp v85, v85, v85, vcc wave_shr:1 row_mask:0xf bank_mask:0xf
    s_lshr_b64 s[52:53], s[52:53], 1
    v_cndmask_b32_dpp v86, v86, v86, vcc wave_shr:1 row_mask:0xf bank_mask:0xf
    v_cndmask_b32_dpp v87, v87, v87, vcc wave_shr:1 row_mask:0xf bank_mask:0xf
    s_andn2_b64 s[82:83], s[82:83], s[52:53]
    v_cndmask_b32_dpp v7, v7, v7, vcc wave_shr:1 row_mask:0xf bank_mask:0xf
    s_mov_b64 exec, s[54:55]
    s_cbranch_scc0 L2_d17
    s_mov_b64 exec, s[82:83]
    s_nop 1
    v_mfma_f32_4x4x4_16b_bf16 v[88:91], v[12:13], v[84:85], 0
    s_nop 1
    v_mfma_f32_4x4x4_16b_bf16 v[88:91], v[10:11], v[86:87], v[88:91]
    s_nop 4
    v_cvt_pk_bf16_f32 v88, v88, v89
    v_cvt_pk_bf16_f32 v89, v90, v91
    ds_pk_add_bf16 v7, v88 offset:65408
    ds_pk_add_bf16 v7, v89 offset:65412
    s_mov_b64 exec, s[54:55]
    s_branch L2_d17
L2_c18:
    s_lshl_b64 s[52:53], s[82:83], 1
    s_andn2_b64 s[52:53], s[52:53], s[80:81]
    s_andn2_b64 s[52:53], s[52:53], s[50:51]
    s_or_b64 s[80:81], s[80:81], s[52:53]
    s_not_b64 vcc, s[52:53]
    s_mov_b64 exec, -1
    v_cndmask_b32_dpp v84, v84, v84, vcc wave_shr:1 row_mask:0xf bank_mask:0xf
    v_cndmask_b32_dpp v85, v85, v85, vcc wave_shr:1 row_mask:0xf bank_mask:0xf
    s_lshr_b64 s[52:53], s[52:53], 1
    v_cndmask_b32_dpp v86, v86, v86, vcc wave_shr:1 row_mask:0xf bank_mask:0xf
    v_cndmask_b32_dpp v87, v87, v87, vcc wave_shr:1 row_mask:0xf bank_mask:0xf
    s_andn2_b64 s[82:83], s[82:83], s[52:53]
    v_cndmask_b32_dpp v7, v7, v7, vcc wave_shr:1 row_mask:0xf bank_mask:0xf
    s_mov_b64 exec, s[50:51]
    s_cbranch_scc0 L2_d18
    s_mov_b64 exec, s[82:83]
    s_nop 1
    v_mfma_f32_4x4x4_16b_bf16 v[88:91], v[12:13], v[84:85], 0
    s_nop 1
    v_mfma_f32_4x4x4_16b_bf16 v[88:91], v[10:11], v[86:87], v[88:91]
    s_nop 4
    v_cvt_pk_bf16_f32 v88, v88, v89
    v_cvt_pk_bf16_f32 v89, v90, v91
    ds_pk_add_bf16 v7, v88 offset:65408
    ds_pk_add_bf16 v7, v89 offset:65412
    s_mov_b64 exec, s[50:51]
    s_branch L2_d18
L2_c21:
    s_lshl_b64 s[52:53], s[82:83], 1
    s_andn2_b64 s[52:53], s[52:53], s[80:81]
    s_andn2_b64 s[52:53], s[52:53], s[54:55]
    s_or_b64 s[80:81], s[80:81], s[52:53]
    s_not_b64 vcc, s[52:53]
    s_mov_b64 exec, -1
    v_cndmask_b32_dpp v84, v84, v84, vcc wave_shr:1 row_mask:0xf bank_mask:0xf
    v_cndmask_b32_dpp v85, v85, v85, vcc wave_shr:1 row_mask:0xf bank_mask:0xf
    s_lshr_b64 s[52:53], s[52:53], 1
    v_cndmask_b32_dpp v86, v86, v86, vcc wave_shr:1 row_mask:0xf bank_mask:0xf
    v_cndmask_b32_dpp v87, v87, v87, vcc wave_shr:1 row_mask:0xf bank_mask:0xf
    s_andn2_b64 s[82:83], s[82:83], s[52:53]
    v_cndmask_b32_dpp v7, v7, v7, vcc wave_shr:1 row_mask:0xf bank_mask:0xf
    s_mov_b64 exec, s[54:55]
    s_cbranch_scc0 L2_d21
    s_mov_b64 exec, s[82:83]
    s_nop 1
    v_mfma_f32_4x4x4_16b_bf16 v[88:91], v[12:13], v[84:85], 0
    s_nop 1
    v_mfma_f32_4x4x4_16b_bf16 v[88:91], v[10:11], v[86:87], v[88:91]
    s_nop 4
    v_cvt_pk_bf16_f32 v88, v88, v89
    v_cvt_pk_bf16_f32 v89, v90, v91
    ds_pk_add_bf16 v7, v88 offset:65408
    ds_pk_add_bf16 v7, v89 offset:65412
    s_mov_b64 exec, s[54:55]
    s_branch L2_d21
L2_c22:
    s_lshl_b64 s[52:53], s[82:83], 1
    s_andn2_b64 s[52:53], s[52:53], s[80:81]
    s_andn2_b64 s[52:53], s[52:53], s[50:51]
    s_or_b64 s[80:81], s[80:81], s[52:53]
    s_not_b64 vcc, s[52:53]
    s_mov_b64 exec, -1
    v_cndmask_b32_dpp v84, v84, v84, vcc wave_shr:1 row_mask:0xf bank_mask:0xf
    v_cndmask_b32_dpp v85, v85, v85, vcc wave_shr:1 row_mask:0xf bank_mask:0xf
    s_lshr_b64 s[52:53], s[52:53], 1
    v_cndmask_b32_dpp v86, v86, v86, vcc wave_shr:1 row_mask:0xf bank_mask:0xf
    v_cndmask_b32_dpp v87, v87, v87, vcc wave_shr:1 row_mask:0xf bank_mask:0xf
    s_andn2_b64 s[82:83], s[82:83], s[52:53]
    v_cndmask_b32_dpp v7, v7, v7, vcc wave_shr:1 row_mask:0xf bank_mask:0xf
    s_mov_b64 exec, s[50:51]
    s_cbranch_scc0 L2_d22
    s_mov_b64 exec, s[82:83]
    s_nop 1
    v_mfma_f32_4x4x4_16b_bf16 v[88:91], v[12:13], v[84:85], 0
    s_nop 1
    v_mfma_f32_4x4x4_16b_bf16 v[88:91], v[10:11], v[86:87], v[88:91]
    s_nop 4
    v_cvt_pk_bf16_f32 v88, v88, v89
    v_cvt_pk_bf16_f32 v89, v90, v91
    ds_pk_add_bf16 v7, v88 offset:65408
    ds_pk_add_bf16 v7, v89 offset:65412
    s_mov_b64 exec, s[50:51]
    s_branch L2_d22
L2_c23:
    s_lshl_b64 s[52:53], s[82:83], 1
    s_andn2_b64 s[52:53], s[52:53], s[80:81]
    s_andn2_b64 s[52:53], s[52:53], s[54:55]
    s_or_b64 s[80:81], s[80:81], s[52:53]
    s_not_b64 vcc, s[52:53]
    s_mov_b64 exec, -1
    v_cndmask_b32_dpp v84, v84, v84, vcc wave_shr:1 row_mask:0xf bank_mask:0xf
    v_cndmask_b32_dpp v85, v85, v85, vcc wave_shr:1 row_mask:0xf bank_mask:0xf
    s_lshr_b64 s[52:53], s[52:53], 1
    v_cndmask_b32_dpp v86, v86, v86, vcc wave_shr:1 row_mask:0xf bank_mask:0xf
    v_cndmask_b32_dpp v87, v87, v87, vcc wave_shr:1 row_mask:0xf bank_mask:0xf
    s_andn2_b64 s[82:83], s[82:83], s[52:53]
    v_cndmask_b32_dpp v7, v7, v7, vcc wave_shr:1 row_mask:0xf bank_mask:0xf
    s_mov_b64 exec, s[54:55]
    s_cbranch_scc0 L2_d23
    s_mov_b64 exec, s[82:83]
    s_nop 1
    v_mfma_f32_4x4x4_16b_bf16 v[88:91], v[12:13], v[84:85], 0
    s_nop 1
    v_mfma_f32_4x4x4_16b_bf16 v[88:91], v[10:11], v[86:87], v[88:91]
    s_nop 4
    v_cvt_pk_bf16_f32 v88, v88, v89
    v_cvt_pk_bf16_f32 v89, v90, v91
    ds_pk_add_bf16 v7, v88 offset:65408
    ds_pk_add_bf16 v7, v89 offset:65412
    s_mov_b64 exec, s[54:55]
    s_branch L2_d23
L2_c24:
    s_lshl_b64 s[52:53], s[82:83], 1
    s_andn2_b64 s[52:53], s[52:53], s[80:81]
    s_andn2_b64 s[52:53], s[52:53], s[50:51]
    s_or_b64 s[80:81], s[80:81], s[52:53]
    s_not_b64 vcc, s[52:53]
    s_mov_b64 exec, -1
    v_cndmask_b32_dpp v84, v84, v84, vcc wave_shr:1 row_mask:0xf bank_mask:0xf
    v_cndmask_b32_dpp v85, v85, v85, vcc wave_shr:1 row_mask:0xf bank_mask:0xf
    s_lshr_b64 s[52:53], s[52:53], 1
    v_cndmask_b32_dpp v86, v86, v86, vcc wave_shr:1 row_mask:0xf bank_mask:0xf
    v_cndmask_b32_dpp v87, v87, v87, vcc wave_shr:1 row_mask:0xf bank_mask:0xf
    s_andn2_b64 s[82:83], s[82:83], s[52:53]
    v_cndmask_b32_dpp v7, v7, v7, vcc wave_shr:1 row_mask:0xf bank_mask:0xf
    s_mov_b64 exec, s[50:51]
    s_cbranch_scc0 L2_d24
    s_mov_b64 exec, s[82:83]
    s_nop 1
    v_mfma_f32_4x4x4_16b_bf16 v[88:91], v[12:13], v[84:85], 0
    s_nop 1
    v_mfma_f32_4x4x4_16b_bf16 v[88:91], v[10:11], v[86:87], v[88:91]
    s_nop 4
    v_cvt_pk_bf16_f32 v88, v88, v89
    v_cvt_pk_bf16_f32 v89, v90, v91
    ds_pk_add_bf16 v7, v88 offset:65408
    ds_pk_add_bf16 v7, v89 offset:65412
    s_mov_b64 exec, s[50:51]
    s_branch L2_d24
L2_xa25:
    s_cmp_eq_u32 s101, 1
    s_cbranch_scc1 L2_xc25
    v_lshlrev_b32 v89, 0, v96
    v_add_u32 v90, 140, v97
    v_bitop3_b32 v90, v89, v45, v90 bitop3:0x6a
    ds_write_b32 v98, v90 offset:28
    v_lshlrev_b32 v89, 4, v96
    v_add_u32 v90, 120, v97
    v_bitop3_b32 v90, v89, v45, v90 bitop3:0x6a
    ds_write_b32 v98, v90 offset:24
    v_lshlrev_b32 v89, 8, v96
    v_add_u32 v90, 100, v97
    v_bitop3_b32 v90, v89, v45, v90 bitop3:0x6a
    ds_write_b32 v98, v90 offset:20
L2_xc25:
    v_lshlrev_b32 v89, 12, v96
    v_add_u32 v90, 80, v97
    v_bitop3_b32 v90, v89, v45, v90 bitop3:0x6a
    ds_write_b32 v98, v90 offset:16
    s_branch L2_xb25
L2_xe25:
    v_cmp_lt_u32 vcc, 32, v99
    v_cmp_lt_u32 s[58:59], 31, v88
    v_lshrrev_b32 v89, 16, v96
    v_add_u32 v97, 80, v97
    s_or_b64 vcc, vcc, s[58:59]
    s_cbranch_scc1 L2_xs25
    v_lshlrev_b32 v89, v1, v89
    v_and_b32 v89, v45, v89
    v_cmp_ne_u32 vcc, 0, v89
    v_xor_b32 v90, v97, v89
    s_add_u32 s3, s37, s38
    v_mbcnt_lo_u32_b32 v98, vcc_lo, 0
    v_mbcnt_hi_u32_b32 v98, vcc_hi, v98
    s_bcnt1_i32_b64 s41, vcc
    v_lshl_add_u32 v98, v98, 2, s3
    s_lshl2_add_u32 s37, s41, s37
    s_mov_b64 exec, vcc
    ds_write_b32 v98, v90
    s_mov_b64 exec, -1
    s_branch L2_xr25
L2_xs25:
    s_waitcnt lgkmcnt(0)
    s_mov_b32 s37, 0x10000
    s_branch L2_xw25
L2_c26:
    s_lshl_b64 s[52:53], s[82:83], 1
    s_andn2_b64 s[52:53], s[52:53], s[80:81]
    s_andn2_b64 s[52:53], s[52:53], s[54:55]
    s_or_b64 s[80:81], s[80:81], s[52:53]
    s_not_b64 vcc, s[52:53]
    s_mov_b64 exec, -1
    v_cndmask_b32_dpp v84, v84, v84, vcc wave_shr:1 row_mask:0xf bank_mask:0xf
    v_cndmask_b32_dpp v85, v85, v85, vcc wave_shr:1 row_mask:0xf bank_mask:0xf
    s_lshr_b64 s[52:53], s[52:53], 1
    v_cndmask_b32_dpp v86, v86, v86, vcc wave_shr:1 row_mask:0xf bank_mask:0xf
    v_cndmask_b32_dpp v87, v87, v87, vcc wave_shr:1 row_mask:0xf bank_mask:0xf
    s_andn2_b64 s[82:83], s[82:83], s[52:53]
    v_cndmask_b32_dpp v7, v7, v7, vcc wave_shr:1 row_mask:0xf bank_mask:0xf
    s_mov_b64 exec, s[54:55]
    s_cbranch_scc0 L2_d26
    s_mov_b64 exec, s[82:83]
    s_nop 1
    v_mfma_f32_4x4x4_16b_bf16 v[88:91], v[12:13], v[84:85], 0
    s_nop 1
    v_mfma_f32_4x4x4_16b_bf16 v[88:91], v[10:11], v[86:87], v[88:91]
    s_nop 4
    v_cvt_pk_bf16_f32 v88, v88, v89
    v_cvt_pk_bf16_f32 v89, v90, v91
    ds_pk_add_bf16 v7, v88 offset:65408
    ds_pk_add_bf16 v7, v89 offset:65412
    s_mov_b64 exec, s[54:55]
    s_branch L2_d26
L2_c27:
    s_lshl_b64 s[52:53], s[82:83], 1
    s_andn2_b64 s[52:53], s[52:53], s[80:81]
    s_andn2_b64 s[52:53], s[52:53], s[50:51]
    s_or_b64 s[80:81], s[80:81], s[52:53]
    s_not_b64 vcc, s[52:53]
    s_mov_b64 exec, -1
    v_cndmask_b32_dpp v84, v84, v84, vcc wave_shr:1 row_mask:0xf bank_mask:0xf
    v_cndmask_b32_dpp v85, v85, v85, vcc wave_shr:1 row_mask:0xf bank_mask:0xf
    s_lshr_b64 s[52:53], s[52:53], 1
    v_cndmask_b32_dpp v86, v86, v86, vcc wave_shr:1 row_mask:0xf bank_mask:0xf
    v_cndmask_b32_dpp v87, v87, v87, vcc wave_shr:1 row_mask:0xf bank_mask:0xf
    s_andn2_b64 s[82:83], s[82:83], s[52:53]
    v_cndmask_b32_dpp v7, v7, v7, vcc wave_shr:1 row_mask:0xf bank_mask:0xf
    s_mov_b64 exec, s[50:51]
    s_cbranch_scc0 L2_d27
    s_mov_b64 exec, s[82:83]
    s_nop 1
    v_mfma_f32_4x4x4_16b_bf16 v[88:91], v[12:13], v[84:85], 0
    s_nop 1
    v_mfma_f32_4x4x4_16b_bf16 v[88:91], v[10:11], v[86:87], v[88:91]
    s_nop 4
    v_cvt_pk_bf16_f32 v88, v88, v89
    v_cvt_pk_bf16_f32 v89, v90, v91
    ds_pk_add_bf16 v7, v88 offset:65408
    ds_pk_add_bf16 v7, v89 offset:65412
    s_mov_b64 exec, s[50:51]
    s_branch L2_d27
L2_xf25:
    s_cmp_gt_u32 s37, 1024
    s_cbranch_scc1 L2_xt25
    s_cmp_lt_u32 s37, 768
    s_cbranch_scc1 L2_xl25
    ds_read_b32 v32, v44 offset:896
    s_add_u32 s3, s42, 2
    s_bitset1_b32 s43, s3
    s_branch L2_xg25
L2_xl25:
    s_waitcnt lgkmcnt(0)
    v_mov_b32 v31, -1
    s_cmp_ge_u32 s37, 512
    s_cbranch_scc1 L2_xg25
    v_mov_b32 v39, -1
    s_cmp_ge_u32 s37, 256
    s_cbranch_scc1 L2_xg25
    v_mov_b32 v27, -1
    s_branch L2_xg25
L2_xt25:
    s_waitcnt lgkmcnt(0)
    v_mov_b32 v21, -1
    v_mov_b32 v27, -1
    v_mov_b32 v39, -1
    v_mov_b32 v31, -1
    s_add_u32 s3, s42, 2
    s_bitset1_b32 s36, s3
    s_branch L2_xg25
L2_oa28:
    v_and_b32 v47, 0x0fffffff, v33
    buffer_load_dword v114, v47, s[8:11], 0 offen offset:16
    s_mov_b64 exec, s[6:7]
    v_add_u32 v47, 8, v47
    v_lshrrev_b32 v33, 2, v33
    s_mov_b64 exec, -1
    buffer_load_dwordx2 v[112:113], v47, s[8:11], 0 offen
    s_branch L2_ob28
L2_c29:
    s_lshl_b64 s[52:53], s[82:83], 1
    s_andn2_b64 s[52:53], s[52:53], s[80:81]
    s_andn2_b64 s[52:53], s[52:53], s[54:55]
    s_or_b64 s[80:81], s[80:81], s[52:53]
    s_not_b64 vcc, s[52:53]
    s_mov_b64 exec, -1
    v_cndmask_b32_dpp v84, v84, v84, vcc wave_shr:1 row_mask:0xf bank_mask:0xf
    v_cndmask_b32_dpp v85, v85, v85, vcc wave_shr:1 row_mask:0xf bank_mask:0xf
    s_lshr_b64 s[52:53], s[52:53], 1
    v_cndmask_b32_dpp v86, v86, v86, vcc wave_shr:1 row_mask:0xf bank_mask:0xf
    v_cndmask_b32_dpp v87, v87, v87, vcc wave_shr:1 row_mask:0xf bank_mask:0xf
    s_andn2_b64 s[82:83], s[82:83], s[52:53]
    v_cndmask_b32_dpp v7, v7, v7, vcc wave_shr:1 row_mask:0xf bank_mask:0xf
    s_mov_b64 exec, s[54:55]
    s_cbranch_scc0 L2_d29
    s_mov_b64 exec, s[82:83]
    s_nop 1
    v_mfma_f32_4x4x4_16b_bf16 v[88:91], v[12:13], v[84:85], 0
    s_nop 1
    v_mfma_f32_4x4x4_16b_bf16 v[88:91], v[10:11], v[86:87], v[88:91]
    s_nop 4
    v_cvt_pk_bf16_f32 v88, v88, v89
    v_cvt_pk_bf16_f32 v89, v90, v91
    ds_pk_add_bf16 v7, v88 offset:65408
    ds_pk_add_bf16 v7, v89 offset:65412
    s_mov_b64 exec, s[54:55]
    s_branch L2_d29
L2_c30:
    s_lshl_b64 s[52:53], s[82:83], 1
    s_andn2_b64 s[52:53], s[52:53], s[80:81]
    s_andn2_b64 s[52:53], s[52:53], s[50:51]
    s_or_b64 s[80:81], s[80:81], s[52:53]
    s_not_b64 vcc, s[52:53]
    s_mov_b64 exec, -1
    v_cndmask_b32_dpp v84, v84, v84, vcc wave_shr:1 row_mask:0xf bank_mask:0xf
    v_cndmask_b32_dpp v85, v85, v85, vcc wave_shr:1 row_mask:0xf bank_mask:0xf
    s_lshr_b64 s[52:53], s[52:53], 1
    v_cndmask_b32_dpp v86, v86, v86, vcc wave_shr:1 row_mask:0xf bank_mask:0xf
    v_cndmask_b32_dpp v87, v87, v87, vcc wave_shr:1 row_mask:0xf bank_mask:0xf
    s_andn2_b64 s[82:83], s[82:83], s[52:53]
    v_cndmask_b32_dpp v7, v7, v7, vcc wave_shr:1 row_mask:0xf bank_mask:0xf
    s_mov_b64 exec, s[50:51]
    s_cbranch_scc0 L2_d30
    s_mov_b64 exec, s[82:83]
    s_nop 1
    v_mfma_f32_4x4x4_16b_bf16 v[88:91], v[12:13], v[84:85], 0
    s_nop 1
    v_mfma_f32_4x4x4_16b_bf16 v[88:91], v[10:11], v[86:87], v[88:91]
    s_nop 4
    v_cvt_pk_bf16_f32 v88, v88, v89
    v_cvt_pk_bf16_f32 v89, v90, v91
    ds_pk_add_bf16 v7, v88 offset:65408
    ds_pk_add_bf16 v7, v89 offset:65412
    s_mov_b64 exec, s[50:51]
    s_branch L2_d30
L2_c31:
    s_lshl_b64 s[52:53], s[82:83], 1
    s_andn2_b64 s[52:53], s[52:53], s[80:81]
    s_andn2_b64 s[52:53], s[52:53], s[54:55]
    s_or_b64 s[80:81], s[80:81], s[52:53]
    s_not_b64 vcc, s[52:53]
    s_mov_b64 exec, -1
    v_cndmask_b32_dpp v84, v84, v84, vcc wave_shr:1 row_mask:0xf bank_mask:0xf
    v_cndmask_b32_dpp v85, v85, v85, vcc wave_shr:1 row_mask:0xf bank_mask:0xf
    s_lshr_b64 s[52:53], s[52:53], 1
    v_cndmask_b32_dpp v86, v86, v86, vcc wave_shr:1 row_mask:0xf bank_mask:0xf
    v_cndmask_b32_dpp v87, v87, v87, vcc wave_shr:1 row_mask:0xf bank_mask:0xf
    s_andn2_b64 s[82:83], s[82:83], s[52:53]
    v_cndmask_b32_dpp v7, v7, v7, vcc wave_shr:1 row_mask:0xf bank_mask:0xf
    s_mov_b64 exec, s[54:55]
    s_cbranch_scc0 L2_d31
    s_mov_b64 exec, s[82:83]
    s_nop 1
    v_mfma_f32_4x4x4_16b_bf16 v[88:91], v[12:13], v[84:85], 0
    s_nop 1
    v_mfma_f32_4x4x4_16b_bf16 v[88:91], v[10:11], v[86:87], v[88:91]
    s_nop 4
    v_cvt_pk_bf16_f32 v88, v88, v89
    v_cvt_pk_bf16_f32 v89, v90, v91
    ds_pk_add_bf16 v7, v88 offset:65408
    ds_pk_add_bf16 v7, v89 offset:65412
    s_mov_b64 exec, s[54:55]
    s_branch L2_d31
L2_c32:
    s_lshl_b64 s[52:53], s[82:83], 1
    s_andn2_b64 s[52:53], s[52:53], s[80:81]
    s_andn2_b64 s[52:53], s[52:53], s[50:51]
    s_or_b64 s[80:81], s[80:81], s[52:53]
    s_not_b64 vcc, s[52:53]
    s_mov_b64 exec, -1
    v_cndmask_b32_dpp v84, v84, v84, vcc wave_shr:1 row_mask:0xf bank_mask:0xf
    v_cndmask_b32_dpp v85, v85, v85, vcc wave_shr:1 row_mask:0xf bank_mask:0xf
    s_lshr_b64 s[52:53], s[52:53], 1
    v_cndmask_b32_dpp v86, v86, v86, vcc wave_shr:1 row_mask:0xf bank_mask:0xf
    v_cndmask_b32_dpp v87, v87, v87, vcc wave_shr:1 row_mask:0xf bank_mask:0xf
    s_andn2_b64 s[82:83], s[82:83], s[52:53]
    v_cndmask_b32_dpp v7, v7, v7, vcc wave_shr:1 row_mask:0xf bank_mask:0xf
    s_mov_b64 exec, s[50:51]
    s_cbranch_scc0 L2_d32
    s_mov_b64 exec, s[82:83]
    s_nop 1
    v_mfma_f32_4x4x4_16b_bf16 v[88:91], v[12:13], v[84:85], 0
    s_nop 1
    v_mfma_f32_4x4x4_16b_bf16 v[88:91], v[10:11], v[86:87], v[88:91]
    s_nop 4
    v_cvt_pk_bf16_f32 v88, v88, v89
    v_cvt_pk_bf16_f32 v89, v90, v91
    ds_pk_add_bf16 v7, v88 offset:65408
    ds_pk_add_bf16 v7, v89 offset:65412
    s_mov_b64 exec, s[50:51]
    s_branch L2_d32
L2_c33:
    s_lshl_b64 s[52:53], s[82:83], 1
    s_andn2_b64 s[52:53], s[52:53], s[80:81]
    s_andn2_b64 s[52:53], s[52:53], s[54:55]
    s_or_b64 s[80:81], s[80:81], s[52:53]
    s_not_b64 vcc, s[52:53]
    s_mov_b64 exec, -1
    v_cndmask_b32_dpp v84, v84, v84, vcc wave_shr:1 row_mask:0xf bank_mask:0xf
    v_cndmask_b32_dpp v85, v85, v85, vcc wave_shr:1 row_mask:0xf bank_mask:0xf
    s_lshr_b64 s[52:53], s[52:53], 1
    v_cndmask_b32_dpp v86, v86, v86, vcc wave_shr:1 row_mask:0xf bank_mask:0xf
    v_cndmask_b32_dpp v87, v87, v87, vcc wave_shr:1 row_mask:0xf bank_mask:0xf
    s_andn2_b64 s[82:83], s[82:83], s[52:53]
    v_cndmask_b32_dpp v7, v7, v7, vcc wave_shr:1 row_mask:0xf bank_mask:0xf
    s_mov_b64 exec, s[54:55]
    s_cbranch_scc0 L2_d33
    s_mov_b64 exec, s[82:83]
    s_nop 1
    v_mfma_f32_4x4x4_16b_bf16 v[88:91], v[12:13], v[84:85], 0
    s_nop 1
    v_mfma_f32_4x4x4_16b_bf16 v[88:91], v[10:11], v[86:87], v[88:91]
    s_nop 4
    v_cvt_pk_bf16_f32 v88, v88, v89
    v_cvt_pk_bf16_f32 v89, v90, v91
    ds_pk_add_bf16 v7, v88 offset:65408
    ds_pk_add_bf16 v7, v89 offset:65412
    s_mov_b64 exec, s[54:55]
    s_branch L2_d33
L2_c34:
    s_lshl_b64 s[52:53], s[82:83], 1
    s_andn2_b64 s[52:53], s[52:53], s[80:81]
    s_andn2_b64 s[52:53], s[52:53], s[50:51]
    s_or_b64 s[80:81], s[80:81], s[52:53]
    s_not_b64 vcc, s[52:53]
    s_mov_b64 exec, -1
    v_cndmask_b32_dpp v84, v84, v84, vcc wave_shr:1 row_mask:0xf bank_mask:0xf
    v_cndmask_b32_dpp v85, v85, v85, vcc wave_shr:1 row_mask:0xf bank_mask:0xf
    s_lshr_b64 s[52:53], s[52:53], 1
    v_cndmask_b32_dpp v86, v86, v86, vcc wave_shr:1 row_mask:0xf bank_mask:0xf
    v_cndmask_b32_dpp v87, v87, v87, vcc wave_shr:1 row_mask:0xf bank_mask:0xf
    s_andn2_b64 s[82:83], s[82:83], s[52:53]
    v_cndmask_b32_dpp v7, v7, v7, vcc wave_shr:1 row_mask:0xf bank_mask:0xf
    s_mov_b64 exec, s[50:51]
    s_cbranch_scc0 L2_d34
    s_mov_b64 exec, s[82:83]
    s_nop 1
    v_mfma_f32_4x4x4_16b_bf16 v[88:91], v[12:13], v[84:85], 0
    s_nop 1
    v_mfma_f32_4x4x4_16b_bf16 v[88:91], v[10:11], v[86:87], v[88:91]
    s_nop 4
    v_cvt_pk_bf16_f32 v88, v88, v89
    v_cvt_pk_bf16_f32 v89, v90, v91
    ds_pk_add_bf16 v7, v88 offset:65408
    ds_pk_add_bf16 v7, v89 offset:65412
    s_mov_b64 exec, s[50:51]
    s_branch L2_d34
L2_oa35:
    s_waitcnt vmcnt(3)
    s_mov_b64 exec, s[6:7]
    v_lshrrev_b32 v114, 16, v114
    s_mov_b64 exec, -1
    v_and_b32 v46, 0x10000000, v33
    v_cmpx_eq_u32 vcc, 0, v46
    v_lshrrev_b32 v47, 14, v112
    v_and_b32 v47, v5, v47
    ds_read_b64 v[96:97], v47
    v_perm_b32 v98, v112, v114, s44
    v_bitop3_b32 v99, v112, 0.5, -0.5 bitop3:0xa8
    v_bitop3_b32 v98, v6, v98, v99 bitop3:0xca
    v_and_b32 v47, v5, v112
    s_waitcnt lgkmcnt(0)
    v_mfma_f32_4x4x4_16b_bf16 v[88:91], v[8:9], v[96:97], 0
    s_nop 4
    v_mul_f32 v88, v98, v88
    v_mul_f32 v89, v98, v89
    v_mul_f32 v90, v98, v90
    v_mul_f32 v91, v98, v91
    v_cvt_pk_bf16_f32 v88, v88, v89
    v_cvt_pk_bf16_f32 v89, v90, v91
    ds_pk_add_bf16 v47, v88 offset:65408
    ds_pk_add_bf16 v47, v89 offset:65412
    s_mov_b64 exec, -1
    v_and_b32 v46, 0x20000000, v33
    v_cmpx_eq_u32 vcc, 0, v46
    v_lshrrev_b32 v47, 14, v113
    v_and_b32 v47, v5, v47
    ds_read_b64 v[96:97], v47
    v_perm_b32 v98, v113, v114, s45
    v_bitop3_b32 v99, v113, 0.5, -0.5 bitop3:0xa8
    v_bitop3_b32 v98, v6, v98, v99 bitop3:0xca
    v_and_b32 v47, v5, v113
    s_waitcnt lgkmcnt(0)
    v_mfma_f32_4x4x4_16b_bf16 v[88:91], v[8:9], v[96:97], 0
    s_nop 4
    v_mul_f32 v88, v98, v88
    v_mul_f32 v89, v98, v89
    v_mul_f32 v90, v98, v90
    v_mul_f32 v91, v98, v91
    v_cvt_pk_bf16_f32 v88, v88, v89
    v_cvt_pk_bf16_f32 v89, v90, v91
    ds_pk_add_bf16 v47, v88 offset:65408
    ds_pk_add_bf16 v47, v89 offset:65412
    s_mov_b64 exec, -1
    s_branch L2_ob35
L2_xo36:
    v_cmp_lt_u32 vcc, 20, v99
    s_mov_b32 s101, 1
    s_cbranch_vccz L2_xp36
    v_cmp_lt_u32 vcc, 32, v99
    v_cmp_lt_u32 s[58:59], 31, v88
    s_mov_b32 s101, 2
    s_or_b64 vcc, vcc, s[58:59]
    s_cbranch_scc0 L2_xp36
    s_mov_b32 s37, 0x10000
    s_branch L2_xp36
L2_c37:
    s_lshl_b64 s[52:53], s[82:83], 1
    s_andn2_b64 s[52:53], s[52:53], s[80:81]
    s_andn2_b64 s[52:53], s[52:53], s[54:55]
    s_or_b64 s[80:81], s[80:81], s[52:53]
    s_not_b64 vcc, s[52:53]
    s_mov_b64 exec, -1
    v_cndmask_b32_dpp v84, v84, v84, vcc wave_shr:1 row_mask:0xf bank_mask:0xf
    v_cndmask_b32_dpp v85, v85, v85, vcc wave_shr:1 row_mask:0xf bank_mask:0xf
    s_lshr_b64 s[52:53], s[52:53], 1
    v_cndmask_b32_dpp v86, v86, v86, vcc wave_shr:1 row_mask:0xf bank_mask:0xf
    v_cndmask_b32_dpp v87, v87, v87, vcc wave_shr:1 row_mask:0xf bank_mask:0xf
    s_andn2_b64 s[82:83], s[82:83], s[52:53]
    v_cndmask_b32_dpp v7, v7, v7, vcc wave_shr:1 row_mask:0xf bank_mask:0xf
    s_mov_b64 exec, s[54:55]
    s_cbranch_scc0 L2_d37
    s_mov_b64 exec, s[82:83]
    s_nop 1
    v_mfma_f32_4x4x4_16b_bf16 v[88:91], v[12:13], v[84:85], 0
    s_nop 1
    v_mfma_f32_4x4x4_16b_bf16 v[88:91], v[10:11], v[86:87], v[88:91]
    s_nop 4
    v_cvt_pk_bf16_f32 v88, v88, v89
    v_cvt_pk_bf16_f32 v89, v90, v91
    ds_pk_add_bf16 v7, v88 offset:65408
    ds_pk_add_bf16 v7, v89 offset:65412
    s_mov_b64 exec, s[54:55]
    s_branch L2_d37
L2_c38:
    s_lshl_b64 s[52:53], s[82:83], 1
    s_andn2_b64 s[52:53], s[52:53], s[80:81]
    s_andn2_b64 s[52:53], s[52:53], s[50:51]
    s_or_b64 s[80:81], s[80:81], s[52:53]
    s_not_b64 vcc, s[52:53]
    s_mov_b64 exec, -1
    v_cndmask_b32_dpp v84, v84, v84, vcc wave_shr:1 row_mask:0xf bank_mask:0xf
    v_cndmask_b32_dpp v85, v85, v85, vcc wave_shr:1 row_mask:0xf bank_mask:0xf
    s_lshr_b64 s[52:53], s[52:53], 1
    v_cndmask_b32_dpp v86, v86, v86, vcc wave_shr:1 row_mask:0xf bank_mask:0xf
    v_cndmask_b32_dpp v87, v87, v87, vcc wave_shr:1 row_mask:0xf bank_mask:0xf
    s_andn2_b64 s[82:83], s[82:83], s[52:53]
    v_cndmask_b32_dpp v7, v7, v7, vcc wave_shr:1 row_mask:0xf bank_mask:0xf
    s_mov_b64 exec, s[50:51]
    s_cbranch_scc0 L2_d38
    s_mov_b64 exec, s[82:83]
    s_nop 1
    v_mfma_f32_4x4x4_16b_bf16 v[88:91], v[12:13], v[84:85], 0
    s_nop 1
    v_mfma_f32_4x4x4_16b_bf16 v[88:91], v[10:11], v[86:87], v[88:91]
    s_nop 4
    v_cvt_pk_bf16_f32 v88, v88, v89
    v_cvt_pk_bf16_f32 v89, v90, v91
    ds_pk_add_bf16 v7, v88 offset:65408
    ds_pk_add_bf16 v7, v89 offset:65412
    s_mov_b64 exec, s[50:51]
    s_branch L2_d38
L2_c39:
    s_lshl_b64 s[52:53], s[82:83], 1
    s_andn2_b64 s[52:53], s[52:53], s[80:81]
    s_andn2_b64 s[52:53], s[52:53], s[54:55]
    s_or_b64 s[80:81], s[80:81], s[52:53]
    s_not_b64 vcc, s[52:53]
    s_mov_b64 exec, -1
    v_cndmask_b32_dpp v84, v84, v84, vcc wave_shr:1 row_mask:0xf bank_mask:0xf
    v_cndmask_b32_dpp v85, v85, v85, vcc wave_shr:1 row_mask:0xf bank_mask:0xf
    s_lshr_b64 s[52:53], s[52:53], 1
    v_cndmask_b32_dpp v86, v86, v86, vcc wave_shr:1 row_mask:0xf bank_mask:0xf
    v_cndmask_b32_dpp v87, v87, v87, vcc wave_shr:1 row_mask:0xf bank_mask:0xf
    s_andn2_b64 s[82:83], s[82:83], s[52:53]
    v_cndmask_b32_dpp v7, v7, v7, vcc wave_shr:1 row_mask:0xf bank_mask:0xf
    s_mov_b64 exec, s[54:55]
    s_cbranch_scc0 L2_d39
    s_mov_b64 exec, s[82:83]
    s_nop 1
    v_mfma_f32_4x4x4_16b_bf16 v[88:91], v[12:13], v[84:85], 0
    s_nop 1
    v_mfma_f32_4x4x4_16b_bf16 v[88:91], v[10:11], v[86:87], v[88:91]
    s_nop 4
    v_cvt_pk_bf16_f32 v88, v88, v89
    v_cvt_pk_bf16_f32 v89, v90, v91
    ds_pk_add_bf16 v7, v88 offset:65408
    ds_pk_add_bf16 v7, v89 offset:65412
    s_mov_b64 exec, s[54:55]
    s_branch L2_d39
L2_c40:
    s_lshl_b64 s[52:53], s[82:83], 1
    s_andn2_b64 s[52:53], s[52:53], s[80:81]
    s_andn2_b64 s[52:53], s[52:53], s[50:51]
    s_or_b64 s[80:81], s[80:81], s[52:53]
    s_not_b64 vcc, s[52:53]
    s_mov_b64 exec, -1
    v_cndmask_b32_dpp v84, v84, v84, vcc wave_shr:1 row_mask:0xf bank_mask:0xf
    v_cndmask_b32_dpp v85, v85, v85, vcc wave_shr:1 row_mask:0xf bank_mask:0xf
    s_lshr_b64 s[52:53], s[52:53], 1
    v_cndmask_b32_dpp v86, v86, v86, vcc wave_shr:1 row_mask:0xf bank_mask:0xf
    v_cndmask_b32_dpp v87, v87, v87, vcc wave_shr:1 row_mask:0xf bank_mask:0xf
    s_andn2_b64 s[82:83], s[82:83], s[52:53]
    v_cndmask_b32_dpp v7, v7, v7, vcc wave_shr:1 row_mask:0xf bank_mask:0xf
    s_mov_b64 exec, s[50:51]
    s_cbranch_scc0 L2_d40
    s_mov_b64 exec, s[82:83]
    s_nop 1
    v_mfma_f32_4x4x4_16b_bf16 v[88:91], v[12:13], v[84:85], 0
    s_nop 1
    v_mfma_f32_4x4x4_16b_bf16 v[88:91], v[10:11], v[86:87], v[88:91]
    s_nop 4
    v_cvt_pk_bf16_f32 v88, v88, v89
    v_cvt_pk_bf16_f32 v89, v90, v91
    ds_pk_add_bf16 v7, v88 offset:65408
    ds_pk_add_bf16 v7, v89 offset:65412
    s_mov_b64 exec, s[50:51]
    s_branch L2_d40
L2_c41:
    s_lshl_b64 s[52:53], s[82:83], 1
    s_andn2_b64 s[52:53], s[52:53], s[80:81]
    s_andn2_b64 s[52:53], s[52:53], s[54:55]
    s_or_b64 s[80:81], s[80:81], s[52:53]
    s_not_b64 vcc, s[52:53]
    s_mov_b64 exec, -1
    v_cndmask_b32_dpp v84, v84, v84, vcc wave_shr:1 row_mask:0xf bank_mask:0xf
    v_cndmask_b32_dpp v85, v85, v85, vcc wave_shr:1 row_mask:0xf bank_mask:0xf
    s_lshr_b64 s[52:53], s[52:53], 1
    v_cndmask_b32_dpp v86, v86, v86, vcc wave_shr:1 row_mask:0xf bank_mask:0xf
    v_cndmask_b32_dpp v87, v87, v87, vcc wave_shr:1 row_mask:0xf bank_mask:0xf
    s_andn2_b64 s[82:83], s[82:83], s[52:53]
    v_cndmask_b32_dpp v7, v7, v7, vcc wave_shr:1 row_mask:0xf bank_mask:0xf
    s_mov_b64 exec, s[54:55]
    s_cbranch_scc0 L2_d41
    s_mov_b64 exec, s[82:83]
    s_nop 1
    v_mfma_f32_4x4x4_16b_bf16 v[88:91], v[12:13], v[84:85], 0
    s_nop 1
    v_mfma_f32_4x4x4_16b_bf16 v[88:91], v[10:11], v[86:87], v[88:91]
    s_nop 4
    v_cvt_pk_bf16_f32 v88, v88, v89
    v_cvt_pk_bf16_f32 v89, v90, v91
    ds_pk_add_bf16 v7, v88 offset:65408
    ds_pk_add_bf16 v7, v89 offset:65412
    s_mov_b64 exec, s[54:55]
    s_branch L2_d41
L2_c42:
    s_lshl_b64 s[52:53], s[82:83], 1
    s_andn2_b64 s[52:53], s[52:53], s[80:81]
    s_andn2_b64 s[52:53], s[52:53], s[50:51]
    s_or_b64 s[80:81], s[80:81], s[52:53]
    s_not_b64 vcc, s[52:53]
    s_mov_b64 exec, -1
    v_cndmask_b32_dpp v84, v84, v84, vcc wave_shr:1 row_mask:0xf bank_mask:0xf
    v_cndmask_b32_dpp v85, v85, v85, vcc wave_shr:1 row_mask:0xf bank_mask:0xf
    s_lshr_b64 s[52:53], s[52:53], 1
    v_cndmask_b32_dpp v86, v86, v86, vcc wave_shr:1 row_mask:0xf bank_mask:0xf
    v_cndmask_b32_dpp v87, v87, v87, vcc wave_shr:1 row_mask:0xf bank_mask:0xf
    s_andn2_b64 s[82:83], s[82:83], s[52:53]
    v_cndmask_b32_dpp v7, v7, v7, vcc wave_shr:1 row_mask:0xf bank_mask:0xf
    s_mov_b64 exec, s[50:51]
    s_cbranch_scc0 L2_d42
    s_mov_b64 exec, s[82:83]
    s_nop 1
    v_mfma_f32_4x4x4_16b_bf16 v[88:91], v[12:13], v[84:85], 0
    s_nop 1
    v_mfma_f32_4x4x4_16b_bf16 v[88:91], v[10:11], v[86:87], v[88:91]
    s_nop 4
    v_cvt_pk_bf16_f32 v88, v88, v89
    v_cvt_pk_bf16_f32 v89, v90, v91
    ds_pk_add_bf16 v7, v88 offset:65408
    ds_pk_add_bf16 v7, v89 offset:65412
    s_mov_b64 exec, s[50:51]
    s_branch L2_d42
L2_xa43:
    s_cmp_eq_u32 s101, 1
    s_cbranch_scc1 L2_xc43
    v_lshlrev_b32 v89, 0, v96
    v_add_u32 v90, 140, v97
    v_bitop3_b32 v90, v89, v45, v90 bitop3:0x6a
    ds_write_b32 v98, v90 offset:28
    v_lshlrev_b32 v89, 4, v96
    v_add_u32 v90, 120, v97
    v_bitop3_b32 v90, v89, v45, v90 bitop3:0x6a
    ds_write_b32 v98, v90 offset:24
    v_lshlrev_b32 v89, 8, v96
    v_add_u32 v90, 100, v97
    v_bitop3_b32 v90, v89, v45, v90 bitop3:0x6a
    ds_write_b32 v98, v90 offset:20
L2_xc43:
    v_lshlrev_b32 v89, 12, v96
    v_add_u32 v90, 80, v97
    v_bitop3_b32 v90, v89, v45, v90 bitop3:0x6a
    ds_write_b32 v98, v90 offset:16
    s_branch L2_xb43
L2_xe43:
    v_cmp_lt_u32 vcc, 32, v99
    v_cmp_lt_u32 s[58:59], 31, v88
    v_lshrrev_b32 v89, 16, v96
    v_add_u32 v97, 80, v97
    s_or_b64 vcc, vcc, s[58:59]
    s_cbranch_scc1 L2_xs43
    v_lshlrev_b32 v89, v1, v89
    v_and_b32 v89, v45, v89
    v_cmp_ne_u32 vcc, 0, v89
    v_xor_b32 v90, v97, v89
    s_add_u32 s3, s37, s38
    v_mbcnt_lo_u32_b32 v98, vcc_lo, 0
    v_mbcnt_hi_u32_b32 v98, vcc_hi, v98
    s_bcnt1_i32_b64 s41, vcc
    v_lshl_add_u32 v98, v98, 2, s3
    s_lshl2_add_u32 s37, s41, s37
    s_mov_b64 exec, vcc
    ds_write_b32 v98, v90
    s_mov_b64 exec, -1
    s_branch L2_xr43
L2_xs43:
    s_waitcnt lgkmcnt(0)
    s_mov_b32 s37, 0x10000
    s_branch L2_xw43
L2_c44:
    s_lshl_b64 s[52:53], s[82:83], 1
    s_andn2_b64 s[52:53], s[52:53], s[80:81]
    s_andn2_b64 s[52:53], s[52:53], s[54:55]
    s_or_b64 s[80:81], s[80:81], s[52:53]
    s_not_b64 vcc, s[52:53]
    s_mov_b64 exec, -1
    v_cndmask_b32_dpp v84, v84, v84, vcc wave_shr:1 row_mask:0xf bank_mask:0xf
    v_cndmask_b32_dpp v85, v85, v85, vcc wave_shr:1 row_mask:0xf bank_mask:0xf
    s_lshr_b64 s[52:53], s[52:53], 1
    v_cndmask_b32_dpp v86, v86, v86, vcc wave_shr:1 row_mask:0xf bank_mask:0xf
    v_cndmask_b32_dpp v87, v87, v87, vcc wave_shr:1 row_mask:0xf bank_mask:0xf
    s_andn2_b64 s[82:83], s[82:83], s[52:53]
    v_cndmask_b32_dpp v7, v7, v7, vcc wave_shr:1 row_mask:0xf bank_mask:0xf
    s_mov_b64 exec, s[54:55]
    s_cbranch_scc0 L2_d44
    s_mov_b64 exec, s[82:83]
    s_nop 1
    v_mfma_f32_4x4x4_16b_bf16 v[88:91], v[12:13], v[84:85], 0
    s_nop 1
    v_mfma_f32_4x4x4_16b_bf16 v[88:91], v[10:11], v[86:87], v[88:91]
    s_nop 4
    v_cvt_pk_bf16_f32 v88, v88, v89
    v_cvt_pk_bf16_f32 v89, v90, v91
    ds_pk_add_bf16 v7, v88 offset:65408
    ds_pk_add_bf16 v7, v89 offset:65412
    s_mov_b64 exec, s[54:55]
    s_branch L2_d44
L2_c45:
    s_lshl_b64 s[52:53], s[82:83], 1
    s_andn2_b64 s[52:53], s[52:53], s[80:81]
    s_andn2_b64 s[52:53], s[52:53], s[50:51]
    s_or_b64 s[80:81], s[80:81], s[52:53]
    s_not_b64 vcc, s[52:53]
    s_mov_b64 exec, -1
    v_cndmask_b32_dpp v84, v84, v84, vcc wave_shr:1 row_mask:0xf bank_mask:0xf
    v_cndmask_b32_dpp v85, v85, v85, vcc wave_shr:1 row_mask:0xf bank_mask:0xf
    s_lshr_b64 s[52:53], s[52:53], 1
    v_cndmask_b32_dpp v86, v86, v86, vcc wave_shr:1 row_mask:0xf bank_mask:0xf
    v_cndmask_b32_dpp v87, v87, v87, vcc wave_shr:1 row_mask:0xf bank_mask:0xf
    s_andn2_b64 s[82:83], s[82:83], s[52:53]
    v_cndmask_b32_dpp v7, v7, v7, vcc wave_shr:1 row_mask:0xf bank_mask:0xf
    s_mov_b64 exec, s[50:51]
    s_cbranch_scc0 L2_d45
    s_mov_b64 exec, s[82:83]
    s_nop 1
    v_mfma_f32_4x4x4_16b_bf16 v[88:91], v[12:13], v[84:85], 0
    s_nop 1
    v_mfma_f32_4x4x4_16b_bf16 v[88:91], v[10:11], v[86:87], v[88:91]
    s_nop 4
    v_cvt_pk_bf16_f32 v88, v88, v89
    v_cvt_pk_bf16_f32 v89, v90, v91
    ds_pk_add_bf16 v7, v88 offset:65408
    ds_pk_add_bf16 v7, v89 offset:65412
    s_mov_b64 exec, s[50:51]
    s_branch L2_d45
L2_xf43:
    s_cmp_gt_u32 s37, 1024
    s_cbranch_scc1 L2_xt43
    s_cmp_lt_u32 s37, 768
    s_cbranch_scc1 L2_xl43
    ds_read_b32 v33, v44 offset:896
    s_add_u32 s3, s42, 2
    s_bitset1_b32 s43, s3
    s_branch L2_xg43
L2_xl43:
    s_waitcnt lgkmcnt(0)
    v_mov_b32 v42, -1
    s_cmp_ge_u32 s37, 512
    s_cbranch_scc1 L2_xg43
    v_mov_b32 v43, -1
    s_cmp_ge_u32 s37, 256
    s_cbranch_scc1 L2_xg43
    v_mov_b32 v41, -1
    s_branch L2_xg43
L2_xt43:
    s_waitcnt lgkmcnt(0)
    v_mov_b32 v40, -1
    v_mov_b32 v41, -1
    v_mov_b32 v43, -1
    v_mov_b32 v42, -1
    s_add_u32 s3, s42, 2
    s_bitset1_b32 s36, s3
    s_branch L2_xg43
L2_oa46:
    v_and_b32 v47, 0x0fffffff, v32
    buffer_load_dword v114, v47, s[8:11], 0 offen offset:16
    s_mov_b64 exec, s[6:7]
    v_add_u32 v47, 8, v47
    v_lshrrev_b32 v32, 2, v32
    s_mov_b64 exec, -1
    buffer_load_dwordx2 v[112:113], v47, s[8:11], 0 offen
    s_branch L2_ob46
L2_c47:
    s_lshl_b64 s[52:53], s[82:83], 1
    s_andn2_b64 s[52:53], s[52:53], s[80:81]
    s_andn2_b64 s[52:53], s[52:53], s[54:55]
    s_or_b64 s[80:81], s[80:81], s[52:53]
    s_not_b64 vcc, s[52:53]
    s_mov_b64 exec, -1
    v_cndmask_b32_dpp v84, v84, v84, vcc wave_shr:1 row_mask:0xf bank_mask:0xf
    v_cndmask_b32_dpp v85, v85, v85, vcc wave_shr:1 row_mask:0xf bank_mask:0xf
    s_lshr_b64 s[52:53], s[52:53], 1
    v_cndmask_b32_dpp v86, v86, v86, vcc wave_shr:1 row_mask:0xf bank_mask:0xf
    v_cndmask_b32_dpp v87, v87, v87, vcc wave_shr:1 row_mask:0xf bank_mask:0xf
    s_andn2_b64 s[82:83], s[82:83], s[52:53]
    v_cndmask_b32_dpp v7, v7, v7, vcc wave_shr:1 row_mask:0xf bank_mask:0xf
    s_mov_b64 exec, s[54:55]
    s_cbranch_scc0 L2_d47
    s_mov_b64 exec, s[82:83]
    s_nop 1
    v_mfma_f32_4x4x4_16b_bf16 v[88:91], v[12:13], v[84:85], 0
    s_nop 1
    v_mfma_f32_4x4x4_16b_bf16 v[88:91], v[10:11], v[86:87], v[88:91]
    s_nop 4
    v_cvt_pk_bf16_f32 v88, v88, v89
    v_cvt_pk_bf16_f32 v89, v90, v91
    ds_pk_add_bf16 v7, v88 offset:65408
    ds_pk_add_bf16 v7, v89 offset:65412
    s_mov_b64 exec, s[54:55]
    s_branch L2_d47
L2_c48:
    s_lshl_b64 s[52:53], s[82:83], 1
    s_andn2_b64 s[52:53], s[52:53], s[80:81]
    s_andn2_b64 s[52:53], s[52:53], s[50:51]
    s_or_b64 s[80:81], s[80:81], s[52:53]
    s_not_b64 vcc, s[52:53]
    s_mov_b64 exec, -1
    v_cndmask_b32_dpp v84, v84, v84, vcc wave_shr:1 row_mask:0xf bank_mask:0xf
    v_cndmask_b32_dpp v85, v85, v85, vcc wave_shr:1 row_mask:0xf bank_mask:0xf
    s_lshr_b64 s[52:53], s[52:53], 1
    v_cndmask_b32_dpp v86, v86, v86, vcc wave_shr:1 row_mask:0xf bank_mask:0xf
    v_cndmask_b32_dpp v87, v87, v87, vcc wave_shr:1 row_mask:0xf bank_mask:0xf
    s_andn2_b64 s[82:83], s[82:83], s[52:53]
    v_cndmask_b32_dpp v7, v7, v7, vcc wave_shr:1 row_mask:0xf bank_mask:0xf
    s_mov_b64 exec, s[50:51]
    s_cbranch_scc0 L2_d48
    s_mov_b64 exec, s[82:83]
    s_nop 1
    v_mfma_f32_4x4x4_16b_bf16 v[88:91], v[12:13], v[84:85], 0
    s_nop 1
    v_mfma_f32_4x4x4_16b_bf16 v[88:91], v[10:11], v[86:87], v[88:91]
    s_nop 4
    v_cvt_pk_bf16_f32 v88, v88, v89
    v_cvt_pk_bf16_f32 v89, v90, v91
    ds_pk_add_bf16 v7, v88 offset:65408
    ds_pk_add_bf16 v7, v89 offset:65412
    s_mov_b64 exec, s[50:51]
    s_branch L2_d48
L2_c49:
    s_lshl_b64 s[52:53], s[82:83], 1
    s_andn2_b64 s[52:53], s[52:53], s[80:81]
    s_andn2_b64 s[52:53], s[52:53], s[54:55]
    s_or_b64 s[80:81], s[80:81], s[52:53]
    s_not_b64 vcc, s[52:53]
    s_mov_b64 exec, -1
    v_cndmask_b32_dpp v84, v84, v84, vcc wave_shr:1 row_mask:0xf bank_mask:0xf
    v_cndmask_b32_dpp v85, v85, v85, vcc wave_shr:1 row_mask:0xf bank_mask:0xf
    s_lshr_b64 s[52:53], s[52:53], 1
    v_cndmask_b32_dpp v86, v86, v86, vcc wave_shr:1 row_mask:0xf bank_mask:0xf
    v_cndmask_b32_dpp v87, v87, v87, vcc wave_shr:1 row_mask:0xf bank_mask:0xf
    s_andn2_b64 s[82:83], s[82:83], s[52:53]
    v_cndmask_b32_dpp v7, v7, v7, vcc wave_shr:1 row_mask:0xf bank_mask:0xf
    s_mov_b64 exec, s[54:55]
    s_cbranch_scc0 L2_d49
    s_mov_b64 exec, s[82:83]
    s_nop 1
    v_mfma_f32_4x4x4_16b_bf16 v[88:91], v[12:13], v[84:85], 0
    s_nop 1
    v_mfma_f32_4x4x4_16b_bf16 v[88:91], v[10:11], v[86:87], v[88:91]
    s_nop 4
    v_cvt_pk_bf16_f32 v88, v88, v89
    v_cvt_pk_bf16_f32 v89, v90, v91
    ds_pk_add_bf16 v7, v88 offset:65408
    ds_pk_add_bf16 v7, v89 offset:65412
    s_mov_b64 exec, s[54:55]
    s_branch L2_d49
L2_c50:
    s_lshl_b64 s[52:53], s[82:83], 1
    s_andn2_b64 s[52:53], s[52:53], s[80:81]
    s_andn2_b64 s[52:53], s[52:53], s[50:51]
    s_or_b64 s[80:81], s[80:81], s[52:53]
    s_not_b64 vcc, s[52:53]
    s_mov_b64 exec, -1
    v_cndmask_b32_dpp v84, v84, v84, vcc wave_shr:1 row_mask:0xf bank_mask:0xf
    v_cndmask_b32_dpp v85, v85, v85, vcc wave_shr:1 row_mask:0xf bank_mask:0xf
    s_lshr_b64 s[52:53], s[52:53], 1
    v_cndmask_b32_dpp v86, v86, v86, vcc wave_shr:1 row_mask:0xf bank_mask:0xf
    v_cndmask_b32_dpp v87, v87, v87, vcc wave_shr:1 row_mask:0xf bank_mask:0xf
    s_andn2_b64 s[82:83], s[82:83], s[52:53]
    v_cndmask_b32_dpp v7, v7, v7, vcc wave_shr:1 row_mask:0xf bank_mask:0xf
    s_mov_b64 exec, s[50:51]
    s_cbranch_scc0 L2_d50
    s_mov_b64 exec, s[82:83]
    s_nop 1
    v_mfma_f32_4x4x4_16b_bf16 v[88:91], v[12:13], v[84:85], 0
    s_nop 1
    v_mfma_f32_4x4x4_16b_bf16 v[88:91], v[10:11], v[86:87], v[88:91]
    s_nop 4
    v_cvt_pk_bf16_f32 v88, v88, v89
    v_cvt_pk_bf16_f32 v89, v90, v91
    ds_pk_add_bf16 v7, v88 offset:65408
    ds_pk_add_bf16 v7, v89 offset:65412
    s_mov_b64 exec, s[50:51]
    s_branch L2_d50
L2_c51:
    s_lshl_b64 s[52:53], s[82:83], 1
    s_andn2_b64 s[52:53], s[52:53], s[80:81]
    s_andn2_b64 s[52:53], s[52:53], s[54:55]
    s_or_b64 s[80:81], s[80:81], s[52:53]
    s_not_b64 vcc, s[52:53]
    s_mov_b64 exec, -1
    v_cndmask_b32_dpp v84, v84, v84, vcc wave_shr:1 row_mask:0xf bank_mask:0xf
    v_cndmask_b32_dpp v85, v85, v85, vcc wave_shr:1 row_mask:0xf bank_mask:0xf
    s_lshr_b64 s[52:53], s[52:53], 1
    v_cndmask_b32_dpp v86, v86, v86, vcc wave_shr:1 row_mask:0xf bank_mask:0xf
    v_cndmask_b32_dpp v87, v87, v87, vcc wave_shr:1 row_mask:0xf bank_mask:0xf
    s_andn2_b64 s[82:83], s[82:83], s[52:53]
    v_cndmask_b32_dpp v7, v7, v7, vcc wave_shr:1 row_mask:0xf bank_mask:0xf
    s_mov_b64 exec, s[54:55]
    s_cbranch_scc0 L2_d51
    s_mov_b64 exec, s[82:83]
    s_nop 1
    v_mfma_f32_4x4x4_16b_bf16 v[88:91], v[12:13], v[84:85], 0
    s_nop 1
    v_mfma_f32_4x4x4_16b_bf16 v[88:91], v[10:11], v[86:87], v[88:91]
    s_nop 4
    v_cvt_pk_bf16_f32 v88, v88, v89
    v_cvt_pk_bf16_f32 v89, v90, v91
    ds_pk_add_bf16 v7, v88 offset:65408
    ds_pk_add_bf16 v7, v89 offset:65412
    s_mov_b64 exec, s[54:55]
    s_branch L2_d51
L2_c52:
    s_lshl_b64 s[52:53], s[82:83], 1
    s_andn2_b64 s[52:53], s[52:53], s[80:81]
    s_andn2_b64 s[52:53], s[52:53], s[50:51]
    s_or_b64 s[80:81], s[80:81], s[52:53]
    s_not_b64 vcc, s[52:53]
    s_mov_b64 exec, -1
    v_cndmask_b32_dpp v84, v84, v84, vcc wave_shr:1 row_mask:0xf bank_mask:0xf
    v_cndmask_b32_dpp v85, v85, v85, vcc wave_shr:1 row_mask:0xf bank_mask:0xf
    s_lshr_b64 s[52:53], s[52:53], 1
    v_cndmask_b32_dpp v86, v86, v86, vcc wave_shr:1 row_mask:0xf bank_mask:0xf
    v_cndmask_b32_dpp v87, v87, v87, vcc wave_shr:1 row_mask:0xf bank_mask:0xf
    s_andn2_b64 s[82:83], s[82:83], s[52:53]
    v_cndmask_b32_dpp v7, v7, v7, vcc wave_shr:1 row_mask:0xf bank_mask:0xf
    s_mov_b64 exec, s[50:51]
    s_cbranch_scc0 L2_d52
    s_mov_b64 exec, s[82:83]
    s_nop 1
    v_mfma_f32_4x4x4_16b_bf16 v[88:91], v[12:13], v[84:85], 0
    s_nop 1
    v_mfma_f32_4x4x4_16b_bf16 v[88:91], v[10:11], v[86:87], v[88:91]
    s_nop 4
    v_cvt_pk_bf16_f32 v88, v88, v89
    v_cvt_pk_bf16_f32 v89, v90, v91
    ds_pk_add_bf16 v7, v88 offset:65408
    ds_pk_add_bf16 v7, v89 offset:65412
    s_mov_b64 exec, s[50:51]
    s_branch L2_d52
L2_oa53:
    s_waitcnt vmcnt(3)
    s_mov_b64 exec, s[6:7]
    v_lshrrev_b32 v114, 16, v114
    s_mov_b64 exec, -1
    v_and_b32 v46, 0x10000000, v32
    v_cmpx_eq_u32 vcc, 0, v46
    v_lshrrev_b32 v47, 14, v112
    v_and_b32 v47, v5, v47
    ds_read_b64 v[96:97], v47
    v_perm_b32 v98, v112, v114, s44
    v_bitop3_b32 v99, v112, 0.5, -0.5 bitop3:0xa8
    v_bitop3_b32 v98, v6, v98, v99 bitop3:0xca
    v_and_b32 v47, v5, v112
    s_waitcnt lgkmcnt(0)
    v_mfma_f32_4x4x4_16b_bf16 v[88:91], v[8:9], v[96:97], 0
    s_nop 4
    v_mul_f32 v88, v98, v88
    v_mul_f32 v89, v98, v89
    v_mul_f32 v90, v98, v90
    v_mul_f32 v91, v98, v91
    v_cvt_pk_bf16_f32 v88, v88, v89
    v_cvt_pk_bf16_f32 v89, v90, v91
    ds_pk_add_bf16 v47, v88 offset:65408
    ds_pk_add_bf16 v47, v89 offset:65412
    s_mov_b64 exec, -1
    v_and_b32 v46, 0x20000000, v32
    v_cmpx_eq_u32 vcc, 0, v46
    v_lshrrev_b32 v47, 14, v113
    v_and_b32 v47, v5, v47
    ds_read_b64 v[96:97], v47
    v_perm_b32 v98, v113, v114, s45
    v_bitop3_b32 v99, v113, 0.5, -0.5 bitop3:0xa8
    v_bitop3_b32 v98, v6, v98, v99 bitop3:0xca
    v_and_b32 v47, v5, v113
    s_waitcnt lgkmcnt(0)
    v_mfma_f32_4x4x4_16b_bf16 v[88:91], v[8:9], v[96:97], 0
    s_nop 4
    v_mul_f32 v88, v98, v88
    v_mul_f32 v89, v98, v89
    v_mul_f32 v90, v98, v90
    v_mul_f32 v91, v98, v91
    v_cvt_pk_bf16_f32 v88, v88, v89
    v_cvt_pk_bf16_f32 v89, v90, v91
    ds_pk_add_bf16 v47, v88 offset:65408
    ds_pk_add_bf16 v47, v89 offset:65412
    s_mov_b64 exec, -1
    s_branch L2_ob53
L2_xo54:
    v_cmp_lt_u32 vcc, 20, v99
    s_mov_b32 s101, 1
    s_cbranch_vccz L2_xp54
    v_cmp_lt_u32 vcc, 32, v99
    v_cmp_lt_u32 s[58:59], 31, v88
    s_mov_b32 s101, 2
    s_or_b64 vcc, vcc, s[58:59]
    s_cbranch_scc0 L2_xp54
    s_mov_b32 s37, 0x10000
    s_branch L2_xp54
L2_c55:
    s_lshl_b64 s[52:53], s[82:83], 1
    s_andn2_b64 s[52:53], s[52:53], s[80:81]
    s_andn2_b64 s[52:53], s[52:53], s[54:55]
    s_or_b64 s[80:81], s[80:81], s[52:53]
    s_not_b64 vcc, s[52:53]
    s_mov_b64 exec, -1
    v_cndmask_b32_dpp v84, v84, v84, vcc wave_shr:1 row_mask:0xf bank_mask:0xf
    v_cndmask_b32_dpp v85, v85, v85, vcc wave_shr:1 row_mask:0xf bank_mask:0xf
    s_lshr_b64 s[52:53], s[52:53], 1
    v_cndmask_b32_dpp v86, v86, v86, vcc wave_shr:1 row_mask:0xf bank_mask:0xf
    v_cndmask_b32_dpp v87, v87, v87, vcc wave_shr:1 row_mask:0xf bank_mask:0xf
    s_andn2_b64 s[82:83], s[82:83], s[52:53]
    v_cndmask_b32_dpp v7, v7, v7, vcc wave_shr:1 row_mask:0xf bank_mask:0xf
    s_mov_b64 exec, s[54:55]
    s_cbranch_scc0 L2_d55
    s_mov_b64 exec, s[82:83]
    s_nop 1
    v_mfma_f32_4x4x4_16b_bf16 v[88:91], v[12:13], v[84:85], 0
    s_nop 1
    v_mfma_f32_4x4x4_16b_bf16 v[88:91], v[10:11], v[86:87], v[88:91]
    s_nop 4
    v_cvt_pk_bf16_f32 v88, v88, v89
    v_cvt_pk_bf16_f32 v89, v90, v91
    ds_pk_add_bf16 v7, v88 offset:65408
    ds_pk_add_bf16 v7, v89 offset:65412
    s_mov_b64 exec, s[54:55]
    s_branch L2_d55
L2_c56:
    s_lshl_b64 s[52:53], s[82:83], 1
    s_andn2_b64 s[52:53], s[52:53], s[80:81]
    s_andn2_b64 s[52:53], s[52:53], s[50:51]
    s_or_b64 s[80:81], s[80:81], s[52:53]
    s_not_b64 vcc, s[52:53]
    s_mov_b64 exec, -1
    v_cndmask_b32_dpp v84, v84, v84, vcc wave_shr:1 row_mask:0xf bank_mask:0xf
    v_cndmask_b32_dpp v85, v85, v85, vcc wave_shr:1 row_mask:0xf bank_mask:0xf
    s_lshr_b64 s[52:53], s[52:53], 1
    v_cndmask_b32_dpp v86, v86, v86, vcc wave_shr:1 row_mask:0xf bank_mask:0xf
    v_cndmask_b32_dpp v87, v87, v87, vcc wave_shr:1 row_mask:0xf bank_mask:0xf
    s_andn2_b64 s[82:83], s[82:83], s[52:53]
    v_cndmask_b32_dpp v7, v7, v7, vcc wave_shr:1 row_mask:0xf bank_mask:0xf
    s_mov_b64 exec, s[50:51]
    s_cbranch_scc0 L2_d56
    s_mov_b64 exec, s[82:83]
    s_nop 1
    v_mfma_f32_4x4x4_16b_bf16 v[88:91], v[12:13], v[84:85], 0
    s_nop 1
    v_mfma_f32_4x4x4_16b_bf16 v[88:91], v[10:11], v[86:87], v[88:91]
    s_nop 4
    v_cvt_pk_bf16_f32 v88, v88, v89
    v_cvt_pk_bf16_f32 v89, v90, v91
    ds_pk_add_bf16 v7, v88 offset:65408
    ds_pk_add_bf16 v7, v89 offset:65412
    s_mov_b64 exec, s[50:51]
    s_branch L2_d56
L2_c57:
    s_lshl_b64 s[52:53], s[82:83], 1
    s_andn2_b64 s[52:53], s[52:53], s[80:81]
    s_andn2_b64 s[52:53], s[52:53], s[54:55]
    s_or_b64 s[80:81], s[80:81], s[52:53]
    s_not_b64 vcc, s[52:53]
    s_mov_b64 exec, -1
    v_cndmask_b32_dpp v84, v84, v84, vcc wave_shr:1 row_mask:0xf bank_mask:0xf
    v_cndmask_b32_dpp v85, v85, v85, vcc wave_shr:1 row_mask:0xf bank_mask:0xf
    s_lshr_b64 s[52:53], s[52:53], 1
    v_cndmask_b32_dpp v86, v86, v86, vcc wave_shr:1 row_mask:0xf bank_mask:0xf
    v_cndmask_b32_dpp v87, v87, v87, vcc wave_shr:1 row_mask:0xf bank_mask:0xf
    s_andn2_b64 s[82:83], s[82:83], s[52:53]
    v_cndmask_b32_dpp v7, v7, v7, vcc wave_shr:1 row_mask:0xf bank_mask:0xf
    s_mov_b64 exec, s[54:55]
    s_cbranch_scc0 L2_d57
    s_mov_b64 exec, s[82:83]
    s_nop 1
    v_mfma_f32_4x4x4_16b_bf16 v[88:91], v[12:13], v[84:85], 0
    s_nop 1
    v_mfma_f32_4x4x4_16b_bf16 v[88:91], v[10:11], v[86:87], v[88:91]
    s_nop 4
    v_cvt_pk_bf16_f32 v88, v88, v89
    v_cvt_pk_bf16_f32 v89, v90, v91
    ds_pk_add_bf16 v7, v88 offset:65408
    ds_pk_add_bf16 v7, v89 offset:65412
    s_mov_b64 exec, s[54:55]
    s_branch L2_d57
L2_c58:
    s_lshl_b64 s[52:53], s[82:83], 1
    s_andn2_b64 s[52:53], s[52:53], s[80:81]
    s_andn2_b64 s[52:53], s[52:53], s[50:51]
    s_or_b64 s[80:81], s[80:81], s[52:53]
    s_not_b64 vcc, s[52:53]
    s_mov_b64 exec, -1
    v_cndmask_b32_dpp v84, v84, v84, vcc wave_shr:1 row_mask:0xf bank_mask:0xf
    v_cndmask_b32_dpp v85, v85, v85, vcc wave_shr:1 row_mask:0xf bank_mask:0xf
    s_lshr_b64 s[52:53], s[52:53], 1
    v_cndmask_b32_dpp v86, v86, v86, vcc wave_shr:1 row_mask:0xf bank_mask:0xf
    v_cndmask_b32_dpp v87, v87, v87, vcc wave_shr:1 row_mask:0xf bank_mask:0xf
    s_andn2_b64 s[82:83], s[82:83], s[52:53]
    v_cndmask_b32_dpp v7, v7, v7, vcc wave_shr:1 row_mask:0xf bank_mask:0xf
    s_mov_b64 exec, s[50:51]
    s_cbranch_scc0 L2_d58
    s_mov_b64 exec, s[82:83]
    s_nop 1
    v_mfma_f32_4x4x4_16b_bf16 v[88:91], v[12:13], v[84:85], 0
    s_nop 1
    v_mfma_f32_4x4x4_16b_bf16 v[88:91], v[10:11], v[86:87], v[88:91]
    s_nop 4
    v_cvt_pk_bf16_f32 v88, v88, v89
    v_cvt_pk_bf16_f32 v89, v90, v91
    ds_pk_add_bf16 v7, v88 offset:65408
    ds_pk_add_bf16 v7, v89 offset:65412
    s_mov_b64 exec, s[50:51]
    s_branch L2_d58
L2_c59:
    s_lshl_b64 s[52:53], s[82:83], 1
    s_andn2_b64 s[52:53], s[52:53], s[80:81]
    s_andn2_b64 s[52:53], s[52:53], s[54:55]
    s_or_b64 s[80:81], s[80:81], s[52:53]
    s_not_b64 vcc, s[52:53]
    s_mov_b64 exec, -1
    v_cndmask_b32_dpp v84, v84, v84, vcc wave_shr:1 row_mask:0xf bank_mask:0xf
    v_cndmask_b32_dpp v85, v85, v85, vcc wave_shr:1 row_mask:0xf bank_mask:0xf
    s_lshr_b64 s[52:53], s[52:53], 1
    v_cndmask_b32_dpp v86, v86, v86, vcc wave_shr:1 row_mask:0xf bank_mask:0xf
    v_cndmask_b32_dpp v87, v87, v87, vcc wave_shr:1 row_mask:0xf bank_mask:0xf
    s_andn2_b64 s[82:83], s[82:83], s[52:53]
    v_cndmask_b32_dpp v7, v7, v7, vcc wave_shr:1 row_mask:0xf bank_mask:0xf
    s_mov_b64 exec, s[54:55]
    s_cbranch_scc0 L2_d59
    s_mov_b64 exec, s[82:83]
    s_nop 1
    v_mfma_f32_4x4x4_16b_bf16 v[88:91], v[12:13], v[84:85], 0
    s_nop 1
    v_mfma_f32_4x4x4_16b_bf16 v[88:91], v[10:11], v[86:87], v[88:91]
    s_nop 4
    v_cvt_pk_bf16_f32 v88, v88, v89
    v_cvt_pk_bf16_f32 v89, v90, v91
    ds_pk_add_bf16 v7, v88 offset:65408
    ds_pk_add_bf16 v7, v89 offset:65412
    s_mov_b64 exec, s[54:55]
    s_branch L2_d59
L2_c60:
    s_lshl_b64 s[52:53], s[82:83], 1
    s_andn2_b64 s[52:53], s[52:53], s[80:81]
    s_andn2_b64 s[52:53], s[52:53], s[50:51]
    s_or_b64 s[80:81], s[80:81], s[52:53]
    s_not_b64 vcc, s[52:53]
    s_mov_b64 exec, -1
    v_cndmask_b32_dpp v84, v84, v84, vcc wave_shr:1 row_mask:0xf bank_mask:0xf
    v_cndmask_b32_dpp v85, v85, v85, vcc wave_shr:1 row_mask:0xf bank_mask:0xf
    s_lshr_b64 s[52:53], s[52:53], 1
    v_cndmask_b32_dpp v86, v86, v86, vcc wave_shr:1 row_mask:0xf bank_mask:0xf
    v_cndmask_b32_dpp v87, v87, v87, vcc wave_shr:1 row_mask:0xf bank_mask:0xf
    s_andn2_b64 s[82:83], s[82:83], s[52:53]
    v_cndmask_b32_dpp v7, v7, v7, vcc wave_shr:1 row_mask:0xf bank_mask:0xf
    s_mov_b64 exec, s[50:51]
    s_cbranch_scc0 L2_d60
    s_mov_b64 exec, s[82:83]
    s_nop 1
    v_mfma_f32_4x4x4_16b_bf16 v[88:91], v[12:13], v[84:85], 0
    s_nop 1
    v_mfma_f32_4x4x4_16b_bf16 v[88:91], v[10:11], v[86:87], v[88:91]
    s_nop 4
    v_cvt_pk_bf16_f32 v88, v88, v89
    v_cvt_pk_bf16_f32 v89, v90, v91
    ds_pk_add_bf16 v7, v88 offset:65408
    ds_pk_add_bf16 v7, v89 offset:65412
    s_mov_b64 exec, s[50:51]
    s_branch L2_d60
L2_xa61:
    s_cmp_eq_u32 s101, 1
    s_cbranch_scc1 L2_xc61
    v_lshlrev_b32 v89, 0, v96
    v_add_u32 v90, 140, v97
    v_bitop3_b32 v90, v89, v45, v90 bitop3:0x6a
    ds_write_b32 v98, v90 offset:28
    v_lshlrev_b32 v89, 4, v96
    v_add_u32 v90, 120, v97
    v_bitop3_b32 v90, v89, v45, v90 bitop3:0x6a
    ds_write_b32 v98, v90 offset:24
    v_lshlrev_b32 v89, 8, v96
    v_add_u32 v90, 100, v97
    v_bitop3_b32 v90, v89, v45, v90 bitop3:0x6a
    ds_write_b32 v98, v90 offset:20
L2_xc61:
    v_lshlrev_b32 v89, 12, v96
    v_add_u32 v90, 80, v97
    v_bitop3_b32 v90, v89, v45, v90 bitop3:0x6a
    ds_write_b32 v98, v90 offset:16
    s_branch L2_xb61
L2_xe61:
    v_cmp_lt_u32 vcc, 32, v99
    v_cmp_lt_u32 s[58:59], 31, v88
    v_lshrrev_b32 v89, 16, v96
    v_add_u32 v97, 80, v97
    s_or_b64 vcc, vcc, s[58:59]
    s_cbranch_scc1 L2_xs61
    v_lshlrev_b32 v89, v1, v89
    v_and_b32 v89, v45, v89
    v_cmp_ne_u32 vcc, 0, v89
    v_xor_b32 v90, v97, v89
    s_add_u32 s3, s37, s38
    v_mbcnt_lo_u32_b32 v98, vcc_lo, 0
    v_mbcnt_hi_u32_b32 v98, vcc_hi, v98
    s_bcnt1_i32_b64 s41, vcc
    v_lshl_add_u32 v98, v98, 2, s3
    s_lshl2_add_u32 s37, s41, s37
    s_mov_b64 exec, vcc
    ds_write_b32 v98, v90
    s_mov_b64 exec, -1
    s_branch L2_xr61
L2_xs61:
    s_waitcnt lgkmcnt(0)
    s_mov_b32 s37, 0x10000
    s_branch L2_xw61
L2_c62:
    s_lshl_b64 s[52:53], s[82:83], 1
    s_andn2_b64 s[52:53], s[52:53], s[80:81]
    s_andn2_b64 s[52:53], s[52:53], s[54:55]
    s_or_b64 s[80:81], s[80:81], s[52:53]
    s_not_b64 vcc, s[52:53]
    s_mov_b64 exec, -1
    v_cndmask_b32_dpp v84, v84, v84, vcc wave_shr:1 row_mask:0xf bank_mask:0xf
    v_cndmask_b32_dpp v85, v85, v85, vcc wave_shr:1 row_mask:0xf bank_mask:0xf
    s_lshr_b64 s[52:53], s[52:53], 1
    v_cndmask_b32_dpp v86, v86, v86, vcc wave_shr:1 row_mask:0xf bank_mask:0xf
    v_cndmask_b32_dpp v87, v87, v87, vcc wave_shr:1 row_mask:0xf bank_mask:0xf
    s_andn2_b64 s[82:83], s[82:83], s[52:53]
    v_cndmask_b32_dpp v7, v7, v7, vcc wave_shr:1 row_mask:0xf bank_mask:0xf
    s_mov_b64 exec, s[54:55]
    s_cbranch_scc0 L2_d62
    s_mov_b64 exec, s[82:83]
    s_nop 1
    v_mfma_f32_4x4x4_16b_bf16 v[88:91], v[12:13], v[84:85], 0
    s_nop 1
    v_mfma_f32_4x4x4_16b_bf16 v[88:91], v[10:11], v[86:87], v[88:91]
    s_nop 4
    v_cvt_pk_bf16_f32 v88, v88, v89
    v_cvt_pk_bf16_f32 v89, v90, v91
    ds_pk_add_bf16 v7, v88 offset:65408
    ds_pk_add_bf16 v7, v89 offset:65412
    s_mov_b64 exec, s[54:55]
    s_branch L2_d62
L2_c63:
    s_lshl_b64 s[52:53], s[82:83], 1
    s_andn2_b64 s[52:53], s[52:53], s[80:81]
    s_andn2_b64 s[52:53], s[52:53], s[50:51]
    s_or_b64 s[80:81], s[80:81], s[52:53]
    s_not_b64 vcc, s[52:53]
    s_mov_b64 exec, -1
    v_cndmask_b32_dpp v84, v84, v84, vcc wave_shr:1 row_mask:0xf bank_mask:0xf
    v_cndmask_b32_dpp v85, v85, v85, vcc wave_shr:1 row_mask:0xf bank_mask:0xf
    s_lshr_b64 s[52:53], s[52:53], 1
    v_cndmask_b32_dpp v86, v86, v86, vcc wave_shr:1 row_mask:0xf bank_mask:0xf
    v_cndmask_b32_dpp v87, v87, v87, vcc wave_shr:1 row_mask:0xf bank_mask:0xf
    s_andn2_b64 s[82:83], s[82:83], s[52:53]
    v_cndmask_b32_dpp v7, v7, v7, vcc wave_shr:1 row_mask:0xf bank_mask:0xf
    s_mov_b64 exec, s[50:51]
    s_cbranch_scc0 L2_d63
    s_mov_b64 exec, s[82:83]
    s_nop 1
    v_mfma_f32_4x4x4_16b_bf16 v[88:91], v[12:13], v[84:85], 0
    s_nop 1
    v_mfma_f32_4x4x4_16b_bf16 v[88:91], v[10:11], v[86:87], v[88:91]
    s_nop 4
    v_cvt_pk_bf16_f32 v88, v88, v89
    v_cvt_pk_bf16_f32 v89, v90, v91
    ds_pk_add_bf16 v7, v88 offset:65408
    ds_pk_add_bf16 v7, v89 offset:65412
    s_mov_b64 exec, s[50:51]
    s_branch L2_d63
L2_xf61:
    s_cmp_gt_u32 s37, 1024
    s_cbranch_scc1 L2_xt61
    s_cmp_lt_u32 s37, 768
    s_cbranch_scc1 L2_xl61
    ds_read_b32 v32, v44 offset:896
    s_add_u32 s3, s42, 2
    s_bitset1_b32 s43, s3
    s_branch L2_xg61
L2_xl61:
    s_waitcnt lgkmcnt(0)
    v_mov_b32 v31, -1
    s_cmp_ge_u32 s37, 512
    s_cbranch_scc1 L2_xg61
    v_mov_b32 v39, -1
    s_cmp_ge_u32 s37, 256
    s_cbranch_scc1 L2_xg61
    v_mov_b32 v27, -1
    s_branch L2_xg61
L2_xt61:
    s_waitcnt lgkmcnt(0)
    v_mov_b32 v21, -1
    v_mov_b32 v27, -1
    v_mov_b32 v39, -1
    v_mov_b32 v31, -1
    s_add_u32 s3, s42, 2
    s_bitset1_b32 s36, s3
    s_branch L2_xg61
L2_oa64:
    v_and_b32 v47, 0x0fffffff, v33
    buffer_load_dword v114, v47, s[8:11], 0 offen offset:16
    s_mov_b64 exec, s[6:7]
    v_add_u32 v47, 8, v47
    v_lshrrev_b32 v33, 2, v33
    s_mov_b64 exec, -1
    buffer_load_dwordx2 v[112:113], v47, s[8:11], 0 offen
    s_branch L2_ob64
L2_c65:
    s_lshl_b64 s[52:53], s[82:83], 1
    s_andn2_b64 s[52:53], s[52:53], s[80:81]
    s_andn2_b64 s[52:53], s[52:53], s[54:55]
    s_or_b64 s[80:81], s[80:81], s[52:53]
    s_not_b64 vcc, s[52:53]
    s_mov_b64 exec, -1
    v_cndmask_b32_dpp v84, v84, v84, vcc wave_shr:1 row_mask:0xf bank_mask:0xf
    v_cndmask_b32_dpp v85, v85, v85, vcc wave_shr:1 row_mask:0xf bank_mask:0xf
    s_lshr_b64 s[52:53], s[52:53], 1
    v_cndmask_b32_dpp v86, v86, v86, vcc wave_shr:1 row_mask:0xf bank_mask:0xf
    v_cndmask_b32_dpp v87, v87, v87, vcc wave_shr:1 row_mask:0xf bank_mask:0xf
    s_andn2_b64 s[82:83], s[82:83], s[52:53]
    v_cndmask_b32_dpp v7, v7, v7, vcc wave_shr:1 row_mask:0xf bank_mask:0xf
    s_mov_b64 exec, s[54:55]
    s_cbranch_scc0 L2_d65
    s_mov_b64 exec, s[82:83]
    s_nop 1
    v_mfma_f32_4x4x4_16b_bf16 v[88:91], v[12:13], v[84:85], 0
    s_nop 1
    v_mfma_f32_4x4x4_16b_bf16 v[88:91], v[10:11], v[86:87], v[88:91]
    s_nop 4
    v_cvt_pk_bf16_f32 v88, v88, v89
    v_cvt_pk_bf16_f32 v89, v90, v91
    ds_pk_add_bf16 v7, v88 offset:65408
    ds_pk_add_bf16 v7, v89 offset:65412
    s_mov_b64 exec, s[54:55]
    s_branch L2_d65
L2_c66:
    s_lshl_b64 s[52:53], s[82:83], 1
    s_andn2_b64 s[52:53], s[52:53], s[80:81]
    s_andn2_b64 s[52:53], s[52:53], s[50:51]
    s_or_b64 s[80:81], s[80:81], s[52:53]
    s_not_b64 vcc, s[52:53]
    s_mov_b64 exec, -1
    v_cndmask_b32_dpp v84, v84, v84, vcc wave_shr:1 row_mask:0xf bank_mask:0xf
    v_cndmask_b32_dpp v85, v85, v85, vcc wave_shr:1 row_mask:0xf bank_mask:0xf
    s_lshr_b64 s[52:53], s[52:53], 1
    v_cndmask_b32_dpp v86, v86, v86, vcc wave_shr:1 row_mask:0xf bank_mask:0xf
    v_cndmask_b32_dpp v87, v87, v87, vcc wave_shr:1 row_mask:0xf bank_mask:0xf
    s_andn2_b64 s[82:83], s[82:83], s[52:53]
    v_cndmask_b32_dpp v7, v7, v7, vcc wave_shr:1 row_mask:0xf bank_mask:0xf
    s_mov_b64 exec, s[50:51]
    s_cbranch_scc0 L2_d66
    s_mov_b64 exec, s[82:83]
    s_nop 1
    v_mfma_f32_4x4x4_16b_bf16 v[88:91], v[12:13], v[84:85], 0
    s_nop 1
    v_mfma_f32_4x4x4_16b_bf16 v[88:91], v[10:11], v[86:87], v[88:91]
    s_nop 4
    v_cvt_pk_bf16_f32 v88, v88, v89
    v_cvt_pk_bf16_f32 v89, v90, v91
    ds_pk_add_bf16 v7, v88 offset:65408
    ds_pk_add_bf16 v7, v89 offset:65412
    s_mov_b64 exec, s[50:51]
    s_branch L2_d66
L2_c67:
    s_lshl_b64 s[52:53], s[82:83], 1
    s_andn2_b64 s[52:53], s[52:53], s[80:81]
    s_andn2_b64 s[52:53], s[52:53], s[54:55]
    s_or_b64 s[80:81], s[80:81], s[52:53]
    s_not_b64 vcc, s[52:53]
    s_mov_b64 exec, -1
    v_cndmask_b32_dpp v84, v84, v84, vcc wave_shr:1 row_mask:0xf bank_mask:0xf
    v_cndmask_b32_dpp v85, v85, v85, vcc wave_shr:1 row_mask:0xf bank_mask:0xf
    s_lshr_b64 s[52:53], s[52:53], 1
    v_cndmask_b32_dpp v86, v86, v86, vcc wave_shr:1 row_mask:0xf bank_mask:0xf
    v_cndmask_b32_dpp v87, v87, v87, vcc wave_shr:1 row_mask:0xf bank_mask:0xf
    s_andn2_b64 s[82:83], s[82:83], s[52:53]
    v_cndmask_b32_dpp v7, v7, v7, vcc wave_shr:1 row_mask:0xf bank_mask:0xf
    s_mov_b64 exec, s[54:55]
    s_cbranch_scc0 L2_d67
    s_mov_b64 exec, s[82:83]
    s_nop 1
    v_mfma_f32_4x4x4_16b_bf16 v[88:91], v[12:13], v[84:85], 0
    s_nop 1
    v_mfma_f32_4x4x4_16b_bf16 v[88:91], v[10:11], v[86:87], v[88:91]
    s_nop 4
    v_cvt_pk_bf16_f32 v88, v88, v89
    v_cvt_pk_bf16_f32 v89, v90, v91
    ds_pk_add_bf16 v7, v88 offset:65408
    ds_pk_add_bf16 v7, v89 offset:65412
    s_mov_b64 exec, s[54:55]
    s_branch L2_d67
L2_c68:
    s_lshl_b64 s[52:53], s[82:83], 1
    s_andn2_b64 s[52:53], s[52:53], s[80:81]
    s_andn2_b64 s[52:53], s[52:53], s[50:51]
    s_or_b64 s[80:81], s[80:81], s[52:53]
    s_not_b64 vcc, s[52:53]
    s_mov_b64 exec, -1
    v_cndmask_b32_dpp v84, v84, v84, vcc wave_shr:1 row_mask:0xf bank_mask:0xf
    v_cndmask_b32_dpp v85, v85, v85, vcc wave_shr:1 row_mask:0xf bank_mask:0xf
    s_lshr_b64 s[52:53], s[52:53], 1
    v_cndmask_b32_dpp v86, v86, v86, vcc wave_shr:1 row_mask:0xf bank_mask:0xf
    v_cndmask_b32_dpp v87, v87, v87, vcc wave_shr:1 row_mask:0xf bank_mask:0xf
    s_andn2_b64 s[82:83], s[82:83], s[52:53]
    v_cndmask_b32_dpp v7, v7, v7, vcc wave_shr:1 row_mask:0xf bank_mask:0xf
    s_mov_b64 exec, s[50:51]
    s_cbranch_scc0 L2_d68
    s_mov_b64 exec, s[82:83]
    s_nop 1
    v_mfma_f32_4x4x4_16b_bf16 v[88:91], v[12:13], v[84:85], 0
    s_nop 1
    v_mfma_f32_4x4x4_16b_bf16 v[88:91], v[10:11], v[86:87], v[88:91]
    s_nop 4
    v_cvt_pk_bf16_f32 v88, v88, v89
    v_cvt_pk_bf16_f32 v89, v90, v91
    ds_pk_add_bf16 v7, v88 offset:65408
    ds_pk_add_bf16 v7, v89 offset:65412
    s_mov_b64 exec, s[50:51]
    s_branch L2_d68
L2_c69:
    s_lshl_b64 s[52:53], s[82:83], 1
    s_andn2_b64 s[52:53], s[52:53], s[80:81]
    s_andn2_b64 s[52:53], s[52:53], s[54:55]
    s_or_b64 s[80:81], s[80:81], s[52:53]
    s_not_b64 vcc, s[52:53]
    s_mov_b64 exec, -1
    v_cndmask_b32_dpp v84, v84, v84, vcc wave_shr:1 row_mask:0xf bank_mask:0xf
    v_cndmask_b32_dpp v85, v85, v85, vcc wave_shr:1 row_mask:0xf bank_mask:0xf
    s_lshr_b64 s[52:53], s[52:53], 1
    v_cndmask_b32_dpp v86, v86, v86, vcc wave_shr:1 row_mask:0xf bank_mask:0xf
    v_cndmask_b32_dpp v87, v87, v87, vcc wave_shr:1 row_mask:0xf bank_mask:0xf
    s_andn2_b64 s[82:83], s[82:83], s[52:53]
    v_cndmask_b32_dpp v7, v7, v7, vcc wave_shr:1 row_mask:0xf bank_mask:0xf
    s_mov_b64 exec, s[54:55]
    s_cbranch_scc0 L2_d69
    s_mov_b64 exec, s[82:83]
    s_nop 1
    v_mfma_f32_4x4x4_16b_bf16 v[88:91], v[12:13], v[84:85], 0
    s_nop 1
    v_mfma_f32_4x4x4_16b_bf16 v[88:91], v[10:11], v[86:87], v[88:91]
    s_nop 4
    v_cvt_pk_bf16_f32 v88, v88, v89
    v_cvt_pk_bf16_f32 v89, v90, v91
    ds_pk_add_bf16 v7, v88 offset:65408
    ds_pk_add_bf16 v7, v89 offset:65412
    s_mov_b64 exec, s[54:55]
    s_branch L2_d69
L2_c70:
    s_lshl_b64 s[52:53], s[82:83], 1
    s_andn2_b64 s[52:53], s[52:53], s[80:81]
    s_andn2_b64 s[52:53], s[52:53], s[50:51]
    s_or_b64 s[80:81], s[80:81], s[52:53]
    s_not_b64 vcc, s[52:53]
    s_mov_b64 exec, -1
    v_cndmask_b32_dpp v84, v84, v84, vcc wave_shr:1 row_mask:0xf bank_mask:0xf
    v_cndmask_b32_dpp v85, v85, v85, vcc wave_shr:1 row_mask:0xf bank_mask:0xf
    s_lshr_b64 s[52:53], s[52:53], 1
    v_cndmask_b32_dpp v86, v86, v86, vcc wave_shr:1 row_mask:0xf bank_mask:0xf
    v_cndmask_b32_dpp v87, v87, v87, vcc wave_shr:1 row_mask:0xf bank_mask:0xf
    s_andn2_b64 s[82:83], s[82:83], s[52:53]
    v_cndmask_b32_dpp v7, v7, v7, vcc wave_shr:1 row_mask:0xf bank_mask:0xf
    s_mov_b64 exec, s[50:51]
    s_cbranch_scc0 L2_d70
    s_mov_b64 exec, s[82:83]
    s_nop 1
    v_mfma_f32_4x4x4_16b_bf16 v[88:91], v[12:13], v[84:85], 0
    s_nop 1
    v_mfma_f32_4x4x4_16b_bf16 v[88:91], v[10:11], v[86:87], v[88:91]
    s_nop 4
    v_cvt_pk_bf16_f32 v88, v88, v89
    v_cvt_pk_bf16_f32 v89, v90, v91
    ds_pk_add_bf16 v7, v88 offset:65408
    ds_pk_add_bf16 v7, v89 offset:65412
    s_mov_b64 exec, s[50:51]
    s_branch L2_d70
L2_oa71:
    s_waitcnt vmcnt(3)
    s_mov_b64 exec, s[6:7]
    v_lshrrev_b32 v114, 16, v114
    s_mov_b64 exec, -1
    v_and_b32 v46, 0x10000000, v33
    v_cmpx_eq_u32 vcc, 0, v46
    v_lshrrev_b32 v47, 14, v112
    v_and_b32 v47, v5, v47
    ds_read_b64 v[96:97], v47
    v_perm_b32 v98, v112, v114, s44
    v_bitop3_b32 v99, v112, 0.5, -0.5 bitop3:0xa8
    v_bitop3_b32 v98, v6, v98, v99 bitop3:0xca
    v_and_b32 v47, v5, v112
    s_waitcnt lgkmcnt(0)
    v_mfma_f32_4x4x4_16b_bf16 v[88:91], v[8:9], v[96:97], 0
    s_nop 4
    v_mul_f32 v88, v98, v88
    v_mul_f32 v89, v98, v89
    v_mul_f32 v90, v98, v90
    v_mul_f32 v91, v98, v91
    v_cvt_pk_bf16_f32 v88, v88, v89
    v_cvt_pk_bf16_f32 v89, v90, v91
    ds_pk_add_bf16 v47, v88 offset:65408
    ds_pk_add_bf16 v47, v89 offset:65412
    s_mov_b64 exec, -1
    v_and_b32 v46, 0x20000000, v33
    v_cmpx_eq_u32 vcc, 0, v46
    v_lshrrev_b32 v47, 14, v113
    v_and_b32 v47, v5, v47
    ds_read_b64 v[96:97], v47
    v_perm_b32 v98, v113, v114, s45
    v_bitop3_b32 v99, v113, 0.5, -0.5 bitop3:0xa8
    v_bitop3_b32 v98, v6, v98, v99 bitop3:0xca
    v_and_b32 v47, v5, v113
    s_waitcnt lgkmcnt(0)
    v_mfma_f32_4x4x4_16b_bf16 v[88:91], v[8:9], v[96:97], 0
    s_nop 4
    v_mul_f32 v88, v98, v88
    v_mul_f32 v89, v98, v89
    v_mul_f32 v90, v98, v90
    v_mul_f32 v91, v98, v91
    v_cvt_pk_bf16_f32 v88, v88, v89
    v_cvt_pk_bf16_f32 v89, v90, v91
    ds_pk_add_bf16 v47, v88 offset:65408
    ds_pk_add_bf16 v47, v89 offset:65412
    s_mov_b64 exec, -1
    s_branch L2_ob71
L2_xo72:
    v_cmp_lt_u32 vcc, 20, v99
    s_mov_b32 s101, 1
    s_cbranch_vccz L2_xp72
    v_cmp_lt_u32 vcc, 32, v99
    v_cmp_lt_u32 s[58:59], 31, v88
    s_mov_b32 s101, 2
    s_or_b64 vcc, vcc, s[58:59]
    s_cbranch_scc0 L2_xp72
    s_mov_b32 s37, 0x10000
    s_branch L2_xp72
L2_c73:
    s_lshl_b64 s[52:53], s[82:83], 1
    s_andn2_b64 s[52:53], s[52:53], s[80:81]
    s_andn2_b64 s[52:53], s[52:53], s[54:55]
    s_or_b64 s[80:81], s[80:81], s[52:53]
    s_not_b64 vcc, s[52:53]
    s_mov_b64 exec, -1
    v_cndmask_b32_dpp v84, v84, v84, vcc wave_shr:1 row_mask:0xf bank_mask:0xf
    v_cndmask_b32_dpp v85, v85, v85, vcc wave_shr:1 row_mask:0xf bank_mask:0xf
    s_lshr_b64 s[52:53], s[52:53], 1
    v_cndmask_b32_dpp v86, v86, v86, vcc wave_shr:1 row_mask:0xf bank_mask:0xf
    v_cndmask_b32_dpp v87, v87, v87, vcc wave_shr:1 row_mask:0xf bank_mask:0xf
    s_andn2_b64 s[82:83], s[82:83], s[52:53]
    v_cndmask_b32_dpp v7, v7, v7, vcc wave_shr:1 row_mask:0xf bank_mask:0xf
    s_mov_b64 exec, s[54:55]
    s_cbranch_scc0 L2_d73
    s_mov_b64 exec, s[82:83]
    s_nop 1
    v_mfma_f32_4x4x4_16b_bf16 v[88:91], v[12:13], v[84:85], 0
    s_nop 1
    v_mfma_f32_4x4x4_16b_bf16 v[88:91], v[10:11], v[86:87], v[88:91]
    s_nop 4
    v_cvt_pk_bf16_f32 v88, v88, v89
    v_cvt_pk_bf16_f32 v89, v90, v91
    ds_pk_add_bf16 v7, v88 offset:65408
    ds_pk_add_bf16 v7, v89 offset:65412
    s_mov_b64 exec, s[54:55]
    s_branch L2_d73
L2_c74:
    s_lshl_b64 s[52:53], s[82:83], 1
    s_andn2_b64 s[52:53], s[52:53], s[80:81]
    s_andn2_b64 s[52:53], s[52:53], s[50:51]
    s_or_b64 s[80:81], s[80:81], s[52:53]
    s_not_b64 vcc, s[52:53]
    s_mov_b64 exec, -1
    v_cndmask_b32_dpp v84, v84, v84, vcc wave_shr:1 row_mask:0xf bank_mask:0xf
    v_cndmask_b32_dpp v85, v85, v85, vcc wave_shr:1 row_mask:0xf bank_mask:0xf
    s_lshr_b64 s[52:53], s[52:53], 1
    v_cndmask_b32_dpp v86, v86, v86, vcc wave_shr:1 row_mask:0xf bank_mask:0xf
    v_cndmask_b32_dpp v87, v87, v87, vcc wave_shr:1 row_mask:0xf bank_mask:0xf
    s_andn2_b64 s[82:83], s[82:83], s[52:53]
    v_cndmask_b32_dpp v7, v7, v7, vcc wave_shr:1 row_mask:0xf bank_mask:0xf
    s_mov_b64 exec, s[50:51]
    s_cbranch_scc0 L2_d74
    s_mov_b64 exec, s[82:83]
    s_nop 1
    v_mfma_f32_4x4x4_16b_bf16 v[88:91], v[12:13], v[84:85], 0
    s_nop 1
    v_mfma_f32_4x4x4_16b_bf16 v[88:91], v[10:11], v[86:87], v[88:91]
    s_nop 4
    v_cvt_pk_bf16_f32 v88, v88, v89
    v_cvt_pk_bf16_f32 v89, v90, v91
    ds_pk_add_bf16 v7, v88 offset:65408
    ds_pk_add_bf16 v7, v89 offset:65412
    s_mov_b64 exec, s[50:51]
    s_branch L2_d74
L2_c75:
    s_lshl_b64 s[52:53], s[82:83], 1
    s_andn2_b64 s[52:53], s[52:53], s[80:81]
    s_andn2_b64 s[52:53], s[52:53], s[54:55]
    s_or_b64 s[80:81], s[80:81], s[52:53]
    s_not_b64 vcc, s[52:53]
    s_mov_b64 exec, -1
    v_cndmask_b32_dpp v84, v84, v84, vcc wave_shr:1 row_mask:0xf bank_mask:0xf
    v_cndmask_b32_dpp v85, v85, v85, vcc wave_shr:1 row_mask:0xf bank_mask:0xf
    s_lshr_b64 s[52:53], s[52:53], 1
    v_cndmask_b32_dpp v86, v86, v86, vcc wave_shr:1 row_mask:0xf bank_mask:0xf
    v_cndmask_b32_dpp v87, v87, v87, vcc wave_shr:1 row_mask:0xf bank_mask:0xf
    s_andn2_b64 s[82:83], s[82:83], s[52:53]
    v_cndmask_b32_dpp v7, v7, v7, vcc wave_shr:1 row_mask:0xf bank_mask:0xf
    s_mov_b64 exec, s[54:55]
    s_cbranch_scc0 L2_d75
    s_mov_b64 exec, s[82:83]
    s_nop 1
    v_mfma_f32_4x4x4_16b_bf16 v[88:91], v[12:13], v[84:85], 0
    s_nop 1
    v_mfma_f32_4x4x4_16b_bf16 v[88:91], v[10:11], v[86:87], v[88:91]
    s_nop 4
    v_cvt_pk_bf16_f32 v88, v88, v89
    v_cvt_pk_bf16_f32 v89, v90, v91
    ds_pk_add_bf16 v7, v88 offset:65408
    ds_pk_add_bf16 v7, v89 offset:65412
    s_mov_b64 exec, s[54:55]
    s_branch L2_d75
L2_c76:
    s_lshl_b64 s[52:53], s[82:83], 1
    s_andn2_b64 s[52:53], s[52:53], s[80:81]
    s_andn2_b64 s[52:53], s[52:53], s[50:51]
    s_or_b64 s[80:81], s[80:81], s[52:53]
    s_not_b64 vcc, s[52:53]
    s_mov_b64 exec, -1
    v_cndmask_b32_dpp v84, v84, v84, vcc wave_shr:1 row_mask:0xf bank_mask:0xf
    v_cndmask_b32_dpp v85, v85, v85, vcc wave_shr:1 row_mask:0xf bank_mask:0xf
    s_lshr_b64 s[52:53], s[52:53], 1
    v_cndmask_b32_dpp v86, v86, v86, vcc wave_shr:1 row_mask:0xf bank_mask:0xf
    v_cndmask_b32_dpp v87, v87, v87, vcc wave_shr:1 row_mask:0xf bank_mask:0xf
    s_andn2_b64 s[82:83], s[82:83], s[52:53]
    v_cndmask_b32_dpp v7, v7, v7, vcc wave_shr:1 row_mask:0xf bank_mask:0xf
    s_mov_b64 exec, s[50:51]
    s_cbranch_scc0 L2_d76
    s_mov_b64 exec, s[82:83]
    s_nop 1
    v_mfma_f32_4x4x4_16b_bf16 v[88:91], v[12:13], v[84:85], 0
    s_nop 1
    v_mfma_f32_4x4x4_16b_bf16 v[88:91], v[10:11], v[86:87], v[88:91]
    s_nop 4
    v_cvt_pk_bf16_f32 v88, v88, v89
    v_cvt_pk_bf16_f32 v89, v90, v91
    ds_pk_add_bf16 v7, v88 offset:65408
    ds_pk_add_bf16 v7, v89 offset:65412
    s_mov_b64 exec, s[50:51]
    s_branch L2_d76
L2_c77:
    s_lshl_b64 s[52:53], s[82:83], 1
    s_andn2_b64 s[52:53], s[52:53], s[80:81]
    s_andn2_b64 s[52:53], s[52:53], s[54:55]
    s_or_b64 s[80:81], s[80:81], s[52:53]
    s_not_b64 vcc, s[52:53]
    s_mov_b64 exec, -1
    v_cndmask_b32_dpp v84, v84, v84, vcc wave_shr:1 row_mask:0xf bank_mask:0xf
    v_cndmask_b32_dpp v85, v85, v85, vcc wave_shr:1 row_mask:0xf bank_mask:0xf
    s_lshr_b64 s[52:53], s[52:53], 1
    v_cndmask_b32_dpp v86, v86, v86, vcc wave_shr:1 row_mask:0xf bank_mask:0xf
    v_cndmask_b32_dpp v87, v87, v87, vcc wave_shr:1 row_mask:0xf bank_mask:0xf
    s_andn2_b64 s[82:83], s[82:83], s[52:53]
    v_cndmask_b32_dpp v7, v7, v7, vcc wave_shr:1 row_mask:0xf bank_mask:0xf
    s_mov_b64 exec, s[54:55]
    s_cbranch_scc0 L2_d77
    s_mov_b64 exec, s[82:83]
    s_nop 1
    v_mfma_f32_4x4x4_16b_bf16 v[88:91], v[12:13], v[84:85], 0
    s_nop 1
    v_mfma_f32_4x4x4_16b_bf16 v[88:91], v[10:11], v[86:87], v[88:91]
    s_nop 4
    v_cvt_pk_bf16_f32 v88, v88, v89
    v_cvt_pk_bf16_f32 v89, v90, v91
    ds_pk_add_bf16 v7, v88 offset:65408
    ds_pk_add_bf16 v7, v89 offset:65412
    s_mov_b64 exec, s[54:55]
    s_branch L2_d77
L2_c78:
    s_lshl_b64 s[52:53], s[82:83], 1
    s_andn2_b64 s[52:53], s[52:53], s[80:81]
    s_andn2_b64 s[52:53], s[52:53], s[50:51]
    s_or_b64 s[80:81], s[80:81], s[52:53]
    s_not_b64 vcc, s[52:53]
    s_mov_b64 exec, -1
    v_cndmask_b32_dpp v84, v84, v84, vcc wave_shr:1 row_mask:0xf bank_mask:0xf
    v_cndmask_b32_dpp v85, v85, v85, vcc wave_shr:1 row_mask:0xf bank_mask:0xf
    s_lshr_b64 s[52:53], s[52:53], 1
    v_cndmask_b32_dpp v86, v86, v86, vcc wave_shr:1 row_mask:0xf bank_mask:0xf
    v_cndmask_b32_dpp v87, v87, v87, vcc wave_shr:1 row_mask:0xf bank_mask:0xf
    s_andn2_b64 s[82:83], s[82:83], s[52:53]
    v_cndmask_b32_dpp v7, v7, v7, vcc wave_shr:1 row_mask:0xf bank_mask:0xf
    s_mov_b64 exec, s[50:51]
    s_cbranch_scc0 L2_d78
    s_mov_b64 exec, s[82:83]
    s_nop 1
    v_mfma_f32_4x4x4_16b_bf16 v[88:91], v[12:13], v[84:85], 0
    s_nop 1
    v_mfma_f32_4x4x4_16b_bf16 v[88:91], v[10:11], v[86:87], v[88:91]
    s_nop 4
    v_cvt_pk_bf16_f32 v88, v88, v89
    v_cvt_pk_bf16_f32 v89, v90, v91
    ds_pk_add_bf16 v7, v88 offset:65408
    ds_pk_add_bf16 v7, v89 offset:65412
    s_mov_b64 exec, s[50:51]
    s_branch L2_d78
L2_xa79:
    s_cmp_eq_u32 s101, 1
    s_cbranch_scc1 L2_xc79
    v_lshlrev_b32 v89, 0, v96
    v_add_u32 v90, 140, v97
    v_bitop3_b32 v90, v89, v45, v90 bitop3:0x6a
    ds_write_b32 v98, v90 offset:28
    v_lshlrev_b32 v89, 4, v96
    v_add_u32 v90, 120, v97
    v_bitop3_b32 v90, v89, v45, v90 bitop3:0x6a
    ds_write_b32 v98, v90 offset:24
    v_lshlrev_b32 v89, 8, v96
    v_add_u32 v90, 100, v97
    v_bitop3_b32 v90, v89, v45, v90 bitop3:0x6a
    ds_write_b32 v98, v90 offset:20
L2_xc79:
    v_lshlrev_b32 v89, 12, v96
    v_add_u32 v90, 80, v97
    v_bitop3_b32 v90, v89, v45, v90 bitop3:0x6a
    ds_write_b32 v98, v90 offset:16
    s_branch L2_xb79
L2_xe79:
    v_cmp_lt_u32 vcc, 32, v99
    v_cmp_lt_u32 s[58:59], 31, v88
    v_lshrrev_b32 v89, 16, v96
    v_add_u32 v97, 80, v97
    s_or_b64 vcc, vcc, s[58:59]
    s_cbranch_scc1 L2_xs79
    v_lshlrev_b32 v89, v1, v89
    v_and_b32 v89, v45, v89
    v_cmp_ne_u32 vcc, 0, v89
    v_xor_b32 v90, v97, v89
    s_add_u32 s3, s37, s38
    v_mbcnt_lo_u32_b32 v98, vcc_lo, 0
    v_mbcnt_hi_u32_b32 v98, vcc_hi, v98
    s_bcnt1_i32_b64 s41, vcc
    v_lshl_add_u32 v98, v98, 2, s3
    s_lshl2_add_u32 s37, s41, s37
    s_mov_b64 exec, vcc
    ds_write_b32 v98, v90
    s_mov_b64 exec, -1
    s_branch L2_xr79
L2_xs79:
    s_waitcnt lgkmcnt(0)
    s_mov_b32 s37, 0x10000
    s_branch L2_xw79
L2_c80:
    s_lshl_b64 s[52:53], s[82:83], 1
    s_andn2_b64 s[52:53], s[52:53], s[80:81]
    s_andn2_b64 s[52:53], s[52:53], s[54:55]
    s_or_b64 s[80:81], s[80:81], s[52:53]
    s_not_b64 vcc, s[52:53]
    s_mov_b64 exec, -1
    v_cndmask_b32_dpp v84, v84, v84, vcc wave_shr:1 row_mask:0xf bank_mask:0xf
    v_cndmask_b32_dpp v85, v85, v85, vcc wave_shr:1 row_mask:0xf bank_mask:0xf
    s_lshr_b64 s[52:53], s[52:53], 1
    v_cndmask_b32_dpp v86, v86, v86, vcc wave_shr:1 row_mask:0xf bank_mask:0xf
    v_cndmask_b32_dpp v87, v87, v87, vcc wave_shr:1 row_mask:0xf bank_mask:0xf
    s_andn2_b64 s[82:83], s[82:83], s[52:53]
    v_cndmask_b32_dpp v7, v7, v7, vcc wave_shr:1 row_mask:0xf bank_mask:0xf
    s_mov_b64 exec, s[54:55]
    s_cbranch_scc0 L2_d80
    s_mov_b64 exec, s[82:83]
    s_nop 1
    v_mfma_f32_4x4x4_16b_bf16 v[88:91], v[12:13], v[84:85], 0
    s_nop 1
    v_mfma_f32_4x4x4_16b_bf16 v[88:91], v[10:11], v[86:87], v[88:91]
    s_nop 4
    v_cvt_pk_bf16_f32 v88, v88, v89
    v_cvt_pk_bf16_f32 v89, v90, v91
    ds_pk_add_bf16 v7, v88 offset:65408
    ds_pk_add_bf16 v7, v89 offset:65412
    s_mov_b64 exec, s[54:55]
    s_branch L2_d80
L2_c81:
    s_lshl_b64 s[52:53], s[82:83], 1
    s_andn2_b64 s[52:53], s[52:53], s[80:81]
    s_andn2_b64 s[52:53], s[52:53], s[50:51]
    s_or_b64 s[80:81], s[80:81], s[52:53]
    s_not_b64 vcc, s[52:53]
    s_mov_b64 exec, -1
    v_cndmask_b32_dpp v84, v84, v84, vcc wave_shr:1 row_mask:0xf bank_mask:0xf
    v_cndmask_b32_dpp v85, v85, v85, vcc wave_shr:1 row_mask:0xf bank_mask:0xf
    s_lshr_b64 s[52:53], s[52:53], 1
    v_cndmask_b32_dpp v86, v86, v86, vcc wave_shr:1 row_mask:0xf bank_mask:0xf
    v_cndmask_b32_dpp v87, v87, v87, vcc wave_shr:1 row_mask:0xf bank_mask:0xf
    s_andn2_b64 s[82:83], s[82:83], s[52:53]
    v_cndmask_b32_dpp v7, v7, v7, vcc wave_shr:1 row_mask:0xf bank_mask:0xf
    s_mov_b64 exec, s[50:51]
    s_cbranch_scc0 L2_d81
    s_mov_b64 exec, s[82:83]
    s_nop 1
    v_mfma_f32_4x4x4_16b_bf16 v[88:91], v[12:13], v[84:85], 0
    s_nop 1
    v_mfma_f32_4x4x4_16b_bf16 v[88:91], v[10:11], v[86:87], v[88:91]
    s_nop 4
    v_cvt_pk_bf16_f32 v88, v88, v89
    v_cvt_pk_bf16_f32 v89, v90, v91
    ds_pk_add_bf16 v7, v88 offset:65408
    ds_pk_add_bf16 v7, v89 offset:65412
    s_mov_b64 exec, s[50:51]
    s_branch L2_d81
L2_xf79:
    s_cmp_gt_u32 s37, 1024
    s_cbranch_scc1 L2_xt79
    s_cmp_lt_u32 s37, 768
    s_cbranch_scc1 L2_xl79
    ds_read_b32 v33, v44 offset:896
    s_add_u32 s3, s42, 2
    s_bitset1_b32 s43, s3
    s_branch L2_xg79
L2_xl79:
    s_waitcnt lgkmcnt(0)
    v_mov_b32 v42, -1
    s_cmp_ge_u32 s37, 512
    s_cbranch_scc1 L2_xg79
    v_mov_b32 v43, -1
    s_cmp_ge_u32 s37, 256
    s_cbranch_scc1 L2_xg79
    v_mov_b32 v41, -1
    s_branch L2_xg79
L2_xt79:
    s_waitcnt lgkmcnt(0)
    v_mov_b32 v40, -1
    v_mov_b32 v41, -1
    v_mov_b32 v43, -1
    v_mov_b32 v42, -1
    s_add_u32 s3, s42, 2
    s_bitset1_b32 s36, s3
    s_branch L2_xg79
L2_oa82:
    v_and_b32 v47, 0x0fffffff, v32
    buffer_load_dword v114, v47, s[8:11], 0 offen offset:16
    s_mov_b64 exec, s[6:7]
    v_add_u32 v47, 8, v47
    v_lshrrev_b32 v32, 2, v32
    s_mov_b64 exec, -1
    buffer_load_dwordx2 v[112:113], v47, s[8:11], 0 offen
    s_branch L2_ob82
L2_c83:
    s_lshl_b64 s[52:53], s[82:83], 1
    s_andn2_b64 s[52:53], s[52:53], s[80:81]
    s_andn2_b64 s[52:53], s[52:53], s[54:55]
    s_or_b64 s[80:81], s[80:81], s[52:53]
    s_not_b64 vcc, s[52:53]
    s_mov_b64 exec, -1
    v_cndmask_b32_dpp v84, v84, v84, vcc wave_shr:1 row_mask:0xf bank_mask:0xf
    v_cndmask_b32_dpp v85, v85, v85, vcc wave_shr:1 row_mask:0xf bank_mask:0xf
    s_lshr_b64 s[52:53], s[52:53], 1
    v_cndmask_b32_dpp v86, v86, v86, vcc wave_shr:1 row_mask:0xf bank_mask:0xf
    v_cndmask_b32_dpp v87, v87, v87, vcc wave_shr:1 row_mask:0xf bank_mask:0xf
    s_andn2_b64 s[82:83], s[82:83], s[52:53]
    v_cndmask_b32_dpp v7, v7, v7, vcc wave_shr:1 row_mask:0xf bank_mask:0xf
    s_mov_b64 exec, s[54:55]
    s_cbranch_scc0 L2_d83
    s_mov_b64 exec, s[82:83]
    s_nop 1
    v_mfma_f32_4x4x4_16b_bf16 v[88:91], v[12:13], v[84:85], 0
    s_nop 1
    v_mfma_f32_4x4x4_16b_bf16 v[88:91], v[10:11], v[86:87], v[88:91]
    s_nop 4
    v_cvt_pk_bf16_f32 v88, v88, v89
    v_cvt_pk_bf16_f32 v89, v90, v91
    ds_pk_add_bf16 v7, v88 offset:65408
    ds_pk_add_bf16 v7, v89 offset:65412
    s_mov_b64 exec, s[54:55]
    s_branch L2_d83
L2_c84:
    s_lshl_b64 s[52:53], s[82:83], 1
    s_andn2_b64 s[52:53], s[52:53], s[80:81]
    s_andn2_b64 s[52:53], s[52:53], s[50:51]
    s_or_b64 s[80:81], s[80:81], s[52:53]
    s_not_b64 vcc, s[52:53]
    s_mov_b64 exec, -1
    v_cndmask_b32_dpp v84, v84, v84, vcc wave_shr:1 row_mask:0xf bank_mask:0xf
    v_cndmask_b32_dpp v85, v85, v85, vcc wave_shr:1 row_mask:0xf bank_mask:0xf
    s_lshr_b64 s[52:53], s[52:53], 1
    v_cndmask_b32_dpp v86, v86, v86, vcc wave_shr:1 row_mask:0xf bank_mask:0xf
    v_cndmask_b32_dpp v87, v87, v87, vcc wave_shr:1 row_mask:0xf bank_mask:0xf
    s_andn2_b64 s[82:83], s[82:83], s[52:53]
    v_cndmask_b32_dpp v7, v7, v7, vcc wave_shr:1 row_mask:0xf bank_mask:0xf
    s_mov_b64 exec, s[50:51]
    s_cbranch_scc0 L2_d84
    s_mov_b64 exec, s[82:83]
    s_nop 1
    v_mfma_f32_4x4x4_16b_bf16 v[88:91], v[12:13], v[84:85], 0
    s_nop 1
    v_mfma_f32_4x4x4_16b_bf16 v[88:91], v[10:11], v[86:87], v[88:91]
    s_nop 4
    v_cvt_pk_bf16_f32 v88, v88, v89
    v_cvt_pk_bf16_f32 v89, v90, v91
    ds_pk_add_bf16 v7, v88 offset:65408
    ds_pk_add_bf16 v7, v89 offset:65412
    s_mov_b64 exec, s[50:51]
    s_branch L2_d84
L2_c85:
    s_lshl_b64 s[52:53], s[82:83], 1
    s_andn2_b64 s[52:53], s[52:53], s[80:81]
    s_andn2_b64 s[52:53], s[52:53], s[54:55]
    s_or_b64 s[80:81], s[80:81], s[52:53]
    s_not_b64 vcc, s[52:53]
    s_mov_b64 exec, -1
    v_cndmask_b32_dpp v84, v84, v84, vcc wave_shr:1 row_mask:0xf bank_mask:0xf
    v_cndmask_b32_dpp v85, v85, v85, vcc wave_shr:1 row_mask:0xf bank_mask:0xf
    s_lshr_b64 s[52:53], s[52:53], 1
    v_cndmask_b32_dpp v86, v86, v86, vcc wave_shr:1 row_mask:0xf bank_mask:0xf
    v_cndmask_b32_dpp v87, v87, v87, vcc wave_shr:1 row_mask:0xf bank_mask:0xf
    s_andn2_b64 s[82:83], s[82:83], s[52:53]
    v_cndmask_b32_dpp v7, v7, v7, vcc wave_shr:1 row_mask:0xf bank_mask:0xf
    s_mov_b64 exec, s[54:55]
    s_cbranch_scc0 L2_d85
    s_mov_b64 exec, s[82:83]
    s_nop 1
    v_mfma_f32_4x4x4_16b_bf16 v[88:91], v[12:13], v[84:85], 0
    s_nop 1
    v_mfma_f32_4x4x4_16b_bf16 v[88:91], v[10:11], v[86:87], v[88:91]
    s_nop 4
    v_cvt_pk_bf16_f32 v88, v88, v89
    v_cvt_pk_bf16_f32 v89, v90, v91
    ds_pk_add_bf16 v7, v88 offset:65408
    ds_pk_add_bf16 v7, v89 offset:65412
    s_mov_b64 exec, s[54:55]
    s_branch L2_d85
L2_c86:
    s_lshl_b64 s[52:53], s[82:83], 1
    s_andn2_b64 s[52:53], s[52:53], s[80:81]
    s_andn2_b64 s[52:53], s[52:53], s[50:51]
    s_or_b64 s[80:81], s[80:81], s[52:53]
    s_not_b64 vcc, s[52:53]
    s_mov_b64 exec, -1
    v_cndmask_b32_dpp v84, v84, v84, vcc wave_shr:1 row_mask:0xf bank_mask:0xf
    v_cndmask_b32_dpp v85, v85, v85, vcc wave_shr:1 row_mask:0xf bank_mask:0xf
    s_lshr_b64 s[52:53], s[52:53], 1
    v_cndmask_b32_dpp v86, v86, v86, vcc wave_shr:1 row_mask:0xf bank_mask:0xf
    v_cndmask_b32_dpp v87, v87, v87, vcc wave_shr:1 row_mask:0xf bank_mask:0xf
    s_andn2_b64 s[82:83], s[82:83], s[52:53]
    v_cndmask_b32_dpp v7, v7, v7, vcc wave_shr:1 row_mask:0xf bank_mask:0xf
    s_mov_b64 exec, s[50:51]
    s_cbranch_scc0 L2_d86
    s_mov_b64 exec, s[82:83]
    s_nop 1
    v_mfma_f32_4x4x4_16b_bf16 v[88:91], v[12:13], v[84:85], 0
    s_nop 1
    v_mfma_f32_4x4x4_16b_bf16 v[88:91], v[10:11], v[86:87], v[88:91]
    s_nop 4
    v_cvt_pk_bf16_f32 v88, v88, v89
    v_cvt_pk_bf16_f32 v89, v90, v91
    ds_pk_add_bf16 v7, v88 offset:65408
    ds_pk_add_bf16 v7, v89 offset:65412
    s_mov_b64 exec, s[50:51]
    s_branch L2_d86
L2_c87:
    s_lshl_b64 s[52:53], s[82:83], 1
    s_andn2_b64 s[52:53], s[52:53], s[80:81]
    s_andn2_b64 s[52:53], s[52:53], s[54:55]
    s_or_b64 s[80:81], s[80:81], s[52:53]
    s_not_b64 vcc, s[52:53]
    s_mov_b64 exec, -1
    v_cndmask_b32_dpp v84, v84, v84, vcc wave_shr:1 row_mask:0xf bank_mask:0xf
    v_cndmask_b32_dpp v85, v85, v85, vcc wave_shr:1 row_mask:0xf bank_mask:0xf
    s_lshr_b64 s[52:53], s[52:53], 1
    v_cndmask_b32_dpp v86, v86, v86, vcc wave_shr:1 row_mask:0xf bank_mask:0xf
    v_cndmask_b32_dpp v87, v87, v87, vcc wave_shr:1 row_mask:0xf bank_mask:0xf
    s_andn2_b64 s[82:83], s[82:83], s[52:53]
    v_cndmask_b32_dpp v7, v7, v7, vcc wave_shr:1 row_mask:0xf bank_mask:0xf
    s_mov_b64 exec, s[54:55]
    s_cbranch_scc0 L2_d87
    s_mov_b64 exec, s[82:83]
    s_nop 1
    v_mfma_f32_4x4x4_16b_bf16 v[88:91], v[12:13], v[84:85], 0
    s_nop 1
    v_mfma_f32_4x4x4_16b_bf16 v[88:91], v[10:11], v[86:87], v[88:91]
    s_nop 4
    v_cvt_pk_bf16_f32 v88, v88, v89
    v_cvt_pk_bf16_f32 v89, v90, v91
    ds_pk_add_bf16 v7, v88 offset:65408
    ds_pk_add_bf16 v7, v89 offset:65412
    s_mov_b64 exec, s[54:55]
    s_branch L2_d87
L2_c88:
    s_lshl_b64 s[52:53], s[82:83], 1
    s_andn2_b64 s[52:53], s[52:53], s[80:81]
    s_andn2_b64 s[52:53], s[52:53], s[50:51]
    s_or_b64 s[80:81], s[80:81], s[52:53]
    s_not_b64 vcc, s[52:53]
    s_mov_b64 exec, -1
    v_cndmask_b32_dpp v84, v84, v84, vcc wave_shr:1 row_mask:0xf bank_mask:0xf
    v_cndmask_b32_dpp v85, v85, v85, vcc wave_shr:1 row_mask:0xf bank_mask:0xf
    s_lshr_b64 s[52:53], s[52:53], 1
    v_cndmask_b32_dpp v86, v86, v86, vcc wave_shr:1 row_mask:0xf bank_mask:0xf
    v_cndmask_b32_dpp v87, v87, v87, vcc wave_shr:1 row_mask:0xf bank_mask:0xf
    s_andn2_b64 s[82:83], s[82:83], s[52:53]
    v_cndmask_b32_dpp v7, v7, v7, vcc wave_shr:1 row_mask:0xf bank_mask:0xf
    s_mov_b64 exec, s[50:51]
    s_cbranch_scc0 L2_d88
    s_mov_b64 exec, s[82:83]
    s_nop 1
    v_mfma_f32_4x4x4_16b_bf16 v[88:91], v[12:13], v[84:85], 0
    s_nop 1
    v_mfma_f32_4x4x4_16b_bf16 v[88:91], v[10:11], v[86:87], v[88:91]
    s_nop 4
    v_cvt_pk_bf16_f32 v88, v88, v89
    v_cvt_pk_bf16_f32 v89, v90, v91
    ds_pk_add_bf16 v7, v88 offset:65408
    ds_pk_add_bf16 v7, v89 offset:65412
    s_mov_b64 exec, s[50:51]
    s_branch L2_d88
L2_oa89:
    s_waitcnt vmcnt(3)
    s_mov_b64 exec, s[6:7]
    v_lshrrev_b32 v114, 16, v114
    s_mov_b64 exec, -1
    v_and_b32 v46, 0x10000000, v32
    v_cmpx_eq_u32 vcc, 0, v46
    v_lshrrev_b32 v47, 14, v112
    v_and_b32 v47, v5, v47
    ds_read_b64 v[96:97], v47
    v_perm_b32 v98, v112, v114, s44
    v_bitop3_b32 v99, v112, 0.5, -0.5 bitop3:0xa8
    v_bitop3_b32 v98, v6, v98, v99 bitop3:0xca
    v_and_b32 v47, v5, v112
    s_waitcnt lgkmcnt(0)
    v_mfma_f32_4x4x4_16b_bf16 v[88:91], v[8:9], v[96:97], 0
    s_nop 4
    v_mul_f32 v88, v98, v88
    v_mul_f32 v89, v98, v89
    v_mul_f32 v90, v98, v90
    v_mul_f32 v91, v98, v91
    v_cvt_pk_bf16_f32 v88, v88, v89
    v_cvt_pk_bf16_f32 v89, v90, v91
    ds_pk_add_bf16 v47, v88 offset:65408
    ds_pk_add_bf16 v47, v89 offset:65412
    s_mov_b64 exec, -1
    v_and_b32 v46, 0x20000000, v32
    v_cmpx_eq_u32 vcc, 0, v46
    v_lshrrev_b32 v47, 14, v113
    v_and_b32 v47, v5, v47
    ds_read_b64 v[96:97], v47
    v_perm_b32 v98, v113, v114, s45
    v_bitop3_b32 v99, v113, 0.5, -0.5 bitop3:0xa8
    v_bitop3_b32 v98, v6, v98, v99 bitop3:0xca
    v_and_b32 v47, v5, v113
    s_waitcnt lgkmcnt(0)
    v_mfma_f32_4x4x4_16b_bf16 v[88:91], v[8:9], v[96:97], 0
    s_nop 4
    v_mul_f32 v88, v98, v88
    v_mul_f32 v89, v98, v89
    v_mul_f32 v90, v98, v90
    v_mul_f32 v91, v98, v91
    v_cvt_pk_bf16_f32 v88, v88, v89
    v_cvt_pk_bf16_f32 v89, v90, v91
    ds_pk_add_bf16 v47, v88 offset:65408
    ds_pk_add_bf16 v47, v89 offset:65412
    s_mov_b64 exec, -1
    s_branch L2_ob89
L2_xo90:
    v_cmp_lt_u32 vcc, 20, v99
    s_mov_b32 s101, 1
    s_cbranch_vccz L2_xp90
    v_cmp_lt_u32 vcc, 32, v99
    v_cmp_lt_u32 s[58:59], 31, v88
    s_mov_b32 s101, 2
    s_or_b64 vcc, vcc, s[58:59]
    s_cbranch_scc0 L2_xp90
    s_mov_b32 s37, 0x10000
    s_branch L2_xp90
L2_c91:
    s_lshl_b64 s[52:53], s[82:83], 1
    s_andn2_b64 s[52:53], s[52:53], s[80:81]
    s_andn2_b64 s[52:53], s[52:53], s[54:55]
    s_or_b64 s[80:81], s[80:81], s[52:53]
    s_not_b64 vcc, s[52:53]
    s_mov_b64 exec, -1
    v_cndmask_b32_dpp v84, v84, v84, vcc wave_shr:1 row_mask:0xf bank_mask:0xf
    v_cndmask_b32_dpp v85, v85, v85, vcc wave_shr:1 row_mask:0xf bank_mask:0xf
    s_lshr_b64 s[52:53], s[52:53], 1
    v_cndmask_b32_dpp v86, v86, v86, vcc wave_shr:1 row_mask:0xf bank_mask:0xf
    v_cndmask_b32_dpp v87, v87, v87, vcc wave_shr:1 row_mask:0xf bank_mask:0xf
    s_andn2_b64 s[82:83], s[82:83], s[52:53]
    v_cndmask_b32_dpp v7, v7, v7, vcc wave_shr:1 row_mask:0xf bank_mask:0xf
    s_mov_b64 exec, s[54:55]
    s_cbranch_scc0 L2_d91
    s_mov_b64 exec, s[82:83]
    s_nop 1
    v_mfma_f32_4x4x4_16b_bf16 v[88:91], v[12:13], v[84:85], 0
    s_nop 1
    v_mfma_f32_4x4x4_16b_bf16 v[88:91], v[10:11], v[86:87], v[88:91]
    s_nop 4
    v_cvt_pk_bf16_f32 v88, v88, v89
    v_cvt_pk_bf16_f32 v89, v90, v91
    ds_pk_add_bf16 v7, v88 offset:65408
    ds_pk_add_bf16 v7, v89 offset:65412
    s_mov_b64 exec, s[54:55]
    s_branch L2_d91
L2_c92:
    s_lshl_b64 s[52:53], s[82:83], 1
    s_andn2_b64 s[52:53], s[52:53], s[80:81]
    s_andn2_b64 s[52:53], s[52:53], s[50:51]
    s_or_b64 s[80:81], s[80:81], s[52:53]
    s_not_b64 vcc, s[52:53]
    s_mov_b64 exec, -1
    v_cndmask_b32_dpp v84, v84, v84, vcc wave_shr:1 row_mask:0xf bank_mask:0xf
    v_cndmask_b32_dpp v85, v85, v85, vcc wave_shr:1 row_mask:0xf bank_mask:0xf
    s_lshr_b64 s[52:53], s[52:53], 1
    v_cndmask_b32_dpp v86, v86, v86, vcc wave_shr:1 row_mask:0xf bank_mask:0xf
    v_cndmask_b32_dpp v87, v87, v87, vcc wave_shr:1 row_mask:0xf bank_mask:0xf
    s_andn2_b64 s[82:83], s[82:83], s[52:53]
    v_cndmask_b32_dpp v7, v7, v7, vcc wave_shr:1 row_mask:0xf bank_mask:0xf
    s_mov_b64 exec, s[50:51]
    s_cbranch_scc0 L2_d92
    s_mov_b64 exec, s[82:83]
    s_nop 1
    v_mfma_f32_4x4x4_16b_bf16 v[88:91], v[12:13], v[84:85], 0
    s_nop 1
    v_mfma_f32_4x4x4_16b_bf16 v[88:91], v[10:11], v[86:87], v[88:91]
    s_nop 4
    v_cvt_pk_bf16_f32 v88, v88, v89
    v_cvt_pk_bf16_f32 v89, v90, v91
    ds_pk_add_bf16 v7, v88 offset:65408
    ds_pk_add_bf16 v7, v89 offset:65412
    s_mov_b64 exec, s[50:51]
    s_branch L2_d92
L2_c93:
    s_lshl_b64 s[52:53], s[82:83], 1
    s_andn2_b64 s[52:53], s[52:53], s[80:81]
    s_andn2_b64 s[52:53], s[52:53], s[54:55]
    s_or_b64 s[80:81], s[80:81], s[52:53]
    s_not_b64 vcc, s[52:53]
    s_mov_b64 exec, -1
    v_cndmask_b32_dpp v84, v84, v84, vcc wave_shr:1 row_mask:0xf bank_mask:0xf
    v_cndmask_b32_dpp v85, v85, v85, vcc wave_shr:1 row_mask:0xf bank_mask:0xf
    s_lshr_b64 s[52:53], s[52:53], 1
    v_cndmask_b32_dpp v86, v86, v86, vcc wave_shr:1 row_mask:0xf bank_mask:0xf
    v_cndmask_b32_dpp v87, v87, v87, vcc wave_shr:1 row_mask:0xf bank_mask:0xf
    s_andn2_b64 s[82:83], s[82:83], s[52:53]
    v_cndmask_b32_dpp v7, v7, v7, vcc wave_shr:1 row_mask:0xf bank_mask:0xf
    s_mov_b64 exec, s[54:55]
    s_cbranch_scc0 L2_d93
    s_mov_b64 exec, s[82:83]
    s_nop 1
    v_mfma_f32_4x4x4_16b_bf16 v[88:91], v[12:13], v[84:85], 0
    s_nop 1
    v_mfma_f32_4x4x4_16b_bf16 v[88:91], v[10:11], v[86:87], v[88:91]
    s_nop 4
    v_cvt_pk_bf16_f32 v88, v88, v89
    v_cvt_pk_bf16_f32 v89, v90, v91
    ds_pk_add_bf16 v7, v88 offset:65408
    ds_pk_add_bf16 v7, v89 offset:65412
    s_mov_b64 exec, s[54:55]
    s_branch L2_d93
L2_c94:
    s_lshl_b64 s[52:53], s[82:83], 1
    s_andn2_b64 s[52:53], s[52:53], s[80:81]
    s_andn2_b64 s[52:53], s[52:53], s[50:51]
    s_or_b64 s[80:81], s[80:81], s[52:53]
    s_not_b64 vcc, s[52:53]
    s_mov_b64 exec, -1
    v_cndmask_b32_dpp v84, v84, v84, vcc wave_shr:1 row_mask:0xf bank_mask:0xf
    v_cndmask_b32_dpp v85, v85, v85, vcc wave_shr:1 row_mask:0xf bank_mask:0xf
    s_lshr_b64 s[52:53], s[52:53], 1
    v_cndmask_b32_dpp v86, v86, v86, vcc wave_shr:1 row_mask:0xf bank_mask:0xf
    v_cndmask_b32_dpp v87, v87, v87, vcc wave_shr:1 row_mask:0xf bank_mask:0xf
    s_andn2_b64 s[82:83], s[82:83], s[52:53]
    v_cndmask_b32_dpp v7, v7, v7, vcc wave_shr:1 row_mask:0xf bank_mask:0xf
    s_mov_b64 exec, s[50:51]
    s_cbranch_scc0 L2_d94
    s_mov_b64 exec, s[82:83]
    s_nop 1
    v_mfma_f32_4x4x4_16b_bf16 v[88:91], v[12:13], v[84:85], 0
    s_nop 1
    v_mfma_f32_4x4x4_16b_bf16 v[88:91], v[10:11], v[86:87], v[88:91]
    s_nop 4
    v_cvt_pk_bf16_f32 v88, v88, v89
    v_cvt_pk_bf16_f32 v89, v90, v91
    ds_pk_add_bf16 v7, v88 offset:65408
    ds_pk_add_bf16 v7, v89 offset:65412
    s_mov_b64 exec, s[50:51]
    s_branch L2_d94
L2_c95:
    s_lshl_b64 s[52:53], s[82:83], 1
    s_andn2_b64 s[52:53], s[52:53], s[80:81]
    s_andn2_b64 s[52:53], s[52:53], s[54:55]
    s_or_b64 s[80:81], s[80:81], s[52:53]
    s_not_b64 vcc, s[52:53]
    s_mov_b64 exec, -1
    v_cndmask_b32_dpp v84, v84, v84, vcc wave_shr:1 row_mask:0xf bank_mask:0xf
    v_cndmask_b32_dpp v85, v85, v85, vcc wave_shr:1 row_mask:0xf bank_mask:0xf
    s_lshr_b64 s[52:53], s[52:53], 1
    v_cndmask_b32_dpp v86, v86, v86, vcc wave_shr:1 row_mask:0xf bank_mask:0xf
    v_cndmask_b32_dpp v87, v87, v87, vcc wave_shr:1 row_mask:0xf bank_mask:0xf
    s_andn2_b64 s[82:83], s[82:83], s[52:53]
    v_cndmask_b32_dpp v7, v7, v7, vcc wave_shr:1 row_mask:0xf bank_mask:0xf
    s_mov_b64 exec, s[54:55]
    s_cbranch_scc0 L2_d95
    s_mov_b64 exec, s[82:83]
    s_nop 1
    v_mfma_f32_4x4x4_16b_bf16 v[88:91], v[12:13], v[84:85], 0
    s_nop 1
    v_mfma_f32_4x4x4_16b_bf16 v[88:91], v[10:11], v[86:87], v[88:91]
    s_nop 4
    v_cvt_pk_bf16_f32 v88, v88, v89
    v_cvt_pk_bf16_f32 v89, v90, v91
    ds_pk_add_bf16 v7, v88 offset:65408
    ds_pk_add_bf16 v7, v89 offset:65412
    s_mov_b64 exec, s[54:55]
    s_branch L2_d95
L2_c96:
    s_lshl_b64 s[52:53], s[82:83], 1
    s_andn2_b64 s[52:53], s[52:53], s[80:81]
    s_andn2_b64 s[52:53], s[52:53], s[50:51]
    s_or_b64 s[80:81], s[80:81], s[52:53]
    s_not_b64 vcc, s[52:53]
    s_mov_b64 exec, -1
    v_cndmask_b32_dpp v84, v84, v84, vcc wave_shr:1 row_mask:0xf bank_mask:0xf
    v_cndmask_b32_dpp v85, v85, v85, vcc wave_shr:1 row_mask:0xf bank_mask:0xf
    s_lshr_b64 s[52:53], s[52:53], 1
    v_cndmask_b32_dpp v86, v86, v86, vcc wave_shr:1 row_mask:0xf bank_mask:0xf
    v_cndmask_b32_dpp v87, v87, v87, vcc wave_shr:1 row_mask:0xf bank_mask:0xf
    s_andn2_b64 s[82:83], s[82:83], s[52:53]
    v_cndmask_b32_dpp v7, v7, v7, vcc wave_shr:1 row_mask:0xf bank_mask:0xf
    s_mov_b64 exec, s[50:51]
    s_cbranch_scc0 L2_d96
    s_mov_b64 exec, s[82:83]
    s_nop 1
    v_mfma_f32_4x4x4_16b_bf16 v[88:91], v[12:13], v[84:85], 0
    s_nop 1
    v_mfma_f32_4x4x4_16b_bf16 v[88:91], v[10:11], v[86:87], v[88:91]
    s_nop 4
    v_cvt_pk_bf16_f32 v88, v88, v89
    v_cvt_pk_bf16_f32 v89, v90, v91
    ds_pk_add_bf16 v7, v88 offset:65408
    ds_pk_add_bf16 v7, v89 offset:65412
    s_mov_b64 exec, s[50:51]
    s_branch L2_d96
L2_xa97:
    s_cmp_eq_u32 s101, 1
    s_cbranch_scc1 L2_xc97
    v_lshlrev_b32 v89, 0, v96
    v_add_u32 v90, 140, v97
    v_bitop3_b32 v90, v89, v45, v90 bitop3:0x6a
    ds_write_b32 v98, v90 offset:28
    v_lshlrev_b32 v89, 4, v96
    v_add_u32 v90, 120, v97
    v_bitop3_b32 v90, v89, v45, v90 bitop3:0x6a
    ds_write_b32 v98, v90 offset:24
    v_lshlrev_b32 v89, 8, v96
    v_add_u32 v90, 100, v97
    v_bitop3_b32 v90, v89, v45, v90 bitop3:0x6a
    ds_write_b32 v98, v90 offset:20
L2_xc97:
    v_lshlrev_b32 v89, 12, v96
    v_add_u32 v90, 80, v97
    v_bitop3_b32 v90, v89, v45, v90 bitop3:0x6a
    ds_write_b32 v98, v90 offset:16
    s_branch L2_xb97
L2_xe97:
    v_cmp_lt_u32 vcc, 32, v99
    v_cmp_lt_u32 s[58:59], 31, v88
    v_lshrrev_b32 v89, 16, v96
    v_add_u32 v97, 80, v97
    s_or_b64 vcc, vcc, s[58:59]
    s_cbranch_scc1 L2_xs97
    v_lshlrev_b32 v89, v1, v89
    v_and_b32 v89, v45, v89
    v_cmp_ne_u32 vcc, 0, v89
    v_xor_b32 v90, v97, v89
    s_add_u32 s3, s37, s38
    v_mbcnt_lo_u32_b32 v98, vcc_lo, 0
    v_mbcnt_hi_u32_b32 v98, vcc_hi, v98
    s_bcnt1_i32_b64 s41, vcc
    v_lshl_add_u32 v98, v98, 2, s3
    s_lshl2_add_u32 s37, s41, s37
    s_mov_b64 exec, vcc
    ds_write_b32 v98, v90
    s_mov_b64 exec, -1
    s_branch L2_xr97
L2_xs97:
    s_waitcnt lgkmcnt(0)
    s_mov_b32 s37, 0x10000
    s_branch L2_xw97
L2_c98:
    s_lshl_b64 s[52:53], s[82:83], 1
    s_andn2_b64 s[52:53], s[52:53], s[80:81]
    s_andn2_b64 s[52:53], s[52:53], s[54:55]
    s_or_b64 s[80:81], s[80:81], s[52:53]
    s_not_b64 vcc, s[52:53]
    s_mov_b64 exec, -1
    v_cndmask_b32_dpp v84, v84, v84, vcc wave_shr:1 row_mask:0xf bank_mask:0xf
    v_cndmask_b32_dpp v85, v85, v85, vcc wave_shr:1 row_mask:0xf bank_mask:0xf
    s_lshr_b64 s[52:53], s[52:53], 1
    v_cndmask_b32_dpp v86, v86, v86, vcc wave_shr:1 row_mask:0xf bank_mask:0xf
    v_cndmask_b32_dpp v87, v87, v87, vcc wave_shr:1 row_mask:0xf bank_mask:0xf
    s_andn2_b64 s[82:83], s[82:83], s[52:53]
    v_cndmask_b32_dpp v7, v7, v7, vcc wave_shr:1 row_mask:0xf bank_mask:0xf
    s_mov_b64 exec, s[54:55]
    s_cbranch_scc0 L2_d98
    s_mov_b64 exec, s[82:83]
    s_nop 1
    v_mfma_f32_4x4x4_16b_bf16 v[88:91], v[12:13], v[84:85], 0
    s_nop 1
    v_mfma_f32_4x4x4_16b_bf16 v[88:91], v[10:11], v[86:87], v[88:91]
    s_nop 4
    v_cvt_pk_bf16_f32 v88, v88, v89
    v_cvt_pk_bf16_f32 v89, v90, v91
    ds_pk_add_bf16 v7, v88 offset:65408
    ds_pk_add_bf16 v7, v89 offset:65412
    s_mov_b64 exec, s[54:55]
    s_branch L2_d98
L2_c99:
    s_lshl_b64 s[52:53], s[82:83], 1
    s_andn2_b64 s[52:53], s[52:53], s[80:81]
    s_andn2_b64 s[52:53], s[52:53], s[50:51]
    s_or_b64 s[80:81], s[80:81], s[52:53]
    s_not_b64 vcc, s[52:53]
    s_mov_b64 exec, -1
    v_cndmask_b32_dpp v84, v84, v84, vcc wave_shr:1 row_mask:0xf bank_mask:0xf
    v_cndmask_b32_dpp v85, v85, v85, vcc wave_shr:1 row_mask:0xf bank_mask:0xf
    s_lshr_b64 s[52:53], s[52:53], 1
    v_cndmask_b32_dpp v86, v86, v86, vcc wave_shr:1 row_mask:0xf bank_mask:0xf
    v_cndmask_b32_dpp v87, v87, v87, vcc wave_shr:1 row_mask:0xf bank_mask:0xf
    s_andn2_b64 s[82:83], s[82:83], s[52:53]
    v_cndmask_b32_dpp v7, v7, v7, vcc wave_shr:1 row_mask:0xf bank_mask:0xf
    s_mov_b64 exec, s[50:51]
    s_cbranch_scc0 L2_d99
    s_mov_b64 exec, s[82:83]
    s_nop 1
    v_mfma_f32_4x4x4_16b_bf16 v[88:91], v[12:13], v[84:85], 0
    s_nop 1
    v_mfma_f32_4x4x4_16b_bf16 v[88:91], v[10:11], v[86:87], v[88:91]
    s_nop 4
    v_cvt_pk_bf16_f32 v88, v88, v89
    v_cvt_pk_bf16_f32 v89, v90, v91
    ds_pk_add_bf16 v7, v88 offset:65408
    ds_pk_add_bf16 v7, v89 offset:65412
    s_mov_b64 exec, s[50:51]
    s_branch L2_d99
L2_xf97:
    s_cmp_gt_u32 s37, 1024
    s_cbranch_scc1 L2_xt97
    s_cmp_lt_u32 s37, 768
    s_cbranch_scc1 L2_xl97
    ds_read_b32 v32, v44 offset:896
    s_add_u32 s3, s42, 2
    s_bitset1_b32 s43, s3
    s_branch L2_xg97
L2_xl97:
    s_waitcnt lgkmcnt(0)
    v_mov_b32 v31, -1
    s_cmp_ge_u32 s37, 512
    s_cbranch_scc1 L2_xg97
    v_mov_b32 v39, -1
    s_cmp_ge_u32 s37, 256
    s_cbranch_scc1 L2_xg97
    v_mov_b32 v27, -1
    s_branch L2_xg97
L2_xt97:
    s_waitcnt lgkmcnt(0)
    v_mov_b32 v21, -1
    v_mov_b32 v27, -1
    v_mov_b32 v39, -1
    v_mov_b32 v31, -1
    s_add_u32 s3, s42, 2
    s_bitset1_b32 s36, s3
    s_branch L2_xg97
L2_oa100:
    v_and_b32 v47, 0x0fffffff, v33
    buffer_load_dword v114, v47, s[8:11], 0 offen offset:16
    s_mov_b64 exec, s[6:7]
    v_add_u32 v47, 8, v47
    v_lshrrev_b32 v33, 2, v33
    s_mov_b64 exec, -1
    buffer_load_dwordx2 v[112:113], v47, s[8:11], 0 offen
    s_branch L2_ob100
L2_c101:
    s_lshl_b64 s[52:53], s[82:83], 1
    s_andn2_b64 s[52:53], s[52:53], s[80:81]
    s_andn2_b64 s[52:53], s[52:53], s[54:55]
    s_or_b64 s[80:81], s[80:81], s[52:53]
    s_not_b64 vcc, s[52:53]
    s_mov_b64 exec, -1
    v_cndmask_b32_dpp v84, v84, v84, vcc wave_shr:1 row_mask:0xf bank_mask:0xf
    v_cndmask_b32_dpp v85, v85, v85, vcc wave_shr:1 row_mask:0xf bank_mask:0xf
    s_lshr_b64 s[52:53], s[52:53], 1
    v_cndmask_b32_dpp v86, v86, v86, vcc wave_shr:1 row_mask:0xf bank_mask:0xf
    v_cndmask_b32_dpp v87, v87, v87, vcc wave_shr:1 row_mask:0xf bank_mask:0xf
    s_andn2_b64 s[82:83], s[82:83], s[52:53]
    v_cndmask_b32_dpp v7, v7, v7, vcc wave_shr:1 row_mask:0xf bank_mask:0xf
    s_mov_b64 exec, s[54:55]
    s_cbranch_scc0 L2_d101
    s_mov_b64 exec, s[82:83]
    s_nop 1
    v_mfma_f32_4x4x4_16b_bf16 v[88:91], v[12:13], v[84:85], 0
    s_nop 1
    v_mfma_f32_4x4x4_16b_bf16 v[88:91], v[10:11], v[86:87], v[88:91]
    s_nop 4
    v_cvt_pk_bf16_f32 v88, v88, v89
    v_cvt_pk_bf16_f32 v89, v90, v91
    ds_pk_add_bf16 v7, v88 offset:65408
    ds_pk_add_bf16 v7, v89 offset:65412
    s_mov_b64 exec, s[54:55]
    s_branch L2_d101
L2_c102:
    s_lshl_b64 s[52:53], s[82:83], 1
    s_andn2_b64 s[52:53], s[52:53], s[80:81]
    s_andn2_b64 s[52:53], s[52:53], s[50:51]
    s_or_b64 s[80:81], s[80:81], s[52:53]
    s_not_b64 vcc, s[52:53]
    s_mov_b64 exec, -1
    v_cndmask_b32_dpp v84, v84, v84, vcc wave_shr:1 row_mask:0xf bank_mask:0xf
    v_cndmask_b32_dpp v85, v85, v85, vcc wave_shr:1 row_mask:0xf bank_mask:0xf
    s_lshr_b64 s[52:53], s[52:53], 1
    v_cndmask_b32_dpp v86, v86, v86, vcc wave_shr:1 row_mask:0xf bank_mask:0xf
    v_cndmask_b32_dpp v87, v87, v87, vcc wave_shr:1 row_mask:0xf bank_mask:0xf
    s_andn2_b64 s[82:83], s[82:83], s[52:53]
    v_cndmask_b32_dpp v7, v7, v7, vcc wave_shr:1 row_mask:0xf bank_mask:0xf
    s_mov_b64 exec, s[50:51]
    s_cbranch_scc0 L2_d102
    s_mov_b64 exec, s[82:83]
    s_nop 1
    v_mfma_f32_4x4x4_16b_bf16 v[88:91], v[12:13], v[84:85], 0
    s_nop 1
    v_mfma_f32_4x4x4_16b_bf16 v[88:91], v[10:11], v[86:87], v[88:91]
    s_nop 4
    v_cvt_pk_bf16_f32 v88, v88, v89
    v_cvt_pk_bf16_f32 v89, v90, v91
    ds_pk_add_bf16 v7, v88 offset:65408
    ds_pk_add_bf16 v7, v89 offset:65412
    s_mov_b64 exec, s[50:51]
    s_branch L2_d102
L2_c103:
    s_lshl_b64 s[52:53], s[82:83], 1
    s_andn2_b64 s[52:53], s[52:53], s[80:81]
    s_andn2_b64 s[52:53], s[52:53], s[54:55]
    s_or_b64 s[80:81], s[80:81], s[52:53]
    s_not_b64 vcc, s[52:53]
    s_mov_b64 exec, -1
    v_cndmask_b32_dpp v84, v84, v84, vcc wave_shr:1 row_mask:0xf bank_mask:0xf
    v_cndmask_b32_dpp v85, v85, v85, vcc wave_shr:1 row_mask:0xf bank_mask:0xf
    s_lshr_b64 s[52:53], s[52:53], 1
    v_cndmask_b32_dpp v86, v86, v86, vcc wave_shr:1 row_mask:0xf bank_mask:0xf
    v_cndmask_b32_dpp v87, v87, v87, vcc wave_shr:1 row_mask:0xf bank_mask:0xf
    s_andn2_b64 s[82:83], s[82:83], s[52:53]
    v_cndmask_b32_dpp v7, v7, v7, vcc wave_shr:1 row_mask:0xf bank_mask:0xf
    s_mov_b64 exec, s[54:55]
    s_cbranch_scc0 L2_d103
    s_mov_b64 exec, s[82:83]
    s_nop 1
    v_mfma_f32_4x4x4_16b_bf16 v[88:91], v[12:13], v[84:85], 0
    s_nop 1
    v_mfma_f32_4x4x4_16b_bf16 v[88:91], v[10:11], v[86:87], v[88:91]
    s_nop 4
    v_cvt_pk_bf16_f32 v88, v88, v89
    v_cvt_pk_bf16_f32 v89, v90, v91
    ds_pk_add_bf16 v7, v88 offset:65408
    ds_pk_add_bf16 v7, v89 offset:65412
    s_mov_b64 exec, s[54:55]
    s_branch L2_d103
L2_c104:
    s_lshl_b64 s[52:53], s[82:83], 1
    s_andn2_b64 s[52:53], s[52:53], s[80:81]
    s_andn2_b64 s[52:53], s[52:53], s[50:51]
    s_or_b64 s[80:81], s[80:81], s[52:53]
    s_not_b64 vcc, s[52:53]
    s_mov_b64 exec, -1
    v_cndmask_b32_dpp v84, v84, v84, vcc wave_shr:1 row_mask:0xf bank_mask:0xf
    v_cndmask_b32_dpp v85, v85, v85, vcc wave_shr:1 row_mask:0xf bank_mask:0xf
    s_lshr_b64 s[52:53], s[52:53], 1
    v_cndmask_b32_dpp v86, v86, v86, vcc wave_shr:1 row_mask:0xf bank_mask:0xf
    v_cndmask_b32_dpp v87, v87, v87, vcc wave_shr:1 row_mask:0xf bank_mask:0xf
    s_andn2_b64 s[82:83], s[82:83], s[52:53]
    v_cndmask_b32_dpp v7, v7, v7, vcc wave_shr:1 row_mask:0xf bank_mask:0xf
    s_mov_b64 exec, s[50:51]
    s_cbranch_scc0 L2_d104
    s_mov_b64 exec, s[82:83]
    s_nop 1
    v_mfma_f32_4x4x4_16b_bf16 v[88:91], v[12:13], v[84:85], 0
    s_nop 1
    v_mfma_f32_4x4x4_16b_bf16 v[88:91], v[10:11], v[86:87], v[88:91]
    s_nop 4
    v_cvt_pk_bf16_f32 v88, v88, v89
    v_cvt_pk_bf16_f32 v89, v90, v91
    ds_pk_add_bf16 v7, v88 offset:65408
    ds_pk_add_bf16 v7, v89 offset:65412
    s_mov_b64 exec, s[50:51]
    s_branch L2_d104
L2_c105:
    s_lshl_b64 s[52:53], s[82:83], 1
    s_andn2_b64 s[52:53], s[52:53], s[80:81]
    s_andn2_b64 s[52:53], s[52:53], s[54:55]
    s_or_b64 s[80:81], s[80:81], s[52:53]
    s_not_b64 vcc, s[52:53]
    s_mov_b64 exec, -1
    v_cndmask_b32_dpp v84, v84, v84, vcc wave_shr:1 row_mask:0xf bank_mask:0xf
    v_cndmask_b32_dpp v85, v85, v85, vcc wave_shr:1 row_mask:0xf bank_mask:0xf
    s_lshr_b64 s[52:53], s[52:53], 1
    v_cndmask_b32_dpp v86, v86, v86, vcc wave_shr:1 row_mask:0xf bank_mask:0xf
    v_cndmask_b32_dpp v87, v87, v87, vcc wave_shr:1 row_mask:0xf bank_mask:0xf
    s_andn2_b64 s[82:83], s[82:83], s[52:53]
    v_cndmask_b32_dpp v7, v7, v7, vcc wave_shr:1 row_mask:0xf bank_mask:0xf
    s_mov_b64 exec, s[54:55]
    s_cbranch_scc0 L2_d105
    s_mov_b64 exec, s[82:83]
    s_nop 1
    v_mfma_f32_4x4x4_16b_bf16 v[88:91], v[12:13], v[84:85], 0
    s_nop 1
    v_mfma_f32_4x4x4_16b_bf16 v[88:91], v[10:11], v[86:87], v[88:91]
    s_nop 4
    v_cvt_pk_bf16_f32 v88, v88, v89
    v_cvt_pk_bf16_f32 v89, v90, v91
    ds_pk_add_bf16 v7, v88 offset:65408
    ds_pk_add_bf16 v7, v89 offset:65412
    s_mov_b64 exec, s[54:55]
    s_branch L2_d105
L2_c106:
    s_lshl_b64 s[52:53], s[82:83], 1
    s_andn2_b64 s[52:53], s[52:53], s[80:81]
    s_andn2_b64 s[52:53], s[52:53], s[50:51]
    s_or_b64 s[80:81], s[80:81], s[52:53]
    s_not_b64 vcc, s[52:53]
    s_mov_b64 exec, -1
    v_cndmask_b32_dpp v84, v84, v84, vcc wave_shr:1 row_mask:0xf bank_mask:0xf
    v_cndmask_b32_dpp v85, v85, v85, vcc wave_shr:1 row_mask:0xf bank_mask:0xf
    s_lshr_b64 s[52:53], s[52:53], 1
    v_cndmask_b32_dpp v86, v86, v86, vcc wave_shr:1 row_mask:0xf bank_mask:0xf
    v_cndmask_b32_dpp v87, v87, v87, vcc wave_shr:1 row_mask:0xf bank_mask:0xf
    s_andn2_b64 s[82:83], s[82:83], s[52:53]
    v_cndmask_b32_dpp v7, v7, v7, vcc wave_shr:1 row_mask:0xf bank_mask:0xf
    s_mov_b64 exec, s[50:51]
    s_cbranch_scc0 L2_d106
    s_mov_b64 exec, s[82:83]
    s_nop 1
    v_mfma_f32_4x4x4_16b_bf16 v[88:91], v[12:13], v[84:85], 0
    s_nop 1
    v_mfma_f32_4x4x4_16b_bf16 v[88:91], v[10:11], v[86:87], v[88:91]
    s_nop 4
    v_cvt_pk_bf16_f32 v88, v88, v89
    v_cvt_pk_bf16_f32 v89, v90, v91
    ds_pk_add_bf16 v7, v88 offset:65408
    ds_pk_add_bf16 v7, v89 offset:65412
    s_mov_b64 exec, s[50:51]
    s_branch L2_d106
L2_oa107:
    s_waitcnt vmcnt(3)
    s_mov_b64 exec, s[6:7]
    v_lshrrev_b32 v114, 16, v114
    s_mov_b64 exec, -1
    v_and_b32 v46, 0x10000000, v33
    v_cmpx_eq_u32 vcc, 0, v46
    v_lshrrev_b32 v47, 14, v112
    v_and_b32 v47, v5, v47
    ds_read_b64 v[96:97], v47
    v_perm_b32 v98, v112, v114, s44
    v_bitop3_b32 v99, v112, 0.5, -0.5 bitop3:0xa8
    v_bitop3_b32 v98, v6, v98, v99 bitop3:0xca
    v_and_b32 v47, v5, v112
    s_waitcnt lgkmcnt(0)
    v_mfma_f32_4x4x4_16b_bf16 v[88:91], v[8:9], v[96:97], 0
    s_nop 4
    v_mul_f32 v88, v98, v88
    v_mul_f32 v89, v98, v89
    v_mul_f32 v90, v98, v90
    v_mul_f32 v91, v98, v91
    v_cvt_pk_bf16_f32 v88, v88, v89
    v_cvt_pk_bf16_f32 v89, v90, v91
    ds_pk_add_bf16 v47, v88 offset:65408
    ds_pk_add_bf16 v47, v89 offset:65412
    s_mov_b64 exec, -1
    v_and_b32 v46, 0x20000000, v33
    v_cmpx_eq_u32 vcc, 0, v46
    v_lshrrev_b32 v47, 14, v113
    v_and_b32 v47, v5, v47
    ds_read_b64 v[96:97], v47
    v_perm_b32 v98, v113, v114, s45
    v_bitop3_b32 v99, v113, 0.5, -0.5 bitop3:0xa8
    v_bitop3_b32 v98, v6, v98, v99 bitop3:0xca
    v_and_b32 v47, v5, v113
    s_waitcnt lgkmcnt(0)
    v_mfma_f32_4x4x4_16b_bf16 v[88:91], v[8:9], v[96:97], 0
    s_nop 4
    v_mul_f32 v88, v98, v88
    v_mul_f32 v89, v98, v89
    v_mul_f32 v90, v98, v90
    v_mul_f32 v91, v98, v91
    v_cvt_pk_bf16_f32 v88, v88, v89
    v_cvt_pk_bf16_f32 v89, v90, v91
    ds_pk_add_bf16 v47, v88 offset:65408
    ds_pk_add_bf16 v47, v89 offset:65412
    s_mov_b64 exec, -1
    s_branch L2_ob107
L2_xo108:
    v_cmp_lt_u32 vcc, 20, v99
    s_mov_b32 s101, 1
    s_cbranch_vccz L2_xp108
    v_cmp_lt_u32 vcc, 32, v99
    v_cmp_lt_u32 s[58:59], 31, v88
    s_mov_b32 s101, 2
    s_or_b64 vcc, vcc, s[58:59]
    s_cbranch_scc0 L2_xp108
    s_mov_b32 s37, 0x10000
    s_branch L2_xp108
L2_c109:
    s_lshl_b64 s[52:53], s[82:83], 1
    s_andn2_b64 s[52:53], s[52:53], s[80:81]
    s_andn2_b64 s[52:53], s[52:53], s[54:55]
    s_or_b64 s[80:81], s[80:81], s[52:53]
    s_not_b64 vcc, s[52:53]
    s_mov_b64 exec, -1
    v_cndmask_b32_dpp v84, v84, v84, vcc wave_shr:1 row_mask:0xf bank_mask:0xf
    v_cndmask_b32_dpp v85, v85, v85, vcc wave_shr:1 row_mask:0xf bank_mask:0xf
    s_lshr_b64 s[52:53], s[52:53], 1
    v_cndmask_b32_dpp v86, v86, v86, vcc wave_shr:1 row_mask:0xf bank_mask:0xf
    v_cndmask_b32_dpp v87, v87, v87, vcc wave_shr:1 row_mask:0xf bank_mask:0xf
    s_andn2_b64 s[82:83], s[82:83], s[52:53]
    v_cndmask_b32_dpp v7, v7, v7, vcc wave_shr:1 row_mask:0xf bank_mask:0xf
    s_mov_b64 exec, s[54:55]
    s_cbranch_scc0 L2_d109
    s_mov_b64 exec, s[82:83]
    s_nop 1
    v_mfma_f32_4x4x4_16b_bf16 v[88:91], v[12:13], v[84:85], 0
    s_nop 1
    v_mfma_f32_4x4x4_16b_bf16 v[88:91], v[10:11], v[86:87], v[88:91]
    s_nop 4
    v_cvt_pk_bf16_f32 v88, v88, v89
    v_cvt_pk_bf16_f32 v89, v90, v91
    ds_pk_add_bf16 v7, v88 offset:65408
    ds_pk_add_bf16 v7, v89 offset:65412
    s_mov_b64 exec, s[54:55]
    s_branch L2_d109
L2_c110:
    s_lshl_b64 s[52:53], s[82:83], 1
    s_andn2_b64 s[52:53], s[52:53], s[80:81]
    s_andn2_b64 s[52:53], s[52:53], s[50:51]
    s_or_b64 s[80:81], s[80:81], s[52:53]
    s_not_b64 vcc, s[52:53]
    s_mov_b64 exec, -1
    v_cndmask_b32_dpp v84, v84, v84, vcc wave_shr:1 row_mask:0xf bank_mask:0xf
    v_cndmask_b32_dpp v85, v85, v85, vcc wave_shr:1 row_mask:0xf bank_mask:0xf
    s_lshr_b64 s[52:53], s[52:53], 1
    v_cndmask_b32_dpp v86, v86, v86, vcc wave_shr:1 row_mask:0xf bank_mask:0xf
    v_cndmask_b32_dpp v87, v87, v87, vcc wave_shr:1 row_mask:0xf bank_mask:0xf
    s_andn2_b64 s[82:83], s[82:83], s[52:53]
    v_cndmask_b32_dpp v7, v7, v7, vcc wave_shr:1 row_mask:0xf bank_mask:0xf
    s_mov_b64 exec, s[50:51]
    s_cbranch_scc0 L2_d110
    s_mov_b64 exec, s[82:83]
    s_nop 1
    v_mfma_f32_4x4x4_16b_bf16 v[88:91], v[12:13], v[84:85], 0
    s_nop 1
    v_mfma_f32_4x4x4_16b_bf16 v[88:91], v[10:11], v[86:87], v[88:91]
    s_nop 4
    v_cvt_pk_bf16_f32 v88, v88, v89
    v_cvt_pk_bf16_f32 v89, v90, v91
    ds_pk_add_bf16 v7, v88 offset:65408
    ds_pk_add_bf16 v7, v89 offset:65412
    s_mov_b64 exec, s[50:51]
    s_branch L2_d110
L2_c111:
    s_lshl_b64 s[52:53], s[82:83], 1
    s_andn2_b64 s[52:53], s[52:53], s[80:81]
    s_andn2_b64 s[52:53], s[52:53], s[54:55]
    s_or_b64 s[80:81], s[80:81], s[52:53]
    s_not_b64 vcc, s[52:53]
    s_mov_b64 exec, -1
    v_cndmask_b32_dpp v84, v84, v84, vcc wave_shr:1 row_mask:0xf bank_mask:0xf
    v_cndmask_b32_dpp v85, v85, v85, vcc wave_shr:1 row_mask:0xf bank_mask:0xf
    s_lshr_b64 s[52:53], s[52:53], 1
    v_cndmask_b32_dpp v86, v86, v86, vcc wave_shr:1 row_mask:0xf bank_mask:0xf
    v_cndmask_b32_dpp v87, v87, v87, vcc wave_shr:1 row_mask:0xf bank_mask:0xf
    s_andn2_b64 s[82:83], s[82:83], s[52:53]
    v_cndmask_b32_dpp v7, v7, v7, vcc wave_shr:1 row_mask:0xf bank_mask:0xf
    s_mov_b64 exec, s[54:55]
    s_cbranch_scc0 L2_d111
    s_mov_b64 exec, s[82:83]
    s_nop 1
    v_mfma_f32_4x4x4_16b_bf16 v[88:91], v[12:13], v[84:85], 0
    s_nop 1
    v_mfma_f32_4x4x4_16b_bf16 v[88:91], v[10:11], v[86:87], v[88:91]
    s_nop 4
    v_cvt_pk_bf16_f32 v88, v88, v89
    v_cvt_pk_bf16_f32 v89, v90, v91
    ds_pk_add_bf16 v7, v88 offset:65408
    ds_pk_add_bf16 v7, v89 offset:65412
    s_mov_b64 exec, s[54:55]
    s_branch L2_d111
L2_c112:
    s_lshl_b64 s[52:53], s[82:83], 1
    s_andn2_b64 s[52:53], s[52:53], s[80:81]
    s_andn2_b64 s[52:53], s[52:53], s[50:51]
    s_or_b64 s[80:81], s[80:81], s[52:53]
    s_not_b64 vcc, s[52:53]
    s_mov_b64 exec, -1
    v_cndmask_b32_dpp v84, v84, v84, vcc wave_shr:1 row_mask:0xf bank_mask:0xf
    v_cndmask_b32_dpp v85, v85, v85, vcc wave_shr:1 row_mask:0xf bank_mask:0xf
    s_lshr_b64 s[52:53], s[52:53], 1
    v_cndmask_b32_dpp v86, v86, v86, vcc wave_shr:1 row_mask:0xf bank_mask:0xf
    v_cndmask_b32_dpp v87, v87, v87, vcc wave_shr:1 row_mask:0xf bank_mask:0xf
    s_andn2_b64 s[82:83], s[82:83], s[52:53]
    v_cndmask_b32_dpp v7, v7, v7, vcc wave_shr:1 row_mask:0xf bank_mask:0xf
    s_mov_b64 exec, s[50:51]
    s_cbranch_scc0 L2_d112
    s_mov_b64 exec, s[82:83]
    s_nop 1
    v_mfma_f32_4x4x4_16b_bf16 v[88:91], v[12:13], v[84:85], 0
    s_nop 1
    v_mfma_f32_4x4x4_16b_bf16 v[88:91], v[10:11], v[86:87], v[88:91]
    s_nop 4
    v_cvt_pk_bf16_f32 v88, v88, v89
    v_cvt_pk_bf16_f32 v89, v90, v91
    ds_pk_add_bf16 v7, v88 offset:65408
    ds_pk_add_bf16 v7, v89 offset:65412
    s_mov_b64 exec, s[50:51]
    s_branch L2_d112
L2_c113:
    s_lshl_b64 s[52:53], s[82:83], 1
    s_andn2_b64 s[52:53], s[52:53], s[80:81]
    s_andn2_b64 s[52:53], s[52:53], s[54:55]
    s_or_b64 s[80:81], s[80:81], s[52:53]
    s_not_b64 vcc, s[52:53]
    s_mov_b64 exec, -1
    v_cndmask_b32_dpp v84, v84, v84, vcc wave_shr:1 row_mask:0xf bank_mask:0xf
    v_cndmask_b32_dpp v85, v85, v85, vcc wave_shr:1 row_mask:0xf bank_mask:0xf
    s_lshr_b64 s[52:53], s[52:53], 1
    v_cndmask_b32_dpp v86, v86, v86, vcc wave_shr:1 row_mask:0xf bank_mask:0xf
    v_cndmask_b32_dpp v87, v87, v87, vcc wave_shr:1 row_mask:0xf bank_mask:0xf
    s_andn2_b64 s[82:83], s[82:83], s[52:53]
    v_cndmask_b32_dpp v7, v7, v7, vcc wave_shr:1 row_mask:0xf bank_mask:0xf
    s_mov_b64 exec, s[54:55]
    s_cbranch_scc0 L2_d113
    s_mov_b64 exec, s[82:83]
    s_nop 1
    v_mfma_f32_4x4x4_16b_bf16 v[88:91], v[12:13], v[84:85], 0
    s_nop 1
    v_mfma_f32_4x4x4_16b_bf16 v[88:91], v[10:11], v[86:87], v[88:91]
    s_nop 4
    v_cvt_pk_bf16_f32 v88, v88, v89
    v_cvt_pk_bf16_f32 v89, v90, v91
    ds_pk_add_bf16 v7, v88 offset:65408
    ds_pk_add_bf16 v7, v89 offset:65412
    s_mov_b64 exec, s[54:55]
    s_branch L2_d113
L2_c114:
    s_lshl_b64 s[52:53], s[82:83], 1
    s_andn2_b64 s[52:53], s[52:53], s[80:81]
    s_andn2_b64 s[52:53], s[52:53], s[50:51]
    s_or_b64 s[80:81], s[80:81], s[52:53]
    s_not_b64 vcc, s[52:53]
    s_mov_b64 exec, -1
    v_cndmask_b32_dpp v84, v84, v84, vcc wave_shr:1 row_mask:0xf bank_mask:0xf
    v_cndmask_b32_dpp v85, v85, v85, vcc wave_shr:1 row_mask:0xf bank_mask:0xf
    s_lshr_b64 s[52:53], s[52:53], 1
    v_cndmask_b32_dpp v86, v86, v86, vcc wave_shr:1 row_mask:0xf bank_mask:0xf
    v_cndmask_b32_dpp v87, v87, v87, vcc wave_shr:1 row_mask:0xf bank_mask:0xf
    s_andn2_b64 s[82:83], s[82:83], s[52:53]
    v_cndmask_b32_dpp v7, v7, v7, vcc wave_shr:1 row_mask:0xf bank_mask:0xf
    s_mov_b64 exec, s[50:51]
    s_cbranch_scc0 L2_d114
    s_mov_b64 exec, s[82:83]
    s_nop 1
    v_mfma_f32_4x4x4_16b_bf16 v[88:91], v[12:13], v[84:85], 0
    s_nop 1
    v_mfma_f32_4x4x4_16b_bf16 v[88:91], v[10:11], v[86:87], v[88:91]
    s_nop 4
    v_cvt_pk_bf16_f32 v88, v88, v89
    v_cvt_pk_bf16_f32 v89, v90, v91
    ds_pk_add_bf16 v7, v88 offset:65408
    ds_pk_add_bf16 v7, v89 offset:65412
    s_mov_b64 exec, s[50:51]
    s_branch L2_d114
L2_xa115:
    s_cmp_eq_u32 s101, 1
    s_cbranch_scc1 L2_xc115
    v_lshlrev_b32 v89, 0, v96
    v_add_u32 v90, 140, v97
    v_bitop3_b32 v90, v89, v45, v90 bitop3:0x6a
    ds_write_b32 v98, v90 offset:28
    v_lshlrev_b32 v89, 4, v96
    v_add_u32 v90, 120, v97
    v_bitop3_b32 v90, v89, v45, v90 bitop3:0x6a
    ds_write_b32 v98, v90 offset:24
    v_lshlrev_b32 v89, 8, v96
    v_add_u32 v90, 100, v97
    v_bitop3_b32 v90, v89, v45, v90 bitop3:0x6a
    ds_write_b32 v98, v90 offset:20
L2_xc115:
    v_lshlrev_b32 v89, 12, v96
    v_add_u32 v90, 80, v97
    v_bitop3_b32 v90, v89, v45, v90 bitop3:0x6a
    ds_write_b32 v98, v90 offset:16
    s_branch L2_xb115
L2_xe115:
    v_cmp_lt_u32 vcc, 32, v99
    v_cmp_lt_u32 s[58:59], 31, v88
    v_lshrrev_b32 v89, 16, v96
    v_add_u32 v97, 80, v97
    s_or_b64 vcc, vcc, s[58:59]
    s_cbranch_scc1 L2_xs115
    v_lshlrev_b32 v89, v1, v89
    v_and_b32 v89, v45, v89
    v_cmp_ne_u32 vcc, 0, v89
    v_xor_b32 v90, v97, v89
    s_add_u32 s3, s37, s38
    v_mbcnt_lo_u32_b32 v98, vcc_lo, 0
    v_mbcnt_hi_u32_b32 v98, vcc_hi, v98
    s_bcnt1_i32_b64 s41, vcc
    v_lshl_add_u32 v98, v98, 2, s3
    s_lshl2_add_u32 s37, s41, s37
    s_mov_b64 exec, vcc
    ds_write_b32 v98, v90
    s_mov_b64 exec, -1
    s_branch L2_xr115
L2_xs115:
    s_waitcnt lgkmcnt(0)
    s_mov_b32 s37, 0x10000
    s_branch L2_xw115
L2_c116:
    s_lshl_b64 s[52:53], s[82:83], 1
    s_andn2_b64 s[52:53], s[52:53], s[80:81]
    s_andn2_b64 s[52:53], s[52:53], s[54:55]
    s_or_b64 s[80:81], s[80:81], s[52:53]
    s_not_b64 vcc, s[52:53]
    s_mov_b64 exec, -1
    v_cndmask_b32_dpp v84, v84, v84, vcc wave_shr:1 row_mask:0xf bank_mask:0xf
    v_cndmask_b32_dpp v85, v85, v85, vcc wave_shr:1 row_mask:0xf bank_mask:0xf
    s_lshr_b64 s[52:53], s[52:53], 1
    v_cndmask_b32_dpp v86, v86, v86, vcc wave_shr:1 row_mask:0xf bank_mask:0xf
    v_cndmask_b32_dpp v87, v87, v87, vcc wave_shr:1 row_mask:0xf bank_mask:0xf
    s_andn2_b64 s[82:83], s[82:83], s[52:53]
    v_cndmask_b32_dpp v7, v7, v7, vcc wave_shr:1 row_mask:0xf bank_mask:0xf
    s_mov_b64 exec, s[54:55]
    s_cbranch_scc0 L2_d116
    s_mov_b64 exec, s[82:83]
    s_nop 1
    v_mfma_f32_4x4x4_16b_bf16 v[88:91], v[12:13], v[84:85], 0
    s_nop 1
    v_mfma_f32_4x4x4_16b_bf16 v[88:91], v[10:11], v[86:87], v[88:91]
    s_nop 4
    v_cvt_pk_bf16_f32 v88, v88, v89
    v_cvt_pk_bf16_f32 v89, v90, v91
    ds_pk_add_bf16 v7, v88 offset:65408
    ds_pk_add_bf16 v7, v89 offset:65412
    s_mov_b64 exec, s[54:55]
    s_branch L2_d116
L2_c117:
    s_lshl_b64 s[52:53], s[82:83], 1
    s_andn2_b64 s[52:53], s[52:53], s[80:81]
    s_andn2_b64 s[52:53], s[52:53], s[50:51]
    s_or_b64 s[80:81], s[80:81], s[52:53]
    s_not_b64 vcc, s[52:53]
    s_mov_b64 exec, -1
    v_cndmask_b32_dpp v84, v84, v84, vcc wave_shr:1 row_mask:0xf bank_mask:0xf
    v_cndmask_b32_dpp v85, v85, v85, vcc wave_shr:1 row_mask:0xf bank_mask:0xf
    s_lshr_b64 s[52:53], s[52:53], 1
    v_cndmask_b32_dpp v86, v86, v86, vcc wave_shr:1 row_mask:0xf bank_mask:0xf
    v_cndmask_b32_dpp v87, v87, v87, vcc wave_shr:1 row_mask:0xf bank_mask:0xf
    s_andn2_b64 s[82:83], s[82:83], s[52:53]
    v_cndmask_b32_dpp v7, v7, v7, vcc wave_shr:1 row_mask:0xf bank_mask:0xf
    s_mov_b64 exec, s[50:51]
    s_cbranch_scc0 L2_d117
    s_mov_b64 exec, s[82:83]
    s_nop 1
    v_mfma_f32_4x4x4_16b_bf16 v[88:91], v[12:13], v[84:85], 0
    s_nop 1
    v_mfma_f32_4x4x4_16b_bf16 v[88:91], v[10:11], v[86:87], v[88:91]
    s_nop 4
    v_cvt_pk_bf16_f32 v88, v88, v89
    v_cvt_pk_bf16_f32 v89, v90, v91
    ds_pk_add_bf16 v7, v88 offset:65408
    ds_pk_add_bf16 v7, v89 offset:65412
    s_mov_b64 exec, s[50:51]
    s_branch L2_d117
L2_xf115:
    s_cmp_gt_u32 s37, 1024
    s_cbranch_scc1 L2_xt115
    s_cmp_lt_u32 s37, 768
    s_cbranch_scc1 L2_xl115
    ds_read_b32 v33, v44 offset:896
    s_add_u32 s3, s42, 2
    s_bitset1_b32 s43, s3
    s_branch L2_xg115
L2_xl115:
    s_waitcnt lgkmcnt(0)
    v_mov_b32 v42, -1
    s_cmp_ge_u32 s37, 512
    s_cbranch_scc1 L2_xg115
    v_mov_b32 v43, -1
    s_cmp_ge_u32 s37, 256
    s_cbranch_scc1 L2_xg115
    v_mov_b32 v41, -1
    s_branch L2_xg115
L2_xt115:
    s_waitcnt lgkmcnt(0)
    v_mov_b32 v40, -1
    v_mov_b32 v41, -1
    v_mov_b32 v43, -1
    v_mov_b32 v42, -1
    s_add_u32 s3, s42, 2
    s_bitset1_b32 s36, s3
    s_branch L2_xg115
L2_oa118:
    v_and_b32 v47, 0x0fffffff, v32
    buffer_load_dword v114, v47, s[8:11], 0 offen offset:16
    s_mov_b64 exec, s[6:7]
    v_add_u32 v47, 8, v47
    v_lshrrev_b32 v32, 2, v32
    s_mov_b64 exec, -1
    buffer_load_dwordx2 v[112:113], v47, s[8:11], 0 offen
    s_branch L2_ob118
L2_c119:
    s_lshl_b64 s[52:53], s[82:83], 1
    s_andn2_b64 s[52:53], s[52:53], s[80:81]
    s_andn2_b64 s[52:53], s[52:53], s[54:55]
    s_or_b64 s[80:81], s[80:81], s[52:53]
    s_not_b64 vcc, s[52:53]
    s_mov_b64 exec, -1
    v_cndmask_b32_dpp v84, v84, v84, vcc wave_shr:1 row_mask:0xf bank_mask:0xf
    v_cndmask_b32_dpp v85, v85, v85, vcc wave_shr:1 row_mask:0xf bank_mask:0xf
    s_lshr_b64 s[52:53], s[52:53], 1
    v_cndmask_b32_dpp v86, v86, v86, vcc wave_shr:1 row_mask:0xf bank_mask:0xf
    v_cndmask_b32_dpp v87, v87, v87, vcc wave_shr:1 row_mask:0xf bank_mask:0xf
    s_andn2_b64 s[82:83], s[82:83], s[52:53]
    v_cndmask_b32_dpp v7, v7, v7, vcc wave_shr:1 row_mask:0xf bank_mask:0xf
    s_mov_b64 exec, s[54:55]
    s_cbranch_scc0 L2_d119
    s_mov_b64 exec, s[82:83]
    s_nop 1
    v_mfma_f32_4x4x4_16b_bf16 v[88:91], v[12:13], v[84:85], 0
    s_nop 1
    v_mfma_f32_4x4x4_16b_bf16 v[88:91], v[10:11], v[86:87], v[88:91]
    s_nop 4
    v_cvt_pk_bf16_f32 v88, v88, v89
    v_cvt_pk_bf16_f32 v89, v90, v91
    ds_pk_add_bf16 v7, v88 offset:65408
    ds_pk_add_bf16 v7, v89 offset:65412
    s_mov_b64 exec, s[54:55]
    s_branch L2_d119
L2_c120:
    s_lshl_b64 s[52:53], s[82:83], 1
    s_andn2_b64 s[52:53], s[52:53], s[80:81]
    s_andn2_b64 s[52:53], s[52:53], s[50:51]
    s_or_b64 s[80:81], s[80:81], s[52:53]
    s_not_b64 vcc, s[52:53]
    s_mov_b64 exec, -1
    v_cndmask_b32_dpp v84, v84, v84, vcc wave_shr:1 row_mask:0xf bank_mask:0xf
    v_cndmask_b32_dpp v85, v85, v85, vcc wave_shr:1 row_mask:0xf bank_mask:0xf
    s_lshr_b64 s[52:53], s[52:53], 1
    v_cndmask_b32_dpp v86, v86, v86, vcc wave_shr:1 row_mask:0xf bank_mask:0xf
    v_cndmask_b32_dpp v87, v87, v87, vcc wave_shr:1 row_mask:0xf bank_mask:0xf
    s_andn2_b64 s[82:83], s[82:83], s[52:53]
    v_cndmask_b32_dpp v7, v7, v7, vcc wave_shr:1 row_mask:0xf bank_mask:0xf
    s_mov_b64 exec, s[50:51]
    s_cbranch_scc0 L2_d120
    s_mov_b64 exec, s[82:83]
    s_nop 1
    v_mfma_f32_4x4x4_16b_bf16 v[88:91], v[12:13], v[84:85], 0
    s_nop 1
    v_mfma_f32_4x4x4_16b_bf16 v[88:91], v[10:11], v[86:87], v[88:91]
    s_nop 4
    v_cvt_pk_bf16_f32 v88, v88, v89
    v_cvt_pk_bf16_f32 v89, v90, v91
    ds_pk_add_bf16 v7, v88 offset:65408
    ds_pk_add_bf16 v7, v89 offset:65412
    s_mov_b64 exec, s[50:51]
    s_branch L2_d120
L2_c121:
    s_lshl_b64 s[52:53], s[82:83], 1
    s_andn2_b64 s[52:53], s[52:53], s[80:81]
    s_andn2_b64 s[52:53], s[52:53], s[54:55]
    s_or_b64 s[80:81], s[80:81], s[52:53]
    s_not_b64 vcc, s[52:53]
    s_mov_b64 exec, -1
    v_cndmask_b32_dpp v84, v84, v84, vcc wave_shr:1 row_mask:0xf bank_mask:0xf
    v_cndmask_b32_dpp v85, v85, v85, vcc wave_shr:1 row_mask:0xf bank_mask:0xf
    s_lshr_b64 s[52:53], s[52:53], 1
    v_cndmask_b32_dpp v86, v86, v86, vcc wave_shr:1 row_mask:0xf bank_mask:0xf
    v_cndmask_b32_dpp v87, v87, v87, vcc wave_shr:1 row_mask:0xf bank_mask:0xf
    s_andn2_b64 s[82:83], s[82:83], s[52:53]
    v_cndmask_b32_dpp v7, v7, v7, vcc wave_shr:1 row_mask:0xf bank_mask:0xf
    s_mov_b64 exec, s[54:55]
    s_cbranch_scc0 L2_d121
    s_mov_b64 exec, s[82:83]
    s_nop 1
    v_mfma_f32_4x4x4_16b_bf16 v[88:91], v[12:13], v[84:85], 0
    s_nop 1
    v_mfma_f32_4x4x4_16b_bf16 v[88:91], v[10:11], v[86:87], v[88:91]
    s_nop 4
    v_cvt_pk_bf16_f32 v88, v88, v89
    v_cvt_pk_bf16_f32 v89, v90, v91
    ds_pk_add_bf16 v7, v88 offset:65408
    ds_pk_add_bf16 v7, v89 offset:65412
    s_mov_b64 exec, s[54:55]
    s_branch L2_d121
L2_c122:
    s_lshl_b64 s[52:53], s[82:83], 1
    s_andn2_b64 s[52:53], s[52:53], s[80:81]
    s_andn2_b64 s[52:53], s[52:53], s[50:51]
    s_or_b64 s[80:81], s[80:81], s[52:53]
    s_not_b64 vcc, s[52:53]
    s_mov_b64 exec, -1
    v_cndmask_b32_dpp v84, v84, v84, vcc wave_shr:1 row_mask:0xf bank_mask:0xf
    v_cndmask_b32_dpp v85, v85, v85, vcc wave_shr:1 row_mask:0xf bank_mask:0xf
    s_lshr_b64 s[52:53], s[52:53], 1
    v_cndmask_b32_dpp v86, v86, v86, vcc wave_shr:1 row_mask:0xf bank_mask:0xf
    v_cndmask_b32_dpp v87, v87, v87, vcc wave_shr:1 row_mask:0xf bank_mask:0xf
    s_andn2_b64 s[82:83], s[82:83], s[52:53]
    v_cndmask_b32_dpp v7, v7, v7, vcc wave_shr:1 row_mask:0xf bank_mask:0xf
    s_mov_b64 exec, s[50:51]
    s_cbranch_scc0 L2_d122
    s_mov_b64 exec, s[82:83]
    s_nop 1
    v_mfma_f32_4x4x4_16b_bf16 v[88:91], v[12:13], v[84:85], 0
    s_nop 1
    v_mfma_f32_4x4x4_16b_bf16 v[88:91], v[10:11], v[86:87], v[88:91]
    s_nop 4
    v_cvt_pk_bf16_f32 v88, v88, v89
    v_cvt_pk_bf16_f32 v89, v90, v91
    ds_pk_add_bf16 v7, v88 offset:65408
    ds_pk_add_bf16 v7, v89 offset:65412
    s_mov_b64 exec, s[50:51]
    s_branch L2_d122
L2_c123:
    s_lshl_b64 s[52:53], s[82:83], 1
    s_andn2_b64 s[52:53], s[52:53], s[80:81]
    s_andn2_b64 s[52:53], s[52:53], s[54:55]
    s_or_b64 s[80:81], s[80:81], s[52:53]
    s_not_b64 vcc, s[52:53]
    s_mov_b64 exec, -1
    v_cndmask_b32_dpp v84, v84, v84, vcc wave_shr:1 row_mask:0xf bank_mask:0xf
    v_cndmask_b32_dpp v85, v85, v85, vcc wave_shr:1 row_mask:0xf bank_mask:0xf
    s_lshr_b64 s[52:53], s[52:53], 1
    v_cndmask_b32_dpp v86, v86, v86, vcc wave_shr:1 row_mask:0xf bank_mask:0xf
    v_cndmask_b32_dpp v87, v87, v87, vcc wave_shr:1 row_mask:0xf bank_mask:0xf
    s_andn2_b64 s[82:83], s[82:83], s[52:53]
    v_cndmask_b32_dpp v7, v7, v7, vcc wave_shr:1 row_mask:0xf bank_mask:0xf
    s_mov_b64 exec, s[54:55]
    s_cbranch_scc0 L2_d123
    s_mov_b64 exec, s[82:83]
    s_nop 1
    v_mfma_f32_4x4x4_16b_bf16 v[88:91], v[12:13], v[84:85], 0
    s_nop 1
    v_mfma_f32_4x4x4_16b_bf16 v[88:91], v[10:11], v[86:87], v[88:91]
    s_nop 4
    v_cvt_pk_bf16_f32 v88, v88, v89
    v_cvt_pk_bf16_f32 v89, v90, v91
    ds_pk_add_bf16 v7, v88 offset:65408
    ds_pk_add_bf16 v7, v89 offset:65412
    s_mov_b64 exec, s[54:55]
    s_branch L2_d123
L2_c124:
    s_lshl_b64 s[52:53], s[82:83], 1
    s_andn2_b64 s[52:53], s[52:53], s[80:81]
    s_andn2_b64 s[52:53], s[52:53], s[50:51]
    s_or_b64 s[80:81], s[80:81], s[52:53]
    s_not_b64 vcc, s[52:53]
    s_mov_b64 exec, -1
    v_cndmask_b32_dpp v84, v84, v84, vcc wave_shr:1 row_mask:0xf bank_mask:0xf
    v_cndmask_b32_dpp v85, v85, v85, vcc wave_shr:1 row_mask:0xf bank_mask:0xf
    s_lshr_b64 s[52:53], s[52:53], 1
    v_cndmask_b32_dpp v86, v86, v86, vcc wave_shr:1 row_mask:0xf bank_mask:0xf
    v_cndmask_b32_dpp v87, v87, v87, vcc wave_shr:1 row_mask:0xf bank_mask:0xf
    s_andn2_b64 s[82:83], s[82:83], s[52:53]
    v_cndmask_b32_dpp v7, v7, v7, vcc wave_shr:1 row_mask:0xf bank_mask:0xf
    s_mov_b64 exec, s[50:51]
    s_cbranch_scc0 L2_d124
    s_mov_b64 exec, s[82:83]
    s_nop 1
    v_mfma_f32_4x4x4_16b_bf16 v[88:91], v[12:13], v[84:85], 0
    s_nop 1
    v_mfma_f32_4x4x4_16b_bf16 v[88:91], v[10:11], v[86:87], v[88:91]
    s_nop 4
    v_cvt_pk_bf16_f32 v88, v88, v89
    v_cvt_pk_bf16_f32 v89, v90, v91
    ds_pk_add_bf16 v7, v88 offset:65408
    ds_pk_add_bf16 v7, v89 offset:65412
    s_mov_b64 exec, s[50:51]
    s_branch L2_d124
L2_oa125:
    s_waitcnt vmcnt(3)
    s_mov_b64 exec, s[6:7]
    v_lshrrev_b32 v114, 16, v114
    s_mov_b64 exec, -1
    v_and_b32 v46, 0x10000000, v32
    v_cmpx_eq_u32 vcc, 0, v46
    v_lshrrev_b32 v47, 14, v112
    v_and_b32 v47, v5, v47
    ds_read_b64 v[96:97], v47
    v_perm_b32 v98, v112, v114, s44
    v_bitop3_b32 v99, v112, 0.5, -0.5 bitop3:0xa8
    v_bitop3_b32 v98, v6, v98, v99 bitop3:0xca
    v_and_b32 v47, v5, v112
    s_waitcnt lgkmcnt(0)
    v_mfma_f32_4x4x4_16b_bf16 v[88:91], v[8:9], v[96:97], 0
    s_nop 4
    v_mul_f32 v88, v98, v88
    v_mul_f32 v89, v98, v89
    v_mul_f32 v90, v98, v90
    v_mul_f32 v91, v98, v91
    v_cvt_pk_bf16_f32 v88, v88, v89
    v_cvt_pk_bf16_f32 v89, v90, v91
    ds_pk_add_bf16 v47, v88 offset:65408
    ds_pk_add_bf16 v47, v89 offset:65412
    s_mov_b64 exec, -1
    v_and_b32 v46, 0x20000000, v32
    v_cmpx_eq_u32 vcc, 0, v46
    v_lshrrev_b32 v47, 14, v113
    v_and_b32 v47, v5, v47
    ds_read_b64 v[96:97], v47
    v_perm_b32 v98, v113, v114, s45
    v_bitop3_b32 v99, v113, 0.5, -0.5 bitop3:0xa8
    v_bitop3_b32 v98, v6, v98, v99 bitop3:0xca
    v_and_b32 v47, v5, v113
    s_waitcnt lgkmcnt(0)
    v_mfma_f32_4x4x4_16b_bf16 v[88:91], v[8:9], v[96:97], 0
    s_nop 4
    v_mul_f32 v88, v98, v88
    v_mul_f32 v89, v98, v89
    v_mul_f32 v90, v98, v90
    v_mul_f32 v91, v98, v91
    v_cvt_pk_bf16_f32 v88, v88, v89
    v_cvt_pk_bf16_f32 v89, v90, v91
    ds_pk_add_bf16 v47, v88 offset:65408
    ds_pk_add_bf16 v47, v89 offset:65412
    s_mov_b64 exec, -1
    s_branch L2_ob125
L2_c126:
    s_lshl_b64 s[52:53], s[82:83], 1
    s_andn2_b64 s[52:53], s[52:53], s[80:81]
    s_andn2_b64 s[52:53], s[52:53], s[54:55]
    s_or_b64 s[80:81], s[80:81], s[52:53]
    s_not_b64 vcc, s[52:53]
    s_mov_b64 exec, -1
    v_cndmask_b32_dpp v84, v84, v84, vcc wave_shr:1 row_mask:0xf bank_mask:0xf
    v_cndmask_b32_dpp v85, v85, v85, vcc wave_shr:1 row_mask:0xf bank_mask:0xf
    s_lshr_b64 s[52:53], s[52:53], 1
    v_cndmask_b32_dpp v86, v86, v86, vcc wave_shr:1 row_mask:0xf bank_mask:0xf
    v_cndmask_b32_dpp v87, v87, v87, vcc wave_shr:1 row_mask:0xf bank_mask:0xf
    s_andn2_b64 s[82:83], s[82:83], s[52:53]
    v_cndmask_b32_dpp v7, v7, v7, vcc wave_shr:1 row_mask:0xf bank_mask:0xf
    s_mov_b64 exec, s[54:55]
    s_cbranch_scc0 L2_d126
    s_mov_b64 exec, s[82:83]
    s_nop 1
    v_mfma_f32_4x4x4_16b_bf16 v[88:91], v[12:13], v[84:85], 0
    s_nop 1
    v_mfma_f32_4x4x4_16b_bf16 v[88:91], v[10:11], v[86:87], v[88:91]
    s_nop 4
    v_cvt_pk_bf16_f32 v88, v88, v89
    v_cvt_pk_bf16_f32 v89, v90, v91
    ds_pk_add_bf16 v7, v88 offset:65408
    ds_pk_add_bf16 v7, v89 offset:65412
    s_mov_b64 exec, s[54:55]
    s_branch L2_d126
L2_c127:
    s_lshl_b64 s[52:53], s[82:83], 1
    s_andn2_b64 s[52:53], s[52:53], s[80:81]
    s_andn2_b64 s[52:53], s[52:53], s[50:51]
    s_or_b64 s[80:81], s[80:81], s[52:53]
    s_not_b64 vcc, s[52:53]
    s_mov_b64 exec, -1
    v_cndmask_b32_dpp v84, v84, v84, vcc wave_shr:1 row_mask:0xf bank_mask:0xf
    v_cndmask_b32_dpp v85, v85, v85, vcc wave_shr:1 row_mask:0xf bank_mask:0xf
    s_lshr_b64 s[52:53], s[52:53], 1
    v_cndmask_b32_dpp v86, v86, v86, vcc wave_shr:1 row_mask:0xf bank_mask:0xf
    v_cndmask_b32_dpp v87, v87, v87, vcc wave_shr:1 row_mask:0xf bank_mask:0xf
    s_andn2_b64 s[82:83], s[82:83], s[52:53]
    v_cndmask_b32_dpp v7, v7, v7, vcc wave_shr:1 row_mask:0xf bank_mask:0xf
    s_mov_b64 exec, s[50:51]
    s_cbranch_scc0 L2_d127
    s_mov_b64 exec, s[82:83]
    s_nop 1
    v_mfma_f32_4x4x4_16b_bf16 v[88:91], v[12:13], v[84:85], 0
    s_nop 1
    v_mfma_f32_4x4x4_16b_bf16 v[88:91], v[10:11], v[86:87], v[88:91]
    s_nop 4
    v_cvt_pk_bf16_f32 v88, v88, v89
    v_cvt_pk_bf16_f32 v89, v90, v91
    ds_pk_add_bf16 v7, v88 offset:65408
    ds_pk_add_bf16 v7, v89 offset:65412
    s_mov_b64 exec, s[50:51]
    s_branch L2_d127
L2_c128:
    s_lshl_b64 s[52:53], s[82:83], 1
    s_andn2_b64 s[52:53], s[52:53], s[80:81]
    s_andn2_b64 s[52:53], s[52:53], s[54:55]
    s_or_b64 s[80:81], s[80:81], s[52:53]
    s_not_b64 vcc, s[52:53]
    s_mov_b64 exec, -1
    v_cndmask_b32_dpp v84, v84, v84, vcc wave_shr:1 row_mask:0xf bank_mask:0xf
    v_cndmask_b32_dpp v85, v85, v85, vcc wave_shr:1 row_mask:0xf bank_mask:0xf
    s_lshr_b64 s[52:53], s[52:53], 1
    v_cndmask_b32_dpp v86, v86, v86, vcc wave_shr:1 row_mask:0xf bank_mask:0xf
    v_cndmask_b32_dpp v87, v87, v87, vcc wave_shr:1 row_mask:0xf bank_mask:0xf
    s_andn2_b64 s[82:83], s[82:83], s[52:53]
    v_cndmask_b32_dpp v7, v7, v7, vcc wave_shr:1 row_mask:0xf bank_mask:0xf
    s_mov_b64 exec, s[54:55]
    s_cbranch_scc0 L2_d128
    s_mov_b64 exec, s[82:83]
    s_nop 1
    v_mfma_f32_4x4x4_16b_bf16 v[88:91], v[12:13], v[84:85], 0
    s_nop 1
    v_mfma_f32_4x4x4_16b_bf16 v[88:91], v[10:11], v[86:87], v[88:91]
    s_nop 4
    v_cvt_pk_bf16_f32 v88, v88, v89
    v_cvt_pk_bf16_f32 v89, v90, v91
    ds_pk_add_bf16 v7, v88 offset:65408
    ds_pk_add_bf16 v7, v89 offset:65412
    s_mov_b64 exec, s[54:55]
    s_branch L2_d128
L2_c129:
    s_lshl_b64 s[52:53], s[82:83], 1
    s_andn2_b64 s[52:53], s[52:53], s[80:81]
    s_andn2_b64 s[52:53], s[52:53], s[50:51]
    s_or_b64 s[80:81], s[80:81], s[52:53]
    s_not_b64 vcc, s[52:53]
    s_mov_b64 exec, -1
    v_cndmask_b32_dpp v84, v84, v84, vcc wave_shr:1 row_mask:0xf bank_mask:0xf
    v_cndmask_b32_dpp v85, v85, v85, vcc wave_shr:1 row_mask:0xf bank_mask:0xf
    s_lshr_b64 s[52:53], s[52:53], 1
    v_cndmask_b32_dpp v86, v86, v86, vcc wave_shr:1 row_mask:0xf bank_mask:0xf
    v_cndmask_b32_dpp v87, v87, v87, vcc wave_shr:1 row_mask:0xf bank_mask:0xf
    s_andn2_b64 s[82:83], s[82:83], s[52:53]
    v_cndmask_b32_dpp v7, v7, v7, vcc wave_shr:1 row_mask:0xf bank_mask:0xf
    s_mov_b64 exec, s[50:51]
    s_cbranch_scc0 L2_d129
    s_mov_b64 exec, s[82:83]
    s_nop 1
    v_mfma_f32_4x4x4_16b_bf16 v[88:91], v[12:13], v[84:85], 0
    s_nop 1
    v_mfma_f32_4x4x4_16b_bf16 v[88:91], v[10:11], v[86:87], v[88:91]
    s_nop 4
    v_cvt_pk_bf16_f32 v88, v88, v89
    v_cvt_pk_bf16_f32 v89, v90, v91
    ds_pk_add_bf16 v7, v88 offset:65408
    ds_pk_add_bf16 v7, v89 offset:65412
    s_mov_b64 exec, s[50:51]
    s_branch L2_d129
L2_c130:
    s_lshl_b64 s[52:53], s[82:83], 1
    s_andn2_b64 s[52:53], s[52:53], s[80:81]
    s_andn2_b64 s[52:53], s[52:53], s[54:55]
    s_or_b64 s[80:81], s[80:81], s[52:53]
    s_not_b64 vcc, s[52:53]
    s_mov_b64 exec, -1
    v_cndmask_b32_dpp v84, v84, v84, vcc wave_shr:1 row_mask:0xf bank_mask:0xf
    v_cndmask_b32_dpp v85, v85, v85, vcc wave_shr:1 row_mask:0xf bank_mask:0xf
    s_lshr_b64 s[52:53], s[52:53], 1
    v_cndmask_b32_dpp v86, v86, v86, vcc wave_shr:1 row_mask:0xf bank_mask:0xf
    v_cndmask_b32_dpp v87, v87, v87, vcc wave_shr:1 row_mask:0xf bank_mask:0xf
    s_andn2_b64 s[82:83], s[82:83], s[52:53]
    v_cndmask_b32_dpp v7, v7, v7, vcc wave_shr:1 row_mask:0xf bank_mask:0xf
    s_mov_b64 exec, s[54:55]
    s_cbranch_scc0 L2_d130
    s_mov_b64 exec, s[82:83]
    s_nop 1
    v_mfma_f32_4x4x4_16b_bf16 v[88:91], v[12:13], v[84:85], 0
    s_nop 1
    v_mfma_f32_4x4x4_16b_bf16 v[88:91], v[10:11], v[86:87], v[88:91]
    s_nop 4
    v_cvt_pk_bf16_f32 v88, v88, v89
    v_cvt_pk_bf16_f32 v89, v90, v91
    ds_pk_add_bf16 v7, v88 offset:65408
    ds_pk_add_bf16 v7, v89 offset:65412
    s_mov_b64 exec, s[54:55]
    s_branch L2_d130
L2_c131:
    s_lshl_b64 s[52:53], s[82:83], 1
    s_andn2_b64 s[52:53], s[52:53], s[80:81]
    s_andn2_b64 s[52:53], s[52:53], s[50:51]
    s_or_b64 s[80:81], s[80:81], s[52:53]
    s_not_b64 vcc, s[52:53]
    s_mov_b64 exec, -1
    v_cndmask_b32_dpp v84, v84, v84, vcc wave_shr:1 row_mask:0xf bank_mask:0xf
    v_cndmask_b32_dpp v85, v85, v85, vcc wave_shr:1 row_mask:0xf bank_mask:0xf
    s_lshr_b64 s[52:53], s[52:53], 1
    v_cndmask_b32_dpp v86, v86, v86, vcc wave_shr:1 row_mask:0xf bank_mask:0xf
    v_cndmask_b32_dpp v87, v87, v87, vcc wave_shr:1 row_mask:0xf bank_mask:0xf
    s_andn2_b64 s[82:83], s[82:83], s[52:53]
    v_cndmask_b32_dpp v7, v7, v7, vcc wave_shr:1 row_mask:0xf bank_mask:0xf
    s_mov_b64 exec, s[50:51]
    s_cbranch_scc0 L2_d131
    s_mov_b64 exec, s[82:83]
    s_nop 1
    v_mfma_f32_4x4x4_16b_bf16 v[88:91], v[12:13], v[84:85], 0
    s_nop 1
    v_mfma_f32_4x4x4_16b_bf16 v[88:91], v[10:11], v[86:87], v[88:91]
    s_nop 4
    v_cvt_pk_bf16_f32 v88, v88, v89
    v_cvt_pk_bf16_f32 v89, v90, v91
    ds_pk_add_bf16 v7, v88 offset:65408
    ds_pk_add_bf16 v7, v89 offset:65412
    s_mov_b64 exec, s[50:51]
    s_branch L2_d131
L2_c132:
    s_lshl_b64 s[52:53], s[82:83], 1
    s_andn2_b64 s[52:53], s[52:53], s[80:81]
    s_andn2_b64 s[52:53], s[52:53], s[54:55]
    s_or_b64 s[80:81], s[80:81], s[52:53]
    s_not_b64 vcc, s[52:53]
    s_mov_b64 exec, -1
    v_cndmask_b32_dpp v84, v84, v84, vcc wave_shr:1 row_mask:0xf bank_mask:0xf
    v_cndmask_b32_dpp v85, v85, v85, vcc wave_shr:1 row_mask:0xf bank_mask:0xf
    s_lshr_b64 s[52:53], s[52:53], 1
    v_cndmask_b32_dpp v86, v86, v86, vcc wave_shr:1 row_mask:0xf bank_mask:0xf
    v_cndmask_b32_dpp v87, v87, v87, vcc wave_shr:1 row_mask:0xf bank_mask:0xf
    s_andn2_b64 s[82:83], s[82:83], s[52:53]
    v_cndmask_b32_dpp v7, v7, v7, vcc wave_shr:1 row_mask:0xf bank_mask:0xf
    s_mov_b64 exec, s[54:55]
    s_cbranch_scc0 L2_d132
    s_mov_b64 exec, s[82:83]
    s_nop 1
    v_mfma_f32_4x4x4_16b_bf16 v[88:91], v[12:13], v[84:85], 0
    s_nop 1
    v_mfma_f32_4x4x4_16b_bf16 v[88:91], v[10:11], v[86:87], v[88:91]
    s_nop 4
    v_cvt_pk_bf16_f32 v88, v88, v89
    v_cvt_pk_bf16_f32 v89, v90, v91
    ds_pk_add_bf16 v7, v88 offset:65408
    ds_pk_add_bf16 v7, v89 offset:65412
    s_mov_b64 exec, s[54:55]
    s_branch L2_d132
L2_c133:
    s_lshl_b64 s[52:53], s[82:83], 1
    s_andn2_b64 s[52:53], s[52:53], s[80:81]
    s_andn2_b64 s[52:53], s[52:53], s[50:51]
    s_or_b64 s[80:81], s[80:81], s[52:53]
    s_not_b64 vcc, s[52:53]
    s_mov_b64 exec, -1
    v_cndmask_b32_dpp v84, v84, v84, vcc wave_shr:1 row_mask:0xf bank_mask:0xf
    v_cndmask_b32_dpp v85, v85, v85, vcc wave_shr:1 row_mask:0xf bank_mask:0xf
    s_lshr_b64 s[52:53], s[52:53], 1
    v_cndmask_b32_dpp v86, v86, v86, vcc wave_shr:1 row_mask:0xf bank_mask:0xf
    v_cndmask_b32_dpp v87, v87, v87, vcc wave_shr:1 row_mask:0xf bank_mask:0xf
    s_andn2_b64 s[82:83], s[82:83], s[52:53]
    v_cndmask_b32_dpp v7, v7, v7, vcc wave_shr:1 row_mask:0xf bank_mask:0xf
    s_mov_b64 exec, s[50:51]
    s_cbranch_scc0 L2_d133
    s_mov_b64 exec, s[82:83]
    s_nop 1
    v_mfma_f32_4x4x4_16b_bf16 v[88:91], v[12:13], v[84:85], 0
    s_nop 1
    v_mfma_f32_4x4x4_16b_bf16 v[88:91], v[10:11], v[86:87], v[88:91]
    s_nop 4
    v_cvt_pk_bf16_f32 v88, v88, v89
    v_cvt_pk_bf16_f32 v89, v90, v91
    ds_pk_add_bf16 v7, v88 offset:65408
    ds_pk_add_bf16 v7, v89 offset:65412
    s_mov_b64 exec, s[50:51]
    s_branch L2_d133
L2_oa134:
    v_and_b32 v47, 0x0fffffff, v33
    buffer_load_dword v114, v47, s[8:11], 0 offen offset:16
    s_mov_b64 exec, s[6:7]
    v_add_u32 v47, 8, v47
    v_lshrrev_b32 v33, 2, v33
    s_mov_b64 exec, -1
    buffer_load_dwordx2 v[112:113], v47, s[8:11], 0 offen
    s_branch L2_ob134
L2_c135:
    s_lshl_b64 s[52:53], s[82:83], 1
    s_andn2_b64 s[52:53], s[52:53], s[80:81]
    s_andn2_b64 s[52:53], s[52:53], s[54:55]
    s_or_b64 s[80:81], s[80:81], s[52:53]
    s_not_b64 vcc, s[52:53]
    s_mov_b64 exec, -1
    v_cndmask_b32_dpp v84, v84, v84, vcc wave_shr:1 row_mask:0xf bank_mask:0xf
    v_cndmask_b32_dpp v85, v85, v85, vcc wave_shr:1 row_mask:0xf bank_mask:0xf
    s_lshr_b64 s[52:53], s[52:53], 1
    v_cndmask_b32_dpp v86, v86, v86, vcc wave_shr:1 row_mask:0xf bank_mask:0xf
    v_cndmask_b32_dpp v87, v87, v87, vcc wave_shr:1 row_mask:0xf bank_mask:0xf
    s_andn2_b64 s[82:83], s[82:83], s[52:53]
    v_cndmask_b32_dpp v7, v7, v7, vcc wave_shr:1 row_mask:0xf bank_mask:0xf
    s_mov_b64 exec, s[54:55]
    s_cbranch_scc0 L2_d135
    s_mov_b64 exec, s[82:83]
    s_nop 1
    v_mfma_f32_4x4x4_16b_bf16 v[88:91], v[12:13], v[84:85], 0
    s_nop 1
    v_mfma_f32_4x4x4_16b_bf16 v[88:91], v[10:11], v[86:87], v[88:91]
    s_nop 4
    v_cvt_pk_bf16_f32 v88, v88, v89
    v_cvt_pk_bf16_f32 v89, v90, v91
    ds_pk_add_bf16 v7, v88 offset:65408
    ds_pk_add_bf16 v7, v89 offset:65412
    s_mov_b64 exec, s[54:55]
    s_branch L2_d135
L2_c136:
    s_lshl_b64 s[52:53], s[82:83], 1
    s_andn2_b64 s[52:53], s[52:53], s[80:81]
    s_andn2_b64 s[52:53], s[52:53], s[50:51]
    s_or_b64 s[80:81], s[80:81], s[52:53]
    s_not_b64 vcc, s[52:53]
    s_mov_b64 exec, -1
    v_cndmask_b32_dpp v84, v84, v84, vcc wave_shr:1 row_mask:0xf bank_mask:0xf
    v_cndmask_b32_dpp v85, v85, v85, vcc wave_shr:1 row_mask:0xf bank_mask:0xf
    s_lshr_b64 s[52:53], s[52:53], 1
    v_cndmask_b32_dpp v86, v86, v86, vcc wave_shr:1 row_mask:0xf bank_mask:0xf
    v_cndmask_b32_dpp v87, v87, v87, vcc wave_shr:1 row_mask:0xf bank_mask:0xf
    s_andn2_b64 s[82:83], s[82:83], s[52:53]
    v_cndmask_b32_dpp v7, v7, v7, vcc wave_shr:1 row_mask:0xf bank_mask:0xf
    s_mov_b64 exec, s[50:51]
    s_cbranch_scc0 L2_d136
    s_mov_b64 exec, s[82:83]
    s_nop 1
    v_mfma_f32_4x4x4_16b_bf16 v[88:91], v[12:13], v[84:85], 0
    s_nop 1
    v_mfma_f32_4x4x4_16b_bf16 v[88:91], v[10:11], v[86:87], v[88:91]
    s_nop 4
    v_cvt_pk_bf16_f32 v88, v88, v89
    v_cvt_pk_bf16_f32 v89, v90, v91
    ds_pk_add_bf16 v7, v88 offset:65408
    ds_pk_add_bf16 v7, v89 offset:65412
    s_mov_b64 exec, s[50:51]
    s_branch L2_d136
L2_c137:
    s_lshl_b64 s[52:53], s[82:83], 1
    s_andn2_b64 s[52:53], s[52:53], s[80:81]
    s_andn2_b64 s[52:53], s[52:53], s[54:55]
    s_or_b64 s[80:81], s[80:81], s[52:53]
    s_not_b64 vcc, s[52:53]
    s_mov_b64 exec, -1
    v_cndmask_b32_dpp v84, v84, v84, vcc wave_shr:1 row_mask:0xf bank_mask:0xf
    v_cndmask_b32_dpp v85, v85, v85, vcc wave_shr:1 row_mask:0xf bank_mask:0xf
    s_lshr_b64 s[52:53], s[52:53], 1
    v_cndmask_b32_dpp v86, v86, v86, vcc wave_shr:1 row_mask:0xf bank_mask:0xf
    v_cndmask_b32_dpp v87, v87, v87, vcc wave_shr:1 row_mask:0xf bank_mask:0xf
    s_andn2_b64 s[82:83], s[82:83], s[52:53]
    v_cndmask_b32_dpp v7, v7, v7, vcc wave_shr:1 row_mask:0xf bank_mask:0xf
    s_mov_b64 exec, s[54:55]
    s_cbranch_scc0 L2_d137
    s_mov_b64 exec, s[82:83]
    s_nop 1
    v_mfma_f32_4x4x4_16b_bf16 v[88:91], v[12:13], v[84:85], 0
    s_nop 1
    v_mfma_f32_4x4x4_16b_bf16 v[88:91], v[10:11], v[86:87], v[88:91]
    s_nop 4
    v_cvt_pk_bf16_f32 v88, v88, v89
    v_cvt_pk_bf16_f32 v89, v90, v91
    ds_pk_add_bf16 v7, v88 offset:65408
    ds_pk_add_bf16 v7, v89 offset:65412
    s_mov_b64 exec, s[54:55]
    s_branch L2_d137
L2_c138:
    s_lshl_b64 s[52:53], s[82:83], 1
    s_andn2_b64 s[52:53], s[52:53], s[80:81]
    s_andn2_b64 s[52:53], s[52:53], s[50:51]
    s_or_b64 s[80:81], s[80:81], s[52:53]
    s_not_b64 vcc, s[52:53]
    s_mov_b64 exec, -1
    v_cndmask_b32_dpp v84, v84, v84, vcc wave_shr:1 row_mask:0xf bank_mask:0xf
    v_cndmask_b32_dpp v85, v85, v85, vcc wave_shr:1 row_mask:0xf bank_mask:0xf
    s_lshr_b64 s[52:53], s[52:53], 1
    v_cndmask_b32_dpp v86, v86, v86, vcc wave_shr:1 row_mask:0xf bank_mask:0xf
    v_cndmask_b32_dpp v87, v87, v87, vcc wave_shr:1 row_mask:0xf bank_mask:0xf
    s_andn2_b64 s[82:83], s[82:83], s[52:53]
    v_cndmask_b32_dpp v7, v7, v7, vcc wave_shr:1 row_mask:0xf bank_mask:0xf
    s_mov_b64 exec, s[50:51]
    s_cbranch_scc0 L2_d138
    s_mov_b64 exec, s[82:83]
    s_nop 1
    v_mfma_f32_4x4x4_16b_bf16 v[88:91], v[12:13], v[84:85], 0
    s_nop 1
    v_mfma_f32_4x4x4_16b_bf16 v[88:91], v[10:11], v[86:87], v[88:91]
    s_nop 4
    v_cvt_pk_bf16_f32 v88, v88, v89
    v_cvt_pk_bf16_f32 v89, v90, v91
    ds_pk_add_bf16 v7, v88 offset:65408
    ds_pk_add_bf16 v7, v89 offset:65412
    s_mov_b64 exec, s[50:51]
    s_branch L2_d138
L2_c139:
    s_lshl_b64 s[52:53], s[82:83], 1
    s_andn2_b64 s[52:53], s[52:53], s[80:81]
    s_andn2_b64 s[52:53], s[52:53], s[54:55]
    s_or_b64 s[80:81], s[80:81], s[52:53]
    s_not_b64 vcc, s[52:53]
    s_mov_b64 exec, -1
    v_cndmask_b32_dpp v84, v84, v84, vcc wave_shr:1 row_mask:0xf bank_mask:0xf
    v_cndmask_b32_dpp v85, v85, v85, vcc wave_shr:1 row_mask:0xf bank_mask:0xf
    s_lshr_b64 s[52:53], s[52:53], 1
    v_cndmask_b32_dpp v86, v86, v86, vcc wave_shr:1 row_mask:0xf bank_mask:0xf
    v_cndmask_b32_dpp v87, v87, v87, vcc wave_shr:1 row_mask:0xf bank_mask:0xf
    s_andn2_b64 s[82:83], s[82:83], s[52:53]
    v_cndmask_b32_dpp v7, v7, v7, vcc wave_shr:1 row_mask:0xf bank_mask:0xf
    s_mov_b64 exec, s[54:55]
    s_cbranch_scc0 L2_d139
    s_mov_b64 exec, s[82:83]
    s_nop 1
    v_mfma_f32_4x4x4_16b_bf16 v[88:91], v[12:13], v[84:85], 0
    s_nop 1
    v_mfma_f32_4x4x4_16b_bf16 v[88:91], v[10:11], v[86:87], v[88:91]
    s_nop 4
    v_cvt_pk_bf16_f32 v88, v88, v89
    v_cvt_pk_bf16_f32 v89, v90, v91
    ds_pk_add_bf16 v7, v88 offset:65408
    ds_pk_add_bf16 v7, v89 offset:65412
    s_mov_b64 exec, s[54:55]
    s_branch L2_d139
L2_c140:
    s_lshl_b64 s[52:53], s[82:83], 1
    s_andn2_b64 s[52:53], s[52:53], s[80:81]
    s_andn2_b64 s[52:53], s[52:53], s[50:51]
    s_or_b64 s[80:81], s[80:81], s[52:53]
    s_not_b64 vcc, s[52:53]
    s_mov_b64 exec, -1
    v_cndmask_b32_dpp v84, v84, v84, vcc wave_shr:1 row_mask:0xf bank_mask:0xf
    v_cndmask_b32_dpp v85, v85, v85, vcc wave_shr:1 row_mask:0xf bank_mask:0xf
    s_lshr_b64 s[52:53], s[52:53], 1
    v_cndmask_b32_dpp v86, v86, v86, vcc wave_shr:1 row_mask:0xf bank_mask:0xf
    v_cndmask_b32_dpp v87, v87, v87, vcc wave_shr:1 row_mask:0xf bank_mask:0xf
    s_andn2_b64 s[82:83], s[82:83], s[52:53]
    v_cndmask_b32_dpp v7, v7, v7, vcc wave_shr:1 row_mask:0xf bank_mask:0xf
    s_mov_b64 exec, s[50:51]
    s_cbranch_scc0 L2_d140
    s_mov_b64 exec, s[82:83]
    s_nop 1
    v_mfma_f32_4x4x4_16b_bf16 v[88:91], v[12:13], v[84:85], 0
    s_nop 1
    v_mfma_f32_4x4x4_16b_bf16 v[88:91], v[10:11], v[86:87], v[88:91]
    s_nop 4
    v_cvt_pk_bf16_f32 v88, v88, v89
    v_cvt_pk_bf16_f32 v89, v90, v91
    ds_pk_add_bf16 v7, v88 offset:65408
    ds_pk_add_bf16 v7, v89 offset:65412
    s_mov_b64 exec, s[50:51]
    s_branch L2_d140
L2_oa141:
    s_waitcnt vmcnt(0)
    s_mov_b64 exec, s[6:7]
    v_lshrrev_b32 v114, 16, v114
    s_mov_b64 exec, -1
    v_and_b32 v46, 0x10000000, v33
    v_cmpx_eq_u32 vcc, 0, v46
    v_lshrrev_b32 v47, 14, v112
    v_and_b32 v47, v5, v47
    ds_read_b64 v[96:97], v47
    v_perm_b32 v98, v112, v114, s44
    v_bitop3_b32 v99, v112, 0.5, -0.5 bitop3:0xa8
    v_bitop3_b32 v98, v6, v98, v99 bitop3:0xca
    v_and_b32 v47, v5, v112
    s_waitcnt lgkmcnt(0)
    v_mfma_f32_4x4x4_16b_bf16 v[88:91], v[8:9], v[96:97], 0
    s_nop 4
    v_mul_f32 v88, v98, v88
    v_mul_f32 v89, v98, v89
    v_mul_f32 v90, v98, v90
    v_mul_f32 v91, v98, v91
    v_cvt_pk_bf16_f32 v88, v88, v89
    v_cvt_pk_bf16_f32 v89, v90, v91
    ds_pk_add_bf16 v47, v88 offset:65408
    ds_pk_add_bf16 v47, v89 offset:65412
    s_mov_b64 exec, -1
    v_and_b32 v46, 0x20000000, v33
    v_cmpx_eq_u32 vcc, 0, v46
    v_lshrrev_b32 v47, 14, v113
    v_and_b32 v47, v5, v47
    ds_read_b64 v[96:97], v47
    v_perm_b32 v98, v113, v114, s45
    v_bitop3_b32 v99, v113, 0.5, -0.5 bitop3:0xa8
    v_bitop3_b32 v98, v6, v98, v99 bitop3:0xca
    v_and_b32 v47, v5, v113
    s_waitcnt lgkmcnt(0)
    v_mfma_f32_4x4x4_16b_bf16 v[88:91], v[8:9], v[96:97], 0
    s_nop 4
    v_mul_f32 v88, v98, v88
    v_mul_f32 v89, v98, v89
    v_mul_f32 v90, v98, v90
    v_mul_f32 v91, v98, v91
    v_cvt_pk_bf16_f32 v88, v88, v89
    v_cvt_pk_bf16_f32 v89, v90, v91
    ds_pk_add_bf16 v47, v88 offset:65408
    ds_pk_add_bf16 v47, v89 offset:65412
    s_mov_b64 exec, -1
    s_branch L2_ob141
L2_c142:
    s_lshl_b64 s[52:53], s[82:83], 1
    s_andn2_b64 s[52:53], s[52:53], s[80:81]
    s_andn2_b64 s[52:53], s[52:53], s[54:55]
    s_or_b64 s[80:81], s[80:81], s[52:53]
    s_not_b64 vcc, s[52:53]
    s_mov_b64 exec, -1
    v_cndmask_b32_dpp v84, v84, v84, vcc wave_shr:1 row_mask:0xf bank_mask:0xf
    v_cndmask_b32_dpp v85, v85, v85, vcc wave_shr:1 row_mask:0xf bank_mask:0xf
    s_lshr_b64 s[52:53], s[52:53], 1
    v_cndmask_b32_dpp v86, v86, v86, vcc wave_shr:1 row_mask:0xf bank_mask:0xf
    v_cndmask_b32_dpp v87, v87, v87, vcc wave_shr:1 row_mask:0xf bank_mask:0xf
    s_andn2_b64 s[82:83], s[82:83], s[52:53]
    v_cndmask_b32_dpp v7, v7, v7, vcc wave_shr:1 row_mask:0xf bank_mask:0xf
    s_mov_b64 exec, s[54:55]
    s_cbranch_scc0 L2_d142
    s_mov_b64 exec, s[82:83]
    s_nop 1
    v_mfma_f32_4x4x4_16b_bf16 v[88:91], v[12:13], v[84:85], 0
    s_nop 1
    v_mfma_f32_4x4x4_16b_bf16 v[88:91], v[10:11], v[86:87], v[88:91]
    s_nop 4
    v_cvt_pk_bf16_f32 v88, v88, v89
    v_cvt_pk_bf16_f32 v89, v90, v91
    ds_pk_add_bf16 v7, v88 offset:65408
    ds_pk_add_bf16 v7, v89 offset:65412
    s_mov_b64 exec, s[54:55]
    s_branch L2_d142
L2_c143:
    s_lshl_b64 s[52:53], s[82:83], 1
    s_andn2_b64 s[52:53], s[52:53], s[80:81]
    s_andn2_b64 s[52:53], s[52:53], s[50:51]
    s_or_b64 s[80:81], s[80:81], s[52:53]
    s_not_b64 vcc, s[52:53]
    s_mov_b64 exec, -1
    v_cndmask_b32_dpp v84, v84, v84, vcc wave_shr:1 row_mask:0xf bank_mask:0xf
    v_cndmask_b32_dpp v85, v85, v85, vcc wave_shr:1 row_mask:0xf bank_mask:0xf
    s_lshr_b64 s[52:53], s[52:53], 1
    v_cndmask_b32_dpp v86, v86, v86, vcc wave_shr:1 row_mask:0xf bank_mask:0xf
    v_cndmask_b32_dpp v87, v87, v87, vcc wave_shr:1 row_mask:0xf bank_mask:0xf
    s_andn2_b64 s[82:83], s[82:83], s[52:53]
    v_cndmask_b32_dpp v7, v7, v7, vcc wave_shr:1 row_mask:0xf bank_mask:0xf
    s_mov_b64 exec, s[50:51]
    s_cbranch_scc0 L2_d143
    s_mov_b64 exec, s[82:83]
    s_nop 1
    v_mfma_f32_4x4x4_16b_bf16 v[88:91], v[12:13], v[84:85], 0
    s_nop 1
    v_mfma_f32_4x4x4_16b_bf16 v[88:91], v[10:11], v[86:87], v[88:91]
    s_nop 4
    v_cvt_pk_bf16_f32 v88, v88, v89
    v_cvt_pk_bf16_f32 v89, v90, v91
    ds_pk_add_bf16 v7, v88 offset:65408
    ds_pk_add_bf16 v7, v89 offset:65412
    s_mov_b64 exec, s[50:51]
    s_branch L2_d143
L2_c144:
    s_lshl_b64 s[52:53], s[82:83], 1
    s_andn2_b64 s[52:53], s[52:53], s[80:81]
    s_andn2_b64 s[52:53], s[52:53], s[54:55]
    s_or_b64 s[80:81], s[80:81], s[52:53]
    s_not_b64 vcc, s[52:53]
    s_mov_b64 exec, -1
    v_cndmask_b32_dpp v84, v84, v84, vcc wave_shr:1 row_mask:0xf bank_mask:0xf
    v_cndmask_b32_dpp v85, v85, v85, vcc wave_shr:1 row_mask:0xf bank_mask:0xf
    s_lshr_b64 s[52:53], s[52:53], 1
    v_cndmask_b32_dpp v86, v86, v86, vcc wave_shr:1 row_mask:0xf bank_mask:0xf
    v_cndmask_b32_dpp v87, v87, v87, vcc wave_shr:1 row_mask:0xf bank_mask:0xf
    s_andn2_b64 s[82:83], s[82:83], s[52:53]
    v_cndmask_b32_dpp v7, v7, v7, vcc wave_shr:1 row_mask:0xf bank_mask:0xf
    s_mov_b64 exec, s[54:55]
    s_cbranch_scc0 L2_d144
    s_mov_b64 exec, s[82:83]
    s_nop 1
    v_mfma_f32_4x4x4_16b_bf16 v[88:91], v[12:13], v[84:85], 0
    s_nop 1
    v_mfma_f32_4x4x4_16b_bf16 v[88:91], v[10:11], v[86:87], v[88:91]
    s_nop 4
    v_cvt_pk_bf16_f32 v88, v88, v89
    v_cvt_pk_bf16_f32 v89, v90, v91
    ds_pk_add_bf16 v7, v88 offset:65408
    ds_pk_add_bf16 v7, v89 offset:65412
    s_mov_b64 exec, s[54:55]
    s_branch L2_d144
L2_c145:
    s_lshl_b64 s[52:53], s[82:83], 1
    s_andn2_b64 s[52:53], s[52:53], s[80:81]
    s_andn2_b64 s[52:53], s[52:53], s[50:51]
    s_or_b64 s[80:81], s[80:81], s[52:53]
    s_not_b64 vcc, s[52:53]
    s_mov_b64 exec, -1
    v_cndmask_b32_dpp v84, v84, v84, vcc wave_shr:1 row_mask:0xf bank_mask:0xf
    v_cndmask_b32_dpp v85, v85, v85, vcc wave_shr:1 row_mask:0xf bank_mask:0xf
    s_lshr_b64 s[52:53], s[52:53], 1
    v_cndmask_b32_dpp v86, v86, v86, vcc wave_shr:1 row_mask:0xf bank_mask:0xf
    v_cndmask_b32_dpp v87, v87, v87, vcc wave_shr:1 row_mask:0xf bank_mask:0xf
    s_andn2_b64 s[82:83], s[82:83], s[52:53]
    v_cndmask_b32_dpp v7, v7, v7, vcc wave_shr:1 row_mask:0xf bank_mask:0xf
    s_mov_b64 exec, s[50:51]
    s_cbranch_scc0 L2_d145
    s_mov_b64 exec, s[82:83]
    s_nop 1
    v_mfma_f32_4x4x4_16b_bf16 v[88:91], v[12:13], v[84:85], 0
    s_nop 1
    v_mfma_f32_4x4x4_16b_bf16 v[88:91], v[10:11], v[86:87], v[88:91]
    s_nop 4
    v_cvt_pk_bf16_f32 v88, v88, v89
    v_cvt_pk_bf16_f32 v89, v90, v91
    ds_pk_add_bf16 v7, v88 offset:65408
    ds_pk_add_bf16 v7, v89 offset:65412
    s_mov_b64 exec, s[50:51]
    s_branch L2_d145
L2_c146:
    s_lshl_b64 s[52:53], s[82:83], 1
    s_andn2_b64 s[52:53], s[52:53], s[80:81]
    s_andn2_b64 s[52:53], s[52:53], s[54:55]
    s_or_b64 s[80:81], s[80:81], s[52:53]
    s_not_b64 vcc, s[52:53]
    s_mov_b64 exec, -1
    v_cndmask_b32_dpp v84, v84, v84, vcc wave_shr:1 row_mask:0xf bank_mask:0xf
    v_cndmask_b32_dpp v85, v85, v85, vcc wave_shr:1 row_mask:0xf bank_mask:0xf
    s_lshr_b64 s[52:53], s[52:53], 1
    v_cndmask_b32_dpp v86, v86, v86, vcc wave_shr:1 row_mask:0xf bank_mask:0xf
    v_cndmask_b32_dpp v87, v87, v87, vcc wave_shr:1 row_mask:0xf bank_mask:0xf
    s_andn2_b64 s[82:83], s[82:83], s[52:53]
    v_cndmask_b32_dpp v7, v7, v7, vcc wave_shr:1 row_mask:0xf bank_mask:0xf
    s_mov_b64 exec, s[54:55]
    s_cbranch_scc0 L2_d146
    s_mov_b64 exec, s[82:83]
    s_nop 1
    v_mfma_f32_4x4x4_16b_bf16 v[88:91], v[12:13], v[84:85], 0
    s_nop 1
    v_mfma_f32_4x4x4_16b_bf16 v[88:91], v[10:11], v[86:87], v[88:91]
    s_nop 4
    v_cvt_pk_bf16_f32 v88, v88, v89
    v_cvt_pk_bf16_f32 v89, v90, v91
    ds_pk_add_bf16 v7, v88 offset:65408
    ds_pk_add_bf16 v7, v89 offset:65412
    s_mov_b64 exec, s[54:55]
    s_branch L2_d146
L2_c147:
    s_lshl_b64 s[52:53], s[82:83], 1
    s_andn2_b64 s[52:53], s[52:53], s[80:81]
    s_andn2_b64 s[52:53], s[52:53], s[50:51]
    s_or_b64 s[80:81], s[80:81], s[52:53]
    s_not_b64 vcc, s[52:53]
    s_mov_b64 exec, -1
    v_cndmask_b32_dpp v84, v84, v84, vcc wave_shr:1 row_mask:0xf bank_mask:0xf
    v_cndmask_b32_dpp v85, v85, v85, vcc wave_shr:1 row_mask:0xf bank_mask:0xf
    s_lshr_b64 s[52:53], s[52:53], 1
    v_cndmask_b32_dpp v86, v86, v86, vcc wave_shr:1 row_mask:0xf bank_mask:0xf
    v_cndmask_b32_dpp v87, v87, v87, vcc wave_shr:1 row_mask:0xf bank_mask:0xf
    s_andn2_b64 s[82:83], s[82:83], s[52:53]
    v_cndmask_b32_dpp v7, v7, v7, vcc wave_shr:1 row_mask:0xf bank_mask:0xf
    s_mov_b64 exec, s[50:51]
    s_cbranch_scc0 L2_d147
    s_mov_b64 exec, s[82:83]
    s_nop 1
    v_mfma_f32_4x4x4_16b_bf16 v[88:91], v[12:13], v[84:85], 0
    s_nop 1
    v_mfma_f32_4x4x4_16b_bf16 v[88:91], v[10:11], v[86:87], v[88:91]
    s_nop 4
    v_cvt_pk_bf16_f32 v88, v88, v89
    v_cvt_pk_bf16_f32 v89, v90, v91
    ds_pk_add_bf16 v7, v88 offset:65408
    ds_pk_add_bf16 v7, v89 offset:65412
    s_mov_b64 exec, s[50:51]
    s_branch L2_d147
L2_c148:
    s_lshl_b64 s[52:53], s[82:83], 1
    s_andn2_b64 s[52:53], s[52:53], s[80:81]
    s_andn2_b64 s[52:53], s[52:53], s[54:55]
    s_or_b64 s[80:81], s[80:81], s[52:53]
    s_not_b64 vcc, s[52:53]
    s_mov_b64 exec, -1
    v_cndmask_b32_dpp v84, v84, v84, vcc wave_shr:1 row_mask:0xf bank_mask:0xf
    v_cndmask_b32_dpp v85, v85, v85, vcc wave_shr:1 row_mask:0xf bank_mask:0xf
    s_lshr_b64 s[52:53], s[52:53], 1
    v_cndmask_b32_dpp v86, v86, v86, vcc wave_shr:1 row_mask:0xf bank_mask:0xf
    v_cndmask_b32_dpp v87, v87, v87, vcc wave_shr:1 row_mask:0xf bank_mask:0xf
    s_andn2_b64 s[82:83], s[82:83], s[52:53]
    v_cndmask_b32_dpp v7, v7, v7, vcc wave_shr:1 row_mask:0xf bank_mask:0xf
    s_mov_b64 exec, s[54:55]
    s_cbranch_scc0 L2_d148
    s_mov_b64 exec, s[82:83]
    s_nop 1
    v_mfma_f32_4x4x4_16b_bf16 v[88:91], v[12:13], v[84:85], 0
    s_nop 1
    v_mfma_f32_4x4x4_16b_bf16 v[88:91], v[10:11], v[86:87], v[88:91]
    s_nop 4
    v_cvt_pk_bf16_f32 v88, v88, v89
    v_cvt_pk_bf16_f32 v89, v90, v91
    ds_pk_add_bf16 v7, v88 offset:65408
    ds_pk_add_bf16 v7, v89 offset:65412
    s_mov_b64 exec, s[54:55]
    s_branch L2_d148
L2_c149:
    s_lshl_b64 s[52:53], s[82:83], 1
    s_andn2_b64 s[52:53], s[52:53], s[80:81]
    s_andn2_b64 s[52:53], s[52:53], s[50:51]
    s_or_b64 s[80:81], s[80:81], s[52:53]
    s_not_b64 vcc, s[52:53]
    s_mov_b64 exec, -1
    v_cndmask_b32_dpp v84, v84, v84, vcc wave_shr:1 row_mask:0xf bank_mask:0xf
    v_cndmask_b32_dpp v85, v85, v85, vcc wave_shr:1 row_mask:0xf bank_mask:0xf
    s_lshr_b64 s[52:53], s[52:53], 1
    v_cndmask_b32_dpp v86, v86, v86, vcc wave_shr:1 row_mask:0xf bank_mask:0xf
    v_cndmask_b32_dpp v87, v87, v87, vcc wave_shr:1 row_mask:0xf bank_mask:0xf
    s_andn2_b64 s[82:83], s[82:83], s[52:53]
    v_cndmask_b32_dpp v7, v7, v7, vcc wave_shr:1 row_mask:0xf bank_mask:0xf
    s_mov_b64 exec, s[50:51]
    s_cbranch_scc0 L2_d149
    s_mov_b64 exec, s[82:83]
    s_nop 1
    v_mfma_f32_4x4x4_16b_bf16 v[88:91], v[12:13], v[84:85], 0
    s_nop 1
    v_mfma_f32_4x4x4_16b_bf16 v[88:91], v[10:11], v[86:87], v[88:91]
    s_nop 4
    v_cvt_pk_bf16_f32 v88, v88, v89
    v_cvt_pk_bf16_f32 v89, v90, v91
    ds_pk_add_bf16 v7, v88 offset:65408
    ds_pk_add_bf16 v7, v89 offset:65412
    s_mov_b64 exec, s[50:51]
    s_branch L2_d149
L2_c150:
    s_lshl_b64 s[52:53], s[82:83], 1
    s_andn2_b64 s[52:53], s[52:53], s[80:81]
    s_andn2_b64 s[52:53], s[52:53], s[54:55]
    s_or_b64 s[80:81], s[80:81], s[52:53]
    s_not_b64 vcc, s[52:53]
    s_mov_b64 exec, -1
    v_cndmask_b32_dpp v84, v84, v84, vcc wave_shr:1 row_mask:0xf bank_mask:0xf
    v_cndmask_b32_dpp v85, v85, v85, vcc wave_shr:1 row_mask:0xf bank_mask:0xf
    s_lshr_b64 s[52:53], s[52:53], 1
    v_cndmask_b32_dpp v86, v86, v86, vcc wave_shr:1 row_mask:0xf bank_mask:0xf
    v_cndmask_b32_dpp v87, v87, v87, vcc wave_shr:1 row_mask:0xf bank_mask:0xf
    s_andn2_b64 s[82:83], s[82:83], s[52:53]
    v_cndmask_b32_dpp v7, v7, v7, vcc wave_shr:1 row_mask:0xf bank_mask:0xf
    s_mov_b64 exec, s[54:55]
    s_cbranch_scc0 L2_d150
    s_mov_b64 exec, s[82:83]
    s_nop 1
    v_mfma_f32_4x4x4_16b_bf16 v[88:91], v[12:13], v[84:85], 0
    s_nop 1
    v_mfma_f32_4x4x4_16b_bf16 v[88:91], v[10:11], v[86:87], v[88:91]
    s_nop 4
    v_cvt_pk_bf16_f32 v88, v88, v89
    v_cvt_pk_bf16_f32 v89, v90, v91
    ds_pk_add_bf16 v7, v88 offset:65408
    ds_pk_add_bf16 v7, v89 offset:65412
    s_mov_b64 exec, s[54:55]
    s_branch L2_d150
L2_c151:
    s_lshl_b64 s[52:53], s[82:83], 1
    s_andn2_b64 s[52:53], s[52:53], s[80:81]
    s_andn2_b64 s[52:53], s[52:53], s[50:51]
    s_or_b64 s[80:81], s[80:81], s[52:53]
    s_not_b64 vcc, s[52:53]
    s_mov_b64 exec, -1
    v_cndmask_b32_dpp v84, v84, v84, vcc wave_shr:1 row_mask:0xf bank_mask:0xf
    v_cndmask_b32_dpp v85, v85, v85, vcc wave_shr:1 row_mask:0xf bank_mask:0xf
    s_lshr_b64 s[52:53], s[52:53], 1
    v_cndmask_b32_dpp v86, v86, v86, vcc wave_shr:1 row_mask:0xf bank_mask:0xf
    v_cndmask_b32_dpp v87, v87, v87, vcc wave_shr:1 row_mask:0xf bank_mask:0xf
    s_andn2_b64 s[82:83], s[82:83], s[52:53]
    v_cndmask_b32_dpp v7, v7, v7, vcc wave_shr:1 row_mask:0xf bank_mask:0xf
    s_mov_b64 exec, s[50:51]
    s_cbranch_scc0 L2_d151
    s_mov_b64 exec, s[82:83]
    s_nop 1
    v_mfma_f32_4x4x4_16b_bf16 v[88:91], v[12:13], v[84:85], 0
    s_nop 1
    v_mfma_f32_4x4x4_16b_bf16 v[88:91], v[10:11], v[86:87], v[88:91]
    s_nop 4
    v_cvt_pk_bf16_f32 v88, v88, v89
    v_cvt_pk_bf16_f32 v89, v90, v91
    ds_pk_add_bf16 v7, v88 offset:65408
    ds_pk_add_bf16 v7, v89 offset:65412
    s_mov_b64 exec, s[50:51]
    s_branch L2_d151
L2_c152:
    s_mov_b64 s[50:51], vcc
    s_lshl_b64 s[52:53], s[82:83], 1
    s_andn2_b64 s[52:53], s[52:53], s[80:81]
    s_andn2_b64 s[52:53], s[52:53], s[50:51]
    s_or_b64 s[80:81], s[80:81], s[52:53]
    s_not_b64 vcc, s[52:53]
    s_mov_b64 exec, -1
    v_cndmask_b32_dpp v84, v84, v84, vcc wave_shr:1 row_mask:0xf bank_mask:0xf
    v_cndmask_b32_dpp v85, v85, v85, vcc wave_shr:1 row_mask:0xf bank_mask:0xf
    s_lshr_b64 s[52:53], s[52:53], 1
    v_cndmask_b32_dpp v86, v86, v86, vcc wave_shr:1 row_mask:0xf bank_mask:0xf
    v_cndmask_b32_dpp v87, v87, v87, vcc wave_shr:1 row_mask:0xf bank_mask:0xf
    s_andn2_b64 s[82:83], s[82:83], s[52:53]
    v_cndmask_b32_dpp v7, v7, v7, vcc wave_shr:1 row_mask:0xf bank_mask:0xf
    s_mov_b64 vcc, s[50:51]
    s_mov_b64 exec, s[50:51]
    s_cbranch_scc0 L2_d152
    s_mov_b64 exec, s[82:83]
    s_nop 1
    v_mfma_f32_4x4x4_16b_bf16 v[88:91], v[12:13], v[84:85], 0
    s_nop 1
    v_mfma_f32_4x4x4_16b_bf16 v[88:91], v[10:11], v[86:87], v[88:91]
    s_nop 4
    v_cvt_pk_bf16_f32 v88, v88, v89
    v_cvt_pk_bf16_f32 v89, v90, v91
    ds_pk_add_bf16 v7, v88 offset:65408
    ds_pk_add_bf16 v7, v89 offset:65412
    s_mov_b64 exec, vcc
    s_branch L2_d152
L2_c153:
    s_mov_b64 s[50:51], vcc
    s_lshl_b64 s[52:53], s[82:83], 1
    s_andn2_b64 s[52:53], s[52:53], s[80:81]
    s_andn2_b64 s[52:53], s[52:53], s[50:51]
    s_or_b64 s[80:81], s[80:81], s[52:53]
    s_not_b64 vcc, s[52:53]
    s_mov_b64 exec, -1
    v_cndmask_b32_dpp v84, v84, v84, vcc wave_shr:1 row_mask:0xf bank_mask:0xf
    v_cndmask_b32_dpp v85, v85, v85, vcc wave_shr:1 row_mask:0xf bank_mask:0xf
    s_lshr_b64 s[52:53], s[52:53], 1
    v_cndmask_b32_dpp v86, v86, v86, vcc wave_shr:1 row_mask:0xf bank_mask:0xf
    v_cndmask_b32_dpp v87, v87, v87, vcc wave_shr:1 row_mask:0xf bank_mask:0xf
    s_andn2_b64 s[82:83], s[82:83], s[52:53]
    v_cndmask_b32_dpp v7, v7, v7, vcc wave_shr:1 row_mask:0xf bank_mask:0xf
    s_mov_b64 vcc, s[50:51]
    s_mov_b64 exec, s[50:51]
    s_cbranch_scc0 L2_d153
    s_mov_b64 exec, s[82:83]
    s_nop 1
    v_mfma_f32_4x4x4_16b_bf16 v[88:91], v[12:13], v[84:85], 0
    s_nop 1
    v_mfma_f32_4x4x4_16b_bf16 v[88:91], v[10:11], v[86:87], v[88:91]
    s_nop 4
    v_cvt_pk_bf16_f32 v88, v88, v89
    v_cvt_pk_bf16_f32 v89, v90, v91
    ds_pk_add_bf16 v7, v88 offset:65408
    ds_pk_add_bf16 v7, v89 offset:65412
    s_mov_b64 exec, vcc
    s_branch L2_d153
L2_f3s:
    s_branch L2_f3
.section .rodata,"a"
.p2align 6
.amdhsa_kernel gather_scatter__molecular_angular_gemnet__graph_kernel
  .amdhsa_next_free_vgpr 128
  .amdhsa_next_free_sgpr 102
  .amdhsa_accum_offset 128
  .amdhsa_group_segment_fixed_size 0
  .amdhsa_kernarg_size 112
  .amdhsa_user_sgpr_count 2
  .amdhsa_user_sgpr_kernarg_segment_ptr 1
  .amdhsa_system_sgpr_workgroup_id_x 1
  .amdhsa_float_denorm_mode_32 3
.end_amdhsa_kernel
```

```asm
; @launch grid=(256,1,1) block=(1024,1,1) lds=163840
.amdgcn_target "amdgcn-amd-amdhsa--gfx950"
.text
.globl gather_scatter__molecular_angular_gemnet__graph_kernel
.p2align 8
.type gather_scatter__molecular_angular_gemnet__graph_kernel,@function
gather_scatter__molecular_angular_gemnet__graph_kernel:
    s_cmp_ge_u32 s2, 256
    s_cbranch_scc0 L1_go
    s_endpgm
L1_go:
    s_load_dwordx2 s[8:9], s[0:1], 8
    s_load_dwordx2 s[12:13], s[0:1], 16
    s_load_dwordx2 s[16:17], s[0:1], 32
    s_load_dwordx2 s[30:31], s[0:1], 104
    s_load_dwordx2 s[56:57], s[0:1], 96
    s_load_dwordx2 s[86:87], s[0:1], 0
    s_load_dwordx4 s[60:63], s[0:1], 56
    s_load_dwordx4 s[64:67], s[0:1], 72
    v_lshrrev_b32 v7, 6, v0
    v_lshlrev_b32 v1, 3, v0
    v_readfirstlane_b32 s32, v7
    v_lshlrev_b32 v0, 4, v0
    v_and_b32 v1, 0x1f8, v1
    s_lshr_b32 s3, s32, 1
    s_and_b32 s44, s32, 1
    s_lshl_b32 s44, s44, 3
    s_or_b32 s3, s3, s44
    s_lshl_b32 s3, s3, 10
    s_lshl_b32 s96, s2, 14
    s_add_u32 s96, s96, s3
    s_mov_b32 s10, 0x9c40000
    s_mov_b32 s11, 0x20000
    s_mov_b32 s14, 0x9c40000
    s_mov_b32 s15, 0x20000
    s_mov_b32 s18, 0x4e20000
    s_mov_b32 s19, 0x20000
    s_waitcnt lgkmcnt(0)
    s_add_u32 s44, s96, 0x0
    v_lshlrev_b32 v16, 1, v1
    buffer_load_dwordx4 v[16:19], v16, s[8:11], s44 offen nt
    s_add_u32 s45, s96, 0x0
    v_lshlrev_b32 v20, 1, v1
    buffer_load_dwordx4 v[20:23], v20, s[12:15], s45 offen nt
    s_add_u32 s46, s96, 0x0
    s_lshr_b32 s46, s46, 1
    buffer_load_dwordx2 v[24:25], v1, s[16:19], s46 offen nt
    s_add_u32 s47, s96, 0x400000
    s_lshr_b32 s47, s47, 1
    buffer_load_dwordx2 v[26:27], v1, s[16:19], s47 offen nt
    s_add_u32 s44, s96, 0x400000
    v_lshlrev_b32 v28, 1, v1
    buffer_load_dwordx4 v[28:31], v28, s[8:11], s44 offen nt
    s_add_u32 s45, s96, 0x400000
    v_lshlrev_b32 v32, 1, v1
    buffer_load_dwordx4 v[32:35], v32, s[12:15], s45 offen nt
    s_add_u32 s46, s96, 0x800000
    v_lshlrev_b32 v36, 1, v1
    buffer_load_dwordx4 v[36:39], v36, s[8:11], s46 offen nt
    s_add_u32 s47, s96, 0x800000
    v_lshlrev_b32 v40, 1, v1
    buffer_load_dwordx4 v[40:43], v40, s[12:15], s47 offen nt
    s_add_u32 s44, s96, 0x800000
    s_lshr_b32 s44, s44, 1
    buffer_load_dwordx2 v[44:45], v1, s[16:19], s44 offen nt
    s_add_u32 s45, s96, 0xc00000
    s_lshr_b32 s45, s45, 1
    buffer_load_dwordx2 v[46:47], v1, s[16:19], s45 offen nt
    s_mov_b32 s68, s62
    s_mov_b32 s69, s63
    s_mov_b32 s70, 0x40
    s_mov_b32 s71, 0x20000
    s_mov_b32 s72, s60
    s_mov_b32 s73, s61
    s_mov_b32 s74, 0x40
    s_mov_b32 s75, 0x20000
    s_mov_b32 s20, s66
    s_mov_b32 s21, s67
    s_mov_b32 s22, 0x20
    s_mov_b32 s23, 0x20000
    s_mov_b32 s80, s64
    s_mov_b32 s81, s65
    s_mov_b32 s82, 0x20
    s_mov_b32 s83, 0x20000
    s_add_u32 s24, s30, 0xec54000
    s_addc_u32 s25, s31, 0
    s_mov_b32 s26, 0x100
    s_mov_b32 s27, 0x20000
    v_lshrrev_b32 v2, 3, v0
    v_and_b32 v2, 6, v2
    v_lshlrev_b32 v3, 2, v0
    s_lshl_b32 s3, s32, 8
    s_add_u32 s3, s3, s2
    s_cmp_lg_u32 s3, 254
    s_cbranch_scc1 L1_wt
    buffer_load_ushort v116, v2, s[68:71], 0 offen offset:0
    buffer_load_ushort v108, v2, s[68:71], 0 offen offset:8
    buffer_load_ushort v117, v2, s[68:71], 0 offen offset:16
    buffer_load_ushort v109, v2, s[68:71], 0 offen offset:24
    buffer_load_ushort v118, v2, s[68:71], 0 offen offset:32
    buffer_load_ushort v110, v2, s[68:71], 0 offen offset:40
    buffer_load_ushort v119, v2, s[68:71], 0 offen offset:48
    buffer_load_ushort v111, v2, s[68:71], 0 offen offset:56
    buffer_load_ushort v120, v2, s[72:75], 0 offen offset:0
    buffer_load_ushort v100, v2, s[72:75], 0 offen offset:8
    buffer_load_ushort v121, v2, s[72:75], 0 offen offset:16
    buffer_load_ushort v101, v2, s[72:75], 0 offen offset:24
    buffer_load_ushort v122, v2, s[72:75], 0 offen offset:32
    buffer_load_ushort v102, v2, s[72:75], 0 offen offset:40
    buffer_load_ushort v123, v2, s[72:75], 0 offen offset:48
    buffer_load_ushort v103, v2, s[72:75], 0 offen offset:56
    buffer_load_ushort v124, v2, s[20:23], 0 offen offset:0
    buffer_load_ushort v112, v2, s[20:23], 0 offen offset:8
    buffer_load_ushort v125, v2, s[20:23], 0 offen offset:16
    buffer_load_ushort v113, v2, s[20:23], 0 offen offset:24
    buffer_load_ushort v126, v2, s[80:83], 0 offen offset:0
    buffer_load_ushort v114, v2, s[80:83], 0 offen offset:8
    buffer_load_ushort v127, v2, s[80:83], 0 offen offset:16
    buffer_load_ushort v115, v2, s[80:83], 0 offen offset:24
    s_waitcnt vmcnt(0)
    v_lshl_or_b32 v116, v108, 16, v116
    v_lshl_or_b32 v117, v109, 16, v117
    v_lshl_or_b32 v118, v110, 16, v118
    v_lshl_or_b32 v119, v111, 16, v119
    v_lshl_or_b32 v120, v100, 16, v120
    v_lshl_or_b32 v121, v101, 16, v121
    v_lshl_or_b32 v122, v102, 16, v122
    v_lshl_or_b32 v123, v103, 16, v123
    v_lshl_or_b32 v124, v112, 16, v124
    v_lshl_or_b32 v125, v113, 16, v125
    v_lshl_or_b32 v126, v114, 16, v126
    v_lshl_or_b32 v127, v115, 16, v127
    buffer_store_dwordx4 v[116:119], v3, s[24:27], 0 offen offset:0 sc1
    buffer_store_dwordx4 v[120:123], v3, s[24:27], 0 offen offset:16 sc1
    buffer_store_dwordx4 v[124:127], v3, s[24:27], 0 offen offset:32 sc1
L1_wt:
    s_mov_b32 s20, s30
    s_mov_b32 s21, s31
    s_mov_b32 s22, 0xd344000
    s_mov_b32 s23, 0x20000
    s_add_u32 s24, s30, 0x2c000
    s_addc_u32 s25, s31, 0
    s_mov_b32 s26, 0xd318000
    s_mov_b32 s27, 0x20000
    s_add_u32 s3, s32, 0
    s_mul_i32 s4, s3, 205
    s_lshr_b32 s4, s4, 10
    s_mul_i32 s5, s4, 5
    s_sub_u32 s5, s3, s5
    s_lshl_b32 s5, s5, 5
    s_add_u32 s4, s4, s5
    s_sub_u32 s4, s4, s32
    s_lshl_b32 s72, s4, 10
    s_add_u32 s3, s32, 16
    s_mul_i32 s4, s3, 205
    s_lshr_b32 s4, s4, 10
    s_mul_i32 s5, s4, 5
    s_sub_u32 s5, s3, s5
    s_lshl_b32 s5, s5, 5
    s_add_u32 s4, s4, s5
    s_sub_u32 s4, s4, s32
    s_lshl_b32 s73, s4, 10
    s_add_u32 s3, s32, 32
    s_mul_i32 s4, s3, 205
    s_lshr_b32 s4, s4, 10
    s_mul_i32 s5, s4, 5
    s_sub_u32 s5, s3, s5
    s_lshl_b32 s5, s5, 5
    s_add_u32 s4, s4, s5
    s_sub_u32 s4, s4, s32
    s_lshl_b32 s85, s4, 10
    s_add_u32 s3, s32, 48
    s_mul_i32 s4, s3, 205
    s_lshr_b32 s4, s4, 10
    s_mul_i32 s5, s4, 5
    s_sub_u32 s5, s3, s5
    s_lshl_b32 s5, s5, 5
    s_add_u32 s4, s4, s5
    s_sub_u32 s4, s4, s32
    s_lshl_b32 s91, s4, 10
    s_add_u32 s3, s32, 64
    s_mul_i32 s4, s3, 205
    s_lshr_b32 s4, s4, 10
    s_mul_i32 s5, s4, 5
    s_sub_u32 s5, s3, s5
    s_lshl_b32 s5, s5, 5
    s_add_u32 s4, s4, s5
    s_sub_u32 s4, s4, s32
    s_lshl_b32 s93, s4, 10
    s_mov_b32 s80, s86
    s_mov_b32 s81, s87
    s_mov_b32 s82, 0x4e2000
    s_mov_b32 s83, 0x20000
    s_mul_i32 s35, s2, 173056
    s_and_b32 s37, s32, 3
    s_lshl_b32 s37, s37, 3
    s_mov_b32 s36, s37
    s_lshr_b32 s37, s32, 2
    s_mul_i32 s37, s37, 2080
    s_add_u32 s36, s36, s37
    s_and_b32 s37, s2, 3
    s_lshl_b32 s37, s37, 5
    s_add_u32 s36, s36, s37
    s_mul_i32 s4, s2, 5
    s_add_u32 s4, s4, 8192
    s_lshl_b32 s38, s4, 14
    s_lshl_b32 s39, s4, 13
    v_mov_b32 v2, 1
    v_mov_b32 v4, 0x80000007
    v_mov_b32 v5, 0xfc
    v_mov_b32 v6, 0x78
    s_mov_b32 s40, 16512
    s_mov_b32 s55, -10000
    s_mov_b32 s41, 0x010c0c01
    s_mov_b32 s42, 0x030c0c03
    v_mov_b32 v8, 0
    v_mov_b32 v9, 0
    v_mov_b32 v10, 0
    v_mov_b32 v11, 0
    ds_write_b128 v0, v[8:11]
    s_add_u32 s60, s30, 0xec5d000
    s_addc_u32 s61, s31, 0
    s_mov_b32 s62, 0x8000
    s_mov_b32 s63, 0x20000
    s_mov_b64 s[66:67], s[56:57]
    s_lshl_b32 s57, s2, 7
    s_add_u32 s68, s30, 0xec55000
    s_addc_u32 s69, s31, 0
    s_mov_b32 s70, 0x80
    s_mov_b32 s71, 0x20000
    s_lshl_b32 s3, s2, 7
    s_add_u32 s68, s68, s3
    s_addc_u32 s69, s69, 0
    s_cmp_lg_u32 s32, 0
    s_cbranch_scc1 L1_fl
    buffer_store_dwordx4 v[8:11], v0, s[68:71], 0 offen sc1
    s_mov_b64 exec, 0xff
    buffer_store_dwordx4 v[8:11], v0, s[60:63], s57 offen sc1
    s_mov_b64 exec, -1
L1_fl:
    s_waitcnt lgkmcnt(0)
    s_barrier
    s_setprio 3
    s_add_u32 s46, s96, 0xc00000
    v_lshlrev_b32 v48, 1, v1
    buffer_load_dwordx4 v[48:51], v48, s[8:11], s46 offen nt
    s_add_u32 s47, s96, 0xc00000
    v_lshlrev_b32 v52, 1, v1
    buffer_load_dwordx4 v[52:55], v52, s[12:15], s47 offen nt
    s_waitcnt vmcnt(8)
    v_lshlrev_b32 v7, 16, v24
    v_and_b32 v8, 0xffff0000, v24
    v_lshlrev_b32 v9, 16, v25
    v_and_b32 v10, 0xffff0000, v25
    v_mul_f32 v7, 0.15915494, v7
    v_mul_f32 v8, 0.15915494, v8
    v_mul_f32 v9, 0.15915494, v9
    v_mul_f32 v10, 0.15915494, v10
    v_mul_hi_u32_u24 v14, 429497, v16
    v_lshrrev_b32 v12, 3, v20
    v_cos_f32 v7, v7
    v_lshlrev_b16 v13, 3, v20
    v_mad_i32_i24 v11, v14, s55, v16
    v_bitop3_b32 v12, v6, v13, v12 bitop3:0xca
    v_lshl_add_u32 v11, v11, 17, s40
    v_lshlrev_b16 v14, 8, v14
    v_lshrrev_b32 v13, 2, v20
    v_add_u32 v16, v12, v11
    v_bitop3_b32 v20, v5, v13, v14 bitop3:0xea
    ds_add_u32 v20, v2
    v_mul_hi_u32_u24 v14, 429497, v17
    v_lshrrev_b32 v12, 3, v21
    v_cos_f32 v8, v8
    v_lshlrev_b16 v13, 3, v21
    v_mad_i32_i24 v11, v14, s55, v17
    v_bitop3_b32 v12, v6, v13, v12 bitop3:0xca
    v_lshl_add_u32 v11, v11, 17, s40
    v_lshlrev_b16 v14, 8, v14
    v_lshrrev_b32 v13, 2, v21
    v_add_u32 v17, v12, v11
    v_bitop3_b32 v21, v5, v13, v14 bitop3:0xea
    ds_add_u32 v21, v2
    v_cvt_pk_bf16_f32 v24, v7, v8
    v_perm_b32 v12, v24, v24, s41
    v_bitop3_b32 v16, v4, v12, v16 bitop3:0xca
    v_perm_b32 v13, v24, v24, s42
    v_bitop3_b32 v17, v4, v13, v17 bitop3:0xca
    v_mul_hi_u32_u24 v14, 429497, v18
    v_lshrrev_b32 v12, 3, v22
    v_cos_f32 v9, v9
    v_lshlrev_b16 v13, 3, v22
    v_mad_i32_i24 v11, v14, s55, v18
    v_bitop3_b32 v12, v6, v13, v12 bitop3:0xca
    v_lshl_add_u32 v11, v11, 17, s40
    v_lshlrev_b16 v14, 8, v14
    v_lshrrev_b32 v13, 2, v22
    v_add_u32 v18, v12, v11
    v_bitop3_b32 v22, v5, v13, v14 bitop3:0xea
    ds_add_u32 v22, v2
    v_mul_hi_u32_u24 v14, 429497, v19
    v_lshrrev_b32 v12, 3, v23
    v_cos_f32 v10, v10
    v_lshlrev_b16 v13, 3, v23
    v_mad_i32_i24 v11, v14, s55, v19
    v_bitop3_b32 v12, v6, v13, v12 bitop3:0xca
    v_lshl_add_u32 v11, v11, 17, s40
    v_lshlrev_b16 v14, 8, v14
    v_lshrrev_b32 v13, 2, v23
    v_add_u32 v19, v12, v11
    v_bitop3_b32 v23, v5, v13, v14 bitop3:0xea
    ds_add_u32 v23, v2
    v_cvt_pk_bf16_f32 v25, v9, v10
    v_perm_b32 v12, v25, v25, s41
    v_bitop3_b32 v18, v4, v12, v18 bitop3:0xca
    v_perm_b32 v13, v25, v25, s42
    v_bitop3_b32 v19, v4, v13, v19 bitop3:0xca
    s_add_u32 s44, s96, 0x1000000
    v_lshlrev_b32 v56, 1, v1
    buffer_load_dwordx4 v[56:59], v56, s[8:11], s44 offen nt
    s_add_u32 s45, s96, 0x1000000
    v_lshlrev_b32 v60, 1, v1
    buffer_load_dwordx4 v[60:63], v60, s[12:15], s45 offen nt
    s_add_u32 s46, s96, 0x1000000
    s_lshr_b32 s46, s46, 1
    buffer_load_dwordx2 v[64:65], v1, s[16:19], s46 offen nt
    s_add_u32 s47, s96, 0x1400000
    s_lshr_b32 s47, s47, 1
    buffer_load_dwordx2 v[66:67], v1, s[16:19], s47 offen nt
    s_waitcnt vmcnt(10)
    v_lshlrev_b32 v7, 16, v26
    v_and_b32 v8, 0xffff0000, v26
    v_lshlrev_b32 v9, 16, v27
    v_and_b32 v10, 0xffff0000, v27
    v_mul_f32 v7, 0.15915494, v7
    v_mul_f32 v8, 0.15915494, v8
    v_mul_f32 v9, 0.15915494, v9
    v_mul_f32 v10, 0.15915494, v10
    v_mul_hi_u32_u24 v14, 429497, v28
    v_lshrrev_b32 v12, 3, v32
    v_cos_f32 v7, v7
    v_lshlrev_b16 v13, 3, v32
    v_mad_i32_i24 v11, v14, s55, v28
    v_bitop3_b32 v12, v6, v13, v12 bitop3:0xca
    v_lshl_add_u32 v11, v11, 17, s40
    v_lshlrev_b16 v14, 8, v14
    v_lshrrev_b32 v13, 2, v32
    v_add_u32 v28, v12, v11
    v_bitop3_b32 v32, v5, v13, v14 bitop3:0xea
    ds_add_u32 v32, v2
    v_mul_hi_u32_u24 v14, 429497, v29
    v_lshrrev_b32 v12, 3, v33
    v_cos_f32 v8, v8
    v_lshlrev_b16 v13, 3, v33
    v_mad_i32_i24 v11, v14, s55, v29
    v_bitop3_b32 v12, v6, v13, v12 bitop3:0xca
    v_lshl_add_u32 v11, v11, 17, s40
    v_lshlrev_b16 v14, 8, v14
    v_lshrrev_b32 v13, 2, v33
    v_add_u32 v29, v12, v11
    v_bitop3_b32 v33, v5, v13, v14 bitop3:0xea
    ds_add_u32 v33, v2
    v_cvt_pk_bf16_f32 v26, v7, v8
    v_perm_b32 v12, v26, v26, s41
    v_bitop3_b32 v28, v4, v12, v28 bitop3:0xca
    v_perm_b32 v13, v26, v26, s42
    v_bitop3_b32 v29, v4, v13, v29 bitop3:0xca
    v_mul_hi_u32_u24 v14, 429497, v30
    v_lshrrev_b32 v12, 3, v34
    v_cos_f32 v9, v9
    v_lshlrev_b16 v13, 3, v34
    v_mad_i32_i24 v11, v14, s55, v30
    v_bitop3_b32 v12, v6, v13, v12 bitop3:0xca
    v_lshl_add_u32 v11, v11, 17, s40
    v_lshlrev_b16 v14, 8, v14
    v_lshrrev_b32 v13, 2, v34
    v_add_u32 v30, v12, v11
    v_bitop3_b32 v34, v5, v13, v14 bitop3:0xea
    ds_add_u32 v34, v2
    v_mul_hi_u32_u24 v14, 429497, v31
    v_lshrrev_b32 v12, 3, v35
    v_cos_f32 v10, v10
    v_lshlrev_b16 v13, 3, v35
    v_mad_i32_i24 v11, v14, s55, v31
    v_bitop3_b32 v12, v6, v13, v12 bitop3:0xca
    v_lshl_add_u32 v11, v11, 17, s40
    v_lshlrev_b16 v14, 8, v14
    v_lshrrev_b32 v13, 2, v35
    v_add_u32 v31, v12, v11
    v_bitop3_b32 v35, v5, v13, v14 bitop3:0xea
    ds_add_u32 v35, v2
    v_cvt_pk_bf16_f32 v27, v9, v10
    v_perm_b32 v12, v27, v27, s41
    v_bitop3_b32 v30, v4, v12, v30 bitop3:0xca
    v_perm_b32 v13, v27, v27, s42
    v_bitop3_b32 v31, v4, v13, v31 bitop3:0xca
    s_setprio 2
    s_add_u32 s44, s96, 0x1400000
    v_lshlrev_b32 v68, 1, v1
    buffer_load_dwordx4 v[68:71], v68, s[8:11], s44 offen nt
    s_add_u32 s45, s96, 0x1400000
    v_lshlrev_b32 v72, 1, v1
    buffer_load_dwordx4 v[72:75], v72, s[12:15], s45 offen nt
    s_waitcnt vmcnt(8)
    v_lshlrev_b32 v7, 16, v44
    v_and_b32 v8, 0xffff0000, v44
    v_lshlrev_b32 v9, 16, v45
    v_and_b32 v10, 0xffff0000, v45
    v_mul_f32 v7, 0.15915494, v7
    v_mul_f32 v8, 0.15915494, v8
    v_mul_f32 v9, 0.15915494, v9
    v_mul_f32 v10, 0.15915494, v10
    v_mul_hi_u32_u24 v14, 429497, v36
    v_lshrrev_b32 v12, 3, v40
    v_cos_f32 v7, v7
    v_lshlrev_b16 v13, 3, v40
    v_mad_i32_i24 v11, v14, s55, v36
    v_bitop3_b32 v12, v6, v13, v12 bitop3:0xca
    v_lshl_add_u32 v11, v11, 17, s40
    v_lshlrev_b16 v14, 8, v14
    v_lshrrev_b32 v13, 2, v40
    v_add_u32 v36, v12, v11
    v_bitop3_b32 v40, v5, v13, v14 bitop3:0xea
    ds_add_u32 v40, v2
    v_mul_hi_u32_u24 v14, 429497, v37
    v_lshrrev_b32 v12, 3, v41
    v_cos_f32 v8, v8
    v_lshlrev_b16 v13, 3, v41
    v_mad_i32_i24 v11, v14, s55, v37
    v_bitop3_b32 v12, v6, v13, v12 bitop3:0xca
    v_lshl_add_u32 v11, v11, 17, s40
    v_lshlrev_b16 v14, 8, v14
    v_lshrrev_b32 v13, 2, v41
    v_add_u32 v37, v12, v11
    v_bitop3_b32 v41, v5, v13, v14 bitop3:0xea
    ds_add_u32 v41, v2
    v_cvt_pk_bf16_f32 v44, v7, v8
    v_perm_b32 v12, v44, v44, s41
    v_bitop3_b32 v36, v4, v12, v36 bitop3:0xca
    v_perm_b32 v13, v44, v44, s42
    v_bitop3_b32 v37, v4, v13, v37 bitop3:0xca
    v_mul_hi_u32_u24 v14, 429497, v38
    v_lshrrev_b32 v12, 3, v42
    v_cos_f32 v9, v9
    v_lshlrev_b16 v13, 3, v42
    v_mad_i32_i24 v11, v14, s55, v38
    v_bitop3_b32 v12, v6, v13, v12 bitop3:0xca
    v_lshl_add_u32 v11, v11, 17, s40
    v_lshlrev_b16 v14, 8, v14
    v_lshrrev_b32 v13, 2, v42
    v_add_u32 v38, v12, v11
    v_bitop3_b32 v42, v5, v13, v14 bitop3:0xea
    ds_add_u32 v42, v2
    v_mul_hi_u32_u24 v14, 429497, v39
    v_lshrrev_b32 v12, 3, v43
    v_cos_f32 v10, v10
    v_lshlrev_b16 v13, 3, v43
    v_mad_i32_i24 v11, v14, s55, v39
    v_bitop3_b32 v12, v6, v13, v12 bitop3:0xca
    v_lshl_add_u32 v11, v11, 17, s40
    v_lshlrev_b16 v14, 8, v14
    v_lshrrev_b32 v13, 2, v43
    v_add_u32 v39, v12, v11
    v_bitop3_b32 v43, v5, v13, v14 bitop3:0xea
    ds_add_u32 v43, v2
    v_cvt_pk_bf16_f32 v45, v9, v10
    v_perm_b32 v12, v45, v45, s41
    v_bitop3_b32 v38, v4, v12, v38 bitop3:0xca
    v_perm_b32 v13, v45, v45, s42
    v_bitop3_b32 v39, v4, v13, v39 bitop3:0xca
    s_add_u32 s46, s96, 0x1800000
    v_lshlrev_b32 v76, 1, v1
    buffer_load_dwordx4 v[76:79], v76, s[8:11], s46 offen nt
    s_add_u32 s47, s96, 0x1800000
    v_lshlrev_b32 v80, 1, v1
    buffer_load_dwordx4 v[80:83], v80, s[12:15], s47 offen nt
    s_add_u32 s44, s96, 0x1800000
    s_lshr_b32 s44, s44, 1
    buffer_load_dwordx2 v[84:85], v1, s[16:19], s44 offen nt
    s_add_u32 s45, s96, 0x1c00000
    s_lshr_b32 s45, s45, 1
    buffer_load_dwordx2 v[86:87], v1, s[16:19], s45 offen nt
    s_waitcnt vmcnt(10)
    v_lshlrev_b32 v7, 16, v46
    v_and_b32 v8, 0xffff0000, v46
    v_lshlrev_b32 v9, 16, v47
    v_and_b32 v10, 0xffff0000, v47
    v_mul_f32 v7, 0.15915494, v7
    v_mul_f32 v8, 0.15915494, v8
    v_mul_f32 v9, 0.15915494, v9
    v_mul_f32 v10, 0.15915494, v10
    v_mul_hi_u32_u24 v14, 429497, v48
    v_lshrrev_b32 v12, 3, v52
    v_cos_f32 v7, v7
    v_lshlrev_b16 v13, 3, v52
    v_mad_i32_i24 v11, v14, s55, v48
    v_bitop3_b32 v12, v6, v13, v12 bitop3:0xca
    v_lshl_add_u32 v11, v11, 17, s40
    v_lshlrev_b16 v14, 8, v14
    v_lshrrev_b32 v13, 2, v52
    v_add_u32 v48, v12, v11
    v_bitop3_b32 v52, v5, v13, v14 bitop3:0xea
    ds_add_u32 v52, v2
    v_mul_hi_u32_u24 v14, 429497, v49
    v_lshrrev_b32 v12, 3, v53
    v_cos_f32 v8, v8
    v_lshlrev_b16 v13, 3, v53
    v_mad_i32_i24 v11, v14, s55, v49
    v_bitop3_b32 v12, v6, v13, v12 bitop3:0xca
    v_lshl_add_u32 v11, v11, 17, s40
    v_lshlrev_b16 v14, 8, v14
    v_lshrrev_b32 v13, 2, v53
    v_add_u32 v49, v12, v11
    v_bitop3_b32 v53, v5, v13, v14 bitop3:0xea
    ds_add_u32 v53, v2
    v_cvt_pk_bf16_f32 v46, v7, v8
    v_perm_b32 v12, v46, v46, s41
    v_bitop3_b32 v48, v4, v12, v48 bitop3:0xca
    v_perm_b32 v13, v46, v46, s42
    v_bitop3_b32 v49, v4, v13, v49 bitop3:0xca
    v_mul_hi_u32_u24 v14, 429497, v50
    v_lshrrev_b32 v12, 3, v54
    v_cos_f32 v9, v9
    v_lshlrev_b16 v13, 3, v54
    v_mad_i32_i24 v11, v14, s55, v50
    v_bitop3_b32 v12, v6, v13, v12 bitop3:0xca
    v_lshl_add_u32 v11, v11, 17, s40
    v_lshlrev_b16 v14, 8, v14
    v_lshrrev_b32 v13, 2, v54
    v_add_u32 v50, v12, v11
    v_bitop3_b32 v54, v5, v13, v14 bitop3:0xea
    ds_add_u32 v54, v2
    v_mul_hi_u32_u24 v14, 429497, v51
    v_lshrrev_b32 v12, 3, v55
    v_cos_f32 v10, v10
    v_lshlrev_b16 v13, 3, v55
    v_mad_i32_i24 v11, v14, s55, v51
    v_bitop3_b32 v12, v6, v13, v12 bitop3:0xca
    v_lshl_add_u32 v11, v11, 17, s40
    v_lshlrev_b16 v14, 8, v14
    v_lshrrev_b32 v13, 2, v55
    v_add_u32 v51, v12, v11
    v_bitop3_b32 v55, v5, v13, v14 bitop3:0xea
    ds_add_u32 v55, v2
    v_cvt_pk_bf16_f32 v47, v9, v10
    v_perm_b32 v12, v47, v47, s41
    v_bitop3_b32 v50, v4, v12, v50 bitop3:0xca
    v_perm_b32 v13, v47, v47, s42
    v_bitop3_b32 v51, v4, v13, v51 bitop3:0xca
    s_setprio 1
    s_add_u32 s46, s96, 0x1c00000
    v_lshlrev_b32 v88, 1, v1
    buffer_load_dwordx4 v[88:91], v88, s[8:11], s46 offen nt
    s_add_u32 s47, s96, 0x1c00000
    v_lshlrev_b32 v92, 1, v1
    buffer_load_dwordx4 v[92:95], v92, s[12:15], s47 offen nt
    s_waitcnt vmcnt(8)
    v_lshlrev_b32 v7, 16, v64
    v_and_b32 v8, 0xffff0000, v64
    v_lshlrev_b32 v9, 16, v65
    v_and_b32 v10, 0xffff0000, v65
    v_mul_f32 v7, 0.15915494, v7
    v_mul_f32 v8, 0.15915494, v8
    v_mul_f32 v9, 0.15915494, v9
    v_mul_f32 v10, 0.15915494, v10
    v_mul_hi_u32_u24 v14, 429497, v56
    v_lshrrev_b32 v12, 3, v60
    v_cos_f32 v7, v7
    v_lshlrev_b16 v13, 3, v60
    v_mad_i32_i24 v11, v14, s55, v56
    v_bitop3_b32 v12, v6, v13, v12 bitop3:0xca
    v_lshl_add_u32 v11, v11, 17, s40
    v_lshlrev_b16 v14, 8, v14
    v_lshrrev_b32 v13, 2, v60
    v_add_u32 v56, v12, v11
    v_bitop3_b32 v60, v5, v13, v14 bitop3:0xea
    ds_add_u32 v60, v2
    v_mul_hi_u32_u24 v14, 429497, v57
    v_lshrrev_b32 v12, 3, v61
    v_cos_f32 v8, v8
    v_lshlrev_b16 v13, 3, v61
    v_mad_i32_i24 v11, v14, s55, v57
    v_bitop3_b32 v12, v6, v13, v12 bitop3:0xca
    v_lshl_add_u32 v11, v11, 17, s40
    v_lshlrev_b16 v14, 8, v14
    v_lshrrev_b32 v13, 2, v61
    v_add_u32 v57, v12, v11
    v_bitop3_b32 v61, v5, v13, v14 bitop3:0xea
    ds_add_u32 v61, v2
    v_cvt_pk_bf16_f32 v64, v7, v8
    v_perm_b32 v12, v64, v64, s41
    v_bitop3_b32 v56, v4, v12, v56 bitop3:0xca
    v_perm_b32 v13, v64, v64, s42
    v_bitop3_b32 v57, v4, v13, v57 bitop3:0xca
    v_mul_hi_u32_u24 v14, 429497, v58
    v_lshrrev_b32 v12, 3, v62
    v_cos_f32 v9, v9
    v_lshlrev_b16 v13, 3, v62
    v_mad_i32_i24 v11, v14, s55, v58
    v_bitop3_b32 v12, v6, v13, v12 bitop3:0xca
    v_lshl_add_u32 v11, v11, 17, s40
    v_lshlrev_b16 v14, 8, v14
    v_lshrrev_b32 v13, 2, v62
    v_add_u32 v58, v12, v11
    v_bitop3_b32 v62, v5, v13, v14 bitop3:0xea
    ds_add_u32 v62, v2
    v_mul_hi_u32_u24 v14, 429497, v59
    v_lshrrev_b32 v12, 3, v63
    v_cos_f32 v10, v10
    v_lshlrev_b16 v13, 3, v63
    v_mad_i32_i24 v11, v14, s55, v59
    v_bitop3_b32 v12, v6, v13, v12 bitop3:0xca
    v_lshl_add_u32 v11, v11, 17, s40
    v_lshlrev_b16 v14, 8, v14
    v_lshrrev_b32 v13, 2, v63
    v_add_u32 v59, v12, v11
    v_bitop3_b32 v63, v5, v13, v14 bitop3:0xea
    ds_add_u32 v63, v2
    v_cvt_pk_bf16_f32 v65, v9, v10
    v_perm_b32 v12, v65, v65, s41
    v_bitop3_b32 v58, v4, v12, v58 bitop3:0xca
    v_perm_b32 v13, v65, v65, s42
    v_bitop3_b32 v59, v4, v13, v59 bitop3:0xca
    s_add_u32 s44, s96, 0x2000000
    v_lshlrev_b32 v96, 1, v1
    buffer_load_dwordx4 v[96:99], v96, s[8:11], s44 offen nt
    s_add_u32 s45, s96, 0x2000000
    v_lshlrev_b32 v104, 1, v1
    buffer_load_dwordx4 v[104:107], v104, s[12:15], s45 offen nt
    s_add_u32 s46, s96, 0x2000000
    s_lshr_b32 s46, s46, 1
    buffer_load_dwordx2 v[108:109], v1, s[16:19], s46 offen nt
    s_add_u32 s47, s96, 0x2400000
    s_lshr_b32 s47, s47, 1
    buffer_load_dwordx2 v[110:111], v1, s[16:19], s47 offen nt
    s_waitcnt vmcnt(10)
    v_lshlrev_b32 v7, 16, v66
    v_and_b32 v8, 0xffff0000, v66
    v_lshlrev_b32 v9, 16, v67
    v_and_b32 v10, 0xffff0000, v67
    v_mul_f32 v7, 0.15915494, v7
    v_mul_f32 v8, 0.15915494, v8
    v_mul_f32 v9, 0.15915494, v9
    v_mul_f32 v10, 0.15915494, v10
    v_mul_hi_u32_u24 v14, 429497, v68
    v_lshrrev_b32 v12, 3, v72
    v_cos_f32 v7, v7
    v_lshlrev_b16 v13, 3, v72
    v_mad_i32_i24 v11, v14, s55, v68
    v_bitop3_b32 v12, v6, v13, v12 bitop3:0xca
    v_lshl_add_u32 v11, v11, 17, s40
    v_lshlrev_b16 v14, 8, v14
    v_lshrrev_b32 v13, 2, v72
    v_add_u32 v68, v12, v11
    v_bitop3_b32 v72, v5, v13, v14 bitop3:0xea
    ds_add_u32 v72, v2
    v_mul_hi_u32_u24 v14, 429497, v69
    v_lshrrev_b32 v12, 3, v73
    v_cos_f32 v8, v8
    v_lshlrev_b16 v13, 3, v73
    v_mad_i32_i24 v11, v14, s55, v69
    v_bitop3_b32 v12, v6, v13, v12 bitop3:0xca
    v_lshl_add_u32 v11, v11, 17, s40
    v_lshlrev_b16 v14, 8, v14
    v_lshrrev_b32 v13, 2, v73
    v_add_u32 v69, v12, v11
    v_bitop3_b32 v73, v5, v13, v14 bitop3:0xea
    ds_add_u32 v73, v2
    v_cvt_pk_bf16_f32 v66, v7, v8
    v_perm_b32 v12, v66, v66, s41
    v_bitop3_b32 v68, v4, v12, v68 bitop3:0xca
    v_perm_b32 v13, v66, v66, s42
    v_bitop3_b32 v69, v4, v13, v69 bitop3:0xca
    v_mul_hi_u32_u24 v14, 429497, v70
    v_lshrrev_b32 v12, 3, v74
    v_cos_f32 v9, v9
    v_lshlrev_b16 v13, 3, v74
    v_mad_i32_i24 v11, v14, s55, v70
    v_bitop3_b32 v12, v6, v13, v12 bitop3:0xca
    v_lshl_add_u32 v11, v11, 17, s40
    v_lshlrev_b16 v14, 8, v14
    v_lshrrev_b32 v13, 2, v74
    v_add_u32 v70, v12, v11
    v_bitop3_b32 v74, v5, v13, v14 bitop3:0xea
    ds_add_u32 v74, v2
    v_mul_hi_u32_u24 v14, 429497, v71
    v_lshrrev_b32 v12, 3, v75
    v_cos_f32 v10, v10
    v_lshlrev_b16 v13, 3, v75
    v_mad_i32_i24 v11, v14, s55, v71
    v_bitop3_b32 v12, v6, v13, v12 bitop3:0xca
    v_lshl_add_u32 v11, v11, 17, s40
    v_lshlrev_b16 v14, 8, v14
    v_lshrrev_b32 v13, 2, v75
    v_add_u32 v71, v12, v11
    v_bitop3_b32 v75, v5, v13, v14 bitop3:0xea
    ds_add_u32 v75, v2
    v_cvt_pk_bf16_f32 v67, v9, v10
    v_perm_b32 v12, v67, v67, s41
    v_bitop3_b32 v70, v4, v12, v70 bitop3:0xca
    v_perm_b32 v13, v67, v67, s42
    v_bitop3_b32 v71, v4, v13, v71 bitop3:0xca
    s_setprio 0
    s_add_u32 s44, s96, 0x2400000
    v_lshlrev_b32 v100, 1, v1
    buffer_load_dwordx4 v[100:103], v100, s[8:11], s44 offen nt
    s_waitcnt vmcnt(7)
    v_lshlrev_b32 v7, 16, v84
    v_and_b32 v8, 0xffff0000, v84
    v_lshlrev_b32 v9, 16, v85
    v_and_b32 v10, 0xffff0000, v85
    v_mul_f32 v7, 0.15915494, v7
    v_mul_f32 v8, 0.15915494, v8
    v_mul_f32 v9, 0.15915494, v9
    v_mul_f32 v10, 0.15915494, v10
    v_mul_hi_u32_u24 v14, 429497, v76
    v_lshrrev_b32 v12, 3, v80
    v_cos_f32 v7, v7
    v_lshlrev_b16 v13, 3, v80
    v_mad_i32_i24 v11, v14, s55, v76
    v_bitop3_b32 v12, v6, v13, v12 bitop3:0xca
    v_lshl_add_u32 v11, v11, 17, s40
    v_lshlrev_b16 v14, 8, v14
    v_lshrrev_b32 v13, 2, v80
    v_add_u32 v76, v12, v11
    v_bitop3_b32 v80, v5, v13, v14 bitop3:0xea
    ds_add_u32 v80, v2
    v_mul_hi_u32_u24 v14, 429497, v77
    v_lshrrev_b32 v12, 3, v81
    v_cos_f32 v8, v8
    v_lshlrev_b16 v13, 3, v81
    v_mad_i32_i24 v11, v14, s55, v77
    v_bitop3_b32 v12, v6, v13, v12 bitop3:0xca
    v_lshl_add_u32 v11, v11, 17, s40
    v_lshlrev_b16 v14, 8, v14
    v_lshrrev_b32 v13, 2, v81
    v_add_u32 v77, v12, v11
    v_bitop3_b32 v81, v5, v13, v14 bitop3:0xea
    ds_add_u32 v81, v2
    v_cvt_pk_bf16_f32 v84, v7, v8
    v_perm_b32 v12, v84, v84, s41
    v_bitop3_b32 v76, v4, v12, v76 bitop3:0xca
    v_perm_b32 v13, v84, v84, s42
    v_bitop3_b32 v77, v4, v13, v77 bitop3:0xca
    v_mul_hi_u32_u24 v14, 429497, v78
    v_lshrrev_b32 v12, 3, v82
    v_cos_f32 v9, v9
    v_lshlrev_b16 v13, 3, v82
    v_mad_i32_i24 v11, v14, s55, v78
    v_bitop3_b32 v12, v6, v13, v12 bitop3:0xca
    v_lshl_add_u32 v11, v11, 17, s40
    v_lshlrev_b16 v14, 8, v14
    v_lshrrev_b32 v13, 2, v82
    v_add_u32 v78, v12, v11
    v_bitop3_b32 v82, v5, v13, v14 bitop3:0xea
    ds_add_u32 v82, v2
    v_mul_hi_u32_u24 v14, 429497, v79
    v_lshrrev_b32 v12, 3, v83
    v_cos_f32 v10, v10
    v_lshlrev_b16 v13, 3, v83
    v_mad_i32_i24 v11, v14, s55, v79
    v_bitop3_b32 v12, v6, v13, v12 bitop3:0xca
    v_lshl_add_u32 v11, v11, 17, s40
    v_lshlrev_b16 v14, 8, v14
    v_lshrrev_b32 v13, 2, v83
    v_add_u32 v79, v12, v11
    v_bitop3_b32 v83, v5, v13, v14 bitop3:0xea
    ds_add_u32 v83, v2
    v_cvt_pk_bf16_f32 v85, v9, v10
    v_perm_b32 v12, v85, v85, s41
    v_bitop3_b32 v78, v4, v12, v78 bitop3:0xca
    v_perm_b32 v13, v85, v85, s42
    v_bitop3_b32 v79, v4, v13, v79 bitop3:0xca
    s_waitcnt vmcnt(5)
    v_lshlrev_b32 v7, 16, v86
    v_and_b32 v8, 0xffff0000, v86
    v_lshlrev_b32 v9, 16, v87
    v_and_b32 v10, 0xffff0000, v87
    v_mul_f32 v7, 0.15915494, v7
    v_mul_f32 v8, 0.15915494, v8
    v_mul_f32 v9, 0.15915494, v9
    v_mul_f32 v10, 0.15915494, v10
    v_mul_hi_u32_u24 v14, 429497, v88
    v_lshrrev_b32 v12, 3, v92
    v_cos_f32 v7, v7
    v_lshlrev_b16 v13, 3, v92
    v_mad_i32_i24 v11, v14, s55, v88
    v_bitop3_b32 v12, v6, v13, v12 bitop3:0xca
    v_lshl_add_u32 v11, v11, 17, s40
    v_lshlrev_b16 v14, 8, v14
    v_lshrrev_b32 v13, 2, v92
    v_add_u32 v88, v12, v11
    v_bitop3_b32 v92, v5, v13, v14 bitop3:0xea
    ds_add_u32 v92, v2
    v_mul_hi_u32_u24 v14, 429497, v89
    v_lshrrev_b32 v12, 3, v93
    v_cos_f32 v8, v8
    v_lshlrev_b16 v13, 3, v93
    v_mad_i32_i24 v11, v14, s55, v89
    v_bitop3_b32 v12, v6, v13, v12 bitop3:0xca
    v_lshl_add_u32 v11, v11, 17, s40
    v_lshlrev_b16 v14, 8, v14
    v_lshrrev_b32 v13, 2, v93
    v_add_u32 v89, v12, v11
    v_bitop3_b32 v93, v5, v13, v14 bitop3:0xea
    ds_add_u32 v93, v2
    v_cvt_pk_bf16_f32 v86, v7, v8
    v_perm_b32 v12, v86, v86, s41
    v_bitop3_b32 v88, v4, v12, v88 bitop3:0xca
    v_perm_b32 v13, v86, v86, s42
    v_bitop3_b32 v89, v4, v13, v89 bitop3:0xca
    v_mul_hi_u32_u24 v14, 429497, v90
    v_lshrrev_b32 v12, 3, v94
    v_cos_f32 v9, v9
    v_lshlrev_b16 v13, 3, v94
    v_mad_i32_i24 v11, v14, s55, v90
    v_bitop3_b32 v12, v6, v13, v12 bitop3:0xca
    v_lshl_add_u32 v11, v11, 17, s40
    v_lshlrev_b16 v14, 8, v14
    v_lshrrev_b32 v13, 2, v94
    v_add_u32 v90, v12, v11
    v_bitop3_b32 v94, v5, v13, v14 bitop3:0xea
    ds_add_u32 v94, v2
    v_mul_hi_u32_u24 v14, 429497, v91
    v_lshrrev_b32 v12, 3, v95
    v_cos_f32 v10, v10
    v_lshlrev_b16 v13, 3, v95
    v_mad_i32_i24 v11, v14, s55, v91
    v_bitop3_b32 v12, v6, v13, v12 bitop3:0xca
    v_lshl_add_u32 v11, v11, 17, s40
    v_lshlrev_b16 v14, 8, v14
    v_lshrrev_b32 v13, 2, v95
    v_add_u32 v91, v12, v11
    v_bitop3_b32 v95, v5, v13, v14 bitop3:0xea
    ds_add_u32 v95, v2
    v_cvt_pk_bf16_f32 v87, v9, v10
    v_perm_b32 v12, v87, v87, s41
    v_bitop3_b32 v90, v4, v12, v90 bitop3:0xca
    v_perm_b32 v13, v87, v87, s42
    v_bitop3_b32 v91, v4, v13, v91 bitop3:0xca
    v_lshrrev_b32 v8, 2, v0
    v_and_b32 v7, 0x3c00, v0
    v_bitop3_b32 v7, v5, v8, v7 bitop3:0xea
    s_waitcnt lgkmcnt(0)
    s_barrier
    ds_read2st64_b32 v[8:9], v7 offset0:0 offset1:1
    ds_read2st64_b32 v[10:11], v7 offset0:2 offset1:3
    s_add_u32 s45, s96, 0x2400000
    v_lshlrev_b32 v112, 1, v1
    buffer_load_dwordx4 v[112:115], v112, s[12:15], s45 offen nt
    s_waitcnt lgkmcnt(0)
    v_lshl_or_b32 v12, v9, 16, v8
    v_lshl_or_b32 v13, v11, 16, v10
    v_mov_b32 v14, v12
    v_mov_b32 v15, v13
    s_nop 0
    v_add_u32_dpp v14, v14, v14 row_shr:1 row_mask:0xf bank_mask:0xf bound_ctrl:1
    v_add_u32_dpp v15, v15, v15 row_shr:1 row_mask:0xf bank_mask:0xf bound_ctrl:1
    s_nop 0
    v_add_u32_dpp v14, v14, v14 row_shr:2 row_mask:0xf bank_mask:0xf bound_ctrl:1
    v_add_u32_dpp v15, v15, v15 row_shr:2 row_mask:0xf bank_mask:0xf bound_ctrl:1
    s_nop 0
    v_add_u32_dpp v14, v14, v14 row_shr:4 row_mask:0xf bank_mask:0xf bound_ctrl:1
    v_add_u32_dpp v15, v15, v15 row_shr:4 row_mask:0xf bank_mask:0xf bound_ctrl:1
    s_nop 0
    v_add_u32_dpp v14, v14, v14 row_shr:8 row_mask:0xf bank_mask:0xf bound_ctrl:1
    v_add_u32_dpp v15, v15, v15 row_shr:8 row_mask:0xf bank_mask:0xf bound_ctrl:1
    s_nop 0
    v_add_u32_dpp v14, v14, v14 row_bcast:15 row_mask:0xa bank_mask:0xf
    v_add_u32_dpp v15, v15, v15 row_bcast:15 row_mask:0xa bank_mask:0xf
    s_nop 0
    v_add_u32_dpp v14, v14, v14 row_bcast:31 row_mask:0xc bank_mask:0xf
    v_add_u32_dpp v15, v15, v15 row_bcast:31 row_mask:0xc bank_mask:0xf
    v_readlane_b32 s48, v14, 63
    v_readlane_b32 s49, v15, 63
    s_lshl_b32 s54, s32, 2
    v_mov_b32 v8, s54
    s_and_b32 s50, s48, 0xffff
    s_lshr_b32 s51, s48, 16
    s_and_b32 s52, s49, 0xffff
    s_lshr_b32 s53, s49, 16
    s_add_u32 s51, s51, s50
    s_add_u32 s52, s52, s51
    s_add_u32 s53, s53, s52
    v_mov_b32 v9, s53
    s_mov_b64 exec, 1
    ds_write_b32 v8, v9 offset:16384
    s_mov_b64 exec, -1
    v_and_b32 v8, 60, v7
    s_waitcnt lgkmcnt(0)
    s_barrier
    ds_read_b32 v9, v8 offset:16384
    s_waitcnt lgkmcnt(0)
    v_add_u32_dpp v9, v9, v9 row_shr:1 row_mask:0xf bank_mask:0xf bound_ctrl:1
    s_nop 1
    v_add_u32_dpp v9, v9, v9 row_shr:2 row_mask:0xf bank_mask:0xf bound_ctrl:1
    s_nop 1
    v_add_u32_dpp v9, v9, v9 row_shr:4 row_mask:0xf bank_mask:0xf bound_ctrl:1
    s_nop 1
    v_add_u32_dpp v9, v9, v9 row_shr:8 row_mask:0xf bank_mask:0xf bound_ctrl:1
    s_nop 0
    v_readlane_b32 s54, v9, s32
    s_sub_u32 s54, s54, s53
    s_add_u32 s50, s50, s54
    s_add_u32 s51, s51, s54
    s_add_u32 s52, s52, s54
    s_pack_ll_b32_b16 s48, s54, s50
    s_pack_ll_b32_b16 s49, s51, s52
    v_add_u32 v14, s48, v14
    v_add_u32 v15, s49, v15
    v_sub_u32 v12, v14, v12
    v_sub_u32 v13, v15, v13
    v_and_b32 v8, 0xffff, v12
    v_lshrrev_b32 v9, 16, v12
    v_and_b32 v10, 0xffff, v13
    v_lshrrev_b32 v11, 16, v13
    ds_write2st64_b32 v7, v8, v9 offset0:0 offset1:1
    ds_write2st64_b32 v7, v10, v11 offset0:2 offset1:3
    v_and_b32 v8, 0x3f0, v0
    v_lshl_add_u32 v8, v8, 1, s36
    ds_write_b64 v8, v[12:13] offset:20480
    s_bitset0_b64 exec, 63
    s_not_b64 exec, exec
    ds_write_b64 v8, v[14:15] offset:20512
    s_mov_b64 exec, -1
    s_waitcnt lgkmcnt(0)
    s_barrier
    s_setprio 3
    ds_add_rtn_u32 v20, v20, v2
    ds_add_rtn_u32 v21, v21, v2
    ds_add_rtn_u32 v22, v22, v2
    ds_add_rtn_u32 v23, v23, v2
    ds_read_b128 v[12:15], v0 offset:20480
    v_cmp_gt_u32 vcc, 8448, v0
    s_add_u32 s46, s96, 0x2800000
    v_lshlrev_b32 v116, 1, v1
    buffer_load_dwordx4 v[116:119], v116, s[8:11], s46 offen nt
    ds_add_rtn_u32 v32, v32, v2
    ds_add_rtn_u32 v33, v33, v2
    ds_add_rtn_u32 v34, v34, v2
    ds_add_rtn_u32 v35, v35, v2
    s_setprio 2
    ds_add_rtn_u32 v40, v40, v2
    ds_add_rtn_u32 v41, v41, v2
    ds_add_rtn_u32 v42, v42, v2
    ds_add_rtn_u32 v43, v43, v2
    s_waitcnt lgkmcnt(8)
    s_cbranch_vccz L1_p1
    s_add_u32 s47, s35, 0x0
    s_mov_b64 exec, vcc
    buffer_store_dwordx4 v[12:15], v0, s[24:27], s47 offen sc1
    s_mov_b64 exec, -1
L1_p1:
    s_add_u32 s44, s96, 0x2800000
    v_lshlrev_b32 v120, 1, v1
    buffer_load_dwordx4 v[120:123], v120, s[12:15], s44 offen nt
    ds_add_rtn_u32 v52, v52, v2
    ds_add_rtn_u32 v53, v53, v2
    ds_add_rtn_u32 v54, v54, v2
    ds_add_rtn_u32 v55, v55, v2
    s_setprio 1
    ds_add_rtn_u32 v60, v60, v2
    ds_add_rtn_u32 v61, v61, v2
    ds_add_rtn_u32 v62, v62, v2
    ds_add_rtn_u32 v63, v63, v2
    ds_add_rtn_u32 v72, v72, v2
    ds_add_rtn_u32 v73, v73, v2
    ds_add_rtn_u32 v74, v74, v2
    ds_add_rtn_u32 v75, v75, v2
    s_add_u32 s45, s96, 0x2800000
    s_lshr_b32 s45, s45, 1
    buffer_load_dwordx2 v[124:125], v1, s[16:19], s45 offen nt
    s_add_u32 s46, s96, 0x2c00000
    s_lshr_b32 s46, s46, 1
    buffer_load_dwordx2 v[126:127], v1, s[16:19], s46 offen nt
    s_setprio 0
    ds_add_rtn_u32 v80, v80, v2
    ds_add_rtn_u32 v81, v81, v2
    ds_add_rtn_u32 v82, v82, v2
    ds_add_rtn_u32 v83, v83, v2
    ds_add_rtn_u32 v92, v92, v2
    ds_add_rtn_u32 v93, v93, v2
    ds_add_rtn_u32 v94, v94, v2
    ds_add_rtn_u32 v95, v95, v2
    s_waitcnt lgkmcnt(0)
    s_barrier
    s_setprio 3
    v_and_b32 v7, -4, v20
    v_lshl_add_u32 v8, v20, 2, v7
    ds_write_b32 v8, v16
    v_lshl_add_u32 v7, v7, 2, v20
    ds_write_b8 v7, v24 offset:16
    v_and_b32 v9, -4, v21
    v_lshl_add_u32 v10, v21, 2, v9
    ds_write_b32 v10, v17
    v_lshl_add_u32 v9, v9, 2, v21
    ds_write_b8_d16_hi v9, v24 offset:16
    v_and_b32 v7, -4, v22
    v_lshl_add_u32 v8, v22, 2, v7
    ds_write_b32 v8, v18
    v_lshl_add_u32 v7, v7, 2, v22
    ds_write_b8 v7, v25 offset:16
    v_and_b32 v9, -4, v23
    v_lshl_add_u32 v10, v23, 2, v9
    ds_write_b32 v10, v19
    v_lshl_add_u32 v9, v9, 2, v23
    ds_write_b8_d16_hi v9, v25 offset:16
    s_add_u32 s47, s96, 0x2c00000
    v_lshlrev_b32 v16, 1, v1
    buffer_load_dwordx4 v[16:19], v16, s[8:11], s47 offen nt
    s_add_u32 s44, s96, 0x2c00000
    v_lshlrev_b32 v20, 1, v1
    buffer_load_dwordx4 v[20:23], v20, s[12:15], s44 offen nt
    v_and_b32 v7, -4, v32
    v_lshl_add_u32 v8, v32, 2, v7
    ds_write_b32 v8, v28
    v_lshl_add_u32 v7, v7, 2, v32
    ds_write_b8 v7, v26 offset:16
    v_and_b32 v9, -4, v33
    v_lshl_add_u32 v10, v33, 2, v9
    ds_write_b32 v10, v29
    v_lshl_add_u32 v9, v9, 2, v33
    ds_write_b8_d16_hi v9, v26 offset:16
    v_and_b32 v7, -4, v34
    v_lshl_add_u32 v8, v34, 2, v7
    ds_write_b32 v8, v30
    v_lshl_add_u32 v7, v7, 2, v34
    ds_write_b8 v7, v27 offset:16
    v_and_b32 v9, -4, v35
    v_lshl_add_u32 v10, v35, 2, v9
    ds_write_b32 v10, v31
    v_lshl_add_u32 v9, v9, 2, v35
    ds_write_b8_d16_hi v9, v27 offset:16
    s_add_u32 s45, s96, 0x3000000
    v_lshlrev_b32 v28, 1, v1
    buffer_load_dwordx4 v[28:31], v28, s[8:11], s45 offen nt
    s_waitcnt vmcnt(9)
    v_lshlrev_b32 v7, 16, v108
    v_and_b32 v8, 0xffff0000, v108
    v_lshlrev_b32 v9, 16, v109
    v_and_b32 v10, 0xffff0000, v109
    v_mul_f32 v7, 0.15915494, v7
    v_mul_f32 v8, 0.15915494, v8
    v_mul_f32 v9, 0.15915494, v9
    v_mul_f32 v10, 0.15915494, v10
    v_mul_hi_u32_u24 v14, 429497, v96
    v_lshrrev_b32 v12, 3, v104
    v_cos_f32 v7, v7
    v_lshlrev_b16 v13, 3, v104
    v_mad_i32_i24 v11, v14, s55, v96
    v_bitop3_b32 v12, v6, v13, v12 bitop3:0xca
    v_lshl_add_u32 v11, v11, 17, s40
    v_lshlrev_b16 v14, 8, v14
    v_lshrrev_b32 v13, 2, v104
    v_add_u32 v96, v12, v11
    v_bitop3_b32 v104, v5, v13, v14 bitop3:0xea
    v_mul_hi_u32_u24 v14, 429497, v97
    v_lshrrev_b32 v12, 3, v105
    v_cos_f32 v8, v8
    v_lshlrev_b16 v13, 3, v105
    v_mad_i32_i24 v11, v14, s55, v97
    v_bitop3_b32 v12, v6, v13, v12 bitop3:0xca
    v_lshl_add_u32 v11, v11, 17, s40
    v_lshlrev_b16 v14, 8, v14
    v_lshrrev_b32 v13, 2, v105
    v_add_u32 v97, v12, v11
    v_bitop3_b32 v105, v5, v13, v14 bitop3:0xea
    v_cvt_pk_bf16_f32 v108, v7, v8
    v_perm_b32 v12, v108, v108, s41
    v_bitop3_b32 v96, v4, v12, v96 bitop3:0xca
    v_perm_b32 v13, v108, v108, s42
    v_bitop3_b32 v97, v4, v13, v97 bitop3:0xca
    v_mul_hi_u32_u24 v14, 429497, v98
    v_lshrrev_b32 v12, 3, v106
    v_cos_f32 v9, v9
    v_lshlrev_b16 v13, 3, v106
    v_mad_i32_i24 v11, v14, s55, v98
    v_bitop3_b32 v12, v6, v13, v12 bitop3:0xca
    v_lshl_add_u32 v11, v11, 17, s40
    v_lshlrev_b16 v14, 8, v14
    v_lshrrev_b32 v13, 2, v106
    v_add_u32 v98, v12, v11
    v_bitop3_b32 v106, v5, v13, v14 bitop3:0xea
    v_mul_hi_u32_u24 v14, 429497, v99
    v_lshrrev_b32 v12, 3, v107
    v_cos_f32 v10, v10
    v_lshlrev_b16 v13, 3, v107
    v_mad_i32_i24 v11, v14, s55, v99
    v_bitop3_b32 v12, v6, v13, v12 bitop3:0xca
    v_lshl_add_u32 v11, v11, 17, s40
    v_lshlrev_b16 v14, 8, v14
    v_lshrrev_b32 v13, 2, v107
    v_add_u32 v99, v12, v11
    v_bitop3_b32 v107, v5, v13, v14 bitop3:0xea
    v_cvt_pk_bf16_f32 v109, v9, v10
    v_perm_b32 v12, v109, v109, s41
    v_bitop3_b32 v98, v4, v12, v98 bitop3:0xca
    v_perm_b32 v13, v109, v109, s42
    v_bitop3_b32 v99, v4, v13, v99 bitop3:0xca
    s_setprio 2
    v_and_b32 v7, -4, v40
    v_lshl_add_u32 v8, v40, 2, v7
    ds_write_b32 v8, v36
    v_lshl_add_u32 v7, v7, 2, v40
    ds_write_b8 v7, v44 offset:16
    v_and_b32 v9, -4, v41
    v_lshl_add_u32 v10, v41, 2, v9
    ds_write_b32 v10, v37
    v_lshl_add_u32 v9, v9, 2, v41
    ds_write_b8_d16_hi v9, v44 offset:16
    v_and_b32 v7, -4, v42
    v_lshl_add_u32 v8, v42, 2, v7
    ds_write_b32 v8, v38
    v_lshl_add_u32 v7, v7, 2, v42
    ds_write_b8 v7, v45 offset:16
    v_and_b32 v9, -4, v43
    v_lshl_add_u32 v10, v43, 2, v9
    ds_write_b32 v10, v39
    v_lshl_add_u32 v9, v9, 2, v43
    ds_write_b8_d16_hi v9, v45 offset:16
    s_add_u32 s46, s96, 0x3000000
    v_lshlrev_b32 v32, 1, v1
    buffer_load_dwordx4 v[32:35], v32, s[12:15], s46 offen nt
    s_waitcnt vmcnt(8)
    v_lshlrev_b32 v7, 16, v110
    v_and_b32 v8, 0xffff0000, v110
    v_lshlrev_b32 v9, 16, v111
    v_and_b32 v10, 0xffff0000, v111
    v_mul_f32 v7, 0.15915494, v7
    v_mul_f32 v8, 0.15915494, v8
    v_mul_f32 v9, 0.15915494, v9
    v_mul_f32 v10, 0.15915494, v10
    v_mul_hi_u32_u24 v14, 429497, v100
    v_lshrrev_b32 v12, 3, v112
    v_cos_f32 v7, v7
    v_lshlrev_b16 v13, 3, v112
    v_mad_i32_i24 v11, v14, s55, v100
    v_bitop3_b32 v12, v6, v13, v12 bitop3:0xca
    v_lshl_add_u32 v11, v11, 17, s40
    v_lshlrev_b16 v14, 8, v14
    v_lshrrev_b32 v13, 2, v112
    v_add_u32 v100, v12, v11
    v_bitop3_b32 v112, v5, v13, v14 bitop3:0xea
    v_mul_hi_u32_u24 v14, 429497, v101
    v_lshrrev_b32 v12, 3, v113
    v_cos_f32 v8, v8
    v_lshlrev_b16 v13, 3, v113
    v_mad_i32_i24 v11, v14, s55, v101
    v_bitop3_b32 v12, v6, v13, v12 bitop3:0xca
    v_lshl_add_u32 v11, v11, 17, s40
    v_lshlrev_b16 v14, 8, v14
    v_lshrrev_b32 v13, 2, v113
    v_add_u32 v101, v12, v11
    v_bitop3_b32 v113, v5, v13, v14 bitop3:0xea
    v_cvt_pk_bf16_f32 v110, v7, v8
    v_perm_b32 v12, v110, v110, s41
    v_bitop3_b32 v100, v4, v12, v100 bitop3:0xca
    v_perm_b32 v13, v110, v110, s42
    v_bitop3_b32 v101, v4, v13, v101 bitop3:0xca
    v_mul_hi_u32_u24 v14, 429497, v102
    v_lshrrev_b32 v12, 3, v114
    v_cos_f32 v9, v9
    v_lshlrev_b16 v13, 3, v114
    v_mad_i32_i24 v11, v14, s55, v102
    v_bitop3_b32 v12, v6, v13, v12 bitop3:0xca
    v_lshl_add_u32 v11, v11, 17, s40
    v_lshlrev_b16 v14, 8, v14
    v_lshrrev_b32 v13, 2, v114
    v_add_u32 v102, v12, v11
    v_bitop3_b32 v114, v5, v13, v14 bitop3:0xea
    v_mul_hi_u32_u24 v14, 429497, v103
    v_lshrrev_b32 v12, 3, v115
    v_cos_f32 v10, v10
    v_lshlrev_b16 v13, 3, v115
    v_mad_i32_i24 v11, v14, s55, v103
    v_bitop3_b32 v12, v6, v13, v12 bitop3:0xca
    v_lshl_add_u32 v11, v11, 17, s40
    v_lshlrev_b16 v14, 8, v14
    v_lshrrev_b32 v13, 2, v115
    v_add_u32 v103, v12, v11
    v_bitop3_b32 v115, v5, v13, v14 bitop3:0xea
    v_cvt_pk_bf16_f32 v111, v9, v10
    v_perm_b32 v12, v111, v111, s41
    v_bitop3_b32 v102, v4, v12, v102 bitop3:0xca
    v_perm_b32 v13, v111, v111, s42
    v_bitop3_b32 v103, v4, v13, v103 bitop3:0xca
    v_and_b32 v7, -4, v52
    v_lshl_add_u32 v8, v52, 2, v7
    ds_write_b32 v8, v48
    v_lshl_add_u32 v7, v7, 2, v52
    ds_write_b8 v7, v46 offset:16
    v_and_b32 v9, -4, v53
    v_lshl_add_u32 v10, v53, 2, v9
    ds_write_b32 v10, v49
    v_lshl_add_u32 v9, v9, 2, v53
    ds_write_b8_d16_hi v9, v46 offset:16
    v_and_b32 v7, -4, v54
    v_lshl_add_u32 v8, v54, 2, v7
    ds_write_b32 v8, v50
    v_lshl_add_u32 v7, v7, 2, v54
    ds_write_b8 v7, v47 offset:16
    v_and_b32 v9, -4, v55
    v_lshl_add_u32 v10, v55, 2, v9
    ds_write_b32 v10, v51
    v_lshl_add_u32 v9, v9, 2, v55
    ds_write_b8_d16_hi v9, v47 offset:16
    s_add_u32 s47, s96, 0x3000000
    s_lshr_b32 s47, s47, 1
    buffer_load_dwordx2 v[24:25], v1, s[16:19], s47 offen nt
    s_add_u32 s44, s96, 0x3400000
    s_lshr_b32 s44, s44, 1
    buffer_load_dwordx2 v[26:27], v1, s[16:19], s44 offen nt
    s_waitcnt vmcnt(6)
    v_lshlrev_b32 v7, 16, v124
    v_and_b32 v8, 0xffff0000, v124
    v_lshlrev_b32 v9, 16, v125
    v_and_b32 v10, 0xffff0000, v125
    v_mul_f32 v7, 0.15915494, v7
    v_mul_f32 v8, 0.15915494, v8
    v_mul_f32 v9, 0.15915494, v9
    v_mul_f32 v10, 0.15915494, v10
    v_mul_hi_u32_u24 v14, 429497, v116
    v_lshrrev_b32 v12, 3, v120
    v_cos_f32 v7, v7
    v_lshlrev_b16 v13, 3, v120
    v_mad_i32_i24 v11, v14, s55, v116
    v_bitop3_b32 v12, v6, v13, v12 bitop3:0xca
    v_lshl_add_u32 v11, v11, 17, s40
    v_lshlrev_b16 v14, 8, v14
    v_lshrrev_b32 v13, 2, v120
    v_add_u32 v116, v12, v11
    v_bitop3_b32 v120, v5, v13, v14 bitop3:0xea
    v_mul_hi_u32_u24 v14, 429497, v117
    v_lshrrev_b32 v12, 3, v121
    v_cos_f32 v8, v8
    v_lshlrev_b16 v13, 3, v121
    v_mad_i32_i24 v11, v14, s55, v117
    v_bitop3_b32 v12, v6, v13, v12 bitop3:0xca
    v_lshl_add_u32 v11, v11, 17, s40
    v_lshlrev_b16 v14, 8, v14
    v_lshrrev_b32 v13, 2, v121
    v_add_u32 v117, v12, v11
    v_bitop3_b32 v121, v5, v13, v14 bitop3:0xea
    v_cvt_pk_bf16_f32 v124, v7, v8
    v_perm_b32 v12, v124, v124, s41
    v_bitop3_b32 v116, v4, v12, v116 bitop3:0xca
    v_perm_b32 v13, v124, v124, s42
    v_bitop3_b32 v117, v4, v13, v117 bitop3:0xca
    v_mul_hi_u32_u24 v14, 429497, v118
    v_lshrrev_b32 v12, 3, v122
    v_cos_f32 v9, v9
    v_lshlrev_b16 v13, 3, v122
    v_mad_i32_i24 v11, v14, s55, v118
    v_bitop3_b32 v12, v6, v13, v12 bitop3:0xca
    v_lshl_add_u32 v11, v11, 17, s40
    v_lshlrev_b16 v14, 8, v14
    v_lshrrev_b32 v13, 2, v122
    v_add_u32 v118, v12, v11
    v_bitop3_b32 v122, v5, v13, v14 bitop3:0xea
    v_mul_hi_u32_u24 v14, 429497, v119
    v_lshrrev_b32 v12, 3, v123
    v_cos_f32 v10, v10
    v_lshlrev_b16 v13, 3, v123
    v_mad_i32_i24 v11, v14, s55, v119
    v_bitop3_b32 v12, v6, v13, v12 bitop3:0xca
    v_lshl_add_u32 v11, v11, 17, s40
    v_lshlrev_b16 v14, 8, v14
    v_lshrrev_b32 v13, 2, v123
    v_add_u32 v119, v12, v11
    v_bitop3_b32 v123, v5, v13, v14 bitop3:0xea
    v_cvt_pk_bf16_f32 v125, v9, v10
    v_perm_b32 v12, v125, v125, s41
    v_bitop3_b32 v118, v4, v12, v118 bitop3:0xca
    v_perm_b32 v13, v125, v125, s42
    v_bitop3_b32 v119, v4, v13, v119 bitop3:0xca
    s_setprio 1
    v_and_b32 v7, -4, v60
    v_lshl_add_u32 v8, v60, 2, v7
    ds_write_b32 v8, v56
    v_lshl_add_u32 v7, v7, 2, v60
    ds_write_b8 v7, v64 offset:16
    v_and_b32 v9, -4, v61
    v_lshl_add_u32 v10, v61, 2, v9
    ds_write_b32 v10, v57
    v_lshl_add_u32 v9, v9, 2, v61
    ds_write_b8_d16_hi v9, v64 offset:16
    v_and_b32 v7, -4, v62
    v_lshl_add_u32 v8, v62, 2, v7
    ds_write_b32 v8, v58
    v_lshl_add_u32 v7, v7, 2, v62
    ds_write_b8 v7, v65 offset:16
    v_and_b32 v9, -4, v63
    v_lshl_add_u32 v10, v63, 2, v9
    ds_write_b32 v10, v59
    v_lshl_add_u32 v9, v9, 2, v63
    ds_write_b8_d16_hi v9, v65 offset:16
    s_add_u32 s45, s96, 0x3400000
    v_lshlrev_b32 v36, 1, v1
    buffer_load_dwordx4 v[36:39], v36, s[8:11], s45 offen nt
    s_add_u32 s46, s96, 0x3400000
    v_lshlrev_b32 v40, 1, v1
    buffer_load_dwordx4 v[40:43], v40, s[12:15], s46 offen nt
    v_and_b32 v7, -4, v72
    v_lshl_add_u32 v8, v72, 2, v7
    ds_write_b32 v8, v68
    v_lshl_add_u32 v7, v7, 2, v72
    ds_write_b8 v7, v66 offset:16
    v_and_b32 v9, -4, v73
    v_lshl_add_u32 v10, v73, 2, v9
    ds_write_b32 v10, v69
    v_lshl_add_u32 v9, v9, 2, v73
    ds_write_b8_d16_hi v9, v66 offset:16
    v_and_b32 v7, -4, v74
    v_lshl_add_u32 v8, v74, 2, v7
    ds_write_b32 v8, v70
    v_lshl_add_u32 v7, v7, 2, v74
    ds_write_b8 v7, v67 offset:16
    v_and_b32 v9, -4, v75
    v_lshl_add_u32 v10, v75, 2, v9
    ds_write_b32 v10, v71
    v_lshl_add_u32 v9, v9, 2, v75
    ds_write_b8_d16_hi v9, v67 offset:16
    s_add_u32 s47, s96, 0x3800000
    v_lshlrev_b32 v48, 1, v1
    buffer_load_dwordx4 v[48:51], v48, s[8:11], s47 offen nt
    s_waitcnt vmcnt(7)
    v_lshlrev_b32 v7, 16, v126
    v_and_b32 v8, 0xffff0000, v126
    v_lshlrev_b32 v9, 16, v127
    v_and_b32 v10, 0xffff0000, v127
    v_mul_f32 v7, 0.15915494, v7
    v_mul_f32 v8, 0.15915494, v8
    v_mul_f32 v9, 0.15915494, v9
    v_mul_f32 v10, 0.15915494, v10
    v_mul_hi_u32_u24 v14, 429497, v16
    v_lshrrev_b32 v12, 3, v20
    v_cos_f32 v7, v7
    v_lshlrev_b16 v13, 3, v20
    v_mad_i32_i24 v11, v14, s55, v16
    v_bitop3_b32 v12, v6, v13, v12 bitop3:0xca
    v_lshl_add_u32 v11, v11, 17, s40
    v_lshlrev_b16 v14, 8, v14
    v_lshrrev_b32 v13, 2, v20
    v_add_u32 v16, v12, v11
    v_bitop3_b32 v20, v5, v13, v14 bitop3:0xea
    v_mul_hi_u32_u24 v14, 429497, v17
    v_lshrrev_b32 v12, 3, v21
    v_cos_f32 v8, v8
    v_lshlrev_b16 v13, 3, v21
    v_mad_i32_i24 v11, v14, s55, v17
    v_bitop3_b32 v12, v6, v13, v12 bitop3:0xca
    v_lshl_add_u32 v11, v11, 17, s40
    v_lshlrev_b16 v14, 8, v14
    v_lshrrev_b32 v13, 2, v21
    v_add_u32 v17, v12, v11
    v_bitop3_b32 v21, v5, v13, v14 bitop3:0xea
    v_cvt_pk_bf16_f32 v126, v7, v8
    v_perm_b32 v12, v126, v126, s41
    v_bitop3_b32 v16, v4, v12, v16 bitop3:0xca
    v_perm_b32 v13, v126, v126, s42
    v_bitop3_b32 v17, v4, v13, v17 bitop3:0xca
    v_mul_hi_u32_u24 v14, 429497, v18
    v_lshrrev_b32 v12, 3, v22
    v_cos_f32 v9, v9
    v_lshlrev_b16 v13, 3, v22
    v_mad_i32_i24 v11, v14, s55, v18
    v_bitop3_b32 v12, v6, v13, v12 bitop3:0xca
    v_lshl_add_u32 v11, v11, 17, s40
    v_lshlrev_b16 v14, 8, v14
    v_lshrrev_b32 v13, 2, v22
    v_add_u32 v18, v12, v11
    v_bitop3_b32 v22, v5, v13, v14 bitop3:0xea
    v_mul_hi_u32_u24 v14, 429497, v19
    v_lshrrev_b32 v12, 3, v23
    v_cos_f32 v10, v10
    v_lshlrev_b16 v13, 3, v23
    v_mad_i32_i24 v11, v14, s55, v19
    v_bitop3_b32 v12, v6, v13, v12 bitop3:0xca
    v_lshl_add_u32 v11, v11, 17, s40
    v_lshlrev_b16 v14, 8, v14
    v_lshrrev_b32 v13, 2, v23
    v_add_u32 v19, v12, v11
    v_bitop3_b32 v23, v5, v13, v14 bitop3:0xea
    v_cvt_pk_bf16_f32 v127, v9, v10
    v_perm_b32 v12, v127, v127, s41
    v_bitop3_b32 v18, v4, v12, v18 bitop3:0xca
    v_perm_b32 v13, v127, v127, s42
    v_bitop3_b32 v19, v4, v13, v19 bitop3:0xca
    s_setprio 0
    v_and_b32 v7, -4, v80
    v_lshl_add_u32 v8, v80, 2, v7
    ds_write_b32 v8, v76
    v_lshl_add_u32 v7, v7, 2, v80
    ds_write_b8 v7, v84 offset:16
    v_and_b32 v9, -4, v81
    v_lshl_add_u32 v10, v81, 2, v9
    ds_write_b32 v10, v77
    v_lshl_add_u32 v9, v9, 2, v81
    ds_write_b8_d16_hi v9, v84 offset:16
    v_and_b32 v7, -4, v82
    v_lshl_add_u32 v8, v82, 2, v7
    ds_write_b32 v8, v78
    v_lshl_add_u32 v7, v7, 2, v82
    ds_write_b8 v7, v85 offset:16
    v_and_b32 v9, -4, v83
    v_lshl_add_u32 v10, v83, 2, v9
    ds_write_b32 v10, v79
    v_lshl_add_u32 v9, v9, 2, v83
    ds_write_b8_d16_hi v9, v85 offset:16
    s_add_u32 s44, s96, 0x3800000
    v_lshlrev_b32 v52, 1, v1
    buffer_load_dwordx4 v[52:55], v52, s[12:15], s44 offen nt
    s_waitcnt vmcnt(4)
    v_lshlrev_b32 v7, 16, v24
    v_and_b32 v8, 0xffff0000, v24
    v_lshlrev_b32 v9, 16, v25
    v_and_b32 v10, 0xffff0000, v25
    v_mul_f32 v7, 0.15915494, v7
    v_mul_f32 v8, 0.15915494, v8
    v_mul_f32 v9, 0.15915494, v9
    v_mul_f32 v10, 0.15915494, v10
    v_mul_hi_u32_u24 v14, 429497, v28
    v_lshrrev_b32 v12, 3, v32
    v_cos_f32 v7, v7
    v_lshlrev_b16 v13, 3, v32
    v_mad_i32_i24 v11, v14, s55, v28
    v_bitop3_b32 v12, v6, v13, v12 bitop3:0xca
    v_lshl_add_u32 v11, v11, 17, s40
    v_lshlrev_b16 v14, 8, v14
    v_lshrrev_b32 v13, 2, v32
    v_add_u32 v28, v12, v11
    v_bitop3_b32 v32, v5, v13, v14 bitop3:0xea
    v_mul_hi_u32_u24 v14, 429497, v29
    v_lshrrev_b32 v12, 3, v33
    v_cos_f32 v8, v8
    v_lshlrev_b16 v13, 3, v33
    v_mad_i32_i24 v11, v14, s55, v29
    v_bitop3_b32 v12, v6, v13, v12 bitop3:0xca
    v_lshl_add_u32 v11, v11, 17, s40
    v_lshlrev_b16 v14, 8, v14
    v_lshrrev_b32 v13, 2, v33
    v_add_u32 v29, v12, v11
    v_bitop3_b32 v33, v5, v13, v14 bitop3:0xea
    v_cvt_pk_bf16_f32 v24, v7, v8
    v_perm_b32 v12, v24, v24, s41
    v_bitop3_b32 v28, v4, v12, v28 bitop3:0xca
    v_perm_b32 v13, v24, v24, s42
    v_bitop3_b32 v29, v4, v13, v29 bitop3:0xca
    v_mul_hi_u32_u24 v14, 429497, v30
    v_lshrrev_b32 v12, 3, v34
    v_cos_f32 v9, v9
    v_lshlrev_b16 v13, 3, v34
    v_mad_i32_i24 v11, v14, s55, v30
    v_bitop3_b32 v12, v6, v13, v12 bitop3:0xca
    v_lshl_add_u32 v11, v11, 17, s40
    v_lshlrev_b16 v14, 8, v14
    v_lshrrev_b32 v13, 2, v34
    v_add_u32 v30, v12, v11
    v_bitop3_b32 v34, v5, v13, v14 bitop3:0xea
    v_mul_hi_u32_u24 v14, 429497, v31
    v_lshrrev_b32 v12, 3, v35
    v_cos_f32 v10, v10
    v_lshlrev_b16 v13, 3, v35
    v_mad_i32_i24 v11, v14, s55, v31
    v_bitop3_b32 v12, v6, v13, v12 bitop3:0xca
    v_lshl_add_u32 v11, v11, 17, s40
    v_lshlrev_b16 v14, 8, v14
    v_lshrrev_b32 v13, 2, v35
    v_add_u32 v31, v12, v11
    v_bitop3_b32 v35, v5, v13, v14 bitop3:0xea
    v_cvt_pk_bf16_f32 v25, v9, v10
    v_perm_b32 v12, v25, v25, s41
    v_bitop3_b32 v30, v4, v12, v30 bitop3:0xca
    v_perm_b32 v13, v25, v25, s42
    v_bitop3_b32 v31, v4, v13, v31 bitop3:0xca
    v_and_b32 v7, -4, v92
    v_lshl_add_u32 v8, v92, 2, v7
    ds_write_b32 v8, v88
    v_lshl_add_u32 v7, v7, 2, v92
    ds_write_b8 v7, v86 offset:16
    v_and_b32 v9, -4, v93
    v_lshl_add_u32 v10, v93, 2, v9
    ds_write_b32 v10, v89
    v_lshl_add_u32 v9, v9, 2, v93
    ds_write_b8_d16_hi v9, v86 offset:16
    v_and_b32 v7, -4, v94
    v_lshl_add_u32 v8, v94, 2, v7
    ds_write_b32 v8, v90
    v_lshl_add_u32 v7, v7, 2, v94
    ds_write_b8 v7, v87 offset:16
    v_and_b32 v9, -4, v95
    v_lshl_add_u32 v10, v95, 2, v9
    ds_write_b32 v10, v91
    v_lshl_add_u32 v9, v9, 2, v95
    ds_write_b8_d16_hi v9, v87 offset:16
    s_add_u32 s45, s96, 0x3800000
    s_lshr_b32 s45, s45, 1
    buffer_load_dwordx2 v[44:45], v1, s[16:19], s45 offen nt
    s_add_u32 s46, s96, 0x3c00000
    s_lshr_b32 s46, s46, 1
    buffer_load_dwordx2 v[46:47], v1, s[16:19], s46 offen nt
    s_waitcnt vmcnt(4)
    v_lshlrev_b32 v7, 16, v26
    v_and_b32 v8, 0xffff0000, v26
    v_lshlrev_b32 v9, 16, v27
    v_and_b32 v10, 0xffff0000, v27
    v_mul_f32 v7, 0.15915494, v7
    v_mul_f32 v8, 0.15915494, v8
    v_mul_f32 v9, 0.15915494, v9
    v_mul_f32 v10, 0.15915494, v10
    v_mul_hi_u32_u24 v14, 429497, v36
    v_lshrrev_b32 v12, 3, v40
    v_cos_f32 v7, v7
    v_lshlrev_b16 v13, 3, v40
    v_mad_i32_i24 v11, v14, s55, v36
    v_bitop3_b32 v12, v6, v13, v12 bitop3:0xca
    v_lshl_add_u32 v11, v11, 17, s40
    v_lshlrev_b16 v14, 8, v14
    v_lshrrev_b32 v13, 2, v40
    v_add_u32 v36, v12, v11
    v_bitop3_b32 v40, v5, v13, v14 bitop3:0xea
    v_mul_hi_u32_u24 v14, 429497, v37
    v_lshrrev_b32 v12, 3, v41
    v_cos_f32 v8, v8
    v_lshlrev_b16 v13, 3, v41
    v_mad_i32_i24 v11, v14, s55, v37
    v_bitop3_b32 v12, v6, v13, v12 bitop3:0xca
    v_lshl_add_u32 v11, v11, 17, s40
    v_lshlrev_b16 v14, 8, v14
    v_lshrrev_b32 v13, 2, v41
    v_add_u32 v37, v12, v11
    v_bitop3_b32 v41, v5, v13, v14 bitop3:0xea
    v_cvt_pk_bf16_f32 v26, v7, v8
    v_perm_b32 v12, v26, v26, s41
    v_bitop3_b32 v36, v4, v12, v36 bitop3:0xca
    v_perm_b32 v13, v26, v26, s42
    v_bitop3_b32 v37, v4, v13, v37 bitop3:0xca
    v_mul_hi_u32_u24 v14, 429497, v38
    v_lshrrev_b32 v12, 3, v42
    v_cos_f32 v9, v9
    v_lshlrev_b16 v13, 3, v42
    v_mad_i32_i24 v11, v14, s55, v38
    v_bitop3_b32 v12, v6, v13, v12 bitop3:0xca
    v_lshl_add_u32 v11, v11, 17, s40
    v_lshlrev_b16 v14, 8, v14
    v_lshrrev_b32 v13, 2, v42
    v_add_u32 v38, v12, v11
    v_bitop3_b32 v42, v5, v13, v14 bitop3:0xea
    v_mul_hi_u32_u24 v14, 429497, v39
    v_lshrrev_b32 v12, 3, v43
    v_cos_f32 v10, v10
    v_lshlrev_b16 v13, 3, v43
    v_mad_i32_i24 v11, v14, s55, v39
    v_bitop3_b32 v12, v6, v13, v12 bitop3:0xca
    v_lshl_add_u32 v11, v11, 17, s40
    v_lshlrev_b16 v14, 8, v14
    v_lshrrev_b32 v13, 2, v43
    v_add_u32 v39, v12, v11
    v_bitop3_b32 v43, v5, v13, v14 bitop3:0xea
    v_cvt_pk_bf16_f32 v27, v9, v10
    v_perm_b32 v12, v27, v27, s41
    v_bitop3_b32 v38, v4, v12, v38 bitop3:0xca
    v_perm_b32 v13, v27, v27, s42
    v_bitop3_b32 v39, v4, v13, v39 bitop3:0xca
    v_add_u32 v7, s72, v0
    v_add_u32 v12, s73, v0
    v_add_u32 v13, s85, v0
    v_add_u32 v14, s91, v0
    v_add_u32 v15, s93, v0
    s_min_i32 s3, s72, s73
    s_min_i32 s3, s3, s85
    s_min_i32 s3, s3, s91
    s_min_i32 s3, s3, s93
    v_add_u32 v3, s3, v0
    v_mov_b32 v8, 0
    v_mov_b32 v9, 0
    v_mov_b32 v10, 0
    v_mov_b32 v11, 0
    s_waitcnt lgkmcnt(0)
    s_barrier
    ds_read_b128 v[56:59], v7 offset:0
    ds_read_b128 v[60:63], v12 offset:0
    ds_read_b128 v[68:71], v13 offset:0
    ds_read_b128 v[72:75], v14 offset:0
    ds_read_b128 v[64:67], v15 offset:0
    ds_write_b128 v3, v[8:11]
    ds_read_b128 v[76:79], v7 offset:16384
    ds_read_b128 v[80:83], v12 offset:16384
    ds_read_b128 v[88:91], v13 offset:16384
    ds_read_b128 v[92:95], v14 offset:16384
    ds_read_b128 v[84:87], v15 offset:16384
    s_waitcnt lgkmcnt(0)
    s_barrier
    s_setprio 3
    s_add_u32 s47, s35, 0x4000
    s_add_u32 s47, s47, s72
    buffer_store_dwordx4 v[56:59], v0, s[20:23], s47 offen sc1
    s_add_u32 s44, s96, 0x3c00000
    s_nop 0
    v_lshlrev_b32 v56, 1, v1
    buffer_load_dwordx4 v[56:59], v56, s[8:11], s44 offen nt
    s_add_u32 s45, s35, 0x4000
    s_add_u32 s45, s45, s73
    buffer_store_dwordx4 v[60:63], v0, s[20:23], s45 offen sc1
    s_add_u32 s46, s96, 0x3c00000
    s_nop 0
    v_lshlrev_b32 v60, 1, v1
    buffer_load_dwordx4 v[60:63], v60, s[12:15], s46 offen nt
    ds_add_u32 v104, v2
    ds_add_u32 v105, v2
    ds_add_u32 v106, v2
    ds_add_u32 v107, v2
    ds_add_u32 v112, v2
    ds_add_u32 v113, v2
    ds_add_u32 v114, v2
    ds_add_u32 v115, v2
    s_setprio 2
    ds_add_u32 v120, v2
    ds_add_u32 v121, v2
    ds_add_u32 v122, v2
    ds_add_u32 v123, v2
    ds_add_u32 v20, v2
    ds_add_u32 v21, v2
    ds_add_u32 v22, v2
    ds_add_u32 v23, v2
    s_setprio 1
    s_add_u32 s47, s35, 0x4000
    s_add_u32 s47, s47, s85
    buffer_store_dwordx4 v[68:71], v0, s[20:23], s47 offen sc1
    s_add_u32 s44, s96, 0x4000000
    s_nop 0
    v_lshlrev_b32 v68, 1, v1
    buffer_load_dwordx4 v[68:71], v68, s[8:11], s44 offen nt
    ds_add_u32 v32, v2
    ds_add_u32 v33, v2
    ds_add_u32 v34, v2
    ds_add_u32 v35, v2
    ds_add_u32 v40, v2
    ds_add_u32 v41, v2
    ds_add_u32 v42, v2
    ds_add_u32 v43, v2
    s_setprio 0
    s_waitcnt vmcnt(6)
    v_lshlrev_b32 v7, 16, v44
    v_and_b32 v8, 0xffff0000, v44
    v_lshlrev_b32 v9, 16, v45
    v_and_b32 v10, 0xffff0000, v45
    v_mul_f32 v7, 0.15915494, v7
    v_mul_f32 v8, 0.15915494, v8
    v_mul_f32 v9, 0.15915494, v9
    v_mul_f32 v10, 0.15915494, v10
    v_mul_hi_u32_u24 v14, 429497, v48
    v_lshrrev_b32 v12, 3, v52
    v_cos_f32 v7, v7
    v_lshlrev_b16 v13, 3, v52
    v_mad_i32_i24 v11, v14, s55, v48
    v_bitop3_b32 v12, v6, v13, v12 bitop3:0xca
    v_lshl_add_u32 v11, v11, 17, s40
    v_lshlrev_b16 v14, 8, v14
    v_lshrrev_b32 v13, 2, v52
    v_add_u32 v48, v12, v11
    v_bitop3_b32 v52, v5, v13, v14 bitop3:0xea
    ds_add_u32 v52, v2
    v_mul_hi_u32_u24 v14, 429497, v49
    v_lshrrev_b32 v12, 3, v53
    v_cos_f32 v8, v8
    v_lshlrev_b16 v13, 3, v53
    v_mad_i32_i24 v11, v14, s55, v49
    v_bitop3_b32 v12, v6, v13, v12 bitop3:0xca
    v_lshl_add_u32 v11, v11, 17, s40
    v_lshlrev_b16 v14, 8, v14
    v_lshrrev_b32 v13, 2, v53
    v_add_u32 v49, v12, v11
    v_bitop3_b32 v53, v5, v13, v14 bitop3:0xea
    ds_add_u32 v53, v2
    v_cvt_pk_bf16_f32 v44, v7, v8
    v_perm_b32 v12, v44, v44, s41
    v_bitop3_b32 v48, v4, v12, v48 bitop3:0xca
    v_perm_b32 v13, v44, v44, s42
    v_bitop3_b32 v49, v4, v13, v49 bitop3:0xca
    v_mul_hi_u32_u24 v14, 429497, v50
    v_lshrrev_b32 v12, 3, v54
    v_cos_f32 v9, v9
    v_lshlrev_b16 v13, 3, v54
    v_mad_i32_i24 v11, v14, s55, v50
    v_bitop3_b32 v12, v6, v13, v12 bitop3:0xca
    v_lshl_add_u32 v11, v11, 17, s40
    v_lshlrev_b16 v14, 8, v14
    v_lshrrev_b32 v13, 2, v54
    v_add_u32 v50, v12, v11
    v_bitop3_b32 v54, v5, v13, v14 bitop3:0xea
    ds_add_u32 v54, v2
    v_mul_hi_u32_u24 v14, 429497, v51
    v_lshrrev_b32 v12, 3, v55
    v_cos_f32 v10, v10
    v_lshlrev_b16 v13, 3, v55
    v_mad_i32_i24 v11, v14, s55, v51
    v_bitop3_b32 v12, v6, v13, v12 bitop3:0xca
    v_lshl_add_u32 v11, v11, 17, s40
    v_lshlrev_b16 v14, 8, v14
    v_lshrrev_b32 v13, 2, v55
    v_add_u32 v51, v12, v11
    v_bitop3_b32 v55, v5, v13, v14 bitop3:0xea
    ds_add_u32 v55, v2
    v_cvt_pk_bf16_f32 v45, v9, v10
    v_perm_b32 v12, v45, v45, s41
    v_bitop3_b32 v50, v4, v12, v50 bitop3:0xca
    v_perm_b32 v13, v45, v45, s42
    v_bitop3_b32 v51, v4, v13, v51 bitop3:0xca
    s_waitcnt vmcnt(2)
    v_lshlrev_b32 v7, 16, v46
    v_and_b32 v8, 0xffff0000, v46
    v_lshlrev_b32 v9, 16, v47
    v_and_b32 v10, 0xffff0000, v47
    v_mul_f32 v7, 0.15915494, v7
    v_mul_f32 v8, 0.15915494, v8
    v_mul_f32 v9, 0.15915494, v9
    v_mul_f32 v10, 0.15915494, v10
    v_mul_hi_u32_u24 v14, 429497, v56
    v_lshrrev_b32 v12, 3, v60
    v_cos_f32 v7, v7
    v_lshlrev_b16 v13, 3, v60
    v_mad_i32_i24 v11, v14, s55, v56
    v_bitop3_b32 v12, v6, v13, v12 bitop3:0xca
    v_lshl_add_u32 v11, v11, 17, s40
    v_lshlrev_b16 v14, 8, v14
    v_lshrrev_b32 v13, 2, v60
    v_add_u32 v56, v12, v11
    v_bitop3_b32 v60, v5, v13, v14 bitop3:0xea
    ds_add_u32 v60, v2
    v_mul_hi_u32_u24 v14, 429497, v57
    v_lshrrev_b32 v12, 3, v61
    v_cos_f32 v8, v8
    v_lshlrev_b16 v13, 3, v61
    v_mad_i32_i24 v11, v14, s55, v57
    v_bitop3_b32 v12, v6, v13, v12 bitop3:0xca
    v_lshl_add_u32 v11, v11, 17, s40
    v_lshlrev_b16 v14, 8, v14
    v_lshrrev_b32 v13, 2, v61
    v_add_u32 v57, v12, v11
    v_bitop3_b32 v61, v5, v13, v14 bitop3:0xea
    ds_add_u32 v61, v2
    v_cvt_pk_bf16_f32 v46, v7, v8
    v_perm_b32 v12, v46, v46, s41
    v_bitop3_b32 v56, v4, v12, v56 bitop3:0xca
    v_perm_b32 v13, v46, v46, s42
    v_bitop3_b32 v57, v4, v13, v57 bitop3:0xca
    v_mul_hi_u32_u24 v14, 429497, v58
    v_lshrrev_b32 v12, 3, v62
    v_cos_f32 v9, v9
    v_lshlrev_b16 v13, 3, v62
    v_mad_i32_i24 v11, v14, s55, v58
    v_bitop3_b32 v12, v6, v13, v12 bitop3:0xca
    v_lshl_add_u32 v11, v11, 17, s40
    v_lshlrev_b16 v14, 8, v14
    v_lshrrev_b32 v13, 2, v62
    v_add_u32 v58, v12, v11
    v_bitop3_b32 v62, v5, v13, v14 bitop3:0xea
    ds_add_u32 v62, v2
    v_mul_hi_u32_u24 v14, 429497, v59
    v_lshrrev_b32 v12, 3, v63
    v_cos_f32 v10, v10
    v_lshlrev_b16 v13, 3, v63
    v_mad_i32_i24 v11, v14, s55, v59
    v_bitop3_b32 v12, v6, v13, v12 bitop3:0xca
    v_lshl_add_u32 v11, v11, 17, s40
    v_lshlrev_b16 v14, 8, v14
    v_lshrrev_b32 v13, 2, v63
    v_add_u32 v59, v12, v11
    v_bitop3_b32 v63, v5, v13, v14 bitop3:0xea
    ds_add_u32 v63, v2
    v_cvt_pk_bf16_f32 v47, v9, v10
    v_perm_b32 v12, v47, v47, s41
    v_bitop3_b32 v58, v4, v12, v58 bitop3:0xca
    v_perm_b32 v13, v47, v47, s42
    v_bitop3_b32 v59, v4, v13, v59 bitop3:0xca
    v_lshrrev_b32 v8, 2, v0
    v_and_b32 v7, 0x3c00, v0
    v_bitop3_b32 v7, v5, v8, v7 bitop3:0xea
    s_waitcnt lgkmcnt(0)
    s_barrier
    ds_read2st64_b32 v[8:9], v7 offset0:0 offset1:1
    ds_read2st64_b32 v[10:11], v7 offset0:2 offset1:3
    s_add_u32 s45, s35, 0x4000
    s_add_u32 s45, s45, s91
    buffer_store_dwordx4 v[72:75], v0, s[20:23], s45 offen sc1
    s_add_u32 s46, s96, 0x4000000
    s_nop 0
    v_lshlrev_b32 v72, 1, v1
    buffer_load_dwordx4 v[72:75], v72, s[12:15], s46 offen nt
    s_waitcnt lgkmcnt(0)
    v_lshl_or_b32 v12, v9, 16, v8
    v_lshl_or_b32 v13, v11, 16, v10
    v_mov_b32 v14, v12
    v_mov_b32 v15, v13
    s_nop 0
    v_add_u32_dpp v14, v14, v14 row_shr:1 row_mask:0xf bank_mask:0xf bound_ctrl:1
    v_add_u32_dpp v15, v15, v15 row_shr:1 row_mask:0xf bank_mask:0xf bound_ctrl:1
    s_nop 0
    v_add_u32_dpp v14, v14, v14 row_shr:2 row_mask:0xf bank_mask:0xf bound_ctrl:1
    v_add_u32_dpp v15, v15, v15 row_shr:2 row_mask:0xf bank_mask:0xf bound_ctrl:1
    s_nop 0
    v_add_u32_dpp v14, v14, v14 row_shr:4 row_mask:0xf bank_mask:0xf bound_ctrl:1
    v_add_u32_dpp v15, v15, v15 row_shr:4 row_mask:0xf bank_mask:0xf bound_ctrl:1
    s_nop 0
    v_add_u32_dpp v14, v14, v14 row_shr:8 row_mask:0xf bank_mask:0xf bound_ctrl:1
    v_add_u32_dpp v15, v15, v15 row_shr:8 row_mask:0xf bank_mask:0xf bound_ctrl:1
    s_nop 0
    v_add_u32_dpp v14, v14, v14 row_bcast:15 row_mask:0xa bank_mask:0xf
    v_add_u32_dpp v15, v15, v15 row_bcast:15 row_mask:0xa bank_mask:0xf
    s_nop 0
    v_add_u32_dpp v14, v14, v14 row_bcast:31 row_mask:0xc bank_mask:0xf
    v_add_u32_dpp v15, v15, v15 row_bcast:31 row_mask:0xc bank_mask:0xf
    v_readlane_b32 s48, v14, 63
    v_readlane_b32 s49, v15, 63
    s_lshl_b32 s54, s32, 2
    v_mov_b32 v8, s54
    s_and_b32 s50, s48, 0xffff
    s_lshr_b32 s51, s48, 16
    s_and_b32 s52, s49, 0xffff
    s_lshr_b32 s53, s49, 16
    s_add_u32 s51, s51, s50
    s_add_u32 s52, s52, s51
    s_add_u32 s53, s53, s52
    v_mov_b32 v9, s53
    s_mov_b64 exec, 1
    ds_write_b32 v8, v9 offset:16384
    s_mov_b64 exec, -1
    v_and_b32 v8, 60, v7
    s_waitcnt lgkmcnt(0)
    s_barrier
    ds_read_b32 v9, v8 offset:16384
    s_waitcnt lgkmcnt(0)
    v_add_u32_dpp v9, v9, v9 row_shr:1 row_mask:0xf bank_mask:0xf bound_ctrl:1
    s_nop 1
    v_add_u32_dpp v9, v9, v9 row_shr:2 row_mask:0xf bank_mask:0xf bound_ctrl:1
    s_nop 1
    v_add_u32_dpp v9, v9, v9 row_shr:4 row_mask:0xf bank_mask:0xf bound_ctrl:1
    s_nop 1
    v_add_u32_dpp v9, v9, v9 row_shr:8 row_mask:0xf bank_mask:0xf bound_ctrl:1
    s_nop 0
    v_readlane_b32 s54, v9, s32
    s_sub_u32 s54, s54, s53
    s_add_u32 s50, s50, s54
    s_add_u32 s51, s51, s54
    s_add_u32 s52, s52, s54
    s_pack_ll_b32_b16 s48, s54, s50
    s_pack_ll_b32_b16 s49, s51, s52
    v_add_u32 v14, s48, v14
    v_add_u32 v15, s49, v15
    v_sub_u32 v12, v14, v12
    v_sub_u32 v13, v15, v13
    v_and_b32 v8, 0xffff, v12
    v_lshrrev_b32 v9, 16, v12
    v_and_b32 v10, 0xffff, v13
    v_lshrrev_b32 v11, 16, v13
    ds_write2st64_b32 v7, v8, v9 offset0:0 offset1:1
    ds_write2st64_b32 v7, v10, v11 offset0:2 offset1:3
    v_and_b32 v8, 0x3f0, v0
    v_lshl_add_u32 v8, v8, 1, s36
    ds_write_b64 v8, v[12:13] offset:20480
    s_bitset0_b64 exec, 63
    s_not_b64 exec, exec
    ds_write_b64 v8, v[14:15] offset:20512
    s_mov_b64 exec, -1
    s_waitcnt lgkmcnt(0)
    s_barrier
    s_setprio 3
    ds_add_rtn_u32 v104, v104, v2
    ds_add_rtn_u32 v105, v105, v2
    ds_add_rtn_u32 v106, v106, v2
    ds_add_rtn_u32 v107, v107, v2
    ds_read_b128 v[12:15], v0 offset:20480
    v_cmp_gt_u32 vcc, 8448, v0
    s_add_u32 s47, s35, 0x4000
    s_add_u32 s47, s47, s93
    buffer_store_dwordx4 v[64:67], v0, s[20:23], s47 offen sc1
    s_add_u32 s44, s96, 0x4000000
    s_lshr_b32 s44, s44, 1
    buffer_load_dwordx2 v[64:65], v1, s[16:19], s44 offen nt
    s_add_u32 s45, s96, 0x4400000
    s_lshr_b32 s45, s45, 1
    buffer_load_dwordx2 v[66:67], v1, s[16:19], s45 offen nt
    ds_add_rtn_u32 v112, v112, v2
    ds_add_rtn_u32 v113, v113, v2
    ds_add_rtn_u32 v114, v114, v2
    ds_add_rtn_u32 v115, v115, v2
    s_setprio 2
    ds_add_rtn_u32 v120, v120, v2
    ds_add_rtn_u32 v121, v121, v2
    ds_add_rtn_u32 v122, v122, v2
    ds_add_rtn_u32 v123, v123, v2
    s_waitcnt lgkmcnt(8)
    s_cbranch_vccz L1_p2
    s_add_u32 s46, s35, 0x2a40000
    s_mov_b64 exec, vcc
    buffer_store_dwordx4 v[12:15], v0, s[24:27], s46 offen sc1
    s_mov_b64 exec, -1
L1_p2:
    s_add_u32 s47, s35, 0x8000
    s_add_u32 s47, s47, s72
    buffer_store_dwordx4 v[76:79], v0, s[20:23], s47 offen sc1
    s_add_u32 s44, s96, 0x4400000
    s_nop 0
    v_lshlrev_b32 v76, 1, v1
    buffer_load_dwordx4 v[76:79], v76, s[8:11], s44 offen nt
    ds_add_rtn_u32 v20, v20, v2
    ds_add_rtn_u32 v21, v21, v2
    ds_add_rtn_u32 v22, v22, v2
    ds_add_rtn_u32 v23, v23, v2
    s_setprio 1
    ds_add_rtn_u32 v32, v32, v2
    ds_add_rtn_u32 v33, v33, v2
    ds_add_rtn_u32 v34, v34, v2
    ds_add_rtn_u32 v35, v35, v2
    ds_add_rtn_u32 v40, v40, v2
    ds_add_rtn_u32 v41, v41, v2
    ds_add_rtn_u32 v42, v42, v2
    ds_add_rtn_u32 v43, v43, v2
    s_add_u32 s45, s35, 0x8000
    s_add_u32 s45, s45, s73
    buffer_store_dwordx4 v[80:83], v0, s[20:23], s45 offen sc1
    s_add_u32 s46, s96, 0x4400000
    s_nop 0
    v_lshlrev_b32 v80, 1, v1
    buffer_load_dwordx4 v[80:83], v80, s[12:15], s46 offen nt
    s_setprio 0
    ds_add_rtn_u32 v52, v52, v2
    ds_add_rtn_u32 v53, v53, v2
    ds_add_rtn_u32 v54, v54, v2
    ds_add_rtn_u32 v55, v55, v2
    ds_add_rtn_u32 v60, v60, v2
    ds_add_rtn_u32 v61, v61, v2
    ds_add_rtn_u32 v62, v62, v2
    ds_add_rtn_u32 v63, v63, v2
    s_waitcnt lgkmcnt(0)
    s_barrier
    s_setprio 3
    v_and_b32 v7, -4, v104
    v_lshl_add_u32 v8, v104, 2, v7
    ds_write_b32 v8, v96
    v_lshl_add_u32 v7, v7, 2, v104
    ds_write_b8 v7, v108 offset:16
    v_and_b32 v9, -4, v105
    v_lshl_add_u32 v10, v105, 2, v9
    ds_write_b32 v10, v97
    v_lshl_add_u32 v9, v9, 2, v105
    ds_write_b8_d16_hi v9, v108 offset:16
    v_and_b32 v7, -4, v106
    v_lshl_add_u32 v8, v106, 2, v7
    ds_write_b32 v8, v98
    v_lshl_add_u32 v7, v7, 2, v106
    ds_write_b8 v7, v109 offset:16
    v_and_b32 v9, -4, v107
    v_lshl_add_u32 v10, v107, 2, v9
    ds_write_b32 v10, v99
    v_lshl_add_u32 v9, v9, 2, v107
    ds_write_b8_d16_hi v9, v109 offset:16
    s_add_u32 s47, s35, 0x8000
    s_add_u32 s47, s47, s85
    buffer_store_dwordx4 v[88:91], v0, s[20:23], s47 offen sc1
    s_add_u32 s44, s96, 0x4800000
    v_lshlrev_b32 v96, 1, v1
    buffer_load_dwordx4 v[96:99], v96, s[8:11], s44 offen nt
    s_add_u32 s45, s96, 0x4800000
    v_lshlrev_b32 v104, 1, v1
    buffer_load_dwordx4 v[104:107], v104, s[12:15], s45 offen nt
    v_and_b32 v7, -4, v112
    v_lshl_add_u32 v8, v112, 2, v7
    ds_write_b32 v8, v100
    v_lshl_add_u32 v7, v7, 2, v112
    ds_write_b8 v7, v110 offset:16
    v_and_b32 v9, -4, v113
    v_lshl_add_u32 v10, v113, 2, v9
    ds_write_b32 v10, v101
    v_lshl_add_u32 v9, v9, 2, v113
    ds_write_b8_d16_hi v9, v110 offset:16
    v_and_b32 v7, -4, v114
    v_lshl_add_u32 v8, v114, 2, v7
    ds_write_b32 v8, v102
    v_lshl_add_u32 v7, v7, 2, v114
    ds_write_b8 v7, v111 offset:16
    v_and_b32 v9, -4, v115
    v_lshl_add_u32 v10, v115, 2, v9
    ds_write_b32 v10, v103
    v_lshl_add_u32 v9, v9, 2, v115
    ds_write_b8_d16_hi v9, v111 offset:16
    s_add_u32 s46, s96, 0x4800000
    s_lshr_b32 s46, s46, 1
    buffer_load_dwordx2 v[88:89], v1, s[16:19], s46 offen nt
    s_add_u32 s47, s96, 0x4c00000
    s_lshr_b32 s47, s47, 1
    buffer_load_dwordx2 v[90:91], v1, s[16:19], s47 offen nt
    s_add_u32 s44, s96, 0x4c00000
    v_lshlrev_b32 v100, 1, v1
    buffer_load_dwordx4 v[100:103], v100, s[8:11], s44 offen nt
    s_waitcnt vmcnt(10)
    v_lshlrev_b32 v7, 16, v64
    v_and_b32 v8, 0xffff0000, v64
    v_lshlrev_b32 v9, 16, v65
    v_and_b32 v10, 0xffff0000, v65
    v_mul_f32 v7, 0.15915494, v7
    v_mul_f32 v8, 0.15915494, v8
    v_mul_f32 v9, 0.15915494, v9
    v_mul_f32 v10, 0.15915494, v10
    v_mul_hi_u32_u24 v14, 429497, v68
    v_lshrrev_b32 v12, 3, v72
    v_cos_f32 v7, v7
    v_lshlrev_b16 v13, 3, v72
    v_mad_i32_i24 v11, v14, s55, v68
    v_bitop3_b32 v12, v6, v13, v12 bitop3:0xca
    v_lshl_add_u32 v11, v11, 17, s40
    v_lshlrev_b16 v14, 8, v14
    v_lshrrev_b32 v13, 2, v72
    v_add_u32 v68, v12, v11
    v_bitop3_b32 v72, v5, v13, v14 bitop3:0xea
    v_mul_hi_u32_u24 v14, 429497, v69
    v_lshrrev_b32 v12, 3, v73
    v_cos_f32 v8, v8
    v_lshlrev_b16 v13, 3, v73
    v_mad_i32_i24 v11, v14, s55, v69
    v_bitop3_b32 v12, v6, v13, v12 bitop3:0xca
    v_lshl_add_u32 v11, v11, 17, s40
    v_lshlrev_b16 v14, 8, v14
    v_lshrrev_b32 v13, 2, v73
    v_add_u32 v69, v12, v11
    v_bitop3_b32 v73, v5, v13, v14 bitop3:0xea
    v_cvt_pk_bf16_f32 v64, v7, v8
    v_perm_b32 v12, v64, v64, s41
    v_bitop3_b32 v68, v4, v12, v68 bitop3:0xca
    v_perm_b32 v13, v64, v64, s42
    v_bitop3_b32 v69, v4, v13, v69 bitop3:0xca
    v_mul_hi_u32_u24 v14, 429497, v70
    v_lshrrev_b32 v12, 3, v74
    v_cos_f32 v9, v9
    v_lshlrev_b16 v13, 3, v74
    v_mad_i32_i24 v11, v14, s55, v70
    v_bitop3_b32 v12, v6, v13, v12 bitop3:0xca
    v_lshl_add_u32 v11, v11, 17, s40
    v_lshlrev_b16 v14, 8, v14
    v_lshrrev_b32 v13, 2, v74
    v_add_u32 v70, v12, v11
    v_bitop3_b32 v74, v5, v13, v14 bitop3:0xea
    v_mul_hi_u32_u24 v14, 429497, v71
    v_lshrrev_b32 v12, 3, v75
    v_cos_f32 v10, v10
    v_lshlrev_b16 v13, 3, v75
    v_mad_i32_i24 v11, v14, s55, v71
    v_bitop3_b32 v12, v6, v13, v12 bitop3:0xca
    v_lshl_add_u32 v11, v11, 17, s40
    v_lshlrev_b16 v14, 8, v14
    v_lshrrev_b32 v13, 2, v75
    v_add_u32 v71, v12, v11
    v_bitop3_b32 v75, v5, v13, v14 bitop3:0xea
    v_cvt_pk_bf16_f32 v65, v9, v10
    v_perm_b32 v12, v65, v65, s41
    v_bitop3_b32 v70, v4, v12, v70 bitop3:0xca
    v_perm_b32 v13, v65, v65, s42
    v_bitop3_b32 v71, v4, v13, v71 bitop3:0xca
    s_setprio 2
    v_and_b32 v7, -4, v120
    v_lshl_add_u32 v8, v120, 2, v7
    ds_write_b32 v8, v116
    v_lshl_add_u32 v7, v7, 2, v120
    ds_write_b8 v7, v124 offset:16
    v_and_b32 v9, -4, v121
    v_lshl_add_u32 v10, v121, 2, v9
    ds_write_b32 v10, v117
    v_lshl_add_u32 v9, v9, 2, v121
    ds_write_b8_d16_hi v9, v124 offset:16
    v_and_b32 v7, -4, v122
    v_lshl_add_u32 v8, v122, 2, v7
    ds_write_b32 v8, v118
    v_lshl_add_u32 v7, v7, 2, v122
    ds_write_b8 v7, v125 offset:16
    v_and_b32 v9, -4, v123
    v_lshl_add_u32 v10, v123, 2, v9
    ds_write_b32 v10, v119
    v_lshl_add_u32 v9, v9, 2, v123
    ds_write_b8_d16_hi v9, v125 offset:16
    s_add_u32 s45, s35, 0x8000
    s_add_u32 s45, s45, s91
    buffer_store_dwordx4 v[92:95], v0, s[20:23], s45 offen sc1
    s_add_u32 s46, s96, 0x4c00000
    v_lshlrev_b32 v112, 1, v1
    buffer_load_dwordx4 v[112:115], v112, s[12:15], s46 offen nt
    s_waitcnt vmcnt(8)
    v_lshlrev_b32 v7, 16, v66
    v_and_b32 v8, 0xffff0000, v66
    v_lshlrev_b32 v9, 16, v67
    v_and_b32 v10, 0xffff0000, v67
    v_mul_f32 v7, 0.15915494, v7
    v_mul_f32 v8, 0.15915494, v8
    v_mul_f32 v9, 0.15915494, v9
    v_mul_f32 v10, 0.15915494, v10
    v_mul_hi_u32_u24 v14, 429497, v76
    v_lshrrev_b32 v12, 3, v80
    v_cos_f32 v7, v7
    v_lshlrev_b16 v13, 3, v80
    v_mad_i32_i24 v11, v14, s55, v76
    v_bitop3_b32 v12, v6, v13, v12 bitop3:0xca
    v_lshl_add_u32 v11, v11, 17, s40
    v_lshlrev_b16 v14, 8, v14
    v_lshrrev_b32 v13, 2, v80
    v_add_u32 v76, v12, v11
    v_bitop3_b32 v80, v5, v13, v14 bitop3:0xea
    v_mul_hi_u32_u24 v14, 429497, v77
    v_lshrrev_b32 v12, 3, v81
    v_cos_f32 v8, v8
    v_lshlrev_b16 v13, 3, v81
    v_mad_i32_i24 v11, v14, s55, v77
    v_bitop3_b32 v12, v6, v13, v12 bitop3:0xca
    v_lshl_add_u32 v11, v11, 17, s40
    v_lshlrev_b16 v14, 8, v14
    v_lshrrev_b32 v13, 2, v81
    v_add_u32 v77, v12, v11
    v_bitop3_b32 v81, v5, v13, v14 bitop3:0xea
    v_cvt_pk_bf16_f32 v66, v7, v8
    v_perm_b32 v12, v66, v66, s41
    v_bitop3_b32 v76, v4, v12, v76 bitop3:0xca
    v_perm_b32 v13, v66, v66, s42
    v_bitop3_b32 v77, v4, v13, v77 bitop3:0xca
    v_mul_hi_u32_u24 v14, 429497, v78
    v_lshrrev_b32 v12, 3, v82
    v_cos_f32 v9, v9
    v_lshlrev_b16 v13, 3, v82
    v_mad_i32_i24 v11, v14, s55, v78
    v_bitop3_b32 v12, v6, v13, v12 bitop3:0xca
    v_lshl_add_u32 v11, v11, 17, s40
    v_lshlrev_b16 v14, 8, v14
    v_lshrrev_b32 v13, 2, v82
    v_add_u32 v78, v12, v11
    v_bitop3_b32 v82, v5, v13, v14 bitop3:0xea
    v_mul_hi_u32_u24 v14, 429497, v79
    v_lshrrev_b32 v12, 3, v83
    v_cos_f32 v10, v10
    v_lshlrev_b16 v13, 3, v83
    v_mad_i32_i24 v11, v14, s55, v79
    v_bitop3_b32 v12, v6, v13, v12 bitop3:0xca
    v_lshl_add_u32 v11, v11, 17, s40
    v_lshlrev_b16 v14, 8, v14
    v_lshrrev_b32 v13, 2, v83
    v_add_u32 v79, v12, v11
    v_bitop3_b32 v83, v5, v13, v14 bitop3:0xea
    v_cvt_pk_bf16_f32 v67, v9, v10
    v_perm_b32 v12, v67, v67, s41
    v_bitop3_b32 v78, v4, v12, v78 bitop3:0xca
    v_perm_b32 v13, v67, v67, s42
    v_bitop3_b32 v79, v4, v13, v79 bitop3:0xca
    v_and_b32 v7, -4, v20
    v_lshl_add_u32 v8, v20, 2, v7
    ds_write_b32 v8, v16
    v_lshl_add_u32 v7, v7, 2, v20
    ds_write_b8 v7, v126 offset:16
    v_and_b32 v9, -4, v21
    v_lshl_add_u32 v10, v21, 2, v9
    ds_write_b32 v10, v17
    v_lshl_add_u32 v9, v9, 2, v21
    ds_write_b8_d16_hi v9, v126 offset:16
    v_and_b32 v7, -4, v22
    v_lshl_add_u32 v8, v22, 2, v7
    ds_write_b32 v8, v18
    v_lshl_add_u32 v7, v7, 2, v22
    ds_write_b8 v7, v127 offset:16
    v_and_b32 v9, -4, v23
    v_lshl_add_u32 v10, v23, 2, v9
    ds_write_b32 v10, v19
    v_lshl_add_u32 v9, v9, 2, v23
    ds_write_b8_d16_hi v9, v127 offset:16
    s_add_u32 s47, s96, 0x5000000
    v_lshlrev_b32 v108, 1, v1
    buffer_load_dwordx4 v[108:111], v108, s[8:11], s47 offen nt
    s_add_u32 s44, s96, 0x5000000
    v_lshlrev_b32 v116, 1, v1
    buffer_load_dwordx4 v[116:119], v116, s[12:15], s44 offen nt
    s_waitcnt vmcnt(5)
    v_lshlrev_b32 v7, 16, v88
    v_and_b32 v8, 0xffff0000, v88
    v_lshlrev_b32 v9, 16, v89
    v_and_b32 v10, 0xffff0000, v89
    v_mul_f32 v7, 0.15915494, v7
    v_mul_f32 v8, 0.15915494, v8
    v_mul_f32 v9, 0.15915494, v9
    v_mul_f32 v10, 0.15915494, v10
    v_mul_hi_u32_u24 v14, 429497, v96
    v_lshrrev_b32 v12, 3, v104
    v_cos_f32 v7, v7
    v_lshlrev_b16 v13, 3, v104
    v_mad_i32_i24 v11, v14, s55, v96
    v_bitop3_b32 v12, v6, v13, v12 bitop3:0xca
    v_lshl_add_u32 v11, v11, 17, s40
    v_lshlrev_b16 v14, 8, v14
    v_lshrrev_b32 v13, 2, v104
    v_add_u32 v96, v12, v11
    v_bitop3_b32 v104, v5, v13, v14 bitop3:0xea
    v_mul_hi_u32_u24 v14, 429497, v97
    v_lshrrev_b32 v12, 3, v105
    v_cos_f32 v8, v8
    v_lshlrev_b16 v13, 3, v105
    v_mad_i32_i24 v11, v14, s55, v97
    v_bitop3_b32 v12, v6, v13, v12 bitop3:0xca
    v_lshl_add_u32 v11, v11, 17, s40
    v_lshlrev_b16 v14, 8, v14
    v_lshrrev_b32 v13, 2, v105
    v_add_u32 v97, v12, v11
    v_bitop3_b32 v105, v5, v13, v14 bitop3:0xea
    v_cvt_pk_bf16_f32 v88, v7, v8
    v_perm_b32 v12, v88, v88, s41
    v_bitop3_b32 v96, v4, v12, v96 bitop3:0xca
    v_perm_b32 v13, v88, v88, s42
    v_bitop3_b32 v97, v4, v13, v97 bitop3:0xca
    v_mul_hi_u32_u24 v14, 429497, v98
    v_lshrrev_b32 v12, 3, v106
    v_cos_f32 v9, v9
    v_lshlrev_b16 v13, 3, v106
    v_mad_i32_i24 v11, v14, s55, v98
    v_bitop3_b32 v12, v6, v13, v12 bitop3:0xca
    v_lshl_add_u32 v11, v11, 17, s40
    v_lshlrev_b16 v14, 8, v14
    v_lshrrev_b32 v13, 2, v106
    v_add_u32 v98, v12, v11
    v_bitop3_b32 v106, v5, v13, v14 bitop3:0xea
    v_mul_hi_u32_u24 v14, 429497, v99
    v_lshrrev_b32 v12, 3, v107
    v_cos_f32 v10, v10
    v_lshlrev_b16 v13, 3, v107
    v_mad_i32_i24 v11, v14, s55, v99
    v_bitop3_b32 v12, v6, v13, v12 bitop3:0xca
    v_lshl_add_u32 v11, v11, 17, s40
    v_lshlrev_b16 v14, 8, v14
    v_lshrrev_b32 v13, 2, v107
    v_add_u32 v99, v12, v11
    v_bitop3_b32 v107, v5, v13, v14 bitop3:0xea
    v_cvt_pk_bf16_f32 v89, v9, v10
    v_perm_b32 v12, v89, v89, s41
    v_bitop3_b32 v98, v4, v12, v98 bitop3:0xca
    v_perm_b32 v13, v89, v89, s42
    v_bitop3_b32 v99, v4, v13, v99 bitop3:0xca
    s_setprio 1
    v_and_b32 v7, -4, v32
    v_lshl_add_u32 v8, v32, 2, v7
    ds_write_b32 v8, v28
    v_lshl_add_u32 v7, v7, 2, v32
    ds_write_b8 v7, v24 offset:16
    v_and_b32 v9, -4, v33
    v_lshl_add_u32 v10, v33, 2, v9
    ds_write_b32 v10, v29
    v_lshl_add_u32 v9, v9, 2, v33
    ds_write_b8_d16_hi v9, v24 offset:16
    v_and_b32 v7, -4, v34
    v_lshl_add_u32 v8, v34, 2, v7
    ds_write_b32 v8, v30
    v_lshl_add_u32 v7, v7, 2, v34
    ds_write_b8 v7, v25 offset:16
    v_and_b32 v9, -4, v35
    v_lshl_add_u32 v10, v35, 2, v9
    ds_write_b32 v10, v31
    v_lshl_add_u32 v9, v9, 2, v35
    ds_write_b8_d16_hi v9, v25 offset:16
    s_add_u32 s45, s96, 0x5000000
    s_lshr_b32 s45, s45, 1
    buffer_load_dwordx2 v[120:121], v1, s[16:19], s45 offen nt
    s_add_u32 s46, s96, 0x5400000
    s_lshr_b32 s46, s46, 1
    buffer_load_dwordx2 v[122:123], v1, s[16:19], s46 offen nt
    s_add_u32 s47, s96, 0x5400000
    v_lshlrev_b32 v92, 1, v1
    buffer_load_dwordx4 v[92:95], v92, s[8:11], s47 offen nt
    v_and_b32 v7, -4, v40
    v_lshl_add_u32 v8, v40, 2, v7
    ds_write_b32 v8, v36
    v_lshl_add_u32 v7, v7, 2, v40
    ds_write_b8 v7, v26 offset:16
    v_and_b32 v9, -4, v41
    v_lshl_add_u32 v10, v41, 2, v9
    ds_write_b32 v10, v37
    v_lshl_add_u32 v9, v9, 2, v41
    ds_write_b8_d16_hi v9, v26 offset:16
    v_and_b32 v7, -4, v42
    v_lshl_add_u32 v8, v42, 2, v7
    ds_write_b32 v8, v38
    v_lshl_add_u32 v7, v7, 2, v42
    ds_write_b8 v7, v27 offset:16
    v_and_b32 v9, -4, v43
    v_lshl_add_u32 v10, v43, 2, v9
    ds_write_b32 v10, v39
    v_lshl_add_u32 v9, v9, 2, v43
    ds_write_b8_d16_hi v9, v27 offset:16
    s_add_u32 s44, s35, 0x8000
    s_add_u32 s44, s44, s93
    buffer_store_dwordx4 v[84:87], v0, s[20:23], s44 offen sc1
    s_add_u32 s45, s96, 0x5400000
    v_lshlrev_b32 v16, 1, v1
    buffer_load_dwordx4 v[16:19], v16, s[12:15], s45 offen nt
    s_waitcnt vmcnt(7)
    v_lshlrev_b32 v7, 16, v90
    v_and_b32 v8, 0xffff0000, v90
    v_lshlrev_b32 v9, 16, v91
    v_and_b32 v10, 0xffff0000, v91
    v_mul_f32 v7, 0.15915494, v7
    v_mul_f32 v8, 0.15915494, v8
    v_mul_f32 v9, 0.15915494, v9
    v_mul_f32 v10, 0.15915494, v10
    v_mul_hi_u32_u24 v14, 429497, v100
    v_lshrrev_b32 v12, 3, v112
    v_cos_f32 v7, v7
    v_lshlrev_b16 v13, 3, v112
    v_mad_i32_i24 v11, v14, s55, v100
    v_bitop3_b32 v12, v6, v13, v12 bitop3:0xca
    v_lshl_add_u32 v11, v11, 17, s40
    v_lshlrev_b16 v14, 8, v14
    v_lshrrev_b32 v13, 2, v112
    v_add_u32 v100, v12, v11
    v_bitop3_b32 v112, v5, v13, v14 bitop3:0xea
    v_mul_hi_u32_u24 v14, 429497, v101
    v_lshrrev_b32 v12, 3, v113
    v_cos_f32 v8, v8
    v_lshlrev_b16 v13, 3, v113
    v_mad_i32_i24 v11, v14, s55, v101
    v_bitop3_b32 v12, v6, v13, v12 bitop3:0xca
    v_lshl_add_u32 v11, v11, 17, s40
    v_lshlrev_b16 v14, 8, v14
    v_lshrrev_b32 v13, 2, v113
    v_add_u32 v101, v12, v11
    v_bitop3_b32 v113, v5, v13, v14 bitop3:0xea
    v_cvt_pk_bf16_f32 v90, v7, v8
    v_perm_b32 v12, v90, v90, s41
    v_bitop3_b32 v100, v4, v12, v100 bitop3:0xca
    v_perm_b32 v13, v90, v90, s42
    v_bitop3_b32 v101, v4, v13, v101 bitop3:0xca
    v_mul_hi_u32_u24 v14, 429497, v102
    v_lshrrev_b32 v12, 3, v114
    v_cos_f32 v9, v9
    v_lshlrev_b16 v13, 3, v114
    v_mad_i32_i24 v11, v14, s55, v102
    v_bitop3_b32 v12, v6, v13, v12 bitop3:0xca
    v_lshl_add_u32 v11, v11, 17, s40
    v_lshlrev_b16 v14, 8, v14
    v_lshrrev_b32 v13, 2, v114
    v_add_u32 v102, v12, v11
    v_bitop3_b32 v114, v5, v13, v14 bitop3:0xea
    v_mul_hi_u32_u24 v14, 429497, v103
    v_lshrrev_b32 v12, 3, v115
    v_cos_f32 v10, v10
    v_lshlrev_b16 v13, 3, v115
    v_mad_i32_i24 v11, v14, s55, v103
    v_bitop3_b32 v12, v6, v13, v12 bitop3:0xca
    v_lshl_add_u32 v11, v11, 17, s40
    v_lshlrev_b16 v14, 8, v14
    v_lshrrev_b32 v13, 2, v115
    v_add_u32 v103, v12, v11
    v_bitop3_b32 v115, v5, v13, v14 bitop3:0xea
    v_cvt_pk_bf16_f32 v91, v9, v10
    v_perm_b32 v12, v91, v91, s41
    v_bitop3_b32 v102, v4, v12, v102 bitop3:0xca
    v_perm_b32 v13, v91, v91, s42
    v_bitop3_b32 v103, v4, v13, v103 bitop3:0xca
    s_setprio 0
    v_and_b32 v7, -4, v52
    v_lshl_add_u32 v8, v52, 2, v7
    ds_write_b32 v8, v48
    v_lshl_add_u32 v7, v7, 2, v52
    ds_write_b8 v7, v44 offset:16
    v_and_b32 v9, -4, v53
    v_lshl_add_u32 v10, v53, 2, v9
    ds_write_b32 v10, v49
    v_lshl_add_u32 v9, v9, 2, v53
    ds_write_b8_d16_hi v9, v44 offset:16
    v_and_b32 v7, -4, v54
    v_lshl_add_u32 v8, v54, 2, v7
    ds_write_b32 v8, v50
    v_lshl_add_u32 v7, v7, 2, v54
    ds_write_b8 v7, v45 offset:16
    v_and_b32 v9, -4, v55
    v_lshl_add_u32 v10, v55, 2, v9
    ds_write_b32 v10, v51
    v_lshl_add_u32 v9, v9, 2, v55
    ds_write_b8_d16_hi v9, v45 offset:16
    s_add_u32 s46, s96, 0x5800000
    v_lshlrev_b32 v20, 1, v1
    buffer_load_dwordx4 v[20:23], v20, s[8:11], s46 offen nt
    s_add_u32 s47, s96, 0x5800000
    v_lshlrev_b32 v124, 1, v1
    buffer_load_dwordx4 v[124:127], v124, s[12:15], s47 offen nt
    s_waitcnt vmcnt(5)
    v_lshlrev_b32 v7, 16, v120
    v_and_b32 v8, 0xffff0000, v120
    v_lshlrev_b32 v9, 16, v121
    v_and_b32 v10, 0xffff0000, v121
    v_mul_f32 v7, 0.15915494, v7
    v_mul_f32 v8, 0.15915494, v8
    v_mul_f32 v9, 0.15915494, v9
    v_mul_f32 v10, 0.15915494, v10
    v_mul_hi_u32_u24 v14, 429497, v108
    v_lshrrev_b32 v12, 3, v116
    v_cos_f32 v7, v7
    v_lshlrev_b16 v13, 3, v116
    v_mad_i32_i24 v11, v14, s55, v108
    v_bitop3_b32 v12, v6, v13, v12 bitop3:0xca
    v_lshl_add_u32 v11, v11, 17, s40
    v_lshlrev_b16 v14, 8, v14
    v_lshrrev_b32 v13, 2, v116
    v_add_u32 v108, v12, v11
    v_bitop3_b32 v116, v5, v13, v14 bitop3:0xea
    v_mul_hi_u32_u24 v14, 429497, v109
    v_lshrrev_b32 v12, 3, v117
    v_cos_f32 v8, v8
    v_lshlrev_b16 v13, 3, v117
    v_mad_i32_i24 v11, v14, s55, v109
    v_bitop3_b32 v12, v6, v13, v12 bitop3:0xca
    v_lshl_add_u32 v11, v11, 17, s40
    v_lshlrev_b16 v14, 8, v14
    v_lshrrev_b32 v13, 2, v117
    v_add_u32 v109, v12, v11
    v_bitop3_b32 v117, v5, v13, v14 bitop3:0xea
    v_cvt_pk_bf16_f32 v120, v7, v8
    v_perm_b32 v12, v120, v120, s41
    v_bitop3_b32 v108, v4, v12, v108 bitop3:0xca
    v_perm_b32 v13, v120, v120, s42
    v_bitop3_b32 v109, v4, v13, v109 bitop3:0xca
    v_mul_hi_u32_u24 v14, 429497, v110
    v_lshrrev_b32 v12, 3, v118
    v_cos_f32 v9, v9
    v_lshlrev_b16 v13, 3, v118
    v_mad_i32_i24 v11, v14, s55, v110
    v_bitop3_b32 v12, v6, v13, v12 bitop3:0xca
    v_lshl_add_u32 v11, v11, 17, s40
    v_lshlrev_b16 v14, 8, v14
    v_lshrrev_b32 v13, 2, v118
    v_add_u32 v110, v12, v11
    v_bitop3_b32 v118, v5, v13, v14 bitop3:0xea
    v_mul_hi_u32_u24 v14, 429497, v111
    v_lshrrev_b32 v12, 3, v119
    v_cos_f32 v10, v10
    v_lshlrev_b16 v13, 3, v119
    v_mad_i32_i24 v11, v14, s55, v111
    v_bitop3_b32 v12, v6, v13, v12 bitop3:0xca
    v_lshl_add_u32 v11, v11, 17, s40
    v_lshlrev_b16 v14, 8, v14
    v_lshrrev_b32 v13, 2, v119
    v_add_u32 v111, v12, v11
    v_bitop3_b32 v119, v5, v13, v14 bitop3:0xea
    v_cvt_pk_bf16_f32 v121, v9, v10
    v_perm_b32 v12, v121, v121, s41
    v_bitop3_b32 v110, v4, v12, v110 bitop3:0xca
    v_perm_b32 v13, v121, v121, s42
    v_bitop3_b32 v111, v4, v13, v111 bitop3:0xca
    v_and_b32 v7, -4, v60
    v_lshl_add_u32 v8, v60, 2, v7
    ds_write_b32 v8, v56
    v_lshl_add_u32 v7, v7, 2, v60
    ds_write_b8 v7, v46 offset:16
    v_and_b32 v9, -4, v61
    v_lshl_add_u32 v10, v61, 2, v9
    ds_write_b32 v10, v57
    v_lshl_add_u32 v9, v9, 2, v61
    ds_write_b8_d16_hi v9, v46 offset:16
    v_and_b32 v7, -4, v62
    v_lshl_add_u32 v8, v62, 2, v7
    ds_write_b32 v8, v58
    v_lshl_add_u32 v7, v7, 2, v62
    ds_write_b8 v7, v47 offset:16
    v_and_b32 v9, -4, v63
    v_lshl_add_u32 v10, v63, 2, v9
    ds_write_b32 v10, v59
    v_lshl_add_u32 v9, v9, 2, v63
    ds_write_b8_d16_hi v9, v47 offset:16
    s_add_u32 s44, s96, 0x5800000
    s_lshr_b32 s44, s44, 1
    buffer_load_dwordx2 v[28:29], v1, s[16:19], s44 offen nt
    s_add_u32 s45, s96, 0x5c00000
    s_lshr_b32 s45, s45, 1
    buffer_load_dwordx2 v[30:31], v1, s[16:19], s45 offen nt
    s_waitcnt vmcnt(4)
    v_lshlrev_b32 v7, 16, v122
    v_and_b32 v8, 0xffff0000, v122
    v_lshlrev_b32 v9, 16, v123
    v_and_b32 v10, 0xffff0000, v123
    v_mul_f32 v7, 0.15915494, v7
    v_mul_f32 v8, 0.15915494, v8
    v_mul_f32 v9, 0.15915494, v9
    v_mul_f32 v10, 0.15915494, v10
    v_mul_hi_u32_u24 v14, 429497, v92
    v_lshrrev_b32 v12, 3, v16
    v_cos_f32 v7, v7
    v_lshlrev_b16 v13, 3, v16
    v_mad_i32_i24 v11, v14, s55, v92
    v_bitop3_b32 v12, v6, v13, v12 bitop3:0xca
    v_lshl_add_u32 v11, v11, 17, s40
    v_lshlrev_b16 v14, 8, v14
    v_lshrrev_b32 v13, 2, v16
    v_add_u32 v92, v12, v11
    v_bitop3_b32 v16, v5, v13, v14 bitop3:0xea
    v_mul_hi_u32_u24 v14, 429497, v93
    v_lshrrev_b32 v12, 3, v17
    v_cos_f32 v8, v8
    v_lshlrev_b16 v13, 3, v17
    v_mad_i32_i24 v11, v14, s55, v93
    v_bitop3_b32 v12, v6, v13, v12 bitop3:0xca
    v_lshl_add_u32 v11, v11, 17, s40
    v_lshlrev_b16 v14, 8, v14
    v_lshrrev_b32 v13, 2, v17
    v_add_u32 v93, v12, v11
    v_bitop3_b32 v17, v5, v13, v14 bitop3:0xea
    v_cvt_pk_bf16_f32 v122, v7, v8
    v_perm_b32 v12, v122, v122, s41
    v_bitop3_b32 v92, v4, v12, v92 bitop3:0xca
    v_perm_b32 v13, v122, v122, s42
    v_bitop3_b32 v93, v4, v13, v93 bitop3:0xca
    v_mul_hi_u32_u24 v14, 429497, v94
    v_lshrrev_b32 v12, 3, v18
    v_cos_f32 v9, v9
    v_lshlrev_b16 v13, 3, v18
    v_mad_i32_i24 v11, v14, s55, v94
    v_bitop3_b32 v12, v6, v13, v12 bitop3:0xca
    v_lshl_add_u32 v11, v11, 17, s40
    v_lshlrev_b16 v14, 8, v14
    v_lshrrev_b32 v13, 2, v18
    v_add_u32 v94, v12, v11
    v_bitop3_b32 v18, v5, v13, v14 bitop3:0xea
    v_mul_hi_u32_u24 v14, 429497, v95
    v_lshrrev_b32 v12, 3, v19
    v_cos_f32 v10, v10
    v_lshlrev_b16 v13, 3, v19
    v_mad_i32_i24 v11, v14, s55, v95
    v_bitop3_b32 v12, v6, v13, v12 bitop3:0xca
    v_lshl_add_u32 v11, v11, 17, s40
    v_lshlrev_b16 v14, 8, v14
    v_lshrrev_b32 v13, 2, v19
    v_add_u32 v95, v12, v11
    v_bitop3_b32 v19, v5, v13, v14 bitop3:0xea
    v_cvt_pk_bf16_f32 v123, v9, v10
    v_perm_b32 v12, v123, v123, s41
    v_bitop3_b32 v94, v4, v12, v94 bitop3:0xca
    v_perm_b32 v13, v123, v123, s42
    v_bitop3_b32 v95, v4, v13, v95 bitop3:0xca
    v_add_u32 v7, s72, v0
    v_add_u32 v12, s73, v0
    v_add_u32 v13, s85, v0
    v_add_u32 v14, s91, v0
    v_add_u32 v15, s93, v0
    s_min_i32 s3, s72, s73
    s_min_i32 s3, s3, s85
    s_min_i32 s3, s3, s91
    s_min_i32 s3, s3, s93
    v_add_u32 v3, s3, v0
    v_mov_b32 v8, 0
    v_mov_b32 v9, 0
    v_mov_b32 v10, 0
    v_mov_b32 v11, 0
    s_waitcnt lgkmcnt(0)
    s_barrier
    ds_read_b128 v[32:35], v7 offset:0
    ds_read_b128 v[36:39], v12 offset:0
    ds_read_b128 v[40:43], v13 offset:0
    ds_read_b128 v[24:27], v14 offset:0
    ds_read_b128 v[84:87], v15 offset:0
    ds_write_b128 v3, v[8:11]
    ds_read_b128 v[48:51], v7 offset:16384
    ds_read_b128 v[52:55], v12 offset:16384
    ds_read_b128 v[56:59], v13 offset:16384
    ds_read_b128 v[60:63], v14 offset:16384
    ds_read_b128 v[44:47], v15 offset:16384
    s_waitcnt lgkmcnt(0)
    s_barrier
    s_setprio 3
    s_add_u32 s46, s35, 0x2a44000
    s_add_u32 s46, s46, s72
    buffer_store_dwordx4 v[32:35], v0, s[20:23], s46 offen sc1
    s_add_u32 s47, s96, 0x5c00000
    s_nop 0
    v_lshlrev_b32 v32, 1, v1
    buffer_load_dwordx4 v[32:35], v32, s[8:11], s47 offen nt
    s_add_u32 s44, s35, 0x2a44000
    s_add_u32 s44, s44, s73
    buffer_store_dwordx4 v[36:39], v0, s[20:23], s44 offen sc1
    s_add_u32 s45, s96, 0x5c00000
    s_nop 0
    v_lshlrev_b32 v36, 1, v1
    buffer_load_dwordx4 v[36:39], v36, s[12:15], s45 offen nt
    ds_add_u32 v72, v2
    ds_add_u32 v73, v2
    ds_add_u32 v74, v2
    ds_add_u32 v75, v2
    ds_add_u32 v80, v2
    ds_add_u32 v81, v2
    ds_add_u32 v82, v2
    ds_add_u32 v83, v2
    s_setprio 2
    ds_add_u32 v104, v2
    ds_add_u32 v105, v2
    ds_add_u32 v106, v2
    ds_add_u32 v107, v2
    ds_add_u32 v112, v2
    ds_add_u32 v113, v2
    ds_add_u32 v114, v2
    ds_add_u32 v115, v2
    s_setprio 1
    s_add_u32 s46, s35, 0x2a44000
    s_add_u32 s46, s46, s85
    buffer_store_dwordx4 v[40:43], v0, s[20:23], s46 offen sc1
    s_add_u32 s47, s96, 0x6000000
    s_nop 0
    v_lshlrev_b32 v40, 1, v1
    buffer_load_dwordx4 v[40:43], v40, s[8:11], s47 offen nt
    ds_add_u32 v116, v2
    ds_add_u32 v117, v2
    ds_add_u32 v118, v2
    ds_add_u32 v119, v2
    ds_add_u32 v16, v2
    ds_add_u32 v17, v2
    ds_add_u32 v18, v2
    ds_add_u32 v19, v2
    s_setprio 0
    s_waitcnt vmcnt(6)
    v_lshlrev_b32 v7, 16, v28
    v_and_b32 v8, 0xffff0000, v28
    v_lshlrev_b32 v9, 16, v29
    v_and_b32 v10, 0xffff0000, v29
    v_mul_f32 v7, 0.15915494, v7
    v_mul_f32 v8, 0.15915494, v8
    v_mul_f32 v9, 0.15915494, v9
    v_mul_f32 v10, 0.15915494, v10
    v_mul_hi_u32_u24 v14, 429497, v20
    v_lshrrev_b32 v12, 3, v124
    v_cos_f32 v7, v7
    v_lshlrev_b16 v13, 3, v124
    v_mad_i32_i24 v11, v14, s55, v20
    v_bitop3_b32 v12, v6, v13, v12 bitop3:0xca
    v_lshl_add_u32 v11, v11, 17, s40
    v_lshlrev_b16 v14, 8, v14
    v_lshrrev_b32 v13, 2, v124
    v_add_u32 v20, v12, v11
    v_bitop3_b32 v124, v5, v13, v14 bitop3:0xea
    ds_add_u32 v124, v2
    v_mul_hi_u32_u24 v14, 429497, v21
    v_lshrrev_b32 v12, 3, v125
    v_cos_f32 v8, v8
    v_lshlrev_b16 v13, 3, v125
    v_mad_i32_i24 v11, v14, s55, v21
    v_bitop3_b32 v12, v6, v13, v12 bitop3:0xca
    v_lshl_add_u32 v11, v11, 17, s40
    v_lshlrev_b16 v14, 8, v14
    v_lshrrev_b32 v13, 2, v125
    v_add_u32 v21, v12, v11
    v_bitop3_b32 v125, v5, v13, v14 bitop3:0xea
    ds_add_u32 v125, v2
    v_cvt_pk_bf16_f32 v28, v7, v8
    v_perm_b32 v12, v28, v28, s41
    v_bitop3_b32 v20, v4, v12, v20 bitop3:0xca
    v_perm_b32 v13, v28, v28, s42
    v_bitop3_b32 v21, v4, v13, v21 bitop3:0xca
    v_mul_hi_u32_u24 v14, 429497, v22
    v_lshrrev_b32 v12, 3, v126
    v_cos_f32 v9, v9
    v_lshlrev_b16 v13, 3, v126
    v_mad_i32_i24 v11, v14, s55, v22
    v_bitop3_b32 v12, v6, v13, v12 bitop3:0xca
    v_lshl_add_u32 v11, v11, 17, s40
    v_lshlrev_b16 v14, 8, v14
    v_lshrrev_b32 v13, 2, v126
    v_add_u32 v22, v12, v11
    v_bitop3_b32 v126, v5, v13, v14 bitop3:0xea
    ds_add_u32 v126, v2
    v_mul_hi_u32_u24 v14, 429497, v23
    v_lshrrev_b32 v12, 3, v127
    v_cos_f32 v10, v10
    v_lshlrev_b16 v13, 3, v127
    v_mad_i32_i24 v11, v14, s55, v23
    v_bitop3_b32 v12, v6, v13, v12 bitop3:0xca
    v_lshl_add_u32 v11, v11, 17, s40
    v_lshlrev_b16 v14, 8, v14
    v_lshrrev_b32 v13, 2, v127
    v_add_u32 v23, v12, v11
    v_bitop3_b32 v127, v5, v13, v14 bitop3:0xea
    ds_add_u32 v127, v2
    v_cvt_pk_bf16_f32 v29, v9, v10
    v_perm_b32 v12, v29, v29, s41
    v_bitop3_b32 v22, v4, v12, v22 bitop3:0xca
    v_perm_b32 v13, v29, v29, s42
    v_bitop3_b32 v23, v4, v13, v23 bitop3:0xca
    s_waitcnt vmcnt(2)
    v_lshlrev_b32 v7, 16, v30
    v_and_b32 v8, 0xffff0000, v30
    v_lshlrev_b32 v9, 16, v31
    v_and_b32 v10, 0xffff0000, v31
    v_mul_f32 v7, 0.15915494, v7
    v_mul_f32 v8, 0.15915494, v8
    v_mul_f32 v9, 0.15915494, v9
    v_mul_f32 v10, 0.15915494, v10
    v_mul_hi_u32_u24 v14, 429497, v32
    v_lshrrev_b32 v12, 3, v36
    v_cos_f32 v7, v7
    v_lshlrev_b16 v13, 3, v36
    v_mad_i32_i24 v11, v14, s55, v32
    v_bitop3_b32 v12, v6, v13, v12 bitop3:0xca
    v_lshl_add_u32 v11, v11, 17, s40
    v_lshlrev_b16 v14, 8, v14
    v_lshrrev_b32 v13, 2, v36
    v_add_u32 v32, v12, v11
    v_bitop3_b32 v36, v5, v13, v14 bitop3:0xea
    ds_add_u32 v36, v2
    v_mul_hi_u32_u24 v14, 429497, v33
    v_lshrrev_b32 v12, 3, v37
    v_cos_f32 v8, v8
    v_lshlrev_b16 v13, 3, v37
    v_mad_i32_i24 v11, v14, s55, v33
    v_bitop3_b32 v12, v6, v13, v12 bitop3:0xca
    v_lshl_add_u32 v11, v11, 17, s40
    v_lshlrev_b16 v14, 8, v14
    v_lshrrev_b32 v13, 2, v37
    v_add_u32 v33, v12, v11
    v_bitop3_b32 v37, v5, v13, v14 bitop3:0xea
    ds_add_u32 v37, v2
    v_cvt_pk_bf16_f32 v30, v7, v8
    v_perm_b32 v12, v30, v30, s41
    v_bitop3_b32 v32, v4, v12, v32 bitop3:0xca
    v_perm_b32 v13, v30, v30, s42
    v_bitop3_b32 v33, v4, v13, v33 bitop3:0xca
    v_mul_hi_u32_u24 v14, 429497, v34
    v_lshrrev_b32 v12, 3, v38
    v_cos_f32 v9, v9
    v_lshlrev_b16 v13, 3, v38
    v_mad_i32_i24 v11, v14, s55, v34
    v_bitop3_b32 v12, v6, v13, v12 bitop3:0xca
    v_lshl_add_u32 v11, v11, 17, s40
    v_lshlrev_b16 v14, 8, v14
    v_lshrrev_b32 v13, 2, v38
    v_add_u32 v34, v12, v11
    v_bitop3_b32 v38, v5, v13, v14 bitop3:0xea
    ds_add_u32 v38, v2
    v_mul_hi_u32_u24 v14, 429497, v35
    v_lshrrev_b32 v12, 3, v39
    v_cos_f32 v10, v10
    v_lshlrev_b16 v13, 3, v39
    v_mad_i32_i24 v11, v14, s55, v35
    v_bitop3_b32 v12, v6, v13, v12 bitop3:0xca
    v_lshl_add_u32 v11, v11, 17, s40
    v_lshlrev_b16 v14, 8, v14
    v_lshrrev_b32 v13, 2, v39
    v_add_u32 v35, v12, v11
    v_bitop3_b32 v39, v5, v13, v14 bitop3:0xea
    ds_add_u32 v39, v2
    v_cvt_pk_bf16_f32 v31, v9, v10
    v_perm_b32 v12, v31, v31, s41
    v_bitop3_b32 v34, v4, v12, v34 bitop3:0xca
    v_perm_b32 v13, v31, v31, s42
    v_bitop3_b32 v35, v4, v13, v35 bitop3:0xca
    v_lshrrev_b32 v8, 2, v0
    v_and_b32 v7, 0x3c00, v0
    v_bitop3_b32 v7, v5, v8, v7 bitop3:0xea
    s_waitcnt lgkmcnt(0)
    s_barrier
    ds_read2st64_b32 v[8:9], v7 offset0:0 offset1:1
    ds_read2st64_b32 v[10:11], v7 offset0:2 offset1:3
    s_add_u32 s44, s35, 0x2a44000
    s_add_u32 s44, s44, s91
    buffer_store_dwordx4 v[24:27], v0, s[20:23], s44 offen sc1
    s_add_u32 s45, s96, 0x6000000
    s_nop 0
    v_lshlrev_b32 v24, 1, v1
    buffer_load_dwordx4 v[24:27], v24, s[12:15], s45 offen nt
    s_waitcnt lgkmcnt(0)
    v_lshl_or_b32 v12, v9, 16, v8
    v_lshl_or_b32 v13, v11, 16, v10
    v_mov_b32 v14, v12
    v_mov_b32 v15, v13
    s_nop 0
    v_add_u32_dpp v14, v14, v14 row_shr:1 row_mask:0xf bank_mask:0xf bound_ctrl:1
    v_add_u32_dpp v15, v15, v15 row_shr:1 row_mask:0xf bank_mask:0xf bound_ctrl:1
    s_nop 0
    v_add_u32_dpp v14, v14, v14 row_shr:2 row_mask:0xf bank_mask:0xf bound_ctrl:1
    v_add_u32_dpp v15, v15, v15 row_shr:2 row_mask:0xf bank_mask:0xf bound_ctrl:1
    s_nop 0
    v_add_u32_dpp v14, v14, v14 row_shr:4 row_mask:0xf bank_mask:0xf bound_ctrl:1
    v_add_u32_dpp v15, v15, v15 row_shr:4 row_mask:0xf bank_mask:0xf bound_ctrl:1
    s_nop 0
    v_add_u32_dpp v14, v14, v14 row_shr:8 row_mask:0xf bank_mask:0xf bound_ctrl:1
    v_add_u32_dpp v15, v15, v15 row_shr:8 row_mask:0xf bank_mask:0xf bound_ctrl:1
    s_nop 0
    v_add_u32_dpp v14, v14, v14 row_bcast:15 row_mask:0xa bank_mask:0xf
    v_add_u32_dpp v15, v15, v15 row_bcast:15 row_mask:0xa bank_mask:0xf
    s_nop 0
    v_add_u32_dpp v14, v14, v14 row_bcast:31 row_mask:0xc bank_mask:0xf
    v_add_u32_dpp v15, v15, v15 row_bcast:31 row_mask:0xc bank_mask:0xf
    v_readlane_b32 s48, v14, 63
    v_readlane_b32 s49, v15, 63
    s_lshl_b32 s54, s32, 2
    v_mov_b32 v8, s54
    s_and_b32 s50, s48, 0xffff
    s_lshr_b32 s51, s48, 16
    s_and_b32 s52, s49, 0xffff
    s_lshr_b32 s53, s49, 16
    s_add_u32 s51, s51, s50
    s_add_u32 s52, s52, s51
    s_add_u32 s53, s53, s52
    v_mov_b32 v9, s53
    s_mov_b64 exec, 1
    ds_write_b32 v8, v9 offset:16384
    s_mov_b64 exec, -1
    v_and_b32 v8, 60, v7
    s_waitcnt lgkmcnt(0)
    s_barrier
    ds_read_b32 v9, v8 offset:16384
    s_waitcnt lgkmcnt(0)
    v_add_u32_dpp v9, v9, v9 row_shr:1 row_mask:0xf bank_mask:0xf bound_ctrl:1
    s_nop 1
    v_add_u32_dpp v9, v9, v9 row_shr:2 row_mask:0xf bank_mask:0xf bound_ctrl:1
    s_nop 1
    v_add_u32_dpp v9, v9, v9 row_shr:4 row_mask:0xf bank_mask:0xf bound_ctrl:1
    s_nop 1
    v_add_u32_dpp v9, v9, v9 row_shr:8 row_mask:0xf bank_mask:0xf bound_ctrl:1
    s_nop 0
    v_readlane_b32 s54, v9, s32
    s_sub_u32 s54, s54, s53
    s_add_u32 s50, s50, s54
    s_add_u32 s51, s51, s54
    s_add_u32 s52, s52, s54
    s_pack_ll_b32_b16 s48, s54, s50
    s_pack_ll_b32_b16 s49, s51, s52
    v_add_u32 v14, s48, v14
    v_add_u32 v15, s49, v15
    v_sub_u32 v12, v14, v12
    v_sub_u32 v13, v15, v13
    v_and_b32 v8, 0xffff, v12
    v_lshrrev_b32 v9, 16, v12
    v_and_b32 v10, 0xffff, v13
    v_lshrrev_b32 v11, 16, v13
    ds_write2st64_b32 v7, v8, v9 offset0:0 offset1:1
    ds_write2st64_b32 v7, v10, v11 offset0:2 offset1:3
    v_and_b32 v8, 0x3f0, v0
    v_lshl_add_u32 v8, v8, 1, s36
    ds_write_b64 v8, v[12:13] offset:20480
    s_bitset0_b64 exec, 63
    s_not_b64 exec, exec
    ds_write_b64 v8, v[14:15] offset:20512
    s_mov_b64 exec, -1
    s_waitcnt lgkmcnt(0)
    s_barrier
    s_setprio 3
    ds_add_rtn_u32 v72, v72, v2
    ds_add_rtn_u32 v73, v73, v2
    ds_add_rtn_u32 v74, v74, v2
    ds_add_rtn_u32 v75, v75, v2
    ds_read_b128 v[12:15], v0 offset:20480
    v_cmp_gt_u32 vcc, 8448, v0
    s_add_u32 s46, s35, 0x2a44000
    s_add_u32 s46, s46, s93
    buffer_store_dwordx4 v[84:87], v0, s[20:23], s46 offen sc1
    s_add_u32 s47, s96, 0x6000000
    s_lshr_b32 s47, s47, 1
    buffer_load_dwordx2 v[84:85], v1, s[16:19], s47 offen nt
    s_add_u32 s44, s96, 0x6400000
    s_lshr_b32 s44, s44, 1
    buffer_load_dwordx2 v[86:87], v1, s[16:19], s44 offen nt
    ds_add_rtn_u32 v80, v80, v2
    ds_add_rtn_u32 v81, v81, v2
    ds_add_rtn_u32 v82, v82, v2
    ds_add_rtn_u32 v83, v83, v2
    s_setprio 2
    ds_add_rtn_u32 v104, v104, v2
    ds_add_rtn_u32 v105, v105, v2
    ds_add_rtn_u32 v106, v106, v2
    ds_add_rtn_u32 v107, v107, v2
    s_waitcnt lgkmcnt(8)
    s_cbranch_vccz L1_p3
    s_add_u32 s45, s35, 0x5480000
    s_mov_b64 exec, vcc
    buffer_store_dwordx4 v[12:15], v0, s[24:27], s45 offen sc1
    s_mov_b64 exec, -1
L1_p3:
    s_add_u32 s46, s35, 0x2a48000
    s_add_u32 s46, s46, s72
    buffer_store_dwordx4 v[48:51], v0, s[20:23], s46 offen sc1
    s_add_u32 s47, s96, 0x6400000
    s_nop 0
    v_lshlrev_b32 v48, 1, v1
    buffer_load_dwordx4 v[48:51], v48, s[8:11], s47 offen nt
    ds_add_rtn_u32 v112, v112, v2
    ds_add_rtn_u32 v113, v113, v2
    ds_add_rtn_u32 v114, v114, v2
    ds_add_rtn_u32 v115, v115, v2
    s_setprio 1
    ds_add_rtn_u32 v116, v116, v2
    ds_add_rtn_u32 v117, v117, v2
    ds_add_rtn_u32 v118, v118, v2
    ds_add_rtn_u32 v119, v119, v2
    ds_add_rtn_u32 v16, v16, v2
    ds_add_rtn_u32 v17, v17, v2
    ds_add_rtn_u32 v18, v18, v2
    ds_add_rtn_u32 v19, v19, v2
    s_add_u32 s44, s35, 0x2a48000
    s_add_u32 s44, s44, s73
    buffer_store_dwordx4 v[52:55], v0, s[20:23], s44 offen sc1
    s_add_u32 s45, s96, 0x6400000
    s_nop 0
    v_lshlrev_b32 v52, 1, v1
    buffer_load_dwordx4 v[52:55], v52, s[12:15], s45 offen nt
    s_setprio 0
    ds_add_rtn_u32 v124, v124, v2
    ds_add_rtn_u32 v125, v125, v2
    ds_add_rtn_u32 v126, v126, v2
    ds_add_rtn_u32 v127, v127, v2
    ds_add_rtn_u32 v36, v36, v2
    ds_add_rtn_u32 v37, v37, v2
    ds_add_rtn_u32 v38, v38, v2
    ds_add_rtn_u32 v39, v39, v2
    s_waitcnt lgkmcnt(0)
    s_barrier
    s_setprio 3
    v_and_b32 v7, -4, v72
    v_lshl_add_u32 v8, v72, 2, v7
    ds_write_b32 v8, v68
    v_lshl_add_u32 v7, v7, 2, v72
    ds_write_b8 v7, v64 offset:16
    v_and_b32 v9, -4, v73
    v_lshl_add_u32 v10, v73, 2, v9
    ds_write_b32 v10, v69
    v_lshl_add_u32 v9, v9, 2, v73
    ds_write_b8_d16_hi v9, v64 offset:16
    v_and_b32 v7, -4, v74
    v_lshl_add_u32 v8, v74, 2, v7
    ds_write_b32 v8, v70
    v_lshl_add_u32 v7, v7, 2, v74
    ds_write_b8 v7, v65 offset:16
    v_and_b32 v9, -4, v75
    v_lshl_add_u32 v10, v75, 2, v9
    ds_write_b32 v10, v71
    v_lshl_add_u32 v9, v9, 2, v75
    ds_write_b8_d16_hi v9, v65 offset:16
    s_add_u32 s46, s35, 0x2a48000
    s_add_u32 s46, s46, s85
    buffer_store_dwordx4 v[56:59], v0, s[20:23], s46 offen sc1
    s_add_u32 s47, s96, 0x6800000
    v_lshlrev_b32 v68, 1, v1
    buffer_load_dwordx4 v[68:71], v68, s[8:11], s47 offen nt
    s_add_u32 s44, s96, 0x6800000
    v_lshlrev_b32 v72, 1, v1
    buffer_load_dwordx4 v[72:75], v72, s[12:15], s44 offen nt
    v_and_b32 v7, -4, v80
    v_lshl_add_u32 v8, v80, 2, v7
    ds_write_b32 v8, v76
    v_lshl_add_u32 v7, v7, 2, v80
    ds_write_b8 v7, v66 offset:16
    v_and_b32 v9, -4, v81
    v_lshl_add_u32 v10, v81, 2, v9
    ds_write_b32 v10, v77
    v_lshl_add_u32 v9, v9, 2, v81
    ds_write_b8_d16_hi v9, v66 offset:16
    v_and_b32 v7, -4, v82
    v_lshl_add_u32 v8, v82, 2, v7
    ds_write_b32 v8, v78
    v_lshl_add_u32 v7, v7, 2, v82
    ds_write_b8 v7, v67 offset:16
    v_and_b32 v9, -4, v83
    v_lshl_add_u32 v10, v83, 2, v9
    ds_write_b32 v10, v79
    v_lshl_add_u32 v9, v9, 2, v83
    ds_write_b8_d16_hi v9, v67 offset:16
    s_add_u32 s45, s96, 0x6800000
    s_lshr_b32 s45, s45, 1
    buffer_load_dwordx2 v[56:57], v1, s[16:19], s45 offen nt
    s_add_u32 s46, s96, 0x6c00000
    s_lshr_b32 s46, s46, 1
    buffer_load_dwordx2 v[58:59], v1, s[16:19], s46 offen nt
    s_add_u32 s47, s96, 0x6c00000
    v_lshlrev_b32 v76, 1, v1
    buffer_load_dwordx4 v[76:79], v76, s[8:11], s47 offen nt
    s_waitcnt vmcnt(10)
    v_lshlrev_b32 v7, 16, v84
    v_and_b32 v8, 0xffff0000, v84
    v_lshlrev_b32 v9, 16, v85
    v_and_b32 v10, 0xffff0000, v85
    v_mul_f32 v7, 0.15915494, v7
    v_mul_f32 v8, 0.15915494, v8
    v_mul_f32 v9, 0.15915494, v9
    v_mul_f32 v10, 0.15915494, v10
    v_mul_hi_u32_u24 v14, 429497, v40
    v_lshrrev_b32 v12, 3, v24
    v_cos_f32 v7, v7
    v_lshlrev_b16 v13, 3, v24
    v_mad_i32_i24 v11, v14, s55, v40
    v_bitop3_b32 v12, v6, v13, v12 bitop3:0xca
    v_lshl_add_u32 v11, v11, 17, s40
    v_lshlrev_b16 v14, 8, v14
    v_lshrrev_b32 v13, 2, v24
    v_add_u32 v40, v12, v11
    v_bitop3_b32 v24, v5, v13, v14 bitop3:0xea
    v_mul_hi_u32_u24 v14, 429497, v41
    v_lshrrev_b32 v12, 3, v25
    v_cos_f32 v8, v8
    v_lshlrev_b16 v13, 3, v25
    v_mad_i32_i24 v11, v14, s55, v41
    v_bitop3_b32 v12, v6, v13, v12 bitop3:0xca
    v_lshl_add_u32 v11, v11, 17, s40
    v_lshlrev_b16 v14, 8, v14
    v_lshrrev_b32 v13, 2, v25
    v_add_u32 v41, v12, v11
    v_bitop3_b32 v25, v5, v13, v14 bitop3:0xea
    v_cvt_pk_bf16_f32 v84, v7, v8
    v_perm_b32 v12, v84, v84, s41
    v_bitop3_b32 v40, v4, v12, v40 bitop3:0xca
    v_perm_b32 v13, v84, v84, s42
    v_bitop3_b32 v41, v4, v13, v41 bitop3:0xca
    v_mul_hi_u32_u24 v14, 429497, v42
    v_lshrrev_b32 v12, 3, v26
    v_cos_f32 v9, v9
    v_lshlrev_b16 v13, 3, v26
    v_mad_i32_i24 v11, v14, s55, v42
    v_bitop3_b32 v12, v6, v13, v12 bitop3:0xca
    v_lshl_add_u32 v11, v11, 17, s40
    v_lshlrev_b16 v14, 8, v14
    v_lshrrev_b32 v13, 2, v26
    v_add_u32 v42, v12, v11
    v_bitop3_b32 v26, v5, v13, v14 bitop3:0xea
    v_mul_hi_u32_u24 v14, 429497, v43
    v_lshrrev_b32 v12, 3, v27
    v_cos_f32 v10, v10
    v_lshlrev_b16 v13, 3, v27
    v_mad_i32_i24 v11, v14, s55, v43
    v_bitop3_b32 v12, v6, v13, v12 bitop3:0xca
    v_lshl_add_u32 v11, v11, 17, s40
    v_lshlrev_b16 v14, 8, v14
    v_lshrrev_b32 v13, 2, v27
    v_add_u32 v43, v12, v11
    v_bitop3_b32 v27, v5, v13, v14 bitop3:0xea
    v_cvt_pk_bf16_f32 v85, v9, v10
    v_perm_b32 v12, v85, v85, s41
    v_bitop3_b32 v42, v4, v12, v42 bitop3:0xca
    v_perm_b32 v13, v85, v85, s42
    v_bitop3_b32 v43, v4, v13, v43 bitop3:0xca
    s_setprio 2
    v_and_b32 v7, -4, v104
    v_lshl_add_u32 v8, v104, 2, v7
    ds_write_b32 v8, v96
    v_lshl_add_u32 v7, v7, 2, v104
    ds_write_b8 v7, v88 offset:16
    v_and_b32 v9, -4, v105
    v_lshl_add_u32 v10, v105, 2, v9
    ds_write_b32 v10, v97
    v_lshl_add_u32 v9, v9, 2, v105
    ds_write_b8_d16_hi v9, v88 offset:16
    v_and_b32 v7, -4, v106
    v_lshl_add_u32 v8, v106, 2, v7
    ds_write_b32 v8, v98
    v_lshl_add_u32 v7, v7, 2, v106
    ds_write_b8 v7, v89 offset:16
    v_and_b32 v9, -4, v107
    v_lshl_add_u32 v10, v107, 2, v9
    ds_write_b32 v10, v99
    v_lshl_add_u32 v9, v9, 2, v107
    ds_write_b8_d16_hi v9, v89 offset:16
    s_add_u32 s44, s35, 0x2a48000
    s_add_u32 s44, s44, s91
    buffer_store_dwordx4 v[60:63], v0, s[20:23], s44 offen sc1
    s_add_u32 s45, s96, 0x6c00000
    v_lshlrev_b32 v80, 1, v1
    buffer_load_dwordx4 v[80:83], v80, s[12:15], s45 offen nt
    s_waitcnt vmcnt(8)
    v_lshlrev_b32 v7, 16, v86
    v_and_b32 v8, 0xffff0000, v86
    v_lshlrev_b32 v9, 16, v87
    v_and_b32 v10, 0xffff0000, v87
    v_mul_f32 v7, 0.15915494, v7
    v_mul_f32 v8, 0.15915494, v8
    v_mul_f32 v9, 0.15915494, v9
    v_mul_f32 v10, 0.15915494, v10
    v_mul_hi_u32_u24 v14, 429497, v48
    v_lshrrev_b32 v12, 3, v52
    v_cos_f32 v7, v7
    v_lshlrev_b16 v13, 3, v52
    v_mad_i32_i24 v11, v14, s55, v48
    v_bitop3_b32 v12, v6, v13, v12 bitop3:0xca
    v_lshl_add_u32 v11, v11, 17, s40
    v_lshlrev_b16 v14, 8, v14
    v_lshrrev_b32 v13, 2, v52
    v_add_u32 v48, v12, v11
    v_bitop3_b32 v52, v5, v13, v14 bitop3:0xea
    v_mul_hi_u32_u24 v14, 429497, v49
    v_lshrrev_b32 v12, 3, v53
    v_cos_f32 v8, v8
    v_lshlrev_b16 v13, 3, v53
    v_mad_i32_i24 v11, v14, s55, v49
    v_bitop3_b32 v12, v6, v13, v12 bitop3:0xca
    v_lshl_add_u32 v11, v11, 17, s40
    v_lshlrev_b16 v14, 8, v14
    v_lshrrev_b32 v13, 2, v53
    v_add_u32 v49, v12, v11
    v_bitop3_b32 v53, v5, v13, v14 bitop3:0xea
    v_cvt_pk_bf16_f32 v86, v7, v8
    v_perm_b32 v12, v86, v86, s41
    v_bitop3_b32 v48, v4, v12, v48 bitop3:0xca
    v_perm_b32 v13, v86, v86, s42
    v_bitop3_b32 v49, v4, v13, v49 bitop3:0xca
    v_mul_hi_u32_u24 v14, 429497, v50
    v_lshrrev_b32 v12, 3, v54
    v_cos_f32 v9, v9
    v_lshlrev_b16 v13, 3, v54
    v_mad_i32_i24 v11, v14, s55, v50
    v_bitop3_b32 v12, v6, v13, v12 bitop3:0xca
    v_lshl_add_u32 v11, v11, 17, s40
    v_lshlrev_b16 v14, 8, v14
    v_lshrrev_b32 v13, 2, v54
    v_add_u32 v50, v12, v11
    v_bitop3_b32 v54, v5, v13, v14 bitop3:0xea
    v_mul_hi_u32_u24 v14, 429497, v51
    v_lshrrev_b32 v12, 3, v55
    v_cos_f32 v10, v10
    v_lshlrev_b16 v13, 3, v55
    v_mad_i32_i24 v11, v14, s55, v51
    v_bitop3_b32 v12, v6, v13, v12 bitop3:0xca
    v_lshl_add_u32 v11, v11, 17, s40
    v_lshlrev_b16 v14, 8, v14
    v_lshrrev_b32 v13, 2, v55
    v_add_u32 v51, v12, v11
    v_bitop3_b32 v55, v5, v13, v14 bitop3:0xea
    v_cvt_pk_bf16_f32 v87, v9, v10
    v_perm_b32 v12, v87, v87, s41
    v_bitop3_b32 v50, v4, v12, v50 bitop3:0xca
    v_perm_b32 v13, v87, v87, s42
    v_bitop3_b32 v51, v4, v13, v51 bitop3:0xca
    v_and_b32 v7, -4, v112
    v_lshl_add_u32 v8, v112, 2, v7
    ds_write_b32 v8, v100
    v_lshl_add_u32 v7, v7, 2, v112
    ds_write_b8 v7, v90 offset:16
    v_and_b32 v9, -4, v113
    v_lshl_add_u32 v10, v113, 2, v9
    ds_write_b32 v10, v101
    v_lshl_add_u32 v9, v9, 2, v113
    ds_write_b8_d16_hi v9, v90 offset:16
    v_and_b32 v7, -4, v114
    v_lshl_add_u32 v8, v114, 2, v7
    ds_write_b32 v8, v102
    v_lshl_add_u32 v7, v7, 2, v114
    ds_write_b8 v7, v91 offset:16
    v_and_b32 v9, -4, v115
    v_lshl_add_u32 v10, v115, 2, v9
    ds_write_b32 v10, v103
    v_lshl_add_u32 v9, v9, 2, v115
    ds_write_b8_d16_hi v9, v91 offset:16
    s_add_u32 s46, s96, 0x7000000
    v_lshlrev_b32 v64, 1, v1
    buffer_load_dwordx4 v[64:67], v64, s[8:11], s46 offen nt
    s_add_u32 s47, s96, 0x7000000
    v_lshlrev_b32 v96, 1, v1
    buffer_load_dwordx4 v[96:99], v96, s[12:15], s47 offen nt
    s_waitcnt vmcnt(5)
    v_lshlrev_b32 v7, 16, v56
    v_and_b32 v8, 0xffff0000, v56
    v_lshlrev_b32 v9, 16, v57
    v_and_b32 v10, 0xffff0000, v57
    v_mul_f32 v7, 0.15915494, v7
    v_mul_f32 v8, 0.15915494, v8
    v_mul_f32 v9, 0.15915494, v9
    v_mul_f32 v10, 0.15915494, v10
    v_mul_hi_u32_u24 v14, 429497, v68
    v_lshrrev_b32 v12, 3, v72
    v_cos_f32 v7, v7
    v_lshlrev_b16 v13, 3, v72
    v_mad_i32_i24 v11, v14, s55, v68
    v_bitop3_b32 v12, v6, v13, v12 bitop3:0xca
    v_lshl_add_u32 v11, v11, 17, s40
    v_lshlrev_b16 v14, 8, v14
    v_lshrrev_b32 v13, 2, v72
    v_add_u32 v68, v12, v11
    v_bitop3_b32 v72, v5, v13, v14 bitop3:0xea
    v_mul_hi_u32_u24 v14, 429497, v69
    v_lshrrev_b32 v12, 3, v73
    v_cos_f32 v8, v8
    v_lshlrev_b16 v13, 3, v73
    v_mad_i32_i24 v11, v14, s55, v69
    v_bitop3_b32 v12, v6, v13, v12 bitop3:0xca
    v_lshl_add_u32 v11, v11, 17, s40
    v_lshlrev_b16 v14, 8, v14
    v_lshrrev_b32 v13, 2, v73
    v_add_u32 v69, v12, v11
    v_bitop3_b32 v73, v5, v13, v14 bitop3:0xea
    v_cvt_pk_bf16_f32 v56, v7, v8
    v_perm_b32 v12, v56, v56, s41
    v_bitop3_b32 v68, v4, v12, v68 bitop3:0xca
    v_perm_b32 v13, v56, v56, s42
    v_bitop3_b32 v69, v4, v13, v69 bitop3:0xca
    v_mul_hi_u32_u24 v14, 429497, v70
    v_lshrrev_b32 v12, 3, v74
    v_cos_f32 v9, v9
    v_lshlrev_b16 v13, 3, v74
    v_mad_i32_i24 v11, v14, s55, v70
    v_bitop3_b32 v12, v6, v13, v12 bitop3:0xca
    v_lshl_add_u32 v11, v11, 17, s40
    v_lshlrev_b16 v14, 8, v14
    v_lshrrev_b32 v13, 2, v74
    v_add_u32 v70, v12, v11
    v_bitop3_b32 v74, v5, v13, v14 bitop3:0xea
    v_mul_hi_u32_u24 v14, 429497, v71
    v_lshrrev_b32 v12, 3, v75
    v_cos_f32 v10, v10
    v_lshlrev_b16 v13, 3, v75
    v_mad_i32_i24 v11, v14, s55, v71
    v_bitop3_b32 v12, v6, v13, v12 bitop3:0xca
    v_lshl_add_u32 v11, v11, 17, s40
    v_lshlrev_b16 v14, 8, v14
    v_lshrrev_b32 v13, 2, v75
    v_add_u32 v71, v12, v11
    v_bitop3_b32 v75, v5, v13, v14 bitop3:0xea
    v_cvt_pk_bf16_f32 v57, v9, v10
    v_perm_b32 v12, v57, v57, s41
    v_bitop3_b32 v70, v4, v12, v70 bitop3:0xca
    v_perm_b32 v13, v57, v57, s42
    v_bitop3_b32 v71, v4, v13, v71 bitop3:0xca
    s_setprio 1
    v_and_b32 v7, -4, v116
    v_lshl_add_u32 v8, v116, 2, v7
    ds_write_b32 v8, v108
    v_lshl_add_u32 v7, v7, 2, v116
    ds_write_b8 v7, v120 offset:16
    v_and_b32 v9, -4, v117
    v_lshl_add_u32 v10, v117, 2, v9
    ds_write_b32 v10, v109
    v_lshl_add_u32 v9, v9, 2, v117
    ds_write_b8_d16_hi v9, v120 offset:16
    v_and_b32 v7, -4, v118
    v_lshl_add_u32 v8, v118, 2, v7
    ds_write_b32 v8, v110
    v_lshl_add_u32 v7, v7, 2, v118
    ds_write_b8 v7, v121 offset:16
    v_and_b32 v9, -4, v119
    v_lshl_add_u32 v10, v119, 2, v9
    ds_write_b32 v10, v111
    v_lshl_add_u32 v9, v9, 2, v119
    ds_write_b8_d16_hi v9, v121 offset:16
    s_add_u32 s44, s96, 0x7000000
    s_lshr_b32 s44, s44, 1
    buffer_load_dwordx2 v[104:105], v1, s[16:19], s44 offen nt
    s_add_u32 s45, s96, 0x7400000
    s_lshr_b32 s45, s45, 1
    buffer_load_dwordx2 v[106:107], v1, s[16:19], s45 offen nt
    s_add_u32 s46, s96, 0x7400000
    v_lshlrev_b32 v60, 1, v1
    buffer_load_dwordx4 v[60:63], v60, s[8:11], s46 offen nt
    v_and_b32 v7, -4, v16
    v_lshl_add_u32 v8, v16, 2, v7
    ds_write_b32 v8, v92
    v_lshl_add_u32 v7, v7, 2, v16
    ds_write_b8 v7, v122 offset:16
    v_and_b32 v9, -4, v17
    v_lshl_add_u32 v10, v17, 2, v9
    ds_write_b32 v10, v93
    v_lshl_add_u32 v9, v9, 2, v17
    ds_write_b8_d16_hi v9, v122 offset:16
    v_and_b32 v7, -4, v18
    v_lshl_add_u32 v8, v18, 2, v7
    ds_write_b32 v8, v94
    v_lshl_add_u32 v7, v7, 2, v18
    ds_write_b8 v7, v123 offset:16
    v_and_b32 v9, -4, v19
    v_lshl_add_u32 v10, v19, 2, v9
    ds_write_b32 v10, v95
    v_lshl_add_u32 v9, v9, 2, v19
    ds_write_b8_d16_hi v9, v123 offset:16
    s_add_u32 s47, s35, 0x2a48000
    s_add_u32 s47, s47, s93
    buffer_store_dwordx4 v[44:47], v0, s[20:23], s47 offen sc1
    s_add_u32 s44, s96, 0x7400000
    v_lshlrev_b32 v100, 1, v1
    buffer_load_dwordx4 v[100:103], v100, s[12:15], s44 offen nt
    s_waitcnt vmcnt(7)
    v_lshlrev_b32 v7, 16, v58
    v_and_b32 v8, 0xffff0000, v58
    v_lshlrev_b32 v9, 16, v59
    v_and_b32 v10, 0xffff0000, v59
    v_mul_f32 v7, 0.15915494, v7
    v_mul_f32 v8, 0.15915494, v8
    v_mul_f32 v9, 0.15915494, v9
    v_mul_f32 v10, 0.15915494, v10
    v_mul_hi_u32_u24 v14, 429497, v76
    v_lshrrev_b32 v12, 3, v80
    v_cos_f32 v7, v7
    v_lshlrev_b16 v13, 3, v80
    v_mad_i32_i24 v11, v14, s55, v76
    v_bitop3_b32 v12, v6, v13, v12 bitop3:0xca
    v_lshl_add_u32 v11, v11, 17, s40
    v_lshlrev_b16 v14, 8, v14
    v_lshrrev_b32 v13, 2, v80
    v_add_u32 v76, v12, v11
    v_bitop3_b32 v80, v5, v13, v14 bitop3:0xea
    v_mul_hi_u32_u24 v14, 429497, v77
    v_lshrrev_b32 v12, 3, v81
    v_cos_f32 v8, v8
    v_lshlrev_b16 v13, 3, v81
    v_mad_i32_i24 v11, v14, s55, v77
    v_bitop3_b32 v12, v6, v13, v12 bitop3:0xca
    v_lshl_add_u32 v11, v11, 17, s40
    v_lshlrev_b16 v14, 8, v14
    v_lshrrev_b32 v13, 2, v81
    v_add_u32 v77, v12, v11
    v_bitop3_b32 v81, v5, v13, v14 bitop3:0xea
    v_cvt_pk_bf16_f32 v58, v7, v8
    v_perm_b32 v12, v58, v58, s41
    v_bitop3_b32 v76, v4, v12, v76 bitop3:0xca
    v_perm_b32 v13, v58, v58, s42
    v_bitop3_b32 v77, v4, v13, v77 bitop3:0xca
    v_mul_hi_u32_u24 v14, 429497, v78
    v_lshrrev_b32 v12, 3, v82
    v_cos_f32 v9, v9
    v_lshlrev_b16 v13, 3, v82
    v_mad_i32_i24 v11, v14, s55, v78
    v_bitop3_b32 v12, v6, v13, v12 bitop3:0xca
    v_lshl_add_u32 v11, v11, 17, s40
    v_lshlrev_b16 v14, 8, v14
    v_lshrrev_b32 v13, 2, v82
    v_add_u32 v78, v12, v11
    v_bitop3_b32 v82, v5, v13, v14 bitop3:0xea
    v_mul_hi_u32_u24 v14, 429497, v79
    v_lshrrev_b32 v12, 3, v83
    v_cos_f32 v10, v10
    v_lshlrev_b16 v13, 3, v83
    v_mad_i32_i24 v11, v14, s55, v79
    v_bitop3_b32 v12, v6, v13, v12 bitop3:0xca
    v_lshl_add_u32 v11, v11, 17, s40
    v_lshlrev_b16 v14, 8, v14
    v_lshrrev_b32 v13, 2, v83
    v_add_u32 v79, v12, v11
    v_bitop3_b32 v83, v5, v13, v14 bitop3:0xea
    v_cvt_pk_bf16_f32 v59, v9, v10
    v_perm_b32 v12, v59, v59, s41
    v_bitop3_b32 v78, v4, v12, v78 bitop3:0xca
    v_perm_b32 v13, v59, v59, s42
    v_bitop3_b32 v79, v4, v13, v79 bitop3:0xca
    s_setprio 0
    v_and_b32 v7, -4, v124
    v_lshl_add_u32 v8, v124, 2, v7
    ds_write_b32 v8, v20
    v_lshl_add_u32 v7, v7, 2, v124
    ds_write_b8 v7, v28 offset:16
    v_and_b32 v9, -4, v125
    v_lshl_add_u32 v10, v125, 2, v9
    ds_write_b32 v10, v21
    v_lshl_add_u32 v9, v9, 2, v125
    ds_write_b8_d16_hi v9, v28 offset:16
    v_and_b32 v7, -4, v126
    v_lshl_add_u32 v8, v126, 2, v7
    ds_write_b32 v8, v22
    v_lshl_add_u32 v7, v7, 2, v126
    ds_write_b8 v7, v29 offset:16
    v_and_b32 v9, -4, v127
    v_lshl_add_u32 v10, v127, 2, v9
    ds_write_b32 v10, v23
    v_lshl_add_u32 v9, v9, 2, v127
    ds_write_b8_d16_hi v9, v29 offset:16
    s_add_u32 s45, s96, 0x7800000
    v_lshlrev_b32 v112, 1, v1
    buffer_load_dwordx4 v[112:115], v112, s[8:11], s45 offen nt
    s_add_u32 s46, s96, 0x7800000
    v_lshlrev_b32 v88, 1, v1
    buffer_load_dwordx4 v[88:91], v88, s[12:15], s46 offen nt
    s_waitcnt vmcnt(5)
    v_lshlrev_b32 v7, 16, v104
    v_and_b32 v8, 0xffff0000, v104
    v_lshlrev_b32 v9, 16, v105
    v_and_b32 v10, 0xffff0000, v105
    v_mul_f32 v7, 0.15915494, v7
    v_mul_f32 v8, 0.15915494, v8
    v_mul_f32 v9, 0.15915494, v9
    v_mul_f32 v10, 0.15915494, v10
    v_mul_hi_u32_u24 v14, 429497, v64
    v_lshrrev_b32 v12, 3, v96
    v_cos_f32 v7, v7
    v_lshlrev_b16 v13, 3, v96
    v_mad_i32_i24 v11, v14, s55, v64
    v_bitop3_b32 v12, v6, v13, v12 bitop3:0xca
    v_lshl_add_u32 v11, v11, 17, s40
    v_lshlrev_b16 v14, 8, v14
    v_lshrrev_b32 v13, 2, v96
    v_add_u32 v64, v12, v11
    v_bitop3_b32 v96, v5, v13, v14 bitop3:0xea
    v_mul_hi_u32_u24 v14, 429497, v65
    v_lshrrev_b32 v12, 3, v97
    v_cos_f32 v8, v8
    v_lshlrev_b16 v13, 3, v97
    v_mad_i32_i24 v11, v14, s55, v65
    v_bitop3_b32 v12, v6, v13, v12 bitop3:0xca
    v_lshl_add_u32 v11, v11, 17, s40
    v_lshlrev_b16 v14, 8, v14
    v_lshrrev_b32 v13, 2, v97
    v_add_u32 v65, v12, v11
    v_bitop3_b32 v97, v5, v13, v14 bitop3:0xea
    v_cvt_pk_bf16_f32 v104, v7, v8
    v_perm_b32 v12, v104, v104, s41
    v_bitop3_b32 v64, v4, v12, v64 bitop3:0xca
    v_perm_b32 v13, v104, v104, s42
    v_bitop3_b32 v65, v4, v13, v65 bitop3:0xca
    v_mul_hi_u32_u24 v14, 429497, v66
    v_lshrrev_b32 v12, 3, v98
    v_cos_f32 v9, v9
    v_lshlrev_b16 v13, 3, v98
    v_mad_i32_i24 v11, v14, s55, v66
    v_bitop3_b32 v12, v6, v13, v12 bitop3:0xca
    v_lshl_add_u32 v11, v11, 17, s40
    v_lshlrev_b16 v14, 8, v14
    v_lshrrev_b32 v13, 2, v98
    v_add_u32 v66, v12, v11
    v_bitop3_b32 v98, v5, v13, v14 bitop3:0xea
    v_mul_hi_u32_u24 v14, 429497, v67
    v_lshrrev_b32 v12, 3, v99
    v_cos_f32 v10, v10
    v_lshlrev_b16 v13, 3, v99
    v_mad_i32_i24 v11, v14, s55, v67
    v_bitop3_b32 v12, v6, v13, v12 bitop3:0xca
    v_lshl_add_u32 v11, v11, 17, s40
    v_lshlrev_b16 v14, 8, v14
    v_lshrrev_b32 v13, 2, v99
    v_add_u32 v67, v12, v11
    v_bitop3_b32 v99, v5, v13, v14 bitop3:0xea
    v_cvt_pk_bf16_f32 v105, v9, v10
    v_perm_b32 v12, v105, v105, s41
    v_bitop3_b32 v66, v4, v12, v66 bitop3:0xca
    v_perm_b32 v13, v105, v105, s42
    v_bitop3_b32 v67, v4, v13, v67 bitop3:0xca
    v_and_b32 v7, -4, v36
    v_lshl_add_u32 v8, v36, 2, v7
    ds_write_b32 v8, v32
    v_lshl_add_u32 v7, v7, 2, v36
    ds_write_b8 v7, v30 offset:16
    v_and_b32 v9, -4, v37
    v_lshl_add_u32 v10, v37, 2, v9
    ds_write_b32 v10, v33
    v_lshl_add_u32 v9, v9, 2, v37
    ds_write_b8_d16_hi v9, v30 offset:16
    v_and_b32 v7, -4, v38
    v_lshl_add_u32 v8, v38, 2, v7
    ds_write_b32 v8, v34
    v_lshl_add_u32 v7, v7, 2, v38
    ds_write_b8 v7, v31 offset:16
    v_and_b32 v9, -4, v39
    v_lshl_add_u32 v10, v39, 2, v9
    ds_write_b32 v10, v35
    v_lshl_add_u32 v9, v9, 2, v39
    ds_write_b8_d16_hi v9, v31 offset:16
    s_add_u32 s47, s96, 0x7800000
    s_lshr_b32 s47, s47, 1
    buffer_load_dwordx2 v[108:109], v1, s[16:19], s47 offen nt
    s_add_u32 s44, s96, 0x7c00000
    s_lshr_b32 s44, s44, 1
    buffer_load_dwordx2 v[110:111], v1, s[16:19], s44 offen nt
    s_waitcnt vmcnt(4)
    v_lshlrev_b32 v7, 16, v106
    v_and_b32 v8, 0xffff0000, v106
    v_lshlrev_b32 v9, 16, v107
    v_and_b32 v10, 0xffff0000, v107
    v_mul_f32 v7, 0.15915494, v7
    v_mul_f32 v8, 0.15915494, v8
    v_mul_f32 v9, 0.15915494, v9
    v_mul_f32 v10, 0.15915494, v10
    v_mul_hi_u32_u24 v14, 429497, v60
    v_lshrrev_b32 v12, 3, v100
    v_cos_f32 v7, v7
    v_lshlrev_b16 v13, 3, v100
    v_mad_i32_i24 v11, v14, s55, v60
    v_bitop3_b32 v12, v6, v13, v12 bitop3:0xca
    v_lshl_add_u32 v11, v11, 17, s40
    v_lshlrev_b16 v14, 8, v14
    v_lshrrev_b32 v13, 2, v100
    v_add_u32 v60, v12, v11
    v_bitop3_b32 v100, v5, v13, v14 bitop3:0xea
    v_mul_hi_u32_u24 v14, 429497, v61
    v_lshrrev_b32 v12, 3, v101
    v_cos_f32 v8, v8
    v_lshlrev_b16 v13, 3, v101
    v_mad_i32_i24 v11, v14, s55, v61
    v_bitop3_b32 v12, v6, v13, v12 bitop3:0xca
    v_lshl_add_u32 v11, v11, 17, s40
    v_lshlrev_b16 v14, 8, v14
    v_lshrrev_b32 v13, 2, v101
    v_add_u32 v61, v12, v11
    v_bitop3_b32 v101, v5, v13, v14 bitop3:0xea
    v_cvt_pk_bf16_f32 v106, v7, v8
    v_perm_b32 v12, v106, v106, s41
    v_bitop3_b32 v60, v4, v12, v60 bitop3:0xca
    v_perm_b32 v13, v106, v106, s42
    v_bitop3_b32 v61, v4, v13, v61 bitop3:0xca
    v_mul_hi_u32_u24 v14, 429497, v62
    v_lshrrev_b32 v12, 3, v102
    v_cos_f32 v9, v9
    v_lshlrev_b16 v13, 3, v102
    v_mad_i32_i24 v11, v14, s55, v62
    v_bitop3_b32 v12, v6, v13, v12 bitop3:0xca
    v_lshl_add_u32 v11, v11, 17, s40
    v_lshlrev_b16 v14, 8, v14
    v_lshrrev_b32 v13, 2, v102
    v_add_u32 v62, v12, v11
    v_bitop3_b32 v102, v5, v13, v14 bitop3:0xea
    v_mul_hi_u32_u24 v14, 429497, v63
    v_lshrrev_b32 v12, 3, v103
    v_cos_f32 v10, v10
    v_lshlrev_b16 v13, 3, v103
    v_mad_i32_i24 v11, v14, s55, v63
    v_bitop3_b32 v12, v6, v13, v12 bitop3:0xca
    v_lshl_add_u32 v11, v11, 17, s40
    v_lshlrev_b16 v14, 8, v14
    v_lshrrev_b32 v13, 2, v103
    v_add_u32 v63, v12, v11
    v_bitop3_b32 v103, v5, v13, v14 bitop3:0xea
    v_cvt_pk_bf16_f32 v107, v9, v10
    v_perm_b32 v12, v107, v107, s41
    v_bitop3_b32 v62, v4, v12, v62 bitop3:0xca
    v_perm_b32 v13, v107, v107, s42
    v_bitop3_b32 v63, v4, v13, v63 bitop3:0xca
    v_add_u32 v7, s72, v0
    v_add_u32 v12, s73, v0
    v_add_u32 v13, s85, v0
    v_add_u32 v14, s91, v0
    v_add_u32 v15, s93, v0
    s_min_i32 s3, s72, s73
    s_min_i32 s3, s3, s85
    s_min_i32 s3, s3, s91
    s_min_i32 s3, s3, s93
    v_add_u32 v3, s3, v0
    v_mov_b32 v8, 0
    v_mov_b32 v9, 0
    v_mov_b32 v10, 0
    v_mov_b32 v11, 0
    s_waitcnt lgkmcnt(0)
    s_barrier
    ds_read_b128 v[116:119], v7 offset:0
    ds_read_b128 v[92:95], v12 offset:0
    ds_read_b128 v[16:19], v13 offset:0
    ds_read_b128 v[120:123], v14 offset:0
    ds_read_b128 v[44:47], v15 offset:0
    ds_write_b128 v3, v[8:11]
    ds_read_b128 v[20:23], v7 offset:16384
    ds_read_b128 v[124:127], v12 offset:16384
    ds_read_b128 v[32:35], v13 offset:16384
    ds_read_b128 v[36:39], v14 offset:16384
    ds_read_b128 v[28:31], v15 offset:16384
    s_waitcnt lgkmcnt(0)
    s_barrier
    s_setprio 3
    s_add_u32 s45, s35, 0x5484000
    s_add_u32 s45, s45, s72
    buffer_store_dwordx4 v[116:119], v0, s[20:23], s45 offen sc1
    s_add_u32 s46, s96, 0x7c00000
    s_nop 0
    v_lshlrev_b32 v116, 1, v1
    buffer_load_dwordx4 v[116:119], v116, s[8:11], s46 offen nt
    s_add_u32 s47, s35, 0x5484000
    s_add_u32 s47, s47, s73
    buffer_store_dwordx4 v[92:95], v0, s[20:23], s47 offen sc1
    s_add_u32 s44, s96, 0x7c00000
    s_nop 0
    v_lshlrev_b32 v92, 1, v1
    buffer_load_dwordx4 v[92:95], v92, s[12:15], s44 offen nt
    ds_add_u32 v24, v2
    ds_add_u32 v25, v2
    ds_add_u32 v26, v2
    ds_add_u32 v27, v2
    ds_add_u32 v52, v2
    ds_add_u32 v53, v2
    ds_add_u32 v54, v2
    ds_add_u32 v55, v2
    s_setprio 2
    ds_add_u32 v72, v2
    ds_add_u32 v73, v2
    ds_add_u32 v74, v2
    ds_add_u32 v75, v2
    ds_add_u32 v80, v2
    ds_add_u32 v81, v2
    ds_add_u32 v82, v2
    ds_add_u32 v83, v2
    s_setprio 1
    s_add_u32 s45, s35, 0x5484000
    s_add_u32 s45, s45, s85
    buffer_store_dwordx4 v[16:19], v0, s[20:23], s45 offen sc1
    s_add_u32 s46, s96, 0x8000000
    s_nop 0
    v_lshlrev_b32 v16, 1, v1
    buffer_load_dwordx4 v[16:19], v16, s[8:11], s46 offen nt
    ds_add_u32 v96, v2
    ds_add_u32 v97, v2
    ds_add_u32 v98, v2
    ds_add_u32 v99, v2
    s_mov_b32 s68, s66
    s_mov_b32 s69, s67
    s_mov_b32 s70, 0x100
    s_mov_b32 s71, 0x20000
    v_mov_b32 v3, 1
    s_cmp_lg_u32 s32, 15
    s_cbranch_scc1 L1_tk
    s_mov_b64 exec, 1
    s_and_b32 s3, s2, 1
    s_lshl_b32 s3, s3, 7
    buffer_atomic_add v3, off, s[68:71], s3 sc0
    s_mov_b64 exec, -1
L1_tk:
    ds_add_u32 v100, v2
    ds_add_u32 v101, v2
    ds_add_u32 v102, v2
    ds_add_u32 v103, v2
    s_setprio 0
    s_waitcnt vmcnt(6)
    v_lshlrev_b32 v7, 16, v108
    v_and_b32 v8, 0xffff0000, v108
    v_lshlrev_b32 v9, 16, v109
    v_and_b32 v10, 0xffff0000, v109
    v_mul_f32 v7, 0.15915494, v7
    v_mul_f32 v8, 0.15915494, v8
    v_mul_f32 v9, 0.15915494, v9
    v_mul_f32 v10, 0.15915494, v10
    v_mul_hi_u32_u24 v14, 429497, v112
    v_lshrrev_b32 v12, 3, v88
    v_cos_f32 v7, v7
    v_lshlrev_b16 v13, 3, v88
    v_mad_i32_i24 v11, v14, s55, v112
    v_bitop3_b32 v12, v6, v13, v12 bitop3:0xca
    v_lshl_add_u32 v11, v11, 17, s40
    v_lshlrev_b16 v14, 8, v14
    v_lshrrev_b32 v13, 2, v88
    v_add_u32 v112, v12, v11
    v_bitop3_b32 v88, v5, v13, v14 bitop3:0xea
    ds_add_u32 v88, v2
    v_mul_hi_u32_u24 v14, 429497, v113
    v_lshrrev_b32 v12, 3, v89
    v_cos_f32 v8, v8
    v_lshlrev_b16 v13, 3, v89
    v_mad_i32_i24 v11, v14, s55, v113
    v_bitop3_b32 v12, v6, v13, v12 bitop3:0xca
    v_lshl_add_u32 v11, v11, 17, s40
    v_lshlrev_b16 v14, 8, v14
    v_lshrrev_b32 v13, 2, v89
    v_add_u32 v113, v12, v11
    v_bitop3_b32 v89, v5, v13, v14 bitop3:0xea
    ds_add_u32 v89, v2
    v_cvt_pk_bf16_f32 v108, v7, v8
    v_perm_b32 v12, v108, v108, s41
    v_bitop3_b32 v112, v4, v12, v112 bitop3:0xca
    v_perm_b32 v13, v108, v108, s42
    v_bitop3_b32 v113, v4, v13, v113 bitop3:0xca
    v_mul_hi_u32_u24 v14, 429497, v114
    v_lshrrev_b32 v12, 3, v90
    v_cos_f32 v9, v9
    v_lshlrev_b16 v13, 3, v90
    v_mad_i32_i24 v11, v14, s55, v114
    v_bitop3_b32 v12, v6, v13, v12 bitop3:0xca
    v_lshl_add_u32 v11, v11, 17, s40
    v_lshlrev_b16 v14, 8, v14
    v_lshrrev_b32 v13, 2, v90
    v_add_u32 v114, v12, v11
    v_bitop3_b32 v90, v5, v13, v14 bitop3:0xea
    ds_add_u32 v90, v2
    v_mul_hi_u32_u24 v14, 429497, v115
    v_lshrrev_b32 v12, 3, v91
    v_cos_f32 v10, v10
    v_lshlrev_b16 v13, 3, v91
    v_mad_i32_i24 v11, v14, s55, v115
    v_bitop3_b32 v12, v6, v13, v12 bitop3:0xca
    v_lshl_add_u32 v11, v11, 17, s40
    v_lshlrev_b16 v14, 8, v14
    v_lshrrev_b32 v13, 2, v91
    v_add_u32 v115, v12, v11
    v_bitop3_b32 v91, v5, v13, v14 bitop3:0xea
    ds_add_u32 v91, v2
    v_cvt_pk_bf16_f32 v109, v9, v10
    v_perm_b32 v12, v109, v109, s41
    v_bitop3_b32 v114, v4, v12, v114 bitop3:0xca
    v_perm_b32 v13, v109, v109, s42
    v_bitop3_b32 v115, v4, v13, v115 bitop3:0xca
    s_waitcnt vmcnt(2)
    v_lshlrev_b32 v7, 16, v110
    v_and_b32 v8, 0xffff0000, v110
    v_lshlrev_b32 v9, 16, v111
    v_and_b32 v10, 0xffff0000, v111
    v_mul_f32 v7, 0.15915494, v7
    v_mul_f32 v8, 0.15915494, v8
    v_mul_f32 v9, 0.15915494, v9
    v_mul_f32 v10, 0.15915494, v10
    v_mul_hi_u32_u24 v14, 429497, v116
    v_lshrrev_b32 v12, 3, v92
    v_cos_f32 v7, v7
    v_lshlrev_b16 v13, 3, v92
    v_mad_i32_i24 v11, v14, s55, v116
    v_bitop3_b32 v12, v6, v13, v12 bitop3:0xca
    v_lshl_add_u32 v11, v11, 17, s40
    v_lshlrev_b16 v14, 8, v14
    v_lshrrev_b32 v13, 2, v92
    v_add_u32 v116, v12, v11
    v_bitop3_b32 v92, v5, v13, v14 bitop3:0xea
    ds_add_u32 v92, v2
    v_mul_hi_u32_u24 v14, 429497, v117
    v_lshrrev_b32 v12, 3, v93
    v_cos_f32 v8, v8
    v_lshlrev_b16 v13, 3, v93
    v_mad_i32_i24 v11, v14, s55, v117
    v_bitop3_b32 v12, v6, v13, v12 bitop3:0xca
    v_lshl_add_u32 v11, v11, 17, s40
    v_lshlrev_b16 v14, 8, v14
    v_lshrrev_b32 v13, 2, v93
    v_add_u32 v117, v12, v11
    v_bitop3_b32 v93, v5, v13, v14 bitop3:0xea
    ds_add_u32 v93, v2
    v_cvt_pk_bf16_f32 v110, v7, v8
    v_perm_b32 v12, v110, v110, s41
    v_bitop3_b32 v116, v4, v12, v116 bitop3:0xca
    v_perm_b32 v13, v110, v110, s42
    v_bitop3_b32 v117, v4, v13, v117 bitop3:0xca
    v_mul_hi_u32_u24 v14, 429497, v118
    v_lshrrev_b32 v12, 3, v94
    v_cos_f32 v9, v9
    v_lshlrev_b16 v13, 3, v94
    v_mad_i32_i24 v11, v14, s55, v118
    v_bitop3_b32 v12, v6, v13, v12 bitop3:0xca
    v_lshl_add_u32 v11, v11, 17, s40
    v_lshlrev_b16 v14, 8, v14
    v_lshrrev_b32 v13, 2, v94
    v_add_u32 v118, v12, v11
    v_bitop3_b32 v94, v5, v13, v14 bitop3:0xea
    ds_add_u32 v94, v2
    v_mul_hi_u32_u24 v14, 429497, v119
    v_lshrrev_b32 v12, 3, v95
    v_cos_f32 v10, v10
    v_lshlrev_b16 v13, 3, v95
    v_mad_i32_i24 v11, v14, s55, v119
    v_bitop3_b32 v12, v6, v13, v12 bitop3:0xca
    v_lshl_add_u32 v11, v11, 17, s40
    v_lshlrev_b16 v14, 8, v14
    v_lshrrev_b32 v13, 2, v95
    v_add_u32 v119, v12, v11
    v_bitop3_b32 v95, v5, v13, v14 bitop3:0xea
    ds_add_u32 v95, v2
    v_cvt_pk_bf16_f32 v111, v9, v10
    v_perm_b32 v12, v111, v111, s41
    v_bitop3_b32 v118, v4, v12, v118 bitop3:0xca
    v_perm_b32 v13, v111, v111, s42
    v_bitop3_b32 v119, v4, v13, v119 bitop3:0xca
    v_lshrrev_b32 v8, 2, v0
    v_and_b32 v7, 0x3c00, v0
    v_bitop3_b32 v7, v5, v8, v7 bitop3:0xea
    s_waitcnt lgkmcnt(0)
    s_barrier
    ds_read2st64_b32 v[8:9], v7 offset0:0 offset1:1
    ds_read2st64_b32 v[10:11], v7 offset0:2 offset1:3
    s_add_u32 s47, s35, 0x5484000
    s_add_u32 s47, s47, s91
    buffer_store_dwordx4 v[120:123], v0, s[20:23], s47 offen sc1
    s_add_u32 s44, s96, 0x8000000
    s_nop 0
    v_lshlrev_b32 v120, 1, v1
    buffer_load_dwordx4 v[120:123], v120, s[12:15], s44 offen nt
    s_waitcnt lgkmcnt(0)
    v_lshl_or_b32 v12, v9, 16, v8
    v_lshl_or_b32 v13, v11, 16, v10
    v_mov_b32 v14, v12
    v_mov_b32 v15, v13
    s_nop 0
    v_add_u32_dpp v14, v14, v14 row_shr:1 row_mask:0xf bank_mask:0xf bound_ctrl:1
    v_add_u32_dpp v15, v15, v15 row_shr:1 row_mask:0xf bank_mask:0xf bound_ctrl:1
    s_nop 0
    v_add_u32_dpp v14, v14, v14 row_shr:2 row_mask:0xf bank_mask:0xf bound_ctrl:1
    v_add_u32_dpp v15, v15, v15 row_shr:2 row_mask:0xf bank_mask:0xf bound_ctrl:1
    s_nop 0
    v_add_u32_dpp v14, v14, v14 row_shr:4 row_mask:0xf bank_mask:0xf bound_ctrl:1
    v_add_u32_dpp v15, v15, v15 row_shr:4 row_mask:0xf bank_mask:0xf bound_ctrl:1
    s_nop 0
    v_add_u32_dpp v14, v14, v14 row_shr:8 row_mask:0xf bank_mask:0xf bound_ctrl:1
    v_add_u32_dpp v15, v15, v15 row_shr:8 row_mask:0xf bank_mask:0xf bound_ctrl:1
    s_nop 0
    v_add_u32_dpp v14, v14, v14 row_bcast:15 row_mask:0xa bank_mask:0xf
    v_add_u32_dpp v15, v15, v15 row_bcast:15 row_mask:0xa bank_mask:0xf
    s_nop 0
    v_add_u32_dpp v14, v14, v14 row_bcast:31 row_mask:0xc bank_mask:0xf
    v_add_u32_dpp v15, v15, v15 row_bcast:31 row_mask:0xc bank_mask:0xf
    v_readlane_b32 s48, v14, 63
    v_readlane_b32 s49, v15, 63
    s_lshl_b32 s54, s32, 2
    v_mov_b32 v8, s54
    s_and_b32 s50, s48, 0xffff
    s_lshr_b32 s51, s48, 16
    s_and_b32 s52, s49, 0xffff
    s_lshr_b32 s53, s49, 16
    s_add_u32 s51, s51, s50
    s_add_u32 s52, s52, s51
    s_add_u32 s53, s53, s52
    v_mov_b32 v9, s53
    s_mov_b64 exec, 1
    ds_write_b32 v8, v9 offset:16384
    s_cmp_lg_u32 s32, 15
    s_cbranch_scc1 L1_tk2
    s_waitcnt vmcnt(1)
L1_tk2:
    ds_write_b32 v8, v3 offset:16448
    s_mov_b64 exec, -1
    v_and_b32 v8, 60, v7
    s_waitcnt lgkmcnt(0)
    s_barrier
    ds_read_b32 v9, v8 offset:16384
    ds_read_b32 v10, v8 offset:16448
    s_waitcnt lgkmcnt(0)
    v_readlane_b32 s84, v10, 15
    s_and_b32 s3, s2, 1
    s_lshl_b32 s3, s3, 7
    s_add_u32 s84, s84, s3
    s_and_b32 s4, s84, 127
    s_lshl_b32 s6, s32, 10
    s_mov_b32 s43, 5
    s_bitcmp1_b32 s2, 0
    s_cselect_b32 s5, 128, 0
    s_mov_b32 s7, 128
    s_cselect_b32 s7, 124, s7
    s_add_u32 s5, s5, s4
    s_add_u32 s5, s5, 9472
    s_lshl_b32 s5, s5, 14
    s_add_u32 s38, s5, s6
    s_cmp_lt_u32 s4, s7
    s_addc_u32 s43, s43, 0
    s_bitcmp1_b32 s2, 0
    s_cselect_b32 s5, 112, 0
    s_mov_b32 s7, 112
    s_cselect_b32 s7, 100, s7
    s_add_u32 s5, s5, s4
    s_add_u32 s5, s5, 9724
    s_lshl_b32 s5, s5, 14
    s_add_u32 s39, s5, s6
    s_cmp_lt_u32 s4, s7
    s_addc_u32 s43, s43, 0
    s_bitcmp1_b32 s2, 0
    s_cselect_b32 s5, 64, 0
    s_mov_b32 s7, 64
    s_cselect_b32 s7, 0, s7
    s_add_u32 s5, s5, s4
    s_add_u32 s5, s5, 9936
    s_lshl_b32 s5, s5, 14
    s_add_u32 s58, s5, s6
    s_cmp_lt_u32 s4, s7
    s_addc_u32 s43, s43, 0
    v_add_u32_dpp v9, v9, v9 row_shr:1 row_mask:0xf bank_mask:0xf bound_ctrl:1
    s_nop 1
    v_add_u32_dpp v9, v9, v9 row_shr:2 row_mask:0xf bank_mask:0xf bound_ctrl:1
    s_nop 1
    v_add_u32_dpp v9, v9, v9 row_shr:4 row_mask:0xf bank_mask:0xf bound_ctrl:1
    s_nop 1
    v_add_u32_dpp v9, v9, v9 row_shr:8 row_mask:0xf bank_mask:0xf bound_ctrl:1
    s_nop 0
    v_readlane_b32 s54, v9, s32
    s_sub_u32 s54, s54, s53
    s_add_u32 s50, s50, s54
    s_add_u32 s51, s51, s54
    s_add_u32 s52, s52, s54
    s_pack_ll_b32_b16 s48, s54, s50
    s_pack_ll_b32_b16 s49, s51, s52
    v_add_u32 v14, s48, v14
    v_add_u32 v15, s49, v15
    v_sub_u32 v12, v14, v12
    v_sub_u32 v13, v15, v13
    v_and_b32 v8, 0xffff, v12
    v_lshrrev_b32 v9, 16, v12
    v_and_b32 v10, 0xffff, v13
    v_lshrrev_b32 v11, 16, v13
    ds_write2st64_b32 v7, v8, v9 offset0:0 offset1:1
    ds_write2st64_b32 v7, v10, v11 offset0:2 offset1:3
    v_and_b32 v8, 0x3f0, v0
    v_lshl_add_u32 v8, v8, 1, s36
    ds_write_b64 v8, v[12:13] offset:20480
    s_bitset0_b64 exec, 63
    s_not_b64 exec, exec
    ds_write_b64 v8, v[14:15] offset:20512
    s_mov_b64 exec, -1
    s_waitcnt lgkmcnt(0)
    s_barrier
    s_setprio 3
    ds_add_rtn_u32 v24, v24, v2
    ds_add_rtn_u32 v25, v25, v2
    ds_add_rtn_u32 v26, v26, v2
    ds_add_rtn_u32 v27, v27, v2
    ds_read_b128 v[12:15], v0 offset:20480
    v_cmp_gt_u32 vcc, 8448, v0
    s_add_u32 s45, s35, 0x5484000
    s_add_u32 s45, s45, s93
    buffer_store_dwordx4 v[44:47], v0, s[20:23], s45 offen sc1
    s_add_u32 s46, s96, 0x8000000
    s_lshr_b32 s46, s46, 1
    buffer_load_dwordx2 v[44:45], v1, s[16:19], s46 offen nt
    s_add_u32 s47, s96, 0x8400000
    s_lshr_b32 s47, s47, 1
    buffer_load_dwordx2 v[46:47], v1, s[16:19], s47 offen nt
    ds_add_rtn_u32 v52, v52, v2
    ds_add_rtn_u32 v53, v53, v2
    ds_add_rtn_u32 v54, v54, v2
    ds_add_rtn_u32 v55, v55, v2
    s_setprio 2
    ds_add_rtn_u32 v72, v72, v2
    ds_add_rtn_u32 v73, v73, v2
    ds_add_rtn_u32 v74, v74, v2
    ds_add_rtn_u32 v75, v75, v2
    s_waitcnt lgkmcnt(8)
    s_cbranch_vccz L1_p4
    s_add_u32 s44, s35, 0x7ec0000
    s_mov_b64 exec, vcc
    buffer_store_dwordx4 v[12:15], v0, s[24:27], s44 offen sc1
    s_mov_b64 exec, -1
L1_p4:
    s_add_u32 s45, s35, 0x5488000
    s_add_u32 s45, s45, s72
    buffer_store_dwordx4 v[20:23], v0, s[20:23], s45 offen sc1
    s_add_u32 s46, s96, 0x8400000
    s_nop 0
    v_lshlrev_b32 v20, 1, v1
    buffer_load_dwordx4 v[20:23], v20, s[8:11], s46 offen nt
    ds_add_rtn_u32 v80, v80, v2
    ds_add_rtn_u32 v81, v81, v2
    ds_add_rtn_u32 v82, v82, v2
    ds_add_rtn_u32 v83, v83, v2
    s_setprio 1
    ds_add_rtn_u32 v96, v96, v2
    ds_add_rtn_u32 v97, v97, v2
    ds_add_rtn_u32 v98, v98, v2
    ds_add_rtn_u32 v99, v99, v2
    ds_add_rtn_u32 v100, v100, v2
    ds_add_rtn_u32 v101, v101, v2
    ds_add_rtn_u32 v102, v102, v2
    ds_add_rtn_u32 v103, v103, v2
    s_add_u32 s47, s35, 0x5488000
    s_add_u32 s47, s47, s73
    buffer_store_dwordx4 v[124:127], v0, s[20:23], s47 offen sc1
    s_add_u32 s44, s96, 0x8400000
    s_nop 0
    v_lshlrev_b32 v124, 1, v1
    buffer_load_dwordx4 v[124:127], v124, s[12:15], s44 offen nt
    s_setprio 0
    ds_add_rtn_u32 v88, v88, v2
    ds_add_rtn_u32 v89, v89, v2
    ds_add_rtn_u32 v90, v90, v2
    ds_add_rtn_u32 v91, v91, v2
    ds_add_rtn_u32 v92, v92, v2
    ds_add_rtn_u32 v93, v93, v2
    ds_add_rtn_u32 v94, v94, v2
    ds_add_rtn_u32 v95, v95, v2
    s_waitcnt lgkmcnt(0)
    s_barrier
    s_setprio 3
    v_and_b32 v7, -4, v24
    v_lshl_add_u32 v8, v24, 2, v7
    ds_write_b32 v8, v40
    v_lshl_add_u32 v7, v7, 2, v24
    ds_write_b8 v7, v84 offset:16
    v_and_b32 v9, -4, v25
    v_lshl_add_u32 v10, v25, 2, v9
    ds_write_b32 v10, v41
    v_lshl_add_u32 v9, v9, 2, v25
    ds_write_b8_d16_hi v9, v84 offset:16
    v_and_b32 v7, -4, v26
    v_lshl_add_u32 v8, v26, 2, v7
    ds_write_b32 v8, v42
    v_lshl_add_u32 v7, v7, 2, v26
    ds_write_b8 v7, v85 offset:16
    v_and_b32 v9, -4, v27
    v_lshl_add_u32 v10, v27, 2, v9
    ds_write_b32 v10, v43
    v_lshl_add_u32 v9, v9, 2, v27
    ds_write_b8_d16_hi v9, v85 offset:16
    s_add_u32 s45, s35, 0x5488000
    s_add_u32 s45, s45, s85
    buffer_store_dwordx4 v[32:35], v0, s[20:23], s45 offen sc1
    s_add_u32 s46, s96, 0x8800000
    v_lshlrev_b32 v40, 1, v1
    buffer_load_dwordx4 v[40:43], v40, s[8:11], s46 offen nt
    s_add_u32 s47, s96, 0x8800000
    v_lshlrev_b32 v24, 1, v1
    buffer_load_dwordx4 v[24:27], v24, s[12:15], s47 offen nt
    v_and_b32 v7, -4, v52
    v_lshl_add_u32 v8, v52, 2, v7
    ds_write_b32 v8, v48
    v_lshl_add_u32 v7, v7, 2, v52
    ds_write_b8 v7, v86 offset:16
    v_and_b32 v9, -4, v53
    v_lshl_add_u32 v10, v53, 2, v9
    ds_write_b32 v10, v49
    v_lshl_add_u32 v9, v9, 2, v53
    ds_write_b8_d16_hi v9, v86 offset:16
    v_and_b32 v7, -4, v54
    v_lshl_add_u32 v8, v54, 2, v7
    ds_write_b32 v8, v50
    v_lshl_add_u32 v7, v7, 2, v54
    ds_write_b8 v7, v87 offset:16
    v_and_b32 v9, -4, v55
    v_lshl_add_u32 v10, v55, 2, v9
    ds_write_b32 v10, v51
    v_lshl_add_u32 v9, v9, 2, v55
    ds_write_b8_d16_hi v9, v87 offset:16
    s_add_u32 s44, s96, 0x8800000
    s_lshr_b32 s44, s44, 1
    buffer_load_dwordx2 v[32:33], v1, s[16:19], s44 offen nt
    s_add_u32 s45, s96, 0x8c00000
    s_lshr_b32 s45, s45, 1
    buffer_load_dwordx2 v[34:35], v1, s[16:19], s45 offen nt
    s_add_u32 s46, s96, 0x8c00000
    v_lshlrev_b32 v48, 1, v1
    buffer_load_dwordx4 v[48:51], v48, s[8:11], s46 offen nt
    s_waitcnt vmcnt(10)
    v_lshlrev_b32 v7, 16, v44
    v_and_b32 v8, 0xffff0000, v44
    v_lshlrev_b32 v9, 16, v45
    v_and_b32 v10, 0xffff0000, v45
    v_mul_f32 v7, 0.15915494, v7
    v_mul_f32 v8, 0.15915494, v8
    v_mul_f32 v9, 0.15915494, v9
    v_mul_f32 v10, 0.15915494, v10
    v_mul_hi_u32_u24 v14, 429497, v16
    v_lshrrev_b32 v12, 3, v120
    v_cos_f32 v7, v7
    v_lshlrev_b16 v13, 3, v120
    v_mad_i32_i24 v11, v14, s55, v16
    v_bitop3_b32 v12, v6, v13, v12 bitop3:0xca
    v_lshl_add_u32 v11, v11, 17, s40
    v_lshlrev_b16 v14, 8, v14
    v_lshrrev_b32 v13, 2, v120
    v_add_u32 v16, v12, v11
    v_bitop3_b32 v120, v5, v13, v14 bitop3:0xea
    v_mul_hi_u32_u24 v14, 429497, v17
    v_lshrrev_b32 v12, 3, v121
    v_cos_f32 v8, v8
    v_lshlrev_b16 v13, 3, v121
    v_mad_i32_i24 v11, v14, s55, v17
    v_bitop3_b32 v12, v6, v13, v12 bitop3:0xca
    v_lshl_add_u32 v11, v11, 17, s40
    v_lshlrev_b16 v14, 8, v14
    v_lshrrev_b32 v13, 2, v121
    v_add_u32 v17, v12, v11
    v_bitop3_b32 v121, v5, v13, v14 bitop3:0xea
    v_cvt_pk_bf16_f32 v44, v7, v8
    v_perm_b32 v12, v44, v44, s41
    v_bitop3_b32 v16, v4, v12, v16 bitop3:0xca
    v_perm_b32 v13, v44, v44, s42
    v_bitop3_b32 v17, v4, v13, v17 bitop3:0xca
    v_mul_hi_u32_u24 v14, 429497, v18
    v_lshrrev_b32 v12, 3, v122
    v_cos_f32 v9, v9
    v_lshlrev_b16 v13, 3, v122
    v_mad_i32_i24 v11, v14, s55, v18
    v_bitop3_b32 v12, v6, v13, v12 bitop3:0xca
    v_lshl_add_u32 v11, v11, 17, s40
    v_lshlrev_b16 v14, 8, v14
    v_lshrrev_b32 v13, 2, v122
    v_add_u32 v18, v12, v11
    v_bitop3_b32 v122, v5, v13, v14 bitop3:0xea
    v_mul_hi_u32_u24 v14, 429497, v19
    v_lshrrev_b32 v12, 3, v123
    v_cos_f32 v10, v10
    v_lshlrev_b16 v13, 3, v123
    v_mad_i32_i24 v11, v14, s55, v19
    v_bitop3_b32 v12, v6, v13, v12 bitop3:0xca
    v_lshl_add_u32 v11, v11, 17, s40
    v_lshlrev_b16 v14, 8, v14
    v_lshrrev_b32 v13, 2, v123
    v_add_u32 v19, v12, v11
    v_bitop3_b32 v123, v5, v13, v14 bitop3:0xea
    v_cvt_pk_bf16_f32 v45, v9, v10
    v_perm_b32 v12, v45, v45, s41
    v_bitop3_b32 v18, v4, v12, v18 bitop3:0xca
    v_perm_b32 v13, v45, v45, s42
    v_bitop3_b32 v19, v4, v13, v19 bitop3:0xca
    s_setprio 2
    v_and_b32 v7, -4, v72
    v_lshl_add_u32 v8, v72, 2, v7
    ds_write_b32 v8, v68
    v_lshl_add_u32 v7, v7, 2, v72
    ds_write_b8 v7, v56 offset:16
    v_and_b32 v9, -4, v73
    v_lshl_add_u32 v10, v73, 2, v9
    ds_write_b32 v10, v69
    v_lshl_add_u32 v9, v9, 2, v73
    ds_write_b8_d16_hi v9, v56 offset:16
    v_and_b32 v7, -4, v74
    v_lshl_add_u32 v8, v74, 2, v7
    ds_write_b32 v8, v70
    v_lshl_add_u32 v7, v7, 2, v74
    ds_write_b8 v7, v57 offset:16
    v_and_b32 v9, -4, v75
    v_lshl_add_u32 v10, v75, 2, v9
    ds_write_b32 v10, v71
    v_lshl_add_u32 v9, v9, 2, v75
    ds_write_b8_d16_hi v9, v57 offset:16
    s_add_u32 s47, s35, 0x5488000
    s_add_u32 s47, s47, s91
    buffer_store_dwordx4 v[36:39], v0, s[20:23], s47 offen sc1
    s_add_u32 s44, s96, 0x8c00000
    v_lshlrev_b32 v52, 1, v1
    buffer_load_dwordx4 v[52:55], v52, s[12:15], s44 offen nt
    s_waitcnt vmcnt(8)
    v_lshlrev_b32 v7, 16, v46
    v_and_b32 v8, 0xffff0000, v46
    v_lshlrev_b32 v9, 16, v47
    v_and_b32 v10, 0xffff0000, v47
    v_mul_f32 v7, 0.15915494, v7
    v_mul_f32 v8, 0.15915494, v8
    v_mul_f32 v9, 0.15915494, v9
    v_mul_f32 v10, 0.15915494, v10
    v_mul_hi_u32_u24 v14, 429497, v20
    v_lshrrev_b32 v12, 3, v124
    v_cos_f32 v7, v7
    v_lshlrev_b16 v13, 3, v124
    v_mad_i32_i24 v11, v14, s55, v20
    v_bitop3_b32 v12, v6, v13, v12 bitop3:0xca
    v_lshl_add_u32 v11, v11, 17, s40
    v_lshlrev_b16 v14, 8, v14
    v_lshrrev_b32 v13, 2, v124
    v_add_u32 v20, v12, v11
    v_bitop3_b32 v124, v5, v13, v14 bitop3:0xea
    v_mul_hi_u32_u24 v14, 429497, v21
    v_lshrrev_b32 v12, 3, v125
    v_cos_f32 v8, v8
    v_lshlrev_b16 v13, 3, v125
    v_mad_i32_i24 v11, v14, s55, v21
    v_bitop3_b32 v12, v6, v13, v12 bitop3:0xca
    v_lshl_add_u32 v11, v11, 17, s40
    v_lshlrev_b16 v14, 8, v14
    v_lshrrev_b32 v13, 2, v125
    v_add_u32 v21, v12, v11
    v_bitop3_b32 v125, v5, v13, v14 bitop3:0xea
    v_cvt_pk_bf16_f32 v46, v7, v8
    v_perm_b32 v12, v46, v46, s41
    v_bitop3_b32 v20, v4, v12, v20 bitop3:0xca
    v_perm_b32 v13, v46, v46, s42
    v_bitop3_b32 v21, v4, v13, v21 bitop3:0xca
    v_mul_hi_u32_u24 v14, 429497, v22
    v_lshrrev_b32 v12, 3, v126
    v_cos_f32 v9, v9
    v_lshlrev_b16 v13, 3, v126
    v_mad_i32_i24 v11, v14, s55, v22
    v_bitop3_b32 v12, v6, v13, v12 bitop3:0xca
    v_lshl_add_u32 v11, v11, 17, s40
    v_lshlrev_b16 v14, 8, v14
    v_lshrrev_b32 v13, 2, v126
    v_add_u32 v22, v12, v11
    v_bitop3_b32 v126, v5, v13, v14 bitop3:0xea
    v_mul_hi_u32_u24 v14, 429497, v23
    v_lshrrev_b32 v12, 3, v127
    v_cos_f32 v10, v10
    v_lshlrev_b16 v13, 3, v127
    v_mad_i32_i24 v11, v14, s55, v23
    v_bitop3_b32 v12, v6, v13, v12 bitop3:0xca
    v_lshl_add_u32 v11, v11, 17, s40
    v_lshlrev_b16 v14, 8, v14
    v_lshrrev_b32 v13, 2, v127
    v_add_u32 v23, v12, v11
    v_bitop3_b32 v127, v5, v13, v14 bitop3:0xea
    v_cvt_pk_bf16_f32 v47, v9, v10
    v_perm_b32 v12, v47, v47, s41
    v_bitop3_b32 v22, v4, v12, v22 bitop3:0xca
    v_perm_b32 v13, v47, v47, s42
    v_bitop3_b32 v23, v4, v13, v23 bitop3:0xca
    v_and_b32 v7, -4, v80
    v_lshl_add_u32 v8, v80, 2, v7
    ds_write_b32 v8, v76
    v_lshl_add_u32 v7, v7, 2, v80
    ds_write_b8 v7, v58 offset:16
    v_and_b32 v9, -4, v81
    v_lshl_add_u32 v10, v81, 2, v9
    ds_write_b32 v10, v77
    v_lshl_add_u32 v9, v9, 2, v81
    ds_write_b8_d16_hi v9, v58 offset:16
    v_and_b32 v7, -4, v82
    v_lshl_add_u32 v8, v82, 2, v7
    ds_write_b32 v8, v78
    v_lshl_add_u32 v7, v7, 2, v82
    ds_write_b8 v7, v59 offset:16
    v_and_b32 v9, -4, v83
    v_lshl_add_u32 v10, v83, 2, v9
    ds_write_b32 v10, v79
    v_lshl_add_u32 v9, v9, 2, v83
    ds_write_b8_d16_hi v9, v59 offset:16
    s_add_u32 s45, s96, 0x9000000
    v_lshlrev_b32 v84, 1, v1
    buffer_load_dwordx4 v[84:87], v84, s[8:11], s45 offen nt
    s_add_u32 s46, s96, 0x9000000
    v_lshlrev_b32 v68, 1, v1
    buffer_load_dwordx4 v[68:71], v68, s[12:15], s46 offen nt
    s_waitcnt vmcnt(5)
    v_lshlrev_b32 v7, 16, v32
    v_and_b32 v8, 0xffff0000, v32
    v_lshlrev_b32 v9, 16, v33
    v_and_b32 v10, 0xffff0000, v33
    v_mul_f32 v7, 0.15915494, v7
    v_mul_f32 v8, 0.15915494, v8
    v_mul_f32 v9, 0.15915494, v9
    v_mul_f32 v10, 0.15915494, v10
    v_mul_hi_u32_u24 v14, 429497, v40
    v_lshrrev_b32 v12, 3, v24
    v_cos_f32 v7, v7
    v_lshlrev_b16 v13, 3, v24
    v_mad_i32_i24 v11, v14, s55, v40
    v_bitop3_b32 v12, v6, v13, v12 bitop3:0xca
    v_lshl_add_u32 v11, v11, 17, s40
    v_lshlrev_b16 v14, 8, v14
    v_lshrrev_b32 v13, 2, v24
    v_add_u32 v40, v12, v11
    v_bitop3_b32 v24, v5, v13, v14 bitop3:0xea
    v_mul_hi_u32_u24 v14, 429497, v41
    v_lshrrev_b32 v12, 3, v25
    v_cos_f32 v8, v8
    v_lshlrev_b16 v13, 3, v25
    v_mad_i32_i24 v11, v14, s55, v41
    v_bitop3_b32 v12, v6, v13, v12 bitop3:0xca
    v_lshl_add_u32 v11, v11, 17, s40
    v_lshlrev_b16 v14, 8, v14
    v_lshrrev_b32 v13, 2, v25
    v_add_u32 v41, v12, v11
    v_bitop3_b32 v25, v5, v13, v14 bitop3:0xea
    v_cvt_pk_bf16_f32 v32, v7, v8
    v_perm_b32 v12, v32, v32, s41
    v_bitop3_b32 v40, v4, v12, v40 bitop3:0xca
    v_perm_b32 v13, v32, v32, s42
    v_bitop3_b32 v41, v4, v13, v41 bitop3:0xca
    v_mul_hi_u32_u24 v14, 429497, v42
    v_lshrrev_b32 v12, 3, v26
    v_cos_f32 v9, v9
    v_lshlrev_b16 v13, 3, v26
    v_mad_i32_i24 v11, v14, s55, v42
    v_bitop3_b32 v12, v6, v13, v12 bitop3:0xca
    v_lshl_add_u32 v11, v11, 17, s40
    v_lshlrev_b16 v14, 8, v14
    v_lshrrev_b32 v13, 2, v26
    v_add_u32 v42, v12, v11
    v_bitop3_b32 v26, v5, v13, v14 bitop3:0xea
    v_mul_hi_u32_u24 v14, 429497, v43
    v_lshrrev_b32 v12, 3, v27
    v_cos_f32 v10, v10
    v_lshlrev_b16 v13, 3, v27
    v_mad_i32_i24 v11, v14, s55, v43
    v_bitop3_b32 v12, v6, v13, v12 bitop3:0xca
    v_lshl_add_u32 v11, v11, 17, s40
    v_lshlrev_b16 v14, 8, v14
    v_lshrrev_b32 v13, 2, v27
    v_add_u32 v43, v12, v11
    v_bitop3_b32 v27, v5, v13, v14 bitop3:0xea
    v_cvt_pk_bf16_f32 v33, v9, v10
    v_perm_b32 v12, v33, v33, s41
    v_bitop3_b32 v42, v4, v12, v42 bitop3:0xca
    v_perm_b32 v13, v33, v33, s42
    v_bitop3_b32 v43, v4, v13, v43 bitop3:0xca
    s_setprio 1
    v_and_b32 v7, -4, v96
    v_lshl_add_u32 v8, v96, 2, v7
    ds_write_b32 v8, v64
    v_lshl_add_u32 v7, v7, 2, v96
    ds_write_b8 v7, v104 offset:16
    v_and_b32 v9, -4, v97
    v_lshl_add_u32 v10, v97, 2, v9
    ds_write_b32 v10, v65
    v_lshl_add_u32 v9, v9, 2, v97
    ds_write_b8_d16_hi v9, v104 offset:16
    v_and_b32 v7, -4, v98
    v_lshl_add_u32 v8, v98, 2, v7
    ds_write_b32 v8, v66
    v_lshl_add_u32 v7, v7, 2, v98
    ds_write_b8 v7, v105 offset:16
    v_and_b32 v9, -4, v99
    v_lshl_add_u32 v10, v99, 2, v9
    ds_write_b32 v10, v67
    v_lshl_add_u32 v9, v9, 2, v99
    ds_write_b8_d16_hi v9, v105 offset:16
    s_add_u32 s47, s96, 0x9000000
    s_lshr_b32 s47, s47, 1
    buffer_load_dwordx2 v[72:73], v1, s[16:19], s47 offen nt
    s_cmp_le_u32 s43, 5
    s_cselect_b32 s18, 0, s18
    s_add_u32 s44, s38, 0x0
    s_lshr_b32 s44, s44, 1
    buffer_load_dwordx2 v[74:75], v1, s[16:19], s44 offen nt
    s_cmp_le_u32 s43, 5
    s_cselect_b32 s10, 0, s10
    s_add_u32 s45, s38, 0x0
    v_lshlrev_b32 v36, 1, v1
    buffer_load_dwordx4 v[36:39], v36, s[8:11], s45 offen nt
    v_and_b32 v7, -4, v100
    v_lshl_add_u32 v8, v100, 2, v7
    ds_write_b32 v8, v60
    v_lshl_add_u32 v7, v7, 2, v100
    ds_write_b8 v7, v106 offset:16
    v_and_b32 v9, -4, v101
    v_lshl_add_u32 v10, v101, 2, v9
    ds_write_b32 v10, v61
    v_lshl_add_u32 v9, v9, 2, v101
    ds_write_b8_d16_hi v9, v106 offset:16
    v_and_b32 v7, -4, v102
    v_lshl_add_u32 v8, v102, 2, v7
    ds_write_b32 v8, v62
    v_lshl_add_u32 v7, v7, 2, v102
    ds_write_b8 v7, v107 offset:16
    v_and_b32 v9, -4, v103
    v_lshl_add_u32 v10, v103, 2, v9
    ds_write_b32 v10, v63
    v_lshl_add_u32 v9, v9, 2, v103
    ds_write_b8_d16_hi v9, v107 offset:16
    s_add_u32 s46, s35, 0x5488000
    s_add_u32 s46, s46, s93
    buffer_store_dwordx4 v[28:31], v0, s[20:23], s46 offen sc1
    s_cmp_le_u32 s43, 5
    s_cselect_b32 s14, 0, s14
    s_add_u32 s47, s38, 0x0
    v_lshlrev_b32 v76, 1, v1
    buffer_load_dwordx4 v[76:79], v76, s[12:15], s47 offen nt
    s_waitcnt vmcnt(7)
    v_lshlrev_b32 v7, 16, v34
    v_and_b32 v8, 0xffff0000, v34
    v_lshlrev_b32 v9, 16, v35
    v_and_b32 v10, 0xffff0000, v35
    v_mul_f32 v7, 0.15915494, v7
    v_mul_f32 v8, 0.15915494, v8
    v_mul_f32 v9, 0.15915494, v9
    v_mul_f32 v10, 0.15915494, v10
    v_mul_hi_u32_u24 v14, 429497, v48
    v_lshrrev_b32 v12, 3, v52
    v_cos_f32 v7, v7
    v_lshlrev_b16 v13, 3, v52
    v_mad_i32_i24 v11, v14, s55, v48
    v_bitop3_b32 v12, v6, v13, v12 bitop3:0xca
    v_lshl_add_u32 v11, v11, 17, s40
    v_lshlrev_b16 v14, 8, v14
    v_lshrrev_b32 v13, 2, v52
    v_add_u32 v48, v12, v11
    v_bitop3_b32 v52, v5, v13, v14 bitop3:0xea
    v_mul_hi_u32_u24 v14, 429497, v49
    v_lshrrev_b32 v12, 3, v53
    v_cos_f32 v8, v8
    v_lshlrev_b16 v13, 3, v53
    v_mad_i32_i24 v11, v14, s55, v49
    v_bitop3_b32 v12, v6, v13, v12 bitop3:0xca
    v_lshl_add_u32 v11, v11, 17, s40
    v_lshlrev_b16 v14, 8, v14
    v_lshrrev_b32 v13, 2, v53
    v_add_u32 v49, v12, v11
    v_bitop3_b32 v53, v5, v13, v14 bitop3:0xea
    v_cvt_pk_bf16_f32 v34, v7, v8
    v_perm_b32 v12, v34, v34, s41
    v_bitop3_b32 v48, v4, v12, v48 bitop3:0xca
    v_perm_b32 v13, v34, v34, s42
    v_bitop3_b32 v49, v4, v13, v49 bitop3:0xca
    v_mul_hi_u32_u24 v14, 429497, v50
    v_lshrrev_b32 v12, 3, v54
    v_cos_f32 v9, v9
    v_lshlrev_b16 v13, 3, v54
    v_mad_i32_i24 v11, v14, s55, v50
    v_bitop3_b32 v12, v6, v13, v12 bitop3:0xca
    v_lshl_add_u32 v11, v11, 17, s40
    v_lshlrev_b16 v14, 8, v14
    v_lshrrev_b32 v13, 2, v54
    v_add_u32 v50, v12, v11
    v_bitop3_b32 v54, v5, v13, v14 bitop3:0xea
    v_mul_hi_u32_u24 v14, 429497, v51
    v_lshrrev_b32 v12, 3, v55
    v_cos_f32 v10, v10
    v_lshlrev_b16 v13, 3, v55
    v_mad_i32_i24 v11, v14, s55, v51
    v_bitop3_b32 v12, v6, v13, v12 bitop3:0xca
    v_lshl_add_u32 v11, v11, 17, s40
    v_lshlrev_b16 v14, 8, v14
    v_lshrrev_b32 v13, 2, v55
    v_add_u32 v51, v12, v11
    v_bitop3_b32 v55, v5, v13, v14 bitop3:0xea
    v_cvt_pk_bf16_f32 v35, v9, v10
    v_perm_b32 v12, v35, v35, s41
    v_bitop3_b32 v50, v4, v12, v50 bitop3:0xca
    v_perm_b32 v13, v35, v35, s42
    v_bitop3_b32 v51, v4, v13, v51 bitop3:0xca
    s_setprio 0
    v_and_b32 v7, -4, v88
    v_lshl_add_u32 v8, v88, 2, v7
    ds_write_b32 v8, v112
    v_lshl_add_u32 v7, v7, 2, v88
    ds_write_b8 v7, v108 offset:16
    v_and_b32 v9, -4, v89
    v_lshl_add_u32 v10, v89, 2, v9
    ds_write_b32 v10, v113
    v_lshl_add_u32 v9, v9, 2, v89
    ds_write_b8_d16_hi v9, v108 offset:16
    v_and_b32 v7, -4, v90
    v_lshl_add_u32 v8, v90, 2, v7
    ds_write_b32 v8, v114
    v_lshl_add_u32 v7, v7, 2, v90
    ds_write_b8 v7, v109 offset:16
    v_and_b32 v9, -4, v91
    v_lshl_add_u32 v10, v91, 2, v9
    ds_write_b32 v10, v115
    v_lshl_add_u32 v9, v9, 2, v91
    ds_write_b8_d16_hi v9, v109 offset:16
    s_cmp_le_u32 s43, 6
    s_cselect_b32 s10, 0, s10
    s_add_u32 s44, s39, 0x0
    v_lshlrev_b32 v80, 1, v1
    buffer_load_dwordx4 v[80:83], v80, s[8:11], s44 offen nt
    s_cmp_le_u32 s43, 6
    s_cselect_b32 s14, 0, s14
    s_add_u32 s45, s39, 0x0
    v_lshlrev_b32 v56, 1, v1
    buffer_load_dwordx4 v[56:59], v56, s[12:15], s45 offen nt
    s_waitcnt vmcnt(5)
    v_lshlrev_b32 v7, 16, v72
    v_and_b32 v8, 0xffff0000, v72
    v_lshlrev_b32 v9, 16, v73
    v_and_b32 v10, 0xffff0000, v73
    v_mul_f32 v7, 0.15915494, v7
    v_mul_f32 v8, 0.15915494, v8
    v_mul_f32 v9, 0.15915494, v9
    v_mul_f32 v10, 0.15915494, v10
    v_mul_hi_u32_u24 v14, 429497, v84
    v_lshrrev_b32 v12, 3, v68
    v_cos_f32 v7, v7
    v_lshlrev_b16 v13, 3, v68
    v_mad_i32_i24 v11, v14, s55, v84
    v_bitop3_b32 v12, v6, v13, v12 bitop3:0xca
    v_lshl_add_u32 v11, v11, 17, s40
    v_lshlrev_b16 v14, 8, v14
    v_lshrrev_b32 v13, 2, v68
    v_add_u32 v84, v12, v11
    v_bitop3_b32 v68, v5, v13, v14 bitop3:0xea
    v_mul_hi_u32_u24 v14, 429497, v85
    v_lshrrev_b32 v12, 3, v69
    v_cos_f32 v8, v8
    v_lshlrev_b16 v13, 3, v69
    v_mad_i32_i24 v11, v14, s55, v85
    v_bitop3_b32 v12, v6, v13, v12 bitop3:0xca
    v_lshl_add_u32 v11, v11, 17, s40
    v_lshlrev_b16 v14, 8, v14
    v_lshrrev_b32 v13, 2, v69
    v_add_u32 v85, v12, v11
    v_bitop3_b32 v69, v5, v13, v14 bitop3:0xea
    v_cvt_pk_bf16_f32 v72, v7, v8
    v_perm_b32 v12, v72, v72, s41
    v_bitop3_b32 v84, v4, v12, v84 bitop3:0xca
    v_perm_b32 v13, v72, v72, s42
    v_bitop3_b32 v85, v4, v13, v85 bitop3:0xca
    v_mul_hi_u32_u24 v14, 429497, v86
    v_lshrrev_b32 v12, 3, v70
    v_cos_f32 v9, v9
    v_lshlrev_b16 v13, 3, v70
    v_mad_i32_i24 v11, v14, s55, v86
    v_bitop3_b32 v12, v6, v13, v12 bitop3:0xca
    v_lshl_add_u32 v11, v11, 17, s40
    v_lshlrev_b16 v14, 8, v14
    v_lshrrev_b32 v13, 2, v70
    v_add_u32 v86, v12, v11
    v_bitop3_b32 v70, v5, v13, v14 bitop3:0xea
    v_mul_hi_u32_u24 v14, 429497, v87
    v_lshrrev_b32 v12, 3, v71
    v_cos_f32 v10, v10
    v_lshlrev_b16 v13, 3, v71
    v_mad_i32_i24 v11, v14, s55, v87
    v_bitop3_b32 v12, v6, v13, v12 bitop3:0xca
    v_lshl_add_u32 v11, v11, 17, s40
    v_lshlrev_b16 v14, 8, v14
    v_lshrrev_b32 v13, 2, v71
    v_add_u32 v87, v12, v11
    v_bitop3_b32 v71, v5, v13, v14 bitop3:0xea
    v_cvt_pk_bf16_f32 v73, v9, v10
    v_perm_b32 v12, v73, v73, s41
    v_bitop3_b32 v86, v4, v12, v86 bitop3:0xca
    v_perm_b32 v13, v73, v73, s42
    v_bitop3_b32 v87, v4, v13, v87 bitop3:0xca
    v_and_b32 v7, -4, v92
    v_lshl_add_u32 v8, v92, 2, v7
    ds_write_b32 v8, v116
    v_lshl_add_u32 v7, v7, 2, v92
    ds_write_b8 v7, v110 offset:16
    v_and_b32 v9, -4, v93
    v_lshl_add_u32 v10, v93, 2, v9
    ds_write_b32 v10, v117
    v_lshl_add_u32 v9, v9, 2, v93
    ds_write_b8_d16_hi v9, v110 offset:16
    v_and_b32 v7, -4, v94
    v_lshl_add_u32 v8, v94, 2, v7
    ds_write_b32 v8, v118
    v_lshl_add_u32 v7, v7, 2, v94
    ds_write_b8 v7, v111 offset:16
    v_and_b32 v9, -4, v95
    v_lshl_add_u32 v10, v95, 2, v9
    ds_write_b32 v10, v119
    v_lshl_add_u32 v9, v9, 2, v95
    ds_write_b8_d16_hi v9, v111 offset:16
    s_cmp_le_u32 s43, 6
    s_cselect_b32 s18, 0, s18
    s_add_u32 s46, s39, 0x0
    s_lshr_b32 s46, s46, 1
    buffer_load_dwordx2 v[64:65], v1, s[16:19], s46 offen nt
    s_cmp_le_u32 s43, 7
    s_cselect_b32 s18, 0, s18
    s_add_u32 s47, s58, 0x0
    s_lshr_b32 s47, s47, 1
    buffer_load_dwordx2 v[66:67], v1, s[16:19], s47 offen nt
    s_waitcnt vmcnt(4)
    s_cmp_le_u32 s43, 5
    s_cbranch_scc1 L1_s5
    v_lshlrev_b32 v7, 16, v74
    v_and_b32 v8, 0xffff0000, v74
    v_lshlrev_b32 v9, 16, v75
    v_and_b32 v10, 0xffff0000, v75
    v_mul_f32 v7, 0.15915494, v7
    v_mul_f32 v8, 0.15915494, v8
    v_mul_f32 v9, 0.15915494, v9
    v_mul_f32 v10, 0.15915494, v10
    v_mul_hi_u32_u24 v14, 429497, v36
    v_lshrrev_b32 v12, 3, v76
    v_cos_f32 v7, v7
    v_lshlrev_b16 v13, 3, v76
    v_mad_i32_i24 v11, v14, s55, v36
    v_bitop3_b32 v12, v6, v13, v12 bitop3:0xca
    v_lshl_add_u32 v11, v11, 17, s40
    v_lshlrev_b16 v14, 8, v14
    v_lshrrev_b32 v13, 2, v76
    v_add_u32 v36, v12, v11
    v_bitop3_b32 v76, v5, v13, v14 bitop3:0xea
    v_mul_hi_u32_u24 v14, 429497, v37
    v_lshrrev_b32 v12, 3, v77
    v_cos_f32 v8, v8
    v_lshlrev_b16 v13, 3, v77
    v_mad_i32_i24 v11, v14, s55, v37
    v_bitop3_b32 v12, v6, v13, v12 bitop3:0xca
    v_lshl_add_u32 v11, v11, 17, s40
    v_lshlrev_b16 v14, 8, v14
    v_lshrrev_b32 v13, 2, v77
    v_add_u32 v37, v12, v11
    v_bitop3_b32 v77, v5, v13, v14 bitop3:0xea
    v_cvt_pk_bf16_f32 v74, v7, v8
    v_perm_b32 v12, v74, v74, s41
    v_bitop3_b32 v36, v4, v12, v36 bitop3:0xca
    v_perm_b32 v13, v74, v74, s42
    v_bitop3_b32 v37, v4, v13, v37 bitop3:0xca
    v_mul_hi_u32_u24 v14, 429497, v38
    v_lshrrev_b32 v12, 3, v78
    v_cos_f32 v9, v9
    v_lshlrev_b16 v13, 3, v78
    v_mad_i32_i24 v11, v14, s55, v38
    v_bitop3_b32 v12, v6, v13, v12 bitop3:0xca
    v_lshl_add_u32 v11, v11, 17, s40
    v_lshlrev_b16 v14, 8, v14
    v_lshrrev_b32 v13, 2, v78
    v_add_u32 v38, v12, v11
    v_bitop3_b32 v78, v5, v13, v14 bitop3:0xea
    v_mul_hi_u32_u24 v14, 429497, v39
    v_lshrrev_b32 v12, 3, v79
    v_cos_f32 v10, v10
    v_lshlrev_b16 v13, 3, v79
    v_mad_i32_i24 v11, v14, s55, v39
    v_bitop3_b32 v12, v6, v13, v12 bitop3:0xca
    v_lshl_add_u32 v11, v11, 17, s40
    v_lshlrev_b16 v14, 8, v14
    v_lshrrev_b32 v13, 2, v79
    v_add_u32 v39, v12, v11
    v_bitop3_b32 v79, v5, v13, v14 bitop3:0xea
    v_cvt_pk_bf16_f32 v75, v9, v10
    v_perm_b32 v12, v75, v75, s41
    v_bitop3_b32 v38, v4, v12, v38 bitop3:0xca
    v_perm_b32 v13, v75, v75, s42
    v_bitop3_b32 v39, v4, v13, v39 bitop3:0xca
L1_s5:
    v_add_u32 v7, s72, v0
    v_add_u32 v12, s73, v0
    v_add_u32 v13, s85, v0
    v_add_u32 v14, s91, v0
    v_add_u32 v15, s93, v0
    s_min_i32 s3, s72, s73
    s_min_i32 s3, s3, s85
    s_min_i32 s3, s3, s91
    s_min_i32 s3, s3, s93
    v_add_u32 v3, s3, v0
    v_mov_b32 v8, 0
    v_mov_b32 v9, 0
    v_mov_b32 v10, 0
    v_mov_b32 v11, 0
    s_waitcnt lgkmcnt(0)
    s_barrier
    ds_read_b128 v[96:99], v7 offset:0
    ds_read_b128 v[60:63], v12 offset:0
    ds_read_b128 v[100:103], v13 offset:0
    ds_read_b128 v[104:107], v14 offset:0
    ds_read_b128 v[28:31], v15 offset:0
    ds_write_b128 v3, v[8:11]
    ds_read_b128 v[112:115], v7 offset:16384
    ds_read_b128 v[88:91], v12 offset:16384
    ds_read_b128 v[116:119], v13 offset:16384
    ds_read_b128 v[92:95], v14 offset:16384
    ds_read_b128 v[108:111], v15 offset:16384
    s_waitcnt lgkmcnt(0)
    s_barrier
    v_lshlrev_b32 v3, 3, v0
    v_and_b32 v3, 0x80, v3
    s_cmp_lg_u32 s32, 15
    s_cbranch_scc1 L2_k0
    s_mov_b64 exec, 3
    buffer_load_dword v3, v3, s[68:71], 0 offen sc1
    s_mov_b64 exec, -1
L2_k0:
    s_add_u32 s44, s35, 0x7ec4000
    s_add_u32 s44, s44, s72
    buffer_store_dwordx4 v[96:99], v0, s[20:23], s44 offen sc1
    s_cmp_le_u32 s43, 7
    s_cselect_b32 s10, 0, s10
    s_add_u32 s45, s58, 0x0
    v_lshlrev_b32 v96, 1, v1
    buffer_load_dwordx4 v[96:99], v96, s[8:11], s45 offen nt
    s_add_u32 s46, s35, 0x7ec4000
    s_add_u32 s46, s46, s73
    buffer_store_dwordx4 v[60:63], v0, s[20:23], s46 offen sc1
    s_cmp_le_u32 s43, 7
    s_cselect_b32 s14, 0, s14
    s_add_u32 s47, s58, 0x0
    v_lshlrev_b32 v60, 1, v1
    buffer_load_dwordx4 v[60:63], v60, s[12:15], s47 offen nt
    s_setprio 3
    ds_add_u32 v120, v2
    ds_add_u32 v121, v2
    ds_add_u32 v122, v2
    ds_add_u32 v123, v2
    ds_add_u32 v124, v2
    ds_add_u32 v125, v2
    ds_add_u32 v126, v2
    ds_add_u32 v127, v2
    s_setprio 2
    s_add_u32 s44, s35, 0x7ec4000
    s_add_u32 s44, s44, s85
    buffer_store_dwordx4 v[100:103], v0, s[20:23], s44 offen sc1
    ds_add_u32 v24, v2
    ds_add_u32 v25, v2
    ds_add_u32 v26, v2
    ds_add_u32 v27, v2
    ds_add_u32 v52, v2
    ds_add_u32 v53, v2
    ds_add_u32 v54, v2
    ds_add_u32 v55, v2
    s_setprio 1
    ds_add_u32 v68, v2
    ds_add_u32 v69, v2
    ds_add_u32 v70, v2
    ds_add_u32 v71, v2
    s_add_u32 s45, s35, 0x7ec4000
    s_add_u32 s45, s45, s91
    buffer_store_dwordx4 v[104:107], v0, s[20:23], s45 offen sc1
    s_cmp_le_u32 s43, 5
    s_cbranch_scc1 L1_s6
    ds_add_u32 v76, v2
    ds_add_u32 v77, v2
    ds_add_u32 v78, v2
    ds_add_u32 v79, v2
L1_s6:
    s_setprio 0
    s_waitcnt vmcnt(6)
    s_cmp_le_u32 s43, 6
    s_cbranch_scc1 L1_s7
    v_lshlrev_b32 v7, 16, v64
    v_and_b32 v8, 0xffff0000, v64
    v_lshlrev_b32 v9, 16, v65
    v_and_b32 v10, 0xffff0000, v65
    v_mul_f32 v7, 0.15915494, v7
    v_mul_f32 v8, 0.15915494, v8
    v_mul_f32 v9, 0.15915494, v9
    v_mul_f32 v10, 0.15915494, v10
    v_mul_hi_u32_u24 v14, 429497, v80
    v_lshrrev_b32 v12, 3, v56
    v_cos_f32 v7, v7
    v_lshlrev_b16 v13, 3, v56
    v_mad_i32_i24 v11, v14, s55, v80
    v_bitop3_b32 v12, v6, v13, v12 bitop3:0xca
    v_lshl_add_u32 v11, v11, 17, s40
    v_lshlrev_b16 v14, 8, v14
    v_lshrrev_b32 v13, 2, v56
    v_add_u32 v80, v12, v11
    v_bitop3_b32 v56, v5, v13, v14 bitop3:0xea
    ds_add_u32 v56, v2
    v_mul_hi_u32_u24 v14, 429497, v81
    v_lshrrev_b32 v12, 3, v57
    v_cos_f32 v8, v8
    v_lshlrev_b16 v13, 3, v57
    v_mad_i32_i24 v11, v14, s55, v81
    v_bitop3_b32 v12, v6, v13, v12 bitop3:0xca
    v_lshl_add_u32 v11, v11, 17, s40
    v_lshlrev_b16 v14, 8, v14
    v_lshrrev_b32 v13, 2, v57
    v_add_u32 v81, v12, v11
    v_bitop3_b32 v57, v5, v13, v14 bitop3:0xea
    ds_add_u32 v57, v2
    v_cvt_pk_bf16_f32 v64, v7, v8
    v_perm_b32 v12, v64, v64, s41
    v_bitop3_b32 v80, v4, v12, v80 bitop3:0xca
    v_perm_b32 v13, v64, v64, s42
    v_bitop3_b32 v81, v4, v13, v81 bitop3:0xca
    v_mul_hi_u32_u24 v14, 429497, v82
    v_lshrrev_b32 v12, 3, v58
    v_cos_f32 v9, v9
    v_lshlrev_b16 v13, 3, v58
    v_mad_i32_i24 v11, v14, s55, v82
    v_bitop3_b32 v12, v6, v13, v12 bitop3:0xca
    v_lshl_add_u32 v11, v11, 17, s40
    v_lshlrev_b16 v14, 8, v14
    v_lshrrev_b32 v13, 2, v58
    v_add_u32 v82, v12, v11
    v_bitop3_b32 v58, v5, v13, v14 bitop3:0xea
    ds_add_u32 v58, v2
    v_mul_hi_u32_u24 v14, 429497, v83
    v_lshrrev_b32 v12, 3, v59
    v_cos_f32 v10, v10
    v_lshlrev_b16 v13, 3, v59
    v_mad_i32_i24 v11, v14, s55, v83
    v_bitop3_b32 v12, v6, v13, v12 bitop3:0xca
    v_lshl_add_u32 v11, v11, 17, s40
    v_lshlrev_b16 v14, 8, v14
    v_lshrrev_b32 v13, 2, v59
    v_add_u32 v83, v12, v11
    v_bitop3_b32 v59, v5, v13, v14 bitop3:0xea
    ds_add_u32 v59, v2
    v_cvt_pk_bf16_f32 v65, v9, v10
    v_perm_b32 v12, v65, v65, s41
    v_bitop3_b32 v82, v4, v12, v82 bitop3:0xca
    v_perm_b32 v13, v65, v65, s42
    v_bitop3_b32 v83, v4, v13, v83 bitop3:0xca
L1_s7:
    s_waitcnt vmcnt(2)
    s_cmp_le_u32 s43, 7
    s_cbranch_scc1 L1_s8
    v_lshlrev_b32 v7, 16, v66
    v_and_b32 v8, 0xffff0000, v66
    v_lshlrev_b32 v9, 16, v67
    v_and_b32 v10, 0xffff0000, v67
    v_mul_f32 v7, 0.15915494, v7
    v_mul_f32 v8, 0.15915494, v8
    v_mul_f32 v9, 0.15915494, v9
    v_mul_f32 v10, 0.15915494, v10
    v_mul_hi_u32_u24 v14, 429497, v96
    v_lshrrev_b32 v12, 3, v60
    v_cos_f32 v7, v7
    v_lshlrev_b16 v13, 3, v60
    v_mad_i32_i24 v11, v14, s55, v96
    v_bitop3_b32 v12, v6, v13, v12 bitop3:0xca
    v_lshl_add_u32 v11, v11, 17, s40
    v_lshlrev_b16 v14, 8, v14
    v_lshrrev_b32 v13, 2, v60
    v_add_u32 v96, v12, v11
    v_bitop3_b32 v60, v5, v13, v14 bitop3:0xea
    ds_add_u32 v60, v2
    v_mul_hi_u32_u24 v14, 429497, v97
    v_lshrrev_b32 v12, 3, v61
    v_cos_f32 v8, v8
    v_lshlrev_b16 v13, 3, v61
    v_mad_i32_i24 v11, v14, s55, v97
    v_bitop3_b32 v12, v6, v13, v12 bitop3:0xca
    v_lshl_add_u32 v11, v11, 17, s40
    v_lshlrev_b16 v14, 8, v14
    v_lshrrev_b32 v13, 2, v61
    v_add_u32 v97, v12, v11
    v_bitop3_b32 v61, v5, v13, v14 bitop3:0xea
    ds_add_u32 v61, v2
    v_cvt_pk_bf16_f32 v66, v7, v8
    v_perm_b32 v12, v66, v66, s41
    v_bitop3_b32 v96, v4, v12, v96 bitop3:0xca
    v_perm_b32 v13, v66, v66, s42
    v_bitop3_b32 v97, v4, v13, v97 bitop3:0xca
    v_mul_hi_u32_u24 v14, 429497, v98
    v_lshrrev_b32 v12, 3, v62
    v_cos_f32 v9, v9
    v_lshlrev_b16 v13, 3, v62
    v_mad_i32_i24 v11, v14, s55, v98
    v_bitop3_b32 v12, v6, v13, v12 bitop3:0xca
    v_lshl_add_u32 v11, v11, 17, s40
    v_lshlrev_b16 v14, 8, v14
    v_lshrrev_b32 v13, 2, v62
    v_add_u32 v98, v12, v11
    v_bitop3_b32 v62, v5, v13, v14 bitop3:0xea
    ds_add_u32 v62, v2
    v_mul_hi_u32_u24 v14, 429497, v99
    v_lshrrev_b32 v12, 3, v63
    v_cos_f32 v10, v10
    v_lshlrev_b16 v13, 3, v63
    v_mad_i32_i24 v11, v14, s55, v99
    v_bitop3_b32 v12, v6, v13, v12 bitop3:0xca
    v_lshl_add_u32 v11, v11, 17, s40
    v_lshlrev_b16 v14, 8, v14
    v_lshrrev_b32 v13, 2, v63
    v_add_u32 v99, v12, v11
    v_bitop3_b32 v63, v5, v13, v14 bitop3:0xea
    ds_add_u32 v63, v2
    v_cvt_pk_bf16_f32 v67, v9, v10
    v_perm_b32 v12, v67, v67, s41
    v_bitop3_b32 v98, v4, v12, v98 bitop3:0xca
    v_perm_b32 v13, v67, v67, s42
    v_bitop3_b32 v99, v4, v13, v99 bitop3:0xca
L1_s8:
    v_lshrrev_b32 v8, 2, v0
    v_and_b32 v7, 0x3c00, v0
    v_bitop3_b32 v7, v5, v8, v7 bitop3:0xea
    s_waitcnt lgkmcnt(0)
    s_barrier
    ds_read2st64_b32 v[8:9], v7 offset0:0 offset1:1
    ds_read2st64_b32 v[10:11], v7 offset0:2 offset1:3
    s_waitcnt lgkmcnt(0)
    v_lshl_or_b32 v12, v9, 16, v8
    v_lshl_or_b32 v13, v11, 16, v10
    v_mov_b32 v14, v12
    v_mov_b32 v15, v13
    s_nop 0
    v_add_u32_dpp v14, v14, v14 row_shr:1 row_mask:0xf bank_mask:0xf bound_ctrl:1
    v_add_u32_dpp v15, v15, v15 row_shr:1 row_mask:0xf bank_mask:0xf bound_ctrl:1
    s_nop 0
    v_add_u32_dpp v14, v14, v14 row_shr:2 row_mask:0xf bank_mask:0xf bound_ctrl:1
    v_add_u32_dpp v15, v15, v15 row_shr:2 row_mask:0xf bank_mask:0xf bound_ctrl:1
    s_nop 0
    v_add_u32_dpp v14, v14, v14 row_shr:4 row_mask:0xf bank_mask:0xf bound_ctrl:1
    v_add_u32_dpp v15, v15, v15 row_shr:4 row_mask:0xf bank_mask:0xf bound_ctrl:1
    s_nop 0
    v_add_u32_dpp v14, v14, v14 row_shr:8 row_mask:0xf bank_mask:0xf bound_ctrl:1
    v_add_u32_dpp v15, v15, v15 row_shr:8 row_mask:0xf bank_mask:0xf bound_ctrl:1
    s_nop 0
    v_add_u32_dpp v14, v14, v14 row_bcast:15 row_mask:0xa bank_mask:0xf
    v_add_u32_dpp v15, v15, v15 row_bcast:15 row_mask:0xa bank_mask:0xf
    s_nop 0
    v_add_u32_dpp v14, v14, v14 row_bcast:31 row_mask:0xc bank_mask:0xf
    v_add_u32_dpp v15, v15, v15 row_bcast:31 row_mask:0xc bank_mask:0xf
    v_readlane_b32 s48, v14, 63
    v_readlane_b32 s49, v15, 63
    s_lshl_b32 s54, s32, 2
    v_mov_b32 v8, s54
    s_and_b32 s50, s48, 0xffff
    s_lshr_b32 s51, s48, 16
    s_and_b32 s52, s49, 0xffff
    s_lshr_b32 s53, s49, 16
    s_add_u32 s51, s51, s50
    s_add_u32 s52, s52, s51
    s_add_u32 s53, s53, s52
    v_mov_b32 v9, s53
    v_and_b32_dpp v3, v3, v3 quad_perm:[1,0,3,2] row_mask:0xf bank_mask:0xf
    s_mov_b64 exec, 1
    ds_write_b32 v8, v9 offset:16384
    ds_write_b32 v8, v3 offset:16448
    s_mov_b64 exec, -1
    v_and_b32 v8, 60, v7
    s_waitcnt lgkmcnt(0)
    s_barrier
    ds_read_b32 v9, v8 offset:16384
    ds_read_b32 v10, v8 offset:16448
    s_waitcnt lgkmcnt(0)
    v_readlane_b32 s56, v10, 15
    s_xor_b32 s56, s56, 0x80
    v_add_u32_dpp v9, v9, v9 row_shr:1 row_mask:0xf bank_mask:0xf bound_ctrl:1
    s_nop 1
    v_add_u32_dpp v9, v9, v9 row_shr:2 row_mask:0xf bank_mask:0xf bound_ctrl:1
    s_nop 1
    v_add_u32_dpp v9, v9, v9 row_shr:4 row_mask:0xf bank_mask:0xf bound_ctrl:1
    s_nop 1
    v_add_u32_dpp v9, v9, v9 row_shr:8 row_mask:0xf bank_mask:0xf bound_ctrl:1
    s_nop 0
    v_readlane_b32 s54, v9, s32
    s_sub_u32 s54, s54, s53
    s_add_u32 s50, s50, s54
    s_add_u32 s51, s51, s54
    s_add_u32 s52, s52, s54
    s_pack_ll_b32_b16 s48, s54, s50
    s_pack_ll_b32_b16 s49, s51, s52
    v_add_u32 v14, s48, v14
    v_add_u32 v15, s49, v15
    v_sub_u32 v12, v14, v12
    v_sub_u32 v13, v15, v13
    v_and_b32 v8, 0xffff, v12
    v_lshrrev_b32 v9, 16, v12
    v_and_b32 v10, 0xffff, v13
    v_lshrrev_b32 v11, 16, v13
    ds_write2st64_b32 v7, v8, v9 offset0:0 offset1:1
    ds_write2st64_b32 v7, v10, v11 offset0:2 offset1:3
    v_and_b32 v8, 0x3f0, v0
    v_lshl_add_u32 v8, v8, 1, s36
    ds_write_b64 v8, v[12:13] offset:20480
    s_bitset0_b64 exec, 63
    s_not_b64 exec, exec
    ds_write_b64 v8, v[14:15] offset:20512
    s_mov_b64 exec, -1
    s_waitcnt lgkmcnt(0)
    s_barrier
    s_setprio 3
    ds_add_rtn_u32 v120, v120, v2
    ds_add_rtn_u32 v121, v121, v2
    ds_add_rtn_u32 v122, v122, v2
    ds_add_rtn_u32 v123, v123, v2
    ds_read_b128 v[12:15], v0 offset:20480
    v_cmp_gt_u32 vcc, 8448, v0
    s_add_u32 s46, s35, 0x7ec4000
    s_add_u32 s46, s46, s93
    buffer_store_dwordx4 v[28:31], v0, s[20:23], s46 offen sc1
    ds_add_rtn_u32 v124, v124, v2
    ds_add_rtn_u32 v125, v125, v2
    ds_add_rtn_u32 v126, v126, v2
    ds_add_rtn_u32 v127, v127, v2
    s_setprio 2
    ds_add_rtn_u32 v24, v24, v2
    ds_add_rtn_u32 v25, v25, v2
    ds_add_rtn_u32 v26, v26, v2
    ds_add_rtn_u32 v27, v27, v2
    s_waitcnt lgkmcnt(8)
    s_cbranch_vccz L1_p9
    s_add_u32 s47, s35, 0xa900000
    s_mov_b64 exec, vcc
    buffer_store_dwordx4 v[12:15], v0, s[24:27], s47 offen sc1
    s_mov_b64 exec, -1
L1_p9:
    s_add_u32 s44, s35, 0x7ec8000
    s_add_u32 s44, s44, s72
    buffer_store_dwordx4 v[112:115], v0, s[20:23], s44 offen sc1
    ds_add_rtn_u32 v52, v52, v2
    ds_add_rtn_u32 v53, v53, v2
    ds_add_rtn_u32 v54, v54, v2
    ds_add_rtn_u32 v55, v55, v2
    s_load_dwordx2 s[28:29], s[0:1], 0
    s_load_dwordx2 s[50:51], s[0:1], 40
    s_load_dwordx2 s[52:53], s[0:1], 24
    s_setprio 1
    ds_add_rtn_u32 v68, v68, v2
    ds_add_rtn_u32 v69, v69, v2
    ds_add_rtn_u32 v70, v70, v2
    ds_add_rtn_u32 v71, v71, v2
    s_cmp_le_u32 s43, 5
    s_cbranch_scc1 L1_s10
    ds_add_rtn_u32 v76, v76, v2
    ds_add_rtn_u32 v77, v77, v2
    ds_add_rtn_u32 v78, v78, v2
    ds_add_rtn_u32 v79, v79, v2
L1_s10:
    s_add_u32 s45, s35, 0x7ec8000
    s_add_u32 s45, s45, s73
    buffer_store_dwordx4 v[88:91], v0, s[20:23], s45 offen sc1
    s_setprio 0
    s_cmp_le_u32 s43, 6
    s_cbranch_scc1 L1_s11
    ds_add_rtn_u32 v56, v56, v2
    ds_add_rtn_u32 v57, v57, v2
    ds_add_rtn_u32 v58, v58, v2
    ds_add_rtn_u32 v59, v59, v2
L1_s11:
    s_cmp_le_u32 s43, 7
    s_cbranch_scc1 L1_s12
    ds_add_rtn_u32 v60, v60, v2
    ds_add_rtn_u32 v61, v61, v2
    ds_add_rtn_u32 v62, v62, v2
    ds_add_rtn_u32 v63, v63, v2
L1_s12:
    s_waitcnt lgkmcnt(0)
    s_barrier
    s_load_dwordx4 s[96:99], s[50:51], 0
    s_mov_b64 s[4:5], s[52:53]
    s_bfe_u32 s33, s2, 0x20001
    s_and_b32 s34, s2, 1
    s_lshl_b32 s34, s34, 5
    s_lshr_b32 s3, s2, 3
    s_add_u32 s34, s34, s3
    s_mul_i32 s39, s33, 2080
    s_lshl_b32 s3, s34, 5
    s_add_u32 s39, s39, s3
    s_mul_i32 s40, s33, 1310720
    s_add_u32 s40, s40, 0x50000
    s_lshl_b32 s38, s32, 11
    s_mul_i32 s100, s32, 3072
    s_add_u32 s8, s30, 0x4000
    s_addc_u32 s9, s31, 0
    s_mov_b32 s10, 0xd340000
    s_mov_b32 s11, 0x20000
    s_add_u32 s12, s30, 0x2c000
    s_addc_u32 s13, s31, 0
    s_mov_b32 s14, 0xd318000
    s_mov_b32 s15, 0x20000
    s_mov_b32 s16, s64
    s_mov_b32 s17, s65
    s_mov_b32 s18, 0x20
    s_mov_b32 s19, 0x20000
    s_mov_b32 s24, s28
    s_mov_b32 s25, s29
    s_mov_b32 s26, 0x4e2000
    s_mov_b32 s27, 0x20000
    s_setprio 3
    v_and_b32 v7, -4, v120
    v_lshl_add_u32 v8, v120, 2, v7
    ds_write_b32 v8, v16
    v_lshl_add_u32 v7, v7, 2, v120
    ds_write_b8 v7, v44 offset:16
    v_and_b32 v9, -4, v121
    v_lshl_add_u32 v10, v121, 2, v9
    ds_write_b32 v10, v17
    v_lshl_add_u32 v9, v9, 2, v121
    ds_write_b8_d16_hi v9, v44 offset:16
    v_and_b32 v7, -4, v122
    v_lshl_add_u32 v8, v122, 2, v7
    ds_write_b32 v8, v18
    v_lshl_add_u32 v7, v7, 2, v122
    ds_write_b8 v7, v45 offset:16
    v_and_b32 v9, -4, v123
    v_lshl_add_u32 v10, v123, 2, v9
    ds_write_b32 v10, v19
    v_lshl_add_u32 v9, v9, 2, v123
    ds_write_b8_d16_hi v9, v45 offset:16
    s_add_u32 s46, s35, 0x7ec8000
    s_add_u32 s46, s46, s85
    buffer_store_dwordx4 v[116:119], v0, s[20:23], s46 offen sc1
    v_and_b32 v13, 0x3f0, v0
    v_and_b32 v14, 0x300, v13
    v_bfe_u32 v15, v13, 4, 4
    s_lshl_b32 s3, s32, 4
    v_add3_u32 v14, v14, v15, s3
    v_mul_u32_u24 v2, 173056, v14
    v_lshrrev_b32 v14, 6, v13
    s_add_u32 s3, s3, 0x400
    v_add_u32 v14, s3, v14
    v_mul_u32_u24 v4, 173056, v14
    v_and_b32 v14, 3, v14
    v_and_b32 v15, 0x30, v13
    v_lshl_add_u32 v14, v14, 5, v15
    v_add_u32 v6, v14, v4
    v_lshl_add_u32 v5, v15, 1, v2
    v_lshrrev_b32 v14, 3, v15
    buffer_load_ushort v100, v14, s[16:19], 0 offen offset:0
    buffer_load_ushort v101, v14, s[16:19], 0 offen offset:8
    buffer_load_ushort v102, v14, s[16:19], 0 offen offset:16
    buffer_load_ushort v103, v14, s[16:19], 0 offen offset:24
    s_mul_i32 s3, s32, 5120
    v_add_u32 v3, s3, v13
    v_lshrrev_b32 v14, 2, v13
    v_add_u32 v14, s38, v14
    v_and_b32 v7, -4, v124
    v_lshl_add_u32 v8, v124, 2, v7
    ds_write_b32 v8, v20
    v_lshl_add_u32 v7, v7, 2, v124
    ds_write_b8 v7, v46 offset:16
    v_and_b32 v9, -4, v125
    v_lshl_add_u32 v10, v125, 2, v9
    ds_write_b32 v10, v21
    v_lshl_add_u32 v9, v9, 2, v125
    ds_write_b8_d16_hi v9, v46 offset:16
    v_and_b32 v7, -4, v126
    v_lshl_add_u32 v8, v126, 2, v7
    ds_write_b32 v8, v22
    v_lshl_add_u32 v7, v7, 2, v126
    ds_write_b8 v7, v47 offset:16
    v_and_b32 v9, -4, v127
    v_lshl_add_u32 v10, v127, 2, v9
    ds_write_b32 v10, v23
    v_lshl_add_u32 v9, v9, 2, v127
    ds_write_b8_d16_hi v9, v47 offset:16
    s_setprio 2
    v_and_b32 v7, -4, v24
    v_lshl_add_u32 v8, v24, 2, v7
    ds_write_b32 v8, v40
    v_lshl_add_u32 v7, v7, 2, v24
    ds_write_b8 v7, v32 offset:16
    v_and_b32 v9, -4, v25
    v_lshl_add_u32 v10, v25, 2, v9
    ds_write_b32 v10, v41
    v_lshl_add_u32 v9, v9, 2, v25
    ds_write_b8_d16_hi v9, v32 offset:16
    v_and_b32 v7, -4, v26
    v_lshl_add_u32 v8, v26, 2, v7
    ds_write_b32 v8, v42
    v_lshl_add_u32 v7, v7, 2, v26
    ds_write_b8 v7, v33 offset:16
    v_and_b32 v9, -4, v27
    v_lshl_add_u32 v10, v27, 2, v9
    ds_write_b32 v10, v43
    v_lshl_add_u32 v9, v9, 2, v27
    ds_write_b8_d16_hi v9, v33 offset:16
    s_add_u32 s47, s35, 0x7ec8000
    s_add_u32 s47, s47, s91
    buffer_store_dwordx4 v[92:95], v0, s[20:23], s47 offen sc1
    v_lshrrev_b32 v11, 2, v0
    v_and_b32 v11, 0xfc, v11
    s_cmp_ge_u32 s84, 128
    s_cselect_b32 s82, 0, s82
    s_mul_i32 s3, s84, 40
    s_add_u32 s3, s3, s32
    s_mul_i32 s76, s3, 52429
    s_lshr_b32 s76, s76, 22
    s_mul_i32 s74, s76, 80
    s_sub_u32 s3, s3, s74
    s_mul_i32 s74, s3, 205
    s_lshr_b32 s74, s74, 10
    s_mul_i32 s75, s74, 5
    s_sub_u32 s75, s3, s75
    s_lshl_b32 s48, s74, 1
    s_add_u32 s48, s48, s75
    s_add_u32 s49, s48, s74
    s_add_u32 s49, s49, 30
    s_cmp_lt_u32 s75, 2
    s_cselect_b32 s48, s48, s49
    s_lshl_b32 s48, s48, 10
    s_mul_i32 s49, s76, 80000
    s_add_u32 s48, s48, s49
    buffer_load_dword v104, v11, s[80:83], s48 offen offset:0
    buffer_load_dword v105, v11, s[80:83], s48 offen offset:256
    buffer_load_dword v106, v11, s[80:83], s48 offen offset:512
    buffer_load_dword v107, v11, s[80:83], s48 offen offset:768
    s_mul_i32 s3, s84, 40
    s_add_u32 s3, s3, s32
    s_add_u32 s3, s3, 16
    s_mul_i32 s76, s3, 52429
    s_lshr_b32 s76, s76, 22
    s_mul_i32 s74, s76, 80
    s_sub_u32 s3, s3, s74
    s_mul_i32 s74, s3, 205
    s_lshr_b32 s74, s74, 10
    s_mul_i32 s75, s74, 5
    s_sub_u32 s75, s3, s75
    s_lshl_b32 s48, s74, 1
    s_add_u32 s48, s48, s75
    s_add_u32 s49, s48, s74
    s_add_u32 s49, s49, 30
    s_cmp_lt_u32 s75, 2
    s_cselect_b32 s48, s48, s49
    s_lshl_b32 s48, s48, 10
    s_mul_i32 s49, s76, 80000
    s_add_u32 s48, s48, s49
    buffer_load_dword v28, v11, s[80:83], s48 offen offset:0
    buffer_load_dword v29, v11, s[80:83], s48 offen offset:256
    buffer_load_dword v30, v11, s[80:83], s48 offen offset:512
    buffer_load_dword v31, v11, s[80:83], s48 offen offset:768
    s_mul_i32 s3, s84, 40
    s_add_u32 s3, s3, s32
    s_add_u32 s3, s3, 32
    s_mul_i32 s76, s3, 52429
    s_lshr_b32 s76, s76, 22
    s_mul_i32 s74, s76, 80
    s_sub_u32 s3, s3, s74
    s_cmp_ge_u32 s32, 8
    s_cselect_b32 s82, 0, s82
    s_mul_i32 s74, s3, 205
    s_lshr_b32 s74, s74, 10
    s_mul_i32 s75, s74, 5
    s_sub_u32 s75, s3, s75
    s_lshl_b32 s48, s74, 1
    s_add_u32 s48, s48, s75
    s_add_u32 s49, s48, s74
    s_add_u32 s49, s49, 30
    s_cmp_lt_u32 s75, 2
    s_cselect_b32 s48, s48, s49
    s_lshl_b32 s48, s48, 10
    s_mul_i32 s49, s76, 80000
    s_add_u32 s48, s48, s49
    buffer_load_dword v112, v11, s[80:83], s48 offen offset:0
    buffer_load_dword v113, v11, s[80:83], s48 offen offset:256
    buffer_load_dword v114, v11, s[80:83], s48 offen offset:512
    buffer_load_dword v115, v11, s[80:83], s48 offen offset:768
    v_and_b32 v7, -4, v52
    v_lshl_add_u32 v8, v52, 2, v7
    ds_write_b32 v8, v48
    v_lshl_add_u32 v7, v7, 2, v52
    ds_write_b8 v7, v34 offset:16
    v_and_b32 v9, -4, v53
    v_lshl_add_u32 v10, v53, 2, v9
    ds_write_b32 v10, v49
    v_lshl_add_u32 v9, v9, 2, v53
    ds_write_b8_d16_hi v9, v34 offset:16
    v_and_b32 v7, -4, v54
    v_lshl_add_u32 v8, v54, 2, v7
    ds_write_b32 v8, v50
    v_lshl_add_u32 v7, v7, 2, v54
    ds_write_b8 v7, v35 offset:16
    v_and_b32 v9, -4, v55
    v_lshl_add_u32 v10, v55, 2, v9
    ds_write_b32 v10, v51
    v_lshl_add_u32 v9, v9, 2, v55
    ds_write_b8_d16_hi v9, v35 offset:16
    s_setprio 1
    v_and_b32 v7, -4, v68
    v_lshl_add_u32 v8, v68, 2, v7
    ds_write_b32 v8, v84
    v_lshl_add_u32 v7, v7, 2, v68
    ds_write_b8 v7, v72 offset:16
    v_and_b32 v9, -4, v69
    v_lshl_add_u32 v10, v69, 2, v9
    ds_write_b32 v10, v85
    v_lshl_add_u32 v9, v9, 2, v69
    ds_write_b8_d16_hi v9, v72 offset:16
    v_and_b32 v7, -4, v70
    v_lshl_add_u32 v8, v70, 2, v7
    ds_write_b32 v8, v86
    v_lshl_add_u32 v7, v7, 2, v70
    ds_write_b8 v7, v73 offset:16
    v_and_b32 v9, -4, v71
    v_lshl_add_u32 v10, v71, 2, v9
    ds_write_b32 v10, v87
    v_lshl_add_u32 v9, v9, 2, v71
    ds_write_b8_d16_hi v9, v73 offset:16
    s_cmp_le_u32 s43, 5
    s_cbranch_scc1 L1_s13
    v_and_b32 v7, -4, v76
    v_lshl_add_u32 v8, v76, 2, v7
    ds_write_b32 v8, v36
    v_lshl_add_u32 v7, v7, 2, v76
    ds_write_b8 v7, v74 offset:16
    v_and_b32 v9, -4, v77
    v_lshl_add_u32 v10, v77, 2, v9
    ds_write_b32 v10, v37
    v_lshl_add_u32 v9, v9, 2, v77
    ds_write_b8_d16_hi v9, v74 offset:16
    v_and_b32 v7, -4, v78
    v_lshl_add_u32 v8, v78, 2, v7
    ds_write_b32 v8, v38
    v_lshl_add_u32 v7, v7, 2, v78
    ds_write_b8 v7, v75 offset:16
    v_and_b32 v9, -4, v79
    v_lshl_add_u32 v10, v79, 2, v9
    ds_write_b32 v10, v39
    v_lshl_add_u32 v9, v9, 2, v79
    ds_write_b8_d16_hi v9, v75 offset:16
L1_s13:
    s_add_u32 s44, s35, 0x7ec8000
    s_add_u32 s44, s44, s93
    buffer_store_dwordx4 v[108:111], v0, s[20:23], s44 offen sc1
    s_setprio 0
    s_cmp_le_u32 s43, 6
    s_cbranch_scc1 L1_s14
    v_and_b32 v7, -4, v56
    v_lshl_add_u32 v8, v56, 2, v7
    ds_write_b32 v8, v80
    v_lshl_add_u32 v7, v7, 2, v56
    ds_write_b8 v7, v64 offset:16
    v_and_b32 v9, -4, v57
    v_lshl_add_u32 v10, v57, 2, v9
    ds_write_b32 v10, v81
    v_lshl_add_u32 v9, v9, 2, v57
    ds_write_b8_d16_hi v9, v64 offset:16
    v_and_b32 v7, -4, v58
    v_lshl_add_u32 v8, v58, 2, v7
    ds_write_b32 v8, v82
    v_lshl_add_u32 v7, v7, 2, v58
    ds_write_b8 v7, v65 offset:16
    v_and_b32 v9, -4, v59
    v_lshl_add_u32 v10, v59, 2, v9
    ds_write_b32 v10, v83
    v_lshl_add_u32 v9, v9, 2, v59
    ds_write_b8_d16_hi v9, v65 offset:16
L1_s14:
    s_cmp_le_u32 s43, 7
    s_cbranch_scc1 L1_s15
    v_and_b32 v7, -4, v60
    v_lshl_add_u32 v8, v60, 2, v7
    ds_write_b32 v8, v96
    v_lshl_add_u32 v7, v7, 2, v60
    ds_write_b8 v7, v66 offset:16
    v_and_b32 v9, -4, v61
    v_lshl_add_u32 v10, v61, 2, v9
    ds_write_b32 v10, v97
    v_lshl_add_u32 v9, v9, 2, v61
    ds_write_b8_d16_hi v9, v66 offset:16
    v_and_b32 v7, -4, v62
    v_lshl_add_u32 v8, v62, 2, v7
    ds_write_b32 v8, v98
    v_lshl_add_u32 v7, v7, 2, v62
    ds_write_b8 v7, v67 offset:16
    v_and_b32 v9, -4, v63
    v_lshl_add_u32 v10, v63, 2, v9
    ds_write_b32 v10, v99
    v_lshl_add_u32 v9, v9, 2, v63
    ds_write_b8_d16_hi v9, v67 offset:16
L1_s15:
    s_add_u32 s80, s30, 0xd344000
    s_addc_u32 s81, s31, 0
    s_mov_b32 s82, 0xa000
    s_mov_b32 s83, 0x20000
    s_min_u32 s3, s84, 127
    s_mul_i32 s3, s3, 40960
    s_add_u32 s80, s80, s3
    s_addc_u32 s81, s81, 0
    s_cmp_ge_u32 s84, 128
    s_cselect_b32 s82, 0, s82
    s_waitcnt vmcnt(1)
    v_add_u32 v11, 0, v0
    buffer_store_dwordx4 v[104:107], v11, s[80:83], 0 offen sc1
    v_add_u32 v11, 16384, v0
    buffer_store_dwordx4 v[28:31], v11, s[80:83], 0 offen sc1
    v_add_u32 v11, 32768, v0
    buffer_store_dwordx4 v[112:115], v11, s[80:83], 0 offen sc1
    v_add_u32 v7, 0x10000, v0
    v_add_u32 v12, 0x20000, v0
    s_waitcnt lgkmcnt(0)
    s_barrier
    ds_read_b128 v[24:27], v0 offset:0
    ds_read_b128 v[28:31], v0 offset:16384
    ds_read_b128 v[32:35], v0 offset:32768
    ds_read_b128 v[36:39], v0 offset:49152
    ds_read_b128 v[76:79], v7 offset:0
    ds_read_b128 v[80:83], v7 offset:16384
    ds_read_b128 v[84:87], v7 offset:32768
    ds_read_b128 v[104:107], v7 offset:49152
    ds_read_b128 v[68:71], v12 offset:0
    ds_read_b128 v[72:75], v12 offset:16384
    s_cmp_lg_u32 s32, 0
    s_cbranch_scc1 L2_sg1
    s_mov_b32 exec_hi, 0
    v_mov_b32 v11, 1
    buffer_store_dword v11, v14, s[60:63], s57 offen sc1
    s_mov_b64 exec, -1
L2_sg1:
    s_waitcnt lgkmcnt(9)
    s_add_u32 s45, s35, 0xa904000
    buffer_store_dwordx4 v[24:27], v0, s[20:23], s45 offen sc1
    s_waitcnt lgkmcnt(8)
    s_add_u32 s46, s35, 0xa908000
    buffer_store_dwordx4 v[28:31], v0, s[20:23], s46 offen sc1
    s_waitcnt lgkmcnt(7)
    s_add_u32 s47, s35, 0xa90c000
    buffer_store_dwordx4 v[32:35], v0, s[20:23], s47 offen sc1
    s_waitcnt lgkmcnt(6)
    s_add_u32 s44, s35, 0xa910000
    buffer_store_dwordx4 v[36:39], v0, s[20:23], s44 offen sc1
    s_waitcnt lgkmcnt(5)
    s_add_u32 s45, s35, 0xa914000
    buffer_store_dwordx4 v[76:79], v0, s[20:23], s45 offen sc1
    s_waitcnt lgkmcnt(4)
    s_add_u32 s46, s35, 0xa918000
    buffer_store_dwordx4 v[80:83], v0, s[20:23], s46 offen sc1
    s_waitcnt lgkmcnt(3)
    s_add_u32 s47, s35, 0xa91c000
    buffer_store_dwordx4 v[84:87], v0, s[20:23], s47 offen sc1
    s_waitcnt lgkmcnt(2)
    s_cmp_le_u32 s43, 5
    s_cbranch_scc1 L1_q16
    s_add_u32 s44, s35, 0xa920000
    buffer_store_dwordx4 v[104:107], v0, s[20:23], s44 offen sc1
L1_q16:
    s_waitcnt lgkmcnt(1)
    s_cmp_le_u32 s43, 6
    s_cbranch_scc1 L1_q17
    s_add_u32 s45, s35, 0xa924000
    buffer_store_dwordx4 v[68:71], v0, s[20:23], s45 offen sc1
L1_q17:
    s_waitcnt lgkmcnt(0)
    s_cmp_le_u32 s43, 7
    s_cbranch_scc1 L1_q18
    s_add_u32 s46, s35, 0xa928000
    buffer_store_dwordx4 v[72:75], v0, s[20:23], s46 offen sc1
L1_q18:
    s_waitcnt lgkmcnt(0)
    s_setprio 3
    v_mov_b32 v92, v0
    v_mov_b32 v93, v6
    v_mov_b32 v94, v13
    v_mov_b32 v95, v5
    v_mov_b32 v0, v14
    v_lshl_add_u32 v7, v13, 3, s38
    v_lshrrev_b32 v16, 2, v15
    v_mad_u32_u24 v4, v16, 5, v4
    v_or_b32 v4, 0xf0000000, v4
    v_or_b32 v2, 0xf0000000, v2
    v_sub_u32 v1, 28, v16
    v_lshrrev_b32 v17, 2, v16
    v_and_b32 v18, 3, v17
    v_lshlrev_b32 v18, 4, v18
    v_mov_b32 v10, 0x3f80
    v_mov_b32 v11, 0
    v_lshlrev_b64 v[10:11], v18, v[10:11]
    v_and_b32 v18, 3, v17
    v_lshlrev_b32 v18, 4, v18
    v_mov_b32 v12, 0xbf80
    v_mov_b32 v13, 0
    v_lshlrev_b64 v[12:13], v18, v[12:13]
    v_mov_b32 v45, 0xf0000000
    v_add_u32 v44, s38, v0
    v_lshrrev_b32 v44, 1, v44
    v_and_b32 v44, -4, v44
    v_mov_b32 v5, 0x1fff8
    v_mov_b32 v6, 0x07ff0000
    v_mov_b32 v16, 0
    v_mov_b32 v17, 0
    v_mov_b32 v18, 0
    v_mov_b32 v19, 0
    v_add_u32 v20, 81920, v92
    v_add_u32 v21, 0x10000, v20
    s_setprio 1
    s_setprio 2
    s_mov_b32 s44, 0x4000c0c
    s_mov_b32 s45, 0x4010c0c
    s_mov_b32 s46, 0x4020c0c
    s_mov_b32 s47, 0x4030c0c
    s_mov_b32 s36, 0
    s_mov_b32 s43, 0
    s_mov_b32 s42, 0
    s_mov_b64 s[80:81], 0
    s_mov_b64 s[48:49], 0
    s_add_u32 s16, s30, 0xd344000
    s_addc_u32 s17, s31, 0
    s_mov_b32 s18, 0x500000
    s_mov_b32 s19, 0x20000
    v_mov_b32 v68, 0
    v_mov_b32 v69, 0
    v_mov_b32 v70, 0
    v_mov_b32 v71, 0
    v_mov_b32 v72, 0
    v_mov_b32 v73, 0
    v_mov_b32 v74, 0
    v_mov_b32 v75, 0
    s_waitcnt vmcnt(0)
    v_lshl_or_b32 v8, v101, 16, v100
    v_lshl_or_b32 v9, v103, 16, v102
    s_barrier
    s_cmp_lg_u32 s32, 0
    s_cbranch_scc1 L2_sg2
    s_mov_b32 exec_hi, 0
    v_mov_b32 v88, 2
    buffer_store_dword v88, v0, s[60:63], s57 offen sc1
    s_mov_b64 exec, -1
L2_sg2:
    s_mov_b64 s[84:85], 0
    s_mul_i32 s3, s33, 1280000
    s_add_u32 s3, s3, s100
    s_add_u32 s3, s3, 32768
    buffer_load_dwordx4 v[124:127], v94, s[24:27], s3 offen offset:2048
    s_mul_i32 s3, s33, 1280000
    s_add_u32 s3, s3, s100
    s_add_u32 s3, s3, 32768
    buffer_load_dwordx4 v[116:119], v94, s[24:27], s3 offen offset:0
    s_mul_i32 s3, s33, 1280000
    s_add_u32 s3, s3, s100
    s_add_u32 s3, s3, 32768
    buffer_load_dwordx4 v[120:123], v94, s[24:27], s3 offen offset:1024
    s_mul_i32 s3, s33, 1280000
    s_add_u32 s3, s3, s38
    s_add_u32 s3, s3, 0
    buffer_load_dwordx4 v[108:111], v94, s[24:27], s3 offen offset:0
    s_mul_i32 s3, s33, 1280000
    s_add_u32 s3, s3, s38
    s_add_u32 s3, s3, 0
    buffer_load_dwordx4 v[112:115], v94, s[24:27], s3 offen offset:1024
    ds_write_b128 v20, v[16:19] offset:0
    ds_write_b128 v20, v[16:19] offset:16384
    ds_write_b128 v20, v[16:19] offset:32768
    ds_write_b128 v20, v[16:19] offset:49152
    ds_write_b128 v21, v[16:19]
    s_cmp_eq_u32 s56, 0
    s_cbranch_scc1 L2_e3
    v_lshlrev_b32 v16, 3, v94
    v_and_b32 v16, 0x80, v16
L2_e4:
    buffer_load_dword v88, v16, s[68:71], 0 offen sc1
    s_waitcnt vmcnt(0)
    v_cmp_gt_u32 vcc, 0x80, v88
    s_cbranch_vccnz L2_e4
L2_e3:
    s_mov_b64 exec, 0xffff
L2_p1:
    buffer_load_dword v88, v7, s[60:63], 0 offen sc1
    s_waitcnt vmcnt(0)
    v_cmpx_gt_u32 vcc, 1, v88
    s_cbranch_vccnz L2_p1
    s_mov_b64 exec, -1
    v_cmp_gt_u32 vcc, 2, v88
    s_and_b32 s56, vcc_lo, 0xffff
    buffer_load_dwordx4 v[48:51], v95, s[12:15], s39 offen offset:0
    buffer_load_dwordx4 v[56:59], v95, s[12:15], s39 offen offset:32
    buffer_load_dwordx4 v[52:55], v95, s[12:15], s39 offen offset:16
    buffer_load_dwordx4 v[60:63], v95, s[12:15], s39 offen offset:48
    buffer_load_dwordx4 v[64:67], v93, s[12:15], s39 offen
    s_waitcnt vmcnt(0)
    v_sub_u16 v88, v56, v48
    v_and_b32 v89, 3, v48
    v_add3_u32 v99, v88, v89, 3
    v_and_b32 v99, -4, v99
    v_max_u32 v99, 4, v99
    v_and_b32 v97, 0xfffc, v48
    v_bfm_b32 v96, v88, v89
    v_add_u32_dpp v91, v99, v99 row_shr:1 row_mask:0xf bank_mask:0xf bound_ctrl:1
    v_mad_u32_u24 v97, v97, 5, v2
    v_cmp_lt_u32 vcc, 16, v99
    v_add_u32_dpp v91, v91, v91 row_shr:2 row_mask:0xf bank_mask:0xf bound_ctrl:1
    v_sub_u32 v98, s38, v99
    v_lshrrev_b64 v[48:49], 16, v[48:49]
    v_add_u32_dpp v91, v91, v91 row_shr:4 row_mask:0xf bank_mask:0xf bound_ctrl:1
    v_lshrrev_b64 v[56:57], 16, v[56:57]
    s_mov_b32 s101, 0
    v_add_u32_dpp v91, v91, v91 row_shr:8 row_mask:0xf bank_mask:0xf bound_ctrl:1
    s_nop 1
    v_add_u32_dpp v91, v91, v91 row_bcast:15 row_mask:0xa bank_mask:0xf
    s_nop 1
    v_add_u32_dpp v91, v91, v91 row_bcast:31 row_mask:0xc bank_mask:0xf
    v_add_u32 v98, v98, v91
    v_readlane_b32 s37, v91, 63
    s_cbranch_vccnz L2_xo3
L2_xp3:
    s_cmp_gt_u32 s37, 1024
    s_cbranch_scc1 L2_xs4
    s_cmp_lg_u32 s101, 0
    s_cbranch_scc1 L2_xa4
L2_xb4:
    v_lshlrev_b32 v89, 16, v96
    v_add_u32 v90, 60, v97
    v_bitop3_b32 v90, v89, v45, v90 bitop3:0x6a
    ds_write_b32 v98, v90 offset:12
    v_lshlrev_b32 v89, 20, v96
    v_add_u32 v90, 40, v97
    v_bitop3_b32 v90, v89, v45, v90 bitop3:0x6a
    ds_write_b32 v98, v90 offset:8
    v_lshlrev_b32 v89, 24, v96
    v_add_u32 v90, 20, v97
    v_bitop3_b32 v90, v89, v45, v90 bitop3:0x6a
    ds_write_b32 v98, v90 offset:4
    v_lshlrev_b32 v89, 28, v96
    v_bitop3_b32 v90, v89, v45, v97 bitop3:0x6a
    ds_write_b32 v98, v90 offset:0
    v_mov_b32_dpp v91, v64 quad_perm:[0,0,0,0] row_mask:0xf bank_mask:0xf
    v_and_b32 v89, 3, v91
    v_and_b32 v97, 0xfffc, v91
    v_sub_u16_dpp v88, v64, v91 quad_perm:[2,2,2,2] row_mask:0xf bank_mask:0xf
    v_mad_u32_u24 v97, v97, 5, v4
    v_add_u32 v99, v88, v89
    v_bfm_b32 v96, v88, v89
    v_cmp_lt_u32 s[58:59], 16, v99
    v_lshlrev_b32 v89, v1, v96
    v_and_b32 v89, v45, v89
    v_cmp_ne_u32 vcc, 0, v89
    v_xor_b32 v90, v97, v89
    s_add_u32 s3, s37, s38
    v_mbcnt_lo_u32_b32 v98, vcc_lo, 0
    v_mbcnt_hi_u32_b32 v98, vcc_hi, v98
    s_bcnt1_i32_b64 s41, vcc
    v_lshl_add_u32 v98, v98, 2, s3
    s_lshl2_add_u32 s37, s41, s37
    s_mov_b64 exec, vcc
    ds_write_b32 v98, v90
    s_mov_b64 exec, -1
    s_cmp_lg_u64 s[58:59], 0
    s_cbranch_scc1 L2_xe4
L2_xr4:
    v_add_u32 v98, s37, v0
    v_mov_b32 v90, -1
    ds_write_b32 v98, v90
L2_xw4:
    ds_read_b32 v21, v0 offset:0
    ds_read_b32 v27, v0 offset:256
    ds_read_b32 v31, v44 offset:768
    ds_read_b32 v39, v0 offset:512
    s_sub_u32 s3, s37, 768
    s_cmp_gt_u32 s3, 128
    s_cbranch_scc1 L2_xf4
L2_xg4:
    v_sub_u16 v88, v58, v50
    v_and_b32 v89, 3, v50
    v_add3_u32 v99, v88, v89, 3
    v_and_b32 v99, -4, v99
    v_max_u32 v99, 4, v99
    v_and_b32 v97, 0xfffc, v50
    v_bfm_b32 v96, v88, v89
    v_add_u32_dpp v91, v99, v99 row_shr:1 row_mask:0xf bank_mask:0xf bound_ctrl:1
    v_mad_u32_u24 v97, v97, 5, v2
    v_cmp_lt_u32 vcc, 16, v99
    v_add_u32_dpp v91, v91, v91 row_shr:2 row_mask:0xf bank_mask:0xf bound_ctrl:1
    v_sub_u32 v98, s38, v99
    v_lshrrev_b64 v[50:51], 16, v[50:51]
    v_add_u32_dpp v91, v91, v91 row_shr:4 row_mask:0xf bank_mask:0xf bound_ctrl:1
    v_lshrrev_b64 v[58:59], 16, v[58:59]
    s_mov_b32 s101, 0
    v_add_u32_dpp v91, v91, v91 row_shr:8 row_mask:0xf bank_mask:0xf bound_ctrl:1
    s_nop 1
    v_add_u32_dpp v91, v91, v91 row_bcast:15 row_mask:0xa bank_mask:0xf
    s_nop 1
    v_add_u32_dpp v91, v91, v91 row_bcast:31 row_mask:0xc bank_mask:0xf
    v_add_u32 v98, v98, v91
    v_readlane_b32 s37, v91, 63
    s_cbranch_vccnz L2_xo5
L2_xp5:
    s_waitcnt lgkmcnt(0)
    s_cmp_gt_u32 s37, 1024
    s_cbranch_scc1 L2_xs6
    s_cmp_lg_u32 s101, 0
    s_cbranch_scc1 L2_xa6
L2_xb6:
    v_lshlrev_b32 v89, 16, v96
    v_add_u32 v90, 60, v97
    v_bitop3_b32 v90, v89, v45, v90 bitop3:0x6a
    ds_write_b32 v98, v90 offset:12
    v_lshlrev_b32 v89, 20, v96
    v_add_u32 v90, 40, v97
    v_bitop3_b32 v90, v89, v45, v90 bitop3:0x6a
    ds_write_b32 v98, v90 offset:8
    v_lshlrev_b32 v89, 24, v96
    v_add_u32 v90, 20, v97
    v_bitop3_b32 v90, v89, v45, v90 bitop3:0x6a
    ds_write_b32 v98, v90 offset:4
    v_lshlrev_b32 v89, 28, v96
    v_bitop3_b32 v90, v89, v45, v97 bitop3:0x6a
    ds_write_b32 v98, v90 offset:0
    v_mov_b32_dpp v91, v66 quad_perm:[0,0,0,0] row_mask:0xf bank_mask:0xf
    v_and_b32 v89, 3, v91
    v_and_b32 v97, 0xfffc, v91
    v_sub_u16_dpp v88, v66, v91 quad_perm:[2,2,2,2] row_mask:0xf bank_mask:0xf
    v_mad_u32_u24 v97, v97, 5, v4
    v_add_u32 v99, v88, v89
    v_bfm_b32 v96, v88, v89
    v_cmp_lt_u32 s[58:59], 16, v99
    v_lshlrev_b32 v89, v1, v96
    v_and_b32 v89, v45, v89
    v_cmp_ne_u32 vcc, 0, v89
    v_xor_b32 v90, v97, v89
    s_add_u32 s3, s37, s38
    v_mbcnt_lo_u32_b32 v98, vcc_lo, 0
    v_mbcnt_hi_u32_b32 v98, vcc_hi, v98
    s_bcnt1_i32_b64 s41, vcc
    v_lshl_add_u32 v98, v98, 2, s3
    s_lshl2_add_u32 s37, s41, s37
    s_mov_b64 exec, vcc
    ds_write_b32 v98, v90
    s_mov_b64 exec, -1
    s_cmp_lg_u64 s[58:59], 0
    s_cbranch_scc1 L2_xe6
L2_xr6:
    v_add_u32 v98, s37, v0
    v_mov_b32 v90, -1
    ds_write_b32 v98, v90
L2_xw6:
    ds_read_b32 v40, v0 offset:0
    ds_read_b32 v41, v0 offset:256
    ds_read_b32 v42, v44 offset:768
    ds_read_b32 v43, v0 offset:512
    s_sub_u32 s3, s37, 768
    s_cmp_gt_u32 s3, 128
    s_cbranch_scc1 L2_xf6
L2_xg6:
    v_subrev_u32 v88, s38, v3
    ds_write_b128 v88, v[124:127] offset:34816
    v_subrev_u32 v88, s38, v3
    ds_write_b128 v88, v[116:119] offset:32768
    v_subrev_u32 v88, s38, v3
    ds_write_b128 v88, v[120:123] offset:33792
    v_subrev_u32 v88, s100, v3
    ds_write_b128 v88, v[108:111] offset:0
    v_subrev_u32 v88, s100, v3
    ds_write_b128 v88, v[112:115] offset:1024
    s_cmp_eq_u32 s56, 0
    s_cbranch_scc1 L2_e2
    s_mov_b32 exec_lo, s56
    s_mov_b32 exec_hi, 0
    buffer_load_dword v88, v7, s[60:63], 0 offen sc1
    s_mov_b64 exec, -1
    s_waitcnt vmcnt(0)
    v_cmp_gt_u32 vcc, 2, v88
    s_and_b32 s56, vcc_lo, s56
    s_cbranch_scc0 L2_e2
    s_mul_i32 s3, s33, 1280000
    s_add_u32 s3, s3, s100
    s_add_u32 s3, s3, 352768
    buffer_load_dwordx4 v[124:127], v94, s[24:27], s3 offen offset:2048
    s_mul_i32 s3, s33, 1280000
    s_add_u32 s3, s3, s100
    s_add_u32 s3, s3, 352768
    buffer_load_dwordx4 v[116:119], v94, s[24:27], s3 offen offset:0
    s_mul_i32 s3, s33, 1280000
    s_add_u32 s3, s3, s100
    s_add_u32 s3, s3, 352768
    buffer_load_dwordx4 v[120:123], v94, s[24:27], s3 offen offset:1024
    s_mul_i32 s3, s33, 1280000
    s_add_u32 s3, s3, s38
    s_add_u32 s3, s3, 320000
    buffer_load_dwordx4 v[108:111], v94, s[24:27], s3 offen offset:0
    s_mul_i32 s3, s33, 1280000
    s_add_u32 s3, s3, s38
    s_add_u32 s3, s3, 320000
    buffer_load_dwordx4 v[112:115], v94, s[24:27], s3 offen offset:1024
    s_mov_b32 exec_lo, s56
    s_mov_b32 exec_hi, 0
L2_p2:
    buffer_load_dword v88, v7, s[60:63], 0 offen sc1
    s_waitcnt vmcnt(0)
    v_cmpx_gt_u32 vcc, 2, v88
    s_cbranch_vccnz L2_p2
    s_mov_b64 exec, -1
L2_e2:
    s_mov_b32 s6, 0xaaaaaaaa
    s_mov_b32 s7, 0xaaaaaaaa
    v_and_b32 v47, 0x0fffffff, v21
    buffer_load_dwordx2 v[16:17], v47, s[8:11], 0 offen
    buffer_load_dwordx3 v[18:20], v47, s[8:11], 0 offen offset:8
    s_setprio 1
    v_and_b32 v47, 0x0fffffff, v27
    buffer_load_dwordx2 v[22:23], v47, s[8:11], 0 offen
    buffer_load_dwordx3 v[24:26], v47, s[8:11], 0 offen offset:8
    s_waitcnt lgkmcnt(0)
    s_barrier
    s_bitcmp1_b32 s36, s42
    s_cbranch_scc1 L2_slow
L2_ret0:
    s_setprio 3
    s_bitcmp1_b32 s43, s42
    s_cbranch_scc1 L2_oa7
L2_ob7:
    s_bitcmp1_b32 s43, s42
    s_cbranch_scc1 L2_oa8
L2_ob8:
    s_waitcnt vmcnt(2)
    v_and_b32 v46, 0x20000000, v21
    v_lshrrev_b32 v47, 14, v17
    v_bitop3_b32 v47, v47, v5, v46 bitop3:0xea
    ds_read_b64 v[102:103], v47
    v_bitop3_b32 v93, v17, v5, v46 bitop3:0xea
    v_and_b32 v46, 0x10000000, v21
    v_lshrrev_b32 v47, 14, v16
    v_bitop3_b32 v47, v47, v5, v46 bitop3:0xea
    ds_read_b64 v[100:101], v47
    v_bitop3_b32 v92, v16, v5, v46 bitop3:0xea
    v_perm_b32 v15, v17, v20, s45
    v_bitop3_b32 v46, v17, 0.5, -0.5 bitop3:0xa8
    v_perm_b32 v14, v16, v20, s44
    v_bitop3_b32 v47, v16, 0.5, -0.5 bitop3:0xa8
    v_bitop3_b32 v15, v6, v15, v46 bitop3:0xca
    v_bitop3_b32 v14, v6, v14, v47 bitop3:0xca
    s_waitcnt lgkmcnt(0)
    v_mfma_f32_4x4x4_16b_bf16 v[80:83], v[8:9], v[102:103], 0
    v_mfma_f32_4x4x4_16b_bf16 v[76:79], v[8:9], v[100:101], 0
    v_cmp_lt_u32 s[84:85], v5, v92
    s_nop 2
    v_pk_mul_f32 v[80:81], v[80:81], v[14:15] op_sel:[0,1] op_sel_hi:[1,1]
    v_pk_mul_f32 v[82:83], v[82:83], v[14:15] op_sel:[0,1] op_sel_hi:[1,1]
    v_pk_mul_f32 v[76:77], v[76:77], v[14:15] op_sel:[0,0] op_sel_hi:[1,0]
    v_pk_mul_f32 v[78:79], v[78:79], v[14:15] op_sel:[0,0] op_sel_hi:[1,0]
    v_and_b32 v47, 0x0fffffff, v39
    buffer_load_dwordx2 v[34:35], v47, s[8:11], 0 offen
    buffer_load_dwordx3 v[36:38], v47, s[8:11], 0 offen offset:8
    v_and_b32 v46, 0x80000000, v21
    v_lshrrev_b32 v47, 14, v19
    v_bitop3_b32 v47, v47, v5, v46 bitop3:0xea
    ds_read_b64 v[106:107], v47
    v_and_b32 v99, 0x40000000, v21
    v_lshrrev_b32 v47, 14, v18
    v_bitop3_b32 v47, v47, v5, v99 bitop3:0xea
    ds_read_b64 v[104:105], v47
    v_cmp_ne_u64 s[50:51], v[72:73], v[68:69]
    v_cmpx_ne_u64 s[54:55], v[74:75], v[70:71]
    s_and_b64 s[82:83], s[54:55], s[80:81]
    s_cbranch_scc1 L2_c9
L2_d9:
    v_mov_b64 v[84:85], v[70:71]
    v_mov_b32 v7, v95
    v_mov_b64 v[86:87], v[74:75]
    s_or_b64 s[80:81], s[80:81], s[54:55]
    s_mov_b64 exec, s[50:51]
    s_and_b64 s[82:83], s[50:51], s[80:81]
    s_cbranch_scc1 L2_c10
L2_d10:
    v_mov_b64 v[84:85], v[68:69]
    v_mov_b32 v7, v94
    v_mov_b64 v[86:87], v[72:73]
    s_mov_b64 exec, -1
    s_or_b64 s[80:81], s[80:81], s[50:51]
    s_and_b64 exec, s[84:85], s[80:81]
    v_mfma_f32_4x4x4_16b_bf16 v[76:79], v[12:13], v[84:85], 0
    v_mov_b32 v92, v7
    s_andn2_b64 s[80:81], s[80:81], s[84:85]
    v_mfma_f32_4x4x4_16b_bf16 v[76:79], v[10:11], v[86:87], v[76:79]
    s_mov_b64 exec, -1
    ds_read_b64 v[70:71], v93 offset:65408
    ds_read_b64 v[68:69], v92 offset:65408
    v_bitop3_b32 v94, v18, v5, v99 bitop3:0xea
    v_bitop3_b32 v95, v19, v5, v46 bitop3:0xea
    v_perm_b32 v15, v19, v20, s47
    v_bitop3_b32 v46, v19, 0.5, -0.5 bitop3:0xa8
    v_perm_b32 v14, v18, v20, s46
    v_bitop3_b32 v47, v18, 0.5, -0.5 bitop3:0xa8
    v_bitop3_b32 v15, v6, v15, v46 bitop3:0xca
    v_bitop3_b32 v14, v6, v14, v47 bitop3:0xca
    s_waitcnt lgkmcnt(1)
    v_mfma_f32_4x4x4_16b_bf16 v[80:83], v[10:11], v[70:71], v[80:83]
    s_waitcnt lgkmcnt(0)
    v_mfma_f32_4x4x4_16b_bf16 v[76:79], v[10:11], v[68:69], v[76:79]
    s_nop 2
    v_cvt_pk_bf16_f32 v80, v80, v81
    v_cvt_pk_bf16_f32 v81, v82, v83
    ds_wrxchg_rtn_b64 v[74:75], v93, v[80:81] offset:65408
    v_cvt_pk_bf16_f32 v76, v76, v77
    v_cvt_pk_bf16_f32 v77, v78, v79
    ds_wrxchg_rtn_b64 v[72:73], v92, v[76:77] offset:65408
    s_setprio 2
    v_mfma_f32_4x4x4_16b_bf16 v[80:83], v[8:9], v[106:107], 0
    v_mfma_f32_4x4x4_16b_bf16 v[76:79], v[8:9], v[104:105], 0
    v_cmp_lt_u32 s[48:49], v5, v95
    s_nop 2
    v_pk_mul_f32 v[80:81], v[80:81], v[14:15] op_sel:[0,1] op_sel_hi:[1,1]
    v_pk_mul_f32 v[82:83], v[82:83], v[14:15] op_sel:[0,1] op_sel_hi:[1,1]
    v_pk_mul_f32 v[76:77], v[76:77], v[14:15] op_sel:[0,0] op_sel_hi:[1,0]
    v_pk_mul_f32 v[78:79], v[78:79], v[14:15] op_sel:[0,0] op_sel_hi:[1,0]
    v_and_b32 v47, 0x0fffffff, v31
    buffer_load_dword v30, v47, s[8:11], 0 offen offset:16
    s_mov_b64 exec, s[6:7]
    v_add_u32 v47, 8, v47
    v_lshrrev_b32 v31, 2, v31
    s_mov_b64 exec, -1
    buffer_load_dwordx2 v[28:29], v47, s[8:11], 0 offen
    v_and_b32 v47, 0x3f0, v3
    s_cmp_lg_u32 s56, 0
    s_cbranch_scc1 L2_m11
    s_mul_i32 s3, s33, 1280000
    s_add_u32 s3, s3, s100
    s_add_u32 s3, s3, 352768
    buffer_load_dwordx4 v[124:127], v47, s[24:27], s3 offen offset:2048
L2_m11:
    v_and_b32 v47, 0x3f0, v3
    s_cmp_lg_u32 s56, 0
    s_cbranch_scc1 L2_m12
    s_mul_i32 s3, s33, 1280000
    s_add_u32 s3, s3, s100
    s_add_u32 s3, s3, 352768
    buffer_load_dwordx4 v[116:119], v47, s[24:27], s3 offen offset:0
L2_m12:
    s_waitcnt vmcnt(4)
    v_and_b32 v46, 0x20000000, v27
    v_lshrrev_b32 v47, 14, v23
    v_bitop3_b32 v47, v47, v5, v46 bitop3:0xea
    ds_read_b64 v[102:103], v47
    v_and_b32 v99, 0x10000000, v27
    v_lshrrev_b32 v47, 14, v22
    v_bitop3_b32 v47, v47, v5, v99 bitop3:0xea
    ds_read_b64 v[100:101], v47
    s_waitcnt lgkmcnt(2)
    v_cmp_ne_u64 s[50:51], v[72:73], v[68:69]
    v_cmpx_ne_u64 s[54:55], v[74:75], v[70:71]
    s_and_b64 s[82:83], s[54:55], s[80:81]
    s_cbranch_scc1 L2_c13
L2_d13:
    v_mov_b64 v[84:85], v[70:71]
    v_mov_b32 v7, v93
    v_mov_b64 v[86:87], v[74:75]
    s_or_b64 s[80:81], s[80:81], s[54:55]
    s_mov_b64 exec, s[50:51]
    s_and_b64 s[82:83], s[50:51], s[80:81]
    s_cbranch_scc1 L2_c14
L2_d14:
    v_mov_b64 v[84:85], v[68:69]
    v_mov_b32 v7, v92
    v_mov_b64 v[86:87], v[72:73]
    s_mov_b64 exec, -1
    s_or_b64 s[80:81], s[80:81], s[50:51]
    s_and_b64 exec, s[48:49], s[80:81]
    v_mfma_f32_4x4x4_16b_bf16 v[80:83], v[12:13], v[84:85], 0
    v_mov_b32 v95, v7
    s_andn2_b64 s[80:81], s[80:81], s[48:49]
    v_mfma_f32_4x4x4_16b_bf16 v[80:83], v[10:11], v[86:87], v[80:83]
    s_mov_b64 exec, -1
    ds_read_b64 v[70:71], v95 offset:65408
    ds_read_b64 v[68:69], v94 offset:65408
    v_bitop3_b32 v92, v22, v5, v99 bitop3:0xea
    v_bitop3_b32 v93, v23, v5, v46 bitop3:0xea
    v_perm_b32 v15, v23, v26, s45
    v_bitop3_b32 v46, v23, 0.5, -0.5 bitop3:0xa8
    v_perm_b32 v14, v22, v26, s44
    v_bitop3_b32 v47, v22, 0.5, -0.5 bitop3:0xa8
    v_bitop3_b32 v15, v6, v15, v46 bitop3:0xca
    v_bitop3_b32 v14, v6, v14, v47 bitop3:0xca
    s_waitcnt lgkmcnt(1)
    v_mfma_f32_4x4x4_16b_bf16 v[80:83], v[10:11], v[70:71], v[80:83]
    s_waitcnt lgkmcnt(0)
    v_mfma_f32_4x4x4_16b_bf16 v[76:79], v[10:11], v[68:69], v[76:79]
    s_nop 2
    v_cvt_pk_bf16_f32 v80, v80, v81
    v_cvt_pk_bf16_f32 v81, v82, v83
    ds_wrxchg_rtn_b64 v[74:75], v95, v[80:81] offset:65408
    v_cvt_pk_bf16_f32 v76, v76, v77
    v_cvt_pk_bf16_f32 v77, v78, v79
    ds_wrxchg_rtn_b64 v[72:73], v94, v[76:77] offset:65408
    s_setprio 1
    v_mfma_f32_4x4x4_16b_bf16 v[80:83], v[8:9], v[102:103], 0
    v_mfma_f32_4x4x4_16b_bf16 v[76:79], v[8:9], v[100:101], 0
    s_nop 3
    v_pk_mul_f32 v[80:81], v[80:81], v[14:15] op_sel:[0,1] op_sel_hi:[1,1]
    v_pk_mul_f32 v[82:83], v[82:83], v[14:15] op_sel:[0,1] op_sel_hi:[1,1]
    v_pk_mul_f32 v[76:77], v[76:77], v[14:15] op_sel:[0,0] op_sel_hi:[1,0]
    v_pk_mul_f32 v[78:79], v[78:79], v[14:15] op_sel:[0,0] op_sel_hi:[1,0]
    v_and_b32 v47, 0x3f0, v3
    s_cmp_lg_u32 s56, 0
    s_cbranch_scc1 L2_m15
    s_mul_i32 s3, s33, 1280000
    s_add_u32 s3, s3, s100
    s_add_u32 s3, s3, 352768
    buffer_load_dwordx4 v[120:123], v47, s[24:27], s3 offen offset:1024
L2_m15:
    v_sub_u16 v88, v60, v52
    v_and_b32 v89, 3, v52
    v_add3_u32 v99, v88, v89, 3
    v_and_b32 v99, -4, v99
    v_max_u32 v99, 4, v99
    v_and_b32 v97, 0xfffc, v52
    v_bfm_b32 v96, v88, v89
    v_add_u32_dpp v91, v99, v99 row_shr:1 row_mask:0xf bank_mask:0xf bound_ctrl:1
    v_mad_u32_u24 v97, v97, 5, v2
    v_cmp_lt_u32 vcc, 16, v99
    v_add_u32_dpp v91, v91, v91 row_shr:2 row_mask:0xf bank_mask:0xf bound_ctrl:1
    v_sub_u32 v98, s38, v99
    v_lshrrev_b64 v[52:53], 16, v[52:53]
    v_add_u32_dpp v91, v91, v91 row_shr:4 row_mask:0xf bank_mask:0xf bound_ctrl:1
    v_lshrrev_b64 v[60:61], 16, v[60:61]
    s_mov_b32 s101, 0
    v_add_u32_dpp v91, v91, v91 row_shr:8 row_mask:0xf bank_mask:0xf bound_ctrl:1
    s_nop 1
    v_add_u32_dpp v91, v91, v91 row_bcast:15 row_mask:0xa bank_mask:0xf
    s_nop 1
    v_add_u32_dpp v91, v91, v91 row_bcast:31 row_mask:0xc bank_mask:0xf
    v_add_u32 v98, v98, v91
    v_readlane_b32 s37, v91, 63
    s_cbranch_vccnz L2_xo16
L2_xp16:
    v_and_b32 v46, 0x80000000, v27
    v_lshrrev_b32 v47, 14, v25
    v_bitop3_b32 v47, v47, v5, v46 bitop3:0xea
    ds_read_b64 v[106:107], v47
    v_and_b32 v99, 0x40000000, v27
    v_lshrrev_b32 v47, 14, v24
    v_bitop3_b32 v47, v47, v5, v99 bitop3:0xea
    ds_read_b64 v[104:105], v47
    s_waitcnt lgkmcnt(2)
    v_cmp_ne_u64 s[50:51], v[72:73], v[68:69]
    v_cmpx_ne_u64 s[54:55], v[74:75], v[70:71]
    s_and_b64 s[82:83], s[54:55], s[80:81]
    s_cbranch_scc1 L2_c17
L2_d17:
    v_mov_b64 v[84:85], v[70:71]
    v_mov_b32 v7, v95
    v_mov_b64 v[86:87], v[74:75]
    s_or_b64 s[80:81], s[80:81], s[54:55]
    s_mov_b64 exec, s[50:51]
    s_and_b64 s[82:83], s[50:51], s[80:81]
    s_cbranch_scc1 L2_c18
L2_d18:
    v_mov_b64 v[84:85], v[68:69]
    v_mov_b32 v7, v94
    v_mov_b64 v[86:87], v[72:73]
    s_mov_b64 exec, -1
    s_or_b64 s[80:81], s[80:81], s[50:51]
    ds_read_b64 v[70:71], v93 offset:65408
    ds_read_b64 v[68:69], v92 offset:65408
    v_bitop3_b32 v94, v24, v5, v99 bitop3:0xea
    v_bitop3_b32 v95, v25, v5, v46 bitop3:0xea
    v_perm_b32 v15, v25, v26, s47
    v_bitop3_b32 v46, v25, 0.5, -0.5 bitop3:0xa8
    v_perm_b32 v14, v24, v26, s46
    v_bitop3_b32 v47, v24, 0.5, -0.5 bitop3:0xa8
    v_bitop3_b32 v15, v6, v15, v46 bitop3:0xca
    v_bitop3_b32 v14, v6, v14, v47 bitop3:0xca
    s_waitcnt lgkmcnt(1)
    v_mfma_f32_4x4x4_16b_bf16 v[80:83], v[10:11], v[70:71], v[80:83]
    s_waitcnt lgkmcnt(0)
    v_mfma_f32_4x4x4_16b_bf16 v[76:79], v[10:11], v[68:69], v[76:79]
    s_nop 2
    v_cvt_pk_bf16_f32 v80, v80, v81
    v_cvt_pk_bf16_f32 v81, v82, v83
    ds_wrxchg_rtn_b64 v[74:75], v93, v[80:81] offset:65408
    v_cvt_pk_bf16_f32 v76, v76, v77
    v_cvt_pk_bf16_f32 v77, v78, v79
    ds_wrxchg_rtn_b64 v[72:73], v92, v[76:77] offset:65408
    v_mfma_f32_4x4x4_16b_bf16 v[80:83], v[8:9], v[106:107], 0
    v_mfma_f32_4x4x4_16b_bf16 v[76:79], v[8:9], v[104:105], 0
    v_cmp_lt_u32 s[84:85], v5, v94
    s_nop 2
    v_pk_mul_f32 v[80:81], v[80:81], v[14:15] op_sel:[0,1] op_sel_hi:[1,1]
    v_pk_mul_f32 v[82:83], v[82:83], v[14:15] op_sel:[0,1] op_sel_hi:[1,1]
    v_pk_mul_f32 v[76:77], v[76:77], v[14:15] op_sel:[0,0] op_sel_hi:[1,0]
    v_pk_mul_f32 v[78:79], v[78:79], v[14:15] op_sel:[0,0] op_sel_hi:[1,0]
    v_and_b32 v47, 0x3f0, v3
    s_cmp_lg_u32 s56, 0
    s_cbranch_scc1 L2_m19
    s_mul_i32 s3, s33, 1280000
    s_add_u32 s3, s3, s38
    s_add_u32 s3, s3, 320000
    buffer_load_dwordx4 v[108:111], v47, s[24:27], s3 offen offset:0
L2_m19:
    v_and_b32 v47, 0x3f0, v3
    s_cmp_lg_u32 s56, 0
    s_cbranch_scc1 L2_m20
    s_mul_i32 s3, s33, 1280000
    s_add_u32 s3, s3, s38
    s_add_u32 s3, s3, 320000
    buffer_load_dwordx4 v[112:115], v47, s[24:27], s3 offen offset:1024
L2_m20:
    v_and_b32 v47, 0x0fffffff, v40
    buffer_load_dwordx2 v[16:17], v47, s[8:11], 0 offen
    buffer_load_dwordx3 v[18:20], v47, s[8:11], 0 offen offset:8
    s_waitcnt vmcnt(2)
    s_mov_b64 exec, s[6:7]
    v_lshrrev_b32 v30, 16, v30
    s_mov_b64 exec, -1
    v_and_b32 v46, 0x20000000, v31
    v_lshrrev_b32 v47, 14, v29
    v_bitop3_b32 v47, v47, v5, v46 bitop3:0xea
    ds_read_b64 v[102:103], v47
    v_and_b32 v99, 0x10000000, v31
    v_lshrrev_b32 v47, 14, v28
    v_bitop3_b32 v47, v47, v5, v99 bitop3:0xea
    ds_read_b64 v[100:101], v47
    s_waitcnt lgkmcnt(2)
    v_cmp_ne_u64 s[50:51], v[72:73], v[68:69]
    v_cmpx_ne_u64 s[54:55], v[74:75], v[70:71]
    s_and_b64 s[82:83], s[54:55], s[80:81]
    s_cbranch_scc1 L2_c21
L2_d21:
    v_mov_b64 v[84:85], v[70:71]
    v_mov_b32 v7, v93
    v_mov_b64 v[86:87], v[74:75]
    s_or_b64 s[80:81], s[80:81], s[54:55]
    s_mov_b64 exec, s[50:51]
    s_and_b64 s[82:83], s[50:51], s[80:81]
    s_cbranch_scc1 L2_c22
L2_d22:
    v_mov_b64 v[84:85], v[68:69]
    v_mov_b32 v7, v92
    v_mov_b64 v[86:87], v[72:73]
    s_mov_b64 exec, -1
    s_or_b64 s[80:81], s[80:81], s[50:51]
    s_and_b64 exec, s[84:85], s[80:81]
    v_mfma_f32_4x4x4_16b_bf16 v[76:79], v[12:13], v[84:85], 0
    v_mov_b32 v94, v7
    s_andn2_b64 s[80:81], s[80:81], s[84:85]
    v_mfma_f32_4x4x4_16b_bf16 v[76:79], v[10:11], v[86:87], v[76:79]
    s_mov_b64 exec, -1
    ds_read_b64 v[70:71], v95 offset:65408
    ds_read_b64 v[68:69], v94 offset:65408
    v_bitop3_b32 v92, v28, v5, v99 bitop3:0xea
    v_bitop3_b32 v93, v29, v5, v46 bitop3:0xea
    v_perm_b32 v15, v29, v30, s45
    v_bitop3_b32 v46, v29, 0.5, -0.5 bitop3:0xa8
    v_perm_b32 v14, v28, v30, s44
    v_bitop3_b32 v47, v28, 0.5, -0.5 bitop3:0xa8
    v_bitop3_b32 v15, v6, v15, v46 bitop3:0xca
    v_bitop3_b32 v14, v6, v14, v47 bitop3:0xca
    s_waitcnt lgkmcnt(1)
    v_mfma_f32_4x4x4_16b_bf16 v[80:83], v[10:11], v[70:71], v[80:83]
    s_waitcnt lgkmcnt(0)
    v_mfma_f32_4x4x4_16b_bf16 v[76:79], v[10:11], v[68:69], v[76:79]
    s_nop 2
    v_cvt_pk_bf16_f32 v80, v80, v81
    v_cvt_pk_bf16_f32 v81, v82, v83
    ds_wrxchg_rtn_b64 v[74:75], v95, v[80:81] offset:65408
    v_cvt_pk_bf16_f32 v76, v76, v77
    v_cvt_pk_bf16_f32 v77, v78, v79
    ds_wrxchg_rtn_b64 v[72:73], v94, v[76:77] offset:65408
    s_setprio 0
    v_mfma_f32_4x4x4_16b_bf16 v[80:83], v[8:9], v[102:103], 0
    v_mfma_f32_4x4x4_16b_bf16 v[76:79], v[8:9], v[100:101], 0
    v_cmp_lt_u32 s[48:49], v5, v93
    s_nop 2
    v_pk_mul_f32 v[80:81], v[80:81], v[14:15] op_sel:[0,1] op_sel_hi:[1,1]
    v_pk_mul_f32 v[82:83], v[82:83], v[14:15] op_sel:[0,1] op_sel_hi:[1,1]
    v_pk_mul_f32 v[76:77], v[76:77], v[14:15] op_sel:[0,0] op_sel_hi:[1,0]
    v_pk_mul_f32 v[78:79], v[78:79], v[14:15] op_sel:[0,0] op_sel_hi:[1,0]
    s_add_u32 s40, s40, 0x50000
    v_and_b32 v47, 0x0fffffff, v41
    buffer_load_dwordx2 v[22:23], v47, s[8:11], 0 offen
    buffer_load_dwordx3 v[24:26], v47, s[8:11], 0 offen offset:8
    v_and_b32 v46, 0x80000000, v39
    v_lshrrev_b32 v47, 14, v37
    v_bitop3_b32 v47, v47, v5, v46 bitop3:0xea
    ds_read_b64 v[102:103], v47
    v_and_b32 v99, 0x40000000, v39
    v_lshrrev_b32 v47, 14, v36
    v_bitop3_b32 v47, v47, v5, v99 bitop3:0xea
    ds_read_b64 v[100:101], v47
    v_and_b32 v46, 0x20000000, v39
    v_lshrrev_b32 v47, 14, v35
    v_bitop3_b32 v47, v47, v5, v46 bitop3:0xea
    ds_read_b64 v[106:107], v47
    v_and_b32 v99, 0x10000000, v39
    v_lshrrev_b32 v47, 14, v34
    v_bitop3_b32 v47, v47, v5, v99 bitop3:0xea
    ds_read_b64 v[104:105], v47
    s_waitcnt lgkmcnt(4)
    v_cmp_ne_u64 s[50:51], v[72:73], v[68:69]
    v_cmpx_ne_u64 s[54:55], v[74:75], v[70:71]
    s_and_b64 s[82:83], s[54:55], s[80:81]
    s_cbranch_scc1 L2_c23
L2_d23:
    v_mov_b64 v[84:85], v[70:71]
    v_mov_b32 v7, v95
    v_mov_b64 v[86:87], v[74:75]
    s_or_b64 s[80:81], s[80:81], s[54:55]
    s_mov_b64 exec, s[50:51]
    s_and_b64 s[82:83], s[50:51], s[80:81]
    s_cbranch_scc1 L2_c24
L2_d24:
    v_mov_b64 v[84:85], v[68:69]
    v_mov_b32 v7, v94
    v_mov_b64 v[86:87], v[72:73]
    s_mov_b64 exec, -1
    s_or_b64 s[80:81], s[80:81], s[50:51]
    s_and_b64 exec, s[48:49], s[80:81]
    v_mfma_f32_4x4x4_16b_bf16 v[80:83], v[12:13], v[84:85], 0
    v_mov_b32 v93, v7
    s_andn2_b64 s[80:81], s[80:81], s[48:49]
    v_mfma_f32_4x4x4_16b_bf16 v[80:83], v[10:11], v[86:87], v[80:83]
    s_mov_b64 exec, -1
    ds_read_b64 v[70:71], v93 offset:65408
    ds_read_b64 v[68:69], v92 offset:65408
    v_bitop3_b32 v94, v34, v5, v99 bitop3:0xea
    v_bitop3_b32 v95, v35, v5, v46 bitop3:0xea
    v_perm_b32 v15, v35, v38, s45
    v_bitop3_b32 v46, v35, 0.5, -0.5 bitop3:0xa8
    v_perm_b32 v14, v34, v38, s44
    v_bitop3_b32 v47, v34, 0.5, -0.5 bitop3:0xa8
    v_bitop3_b32 v15, v6, v15, v46 bitop3:0xca
    v_bitop3_b32 v14, v6, v14, v47 bitop3:0xca
    s_waitcnt lgkmcnt(1)
    v_mfma_f32_4x4x4_16b_bf16 v[80:83], v[10:11], v[70:71], v[80:83]
    s_waitcnt lgkmcnt(0)
    v_mfma_f32_4x4x4_16b_bf16 v[76:79], v[10:11], v[68:69], v[76:79]
    s_nop 2
    v_cvt_pk_bf16_f32 v80, v80, v81
    v_cvt_pk_bf16_f32 v81, v82, v83
    ds_wrxchg_rtn_b64 v[74:75], v93, v[80:81] offset:65408
    v_cvt_pk_bf16_f32 v76, v76, v77
    v_cvt_pk_bf16_f32 v77, v78, v79
    ds_wrxchg_rtn_b64 v[72:73], v92, v[76:77] offset:65408
    s_barrier
    s_setprio 3
    s_waitcnt vmcnt(4)
    v_subrev_u32 v88, s38, v3
    ds_write_b128 v88, v[124:127] offset:34816
    s_add_u32 s3, s40, 4096
    buffer_load_dwordx4 v[124:127], v3, s[16:19], s3 offen sc1
    s_waitcnt vmcnt(5)
    v_subrev_u32 v88, s38, v3
    ds_write_b128 v88, v[116:119] offset:32768
    buffer_load_dwordx4 v[116:119], v3, s[16:19], s40 offen offset:2048 sc1
    s_waitcnt vmcnt(6)
    v_subrev_u32 v88, s38, v3
    ds_write_b128 v88, v[120:123] offset:33792
    buffer_load_dwordx4 v[120:123], v3, s[16:19], s40 offen offset:3072 sc1
    v_mfma_f32_4x4x4_16b_bf16 v[80:83], v[8:9], v[106:107], 0
    v_mfma_f32_4x4x4_16b_bf16 v[76:79], v[8:9], v[104:105], 0
    s_nop 3
    v_pk_mul_f32 v[80:81], v[80:81], v[14:15] op_sel:[0,1] op_sel_hi:[1,1]
    v_pk_mul_f32 v[82:83], v[82:83], v[14:15] op_sel:[0,1] op_sel_hi:[1,1]
    v_pk_mul_f32 v[76:77], v[76:77], v[14:15] op_sel:[0,0] op_sel_hi:[1,0]
    v_pk_mul_f32 v[78:79], v[78:79], v[14:15] op_sel:[0,0] op_sel_hi:[1,0]
    v_and_b32 v47, 0x0fffffff, v42
    buffer_load_dword v30, v47, s[8:11], 0 offen offset:16
    s_mov_b64 exec, s[6:7]
    v_add_u32 v47, 8, v47
    v_lshrrev_b32 v42, 2, v42
    s_mov_b64 exec, -1
    buffer_load_dwordx2 v[28:29], v47, s[8:11], 0 offen
    s_cmp_gt_u32 s37, 1024
    s_cbranch_scc1 L2_xs25
    s_cmp_lg_u32 s101, 0
    s_cbranch_scc1 L2_xa25
L2_xb25:
    v_lshlrev_b32 v89, 16, v96
    v_add_u32 v90, 60, v97
    v_bitop3_b32 v90, v89, v45, v90 bitop3:0x6a
    ds_write_b32 v98, v90 offset:12
    v_lshlrev_b32 v89, 20, v96
    v_add_u32 v90, 40, v97
    v_bitop3_b32 v90, v89, v45, v90 bitop3:0x6a
    ds_write_b32 v98, v90 offset:8
    v_lshlrev_b32 v89, 24, v96
    v_add_u32 v90, 20, v97
    v_bitop3_b32 v90, v89, v45, v90 bitop3:0x6a
    ds_write_b32 v98, v90 offset:4
    v_lshlrev_b32 v89, 28, v96
    v_bitop3_b32 v90, v89, v45, v97 bitop3:0x6a
    ds_write_b32 v98, v90 offset:0
    v_mov_b32_dpp v91, v64 quad_perm:[1,1,1,1] row_mask:0xf bank_mask:0xf
    v_and_b32 v89, 3, v91
    v_and_b32 v97, 0xfffc, v91
    v_sub_u16_dpp v88, v64, v91 quad_perm:[3,3,3,3] row_mask:0xf bank_mask:0xf
    v_mad_u32_u24 v97, v97, 5, v4
    v_add_u32 v99, v88, v89
    v_bfm_b32 v96, v88, v89
    v_cmp_lt_u32 s[58:59], 16, v99
    v_lshlrev_b32 v89, v1, v96
    v_and_b32 v89, v45, v89
    v_cmp_ne_u32 vcc, 0, v89
    v_xor_b32 v90, v97, v89
    s_add_u32 s3, s37, s38
    v_mbcnt_lo_u32_b32 v98, vcc_lo, 0
    v_mbcnt_hi_u32_b32 v98, vcc_hi, v98
    s_bcnt1_i32_b64 s41, vcc
    v_lshl_add_u32 v98, v98, 2, s3
    s_lshl2_add_u32 s37, s41, s37
    s_mov_b64 exec, vcc
    ds_write_b32 v98, v90
    s_mov_b64 exec, -1
    s_cmp_lg_u64 s[58:59], 0
    s_cbranch_scc1 L2_xe25
L2_xr25:
    v_add_u32 v98, s37, v0
    v_mov_b32 v90, -1
    ds_write_b32 v98, v90
L2_xw25:
    s_setprio 2
    s_waitcnt lgkmcnt(9)
    v_cmp_ne_u64 s[50:51], v[72:73], v[68:69]
    v_cmpx_ne_u64 s[54:55], v[74:75], v[70:71]
    s_and_b64 s[82:83], s[54:55], s[80:81]
    s_cbranch_scc1 L2_c26
L2_d26:
    v_mov_b64 v[84:85], v[70:71]
    v_mov_b32 v7, v93
    v_mov_b64 v[86:87], v[74:75]
    s_or_b64 s[80:81], s[80:81], s[54:55]
    s_mov_b64 exec, s[50:51]
    s_and_b64 s[82:83], s[50:51], s[80:81]
    s_cbranch_scc1 L2_c27
L2_d27:
    v_mov_b64 v[84:85], v[68:69]
    v_mov_b32 v7, v92
    v_mov_b64 v[86:87], v[72:73]
    s_mov_b64 exec, -1
    s_or_b64 s[80:81], s[80:81], s[50:51]
    ds_read_b64 v[70:71], v95 offset:65408
    ds_read_b64 v[68:69], v94 offset:65408
    v_and_b32 v46, 0x40000000, v39
    v_bitop3_b32 v92, v36, v5, v46 bitop3:0xea
    v_and_b32 v46, 0x80000000, v39
    v_bitop3_b32 v93, v37, v5, v46 bitop3:0xea
    v_perm_b32 v15, v37, v38, s47
    v_bitop3_b32 v46, v37, 0.5, -0.5 bitop3:0xa8
    v_perm_b32 v14, v36, v38, s46
    v_bitop3_b32 v47, v36, 0.5, -0.5 bitop3:0xa8
    v_bitop3_b32 v15, v6, v15, v46 bitop3:0xca
    v_bitop3_b32 v14, v6, v14, v47 bitop3:0xca
    s_setprio 1
    s_waitcnt lgkmcnt(1)
    v_mfma_f32_4x4x4_16b_bf16 v[80:83], v[10:11], v[70:71], v[80:83]
    s_waitcnt lgkmcnt(0)
    v_mfma_f32_4x4x4_16b_bf16 v[76:79], v[10:11], v[68:69], v[76:79]
    s_nop 2
    v_cvt_pk_bf16_f32 v80, v80, v81
    v_cvt_pk_bf16_f32 v81, v82, v83
    ds_wrxchg_rtn_b64 v[74:75], v95, v[80:81] offset:65408
    v_cvt_pk_bf16_f32 v76, v76, v77
    v_cvt_pk_bf16_f32 v77, v78, v79
    ds_wrxchg_rtn_b64 v[72:73], v94, v[76:77] offset:65408
    ds_read_b32 v21, v0 offset:0
    ds_read_b32 v27, v0 offset:256
    ds_read_b32 v31, v44 offset:768
    ds_read_b32 v39, v0 offset:512
    s_sub_u32 s3, s37, 768
    s_cmp_gt_u32 s3, 128
    s_cbranch_scc1 L2_xf25
L2_xg25:
    v_and_b32 v88, 0x0fffffff, v43
    buffer_load_dwordx2 v[34:35], v88, s[8:11], 0 offen
    buffer_load_dwordx3 v[36:38], v88, s[8:11], 0 offen offset:8
    s_setprio 0
    s_waitcnt vmcnt(11)
    v_subrev_u32 v88, s100, v3
    ds_write_b128 v88, v[108:111] offset:0
    s_waitcnt vmcnt(11)
    v_subrev_u32 v88, s100, v3
    ds_write_b128 v88, v[112:115] offset:1024
    v_mfma_f32_4x4x4_16b_bf16 v[80:83], v[8:9], v[102:103], 0
    v_mfma_f32_4x4x4_16b_bf16 v[76:79], v[8:9], v[100:101], 0
    v_cmp_lt_u32 s[84:85], v5, v92
    s_nop 2
    v_pk_mul_f32 v[80:81], v[80:81], v[14:15] op_sel:[0,1] op_sel_hi:[1,1]
    v_pk_mul_f32 v[82:83], v[82:83], v[14:15] op_sel:[0,1] op_sel_hi:[1,1]
    v_pk_mul_f32 v[76:77], v[76:77], v[14:15] op_sel:[0,0] op_sel_hi:[1,0]
    v_pk_mul_f32 v[78:79], v[78:79], v[14:15] op_sel:[0,0] op_sel_hi:[1,0]
    s_add_u32 s42, s42, 1
    s_waitcnt lgkmcnt(0)
    s_add_u32 s24, s30, 0xec54000
    s_addc_u32 s25, s31, 0
    s_mov_b32 s26, 0x100
    s_mov_b32 s27, 0x20000
    s_barrier
    s_bitcmp1_b32 s36, s42
    s_cbranch_scc1 L2_slow
L2_ret1:
    s_setprio 3
    s_bitcmp1_b32 s43, s42
    s_cbranch_scc1 L2_oa28
L2_ob28:
    s_waitcnt vmcnt(9)
    v_and_b32 v46, 0x20000000, v40
    v_lshrrev_b32 v47, 14, v17
    v_bitop3_b32 v47, v47, v5, v46 bitop3:0xea
    ds_read_b64 v[106:107], v47
    v_and_b32 v99, 0x10000000, v40
    v_lshrrev_b32 v47, 14, v16
    v_bitop3_b32 v47, v47, v5, v99 bitop3:0xea
    ds_read_b64 v[104:105], v47
    v_cmp_ne_u64 s[50:51], v[72:73], v[68:69]
    v_cmpx_ne_u64 s[54:55], v[74:75], v[70:71]
    s_and_b64 s[82:83], s[54:55], s[80:81]
    s_cbranch_scc1 L2_c29
L2_d29:
    v_mov_b64 v[84:85], v[70:71]
    v_mov_b32 v7, v95
    v_mov_b64 v[86:87], v[74:75]
    s_or_b64 s[80:81], s[80:81], s[54:55]
    s_mov_b64 exec, s[50:51]
    s_and_b64 s[82:83], s[50:51], s[80:81]
    s_cbranch_scc1 L2_c30
L2_d30:
    v_mov_b64 v[84:85], v[68:69]
    v_mov_b32 v7, v94
    v_mov_b64 v[86:87], v[72:73]
    s_mov_b64 exec, -1
    s_or_b64 s[80:81], s[80:81], s[50:51]
    s_and_b64 exec, s[84:85], s[80:81]
    v_mfma_f32_4x4x4_16b_bf16 v[76:79], v[12:13], v[84:85], 0
    v_mov_b32 v92, v7
    s_andn2_b64 s[80:81], s[80:81], s[84:85]
    v_mfma_f32_4x4x4_16b_bf16 v[76:79], v[10:11], v[86:87], v[76:79]
    s_mov_b64 exec, -1
    ds_read_b64 v[70:71], v93 offset:65408
    ds_read_b64 v[68:69], v92 offset:65408
    v_bitop3_b32 v94, v16, v5, v99 bitop3:0xea
    v_bitop3_b32 v95, v17, v5, v46 bitop3:0xea
    v_perm_b32 v15, v17, v20, s45
    v_bitop3_b32 v46, v17, 0.5, -0.5 bitop3:0xa8
    v_perm_b32 v14, v16, v20, s44
    v_bitop3_b32 v47, v16, 0.5, -0.5 bitop3:0xa8
    v_bitop3_b32 v15, v6, v15, v46 bitop3:0xca
    v_bitop3_b32 v14, v6, v14, v47 bitop3:0xca
    s_waitcnt lgkmcnt(1)
    v_mfma_f32_4x4x4_16b_bf16 v[80:83], v[10:11], v[70:71], v[80:83]
    s_waitcnt lgkmcnt(0)
    v_mfma_f32_4x4x4_16b_bf16 v[76:79], v[10:11], v[68:69], v[76:79]
    s_nop 2
    v_cvt_pk_bf16_f32 v80, v80, v81
    v_cvt_pk_bf16_f32 v81, v82, v83
    ds_wrxchg_rtn_b64 v[74:75], v93, v[80:81] offset:65408
    v_cvt_pk_bf16_f32 v76, v76, v77
    v_cvt_pk_bf16_f32 v77, v78, v79
    ds_wrxchg_rtn_b64 v[72:73], v92, v[76:77] offset:65408
    v_mfma_f32_4x4x4_16b_bf16 v[80:83], v[8:9], v[106:107], 0
    v_mfma_f32_4x4x4_16b_bf16 v[76:79], v[8:9], v[104:105], 0
    v_cmp_lt_u32 s[84:85], v5, v94
    s_nop 2
    v_pk_mul_f32 v[80:81], v[80:81], v[14:15] op_sel:[0,1] op_sel_hi:[1,1]
    v_pk_mul_f32 v[82:83], v[82:83], v[14:15] op_sel:[0,1] op_sel_hi:[1,1]
    v_pk_mul_f32 v[76:77], v[76:77], v[14:15] op_sel:[0,0] op_sel_hi:[1,0]
    v_pk_mul_f32 v[78:79], v[78:79], v[14:15] op_sel:[0,0] op_sel_hi:[1,0]
    buffer_load_dwordx4 v[108:111], v3, s[16:19], s40 offen offset:0 sc1
    v_and_b32 v46, 0x80000000, v40
    v_lshrrev_b32 v47, 14, v19
    v_bitop3_b32 v47, v47, v5, v46 bitop3:0xea
    ds_read_b64 v[102:103], v47
    v_and_b32 v99, 0x40000000, v40
    v_lshrrev_b32 v47, 14, v18
    v_bitop3_b32 v47, v47, v5, v99 bitop3:0xea
    ds_read_b64 v[100:101], v47
    s_waitcnt lgkmcnt(2)
    v_cmp_ne_u64 s[50:51], v[72:73], v[68:69]
    v_cmpx_ne_u64 s[54:55], v[74:75], v[70:71]
    s_and_b64 s[82:83], s[54:55], s[80:81]
    s_cbranch_scc1 L2_c31
L2_d31:
    v_mov_b64 v[84:85], v[70:71]
    v_mov_b32 v7, v93
    v_mov_b64 v[86:87], v[74:75]
    s_or_b64 s[80:81], s[80:81], s[54:55]
    s_mov_b64 exec, s[50:51]
    s_and_b64 s[82:83], s[50:51], s[80:81]
    s_cbranch_scc1 L2_c32
L2_d32:
    v_mov_b64 v[84:85], v[68:69]
    v_mov_b32 v7, v92
    v_mov_b64 v[86:87], v[72:73]
    s_mov_b64 exec, -1
    s_or_b64 s[80:81], s[80:81], s[50:51]
    s_and_b64 exec, s[84:85], s[80:81]
    v_mfma_f32_4x4x4_16b_bf16 v[76:79], v[12:13], v[84:85], 0
    v_mov_b32 v94, v7
    s_andn2_b64 s[80:81], s[80:81], s[84:85]
    v_mfma_f32_4x4x4_16b_bf16 v[76:79], v[10:11], v[86:87], v[76:79]
    s_mov_b64 exec, -1
    ds_read_b64 v[70:71], v95 offset:65408
    ds_read_b64 v[68:69], v94 offset:65408
    v_bitop3_b32 v92, v18, v5, v99 bitop3:0xea
    v_bitop3_b32 v93, v19, v5, v46 bitop3:0xea
    v_perm_b32 v15, v19, v20, s47
    v_bitop3_b32 v46, v19, 0.5, -0.5 bitop3:0xa8
    v_perm_b32 v14, v18, v20, s46
    v_bitop3_b32 v47, v18, 0.5, -0.5 bitop3:0xa8
    v_bitop3_b32 v15, v6, v15, v46 bitop3:0xca
    v_bitop3_b32 v14, v6, v14, v47 bitop3:0xca
    s_waitcnt lgkmcnt(1)
    v_mfma_f32_4x4x4_16b_bf16 v[80:83], v[10:11], v[70:71], v[80:83]
    s_waitcnt lgkmcnt(0)
    v_mfma_f32_4x4x4_16b_bf16 v[76:79], v[10:11], v[68:69], v[76:79]
    s_nop 2
    v_cvt_pk_bf16_f32 v80, v80, v81
    v_cvt_pk_bf16_f32 v81, v82, v83
    ds_wrxchg_rtn_b64 v[74:75], v95, v[80:81] offset:65408
    v_cvt_pk_bf16_f32 v76, v76, v77
    v_cvt_pk_bf16_f32 v77, v78, v79
    ds_wrxchg_rtn_b64 v[72:73], v94, v[76:77] offset:65408
    v_and_b32 v88, 0x0fffffff, v21
    buffer_load_dwordx2 v[16:17], v88, s[8:11], 0 offen
    buffer_load_dwordx3 v[18:20], v88, s[8:11], 0 offen offset:8
    s_setprio 2
    v_mfma_f32_4x4x4_16b_bf16 v[80:83], v[8:9], v[102:103], 0
    v_mfma_f32_4x4x4_16b_bf16 v[76:79], v[8:9], v[100:101], 0
    v_cmp_lt_u32 s[48:49], v5, v93
    s_nop 2
    v_pk_mul_f32 v[80:81], v[80:81], v[14:15] op_sel:[0,1] op_sel_hi:[1,1]
    v_pk_mul_f32 v[82:83], v[82:83], v[14:15] op_sel:[0,1] op_sel_hi:[1,1]
    v_pk_mul_f32 v[76:77], v[76:77], v[14:15] op_sel:[0,0] op_sel_hi:[1,0]
    v_pk_mul_f32 v[78:79], v[78:79], v[14:15] op_sel:[0,0] op_sel_hi:[1,0]
    s_waitcnt vmcnt(10)
    v_and_b32 v46, 0x20000000, v41
    v_lshrrev_b32 v47, 14, v23
    v_bitop3_b32 v47, v47, v5, v46 bitop3:0xea
    ds_read_b64 v[106:107], v47
    v_and_b32 v99, 0x10000000, v41
    v_lshrrev_b32 v47, 14, v22
    v_bitop3_b32 v47, v47, v5, v99 bitop3:0xea
    ds_read_b64 v[104:105], v47
    s_waitcnt lgkmcnt(2)
    v_cmp_ne_u64 s[50:51], v[72:73], v[68:69]
    v_cmpx_ne_u64 s[54:55], v[74:75], v[70:71]
    s_and_b64 s[82:83], s[54:55], s[80:81]
    s_cbranch_scc1 L2_c33
L2_d33:
    v_mov_b64 v[84:85], v[70:71]
    v_mov_b32 v7, v95
    v_mov_b64 v[86:87], v[74:75]
    s_or_b64 s[80:81], s[80:81], s[54:55]
    s_mov_b64 exec, s[50:51]
    s_and_b64 s[82:83], s[50:51], s[80:81]
    s_cbranch_scc1 L2_c34
L2_d34:
    v_mov_b64 v[84:85], v[68:69]
    v_mov_b32 v7, v94
    v_mov_b64 v[86:87], v[72:73]
    s_mov_b64 exec, -1
    s_or_b64 s[80:81], s[80:81], s[50:51]
    s_and_b64 exec, s[48:49], s[80:81]
    v_mfma_f32_4x4x4_16b_bf16 v[80:83], v[12:13], v[84:85], 0
    v_mov_b32 v93, v7
    s_andn2_b64 s[80:81], s[80:81], s[48:49]
    v_mfma_f32_4x4x4_16b_bf16 v[80:83], v[10:11], v[86:87], v[80:83]
    s_mov_b64 exec, -1
    ds_read_b64 v[70:71], v93 offset:65408
    ds_read_b64 v[68:69], v92 offset:65408
    v_bitop3_b32 v94, v22, v5, v99 bitop3:0xea
    v_bitop3_b32 v95, v23, v5, v46 bitop3:0xea
    v_perm_b32 v15, v23, v26, s45
    v_bitop3_b32 v46, v23, 0.5, -0.5 bitop3:0xa8
    v_perm_b32 v14, v22, v26, s44
    v_bitop3_b32 v47, v22, 0.5, -0.5 bitop3:0xa8
    v_bitop3_b32 v15, v6, v15, v46 bitop3:0xca
    v_bitop3_b32 v14, v6, v14, v47 bitop3:0xca
    s_waitcnt lgkmcnt(1)
    v_mfma_f32_4x4x4_16b_bf16 v[80:83], v[10:11], v[70:71], v[80:83]
    s_waitcnt lgkmcnt(0)
    v_mfma_f32_4x4x4_16b_bf16 v[76:79], v[10:11], v[68:69], v[76:79]
    s_nop 2
    v_cvt_pk_bf16_f32 v80, v80, v81
    v_cvt_pk_bf16_f32 v81, v82, v83
    ds_wrxchg_rtn_b64 v[74:75], v93, v[80:81] offset:65408
    v_cvt_pk_bf16_f32 v76, v76, v77
    v_cvt_pk_bf16_f32 v77, v78, v79
    ds_wrxchg_rtn_b64 v[72:73], v92, v[76:77] offset:65408
    s_setprio 1
    v_mfma_f32_4x4x4_16b_bf16 v[80:83], v[8:9], v[106:107], 0
    v_mfma_f32_4x4x4_16b_bf16 v[76:79], v[8:9], v[104:105], 0
    s_nop 3
    v_pk_mul_f32 v[80:81], v[80:81], v[14:15] op_sel:[0,1] op_sel_hi:[1,1]
    v_pk_mul_f32 v[82:83], v[82:83], v[14:15] op_sel:[0,1] op_sel_hi:[1,1]
    v_pk_mul_f32 v[76:77], v[76:77], v[14:15] op_sel:[0,0] op_sel_hi:[1,0]
    v_pk_mul_f32 v[78:79], v[78:79], v[14:15] op_sel:[0,0] op_sel_hi:[1,0]
    s_bitcmp1_b32 s43, s42
    s_cbranch_scc1 L2_oa35
L2_ob35:
    buffer_load_dwordx4 v[112:115], v3, s[16:19], s40 offen offset:1024 sc1
    v_sub_u16 v88, v62, v54
    v_and_b32 v89, 3, v54
    v_add3_u32 v99, v88, v89, 3
    v_and_b32 v99, -4, v99
    v_max_u32 v99, 4, v99
    v_and_b32 v97, 0xfffc, v54
    v_bfm_b32 v96, v88, v89
    v_add_u32_dpp v91, v99, v99 row_shr:1 row_mask:0xf bank_mask:0xf bound_ctrl:1
    v_mad_u32_u24 v97, v97, 5, v2
    v_cmp_lt_u32 vcc, 16, v99
    v_add_u32_dpp v91, v91, v91 row_shr:2 row_mask:0xf bank_mask:0xf bound_ctrl:1
    v_sub_u32 v98, s38, v99
    v_lshrrev_b64 v[54:55], 16, v[54:55]
    v_add_u32_dpp v91, v91, v91 row_shr:4 row_mask:0xf bank_mask:0xf bound_ctrl:1
    v_lshrrev_b64 v[62:63], 16, v[62:63]
    s_mov_b32 s101, 0
    v_add_u32_dpp v91, v91, v91 row_shr:8 row_mask:0xf bank_mask:0xf bound_ctrl:1
    s_nop 1
    v_add_u32_dpp v91, v91, v91 row_bcast:15 row_mask:0xa bank_mask:0xf
    s_nop 1
    v_add_u32_dpp v91, v91, v91 row_bcast:31 row_mask:0xc bank_mask:0xf
    v_add_u32 v98, v98, v91
    v_readlane_b32 s37, v91, 63
    s_cbranch_vccnz L2_xo36
L2_xp36:
    v_and_b32 v46, 0x80000000, v41
    v_lshrrev_b32 v47, 14, v25
    v_bitop3_b32 v47, v47, v5, v46 bitop3:0xea
    ds_read_b64 v[102:103], v47
    v_and_b32 v99, 0x40000000, v41
    v_lshrrev_b32 v47, 14, v24
    v_bitop3_b32 v47, v47, v5, v99 bitop3:0xea
    ds_read_b64 v[100:101], v47
    s_waitcnt lgkmcnt(2)
    v_cmp_ne_u64 s[50:51], v[72:73], v[68:69]
    v_cmpx_ne_u64 s[54:55], v[74:75], v[70:71]
    s_and_b64 s[82:83], s[54:55], s[80:81]
    s_cbranch_scc1 L2_c37
L2_d37:
    v_mov_b64 v[84:85], v[70:71]
    v_mov_b32 v7, v93
    v_mov_b64 v[86:87], v[74:75]
    s_or_b64 s[80:81], s[80:81], s[54:55]
    s_mov_b64 exec, s[50:51]
    s_and_b64 s[82:83], s[50:51], s[80:81]
    s_cbranch_scc1 L2_c38
L2_d38:
    v_mov_b64 v[84:85], v[68:69]
    v_mov_b32 v7, v92
    v_mov_b64 v[86:87], v[72:73]
    s_mov_b64 exec, -1
    s_or_b64 s[80:81], s[80:81], s[50:51]
    ds_read_b64 v[70:71], v95 offset:65408
    ds_read_b64 v[68:69], v94 offset:65408
    v_bitop3_b32 v92, v24, v5, v99 bitop3:0xea
    v_bitop3_b32 v93, v25, v5, v46 bitop3:0xea
    v_perm_b32 v15, v25, v26, s47
    v_bitop3_b32 v46, v25, 0.5, -0.5 bitop3:0xa8
    v_perm_b32 v14, v24, v26, s46
    v_bitop3_b32 v47, v24, 0.5, -0.5 bitop3:0xa8
    v_bitop3_b32 v15, v6, v15, v46 bitop3:0xca
    v_bitop3_b32 v14, v6, v14, v47 bitop3:0xca
    s_waitcnt lgkmcnt(1)
    v_mfma_f32_4x4x4_16b_bf16 v[80:83], v[10:11], v[70:71], v[80:83]
    s_waitcnt lgkmcnt(0)
    v_mfma_f32_4x4x4_16b_bf16 v[76:79], v[10:11], v[68:69], v[76:79]
    s_nop 2
    v_cvt_pk_bf16_f32 v80, v80, v81
    v_cvt_pk_bf16_f32 v81, v82, v83
    ds_wrxchg_rtn_b64 v[74:75], v95, v[80:81] offset:65408
    v_cvt_pk_bf16_f32 v76, v76, v77
    v_cvt_pk_bf16_f32 v77, v78, v79
    ds_wrxchg_rtn_b64 v[72:73], v94, v[76:77] offset:65408
    v_and_b32 v88, 0x0fffffff, v27
    buffer_load_dwordx2 v[22:23], v88, s[8:11], 0 offen
    buffer_load_dwordx3 v[24:26], v88, s[8:11], 0 offen offset:8
    v_mfma_f32_4x4x4_16b_bf16 v[80:83], v[8:9], v[102:103], 0
    v_mfma_f32_4x4x4_16b_bf16 v[76:79], v[8:9], v[100:101], 0
    v_cmp_lt_u32 s[84:85], v5, v92
    s_nop 2
    v_pk_mul_f32 v[80:81], v[80:81], v[14:15] op_sel:[0,1] op_sel_hi:[1,1]
    v_pk_mul_f32 v[82:83], v[82:83], v[14:15] op_sel:[0,1] op_sel_hi:[1,1]
    v_pk_mul_f32 v[76:77], v[76:77], v[14:15] op_sel:[0,0] op_sel_hi:[1,0]
    v_pk_mul_f32 v[78:79], v[78:79], v[14:15] op_sel:[0,0] op_sel_hi:[1,0]
    s_waitcnt vmcnt(8)
    s_mov_b64 exec, s[6:7]
    v_lshrrev_b32 v30, 16, v30
    s_mov_b64 exec, -1
    v_and_b32 v46, 0x20000000, v42
    v_lshrrev_b32 v47, 14, v29
    v_bitop3_b32 v47, v47, v5, v46 bitop3:0xea
    ds_read_b64 v[106:107], v47
    v_and_b32 v99, 0x10000000, v42
    v_lshrrev_b32 v47, 14, v28
    v_bitop3_b32 v47, v47, v5, v99 bitop3:0xea
    ds_read_b64 v[104:105], v47
    s_waitcnt lgkmcnt(2)
    v_cmp_ne_u64 s[50:51], v[72:73], v[68:69]
    v_cmpx_ne_u64 s[54:55], v[74:75], v[70:71]
    s_and_b64 s[82:83], s[54:55], s[80:81]
    s_cbranch_scc1 L2_c39
L2_d39:
    v_mov_b64 v[84:85], v[70:71]
    v_mov_b32 v7, v95
    v_mov_b64 v[86:87], v[74:75]
    s_or_b64 s[80:81], s[80:81], s[54:55]
    s_mov_b64 exec, s[50:51]
    s_and_b64 s[82:83], s[50:51], s[80:81]
    s_cbranch_scc1 L2_c40
L2_d40:
    v_mov_b64 v[84:85], v[68:69]
    v_mov_b32 v7, v94
    v_mov_b64 v[86:87], v[72:73]
    s_mov_b64 exec, -1
    s_or_b64 s[80:81], s[80:81], s[50:51]
    s_and_b64 exec, s[84:85], s[80:81]
    v_mfma_f32_4x4x4_16b_bf16 v[76:79], v[12:13], v[84:85], 0
    v_mov_b32 v92, v7
    s_andn2_b64 s[80:81], s[80:81], s[84:85]
    v_mfma_f32_4x4x4_16b_bf16 v[76:79], v[10:11], v[86:87], v[76:79]
    s_mov_b64 exec, -1
    ds_read_b64 v[70:71], v93 offset:65408
    ds_read_b64 v[68:69], v92 offset:65408
    v_bitop3_b32 v94, v28, v5, v99 bitop3:0xea
    v_bitop3_b32 v95, v29, v5, v46 bitop3:0xea
    v_perm_b32 v15, v29, v30, s45
    v_bitop3_b32 v46, v29, 0.5, -0.5 bitop3:0xa8
    v_perm_b32 v14, v28, v30, s44
    v_bitop3_b32 v47, v28, 0.5, -0.5 bitop3:0xa8
    v_bitop3_b32 v15, v6, v15, v46 bitop3:0xca
    v_bitop3_b32 v14, v6, v14, v47 bitop3:0xca
    s_waitcnt lgkmcnt(1)
    v_mfma_f32_4x4x4_16b_bf16 v[80:83], v[10:11], v[70:71], v[80:83]
    s_waitcnt lgkmcnt(0)
    v_mfma_f32_4x4x4_16b_bf16 v[76:79], v[10:11], v[68:69], v[76:79]
    s_nop 2
    v_cvt_pk_bf16_f32 v80, v80, v81
    v_cvt_pk_bf16_f32 v81, v82, v83
    ds_wrxchg_rtn_b64 v[74:75], v93, v[80:81] offset:65408
    v_cvt_pk_bf16_f32 v76, v76, v77
    v_cvt_pk_bf16_f32 v77, v78, v79
    ds_wrxchg_rtn_b64 v[72:73], v92, v[76:77] offset:65408
    s_setprio 0
    v_mfma_f32_4x4x4_16b_bf16 v[80:83], v[8:9], v[106:107], 0
    v_mfma_f32_4x4x4_16b_bf16 v[76:79], v[8:9], v[104:105], 0
    v_cmp_lt_u32 s[48:49], v5, v95
    s_nop 2
    v_pk_mul_f32 v[80:81], v[80:81], v[14:15] op_sel:[0,1] op_sel_hi:[1,1]
    v_pk_mul_f32 v[82:83], v[82:83], v[14:15] op_sel:[0,1] op_sel_hi:[1,1]
    v_pk_mul_f32 v[76:77], v[76:77], v[14:15] op_sel:[0,0] op_sel_hi:[1,0]
    v_pk_mul_f32 v[78:79], v[78:79], v[14:15] op_sel:[0,0] op_sel_hi:[1,0]
    s_add_u32 s40, s40, 0x50000
    v_and_b32 v47, 0x0fffffff, v31
    buffer_load_dword v30, v47, s[8:11], 0 offen offset:16
    s_mov_b64 exec, s[6:7]
    v_add_u32 v47, 8, v47
    v_lshrrev_b32 v31, 2, v31
    s_mov_b64 exec, -1
    buffer_load_dwordx2 v[28:29], v47, s[8:11], 0 offen
    s_waitcnt vmcnt(8)
    v_and_b32 v46, 0x80000000, v43
    v_lshrrev_b32 v47, 14, v37
    v_bitop3_b32 v47, v47, v5, v46 bitop3:0xea
    ds_read_b64 v[106:107], v47
    v_and_b32 v99, 0x40000000, v43
    v_lshrrev_b32 v47, 14, v36
    v_bitop3_b32 v47, v47, v5, v99 bitop3:0xea
    ds_read_b64 v[104:105], v47
    v_and_b32 v46, 0x20000000, v43
    v_lshrrev_b32 v47, 14, v35
    v_bitop3_b32 v47, v47, v5, v46 bitop3:0xea
    ds_read_b64 v[102:103], v47
    v_and_b32 v99, 0x10000000, v43
    v_lshrrev_b32 v47, 14, v34
    v_bitop3_b32 v47, v47, v5, v99 bitop3:0xea
    ds_read_b64 v[100:101], v47
    s_waitcnt lgkmcnt(4)
    v_cmp_ne_u64 s[50:51], v[72:73], v[68:69]
    v_cmpx_ne_u64 s[54:55], v[74:75], v[70:71]
    s_and_b64 s[82:83], s[54:55], s[80:81]
    s_cbranch_scc1 L2_c41
L2_d41:
    v_mov_b64 v[84:85], v[70:71]
    v_mov_b32 v7, v93
    v_mov_b64 v[86:87], v[74:75]
    s_or_b64 s[80:81], s[80:81], s[54:55]
    s_mov_b64 exec, s[50:51]
    s_and_b64 s[82:83], s[50:51], s[80:81]
    s_cbranch_scc1 L2_c42
L2_d42:
    v_mov_b64 v[84:85], v[68:69]
    v_mov_b32 v7, v92
    v_mov_b64 v[86:87], v[72:73]
    s_mov_b64 exec, -1
    s_or_b64 s[80:81], s[80:81], s[50:51]
    s_and_b64 exec, s[48:49], s[80:81]
    v_mfma_f32_4x4x4_16b_bf16 v[80:83], v[12:13], v[84:85], 0
    v_mov_b32 v95, v7
    s_andn2_b64 s[80:81], s[80:81], s[48:49]
    v_mfma_f32_4x4x4_16b_bf16 v[80:83], v[10:11], v[86:87], v[80:83]
    s_mov_b64 exec, -1
    ds_read_b64 v[70:71], v95 offset:65408
    ds_read_b64 v[68:69], v94 offset:65408
    v_bitop3_b32 v92, v34, v5, v99 bitop3:0xea
    v_bitop3_b32 v93, v35, v5, v46 bitop3:0xea
    v_perm_b32 v15, v35, v38, s45
    v_bitop3_b32 v46, v35, 0.5, -0.5 bitop3:0xa8
    v_perm_b32 v14, v34, v38, s44
    v_bitop3_b32 v47, v34, 0.5, -0.5 bitop3:0xa8
    v_bitop3_b32 v15, v6, v15, v46 bitop3:0xca
    v_bitop3_b32 v14, v6, v14, v47 bitop3:0xca
    s_waitcnt lgkmcnt(1)
    v_mfma_f32_4x4x4_16b_bf16 v[80:83], v[10:11], v[70:71], v[80:83]
    s_waitcnt lgkmcnt(0)
    v_mfma_f32_4x4x4_16b_bf16 v[76:79], v[10:11], v[68:69], v[76:79]
    s_nop 2
    v_cvt_pk_bf16_f32 v80, v80, v81
    v_cvt_pk_bf16_f32 v81, v82, v83
    ds_wrxchg_rtn_b64 v[74:75], v95, v[80:81] offset:65408
    v_cvt_pk_bf16_f32 v76, v76, v77
    v_cvt_pk_bf16_f32 v77, v78, v79
    ds_wrxchg_rtn_b64 v[72:73], v94, v[76:77] offset:65408
    s_barrier
    s_setprio 3
    s_mov_b32 m0, s100
    s_nop 0
    ds_write_addtid_b32 v124 offset:34816
    ds_write_addtid_b32 v125 offset:35072
    ds_write_addtid_b32 v126 offset:35328
    ds_write_addtid_b32 v127 offset:35584
    s_add_u32 s3, s40, 4096
    buffer_load_dwordx4 v[124:127], v3, s[16:19], s3 offen sc1
    ds_write_addtid_b32 v116 offset:32768
    ds_write_addtid_b32 v117 offset:33024
    ds_write_addtid_b32 v118 offset:33280
    ds_write_addtid_b32 v119 offset:33536
    buffer_load_dwordx4 v[116:119], v3, s[16:19], s40 offen offset:2048 sc1
    ds_write_addtid_b32 v120 offset:33792
    ds_write_addtid_b32 v121 offset:34048
    ds_write_addtid_b32 v122 offset:34304
    ds_write_addtid_b32 v123 offset:34560
    buffer_load_dwordx4 v[120:123], v3, s[16:19], s40 offen offset:3072 sc1
    v_mfma_f32_4x4x4_16b_bf16 v[80:83], v[8:9], v[102:103], 0
    v_mfma_f32_4x4x4_16b_bf16 v[76:79], v[8:9], v[100:101], 0
    s_nop 3
    v_pk_mul_f32 v[80:81], v[80:81], v[14:15] op_sel:[0,1] op_sel_hi:[1,1]
    v_pk_mul_f32 v[82:83], v[82:83], v[14:15] op_sel:[0,1] op_sel_hi:[1,1]
    v_pk_mul_f32 v[76:77], v[76:77], v[14:15] op_sel:[0,0] op_sel_hi:[1,0]
    v_pk_mul_f32 v[78:79], v[78:79], v[14:15] op_sel:[0,0] op_sel_hi:[1,0]
    s_cmp_gt_u32 s37, 1024
    s_cbranch_scc1 L2_xs43
    s_cmp_lg_u32 s101, 0
    s_cbranch_scc1 L2_xa43
L2_xb43:
    v_lshlrev_b32 v89, 16, v96
    v_add_u32 v90, 60, v97
    v_bitop3_b32 v90, v89, v45, v90 bitop3:0x6a
    ds_write_b32 v98, v90 offset:12
    v_lshlrev_b32 v89, 20, v96
    v_add_u32 v90, 40, v97
    v_bitop3_b32 v90, v89, v45, v90 bitop3:0x6a
    ds_write_b32 v98, v90 offset:8
    v_lshlrev_b32 v89, 24, v96
    v_add_u32 v90, 20, v97
    v_bitop3_b32 v90, v89, v45, v90 bitop3:0x6a
    ds_write_b32 v98, v90 offset:4
    v_lshlrev_b32 v89, 28, v96
    v_bitop3_b32 v90, v89, v45, v97 bitop3:0x6a
    ds_write_b32 v98, v90 offset:0
    v_mov_b32_dpp v91, v66 quad_perm:[1,1,1,1] row_mask:0xf bank_mask:0xf
    v_and_b32 v89, 3, v91
    v_and_b32 v97, 0xfffc, v91
    v_sub_u16_dpp v88, v66, v91 quad_perm:[3,3,3,3] row_mask:0xf bank_mask:0xf
    v_mad_u32_u24 v97, v97, 5, v4
    v_add_u32 v99, v88, v89
    v_bfm_b32 v96, v88, v89
    v_cmp_lt_u32 s[58:59], 16, v99
    v_lshlrev_b32 v89, v1, v96
    v_and_b32 v89, v45, v89
    v_cmp_ne_u32 vcc, 0, v89
    v_xor_b32 v90, v97, v89
    s_add_u32 s3, s37, s38
    v_mbcnt_lo_u32_b32 v98, vcc_lo, 0
    v_mbcnt_hi_u32_b32 v98, vcc_hi, v98
    s_bcnt1_i32_b64 s41, vcc
    v_lshl_add_u32 v98, v98, 2, s3
    s_lshl2_add_u32 s37, s41, s37
    s_mov_b64 exec, vcc
    ds_write_b32 v98, v90
    s_mov_b64 exec, -1
    s_cmp_lg_u64 s[58:59], 0
    s_cbranch_scc1 L2_xe43
L2_xr43:
    v_add_u32 v98, s37, v0
    v_mov_b32 v90, -1
    ds_write_b32 v98, v90
L2_xw43:
    s_setprio 2
    s_waitcnt lgkmcnt(14)
    v_cmp_ne_u64 s[50:51], v[72:73], v[68:69]
    v_cmpx_ne_u64 s[54:55], v[74:75], v[70:71]
    s_and_b64 s[82:83], s[54:55], s[80:81]
    s_cbranch_scc1 L2_c44
L2_d44:
    v_mov_b64 v[84:85], v[70:71]
    v_mov_b32 v7, v95
    v_mov_b64 v[86:87], v[74:75]
    s_or_b64 s[80:81], s[80:81], s[54:55]
    s_mov_b64 exec, s[50:51]
    s_and_b64 s[82:83], s[50:51], s[80:81]
    s_cbranch_scc1 L2_c45
L2_d45:
    v_mov_b64 v[84:85], v[68:69]
    v_mov_b32 v7, v94
    v_mov_b64 v[86:87], v[72:73]
    s_mov_b64 exec, -1
    s_or_b64 s[80:81], s[80:81], s[50:51]
    ds_read_b64 v[70:71], v93 offset:65408
    ds_read_b64 v[68:69], v92 offset:65408
    v_and_b32 v46, 0x40000000, v43
    v_bitop3_b32 v94, v36, v5, v46 bitop3:0xea
    v_and_b32 v46, 0x80000000, v43
    v_bitop3_b32 v95, v37, v5, v46 bitop3:0xea
    v_perm_b32 v15, v37, v38, s47
    v_bitop3_b32 v46, v37, 0.5, -0.5 bitop3:0xa8
    v_perm_b32 v14, v36, v38, s46
    v_bitop3_b32 v47, v36, 0.5, -0.5 bitop3:0xa8
    v_bitop3_b32 v15, v6, v15, v46 bitop3:0xca
    v_bitop3_b32 v14, v6, v14, v47 bitop3:0xca
    s_setprio 1
    s_waitcnt lgkmcnt(1)
    v_mfma_f32_4x4x4_16b_bf16 v[80:83], v[10:11], v[70:71], v[80:83]
    s_waitcnt lgkmcnt(0)
    v_mfma_f32_4x4x4_16b_bf16 v[76:79], v[10:11], v[68:69], v[76:79]
    s_nop 2
    v_cvt_pk_bf16_f32 v80, v80, v81
    v_cvt_pk_bf16_f32 v81, v82, v83
    ds_wrxchg_rtn_b64 v[74:75], v93, v[80:81] offset:65408
    v_cvt_pk_bf16_f32 v76, v76, v77
    v_cvt_pk_bf16_f32 v77, v78, v79
    ds_wrxchg_rtn_b64 v[72:73], v92, v[76:77] offset:65408
    ds_read_b32 v40, v0 offset:0
    ds_read_b32 v41, v0 offset:256
    ds_read_b32 v42, v44 offset:768
    ds_read_b32 v43, v0 offset:512
    s_sub_u32 s3, s37, 768
    s_cmp_gt_u32 s3, 128
    s_cbranch_scc1 L2_xf43
L2_xg43:
    v_lshrrev_b64 v[64:65], 16, v[64:65]
    v_lshrrev_b64 v[66:67], 16, v[66:67]
    v_and_b32 v88, 0x0fffffff, v39
    buffer_load_dwordx2 v[34:35], v88, s[8:11], 0 offen
    buffer_load_dwordx3 v[36:38], v88, s[8:11], 0 offen offset:8
    s_setprio 0
    s_waitcnt vmcnt(12)
    s_mov_b32 m0, s38
    s_nop 0
    ds_write_addtid_b32 v108 offset:0
    ds_write_addtid_b32 v109 offset:256
    ds_write_addtid_b32 v110 offset:512
    ds_write_addtid_b32 v111 offset:768
    s_waitcnt vmcnt(9)
    ds_write_addtid_b32 v112 offset:1024
    ds_write_addtid_b32 v113 offset:1280
    ds_write_addtid_b32 v114 offset:1536
    ds_write_addtid_b32 v115 offset:1792
    v_mfma_f32_4x4x4_16b_bf16 v[80:83], v[8:9], v[106:107], 0
    v_mfma_f32_4x4x4_16b_bf16 v[76:79], v[8:9], v[104:105], 0
    v_cmp_lt_u32 s[84:85], v5, v94
    s_nop 2
    v_pk_mul_f32 v[80:81], v[80:81], v[14:15] op_sel:[0,1] op_sel_hi:[1,1]
    v_pk_mul_f32 v[82:83], v[82:83], v[14:15] op_sel:[0,1] op_sel_hi:[1,1]
    v_pk_mul_f32 v[76:77], v[76:77], v[14:15] op_sel:[0,0] op_sel_hi:[1,0]
    v_pk_mul_f32 v[78:79], v[78:79], v[14:15] op_sel:[0,0] op_sel_hi:[1,0]
    s_add_u32 s42, s42, 1
    s_waitcnt lgkmcnt(0)
L2_loop:
    s_barrier
    s_bitcmp1_b32 s36, s42
    s_cbranch_scc1 L2_slow
L2_ret2:
    s_setprio 3
    s_bitcmp1_b32 s43, s42
    s_cbranch_scc1 L2_oa46
L2_ob46:
    v_and_b32 v46, 0x20000000, v21
    v_lshrrev_b32 v47, 14, v17
    v_bitop3_b32 v47, v47, v5, v46 bitop3:0xea
    ds_read_b64 v[102:103], v47
    v_and_b32 v99, 0x10000000, v21
    v_lshrrev_b32 v47, 14, v16
    v_bitop3_b32 v47, v47, v5, v99 bitop3:0xea
    ds_read_b64 v[100:101], v47
    v_cmp_ne_u64 s[50:51], v[72:73], v[68:69]
    v_cmpx_ne_u64 s[54:55], v[74:75], v[70:71]
    s_and_b64 s[82:83], s[54:55], s[80:81]
    s_cbranch_scc1 L2_c47
L2_d47:
    v_mov_b64 v[84:85], v[70:71]
    v_mov_b32 v7, v93
    v_mov_b64 v[86:87], v[74:75]
    s_or_b64 s[80:81], s[80:81], s[54:55]
    s_mov_b64 exec, s[50:51]
    s_and_b64 s[82:83], s[50:51], s[80:81]
    s_cbranch_scc1 L2_c48
L2_d48:
    v_mov_b64 v[84:85], v[68:69]
    v_mov_b32 v7, v92
    v_mov_b64 v[86:87], v[72:73]
    s_mov_b64 exec, -1
    s_or_b64 s[80:81], s[80:81], s[50:51]
    s_and_b64 exec, s[84:85], s[80:81]
    v_mfma_f32_4x4x4_16b_bf16 v[76:79], v[12:13], v[84:85], 0
    v_mov_b32 v94, v7
    s_andn2_b64 s[80:81], s[80:81], s[84:85]
    v_mfma_f32_4x4x4_16b_bf16 v[76:79], v[10:11], v[86:87], v[76:79]
    s_mov_b64 exec, -1
    ds_read_b64 v[70:71], v95 offset:65408
    ds_read_b64 v[68:69], v94 offset:65408
    v_bitop3_b32 v92, v16, v5, v99 bitop3:0xea
    v_bitop3_b32 v93, v17, v5, v46 bitop3:0xea
    v_perm_b32 v15, v17, v20, s45
    v_bitop3_b32 v46, v17, 0.5, -0.5 bitop3:0xa8
    v_perm_b32 v14, v16, v20, s44
    v_bitop3_b32 v47, v16, 0.5, -0.5 bitop3:0xa8
    v_bitop3_b32 v15, v6, v15, v46 bitop3:0xca
    v_bitop3_b32 v14, v6, v14, v47 bitop3:0xca
    s_waitcnt lgkmcnt(1)
    v_mfma_f32_4x4x4_16b_bf16 v[80:83], v[10:11], v[70:71], v[80:83]
    s_waitcnt lgkmcnt(0)
    v_mfma_f32_4x4x4_16b_bf16 v[76:79], v[10:11], v[68:69], v[76:79]
    s_nop 2
    v_cvt_pk_bf16_f32 v80, v80, v81
    v_cvt_pk_bf16_f32 v81, v82, v83
    ds_wrxchg_rtn_b64 v[74:75], v95, v[80:81] offset:65408
    v_cvt_pk_bf16_f32 v76, v76, v77
    v_cvt_pk_bf16_f32 v77, v78, v79
    ds_wrxchg_rtn_b64 v[72:73], v94, v[76:77] offset:65408
    v_mfma_f32_4x4x4_16b_bf16 v[80:83], v[8:9], v[102:103], 0
    v_mfma_f32_4x4x4_16b_bf16 v[76:79], v[8:9], v[100:101], 0
    v_cmp_lt_u32 s[84:85], v5, v92
    s_nop 2
    v_pk_mul_f32 v[80:81], v[80:81], v[14:15] op_sel:[0,1] op_sel_hi:[1,1]
    v_pk_mul_f32 v[82:83], v[82:83], v[14:15] op_sel:[0,1] op_sel_hi:[1,1]
    v_pk_mul_f32 v[76:77], v[76:77], v[14:15] op_sel:[0,0] op_sel_hi:[1,0]
    v_pk_mul_f32 v[78:79], v[78:79], v[14:15] op_sel:[0,0] op_sel_hi:[1,0]
    buffer_load_dwordx4 v[108:111], v3, s[16:19], s40 offen offset:0 sc1
    v_and_b32 v46, 0x80000000, v21
    v_lshrrev_b32 v47, 14, v19
    v_bitop3_b32 v47, v47, v5, v46 bitop3:0xea
    ds_read_b64 v[106:107], v47
    v_and_b32 v99, 0x40000000, v21
    v_lshrrev_b32 v47, 14, v18
    v_bitop3_b32 v47, v47, v5, v99 bitop3:0xea
    ds_read_b64 v[104:105], v47
    s_waitcnt lgkmcnt(2)
    v_cmp_ne_u64 s[50:51], v[72:73], v[68:69]
    v_cmpx_ne_u64 s[54:55], v[74:75], v[70:71]
    s_and_b64 s[82:83], s[54:55], s[80:81]
    s_cbranch_scc1 L2_c49
L2_d49:
    v_mov_b64 v[84:85], v[70:71]
    v_mov_b32 v7, v95
    v_mov_b64 v[86:87], v[74:75]
    s_or_b64 s[80:81], s[80:81], s[54:55]
    s_mov_b64 exec, s[50:51]
    s_and_b64 s[82:83], s[50:51], s[80:81]
    s_cbranch_scc1 L2_c50
L2_d50:
    v_mov_b64 v[84:85], v[68:69]
    v_mov_b32 v7, v94
    v_mov_b64 v[86:87], v[72:73]
    s_mov_b64 exec, -1
    s_or_b64 s[80:81], s[80:81], s[50:51]
    s_and_b64 exec, s[84:85], s[80:81]
    v_mfma_f32_4x4x4_16b_bf16 v[76:79], v[12:13], v[84:85], 0
    v_mov_b32 v92, v7
    s_andn2_b64 s[80:81], s[80:81], s[84:85]
    v_mfma_f32_4x4x4_16b_bf16 v[76:79], v[10:11], v[86:87], v[76:79]
    s_mov_b64 exec, -1
    ds_read_b64 v[70:71], v93 offset:65408
    ds_read_b64 v[68:69], v92 offset:65408
    v_bitop3_b32 v94, v18, v5, v99 bitop3:0xea
    v_bitop3_b32 v95, v19, v5, v46 bitop3:0xea
    v_perm_b32 v15, v19, v20, s47
    v_bitop3_b32 v46, v19, 0.5, -0.5 bitop3:0xa8
    v_perm_b32 v14, v18, v20, s46
    v_bitop3_b32 v47, v18, 0.5, -0.5 bitop3:0xa8
    v_bitop3_b32 v15, v6, v15, v46 bitop3:0xca
    v_bitop3_b32 v14, v6, v14, v47 bitop3:0xca
    s_waitcnt lgkmcnt(1)
    v_mfma_f32_4x4x4_16b_bf16 v[80:83], v[10:11], v[70:71], v[80:83]
    s_waitcnt lgkmcnt(0)
    v_mfma_f32_4x4x4_16b_bf16 v[76:79], v[10:11], v[68:69], v[76:79]
    s_nop 2
    v_cvt_pk_bf16_f32 v80, v80, v81
    v_cvt_pk_bf16_f32 v81, v82, v83
    ds_wrxchg_rtn_b64 v[74:75], v93, v[80:81] offset:65408
    v_cvt_pk_bf16_f32 v76, v76, v77
    v_cvt_pk_bf16_f32 v77, v78, v79
    ds_wrxchg_rtn_b64 v[72:73], v92, v[76:77] offset:65408
    v_and_b32 v88, 0x0fffffff, v40
    buffer_load_dwordx2 v[16:17], v88, s[8:11], 0 offen
    buffer_load_dwordx3 v[18:20], v88, s[8:11], 0 offen offset:8
    s_setprio 2
    v_mfma_f32_4x4x4_16b_bf16 v[80:83], v[8:9], v[106:107], 0
    v_mfma_f32_4x4x4_16b_bf16 v[76:79], v[8:9], v[104:105], 0
    v_cmp_lt_u32 s[48:49], v5, v95
    s_nop 2
    v_pk_mul_f32 v[80:81], v[80:81], v[14:15] op_sel:[0,1] op_sel_hi:[1,1]
    v_pk_mul_f32 v[82:83], v[82:83], v[14:15] op_sel:[0,1] op_sel_hi:[1,1]
    v_pk_mul_f32 v[76:77], v[76:77], v[14:15] op_sel:[0,0] op_sel_hi:[1,0]
    v_pk_mul_f32 v[78:79], v[78:79], v[14:15] op_sel:[0,0] op_sel_hi:[1,0]
    s_waitcnt vmcnt(10)
    v_and_b32 v46, 0x20000000, v27
    v_lshrrev_b32 v47, 14, v23
    v_bitop3_b32 v47, v47, v5, v46 bitop3:0xea
    ds_read_b64 v[102:103], v47
    v_and_b32 v99, 0x10000000, v27
    v_lshrrev_b32 v47, 14, v22
    v_bitop3_b32 v47, v47, v5, v99 bitop3:0xea
    ds_read_b64 v[100:101], v47
    s_waitcnt lgkmcnt(2)
    v_cmp_ne_u64 s[50:51], v[72:73], v[68:69]
    v_cmpx_ne_u64 s[54:55], v[74:75], v[70:71]
    s_and_b64 s[82:83], s[54:55], s[80:81]
    s_cbranch_scc1 L2_c51
L2_d51:
    v_mov_b64 v[84:85], v[70:71]
    v_mov_b32 v7, v93
    v_mov_b64 v[86:87], v[74:75]
    s_or_b64 s[80:81], s[80:81], s[54:55]
    s_mov_b64 exec, s[50:51]
    s_and_b64 s[82:83], s[50:51], s[80:81]
    s_cbranch_scc1 L2_c52
L2_d52:
    v_mov_b64 v[84:85], v[68:69]
    v_mov_b32 v7, v92
    v_mov_b64 v[86:87], v[72:73]
    s_mov_b64 exec, -1
    s_or_b64 s[80:81], s[80:81], s[50:51]
    s_and_b64 exec, s[48:49], s[80:81]
    v_mfma_f32_4x4x4_16b_bf16 v[80:83], v[12:13], v[84:85], 0
    v_mov_b32 v95, v7
    s_andn2_b64 s[80:81], s[80:81], s[48:49]
    v_mfma_f32_4x4x4_16b_bf16 v[80:83], v[10:11], v[86:87], v[80:83]
    s_mov_b64 exec, -1
    ds_read_b64 v[70:71], v95 offset:65408
    ds_read_b64 v[68:69], v94 offset:65408
    v_bitop3_b32 v92, v22, v5, v99 bitop3:0xea
    v_bitop3_b32 v93, v23, v5, v46 bitop3:0xea
    v_perm_b32 v15, v23, v26, s45
    v_bitop3_b32 v46, v23, 0.5, -0.5 bitop3:0xa8
    v_perm_b32 v14, v22, v26, s44
    v_bitop3_b32 v47, v22, 0.5, -0.5 bitop3:0xa8
    v_bitop3_b32 v15, v6, v15, v46 bitop3:0xca
    v_bitop3_b32 v14, v6, v14, v47 bitop3:0xca
    s_waitcnt lgkmcnt(1)
    v_mfma_f32_4x4x4_16b_bf16 v[80:83], v[10:11], v[70:71], v[80:83]
    s_waitcnt lgkmcnt(0)
    v_mfma_f32_4x4x4_16b_bf16 v[76:79], v[10:11], v[68:69], v[76:79]
    s_nop 2
    v_cvt_pk_bf16_f32 v80, v80, v81
    v_cvt_pk_bf16_f32 v81, v82, v83
    ds_wrxchg_rtn_b64 v[74:75], v95, v[80:81] offset:65408
    v_cvt_pk_bf16_f32 v76, v76, v77
    v_cvt_pk_bf16_f32 v77, v78, v79
    ds_wrxchg_rtn_b64 v[72:73], v94, v[76:77] offset:65408
    s_setprio 1
    v_mfma_f32_4x4x4_16b_bf16 v[80:83], v[8:9], v[102:103], 0
    v_mfma_f32_4x4x4_16b_bf16 v[76:79], v[8:9], v[100:101], 0
    s_nop 3
    v_pk_mul_f32 v[80:81], v[80:81], v[14:15] op_sel:[0,1] op_sel_hi:[1,1]
    v_pk_mul_f32 v[82:83], v[82:83], v[14:15] op_sel:[0,1] op_sel_hi:[1,1]
    v_pk_mul_f32 v[76:77], v[76:77], v[14:15] op_sel:[0,0] op_sel_hi:[1,0]
    v_pk_mul_f32 v[78:79], v[78:79], v[14:15] op_sel:[0,0] op_sel_hi:[1,0]
    s_bitcmp1_b32 s43, s42
    s_cbranch_scc1 L2_oa53
L2_ob53:
    buffer_load_dwordx4 v[112:115], v3, s[16:19], s40 offen offset:1024 sc1
    v_sub_u16 v88, v56, v48
    v_and_b32 v89, 3, v48
    v_add3_u32 v99, v88, v89, 3
    v_and_b32 v99, -4, v99
    v_max_u32 v99, 4, v99
    v_and_b32 v97, 0xfffc, v48
    v_bfm_b32 v96, v88, v89
    v_add_u32_dpp v91, v99, v99 row_shr:1 row_mask:0xf bank_mask:0xf bound_ctrl:1
    v_mad_u32_u24 v97, v97, 5, v2
    v_cmp_lt_u32 vcc, 16, v99
    v_add_u32_dpp v91, v91, v91 row_shr:2 row_mask:0xf bank_mask:0xf bound_ctrl:1
    v_sub_u32 v98, s38, v99
    v_lshrrev_b64 v[48:49], 16, v[48:49]
    v_add_u32_dpp v91, v91, v91 row_shr:4 row_mask:0xf bank_mask:0xf bound_ctrl:1
    v_lshrrev_b64 v[56:57], 16, v[56:57]
    s_mov_b32 s101, 0
    v_add_u32_dpp v91, v91, v91 row_shr:8 row_mask:0xf bank_mask:0xf bound_ctrl:1
    s_nop 1
    v_add_u32_dpp v91, v91, v91 row_bcast:15 row_mask:0xa bank_mask:0xf
    s_nop 1
    v_add_u32_dpp v91, v91, v91 row_bcast:31 row_mask:0xc bank_mask:0xf
    v_add_u32 v98, v98, v91
    v_readlane_b32 s37, v91, 63
    s_cbranch_vccnz L2_xo54
L2_xp54:
    v_and_b32 v46, 0x80000000, v27
    v_lshrrev_b32 v47, 14, v25
    v_bitop3_b32 v47, v47, v5, v46 bitop3:0xea
    ds_read_b64 v[106:107], v47
    v_and_b32 v99, 0x40000000, v27
    v_lshrrev_b32 v47, 14, v24
    v_bitop3_b32 v47, v47, v5, v99 bitop3:0xea
    ds_read_b64 v[104:105], v47
    s_waitcnt lgkmcnt(2)
    v_cmp_ne_u64 s[50:51], v[72:73], v[68:69]
    v_cmpx_ne_u64 s[54:55], v[74:75], v[70:71]
    s_and_b64 s[82:83], s[54:55], s[80:81]
    s_cbranch_scc1 L2_c55
L2_d55:
    v_mov_b64 v[84:85], v[70:71]
    v_mov_b32 v7, v95
    v_mov_b64 v[86:87], v[74:75]
    s_or_b64 s[80:81], s[80:81], s[54:55]
    s_mov_b64 exec, s[50:51]
    s_and_b64 s[82:83], s[50:51], s[80:81]
    s_cbranch_scc1 L2_c56
L2_d56:
    v_mov_b64 v[84:85], v[68:69]
    v_mov_b32 v7, v94
    v_mov_b64 v[86:87], v[72:73]
    s_mov_b64 exec, -1
    s_or_b64 s[80:81], s[80:81], s[50:51]
    ds_read_b64 v[70:71], v93 offset:65408
    ds_read_b64 v[68:69], v92 offset:65408
    v_bitop3_b32 v94, v24, v5, v99 bitop3:0xea
    v_bitop3_b32 v95, v25, v5, v46 bitop3:0xea
    v_perm_b32 v15, v25, v26, s47
    v_bitop3_b32 v46, v25, 0.5, -0.5 bitop3:0xa8
    v_perm_b32 v14, v24, v26, s46
    v_bitop3_b32 v47, v24, 0.5, -0.5 bitop3:0xa8
    v_bitop3_b32 v15, v6, v15, v46 bitop3:0xca
    v_bitop3_b32 v14, v6, v14, v47 bitop3:0xca
    s_waitcnt lgkmcnt(1)
    v_mfma_f32_4x4x4_16b_bf16 v[80:83], v[10:11], v[70:71], v[80:83]
    s_waitcnt lgkmcnt(0)
    v_mfma_f32_4x4x4_16b_bf16 v[76:79], v[10:11], v[68:69], v[76:79]
    s_nop 2
    v_cvt_pk_bf16_f32 v80, v80, v81
    v_cvt_pk_bf16_f32 v81, v82, v83
    ds_wrxchg_rtn_b64 v[74:75], v93, v[80:81] offset:65408
    v_cvt_pk_bf16_f32 v76, v76, v77
    v_cvt_pk_bf16_f32 v77, v78, v79
    ds_wrxchg_rtn_b64 v[72:73], v92, v[76:77] offset:65408
    v_and_b32 v88, 0x0fffffff, v41
    buffer_load_dwordx2 v[22:23], v88, s[8:11], 0 offen
    buffer_load_dwordx3 v[24:26], v88, s[8:11], 0 offen offset:8
    v_mfma_f32_4x4x4_16b_bf16 v[80:83], v[8:9], v[106:107], 0
    v_mfma_f32_4x4x4_16b_bf16 v[76:79], v[8:9], v[104:105], 0
    v_cmp_lt_u32 s[84:85], v5, v94
    s_nop 2
    v_pk_mul_f32 v[80:81], v[80:81], v[14:15] op_sel:[0,1] op_sel_hi:[1,1]
    v_pk_mul_f32 v[82:83], v[82:83], v[14:15] op_sel:[0,1] op_sel_hi:[1,1]
    v_pk_mul_f32 v[76:77], v[76:77], v[14:15] op_sel:[0,0] op_sel_hi:[1,0]
    v_pk_mul_f32 v[78:79], v[78:79], v[14:15] op_sel:[0,0] op_sel_hi:[1,0]
    s_waitcnt vmcnt(11)
    s_mov_b64 exec, s[6:7]
    v_lshrrev_b32 v30, 16, v30
    s_mov_b64 exec, -1
    v_and_b32 v46, 0x20000000, v31
    v_lshrrev_b32 v47, 14, v29
    v_bitop3_b32 v47, v47, v5, v46 bitop3:0xea
    ds_read_b64 v[102:103], v47
    v_and_b32 v99, 0x10000000, v31
    v_lshrrev_b32 v47, 14, v28
    v_bitop3_b32 v47, v47, v5, v99 bitop3:0xea
    ds_read_b64 v[100:101], v47
    s_waitcnt lgkmcnt(2)
    v_cmp_ne_u64 s[50:51], v[72:73], v[68:69]
    v_cmpx_ne_u64 s[54:55], v[74:75], v[70:71]
    s_and_b64 s[82:83], s[54:55], s[80:81]
    s_cbranch_scc1 L2_c57
L2_d57:
    v_mov_b64 v[84:85], v[70:71]
    v_mov_b32 v7, v93
    v_mov_b64 v[86:87], v[74:75]
    s_or_b64 s[80:81], s[80:81], s[54:55]
    s_mov_b64 exec, s[50:51]
    s_and_b64 s[82:83], s[50:51], s[80:81]
    s_cbranch_scc1 L2_c58
L2_d58:
    v_mov_b64 v[84:85], v[68:69]
    v_mov_b32 v7, v92
    v_mov_b64 v[86:87], v[72:73]
    s_mov_b64 exec, -1
    s_or_b64 s[80:81], s[80:81], s[50:51]
    s_and_b64 exec, s[84:85], s[80:81]
    v_mfma_f32_4x4x4_16b_bf16 v[76:79], v[12:13], v[84:85], 0
    v_mov_b32 v94, v7
    s_andn2_b64 s[80:81], s[80:81], s[84:85]
    v_mfma_f32_4x4x4_16b_bf16 v[76:79], v[10:11], v[86:87], v[76:79]
    s_mov_b64 exec, -1
    ds_read_b64 v[70:71], v95 offset:65408
    ds_read_b64 v[68:69], v94 offset:65408
    v_bitop3_b32 v92, v28, v5, v99 bitop3:0xea
    v_bitop3_b32 v93, v29, v5, v46 bitop3:0xea
    v_perm_b32 v15, v29, v30, s45
    v_bitop3_b32 v46, v29, 0.5, -0.5 bitop3:0xa8
    v_perm_b32 v14, v28, v30, s44
    v_bitop3_b32 v47, v28, 0.5, -0.5 bitop3:0xa8
    v_bitop3_b32 v15, v6, v15, v46 bitop3:0xca
    v_bitop3_b32 v14, v6, v14, v47 bitop3:0xca
    s_waitcnt lgkmcnt(1)
    v_mfma_f32_4x4x4_16b_bf16 v[80:83], v[10:11], v[70:71], v[80:83]
    s_waitcnt lgkmcnt(0)
    v_mfma_f32_4x4x4_16b_bf16 v[76:79], v[10:11], v[68:69], v[76:79]
    s_nop 2
    v_cvt_pk_bf16_f32 v80, v80, v81
    v_cvt_pk_bf16_f32 v81, v82, v83
    ds_wrxchg_rtn_b64 v[74:75], v95, v[80:81] offset:65408
    v_cvt_pk_bf16_f32 v76, v76, v77
    v_cvt_pk_bf16_f32 v77, v78, v79
    ds_wrxchg_rtn_b64 v[72:73], v94, v[76:77] offset:65408
    s_setprio 0
    v_mfma_f32_4x4x4_16b_bf16 v[80:83], v[8:9], v[102:103], 0
    v_mfma_f32_4x4x4_16b_bf16 v[76:79], v[8:9], v[100:101], 0
    v_cmp_lt_u32 s[48:49], v5, v93
    s_nop 2
    v_pk_mul_f32 v[80:81], v[80:81], v[14:15] op_sel:[0,1] op_sel_hi:[1,1]
    v_pk_mul_f32 v[82:83], v[82:83], v[14:15] op_sel:[0,1] op_sel_hi:[1,1]
    v_pk_mul_f32 v[76:77], v[76:77], v[14:15] op_sel:[0,0] op_sel_hi:[1,0]
    v_pk_mul_f32 v[78:79], v[78:79], v[14:15] op_sel:[0,0] op_sel_hi:[1,0]
    s_add_u32 s40, s40, 0xfff24000
    v_and_b32 v47, 0x0fffffff, v42
    buffer_load_dword v30, v47, s[8:11], 0 offen offset:16
    s_mov_b64 exec, s[6:7]
    v_add_u32 v47, 8, v47
    v_lshrrev_b32 v42, 2, v42
    s_mov_b64 exec, -1
    buffer_load_dwordx2 v[28:29], v47, s[8:11], 0 offen
    s_waitcnt vmcnt(8)
    v_and_b32 v46, 0x80000000, v39
    v_lshrrev_b32 v47, 14, v37
    v_bitop3_b32 v47, v47, v5, v46 bitop3:0xea
    ds_read_b64 v[102:103], v47
    v_and_b32 v99, 0x40000000, v39
    v_lshrrev_b32 v47, 14, v36
    v_bitop3_b32 v47, v47, v5, v99 bitop3:0xea
    ds_read_b64 v[100:101], v47
    v_and_b32 v46, 0x20000000, v39
    v_lshrrev_b32 v47, 14, v35
    v_bitop3_b32 v47, v47, v5, v46 bitop3:0xea
    ds_read_b64 v[106:107], v47
    v_and_b32 v99, 0x10000000, v39
    v_lshrrev_b32 v47, 14, v34
    v_bitop3_b32 v47, v47, v5, v99 bitop3:0xea
    ds_read_b64 v[104:105], v47
    s_waitcnt lgkmcnt(4)
    v_cmp_ne_u64 s[50:51], v[72:73], v[68:69]
    v_cmpx_ne_u64 s[54:55], v[74:75], v[70:71]
    s_and_b64 s[82:83], s[54:55], s[80:81]
    s_cbranch_scc1 L2_c59
L2_d59:
    v_mov_b64 v[84:85], v[70:71]
    v_mov_b32 v7, v95
    v_mov_b64 v[86:87], v[74:75]
    s_or_b64 s[80:81], s[80:81], s[54:55]
    s_mov_b64 exec, s[50:51]
    s_and_b64 s[82:83], s[50:51], s[80:81]
    s_cbranch_scc1 L2_c60
L2_d60:
    v_mov_b64 v[84:85], v[68:69]
    v_mov_b32 v7, v94
    v_mov_b64 v[86:87], v[72:73]
    s_mov_b64 exec, -1
    s_or_b64 s[80:81], s[80:81], s[50:51]
    s_and_b64 exec, s[48:49], s[80:81]
    v_mfma_f32_4x4x4_16b_bf16 v[80:83], v[12:13], v[84:85], 0
    v_mov_b32 v93, v7
    s_andn2_b64 s[80:81], s[80:81], s[48:49]
    v_mfma_f32_4x4x4_16b_bf16 v[80:83], v[10:11], v[86:87], v[80:83]
    s_mov_b64 exec, -1
    ds_read_b64 v[70:71], v93 offset:65408
    ds_read_b64 v[68:69], v92 offset:65408
    v_bitop3_b32 v94, v34, v5, v99 bitop3:0xea
    v_bitop3_b32 v95, v35, v5, v46 bitop3:0xea
    v_perm_b32 v15, v35, v38, s45
    v_bitop3_b32 v46, v35, 0.5, -0.5 bitop3:0xa8
    v_perm_b32 v14, v34, v38, s44
    v_bitop3_b32 v47, v34, 0.5, -0.5 bitop3:0xa8
    v_bitop3_b32 v15, v6, v15, v46 bitop3:0xca
    v_bitop3_b32 v14, v6, v14, v47 bitop3:0xca
    s_waitcnt lgkmcnt(1)
    v_mfma_f32_4x4x4_16b_bf16 v[80:83], v[10:11], v[70:71], v[80:83]
    s_waitcnt lgkmcnt(0)
    v_mfma_f32_4x4x4_16b_bf16 v[76:79], v[10:11], v[68:69], v[76:79]
    s_nop 2
    v_cvt_pk_bf16_f32 v80, v80, v81
    v_cvt_pk_bf16_f32 v81, v82, v83
    ds_wrxchg_rtn_b64 v[74:75], v93, v[80:81] offset:65408
    v_cvt_pk_bf16_f32 v76, v76, v77
    v_cvt_pk_bf16_f32 v77, v78, v79
    ds_wrxchg_rtn_b64 v[72:73], v92, v[76:77] offset:65408
    s_barrier
    s_setprio 3
    s_mov_b32 m0, s100
    s_nop 0
    ds_write_addtid_b32 v124 offset:34816
    ds_write_addtid_b32 v125 offset:35072
    ds_write_addtid_b32 v126 offset:35328
    ds_write_addtid_b32 v127 offset:35584
    s_add_u32 s3, s40, 4096
    buffer_load_dwordx4 v[124:127], v3, s[16:19], s3 offen sc1
    ds_write_addtid_b32 v116 offset:32768
    ds_write_addtid_b32 v117 offset:33024
    ds_write_addtid_b32 v118 offset:33280
    ds_write_addtid_b32 v119 offset:33536
    buffer_load_dwordx4 v[116:119], v3, s[16:19], s40 offen offset:2048 sc1
    ds_write_addtid_b32 v120 offset:33792
    ds_write_addtid_b32 v121 offset:34048
    ds_write_addtid_b32 v122 offset:34304
    ds_write_addtid_b32 v123 offset:34560
    buffer_load_dwordx4 v[120:123], v3, s[16:19], s40 offen offset:3072 sc1
    v_mfma_f32_4x4x4_16b_bf16 v[80:83], v[8:9], v[106:107], 0
    v_mfma_f32_4x4x4_16b_bf16 v[76:79], v[8:9], v[104:105], 0
    s_nop 3
    v_pk_mul_f32 v[80:81], v[80:81], v[14:15] op_sel:[0,1] op_sel_hi:[1,1]
    v_pk_mul_f32 v[82:83], v[82:83], v[14:15] op_sel:[0,1] op_sel_hi:[1,1]
    v_pk_mul_f32 v[76:77], v[76:77], v[14:15] op_sel:[0,0] op_sel_hi:[1,0]
    v_pk_mul_f32 v[78:79], v[78:79], v[14:15] op_sel:[0,0] op_sel_hi:[1,0]
    s_cmp_gt_u32 s37, 1024
    s_cbranch_scc1 L2_xs61
    s_cmp_lg_u32 s101, 0
    s_cbranch_scc1 L2_xa61
L2_xb61:
    v_lshlrev_b32 v89, 16, v96
    v_add_u32 v90, 60, v97
    v_bitop3_b32 v90, v89, v45, v90 bitop3:0x6a
    ds_write_b32 v98, v90 offset:12
    v_lshlrev_b32 v89, 20, v96
    v_add_u32 v90, 40, v97
    v_bitop3_b32 v90, v89, v45, v90 bitop3:0x6a
    ds_write_b32 v98, v90 offset:8
    v_lshlrev_b32 v89, 24, v96
    v_add_u32 v90, 20, v97
    v_bitop3_b32 v90, v89, v45, v90 bitop3:0x6a
    ds_write_b32 v98, v90 offset:4
    v_lshlrev_b32 v89, 28, v96
    v_bitop3_b32 v90, v89, v45, v97 bitop3:0x6a
    ds_write_b32 v98, v90 offset:0
    v_mov_b32_dpp v91, v64 quad_perm:[0,0,0,0] row_mask:0xf bank_mask:0xf
    v_and_b32 v89, 3, v91
    v_and_b32 v97, 0xfffc, v91
    v_sub_u16_dpp v88, v64, v91 quad_perm:[2,2,2,2] row_mask:0xf bank_mask:0xf
    v_mad_u32_u24 v97, v97, 5, v4
    v_add_u32 v99, v88, v89
    v_bfm_b32 v96, v88, v89
    v_cmp_lt_u32 s[58:59], 16, v99
    v_lshlrev_b32 v89, v1, v96
    v_and_b32 v89, v45, v89
    v_cmp_ne_u32 vcc, 0, v89
    v_xor_b32 v90, v97, v89
    s_add_u32 s3, s37, s38
    v_mbcnt_lo_u32_b32 v98, vcc_lo, 0
    v_mbcnt_hi_u32_b32 v98, vcc_hi, v98
    s_bcnt1_i32_b64 s41, vcc
    v_lshl_add_u32 v98, v98, 2, s3
    s_lshl2_add_u32 s37, s41, s37
    s_mov_b64 exec, vcc
    ds_write_b32 v98, v90
    s_mov_b64 exec, -1
    s_cmp_lg_u64 s[58:59], 0
    s_cbranch_scc1 L2_xe61
L2_xr61:
    v_add_u32 v98, s37, v0
    v_mov_b32 v90, -1
    ds_write_b32 v98, v90
L2_xw61:
    s_setprio 2
    s_waitcnt lgkmcnt(14)
    v_cmp_ne_u64 s[50:51], v[72:73], v[68:69]
    v_cmpx_ne_u64 s[54:55], v[74:75], v[70:71]
    s_and_b64 s[82:83], s[54:55], s[80:81]
    s_cbranch_scc1 L2_c62
L2_d62:
    v_mov_b64 v[84:85], v[70:71]
    v_mov_b32 v7, v93
    v_mov_b64 v[86:87], v[74:75]
    s_or_b64 s[80:81], s[80:81], s[54:55]
    s_mov_b64 exec, s[50:51]
    s_and_b64 s[82:83], s[50:51], s[80:81]
    s_cbranch_scc1 L2_c63
L2_d63:
    v_mov_b64 v[84:85], v[68:69]
    v_mov_b32 v7, v92
    v_mov_b64 v[86:87], v[72:73]
    s_mov_b64 exec, -1
    s_or_b64 s[80:81], s[80:81], s[50:51]
    ds_read_b64 v[70:71], v95 offset:65408
    ds_read_b64 v[68:69], v94 offset:65408
    v_and_b32 v46, 0x40000000, v39
    v_bitop3_b32 v92, v36, v5, v46 bitop3:0xea
    v_and_b32 v46, 0x80000000, v39
    v_bitop3_b32 v93, v37, v5, v46 bitop3:0xea
    v_perm_b32 v15, v37, v38, s47
    v_bitop3_b32 v46, v37, 0.5, -0.5 bitop3:0xa8
    v_perm_b32 v14, v36, v38, s46
    v_bitop3_b32 v47, v36, 0.5, -0.5 bitop3:0xa8
    v_bitop3_b32 v15, v6, v15, v46 bitop3:0xca
    v_bitop3_b32 v14, v6, v14, v47 bitop3:0xca
    s_setprio 1
    s_waitcnt lgkmcnt(1)
    v_mfma_f32_4x4x4_16b_bf16 v[80:83], v[10:11], v[70:71], v[80:83]
    s_waitcnt lgkmcnt(0)
    v_mfma_f32_4x4x4_16b_bf16 v[76:79], v[10:11], v[68:69], v[76:79]
    s_nop 2
    v_cvt_pk_bf16_f32 v80, v80, v81
    v_cvt_pk_bf16_f32 v81, v82, v83
    ds_wrxchg_rtn_b64 v[74:75], v95, v[80:81] offset:65408
    v_cvt_pk_bf16_f32 v76, v76, v77
    v_cvt_pk_bf16_f32 v77, v78, v79
    ds_wrxchg_rtn_b64 v[72:73], v94, v[76:77] offset:65408
    ds_read_b32 v21, v0 offset:0
    ds_read_b32 v27, v0 offset:256
    ds_read_b32 v31, v44 offset:768
    ds_read_b32 v39, v0 offset:512
    s_sub_u32 s3, s37, 768
    s_cmp_gt_u32 s3, 128
    s_cbranch_scc1 L2_xf61
L2_xg61:
    v_and_b32 v88, 0x0fffffff, v43
    buffer_load_dwordx2 v[34:35], v88, s[8:11], 0 offen
    buffer_load_dwordx3 v[36:38], v88, s[8:11], 0 offen offset:8
    s_setprio 0
    s_waitcnt vmcnt(12)
    s_mov_b32 m0, s38
    s_nop 0
    ds_write_addtid_b32 v108 offset:0
    ds_write_addtid_b32 v109 offset:256
    ds_write_addtid_b32 v110 offset:512
    ds_write_addtid_b32 v111 offset:768
    s_waitcnt vmcnt(9)
    ds_write_addtid_b32 v112 offset:1024
    ds_write_addtid_b32 v113 offset:1280
    ds_write_addtid_b32 v114 offset:1536
    ds_write_addtid_b32 v115 offset:1792
    v_mfma_f32_4x4x4_16b_bf16 v[80:83], v[8:9], v[102:103], 0
    v_mfma_f32_4x4x4_16b_bf16 v[76:79], v[8:9], v[100:101], 0
    v_cmp_lt_u32 s[84:85], v5, v92
    s_nop 2
    v_pk_mul_f32 v[80:81], v[80:81], v[14:15] op_sel:[0,1] op_sel_hi:[1,1]
    v_pk_mul_f32 v[82:83], v[82:83], v[14:15] op_sel:[0,1] op_sel_hi:[1,1]
    v_pk_mul_f32 v[76:77], v[76:77], v[14:15] op_sel:[0,0] op_sel_hi:[1,0]
    v_pk_mul_f32 v[78:79], v[78:79], v[14:15] op_sel:[0,0] op_sel_hi:[1,0]
    s_add_u32 s42, s42, 1
    s_waitcnt lgkmcnt(0)
    s_barrier
    s_bitcmp1_b32 s36, s42
    s_cbranch_scc1 L2_slow
L2_ret3:
    s_setprio 3
    s_bitcmp1_b32 s43, s42
    s_cbranch_scc1 L2_oa64
L2_ob64:
    v_and_b32 v46, 0x20000000, v40
    v_lshrrev_b32 v47, 14, v17
    v_bitop3_b32 v47, v47, v5, v46 bitop3:0xea
    ds_read_b64 v[106:107], v47
    v_and_b32 v99, 0x10000000, v40
    v_lshrrev_b32 v47, 14, v16
    v_bitop3_b32 v47, v47, v5, v99 bitop3:0xea
    ds_read_b64 v[104:105], v47
    v_cmp_ne_u64 s[50:51], v[72:73], v[68:69]
    v_cmpx_ne_u64 s[54:55], v[74:75], v[70:71]
    s_and_b64 s[82:83], s[54:55], s[80:81]
    s_cbranch_scc1 L2_c65
L2_d65:
    v_mov_b64 v[84:85], v[70:71]
    v_mov_b32 v7, v95
    v_mov_b64 v[86:87], v[74:75]
    s_or_b64 s[80:81], s[80:81], s[54:55]
    s_mov_b64 exec, s[50:51]
    s_and_b64 s[82:83], s[50:51], s[80:81]
    s_cbranch_scc1 L2_c66
L2_d66:
    v_mov_b64 v[84:85], v[68:69]
    v_mov_b32 v7, v94
    v_mov_b64 v[86:87], v[72:73]
    s_mov_b64 exec, -1
    s_or_b64 s[80:81], s[80:81], s[50:51]
    s_and_b64 exec, s[84:85], s[80:81]
    v_mfma_f32_4x4x4_16b_bf16 v[76:79], v[12:13], v[84:85], 0
    v_mov_b32 v92, v7
    s_andn2_b64 s[80:81], s[80:81], s[84:85]
    v_mfma_f32_4x4x4_16b_bf16 v[76:79], v[10:11], v[86:87], v[76:79]
    s_mov_b64 exec, -1
    ds_read_b64 v[70:71], v93 offset:65408
    ds_read_b64 v[68:69], v92 offset:65408
    v_bitop3_b32 v94, v16, v5, v99 bitop3:0xea
    v_bitop3_b32 v95, v17, v5, v46 bitop3:0xea
    v_perm_b32 v15, v17, v20, s45
    v_bitop3_b32 v46, v17, 0.5, -0.5 bitop3:0xa8
    v_perm_b32 v14, v16, v20, s44
    v_bitop3_b32 v47, v16, 0.5, -0.5 bitop3:0xa8
    v_bitop3_b32 v15, v6, v15, v46 bitop3:0xca
    v_bitop3_b32 v14, v6, v14, v47 bitop3:0xca
    s_waitcnt lgkmcnt(1)
    v_mfma_f32_4x4x4_16b_bf16 v[80:83], v[10:11], v[70:71], v[80:83]
    s_waitcnt lgkmcnt(0)
    v_mfma_f32_4x4x4_16b_bf16 v[76:79], v[10:11], v[68:69], v[76:79]
    s_nop 2
    v_cvt_pk_bf16_f32 v80, v80, v81
    v_cvt_pk_bf16_f32 v81, v82, v83
    ds_wrxchg_rtn_b64 v[74:75], v93, v[80:81] offset:65408
    v_cvt_pk_bf16_f32 v76, v76, v77
    v_cvt_pk_bf16_f32 v77, v78, v79
    ds_wrxchg_rtn_b64 v[72:73], v92, v[76:77] offset:65408
    v_mfma_f32_4x4x4_16b_bf16 v[80:83], v[8:9], v[106:107], 0
    v_mfma_f32_4x4x4_16b_bf16 v[76:79], v[8:9], v[104:105], 0
    v_cmp_lt_u32 s[84:85], v5, v94
    s_nop 2
    v_pk_mul_f32 v[80:81], v[80:81], v[14:15] op_sel:[0,1] op_sel_hi:[1,1]
    v_pk_mul_f32 v[82:83], v[82:83], v[14:15] op_sel:[0,1] op_sel_hi:[1,1]
    v_pk_mul_f32 v[76:77], v[76:77], v[14:15] op_sel:[0,0] op_sel_hi:[1,0]
    v_pk_mul_f32 v[78:79], v[78:79], v[14:15] op_sel:[0,0] op_sel_hi:[1,0]
    buffer_load_dwordx4 v[108:111], v3, s[16:19], s40 offen offset:0 sc1
    v_and_b32 v46, 0x80000000, v40
    v_lshrrev_b32 v47, 14, v19
    v_bitop3_b32 v47, v47, v5, v46 bitop3:0xea
    ds_read_b64 v[102:103], v47
    v_and_b32 v99, 0x40000000, v40
    v_lshrrev_b32 v47, 14, v18
    v_bitop3_b32 v47, v47, v5, v99 bitop3:0xea
    ds_read_b64 v[100:101], v47
    s_waitcnt lgkmcnt(2)
    v_cmp_ne_u64 s[50:51], v[72:73], v[68:69]
    v_cmpx_ne_u64 s[54:55], v[74:75], v[70:71]
    s_and_b64 s[82:83], s[54:55], s[80:81]
    s_cbranch_scc1 L2_c67
L2_d67:
    v_mov_b64 v[84:85], v[70:71]
    v_mov_b32 v7, v93
    v_mov_b64 v[86:87], v[74:75]
    s_or_b64 s[80:81], s[80:81], s[54:55]
    s_mov_b64 exec, s[50:51]
    s_and_b64 s[82:83], s[50:51], s[80:81]
    s_cbranch_scc1 L2_c68
L2_d68:
    v_mov_b64 v[84:85], v[68:69]
    v_mov_b32 v7, v92
    v_mov_b64 v[86:87], v[72:73]
    s_mov_b64 exec, -1
    s_or_b64 s[80:81], s[80:81], s[50:51]
    s_and_b64 exec, s[84:85], s[80:81]
    v_mfma_f32_4x4x4_16b_bf16 v[76:79], v[12:13], v[84:85], 0
    v_mov_b32 v94, v7
    s_andn2_b64 s[80:81], s[80:81], s[84:85]
    v_mfma_f32_4x4x4_16b_bf16 v[76:79], v[10:11], v[86:87], v[76:79]
    s_mov_b64 exec, -1
    ds_read_b64 v[70:71], v95 offset:65408
    ds_read_b64 v[68:69], v94 offset:65408
    v_bitop3_b32 v92, v18, v5, v99 bitop3:0xea
    v_bitop3_b32 v93, v19, v5, v46 bitop3:0xea
    v_perm_b32 v15, v19, v20, s47
    v_bitop3_b32 v46, v19, 0.5, -0.5 bitop3:0xa8
    v_perm_b32 v14, v18, v20, s46
    v_bitop3_b32 v47, v18, 0.5, -0.5 bitop3:0xa8
    v_bitop3_b32 v15, v6, v15, v46 bitop3:0xca
    v_bitop3_b32 v14, v6, v14, v47 bitop3:0xca
    s_waitcnt lgkmcnt(1)
    v_mfma_f32_4x4x4_16b_bf16 v[80:83], v[10:11], v[70:71], v[80:83]
    s_waitcnt lgkmcnt(0)
    v_mfma_f32_4x4x4_16b_bf16 v[76:79], v[10:11], v[68:69], v[76:79]
    s_nop 2
    v_cvt_pk_bf16_f32 v80, v80, v81
    v_cvt_pk_bf16_f32 v81, v82, v83
    ds_wrxchg_rtn_b64 v[74:75], v95, v[80:81] offset:65408
    v_cvt_pk_bf16_f32 v76, v76, v77
    v_cvt_pk_bf16_f32 v77, v78, v79
    ds_wrxchg_rtn_b64 v[72:73], v94, v[76:77] offset:65408
    v_and_b32 v88, 0x0fffffff, v21
    buffer_load_dwordx2 v[16:17], v88, s[8:11], 0 offen
    buffer_load_dwordx3 v[18:20], v88, s[8:11], 0 offen offset:8
    s_setprio 2
    v_mfma_f32_4x4x4_16b_bf16 v[80:83], v[8:9], v[102:103], 0
    v_mfma_f32_4x4x4_16b_bf16 v[76:79], v[8:9], v[100:101], 0
    v_cmp_lt_u32 s[48:49], v5, v93
    s_nop 2
    v_pk_mul_f32 v[80:81], v[80:81], v[14:15] op_sel:[0,1] op_sel_hi:[1,1]
    v_pk_mul_f32 v[82:83], v[82:83], v[14:15] op_sel:[0,1] op_sel_hi:[1,1]
    v_pk_mul_f32 v[76:77], v[76:77], v[14:15] op_sel:[0,0] op_sel_hi:[1,0]
    v_pk_mul_f32 v[78:79], v[78:79], v[14:15] op_sel:[0,0] op_sel_hi:[1,0]
    s_waitcnt vmcnt(10)
    v_and_b32 v46, 0x20000000, v41
    v_lshrrev_b32 v47, 14, v23
    v_bitop3_b32 v47, v47, v5, v46 bitop3:0xea
    ds_read_b64 v[106:107], v47
    v_and_b32 v99, 0x10000000, v41
    v_lshrrev_b32 v47, 14, v22
    v_bitop3_b32 v47, v47, v5, v99 bitop3:0xea
    ds_read_b64 v[104:105], v47
    s_waitcnt lgkmcnt(2)
    v_cmp_ne_u64 s[50:51], v[72:73], v[68:69]
    v_cmpx_ne_u64 s[54:55], v[74:75], v[70:71]
    s_and_b64 s[82:83], s[54:55], s[80:81]
    s_cbranch_scc1 L2_c69
L2_d69:
    v_mov_b64 v[84:85], v[70:71]
    v_mov_b32 v7, v95
    v_mov_b64 v[86:87], v[74:75]
    s_or_b64 s[80:81], s[80:81], s[54:55]
    s_mov_b64 exec, s[50:51]
    s_and_b64 s[82:83], s[50:51], s[80:81]
    s_cbranch_scc1 L2_c70
L2_d70:
    v_mov_b64 v[84:85], v[68:69]
    v_mov_b32 v7, v94
    v_mov_b64 v[86:87], v[72:73]
    s_mov_b64 exec, -1
    s_or_b64 s[80:81], s[80:81], s[50:51]
    s_and_b64 exec, s[48:49], s[80:81]
    v_mfma_f32_4x4x4_16b_bf16 v[80:83], v[12:13], v[84:85], 0
    v_mov_b32 v93, v7
    s_andn2_b64 s[80:81], s[80:81], s[48:49]
    v_mfma_f32_4x4x4_16b_bf16 v[80:83], v[10:11], v[86:87], v[80:83]
    s_mov_b64 exec, -1
    ds_read_b64 v[70:71], v93 offset:65408
    ds_read_b64 v[68:69], v92 offset:65408
    v_bitop3_b32 v94, v22, v5, v99 bitop3:0xea
    v_bitop3_b32 v95, v23, v5, v46 bitop3:0xea
    v_perm_b32 v15, v23, v26, s45
    v_bitop3_b32 v46, v23, 0.5, -0.5 bitop3:0xa8
    v_perm_b32 v14, v22, v26, s44
    v_bitop3_b32 v47, v22, 0.5, -0.5 bitop3:0xa8
    v_bitop3_b32 v15, v6, v15, v46 bitop3:0xca
    v_bitop3_b32 v14, v6, v14, v47 bitop3:0xca
    s_waitcnt lgkmcnt(1)
    v_mfma_f32_4x4x4_16b_bf16 v[80:83], v[10:11], v[70:71], v[80:83]
    s_waitcnt lgkmcnt(0)
    v_mfma_f32_4x4x4_16b_bf16 v[76:79], v[10:11], v[68:69], v[76:79]
    s_nop 2
    v_cvt_pk_bf16_f32 v80, v80, v81
    v_cvt_pk_bf16_f32 v81, v82, v83
    ds_wrxchg_rtn_b64 v[74:75], v93, v[80:81] offset:65408
    v_cvt_pk_bf16_f32 v76, v76, v77
    v_cvt_pk_bf16_f32 v77, v78, v79
    ds_wrxchg_rtn_b64 v[72:73], v92, v[76:77] offset:65408
    s_setprio 1
    v_mfma_f32_4x4x4_16b_bf16 v[80:83], v[8:9], v[106:107], 0
    v_mfma_f32_4x4x4_16b_bf16 v[76:79], v[8:9], v[104:105], 0
    s_nop 3
    v_pk_mul_f32 v[80:81], v[80:81], v[14:15] op_sel:[0,1] op_sel_hi:[1,1]
    v_pk_mul_f32 v[82:83], v[82:83], v[14:15] op_sel:[0,1] op_sel_hi:[1,1]
    v_pk_mul_f32 v[76:77], v[76:77], v[14:15] op_sel:[0,0] op_sel_hi:[1,0]
    v_pk_mul_f32 v[78:79], v[78:79], v[14:15] op_sel:[0,0] op_sel_hi:[1,0]
    s_bitcmp1_b32 s43, s42
    s_cbranch_scc1 L2_oa71
L2_ob71:
    buffer_load_dwordx4 v[112:115], v3, s[16:19], s40 offen offset:1024 sc1
    v_sub_u16 v88, v58, v50
    v_and_b32 v89, 3, v50
    v_add3_u32 v99, v88, v89, 3
    v_and_b32 v99, -4, v99
    v_max_u32 v99, 4, v99
    v_and_b32 v97, 0xfffc, v50
    v_bfm_b32 v96, v88, v89
    v_add_u32_dpp v91, v99, v99 row_shr:1 row_mask:0xf bank_mask:0xf bound_ctrl:1
    v_mad_u32_u24 v97, v97, 5, v2
    v_cmp_lt_u32 vcc, 16, v99
    v_add_u32_dpp v91, v91, v91 row_shr:2 row_mask:0xf bank_mask:0xf bound_ctrl:1
    v_sub_u32 v98, s38, v99
    v_lshrrev_b64 v[50:51], 16, v[50:51]
    v_add_u32_dpp v91, v91, v91 row_shr:4 row_mask:0xf bank_mask:0xf bound_ctrl:1
    v_lshrrev_b64 v[58:59], 16, v[58:59]
    s_mov_b32 s101, 0
    v_add_u32_dpp v91, v91, v91 row_shr:8 row_mask:0xf bank_mask:0xf bound_ctrl:1
    s_nop 1
    v_add_u32_dpp v91, v91, v91 row_bcast:15 row_mask:0xa bank_mask:0xf
    s_nop 1
    v_add_u32_dpp v91, v91, v91 row_bcast:31 row_mask:0xc bank_mask:0xf
    v_add_u32 v98, v98, v91
    v_readlane_b32 s37, v91, 63
    s_cbranch_vccnz L2_xo72
L2_xp72:
    v_and_b32 v46, 0x80000000, v41
    v_lshrrev_b32 v47, 14, v25
    v_bitop3_b32 v47, v47, v5, v46 bitop3:0xea
    ds_read_b64 v[102:103], v47
    v_and_b32 v99, 0x40000000, v41
    v_lshrrev_b32 v47, 14, v24
    v_bitop3_b32 v47, v47, v5, v99 bitop3:0xea
    ds_read_b64 v[100:101], v47
    s_waitcnt lgkmcnt(2)
    v_cmp_ne_u64 s[50:51], v[72:73], v[68:69]
    v_cmpx_ne_u64 s[54:55], v[74:75], v[70:71]
    s_and_b64 s[82:83], s[54:55], s[80:81]
    s_cbranch_scc1 L2_c73
L2_d73:
    v_mov_b64 v[84:85], v[70:71]
    v_mov_b32 v7, v93
    v_mov_b64 v[86:87], v[74:75]
    s_or_b64 s[80:81], s[80:81], s[54:55]
    s_mov_b64 exec, s[50:51]
    s_and_b64 s[82:83], s[50:51], s[80:81]
    s_cbranch_scc1 L2_c74
L2_d74:
    v_mov_b64 v[84:85], v[68:69]
    v_mov_b32 v7, v92
    v_mov_b64 v[86:87], v[72:73]
    s_mov_b64 exec, -1
    s_or_b64 s[80:81], s[80:81], s[50:51]
    ds_read_b64 v[70:71], v95 offset:65408
    ds_read_b64 v[68:69], v94 offset:65408
    v_bitop3_b32 v92, v24, v5, v99 bitop3:0xea
    v_bitop3_b32 v93, v25, v5, v46 bitop3:0xea
    v_perm_b32 v15, v25, v26, s47
    v_bitop3_b32 v46, v25, 0.5, -0.5 bitop3:0xa8
    v_perm_b32 v14, v24, v26, s46
    v_bitop3_b32 v47, v24, 0.5, -0.5 bitop3:0xa8
    v_bitop3_b32 v15, v6, v15, v46 bitop3:0xca
    v_bitop3_b32 v14, v6, v14, v47 bitop3:0xca
    s_waitcnt lgkmcnt(1)
    v_mfma_f32_4x4x4_16b_bf16 v[80:83], v[10:11], v[70:71], v[80:83]
    s_waitcnt lgkmcnt(0)
    v_mfma_f32_4x4x4_16b_bf16 v[76:79], v[10:11], v[68:69], v[76:79]
    s_nop 2
    v_cvt_pk_bf16_f32 v80, v80, v81
    v_cvt_pk_bf16_f32 v81, v82, v83
    ds_wrxchg_rtn_b64 v[74:75], v95, v[80:81] offset:65408
    v_cvt_pk_bf16_f32 v76, v76, v77
    v_cvt_pk_bf16_f32 v77, v78, v79
    ds_wrxchg_rtn_b64 v[72:73], v94, v[76:77] offset:65408
    v_and_b32 v88, 0x0fffffff, v27
    buffer_load_dwordx2 v[22:23], v88, s[8:11], 0 offen
    buffer_load_dwordx3 v[24:26], v88, s[8:11], 0 offen offset:8
    v_mfma_f32_4x4x4_16b_bf16 v[80:83], v[8:9], v[102:103], 0
    v_mfma_f32_4x4x4_16b_bf16 v[76:79], v[8:9], v[100:101], 0
    v_cmp_lt_u32 s[84:85], v5, v92
    s_nop 2
    v_pk_mul_f32 v[80:81], v[80:81], v[14:15] op_sel:[0,1] op_sel_hi:[1,1]
    v_pk_mul_f32 v[82:83], v[82:83], v[14:15] op_sel:[0,1] op_sel_hi:[1,1]
    v_pk_mul_f32 v[76:77], v[76:77], v[14:15] op_sel:[0,0] op_sel_hi:[1,0]
    v_pk_mul_f32 v[78:79], v[78:79], v[14:15] op_sel:[0,0] op_sel_hi:[1,0]
    s_waitcnt vmcnt(11)
    s_mov_b64 exec, s[6:7]
    v_lshrrev_b32 v30, 16, v30
    s_mov_b64 exec, -1
    v_and_b32 v46, 0x20000000, v42
    v_lshrrev_b32 v47, 14, v29
    v_bitop3_b32 v47, v47, v5, v46 bitop3:0xea
    ds_read_b64 v[106:107], v47
    v_and_b32 v99, 0x10000000, v42
    v_lshrrev_b32 v47, 14, v28
    v_bitop3_b32 v47, v47, v5, v99 bitop3:0xea
    ds_read_b64 v[104:105], v47
    s_waitcnt lgkmcnt(2)
    v_cmp_ne_u64 s[50:51], v[72:73], v[68:69]
    v_cmpx_ne_u64 s[54:55], v[74:75], v[70:71]
    s_and_b64 s[82:83], s[54:55], s[80:81]
    s_cbranch_scc1 L2_c75
L2_d75:
    v_mov_b64 v[84:85], v[70:71]
    v_mov_b32 v7, v95
    v_mov_b64 v[86:87], v[74:75]
    s_or_b64 s[80:81], s[80:81], s[54:55]
    s_mov_b64 exec, s[50:51]
    s_and_b64 s[82:83], s[50:51], s[80:81]
    s_cbranch_scc1 L2_c76
L2_d76:
    v_mov_b64 v[84:85], v[68:69]
    v_mov_b32 v7, v94
    v_mov_b64 v[86:87], v[72:73]
    s_mov_b64 exec, -1
    s_or_b64 s[80:81], s[80:81], s[50:51]
    s_and_b64 exec, s[84:85], s[80:81]
    v_mfma_f32_4x4x4_16b_bf16 v[76:79], v[12:13], v[84:85], 0
    v_mov_b32 v92, v7
    s_andn2_b64 s[80:81], s[80:81], s[84:85]
    v_mfma_f32_4x4x4_16b_bf16 v[76:79], v[10:11], v[86:87], v[76:79]
    s_mov_b64 exec, -1
    ds_read_b64 v[70:71], v93 offset:65408
    ds_read_b64 v[68:69], v92 offset:65408
    v_bitop3_b32 v94, v28, v5, v99 bitop3:0xea
    v_bitop3_b32 v95, v29, v5, v46 bitop3:0xea
    v_perm_b32 v15, v29, v30, s45
    v_bitop3_b32 v46, v29, 0.5, -0.5 bitop3:0xa8
    v_perm_b32 v14, v28, v30, s44
    v_bitop3_b32 v47, v28, 0.5, -0.5 bitop3:0xa8
    v_bitop3_b32 v15, v6, v15, v46 bitop3:0xca
    v_bitop3_b32 v14, v6, v14, v47 bitop3:0xca
    s_waitcnt lgkmcnt(1)
    v_mfma_f32_4x4x4_16b_bf16 v[80:83], v[10:11], v[70:71], v[80:83]
    s_waitcnt lgkmcnt(0)
    v_mfma_f32_4x4x4_16b_bf16 v[76:79], v[10:11], v[68:69], v[76:79]
    s_nop 2
    v_cvt_pk_bf16_f32 v80, v80, v81
    v_cvt_pk_bf16_f32 v81, v82, v83
    ds_wrxchg_rtn_b64 v[74:75], v93, v[80:81] offset:65408
    v_cvt_pk_bf16_f32 v76, v76, v77
    v_cvt_pk_bf16_f32 v77, v78, v79
    ds_wrxchg_rtn_b64 v[72:73], v92, v[76:77] offset:65408
    s_setprio 0
    v_mfma_f32_4x4x4_16b_bf16 v[80:83], v[8:9], v[106:107], 0
    v_mfma_f32_4x4x4_16b_bf16 v[76:79], v[8:9], v[104:105], 0
    v_cmp_lt_u32 s[48:49], v5, v95
    s_nop 2
    v_pk_mul_f32 v[80:81], v[80:81], v[14:15] op_sel:[0,1] op_sel_hi:[1,1]
    v_pk_mul_f32 v[82:83], v[82:83], v[14:15] op_sel:[0,1] op_sel_hi:[1,1]
    v_pk_mul_f32 v[76:77], v[76:77], v[14:15] op_sel:[0,0] op_sel_hi:[1,0]
    v_pk_mul_f32 v[78:79], v[78:79], v[14:15] op_sel:[0,0] op_sel_hi:[1,0]
    s_add_u32 s40, s40, 0x50000
    v_and_b32 v47, 0x0fffffff, v31
    buffer_load_dword v30, v47, s[8:11], 0 offen offset:16
    s_mov_b64 exec, s[6:7]
    v_add_u32 v47, 8, v47
    v_lshrrev_b32 v31, 2, v31
    s_mov_b64 exec, -1
    buffer_load_dwordx2 v[28:29], v47, s[8:11], 0 offen
    s_waitcnt vmcnt(8)
    v_and_b32 v46, 0x80000000, v43
    v_lshrrev_b32 v47, 14, v37
    v_bitop3_b32 v47, v47, v5, v46 bitop3:0xea
    ds_read_b64 v[106:107], v47
    v_and_b32 v99, 0x40000000, v43
    v_lshrrev_b32 v47, 14, v36
    v_bitop3_b32 v47, v47, v5, v99 bitop3:0xea
    ds_read_b64 v[104:105], v47
    v_and_b32 v46, 0x20000000, v43
    v_lshrrev_b32 v47, 14, v35
    v_bitop3_b32 v47, v47, v5, v46 bitop3:0xea
    ds_read_b64 v[102:103], v47
    v_and_b32 v99, 0x10000000, v43
    v_lshrrev_b32 v47, 14, v34
    v_bitop3_b32 v47, v47, v5, v99 bitop3:0xea
    ds_read_b64 v[100:101], v47
    s_waitcnt lgkmcnt(4)
    v_cmp_ne_u64 s[50:51], v[72:73], v[68:69]
    v_cmpx_ne_u64 s[54:55], v[74:75], v[70:71]
    s_and_b64 s[82:83], s[54:55], s[80:81]
    s_cbranch_scc1 L2_c77
L2_d77:
    v_mov_b64 v[84:85], v[70:71]
    v_mov_b32 v7, v93
    v_mov_b64 v[86:87], v[74:75]
    s_or_b64 s[80:81], s[80:81], s[54:55]
    s_mov_b64 exec, s[50:51]
    s_and_b64 s[82:83], s[50:51], s[80:81]
    s_cbranch_scc1 L2_c78
L2_d78:
    v_mov_b64 v[84:85], v[68:69]
    v_mov_b32 v7, v92
    v_mov_b64 v[86:87], v[72:73]
    s_mov_b64 exec, -1
    s_or_b64 s[80:81], s[80:81], s[50:51]
    s_and_b64 exec, s[48:49], s[80:81]
    v_mfma_f32_4x4x4_16b_bf16 v[80:83], v[12:13], v[84:85], 0
    v_mov_b32 v95, v7
    s_andn2_b64 s[80:81], s[80:81], s[48:49]
    v_mfma_f32_4x4x4_16b_bf16 v[80:83], v[10:11], v[86:87], v[80:83]
    s_mov_b64 exec, -1
    ds_read_b64 v[70:71], v95 offset:65408
    ds_read_b64 v[68:69], v94 offset:65408
    v_bitop3_b32 v92, v34, v5, v99 bitop3:0xea
    v_bitop3_b32 v93, v35, v5, v46 bitop3:0xea
    v_perm_b32 v15, v35, v38, s45
    v_bitop3_b32 v46, v35, 0.5, -0.5 bitop3:0xa8
    v_perm_b32 v14, v34, v38, s44
    v_bitop3_b32 v47, v34, 0.5, -0.5 bitop3:0xa8
    v_bitop3_b32 v15, v6, v15, v46 bitop3:0xca
    v_bitop3_b32 v14, v6, v14, v47 bitop3:0xca
    s_waitcnt lgkmcnt(1)
    v_mfma_f32_4x4x4_16b_bf16 v[80:83], v[10:11], v[70:71], v[80:83]
    s_waitcnt lgkmcnt(0)
    v_mfma_f32_4x4x4_16b_bf16 v[76:79], v[10:11], v[68:69], v[76:79]
    s_nop 2
    v_cvt_pk_bf16_f32 v80, v80, v81
    v_cvt_pk_bf16_f32 v81, v82, v83
    ds_wrxchg_rtn_b64 v[74:75], v95, v[80:81] offset:65408
    v_cvt_pk_bf16_f32 v76, v76, v77
    v_cvt_pk_bf16_f32 v77, v78, v79
    ds_wrxchg_rtn_b64 v[72:73], v94, v[76:77] offset:65408
    s_barrier
    s_setprio 3
    s_mov_b32 m0, s100
    s_nop 0
    ds_write_addtid_b32 v124 offset:34816
    ds_write_addtid_b32 v125 offset:35072
    ds_write_addtid_b32 v126 offset:35328
    ds_write_addtid_b32 v127 offset:35584
    s_add_u32 s3, s40, 4096
    buffer_load_dwordx4 v[124:127], v3, s[16:19], s3 offen sc1
    ds_write_addtid_b32 v116 offset:32768
    ds_write_addtid_b32 v117 offset:33024
    ds_write_addtid_b32 v118 offset:33280
    ds_write_addtid_b32 v119 offset:33536
    buffer_load_dwordx4 v[116:119], v3, s[16:19], s40 offen offset:2048 sc1
    ds_write_addtid_b32 v120 offset:33792
    ds_write_addtid_b32 v121 offset:34048
    ds_write_addtid_b32 v122 offset:34304
    ds_write_addtid_b32 v123 offset:34560
    buffer_load_dwordx4 v[120:123], v3, s[16:19], s40 offen offset:3072 sc1
    v_mfma_f32_4x4x4_16b_bf16 v[80:83], v[8:9], v[102:103], 0
    v_mfma_f32_4x4x4_16b_bf16 v[76:79], v[8:9], v[100:101], 0
    s_nop 3
    v_pk_mul_f32 v[80:81], v[80:81], v[14:15] op_sel:[0,1] op_sel_hi:[1,1]
    v_pk_mul_f32 v[82:83], v[82:83], v[14:15] op_sel:[0,1] op_sel_hi:[1,1]
    v_pk_mul_f32 v[76:77], v[76:77], v[14:15] op_sel:[0,0] op_sel_hi:[1,0]
    v_pk_mul_f32 v[78:79], v[78:79], v[14:15] op_sel:[0,0] op_sel_hi:[1,0]
    s_cmp_gt_u32 s37, 1024
    s_cbranch_scc1 L2_xs79
    s_cmp_lg_u32 s101, 0
    s_cbranch_scc1 L2_xa79
L2_xb79:
    v_lshlrev_b32 v89, 16, v96
    v_add_u32 v90, 60, v97
    v_bitop3_b32 v90, v89, v45, v90 bitop3:0x6a
    ds_write_b32 v98, v90 offset:12
    v_lshlrev_b32 v89, 20, v96
    v_add_u32 v90, 40, v97
    v_bitop3_b32 v90, v89, v45, v90 bitop3:0x6a
    ds_write_b32 v98, v90 offset:8
    v_lshlrev_b32 v89, 24, v96
    v_add_u32 v90, 20, v97
    v_bitop3_b32 v90, v89, v45, v90 bitop3:0x6a
    ds_write_b32 v98, v90 offset:4
    v_lshlrev_b32 v89, 28, v96
    v_bitop3_b32 v90, v89, v45, v97 bitop3:0x6a
    ds_write_b32 v98, v90 offset:0
    v_mov_b32_dpp v91, v66 quad_perm:[0,0,0,0] row_mask:0xf bank_mask:0xf
    v_and_b32 v89, 3, v91
    v_and_b32 v97, 0xfffc, v91
    v_sub_u16_dpp v88, v66, v91 quad_perm:[2,2,2,2] row_mask:0xf bank_mask:0xf
    v_mad_u32_u24 v97, v97, 5, v4
    v_add_u32 v99, v88, v89
    v_bfm_b32 v96, v88, v89
    v_cmp_lt_u32 s[58:59], 16, v99
    v_lshlrev_b32 v89, v1, v96
    v_and_b32 v89, v45, v89
    v_cmp_ne_u32 vcc, 0, v89
    v_xor_b32 v90, v97, v89
    s_add_u32 s3, s37, s38
    v_mbcnt_lo_u32_b32 v98, vcc_lo, 0
    v_mbcnt_hi_u32_b32 v98, vcc_hi, v98
    s_bcnt1_i32_b64 s41, vcc
    v_lshl_add_u32 v98, v98, 2, s3
    s_lshl2_add_u32 s37, s41, s37
    s_mov_b64 exec, vcc
    ds_write_b32 v98, v90
    s_mov_b64 exec, -1
    s_cmp_lg_u64 s[58:59], 0
    s_cbranch_scc1 L2_xe79
L2_xr79:
    v_add_u32 v98, s37, v0
    v_mov_b32 v90, -1
    ds_write_b32 v98, v90
L2_xw79:
    s_setprio 2
    s_waitcnt lgkmcnt(14)
    v_cmp_ne_u64 s[50:51], v[72:73], v[68:69]
    v_cmpx_ne_u64 s[54:55], v[74:75], v[70:71]
    s_and_b64 s[82:83], s[54:55], s[80:81]
    s_cbranch_scc1 L2_c80
L2_d80:
    v_mov_b64 v[84:85], v[70:71]
    v_mov_b32 v7, v95
    v_mov_b64 v[86:87], v[74:75]
    s_or_b64 s[80:81], s[80:81], s[54:55]
    s_mov_b64 exec, s[50:51]
    s_and_b64 s[82:83], s[50:51], s[80:81]
    s_cbranch_scc1 L2_c81
L2_d81:
    v_mov_b64 v[84:85], v[68:69]
    v_mov_b32 v7, v94
    v_mov_b64 v[86:87], v[72:73]
    s_mov_b64 exec, -1
    s_or_b64 s[80:81], s[80:81], s[50:51]
    ds_read_b64 v[70:71], v93 offset:65408
    ds_read_b64 v[68:69], v92 offset:65408
    v_and_b32 v46, 0x40000000, v43
    v_bitop3_b32 v94, v36, v5, v46 bitop3:0xea
    v_and_b32 v46, 0x80000000, v43
    v_bitop3_b32 v95, v37, v5, v46 bitop3:0xea
    v_perm_b32 v15, v37, v38, s47
    v_bitop3_b32 v46, v37, 0.5, -0.5 bitop3:0xa8
    v_perm_b32 v14, v36, v38, s46
    v_bitop3_b32 v47, v36, 0.5, -0.5 bitop3:0xa8
    v_bitop3_b32 v15, v6, v15, v46 bitop3:0xca
    v_bitop3_b32 v14, v6, v14, v47 bitop3:0xca
    s_setprio 1
    s_waitcnt lgkmcnt(1)
    v_mfma_f32_4x4x4_16b_bf16 v[80:83], v[10:11], v[70:71], v[80:83]
    s_waitcnt lgkmcnt(0)
    v_mfma_f32_4x4x4_16b_bf16 v[76:79], v[10:11], v[68:69], v[76:79]
    s_nop 2
    v_cvt_pk_bf16_f32 v80, v80, v81
    v_cvt_pk_bf16_f32 v81, v82, v83
    ds_wrxchg_rtn_b64 v[74:75], v93, v[80:81] offset:65408
    v_cvt_pk_bf16_f32 v76, v76, v77
    v_cvt_pk_bf16_f32 v77, v78, v79
    ds_wrxchg_rtn_b64 v[72:73], v92, v[76:77] offset:65408
    ds_read_b32 v40, v0 offset:0
    ds_read_b32 v41, v0 offset:256
    ds_read_b32 v42, v44 offset:768
    ds_read_b32 v43, v0 offset:512
    s_sub_u32 s3, s37, 768
    s_cmp_gt_u32 s3, 128
    s_cbranch_scc1 L2_xf79
L2_xg79:
    v_and_b32 v88, 0x0fffffff, v39
    buffer_load_dwordx2 v[34:35], v88, s[8:11], 0 offen
    buffer_load_dwordx3 v[36:38], v88, s[8:11], 0 offen offset:8
    s_setprio 0
    s_waitcnt vmcnt(12)
    s_mov_b32 m0, s38
    s_nop 0
    ds_write_addtid_b32 v108 offset:0
    ds_write_addtid_b32 v109 offset:256
    ds_write_addtid_b32 v110 offset:512
    ds_write_addtid_b32 v111 offset:768
    s_waitcnt vmcnt(9)
    ds_write_addtid_b32 v112 offset:1024
    ds_write_addtid_b32 v113 offset:1280
    ds_write_addtid_b32 v114 offset:1536
    ds_write_addtid_b32 v115 offset:1792
    v_mfma_f32_4x4x4_16b_bf16 v[80:83], v[8:9], v[106:107], 0
    v_mfma_f32_4x4x4_16b_bf16 v[76:79], v[8:9], v[104:105], 0
    v_cmp_lt_u32 s[84:85], v5, v94
    s_nop 2
    v_pk_mul_f32 v[80:81], v[80:81], v[14:15] op_sel:[0,1] op_sel_hi:[1,1]
    v_pk_mul_f32 v[82:83], v[82:83], v[14:15] op_sel:[0,1] op_sel_hi:[1,1]
    v_pk_mul_f32 v[76:77], v[76:77], v[14:15] op_sel:[0,0] op_sel_hi:[1,0]
    v_pk_mul_f32 v[78:79], v[78:79], v[14:15] op_sel:[0,0] op_sel_hi:[1,0]
    s_add_u32 s42, s42, 1
    s_waitcnt lgkmcnt(0)
    s_barrier
    s_bitcmp1_b32 s36, s42
    s_cbranch_scc1 L2_slow
L2_ret4:
    s_setprio 3
    s_bitcmp1_b32 s43, s42
    s_cbranch_scc1 L2_oa82
L2_ob82:
    v_and_b32 v46, 0x20000000, v21
    v_lshrrev_b32 v47, 14, v17
    v_bitop3_b32 v47, v47, v5, v46 bitop3:0xea
    ds_read_b64 v[102:103], v47
    v_and_b32 v99, 0x10000000, v21
    v_lshrrev_b32 v47, 14, v16
    v_bitop3_b32 v47, v47, v5, v99 bitop3:0xea
    ds_read_b64 v[100:101], v47
    v_cmp_ne_u64 s[50:51], v[72:73], v[68:69]
    v_cmpx_ne_u64 s[54:55], v[74:75], v[70:71]
    s_and_b64 s[82:83], s[54:55], s[80:81]
    s_cbranch_scc1 L2_c83
L2_d83:
    v_mov_b64 v[84:85], v[70:71]
    v_mov_b32 v7, v93
    v_mov_b64 v[86:87], v[74:75]
    s_or_b64 s[80:81], s[80:81], s[54:55]
    s_mov_b64 exec, s[50:51]
    s_and_b64 s[82:83], s[50:51], s[80:81]
    s_cbranch_scc1 L2_c84
L2_d84:
    v_mov_b64 v[84:85], v[68:69]
    v_mov_b32 v7, v92
    v_mov_b64 v[86:87], v[72:73]
    s_mov_b64 exec, -1
    s_or_b64 s[80:81], s[80:81], s[50:51]
    s_and_b64 exec, s[84:85], s[80:81]
    v_mfma_f32_4x4x4_16b_bf16 v[76:79], v[12:13], v[84:85], 0
    v_mov_b32 v94, v7
    s_andn2_b64 s[80:81], s[80:81], s[84:85]
    v_mfma_f32_4x4x4_16b_bf16 v[76:79], v[10:11], v[86:87], v[76:79]
    s_mov_b64 exec, -1
    ds_read_b64 v[70:71], v95 offset:65408
    ds_read_b64 v[68:69], v94 offset:65408
    v_bitop3_b32 v92, v16, v5, v99 bitop3:0xea
    v_bitop3_b32 v93, v17, v5, v46 bitop3:0xea
    v_perm_b32 v15, v17, v20, s45
    v_bitop3_b32 v46, v17, 0.5, -0.5 bitop3:0xa8
    v_perm_b32 v14, v16, v20, s44
    v_bitop3_b32 v47, v16, 0.5, -0.5 bitop3:0xa8
    v_bitop3_b32 v15, v6, v15, v46 bitop3:0xca
    v_bitop3_b32 v14, v6, v14, v47 bitop3:0xca
    s_waitcnt lgkmcnt(1)
    v_mfma_f32_4x4x4_16b_bf16 v[80:83], v[10:11], v[70:71], v[80:83]
    s_waitcnt lgkmcnt(0)
    v_mfma_f32_4x4x4_16b_bf16 v[76:79], v[10:11], v[68:69], v[76:79]
    s_nop 2
    v_cvt_pk_bf16_f32 v80, v80, v81
    v_cvt_pk_bf16_f32 v81, v82, v83
    ds_wrxchg_rtn_b64 v[74:75], v95, v[80:81] offset:65408
    v_cvt_pk_bf16_f32 v76, v76, v77
    v_cvt_pk_bf16_f32 v77, v78, v79
    ds_wrxchg_rtn_b64 v[72:73], v94, v[76:77] offset:65408
    v_mfma_f32_4x4x4_16b_bf16 v[80:83], v[8:9], v[102:103], 0
    v_mfma_f32_4x4x4_16b_bf16 v[76:79], v[8:9], v[100:101], 0
    v_cmp_lt_u32 s[84:85], v5, v92
    s_nop 2
    v_pk_mul_f32 v[80:81], v[80:81], v[14:15] op_sel:[0,1] op_sel_hi:[1,1]
    v_pk_mul_f32 v[82:83], v[82:83], v[14:15] op_sel:[0,1] op_sel_hi:[1,1]
    v_pk_mul_f32 v[76:77], v[76:77], v[14:15] op_sel:[0,0] op_sel_hi:[1,0]
    v_pk_mul_f32 v[78:79], v[78:79], v[14:15] op_sel:[0,0] op_sel_hi:[1,0]
    buffer_load_dwordx4 v[108:111], v3, s[16:19], s40 offen offset:0 sc1
    v_and_b32 v46, 0x80000000, v21
    v_lshrrev_b32 v47, 14, v19
    v_bitop3_b32 v47, v47, v5, v46 bitop3:0xea
    ds_read_b64 v[106:107], v47
    v_and_b32 v99, 0x40000000, v21
    v_lshrrev_b32 v47, 14, v18
    v_bitop3_b32 v47, v47, v5, v99 bitop3:0xea
    ds_read_b64 v[104:105], v47
    s_waitcnt lgkmcnt(2)
    v_cmp_ne_u64 s[50:51], v[72:73], v[68:69]
    v_cmpx_ne_u64 s[54:55], v[74:75], v[70:71]
    s_and_b64 s[82:83], s[54:55], s[80:81]
    s_cbranch_scc1 L2_c85
L2_d85:
    v_mov_b64 v[84:85], v[70:71]
    v_mov_b32 v7, v95
    v_mov_b64 v[86:87], v[74:75]
    s_or_b64 s[80:81], s[80:81], s[54:55]
    s_mov_b64 exec, s[50:51]
    s_and_b64 s[82:83], s[50:51], s[80:81]
    s_cbranch_scc1 L2_c86
L2_d86:
    v_mov_b64 v[84:85], v[68:69]
    v_mov_b32 v7, v94
    v_mov_b64 v[86:87], v[72:73]
    s_mov_b64 exec, -1
    s_or_b64 s[80:81], s[80:81], s[50:51]
    s_and_b64 exec, s[84:85], s[80:81]
    v_mfma_f32_4x4x4_16b_bf16 v[76:79], v[12:13], v[84:85], 0
    v_mov_b32 v92, v7
    s_andn2_b64 s[80:81], s[80:81], s[84:85]
    v_mfma_f32_4x4x4_16b_bf16 v[76:79], v[10:11], v[86:87], v[76:79]
    s_mov_b64 exec, -1
    ds_read_b64 v[70:71], v93 offset:65408
    ds_read_b64 v[68:69], v92 offset:65408
    v_bitop3_b32 v94, v18, v5, v99 bitop3:0xea
    v_bitop3_b32 v95, v19, v5, v46 bitop3:0xea
    v_perm_b32 v15, v19, v20, s47
    v_bitop3_b32 v46, v19, 0.5, -0.5 bitop3:0xa8
    v_perm_b32 v14, v18, v20, s46
    v_bitop3_b32 v47, v18, 0.5, -0.5 bitop3:0xa8
    v_bitop3_b32 v15, v6, v15, v46 bitop3:0xca
    v_bitop3_b32 v14, v6, v14, v47 bitop3:0xca
    s_waitcnt lgkmcnt(1)
    v_mfma_f32_4x4x4_16b_bf16 v[80:83], v[10:11], v[70:71], v[80:83]
    s_waitcnt lgkmcnt(0)
    v_mfma_f32_4x4x4_16b_bf16 v[76:79], v[10:11], v[68:69], v[76:79]
    s_nop 2
    v_cvt_pk_bf16_f32 v80, v80, v81
    v_cvt_pk_bf16_f32 v81, v82, v83
    ds_wrxchg_rtn_b64 v[74:75], v93, v[80:81] offset:65408
    v_cvt_pk_bf16_f32 v76, v76, v77
    v_cvt_pk_bf16_f32 v77, v78, v79
    ds_wrxchg_rtn_b64 v[72:73], v92, v[76:77] offset:65408
    v_and_b32 v88, 0x0fffffff, v40
    buffer_load_dwordx2 v[16:17], v88, s[8:11], 0 offen
    buffer_load_dwordx3 v[18:20], v88, s[8:11], 0 offen offset:8
    s_setprio 2
    v_mfma_f32_4x4x4_16b_bf16 v[80:83], v[8:9], v[106:107], 0
    v_mfma_f32_4x4x4_16b_bf16 v[76:79], v[8:9], v[104:105], 0
    v_cmp_lt_u32 s[48:49], v5, v95
    s_nop 2
    v_pk_mul_f32 v[80:81], v[80:81], v[14:15] op_sel:[0,1] op_sel_hi:[1,1]
    v_pk_mul_f32 v[82:83], v[82:83], v[14:15] op_sel:[0,1] op_sel_hi:[1,1]
    v_pk_mul_f32 v[76:77], v[76:77], v[14:15] op_sel:[0,0] op_sel_hi:[1,0]
    v_pk_mul_f32 v[78:79], v[78:79], v[14:15] op_sel:[0,0] op_sel_hi:[1,0]
    s_waitcnt vmcnt(10)
    v_and_b32 v46, 0x20000000, v27
    v_lshrrev_b32 v47, 14, v23
    v_bitop3_b32 v47, v47, v5, v46 bitop3:0xea
    ds_read_b64 v[102:103], v47
    v_and_b32 v99, 0x10000000, v27
    v_lshrrev_b32 v47, 14, v22
    v_bitop3_b32 v47, v47, v5, v99 bitop3:0xea
    ds_read_b64 v[100:101], v47
    s_waitcnt lgkmcnt(2)
    v_cmp_ne_u64 s[50:51], v[72:73], v[68:69]
    v_cmpx_ne_u64 s[54:55], v[74:75], v[70:71]
    s_and_b64 s[82:83], s[54:55], s[80:81]
    s_cbranch_scc1 L2_c87
L2_d87:
    v_mov_b64 v[84:85], v[70:71]
    v_mov_b32 v7, v93
    v_mov_b64 v[86:87], v[74:75]
    s_or_b64 s[80:81], s[80:81], s[54:55]
    s_mov_b64 exec, s[50:51]
    s_and_b64 s[82:83], s[50:51], s[80:81]
    s_cbranch_scc1 L2_c88
L2_d88:
    v_mov_b64 v[84:85], v[68:69]
    v_mov_b32 v7, v92
    v_mov_b64 v[86:87], v[72:73]
    s_mov_b64 exec, -1
    s_or_b64 s[80:81], s[80:81], s[50:51]
    s_and_b64 exec, s[48:49], s[80:81]
    v_mfma_f32_4x4x4_16b_bf16 v[80:83], v[12:13], v[84:85], 0
    v_mov_b32 v95, v7
    s_andn2_b64 s[80:81], s[80:81], s[48:49]
    v_mfma_f32_4x4x4_16b_bf16 v[80:83], v[10:11], v[86:87], v[80:83]
    s_mov_b64 exec, -1
    ds_read_b64 v[70:71], v95 offset:65408
    ds_read_b64 v[68:69], v94 offset:65408
    v_bitop3_b32 v92, v22, v5, v99 bitop3:0xea
    v_bitop3_b32 v93, v23, v5, v46 bitop3:0xea
    v_perm_b32 v15, v23, v26, s45
    v_bitop3_b32 v46, v23, 0.5, -0.5 bitop3:0xa8
    v_perm_b32 v14, v22, v26, s44
    v_bitop3_b32 v47, v22, 0.5, -0.5 bitop3:0xa8
    v_bitop3_b32 v15, v6, v15, v46 bitop3:0xca
    v_bitop3_b32 v14, v6, v14, v47 bitop3:0xca
    s_waitcnt lgkmcnt(1)
    v_mfma_f32_4x4x4_16b_bf16 v[80:83], v[10:11], v[70:71], v[80:83]
    s_waitcnt lgkmcnt(0)
    v_mfma_f32_4x4x4_16b_bf16 v[76:79], v[10:11], v[68:69], v[76:79]
    s_nop 2
    v_cvt_pk_bf16_f32 v80, v80, v81
    v_cvt_pk_bf16_f32 v81, v82, v83
    ds_wrxchg_rtn_b64 v[74:75], v95, v[80:81] offset:65408
    v_cvt_pk_bf16_f32 v76, v76, v77
    v_cvt_pk_bf16_f32 v77, v78, v79
    ds_wrxchg_rtn_b64 v[72:73], v94, v[76:77] offset:65408
    s_setprio 1
    v_mfma_f32_4x4x4_16b_bf16 v[80:83], v[8:9], v[102:103], 0
    v_mfma_f32_4x4x4_16b_bf16 v[76:79], v[8:9], v[100:101], 0
    s_nop 3
    v_pk_mul_f32 v[80:81], v[80:81], v[14:15] op_sel:[0,1] op_sel_hi:[1,1]
    v_pk_mul_f32 v[82:83], v[82:83], v[14:15] op_sel:[0,1] op_sel_hi:[1,1]
    v_pk_mul_f32 v[76:77], v[76:77], v[14:15] op_sel:[0,0] op_sel_hi:[1,0]
    v_pk_mul_f32 v[78:79], v[78:79], v[14:15] op_sel:[0,0] op_sel_hi:[1,0]
    s_bitcmp1_b32 s43, s42
    s_cbranch_scc1 L2_oa89
L2_ob89:
    buffer_load_dwordx4 v[112:115], v3, s[16:19], s40 offen offset:1024 sc1
    v_sub_u16 v88, v60, v52
    v_and_b32 v89, 3, v52
    v_add3_u32 v99, v88, v89, 3
    v_and_b32 v99, -4, v99
    v_max_u32 v99, 4, v99
    v_and_b32 v97, 0xfffc, v52
    v_bfm_b32 v96, v88, v89
    v_add_u32_dpp v91, v99, v99 row_shr:1 row_mask:0xf bank_mask:0xf bound_ctrl:1
    v_mad_u32_u24 v97, v97, 5, v2
    v_cmp_lt_u32 vcc, 16, v99
    v_add_u32_dpp v91, v91, v91 row_shr:2 row_mask:0xf bank_mask:0xf bound_ctrl:1
    v_sub_u32 v98, s38, v99
    v_lshrrev_b64 v[52:53], 16, v[52:53]
    v_add_u32_dpp v91, v91, v91 row_shr:4 row_mask:0xf bank_mask:0xf bound_ctrl:1
    v_lshrrev_b64 v[60:61], 16, v[60:61]
    s_mov_b32 s101, 0
    v_add_u32_dpp v91, v91, v91 row_shr:8 row_mask:0xf bank_mask:0xf bound_ctrl:1
    s_nop 1
    v_add_u32_dpp v91, v91, v91 row_bcast:15 row_mask:0xa bank_mask:0xf
    s_nop 1
    v_add_u32_dpp v91, v91, v91 row_bcast:31 row_mask:0xc bank_mask:0xf
    v_add_u32 v98, v98, v91
    v_readlane_b32 s37, v91, 63
    s_cbranch_vccnz L2_xo90
L2_xp90:
    v_and_b32 v46, 0x80000000, v27
    v_lshrrev_b32 v47, 14, v25
    v_bitop3_b32 v47, v47, v5, v46 bitop3:0xea
    ds_read_b64 v[106:107], v47
    v_and_b32 v99, 0x40000000, v27
    v_lshrrev_b32 v47, 14, v24
    v_bitop3_b32 v47, v47, v5, v99 bitop3:0xea
    ds_read_b64 v[104:105], v47
    s_waitcnt lgkmcnt(2)
    v_cmp_ne_u64 s[50:51], v[72:73], v[68:69]
    v_cmpx_ne_u64 s[54:55], v[74:75], v[70:71]
    s_and_b64 s[82:83], s[54:55], s[80:81]
    s_cbranch_scc1 L2_c91
L2_d91:
    v_mov_b64 v[84:85], v[70:71]
    v_mov_b32 v7, v95
    v_mov_b64 v[86:87], v[74:75]
    s_or_b64 s[80:81], s[80:81], s[54:55]
    s_mov_b64 exec, s[50:51]
    s_and_b64 s[82:83], s[50:51], s[80:81]
    s_cbranch_scc1 L2_c92
L2_d92:
    v_mov_b64 v[84:85], v[68:69]
    v_mov_b32 v7, v94
    v_mov_b64 v[86:87], v[72:73]
    s_mov_b64 exec, -1
    s_or_b64 s[80:81], s[80:81], s[50:51]
    ds_read_b64 v[70:71], v93 offset:65408
    ds_read_b64 v[68:69], v92 offset:65408
    v_bitop3_b32 v94, v24, v5, v99 bitop3:0xea
    v_bitop3_b32 v95, v25, v5, v46 bitop3:0xea
    v_perm_b32 v15, v25, v26, s47
    v_bitop3_b32 v46, v25, 0.5, -0.5 bitop3:0xa8
    v_perm_b32 v14, v24, v26, s46
    v_bitop3_b32 v47, v24, 0.5, -0.5 bitop3:0xa8
    v_bitop3_b32 v15, v6, v15, v46 bitop3:0xca
    v_bitop3_b32 v14, v6, v14, v47 bitop3:0xca
    s_waitcnt lgkmcnt(1)
    v_mfma_f32_4x4x4_16b_bf16 v[80:83], v[10:11], v[70:71], v[80:83]
    s_waitcnt lgkmcnt(0)
    v_mfma_f32_4x4x4_16b_bf16 v[76:79], v[10:11], v[68:69], v[76:79]
    s_nop 2
    v_cvt_pk_bf16_f32 v80, v80, v81
    v_cvt_pk_bf16_f32 v81, v82, v83
    ds_wrxchg_rtn_b64 v[74:75], v93, v[80:81] offset:65408
    v_cvt_pk_bf16_f32 v76, v76, v77
    v_cvt_pk_bf16_f32 v77, v78, v79
    ds_wrxchg_rtn_b64 v[72:73], v92, v[76:77] offset:65408
    v_and_b32 v88, 0x0fffffff, v41
    buffer_load_dwordx2 v[22:23], v88, s[8:11], 0 offen
    buffer_load_dwordx3 v[24:26], v88, s[8:11], 0 offen offset:8
    v_mfma_f32_4x4x4_16b_bf16 v[80:83], v[8:9], v[106:107], 0
    v_mfma_f32_4x4x4_16b_bf16 v[76:79], v[8:9], v[104:105], 0
    v_cmp_lt_u32 s[84:85], v5, v94
    s_nop 2
    v_pk_mul_f32 v[80:81], v[80:81], v[14:15] op_sel:[0,1] op_sel_hi:[1,1]
    v_pk_mul_f32 v[82:83], v[82:83], v[14:15] op_sel:[0,1] op_sel_hi:[1,1]
    v_pk_mul_f32 v[76:77], v[76:77], v[14:15] op_sel:[0,0] op_sel_hi:[1,0]
    v_pk_mul_f32 v[78:79], v[78:79], v[14:15] op_sel:[0,0] op_sel_hi:[1,0]
    s_waitcnt vmcnt(11)
    s_mov_b64 exec, s[6:7]
    v_lshrrev_b32 v30, 16, v30
    s_mov_b64 exec, -1
    v_and_b32 v46, 0x20000000, v31
    v_lshrrev_b32 v47, 14, v29
    v_bitop3_b32 v47, v47, v5, v46 bitop3:0xea
    ds_read_b64 v[102:103], v47
    v_and_b32 v99, 0x10000000, v31
    v_lshrrev_b32 v47, 14, v28
    v_bitop3_b32 v47, v47, v5, v99 bitop3:0xea
    ds_read_b64 v[100:101], v47
    s_waitcnt lgkmcnt(2)
    v_cmp_ne_u64 s[50:51], v[72:73], v[68:69]
    v_cmpx_ne_u64 s[54:55], v[74:75], v[70:71]
    s_and_b64 s[82:83], s[54:55], s[80:81]
    s_cbranch_scc1 L2_c93
L2_d93:
    v_mov_b64 v[84:85], v[70:71]
    v_mov_b32 v7, v93
    v_mov_b64 v[86:87], v[74:75]
    s_or_b64 s[80:81], s[80:81], s[54:55]
    s_mov_b64 exec, s[50:51]
    s_and_b64 s[82:83], s[50:51], s[80:81]
    s_cbranch_scc1 L2_c94
L2_d94:
    v_mov_b64 v[84:85], v[68:69]
    v_mov_b32 v7, v92
    v_mov_b64 v[86:87], v[72:73]
    s_mov_b64 exec, -1
    s_or_b64 s[80:81], s[80:81], s[50:51]
    s_and_b64 exec, s[84:85], s[80:81]
    v_mfma_f32_4x4x4_16b_bf16 v[76:79], v[12:13], v[84:85], 0
    v_mov_b32 v94, v7
    s_andn2_b64 s[80:81], s[80:81], s[84:85]
    v_mfma_f32_4x4x4_16b_bf16 v[76:79], v[10:11], v[86:87], v[76:79]
    s_mov_b64 exec, -1
    ds_read_b64 v[70:71], v95 offset:65408
    ds_read_b64 v[68:69], v94 offset:65408
    v_bitop3_b32 v92, v28, v5, v99 bitop3:0xea
    v_bitop3_b32 v93, v29, v5, v46 bitop3:0xea
    v_perm_b32 v15, v29, v30, s45
    v_bitop3_b32 v46, v29, 0.5, -0.5 bitop3:0xa8
    v_perm_b32 v14, v28, v30, s44
    v_bitop3_b32 v47, v28, 0.5, -0.5 bitop3:0xa8
    v_bitop3_b32 v15, v6, v15, v46 bitop3:0xca
    v_bitop3_b32 v14, v6, v14, v47 bitop3:0xca
    s_waitcnt lgkmcnt(1)
    v_mfma_f32_4x4x4_16b_bf16 v[80:83], v[10:11], v[70:71], v[80:83]
    s_waitcnt lgkmcnt(0)
    v_mfma_f32_4x4x4_16b_bf16 v[76:79], v[10:11], v[68:69], v[76:79]
    s_nop 2
    v_cvt_pk_bf16_f32 v80, v80, v81
    v_cvt_pk_bf16_f32 v81, v82, v83
    ds_wrxchg_rtn_b64 v[74:75], v95, v[80:81] offset:65408
    v_cvt_pk_bf16_f32 v76, v76, v77
    v_cvt_pk_bf16_f32 v77, v78, v79
    ds_wrxchg_rtn_b64 v[72:73], v94, v[76:77] offset:65408
    s_setprio 0
    v_mfma_f32_4x4x4_16b_bf16 v[80:83], v[8:9], v[102:103], 0
    v_mfma_f32_4x4x4_16b_bf16 v[76:79], v[8:9], v[100:101], 0
    v_cmp_lt_u32 s[48:49], v5, v93
    s_nop 2
    v_pk_mul_f32 v[80:81], v[80:81], v[14:15] op_sel:[0,1] op_sel_hi:[1,1]
    v_pk_mul_f32 v[82:83], v[82:83], v[14:15] op_sel:[0,1] op_sel_hi:[1,1]
    v_pk_mul_f32 v[76:77], v[76:77], v[14:15] op_sel:[0,0] op_sel_hi:[1,0]
    v_pk_mul_f32 v[78:79], v[78:79], v[14:15] op_sel:[0,0] op_sel_hi:[1,0]
    s_add_u32 s40, s40, 0x50000
    v_and_b32 v47, 0x0fffffff, v42
    buffer_load_dword v30, v47, s[8:11], 0 offen offset:16
    s_mov_b64 exec, s[6:7]
    v_add_u32 v47, 8, v47
    v_lshrrev_b32 v42, 2, v42
    s_mov_b64 exec, -1
    buffer_load_dwordx2 v[28:29], v47, s[8:11], 0 offen
    s_waitcnt vmcnt(8)
    v_and_b32 v46, 0x80000000, v39
    v_lshrrev_b32 v47, 14, v37
    v_bitop3_b32 v47, v47, v5, v46 bitop3:0xea
    ds_read_b64 v[102:103], v47
    v_and_b32 v99, 0x40000000, v39
    v_lshrrev_b32 v47, 14, v36
    v_bitop3_b32 v47, v47, v5, v99 bitop3:0xea
    ds_read_b64 v[100:101], v47
    v_and_b32 v46, 0x20000000, v39
    v_lshrrev_b32 v47, 14, v35
    v_bitop3_b32 v47, v47, v5, v46 bitop3:0xea
    ds_read_b64 v[106:107], v47
    v_and_b32 v99, 0x10000000, v39
    v_lshrrev_b32 v47, 14, v34
    v_bitop3_b32 v47, v47, v5, v99 bitop3:0xea
    ds_read_b64 v[104:105], v47
    s_waitcnt lgkmcnt(4)
    v_cmp_ne_u64 s[50:51], v[72:73], v[68:69]
    v_cmpx_ne_u64 s[54:55], v[74:75], v[70:71]
    s_and_b64 s[82:83], s[54:55], s[80:81]
    s_cbranch_scc1 L2_c95
L2_d95:
    v_mov_b64 v[84:85], v[70:71]
    v_mov_b32 v7, v95
    v_mov_b64 v[86:87], v[74:75]
    s_or_b64 s[80:81], s[80:81], s[54:55]
    s_mov_b64 exec, s[50:51]
    s_and_b64 s[82:83], s[50:51], s[80:81]
    s_cbranch_scc1 L2_c96
L2_d96:
    v_mov_b64 v[84:85], v[68:69]
    v_mov_b32 v7, v94
    v_mov_b64 v[86:87], v[72:73]
    s_mov_b64 exec, -1
    s_or_b64 s[80:81], s[80:81], s[50:51]
    s_and_b64 exec, s[48:49], s[80:81]
    v_mfma_f32_4x4x4_16b_bf16 v[80:83], v[12:13], v[84:85], 0
    v_mov_b32 v93, v7
    s_andn2_b64 s[80:81], s[80:81], s[48:49]
    v_mfma_f32_4x4x4_16b_bf16 v[80:83], v[10:11], v[86:87], v[80:83]
    s_mov_b64 exec, -1
    ds_read_b64 v[70:71], v93 offset:65408
    ds_read_b64 v[68:69], v92 offset:65408
    v_bitop3_b32 v94, v34, v5, v99 bitop3:0xea
    v_bitop3_b32 v95, v35, v5, v46 bitop3:0xea
    v_perm_b32 v15, v35, v38, s45
    v_bitop3_b32 v46, v35, 0.5, -0.5 bitop3:0xa8
    v_perm_b32 v14, v34, v38, s44
    v_bitop3_b32 v47, v34, 0.5, -0.5 bitop3:0xa8
    v_bitop3_b32 v15, v6, v15, v46 bitop3:0xca
    v_bitop3_b32 v14, v6, v14, v47 bitop3:0xca
    s_waitcnt lgkmcnt(1)
    v_mfma_f32_4x4x4_16b_bf16 v[80:83], v[10:11], v[70:71], v[80:83]
    s_waitcnt lgkmcnt(0)
    v_mfma_f32_4x4x4_16b_bf16 v[76:79], v[10:11], v[68:69], v[76:79]
    s_nop 2
    v_cvt_pk_bf16_f32 v80, v80, v81
    v_cvt_pk_bf16_f32 v81, v82, v83
    ds_wrxchg_rtn_b64 v[74:75], v93, v[80:81] offset:65408
    v_cvt_pk_bf16_f32 v76, v76, v77
    v_cvt_pk_bf16_f32 v77, v78, v79
    ds_wrxchg_rtn_b64 v[72:73], v92, v[76:77] offset:65408
    s_barrier
    s_setprio 3
    s_mov_b32 m0, s100
    s_nop 0
    ds_write_addtid_b32 v124 offset:34816
    ds_write_addtid_b32 v125 offset:35072
    ds_write_addtid_b32 v126 offset:35328
    ds_write_addtid_b32 v127 offset:35584
    s_add_u32 s3, s40, 4096
    buffer_load_dwordx4 v[124:127], v3, s[16:19], s3 offen sc1
    ds_write_addtid_b32 v116 offset:32768
    ds_write_addtid_b32 v117 offset:33024
    ds_write_addtid_b32 v118 offset:33280
    ds_write_addtid_b32 v119 offset:33536
    buffer_load_dwordx4 v[116:119], v3, s[16:19], s40 offen offset:2048 sc1
    ds_write_addtid_b32 v120 offset:33792
    ds_write_addtid_b32 v121 offset:34048
    ds_write_addtid_b32 v122 offset:34304
    ds_write_addtid_b32 v123 offset:34560
    buffer_load_dwordx4 v[120:123], v3, s[16:19], s40 offen offset:3072 sc1
    v_mfma_f32_4x4x4_16b_bf16 v[80:83], v[8:9], v[106:107], 0
    v_mfma_f32_4x4x4_16b_bf16 v[76:79], v[8:9], v[104:105], 0
    s_nop 3
    v_pk_mul_f32 v[80:81], v[80:81], v[14:15] op_sel:[0,1] op_sel_hi:[1,1]
    v_pk_mul_f32 v[82:83], v[82:83], v[14:15] op_sel:[0,1] op_sel_hi:[1,1]
    v_pk_mul_f32 v[76:77], v[76:77], v[14:15] op_sel:[0,0] op_sel_hi:[1,0]
    v_pk_mul_f32 v[78:79], v[78:79], v[14:15] op_sel:[0,0] op_sel_hi:[1,0]
    s_cmp_gt_u32 s37, 1024
    s_cbranch_scc1 L2_xs97
    s_cmp_lg_u32 s101, 0
    s_cbranch_scc1 L2_xa97
L2_xb97:
    v_lshlrev_b32 v89, 16, v96
    v_add_u32 v90, 60, v97
    v_bitop3_b32 v90, v89, v45, v90 bitop3:0x6a
    ds_write_b32 v98, v90 offset:12
    v_lshlrev_b32 v89, 20, v96
    v_add_u32 v90, 40, v97
    v_bitop3_b32 v90, v89, v45, v90 bitop3:0x6a
    ds_write_b32 v98, v90 offset:8
    v_lshlrev_b32 v89, 24, v96
    v_add_u32 v90, 20, v97
    v_bitop3_b32 v90, v89, v45, v90 bitop3:0x6a
    ds_write_b32 v98, v90 offset:4
    v_lshlrev_b32 v89, 28, v96
    v_bitop3_b32 v90, v89, v45, v97 bitop3:0x6a
    ds_write_b32 v98, v90 offset:0
    v_mov_b32_dpp v91, v64 quad_perm:[1,1,1,1] row_mask:0xf bank_mask:0xf
    v_and_b32 v89, 3, v91
    v_and_b32 v97, 0xfffc, v91
    v_sub_u16_dpp v88, v64, v91 quad_perm:[3,3,3,3] row_mask:0xf bank_mask:0xf
    v_mad_u32_u24 v97, v97, 5, v4
    v_add_u32 v99, v88, v89
    v_bfm_b32 v96, v88, v89
    v_cmp_lt_u32 s[58:59], 16, v99
    v_lshlrev_b32 v89, v1, v96
    v_and_b32 v89, v45, v89
    v_cmp_ne_u32 vcc, 0, v89
    v_xor_b32 v90, v97, v89
    s_add_u32 s3, s37, s38
    v_mbcnt_lo_u32_b32 v98, vcc_lo, 0
    v_mbcnt_hi_u32_b32 v98, vcc_hi, v98
    s_bcnt1_i32_b64 s41, vcc
    v_lshl_add_u32 v98, v98, 2, s3
    s_lshl2_add_u32 s37, s41, s37
    s_mov_b64 exec, vcc
    ds_write_b32 v98, v90
    s_mov_b64 exec, -1
    s_cmp_lg_u64 s[58:59], 0
    s_cbranch_scc1 L2_xe97
L2_xr97:
    v_add_u32 v98, s37, v0
    v_mov_b32 v90, -1
    ds_write_b32 v98, v90
L2_xw97:
    s_setprio 2
    s_waitcnt lgkmcnt(14)
    v_cmp_ne_u64 s[50:51], v[72:73], v[68:69]
    v_cmpx_ne_u64 s[54:55], v[74:75], v[70:71]
    s_and_b64 s[82:83], s[54:55], s[80:81]
    s_cbranch_scc1 L2_c98
L2_d98:
    v_mov_b64 v[84:85], v[70:71]
    v_mov_b32 v7, v93
    v_mov_b64 v[86:87], v[74:75]
    s_or_b64 s[80:81], s[80:81], s[54:55]
    s_mov_b64 exec, s[50:51]
    s_and_b64 s[82:83], s[50:51], s[80:81]
    s_cbranch_scc1 L2_c99
L2_d99:
    v_mov_b64 v[84:85], v[68:69]
    v_mov_b32 v7, v92
    v_mov_b64 v[86:87], v[72:73]
    s_mov_b64 exec, -1
    s_or_b64 s[80:81], s[80:81], s[50:51]
    ds_read_b64 v[70:71], v95 offset:65408
    ds_read_b64 v[68:69], v94 offset:65408
    v_and_b32 v46, 0x40000000, v39
    v_bitop3_b32 v92, v36, v5, v46 bitop3:0xea
    v_and_b32 v46, 0x80000000, v39
    v_bitop3_b32 v93, v37, v5, v46 bitop3:0xea
    v_perm_b32 v15, v37, v38, s47
    v_bitop3_b32 v46, v37, 0.5, -0.5 bitop3:0xa8
    v_perm_b32 v14, v36, v38, s46
    v_bitop3_b32 v47, v36, 0.5, -0.5 bitop3:0xa8
    v_bitop3_b32 v15, v6, v15, v46 bitop3:0xca
    v_bitop3_b32 v14, v6, v14, v47 bitop3:0xca
    s_setprio 1
    s_waitcnt lgkmcnt(1)
    v_mfma_f32_4x4x4_16b_bf16 v[80:83], v[10:11], v[70:71], v[80:83]
    s_waitcnt lgkmcnt(0)
    v_mfma_f32_4x4x4_16b_bf16 v[76:79], v[10:11], v[68:69], v[76:79]
    s_nop 2
    v_cvt_pk_bf16_f32 v80, v80, v81
    v_cvt_pk_bf16_f32 v81, v82, v83
    ds_wrxchg_rtn_b64 v[74:75], v95, v[80:81] offset:65408
    v_cvt_pk_bf16_f32 v76, v76, v77
    v_cvt_pk_bf16_f32 v77, v78, v79
    ds_wrxchg_rtn_b64 v[72:73], v94, v[76:77] offset:65408
    ds_read_b32 v21, v0 offset:0
    ds_read_b32 v27, v0 offset:256
    ds_read_b32 v31, v44 offset:768
    ds_read_b32 v39, v0 offset:512
    s_sub_u32 s3, s37, 768
    s_cmp_gt_u32 s3, 128
    s_cbranch_scc1 L2_xf97
L2_xg97:
    v_and_b32 v88, 0x0fffffff, v43
    buffer_load_dwordx2 v[34:35], v88, s[8:11], 0 offen
    buffer_load_dwordx3 v[36:38], v88, s[8:11], 0 offen offset:8
    s_setprio 0
    s_waitcnt vmcnt(12)
    s_mov_b32 m0, s38
    s_nop 0
    ds_write_addtid_b32 v108 offset:0
    ds_write_addtid_b32 v109 offset:256
    ds_write_addtid_b32 v110 offset:512
    ds_write_addtid_b32 v111 offset:768
    s_waitcnt vmcnt(9)
    ds_write_addtid_b32 v112 offset:1024
    ds_write_addtid_b32 v113 offset:1280
    ds_write_addtid_b32 v114 offset:1536
    ds_write_addtid_b32 v115 offset:1792
    v_mfma_f32_4x4x4_16b_bf16 v[80:83], v[8:9], v[102:103], 0
    v_mfma_f32_4x4x4_16b_bf16 v[76:79], v[8:9], v[100:101], 0
    v_cmp_lt_u32 s[84:85], v5, v92
    s_nop 2
    v_pk_mul_f32 v[80:81], v[80:81], v[14:15] op_sel:[0,1] op_sel_hi:[1,1]
    v_pk_mul_f32 v[82:83], v[82:83], v[14:15] op_sel:[0,1] op_sel_hi:[1,1]
    v_pk_mul_f32 v[76:77], v[76:77], v[14:15] op_sel:[0,0] op_sel_hi:[1,0]
    v_pk_mul_f32 v[78:79], v[78:79], v[14:15] op_sel:[0,0] op_sel_hi:[1,0]
    s_add_u32 s42, s42, 1
    s_waitcnt lgkmcnt(0)
    s_barrier
    s_bitcmp1_b32 s36, s42
    s_cbranch_scc1 L2_slow
L2_ret5:
    s_setprio 3
    s_bitcmp1_b32 s43, s42
    s_cbranch_scc1 L2_oa100
L2_ob100:
    v_and_b32 v46, 0x20000000, v40
    v_lshrrev_b32 v47, 14, v17
    v_bitop3_b32 v47, v47, v5, v46 bitop3:0xea
    ds_read_b64 v[106:107], v47
    v_and_b32 v99, 0x10000000, v40
    v_lshrrev_b32 v47, 14, v16
    v_bitop3_b32 v47, v47, v5, v99 bitop3:0xea
    ds_read_b64 v[104:105], v47
    v_cmp_ne_u64 s[50:51], v[72:73], v[68:69]
    v_cmpx_ne_u64 s[54:55], v[74:75], v[70:71]
    s_and_b64 s[82:83], s[54:55], s[80:81]
    s_cbranch_scc1 L2_c101
L2_d101:
    v_mov_b64 v[84:85], v[70:71]
    v_mov_b32 v7, v95
    v_mov_b64 v[86:87], v[74:75]
    s_or_b64 s[80:81], s[80:81], s[54:55]
    s_mov_b64 exec, s[50:51]
    s_and_b64 s[82:83], s[50:51], s[80:81]
    s_cbranch_scc1 L2_c102
L2_d102:
    v_mov_b64 v[84:85], v[68:69]
    v_mov_b32 v7, v94
    v_mov_b64 v[86:87], v[72:73]
    s_mov_b64 exec, -1
    s_or_b64 s[80:81], s[80:81], s[50:51]
    s_and_b64 exec, s[84:85], s[80:81]
    v_mfma_f32_4x4x4_16b_bf16 v[76:79], v[12:13], v[84:85], 0
    v_mov_b32 v92, v7
    s_andn2_b64 s[80:81], s[80:81], s[84:85]
    v_mfma_f32_4x4x4_16b_bf16 v[76:79], v[10:11], v[86:87], v[76:79]
    s_mov_b64 exec, -1
    ds_read_b64 v[70:71], v93 offset:65408
    ds_read_b64 v[68:69], v92 offset:65408
    v_bitop3_b32 v94, v16, v5, v99 bitop3:0xea
    v_bitop3_b32 v95, v17, v5, v46 bitop3:0xea
    v_perm_b32 v15, v17, v20, s45
    v_bitop3_b32 v46, v17, 0.5, -0.5 bitop3:0xa8
    v_perm_b32 v14, v16, v20, s44
    v_bitop3_b32 v47, v16, 0.5, -0.5 bitop3:0xa8
    v_bitop3_b32 v15, v6, v15, v46 bitop3:0xca
    v_bitop3_b32 v14, v6, v14, v47 bitop3:0xca
    s_waitcnt lgkmcnt(1)
    v_mfma_f32_4x4x4_16b_bf16 v[80:83], v[10:11], v[70:71], v[80:83]
    s_waitcnt lgkmcnt(0)
    v_mfma_f32_4x4x4_16b_bf16 v[76:79], v[10:11], v[68:69], v[76:79]
    s_nop 2
    v_cvt_pk_bf16_f32 v80, v80, v81
    v_cvt_pk_bf16_f32 v81, v82, v83
    ds_wrxchg_rtn_b64 v[74:75], v93, v[80:81] offset:65408
    v_cvt_pk_bf16_f32 v76, v76, v77
    v_cvt_pk_bf16_f32 v77, v78, v79
    ds_wrxchg_rtn_b64 v[72:73], v92, v[76:77] offset:65408
    v_mfma_f32_4x4x4_16b_bf16 v[80:83], v[8:9], v[106:107], 0
    v_mfma_f32_4x4x4_16b_bf16 v[76:79], v[8:9], v[104:105], 0
    v_cmp_lt_u32 s[84:85], v5, v94
    s_nop 2
    v_pk_mul_f32 v[80:81], v[80:81], v[14:15] op_sel:[0,1] op_sel_hi:[1,1]
    v_pk_mul_f32 v[82:83], v[82:83], v[14:15] op_sel:[0,1] op_sel_hi:[1,1]
    v_pk_mul_f32 v[76:77], v[76:77], v[14:15] op_sel:[0,0] op_sel_hi:[1,0]
    v_pk_mul_f32 v[78:79], v[78:79], v[14:15] op_sel:[0,0] op_sel_hi:[1,0]
    buffer_load_dwordx4 v[108:111], v3, s[16:19], s40 offen offset:0 sc1
    v_and_b32 v46, 0x80000000, v40
    v_lshrrev_b32 v47, 14, v19
    v_bitop3_b32 v47, v47, v5, v46 bitop3:0xea
    ds_read_b64 v[102:103], v47
    v_and_b32 v99, 0x40000000, v40
    v_lshrrev_b32 v47, 14, v18
    v_bitop3_b32 v47, v47, v5, v99 bitop3:0xea
    ds_read_b64 v[100:101], v47
    s_waitcnt lgkmcnt(2)
    v_cmp_ne_u64 s[50:51], v[72:73], v[68:69]
    v_cmpx_ne_u64 s[54:55], v[74:75], v[70:71]
    s_and_b64 s[82:83], s[54:55], s[80:81]
    s_cbranch_scc1 L2_c103
L2_d103:
    v_mov_b64 v[84:85], v[70:71]
    v_mov_b32 v7, v93
    v_mov_b64 v[86:87], v[74:75]
    s_or_b64 s[80:81], s[80:81], s[54:55]
    s_mov_b64 exec, s[50:51]
    s_and_b64 s[82:83], s[50:51], s[80:81]
    s_cbranch_scc1 L2_c104
L2_d104:
    v_mov_b64 v[84:85], v[68:69]
    v_mov_b32 v7, v92
    v_mov_b64 v[86:87], v[72:73]
    s_mov_b64 exec, -1
    s_or_b64 s[80:81], s[80:81], s[50:51]
    s_and_b64 exec, s[84:85], s[80:81]
    v_mfma_f32_4x4x4_16b_bf16 v[76:79], v[12:13], v[84:85], 0
    v_mov_b32 v94, v7
    s_andn2_b64 s[80:81], s[80:81], s[84:85]
    v_mfma_f32_4x4x4_16b_bf16 v[76:79], v[10:11], v[86:87], v[76:79]
    s_mov_b64 exec, -1
    ds_read_b64 v[70:71], v95 offset:65408
    ds_read_b64 v[68:69], v94 offset:65408
    v_bitop3_b32 v92, v18, v5, v99 bitop3:0xea
    v_bitop3_b32 v93, v19, v5, v46 bitop3:0xea
    v_perm_b32 v15, v19, v20, s47
    v_bitop3_b32 v46, v19, 0.5, -0.5 bitop3:0xa8
    v_perm_b32 v14, v18, v20, s46
    v_bitop3_b32 v47, v18, 0.5, -0.5 bitop3:0xa8
    v_bitop3_b32 v15, v6, v15, v46 bitop3:0xca
    v_bitop3_b32 v14, v6, v14, v47 bitop3:0xca
    s_waitcnt lgkmcnt(1)
    v_mfma_f32_4x4x4_16b_bf16 v[80:83], v[10:11], v[70:71], v[80:83]
    s_waitcnt lgkmcnt(0)
    v_mfma_f32_4x4x4_16b_bf16 v[76:79], v[10:11], v[68:69], v[76:79]
    s_nop 2
    v_cvt_pk_bf16_f32 v80, v80, v81
    v_cvt_pk_bf16_f32 v81, v82, v83
    ds_wrxchg_rtn_b64 v[74:75], v95, v[80:81] offset:65408
    v_cvt_pk_bf16_f32 v76, v76, v77
    v_cvt_pk_bf16_f32 v77, v78, v79
    ds_wrxchg_rtn_b64 v[72:73], v94, v[76:77] offset:65408
    v_and_b32 v88, 0x0fffffff, v21
    buffer_load_dwordx2 v[16:17], v88, s[8:11], 0 offen
    buffer_load_dwordx3 v[18:20], v88, s[8:11], 0 offen offset:8
    s_setprio 2
    v_mfma_f32_4x4x4_16b_bf16 v[80:83], v[8:9], v[102:103], 0
    v_mfma_f32_4x4x4_16b_bf16 v[76:79], v[8:9], v[100:101], 0
    v_cmp_lt_u32 s[48:49], v5, v93
    s_nop 2
    v_pk_mul_f32 v[80:81], v[80:81], v[14:15] op_sel:[0,1] op_sel_hi:[1,1]
    v_pk_mul_f32 v[82:83], v[82:83], v[14:15] op_sel:[0,1] op_sel_hi:[1,1]
    v_pk_mul_f32 v[76:77], v[76:77], v[14:15] op_sel:[0,0] op_sel_hi:[1,0]
    v_pk_mul_f32 v[78:79], v[78:79], v[14:15] op_sel:[0,0] op_sel_hi:[1,0]
    s_waitcnt vmcnt(10)
    v_and_b32 v46, 0x20000000, v41
    v_lshrrev_b32 v47, 14, v23
    v_bitop3_b32 v47, v47, v5, v46 bitop3:0xea
    ds_read_b64 v[106:107], v47
    v_and_b32 v99, 0x10000000, v41
    v_lshrrev_b32 v47, 14, v22
    v_bitop3_b32 v47, v47, v5, v99 bitop3:0xea
    ds_read_b64 v[104:105], v47
    s_waitcnt lgkmcnt(2)
    v_cmp_ne_u64 s[50:51], v[72:73], v[68:69]
    v_cmpx_ne_u64 s[54:55], v[74:75], v[70:71]
    s_and_b64 s[82:83], s[54:55], s[80:81]
    s_cbranch_scc1 L2_c105
L2_d105:
    v_mov_b64 v[84:85], v[70:71]
    v_mov_b32 v7, v95
    v_mov_b64 v[86:87], v[74:75]
    s_or_b64 s[80:81], s[80:81], s[54:55]
    s_mov_b64 exec, s[50:51]
    s_and_b64 s[82:83], s[50:51], s[80:81]
    s_cbranch_scc1 L2_c106
L2_d106:
    v_mov_b64 v[84:85], v[68:69]
    v_mov_b32 v7, v94
    v_mov_b64 v[86:87], v[72:73]
    s_mov_b64 exec, -1
    s_or_b64 s[80:81], s[80:81], s[50:51]
    s_and_b64 exec, s[48:49], s[80:81]
    v_mfma_f32_4x4x4_16b_bf16 v[80:83], v[12:13], v[84:85], 0
    v_mov_b32 v93, v7
    s_andn2_b64 s[80:81], s[80:81], s[48:49]
    v_mfma_f32_4x4x4_16b_bf16 v[80:83], v[10:11], v[86:87], v[80:83]
    s_mov_b64 exec, -1
    ds_read_b64 v[70:71], v93 offset:65408
    ds_read_b64 v[68:69], v92 offset:65408
    v_bitop3_b32 v94, v22, v5, v99 bitop3:0xea
    v_bitop3_b32 v95, v23, v5, v46 bitop3:0xea
    v_perm_b32 v15, v23, v26, s45
    v_bitop3_b32 v46, v23, 0.5, -0.5 bitop3:0xa8
    v_perm_b32 v14, v22, v26, s44
    v_bitop3_b32 v47, v22, 0.5, -0.5 bitop3:0xa8
    v_bitop3_b32 v15, v6, v15, v46 bitop3:0xca
    v_bitop3_b32 v14, v6, v14, v47 bitop3:0xca
    s_waitcnt lgkmcnt(1)
    v_mfma_f32_4x4x4_16b_bf16 v[80:83], v[10:11], v[70:71], v[80:83]
    s_waitcnt lgkmcnt(0)
    v_mfma_f32_4x4x4_16b_bf16 v[76:79], v[10:11], v[68:69], v[76:79]
    s_nop 2
    v_cvt_pk_bf16_f32 v80, v80, v81
    v_cvt_pk_bf16_f32 v81, v82, v83
    ds_wrxchg_rtn_b64 v[74:75], v93, v[80:81] offset:65408
    v_cvt_pk_bf16_f32 v76, v76, v77
    v_cvt_pk_bf16_f32 v77, v78, v79
    ds_wrxchg_rtn_b64 v[72:73], v92, v[76:77] offset:65408
    s_setprio 1
    v_mfma_f32_4x4x4_16b_bf16 v[80:83], v[8:9], v[106:107], 0
    v_mfma_f32_4x4x4_16b_bf16 v[76:79], v[8:9], v[104:105], 0
    s_nop 3
    v_pk_mul_f32 v[80:81], v[80:81], v[14:15] op_sel:[0,1] op_sel_hi:[1,1]
    v_pk_mul_f32 v[82:83], v[82:83], v[14:15] op_sel:[0,1] op_sel_hi:[1,1]
    v_pk_mul_f32 v[76:77], v[76:77], v[14:15] op_sel:[0,0] op_sel_hi:[1,0]
    v_pk_mul_f32 v[78:79], v[78:79], v[14:15] op_sel:[0,0] op_sel_hi:[1,0]
    s_bitcmp1_b32 s43, s42
    s_cbranch_scc1 L2_oa107
L2_ob107:
    buffer_load_dwordx4 v[112:115], v3, s[16:19], s40 offen offset:1024 sc1
    v_sub_u16 v88, v62, v54
    v_and_b32 v89, 3, v54
    v_add3_u32 v99, v88, v89, 3
    v_and_b32 v99, -4, v99
    v_max_u32 v99, 4, v99
    v_and_b32 v97, 0xfffc, v54
    v_bfm_b32 v96, v88, v89
    v_add_u32_dpp v91, v99, v99 row_shr:1 row_mask:0xf bank_mask:0xf bound_ctrl:1
    v_mad_u32_u24 v97, v97, 5, v2
    v_cmp_lt_u32 vcc, 16, v99
    v_add_u32_dpp v91, v91, v91 row_shr:2 row_mask:0xf bank_mask:0xf bound_ctrl:1
    v_sub_u32 v98, s38, v99
    v_lshrrev_b64 v[54:55], 16, v[54:55]
    v_add_u32_dpp v91, v91, v91 row_shr:4 row_mask:0xf bank_mask:0xf bound_ctrl:1
    v_lshrrev_b64 v[62:63], 16, v[62:63]
    s_mov_b32 s101, 0
    v_add_u32_dpp v91, v91, v91 row_shr:8 row_mask:0xf bank_mask:0xf bound_ctrl:1
    s_nop 1
    v_add_u32_dpp v91, v91, v91 row_bcast:15 row_mask:0xa bank_mask:0xf
    s_nop 1
    v_add_u32_dpp v91, v91, v91 row_bcast:31 row_mask:0xc bank_mask:0xf
    v_add_u32 v98, v98, v91
    v_readlane_b32 s37, v91, 63
    s_cbranch_vccnz L2_xo108
L2_xp108:
    v_and_b32 v46, 0x80000000, v41
    v_lshrrev_b32 v47, 14, v25
    v_bitop3_b32 v47, v47, v5, v46 bitop3:0xea
    ds_read_b64 v[102:103], v47
    v_and_b32 v99, 0x40000000, v41
    v_lshrrev_b32 v47, 14, v24
    v_bitop3_b32 v47, v47, v5, v99 bitop3:0xea
    ds_read_b64 v[100:101], v47
    s_waitcnt lgkmcnt(2)
    v_cmp_ne_u64 s[50:51], v[72:73], v[68:69]
    v_cmpx_ne_u64 s[54:55], v[74:75], v[70:71]
    s_and_b64 s[82:83], s[54:55], s[80:81]
    s_cbranch_scc1 L2_c109
L2_d109:
    v_mov_b64 v[84:85], v[70:71]
    v_mov_b32 v7, v93
    v_mov_b64 v[86:87], v[74:75]
    s_or_b64 s[80:81], s[80:81], s[54:55]
    s_mov_b64 exec, s[50:51]
    s_and_b64 s[82:83], s[50:51], s[80:81]
    s_cbranch_scc1 L2_c110
L2_d110:
    v_mov_b64 v[84:85], v[68:69]
    v_mov_b32 v7, v92
    v_mov_b64 v[86:87], v[72:73]
    s_mov_b64 exec, -1
    s_or_b64 s[80:81], s[80:81], s[50:51]
    ds_read_b64 v[70:71], v95 offset:65408
    ds_read_b64 v[68:69], v94 offset:65408
    v_bitop3_b32 v92, v24, v5, v99 bitop3:0xea
    v_bitop3_b32 v93, v25, v5, v46 bitop3:0xea
    v_perm_b32 v15, v25, v26, s47
    v_bitop3_b32 v46, v25, 0.5, -0.5 bitop3:0xa8
    v_perm_b32 v14, v24, v26, s46
    v_bitop3_b32 v47, v24, 0.5, -0.5 bitop3:0xa8
    v_bitop3_b32 v15, v6, v15, v46 bitop3:0xca
    v_bitop3_b32 v14, v6, v14, v47 bitop3:0xca
    s_waitcnt lgkmcnt(1)
    v_mfma_f32_4x4x4_16b_bf16 v[80:83], v[10:11], v[70:71], v[80:83]
    s_waitcnt lgkmcnt(0)
    v_mfma_f32_4x4x4_16b_bf16 v[76:79], v[10:11], v[68:69], v[76:79]
    s_nop 2
    v_cvt_pk_bf16_f32 v80, v80, v81
    v_cvt_pk_bf16_f32 v81, v82, v83
    ds_wrxchg_rtn_b64 v[74:75], v95, v[80:81] offset:65408
    v_cvt_pk_bf16_f32 v76, v76, v77
    v_cvt_pk_bf16_f32 v77, v78, v79
    ds_wrxchg_rtn_b64 v[72:73], v94, v[76:77] offset:65408
    v_and_b32 v88, 0x0fffffff, v27
    buffer_load_dwordx2 v[22:23], v88, s[8:11], 0 offen
    buffer_load_dwordx3 v[24:26], v88, s[8:11], 0 offen offset:8
    v_mfma_f32_4x4x4_16b_bf16 v[80:83], v[8:9], v[102:103], 0
    v_mfma_f32_4x4x4_16b_bf16 v[76:79], v[8:9], v[100:101], 0
    v_cmp_lt_u32 s[84:85], v5, v92
    s_nop 2
    v_pk_mul_f32 v[80:81], v[80:81], v[14:15] op_sel:[0,1] op_sel_hi:[1,1]
    v_pk_mul_f32 v[82:83], v[82:83], v[14:15] op_sel:[0,1] op_sel_hi:[1,1]
    v_pk_mul_f32 v[76:77], v[76:77], v[14:15] op_sel:[0,0] op_sel_hi:[1,0]
    v_pk_mul_f32 v[78:79], v[78:79], v[14:15] op_sel:[0,0] op_sel_hi:[1,0]
    s_waitcnt vmcnt(11)
    s_mov_b64 exec, s[6:7]
    v_lshrrev_b32 v30, 16, v30
    s_mov_b64 exec, -1
    v_and_b32 v46, 0x20000000, v42
    v_lshrrev_b32 v47, 14, v29
    v_bitop3_b32 v47, v47, v5, v46 bitop3:0xea
    ds_read_b64 v[106:107], v47
    v_and_b32 v99, 0x10000000, v42
    v_lshrrev_b32 v47, 14, v28
    v_bitop3_b32 v47, v47, v5, v99 bitop3:0xea
    ds_read_b64 v[104:105], v47
    s_waitcnt lgkmcnt(2)
    v_cmp_ne_u64 s[50:51], v[72:73], v[68:69]
    v_cmpx_ne_u64 s[54:55], v[74:75], v[70:71]
    s_and_b64 s[82:83], s[54:55], s[80:81]
    s_cbranch_scc1 L2_c111
L2_d111:
    v_mov_b64 v[84:85], v[70:71]
    v_mov_b32 v7, v95
    v_mov_b64 v[86:87], v[74:75]
    s_or_b64 s[80:81], s[80:81], s[54:55]
    s_mov_b64 exec, s[50:51]
    s_and_b64 s[82:83], s[50:51], s[80:81]
    s_cbranch_scc1 L2_c112
L2_d112:
    v_mov_b64 v[84:85], v[68:69]
    v_mov_b32 v7, v94
    v_mov_b64 v[86:87], v[72:73]
    s_mov_b64 exec, -1
    s_or_b64 s[80:81], s[80:81], s[50:51]
    s_and_b64 exec, s[84:85], s[80:81]
    v_mfma_f32_4x4x4_16b_bf16 v[76:79], v[12:13], v[84:85], 0
    v_mov_b32 v92, v7
    s_andn2_b64 s[80:81], s[80:81], s[84:85]
    v_mfma_f32_4x4x4_16b_bf16 v[76:79], v[10:11], v[86:87], v[76:79]
    s_mov_b64 exec, -1
    ds_read_b64 v[70:71], v93 offset:65408
    ds_read_b64 v[68:69], v92 offset:65408
    v_bitop3_b32 v94, v28, v5, v99 bitop3:0xea
    v_bitop3_b32 v95, v29, v5, v46 bitop3:0xea
    v_perm_b32 v15, v29, v30, s45
    v_bitop3_b32 v46, v29, 0.5, -0.5 bitop3:0xa8
    v_perm_b32 v14, v28, v30, s44
    v_bitop3_b32 v47, v28, 0.5, -0.5 bitop3:0xa8
    v_bitop3_b32 v15, v6, v15, v46 bitop3:0xca
    v_bitop3_b32 v14, v6, v14, v47 bitop3:0xca
    s_waitcnt lgkmcnt(1)
    v_mfma_f32_4x4x4_16b_bf16 v[80:83], v[10:11], v[70:71], v[80:83]
    s_waitcnt lgkmcnt(0)
    v_mfma_f32_4x4x4_16b_bf16 v[76:79], v[10:11], v[68:69], v[76:79]
    s_nop 2
    v_cvt_pk_bf16_f32 v80, v80, v81
    v_cvt_pk_bf16_f32 v81, v82, v83
    ds_wrxchg_rtn_b64 v[74:75], v93, v[80:81] offset:65408
    v_cvt_pk_bf16_f32 v76, v76, v77
    v_cvt_pk_bf16_f32 v77, v78, v79
    ds_wrxchg_rtn_b64 v[72:73], v92, v[76:77] offset:65408
    s_setprio 0
    v_mfma_f32_4x4x4_16b_bf16 v[80:83], v[8:9], v[106:107], 0
    v_mfma_f32_4x4x4_16b_bf16 v[76:79], v[8:9], v[104:105], 0
    v_cmp_lt_u32 s[48:49], v5, v95
    s_nop 2
    v_pk_mul_f32 v[80:81], v[80:81], v[14:15] op_sel:[0,1] op_sel_hi:[1,1]
    v_pk_mul_f32 v[82:83], v[82:83], v[14:15] op_sel:[0,1] op_sel_hi:[1,1]
    v_pk_mul_f32 v[76:77], v[76:77], v[14:15] op_sel:[0,0] op_sel_hi:[1,0]
    v_pk_mul_f32 v[78:79], v[78:79], v[14:15] op_sel:[0,0] op_sel_hi:[1,0]
    s_add_u32 s40, s40, 0x50000
    v_and_b32 v47, 0x0fffffff, v31
    buffer_load_dword v30, v47, s[8:11], 0 offen offset:16
    s_mov_b64 exec, s[6:7]
    v_add_u32 v47, 8, v47
    v_lshrrev_b32 v31, 2, v31
    s_mov_b64 exec, -1
    buffer_load_dwordx2 v[28:29], v47, s[8:11], 0 offen
    s_waitcnt vmcnt(8)
    v_and_b32 v46, 0x80000000, v43
    v_lshrrev_b32 v47, 14, v37
    v_bitop3_b32 v47, v47, v5, v46 bitop3:0xea
    ds_read_b64 v[106:107], v47
    v_and_b32 v99, 0x40000000, v43
    v_lshrrev_b32 v47, 14, v36
    v_bitop3_b32 v47, v47, v5, v99 bitop3:0xea
    ds_read_b64 v[104:105], v47
    v_and_b32 v46, 0x20000000, v43
    v_lshrrev_b32 v47, 14, v35
    v_bitop3_b32 v47, v47, v5, v46 bitop3:0xea
    ds_read_b64 v[102:103], v47
    v_and_b32 v99, 0x10000000, v43
    v_lshrrev_b32 v47, 14, v34
    v_bitop3_b32 v47, v47, v5, v99 bitop3:0xea
    ds_read_b64 v[100:101], v47
    s_waitcnt lgkmcnt(4)
    v_cmp_ne_u64 s[50:51], v[72:73], v[68:69]
    v_cmpx_ne_u64 s[54:55], v[74:75], v[70:71]
    s_and_b64 s[82:83], s[54:55], s[80:81]
    s_cbranch_scc1 L2_c113
L2_d113:
    v_mov_b64 v[84:85], v[70:71]
    v_mov_b32 v7, v93
    v_mov_b64 v[86:87], v[74:75]
    s_or_b64 s[80:81], s[80:81], s[54:55]
    s_mov_b64 exec, s[50:51]
    s_and_b64 s[82:83], s[50:51], s[80:81]
    s_cbranch_scc1 L2_c114
L2_d114:
    v_mov_b64 v[84:85], v[68:69]
    v_mov_b32 v7, v92
    v_mov_b64 v[86:87], v[72:73]
    s_mov_b64 exec, -1
    s_or_b64 s[80:81], s[80:81], s[50:51]
    s_and_b64 exec, s[48:49], s[80:81]
    v_mfma_f32_4x4x4_16b_bf16 v[80:83], v[12:13], v[84:85], 0
    v_mov_b32 v95, v7
    s_andn2_b64 s[80:81], s[80:81], s[48:49]
    v_mfma_f32_4x4x4_16b_bf16 v[80:83], v[10:11], v[86:87], v[80:83]
    s_mov_b64 exec, -1
    ds_read_b64 v[70:71], v95 offset:65408
    ds_read_b64 v[68:69], v94 offset:65408
    v_bitop3_b32 v92, v34, v5, v99 bitop3:0xea
    v_bitop3_b32 v93, v35, v5, v46 bitop3:0xea
    v_perm_b32 v15, v35, v38, s45
    v_bitop3_b32 v46, v35, 0.5, -0.5 bitop3:0xa8
    v_perm_b32 v14, v34, v38, s44
    v_bitop3_b32 v47, v34, 0.5, -0.5 bitop3:0xa8
    v_bitop3_b32 v15, v6, v15, v46 bitop3:0xca
    v_bitop3_b32 v14, v6, v14, v47 bitop3:0xca
    s_waitcnt lgkmcnt(1)
    v_mfma_f32_4x4x4_16b_bf16 v[80:83], v[10:11], v[70:71], v[80:83]
    s_waitcnt lgkmcnt(0)
    v_mfma_f32_4x4x4_16b_bf16 v[76:79], v[10:11], v[68:69], v[76:79]
    s_nop 2
    v_cvt_pk_bf16_f32 v80, v80, v81
    v_cvt_pk_bf16_f32 v81, v82, v83
    ds_wrxchg_rtn_b64 v[74:75], v95, v[80:81] offset:65408
    v_cvt_pk_bf16_f32 v76, v76, v77
    v_cvt_pk_bf16_f32 v77, v78, v79
    ds_wrxchg_rtn_b64 v[72:73], v94, v[76:77] offset:65408
    s_barrier
    s_setprio 3
    s_mov_b32 m0, s100
    s_nop 0
    ds_write_addtid_b32 v124 offset:34816
    ds_write_addtid_b32 v125 offset:35072
    ds_write_addtid_b32 v126 offset:35328
    ds_write_addtid_b32 v127 offset:35584
    s_add_u32 s3, s40, 4096
    buffer_load_dwordx4 v[124:127], v3, s[16:19], s3 offen sc1
    ds_write_addtid_b32 v116 offset:32768
    ds_write_addtid_b32 v117 offset:33024
    ds_write_addtid_b32 v118 offset:33280
    ds_write_addtid_b32 v119 offset:33536
    buffer_load_dwordx4 v[116:119], v3, s[16:19], s40 offen offset:2048 sc1
    ds_write_addtid_b32 v120 offset:33792
    ds_write_addtid_b32 v121 offset:34048
    ds_write_addtid_b32 v122 offset:34304
    ds_write_addtid_b32 v123 offset:34560
    buffer_load_dwordx4 v[120:123], v3, s[16:19], s40 offen offset:3072 sc1
    v_mfma_f32_4x4x4_16b_bf16 v[80:83], v[8:9], v[102:103], 0
    v_mfma_f32_4x4x4_16b_bf16 v[76:79], v[8:9], v[100:101], 0
    s_nop 3
    v_pk_mul_f32 v[80:81], v[80:81], v[14:15] op_sel:[0,1] op_sel_hi:[1,1]
    v_pk_mul_f32 v[82:83], v[82:83], v[14:15] op_sel:[0,1] op_sel_hi:[1,1]
    v_pk_mul_f32 v[76:77], v[76:77], v[14:15] op_sel:[0,0] op_sel_hi:[1,0]
    v_pk_mul_f32 v[78:79], v[78:79], v[14:15] op_sel:[0,0] op_sel_hi:[1,0]
    s_cmp_gt_u32 s37, 1024
    s_cbranch_scc1 L2_xs115
    s_cmp_lg_u32 s101, 0
    s_cbranch_scc1 L2_xa115
L2_xb115:
    v_lshlrev_b32 v89, 16, v96
    v_add_u32 v90, 60, v97
    v_bitop3_b32 v90, v89, v45, v90 bitop3:0x6a
    ds_write_b32 v98, v90 offset:12
    v_lshlrev_b32 v89, 20, v96
    v_add_u32 v90, 40, v97
    v_bitop3_b32 v90, v89, v45, v90 bitop3:0x6a
    ds_write_b32 v98, v90 offset:8
    v_lshlrev_b32 v89, 24, v96
    v_add_u32 v90, 20, v97
    v_bitop3_b32 v90, v89, v45, v90 bitop3:0x6a
    ds_write_b32 v98, v90 offset:4
    v_lshlrev_b32 v89, 28, v96
    v_bitop3_b32 v90, v89, v45, v97 bitop3:0x6a
    ds_write_b32 v98, v90 offset:0
    v_mov_b32_dpp v91, v66 quad_perm:[1,1,1,1] row_mask:0xf bank_mask:0xf
    v_and_b32 v89, 3, v91
    v_and_b32 v97, 0xfffc, v91
    v_sub_u16_dpp v88, v66, v91 quad_perm:[3,3,3,3] row_mask:0xf bank_mask:0xf
    v_mad_u32_u24 v97, v97, 5, v4
    v_add_u32 v99, v88, v89
    v_bfm_b32 v96, v88, v89
    v_cmp_lt_u32 s[58:59], 16, v99
    v_lshlrev_b32 v89, v1, v96
    v_and_b32 v89, v45, v89
    v_cmp_ne_u32 vcc, 0, v89
    v_xor_b32 v90, v97, v89
    s_add_u32 s3, s37, s38
    v_mbcnt_lo_u32_b32 v98, vcc_lo, 0
    v_mbcnt_hi_u32_b32 v98, vcc_hi, v98
    s_bcnt1_i32_b64 s41, vcc
    v_lshl_add_u32 v98, v98, 2, s3
    s_lshl2_add_u32 s37, s41, s37
    s_mov_b64 exec, vcc
    ds_write_b32 v98, v90
    s_mov_b64 exec, -1
    s_cmp_lg_u64 s[58:59], 0
    s_cbranch_scc1 L2_xe115
L2_xr115:
    v_add_u32 v98, s37, v0
    v_mov_b32 v90, -1
    ds_write_b32 v98, v90
L2_xw115:
    s_setprio 2
    s_waitcnt lgkmcnt(14)
    v_cmp_ne_u64 s[50:51], v[72:73], v[68:69]
    v_cmpx_ne_u64 s[54:55], v[74:75], v[70:71]
    s_and_b64 s[82:83], s[54:55], s[80:81]
    s_cbranch_scc1 L2_c116
L2_d116:
    v_mov_b64 v[84:85], v[70:71]
    v_mov_b32 v7, v95
    v_mov_b64 v[86:87], v[74:75]
    s_or_b64 s[80:81], s[80:81], s[54:55]
    s_mov_b64 exec, s[50:51]
    s_and_b64 s[82:83], s[50:51], s[80:81]
    s_cbranch_scc1 L2_c117
L2_d117:
    v_mov_b64 v[84:85], v[68:69]
    v_mov_b32 v7, v94
    v_mov_b64 v[86:87], v[72:73]
    s_mov_b64 exec, -1
    s_or_b64 s[80:81], s[80:81], s[50:51]
    ds_read_b64 v[70:71], v93 offset:65408
    ds_read_b64 v[68:69], v92 offset:65408
    v_and_b32 v46, 0x40000000, v43
    v_bitop3_b32 v94, v36, v5, v46 bitop3:0xea
    v_and_b32 v46, 0x80000000, v43
    v_bitop3_b32 v95, v37, v5, v46 bitop3:0xea
    v_perm_b32 v15, v37, v38, s47
    v_bitop3_b32 v46, v37, 0.5, -0.5 bitop3:0xa8
    v_perm_b32 v14, v36, v38, s46
    v_bitop3_b32 v47, v36, 0.5, -0.5 bitop3:0xa8
    v_bitop3_b32 v15, v6, v15, v46 bitop3:0xca
    v_bitop3_b32 v14, v6, v14, v47 bitop3:0xca
    s_setprio 1
    s_waitcnt lgkmcnt(1)
    v_mfma_f32_4x4x4_16b_bf16 v[80:83], v[10:11], v[70:71], v[80:83]
    s_waitcnt lgkmcnt(0)
    v_mfma_f32_4x4x4_16b_bf16 v[76:79], v[10:11], v[68:69], v[76:79]
    s_nop 2
    v_cvt_pk_bf16_f32 v80, v80, v81
    v_cvt_pk_bf16_f32 v81, v82, v83
    ds_wrxchg_rtn_b64 v[74:75], v93, v[80:81] offset:65408
    v_cvt_pk_bf16_f32 v76, v76, v77
    v_cvt_pk_bf16_f32 v77, v78, v79
    ds_wrxchg_rtn_b64 v[72:73], v92, v[76:77] offset:65408
    ds_read_b32 v40, v0 offset:0
    ds_read_b32 v41, v0 offset:256
    ds_read_b32 v42, v44 offset:768
    ds_read_b32 v43, v0 offset:512
    s_sub_u32 s3, s37, 768
    s_cmp_gt_u32 s3, 128
    s_cbranch_scc1 L2_xf115
L2_xg115:
    v_lshrrev_b64 v[64:65], 16, v[64:65]
    v_lshrrev_b64 v[66:67], 16, v[66:67]
    v_and_b32 v88, 0x0fffffff, v39
    buffer_load_dwordx2 v[34:35], v88, s[8:11], 0 offen
    buffer_load_dwordx3 v[36:38], v88, s[8:11], 0 offen offset:8
    s_setprio 0
    s_waitcnt vmcnt(12)
    s_mov_b32 m0, s38
    s_nop 0
    ds_write_addtid_b32 v108 offset:0
    ds_write_addtid_b32 v109 offset:256
    ds_write_addtid_b32 v110 offset:512
    ds_write_addtid_b32 v111 offset:768
    s_waitcnt vmcnt(9)
    ds_write_addtid_b32 v112 offset:1024
    ds_write_addtid_b32 v113 offset:1280
    ds_write_addtid_b32 v114 offset:1536
    ds_write_addtid_b32 v115 offset:1792
    v_mfma_f32_4x4x4_16b_bf16 v[80:83], v[8:9], v[106:107], 0
    v_mfma_f32_4x4x4_16b_bf16 v[76:79], v[8:9], v[104:105], 0
    v_cmp_lt_u32 s[84:85], v5, v94
    s_nop 2
    v_pk_mul_f32 v[80:81], v[80:81], v[14:15] op_sel:[0,1] op_sel_hi:[1,1]
    v_pk_mul_f32 v[82:83], v[82:83], v[14:15] op_sel:[0,1] op_sel_hi:[1,1]
    v_pk_mul_f32 v[76:77], v[76:77], v[14:15] op_sel:[0,0] op_sel_hi:[1,0]
    v_pk_mul_f32 v[78:79], v[78:79], v[14:15] op_sel:[0,0] op_sel_hi:[1,0]
    s_add_u32 s42, s42, 1
    s_waitcnt lgkmcnt(0)
    s_cmp_lg_u32 s42, 14
    s_cbranch_scc1 L2_loop
    s_barrier
    s_bitcmp1_b32 s36, s42
    s_cbranch_scc1 L2_slow
L2_ret6:
    s_setprio 3
    s_bitcmp1_b32 s43, s42
    s_cbranch_scc1 L2_oa118
L2_ob118:
    v_and_b32 v46, 0x20000000, v21
    v_lshrrev_b32 v47, 14, v17
    v_bitop3_b32 v47, v47, v5, v46 bitop3:0xea
    ds_read_b64 v[102:103], v47
    v_and_b32 v99, 0x10000000, v21
    v_lshrrev_b32 v47, 14, v16
    v_bitop3_b32 v47, v47, v5, v99 bitop3:0xea
    ds_read_b64 v[100:101], v47
    v_cmp_ne_u64 s[50:51], v[72:73], v[68:69]
    v_cmpx_ne_u64 s[54:55], v[74:75], v[70:71]
    s_and_b64 s[82:83], s[54:55], s[80:81]
    s_cbranch_scc1 L2_c119
L2_d119:
    v_mov_b64 v[84:85], v[70:71]
    v_mov_b32 v7, v93
    v_mov_b64 v[86:87], v[74:75]
    s_or_b64 s[80:81], s[80:81], s[54:55]
    s_mov_b64 exec, s[50:51]
    s_and_b64 s[82:83], s[50:51], s[80:81]
    s_cbranch_scc1 L2_c120
L2_d120:
    v_mov_b64 v[84:85], v[68:69]
    v_mov_b32 v7, v92
    v_mov_b64 v[86:87], v[72:73]
    s_mov_b64 exec, -1
    s_or_b64 s[80:81], s[80:81], s[50:51]
    s_and_b64 exec, s[84:85], s[80:81]
    v_mfma_f32_4x4x4_16b_bf16 v[76:79], v[12:13], v[84:85], 0
    v_mov_b32 v94, v7
    s_andn2_b64 s[80:81], s[80:81], s[84:85]
    v_mfma_f32_4x4x4_16b_bf16 v[76:79], v[10:11], v[86:87], v[76:79]
    s_mov_b64 exec, -1
    ds_read_b64 v[70:71], v95 offset:65408
    ds_read_b64 v[68:69], v94 offset:65408
    v_bitop3_b32 v92, v16, v5, v99 bitop3:0xea
    v_bitop3_b32 v93, v17, v5, v46 bitop3:0xea
    v_perm_b32 v15, v17, v20, s45
    v_bitop3_b32 v46, v17, 0.5, -0.5 bitop3:0xa8
    v_perm_b32 v14, v16, v20, s44
    v_bitop3_b32 v47, v16, 0.5, -0.5 bitop3:0xa8
    v_bitop3_b32 v15, v6, v15, v46 bitop3:0xca
    v_bitop3_b32 v14, v6, v14, v47 bitop3:0xca
    s_waitcnt lgkmcnt(1)
    v_mfma_f32_4x4x4_16b_bf16 v[80:83], v[10:11], v[70:71], v[80:83]
    s_waitcnt lgkmcnt(0)
    v_mfma_f32_4x4x4_16b_bf16 v[76:79], v[10:11], v[68:69], v[76:79]
    s_nop 2
    v_cvt_pk_bf16_f32 v80, v80, v81
    v_cvt_pk_bf16_f32 v81, v82, v83
    ds_wrxchg_rtn_b64 v[74:75], v95, v[80:81] offset:65408
    v_cvt_pk_bf16_f32 v76, v76, v77
    v_cvt_pk_bf16_f32 v77, v78, v79
    ds_wrxchg_rtn_b64 v[72:73], v94, v[76:77] offset:65408
    v_mfma_f32_4x4x4_16b_bf16 v[80:83], v[8:9], v[102:103], 0
    v_mfma_f32_4x4x4_16b_bf16 v[76:79], v[8:9], v[100:101], 0
    v_cmp_lt_u32 s[84:85], v5, v92
    s_nop 2
    v_pk_mul_f32 v[80:81], v[80:81], v[14:15] op_sel:[0,1] op_sel_hi:[1,1]
    v_pk_mul_f32 v[82:83], v[82:83], v[14:15] op_sel:[0,1] op_sel_hi:[1,1]
    v_pk_mul_f32 v[76:77], v[76:77], v[14:15] op_sel:[0,0] op_sel_hi:[1,0]
    v_pk_mul_f32 v[78:79], v[78:79], v[14:15] op_sel:[0,0] op_sel_hi:[1,0]
    buffer_load_dwordx4 v[108:111], v3, s[16:19], s40 offen offset:0 sc1
    v_and_b32 v46, 0x80000000, v21
    v_lshrrev_b32 v47, 14, v19
    v_bitop3_b32 v47, v47, v5, v46 bitop3:0xea
    ds_read_b64 v[106:107], v47
    v_and_b32 v99, 0x40000000, v21
    v_lshrrev_b32 v47, 14, v18
    v_bitop3_b32 v47, v47, v5, v99 bitop3:0xea
    ds_read_b64 v[104:105], v47
    s_waitcnt lgkmcnt(2)
    v_cmp_ne_u64 s[50:51], v[72:73], v[68:69]
    v_cmpx_ne_u64 s[54:55], v[74:75], v[70:71]
    s_and_b64 s[82:83], s[54:55], s[80:81]
    s_cbranch_scc1 L2_c121
L2_d121:
    v_mov_b64 v[84:85], v[70:71]
    v_mov_b32 v7, v95
    v_mov_b64 v[86:87], v[74:75]
    s_or_b64 s[80:81], s[80:81], s[54:55]
    s_mov_b64 exec, s[50:51]
    s_and_b64 s[82:83], s[50:51], s[80:81]
    s_cbranch_scc1 L2_c122
L2_d122:
    v_mov_b64 v[84:85], v[68:69]
    v_mov_b32 v7, v94
    v_mov_b64 v[86:87], v[72:73]
    s_mov_b64 exec, -1
    s_or_b64 s[80:81], s[80:81], s[50:51]
    s_and_b64 exec, s[84:85], s[80:81]
    v_mfma_f32_4x4x4_16b_bf16 v[76:79], v[12:13], v[84:85], 0
    v_mov_b32 v92, v7
    s_andn2_b64 s[80:81], s[80:81], s[84:85]
    v_mfma_f32_4x4x4_16b_bf16 v[76:79], v[10:11], v[86:87], v[76:79]
    s_mov_b64 exec, -1
    ds_read_b64 v[70:71], v93 offset:65408
    ds_read_b64 v[68:69], v92 offset:65408
    v_bitop3_b32 v94, v18, v5, v99 bitop3:0xea
    v_bitop3_b32 v95, v19, v5, v46 bitop3:0xea
    v_perm_b32 v15, v19, v20, s47
    v_bitop3_b32 v46, v19, 0.5, -0.5 bitop3:0xa8
    v_perm_b32 v14, v18, v20, s46
    v_bitop3_b32 v47, v18, 0.5, -0.5 bitop3:0xa8
    v_bitop3_b32 v15, v6, v15, v46 bitop3:0xca
    v_bitop3_b32 v14, v6, v14, v47 bitop3:0xca
    s_waitcnt lgkmcnt(1)
    v_mfma_f32_4x4x4_16b_bf16 v[80:83], v[10:11], v[70:71], v[80:83]
    s_waitcnt lgkmcnt(0)
    v_mfma_f32_4x4x4_16b_bf16 v[76:79], v[10:11], v[68:69], v[76:79]
    s_nop 2
    v_cvt_pk_bf16_f32 v80, v80, v81
    v_cvt_pk_bf16_f32 v81, v82, v83
    ds_wrxchg_rtn_b64 v[74:75], v93, v[80:81] offset:65408
    v_cvt_pk_bf16_f32 v76, v76, v77
    v_cvt_pk_bf16_f32 v77, v78, v79
    ds_wrxchg_rtn_b64 v[72:73], v92, v[76:77] offset:65408
    v_and_b32 v88, 0x0fffffff, v40
    buffer_load_dwordx2 v[16:17], v88, s[8:11], 0 offen
    buffer_load_dwordx3 v[18:20], v88, s[8:11], 0 offen offset:8
    s_setprio 2
    v_mfma_f32_4x4x4_16b_bf16 v[80:83], v[8:9], v[106:107], 0
    v_mfma_f32_4x4x4_16b_bf16 v[76:79], v[8:9], v[104:105], 0
    v_cmp_lt_u32 s[48:49], v5, v95
    s_nop 2
    v_pk_mul_f32 v[80:81], v[80:81], v[14:15] op_sel:[0,1] op_sel_hi:[1,1]
    v_pk_mul_f32 v[82:83], v[82:83], v[14:15] op_sel:[0,1] op_sel_hi:[1,1]
    v_pk_mul_f32 v[76:77], v[76:77], v[14:15] op_sel:[0,0] op_sel_hi:[1,0]
    v_pk_mul_f32 v[78:79], v[78:79], v[14:15] op_sel:[0,0] op_sel_hi:[1,0]
    s_waitcnt vmcnt(10)
    v_and_b32 v46, 0x20000000, v27
    v_lshrrev_b32 v47, 14, v23
    v_bitop3_b32 v47, v47, v5, v46 bitop3:0xea
    ds_read_b64 v[102:103], v47
    v_and_b32 v99, 0x10000000, v27
    v_lshrrev_b32 v47, 14, v22
    v_bitop3_b32 v47, v47, v5, v99 bitop3:0xea
    ds_read_b64 v[100:101], v47
    s_waitcnt lgkmcnt(2)
    v_cmp_ne_u64 s[50:51], v[72:73], v[68:69]
    v_cmpx_ne_u64 s[54:55], v[74:75], v[70:71]
    s_and_b64 s[82:83], s[54:55], s[80:81]
    s_cbranch_scc1 L2_c123
L2_d123:
    v_mov_b64 v[84:85], v[70:71]
    v_mov_b32 v7, v93
    v_mov_b64 v[86:87], v[74:75]
    s_or_b64 s[80:81], s[80:81], s[54:55]
    s_mov_b64 exec, s[50:51]
    s_and_b64 s[82:83], s[50:51], s[80:81]
    s_cbranch_scc1 L2_c124
L2_d124:
    v_mov_b64 v[84:85], v[68:69]
    v_mov_b32 v7, v92
    v_mov_b64 v[86:87], v[72:73]
    s_mov_b64 exec, -1
    s_or_b64 s[80:81], s[80:81], s[50:51]
    s_and_b64 exec, s[48:49], s[80:81]
    v_mfma_f32_4x4x4_16b_bf16 v[80:83], v[12:13], v[84:85], 0
    v_mov_b32 v95, v7
    s_andn2_b64 s[80:81], s[80:81], s[48:49]
    v_mfma_f32_4x4x4_16b_bf16 v[80:83], v[10:11], v[86:87], v[80:83]
    s_mov_b64 exec, -1
    ds_read_b64 v[70:71], v95 offset:65408
    ds_read_b64 v[68:69], v94 offset:65408
    v_bitop3_b32 v92, v22, v5, v99 bitop3:0xea
    v_bitop3_b32 v93, v23, v5, v46 bitop3:0xea
    v_perm_b32 v15, v23, v26, s45
    v_bitop3_b32 v46, v23, 0.5, -0.5 bitop3:0xa8
    v_perm_b32 v14, v22, v26, s44
    v_bitop3_b32 v47, v22, 0.5, -0.5 bitop3:0xa8
    v_bitop3_b32 v15, v6, v15, v46 bitop3:0xca
    v_bitop3_b32 v14, v6, v14, v47 bitop3:0xca
    s_waitcnt lgkmcnt(1)
    v_mfma_f32_4x4x4_16b_bf16 v[80:83], v[10:11], v[70:71], v[80:83]
    s_waitcnt lgkmcnt(0)
    v_mfma_f32_4x4x4_16b_bf16 v[76:79], v[10:11], v[68:69], v[76:79]
    s_nop 2
    v_cvt_pk_bf16_f32 v80, v80, v81
    v_cvt_pk_bf16_f32 v81, v82, v83
    ds_wrxchg_rtn_b64 v[74:75], v95, v[80:81] offset:65408
    v_cvt_pk_bf16_f32 v76, v76, v77
    v_cvt_pk_bf16_f32 v77, v78, v79
    ds_wrxchg_rtn_b64 v[72:73], v94, v[76:77] offset:65408
    s_setprio 1
    v_mfma_f32_4x4x4_16b_bf16 v[80:83], v[8:9], v[102:103], 0
    v_mfma_f32_4x4x4_16b_bf16 v[76:79], v[8:9], v[100:101], 0
    s_nop 3
    v_pk_mul_f32 v[80:81], v[80:81], v[14:15] op_sel:[0,1] op_sel_hi:[1,1]
    v_pk_mul_f32 v[82:83], v[82:83], v[14:15] op_sel:[0,1] op_sel_hi:[1,1]
    v_pk_mul_f32 v[76:77], v[76:77], v[14:15] op_sel:[0,0] op_sel_hi:[1,0]
    v_pk_mul_f32 v[78:79], v[78:79], v[14:15] op_sel:[0,0] op_sel_hi:[1,0]
    s_bitcmp1_b32 s43, s42
    s_cbranch_scc1 L2_oa125
L2_ob125:
    buffer_load_dwordx4 v[112:115], v3, s[16:19], s40 offen offset:1024 sc1
    v_and_b32 v46, 0x80000000, v27
    v_lshrrev_b32 v47, 14, v25
    v_bitop3_b32 v47, v47, v5, v46 bitop3:0xea
    ds_read_b64 v[106:107], v47
    v_and_b32 v99, 0x40000000, v27
    v_lshrrev_b32 v47, 14, v24
    v_bitop3_b32 v47, v47, v5, v99 bitop3:0xea
    ds_read_b64 v[104:105], v47
    s_waitcnt lgkmcnt(2)
    v_cmp_ne_u64 s[50:51], v[72:73], v[68:69]
    v_cmpx_ne_u64 s[54:55], v[74:75], v[70:71]
    s_and_b64 s[82:83], s[54:55], s[80:81]
    s_cbranch_scc1 L2_c126
L2_d126:
    v_mov_b64 v[84:85], v[70:71]
    v_mov_b32 v7, v95
    v_mov_b64 v[86:87], v[74:75]
    s_or_b64 s[80:81], s[80:81], s[54:55]
    s_mov_b64 exec, s[50:51]
    s_and_b64 s[82:83], s[50:51], s[80:81]
    s_cbranch_scc1 L2_c127
L2_d127:
    v_mov_b64 v[84:85], v[68:69]
    v_mov_b32 v7, v94
    v_mov_b64 v[86:87], v[72:73]
    s_mov_b64 exec, -1
    s_or_b64 s[80:81], s[80:81], s[50:51]
    ds_read_b64 v[70:71], v93 offset:65408
    ds_read_b64 v[68:69], v92 offset:65408
    v_bitop3_b32 v94, v24, v5, v99 bitop3:0xea
    v_bitop3_b32 v95, v25, v5, v46 bitop3:0xea
    v_perm_b32 v15, v25, v26, s47
    v_bitop3_b32 v46, v25, 0.5, -0.5 bitop3:0xa8
    v_perm_b32 v14, v24, v26, s46
    v_bitop3_b32 v47, v24, 0.5, -0.5 bitop3:0xa8
    v_bitop3_b32 v15, v6, v15, v46 bitop3:0xca
    v_bitop3_b32 v14, v6, v14, v47 bitop3:0xca
    s_waitcnt lgkmcnt(1)
    v_mfma_f32_4x4x4_16b_bf16 v[80:83], v[10:11], v[70:71], v[80:83]
    s_waitcnt lgkmcnt(0)
    v_mfma_f32_4x4x4_16b_bf16 v[76:79], v[10:11], v[68:69], v[76:79]
    s_nop 2
    v_cvt_pk_bf16_f32 v80, v80, v81
    v_cvt_pk_bf16_f32 v81, v82, v83
    ds_wrxchg_rtn_b64 v[74:75], v93, v[80:81] offset:65408
    v_cvt_pk_bf16_f32 v76, v76, v77
    v_cvt_pk_bf16_f32 v77, v78, v79
    ds_wrxchg_rtn_b64 v[72:73], v92, v[76:77] offset:65408
    v_and_b32 v88, 0x0fffffff, v41
    buffer_load_dwordx2 v[22:23], v88, s[8:11], 0 offen
    buffer_load_dwordx3 v[24:26], v88, s[8:11], 0 offen offset:8
    v_mfma_f32_4x4x4_16b_bf16 v[80:83], v[8:9], v[106:107], 0
    v_mfma_f32_4x4x4_16b_bf16 v[76:79], v[8:9], v[104:105], 0
    v_cmp_lt_u32 s[84:85], v5, v94
    s_nop 2
    v_pk_mul_f32 v[80:81], v[80:81], v[14:15] op_sel:[0,1] op_sel_hi:[1,1]
    v_pk_mul_f32 v[82:83], v[82:83], v[14:15] op_sel:[0,1] op_sel_hi:[1,1]
    v_pk_mul_f32 v[76:77], v[76:77], v[14:15] op_sel:[0,0] op_sel_hi:[1,0]
    v_pk_mul_f32 v[78:79], v[78:79], v[14:15] op_sel:[0,0] op_sel_hi:[1,0]
    s_waitcnt vmcnt(11)
    s_mov_b64 exec, s[6:7]
    v_lshrrev_b32 v30, 16, v30
    s_mov_b64 exec, -1
    v_and_b32 v46, 0x20000000, v31
    v_lshrrev_b32 v47, 14, v29
    v_bitop3_b32 v47, v47, v5, v46 bitop3:0xea
    ds_read_b64 v[102:103], v47
    v_and_b32 v99, 0x10000000, v31
    v_lshrrev_b32 v47, 14, v28
    v_bitop3_b32 v47, v47, v5, v99 bitop3:0xea
    ds_read_b64 v[100:101], v47
    s_waitcnt lgkmcnt(2)
    v_cmp_ne_u64 s[50:51], v[72:73], v[68:69]
    v_cmpx_ne_u64 s[54:55], v[74:75], v[70:71]
    s_and_b64 s[82:83], s[54:55], s[80:81]
    s_cbranch_scc1 L2_c128
L2_d128:
    v_mov_b64 v[84:85], v[70:71]
    v_mov_b32 v7, v93
    v_mov_b64 v[86:87], v[74:75]
    s_or_b64 s[80:81], s[80:81], s[54:55]
    s_mov_b64 exec, s[50:51]
    s_and_b64 s[82:83], s[50:51], s[80:81]
    s_cbranch_scc1 L2_c129
L2_d129:
    v_mov_b64 v[84:85], v[68:69]
    v_mov_b32 v7, v92
    v_mov_b64 v[86:87], v[72:73]
    s_mov_b64 exec, -1
    s_or_b64 s[80:81], s[80:81], s[50:51]
    s_and_b64 exec, s[84:85], s[80:81]
    v_mfma_f32_4x4x4_16b_bf16 v[76:79], v[12:13], v[84:85], 0
    v_mov_b32 v94, v7
    s_andn2_b64 s[80:81], s[80:81], s[84:85]
    v_mfma_f32_4x4x4_16b_bf16 v[76:79], v[10:11], v[86:87], v[76:79]
    s_mov_b64 exec, -1
    ds_read_b64 v[70:71], v95 offset:65408
    ds_read_b64 v[68:69], v94 offset:65408
    v_bitop3_b32 v92, v28, v5, v99 bitop3:0xea
    v_bitop3_b32 v93, v29, v5, v46 bitop3:0xea
    v_perm_b32 v15, v29, v30, s45
    v_bitop3_b32 v46, v29, 0.5, -0.5 bitop3:0xa8
    v_perm_b32 v14, v28, v30, s44
    v_bitop3_b32 v47, v28, 0.5, -0.5 bitop3:0xa8
    v_bitop3_b32 v15, v6, v15, v46 bitop3:0xca
    v_bitop3_b32 v14, v6, v14, v47 bitop3:0xca
    s_waitcnt lgkmcnt(1)
    v_mfma_f32_4x4x4_16b_bf16 v[80:83], v[10:11], v[70:71], v[80:83]
    s_waitcnt lgkmcnt(0)
    v_mfma_f32_4x4x4_16b_bf16 v[76:79], v[10:11], v[68:69], v[76:79]
    s_nop 2
    v_cvt_pk_bf16_f32 v80, v80, v81
    v_cvt_pk_bf16_f32 v81, v82, v83
    ds_wrxchg_rtn_b64 v[74:75], v95, v[80:81] offset:65408
    v_cvt_pk_bf16_f32 v76, v76, v77
    v_cvt_pk_bf16_f32 v77, v78, v79
    ds_wrxchg_rtn_b64 v[72:73], v94, v[76:77] offset:65408
    s_setprio 0
    v_mfma_f32_4x4x4_16b_bf16 v[80:83], v[8:9], v[102:103], 0
    v_mfma_f32_4x4x4_16b_bf16 v[76:79], v[8:9], v[100:101], 0
    v_cmp_lt_u32 s[48:49], v5, v93
    s_nop 2
    v_pk_mul_f32 v[80:81], v[80:81], v[14:15] op_sel:[0,1] op_sel_hi:[1,1]
    v_pk_mul_f32 v[82:83], v[82:83], v[14:15] op_sel:[0,1] op_sel_hi:[1,1]
    v_pk_mul_f32 v[76:77], v[76:77], v[14:15] op_sel:[0,0] op_sel_hi:[1,0]
    v_pk_mul_f32 v[78:79], v[78:79], v[14:15] op_sel:[0,0] op_sel_hi:[1,0]
    s_add_u32 s40, s40, 0xfff24000
    v_and_b32 v47, 0x0fffffff, v42
    buffer_load_dword v30, v47, s[8:11], 0 offen offset:16
    s_mov_b64 exec, s[6:7]
    v_add_u32 v47, 8, v47
    v_lshrrev_b32 v42, 2, v42
    s_mov_b64 exec, -1
    buffer_load_dwordx2 v[28:29], v47, s[8:11], 0 offen
    s_waitcnt vmcnt(8)
    v_and_b32 v46, 0x80000000, v39
    v_lshrrev_b32 v47, 14, v37
    v_bitop3_b32 v47, v47, v5, v46 bitop3:0xea
    ds_read_b64 v[102:103], v47
    v_and_b32 v99, 0x40000000, v39
    v_lshrrev_b32 v47, 14, v36
    v_bitop3_b32 v47, v47, v5, v99 bitop3:0xea
    ds_read_b64 v[100:101], v47
    v_and_b32 v46, 0x20000000, v39
    v_lshrrev_b32 v47, 14, v35
    v_bitop3_b32 v47, v47, v5, v46 bitop3:0xea
    ds_read_b64 v[106:107], v47
    v_and_b32 v99, 0x10000000, v39
    v_lshrrev_b32 v47, 14, v34
    v_bitop3_b32 v47, v47, v5, v99 bitop3:0xea
    ds_read_b64 v[104:105], v47
    s_waitcnt lgkmcnt(4)
    v_cmp_ne_u64 s[50:51], v[72:73], v[68:69]
    v_cmpx_ne_u64 s[54:55], v[74:75], v[70:71]
    s_and_b64 s[82:83], s[54:55], s[80:81]
    s_cbranch_scc1 L2_c130
L2_d130:
    v_mov_b64 v[84:85], v[70:71]
    v_mov_b32 v7, v95
    v_mov_b64 v[86:87], v[74:75]
    s_or_b64 s[80:81], s[80:81], s[54:55]
    s_mov_b64 exec, s[50:51]
    s_and_b64 s[82:83], s[50:51], s[80:81]
    s_cbranch_scc1 L2_c131
L2_d131:
    v_mov_b64 v[84:85], v[68:69]
    v_mov_b32 v7, v94
    v_mov_b64 v[86:87], v[72:73]
    s_mov_b64 exec, -1
    s_or_b64 s[80:81], s[80:81], s[50:51]
    s_and_b64 exec, s[48:49], s[80:81]
    v_mfma_f32_4x4x4_16b_bf16 v[80:83], v[12:13], v[84:85], 0
    v_mov_b32 v93, v7
    s_andn2_b64 s[80:81], s[80:81], s[48:49]
    v_mfma_f32_4x4x4_16b_bf16 v[80:83], v[10:11], v[86:87], v[80:83]
    s_mov_b64 exec, -1
    ds_read_b64 v[70:71], v93 offset:65408
    ds_read_b64 v[68:69], v92 offset:65408
    v_bitop3_b32 v94, v34, v5, v99 bitop3:0xea
    v_bitop3_b32 v95, v35, v5, v46 bitop3:0xea
    v_perm_b32 v15, v35, v38, s45
    v_bitop3_b32 v46, v35, 0.5, -0.5 bitop3:0xa8
    v_perm_b32 v14, v34, v38, s44
    v_bitop3_b32 v47, v34, 0.5, -0.5 bitop3:0xa8
    v_bitop3_b32 v15, v6, v15, v46 bitop3:0xca
    v_bitop3_b32 v14, v6, v14, v47 bitop3:0xca
    s_waitcnt lgkmcnt(1)
    v_mfma_f32_4x4x4_16b_bf16 v[80:83], v[10:11], v[70:71], v[80:83]
    s_waitcnt lgkmcnt(0)
    v_mfma_f32_4x4x4_16b_bf16 v[76:79], v[10:11], v[68:69], v[76:79]
    s_nop 2
    v_cvt_pk_bf16_f32 v80, v80, v81
    v_cvt_pk_bf16_f32 v81, v82, v83
    ds_wrxchg_rtn_b64 v[74:75], v93, v[80:81] offset:65408
    v_cvt_pk_bf16_f32 v76, v76, v77
    v_cvt_pk_bf16_f32 v77, v78, v79
    ds_wrxchg_rtn_b64 v[72:73], v92, v[76:77] offset:65408
    s_barrier
    s_setprio 3
    s_mov_b32 m0, s100
    s_nop 0
    ds_write_addtid_b32 v124 offset:34816
    ds_write_addtid_b32 v125 offset:35072
    ds_write_addtid_b32 v126 offset:35328
    ds_write_addtid_b32 v127 offset:35584
    ds_write_addtid_b32 v116 offset:32768
    ds_write_addtid_b32 v117 offset:33024
    ds_write_addtid_b32 v118 offset:33280
    ds_write_addtid_b32 v119 offset:33536
    ds_write_addtid_b32 v120 offset:33792
    ds_write_addtid_b32 v121 offset:34048
    ds_write_addtid_b32 v122 offset:34304
    ds_write_addtid_b32 v123 offset:34560
    v_mfma_f32_4x4x4_16b_bf16 v[80:83], v[8:9], v[106:107], 0
    v_mfma_f32_4x4x4_16b_bf16 v[76:79], v[8:9], v[104:105], 0
    s_nop 3
    v_pk_mul_f32 v[80:81], v[80:81], v[14:15] op_sel:[0,1] op_sel_hi:[1,1]
    v_pk_mul_f32 v[82:83], v[82:83], v[14:15] op_sel:[0,1] op_sel_hi:[1,1]
    v_pk_mul_f32 v[76:77], v[76:77], v[14:15] op_sel:[0,0] op_sel_hi:[1,0]
    v_pk_mul_f32 v[78:79], v[78:79], v[14:15] op_sel:[0,0] op_sel_hi:[1,0]
    s_setprio 2
    s_waitcnt lgkmcnt(12)
    v_cmp_ne_u64 s[50:51], v[72:73], v[68:69]
    v_cmpx_ne_u64 s[54:55], v[74:75], v[70:71]
    s_and_b64 s[82:83], s[54:55], s[80:81]
    s_cbranch_scc1 L2_c132
L2_d132:
    v_mov_b64 v[84:85], v[70:71]
    v_mov_b32 v7, v93
    v_mov_b64 v[86:87], v[74:75]
    s_or_b64 s[80:81], s[80:81], s[54:55]
    s_mov_b64 exec, s[50:51]
    s_and_b64 s[82:83], s[50:51], s[80:81]
    s_cbranch_scc1 L2_c133
L2_d133:
    v_mov_b64 v[84:85], v[68:69]
    v_mov_b32 v7, v92
    v_mov_b64 v[86:87], v[72:73]
    s_mov_b64 exec, -1
    s_or_b64 s[80:81], s[80:81], s[50:51]
    ds_read_b64 v[70:71], v95 offset:65408
    ds_read_b64 v[68:69], v94 offset:65408
    v_and_b32 v46, 0x40000000, v39
    v_bitop3_b32 v92, v36, v5, v46 bitop3:0xea
    v_and_b32 v46, 0x80000000, v39
    v_bitop3_b32 v93, v37, v5, v46 bitop3:0xea
    v_perm_b32 v15, v37, v38, s47
    v_bitop3_b32 v46, v37, 0.5, -0.5 bitop3:0xa8
    v_perm_b32 v14, v36, v38, s46
    v_bitop3_b32 v47, v36, 0.5, -0.5 bitop3:0xa8
    v_bitop3_b32 v15, v6, v15, v46 bitop3:0xca
    v_bitop3_b32 v14, v6, v14, v47 bitop3:0xca
    s_setprio 1
    s_waitcnt lgkmcnt(1)
    v_mfma_f32_4x4x4_16b_bf16 v[80:83], v[10:11], v[70:71], v[80:83]
    s_waitcnt lgkmcnt(0)
    v_mfma_f32_4x4x4_16b_bf16 v[76:79], v[10:11], v[68:69], v[76:79]
    s_nop 2
    v_cvt_pk_bf16_f32 v80, v80, v81
    v_cvt_pk_bf16_f32 v81, v82, v83
    ds_wrxchg_rtn_b64 v[74:75], v95, v[80:81] offset:65408
    v_cvt_pk_bf16_f32 v76, v76, v77
    v_cvt_pk_bf16_f32 v77, v78, v79
    ds_wrxchg_rtn_b64 v[72:73], v94, v[76:77] offset:65408
    v_and_b32 v88, 0x0fffffff, v43
    buffer_load_dwordx2 v[34:35], v88, s[8:11], 0 offen
    buffer_load_dwordx3 v[36:38], v88, s[8:11], 0 offen offset:8
    s_setprio 0
    s_waitcnt vmcnt(9)
    s_mov_b32 m0, s38
    s_nop 0
    ds_write_addtid_b32 v108 offset:0
    ds_write_addtid_b32 v109 offset:256
    ds_write_addtid_b32 v110 offset:512
    ds_write_addtid_b32 v111 offset:768
    s_waitcnt vmcnt(6)
    ds_write_addtid_b32 v112 offset:1024
    ds_write_addtid_b32 v113 offset:1280
    ds_write_addtid_b32 v114 offset:1536
    ds_write_addtid_b32 v115 offset:1792
    v_mfma_f32_4x4x4_16b_bf16 v[80:83], v[8:9], v[102:103], 0
    v_mfma_f32_4x4x4_16b_bf16 v[76:79], v[8:9], v[100:101], 0
    v_cmp_lt_u32 s[84:85], v5, v92
    s_nop 2
    v_pk_mul_f32 v[80:81], v[80:81], v[14:15] op_sel:[0,1] op_sel_hi:[1,1]
    v_pk_mul_f32 v[82:83], v[82:83], v[14:15] op_sel:[0,1] op_sel_hi:[1,1]
    v_pk_mul_f32 v[76:77], v[76:77], v[14:15] op_sel:[0,0] op_sel_hi:[1,0]
    v_pk_mul_f32 v[78:79], v[78:79], v[14:15] op_sel:[0,0] op_sel_hi:[1,0]
    s_add_u32 s42, s42, 1
    s_waitcnt lgkmcnt(0)
    s_barrier
    s_bitcmp1_b32 s36, s42
    s_cbranch_scc1 L2_slow
L2_ret7:
    s_setprio 3
    s_bitcmp1_b32 s43, s42
    s_cbranch_scc1 L2_oa134
L2_ob134:
    v_and_b32 v46, 0x20000000, v40
    v_lshrrev_b32 v47, 14, v17
    v_bitop3_b32 v47, v47, v5, v46 bitop3:0xea
    ds_read_b64 v[106:107], v47
    v_and_b32 v99, 0x10000000, v40
    v_lshrrev_b32 v47, 14, v16
    v_bitop3_b32 v47, v47, v5, v99 bitop3:0xea
    ds_read_b64 v[104:105], v47
    v_cmp_ne_u64 s[50:51], v[72:73], v[68:69]
    v_cmpx_ne_u64 s[54:55], v[74:75], v[70:71]
    s_and_b64 s[82:83], s[54:55], s[80:81]
    s_cbranch_scc1 L2_c135
L2_d135:
    v_mov_b64 v[84:85], v[70:71]
    v_mov_b32 v7, v95
    v_mov_b64 v[86:87], v[74:75]
    s_or_b64 s[80:81], s[80:81], s[54:55]
    s_mov_b64 exec, s[50:51]
    s_and_b64 s[82:83], s[50:51], s[80:81]
    s_cbranch_scc1 L2_c136
L2_d136:
    v_mov_b64 v[84:85], v[68:69]
    v_mov_b32 v7, v94
    v_mov_b64 v[86:87], v[72:73]
    s_mov_b64 exec, -1
    s_or_b64 s[80:81], s[80:81], s[50:51]
    s_and_b64 exec, s[84:85], s[80:81]
    v_mfma_f32_4x4x4_16b_bf16 v[76:79], v[12:13], v[84:85], 0
    v_mov_b32 v92, v7
    s_andn2_b64 s[80:81], s[80:81], s[84:85]
    v_mfma_f32_4x4x4_16b_bf16 v[76:79], v[10:11], v[86:87], v[76:79]
    s_mov_b64 exec, -1
    ds_read_b64 v[70:71], v93 offset:65408
    ds_read_b64 v[68:69], v92 offset:65408
    v_bitop3_b32 v94, v16, v5, v99 bitop3:0xea
    v_bitop3_b32 v95, v17, v5, v46 bitop3:0xea
    v_perm_b32 v15, v17, v20, s45
    v_bitop3_b32 v46, v17, 0.5, -0.5 bitop3:0xa8
    v_perm_b32 v14, v16, v20, s44
    v_bitop3_b32 v47, v16, 0.5, -0.5 bitop3:0xa8
    v_bitop3_b32 v15, v6, v15, v46 bitop3:0xca
    v_bitop3_b32 v14, v6, v14, v47 bitop3:0xca
    s_waitcnt lgkmcnt(1)
    v_mfma_f32_4x4x4_16b_bf16 v[80:83], v[10:11], v[70:71], v[80:83]
    s_waitcnt lgkmcnt(0)
    v_mfma_f32_4x4x4_16b_bf16 v[76:79], v[10:11], v[68:69], v[76:79]
    s_nop 2
    v_cvt_pk_bf16_f32 v80, v80, v81
    v_cvt_pk_bf16_f32 v81, v82, v83
    ds_wrxchg_rtn_b64 v[74:75], v93, v[80:81] offset:65408
    v_cvt_pk_bf16_f32 v76, v76, v77
    v_cvt_pk_bf16_f32 v77, v78, v79
    ds_wrxchg_rtn_b64 v[72:73], v92, v[76:77] offset:65408
    v_mfma_f32_4x4x4_16b_bf16 v[80:83], v[8:9], v[106:107], 0
    v_mfma_f32_4x4x4_16b_bf16 v[76:79], v[8:9], v[104:105], 0
    v_cmp_lt_u32 s[84:85], v5, v94
    s_nop 2
    v_pk_mul_f32 v[80:81], v[80:81], v[14:15] op_sel:[0,1] op_sel_hi:[1,1]
    v_pk_mul_f32 v[82:83], v[82:83], v[14:15] op_sel:[0,1] op_sel_hi:[1,1]
    v_pk_mul_f32 v[76:77], v[76:77], v[14:15] op_sel:[0,0] op_sel_hi:[1,0]
    v_pk_mul_f32 v[78:79], v[78:79], v[14:15] op_sel:[0,0] op_sel_hi:[1,0]
    v_and_b32 v46, 0x80000000, v40
    v_lshrrev_b32 v47, 14, v19
    v_bitop3_b32 v47, v47, v5, v46 bitop3:0xea
    ds_read_b64 v[102:103], v47
    v_and_b32 v99, 0x40000000, v40
    v_lshrrev_b32 v47, 14, v18
    v_bitop3_b32 v47, v47, v5, v99 bitop3:0xea
    ds_read_b64 v[100:101], v47
    s_waitcnt lgkmcnt(2)
    v_cmp_ne_u64 s[50:51], v[72:73], v[68:69]
    v_cmpx_ne_u64 s[54:55], v[74:75], v[70:71]
    s_and_b64 s[82:83], s[54:55], s[80:81]
    s_cbranch_scc1 L2_c137
L2_d137:
    v_mov_b64 v[84:85], v[70:71]
    v_mov_b32 v7, v93
    v_mov_b64 v[86:87], v[74:75]
    s_or_b64 s[80:81], s[80:81], s[54:55]
    s_mov_b64 exec, s[50:51]
    s_and_b64 s[82:83], s[50:51], s[80:81]
    s_cbranch_scc1 L2_c138
L2_d138:
    v_mov_b64 v[84:85], v[68:69]
    v_mov_b32 v7, v92
    v_mov_b64 v[86:87], v[72:73]
    s_mov_b64 exec, -1
    s_or_b64 s[80:81], s[80:81], s[50:51]
    s_and_b64 exec, s[84:85], s[80:81]
    v_mfma_f32_4x4x4_16b_bf16 v[76:79], v[12:13], v[84:85], 0
    v_mov_b32 v94, v7
    s_andn2_b64 s[80:81], s[80:81], s[84:85]
    v_mfma_f32_4x4x4_16b_bf16 v[76:79], v[10:11], v[86:87], v[76:79]
    s_mov_b64 exec, -1
    ds_read_b64 v[70:71], v95 offset:65408
    ds_read_b64 v[68:69], v94 offset:65408
    v_bitop3_b32 v92, v18, v5, v99 bitop3:0xea
    v_bitop3_b32 v93, v19, v5, v46 bitop3:0xea
    v_perm_b32 v15, v19, v20, s47
    v_bitop3_b32 v46, v19, 0.5, -0.5 bitop3:0xa8
    v_perm_b32 v14, v18, v20, s46
    v_bitop3_b32 v47, v18, 0.5, -0.5 bitop3:0xa8
    v_bitop3_b32 v15, v6, v15, v46 bitop3:0xca
    v_bitop3_b32 v14, v6, v14, v47 bitop3:0xca
    s_waitcnt lgkmcnt(1)
    v_mfma_f32_4x4x4_16b_bf16 v[80:83], v[10:11], v[70:71], v[80:83]
    s_waitcnt lgkmcnt(0)
    v_mfma_f32_4x4x4_16b_bf16 v[76:79], v[10:11], v[68:69], v[76:79]
    s_nop 2
    v_cvt_pk_bf16_f32 v80, v80, v81
    v_cvt_pk_bf16_f32 v81, v82, v83
    ds_wrxchg_rtn_b64 v[74:75], v95, v[80:81] offset:65408
    v_cvt_pk_bf16_f32 v76, v76, v77
    v_cvt_pk_bf16_f32 v77, v78, v79
    ds_wrxchg_rtn_b64 v[72:73], v94, v[76:77] offset:65408
    s_setprio 2
    v_mfma_f32_4x4x4_16b_bf16 v[80:83], v[8:9], v[102:103], 0
    v_mfma_f32_4x4x4_16b_bf16 v[76:79], v[8:9], v[100:101], 0
    v_cmp_lt_u32 s[48:49], v5, v93
    s_nop 2
    v_pk_mul_f32 v[80:81], v[80:81], v[14:15] op_sel:[0,1] op_sel_hi:[1,1]
    v_pk_mul_f32 v[82:83], v[82:83], v[14:15] op_sel:[0,1] op_sel_hi:[1,1]
    v_pk_mul_f32 v[76:77], v[76:77], v[14:15] op_sel:[0,0] op_sel_hi:[1,0]
    v_pk_mul_f32 v[78:79], v[78:79], v[14:15] op_sel:[0,0] op_sel_hi:[1,0]
    s_waitcnt vmcnt(4)
    v_and_b32 v46, 0x20000000, v41
    v_lshrrev_b32 v47, 14, v23
    v_bitop3_b32 v47, v47, v5, v46 bitop3:0xea
    ds_read_b64 v[106:107], v47
    v_and_b32 v99, 0x10000000, v41
    v_lshrrev_b32 v47, 14, v22
    v_bitop3_b32 v47, v47, v5, v99 bitop3:0xea
    ds_read_b64 v[104:105], v47
    s_waitcnt lgkmcnt(2)
    v_cmp_ne_u64 s[50:51], v[72:73], v[68:69]
    v_cmpx_ne_u64 s[54:55], v[74:75], v[70:71]
    s_and_b64 s[82:83], s[54:55], s[80:81]
    s_cbranch_scc1 L2_c139
L2_d139:
    v_mov_b64 v[84:85], v[70:71]
    v_mov_b32 v7, v95
    v_mov_b64 v[86:87], v[74:75]
    s_or_b64 s[80:81], s[80:81], s[54:55]
    s_mov_b64 exec, s[50:51]
    s_and_b64 s[82:83], s[50:51], s[80:81]
    s_cbranch_scc1 L2_c140
L2_d140:
    v_mov_b64 v[84:85], v[68:69]
    v_mov_b32 v7, v94
    v_mov_b64 v[86:87], v[72:73]
    s_mov_b64 exec, -1
    s_or_b64 s[80:81], s[80:81], s[50:51]
    s_and_b64 exec, s[48:49], s[80:81]
    v_mfma_f32_4x4x4_16b_bf16 v[80:83], v[12:13], v[84:85], 0
    v_mov_b32 v93, v7
    s_andn2_b64 s[80:81], s[80:81], s[48:49]
    v_mfma_f32_4x4x4_16b_bf16 v[80:83], v[10:11], v[86:87], v[80:83]
    s_mov_b64 exec, -1
    ds_read_b64 v[70:71], v93 offset:65408
    ds_read_b64 v[68:69], v92 offset:65408
    v_bitop3_b32 v94, v22, v5, v99 bitop3:0xea
    v_bitop3_b32 v95, v23, v5, v46 bitop3:0xea
    v_perm_b32 v15, v23, v26, s45
    v_bitop3_b32 v46, v23, 0.5, -0.5 bitop3:0xa8
    v_perm_b32 v14, v22, v26, s44
    v_bitop3_b32 v47, v22, 0.5, -0.5 bitop3:0xa8
    v_bitop3_b32 v15, v6, v15, v46 bitop3:0xca
    v_bitop3_b32 v14, v6, v14, v47 bitop3:0xca
    s_waitcnt lgkmcnt(1)
    v_mfma_f32_4x4x4_16b_bf16 v[80:83], v[10:11], v[70:71], v[80:83]
    s_waitcnt lgkmcnt(0)
    v_mfma_f32_4x4x4_16b_bf16 v[76:79], v[10:11], v[68:69], v[76:79]
    s_nop 2
    v_cvt_pk_bf16_f32 v80, v80, v81
    v_cvt_pk_bf16_f32 v81, v82, v83
    ds_wrxchg_rtn_b64 v[74:75], v93, v[80:81] offset:65408
    v_cvt_pk_bf16_f32 v76, v76, v77
    v_cvt_pk_bf16_f32 v77, v78, v79
    ds_wrxchg_rtn_b64 v[72:73], v92, v[76:77] offset:65408
    s_setprio 1
    v_mfma_f32_4x4x4_16b_bf16 v[80:83], v[8:9], v[106:107], 0
    v_mfma_f32_4x4x4_16b_bf16 v[76:79], v[8:9], v[104:105], 0
    s_nop 3
    v_pk_mul_f32 v[80:81], v[80:81], v[14:15] op_sel:[0,1] op_sel_hi:[1,1]
    v_pk_mul_f32 v[82:83], v[82:83], v[14:15] op_sel:[0,1] op_sel_hi:[1,1]
    v_pk_mul_f32 v[76:77], v[76:77], v[14:15] op_sel:[0,0] op_sel_hi:[1,0]
    v_pk_mul_f32 v[78:79], v[78:79], v[14:15] op_sel:[0,0] op_sel_hi:[1,0]
    s_bitcmp1_b32 s43, s42
    s_cbranch_scc1 L2_oa141
L2_ob141:
    v_and_b32 v46, 0x80000000, v41
    v_lshrrev_b32 v47, 14, v25
    v_bitop3_b32 v47, v47, v5, v46 bitop3:0xea
    ds_read_b64 v[102:103], v47
    v_and_b32 v99, 0x40000000, v41
    v_lshrrev_b32 v47, 14, v24
    v_bitop3_b32 v47, v47, v5, v99 bitop3:0xea
    ds_read_b64 v[100:101], v47
    s_waitcnt lgkmcnt(2)
    v_cmp_ne_u64 s[50:51], v[72:73], v[68:69]
    v_cmpx_ne_u64 s[54:55], v[74:75], v[70:71]
    s_and_b64 s[82:83], s[54:55], s[80:81]
    s_cbranch_scc1 L2_c142
L2_d142:
    v_mov_b64 v[84:85], v[70:71]
    v_mov_b32 v7, v93
    v_mov_b64 v[86:87], v[74:75]
    s_or_b64 s[80:81], s[80:81], s[54:55]
    s_mov_b64 exec, s[50:51]
    s_and_b64 s[82:83], s[50:51], s[80:81]
    s_cbranch_scc1 L2_c143
L2_d143:
    v_mov_b64 v[84:85], v[68:69]
    v_mov_b32 v7, v92
    v_mov_b64 v[86:87], v[72:73]
    s_mov_b64 exec, -1
    s_or_b64 s[80:81], s[80:81], s[50:51]
    ds_read_b64 v[70:71], v95 offset:65408
    ds_read_b64 v[68:69], v94 offset:65408
    v_bitop3_b32 v92, v24, v5, v99 bitop3:0xea
    v_bitop3_b32 v93, v25, v5, v46 bitop3:0xea
    v_perm_b32 v15, v25, v26, s47
    v_bitop3_b32 v46, v25, 0.5, -0.5 bitop3:0xa8
    v_perm_b32 v14, v24, v26, s46
    v_bitop3_b32 v47, v24, 0.5, -0.5 bitop3:0xa8
    v_bitop3_b32 v15, v6, v15, v46 bitop3:0xca
    v_bitop3_b32 v14, v6, v14, v47 bitop3:0xca
    s_waitcnt lgkmcnt(1)
    v_mfma_f32_4x4x4_16b_bf16 v[80:83], v[10:11], v[70:71], v[80:83]
    s_waitcnt lgkmcnt(0)
    v_mfma_f32_4x4x4_16b_bf16 v[76:79], v[10:11], v[68:69], v[76:79]
    s_nop 2
    v_cvt_pk_bf16_f32 v80, v80, v81
    v_cvt_pk_bf16_f32 v81, v82, v83
    ds_wrxchg_rtn_b64 v[74:75], v95, v[80:81] offset:65408
    v_cvt_pk_bf16_f32 v76, v76, v77
    v_cvt_pk_bf16_f32 v77, v78, v79
    ds_wrxchg_rtn_b64 v[72:73], v94, v[76:77] offset:65408
    v_mfma_f32_4x4x4_16b_bf16 v[80:83], v[8:9], v[102:103], 0
    v_mfma_f32_4x4x4_16b_bf16 v[76:79], v[8:9], v[100:101], 0
    v_cmp_lt_u32 s[84:85], v5, v92
    s_nop 2
    v_pk_mul_f32 v[80:81], v[80:81], v[14:15] op_sel:[0,1] op_sel_hi:[1,1]
    v_pk_mul_f32 v[82:83], v[82:83], v[14:15] op_sel:[0,1] op_sel_hi:[1,1]
    v_pk_mul_f32 v[76:77], v[76:77], v[14:15] op_sel:[0,0] op_sel_hi:[1,0]
    v_pk_mul_f32 v[78:79], v[78:79], v[14:15] op_sel:[0,0] op_sel_hi:[1,0]
    s_lshl_b32 s3, s32, 12
    v_subrev_u32 v122, s3, v3
    s_mul_i32 s3, s33, 20000
    v_add_u32 v118, s3, v122
    v_add_u32 v119, 0x4000, v118
    s_lshl_b32 s3, s34, 7
    v_lshrrev_b32 v123, 7, v118
    v_and_b32 v120, 0x70, v118
    v_lshl_add_u32 v120, v123, 13, v120
    v_add_u32 v120, s3, v120
    v_lshrrev_b32 v123, 7, v119
    v_and_b32 v121, 0x70, v119
    v_lshl_add_u32 v121, v123, 13, v121
    v_add_u32 v121, s3, v121
    v_cmp_le_u32 vcc, 3616, v122
    s_mov_b64 exec, vcc
    v_mov_b32 v119, 2.0
    v_mov_b32 v121, 2.0
    s_mov_b64 exec, -1
    v_and_b32 v123, 0x30, v122
    v_lshlrev_b32 v123, 2, v123
    buffer_load_dwordx4 v[48:51], v123, s[24:27], 0 offen
    buffer_load_dwordx4 v[52:55], v123, s[24:27], 0 offen offset:16
    buffer_load_dwordx2 v[56:57], v123, s[24:27], 0 offen offset:32
    s_mov_b32 s12, s4
    s_mov_b32 s13, s5
    s_mov_b32 s14, 0x138800
    s_mov_b32 s15, 0x20000
    s_mov_b32 s16, s28
    s_mov_b32 s17, s29
    s_mov_b32 s18, 0x4e2000
    s_mov_b32 s19, 0x20000
    v_lshrrev_b32 v123, 2, v120
    buffer_load_dword v116, v123, s[12:15], 0 offen
    buffer_load_dwordx4 v[108:111], v120, s[16:19], 0 offen
    v_lshrrev_b32 v123, 2, v121
    buffer_load_dword v117, v123, s[12:15], 0 offen
    buffer_load_dwordx4 v[112:115], v121, s[16:19], 0 offen
    s_waitcnt vmcnt(9)
    s_mov_b64 exec, s[6:7]
    v_lshrrev_b32 v30, 16, v30
    s_mov_b64 exec, -1
    v_and_b32 v46, 0x20000000, v42
    v_lshrrev_b32 v47, 14, v29
    v_bitop3_b32 v47, v47, v5, v46 bitop3:0xea
    ds_read_b64 v[106:107], v47
    v_and_b32 v99, 0x10000000, v42
    v_lshrrev_b32 v47, 14, v28
    v_bitop3_b32 v47, v47, v5, v99 bitop3:0xea
    ds_read_b64 v[104:105], v47
    s_waitcnt lgkmcnt(2)
    v_cmp_ne_u64 s[50:51], v[72:73], v[68:69]
    v_cmpx_ne_u64 s[54:55], v[74:75], v[70:71]
    s_and_b64 s[82:83], s[54:55], s[80:81]
    s_cbranch_scc1 L2_c144
L2_d144:
    v_mov_b64 v[84:85], v[70:71]
    v_mov_b32 v7, v95
    v_mov_b64 v[86:87], v[74:75]
    s_or_b64 s[80:81], s[80:81], s[54:55]
    s_mov_b64 exec, s[50:51]
    s_and_b64 s[82:83], s[50:51], s[80:81]
    s_cbranch_scc1 L2_c145
L2_d145:
    v_mov_b64 v[84:85], v[68:69]
    v_mov_b32 v7, v94
    v_mov_b64 v[86:87], v[72:73]
    s_mov_b64 exec, -1
    s_or_b64 s[80:81], s[80:81], s[50:51]
    s_and_b64 exec, s[84:85], s[80:81]
    v_mfma_f32_4x4x4_16b_bf16 v[76:79], v[12:13], v[84:85], 0
    v_mov_b32 v92, v7
    s_andn2_b64 s[80:81], s[80:81], s[84:85]
    v_mfma_f32_4x4x4_16b_bf16 v[76:79], v[10:11], v[86:87], v[76:79]
    s_mov_b64 exec, -1
    ds_read_b64 v[70:71], v93 offset:65408
    ds_read_b64 v[68:69], v92 offset:65408
    v_bitop3_b32 v94, v28, v5, v99 bitop3:0xea
    v_bitop3_b32 v95, v29, v5, v46 bitop3:0xea
    v_perm_b32 v15, v29, v30, s45
    v_bitop3_b32 v46, v29, 0.5, -0.5 bitop3:0xa8
    v_perm_b32 v14, v28, v30, s44
    v_bitop3_b32 v47, v28, 0.5, -0.5 bitop3:0xa8
    v_bitop3_b32 v15, v6, v15, v46 bitop3:0xca
    v_bitop3_b32 v14, v6, v14, v47 bitop3:0xca
    s_waitcnt lgkmcnt(1)
    v_mfma_f32_4x4x4_16b_bf16 v[80:83], v[10:11], v[70:71], v[80:83]
    s_waitcnt lgkmcnt(0)
    v_mfma_f32_4x4x4_16b_bf16 v[76:79], v[10:11], v[68:69], v[76:79]
    s_nop 2
    v_cvt_pk_bf16_f32 v80, v80, v81
    v_cvt_pk_bf16_f32 v81, v82, v83
    ds_wrxchg_rtn_b64 v[74:75], v93, v[80:81] offset:65408
    v_cvt_pk_bf16_f32 v76, v76, v77
    v_cvt_pk_bf16_f32 v77, v78, v79
    ds_wrxchg_rtn_b64 v[72:73], v92, v[76:77] offset:65408
    s_setprio 0
    v_mfma_f32_4x4x4_16b_bf16 v[80:83], v[8:9], v[106:107], 0
    v_mfma_f32_4x4x4_16b_bf16 v[76:79], v[8:9], v[104:105], 0
    v_cmp_lt_u32 s[48:49], v5, v95
    s_nop 2
    v_pk_mul_f32 v[80:81], v[80:81], v[14:15] op_sel:[0,1] op_sel_hi:[1,1]
    v_pk_mul_f32 v[82:83], v[82:83], v[14:15] op_sel:[0,1] op_sel_hi:[1,1]
    v_pk_mul_f32 v[76:77], v[76:77], v[14:15] op_sel:[0,0] op_sel_hi:[1,0]
    v_pk_mul_f32 v[78:79], v[78:79], v[14:15] op_sel:[0,0] op_sel_hi:[1,0]
    s_waitcnt vmcnt(7)
    v_and_b32 v46, 0x80000000, v43
    v_lshrrev_b32 v47, 14, v37
    v_bitop3_b32 v47, v47, v5, v46 bitop3:0xea
    ds_read_b64 v[106:107], v47
    v_and_b32 v99, 0x40000000, v43
    v_lshrrev_b32 v47, 14, v36
    v_bitop3_b32 v47, v47, v5, v99 bitop3:0xea
    ds_read_b64 v[104:105], v47
    v_and_b32 v46, 0x20000000, v43
    v_lshrrev_b32 v47, 14, v35
    v_bitop3_b32 v47, v47, v5, v46 bitop3:0xea
    ds_read_b64 v[102:103], v47
    v_and_b32 v99, 0x10000000, v43
    v_lshrrev_b32 v47, 14, v34
    v_bitop3_b32 v47, v47, v5, v99 bitop3:0xea
    ds_read_b64 v[100:101], v47
    s_waitcnt lgkmcnt(4)
    v_cmp_ne_u64 s[50:51], v[72:73], v[68:69]
    v_cmpx_ne_u64 s[54:55], v[74:75], v[70:71]
    s_and_b64 s[82:83], s[54:55], s[80:81]
    s_cbranch_scc1 L2_c146
L2_d146:
    v_mov_b64 v[84:85], v[70:71]
    v_mov_b32 v7, v93
    v_mov_b64 v[86:87], v[74:75]
    s_or_b64 s[80:81], s[80:81], s[54:55]
    s_mov_b64 exec, s[50:51]
    s_and_b64 s[82:83], s[50:51], s[80:81]
    s_cbranch_scc1 L2_c147
L2_d147:
    v_mov_b64 v[84:85], v[68:69]
    v_mov_b32 v7, v92
    v_mov_b64 v[86:87], v[72:73]
    s_mov_b64 exec, -1
    s_or_b64 s[80:81], s[80:81], s[50:51]
    s_and_b64 exec, s[48:49], s[80:81]
    v_mfma_f32_4x4x4_16b_bf16 v[80:83], v[12:13], v[84:85], 0
    v_mov_b32 v95, v7
    s_andn2_b64 s[80:81], s[80:81], s[48:49]
    v_mfma_f32_4x4x4_16b_bf16 v[80:83], v[10:11], v[86:87], v[80:83]
    s_mov_b64 exec, -1
    ds_read_b64 v[70:71], v95 offset:65408
    ds_read_b64 v[68:69], v94 offset:65408
    v_bitop3_b32 v92, v34, v5, v99 bitop3:0xea
    v_bitop3_b32 v93, v35, v5, v46 bitop3:0xea
    v_perm_b32 v15, v35, v38, s45
    v_bitop3_b32 v46, v35, 0.5, -0.5 bitop3:0xa8
    v_perm_b32 v14, v34, v38, s44
    v_bitop3_b32 v47, v34, 0.5, -0.5 bitop3:0xa8
    v_bitop3_b32 v15, v6, v15, v46 bitop3:0xca
    v_bitop3_b32 v14, v6, v14, v47 bitop3:0xca
    s_waitcnt lgkmcnt(1)
    v_mfma_f32_4x4x4_16b_bf16 v[80:83], v[10:11], v[70:71], v[80:83]
    s_waitcnt lgkmcnt(0)
    v_mfma_f32_4x4x4_16b_bf16 v[76:79], v[10:11], v[68:69], v[76:79]
    s_nop 2
    v_cvt_pk_bf16_f32 v80, v80, v81
    v_cvt_pk_bf16_f32 v81, v82, v83
    ds_wrxchg_rtn_b64 v[74:75], v95, v[80:81] offset:65408
    v_cvt_pk_bf16_f32 v76, v76, v77
    v_cvt_pk_bf16_f32 v77, v78, v79
    ds_wrxchg_rtn_b64 v[72:73], v94, v[76:77] offset:65408
    v_mfma_f32_4x4x4_16b_bf16 v[80:83], v[8:9], v[102:103], 0
    v_mfma_f32_4x4x4_16b_bf16 v[76:79], v[8:9], v[100:101], 0
    s_nop 3
    v_pk_mul_f32 v[80:81], v[80:81], v[14:15] op_sel:[0,1] op_sel_hi:[1,1]
    v_pk_mul_f32 v[82:83], v[82:83], v[14:15] op_sel:[0,1] op_sel_hi:[1,1]
    v_pk_mul_f32 v[76:77], v[76:77], v[14:15] op_sel:[0,0] op_sel_hi:[1,0]
    v_pk_mul_f32 v[78:79], v[78:79], v[14:15] op_sel:[0,0] op_sel_hi:[1,0]
    s_waitcnt lgkmcnt(0)
    v_cmp_ne_u64 s[50:51], v[72:73], v[68:69]
    v_cmpx_ne_u64 s[54:55], v[74:75], v[70:71]
    s_and_b64 s[82:83], s[54:55], s[80:81]
    s_cbranch_scc1 L2_c148
L2_d148:
    v_mov_b64 v[84:85], v[70:71]
    v_mov_b32 v7, v95
    v_mov_b64 v[86:87], v[74:75]
    s_or_b64 s[80:81], s[80:81], s[54:55]
    s_mov_b64 exec, s[50:51]
    s_and_b64 s[82:83], s[50:51], s[80:81]
    s_cbranch_scc1 L2_c149
L2_d149:
    v_mov_b64 v[84:85], v[68:69]
    v_mov_b32 v7, v94
    v_mov_b64 v[86:87], v[72:73]
    s_mov_b64 exec, -1
    s_or_b64 s[80:81], s[80:81], s[50:51]
    ds_read_b64 v[70:71], v93 offset:65408
    ds_read_b64 v[68:69], v92 offset:65408
    v_and_b32 v46, 0x40000000, v43
    v_bitop3_b32 v94, v36, v5, v46 bitop3:0xea
    v_and_b32 v46, 0x80000000, v43
    v_bitop3_b32 v95, v37, v5, v46 bitop3:0xea
    v_perm_b32 v15, v37, v38, s47
    v_bitop3_b32 v46, v37, 0.5, -0.5 bitop3:0xa8
    v_perm_b32 v14, v36, v38, s46
    v_bitop3_b32 v47, v36, 0.5, -0.5 bitop3:0xa8
    v_bitop3_b32 v15, v6, v15, v46 bitop3:0xca
    v_bitop3_b32 v14, v6, v14, v47 bitop3:0xca
    s_waitcnt lgkmcnt(1)
    v_mfma_f32_4x4x4_16b_bf16 v[80:83], v[10:11], v[70:71], v[80:83]
    s_waitcnt lgkmcnt(0)
    v_mfma_f32_4x4x4_16b_bf16 v[76:79], v[10:11], v[68:69], v[76:79]
    s_nop 2
    v_cvt_pk_bf16_f32 v80, v80, v81
    v_cvt_pk_bf16_f32 v81, v82, v83
    ds_wrxchg_rtn_b64 v[74:75], v93, v[80:81] offset:65408
    v_cvt_pk_bf16_f32 v76, v76, v77
    v_cvt_pk_bf16_f32 v77, v78, v79
    ds_wrxchg_rtn_b64 v[72:73], v92, v[76:77] offset:65408
    v_mfma_f32_4x4x4_16b_bf16 v[80:83], v[8:9], v[106:107], 0
    v_mfma_f32_4x4x4_16b_bf16 v[76:79], v[8:9], v[104:105], 0
    v_cmp_lt_u32 s[84:85], v5, v94
    s_nop 2
    v_pk_mul_f32 v[80:81], v[80:81], v[14:15] op_sel:[0,1] op_sel_hi:[1,1]
    v_pk_mul_f32 v[82:83], v[82:83], v[14:15] op_sel:[0,1] op_sel_hi:[1,1]
    v_pk_mul_f32 v[76:77], v[76:77], v[14:15] op_sel:[0,0] op_sel_hi:[1,0]
    v_pk_mul_f32 v[78:79], v[78:79], v[14:15] op_sel:[0,0] op_sel_hi:[1,0]
    s_waitcnt lgkmcnt(0)
    v_cmp_ne_u64 s[50:51], v[72:73], v[68:69]
    v_cmpx_ne_u64 s[54:55], v[74:75], v[70:71]
    s_and_b64 s[82:83], s[54:55], s[80:81]
    s_cbranch_scc1 L2_c150
L2_d150:
    v_mov_b64 v[84:85], v[70:71]
    v_mov_b32 v7, v93
    v_mov_b64 v[86:87], v[74:75]
    s_or_b64 s[80:81], s[80:81], s[54:55]
    s_mov_b64 exec, s[50:51]
    s_and_b64 s[82:83], s[50:51], s[80:81]
    s_cbranch_scc1 L2_c151
L2_d151:
    v_mov_b64 v[84:85], v[68:69]
    v_mov_b32 v7, v92
    v_mov_b64 v[86:87], v[72:73]
    s_mov_b64 exec, -1
    s_or_b64 s[80:81], s[80:81], s[50:51]
    s_and_b64 exec, s[84:85], s[80:81]
    v_mfma_f32_4x4x4_16b_bf16 v[76:79], v[12:13], v[84:85], 0
    v_mov_b32 v94, v7
    s_andn2_b64 s[80:81], s[80:81], s[84:85]
    v_mfma_f32_4x4x4_16b_bf16 v[76:79], v[10:11], v[86:87], v[76:79]
    s_mov_b64 exec, -1
    ds_read_b64 v[70:71], v95 offset:65408
    ds_read_b64 v[68:69], v94 offset:65408
    s_waitcnt lgkmcnt(1)
    v_mfma_f32_4x4x4_16b_bf16 v[80:83], v[10:11], v[70:71], v[80:83]
    s_waitcnt lgkmcnt(0)
    v_mfma_f32_4x4x4_16b_bf16 v[76:79], v[10:11], v[68:69], v[76:79]
    s_nop 2
    v_cvt_pk_bf16_f32 v80, v80, v81
    v_cvt_pk_bf16_f32 v81, v82, v83
    ds_wrxchg_rtn_b64 v[74:75], v95, v[80:81] offset:65408
    v_cvt_pk_bf16_f32 v76, v76, v77
    v_cvt_pk_bf16_f32 v77, v78, v79
    ds_wrxchg_rtn_b64 v[72:73], v94, v[76:77] offset:65408
    s_waitcnt lgkmcnt(0)
    v_cmpx_ne_u64 vcc, v[74:75], v[70:71]
    s_and_b64 s[82:83], vcc, s[80:81]
    s_cbranch_scc1 L2_c152
L2_d152:
    v_mov_b64 v[84:85], v[70:71]
    v_mov_b32 v7, v95
    v_mov_b64 v[86:87], v[74:75]
    s_mov_b64 exec, -1
    s_or_b64 s[80:81], s[80:81], vcc
    v_cmpx_ne_u64 vcc, v[72:73], v[68:69]
    s_and_b64 s[82:83], vcc, s[80:81]
    s_cbranch_scc1 L2_c153
L2_d153:
    v_mov_b64 v[84:85], v[68:69]
    v_mov_b32 v7, v94
    v_mov_b64 v[86:87], v[72:73]
    s_mov_b64 exec, -1
    s_or_b64 s[80:81], s[80:81], vcc
    s_mov_b64 exec, s[80:81]
    ds_read_b64 v[68:69], v7 offset:65408
    v_mfma_f32_4x4x4_16b_bf16 v[76:79], v[12:13], v[84:85], 0
    s_nop 1
    v_mfma_f32_4x4x4_16b_bf16 v[76:79], v[10:11], v[86:87], v[76:79]
    s_waitcnt lgkmcnt(0)
    s_nop 0
    v_mfma_f32_4x4x4_16b_bf16 v[76:79], v[10:11], v[68:69], v[76:79]
    v_mov_b64 v[84:85], v[68:69]
    s_nop 3
    v_cvt_pk_bf16_f32 v76, v76, v77
    v_cvt_pk_bf16_f32 v77, v78, v79
    ds_wrxchg_rtn_b64 v[86:87], v7, v[76:77] offset:65408
    s_waitcnt lgkmcnt(0)
    v_cmp_ne_u64 s[80:81], v[86:87], v[84:85]
    s_mov_b64 exec, s[80:81]
    s_nop 1
    v_mfma_f32_4x4x4_16b_bf16 v[88:91], v[12:13], v[84:85], 0
    s_nop 1
    v_mfma_f32_4x4x4_16b_bf16 v[88:91], v[10:11], v[86:87], v[88:91]
    s_nop 4
    v_cvt_pk_bf16_f32 v88, v88, v89
    v_cvt_pk_bf16_f32 v89, v90, v91
    ds_pk_add_bf16 v7, v88 offset:65408
    ds_pk_add_bf16 v7, v89 offset:65412
    s_mov_b64 exec, -1
    s_load_dwordx2 s[4:5], s[0:1], 88
    v_add_u32 v123, 0x4000, v122
    s_lshl_b32 s50, s96, 16
    s_and_b32 s51, s96, 0xffff0000
    s_lshl_b32 s52, s97, 16
    s_and_b32 s53, s97, 0xffff0000
    s_lshl_b32 s54, s98, 16
    s_and_b32 s55, s98, 0xffff0000
    s_lshl_b32 s56, s99, 16
    s_and_b32 s57, s99, 0xffff0000
    s_waitcnt vmcnt(0) lgkmcnt(0)
    s_barrier
    s_add_u32 s8, s30, 0xec55000
    s_addc_u32 s9, s31, 0
    s_mov_b32 s10, 0x8000
    s_mov_b32 s11, 0x20000
    s_mov_b32 s12, s4
    s_mov_b32 s13, s5
    s_mov_b32 s14, 0x4e2000
    s_mov_b32 s15, 0x20000
    s_add_u32 s20, s30, 0xd854000
    s_addc_u32 s21, s31, 0
    s_mov_b32 s22, 0x1400000
    s_mov_b32 s23, 0x20000
    s_lshl2_add_u32 s4, s34, s33
    s_mul_i32 s4, s4, 81920
    s_add_u32 s3, s33, 1
    s_and_b32 s3, s3, 3
    s_mul_i32 s36, s3, 20000
    s_add_u32 s36, s36, 81920
    s_mul_i32 s40, s3, 20480
    s_add_u32 s40, s40, s4
    s_lshl2_add_u32 s3, s34, s3
    s_mul_i32 s3, s3, 81920
    s_mul_i32 s44, s33, 20480
    s_add_u32 s44, s44, s3
    s_add_u32 s3, s33, 2
    s_and_b32 s3, s3, 3
    s_mul_i32 s37, s3, 20000
    s_add_u32 s37, s37, 81920
    s_mul_i32 s41, s3, 20480
    s_add_u32 s41, s41, s4
    s_lshl2_add_u32 s3, s34, s3
    s_mul_i32 s3, s3, 81920
    s_mul_i32 s45, s33, 20480
    s_add_u32 s45, s45, s3
    s_add_u32 s3, s33, 3
    s_and_b32 s3, s3, 3
    s_mul_i32 s38, s3, 20000
    s_add_u32 s38, s38, 81920
    s_mul_i32 s42, s3, 20480
    s_add_u32 s42, s42, s4
    s_lshl2_add_u32 s3, s34, s3
    s_mul_i32 s3, s3, 81920
    s_mul_i32 s46, s33, 20480
    s_add_u32 s46, s46, s3
    v_add_u32 v104, s36, v122
    ds_read_b128 v[16:19], v104
    v_add_u32 v104, s37, v122
    ds_read_b128 v[20:23], v104
    v_add_u32 v104, s38, v122
    ds_read_b128 v[24:27], v104
    s_waitcnt lgkmcnt(2)
    buffer_store_dwordx4 v[16:19], v122, s[20:23], s40 offen sc1
    s_waitcnt lgkmcnt(1)
    buffer_store_dwordx4 v[20:23], v122, s[20:23], s41 offen sc1
    s_waitcnt lgkmcnt(0)
    buffer_store_dwordx4 v[24:27], v122, s[20:23], s42 offen sc1
    s_cmp_ge_u32 s32, 4
    s_cbranch_scc1 L2_g0
    v_add_u32 v104, s36, v123
    ds_read_b128 v[36:39], v104
    v_add_u32 v104, s37, v123
    ds_read_b128 v[40:43], v104
    v_add_u32 v104, s38, v123
    ds_read_b128 v[44:47], v104
    s_waitcnt lgkmcnt(2)
    buffer_store_dwordx4 v[36:39], v123, s[20:23], s40 offen sc1
    s_waitcnt lgkmcnt(1)
    buffer_store_dwordx4 v[40:43], v123, s[20:23], s41 offen sc1
    s_waitcnt lgkmcnt(0)
    buffer_store_dwordx4 v[44:47], v123, s[20:23], s42 offen sc1
L2_g0:
    v_lshlrev_b32 v80, 16, v116
    v_subrev_f32 v60, s50, v80
    v_subrev_f32 v61, s51, v80
    v_subrev_f32 v62, s52, v80
    v_subrev_f32 v63, s53, v80
    v_subrev_f32 v64, s54, v80
    v_subrev_f32 v65, s55, v80
    v_subrev_f32 v66, s56, v80
    v_subrev_f32 v67, s57, v80
    v_cvt_pk_bf16_f32 v68, v60, v61
    v_cvt_pk_bf16_f32 v69, v62, v63
    v_cvt_pk_bf16_f32 v70, v64, v65
    v_cvt_pk_bf16_f32 v71, v66, v67
    v_lshlrev_b32 v60, 16, v68
    v_and_b32 v61, 0xffff0000, v68
    v_lshlrev_b32 v62, 16, v69
    v_and_b32 v63, 0xffff0000, v69
    v_lshlrev_b32 v64, 16, v70
    v_and_b32 v65, 0xffff0000, v70
    v_lshlrev_b32 v66, 16, v71
    v_and_b32 v67, 0xffff0000, v71
    v_mul_f32 v60, v60, v60
    v_mul_f32 v61, v61, v61
    v_mul_f32 v62, v62, v62
    v_mul_f32 v63, v63, v63
    v_mul_f32 v64, v64, v64
    v_mul_f32 v65, v65, v65
    v_mul_f32 v66, v66, v66
    v_mul_f32 v67, v67, v67
    v_cvt_pk_bf16_f32 v68, v60, v61
    v_cvt_pk_bf16_f32 v69, v62, v63
    v_cvt_pk_bf16_f32 v70, v64, v65
    v_cvt_pk_bf16_f32 v71, v66, v67
    v_lshlrev_b32 v60, 16, v68
    v_and_b32 v61, 0xffff0000, v68
    v_lshlrev_b32 v62, 16, v69
    v_and_b32 v63, 0xffff0000, v69
    v_lshlrev_b32 v64, 16, v70
    v_and_b32 v65, 0xffff0000, v70
    v_lshlrev_b32 v66, 16, v71
    v_and_b32 v67, 0xffff0000, v71
    v_mul_f32 v60, 0xc1200000, v60
    v_mul_f32 v61, 0xc1200000, v61
    v_mul_f32 v62, 0xc1200000, v62
    v_mul_f32 v63, 0xc1200000, v63
    v_mul_f32 v64, 0xc1200000, v64
    v_mul_f32 v65, 0xc1200000, v65
    v_mul_f32 v66, 0xc1200000, v66
    v_mul_f32 v67, 0xc1200000, v67
    v_cvt_pk_bf16_f32 v68, v60, v61
    v_cvt_pk_bf16_f32 v69, v62, v63
    v_cvt_pk_bf16_f32 v70, v64, v65
    v_cvt_pk_bf16_f32 v71, v66, v67
    v_lshlrev_b32 v60, 16, v68
    v_and_b32 v61, 0xffff0000, v68
    v_lshlrev_b32 v62, 16, v69
    v_and_b32 v63, 0xffff0000, v69
    v_lshlrev_b32 v64, 16, v70
    v_and_b32 v65, 0xffff0000, v70
    v_lshlrev_b32 v66, 16, v71
    v_and_b32 v67, 0xffff0000, v71
    v_mul_f32 v60, 0x3fb8aa3b, v60
    v_mul_f32 v61, 0x3fb8aa3b, v61
    v_mul_f32 v62, 0x3fb8aa3b, v62
    v_mul_f32 v63, 0x3fb8aa3b, v63
    v_mul_f32 v64, 0x3fb8aa3b, v64
    v_mul_f32 v65, 0x3fb8aa3b, v65
    v_mul_f32 v66, 0x3fb8aa3b, v66
    v_mul_f32 v67, 0x3fb8aa3b, v67
    v_exp_f32 v60, v60
    v_exp_f32 v61, v61
    v_exp_f32 v62, v62
    v_exp_f32 v63, v63
    v_exp_f32 v64, v64
    v_exp_f32 v65, v65
    v_exp_f32 v66, v66
    v_exp_f32 v67, v67
    v_cvt_pk_bf16_f32 v72, v60, v61
    v_cvt_pk_bf16_f32 v73, v62, v63
    v_cvt_pk_bf16_f32 v74, v64, v65
    v_cvt_pk_bf16_f32 v75, v66, v67
    v_and_b32 v84, 0xffff0000, v116
    v_subrev_f32 v60, s50, v84
    v_subrev_f32 v61, s51, v84
    v_subrev_f32 v62, s52, v84
    v_subrev_f32 v63, s53, v84
    v_subrev_f32 v64, s54, v84
    v_subrev_f32 v65, s55, v84
    v_subrev_f32 v66, s56, v84
    v_subrev_f32 v67, s57, v84
    v_cvt_pk_bf16_f32 v68, v60, v61
    v_cvt_pk_bf16_f32 v69, v62, v63
    v_cvt_pk_bf16_f32 v70, v64, v65
    v_cvt_pk_bf16_f32 v71, v66, v67
    v_lshlrev_b32 v60, 16, v68
    v_and_b32 v61, 0xffff0000, v68
    v_lshlrev_b32 v62, 16, v69
    v_and_b32 v63, 0xffff0000, v69
    v_lshlrev_b32 v64, 16, v70
    v_and_b32 v65, 0xffff0000, v70
    v_lshlrev_b32 v66, 16, v71
    v_and_b32 v67, 0xffff0000, v71
    v_mul_f32 v60, v60, v60
    v_mul_f32 v61, v61, v61
    v_mul_f32 v62, v62, v62
    v_mul_f32 v63, v63, v63
    v_mul_f32 v64, v64, v64
    v_mul_f32 v65, v65, v65
    v_mul_f32 v66, v66, v66
    v_mul_f32 v67, v67, v67
    v_cvt_pk_bf16_f32 v68, v60, v61
    v_cvt_pk_bf16_f32 v69, v62, v63
    v_cvt_pk_bf16_f32 v70, v64, v65
    v_cvt_pk_bf16_f32 v71, v66, v67
    v_lshlrev_b32 v60, 16, v68
    v_and_b32 v61, 0xffff0000, v68
    v_lshlrev_b32 v62, 16, v69
    v_and_b32 v63, 0xffff0000, v69
    v_lshlrev_b32 v64, 16, v70
    v_and_b32 v65, 0xffff0000, v70
    v_lshlrev_b32 v66, 16, v71
    v_and_b32 v67, 0xffff0000, v71
    v_mul_f32 v60, 0xc1200000, v60
    v_mul_f32 v61, 0xc1200000, v61
    v_mul_f32 v62, 0xc1200000, v62
    v_mul_f32 v63, 0xc1200000, v63
    v_mul_f32 v64, 0xc1200000, v64
    v_mul_f32 v65, 0xc1200000, v65
    v_mul_f32 v66, 0xc1200000, v66
    v_mul_f32 v67, 0xc1200000, v67
    v_cvt_pk_bf16_f32 v68, v60, v61
    v_cvt_pk_bf16_f32 v69, v62, v63
    v_cvt_pk_bf16_f32 v70, v64, v65
    v_cvt_pk_bf16_f32 v71, v66, v67
    v_lshlrev_b32 v60, 16, v68
    v_and_b32 v61, 0xffff0000, v68
    v_lshlrev_b32 v62, 16, v69
    v_and_b32 v63, 0xffff0000, v69
    v_lshlrev_b32 v64, 16, v70
    v_and_b32 v65, 0xffff0000, v70
    v_lshlrev_b32 v66, 16, v71
    v_and_b32 v67, 0xffff0000, v71
    v_mul_f32 v60, 0x3fb8aa3b, v60
    v_mul_f32 v61, 0x3fb8aa3b, v61
    v_mul_f32 v62, 0x3fb8aa3b, v62
    v_mul_f32 v63, 0x3fb8aa3b, v63
    v_mul_f32 v64, 0x3fb8aa3b, v64
    v_mul_f32 v65, 0x3fb8aa3b, v65
    v_mul_f32 v66, 0x3fb8aa3b, v66
    v_mul_f32 v67, 0x3fb8aa3b, v67
    v_exp_f32 v60, v60
    v_exp_f32 v61, v61
    v_exp_f32 v62, v62
    v_exp_f32 v63, v63
    v_exp_f32 v64, v64
    v_exp_f32 v65, v65
    v_exp_f32 v66, v66
    v_exp_f32 v67, v67
    v_cvt_pk_bf16_f32 v76, v60, v61
    v_cvt_pk_bf16_f32 v77, v62, v63
    v_cvt_pk_bf16_f32 v78, v64, v65
    v_cvt_pk_bf16_f32 v79, v66, v67
    v_mfma_f32_4x4x4_16b_bf16 v[80:83], v[48:49], v[72:73], 0
    v_mfma_f32_4x4x4_16b_bf16 v[88:91], v[52:53], v[72:73], 0
    v_mfma_f32_4x4x4_16b_bf16 v[84:87], v[48:49], v[76:77], 0
    v_mfma_f32_4x4x4_16b_bf16 v[92:95], v[52:53], v[76:77], 0
    v_mfma_f32_4x4x4_16b_bf16 v[80:83], v[50:51], v[74:75], v[80:83]
    v_mfma_f32_4x4x4_16b_bf16 v[88:91], v[54:55], v[74:75], v[88:91]
    v_mfma_f32_4x4x4_16b_bf16 v[84:87], v[50:51], v[78:79], v[84:87]
    v_mfma_f32_4x4x4_16b_bf16 v[92:95], v[54:55], v[78:79], v[92:95]
    s_lshl_b32 s3, s34, 9
    s_lshl_b32 s4, s33, 7
    s_add_u32 s4, s4, s3
    v_mov_b32 v104, 1
    v_and_b32 v105, 0x3f0, v122
    v_lshlrev_b32 v105, 3, v105
    v_add_u32 v106, 81920, v118
    ds_read_b128 v[32:35], v106
    v_add_u32 v106, 81920, v119
    ds_read_b128 v[60:63], v106
    s_waitcnt vmcnt(0)
    s_barrier
    s_cmp_lg_u32 s32, 0
    s_cbranch_scc1 L2_f2
    s_mov_b64 exec, 1
    buffer_store_dword v104, off, s[8:11], s4 sc1
    s_mov_b64 exec, 15
    s_bitset0_b64 exec, s33
L2_f3:
    buffer_load_dword v104, v105, s[8:11], s3 offen sc1
    s_waitcnt vmcnt(0)
    v_cmp_ne_u32 vcc, 1, v104
    s_cbranch_vccnz L2_f3s
    s_mov_b64 exec, -1
L2_f2:
    s_barrier
    buffer_load_dwordx4 v[36:39], v122, s[20:23], s44 offen sc1
    buffer_load_dwordx4 v[40:43], v122, s[20:23], s45 offen sc1
    buffer_load_dwordx4 v[44:47], v122, s[20:23], s46 offen sc1
    s_cmp_ge_u32 s32, 4
    s_cbranch_scc1 L2_f5
    buffer_load_dwordx4 v[64:67], v123, s[20:23], s44 offen sc1
    buffer_load_dwordx4 v[68:71], v123, s[20:23], s45 offen sc1
    buffer_load_dwordx4 v[72:75], v123, s[20:23], s46 offen sc1
    v_lshlrev_b32 v16, 16, v117
    v_subrev_f32 v96, s50, v16
    v_subrev_f32 v97, s51, v16
    v_subrev_f32 v98, s52, v16
    v_subrev_f32 v99, s53, v16
    v_subrev_f32 v100, s54, v16
    v_subrev_f32 v101, s55, v16
    v_subrev_f32 v102, s56, v16
    v_subrev_f32 v103, s57, v16
    v_cvt_pk_bf16_f32 v0, v96, v97
    v_cvt_pk_bf16_f32 v1, v98, v99
    v_cvt_pk_bf16_f32 v2, v100, v101
    v_cvt_pk_bf16_f32 v3, v102, v103
    v_lshlrev_b32 v96, 16, v0
    v_and_b32 v97, 0xffff0000, v0
    v_lshlrev_b32 v98, 16, v1
    v_and_b32 v99, 0xffff0000, v1
    v_lshlrev_b32 v100, 16, v2
    v_and_b32 v101, 0xffff0000, v2
    v_lshlrev_b32 v102, 16, v3
    v_and_b32 v103, 0xffff0000, v3
    v_mul_f32 v96, v96, v96
    v_mul_f32 v97, v97, v97
    v_mul_f32 v98, v98, v98
    v_mul_f32 v99, v99, v99
    v_mul_f32 v100, v100, v100
    v_mul_f32 v101, v101, v101
    v_mul_f32 v102, v102, v102
    v_mul_f32 v103, v103, v103
    v_cvt_pk_bf16_f32 v0, v96, v97
    v_cvt_pk_bf16_f32 v1, v98, v99
    v_cvt_pk_bf16_f32 v2, v100, v101
    v_cvt_pk_bf16_f32 v3, v102, v103
    v_lshlrev_b32 v96, 16, v0
    v_and_b32 v97, 0xffff0000, v0
    v_lshlrev_b32 v98, 16, v1
    v_and_b32 v99, 0xffff0000, v1
    v_lshlrev_b32 v100, 16, v2
    v_and_b32 v101, 0xffff0000, v2
    v_lshlrev_b32 v102, 16, v3
    v_and_b32 v103, 0xffff0000, v3
    v_mul_f32 v96, 0xc1200000, v96
    v_mul_f32 v97, 0xc1200000, v97
    v_mul_f32 v98, 0xc1200000, v98
    v_mul_f32 v99, 0xc1200000, v99
    v_mul_f32 v100, 0xc1200000, v100
    v_mul_f32 v101, 0xc1200000, v101
    v_mul_f32 v102, 0xc1200000, v102
    v_mul_f32 v103, 0xc1200000, v103
    v_cvt_pk_bf16_f32 v0, v96, v97
    v_cvt_pk_bf16_f32 v1, v98, v99
    v_cvt_pk_bf16_f32 v2, v100, v101
    v_cvt_pk_bf16_f32 v3, v102, v103
    v_lshlrev_b32 v96, 16, v0
    v_and_b32 v97, 0xffff0000, v0
    v_lshlrev_b32 v98, 16, v1
    v_and_b32 v99, 0xffff0000, v1
    v_lshlrev_b32 v100, 16, v2
    v_and_b32 v101, 0xffff0000, v2
    v_lshlrev_b32 v102, 16, v3
    v_and_b32 v103, 0xffff0000, v3
    v_mul_f32 v96, 0x3fb8aa3b, v96
    v_mul_f32 v97, 0x3fb8aa3b, v97
    v_mul_f32 v98, 0x3fb8aa3b, v98
    v_mul_f32 v99, 0x3fb8aa3b, v99
    v_mul_f32 v100, 0x3fb8aa3b, v100
    v_mul_f32 v101, 0x3fb8aa3b, v101
    v_mul_f32 v102, 0x3fb8aa3b, v102
    v_mul_f32 v103, 0x3fb8aa3b, v103
    v_exp_f32 v96, v96
    v_exp_f32 v97, v97
    v_exp_f32 v98, v98
    v_exp_f32 v99, v99
    v_exp_f32 v100, v100
    v_exp_f32 v101, v101
    v_exp_f32 v102, v102
    v_exp_f32 v103, v103
    v_cvt_pk_bf16_f32 v104, v96, v97
    v_cvt_pk_bf16_f32 v105, v98, v99
    v_cvt_pk_bf16_f32 v106, v100, v101
    v_cvt_pk_bf16_f32 v107, v102, v103
    v_and_b32 v20, 0xffff0000, v117
    v_subrev_f32 v96, s50, v20
    v_subrev_f32 v97, s51, v20
    v_subrev_f32 v98, s52, v20
    v_subrev_f32 v99, s53, v20
    v_subrev_f32 v100, s54, v20
    v_subrev_f32 v101, s55, v20
    v_subrev_f32 v102, s56, v20
    v_subrev_f32 v103, s57, v20
    v_cvt_pk_bf16_f32 v0, v96, v97
    v_cvt_pk_bf16_f32 v1, v98, v99
    v_cvt_pk_bf16_f32 v2, v100, v101
    v_cvt_pk_bf16_f32 v3, v102, v103
    v_lshlrev_b32 v96, 16, v0
    v_and_b32 v97, 0xffff0000, v0
    v_lshlrev_b32 v98, 16, v1
    v_and_b32 v99, 0xffff0000, v1
    v_lshlrev_b32 v100, 16, v2
    v_and_b32 v101, 0xffff0000, v2
    v_lshlrev_b32 v102, 16, v3
    v_and_b32 v103, 0xffff0000, v3
    v_mul_f32 v96, v96, v96
    v_mul_f32 v97, v97, v97
    v_mul_f32 v98, v98, v98
    v_mul_f32 v99, v99, v99
    v_mul_f32 v100, v100, v100
    v_mul_f32 v101, v101, v101
    v_mul_f32 v102, v102, v102
    v_mul_f32 v103, v103, v103
    v_cvt_pk_bf16_f32 v0, v96, v97
    v_cvt_pk_bf16_f32 v1, v98, v99
    v_cvt_pk_bf16_f32 v2, v100, v101
    v_cvt_pk_bf16_f32 v3, v102, v103
    v_lshlrev_b32 v96, 16, v0
    v_and_b32 v97, 0xffff0000, v0
    v_lshlrev_b32 v98, 16, v1
    v_and_b32 v99, 0xffff0000, v1
    v_lshlrev_b32 v100, 16, v2
    v_and_b32 v101, 0xffff0000, v2
    v_lshlrev_b32 v102, 16, v3
    v_and_b32 v103, 0xffff0000, v3
    v_mul_f32 v96, 0xc1200000, v96
    v_mul_f32 v97, 0xc1200000, v97
    v_mul_f32 v98, 0xc1200000, v98
    v_mul_f32 v99, 0xc1200000, v99
    v_mul_f32 v100, 0xc1200000, v100
    v_mul_f32 v101, 0xc1200000, v101
    v_mul_f32 v102, 0xc1200000, v102
    v_mul_f32 v103, 0xc1200000, v103
    v_cvt_pk_bf16_f32 v0, v96, v97
    v_cvt_pk_bf16_f32 v1, v98, v99
    v_cvt_pk_bf16_f32 v2, v100, v101
    v_cvt_pk_bf16_f32 v3, v102, v103
    v_lshlrev_b32 v96, 16, v0
    v_and_b32 v97, 0xffff0000, v0
    v_lshlrev_b32 v98, 16, v1
    v_and_b32 v99, 0xffff0000, v1
    v_lshlrev_b32 v100, 16, v2
    v_and_b32 v101, 0xffff0000, v2
    v_lshlrev_b32 v102, 16, v3
    v_and_b32 v103, 0xffff0000, v3
    v_mul_f32 v96, 0x3fb8aa3b, v96
    v_mul_f32 v97, 0x3fb8aa3b, v97
    v_mul_f32 v98, 0x3fb8aa3b, v98
    v_mul_f32 v99, 0x3fb8aa3b, v99
    v_mul_f32 v100, 0x3fb8aa3b, v100
    v_mul_f32 v101, 0x3fb8aa3b, v101
    v_mul_f32 v102, 0x3fb8aa3b, v102
    v_mul_f32 v103, 0x3fb8aa3b, v103
    v_exp_f32 v96, v96
    v_exp_f32 v97, v97
    v_exp_f32 v98, v98
    v_exp_f32 v99, v99
    v_exp_f32 v100, v100
    v_exp_f32 v101, v101
    v_exp_f32 v102, v102
    v_exp_f32 v103, v103
    v_cvt_pk_bf16_f32 v76, v96, v97
    v_cvt_pk_bf16_f32 v77, v98, v99
    v_cvt_pk_bf16_f32 v78, v100, v101
    v_cvt_pk_bf16_f32 v79, v102, v103
    v_mfma_f32_4x4x4_16b_bf16 v[16:19], v[48:49], v[104:105], 0
    v_mfma_f32_4x4x4_16b_bf16 v[24:27], v[52:53], v[104:105], 0
    v_mfma_f32_4x4x4_16b_bf16 v[20:23], v[48:49], v[76:77], 0
    v_mfma_f32_4x4x4_16b_bf16 v[28:31], v[52:53], v[76:77], 0
    v_mfma_f32_4x4x4_16b_bf16 v[16:19], v[50:51], v[106:107], v[16:19]
    v_mfma_f32_4x4x4_16b_bf16 v[24:27], v[54:55], v[106:107], v[24:27]
    v_mfma_f32_4x4x4_16b_bf16 v[20:23], v[50:51], v[78:79], v[20:23]
    v_mfma_f32_4x4x4_16b_bf16 v[28:31], v[54:55], v[78:79], v[28:31]
L2_f5:
    s_waitcnt vmcnt(0) lgkmcnt(0)
    v_mfma_f32_4x4x4_16b_bf16 v[96:99], v[10:11], v[32:33], 0
    v_mfma_f32_4x4x4_16b_bf16 v[100:103], v[10:11], v[34:35], 0
    s_nop 0
    v_mfma_f32_4x4x4_16b_bf16 v[96:99], v[10:11], v[36:37], v[96:99]
    v_mfma_f32_4x4x4_16b_bf16 v[100:103], v[10:11], v[38:39], v[100:103]
    s_nop 0
    v_mfma_f32_4x4x4_16b_bf16 v[96:99], v[10:11], v[40:41], v[96:99]
    v_mfma_f32_4x4x4_16b_bf16 v[100:103], v[10:11], v[42:43], v[100:103]
    s_nop 0
    v_mfma_f32_4x4x4_16b_bf16 v[96:99], v[10:11], v[44:45], v[96:99]
    v_mfma_f32_4x4x4_16b_bf16 v[100:103], v[10:11], v[46:47], v[100:103]
    s_nop 3
    v_mul_f32 v96, v96, v80
    v_mul_f32 v97, v97, v81
    v_mul_f32 v98, v98, v82
    v_mul_f32 v99, v99, v83
    v_cvt_pk_bf16_f32 v32, v96, v97
    v_cvt_pk_bf16_f32 v33, v98, v99
    v_mul_f32 v100, v100, v84
    v_mul_f32 v101, v101, v85
    v_mul_f32 v102, v102, v86
    v_mul_f32 v103, v103, v87
    v_cvt_pk_bf16_f32 v34, v100, v101
    v_cvt_pk_bf16_f32 v35, v102, v103
    v_mfma_f32_4x4x4_16b_bf16 v[80:83], v[56:57], v[32:33], 0
    s_nop 0
    v_mfma_f32_4x4x4_16b_bf16 v[84:87], v[56:57], v[34:35], 0
    s_nop 2
    v_mul_f32 v80, v80, v88
    v_mul_f32 v81, v81, v89
    v_mul_f32 v82, v82, v90
    v_mul_f32 v83, v83, v91
    v_mul_f32 v84, v84, v92
    v_mul_f32 v85, v85, v93
    v_mul_f32 v86, v86, v94
    v_mul_f32 v87, v87, v95
    v_mfma_f32_4x4x4_16b_bf16 v[96:99], v[10:11], v[108:109], v[80:83]
    s_nop 0
    v_mfma_f32_4x4x4_16b_bf16 v[100:103], v[10:11], v[110:111], v[84:87]
    s_nop 2
    v_cvt_pk_bf16_f32 v36, v96, v97
    v_cvt_pk_bf16_f32 v37, v98, v99
    v_cvt_pk_bf16_f32 v38, v100, v101
    v_cvt_pk_bf16_f32 v39, v102, v103
    buffer_store_dwordx4 v[36:39], v120, s[12:15], 0 offen nt
    s_cmp_ge_u32 s32, 4
    s_cbranch_scc1 L2_f6
    v_mfma_f32_4x4x4_16b_bf16 v[96:99], v[10:11], v[60:61], 0
    v_mfma_f32_4x4x4_16b_bf16 v[100:103], v[10:11], v[62:63], 0
    s_nop 0
    v_mfma_f32_4x4x4_16b_bf16 v[96:99], v[10:11], v[64:65], v[96:99]
    v_mfma_f32_4x4x4_16b_bf16 v[100:103], v[10:11], v[66:67], v[100:103]
    s_nop 0
    v_mfma_f32_4x4x4_16b_bf16 v[96:99], v[10:11], v[68:69], v[96:99]
    v_mfma_f32_4x4x4_16b_bf16 v[100:103], v[10:11], v[70:71], v[100:103]
    s_nop 0
    v_mfma_f32_4x4x4_16b_bf16 v[96:99], v[10:11], v[72:73], v[96:99]
    v_mfma_f32_4x4x4_16b_bf16 v[100:103], v[10:11], v[74:75], v[100:103]
    s_nop 3
    v_mul_f32 v96, v96, v16
    v_mul_f32 v97, v97, v17
    v_mul_f32 v98, v98, v18
    v_mul_f32 v99, v99, v19
    v_cvt_pk_bf16_f32 v60, v96, v97
    v_cvt_pk_bf16_f32 v61, v98, v99
    v_mul_f32 v100, v100, v20
    v_mul_f32 v101, v101, v21
    v_mul_f32 v102, v102, v22
    v_mul_f32 v103, v103, v23
    v_cvt_pk_bf16_f32 v62, v100, v101
    v_cvt_pk_bf16_f32 v63, v102, v103
    v_mfma_f32_4x4x4_16b_bf16 v[16:19], v[56:57], v[60:61], 0
    s_nop 0
    v_mfma_f32_4x4x4_16b_bf16 v[20:23], v[56:57], v[62:63], 0
    s_nop 2
    v_mul_f32 v16, v16, v24
    v_mul_f32 v17, v17, v25
    v_mul_f32 v18, v18, v26
    v_mul_f32 v19, v19, v27
    v_mul_f32 v20, v20, v28
    v_mul_f32 v21, v21, v29
    v_mul_f32 v22, v22, v30
    v_mul_f32 v23, v23, v31
    v_mfma_f32_4x4x4_16b_bf16 v[96:99], v[10:11], v[112:113], v[16:19]
    s_nop 0
    v_mfma_f32_4x4x4_16b_bf16 v[100:103], v[10:11], v[114:115], v[20:23]
    s_nop 2
    v_cvt_pk_bf16_f32 v64, v96, v97
    v_cvt_pk_bf16_f32 v65, v98, v99
    v_cvt_pk_bf16_f32 v66, v100, v101
    v_cvt_pk_bf16_f32 v67, v102, v103
    buffer_store_dwordx4 v[64:67], v121, s[12:15], 0 offen nt
L2_f6:
L2_end:
    s_endpgm
L2_slow:
    s_lshr_b32 s35, s42, 2
    s_lshl_b32 s50, s32, 4
    s_and_b32 s3, s42, 3
    s_lshl_b32 s53, s3, 3
    s_add_u32 s53, s53, s39
    s_and_b32 s3, s35, 2
    s_lshl_b32 s3, s3, 1
    s_add_u32 s53, s53, s3
    s_and_b32 s54, s35, 1
    s_lshl_b32 s54, s54, 4
L2_sl_seg:
    s_mul_i32 s55, s50, 173056
    s_and_b32 s3, s50, 3
    s_lshl_b32 s3, s3, 5
    s_add_u32 s3, s3, s55
    s_add_u32 s3, s3, s53
    buffer_load_dword v104, off, s[12:15], s3 sc1
    buffer_load_dword v105, off, s[12:15], s3 offset:32 sc1
    s_waitcnt vmcnt(0)
    v_readfirstlane_b32 s51, v104
    v_readfirstlane_b32 s52, v105
    s_lshr_b32 s51, s51, s54
    s_and_b32 s51, s51, 0xffff
    s_lshr_b32 s52, s52, s54
    s_and_b32 s52, s52, 0xffff
L2_sl_rec:
    s_cmp_ge_u32 s51, s52
    s_cbranch_scc1 L2_sl_next
    v_mbcnt_lo_u32_b32 v102, -1, 0
    v_mbcnt_hi_u32_b32 v102, -1, v102
    v_add_u32 v102, s51, v102
    v_and_b32 v103, -4, v102
    v_lshl_add_u32 v104, v102, 2, v103
    v_lshl_add_u32 v105, v103, 2, v102
    v_cmp_gt_u32 vcc, s52, v102
    s_mov_b64 exec, vcc
    buffer_load_dword v106, v104, s[8:11], s55 offen
    buffer_load_ubyte v107, v105, s[8:11], s55 offen offset:16
    s_waitcnt vmcnt(0)
    v_lshrrev_b32 v98, 14, v106
    v_and_b32 v98, v5, v98
    ds_read_b64 v[100:101], v98
    v_perm_b32 v97, v106, v107, s44
    v_and_b32 v96, v5, v106
    v_bitop3_b32 v103, v106, 0.5, -0.5 bitop3:0xa8
    v_bitop3_b32 v97, v6, v97, v103 bitop3:0xca
    s_waitcnt lgkmcnt(0)
    v_mfma_f32_4x4x4_16b_bf16 v[88:91], v[8:9], v[100:101], 0
    s_nop 4
    v_mul_f32 v88, v97, v88
    v_mul_f32 v89, v97, v89
    v_mul_f32 v90, v97, v90
    v_mul_f32 v91, v97, v91
    v_cvt_pk_bf16_f32 v88, v88, v89
    v_cvt_pk_bf16_f32 v89, v90, v91
    ds_pk_add_bf16 v96, v88 offset:65408
    ds_pk_add_bf16 v96, v89 offset:65412
    s_mov_b64 exec, -1
    s_add_u32 s51, s51, 64
    s_branch L2_sl_rec
L2_sl_next:
    s_add_u32 s50, s50, 1
    s_and_b32 s3, s50, 15
    s_cbranch_scc1 L2_sl_seg
    s_add_u32 s50, s50, 240
    s_cmp_lt_u32 s50, 1280
    s_cbranch_scc1 L2_sl_seg
    s_waitcnt lgkmcnt(0)
    s_cmp_eq_u32 s42, 0
    s_cbranch_scc1 L2_ret0
    s_cmp_eq_u32 s42, 1
    s_cbranch_scc1 L2_ret1
    s_cmp_eq_u32 s42, 14
    s_cbranch_scc1 L2_ret6
    s_cmp_eq_u32 s42, 15
    s_cbranch_scc1 L2_ret7
    s_and_b32 s3, s42, 3
    s_cmp_eq_u32 s3, 2
    s_cbranch_scc1 L2_ret2
    s_cmp_eq_u32 s3, 3
    s_cbranch_scc1 L2_ret3
    s_cmp_eq_u32 s3, 0
    s_cbranch_scc1 L2_ret4
    s_branch L2_ret5
L2_xo3:
    v_cmp_lt_u32 vcc, 20, v99
    s_mov_b32 s101, 1
    s_cbranch_vccz L2_xp3
    v_cmp_lt_u32 vcc, 32, v99
    v_cmp_lt_u32 s[58:59], 31, v88
    s_mov_b32 s101, 2
    s_or_b64 vcc, vcc, s[58:59]
    s_cbranch_scc0 L2_xp3
    s_mov_b32 s37, 0x10000
    s_branch L2_xp3
L2_xa4:
    s_cmp_eq_u32 s101, 1
    s_cbranch_scc1 L2_xc4
    v_lshlrev_b32 v89, 0, v96
    v_add_u32 v90, 140, v97
    v_bitop3_b32 v90, v89, v45, v90 bitop3:0x6a
    ds_write_b32 v98, v90 offset:28
    v_lshlrev_b32 v89, 4, v96
    v_add_u32 v90, 120, v97
    v_bitop3_b32 v90, v89, v45, v90 bitop3:0x6a
    ds_write_b32 v98, v90 offset:24
    v_lshlrev_b32 v89, 8, v96
    v_add_u32 v90, 100, v97
    v_bitop3_b32 v90, v89, v45, v90 bitop3:0x6a
    ds_write_b32 v98, v90 offset:20
L2_xc4:
    v_lshlrev_b32 v89, 12, v96
    v_add_u32 v90, 80, v97
    v_bitop3_b32 v90, v89, v45, v90 bitop3:0x6a
    ds_write_b32 v98, v90 offset:16
    s_branch L2_xb4
L2_xe4:
    v_cmp_lt_u32 vcc, 32, v99
    v_cmp_lt_u32 s[58:59], 31, v88
    v_lshrrev_b32 v89, 16, v96
    v_add_u32 v97, 80, v97
    s_or_b64 vcc, vcc, s[58:59]
    s_cbranch_scc1 L2_xs4
    v_lshlrev_b32 v89, v1, v89
    v_and_b32 v89, v45, v89
    v_cmp_ne_u32 vcc, 0, v89
    v_xor_b32 v90, v97, v89
    s_add_u32 s3, s37, s38
    v_mbcnt_lo_u32_b32 v98, vcc_lo, 0
    v_mbcnt_hi_u32_b32 v98, vcc_hi, v98
    s_bcnt1_i32_b64 s41, vcc
    v_lshl_add_u32 v98, v98, 2, s3
    s_lshl2_add_u32 s37, s41, s37
    s_mov_b64 exec, vcc
    ds_write_b32 v98, v90
    s_mov_b64 exec, -1
    s_branch L2_xr4
L2_xs4:
    s_waitcnt lgkmcnt(0)
    s_mov_b32 s37, 0x10000
    s_branch L2_xw4
L2_xf4:
    s_cmp_gt_u32 s37, 1024
    s_cbranch_scc1 L2_xt4
    s_cmp_lt_u32 s37, 768
    s_cbranch_scc1 L2_xl4
    ds_read_b32 v32, v44 offset:896
    s_add_u32 s3, s42, 0
    s_bitset1_b32 s43, s3
    s_branch L2_xg4
L2_xl4:
    s_waitcnt lgkmcnt(0)
    v_mov_b32 v31, -1
    s_cmp_ge_u32 s37, 512
    s_cbranch_scc1 L2_xg4
    v_mov_b32 v39, -1
    s_cmp_ge_u32 s37, 256
    s_cbranch_scc1 L2_xg4
    v_mov_b32 v27, -1
    s_branch L2_xg4
L2_xt4:
    s_waitcnt lgkmcnt(0)
    v_mov_b32 v21, -1
    v_mov_b32 v27, -1
    v_mov_b32 v39, -1
    v_mov_b32 v31, -1
    s_add_u32 s3, s42, 0
    s_bitset1_b32 s36, s3
    s_branch L2_xg4
L2_xo5:
    v_cmp_lt_u32 vcc, 20, v99
    s_mov_b32 s101, 1
    s_cbranch_vccz L2_xp5
    v_cmp_lt_u32 vcc, 32, v99
    v_cmp_lt_u32 s[58:59], 31, v88
    s_mov_b32 s101, 2
    s_or_b64 vcc, vcc, s[58:59]
    s_cbranch_scc0 L2_xp5
    s_mov_b32 s37, 0x10000
    s_branch L2_xp5
L2_xa6:
    s_cmp_eq_u32 s101, 1
    s_cbranch_scc1 L2_xc6
    v_lshlrev_b32 v89, 0, v96
    v_add_u32 v90, 140, v97
    v_bitop3_b32 v90, v89, v45, v90 bitop3:0x6a
    ds_write_b32 v98, v90 offset:28
    v_lshlrev_b32 v89, 4, v96
    v_add_u32 v90, 120, v97
    v_bitop3_b32 v90, v89, v45, v90 bitop3:0x6a
    ds_write_b32 v98, v90 offset:24
    v_lshlrev_b32 v89, 8, v96
    v_add_u32 v90, 100, v97
    v_bitop3_b32 v90, v89, v45, v90 bitop3:0x6a
    ds_write_b32 v98, v90 offset:20
L2_xc6:
    v_lshlrev_b32 v89, 12, v96
    v_add_u32 v90, 80, v97
    v_bitop3_b32 v90, v89, v45, v90 bitop3:0x6a
    ds_write_b32 v98, v90 offset:16
    s_branch L2_xb6
L2_xe6:
    v_cmp_lt_u32 vcc, 32, v99
    v_cmp_lt_u32 s[58:59], 31, v88
    v_lshrrev_b32 v89, 16, v96
    v_add_u32 v97, 80, v97
    s_or_b64 vcc, vcc, s[58:59]
    s_cbranch_scc1 L2_xs6
    v_lshlrev_b32 v89, v1, v89
    v_and_b32 v89, v45, v89
    v_cmp_ne_u32 vcc, 0, v89
    v_xor_b32 v90, v97, v89
    s_add_u32 s3, s37, s38
    v_mbcnt_lo_u32_b32 v98, vcc_lo, 0
    v_mbcnt_hi_u32_b32 v98, vcc_hi, v98
    s_bcnt1_i32_b64 s41, vcc
    v_lshl_add_u32 v98, v98, 2, s3
    s_lshl2_add_u32 s37, s41, s37
    s_mov_b64 exec, vcc
    ds_write_b32 v98, v90
    s_mov_b64 exec, -1
    s_branch L2_xr6
L2_xs6:
    s_waitcnt lgkmcnt(0)
    s_mov_b32 s37, 0x10000
    s_branch L2_xw6
L2_xf6:
    s_cmp_gt_u32 s37, 1024
    s_cbranch_scc1 L2_xt6
    s_cmp_lt_u32 s37, 768
    s_cbranch_scc1 L2_xl6
    ds_read_b32 v33, v44 offset:896
    s_add_u32 s3, s42, 1
    s_bitset1_b32 s43, s3
    s_branch L2_xg6
L2_xl6:
    s_waitcnt lgkmcnt(0)
    v_mov_b32 v42, -1
    s_cmp_ge_u32 s37, 512
    s_cbranch_scc1 L2_xg6
    v_mov_b32 v43, -1
    s_cmp_ge_u32 s37, 256
    s_cbranch_scc1 L2_xg6
    v_mov_b32 v41, -1
    s_branch L2_xg6
L2_xt6:
    s_waitcnt lgkmcnt(0)
    v_mov_b32 v40, -1
    v_mov_b32 v41, -1
    v_mov_b32 v43, -1
    v_mov_b32 v42, -1
    s_add_u32 s3, s42, 1
    s_bitset1_b32 s36, s3
    s_branch L2_xg6
L2_oa7:
    v_and_b32 v47, 0x0fffffff, v32
    buffer_load_dword v78, v47, s[8:11], 0 offen offset:16
    s_mov_b64 exec, s[6:7]
    v_add_u32 v47, 8, v47
    v_lshrrev_b32 v32, 2, v32
    s_mov_b64 exec, -1
    buffer_load_dwordx2 v[76:77], v47, s[8:11], 0 offen
    s_branch L2_ob7
L2_oa8:
    s_waitcnt vmcnt(0)
    s_mov_b64 exec, s[6:7]
    v_lshrrev_b32 v78, 16, v78
    s_mov_b64 exec, -1
    v_and_b32 v46, 0x10000000, v32
    v_cmpx_eq_u32 vcc, 0, v46
    v_lshrrev_b32 v47, 14, v76
    v_and_b32 v47, v5, v47
    ds_read_b64 v[96:97], v47
    v_perm_b32 v98, v76, v78, s44
    v_bitop3_b32 v99, v76, 0.5, -0.5 bitop3:0xa8
    v_bitop3_b32 v98, v6, v98, v99 bitop3:0xca
    v_and_b32 v47, v5, v76
    s_waitcnt lgkmcnt(0)
    v_mfma_f32_4x4x4_16b_bf16 v[88:91], v[8:9], v[96:97], 0
    s_nop 4
    v_mul_f32 v88, v98, v88
    v_mul_f32 v89, v98, v89
    v_mul_f32 v90, v98, v90
    v_mul_f32 v91, v98, v91
    v_cvt_pk_bf16_f32 v88, v88, v89
    v_cvt_pk_bf16_f32 v89, v90, v91
    ds_pk_add_bf16 v47, v88 offset:65408
    ds_pk_add_bf16 v47, v89 offset:65412
    s_mov_b64 exec, -1
    v_and_b32 v46, 0x20000000, v32
    v_cmpx_eq_u32 vcc, 0, v46
    v_lshrrev_b32 v47, 14, v77
    v_and_b32 v47, v5, v47
    ds_read_b64 v[96:97], v47
    v_perm_b32 v98, v77, v78, s45
    v_bitop3_b32 v99, v77, 0.5, -0.5 bitop3:0xa8
    v_bitop3_b32 v98, v6, v98, v99 bitop3:0xca
    v_and_b32 v47, v5, v77
    s_waitcnt lgkmcnt(0)
    v_mfma_f32_4x4x4_16b_bf16 v[88:91], v[8:9], v[96:97], 0
    s_nop 4
    v_mul_f32 v88, v98, v88
    v_mul_f32 v89, v98, v89
    v_mul_f32 v90, v98, v90
    v_mul_f32 v91, v98, v91
    v_cvt_pk_bf16_f32 v88, v88, v89
    v_cvt_pk_bf16_f32 v89, v90, v91
    ds_pk_add_bf16 v47, v88 offset:65408
    ds_pk_add_bf16 v47, v89 offset:65412
    s_mov_b64 exec, -1
    s_branch L2_ob8
L2_c9:
    s_lshl_b64 s[52:53], s[82:83], 1
    s_andn2_b64 s[52:53], s[52:53], s[80:81]
    s_andn2_b64 s[52:53], s[52:53], s[54:55]
    s_or_b64 s[80:81], s[80:81], s[52:53]
    s_not_b64 vcc, s[52:53]
    s_mov_b64 exec, -1
    v_cndmask_b32_dpp v84, v84, v84, vcc wave_shr:1 row_mask:0xf bank_mask:0xf
    v_cndmask_b32_dpp v85, v85, v85, vcc wave_shr:1 row_mask:0xf bank_mask:0xf
    s_lshr_b64 s[52:53], s[52:53], 1
    v_cndmask_b32_dpp v86, v86, v86, vcc wave_shr:1 row_mask:0xf bank_mask:0xf
    v_cndmask_b32_dpp v87, v87, v87, vcc wave_shr:1 row_mask:0xf bank_mask:0xf
    s_andn2_b64 s[82:83], s[82:83], s[52:53]
    v_cndmask_b32_dpp v7, v7, v7, vcc wave_shr:1 row_mask:0xf bank_mask:0xf
    s_mov_b64 exec, s[54:55]
    s_cbranch_scc0 L2_d9
    s_mov_b64 exec, s[82:83]
    s_nop 1
    v_mfma_f32_4x4x4_16b_bf16 v[88:91], v[12:13], v[84:85], 0
    s_nop 1
    v_mfma_f32_4x4x4_16b_bf16 v[88:91], v[10:11], v[86:87], v[88:91]
    s_nop 4
    v_cvt_pk_bf16_f32 v88, v88, v89
    v_cvt_pk_bf16_f32 v89, v90, v91
    ds_pk_add_bf16 v7, v88 offset:65408
    ds_pk_add_bf16 v7, v89 offset:65412
    s_mov_b64 exec, s[54:55]
    s_branch L2_d9
L2_c10:
    s_lshl_b64 s[52:53], s[82:83], 1
    s_andn2_b64 s[52:53], s[52:53], s[80:81]
    s_andn2_b64 s[52:53], s[52:53], s[50:51]
    s_or_b64 s[80:81], s[80:81], s[52:53]
    s_not_b64 vcc, s[52:53]
    s_mov_b64 exec, -1
    v_cndmask_b32_dpp v84, v84, v84, vcc wave_shr:1 row_mask:0xf bank_mask:0xf
    v_cndmask_b32_dpp v85, v85, v85, vcc wave_shr:1 row_mask:0xf bank_mask:0xf
    s_lshr_b64 s[52:53], s[52:53], 1
    v_cndmask_b32_dpp v86, v86, v86, vcc wave_shr:1 row_mask:0xf bank_mask:0xf
    v_cndmask_b32_dpp v87, v87, v87, vcc wave_shr:1 row_mask:0xf bank_mask:0xf
    s_andn2_b64 s[82:83], s[82:83], s[52:53]
    v_cndmask_b32_dpp v7, v7, v7, vcc wave_shr:1 row_mask:0xf bank_mask:0xf
    s_mov_b64 exec, s[50:51]
    s_cbranch_scc0 L2_d10
    s_mov_b64 exec, s[82:83]
    s_nop 1
    v_mfma_f32_4x4x4_16b_bf16 v[88:91], v[12:13], v[84:85], 0
    s_nop 1
    v_mfma_f32_4x4x4_16b_bf16 v[88:91], v[10:11], v[86:87], v[88:91]
    s_nop 4
    v_cvt_pk_bf16_f32 v88, v88, v89
    v_cvt_pk_bf16_f32 v89, v90, v91
    ds_pk_add_bf16 v7, v88 offset:65408
    ds_pk_add_bf16 v7, v89 offset:65412
    s_mov_b64 exec, s[50:51]
    s_branch L2_d10
L2_c13:
    s_lshl_b64 s[52:53], s[82:83], 1
    s_andn2_b64 s[52:53], s[52:53], s[80:81]
    s_andn2_b64 s[52:53], s[52:53], s[54:55]
    s_or_b64 s[80:81], s[80:81], s[52:53]
    s_not_b64 vcc, s[52:53]
    s_mov_b64 exec, -1
    v_cndmask_b32_dpp v84, v84, v84, vcc wave_shr:1 row_mask:0xf bank_mask:0xf
    v_cndmask_b32_dpp v85, v85, v85, vcc wave_shr:1 row_mask:0xf bank_mask:0xf
    s_lshr_b64 s[52:53], s[52:53], 1
    v_cndmask_b32_dpp v86, v86, v86, vcc wave_shr:1 row_mask:0xf bank_mask:0xf
    v_cndmask_b32_dpp v87, v87, v87, vcc wave_shr:1 row_mask:0xf bank_mask:0xf
    s_andn2_b64 s[82:83], s[82:83], s[52:53]
    v_cndmask_b32_dpp v7, v7, v7, vcc wave_shr:1 row_mask:0xf bank_mask:0xf
    s_mov_b64 exec, s[54:55]
    s_cbranch_scc0 L2_d13
    s_mov_b64 exec, s[82:83]
    s_nop 1
    v_mfma_f32_4x4x4_16b_bf16 v[88:91], v[12:13], v[84:85], 0
    s_nop 1
    v_mfma_f32_4x4x4_16b_bf16 v[88:91], v[10:11], v[86:87], v[88:91]
    s_nop 4
    v_cvt_pk_bf16_f32 v88, v88, v89
    v_cvt_pk_bf16_f32 v89, v90, v91
    ds_pk_add_bf16 v7, v88 offset:65408
    ds_pk_add_bf16 v7, v89 offset:65412
    s_mov_b64 exec, s[54:55]
    s_branch L2_d13
L2_c14:
    s_lshl_b64 s[52:53], s[82:83], 1
    s_andn2_b64 s[52:53], s[52:53], s[80:81]
    s_andn2_b64 s[52:53], s[52:53], s[50:51]
    s_or_b64 s[80:81], s[80:81], s[52:53]
    s_not_b64 vcc, s[52:53]
    s_mov_b64 exec, -1
    v_cndmask_b32_dpp v84, v84, v84, vcc wave_shr:1 row_mask:0xf bank_mask:0xf
    v_cndmask_b32_dpp v85, v85, v85, vcc wave_shr:1 row_mask:0xf bank_mask:0xf
    s_lshr_b64 s[52:53], s[52:53], 1
    v_cndmask_b32_dpp v86, v86, v86, vcc wave_shr:1 row_mask:0xf bank_mask:0xf
    v_cndmask_b32_dpp v87, v87, v87, vcc wave_shr:1 row_mask:0xf bank_mask:0xf
    s_andn2_b64 s[82:83], s[82:83], s[52:53]
    v_cndmask_b32_dpp v7, v7, v7, vcc wave_shr:1 row_mask:0xf bank_mask:0xf
    s_mov_b64 exec, s[50:51]
    s_cbranch_scc0 L2_d14
    s_mov_b64 exec, s[82:83]
    s_nop 1
    v_mfma_f32_4x4x4_16b_bf16 v[88:91], v[12:13], v[84:85], 0
    s_nop 1
    v_mfma_f32_4x4x4_16b_bf16 v[88:91], v[10:11], v[86:87], v[88:91]
    s_nop 4
    v_cvt_pk_bf16_f32 v88, v88, v89
    v_cvt_pk_bf16_f32 v89, v90, v91
    ds_pk_add_bf16 v7, v88 offset:65408
    ds_pk_add_bf16 v7, v89 offset:65412
    s_mov_b64 exec, s[50:51]
    s_branch L2_d14
L2_xo16:
    v_cmp_lt_u32 vcc, 20, v99
    s_mov_b32 s101, 1
    s_cbranch_vccz L2_xp16
    v_cmp_lt_u32 vcc, 32, v99
    v_cmp_lt_u32 s[58:59], 31, v88
    s_mov_b32 s101, 2
    s_or_b64 vcc, vcc, s[58:59]
    s_cbranch_scc0 L2_xp16
    s_mov_b32 s37, 0x10000
    s_branch L2_xp16
L2_c17:
    s_lshl_b64 s[52:53], s[82:83], 1
    s_andn2_b64 s[52:53], s[52:53], s[80:81]
    s_andn2_b64 s[52:53], s[52:53], s[54:55]
    s_or_b64 s[80:81], s[80:81], s[52:53]
    s_not_b64 vcc, s[52:53]
    s_mov_b64 exec, -1
    v_cndmask_b32_dpp v84, v84, v84, vcc wave_shr:1 row_mask:0xf bank_mask:0xf
    v_cndmask_b32_dpp v85, v85, v85, vcc wave_shr:1 row_mask:0xf bank_mask:0xf
    s_lshr_b64 s[52:53], s[52:53], 1
    v_cndmask_b32_dpp v86, v86, v86, vcc wave_shr:1 row_mask:0xf bank_mask:0xf
    v_cndmask_b32_dpp v87, v87, v87, vcc wave_shr:1 row_mask:0xf bank_mask:0xf
    s_andn2_b64 s[82:83], s[82:83], s[52:53]
    v_cndmask_b32_dpp v7, v7, v7, vcc wave_shr:1 row_mask:0xf bank_mask:0xf
    s_mov_b64 exec, s[54:55]
    s_cbranch_scc0 L2_d17
    s_mov_b64 exec, s[82:83]
    s_nop 1
    v_mfma_f32_4x4x4_16b_bf16 v[88:91], v[12:13], v[84:85], 0
    s_nop 1
    v_mfma_f32_4x4x4_16b_bf16 v[88:91], v[10:11], v[86:87], v[88:91]
    s_nop 4
    v_cvt_pk_bf16_f32 v88, v88, v89
    v_cvt_pk_bf16_f32 v89, v90, v91
    ds_pk_add_bf16 v7, v88 offset:65408
    ds_pk_add_bf16 v7, v89 offset:65412
    s_mov_b64 exec, s[54:55]
    s_branch L2_d17
L2_c18:
    s_lshl_b64 s[52:53], s[82:83], 1
    s_andn2_b64 s[52:53], s[52:53], s[80:81]
    s_andn2_b64 s[52:53], s[52:53], s[50:51]
    s_or_b64 s[80:81], s[80:81], s[52:53]
    s_not_b64 vcc, s[52:53]
    s_mov_b64 exec, -1
    v_cndmask_b32_dpp v84, v84, v84, vcc wave_shr:1 row_mask:0xf bank_mask:0xf
    v_cndmask_b32_dpp v85, v85, v85, vcc wave_shr:1 row_mask:0xf bank_mask:0xf
    s_lshr_b64 s[52:53], s[52:53], 1
    v_cndmask_b32_dpp v86, v86, v86, vcc wave_shr:1 row_mask:0xf bank_mask:0xf
    v_cndmask_b32_dpp v87, v87, v87, vcc wave_shr:1 row_mask:0xf bank_mask:0xf
    s_andn2_b64 s[82:83], s[82:83], s[52:53]
    v_cndmask_b32_dpp v7, v7, v7, vcc wave_shr:1 row_mask:0xf bank_mask:0xf
    s_mov_b64 exec, s[50:51]
    s_cbranch_scc0 L2_d18
    s_mov_b64 exec, s[82:83]
    s_nop 1
    v_mfma_f32_4x4x4_16b_bf16 v[88:91], v[12:13], v[84:85], 0
    s_nop 1
    v_mfma_f32_4x4x4_16b_bf16 v[88:91], v[10:11], v[86:87], v[88:91]
    s_nop 4
    v_cvt_pk_bf16_f32 v88, v88, v89
    v_cvt_pk_bf16_f32 v89, v90, v91
    ds_pk_add_bf16 v7, v88 offset:65408
    ds_pk_add_bf16 v7, v89 offset:65412
    s_mov_b64 exec, s[50:51]
    s_branch L2_d18
L2_c21:
    s_lshl_b64 s[52:53], s[82:83], 1
    s_andn2_b64 s[52:53], s[52:53], s[80:81]
    s_andn2_b64 s[52:53], s[52:53], s[54:55]
    s_or_b64 s[80:81], s[80:81], s[52:53]
    s_not_b64 vcc, s[52:53]
    s_mov_b64 exec, -1
    v_cndmask_b32_dpp v84, v84, v84, vcc wave_shr:1 row_mask:0xf bank_mask:0xf
    v_cndmask_b32_dpp v85, v85, v85, vcc wave_shr:1 row_mask:0xf bank_mask:0xf
    s_lshr_b64 s[52:53], s[52:53], 1
    v_cndmask_b32_dpp v86, v86, v86, vcc wave_shr:1 row_mask:0xf bank_mask:0xf
    v_cndmask_b32_dpp v87, v87, v87, vcc wave_shr:1 row_mask:0xf bank_mask:0xf
    s_andn2_b64 s[82:83], s[82:83], s[52:53]
    v_cndmask_b32_dpp v7, v7, v7, vcc wave_shr:1 row_mask:0xf bank_mask:0xf
    s_mov_b64 exec, s[54:55]
    s_cbranch_scc0 L2_d21
    s_mov_b64 exec, s[82:83]
    s_nop 1
    v_mfma_f32_4x4x4_16b_bf16 v[88:91], v[12:13], v[84:85], 0
    s_nop 1
    v_mfma_f32_4x4x4_16b_bf16 v[88:91], v[10:11], v[86:87], v[88:91]
    s_nop 4
    v_cvt_pk_bf16_f32 v88, v88, v89
    v_cvt_pk_bf16_f32 v89, v90, v91
    ds_pk_add_bf16 v7, v88 offset:65408
    ds_pk_add_bf16 v7, v89 offset:65412
    s_mov_b64 exec, s[54:55]
    s_branch L2_d21
L2_c22:
    s_lshl_b64 s[52:53], s[82:83], 1
    s_andn2_b64 s[52:53], s[52:53], s[80:81]
    s_andn2_b64 s[52:53], s[52:53], s[50:51]
    s_or_b64 s[80:81], s[80:81], s[52:53]
    s_not_b64 vcc, s[52:53]
    s_mov_b64 exec, -1
    v_cndmask_b32_dpp v84, v84, v84, vcc wave_shr:1 row_mask:0xf bank_mask:0xf
    v_cndmask_b32_dpp v85, v85, v85, vcc wave_shr:1 row_mask:0xf bank_mask:0xf
    s_lshr_b64 s[52:53], s[52:53], 1
    v_cndmask_b32_dpp v86, v86, v86, vcc wave_shr:1 row_mask:0xf bank_mask:0xf
    v_cndmask_b32_dpp v87, v87, v87, vcc wave_shr:1 row_mask:0xf bank_mask:0xf
    s_andn2_b64 s[82:83], s[82:83], s[52:53]
    v_cndmask_b32_dpp v7, v7, v7, vcc wave_shr:1 row_mask:0xf bank_mask:0xf
    s_mov_b64 exec, s[50:51]
    s_cbranch_scc0 L2_d22
    s_mov_b64 exec, s[82:83]
    s_nop 1
    v_mfma_f32_4x4x4_16b_bf16 v[88:91], v[12:13], v[84:85], 0
    s_nop 1
    v_mfma_f32_4x4x4_16b_bf16 v[88:91], v[10:11], v[86:87], v[88:91]
    s_nop 4
    v_cvt_pk_bf16_f32 v88, v88, v89
    v_cvt_pk_bf16_f32 v89, v90, v91
    ds_pk_add_bf16 v7, v88 offset:65408
    ds_pk_add_bf16 v7, v89 offset:65412
    s_mov_b64 exec, s[50:51]
    s_branch L2_d22
L2_c23:
    s_lshl_b64 s[52:53], s[82:83], 1
    s_andn2_b64 s[52:53], s[52:53], s[80:81]
    s_andn2_b64 s[52:53], s[52:53], s[54:55]
    s_or_b64 s[80:81], s[80:81], s[52:53]
    s_not_b64 vcc, s[52:53]
    s_mov_b64 exec, -1
    v_cndmask_b32_dpp v84, v84, v84, vcc wave_shr:1 row_mask:0xf bank_mask:0xf
    v_cndmask_b32_dpp v85, v85, v85, vcc wave_shr:1 row_mask:0xf bank_mask:0xf
    s_lshr_b64 s[52:53], s[52:53], 1
    v_cndmask_b32_dpp v86, v86, v86, vcc wave_shr:1 row_mask:0xf bank_mask:0xf
    v_cndmask_b32_dpp v87, v87, v87, vcc wave_shr:1 row_mask:0xf bank_mask:0xf
    s_andn2_b64 s[82:83], s[82:83], s[52:53]
    v_cndmask_b32_dpp v7, v7, v7, vcc wave_shr:1 row_mask:0xf bank_mask:0xf
    s_mov_b64 exec, s[54:55]
    s_cbranch_scc0 L2_d23
    s_mov_b64 exec, s[82:83]
    s_nop 1
    v_mfma_f32_4x4x4_16b_bf16 v[88:91], v[12:13], v[84:85], 0
    s_nop 1
    v_mfma_f32_4x4x4_16b_bf16 v[88:91], v[10:11], v[86:87], v[88:91]
    s_nop 4
    v_cvt_pk_bf16_f32 v88, v88, v89
    v_cvt_pk_bf16_f32 v89, v90, v91
    ds_pk_add_bf16 v7, v88 offset:65408
    ds_pk_add_bf16 v7, v89 offset:65412
    s_mov_b64 exec, s[54:55]
    s_branch L2_d23
L2_c24:
    s_lshl_b64 s[52:53], s[82:83], 1
    s_andn2_b64 s[52:53], s[52:53], s[80:81]
    s_andn2_b64 s[52:53], s[52:53], s[50:51]
    s_or_b64 s[80:81], s[80:81], s[52:53]
    s_not_b64 vcc, s[52:53]
    s_mov_b64 exec, -1
    v_cndmask_b32_dpp v84, v84, v84, vcc wave_shr:1 row_mask:0xf bank_mask:0xf
    v_cndmask_b32_dpp v85, v85, v85, vcc wave_shr:1 row_mask:0xf bank_mask:0xf
    s_lshr_b64 s[52:53], s[52:53], 1
    v_cndmask_b32_dpp v86, v86, v86, vcc wave_shr:1 row_mask:0xf bank_mask:0xf
    v_cndmask_b32_dpp v87, v87, v87, vcc wave_shr:1 row_mask:0xf bank_mask:0xf
    s_andn2_b64 s[82:83], s[82:83], s[52:53]
    v_cndmask_b32_dpp v7, v7, v7, vcc wave_shr:1 row_mask:0xf bank_mask:0xf
    s_mov_b64 exec, s[50:51]
    s_cbranch_scc0 L2_d24
    s_mov_b64 exec, s[82:83]
    s_nop 1
    v_mfma_f32_4x4x4_16b_bf16 v[88:91], v[12:13], v[84:85], 0
    s_nop 1
    v_mfma_f32_4x4x4_16b_bf16 v[88:91], v[10:11], v[86:87], v[88:91]
    s_nop 4
    v_cvt_pk_bf16_f32 v88, v88, v89
    v_cvt_pk_bf16_f32 v89, v90, v91
    ds_pk_add_bf16 v7, v88 offset:65408
    ds_pk_add_bf16 v7, v89 offset:65412
    s_mov_b64 exec, s[50:51]
    s_branch L2_d24
L2_xa25:
    s_cmp_eq_u32 s101, 1
    s_cbranch_scc1 L2_xc25
    v_lshlrev_b32 v89, 0, v96
    v_add_u32 v90, 140, v97
    v_bitop3_b32 v90, v89, v45, v90 bitop3:0x6a
    ds_write_b32 v98, v90 offset:28
    v_lshlrev_b32 v89, 4, v96
    v_add_u32 v90, 120, v97
    v_bitop3_b32 v90, v89, v45, v90 bitop3:0x6a
    ds_write_b32 v98, v90 offset:24
    v_lshlrev_b32 v89, 8, v96
    v_add_u32 v90, 100, v97
    v_bitop3_b32 v90, v89, v45, v90 bitop3:0x6a
    ds_write_b32 v98, v90 offset:20
L2_xc25:
    v_lshlrev_b32 v89, 12, v96
    v_add_u32 v90, 80, v97
    v_bitop3_b32 v90, v89, v45, v90 bitop3:0x6a
    ds_write_b32 v98, v90 offset:16
    s_branch L2_xb25
L2_xe25:
    v_cmp_lt_u32 vcc, 32, v99
    v_cmp_lt_u32 s[58:59], 31, v88
    v_lshrrev_b32 v89, 16, v96
    v_add_u32 v97, 80, v97
    s_or_b64 vcc, vcc, s[58:59]
    s_cbranch_scc1 L2_xs25
    v_lshlrev_b32 v89, v1, v89
    v_and_b32 v89, v45, v89
    v_cmp_ne_u32 vcc, 0, v89
    v_xor_b32 v90, v97, v89
    s_add_u32 s3, s37, s38
    v_mbcnt_lo_u32_b32 v98, vcc_lo, 0
    v_mbcnt_hi_u32_b32 v98, vcc_hi, v98
    s_bcnt1_i32_b64 s41, vcc
    v_lshl_add_u32 v98, v98, 2, s3
    s_lshl2_add_u32 s37, s41, s37
    s_mov_b64 exec, vcc
    ds_write_b32 v98, v90
    s_mov_b64 exec, -1
    s_branch L2_xr25
L2_xs25:
    s_waitcnt lgkmcnt(0)
    s_mov_b32 s37, 0x10000
    s_branch L2_xw25
L2_c26:
    s_lshl_b64 s[52:53], s[82:83], 1
    s_andn2_b64 s[52:53], s[52:53], s[80:81]
    s_andn2_b64 s[52:53], s[52:53], s[54:55]
    s_or_b64 s[80:81], s[80:81], s[52:53]
    s_not_b64 vcc, s[52:53]
    s_mov_b64 exec, -1
    v_cndmask_b32_dpp v84, v84, v84, vcc wave_shr:1 row_mask:0xf bank_mask:0xf
    v_cndmask_b32_dpp v85, v85, v85, vcc wave_shr:1 row_mask:0xf bank_mask:0xf
    s_lshr_b64 s[52:53], s[52:53], 1
    v_cndmask_b32_dpp v86, v86, v86, vcc wave_shr:1 row_mask:0xf bank_mask:0xf
    v_cndmask_b32_dpp v87, v87, v87, vcc wave_shr:1 row_mask:0xf bank_mask:0xf
    s_andn2_b64 s[82:83], s[82:83], s[52:53]
    v_cndmask_b32_dpp v7, v7, v7, vcc wave_shr:1 row_mask:0xf bank_mask:0xf
    s_mov_b64 exec, s[54:55]
    s_cbranch_scc0 L2_d26
    s_mov_b64 exec, s[82:83]
    s_nop 1
    v_mfma_f32_4x4x4_16b_bf16 v[88:91], v[12:13], v[84:85], 0
    s_nop 1
    v_mfma_f32_4x4x4_16b_bf16 v[88:91], v[10:11], v[86:87], v[88:91]
    s_nop 4
    v_cvt_pk_bf16_f32 v88, v88, v89
    v_cvt_pk_bf16_f32 v89, v90, v91
    ds_pk_add_bf16 v7, v88 offset:65408
    ds_pk_add_bf16 v7, v89 offset:65412
    s_mov_b64 exec, s[54:55]
    s_branch L2_d26
L2_c27:
    s_lshl_b64 s[52:53], s[82:83], 1
    s_andn2_b64 s[52:53], s[52:53], s[80:81]
    s_andn2_b64 s[52:53], s[52:53], s[50:51]
    s_or_b64 s[80:81], s[80:81], s[52:53]
    s_not_b64 vcc, s[52:53]
    s_mov_b64 exec, -1
    v_cndmask_b32_dpp v84, v84, v84, vcc wave_shr:1 row_mask:0xf bank_mask:0xf
    v_cndmask_b32_dpp v85, v85, v85, vcc wave_shr:1 row_mask:0xf bank_mask:0xf
    s_lshr_b64 s[52:53], s[52:53], 1
    v_cndmask_b32_dpp v86, v86, v86, vcc wave_shr:1 row_mask:0xf bank_mask:0xf
    v_cndmask_b32_dpp v87, v87, v87, vcc wave_shr:1 row_mask:0xf bank_mask:0xf
    s_andn2_b64 s[82:83], s[82:83], s[52:53]
    v_cndmask_b32_dpp v7, v7, v7, vcc wave_shr:1 row_mask:0xf bank_mask:0xf
    s_mov_b64 exec, s[50:51]
    s_cbranch_scc0 L2_d27
    s_mov_b64 exec, s[82:83]
    s_nop 1
    v_mfma_f32_4x4x4_16b_bf16 v[88:91], v[12:13], v[84:85], 0
    s_nop 1
    v_mfma_f32_4x4x4_16b_bf16 v[88:91], v[10:11], v[86:87], v[88:91]
    s_nop 4
    v_cvt_pk_bf16_f32 v88, v88, v89
    v_cvt_pk_bf16_f32 v89, v90, v91
    ds_pk_add_bf16 v7, v88 offset:65408
    ds_pk_add_bf16 v7, v89 offset:65412
    s_mov_b64 exec, s[50:51]
    s_branch L2_d27
L2_xf25:
    s_cmp_gt_u32 s37, 1024
    s_cbranch_scc1 L2_xt25
    s_cmp_lt_u32 s37, 768
    s_cbranch_scc1 L2_xl25
    ds_read_b32 v32, v44 offset:896
    s_add_u32 s3, s42, 2
    s_bitset1_b32 s43, s3
    s_branch L2_xg25
L2_xl25:
    s_waitcnt lgkmcnt(0)
    v_mov_b32 v31, -1
    s_cmp_ge_u32 s37, 512
    s_cbranch_scc1 L2_xg25
    v_mov_b32 v39, -1
    s_cmp_ge_u32 s37, 256
    s_cbranch_scc1 L2_xg25
    v_mov_b32 v27, -1
    s_branch L2_xg25
L2_xt25:
    s_waitcnt lgkmcnt(0)
    v_mov_b32 v21, -1
    v_mov_b32 v27, -1
    v_mov_b32 v39, -1
    v_mov_b32 v31, -1
    s_add_u32 s3, s42, 2
    s_bitset1_b32 s36, s3
    s_branch L2_xg25
L2_oa28:
    v_and_b32 v47, 0x0fffffff, v33
    buffer_load_dword v114, v47, s[8:11], 0 offen offset:16
    s_mov_b64 exec, s[6:7]
    v_add_u32 v47, 8, v47
    v_lshrrev_b32 v33, 2, v33
    s_mov_b64 exec, -1
    buffer_load_dwordx2 v[112:113], v47, s[8:11], 0 offen
    s_branch L2_ob28
L2_c29:
    s_lshl_b64 s[52:53], s[82:83], 1
    s_andn2_b64 s[52:53], s[52:53], s[80:81]
    s_andn2_b64 s[52:53], s[52:53], s[54:55]
    s_or_b64 s[80:81], s[80:81], s[52:53]
    s_not_b64 vcc, s[52:53]
    s_mov_b64 exec, -1
    v_cndmask_b32_dpp v84, v84, v84, vcc wave_shr:1 row_mask:0xf bank_mask:0xf
    v_cndmask_b32_dpp v85, v85, v85, vcc wave_shr:1 row_mask:0xf bank_mask:0xf
    s_lshr_b64 s[52:53], s[52:53], 1
    v_cndmask_b32_dpp v86, v86, v86, vcc wave_shr:1 row_mask:0xf bank_mask:0xf
    v_cndmask_b32_dpp v87, v87, v87, vcc wave_shr:1 row_mask:0xf bank_mask:0xf
    s_andn2_b64 s[82:83], s[82:83], s[52:53]
    v_cndmask_b32_dpp v7, v7, v7, vcc wave_shr:1 row_mask:0xf bank_mask:0xf
    s_mov_b64 exec, s[54:55]
    s_cbranch_scc0 L2_d29
    s_mov_b64 exec, s[82:83]
    s_nop 1
    v_mfma_f32_4x4x4_16b_bf16 v[88:91], v[12:13], v[84:85], 0
    s_nop 1
    v_mfma_f32_4x4x4_16b_bf16 v[88:91], v[10:11], v[86:87], v[88:91]
    s_nop 4
    v_cvt_pk_bf16_f32 v88, v88, v89
    v_cvt_pk_bf16_f32 v89, v90, v91
    ds_pk_add_bf16 v7, v88 offset:65408
    ds_pk_add_bf16 v7, v89 offset:65412
    s_mov_b64 exec, s[54:55]
    s_branch L2_d29
L2_c30:
    s_lshl_b64 s[52:53], s[82:83], 1
    s_andn2_b64 s[52:53], s[52:53], s[80:81]
    s_andn2_b64 s[52:53], s[52:53], s[50:51]
    s_or_b64 s[80:81], s[80:81], s[52:53]
    s_not_b64 vcc, s[52:53]
    s_mov_b64 exec, -1
    v_cndmask_b32_dpp v84, v84, v84, vcc wave_shr:1 row_mask:0xf bank_mask:0xf
    v_cndmask_b32_dpp v85, v85, v85, vcc wave_shr:1 row_mask:0xf bank_mask:0xf
    s_lshr_b64 s[52:53], s[52:53], 1
    v_cndmask_b32_dpp v86, v86, v86, vcc wave_shr:1 row_mask:0xf bank_mask:0xf
    v_cndmask_b32_dpp v87, v87, v87, vcc wave_shr:1 row_mask:0xf bank_mask:0xf
    s_andn2_b64 s[82:83], s[82:83], s[52:53]
    v_cndmask_b32_dpp v7, v7, v7, vcc wave_shr:1 row_mask:0xf bank_mask:0xf
    s_mov_b64 exec, s[50:51]
    s_cbranch_scc0 L2_d30
    s_mov_b64 exec, s[82:83]
    s_nop 1
    v_mfma_f32_4x4x4_16b_bf16 v[88:91], v[12:13], v[84:85], 0
    s_nop 1
    v_mfma_f32_4x4x4_16b_bf16 v[88:91], v[10:11], v[86:87], v[88:91]
    s_nop 4
    v_cvt_pk_bf16_f32 v88, v88, v89
    v_cvt_pk_bf16_f32 v89, v90, v91
    ds_pk_add_bf16 v7, v88 offset:65408
    ds_pk_add_bf16 v7, v89 offset:65412
    s_mov_b64 exec, s[50:51]
    s_branch L2_d30
L2_c31:
    s_lshl_b64 s[52:53], s[82:83], 1
    s_andn2_b64 s[52:53], s[52:53], s[80:81]
    s_andn2_b64 s[52:53], s[52:53], s[54:55]
    s_or_b64 s[80:81], s[80:81], s[52:53]
    s_not_b64 vcc, s[52:53]
    s_mov_b64 exec, -1
    v_cndmask_b32_dpp v84, v84, v84, vcc wave_shr:1 row_mask:0xf bank_mask:0xf
    v_cndmask_b32_dpp v85, v85, v85, vcc wave_shr:1 row_mask:0xf bank_mask:0xf
    s_lshr_b64 s[52:53], s[52:53], 1
    v_cndmask_b32_dpp v86, v86, v86, vcc wave_shr:1 row_mask:0xf bank_mask:0xf
    v_cndmask_b32_dpp v87, v87, v87, vcc wave_shr:1 row_mask:0xf bank_mask:0xf
    s_andn2_b64 s[82:83], s[82:83], s[52:53]
    v_cndmask_b32_dpp v7, v7, v7, vcc wave_shr:1 row_mask:0xf bank_mask:0xf
    s_mov_b64 exec, s[54:55]
    s_cbranch_scc0 L2_d31
    s_mov_b64 exec, s[82:83]
    s_nop 1
    v_mfma_f32_4x4x4_16b_bf16 v[88:91], v[12:13], v[84:85], 0
    s_nop 1
    v_mfma_f32_4x4x4_16b_bf16 v[88:91], v[10:11], v[86:87], v[88:91]
    s_nop 4
    v_cvt_pk_bf16_f32 v88, v88, v89
    v_cvt_pk_bf16_f32 v89, v90, v91
    ds_pk_add_bf16 v7, v88 offset:65408
    ds_pk_add_bf16 v7, v89 offset:65412
    s_mov_b64 exec, s[54:55]
    s_branch L2_d31
L2_c32:
    s_lshl_b64 s[52:53], s[82:83], 1
    s_andn2_b64 s[52:53], s[52:53], s[80:81]
    s_andn2_b64 s[52:53], s[52:53], s[50:51]
    s_or_b64 s[80:81], s[80:81], s[52:53]
    s_not_b64 vcc, s[52:53]
    s_mov_b64 exec, -1
    v_cndmask_b32_dpp v84, v84, v84, vcc wave_shr:1 row_mask:0xf bank_mask:0xf
    v_cndmask_b32_dpp v85, v85, v85, vcc wave_shr:1 row_mask:0xf bank_mask:0xf
    s_lshr_b64 s[52:53], s[52:53], 1
    v_cndmask_b32_dpp v86, v86, v86, vcc wave_shr:1 row_mask:0xf bank_mask:0xf
    v_cndmask_b32_dpp v87, v87, v87, vcc wave_shr:1 row_mask:0xf bank_mask:0xf
    s_andn2_b64 s[82:83], s[82:83], s[52:53]
    v_cndmask_b32_dpp v7, v7, v7, vcc wave_shr:1 row_mask:0xf bank_mask:0xf
    s_mov_b64 exec, s[50:51]
    s_cbranch_scc0 L2_d32
    s_mov_b64 exec, s[82:83]
    s_nop 1
    v_mfma_f32_4x4x4_16b_bf16 v[88:91], v[12:13], v[84:85], 0
    s_nop 1
    v_mfma_f32_4x4x4_16b_bf16 v[88:91], v[10:11], v[86:87], v[88:91]
    s_nop 4
    v_cvt_pk_bf16_f32 v88, v88, v89
    v_cvt_pk_bf16_f32 v89, v90, v91
    ds_pk_add_bf16 v7, v88 offset:65408
    ds_pk_add_bf16 v7, v89 offset:65412
    s_mov_b64 exec, s[50:51]
    s_branch L2_d32
L2_c33:
    s_lshl_b64 s[52:53], s[82:83], 1
    s_andn2_b64 s[52:53], s[52:53], s[80:81]
    s_andn2_b64 s[52:53], s[52:53], s[54:55]
    s_or_b64 s[80:81], s[80:81], s[52:53]
    s_not_b64 vcc, s[52:53]
    s_mov_b64 exec, -1
    v_cndmask_b32_dpp v84, v84, v84, vcc wave_shr:1 row_mask:0xf bank_mask:0xf
    v_cndmask_b32_dpp v85, v85, v85, vcc wave_shr:1 row_mask:0xf bank_mask:0xf
    s_lshr_b64 s[52:53], s[52:53], 1
    v_cndmask_b32_dpp v86, v86, v86, vcc wave_shr:1 row_mask:0xf bank_mask:0xf
    v_cndmask_b32_dpp v87, v87, v87, vcc wave_shr:1 row_mask:0xf bank_mask:0xf
    s_andn2_b64 s[82:83], s[82:83], s[52:53]
    v_cndmask_b32_dpp v7, v7, v7, vcc wave_shr:1 row_mask:0xf bank_mask:0xf
    s_mov_b64 exec, s[54:55]
    s_cbranch_scc0 L2_d33
    s_mov_b64 exec, s[82:83]
    s_nop 1
    v_mfma_f32_4x4x4_16b_bf16 v[88:91], v[12:13], v[84:85], 0
    s_nop 1
    v_mfma_f32_4x4x4_16b_bf16 v[88:91], v[10:11], v[86:87], v[88:91]
    s_nop 4
    v_cvt_pk_bf16_f32 v88, v88, v89
    v_cvt_pk_bf16_f32 v89, v90, v91
    ds_pk_add_bf16 v7, v88 offset:65408
    ds_pk_add_bf16 v7, v89 offset:65412
    s_mov_b64 exec, s[54:55]
    s_branch L2_d33
L2_c34:
    s_lshl_b64 s[52:53], s[82:83], 1
    s_andn2_b64 s[52:53], s[52:53], s[80:81]
    s_andn2_b64 s[52:53], s[52:53], s[50:51]
    s_or_b64 s[80:81], s[80:81], s[52:53]
    s_not_b64 vcc, s[52:53]
    s_mov_b64 exec, -1
    v_cndmask_b32_dpp v84, v84, v84, vcc wave_shr:1 row_mask:0xf bank_mask:0xf
    v_cndmask_b32_dpp v85, v85, v85, vcc wave_shr:1 row_mask:0xf bank_mask:0xf
    s_lshr_b64 s[52:53], s[52:53], 1
    v_cndmask_b32_dpp v86, v86, v86, vcc wave_shr:1 row_mask:0xf bank_mask:0xf
    v_cndmask_b32_dpp v87, v87, v87, vcc wave_shr:1 row_mask:0xf bank_mask:0xf
    s_andn2_b64 s[82:83], s[82:83], s[52:53]
    v_cndmask_b32_dpp v7, v7, v7, vcc wave_shr:1 row_mask:0xf bank_mask:0xf
    s_mov_b64 exec, s[50:51]
    s_cbranch_scc0 L2_d34
    s_mov_b64 exec, s[82:83]
    s_nop 1
    v_mfma_f32_4x4x4_16b_bf16 v[88:91], v[12:13], v[84:85], 0
    s_nop 1
    v_mfma_f32_4x4x4_16b_bf16 v[88:91], v[10:11], v[86:87], v[88:91]
    s_nop 4
    v_cvt_pk_bf16_f32 v88, v88, v89
    v_cvt_pk_bf16_f32 v89, v90, v91
    ds_pk_add_bf16 v7, v88 offset:65408
    ds_pk_add_bf16 v7, v89 offset:65412
    s_mov_b64 exec, s[50:51]
    s_branch L2_d34
L2_oa35:
    s_waitcnt vmcnt(3)
    s_mov_b64 exec, s[6:7]
    v_lshrrev_b32 v114, 16, v114
    s_mov_b64 exec, -1
    v_and_b32 v46, 0x10000000, v33
    v_cmpx_eq_u32 vcc, 0, v46
    v_lshrrev_b32 v47, 14, v112
    v_and_b32 v47, v5, v47
    ds_read_b64 v[96:97], v47
    v_perm_b32 v98, v112, v114, s44
    v_bitop3_b32 v99, v112, 0.5, -0.5 bitop3:0xa8
    v_bitop3_b32 v98, v6, v98, v99 bitop3:0xca
    v_and_b32 v47, v5, v112
    s_waitcnt lgkmcnt(0)
    v_mfma_f32_4x4x4_16b_bf16 v[88:91], v[8:9], v[96:97], 0
    s_nop 4
    v_mul_f32 v88, v98, v88
    v_mul_f32 v89, v98, v89
    v_mul_f32 v90, v98, v90
    v_mul_f32 v91, v98, v91
    v_cvt_pk_bf16_f32 v88, v88, v89
    v_cvt_pk_bf16_f32 v89, v90, v91
    ds_pk_add_bf16 v47, v88 offset:65408
    ds_pk_add_bf16 v47, v89 offset:65412
    s_mov_b64 exec, -1
    v_and_b32 v46, 0x20000000, v33
    v_cmpx_eq_u32 vcc, 0, v46
    v_lshrrev_b32 v47, 14, v113
    v_and_b32 v47, v5, v47
    ds_read_b64 v[96:97], v47
    v_perm_b32 v98, v113, v114, s45
    v_bitop3_b32 v99, v113, 0.5, -0.5 bitop3:0xa8
    v_bitop3_b32 v98, v6, v98, v99 bitop3:0xca
    v_and_b32 v47, v5, v113
    s_waitcnt lgkmcnt(0)
    v_mfma_f32_4x4x4_16b_bf16 v[88:91], v[8:9], v[96:97], 0
    s_nop 4
    v_mul_f32 v88, v98, v88
    v_mul_f32 v89, v98, v89
    v_mul_f32 v90, v98, v90
    v_mul_f32 v91, v98, v91
    v_cvt_pk_bf16_f32 v88, v88, v89
    v_cvt_pk_bf16_f32 v89, v90, v91
    ds_pk_add_bf16 v47, v88 offset:65408
    ds_pk_add_bf16 v47, v89 offset:65412
    s_mov_b64 exec, -1
    s_branch L2_ob35
L2_xo36:
    v_cmp_lt_u32 vcc, 20, v99
    s_mov_b32 s101, 1
    s_cbranch_vccz L2_xp36
    v_cmp_lt_u32 vcc, 32, v99
    v_cmp_lt_u32 s[58:59], 31, v88
    s_mov_b32 s101, 2
    s_or_b64 vcc, vcc, s[58:59]
    s_cbranch_scc0 L2_xp36
    s_mov_b32 s37, 0x10000
    s_branch L2_xp36
L2_c37:
    s_lshl_b64 s[52:53], s[82:83], 1
    s_andn2_b64 s[52:53], s[52:53], s[80:81]
    s_andn2_b64 s[52:53], s[52:53], s[54:55]
    s_or_b64 s[80:81], s[80:81], s[52:53]
    s_not_b64 vcc, s[52:53]
    s_mov_b64 exec, -1
    v_cndmask_b32_dpp v84, v84, v84, vcc wave_shr:1 row_mask:0xf bank_mask:0xf
    v_cndmask_b32_dpp v85, v85, v85, vcc wave_shr:1 row_mask:0xf bank_mask:0xf
    s_lshr_b64 s[52:53], s[52:53], 1
    v_cndmask_b32_dpp v86, v86, v86, vcc wave_shr:1 row_mask:0xf bank_mask:0xf
    v_cndmask_b32_dpp v87, v87, v87, vcc wave_shr:1 row_mask:0xf bank_mask:0xf
    s_andn2_b64 s[82:83], s[82:83], s[52:53]
    v_cndmask_b32_dpp v7, v7, v7, vcc wave_shr:1 row_mask:0xf bank_mask:0xf
    s_mov_b64 exec, s[54:55]
    s_cbranch_scc0 L2_d37
    s_mov_b64 exec, s[82:83]
    s_nop 1
    v_mfma_f32_4x4x4_16b_bf16 v[88:91], v[12:13], v[84:85], 0
    s_nop 1
    v_mfma_f32_4x4x4_16b_bf16 v[88:91], v[10:11], v[86:87], v[88:91]
    s_nop 4
    v_cvt_pk_bf16_f32 v88, v88, v89
    v_cvt_pk_bf16_f32 v89, v90, v91
    ds_pk_add_bf16 v7, v88 offset:65408
    ds_pk_add_bf16 v7, v89 offset:65412
    s_mov_b64 exec, s[54:55]
    s_branch L2_d37
L2_c38:
    s_lshl_b64 s[52:53], s[82:83], 1
    s_andn2_b64 s[52:53], s[52:53], s[80:81]
    s_andn2_b64 s[52:53], s[52:53], s[50:51]
    s_or_b64 s[80:81], s[80:81], s[52:53]
    s_not_b64 vcc, s[52:53]
    s_mov_b64 exec, -1
    v_cndmask_b32_dpp v84, v84, v84, vcc wave_shr:1 row_mask:0xf bank_mask:0xf
    v_cndmask_b32_dpp v85, v85, v85, vcc wave_shr:1 row_mask:0xf bank_mask:0xf
    s_lshr_b64 s[52:53], s[52:53], 1
    v_cndmask_b32_dpp v86, v86, v86, vcc wave_shr:1 row_mask:0xf bank_mask:0xf
    v_cndmask_b32_dpp v87, v87, v87, vcc wave_shr:1 row_mask:0xf bank_mask:0xf
    s_andn2_b64 s[82:83], s[82:83], s[52:53]
    v_cndmask_b32_dpp v7, v7, v7, vcc wave_shr:1 row_mask:0xf bank_mask:0xf
    s_mov_b64 exec, s[50:51]
    s_cbranch_scc0 L2_d38
    s_mov_b64 exec, s[82:83]
    s_nop 1
    v_mfma_f32_4x4x4_16b_bf16 v[88:91], v[12:13], v[84:85], 0
    s_nop 1
    v_mfma_f32_4x4x4_16b_bf16 v[88:91], v[10:11], v[86:87], v[88:91]
    s_nop 4
    v_cvt_pk_bf16_f32 v88, v88, v89
    v_cvt_pk_bf16_f32 v89, v90, v91
    ds_pk_add_bf16 v7, v88 offset:65408
    ds_pk_add_bf16 v7, v89 offset:65412
    s_mov_b64 exec, s[50:51]
    s_branch L2_d38
L2_c39:
    s_lshl_b64 s[52:53], s[82:83], 1
    s_andn2_b64 s[52:53], s[52:53], s[80:81]
    s_andn2_b64 s[52:53], s[52:53], s[54:55]
    s_or_b64 s[80:81], s[80:81], s[52:53]
    s_not_b64 vcc, s[52:53]
    s_mov_b64 exec, -1
    v_cndmask_b32_dpp v84, v84, v84, vcc wave_shr:1 row_mask:0xf bank_mask:0xf
    v_cndmask_b32_dpp v85, v85, v85, vcc wave_shr:1 row_mask:0xf bank_mask:0xf
    s_lshr_b64 s[52:53], s[52:53], 1
    v_cndmask_b32_dpp v86, v86, v86, vcc wave_shr:1 row_mask:0xf bank_mask:0xf
    v_cndmask_b32_dpp v87, v87, v87, vcc wave_shr:1 row_mask:0xf bank_mask:0xf
    s_andn2_b64 s[82:83], s[82:83], s[52:53]
    v_cndmask_b32_dpp v7, v7, v7, vcc wave_shr:1 row_mask:0xf bank_mask:0xf
    s_mov_b64 exec, s[54:55]
    s_cbranch_scc0 L2_d39
    s_mov_b64 exec, s[82:83]
    s_nop 1
    v_mfma_f32_4x4x4_16b_bf16 v[88:91], v[12:13], v[84:85], 0
    s_nop 1
    v_mfma_f32_4x4x4_16b_bf16 v[88:91], v[10:11], v[86:87], v[88:91]
    s_nop 4
    v_cvt_pk_bf16_f32 v88, v88, v89
    v_cvt_pk_bf16_f32 v89, v90, v91
    ds_pk_add_bf16 v7, v88 offset:65408
    ds_pk_add_bf16 v7, v89 offset:65412
    s_mov_b64 exec, s[54:55]
    s_branch L2_d39
L2_c40:
    s_lshl_b64 s[52:53], s[82:83], 1
    s_andn2_b64 s[52:53], s[52:53], s[80:81]
    s_andn2_b64 s[52:53], s[52:53], s[50:51]
    s_or_b64 s[80:81], s[80:81], s[52:53]
    s_not_b64 vcc, s[52:53]
    s_mov_b64 exec, -1
    v_cndmask_b32_dpp v84, v84, v84, vcc wave_shr:1 row_mask:0xf bank_mask:0xf
    v_cndmask_b32_dpp v85, v85, v85, vcc wave_shr:1 row_mask:0xf bank_mask:0xf
    s_lshr_b64 s[52:53], s[52:53], 1
    v_cndmask_b32_dpp v86, v86, v86, vcc wave_shr:1 row_mask:0xf bank_mask:0xf
    v_cndmask_b32_dpp v87, v87, v87, vcc wave_shr:1 row_mask:0xf bank_mask:0xf
    s_andn2_b64 s[82:83], s[82:83], s[52:53]
    v_cndmask_b32_dpp v7, v7, v7, vcc wave_shr:1 row_mask:0xf bank_mask:0xf
    s_mov_b64 exec, s[50:51]
    s_cbranch_scc0 L2_d40
    s_mov_b64 exec, s[82:83]
    s_nop 1
    v_mfma_f32_4x4x4_16b_bf16 v[88:91], v[12:13], v[84:85], 0
    s_nop 1
    v_mfma_f32_4x4x4_16b_bf16 v[88:91], v[10:11], v[86:87], v[88:91]
    s_nop 4
    v_cvt_pk_bf16_f32 v88, v88, v89
    v_cvt_pk_bf16_f32 v89, v90, v91
    ds_pk_add_bf16 v7, v88 offset:65408
    ds_pk_add_bf16 v7, v89 offset:65412
    s_mov_b64 exec, s[50:51]
    s_branch L2_d40
L2_c41:
    s_lshl_b64 s[52:53], s[82:83], 1
    s_andn2_b64 s[52:53], s[52:53], s[80:81]
    s_andn2_b64 s[52:53], s[52:53], s[54:55]
    s_or_b64 s[80:81], s[80:81], s[52:53]
    s_not_b64 vcc, s[52:53]
    s_mov_b64 exec, -1
    v_cndmask_b32_dpp v84, v84, v84, vcc wave_shr:1 row_mask:0xf bank_mask:0xf
    v_cndmask_b32_dpp v85, v85, v85, vcc wave_shr:1 row_mask:0xf bank_mask:0xf
    s_lshr_b64 s[52:53], s[52:53], 1
    v_cndmask_b32_dpp v86, v86, v86, vcc wave_shr:1 row_mask:0xf bank_mask:0xf
    v_cndmask_b32_dpp v87, v87, v87, vcc wave_shr:1 row_mask:0xf bank_mask:0xf
    s_andn2_b64 s[82:83], s[82:83], s[52:53]
    v_cndmask_b32_dpp v7, v7, v7, vcc wave_shr:1 row_mask:0xf bank_mask:0xf
    s_mov_b64 exec, s[54:55]
    s_cbranch_scc0 L2_d41
    s_mov_b64 exec, s[82:83]
    s_nop 1
    v_mfma_f32_4x4x4_16b_bf16 v[88:91], v[12:13], v[84:85], 0
    s_nop 1
    v_mfma_f32_4x4x4_16b_bf16 v[88:91], v[10:11], v[86:87], v[88:91]
    s_nop 4
    v_cvt_pk_bf16_f32 v88, v88, v89
    v_cvt_pk_bf16_f32 v89, v90, v91
    ds_pk_add_bf16 v7, v88 offset:65408
    ds_pk_add_bf16 v7, v89 offset:65412
    s_mov_b64 exec, s[54:55]
    s_branch L2_d41
L2_c42:
    s_lshl_b64 s[52:53], s[82:83], 1
    s_andn2_b64 s[52:53], s[52:53], s[80:81]
    s_andn2_b64 s[52:53], s[52:53], s[50:51]
    s_or_b64 s[80:81], s[80:81], s[52:53]
    s_not_b64 vcc, s[52:53]
    s_mov_b64 exec, -1
    v_cndmask_b32_dpp v84, v84, v84, vcc wave_shr:1 row_mask:0xf bank_mask:0xf
    v_cndmask_b32_dpp v85, v85, v85, vcc wave_shr:1 row_mask:0xf bank_mask:0xf
    s_lshr_b64 s[52:53], s[52:53], 1
    v_cndmask_b32_dpp v86, v86, v86, vcc wave_shr:1 row_mask:0xf bank_mask:0xf
    v_cndmask_b32_dpp v87, v87, v87, vcc wave_shr:1 row_mask:0xf bank_mask:0xf
    s_andn2_b64 s[82:83], s[82:83], s[52:53]
    v_cndmask_b32_dpp v7, v7, v7, vcc wave_shr:1 row_mask:0xf bank_mask:0xf
    s_mov_b64 exec, s[50:51]
    s_cbranch_scc0 L2_d42
    s_mov_b64 exec, s[82:83]
    s_nop 1
    v_mfma_f32_4x4x4_16b_bf16 v[88:91], v[12:13], v[84:85], 0
    s_nop 1
    v_mfma_f32_4x4x4_16b_bf16 v[88:91], v[10:11], v[86:87], v[88:91]
    s_nop 4
    v_cvt_pk_bf16_f32 v88, v88, v89
    v_cvt_pk_bf16_f32 v89, v90, v91
    ds_pk_add_bf16 v7, v88 offset:65408
    ds_pk_add_bf16 v7, v89 offset:65412
    s_mov_b64 exec, s[50:51]
    s_branch L2_d42
L2_xa43:
    s_cmp_eq_u32 s101, 1
    s_cbranch_scc1 L2_xc43
    v_lshlrev_b32 v89, 0, v96
    v_add_u32 v90, 140, v97
    v_bitop3_b32 v90, v89, v45, v90 bitop3:0x6a
    ds_write_b32 v98, v90 offset:28
    v_lshlrev_b32 v89, 4, v96
    v_add_u32 v90, 120, v97
    v_bitop3_b32 v90, v89, v45, v90 bitop3:0x6a
    ds_write_b32 v98, v90 offset:24
    v_lshlrev_b32 v89, 8, v96
    v_add_u32 v90, 100, v97
    v_bitop3_b32 v90, v89, v45, v90 bitop3:0x6a
    ds_write_b32 v98, v90 offset:20
L2_xc43:
    v_lshlrev_b32 v89, 12, v96
    v_add_u32 v90, 80, v97
    v_bitop3_b32 v90, v89, v45, v90 bitop3:0x6a
    ds_write_b32 v98, v90 offset:16
    s_branch L2_xb43
L2_xe43:
    v_cmp_lt_u32 vcc, 32, v99
    v_cmp_lt_u32 s[58:59], 31, v88
    v_lshrrev_b32 v89, 16, v96
    v_add_u32 v97, 80, v97
    s_or_b64 vcc, vcc, s[58:59]
    s_cbranch_scc1 L2_xs43
    v_lshlrev_b32 v89, v1, v89
    v_and_b32 v89, v45, v89
    v_cmp_ne_u32 vcc, 0, v89
    v_xor_b32 v90, v97, v89
    s_add_u32 s3, s37, s38
    v_mbcnt_lo_u32_b32 v98, vcc_lo, 0
    v_mbcnt_hi_u32_b32 v98, vcc_hi, v98
    s_bcnt1_i32_b64 s41, vcc
    v_lshl_add_u32 v98, v98, 2, s3
    s_lshl2_add_u32 s37, s41, s37
    s_mov_b64 exec, vcc
    ds_write_b32 v98, v90
    s_mov_b64 exec, -1
    s_branch L2_xr43
L2_xs43:
    s_waitcnt lgkmcnt(0)
    s_mov_b32 s37, 0x10000
    s_branch L2_xw43
L2_c44:
    s_lshl_b64 s[52:53], s[82:83], 1
    s_andn2_b64 s[52:53], s[52:53], s[80:81]
    s_andn2_b64 s[52:53], s[52:53], s[54:55]
    s_or_b64 s[80:81], s[80:81], s[52:53]
    s_not_b64 vcc, s[52:53]
    s_mov_b64 exec, -1
    v_cndmask_b32_dpp v84, v84, v84, vcc wave_shr:1 row_mask:0xf bank_mask:0xf
    v_cndmask_b32_dpp v85, v85, v85, vcc wave_shr:1 row_mask:0xf bank_mask:0xf
    s_lshr_b64 s[52:53], s[52:53], 1
    v_cndmask_b32_dpp v86, v86, v86, vcc wave_shr:1 row_mask:0xf bank_mask:0xf
    v_cndmask_b32_dpp v87, v87, v87, vcc wave_shr:1 row_mask:0xf bank_mask:0xf
    s_andn2_b64 s[82:83], s[82:83], s[52:53]
    v_cndmask_b32_dpp v7, v7, v7, vcc wave_shr:1 row_mask:0xf bank_mask:0xf
    s_mov_b64 exec, s[54:55]
    s_cbranch_scc0 L2_d44
    s_mov_b64 exec, s[82:83]
    s_nop 1
    v_mfma_f32_4x4x4_16b_bf16 v[88:91], v[12:13], v[84:85], 0
    s_nop 1
    v_mfma_f32_4x4x4_16b_bf16 v[88:91], v[10:11], v[86:87], v[88:91]
    s_nop 4
    v_cvt_pk_bf16_f32 v88, v88, v89
    v_cvt_pk_bf16_f32 v89, v90, v91
    ds_pk_add_bf16 v7, v88 offset:65408
    ds_pk_add_bf16 v7, v89 offset:65412
    s_mov_b64 exec, s[54:55]
    s_branch L2_d44
L2_c45:
    s_lshl_b64 s[52:53], s[82:83], 1
    s_andn2_b64 s[52:53], s[52:53], s[80:81]
    s_andn2_b64 s[52:53], s[52:53], s[50:51]
    s_or_b64 s[80:81], s[80:81], s[52:53]
    s_not_b64 vcc, s[52:53]
    s_mov_b64 exec, -1
    v_cndmask_b32_dpp v84, v84, v84, vcc wave_shr:1 row_mask:0xf bank_mask:0xf
    v_cndmask_b32_dpp v85, v85, v85, vcc wave_shr:1 row_mask:0xf bank_mask:0xf
    s_lshr_b64 s[52:53], s[52:53], 1
    v_cndmask_b32_dpp v86, v86, v86, vcc wave_shr:1 row_mask:0xf bank_mask:0xf
    v_cndmask_b32_dpp v87, v87, v87, vcc wave_shr:1 row_mask:0xf bank_mask:0xf
    s_andn2_b64 s[82:83], s[82:83], s[52:53]
    v_cndmask_b32_dpp v7, v7, v7, vcc wave_shr:1 row_mask:0xf bank_mask:0xf
    s_mov_b64 exec, s[50:51]
    s_cbranch_scc0 L2_d45
    s_mov_b64 exec, s[82:83]
    s_nop 1
    v_mfma_f32_4x4x4_16b_bf16 v[88:91], v[12:13], v[84:85], 0
    s_nop 1
    v_mfma_f32_4x4x4_16b_bf16 v[88:91], v[10:11], v[86:87], v[88:91]
    s_nop 4
    v_cvt_pk_bf16_f32 v88, v88, v89
    v_cvt_pk_bf16_f32 v89, v90, v91
    ds_pk_add_bf16 v7, v88 offset:65408
    ds_pk_add_bf16 v7, v89 offset:65412
    s_mov_b64 exec, s[50:51]
    s_branch L2_d45
L2_xf43:
    s_cmp_gt_u32 s37, 1024
    s_cbranch_scc1 L2_xt43
    s_cmp_lt_u32 s37, 768
    s_cbranch_scc1 L2_xl43
    ds_read_b32 v33, v44 offset:896
    s_add_u32 s3, s42, 2
    s_bitset1_b32 s43, s3
    s_branch L2_xg43
L2_xl43:
    s_waitcnt lgkmcnt(0)
    v_mov_b32 v42, -1
    s_cmp_ge_u32 s37, 512
    s_cbranch_scc1 L2_xg43
    v_mov_b32 v43, -1
    s_cmp_ge_u32 s37, 256
    s_cbranch_scc1 L2_xg43
    v_mov_b32 v41, -1
    s_branch L2_xg43
L2_xt43:
    s_waitcnt lgkmcnt(0)
    v_mov_b32 v40, -1
    v_mov_b32 v41, -1
    v_mov_b32 v43, -1
    v_mov_b32 v42, -1
    s_add_u32 s3, s42, 2
    s_bitset1_b32 s36, s3
    s_branch L2_xg43
L2_oa46:
    v_and_b32 v47, 0x0fffffff, v32
    buffer_load_dword v114, v47, s[8:11], 0 offen offset:16
    s_mov_b64 exec, s[6:7]
    v_add_u32 v47, 8, v47
    v_lshrrev_b32 v32, 2, v32
    s_mov_b64 exec, -1
    buffer_load_dwordx2 v[112:113], v47, s[8:11], 0 offen
    s_branch L2_ob46
L2_c47:
    s_lshl_b64 s[52:53], s[82:83], 1
    s_andn2_b64 s[52:53], s[52:53], s[80:81]
    s_andn2_b64 s[52:53], s[52:53], s[54:55]
    s_or_b64 s[80:81], s[80:81], s[52:53]
    s_not_b64 vcc, s[52:53]
    s_mov_b64 exec, -1
    v_cndmask_b32_dpp v84, v84, v84, vcc wave_shr:1 row_mask:0xf bank_mask:0xf
    v_cndmask_b32_dpp v85, v85, v85, vcc wave_shr:1 row_mask:0xf bank_mask:0xf
    s_lshr_b64 s[52:53], s[52:53], 1
    v_cndmask_b32_dpp v86, v86, v86, vcc wave_shr:1 row_mask:0xf bank_mask:0xf
    v_cndmask_b32_dpp v87, v87, v87, vcc wave_shr:1 row_mask:0xf bank_mask:0xf
    s_andn2_b64 s[82:83], s[82:83], s[52:53]
    v_cndmask_b32_dpp v7, v7, v7, vcc wave_shr:1 row_mask:0xf bank_mask:0xf
    s_mov_b64 exec, s[54:55]
    s_cbranch_scc0 L2_d47
    s_mov_b64 exec, s[82:83]
    s_nop 1
    v_mfma_f32_4x4x4_16b_bf16 v[88:91], v[12:13], v[84:85], 0
    s_nop 1
    v_mfma_f32_4x4x4_16b_bf16 v[88:91], v[10:11], v[86:87], v[88:91]
    s_nop 4
    v_cvt_pk_bf16_f32 v88, v88, v89
    v_cvt_pk_bf16_f32 v89, v90, v91
    ds_pk_add_bf16 v7, v88 offset:65408
    ds_pk_add_bf16 v7, v89 offset:65412
    s_mov_b64 exec, s[54:55]
    s_branch L2_d47
L2_c48:
    s_lshl_b64 s[52:53], s[82:83], 1
    s_andn2_b64 s[52:53], s[52:53], s[80:81]
    s_andn2_b64 s[52:53], s[52:53], s[50:51]
    s_or_b64 s[80:81], s[80:81], s[52:53]
    s_not_b64 vcc, s[52:53]
    s_mov_b64 exec, -1
    v_cndmask_b32_dpp v84, v84, v84, vcc wave_shr:1 row_mask:0xf bank_mask:0xf
    v_cndmask_b32_dpp v85, v85, v85, vcc wave_shr:1 row_mask:0xf bank_mask:0xf
    s_lshr_b64 s[52:53], s[52:53], 1
    v_cndmask_b32_dpp v86, v86, v86, vcc wave_shr:1 row_mask:0xf bank_mask:0xf
    v_cndmask_b32_dpp v87, v87, v87, vcc wave_shr:1 row_mask:0xf bank_mask:0xf
    s_andn2_b64 s[82:83], s[82:83], s[52:53]
    v_cndmask_b32_dpp v7, v7, v7, vcc wave_shr:1 row_mask:0xf bank_mask:0xf
    s_mov_b64 exec, s[50:51]
    s_cbranch_scc0 L2_d48
    s_mov_b64 exec, s[82:83]
    s_nop 1
    v_mfma_f32_4x4x4_16b_bf16 v[88:91], v[12:13], v[84:85], 0
    s_nop 1
    v_mfma_f32_4x4x4_16b_bf16 v[88:91], v[10:11], v[86:87], v[88:91]
    s_nop 4
    v_cvt_pk_bf16_f32 v88, v88, v89
    v_cvt_pk_bf16_f32 v89, v90, v91
    ds_pk_add_bf16 v7, v88 offset:65408
    ds_pk_add_bf16 v7, v89 offset:65412
    s_mov_b64 exec, s[50:51]
    s_branch L2_d48
L2_c49:
    s_lshl_b64 s[52:53], s[82:83], 1
    s_andn2_b64 s[52:53], s[52:53], s[80:81]
    s_andn2_b64 s[52:53], s[52:53], s[54:55]
    s_or_b64 s[80:81], s[80:81], s[52:53]
    s_not_b64 vcc, s[52:53]
    s_mov_b64 exec, -1
    v_cndmask_b32_dpp v84, v84, v84, vcc wave_shr:1 row_mask:0xf bank_mask:0xf
    v_cndmask_b32_dpp v85, v85, v85, vcc wave_shr:1 row_mask:0xf bank_mask:0xf
    s_lshr_b64 s[52:53], s[52:53], 1
    v_cndmask_b32_dpp v86, v86, v86, vcc wave_shr:1 row_mask:0xf bank_mask:0xf
    v_cndmask_b32_dpp v87, v87, v87, vcc wave_shr:1 row_mask:0xf bank_mask:0xf
    s_andn2_b64 s[82:83], s[82:83], s[52:53]
    v_cndmask_b32_dpp v7, v7, v7, vcc wave_shr:1 row_mask:0xf bank_mask:0xf
    s_mov_b64 exec, s[54:55]
    s_cbranch_scc0 L2_d49
    s_mov_b64 exec, s[82:83]
    s_nop 1
    v_mfma_f32_4x4x4_16b_bf16 v[88:91], v[12:13], v[84:85], 0
    s_nop 1
    v_mfma_f32_4x4x4_16b_bf16 v[88:91], v[10:11], v[86:87], v[88:91]
    s_nop 4
    v_cvt_pk_bf16_f32 v88, v88, v89
    v_cvt_pk_bf16_f32 v89, v90, v91
    ds_pk_add_bf16 v7, v88 offset:65408
    ds_pk_add_bf16 v7, v89 offset:65412
    s_mov_b64 exec, s[54:55]
    s_branch L2_d49
L2_c50:
    s_lshl_b64 s[52:53], s[82:83], 1
    s_andn2_b64 s[52:53], s[52:53], s[80:81]
    s_andn2_b64 s[52:53], s[52:53], s[50:51]
    s_or_b64 s[80:81], s[80:81], s[52:53]
    s_not_b64 vcc, s[52:53]
    s_mov_b64 exec, -1
    v_cndmask_b32_dpp v84, v84, v84, vcc wave_shr:1 row_mask:0xf bank_mask:0xf
    v_cndmask_b32_dpp v85, v85, v85, vcc wave_shr:1 row_mask:0xf bank_mask:0xf
    s_lshr_b64 s[52:53], s[52:53], 1
    v_cndmask_b32_dpp v86, v86, v86, vcc wave_shr:1 row_mask:0xf bank_mask:0xf
    v_cndmask_b32_dpp v87, v87, v87, vcc wave_shr:1 row_mask:0xf bank_mask:0xf
    s_andn2_b64 s[82:83], s[82:83], s[52:53]
    v_cndmask_b32_dpp v7, v7, v7, vcc wave_shr:1 row_mask:0xf bank_mask:0xf
    s_mov_b64 exec, s[50:51]
    s_cbranch_scc0 L2_d50
    s_mov_b64 exec, s[82:83]
    s_nop 1
    v_mfma_f32_4x4x4_16b_bf16 v[88:91], v[12:13], v[84:85], 0
    s_nop 1
    v_mfma_f32_4x4x4_16b_bf16 v[88:91], v[10:11], v[86:87], v[88:91]
    s_nop 4
    v_cvt_pk_bf16_f32 v88, v88, v89
    v_cvt_pk_bf16_f32 v89, v90, v91
    ds_pk_add_bf16 v7, v88 offset:65408
    ds_pk_add_bf16 v7, v89 offset:65412
    s_mov_b64 exec, s[50:51]
    s_branch L2_d50
L2_c51:
    s_lshl_b64 s[52:53], s[82:83], 1
    s_andn2_b64 s[52:53], s[52:53], s[80:81]
    s_andn2_b64 s[52:53], s[52:53], s[54:55]
    s_or_b64 s[80:81], s[80:81], s[52:53]
    s_not_b64 vcc, s[52:53]
    s_mov_b64 exec, -1
    v_cndmask_b32_dpp v84, v84, v84, vcc wave_shr:1 row_mask:0xf bank_mask:0xf
    v_cndmask_b32_dpp v85, v85, v85, vcc wave_shr:1 row_mask:0xf bank_mask:0xf
    s_lshr_b64 s[52:53], s[52:53], 1
    v_cndmask_b32_dpp v86, v86, v86, vcc wave_shr:1 row_mask:0xf bank_mask:0xf
    v_cndmask_b32_dpp v87, v87, v87, vcc wave_shr:1 row_mask:0xf bank_mask:0xf
    s_andn2_b64 s[82:83], s[82:83], s[52:53]
    v_cndmask_b32_dpp v7, v7, v7, vcc wave_shr:1 row_mask:0xf bank_mask:0xf
    s_mov_b64 exec, s[54:55]
    s_cbranch_scc0 L2_d51
    s_mov_b64 exec, s[82:83]
    s_nop 1
    v_mfma_f32_4x4x4_16b_bf16 v[88:91], v[12:13], v[84:85], 0
    s_nop 1
    v_mfma_f32_4x4x4_16b_bf16 v[88:91], v[10:11], v[86:87], v[88:91]
    s_nop 4
    v_cvt_pk_bf16_f32 v88, v88, v89
    v_cvt_pk_bf16_f32 v89, v90, v91
    ds_pk_add_bf16 v7, v88 offset:65408
    ds_pk_add_bf16 v7, v89 offset:65412
    s_mov_b64 exec, s[54:55]
    s_branch L2_d51
L2_c52:
    s_lshl_b64 s[52:53], s[82:83], 1
    s_andn2_b64 s[52:53], s[52:53], s[80:81]
    s_andn2_b64 s[52:53], s[52:53], s[50:51]
    s_or_b64 s[80:81], s[80:81], s[52:53]
    s_not_b64 vcc, s[52:53]
    s_mov_b64 exec, -1
    v_cndmask_b32_dpp v84, v84, v84, vcc wave_shr:1 row_mask:0xf bank_mask:0xf
    v_cndmask_b32_dpp v85, v85, v85, vcc wave_shr:1 row_mask:0xf bank_mask:0xf
    s_lshr_b64 s[52:53], s[52:53], 1
    v_cndmask_b32_dpp v86, v86, v86, vcc wave_shr:1 row_mask:0xf bank_mask:0xf
    v_cndmask_b32_dpp v87, v87, v87, vcc wave_shr:1 row_mask:0xf bank_mask:0xf
    s_andn2_b64 s[82:83], s[82:83], s[52:53]
    v_cndmask_b32_dpp v7, v7, v7, vcc wave_shr:1 row_mask:0xf bank_mask:0xf
    s_mov_b64 exec, s[50:51]
    s_cbranch_scc0 L2_d52
    s_mov_b64 exec, s[82:83]
    s_nop 1
    v_mfma_f32_4x4x4_16b_bf16 v[88:91], v[12:13], v[84:85], 0
    s_nop 1
    v_mfma_f32_4x4x4_16b_bf16 v[88:91], v[10:11], v[86:87], v[88:91]
    s_nop 4
    v_cvt_pk_bf16_f32 v88, v88, v89
    v_cvt_pk_bf16_f32 v89, v90, v91
    ds_pk_add_bf16 v7, v88 offset:65408
    ds_pk_add_bf16 v7, v89 offset:65412
    s_mov_b64 exec, s[50:51]
    s_branch L2_d52
L2_oa53:
    s_waitcnt vmcnt(3)
    s_mov_b64 exec, s[6:7]
    v_lshrrev_b32 v114, 16, v114
    s_mov_b64 exec, -1
    v_and_b32 v46, 0x10000000, v32
    v_cmpx_eq_u32 vcc, 0, v46
    v_lshrrev_b32 v47, 14, v112
    v_and_b32 v47, v5, v47
    ds_read_b64 v[96:97], v47
    v_perm_b32 v98, v112, v114, s44
    v_bitop3_b32 v99, v112, 0.5, -0.5 bitop3:0xa8
    v_bitop3_b32 v98, v6, v98, v99 bitop3:0xca
    v_and_b32 v47, v5, v112
    s_waitcnt lgkmcnt(0)
    v_mfma_f32_4x4x4_16b_bf16 v[88:91], v[8:9], v[96:97], 0
    s_nop 4
    v_mul_f32 v88, v98, v88
    v_mul_f32 v89, v98, v89
    v_mul_f32 v90, v98, v90
    v_mul_f32 v91, v98, v91
    v_cvt_pk_bf16_f32 v88, v88, v89
    v_cvt_pk_bf16_f32 v89, v90, v91
    ds_pk_add_bf16 v47, v88 offset:65408
    ds_pk_add_bf16 v47, v89 offset:65412
    s_mov_b64 exec, -1
    v_and_b32 v46, 0x20000000, v32
    v_cmpx_eq_u32 vcc, 0, v46
    v_lshrrev_b32 v47, 14, v113
    v_and_b32 v47, v5, v47
    ds_read_b64 v[96:97], v47
    v_perm_b32 v98, v113, v114, s45
    v_bitop3_b32 v99, v113, 0.5, -0.5 bitop3:0xa8
    v_bitop3_b32 v98, v6, v98, v99 bitop3:0xca
    v_and_b32 v47, v5, v113
    s_waitcnt lgkmcnt(0)
    v_mfma_f32_4x4x4_16b_bf16 v[88:91], v[8:9], v[96:97], 0
    s_nop 4
    v_mul_f32 v88, v98, v88
    v_mul_f32 v89, v98, v89
    v_mul_f32 v90, v98, v90
    v_mul_f32 v91, v98, v91
    v_cvt_pk_bf16_f32 v88, v88, v89
    v_cvt_pk_bf16_f32 v89, v90, v91
    ds_pk_add_bf16 v47, v88 offset:65408
    ds_pk_add_bf16 v47, v89 offset:65412
    s_mov_b64 exec, -1
    s_branch L2_ob53
L2_xo54:
    v_cmp_lt_u32 vcc, 20, v99
    s_mov_b32 s101, 1
    s_cbranch_vccz L2_xp54
    v_cmp_lt_u32 vcc, 32, v99
    v_cmp_lt_u32 s[58:59], 31, v88
    s_mov_b32 s101, 2
    s_or_b64 vcc, vcc, s[58:59]
    s_cbranch_scc0 L2_xp54
    s_mov_b32 s37, 0x10000
    s_branch L2_xp54
L2_c55:
    s_lshl_b64 s[52:53], s[82:83], 1
    s_andn2_b64 s[52:53], s[52:53], s[80:81]
    s_andn2_b64 s[52:53], s[52:53], s[54:55]
    s_or_b64 s[80:81], s[80:81], s[52:53]
    s_not_b64 vcc, s[52:53]
    s_mov_b64 exec, -1
    v_cndmask_b32_dpp v84, v84, v84, vcc wave_shr:1 row_mask:0xf bank_mask:0xf
    v_cndmask_b32_dpp v85, v85, v85, vcc wave_shr:1 row_mask:0xf bank_mask:0xf
    s_lshr_b64 s[52:53], s[52:53], 1
    v_cndmask_b32_dpp v86, v86, v86, vcc wave_shr:1 row_mask:0xf bank_mask:0xf
    v_cndmask_b32_dpp v87, v87, v87, vcc wave_shr:1 row_mask:0xf bank_mask:0xf
    s_andn2_b64 s[82:83], s[82:83], s[52:53]
    v_cndmask_b32_dpp v7, v7, v7, vcc wave_shr:1 row_mask:0xf bank_mask:0xf
    s_mov_b64 exec, s[54:55]
    s_cbranch_scc0 L2_d55
    s_mov_b64 exec, s[82:83]
    s_nop 1
    v_mfma_f32_4x4x4_16b_bf16 v[88:91], v[12:13], v[84:85], 0
    s_nop 1
    v_mfma_f32_4x4x4_16b_bf16 v[88:91], v[10:11], v[86:87], v[88:91]
    s_nop 4
    v_cvt_pk_bf16_f32 v88, v88, v89
    v_cvt_pk_bf16_f32 v89, v90, v91
    ds_pk_add_bf16 v7, v88 offset:65408
    ds_pk_add_bf16 v7, v89 offset:65412
    s_mov_b64 exec, s[54:55]
    s_branch L2_d55
L2_c56:
    s_lshl_b64 s[52:53], s[82:83], 1
    s_andn2_b64 s[52:53], s[52:53], s[80:81]
    s_andn2_b64 s[52:53], s[52:53], s[50:51]
    s_or_b64 s[80:81], s[80:81], s[52:53]
    s_not_b64 vcc, s[52:53]
    s_mov_b64 exec, -1
    v_cndmask_b32_dpp v84, v84, v84, vcc wave_shr:1 row_mask:0xf bank_mask:0xf
    v_cndmask_b32_dpp v85, v85, v85, vcc wave_shr:1 row_mask:0xf bank_mask:0xf
    s_lshr_b64 s[52:53], s[52:53], 1
    v_cndmask_b32_dpp v86, v86, v86, vcc wave_shr:1 row_mask:0xf bank_mask:0xf
    v_cndmask_b32_dpp v87, v87, v87, vcc wave_shr:1 row_mask:0xf bank_mask:0xf
    s_andn2_b64 s[82:83], s[82:83], s[52:53]
    v_cndmask_b32_dpp v7, v7, v7, vcc wave_shr:1 row_mask:0xf bank_mask:0xf
    s_mov_b64 exec, s[50:51]
    s_cbranch_scc0 L2_d56
    s_mov_b64 exec, s[82:83]
    s_nop 1
    v_mfma_f32_4x4x4_16b_bf16 v[88:91], v[12:13], v[84:85], 0
    s_nop 1
    v_mfma_f32_4x4x4_16b_bf16 v[88:91], v[10:11], v[86:87], v[88:91]
    s_nop 4
    v_cvt_pk_bf16_f32 v88, v88, v89
    v_cvt_pk_bf16_f32 v89, v90, v91
    ds_pk_add_bf16 v7, v88 offset:65408
    ds_pk_add_bf16 v7, v89 offset:65412
    s_mov_b64 exec, s[50:51]
    s_branch L2_d56
L2_c57:
    s_lshl_b64 s[52:53], s[82:83], 1
    s_andn2_b64 s[52:53], s[52:53], s[80:81]
    s_andn2_b64 s[52:53], s[52:53], s[54:55]
    s_or_b64 s[80:81], s[80:81], s[52:53]
    s_not_b64 vcc, s[52:53]
    s_mov_b64 exec, -1
    v_cndmask_b32_dpp v84, v84, v84, vcc wave_shr:1 row_mask:0xf bank_mask:0xf
    v_cndmask_b32_dpp v85, v85, v85, vcc wave_shr:1 row_mask:0xf bank_mask:0xf
    s_lshr_b64 s[52:53], s[52:53], 1
    v_cndmask_b32_dpp v86, v86, v86, vcc wave_shr:1 row_mask:0xf bank_mask:0xf
    v_cndmask_b32_dpp v87, v87, v87, vcc wave_shr:1 row_mask:0xf bank_mask:0xf
    s_andn2_b64 s[82:83], s[82:83], s[52:53]
    v_cndmask_b32_dpp v7, v7, v7, vcc wave_shr:1 row_mask:0xf bank_mask:0xf
    s_mov_b64 exec, s[54:55]
    s_cbranch_scc0 L2_d57
    s_mov_b64 exec, s[82:83]
    s_nop 1
    v_mfma_f32_4x4x4_16b_bf16 v[88:91], v[12:13], v[84:85], 0
    s_nop 1
    v_mfma_f32_4x4x4_16b_bf16 v[88:91], v[10:11], v[86:87], v[88:91]
    s_nop 4
    v_cvt_pk_bf16_f32 v88, v88, v89
    v_cvt_pk_bf16_f32 v89, v90, v91
    ds_pk_add_bf16 v7, v88 offset:65408
    ds_pk_add_bf16 v7, v89 offset:65412
    s_mov_b64 exec, s[54:55]
    s_branch L2_d57
L2_c58:
    s_lshl_b64 s[52:53], s[82:83], 1
    s_andn2_b64 s[52:53], s[52:53], s[80:81]
    s_andn2_b64 s[52:53], s[52:53], s[50:51]
    s_or_b64 s[80:81], s[80:81], s[52:53]
    s_not_b64 vcc, s[52:53]
    s_mov_b64 exec, -1
    v_cndmask_b32_dpp v84, v84, v84, vcc wave_shr:1 row_mask:0xf bank_mask:0xf
    v_cndmask_b32_dpp v85, v85, v85, vcc wave_shr:1 row_mask:0xf bank_mask:0xf
    s_lshr_b64 s[52:53], s[52:53], 1
    v_cndmask_b32_dpp v86, v86, v86, vcc wave_shr:1 row_mask:0xf bank_mask:0xf
    v_cndmask_b32_dpp v87, v87, v87, vcc wave_shr:1 row_mask:0xf bank_mask:0xf
    s_andn2_b64 s[82:83], s[82:83], s[52:53]
    v_cndmask_b32_dpp v7, v7, v7, vcc wave_shr:1 row_mask:0xf bank_mask:0xf
    s_mov_b64 exec, s[50:51]
    s_cbranch_scc0 L2_d58
    s_mov_b64 exec, s[82:83]
    s_nop 1
    v_mfma_f32_4x4x4_16b_bf16 v[88:91], v[12:13], v[84:85], 0
    s_nop 1
    v_mfma_f32_4x4x4_16b_bf16 v[88:91], v[10:11], v[86:87], v[88:91]
    s_nop 4
    v_cvt_pk_bf16_f32 v88, v88, v89
    v_cvt_pk_bf16_f32 v89, v90, v91
    ds_pk_add_bf16 v7, v88 offset:65408
    ds_pk_add_bf16 v7, v89 offset:65412
    s_mov_b64 exec, s[50:51]
    s_branch L2_d58
L2_c59:
    s_lshl_b64 s[52:53], s[82:83], 1
    s_andn2_b64 s[52:53], s[52:53], s[80:81]
    s_andn2_b64 s[52:53], s[52:53], s[54:55]
    s_or_b64 s[80:81], s[80:81], s[52:53]
    s_not_b64 vcc, s[52:53]
    s_mov_b64 exec, -1
    v_cndmask_b32_dpp v84, v84, v84, vcc wave_shr:1 row_mask:0xf bank_mask:0xf
    v_cndmask_b32_dpp v85, v85, v85, vcc wave_shr:1 row_mask:0xf bank_mask:0xf
    s_lshr_b64 s[52:53], s[52:53], 1
    v_cndmask_b32_dpp v86, v86, v86, vcc wave_shr:1 row_mask:0xf bank_mask:0xf
    v_cndmask_b32_dpp v87, v87, v87, vcc wave_shr:1 row_mask:0xf bank_mask:0xf
    s_andn2_b64 s[82:83], s[82:83], s[52:53]
    v_cndmask_b32_dpp v7, v7, v7, vcc wave_shr:1 row_mask:0xf bank_mask:0xf
    s_mov_b64 exec, s[54:55]
    s_cbranch_scc0 L2_d59
    s_mov_b64 exec, s[82:83]
    s_nop 1
    v_mfma_f32_4x4x4_16b_bf16 v[88:91], v[12:13], v[84:85], 0
    s_nop 1
    v_mfma_f32_4x4x4_16b_bf16 v[88:91], v[10:11], v[86:87], v[88:91]
    s_nop 4
    v_cvt_pk_bf16_f32 v88, v88, v89
    v_cvt_pk_bf16_f32 v89, v90, v91
    ds_pk_add_bf16 v7, v88 offset:65408
    ds_pk_add_bf16 v7, v89 offset:65412
    s_mov_b64 exec, s[54:55]
    s_branch L2_d59
L2_c60:
    s_lshl_b64 s[52:53], s[82:83], 1
    s_andn2_b64 s[52:53], s[52:53], s[80:81]
    s_andn2_b64 s[52:53], s[52:53], s[50:51]
    s_or_b64 s[80:81], s[80:81], s[52:53]
    s_not_b64 vcc, s[52:53]
    s_mov_b64 exec, -1
    v_cndmask_b32_dpp v84, v84, v84, vcc wave_shr:1 row_mask:0xf bank_mask:0xf
    v_cndmask_b32_dpp v85, v85, v85, vcc wave_shr:1 row_mask:0xf bank_mask:0xf
    s_lshr_b64 s[52:53], s[52:53], 1
    v_cndmask_b32_dpp v86, v86, v86, vcc wave_shr:1 row_mask:0xf bank_mask:0xf
    v_cndmask_b32_dpp v87, v87, v87, vcc wave_shr:1 row_mask:0xf bank_mask:0xf
    s_andn2_b64 s[82:83], s[82:83], s[52:53]
    v_cndmask_b32_dpp v7, v7, v7, vcc wave_shr:1 row_mask:0xf bank_mask:0xf
    s_mov_b64 exec, s[50:51]
    s_cbranch_scc0 L2_d60
    s_mov_b64 exec, s[82:83]
    s_nop 1
    v_mfma_f32_4x4x4_16b_bf16 v[88:91], v[12:13], v[84:85], 0
    s_nop 1
    v_mfma_f32_4x4x4_16b_bf16 v[88:91], v[10:11], v[86:87], v[88:91]
    s_nop 4
    v_cvt_pk_bf16_f32 v88, v88, v89
    v_cvt_pk_bf16_f32 v89, v90, v91
    ds_pk_add_bf16 v7, v88 offset:65408
    ds_pk_add_bf16 v7, v89 offset:65412
    s_mov_b64 exec, s[50:51]
    s_branch L2_d60
L2_xa61:
    s_cmp_eq_u32 s101, 1
    s_cbranch_scc1 L2_xc61
    v_lshlrev_b32 v89, 0, v96
    v_add_u32 v90, 140, v97
    v_bitop3_b32 v90, v89, v45, v90 bitop3:0x6a
    ds_write_b32 v98, v90 offset:28
    v_lshlrev_b32 v89, 4, v96
    v_add_u32 v90, 120, v97
    v_bitop3_b32 v90, v89, v45, v90 bitop3:0x6a
    ds_write_b32 v98, v90 offset:24
    v_lshlrev_b32 v89, 8, v96
    v_add_u32 v90, 100, v97
    v_bitop3_b32 v90, v89, v45, v90 bitop3:0x6a
    ds_write_b32 v98, v90 offset:20
L2_xc61:
    v_lshlrev_b32 v89, 12, v96
    v_add_u32 v90, 80, v97
    v_bitop3_b32 v90, v89, v45, v90 bitop3:0x6a
    ds_write_b32 v98, v90 offset:16
    s_branch L2_xb61
L2_xe61:
    v_cmp_lt_u32 vcc, 32, v99
    v_cmp_lt_u32 s[58:59], 31, v88
    v_lshrrev_b32 v89, 16, v96
    v_add_u32 v97, 80, v97
    s_or_b64 vcc, vcc, s[58:59]
    s_cbranch_scc1 L2_xs61
    v_lshlrev_b32 v89, v1, v89
    v_and_b32 v89, v45, v89
    v_cmp_ne_u32 vcc, 0, v89
    v_xor_b32 v90, v97, v89
    s_add_u32 s3, s37, s38
    v_mbcnt_lo_u32_b32 v98, vcc_lo, 0
    v_mbcnt_hi_u32_b32 v98, vcc_hi, v98
    s_bcnt1_i32_b64 s41, vcc
    v_lshl_add_u32 v98, v98, 2, s3
    s_lshl2_add_u32 s37, s41, s37
    s_mov_b64 exec, vcc
    ds_write_b32 v98, v90
    s_mov_b64 exec, -1
    s_branch L2_xr61
L2_xs61:
    s_waitcnt lgkmcnt(0)
    s_mov_b32 s37, 0x10000
    s_branch L2_xw61
L2_c62:
    s_lshl_b64 s[52:53], s[82:83], 1
    s_andn2_b64 s[52:53], s[52:53], s[80:81]
    s_andn2_b64 s[52:53], s[52:53], s[54:55]
    s_or_b64 s[80:81], s[80:81], s[52:53]
    s_not_b64 vcc, s[52:53]
    s_mov_b64 exec, -1
    v_cndmask_b32_dpp v84, v84, v84, vcc wave_shr:1 row_mask:0xf bank_mask:0xf
    v_cndmask_b32_dpp v85, v85, v85, vcc wave_shr:1 row_mask:0xf bank_mask:0xf
    s_lshr_b64 s[52:53], s[52:53], 1
    v_cndmask_b32_dpp v86, v86, v86, vcc wave_shr:1 row_mask:0xf bank_mask:0xf
    v_cndmask_b32_dpp v87, v87, v87, vcc wave_shr:1 row_mask:0xf bank_mask:0xf
    s_andn2_b64 s[82:83], s[82:83], s[52:53]
    v_cndmask_b32_dpp v7, v7, v7, vcc wave_shr:1 row_mask:0xf bank_mask:0xf
    s_mov_b64 exec, s[54:55]
    s_cbranch_scc0 L2_d62
    s_mov_b64 exec, s[82:83]
    s_nop 1
    v_mfma_f32_4x4x4_16b_bf16 v[88:91], v[12:13], v[84:85], 0
    s_nop 1
    v_mfma_f32_4x4x4_16b_bf16 v[88:91], v[10:11], v[86:87], v[88:91]
    s_nop 4
    v_cvt_pk_bf16_f32 v88, v88, v89
    v_cvt_pk_bf16_f32 v89, v90, v91
    ds_pk_add_bf16 v7, v88 offset:65408
    ds_pk_add_bf16 v7, v89 offset:65412
    s_mov_b64 exec, s[54:55]
    s_branch L2_d62
L2_c63:
    s_lshl_b64 s[52:53], s[82:83], 1
    s_andn2_b64 s[52:53], s[52:53], s[80:81]
    s_andn2_b64 s[52:53], s[52:53], s[50:51]
    s_or_b64 s[80:81], s[80:81], s[52:53]
    s_not_b64 vcc, s[52:53]
    s_mov_b64 exec, -1
    v_cndmask_b32_dpp v84, v84, v84, vcc wave_shr:1 row_mask:0xf bank_mask:0xf
    v_cndmask_b32_dpp v85, v85, v85, vcc wave_shr:1 row_mask:0xf bank_mask:0xf
    s_lshr_b64 s[52:53], s[52:53], 1
    v_cndmask_b32_dpp v86, v86, v86, vcc wave_shr:1 row_mask:0xf bank_mask:0xf
    v_cndmask_b32_dpp v87, v87, v87, vcc wave_shr:1 row_mask:0xf bank_mask:0xf
    s_andn2_b64 s[82:83], s[82:83], s[52:53]
    v_cndmask_b32_dpp v7, v7, v7, vcc wave_shr:1 row_mask:0xf bank_mask:0xf
    s_mov_b64 exec, s[50:51]
    s_cbranch_scc0 L2_d63
    s_mov_b64 exec, s[82:83]
    s_nop 1
    v_mfma_f32_4x4x4_16b_bf16 v[88:91], v[12:13], v[84:85], 0
    s_nop 1
    v_mfma_f32_4x4x4_16b_bf16 v[88:91], v[10:11], v[86:87], v[88:91]
    s_nop 4
    v_cvt_pk_bf16_f32 v88, v88, v89
    v_cvt_pk_bf16_f32 v89, v90, v91
    ds_pk_add_bf16 v7, v88 offset:65408
    ds_pk_add_bf16 v7, v89 offset:65412
    s_mov_b64 exec, s[50:51]
    s_branch L2_d63
L2_xf61:
    s_cmp_gt_u32 s37, 1024
    s_cbranch_scc1 L2_xt61
    s_cmp_lt_u32 s37, 768
    s_cbranch_scc1 L2_xl61
    ds_read_b32 v32, v44 offset:896
    s_add_u32 s3, s42, 2
    s_bitset1_b32 s43, s3
    s_branch L2_xg61
L2_xl61:
    s_waitcnt lgkmcnt(0)
    v_mov_b32 v31, -1
    s_cmp_ge_u32 s37, 512
    s_cbranch_scc1 L2_xg61
    v_mov_b32 v39, -1
    s_cmp_ge_u32 s37, 256
    s_cbranch_scc1 L2_xg61
    v_mov_b32 v27, -1
    s_branch L2_xg61
L2_xt61:
    s_waitcnt lgkmcnt(0)
    v_mov_b32 v21, -1
    v_mov_b32 v27, -1
    v_mov_b32 v39, -1
    v_mov_b32 v31, -1
    s_add_u32 s3, s42, 2
    s_bitset1_b32 s36, s3
    s_branch L2_xg61
L2_oa64:
    v_and_b32 v47, 0x0fffffff, v33
    buffer_load_dword v114, v47, s[8:11], 0 offen offset:16
    s_mov_b64 exec, s[6:7]
    v_add_u32 v47, 8, v47
    v_lshrrev_b32 v33, 2, v33
    s_mov_b64 exec, -1
    buffer_load_dwordx2 v[112:113], v47, s[8:11], 0 offen
    s_branch L2_ob64
L2_c65:
    s_lshl_b64 s[52:53], s[82:83], 1
    s_andn2_b64 s[52:53], s[52:53], s[80:81]
    s_andn2_b64 s[52:53], s[52:53], s[54:55]
    s_or_b64 s[80:81], s[80:81], s[52:53]
    s_not_b64 vcc, s[52:53]
    s_mov_b64 exec, -1
    v_cndmask_b32_dpp v84, v84, v84, vcc wave_shr:1 row_mask:0xf bank_mask:0xf
    v_cndmask_b32_dpp v85, v85, v85, vcc wave_shr:1 row_mask:0xf bank_mask:0xf
    s_lshr_b64 s[52:53], s[52:53], 1
    v_cndmask_b32_dpp v86, v86, v86, vcc wave_shr:1 row_mask:0xf bank_mask:0xf
    v_cndmask_b32_dpp v87, v87, v87, vcc wave_shr:1 row_mask:0xf bank_mask:0xf
    s_andn2_b64 s[82:83], s[82:83], s[52:53]
    v_cndmask_b32_dpp v7, v7, v7, vcc wave_shr:1 row_mask:0xf bank_mask:0xf
    s_mov_b64 exec, s[54:55]
    s_cbranch_scc0 L2_d65
    s_mov_b64 exec, s[82:83]
    s_nop 1
    v_mfma_f32_4x4x4_16b_bf16 v[88:91], v[12:13], v[84:85], 0
    s_nop 1
    v_mfma_f32_4x4x4_16b_bf16 v[88:91], v[10:11], v[86:87], v[88:91]
    s_nop 4
    v_cvt_pk_bf16_f32 v88, v88, v89
    v_cvt_pk_bf16_f32 v89, v90, v91
    ds_pk_add_bf16 v7, v88 offset:65408
    ds_pk_add_bf16 v7, v89 offset:65412
    s_mov_b64 exec, s[54:55]
    s_branch L2_d65
L2_c66:
    s_lshl_b64 s[52:53], s[82:83], 1
    s_andn2_b64 s[52:53], s[52:53], s[80:81]
    s_andn2_b64 s[52:53], s[52:53], s[50:51]
    s_or_b64 s[80:81], s[80:81], s[52:53]
    s_not_b64 vcc, s[52:53]
    s_mov_b64 exec, -1
    v_cndmask_b32_dpp v84, v84, v84, vcc wave_shr:1 row_mask:0xf bank_mask:0xf
    v_cndmask_b32_dpp v85, v85, v85, vcc wave_shr:1 row_mask:0xf bank_mask:0xf
    s_lshr_b64 s[52:53], s[52:53], 1
    v_cndmask_b32_dpp v86, v86, v86, vcc wave_shr:1 row_mask:0xf bank_mask:0xf
    v_cndmask_b32_dpp v87, v87, v87, vcc wave_shr:1 row_mask:0xf bank_mask:0xf
    s_andn2_b64 s[82:83], s[82:83], s[52:53]
    v_cndmask_b32_dpp v7, v7, v7, vcc wave_shr:1 row_mask:0xf bank_mask:0xf
    s_mov_b64 exec, s[50:51]
    s_cbranch_scc0 L2_d66
    s_mov_b64 exec, s[82:83]
    s_nop 1
    v_mfma_f32_4x4x4_16b_bf16 v[88:91], v[12:13], v[84:85], 0
    s_nop 1
    v_mfma_f32_4x4x4_16b_bf16 v[88:91], v[10:11], v[86:87], v[88:91]
    s_nop 4
    v_cvt_pk_bf16_f32 v88, v88, v89
    v_cvt_pk_bf16_f32 v89, v90, v91
    ds_pk_add_bf16 v7, v88 offset:65408
    ds_pk_add_bf16 v7, v89 offset:65412
    s_mov_b64 exec, s[50:51]
    s_branch L2_d66
L2_c67:
    s_lshl_b64 s[52:53], s[82:83], 1
    s_andn2_b64 s[52:53], s[52:53], s[80:81]
    s_andn2_b64 s[52:53], s[52:53], s[54:55]
    s_or_b64 s[80:81], s[80:81], s[52:53]
    s_not_b64 vcc, s[52:53]
    s_mov_b64 exec, -1
    v_cndmask_b32_dpp v84, v84, v84, vcc wave_shr:1 row_mask:0xf bank_mask:0xf
    v_cndmask_b32_dpp v85, v85, v85, vcc wave_shr:1 row_mask:0xf bank_mask:0xf
    s_lshr_b64 s[52:53], s[52:53], 1
    v_cndmask_b32_dpp v86, v86, v86, vcc wave_shr:1 row_mask:0xf bank_mask:0xf
    v_cndmask_b32_dpp v87, v87, v87, vcc wave_shr:1 row_mask:0xf bank_mask:0xf
    s_andn2_b64 s[82:83], s[82:83], s[52:53]
    v_cndmask_b32_dpp v7, v7, v7, vcc wave_shr:1 row_mask:0xf bank_mask:0xf
    s_mov_b64 exec, s[54:55]
    s_cbranch_scc0 L2_d67
    s_mov_b64 exec, s[82:83]
    s_nop 1
    v_mfma_f32_4x4x4_16b_bf16 v[88:91], v[12:13], v[84:85], 0
    s_nop 1
    v_mfma_f32_4x4x4_16b_bf16 v[88:91], v[10:11], v[86:87], v[88:91]
    s_nop 4
    v_cvt_pk_bf16_f32 v88, v88, v89
    v_cvt_pk_bf16_f32 v89, v90, v91
    ds_pk_add_bf16 v7, v88 offset:65408
    ds_pk_add_bf16 v7, v89 offset:65412
    s_mov_b64 exec, s[54:55]
    s_branch L2_d67
L2_c68:
    s_lshl_b64 s[52:53], s[82:83], 1
    s_andn2_b64 s[52:53], s[52:53], s[80:81]
    s_andn2_b64 s[52:53], s[52:53], s[50:51]
    s_or_b64 s[80:81], s[80:81], s[52:53]
    s_not_b64 vcc, s[52:53]
    s_mov_b64 exec, -1
    v_cndmask_b32_dpp v84, v84, v84, vcc wave_shr:1 row_mask:0xf bank_mask:0xf
    v_cndmask_b32_dpp v85, v85, v85, vcc wave_shr:1 row_mask:0xf bank_mask:0xf
    s_lshr_b64 s[52:53], s[52:53], 1
    v_cndmask_b32_dpp v86, v86, v86, vcc wave_shr:1 row_mask:0xf bank_mask:0xf
    v_cndmask_b32_dpp v87, v87, v87, vcc wave_shr:1 row_mask:0xf bank_mask:0xf
    s_andn2_b64 s[82:83], s[82:83], s[52:53]
    v_cndmask_b32_dpp v7, v7, v7, vcc wave_shr:1 row_mask:0xf bank_mask:0xf
    s_mov_b64 exec, s[50:51]
    s_cbranch_scc0 L2_d68
    s_mov_b64 exec, s[82:83]
    s_nop 1
    v_mfma_f32_4x4x4_16b_bf16 v[88:91], v[12:13], v[84:85], 0
    s_nop 1
    v_mfma_f32_4x4x4_16b_bf16 v[88:91], v[10:11], v[86:87], v[88:91]
    s_nop 4
    v_cvt_pk_bf16_f32 v88, v88, v89
    v_cvt_pk_bf16_f32 v89, v90, v91
    ds_pk_add_bf16 v7, v88 offset:65408
    ds_pk_add_bf16 v7, v89 offset:65412
    s_mov_b64 exec, s[50:51]
    s_branch L2_d68
L2_c69:
    s_lshl_b64 s[52:53], s[82:83], 1
    s_andn2_b64 s[52:53], s[52:53], s[80:81]
    s_andn2_b64 s[52:53], s[52:53], s[54:55]
    s_or_b64 s[80:81], s[80:81], s[52:53]
    s_not_b64 vcc, s[52:53]
    s_mov_b64 exec, -1
    v_cndmask_b32_dpp v84, v84, v84, vcc wave_shr:1 row_mask:0xf bank_mask:0xf
    v_cndmask_b32_dpp v85, v85, v85, vcc wave_shr:1 row_mask:0xf bank_mask:0xf
    s_lshr_b64 s[52:53], s[52:53], 1
    v_cndmask_b32_dpp v86, v86, v86, vcc wave_shr:1 row_mask:0xf bank_mask:0xf
    v_cndmask_b32_dpp v87, v87, v87, vcc wave_shr:1 row_mask:0xf bank_mask:0xf
    s_andn2_b64 s[82:83], s[82:83], s[52:53]
    v_cndmask_b32_dpp v7, v7, v7, vcc wave_shr:1 row_mask:0xf bank_mask:0xf
    s_mov_b64 exec, s[54:55]
    s_cbranch_scc0 L2_d69
    s_mov_b64 exec, s[82:83]
    s_nop 1
    v_mfma_f32_4x4x4_16b_bf16 v[88:91], v[12:13], v[84:85], 0
    s_nop 1
    v_mfma_f32_4x4x4_16b_bf16 v[88:91], v[10:11], v[86:87], v[88:91]
    s_nop 4
    v_cvt_pk_bf16_f32 v88, v88, v89
    v_cvt_pk_bf16_f32 v89, v90, v91
    ds_pk_add_bf16 v7, v88 offset:65408
    ds_pk_add_bf16 v7, v89 offset:65412
    s_mov_b64 exec, s[54:55]
    s_branch L2_d69
L2_c70:
    s_lshl_b64 s[52:53], s[82:83], 1
    s_andn2_b64 s[52:53], s[52:53], s[80:81]
    s_andn2_b64 s[52:53], s[52:53], s[50:51]
    s_or_b64 s[80:81], s[80:81], s[52:53]
    s_not_b64 vcc, s[52:53]
    s_mov_b64 exec, -1
    v_cndmask_b32_dpp v84, v84, v84, vcc wave_shr:1 row_mask:0xf bank_mask:0xf
    v_cndmask_b32_dpp v85, v85, v85, vcc wave_shr:1 row_mask:0xf bank_mask:0xf
    s_lshr_b64 s[52:53], s[52:53], 1
    v_cndmask_b32_dpp v86, v86, v86, vcc wave_shr:1 row_mask:0xf bank_mask:0xf
    v_cndmask_b32_dpp v87, v87, v87, vcc wave_shr:1 row_mask:0xf bank_mask:0xf
    s_andn2_b64 s[82:83], s[82:83], s[52:53]
    v_cndmask_b32_dpp v7, v7, v7, vcc wave_shr:1 row_mask:0xf bank_mask:0xf
    s_mov_b64 exec, s[50:51]
    s_cbranch_scc0 L2_d70
    s_mov_b64 exec, s[82:83]
    s_nop 1
    v_mfma_f32_4x4x4_16b_bf16 v[88:91], v[12:13], v[84:85], 0
    s_nop 1
    v_mfma_f32_4x4x4_16b_bf16 v[88:91], v[10:11], v[86:87], v[88:91]
    s_nop 4
    v_cvt_pk_bf16_f32 v88, v88, v89
    v_cvt_pk_bf16_f32 v89, v90, v91
    ds_pk_add_bf16 v7, v88 offset:65408
    ds_pk_add_bf16 v7, v89 offset:65412
    s_mov_b64 exec, s[50:51]
    s_branch L2_d70
L2_oa71:
    s_waitcnt vmcnt(3)
    s_mov_b64 exec, s[6:7]
    v_lshrrev_b32 v114, 16, v114
    s_mov_b64 exec, -1
    v_and_b32 v46, 0x10000000, v33
    v_cmpx_eq_u32 vcc, 0, v46
    v_lshrrev_b32 v47, 14, v112
    v_and_b32 v47, v5, v47
    ds_read_b64 v[96:97], v47
    v_perm_b32 v98, v112, v114, s44
    v_bitop3_b32 v99, v112, 0.5, -0.5 bitop3:0xa8
    v_bitop3_b32 v98, v6, v98, v99 bitop3:0xca
    v_and_b32 v47, v5, v112
    s_waitcnt lgkmcnt(0)
    v_mfma_f32_4x4x4_16b_bf16 v[88:91], v[8:9], v[96:97], 0
    s_nop 4
    v_mul_f32 v88, v98, v88
    v_mul_f32 v89, v98, v89
    v_mul_f32 v90, v98, v90
    v_mul_f32 v91, v98, v91
    v_cvt_pk_bf16_f32 v88, v88, v89
    v_cvt_pk_bf16_f32 v89, v90, v91
    ds_pk_add_bf16 v47, v88 offset:65408
    ds_pk_add_bf16 v47, v89 offset:65412
    s_mov_b64 exec, -1
    v_and_b32 v46, 0x20000000, v33
    v_cmpx_eq_u32 vcc, 0, v46
    v_lshrrev_b32 v47, 14, v113
    v_and_b32 v47, v5, v47
    ds_read_b64 v[96:97], v47
    v_perm_b32 v98, v113, v114, s45
    v_bitop3_b32 v99, v113, 0.5, -0.5 bitop3:0xa8
    v_bitop3_b32 v98, v6, v98, v99 bitop3:0xca
    v_and_b32 v47, v5, v113
    s_waitcnt lgkmcnt(0)
    v_mfma_f32_4x4x4_16b_bf16 v[88:91], v[8:9], v[96:97], 0
    s_nop 4
    v_mul_f32 v88, v98, v88
    v_mul_f32 v89, v98, v89
    v_mul_f32 v90, v98, v90
    v_mul_f32 v91, v98, v91
    v_cvt_pk_bf16_f32 v88, v88, v89
    v_cvt_pk_bf16_f32 v89, v90, v91
    ds_pk_add_bf16 v47, v88 offset:65408
    ds_pk_add_bf16 v47, v89 offset:65412
    s_mov_b64 exec, -1
    s_branch L2_ob71
L2_xo72:
    v_cmp_lt_u32 vcc, 20, v99
    s_mov_b32 s101, 1
    s_cbranch_vccz L2_xp72
    v_cmp_lt_u32 vcc, 32, v99
    v_cmp_lt_u32 s[58:59], 31, v88
    s_mov_b32 s101, 2
    s_or_b64 vcc, vcc, s[58:59]
    s_cbranch_scc0 L2_xp72
    s_mov_b32 s37, 0x10000
    s_branch L2_xp72
L2_c73:
    s_lshl_b64 s[52:53], s[82:83], 1
    s_andn2_b64 s[52:53], s[52:53], s[80:81]
    s_andn2_b64 s[52:53], s[52:53], s[54:55]
    s_or_b64 s[80:81], s[80:81], s[52:53]
    s_not_b64 vcc, s[52:53]
    s_mov_b64 exec, -1
    v_cndmask_b32_dpp v84, v84, v84, vcc wave_shr:1 row_mask:0xf bank_mask:0xf
    v_cndmask_b32_dpp v85, v85, v85, vcc wave_shr:1 row_mask:0xf bank_mask:0xf
    s_lshr_b64 s[52:53], s[52:53], 1
    v_cndmask_b32_dpp v86, v86, v86, vcc wave_shr:1 row_mask:0xf bank_mask:0xf
    v_cndmask_b32_dpp v87, v87, v87, vcc wave_shr:1 row_mask:0xf bank_mask:0xf
    s_andn2_b64 s[82:83], s[82:83], s[52:53]
    v_cndmask_b32_dpp v7, v7, v7, vcc wave_shr:1 row_mask:0xf bank_mask:0xf
    s_mov_b64 exec, s[54:55]
    s_cbranch_scc0 L2_d73
    s_mov_b64 exec, s[82:83]
    s_nop 1
    v_mfma_f32_4x4x4_16b_bf16 v[88:91], v[12:13], v[84:85], 0
    s_nop 1
    v_mfma_f32_4x4x4_16b_bf16 v[88:91], v[10:11], v[86:87], v[88:91]
    s_nop 4
    v_cvt_pk_bf16_f32 v88, v88, v89
    v_cvt_pk_bf16_f32 v89, v90, v91
    ds_pk_add_bf16 v7, v88 offset:65408
    ds_pk_add_bf16 v7, v89 offset:65412
    s_mov_b64 exec, s[54:55]
    s_branch L2_d73
L2_c74:
    s_lshl_b64 s[52:53], s[82:83], 1
    s_andn2_b64 s[52:53], s[52:53], s[80:81]
    s_andn2_b64 s[52:53], s[52:53], s[50:51]
    s_or_b64 s[80:81], s[80:81], s[52:53]
    s_not_b64 vcc, s[52:53]
    s_mov_b64 exec, -1
    v_cndmask_b32_dpp v84, v84, v84, vcc wave_shr:1 row_mask:0xf bank_mask:0xf
    v_cndmask_b32_dpp v85, v85, v85, vcc wave_shr:1 row_mask:0xf bank_mask:0xf
    s_lshr_b64 s[52:53], s[52:53], 1
    v_cndmask_b32_dpp v86, v86, v86, vcc wave_shr:1 row_mask:0xf bank_mask:0xf
    v_cndmask_b32_dpp v87, v87, v87, vcc wave_shr:1 row_mask:0xf bank_mask:0xf
    s_andn2_b64 s[82:83], s[82:83], s[52:53]
    v_cndmask_b32_dpp v7, v7, v7, vcc wave_shr:1 row_mask:0xf bank_mask:0xf
    s_mov_b64 exec, s[50:51]
    s_cbranch_scc0 L2_d74
    s_mov_b64 exec, s[82:83]
    s_nop 1
    v_mfma_f32_4x4x4_16b_bf16 v[88:91], v[12:13], v[84:85], 0
    s_nop 1
    v_mfma_f32_4x4x4_16b_bf16 v[88:91], v[10:11], v[86:87], v[88:91]
    s_nop 4
    v_cvt_pk_bf16_f32 v88, v88, v89
    v_cvt_pk_bf16_f32 v89, v90, v91
    ds_pk_add_bf16 v7, v88 offset:65408
    ds_pk_add_bf16 v7, v89 offset:65412
    s_mov_b64 exec, s[50:51]
    s_branch L2_d74
L2_c75:
    s_lshl_b64 s[52:53], s[82:83], 1
    s_andn2_b64 s[52:53], s[52:53], s[80:81]
    s_andn2_b64 s[52:53], s[52:53], s[54:55]
    s_or_b64 s[80:81], s[80:81], s[52:53]
    s_not_b64 vcc, s[52:53]
    s_mov_b64 exec, -1
    v_cndmask_b32_dpp v84, v84, v84, vcc wave_shr:1 row_mask:0xf bank_mask:0xf
    v_cndmask_b32_dpp v85, v85, v85, vcc wave_shr:1 row_mask:0xf bank_mask:0xf
    s_lshr_b64 s[52:53], s[52:53], 1
    v_cndmask_b32_dpp v86, v86, v86, vcc wave_shr:1 row_mask:0xf bank_mask:0xf
    v_cndmask_b32_dpp v87, v87, v87, vcc wave_shr:1 row_mask:0xf bank_mask:0xf
    s_andn2_b64 s[82:83], s[82:83], s[52:53]
    v_cndmask_b32_dpp v7, v7, v7, vcc wave_shr:1 row_mask:0xf bank_mask:0xf
    s_mov_b64 exec, s[54:55]
    s_cbranch_scc0 L2_d75
    s_mov_b64 exec, s[82:83]
    s_nop 1
    v_mfma_f32_4x4x4_16b_bf16 v[88:91], v[12:13], v[84:85], 0
    s_nop 1
    v_mfma_f32_4x4x4_16b_bf16 v[88:91], v[10:11], v[86:87], v[88:91]
    s_nop 4
    v_cvt_pk_bf16_f32 v88, v88, v89
    v_cvt_pk_bf16_f32 v89, v90, v91
    ds_pk_add_bf16 v7, v88 offset:65408
    ds_pk_add_bf16 v7, v89 offset:65412
    s_mov_b64 exec, s[54:55]
    s_branch L2_d75
L2_c76:
    s_lshl_b64 s[52:53], s[82:83], 1
    s_andn2_b64 s[52:53], s[52:53], s[80:81]
    s_andn2_b64 s[52:53], s[52:53], s[50:51]
    s_or_b64 s[80:81], s[80:81], s[52:53]
    s_not_b64 vcc, s[52:53]
    s_mov_b64 exec, -1
    v_cndmask_b32_dpp v84, v84, v84, vcc wave_shr:1 row_mask:0xf bank_mask:0xf
    v_cndmask_b32_dpp v85, v85, v85, vcc wave_shr:1 row_mask:0xf bank_mask:0xf
    s_lshr_b64 s[52:53], s[52:53], 1
    v_cndmask_b32_dpp v86, v86, v86, vcc wave_shr:1 row_mask:0xf bank_mask:0xf
    v_cndmask_b32_dpp v87, v87, v87, vcc wave_shr:1 row_mask:0xf bank_mask:0xf
    s_andn2_b64 s[82:83], s[82:83], s[52:53]
    v_cndmask_b32_dpp v7, v7, v7, vcc wave_shr:1 row_mask:0xf bank_mask:0xf
    s_mov_b64 exec, s[50:51]
    s_cbranch_scc0 L2_d76
    s_mov_b64 exec, s[82:83]
    s_nop 1
    v_mfma_f32_4x4x4_16b_bf16 v[88:91], v[12:13], v[84:85], 0
    s_nop 1
    v_mfma_f32_4x4x4_16b_bf16 v[88:91], v[10:11], v[86:87], v[88:91]
    s_nop 4
    v_cvt_pk_bf16_f32 v88, v88, v89
    v_cvt_pk_bf16_f32 v89, v90, v91
    ds_pk_add_bf16 v7, v88 offset:65408
    ds_pk_add_bf16 v7, v89 offset:65412
    s_mov_b64 exec, s[50:51]
    s_branch L2_d76
L2_c77:
    s_lshl_b64 s[52:53], s[82:83], 1
    s_andn2_b64 s[52:53], s[52:53], s[80:81]
    s_andn2_b64 s[52:53], s[52:53], s[54:55]
    s_or_b64 s[80:81], s[80:81], s[52:53]
    s_not_b64 vcc, s[52:53]
    s_mov_b64 exec, -1
    v_cndmask_b32_dpp v84, v84, v84, vcc wave_shr:1 row_mask:0xf bank_mask:0xf
    v_cndmask_b32_dpp v85, v85, v85, vcc wave_shr:1 row_mask:0xf bank_mask:0xf
    s_lshr_b64 s[52:53], s[52:53], 1
    v_cndmask_b32_dpp v86, v86, v86, vcc wave_shr:1 row_mask:0xf bank_mask:0xf
    v_cndmask_b32_dpp v87, v87, v87, vcc wave_shr:1 row_mask:0xf bank_mask:0xf
    s_andn2_b64 s[82:83], s[82:83], s[52:53]
    v_cndmask_b32_dpp v7, v7, v7, vcc wave_shr:1 row_mask:0xf bank_mask:0xf
    s_mov_b64 exec, s[54:55]
    s_cbranch_scc0 L2_d77
    s_mov_b64 exec, s[82:83]
    s_nop 1
    v_mfma_f32_4x4x4_16b_bf16 v[88:91], v[12:13], v[84:85], 0
    s_nop 1
    v_mfma_f32_4x4x4_16b_bf16 v[88:91], v[10:11], v[86:87], v[88:91]
    s_nop 4
    v_cvt_pk_bf16_f32 v88, v88, v89
    v_cvt_pk_bf16_f32 v89, v90, v91
    ds_pk_add_bf16 v7, v88 offset:65408
    ds_pk_add_bf16 v7, v89 offset:65412
    s_mov_b64 exec, s[54:55]
    s_branch L2_d77
L2_c78:
    s_lshl_b64 s[52:53], s[82:83], 1
    s_andn2_b64 s[52:53], s[52:53], s[80:81]
    s_andn2_b64 s[52:53], s[52:53], s[50:51]
    s_or_b64 s[80:81], s[80:81], s[52:53]
    s_not_b64 vcc, s[52:53]
    s_mov_b64 exec, -1
    v_cndmask_b32_dpp v84, v84, v84, vcc wave_shr:1 row_mask:0xf bank_mask:0xf
    v_cndmask_b32_dpp v85, v85, v85, vcc wave_shr:1 row_mask:0xf bank_mask:0xf
    s_lshr_b64 s[52:53], s[52:53], 1
    v_cndmask_b32_dpp v86, v86, v86, vcc wave_shr:1 row_mask:0xf bank_mask:0xf
    v_cndmask_b32_dpp v87, v87, v87, vcc wave_shr:1 row_mask:0xf bank_mask:0xf
    s_andn2_b64 s[82:83], s[82:83], s[52:53]
    v_cndmask_b32_dpp v7, v7, v7, vcc wave_shr:1 row_mask:0xf bank_mask:0xf
    s_mov_b64 exec, s[50:51]
    s_cbranch_scc0 L2_d78
    s_mov_b64 exec, s[82:83]
    s_nop 1
    v_mfma_f32_4x4x4_16b_bf16 v[88:91], v[12:13], v[84:85], 0
    s_nop 1
    v_mfma_f32_4x4x4_16b_bf16 v[88:91], v[10:11], v[86:87], v[88:91]
    s_nop 4
    v_cvt_pk_bf16_f32 v88, v88, v89
    v_cvt_pk_bf16_f32 v89, v90, v91
    ds_pk_add_bf16 v7, v88 offset:65408
    ds_pk_add_bf16 v7, v89 offset:65412
    s_mov_b64 exec, s[50:51]
    s_branch L2_d78
L2_xa79:
    s_cmp_eq_u32 s101, 1
    s_cbranch_scc1 L2_xc79
    v_lshlrev_b32 v89, 0, v96
    v_add_u32 v90, 140, v97
    v_bitop3_b32 v90, v89, v45, v90 bitop3:0x6a
    ds_write_b32 v98, v90 offset:28
    v_lshlrev_b32 v89, 4, v96
    v_add_u32 v90, 120, v97
    v_bitop3_b32 v90, v89, v45, v90 bitop3:0x6a
    ds_write_b32 v98, v90 offset:24
    v_lshlrev_b32 v89, 8, v96
    v_add_u32 v90, 100, v97
    v_bitop3_b32 v90, v89, v45, v90 bitop3:0x6a
    ds_write_b32 v98, v90 offset:20
L2_xc79:
    v_lshlrev_b32 v89, 12, v96
    v_add_u32 v90, 80, v97
    v_bitop3_b32 v90, v89, v45, v90 bitop3:0x6a
    ds_write_b32 v98, v90 offset:16
    s_branch L2_xb79
L2_xe79:
    v_cmp_lt_u32 vcc, 32, v99
    v_cmp_lt_u32 s[58:59], 31, v88
    v_lshrrev_b32 v89, 16, v96
    v_add_u32 v97, 80, v97
    s_or_b64 vcc, vcc, s[58:59]
    s_cbranch_scc1 L2_xs79
    v_lshlrev_b32 v89, v1, v89
    v_and_b32 v89, v45, v89
    v_cmp_ne_u32 vcc, 0, v89
    v_xor_b32 v90, v97, v89
    s_add_u32 s3, s37, s38
    v_mbcnt_lo_u32_b32 v98, vcc_lo, 0
    v_mbcnt_hi_u32_b32 v98, vcc_hi, v98
    s_bcnt1_i32_b64 s41, vcc
    v_lshl_add_u32 v98, v98, 2, s3
    s_lshl2_add_u32 s37, s41, s37
    s_mov_b64 exec, vcc
    ds_write_b32 v98, v90
    s_mov_b64 exec, -1
    s_branch L2_xr79
L2_xs79:
    s_waitcnt lgkmcnt(0)
    s_mov_b32 s37, 0x10000
    s_branch L2_xw79
L2_c80:
    s_lshl_b64 s[52:53], s[82:83], 1
    s_andn2_b64 s[52:53], s[52:53], s[80:81]
    s_andn2_b64 s[52:53], s[52:53], s[54:55]
    s_or_b64 s[80:81], s[80:81], s[52:53]
    s_not_b64 vcc, s[52:53]
    s_mov_b64 exec, -1
    v_cndmask_b32_dpp v84, v84, v84, vcc wave_shr:1 row_mask:0xf bank_mask:0xf
    v_cndmask_b32_dpp v85, v85, v85, vcc wave_shr:1 row_mask:0xf bank_mask:0xf
    s_lshr_b64 s[52:53], s[52:53], 1
    v_cndmask_b32_dpp v86, v86, v86, vcc wave_shr:1 row_mask:0xf bank_mask:0xf
    v_cndmask_b32_dpp v87, v87, v87, vcc wave_shr:1 row_mask:0xf bank_mask:0xf
    s_andn2_b64 s[82:83], s[82:83], s[52:53]
    v_cndmask_b32_dpp v7, v7, v7, vcc wave_shr:1 row_mask:0xf bank_mask:0xf
    s_mov_b64 exec, s[54:55]
    s_cbranch_scc0 L2_d80
    s_mov_b64 exec, s[82:83]
    s_nop 1
    v_mfma_f32_4x4x4_16b_bf16 v[88:91], v[12:13], v[84:85], 0
    s_nop 1
    v_mfma_f32_4x4x4_16b_bf16 v[88:91], v[10:11], v[86:87], v[88:91]
    s_nop 4
    v_cvt_pk_bf16_f32 v88, v88, v89
    v_cvt_pk_bf16_f32 v89, v90, v91
    ds_pk_add_bf16 v7, v88 offset:65408
    ds_pk_add_bf16 v7, v89 offset:65412
    s_mov_b64 exec, s[54:55]
    s_branch L2_d80
L2_c81:
    s_lshl_b64 s[52:53], s[82:83], 1
    s_andn2_b64 s[52:53], s[52:53], s[80:81]
    s_andn2_b64 s[52:53], s[52:53], s[50:51]
    s_or_b64 s[80:81], s[80:81], s[52:53]
    s_not_b64 vcc, s[52:53]
    s_mov_b64 exec, -1
    v_cndmask_b32_dpp v84, v84, v84, vcc wave_shr:1 row_mask:0xf bank_mask:0xf
    v_cndmask_b32_dpp v85, v85, v85, vcc wave_shr:1 row_mask:0xf bank_mask:0xf
    s_lshr_b64 s[52:53], s[52:53], 1
    v_cndmask_b32_dpp v86, v86, v86, vcc wave_shr:1 row_mask:0xf bank_mask:0xf
    v_cndmask_b32_dpp v87, v87, v87, vcc wave_shr:1 row_mask:0xf bank_mask:0xf
    s_andn2_b64 s[82:83], s[82:83], s[52:53]
    v_cndmask_b32_dpp v7, v7, v7, vcc wave_shr:1 row_mask:0xf bank_mask:0xf
    s_mov_b64 exec, s[50:51]
    s_cbranch_scc0 L2_d81
    s_mov_b64 exec, s[82:83]
    s_nop 1
    v_mfma_f32_4x4x4_16b_bf16 v[88:91], v[12:13], v[84:85], 0
    s_nop 1
    v_mfma_f32_4x4x4_16b_bf16 v[88:91], v[10:11], v[86:87], v[88:91]
    s_nop 4
    v_cvt_pk_bf16_f32 v88, v88, v89
    v_cvt_pk_bf16_f32 v89, v90, v91
    ds_pk_add_bf16 v7, v88 offset:65408
    ds_pk_add_bf16 v7, v89 offset:65412
    s_mov_b64 exec, s[50:51]
    s_branch L2_d81
L2_xf79:
    s_cmp_gt_u32 s37, 1024
    s_cbranch_scc1 L2_xt79
    s_cmp_lt_u32 s37, 768
    s_cbranch_scc1 L2_xl79
    ds_read_b32 v33, v44 offset:896
    s_add_u32 s3, s42, 2
    s_bitset1_b32 s43, s3
    s_branch L2_xg79
L2_xl79:
    s_waitcnt lgkmcnt(0)
    v_mov_b32 v42, -1
    s_cmp_ge_u32 s37, 512
    s_cbranch_scc1 L2_xg79
    v_mov_b32 v43, -1
    s_cmp_ge_u32 s37, 256
    s_cbranch_scc1 L2_xg79
    v_mov_b32 v41, -1
    s_branch L2_xg79
L2_xt79:
    s_waitcnt lgkmcnt(0)
    v_mov_b32 v40, -1
    v_mov_b32 v41, -1
    v_mov_b32 v43, -1
    v_mov_b32 v42, -1
    s_add_u32 s3, s42, 2
    s_bitset1_b32 s36, s3
    s_branch L2_xg79
L2_oa82:
    v_and_b32 v47, 0x0fffffff, v32
    buffer_load_dword v114, v47, s[8:11], 0 offen offset:16
    s_mov_b64 exec, s[6:7]
    v_add_u32 v47, 8, v47
    v_lshrrev_b32 v32, 2, v32
    s_mov_b64 exec, -1
    buffer_load_dwordx2 v[112:113], v47, s[8:11], 0 offen
    s_branch L2_ob82
L2_c83:
    s_lshl_b64 s[52:53], s[82:83], 1
    s_andn2_b64 s[52:53], s[52:53], s[80:81]
    s_andn2_b64 s[52:53], s[52:53], s[54:55]
    s_or_b64 s[80:81], s[80:81], s[52:53]
    s_not_b64 vcc, s[52:53]
    s_mov_b64 exec, -1
    v_cndmask_b32_dpp v84, v84, v84, vcc wave_shr:1 row_mask:0xf bank_mask:0xf
    v_cndmask_b32_dpp v85, v85, v85, vcc wave_shr:1 row_mask:0xf bank_mask:0xf
    s_lshr_b64 s[52:53], s[52:53], 1
    v_cndmask_b32_dpp v86, v86, v86, vcc wave_shr:1 row_mask:0xf bank_mask:0xf
    v_cndmask_b32_dpp v87, v87, v87, vcc wave_shr:1 row_mask:0xf bank_mask:0xf
    s_andn2_b64 s[82:83], s[82:83], s[52:53]
    v_cndmask_b32_dpp v7, v7, v7, vcc wave_shr:1 row_mask:0xf bank_mask:0xf
    s_mov_b64 exec, s[54:55]
    s_cbranch_scc0 L2_d83
    s_mov_b64 exec, s[82:83]
    s_nop 1
    v_mfma_f32_4x4x4_16b_bf16 v[88:91], v[12:13], v[84:85], 0
    s_nop 1
    v_mfma_f32_4x4x4_16b_bf16 v[88:91], v[10:11], v[86:87], v[88:91]
    s_nop 4
    v_cvt_pk_bf16_f32 v88, v88, v89
    v_cvt_pk_bf16_f32 v89, v90, v91
    ds_pk_add_bf16 v7, v88 offset:65408
    ds_pk_add_bf16 v7, v89 offset:65412
    s_mov_b64 exec, s[54:55]
    s_branch L2_d83
L2_c84:
    s_lshl_b64 s[52:53], s[82:83], 1
    s_andn2_b64 s[52:53], s[52:53], s[80:81]
    s_andn2_b64 s[52:53], s[52:53], s[50:51]
    s_or_b64 s[80:81], s[80:81], s[52:53]
    s_not_b64 vcc, s[52:53]
    s_mov_b64 exec, -1
    v_cndmask_b32_dpp v84, v84, v84, vcc wave_shr:1 row_mask:0xf bank_mask:0xf
    v_cndmask_b32_dpp v85, v85, v85, vcc wave_shr:1 row_mask:0xf bank_mask:0xf
    s_lshr_b64 s[52:53], s[52:53], 1
    v_cndmask_b32_dpp v86, v86, v86, vcc wave_shr:1 row_mask:0xf bank_mask:0xf
    v_cndmask_b32_dpp v87, v87, v87, vcc wave_shr:1 row_mask:0xf bank_mask:0xf
    s_andn2_b64 s[82:83], s[82:83], s[52:53]
    v_cndmask_b32_dpp v7, v7, v7, vcc wave_shr:1 row_mask:0xf bank_mask:0xf
    s_mov_b64 exec, s[50:51]
    s_cbranch_scc0 L2_d84
    s_mov_b64 exec, s[82:83]
    s_nop 1
    v_mfma_f32_4x4x4_16b_bf16 v[88:91], v[12:13], v[84:85], 0
    s_nop 1
    v_mfma_f32_4x4x4_16b_bf16 v[88:91], v[10:11], v[86:87], v[88:91]
    s_nop 4
    v_cvt_pk_bf16_f32 v88, v88, v89
    v_cvt_pk_bf16_f32 v89, v90, v91
    ds_pk_add_bf16 v7, v88 offset:65408
    ds_pk_add_bf16 v7, v89 offset:65412
    s_mov_b64 exec, s[50:51]
    s_branch L2_d84
L2_c85:
    s_lshl_b64 s[52:53], s[82:83], 1
    s_andn2_b64 s[52:53], s[52:53], s[80:81]
    s_andn2_b64 s[52:53], s[52:53], s[54:55]
    s_or_b64 s[80:81], s[80:81], s[52:53]
    s_not_b64 vcc, s[52:53]
    s_mov_b64 exec, -1
    v_cndmask_b32_dpp v84, v84, v84, vcc wave_shr:1 row_mask:0xf bank_mask:0xf
    v_cndmask_b32_dpp v85, v85, v85, vcc wave_shr:1 row_mask:0xf bank_mask:0xf
    s_lshr_b64 s[52:53], s[52:53], 1
    v_cndmask_b32_dpp v86, v86, v86, vcc wave_shr:1 row_mask:0xf bank_mask:0xf
    v_cndmask_b32_dpp v87, v87, v87, vcc wave_shr:1 row_mask:0xf bank_mask:0xf
    s_andn2_b64 s[82:83], s[82:83], s[52:53]
    v_cndmask_b32_dpp v7, v7, v7, vcc wave_shr:1 row_mask:0xf bank_mask:0xf
    s_mov_b64 exec, s[54:55]
    s_cbranch_scc0 L2_d85
    s_mov_b64 exec, s[82:83]
    s_nop 1
    v_mfma_f32_4x4x4_16b_bf16 v[88:91], v[12:13], v[84:85], 0
    s_nop 1
    v_mfma_f32_4x4x4_16b_bf16 v[88:91], v[10:11], v[86:87], v[88:91]
    s_nop 4
    v_cvt_pk_bf16_f32 v88, v88, v89
    v_cvt_pk_bf16_f32 v89, v90, v91
    ds_pk_add_bf16 v7, v88 offset:65408
    ds_pk_add_bf16 v7, v89 offset:65412
    s_mov_b64 exec, s[54:55]
    s_branch L2_d85
L2_c86:
    s_lshl_b64 s[52:53], s[82:83], 1
    s_andn2_b64 s[52:53], s[52:53], s[80:81]
    s_andn2_b64 s[52:53], s[52:53], s[50:51]
    s_or_b64 s[80:81], s[80:81], s[52:53]
    s_not_b64 vcc, s[52:53]
    s_mov_b64 exec, -1
    v_cndmask_b32_dpp v84, v84, v84, vcc wave_shr:1 row_mask:0xf bank_mask:0xf
    v_cndmask_b32_dpp v85, v85, v85, vcc wave_shr:1 row_mask:0xf bank_mask:0xf
    s_lshr_b64 s[52:53], s[52:53], 1
    v_cndmask_b32_dpp v86, v86, v86, vcc wave_shr:1 row_mask:0xf bank_mask:0xf
    v_cndmask_b32_dpp v87, v87, v87, vcc wave_shr:1 row_mask:0xf bank_mask:0xf
    s_andn2_b64 s[82:83], s[82:83], s[52:53]
    v_cndmask_b32_dpp v7, v7, v7, vcc wave_shr:1 row_mask:0xf bank_mask:0xf
    s_mov_b64 exec, s[50:51]
    s_cbranch_scc0 L2_d86
    s_mov_b64 exec, s[82:83]
    s_nop 1
    v_mfma_f32_4x4x4_16b_bf16 v[88:91], v[12:13], v[84:85], 0
    s_nop 1
    v_mfma_f32_4x4x4_16b_bf16 v[88:91], v[10:11], v[86:87], v[88:91]
    s_nop 4
    v_cvt_pk_bf16_f32 v88, v88, v89
    v_cvt_pk_bf16_f32 v89, v90, v91
    ds_pk_add_bf16 v7, v88 offset:65408
    ds_pk_add_bf16 v7, v89 offset:65412
    s_mov_b64 exec, s[50:51]
    s_branch L2_d86
L2_c87:
    s_lshl_b64 s[52:53], s[82:83], 1
    s_andn2_b64 s[52:53], s[52:53], s[80:81]
    s_andn2_b64 s[52:53], s[52:53], s[54:55]
    s_or_b64 s[80:81], s[80:81], s[52:53]
    s_not_b64 vcc, s[52:53]
    s_mov_b64 exec, -1
    v_cndmask_b32_dpp v84, v84, v84, vcc wave_shr:1 row_mask:0xf bank_mask:0xf
    v_cndmask_b32_dpp v85, v85, v85, vcc wave_shr:1 row_mask:0xf bank_mask:0xf
    s_lshr_b64 s[52:53], s[52:53], 1
    v_cndmask_b32_dpp v86, v86, v86, vcc wave_shr:1 row_mask:0xf bank_mask:0xf
    v_cndmask_b32_dpp v87, v87, v87, vcc wave_shr:1 row_mask:0xf bank_mask:0xf
    s_andn2_b64 s[82:83], s[82:83], s[52:53]
    v_cndmask_b32_dpp v7, v7, v7, vcc wave_shr:1 row_mask:0xf bank_mask:0xf
    s_mov_b64 exec, s[54:55]
    s_cbranch_scc0 L2_d87
    s_mov_b64 exec, s[82:83]
    s_nop 1
    v_mfma_f32_4x4x4_16b_bf16 v[88:91], v[12:13], v[84:85], 0
    s_nop 1
    v_mfma_f32_4x4x4_16b_bf16 v[88:91], v[10:11], v[86:87], v[88:91]
    s_nop 4
    v_cvt_pk_bf16_f32 v88, v88, v89
    v_cvt_pk_bf16_f32 v89, v90, v91
    ds_pk_add_bf16 v7, v88 offset:65408
    ds_pk_add_bf16 v7, v89 offset:65412
    s_mov_b64 exec, s[54:55]
    s_branch L2_d87
L2_c88:
    s_lshl_b64 s[52:53], s[82:83], 1
    s_andn2_b64 s[52:53], s[52:53], s[80:81]
    s_andn2_b64 s[52:53], s[52:53], s[50:51]
    s_or_b64 s[80:81], s[80:81], s[52:53]
    s_not_b64 vcc, s[52:53]
    s_mov_b64 exec, -1
    v_cndmask_b32_dpp v84, v84, v84, vcc wave_shr:1 row_mask:0xf bank_mask:0xf
    v_cndmask_b32_dpp v85, v85, v85, vcc wave_shr:1 row_mask:0xf bank_mask:0xf
    s_lshr_b64 s[52:53], s[52:53], 1
    v_cndmask_b32_dpp v86, v86, v86, vcc wave_shr:1 row_mask:0xf bank_mask:0xf
    v_cndmask_b32_dpp v87, v87, v87, vcc wave_shr:1 row_mask:0xf bank_mask:0xf
    s_andn2_b64 s[82:83], s[82:83], s[52:53]
    v_cndmask_b32_dpp v7, v7, v7, vcc wave_shr:1 row_mask:0xf bank_mask:0xf
    s_mov_b64 exec, s[50:51]
    s_cbranch_scc0 L2_d88
    s_mov_b64 exec, s[82:83]
    s_nop 1
    v_mfma_f32_4x4x4_16b_bf16 v[88:91], v[12:13], v[84:85], 0
    s_nop 1
    v_mfma_f32_4x4x4_16b_bf16 v[88:91], v[10:11], v[86:87], v[88:91]
    s_nop 4
    v_cvt_pk_bf16_f32 v88, v88, v89
    v_cvt_pk_bf16_f32 v89, v90, v91
    ds_pk_add_bf16 v7, v88 offset:65408
    ds_pk_add_bf16 v7, v89 offset:65412
    s_mov_b64 exec, s[50:51]
    s_branch L2_d88
L2_oa89:
    s_waitcnt vmcnt(3)
    s_mov_b64 exec, s[6:7]
    v_lshrrev_b32 v114, 16, v114
    s_mov_b64 exec, -1
    v_and_b32 v46, 0x10000000, v32
    v_cmpx_eq_u32 vcc, 0, v46
    v_lshrrev_b32 v47, 14, v112
    v_and_b32 v47, v5, v47
    ds_read_b64 v[96:97], v47
    v_perm_b32 v98, v112, v114, s44
    v_bitop3_b32 v99, v112, 0.5, -0.5 bitop3:0xa8
    v_bitop3_b32 v98, v6, v98, v99 bitop3:0xca
    v_and_b32 v47, v5, v112
    s_waitcnt lgkmcnt(0)
    v_mfma_f32_4x4x4_16b_bf16 v[88:91], v[8:9], v[96:97], 0
    s_nop 4
    v_mul_f32 v88, v98, v88
    v_mul_f32 v89, v98, v89
    v_mul_f32 v90, v98, v90
    v_mul_f32 v91, v98, v91
    v_cvt_pk_bf16_f32 v88, v88, v89
    v_cvt_pk_bf16_f32 v89, v90, v91
    ds_pk_add_bf16 v47, v88 offset:65408
    ds_pk_add_bf16 v47, v89 offset:65412
    s_mov_b64 exec, -1
    v_and_b32 v46, 0x20000000, v32
    v_cmpx_eq_u32 vcc, 0, v46
    v_lshrrev_b32 v47, 14, v113
    v_and_b32 v47, v5, v47
    ds_read_b64 v[96:97], v47
    v_perm_b32 v98, v113, v114, s45
    v_bitop3_b32 v99, v113, 0.5, -0.5 bitop3:0xa8
    v_bitop3_b32 v98, v6, v98, v99 bitop3:0xca
    v_and_b32 v47, v5, v113
    s_waitcnt lgkmcnt(0)
    v_mfma_f32_4x4x4_16b_bf16 v[88:91], v[8:9], v[96:97], 0
    s_nop 4
    v_mul_f32 v88, v98, v88
    v_mul_f32 v89, v98, v89
    v_mul_f32 v90, v98, v90
    v_mul_f32 v91, v98, v91
    v_cvt_pk_bf16_f32 v88, v88, v89
    v_cvt_pk_bf16_f32 v89, v90, v91
    ds_pk_add_bf16 v47, v88 offset:65408
    ds_pk_add_bf16 v47, v89 offset:65412
    s_mov_b64 exec, -1
    s_branch L2_ob89
L2_xo90:
    v_cmp_lt_u32 vcc, 20, v99
    s_mov_b32 s101, 1
    s_cbranch_vccz L2_xp90
    v_cmp_lt_u32 vcc, 32, v99
    v_cmp_lt_u32 s[58:59], 31, v88
    s_mov_b32 s101, 2
    s_or_b64 vcc, vcc, s[58:59]
    s_cbranch_scc0 L2_xp90
    s_mov_b32 s37, 0x10000
    s_branch L2_xp90
L2_c91:
    s_lshl_b64 s[52:53], s[82:83], 1
    s_andn2_b64 s[52:53], s[52:53], s[80:81]
    s_andn2_b64 s[52:53], s[52:53], s[54:55]
    s_or_b64 s[80:81], s[80:81], s[52:53]
    s_not_b64 vcc, s[52:53]
    s_mov_b64 exec, -1
    v_cndmask_b32_dpp v84, v84, v84, vcc wave_shr:1 row_mask:0xf bank_mask:0xf
    v_cndmask_b32_dpp v85, v85, v85, vcc wave_shr:1 row_mask:0xf bank_mask:0xf
    s_lshr_b64 s[52:53], s[52:53], 1
    v_cndmask_b32_dpp v86, v86, v86, vcc wave_shr:1 row_mask:0xf bank_mask:0xf
    v_cndmask_b32_dpp v87, v87, v87, vcc wave_shr:1 row_mask:0xf bank_mask:0xf
    s_andn2_b64 s[82:83], s[82:83], s[52:53]
    v_cndmask_b32_dpp v7, v7, v7, vcc wave_shr:1 row_mask:0xf bank_mask:0xf
    s_mov_b64 exec, s[54:55]
    s_cbranch_scc0 L2_d91
    s_mov_b64 exec, s[82:83]
    s_nop 1
    v_mfma_f32_4x4x4_16b_bf16 v[88:91], v[12:13], v[84:85], 0
    s_nop 1
    v_mfma_f32_4x4x4_16b_bf16 v[88:91], v[10:11], v[86:87], v[88:91]
    s_nop 4
    v_cvt_pk_bf16_f32 v88, v88, v89
    v_cvt_pk_bf16_f32 v89, v90, v91
    ds_pk_add_bf16 v7, v88 offset:65408
    ds_pk_add_bf16 v7, v89 offset:65412
    s_mov_b64 exec, s[54:55]
    s_branch L2_d91
L2_c92:
    s_lshl_b64 s[52:53], s[82:83], 1
    s_andn2_b64 s[52:53], s[52:53], s[80:81]
    s_andn2_b64 s[52:53], s[52:53], s[50:51]
    s_or_b64 s[80:81], s[80:81], s[52:53]
    s_not_b64 vcc, s[52:53]
    s_mov_b64 exec, -1
    v_cndmask_b32_dpp v84, v84, v84, vcc wave_shr:1 row_mask:0xf bank_mask:0xf
    v_cndmask_b32_dpp v85, v85, v85, vcc wave_shr:1 row_mask:0xf bank_mask:0xf
    s_lshr_b64 s[52:53], s[52:53], 1
    v_cndmask_b32_dpp v86, v86, v86, vcc wave_shr:1 row_mask:0xf bank_mask:0xf
    v_cndmask_b32_dpp v87, v87, v87, vcc wave_shr:1 row_mask:0xf bank_mask:0xf
    s_andn2_b64 s[82:83], s[82:83], s[52:53]
    v_cndmask_b32_dpp v7, v7, v7, vcc wave_shr:1 row_mask:0xf bank_mask:0xf
    s_mov_b64 exec, s[50:51]
    s_cbranch_scc0 L2_d92
    s_mov_b64 exec, s[82:83]
    s_nop 1
    v_mfma_f32_4x4x4_16b_bf16 v[88:91], v[12:13], v[84:85], 0
    s_nop 1
    v_mfma_f32_4x4x4_16b_bf16 v[88:91], v[10:11], v[86:87], v[88:91]
    s_nop 4
    v_cvt_pk_bf16_f32 v88, v88, v89
    v_cvt_pk_bf16_f32 v89, v90, v91
    ds_pk_add_bf16 v7, v88 offset:65408
    ds_pk_add_bf16 v7, v89 offset:65412
    s_mov_b64 exec, s[50:51]
    s_branch L2_d92
L2_c93:
    s_lshl_b64 s[52:53], s[82:83], 1
    s_andn2_b64 s[52:53], s[52:53], s[80:81]
    s_andn2_b64 s[52:53], s[52:53], s[54:55]
    s_or_b64 s[80:81], s[80:81], s[52:53]
    s_not_b64 vcc, s[52:53]
    s_mov_b64 exec, -1
    v_cndmask_b32_dpp v84, v84, v84, vcc wave_shr:1 row_mask:0xf bank_mask:0xf
    v_cndmask_b32_dpp v85, v85, v85, vcc wave_shr:1 row_mask:0xf bank_mask:0xf
    s_lshr_b64 s[52:53], s[52:53], 1
    v_cndmask_b32_dpp v86, v86, v86, vcc wave_shr:1 row_mask:0xf bank_mask:0xf
    v_cndmask_b32_dpp v87, v87, v87, vcc wave_shr:1 row_mask:0xf bank_mask:0xf
    s_andn2_b64 s[82:83], s[82:83], s[52:53]
    v_cndmask_b32_dpp v7, v7, v7, vcc wave_shr:1 row_mask:0xf bank_mask:0xf
    s_mov_b64 exec, s[54:55]
    s_cbranch_scc0 L2_d93
    s_mov_b64 exec, s[82:83]
    s_nop 1
    v_mfma_f32_4x4x4_16b_bf16 v[88:91], v[12:13], v[84:85], 0
    s_nop 1
    v_mfma_f32_4x4x4_16b_bf16 v[88:91], v[10:11], v[86:87], v[88:91]
    s_nop 4
    v_cvt_pk_bf16_f32 v88, v88, v89
    v_cvt_pk_bf16_f32 v89, v90, v91
    ds_pk_add_bf16 v7, v88 offset:65408
    ds_pk_add_bf16 v7, v89 offset:65412
    s_mov_b64 exec, s[54:55]
    s_branch L2_d93
L2_c94:
    s_lshl_b64 s[52:53], s[82:83], 1
    s_andn2_b64 s[52:53], s[52:53], s[80:81]
    s_andn2_b64 s[52:53], s[52:53], s[50:51]
    s_or_b64 s[80:81], s[80:81], s[52:53]
    s_not_b64 vcc, s[52:53]
    s_mov_b64 exec, -1
    v_cndmask_b32_dpp v84, v84, v84, vcc wave_shr:1 row_mask:0xf bank_mask:0xf
    v_cndmask_b32_dpp v85, v85, v85, vcc wave_shr:1 row_mask:0xf bank_mask:0xf
    s_lshr_b64 s[52:53], s[52:53], 1
    v_cndmask_b32_dpp v86, v86, v86, vcc wave_shr:1 row_mask:0xf bank_mask:0xf
    v_cndmask_b32_dpp v87, v87, v87, vcc wave_shr:1 row_mask:0xf bank_mask:0xf
    s_andn2_b64 s[82:83], s[82:83], s[52:53]
    v_cndmask_b32_dpp v7, v7, v7, vcc wave_shr:1 row_mask:0xf bank_mask:0xf
    s_mov_b64 exec, s[50:51]
    s_cbranch_scc0 L2_d94
    s_mov_b64 exec, s[82:83]
    s_nop 1
    v_mfma_f32_4x4x4_16b_bf16 v[88:91], v[12:13], v[84:85], 0
    s_nop 1
    v_mfma_f32_4x4x4_16b_bf16 v[88:91], v[10:11], v[86:87], v[88:91]
    s_nop 4
    v_cvt_pk_bf16_f32 v88, v88, v89
    v_cvt_pk_bf16_f32 v89, v90, v91
    ds_pk_add_bf16 v7, v88 offset:65408
    ds_pk_add_bf16 v7, v89 offset:65412
    s_mov_b64 exec, s[50:51]
    s_branch L2_d94
L2_c95:
    s_lshl_b64 s[52:53], s[82:83], 1
    s_andn2_b64 s[52:53], s[52:53], s[80:81]
    s_andn2_b64 s[52:53], s[52:53], s[54:55]
    s_or_b64 s[80:81], s[80:81], s[52:53]
    s_not_b64 vcc, s[52:53]
    s_mov_b64 exec, -1
    v_cndmask_b32_dpp v84, v84, v84, vcc wave_shr:1 row_mask:0xf bank_mask:0xf
    v_cndmask_b32_dpp v85, v85, v85, vcc wave_shr:1 row_mask:0xf bank_mask:0xf
    s_lshr_b64 s[52:53], s[52:53], 1
    v_cndmask_b32_dpp v86, v86, v86, vcc wave_shr:1 row_mask:0xf bank_mask:0xf
    v_cndmask_b32_dpp v87, v87, v87, vcc wave_shr:1 row_mask:0xf bank_mask:0xf
    s_andn2_b64 s[82:83], s[82:83], s[52:53]
    v_cndmask_b32_dpp v7, v7, v7, vcc wave_shr:1 row_mask:0xf bank_mask:0xf
    s_mov_b64 exec, s[54:55]
    s_cbranch_scc0 L2_d95
    s_mov_b64 exec, s[82:83]
    s_nop 1
    v_mfma_f32_4x4x4_16b_bf16 v[88:91], v[12:13], v[84:85], 0
    s_nop 1
    v_mfma_f32_4x4x4_16b_bf16 v[88:91], v[10:11], v[86:87], v[88:91]
    s_nop 4
    v_cvt_pk_bf16_f32 v88, v88, v89
    v_cvt_pk_bf16_f32 v89, v90, v91
    ds_pk_add_bf16 v7, v88 offset:65408
    ds_pk_add_bf16 v7, v89 offset:65412
    s_mov_b64 exec, s[54:55]
    s_branch L2_d95
L2_c96:
    s_lshl_b64 s[52:53], s[82:83], 1
    s_andn2_b64 s[52:53], s[52:53], s[80:81]
    s_andn2_b64 s[52:53], s[52:53], s[50:51]
    s_or_b64 s[80:81], s[80:81], s[52:53]
    s_not_b64 vcc, s[52:53]
    s_mov_b64 exec, -1
    v_cndmask_b32_dpp v84, v84, v84, vcc wave_shr:1 row_mask:0xf bank_mask:0xf
    v_cndmask_b32_dpp v85, v85, v85, vcc wave_shr:1 row_mask:0xf bank_mask:0xf
    s_lshr_b64 s[52:53], s[52:53], 1
    v_cndmask_b32_dpp v86, v86, v86, vcc wave_shr:1 row_mask:0xf bank_mask:0xf
    v_cndmask_b32_dpp v87, v87, v87, vcc wave_shr:1 row_mask:0xf bank_mask:0xf
    s_andn2_b64 s[82:83], s[82:83], s[52:53]
    v_cndmask_b32_dpp v7, v7, v7, vcc wave_shr:1 row_mask:0xf bank_mask:0xf
    s_mov_b64 exec, s[50:51]
    s_cbranch_scc0 L2_d96
    s_mov_b64 exec, s[82:83]
    s_nop 1
    v_mfma_f32_4x4x4_16b_bf16 v[88:91], v[12:13], v[84:85], 0
    s_nop 1
    v_mfma_f32_4x4x4_16b_bf16 v[88:91], v[10:11], v[86:87], v[88:91]
    s_nop 4
    v_cvt_pk_bf16_f32 v88, v88, v89
    v_cvt_pk_bf16_f32 v89, v90, v91
    ds_pk_add_bf16 v7, v88 offset:65408
    ds_pk_add_bf16 v7, v89 offset:65412
    s_mov_b64 exec, s[50:51]
    s_branch L2_d96
L2_xa97:
    s_cmp_eq_u32 s101, 1
    s_cbranch_scc1 L2_xc97
    v_lshlrev_b32 v89, 0, v96
    v_add_u32 v90, 140, v97
    v_bitop3_b32 v90, v89, v45, v90 bitop3:0x6a
    ds_write_b32 v98, v90 offset:28
    v_lshlrev_b32 v89, 4, v96
    v_add_u32 v90, 120, v97
    v_bitop3_b32 v90, v89, v45, v90 bitop3:0x6a
    ds_write_b32 v98, v90 offset:24
    v_lshlrev_b32 v89, 8, v96
    v_add_u32 v90, 100, v97
    v_bitop3_b32 v90, v89, v45, v90 bitop3:0x6a
    ds_write_b32 v98, v90 offset:20
L2_xc97:
    v_lshlrev_b32 v89, 12, v96
    v_add_u32 v90, 80, v97
    v_bitop3_b32 v90, v89, v45, v90 bitop3:0x6a
    ds_write_b32 v98, v90 offset:16
    s_branch L2_xb97
L2_xe97:
    v_cmp_lt_u32 vcc, 32, v99
    v_cmp_lt_u32 s[58:59], 31, v88
    v_lshrrev_b32 v89, 16, v96
    v_add_u32 v97, 80, v97
    s_or_b64 vcc, vcc, s[58:59]
    s_cbranch_scc1 L2_xs97
    v_lshlrev_b32 v89, v1, v89
    v_and_b32 v89, v45, v89
    v_cmp_ne_u32 vcc, 0, v89
    v_xor_b32 v90, v97, v89
    s_add_u32 s3, s37, s38
    v_mbcnt_lo_u32_b32 v98, vcc_lo, 0
    v_mbcnt_hi_u32_b32 v98, vcc_hi, v98
    s_bcnt1_i32_b64 s41, vcc
    v_lshl_add_u32 v98, v98, 2, s3
    s_lshl2_add_u32 s37, s41, s37
    s_mov_b64 exec, vcc
    ds_write_b32 v98, v90
    s_mov_b64 exec, -1
    s_branch L2_xr97
L2_xs97:
    s_waitcnt lgkmcnt(0)
    s_mov_b32 s37, 0x10000
    s_branch L2_xw97
L2_c98:
    s_lshl_b64 s[52:53], s[82:83], 1
    s_andn2_b64 s[52:53], s[52:53], s[80:81]
    s_andn2_b64 s[52:53], s[52:53], s[54:55]
    s_or_b64 s[80:81], s[80:81], s[52:53]
    s_not_b64 vcc, s[52:53]
    s_mov_b64 exec, -1
    v_cndmask_b32_dpp v84, v84, v84, vcc wave_shr:1 row_mask:0xf bank_mask:0xf
    v_cndmask_b32_dpp v85, v85, v85, vcc wave_shr:1 row_mask:0xf bank_mask:0xf
    s_lshr_b64 s[52:53], s[52:53], 1
    v_cndmask_b32_dpp v86, v86, v86, vcc wave_shr:1 row_mask:0xf bank_mask:0xf
    v_cndmask_b32_dpp v87, v87, v87, vcc wave_shr:1 row_mask:0xf bank_mask:0xf
    s_andn2_b64 s[82:83], s[82:83], s[52:53]
    v_cndmask_b32_dpp v7, v7, v7, vcc wave_shr:1 row_mask:0xf bank_mask:0xf
    s_mov_b64 exec, s[54:55]
    s_cbranch_scc0 L2_d98
    s_mov_b64 exec, s[82:83]
    s_nop 1
    v_mfma_f32_4x4x4_16b_bf16 v[88:91], v[12:13], v[84:85], 0
    s_nop 1
    v_mfma_f32_4x4x4_16b_bf16 v[88:91], v[10:11], v[86:87], v[88:91]
    s_nop 4
    v_cvt_pk_bf16_f32 v88, v88, v89
    v_cvt_pk_bf16_f32 v89, v90, v91
    ds_pk_add_bf16 v7, v88 offset:65408
    ds_pk_add_bf16 v7, v89 offset:65412
    s_mov_b64 exec, s[54:55]
    s_branch L2_d98
L2_c99:
    s_lshl_b64 s[52:53], s[82:83], 1
    s_andn2_b64 s[52:53], s[52:53], s[80:81]
    s_andn2_b64 s[52:53], s[52:53], s[50:51]
    s_or_b64 s[80:81], s[80:81], s[52:53]
    s_not_b64 vcc, s[52:53]
    s_mov_b64 exec, -1
    v_cndmask_b32_dpp v84, v84, v84, vcc wave_shr:1 row_mask:0xf bank_mask:0xf
    v_cndmask_b32_dpp v85, v85, v85, vcc wave_shr:1 row_mask:0xf bank_mask:0xf
    s_lshr_b64 s[52:53], s[52:53], 1
    v_cndmask_b32_dpp v86, v86, v86, vcc wave_shr:1 row_mask:0xf bank_mask:0xf
    v_cndmask_b32_dpp v87, v87, v87, vcc wave_shr:1 row_mask:0xf bank_mask:0xf
    s_andn2_b64 s[82:83], s[82:83], s[52:53]
    v_cndmask_b32_dpp v7, v7, v7, vcc wave_shr:1 row_mask:0xf bank_mask:0xf
    s_mov_b64 exec, s[50:51]
    s_cbranch_scc0 L2_d99
    s_mov_b64 exec, s[82:83]
    s_nop 1
    v_mfma_f32_4x4x4_16b_bf16 v[88:91], v[12:13], v[84:85], 0
    s_nop 1
    v_mfma_f32_4x4x4_16b_bf16 v[88:91], v[10:11], v[86:87], v[88:91]
    s_nop 4
    v_cvt_pk_bf16_f32 v88, v88, v89
    v_cvt_pk_bf16_f32 v89, v90, v91
    ds_pk_add_bf16 v7, v88 offset:65408
    ds_pk_add_bf16 v7, v89 offset:65412
    s_mov_b64 exec, s[50:51]
    s_branch L2_d99
L2_xf97:
    s_cmp_gt_u32 s37, 1024
    s_cbranch_scc1 L2_xt97
    s_cmp_lt_u32 s37, 768
    s_cbranch_scc1 L2_xl97
    ds_read_b32 v32, v44 offset:896
    s_add_u32 s3, s42, 2
    s_bitset1_b32 s43, s3
    s_branch L2_xg97
L2_xl97:
    s_waitcnt lgkmcnt(0)
    v_mov_b32 v31, -1
    s_cmp_ge_u32 s37, 512
    s_cbranch_scc1 L2_xg97
    v_mov_b32 v39, -1
    s_cmp_ge_u32 s37, 256
    s_cbranch_scc1 L2_xg97
    v_mov_b32 v27, -1
    s_branch L2_xg97
L2_xt97:
    s_waitcnt lgkmcnt(0)
    v_mov_b32 v21, -1
    v_mov_b32 v27, -1
    v_mov_b32 v39, -1
    v_mov_b32 v31, -1
    s_add_u32 s3, s42, 2
    s_bitset1_b32 s36, s3
    s_branch L2_xg97
L2_oa100:
    v_and_b32 v47, 0x0fffffff, v33
    buffer_load_dword v114, v47, s[8:11], 0 offen offset:16
    s_mov_b64 exec, s[6:7]
    v_add_u32 v47, 8, v47
    v_lshrrev_b32 v33, 2, v33
    s_mov_b64 exec, -1
    buffer_load_dwordx2 v[112:113], v47, s[8:11], 0 offen
    s_branch L2_ob100
L2_c101:
    s_lshl_b64 s[52:53], s[82:83], 1
    s_andn2_b64 s[52:53], s[52:53], s[80:81]
    s_andn2_b64 s[52:53], s[52:53], s[54:55]
    s_or_b64 s[80:81], s[80:81], s[52:53]
    s_not_b64 vcc, s[52:53]
    s_mov_b64 exec, -1
    v_cndmask_b32_dpp v84, v84, v84, vcc wave_shr:1 row_mask:0xf bank_mask:0xf
    v_cndmask_b32_dpp v85, v85, v85, vcc wave_shr:1 row_mask:0xf bank_mask:0xf
    s_lshr_b64 s[52:53], s[52:53], 1
    v_cndmask_b32_dpp v86, v86, v86, vcc wave_shr:1 row_mask:0xf bank_mask:0xf
    v_cndmask_b32_dpp v87, v87, v87, vcc wave_shr:1 row_mask:0xf bank_mask:0xf
    s_andn2_b64 s[82:83], s[82:83], s[52:53]
    v_cndmask_b32_dpp v7, v7, v7, vcc wave_shr:1 row_mask:0xf bank_mask:0xf
    s_mov_b64 exec, s[54:55]
    s_cbranch_scc0 L2_d101
    s_mov_b64 exec, s[82:83]
    s_nop 1
    v_mfma_f32_4x4x4_16b_bf16 v[88:91], v[12:13], v[84:85], 0
    s_nop 1
    v_mfma_f32_4x4x4_16b_bf16 v[88:91], v[10:11], v[86:87], v[88:91]
    s_nop 4
    v_cvt_pk_bf16_f32 v88, v88, v89
    v_cvt_pk_bf16_f32 v89, v90, v91
    ds_pk_add_bf16 v7, v88 offset:65408
    ds_pk_add_bf16 v7, v89 offset:65412
    s_mov_b64 exec, s[54:55]
    s_branch L2_d101
L2_c102:
    s_lshl_b64 s[52:53], s[82:83], 1
    s_andn2_b64 s[52:53], s[52:53], s[80:81]
    s_andn2_b64 s[52:53], s[52:53], s[50:51]
    s_or_b64 s[80:81], s[80:81], s[52:53]
    s_not_b64 vcc, s[52:53]
    s_mov_b64 exec, -1
    v_cndmask_b32_dpp v84, v84, v84, vcc wave_shr:1 row_mask:0xf bank_mask:0xf
    v_cndmask_b32_dpp v85, v85, v85, vcc wave_shr:1 row_mask:0xf bank_mask:0xf
    s_lshr_b64 s[52:53], s[52:53], 1
    v_cndmask_b32_dpp v86, v86, v86, vcc wave_shr:1 row_mask:0xf bank_mask:0xf
    v_cndmask_b32_dpp v87, v87, v87, vcc wave_shr:1 row_mask:0xf bank_mask:0xf
    s_andn2_b64 s[82:83], s[82:83], s[52:53]
    v_cndmask_b32_dpp v7, v7, v7, vcc wave_shr:1 row_mask:0xf bank_mask:0xf
    s_mov_b64 exec, s[50:51]
    s_cbranch_scc0 L2_d102
    s_mov_b64 exec, s[82:83]
    s_nop 1
    v_mfma_f32_4x4x4_16b_bf16 v[88:91], v[12:13], v[84:85], 0
    s_nop 1
    v_mfma_f32_4x4x4_16b_bf16 v[88:91], v[10:11], v[86:87], v[88:91]
    s_nop 4
    v_cvt_pk_bf16_f32 v88, v88, v89
    v_cvt_pk_bf16_f32 v89, v90, v91
    ds_pk_add_bf16 v7, v88 offset:65408
    ds_pk_add_bf16 v7, v89 offset:65412
    s_mov_b64 exec, s[50:51]
    s_branch L2_d102
L2_c103:
    s_lshl_b64 s[52:53], s[82:83], 1
    s_andn2_b64 s[52:53], s[52:53], s[80:81]
    s_andn2_b64 s[52:53], s[52:53], s[54:55]
    s_or_b64 s[80:81], s[80:81], s[52:53]
    s_not_b64 vcc, s[52:53]
    s_mov_b64 exec, -1
    v_cndmask_b32_dpp v84, v84, v84, vcc wave_shr:1 row_mask:0xf bank_mask:0xf
    v_cndmask_b32_dpp v85, v85, v85, vcc wave_shr:1 row_mask:0xf bank_mask:0xf
    s_lshr_b64 s[52:53], s[52:53], 1
    v_cndmask_b32_dpp v86, v86, v86, vcc wave_shr:1 row_mask:0xf bank_mask:0xf
    v_cndmask_b32_dpp v87, v87, v87, vcc wave_shr:1 row_mask:0xf bank_mask:0xf
    s_andn2_b64 s[82:83], s[82:83], s[52:53]
    v_cndmask_b32_dpp v7, v7, v7, vcc wave_shr:1 row_mask:0xf bank_mask:0xf
    s_mov_b64 exec, s[54:55]
    s_cbranch_scc0 L2_d103
    s_mov_b64 exec, s[82:83]
    s_nop 1
    v_mfma_f32_4x4x4_16b_bf16 v[88:91], v[12:13], v[84:85], 0
    s_nop 1
    v_mfma_f32_4x4x4_16b_bf16 v[88:91], v[10:11], v[86:87], v[88:91]
    s_nop 4
    v_cvt_pk_bf16_f32 v88, v88, v89
    v_cvt_pk_bf16_f32 v89, v90, v91
    ds_pk_add_bf16 v7, v88 offset:65408
    ds_pk_add_bf16 v7, v89 offset:65412
    s_mov_b64 exec, s[54:55]
    s_branch L2_d103
L2_c104:
    s_lshl_b64 s[52:53], s[82:83], 1
    s_andn2_b64 s[52:53], s[52:53], s[80:81]
    s_andn2_b64 s[52:53], s[52:53], s[50:51]
    s_or_b64 s[80:81], s[80:81], s[52:53]
    s_not_b64 vcc, s[52:53]
    s_mov_b64 exec, -1
    v_cndmask_b32_dpp v84, v84, v84, vcc wave_shr:1 row_mask:0xf bank_mask:0xf
    v_cndmask_b32_dpp v85, v85, v85, vcc wave_shr:1 row_mask:0xf bank_mask:0xf
    s_lshr_b64 s[52:53], s[52:53], 1
    v_cndmask_b32_dpp v86, v86, v86, vcc wave_shr:1 row_mask:0xf bank_mask:0xf
    v_cndmask_b32_dpp v87, v87, v87, vcc wave_shr:1 row_mask:0xf bank_mask:0xf
    s_andn2_b64 s[82:83], s[82:83], s[52:53]
    v_cndmask_b32_dpp v7, v7, v7, vcc wave_shr:1 row_mask:0xf bank_mask:0xf
    s_mov_b64 exec, s[50:51]
    s_cbranch_scc0 L2_d104
    s_mov_b64 exec, s[82:83]
    s_nop 1
    v_mfma_f32_4x4x4_16b_bf16 v[88:91], v[12:13], v[84:85], 0
    s_nop 1
    v_mfma_f32_4x4x4_16b_bf16 v[88:91], v[10:11], v[86:87], v[88:91]
    s_nop 4
    v_cvt_pk_bf16_f32 v88, v88, v89
    v_cvt_pk_bf16_f32 v89, v90, v91
    ds_pk_add_bf16 v7, v88 offset:65408
    ds_pk_add_bf16 v7, v89 offset:65412
    s_mov_b64 exec, s[50:51]
    s_branch L2_d104
L2_c105:
    s_lshl_b64 s[52:53], s[82:83], 1
    s_andn2_b64 s[52:53], s[52:53], s[80:81]
    s_andn2_b64 s[52:53], s[52:53], s[54:55]
    s_or_b64 s[80:81], s[80:81], s[52:53]
    s_not_b64 vcc, s[52:53]
    s_mov_b64 exec, -1
    v_cndmask_b32_dpp v84, v84, v84, vcc wave_shr:1 row_mask:0xf bank_mask:0xf
    v_cndmask_b32_dpp v85, v85, v85, vcc wave_shr:1 row_mask:0xf bank_mask:0xf
    s_lshr_b64 s[52:53], s[52:53], 1
    v_cndmask_b32_dpp v86, v86, v86, vcc wave_shr:1 row_mask:0xf bank_mask:0xf
    v_cndmask_b32_dpp v87, v87, v87, vcc wave_shr:1 row_mask:0xf bank_mask:0xf
    s_andn2_b64 s[82:83], s[82:83], s[52:53]
    v_cndmask_b32_dpp v7, v7, v7, vcc wave_shr:1 row_mask:0xf bank_mask:0xf
    s_mov_b64 exec, s[54:55]
    s_cbranch_scc0 L2_d105
    s_mov_b64 exec, s[82:83]
    s_nop 1
    v_mfma_f32_4x4x4_16b_bf16 v[88:91], v[12:13], v[84:85], 0
    s_nop 1
    v_mfma_f32_4x4x4_16b_bf16 v[88:91], v[10:11], v[86:87], v[88:91]
    s_nop 4
    v_cvt_pk_bf16_f32 v88, v88, v89
    v_cvt_pk_bf16_f32 v89, v90, v91
    ds_pk_add_bf16 v7, v88 offset:65408
    ds_pk_add_bf16 v7, v89 offset:65412
    s_mov_b64 exec, s[54:55]
    s_branch L2_d105
L2_c106:
    s_lshl_b64 s[52:53], s[82:83], 1
    s_andn2_b64 s[52:53], s[52:53], s[80:81]
    s_andn2_b64 s[52:53], s[52:53], s[50:51]
    s_or_b64 s[80:81], s[80:81], s[52:53]
    s_not_b64 vcc, s[52:53]
    s_mov_b64 exec, -1
    v_cndmask_b32_dpp v84, v84, v84, vcc wave_shr:1 row_mask:0xf bank_mask:0xf
    v_cndmask_b32_dpp v85, v85, v85, vcc wave_shr:1 row_mask:0xf bank_mask:0xf
    s_lshr_b64 s[52:53], s[52:53], 1
    v_cndmask_b32_dpp v86, v86, v86, vcc wave_shr:1 row_mask:0xf bank_mask:0xf
    v_cndmask_b32_dpp v87, v87, v87, vcc wave_shr:1 row_mask:0xf bank_mask:0xf
    s_andn2_b64 s[82:83], s[82:83], s[52:53]
    v_cndmask_b32_dpp v7, v7, v7, vcc wave_shr:1 row_mask:0xf bank_mask:0xf
    s_mov_b64 exec, s[50:51]
    s_cbranch_scc0 L2_d106
    s_mov_b64 exec, s[82:83]
    s_nop 1
    v_mfma_f32_4x4x4_16b_bf16 v[88:91], v[12:13], v[84:85], 0
    s_nop 1
    v_mfma_f32_4x4x4_16b_bf16 v[88:91], v[10:11], v[86:87], v[88:91]
    s_nop 4
    v_cvt_pk_bf16_f32 v88, v88, v89
    v_cvt_pk_bf16_f32 v89, v90, v91
    ds_pk_add_bf16 v7, v88 offset:65408
    ds_pk_add_bf16 v7, v89 offset:65412
    s_mov_b64 exec, s[50:51]
    s_branch L2_d106
L2_oa107:
    s_waitcnt vmcnt(3)
    s_mov_b64 exec, s[6:7]
    v_lshrrev_b32 v114, 16, v114
    s_mov_b64 exec, -1
    v_and_b32 v46, 0x10000000, v33
    v_cmpx_eq_u32 vcc, 0, v46
    v_lshrrev_b32 v47, 14, v112
    v_and_b32 v47, v5, v47
    ds_read_b64 v[96:97], v47
    v_perm_b32 v98, v112, v114, s44
    v_bitop3_b32 v99, v112, 0.5, -0.5 bitop3:0xa8
    v_bitop3_b32 v98, v6, v98, v99 bitop3:0xca
    v_and_b32 v47, v5, v112
    s_waitcnt lgkmcnt(0)
    v_mfma_f32_4x4x4_16b_bf16 v[88:91], v[8:9], v[96:97], 0
    s_nop 4
    v_mul_f32 v88, v98, v88
    v_mul_f32 v89, v98, v89
    v_mul_f32 v90, v98, v90
    v_mul_f32 v91, v98, v91
    v_cvt_pk_bf16_f32 v88, v88, v89
    v_cvt_pk_bf16_f32 v89, v90, v91
    ds_pk_add_bf16 v47, v88 offset:65408
    ds_pk_add_bf16 v47, v89 offset:65412
    s_mov_b64 exec, -1
    v_and_b32 v46, 0x20000000, v33
    v_cmpx_eq_u32 vcc, 0, v46
    v_lshrrev_b32 v47, 14, v113
    v_and_b32 v47, v5, v47
    ds_read_b64 v[96:97], v47
    v_perm_b32 v98, v113, v114, s45
    v_bitop3_b32 v99, v113, 0.5, -0.5 bitop3:0xa8
    v_bitop3_b32 v98, v6, v98, v99 bitop3:0xca
    v_and_b32 v47, v5, v113
    s_waitcnt lgkmcnt(0)
    v_mfma_f32_4x4x4_16b_bf16 v[88:91], v[8:9], v[96:97], 0
    s_nop 4
    v_mul_f32 v88, v98, v88
    v_mul_f32 v89, v98, v89
    v_mul_f32 v90, v98, v90
    v_mul_f32 v91, v98, v91
    v_cvt_pk_bf16_f32 v88, v88, v89
    v_cvt_pk_bf16_f32 v89, v90, v91
    ds_pk_add_bf16 v47, v88 offset:65408
    ds_pk_add_bf16 v47, v89 offset:65412
    s_mov_b64 exec, -1
    s_branch L2_ob107
L2_xo108:
    v_cmp_lt_u32 vcc, 20, v99
    s_mov_b32 s101, 1
    s_cbranch_vccz L2_xp108
    v_cmp_lt_u32 vcc, 32, v99
    v_cmp_lt_u32 s[58:59], 31, v88
    s_mov_b32 s101, 2
    s_or_b64 vcc, vcc, s[58:59]
    s_cbranch_scc0 L2_xp108
    s_mov_b32 s37, 0x10000
    s_branch L2_xp108
L2_c109:
    s_lshl_b64 s[52:53], s[82:83], 1
    s_andn2_b64 s[52:53], s[52:53], s[80:81]
    s_andn2_b64 s[52:53], s[52:53], s[54:55]
    s_or_b64 s[80:81], s[80:81], s[52:53]
    s_not_b64 vcc, s[52:53]
    s_mov_b64 exec, -1
    v_cndmask_b32_dpp v84, v84, v84, vcc wave_shr:1 row_mask:0xf bank_mask:0xf
    v_cndmask_b32_dpp v85, v85, v85, vcc wave_shr:1 row_mask:0xf bank_mask:0xf
    s_lshr_b64 s[52:53], s[52:53], 1
    v_cndmask_b32_dpp v86, v86, v86, vcc wave_shr:1 row_mask:0xf bank_mask:0xf
    v_cndmask_b32_dpp v87, v87, v87, vcc wave_shr:1 row_mask:0xf bank_mask:0xf
    s_andn2_b64 s[82:83], s[82:83], s[52:53]
    v_cndmask_b32_dpp v7, v7, v7, vcc wave_shr:1 row_mask:0xf bank_mask:0xf
    s_mov_b64 exec, s[54:55]
    s_cbranch_scc0 L2_d109
    s_mov_b64 exec, s[82:83]
    s_nop 1
    v_mfma_f32_4x4x4_16b_bf16 v[88:91], v[12:13], v[84:85], 0
    s_nop 1
    v_mfma_f32_4x4x4_16b_bf16 v[88:91], v[10:11], v[86:87], v[88:91]
    s_nop 4
    v_cvt_pk_bf16_f32 v88, v88, v89
    v_cvt_pk_bf16_f32 v89, v90, v91
    ds_pk_add_bf16 v7, v88 offset:65408
    ds_pk_add_bf16 v7, v89 offset:65412
    s_mov_b64 exec, s[54:55]
    s_branch L2_d109
L2_c110:
    s_lshl_b64 s[52:53], s[82:83], 1
    s_andn2_b64 s[52:53], s[52:53], s[80:81]
    s_andn2_b64 s[52:53], s[52:53], s[50:51]
    s_or_b64 s[80:81], s[80:81], s[52:53]
    s_not_b64 vcc, s[52:53]
    s_mov_b64 exec, -1
    v_cndmask_b32_dpp v84, v84, v84, vcc wave_shr:1 row_mask:0xf bank_mask:0xf
    v_cndmask_b32_dpp v85, v85, v85, vcc wave_shr:1 row_mask:0xf bank_mask:0xf
    s_lshr_b64 s[52:53], s[52:53], 1
    v_cndmask_b32_dpp v86, v86, v86, vcc wave_shr:1 row_mask:0xf bank_mask:0xf
    v_cndmask_b32_dpp v87, v87, v87, vcc wave_shr:1 row_mask:0xf bank_mask:0xf
    s_andn2_b64 s[82:83], s[82:83], s[52:53]
    v_cndmask_b32_dpp v7, v7, v7, vcc wave_shr:1 row_mask:0xf bank_mask:0xf
    s_mov_b64 exec, s[50:51]
    s_cbranch_scc0 L2_d110
    s_mov_b64 exec, s[82:83]
    s_nop 1
    v_mfma_f32_4x4x4_16b_bf16 v[88:91], v[12:13], v[84:85], 0
    s_nop 1
    v_mfma_f32_4x4x4_16b_bf16 v[88:91], v[10:11], v[86:87], v[88:91]
    s_nop 4
    v_cvt_pk_bf16_f32 v88, v88, v89
    v_cvt_pk_bf16_f32 v89, v90, v91
    ds_pk_add_bf16 v7, v88 offset:65408
    ds_pk_add_bf16 v7, v89 offset:65412
    s_mov_b64 exec, s[50:51]
    s_branch L2_d110
L2_c111:
    s_lshl_b64 s[52:53], s[82:83], 1
    s_andn2_b64 s[52:53], s[52:53], s[80:81]
    s_andn2_b64 s[52:53], s[52:53], s[54:55]
    s_or_b64 s[80:81], s[80:81], s[52:53]
    s_not_b64 vcc, s[52:53]
    s_mov_b64 exec, -1
    v_cndmask_b32_dpp v84, v84, v84, vcc wave_shr:1 row_mask:0xf bank_mask:0xf
    v_cndmask_b32_dpp v85, v85, v85, vcc wave_shr:1 row_mask:0xf bank_mask:0xf
    s_lshr_b64 s[52:53], s[52:53], 1
    v_cndmask_b32_dpp v86, v86, v86, vcc wave_shr:1 row_mask:0xf bank_mask:0xf
    v_cndmask_b32_dpp v87, v87, v87, vcc wave_shr:1 row_mask:0xf bank_mask:0xf
    s_andn2_b64 s[82:83], s[82:83], s[52:53]
    v_cndmask_b32_dpp v7, v7, v7, vcc wave_shr:1 row_mask:0xf bank_mask:0xf
    s_mov_b64 exec, s[54:55]
    s_cbranch_scc0 L2_d111
    s_mov_b64 exec, s[82:83]
    s_nop 1
    v_mfma_f32_4x4x4_16b_bf16 v[88:91], v[12:13], v[84:85], 0
    s_nop 1
    v_mfma_f32_4x4x4_16b_bf16 v[88:91], v[10:11], v[86:87], v[88:91]
    s_nop 4
    v_cvt_pk_bf16_f32 v88, v88, v89
    v_cvt_pk_bf16_f32 v89, v90, v91
    ds_pk_add_bf16 v7, v88 offset:65408
    ds_pk_add_bf16 v7, v89 offset:65412
    s_mov_b64 exec, s[54:55]
    s_branch L2_d111
L2_c112:
    s_lshl_b64 s[52:53], s[82:83], 1
    s_andn2_b64 s[52:53], s[52:53], s[80:81]
    s_andn2_b64 s[52:53], s[52:53], s[50:51]
    s_or_b64 s[80:81], s[80:81], s[52:53]
    s_not_b64 vcc, s[52:53]
    s_mov_b64 exec, -1
    v_cndmask_b32_dpp v84, v84, v84, vcc wave_shr:1 row_mask:0xf bank_mask:0xf
    v_cndmask_b32_dpp v85, v85, v85, vcc wave_shr:1 row_mask:0xf bank_mask:0xf
    s_lshr_b64 s[52:53], s[52:53], 1
    v_cndmask_b32_dpp v86, v86, v86, vcc wave_shr:1 row_mask:0xf bank_mask:0xf
    v_cndmask_b32_dpp v87, v87, v87, vcc wave_shr:1 row_mask:0xf bank_mask:0xf
    s_andn2_b64 s[82:83], s[82:83], s[52:53]
    v_cndmask_b32_dpp v7, v7, v7, vcc wave_shr:1 row_mask:0xf bank_mask:0xf
    s_mov_b64 exec, s[50:51]
    s_cbranch_scc0 L2_d112
    s_mov_b64 exec, s[82:83]
    s_nop 1
    v_mfma_f32_4x4x4_16b_bf16 v[88:91], v[12:13], v[84:85], 0
    s_nop 1
    v_mfma_f32_4x4x4_16b_bf16 v[88:91], v[10:11], v[86:87], v[88:91]
    s_nop 4
    v_cvt_pk_bf16_f32 v88, v88, v89
    v_cvt_pk_bf16_f32 v89, v90, v91
    ds_pk_add_bf16 v7, v88 offset:65408
    ds_pk_add_bf16 v7, v89 offset:65412
    s_mov_b64 exec, s[50:51]
    s_branch L2_d112
L2_c113:
    s_lshl_b64 s[52:53], s[82:83], 1
    s_andn2_b64 s[52:53], s[52:53], s[80:81]
    s_andn2_b64 s[52:53], s[52:53], s[54:55]
    s_or_b64 s[80:81], s[80:81], s[52:53]
    s_not_b64 vcc, s[52:53]
    s_mov_b64 exec, -1
    v_cndmask_b32_dpp v84, v84, v84, vcc wave_shr:1 row_mask:0xf bank_mask:0xf
    v_cndmask_b32_dpp v85, v85, v85, vcc wave_shr:1 row_mask:0xf bank_mask:0xf
    s_lshr_b64 s[52:53], s[52:53], 1
    v_cndmask_b32_dpp v86, v86, v86, vcc wave_shr:1 row_mask:0xf bank_mask:0xf
    v_cndmask_b32_dpp v87, v87, v87, vcc wave_shr:1 row_mask:0xf bank_mask:0xf
    s_andn2_b64 s[82:83], s[82:83], s[52:53]
    v_cndmask_b32_dpp v7, v7, v7, vcc wave_shr:1 row_mask:0xf bank_mask:0xf
    s_mov_b64 exec, s[54:55]
    s_cbranch_scc0 L2_d113
    s_mov_b64 exec, s[82:83]
    s_nop 1
    v_mfma_f32_4x4x4_16b_bf16 v[88:91], v[12:13], v[84:85], 0
    s_nop 1
    v_mfma_f32_4x4x4_16b_bf16 v[88:91], v[10:11], v[86:87], v[88:91]
    s_nop 4
    v_cvt_pk_bf16_f32 v88, v88, v89
    v_cvt_pk_bf16_f32 v89, v90, v91
    ds_pk_add_bf16 v7, v88 offset:65408
    ds_pk_add_bf16 v7, v89 offset:65412
    s_mov_b64 exec, s[54:55]
    s_branch L2_d113
L2_c114:
    s_lshl_b64 s[52:53], s[82:83], 1
    s_andn2_b64 s[52:53], s[52:53], s[80:81]
    s_andn2_b64 s[52:53], s[52:53], s[50:51]
    s_or_b64 s[80:81], s[80:81], s[52:53]
    s_not_b64 vcc, s[52:53]
    s_mov_b64 exec, -1
    v_cndmask_b32_dpp v84, v84, v84, vcc wave_shr:1 row_mask:0xf bank_mask:0xf
    v_cndmask_b32_dpp v85, v85, v85, vcc wave_shr:1 row_mask:0xf bank_mask:0xf
    s_lshr_b64 s[52:53], s[52:53], 1
    v_cndmask_b32_dpp v86, v86, v86, vcc wave_shr:1 row_mask:0xf bank_mask:0xf
    v_cndmask_b32_dpp v87, v87, v87, vcc wave_shr:1 row_mask:0xf bank_mask:0xf
    s_andn2_b64 s[82:83], s[82:83], s[52:53]
    v_cndmask_b32_dpp v7, v7, v7, vcc wave_shr:1 row_mask:0xf bank_mask:0xf
    s_mov_b64 exec, s[50:51]
    s_cbranch_scc0 L2_d114
    s_mov_b64 exec, s[82:83]
    s_nop 1
    v_mfma_f32_4x4x4_16b_bf16 v[88:91], v[12:13], v[84:85], 0
    s_nop 1
    v_mfma_f32_4x4x4_16b_bf16 v[88:91], v[10:11], v[86:87], v[88:91]
    s_nop 4
    v_cvt_pk_bf16_f32 v88, v88, v89
    v_cvt_pk_bf16_f32 v89, v90, v91
    ds_pk_add_bf16 v7, v88 offset:65408
    ds_pk_add_bf16 v7, v89 offset:65412
    s_mov_b64 exec, s[50:51]
    s_branch L2_d114
L2_xa115:
    s_cmp_eq_u32 s101, 1
    s_cbranch_scc1 L2_xc115
    v_lshlrev_b32 v89, 0, v96
    v_add_u32 v90, 140, v97
    v_bitop3_b32 v90, v89, v45, v90 bitop3:0x6a
    ds_write_b32 v98, v90 offset:28
    v_lshlrev_b32 v89, 4, v96
    v_add_u32 v90, 120, v97
    v_bitop3_b32 v90, v89, v45, v90 bitop3:0x6a
    ds_write_b32 v98, v90 offset:24
    v_lshlrev_b32 v89, 8, v96
    v_add_u32 v90, 100, v97
    v_bitop3_b32 v90, v89, v45, v90 bitop3:0x6a
    ds_write_b32 v98, v90 offset:20
L2_xc115:
    v_lshlrev_b32 v89, 12, v96
    v_add_u32 v90, 80, v97
    v_bitop3_b32 v90, v89, v45, v90 bitop3:0x6a
    ds_write_b32 v98, v90 offset:16
    s_branch L2_xb115
L2_xe115:
    v_cmp_lt_u32 vcc, 32, v99
    v_cmp_lt_u32 s[58:59], 31, v88
    v_lshrrev_b32 v89, 16, v96
    v_add_u32 v97, 80, v97
    s_or_b64 vcc, vcc, s[58:59]
    s_cbranch_scc1 L2_xs115
    v_lshlrev_b32 v89, v1, v89
    v_and_b32 v89, v45, v89
    v_cmp_ne_u32 vcc, 0, v89
    v_xor_b32 v90, v97, v89
    s_add_u32 s3, s37, s38
    v_mbcnt_lo_u32_b32 v98, vcc_lo, 0
    v_mbcnt_hi_u32_b32 v98, vcc_hi, v98
    s_bcnt1_i32_b64 s41, vcc
    v_lshl_add_u32 v98, v98, 2, s3
    s_lshl2_add_u32 s37, s41, s37
    s_mov_b64 exec, vcc
    ds_write_b32 v98, v90
    s_mov_b64 exec, -1
    s_branch L2_xr115
L2_xs115:
    s_waitcnt lgkmcnt(0)
    s_mov_b32 s37, 0x10000
    s_branch L2_xw115
L2_c116:
    s_lshl_b64 s[52:53], s[82:83], 1
    s_andn2_b64 s[52:53], s[52:53], s[80:81]
    s_andn2_b64 s[52:53], s[52:53], s[54:55]
    s_or_b64 s[80:81], s[80:81], s[52:53]
    s_not_b64 vcc, s[52:53]
    s_mov_b64 exec, -1
    v_cndmask_b32_dpp v84, v84, v84, vcc wave_shr:1 row_mask:0xf bank_mask:0xf
    v_cndmask_b32_dpp v85, v85, v85, vcc wave_shr:1 row_mask:0xf bank_mask:0xf
    s_lshr_b64 s[52:53], s[52:53], 1
    v_cndmask_b32_dpp v86, v86, v86, vcc wave_shr:1 row_mask:0xf bank_mask:0xf
    v_cndmask_b32_dpp v87, v87, v87, vcc wave_shr:1 row_mask:0xf bank_mask:0xf
    s_andn2_b64 s[82:83], s[82:83], s[52:53]
    v_cndmask_b32_dpp v7, v7, v7, vcc wave_shr:1 row_mask:0xf bank_mask:0xf
    s_mov_b64 exec, s[54:55]
    s_cbranch_scc0 L2_d116
    s_mov_b64 exec, s[82:83]
    s_nop 1
    v_mfma_f32_4x4x4_16b_bf16 v[88:91], v[12:13], v[84:85], 0
    s_nop 1
    v_mfma_f32_4x4x4_16b_bf16 v[88:91], v[10:11], v[86:87], v[88:91]
    s_nop 4
    v_cvt_pk_bf16_f32 v88, v88, v89
    v_cvt_pk_bf16_f32 v89, v90, v91
    ds_pk_add_bf16 v7, v88 offset:65408
    ds_pk_add_bf16 v7, v89 offset:65412
    s_mov_b64 exec, s[54:55]
    s_branch L2_d116
L2_c117:
    s_lshl_b64 s[52:53], s[82:83], 1
    s_andn2_b64 s[52:53], s[52:53], s[80:81]
    s_andn2_b64 s[52:53], s[52:53], s[50:51]
    s_or_b64 s[80:81], s[80:81], s[52:53]
    s_not_b64 vcc, s[52:53]
    s_mov_b64 exec, -1
    v_cndmask_b32_dpp v84, v84, v84, vcc wave_shr:1 row_mask:0xf bank_mask:0xf
    v_cndmask_b32_dpp v85, v85, v85, vcc wave_shr:1 row_mask:0xf bank_mask:0xf
    s_lshr_b64 s[52:53], s[52:53], 1
    v_cndmask_b32_dpp v86, v86, v86, vcc wave_shr:1 row_mask:0xf bank_mask:0xf
    v_cndmask_b32_dpp v87, v87, v87, vcc wave_shr:1 row_mask:0xf bank_mask:0xf
    s_andn2_b64 s[82:83], s[82:83], s[52:53]
    v_cndmask_b32_dpp v7, v7, v7, vcc wave_shr:1 row_mask:0xf bank_mask:0xf
    s_mov_b64 exec, s[50:51]
    s_cbranch_scc0 L2_d117
    s_mov_b64 exec, s[82:83]
    s_nop 1
    v_mfma_f32_4x4x4_16b_bf16 v[88:91], v[12:13], v[84:85], 0
    s_nop 1
    v_mfma_f32_4x4x4_16b_bf16 v[88:91], v[10:11], v[86:87], v[88:91]
    s_nop 4
    v_cvt_pk_bf16_f32 v88, v88, v89
    v_cvt_pk_bf16_f32 v89, v90, v91
    ds_pk_add_bf16 v7, v88 offset:65408
    ds_pk_add_bf16 v7, v89 offset:65412
    s_mov_b64 exec, s[50:51]
    s_branch L2_d117
L2_xf115:
    s_cmp_gt_u32 s37, 1024
    s_cbranch_scc1 L2_xt115
    s_cmp_lt_u32 s37, 768
    s_cbranch_scc1 L2_xl115
    ds_read_b32 v33, v44 offset:896
    s_add_u32 s3, s42, 2
    s_bitset1_b32 s43, s3
    s_branch L2_xg115
L2_xl115:
    s_waitcnt lgkmcnt(0)
    v_mov_b32 v42, -1
    s_cmp_ge_u32 s37, 512
    s_cbranch_scc1 L2_xg115
    v_mov_b32 v43, -1
    s_cmp_ge_u32 s37, 256
    s_cbranch_scc1 L2_xg115
    v_mov_b32 v41, -1
    s_branch L2_xg115
L2_xt115:
    s_waitcnt lgkmcnt(0)
    v_mov_b32 v40, -1
    v_mov_b32 v41, -1
    v_mov_b32 v43, -1
    v_mov_b32 v42, -1
    s_add_u32 s3, s42, 2
    s_bitset1_b32 s36, s3
    s_branch L2_xg115
L2_oa118:
    v_and_b32 v47, 0x0fffffff, v32
    buffer_load_dword v114, v47, s[8:11], 0 offen offset:16
    s_mov_b64 exec, s[6:7]
    v_add_u32 v47, 8, v47
    v_lshrrev_b32 v32, 2, v32
    s_mov_b64 exec, -1
    buffer_load_dwordx2 v[112:113], v47, s[8:11], 0 offen
    s_branch L2_ob118
L2_c119:
    s_lshl_b64 s[52:53], s[82:83], 1
    s_andn2_b64 s[52:53], s[52:53], s[80:81]
    s_andn2_b64 s[52:53], s[52:53], s[54:55]
    s_or_b64 s[80:81], s[80:81], s[52:53]
    s_not_b64 vcc, s[52:53]
    s_mov_b64 exec, -1
    v_cndmask_b32_dpp v84, v84, v84, vcc wave_shr:1 row_mask:0xf bank_mask:0xf
    v_cndmask_b32_dpp v85, v85, v85, vcc wave_shr:1 row_mask:0xf bank_mask:0xf
    s_lshr_b64 s[52:53], s[52:53], 1
    v_cndmask_b32_dpp v86, v86, v86, vcc wave_shr:1 row_mask:0xf bank_mask:0xf
    v_cndmask_b32_dpp v87, v87, v87, vcc wave_shr:1 row_mask:0xf bank_mask:0xf
    s_andn2_b64 s[82:83], s[82:83], s[52:53]
    v_cndmask_b32_dpp v7, v7, v7, vcc wave_shr:1 row_mask:0xf bank_mask:0xf
    s_mov_b64 exec, s[54:55]
    s_cbranch_scc0 L2_d119
    s_mov_b64 exec, s[82:83]
    s_nop 1
    v_mfma_f32_4x4x4_16b_bf16 v[88:91], v[12:13], v[84:85], 0
    s_nop 1
    v_mfma_f32_4x4x4_16b_bf16 v[88:91], v[10:11], v[86:87], v[88:91]
    s_nop 4
    v_cvt_pk_bf16_f32 v88, v88, v89
    v_cvt_pk_bf16_f32 v89, v90, v91
    ds_pk_add_bf16 v7, v88 offset:65408
    ds_pk_add_bf16 v7, v89 offset:65412
    s_mov_b64 exec, s[54:55]
    s_branch L2_d119
L2_c120:
    s_lshl_b64 s[52:53], s[82:83], 1
    s_andn2_b64 s[52:53], s[52:53], s[80:81]
    s_andn2_b64 s[52:53], s[52:53], s[50:51]
    s_or_b64 s[80:81], s[80:81], s[52:53]
    s_not_b64 vcc, s[52:53]
    s_mov_b64 exec, -1
    v_cndmask_b32_dpp v84, v84, v84, vcc wave_shr:1 row_mask:0xf bank_mask:0xf
    v_cndmask_b32_dpp v85, v85, v85, vcc wave_shr:1 row_mask:0xf bank_mask:0xf
    s_lshr_b64 s[52:53], s[52:53], 1
    v_cndmask_b32_dpp v86, v86, v86, vcc wave_shr:1 row_mask:0xf bank_mask:0xf
    v_cndmask_b32_dpp v87, v87, v87, vcc wave_shr:1 row_mask:0xf bank_mask:0xf
    s_andn2_b64 s[82:83], s[82:83], s[52:53]
    v_cndmask_b32_dpp v7, v7, v7, vcc wave_shr:1 row_mask:0xf bank_mask:0xf
    s_mov_b64 exec, s[50:51]
    s_cbranch_scc0 L2_d120
    s_mov_b64 exec, s[82:83]
    s_nop 1
    v_mfma_f32_4x4x4_16b_bf16 v[88:91], v[12:13], v[84:85], 0
    s_nop 1
    v_mfma_f32_4x4x4_16b_bf16 v[88:91], v[10:11], v[86:87], v[88:91]
    s_nop 4
    v_cvt_pk_bf16_f32 v88, v88, v89
    v_cvt_pk_bf16_f32 v89, v90, v91
    ds_pk_add_bf16 v7, v88 offset:65408
    ds_pk_add_bf16 v7, v89 offset:65412
    s_mov_b64 exec, s[50:51]
    s_branch L2_d120
L2_c121:
    s_lshl_b64 s[52:53], s[82:83], 1
    s_andn2_b64 s[52:53], s[52:53], s[80:81]
    s_andn2_b64 s[52:53], s[52:53], s[54:55]
    s_or_b64 s[80:81], s[80:81], s[52:53]
    s_not_b64 vcc, s[52:53]
    s_mov_b64 exec, -1
    v_cndmask_b32_dpp v84, v84, v84, vcc wave_shr:1 row_mask:0xf bank_mask:0xf
    v_cndmask_b32_dpp v85, v85, v85, vcc wave_shr:1 row_mask:0xf bank_mask:0xf
    s_lshr_b64 s[52:53], s[52:53], 1
    v_cndmask_b32_dpp v86, v86, v86, vcc wave_shr:1 row_mask:0xf bank_mask:0xf
    v_cndmask_b32_dpp v87, v87, v87, vcc wave_shr:1 row_mask:0xf bank_mask:0xf
    s_andn2_b64 s[82:83], s[82:83], s[52:53]
    v_cndmask_b32_dpp v7, v7, v7, vcc wave_shr:1 row_mask:0xf bank_mask:0xf
    s_mov_b64 exec, s[54:55]
    s_cbranch_scc0 L2_d121
    s_mov_b64 exec, s[82:83]
    s_nop 1
    v_mfma_f32_4x4x4_16b_bf16 v[88:91], v[12:13], v[84:85], 0
    s_nop 1
    v_mfma_f32_4x4x4_16b_bf16 v[88:91], v[10:11], v[86:87], v[88:91]
    s_nop 4
    v_cvt_pk_bf16_f32 v88, v88, v89
    v_cvt_pk_bf16_f32 v89, v90, v91
    ds_pk_add_bf16 v7, v88 offset:65408
    ds_pk_add_bf16 v7, v89 offset:65412
    s_mov_b64 exec, s[54:55]
    s_branch L2_d121
L2_c122:
    s_lshl_b64 s[52:53], s[82:83], 1
    s_andn2_b64 s[52:53], s[52:53], s[80:81]
    s_andn2_b64 s[52:53], s[52:53], s[50:51]
    s_or_b64 s[80:81], s[80:81], s[52:53]
    s_not_b64 vcc, s[52:53]
    s_mov_b64 exec, -1
    v_cndmask_b32_dpp v84, v84, v84, vcc wave_shr:1 row_mask:0xf bank_mask:0xf
    v_cndmask_b32_dpp v85, v85, v85, vcc wave_shr:1 row_mask:0xf bank_mask:0xf
    s_lshr_b64 s[52:53], s[52:53], 1
    v_cndmask_b32_dpp v86, v86, v86, vcc wave_shr:1 row_mask:0xf bank_mask:0xf
    v_cndmask_b32_dpp v87, v87, v87, vcc wave_shr:1 row_mask:0xf bank_mask:0xf
    s_andn2_b64 s[82:83], s[82:83], s[52:53]
    v_cndmask_b32_dpp v7, v7, v7, vcc wave_shr:1 row_mask:0xf bank_mask:0xf
    s_mov_b64 exec, s[50:51]
    s_cbranch_scc0 L2_d122
    s_mov_b64 exec, s[82:83]
    s_nop 1
    v_mfma_f32_4x4x4_16b_bf16 v[88:91], v[12:13], v[84:85], 0
    s_nop 1
    v_mfma_f32_4x4x4_16b_bf16 v[88:91], v[10:11], v[86:87], v[88:91]
    s_nop 4
    v_cvt_pk_bf16_f32 v88, v88, v89
    v_cvt_pk_bf16_f32 v89, v90, v91
    ds_pk_add_bf16 v7, v88 offset:65408
    ds_pk_add_bf16 v7, v89 offset:65412
    s_mov_b64 exec, s[50:51]
    s_branch L2_d122
L2_c123:
    s_lshl_b64 s[52:53], s[82:83], 1
    s_andn2_b64 s[52:53], s[52:53], s[80:81]
    s_andn2_b64 s[52:53], s[52:53], s[54:55]
    s_or_b64 s[80:81], s[80:81], s[52:53]
    s_not_b64 vcc, s[52:53]
    s_mov_b64 exec, -1
    v_cndmask_b32_dpp v84, v84, v84, vcc wave_shr:1 row_mask:0xf bank_mask:0xf
    v_cndmask_b32_dpp v85, v85, v85, vcc wave_shr:1 row_mask:0xf bank_mask:0xf
    s_lshr_b64 s[52:53], s[52:53], 1
    v_cndmask_b32_dpp v86, v86, v86, vcc wave_shr:1 row_mask:0xf bank_mask:0xf
    v_cndmask_b32_dpp v87, v87, v87, vcc wave_shr:1 row_mask:0xf bank_mask:0xf
    s_andn2_b64 s[82:83], s[82:83], s[52:53]
    v_cndmask_b32_dpp v7, v7, v7, vcc wave_shr:1 row_mask:0xf bank_mask:0xf
    s_mov_b64 exec, s[54:55]
    s_cbranch_scc0 L2_d123
    s_mov_b64 exec, s[82:83]
    s_nop 1
    v_mfma_f32_4x4x4_16b_bf16 v[88:91], v[12:13], v[84:85], 0
    s_nop 1
    v_mfma_f32_4x4x4_16b_bf16 v[88:91], v[10:11], v[86:87], v[88:91]
    s_nop 4
    v_cvt_pk_bf16_f32 v88, v88, v89
    v_cvt_pk_bf16_f32 v89, v90, v91
    ds_pk_add_bf16 v7, v88 offset:65408
    ds_pk_add_bf16 v7, v89 offset:65412
    s_mov_b64 exec, s[54:55]
    s_branch L2_d123
L2_c124:
    s_lshl_b64 s[52:53], s[82:83], 1
    s_andn2_b64 s[52:53], s[52:53], s[80:81]
    s_andn2_b64 s[52:53], s[52:53], s[50:51]
    s_or_b64 s[80:81], s[80:81], s[52:53]
    s_not_b64 vcc, s[52:53]
    s_mov_b64 exec, -1
    v_cndmask_b32_dpp v84, v84, v84, vcc wave_shr:1 row_mask:0xf bank_mask:0xf
    v_cndmask_b32_dpp v85, v85, v85, vcc wave_shr:1 row_mask:0xf bank_mask:0xf
    s_lshr_b64 s[52:53], s[52:53], 1
    v_cndmask_b32_dpp v86, v86, v86, vcc wave_shr:1 row_mask:0xf bank_mask:0xf
    v_cndmask_b32_dpp v87, v87, v87, vcc wave_shr:1 row_mask:0xf bank_mask:0xf
    s_andn2_b64 s[82:83], s[82:83], s[52:53]
    v_cndmask_b32_dpp v7, v7, v7, vcc wave_shr:1 row_mask:0xf bank_mask:0xf
    s_mov_b64 exec, s[50:51]
    s_cbranch_scc0 L2_d124
    s_mov_b64 exec, s[82:83]
    s_nop 1
    v_mfma_f32_4x4x4_16b_bf16 v[88:91], v[12:13], v[84:85], 0
    s_nop 1
    v_mfma_f32_4x4x4_16b_bf16 v[88:91], v[10:11], v[86:87], v[88:91]
    s_nop 4
    v_cvt_pk_bf16_f32 v88, v88, v89
    v_cvt_pk_bf16_f32 v89, v90, v91
    ds_pk_add_bf16 v7, v88 offset:65408
    ds_pk_add_bf16 v7, v89 offset:65412
    s_mov_b64 exec, s[50:51]
    s_branch L2_d124
L2_oa125:
    s_waitcnt vmcnt(3)
    s_mov_b64 exec, s[6:7]
    v_lshrrev_b32 v114, 16, v114
    s_mov_b64 exec, -1
    v_and_b32 v46, 0x10000000, v32
    v_cmpx_eq_u32 vcc, 0, v46
    v_lshrrev_b32 v47, 14, v112
    v_and_b32 v47, v5, v47
    ds_read_b64 v[96:97], v47
    v_perm_b32 v98, v112, v114, s44
    v_bitop3_b32 v99, v112, 0.5, -0.5 bitop3:0xa8
    v_bitop3_b32 v98, v6, v98, v99 bitop3:0xca
    v_and_b32 v47, v5, v112
    s_waitcnt lgkmcnt(0)
    v_mfma_f32_4x4x4_16b_bf16 v[88:91], v[8:9], v[96:97], 0
    s_nop 4
    v_mul_f32 v88, v98, v88
    v_mul_f32 v89, v98, v89
    v_mul_f32 v90, v98, v90
    v_mul_f32 v91, v98, v91
    v_cvt_pk_bf16_f32 v88, v88, v89
    v_cvt_pk_bf16_f32 v89, v90, v91
    ds_pk_add_bf16 v47, v88 offset:65408
    ds_pk_add_bf16 v47, v89 offset:65412
    s_mov_b64 exec, -1
    v_and_b32 v46, 0x20000000, v32
    v_cmpx_eq_u32 vcc, 0, v46
    v_lshrrev_b32 v47, 14, v113
    v_and_b32 v47, v5, v47
    ds_read_b64 v[96:97], v47
    v_perm_b32 v98, v113, v114, s45
    v_bitop3_b32 v99, v113, 0.5, -0.5 bitop3:0xa8
    v_bitop3_b32 v98, v6, v98, v99 bitop3:0xca
    v_and_b32 v47, v5, v113
    s_waitcnt lgkmcnt(0)
    v_mfma_f32_4x4x4_16b_bf16 v[88:91], v[8:9], v[96:97], 0
    s_nop 4
    v_mul_f32 v88, v98, v88
    v_mul_f32 v89, v98, v89
    v_mul_f32 v90, v98, v90
    v_mul_f32 v91, v98, v91
    v_cvt_pk_bf16_f32 v88, v88, v89
    v_cvt_pk_bf16_f32 v89, v90, v91
    ds_pk_add_bf16 v47, v88 offset:65408
    ds_pk_add_bf16 v47, v89 offset:65412
    s_mov_b64 exec, -1
    s_branch L2_ob125
L2_c126:
    s_lshl_b64 s[52:53], s[82:83], 1
    s_andn2_b64 s[52:53], s[52:53], s[80:81]
    s_andn2_b64 s[52:53], s[52:53], s[54:55]
    s_or_b64 s[80:81], s[80:81], s[52:53]
    s_not_b64 vcc, s[52:53]
    s_mov_b64 exec, -1
    v_cndmask_b32_dpp v84, v84, v84, vcc wave_shr:1 row_mask:0xf bank_mask:0xf
    v_cndmask_b32_dpp v85, v85, v85, vcc wave_shr:1 row_mask:0xf bank_mask:0xf
    s_lshr_b64 s[52:53], s[52:53], 1
    v_cndmask_b32_dpp v86, v86, v86, vcc wave_shr:1 row_mask:0xf bank_mask:0xf
    v_cndmask_b32_dpp v87, v87, v87, vcc wave_shr:1 row_mask:0xf bank_mask:0xf
    s_andn2_b64 s[82:83], s[82:83], s[52:53]
    v_cndmask_b32_dpp v7, v7, v7, vcc wave_shr:1 row_mask:0xf bank_mask:0xf
    s_mov_b64 exec, s[54:55]
    s_cbranch_scc0 L2_d126
    s_mov_b64 exec, s[82:83]
    s_nop 1
    v_mfma_f32_4x4x4_16b_bf16 v[88:91], v[12:13], v[84:85], 0
    s_nop 1
    v_mfma_f32_4x4x4_16b_bf16 v[88:91], v[10:11], v[86:87], v[88:91]
    s_nop 4
    v_cvt_pk_bf16_f32 v88, v88, v89
    v_cvt_pk_bf16_f32 v89, v90, v91
    ds_pk_add_bf16 v7, v88 offset:65408
    ds_pk_add_bf16 v7, v89 offset:65412
    s_mov_b64 exec, s[54:55]
    s_branch L2_d126
L2_c127:
    s_lshl_b64 s[52:53], s[82:83], 1
    s_andn2_b64 s[52:53], s[52:53], s[80:81]
    s_andn2_b64 s[52:53], s[52:53], s[50:51]
    s_or_b64 s[80:81], s[80:81], s[52:53]
    s_not_b64 vcc, s[52:53]
    s_mov_b64 exec, -1
    v_cndmask_b32_dpp v84, v84, v84, vcc wave_shr:1 row_mask:0xf bank_mask:0xf
    v_cndmask_b32_dpp v85, v85, v85, vcc wave_shr:1 row_mask:0xf bank_mask:0xf
    s_lshr_b64 s[52:53], s[52:53], 1
    v_cndmask_b32_dpp v86, v86, v86, vcc wave_shr:1 row_mask:0xf bank_mask:0xf
    v_cndmask_b32_dpp v87, v87, v87, vcc wave_shr:1 row_mask:0xf bank_mask:0xf
    s_andn2_b64 s[82:83], s[82:83], s[52:53]
    v_cndmask_b32_dpp v7, v7, v7, vcc wave_shr:1 row_mask:0xf bank_mask:0xf
    s_mov_b64 exec, s[50:51]
    s_cbranch_scc0 L2_d127
    s_mov_b64 exec, s[82:83]
    s_nop 1
    v_mfma_f32_4x4x4_16b_bf16 v[88:91], v[12:13], v[84:85], 0
    s_nop 1
    v_mfma_f32_4x4x4_16b_bf16 v[88:91], v[10:11], v[86:87], v[88:91]
    s_nop 4
    v_cvt_pk_bf16_f32 v88, v88, v89
    v_cvt_pk_bf16_f32 v89, v90, v91
    ds_pk_add_bf16 v7, v88 offset:65408
    ds_pk_add_bf16 v7, v89 offset:65412
    s_mov_b64 exec, s[50:51]
    s_branch L2_d127
L2_c128:
    s_lshl_b64 s[52:53], s[82:83], 1
    s_andn2_b64 s[52:53], s[52:53], s[80:81]
    s_andn2_b64 s[52:53], s[52:53], s[54:55]
    s_or_b64 s[80:81], s[80:81], s[52:53]
    s_not_b64 vcc, s[52:53]
    s_mov_b64 exec, -1
    v_cndmask_b32_dpp v84, v84, v84, vcc wave_shr:1 row_mask:0xf bank_mask:0xf
    v_cndmask_b32_dpp v85, v85, v85, vcc wave_shr:1 row_mask:0xf bank_mask:0xf
    s_lshr_b64 s[52:53], s[52:53], 1
    v_cndmask_b32_dpp v86, v86, v86, vcc wave_shr:1 row_mask:0xf bank_mask:0xf
    v_cndmask_b32_dpp v87, v87, v87, vcc wave_shr:1 row_mask:0xf bank_mask:0xf
    s_andn2_b64 s[82:83], s[82:83], s[52:53]
    v_cndmask_b32_dpp v7, v7, v7, vcc wave_shr:1 row_mask:0xf bank_mask:0xf
    s_mov_b64 exec, s[54:55]
    s_cbranch_scc0 L2_d128
    s_mov_b64 exec, s[82:83]
    s_nop 1
    v_mfma_f32_4x4x4_16b_bf16 v[88:91], v[12:13], v[84:85], 0
    s_nop 1
    v_mfma_f32_4x4x4_16b_bf16 v[88:91], v[10:11], v[86:87], v[88:91]
    s_nop 4
    v_cvt_pk_bf16_f32 v88, v88, v89
    v_cvt_pk_bf16_f32 v89, v90, v91
    ds_pk_add_bf16 v7, v88 offset:65408
    ds_pk_add_bf16 v7, v89 offset:65412
    s_mov_b64 exec, s[54:55]
    s_branch L2_d128
L2_c129:
    s_lshl_b64 s[52:53], s[82:83], 1
    s_andn2_b64 s[52:53], s[52:53], s[80:81]
    s_andn2_b64 s[52:53], s[52:53], s[50:51]
    s_or_b64 s[80:81], s[80:81], s[52:53]
    s_not_b64 vcc, s[52:53]
    s_mov_b64 exec, -1
    v_cndmask_b32_dpp v84, v84, v84, vcc wave_shr:1 row_mask:0xf bank_mask:0xf
    v_cndmask_b32_dpp v85, v85, v85, vcc wave_shr:1 row_mask:0xf bank_mask:0xf
    s_lshr_b64 s[52:53], s[52:53], 1
    v_cndmask_b32_dpp v86, v86, v86, vcc wave_shr:1 row_mask:0xf bank_mask:0xf
    v_cndmask_b32_dpp v87, v87, v87, vcc wave_shr:1 row_mask:0xf bank_mask:0xf
    s_andn2_b64 s[82:83], s[82:83], s[52:53]
    v_cndmask_b32_dpp v7, v7, v7, vcc wave_shr:1 row_mask:0xf bank_mask:0xf
    s_mov_b64 exec, s[50:51]
    s_cbranch_scc0 L2_d129
    s_mov_b64 exec, s[82:83]
    s_nop 1
    v_mfma_f32_4x4x4_16b_bf16 v[88:91], v[12:13], v[84:85], 0
    s_nop 1
    v_mfma_f32_4x4x4_16b_bf16 v[88:91], v[10:11], v[86:87], v[88:91]
    s_nop 4
    v_cvt_pk_bf16_f32 v88, v88, v89
    v_cvt_pk_bf16_f32 v89, v90, v91
    ds_pk_add_bf16 v7, v88 offset:65408
    ds_pk_add_bf16 v7, v89 offset:65412
    s_mov_b64 exec, s[50:51]
    s_branch L2_d129
L2_c130:
    s_lshl_b64 s[52:53], s[82:83], 1
    s_andn2_b64 s[52:53], s[52:53], s[80:81]
    s_andn2_b64 s[52:53], s[52:53], s[54:55]
    s_or_b64 s[80:81], s[80:81], s[52:53]
    s_not_b64 vcc, s[52:53]
    s_mov_b64 exec, -1
    v_cndmask_b32_dpp v84, v84, v84, vcc wave_shr:1 row_mask:0xf bank_mask:0xf
    v_cndmask_b32_dpp v85, v85, v85, vcc wave_shr:1 row_mask:0xf bank_mask:0xf
    s_lshr_b64 s[52:53], s[52:53], 1
    v_cndmask_b32_dpp v86, v86, v86, vcc wave_shr:1 row_mask:0xf bank_mask:0xf
    v_cndmask_b32_dpp v87, v87, v87, vcc wave_shr:1 row_mask:0xf bank_mask:0xf
    s_andn2_b64 s[82:83], s[82:83], s[52:53]
    v_cndmask_b32_dpp v7, v7, v7, vcc wave_shr:1 row_mask:0xf bank_mask:0xf
    s_mov_b64 exec, s[54:55]
    s_cbranch_scc0 L2_d130
    s_mov_b64 exec, s[82:83]
    s_nop 1
    v_mfma_f32_4x4x4_16b_bf16 v[88:91], v[12:13], v[84:85], 0
    s_nop 1
    v_mfma_f32_4x4x4_16b_bf16 v[88:91], v[10:11], v[86:87], v[88:91]
    s_nop 4
    v_cvt_pk_bf16_f32 v88, v88, v89
    v_cvt_pk_bf16_f32 v89, v90, v91
    ds_pk_add_bf16 v7, v88 offset:65408
    ds_pk_add_bf16 v7, v89 offset:65412
    s_mov_b64 exec, s[54:55]
    s_branch L2_d130
L2_c131:
    s_lshl_b64 s[52:53], s[82:83], 1
    s_andn2_b64 s[52:53], s[52:53], s[80:81]
    s_andn2_b64 s[52:53], s[52:53], s[50:51]
    s_or_b64 s[80:81], s[80:81], s[52:53]
    s_not_b64 vcc, s[52:53]
    s_mov_b64 exec, -1
    v_cndmask_b32_dpp v84, v84, v84, vcc wave_shr:1 row_mask:0xf bank_mask:0xf
    v_cndmask_b32_dpp v85, v85, v85, vcc wave_shr:1 row_mask:0xf bank_mask:0xf
    s_lshr_b64 s[52:53], s[52:53], 1
    v_cndmask_b32_dpp v86, v86, v86, vcc wave_shr:1 row_mask:0xf bank_mask:0xf
    v_cndmask_b32_dpp v87, v87, v87, vcc wave_shr:1 row_mask:0xf bank_mask:0xf
    s_andn2_b64 s[82:83], s[82:83], s[52:53]
    v_cndmask_b32_dpp v7, v7, v7, vcc wave_shr:1 row_mask:0xf bank_mask:0xf
    s_mov_b64 exec, s[50:51]
    s_cbranch_scc0 L2_d131
    s_mov_b64 exec, s[82:83]
    s_nop 1
    v_mfma_f32_4x4x4_16b_bf16 v[88:91], v[12:13], v[84:85], 0
    s_nop 1
    v_mfma_f32_4x4x4_16b_bf16 v[88:91], v[10:11], v[86:87], v[88:91]
    s_nop 4
    v_cvt_pk_bf16_f32 v88, v88, v89
    v_cvt_pk_bf16_f32 v89, v90, v91
    ds_pk_add_bf16 v7, v88 offset:65408
    ds_pk_add_bf16 v7, v89 offset:65412
    s_mov_b64 exec, s[50:51]
    s_branch L2_d131
L2_c132:
    s_lshl_b64 s[52:53], s[82:83], 1
    s_andn2_b64 s[52:53], s[52:53], s[80:81]
    s_andn2_b64 s[52:53], s[52:53], s[54:55]
    s_or_b64 s[80:81], s[80:81], s[52:53]
    s_not_b64 vcc, s[52:53]
    s_mov_b64 exec, -1
    v_cndmask_b32_dpp v84, v84, v84, vcc wave_shr:1 row_mask:0xf bank_mask:0xf
    v_cndmask_b32_dpp v85, v85, v85, vcc wave_shr:1 row_mask:0xf bank_mask:0xf
    s_lshr_b64 s[52:53], s[52:53], 1
    v_cndmask_b32_dpp v86, v86, v86, vcc wave_shr:1 row_mask:0xf bank_mask:0xf
    v_cndmask_b32_dpp v87, v87, v87, vcc wave_shr:1 row_mask:0xf bank_mask:0xf
    s_andn2_b64 s[82:83], s[82:83], s[52:53]
    v_cndmask_b32_dpp v7, v7, v7, vcc wave_shr:1 row_mask:0xf bank_mask:0xf
    s_mov_b64 exec, s[54:55]
    s_cbranch_scc0 L2_d132
    s_mov_b64 exec, s[82:83]
    s_nop 1
    v_mfma_f32_4x4x4_16b_bf16 v[88:91], v[12:13], v[84:85], 0
    s_nop 1
    v_mfma_f32_4x4x4_16b_bf16 v[88:91], v[10:11], v[86:87], v[88:91]
    s_nop 4
    v_cvt_pk_bf16_f32 v88, v88, v89
    v_cvt_pk_bf16_f32 v89, v90, v91
    ds_pk_add_bf16 v7, v88 offset:65408
    ds_pk_add_bf16 v7, v89 offset:65412
    s_mov_b64 exec, s[54:55]
    s_branch L2_d132
L2_c133:
    s_lshl_b64 s[52:53], s[82:83], 1
    s_andn2_b64 s[52:53], s[52:53], s[80:81]
    s_andn2_b64 s[52:53], s[52:53], s[50:51]
    s_or_b64 s[80:81], s[80:81], s[52:53]
    s_not_b64 vcc, s[52:53]
    s_mov_b64 exec, -1
    v_cndmask_b32_dpp v84, v84, v84, vcc wave_shr:1 row_mask:0xf bank_mask:0xf
    v_cndmask_b32_dpp v85, v85, v85, vcc wave_shr:1 row_mask:0xf bank_mask:0xf
    s_lshr_b64 s[52:53], s[52:53], 1
    v_cndmask_b32_dpp v86, v86, v86, vcc wave_shr:1 row_mask:0xf bank_mask:0xf
    v_cndmask_b32_dpp v87, v87, v87, vcc wave_shr:1 row_mask:0xf bank_mask:0xf
    s_andn2_b64 s[82:83], s[82:83], s[52:53]
    v_cndmask_b32_dpp v7, v7, v7, vcc wave_shr:1 row_mask:0xf bank_mask:0xf
    s_mov_b64 exec, s[50:51]
    s_cbranch_scc0 L2_d133
    s_mov_b64 exec, s[82:83]
    s_nop 1
    v_mfma_f32_4x4x4_16b_bf16 v[88:91], v[12:13], v[84:85], 0
    s_nop 1
    v_mfma_f32_4x4x4_16b_bf16 v[88:91], v[10:11], v[86:87], v[88:91]
    s_nop 4
    v_cvt_pk_bf16_f32 v88, v88, v89
    v_cvt_pk_bf16_f32 v89, v90, v91
    ds_pk_add_bf16 v7, v88 offset:65408
    ds_pk_add_bf16 v7, v89 offset:65412
    s_mov_b64 exec, s[50:51]
    s_branch L2_d133
L2_oa134:
    v_and_b32 v47, 0x0fffffff, v33
    buffer_load_dword v114, v47, s[8:11], 0 offen offset:16
    s_mov_b64 exec, s[6:7]
    v_add_u32 v47, 8, v47
    v_lshrrev_b32 v33, 2, v33
    s_mov_b64 exec, -1
    buffer_load_dwordx2 v[112:113], v47, s[8:11], 0 offen
    s_branch L2_ob134
L2_c135:
    s_lshl_b64 s[52:53], s[82:83], 1
    s_andn2_b64 s[52:53], s[52:53], s[80:81]
    s_andn2_b64 s[52:53], s[52:53], s[54:55]
    s_or_b64 s[80:81], s[80:81], s[52:53]
    s_not_b64 vcc, s[52:53]
    s_mov_b64 exec, -1
    v_cndmask_b32_dpp v84, v84, v84, vcc wave_shr:1 row_mask:0xf bank_mask:0xf
    v_cndmask_b32_dpp v85, v85, v85, vcc wave_shr:1 row_mask:0xf bank_mask:0xf
    s_lshr_b64 s[52:53], s[52:53], 1
    v_cndmask_b32_dpp v86, v86, v86, vcc wave_shr:1 row_mask:0xf bank_mask:0xf
    v_cndmask_b32_dpp v87, v87, v87, vcc wave_shr:1 row_mask:0xf bank_mask:0xf
    s_andn2_b64 s[82:83], s[82:83], s[52:53]
    v_cndmask_b32_dpp v7, v7, v7, vcc wave_shr:1 row_mask:0xf bank_mask:0xf
    s_mov_b64 exec, s[54:55]
    s_cbranch_scc0 L2_d135
    s_mov_b64 exec, s[82:83]
    s_nop 1
    v_mfma_f32_4x4x4_16b_bf16 v[88:91], v[12:13], v[84:85], 0
    s_nop 1
    v_mfma_f32_4x4x4_16b_bf16 v[88:91], v[10:11], v[86:87], v[88:91]
    s_nop 4
    v_cvt_pk_bf16_f32 v88, v88, v89
    v_cvt_pk_bf16_f32 v89, v90, v91
    ds_pk_add_bf16 v7, v88 offset:65408
    ds_pk_add_bf16 v7, v89 offset:65412
    s_mov_b64 exec, s[54:55]
    s_branch L2_d135
L2_c136:
    s_lshl_b64 s[52:53], s[82:83], 1
    s_andn2_b64 s[52:53], s[52:53], s[80:81]
    s_andn2_b64 s[52:53], s[52:53], s[50:51]
    s_or_b64 s[80:81], s[80:81], s[52:53]
    s_not_b64 vcc, s[52:53]
    s_mov_b64 exec, -1
    v_cndmask_b32_dpp v84, v84, v84, vcc wave_shr:1 row_mask:0xf bank_mask:0xf
    v_cndmask_b32_dpp v85, v85, v85, vcc wave_shr:1 row_mask:0xf bank_mask:0xf
    s_lshr_b64 s[52:53], s[52:53], 1
    v_cndmask_b32_dpp v86, v86, v86, vcc wave_shr:1 row_mask:0xf bank_mask:0xf
    v_cndmask_b32_dpp v87, v87, v87, vcc wave_shr:1 row_mask:0xf bank_mask:0xf
    s_andn2_b64 s[82:83], s[82:83], s[52:53]
    v_cndmask_b32_dpp v7, v7, v7, vcc wave_shr:1 row_mask:0xf bank_mask:0xf
    s_mov_b64 exec, s[50:51]
    s_cbranch_scc0 L2_d136
    s_mov_b64 exec, s[82:83]
    s_nop 1
    v_mfma_f32_4x4x4_16b_bf16 v[88:91], v[12:13], v[84:85], 0
    s_nop 1
    v_mfma_f32_4x4x4_16b_bf16 v[88:91], v[10:11], v[86:87], v[88:91]
    s_nop 4
    v_cvt_pk_bf16_f32 v88, v88, v89
    v_cvt_pk_bf16_f32 v89, v90, v91
    ds_pk_add_bf16 v7, v88 offset:65408
    ds_pk_add_bf16 v7, v89 offset:65412
    s_mov_b64 exec, s[50:51]
    s_branch L2_d136
L2_c137:
    s_lshl_b64 s[52:53], s[82:83], 1
    s_andn2_b64 s[52:53], s[52:53], s[80:81]
    s_andn2_b64 s[52:53], s[52:53], s[54:55]
    s_or_b64 s[80:81], s[80:81], s[52:53]
    s_not_b64 vcc, s[52:53]
    s_mov_b64 exec, -1
    v_cndmask_b32_dpp v84, v84, v84, vcc wave_shr:1 row_mask:0xf bank_mask:0xf
    v_cndmask_b32_dpp v85, v85, v85, vcc wave_shr:1 row_mask:0xf bank_mask:0xf
    s_lshr_b64 s[52:53], s[52:53], 1
    v_cndmask_b32_dpp v86, v86, v86, vcc wave_shr:1 row_mask:0xf bank_mask:0xf
    v_cndmask_b32_dpp v87, v87, v87, vcc wave_shr:1 row_mask:0xf bank_mask:0xf
    s_andn2_b64 s[82:83], s[82:83], s[52:53]
    v_cndmask_b32_dpp v7, v7, v7, vcc wave_shr:1 row_mask:0xf bank_mask:0xf
    s_mov_b64 exec, s[54:55]
    s_cbranch_scc0 L2_d137
    s_mov_b64 exec, s[82:83]
    s_nop 1
    v_mfma_f32_4x4x4_16b_bf16 v[88:91], v[12:13], v[84:85], 0
    s_nop 1
    v_mfma_f32_4x4x4_16b_bf16 v[88:91], v[10:11], v[86:87], v[88:91]
    s_nop 4
    v_cvt_pk_bf16_f32 v88, v88, v89
    v_cvt_pk_bf16_f32 v89, v90, v91
    ds_pk_add_bf16 v7, v88 offset:65408
    ds_pk_add_bf16 v7, v89 offset:65412
    s_mov_b64 exec, s[54:55]
    s_branch L2_d137
L2_c138:
    s_lshl_b64 s[52:53], s[82:83], 1
    s_andn2_b64 s[52:53], s[52:53], s[80:81]
    s_andn2_b64 s[52:53], s[52:53], s[50:51]
    s_or_b64 s[80:81], s[80:81], s[52:53]
    s_not_b64 vcc, s[52:53]
    s_mov_b64 exec, -1
    v_cndmask_b32_dpp v84, v84, v84, vcc wave_shr:1 row_mask:0xf bank_mask:0xf
    v_cndmask_b32_dpp v85, v85, v85, vcc wave_shr:1 row_mask:0xf bank_mask:0xf
    s_lshr_b64 s[52:53], s[52:53], 1
    v_cndmask_b32_dpp v86, v86, v86, vcc wave_shr:1 row_mask:0xf bank_mask:0xf
    v_cndmask_b32_dpp v87, v87, v87, vcc wave_shr:1 row_mask:0xf bank_mask:0xf
    s_andn2_b64 s[82:83], s[82:83], s[52:53]
    v_cndmask_b32_dpp v7, v7, v7, vcc wave_shr:1 row_mask:0xf bank_mask:0xf
    s_mov_b64 exec, s[50:51]
    s_cbranch_scc0 L2_d138
    s_mov_b64 exec, s[82:83]
    s_nop 1
    v_mfma_f32_4x4x4_16b_bf16 v[88:91], v[12:13], v[84:85], 0
    s_nop 1
    v_mfma_f32_4x4x4_16b_bf16 v[88:91], v[10:11], v[86:87], v[88:91]
    s_nop 4
    v_cvt_pk_bf16_f32 v88, v88, v89
    v_cvt_pk_bf16_f32 v89, v90, v91
    ds_pk_add_bf16 v7, v88 offset:65408
    ds_pk_add_bf16 v7, v89 offset:65412
    s_mov_b64 exec, s[50:51]
    s_branch L2_d138
L2_c139:
    s_lshl_b64 s[52:53], s[82:83], 1
    s_andn2_b64 s[52:53], s[52:53], s[80:81]
    s_andn2_b64 s[52:53], s[52:53], s[54:55]
    s_or_b64 s[80:81], s[80:81], s[52:53]
    s_not_b64 vcc, s[52:53]
    s_mov_b64 exec, -1
    v_cndmask_b32_dpp v84, v84, v84, vcc wave_shr:1 row_mask:0xf bank_mask:0xf
    v_cndmask_b32_dpp v85, v85, v85, vcc wave_shr:1 row_mask:0xf bank_mask:0xf
    s_lshr_b64 s[52:53], s[52:53], 1
    v_cndmask_b32_dpp v86, v86, v86, vcc wave_shr:1 row_mask:0xf bank_mask:0xf
    v_cndmask_b32_dpp v87, v87, v87, vcc wave_shr:1 row_mask:0xf bank_mask:0xf
    s_andn2_b64 s[82:83], s[82:83], s[52:53]
    v_cndmask_b32_dpp v7, v7, v7, vcc wave_shr:1 row_mask:0xf bank_mask:0xf
    s_mov_b64 exec, s[54:55]
    s_cbranch_scc0 L2_d139
    s_mov_b64 exec, s[82:83]
    s_nop 1
    v_mfma_f32_4x4x4_16b_bf16 v[88:91], v[12:13], v[84:85], 0
    s_nop 1
    v_mfma_f32_4x4x4_16b_bf16 v[88:91], v[10:11], v[86:87], v[88:91]
    s_nop 4
    v_cvt_pk_bf16_f32 v88, v88, v89
    v_cvt_pk_bf16_f32 v89, v90, v91
    ds_pk_add_bf16 v7, v88 offset:65408
    ds_pk_add_bf16 v7, v89 offset:65412
    s_mov_b64 exec, s[54:55]
    s_branch L2_d139
L2_c140:
    s_lshl_b64 s[52:53], s[82:83], 1
    s_andn2_b64 s[52:53], s[52:53], s[80:81]
    s_andn2_b64 s[52:53], s[52:53], s[50:51]
    s_or_b64 s[80:81], s[80:81], s[52:53]
    s_not_b64 vcc, s[52:53]
    s_mov_b64 exec, -1
    v_cndmask_b32_dpp v84, v84, v84, vcc wave_shr:1 row_mask:0xf bank_mask:0xf
    v_cndmask_b32_dpp v85, v85, v85, vcc wave_shr:1 row_mask:0xf bank_mask:0xf
    s_lshr_b64 s[52:53], s[52:53], 1
    v_cndmask_b32_dpp v86, v86, v86, vcc wave_shr:1 row_mask:0xf bank_mask:0xf
    v_cndmask_b32_dpp v87, v87, v87, vcc wave_shr:1 row_mask:0xf bank_mask:0xf
    s_andn2_b64 s[82:83], s[82:83], s[52:53]
    v_cndmask_b32_dpp v7, v7, v7, vcc wave_shr:1 row_mask:0xf bank_mask:0xf
    s_mov_b64 exec, s[50:51]
    s_cbranch_scc0 L2_d140
    s_mov_b64 exec, s[82:83]
    s_nop 1
    v_mfma_f32_4x4x4_16b_bf16 v[88:91], v[12:13], v[84:85], 0
    s_nop 1
    v_mfma_f32_4x4x4_16b_bf16 v[88:91], v[10:11], v[86:87], v[88:91]
    s_nop 4
    v_cvt_pk_bf16_f32 v88, v88, v89
    v_cvt_pk_bf16_f32 v89, v90, v91
    ds_pk_add_bf16 v7, v88 offset:65408
    ds_pk_add_bf16 v7, v89 offset:65412
    s_mov_b64 exec, s[50:51]
    s_branch L2_d140
L2_oa141:
    s_waitcnt vmcnt(0)
    s_mov_b64 exec, s[6:7]
    v_lshrrev_b32 v114, 16, v114
    s_mov_b64 exec, -1
    v_and_b32 v46, 0x10000000, v33
    v_cmpx_eq_u32 vcc, 0, v46
    v_lshrrev_b32 v47, 14, v112
    v_and_b32 v47, v5, v47
    ds_read_b64 v[96:97], v47
    v_perm_b32 v98, v112, v114, s44
    v_bitop3_b32 v99, v112, 0.5, -0.5 bitop3:0xa8
    v_bitop3_b32 v98, v6, v98, v99 bitop3:0xca
    v_and_b32 v47, v5, v112
    s_waitcnt lgkmcnt(0)
    v_mfma_f32_4x4x4_16b_bf16 v[88:91], v[8:9], v[96:97], 0
    s_nop 4
    v_mul_f32 v88, v98, v88
    v_mul_f32 v89, v98, v89
    v_mul_f32 v90, v98, v90
    v_mul_f32 v91, v98, v91
    v_cvt_pk_bf16_f32 v88, v88, v89
    v_cvt_pk_bf16_f32 v89, v90, v91
    ds_pk_add_bf16 v47, v88 offset:65408
    ds_pk_add_bf16 v47, v89 offset:65412
    s_mov_b64 exec, -1
    v_and_b32 v46, 0x20000000, v33
    v_cmpx_eq_u32 vcc, 0, v46
    v_lshrrev_b32 v47, 14, v113
    v_and_b32 v47, v5, v47
    ds_read_b64 v[96:97], v47
    v_perm_b32 v98, v113, v114, s45
    v_bitop3_b32 v99, v113, 0.5, -0.5 bitop3:0xa8
    v_bitop3_b32 v98, v6, v98, v99 bitop3:0xca
    v_and_b32 v47, v5, v113
    s_waitcnt lgkmcnt(0)
    v_mfma_f32_4x4x4_16b_bf16 v[88:91], v[8:9], v[96:97], 0
    s_nop 4
    v_mul_f32 v88, v98, v88
    v_mul_f32 v89, v98, v89
    v_mul_f32 v90, v98, v90
    v_mul_f32 v91, v98, v91
    v_cvt_pk_bf16_f32 v88, v88, v89
    v_cvt_pk_bf16_f32 v89, v90, v91
    ds_pk_add_bf16 v47, v88 offset:65408
    ds_pk_add_bf16 v47, v89 offset:65412
    s_mov_b64 exec, -1
    s_branch L2_ob141
L2_c142:
    s_lshl_b64 s[52:53], s[82:83], 1
    s_andn2_b64 s[52:53], s[52:53], s[80:81]
    s_andn2_b64 s[52:53], s[52:53], s[54:55]
    s_or_b64 s[80:81], s[80:81], s[52:53]
    s_not_b64 vcc, s[52:53]
    s_mov_b64 exec, -1
    v_cndmask_b32_dpp v84, v84, v84, vcc wave_shr:1 row_mask:0xf bank_mask:0xf
    v_cndmask_b32_dpp v85, v85, v85, vcc wave_shr:1 row_mask:0xf bank_mask:0xf
    s_lshr_b64 s[52:53], s[52:53], 1
    v_cndmask_b32_dpp v86, v86, v86, vcc wave_shr:1 row_mask:0xf bank_mask:0xf
    v_cndmask_b32_dpp v87, v87, v87, vcc wave_shr:1 row_mask:0xf bank_mask:0xf
    s_andn2_b64 s[82:83], s[82:83], s[52:53]
    v_cndmask_b32_dpp v7, v7, v7, vcc wave_shr:1 row_mask:0xf bank_mask:0xf
    s_mov_b64 exec, s[54:55]
    s_cbranch_scc0 L2_d142
    s_mov_b64 exec, s[82:83]
    s_nop 1
    v_mfma_f32_4x4x4_16b_bf16 v[88:91], v[12:13], v[84:85], 0
    s_nop 1
    v_mfma_f32_4x4x4_16b_bf16 v[88:91], v[10:11], v[86:87], v[88:91]
    s_nop 4
    v_cvt_pk_bf16_f32 v88, v88, v89
    v_cvt_pk_bf16_f32 v89, v90, v91
    ds_pk_add_bf16 v7, v88 offset:65408
    ds_pk_add_bf16 v7, v89 offset:65412
    s_mov_b64 exec, s[54:55]
    s_branch L2_d142
L2_c143:
    s_lshl_b64 s[52:53], s[82:83], 1
    s_andn2_b64 s[52:53], s[52:53], s[80:81]
    s_andn2_b64 s[52:53], s[52:53], s[50:51]
    s_or_b64 s[80:81], s[80:81], s[52:53]
    s_not_b64 vcc, s[52:53]
    s_mov_b64 exec, -1
    v_cndmask_b32_dpp v84, v84, v84, vcc wave_shr:1 row_mask:0xf bank_mask:0xf
    v_cndmask_b32_dpp v85, v85, v85, vcc wave_shr:1 row_mask:0xf bank_mask:0xf
    s_lshr_b64 s[52:53], s[52:53], 1
    v_cndmask_b32_dpp v86, v86, v86, vcc wave_shr:1 row_mask:0xf bank_mask:0xf
    v_cndmask_b32_dpp v87, v87, v87, vcc wave_shr:1 row_mask:0xf bank_mask:0xf
    s_andn2_b64 s[82:83], s[82:83], s[52:53]
    v_cndmask_b32_dpp v7, v7, v7, vcc wave_shr:1 row_mask:0xf bank_mask:0xf
    s_mov_b64 exec, s[50:51]
    s_cbranch_scc0 L2_d143
    s_mov_b64 exec, s[82:83]
    s_nop 1
    v_mfma_f32_4x4x4_16b_bf16 v[88:91], v[12:13], v[84:85], 0
    s_nop 1
    v_mfma_f32_4x4x4_16b_bf16 v[88:91], v[10:11], v[86:87], v[88:91]
    s_nop 4
    v_cvt_pk_bf16_f32 v88, v88, v89
    v_cvt_pk_bf16_f32 v89, v90, v91
    ds_pk_add_bf16 v7, v88 offset:65408
    ds_pk_add_bf16 v7, v89 offset:65412
    s_mov_b64 exec, s[50:51]
    s_branch L2_d143
L2_c144:
    s_lshl_b64 s[52:53], s[82:83], 1
    s_andn2_b64 s[52:53], s[52:53], s[80:81]
    s_andn2_b64 s[52:53], s[52:53], s[54:55]
    s_or_b64 s[80:81], s[80:81], s[52:53]
    s_not_b64 vcc, s[52:53]
    s_mov_b64 exec, -1
    v_cndmask_b32_dpp v84, v84, v84, vcc wave_shr:1 row_mask:0xf bank_mask:0xf
    v_cndmask_b32_dpp v85, v85, v85, vcc wave_shr:1 row_mask:0xf bank_mask:0xf
    s_lshr_b64 s[52:53], s[52:53], 1
    v_cndmask_b32_dpp v86, v86, v86, vcc wave_shr:1 row_mask:0xf bank_mask:0xf
    v_cndmask_b32_dpp v87, v87, v87, vcc wave_shr:1 row_mask:0xf bank_mask:0xf
    s_andn2_b64 s[82:83], s[82:83], s[52:53]
    v_cndmask_b32_dpp v7, v7, v7, vcc wave_shr:1 row_mask:0xf bank_mask:0xf
    s_mov_b64 exec, s[54:55]
    s_cbranch_scc0 L2_d144
    s_mov_b64 exec, s[82:83]
    s_nop 1
    v_mfma_f32_4x4x4_16b_bf16 v[88:91], v[12:13], v[84:85], 0
    s_nop 1
    v_mfma_f32_4x4x4_16b_bf16 v[88:91], v[10:11], v[86:87], v[88:91]
    s_nop 4
    v_cvt_pk_bf16_f32 v88, v88, v89
    v_cvt_pk_bf16_f32 v89, v90, v91
    ds_pk_add_bf16 v7, v88 offset:65408
    ds_pk_add_bf16 v7, v89 offset:65412
    s_mov_b64 exec, s[54:55]
    s_branch L2_d144
L2_c145:
    s_lshl_b64 s[52:53], s[82:83], 1
    s_andn2_b64 s[52:53], s[52:53], s[80:81]
    s_andn2_b64 s[52:53], s[52:53], s[50:51]
    s_or_b64 s[80:81], s[80:81], s[52:53]
    s_not_b64 vcc, s[52:53]
    s_mov_b64 exec, -1
    v_cndmask_b32_dpp v84, v84, v84, vcc wave_shr:1 row_mask:0xf bank_mask:0xf
    v_cndmask_b32_dpp v85, v85, v85, vcc wave_shr:1 row_mask:0xf bank_mask:0xf
    s_lshr_b64 s[52:53], s[52:53], 1
    v_cndmask_b32_dpp v86, v86, v86, vcc wave_shr:1 row_mask:0xf bank_mask:0xf
    v_cndmask_b32_dpp v87, v87, v87, vcc wave_shr:1 row_mask:0xf bank_mask:0xf
    s_andn2_b64 s[82:83], s[82:83], s[52:53]
    v_cndmask_b32_dpp v7, v7, v7, vcc wave_shr:1 row_mask:0xf bank_mask:0xf
    s_mov_b64 exec, s[50:51]
    s_cbranch_scc0 L2_d145
    s_mov_b64 exec, s[82:83]
    s_nop 1
    v_mfma_f32_4x4x4_16b_bf16 v[88:91], v[12:13], v[84:85], 0
    s_nop 1
    v_mfma_f32_4x4x4_16b_bf16 v[88:91], v[10:11], v[86:87], v[88:91]
    s_nop 4
    v_cvt_pk_bf16_f32 v88, v88, v89
    v_cvt_pk_bf16_f32 v89, v90, v91
    ds_pk_add_bf16 v7, v88 offset:65408
    ds_pk_add_bf16 v7, v89 offset:65412
    s_mov_b64 exec, s[50:51]
    s_branch L2_d145
L2_c146:
    s_lshl_b64 s[52:53], s[82:83], 1
    s_andn2_b64 s[52:53], s[52:53], s[80:81]
    s_andn2_b64 s[52:53], s[52:53], s[54:55]
    s_or_b64 s[80:81], s[80:81], s[52:53]
    s_not_b64 vcc, s[52:53]
    s_mov_b64 exec, -1
    v_cndmask_b32_dpp v84, v84, v84, vcc wave_shr:1 row_mask:0xf bank_mask:0xf
    v_cndmask_b32_dpp v85, v85, v85, vcc wave_shr:1 row_mask:0xf bank_mask:0xf
    s_lshr_b64 s[52:53], s[52:53], 1
    v_cndmask_b32_dpp v86, v86, v86, vcc wave_shr:1 row_mask:0xf bank_mask:0xf
    v_cndmask_b32_dpp v87, v87, v87, vcc wave_shr:1 row_mask:0xf bank_mask:0xf
    s_andn2_b64 s[82:83], s[82:83], s[52:53]
    v_cndmask_b32_dpp v7, v7, v7, vcc wave_shr:1 row_mask:0xf bank_mask:0xf
    s_mov_b64 exec, s[54:55]
    s_cbranch_scc0 L2_d146
    s_mov_b64 exec, s[82:83]
    s_nop 1
    v_mfma_f32_4x4x4_16b_bf16 v[88:91], v[12:13], v[84:85], 0
    s_nop 1
    v_mfma_f32_4x4x4_16b_bf16 v[88:91], v[10:11], v[86:87], v[88:91]
    s_nop 4
    v_cvt_pk_bf16_f32 v88, v88, v89
    v_cvt_pk_bf16_f32 v89, v90, v91
    ds_pk_add_bf16 v7, v88 offset:65408
    ds_pk_add_bf16 v7, v89 offset:65412
    s_mov_b64 exec, s[54:55]
    s_branch L2_d146
L2_c147:
    s_lshl_b64 s[52:53], s[82:83], 1
    s_andn2_b64 s[52:53], s[52:53], s[80:81]
    s_andn2_b64 s[52:53], s[52:53], s[50:51]
    s_or_b64 s[80:81], s[80:81], s[52:53]
    s_not_b64 vcc, s[52:53]
    s_mov_b64 exec, -1
    v_cndmask_b32_dpp v84, v84, v84, vcc wave_shr:1 row_mask:0xf bank_mask:0xf
    v_cndmask_b32_dpp v85, v85, v85, vcc wave_shr:1 row_mask:0xf bank_mask:0xf
    s_lshr_b64 s[52:53], s[52:53], 1
    v_cndmask_b32_dpp v86, v86, v86, vcc wave_shr:1 row_mask:0xf bank_mask:0xf
    v_cndmask_b32_dpp v87, v87, v87, vcc wave_shr:1 row_mask:0xf bank_mask:0xf
    s_andn2_b64 s[82:83], s[82:83], s[52:53]
    v_cndmask_b32_dpp v7, v7, v7, vcc wave_shr:1 row_mask:0xf bank_mask:0xf
    s_mov_b64 exec, s[50:51]
    s_cbranch_scc0 L2_d147
    s_mov_b64 exec, s[82:83]
    s_nop 1
    v_mfma_f32_4x4x4_16b_bf16 v[88:91], v[12:13], v[84:85], 0
    s_nop 1
    v_mfma_f32_4x4x4_16b_bf16 v[88:91], v[10:11], v[86:87], v[88:91]
    s_nop 4
    v_cvt_pk_bf16_f32 v88, v88, v89
    v_cvt_pk_bf16_f32 v89, v90, v91
    ds_pk_add_bf16 v7, v88 offset:65408
    ds_pk_add_bf16 v7, v89 offset:65412
    s_mov_b64 exec, s[50:51]
    s_branch L2_d147
L2_c148:
    s_lshl_b64 s[52:53], s[82:83], 1
    s_andn2_b64 s[52:53], s[52:53], s[80:81]
    s_andn2_b64 s[52:53], s[52:53], s[54:55]
    s_or_b64 s[80:81], s[80:81], s[52:53]
    s_not_b64 vcc, s[52:53]
    s_mov_b64 exec, -1
    v_cndmask_b32_dpp v84, v84, v84, vcc wave_shr:1 row_mask:0xf bank_mask:0xf
    v_cndmask_b32_dpp v85, v85, v85, vcc wave_shr:1 row_mask:0xf bank_mask:0xf
    s_lshr_b64 s[52:53], s[52:53], 1
    v_cndmask_b32_dpp v86, v86, v86, vcc wave_shr:1 row_mask:0xf bank_mask:0xf
    v_cndmask_b32_dpp v87, v87, v87, vcc wave_shr:1 row_mask:0xf bank_mask:0xf
    s_andn2_b64 s[82:83], s[82:83], s[52:53]
    v_cndmask_b32_dpp v7, v7, v7, vcc wave_shr:1 row_mask:0xf bank_mask:0xf
    s_mov_b64 exec, s[54:55]
    s_cbranch_scc0 L2_d148
    s_mov_b64 exec, s[82:83]
    s_nop 1
    v_mfma_f32_4x4x4_16b_bf16 v[88:91], v[12:13], v[84:85], 0
    s_nop 1
    v_mfma_f32_4x4x4_16b_bf16 v[88:91], v[10:11], v[86:87], v[88:91]
    s_nop 4
    v_cvt_pk_bf16_f32 v88, v88, v89
    v_cvt_pk_bf16_f32 v89, v90, v91
    ds_pk_add_bf16 v7, v88 offset:65408
    ds_pk_add_bf16 v7, v89 offset:65412
    s_mov_b64 exec, s[54:55]
    s_branch L2_d148
L2_c149:
    s_lshl_b64 s[52:53], s[82:83], 1
    s_andn2_b64 s[52:53], s[52:53], s[80:81]
    s_andn2_b64 s[52:53], s[52:53], s[50:51]
    s_or_b64 s[80:81], s[80:81], s[52:53]
    s_not_b64 vcc, s[52:53]
    s_mov_b64 exec, -1
    v_cndmask_b32_dpp v84, v84, v84, vcc wave_shr:1 row_mask:0xf bank_mask:0xf
    v_cndmask_b32_dpp v85, v85, v85, vcc wave_shr:1 row_mask:0xf bank_mask:0xf
    s_lshr_b64 s[52:53], s[52:53], 1
    v_cndmask_b32_dpp v86, v86, v86, vcc wave_shr:1 row_mask:0xf bank_mask:0xf
    v_cndmask_b32_dpp v87, v87, v87, vcc wave_shr:1 row_mask:0xf bank_mask:0xf
    s_andn2_b64 s[82:83], s[82:83], s[52:53]
    v_cndmask_b32_dpp v7, v7, v7, vcc wave_shr:1 row_mask:0xf bank_mask:0xf
    s_mov_b64 exec, s[50:51]
    s_cbranch_scc0 L2_d149
    s_mov_b64 exec, s[82:83]
    s_nop 1
    v_mfma_f32_4x4x4_16b_bf16 v[88:91], v[12:13], v[84:85], 0
    s_nop 1
    v_mfma_f32_4x4x4_16b_bf16 v[88:91], v[10:11], v[86:87], v[88:91]
    s_nop 4
    v_cvt_pk_bf16_f32 v88, v88, v89
    v_cvt_pk_bf16_f32 v89, v90, v91
    ds_pk_add_bf16 v7, v88 offset:65408
    ds_pk_add_bf16 v7, v89 offset:65412
    s_mov_b64 exec, s[50:51]
    s_branch L2_d149
L2_c150:
    s_lshl_b64 s[52:53], s[82:83], 1
    s_andn2_b64 s[52:53], s[52:53], s[80:81]
    s_andn2_b64 s[52:53], s[52:53], s[54:55]
    s_or_b64 s[80:81], s[80:81], s[52:53]
    s_not_b64 vcc, s[52:53]
    s_mov_b64 exec, -1
    v_cndmask_b32_dpp v84, v84, v84, vcc wave_shr:1 row_mask:0xf bank_mask:0xf
    v_cndmask_b32_dpp v85, v85, v85, vcc wave_shr:1 row_mask:0xf bank_mask:0xf
    s_lshr_b64 s[52:53], s[52:53], 1
    v_cndmask_b32_dpp v86, v86, v86, vcc wave_shr:1 row_mask:0xf bank_mask:0xf
    v_cndmask_b32_dpp v87, v87, v87, vcc wave_shr:1 row_mask:0xf bank_mask:0xf
    s_andn2_b64 s[82:83], s[82:83], s[52:53]
    v_cndmask_b32_dpp v7, v7, v7, vcc wave_shr:1 row_mask:0xf bank_mask:0xf
    s_mov_b64 exec, s[54:55]
    s_cbranch_scc0 L2_d150
    s_mov_b64 exec, s[82:83]
    s_nop 1
    v_mfma_f32_4x4x4_16b_bf16 v[88:91], v[12:13], v[84:85], 0
    s_nop 1
    v_mfma_f32_4x4x4_16b_bf16 v[88:91], v[10:11], v[86:87], v[88:91]
    s_nop 4
    v_cvt_pk_bf16_f32 v88, v88, v89
    v_cvt_pk_bf16_f32 v89, v90, v91
    ds_pk_add_bf16 v7, v88 offset:65408
    ds_pk_add_bf16 v7, v89 offset:65412
    s_mov_b64 exec, s[54:55]
    s_branch L2_d150
L2_c151:
    s_lshl_b64 s[52:53], s[82:83], 1
    s_andn2_b64 s[52:53], s[52:53], s[80:81]
    s_andn2_b64 s[52:53], s[52:53], s[50:51]
    s_or_b64 s[80:81], s[80:81], s[52:53]
    s_not_b64 vcc, s[52:53]
    s_mov_b64 exec, -1
    v_cndmask_b32_dpp v84, v84, v84, vcc wave_shr:1 row_mask:0xf bank_mask:0xf
    v_cndmask_b32_dpp v85, v85, v85, vcc wave_shr:1 row_mask:0xf bank_mask:0xf
    s_lshr_b64 s[52:53], s[52:53], 1
    v_cndmask_b32_dpp v86, v86, v86, vcc wave_shr:1 row_mask:0xf bank_mask:0xf
    v_cndmask_b32_dpp v87, v87, v87, vcc wave_shr:1 row_mask:0xf bank_mask:0xf
    s_andn2_b64 s[82:83], s[82:83], s[52:53]
    v_cndmask_b32_dpp v7, v7, v7, vcc wave_shr:1 row_mask:0xf bank_mask:0xf
    s_mov_b64 exec, s[50:51]
    s_cbranch_scc0 L2_d151
    s_mov_b64 exec, s[82:83]
    s_nop 1
    v_mfma_f32_4x4x4_16b_bf16 v[88:91], v[12:13], v[84:85], 0
    s_nop 1
    v_mfma_f32_4x4x4_16b_bf16 v[88:91], v[10:11], v[86:87], v[88:91]
    s_nop 4
    v_cvt_pk_bf16_f32 v88, v88, v89
    v_cvt_pk_bf16_f32 v89, v90, v91
    ds_pk_add_bf16 v7, v88 offset:65408
    ds_pk_add_bf16 v7, v89 offset:65412
    s_mov_b64 exec, s[50:51]
    s_branch L2_d151
L2_c152:
    s_mov_b64 s[50:51], vcc
    s_lshl_b64 s[52:53], s[82:83], 1
    s_andn2_b64 s[52:53], s[52:53], s[80:81]
    s_andn2_b64 s[52:53], s[52:53], s[50:51]
    s_or_b64 s[80:81], s[80:81], s[52:53]
    s_not_b64 vcc, s[52:53]
    s_mov_b64 exec, -1
    v_cndmask_b32_dpp v84, v84, v84, vcc wave_shr:1 row_mask:0xf bank_mask:0xf
    v_cndmask_b32_dpp v85, v85, v85, vcc wave_shr:1 row_mask:0xf bank_mask:0xf
    s_lshr_b64 s[52:53], s[52:53], 1
    v_cndmask_b32_dpp v86, v86, v86, vcc wave_shr:1 row_mask:0xf bank_mask:0xf
    v_cndmask_b32_dpp v87, v87, v87, vcc wave_shr:1 row_mask:0xf bank_mask:0xf
    s_andn2_b64 s[82:83], s[82:83], s[52:53]
    v_cndmask_b32_dpp v7, v7, v7, vcc wave_shr:1 row_mask:0xf bank_mask:0xf
    s_mov_b64 vcc, s[50:51]
    s_mov_b64 exec, s[50:51]
    s_cbranch_scc0 L2_d152
    s_mov_b64 exec, s[82:83]
    s_nop 1
    v_mfma_f32_4x4x4_16b_bf16 v[88:91], v[12:13], v[84:85], 0
    s_nop 1
    v_mfma_f32_4x4x4_16b_bf16 v[88:91], v[10:11], v[86:87], v[88:91]
    s_nop 4
    v_cvt_pk_bf16_f32 v88, v88, v89
    v_cvt_pk_bf16_f32 v89, v90, v91
    ds_pk_add_bf16 v7, v88 offset:65408
    ds_pk_add_bf16 v7, v89 offset:65412
    s_mov_b64 exec, vcc
    s_branch L2_d152
L2_c153:
    s_mov_b64 s[50:51], vcc
    s_lshl_b64 s[52:53], s[82:83], 1
    s_andn2_b64 s[52:53], s[52:53], s[80:81]
    s_andn2_b64 s[52:53], s[52:53], s[50:51]
    s_or_b64 s[80:81], s[80:81], s[52:53]
    s_not_b64 vcc, s[52:53]
    s_mov_b64 exec, -1
    v_cndmask_b32_dpp v84, v84, v84, vcc wave_shr:1 row_mask:0xf bank_mask:0xf
    v_cndmask_b32_dpp v85, v85, v85, vcc wave_shr:1 row_mask:0xf bank_mask:0xf
    s_lshr_b64 s[52:53], s[52:53], 1
    v_cndmask_b32_dpp v86, v86, v86, vcc wave_shr:1 row_mask:0xf bank_mask:0xf
    v_cndmask_b32_dpp v87, v87, v87, vcc wave_shr:1 row_mask:0xf bank_mask:0xf
    s_andn2_b64 s[82:83], s[82:83], s[52:53]
    v_cndmask_b32_dpp v7, v7, v7, vcc wave_shr:1 row_mask:0xf bank_mask:0xf
    s_mov_b64 vcc, s[50:51]
    s_mov_b64 exec, s[50:51]
    s_cbranch_scc0 L2_d153
    s_mov_b64 exec, s[82:83]
    s_nop 1
    v_mfma_f32_4x4x4_16b_bf16 v[88:91], v[12:13], v[84:85], 0
    s_nop 1
    v_mfma_f32_4x4x4_16b_bf16 v[88:91], v[10:11], v[86:87], v[88:91]
    s_nop 4
    v_cvt_pk_bf16_f32 v88, v88, v89
    v_cvt_pk_bf16_f32 v89, v90, v91
    ds_pk_add_bf16 v7, v88 offset:65408
    ds_pk_add_bf16 v7, v89 offset:65412
    s_mov_b64 exec, vcc
    s_branch L2_d153
L2_f3s:
    s_branch L2_f3
.section .rodata,"a"
.p2align 6
.amdhsa_kernel gather_scatter__molecular_angular_gemnet__graph_kernel
  .amdhsa_next_free_vgpr 128
  .amdhsa_next_free_sgpr 102
  .amdhsa_accum_offset 128
  .amdhsa_group_segment_fixed_size 0
  .amdhsa_kernarg_size 112
  .amdhsa_user_sgpr_count 2
  .amdhsa_user_sgpr_kernarg_segment_ptr 1
  .amdhsa_system_sgpr_workgroup_id_x 1
  .amdhsa_float_denorm_mode_32 3
.end_amdhsa_kernel
```

```asm
; @launch grid=(256,1,1) block=(1024,1,1) lds=163840
.amdgcn_target "amdgcn-amd-amdhsa--gfx950"
.text
.globl gather_scatter__molecular_angular_gemnet__graph_kernel
.p2align 8
.type gather_scatter__molecular_angular_gemnet__graph_kernel,@function
gather_scatter__molecular_angular_gemnet__graph_kernel:
    s_cmp_ge_u32 s2, 256
    s_cbranch_scc0 L1_go
    s_endpgm
L1_go:
    s_load_dwordx2 s[8:9], s[0:1], 8
    s_load_dwordx2 s[12:13], s[0:1], 16
    s_load_dwordx2 s[16:17], s[0:1], 32
    s_load_dwordx2 s[30:31], s[0:1], 104
    s_load_dwordx2 s[56:57], s[0:1], 96
    s_load_dwordx2 s[86:87], s[0:1], 0
    s_load_dwordx4 s[60:63], s[0:1], 56
    s_load_dwordx4 s[64:67], s[0:1], 72
    v_lshrrev_b32 v7, 6, v0
    v_lshlrev_b32 v1, 3, v0
    v_readfirstlane_b32 s32, v7
    v_lshlrev_b32 v0, 4, v0
    v_and_b32 v1, 0x1f8, v1
    s_lshr_b32 s3, s32, 1
    s_and_b32 s44, s32, 1
    s_lshl_b32 s44, s44, 3
    s_or_b32 s3, s3, s44
    s_lshl_b32 s3, s3, 10
    s_lshl_b32 s96, s2, 14
    s_add_u32 s96, s96, s3
    s_mov_b32 s10, 0x9c40000
    s_mov_b32 s11, 0x20000
    s_mov_b32 s14, 0x9c40000
    s_mov_b32 s15, 0x20000
    s_mov_b32 s18, 0x4e20000
    s_mov_b32 s19, 0x20000
    s_waitcnt lgkmcnt(0)
    s_add_u32 s44, s96, 0x0
    v_lshlrev_b32 v16, 1, v1
    buffer_load_dwordx4 v[16:19], v16, s[8:11], s44 offen nt
    s_add_u32 s45, s96, 0x0
    v_lshlrev_b32 v20, 1, v1
    buffer_load_dwordx4 v[20:23], v20, s[12:15], s45 offen nt
    s_add_u32 s46, s96, 0x0
    s_lshr_b32 s46, s46, 1
    buffer_load_dwordx2 v[24:25], v1, s[16:19], s46 offen nt
    s_add_u32 s47, s96, 0x400000
    s_lshr_b32 s47, s47, 1
    buffer_load_dwordx2 v[26:27], v1, s[16:19], s47 offen nt
    s_add_u32 s44, s96, 0x400000
    v_lshlrev_b32 v28, 1, v1
    buffer_load_dwordx4 v[28:31], v28, s[8:11], s44 offen nt
    s_add_u32 s45, s96, 0x400000
    v_lshlrev_b32 v32, 1, v1
    buffer_load_dwordx4 v[32:35], v32, s[12:15], s45 offen nt
    s_add_u32 s46, s96, 0x800000
    v_lshlrev_b32 v36, 1, v1
    buffer_load_dwordx4 v[36:39], v36, s[8:11], s46 offen nt
    s_add_u32 s47, s96, 0x800000
    v_lshlrev_b32 v40, 1, v1
    buffer_load_dwordx4 v[40:43], v40, s[12:15], s47 offen nt
    s_add_u32 s44, s96, 0x800000
    s_lshr_b32 s44, s44, 1
    buffer_load_dwordx2 v[44:45], v1, s[16:19], s44 offen nt
    s_add_u32 s45, s96, 0xc00000
    s_lshr_b32 s45, s45, 1
    buffer_load_dwordx2 v[46:47], v1, s[16:19], s45 offen nt
    s_mov_b32 s68, s62
    s_mov_b32 s69, s63
    s_mov_b32 s70, 0x40
    s_mov_b32 s71, 0x20000
    s_mov_b32 s72, s60
    s_mov_b32 s73, s61
    s_mov_b32 s74, 0x40
    s_mov_b32 s75, 0x20000
    s_mov_b32 s20, s66
    s_mov_b32 s21, s67
    s_mov_b32 s22, 0x20
    s_mov_b32 s23, 0x20000
    s_mov_b32 s80, s64
    s_mov_b32 s81, s65
    s_mov_b32 s82, 0x20
    s_mov_b32 s83, 0x20000
    s_add_u32 s24, s30, 0xec54000
    s_addc_u32 s25, s31, 0
    s_mov_b32 s26, 0x100
    s_mov_b32 s27, 0x20000
    v_lshrrev_b32 v2, 3, v0
    v_and_b32 v2, 6, v2
    v_lshlrev_b32 v3, 2, v0
    s_lshl_b32 s3, s32, 8
    s_add_u32 s3, s3, s2
    s_cmp_lg_u32 s3, 254
    s_cbranch_scc1 L1_wt
    buffer_load_ushort v116, v2, s[68:71], 0 offen offset:0
    buffer_load_ushort v108, v2, s[68:71], 0 offen offset:8
    buffer_load_ushort v117, v2, s[68:71], 0 offen offset:16
    buffer_load_ushort v109, v2, s[68:71], 0 offen offset:24
    buffer_load_ushort v118, v2, s[68:71], 0 offen offset:32
    buffer_load_ushort v110, v2, s[68:71], 0 offen offset:40
    buffer_load_ushort v119, v2, s[68:71], 0 offen offset:48
    buffer_load_ushort v111, v2, s[68:71], 0 offen offset:56
    buffer_load_ushort v120, v2, s[72:75], 0 offen offset:0
    buffer_load_ushort v100, v2, s[72:75], 0 offen offset:8
    buffer_load_ushort v121, v2, s[72:75], 0 offen offset:16
    buffer_load_ushort v101, v2, s[72:75], 0 offen offset:24
    buffer_load_ushort v122, v2, s[72:75], 0 offen offset:32
    buffer_load_ushort v102, v2, s[72:75], 0 offen offset:40
    buffer_load_ushort v123, v2, s[72:75], 0 offen offset:48
    buffer_load_ushort v103, v2, s[72:75], 0 offen offset:56
    buffer_load_ushort v124, v2, s[20:23], 0 offen offset:0
    buffer_load_ushort v112, v2, s[20:23], 0 offen offset:8
    buffer_load_ushort v125, v2, s[20:23], 0 offen offset:16
    buffer_load_ushort v113, v2, s[20:23], 0 offen offset:24
    buffer_load_ushort v126, v2, s[80:83], 0 offen offset:0
    buffer_load_ushort v114, v2, s[80:83], 0 offen offset:8
    buffer_load_ushort v127, v2, s[80:83], 0 offen offset:16
    buffer_load_ushort v115, v2, s[80:83], 0 offen offset:24
    s_waitcnt vmcnt(0)
    v_lshl_or_b32 v116, v108, 16, v116
    v_lshl_or_b32 v117, v109, 16, v117
    v_lshl_or_b32 v118, v110, 16, v118
    v_lshl_or_b32 v119, v111, 16, v119
    v_lshl_or_b32 v120, v100, 16, v120
    v_lshl_or_b32 v121, v101, 16, v121
    v_lshl_or_b32 v122, v102, 16, v122
    v_lshl_or_b32 v123, v103, 16, v123
    v_lshl_or_b32 v124, v112, 16, v124
    v_lshl_or_b32 v125, v113, 16, v125
    v_lshl_or_b32 v126, v114, 16, v126
    v_lshl_or_b32 v127, v115, 16, v127
    buffer_store_dwordx4 v[116:119], v3, s[24:27], 0 offen offset:0 sc1
    buffer_store_dwordx4 v[120:123], v3, s[24:27], 0 offen offset:16 sc1
    buffer_store_dwordx4 v[124:127], v3, s[24:27], 0 offen offset:32 sc1
L1_wt:
    s_mov_b32 s20, s30
    s_mov_b32 s21, s31
    s_mov_b32 s22, 0xd344000
    s_mov_b32 s23, 0x20000
    s_add_u32 s24, s30, 0x2c000
    s_addc_u32 s25, s31, 0
    s_mov_b32 s26, 0xd318000
    s_mov_b32 s27, 0x20000
    s_add_u32 s3, s32, 0
    s_mul_i32 s4, s3, 205
    s_lshr_b32 s4, s4, 10
    s_mul_i32 s5, s4, 5
    s_sub_u32 s5, s3, s5
    s_lshl_b32 s5, s5, 5
    s_add_u32 s4, s4, s5
    s_sub_u32 s4, s4, s32
    s_lshl_b32 s72, s4, 10
    s_add_u32 s3, s32, 16
    s_mul_i32 s4, s3, 205
    s_lshr_b32 s4, s4, 10
    s_mul_i32 s5, s4, 5
    s_sub_u32 s5, s3, s5
    s_lshl_b32 s5, s5, 5
    s_add_u32 s4, s4, s5
    s_sub_u32 s4, s4, s32
    s_lshl_b32 s73, s4, 10
    s_add_u32 s3, s32, 32
    s_mul_i32 s4, s3, 205
    s_lshr_b32 s4, s4, 10
    s_mul_i32 s5, s4, 5
    s_sub_u32 s5, s3, s5
    s_lshl_b32 s5, s5, 5
    s_add_u32 s4, s4, s5
    s_sub_u32 s4, s4, s32
    s_lshl_b32 s85, s4, 10
    s_add_u32 s3, s32, 48
    s_mul_i32 s4, s3, 205
    s_lshr_b32 s4, s4, 10
    s_mul_i32 s5, s4, 5
    s_sub_u32 s5, s3, s5
    s_lshl_b32 s5, s5, 5
    s_add_u32 s4, s4, s5
    s_sub_u32 s4, s4, s32
    s_lshl_b32 s91, s4, 10
    s_add_u32 s3, s32, 64
    s_mul_i32 s4, s3, 205
    s_lshr_b32 s4, s4, 10
    s_mul_i32 s5, s4, 5
    s_sub_u32 s5, s3, s5
    s_lshl_b32 s5, s5, 5
    s_add_u32 s4, s4, s5
    s_sub_u32 s4, s4, s32
    s_lshl_b32 s93, s4, 10
    s_mov_b32 s80, s86
    s_mov_b32 s81, s87
    s_mov_b32 s82, 0x4e2000
    s_mov_b32 s83, 0x20000
    s_mul_i32 s35, s2, 173056
    s_and_b32 s37, s32, 3
    s_lshl_b32 s37, s37, 3
    s_mov_b32 s36, s37
    s_lshr_b32 s37, s32, 2
    s_mul_i32 s37, s37, 2080
    s_add_u32 s36, s36, s37
    s_and_b32 s37, s2, 3
    s_lshl_b32 s37, s37, 5
    s_add_u32 s36, s36, s37
    s_mul_i32 s4, s2, 5
    s_add_u32 s4, s4, 8192
    s_lshl_b32 s38, s4, 14
    s_lshl_b32 s39, s4, 13
    v_mov_b32 v2, 1
    v_mov_b32 v4, 0x80000007
    v_mov_b32 v5, 0xfc
    v_mov_b32 v6, 0x78
    s_mov_b32 s40, 16512
    s_mov_b32 s55, -10000
    s_mov_b32 s41, 0x010c0c01
    s_mov_b32 s42, 0x030c0c03
    v_mov_b32 v8, 0
    v_mov_b32 v9, 0
    v_mov_b32 v10, 0
    v_mov_b32 v11, 0
    ds_write_b128 v0, v[8:11]
    s_add_u32 s60, s30, 0xec5d000
    s_addc_u32 s61, s31, 0
    s_mov_b32 s62, 0x8000
    s_mov_b32 s63, 0x20000
    s_mov_b64 s[66:67], s[56:57]
    s_lshl_b32 s57, s2, 7
    s_add_u32 s68, s30, 0xec55000
    s_addc_u32 s69, s31, 0
    s_mov_b32 s70, 0x80
    s_mov_b32 s71, 0x20000
    s_lshl_b32 s3, s2, 7
    s_add_u32 s68, s68, s3
    s_addc_u32 s69, s69, 0
    s_cmp_lg_u32 s32, 0
    s_cbranch_scc1 L1_fl
    buffer_store_dwordx4 v[8:11], v0, s[68:71], 0 offen sc1
    s_mov_b64 exec, 0xff
    buffer_store_dwordx4 v[8:11], v0, s[60:63], s57 offen sc1
    s_mov_b64 exec, -1
L1_fl:
    s_waitcnt lgkmcnt(0)
    s_barrier
    s_setprio 3
    s_add_u32 s46, s96, 0xc00000
    v_lshlrev_b32 v48, 1, v1
    buffer_load_dwordx4 v[48:51], v48, s[8:11], s46 offen nt
    s_add_u32 s47, s96, 0xc00000
    v_lshlrev_b32 v52, 1, v1
    buffer_load_dwordx4 v[52:55], v52, s[12:15], s47 offen nt
    s_waitcnt vmcnt(8)
    v_lshlrev_b32 v7, 16, v24
    v_and_b32 v8, 0xffff0000, v24
    v_lshlrev_b32 v9, 16, v25
    v_and_b32 v10, 0xffff0000, v25
    v_mul_f32 v7, 0.15915494, v7
    v_mul_f32 v8, 0.15915494, v8
    v_mul_f32 v9, 0.15915494, v9
    v_mul_f32 v10, 0.15915494, v10
    v_mul_hi_u32_u24 v14, 429497, v16
    v_lshrrev_b32 v12, 3, v20
    v_cos_f32 v7, v7
    v_lshlrev_b16 v13, 3, v20
    v_mad_i32_i24 v11, v14, s55, v16
    v_bitop3_b32 v12, v6, v13, v12 bitop3:0xca
    v_lshl_add_u32 v11, v11, 17, s40
    v_lshlrev_b16 v14, 8, v14
    v_lshrrev_b32 v13, 2, v20
    v_add_u32 v16, v12, v11
    v_bitop3_b32 v20, v5, v13, v14 bitop3:0xea
    ds_add_u32 v20, v2
    v_mul_hi_u32_u24 v14, 429497, v17
    v_lshrrev_b32 v12, 3, v21
    v_cos_f32 v8, v8
    v_lshlrev_b16 v13, 3, v21
    v_mad_i32_i24 v11, v14, s55, v17
    v_bitop3_b32 v12, v6, v13, v12 bitop3:0xca
    v_lshl_add_u32 v11, v11, 17, s40
    v_lshlrev_b16 v14, 8, v14
    v_lshrrev_b32 v13, 2, v21
    v_add_u32 v17, v12, v11
    v_bitop3_b32 v21, v5, v13, v14 bitop3:0xea
    ds_add_u32 v21, v2
    v_cvt_pk_bf16_f32 v24, v7, v8
    v_perm_b32 v12, v24, v24, s41
    v_bitop3_b32 v16, v4, v12, v16 bitop3:0xca
    v_perm_b32 v13, v24, v24, s42
    v_bitop3_b32 v17, v4, v13, v17 bitop3:0xca
    v_mul_hi_u32_u24 v14, 429497, v18
    v_lshrrev_b32 v12, 3, v22
    v_cos_f32 v9, v9
    v_lshlrev_b16 v13, 3, v22
    v_mad_i32_i24 v11, v14, s55, v18
    v_bitop3_b32 v12, v6, v13, v12 bitop3:0xca
    v_lshl_add_u32 v11, v11, 17, s40
    v_lshlrev_b16 v14, 8, v14
    v_lshrrev_b32 v13, 2, v22
    v_add_u32 v18, v12, v11
    v_bitop3_b32 v22, v5, v13, v14 bitop3:0xea
    ds_add_u32 v22, v2
    v_mul_hi_u32_u24 v14, 429497, v19
    v_lshrrev_b32 v12, 3, v23
    v_cos_f32 v10, v10
    v_lshlrev_b16 v13, 3, v23
    v_mad_i32_i24 v11, v14, s55, v19
    v_bitop3_b32 v12, v6, v13, v12 bitop3:0xca
    v_lshl_add_u32 v11, v11, 17, s40
    v_lshlrev_b16 v14, 8, v14
    v_lshrrev_b32 v13, 2, v23
    v_add_u32 v19, v12, v11
    v_bitop3_b32 v23, v5, v13, v14 bitop3:0xea
    ds_add_u32 v23, v2
    v_cvt_pk_bf16_f32 v25, v9, v10
    v_perm_b32 v12, v25, v25, s41
    v_bitop3_b32 v18, v4, v12, v18 bitop3:0xca
    v_perm_b32 v13, v25, v25, s42
    v_bitop3_b32 v19, v4, v13, v19 bitop3:0xca
    s_add_u32 s44, s96, 0x1000000
    v_lshlrev_b32 v56, 1, v1
    buffer_load_dwordx4 v[56:59], v56, s[8:11], s44 offen nt
    s_add_u32 s45, s96, 0x1000000
    v_lshlrev_b32 v60, 1, v1
    buffer_load_dwordx4 v[60:63], v60, s[12:15], s45 offen nt
    s_add_u32 s46, s96, 0x1000000
    s_lshr_b32 s46, s46, 1
    buffer_load_dwordx2 v[64:65], v1, s[16:19], s46 offen nt
    s_add_u32 s47, s96, 0x1400000
    s_lshr_b32 s47, s47, 1
    buffer_load_dwordx2 v[66:67], v1, s[16:19], s47 offen nt
    s_waitcnt vmcnt(10)
    v_lshlrev_b32 v7, 16, v26
    v_and_b32 v8, 0xffff0000, v26
    v_lshlrev_b32 v9, 16, v27
    v_and_b32 v10, 0xffff0000, v27
    v_mul_f32 v7, 0.15915494, v7
    v_mul_f32 v8, 0.15915494, v8
    v_mul_f32 v9, 0.15915494, v9
    v_mul_f32 v10, 0.15915494, v10
    v_mul_hi_u32_u24 v14, 429497, v28
    v_lshrrev_b32 v12, 3, v32
    v_cos_f32 v7, v7
    v_lshlrev_b16 v13, 3, v32
    v_mad_i32_i24 v11, v14, s55, v28
    v_bitop3_b32 v12, v6, v13, v12 bitop3:0xca
    v_lshl_add_u32 v11, v11, 17, s40
    v_lshlrev_b16 v14, 8, v14
    v_lshrrev_b32 v13, 2, v32
    v_add_u32 v28, v12, v11
    v_bitop3_b32 v32, v5, v13, v14 bitop3:0xea
    ds_add_u32 v32, v2
    v_mul_hi_u32_u24 v14, 429497, v29
    v_lshrrev_b32 v12, 3, v33
    v_cos_f32 v8, v8
    v_lshlrev_b16 v13, 3, v33
    v_mad_i32_i24 v11, v14, s55, v29
    v_bitop3_b32 v12, v6, v13, v12 bitop3:0xca
    v_lshl_add_u32 v11, v11, 17, s40
    v_lshlrev_b16 v14, 8, v14
    v_lshrrev_b32 v13, 2, v33
    v_add_u32 v29, v12, v11
    v_bitop3_b32 v33, v5, v13, v14 bitop3:0xea
    ds_add_u32 v33, v2
    v_cvt_pk_bf16_f32 v26, v7, v8
    v_perm_b32 v12, v26, v26, s41
    v_bitop3_b32 v28, v4, v12, v28 bitop3:0xca
    v_perm_b32 v13, v26, v26, s42
    v_bitop3_b32 v29, v4, v13, v29 bitop3:0xca
    v_mul_hi_u32_u24 v14, 429497, v30
    v_lshrrev_b32 v12, 3, v34
    v_cos_f32 v9, v9
    v_lshlrev_b16 v13, 3, v34
    v_mad_i32_i24 v11, v14, s55, v30
    v_bitop3_b32 v12, v6, v13, v12 bitop3:0xca
    v_lshl_add_u32 v11, v11, 17, s40
    v_lshlrev_b16 v14, 8, v14
    v_lshrrev_b32 v13, 2, v34
    v_add_u32 v30, v12, v11
    v_bitop3_b32 v34, v5, v13, v14 bitop3:0xea
    ds_add_u32 v34, v2
    v_mul_hi_u32_u24 v14, 429497, v31
    v_lshrrev_b32 v12, 3, v35
    v_cos_f32 v10, v10
    v_lshlrev_b16 v13, 3, v35
    v_mad_i32_i24 v11, v14, s55, v31
    v_bitop3_b32 v12, v6, v13, v12 bitop3:0xca
    v_lshl_add_u32 v11, v11, 17, s40
    v_lshlrev_b16 v14, 8, v14
    v_lshrrev_b32 v13, 2, v35
    v_add_u32 v31, v12, v11
    v_bitop3_b32 v35, v5, v13, v14 bitop3:0xea
    ds_add_u32 v35, v2
    v_cvt_pk_bf16_f32 v27, v9, v10
    v_perm_b32 v12, v27, v27, s41
    v_bitop3_b32 v30, v4, v12, v30 bitop3:0xca
    v_perm_b32 v13, v27, v27, s42
    v_bitop3_b32 v31, v4, v13, v31 bitop3:0xca
    s_setprio 2
    s_add_u32 s44, s96, 0x1400000
    v_lshlrev_b32 v68, 1, v1
    buffer_load_dwordx4 v[68:71], v68, s[8:11], s44 offen nt
    s_add_u32 s45, s96, 0x1400000
    v_lshlrev_b32 v72, 1, v1
    buffer_load_dwordx4 v[72:75], v72, s[12:15], s45 offen nt
    s_waitcnt vmcnt(8)
    v_lshlrev_b32 v7, 16, v44
    v_and_b32 v8, 0xffff0000, v44
    v_lshlrev_b32 v9, 16, v45
    v_and_b32 v10, 0xffff0000, v45
    v_mul_f32 v7, 0.15915494, v7
    v_mul_f32 v8, 0.15915494, v8
    v_mul_f32 v9, 0.15915494, v9
    v_mul_f32 v10, 0.15915494, v10
    v_mul_hi_u32_u24 v14, 429497, v36
    v_lshrrev_b32 v12, 3, v40
    v_cos_f32 v7, v7
    v_lshlrev_b16 v13, 3, v40
    v_mad_i32_i24 v11, v14, s55, v36
    v_bitop3_b32 v12, v6, v13, v12 bitop3:0xca
    v_lshl_add_u32 v11, v11, 17, s40
    v_lshlrev_b16 v14, 8, v14
    v_lshrrev_b32 v13, 2, v40
    v_add_u32 v36, v12, v11
    v_bitop3_b32 v40, v5, v13, v14 bitop3:0xea
    ds_add_u32 v40, v2
    v_mul_hi_u32_u24 v14, 429497, v37
    v_lshrrev_b32 v12, 3, v41
    v_cos_f32 v8, v8
    v_lshlrev_b16 v13, 3, v41
    v_mad_i32_i24 v11, v14, s55, v37
    v_bitop3_b32 v12, v6, v13, v12 bitop3:0xca
    v_lshl_add_u32 v11, v11, 17, s40
    v_lshlrev_b16 v14, 8, v14
    v_lshrrev_b32 v13, 2, v41
    v_add_u32 v37, v12, v11
    v_bitop3_b32 v41, v5, v13, v14 bitop3:0xea
    ds_add_u32 v41, v2
    v_cvt_pk_bf16_f32 v44, v7, v8
    v_perm_b32 v12, v44, v44, s41
    v_bitop3_b32 v36, v4, v12, v36 bitop3:0xca
    v_perm_b32 v13, v44, v44, s42
    v_bitop3_b32 v37, v4, v13, v37 bitop3:0xca
    v_mul_hi_u32_u24 v14, 429497, v38
    v_lshrrev_b32 v12, 3, v42
    v_cos_f32 v9, v9
    v_lshlrev_b16 v13, 3, v42
    v_mad_i32_i24 v11, v14, s55, v38
    v_bitop3_b32 v12, v6, v13, v12 bitop3:0xca
    v_lshl_add_u32 v11, v11, 17, s40
    v_lshlrev_b16 v14, 8, v14
    v_lshrrev_b32 v13, 2, v42
    v_add_u32 v38, v12, v11
    v_bitop3_b32 v42, v5, v13, v14 bitop3:0xea
    ds_add_u32 v42, v2
    v_mul_hi_u32_u24 v14, 429497, v39
    v_lshrrev_b32 v12, 3, v43
    v_cos_f32 v10, v10
    v_lshlrev_b16 v13, 3, v43
    v_mad_i32_i24 v11, v14, s55, v39
    v_bitop3_b32 v12, v6, v13, v12 bitop3:0xca
    v_lshl_add_u32 v11, v11, 17, s40
    v_lshlrev_b16 v14, 8, v14
    v_lshrrev_b32 v13, 2, v43
    v_add_u32 v39, v12, v11
    v_bitop3_b32 v43, v5, v13, v14 bitop3:0xea
    ds_add_u32 v43, v2
    v_cvt_pk_bf16_f32 v45, v9, v10
    v_perm_b32 v12, v45, v45, s41
    v_bitop3_b32 v38, v4, v12, v38 bitop3:0xca
    v_perm_b32 v13, v45, v45, s42
    v_bitop3_b32 v39, v4, v13, v39 bitop3:0xca
    s_add_u32 s46, s96, 0x1800000
    v_lshlrev_b32 v76, 1, v1
    buffer_load_dwordx4 v[76:79], v76, s[8:11], s46 offen nt
    s_add_u32 s47, s96, 0x1800000
    v_lshlrev_b32 v80, 1, v1
    buffer_load_dwordx4 v[80:83], v80, s[12:15], s47 offen nt
    s_add_u32 s44, s96, 0x1800000
    s_lshr_b32 s44, s44, 1
    buffer_load_dwordx2 v[84:85], v1, s[16:19], s44 offen nt
    s_add_u32 s45, s96, 0x1c00000
    s_lshr_b32 s45, s45, 1
    buffer_load_dwordx2 v[86:87], v1, s[16:19], s45 offen nt
    s_waitcnt vmcnt(10)
    v_lshlrev_b32 v7, 16, v46
    v_and_b32 v8, 0xffff0000, v46
    v_lshlrev_b32 v9, 16, v47
    v_and_b32 v10, 0xffff0000, v47
    v_mul_f32 v7, 0.15915494, v7
    v_mul_f32 v8, 0.15915494, v8
    v_mul_f32 v9, 0.15915494, v9
    v_mul_f32 v10, 0.15915494, v10
    v_mul_hi_u32_u24 v14, 429497, v48
    v_lshrrev_b32 v12, 3, v52
    v_cos_f32 v7, v7
    v_lshlrev_b16 v13, 3, v52
    v_mad_i32_i24 v11, v14, s55, v48
    v_bitop3_b32 v12, v6, v13, v12 bitop3:0xca
    v_lshl_add_u32 v11, v11, 17, s40
    v_lshlrev_b16 v14, 8, v14
    v_lshrrev_b32 v13, 2, v52
    v_add_u32 v48, v12, v11
    v_bitop3_b32 v52, v5, v13, v14 bitop3:0xea
    ds_add_u32 v52, v2
    v_mul_hi_u32_u24 v14, 429497, v49
    v_lshrrev_b32 v12, 3, v53
    v_cos_f32 v8, v8
    v_lshlrev_b16 v13, 3, v53
    v_mad_i32_i24 v11, v14, s55, v49
    v_bitop3_b32 v12, v6, v13, v12 bitop3:0xca
    v_lshl_add_u32 v11, v11, 17, s40
    v_lshlrev_b16 v14, 8, v14
    v_lshrrev_b32 v13, 2, v53
    v_add_u32 v49, v12, v11
    v_bitop3_b32 v53, v5, v13, v14 bitop3:0xea
    ds_add_u32 v53, v2
    v_cvt_pk_bf16_f32 v46, v7, v8
    v_perm_b32 v12, v46, v46, s41
    v_bitop3_b32 v48, v4, v12, v48 bitop3:0xca
    v_perm_b32 v13, v46, v46, s42
    v_bitop3_b32 v49, v4, v13, v49 bitop3:0xca
    v_mul_hi_u32_u24 v14, 429497, v50
    v_lshrrev_b32 v12, 3, v54
    v_cos_f32 v9, v9
    v_lshlrev_b16 v13, 3, v54
    v_mad_i32_i24 v11, v14, s55, v50
    v_bitop3_b32 v12, v6, v13, v12 bitop3:0xca
    v_lshl_add_u32 v11, v11, 17, s40
    v_lshlrev_b16 v14, 8, v14
    v_lshrrev_b32 v13, 2, v54
    v_add_u32 v50, v12, v11
    v_bitop3_b32 v54, v5, v13, v14 bitop3:0xea
    ds_add_u32 v54, v2
    v_mul_hi_u32_u24 v14, 429497, v51
    v_lshrrev_b32 v12, 3, v55
    v_cos_f32 v10, v10
    v_lshlrev_b16 v13, 3, v55
    v_mad_i32_i24 v11, v14, s55, v51
    v_bitop3_b32 v12, v6, v13, v12 bitop3:0xca
    v_lshl_add_u32 v11, v11, 17, s40
    v_lshlrev_b16 v14, 8, v14
    v_lshrrev_b32 v13, 2, v55
    v_add_u32 v51, v12, v11
    v_bitop3_b32 v55, v5, v13, v14 bitop3:0xea
    ds_add_u32 v55, v2
    v_cvt_pk_bf16_f32 v47, v9, v10
    v_perm_b32 v12, v47, v47, s41
    v_bitop3_b32 v50, v4, v12, v50 bitop3:0xca
    v_perm_b32 v13, v47, v47, s42
    v_bitop3_b32 v51, v4, v13, v51 bitop3:0xca
    s_setprio 1
    s_add_u32 s46, s96, 0x1c00000
    v_lshlrev_b32 v88, 1, v1
    buffer_load_dwordx4 v[88:91], v88, s[8:11], s46 offen nt
    s_add_u32 s47, s96, 0x1c00000
    v_lshlrev_b32 v92, 1, v1
    buffer_load_dwordx4 v[92:95], v92, s[12:15], s47 offen nt
    s_waitcnt vmcnt(8)
    v_lshlrev_b32 v7, 16, v64
    v_and_b32 v8, 0xffff0000, v64
    v_lshlrev_b32 v9, 16, v65
    v_and_b32 v10, 0xffff0000, v65
    v_mul_f32 v7, 0.15915494, v7
    v_mul_f32 v8, 0.15915494, v8
    v_mul_f32 v9, 0.15915494, v9
    v_mul_f32 v10, 0.15915494, v10
    v_mul_hi_u32_u24 v14, 429497, v56
    v_lshrrev_b32 v12, 3, v60
    v_cos_f32 v7, v7
    v_lshlrev_b16 v13, 3, v60
    v_mad_i32_i24 v11, v14, s55, v56
    v_bitop3_b32 v12, v6, v13, v12 bitop3:0xca
    v_lshl_add_u32 v11, v11, 17, s40
    v_lshlrev_b16 v14, 8, v14
    v_lshrrev_b32 v13, 2, v60
    v_add_u32 v56, v12, v11
    v_bitop3_b32 v60, v5, v13, v14 bitop3:0xea
    ds_add_u32 v60, v2
    v_mul_hi_u32_u24 v14, 429497, v57
    v_lshrrev_b32 v12, 3, v61
    v_cos_f32 v8, v8
    v_lshlrev_b16 v13, 3, v61
    v_mad_i32_i24 v11, v14, s55, v57
    v_bitop3_b32 v12, v6, v13, v12 bitop3:0xca
    v_lshl_add_u32 v11, v11, 17, s40
    v_lshlrev_b16 v14, 8, v14
    v_lshrrev_b32 v13, 2, v61
    v_add_u32 v57, v12, v11
    v_bitop3_b32 v61, v5, v13, v14 bitop3:0xea
    ds_add_u32 v61, v2
    v_cvt_pk_bf16_f32 v64, v7, v8
    v_perm_b32 v12, v64, v64, s41
    v_bitop3_b32 v56, v4, v12, v56 bitop3:0xca
    v_perm_b32 v13, v64, v64, s42
    v_bitop3_b32 v57, v4, v13, v57 bitop3:0xca
    v_mul_hi_u32_u24 v14, 429497, v58
    v_lshrrev_b32 v12, 3, v62
    v_cos_f32 v9, v9
    v_lshlrev_b16 v13, 3, v62
    v_mad_i32_i24 v11, v14, s55, v58
    v_bitop3_b32 v12, v6, v13, v12 bitop3:0xca
    v_lshl_add_u32 v11, v11, 17, s40
    v_lshlrev_b16 v14, 8, v14
    v_lshrrev_b32 v13, 2, v62
    v_add_u32 v58, v12, v11
    v_bitop3_b32 v62, v5, v13, v14 bitop3:0xea
    ds_add_u32 v62, v2
    v_mul_hi_u32_u24 v14, 429497, v59
    v_lshrrev_b32 v12, 3, v63
    v_cos_f32 v10, v10
    v_lshlrev_b16 v13, 3, v63
    v_mad_i32_i24 v11, v14, s55, v59
    v_bitop3_b32 v12, v6, v13, v12 bitop3:0xca
    v_lshl_add_u32 v11, v11, 17, s40
    v_lshlrev_b16 v14, 8, v14
    v_lshrrev_b32 v13, 2, v63
    v_add_u32 v59, v12, v11
    v_bitop3_b32 v63, v5, v13, v14 bitop3:0xea
    ds_add_u32 v63, v2
    v_cvt_pk_bf16_f32 v65, v9, v10
    v_perm_b32 v12, v65, v65, s41
    v_bitop3_b32 v58, v4, v12, v58 bitop3:0xca
    v_perm_b32 v13, v65, v65, s42
    v_bitop3_b32 v59, v4, v13, v59 bitop3:0xca
    s_add_u32 s44, s96, 0x2000000
    v_lshlrev_b32 v96, 1, v1
    buffer_load_dwordx4 v[96:99], v96, s[8:11], s44 offen nt
    s_add_u32 s45, s96, 0x2000000
    v_lshlrev_b32 v104, 1, v1
    buffer_load_dwordx4 v[104:107], v104, s[12:15], s45 offen nt
    s_add_u32 s46, s96, 0x2000000
    s_lshr_b32 s46, s46, 1
    buffer_load_dwordx2 v[108:109], v1, s[16:19], s46 offen nt
    s_add_u32 s47, s96, 0x2400000
    s_lshr_b32 s47, s47, 1
    buffer_load_dwordx2 v[110:111], v1, s[16:19], s47 offen nt
    s_waitcnt vmcnt(10)
    v_lshlrev_b32 v7, 16, v66
    v_and_b32 v8, 0xffff0000, v66
    v_lshlrev_b32 v9, 16, v67
    v_and_b32 v10, 0xffff0000, v67
    v_mul_f32 v7, 0.15915494, v7
    v_mul_f32 v8, 0.15915494, v8
    v_mul_f32 v9, 0.15915494, v9
    v_mul_f32 v10, 0.15915494, v10
    v_mul_hi_u32_u24 v14, 429497, v68
    v_lshrrev_b32 v12, 3, v72
    v_cos_f32 v7, v7
    v_lshlrev_b16 v13, 3, v72
    v_mad_i32_i24 v11, v14, s55, v68
    v_bitop3_b32 v12, v6, v13, v12 bitop3:0xca
    v_lshl_add_u32 v11, v11, 17, s40
    v_lshlrev_b16 v14, 8, v14
    v_lshrrev_b32 v13, 2, v72
    v_add_u32 v68, v12, v11
    v_bitop3_b32 v72, v5, v13, v14 bitop3:0xea
    ds_add_u32 v72, v2
    v_mul_hi_u32_u24 v14, 429497, v69
    v_lshrrev_b32 v12, 3, v73
    v_cos_f32 v8, v8
    v_lshlrev_b16 v13, 3, v73
    v_mad_i32_i24 v11, v14, s55, v69
    v_bitop3_b32 v12, v6, v13, v12 bitop3:0xca
    v_lshl_add_u32 v11, v11, 17, s40
    v_lshlrev_b16 v14, 8, v14
    v_lshrrev_b32 v13, 2, v73
    v_add_u32 v69, v12, v11
    v_bitop3_b32 v73, v5, v13, v14 bitop3:0xea
    ds_add_u32 v73, v2
    v_cvt_pk_bf16_f32 v66, v7, v8
    v_perm_b32 v12, v66, v66, s41
    v_bitop3_b32 v68, v4, v12, v68 bitop3:0xca
    v_perm_b32 v13, v66, v66, s42
    v_bitop3_b32 v69, v4, v13, v69 bitop3:0xca
    v_mul_hi_u32_u24 v14, 429497, v70
    v_lshrrev_b32 v12, 3, v74
    v_cos_f32 v9, v9
    v_lshlrev_b16 v13, 3, v74
    v_mad_i32_i24 v11, v14, s55, v70
    v_bitop3_b32 v12, v6, v13, v12 bitop3:0xca
    v_lshl_add_u32 v11, v11, 17, s40
    v_lshlrev_b16 v14, 8, v14
    v_lshrrev_b32 v13, 2, v74
    v_add_u32 v70, v12, v11
    v_bitop3_b32 v74, v5, v13, v14 bitop3:0xea
    ds_add_u32 v74, v2
    v_mul_hi_u32_u24 v14, 429497, v71
    v_lshrrev_b32 v12, 3, v75
    v_cos_f32 v10, v10
    v_lshlrev_b16 v13, 3, v75
    v_mad_i32_i24 v11, v14, s55, v71
    v_bitop3_b32 v12, v6, v13, v12 bitop3:0xca
    v_lshl_add_u32 v11, v11, 17, s40
    v_lshlrev_b16 v14, 8, v14
    v_lshrrev_b32 v13, 2, v75
    v_add_u32 v71, v12, v11
    v_bitop3_b32 v75, v5, v13, v14 bitop3:0xea
    ds_add_u32 v75, v2
    v_cvt_pk_bf16_f32 v67, v9, v10
    v_perm_b32 v12, v67, v67, s41
    v_bitop3_b32 v70, v4, v12, v70 bitop3:0xca
    v_perm_b32 v13, v67, v67, s42
    v_bitop3_b32 v71, v4, v13, v71 bitop3:0xca
    s_setprio 0
    s_add_u32 s44, s96, 0x2400000
    v_lshlrev_b32 v100, 1, v1
    buffer_load_dwordx4 v[100:103], v100, s[8:11], s44 offen nt
    s_waitcnt vmcnt(7)
    v_lshlrev_b32 v7, 16, v84
    v_and_b32 v8, 0xffff0000, v84
    v_lshlrev_b32 v9, 16, v85
    v_and_b32 v10, 0xffff0000, v85
    v_mul_f32 v7, 0.15915494, v7
    v_mul_f32 v8, 0.15915494, v8
    v_mul_f32 v9, 0.15915494, v9
    v_mul_f32 v10, 0.15915494, v10
    v_mul_hi_u32_u24 v14, 429497, v76
    v_lshrrev_b32 v12, 3, v80
    v_cos_f32 v7, v7
    v_lshlrev_b16 v13, 3, v80
    v_mad_i32_i24 v11, v14, s55, v76
    v_bitop3_b32 v12, v6, v13, v12 bitop3:0xca
    v_lshl_add_u32 v11, v11, 17, s40
    v_lshlrev_b16 v14, 8, v14
    v_lshrrev_b32 v13, 2, v80
    v_add_u32 v76, v12, v11
    v_bitop3_b32 v80, v5, v13, v14 bitop3:0xea
    ds_add_u32 v80, v2
    v_mul_hi_u32_u24 v14, 429497, v77
    v_lshrrev_b32 v12, 3, v81
    v_cos_f32 v8, v8
    v_lshlrev_b16 v13, 3, v81
    v_mad_i32_i24 v11, v14, s55, v77
    v_bitop3_b32 v12, v6, v13, v12 bitop3:0xca
    v_lshl_add_u32 v11, v11, 17, s40
    v_lshlrev_b16 v14, 8, v14
    v_lshrrev_b32 v13, 2, v81
    v_add_u32 v77, v12, v11
    v_bitop3_b32 v81, v5, v13, v14 bitop3:0xea
    ds_add_u32 v81, v2
    v_cvt_pk_bf16_f32 v84, v7, v8
    v_perm_b32 v12, v84, v84, s41
    v_bitop3_b32 v76, v4, v12, v76 bitop3:0xca
    v_perm_b32 v13, v84, v84, s42
    v_bitop3_b32 v77, v4, v13, v77 bitop3:0xca
    v_mul_hi_u32_u24 v14, 429497, v78
    v_lshrrev_b32 v12, 3, v82
    v_cos_f32 v9, v9
    v_lshlrev_b16 v13, 3, v82
    v_mad_i32_i24 v11, v14, s55, v78
    v_bitop3_b32 v12, v6, v13, v12 bitop3:0xca
    v_lshl_add_u32 v11, v11, 17, s40
    v_lshlrev_b16 v14, 8, v14
    v_lshrrev_b32 v13, 2, v82
    v_add_u32 v78, v12, v11
    v_bitop3_b32 v82, v5, v13, v14 bitop3:0xea
    ds_add_u32 v82, v2
    v_mul_hi_u32_u24 v14, 429497, v79
    v_lshrrev_b32 v12, 3, v83
    v_cos_f32 v10, v10
    v_lshlrev_b16 v13, 3, v83
    v_mad_i32_i24 v11, v14, s55, v79
    v_bitop3_b32 v12, v6, v13, v12 bitop3:0xca
    v_lshl_add_u32 v11, v11, 17, s40
    v_lshlrev_b16 v14, 8, v14
    v_lshrrev_b32 v13, 2, v83
    v_add_u32 v79, v12, v11
    v_bitop3_b32 v83, v5, v13, v14 bitop3:0xea
    ds_add_u32 v83, v2
    v_cvt_pk_bf16_f32 v85, v9, v10
    v_perm_b32 v12, v85, v85, s41
    v_bitop3_b32 v78, v4, v12, v78 bitop3:0xca
    v_perm_b32 v13, v85, v85, s42
    v_bitop3_b32 v79, v4, v13, v79 bitop3:0xca
    s_waitcnt vmcnt(5)
    v_lshlrev_b32 v7, 16, v86
    v_and_b32 v8, 0xffff0000, v86
    v_lshlrev_b32 v9, 16, v87
    v_and_b32 v10, 0xffff0000, v87
    v_mul_f32 v7, 0.15915494, v7
    v_mul_f32 v8, 0.15915494, v8
    v_mul_f32 v9, 0.15915494, v9
    v_mul_f32 v10, 0.15915494, v10
    v_mul_hi_u32_u24 v14, 429497, v88
    v_lshrrev_b32 v12, 3, v92
    v_cos_f32 v7, v7
    v_lshlrev_b16 v13, 3, v92
    v_mad_i32_i24 v11, v14, s55, v88
    v_bitop3_b32 v12, v6, v13, v12 bitop3:0xca
    v_lshl_add_u32 v11, v11, 17, s40
    v_lshlrev_b16 v14, 8, v14
    v_lshrrev_b32 v13, 2, v92
    v_add_u32 v88, v12, v11
    v_bitop3_b32 v92, v5, v13, v14 bitop3:0xea
    ds_add_u32 v92, v2
    v_mul_hi_u32_u24 v14, 429497, v89
    v_lshrrev_b32 v12, 3, v93
    v_cos_f32 v8, v8
    v_lshlrev_b16 v13, 3, v93
    v_mad_i32_i24 v11, v14, s55, v89
    v_bitop3_b32 v12, v6, v13, v12 bitop3:0xca
    v_lshl_add_u32 v11, v11, 17, s40
    v_lshlrev_b16 v14, 8, v14
    v_lshrrev_b32 v13, 2, v93
    v_add_u32 v89, v12, v11
    v_bitop3_b32 v93, v5, v13, v14 bitop3:0xea
    ds_add_u32 v93, v2
    v_cvt_pk_bf16_f32 v86, v7, v8
    v_perm_b32 v12, v86, v86, s41
    v_bitop3_b32 v88, v4, v12, v88 bitop3:0xca
    v_perm_b32 v13, v86, v86, s42
    v_bitop3_b32 v89, v4, v13, v89 bitop3:0xca
    v_mul_hi_u32_u24 v14, 429497, v90
    v_lshrrev_b32 v12, 3, v94
    v_cos_f32 v9, v9
    v_lshlrev_b16 v13, 3, v94
    v_mad_i32_i24 v11, v14, s55, v90
    v_bitop3_b32 v12, v6, v13, v12 bitop3:0xca
    v_lshl_add_u32 v11, v11, 17, s40
    v_lshlrev_b16 v14, 8, v14
    v_lshrrev_b32 v13, 2, v94
    v_add_u32 v90, v12, v11
    v_bitop3_b32 v94, v5, v13, v14 bitop3:0xea
    ds_add_u32 v94, v2
    v_mul_hi_u32_u24 v14, 429497, v91
    v_lshrrev_b32 v12, 3, v95
    v_cos_f32 v10, v10
    v_lshlrev_b16 v13, 3, v95
    v_mad_i32_i24 v11, v14, s55, v91
    v_bitop3_b32 v12, v6, v13, v12 bitop3:0xca
    v_lshl_add_u32 v11, v11, 17, s40
    v_lshlrev_b16 v14, 8, v14
    v_lshrrev_b32 v13, 2, v95
    v_add_u32 v91, v12, v11
    v_bitop3_b32 v95, v5, v13, v14 bitop3:0xea
    ds_add_u32 v95, v2
    v_cvt_pk_bf16_f32 v87, v9, v10
    v_perm_b32 v12, v87, v87, s41
    v_bitop3_b32 v90, v4, v12, v90 bitop3:0xca
    v_perm_b32 v13, v87, v87, s42
    v_bitop3_b32 v91, v4, v13, v91 bitop3:0xca
    v_lshrrev_b32 v8, 2, v0
    v_and_b32 v7, 0x3c00, v0
    v_bitop3_b32 v7, v5, v8, v7 bitop3:0xea
    s_waitcnt lgkmcnt(0)
    s_barrier
    ds_read2st64_b32 v[8:9], v7 offset0:0 offset1:1
    ds_read2st64_b32 v[10:11], v7 offset0:2 offset1:3
    s_add_u32 s45, s96, 0x2400000
    v_lshlrev_b32 v112, 1, v1
    buffer_load_dwordx4 v[112:115], v112, s[12:15], s45 offen nt
    s_waitcnt lgkmcnt(0)
    v_lshl_or_b32 v12, v9, 16, v8
    v_lshl_or_b32 v13, v11, 16, v10
    v_mov_b32 v14, v12
    v_mov_b32 v15, v13
    s_nop 0
    v_add_u32_dpp v14, v14, v14 row_shr:1 row_mask:0xf bank_mask:0xf bound_ctrl:1
    v_add_u32_dpp v15, v15, v15 row_shr:1 row_mask:0xf bank_mask:0xf bound_ctrl:1
    s_nop 0
    v_add_u32_dpp v14, v14, v14 row_shr:2 row_mask:0xf bank_mask:0xf bound_ctrl:1
    v_add_u32_dpp v15, v15, v15 row_shr:2 row_mask:0xf bank_mask:0xf bound_ctrl:1
    s_nop 0
    v_add_u32_dpp v14, v14, v14 row_shr:4 row_mask:0xf bank_mask:0xf bound_ctrl:1
    v_add_u32_dpp v15, v15, v15 row_shr:4 row_mask:0xf bank_mask:0xf bound_ctrl:1
    s_nop 0
    v_add_u32_dpp v14, v14, v14 row_shr:8 row_mask:0xf bank_mask:0xf bound_ctrl:1
    v_add_u32_dpp v15, v15, v15 row_shr:8 row_mask:0xf bank_mask:0xf bound_ctrl:1
    s_nop 0
    v_add_u32_dpp v14, v14, v14 row_bcast:15 row_mask:0xa bank_mask:0xf
    v_add_u32_dpp v15, v15, v15 row_bcast:15 row_mask:0xa bank_mask:0xf
    s_nop 0
    v_add_u32_dpp v14, v14, v14 row_bcast:31 row_mask:0xc bank_mask:0xf
    v_add_u32_dpp v15, v15, v15 row_bcast:31 row_mask:0xc bank_mask:0xf
    v_readlane_b32 s48, v14, 63
    v_readlane_b32 s49, v15, 63
    s_lshl_b32 s54, s32, 2
    v_mov_b32 v8, s54
    s_and_b32 s50, s48, 0xffff
    s_lshr_b32 s51, s48, 16
    s_and_b32 s52, s49, 0xffff
    s_lshr_b32 s53, s49, 16
    s_add_u32 s51, s51, s50
    s_add_u32 s52, s52, s51
    s_add_u32 s53, s53, s52
    v_mov_b32 v9, s53
    s_mov_b64 exec, 1
    ds_write_b32 v8, v9 offset:16384
    s_mov_b64 exec, -1
    v_and_b32 v8, 60, v7
    s_waitcnt lgkmcnt(0)
    s_barrier
    ds_read_b32 v9, v8 offset:16384
    s_waitcnt lgkmcnt(0)
    v_add_u32_dpp v9, v9, v9 row_shr:1 row_mask:0xf bank_mask:0xf bound_ctrl:1
    s_nop 1
    v_add_u32_dpp v9, v9, v9 row_shr:2 row_mask:0xf bank_mask:0xf bound_ctrl:1
    s_nop 1
    v_add_u32_dpp v9, v9, v9 row_shr:4 row_mask:0xf bank_mask:0xf bound_ctrl:1
    s_nop 1
    v_add_u32_dpp v9, v9, v9 row_shr:8 row_mask:0xf bank_mask:0xf bound_ctrl:1
    s_nop 0
    v_readlane_b32 s54, v9, s32
    s_sub_u32 s54, s54, s53
    s_add_u32 s50, s50, s54
    s_add_u32 s51, s51, s54
    s_add_u32 s52, s52, s54
    s_pack_ll_b32_b16 s48, s54, s50
    s_pack_ll_b32_b16 s49, s51, s52
    v_add_u32 v14, s48, v14
    v_add_u32 v15, s49, v15
    v_sub_u32 v12, v14, v12
    v_sub_u32 v13, v15, v13
    v_and_b32 v8, 0xffff, v12
    v_lshrrev_b32 v9, 16, v12
    v_and_b32 v10, 0xffff, v13
    v_lshrrev_b32 v11, 16, v13
    ds_write2st64_b32 v7, v8, v9 offset0:0 offset1:1
    ds_write2st64_b32 v7, v10, v11 offset0:2 offset1:3
    v_and_b32 v8, 0x3f0, v0
    v_lshl_add_u32 v8, v8, 1, s36
    ds_write_b64 v8, v[12:13] offset:20480
    s_bitset0_b64 exec, 63
    s_not_b64 exec, exec
    ds_write_b64 v8, v[14:15] offset:20512
    s_mov_b64 exec, -1
    s_waitcnt lgkmcnt(0)
    s_barrier
    s_setprio 3
    ds_add_rtn_u32 v20, v20, v2
    ds_add_rtn_u32 v21, v21, v2
    ds_add_rtn_u32 v22, v22, v2
    ds_add_rtn_u32 v23, v23, v2
    ds_read_b128 v[12:15], v0 offset:20480
    v_cmp_gt_u32 vcc, 8448, v0
    s_add_u32 s46, s96, 0x2800000
    v_lshlrev_b32 v116, 1, v1
    buffer_load_dwordx4 v[116:119], v116, s[8:11], s46 offen nt
    ds_add_rtn_u32 v32, v32, v2
    ds_add_rtn_u32 v33, v33, v2
    ds_add_rtn_u32 v34, v34, v2
    ds_add_rtn_u32 v35, v35, v2
    s_setprio 2
    ds_add_rtn_u32 v40, v40, v2
    ds_add_rtn_u32 v41, v41, v2
    ds_add_rtn_u32 v42, v42, v2
    ds_add_rtn_u32 v43, v43, v2
    s_waitcnt lgkmcnt(8)
    s_cbranch_vccz L1_p1
    s_add_u32 s47, s35, 0x0
    s_mov_b64 exec, vcc
    buffer_store_dwordx4 v[12:15], v0, s[24:27], s47 offen sc1
    s_mov_b64 exec, -1
L1_p1:
    s_add_u32 s44, s96, 0x2800000
    v_lshlrev_b32 v120, 1, v1
    buffer_load_dwordx4 v[120:123], v120, s[12:15], s44 offen nt
    ds_add_rtn_u32 v52, v52, v2
    ds_add_rtn_u32 v53, v53, v2
    ds_add_rtn_u32 v54, v54, v2
    ds_add_rtn_u32 v55, v55, v2
    s_setprio 1
    ds_add_rtn_u32 v60, v60, v2
    ds_add_rtn_u32 v61, v61, v2
    ds_add_rtn_u32 v62, v62, v2
    ds_add_rtn_u32 v63, v63, v2
    ds_add_rtn_u32 v72, v72, v2
    ds_add_rtn_u32 v73, v73, v2
    ds_add_rtn_u32 v74, v74, v2
    ds_add_rtn_u32 v75, v75, v2
    s_add_u32 s45, s96, 0x2800000
    s_lshr_b32 s45, s45, 1
    buffer_load_dwordx2 v[124:125], v1, s[16:19], s45 offen nt
    s_add_u32 s46, s96, 0x2c00000
    s_lshr_b32 s46, s46, 1
    buffer_load_dwordx2 v[126:127], v1, s[16:19], s46 offen nt
    s_setprio 0
    ds_add_rtn_u32 v80, v80, v2
    ds_add_rtn_u32 v81, v81, v2
    ds_add_rtn_u32 v82, v82, v2
    ds_add_rtn_u32 v83, v83, v2
    ds_add_rtn_u32 v92, v92, v2
    ds_add_rtn_u32 v93, v93, v2
    ds_add_rtn_u32 v94, v94, v2
    ds_add_rtn_u32 v95, v95, v2
    s_waitcnt lgkmcnt(0)
    s_barrier
    s_setprio 3
    v_and_b32 v7, -4, v20
    v_lshl_add_u32 v8, v20, 2, v7
    ds_write_b32 v8, v16
    v_lshl_add_u32 v7, v7, 2, v20
    ds_write_b8 v7, v24 offset:16
    v_and_b32 v9, -4, v21
    v_lshl_add_u32 v10, v21, 2, v9
    ds_write_b32 v10, v17
    v_lshl_add_u32 v9, v9, 2, v21
    ds_write_b8_d16_hi v9, v24 offset:16
    v_and_b32 v7, -4, v22
    v_lshl_add_u32 v8, v22, 2, v7
    ds_write_b32 v8, v18
    v_lshl_add_u32 v7, v7, 2, v22
    ds_write_b8 v7, v25 offset:16
    v_and_b32 v9, -4, v23
    v_lshl_add_u32 v10, v23, 2, v9
    ds_write_b32 v10, v19
    v_lshl_add_u32 v9, v9, 2, v23
    ds_write_b8_d16_hi v9, v25 offset:16
    s_add_u32 s47, s96, 0x2c00000
    v_lshlrev_b32 v16, 1, v1
    buffer_load_dwordx4 v[16:19], v16, s[8:11], s47 offen nt
    s_add_u32 s44, s96, 0x2c00000
    v_lshlrev_b32 v20, 1, v1
    buffer_load_dwordx4 v[20:23], v20, s[12:15], s44 offen nt
    v_and_b32 v7, -4, v32
    v_lshl_add_u32 v8, v32, 2, v7
    ds_write_b32 v8, v28
    v_lshl_add_u32 v7, v7, 2, v32
    ds_write_b8 v7, v26 offset:16
    v_and_b32 v9, -4, v33
    v_lshl_add_u32 v10, v33, 2, v9
    ds_write_b32 v10, v29
    v_lshl_add_u32 v9, v9, 2, v33
    ds_write_b8_d16_hi v9, v26 offset:16
    v_and_b32 v7, -4, v34
    v_lshl_add_u32 v8, v34, 2, v7
    ds_write_b32 v8, v30
    v_lshl_add_u32 v7, v7, 2, v34
    ds_write_b8 v7, v27 offset:16
    v_and_b32 v9, -4, v35
    v_lshl_add_u32 v10, v35, 2, v9
    ds_write_b32 v10, v31
    v_lshl_add_u32 v9, v9, 2, v35
    ds_write_b8_d16_hi v9, v27 offset:16
    s_add_u32 s45, s96, 0x3000000
    v_lshlrev_b32 v28, 1, v1
    buffer_load_dwordx4 v[28:31], v28, s[8:11], s45 offen nt
    s_waitcnt vmcnt(9)
    v_lshlrev_b32 v7, 16, v108
    v_and_b32 v8, 0xffff0000, v108
    v_lshlrev_b32 v9, 16, v109
    v_and_b32 v10, 0xffff0000, v109
    v_mul_f32 v7, 0.15915494, v7
    v_mul_f32 v8, 0.15915494, v8
    v_mul_f32 v9, 0.15915494, v9
    v_mul_f32 v10, 0.15915494, v10
    v_mul_hi_u32_u24 v14, 429497, v96
    v_lshrrev_b32 v12, 3, v104
    v_cos_f32 v7, v7
    v_lshlrev_b16 v13, 3, v104
    v_mad_i32_i24 v11, v14, s55, v96
    v_bitop3_b32 v12, v6, v13, v12 bitop3:0xca
    v_lshl_add_u32 v11, v11, 17, s40
    v_lshlrev_b16 v14, 8, v14
    v_lshrrev_b32 v13, 2, v104
    v_add_u32 v96, v12, v11
    v_bitop3_b32 v104, v5, v13, v14 bitop3:0xea
    v_mul_hi_u32_u24 v14, 429497, v97
    v_lshrrev_b32 v12, 3, v105
    v_cos_f32 v8, v8
    v_lshlrev_b16 v13, 3, v105
    v_mad_i32_i24 v11, v14, s55, v97
    v_bitop3_b32 v12, v6, v13, v12 bitop3:0xca
    v_lshl_add_u32 v11, v11, 17, s40
    v_lshlrev_b16 v14, 8, v14
    v_lshrrev_b32 v13, 2, v105
    v_add_u32 v97, v12, v11
    v_bitop3_b32 v105, v5, v13, v14 bitop3:0xea
    v_cvt_pk_bf16_f32 v108, v7, v8
    v_perm_b32 v12, v108, v108, s41
    v_bitop3_b32 v96, v4, v12, v96 bitop3:0xca
    v_perm_b32 v13, v108, v108, s42
    v_bitop3_b32 v97, v4, v13, v97 bitop3:0xca
    v_mul_hi_u32_u24 v14, 429497, v98
    v_lshrrev_b32 v12, 3, v106
    v_cos_f32 v9, v9
    v_lshlrev_b16 v13, 3, v106
    v_mad_i32_i24 v11, v14, s55, v98
    v_bitop3_b32 v12, v6, v13, v12 bitop3:0xca
    v_lshl_add_u32 v11, v11, 17, s40
    v_lshlrev_b16 v14, 8, v14
    v_lshrrev_b32 v13, 2, v106
    v_add_u32 v98, v12, v11
    v_bitop3_b32 v106, v5, v13, v14 bitop3:0xea
    v_mul_hi_u32_u24 v14, 429497, v99
    v_lshrrev_b32 v12, 3, v107
    v_cos_f32 v10, v10
    v_lshlrev_b16 v13, 3, v107
    v_mad_i32_i24 v11, v14, s55, v99
    v_bitop3_b32 v12, v6, v13, v12 bitop3:0xca
    v_lshl_add_u32 v11, v11, 17, s40
    v_lshlrev_b16 v14, 8, v14
    v_lshrrev_b32 v13, 2, v107
    v_add_u32 v99, v12, v11
    v_bitop3_b32 v107, v5, v13, v14 bitop3:0xea
    v_cvt_pk_bf16_f32 v109, v9, v10
    v_perm_b32 v12, v109, v109, s41
    v_bitop3_b32 v98, v4, v12, v98 bitop3:0xca
    v_perm_b32 v13, v109, v109, s42
    v_bitop3_b32 v99, v4, v13, v99 bitop3:0xca
    s_setprio 2
    v_and_b32 v7, -4, v40
    v_lshl_add_u32 v8, v40, 2, v7
    ds_write_b32 v8, v36
    v_lshl_add_u32 v7, v7, 2, v40
    ds_write_b8 v7, v44 offset:16
    v_and_b32 v9, -4, v41
    v_lshl_add_u32 v10, v41, 2, v9
    ds_write_b32 v10, v37
    v_lshl_add_u32 v9, v9, 2, v41
    ds_write_b8_d16_hi v9, v44 offset:16
    v_and_b32 v7, -4, v42
    v_lshl_add_u32 v8, v42, 2, v7
    ds_write_b32 v8, v38
    v_lshl_add_u32 v7, v7, 2, v42
    ds_write_b8 v7, v45 offset:16
    v_and_b32 v9, -4, v43
    v_lshl_add_u32 v10, v43, 2, v9
    ds_write_b32 v10, v39
    v_lshl_add_u32 v9, v9, 2, v43
    ds_write_b8_d16_hi v9, v45 offset:16
    s_add_u32 s46, s96, 0x3000000
    v_lshlrev_b32 v32, 1, v1
    buffer_load_dwordx4 v[32:35], v32, s[12:15], s46 offen nt
    s_waitcnt vmcnt(8)
    v_lshlrev_b32 v7, 16, v110
    v_and_b32 v8, 0xffff0000, v110
    v_lshlrev_b32 v9, 16, v111
    v_and_b32 v10, 0xffff0000, v111
    v_mul_f32 v7, 0.15915494, v7
    v_mul_f32 v8, 0.15915494, v8
    v_mul_f32 v9, 0.15915494, v9
    v_mul_f32 v10, 0.15915494, v10
    v_mul_hi_u32_u24 v14, 429497, v100
    v_lshrrev_b32 v12, 3, v112
    v_cos_f32 v7, v7
    v_lshlrev_b16 v13, 3, v112
    v_mad_i32_i24 v11, v14, s55, v100
    v_bitop3_b32 v12, v6, v13, v12 bitop3:0xca
    v_lshl_add_u32 v11, v11, 17, s40
    v_lshlrev_b16 v14, 8, v14
    v_lshrrev_b32 v13, 2, v112
    v_add_u32 v100, v12, v11
    v_bitop3_b32 v112, v5, v13, v14 bitop3:0xea
    v_mul_hi_u32_u24 v14, 429497, v101
    v_lshrrev_b32 v12, 3, v113
    v_cos_f32 v8, v8
    v_lshlrev_b16 v13, 3, v113
    v_mad_i32_i24 v11, v14, s55, v101
    v_bitop3_b32 v12, v6, v13, v12 bitop3:0xca
    v_lshl_add_u32 v11, v11, 17, s40
    v_lshlrev_b16 v14, 8, v14
    v_lshrrev_b32 v13, 2, v113
    v_add_u32 v101, v12, v11
    v_bitop3_b32 v113, v5, v13, v14 bitop3:0xea
    v_cvt_pk_bf16_f32 v110, v7, v8
    v_perm_b32 v12, v110, v110, s41
    v_bitop3_b32 v100, v4, v12, v100 bitop3:0xca
    v_perm_b32 v13, v110, v110, s42
    v_bitop3_b32 v101, v4, v13, v101 bitop3:0xca
    v_mul_hi_u32_u24 v14, 429497, v102
    v_lshrrev_b32 v12, 3, v114
    v_cos_f32 v9, v9
    v_lshlrev_b16 v13, 3, v114
    v_mad_i32_i24 v11, v14, s55, v102
    v_bitop3_b32 v12, v6, v13, v12 bitop3:0xca
    v_lshl_add_u32 v11, v11, 17, s40
    v_lshlrev_b16 v14, 8, v14
    v_lshrrev_b32 v13, 2, v114
    v_add_u32 v102, v12, v11
    v_bitop3_b32 v114, v5, v13, v14 bitop3:0xea
    v_mul_hi_u32_u24 v14, 429497, v103
    v_lshrrev_b32 v12, 3, v115
    v_cos_f32 v10, v10
    v_lshlrev_b16 v13, 3, v115
    v_mad_i32_i24 v11, v14, s55, v103
    v_bitop3_b32 v12, v6, v13, v12 bitop3:0xca
    v_lshl_add_u32 v11, v11, 17, s40
    v_lshlrev_b16 v14, 8, v14
    v_lshrrev_b32 v13, 2, v115
    v_add_u32 v103, v12, v11
    v_bitop3_b32 v115, v5, v13, v14 bitop3:0xea
    v_cvt_pk_bf16_f32 v111, v9, v10
    v_perm_b32 v12, v111, v111, s41
    v_bitop3_b32 v102, v4, v12, v102 bitop3:0xca
    v_perm_b32 v13, v111, v111, s42
    v_bitop3_b32 v103, v4, v13, v103 bitop3:0xca
    v_and_b32 v7, -4, v52
    v_lshl_add_u32 v8, v52, 2, v7
    ds_write_b32 v8, v48
    v_lshl_add_u32 v7, v7, 2, v52
    ds_write_b8 v7, v46 offset:16
    v_and_b32 v9, -4, v53
    v_lshl_add_u32 v10, v53, 2, v9
    ds_write_b32 v10, v49
    v_lshl_add_u32 v9, v9, 2, v53
    ds_write_b8_d16_hi v9, v46 offset:16
    v_and_b32 v7, -4, v54
    v_lshl_add_u32 v8, v54, 2, v7
    ds_write_b32 v8, v50
    v_lshl_add_u32 v7, v7, 2, v54
    ds_write_b8 v7, v47 offset:16
    v_and_b32 v9, -4, v55
    v_lshl_add_u32 v10, v55, 2, v9
    ds_write_b32 v10, v51
    v_lshl_add_u32 v9, v9, 2, v55
    ds_write_b8_d16_hi v9, v47 offset:16
    s_add_u32 s47, s96, 0x3000000
    s_lshr_b32 s47, s47, 1
    buffer_load_dwordx2 v[24:25], v1, s[16:19], s47 offen nt
    s_add_u32 s44, s96, 0x3400000
    s_lshr_b32 s44, s44, 1
    buffer_load_dwordx2 v[26:27], v1, s[16:19], s44 offen nt
    s_waitcnt vmcnt(6)
    v_lshlrev_b32 v7, 16, v124
    v_and_b32 v8, 0xffff0000, v124
    v_lshlrev_b32 v9, 16, v125
    v_and_b32 v10, 0xffff0000, v125
    v_mul_f32 v7, 0.15915494, v7
    v_mul_f32 v8, 0.15915494, v8
    v_mul_f32 v9, 0.15915494, v9
    v_mul_f32 v10, 0.15915494, v10
    v_mul_hi_u32_u24 v14, 429497, v116
    v_lshrrev_b32 v12, 3, v120
    v_cos_f32 v7, v7
    v_lshlrev_b16 v13, 3, v120
    v_mad_i32_i24 v11, v14, s55, v116
    v_bitop3_b32 v12, v6, v13, v12 bitop3:0xca
    v_lshl_add_u32 v11, v11, 17, s40
    v_lshlrev_b16 v14, 8, v14
    v_lshrrev_b32 v13, 2, v120
    v_add_u32 v116, v12, v11
    v_bitop3_b32 v120, v5, v13, v14 bitop3:0xea
    v_mul_hi_u32_u24 v14, 429497, v117
    v_lshrrev_b32 v12, 3, v121
    v_cos_f32 v8, v8
    v_lshlrev_b16 v13, 3, v121
    v_mad_i32_i24 v11, v14, s55, v117
    v_bitop3_b32 v12, v6, v13, v12 bitop3:0xca
    v_lshl_add_u32 v11, v11, 17, s40
    v_lshlrev_b16 v14, 8, v14
    v_lshrrev_b32 v13, 2, v121
    v_add_u32 v117, v12, v11
    v_bitop3_b32 v121, v5, v13, v14 bitop3:0xea
    v_cvt_pk_bf16_f32 v124, v7, v8
    v_perm_b32 v12, v124, v124, s41
    v_bitop3_b32 v116, v4, v12, v116 bitop3:0xca
    v_perm_b32 v13, v124, v124, s42
    v_bitop3_b32 v117, v4, v13, v117 bitop3:0xca
    v_mul_hi_u32_u24 v14, 429497, v118
    v_lshrrev_b32 v12, 3, v122
    v_cos_f32 v9, v9
    v_lshlrev_b16 v13, 3, v122
    v_mad_i32_i24 v11, v14, s55, v118
    v_bitop3_b32 v12, v6, v13, v12 bitop3:0xca
    v_lshl_add_u32 v11, v11, 17, s40
    v_lshlrev_b16 v14, 8, v14
    v_lshrrev_b32 v13, 2, v122
    v_add_u32 v118, v12, v11
    v_bitop3_b32 v122, v5, v13, v14 bitop3:0xea
    v_mul_hi_u32_u24 v14, 429497, v119
    v_lshrrev_b32 v12, 3, v123
    v_cos_f32 v10, v10
    v_lshlrev_b16 v13, 3, v123
    v_mad_i32_i24 v11, v14, s55, v119
    v_bitop3_b32 v12, v6, v13, v12 bitop3:0xca
    v_lshl_add_u32 v11, v11, 17, s40
    v_lshlrev_b16 v14, 8, v14
    v_lshrrev_b32 v13, 2, v123
    v_add_u32 v119, v12, v11
    v_bitop3_b32 v123, v5, v13, v14 bitop3:0xea
    v_cvt_pk_bf16_f32 v125, v9, v10
    v_perm_b32 v12, v125, v125, s41
    v_bitop3_b32 v118, v4, v12, v118 bitop3:0xca
    v_perm_b32 v13, v125, v125, s42
    v_bitop3_b32 v119, v4, v13, v119 bitop3:0xca
    s_setprio 1
    v_and_b32 v7, -4, v60
    v_lshl_add_u32 v8, v60, 2, v7
    ds_write_b32 v8, v56
    v_lshl_add_u32 v7, v7, 2, v60
    ds_write_b8 v7, v64 offset:16
    v_and_b32 v9, -4, v61
    v_lshl_add_u32 v10, v61, 2, v9
    ds_write_b32 v10, v57
    v_lshl_add_u32 v9, v9, 2, v61
    ds_write_b8_d16_hi v9, v64 offset:16
    v_and_b32 v7, -4, v62
    v_lshl_add_u32 v8, v62, 2, v7
    ds_write_b32 v8, v58
    v_lshl_add_u32 v7, v7, 2, v62
    ds_write_b8 v7, v65 offset:16
    v_and_b32 v9, -4, v63
    v_lshl_add_u32 v10, v63, 2, v9
    ds_write_b32 v10, v59
    v_lshl_add_u32 v9, v9, 2, v63
    ds_write_b8_d16_hi v9, v65 offset:16
    s_add_u32 s45, s96, 0x3400000
    v_lshlrev_b32 v36, 1, v1
    buffer_load_dwordx4 v[36:39], v36, s[8:11], s45 offen nt
    s_add_u32 s46, s96, 0x3400000
    v_lshlrev_b32 v40, 1, v1
    buffer_load_dwordx4 v[40:43], v40, s[12:15], s46 offen nt
    v_and_b32 v7, -4, v72
    v_lshl_add_u32 v8, v72, 2, v7
    ds_write_b32 v8, v68
    v_lshl_add_u32 v7, v7, 2, v72
    ds_write_b8 v7, v66 offset:16
    v_and_b32 v9, -4, v73
    v_lshl_add_u32 v10, v73, 2, v9
    ds_write_b32 v10, v69
    v_lshl_add_u32 v9, v9, 2, v73
    ds_write_b8_d16_hi v9, v66 offset:16
    v_and_b32 v7, -4, v74
    v_lshl_add_u32 v8, v74, 2, v7
    ds_write_b32 v8, v70
    v_lshl_add_u32 v7, v7, 2, v74
    ds_write_b8 v7, v67 offset:16
    v_and_b32 v9, -4, v75
    v_lshl_add_u32 v10, v75, 2, v9
    ds_write_b32 v10, v71
    v_lshl_add_u32 v9, v9, 2, v75
    ds_write_b8_d16_hi v9, v67 offset:16
    s_add_u32 s47, s96, 0x3800000
    v_lshlrev_b32 v48, 1, v1
    buffer_load_dwordx4 v[48:51], v48, s[8:11], s47 offen nt
    s_waitcnt vmcnt(7)
    v_lshlrev_b32 v7, 16, v126
    v_and_b32 v8, 0xffff0000, v126
    v_lshlrev_b32 v9, 16, v127
    v_and_b32 v10, 0xffff0000, v127
    v_mul_f32 v7, 0.15915494, v7
    v_mul_f32 v8, 0.15915494, v8
    v_mul_f32 v9, 0.15915494, v9
    v_mul_f32 v10, 0.15915494, v10
    v_mul_hi_u32_u24 v14, 429497, v16
    v_lshrrev_b32 v12, 3, v20
    v_cos_f32 v7, v7
    v_lshlrev_b16 v13, 3, v20
    v_mad_i32_i24 v11, v14, s55, v16
    v_bitop3_b32 v12, v6, v13, v12 bitop3:0xca
    v_lshl_add_u32 v11, v11, 17, s40
    v_lshlrev_b16 v14, 8, v14
    v_lshrrev_b32 v13, 2, v20
    v_add_u32 v16, v12, v11
    v_bitop3_b32 v20, v5, v13, v14 bitop3:0xea
    v_mul_hi_u32_u24 v14, 429497, v17
    v_lshrrev_b32 v12, 3, v21
    v_cos_f32 v8, v8
    v_lshlrev_b16 v13, 3, v21
    v_mad_i32_i24 v11, v14, s55, v17
    v_bitop3_b32 v12, v6, v13, v12 bitop3:0xca
    v_lshl_add_u32 v11, v11, 17, s40
    v_lshlrev_b16 v14, 8, v14
    v_lshrrev_b32 v13, 2, v21
    v_add_u32 v17, v12, v11
    v_bitop3_b32 v21, v5, v13, v14 bitop3:0xea
    v_cvt_pk_bf16_f32 v126, v7, v8
    v_perm_b32 v12, v126, v126, s41
    v_bitop3_b32 v16, v4, v12, v16 bitop3:0xca
    v_perm_b32 v13, v126, v126, s42
    v_bitop3_b32 v17, v4, v13, v17 bitop3:0xca
    v_mul_hi_u32_u24 v14, 429497, v18
    v_lshrrev_b32 v12, 3, v22
    v_cos_f32 v9, v9
    v_lshlrev_b16 v13, 3, v22
    v_mad_i32_i24 v11, v14, s55, v18
    v_bitop3_b32 v12, v6, v13, v12 bitop3:0xca
    v_lshl_add_u32 v11, v11, 17, s40
    v_lshlrev_b16 v14, 8, v14
    v_lshrrev_b32 v13, 2, v22
    v_add_u32 v18, v12, v11
    v_bitop3_b32 v22, v5, v13, v14 bitop3:0xea
    v_mul_hi_u32_u24 v14, 429497, v19
    v_lshrrev_b32 v12, 3, v23
    v_cos_f32 v10, v10
    v_lshlrev_b16 v13, 3, v23
    v_mad_i32_i24 v11, v14, s55, v19
    v_bitop3_b32 v12, v6, v13, v12 bitop3:0xca
    v_lshl_add_u32 v11, v11, 17, s40
    v_lshlrev_b16 v14, 8, v14
    v_lshrrev_b32 v13, 2, v23
    v_add_u32 v19, v12, v11
    v_bitop3_b32 v23, v5, v13, v14 bitop3:0xea
    v_cvt_pk_bf16_f32 v127, v9, v10
    v_perm_b32 v12, v127, v127, s41
    v_bitop3_b32 v18, v4, v12, v18 bitop3:0xca
    v_perm_b32 v13, v127, v127, s42
    v_bitop3_b32 v19, v4, v13, v19 bitop3:0xca
    s_setprio 0
    v_and_b32 v7, -4, v80
    v_lshl_add_u32 v8, v80, 2, v7
    ds_write_b32 v8, v76
    v_lshl_add_u32 v7, v7, 2, v80
    ds_write_b8 v7, v84 offset:16
    v_and_b32 v9, -4, v81
    v_lshl_add_u32 v10, v81, 2, v9
    ds_write_b32 v10, v77
    v_lshl_add_u32 v9, v9, 2, v81
    ds_write_b8_d16_hi v9, v84 offset:16
    v_and_b32 v7, -4, v82
    v_lshl_add_u32 v8, v82, 2, v7
    ds_write_b32 v8, v78
    v_lshl_add_u32 v7, v7, 2, v82
    ds_write_b8 v7, v85 offset:16
    v_and_b32 v9, -4, v83
    v_lshl_add_u32 v10, v83, 2, v9
    ds_write_b32 v10, v79
    v_lshl_add_u32 v9, v9, 2, v83
    ds_write_b8_d16_hi v9, v85 offset:16
    s_add_u32 s44, s96, 0x3800000
    v_lshlrev_b32 v52, 1, v1
    buffer_load_dwordx4 v[52:55], v52, s[12:15], s44 offen nt
    s_waitcnt vmcnt(4)
    v_lshlrev_b32 v7, 16, v24
    v_and_b32 v8, 0xffff0000, v24
    v_lshlrev_b32 v9, 16, v25
    v_and_b32 v10, 0xffff0000, v25
    v_mul_f32 v7, 0.15915494, v7
    v_mul_f32 v8, 0.15915494, v8
    v_mul_f32 v9, 0.15915494, v9
    v_mul_f32 v10, 0.15915494, v10
    v_mul_hi_u32_u24 v14, 429497, v28
    v_lshrrev_b32 v12, 3, v32
    v_cos_f32 v7, v7
    v_lshlrev_b16 v13, 3, v32
    v_mad_i32_i24 v11, v14, s55, v28
    v_bitop3_b32 v12, v6, v13, v12 bitop3:0xca
    v_lshl_add_u32 v11, v11, 17, s40
    v_lshlrev_b16 v14, 8, v14
    v_lshrrev_b32 v13, 2, v32
    v_add_u32 v28, v12, v11
    v_bitop3_b32 v32, v5, v13, v14 bitop3:0xea
    v_mul_hi_u32_u24 v14, 429497, v29
    v_lshrrev_b32 v12, 3, v33
    v_cos_f32 v8, v8
    v_lshlrev_b16 v13, 3, v33
    v_mad_i32_i24 v11, v14, s55, v29
    v_bitop3_b32 v12, v6, v13, v12 bitop3:0xca
    v_lshl_add_u32 v11, v11, 17, s40
    v_lshlrev_b16 v14, 8, v14
    v_lshrrev_b32 v13, 2, v33
    v_add_u32 v29, v12, v11
    v_bitop3_b32 v33, v5, v13, v14 bitop3:0xea
    v_cvt_pk_bf16_f32 v24, v7, v8
    v_perm_b32 v12, v24, v24, s41
    v_bitop3_b32 v28, v4, v12, v28 bitop3:0xca
    v_perm_b32 v13, v24, v24, s42
    v_bitop3_b32 v29, v4, v13, v29 bitop3:0xca
    v_mul_hi_u32_u24 v14, 429497, v30
    v_lshrrev_b32 v12, 3, v34
    v_cos_f32 v9, v9
    v_lshlrev_b16 v13, 3, v34
    v_mad_i32_i24 v11, v14, s55, v30
    v_bitop3_b32 v12, v6, v13, v12 bitop3:0xca
    v_lshl_add_u32 v11, v11, 17, s40
    v_lshlrev_b16 v14, 8, v14
    v_lshrrev_b32 v13, 2, v34
    v_add_u32 v30, v12, v11
    v_bitop3_b32 v34, v5, v13, v14 bitop3:0xea
    v_mul_hi_u32_u24 v14, 429497, v31
    v_lshrrev_b32 v12, 3, v35
    v_cos_f32 v10, v10
    v_lshlrev_b16 v13, 3, v35
    v_mad_i32_i24 v11, v14, s55, v31
    v_bitop3_b32 v12, v6, v13, v12 bitop3:0xca
    v_lshl_add_u32 v11, v11, 17, s40
    v_lshlrev_b16 v14, 8, v14
    v_lshrrev_b32 v13, 2, v35
    v_add_u32 v31, v12, v11
    v_bitop3_b32 v35, v5, v13, v14 bitop3:0xea
    v_cvt_pk_bf16_f32 v25, v9, v10
    v_perm_b32 v12, v25, v25, s41
    v_bitop3_b32 v30, v4, v12, v30 bitop3:0xca
    v_perm_b32 v13, v25, v25, s42
    v_bitop3_b32 v31, v4, v13, v31 bitop3:0xca
    v_and_b32 v7, -4, v92
    v_lshl_add_u32 v8, v92, 2, v7
    ds_write_b32 v8, v88
    v_lshl_add_u32 v7, v7, 2, v92
    ds_write_b8 v7, v86 offset:16
    v_and_b32 v9, -4, v93
    v_lshl_add_u32 v10, v93, 2, v9
    ds_write_b32 v10, v89
    v_lshl_add_u32 v9, v9, 2, v93
    ds_write_b8_d16_hi v9, v86 offset:16
    v_and_b32 v7, -4, v94
    v_lshl_add_u32 v8, v94, 2, v7
    ds_write_b32 v8, v90
    v_lshl_add_u32 v7, v7, 2, v94
    ds_write_b8 v7, v87 offset:16
    v_and_b32 v9, -4, v95
    v_lshl_add_u32 v10, v95, 2, v9
    ds_write_b32 v10, v91
    v_lshl_add_u32 v9, v9, 2, v95
    ds_write_b8_d16_hi v9, v87 offset:16
    s_add_u32 s45, s96, 0x3800000
    s_lshr_b32 s45, s45, 1
    buffer_load_dwordx2 v[44:45], v1, s[16:19], s45 offen nt
    s_add_u32 s46, s96, 0x3c00000
    s_lshr_b32 s46, s46, 1
    buffer_load_dwordx2 v[46:47], v1, s[16:19], s46 offen nt
    s_waitcnt vmcnt(4)
    v_lshlrev_b32 v7, 16, v26
    v_and_b32 v8, 0xffff0000, v26
    v_lshlrev_b32 v9, 16, v27
    v_and_b32 v10, 0xffff0000, v27
    v_mul_f32 v7, 0.15915494, v7
    v_mul_f32 v8, 0.15915494, v8
    v_mul_f32 v9, 0.15915494, v9
    v_mul_f32 v10, 0.15915494, v10
    v_mul_hi_u32_u24 v14, 429497, v36
    v_lshrrev_b32 v12, 3, v40
    v_cos_f32 v7, v7
    v_lshlrev_b16 v13, 3, v40
    v_mad_i32_i24 v11, v14, s55, v36
    v_bitop3_b32 v12, v6, v13, v12 bitop3:0xca
    v_lshl_add_u32 v11, v11, 17, s40
    v_lshlrev_b16 v14, 8, v14
    v_lshrrev_b32 v13, 2, v40
    v_add_u32 v36, v12, v11
    v_bitop3_b32 v40, v5, v13, v14 bitop3:0xea
    v_mul_hi_u32_u24 v14, 429497, v37
    v_lshrrev_b32 v12, 3, v41
    v_cos_f32 v8, v8
    v_lshlrev_b16 v13, 3, v41
    v_mad_i32_i24 v11, v14, s55, v37
    v_bitop3_b32 v12, v6, v13, v12 bitop3:0xca
    v_lshl_add_u32 v11, v11, 17, s40
    v_lshlrev_b16 v14, 8, v14
    v_lshrrev_b32 v13, 2, v41
    v_add_u32 v37, v12, v11
    v_bitop3_b32 v41, v5, v13, v14 bitop3:0xea
    v_cvt_pk_bf16_f32 v26, v7, v8
    v_perm_b32 v12, v26, v26, s41
    v_bitop3_b32 v36, v4, v12, v36 bitop3:0xca
    v_perm_b32 v13, v26, v26, s42
    v_bitop3_b32 v37, v4, v13, v37 bitop3:0xca
    v_mul_hi_u32_u24 v14, 429497, v38
    v_lshrrev_b32 v12, 3, v42
    v_cos_f32 v9, v9
    v_lshlrev_b16 v13, 3, v42
    v_mad_i32_i24 v11, v14, s55, v38
    v_bitop3_b32 v12, v6, v13, v12 bitop3:0xca
    v_lshl_add_u32 v11, v11, 17, s40
    v_lshlrev_b16 v14, 8, v14
    v_lshrrev_b32 v13, 2, v42
    v_add_u32 v38, v12, v11
    v_bitop3_b32 v42, v5, v13, v14 bitop3:0xea
    v_mul_hi_u32_u24 v14, 429497, v39
    v_lshrrev_b32 v12, 3, v43
    v_cos_f32 v10, v10
    v_lshlrev_b16 v13, 3, v43
    v_mad_i32_i24 v11, v14, s55, v39
    v_bitop3_b32 v12, v6, v13, v12 bitop3:0xca
    v_lshl_add_u32 v11, v11, 17, s40
    v_lshlrev_b16 v14, 8, v14
    v_lshrrev_b32 v13, 2, v43
    v_add_u32 v39, v12, v11
    v_bitop3_b32 v43, v5, v13, v14 bitop3:0xea
    v_cvt_pk_bf16_f32 v27, v9, v10
    v_perm_b32 v12, v27, v27, s41
    v_bitop3_b32 v38, v4, v12, v38 bitop3:0xca
    v_perm_b32 v13, v27, v27, s42
    v_bitop3_b32 v39, v4, v13, v39 bitop3:0xca
    v_add_u32 v7, s72, v0
    v_add_u32 v12, s73, v0
    v_add_u32 v13, s85, v0
    v_add_u32 v14, s91, v0
    v_add_u32 v15, s93, v0
    s_min_i32 s3, s72, s73
    s_min_i32 s3, s3, s85
    s_min_i32 s3, s3, s91
    s_min_i32 s3, s3, s93
    v_add_u32 v3, s3, v0
    v_mov_b32 v8, 0
    v_mov_b32 v9, 0
    v_mov_b32 v10, 0
    v_mov_b32 v11, 0
    s_waitcnt lgkmcnt(0)
    s_barrier
    ds_read_b128 v[56:59], v7 offset:0
    ds_read_b128 v[60:63], v12 offset:0
    ds_read_b128 v[68:71], v13 offset:0
    ds_read_b128 v[72:75], v14 offset:0
    ds_read_b128 v[64:67], v15 offset:0
    ds_write_b128 v3, v[8:11]
    ds_read_b128 v[76:79], v7 offset:16384
    ds_read_b128 v[80:83], v12 offset:16384
    ds_read_b128 v[88:91], v13 offset:16384
    ds_read_b128 v[92:95], v14 offset:16384
    ds_read_b128 v[84:87], v15 offset:16384
    s_waitcnt lgkmcnt(0)
    s_barrier
    s_setprio 3
    s_add_u32 s47, s35, 0x4000
    s_add_u32 s47, s47, s72
    buffer_store_dwordx4 v[56:59], v0, s[20:23], s47 offen sc1
    s_add_u32 s44, s96, 0x3c00000
    s_nop 0
    v_lshlrev_b32 v56, 1, v1
    buffer_load_dwordx4 v[56:59], v56, s[8:11], s44 offen nt
    s_add_u32 s45, s35, 0x4000
    s_add_u32 s45, s45, s73
    buffer_store_dwordx4 v[60:63], v0, s[20:23], s45 offen sc1
    s_add_u32 s46, s96, 0x3c00000
    s_nop 0
    v_lshlrev_b32 v60, 1, v1
    buffer_load_dwordx4 v[60:63], v60, s[12:15], s46 offen nt
    ds_add_u32 v104, v2
    ds_add_u32 v105, v2
    ds_add_u32 v106, v2
    ds_add_u32 v107, v2
    ds_add_u32 v112, v2
    ds_add_u32 v113, v2
    ds_add_u32 v114, v2
    ds_add_u32 v115, v2
    s_setprio 2
    ds_add_u32 v120, v2
    ds_add_u32 v121, v2
    ds_add_u32 v122, v2
    ds_add_u32 v123, v2
    ds_add_u32 v20, v2
    ds_add_u32 v21, v2
    ds_add_u32 v22, v2
    ds_add_u32 v23, v2
    s_setprio 1
    s_add_u32 s47, s35, 0x4000
    s_add_u32 s47, s47, s85
    buffer_store_dwordx4 v[68:71], v0, s[20:23], s47 offen sc1
    s_add_u32 s44, s96, 0x4000000
    s_nop 0
    v_lshlrev_b32 v68, 1, v1
    buffer_load_dwordx4 v[68:71], v68, s[8:11], s44 offen nt
    ds_add_u32 v32, v2
    ds_add_u32 v33, v2
    ds_add_u32 v34, v2
    ds_add_u32 v35, v2
    ds_add_u32 v40, v2
    ds_add_u32 v41, v2
    ds_add_u32 v42, v2
    ds_add_u32 v43, v2
    s_setprio 0
    s_waitcnt vmcnt(6)
    v_lshlrev_b32 v7, 16, v44
    v_and_b32 v8, 0xffff0000, v44
    v_lshlrev_b32 v9, 16, v45
    v_and_b32 v10, 0xffff0000, v45
    v_mul_f32 v7, 0.15915494, v7
    v_mul_f32 v8, 0.15915494, v8
    v_mul_f32 v9, 0.15915494, v9
    v_mul_f32 v10, 0.15915494, v10
    v_mul_hi_u32_u24 v14, 429497, v48
    v_lshrrev_b32 v12, 3, v52
    v_cos_f32 v7, v7
    v_lshlrev_b16 v13, 3, v52
    v_mad_i32_i24 v11, v14, s55, v48
    v_bitop3_b32 v12, v6, v13, v12 bitop3:0xca
    v_lshl_add_u32 v11, v11, 17, s40
    v_lshlrev_b16 v14, 8, v14
    v_lshrrev_b32 v13, 2, v52
    v_add_u32 v48, v12, v11
    v_bitop3_b32 v52, v5, v13, v14 bitop3:0xea
    ds_add_u32 v52, v2
    v_mul_hi_u32_u24 v14, 429497, v49
    v_lshrrev_b32 v12, 3, v53
    v_cos_f32 v8, v8
    v_lshlrev_b16 v13, 3, v53
    v_mad_i32_i24 v11, v14, s55, v49
    v_bitop3_b32 v12, v6, v13, v12 bitop3:0xca
    v_lshl_add_u32 v11, v11, 17, s40
    v_lshlrev_b16 v14, 8, v14
    v_lshrrev_b32 v13, 2, v53
    v_add_u32 v49, v12, v11
    v_bitop3_b32 v53, v5, v13, v14 bitop3:0xea
    ds_add_u32 v53, v2
    v_cvt_pk_bf16_f32 v44, v7, v8
    v_perm_b32 v12, v44, v44, s41
    v_bitop3_b32 v48, v4, v12, v48 bitop3:0xca
    v_perm_b32 v13, v44, v44, s42
    v_bitop3_b32 v49, v4, v13, v49 bitop3:0xca
    v_mul_hi_u32_u24 v14, 429497, v50
    v_lshrrev_b32 v12, 3, v54
    v_cos_f32 v9, v9
    v_lshlrev_b16 v13, 3, v54
    v_mad_i32_i24 v11, v14, s55, v50
    v_bitop3_b32 v12, v6, v13, v12 bitop3:0xca
    v_lshl_add_u32 v11, v11, 17, s40
    v_lshlrev_b16 v14, 8, v14
    v_lshrrev_b32 v13, 2, v54
    v_add_u32 v50, v12, v11
    v_bitop3_b32 v54, v5, v13, v14 bitop3:0xea
    ds_add_u32 v54, v2
    v_mul_hi_u32_u24 v14, 429497, v51
    v_lshrrev_b32 v12, 3, v55
    v_cos_f32 v10, v10
    v_lshlrev_b16 v13, 3, v55
    v_mad_i32_i24 v11, v14, s55, v51
    v_bitop3_b32 v12, v6, v13, v12 bitop3:0xca
    v_lshl_add_u32 v11, v11, 17, s40
    v_lshlrev_b16 v14, 8, v14
    v_lshrrev_b32 v13, 2, v55
    v_add_u32 v51, v12, v11
    v_bitop3_b32 v55, v5, v13, v14 bitop3:0xea
    ds_add_u32 v55, v2
    v_cvt_pk_bf16_f32 v45, v9, v10
    v_perm_b32 v12, v45, v45, s41
    v_bitop3_b32 v50, v4, v12, v50 bitop3:0xca
    v_perm_b32 v13, v45, v45, s42
    v_bitop3_b32 v51, v4, v13, v51 bitop3:0xca
    s_waitcnt vmcnt(2)
    v_lshlrev_b32 v7, 16, v46
    v_and_b32 v8, 0xffff0000, v46
    v_lshlrev_b32 v9, 16, v47
    v_and_b32 v10, 0xffff0000, v47
    v_mul_f32 v7, 0.15915494, v7
    v_mul_f32 v8, 0.15915494, v8
    v_mul_f32 v9, 0.15915494, v9
    v_mul_f32 v10, 0.15915494, v10
    v_mul_hi_u32_u24 v14, 429497, v56
    v_lshrrev_b32 v12, 3, v60
    v_cos_f32 v7, v7
    v_lshlrev_b16 v13, 3, v60
    v_mad_i32_i24 v11, v14, s55, v56
    v_bitop3_b32 v12, v6, v13, v12 bitop3:0xca
    v_lshl_add_u32 v11, v11, 17, s40
    v_lshlrev_b16 v14, 8, v14
    v_lshrrev_b32 v13, 2, v60
    v_add_u32 v56, v12, v11
    v_bitop3_b32 v60, v5, v13, v14 bitop3:0xea
    ds_add_u32 v60, v2
    v_mul_hi_u32_u24 v14, 429497, v57
    v_lshrrev_b32 v12, 3, v61
    v_cos_f32 v8, v8
    v_lshlrev_b16 v13, 3, v61
    v_mad_i32_i24 v11, v14, s55, v57
    v_bitop3_b32 v12, v6, v13, v12 bitop3:0xca
    v_lshl_add_u32 v11, v11, 17, s40
    v_lshlrev_b16 v14, 8, v14
    v_lshrrev_b32 v13, 2, v61
    v_add_u32 v57, v12, v11
    v_bitop3_b32 v61, v5, v13, v14 bitop3:0xea
    ds_add_u32 v61, v2
    v_cvt_pk_bf16_f32 v46, v7, v8
    v_perm_b32 v12, v46, v46, s41
    v_bitop3_b32 v56, v4, v12, v56 bitop3:0xca
    v_perm_b32 v13, v46, v46, s42
    v_bitop3_b32 v57, v4, v13, v57 bitop3:0xca
    v_mul_hi_u32_u24 v14, 429497, v58
    v_lshrrev_b32 v12, 3, v62
    v_cos_f32 v9, v9
    v_lshlrev_b16 v13, 3, v62
    v_mad_i32_i24 v11, v14, s55, v58
    v_bitop3_b32 v12, v6, v13, v12 bitop3:0xca
    v_lshl_add_u32 v11, v11, 17, s40
    v_lshlrev_b16 v14, 8, v14
    v_lshrrev_b32 v13, 2, v62
    v_add_u32 v58, v12, v11
    v_bitop3_b32 v62, v5, v13, v14 bitop3:0xea
    ds_add_u32 v62, v2
    v_mul_hi_u32_u24 v14, 429497, v59
    v_lshrrev_b32 v12, 3, v63
    v_cos_f32 v10, v10
    v_lshlrev_b16 v13, 3, v63
    v_mad_i32_i24 v11, v14, s55, v59
    v_bitop3_b32 v12, v6, v13, v12 bitop3:0xca
    v_lshl_add_u32 v11, v11, 17, s40
    v_lshlrev_b16 v14, 8, v14
    v_lshrrev_b32 v13, 2, v63
    v_add_u32 v59, v12, v11
    v_bitop3_b32 v63, v5, v13, v14 bitop3:0xea
    ds_add_u32 v63, v2
    v_cvt_pk_bf16_f32 v47, v9, v10
    v_perm_b32 v12, v47, v47, s41
    v_bitop3_b32 v58, v4, v12, v58 bitop3:0xca
    v_perm_b32 v13, v47, v47, s42
    v_bitop3_b32 v59, v4, v13, v59 bitop3:0xca
    v_lshrrev_b32 v8, 2, v0
    v_and_b32 v7, 0x3c00, v0
    v_bitop3_b32 v7, v5, v8, v7 bitop3:0xea
    s_waitcnt lgkmcnt(0)
    s_barrier
    ds_read2st64_b32 v[8:9], v7 offset0:0 offset1:1
    ds_read2st64_b32 v[10:11], v7 offset0:2 offset1:3
    s_add_u32 s45, s35, 0x4000
    s_add_u32 s45, s45, s91
    buffer_store_dwordx4 v[72:75], v0, s[20:23], s45 offen sc1
    s_add_u32 s46, s96, 0x4000000
    s_nop 0
    v_lshlrev_b32 v72, 1, v1
    buffer_load_dwordx4 v[72:75], v72, s[12:15], s46 offen nt
    s_waitcnt lgkmcnt(0)
    v_lshl_or_b32 v12, v9, 16, v8
    v_lshl_or_b32 v13, v11, 16, v10
    v_mov_b32 v14, v12
    v_mov_b32 v15, v13
    s_nop 0
    v_add_u32_dpp v14, v14, v14 row_shr:1 row_mask:0xf bank_mask:0xf bound_ctrl:1
    v_add_u32_dpp v15, v15, v15 row_shr:1 row_mask:0xf bank_mask:0xf bound_ctrl:1
    s_nop 0
    v_add_u32_dpp v14, v14, v14 row_shr:2 row_mask:0xf bank_mask:0xf bound_ctrl:1
    v_add_u32_dpp v15, v15, v15 row_shr:2 row_mask:0xf bank_mask:0xf bound_ctrl:1
    s_nop 0
    v_add_u32_dpp v14, v14, v14 row_shr:4 row_mask:0xf bank_mask:0xf bound_ctrl:1
    v_add_u32_dpp v15, v15, v15 row_shr:4 row_mask:0xf bank_mask:0xf bound_ctrl:1
    s_nop 0
    v_add_u32_dpp v14, v14, v14 row_shr:8 row_mask:0xf bank_mask:0xf bound_ctrl:1
    v_add_u32_dpp v15, v15, v15 row_shr:8 row_mask:0xf bank_mask:0xf bound_ctrl:1
    s_nop 0
    v_add_u32_dpp v14, v14, v14 row_bcast:15 row_mask:0xa bank_mask:0xf
    v_add_u32_dpp v15, v15, v15 row_bcast:15 row_mask:0xa bank_mask:0xf
    s_nop 0
    v_add_u32_dpp v14, v14, v14 row_bcast:31 row_mask:0xc bank_mask:0xf
    v_add_u32_dpp v15, v15, v15 row_bcast:31 row_mask:0xc bank_mask:0xf
    v_readlane_b32 s48, v14, 63
    v_readlane_b32 s49, v15, 63
    s_lshl_b32 s54, s32, 2
    v_mov_b32 v8, s54
    s_and_b32 s50, s48, 0xffff
    s_lshr_b32 s51, s48, 16
    s_and_b32 s52, s49, 0xffff
    s_lshr_b32 s53, s49, 16
    s_add_u32 s51, s51, s50
    s_add_u32 s52, s52, s51
    s_add_u32 s53, s53, s52
    v_mov_b32 v9, s53
    s_mov_b64 exec, 1
    ds_write_b32 v8, v9 offset:16384
    s_mov_b64 exec, -1
    v_and_b32 v8, 60, v7
    s_waitcnt lgkmcnt(0)
    s_barrier
    ds_read_b32 v9, v8 offset:16384
    s_waitcnt lgkmcnt(0)
    v_add_u32_dpp v9, v9, v9 row_shr:1 row_mask:0xf bank_mask:0xf bound_ctrl:1
    s_nop 1
    v_add_u32_dpp v9, v9, v9 row_shr:2 row_mask:0xf bank_mask:0xf bound_ctrl:1
    s_nop 1
    v_add_u32_dpp v9, v9, v9 row_shr:4 row_mask:0xf bank_mask:0xf bound_ctrl:1
    s_nop 1
    v_add_u32_dpp v9, v9, v9 row_shr:8 row_mask:0xf bank_mask:0xf bound_ctrl:1
    s_nop 0
    v_readlane_b32 s54, v9, s32
    s_sub_u32 s54, s54, s53
    s_add_u32 s50, s50, s54
    s_add_u32 s51, s51, s54
    s_add_u32 s52, s52, s54
    s_pack_ll_b32_b16 s48, s54, s50
    s_pack_ll_b32_b16 s49, s51, s52
    v_add_u32 v14, s48, v14
    v_add_u32 v15, s49, v15
    v_sub_u32 v12, v14, v12
    v_sub_u32 v13, v15, v13
    v_and_b32 v8, 0xffff, v12
    v_lshrrev_b32 v9, 16, v12
    v_and_b32 v10, 0xffff, v13
    v_lshrrev_b32 v11, 16, v13
    ds_write2st64_b32 v7, v8, v9 offset0:0 offset1:1
    ds_write2st64_b32 v7, v10, v11 offset0:2 offset1:3
    v_and_b32 v8, 0x3f0, v0
    v_lshl_add_u32 v8, v8, 1, s36
    ds_write_b64 v8, v[12:13] offset:20480
    s_bitset0_b64 exec, 63
    s_not_b64 exec, exec
    ds_write_b64 v8, v[14:15] offset:20512
    s_mov_b64 exec, -1
    s_waitcnt lgkmcnt(0)
    s_barrier
    s_setprio 3
    ds_add_rtn_u32 v104, v104, v2
    ds_add_rtn_u32 v105, v105, v2
    ds_add_rtn_u32 v106, v106, v2
    ds_add_rtn_u32 v107, v107, v2
    ds_read_b128 v[12:15], v0 offset:20480
    v_cmp_gt_u32 vcc, 8448, v0
    s_add_u32 s47, s35, 0x4000
    s_add_u32 s47, s47, s93
    buffer_store_dwordx4 v[64:67], v0, s[20:23], s47 offen sc1
    s_add_u32 s44, s96, 0x4000000
    s_lshr_b32 s44, s44, 1
    buffer_load_dwordx2 v[64:65], v1, s[16:19], s44 offen nt
    s_add_u32 s45, s96, 0x4400000
    s_lshr_b32 s45, s45, 1
    buffer_load_dwordx2 v[66:67], v1, s[16:19], s45 offen nt
    ds_add_rtn_u32 v112, v112, v2
    ds_add_rtn_u32 v113, v113, v2
    ds_add_rtn_u32 v114, v114, v2
    ds_add_rtn_u32 v115, v115, v2
    s_setprio 2
    ds_add_rtn_u32 v120, v120, v2
    ds_add_rtn_u32 v121, v121, v2
    ds_add_rtn_u32 v122, v122, v2
    ds_add_rtn_u32 v123, v123, v2
    s_waitcnt lgkmcnt(8)
    s_cbranch_vccz L1_p2
    s_add_u32 s46, s35, 0x2a40000
    s_mov_b64 exec, vcc
    buffer_store_dwordx4 v[12:15], v0, s[24:27], s46 offen sc1
    s_mov_b64 exec, -1
L1_p2:
    s_add_u32 s47, s35, 0x8000
    s_add_u32 s47, s47, s72
    buffer_store_dwordx4 v[76:79], v0, s[20:23], s47 offen sc1
    s_add_u32 s44, s96, 0x4400000
    s_nop 0
    v_lshlrev_b32 v76, 1, v1
    buffer_load_dwordx4 v[76:79], v76, s[8:11], s44 offen nt
    ds_add_rtn_u32 v20, v20, v2
    ds_add_rtn_u32 v21, v21, v2
    ds_add_rtn_u32 v22, v22, v2
    ds_add_rtn_u32 v23, v23, v2
    s_setprio 1
    ds_add_rtn_u32 v32, v32, v2
    ds_add_rtn_u32 v33, v33, v2
    ds_add_rtn_u32 v34, v34, v2
    ds_add_rtn_u32 v35, v35, v2
    ds_add_rtn_u32 v40, v40, v2
    ds_add_rtn_u32 v41, v41, v2
    ds_add_rtn_u32 v42, v42, v2
    ds_add_rtn_u32 v43, v43, v2
    s_add_u32 s45, s35, 0x8000
    s_add_u32 s45, s45, s73
    buffer_store_dwordx4 v[80:83], v0, s[20:23], s45 offen sc1
    s_add_u32 s46, s96, 0x4400000
    s_nop 0
    v_lshlrev_b32 v80, 1, v1
    buffer_load_dwordx4 v[80:83], v80, s[12:15], s46 offen nt
    s_setprio 0
    ds_add_rtn_u32 v52, v52, v2
    ds_add_rtn_u32 v53, v53, v2
    ds_add_rtn_u32 v54, v54, v2
    ds_add_rtn_u32 v55, v55, v2
    ds_add_rtn_u32 v60, v60, v2
    ds_add_rtn_u32 v61, v61, v2
    ds_add_rtn_u32 v62, v62, v2
    ds_add_rtn_u32 v63, v63, v2
    s_waitcnt lgkmcnt(0)
    s_barrier
    s_setprio 3
    v_and_b32 v7, -4, v104
    v_lshl_add_u32 v8, v104, 2, v7
    ds_write_b32 v8, v96
    v_lshl_add_u32 v7, v7, 2, v104
    ds_write_b8 v7, v108 offset:16
    v_and_b32 v9, -4, v105
    v_lshl_add_u32 v10, v105, 2, v9
    ds_write_b32 v10, v97
    v_lshl_add_u32 v9, v9, 2, v105
    ds_write_b8_d16_hi v9, v108 offset:16
    v_and_b32 v7, -4, v106
    v_lshl_add_u32 v8, v106, 2, v7
    ds_write_b32 v8, v98
    v_lshl_add_u32 v7, v7, 2, v106
    ds_write_b8 v7, v109 offset:16
    v_and_b32 v9, -4, v107
    v_lshl_add_u32 v10, v107, 2, v9
    ds_write_b32 v10, v99
    v_lshl_add_u32 v9, v9, 2, v107
    ds_write_b8_d16_hi v9, v109 offset:16
    s_add_u32 s47, s35, 0x8000
    s_add_u32 s47, s47, s85
    buffer_store_dwordx4 v[88:91], v0, s[20:23], s47 offen sc1
    s_add_u32 s44, s96, 0x4800000
    v_lshlrev_b32 v96, 1, v1
    buffer_load_dwordx4 v[96:99], v96, s[8:11], s44 offen nt
    s_add_u32 s45, s96, 0x4800000
    v_lshlrev_b32 v104, 1, v1
    buffer_load_dwordx4 v[104:107], v104, s[12:15], s45 offen nt
    v_and_b32 v7, -4, v112
    v_lshl_add_u32 v8, v112, 2, v7
    ds_write_b32 v8, v100
    v_lshl_add_u32 v7, v7, 2, v112
    ds_write_b8 v7, v110 offset:16
    v_and_b32 v9, -4, v113
    v_lshl_add_u32 v10, v113, 2, v9
    ds_write_b32 v10, v101
    v_lshl_add_u32 v9, v9, 2, v113
    ds_write_b8_d16_hi v9, v110 offset:16
    v_and_b32 v7, -4, v114
    v_lshl_add_u32 v8, v114, 2, v7
    ds_write_b32 v8, v102
    v_lshl_add_u32 v7, v7, 2, v114
    ds_write_b8 v7, v111 offset:16
    v_and_b32 v9, -4, v115
    v_lshl_add_u32 v10, v115, 2, v9
    ds_write_b32 v10, v103
    v_lshl_add_u32 v9, v9, 2, v115
    ds_write_b8_d16_hi v9, v111 offset:16
    s_add_u32 s46, s96, 0x4800000
    s_lshr_b32 s46, s46, 1
    buffer_load_dwordx2 v[88:89], v1, s[16:19], s46 offen nt
    s_add_u32 s47, s96, 0x4c00000
    s_lshr_b32 s47, s47, 1
    buffer_load_dwordx2 v[90:91], v1, s[16:19], s47 offen nt
    s_add_u32 s44, s96, 0x4c00000
    v_lshlrev_b32 v100, 1, v1
    buffer_load_dwordx4 v[100:103], v100, s[8:11], s44 offen nt
    s_waitcnt vmcnt(10)
    v_lshlrev_b32 v7, 16, v64
    v_and_b32 v8, 0xffff0000, v64
    v_lshlrev_b32 v9, 16, v65
    v_and_b32 v10, 0xffff0000, v65
    v_mul_f32 v7, 0.15915494, v7
    v_mul_f32 v8, 0.15915494, v8
    v_mul_f32 v9, 0.15915494, v9
    v_mul_f32 v10, 0.15915494, v10
    v_mul_hi_u32_u24 v14, 429497, v68
    v_lshrrev_b32 v12, 3, v72
    v_cos_f32 v7, v7
    v_lshlrev_b16 v13, 3, v72
    v_mad_i32_i24 v11, v14, s55, v68
    v_bitop3_b32 v12, v6, v13, v12 bitop3:0xca
    v_lshl_add_u32 v11, v11, 17, s40
    v_lshlrev_b16 v14, 8, v14
    v_lshrrev_b32 v13, 2, v72
    v_add_u32 v68, v12, v11
    v_bitop3_b32 v72, v5, v13, v14 bitop3:0xea
    v_mul_hi_u32_u24 v14, 429497, v69
    v_lshrrev_b32 v12, 3, v73
    v_cos_f32 v8, v8
    v_lshlrev_b16 v13, 3, v73
    v_mad_i32_i24 v11, v14, s55, v69
    v_bitop3_b32 v12, v6, v13, v12 bitop3:0xca
    v_lshl_add_u32 v11, v11, 17, s40
    v_lshlrev_b16 v14, 8, v14
    v_lshrrev_b32 v13, 2, v73
    v_add_u32 v69, v12, v11
    v_bitop3_b32 v73, v5, v13, v14 bitop3:0xea
    v_cvt_pk_bf16_f32 v64, v7, v8
    v_perm_b32 v12, v64, v64, s41
    v_bitop3_b32 v68, v4, v12, v68 bitop3:0xca
    v_perm_b32 v13, v64, v64, s42
    v_bitop3_b32 v69, v4, v13, v69 bitop3:0xca
    v_mul_hi_u32_u24 v14, 429497, v70
    v_lshrrev_b32 v12, 3, v74
    v_cos_f32 v9, v9
    v_lshlrev_b16 v13, 3, v74
    v_mad_i32_i24 v11, v14, s55, v70
    v_bitop3_b32 v12, v6, v13, v12 bitop3:0xca
    v_lshl_add_u32 v11, v11, 17, s40
    v_lshlrev_b16 v14, 8, v14
    v_lshrrev_b32 v13, 2, v74
    v_add_u32 v70, v12, v11
    v_bitop3_b32 v74, v5, v13, v14 bitop3:0xea
    v_mul_hi_u32_u24 v14, 429497, v71
    v_lshrrev_b32 v12, 3, v75
    v_cos_f32 v10, v10
    v_lshlrev_b16 v13, 3, v75
    v_mad_i32_i24 v11, v14, s55, v71
    v_bitop3_b32 v12, v6, v13, v12 bitop3:0xca
    v_lshl_add_u32 v11, v11, 17, s40
    v_lshlrev_b16 v14, 8, v14
    v_lshrrev_b32 v13, 2, v75
    v_add_u32 v71, v12, v11
    v_bitop3_b32 v75, v5, v13, v14 bitop3:0xea
    v_cvt_pk_bf16_f32 v65, v9, v10
    v_perm_b32 v12, v65, v65, s41
    v_bitop3_b32 v70, v4, v12, v70 bitop3:0xca
    v_perm_b32 v13, v65, v65, s42
    v_bitop3_b32 v71, v4, v13, v71 bitop3:0xca
    s_setprio 2
    v_and_b32 v7, -4, v120
    v_lshl_add_u32 v8, v120, 2, v7
    ds_write_b32 v8, v116
    v_lshl_add_u32 v7, v7, 2, v120
    ds_write_b8 v7, v124 offset:16
    v_and_b32 v9, -4, v121
    v_lshl_add_u32 v10, v121, 2, v9
    ds_write_b32 v10, v117
    v_lshl_add_u32 v9, v9, 2, v121
    ds_write_b8_d16_hi v9, v124 offset:16
    v_and_b32 v7, -4, v122
    v_lshl_add_u32 v8, v122, 2, v7
    ds_write_b32 v8, v118
    v_lshl_add_u32 v7, v7, 2, v122
    ds_write_b8 v7, v125 offset:16
    v_and_b32 v9, -4, v123
    v_lshl_add_u32 v10, v123, 2, v9
    ds_write_b32 v10, v119
    v_lshl_add_u32 v9, v9, 2, v123
    ds_write_b8_d16_hi v9, v125 offset:16
    s_add_u32 s45, s35, 0x8000
    s_add_u32 s45, s45, s91
    buffer_store_dwordx4 v[92:95], v0, s[20:23], s45 offen sc1
    s_add_u32 s46, s96, 0x4c00000
    v_lshlrev_b32 v112, 1, v1
    buffer_load_dwordx4 v[112:115], v112, s[12:15], s46 offen nt
    s_waitcnt vmcnt(8)
    v_lshlrev_b32 v7, 16, v66
    v_and_b32 v8, 0xffff0000, v66
    v_lshlrev_b32 v9, 16, v67
    v_and_b32 v10, 0xffff0000, v67
    v_mul_f32 v7, 0.15915494, v7
    v_mul_f32 v8, 0.15915494, v8
    v_mul_f32 v9, 0.15915494, v9
    v_mul_f32 v10, 0.15915494, v10
    v_mul_hi_u32_u24 v14, 429497, v76
    v_lshrrev_b32 v12, 3, v80
    v_cos_f32 v7, v7
    v_lshlrev_b16 v13, 3, v80
    v_mad_i32_i24 v11, v14, s55, v76
    v_bitop3_b32 v12, v6, v13, v12 bitop3:0xca
    v_lshl_add_u32 v11, v11, 17, s40
    v_lshlrev_b16 v14, 8, v14
    v_lshrrev_b32 v13, 2, v80
    v_add_u32 v76, v12, v11
    v_bitop3_b32 v80, v5, v13, v14 bitop3:0xea
    v_mul_hi_u32_u24 v14, 429497, v77
    v_lshrrev_b32 v12, 3, v81
    v_cos_f32 v8, v8
    v_lshlrev_b16 v13, 3, v81
    v_mad_i32_i24 v11, v14, s55, v77
    v_bitop3_b32 v12, v6, v13, v12 bitop3:0xca
    v_lshl_add_u32 v11, v11, 17, s40
    v_lshlrev_b16 v14, 8, v14
    v_lshrrev_b32 v13, 2, v81
    v_add_u32 v77, v12, v11
    v_bitop3_b32 v81, v5, v13, v14 bitop3:0xea
    v_cvt_pk_bf16_f32 v66, v7, v8
    v_perm_b32 v12, v66, v66, s41
    v_bitop3_b32 v76, v4, v12, v76 bitop3:0xca
    v_perm_b32 v13, v66, v66, s42
    v_bitop3_b32 v77, v4, v13, v77 bitop3:0xca
    v_mul_hi_u32_u24 v14, 429497, v78
    v_lshrrev_b32 v12, 3, v82
    v_cos_f32 v9, v9
    v_lshlrev_b16 v13, 3, v82
    v_mad_i32_i24 v11, v14, s55, v78
    v_bitop3_b32 v12, v6, v13, v12 bitop3:0xca
    v_lshl_add_u32 v11, v11, 17, s40
    v_lshlrev_b16 v14, 8, v14
    v_lshrrev_b32 v13, 2, v82
    v_add_u32 v78, v12, v11
    v_bitop3_b32 v82, v5, v13, v14 bitop3:0xea
    v_mul_hi_u32_u24 v14, 429497, v79
    v_lshrrev_b32 v12, 3, v83
    v_cos_f32 v10, v10
    v_lshlrev_b16 v13, 3, v83
    v_mad_i32_i24 v11, v14, s55, v79
    v_bitop3_b32 v12, v6, v13, v12 bitop3:0xca
    v_lshl_add_u32 v11, v11, 17, s40
    v_lshlrev_b16 v14, 8, v14
    v_lshrrev_b32 v13, 2, v83
    v_add_u32 v79, v12, v11
    v_bitop3_b32 v83, v5, v13, v14 bitop3:0xea
    v_cvt_pk_bf16_f32 v67, v9, v10
    v_perm_b32 v12, v67, v67, s41
    v_bitop3_b32 v78, v4, v12, v78 bitop3:0xca
    v_perm_b32 v13, v67, v67, s42
    v_bitop3_b32 v79, v4, v13, v79 bitop3:0xca
    v_and_b32 v7, -4, v20
    v_lshl_add_u32 v8, v20, 2, v7
    ds_write_b32 v8, v16
    v_lshl_add_u32 v7, v7, 2, v20
    ds_write_b8 v7, v126 offset:16
    v_and_b32 v9, -4, v21
    v_lshl_add_u32 v10, v21, 2, v9
    ds_write_b32 v10, v17
    v_lshl_add_u32 v9, v9, 2, v21
    ds_write_b8_d16_hi v9, v126 offset:16
    v_and_b32 v7, -4, v22
    v_lshl_add_u32 v8, v22, 2, v7
    ds_write_b32 v8, v18
    v_lshl_add_u32 v7, v7, 2, v22
    ds_write_b8 v7, v127 offset:16
    v_and_b32 v9, -4, v23
    v_lshl_add_u32 v10, v23, 2, v9
    ds_write_b32 v10, v19
    v_lshl_add_u32 v9, v9, 2, v23
    ds_write_b8_d16_hi v9, v127 offset:16
    s_add_u32 s47, s96, 0x5000000
    v_lshlrev_b32 v108, 1, v1
    buffer_load_dwordx4 v[108:111], v108, s[8:11], s47 offen nt
    s_add_u32 s44, s96, 0x5000000
    v_lshlrev_b32 v116, 1, v1
    buffer_load_dwordx4 v[116:119], v116, s[12:15], s44 offen nt
    s_waitcnt vmcnt(5)
    v_lshlrev_b32 v7, 16, v88
    v_and_b32 v8, 0xffff0000, v88
    v_lshlrev_b32 v9, 16, v89
    v_and_b32 v10, 0xffff0000, v89
    v_mul_f32 v7, 0.15915494, v7
    v_mul_f32 v8, 0.15915494, v8
    v_mul_f32 v9, 0.15915494, v9
    v_mul_f32 v10, 0.15915494, v10
    v_mul_hi_u32_u24 v14, 429497, v96
    v_lshrrev_b32 v12, 3, v104
    v_cos_f32 v7, v7
    v_lshlrev_b16 v13, 3, v104
    v_mad_i32_i24 v11, v14, s55, v96
    v_bitop3_b32 v12, v6, v13, v12 bitop3:0xca
    v_lshl_add_u32 v11, v11, 17, s40
    v_lshlrev_b16 v14, 8, v14
    v_lshrrev_b32 v13, 2, v104
    v_add_u32 v96, v12, v11
    v_bitop3_b32 v104, v5, v13, v14 bitop3:0xea
    v_mul_hi_u32_u24 v14, 429497, v97
    v_lshrrev_b32 v12, 3, v105
    v_cos_f32 v8, v8
    v_lshlrev_b16 v13, 3, v105
    v_mad_i32_i24 v11, v14, s55, v97
    v_bitop3_b32 v12, v6, v13, v12 bitop3:0xca
    v_lshl_add_u32 v11, v11, 17, s40
    v_lshlrev_b16 v14, 8, v14
    v_lshrrev_b32 v13, 2, v105
    v_add_u32 v97, v12, v11
    v_bitop3_b32 v105, v5, v13, v14 bitop3:0xea
    v_cvt_pk_bf16_f32 v88, v7, v8
    v_perm_b32 v12, v88, v88, s41
    v_bitop3_b32 v96, v4, v12, v96 bitop3:0xca
    v_perm_b32 v13, v88, v88, s42
    v_bitop3_b32 v97, v4, v13, v97 bitop3:0xca
    v_mul_hi_u32_u24 v14, 429497, v98
    v_lshrrev_b32 v12, 3, v106
    v_cos_f32 v9, v9
    v_lshlrev_b16 v13, 3, v106
    v_mad_i32_i24 v11, v14, s55, v98
    v_bitop3_b32 v12, v6, v13, v12 bitop3:0xca
    v_lshl_add_u32 v11, v11, 17, s40
    v_lshlrev_b16 v14, 8, v14
    v_lshrrev_b32 v13, 2, v106
    v_add_u32 v98, v12, v11
    v_bitop3_b32 v106, v5, v13, v14 bitop3:0xea
    v_mul_hi_u32_u24 v14, 429497, v99
    v_lshrrev_b32 v12, 3, v107
    v_cos_f32 v10, v10
    v_lshlrev_b16 v13, 3, v107
    v_mad_i32_i24 v11, v14, s55, v99
    v_bitop3_b32 v12, v6, v13, v12 bitop3:0xca
    v_lshl_add_u32 v11, v11, 17, s40
    v_lshlrev_b16 v14, 8, v14
    v_lshrrev_b32 v13, 2, v107
    v_add_u32 v99, v12, v11
    v_bitop3_b32 v107, v5, v13, v14 bitop3:0xea
    v_cvt_pk_bf16_f32 v89, v9, v10
    v_perm_b32 v12, v89, v89, s41
    v_bitop3_b32 v98, v4, v12, v98 bitop3:0xca
    v_perm_b32 v13, v89, v89, s42
    v_bitop3_b32 v99, v4, v13, v99 bitop3:0xca
    s_setprio 1
    v_and_b32 v7, -4, v32
    v_lshl_add_u32 v8, v32, 2, v7
    ds_write_b32 v8, v28
    v_lshl_add_u32 v7, v7, 2, v32
    ds_write_b8 v7, v24 offset:16
    v_and_b32 v9, -4, v33
    v_lshl_add_u32 v10, v33, 2, v9
    ds_write_b32 v10, v29
    v_lshl_add_u32 v9, v9, 2, v33
    ds_write_b8_d16_hi v9, v24 offset:16
    v_and_b32 v7, -4, v34
    v_lshl_add_u32 v8, v34, 2, v7
    ds_write_b32 v8, v30
    v_lshl_add_u32 v7, v7, 2, v34
    ds_write_b8 v7, v25 offset:16
    v_and_b32 v9, -4, v35
    v_lshl_add_u32 v10, v35, 2, v9
    ds_write_b32 v10, v31
    v_lshl_add_u32 v9, v9, 2, v35
    ds_write_b8_d16_hi v9, v25 offset:16
    s_add_u32 s45, s96, 0x5000000
    s_lshr_b32 s45, s45, 1
    buffer_load_dwordx2 v[120:121], v1, s[16:19], s45 offen nt
    s_add_u32 s46, s96, 0x5400000
    s_lshr_b32 s46, s46, 1
    buffer_load_dwordx2 v[122:123], v1, s[16:19], s46 offen nt
    s_add_u32 s47, s96, 0x5400000
    v_lshlrev_b32 v92, 1, v1
    buffer_load_dwordx4 v[92:95], v92, s[8:11], s47 offen nt
    v_and_b32 v7, -4, v40
    v_lshl_add_u32 v8, v40, 2, v7
    ds_write_b32 v8, v36
    v_lshl_add_u32 v7, v7, 2, v40
    ds_write_b8 v7, v26 offset:16
    v_and_b32 v9, -4, v41
    v_lshl_add_u32 v10, v41, 2, v9
    ds_write_b32 v10, v37
    v_lshl_add_u32 v9, v9, 2, v41
    ds_write_b8_d16_hi v9, v26 offset:16
    v_and_b32 v7, -4, v42
    v_lshl_add_u32 v8, v42, 2, v7
    ds_write_b32 v8, v38
    v_lshl_add_u32 v7, v7, 2, v42
    ds_write_b8 v7, v27 offset:16
    v_and_b32 v9, -4, v43
    v_lshl_add_u32 v10, v43, 2, v9
    ds_write_b32 v10, v39
    v_lshl_add_u32 v9, v9, 2, v43
    ds_write_b8_d16_hi v9, v27 offset:16
    s_add_u32 s44, s35, 0x8000
    s_add_u32 s44, s44, s93
    buffer_store_dwordx4 v[84:87], v0, s[20:23], s44 offen sc1
    s_add_u32 s45, s96, 0x5400000
    v_lshlrev_b32 v16, 1, v1
    buffer_load_dwordx4 v[16:19], v16, s[12:15], s45 offen nt
    s_waitcnt vmcnt(7)
    v_lshlrev_b32 v7, 16, v90
    v_and_b32 v8, 0xffff0000, v90
    v_lshlrev_b32 v9, 16, v91
    v_and_b32 v10, 0xffff0000, v91
    v_mul_f32 v7, 0.15915494, v7
    v_mul_f32 v8, 0.15915494, v8
    v_mul_f32 v9, 0.15915494, v9
    v_mul_f32 v10, 0.15915494, v10
    v_mul_hi_u32_u24 v14, 429497, v100
    v_lshrrev_b32 v12, 3, v112
    v_cos_f32 v7, v7
    v_lshlrev_b16 v13, 3, v112
    v_mad_i32_i24 v11, v14, s55, v100
    v_bitop3_b32 v12, v6, v13, v12 bitop3:0xca
    v_lshl_add_u32 v11, v11, 17, s40
    v_lshlrev_b16 v14, 8, v14
    v_lshrrev_b32 v13, 2, v112
    v_add_u32 v100, v12, v11
    v_bitop3_b32 v112, v5, v13, v14 bitop3:0xea
    v_mul_hi_u32_u24 v14, 429497, v101
    v_lshrrev_b32 v12, 3, v113
    v_cos_f32 v8, v8
    v_lshlrev_b16 v13, 3, v113
    v_mad_i32_i24 v11, v14, s55, v101
    v_bitop3_b32 v12, v6, v13, v12 bitop3:0xca
    v_lshl_add_u32 v11, v11, 17, s40
    v_lshlrev_b16 v14, 8, v14
    v_lshrrev_b32 v13, 2, v113
    v_add_u32 v101, v12, v11
    v_bitop3_b32 v113, v5, v13, v14 bitop3:0xea
    v_cvt_pk_bf16_f32 v90, v7, v8
    v_perm_b32 v12, v90, v90, s41
    v_bitop3_b32 v100, v4, v12, v100 bitop3:0xca
    v_perm_b32 v13, v90, v90, s42
    v_bitop3_b32 v101, v4, v13, v101 bitop3:0xca
    v_mul_hi_u32_u24 v14, 429497, v102
    v_lshrrev_b32 v12, 3, v114
    v_cos_f32 v9, v9
    v_lshlrev_b16 v13, 3, v114
    v_mad_i32_i24 v11, v14, s55, v102
    v_bitop3_b32 v12, v6, v13, v12 bitop3:0xca
    v_lshl_add_u32 v11, v11, 17, s40
    v_lshlrev_b16 v14, 8, v14
    v_lshrrev_b32 v13, 2, v114
    v_add_u32 v102, v12, v11
    v_bitop3_b32 v114, v5, v13, v14 bitop3:0xea
    v_mul_hi_u32_u24 v14, 429497, v103
    v_lshrrev_b32 v12, 3, v115
    v_cos_f32 v10, v10
    v_lshlrev_b16 v13, 3, v115
    v_mad_i32_i24 v11, v14, s55, v103
    v_bitop3_b32 v12, v6, v13, v12 bitop3:0xca
    v_lshl_add_u32 v11, v11, 17, s40
    v_lshlrev_b16 v14, 8, v14
    v_lshrrev_b32 v13, 2, v115
    v_add_u32 v103, v12, v11
    v_bitop3_b32 v115, v5, v13, v14 bitop3:0xea
    v_cvt_pk_bf16_f32 v91, v9, v10
    v_perm_b32 v12, v91, v91, s41
    v_bitop3_b32 v102, v4, v12, v102 bitop3:0xca
    v_perm_b32 v13, v91, v91, s42
    v_bitop3_b32 v103, v4, v13, v103 bitop3:0xca
    s_setprio 0
    v_and_b32 v7, -4, v52
    v_lshl_add_u32 v8, v52, 2, v7
    ds_write_b32 v8, v48
    v_lshl_add_u32 v7, v7, 2, v52
    ds_write_b8 v7, v44 offset:16
    v_and_b32 v9, -4, v53
    v_lshl_add_u32 v10, v53, 2, v9
    ds_write_b32 v10, v49
    v_lshl_add_u32 v9, v9, 2, v53
    ds_write_b8_d16_hi v9, v44 offset:16
    v_and_b32 v7, -4, v54
    v_lshl_add_u32 v8, v54, 2, v7
    ds_write_b32 v8, v50
    v_lshl_add_u32 v7, v7, 2, v54
    ds_write_b8 v7, v45 offset:16
    v_and_b32 v9, -4, v55
    v_lshl_add_u32 v10, v55, 2, v9
    ds_write_b32 v10, v51
    v_lshl_add_u32 v9, v9, 2, v55
    ds_write_b8_d16_hi v9, v45 offset:16
    s_add_u32 s46, s96, 0x5800000
    v_lshlrev_b32 v20, 1, v1
    buffer_load_dwordx4 v[20:23], v20, s[8:11], s46 offen nt
    s_add_u32 s47, s96, 0x5800000
    v_lshlrev_b32 v124, 1, v1
    buffer_load_dwordx4 v[124:127], v124, s[12:15], s47 offen nt
    s_waitcnt vmcnt(5)
    v_lshlrev_b32 v7, 16, v120
    v_and_b32 v8, 0xffff0000, v120
    v_lshlrev_b32 v9, 16, v121
    v_and_b32 v10, 0xffff0000, v121
    v_mul_f32 v7, 0.15915494, v7
    v_mul_f32 v8, 0.15915494, v8
    v_mul_f32 v9, 0.15915494, v9
    v_mul_f32 v10, 0.15915494, v10
    v_mul_hi_u32_u24 v14, 429497, v108
    v_lshrrev_b32 v12, 3, v116
    v_cos_f32 v7, v7
    v_lshlrev_b16 v13, 3, v116
    v_mad_i32_i24 v11, v14, s55, v108
    v_bitop3_b32 v12, v6, v13, v12 bitop3:0xca
    v_lshl_add_u32 v11, v11, 17, s40
    v_lshlrev_b16 v14, 8, v14
    v_lshrrev_b32 v13, 2, v116
    v_add_u32 v108, v12, v11
    v_bitop3_b32 v116, v5, v13, v14 bitop3:0xea
    v_mul_hi_u32_u24 v14, 429497, v109
    v_lshrrev_b32 v12, 3, v117
    v_cos_f32 v8, v8
    v_lshlrev_b16 v13, 3, v117
    v_mad_i32_i24 v11, v14, s55, v109
    v_bitop3_b32 v12, v6, v13, v12 bitop3:0xca
    v_lshl_add_u32 v11, v11, 17, s40
    v_lshlrev_b16 v14, 8, v14
    v_lshrrev_b32 v13, 2, v117
    v_add_u32 v109, v12, v11
    v_bitop3_b32 v117, v5, v13, v14 bitop3:0xea
    v_cvt_pk_bf16_f32 v120, v7, v8
    v_perm_b32 v12, v120, v120, s41
    v_bitop3_b32 v108, v4, v12, v108 bitop3:0xca
    v_perm_b32 v13, v120, v120, s42
    v_bitop3_b32 v109, v4, v13, v109 bitop3:0xca
    v_mul_hi_u32_u24 v14, 429497, v110
    v_lshrrev_b32 v12, 3, v118
    v_cos_f32 v9, v9
    v_lshlrev_b16 v13, 3, v118
    v_mad_i32_i24 v11, v14, s55, v110
    v_bitop3_b32 v12, v6, v13, v12 bitop3:0xca
    v_lshl_add_u32 v11, v11, 17, s40
    v_lshlrev_b16 v14, 8, v14
    v_lshrrev_b32 v13, 2, v118
    v_add_u32 v110, v12, v11
    v_bitop3_b32 v118, v5, v13, v14 bitop3:0xea
    v_mul_hi_u32_u24 v14, 429497, v111
    v_lshrrev_b32 v12, 3, v119
    v_cos_f32 v10, v10
    v_lshlrev_b16 v13, 3, v119
    v_mad_i32_i24 v11, v14, s55, v111
    v_bitop3_b32 v12, v6, v13, v12 bitop3:0xca
    v_lshl_add_u32 v11, v11, 17, s40
    v_lshlrev_b16 v14, 8, v14
    v_lshrrev_b32 v13, 2, v119
    v_add_u32 v111, v12, v11
    v_bitop3_b32 v119, v5, v13, v14 bitop3:0xea
    v_cvt_pk_bf16_f32 v121, v9, v10
    v_perm_b32 v12, v121, v121, s41
    v_bitop3_b32 v110, v4, v12, v110 bitop3:0xca
    v_perm_b32 v13, v121, v121, s42
    v_bitop3_b32 v111, v4, v13, v111 bitop3:0xca
    v_and_b32 v7, -4, v60
    v_lshl_add_u32 v8, v60, 2, v7
    ds_write_b32 v8, v56
    v_lshl_add_u32 v7, v7, 2, v60
    ds_write_b8 v7, v46 offset:16
    v_and_b32 v9, -4, v61
    v_lshl_add_u32 v10, v61, 2, v9
    ds_write_b32 v10, v57
    v_lshl_add_u32 v9, v9, 2, v61
    ds_write_b8_d16_hi v9, v46 offset:16
    v_and_b32 v7, -4, v62
    v_lshl_add_u32 v8, v62, 2, v7
    ds_write_b32 v8, v58
    v_lshl_add_u32 v7, v7, 2, v62
    ds_write_b8 v7, v47 offset:16
    v_and_b32 v9, -4, v63
    v_lshl_add_u32 v10, v63, 2, v9
    ds_write_b32 v10, v59
    v_lshl_add_u32 v9, v9, 2, v63
    ds_write_b8_d16_hi v9, v47 offset:16
    s_add_u32 s44, s96, 0x5800000
    s_lshr_b32 s44, s44, 1
    buffer_load_dwordx2 v[28:29], v1, s[16:19], s44 offen nt
    s_add_u32 s45, s96, 0x5c00000
    s_lshr_b32 s45, s45, 1
    buffer_load_dwordx2 v[30:31], v1, s[16:19], s45 offen nt
    s_waitcnt vmcnt(4)
    v_lshlrev_b32 v7, 16, v122
    v_and_b32 v8, 0xffff0000, v122
    v_lshlrev_b32 v9, 16, v123
    v_and_b32 v10, 0xffff0000, v123
    v_mul_f32 v7, 0.15915494, v7
    v_mul_f32 v8, 0.15915494, v8
    v_mul_f32 v9, 0.15915494, v9
    v_mul_f32 v10, 0.15915494, v10
    v_mul_hi_u32_u24 v14, 429497, v92
    v_lshrrev_b32 v12, 3, v16
    v_cos_f32 v7, v7
    v_lshlrev_b16 v13, 3, v16
    v_mad_i32_i24 v11, v14, s55, v92
    v_bitop3_b32 v12, v6, v13, v12 bitop3:0xca
    v_lshl_add_u32 v11, v11, 17, s40
    v_lshlrev_b16 v14, 8, v14
    v_lshrrev_b32 v13, 2, v16
    v_add_u32 v92, v12, v11
    v_bitop3_b32 v16, v5, v13, v14 bitop3:0xea
    v_mul_hi_u32_u24 v14, 429497, v93
    v_lshrrev_b32 v12, 3, v17
    v_cos_f32 v8, v8
    v_lshlrev_b16 v13, 3, v17
    v_mad_i32_i24 v11, v14, s55, v93
    v_bitop3_b32 v12, v6, v13, v12 bitop3:0xca
    v_lshl_add_u32 v11, v11, 17, s40
    v_lshlrev_b16 v14, 8, v14
    v_lshrrev_b32 v13, 2, v17
    v_add_u32 v93, v12, v11
    v_bitop3_b32 v17, v5, v13, v14 bitop3:0xea
    v_cvt_pk_bf16_f32 v122, v7, v8
    v_perm_b32 v12, v122, v122, s41
    v_bitop3_b32 v92, v4, v12, v92 bitop3:0xca
    v_perm_b32 v13, v122, v122, s42
    v_bitop3_b32 v93, v4, v13, v93 bitop3:0xca
    v_mul_hi_u32_u24 v14, 429497, v94
    v_lshrrev_b32 v12, 3, v18
    v_cos_f32 v9, v9
    v_lshlrev_b16 v13, 3, v18
    v_mad_i32_i24 v11, v14, s55, v94
    v_bitop3_b32 v12, v6, v13, v12 bitop3:0xca
    v_lshl_add_u32 v11, v11, 17, s40
    v_lshlrev_b16 v14, 8, v14
    v_lshrrev_b32 v13, 2, v18
    v_add_u32 v94, v12, v11
    v_bitop3_b32 v18, v5, v13, v14 bitop3:0xea
    v_mul_hi_u32_u24 v14, 429497, v95
    v_lshrrev_b32 v12, 3, v19
    v_cos_f32 v10, v10
    v_lshlrev_b16 v13, 3, v19
    v_mad_i32_i24 v11, v14, s55, v95
    v_bitop3_b32 v12, v6, v13, v12 bitop3:0xca
    v_lshl_add_u32 v11, v11, 17, s40
    v_lshlrev_b16 v14, 8, v14
    v_lshrrev_b32 v13, 2, v19
    v_add_u32 v95, v12, v11
    v_bitop3_b32 v19, v5, v13, v14 bitop3:0xea
    v_cvt_pk_bf16_f32 v123, v9, v10
    v_perm_b32 v12, v123, v123, s41
    v_bitop3_b32 v94, v4, v12, v94 bitop3:0xca
    v_perm_b32 v13, v123, v123, s42
    v_bitop3_b32 v95, v4, v13, v95 bitop3:0xca
    v_add_u32 v7, s72, v0
    v_add_u32 v12, s73, v0
    v_add_u32 v13, s85, v0
    v_add_u32 v14, s91, v0
    v_add_u32 v15, s93, v0
    s_min_i32 s3, s72, s73
    s_min_i32 s3, s3, s85
    s_min_i32 s3, s3, s91
    s_min_i32 s3, s3, s93
    v_add_u32 v3, s3, v0
    v_mov_b32 v8, 0
    v_mov_b32 v9, 0
    v_mov_b32 v10, 0
    v_mov_b32 v11, 0
    s_waitcnt lgkmcnt(0)
    s_barrier
    ds_read_b128 v[32:35], v7 offset:0
    ds_read_b128 v[36:39], v12 offset:0
    ds_read_b128 v[40:43], v13 offset:0
    ds_read_b128 v[24:27], v14 offset:0
    ds_read_b128 v[84:87], v15 offset:0
    ds_write_b128 v3, v[8:11]
    ds_read_b128 v[48:51], v7 offset:16384
    ds_read_b128 v[52:55], v12 offset:16384
    ds_read_b128 v[56:59], v13 offset:16384
    ds_read_b128 v[60:63], v14 offset:16384
    ds_read_b128 v[44:47], v15 offset:16384
    s_waitcnt lgkmcnt(0)
    s_barrier
    s_setprio 3
    s_add_u32 s46, s35, 0x2a44000
    s_add_u32 s46, s46, s72
    buffer_store_dwordx4 v[32:35], v0, s[20:23], s46 offen sc1
    s_add_u32 s47, s96, 0x5c00000
    s_nop 0
    v_lshlrev_b32 v32, 1, v1
    buffer_load_dwordx4 v[32:35], v32, s[8:11], s47 offen nt
    s_add_u32 s44, s35, 0x2a44000
    s_add_u32 s44, s44, s73
    buffer_store_dwordx4 v[36:39], v0, s[20:23], s44 offen sc1
    s_add_u32 s45, s96, 0x5c00000
    s_nop 0
    v_lshlrev_b32 v36, 1, v1
    buffer_load_dwordx4 v[36:39], v36, s[12:15], s45 offen nt
    ds_add_u32 v72, v2
    ds_add_u32 v73, v2
    ds_add_u32 v74, v2
    ds_add_u32 v75, v2
    ds_add_u32 v80, v2
    ds_add_u32 v81, v2
    ds_add_u32 v82, v2
    ds_add_u32 v83, v2
    s_setprio 2
    ds_add_u32 v104, v2
    ds_add_u32 v105, v2
    ds_add_u32 v106, v2
    ds_add_u32 v107, v2
    ds_add_u32 v112, v2
    ds_add_u32 v113, v2
    ds_add_u32 v114, v2
    ds_add_u32 v115, v2
    s_setprio 1
    s_add_u32 s46, s35, 0x2a44000
    s_add_u32 s46, s46, s85
    buffer_store_dwordx4 v[40:43], v0, s[20:23], s46 offen sc1
    s_add_u32 s47, s96, 0x6000000
    s_nop 0
    v_lshlrev_b32 v40, 1, v1
    buffer_load_dwordx4 v[40:43], v40, s[8:11], s47 offen nt
    ds_add_u32 v116, v2
    ds_add_u32 v117, v2
    ds_add_u32 v118, v2
    ds_add_u32 v119, v2
    ds_add_u32 v16, v2
    ds_add_u32 v17, v2
    ds_add_u32 v18, v2
    ds_add_u32 v19, v2
    s_setprio 0
    s_waitcnt vmcnt(6)
    v_lshlrev_b32 v7, 16, v28
    v_and_b32 v8, 0xffff0000, v28
    v_lshlrev_b32 v9, 16, v29
    v_and_b32 v10, 0xffff0000, v29
    v_mul_f32 v7, 0.15915494, v7
    v_mul_f32 v8, 0.15915494, v8
    v_mul_f32 v9, 0.15915494, v9
    v_mul_f32 v10, 0.15915494, v10
    v_mul_hi_u32_u24 v14, 429497, v20
    v_lshrrev_b32 v12, 3, v124
    v_cos_f32 v7, v7
    v_lshlrev_b16 v13, 3, v124
    v_mad_i32_i24 v11, v14, s55, v20
    v_bitop3_b32 v12, v6, v13, v12 bitop3:0xca
    v_lshl_add_u32 v11, v11, 17, s40
    v_lshlrev_b16 v14, 8, v14
    v_lshrrev_b32 v13, 2, v124
    v_add_u32 v20, v12, v11
    v_bitop3_b32 v124, v5, v13, v14 bitop3:0xea
    ds_add_u32 v124, v2
    v_mul_hi_u32_u24 v14, 429497, v21
    v_lshrrev_b32 v12, 3, v125
    v_cos_f32 v8, v8
    v_lshlrev_b16 v13, 3, v125
    v_mad_i32_i24 v11, v14, s55, v21
    v_bitop3_b32 v12, v6, v13, v12 bitop3:0xca
    v_lshl_add_u32 v11, v11, 17, s40
    v_lshlrev_b16 v14, 8, v14
    v_lshrrev_b32 v13, 2, v125
    v_add_u32 v21, v12, v11
    v_bitop3_b32 v125, v5, v13, v14 bitop3:0xea
    ds_add_u32 v125, v2
    v_cvt_pk_bf16_f32 v28, v7, v8
    v_perm_b32 v12, v28, v28, s41
    v_bitop3_b32 v20, v4, v12, v20 bitop3:0xca
    v_perm_b32 v13, v28, v28, s42
    v_bitop3_b32 v21, v4, v13, v21 bitop3:0xca
    v_mul_hi_u32_u24 v14, 429497, v22
    v_lshrrev_b32 v12, 3, v126
    v_cos_f32 v9, v9
    v_lshlrev_b16 v13, 3, v126
    v_mad_i32_i24 v11, v14, s55, v22
    v_bitop3_b32 v12, v6, v13, v12 bitop3:0xca
    v_lshl_add_u32 v11, v11, 17, s40
    v_lshlrev_b16 v14, 8, v14
    v_lshrrev_b32 v13, 2, v126
    v_add_u32 v22, v12, v11
    v_bitop3_b32 v126, v5, v13, v14 bitop3:0xea
    ds_add_u32 v126, v2
    v_mul_hi_u32_u24 v14, 429497, v23
    v_lshrrev_b32 v12, 3, v127
    v_cos_f32 v10, v10
    v_lshlrev_b16 v13, 3, v127
    v_mad_i32_i24 v11, v14, s55, v23
    v_bitop3_b32 v12, v6, v13, v12 bitop3:0xca
    v_lshl_add_u32 v11, v11, 17, s40
    v_lshlrev_b16 v14, 8, v14
    v_lshrrev_b32 v13, 2, v127
    v_add_u32 v23, v12, v11
    v_bitop3_b32 v127, v5, v13, v14 bitop3:0xea
    ds_add_u32 v127, v2
    v_cvt_pk_bf16_f32 v29, v9, v10
    v_perm_b32 v12, v29, v29, s41
    v_bitop3_b32 v22, v4, v12, v22 bitop3:0xca
    v_perm_b32 v13, v29, v29, s42
    v_bitop3_b32 v23, v4, v13, v23 bitop3:0xca
    s_waitcnt vmcnt(2)
    v_lshlrev_b32 v7, 16, v30
    v_and_b32 v8, 0xffff0000, v30
    v_lshlrev_b32 v9, 16, v31
    v_and_b32 v10, 0xffff0000, v31
    v_mul_f32 v7, 0.15915494, v7
    v_mul_f32 v8, 0.15915494, v8
    v_mul_f32 v9, 0.15915494, v9
    v_mul_f32 v10, 0.15915494, v10
    v_mul_hi_u32_u24 v14, 429497, v32
    v_lshrrev_b32 v12, 3, v36
    v_cos_f32 v7, v7
    v_lshlrev_b16 v13, 3, v36
    v_mad_i32_i24 v11, v14, s55, v32
    v_bitop3_b32 v12, v6, v13, v12 bitop3:0xca
    v_lshl_add_u32 v11, v11, 17, s40
    v_lshlrev_b16 v14, 8, v14
    v_lshrrev_b32 v13, 2, v36
    v_add_u32 v32, v12, v11
    v_bitop3_b32 v36, v5, v13, v14 bitop3:0xea
    ds_add_u32 v36, v2
    v_mul_hi_u32_u24 v14, 429497, v33
    v_lshrrev_b32 v12, 3, v37
    v_cos_f32 v8, v8
    v_lshlrev_b16 v13, 3, v37
    v_mad_i32_i24 v11, v14, s55, v33
    v_bitop3_b32 v12, v6, v13, v12 bitop3:0xca
    v_lshl_add_u32 v11, v11, 17, s40
    v_lshlrev_b16 v14, 8, v14
    v_lshrrev_b32 v13, 2, v37
    v_add_u32 v33, v12, v11
    v_bitop3_b32 v37, v5, v13, v14 bitop3:0xea
    ds_add_u32 v37, v2
    v_cvt_pk_bf16_f32 v30, v7, v8
    v_perm_b32 v12, v30, v30, s41
    v_bitop3_b32 v32, v4, v12, v32 bitop3:0xca
    v_perm_b32 v13, v30, v30, s42
    v_bitop3_b32 v33, v4, v13, v33 bitop3:0xca
    v_mul_hi_u32_u24 v14, 429497, v34
    v_lshrrev_b32 v12, 3, v38
    v_cos_f32 v9, v9
    v_lshlrev_b16 v13, 3, v38
    v_mad_i32_i24 v11, v14, s55, v34
    v_bitop3_b32 v12, v6, v13, v12 bitop3:0xca
    v_lshl_add_u32 v11, v11, 17, s40
    v_lshlrev_b16 v14, 8, v14
    v_lshrrev_b32 v13, 2, v38
    v_add_u32 v34, v12, v11
    v_bitop3_b32 v38, v5, v13, v14 bitop3:0xea
    ds_add_u32 v38, v2
    v_mul_hi_u32_u24 v14, 429497, v35
    v_lshrrev_b32 v12, 3, v39
    v_cos_f32 v10, v10
    v_lshlrev_b16 v13, 3, v39
    v_mad_i32_i24 v11, v14, s55, v35
    v_bitop3_b32 v12, v6, v13, v12 bitop3:0xca
    v_lshl_add_u32 v11, v11, 17, s40
    v_lshlrev_b16 v14, 8, v14
    v_lshrrev_b32 v13, 2, v39
    v_add_u32 v35, v12, v11
    v_bitop3_b32 v39, v5, v13, v14 bitop3:0xea
    ds_add_u32 v39, v2
    v_cvt_pk_bf16_f32 v31, v9, v10
    v_perm_b32 v12, v31, v31, s41
    v_bitop3_b32 v34, v4, v12, v34 bitop3:0xca
    v_perm_b32 v13, v31, v31, s42
    v_bitop3_b32 v35, v4, v13, v35 bitop3:0xca
    v_lshrrev_b32 v8, 2, v0
    v_and_b32 v7, 0x3c00, v0
    v_bitop3_b32 v7, v5, v8, v7 bitop3:0xea
    s_waitcnt lgkmcnt(0)
    s_barrier
    ds_read2st64_b32 v[8:9], v7 offset0:0 offset1:1
    ds_read2st64_b32 v[10:11], v7 offset0:2 offset1:3
    s_add_u32 s44, s35, 0x2a44000
    s_add_u32 s44, s44, s91
    buffer_store_dwordx4 v[24:27], v0, s[20:23], s44 offen sc1
    s_add_u32 s45, s96, 0x6000000
    s_nop 0
    v_lshlrev_b32 v24, 1, v1
    buffer_load_dwordx4 v[24:27], v24, s[12:15], s45 offen nt
    s_waitcnt lgkmcnt(0)
    v_lshl_or_b32 v12, v9, 16, v8
    v_lshl_or_b32 v13, v11, 16, v10
    v_mov_b32 v14, v12
    v_mov_b32 v15, v13
    s_nop 0
    v_add_u32_dpp v14, v14, v14 row_shr:1 row_mask:0xf bank_mask:0xf bound_ctrl:1
    v_add_u32_dpp v15, v15, v15 row_shr:1 row_mask:0xf bank_mask:0xf bound_ctrl:1
    s_nop 0
    v_add_u32_dpp v14, v14, v14 row_shr:2 row_mask:0xf bank_mask:0xf bound_ctrl:1
    v_add_u32_dpp v15, v15, v15 row_shr:2 row_mask:0xf bank_mask:0xf bound_ctrl:1
    s_nop 0
    v_add_u32_dpp v14, v14, v14 row_shr:4 row_mask:0xf bank_mask:0xf bound_ctrl:1
    v_add_u32_dpp v15, v15, v15 row_shr:4 row_mask:0xf bank_mask:0xf bound_ctrl:1
    s_nop 0
    v_add_u32_dpp v14, v14, v14 row_shr:8 row_mask:0xf bank_mask:0xf bound_ctrl:1
    v_add_u32_dpp v15, v15, v15 row_shr:8 row_mask:0xf bank_mask:0xf bound_ctrl:1
    s_nop 0
    v_add_u32_dpp v14, v14, v14 row_bcast:15 row_mask:0xa bank_mask:0xf
    v_add_u32_dpp v15, v15, v15 row_bcast:15 row_mask:0xa bank_mask:0xf
    s_nop 0
    v_add_u32_dpp v14, v14, v14 row_bcast:31 row_mask:0xc bank_mask:0xf
    v_add_u32_dpp v15, v15, v15 row_bcast:31 row_mask:0xc bank_mask:0xf
    v_readlane_b32 s48, v14, 63
    v_readlane_b32 s49, v15, 63
    s_lshl_b32 s54, s32, 2
    v_mov_b32 v8, s54
    s_and_b32 s50, s48, 0xffff
    s_lshr_b32 s51, s48, 16
    s_and_b32 s52, s49, 0xffff
    s_lshr_b32 s53, s49, 16
    s_add_u32 s51, s51, s50
    s_add_u32 s52, s52, s51
    s_add_u32 s53, s53, s52
    v_mov_b32 v9, s53
    s_mov_b64 exec, 1
    ds_write_b32 v8, v9 offset:16384
    s_mov_b64 exec, -1
    v_and_b32 v8, 60, v7
    s_waitcnt lgkmcnt(0)
    s_barrier
    ds_read_b32 v9, v8 offset:16384
    s_waitcnt lgkmcnt(0)
    v_add_u32_dpp v9, v9, v9 row_shr:1 row_mask:0xf bank_mask:0xf bound_ctrl:1
    s_nop 1
    v_add_u32_dpp v9, v9, v9 row_shr:2 row_mask:0xf bank_mask:0xf bound_ctrl:1
    s_nop 1
    v_add_u32_dpp v9, v9, v9 row_shr:4 row_mask:0xf bank_mask:0xf bound_ctrl:1
    s_nop 1
    v_add_u32_dpp v9, v9, v9 row_shr:8 row_mask:0xf bank_mask:0xf bound_ctrl:1
    s_nop 0
    v_readlane_b32 s54, v9, s32
    s_sub_u32 s54, s54, s53
    s_add_u32 s50, s50, s54
    s_add_u32 s51, s51, s54
    s_add_u32 s52, s52, s54
    s_pack_ll_b32_b16 s48, s54, s50
    s_pack_ll_b32_b16 s49, s51, s52
    v_add_u32 v14, s48, v14
    v_add_u32 v15, s49, v15
    v_sub_u32 v12, v14, v12
    v_sub_u32 v13, v15, v13
    v_and_b32 v8, 0xffff, v12
    v_lshrrev_b32 v9, 16, v12
    v_and_b32 v10, 0xffff, v13
    v_lshrrev_b32 v11, 16, v13
    ds_write2st64_b32 v7, v8, v9 offset0:0 offset1:1
    ds_write2st64_b32 v7, v10, v11 offset0:2 offset1:3
    v_and_b32 v8, 0x3f0, v0
    v_lshl_add_u32 v8, v8, 1, s36
    ds_write_b64 v8, v[12:13] offset:20480
    s_bitset0_b64 exec, 63
    s_not_b64 exec, exec
    ds_write_b64 v8, v[14:15] offset:20512
    s_mov_b64 exec, -1
    s_waitcnt lgkmcnt(0)
    s_barrier
    s_setprio 3
    ds_add_rtn_u32 v72, v72, v2
    ds_add_rtn_u32 v73, v73, v2
    ds_add_rtn_u32 v74, v74, v2
    ds_add_rtn_u32 v75, v75, v2
    ds_read_b128 v[12:15], v0 offset:20480
    v_cmp_gt_u32 vcc, 8448, v0
    s_add_u32 s46, s35, 0x2a44000
    s_add_u32 s46, s46, s93
    buffer_store_dwordx4 v[84:87], v0, s[20:23], s46 offen sc1
    s_add_u32 s47, s96, 0x6000000
    s_lshr_b32 s47, s47, 1
    buffer_load_dwordx2 v[84:85], v1, s[16:19], s47 offen nt
    s_add_u32 s44, s96, 0x6400000
    s_lshr_b32 s44, s44, 1
    buffer_load_dwordx2 v[86:87], v1, s[16:19], s44 offen nt
    ds_add_rtn_u32 v80, v80, v2
    ds_add_rtn_u32 v81, v81, v2
    ds_add_rtn_u32 v82, v82, v2
    ds_add_rtn_u32 v83, v83, v2
    s_setprio 2
    ds_add_rtn_u32 v104, v104, v2
    ds_add_rtn_u32 v105, v105, v2
    ds_add_rtn_u32 v106, v106, v2
    ds_add_rtn_u32 v107, v107, v2
    s_waitcnt lgkmcnt(8)
    s_cbranch_vccz L1_p3
    s_add_u32 s45, s35, 0x5480000
    s_mov_b64 exec, vcc
    buffer_store_dwordx4 v[12:15], v0, s[24:27], s45 offen sc1
    s_mov_b64 exec, -1
L1_p3:
    s_add_u32 s46, s35, 0x2a48000
    s_add_u32 s46, s46, s72
    buffer_store_dwordx4 v[48:51], v0, s[20:23], s46 offen sc1
    s_add_u32 s47, s96, 0x6400000
    s_nop 0
    v_lshlrev_b32 v48, 1, v1
    buffer_load_dwordx4 v[48:51], v48, s[8:11], s47 offen nt
    ds_add_rtn_u32 v112, v112, v2
    ds_add_rtn_u32 v113, v113, v2
    ds_add_rtn_u32 v114, v114, v2
    ds_add_rtn_u32 v115, v115, v2
    s_setprio 1
    ds_add_rtn_u32 v116, v116, v2
    ds_add_rtn_u32 v117, v117, v2
    ds_add_rtn_u32 v118, v118, v2
    ds_add_rtn_u32 v119, v119, v2
    ds_add_rtn_u32 v16, v16, v2
    ds_add_rtn_u32 v17, v17, v2
    ds_add_rtn_u32 v18, v18, v2
    ds_add_rtn_u32 v19, v19, v2
    s_add_u32 s44, s35, 0x2a48000
    s_add_u32 s44, s44, s73
    buffer_store_dwordx4 v[52:55], v0, s[20:23], s44 offen sc1
    s_add_u32 s45, s96, 0x6400000
    s_nop 0
    v_lshlrev_b32 v52, 1, v1
    buffer_load_dwordx4 v[52:55], v52, s[12:15], s45 offen nt
    s_setprio 0
    ds_add_rtn_u32 v124, v124, v2
    ds_add_rtn_u32 v125, v125, v2
    ds_add_rtn_u32 v126, v126, v2
    ds_add_rtn_u32 v127, v127, v2
    ds_add_rtn_u32 v36, v36, v2
    ds_add_rtn_u32 v37, v37, v2
    ds_add_rtn_u32 v38, v38, v2
    ds_add_rtn_u32 v39, v39, v2
    s_waitcnt lgkmcnt(0)
    s_barrier
    s_setprio 3
    v_and_b32 v7, -4, v72
    v_lshl_add_u32 v8, v72, 2, v7
    ds_write_b32 v8, v68
    v_lshl_add_u32 v7, v7, 2, v72
    ds_write_b8 v7, v64 offset:16
    v_and_b32 v9, -4, v73
    v_lshl_add_u32 v10, v73, 2, v9
    ds_write_b32 v10, v69
    v_lshl_add_u32 v9, v9, 2, v73
    ds_write_b8_d16_hi v9, v64 offset:16
    v_and_b32 v7, -4, v74
    v_lshl_add_u32 v8, v74, 2, v7
    ds_write_b32 v8, v70
    v_lshl_add_u32 v7, v7, 2, v74
    ds_write_b8 v7, v65 offset:16
    v_and_b32 v9, -4, v75
    v_lshl_add_u32 v10, v75, 2, v9
    ds_write_b32 v10, v71
    v_lshl_add_u32 v9, v9, 2, v75
    ds_write_b8_d16_hi v9, v65 offset:16
    s_add_u32 s46, s35, 0x2a48000
    s_add_u32 s46, s46, s85
    buffer_store_dwordx4 v[56:59], v0, s[20:23], s46 offen sc1
    s_add_u32 s47, s96, 0x6800000
    v_lshlrev_b32 v68, 1, v1
    buffer_load_dwordx4 v[68:71], v68, s[8:11], s47 offen nt
    s_add_u32 s44, s96, 0x6800000
    v_lshlrev_b32 v72, 1, v1
    buffer_load_dwordx4 v[72:75], v72, s[12:15], s44 offen nt
    v_and_b32 v7, -4, v80
    v_lshl_add_u32 v8, v80, 2, v7
    ds_write_b32 v8, v76
    v_lshl_add_u32 v7, v7, 2, v80
    ds_write_b8 v7, v66 offset:16
    v_and_b32 v9, -4, v81
    v_lshl_add_u32 v10, v81, 2, v9
    ds_write_b32 v10, v77
    v_lshl_add_u32 v9, v9, 2, v81
    ds_write_b8_d16_hi v9, v66 offset:16
    v_and_b32 v7, -4, v82
    v_lshl_add_u32 v8, v82, 2, v7
    ds_write_b32 v8, v78
    v_lshl_add_u32 v7, v7, 2, v82
    ds_write_b8 v7, v67 offset:16
    v_and_b32 v9, -4, v83
    v_lshl_add_u32 v10, v83, 2, v9
    ds_write_b32 v10, v79
    v_lshl_add_u32 v9, v9, 2, v83
    ds_write_b8_d16_hi v9, v67 offset:16
    s_add_u32 s45, s96, 0x6800000
    s_lshr_b32 s45, s45, 1
    buffer_load_dwordx2 v[56:57], v1, s[16:19], s45 offen nt
    s_add_u32 s46, s96, 0x6c00000
    s_lshr_b32 s46, s46, 1
    buffer_load_dwordx2 v[58:59], v1, s[16:19], s46 offen nt
    s_add_u32 s47, s96, 0x6c00000
    v_lshlrev_b32 v76, 1, v1
    buffer_load_dwordx4 v[76:79], v76, s[8:11], s47 offen nt
    s_waitcnt vmcnt(10)
    v_lshlrev_b32 v7, 16, v84
    v_and_b32 v8, 0xffff0000, v84
    v_lshlrev_b32 v9, 16, v85
    v_and_b32 v10, 0xffff0000, v85
    v_mul_f32 v7, 0.15915494, v7
    v_mul_f32 v8, 0.15915494, v8
    v_mul_f32 v9, 0.15915494, v9
    v_mul_f32 v10, 0.15915494, v10
    v_mul_hi_u32_u24 v14, 429497, v40
    v_lshrrev_b32 v12, 3, v24
    v_cos_f32 v7, v7
    v_lshlrev_b16 v13, 3, v24
    v_mad_i32_i24 v11, v14, s55, v40
    v_bitop3_b32 v12, v6, v13, v12 bitop3:0xca
    v_lshl_add_u32 v11, v11, 17, s40
    v_lshlrev_b16 v14, 8, v14
    v_lshrrev_b32 v13, 2, v24
    v_add_u32 v40, v12, v11
    v_bitop3_b32 v24, v5, v13, v14 bitop3:0xea
    v_mul_hi_u32_u24 v14, 429497, v41
    v_lshrrev_b32 v12, 3, v25
    v_cos_f32 v8, v8
    v_lshlrev_b16 v13, 3, v25
    v_mad_i32_i24 v11, v14, s55, v41
    v_bitop3_b32 v12, v6, v13, v12 bitop3:0xca
    v_lshl_add_u32 v11, v11, 17, s40
    v_lshlrev_b16 v14, 8, v14
    v_lshrrev_b32 v13, 2, v25
    v_add_u32 v41, v12, v11
    v_bitop3_b32 v25, v5, v13, v14 bitop3:0xea
    v_cvt_pk_bf16_f32 v84, v7, v8
    v_perm_b32 v12, v84, v84, s41
    v_bitop3_b32 v40, v4, v12, v40 bitop3:0xca
    v_perm_b32 v13, v84, v84, s42
    v_bitop3_b32 v41, v4, v13, v41 bitop3:0xca
    v_mul_hi_u32_u24 v14, 429497, v42
    v_lshrrev_b32 v12, 3, v26
    v_cos_f32 v9, v9
    v_lshlrev_b16 v13, 3, v26
    v_mad_i32_i24 v11, v14, s55, v42
    v_bitop3_b32 v12, v6, v13, v12 bitop3:0xca
    v_lshl_add_u32 v11, v11, 17, s40
    v_lshlrev_b16 v14, 8, v14
    v_lshrrev_b32 v13, 2, v26
    v_add_u32 v42, v12, v11
    v_bitop3_b32 v26, v5, v13, v14 bitop3:0xea
    v_mul_hi_u32_u24 v14, 429497, v43
    v_lshrrev_b32 v12, 3, v27
    v_cos_f32 v10, v10
    v_lshlrev_b16 v13, 3, v27
    v_mad_i32_i24 v11, v14, s55, v43
    v_bitop3_b32 v12, v6, v13, v12 bitop3:0xca
    v_lshl_add_u32 v11, v11, 17, s40
    v_lshlrev_b16 v14, 8, v14
    v_lshrrev_b32 v13, 2, v27
    v_add_u32 v43, v12, v11
    v_bitop3_b32 v27, v5, v13, v14 bitop3:0xea
    v_cvt_pk_bf16_f32 v85, v9, v10
    v_perm_b32 v12, v85, v85, s41
    v_bitop3_b32 v42, v4, v12, v42 bitop3:0xca
    v_perm_b32 v13, v85, v85, s42
    v_bitop3_b32 v43, v4, v13, v43 bitop3:0xca
    s_setprio 2
    v_and_b32 v7, -4, v104
    v_lshl_add_u32 v8, v104, 2, v7
    ds_write_b32 v8, v96
    v_lshl_add_u32 v7, v7, 2, v104
    ds_write_b8 v7, v88 offset:16
    v_and_b32 v9, -4, v105
    v_lshl_add_u32 v10, v105, 2, v9
    ds_write_b32 v10, v97
    v_lshl_add_u32 v9, v9, 2, v105
    ds_write_b8_d16_hi v9, v88 offset:16
    v_and_b32 v7, -4, v106
    v_lshl_add_u32 v8, v106, 2, v7
    ds_write_b32 v8, v98
    v_lshl_add_u32 v7, v7, 2, v106
    ds_write_b8 v7, v89 offset:16
    v_and_b32 v9, -4, v107
    v_lshl_add_u32 v10, v107, 2, v9
    ds_write_b32 v10, v99
    v_lshl_add_u32 v9, v9, 2, v107
    ds_write_b8_d16_hi v9, v89 offset:16
    s_add_u32 s44, s35, 0x2a48000
    s_add_u32 s44, s44, s91
    buffer_store_dwordx4 v[60:63], v0, s[20:23], s44 offen sc1
    s_add_u32 s45, s96, 0x6c00000
    v_lshlrev_b32 v80, 1, v1
    buffer_load_dwordx4 v[80:83], v80, s[12:15], s45 offen nt
    s_waitcnt vmcnt(8)
    v_lshlrev_b32 v7, 16, v86
    v_and_b32 v8, 0xffff0000, v86
    v_lshlrev_b32 v9, 16, v87
    v_and_b32 v10, 0xffff0000, v87
    v_mul_f32 v7, 0.15915494, v7
    v_mul_f32 v8, 0.15915494, v8
    v_mul_f32 v9, 0.15915494, v9
    v_mul_f32 v10, 0.15915494, v10
    v_mul_hi_u32_u24 v14, 429497, v48
    v_lshrrev_b32 v12, 3, v52
    v_cos_f32 v7, v7
    v_lshlrev_b16 v13, 3, v52
    v_mad_i32_i24 v11, v14, s55, v48
    v_bitop3_b32 v12, v6, v13, v12 bitop3:0xca
    v_lshl_add_u32 v11, v11, 17, s40
    v_lshlrev_b16 v14, 8, v14
    v_lshrrev_b32 v13, 2, v52
    v_add_u32 v48, v12, v11
    v_bitop3_b32 v52, v5, v13, v14 bitop3:0xea
    v_mul_hi_u32_u24 v14, 429497, v49
    v_lshrrev_b32 v12, 3, v53
    v_cos_f32 v8, v8
    v_lshlrev_b16 v13, 3, v53
    v_mad_i32_i24 v11, v14, s55, v49
    v_bitop3_b32 v12, v6, v13, v12 bitop3:0xca
    v_lshl_add_u32 v11, v11, 17, s40
    v_lshlrev_b16 v14, 8, v14
    v_lshrrev_b32 v13, 2, v53
    v_add_u32 v49, v12, v11
    v_bitop3_b32 v53, v5, v13, v14 bitop3:0xea
    v_cvt_pk_bf16_f32 v86, v7, v8
    v_perm_b32 v12, v86, v86, s41
    v_bitop3_b32 v48, v4, v12, v48 bitop3:0xca
    v_perm_b32 v13, v86, v86, s42
    v_bitop3_b32 v49, v4, v13, v49 bitop3:0xca
    v_mul_hi_u32_u24 v14, 429497, v50
    v_lshrrev_b32 v12, 3, v54
    v_cos_f32 v9, v9
    v_lshlrev_b16 v13, 3, v54
    v_mad_i32_i24 v11, v14, s55, v50
    v_bitop3_b32 v12, v6, v13, v12 bitop3:0xca
    v_lshl_add_u32 v11, v11, 17, s40
    v_lshlrev_b16 v14, 8, v14
    v_lshrrev_b32 v13, 2, v54
    v_add_u32 v50, v12, v11
    v_bitop3_b32 v54, v5, v13, v14 bitop3:0xea
    v_mul_hi_u32_u24 v14, 429497, v51
    v_lshrrev_b32 v12, 3, v55
    v_cos_f32 v10, v10
    v_lshlrev_b16 v13, 3, v55
    v_mad_i32_i24 v11, v14, s55, v51
    v_bitop3_b32 v12, v6, v13, v12 bitop3:0xca
    v_lshl_add_u32 v11, v11, 17, s40
    v_lshlrev_b16 v14, 8, v14
    v_lshrrev_b32 v13, 2, v55
    v_add_u32 v51, v12, v11
    v_bitop3_b32 v55, v5, v13, v14 bitop3:0xea
    v_cvt_pk_bf16_f32 v87, v9, v10
    v_perm_b32 v12, v87, v87, s41
    v_bitop3_b32 v50, v4, v12, v50 bitop3:0xca
    v_perm_b32 v13, v87, v87, s42
    v_bitop3_b32 v51, v4, v13, v51 bitop3:0xca
    v_and_b32 v7, -4, v112
    v_lshl_add_u32 v8, v112, 2, v7
    ds_write_b32 v8, v100
    v_lshl_add_u32 v7, v7, 2, v112
    ds_write_b8 v7, v90 offset:16
    v_and_b32 v9, -4, v113
    v_lshl_add_u32 v10, v113, 2, v9
    ds_write_b32 v10, v101
    v_lshl_add_u32 v9, v9, 2, v113
    ds_write_b8_d16_hi v9, v90 offset:16
    v_and_b32 v7, -4, v114
    v_lshl_add_u32 v8, v114, 2, v7
    ds_write_b32 v8, v102
    v_lshl_add_u32 v7, v7, 2, v114
    ds_write_b8 v7, v91 offset:16
    v_and_b32 v9, -4, v115
    v_lshl_add_u32 v10, v115, 2, v9
    ds_write_b32 v10, v103
    v_lshl_add_u32 v9, v9, 2, v115
    ds_write_b8_d16_hi v9, v91 offset:16
    s_add_u32 s46, s96, 0x7000000
    v_lshlrev_b32 v64, 1, v1
    buffer_load_dwordx4 v[64:67], v64, s[8:11], s46 offen nt
    s_add_u32 s47, s96, 0x7000000
    v_lshlrev_b32 v96, 1, v1
    buffer_load_dwordx4 v[96:99], v96, s[12:15], s47 offen nt
    s_waitcnt vmcnt(5)
    v_lshlrev_b32 v7, 16, v56
    v_and_b32 v8, 0xffff0000, v56
    v_lshlrev_b32 v9, 16, v57
    v_and_b32 v10, 0xffff0000, v57
    v_mul_f32 v7, 0.15915494, v7
    v_mul_f32 v8, 0.15915494, v8
    v_mul_f32 v9, 0.15915494, v9
    v_mul_f32 v10, 0.15915494, v10
    v_mul_hi_u32_u24 v14, 429497, v68
    v_lshrrev_b32 v12, 3, v72
    v_cos_f32 v7, v7
    v_lshlrev_b16 v13, 3, v72
    v_mad_i32_i24 v11, v14, s55, v68
    v_bitop3_b32 v12, v6, v13, v12 bitop3:0xca
    v_lshl_add_u32 v11, v11, 17, s40
    v_lshlrev_b16 v14, 8, v14
    v_lshrrev_b32 v13, 2, v72
    v_add_u32 v68, v12, v11
    v_bitop3_b32 v72, v5, v13, v14 bitop3:0xea
    v_mul_hi_u32_u24 v14, 429497, v69
    v_lshrrev_b32 v12, 3, v73
    v_cos_f32 v8, v8
    v_lshlrev_b16 v13, 3, v73
    v_mad_i32_i24 v11, v14, s55, v69
    v_bitop3_b32 v12, v6, v13, v12 bitop3:0xca
    v_lshl_add_u32 v11, v11, 17, s40
    v_lshlrev_b16 v14, 8, v14
    v_lshrrev_b32 v13, 2, v73
    v_add_u32 v69, v12, v11
    v_bitop3_b32 v73, v5, v13, v14 bitop3:0xea
    v_cvt_pk_bf16_f32 v56, v7, v8
    v_perm_b32 v12, v56, v56, s41
    v_bitop3_b32 v68, v4, v12, v68 bitop3:0xca
    v_perm_b32 v13, v56, v56, s42
    v_bitop3_b32 v69, v4, v13, v69 bitop3:0xca
    v_mul_hi_u32_u24 v14, 429497, v70
    v_lshrrev_b32 v12, 3, v74
    v_cos_f32 v9, v9
    v_lshlrev_b16 v13, 3, v74
    v_mad_i32_i24 v11, v14, s55, v70
    v_bitop3_b32 v12, v6, v13, v12 bitop3:0xca
    v_lshl_add_u32 v11, v11, 17, s40
    v_lshlrev_b16 v14, 8, v14
    v_lshrrev_b32 v13, 2, v74
    v_add_u32 v70, v12, v11
    v_bitop3_b32 v74, v5, v13, v14 bitop3:0xea
    v_mul_hi_u32_u24 v14, 429497, v71
    v_lshrrev_b32 v12, 3, v75
    v_cos_f32 v10, v10
    v_lshlrev_b16 v13, 3, v75
    v_mad_i32_i24 v11, v14, s55, v71
    v_bitop3_b32 v12, v6, v13, v12 bitop3:0xca
    v_lshl_add_u32 v11, v11, 17, s40
    v_lshlrev_b16 v14, 8, v14
    v_lshrrev_b32 v13, 2, v75
    v_add_u32 v71, v12, v11
    v_bitop3_b32 v75, v5, v13, v14 bitop3:0xea
    v_cvt_pk_bf16_f32 v57, v9, v10
    v_perm_b32 v12, v57, v57, s41
    v_bitop3_b32 v70, v4, v12, v70 bitop3:0xca
    v_perm_b32 v13, v57, v57, s42
    v_bitop3_b32 v71, v4, v13, v71 bitop3:0xca
    s_setprio 1
    v_and_b32 v7, -4, v116
    v_lshl_add_u32 v8, v116, 2, v7
    ds_write_b32 v8, v108
    v_lshl_add_u32 v7, v7, 2, v116
    ds_write_b8 v7, v120 offset:16
    v_and_b32 v9, -4, v117
    v_lshl_add_u32 v10, v117, 2, v9
    ds_write_b32 v10, v109
    v_lshl_add_u32 v9, v9, 2, v117
    ds_write_b8_d16_hi v9, v120 offset:16
    v_and_b32 v7, -4, v118
    v_lshl_add_u32 v8, v118, 2, v7
    ds_write_b32 v8, v110
    v_lshl_add_u32 v7, v7, 2, v118
    ds_write_b8 v7, v121 offset:16
    v_and_b32 v9, -4, v119
    v_lshl_add_u32 v10, v119, 2, v9
    ds_write_b32 v10, v111
    v_lshl_add_u32 v9, v9, 2, v119
    ds_write_b8_d16_hi v9, v121 offset:16
    s_add_u32 s44, s96, 0x7000000
    s_lshr_b32 s44, s44, 1
    buffer_load_dwordx2 v[104:105], v1, s[16:19], s44 offen nt
    s_add_u32 s45, s96, 0x7400000
    s_lshr_b32 s45, s45, 1
    buffer_load_dwordx2 v[106:107], v1, s[16:19], s45 offen nt
    s_add_u32 s46, s96, 0x7400000
    v_lshlrev_b32 v60, 1, v1
    buffer_load_dwordx4 v[60:63], v60, s[8:11], s46 offen nt
    v_and_b32 v7, -4, v16
    v_lshl_add_u32 v8, v16, 2, v7
    ds_write_b32 v8, v92
    v_lshl_add_u32 v7, v7, 2, v16
    ds_write_b8 v7, v122 offset:16
    v_and_b32 v9, -4, v17
    v_lshl_add_u32 v10, v17, 2, v9
    ds_write_b32 v10, v93
    v_lshl_add_u32 v9, v9, 2, v17
    ds_write_b8_d16_hi v9, v122 offset:16
    v_and_b32 v7, -4, v18
    v_lshl_add_u32 v8, v18, 2, v7
    ds_write_b32 v8, v94
    v_lshl_add_u32 v7, v7, 2, v18
    ds_write_b8 v7, v123 offset:16
    v_and_b32 v9, -4, v19
    v_lshl_add_u32 v10, v19, 2, v9
    ds_write_b32 v10, v95
    v_lshl_add_u32 v9, v9, 2, v19
    ds_write_b8_d16_hi v9, v123 offset:16
    s_add_u32 s47, s35, 0x2a48000
    s_add_u32 s47, s47, s93
    buffer_store_dwordx4 v[44:47], v0, s[20:23], s47 offen sc1
    s_add_u32 s44, s96, 0x7400000
    v_lshlrev_b32 v100, 1, v1
    buffer_load_dwordx4 v[100:103], v100, s[12:15], s44 offen nt
    s_waitcnt vmcnt(7)
    v_lshlrev_b32 v7, 16, v58
    v_and_b32 v8, 0xffff0000, v58
    v_lshlrev_b32 v9, 16, v59
    v_and_b32 v10, 0xffff0000, v59
    v_mul_f32 v7, 0.15915494, v7
    v_mul_f32 v8, 0.15915494, v8
    v_mul_f32 v9, 0.15915494, v9
    v_mul_f32 v10, 0.15915494, v10
    v_mul_hi_u32_u24 v14, 429497, v76
    v_lshrrev_b32 v12, 3, v80
    v_cos_f32 v7, v7
    v_lshlrev_b16 v13, 3, v80
    v_mad_i32_i24 v11, v14, s55, v76
    v_bitop3_b32 v12, v6, v13, v12 bitop3:0xca
    v_lshl_add_u32 v11, v11, 17, s40
    v_lshlrev_b16 v14, 8, v14
    v_lshrrev_b32 v13, 2, v80
    v_add_u32 v76, v12, v11
    v_bitop3_b32 v80, v5, v13, v14 bitop3:0xea
    v_mul_hi_u32_u24 v14, 429497, v77
    v_lshrrev_b32 v12, 3, v81
    v_cos_f32 v8, v8
    v_lshlrev_b16 v13, 3, v81
    v_mad_i32_i24 v11, v14, s55, v77
    v_bitop3_b32 v12, v6, v13, v12 bitop3:0xca
    v_lshl_add_u32 v11, v11, 17, s40
    v_lshlrev_b16 v14, 8, v14
    v_lshrrev_b32 v13, 2, v81
    v_add_u32 v77, v12, v11
    v_bitop3_b32 v81, v5, v13, v14 bitop3:0xea
    v_cvt_pk_bf16_f32 v58, v7, v8
    v_perm_b32 v12, v58, v58, s41
    v_bitop3_b32 v76, v4, v12, v76 bitop3:0xca
    v_perm_b32 v13, v58, v58, s42
    v_bitop3_b32 v77, v4, v13, v77 bitop3:0xca
    v_mul_hi_u32_u24 v14, 429497, v78
    v_lshrrev_b32 v12, 3, v82
    v_cos_f32 v9, v9
    v_lshlrev_b16 v13, 3, v82
    v_mad_i32_i24 v11, v14, s55, v78
    v_bitop3_b32 v12, v6, v13, v12 bitop3:0xca
    v_lshl_add_u32 v11, v11, 17, s40
    v_lshlrev_b16 v14, 8, v14
    v_lshrrev_b32 v13, 2, v82
    v_add_u32 v78, v12, v11
    v_bitop3_b32 v82, v5, v13, v14 bitop3:0xea
    v_mul_hi_u32_u24 v14, 429497, v79
    v_lshrrev_b32 v12, 3, v83
    v_cos_f32 v10, v10
    v_lshlrev_b16 v13, 3, v83
    v_mad_i32_i24 v11, v14, s55, v79
    v_bitop3_b32 v12, v6, v13, v12 bitop3:0xca
    v_lshl_add_u32 v11, v11, 17, s40
    v_lshlrev_b16 v14, 8, v14
    v_lshrrev_b32 v13, 2, v83
    v_add_u32 v79, v12, v11
    v_bitop3_b32 v83, v5, v13, v14 bitop3:0xea
    v_cvt_pk_bf16_f32 v59, v9, v10
    v_perm_b32 v12, v59, v59, s41
    v_bitop3_b32 v78, v4, v12, v78 bitop3:0xca
    v_perm_b32 v13, v59, v59, s42
    v_bitop3_b32 v79, v4, v13, v79 bitop3:0xca
    s_setprio 0
    v_and_b32 v7, -4, v124
    v_lshl_add_u32 v8, v124, 2, v7
    ds_write_b32 v8, v20
    v_lshl_add_u32 v7, v7, 2, v124
    ds_write_b8 v7, v28 offset:16
    v_and_b32 v9, -4, v125
    v_lshl_add_u32 v10, v125, 2, v9
    ds_write_b32 v10, v21
    v_lshl_add_u32 v9, v9, 2, v125
    ds_write_b8_d16_hi v9, v28 offset:16
    v_and_b32 v7, -4, v126
    v_lshl_add_u32 v8, v126, 2, v7
    ds_write_b32 v8, v22
    v_lshl_add_u32 v7, v7, 2, v126
    ds_write_b8 v7, v29 offset:16
    v_and_b32 v9, -4, v127
    v_lshl_add_u32 v10, v127, 2, v9
    ds_write_b32 v10, v23
    v_lshl_add_u32 v9, v9, 2, v127
    ds_write_b8_d16_hi v9, v29 offset:16
    s_add_u32 s45, s96, 0x7800000
    v_lshlrev_b32 v112, 1, v1
    buffer_load_dwordx4 v[112:115], v112, s[8:11], s45 offen nt
    s_add_u32 s46, s96, 0x7800000
    v_lshlrev_b32 v88, 1, v1
    buffer_load_dwordx4 v[88:91], v88, s[12:15], s46 offen nt
    s_waitcnt vmcnt(5)
    v_lshlrev_b32 v7, 16, v104
    v_and_b32 v8, 0xffff0000, v104
    v_lshlrev_b32 v9, 16, v105
    v_and_b32 v10, 0xffff0000, v105
    v_mul_f32 v7, 0.15915494, v7
    v_mul_f32 v8, 0.15915494, v8
    v_mul_f32 v9, 0.15915494, v9
    v_mul_f32 v10, 0.15915494, v10
    v_mul_hi_u32_u24 v14, 429497, v64
    v_lshrrev_b32 v12, 3, v96
    v_cos_f32 v7, v7
    v_lshlrev_b16 v13, 3, v96
    v_mad_i32_i24 v11, v14, s55, v64
    v_bitop3_b32 v12, v6, v13, v12 bitop3:0xca
    v_lshl_add_u32 v11, v11, 17, s40
    v_lshlrev_b16 v14, 8, v14
    v_lshrrev_b32 v13, 2, v96
    v_add_u32 v64, v12, v11
    v_bitop3_b32 v96, v5, v13, v14 bitop3:0xea
    v_mul_hi_u32_u24 v14, 429497, v65
    v_lshrrev_b32 v12, 3, v97
    v_cos_f32 v8, v8
    v_lshlrev_b16 v13, 3, v97
    v_mad_i32_i24 v11, v14, s55, v65
    v_bitop3_b32 v12, v6, v13, v12 bitop3:0xca
    v_lshl_add_u32 v11, v11, 17, s40
    v_lshlrev_b16 v14, 8, v14
    v_lshrrev_b32 v13, 2, v97
    v_add_u32 v65, v12, v11
    v_bitop3_b32 v97, v5, v13, v14 bitop3:0xea
    v_cvt_pk_bf16_f32 v104, v7, v8
    v_perm_b32 v12, v104, v104, s41
    v_bitop3_b32 v64, v4, v12, v64 bitop3:0xca
    v_perm_b32 v13, v104, v104, s42
    v_bitop3_b32 v65, v4, v13, v65 bitop3:0xca
    v_mul_hi_u32_u24 v14, 429497, v66
    v_lshrrev_b32 v12, 3, v98
    v_cos_f32 v9, v9
    v_lshlrev_b16 v13, 3, v98
    v_mad_i32_i24 v11, v14, s55, v66
    v_bitop3_b32 v12, v6, v13, v12 bitop3:0xca
    v_lshl_add_u32 v11, v11, 17, s40
    v_lshlrev_b16 v14, 8, v14
    v_lshrrev_b32 v13, 2, v98
    v_add_u32 v66, v12, v11
    v_bitop3_b32 v98, v5, v13, v14 bitop3:0xea
    v_mul_hi_u32_u24 v14, 429497, v67
    v_lshrrev_b32 v12, 3, v99
    v_cos_f32 v10, v10
    v_lshlrev_b16 v13, 3, v99
    v_mad_i32_i24 v11, v14, s55, v67
    v_bitop3_b32 v12, v6, v13, v12 bitop3:0xca
    v_lshl_add_u32 v11, v11, 17, s40
    v_lshlrev_b16 v14, 8, v14
    v_lshrrev_b32 v13, 2, v99
    v_add_u32 v67, v12, v11
    v_bitop3_b32 v99, v5, v13, v14 bitop3:0xea
    v_cvt_pk_bf16_f32 v105, v9, v10
    v_perm_b32 v12, v105, v105, s41
    v_bitop3_b32 v66, v4, v12, v66 bitop3:0xca
    v_perm_b32 v13, v105, v105, s42
    v_bitop3_b32 v67, v4, v13, v67 bitop3:0xca
    v_and_b32 v7, -4, v36
    v_lshl_add_u32 v8, v36, 2, v7
    ds_write_b32 v8, v32
    v_lshl_add_u32 v7, v7, 2, v36
    ds_write_b8 v7, v30 offset:16
    v_and_b32 v9, -4, v37
    v_lshl_add_u32 v10, v37, 2, v9
    ds_write_b32 v10, v33
    v_lshl_add_u32 v9, v9, 2, v37
    ds_write_b8_d16_hi v9, v30 offset:16
    v_and_b32 v7, -4, v38
    v_lshl_add_u32 v8, v38, 2, v7
    ds_write_b32 v8, v34
    v_lshl_add_u32 v7, v7, 2, v38
    ds_write_b8 v7, v31 offset:16
    v_and_b32 v9, -4, v39
    v_lshl_add_u32 v10, v39, 2, v9
    ds_write_b32 v10, v35
    v_lshl_add_u32 v9, v9, 2, v39
    ds_write_b8_d16_hi v9, v31 offset:16
    s_add_u32 s47, s96, 0x7800000
    s_lshr_b32 s47, s47, 1
    buffer_load_dwordx2 v[108:109], v1, s[16:19], s47 offen nt
    s_add_u32 s44, s96, 0x7c00000
    s_lshr_b32 s44, s44, 1
    buffer_load_dwordx2 v[110:111], v1, s[16:19], s44 offen nt
    s_waitcnt vmcnt(4)
    v_lshlrev_b32 v7, 16, v106
    v_and_b32 v8, 0xffff0000, v106
    v_lshlrev_b32 v9, 16, v107
    v_and_b32 v10, 0xffff0000, v107
    v_mul_f32 v7, 0.15915494, v7
    v_mul_f32 v8, 0.15915494, v8
    v_mul_f32 v9, 0.15915494, v9
    v_mul_f32 v10, 0.15915494, v10
    v_mul_hi_u32_u24 v14, 429497, v60
    v_lshrrev_b32 v12, 3, v100
    v_cos_f32 v7, v7
    v_lshlrev_b16 v13, 3, v100
    v_mad_i32_i24 v11, v14, s55, v60
    v_bitop3_b32 v12, v6, v13, v12 bitop3:0xca
    v_lshl_add_u32 v11, v11, 17, s40
    v_lshlrev_b16 v14, 8, v14
    v_lshrrev_b32 v13, 2, v100
    v_add_u32 v60, v12, v11
    v_bitop3_b32 v100, v5, v13, v14 bitop3:0xea
    v_mul_hi_u32_u24 v14, 429497, v61
    v_lshrrev_b32 v12, 3, v101
    v_cos_f32 v8, v8
    v_lshlrev_b16 v13, 3, v101
    v_mad_i32_i24 v11, v14, s55, v61
    v_bitop3_b32 v12, v6, v13, v12 bitop3:0xca
    v_lshl_add_u32 v11, v11, 17, s40
    v_lshlrev_b16 v14, 8, v14
    v_lshrrev_b32 v13, 2, v101
    v_add_u32 v61, v12, v11
    v_bitop3_b32 v101, v5, v13, v14 bitop3:0xea
    v_cvt_pk_bf16_f32 v106, v7, v8
    v_perm_b32 v12, v106, v106, s41
    v_bitop3_b32 v60, v4, v12, v60 bitop3:0xca
    v_perm_b32 v13, v106, v106, s42
    v_bitop3_b32 v61, v4, v13, v61 bitop3:0xca
    v_mul_hi_u32_u24 v14, 429497, v62
    v_lshrrev_b32 v12, 3, v102
    v_cos_f32 v9, v9
    v_lshlrev_b16 v13, 3, v102
    v_mad_i32_i24 v11, v14, s55, v62
    v_bitop3_b32 v12, v6, v13, v12 bitop3:0xca
    v_lshl_add_u32 v11, v11, 17, s40
    v_lshlrev_b16 v14, 8, v14
    v_lshrrev_b32 v13, 2, v102
    v_add_u32 v62, v12, v11
    v_bitop3_b32 v102, v5, v13, v14 bitop3:0xea
    v_mul_hi_u32_u24 v14, 429497, v63
    v_lshrrev_b32 v12, 3, v103
    v_cos_f32 v10, v10
    v_lshlrev_b16 v13, 3, v103
    v_mad_i32_i24 v11, v14, s55, v63
    v_bitop3_b32 v12, v6, v13, v12 bitop3:0xca
    v_lshl_add_u32 v11, v11, 17, s40
    v_lshlrev_b16 v14, 8, v14
    v_lshrrev_b32 v13, 2, v103
    v_add_u32 v63, v12, v11
    v_bitop3_b32 v103, v5, v13, v14 bitop3:0xea
    v_cvt_pk_bf16_f32 v107, v9, v10
    v_perm_b32 v12, v107, v107, s41
    v_bitop3_b32 v62, v4, v12, v62 bitop3:0xca
    v_perm_b32 v13, v107, v107, s42
    v_bitop3_b32 v63, v4, v13, v63 bitop3:0xca
    v_add_u32 v7, s72, v0
    v_add_u32 v12, s73, v0
    v_add_u32 v13, s85, v0
    v_add_u32 v14, s91, v0
    v_add_u32 v15, s93, v0
    s_min_i32 s3, s72, s73
    s_min_i32 s3, s3, s85
    s_min_i32 s3, s3, s91
    s_min_i32 s3, s3, s93
    v_add_u32 v3, s3, v0
    v_mov_b32 v8, 0
    v_mov_b32 v9, 0
    v_mov_b32 v10, 0
    v_mov_b32 v11, 0
    s_waitcnt lgkmcnt(0)
    s_barrier
    ds_read_b128 v[116:119], v7 offset:0
    ds_read_b128 v[92:95], v12 offset:0
    ds_read_b128 v[16:19], v13 offset:0
    ds_read_b128 v[120:123], v14 offset:0
    ds_read_b128 v[44:47], v15 offset:0
    ds_write_b128 v3, v[8:11]
    ds_read_b128 v[20:23], v7 offset:16384
    ds_read_b128 v[124:127], v12 offset:16384
    ds_read_b128 v[32:35], v13 offset:16384
    ds_read_b128 v[36:39], v14 offset:16384
    ds_read_b128 v[28:31], v15 offset:16384
    s_waitcnt lgkmcnt(0)
    s_barrier
    s_setprio 3
    s_add_u32 s45, s35, 0x5484000
    s_add_u32 s45, s45, s72
    buffer_store_dwordx4 v[116:119], v0, s[20:23], s45 offen sc1
    s_add_u32 s46, s96, 0x7c00000
    s_nop 0
    v_lshlrev_b32 v116, 1, v1
    buffer_load_dwordx4 v[116:119], v116, s[8:11], s46 offen nt
    s_add_u32 s47, s35, 0x5484000
    s_add_u32 s47, s47, s73
    buffer_store_dwordx4 v[92:95], v0, s[20:23], s47 offen sc1
    s_add_u32 s44, s96, 0x7c00000
    s_nop 0
    v_lshlrev_b32 v92, 1, v1
    buffer_load_dwordx4 v[92:95], v92, s[12:15], s44 offen nt
    ds_add_u32 v24, v2
    ds_add_u32 v25, v2
    ds_add_u32 v26, v2
    ds_add_u32 v27, v2
    ds_add_u32 v52, v2
    ds_add_u32 v53, v2
    ds_add_u32 v54, v2
    ds_add_u32 v55, v2
    s_setprio 2
    ds_add_u32 v72, v2
    ds_add_u32 v73, v2
    ds_add_u32 v74, v2
    ds_add_u32 v75, v2
    ds_add_u32 v80, v2
    ds_add_u32 v81, v2
    ds_add_u32 v82, v2
    ds_add_u32 v83, v2
    s_setprio 1
    s_add_u32 s45, s35, 0x5484000
    s_add_u32 s45, s45, s85
    buffer_store_dwordx4 v[16:19], v0, s[20:23], s45 offen sc1
    s_add_u32 s46, s96, 0x8000000
    s_nop 0
    v_lshlrev_b32 v16, 1, v1
    buffer_load_dwordx4 v[16:19], v16, s[8:11], s46 offen nt
    ds_add_u32 v96, v2
    ds_add_u32 v97, v2
    ds_add_u32 v98, v2
    ds_add_u32 v99, v2
    s_mov_b32 s68, s66
    s_mov_b32 s69, s67
    s_mov_b32 s70, 0x100
    s_mov_b32 s71, 0x20000
    v_mov_b32 v3, 1
    s_cmp_lg_u32 s32, 15
    s_cbranch_scc1 L1_tk
    s_mov_b64 exec, 1
    s_and_b32 s3, s2, 1
    s_lshl_b32 s3, s3, 7
    buffer_atomic_add v3, off, s[68:71], s3 sc0
    s_mov_b64 exec, -1
L1_tk:
    ds_add_u32 v100, v2
    ds_add_u32 v101, v2
    ds_add_u32 v102, v2
    ds_add_u32 v103, v2
    s_setprio 0
    s_waitcnt vmcnt(6)
    v_lshlrev_b32 v7, 16, v108
    v_and_b32 v8, 0xffff0000, v108
    v_lshlrev_b32 v9, 16, v109
    v_and_b32 v10, 0xffff0000, v109
    v_mul_f32 v7, 0.15915494, v7
    v_mul_f32 v8, 0.15915494, v8
    v_mul_f32 v9, 0.15915494, v9
    v_mul_f32 v10, 0.15915494, v10
    v_mul_hi_u32_u24 v14, 429497, v112
    v_lshrrev_b32 v12, 3, v88
    v_cos_f32 v7, v7
    v_lshlrev_b16 v13, 3, v88
    v_mad_i32_i24 v11, v14, s55, v112
    v_bitop3_b32 v12, v6, v13, v12 bitop3:0xca
    v_lshl_add_u32 v11, v11, 17, s40
    v_lshlrev_b16 v14, 8, v14
    v_lshrrev_b32 v13, 2, v88
    v_add_u32 v112, v12, v11
    v_bitop3_b32 v88, v5, v13, v14 bitop3:0xea
    ds_add_u32 v88, v2
    v_mul_hi_u32_u24 v14, 429497, v113
    v_lshrrev_b32 v12, 3, v89
    v_cos_f32 v8, v8
    v_lshlrev_b16 v13, 3, v89
    v_mad_i32_i24 v11, v14, s55, v113
    v_bitop3_b32 v12, v6, v13, v12 bitop3:0xca
    v_lshl_add_u32 v11, v11, 17, s40
    v_lshlrev_b16 v14, 8, v14
    v_lshrrev_b32 v13, 2, v89
    v_add_u32 v113, v12, v11
    v_bitop3_b32 v89, v5, v13, v14 bitop3:0xea
    ds_add_u32 v89, v2
    v_cvt_pk_bf16_f32 v108, v7, v8
    v_perm_b32 v12, v108, v108, s41
    v_bitop3_b32 v112, v4, v12, v112 bitop3:0xca
    v_perm_b32 v13, v108, v108, s42
    v_bitop3_b32 v113, v4, v13, v113 bitop3:0xca
    v_mul_hi_u32_u24 v14, 429497, v114
    v_lshrrev_b32 v12, 3, v90
    v_cos_f32 v9, v9
    v_lshlrev_b16 v13, 3, v90
    v_mad_i32_i24 v11, v14, s55, v114
    v_bitop3_b32 v12, v6, v13, v12 bitop3:0xca
    v_lshl_add_u32 v11, v11, 17, s40
    v_lshlrev_b16 v14, 8, v14
    v_lshrrev_b32 v13, 2, v90
    v_add_u32 v114, v12, v11
    v_bitop3_b32 v90, v5, v13, v14 bitop3:0xea
    ds_add_u32 v90, v2
    v_mul_hi_u32_u24 v14, 429497, v115
    v_lshrrev_b32 v12, 3, v91
    v_cos_f32 v10, v10
    v_lshlrev_b16 v13, 3, v91
    v_mad_i32_i24 v11, v14, s55, v115
    v_bitop3_b32 v12, v6, v13, v12 bitop3:0xca
    v_lshl_add_u32 v11, v11, 17, s40
    v_lshlrev_b16 v14, 8, v14
    v_lshrrev_b32 v13, 2, v91
    v_add_u32 v115, v12, v11
    v_bitop3_b32 v91, v5, v13, v14 bitop3:0xea
    ds_add_u32 v91, v2
    v_cvt_pk_bf16_f32 v109, v9, v10
    v_perm_b32 v12, v109, v109, s41
    v_bitop3_b32 v114, v4, v12, v114 bitop3:0xca
    v_perm_b32 v13, v109, v109, s42
    v_bitop3_b32 v115, v4, v13, v115 bitop3:0xca
    s_waitcnt vmcnt(2)
    v_lshlrev_b32 v7, 16, v110
    v_and_b32 v8, 0xffff0000, v110
    v_lshlrev_b32 v9, 16, v111
    v_and_b32 v10, 0xffff0000, v111
    v_mul_f32 v7, 0.15915494, v7
    v_mul_f32 v8, 0.15915494, v8
    v_mul_f32 v9, 0.15915494, v9
    v_mul_f32 v10, 0.15915494, v10
    v_mul_hi_u32_u24 v14, 429497, v116
    v_lshrrev_b32 v12, 3, v92
    v_cos_f32 v7, v7
    v_lshlrev_b16 v13, 3, v92
    v_mad_i32_i24 v11, v14, s55, v116
    v_bitop3_b32 v12, v6, v13, v12 bitop3:0xca
    v_lshl_add_u32 v11, v11, 17, s40
    v_lshlrev_b16 v14, 8, v14
    v_lshrrev_b32 v13, 2, v92
    v_add_u32 v116, v12, v11
    v_bitop3_b32 v92, v5, v13, v14 bitop3:0xea
    ds_add_u32 v92, v2
    v_mul_hi_u32_u24 v14, 429497, v117
    v_lshrrev_b32 v12, 3, v93
    v_cos_f32 v8, v8
    v_lshlrev_b16 v13, 3, v93
    v_mad_i32_i24 v11, v14, s55, v117
    v_bitop3_b32 v12, v6, v13, v12 bitop3:0xca
    v_lshl_add_u32 v11, v11, 17, s40
    v_lshlrev_b16 v14, 8, v14
    v_lshrrev_b32 v13, 2, v93
    v_add_u32 v117, v12, v11
    v_bitop3_b32 v93, v5, v13, v14 bitop3:0xea
    ds_add_u32 v93, v2
    v_cvt_pk_bf16_f32 v110, v7, v8
    v_perm_b32 v12, v110, v110, s41
    v_bitop3_b32 v116, v4, v12, v116 bitop3:0xca
    v_perm_b32 v13, v110, v110, s42
    v_bitop3_b32 v117, v4, v13, v117 bitop3:0xca
    v_mul_hi_u32_u24 v14, 429497, v118
    v_lshrrev_b32 v12, 3, v94
    v_cos_f32 v9, v9
    v_lshlrev_b16 v13, 3, v94
    v_mad_i32_i24 v11, v14, s55, v118
    v_bitop3_b32 v12, v6, v13, v12 bitop3:0xca
    v_lshl_add_u32 v11, v11, 17, s40
    v_lshlrev_b16 v14, 8, v14
    v_lshrrev_b32 v13, 2, v94
    v_add_u32 v118, v12, v11
    v_bitop3_b32 v94, v5, v13, v14 bitop3:0xea
    ds_add_u32 v94, v2
    v_mul_hi_u32_u24 v14, 429497, v119
    v_lshrrev_b32 v12, 3, v95
    v_cos_f32 v10, v10
    v_lshlrev_b16 v13, 3, v95
    v_mad_i32_i24 v11, v14, s55, v119
    v_bitop3_b32 v12, v6, v13, v12 bitop3:0xca
    v_lshl_add_u32 v11, v11, 17, s40
    v_lshlrev_b16 v14, 8, v14
    v_lshrrev_b32 v13, 2, v95
    v_add_u32 v119, v12, v11
    v_bitop3_b32 v95, v5, v13, v14 bitop3:0xea
    ds_add_u32 v95, v2
    v_cvt_pk_bf16_f32 v111, v9, v10
    v_perm_b32 v12, v111, v111, s41
    v_bitop3_b32 v118, v4, v12, v118 bitop3:0xca
    v_perm_b32 v13, v111, v111, s42
    v_bitop3_b32 v119, v4, v13, v119 bitop3:0xca
    v_lshrrev_b32 v8, 2, v0
    v_and_b32 v7, 0x3c00, v0
    v_bitop3_b32 v7, v5, v8, v7 bitop3:0xea
    s_waitcnt lgkmcnt(0)
    s_barrier
    ds_read2st64_b32 v[8:9], v7 offset0:0 offset1:1
    ds_read2st64_b32 v[10:11], v7 offset0:2 offset1:3
    s_add_u32 s47, s35, 0x5484000
    s_add_u32 s47, s47, s91
    buffer_store_dwordx4 v[120:123], v0, s[20:23], s47 offen sc1
    s_add_u32 s44, s96, 0x8000000
    s_nop 0
    v_lshlrev_b32 v120, 1, v1
    buffer_load_dwordx4 v[120:123], v120, s[12:15], s44 offen nt
    s_waitcnt lgkmcnt(0)
    v_lshl_or_b32 v12, v9, 16, v8
    v_lshl_or_b32 v13, v11, 16, v10
    v_mov_b32 v14, v12
    v_mov_b32 v15, v13
    s_nop 0
    v_add_u32_dpp v14, v14, v14 row_shr:1 row_mask:0xf bank_mask:0xf bound_ctrl:1
    v_add_u32_dpp v15, v15, v15 row_shr:1 row_mask:0xf bank_mask:0xf bound_ctrl:1
    s_nop 0
    v_add_u32_dpp v14, v14, v14 row_shr:2 row_mask:0xf bank_mask:0xf bound_ctrl:1
    v_add_u32_dpp v15, v15, v15 row_shr:2 row_mask:0xf bank_mask:0xf bound_ctrl:1
    s_nop 0
    v_add_u32_dpp v14, v14, v14 row_shr:4 row_mask:0xf bank_mask:0xf bound_ctrl:1
    v_add_u32_dpp v15, v15, v15 row_shr:4 row_mask:0xf bank_mask:0xf bound_ctrl:1
    s_nop 0
    v_add_u32_dpp v14, v14, v14 row_shr:8 row_mask:0xf bank_mask:0xf bound_ctrl:1
    v_add_u32_dpp v15, v15, v15 row_shr:8 row_mask:0xf bank_mask:0xf bound_ctrl:1
    s_nop 0
    v_add_u32_dpp v14, v14, v14 row_bcast:15 row_mask:0xa bank_mask:0xf
    v_add_u32_dpp v15, v15, v15 row_bcast:15 row_mask:0xa bank_mask:0xf
    s_nop 0
    v_add_u32_dpp v14, v14, v14 row_bcast:31 row_mask:0xc bank_mask:0xf
    v_add_u32_dpp v15, v15, v15 row_bcast:31 row_mask:0xc bank_mask:0xf
    v_readlane_b32 s48, v14, 63
    v_readlane_b32 s49, v15, 63
    s_lshl_b32 s54, s32, 2
    v_mov_b32 v8, s54
    s_and_b32 s50, s48, 0xffff
    s_lshr_b32 s51, s48, 16
    s_and_b32 s52, s49, 0xffff
    s_lshr_b32 s53, s49, 16
    s_add_u32 s51, s51, s50
    s_add_u32 s52, s52, s51
    s_add_u32 s53, s53, s52
    v_mov_b32 v9, s53
    s_mov_b64 exec, 1
    ds_write_b32 v8, v9 offset:16384
    s_cmp_lg_u32 s32, 15
    s_cbranch_scc1 L1_tk2
    s_waitcnt vmcnt(1)
L1_tk2:
    ds_write_b32 v8, v3 offset:16448
    s_mov_b64 exec, -1
    v_and_b32 v8, 60, v7
    s_waitcnt lgkmcnt(0)
    s_barrier
    ds_read_b32 v9, v8 offset:16384
    ds_read_b32 v10, v8 offset:16448
    s_waitcnt lgkmcnt(0)
    v_readlane_b32 s84, v10, 15
    s_and_b32 s3, s2, 1
    s_lshl_b32 s3, s3, 7
    s_add_u32 s84, s84, s3
    s_and_b32 s4, s84, 127
    s_lshl_b32 s6, s32, 10
    s_mov_b32 s43, 5
    s_bitcmp1_b32 s2, 0
    s_cselect_b32 s5, 128, 0
    s_mov_b32 s7, 128
    s_cselect_b32 s7, 124, s7
    s_add_u32 s5, s5, s4
    s_add_u32 s5, s5, 9472
    s_lshl_b32 s5, s5, 14
    s_add_u32 s38, s5, s6
    s_cmp_lt_u32 s4, s7
    s_addc_u32 s43, s43, 0
    s_bitcmp1_b32 s2, 0
    s_cselect_b32 s5, 112, 0
    s_mov_b32 s7, 112
    s_cselect_b32 s7, 100, s7
    s_add_u32 s5, s5, s4
    s_add_u32 s5, s5, 9724
    s_lshl_b32 s5, s5, 14
    s_add_u32 s39, s5, s6
    s_cmp_lt_u32 s4, s7
    s_addc_u32 s43, s43, 0
    s_bitcmp1_b32 s2, 0
    s_cselect_b32 s5, 64, 0
    s_mov_b32 s7, 64
    s_cselect_b32 s7, 0, s7
    s_add_u32 s5, s5, s4
    s_add_u32 s5, s5, 9936
    s_lshl_b32 s5, s5, 14
    s_add_u32 s58, s5, s6
    s_cmp_lt_u32 s4, s7
    s_addc_u32 s43, s43, 0
    v_add_u32_dpp v9, v9, v9 row_shr:1 row_mask:0xf bank_mask:0xf bound_ctrl:1
    s_nop 1
    v_add_u32_dpp v9, v9, v9 row_shr:2 row_mask:0xf bank_mask:0xf bound_ctrl:1
    s_nop 1
    v_add_u32_dpp v9, v9, v9 row_shr:4 row_mask:0xf bank_mask:0xf bound_ctrl:1
    s_nop 1
    v_add_u32_dpp v9, v9, v9 row_shr:8 row_mask:0xf bank_mask:0xf bound_ctrl:1
    s_nop 0
    v_readlane_b32 s54, v9, s32
    s_sub_u32 s54, s54, s53
    s_add_u32 s50, s50, s54
    s_add_u32 s51, s51, s54
    s_add_u32 s52, s52, s54
    s_pack_ll_b32_b16 s48, s54, s50
    s_pack_ll_b32_b16 s49, s51, s52
    v_add_u32 v14, s48, v14
    v_add_u32 v15, s49, v15
    v_sub_u32 v12, v14, v12
    v_sub_u32 v13, v15, v13
    v_and_b32 v8, 0xffff, v12
    v_lshrrev_b32 v9, 16, v12
    v_and_b32 v10, 0xffff, v13
    v_lshrrev_b32 v11, 16, v13
    ds_write2st64_b32 v7, v8, v9 offset0:0 offset1:1
    ds_write2st64_b32 v7, v10, v11 offset0:2 offset1:3
    v_and_b32 v8, 0x3f0, v0
    v_lshl_add_u32 v8, v8, 1, s36
    ds_write_b64 v8, v[12:13] offset:20480
    s_bitset0_b64 exec, 63
    s_not_b64 exec, exec
    ds_write_b64 v8, v[14:15] offset:20512
    s_mov_b64 exec, -1
    s_waitcnt lgkmcnt(0)
    s_barrier
    s_setprio 3
    ds_add_rtn_u32 v24, v24, v2
    ds_add_rtn_u32 v25, v25, v2
    ds_add_rtn_u32 v26, v26, v2
    ds_add_rtn_u32 v27, v27, v2
    ds_read_b128 v[12:15], v0 offset:20480
    v_cmp_gt_u32 vcc, 8448, v0
    s_add_u32 s45, s35, 0x5484000
    s_add_u32 s45, s45, s93
    buffer_store_dwordx4 v[44:47], v0, s[20:23], s45 offen sc1
    s_add_u32 s46, s96, 0x8000000
    s_lshr_b32 s46, s46, 1
    buffer_load_dwordx2 v[44:45], v1, s[16:19], s46 offen nt
    s_add_u32 s47, s96, 0x8400000
    s_lshr_b32 s47, s47, 1
    buffer_load_dwordx2 v[46:47], v1, s[16:19], s47 offen nt
    ds_add_rtn_u32 v52, v52, v2
    ds_add_rtn_u32 v53, v53, v2
    ds_add_rtn_u32 v54, v54, v2
    ds_add_rtn_u32 v55, v55, v2
    s_setprio 2
    ds_add_rtn_u32 v72, v72, v2
    ds_add_rtn_u32 v73, v73, v2
    ds_add_rtn_u32 v74, v74, v2
    ds_add_rtn_u32 v75, v75, v2
    s_waitcnt lgkmcnt(8)
    s_cbranch_vccz L1_p4
    s_add_u32 s44, s35, 0x7ec0000
    s_mov_b64 exec, vcc
    buffer_store_dwordx4 v[12:15], v0, s[24:27], s44 offen sc1
    s_mov_b64 exec, -1
L1_p4:
    s_add_u32 s45, s35, 0x5488000
    s_add_u32 s45, s45, s72
    buffer_store_dwordx4 v[20:23], v0, s[20:23], s45 offen sc1
    s_add_u32 s46, s96, 0x8400000
    s_nop 0
    v_lshlrev_b32 v20, 1, v1
    buffer_load_dwordx4 v[20:23], v20, s[8:11], s46 offen nt
    ds_add_rtn_u32 v80, v80, v2
    ds_add_rtn_u32 v81, v81, v2
    ds_add_rtn_u32 v82, v82, v2
    ds_add_rtn_u32 v83, v83, v2
    s_setprio 1
    ds_add_rtn_u32 v96, v96, v2
    ds_add_rtn_u32 v97, v97, v2
    ds_add_rtn_u32 v98, v98, v2
    ds_add_rtn_u32 v99, v99, v2
    ds_add_rtn_u32 v100, v100, v2
    ds_add_rtn_u32 v101, v101, v2
    ds_add_rtn_u32 v102, v102, v2
    ds_add_rtn_u32 v103, v103, v2
    s_add_u32 s47, s35, 0x5488000
    s_add_u32 s47, s47, s73
    buffer_store_dwordx4 v[124:127], v0, s[20:23], s47 offen sc1
    s_add_u32 s44, s96, 0x8400000
    s_nop 0
    v_lshlrev_b32 v124, 1, v1
    buffer_load_dwordx4 v[124:127], v124, s[12:15], s44 offen nt
    s_setprio 0
    ds_add_rtn_u32 v88, v88, v2
    ds_add_rtn_u32 v89, v89, v2
    ds_add_rtn_u32 v90, v90, v2
    ds_add_rtn_u32 v91, v91, v2
    ds_add_rtn_u32 v92, v92, v2
    ds_add_rtn_u32 v93, v93, v2
    ds_add_rtn_u32 v94, v94, v2
    ds_add_rtn_u32 v95, v95, v2
    s_waitcnt lgkmcnt(0)
    s_barrier
    s_setprio 3
    v_and_b32 v7, -4, v24
    v_lshl_add_u32 v8, v24, 2, v7
    ds_write_b32 v8, v40
    v_lshl_add_u32 v7, v7, 2, v24
    ds_write_b8 v7, v84 offset:16
    v_and_b32 v9, -4, v25
    v_lshl_add_u32 v10, v25, 2, v9
    ds_write_b32 v10, v41
    v_lshl_add_u32 v9, v9, 2, v25
    ds_write_b8_d16_hi v9, v84 offset:16
    v_and_b32 v7, -4, v26
    v_lshl_add_u32 v8, v26, 2, v7
    ds_write_b32 v8, v42
    v_lshl_add_u32 v7, v7, 2, v26
    ds_write_b8 v7, v85 offset:16
    v_and_b32 v9, -4, v27
    v_lshl_add_u32 v10, v27, 2, v9
    ds_write_b32 v10, v43
    v_lshl_add_u32 v9, v9, 2, v27
    ds_write_b8_d16_hi v9, v85 offset:16
    s_add_u32 s45, s35, 0x5488000
    s_add_u32 s45, s45, s85
    buffer_store_dwordx4 v[32:35], v0, s[20:23], s45 offen sc1
    s_add_u32 s46, s96, 0x8800000
    v_lshlrev_b32 v40, 1, v1
    buffer_load_dwordx4 v[40:43], v40, s[8:11], s46 offen nt
    s_add_u32 s47, s96, 0x8800000
    v_lshlrev_b32 v24, 1, v1
    buffer_load_dwordx4 v[24:27], v24, s[12:15], s47 offen nt
    v_and_b32 v7, -4, v52
    v_lshl_add_u32 v8, v52, 2, v7
    ds_write_b32 v8, v48
    v_lshl_add_u32 v7, v7, 2, v52
    ds_write_b8 v7, v86 offset:16
    v_and_b32 v9, -4, v53
    v_lshl_add_u32 v10, v53, 2, v9
    ds_write_b32 v10, v49
    v_lshl_add_u32 v9, v9, 2, v53
    ds_write_b8_d16_hi v9, v86 offset:16
    v_and_b32 v7, -4, v54
    v_lshl_add_u32 v8, v54, 2, v7
    ds_write_b32 v8, v50
    v_lshl_add_u32 v7, v7, 2, v54
    ds_write_b8 v7, v87 offset:16
    v_and_b32 v9, -4, v55
    v_lshl_add_u32 v10, v55, 2, v9
    ds_write_b32 v10, v51
    v_lshl_add_u32 v9, v9, 2, v55
    ds_write_b8_d16_hi v9, v87 offset:16
    s_add_u32 s44, s96, 0x8800000
    s_lshr_b32 s44, s44, 1
    buffer_load_dwordx2 v[32:33], v1, s[16:19], s44 offen nt
    s_add_u32 s45, s96, 0x8c00000
    s_lshr_b32 s45, s45, 1
    buffer_load_dwordx2 v[34:35], v1, s[16:19], s45 offen nt
    s_add_u32 s46, s96, 0x8c00000
    v_lshlrev_b32 v48, 1, v1
    buffer_load_dwordx4 v[48:51], v48, s[8:11], s46 offen nt
    s_waitcnt vmcnt(10)
    v_lshlrev_b32 v7, 16, v44
    v_and_b32 v8, 0xffff0000, v44
    v_lshlrev_b32 v9, 16, v45
    v_and_b32 v10, 0xffff0000, v45
    v_mul_f32 v7, 0.15915494, v7
    v_mul_f32 v8, 0.15915494, v8
    v_mul_f32 v9, 0.15915494, v9
    v_mul_f32 v10, 0.15915494, v10
    v_mul_hi_u32_u24 v14, 429497, v16
    v_lshrrev_b32 v12, 3, v120
    v_cos_f32 v7, v7
    v_lshlrev_b16 v13, 3, v120
    v_mad_i32_i24 v11, v14, s55, v16
    v_bitop3_b32 v12, v6, v13, v12 bitop3:0xca
    v_lshl_add_u32 v11, v11, 17, s40
    v_lshlrev_b16 v14, 8, v14
    v_lshrrev_b32 v13, 2, v120
    v_add_u32 v16, v12, v11
    v_bitop3_b32 v120, v5, v13, v14 bitop3:0xea
    v_mul_hi_u32_u24 v14, 429497, v17
    v_lshrrev_b32 v12, 3, v121
    v_cos_f32 v8, v8
    v_lshlrev_b16 v13, 3, v121
    v_mad_i32_i24 v11, v14, s55, v17
    v_bitop3_b32 v12, v6, v13, v12 bitop3:0xca
    v_lshl_add_u32 v11, v11, 17, s40
    v_lshlrev_b16 v14, 8, v14
    v_lshrrev_b32 v13, 2, v121
    v_add_u32 v17, v12, v11
    v_bitop3_b32 v121, v5, v13, v14 bitop3:0xea
    v_cvt_pk_bf16_f32 v44, v7, v8
    v_perm_b32 v12, v44, v44, s41
    v_bitop3_b32 v16, v4, v12, v16 bitop3:0xca
    v_perm_b32 v13, v44, v44, s42
    v_bitop3_b32 v17, v4, v13, v17 bitop3:0xca
    v_mul_hi_u32_u24 v14, 429497, v18
    v_lshrrev_b32 v12, 3, v122
    v_cos_f32 v9, v9
    v_lshlrev_b16 v13, 3, v122
    v_mad_i32_i24 v11, v14, s55, v18
    v_bitop3_b32 v12, v6, v13, v12 bitop3:0xca
    v_lshl_add_u32 v11, v11, 17, s40
    v_lshlrev_b16 v14, 8, v14
    v_lshrrev_b32 v13, 2, v122
    v_add_u32 v18, v12, v11
    v_bitop3_b32 v122, v5, v13, v14 bitop3:0xea
    v_mul_hi_u32_u24 v14, 429497, v19
    v_lshrrev_b32 v12, 3, v123
    v_cos_f32 v10, v10
    v_lshlrev_b16 v13, 3, v123
    v_mad_i32_i24 v11, v14, s55, v19
    v_bitop3_b32 v12, v6, v13, v12 bitop3:0xca
    v_lshl_add_u32 v11, v11, 17, s40
    v_lshlrev_b16 v14, 8, v14
    v_lshrrev_b32 v13, 2, v123
    v_add_u32 v19, v12, v11
    v_bitop3_b32 v123, v5, v13, v14 bitop3:0xea
    v_cvt_pk_bf16_f32 v45, v9, v10
    v_perm_b32 v12, v45, v45, s41
    v_bitop3_b32 v18, v4, v12, v18 bitop3:0xca
    v_perm_b32 v13, v45, v45, s42
    v_bitop3_b32 v19, v4, v13, v19 bitop3:0xca
    s_setprio 2
    v_and_b32 v7, -4, v72
    v_lshl_add_u32 v8, v72, 2, v7
    ds_write_b32 v8, v68
    v_lshl_add_u32 v7, v7, 2, v72
    ds_write_b8 v7, v56 offset:16
    v_and_b32 v9, -4, v73
    v_lshl_add_u32 v10, v73, 2, v9
    ds_write_b32 v10, v69
    v_lshl_add_u32 v9, v9, 2, v73
    ds_write_b8_d16_hi v9, v56 offset:16
    v_and_b32 v7, -4, v74
    v_lshl_add_u32 v8, v74, 2, v7
    ds_write_b32 v8, v70
    v_lshl_add_u32 v7, v7, 2, v74
    ds_write_b8 v7, v57 offset:16
    v_and_b32 v9, -4, v75
    v_lshl_add_u32 v10, v75, 2, v9
    ds_write_b32 v10, v71
    v_lshl_add_u32 v9, v9, 2, v75
    ds_write_b8_d16_hi v9, v57 offset:16
    s_add_u32 s47, s35, 0x5488000
    s_add_u32 s47, s47, s91
    buffer_store_dwordx4 v[36:39], v0, s[20:23], s47 offen sc1
    s_add_u32 s44, s96, 0x8c00000
    v_lshlrev_b32 v52, 1, v1
    buffer_load_dwordx4 v[52:55], v52, s[12:15], s44 offen nt
    s_waitcnt vmcnt(8)
    v_lshlrev_b32 v7, 16, v46
    v_and_b32 v8, 0xffff0000, v46
    v_lshlrev_b32 v9, 16, v47
    v_and_b32 v10, 0xffff0000, v47
    v_mul_f32 v7, 0.15915494, v7
    v_mul_f32 v8, 0.15915494, v8
    v_mul_f32 v9, 0.15915494, v9
    v_mul_f32 v10, 0.15915494, v10
    v_mul_hi_u32_u24 v14, 429497, v20
    v_lshrrev_b32 v12, 3, v124
    v_cos_f32 v7, v7
    v_lshlrev_b16 v13, 3, v124
    v_mad_i32_i24 v11, v14, s55, v20
    v_bitop3_b32 v12, v6, v13, v12 bitop3:0xca
    v_lshl_add_u32 v11, v11, 17, s40
    v_lshlrev_b16 v14, 8, v14
    v_lshrrev_b32 v13, 2, v124
    v_add_u32 v20, v12, v11
    v_bitop3_b32 v124, v5, v13, v14 bitop3:0xea
    v_mul_hi_u32_u24 v14, 429497, v21
    v_lshrrev_b32 v12, 3, v125
    v_cos_f32 v8, v8
    v_lshlrev_b16 v13, 3, v125
    v_mad_i32_i24 v11, v14, s55, v21
    v_bitop3_b32 v12, v6, v13, v12 bitop3:0xca
    v_lshl_add_u32 v11, v11, 17, s40
    v_lshlrev_b16 v14, 8, v14
    v_lshrrev_b32 v13, 2, v125
    v_add_u32 v21, v12, v11
    v_bitop3_b32 v125, v5, v13, v14 bitop3:0xea
    v_cvt_pk_bf16_f32 v46, v7, v8
    v_perm_b32 v12, v46, v46, s41
    v_bitop3_b32 v20, v4, v12, v20 bitop3:0xca
    v_perm_b32 v13, v46, v46, s42
    v_bitop3_b32 v21, v4, v13, v21 bitop3:0xca
    v_mul_hi_u32_u24 v14, 429497, v22
    v_lshrrev_b32 v12, 3, v126
    v_cos_f32 v9, v9
    v_lshlrev_b16 v13, 3, v126
    v_mad_i32_i24 v11, v14, s55, v22
    v_bitop3_b32 v12, v6, v13, v12 bitop3:0xca
    v_lshl_add_u32 v11, v11, 17, s40
    v_lshlrev_b16 v14, 8, v14
    v_lshrrev_b32 v13, 2, v126
    v_add_u32 v22, v12, v11
    v_bitop3_b32 v126, v5, v13, v14 bitop3:0xea
    v_mul_hi_u32_u24 v14, 429497, v23
    v_lshrrev_b32 v12, 3, v127
    v_cos_f32 v10, v10
    v_lshlrev_b16 v13, 3, v127
    v_mad_i32_i24 v11, v14, s55, v23
    v_bitop3_b32 v12, v6, v13, v12 bitop3:0xca
    v_lshl_add_u32 v11, v11, 17, s40
    v_lshlrev_b16 v14, 8, v14
    v_lshrrev_b32 v13, 2, v127
    v_add_u32 v23, v12, v11
    v_bitop3_b32 v127, v5, v13, v14 bitop3:0xea
    v_cvt_pk_bf16_f32 v47, v9, v10
    v_perm_b32 v12, v47, v47, s41
    v_bitop3_b32 v22, v4, v12, v22 bitop3:0xca
    v_perm_b32 v13, v47, v47, s42
    v_bitop3_b32 v23, v4, v13, v23 bitop3:0xca
    v_and_b32 v7, -4, v80
    v_lshl_add_u32 v8, v80, 2, v7
    ds_write_b32 v8, v76
    v_lshl_add_u32 v7, v7, 2, v80
    ds_write_b8 v7, v58 offset:16
    v_and_b32 v9, -4, v81
    v_lshl_add_u32 v10, v81, 2, v9
    ds_write_b32 v10, v77
    v_lshl_add_u32 v9, v9, 2, v81
    ds_write_b8_d16_hi v9, v58 offset:16
    v_and_b32 v7, -4, v82
    v_lshl_add_u32 v8, v82, 2, v7
    ds_write_b32 v8, v78
    v_lshl_add_u32 v7, v7, 2, v82
    ds_write_b8 v7, v59 offset:16
    v_and_b32 v9, -4, v83
    v_lshl_add_u32 v10, v83, 2, v9
    ds_write_b32 v10, v79
    v_lshl_add_u32 v9, v9, 2, v83
    ds_write_b8_d16_hi v9, v59 offset:16
    s_add_u32 s45, s96, 0x9000000
    v_lshlrev_b32 v84, 1, v1
    buffer_load_dwordx4 v[84:87], v84, s[8:11], s45 offen nt
    s_add_u32 s46, s96, 0x9000000
    v_lshlrev_b32 v68, 1, v1
    buffer_load_dwordx4 v[68:71], v68, s[12:15], s46 offen nt
    s_waitcnt vmcnt(5)
    v_lshlrev_b32 v7, 16, v32
    v_and_b32 v8, 0xffff0000, v32
    v_lshlrev_b32 v9, 16, v33
    v_and_b32 v10, 0xffff0000, v33
    v_mul_f32 v7, 0.15915494, v7
    v_mul_f32 v8, 0.15915494, v8
    v_mul_f32 v9, 0.15915494, v9
    v_mul_f32 v10, 0.15915494, v10
    v_mul_hi_u32_u24 v14, 429497, v40
    v_lshrrev_b32 v12, 3, v24
    v_cos_f32 v7, v7
    v_lshlrev_b16 v13, 3, v24
    v_mad_i32_i24 v11, v14, s55, v40
    v_bitop3_b32 v12, v6, v13, v12 bitop3:0xca
    v_lshl_add_u32 v11, v11, 17, s40
    v_lshlrev_b16 v14, 8, v14
    v_lshrrev_b32 v13, 2, v24
    v_add_u32 v40, v12, v11
    v_bitop3_b32 v24, v5, v13, v14 bitop3:0xea
    v_mul_hi_u32_u24 v14, 429497, v41
    v_lshrrev_b32 v12, 3, v25
    v_cos_f32 v8, v8
    v_lshlrev_b16 v13, 3, v25
    v_mad_i32_i24 v11, v14, s55, v41
    v_bitop3_b32 v12, v6, v13, v12 bitop3:0xca
    v_lshl_add_u32 v11, v11, 17, s40
    v_lshlrev_b16 v14, 8, v14
    v_lshrrev_b32 v13, 2, v25
    v_add_u32 v41, v12, v11
    v_bitop3_b32 v25, v5, v13, v14 bitop3:0xea
    v_cvt_pk_bf16_f32 v32, v7, v8
    v_perm_b32 v12, v32, v32, s41
    v_bitop3_b32 v40, v4, v12, v40 bitop3:0xca
    v_perm_b32 v13, v32, v32, s42
    v_bitop3_b32 v41, v4, v13, v41 bitop3:0xca
    v_mul_hi_u32_u24 v14, 429497, v42
    v_lshrrev_b32 v12, 3, v26
    v_cos_f32 v9, v9
    v_lshlrev_b16 v13, 3, v26
    v_mad_i32_i24 v11, v14, s55, v42
    v_bitop3_b32 v12, v6, v13, v12 bitop3:0xca
    v_lshl_add_u32 v11, v11, 17, s40
    v_lshlrev_b16 v14, 8, v14
    v_lshrrev_b32 v13, 2, v26
    v_add_u32 v42, v12, v11
    v_bitop3_b32 v26, v5, v13, v14 bitop3:0xea
    v_mul_hi_u32_u24 v14, 429497, v43
    v_lshrrev_b32 v12, 3, v27
    v_cos_f32 v10, v10
    v_lshlrev_b16 v13, 3, v27
    v_mad_i32_i24 v11, v14, s55, v43
    v_bitop3_b32 v12, v6, v13, v12 bitop3:0xca
    v_lshl_add_u32 v11, v11, 17, s40
    v_lshlrev_b16 v14, 8, v14
    v_lshrrev_b32 v13, 2, v27
    v_add_u32 v43, v12, v11
    v_bitop3_b32 v27, v5, v13, v14 bitop3:0xea
    v_cvt_pk_bf16_f32 v33, v9, v10
    v_perm_b32 v12, v33, v33, s41
    v_bitop3_b32 v42, v4, v12, v42 bitop3:0xca
    v_perm_b32 v13, v33, v33, s42
    v_bitop3_b32 v43, v4, v13, v43 bitop3:0xca
    s_setprio 1
    v_and_b32 v7, -4, v96
    v_lshl_add_u32 v8, v96, 2, v7
    ds_write_b32 v8, v64
    v_lshl_add_u32 v7, v7, 2, v96
    ds_write_b8 v7, v104 offset:16
    v_and_b32 v9, -4, v97
    v_lshl_add_u32 v10, v97, 2, v9
    ds_write_b32 v10, v65
    v_lshl_add_u32 v9, v9, 2, v97
    ds_write_b8_d16_hi v9, v104 offset:16
    v_and_b32 v7, -4, v98
    v_lshl_add_u32 v8, v98, 2, v7
    ds_write_b32 v8, v66
    v_lshl_add_u32 v7, v7, 2, v98
    ds_write_b8 v7, v105 offset:16
    v_and_b32 v9, -4, v99
    v_lshl_add_u32 v10, v99, 2, v9
    ds_write_b32 v10, v67
    v_lshl_add_u32 v9, v9, 2, v99
    ds_write_b8_d16_hi v9, v105 offset:16
    s_add_u32 s47, s96, 0x9000000
    s_lshr_b32 s47, s47, 1
    buffer_load_dwordx2 v[72:73], v1, s[16:19], s47 offen nt
    s_cmp_le_u32 s43, 5
    s_cselect_b32 s18, 0, s18
    s_add_u32 s44, s38, 0x0
    s_lshr_b32 s44, s44, 1
    buffer_load_dwordx2 v[74:75], v1, s[16:19], s44 offen nt
    s_cmp_le_u32 s43, 5
    s_cselect_b32 s10, 0, s10
    s_add_u32 s45, s38, 0x0
    v_lshlrev_b32 v36, 1, v1
    buffer_load_dwordx4 v[36:39], v36, s[8:11], s45 offen nt
    v_and_b32 v7, -4, v100
    v_lshl_add_u32 v8, v100, 2, v7
    ds_write_b32 v8, v60
    v_lshl_add_u32 v7, v7, 2, v100
    ds_write_b8 v7, v106 offset:16
    v_and_b32 v9, -4, v101
    v_lshl_add_u32 v10, v101, 2, v9
    ds_write_b32 v10, v61
    v_lshl_add_u32 v9, v9, 2, v101
    ds_write_b8_d16_hi v9, v106 offset:16
    v_and_b32 v7, -4, v102
    v_lshl_add_u32 v8, v102, 2, v7
    ds_write_b32 v8, v62
    v_lshl_add_u32 v7, v7, 2, v102
    ds_write_b8 v7, v107 offset:16
    v_and_b32 v9, -4, v103
    v_lshl_add_u32 v10, v103, 2, v9
    ds_write_b32 v10, v63
    v_lshl_add_u32 v9, v9, 2, v103
    ds_write_b8_d16_hi v9, v107 offset:16
    s_add_u32 s46, s35, 0x5488000
    s_add_u32 s46, s46, s93
    buffer_store_dwordx4 v[28:31], v0, s[20:23], s46 offen sc1
    s_cmp_le_u32 s43, 5
    s_cselect_b32 s14, 0, s14
    s_add_u32 s47, s38, 0x0
    v_lshlrev_b32 v76, 1, v1
    buffer_load_dwordx4 v[76:79], v76, s[12:15], s47 offen nt
    s_waitcnt vmcnt(7)
    v_lshlrev_b32 v7, 16, v34
    v_and_b32 v8, 0xffff0000, v34
    v_lshlrev_b32 v9, 16, v35
    v_and_b32 v10, 0xffff0000, v35
    v_mul_f32 v7, 0.15915494, v7
    v_mul_f32 v8, 0.15915494, v8
    v_mul_f32 v9, 0.15915494, v9
    v_mul_f32 v10, 0.15915494, v10
    v_mul_hi_u32_u24 v14, 429497, v48
    v_lshrrev_b32 v12, 3, v52
    v_cos_f32 v7, v7
    v_lshlrev_b16 v13, 3, v52
    v_mad_i32_i24 v11, v14, s55, v48
    v_bitop3_b32 v12, v6, v13, v12 bitop3:0xca
    v_lshl_add_u32 v11, v11, 17, s40
    v_lshlrev_b16 v14, 8, v14
    v_lshrrev_b32 v13, 2, v52
    v_add_u32 v48, v12, v11
    v_bitop3_b32 v52, v5, v13, v14 bitop3:0xea
    v_mul_hi_u32_u24 v14, 429497, v49
    v_lshrrev_b32 v12, 3, v53
    v_cos_f32 v8, v8
    v_lshlrev_b16 v13, 3, v53
    v_mad_i32_i24 v11, v14, s55, v49
    v_bitop3_b32 v12, v6, v13, v12 bitop3:0xca
    v_lshl_add_u32 v11, v11, 17, s40
    v_lshlrev_b16 v14, 8, v14
    v_lshrrev_b32 v13, 2, v53
    v_add_u32 v49, v12, v11
    v_bitop3_b32 v53, v5, v13, v14 bitop3:0xea
    v_cvt_pk_bf16_f32 v34, v7, v8
    v_perm_b32 v12, v34, v34, s41
    v_bitop3_b32 v48, v4, v12, v48 bitop3:0xca
    v_perm_b32 v13, v34, v34, s42
    v_bitop3_b32 v49, v4, v13, v49 bitop3:0xca
    v_mul_hi_u32_u24 v14, 429497, v50
    v_lshrrev_b32 v12, 3, v54
    v_cos_f32 v9, v9
    v_lshlrev_b16 v13, 3, v54
    v_mad_i32_i24 v11, v14, s55, v50
    v_bitop3_b32 v12, v6, v13, v12 bitop3:0xca
    v_lshl_add_u32 v11, v11, 17, s40
    v_lshlrev_b16 v14, 8, v14
    v_lshrrev_b32 v13, 2, v54
    v_add_u32 v50, v12, v11
    v_bitop3_b32 v54, v5, v13, v14 bitop3:0xea
    v_mul_hi_u32_u24 v14, 429497, v51
    v_lshrrev_b32 v12, 3, v55
    v_cos_f32 v10, v10
    v_lshlrev_b16 v13, 3, v55
    v_mad_i32_i24 v11, v14, s55, v51
    v_bitop3_b32 v12, v6, v13, v12 bitop3:0xca
    v_lshl_add_u32 v11, v11, 17, s40
    v_lshlrev_b16 v14, 8, v14
    v_lshrrev_b32 v13, 2, v55
    v_add_u32 v51, v12, v11
    v_bitop3_b32 v55, v5, v13, v14 bitop3:0xea
    v_cvt_pk_bf16_f32 v35, v9, v10
    v_perm_b32 v12, v35, v35, s41
    v_bitop3_b32 v50, v4, v12, v50 bitop3:0xca
    v_perm_b32 v13, v35, v35, s42
    v_bitop3_b32 v51, v4, v13, v51 bitop3:0xca
    s_setprio 0
    v_and_b32 v7, -4, v88
    v_lshl_add_u32 v8, v88, 2, v7
    ds_write_b32 v8, v112
    v_lshl_add_u32 v7, v7, 2, v88
    ds_write_b8 v7, v108 offset:16
    v_and_b32 v9, -4, v89
    v_lshl_add_u32 v10, v89, 2, v9
    ds_write_b32 v10, v113
    v_lshl_add_u32 v9, v9, 2, v89
    ds_write_b8_d16_hi v9, v108 offset:16
    v_and_b32 v7, -4, v90
    v_lshl_add_u32 v8, v90, 2, v7
    ds_write_b32 v8, v114
    v_lshl_add_u32 v7, v7, 2, v90
    ds_write_b8 v7, v109 offset:16
    v_and_b32 v9, -4, v91
    v_lshl_add_u32 v10, v91, 2, v9
    ds_write_b32 v10, v115
    v_lshl_add_u32 v9, v9, 2, v91
    ds_write_b8_d16_hi v9, v109 offset:16
    s_cmp_le_u32 s43, 6
    s_cselect_b32 s10, 0, s10
    s_add_u32 s44, s39, 0x0
    v_lshlrev_b32 v80, 1, v1
    buffer_load_dwordx4 v[80:83], v80, s[8:11], s44 offen nt
    s_cmp_le_u32 s43, 6
    s_cselect_b32 s14, 0, s14
    s_add_u32 s45, s39, 0x0
    v_lshlrev_b32 v56, 1, v1
    buffer_load_dwordx4 v[56:59], v56, s[12:15], s45 offen nt
    s_waitcnt vmcnt(5)
    v_lshlrev_b32 v7, 16, v72
    v_and_b32 v8, 0xffff0000, v72
    v_lshlrev_b32 v9, 16, v73
    v_and_b32 v10, 0xffff0000, v73
    v_mul_f32 v7, 0.15915494, v7
    v_mul_f32 v8, 0.15915494, v8
    v_mul_f32 v9, 0.15915494, v9
    v_mul_f32 v10, 0.15915494, v10
    v_mul_hi_u32_u24 v14, 429497, v84
    v_lshrrev_b32 v12, 3, v68
    v_cos_f32 v7, v7
    v_lshlrev_b16 v13, 3, v68
    v_mad_i32_i24 v11, v14, s55, v84
    v_bitop3_b32 v12, v6, v13, v12 bitop3:0xca
    v_lshl_add_u32 v11, v11, 17, s40
    v_lshlrev_b16 v14, 8, v14
    v_lshrrev_b32 v13, 2, v68
    v_add_u32 v84, v12, v11
    v_bitop3_b32 v68, v5, v13, v14 bitop3:0xea
    v_mul_hi_u32_u24 v14, 429497, v85
    v_lshrrev_b32 v12, 3, v69
    v_cos_f32 v8, v8
    v_lshlrev_b16 v13, 3, v69
    v_mad_i32_i24 v11, v14, s55, v85
    v_bitop3_b32 v12, v6, v13, v12 bitop3:0xca
    v_lshl_add_u32 v11, v11, 17, s40
    v_lshlrev_b16 v14, 8, v14
    v_lshrrev_b32 v13, 2, v69
    v_add_u32 v85, v12, v11
    v_bitop3_b32 v69, v5, v13, v14 bitop3:0xea
    v_cvt_pk_bf16_f32 v72, v7, v8
    v_perm_b32 v12, v72, v72, s41
    v_bitop3_b32 v84, v4, v12, v84 bitop3:0xca
    v_perm_b32 v13, v72, v72, s42
    v_bitop3_b32 v85, v4, v13, v85 bitop3:0xca
    v_mul_hi_u32_u24 v14, 429497, v86
    v_lshrrev_b32 v12, 3, v70
    v_cos_f32 v9, v9
    v_lshlrev_b16 v13, 3, v70
    v_mad_i32_i24 v11, v14, s55, v86
    v_bitop3_b32 v12, v6, v13, v12 bitop3:0xca
    v_lshl_add_u32 v11, v11, 17, s40
    v_lshlrev_b16 v14, 8, v14
    v_lshrrev_b32 v13, 2, v70
    v_add_u32 v86, v12, v11
    v_bitop3_b32 v70, v5, v13, v14 bitop3:0xea
    v_mul_hi_u32_u24 v14, 429497, v87
    v_lshrrev_b32 v12, 3, v71
    v_cos_f32 v10, v10
    v_lshlrev_b16 v13, 3, v71
    v_mad_i32_i24 v11, v14, s55, v87
    v_bitop3_b32 v12, v6, v13, v12 bitop3:0xca
    v_lshl_add_u32 v11, v11, 17, s40
    v_lshlrev_b16 v14, 8, v14
    v_lshrrev_b32 v13, 2, v71
    v_add_u32 v87, v12, v11
    v_bitop3_b32 v71, v5, v13, v14 bitop3:0xea
    v_cvt_pk_bf16_f32 v73, v9, v10
    v_perm_b32 v12, v73, v73, s41
    v_bitop3_b32 v86, v4, v12, v86 bitop3:0xca
    v_perm_b32 v13, v73, v73, s42
    v_bitop3_b32 v87, v4, v13, v87 bitop3:0xca
    v_and_b32 v7, -4, v92
    v_lshl_add_u32 v8, v92, 2, v7
    ds_write_b32 v8, v116
    v_lshl_add_u32 v7, v7, 2, v92
    ds_write_b8 v7, v110 offset:16
    v_and_b32 v9, -4, v93
    v_lshl_add_u32 v10, v93, 2, v9
    ds_write_b32 v10, v117
    v_lshl_add_u32 v9, v9, 2, v93
    ds_write_b8_d16_hi v9, v110 offset:16
    v_and_b32 v7, -4, v94
    v_lshl_add_u32 v8, v94, 2, v7
    ds_write_b32 v8, v118
    v_lshl_add_u32 v7, v7, 2, v94
    ds_write_b8 v7, v111 offset:16
    v_and_b32 v9, -4, v95
    v_lshl_add_u32 v10, v95, 2, v9
    ds_write_b32 v10, v119
    v_lshl_add_u32 v9, v9, 2, v95
    ds_write_b8_d16_hi v9, v111 offset:16
    s_cmp_le_u32 s43, 6
    s_cselect_b32 s18, 0, s18
    s_add_u32 s46, s39, 0x0
    s_lshr_b32 s46, s46, 1
    buffer_load_dwordx2 v[64:65], v1, s[16:19], s46 offen nt
    s_cmp_le_u32 s43, 7
    s_cselect_b32 s18, 0, s18
    s_add_u32 s47, s58, 0x0
    s_lshr_b32 s47, s47, 1
    buffer_load_dwordx2 v[66:67], v1, s[16:19], s47 offen nt
    s_waitcnt vmcnt(4)
    s_cmp_le_u32 s43, 5
    s_cbranch_scc1 L1_s5
    v_lshlrev_b32 v7, 16, v74
    v_and_b32 v8, 0xffff0000, v74
    v_lshlrev_b32 v9, 16, v75
    v_and_b32 v10, 0xffff0000, v75
    v_mul_f32 v7, 0.15915494, v7
    v_mul_f32 v8, 0.15915494, v8
    v_mul_f32 v9, 0.15915494, v9
    v_mul_f32 v10, 0.15915494, v10
    v_mul_hi_u32_u24 v14, 429497, v36
    v_lshrrev_b32 v12, 3, v76
    v_cos_f32 v7, v7
    v_lshlrev_b16 v13, 3, v76
    v_mad_i32_i24 v11, v14, s55, v36
    v_bitop3_b32 v12, v6, v13, v12 bitop3:0xca
    v_lshl_add_u32 v11, v11, 17, s40
    v_lshlrev_b16 v14, 8, v14
    v_lshrrev_b32 v13, 2, v76
    v_add_u32 v36, v12, v11
    v_bitop3_b32 v76, v5, v13, v14 bitop3:0xea
    v_mul_hi_u32_u24 v14, 429497, v37
    v_lshrrev_b32 v12, 3, v77
    v_cos_f32 v8, v8
    v_lshlrev_b16 v13, 3, v77
    v_mad_i32_i24 v11, v14, s55, v37
    v_bitop3_b32 v12, v6, v13, v12 bitop3:0xca
    v_lshl_add_u32 v11, v11, 17, s40
    v_lshlrev_b16 v14, 8, v14
    v_lshrrev_b32 v13, 2, v77
    v_add_u32 v37, v12, v11
    v_bitop3_b32 v77, v5, v13, v14 bitop3:0xea
    v_cvt_pk_bf16_f32 v74, v7, v8
    v_perm_b32 v12, v74, v74, s41
    v_bitop3_b32 v36, v4, v12, v36 bitop3:0xca
    v_perm_b32 v13, v74, v74, s42
    v_bitop3_b32 v37, v4, v13, v37 bitop3:0xca
    v_mul_hi_u32_u24 v14, 429497, v38
    v_lshrrev_b32 v12, 3, v78
    v_cos_f32 v9, v9
    v_lshlrev_b16 v13, 3, v78
    v_mad_i32_i24 v11, v14, s55, v38
    v_bitop3_b32 v12, v6, v13, v12 bitop3:0xca
    v_lshl_add_u32 v11, v11, 17, s40
    v_lshlrev_b16 v14, 8, v14
    v_lshrrev_b32 v13, 2, v78
    v_add_u32 v38, v12, v11
    v_bitop3_b32 v78, v5, v13, v14 bitop3:0xea
    v_mul_hi_u32_u24 v14, 429497, v39
    v_lshrrev_b32 v12, 3, v79
    v_cos_f32 v10, v10
    v_lshlrev_b16 v13, 3, v79
    v_mad_i32_i24 v11, v14, s55, v39
    v_bitop3_b32 v12, v6, v13, v12 bitop3:0xca
    v_lshl_add_u32 v11, v11, 17, s40
    v_lshlrev_b16 v14, 8, v14
    v_lshrrev_b32 v13, 2, v79
    v_add_u32 v39, v12, v11
    v_bitop3_b32 v79, v5, v13, v14 bitop3:0xea
    v_cvt_pk_bf16_f32 v75, v9, v10
    v_perm_b32 v12, v75, v75, s41
    v_bitop3_b32 v38, v4, v12, v38 bitop3:0xca
    v_perm_b32 v13, v75, v75, s42
    v_bitop3_b32 v39, v4, v13, v39 bitop3:0xca
L1_s5:
    v_add_u32 v7, s72, v0
    v_add_u32 v12, s73, v0
    v_add_u32 v13, s85, v0
    v_add_u32 v14, s91, v0
    v_add_u32 v15, s93, v0
    s_min_i32 s3, s72, s73
    s_min_i32 s3, s3, s85
    s_min_i32 s3, s3, s91
    s_min_i32 s3, s3, s93
    v_add_u32 v3, s3, v0
    v_mov_b32 v8, 0
    v_mov_b32 v9, 0
    v_mov_b32 v10, 0
    v_mov_b32 v11, 0
    s_waitcnt lgkmcnt(0)
    s_barrier
    ds_read_b128 v[96:99], v7 offset:0
    ds_read_b128 v[60:63], v12 offset:0
    ds_read_b128 v[100:103], v13 offset:0
    ds_read_b128 v[104:107], v14 offset:0
    ds_read_b128 v[28:31], v15 offset:0
    ds_write_b128 v3, v[8:11]
    ds_read_b128 v[112:115], v7 offset:16384
    ds_read_b128 v[88:91], v12 offset:16384
    ds_read_b128 v[116:119], v13 offset:16384
    ds_read_b128 v[92:95], v14 offset:16384
    ds_read_b128 v[108:111], v15 offset:16384
    s_waitcnt lgkmcnt(0)
    s_barrier
    v_lshlrev_b32 v3, 3, v0
    v_and_b32 v3, 0x80, v3
    s_cmp_lg_u32 s32, 15
    s_cbranch_scc1 L2_k0
    s_mov_b64 exec, 3
    buffer_load_dword v3, v3, s[68:71], 0 offen sc1
    s_mov_b64 exec, -1
L2_k0:
    s_add_u32 s44, s35, 0x7ec4000
    s_add_u32 s44, s44, s72
    buffer_store_dwordx4 v[96:99], v0, s[20:23], s44 offen sc1
    s_cmp_le_u32 s43, 7
    s_cselect_b32 s10, 0, s10
    s_add_u32 s45, s58, 0x0
    v_lshlrev_b32 v96, 1, v1
    buffer_load_dwordx4 v[96:99], v96, s[8:11], s45 offen nt
    s_add_u32 s46, s35, 0x7ec4000
    s_add_u32 s46, s46, s73
    buffer_store_dwordx4 v[60:63], v0, s[20:23], s46 offen sc1
    s_cmp_le_u32 s43, 7
    s_cselect_b32 s14, 0, s14
    s_add_u32 s47, s58, 0x0
    v_lshlrev_b32 v60, 1, v1
    buffer_load_dwordx4 v[60:63], v60, s[12:15], s47 offen nt
    s_setprio 3
    ds_add_u32 v120, v2
    ds_add_u32 v121, v2
    ds_add_u32 v122, v2
    ds_add_u32 v123, v2
    ds_add_u32 v124, v2
    ds_add_u32 v125, v2
    ds_add_u32 v126, v2
    ds_add_u32 v127, v2
    s_setprio 2
    s_add_u32 s44, s35, 0x7ec4000
    s_add_u32 s44, s44, s85
    buffer_store_dwordx4 v[100:103], v0, s[20:23], s44 offen sc1
    ds_add_u32 v24, v2
    ds_add_u32 v25, v2
    ds_add_u32 v26, v2
    ds_add_u32 v27, v2
    ds_add_u32 v52, v2
    ds_add_u32 v53, v2
    ds_add_u32 v54, v2
    ds_add_u32 v55, v2
    s_setprio 1
    ds_add_u32 v68, v2
    ds_add_u32 v69, v2
    ds_add_u32 v70, v2
    ds_add_u32 v71, v2
    s_add_u32 s45, s35, 0x7ec4000
    s_add_u32 s45, s45, s91
    buffer_store_dwordx4 v[104:107], v0, s[20:23], s45 offen sc1
    s_cmp_le_u32 s43, 5
    s_cbranch_scc1 L1_s6
    ds_add_u32 v76, v2
    ds_add_u32 v77, v2
    ds_add_u32 v78, v2
    ds_add_u32 v79, v2
L1_s6:
    s_setprio 0
    s_waitcnt vmcnt(6)
    s_cmp_le_u32 s43, 6
    s_cbranch_scc1 L1_s7
    v_lshlrev_b32 v7, 16, v64
    v_and_b32 v8, 0xffff0000, v64
    v_lshlrev_b32 v9, 16, v65
    v_and_b32 v10, 0xffff0000, v65
    v_mul_f32 v7, 0.15915494, v7
    v_mul_f32 v8, 0.15915494, v8
    v_mul_f32 v9, 0.15915494, v9
    v_mul_f32 v10, 0.15915494, v10
    v_mul_hi_u32_u24 v14, 429497, v80
    v_lshrrev_b32 v12, 3, v56
    v_cos_f32 v7, v7
    v_lshlrev_b16 v13, 3, v56
    v_mad_i32_i24 v11, v14, s55, v80
    v_bitop3_b32 v12, v6, v13, v12 bitop3:0xca
    v_lshl_add_u32 v11, v11, 17, s40
    v_lshlrev_b16 v14, 8, v14
    v_lshrrev_b32 v13, 2, v56
    v_add_u32 v80, v12, v11
    v_bitop3_b32 v56, v5, v13, v14 bitop3:0xea
    ds_add_u32 v56, v2
    v_mul_hi_u32_u24 v14, 429497, v81
    v_lshrrev_b32 v12, 3, v57
    v_cos_f32 v8, v8
    v_lshlrev_b16 v13, 3, v57
    v_mad_i32_i24 v11, v14, s55, v81
    v_bitop3_b32 v12, v6, v13, v12 bitop3:0xca
    v_lshl_add_u32 v11, v11, 17, s40
    v_lshlrev_b16 v14, 8, v14
    v_lshrrev_b32 v13, 2, v57
    v_add_u32 v81, v12, v11
    v_bitop3_b32 v57, v5, v13, v14 bitop3:0xea
    ds_add_u32 v57, v2
    v_cvt_pk_bf16_f32 v64, v7, v8
    v_perm_b32 v12, v64, v64, s41
    v_bitop3_b32 v80, v4, v12, v80 bitop3:0xca
    v_perm_b32 v13, v64, v64, s42
    v_bitop3_b32 v81, v4, v13, v81 bitop3:0xca
    v_mul_hi_u32_u24 v14, 429497, v82
    v_lshrrev_b32 v12, 3, v58
    v_cos_f32 v9, v9
    v_lshlrev_b16 v13, 3, v58
    v_mad_i32_i24 v11, v14, s55, v82
    v_bitop3_b32 v12, v6, v13, v12 bitop3:0xca
    v_lshl_add_u32 v11, v11, 17, s40
    v_lshlrev_b16 v14, 8, v14
    v_lshrrev_b32 v13, 2, v58
    v_add_u32 v82, v12, v11
    v_bitop3_b32 v58, v5, v13, v14 bitop3:0xea
    ds_add_u32 v58, v2
    v_mul_hi_u32_u24 v14, 429497, v83
    v_lshrrev_b32 v12, 3, v59
    v_cos_f32 v10, v10
    v_lshlrev_b16 v13, 3, v59
    v_mad_i32_i24 v11, v14, s55, v83
    v_bitop3_b32 v12, v6, v13, v12 bitop3:0xca
    v_lshl_add_u32 v11, v11, 17, s40
    v_lshlrev_b16 v14, 8, v14
    v_lshrrev_b32 v13, 2, v59
    v_add_u32 v83, v12, v11
    v_bitop3_b32 v59, v5, v13, v14 bitop3:0xea
    ds_add_u32 v59, v2
    v_cvt_pk_bf16_f32 v65, v9, v10
    v_perm_b32 v12, v65, v65, s41
    v_bitop3_b32 v82, v4, v12, v82 bitop3:0xca
    v_perm_b32 v13, v65, v65, s42
    v_bitop3_b32 v83, v4, v13, v83 bitop3:0xca
L1_s7:
    s_waitcnt vmcnt(2)
    s_cmp_le_u32 s43, 7
    s_cbranch_scc1 L1_s8
    v_lshlrev_b32 v7, 16, v66
    v_and_b32 v8, 0xffff0000, v66
    v_lshlrev_b32 v9, 16, v67
    v_and_b32 v10, 0xffff0000, v67
    v_mul_f32 v7, 0.15915494, v7
    v_mul_f32 v8, 0.15915494, v8
    v_mul_f32 v9, 0.15915494, v9
    v_mul_f32 v10, 0.15915494, v10
    v_mul_hi_u32_u24 v14, 429497, v96
    v_lshrrev_b32 v12, 3, v60
    v_cos_f32 v7, v7
    v_lshlrev_b16 v13, 3, v60
    v_mad_i32_i24 v11, v14, s55, v96
    v_bitop3_b32 v12, v6, v13, v12 bitop3:0xca
    v_lshl_add_u32 v11, v11, 17, s40
    v_lshlrev_b16 v14, 8, v14
    v_lshrrev_b32 v13, 2, v60
    v_add_u32 v96, v12, v11
    v_bitop3_b32 v60, v5, v13, v14 bitop3:0xea
    ds_add_u32 v60, v2
    v_mul_hi_u32_u24 v14, 429497, v97
    v_lshrrev_b32 v12, 3, v61
    v_cos_f32 v8, v8
    v_lshlrev_b16 v13, 3, v61
    v_mad_i32_i24 v11, v14, s55, v97
    v_bitop3_b32 v12, v6, v13, v12 bitop3:0xca
    v_lshl_add_u32 v11, v11, 17, s40
    v_lshlrev_b16 v14, 8, v14
    v_lshrrev_b32 v13, 2, v61
    v_add_u32 v97, v12, v11
    v_bitop3_b32 v61, v5, v13, v14 bitop3:0xea
    ds_add_u32 v61, v2
    v_cvt_pk_bf16_f32 v66, v7, v8
    v_perm_b32 v12, v66, v66, s41
    v_bitop3_b32 v96, v4, v12, v96 bitop3:0xca
    v_perm_b32 v13, v66, v66, s42
    v_bitop3_b32 v97, v4, v13, v97 bitop3:0xca
    v_mul_hi_u32_u24 v14, 429497, v98
    v_lshrrev_b32 v12, 3, v62
    v_cos_f32 v9, v9
    v_lshlrev_b16 v13, 3, v62
    v_mad_i32_i24 v11, v14, s55, v98
    v_bitop3_b32 v12, v6, v13, v12 bitop3:0xca
    v_lshl_add_u32 v11, v11, 17, s40
    v_lshlrev_b16 v14, 8, v14
    v_lshrrev_b32 v13, 2, v62
    v_add_u32 v98, v12, v11
    v_bitop3_b32 v62, v5, v13, v14 bitop3:0xea
    ds_add_u32 v62, v2
    v_mul_hi_u32_u24 v14, 429497, v99
    v_lshrrev_b32 v12, 3, v63
    v_cos_f32 v10, v10
    v_lshlrev_b16 v13, 3, v63
    v_mad_i32_i24 v11, v14, s55, v99
    v_bitop3_b32 v12, v6, v13, v12 bitop3:0xca
    v_lshl_add_u32 v11, v11, 17, s40
    v_lshlrev_b16 v14, 8, v14
    v_lshrrev_b32 v13, 2, v63
    v_add_u32 v99, v12, v11
    v_bitop3_b32 v63, v5, v13, v14 bitop3:0xea
    ds_add_u32 v63, v2
    v_cvt_pk_bf16_f32 v67, v9, v10
    v_perm_b32 v12, v67, v67, s41
    v_bitop3_b32 v98, v4, v12, v98 bitop3:0xca
    v_perm_b32 v13, v67, v67, s42
    v_bitop3_b32 v99, v4, v13, v99 bitop3:0xca
L1_s8:
    v_lshrrev_b32 v8, 2, v0
    v_and_b32 v7, 0x3c00, v0
    v_bitop3_b32 v7, v5, v8, v7 bitop3:0xea
    s_waitcnt lgkmcnt(0)
    s_barrier
    ds_read2st64_b32 v[8:9], v7 offset0:0 offset1:1
    ds_read2st64_b32 v[10:11], v7 offset0:2 offset1:3
    s_waitcnt lgkmcnt(0)
    v_lshl_or_b32 v12, v9, 16, v8
    v_lshl_or_b32 v13, v11, 16, v10
    v_mov_b32 v14, v12
    v_mov_b32 v15, v13
    s_nop 0
    v_add_u32_dpp v14, v14, v14 row_shr:1 row_mask:0xf bank_mask:0xf bound_ctrl:1
    v_add_u32_dpp v15, v15, v15 row_shr:1 row_mask:0xf bank_mask:0xf bound_ctrl:1
    s_nop 0
    v_add_u32_dpp v14, v14, v14 row_shr:2 row_mask:0xf bank_mask:0xf bound_ctrl:1
    v_add_u32_dpp v15, v15, v15 row_shr:2 row_mask:0xf bank_mask:0xf bound_ctrl:1
    s_nop 0
    v_add_u32_dpp v14, v14, v14 row_shr:4 row_mask:0xf bank_mask:0xf bound_ctrl:1
    v_add_u32_dpp v15, v15, v15 row_shr:4 row_mask:0xf bank_mask:0xf bound_ctrl:1
    s_nop 0
    v_add_u32_dpp v14, v14, v14 row_shr:8 row_mask:0xf bank_mask:0xf bound_ctrl:1
    v_add_u32_dpp v15, v15, v15 row_shr:8 row_mask:0xf bank_mask:0xf bound_ctrl:1
    s_nop 0
    v_add_u32_dpp v14, v14, v14 row_bcast:15 row_mask:0xa bank_mask:0xf
    v_add_u32_dpp v15, v15, v15 row_bcast:15 row_mask:0xa bank_mask:0xf
    s_nop 0
    v_add_u32_dpp v14, v14, v14 row_bcast:31 row_mask:0xc bank_mask:0xf
    v_add_u32_dpp v15, v15, v15 row_bcast:31 row_mask:0xc bank_mask:0xf
    v_readlane_b32 s48, v14, 63
    v_readlane_b32 s49, v15, 63
    s_lshl_b32 s54, s32, 2
    v_mov_b32 v8, s54
    s_and_b32 s50, s48, 0xffff
    s_lshr_b32 s51, s48, 16
    s_and_b32 s52, s49, 0xffff
    s_lshr_b32 s53, s49, 16
    s_add_u32 s51, s51, s50
    s_add_u32 s52, s52, s51
    s_add_u32 s53, s53, s52
    v_mov_b32 v9, s53
    v_and_b32_dpp v3, v3, v3 quad_perm:[1,0,3,2] row_mask:0xf bank_mask:0xf
    s_mov_b64 exec, 1
    ds_write_b32 v8, v9 offset:16384
    ds_write_b32 v8, v3 offset:16448
    s_mov_b64 exec, -1
    v_and_b32 v8, 60, v7
    s_waitcnt lgkmcnt(0)
    s_barrier
    ds_read_b32 v9, v8 offset:16384
    ds_read_b32 v10, v8 offset:16448
    s_waitcnt lgkmcnt(0)
    v_readlane_b32 s56, v10, 15
    s_xor_b32 s56, s56, 0x80
    v_add_u32_dpp v9, v9, v9 row_shr:1 row_mask:0xf bank_mask:0xf bound_ctrl:1
    s_nop 1
    v_add_u32_dpp v9, v9, v9 row_shr:2 row_mask:0xf bank_mask:0xf bound_ctrl:1
    s_nop 1
    v_add_u32_dpp v9, v9, v9 row_shr:4 row_mask:0xf bank_mask:0xf bound_ctrl:1
    s_nop 1
    v_add_u32_dpp v9, v9, v9 row_shr:8 row_mask:0xf bank_mask:0xf bound_ctrl:1
    s_nop 0
    v_readlane_b32 s54, v9, s32
    s_sub_u32 s54, s54, s53
    s_add_u32 s50, s50, s54
    s_add_u32 s51, s51, s54
    s_add_u32 s52, s52, s54
    s_pack_ll_b32_b16 s48, s54, s50
    s_pack_ll_b32_b16 s49, s51, s52
    v_add_u32 v14, s48, v14
    v_add_u32 v15, s49, v15
    v_sub_u32 v12, v14, v12
    v_sub_u32 v13, v15, v13
    v_and_b32 v8, 0xffff, v12
    v_lshrrev_b32 v9, 16, v12
    v_and_b32 v10, 0xffff, v13
    v_lshrrev_b32 v11, 16, v13
    ds_write2st64_b32 v7, v8, v9 offset0:0 offset1:1
    ds_write2st64_b32 v7, v10, v11 offset0:2 offset1:3
    v_and_b32 v8, 0x3f0, v0
    v_lshl_add_u32 v8, v8, 1, s36
    ds_write_b64 v8, v[12:13] offset:20480
    s_bitset0_b64 exec, 63
    s_not_b64 exec, exec
    ds_write_b64 v8, v[14:15] offset:20512
    s_mov_b64 exec, -1
    s_waitcnt lgkmcnt(0)
    s_barrier
    s_setprio 3
    ds_add_rtn_u32 v120, v120, v2
    ds_add_rtn_u32 v121, v121, v2
    ds_add_rtn_u32 v122, v122, v2
    ds_add_rtn_u32 v123, v123, v2
    ds_read_b128 v[12:15], v0 offset:20480
    v_cmp_gt_u32 vcc, 8448, v0
    s_add_u32 s46, s35, 0x7ec4000
    s_add_u32 s46, s46, s93
    buffer_store_dwordx4 v[28:31], v0, s[20:23], s46 offen sc1
    ds_add_rtn_u32 v124, v124, v2
    ds_add_rtn_u32 v125, v125, v2
    ds_add_rtn_u32 v126, v126, v2
    ds_add_rtn_u32 v127, v127, v2
    s_setprio 2
    ds_add_rtn_u32 v24, v24, v2
    ds_add_rtn_u32 v25, v25, v2
    ds_add_rtn_u32 v26, v26, v2
    ds_add_rtn_u32 v27, v27, v2
    s_waitcnt lgkmcnt(8)
    s_cbranch_vccz L1_p9
    s_add_u32 s47, s35, 0xa900000
    s_mov_b64 exec, vcc
    buffer_store_dwordx4 v[12:15], v0, s[24:27], s47 offen sc1
    s_mov_b64 exec, -1
L1_p9:
    s_add_u32 s44, s35, 0x7ec8000
    s_add_u32 s44, s44, s72
    buffer_store_dwordx4 v[112:115], v0, s[20:23], s44 offen sc1
    ds_add_rtn_u32 v52, v52, v2
    ds_add_rtn_u32 v53, v53, v2
    ds_add_rtn_u32 v54, v54, v2
    ds_add_rtn_u32 v55, v55, v2
    s_load_dwordx2 s[28:29], s[0:1], 0
    s_load_dwordx2 s[50:51], s[0:1], 40
    s_load_dwordx2 s[52:53], s[0:1], 24
    s_setprio 1
    ds_add_rtn_u32 v68, v68, v2
    ds_add_rtn_u32 v69, v69, v2
    ds_add_rtn_u32 v70, v70, v2
    ds_add_rtn_u32 v71, v71, v2
    s_cmp_le_u32 s43, 5
    s_cbranch_scc1 L1_s10
    ds_add_rtn_u32 v76, v76, v2
    ds_add_rtn_u32 v77, v77, v2
    ds_add_rtn_u32 v78, v78, v2
    ds_add_rtn_u32 v79, v79, v2
L1_s10:
    s_add_u32 s45, s35, 0x7ec8000
    s_add_u32 s45, s45, s73
    buffer_store_dwordx4 v[88:91], v0, s[20:23], s45 offen sc1
    s_setprio 0
    s_cmp_le_u32 s43, 6
    s_cbranch_scc1 L1_s11
    ds_add_rtn_u32 v56, v56, v2
    ds_add_rtn_u32 v57, v57, v2
    ds_add_rtn_u32 v58, v58, v2
    ds_add_rtn_u32 v59, v59, v2
L1_s11:
    s_cmp_le_u32 s43, 7
    s_cbranch_scc1 L1_s12
    ds_add_rtn_u32 v60, v60, v2
    ds_add_rtn_u32 v61, v61, v2
    ds_add_rtn_u32 v62, v62, v2
    ds_add_rtn_u32 v63, v63, v2
L1_s12:
    s_waitcnt lgkmcnt(0)
    s_barrier
    s_load_dwordx4 s[96:99], s[50:51], 0
    s_mov_b64 s[4:5], s[52:53]
    s_bfe_u32 s33, s2, 0x20001
    s_and_b32 s34, s2, 1
    s_lshl_b32 s34, s34, 5
    s_lshr_b32 s3, s2, 3
    s_add_u32 s34, s34, s3
    s_mul_i32 s39, s33, 2080
    s_lshl_b32 s3, s34, 5
    s_add_u32 s39, s39, s3
    s_mul_i32 s40, s33, 1310720
    s_add_u32 s40, s40, 0x50000
    s_lshl_b32 s38, s32, 11
    s_mul_i32 s100, s32, 3072
    s_add_u32 s8, s30, 0x4000
    s_addc_u32 s9, s31, 0
    s_mov_b32 s10, 0xd340000
    s_mov_b32 s11, 0x20000
    s_add_u32 s12, s30, 0x2c000
    s_addc_u32 s13, s31, 0
    s_mov_b32 s14, 0xd318000
    s_mov_b32 s15, 0x20000
    s_mov_b32 s16, s64
    s_mov_b32 s17, s65
    s_mov_b32 s18, 0x20
    s_mov_b32 s19, 0x20000
    s_mov_b32 s24, s28
    s_mov_b32 s25, s29
    s_mov_b32 s26, 0x4e2000
    s_mov_b32 s27, 0x20000
    s_setprio 3
    v_and_b32 v7, -4, v120
    v_lshl_add_u32 v8, v120, 2, v7
    ds_write_b32 v8, v16
    v_lshl_add_u32 v7, v7, 2, v120
    ds_write_b8 v7, v44 offset:16
    v_and_b32 v9, -4, v121
    v_lshl_add_u32 v10, v121, 2, v9
    ds_write_b32 v10, v17
    v_lshl_add_u32 v9, v9, 2, v121
    ds_write_b8_d16_hi v9, v44 offset:16
    v_and_b32 v7, -4, v122
    v_lshl_add_u32 v8, v122, 2, v7
    ds_write_b32 v8, v18
    v_lshl_add_u32 v7, v7, 2, v122
    ds_write_b8 v7, v45 offset:16
    v_and_b32 v9, -4, v123
    v_lshl_add_u32 v10, v123, 2, v9
    ds_write_b32 v10, v19
    v_lshl_add_u32 v9, v9, 2, v123
    ds_write_b8_d16_hi v9, v45 offset:16
    s_add_u32 s46, s35, 0x7ec8000
    s_add_u32 s46, s46, s85
    buffer_store_dwordx4 v[116:119], v0, s[20:23], s46 offen sc1
    v_and_b32 v13, 0x3f0, v0
    v_and_b32 v14, 0x300, v13
    v_bfe_u32 v15, v13, 4, 4
    s_lshl_b32 s3, s32, 4
    v_add3_u32 v14, v14, v15, s3
    v_mul_u32_u24 v2, 173056, v14
    v_lshrrev_b32 v14, 6, v13
    s_add_u32 s3, s3, 0x400
    v_add_u32 v14, s3, v14
    v_mul_u32_u24 v4, 173056, v14
    v_and_b32 v14, 3, v14
    v_and_b32 v15, 0x30, v13
    v_lshl_add_u32 v14, v14, 5, v15
    v_add_u32 v6, v14, v4
    v_lshl_add_u32 v5, v15, 1, v2
    v_lshrrev_b32 v14, 3, v15
    buffer_load_ushort v100, v14, s[16:19], 0 offen offset:0
    buffer_load_ushort v101, v14, s[16:19], 0 offen offset:8
    buffer_load_ushort v102, v14, s[16:19], 0 offen offset:16
    buffer_load_ushort v103, v14, s[16:19], 0 offen offset:24
    s_mul_i32 s3, s32, 5120
    v_add_u32 v3, s3, v13
    v_lshrrev_b32 v14, 2, v13
    v_add_u32 v14, s38, v14
    v_and_b32 v7, -4, v124
    v_lshl_add_u32 v8, v124, 2, v7
    ds_write_b32 v8, v20
    v_lshl_add_u32 v7, v7, 2, v124
    ds_write_b8 v7, v46 offset:16
    v_and_b32 v9, -4, v125
    v_lshl_add_u32 v10, v125, 2, v9
    ds_write_b32 v10, v21
    v_lshl_add_u32 v9, v9, 2, v125
    ds_write_b8_d16_hi v9, v46 offset:16
    v_and_b32 v7, -4, v126
    v_lshl_add_u32 v8, v126, 2, v7
    ds_write_b32 v8, v22
    v_lshl_add_u32 v7, v7, 2, v126
    ds_write_b8 v7, v47 offset:16
    v_and_b32 v9, -4, v127
    v_lshl_add_u32 v10, v127, 2, v9
    ds_write_b32 v10, v23
    v_lshl_add_u32 v9, v9, 2, v127
    ds_write_b8_d16_hi v9, v47 offset:16
    s_setprio 2
    v_and_b32 v7, -4, v24
    v_lshl_add_u32 v8, v24, 2, v7
    ds_write_b32 v8, v40
    v_lshl_add_u32 v7, v7, 2, v24
    ds_write_b8 v7, v32 offset:16
    v_and_b32 v9, -4, v25
    v_lshl_add_u32 v10, v25, 2, v9
    ds_write_b32 v10, v41
    v_lshl_add_u32 v9, v9, 2, v25
    ds_write_b8_d16_hi v9, v32 offset:16
    v_and_b32 v7, -4, v26
    v_lshl_add_u32 v8, v26, 2, v7
    ds_write_b32 v8, v42
    v_lshl_add_u32 v7, v7, 2, v26
    ds_write_b8 v7, v33 offset:16
    v_and_b32 v9, -4, v27
    v_lshl_add_u32 v10, v27, 2, v9
    ds_write_b32 v10, v43
    v_lshl_add_u32 v9, v9, 2, v27
    ds_write_b8_d16_hi v9, v33 offset:16
    s_add_u32 s47, s35, 0x7ec8000
    s_add_u32 s47, s47, s91
    buffer_store_dwordx4 v[92:95], v0, s[20:23], s47 offen sc1
    v_lshrrev_b32 v11, 2, v0
    v_and_b32 v11, 0xfc, v11
    s_cmp_ge_u32 s84, 128
    s_cselect_b32 s82, 0, s82
    s_mul_i32 s3, s84, 40
    s_add_u32 s3, s3, s32
    s_mul_i32 s76, s3, 52429
    s_lshr_b32 s76, s76, 22
    s_mul_i32 s74, s76, 80
    s_sub_u32 s3, s3, s74
    s_mul_i32 s74, s3, 205
    s_lshr_b32 s74, s74, 10
    s_mul_i32 s75, s74, 5
    s_sub_u32 s75, s3, s75
    s_lshl_b32 s48, s74, 1
    s_add_u32 s48, s48, s75
    s_add_u32 s49, s48, s74
    s_add_u32 s49, s49, 30
    s_cmp_lt_u32 s75, 2
    s_cselect_b32 s48, s48, s49
    s_lshl_b32 s48, s48, 10
    s_mul_i32 s49, s76, 80000
    s_add_u32 s48, s48, s49
    buffer_load_dword v104, v11, s[80:83], s48 offen offset:0
    buffer_load_dword v105, v11, s[80:83], s48 offen offset:256
    buffer_load_dword v106, v11, s[80:83], s48 offen offset:512
    buffer_load_dword v107, v11, s[80:83], s48 offen offset:768
    s_mul_i32 s3, s84, 40
    s_add_u32 s3, s3, s32
    s_add_u32 s3, s3, 16
    s_mul_i32 s76, s3, 52429
    s_lshr_b32 s76, s76, 22
    s_mul_i32 s74, s76, 80
    s_sub_u32 s3, s3, s74
    s_mul_i32 s74, s3, 205
    s_lshr_b32 s74, s74, 10
    s_mul_i32 s75, s74, 5
    s_sub_u32 s75, s3, s75
    s_lshl_b32 s48, s74, 1
    s_add_u32 s48, s48, s75
    s_add_u32 s49, s48, s74
    s_add_u32 s49, s49, 30
    s_cmp_lt_u32 s75, 2
    s_cselect_b32 s48, s48, s49
    s_lshl_b32 s48, s48, 10
    s_mul_i32 s49, s76, 80000
    s_add_u32 s48, s48, s49
    buffer_load_dword v28, v11, s[80:83], s48 offen offset:0
    buffer_load_dword v29, v11, s[80:83], s48 offen offset:256
    buffer_load_dword v30, v11, s[80:83], s48 offen offset:512
    buffer_load_dword v31, v11, s[80:83], s48 offen offset:768
    s_mul_i32 s3, s84, 40
    s_add_u32 s3, s3, s32
    s_add_u32 s3, s3, 32
    s_mul_i32 s76, s3, 52429
    s_lshr_b32 s76, s76, 22
    s_mul_i32 s74, s76, 80
    s_sub_u32 s3, s3, s74
    s_cmp_ge_u32 s32, 8
    s_cselect_b32 s82, 0, s82
    s_mul_i32 s74, s3, 205
    s_lshr_b32 s74, s74, 10
    s_mul_i32 s75, s74, 5
    s_sub_u32 s75, s3, s75
    s_lshl_b32 s48, s74, 1
    s_add_u32 s48, s48, s75
    s_add_u32 s49, s48, s74
    s_add_u32 s49, s49, 30
    s_cmp_lt_u32 s75, 2
    s_cselect_b32 s48, s48, s49
    s_lshl_b32 s48, s48, 10
    s_mul_i32 s49, s76, 80000
    s_add_u32 s48, s48, s49
    buffer_load_dword v112, v11, s[80:83], s48 offen offset:0
    buffer_load_dword v113, v11, s[80:83], s48 offen offset:256
    buffer_load_dword v114, v11, s[80:83], s48 offen offset:512
    buffer_load_dword v115, v11, s[80:83], s48 offen offset:768
    v_and_b32 v7, -4, v52
    v_lshl_add_u32 v8, v52, 2, v7
    ds_write_b32 v8, v48
    v_lshl_add_u32 v7, v7, 2, v52
    ds_write_b8 v7, v34 offset:16
    v_and_b32 v9, -4, v53
    v_lshl_add_u32 v10, v53, 2, v9
    ds_write_b32 v10, v49
    v_lshl_add_u32 v9, v9, 2, v53
    ds_write_b8_d16_hi v9, v34 offset:16
    v_and_b32 v7, -4, v54
    v_lshl_add_u32 v8, v54, 2, v7
    ds_write_b32 v8, v50
    v_lshl_add_u32 v7, v7, 2, v54
    ds_write_b8 v7, v35 offset:16
    v_and_b32 v9, -4, v55
    v_lshl_add_u32 v10, v55, 2, v9
    ds_write_b32 v10, v51
    v_lshl_add_u32 v9, v9, 2, v55
    ds_write_b8_d16_hi v9, v35 offset:16
    s_setprio 1
    v_and_b32 v7, -4, v68
    v_lshl_add_u32 v8, v68, 2, v7
    ds_write_b32 v8, v84
    v_lshl_add_u32 v7, v7, 2, v68
    ds_write_b8 v7, v72 offset:16
    v_and_b32 v9, -4, v69
    v_lshl_add_u32 v10, v69, 2, v9
    ds_write_b32 v10, v85
    v_lshl_add_u32 v9, v9, 2, v69
    ds_write_b8_d16_hi v9, v72 offset:16
    v_and_b32 v7, -4, v70
    v_lshl_add_u32 v8, v70, 2, v7
    ds_write_b32 v8, v86
    v_lshl_add_u32 v7, v7, 2, v70
    ds_write_b8 v7, v73 offset:16
    v_and_b32 v9, -4, v71
    v_lshl_add_u32 v10, v71, 2, v9
    ds_write_b32 v10, v87
    v_lshl_add_u32 v9, v9, 2, v71
    ds_write_b8_d16_hi v9, v73 offset:16
    s_cmp_le_u32 s43, 5
    s_cbranch_scc1 L1_s13
    v_and_b32 v7, -4, v76
    v_lshl_add_u32 v8, v76, 2, v7
    ds_write_b32 v8, v36
    v_lshl_add_u32 v7, v7, 2, v76
    ds_write_b8 v7, v74 offset:16
    v_and_b32 v9, -4, v77
    v_lshl_add_u32 v10, v77, 2, v9
    ds_write_b32 v10, v37
    v_lshl_add_u32 v9, v9, 2, v77
    ds_write_b8_d16_hi v9, v74 offset:16
    v_and_b32 v7, -4, v78
    v_lshl_add_u32 v8, v78, 2, v7
    ds_write_b32 v8, v38
    v_lshl_add_u32 v7, v7, 2, v78
    ds_write_b8 v7, v75 offset:16
    v_and_b32 v9, -4, v79
    v_lshl_add_u32 v10, v79, 2, v9
    ds_write_b32 v10, v39
    v_lshl_add_u32 v9, v9, 2, v79
    ds_write_b8_d16_hi v9, v75 offset:16
L1_s13:
    s_add_u32 s44, s35, 0x7ec8000
    s_add_u32 s44, s44, s93
    buffer_store_dwordx4 v[108:111], v0, s[20:23], s44 offen sc1
    s_setprio 0
    s_cmp_le_u32 s43, 6
    s_cbranch_scc1 L1_s14
    v_and_b32 v7, -4, v56
    v_lshl_add_u32 v8, v56, 2, v7
    ds_write_b32 v8, v80
    v_lshl_add_u32 v7, v7, 2, v56
    ds_write_b8 v7, v64 offset:16
    v_and_b32 v9, -4, v57
    v_lshl_add_u32 v10, v57, 2, v9
    ds_write_b32 v10, v81
    v_lshl_add_u32 v9, v9, 2, v57
    ds_write_b8_d16_hi v9, v64 offset:16
    v_and_b32 v7, -4, v58
    v_lshl_add_u32 v8, v58, 2, v7
    ds_write_b32 v8, v82
    v_lshl_add_u32 v7, v7, 2, v58
    ds_write_b8 v7, v65 offset:16
    v_and_b32 v9, -4, v59
    v_lshl_add_u32 v10, v59, 2, v9
    ds_write_b32 v10, v83
    v_lshl_add_u32 v9, v9, 2, v59
    ds_write_b8_d16_hi v9, v65 offset:16
L1_s14:
    s_cmp_le_u32 s43, 7
    s_cbranch_scc1 L1_s15
    v_and_b32 v7, -4, v60
    v_lshl_add_u32 v8, v60, 2, v7
    ds_write_b32 v8, v96
    v_lshl_add_u32 v7, v7, 2, v60
    ds_write_b8 v7, v66 offset:16
    v_and_b32 v9, -4, v61
    v_lshl_add_u32 v10, v61, 2, v9
    ds_write_b32 v10, v97
    v_lshl_add_u32 v9, v9, 2, v61
    ds_write_b8_d16_hi v9, v66 offset:16
    v_and_b32 v7, -4, v62
    v_lshl_add_u32 v8, v62, 2, v7
    ds_write_b32 v8, v98
    v_lshl_add_u32 v7, v7, 2, v62
    ds_write_b8 v7, v67 offset:16
    v_and_b32 v9, -4, v63
    v_lshl_add_u32 v10, v63, 2, v9
    ds_write_b32 v10, v99
    v_lshl_add_u32 v9, v9, 2, v63
    ds_write_b8_d16_hi v9, v67 offset:16
L1_s15:
    s_add_u32 s80, s30, 0xd344000
    s_addc_u32 s81, s31, 0
    s_mov_b32 s82, 0xa000
    s_mov_b32 s83, 0x20000
    s_min_u32 s3, s84, 127
    s_mul_i32 s3, s3, 40960
    s_add_u32 s80, s80, s3
    s_addc_u32 s81, s81, 0
    s_cmp_ge_u32 s84, 128
    s_cselect_b32 s82, 0, s82
    s_waitcnt vmcnt(1)
    v_add_u32 v11, 0, v0
    buffer_store_dwordx4 v[104:107], v11, s[80:83], 0 offen sc1
    v_add_u32 v11, 16384, v0
    buffer_store_dwordx4 v[28:31], v11, s[80:83], 0 offen sc1
    v_add_u32 v11, 32768, v0
    buffer_store_dwordx4 v[112:115], v11, s[80:83], 0 offen sc1
    v_add_u32 v7, 0x10000, v0
    v_add_u32 v12, 0x20000, v0
    s_waitcnt lgkmcnt(0)
    s_barrier
    ds_read_b128 v[24:27], v0 offset:0
    ds_read_b128 v[28:31], v0 offset:16384
    ds_read_b128 v[32:35], v0 offset:32768
    ds_read_b128 v[36:39], v0 offset:49152
    ds_read_b128 v[76:79], v7 offset:0
    ds_read_b128 v[80:83], v7 offset:16384
    ds_read_b128 v[84:87], v7 offset:32768
    ds_read_b128 v[104:107], v7 offset:49152
    ds_read_b128 v[68:71], v12 offset:0
    ds_read_b128 v[72:75], v12 offset:16384
    s_cmp_lg_u32 s32, 0
    s_cbranch_scc1 L2_sg1
    s_mov_b32 exec_hi, 0
    v_mov_b32 v11, 1
    buffer_store_dword v11, v14, s[60:63], s57 offen sc1
    s_mov_b64 exec, -1
L2_sg1:
    s_waitcnt lgkmcnt(9)
    s_add_u32 s45, s35, 0xa904000
    buffer_store_dwordx4 v[24:27], v0, s[20:23], s45 offen sc1
    s_waitcnt lgkmcnt(8)
    s_add_u32 s46, s35, 0xa908000
    buffer_store_dwordx4 v[28:31], v0, s[20:23], s46 offen sc1
    s_waitcnt lgkmcnt(7)
    s_add_u32 s47, s35, 0xa90c000
    buffer_store_dwordx4 v[32:35], v0, s[20:23], s47 offen sc1
    s_waitcnt lgkmcnt(6)
    s_add_u32 s44, s35, 0xa910000
    buffer_store_dwordx4 v[36:39], v0, s[20:23], s44 offen sc1
    s_waitcnt lgkmcnt(5)
    s_add_u32 s45, s35, 0xa914000
    buffer_store_dwordx4 v[76:79], v0, s[20:23], s45 offen sc1
    s_waitcnt lgkmcnt(4)
    s_add_u32 s46, s35, 0xa918000
    buffer_store_dwordx4 v[80:83], v0, s[20:23], s46 offen sc1
    s_waitcnt lgkmcnt(3)
    s_add_u32 s47, s35, 0xa91c000
    buffer_store_dwordx4 v[84:87], v0, s[20:23], s47 offen sc1
    s_waitcnt lgkmcnt(2)
    s_cmp_le_u32 s43, 5
    s_cbranch_scc1 L1_q16
    s_add_u32 s44, s35, 0xa920000
    buffer_store_dwordx4 v[104:107], v0, s[20:23], s44 offen sc1
L1_q16:
    s_waitcnt lgkmcnt(1)
    s_cmp_le_u32 s43, 6
    s_cbranch_scc1 L1_q17
    s_add_u32 s45, s35, 0xa924000
    buffer_store_dwordx4 v[68:71], v0, s[20:23], s45 offen sc1
L1_q17:
    s_waitcnt lgkmcnt(0)
    s_cmp_le_u32 s43, 7
    s_cbranch_scc1 L1_q18
    s_add_u32 s46, s35, 0xa928000
    buffer_store_dwordx4 v[72:75], v0, s[20:23], s46 offen sc1
L1_q18:
    s_waitcnt lgkmcnt(0)
    s_setprio 3
    v_mov_b32 v92, v0
    v_mov_b32 v93, v6
    v_mov_b32 v94, v13
    v_mov_b32 v95, v5
    v_mov_b32 v0, v14
    v_lshl_add_u32 v7, v13, 3, s38
    v_lshrrev_b32 v16, 2, v15
    v_mad_u32_u24 v4, v16, 5, v4
    v_or_b32 v4, 0xf0000000, v4
    v_or_b32 v2, 0xf0000000, v2
    v_sub_u32 v1, 28, v16
    v_lshrrev_b32 v17, 2, v16
    v_and_b32 v18, 3, v17
    v_lshlrev_b32 v18, 4, v18
    v_mov_b32 v10, 0x3f80
    v_mov_b32 v11, 0
    v_lshlrev_b64 v[10:11], v18, v[10:11]
    v_and_b32 v18, 3, v17
    v_lshlrev_b32 v18, 4, v18
    v_mov_b32 v12, 0xbf80
    v_mov_b32 v13, 0
    v_lshlrev_b64 v[12:13], v18, v[12:13]
    v_mov_b32 v45, 0xf0000000
    v_add_u32 v44, s38, v0
    v_lshrrev_b32 v44, 1, v44
    v_and_b32 v44, -4, v44
    v_mov_b32 v5, 0x1fff8
    v_mov_b32 v6, 0x07ff0000
    v_mov_b32 v16, 0
    v_mov_b32 v17, 0
    v_mov_b32 v18, 0
    v_mov_b32 v19, 0
    v_add_u32 v20, 81920, v92
    v_add_u32 v21, 0x10000, v20
    s_setprio 1
    s_setprio 2
    s_mov_b32 s44, 0x4000c0c
    s_mov_b32 s45, 0x4010c0c
    s_mov_b32 s46, 0x4020c0c
    s_mov_b32 s47, 0x4030c0c
    s_mov_b32 s36, 0
    s_mov_b32 s43, 0
    s_mov_b32 s42, 0
    s_mov_b64 s[80:81], 0
    s_mov_b64 s[48:49], 0
    s_add_u32 s16, s30, 0xd344000
    s_addc_u32 s17, s31, 0
    s_mov_b32 s18, 0x500000
    s_mov_b32 s19, 0x20000
    v_mov_b32 v68, 0
    v_mov_b32 v69, 0
    v_mov_b32 v70, 0
    v_mov_b32 v71, 0
    v_mov_b32 v72, 0
    v_mov_b32 v73, 0
    v_mov_b32 v74, 0
    v_mov_b32 v75, 0
    s_waitcnt vmcnt(0)
    v_lshl_or_b32 v8, v101, 16, v100
    v_lshl_or_b32 v9, v103, 16, v102
    s_barrier
    s_cmp_lg_u32 s32, 0
    s_cbranch_scc1 L2_sg2
    s_mov_b32 exec_hi, 0
    v_mov_b32 v88, 2
    buffer_store_dword v88, v0, s[60:63], s57 offen sc1
    s_mov_b64 exec, -1
L2_sg2:
    s_mov_b64 s[84:85], 0
    s_mul_i32 s3, s33, 1280000
    s_add_u32 s3, s3, s100
    s_add_u32 s3, s3, 32768
    buffer_load_dwordx4 v[124:127], v94, s[24:27], s3 offen offset:2048
    s_mul_i32 s3, s33, 1280000
    s_add_u32 s3, s3, s100
    s_add_u32 s3, s3, 32768
    buffer_load_dwordx4 v[116:119], v94, s[24:27], s3 offen offset:0
    s_mul_i32 s3, s33, 1280000
    s_add_u32 s3, s3, s100
    s_add_u32 s3, s3, 32768
    buffer_load_dwordx4 v[120:123], v94, s[24:27], s3 offen offset:1024
    s_mul_i32 s3, s33, 1280000
    s_add_u32 s3, s3, s38
    s_add_u32 s3, s3, 0
    buffer_load_dwordx4 v[108:111], v94, s[24:27], s3 offen offset:0
    s_mul_i32 s3, s33, 1280000
    s_add_u32 s3, s3, s38
    s_add_u32 s3, s3, 0
    buffer_load_dwordx4 v[112:115], v94, s[24:27], s3 offen offset:1024
    ds_write_b128 v20, v[16:19] offset:0
    ds_write_b128 v20, v[16:19] offset:16384
    ds_write_b128 v20, v[16:19] offset:32768
    ds_write_b128 v20, v[16:19] offset:49152
    ds_write_b128 v21, v[16:19]
    s_cmp_eq_u32 s56, 0
    s_cbranch_scc1 L2_e3
    v_lshlrev_b32 v16, 3, v94
    v_and_b32 v16, 0x80, v16
L2_e4:
    buffer_load_dword v88, v16, s[68:71], 0 offen sc1
    s_waitcnt vmcnt(0)
    v_cmp_gt_u32 vcc, 0x80, v88
    s_cbranch_vccnz L2_e4
L2_e3:
    s_mov_b64 exec, 0xffff
L2_p1:
    buffer_load_dword v88, v7, s[60:63], 0 offen sc1
    s_waitcnt vmcnt(0)
    v_cmpx_gt_u32 vcc, 1, v88
    s_cbranch_vccnz L2_p1
    s_mov_b64 exec, -1
    v_cmp_gt_u32 vcc, 2, v88
    s_and_b32 s56, vcc_lo, 0xffff
    buffer_load_dwordx4 v[48:51], v95, s[12:15], s39 offen offset:0
    buffer_load_dwordx4 v[56:59], v95, s[12:15], s39 offen offset:32
    buffer_load_dwordx4 v[52:55], v95, s[12:15], s39 offen offset:16
    buffer_load_dwordx4 v[60:63], v95, s[12:15], s39 offen offset:48
    buffer_load_dwordx4 v[64:67], v93, s[12:15], s39 offen
    s_waitcnt vmcnt(0)
    v_sub_u16 v88, v56, v48
    v_and_b32 v89, 3, v48
    v_add3_u32 v99, v88, v89, 3
    v_and_b32 v99, -4, v99
    v_max_u32 v99, 4, v99
    v_and_b32 v97, 0xfffc, v48
    v_bfm_b32 v96, v88, v89
    v_add_u32_dpp v91, v99, v99 row_shr:1 row_mask:0xf bank_mask:0xf bound_ctrl:1
    v_mad_u32_u24 v97, v97, 5, v2
    v_cmp_lt_u32 vcc, 16, v99
    v_add_u32_dpp v91, v91, v91 row_shr:2 row_mask:0xf bank_mask:0xf bound_ctrl:1
    v_sub_u32 v98, s38, v99
    v_lshrrev_b64 v[48:49], 16, v[48:49]
    v_add_u32_dpp v91, v91, v91 row_shr:4 row_mask:0xf bank_mask:0xf bound_ctrl:1
    v_lshrrev_b64 v[56:57], 16, v[56:57]
    s_mov_b32 s101, 0
    v_add_u32_dpp v91, v91, v91 row_shr:8 row_mask:0xf bank_mask:0xf bound_ctrl:1
    s_nop 1
    v_add_u32_dpp v91, v91, v91 row_bcast:15 row_mask:0xa bank_mask:0xf
    s_nop 1
    v_add_u32_dpp v91, v91, v91 row_bcast:31 row_mask:0xc bank_mask:0xf
    v_add_u32 v98, v98, v91
    v_readlane_b32 s37, v91, 63
    s_cbranch_vccnz L2_xo3
L2_xp3:
    s_cmp_gt_u32 s37, 1024
    s_cbranch_scc1 L2_xs4
    s_cmp_lg_u32 s101, 0
    s_cbranch_scc1 L2_xa4
L2_xb4:
    v_lshlrev_b32 v89, 16, v96
    v_add_u32 v90, 60, v97
    v_bitop3_b32 v90, v89, v45, v90 bitop3:0x6a
    ds_write_b32 v98, v90 offset:12
    v_lshlrev_b32 v89, 20, v96
    v_add_u32 v90, 40, v97
    v_bitop3_b32 v90, v89, v45, v90 bitop3:0x6a
    ds_write_b32 v98, v90 offset:8
    v_lshlrev_b32 v89, 24, v96
    v_add_u32 v90, 20, v97
    v_bitop3_b32 v90, v89, v45, v90 bitop3:0x6a
    ds_write_b32 v98, v90 offset:4
    v_lshlrev_b32 v89, 28, v96
    v_bitop3_b32 v90, v89, v45, v97 bitop3:0x6a
    ds_write_b32 v98, v90 offset:0
    v_mov_b32_dpp v91, v64 quad_perm:[0,0,0,0] row_mask:0xf bank_mask:0xf
    v_and_b32 v89, 3, v91
    v_and_b32 v97, 0xfffc, v91
    v_sub_u16_dpp v88, v64, v91 quad_perm:[2,2,2,2] row_mask:0xf bank_mask:0xf
    v_mad_u32_u24 v97, v97, 5, v4
    v_add_u32 v99, v88, v89
    v_bfm_b32 v96, v88, v89
    v_cmp_lt_u32 s[58:59], 16, v99
    v_lshlrev_b32 v89, v1, v96
    v_and_b32 v89, v45, v89
    v_cmp_ne_u32 vcc, 0, v89
    v_xor_b32 v90, v97, v89
    s_add_u32 s3, s37, s38
    v_mbcnt_lo_u32_b32 v98, vcc_lo, 0
    v_mbcnt_hi_u32_b32 v98, vcc_hi, v98
    s_bcnt1_i32_b64 s41, vcc
    v_lshl_add_u32 v98, v98, 2, s3
    s_lshl2_add_u32 s37, s41, s37
    s_mov_b64 exec, vcc
    ds_write_b32 v98, v90
    s_mov_b64 exec, -1
    s_cmp_lg_u64 s[58:59], 0
    s_cbranch_scc1 L2_xe4
L2_xr4:
    v_add_u32 v98, s37, v0
    v_mov_b32 v90, -1
    ds_write_b32 v98, v90
L2_xw4:
    ds_read_b32 v21, v0 offset:0
    ds_read_b32 v27, v0 offset:256
    ds_read_b32 v31, v44 offset:768
    ds_read_b32 v39, v0 offset:512
    s_sub_u32 s3, s37, 768
    s_cmp_gt_u32 s3, 128
    s_cbranch_scc1 L2_xf4
L2_xg4:
    v_sub_u16 v88, v58, v50
    v_and_b32 v89, 3, v50
    v_add3_u32 v99, v88, v89, 3
    v_and_b32 v99, -4, v99
    v_max_u32 v99, 4, v99
    v_and_b32 v97, 0xfffc, v50
    v_bfm_b32 v96, v88, v89
    v_add_u32_dpp v91, v99, v99 row_shr:1 row_mask:0xf bank_mask:0xf bound_ctrl:1
    v_mad_u32_u24 v97, v97, 5, v2
    v_cmp_lt_u32 vcc, 16, v99
    v_add_u32_dpp v91, v91, v91 row_shr:2 row_mask:0xf bank_mask:0xf bound_ctrl:1
    v_sub_u32 v98, s38, v99
    v_lshrrev_b64 v[50:51], 16, v[50:51]
    v_add_u32_dpp v91, v91, v91 row_shr:4 row_mask:0xf bank_mask:0xf bound_ctrl:1
    v_lshrrev_b64 v[58:59], 16, v[58:59]
    s_mov_b32 s101, 0
    v_add_u32_dpp v91, v91, v91 row_shr:8 row_mask:0xf bank_mask:0xf bound_ctrl:1
    s_nop 1
    v_add_u32_dpp v91, v91, v91 row_bcast:15 row_mask:0xa bank_mask:0xf
    s_nop 1
    v_add_u32_dpp v91, v91, v91 row_bcast:31 row_mask:0xc bank_mask:0xf
    v_add_u32 v98, v98, v91
    v_readlane_b32 s37, v91, 63
    s_cbranch_vccnz L2_xo5
L2_xp5:
    s_waitcnt lgkmcnt(0)
    s_cmp_gt_u32 s37, 1024
    s_cbranch_scc1 L2_xs6
    s_cmp_lg_u32 s101, 0
    s_cbranch_scc1 L2_xa6
L2_xb6:
    v_lshlrev_b32 v89, 16, v96
    v_add_u32 v90, 60, v97
    v_bitop3_b32 v90, v89, v45, v90 bitop3:0x6a
    ds_write_b32 v98, v90 offset:12
    v_lshlrev_b32 v89, 20, v96
    v_add_u32 v90, 40, v97
    v_bitop3_b32 v90, v89, v45, v90 bitop3:0x6a
    ds_write_b32 v98, v90 offset:8
    v_lshlrev_b32 v89, 24, v96
    v_add_u32 v90, 20, v97
    v_bitop3_b32 v90, v89, v45, v90 bitop3:0x6a
    ds_write_b32 v98, v90 offset:4
    v_lshlrev_b32 v89, 28, v96
    v_bitop3_b32 v90, v89, v45, v97 bitop3:0x6a
    ds_write_b32 v98, v90 offset:0
    v_mov_b32_dpp v91, v66 quad_perm:[0,0,0,0] row_mask:0xf bank_mask:0xf
    v_and_b32 v89, 3, v91
    v_and_b32 v97, 0xfffc, v91
    v_sub_u16_dpp v88, v66, v91 quad_perm:[2,2,2,2] row_mask:0xf bank_mask:0xf
    v_mad_u32_u24 v97, v97, 5, v4
    v_add_u32 v99, v88, v89
    v_bfm_b32 v96, v88, v89
    v_cmp_lt_u32 s[58:59], 16, v99
    v_lshlrev_b32 v89, v1, v96
    v_and_b32 v89, v45, v89
    v_cmp_ne_u32 vcc, 0, v89
    v_xor_b32 v90, v97, v89
    s_add_u32 s3, s37, s38
    v_mbcnt_lo_u32_b32 v98, vcc_lo, 0
    v_mbcnt_hi_u32_b32 v98, vcc_hi, v98
    s_bcnt1_i32_b64 s41, vcc
    v_lshl_add_u32 v98, v98, 2, s3
    s_lshl2_add_u32 s37, s41, s37
    s_mov_b64 exec, vcc
    ds_write_b32 v98, v90
    s_mov_b64 exec, -1
    s_cmp_lg_u64 s[58:59], 0
    s_cbranch_scc1 L2_xe6
L2_xr6:
    v_add_u32 v98, s37, v0
    v_mov_b32 v90, -1
    ds_write_b32 v98, v90
L2_xw6:
    ds_read_b32 v40, v0 offset:0
    ds_read_b32 v41, v0 offset:256
    ds_read_b32 v42, v44 offset:768
    ds_read_b32 v43, v0 offset:512
    s_sub_u32 s3, s37, 768
    s_cmp_gt_u32 s3, 128
    s_cbranch_scc1 L2_xf6
L2_xg6:
    v_subrev_u32 v88, s38, v3
    ds_write_b128 v88, v[124:127] offset:34816
    v_subrev_u32 v88, s38, v3
    ds_write_b128 v88, v[116:119] offset:32768
    v_subrev_u32 v88, s38, v3
    ds_write_b128 v88, v[120:123] offset:33792
    v_subrev_u32 v88, s100, v3
    ds_write_b128 v88, v[108:111] offset:0
    v_subrev_u32 v88, s100, v3
    ds_write_b128 v88, v[112:115] offset:1024
    s_cmp_eq_u32 s56, 0
    s_cbranch_scc1 L2_e2
    s_mov_b32 exec_lo, s56
    s_mov_b32 exec_hi, 0
    buffer_load_dword v88, v7, s[60:63], 0 offen sc1
    s_mov_b64 exec, -1
    s_waitcnt vmcnt(0)
    v_cmp_gt_u32 vcc, 2, v88
    s_and_b32 s56, vcc_lo, s56
    s_cbranch_scc0 L2_e2
    s_mul_i32 s3, s33, 1280000
    s_add_u32 s3, s3, s100
    s_add_u32 s3, s3, 352768
    buffer_load_dwordx4 v[124:127], v94, s[24:27], s3 offen offset:2048
    s_mul_i32 s3, s33, 1280000
    s_add_u32 s3, s3, s100
    s_add_u32 s3, s3, 352768
    buffer_load_dwordx4 v[116:119], v94, s[24:27], s3 offen offset:0
    s_mul_i32 s3, s33, 1280000
    s_add_u32 s3, s3, s100
    s_add_u32 s3, s3, 352768
    buffer_load_dwordx4 v[120:123], v94, s[24:27], s3 offen offset:1024
    s_mul_i32 s3, s33, 1280000
    s_add_u32 s3, s3, s38
    s_add_u32 s3, s3, 320000
    buffer_load_dwordx4 v[108:111], v94, s[24:27], s3 offen offset:0
    s_mul_i32 s3, s33, 1280000
    s_add_u32 s3, s3, s38
    s_add_u32 s3, s3, 320000
    buffer_load_dwordx4 v[112:115], v94, s[24:27], s3 offen offset:1024
    s_mov_b32 exec_lo, s56
    s_mov_b32 exec_hi, 0
L2_p2:
    buffer_load_dword v88, v7, s[60:63], 0 offen sc1
    s_waitcnt vmcnt(0)
    v_cmpx_gt_u32 vcc, 2, v88
    s_cbranch_vccnz L2_p2
    s_mov_b64 exec, -1
L2_e2:
    s_mov_b32 s6, 0xaaaaaaaa
    s_mov_b32 s7, 0xaaaaaaaa
    v_and_b32 v47, 0x0fffffff, v21
    buffer_load_dwordx2 v[16:17], v47, s[8:11], 0 offen
    buffer_load_dwordx3 v[18:20], v47, s[8:11], 0 offen offset:8
    s_setprio 1
    v_and_b32 v47, 0x0fffffff, v27
    buffer_load_dwordx2 v[22:23], v47, s[8:11], 0 offen
    buffer_load_dwordx3 v[24:26], v47, s[8:11], 0 offen offset:8
    s_waitcnt lgkmcnt(0)
    s_barrier
    s_bitcmp1_b32 s36, s42
    s_cbranch_scc1 L2_slow
L2_ret0:
    s_setprio 3
    s_bitcmp1_b32 s43, s42
    s_cbranch_scc1 L2_oa7
L2_ob7:
    s_bitcmp1_b32 s43, s42
    s_cbranch_scc1 L2_oa8
L2_ob8:
    s_waitcnt vmcnt(2)
    v_and_b32 v46, 0x20000000, v21
    v_lshrrev_b32 v47, 14, v17
    v_bitop3_b32 v47, v47, v5, v46 bitop3:0xea
    ds_read_b64 v[102:103], v47
    v_bitop3_b32 v93, v17, v5, v46 bitop3:0xea
    v_and_b32 v46, 0x10000000, v21
    v_lshrrev_b32 v47, 14, v16
    v_bitop3_b32 v47, v47, v5, v46 bitop3:0xea
    ds_read_b64 v[100:101], v47
    v_bitop3_b32 v92, v16, v5, v46 bitop3:0xea
    v_perm_b32 v15, v17, v20, s45
    v_bitop3_b32 v46, v17, 0.5, -0.5 bitop3:0xa8
    v_perm_b32 v14, v16, v20, s44
    v_bitop3_b32 v47, v16, 0.5, -0.5 bitop3:0xa8
    v_bitop3_b32 v15, v6, v15, v46 bitop3:0xca
    v_bitop3_b32 v14, v6, v14, v47 bitop3:0xca
    s_waitcnt lgkmcnt(0)
    v_mfma_f32_4x4x4_16b_bf16 v[80:83], v[8:9], v[102:103], 0
    v_mfma_f32_4x4x4_16b_bf16 v[76:79], v[8:9], v[100:101], 0
    v_cmp_lt_u32 s[84:85], v5, v92
    s_nop 2
    v_pk_mul_f32 v[80:81], v[80:81], v[14:15] op_sel:[0,1] op_sel_hi:[1,1]
    v_pk_mul_f32 v[82:83], v[82:83], v[14:15] op_sel:[0,1] op_sel_hi:[1,1]
    v_pk_mul_f32 v[76:77], v[76:77], v[14:15] op_sel:[0,0] op_sel_hi:[1,0]
    v_pk_mul_f32 v[78:79], v[78:79], v[14:15] op_sel:[0,0] op_sel_hi:[1,0]
    v_and_b32 v47, 0x0fffffff, v39
    buffer_load_dwordx2 v[34:35], v47, s[8:11], 0 offen
    buffer_load_dwordx3 v[36:38], v47, s[8:11], 0 offen offset:8
    v_and_b32 v46, 0x80000000, v21
    v_lshrrev_b32 v47, 14, v19
    v_bitop3_b32 v47, v47, v5, v46 bitop3:0xea
    ds_read_b64 v[106:107], v47
    v_and_b32 v99, 0x40000000, v21
    v_lshrrev_b32 v47, 14, v18
    v_bitop3_b32 v47, v47, v5, v99 bitop3:0xea
    ds_read_b64 v[104:105], v47
    v_cmp_ne_u64 s[50:51], v[72:73], v[68:69]
    v_cmpx_ne_u64 s[54:55], v[74:75], v[70:71]
    s_and_b64 s[82:83], s[54:55], s[80:81]
    s_cbranch_scc1 L2_c9
L2_d9:
    v_mov_b64 v[84:85], v[70:71]
    v_mov_b32 v7, v95
    v_mov_b64 v[86:87], v[74:75]
    s_or_b64 s[80:81], s[80:81], s[54:55]
    s_mov_b64 exec, s[50:51]
    s_and_b64 s[82:83], s[50:51], s[80:81]
    s_cbranch_scc1 L2_c10
L2_d10:
    v_mov_b64 v[84:85], v[68:69]
    v_mov_b32 v7, v94
    v_mov_b64 v[86:87], v[72:73]
    s_mov_b64 exec, -1
    s_or_b64 s[80:81], s[80:81], s[50:51]
    s_and_b64 exec, s[84:85], s[80:81]
    v_mfma_f32_4x4x4_16b_bf16 v[76:79], v[12:13], v[84:85], 0
    v_mov_b32 v92, v7
    s_andn2_b64 s[80:81], s[80:81], s[84:85]
    v_mfma_f32_4x4x4_16b_bf16 v[76:79], v[10:11], v[86:87], v[76:79]
    s_mov_b64 exec, -1
    ds_read_b64 v[70:71], v93 offset:65408
    ds_read_b64 v[68:69], v92 offset:65408
    v_bitop3_b32 v94, v18, v5, v99 bitop3:0xea
    v_bitop3_b32 v95, v19, v5, v46 bitop3:0xea
    v_perm_b32 v15, v19, v20, s47
    v_bitop3_b32 v46, v19, 0.5, -0.5 bitop3:0xa8
    v_perm_b32 v14, v18, v20, s46
    v_bitop3_b32 v47, v18, 0.5, -0.5 bitop3:0xa8
    v_bitop3_b32 v15, v6, v15, v46 bitop3:0xca
    v_bitop3_b32 v14, v6, v14, v47 bitop3:0xca
    s_waitcnt lgkmcnt(1)
    v_mfma_f32_4x4x4_16b_bf16 v[80:83], v[10:11], v[70:71], v[80:83]
    s_waitcnt lgkmcnt(0)
    v_mfma_f32_4x4x4_16b_bf16 v[76:79], v[10:11], v[68:69], v[76:79]
    s_nop 2
    v_cvt_pk_bf16_f32 v80, v80, v81
    v_cvt_pk_bf16_f32 v81, v82, v83
    ds_wrxchg_rtn_b64 v[74:75], v93, v[80:81] offset:65408
    v_cvt_pk_bf16_f32 v76, v76, v77
    v_cvt_pk_bf16_f32 v77, v78, v79
    ds_wrxchg_rtn_b64 v[72:73], v92, v[76:77] offset:65408
    s_setprio 2
    v_mfma_f32_4x4x4_16b_bf16 v[80:83], v[8:9], v[106:107], 0
    v_mfma_f32_4x4x4_16b_bf16 v[76:79], v[8:9], v[104:105], 0
    v_cmp_lt_u32 s[48:49], v5, v95
    s_nop 2
    v_pk_mul_f32 v[80:81], v[80:81], v[14:15] op_sel:[0,1] op_sel_hi:[1,1]
    v_pk_mul_f32 v[82:83], v[82:83], v[14:15] op_sel:[0,1] op_sel_hi:[1,1]
    v_pk_mul_f32 v[76:77], v[76:77], v[14:15] op_sel:[0,0] op_sel_hi:[1,0]
    v_pk_mul_f32 v[78:79], v[78:79], v[14:15] op_sel:[0,0] op_sel_hi:[1,0]
    v_and_b32 v47, 0x0fffffff, v31
    buffer_load_dword v30, v47, s[8:11], 0 offen offset:16
    s_mov_b64 exec, s[6:7]
    v_add_u32 v47, 8, v47
    v_lshrrev_b32 v31, 2, v31
    s_mov_b64 exec, -1
    buffer_load_dwordx2 v[28:29], v47, s[8:11], 0 offen
    v_and_b32 v47, 0x3f0, v3
    s_cmp_lg_u32 s56, 0
    s_cbranch_scc1 L2_m11
    s_mul_i32 s3, s33, 1280000
    s_add_u32 s3, s3, s100
    s_add_u32 s3, s3, 352768
    buffer_load_dwordx4 v[124:127], v47, s[24:27], s3 offen offset:2048
L2_m11:
    v_and_b32 v47, 0x3f0, v3
    s_cmp_lg_u32 s56, 0
    s_cbranch_scc1 L2_m12
    s_mul_i32 s3, s33, 1280000
    s_add_u32 s3, s3, s100
    s_add_u32 s3, s3, 352768
    buffer_load_dwordx4 v[116:119], v47, s[24:27], s3 offen offset:0
L2_m12:
    s_waitcnt vmcnt(4)
    v_and_b32 v46, 0x20000000, v27
    v_lshrrev_b32 v47, 14, v23
    v_bitop3_b32 v47, v47, v5, v46 bitop3:0xea
    ds_read_b64 v[102:103], v47
    v_and_b32 v99, 0x10000000, v27
    v_lshrrev_b32 v47, 14, v22
    v_bitop3_b32 v47, v47, v5, v99 bitop3:0xea
    ds_read_b64 v[100:101], v47
    s_waitcnt lgkmcnt(2)
    v_cmp_ne_u64 s[50:51], v[72:73], v[68:69]
    v_cmpx_ne_u64 s[54:55], v[74:75], v[70:71]
    s_and_b64 s[82:83], s[54:55], s[80:81]
    s_cbranch_scc1 L2_c13
L2_d13:
    v_mov_b64 v[84:85], v[70:71]
    v_mov_b32 v7, v93
    v_mov_b64 v[86:87], v[74:75]
    s_or_b64 s[80:81], s[80:81], s[54:55]
    s_mov_b64 exec, s[50:51]
    s_and_b64 s[82:83], s[50:51], s[80:81]
    s_cbranch_scc1 L2_c14
L2_d14:
    v_mov_b64 v[84:85], v[68:69]
    v_mov_b32 v7, v92
    v_mov_b64 v[86:87], v[72:73]
    s_mov_b64 exec, -1
    s_or_b64 s[80:81], s[80:81], s[50:51]
    s_and_b64 exec, s[48:49], s[80:81]
    v_mfma_f32_4x4x4_16b_bf16 v[80:83], v[12:13], v[84:85], 0
    v_mov_b32 v95, v7
    s_andn2_b64 s[80:81], s[80:81], s[48:49]
    v_mfma_f32_4x4x4_16b_bf16 v[80:83], v[10:11], v[86:87], v[80:83]
    s_mov_b64 exec, -1
    ds_read_b64 v[70:71], v95 offset:65408
    ds_read_b64 v[68:69], v94 offset:65408
    v_bitop3_b32 v92, v22, v5, v99 bitop3:0xea
    v_bitop3_b32 v93, v23, v5, v46 bitop3:0xea
    v_perm_b32 v15, v23, v26, s45
    v_bitop3_b32 v46, v23, 0.5, -0.5 bitop3:0xa8
    v_perm_b32 v14, v22, v26, s44
    v_bitop3_b32 v47, v22, 0.5, -0.5 bitop3:0xa8
    v_bitop3_b32 v15, v6, v15, v46 bitop3:0xca
    v_bitop3_b32 v14, v6, v14, v47 bitop3:0xca
    s_waitcnt lgkmcnt(1)
    v_mfma_f32_4x4x4_16b_bf16 v[80:83], v[10:11], v[70:71], v[80:83]
    s_waitcnt lgkmcnt(0)
    v_mfma_f32_4x4x4_16b_bf16 v[76:79], v[10:11], v[68:69], v[76:79]
    s_nop 2
    v_cvt_pk_bf16_f32 v80, v80, v81
    v_cvt_pk_bf16_f32 v81, v82, v83
    ds_wrxchg_rtn_b64 v[74:75], v95, v[80:81] offset:65408
    v_cvt_pk_bf16_f32 v76, v76, v77
    v_cvt_pk_bf16_f32 v77, v78, v79
    ds_wrxchg_rtn_b64 v[72:73], v94, v[76:77] offset:65408
    s_setprio 1
    v_mfma_f32_4x4x4_16b_bf16 v[80:83], v[8:9], v[102:103], 0
    v_mfma_f32_4x4x4_16b_bf16 v[76:79], v[8:9], v[100:101], 0
    s_nop 3
    v_pk_mul_f32 v[80:81], v[80:81], v[14:15] op_sel:[0,1] op_sel_hi:[1,1]
    v_pk_mul_f32 v[82:83], v[82:83], v[14:15] op_sel:[0,1] op_sel_hi:[1,1]
    v_pk_mul_f32 v[76:77], v[76:77], v[14:15] op_sel:[0,0] op_sel_hi:[1,0]
    v_pk_mul_f32 v[78:79], v[78:79], v[14:15] op_sel:[0,0] op_sel_hi:[1,0]
    v_and_b32 v47, 0x3f0, v3
    s_cmp_lg_u32 s56, 0
    s_cbranch_scc1 L2_m15
    s_mul_i32 s3, s33, 1280000
    s_add_u32 s3, s3, s100
    s_add_u32 s3, s3, 352768
    buffer_load_dwordx4 v[120:123], v47, s[24:27], s3 offen offset:1024
L2_m15:
    v_sub_u16 v88, v60, v52
    v_and_b32 v89, 3, v52
    v_add3_u32 v99, v88, v89, 3
    v_and_b32 v99, -4, v99
    v_max_u32 v99, 4, v99
    v_and_b32 v97, 0xfffc, v52
    v_bfm_b32 v96, v88, v89
    v_add_u32_dpp v91, v99, v99 row_shr:1 row_mask:0xf bank_mask:0xf bound_ctrl:1
    v_mad_u32_u24 v97, v97, 5, v2
    v_cmp_lt_u32 vcc, 16, v99
    v_add_u32_dpp v91, v91, v91 row_shr:2 row_mask:0xf bank_mask:0xf bound_ctrl:1
    v_sub_u32 v98, s38, v99
    v_lshrrev_b64 v[52:53], 16, v[52:53]
    v_add_u32_dpp v91, v91, v91 row_shr:4 row_mask:0xf bank_mask:0xf bound_ctrl:1
    v_lshrrev_b64 v[60:61], 16, v[60:61]
    s_mov_b32 s101, 0
    v_add_u32_dpp v91, v91, v91 row_shr:8 row_mask:0xf bank_mask:0xf bound_ctrl:1
    s_nop 1
    v_add_u32_dpp v91, v91, v91 row_bcast:15 row_mask:0xa bank_mask:0xf
    s_nop 1
    v_add_u32_dpp v91, v91, v91 row_bcast:31 row_mask:0xc bank_mask:0xf
    v_add_u32 v98, v98, v91
    v_readlane_b32 s37, v91, 63
    s_cbranch_vccnz L2_xo16
L2_xp16:
    v_and_b32 v46, 0x80000000, v27
    v_lshrrev_b32 v47, 14, v25
    v_bitop3_b32 v47, v47, v5, v46 bitop3:0xea
    ds_read_b64 v[106:107], v47
    v_and_b32 v99, 0x40000000, v27
    v_lshrrev_b32 v47, 14, v24
    v_bitop3_b32 v47, v47, v5, v99 bitop3:0xea
    ds_read_b64 v[104:105], v47
    s_waitcnt lgkmcnt(2)
    v_cmp_ne_u64 s[50:51], v[72:73], v[68:69]
    v_cmpx_ne_u64 s[54:55], v[74:75], v[70:71]
    s_and_b64 s[82:83], s[54:55], s[80:81]
    s_cbranch_scc1 L2_c17
L2_d17:
    v_mov_b64 v[84:85], v[70:71]
    v_mov_b32 v7, v95
    v_mov_b64 v[86:87], v[74:75]
    s_or_b64 s[80:81], s[80:81], s[54:55]
    s_mov_b64 exec, s[50:51]
    s_and_b64 s[82:83], s[50:51], s[80:81]
    s_cbranch_scc1 L2_c18
L2_d18:
    v_mov_b64 v[84:85], v[68:69]
    v_mov_b32 v7, v94
    v_mov_b64 v[86:87], v[72:73]
    s_mov_b64 exec, -1
    s_or_b64 s[80:81], s[80:81], s[50:51]
    ds_read_b64 v[70:71], v93 offset:65408
    ds_read_b64 v[68:69], v92 offset:65408
    v_bitop3_b32 v94, v24, v5, v99 bitop3:0xea
    v_bitop3_b32 v95, v25, v5, v46 bitop3:0xea
    v_perm_b32 v15, v25, v26, s47
    v_bitop3_b32 v46, v25, 0.5, -0.5 bitop3:0xa8
    v_perm_b32 v14, v24, v26, s46
    v_bitop3_b32 v47, v24, 0.5, -0.5 bitop3:0xa8
    v_bitop3_b32 v15, v6, v15, v46 bitop3:0xca
    v_bitop3_b32 v14, v6, v14, v47 bitop3:0xca
    s_waitcnt lgkmcnt(1)
    v_mfma_f32_4x4x4_16b_bf16 v[80:83], v[10:11], v[70:71], v[80:83]
    s_waitcnt lgkmcnt(0)
    v_mfma_f32_4x4x4_16b_bf16 v[76:79], v[10:11], v[68:69], v[76:79]
    s_nop 2
    v_cvt_pk_bf16_f32 v80, v80, v81
    v_cvt_pk_bf16_f32 v81, v82, v83
    ds_wrxchg_rtn_b64 v[74:75], v93, v[80:81] offset:65408
    v_cvt_pk_bf16_f32 v76, v76, v77
    v_cvt_pk_bf16_f32 v77, v78, v79
    ds_wrxchg_rtn_b64 v[72:73], v92, v[76:77] offset:65408
    v_mfma_f32_4x4x4_16b_bf16 v[80:83], v[8:9], v[106:107], 0
    v_mfma_f32_4x4x4_16b_bf16 v[76:79], v[8:9], v[104:105], 0
    v_cmp_lt_u32 s[84:85], v5, v94
    s_nop 2
    v_pk_mul_f32 v[80:81], v[80:81], v[14:15] op_sel:[0,1] op_sel_hi:[1,1]
    v_pk_mul_f32 v[82:83], v[82:83], v[14:15] op_sel:[0,1] op_sel_hi:[1,1]
    v_pk_mul_f32 v[76:77], v[76:77], v[14:15] op_sel:[0,0] op_sel_hi:[1,0]
    v_pk_mul_f32 v[78:79], v[78:79], v[14:15] op_sel:[0,0] op_sel_hi:[1,0]
    v_and_b32 v47, 0x3f0, v3
    s_cmp_lg_u32 s56, 0
    s_cbranch_scc1 L2_m19
    s_mul_i32 s3, s33, 1280000
    s_add_u32 s3, s3, s38
    s_add_u32 s3, s3, 320000
    buffer_load_dwordx4 v[108:111], v47, s[24:27], s3 offen offset:0
L2_m19:
    v_and_b32 v47, 0x3f0, v3
    s_cmp_lg_u32 s56, 0
    s_cbranch_scc1 L2_m20
    s_mul_i32 s3, s33, 1280000
    s_add_u32 s3, s3, s38
    s_add_u32 s3, s3, 320000
    buffer_load_dwordx4 v[112:115], v47, s[24:27], s3 offen offset:1024
L2_m20:
    v_and_b32 v47, 0x0fffffff, v40
    buffer_load_dwordx2 v[16:17], v47, s[8:11], 0 offen
    buffer_load_dwordx3 v[18:20], v47, s[8:11], 0 offen offset:8
    s_waitcnt vmcnt(2)
    s_mov_b64 exec, s[6:7]
    v_lshrrev_b32 v30, 16, v30
    s_mov_b64 exec, -1
    v_and_b32 v46, 0x20000000, v31
    v_lshrrev_b32 v47, 14, v29
    v_bitop3_b32 v47, v47, v5, v46 bitop3:0xea
    ds_read_b64 v[102:103], v47
    v_and_b32 v99, 0x10000000, v31
    v_lshrrev_b32 v47, 14, v28
    v_bitop3_b32 v47, v47, v5, v99 bitop3:0xea
    ds_read_b64 v[100:101], v47
    s_waitcnt lgkmcnt(2)
    v_cmp_ne_u64 s[50:51], v[72:73], v[68:69]
    v_cmpx_ne_u64 s[54:55], v[74:75], v[70:71]
    s_and_b64 s[82:83], s[54:55], s[80:81]
    s_cbranch_scc1 L2_c21
L2_d21:
    v_mov_b64 v[84:85], v[70:71]
    v_mov_b32 v7, v93
    v_mov_b64 v[86:87], v[74:75]
    s_or_b64 s[80:81], s[80:81], s[54:55]
    s_mov_b64 exec, s[50:51]
    s_and_b64 s[82:83], s[50:51], s[80:81]
    s_cbranch_scc1 L2_c22
L2_d22:
    v_mov_b64 v[84:85], v[68:69]
    v_mov_b32 v7, v92
    v_mov_b64 v[86:87], v[72:73]
    s_mov_b64 exec, -1
    s_or_b64 s[80:81], s[80:81], s[50:51]
    s_and_b64 exec, s[84:85], s[80:81]
    v_mfma_f32_4x4x4_16b_bf16 v[76:79], v[12:13], v[84:85], 0
    v_mov_b32 v94, v7
    s_andn2_b64 s[80:81], s[80:81], s[84:85]
    v_mfma_f32_4x4x4_16b_bf16 v[76:79], v[10:11], v[86:87], v[76:79]
    s_mov_b64 exec, -1
    ds_read_b64 v[70:71], v95 offset:65408
    ds_read_b64 v[68:69], v94 offset:65408
    v_bitop3_b32 v92, v28, v5, v99 bitop3:0xea
    v_bitop3_b32 v93, v29, v5, v46 bitop3:0xea
    v_perm_b32 v15, v29, v30, s45
    v_bitop3_b32 v46, v29, 0.5, -0.5 bitop3:0xa8
    v_perm_b32 v14, v28, v30, s44
    v_bitop3_b32 v47, v28, 0.5, -0.5 bitop3:0xa8
    v_bitop3_b32 v15, v6, v15, v46 bitop3:0xca
    v_bitop3_b32 v14, v6, v14, v47 bitop3:0xca
    s_waitcnt lgkmcnt(1)
    v_mfma_f32_4x4x4_16b_bf16 v[80:83], v[10:11], v[70:71], v[80:83]
    s_waitcnt lgkmcnt(0)
    v_mfma_f32_4x4x4_16b_bf16 v[76:79], v[10:11], v[68:69], v[76:79]
    s_nop 2
    v_cvt_pk_bf16_f32 v80, v80, v81
    v_cvt_pk_bf16_f32 v81, v82, v83
    ds_wrxchg_rtn_b64 v[74:75], v95, v[80:81] offset:65408
    v_cvt_pk_bf16_f32 v76, v76, v77
    v_cvt_pk_bf16_f32 v77, v78, v79
    ds_wrxchg_rtn_b64 v[72:73], v94, v[76:77] offset:65408
    s_setprio 0
    v_mfma_f32_4x4x4_16b_bf16 v[80:83], v[8:9], v[102:103], 0
    v_mfma_f32_4x4x4_16b_bf16 v[76:79], v[8:9], v[100:101], 0
    v_cmp_lt_u32 s[48:49], v5, v93
    s_nop 2
    v_pk_mul_f32 v[80:81], v[80:81], v[14:15] op_sel:[0,1] op_sel_hi:[1,1]
    v_pk_mul_f32 v[82:83], v[82:83], v[14:15] op_sel:[0,1] op_sel_hi:[1,1]
    v_pk_mul_f32 v[76:77], v[76:77], v[14:15] op_sel:[0,0] op_sel_hi:[1,0]
    v_pk_mul_f32 v[78:79], v[78:79], v[14:15] op_sel:[0,0] op_sel_hi:[1,0]
    s_add_u32 s40, s40, 0x50000
    v_and_b32 v47, 0x0fffffff, v41
    buffer_load_dwordx2 v[22:23], v47, s[8:11], 0 offen
    buffer_load_dwordx3 v[24:26], v47, s[8:11], 0 offen offset:8
    v_and_b32 v46, 0x80000000, v39
    v_lshrrev_b32 v47, 14, v37
    v_bitop3_b32 v47, v47, v5, v46 bitop3:0xea
    ds_read_b64 v[102:103], v47
    v_and_b32 v99, 0x40000000, v39
    v_lshrrev_b32 v47, 14, v36
    v_bitop3_b32 v47, v47, v5, v99 bitop3:0xea
    ds_read_b64 v[100:101], v47
    v_and_b32 v46, 0x20000000, v39
    v_lshrrev_b32 v47, 14, v35
    v_bitop3_b32 v47, v47, v5, v46 bitop3:0xea
    ds_read_b64 v[106:107], v47
    v_and_b32 v99, 0x10000000, v39
    v_lshrrev_b32 v47, 14, v34
    v_bitop3_b32 v47, v47, v5, v99 bitop3:0xea
    ds_read_b64 v[104:105], v47
    s_waitcnt lgkmcnt(4)
    v_cmp_ne_u64 s[50:51], v[72:73], v[68:69]
    v_cmpx_ne_u64 s[54:55], v[74:75], v[70:71]
    s_and_b64 s[82:83], s[54:55], s[80:81]
    s_cbranch_scc1 L2_c23
L2_d23:
    v_mov_b64 v[84:85], v[70:71]
    v_mov_b32 v7, v95
    v_mov_b64 v[86:87], v[74:75]
    s_or_b64 s[80:81], s[80:81], s[54:55]
    s_mov_b64 exec, s[50:51]
    s_and_b64 s[82:83], s[50:51], s[80:81]
    s_cbranch_scc1 L2_c24
L2_d24:
    v_mov_b64 v[84:85], v[68:69]
    v_mov_b32 v7, v94
    v_mov_b64 v[86:87], v[72:73]
    s_mov_b64 exec, -1
    s_or_b64 s[80:81], s[80:81], s[50:51]
    s_and_b64 exec, s[48:49], s[80:81]
    v_mfma_f32_4x4x4_16b_bf16 v[80:83], v[12:13], v[84:85], 0
    v_mov_b32 v93, v7
    s_andn2_b64 s[80:81], s[80:81], s[48:49]
    v_mfma_f32_4x4x4_16b_bf16 v[80:83], v[10:11], v[86:87], v[80:83]
    s_mov_b64 exec, -1
    ds_read_b64 v[70:71], v93 offset:65408
    ds_read_b64 v[68:69], v92 offset:65408
    v_bitop3_b32 v94, v34, v5, v99 bitop3:0xea
    v_bitop3_b32 v95, v35, v5, v46 bitop3:0xea
    v_perm_b32 v15, v35, v38, s45
    v_bitop3_b32 v46, v35, 0.5, -0.5 bitop3:0xa8
    v_perm_b32 v14, v34, v38, s44
    v_bitop3_b32 v47, v34, 0.5, -0.5 bitop3:0xa8
    v_bitop3_b32 v15, v6, v15, v46 bitop3:0xca
    v_bitop3_b32 v14, v6, v14, v47 bitop3:0xca
    s_waitcnt lgkmcnt(1)
    v_mfma_f32_4x4x4_16b_bf16 v[80:83], v[10:11], v[70:71], v[80:83]
    s_waitcnt lgkmcnt(0)
    v_mfma_f32_4x4x4_16b_bf16 v[76:79], v[10:11], v[68:69], v[76:79]
    s_nop 2
    v_cvt_pk_bf16_f32 v80, v80, v81
    v_cvt_pk_bf16_f32 v81, v82, v83
    ds_wrxchg_rtn_b64 v[74:75], v93, v[80:81] offset:65408
    v_cvt_pk_bf16_f32 v76, v76, v77
    v_cvt_pk_bf16_f32 v77, v78, v79
    ds_wrxchg_rtn_b64 v[72:73], v92, v[76:77] offset:65408
    s_barrier
    s_setprio 3
    s_waitcnt vmcnt(4)
    v_subrev_u32 v88, s38, v3
    ds_write_b128 v88, v[124:127] offset:34816
    s_add_u32 s3, s40, 4096
    buffer_load_dwordx4 v[124:127], v3, s[16:19], s3 offen sc1
    s_waitcnt vmcnt(5)
    v_subrev_u32 v88, s38, v3
    ds_write_b128 v88, v[116:119] offset:32768
    buffer_load_dwordx4 v[116:119], v3, s[16:19], s40 offen offset:2048 sc1
    s_waitcnt vmcnt(6)
    v_subrev_u32 v88, s38, v3
    ds_write_b128 v88, v[120:123] offset:33792
    buffer_load_dwordx4 v[120:123], v3, s[16:19], s40 offen offset:3072 sc1
    v_mfma_f32_4x4x4_16b_bf16 v[80:83], v[8:9], v[106:107], 0
    v_mfma_f32_4x4x4_16b_bf16 v[76:79], v[8:9], v[104:105], 0
    s_nop 3
    v_pk_mul_f32 v[80:81], v[80:81], v[14:15] op_sel:[0,1] op_sel_hi:[1,1]
    v_pk_mul_f32 v[82:83], v[82:83], v[14:15] op_sel:[0,1] op_sel_hi:[1,1]
    v_pk_mul_f32 v[76:77], v[76:77], v[14:15] op_sel:[0,0] op_sel_hi:[1,0]
    v_pk_mul_f32 v[78:79], v[78:79], v[14:15] op_sel:[0,0] op_sel_hi:[1,0]
    v_and_b32 v47, 0x0fffffff, v42
    buffer_load_dword v30, v47, s[8:11], 0 offen offset:16
    s_mov_b64 exec, s[6:7]
    v_add_u32 v47, 8, v47
    v_lshrrev_b32 v42, 2, v42
    s_mov_b64 exec, -1
    buffer_load_dwordx2 v[28:29], v47, s[8:11], 0 offen
    s_cmp_gt_u32 s37, 1024
    s_cbranch_scc1 L2_xs25
    s_cmp_lg_u32 s101, 0
    s_cbranch_scc1 L2_xa25
L2_xb25:
    v_lshlrev_b32 v89, 16, v96
    v_add_u32 v90, 60, v97
    v_bitop3_b32 v90, v89, v45, v90 bitop3:0x6a
    ds_write_b32 v98, v90 offset:12
    v_lshlrev_b32 v89, 20, v96
    v_add_u32 v90, 40, v97
    v_bitop3_b32 v90, v89, v45, v90 bitop3:0x6a
    ds_write_b32 v98, v90 offset:8
    v_lshlrev_b32 v89, 24, v96
    v_add_u32 v90, 20, v97
    v_bitop3_b32 v90, v89, v45, v90 bitop3:0x6a
    ds_write_b32 v98, v90 offset:4
    v_lshlrev_b32 v89, 28, v96
    v_bitop3_b32 v90, v89, v45, v97 bitop3:0x6a
    ds_write_b32 v98, v90 offset:0
    v_mov_b32_dpp v91, v64 quad_perm:[1,1,1,1] row_mask:0xf bank_mask:0xf
    v_and_b32 v89, 3, v91
    v_and_b32 v97, 0xfffc, v91
    v_sub_u16_dpp v88, v64, v91 quad_perm:[3,3,3,3] row_mask:0xf bank_mask:0xf
    v_mad_u32_u24 v97, v97, 5, v4
    v_add_u32 v99, v88, v89
    v_bfm_b32 v96, v88, v89
    v_cmp_lt_u32 s[58:59], 16, v99
    v_lshlrev_b32 v89, v1, v96
    v_and_b32 v89, v45, v89
    v_cmp_ne_u32 vcc, 0, v89
    v_xor_b32 v90, v97, v89
    s_add_u32 s3, s37, s38
    v_mbcnt_lo_u32_b32 v98, vcc_lo, 0
    v_mbcnt_hi_u32_b32 v98, vcc_hi, v98
    s_bcnt1_i32_b64 s41, vcc
    v_lshl_add_u32 v98, v98, 2, s3
    s_lshl2_add_u32 s37, s41, s37
    s_mov_b64 exec, vcc
    ds_write_b32 v98, v90
    s_mov_b64 exec, -1
    s_cmp_lg_u64 s[58:59], 0
    s_cbranch_scc1 L2_xe25
L2_xr25:
    v_add_u32 v98, s37, v0
    v_mov_b32 v90, -1
    ds_write_b32 v98, v90
L2_xw25:
    s_setprio 2
    s_waitcnt lgkmcnt(9)
    v_cmp_ne_u64 s[50:51], v[72:73], v[68:69]
    v_cmpx_ne_u64 s[54:55], v[74:75], v[70:71]
    s_and_b64 s[82:83], s[54:55], s[80:81]
    s_cbranch_scc1 L2_c26
L2_d26:
    v_mov_b64 v[84:85], v[70:71]
    v_mov_b32 v7, v93
    v_mov_b64 v[86:87], v[74:75]
    s_or_b64 s[80:81], s[80:81], s[54:55]
    s_mov_b64 exec, s[50:51]
    s_and_b64 s[82:83], s[50:51], s[80:81]
    s_cbranch_scc1 L2_c27
L2_d27:
    v_mov_b64 v[84:85], v[68:69]
    v_mov_b32 v7, v92
    v_mov_b64 v[86:87], v[72:73]
    s_mov_b64 exec, -1
    s_or_b64 s[80:81], s[80:81], s[50:51]
    ds_read_b64 v[70:71], v95 offset:65408
    ds_read_b64 v[68:69], v94 offset:65408
    v_and_b32 v46, 0x40000000, v39
    v_bitop3_b32 v92, v36, v5, v46 bitop3:0xea
    v_and_b32 v46, 0x80000000, v39
    v_bitop3_b32 v93, v37, v5, v46 bitop3:0xea
    v_perm_b32 v15, v37, v38, s47
    v_bitop3_b32 v46, v37, 0.5, -0.5 bitop3:0xa8
    v_perm_b32 v14, v36, v38, s46
    v_bitop3_b32 v47, v36, 0.5, -0.5 bitop3:0xa8
    v_bitop3_b32 v15, v6, v15, v46 bitop3:0xca
    v_bitop3_b32 v14, v6, v14, v47 bitop3:0xca
    s_setprio 1
    s_waitcnt lgkmcnt(1)
    v_mfma_f32_4x4x4_16b_bf16 v[80:83], v[10:11], v[70:71], v[80:83]
    s_waitcnt lgkmcnt(0)
    v_mfma_f32_4x4x4_16b_bf16 v[76:79], v[10:11], v[68:69], v[76:79]
    s_nop 2
    v_cvt_pk_bf16_f32 v80, v80, v81
    v_cvt_pk_bf16_f32 v81, v82, v83
    ds_wrxchg_rtn_b64 v[74:75], v95, v[80:81] offset:65408
    v_cvt_pk_bf16_f32 v76, v76, v77
    v_cvt_pk_bf16_f32 v77, v78, v79
    ds_wrxchg_rtn_b64 v[72:73], v94, v[76:77] offset:65408
    ds_read_b32 v21, v0 offset:0
    ds_read_b32 v27, v0 offset:256
    ds_read_b32 v31, v44 offset:768
    ds_read_b32 v39, v0 offset:512
    s_sub_u32 s3, s37, 768
    s_cmp_gt_u32 s3, 128
    s_cbranch_scc1 L2_xf25
L2_xg25:
    v_and_b32 v88, 0x0fffffff, v43
    buffer_load_dwordx2 v[34:35], v88, s[8:11], 0 offen
    buffer_load_dwordx3 v[36:38], v88, s[8:11], 0 offen offset:8
    s_setprio 0
    s_waitcnt vmcnt(11)
    v_subrev_u32 v88, s100, v3
    ds_write_b128 v88, v[108:111] offset:0
    s_waitcnt vmcnt(11)
    v_subrev_u32 v88, s100, v3
    ds_write_b128 v88, v[112:115] offset:1024
    v_mfma_f32_4x4x4_16b_bf16 v[80:83], v[8:9], v[102:103], 0
    v_mfma_f32_4x4x4_16b_bf16 v[76:79], v[8:9], v[100:101], 0
    v_cmp_lt_u32 s[84:85], v5, v92
    s_nop 2
    v_pk_mul_f32 v[80:81], v[80:81], v[14:15] op_sel:[0,1] op_sel_hi:[1,1]
    v_pk_mul_f32 v[82:83], v[82:83], v[14:15] op_sel:[0,1] op_sel_hi:[1,1]
    v_pk_mul_f32 v[76:77], v[76:77], v[14:15] op_sel:[0,0] op_sel_hi:[1,0]
    v_pk_mul_f32 v[78:79], v[78:79], v[14:15] op_sel:[0,0] op_sel_hi:[1,0]
    s_add_u32 s42, s42, 1
    s_waitcnt lgkmcnt(0)
    s_add_u32 s24, s30, 0xec54000
    s_addc_u32 s25, s31, 0
    s_mov_b32 s26, 0x100
    s_mov_b32 s27, 0x20000
    s_barrier
    s_bitcmp1_b32 s36, s42
    s_cbranch_scc1 L2_slow
L2_ret1:
    s_setprio 3
    s_bitcmp1_b32 s43, s42
    s_cbranch_scc1 L2_oa28
L2_ob28:
    s_waitcnt vmcnt(9)
    v_and_b32 v46, 0x20000000, v40
    v_lshrrev_b32 v47, 14, v17
    v_bitop3_b32 v47, v47, v5, v46 bitop3:0xea
    ds_read_b64 v[106:107], v47
    v_and_b32 v99, 0x10000000, v40
    v_lshrrev_b32 v47, 14, v16
    v_bitop3_b32 v47, v47, v5, v99 bitop3:0xea
    ds_read_b64 v[104:105], v47
    v_cmp_ne_u64 s[50:51], v[72:73], v[68:69]
    v_cmpx_ne_u64 s[54:55], v[74:75], v[70:71]
    s_and_b64 s[82:83], s[54:55], s[80:81]
    s_cbranch_scc1 L2_c29
L2_d29:
    v_mov_b64 v[84:85], v[70:71]
    v_mov_b32 v7, v95
    v_mov_b64 v[86:87], v[74:75]
    s_or_b64 s[80:81], s[80:81], s[54:55]
    s_mov_b64 exec, s[50:51]
    s_and_b64 s[82:83], s[50:51], s[80:81]
    s_cbranch_scc1 L2_c30
L2_d30:
    v_mov_b64 v[84:85], v[68:69]
    v_mov_b32 v7, v94
    v_mov_b64 v[86:87], v[72:73]
    s_mov_b64 exec, -1
    s_or_b64 s[80:81], s[80:81], s[50:51]
    s_and_b64 exec, s[84:85], s[80:81]
    v_mfma_f32_4x4x4_16b_bf16 v[76:79], v[12:13], v[84:85], 0
    v_mov_b32 v92, v7
    s_andn2_b64 s[80:81], s[80:81], s[84:85]
    v_mfma_f32_4x4x4_16b_bf16 v[76:79], v[10:11], v[86:87], v[76:79]
    s_mov_b64 exec, -1
    ds_read_b64 v[70:71], v93 offset:65408
    ds_read_b64 v[68:69], v92 offset:65408
    v_bitop3_b32 v94, v16, v5, v99 bitop3:0xea
    v_bitop3_b32 v95, v17, v5, v46 bitop3:0xea
    v_perm_b32 v15, v17, v20, s45
    v_bitop3_b32 v46, v17, 0.5, -0.5 bitop3:0xa8
    v_perm_b32 v14, v16, v20, s44
    v_bitop3_b32 v47, v16, 0.5, -0.5 bitop3:0xa8
    v_bitop3_b32 v15, v6, v15, v46 bitop3:0xca
    v_bitop3_b32 v14, v6, v14, v47 bitop3:0xca
    s_waitcnt lgkmcnt(1)
    v_mfma_f32_4x4x4_16b_bf16 v[80:83], v[10:11], v[70:71], v[80:83]
    s_waitcnt lgkmcnt(0)
    v_mfma_f32_4x4x4_16b_bf16 v[76:79], v[10:11], v[68:69], v[76:79]
    s_nop 2
    v_cvt_pk_bf16_f32 v80, v80, v81
    v_cvt_pk_bf16_f32 v81, v82, v83
    ds_wrxchg_rtn_b64 v[74:75], v93, v[80:81] offset:65408
    v_cvt_pk_bf16_f32 v76, v76, v77
    v_cvt_pk_bf16_f32 v77, v78, v79
    ds_wrxchg_rtn_b64 v[72:73], v92, v[76:77] offset:65408
    v_mfma_f32_4x4x4_16b_bf16 v[80:83], v[8:9], v[106:107], 0
    v_mfma_f32_4x4x4_16b_bf16 v[76:79], v[8:9], v[104:105], 0
    v_cmp_lt_u32 s[84:85], v5, v94
    s_nop 2
    v_pk_mul_f32 v[80:81], v[80:81], v[14:15] op_sel:[0,1] op_sel_hi:[1,1]
    v_pk_mul_f32 v[82:83], v[82:83], v[14:15] op_sel:[0,1] op_sel_hi:[1,1]
    v_pk_mul_f32 v[76:77], v[76:77], v[14:15] op_sel:[0,0] op_sel_hi:[1,0]
    v_pk_mul_f32 v[78:79], v[78:79], v[14:15] op_sel:[0,0] op_sel_hi:[1,0]
    buffer_load_dwordx4 v[108:111], v3, s[16:19], s40 offen offset:0 sc1
    v_and_b32 v46, 0x80000000, v40
    v_lshrrev_b32 v47, 14, v19
    v_bitop3_b32 v47, v47, v5, v46 bitop3:0xea
    ds_read_b64 v[102:103], v47
    v_and_b32 v99, 0x40000000, v40
    v_lshrrev_b32 v47, 14, v18
    v_bitop3_b32 v47, v47, v5, v99 bitop3:0xea
    ds_read_b64 v[100:101], v47
    s_waitcnt lgkmcnt(2)
    v_cmp_ne_u64 s[50:51], v[72:73], v[68:69]
    v_cmpx_ne_u64 s[54:55], v[74:75], v[70:71]
    s_and_b64 s[82:83], s[54:55], s[80:81]
    s_cbranch_scc1 L2_c31
L2_d31:
    v_mov_b64 v[84:85], v[70:71]
    v_mov_b32 v7, v93
    v_mov_b64 v[86:87], v[74:75]
    s_or_b64 s[80:81], s[80:81], s[54:55]
    s_mov_b64 exec, s[50:51]
    s_and_b64 s[82:83], s[50:51], s[80:81]
    s_cbranch_scc1 L2_c32
L2_d32:
    v_mov_b64 v[84:85], v[68:69]
    v_mov_b32 v7, v92
    v_mov_b64 v[86:87], v[72:73]
    s_mov_b64 exec, -1
    s_or_b64 s[80:81], s[80:81], s[50:51]
    s_and_b64 exec, s[84:85], s[80:81]
    v_mfma_f32_4x4x4_16b_bf16 v[76:79], v[12:13], v[84:85], 0
    v_mov_b32 v94, v7
    s_andn2_b64 s[80:81], s[80:81], s[84:85]
    v_mfma_f32_4x4x4_16b_bf16 v[76:79], v[10:11], v[86:87], v[76:79]
    s_mov_b64 exec, -1
    ds_read_b64 v[70:71], v95 offset:65408
    ds_read_b64 v[68:69], v94 offset:65408
    v_bitop3_b32 v92, v18, v5, v99 bitop3:0xea
    v_bitop3_b32 v93, v19, v5, v46 bitop3:0xea
    v_perm_b32 v15, v19, v20, s47
    v_bitop3_b32 v46, v19, 0.5, -0.5 bitop3:0xa8
    v_perm_b32 v14, v18, v20, s46
    v_bitop3_b32 v47, v18, 0.5, -0.5 bitop3:0xa8
    v_bitop3_b32 v15, v6, v15, v46 bitop3:0xca
    v_bitop3_b32 v14, v6, v14, v47 bitop3:0xca
    s_waitcnt lgkmcnt(1)
    v_mfma_f32_4x4x4_16b_bf16 v[80:83], v[10:11], v[70:71], v[80:83]
    s_waitcnt lgkmcnt(0)
    v_mfma_f32_4x4x4_16b_bf16 v[76:79], v[10:11], v[68:69], v[76:79]
    s_nop 2
    v_cvt_pk_bf16_f32 v80, v80, v81
    v_cvt_pk_bf16_f32 v81, v82, v83
    ds_wrxchg_rtn_b64 v[74:75], v95, v[80:81] offset:65408
    v_cvt_pk_bf16_f32 v76, v76, v77
    v_cvt_pk_bf16_f32 v77, v78, v79
    ds_wrxchg_rtn_b64 v[72:73], v94, v[76:77] offset:65408
    v_and_b32 v88, 0x0fffffff, v21
    buffer_load_dwordx2 v[16:17], v88, s[8:11], 0 offen
    buffer_load_dwordx3 v[18:20], v88, s[8:11], 0 offen offset:8
    s_setprio 2
    v_mfma_f32_4x4x4_16b_bf16 v[80:83], v[8:9], v[102:103], 0
    v_mfma_f32_4x4x4_16b_bf16 v[76:79], v[8:9], v[100:101], 0
    v_cmp_lt_u32 s[48:49], v5, v93
    s_nop 2
    v_pk_mul_f32 v[80:81], v[80:81], v[14:15] op_sel:[0,1] op_sel_hi:[1,1]
    v_pk_mul_f32 v[82:83], v[82:83], v[14:15] op_sel:[0,1] op_sel_hi:[1,1]
    v_pk_mul_f32 v[76:77], v[76:77], v[14:15] op_sel:[0,0] op_sel_hi:[1,0]
    v_pk_mul_f32 v[78:79], v[78:79], v[14:15] op_sel:[0,0] op_sel_hi:[1,0]
    s_waitcnt vmcnt(10)
    v_and_b32 v46, 0x20000000, v41
    v_lshrrev_b32 v47, 14, v23
    v_bitop3_b32 v47, v47, v5, v46 bitop3:0xea
    ds_read_b64 v[106:107], v47
    v_and_b32 v99, 0x10000000, v41
    v_lshrrev_b32 v47, 14, v22
    v_bitop3_b32 v47, v47, v5, v99 bitop3:0xea
    ds_read_b64 v[104:105], v47
    s_waitcnt lgkmcnt(2)
    v_cmp_ne_u64 s[50:51], v[72:73], v[68:69]
    v_cmpx_ne_u64 s[54:55], v[74:75], v[70:71]
    s_and_b64 s[82:83], s[54:55], s[80:81]
    s_cbranch_scc1 L2_c33
L2_d33:
    v_mov_b64 v[84:85], v[70:71]
    v_mov_b32 v7, v95
    v_mov_b64 v[86:87], v[74:75]
    s_or_b64 s[80:81], s[80:81], s[54:55]
    s_mov_b64 exec, s[50:51]
    s_and_b64 s[82:83], s[50:51], s[80:81]
    s_cbranch_scc1 L2_c34
L2_d34:
    v_mov_b64 v[84:85], v[68:69]
    v_mov_b32 v7, v94
    v_mov_b64 v[86:87], v[72:73]
    s_mov_b64 exec, -1
    s_or_b64 s[80:81], s[80:81], s[50:51]
    s_and_b64 exec, s[48:49], s[80:81]
    v_mfma_f32_4x4x4_16b_bf16 v[80:83], v[12:13], v[84:85], 0
    v_mov_b32 v93, v7
    s_andn2_b64 s[80:81], s[80:81], s[48:49]
    v_mfma_f32_4x4x4_16b_bf16 v[80:83], v[10:11], v[86:87], v[80:83]
    s_mov_b64 exec, -1
    ds_read_b64 v[70:71], v93 offset:65408
    ds_read_b64 v[68:69], v92 offset:65408
    v_bitop3_b32 v94, v22, v5, v99 bitop3:0xea
    v_bitop3_b32 v95, v23, v5, v46 bitop3:0xea
    v_perm_b32 v15, v23, v26, s45
    v_bitop3_b32 v46, v23, 0.5, -0.5 bitop3:0xa8
    v_perm_b32 v14, v22, v26, s44
    v_bitop3_b32 v47, v22, 0.5, -0.5 bitop3:0xa8
    v_bitop3_b32 v15, v6, v15, v46 bitop3:0xca
    v_bitop3_b32 v14, v6, v14, v47 bitop3:0xca
    s_waitcnt lgkmcnt(1)
    v_mfma_f32_4x4x4_16b_bf16 v[80:83], v[10:11], v[70:71], v[80:83]
    s_waitcnt lgkmcnt(0)
    v_mfma_f32_4x4x4_16b_bf16 v[76:79], v[10:11], v[68:69], v[76:79]
    s_nop 2
    v_cvt_pk_bf16_f32 v80, v80, v81
    v_cvt_pk_bf16_f32 v81, v82, v83
    ds_wrxchg_rtn_b64 v[74:75], v93, v[80:81] offset:65408
    v_cvt_pk_bf16_f32 v76, v76, v77
    v_cvt_pk_bf16_f32 v77, v78, v79
    ds_wrxchg_rtn_b64 v[72:73], v92, v[76:77] offset:65408
    s_setprio 1
    v_mfma_f32_4x4x4_16b_bf16 v[80:83], v[8:9], v[106:107], 0
    v_mfma_f32_4x4x4_16b_bf16 v[76:79], v[8:9], v[104:105], 0
    s_nop 3
    v_pk_mul_f32 v[80:81], v[80:81], v[14:15] op_sel:[0,1] op_sel_hi:[1,1]
    v_pk_mul_f32 v[82:83], v[82:83], v[14:15] op_sel:[0,1] op_sel_hi:[1,1]
    v_pk_mul_f32 v[76:77], v[76:77], v[14:15] op_sel:[0,0] op_sel_hi:[1,0]
    v_pk_mul_f32 v[78:79], v[78:79], v[14:15] op_sel:[0,0] op_sel_hi:[1,0]
    s_bitcmp1_b32 s43, s42
    s_cbranch_scc1 L2_oa35
L2_ob35:
    buffer_load_dwordx4 v[112:115], v3, s[16:19], s40 offen offset:1024 sc1
    v_sub_u16 v88, v62, v54
    v_and_b32 v89, 3, v54
    v_add3_u32 v99, v88, v89, 3
    v_and_b32 v99, -4, v99
    v_max_u32 v99, 4, v99
    v_and_b32 v97, 0xfffc, v54
    v_bfm_b32 v96, v88, v89
    v_add_u32_dpp v91, v99, v99 row_shr:1 row_mask:0xf bank_mask:0xf bound_ctrl:1
    v_mad_u32_u24 v97, v97, 5, v2
    v_cmp_lt_u32 vcc, 16, v99
    v_add_u32_dpp v91, v91, v91 row_shr:2 row_mask:0xf bank_mask:0xf bound_ctrl:1
    v_sub_u32 v98, s38, v99
    v_lshrrev_b64 v[54:55], 16, v[54:55]
    v_add_u32_dpp v91, v91, v91 row_shr:4 row_mask:0xf bank_mask:0xf bound_ctrl:1
    v_lshrrev_b64 v[62:63], 16, v[62:63]
    s_mov_b32 s101, 0
    v_add_u32_dpp v91, v91, v91 row_shr:8 row_mask:0xf bank_mask:0xf bound_ctrl:1
    s_nop 1
    v_add_u32_dpp v91, v91, v91 row_bcast:15 row_mask:0xa bank_mask:0xf
    s_nop 1
    v_add_u32_dpp v91, v91, v91 row_bcast:31 row_mask:0xc bank_mask:0xf
    v_add_u32 v98, v98, v91
    v_readlane_b32 s37, v91, 63
    s_cbranch_vccnz L2_xo36
L2_xp36:
    v_and_b32 v46, 0x80000000, v41
    v_lshrrev_b32 v47, 14, v25
    v_bitop3_b32 v47, v47, v5, v46 bitop3:0xea
    ds_read_b64 v[102:103], v47
    v_and_b32 v99, 0x40000000, v41
    v_lshrrev_b32 v47, 14, v24
    v_bitop3_b32 v47, v47, v5, v99 bitop3:0xea
    ds_read_b64 v[100:101], v47
    s_waitcnt lgkmcnt(2)
    v_cmp_ne_u64 s[50:51], v[72:73], v[68:69]
    v_cmpx_ne_u64 s[54:55], v[74:75], v[70:71]
    s_and_b64 s[82:83], s[54:55], s[80:81]
    s_cbranch_scc1 L2_c37
L2_d37:
    v_mov_b64 v[84:85], v[70:71]
    v_mov_b32 v7, v93
    v_mov_b64 v[86:87], v[74:75]
    s_or_b64 s[80:81], s[80:81], s[54:55]
    s_mov_b64 exec, s[50:51]
    s_and_b64 s[82:83], s[50:51], s[80:81]
    s_cbranch_scc1 L2_c38
L2_d38:
    v_mov_b64 v[84:85], v[68:69]
    v_mov_b32 v7, v92
    v_mov_b64 v[86:87], v[72:73]
    s_mov_b64 exec, -1
    s_or_b64 s[80:81], s[80:81], s[50:51]
    ds_read_b64 v[70:71], v95 offset:65408
    ds_read_b64 v[68:69], v94 offset:65408
    v_bitop3_b32 v92, v24, v5, v99 bitop3:0xea
    v_bitop3_b32 v93, v25, v5, v46 bitop3:0xea
    v_perm_b32 v15, v25, v26, s47
    v_bitop3_b32 v46, v25, 0.5, -0.5 bitop3:0xa8
    v_perm_b32 v14, v24, v26, s46
    v_bitop3_b32 v47, v24, 0.5, -0.5 bitop3:0xa8
    v_bitop3_b32 v15, v6, v15, v46 bitop3:0xca
    v_bitop3_b32 v14, v6, v14, v47 bitop3:0xca
    s_waitcnt lgkmcnt(1)
    v_mfma_f32_4x4x4_16b_bf16 v[80:83], v[10:11], v[70:71], v[80:83]
    s_waitcnt lgkmcnt(0)
    v_mfma_f32_4x4x4_16b_bf16 v[76:79], v[10:11], v[68:69], v[76:79]
    s_nop 2
    v_cvt_pk_bf16_f32 v80, v80, v81
    v_cvt_pk_bf16_f32 v81, v82, v83
    ds_wrxchg_rtn_b64 v[74:75], v95, v[80:81] offset:65408
    v_cvt_pk_bf16_f32 v76, v76, v77
    v_cvt_pk_bf16_f32 v77, v78, v79
    ds_wrxchg_rtn_b64 v[72:73], v94, v[76:77] offset:65408
    v_and_b32 v88, 0x0fffffff, v27
    buffer_load_dwordx2 v[22:23], v88, s[8:11], 0 offen
    buffer_load_dwordx3 v[24:26], v88, s[8:11], 0 offen offset:8
    v_mfma_f32_4x4x4_16b_bf16 v[80:83], v[8:9], v[102:103], 0
    v_mfma_f32_4x4x4_16b_bf16 v[76:79], v[8:9], v[100:101], 0
    v_cmp_lt_u32 s[84:85], v5, v92
    s_nop 2
    v_pk_mul_f32 v[80:81], v[80:81], v[14:15] op_sel:[0,1] op_sel_hi:[1,1]
    v_pk_mul_f32 v[82:83], v[82:83], v[14:15] op_sel:[0,1] op_sel_hi:[1,1]
    v_pk_mul_f32 v[76:77], v[76:77], v[14:15] op_sel:[0,0] op_sel_hi:[1,0]
    v_pk_mul_f32 v[78:79], v[78:79], v[14:15] op_sel:[0,0] op_sel_hi:[1,0]
    s_waitcnt vmcnt(8)
    s_mov_b64 exec, s[6:7]
    v_lshrrev_b32 v30, 16, v30
    s_mov_b64 exec, -1
    v_and_b32 v46, 0x20000000, v42
    v_lshrrev_b32 v47, 14, v29
    v_bitop3_b32 v47, v47, v5, v46 bitop3:0xea
    ds_read_b64 v[106:107], v47
    v_and_b32 v99, 0x10000000, v42
    v_lshrrev_b32 v47, 14, v28
    v_bitop3_b32 v47, v47, v5, v99 bitop3:0xea
    ds_read_b64 v[104:105], v47
    s_waitcnt lgkmcnt(2)
    v_cmp_ne_u64 s[50:51], v[72:73], v[68:69]
    v_cmpx_ne_u64 s[54:55], v[74:75], v[70:71]
    s_and_b64 s[82:83], s[54:55], s[80:81]
    s_cbranch_scc1 L2_c39
L2_d39:
    v_mov_b64 v[84:85], v[70:71]
    v_mov_b32 v7, v95
    v_mov_b64 v[86:87], v[74:75]
    s_or_b64 s[80:81], s[80:81], s[54:55]
    s_mov_b64 exec, s[50:51]
    s_and_b64 s[82:83], s[50:51], s[80:81]
    s_cbranch_scc1 L2_c40
L2_d40:
    v_mov_b64 v[84:85], v[68:69]
    v_mov_b32 v7, v94
    v_mov_b64 v[86:87], v[72:73]
    s_mov_b64 exec, -1
    s_or_b64 s[80:81], s[80:81], s[50:51]
    s_and_b64 exec, s[84:85], s[80:81]
    v_mfma_f32_4x4x4_16b_bf16 v[76:79], v[12:13], v[84:85], 0
    v_mov_b32 v92, v7
    s_andn2_b64 s[80:81], s[80:81], s[84:85]
    v_mfma_f32_4x4x4_16b_bf16 v[76:79], v[10:11], v[86:87], v[76:79]
    s_mov_b64 exec, -1
    ds_read_b64 v[70:71], v93 offset:65408
    ds_read_b64 v[68:69], v92 offset:65408
    v_bitop3_b32 v94, v28, v5, v99 bitop3:0xea
    v_bitop3_b32 v95, v29, v5, v46 bitop3:0xea
    v_perm_b32 v15, v29, v30, s45
    v_bitop3_b32 v46, v29, 0.5, -0.5 bitop3:0xa8
    v_perm_b32 v14, v28, v30, s44
    v_bitop3_b32 v47, v28, 0.5, -0.5 bitop3:0xa8
    v_bitop3_b32 v15, v6, v15, v46 bitop3:0xca
    v_bitop3_b32 v14, v6, v14, v47 bitop3:0xca
    s_waitcnt lgkmcnt(1)
    v_mfma_f32_4x4x4_16b_bf16 v[80:83], v[10:11], v[70:71], v[80:83]
    s_waitcnt lgkmcnt(0)
    v_mfma_f32_4x4x4_16b_bf16 v[76:79], v[10:11], v[68:69], v[76:79]
    s_nop 2
    v_cvt_pk_bf16_f32 v80, v80, v81
    v_cvt_pk_bf16_f32 v81, v82, v83
    ds_wrxchg_rtn_b64 v[74:75], v93, v[80:81] offset:65408
    v_cvt_pk_bf16_f32 v76, v76, v77
    v_cvt_pk_bf16_f32 v77, v78, v79
    ds_wrxchg_rtn_b64 v[72:73], v92, v[76:77] offset:65408
    s_setprio 0
    v_mfma_f32_4x4x4_16b_bf16 v[80:83], v[8:9], v[106:107], 0
    v_mfma_f32_4x4x4_16b_bf16 v[76:79], v[8:9], v[104:105], 0
    v_cmp_lt_u32 s[48:49], v5, v95
    s_nop 2
    v_pk_mul_f32 v[80:81], v[80:81], v[14:15] op_sel:[0,1] op_sel_hi:[1,1]
    v_pk_mul_f32 v[82:83], v[82:83], v[14:15] op_sel:[0,1] op_sel_hi:[1,1]
    v_pk_mul_f32 v[76:77], v[76:77], v[14:15] op_sel:[0,0] op_sel_hi:[1,0]
    v_pk_mul_f32 v[78:79], v[78:79], v[14:15] op_sel:[0,0] op_sel_hi:[1,0]
    s_add_u32 s40, s40, 0x50000
    v_and_b32 v47, 0x0fffffff, v31
    buffer_load_dword v30, v47, s[8:11], 0 offen offset:16
    s_mov_b64 exec, s[6:7]
    v_add_u32 v47, 8, v47
    v_lshrrev_b32 v31, 2, v31
    s_mov_b64 exec, -1
    buffer_load_dwordx2 v[28:29], v47, s[8:11], 0 offen
    s_waitcnt vmcnt(8)
    v_and_b32 v46, 0x80000000, v43
    v_lshrrev_b32 v47, 14, v37
    v_bitop3_b32 v47, v47, v5, v46 bitop3:0xea
    ds_read_b64 v[106:107], v47
    v_and_b32 v99, 0x40000000, v43
    v_lshrrev_b32 v47, 14, v36
    v_bitop3_b32 v47, v47, v5, v99 bitop3:0xea
    ds_read_b64 v[104:105], v47
    v_and_b32 v46, 0x20000000, v43
    v_lshrrev_b32 v47, 14, v35
    v_bitop3_b32 v47, v47, v5, v46 bitop3:0xea
    ds_read_b64 v[102:103], v47
    v_and_b32 v99, 0x10000000, v43
    v_lshrrev_b32 v47, 14, v34
    v_bitop3_b32 v47, v47, v5, v99 bitop3:0xea
    ds_read_b64 v[100:101], v47
    s_waitcnt lgkmcnt(4)
    v_cmp_ne_u64 s[50:51], v[72:73], v[68:69]
    v_cmpx_ne_u64 s[54:55], v[74:75], v[70:71]
    s_and_b64 s[82:83], s[54:55], s[80:81]
    s_cbranch_scc1 L2_c41
L2_d41:
    v_mov_b64 v[84:85], v[70:71]
    v_mov_b32 v7, v93
    v_mov_b64 v[86:87], v[74:75]
    s_or_b64 s[80:81], s[80:81], s[54:55]
    s_mov_b64 exec, s[50:51]
    s_and_b64 s[82:83], s[50:51], s[80:81]
    s_cbranch_scc1 L2_c42
L2_d42:
    v_mov_b64 v[84:85], v[68:69]
    v_mov_b32 v7, v92
    v_mov_b64 v[86:87], v[72:73]
    s_mov_b64 exec, -1
    s_or_b64 s[80:81], s[80:81], s[50:51]
    s_and_b64 exec, s[48:49], s[80:81]
    v_mfma_f32_4x4x4_16b_bf16 v[80:83], v[12:13], v[84:85], 0
    v_mov_b32 v95, v7
    s_andn2_b64 s[80:81], s[80:81], s[48:49]
    v_mfma_f32_4x4x4_16b_bf16 v[80:83], v[10:11], v[86:87], v[80:83]
    s_mov_b64 exec, -1
    ds_read_b64 v[70:71], v95 offset:65408
    ds_read_b64 v[68:69], v94 offset:65408
    v_bitop3_b32 v92, v34, v5, v99 bitop3:0xea
    v_bitop3_b32 v93, v35, v5, v46 bitop3:0xea
    v_perm_b32 v15, v35, v38, s45
    v_bitop3_b32 v46, v35, 0.5, -0.5 bitop3:0xa8
    v_perm_b32 v14, v34, v38, s44
    v_bitop3_b32 v47, v34, 0.5, -0.5 bitop3:0xa8
    v_bitop3_b32 v15, v6, v15, v46 bitop3:0xca
    v_bitop3_b32 v14, v6, v14, v47 bitop3:0xca
    s_waitcnt lgkmcnt(1)
    v_mfma_f32_4x4x4_16b_bf16 v[80:83], v[10:11], v[70:71], v[80:83]
    s_waitcnt lgkmcnt(0)
    v_mfma_f32_4x4x4_16b_bf16 v[76:79], v[10:11], v[68:69], v[76:79]
    s_nop 2
    v_cvt_pk_bf16_f32 v80, v80, v81
    v_cvt_pk_bf16_f32 v81, v82, v83
    ds_wrxchg_rtn_b64 v[74:75], v95, v[80:81] offset:65408
    v_cvt_pk_bf16_f32 v76, v76, v77
    v_cvt_pk_bf16_f32 v77, v78, v79
    ds_wrxchg_rtn_b64 v[72:73], v94, v[76:77] offset:65408
    s_barrier
    s_setprio 3
    s_mov_b32 m0, s100
    s_nop 0
    ds_write_addtid_b32 v124 offset:34816
    ds_write_addtid_b32 v125 offset:35072
    ds_write_addtid_b32 v126 offset:35328
    ds_write_addtid_b32 v127 offset:35584
    s_add_u32 s3, s40, 4096
    buffer_load_dwordx4 v[124:127], v3, s[16:19], s3 offen sc1
    ds_write_addtid_b32 v116 offset:32768
    ds_write_addtid_b32 v117 offset:33024
    ds_write_addtid_b32 v118 offset:33280
    ds_write_addtid_b32 v119 offset:33536
    buffer_load_dwordx4 v[116:119], v3, s[16:19], s40 offen offset:2048 sc1
    ds_write_addtid_b32 v120 offset:33792
    ds_write_addtid_b32 v121 offset:34048
    ds_write_addtid_b32 v122 offset:34304
    ds_write_addtid_b32 v123 offset:34560
    buffer_load_dwordx4 v[120:123], v3, s[16:19], s40 offen offset:3072 sc1
    v_mfma_f32_4x4x4_16b_bf16 v[80:83], v[8:9], v[102:103], 0
    v_mfma_f32_4x4x4_16b_bf16 v[76:79], v[8:9], v[100:101], 0
    s_nop 3
    v_pk_mul_f32 v[80:81], v[80:81], v[14:15] op_sel:[0,1] op_sel_hi:[1,1]
    v_pk_mul_f32 v[82:83], v[82:83], v[14:15] op_sel:[0,1] op_sel_hi:[1,1]
    v_pk_mul_f32 v[76:77], v[76:77], v[14:15] op_sel:[0,0] op_sel_hi:[1,0]
    v_pk_mul_f32 v[78:79], v[78:79], v[14:15] op_sel:[0,0] op_sel_hi:[1,0]
    s_cmp_gt_u32 s37, 1024
    s_cbranch_scc1 L2_xs43
    s_cmp_lg_u32 s101, 0
    s_cbranch_scc1 L2_xa43
L2_xb43:
    v_lshlrev_b32 v89, 16, v96
    v_add_u32 v90, 60, v97
    v_bitop3_b32 v90, v89, v45, v90 bitop3:0x6a
    ds_write_b32 v98, v90 offset:12
    v_lshlrev_b32 v89, 20, v96
    v_add_u32 v90, 40, v97
    v_bitop3_b32 v90, v89, v45, v90 bitop3:0x6a
    ds_write_b32 v98, v90 offset:8
    v_lshlrev_b32 v89, 24, v96
    v_add_u32 v90, 20, v97
    v_bitop3_b32 v90, v89, v45, v90 bitop3:0x6a
    ds_write_b32 v98, v90 offset:4
    v_lshlrev_b32 v89, 28, v96
    v_bitop3_b32 v90, v89, v45, v97 bitop3:0x6a
    ds_write_b32 v98, v90 offset:0
    v_mov_b32_dpp v91, v66 quad_perm:[1,1,1,1] row_mask:0xf bank_mask:0xf
    v_and_b32 v89, 3, v91
    v_and_b32 v97, 0xfffc, v91
    v_sub_u16_dpp v88, v66, v91 quad_perm:[3,3,3,3] row_mask:0xf bank_mask:0xf
    v_mad_u32_u24 v97, v97, 5, v4
    v_add_u32 v99, v88, v89
    v_bfm_b32 v96, v88, v89
    v_cmp_lt_u32 s[58:59], 16, v99
    v_lshlrev_b32 v89, v1, v96
    v_and_b32 v89, v45, v89
    v_cmp_ne_u32 vcc, 0, v89
    v_xor_b32 v90, v97, v89
    s_add_u32 s3, s37, s38
    v_mbcnt_lo_u32_b32 v98, vcc_lo, 0
    v_mbcnt_hi_u32_b32 v98, vcc_hi, v98
    s_bcnt1_i32_b64 s41, vcc
    v_lshl_add_u32 v98, v98, 2, s3
    s_lshl2_add_u32 s37, s41, s37
    s_mov_b64 exec, vcc
    ds_write_b32 v98, v90
    s_mov_b64 exec, -1
    s_cmp_lg_u64 s[58:59], 0
    s_cbranch_scc1 L2_xe43
L2_xr43:
    v_add_u32 v98, s37, v0
    v_mov_b32 v90, -1
    ds_write_b32 v98, v90
L2_xw43:
    s_setprio 2
    s_waitcnt lgkmcnt(14)
    v_cmp_ne_u64 s[50:51], v[72:73], v[68:69]
    v_cmpx_ne_u64 s[54:55], v[74:75], v[70:71]
    s_and_b64 s[82:83], s[54:55], s[80:81]
    s_cbranch_scc1 L2_c44
L2_d44:
    v_mov_b64 v[84:85], v[70:71]
    v_mov_b32 v7, v95
    v_mov_b64 v[86:87], v[74:75]
    s_or_b64 s[80:81], s[80:81], s[54:55]
    s_mov_b64 exec, s[50:51]
    s_and_b64 s[82:83], s[50:51], s[80:81]
    s_cbranch_scc1 L2_c45
L2_d45:
    v_mov_b64 v[84:85], v[68:69]
    v_mov_b32 v7, v94
    v_mov_b64 v[86:87], v[72:73]
    s_mov_b64 exec, -1
    s_or_b64 s[80:81], s[80:81], s[50:51]
    ds_read_b64 v[70:71], v93 offset:65408
    ds_read_b64 v[68:69], v92 offset:65408
    v_and_b32 v46, 0x40000000, v43
    v_bitop3_b32 v94, v36, v5, v46 bitop3:0xea
    v_and_b32 v46, 0x80000000, v43
    v_bitop3_b32 v95, v37, v5, v46 bitop3:0xea
    v_perm_b32 v15, v37, v38, s47
    v_bitop3_b32 v46, v37, 0.5, -0.5 bitop3:0xa8
    v_perm_b32 v14, v36, v38, s46
    v_bitop3_b32 v47, v36, 0.5, -0.5 bitop3:0xa8
    v_bitop3_b32 v15, v6, v15, v46 bitop3:0xca
    v_bitop3_b32 v14, v6, v14, v47 bitop3:0xca
    s_setprio 1
    s_waitcnt lgkmcnt(1)
    v_mfma_f32_4x4x4_16b_bf16 v[80:83], v[10:11], v[70:71], v[80:83]
    s_waitcnt lgkmcnt(0)
    v_mfma_f32_4x4x4_16b_bf16 v[76:79], v[10:11], v[68:69], v[76:79]
    s_nop 2
    v_cvt_pk_bf16_f32 v80, v80, v81
    v_cvt_pk_bf16_f32 v81, v82, v83
    ds_wrxchg_rtn_b64 v[74:75], v93, v[80:81] offset:65408
    v_cvt_pk_bf16_f32 v76, v76, v77
    v_cvt_pk_bf16_f32 v77, v78, v79
    ds_wrxchg_rtn_b64 v[72:73], v92, v[76:77] offset:65408
    ds_read_b32 v40, v0 offset:0
    ds_read_b32 v41, v0 offset:256
    ds_read_b32 v42, v44 offset:768
    ds_read_b32 v43, v0 offset:512
    s_sub_u32 s3, s37, 768
    s_cmp_gt_u32 s3, 128
    s_cbranch_scc1 L2_xf43
L2_xg43:
    v_lshrrev_b64 v[64:65], 16, v[64:65]
    v_lshrrev_b64 v[66:67], 16, v[66:67]
    v_and_b32 v88, 0x0fffffff, v39
    buffer_load_dwordx2 v[34:35], v88, s[8:11], 0 offen
    buffer_load_dwordx3 v[36:38], v88, s[8:11], 0 offen offset:8
    s_setprio 0
    s_waitcnt vmcnt(12)
    s_mov_b32 m0, s38
    s_nop 0
    ds_write_addtid_b32 v108 offset:0
    ds_write_addtid_b32 v109 offset:256
    ds_write_addtid_b32 v110 offset:512
    ds_write_addtid_b32 v111 offset:768
    s_waitcnt vmcnt(9)
    ds_write_addtid_b32 v112 offset:1024
    ds_write_addtid_b32 v113 offset:1280
    ds_write_addtid_b32 v114 offset:1536
    ds_write_addtid_b32 v115 offset:1792
    v_mfma_f32_4x4x4_16b_bf16 v[80:83], v[8:9], v[106:107], 0
    v_mfma_f32_4x4x4_16b_bf16 v[76:79], v[8:9], v[104:105], 0
    v_cmp_lt_u32 s[84:85], v5, v94
    s_nop 2
    v_pk_mul_f32 v[80:81], v[80:81], v[14:15] op_sel:[0,1] op_sel_hi:[1,1]
    v_pk_mul_f32 v[82:83], v[82:83], v[14:15] op_sel:[0,1] op_sel_hi:[1,1]
    v_pk_mul_f32 v[76:77], v[76:77], v[14:15] op_sel:[0,0] op_sel_hi:[1,0]
    v_pk_mul_f32 v[78:79], v[78:79], v[14:15] op_sel:[0,0] op_sel_hi:[1,0]
    s_add_u32 s42, s42, 1
    s_waitcnt lgkmcnt(0)
L2_loop:
    s_barrier
    s_bitcmp1_b32 s36, s42
    s_cbranch_scc1 L2_slow
L2_ret2:
    s_setprio 3
    s_bitcmp1_b32 s43, s42
    s_cbranch_scc1 L2_oa46
L2_ob46:
    v_and_b32 v46, 0x20000000, v21
    v_lshrrev_b32 v47, 14, v17
    v_bitop3_b32 v47, v47, v5, v46 bitop3:0xea
    ds_read_b64 v[102:103], v47
    v_and_b32 v99, 0x10000000, v21
    v_lshrrev_b32 v47, 14, v16
    v_bitop3_b32 v47, v47, v5, v99 bitop3:0xea
    ds_read_b64 v[100:101], v47
    v_cmp_ne_u64 s[50:51], v[72:73], v[68:69]
    v_cmpx_ne_u64 s[54:55], v[74:75], v[70:71]
    s_and_b64 s[82:83], s[54:55], s[80:81]
    s_cbranch_scc1 L2_c47
L2_d47:
    v_mov_b64 v[84:85], v[70:71]
    v_mov_b32 v7, v93
    v_mov_b64 v[86:87], v[74:75]
    s_or_b64 s[80:81], s[80:81], s[54:55]
    s_mov_b64 exec, s[50:51]
    s_and_b64 s[82:83], s[50:51], s[80:81]
    s_cbranch_scc1 L2_c48
L2_d48:
    v_mov_b64 v[84:85], v[68:69]
    v_mov_b32 v7, v92
    v_mov_b64 v[86:87], v[72:73]
    s_mov_b64 exec, -1
    s_or_b64 s[80:81], s[80:81], s[50:51]
    s_and_b64 exec, s[84:85], s[80:81]
    v_mfma_f32_4x4x4_16b_bf16 v[76:79], v[12:13], v[84:85], 0
    v_mov_b32 v94, v7
    s_andn2_b64 s[80:81], s[80:81], s[84:85]
    v_mfma_f32_4x4x4_16b_bf16 v[76:79], v[10:11], v[86:87], v[76:79]
    s_mov_b64 exec, -1
    ds_read_b64 v[70:71], v95 offset:65408
    ds_read_b64 v[68:69], v94 offset:65408
    v_bitop3_b32 v92, v16, v5, v99 bitop3:0xea
    v_bitop3_b32 v93, v17, v5, v46 bitop3:0xea
    v_perm_b32 v15, v17, v20, s45
    v_bitop3_b32 v46, v17, 0.5, -0.5 bitop3:0xa8
    v_perm_b32 v14, v16, v20, s44
    v_bitop3_b32 v47, v16, 0.5, -0.5 bitop3:0xa8
    v_bitop3_b32 v15, v6, v15, v46 bitop3:0xca
    v_bitop3_b32 v14, v6, v14, v47 bitop3:0xca
    s_waitcnt lgkmcnt(1)
    v_mfma_f32_4x4x4_16b_bf16 v[80:83], v[10:11], v[70:71], v[80:83]
    s_waitcnt lgkmcnt(0)
    v_mfma_f32_4x4x4_16b_bf16 v[76:79], v[10:11], v[68:69], v[76:79]
    s_nop 2
    v_cvt_pk_bf16_f32 v80, v80, v81
    v_cvt_pk_bf16_f32 v81, v82, v83
    ds_wrxchg_rtn_b64 v[74:75], v95, v[80:81] offset:65408
    v_cvt_pk_bf16_f32 v76, v76, v77
    v_cvt_pk_bf16_f32 v77, v78, v79
    ds_wrxchg_rtn_b64 v[72:73], v94, v[76:77] offset:65408
    v_mfma_f32_4x4x4_16b_bf16 v[80:83], v[8:9], v[102:103], 0
    v_mfma_f32_4x4x4_16b_bf16 v[76:79], v[8:9], v[100:101], 0
    v_cmp_lt_u32 s[84:85], v5, v92
    s_nop 2
    v_pk_mul_f32 v[80:81], v[80:81], v[14:15] op_sel:[0,1] op_sel_hi:[1,1]
    v_pk_mul_f32 v[82:83], v[82:83], v[14:15] op_sel:[0,1] op_sel_hi:[1,1]
    v_pk_mul_f32 v[76:77], v[76:77], v[14:15] op_sel:[0,0] op_sel_hi:[1,0]
    v_pk_mul_f32 v[78:79], v[78:79], v[14:15] op_sel:[0,0] op_sel_hi:[1,0]
    buffer_load_dwordx4 v[108:111], v3, s[16:19], s40 offen offset:0 sc1
    v_and_b32 v46, 0x80000000, v21
    v_lshrrev_b32 v47, 14, v19
    v_bitop3_b32 v47, v47, v5, v46 bitop3:0xea
    ds_read_b64 v[106:107], v47
    v_and_b32 v99, 0x40000000, v21
    v_lshrrev_b32 v47, 14, v18
    v_bitop3_b32 v47, v47, v5, v99 bitop3:0xea
    ds_read_b64 v[104:105], v47
    s_waitcnt lgkmcnt(2)
    v_cmp_ne_u64 s[50:51], v[72:73], v[68:69]
    v_cmpx_ne_u64 s[54:55], v[74:75], v[70:71]
    s_and_b64 s[82:83], s[54:55], s[80:81]
    s_cbranch_scc1 L2_c49
L2_d49:
    v_mov_b64 v[84:85], v[70:71]
    v_mov_b32 v7, v95
    v_mov_b64 v[86:87], v[74:75]
    s_or_b64 s[80:81], s[80:81], s[54:55]
    s_mov_b64 exec, s[50:51]
    s_and_b64 s[82:83], s[50:51], s[80:81]
    s_cbranch_scc1 L2_c50
L2_d50:
    v_mov_b64 v[84:85], v[68:69]
    v_mov_b32 v7, v94
    v_mov_b64 v[86:87], v[72:73]
    s_mov_b64 exec, -1
    s_or_b64 s[80:81], s[80:81], s[50:51]
    s_and_b64 exec, s[84:85], s[80:81]
    v_mfma_f32_4x4x4_16b_bf16 v[76:79], v[12:13], v[84:85], 0
    v_mov_b32 v92, v7
    s_andn2_b64 s[80:81], s[80:81], s[84:85]
    v_mfma_f32_4x4x4_16b_bf16 v[76:79], v[10:11], v[86:87], v[76:79]
    s_mov_b64 exec, -1
    ds_read_b64 v[70:71], v93 offset:65408
    ds_read_b64 v[68:69], v92 offset:65408
    v_bitop3_b32 v94, v18, v5, v99 bitop3:0xea
    v_bitop3_b32 v95, v19, v5, v46 bitop3:0xea
    v_perm_b32 v15, v19, v20, s47
    v_bitop3_b32 v46, v19, 0.5, -0.5 bitop3:0xa8
    v_perm_b32 v14, v18, v20, s46
    v_bitop3_b32 v47, v18, 0.5, -0.5 bitop3:0xa8
    v_bitop3_b32 v15, v6, v15, v46 bitop3:0xca
    v_bitop3_b32 v14, v6, v14, v47 bitop3:0xca
    s_waitcnt lgkmcnt(1)
    v_mfma_f32_4x4x4_16b_bf16 v[80:83], v[10:11], v[70:71], v[80:83]
    s_waitcnt lgkmcnt(0)
    v_mfma_f32_4x4x4_16b_bf16 v[76:79], v[10:11], v[68:69], v[76:79]
    s_nop 2
    v_cvt_pk_bf16_f32 v80, v80, v81
    v_cvt_pk_bf16_f32 v81, v82, v83
    ds_wrxchg_rtn_b64 v[74:75], v93, v[80:81] offset:65408
    v_cvt_pk_bf16_f32 v76, v76, v77
    v_cvt_pk_bf16_f32 v77, v78, v79
    ds_wrxchg_rtn_b64 v[72:73], v92, v[76:77] offset:65408
    v_and_b32 v88, 0x0fffffff, v40
    buffer_load_dwordx2 v[16:17], v88, s[8:11], 0 offen
    buffer_load_dwordx3 v[18:20], v88, s[8:11], 0 offen offset:8
    s_setprio 2
    v_mfma_f32_4x4x4_16b_bf16 v[80:83], v[8:9], v[106:107], 0
    v_mfma_f32_4x4x4_16b_bf16 v[76:79], v[8:9], v[104:105], 0
    v_cmp_lt_u32 s[48:49], v5, v95
    s_nop 2
    v_pk_mul_f32 v[80:81], v[80:81], v[14:15] op_sel:[0,1] op_sel_hi:[1,1]
    v_pk_mul_f32 v[82:83], v[82:83], v[14:15] op_sel:[0,1] op_sel_hi:[1,1]
    v_pk_mul_f32 v[76:77], v[76:77], v[14:15] op_sel:[0,0] op_sel_hi:[1,0]
    v_pk_mul_f32 v[78:79], v[78:79], v[14:15] op_sel:[0,0] op_sel_hi:[1,0]
    s_waitcnt vmcnt(10)
    v_and_b32 v46, 0x20000000, v27
    v_lshrrev_b32 v47, 14, v23
    v_bitop3_b32 v47, v47, v5, v46 bitop3:0xea
    ds_read_b64 v[102:103], v47
    v_and_b32 v99, 0x10000000, v27
    v_lshrrev_b32 v47, 14, v22
    v_bitop3_b32 v47, v47, v5, v99 bitop3:0xea
    ds_read_b64 v[100:101], v47
    s_waitcnt lgkmcnt(2)
    v_cmp_ne_u64 s[50:51], v[72:73], v[68:69]
    v_cmpx_ne_u64 s[54:55], v[74:75], v[70:71]
    s_and_b64 s[82:83], s[54:55], s[80:81]
    s_cbranch_scc1 L2_c51
L2_d51:
    v_mov_b64 v[84:85], v[70:71]
    v_mov_b32 v7, v93
    v_mov_b64 v[86:87], v[74:75]
    s_or_b64 s[80:81], s[80:81], s[54:55]
    s_mov_b64 exec, s[50:51]
    s_and_b64 s[82:83], s[50:51], s[80:81]
    s_cbranch_scc1 L2_c52
L2_d52:
    v_mov_b64 v[84:85], v[68:69]
    v_mov_b32 v7, v92
    v_mov_b64 v[86:87], v[72:73]
    s_mov_b64 exec, -1
    s_or_b64 s[80:81], s[80:81], s[50:51]
    s_and_b64 exec, s[48:49], s[80:81]
    v_mfma_f32_4x4x4_16b_bf16 v[80:83], v[12:13], v[84:85], 0
    v_mov_b32 v95, v7
    s_andn2_b64 s[80:81], s[80:81], s[48:49]
    v_mfma_f32_4x4x4_16b_bf16 v[80:83], v[10:11], v[86:87], v[80:83]
    s_mov_b64 exec, -1
    ds_read_b64 v[70:71], v95 offset:65408
    ds_read_b64 v[68:69], v94 offset:65408
    v_bitop3_b32 v92, v22, v5, v99 bitop3:0xea
    v_bitop3_b32 v93, v23, v5, v46 bitop3:0xea
    v_perm_b32 v15, v23, v26, s45
    v_bitop3_b32 v46, v23, 0.5, -0.5 bitop3:0xa8
    v_perm_b32 v14, v22, v26, s44
    v_bitop3_b32 v47, v22, 0.5, -0.5 bitop3:0xa8
    v_bitop3_b32 v15, v6, v15, v46 bitop3:0xca
    v_bitop3_b32 v14, v6, v14, v47 bitop3:0xca
    s_waitcnt lgkmcnt(1)
    v_mfma_f32_4x4x4_16b_bf16 v[80:83], v[10:11], v[70:71], v[80:83]
    s_waitcnt lgkmcnt(0)
    v_mfma_f32_4x4x4_16b_bf16 v[76:79], v[10:11], v[68:69], v[76:79]
    s_nop 2
    v_cvt_pk_bf16_f32 v80, v80, v81
    v_cvt_pk_bf16_f32 v81, v82, v83
    ds_wrxchg_rtn_b64 v[74:75], v95, v[80:81] offset:65408
    v_cvt_pk_bf16_f32 v76, v76, v77
    v_cvt_pk_bf16_f32 v77, v78, v79
    ds_wrxchg_rtn_b64 v[72:73], v94, v[76:77] offset:65408
    s_setprio 1
    v_mfma_f32_4x4x4_16b_bf16 v[80:83], v[8:9], v[102:103], 0
    v_mfma_f32_4x4x4_16b_bf16 v[76:79], v[8:9], v[100:101], 0
    s_nop 3
    v_pk_mul_f32 v[80:81], v[80:81], v[14:15] op_sel:[0,1] op_sel_hi:[1,1]
    v_pk_mul_f32 v[82:83], v[82:83], v[14:15] op_sel:[0,1] op_sel_hi:[1,1]
    v_pk_mul_f32 v[76:77], v[76:77], v[14:15] op_sel:[0,0] op_sel_hi:[1,0]
    v_pk_mul_f32 v[78:79], v[78:79], v[14:15] op_sel:[0,0] op_sel_hi:[1,0]
    s_bitcmp1_b32 s43, s42
    s_cbranch_scc1 L2_oa53
L2_ob53:
    buffer_load_dwordx4 v[112:115], v3, s[16:19], s40 offen offset:1024 sc1
    v_sub_u16 v88, v56, v48
    v_and_b32 v89, 3, v48
    v_add3_u32 v99, v88, v89, 3
    v_and_b32 v99, -4, v99
    v_max_u32 v99, 4, v99
    v_and_b32 v97, 0xfffc, v48
    v_bfm_b32 v96, v88, v89
    v_add_u32_dpp v91, v99, v99 row_shr:1 row_mask:0xf bank_mask:0xf bound_ctrl:1
    v_mad_u32_u24 v97, v97, 5, v2
    v_cmp_lt_u32 vcc, 16, v99
    v_add_u32_dpp v91, v91, v91 row_shr:2 row_mask:0xf bank_mask:0xf bound_ctrl:1
    v_sub_u32 v98, s38, v99
    v_lshrrev_b64 v[48:49], 16, v[48:49]
    v_add_u32_dpp v91, v91, v91 row_shr:4 row_mask:0xf bank_mask:0xf bound_ctrl:1
    v_lshrrev_b64 v[56:57], 16, v[56:57]
    s_mov_b32 s101, 0
    v_add_u32_dpp v91, v91, v91 row_shr:8 row_mask:0xf bank_mask:0xf bound_ctrl:1
    s_nop 1
    v_add_u32_dpp v91, v91, v91 row_bcast:15 row_mask:0xa bank_mask:0xf
    s_nop 1
    v_add_u32_dpp v91, v91, v91 row_bcast:31 row_mask:0xc bank_mask:0xf
    v_add_u32 v98, v98, v91
    v_readlane_b32 s37, v91, 63
    s_cbranch_vccnz L2_xo54
L2_xp54:
    v_and_b32 v46, 0x80000000, v27
    v_lshrrev_b32 v47, 14, v25
    v_bitop3_b32 v47, v47, v5, v46 bitop3:0xea
    ds_read_b64 v[106:107], v47
    v_and_b32 v99, 0x40000000, v27
    v_lshrrev_b32 v47, 14, v24
    v_bitop3_b32 v47, v47, v5, v99 bitop3:0xea
    ds_read_b64 v[104:105], v47
    s_waitcnt lgkmcnt(2)
    v_cmp_ne_u64 s[50:51], v[72:73], v[68:69]
    v_cmpx_ne_u64 s[54:55], v[74:75], v[70:71]
    s_and_b64 s[82:83], s[54:55], s[80:81]
    s_cbranch_scc1 L2_c55
L2_d55:
    v_mov_b64 v[84:85], v[70:71]
    v_mov_b32 v7, v95
    v_mov_b64 v[86:87], v[74:75]
    s_or_b64 s[80:81], s[80:81], s[54:55]
    s_mov_b64 exec, s[50:51]
    s_and_b64 s[82:83], s[50:51], s[80:81]
    s_cbranch_scc1 L2_c56
L2_d56:
    v_mov_b64 v[84:85], v[68:69]
    v_mov_b32 v7, v94
    v_mov_b64 v[86:87], v[72:73]
    s_mov_b64 exec, -1
    s_or_b64 s[80:81], s[80:81], s[50:51]
    ds_read_b64 v[70:71], v93 offset:65408
    ds_read_b64 v[68:69], v92 offset:65408
    v_bitop3_b32 v94, v24, v5, v99 bitop3:0xea
    v_bitop3_b32 v95, v25, v5, v46 bitop3:0xea
    v_perm_b32 v15, v25, v26, s47
    v_bitop3_b32 v46, v25, 0.5, -0.5 bitop3:0xa8
    v_perm_b32 v14, v24, v26, s46
    v_bitop3_b32 v47, v24, 0.5, -0.5 bitop3:0xa8
    v_bitop3_b32 v15, v6, v15, v46 bitop3:0xca
    v_bitop3_b32 v14, v6, v14, v47 bitop3:0xca
    s_waitcnt lgkmcnt(1)
    v_mfma_f32_4x4x4_16b_bf16 v[80:83], v[10:11], v[70:71], v[80:83]
    s_waitcnt lgkmcnt(0)
    v_mfma_f32_4x4x4_16b_bf16 v[76:79], v[10:11], v[68:69], v[76:79]
    s_nop 2
    v_cvt_pk_bf16_f32 v80, v80, v81
    v_cvt_pk_bf16_f32 v81, v82, v83
    ds_wrxchg_rtn_b64 v[74:75], v93, v[80:81] offset:65408
    v_cvt_pk_bf16_f32 v76, v76, v77
    v_cvt_pk_bf16_f32 v77, v78, v79
    ds_wrxchg_rtn_b64 v[72:73], v92, v[76:77] offset:65408
    v_and_b32 v88, 0x0fffffff, v41
    buffer_load_dwordx2 v[22:23], v88, s[8:11], 0 offen
    buffer_load_dwordx3 v[24:26], v88, s[8:11], 0 offen offset:8
    v_mfma_f32_4x4x4_16b_bf16 v[80:83], v[8:9], v[106:107], 0
    v_mfma_f32_4x4x4_16b_bf16 v[76:79], v[8:9], v[104:105], 0
    v_cmp_lt_u32 s[84:85], v5, v94
    s_nop 2
    v_pk_mul_f32 v[80:81], v[80:81], v[14:15] op_sel:[0,1] op_sel_hi:[1,1]
    v_pk_mul_f32 v[82:83], v[82:83], v[14:15] op_sel:[0,1] op_sel_hi:[1,1]
    v_pk_mul_f32 v[76:77], v[76:77], v[14:15] op_sel:[0,0] op_sel_hi:[1,0]
    v_pk_mul_f32 v[78:79], v[78:79], v[14:15] op_sel:[0,0] op_sel_hi:[1,0]
    s_waitcnt vmcnt(11)
    s_mov_b64 exec, s[6:7]
    v_lshrrev_b32 v30, 16, v30
    s_mov_b64 exec, -1
    v_and_b32 v46, 0x20000000, v31
    v_lshrrev_b32 v47, 14, v29
    v_bitop3_b32 v47, v47, v5, v46 bitop3:0xea
    ds_read_b64 v[102:103], v47
    v_and_b32 v99, 0x10000000, v31
    v_lshrrev_b32 v47, 14, v28
    v_bitop3_b32 v47, v47, v5, v99 bitop3:0xea
    ds_read_b64 v[100:101], v47
    s_waitcnt lgkmcnt(2)
    v_cmp_ne_u64 s[50:51], v[72:73], v[68:69]
    v_cmpx_ne_u64 s[54:55], v[74:75], v[70:71]
    s_and_b64 s[82:83], s[54:55], s[80:81]
    s_cbranch_scc1 L2_c57
L2_d57:
    v_mov_b64 v[84:85], v[70:71]
    v_mov_b32 v7, v93
    v_mov_b64 v[86:87], v[74:75]
    s_or_b64 s[80:81], s[80:81], s[54:55]
    s_mov_b64 exec, s[50:51]
    s_and_b64 s[82:83], s[50:51], s[80:81]
    s_cbranch_scc1 L2_c58
L2_d58:
    v_mov_b64 v[84:85], v[68:69]
    v_mov_b32 v7, v92
    v_mov_b64 v[86:87], v[72:73]
    s_mov_b64 exec, -1
    s_or_b64 s[80:81], s[80:81], s[50:51]
    s_and_b64 exec, s[84:85], s[80:81]
    v_mfma_f32_4x4x4_16b_bf16 v[76:79], v[12:13], v[84:85], 0
    v_mov_b32 v94, v7
    s_andn2_b64 s[80:81], s[80:81], s[84:85]
    v_mfma_f32_4x4x4_16b_bf16 v[76:79], v[10:11], v[86:87], v[76:79]
    s_mov_b64 exec, -1
    ds_read_b64 v[70:71], v95 offset:65408
    ds_read_b64 v[68:69], v94 offset:65408
    v_bitop3_b32 v92, v28, v5, v99 bitop3:0xea
    v_bitop3_b32 v93, v29, v5, v46 bitop3:0xea
    v_perm_b32 v15, v29, v30, s45
    v_bitop3_b32 v46, v29, 0.5, -0.5 bitop3:0xa8
    v_perm_b32 v14, v28, v30, s44
    v_bitop3_b32 v47, v28, 0.5, -0.5 bitop3:0xa8
    v_bitop3_b32 v15, v6, v15, v46 bitop3:0xca
    v_bitop3_b32 v14, v6, v14, v47 bitop3:0xca
    s_waitcnt lgkmcnt(1)
    v_mfma_f32_4x4x4_16b_bf16 v[80:83], v[10:11], v[70:71], v[80:83]
    s_waitcnt lgkmcnt(0)
    v_mfma_f32_4x4x4_16b_bf16 v[76:79], v[10:11], v[68:69], v[76:79]
    s_nop 2
    v_cvt_pk_bf16_f32 v80, v80, v81
    v_cvt_pk_bf16_f32 v81, v82, v83
    ds_wrxchg_rtn_b64 v[74:75], v95, v[80:81] offset:65408
    v_cvt_pk_bf16_f32 v76, v76, v77
    v_cvt_pk_bf16_f32 v77, v78, v79
    ds_wrxchg_rtn_b64 v[72:73], v94, v[76:77] offset:65408
    s_setprio 0
    v_mfma_f32_4x4x4_16b_bf16 v[80:83], v[8:9], v[102:103], 0
    v_mfma_f32_4x4x4_16b_bf16 v[76:79], v[8:9], v[100:101], 0
    v_cmp_lt_u32 s[48:49], v5, v93
    s_nop 2
    v_pk_mul_f32 v[80:81], v[80:81], v[14:15] op_sel:[0,1] op_sel_hi:[1,1]
    v_pk_mul_f32 v[82:83], v[82:83], v[14:15] op_sel:[0,1] op_sel_hi:[1,1]
    v_pk_mul_f32 v[76:77], v[76:77], v[14:15] op_sel:[0,0] op_sel_hi:[1,0]
    v_pk_mul_f32 v[78:79], v[78:79], v[14:15] op_sel:[0,0] op_sel_hi:[1,0]
    s_add_u32 s40, s40, 0xfff24000
    v_and_b32 v47, 0x0fffffff, v42
    buffer_load_dword v30, v47, s[8:11], 0 offen offset:16
    s_mov_b64 exec, s[6:7]
    v_add_u32 v47, 8, v47
    v_lshrrev_b32 v42, 2, v42
    s_mov_b64 exec, -1
    buffer_load_dwordx2 v[28:29], v47, s[8:11], 0 offen
    s_waitcnt vmcnt(8)
    v_and_b32 v46, 0x80000000, v39
    v_lshrrev_b32 v47, 14, v37
    v_bitop3_b32 v47, v47, v5, v46 bitop3:0xea
    ds_read_b64 v[102:103], v47
    v_and_b32 v99, 0x40000000, v39
    v_lshrrev_b32 v47, 14, v36
    v_bitop3_b32 v47, v47, v5, v99 bitop3:0xea
    ds_read_b64 v[100:101], v47
    v_and_b32 v46, 0x20000000, v39
    v_lshrrev_b32 v47, 14, v35
    v_bitop3_b32 v47, v47, v5, v46 bitop3:0xea
    ds_read_b64 v[106:107], v47
    v_and_b32 v99, 0x10000000, v39
    v_lshrrev_b32 v47, 14, v34
    v_bitop3_b32 v47, v47, v5, v99 bitop3:0xea
    ds_read_b64 v[104:105], v47
    s_waitcnt lgkmcnt(4)
    v_cmp_ne_u64 s[50:51], v[72:73], v[68:69]
    v_cmpx_ne_u64 s[54:55], v[74:75], v[70:71]
    s_and_b64 s[82:83], s[54:55], s[80:81]
    s_cbranch_scc1 L2_c59
L2_d59:
    v_mov_b64 v[84:85], v[70:71]
    v_mov_b32 v7, v95
    v_mov_b64 v[86:87], v[74:75]
    s_or_b64 s[80:81], s[80:81], s[54:55]
    s_mov_b64 exec, s[50:51]
    s_and_b64 s[82:83], s[50:51], s[80:81]
    s_cbranch_scc1 L2_c60
L2_d60:
    v_mov_b64 v[84:85], v[68:69]
    v_mov_b32 v7, v94
    v_mov_b64 v[86:87], v[72:73]
    s_mov_b64 exec, -1
    s_or_b64 s[80:81], s[80:81], s[50:51]
    s_and_b64 exec, s[48:49], s[80:81]
    v_mfma_f32_4x4x4_16b_bf16 v[80:83], v[12:13], v[84:85], 0
    v_mov_b32 v93, v7
    s_andn2_b64 s[80:81], s[80:81], s[48:49]
    v_mfma_f32_4x4x4_16b_bf16 v[80:83], v[10:11], v[86:87], v[80:83]
    s_mov_b64 exec, -1
    ds_read_b64 v[70:71], v93 offset:65408
    ds_read_b64 v[68:69], v92 offset:65408
    v_bitop3_b32 v94, v34, v5, v99 bitop3:0xea
    v_bitop3_b32 v95, v35, v5, v46 bitop3:0xea
    v_perm_b32 v15, v35, v38, s45
    v_bitop3_b32 v46, v35, 0.5, -0.5 bitop3:0xa8
    v_perm_b32 v14, v34, v38, s44
    v_bitop3_b32 v47, v34, 0.5, -0.5 bitop3:0xa8
    v_bitop3_b32 v15, v6, v15, v46 bitop3:0xca
    v_bitop3_b32 v14, v6, v14, v47 bitop3:0xca
    s_waitcnt lgkmcnt(1)
    v_mfma_f32_4x4x4_16b_bf16 v[80:83], v[10:11], v[70:71], v[80:83]
    s_waitcnt lgkmcnt(0)
    v_mfma_f32_4x4x4_16b_bf16 v[76:79], v[10:11], v[68:69], v[76:79]
    s_nop 2
    v_cvt_pk_bf16_f32 v80, v80, v81
    v_cvt_pk_bf16_f32 v81, v82, v83
    ds_wrxchg_rtn_b64 v[74:75], v93, v[80:81] offset:65408
    v_cvt_pk_bf16_f32 v76, v76, v77
    v_cvt_pk_bf16_f32 v77, v78, v79
    ds_wrxchg_rtn_b64 v[72:73], v92, v[76:77] offset:65408
    s_barrier
    s_setprio 3
    s_mov_b32 m0, s100
    s_nop 0
    ds_write_addtid_b32 v124 offset:34816
    ds_write_addtid_b32 v125 offset:35072
    ds_write_addtid_b32 v126 offset:35328
    ds_write_addtid_b32 v127 offset:35584
    s_add_u32 s3, s40, 4096
    buffer_load_dwordx4 v[124:127], v3, s[16:19], s3 offen sc1
    ds_write_addtid_b32 v116 offset:32768
    ds_write_addtid_b32 v117 offset:33024
    ds_write_addtid_b32 v118 offset:33280
    ds_write_addtid_b32 v119 offset:33536
    buffer_load_dwordx4 v[116:119], v3, s[16:19], s40 offen offset:2048 sc1
    ds_write_addtid_b32 v120 offset:33792
    ds_write_addtid_b32 v121 offset:34048
    ds_write_addtid_b32 v122 offset:34304
    ds_write_addtid_b32 v123 offset:34560
    buffer_load_dwordx4 v[120:123], v3, s[16:19], s40 offen offset:3072 sc1
    v_mfma_f32_4x4x4_16b_bf16 v[80:83], v[8:9], v[106:107], 0
    v_mfma_f32_4x4x4_16b_bf16 v[76:79], v[8:9], v[104:105], 0
    s_nop 3
    v_pk_mul_f32 v[80:81], v[80:81], v[14:15] op_sel:[0,1] op_sel_hi:[1,1]
    v_pk_mul_f32 v[82:83], v[82:83], v[14:15] op_sel:[0,1] op_sel_hi:[1,1]
    v_pk_mul_f32 v[76:77], v[76:77], v[14:15] op_sel:[0,0] op_sel_hi:[1,0]
    v_pk_mul_f32 v[78:79], v[78:79], v[14:15] op_sel:[0,0] op_sel_hi:[1,0]
    s_cmp_gt_u32 s37, 1024
    s_cbranch_scc1 L2_xs61
    s_cmp_lg_u32 s101, 0
    s_cbranch_scc1 L2_xa61
L2_xb61:
    v_lshlrev_b32 v89, 16, v96
    v_add_u32 v90, 60, v97
    v_bitop3_b32 v90, v89, v45, v90 bitop3:0x6a
    ds_write_b32 v98, v90 offset:12
    v_lshlrev_b32 v89, 20, v96
    v_add_u32 v90, 40, v97
    v_bitop3_b32 v90, v89, v45, v90 bitop3:0x6a
    ds_write_b32 v98, v90 offset:8
    v_lshlrev_b32 v89, 24, v96
    v_add_u32 v90, 20, v97
    v_bitop3_b32 v90, v89, v45, v90 bitop3:0x6a
    ds_write_b32 v98, v90 offset:4
    v_lshlrev_b32 v89, 28, v96
    v_bitop3_b32 v90, v89, v45, v97 bitop3:0x6a
    ds_write_b32 v98, v90 offset:0
    v_mov_b32_dpp v91, v64 quad_perm:[0,0,0,0] row_mask:0xf bank_mask:0xf
    v_and_b32 v89, 3, v91
    v_and_b32 v97, 0xfffc, v91
    v_sub_u16_dpp v88, v64, v91 quad_perm:[2,2,2,2] row_mask:0xf bank_mask:0xf
    v_mad_u32_u24 v97, v97, 5, v4
    v_add_u32 v99, v88, v89
    v_bfm_b32 v96, v88, v89
    v_cmp_lt_u32 s[58:59], 16, v99
    v_lshlrev_b32 v89, v1, v96
    v_and_b32 v89, v45, v89
    v_cmp_ne_u32 vcc, 0, v89
    v_xor_b32 v90, v97, v89
    s_add_u32 s3, s37, s38
    v_mbcnt_lo_u32_b32 v98, vcc_lo, 0
    v_mbcnt_hi_u32_b32 v98, vcc_hi, v98
    s_bcnt1_i32_b64 s41, vcc
    v_lshl_add_u32 v98, v98, 2, s3
    s_lshl2_add_u32 s37, s41, s37
    s_mov_b64 exec, vcc
    ds_write_b32 v98, v90
    s_mov_b64 exec, -1
    s_cmp_lg_u64 s[58:59], 0
    s_cbranch_scc1 L2_xe61
L2_xr61:
    v_add_u32 v98, s37, v0
    v_mov_b32 v90, -1
    ds_write_b32 v98, v90
L2_xw61:
    s_setprio 2
    s_waitcnt lgkmcnt(14)
    v_cmp_ne_u64 s[50:51], v[72:73], v[68:69]
    v_cmpx_ne_u64 s[54:55], v[74:75], v[70:71]
    s_and_b64 s[82:83], s[54:55], s[80:81]
    s_cbranch_scc1 L2_c62
L2_d62:
    v_mov_b64 v[84:85], v[70:71]
    v_mov_b32 v7, v93
    v_mov_b64 v[86:87], v[74:75]
    s_or_b64 s[80:81], s[80:81], s[54:55]
    s_mov_b64 exec, s[50:51]
    s_and_b64 s[82:83], s[50:51], s[80:81]
    s_cbranch_scc1 L2_c63
L2_d63:
    v_mov_b64 v[84:85], v[68:69]
    v_mov_b32 v7, v92
    v_mov_b64 v[86:87], v[72:73]
    s_mov_b64 exec, -1
    s_or_b64 s[80:81], s[80:81], s[50:51]
    ds_read_b64 v[70:71], v95 offset:65408
    ds_read_b64 v[68:69], v94 offset:65408
    v_and_b32 v46, 0x40000000, v39
    v_bitop3_b32 v92, v36, v5, v46 bitop3:0xea
    v_and_b32 v46, 0x80000000, v39
    v_bitop3_b32 v93, v37, v5, v46 bitop3:0xea
    v_perm_b32 v15, v37, v38, s47
    v_bitop3_b32 v46, v37, 0.5, -0.5 bitop3:0xa8
    v_perm_b32 v14, v36, v38, s46
    v_bitop3_b32 v47, v36, 0.5, -0.5 bitop3:0xa8
    v_bitop3_b32 v15, v6, v15, v46 bitop3:0xca
    v_bitop3_b32 v14, v6, v14, v47 bitop3:0xca
    s_setprio 1
    s_waitcnt lgkmcnt(1)
    v_mfma_f32_4x4x4_16b_bf16 v[80:83], v[10:11], v[70:71], v[80:83]
    s_waitcnt lgkmcnt(0)
    v_mfma_f32_4x4x4_16b_bf16 v[76:79], v[10:11], v[68:69], v[76:79]
    s_nop 2
    v_cvt_pk_bf16_f32 v80, v80, v81
    v_cvt_pk_bf16_f32 v81, v82, v83
    ds_wrxchg_rtn_b64 v[74:75], v95, v[80:81] offset:65408
    v_cvt_pk_bf16_f32 v76, v76, v77
    v_cvt_pk_bf16_f32 v77, v78, v79
    ds_wrxchg_rtn_b64 v[72:73], v94, v[76:77] offset:65408
    ds_read_b32 v21, v0 offset:0
    ds_read_b32 v27, v0 offset:256
    ds_read_b32 v31, v44 offset:768
    ds_read_b32 v39, v0 offset:512
    s_sub_u32 s3, s37, 768
    s_cmp_gt_u32 s3, 128
    s_cbranch_scc1 L2_xf61
L2_xg61:
    v_and_b32 v88, 0x0fffffff, v43
    buffer_load_dwordx2 v[34:35], v88, s[8:11], 0 offen
    buffer_load_dwordx3 v[36:38], v88, s[8:11], 0 offen offset:8
    s_setprio 0
    s_waitcnt vmcnt(12)
    s_mov_b32 m0, s38
    s_nop 0
    ds_write_addtid_b32 v108 offset:0
    ds_write_addtid_b32 v109 offset:256
    ds_write_addtid_b32 v110 offset:512
    ds_write_addtid_b32 v111 offset:768
    s_waitcnt vmcnt(9)
    ds_write_addtid_b32 v112 offset:1024
    ds_write_addtid_b32 v113 offset:1280
    ds_write_addtid_b32 v114 offset:1536
    ds_write_addtid_b32 v115 offset:1792
    v_mfma_f32_4x4x4_16b_bf16 v[80:83], v[8:9], v[102:103], 0
    v_mfma_f32_4x4x4_16b_bf16 v[76:79], v[8:9], v[100:101], 0
    v_cmp_lt_u32 s[84:85], v5, v92
    s_nop 2
    v_pk_mul_f32 v[80:81], v[80:81], v[14:15] op_sel:[0,1] op_sel_hi:[1,1]
    v_pk_mul_f32 v[82:83], v[82:83], v[14:15] op_sel:[0,1] op_sel_hi:[1,1]
    v_pk_mul_f32 v[76:77], v[76:77], v[14:15] op_sel:[0,0] op_sel_hi:[1,0]
    v_pk_mul_f32 v[78:79], v[78:79], v[14:15] op_sel:[0,0] op_sel_hi:[1,0]
    s_add_u32 s42, s42, 1
    s_waitcnt lgkmcnt(0)
    s_barrier
    s_bitcmp1_b32 s36, s42
    s_cbranch_scc1 L2_slow
L2_ret3:
    s_setprio 3
    s_bitcmp1_b32 s43, s42
    s_cbranch_scc1 L2_oa64
L2_ob64:
    v_and_b32 v46, 0x20000000, v40
    v_lshrrev_b32 v47, 14, v17
    v_bitop3_b32 v47, v47, v5, v46 bitop3:0xea
    ds_read_b64 v[106:107], v47
    v_and_b32 v99, 0x10000000, v40
    v_lshrrev_b32 v47, 14, v16
    v_bitop3_b32 v47, v47, v5, v99 bitop3:0xea
    ds_read_b64 v[104:105], v47
    v_cmp_ne_u64 s[50:51], v[72:73], v[68:69]
    v_cmpx_ne_u64 s[54:55], v[74:75], v[70:71]
    s_and_b64 s[82:83], s[54:55], s[80:81]
    s_cbranch_scc1 L2_c65
L2_d65:
    v_mov_b64 v[84:85], v[70:71]
    v_mov_b32 v7, v95
    v_mov_b64 v[86:87], v[74:75]
    s_or_b64 s[80:81], s[80:81], s[54:55]
    s_mov_b64 exec, s[50:51]
    s_and_b64 s[82:83], s[50:51], s[80:81]
    s_cbranch_scc1 L2_c66
L2_d66:
    v_mov_b64 v[84:85], v[68:69]
    v_mov_b32 v7, v94
    v_mov_b64 v[86:87], v[72:73]
    s_mov_b64 exec, -1
    s_or_b64 s[80:81], s[80:81], s[50:51]
    s_and_b64 exec, s[84:85], s[80:81]
    v_mfma_f32_4x4x4_16b_bf16 v[76:79], v[12:13], v[84:85], 0
    v_mov_b32 v92, v7
    s_andn2_b64 s[80:81], s[80:81], s[84:85]
    v_mfma_f32_4x4x4_16b_bf16 v[76:79], v[10:11], v[86:87], v[76:79]
    s_mov_b64 exec, -1
    ds_read_b64 v[70:71], v93 offset:65408
    ds_read_b64 v[68:69], v92 offset:65408
    v_bitop3_b32 v94, v16, v5, v99 bitop3:0xea
    v_bitop3_b32 v95, v17, v5, v46 bitop3:0xea
    v_perm_b32 v15, v17, v20, s45
    v_bitop3_b32 v46, v17, 0.5, -0.5 bitop3:0xa8
    v_perm_b32 v14, v16, v20, s44
    v_bitop3_b32 v47, v16, 0.5, -0.5 bitop3:0xa8
    v_bitop3_b32 v15, v6, v15, v46 bitop3:0xca
    v_bitop3_b32 v14, v6, v14, v47 bitop3:0xca
    s_waitcnt lgkmcnt(1)
    v_mfma_f32_4x4x4_16b_bf16 v[80:83], v[10:11], v[70:71], v[80:83]
    s_waitcnt lgkmcnt(0)
    v_mfma_f32_4x4x4_16b_bf16 v[76:79], v[10:11], v[68:69], v[76:79]
    s_nop 2
    v_cvt_pk_bf16_f32 v80, v80, v81
    v_cvt_pk_bf16_f32 v81, v82, v83
    ds_wrxchg_rtn_b64 v[74:75], v93, v[80:81] offset:65408
    v_cvt_pk_bf16_f32 v76, v76, v77
    v_cvt_pk_bf16_f32 v77, v78, v79
    ds_wrxchg_rtn_b64 v[72:73], v92, v[76:77] offset:65408
    v_mfma_f32_4x4x4_16b_bf16 v[80:83], v[8:9], v[106:107], 0
    v_mfma_f32_4x4x4_16b_bf16 v[76:79], v[8:9], v[104:105], 0
    v_cmp_lt_u32 s[84:85], v5, v94
    s_nop 2
    v_pk_mul_f32 v[80:81], v[80:81], v[14:15] op_sel:[0,1] op_sel_hi:[1,1]
    v_pk_mul_f32 v[82:83], v[82:83], v[14:15] op_sel:[0,1] op_sel_hi:[1,1]
    v_pk_mul_f32 v[76:77], v[76:77], v[14:15] op_sel:[0,0] op_sel_hi:[1,0]
    v_pk_mul_f32 v[78:79], v[78:79], v[14:15] op_sel:[0,0] op_sel_hi:[1,0]
    buffer_load_dwordx4 v[108:111], v3, s[16:19], s40 offen offset:0 sc1
    v_and_b32 v46, 0x80000000, v40
    v_lshrrev_b32 v47, 14, v19
    v_bitop3_b32 v47, v47, v5, v46 bitop3:0xea
    ds_read_b64 v[102:103], v47
    v_and_b32 v99, 0x40000000, v40
    v_lshrrev_b32 v47, 14, v18
    v_bitop3_b32 v47, v47, v5, v99 bitop3:0xea
    ds_read_b64 v[100:101], v47
    s_waitcnt lgkmcnt(2)
    v_cmp_ne_u64 s[50:51], v[72:73], v[68:69]
    v_cmpx_ne_u64 s[54:55], v[74:75], v[70:71]
    s_and_b64 s[82:83], s[54:55], s[80:81]
    s_cbranch_scc1 L2_c67
L2_d67:
    v_mov_b64 v[84:85], v[70:71]
    v_mov_b32 v7, v93
    v_mov_b64 v[86:87], v[74:75]
    s_or_b64 s[80:81], s[80:81], s[54:55]
    s_mov_b64 exec, s[50:51]
    s_and_b64 s[82:83], s[50:51], s[80:81]
    s_cbranch_scc1 L2_c68
L2_d68:
    v_mov_b64 v[84:85], v[68:69]
    v_mov_b32 v7, v92
    v_mov_b64 v[86:87], v[72:73]
    s_mov_b64 exec, -1
    s_or_b64 s[80:81], s[80:81], s[50:51]
    s_and_b64 exec, s[84:85], s[80:81]
    v_mfma_f32_4x4x4_16b_bf16 v[76:79], v[12:13], v[84:85], 0
    v_mov_b32 v94, v7
    s_andn2_b64 s[80:81], s[80:81], s[84:85]
    v_mfma_f32_4x4x4_16b_bf16 v[76:79], v[10:11], v[86:87], v[76:79]
    s_mov_b64 exec, -1
    ds_read_b64 v[70:71], v95 offset:65408
    ds_read_b64 v[68:69], v94 offset:65408
    v_bitop3_b32 v92, v18, v5, v99 bitop3:0xea
    v_bitop3_b32 v93, v19, v5, v46 bitop3:0xea
    v_perm_b32 v15, v19, v20, s47
    v_bitop3_b32 v46, v19, 0.5, -0.5 bitop3:0xa8
    v_perm_b32 v14, v18, v20, s46
    v_bitop3_b32 v47, v18, 0.5, -0.5 bitop3:0xa8
    v_bitop3_b32 v15, v6, v15, v46 bitop3:0xca
    v_bitop3_b32 v14, v6, v14, v47 bitop3:0xca
    s_waitcnt lgkmcnt(1)
    v_mfma_f32_4x4x4_16b_bf16 v[80:83], v[10:11], v[70:71], v[80:83]
    s_waitcnt lgkmcnt(0)
    v_mfma_f32_4x4x4_16b_bf16 v[76:79], v[10:11], v[68:69], v[76:79]
    s_nop 2
    v_cvt_pk_bf16_f32 v80, v80, v81
    v_cvt_pk_bf16_f32 v81, v82, v83
    ds_wrxchg_rtn_b64 v[74:75], v95, v[80:81] offset:65408
    v_cvt_pk_bf16_f32 v76, v76, v77
    v_cvt_pk_bf16_f32 v77, v78, v79
    ds_wrxchg_rtn_b64 v[72:73], v94, v[76:77] offset:65408
    v_and_b32 v88, 0x0fffffff, v21
    buffer_load_dwordx2 v[16:17], v88, s[8:11], 0 offen
    buffer_load_dwordx3 v[18:20], v88, s[8:11], 0 offen offset:8
    s_setprio 2
    v_mfma_f32_4x4x4_16b_bf16 v[80:83], v[8:9], v[102:103], 0
    v_mfma_f32_4x4x4_16b_bf16 v[76:79], v[8:9], v[100:101], 0
    v_cmp_lt_u32 s[48:49], v5, v93
    s_nop 2
    v_pk_mul_f32 v[80:81], v[80:81], v[14:15] op_sel:[0,1] op_sel_hi:[1,1]
    v_pk_mul_f32 v[82:83], v[82:83], v[14:15] op_sel:[0,1] op_sel_hi:[1,1]
    v_pk_mul_f32 v[76:77], v[76:77], v[14:15] op_sel:[0,0] op_sel_hi:[1,0]
    v_pk_mul_f32 v[78:79], v[78:79], v[14:15] op_sel:[0,0] op_sel_hi:[1,0]
    s_waitcnt vmcnt(10)
    v_and_b32 v46, 0x20000000, v41
    v_lshrrev_b32 v47, 14, v23
    v_bitop3_b32 v47, v47, v5, v46 bitop3:0xea
    ds_read_b64 v[106:107], v47
    v_and_b32 v99, 0x10000000, v41
    v_lshrrev_b32 v47, 14, v22
    v_bitop3_b32 v47, v47, v5, v99 bitop3:0xea
    ds_read_b64 v[104:105], v47
    s_waitcnt lgkmcnt(2)
    v_cmp_ne_u64 s[50:51], v[72:73], v[68:69]
    v_cmpx_ne_u64 s[54:55], v[74:75], v[70:71]
    s_and_b64 s[82:83], s[54:55], s[80:81]
    s_cbranch_scc1 L2_c69
L2_d69:
    v_mov_b64 v[84:85], v[70:71]
    v_mov_b32 v7, v95
    v_mov_b64 v[86:87], v[74:75]
    s_or_b64 s[80:81], s[80:81], s[54:55]
    s_mov_b64 exec, s[50:51]
    s_and_b64 s[82:83], s[50:51], s[80:81]
    s_cbranch_scc1 L2_c70
L2_d70:
    v_mov_b64 v[84:85], v[68:69]
    v_mov_b32 v7, v94
    v_mov_b64 v[86:87], v[72:73]
    s_mov_b64 exec, -1
    s_or_b64 s[80:81], s[80:81], s[50:51]
    s_and_b64 exec, s[48:49], s[80:81]
    v_mfma_f32_4x4x4_16b_bf16 v[80:83], v[12:13], v[84:85], 0
    v_mov_b32 v93, v7
    s_andn2_b64 s[80:81], s[80:81], s[48:49]
    v_mfma_f32_4x4x4_16b_bf16 v[80:83], v[10:11], v[86:87], v[80:83]
    s_mov_b64 exec, -1
    ds_read_b64 v[70:71], v93 offset:65408
    ds_read_b64 v[68:69], v92 offset:65408
    v_bitop3_b32 v94, v22, v5, v99 bitop3:0xea
    v_bitop3_b32 v95, v23, v5, v46 bitop3:0xea
    v_perm_b32 v15, v23, v26, s45
    v_bitop3_b32 v46, v23, 0.5, -0.5 bitop3:0xa8
    v_perm_b32 v14, v22, v26, s44
    v_bitop3_b32 v47, v22, 0.5, -0.5 bitop3:0xa8
    v_bitop3_b32 v15, v6, v15, v46 bitop3:0xca
    v_bitop3_b32 v14, v6, v14, v47 bitop3:0xca
    s_waitcnt lgkmcnt(1)
    v_mfma_f32_4x4x4_16b_bf16 v[80:83], v[10:11], v[70:71], v[80:83]
    s_waitcnt lgkmcnt(0)
    v_mfma_f32_4x4x4_16b_bf16 v[76:79], v[10:11], v[68:69], v[76:79]
    s_nop 2
    v_cvt_pk_bf16_f32 v80, v80, v81
    v_cvt_pk_bf16_f32 v81, v82, v83
    ds_wrxchg_rtn_b64 v[74:75], v93, v[80:81] offset:65408
    v_cvt_pk_bf16_f32 v76, v76, v77
    v_cvt_pk_bf16_f32 v77, v78, v79
    ds_wrxchg_rtn_b64 v[72:73], v92, v[76:77] offset:65408
    s_setprio 1
    v_mfma_f32_4x4x4_16b_bf16 v[80:83], v[8:9], v[106:107], 0
    v_mfma_f32_4x4x4_16b_bf16 v[76:79], v[8:9], v[104:105], 0
    s_nop 3
    v_pk_mul_f32 v[80:81], v[80:81], v[14:15] op_sel:[0,1] op_sel_hi:[1,1]
    v_pk_mul_f32 v[82:83], v[82:83], v[14:15] op_sel:[0,1] op_sel_hi:[1,1]
    v_pk_mul_f32 v[76:77], v[76:77], v[14:15] op_sel:[0,0] op_sel_hi:[1,0]
    v_pk_mul_f32 v[78:79], v[78:79], v[14:15] op_sel:[0,0] op_sel_hi:[1,0]
    s_bitcmp1_b32 s43, s42
    s_cbranch_scc1 L2_oa71
L2_ob71:
    buffer_load_dwordx4 v[112:115], v3, s[16:19], s40 offen offset:1024 sc1
    v_sub_u16 v88, v58, v50
    v_and_b32 v89, 3, v50
    v_add3_u32 v99, v88, v89, 3
    v_and_b32 v99, -4, v99
    v_max_u32 v99, 4, v99
    v_and_b32 v97, 0xfffc, v50
    v_bfm_b32 v96, v88, v89
    v_add_u32_dpp v91, v99, v99 row_shr:1 row_mask:0xf bank_mask:0xf bound_ctrl:1
    v_mad_u32_u24 v97, v97, 5, v2
    v_cmp_lt_u32 vcc, 16, v99
    v_add_u32_dpp v91, v91, v91 row_shr:2 row_mask:0xf bank_mask:0xf bound_ctrl:1
    v_sub_u32 v98, s38, v99
    v_lshrrev_b64 v[50:51], 16, v[50:51]
    v_add_u32_dpp v91, v91, v91 row_shr:4 row_mask:0xf bank_mask:0xf bound_ctrl:1
    v_lshrrev_b64 v[58:59], 16, v[58:59]
    s_mov_b32 s101, 0
    v_add_u32_dpp v91, v91, v91 row_shr:8 row_mask:0xf bank_mask:0xf bound_ctrl:1
    s_nop 1
    v_add_u32_dpp v91, v91, v91 row_bcast:15 row_mask:0xa bank_mask:0xf
    s_nop 1
    v_add_u32_dpp v91, v91, v91 row_bcast:31 row_mask:0xc bank_mask:0xf
    v_add_u32 v98, v98, v91
    v_readlane_b32 s37, v91, 63
    s_cbranch_vccnz L2_xo72
L2_xp72:
    v_and_b32 v46, 0x80000000, v41
    v_lshrrev_b32 v47, 14, v25
    v_bitop3_b32 v47, v47, v5, v46 bitop3:0xea
    ds_read_b64 v[102:103], v47
    v_and_b32 v99, 0x40000000, v41
    v_lshrrev_b32 v47, 14, v24
    v_bitop3_b32 v47, v47, v5, v99 bitop3:0xea
    ds_read_b64 v[100:101], v47
    s_waitcnt lgkmcnt(2)
    v_cmp_ne_u64 s[50:51], v[72:73], v[68:69]
    v_cmpx_ne_u64 s[54:55], v[74:75], v[70:71]
    s_and_b64 s[82:83], s[54:55], s[80:81]
    s_cbranch_scc1 L2_c73
L2_d73:
    v_mov_b64 v[84:85], v[70:71]
    v_mov_b32 v7, v93
    v_mov_b64 v[86:87], v[74:75]
    s_or_b64 s[80:81], s[80:81], s[54:55]
    s_mov_b64 exec, s[50:51]
    s_and_b64 s[82:83], s[50:51], s[80:81]
    s_cbranch_scc1 L2_c74
L2_d74:
    v_mov_b64 v[84:85], v[68:69]
    v_mov_b32 v7, v92
    v_mov_b64 v[86:87], v[72:73]
    s_mov_b64 exec, -1
    s_or_b64 s[80:81], s[80:81], s[50:51]
    ds_read_b64 v[70:71], v95 offset:65408
    ds_read_b64 v[68:69], v94 offset:65408
    v_bitop3_b32 v92, v24, v5, v99 bitop3:0xea
    v_bitop3_b32 v93, v25, v5, v46 bitop3:0xea
    v_perm_b32 v15, v25, v26, s47
    v_bitop3_b32 v46, v25, 0.5, -0.5 bitop3:0xa8
    v_perm_b32 v14, v24, v26, s46
    v_bitop3_b32 v47, v24, 0.5, -0.5 bitop3:0xa8
    v_bitop3_b32 v15, v6, v15, v46 bitop3:0xca
    v_bitop3_b32 v14, v6, v14, v47 bitop3:0xca
    s_waitcnt lgkmcnt(1)
    v_mfma_f32_4x4x4_16b_bf16 v[80:83], v[10:11], v[70:71], v[80:83]
    s_waitcnt lgkmcnt(0)
    v_mfma_f32_4x4x4_16b_bf16 v[76:79], v[10:11], v[68:69], v[76:79]
    s_nop 2
    v_cvt_pk_bf16_f32 v80, v80, v81
    v_cvt_pk_bf16_f32 v81, v82, v83
    ds_wrxchg_rtn_b64 v[74:75], v95, v[80:81] offset:65408
    v_cvt_pk_bf16_f32 v76, v76, v77
    v_cvt_pk_bf16_f32 v77, v78, v79
    ds_wrxchg_rtn_b64 v[72:73], v94, v[76:77] offset:65408
    v_and_b32 v88, 0x0fffffff, v27
    buffer_load_dwordx2 v[22:23], v88, s[8:11], 0 offen
    buffer_load_dwordx3 v[24:26], v88, s[8:11], 0 offen offset:8
    v_mfma_f32_4x4x4_16b_bf16 v[80:83], v[8:9], v[102:103], 0
    v_mfma_f32_4x4x4_16b_bf16 v[76:79], v[8:9], v[100:101], 0
    v_cmp_lt_u32 s[84:85], v5, v92
    s_nop 2
    v_pk_mul_f32 v[80:81], v[80:81], v[14:15] op_sel:[0,1] op_sel_hi:[1,1]
    v_pk_mul_f32 v[82:83], v[82:83], v[14:15] op_sel:[0,1] op_sel_hi:[1,1]
    v_pk_mul_f32 v[76:77], v[76:77], v[14:15] op_sel:[0,0] op_sel_hi:[1,0]
    v_pk_mul_f32 v[78:79], v[78:79], v[14:15] op_sel:[0,0] op_sel_hi:[1,0]
    s_waitcnt vmcnt(11)
    s_mov_b64 exec, s[6:7]
    v_lshrrev_b32 v30, 16, v30
    s_mov_b64 exec, -1
    v_and_b32 v46, 0x20000000, v42
    v_lshrrev_b32 v47, 14, v29
    v_bitop3_b32 v47, v47, v5, v46 bitop3:0xea
    ds_read_b64 v[106:107], v47
    v_and_b32 v99, 0x10000000, v42
    v_lshrrev_b32 v47, 14, v28
    v_bitop3_b32 v47, v47, v5, v99 bitop3:0xea
    ds_read_b64 v[104:105], v47
    s_waitcnt lgkmcnt(2)
    v_cmp_ne_u64 s[50:51], v[72:73], v[68:69]
    v_cmpx_ne_u64 s[54:55], v[74:75], v[70:71]
    s_and_b64 s[82:83], s[54:55], s[80:81]
    s_cbranch_scc1 L2_c75
L2_d75:
    v_mov_b64 v[84:85], v[70:71]
    v_mov_b32 v7, v95
    v_mov_b64 v[86:87], v[74:75]
    s_or_b64 s[80:81], s[80:81], s[54:55]
    s_mov_b64 exec, s[50:51]
    s_and_b64 s[82:83], s[50:51], s[80:81]
    s_cbranch_scc1 L2_c76
L2_d76:
    v_mov_b64 v[84:85], v[68:69]
    v_mov_b32 v7, v94
    v_mov_b64 v[86:87], v[72:73]
    s_mov_b64 exec, -1
    s_or_b64 s[80:81], s[80:81], s[50:51]
    s_and_b64 exec, s[84:85], s[80:81]
    v_mfma_f32_4x4x4_16b_bf16 v[76:79], v[12:13], v[84:85], 0
    v_mov_b32 v92, v7
    s_andn2_b64 s[80:81], s[80:81], s[84:85]
    v_mfma_f32_4x4x4_16b_bf16 v[76:79], v[10:11], v[86:87], v[76:79]
    s_mov_b64 exec, -1
    ds_read_b64 v[70:71], v93 offset:65408
    ds_read_b64 v[68:69], v92 offset:65408
    v_bitop3_b32 v94, v28, v5, v99 bitop3:0xea
    v_bitop3_b32 v95, v29, v5, v46 bitop3:0xea
    v_perm_b32 v15, v29, v30, s45
    v_bitop3_b32 v46, v29, 0.5, -0.5 bitop3:0xa8
    v_perm_b32 v14, v28, v30, s44
    v_bitop3_b32 v47, v28, 0.5, -0.5 bitop3:0xa8
    v_bitop3_b32 v15, v6, v15, v46 bitop3:0xca
    v_bitop3_b32 v14, v6, v14, v47 bitop3:0xca
    s_waitcnt lgkmcnt(1)
    v_mfma_f32_4x4x4_16b_bf16 v[80:83], v[10:11], v[70:71], v[80:83]
    s_waitcnt lgkmcnt(0)
    v_mfma_f32_4x4x4_16b_bf16 v[76:79], v[10:11], v[68:69], v[76:79]
    s_nop 2
    v_cvt_pk_bf16_f32 v80, v80, v81
    v_cvt_pk_bf16_f32 v81, v82, v83
    ds_wrxchg_rtn_b64 v[74:75], v93, v[80:81] offset:65408
    v_cvt_pk_bf16_f32 v76, v76, v77
    v_cvt_pk_bf16_f32 v77, v78, v79
    ds_wrxchg_rtn_b64 v[72:73], v92, v[76:77] offset:65408
    s_setprio 0
    v_mfma_f32_4x4x4_16b_bf16 v[80:83], v[8:9], v[106:107], 0
    v_mfma_f32_4x4x4_16b_bf16 v[76:79], v[8:9], v[104:105], 0
    v_cmp_lt_u32 s[48:49], v5, v95
    s_nop 2
    v_pk_mul_f32 v[80:81], v[80:81], v[14:15] op_sel:[0,1] op_sel_hi:[1,1]
    v_pk_mul_f32 v[82:83], v[82:83], v[14:15] op_sel:[0,1] op_sel_hi:[1,1]
    v_pk_mul_f32 v[76:77], v[76:77], v[14:15] op_sel:[0,0] op_sel_hi:[1,0]
    v_pk_mul_f32 v[78:79], v[78:79], v[14:15] op_sel:[0,0] op_sel_hi:[1,0]
    s_add_u32 s40, s40, 0x50000
    v_and_b32 v47, 0x0fffffff, v31
    buffer_load_dword v30, v47, s[8:11], 0 offen offset:16
    s_mov_b64 exec, s[6:7]
    v_add_u32 v47, 8, v47
    v_lshrrev_b32 v31, 2, v31
    s_mov_b64 exec, -1
    buffer_load_dwordx2 v[28:29], v47, s[8:11], 0 offen
    s_waitcnt vmcnt(8)
    v_and_b32 v46, 0x80000000, v43
    v_lshrrev_b32 v47, 14, v37
    v_bitop3_b32 v47, v47, v5, v46 bitop3:0xea
    ds_read_b64 v[106:107], v47
    v_and_b32 v99, 0x40000000, v43
    v_lshrrev_b32 v47, 14, v36
    v_bitop3_b32 v47, v47, v5, v99 bitop3:0xea
    ds_read_b64 v[104:105], v47
    v_and_b32 v46, 0x20000000, v43
    v_lshrrev_b32 v47, 14, v35
    v_bitop3_b32 v47, v47, v5, v46 bitop3:0xea
    ds_read_b64 v[102:103], v47
    v_and_b32 v99, 0x10000000, v43
    v_lshrrev_b32 v47, 14, v34
    v_bitop3_b32 v47, v47, v5, v99 bitop3:0xea
    ds_read_b64 v[100:101], v47
    s_waitcnt lgkmcnt(4)
    v_cmp_ne_u64 s[50:51], v[72:73], v[68:69]
    v_cmpx_ne_u64 s[54:55], v[74:75], v[70:71]
    s_and_b64 s[82:83], s[54:55], s[80:81]
    s_cbranch_scc1 L2_c77
L2_d77:
    v_mov_b64 v[84:85], v[70:71]
    v_mov_b32 v7, v93
    v_mov_b64 v[86:87], v[74:75]
    s_or_b64 s[80:81], s[80:81], s[54:55]
    s_mov_b64 exec, s[50:51]
    s_and_b64 s[82:83], s[50:51], s[80:81]
    s_cbranch_scc1 L2_c78
L2_d78:
    v_mov_b64 v[84:85], v[68:69]
    v_mov_b32 v7, v92
    v_mov_b64 v[86:87], v[72:73]
    s_mov_b64 exec, -1
    s_or_b64 s[80:81], s[80:81], s[50:51]
    s_and_b64 exec, s[48:49], s[80:81]
    v_mfma_f32_4x4x4_16b_bf16 v[80:83], v[12:13], v[84:85], 0
    v_mov_b32 v95, v7
    s_andn2_b64 s[80:81], s[80:81], s[48:49]
    v_mfma_f32_4x4x4_16b_bf16 v[80:83], v[10:11], v[86:87], v[80:83]
    s_mov_b64 exec, -1
    ds_read_b64 v[70:71], v95 offset:65408
    ds_read_b64 v[68:69], v94 offset:65408
    v_bitop3_b32 v92, v34, v5, v99 bitop3:0xea
    v_bitop3_b32 v93, v35, v5, v46 bitop3:0xea
    v_perm_b32 v15, v35, v38, s45
    v_bitop3_b32 v46, v35, 0.5, -0.5 bitop3:0xa8
    v_perm_b32 v14, v34, v38, s44
    v_bitop3_b32 v47, v34, 0.5, -0.5 bitop3:0xa8
    v_bitop3_b32 v15, v6, v15, v46 bitop3:0xca
    v_bitop3_b32 v14, v6, v14, v47 bitop3:0xca
    s_waitcnt lgkmcnt(1)
    v_mfma_f32_4x4x4_16b_bf16 v[80:83], v[10:11], v[70:71], v[80:83]
    s_waitcnt lgkmcnt(0)
    v_mfma_f32_4x4x4_16b_bf16 v[76:79], v[10:11], v[68:69], v[76:79]
    s_nop 2
    v_cvt_pk_bf16_f32 v80, v80, v81
    v_cvt_pk_bf16_f32 v81, v82, v83
    ds_wrxchg_rtn_b64 v[74:75], v95, v[80:81] offset:65408
    v_cvt_pk_bf16_f32 v76, v76, v77
    v_cvt_pk_bf16_f32 v77, v78, v79
    ds_wrxchg_rtn_b64 v[72:73], v94, v[76:77] offset:65408
    s_barrier
    s_setprio 3
    s_mov_b32 m0, s100
    s_nop 0
    ds_write_addtid_b32 v124 offset:34816
    ds_write_addtid_b32 v125 offset:35072
    ds_write_addtid_b32 v126 offset:35328
    ds_write_addtid_b32 v127 offset:35584
    s_add_u32 s3, s40, 4096
    buffer_load_dwordx4 v[124:127], v3, s[16:19], s3 offen sc1
    ds_write_addtid_b32 v116 offset:32768
    ds_write_addtid_b32 v117 offset:33024
    ds_write_addtid_b32 v118 offset:33280
    ds_write_addtid_b32 v119 offset:33536
    buffer_load_dwordx4 v[116:119], v3, s[16:19], s40 offen offset:2048 sc1
    ds_write_addtid_b32 v120 offset:33792
    ds_write_addtid_b32 v121 offset:34048
    ds_write_addtid_b32 v122 offset:34304
    ds_write_addtid_b32 v123 offset:34560
    buffer_load_dwordx4 v[120:123], v3, s[16:19], s40 offen offset:3072 sc1
    v_mfma_f32_4x4x4_16b_bf16 v[80:83], v[8:9], v[102:103], 0
    v_mfma_f32_4x4x4_16b_bf16 v[76:79], v[8:9], v[100:101], 0
    s_nop 3
    v_pk_mul_f32 v[80:81], v[80:81], v[14:15] op_sel:[0,1] op_sel_hi:[1,1]
    v_pk_mul_f32 v[82:83], v[82:83], v[14:15] op_sel:[0,1] op_sel_hi:[1,1]
    v_pk_mul_f32 v[76:77], v[76:77], v[14:15] op_sel:[0,0] op_sel_hi:[1,0]
    v_pk_mul_f32 v[78:79], v[78:79], v[14:15] op_sel:[0,0] op_sel_hi:[1,0]
    s_cmp_gt_u32 s37, 1024
    s_cbranch_scc1 L2_xs79
    s_cmp_lg_u32 s101, 0
    s_cbranch_scc1 L2_xa79
L2_xb79:
    v_lshlrev_b32 v89, 16, v96
    v_add_u32 v90, 60, v97
    v_bitop3_b32 v90, v89, v45, v90 bitop3:0x6a
    ds_write_b32 v98, v90 offset:12
    v_lshlrev_b32 v89, 20, v96
    v_add_u32 v90, 40, v97
    v_bitop3_b32 v90, v89, v45, v90 bitop3:0x6a
    ds_write_b32 v98, v90 offset:8
    v_lshlrev_b32 v89, 24, v96
    v_add_u32 v90, 20, v97
    v_bitop3_b32 v90, v89, v45, v90 bitop3:0x6a
    ds_write_b32 v98, v90 offset:4
    v_lshlrev_b32 v89, 28, v96
    v_bitop3_b32 v90, v89, v45, v97 bitop3:0x6a
    ds_write_b32 v98, v90 offset:0
    v_mov_b32_dpp v91, v66 quad_perm:[0,0,0,0] row_mask:0xf bank_mask:0xf
    v_and_b32 v89, 3, v91
    v_and_b32 v97, 0xfffc, v91
    v_sub_u16_dpp v88, v66, v91 quad_perm:[2,2,2,2] row_mask:0xf bank_mask:0xf
    v_mad_u32_u24 v97, v97, 5, v4
    v_add_u32 v99, v88, v89
    v_bfm_b32 v96, v88, v89
    v_cmp_lt_u32 s[58:59], 16, v99
    v_lshlrev_b32 v89, v1, v96
    v_and_b32 v89, v45, v89
    v_cmp_ne_u32 vcc, 0, v89
    v_xor_b32 v90, v97, v89
    s_add_u32 s3, s37, s38
    v_mbcnt_lo_u32_b32 v98, vcc_lo, 0
    v_mbcnt_hi_u32_b32 v98, vcc_hi, v98
    s_bcnt1_i32_b64 s41, vcc
    v_lshl_add_u32 v98, v98, 2, s3
    s_lshl2_add_u32 s37, s41, s37
    s_mov_b64 exec, vcc
    ds_write_b32 v98, v90
    s_mov_b64 exec, -1
    s_cmp_lg_u64 s[58:59], 0
    s_cbranch_scc1 L2_xe79
L2_xr79:
    v_add_u32 v98, s37, v0
    v_mov_b32 v90, -1
    ds_write_b32 v98, v90
L2_xw79:
    s_setprio 2
    s_waitcnt lgkmcnt(14)
    v_cmp_ne_u64 s[50:51], v[72:73], v[68:69]
    v_cmpx_ne_u64 s[54:55], v[74:75], v[70:71]
    s_and_b64 s[82:83], s[54:55], s[80:81]
    s_cbranch_scc1 L2_c80
L2_d80:
    v_mov_b64 v[84:85], v[70:71]
    v_mov_b32 v7, v95
    v_mov_b64 v[86:87], v[74:75]
    s_or_b64 s[80:81], s[80:81], s[54:55]
    s_mov_b64 exec, s[50:51]
    s_and_b64 s[82:83], s[50:51], s[80:81]
    s_cbranch_scc1 L2_c81
L2_d81:
    v_mov_b64 v[84:85], v[68:69]
    v_mov_b32 v7, v94
    v_mov_b64 v[86:87], v[72:73]
    s_mov_b64 exec, -1
    s_or_b64 s[80:81], s[80:81], s[50:51]
    ds_read_b64 v[70:71], v93 offset:65408
    ds_read_b64 v[68:69], v92 offset:65408
    v_and_b32 v46, 0x40000000, v43
    v_bitop3_b32 v94, v36, v5, v46 bitop3:0xea
    v_and_b32 v46, 0x80000000, v43
    v_bitop3_b32 v95, v37, v5, v46 bitop3:0xea
    v_perm_b32 v15, v37, v38, s47
    v_bitop3_b32 v46, v37, 0.5, -0.5 bitop3:0xa8
    v_perm_b32 v14, v36, v38, s46
    v_bitop3_b32 v47, v36, 0.5, -0.5 bitop3:0xa8
    v_bitop3_b32 v15, v6, v15, v46 bitop3:0xca
    v_bitop3_b32 v14, v6, v14, v47 bitop3:0xca
    s_setprio 1
    s_waitcnt lgkmcnt(1)
    v_mfma_f32_4x4x4_16b_bf16 v[80:83], v[10:11], v[70:71], v[80:83]
    s_waitcnt lgkmcnt(0)
    v_mfma_f32_4x4x4_16b_bf16 v[76:79], v[10:11], v[68:69], v[76:79]
    s_nop 2
    v_cvt_pk_bf16_f32 v80, v80, v81
    v_cvt_pk_bf16_f32 v81, v82, v83
    ds_wrxchg_rtn_b64 v[74:75], v93, v[80:81] offset:65408
    v_cvt_pk_bf16_f32 v76, v76, v77
    v_cvt_pk_bf16_f32 v77, v78, v79
    ds_wrxchg_rtn_b64 v[72:73], v92, v[76:77] offset:65408
    ds_read_b32 v40, v0 offset:0
    ds_read_b32 v41, v0 offset:256
    ds_read_b32 v42, v44 offset:768
    ds_read_b32 v43, v0 offset:512
    s_sub_u32 s3, s37, 768
    s_cmp_gt_u32 s3, 128
    s_cbranch_scc1 L2_xf79
L2_xg79:
    v_and_b32 v88, 0x0fffffff, v39
    buffer_load_dwordx2 v[34:35], v88, s[8:11], 0 offen
    buffer_load_dwordx3 v[36:38], v88, s[8:11], 0 offen offset:8
    s_setprio 0
    s_waitcnt vmcnt(12)
    s_mov_b32 m0, s38
    s_nop 0
    ds_write_addtid_b32 v108 offset:0
    ds_write_addtid_b32 v109 offset:256
    ds_write_addtid_b32 v110 offset:512
    ds_write_addtid_b32 v111 offset:768
    s_waitcnt vmcnt(9)
    ds_write_addtid_b32 v112 offset:1024
    ds_write_addtid_b32 v113 offset:1280
    ds_write_addtid_b32 v114 offset:1536
    ds_write_addtid_b32 v115 offset:1792
    v_mfma_f32_4x4x4_16b_bf16 v[80:83], v[8:9], v[106:107], 0
    v_mfma_f32_4x4x4_16b_bf16 v[76:79], v[8:9], v[104:105], 0
    v_cmp_lt_u32 s[84:85], v5, v94
    s_nop 2
    v_pk_mul_f32 v[80:81], v[80:81], v[14:15] op_sel:[0,1] op_sel_hi:[1,1]
    v_pk_mul_f32 v[82:83], v[82:83], v[14:15] op_sel:[0,1] op_sel_hi:[1,1]
    v_pk_mul_f32 v[76:77], v[76:77], v[14:15] op_sel:[0,0] op_sel_hi:[1,0]
    v_pk_mul_f32 v[78:79], v[78:79], v[14:15] op_sel:[0,0] op_sel_hi:[1,0]
    s_add_u32 s42, s42, 1
    s_waitcnt lgkmcnt(0)
    s_barrier
    s_bitcmp1_b32 s36, s42
    s_cbranch_scc1 L2_slow
L2_ret4:
    s_setprio 3
    s_bitcmp1_b32 s43, s42
    s_cbranch_scc1 L2_oa82
L2_ob82:
    v_and_b32 v46, 0x20000000, v21
    v_lshrrev_b32 v47, 14, v17
    v_bitop3_b32 v47, v47, v5, v46 bitop3:0xea
    ds_read_b64 v[102:103], v47
    v_and_b32 v99, 0x10000000, v21
    v_lshrrev_b32 v47, 14, v16
    v_bitop3_b32 v47, v47, v5, v99 bitop3:0xea
    ds_read_b64 v[100:101], v47
    v_cmp_ne_u64 s[50:51], v[72:73], v[68:69]
    v_cmpx_ne_u64 s[54:55], v[74:75], v[70:71]
    s_and_b64 s[82:83], s[54:55], s[80:81]
    s_cbranch_scc1 L2_c83
L2_d83:
    v_mov_b64 v[84:85], v[70:71]
    v_mov_b32 v7, v93
    v_mov_b64 v[86:87], v[74:75]
    s_or_b64 s[80:81], s[80:81], s[54:55]
    s_mov_b64 exec, s[50:51]
    s_and_b64 s[82:83], s[50:51], s[80:81]
    s_cbranch_scc1 L2_c84
L2_d84:
    v_mov_b64 v[84:85], v[68:69]
    v_mov_b32 v7, v92
    v_mov_b64 v[86:87], v[72:73]
    s_mov_b64 exec, -1
    s_or_b64 s[80:81], s[80:81], s[50:51]
    s_and_b64 exec, s[84:85], s[80:81]
    v_mfma_f32_4x4x4_16b_bf16 v[76:79], v[12:13], v[84:85], 0
    v_mov_b32 v94, v7
    s_andn2_b64 s[80:81], s[80:81], s[84:85]
    v_mfma_f32_4x4x4_16b_bf16 v[76:79], v[10:11], v[86:87], v[76:79]
    s_mov_b64 exec, -1
    ds_read_b64 v[70:71], v95 offset:65408
    ds_read_b64 v[68:69], v94 offset:65408
    v_bitop3_b32 v92, v16, v5, v99 bitop3:0xea
    v_bitop3_b32 v93, v17, v5, v46 bitop3:0xea
    v_perm_b32 v15, v17, v20, s45
    v_bitop3_b32 v46, v17, 0.5, -0.5 bitop3:0xa8
    v_perm_b32 v14, v16, v20, s44
    v_bitop3_b32 v47, v16, 0.5, -0.5 bitop3:0xa8
    v_bitop3_b32 v15, v6, v15, v46 bitop3:0xca
    v_bitop3_b32 v14, v6, v14, v47 bitop3:0xca
    s_waitcnt lgkmcnt(1)
    v_mfma_f32_4x4x4_16b_bf16 v[80:83], v[10:11], v[70:71], v[80:83]
    s_waitcnt lgkmcnt(0)
    v_mfma_f32_4x4x4_16b_bf16 v[76:79], v[10:11], v[68:69], v[76:79]
    s_nop 2
    v_cvt_pk_bf16_f32 v80, v80, v81
    v_cvt_pk_bf16_f32 v81, v82, v83
    ds_wrxchg_rtn_b64 v[74:75], v95, v[80:81] offset:65408
    v_cvt_pk_bf16_f32 v76, v76, v77
    v_cvt_pk_bf16_f32 v77, v78, v79
    ds_wrxchg_rtn_b64 v[72:73], v94, v[76:77] offset:65408
    v_mfma_f32_4x4x4_16b_bf16 v[80:83], v[8:9], v[102:103], 0
    v_mfma_f32_4x4x4_16b_bf16 v[76:79], v[8:9], v[100:101], 0
    v_cmp_lt_u32 s[84:85], v5, v92
    s_nop 2
    v_pk_mul_f32 v[80:81], v[80:81], v[14:15] op_sel:[0,1] op_sel_hi:[1,1]
    v_pk_mul_f32 v[82:83], v[82:83], v[14:15] op_sel:[0,1] op_sel_hi:[1,1]
    v_pk_mul_f32 v[76:77], v[76:77], v[14:15] op_sel:[0,0] op_sel_hi:[1,0]
    v_pk_mul_f32 v[78:79], v[78:79], v[14:15] op_sel:[0,0] op_sel_hi:[1,0]
    buffer_load_dwordx4 v[108:111], v3, s[16:19], s40 offen offset:0 sc1
    v_and_b32 v46, 0x80000000, v21
    v_lshrrev_b32 v47, 14, v19
    v_bitop3_b32 v47, v47, v5, v46 bitop3:0xea
    ds_read_b64 v[106:107], v47
    v_and_b32 v99, 0x40000000, v21
    v_lshrrev_b32 v47, 14, v18
    v_bitop3_b32 v47, v47, v5, v99 bitop3:0xea
    ds_read_b64 v[104:105], v47
    s_waitcnt lgkmcnt(2)
    v_cmp_ne_u64 s[50:51], v[72:73], v[68:69]
    v_cmpx_ne_u64 s[54:55], v[74:75], v[70:71]
    s_and_b64 s[82:83], s[54:55], s[80:81]
    s_cbranch_scc1 L2_c85
L2_d85:
    v_mov_b64 v[84:85], v[70:71]
    v_mov_b32 v7, v95
    v_mov_b64 v[86:87], v[74:75]
    s_or_b64 s[80:81], s[80:81], s[54:55]
    s_mov_b64 exec, s[50:51]
    s_and_b64 s[82:83], s[50:51], s[80:81]
    s_cbranch_scc1 L2_c86
L2_d86:
    v_mov_b64 v[84:85], v[68:69]
    v_mov_b32 v7, v94
    v_mov_b64 v[86:87], v[72:73]
    s_mov_b64 exec, -1
    s_or_b64 s[80:81], s[80:81], s[50:51]
    s_and_b64 exec, s[84:85], s[80:81]
    v_mfma_f32_4x4x4_16b_bf16 v[76:79], v[12:13], v[84:85], 0
    v_mov_b32 v92, v7
    s_andn2_b64 s[80:81], s[80:81], s[84:85]
    v_mfma_f32_4x4x4_16b_bf16 v[76:79], v[10:11], v[86:87], v[76:79]
    s_mov_b64 exec, -1
    ds_read_b64 v[70:71], v93 offset:65408
    ds_read_b64 v[68:69], v92 offset:65408
    v_bitop3_b32 v94, v18, v5, v99 bitop3:0xea
    v_bitop3_b32 v95, v19, v5, v46 bitop3:0xea
    v_perm_b32 v15, v19, v20, s47
    v_bitop3_b32 v46, v19, 0.5, -0.5 bitop3:0xa8
    v_perm_b32 v14, v18, v20, s46
    v_bitop3_b32 v47, v18, 0.5, -0.5 bitop3:0xa8
    v_bitop3_b32 v15, v6, v15, v46 bitop3:0xca
    v_bitop3_b32 v14, v6, v14, v47 bitop3:0xca
    s_waitcnt lgkmcnt(1)
    v_mfma_f32_4x4x4_16b_bf16 v[80:83], v[10:11], v[70:71], v[80:83]
    s_waitcnt lgkmcnt(0)
    v_mfma_f32_4x4x4_16b_bf16 v[76:79], v[10:11], v[68:69], v[76:79]
    s_nop 2
    v_cvt_pk_bf16_f32 v80, v80, v81
    v_cvt_pk_bf16_f32 v81, v82, v83
    ds_wrxchg_rtn_b64 v[74:75], v93, v[80:81] offset:65408
    v_cvt_pk_bf16_f32 v76, v76, v77
    v_cvt_pk_bf16_f32 v77, v78, v79
    ds_wrxchg_rtn_b64 v[72:73], v92, v[76:77] offset:65408
    v_and_b32 v88, 0x0fffffff, v40
    buffer_load_dwordx2 v[16:17], v88, s[8:11], 0 offen
    buffer_load_dwordx3 v[18:20], v88, s[8:11], 0 offen offset:8
    s_setprio 2
    v_mfma_f32_4x4x4_16b_bf16 v[80:83], v[8:9], v[106:107], 0
    v_mfma_f32_4x4x4_16b_bf16 v[76:79], v[8:9], v[104:105], 0
    v_cmp_lt_u32 s[48:49], v5, v95
    s_nop 2
    v_pk_mul_f32 v[80:81], v[80:81], v[14:15] op_sel:[0,1] op_sel_hi:[1,1]
    v_pk_mul_f32 v[82:83], v[82:83], v[14:15] op_sel:[0,1] op_sel_hi:[1,1]
    v_pk_mul_f32 v[76:77], v[76:77], v[14:15] op_sel:[0,0] op_sel_hi:[1,0]
    v_pk_mul_f32 v[78:79], v[78:79], v[14:15] op_sel:[0,0] op_sel_hi:[1,0]
    s_waitcnt vmcnt(10)
    v_and_b32 v46, 0x20000000, v27
    v_lshrrev_b32 v47, 14, v23
    v_bitop3_b32 v47, v47, v5, v46 bitop3:0xea
    ds_read_b64 v[102:103], v47
    v_and_b32 v99, 0x10000000, v27
    v_lshrrev_b32 v47, 14, v22
    v_bitop3_b32 v47, v47, v5, v99 bitop3:0xea
    ds_read_b64 v[100:101], v47
    s_waitcnt lgkmcnt(2)
    v_cmp_ne_u64 s[50:51], v[72:73], v[68:69]
    v_cmpx_ne_u64 s[54:55], v[74:75], v[70:71]
    s_and_b64 s[82:83], s[54:55], s[80:81]
    s_cbranch_scc1 L2_c87
L2_d87:
    v_mov_b64 v[84:85], v[70:71]
    v_mov_b32 v7, v93
    v_mov_b64 v[86:87], v[74:75]
    s_or_b64 s[80:81], s[80:81], s[54:55]
    s_mov_b64 exec, s[50:51]
    s_and_b64 s[82:83], s[50:51], s[80:81]
    s_cbranch_scc1 L2_c88
L2_d88:
    v_mov_b64 v[84:85], v[68:69]
    v_mov_b32 v7, v92
    v_mov_b64 v[86:87], v[72:73]
    s_mov_b64 exec, -1
    s_or_b64 s[80:81], s[80:81], s[50:51]
    s_and_b64 exec, s[48:49], s[80:81]
    v_mfma_f32_4x4x4_16b_bf16 v[80:83], v[12:13], v[84:85], 0
    v_mov_b32 v95, v7
    s_andn2_b64 s[80:81], s[80:81], s[48:49]
    v_mfma_f32_4x4x4_16b_bf16 v[80:83], v[10:11], v[86:87], v[80:83]
    s_mov_b64 exec, -1
    ds_read_b64 v[70:71], v95 offset:65408
    ds_read_b64 v[68:69], v94 offset:65408
    v_bitop3_b32 v92, v22, v5, v99 bitop3:0xea
    v_bitop3_b32 v93, v23, v5, v46 bitop3:0xea
    v_perm_b32 v15, v23, v26, s45
    v_bitop3_b32 v46, v23, 0.5, -0.5 bitop3:0xa8
    v_perm_b32 v14, v22, v26, s44
    v_bitop3_b32 v47, v22, 0.5, -0.5 bitop3:0xa8
    v_bitop3_b32 v15, v6, v15, v46 bitop3:0xca
    v_bitop3_b32 v14, v6, v14, v47 bitop3:0xca
    s_waitcnt lgkmcnt(1)
    v_mfma_f32_4x4x4_16b_bf16 v[80:83], v[10:11], v[70:71], v[80:83]
    s_waitcnt lgkmcnt(0)
    v_mfma_f32_4x4x4_16b_bf16 v[76:79], v[10:11], v[68:69], v[76:79]
    s_nop 2
    v_cvt_pk_bf16_f32 v80, v80, v81
    v_cvt_pk_bf16_f32 v81, v82, v83
    ds_wrxchg_rtn_b64 v[74:75], v95, v[80:81] offset:65408
    v_cvt_pk_bf16_f32 v76, v76, v77
    v_cvt_pk_bf16_f32 v77, v78, v79
    ds_wrxchg_rtn_b64 v[72:73], v94, v[76:77] offset:65408
    s_setprio 1
    v_mfma_f32_4x4x4_16b_bf16 v[80:83], v[8:9], v[102:103], 0
    v_mfma_f32_4x4x4_16b_bf16 v[76:79], v[8:9], v[100:101], 0
    s_nop 3
    v_pk_mul_f32 v[80:81], v[80:81], v[14:15] op_sel:[0,1] op_sel_hi:[1,1]
    v_pk_mul_f32 v[82:83], v[82:83], v[14:15] op_sel:[0,1] op_sel_hi:[1,1]
    v_pk_mul_f32 v[76:77], v[76:77], v[14:15] op_sel:[0,0] op_sel_hi:[1,0]
    v_pk_mul_f32 v[78:79], v[78:79], v[14:15] op_sel:[0,0] op_sel_hi:[1,0]
    s_bitcmp1_b32 s43, s42
    s_cbranch_scc1 L2_oa89
L2_ob89:
    buffer_load_dwordx4 v[112:115], v3, s[16:19], s40 offen offset:1024 sc1
    v_sub_u16 v88, v60, v52
    v_and_b32 v89, 3, v52
    v_add3_u32 v99, v88, v89, 3
    v_and_b32 v99, -4, v99
    v_max_u32 v99, 4, v99
    v_and_b32 v97, 0xfffc, v52
    v_bfm_b32 v96, v88, v89
    v_add_u32_dpp v91, v99, v99 row_shr:1 row_mask:0xf bank_mask:0xf bound_ctrl:1
    v_mad_u32_u24 v97, v97, 5, v2
    v_cmp_lt_u32 vcc, 16, v99
    v_add_u32_dpp v91, v91, v91 row_shr:2 row_mask:0xf bank_mask:0xf bound_ctrl:1
    v_sub_u32 v98, s38, v99
    v_lshrrev_b64 v[52:53], 16, v[52:53]
    v_add_u32_dpp v91, v91, v91 row_shr:4 row_mask:0xf bank_mask:0xf bound_ctrl:1
    v_lshrrev_b64 v[60:61], 16, v[60:61]
    s_mov_b32 s101, 0
    v_add_u32_dpp v91, v91, v91 row_shr:8 row_mask:0xf bank_mask:0xf bound_ctrl:1
    s_nop 1
    v_add_u32_dpp v91, v91, v91 row_bcast:15 row_mask:0xa bank_mask:0xf
    s_nop 1
    v_add_u32_dpp v91, v91, v91 row_bcast:31 row_mask:0xc bank_mask:0xf
    v_add_u32 v98, v98, v91
    v_readlane_b32 s37, v91, 63
    s_cbranch_vccnz L2_xo90
L2_xp90:
    v_and_b32 v46, 0x80000000, v27
    v_lshrrev_b32 v47, 14, v25
    v_bitop3_b32 v47, v47, v5, v46 bitop3:0xea
    ds_read_b64 v[106:107], v47
    v_and_b32 v99, 0x40000000, v27
    v_lshrrev_b32 v47, 14, v24
    v_bitop3_b32 v47, v47, v5, v99 bitop3:0xea
    ds_read_b64 v[104:105], v47
    s_waitcnt lgkmcnt(2)
    v_cmp_ne_u64 s[50:51], v[72:73], v[68:69]
    v_cmpx_ne_u64 s[54:55], v[74:75], v[70:71]
    s_and_b64 s[82:83], s[54:55], s[80:81]
    s_cbranch_scc1 L2_c91
L2_d91:
    v_mov_b64 v[84:85], v[70:71]
    v_mov_b32 v7, v95
    v_mov_b64 v[86:87], v[74:75]
    s_or_b64 s[80:81], s[80:81], s[54:55]
    s_mov_b64 exec, s[50:51]
    s_and_b64 s[82:83], s[50:51], s[80:81]
    s_cbranch_scc1 L2_c92
L2_d92:
    v_mov_b64 v[84:85], v[68:69]
    v_mov_b32 v7, v94
    v_mov_b64 v[86:87], v[72:73]
    s_mov_b64 exec, -1
    s_or_b64 s[80:81], s[80:81], s[50:51]
    ds_read_b64 v[70:71], v93 offset:65408
    ds_read_b64 v[68:69], v92 offset:65408
    v_bitop3_b32 v94, v24, v5, v99 bitop3:0xea
    v_bitop3_b32 v95, v25, v5, v46 bitop3:0xea
    v_perm_b32 v15, v25, v26, s47
    v_bitop3_b32 v46, v25, 0.5, -0.5 bitop3:0xa8
    v_perm_b32 v14, v24, v26, s46
    v_bitop3_b32 v47, v24, 0.5, -0.5 bitop3:0xa8
    v_bitop3_b32 v15, v6, v15, v46 bitop3:0xca
    v_bitop3_b32 v14, v6, v14, v47 bitop3:0xca
    s_waitcnt lgkmcnt(1)
    v_mfma_f32_4x4x4_16b_bf16 v[80:83], v[10:11], v[70:71], v[80:83]
    s_waitcnt lgkmcnt(0)
    v_mfma_f32_4x4x4_16b_bf16 v[76:79], v[10:11], v[68:69], v[76:79]
    s_nop 2
    v_cvt_pk_bf16_f32 v80, v80, v81
    v_cvt_pk_bf16_f32 v81, v82, v83
    ds_wrxchg_rtn_b64 v[74:75], v93, v[80:81] offset:65408
    v_cvt_pk_bf16_f32 v76, v76, v77
    v_cvt_pk_bf16_f32 v77, v78, v79
    ds_wrxchg_rtn_b64 v[72:73], v92, v[76:77] offset:65408
    v_and_b32 v88, 0x0fffffff, v41
    buffer_load_dwordx2 v[22:23], v88, s[8:11], 0 offen
    buffer_load_dwordx3 v[24:26], v88, s[8:11], 0 offen offset:8
    v_mfma_f32_4x4x4_16b_bf16 v[80:83], v[8:9], v[106:107], 0
    v_mfma_f32_4x4x4_16b_bf16 v[76:79], v[8:9], v[104:105], 0
    v_cmp_lt_u32 s[84:85], v5, v94
    s_nop 2
    v_pk_mul_f32 v[80:81], v[80:81], v[14:15] op_sel:[0,1] op_sel_hi:[1,1]
    v_pk_mul_f32 v[82:83], v[82:83], v[14:15] op_sel:[0,1] op_sel_hi:[1,1]
    v_pk_mul_f32 v[76:77], v[76:77], v[14:15] op_sel:[0,0] op_sel_hi:[1,0]
    v_pk_mul_f32 v[78:79], v[78:79], v[14:15] op_sel:[0,0] op_sel_hi:[1,0]
    s_waitcnt vmcnt(11)
    s_mov_b64 exec, s[6:7]
    v_lshrrev_b32 v30, 16, v30
    s_mov_b64 exec, -1
    v_and_b32 v46, 0x20000000, v31
    v_lshrrev_b32 v47, 14, v29
    v_bitop3_b32 v47, v47, v5, v46 bitop3:0xea
    ds_read_b64 v[102:103], v47
    v_and_b32 v99, 0x10000000, v31
    v_lshrrev_b32 v47, 14, v28
    v_bitop3_b32 v47, v47, v5, v99 bitop3:0xea
    ds_read_b64 v[100:101], v47
    s_waitcnt lgkmcnt(2)
    v_cmp_ne_u64 s[50:51], v[72:73], v[68:69]
    v_cmpx_ne_u64 s[54:55], v[74:75], v[70:71]
    s_and_b64 s[82:83], s[54:55], s[80:81]
    s_cbranch_scc1 L2_c93
L2_d93:
    v_mov_b64 v[84:85], v[70:71]
    v_mov_b32 v7, v93
    v_mov_b64 v[86:87], v[74:75]
    s_or_b64 s[80:81], s[80:81], s[54:55]
    s_mov_b64 exec, s[50:51]
    s_and_b64 s[82:83], s[50:51], s[80:81]
    s_cbranch_scc1 L2_c94
L2_d94:
    v_mov_b64 v[84:85], v[68:69]
    v_mov_b32 v7, v92
    v_mov_b64 v[86:87], v[72:73]
    s_mov_b64 exec, -1
    s_or_b64 s[80:81], s[80:81], s[50:51]
    s_and_b64 exec, s[84:85], s[80:81]
    v_mfma_f32_4x4x4_16b_bf16 v[76:79], v[12:13], v[84:85], 0
    v_mov_b32 v94, v7
    s_andn2_b64 s[80:81], s[80:81], s[84:85]
    v_mfma_f32_4x4x4_16b_bf16 v[76:79], v[10:11], v[86:87], v[76:79]
    s_mov_b64 exec, -1
    ds_read_b64 v[70:71], v95 offset:65408
    ds_read_b64 v[68:69], v94 offset:65408
    v_bitop3_b32 v92, v28, v5, v99 bitop3:0xea
    v_bitop3_b32 v93, v29, v5, v46 bitop3:0xea
    v_perm_b32 v15, v29, v30, s45
    v_bitop3_b32 v46, v29, 0.5, -0.5 bitop3:0xa8
    v_perm_b32 v14, v28, v30, s44
    v_bitop3_b32 v47, v28, 0.5, -0.5 bitop3:0xa8
    v_bitop3_b32 v15, v6, v15, v46 bitop3:0xca
    v_bitop3_b32 v14, v6, v14, v47 bitop3:0xca
    s_waitcnt lgkmcnt(1)
    v_mfma_f32_4x4x4_16b_bf16 v[80:83], v[10:11], v[70:71], v[80:83]
    s_waitcnt lgkmcnt(0)
    v_mfma_f32_4x4x4_16b_bf16 v[76:79], v[10:11], v[68:69], v[76:79]
    s_nop 2
    v_cvt_pk_bf16_f32 v80, v80, v81
    v_cvt_pk_bf16_f32 v81, v82, v83
    ds_wrxchg_rtn_b64 v[74:75], v95, v[80:81] offset:65408
    v_cvt_pk_bf16_f32 v76, v76, v77
    v_cvt_pk_bf16_f32 v77, v78, v79
    ds_wrxchg_rtn_b64 v[72:73], v94, v[76:77] offset:65408
    s_setprio 0
    v_mfma_f32_4x4x4_16b_bf16 v[80:83], v[8:9], v[102:103], 0
    v_mfma_f32_4x4x4_16b_bf16 v[76:79], v[8:9], v[100:101], 0
    v_cmp_lt_u32 s[48:49], v5, v93
    s_nop 2
    v_pk_mul_f32 v[80:81], v[80:81], v[14:15] op_sel:[0,1] op_sel_hi:[1,1]
    v_pk_mul_f32 v[82:83], v[82:83], v[14:15] op_sel:[0,1] op_sel_hi:[1,1]
    v_pk_mul_f32 v[76:77], v[76:77], v[14:15] op_sel:[0,0] op_sel_hi:[1,0]
    v_pk_mul_f32 v[78:79], v[78:79], v[14:15] op_sel:[0,0] op_sel_hi:[1,0]
    s_add_u32 s40, s40, 0x50000
    v_and_b32 v47, 0x0fffffff, v42
    buffer_load_dword v30, v47, s[8:11], 0 offen offset:16
    s_mov_b64 exec, s[6:7]
    v_add_u32 v47, 8, v47
    v_lshrrev_b32 v42, 2, v42
    s_mov_b64 exec, -1
    buffer_load_dwordx2 v[28:29], v47, s[8:11], 0 offen
    s_waitcnt vmcnt(8)
    v_and_b32 v46, 0x80000000, v39
    v_lshrrev_b32 v47, 14, v37
    v_bitop3_b32 v47, v47, v5, v46 bitop3:0xea
    ds_read_b64 v[102:103], v47
    v_and_b32 v99, 0x40000000, v39
    v_lshrrev_b32 v47, 14, v36
    v_bitop3_b32 v47, v47, v5, v99 bitop3:0xea
    ds_read_b64 v[100:101], v47
    v_and_b32 v46, 0x20000000, v39
    v_lshrrev_b32 v47, 14, v35
    v_bitop3_b32 v47, v47, v5, v46 bitop3:0xea
    ds_read_b64 v[106:107], v47
    v_and_b32 v99, 0x10000000, v39
    v_lshrrev_b32 v47, 14, v34
    v_bitop3_b32 v47, v47, v5, v99 bitop3:0xea
    ds_read_b64 v[104:105], v47
    s_waitcnt lgkmcnt(4)
    v_cmp_ne_u64 s[50:51], v[72:73], v[68:69]
    v_cmpx_ne_u64 s[54:55], v[74:75], v[70:71]
    s_and_b64 s[82:83], s[54:55], s[80:81]
    s_cbranch_scc1 L2_c95
L2_d95:
    v_mov_b64 v[84:85], v[70:71]
    v_mov_b32 v7, v95
    v_mov_b64 v[86:87], v[74:75]
    s_or_b64 s[80:81], s[80:81], s[54:55]
    s_mov_b64 exec, s[50:51]
    s_and_b64 s[82:83], s[50:51], s[80:81]
    s_cbranch_scc1 L2_c96
L2_d96:
    v_mov_b64 v[84:85], v[68:69]
    v_mov_b32 v7, v94
    v_mov_b64 v[86:87], v[72:73]
    s_mov_b64 exec, -1
    s_or_b64 s[80:81], s[80:81], s[50:51]
    s_and_b64 exec, s[48:49], s[80:81]
    v_mfma_f32_4x4x4_16b_bf16 v[80:83], v[12:13], v[84:85], 0
    v_mov_b32 v93, v7
    s_andn2_b64 s[80:81], s[80:81], s[48:49]
    v_mfma_f32_4x4x4_16b_bf16 v[80:83], v[10:11], v[86:87], v[80:83]
    s_mov_b64 exec, -1
    ds_read_b64 v[70:71], v93 offset:65408
    ds_read_b64 v[68:69], v92 offset:65408
    v_bitop3_b32 v94, v34, v5, v99 bitop3:0xea
    v_bitop3_b32 v95, v35, v5, v46 bitop3:0xea
    v_perm_b32 v15, v35, v38, s45
    v_bitop3_b32 v46, v35, 0.5, -0.5 bitop3:0xa8
    v_perm_b32 v14, v34, v38, s44
    v_bitop3_b32 v47, v34, 0.5, -0.5 bitop3:0xa8
    v_bitop3_b32 v15, v6, v15, v46 bitop3:0xca
    v_bitop3_b32 v14, v6, v14, v47 bitop3:0xca
    s_waitcnt lgkmcnt(1)
    v_mfma_f32_4x4x4_16b_bf16 v[80:83], v[10:11], v[70:71], v[80:83]
    s_waitcnt lgkmcnt(0)
    v_mfma_f32_4x4x4_16b_bf16 v[76:79], v[10:11], v[68:69], v[76:79]
    s_nop 2
    v_cvt_pk_bf16_f32 v80, v80, v81
    v_cvt_pk_bf16_f32 v81, v82, v83
    ds_wrxchg_rtn_b64 v[74:75], v93, v[80:81] offset:65408
    v_cvt_pk_bf16_f32 v76, v76, v77
    v_cvt_pk_bf16_f32 v77, v78, v79
    ds_wrxchg_rtn_b64 v[72:73], v92, v[76:77] offset:65408
    s_barrier
    s_setprio 3
    s_mov_b32 m0, s100
    s_nop 0
    ds_write_addtid_b32 v124 offset:34816
    ds_write_addtid_b32 v125 offset:35072
    ds_write_addtid_b32 v126 offset:35328
    ds_write_addtid_b32 v127 offset:35584
    s_add_u32 s3, s40, 4096
    buffer_load_dwordx4 v[124:127], v3, s[16:19], s3 offen sc1
    ds_write_addtid_b32 v116 offset:32768
    ds_write_addtid_b32 v117 offset:33024
    ds_write_addtid_b32 v118 offset:33280
    ds_write_addtid_b32 v119 offset:33536
    buffer_load_dwordx4 v[116:119], v3, s[16:19], s40 offen offset:2048 sc1
    ds_write_addtid_b32 v120 offset:33792
    ds_write_addtid_b32 v121 offset:34048
    ds_write_addtid_b32 v122 offset:34304
    ds_write_addtid_b32 v123 offset:34560
    buffer_load_dwordx4 v[120:123], v3, s[16:19], s40 offen offset:3072 sc1
    v_mfma_f32_4x4x4_16b_bf16 v[80:83], v[8:9], v[106:107], 0
    v_mfma_f32_4x4x4_16b_bf16 v[76:79], v[8:9], v[104:105], 0
    s_nop 3
    v_pk_mul_f32 v[80:81], v[80:81], v[14:15] op_sel:[0,1] op_sel_hi:[1,1]
    v_pk_mul_f32 v[82:83], v[82:83], v[14:15] op_sel:[0,1] op_sel_hi:[1,1]
    v_pk_mul_f32 v[76:77], v[76:77], v[14:15] op_sel:[0,0] op_sel_hi:[1,0]
    v_pk_mul_f32 v[78:79], v[78:79], v[14:15] op_sel:[0,0] op_sel_hi:[1,0]
    s_cmp_gt_u32 s37, 1024
    s_cbranch_scc1 L2_xs97
    s_cmp_lg_u32 s101, 0
    s_cbranch_scc1 L2_xa97
L2_xb97:
    v_lshlrev_b32 v89, 16, v96
    v_add_u32 v90, 60, v97
    v_bitop3_b32 v90, v89, v45, v90 bitop3:0x6a
    ds_write_b32 v98, v90 offset:12
    v_lshlrev_b32 v89, 20, v96
    v_add_u32 v90, 40, v97
    v_bitop3_b32 v90, v89, v45, v90 bitop3:0x6a
    ds_write_b32 v98, v90 offset:8
    v_lshlrev_b32 v89, 24, v96
    v_add_u32 v90, 20, v97
    v_bitop3_b32 v90, v89, v45, v90 bitop3:0x6a
    ds_write_b32 v98, v90 offset:4
    v_lshlrev_b32 v89, 28, v96
    v_bitop3_b32 v90, v89, v45, v97 bitop3:0x6a
    ds_write_b32 v98, v90 offset:0
    v_mov_b32_dpp v91, v64 quad_perm:[1,1,1,1] row_mask:0xf bank_mask:0xf
    v_and_b32 v89, 3, v91
    v_and_b32 v97, 0xfffc, v91
    v_sub_u16_dpp v88, v64, v91 quad_perm:[3,3,3,3] row_mask:0xf bank_mask:0xf
    v_mad_u32_u24 v97, v97, 5, v4
    v_add_u32 v99, v88, v89
    v_bfm_b32 v96, v88, v89
    v_cmp_lt_u32 s[58:59], 16, v99
    v_lshlrev_b32 v89, v1, v96
    v_and_b32 v89, v45, v89
    v_cmp_ne_u32 vcc, 0, v89
    v_xor_b32 v90, v97, v89
    s_add_u32 s3, s37, s38
    v_mbcnt_lo_u32_b32 v98, vcc_lo, 0
    v_mbcnt_hi_u32_b32 v98, vcc_hi, v98
    s_bcnt1_i32_b64 s41, vcc
    v_lshl_add_u32 v98, v98, 2, s3
    s_lshl2_add_u32 s37, s41, s37
    s_mov_b64 exec, vcc
    ds_write_b32 v98, v90
    s_mov_b64 exec, -1
    s_cmp_lg_u64 s[58:59], 0
    s_cbranch_scc1 L2_xe97
L2_xr97:
    v_add_u32 v98, s37, v0
    v_mov_b32 v90, -1
    ds_write_b32 v98, v90
L2_xw97:
    s_setprio 2
    s_waitcnt lgkmcnt(14)
    v_cmp_ne_u64 s[50:51], v[72:73], v[68:69]
    v_cmpx_ne_u64 s[54:55], v[74:75], v[70:71]
    s_and_b64 s[82:83], s[54:55], s[80:81]
    s_cbranch_scc1 L2_c98
L2_d98:
    v_mov_b64 v[84:85], v[70:71]
    v_mov_b32 v7, v93
    v_mov_b64 v[86:87], v[74:75]
    s_or_b64 s[80:81], s[80:81], s[54:55]
    s_mov_b64 exec, s[50:51]
    s_and_b64 s[82:83], s[50:51], s[80:81]
    s_cbranch_scc1 L2_c99
L2_d99:
    v_mov_b64 v[84:85], v[68:69]
    v_mov_b32 v7, v92
    v_mov_b64 v[86:87], v[72:73]
    s_mov_b64 exec, -1
    s_or_b64 s[80:81], s[80:81], s[50:51]
    ds_read_b64 v[70:71], v95 offset:65408
    ds_read_b64 v[68:69], v94 offset:65408
    v_and_b32 v46, 0x40000000, v39
    v_bitop3_b32 v92, v36, v5, v46 bitop3:0xea
    v_and_b32 v46, 0x80000000, v39
    v_bitop3_b32 v93, v37, v5, v46 bitop3:0xea
    v_perm_b32 v15, v37, v38, s47
    v_bitop3_b32 v46, v37, 0.5, -0.5 bitop3:0xa8
    v_perm_b32 v14, v36, v38, s46
    v_bitop3_b32 v47, v36, 0.5, -0.5 bitop3:0xa8
    v_bitop3_b32 v15, v6, v15, v46 bitop3:0xca
    v_bitop3_b32 v14, v6, v14, v47 bitop3:0xca
    s_setprio 1
    s_waitcnt lgkmcnt(1)
    v_mfma_f32_4x4x4_16b_bf16 v[80:83], v[10:11], v[70:71], v[80:83]
    s_waitcnt lgkmcnt(0)
    v_mfma_f32_4x4x4_16b_bf16 v[76:79], v[10:11], v[68:69], v[76:79]
    s_nop 2
    v_cvt_pk_bf16_f32 v80, v80, v81
    v_cvt_pk_bf16_f32 v81, v82, v83
    ds_wrxchg_rtn_b64 v[74:75], v95, v[80:81] offset:65408
    v_cvt_pk_bf16_f32 v76, v76, v77
    v_cvt_pk_bf16_f32 v77, v78, v79
    ds_wrxchg_rtn_b64 v[72:73], v94, v[76:77] offset:65408
    ds_read_b32 v21, v0 offset:0
    ds_read_b32 v27, v0 offset:256
    ds_read_b32 v31, v44 offset:768
    ds_read_b32 v39, v0 offset:512
    s_sub_u32 s3, s37, 768
    s_cmp_gt_u32 s3, 128
    s_cbranch_scc1 L2_xf97
L2_xg97:
    v_and_b32 v88, 0x0fffffff, v43
    buffer_load_dwordx2 v[34:35], v88, s[8:11], 0 offen
    buffer_load_dwordx3 v[36:38], v88, s[8:11], 0 offen offset:8
    s_setprio 0
    s_waitcnt vmcnt(12)
    s_mov_b32 m0, s38
    s_nop 0
    ds_write_addtid_b32 v108 offset:0
    ds_write_addtid_b32 v109 offset:256
    ds_write_addtid_b32 v110 offset:512
    ds_write_addtid_b32 v111 offset:768
    s_waitcnt vmcnt(9)
    ds_write_addtid_b32 v112 offset:1024
    ds_write_addtid_b32 v113 offset:1280
    ds_write_addtid_b32 v114 offset:1536
    ds_write_addtid_b32 v115 offset:1792
    v_mfma_f32_4x4x4_16b_bf16 v[80:83], v[8:9], v[102:103], 0
    v_mfma_f32_4x4x4_16b_bf16 v[76:79], v[8:9], v[100:101], 0
    v_cmp_lt_u32 s[84:85], v5, v92
    s_nop 2
    v_pk_mul_f32 v[80:81], v[80:81], v[14:15] op_sel:[0,1] op_sel_hi:[1,1]
    v_pk_mul_f32 v[82:83], v[82:83], v[14:15] op_sel:[0,1] op_sel_hi:[1,1]
    v_pk_mul_f32 v[76:77], v[76:77], v[14:15] op_sel:[0,0] op_sel_hi:[1,0]
    v_pk_mul_f32 v[78:79], v[78:79], v[14:15] op_sel:[0,0] op_sel_hi:[1,0]
    s_add_u32 s42, s42, 1
    s_waitcnt lgkmcnt(0)
    s_barrier
    s_bitcmp1_b32 s36, s42
    s_cbranch_scc1 L2_slow
L2_ret5:
    s_setprio 3
    s_bitcmp1_b32 s43, s42
    s_cbranch_scc1 L2_oa100
L2_ob100:
    v_and_b32 v46, 0x20000000, v40
    v_lshrrev_b32 v47, 14, v17
    v_bitop3_b32 v47, v47, v5, v46 bitop3:0xea
    ds_read_b64 v[106:107], v47
    v_and_b32 v99, 0x10000000, v40
    v_lshrrev_b32 v47, 14, v16
    v_bitop3_b32 v47, v47, v5, v99 bitop3:0xea
    ds_read_b64 v[104:105], v47
    v_cmp_ne_u64 s[50:51], v[72:73], v[68:69]
    v_cmpx_ne_u64 s[54:55], v[74:75], v[70:71]
    s_and_b64 s[82:83], s[54:55], s[80:81]
    s_cbranch_scc1 L2_c101
L2_d101:
    v_mov_b64 v[84:85], v[70:71]
    v_mov_b32 v7, v95
    v_mov_b64 v[86:87], v[74:75]
    s_or_b64 s[80:81], s[80:81], s[54:55]
    s_mov_b64 exec, s[50:51]
    s_and_b64 s[82:83], s[50:51], s[80:81]
    s_cbranch_scc1 L2_c102
L2_d102:
    v_mov_b64 v[84:85], v[68:69]
    v_mov_b32 v7, v94
    v_mov_b64 v[86:87], v[72:73]
    s_mov_b64 exec, -1
    s_or_b64 s[80:81], s[80:81], s[50:51]
    s_and_b64 exec, s[84:85], s[80:81]
    v_mfma_f32_4x4x4_16b_bf16 v[76:79], v[12:13], v[84:85], 0
    v_mov_b32 v92, v7
    s_andn2_b64 s[80:81], s[80:81], s[84:85]
    v_mfma_f32_4x4x4_16b_bf16 v[76:79], v[10:11], v[86:87], v[76:79]
    s_mov_b64 exec, -1
    ds_read_b64 v[70:71], v93 offset:65408
    ds_read_b64 v[68:69], v92 offset:65408
    v_bitop3_b32 v94, v16, v5, v99 bitop3:0xea
    v_bitop3_b32 v95, v17, v5, v46 bitop3:0xea
    v_perm_b32 v15, v17, v20, s45
    v_bitop3_b32 v46, v17, 0.5, -0.5 bitop3:0xa8
    v_perm_b32 v14, v16, v20, s44
    v_bitop3_b32 v47, v16, 0.5, -0.5 bitop3:0xa8
    v_bitop3_b32 v15, v6, v15, v46 bitop3:0xca
    v_bitop3_b32 v14, v6, v14, v47 bitop3:0xca
    s_waitcnt lgkmcnt(1)
    v_mfma_f32_4x4x4_16b_bf16 v[80:83], v[10:11], v[70:71], v[80:83]
    s_waitcnt lgkmcnt(0)
    v_mfma_f32_4x4x4_16b_bf16 v[76:79], v[10:11], v[68:69], v[76:79]
    s_nop 2
    v_cvt_pk_bf16_f32 v80, v80, v81
    v_cvt_pk_bf16_f32 v81, v82, v83
    ds_wrxchg_rtn_b64 v[74:75], v93, v[80:81] offset:65408
    v_cvt_pk_bf16_f32 v76, v76, v77
    v_cvt_pk_bf16_f32 v77, v78, v79
    ds_wrxchg_rtn_b64 v[72:73], v92, v[76:77] offset:65408
    v_mfma_f32_4x4x4_16b_bf16 v[80:83], v[8:9], v[106:107], 0
    v_mfma_f32_4x4x4_16b_bf16 v[76:79], v[8:9], v[104:105], 0
    v_cmp_lt_u32 s[84:85], v5, v94
    s_nop 2
    v_pk_mul_f32 v[80:81], v[80:81], v[14:15] op_sel:[0,1] op_sel_hi:[1,1]
    v_pk_mul_f32 v[82:83], v[82:83], v[14:15] op_sel:[0,1] op_sel_hi:[1,1]
    v_pk_mul_f32 v[76:77], v[76:77], v[14:15] op_sel:[0,0] op_sel_hi:[1,0]
    v_pk_mul_f32 v[78:79], v[78:79], v[14:15] op_sel:[0,0] op_sel_hi:[1,0]
    buffer_load_dwordx4 v[108:111], v3, s[16:19], s40 offen offset:0 sc1
    v_and_b32 v46, 0x80000000, v40
    v_lshrrev_b32 v47, 14, v19
    v_bitop3_b32 v47, v47, v5, v46 bitop3:0xea
    ds_read_b64 v[102:103], v47
    v_and_b32 v99, 0x40000000, v40
    v_lshrrev_b32 v47, 14, v18
    v_bitop3_b32 v47, v47, v5, v99 bitop3:0xea
    ds_read_b64 v[100:101], v47
    s_waitcnt lgkmcnt(2)
    v_cmp_ne_u64 s[50:51], v[72:73], v[68:69]
    v_cmpx_ne_u64 s[54:55], v[74:75], v[70:71]
    s_and_b64 s[82:83], s[54:55], s[80:81]
    s_cbranch_scc1 L2_c103
L2_d103:
    v_mov_b64 v[84:85], v[70:71]
    v_mov_b32 v7, v93
    v_mov_b64 v[86:87], v[74:75]
    s_or_b64 s[80:81], s[80:81], s[54:55]
    s_mov_b64 exec, s[50:51]
    s_and_b64 s[82:83], s[50:51], s[80:81]
    s_cbranch_scc1 L2_c104
L2_d104:
    v_mov_b64 v[84:85], v[68:69]
    v_mov_b32 v7, v92
    v_mov_b64 v[86:87], v[72:73]
    s_mov_b64 exec, -1
    s_or_b64 s[80:81], s[80:81], s[50:51]
    s_and_b64 exec, s[84:85], s[80:81]
    v_mfma_f32_4x4x4_16b_bf16 v[76:79], v[12:13], v[84:85], 0
    v_mov_b32 v94, v7
    s_andn2_b64 s[80:81], s[80:81], s[84:85]
    v_mfma_f32_4x4x4_16b_bf16 v[76:79], v[10:11], v[86:87], v[76:79]
    s_mov_b64 exec, -1
    ds_read_b64 v[70:71], v95 offset:65408
    ds_read_b64 v[68:69], v94 offset:65408
    v_bitop3_b32 v92, v18, v5, v99 bitop3:0xea
    v_bitop3_b32 v93, v19, v5, v46 bitop3:0xea
    v_perm_b32 v15, v19, v20, s47
    v_bitop3_b32 v46, v19, 0.5, -0.5 bitop3:0xa8
    v_perm_b32 v14, v18, v20, s46
    v_bitop3_b32 v47, v18, 0.5, -0.5 bitop3:0xa8
    v_bitop3_b32 v15, v6, v15, v46 bitop3:0xca
    v_bitop3_b32 v14, v6, v14, v47 bitop3:0xca
    s_waitcnt lgkmcnt(1)
    v_mfma_f32_4x4x4_16b_bf16 v[80:83], v[10:11], v[70:71], v[80:83]
    s_waitcnt lgkmcnt(0)
    v_mfma_f32_4x4x4_16b_bf16 v[76:79], v[10:11], v[68:69], v[76:79]
    s_nop 2
    v_cvt_pk_bf16_f32 v80, v80, v81
    v_cvt_pk_bf16_f32 v81, v82, v83
    ds_wrxchg_rtn_b64 v[74:75], v95, v[80:81] offset:65408
    v_cvt_pk_bf16_f32 v76, v76, v77
    v_cvt_pk_bf16_f32 v77, v78, v79
    ds_wrxchg_rtn_b64 v[72:73], v94, v[76:77] offset:65408
    v_and_b32 v88, 0x0fffffff, v21
    buffer_load_dwordx2 v[16:17], v88, s[8:11], 0 offen
    buffer_load_dwordx3 v[18:20], v88, s[8:11], 0 offen offset:8
    s_setprio 2
    v_mfma_f32_4x4x4_16b_bf16 v[80:83], v[8:9], v[102:103], 0
    v_mfma_f32_4x4x4_16b_bf16 v[76:79], v[8:9], v[100:101], 0
    v_cmp_lt_u32 s[48:49], v5, v93
    s_nop 2
    v_pk_mul_f32 v[80:81], v[80:81], v[14:15] op_sel:[0,1] op_sel_hi:[1,1]
    v_pk_mul_f32 v[82:83], v[82:83], v[14:15] op_sel:[0,1] op_sel_hi:[1,1]
    v_pk_mul_f32 v[76:77], v[76:77], v[14:15] op_sel:[0,0] op_sel_hi:[1,0]
    v_pk_mul_f32 v[78:79], v[78:79], v[14:15] op_sel:[0,0] op_sel_hi:[1,0]
    s_waitcnt vmcnt(10)
    v_and_b32 v46, 0x20000000, v41
    v_lshrrev_b32 v47, 14, v23
    v_bitop3_b32 v47, v47, v5, v46 bitop3:0xea
    ds_read_b64 v[106:107], v47
    v_and_b32 v99, 0x10000000, v41
    v_lshrrev_b32 v47, 14, v22
    v_bitop3_b32 v47, v47, v5, v99 bitop3:0xea
    ds_read_b64 v[104:105], v47
    s_waitcnt lgkmcnt(2)
    v_cmp_ne_u64 s[50:51], v[72:73], v[68:69]
    v_cmpx_ne_u64 s[54:55], v[74:75], v[70:71]
    s_and_b64 s[82:83], s[54:55], s[80:81]
    s_cbranch_scc1 L2_c105
L2_d105:
    v_mov_b64 v[84:85], v[70:71]
    v_mov_b32 v7, v95
    v_mov_b64 v[86:87], v[74:75]
    s_or_b64 s[80:81], s[80:81], s[54:55]
    s_mov_b64 exec, s[50:51]
    s_and_b64 s[82:83], s[50:51], s[80:81]
    s_cbranch_scc1 L2_c106
L2_d106:
    v_mov_b64 v[84:85], v[68:69]
    v_mov_b32 v7, v94
    v_mov_b64 v[86:87], v[72:73]
    s_mov_b64 exec, -1
    s_or_b64 s[80:81], s[80:81], s[50:51]
    s_and_b64 exec, s[48:49], s[80:81]
    v_mfma_f32_4x4x4_16b_bf16 v[80:83], v[12:13], v[84:85], 0
    v_mov_b32 v93, v7
    s_andn2_b64 s[80:81], s[80:81], s[48:49]
    v_mfma_f32_4x4x4_16b_bf16 v[80:83], v[10:11], v[86:87], v[80:83]
    s_mov_b64 exec, -1
    ds_read_b64 v[70:71], v93 offset:65408
    ds_read_b64 v[68:69], v92 offset:65408
    v_bitop3_b32 v94, v22, v5, v99 bitop3:0xea
    v_bitop3_b32 v95, v23, v5, v46 bitop3:0xea
    v_perm_b32 v15, v23, v26, s45
    v_bitop3_b32 v46, v23, 0.5, -0.5 bitop3:0xa8
    v_perm_b32 v14, v22, v26, s44
    v_bitop3_b32 v47, v22, 0.5, -0.5 bitop3:0xa8
    v_bitop3_b32 v15, v6, v15, v46 bitop3:0xca
    v_bitop3_b32 v14, v6, v14, v47 bitop3:0xca
    s_waitcnt lgkmcnt(1)
    v_mfma_f32_4x4x4_16b_bf16 v[80:83], v[10:11], v[70:71], v[80:83]
    s_waitcnt lgkmcnt(0)
    v_mfma_f32_4x4x4_16b_bf16 v[76:79], v[10:11], v[68:69], v[76:79]
    s_nop 2
    v_cvt_pk_bf16_f32 v80, v80, v81
    v_cvt_pk_bf16_f32 v81, v82, v83
    ds_wrxchg_rtn_b64 v[74:75], v93, v[80:81] offset:65408
    v_cvt_pk_bf16_f32 v76, v76, v77
    v_cvt_pk_bf16_f32 v77, v78, v79
    ds_wrxchg_rtn_b64 v[72:73], v92, v[76:77] offset:65408
    s_setprio 1
    v_mfma_f32_4x4x4_16b_bf16 v[80:83], v[8:9], v[106:107], 0
    v_mfma_f32_4x4x4_16b_bf16 v[76:79], v[8:9], v[104:105], 0
    s_nop 3
    v_pk_mul_f32 v[80:81], v[80:81], v[14:15] op_sel:[0,1] op_sel_hi:[1,1]
    v_pk_mul_f32 v[82:83], v[82:83], v[14:15] op_sel:[0,1] op_sel_hi:[1,1]
    v_pk_mul_f32 v[76:77], v[76:77], v[14:15] op_sel:[0,0] op_sel_hi:[1,0]
    v_pk_mul_f32 v[78:79], v[78:79], v[14:15] op_sel:[0,0] op_sel_hi:[1,0]
    s_bitcmp1_b32 s43, s42
    s_cbranch_scc1 L2_oa107
L2_ob107:
    buffer_load_dwordx4 v[112:115], v3, s[16:19], s40 offen offset:1024 sc1
    v_sub_u16 v88, v62, v54
    v_and_b32 v89, 3, v54
    v_add3_u32 v99, v88, v89, 3
    v_and_b32 v99, -4, v99
    v_max_u32 v99, 4, v99
    v_and_b32 v97, 0xfffc, v54
    v_bfm_b32 v96, v88, v89
    v_add_u32_dpp v91, v99, v99 row_shr:1 row_mask:0xf bank_mask:0xf bound_ctrl:1
    v_mad_u32_u24 v97, v97, 5, v2
    v_cmp_lt_u32 vcc, 16, v99
    v_add_u32_dpp v91, v91, v91 row_shr:2 row_mask:0xf bank_mask:0xf bound_ctrl:1
    v_sub_u32 v98, s38, v99
    v_lshrrev_b64 v[54:55], 16, v[54:55]
    v_add_u32_dpp v91, v91, v91 row_shr:4 row_mask:0xf bank_mask:0xf bound_ctrl:1
    v_lshrrev_b64 v[62:63], 16, v[62:63]
    s_mov_b32 s101, 0
    v_add_u32_dpp v91, v91, v91 row_shr:8 row_mask:0xf bank_mask:0xf bound_ctrl:1
    s_nop 1
    v_add_u32_dpp v91, v91, v91 row_bcast:15 row_mask:0xa bank_mask:0xf
    s_nop 1
    v_add_u32_dpp v91, v91, v91 row_bcast:31 row_mask:0xc bank_mask:0xf
    v_add_u32 v98, v98, v91
    v_readlane_b32 s37, v91, 63
    s_cbranch_vccnz L2_xo108
L2_xp108:
    v_and_b32 v46, 0x80000000, v41
    v_lshrrev_b32 v47, 14, v25
    v_bitop3_b32 v47, v47, v5, v46 bitop3:0xea
    ds_read_b64 v[102:103], v47
    v_and_b32 v99, 0x40000000, v41
    v_lshrrev_b32 v47, 14, v24
    v_bitop3_b32 v47, v47, v5, v99 bitop3:0xea
    ds_read_b64 v[100:101], v47
    s_waitcnt lgkmcnt(2)
    v_cmp_ne_u64 s[50:51], v[72:73], v[68:69]
    v_cmpx_ne_u64 s[54:55], v[74:75], v[70:71]
    s_and_b64 s[82:83], s[54:55], s[80:81]
    s_cbranch_scc1 L2_c109
L2_d109:
    v_mov_b64 v[84:85], v[70:71]
    v_mov_b32 v7, v93
    v_mov_b64 v[86:87], v[74:75]
    s_or_b64 s[80:81], s[80:81], s[54:55]
    s_mov_b64 exec, s[50:51]
    s_and_b64 s[82:83], s[50:51], s[80:81]
    s_cbranch_scc1 L2_c110
L2_d110:
    v_mov_b64 v[84:85], v[68:69]
    v_mov_b32 v7, v92
    v_mov_b64 v[86:87], v[72:73]
    s_mov_b64 exec, -1
    s_or_b64 s[80:81], s[80:81], s[50:51]
    ds_read_b64 v[70:71], v95 offset:65408
    ds_read_b64 v[68:69], v94 offset:65408
    v_bitop3_b32 v92, v24, v5, v99 bitop3:0xea
    v_bitop3_b32 v93, v25, v5, v46 bitop3:0xea
    v_perm_b32 v15, v25, v26, s47
    v_bitop3_b32 v46, v25, 0.5, -0.5 bitop3:0xa8
    v_perm_b32 v14, v24, v26, s46
    v_bitop3_b32 v47, v24, 0.5, -0.5 bitop3:0xa8
    v_bitop3_b32 v15, v6, v15, v46 bitop3:0xca
    v_bitop3_b32 v14, v6, v14, v47 bitop3:0xca
    s_waitcnt lgkmcnt(1)
    v_mfma_f32_4x4x4_16b_bf16 v[80:83], v[10:11], v[70:71], v[80:83]
    s_waitcnt lgkmcnt(0)
    v_mfma_f32_4x4x4_16b_bf16 v[76:79], v[10:11], v[68:69], v[76:79]
    s_nop 2
    v_cvt_pk_bf16_f32 v80, v80, v81
    v_cvt_pk_bf16_f32 v81, v82, v83
    ds_wrxchg_rtn_b64 v[74:75], v95, v[80:81] offset:65408
    v_cvt_pk_bf16_f32 v76, v76, v77
    v_cvt_pk_bf16_f32 v77, v78, v79
    ds_wrxchg_rtn_b64 v[72:73], v94, v[76:77] offset:65408
    v_and_b32 v88, 0x0fffffff, v27
    buffer_load_dwordx2 v[22:23], v88, s[8:11], 0 offen
    buffer_load_dwordx3 v[24:26], v88, s[8:11], 0 offen offset:8
    v_mfma_f32_4x4x4_16b_bf16 v[80:83], v[8:9], v[102:103], 0
    v_mfma_f32_4x4x4_16b_bf16 v[76:79], v[8:9], v[100:101], 0
    v_cmp_lt_u32 s[84:85], v5, v92
    s_nop 2
    v_pk_mul_f32 v[80:81], v[80:81], v[14:15] op_sel:[0,1] op_sel_hi:[1,1]
    v_pk_mul_f32 v[82:83], v[82:83], v[14:15] op_sel:[0,1] op_sel_hi:[1,1]
    v_pk_mul_f32 v[76:77], v[76:77], v[14:15] op_sel:[0,0] op_sel_hi:[1,0]
    v_pk_mul_f32 v[78:79], v[78:79], v[14:15] op_sel:[0,0] op_sel_hi:[1,0]
    s_waitcnt vmcnt(11)
    s_mov_b64 exec, s[6:7]
    v_lshrrev_b32 v30, 16, v30
    s_mov_b64 exec, -1
    v_and_b32 v46, 0x20000000, v42
    v_lshrrev_b32 v47, 14, v29
    v_bitop3_b32 v47, v47, v5, v46 bitop3:0xea
    ds_read_b64 v[106:107], v47
    v_and_b32 v99, 0x10000000, v42
    v_lshrrev_b32 v47, 14, v28
    v_bitop3_b32 v47, v47, v5, v99 bitop3:0xea
    ds_read_b64 v[104:105], v47
    s_waitcnt lgkmcnt(2)
    v_cmp_ne_u64 s[50:51], v[72:73], v[68:69]
    v_cmpx_ne_u64 s[54:55], v[74:75], v[70:71]
    s_and_b64 s[82:83], s[54:55], s[80:81]
    s_cbranch_scc1 L2_c111
L2_d111:
    v_mov_b64 v[84:85], v[70:71]
    v_mov_b32 v7, v95
    v_mov_b64 v[86:87], v[74:75]
    s_or_b64 s[80:81], s[80:81], s[54:55]
    s_mov_b64 exec, s[50:51]
    s_and_b64 s[82:83], s[50:51], s[80:81]
    s_cbranch_scc1 L2_c112
L2_d112:
    v_mov_b64 v[84:85], v[68:69]
    v_mov_b32 v7, v94
    v_mov_b64 v[86:87], v[72:73]
    s_mov_b64 exec, -1
    s_or_b64 s[80:81], s[80:81], s[50:51]
    s_and_b64 exec, s[84:85], s[80:81]
    v_mfma_f32_4x4x4_16b_bf16 v[76:79], v[12:13], v[84:85], 0
    v_mov_b32 v92, v7
    s_andn2_b64 s[80:81], s[80:81], s[84:85]
    v_mfma_f32_4x4x4_16b_bf16 v[76:79], v[10:11], v[86:87], v[76:79]
    s_mov_b64 exec, -1
    ds_read_b64 v[70:71], v93 offset:65408
    ds_read_b64 v[68:69], v92 offset:65408
    v_bitop3_b32 v94, v28, v5, v99 bitop3:0xea
    v_bitop3_b32 v95, v29, v5, v46 bitop3:0xea
    v_perm_b32 v15, v29, v30, s45
    v_bitop3_b32 v46, v29, 0.5, -0.5 bitop3:0xa8
    v_perm_b32 v14, v28, v30, s44
    v_bitop3_b32 v47, v28, 0.5, -0.5 bitop3:0xa8
    v_bitop3_b32 v15, v6, v15, v46 bitop3:0xca
    v_bitop3_b32 v14, v6, v14, v47 bitop3:0xca
    s_waitcnt lgkmcnt(1)
    v_mfma_f32_4x4x4_16b_bf16 v[80:83], v[10:11], v[70:71], v[80:83]
    s_waitcnt lgkmcnt(0)
    v_mfma_f32_4x4x4_16b_bf16 v[76:79], v[10:11], v[68:69], v[76:79]
    s_nop 2
    v_cvt_pk_bf16_f32 v80, v80, v81
    v_cvt_pk_bf16_f32 v81, v82, v83
    ds_wrxchg_rtn_b64 v[74:75], v93, v[80:81] offset:65408
    v_cvt_pk_bf16_f32 v76, v76, v77
    v_cvt_pk_bf16_f32 v77, v78, v79
    ds_wrxchg_rtn_b64 v[72:73], v92, v[76:77] offset:65408
    s_setprio 0
    v_mfma_f32_4x4x4_16b_bf16 v[80:83], v[8:9], v[106:107], 0
    v_mfma_f32_4x4x4_16b_bf16 v[76:79], v[8:9], v[104:105], 0
    v_cmp_lt_u32 s[48:49], v5, v95
    s_nop 2
    v_pk_mul_f32 v[80:81], v[80:81], v[14:15] op_sel:[0,1] op_sel_hi:[1,1]
    v_pk_mul_f32 v[82:83], v[82:83], v[14:15] op_sel:[0,1] op_sel_hi:[1,1]
    v_pk_mul_f32 v[76:77], v[76:77], v[14:15] op_sel:[0,0] op_sel_hi:[1,0]
    v_pk_mul_f32 v[78:79], v[78:79], v[14:15] op_sel:[0,0] op_sel_hi:[1,0]
    s_add_u32 s40, s40, 0x50000
    v_and_b32 v47, 0x0fffffff, v31
    buffer_load_dword v30, v47, s[8:11], 0 offen offset:16
    s_mov_b64 exec, s[6:7]
    v_add_u32 v47, 8, v47
    v_lshrrev_b32 v31, 2, v31
    s_mov_b64 exec, -1
    buffer_load_dwordx2 v[28:29], v47, s[8:11], 0 offen
    s_waitcnt vmcnt(8)
    v_and_b32 v46, 0x80000000, v43
    v_lshrrev_b32 v47, 14, v37
    v_bitop3_b32 v47, v47, v5, v46 bitop3:0xea
    ds_read_b64 v[106:107], v47
    v_and_b32 v99, 0x40000000, v43
    v_lshrrev_b32 v47, 14, v36
    v_bitop3_b32 v47, v47, v5, v99 bitop3:0xea
    ds_read_b64 v[104:105], v47
    v_and_b32 v46, 0x20000000, v43
    v_lshrrev_b32 v47, 14, v35
    v_bitop3_b32 v47, v47, v5, v46 bitop3:0xea
    ds_read_b64 v[102:103], v47
    v_and_b32 v99, 0x10000000, v43
    v_lshrrev_b32 v47, 14, v34
    v_bitop3_b32 v47, v47, v5, v99 bitop3:0xea
    ds_read_b64 v[100:101], v47
    s_waitcnt lgkmcnt(4)
    v_cmp_ne_u64 s[50:51], v[72:73], v[68:69]
    v_cmpx_ne_u64 s[54:55], v[74:75], v[70:71]
    s_and_b64 s[82:83], s[54:55], s[80:81]
    s_cbranch_scc1 L2_c113
L2_d113:
    v_mov_b64 v[84:85], v[70:71]
    v_mov_b32 v7, v93
    v_mov_b64 v[86:87], v[74:75]
    s_or_b64 s[80:81], s[80:81], s[54:55]
    s_mov_b64 exec, s[50:51]
    s_and_b64 s[82:83], s[50:51], s[80:81]
    s_cbranch_scc1 L2_c114
L2_d114:
    v_mov_b64 v[84:85], v[68:69]
    v_mov_b32 v7, v92
    v_mov_b64 v[86:87], v[72:73]
    s_mov_b64 exec, -1
    s_or_b64 s[80:81], s[80:81], s[50:51]
    s_and_b64 exec, s[48:49], s[80:81]
    v_mfma_f32_4x4x4_16b_bf16 v[80:83], v[12:13], v[84:85], 0
    v_mov_b32 v95, v7
    s_andn2_b64 s[80:81], s[80:81], s[48:49]
    v_mfma_f32_4x4x4_16b_bf16 v[80:83], v[10:11], v[86:87], v[80:83]
    s_mov_b64 exec, -1
    ds_read_b64 v[70:71], v95 offset:65408
    ds_read_b64 v[68:69], v94 offset:65408
    v_bitop3_b32 v92, v34, v5, v99 bitop3:0xea
    v_bitop3_b32 v93, v35, v5, v46 bitop3:0xea
    v_perm_b32 v15, v35, v38, s45
    v_bitop3_b32 v46, v35, 0.5, -0.5 bitop3:0xa8
    v_perm_b32 v14, v34, v38, s44
    v_bitop3_b32 v47, v34, 0.5, -0.5 bitop3:0xa8
    v_bitop3_b32 v15, v6, v15, v46 bitop3:0xca
    v_bitop3_b32 v14, v6, v14, v47 bitop3:0xca
    s_waitcnt lgkmcnt(1)
    v_mfma_f32_4x4x4_16b_bf16 v[80:83], v[10:11], v[70:71], v[80:83]
    s_waitcnt lgkmcnt(0)
    v_mfma_f32_4x4x4_16b_bf16 v[76:79], v[10:11], v[68:69], v[76:79]
    s_nop 2
    v_cvt_pk_bf16_f32 v80, v80, v81
    v_cvt_pk_bf16_f32 v81, v82, v83
    ds_wrxchg_rtn_b64 v[74:75], v95, v[80:81] offset:65408
    v_cvt_pk_bf16_f32 v76, v76, v77
    v_cvt_pk_bf16_f32 v77, v78, v79
    ds_wrxchg_rtn_b64 v[72:73], v94, v[76:77] offset:65408
    s_barrier
    s_setprio 3
    s_mov_b32 m0, s100
    s_nop 0
    ds_write_addtid_b32 v124 offset:34816
    ds_write_addtid_b32 v125 offset:35072
    ds_write_addtid_b32 v126 offset:35328
    ds_write_addtid_b32 v127 offset:35584
    s_add_u32 s3, s40, 4096
    buffer_load_dwordx4 v[124:127], v3, s[16:19], s3 offen sc1
    ds_write_addtid_b32 v116 offset:32768
    ds_write_addtid_b32 v117 offset:33024
    ds_write_addtid_b32 v118 offset:33280
    ds_write_addtid_b32 v119 offset:33536
    buffer_load_dwordx4 v[116:119], v3, s[16:19], s40 offen offset:2048 sc1
    ds_write_addtid_b32 v120 offset:33792
    ds_write_addtid_b32 v121 offset:34048
    ds_write_addtid_b32 v122 offset:34304
    ds_write_addtid_b32 v123 offset:34560
    buffer_load_dwordx4 v[120:123], v3, s[16:19], s40 offen offset:3072 sc1
    v_mfma_f32_4x4x4_16b_bf16 v[80:83], v[8:9], v[102:103], 0
    v_mfma_f32_4x4x4_16b_bf16 v[76:79], v[8:9], v[100:101], 0
    s_nop 3
    v_pk_mul_f32 v[80:81], v[80:81], v[14:15] op_sel:[0,1] op_sel_hi:[1,1]
    v_pk_mul_f32 v[82:83], v[82:83], v[14:15] op_sel:[0,1] op_sel_hi:[1,1]
    v_pk_mul_f32 v[76:77], v[76:77], v[14:15] op_sel:[0,0] op_sel_hi:[1,0]
    v_pk_mul_f32 v[78:79], v[78:79], v[14:15] op_sel:[0,0] op_sel_hi:[1,0]
    s_cmp_gt_u32 s37, 1024
    s_cbranch_scc1 L2_xs115
    s_cmp_lg_u32 s101, 0
    s_cbranch_scc1 L2_xa115
L2_xb115:
    v_lshlrev_b32 v89, 16, v96
    v_add_u32 v90, 60, v97
    v_bitop3_b32 v90, v89, v45, v90 bitop3:0x6a
    ds_write_b32 v98, v90 offset:12
    v_lshlrev_b32 v89, 20, v96
    v_add_u32 v90, 40, v97
    v_bitop3_b32 v90, v89, v45, v90 bitop3:0x6a
    ds_write_b32 v98, v90 offset:8
    v_lshlrev_b32 v89, 24, v96
    v_add_u32 v90, 20, v97
    v_bitop3_b32 v90, v89, v45, v90 bitop3:0x6a
    ds_write_b32 v98, v90 offset:4
    v_lshlrev_b32 v89, 28, v96
    v_bitop3_b32 v90, v89, v45, v97 bitop3:0x6a
    ds_write_b32 v98, v90 offset:0
    v_mov_b32_dpp v91, v66 quad_perm:[1,1,1,1] row_mask:0xf bank_mask:0xf
    v_and_b32 v89, 3, v91
    v_and_b32 v97, 0xfffc, v91
    v_sub_u16_dpp v88, v66, v91 quad_perm:[3,3,3,3] row_mask:0xf bank_mask:0xf
    v_mad_u32_u24 v97, v97, 5, v4
    v_add_u32 v99, v88, v89
    v_bfm_b32 v96, v88, v89
    v_cmp_lt_u32 s[58:59], 16, v99
    v_lshlrev_b32 v89, v1, v96
    v_and_b32 v89, v45, v89
    v_cmp_ne_u32 vcc, 0, v89
    v_xor_b32 v90, v97, v89
    s_add_u32 s3, s37, s38
    v_mbcnt_lo_u32_b32 v98, vcc_lo, 0
    v_mbcnt_hi_u32_b32 v98, vcc_hi, v98
    s_bcnt1_i32_b64 s41, vcc
    v_lshl_add_u32 v98, v98, 2, s3
    s_lshl2_add_u32 s37, s41, s37
    s_mov_b64 exec, vcc
    ds_write_b32 v98, v90
    s_mov_b64 exec, -1
    s_cmp_lg_u64 s[58:59], 0
    s_cbranch_scc1 L2_xe115
L2_xr115:
    v_add_u32 v98, s37, v0
    v_mov_b32 v90, -1
    ds_write_b32 v98, v90
L2_xw115:
    s_setprio 2
    s_waitcnt lgkmcnt(14)
    v_cmp_ne_u64 s[50:51], v[72:73], v[68:69]
    v_cmpx_ne_u64 s[54:55], v[74:75], v[70:71]
    s_and_b64 s[82:83], s[54:55], s[80:81]
    s_cbranch_scc1 L2_c116
L2_d116:
    v_mov_b64 v[84:85], v[70:71]
    v_mov_b32 v7, v95
    v_mov_b64 v[86:87], v[74:75]
    s_or_b64 s[80:81], s[80:81], s[54:55]
    s_mov_b64 exec, s[50:51]
    s_and_b64 s[82:83], s[50:51], s[80:81]
    s_cbranch_scc1 L2_c117
L2_d117:
    v_mov_b64 v[84:85], v[68:69]
    v_mov_b32 v7, v94
    v_mov_b64 v[86:87], v[72:73]
    s_mov_b64 exec, -1
    s_or_b64 s[80:81], s[80:81], s[50:51]
    ds_read_b64 v[70:71], v93 offset:65408
    ds_read_b64 v[68:69], v92 offset:65408
    v_and_b32 v46, 0x40000000, v43
    v_bitop3_b32 v94, v36, v5, v46 bitop3:0xea
    v_and_b32 v46, 0x80000000, v43
    v_bitop3_b32 v95, v37, v5, v46 bitop3:0xea
    v_perm_b32 v15, v37, v38, s47
    v_bitop3_b32 v46, v37, 0.5, -0.5 bitop3:0xa8
    v_perm_b32 v14, v36, v38, s46
    v_bitop3_b32 v47, v36, 0.5, -0.5 bitop3:0xa8
    v_bitop3_b32 v15, v6, v15, v46 bitop3:0xca
    v_bitop3_b32 v14, v6, v14, v47 bitop3:0xca
    s_setprio 1
    s_waitcnt lgkmcnt(1)
    v_mfma_f32_4x4x4_16b_bf16 v[80:83], v[10:11], v[70:71], v[80:83]
    s_waitcnt lgkmcnt(0)
    v_mfma_f32_4x4x4_16b_bf16 v[76:79], v[10:11], v[68:69], v[76:79]
    s_nop 2
    v_cvt_pk_bf16_f32 v80, v80, v81
    v_cvt_pk_bf16_f32 v81, v82, v83
    ds_wrxchg_rtn_b64 v[74:75], v93, v[80:81] offset:65408
    v_cvt_pk_bf16_f32 v76, v76, v77
    v_cvt_pk_bf16_f32 v77, v78, v79
    ds_wrxchg_rtn_b64 v[72:73], v92, v[76:77] offset:65408
    ds_read_b32 v40, v0 offset:0
    ds_read_b32 v41, v0 offset:256
    ds_read_b32 v42, v44 offset:768
    ds_read_b32 v43, v0 offset:512
    s_sub_u32 s3, s37, 768
    s_cmp_gt_u32 s3, 128
    s_cbranch_scc1 L2_xf115
L2_xg115:
    v_lshrrev_b64 v[64:65], 16, v[64:65]
    v_lshrrev_b64 v[66:67], 16, v[66:67]
    v_and_b32 v88, 0x0fffffff, v39
    buffer_load_dwordx2 v[34:35], v88, s[8:11], 0 offen
    buffer_load_dwordx3 v[36:38], v88, s[8:11], 0 offen offset:8
    s_setprio 0
    s_waitcnt vmcnt(12)
    s_mov_b32 m0, s38
    s_nop 0
    ds_write_addtid_b32 v108 offset:0
    ds_write_addtid_b32 v109 offset:256
    ds_write_addtid_b32 v110 offset:512
    ds_write_addtid_b32 v111 offset:768
    s_waitcnt vmcnt(9)
    ds_write_addtid_b32 v112 offset:1024
    ds_write_addtid_b32 v113 offset:1280
    ds_write_addtid_b32 v114 offset:1536
    ds_write_addtid_b32 v115 offset:1792
    v_mfma_f32_4x4x4_16b_bf16 v[80:83], v[8:9], v[106:107], 0
    v_mfma_f32_4x4x4_16b_bf16 v[76:79], v[8:9], v[104:105], 0
    v_cmp_lt_u32 s[84:85], v5, v94
    s_nop 2
    v_pk_mul_f32 v[80:81], v[80:81], v[14:15] op_sel:[0,1] op_sel_hi:[1,1]
    v_pk_mul_f32 v[82:83], v[82:83], v[14:15] op_sel:[0,1] op_sel_hi:[1,1]
    v_pk_mul_f32 v[76:77], v[76:77], v[14:15] op_sel:[0,0] op_sel_hi:[1,0]
    v_pk_mul_f32 v[78:79], v[78:79], v[14:15] op_sel:[0,0] op_sel_hi:[1,0]
    s_add_u32 s42, s42, 1
    s_waitcnt lgkmcnt(0)
    s_cmp_lg_u32 s42, 14
    s_cbranch_scc1 L2_loop
    s_barrier
    s_bitcmp1_b32 s36, s42
    s_cbranch_scc1 L2_slow
L2_ret6:
    s_setprio 3
    s_bitcmp1_b32 s43, s42
    s_cbranch_scc1 L2_oa118
L2_ob118:
    v_and_b32 v46, 0x20000000, v21
    v_lshrrev_b32 v47, 14, v17
    v_bitop3_b32 v47, v47, v5, v46 bitop3:0xea
    ds_read_b64 v[102:103], v47
    v_and_b32 v99, 0x10000000, v21
    v_lshrrev_b32 v47, 14, v16
    v_bitop3_b32 v47, v47, v5, v99 bitop3:0xea
    ds_read_b64 v[100:101], v47
    v_cmp_ne_u64 s[50:51], v[72:73], v[68:69]
    v_cmpx_ne_u64 s[54:55], v[74:75], v[70:71]
    s_and_b64 s[82:83], s[54:55], s[80:81]
    s_cbranch_scc1 L2_c119
L2_d119:
    v_mov_b64 v[84:85], v[70:71]
    v_mov_b32 v7, v93
    v_mov_b64 v[86:87], v[74:75]
    s_or_b64 s[80:81], s[80:81], s[54:55]
    s_mov_b64 exec, s[50:51]
    s_and_b64 s[82:83], s[50:51], s[80:81]
    s_cbranch_scc1 L2_c120
L2_d120:
    v_mov_b64 v[84:85], v[68:69]
    v_mov_b32 v7, v92
    v_mov_b64 v[86:87], v[72:73]
    s_mov_b64 exec, -1
    s_or_b64 s[80:81], s[80:81], s[50:51]
    s_and_b64 exec, s[84:85], s[80:81]
    v_mfma_f32_4x4x4_16b_bf16 v[76:79], v[12:13], v[84:85], 0
    v_mov_b32 v94, v7
    s_andn2_b64 s[80:81], s[80:81], s[84:85]
    v_mfma_f32_4x4x4_16b_bf16 v[76:79], v[10:11], v[86:87], v[76:79]
    s_mov_b64 exec, -1
    ds_read_b64 v[70:71], v95 offset:65408
    ds_read_b64 v[68:69], v94 offset:65408
    v_bitop3_b32 v92, v16, v5, v99 bitop3:0xea
    v_bitop3_b32 v93, v17, v5, v46 bitop3:0xea
    v_perm_b32 v15, v17, v20, s45
    v_bitop3_b32 v46, v17, 0.5, -0.5 bitop3:0xa8
    v_perm_b32 v14, v16, v20, s44
    v_bitop3_b32 v47, v16, 0.5, -0.5 bitop3:0xa8
    v_bitop3_b32 v15, v6, v15, v46 bitop3:0xca
    v_bitop3_b32 v14, v6, v14, v47 bitop3:0xca
    s_waitcnt lgkmcnt(1)
    v_mfma_f32_4x4x4_16b_bf16 v[80:83], v[10:11], v[70:71], v[80:83]
    s_waitcnt lgkmcnt(0)
    v_mfma_f32_4x4x4_16b_bf16 v[76:79], v[10:11], v[68:69], v[76:79]
    s_nop 2
    v_cvt_pk_bf16_f32 v80, v80, v81
    v_cvt_pk_bf16_f32 v81, v82, v83
    ds_wrxchg_rtn_b64 v[74:75], v95, v[80:81] offset:65408
    v_cvt_pk_bf16_f32 v76, v76, v77
    v_cvt_pk_bf16_f32 v77, v78, v79
    ds_wrxchg_rtn_b64 v[72:73], v94, v[76:77] offset:65408
    v_mfma_f32_4x4x4_16b_bf16 v[80:83], v[8:9], v[102:103], 0
    v_mfma_f32_4x4x4_16b_bf16 v[76:79], v[8:9], v[100:101], 0
    v_cmp_lt_u32 s[84:85], v5, v92
    s_nop 2
    v_pk_mul_f32 v[80:81], v[80:81], v[14:15] op_sel:[0,1] op_sel_hi:[1,1]
    v_pk_mul_f32 v[82:83], v[82:83], v[14:15] op_sel:[0,1] op_sel_hi:[1,1]
    v_pk_mul_f32 v[76:77], v[76:77], v[14:15] op_sel:[0,0] op_sel_hi:[1,0]
    v_pk_mul_f32 v[78:79], v[78:79], v[14:15] op_sel:[0,0] op_sel_hi:[1,0]
    buffer_load_dwordx4 v[108:111], v3, s[16:19], s40 offen offset:0 sc1
    v_and_b32 v46, 0x80000000, v21
    v_lshrrev_b32 v47, 14, v19
    v_bitop3_b32 v47, v47, v5, v46 bitop3:0xea
    ds_read_b64 v[106:107], v47
    v_and_b32 v99, 0x40000000, v21
    v_lshrrev_b32 v47, 14, v18
    v_bitop3_b32 v47, v47, v5, v99 bitop3:0xea
    ds_read_b64 v[104:105], v47
    s_waitcnt lgkmcnt(2)
    v_cmp_ne_u64 s[50:51], v[72:73], v[68:69]
    v_cmpx_ne_u64 s[54:55], v[74:75], v[70:71]
    s_and_b64 s[82:83], s[54:55], s[80:81]
    s_cbranch_scc1 L2_c121
L2_d121:
    v_mov_b64 v[84:85], v[70:71]
    v_mov_b32 v7, v95
    v_mov_b64 v[86:87], v[74:75]
    s_or_b64 s[80:81], s[80:81], s[54:55]
    s_mov_b64 exec, s[50:51]
    s_and_b64 s[82:83], s[50:51], s[80:81]
    s_cbranch_scc1 L2_c122
L2_d122:
    v_mov_b64 v[84:85], v[68:69]
    v_mov_b32 v7, v94
    v_mov_b64 v[86:87], v[72:73]
    s_mov_b64 exec, -1
    s_or_b64 s[80:81], s[80:81], s[50:51]
    s_and_b64 exec, s[84:85], s[80:81]
    v_mfma_f32_4x4x4_16b_bf16 v[76:79], v[12:13], v[84:85], 0
    v_mov_b32 v92, v7
    s_andn2_b64 s[80:81], s[80:81], s[84:85]
    v_mfma_f32_4x4x4_16b_bf16 v[76:79], v[10:11], v[86:87], v[76:79]
    s_mov_b64 exec, -1
    ds_read_b64 v[70:71], v93 offset:65408
    ds_read_b64 v[68:69], v92 offset:65408
    v_bitop3_b32 v94, v18, v5, v99 bitop3:0xea
    v_bitop3_b32 v95, v19, v5, v46 bitop3:0xea
    v_perm_b32 v15, v19, v20, s47
    v_bitop3_b32 v46, v19, 0.5, -0.5 bitop3:0xa8
    v_perm_b32 v14, v18, v20, s46
    v_bitop3_b32 v47, v18, 0.5, -0.5 bitop3:0xa8
    v_bitop3_b32 v15, v6, v15, v46 bitop3:0xca
    v_bitop3_b32 v14, v6, v14, v47 bitop3:0xca
    s_waitcnt lgkmcnt(1)
    v_mfma_f32_4x4x4_16b_bf16 v[80:83], v[10:11], v[70:71], v[80:83]
    s_waitcnt lgkmcnt(0)
    v_mfma_f32_4x4x4_16b_bf16 v[76:79], v[10:11], v[68:69], v[76:79]
    s_nop 2
    v_cvt_pk_bf16_f32 v80, v80, v81
    v_cvt_pk_bf16_f32 v81, v82, v83
    ds_wrxchg_rtn_b64 v[74:75], v93, v[80:81] offset:65408
    v_cvt_pk_bf16_f32 v76, v76, v77
    v_cvt_pk_bf16_f32 v77, v78, v79
    ds_wrxchg_rtn_b64 v[72:73], v92, v[76:77] offset:65408
    v_and_b32 v88, 0x0fffffff, v40
    buffer_load_dwordx2 v[16:17], v88, s[8:11], 0 offen
    buffer_load_dwordx3 v[18:20], v88, s[8:11], 0 offen offset:8
    s_setprio 2
    v_mfma_f32_4x4x4_16b_bf16 v[80:83], v[8:9], v[106:107], 0
    v_mfma_f32_4x4x4_16b_bf16 v[76:79], v[8:9], v[104:105], 0
    v_cmp_lt_u32 s[48:49], v5, v95
    s_nop 2
    v_pk_mul_f32 v[80:81], v[80:81], v[14:15] op_sel:[0,1] op_sel_hi:[1,1]
    v_pk_mul_f32 v[82:83], v[82:83], v[14:15] op_sel:[0,1] op_sel_hi:[1,1]
    v_pk_mul_f32 v[76:77], v[76:77], v[14:15] op_sel:[0,0] op_sel_hi:[1,0]
    v_pk_mul_f32 v[78:79], v[78:79], v[14:15] op_sel:[0,0] op_sel_hi:[1,0]
    s_waitcnt vmcnt(10)
    v_and_b32 v46, 0x20000000, v27
    v_lshrrev_b32 v47, 14, v23
    v_bitop3_b32 v47, v47, v5, v46 bitop3:0xea
    ds_read_b64 v[102:103], v47
    v_and_b32 v99, 0x10000000, v27
    v_lshrrev_b32 v47, 14, v22
    v_bitop3_b32 v47, v47, v5, v99 bitop3:0xea
    ds_read_b64 v[100:101], v47
    s_waitcnt lgkmcnt(2)
    v_cmp_ne_u64 s[50:51], v[72:73], v[68:69]
    v_cmpx_ne_u64 s[54:55], v[74:75], v[70:71]
    s_and_b64 s[82:83], s[54:55], s[80:81]
    s_cbranch_scc1 L2_c123
L2_d123:
    v_mov_b64 v[84:85], v[70:71]
    v_mov_b32 v7, v93
    v_mov_b64 v[86:87], v[74:75]
    s_or_b64 s[80:81], s[80:81], s[54:55]
    s_mov_b64 exec, s[50:51]
    s_and_b64 s[82:83], s[50:51], s[80:81]
    s_cbranch_scc1 L2_c124
L2_d124:
    v_mov_b64 v[84:85], v[68:69]
    v_mov_b32 v7, v92
    v_mov_b64 v[86:87], v[72:73]
    s_mov_b64 exec, -1
    s_or_b64 s[80:81], s[80:81], s[50:51]
    s_and_b64 exec, s[48:49], s[80:81]
    v_mfma_f32_4x4x4_16b_bf16 v[80:83], v[12:13], v[84:85], 0
    v_mov_b32 v95, v7
    s_andn2_b64 s[80:81], s[80:81], s[48:49]
    v_mfma_f32_4x4x4_16b_bf16 v[80:83], v[10:11], v[86:87], v[80:83]
    s_mov_b64 exec, -1
    ds_read_b64 v[70:71], v95 offset:65408
    ds_read_b64 v[68:69], v94 offset:65408
    v_bitop3_b32 v92, v22, v5, v99 bitop3:0xea
    v_bitop3_b32 v93, v23, v5, v46 bitop3:0xea
    v_perm_b32 v15, v23, v26, s45
    v_bitop3_b32 v46, v23, 0.5, -0.5 bitop3:0xa8
    v_perm_b32 v14, v22, v26, s44
    v_bitop3_b32 v47, v22, 0.5, -0.5 bitop3:0xa8
    v_bitop3_b32 v15, v6, v15, v46 bitop3:0xca
    v_bitop3_b32 v14, v6, v14, v47 bitop3:0xca
    s_waitcnt lgkmcnt(1)
    v_mfma_f32_4x4x4_16b_bf16 v[80:83], v[10:11], v[70:71], v[80:83]
    s_waitcnt lgkmcnt(0)
    v_mfma_f32_4x4x4_16b_bf16 v[76:79], v[10:11], v[68:69], v[76:79]
    s_nop 2
    v_cvt_pk_bf16_f32 v80, v80, v81
    v_cvt_pk_bf16_f32 v81, v82, v83
    ds_wrxchg_rtn_b64 v[74:75], v95, v[80:81] offset:65408
    v_cvt_pk_bf16_f32 v76, v76, v77
    v_cvt_pk_bf16_f32 v77, v78, v79
    ds_wrxchg_rtn_b64 v[72:73], v94, v[76:77] offset:65408
    s_setprio 1
    v_mfma_f32_4x4x4_16b_bf16 v[80:83], v[8:9], v[102:103], 0
    v_mfma_f32_4x4x4_16b_bf16 v[76:79], v[8:9], v[100:101], 0
    s_nop 3
    v_pk_mul_f32 v[80:81], v[80:81], v[14:15] op_sel:[0,1] op_sel_hi:[1,1]
    v_pk_mul_f32 v[82:83], v[82:83], v[14:15] op_sel:[0,1] op_sel_hi:[1,1]
    v_pk_mul_f32 v[76:77], v[76:77], v[14:15] op_sel:[0,0] op_sel_hi:[1,0]
    v_pk_mul_f32 v[78:79], v[78:79], v[14:15] op_sel:[0,0] op_sel_hi:[1,0]
    s_bitcmp1_b32 s43, s42
    s_cbranch_scc1 L2_oa125
L2_ob125:
    buffer_load_dwordx4 v[112:115], v3, s[16:19], s40 offen offset:1024 sc1
    v_and_b32 v46, 0x80000000, v27
    v_lshrrev_b32 v47, 14, v25
    v_bitop3_b32 v47, v47, v5, v46 bitop3:0xea
    ds_read_b64 v[106:107], v47
    v_and_b32 v99, 0x40000000, v27
    v_lshrrev_b32 v47, 14, v24
    v_bitop3_b32 v47, v47, v5, v99 bitop3:0xea
    ds_read_b64 v[104:105], v47
    s_waitcnt lgkmcnt(2)
    v_cmp_ne_u64 s[50:51], v[72:73], v[68:69]
    v_cmpx_ne_u64 s[54:55], v[74:75], v[70:71]
    s_and_b64 s[82:83], s[54:55], s[80:81]
    s_cbranch_scc1 L2_c126
L2_d126:
    v_mov_b64 v[84:85], v[70:71]
    v_mov_b32 v7, v95
    v_mov_b64 v[86:87], v[74:75]
    s_or_b64 s[80:81], s[80:81], s[54:55]
    s_mov_b64 exec, s[50:51]
    s_and_b64 s[82:83], s[50:51], s[80:81]
    s_cbranch_scc1 L2_c127
L2_d127:
    v_mov_b64 v[84:85], v[68:69]
    v_mov_b32 v7, v94
    v_mov_b64 v[86:87], v[72:73]
    s_mov_b64 exec, -1
    s_or_b64 s[80:81], s[80:81], s[50:51]
    ds_read_b64 v[70:71], v93 offset:65408
    ds_read_b64 v[68:69], v92 offset:65408
    v_bitop3_b32 v94, v24, v5, v99 bitop3:0xea
    v_bitop3_b32 v95, v25, v5, v46 bitop3:0xea
    v_perm_b32 v15, v25, v26, s47
    v_bitop3_b32 v46, v25, 0.5, -0.5 bitop3:0xa8
    v_perm_b32 v14, v24, v26, s46
    v_bitop3_b32 v47, v24, 0.5, -0.5 bitop3:0xa8
    v_bitop3_b32 v15, v6, v15, v46 bitop3:0xca
    v_bitop3_b32 v14, v6, v14, v47 bitop3:0xca
    s_waitcnt lgkmcnt(1)
    v_mfma_f32_4x4x4_16b_bf16 v[80:83], v[10:11], v[70:71], v[80:83]
    s_waitcnt lgkmcnt(0)
    v_mfma_f32_4x4x4_16b_bf16 v[76:79], v[10:11], v[68:69], v[76:79]
    s_nop 2
    v_cvt_pk_bf16_f32 v80, v80, v81
    v_cvt_pk_bf16_f32 v81, v82, v83
    ds_wrxchg_rtn_b64 v[74:75], v93, v[80:81] offset:65408
    v_cvt_pk_bf16_f32 v76, v76, v77
    v_cvt_pk_bf16_f32 v77, v78, v79
    ds_wrxchg_rtn_b64 v[72:73], v92, v[76:77] offset:65408
    v_and_b32 v88, 0x0fffffff, v41
    buffer_load_dwordx2 v[22:23], v88, s[8:11], 0 offen
    buffer_load_dwordx3 v[24:26], v88, s[8:11], 0 offen offset:8
    v_mfma_f32_4x4x4_16b_bf16 v[80:83], v[8:9], v[106:107], 0
    v_mfma_f32_4x4x4_16b_bf16 v[76:79], v[8:9], v[104:105], 0
    v_cmp_lt_u32 s[84:85], v5, v94
    s_nop 2
    v_pk_mul_f32 v[80:81], v[80:81], v[14:15] op_sel:[0,1] op_sel_hi:[1,1]
    v_pk_mul_f32 v[82:83], v[82:83], v[14:15] op_sel:[0,1] op_sel_hi:[1,1]
    v_pk_mul_f32 v[76:77], v[76:77], v[14:15] op_sel:[0,0] op_sel_hi:[1,0]
    v_pk_mul_f32 v[78:79], v[78:79], v[14:15] op_sel:[0,0] op_sel_hi:[1,0]
    s_waitcnt vmcnt(11)
    s_mov_b64 exec, s[6:7]
    v_lshrrev_b32 v30, 16, v30
    s_mov_b64 exec, -1
    v_and_b32 v46, 0x20000000, v31
    v_lshrrev_b32 v47, 14, v29
    v_bitop3_b32 v47, v47, v5, v46 bitop3:0xea
    ds_read_b64 v[102:103], v47
    v_and_b32 v99, 0x10000000, v31
    v_lshrrev_b32 v47, 14, v28
    v_bitop3_b32 v47, v47, v5, v99 bitop3:0xea
    ds_read_b64 v[100:101], v47
    s_waitcnt lgkmcnt(2)
    v_cmp_ne_u64 s[50:51], v[72:73], v[68:69]
    v_cmpx_ne_u64 s[54:55], v[74:75], v[70:71]
    s_and_b64 s[82:83], s[54:55], s[80:81]
    s_cbranch_scc1 L2_c128
L2_d128:
    v_mov_b64 v[84:85], v[70:71]
    v_mov_b32 v7, v93
    v_mov_b64 v[86:87], v[74:75]
    s_or_b64 s[80:81], s[80:81], s[54:55]
    s_mov_b64 exec, s[50:51]
    s_and_b64 s[82:83], s[50:51], s[80:81]
    s_cbranch_scc1 L2_c129
L2_d129:
    v_mov_b64 v[84:85], v[68:69]
    v_mov_b32 v7, v92
    v_mov_b64 v[86:87], v[72:73]
    s_mov_b64 exec, -1
    s_or_b64 s[80:81], s[80:81], s[50:51]
    s_and_b64 exec, s[84:85], s[80:81]
    v_mfma_f32_4x4x4_16b_bf16 v[76:79], v[12:13], v[84:85], 0
    v_mov_b32 v94, v7
    s_andn2_b64 s[80:81], s[80:81], s[84:85]
    v_mfma_f32_4x4x4_16b_bf16 v[76:79], v[10:11], v[86:87], v[76:79]
    s_mov_b64 exec, -1
    ds_read_b64 v[70:71], v95 offset:65408
    ds_read_b64 v[68:69], v94 offset:65408
    v_bitop3_b32 v92, v28, v5, v99 bitop3:0xea
    v_bitop3_b32 v93, v29, v5, v46 bitop3:0xea
    v_perm_b32 v15, v29, v30, s45
    v_bitop3_b32 v46, v29, 0.5, -0.5 bitop3:0xa8
    v_perm_b32 v14, v28, v30, s44
    v_bitop3_b32 v47, v28, 0.5, -0.5 bitop3:0xa8
    v_bitop3_b32 v15, v6, v15, v46 bitop3:0xca
    v_bitop3_b32 v14, v6, v14, v47 bitop3:0xca
    s_waitcnt lgkmcnt(1)
    v_mfma_f32_4x4x4_16b_bf16 v[80:83], v[10:11], v[70:71], v[80:83]
    s_waitcnt lgkmcnt(0)
    v_mfma_f32_4x4x4_16b_bf16 v[76:79], v[10:11], v[68:69], v[76:79]
    s_nop 2
    v_cvt_pk_bf16_f32 v80, v80, v81
    v_cvt_pk_bf16_f32 v81, v82, v83
    ds_wrxchg_rtn_b64 v[74:75], v95, v[80:81] offset:65408
    v_cvt_pk_bf16_f32 v76, v76, v77
    v_cvt_pk_bf16_f32 v77, v78, v79
    ds_wrxchg_rtn_b64 v[72:73], v94, v[76:77] offset:65408
    s_setprio 0
    v_mfma_f32_4x4x4_16b_bf16 v[80:83], v[8:9], v[102:103], 0
    v_mfma_f32_4x4x4_16b_bf16 v[76:79], v[8:9], v[100:101], 0
    v_cmp_lt_u32 s[48:49], v5, v93
    s_nop 2
    v_pk_mul_f32 v[80:81], v[80:81], v[14:15] op_sel:[0,1] op_sel_hi:[1,1]
    v_pk_mul_f32 v[82:83], v[82:83], v[14:15] op_sel:[0,1] op_sel_hi:[1,1]
    v_pk_mul_f32 v[76:77], v[76:77], v[14:15] op_sel:[0,0] op_sel_hi:[1,0]
    v_pk_mul_f32 v[78:79], v[78:79], v[14:15] op_sel:[0,0] op_sel_hi:[1,0]
    s_add_u32 s40, s40, 0xfff24000
    v_and_b32 v47, 0x0fffffff, v42
    buffer_load_dword v30, v47, s[8:11], 0 offen offset:16
    s_mov_b64 exec, s[6:7]
    v_add_u32 v47, 8, v47
    v_lshrrev_b32 v42, 2, v42
    s_mov_b64 exec, -1
    buffer_load_dwordx2 v[28:29], v47, s[8:11], 0 offen
    s_waitcnt vmcnt(8)
    v_and_b32 v46, 0x80000000, v39
    v_lshrrev_b32 v47, 14, v37
    v_bitop3_b32 v47, v47, v5, v46 bitop3:0xea
    ds_read_b64 v[102:103], v47
    v_and_b32 v99, 0x40000000, v39
    v_lshrrev_b32 v47, 14, v36
    v_bitop3_b32 v47, v47, v5, v99 bitop3:0xea
    ds_read_b64 v[100:101], v47
    v_and_b32 v46, 0x20000000, v39
    v_lshrrev_b32 v47, 14, v35
    v_bitop3_b32 v47, v47, v5, v46 bitop3:0xea
    ds_read_b64 v[106:107], v47
    v_and_b32 v99, 0x10000000, v39
    v_lshrrev_b32 v47, 14, v34
    v_bitop3_b32 v47, v47, v5, v99 bitop3:0xea
    ds_read_b64 v[104:105], v47
    s_waitcnt lgkmcnt(4)
    v_cmp_ne_u64 s[50:51], v[72:73], v[68:69]
    v_cmpx_ne_u64 s[54:55], v[74:75], v[70:71]
    s_and_b64 s[82:83], s[54:55], s[80:81]
    s_cbranch_scc1 L2_c130
L2_d130:
    v_mov_b64 v[84:85], v[70:71]
    v_mov_b32 v7, v95
    v_mov_b64 v[86:87], v[74:75]
    s_or_b64 s[80:81], s[80:81], s[54:55]
    s_mov_b64 exec, s[50:51]
    s_and_b64 s[82:83], s[50:51], s[80:81]
    s_cbranch_scc1 L2_c131
L2_d131:
    v_mov_b64 v[84:85], v[68:69]
    v_mov_b32 v7, v94
    v_mov_b64 v[86:87], v[72:73]
    s_mov_b64 exec, -1
    s_or_b64 s[80:81], s[80:81], s[50:51]
    s_and_b64 exec, s[48:49], s[80:81]
    v_mfma_f32_4x4x4_16b_bf16 v[80:83], v[12:13], v[84:85], 0
    v_mov_b32 v93, v7
    s_andn2_b64 s[80:81], s[80:81], s[48:49]
    v_mfma_f32_4x4x4_16b_bf16 v[80:83], v[10:11], v[86:87], v[80:83]
    s_mov_b64 exec, -1
    ds_read_b64 v[70:71], v93 offset:65408
    ds_read_b64 v[68:69], v92 offset:65408
    v_bitop3_b32 v94, v34, v5, v99 bitop3:0xea
    v_bitop3_b32 v95, v35, v5, v46 bitop3:0xea
    v_perm_b32 v15, v35, v38, s45
    v_bitop3_b32 v46, v35, 0.5, -0.5 bitop3:0xa8
    v_perm_b32 v14, v34, v38, s44
    v_bitop3_b32 v47, v34, 0.5, -0.5 bitop3:0xa8
    v_bitop3_b32 v15, v6, v15, v46 bitop3:0xca
    v_bitop3_b32 v14, v6, v14, v47 bitop3:0xca
    s_waitcnt lgkmcnt(1)
    v_mfma_f32_4x4x4_16b_bf16 v[80:83], v[10:11], v[70:71], v[80:83]
    s_waitcnt lgkmcnt(0)
    v_mfma_f32_4x4x4_16b_bf16 v[76:79], v[10:11], v[68:69], v[76:79]
    s_nop 2
    v_cvt_pk_bf16_f32 v80, v80, v81
    v_cvt_pk_bf16_f32 v81, v82, v83
    ds_wrxchg_rtn_b64 v[74:75], v93, v[80:81] offset:65408
    v_cvt_pk_bf16_f32 v76, v76, v77
    v_cvt_pk_bf16_f32 v77, v78, v79
    ds_wrxchg_rtn_b64 v[72:73], v92, v[76:77] offset:65408
    s_barrier
    s_setprio 3
    s_mov_b32 m0, s100
    s_nop 0
    ds_write_addtid_b32 v124 offset:34816
    ds_write_addtid_b32 v125 offset:35072
    ds_write_addtid_b32 v126 offset:35328
    ds_write_addtid_b32 v127 offset:35584
    ds_write_addtid_b32 v116 offset:32768
    ds_write_addtid_b32 v117 offset:33024
    ds_write_addtid_b32 v118 offset:33280
    ds_write_addtid_b32 v119 offset:33536
    ds_write_addtid_b32 v120 offset:33792
    ds_write_addtid_b32 v121 offset:34048
    ds_write_addtid_b32 v122 offset:34304
    ds_write_addtid_b32 v123 offset:34560
    v_mfma_f32_4x4x4_16b_bf16 v[80:83], v[8:9], v[106:107], 0
    v_mfma_f32_4x4x4_16b_bf16 v[76:79], v[8:9], v[104:105], 0
    s_nop 3
    v_pk_mul_f32 v[80:81], v[80:81], v[14:15] op_sel:[0,1] op_sel_hi:[1,1]
    v_pk_mul_f32 v[82:83], v[82:83], v[14:15] op_sel:[0,1] op_sel_hi:[1,1]
    v_pk_mul_f32 v[76:77], v[76:77], v[14:15] op_sel:[0,0] op_sel_hi:[1,0]
    v_pk_mul_f32 v[78:79], v[78:79], v[14:15] op_sel:[0,0] op_sel_hi:[1,0]
    s_setprio 2
    s_waitcnt lgkmcnt(12)
    v_cmp_ne_u64 s[50:51], v[72:73], v[68:69]
    v_cmpx_ne_u64 s[54:55], v[74:75], v[70:71]
    s_and_b64 s[82:83], s[54:55], s[80:81]
    s_cbranch_scc1 L2_c132
L2_d132:
    v_mov_b64 v[84:85], v[70:71]
    v_mov_b32 v7, v93
    v_mov_b64 v[86:87], v[74:75]
    s_or_b64 s[80:81], s[80:81], s[54:55]
    s_mov_b64 exec, s[50:51]
    s_and_b64 s[82:83], s[50:51], s[80:81]
    s_cbranch_scc1 L2_c133
L2_d133:
    v_mov_b64 v[84:85], v[68:69]
    v_mov_b32 v7, v92
    v_mov_b64 v[86:87], v[72:73]
    s_mov_b64 exec, -1
    s_or_b64 s[80:81], s[80:81], s[50:51]
    ds_read_b64 v[70:71], v95 offset:65408
    ds_read_b64 v[68:69], v94 offset:65408
    v_and_b32 v46, 0x40000000, v39
    v_bitop3_b32 v92, v36, v5, v46 bitop3:0xea
    v_and_b32 v46, 0x80000000, v39
    v_bitop3_b32 v93, v37, v5, v46 bitop3:0xea
    v_perm_b32 v15, v37, v38, s47
    v_bitop3_b32 v46, v37, 0.5, -0.5 bitop3:0xa8
    v_perm_b32 v14, v36, v38, s46
    v_bitop3_b32 v47, v36, 0.5, -0.5 bitop3:0xa8
    v_bitop3_b32 v15, v6, v15, v46 bitop3:0xca
    v_bitop3_b32 v14, v6, v14, v47 bitop3:0xca
    s_setprio 1
    s_waitcnt lgkmcnt(1)
    v_mfma_f32_4x4x4_16b_bf16 v[80:83], v[10:11], v[70:71], v[80:83]
    s_waitcnt lgkmcnt(0)
    v_mfma_f32_4x4x4_16b_bf16 v[76:79], v[10:11], v[68:69], v[76:79]
    s_nop 2
    v_cvt_pk_bf16_f32 v80, v80, v81
    v_cvt_pk_bf16_f32 v81, v82, v83
    ds_wrxchg_rtn_b64 v[74:75], v95, v[80:81] offset:65408
    v_cvt_pk_bf16_f32 v76, v76, v77
    v_cvt_pk_bf16_f32 v77, v78, v79
    ds_wrxchg_rtn_b64 v[72:73], v94, v[76:77] offset:65408
    v_and_b32 v88, 0x0fffffff, v43
    buffer_load_dwordx2 v[34:35], v88, s[8:11], 0 offen
    buffer_load_dwordx3 v[36:38], v88, s[8:11], 0 offen offset:8
    s_setprio 0
    s_waitcnt vmcnt(9)
    s_mov_b32 m0, s38
    s_nop 0
    ds_write_addtid_b32 v108 offset:0
    ds_write_addtid_b32 v109 offset:256
    ds_write_addtid_b32 v110 offset:512
    ds_write_addtid_b32 v111 offset:768
    s_waitcnt vmcnt(6)
    ds_write_addtid_b32 v112 offset:1024
    ds_write_addtid_b32 v113 offset:1280
    ds_write_addtid_b32 v114 offset:1536
    ds_write_addtid_b32 v115 offset:1792
    v_mfma_f32_4x4x4_16b_bf16 v[80:83], v[8:9], v[102:103], 0
    v_mfma_f32_4x4x4_16b_bf16 v[76:79], v[8:9], v[100:101], 0
    v_cmp_lt_u32 s[84:85], v5, v92
    s_nop 2
    v_pk_mul_f32 v[80:81], v[80:81], v[14:15] op_sel:[0,1] op_sel_hi:[1,1]
    v_pk_mul_f32 v[82:83], v[82:83], v[14:15] op_sel:[0,1] op_sel_hi:[1,1]
    v_pk_mul_f32 v[76:77], v[76:77], v[14:15] op_sel:[0,0] op_sel_hi:[1,0]
    v_pk_mul_f32 v[78:79], v[78:79], v[14:15] op_sel:[0,0] op_sel_hi:[1,0]
    s_add_u32 s42, s42, 1
    s_waitcnt lgkmcnt(0)
    s_barrier
    s_bitcmp1_b32 s36, s42
    s_cbranch_scc1 L2_slow
L2_ret7:
    s_setprio 3
    s_bitcmp1_b32 s43, s42
    s_cbranch_scc1 L2_oa134
L2_ob134:
    v_and_b32 v46, 0x20000000, v40
    v_lshrrev_b32 v47, 14, v17
    v_bitop3_b32 v47, v47, v5, v46 bitop3:0xea
    ds_read_b64 v[106:107], v47
    v_and_b32 v99, 0x10000000, v40
    v_lshrrev_b32 v47, 14, v16
    v_bitop3_b32 v47, v47, v5, v99 bitop3:0xea
    ds_read_b64 v[104:105], v47
    v_cmp_ne_u64 s[50:51], v[72:73], v[68:69]
    v_cmpx_ne_u64 s[54:55], v[74:75], v[70:71]
    s_and_b64 s[82:83], s[54:55], s[80:81]
    s_cbranch_scc1 L2_c135
L2_d135:
    v_mov_b64 v[84:85], v[70:71]
    v_mov_b32 v7, v95
    v_mov_b64 v[86:87], v[74:75]
    s_or_b64 s[80:81], s[80:81], s[54:55]
    s_mov_b64 exec, s[50:51]
    s_and_b64 s[82:83], s[50:51], s[80:81]
    s_cbranch_scc1 L2_c136
L2_d136:
    v_mov_b64 v[84:85], v[68:69]
    v_mov_b32 v7, v94
    v_mov_b64 v[86:87], v[72:73]
    s_mov_b64 exec, -1
    s_or_b64 s[80:81], s[80:81], s[50:51]
    s_and_b64 exec, s[84:85], s[80:81]
    v_mfma_f32_4x4x4_16b_bf16 v[76:79], v[12:13], v[84:85], 0
    v_mov_b32 v92, v7
    s_andn2_b64 s[80:81], s[80:81], s[84:85]
    v_mfma_f32_4x4x4_16b_bf16 v[76:79], v[10:11], v[86:87], v[76:79]
    s_mov_b64 exec, -1
    ds_read_b64 v[70:71], v93 offset:65408
    ds_read_b64 v[68:69], v92 offset:65408
    v_bitop3_b32 v94, v16, v5, v99 bitop3:0xea
    v_bitop3_b32 v95, v17, v5, v46 bitop3:0xea
    v_perm_b32 v15, v17, v20, s45
    v_bitop3_b32 v46, v17, 0.5, -0.5 bitop3:0xa8
    v_perm_b32 v14, v16, v20, s44
    v_bitop3_b32 v47, v16, 0.5, -0.5 bitop3:0xa8
    v_bitop3_b32 v15, v6, v15, v46 bitop3:0xca
    v_bitop3_b32 v14, v6, v14, v47 bitop3:0xca
    s_waitcnt lgkmcnt(1)
    v_mfma_f32_4x4x4_16b_bf16 v[80:83], v[10:11], v[70:71], v[80:83]
    s_waitcnt lgkmcnt(0)
    v_mfma_f32_4x4x4_16b_bf16 v[76:79], v[10:11], v[68:69], v[76:79]
    s_nop 2
    v_cvt_pk_bf16_f32 v80, v80, v81
    v_cvt_pk_bf16_f32 v81, v82, v83
    ds_wrxchg_rtn_b64 v[74:75], v93, v[80:81] offset:65408
    v_cvt_pk_bf16_f32 v76, v76, v77
    v_cvt_pk_bf16_f32 v77, v78, v79
    ds_wrxchg_rtn_b64 v[72:73], v92, v[76:77] offset:65408
    v_mfma_f32_4x4x4_16b_bf16 v[80:83], v[8:9], v[106:107], 0
    v_mfma_f32_4x4x4_16b_bf16 v[76:79], v[8:9], v[104:105], 0
    v_cmp_lt_u32 s[84:85], v5, v94
    s_nop 2
    v_pk_mul_f32 v[80:81], v[80:81], v[14:15] op_sel:[0,1] op_sel_hi:[1,1]
    v_pk_mul_f32 v[82:83], v[82:83], v[14:15] op_sel:[0,1] op_sel_hi:[1,1]
    v_pk_mul_f32 v[76:77], v[76:77], v[14:15] op_sel:[0,0] op_sel_hi:[1,0]
    v_pk_mul_f32 v[78:79], v[78:79], v[14:15] op_sel:[0,0] op_sel_hi:[1,0]
    v_and_b32 v46, 0x80000000, v40
    v_lshrrev_b32 v47, 14, v19
    v_bitop3_b32 v47, v47, v5, v46 bitop3:0xea
    ds_read_b64 v[102:103], v47
    v_and_b32 v99, 0x40000000, v40
    v_lshrrev_b32 v47, 14, v18
    v_bitop3_b32 v47, v47, v5, v99 bitop3:0xea
    ds_read_b64 v[100:101], v47
    s_waitcnt lgkmcnt(2)
    v_cmp_ne_u64 s[50:51], v[72:73], v[68:69]
    v_cmpx_ne_u64 s[54:55], v[74:75], v[70:71]
    s_and_b64 s[82:83], s[54:55], s[80:81]
    s_cbranch_scc1 L2_c137
L2_d137:
    v_mov_b64 v[84:85], v[70:71]
    v_mov_b32 v7, v93
    v_mov_b64 v[86:87], v[74:75]
    s_or_b64 s[80:81], s[80:81], s[54:55]
    s_mov_b64 exec, s[50:51]
    s_and_b64 s[82:83], s[50:51], s[80:81]
    s_cbranch_scc1 L2_c138
L2_d138:
    v_mov_b64 v[84:85], v[68:69]
    v_mov_b32 v7, v92
    v_mov_b64 v[86:87], v[72:73]
    s_mov_b64 exec, -1
    s_or_b64 s[80:81], s[80:81], s[50:51]
    s_and_b64 exec, s[84:85], s[80:81]
    v_mfma_f32_4x4x4_16b_bf16 v[76:79], v[12:13], v[84:85], 0
    v_mov_b32 v94, v7
    s_andn2_b64 s[80:81], s[80:81], s[84:85]
    v_mfma_f32_4x4x4_16b_bf16 v[76:79], v[10:11], v[86:87], v[76:79]
    s_mov_b64 exec, -1
    ds_read_b64 v[70:71], v95 offset:65408
    ds_read_b64 v[68:69], v94 offset:65408
    v_bitop3_b32 v92, v18, v5, v99 bitop3:0xea
    v_bitop3_b32 v93, v19, v5, v46 bitop3:0xea
    v_perm_b32 v15, v19, v20, s47
    v_bitop3_b32 v46, v19, 0.5, -0.5 bitop3:0xa8
    v_perm_b32 v14, v18, v20, s46
    v_bitop3_b32 v47, v18, 0.5, -0.5 bitop3:0xa8
    v_bitop3_b32 v15, v6, v15, v46 bitop3:0xca
    v_bitop3_b32 v14, v6, v14, v47 bitop3:0xca
    s_waitcnt lgkmcnt(1)
    v_mfma_f32_4x4x4_16b_bf16 v[80:83], v[10:11], v[70:71], v[80:83]
    s_waitcnt lgkmcnt(0)
    v_mfma_f32_4x4x4_16b_bf16 v[76:79], v[10:11], v[68:69], v[76:79]
    s_nop 2
    v_cvt_pk_bf16_f32 v80, v80, v81
    v_cvt_pk_bf16_f32 v81, v82, v83
    ds_wrxchg_rtn_b64 v[74:75], v95, v[80:81] offset:65408
    v_cvt_pk_bf16_f32 v76, v76, v77
    v_cvt_pk_bf16_f32 v77, v78, v79
    ds_wrxchg_rtn_b64 v[72:73], v94, v[76:77] offset:65408
    s_setprio 2
    v_mfma_f32_4x4x4_16b_bf16 v[80:83], v[8:9], v[102:103], 0
    v_mfma_f32_4x4x4_16b_bf16 v[76:79], v[8:9], v[100:101], 0
    v_cmp_lt_u32 s[48:49], v5, v93
    s_nop 2
    v_pk_mul_f32 v[80:81], v[80:81], v[14:15] op_sel:[0,1] op_sel_hi:[1,1]
    v_pk_mul_f32 v[82:83], v[82:83], v[14:15] op_sel:[0,1] op_sel_hi:[1,1]
    v_pk_mul_f32 v[76:77], v[76:77], v[14:15] op_sel:[0,0] op_sel_hi:[1,0]
    v_pk_mul_f32 v[78:79], v[78:79], v[14:15] op_sel:[0,0] op_sel_hi:[1,0]
    s_lshl_b32 s3, s32, 12
    v_subrev_u32 v122, s3, v3
    s_mul_i32 s3, s33, 20000
    v_add_u32 v118, s3, v122
    v_add_u32 v119, 0x4000, v118
    s_lshl_b32 s3, s34, 7
    v_lshrrev_b32 v123, 7, v118
    v_and_b32 v120, 0x70, v118
    v_lshl_add_u32 v120, v123, 13, v120
    v_add_u32 v120, s3, v120
    v_lshrrev_b32 v123, 7, v119
    v_and_b32 v121, 0x70, v119
    v_lshl_add_u32 v121, v123, 13, v121
    v_add_u32 v121, s3, v121
    v_cmp_le_u32 vcc, 3616, v122
    s_mov_b64 exec, vcc
    v_mov_b32 v119, 2.0
    v_mov_b32 v121, 2.0
    s_mov_b64 exec, -1
    v_and_b32 v123, 0x30, v122
    v_lshlrev_b32 v123, 2, v123
    buffer_load_dwordx4 v[48:51], v123, s[24:27], 0 offen
    buffer_load_dwordx4 v[52:55], v123, s[24:27], 0 offen offset:16
    buffer_load_dwordx2 v[56:57], v123, s[24:27], 0 offen offset:32
    s_mov_b32 s12, s4
    s_mov_b32 s13, s5
    s_mov_b32 s14, 0x138800
    s_mov_b32 s15, 0x20000
    s_mov_b32 s16, s28
    s_mov_b32 s17, s29
    s_mov_b32 s18, 0x4e2000
    s_mov_b32 s19, 0x20000
    v_lshrrev_b32 v123, 2, v120
    buffer_load_dword v116, v123, s[12:15], 0 offen
    buffer_load_dwordx4 v[108:111], v120, s[16:19], 0 offen
    v_lshrrev_b32 v123, 2, v121
    buffer_load_dword v117, v123, s[12:15], 0 offen
    buffer_load_dwordx4 v[124:127], v121, s[16:19], 0 offen
    s_waitcnt vmcnt(11)
    v_and_b32 v46, 0x20000000, v41
    v_lshrrev_b32 v47, 14, v23
    v_bitop3_b32 v47, v47, v5, v46 bitop3:0xea
    ds_read_b64 v[106:107], v47
    v_and_b32 v99, 0x10000000, v41
    v_lshrrev_b32 v47, 14, v22
    v_bitop3_b32 v47, v47, v5, v99 bitop3:0xea
    ds_read_b64 v[104:105], v47
    s_waitcnt lgkmcnt(2)
    v_cmp_ne_u64 s[50:51], v[72:73], v[68:69]
    v_cmpx_ne_u64 s[54:55], v[74:75], v[70:71]
    s_and_b64 s[82:83], s[54:55], s[80:81]
    s_cbranch_scc1 L2_c139
L2_d139:
    v_mov_b64 v[84:85], v[70:71]
    v_mov_b32 v7, v95
    v_mov_b64 v[86:87], v[74:75]
    s_or_b64 s[80:81], s[80:81], s[54:55]
    s_mov_b64 exec, s[50:51]
    s_and_b64 s[82:83], s[50:51], s[80:81]
    s_cbranch_scc1 L2_c140
L2_d140:
    v_mov_b64 v[84:85], v[68:69]
    v_mov_b32 v7, v94
    v_mov_b64 v[86:87], v[72:73]
    s_mov_b64 exec, -1
    s_or_b64 s[80:81], s[80:81], s[50:51]
    s_and_b64 exec, s[48:49], s[80:81]
    v_mfma_f32_4x4x4_16b_bf16 v[80:83], v[12:13], v[84:85], 0
    v_mov_b32 v93, v7
    s_andn2_b64 s[80:81], s[80:81], s[48:49]
    v_mfma_f32_4x4x4_16b_bf16 v[80:83], v[10:11], v[86:87], v[80:83]
    s_mov_b64 exec, -1
    ds_read_b64 v[70:71], v93 offset:65408
    ds_read_b64 v[68:69], v92 offset:65408
    v_bitop3_b32 v94, v22, v5, v99 bitop3:0xea
    v_bitop3_b32 v95, v23, v5, v46 bitop3:0xea
    v_perm_b32 v15, v23, v26, s45
    v_bitop3_b32 v46, v23, 0.5, -0.5 bitop3:0xa8
    v_perm_b32 v14, v22, v26, s44
    v_bitop3_b32 v47, v22, 0.5, -0.5 bitop3:0xa8
    v_bitop3_b32 v15, v6, v15, v46 bitop3:0xca
    v_bitop3_b32 v14, v6, v14, v47 bitop3:0xca
    s_waitcnt lgkmcnt(1)
    v_mfma_f32_4x4x4_16b_bf16 v[80:83], v[10:11], v[70:71], v[80:83]
    s_waitcnt lgkmcnt(0)
    v_mfma_f32_4x4x4_16b_bf16 v[76:79], v[10:11], v[68:69], v[76:79]
    s_nop 2
    v_cvt_pk_bf16_f32 v80, v80, v81
    v_cvt_pk_bf16_f32 v81, v82, v83
    ds_wrxchg_rtn_b64 v[74:75], v93, v[80:81] offset:65408
    v_cvt_pk_bf16_f32 v76, v76, v77
    v_cvt_pk_bf16_f32 v77, v78, v79
    ds_wrxchg_rtn_b64 v[72:73], v92, v[76:77] offset:65408
    s_setprio 1
    v_mfma_f32_4x4x4_16b_bf16 v[80:83], v[8:9], v[106:107], 0
    v_mfma_f32_4x4x4_16b_bf16 v[76:79], v[8:9], v[104:105], 0
    s_nop 3
    v_pk_mul_f32 v[80:81], v[80:81], v[14:15] op_sel:[0,1] op_sel_hi:[1,1]
    v_pk_mul_f32 v[82:83], v[82:83], v[14:15] op_sel:[0,1] op_sel_hi:[1,1]
    v_pk_mul_f32 v[76:77], v[76:77], v[14:15] op_sel:[0,0] op_sel_hi:[1,0]
    v_pk_mul_f32 v[78:79], v[78:79], v[14:15] op_sel:[0,0] op_sel_hi:[1,0]
    s_bitcmp1_b32 s43, s42
    s_cbranch_scc1 L2_oa141
L2_ob141:
    v_and_b32 v46, 0x80000000, v41
    v_lshrrev_b32 v47, 14, v25
    v_bitop3_b32 v47, v47, v5, v46 bitop3:0xea
    ds_read_b64 v[102:103], v47
    v_and_b32 v99, 0x40000000, v41
    v_lshrrev_b32 v47, 14, v24
    v_bitop3_b32 v47, v47, v5, v99 bitop3:0xea
    ds_read_b64 v[100:101], v47
    s_waitcnt lgkmcnt(2)
    v_cmp_ne_u64 s[50:51], v[72:73], v[68:69]
    v_cmpx_ne_u64 s[54:55], v[74:75], v[70:71]
    s_and_b64 s[82:83], s[54:55], s[80:81]
    s_cbranch_scc1 L2_c142
L2_d142:
    v_mov_b64 v[84:85], v[70:71]
    v_mov_b32 v7, v93
    v_mov_b64 v[86:87], v[74:75]
    s_or_b64 s[80:81], s[80:81], s[54:55]
    s_mov_b64 exec, s[50:51]
    s_and_b64 s[82:83], s[50:51], s[80:81]
    s_cbranch_scc1 L2_c143
L2_d143:
    v_mov_b64 v[84:85], v[68:69]
    v_mov_b32 v7, v92
    v_mov_b64 v[86:87], v[72:73]
    s_mov_b64 exec, -1
    s_or_b64 s[80:81], s[80:81], s[50:51]
    ds_read_b64 v[70:71], v95 offset:65408
    ds_read_b64 v[68:69], v94 offset:65408
    v_bitop3_b32 v92, v24, v5, v99 bitop3:0xea
    v_bitop3_b32 v93, v25, v5, v46 bitop3:0xea
    v_perm_b32 v15, v25, v26, s47
    v_bitop3_b32 v46, v25, 0.5, -0.5 bitop3:0xa8
    v_perm_b32 v14, v24, v26, s46
    v_bitop3_b32 v47, v24, 0.5, -0.5 bitop3:0xa8
    v_bitop3_b32 v15, v6, v15, v46 bitop3:0xca
    v_bitop3_b32 v14, v6, v14, v47 bitop3:0xca
    s_waitcnt lgkmcnt(1)
    v_mfma_f32_4x4x4_16b_bf16 v[80:83], v[10:11], v[70:71], v[80:83]
    s_waitcnt lgkmcnt(0)
    v_mfma_f32_4x4x4_16b_bf16 v[76:79], v[10:11], v[68:69], v[76:79]
    s_nop 2
    v_cvt_pk_bf16_f32 v80, v80, v81
    v_cvt_pk_bf16_f32 v81, v82, v83
    ds_wrxchg_rtn_b64 v[74:75], v95, v[80:81] offset:65408
    v_cvt_pk_bf16_f32 v76, v76, v77
    v_cvt_pk_bf16_f32 v77, v78, v79
    ds_wrxchg_rtn_b64 v[72:73], v94, v[76:77] offset:65408
    v_mfma_f32_4x4x4_16b_bf16 v[80:83], v[8:9], v[102:103], 0
    v_mfma_f32_4x4x4_16b_bf16 v[76:79], v[8:9], v[100:101], 0
    v_cmp_lt_u32 s[84:85], v5, v92
    s_nop 2
    v_pk_mul_f32 v[80:81], v[80:81], v[14:15] op_sel:[0,1] op_sel_hi:[1,1]
    v_pk_mul_f32 v[82:83], v[82:83], v[14:15] op_sel:[0,1] op_sel_hi:[1,1]
    v_pk_mul_f32 v[76:77], v[76:77], v[14:15] op_sel:[0,0] op_sel_hi:[1,0]
    v_pk_mul_f32 v[78:79], v[78:79], v[14:15] op_sel:[0,0] op_sel_hi:[1,0]
    s_waitcnt vmcnt(9)
    s_mov_b64 exec, s[6:7]
    v_lshrrev_b32 v30, 16, v30
    s_mov_b64 exec, -1
    v_and_b32 v46, 0x20000000, v42
    v_lshrrev_b32 v47, 14, v29
    v_bitop3_b32 v47, v47, v5, v46 bitop3:0xea
    ds_read_b64 v[106:107], v47
    v_and_b32 v99, 0x10000000, v42
    v_lshrrev_b32 v47, 14, v28
    v_bitop3_b32 v47, v47, v5, v99 bitop3:0xea
    ds_read_b64 v[104:105], v47
    s_waitcnt lgkmcnt(2)
    v_cmp_ne_u64 s[50:51], v[72:73], v[68:69]
    v_cmpx_ne_u64 s[54:55], v[74:75], v[70:71]
    s_and_b64 s[82:83], s[54:55], s[80:81]
    s_cbranch_scc1 L2_c144
L2_d144:
    v_mov_b64 v[84:85], v[70:71]
    v_mov_b32 v7, v95
    v_mov_b64 v[86:87], v[74:75]
    s_or_b64 s[80:81], s[80:81], s[54:55]
    s_mov_b64 exec, s[50:51]
    s_and_b64 s[82:83], s[50:51], s[80:81]
    s_cbranch_scc1 L2_c145
L2_d145:
    v_mov_b64 v[84:85], v[68:69]
    v_mov_b32 v7, v94
    v_mov_b64 v[86:87], v[72:73]
    s_mov_b64 exec, -1
    s_or_b64 s[80:81], s[80:81], s[50:51]
    s_and_b64 exec, s[84:85], s[80:81]
    v_mfma_f32_4x4x4_16b_bf16 v[76:79], v[12:13], v[84:85], 0
    v_mov_b32 v92, v7
    s_andn2_b64 s[80:81], s[80:81], s[84:85]
    v_mfma_f32_4x4x4_16b_bf16 v[76:79], v[10:11], v[86:87], v[76:79]
    s_mov_b64 exec, -1
    ds_read_b64 v[70:71], v93 offset:65408
    ds_read_b64 v[68:69], v92 offset:65408
    v_bitop3_b32 v94, v28, v5, v99 bitop3:0xea
    v_bitop3_b32 v95, v29, v5, v46 bitop3:0xea
    v_perm_b32 v15, v29, v30, s45
    v_bitop3_b32 v46, v29, 0.5, -0.5 bitop3:0xa8
    v_perm_b32 v14, v28, v30, s44
    v_bitop3_b32 v47, v28, 0.5, -0.5 bitop3:0xa8
    v_bitop3_b32 v15, v6, v15, v46 bitop3:0xca
    v_bitop3_b32 v14, v6, v14, v47 bitop3:0xca
    s_waitcnt lgkmcnt(1)
    v_mfma_f32_4x4x4_16b_bf16 v[80:83], v[10:11], v[70:71], v[80:83]
    s_waitcnt lgkmcnt(0)
    v_mfma_f32_4x4x4_16b_bf16 v[76:79], v[10:11], v[68:69], v[76:79]
    s_nop 2
    v_cvt_pk_bf16_f32 v80, v80, v81
    v_cvt_pk_bf16_f32 v81, v82, v83
    ds_wrxchg_rtn_b64 v[74:75], v93, v[80:81] offset:65408
    v_cvt_pk_bf16_f32 v76, v76, v77
    v_cvt_pk_bf16_f32 v77, v78, v79
    ds_wrxchg_rtn_b64 v[72:73], v92, v[76:77] offset:65408
    s_setprio 0
    v_mfma_f32_4x4x4_16b_bf16 v[80:83], v[8:9], v[106:107], 0
    v_mfma_f32_4x4x4_16b_bf16 v[76:79], v[8:9], v[104:105], 0
    v_cmp_lt_u32 s[48:49], v5, v95
    s_nop 2
    v_pk_mul_f32 v[80:81], v[80:81], v[14:15] op_sel:[0,1] op_sel_hi:[1,1]
    v_pk_mul_f32 v[82:83], v[82:83], v[14:15] op_sel:[0,1] op_sel_hi:[1,1]
    v_pk_mul_f32 v[76:77], v[76:77], v[14:15] op_sel:[0,0] op_sel_hi:[1,0]
    v_pk_mul_f32 v[78:79], v[78:79], v[14:15] op_sel:[0,0] op_sel_hi:[1,0]
    s_waitcnt vmcnt(7)
    v_and_b32 v46, 0x80000000, v43
    v_lshrrev_b32 v47, 14, v37
    v_bitop3_b32 v47, v47, v5, v46 bitop3:0xea
    ds_read_b64 v[106:107], v47
    v_and_b32 v99, 0x40000000, v43
    v_lshrrev_b32 v47, 14, v36
    v_bitop3_b32 v47, v47, v5, v99 bitop3:0xea
    ds_read_b64 v[104:105], v47
    v_and_b32 v46, 0x20000000, v43
    v_lshrrev_b32 v47, 14, v35
    v_bitop3_b32 v47, v47, v5, v46 bitop3:0xea
    ds_read_b64 v[102:103], v47
    v_and_b32 v99, 0x10000000, v43
    v_lshrrev_b32 v47, 14, v34
    v_bitop3_b32 v47, v47, v5, v99 bitop3:0xea
    ds_read_b64 v[100:101], v47
    s_waitcnt lgkmcnt(4)
    v_cmp_ne_u64 s[50:51], v[72:73], v[68:69]
    v_cmpx_ne_u64 s[54:55], v[74:75], v[70:71]
    s_and_b64 s[82:83], s[54:55], s[80:81]
    s_cbranch_scc1 L2_c146
L2_d146:
    v_mov_b64 v[84:85], v[70:71]
    v_mov_b32 v7, v93
    v_mov_b64 v[86:87], v[74:75]
    s_or_b64 s[80:81], s[80:81], s[54:55]
    s_mov_b64 exec, s[50:51]
    s_and_b64 s[82:83], s[50:51], s[80:81]
    s_cbranch_scc1 L2_c147
L2_d147:
    v_mov_b64 v[84:85], v[68:69]
    v_mov_b32 v7, v92
    v_mov_b64 v[86:87], v[72:73]
    s_mov_b64 exec, -1
    s_or_b64 s[80:81], s[80:81], s[50:51]
    s_and_b64 exec, s[48:49], s[80:81]
    v_mfma_f32_4x4x4_16b_bf16 v[80:83], v[12:13], v[84:85], 0
    v_mov_b32 v95, v7
    s_andn2_b64 s[80:81], s[80:81], s[48:49]
    v_mfma_f32_4x4x4_16b_bf16 v[80:83], v[10:11], v[86:87], v[80:83]
    s_mov_b64 exec, -1
    ds_read_b64 v[70:71], v95 offset:65408
    ds_read_b64 v[68:69], v94 offset:65408
    v_bitop3_b32 v92, v34, v5, v99 bitop3:0xea
    v_bitop3_b32 v93, v35, v5, v46 bitop3:0xea
    v_perm_b32 v15, v35, v38, s45
    v_bitop3_b32 v46, v35, 0.5, -0.5 bitop3:0xa8
    v_perm_b32 v14, v34, v38, s44
    v_bitop3_b32 v47, v34, 0.5, -0.5 bitop3:0xa8
    v_bitop3_b32 v15, v6, v15, v46 bitop3:0xca
    v_bitop3_b32 v14, v6, v14, v47 bitop3:0xca
    s_waitcnt lgkmcnt(1)
    v_mfma_f32_4x4x4_16b_bf16 v[80:83], v[10:11], v[70:71], v[80:83]
    s_waitcnt lgkmcnt(0)
    v_mfma_f32_4x4x4_16b_bf16 v[76:79], v[10:11], v[68:69], v[76:79]
    s_nop 2
    v_cvt_pk_bf16_f32 v80, v80, v81
    v_cvt_pk_bf16_f32 v81, v82, v83
    ds_wrxchg_rtn_b64 v[74:75], v95, v[80:81] offset:65408
    v_cvt_pk_bf16_f32 v76, v76, v77
    v_cvt_pk_bf16_f32 v77, v78, v79
    ds_wrxchg_rtn_b64 v[72:73], v94, v[76:77] offset:65408
    v_mfma_f32_4x4x4_16b_bf16 v[80:83], v[8:9], v[102:103], 0
    v_mfma_f32_4x4x4_16b_bf16 v[76:79], v[8:9], v[100:101], 0
    s_nop 3
    v_pk_mul_f32 v[80:81], v[80:81], v[14:15] op_sel:[0,1] op_sel_hi:[1,1]
    v_pk_mul_f32 v[82:83], v[82:83], v[14:15] op_sel:[0,1] op_sel_hi:[1,1]
    v_pk_mul_f32 v[76:77], v[76:77], v[14:15] op_sel:[0,0] op_sel_hi:[1,0]
    v_pk_mul_f32 v[78:79], v[78:79], v[14:15] op_sel:[0,0] op_sel_hi:[1,0]
    s_waitcnt lgkmcnt(0)
    v_cmp_ne_u64 s[50:51], v[72:73], v[68:69]
    v_cmpx_ne_u64 s[54:55], v[74:75], v[70:71]
    s_and_b64 s[82:83], s[54:55], s[80:81]
    s_cbranch_scc1 L2_c148
L2_d148:
    v_mov_b64 v[84:85], v[70:71]
    v_mov_b32 v7, v95
    v_mov_b64 v[86:87], v[74:75]
    s_or_b64 s[80:81], s[80:81], s[54:55]
    s_mov_b64 exec, s[50:51]
    s_and_b64 s[82:83], s[50:51], s[80:81]
    s_cbranch_scc1 L2_c149
L2_d149:
    v_mov_b64 v[84:85], v[68:69]
    v_mov_b32 v7, v94
    v_mov_b64 v[86:87], v[72:73]
    s_mov_b64 exec, -1
    s_or_b64 s[80:81], s[80:81], s[50:51]
    ds_read_b64 v[70:71], v93 offset:65408
    ds_read_b64 v[68:69], v92 offset:65408
    v_and_b32 v46, 0x40000000, v43
    v_bitop3_b32 v94, v36, v5, v46 bitop3:0xea
    v_and_b32 v46, 0x80000000, v43
    v_bitop3_b32 v95, v37, v5, v46 bitop3:0xea
    v_perm_b32 v15, v37, v38, s47
    v_bitop3_b32 v46, v37, 0.5, -0.5 bitop3:0xa8
    v_perm_b32 v14, v36, v38, s46
    v_bitop3_b32 v47, v36, 0.5, -0.5 bitop3:0xa8
    v_bitop3_b32 v15, v6, v15, v46 bitop3:0xca
    v_bitop3_b32 v14, v6, v14, v47 bitop3:0xca
    s_waitcnt lgkmcnt(1)
    v_mfma_f32_4x4x4_16b_bf16 v[80:83], v[10:11], v[70:71], v[80:83]
    s_waitcnt lgkmcnt(0)
    v_mfma_f32_4x4x4_16b_bf16 v[76:79], v[10:11], v[68:69], v[76:79]
    s_nop 2
    v_cvt_pk_bf16_f32 v80, v80, v81
    v_cvt_pk_bf16_f32 v81, v82, v83
    ds_wrxchg_rtn_b64 v[74:75], v93, v[80:81] offset:65408
    v_cvt_pk_bf16_f32 v76, v76, v77
    v_cvt_pk_bf16_f32 v77, v78, v79
    ds_wrxchg_rtn_b64 v[72:73], v92, v[76:77] offset:65408
    v_mfma_f32_4x4x4_16b_bf16 v[80:83], v[8:9], v[106:107], 0
    v_mfma_f32_4x4x4_16b_bf16 v[76:79], v[8:9], v[104:105], 0
    v_cmp_lt_u32 s[84:85], v5, v94
    s_nop 2
    v_pk_mul_f32 v[80:81], v[80:81], v[14:15] op_sel:[0,1] op_sel_hi:[1,1]
    v_pk_mul_f32 v[82:83], v[82:83], v[14:15] op_sel:[0,1] op_sel_hi:[1,1]
    v_pk_mul_f32 v[76:77], v[76:77], v[14:15] op_sel:[0,0] op_sel_hi:[1,0]
    v_pk_mul_f32 v[78:79], v[78:79], v[14:15] op_sel:[0,0] op_sel_hi:[1,0]
    s_waitcnt lgkmcnt(0)
    v_cmp_ne_u64 s[50:51], v[72:73], v[68:69]
    v_cmpx_ne_u64 s[54:55], v[74:75], v[70:71]
    s_and_b64 s[82:83], s[54:55], s[80:81]
    s_cbranch_scc1 L2_c150
L2_d150:
    v_mov_b64 v[84:85], v[70:71]
    v_mov_b32 v7, v93
    v_mov_b64 v[86:87], v[74:75]
    s_or_b64 s[80:81], s[80:81], s[54:55]
    s_mov_b64 exec, s[50:51]
    s_and_b64 s[82:83], s[50:51], s[80:81]
    s_cbranch_scc1 L2_c151
L2_d151:
    v_mov_b64 v[84:85], v[68:69]
    v_mov_b32 v7, v92
    v_mov_b64 v[86:87], v[72:73]
    s_mov_b64 exec, -1
    s_or_b64 s[80:81], s[80:81], s[50:51]
    s_and_b64 exec, s[84:85], s[80:81]
    v_mfma_f32_4x4x4_16b_bf16 v[76:79], v[12:13], v[84:85], 0
    v_mov_b32 v94, v7
    s_andn2_b64 s[80:81], s[80:81], s[84:85]
    v_mfma_f32_4x4x4_16b_bf16 v[76:79], v[10:11], v[86:87], v[76:79]
    s_mov_b64 exec, -1
    ds_read_b64 v[70:71], v95 offset:65408
    ds_read_b64 v[68:69], v94 offset:65408
    s_waitcnt lgkmcnt(1)
    v_mfma_f32_4x4x4_16b_bf16 v[80:83], v[10:11], v[70:71], v[80:83]
    s_waitcnt lgkmcnt(0)
    v_mfma_f32_4x4x4_16b_bf16 v[76:79], v[10:11], v[68:69], v[76:79]
    s_nop 2
    v_cvt_pk_bf16_f32 v80, v80, v81
    v_cvt_pk_bf16_f32 v81, v82, v83
    ds_wrxchg_rtn_b64 v[74:75], v95, v[80:81] offset:65408
    v_cvt_pk_bf16_f32 v76, v76, v77
    v_cvt_pk_bf16_f32 v77, v78, v79
    ds_wrxchg_rtn_b64 v[72:73], v94, v[76:77] offset:65408
    s_waitcnt lgkmcnt(0)
    v_cmpx_ne_u64 vcc, v[74:75], v[70:71]
    s_and_b64 s[82:83], vcc, s[80:81]
    s_cbranch_scc1 L2_c152
L2_d152:
    v_mov_b64 v[84:85], v[70:71]
    v_mov_b32 v7, v95
    v_mov_b64 v[86:87], v[74:75]
    s_mov_b64 exec, -1
    s_or_b64 s[80:81], s[80:81], vcc
    v_cmpx_ne_u64 vcc, v[72:73], v[68:69]
    s_and_b64 s[82:83], vcc, s[80:81]
    s_cbranch_scc1 L2_c153
L2_d153:
    v_mov_b64 v[84:85], v[68:69]
    v_mov_b32 v7, v94
    v_mov_b64 v[86:87], v[72:73]
    s_mov_b64 exec, -1
    s_or_b64 s[80:81], s[80:81], vcc
    s_mov_b64 exec, s[80:81]
    ds_read_b64 v[68:69], v7 offset:65408
    v_mfma_f32_4x4x4_16b_bf16 v[76:79], v[12:13], v[84:85], 0
    s_nop 1
    v_mfma_f32_4x4x4_16b_bf16 v[76:79], v[10:11], v[86:87], v[76:79]
    s_waitcnt lgkmcnt(0)
    s_nop 0
    v_mfma_f32_4x4x4_16b_bf16 v[76:79], v[10:11], v[68:69], v[76:79]
    v_mov_b64 v[84:85], v[68:69]
    s_nop 3
    v_cvt_pk_bf16_f32 v76, v76, v77
    v_cvt_pk_bf16_f32 v77, v78, v79
    ds_wrxchg_rtn_b64 v[86:87], v7, v[76:77] offset:65408
    s_waitcnt lgkmcnt(0)
    v_cmp_ne_u64 s[80:81], v[86:87], v[84:85]
    s_mov_b64 exec, s[80:81]
    s_nop 1
    v_mfma_f32_4x4x4_16b_bf16 v[88:91], v[12:13], v[84:85], 0
    s_nop 1
    v_mfma_f32_4x4x4_16b_bf16 v[88:91], v[10:11], v[86:87], v[88:91]
    s_nop 4
    v_cvt_pk_bf16_f32 v88, v88, v89
    v_cvt_pk_bf16_f32 v89, v90, v91
    ds_pk_add_bf16 v7, v88 offset:65408
    ds_pk_add_bf16 v7, v89 offset:65412
    s_mov_b64 exec, -1
    s_load_dwordx2 s[4:5], s[0:1], 88
    v_add_u32 v123, 0x4000, v122
    s_lshl_b32 s50, s96, 16
    s_and_b32 s51, s96, 0xffff0000
    s_lshl_b32 s52, s97, 16
    s_and_b32 s53, s97, 0xffff0000
    s_lshl_b32 s54, s98, 16
    s_and_b32 s55, s98, 0xffff0000
    s_lshl_b32 s56, s99, 16
    s_and_b32 s57, s99, 0xffff0000
    s_waitcnt vmcnt(0) lgkmcnt(0)
    s_barrier
    s_add_u32 s8, s30, 0xec55000
    s_addc_u32 s9, s31, 0
    s_mov_b32 s10, 0x8000
    s_mov_b32 s11, 0x20000
    s_mov_b32 s12, s4
    s_mov_b32 s13, s5
    s_mov_b32 s14, 0x4e2000
    s_mov_b32 s15, 0x20000
    s_add_u32 s20, s30, 0xd854000
    s_addc_u32 s21, s31, 0
    s_mov_b32 s22, 0x1400000
    s_mov_b32 s23, 0x20000
    s_lshl2_add_u32 s4, s34, s33
    s_mul_i32 s4, s4, 81920
    s_add_u32 s3, s33, 1
    s_and_b32 s3, s3, 3
    s_mul_i32 s36, s3, 20000
    s_add_u32 s36, s36, 81920
    s_mul_i32 s40, s3, 20480
    s_add_u32 s40, s40, s4
    s_lshl2_add_u32 s3, s34, s3
    s_mul_i32 s3, s3, 81920
    s_mul_i32 s44, s33, 20480
    s_add_u32 s44, s44, s3
    s_add_u32 s3, s33, 2
    s_and_b32 s3, s3, 3
    s_mul_i32 s37, s3, 20000
    s_add_u32 s37, s37, 81920
    s_mul_i32 s41, s3, 20480
    s_add_u32 s41, s41, s4
    s_lshl2_add_u32 s3, s34, s3
    s_mul_i32 s3, s3, 81920
    s_mul_i32 s45, s33, 20480
    s_add_u32 s45, s45, s3
    s_add_u32 s3, s33, 3
    s_and_b32 s3, s3, 3
    s_mul_i32 s38, s3, 20000
    s_add_u32 s38, s38, 81920
    s_mul_i32 s42, s3, 20480
    s_add_u32 s42, s42, s4
    s_lshl2_add_u32 s3, s34, s3
    s_mul_i32 s3, s3, 81920
    s_mul_i32 s46, s33, 20480
    s_add_u32 s46, s46, s3
    v_add_u32 v104, s36, v122
    ds_read_b128 v[16:19], v104
    v_add_u32 v104, s37, v122
    ds_read_b128 v[20:23], v104
    v_add_u32 v104, s38, v122
    ds_read_b128 v[24:27], v104
    s_waitcnt lgkmcnt(2)
    buffer_store_dwordx4 v[16:19], v122, s[20:23], s40 offen sc1
    s_waitcnt lgkmcnt(1)
    buffer_store_dwordx4 v[20:23], v122, s[20:23], s41 offen sc1
    s_waitcnt lgkmcnt(0)
    buffer_store_dwordx4 v[24:27], v122, s[20:23], s42 offen sc1
    s_cmp_ge_u32 s32, 4
    s_cbranch_scc1 L2_g0
    v_add_u32 v104, s36, v123
    ds_read_b128 v[36:39], v104
    v_add_u32 v104, s37, v123
    ds_read_b128 v[40:43], v104
    v_add_u32 v104, s38, v123
    ds_read_b128 v[44:47], v104
    s_waitcnt lgkmcnt(2)
    buffer_store_dwordx4 v[36:39], v123, s[20:23], s40 offen sc1
    s_waitcnt lgkmcnt(1)
    buffer_store_dwordx4 v[40:43], v123, s[20:23], s41 offen sc1
    s_waitcnt lgkmcnt(0)
    buffer_store_dwordx4 v[44:47], v123, s[20:23], s42 offen sc1
L2_g0:
    v_lshlrev_b32 v80, 16, v116
    v_subrev_f32 v60, s50, v80
    v_subrev_f32 v61, s51, v80
    v_subrev_f32 v62, s52, v80
    v_subrev_f32 v63, s53, v80
    v_subrev_f32 v64, s54, v80
    v_subrev_f32 v65, s55, v80
    v_subrev_f32 v66, s56, v80
    v_subrev_f32 v67, s57, v80
    v_cvt_pk_bf16_f32 v68, v60, v61
    v_cvt_pk_bf16_f32 v69, v62, v63
    v_cvt_pk_bf16_f32 v70, v64, v65
    v_cvt_pk_bf16_f32 v71, v66, v67
    v_lshlrev_b32 v60, 16, v68
    v_and_b32 v61, 0xffff0000, v68
    v_lshlrev_b32 v62, 16, v69
    v_and_b32 v63, 0xffff0000, v69
    v_lshlrev_b32 v64, 16, v70
    v_and_b32 v65, 0xffff0000, v70
    v_lshlrev_b32 v66, 16, v71
    v_and_b32 v67, 0xffff0000, v71
    v_mul_f32 v60, v60, v60
    v_mul_f32 v61, v61, v61
    v_mul_f32 v62, v62, v62
    v_mul_f32 v63, v63, v63
    v_mul_f32 v64, v64, v64
    v_mul_f32 v65, v65, v65
    v_mul_f32 v66, v66, v66
    v_mul_f32 v67, v67, v67
    v_cvt_pk_bf16_f32 v68, v60, v61
    v_cvt_pk_bf16_f32 v69, v62, v63
    v_cvt_pk_bf16_f32 v70, v64, v65
    v_cvt_pk_bf16_f32 v71, v66, v67
    v_lshlrev_b32 v60, 16, v68
    v_and_b32 v61, 0xffff0000, v68
    v_lshlrev_b32 v62, 16, v69
    v_and_b32 v63, 0xffff0000, v69
    v_lshlrev_b32 v64, 16, v70
    v_and_b32 v65, 0xffff0000, v70
    v_lshlrev_b32 v66, 16, v71
    v_and_b32 v67, 0xffff0000, v71
    v_mul_f32 v60, 0xc1200000, v60
    v_mul_f32 v61, 0xc1200000, v61
    v_mul_f32 v62, 0xc1200000, v62
    v_mul_f32 v63, 0xc1200000, v63
    v_mul_f32 v64, 0xc1200000, v64
    v_mul_f32 v65, 0xc1200000, v65
    v_mul_f32 v66, 0xc1200000, v66
    v_mul_f32 v67, 0xc1200000, v67
    v_cvt_pk_bf16_f32 v68, v60, v61
    v_cvt_pk_bf16_f32 v69, v62, v63
    v_cvt_pk_bf16_f32 v70, v64, v65
    v_cvt_pk_bf16_f32 v71, v66, v67
    v_lshlrev_b32 v60, 16, v68
    v_and_b32 v61, 0xffff0000, v68
    v_lshlrev_b32 v62, 16, v69
    v_and_b32 v63, 0xffff0000, v69
    v_lshlrev_b32 v64, 16, v70
    v_and_b32 v65, 0xffff0000, v70
    v_lshlrev_b32 v66, 16, v71
    v_and_b32 v67, 0xffff0000, v71
    v_mul_f32 v60, 0x3fb8aa3b, v60
    v_mul_f32 v61, 0x3fb8aa3b, v61
    v_mul_f32 v62, 0x3fb8aa3b, v62
    v_mul_f32 v63, 0x3fb8aa3b, v63
    v_mul_f32 v64, 0x3fb8aa3b, v64
    v_mul_f32 v65, 0x3fb8aa3b, v65
    v_mul_f32 v66, 0x3fb8aa3b, v66
    v_mul_f32 v67, 0x3fb8aa3b, v67
    v_exp_f32 v60, v60
    v_exp_f32 v61, v61
    v_exp_f32 v62, v62
    v_exp_f32 v63, v63
    v_exp_f32 v64, v64
    v_exp_f32 v65, v65
    v_exp_f32 v66, v66
    v_exp_f32 v67, v67
    v_cvt_pk_bf16_f32 v72, v60, v61
    v_cvt_pk_bf16_f32 v73, v62, v63
    v_cvt_pk_bf16_f32 v74, v64, v65
    v_cvt_pk_bf16_f32 v75, v66, v67
    v_and_b32 v84, 0xffff0000, v116
    v_subrev_f32 v60, s50, v84
    v_subrev_f32 v61, s51, v84
    v_subrev_f32 v62, s52, v84
    v_subrev_f32 v63, s53, v84
    v_subrev_f32 v64, s54, v84
    v_subrev_f32 v65, s55, v84
    v_subrev_f32 v66, s56, v84
    v_subrev_f32 v67, s57, v84
    v_cvt_pk_bf16_f32 v68, v60, v61
    v_cvt_pk_bf16_f32 v69, v62, v63
    v_cvt_pk_bf16_f32 v70, v64, v65
    v_cvt_pk_bf16_f32 v71, v66, v67
    v_lshlrev_b32 v60, 16, v68
    v_and_b32 v61, 0xffff0000, v68
    v_lshlrev_b32 v62, 16, v69
    v_and_b32 v63, 0xffff0000, v69
    v_lshlrev_b32 v64, 16, v70
    v_and_b32 v65, 0xffff0000, v70
    v_lshlrev_b32 v66, 16, v71
    v_and_b32 v67, 0xffff0000, v71
    v_mul_f32 v60, v60, v60
    v_mul_f32 v61, v61, v61
    v_mul_f32 v62, v62, v62
    v_mul_f32 v63, v63, v63
    v_mul_f32 v64, v64, v64
    v_mul_f32 v65, v65, v65
    v_mul_f32 v66, v66, v66
    v_mul_f32 v67, v67, v67
    v_cvt_pk_bf16_f32 v68, v60, v61
    v_cvt_pk_bf16_f32 v69, v62, v63
    v_cvt_pk_bf16_f32 v70, v64, v65
    v_cvt_pk_bf16_f32 v71, v66, v67
    v_lshlrev_b32 v60, 16, v68
    v_and_b32 v61, 0xffff0000, v68
    v_lshlrev_b32 v62, 16, v69
    v_and_b32 v63, 0xffff0000, v69
    v_lshlrev_b32 v64, 16, v70
    v_and_b32 v65, 0xffff0000, v70
    v_lshlrev_b32 v66, 16, v71
    v_and_b32 v67, 0xffff0000, v71
    v_mul_f32 v60, 0xc1200000, v60
    v_mul_f32 v61, 0xc1200000, v61
    v_mul_f32 v62, 0xc1200000, v62
    v_mul_f32 v63, 0xc1200000, v63
    v_mul_f32 v64, 0xc1200000, v64
    v_mul_f32 v65, 0xc1200000, v65
    v_mul_f32 v66, 0xc1200000, v66
    v_mul_f32 v67, 0xc1200000, v67
    v_cvt_pk_bf16_f32 v68, v60, v61
    v_cvt_pk_bf16_f32 v69, v62, v63
    v_cvt_pk_bf16_f32 v70, v64, v65
    v_cvt_pk_bf16_f32 v71, v66, v67
    v_lshlrev_b32 v60, 16, v68
    v_and_b32 v61, 0xffff0000, v68
    v_lshlrev_b32 v62, 16, v69
    v_and_b32 v63, 0xffff0000, v69
    v_lshlrev_b32 v64, 16, v70
    v_and_b32 v65, 0xffff0000, v70
    v_lshlrev_b32 v66, 16, v71
    v_and_b32 v67, 0xffff0000, v71
    v_mul_f32 v60, 0x3fb8aa3b, v60
    v_mul_f32 v61, 0x3fb8aa3b, v61
    v_mul_f32 v62, 0x3fb8aa3b, v62
    v_mul_f32 v63, 0x3fb8aa3b, v63
    v_mul_f32 v64, 0x3fb8aa3b, v64
    v_mul_f32 v65, 0x3fb8aa3b, v65
    v_mul_f32 v66, 0x3fb8aa3b, v66
    v_mul_f32 v67, 0x3fb8aa3b, v67
    v_exp_f32 v60, v60
    v_exp_f32 v61, v61
    v_exp_f32 v62, v62
    v_exp_f32 v63, v63
    v_exp_f32 v64, v64
    v_exp_f32 v65, v65
    v_exp_f32 v66, v66
    v_exp_f32 v67, v67
    v_cvt_pk_bf16_f32 v76, v60, v61
    v_cvt_pk_bf16_f32 v77, v62, v63
    v_cvt_pk_bf16_f32 v78, v64, v65
    v_cvt_pk_bf16_f32 v79, v66, v67
    v_mfma_f32_4x4x4_16b_bf16 v[80:83], v[48:49], v[72:73], 0
    v_mfma_f32_4x4x4_16b_bf16 v[88:91], v[52:53], v[72:73], 0
    v_mfma_f32_4x4x4_16b_bf16 v[84:87], v[48:49], v[76:77], 0
    v_mfma_f32_4x4x4_16b_bf16 v[92:95], v[52:53], v[76:77], 0
    v_mfma_f32_4x4x4_16b_bf16 v[80:83], v[50:51], v[74:75], v[80:83]
    v_mfma_f32_4x4x4_16b_bf16 v[88:91], v[54:55], v[74:75], v[88:91]
    v_mfma_f32_4x4x4_16b_bf16 v[84:87], v[50:51], v[78:79], v[84:87]
    v_mfma_f32_4x4x4_16b_bf16 v[92:95], v[54:55], v[78:79], v[92:95]
    s_lshl_b32 s3, s34, 9
    s_lshl_b32 s4, s33, 7
    s_add_u32 s4, s4, s3
    v_mov_b32 v104, 1
    v_and_b32 v105, 0x3f0, v122
    v_lshlrev_b32 v105, 3, v105
    v_add_u32 v106, 81920, v118
    ds_read_b128 v[32:35], v106
    v_add_u32 v106, 81920, v119
    ds_read_b128 v[60:63], v106
    s_waitcnt vmcnt(0)
    s_barrier
    s_cmp_lg_u32 s32, 0
    s_cbranch_scc1 L2_f2
    s_mov_b64 exec, 1
    buffer_store_dword v104, off, s[8:11], s4 sc1
    s_mov_b64 exec, 15
    s_bitset0_b64 exec, s33
L2_f3:
    buffer_load_dword v104, v105, s[8:11], s3 offen sc1
    s_waitcnt vmcnt(0)
    v_cmp_ne_u32 vcc, 1, v104
    s_cbranch_vccnz L2_f3s
    s_mov_b64 exec, -1
L2_f2:
    s_barrier
    buffer_load_dwordx4 v[36:39], v122, s[20:23], s44 offen sc1
    buffer_load_dwordx4 v[40:43], v122, s[20:23], s45 offen sc1
    buffer_load_dwordx4 v[44:47], v122, s[20:23], s46 offen sc1
    s_cmp_ge_u32 s32, 4
    s_cbranch_scc1 L2_f5
    buffer_load_dwordx4 v[64:67], v123, s[20:23], s44 offen sc1
    buffer_load_dwordx4 v[68:71], v123, s[20:23], s45 offen sc1
    buffer_load_dwordx4 v[72:75], v123, s[20:23], s46 offen sc1
    v_lshlrev_b32 v16, 16, v117
    v_subrev_f32 v96, s50, v16
    v_subrev_f32 v97, s51, v16
    v_subrev_f32 v98, s52, v16
    v_subrev_f32 v99, s53, v16
    v_subrev_f32 v100, s54, v16
    v_subrev_f32 v101, s55, v16
    v_subrev_f32 v102, s56, v16
    v_subrev_f32 v103, s57, v16
    v_cvt_pk_bf16_f32 v0, v96, v97
    v_cvt_pk_bf16_f32 v1, v98, v99
    v_cvt_pk_bf16_f32 v2, v100, v101
    v_cvt_pk_bf16_f32 v3, v102, v103
    v_lshlrev_b32 v96, 16, v0
    v_and_b32 v97, 0xffff0000, v0
    v_lshlrev_b32 v98, 16, v1
    v_and_b32 v99, 0xffff0000, v1
    v_lshlrev_b32 v100, 16, v2
    v_and_b32 v101, 0xffff0000, v2
    v_lshlrev_b32 v102, 16, v3
    v_and_b32 v103, 0xffff0000, v3
    v_mul_f32 v96, v96, v96
    v_mul_f32 v97, v97, v97
    v_mul_f32 v98, v98, v98
    v_mul_f32 v99, v99, v99
    v_mul_f32 v100, v100, v100
    v_mul_f32 v101, v101, v101
    v_mul_f32 v102, v102, v102
    v_mul_f32 v103, v103, v103
    v_cvt_pk_bf16_f32 v0, v96, v97
    v_cvt_pk_bf16_f32 v1, v98, v99
    v_cvt_pk_bf16_f32 v2, v100, v101
    v_cvt_pk_bf16_f32 v3, v102, v103
    v_lshlrev_b32 v96, 16, v0
    v_and_b32 v97, 0xffff0000, v0
    v_lshlrev_b32 v98, 16, v1
    v_and_b32 v99, 0xffff0000, v1
    v_lshlrev_b32 v100, 16, v2
    v_and_b32 v101, 0xffff0000, v2
    v_lshlrev_b32 v102, 16, v3
    v_and_b32 v103, 0xffff0000, v3
    v_mul_f32 v96, 0xc1200000, v96
    v_mul_f32 v97, 0xc1200000, v97
    v_mul_f32 v98, 0xc1200000, v98
    v_mul_f32 v99, 0xc1200000, v99
    v_mul_f32 v100, 0xc1200000, v100
    v_mul_f32 v101, 0xc1200000, v101
    v_mul_f32 v102, 0xc1200000, v102
    v_mul_f32 v103, 0xc1200000, v103
    v_cvt_pk_bf16_f32 v0, v96, v97
    v_cvt_pk_bf16_f32 v1, v98, v99
    v_cvt_pk_bf16_f32 v2, v100, v101
    v_cvt_pk_bf16_f32 v3, v102, v103
    v_lshlrev_b32 v96, 16, v0
    v_and_b32 v97, 0xffff0000, v0
    v_lshlrev_b32 v98, 16, v1
    v_and_b32 v99, 0xffff0000, v1
    v_lshlrev_b32 v100, 16, v2
    v_and_b32 v101, 0xffff0000, v2
    v_lshlrev_b32 v102, 16, v3
    v_and_b32 v103, 0xffff0000, v3
    v_mul_f32 v96, 0x3fb8aa3b, v96
    v_mul_f32 v97, 0x3fb8aa3b, v97
    v_mul_f32 v98, 0x3fb8aa3b, v98
    v_mul_f32 v99, 0x3fb8aa3b, v99
    v_mul_f32 v100, 0x3fb8aa3b, v100
    v_mul_f32 v101, 0x3fb8aa3b, v101
    v_mul_f32 v102, 0x3fb8aa3b, v102
    v_mul_f32 v103, 0x3fb8aa3b, v103
    v_exp_f32 v96, v96
    v_exp_f32 v97, v97
    v_exp_f32 v98, v98
    v_exp_f32 v99, v99
    v_exp_f32 v100, v100
    v_exp_f32 v101, v101
    v_exp_f32 v102, v102
    v_exp_f32 v103, v103
    v_cvt_pk_bf16_f32 v104, v96, v97
    v_cvt_pk_bf16_f32 v105, v98, v99
    v_cvt_pk_bf16_f32 v106, v100, v101
    v_cvt_pk_bf16_f32 v107, v102, v103
    v_and_b32 v20, 0xffff0000, v117
    v_subrev_f32 v96, s50, v20
    v_subrev_f32 v97, s51, v20
    v_subrev_f32 v98, s52, v20
    v_subrev_f32 v99, s53, v20
    v_subrev_f32 v100, s54, v20
    v_subrev_f32 v101, s55, v20
    v_subrev_f32 v102, s56, v20
    v_subrev_f32 v103, s57, v20
    v_cvt_pk_bf16_f32 v0, v96, v97
    v_cvt_pk_bf16_f32 v1, v98, v99
    v_cvt_pk_bf16_f32 v2, v100, v101
    v_cvt_pk_bf16_f32 v3, v102, v103
    v_lshlrev_b32 v96, 16, v0
    v_and_b32 v97, 0xffff0000, v0
    v_lshlrev_b32 v98, 16, v1
    v_and_b32 v99, 0xffff0000, v1
    v_lshlrev_b32 v100, 16, v2
    v_and_b32 v101, 0xffff0000, v2
    v_lshlrev_b32 v102, 16, v3
    v_and_b32 v103, 0xffff0000, v3
    v_mul_f32 v96, v96, v96
    v_mul_f32 v97, v97, v97
    v_mul_f32 v98, v98, v98
    v_mul_f32 v99, v99, v99
    v_mul_f32 v100, v100, v100
    v_mul_f32 v101, v101, v101
    v_mul_f32 v102, v102, v102
    v_mul_f32 v103, v103, v103
    v_cvt_pk_bf16_f32 v0, v96, v97
    v_cvt_pk_bf16_f32 v1, v98, v99
    v_cvt_pk_bf16_f32 v2, v100, v101
    v_cvt_pk_bf16_f32 v3, v102, v103
    v_lshlrev_b32 v96, 16, v0
    v_and_b32 v97, 0xffff0000, v0
    v_lshlrev_b32 v98, 16, v1
    v_and_b32 v99, 0xffff0000, v1
    v_lshlrev_b32 v100, 16, v2
    v_and_b32 v101, 0xffff0000, v2
    v_lshlrev_b32 v102, 16, v3
    v_and_b32 v103, 0xffff0000, v3
    v_mul_f32 v96, 0xc1200000, v96
    v_mul_f32 v97, 0xc1200000, v97
    v_mul_f32 v98, 0xc1200000, v98
    v_mul_f32 v99, 0xc1200000, v99
    v_mul_f32 v100, 0xc1200000, v100
    v_mul_f32 v101, 0xc1200000, v101
    v_mul_f32 v102, 0xc1200000, v102
    v_mul_f32 v103, 0xc1200000, v103
    v_cvt_pk_bf16_f32 v0, v96, v97
    v_cvt_pk_bf16_f32 v1, v98, v99
    v_cvt_pk_bf16_f32 v2, v100, v101
    v_cvt_pk_bf16_f32 v3, v102, v103
    v_lshlrev_b32 v96, 16, v0
    v_and_b32 v97, 0xffff0000, v0
    v_lshlrev_b32 v98, 16, v1
    v_and_b32 v99, 0xffff0000, v1
    v_lshlrev_b32 v100, 16, v2
    v_and_b32 v101, 0xffff0000, v2
    v_lshlrev_b32 v102, 16, v3
    v_and_b32 v103, 0xffff0000, v3
    v_mul_f32 v96, 0x3fb8aa3b, v96
    v_mul_f32 v97, 0x3fb8aa3b, v97
    v_mul_f32 v98, 0x3fb8aa3b, v98
    v_mul_f32 v99, 0x3fb8aa3b, v99
    v_mul_f32 v100, 0x3fb8aa3b, v100
    v_mul_f32 v101, 0x3fb8aa3b, v101
    v_mul_f32 v102, 0x3fb8aa3b, v102
    v_mul_f32 v103, 0x3fb8aa3b, v103
    v_exp_f32 v96, v96
    v_exp_f32 v97, v97
    v_exp_f32 v98, v98
    v_exp_f32 v99, v99
    v_exp_f32 v100, v100
    v_exp_f32 v101, v101
    v_exp_f32 v102, v102
    v_exp_f32 v103, v103
    v_cvt_pk_bf16_f32 v76, v96, v97
    v_cvt_pk_bf16_f32 v77, v98, v99
    v_cvt_pk_bf16_f32 v78, v100, v101
    v_cvt_pk_bf16_f32 v79, v102, v103
    v_mfma_f32_4x4x4_16b_bf16 v[16:19], v[48:49], v[104:105], 0
    v_mfma_f32_4x4x4_16b_bf16 v[24:27], v[52:53], v[104:105], 0
    v_mfma_f32_4x4x4_16b_bf16 v[20:23], v[48:49], v[76:77], 0
    v_mfma_f32_4x4x4_16b_bf16 v[28:31], v[52:53], v[76:77], 0
    v_mfma_f32_4x4x4_16b_bf16 v[16:19], v[50:51], v[106:107], v[16:19]
    v_mfma_f32_4x4x4_16b_bf16 v[24:27], v[54:55], v[106:107], v[24:27]
    v_mfma_f32_4x4x4_16b_bf16 v[20:23], v[50:51], v[78:79], v[20:23]
    v_mfma_f32_4x4x4_16b_bf16 v[28:31], v[54:55], v[78:79], v[28:31]
L2_f5:
    s_waitcnt vmcnt(0) lgkmcnt(0)
    v_mfma_f32_4x4x4_16b_bf16 v[96:99], v[10:11], v[32:33], 0
    v_mfma_f32_4x4x4_16b_bf16 v[100:103], v[10:11], v[34:35], 0
    s_nop 0
    v_mfma_f32_4x4x4_16b_bf16 v[96:99], v[10:11], v[36:37], v[96:99]
    v_mfma_f32_4x4x4_16b_bf16 v[100:103], v[10:11], v[38:39], v[100:103]
    s_nop 0
    v_mfma_f32_4x4x4_16b_bf16 v[96:99], v[10:11], v[40:41], v[96:99]
    v_mfma_f32_4x4x4_16b_bf16 v[100:103], v[10:11], v[42:43], v[100:103]
    s_nop 0
    v_mfma_f32_4x4x4_16b_bf16 v[96:99], v[10:11], v[44:45], v[96:99]
    v_mfma_f32_4x4x4_16b_bf16 v[100:103], v[10:11], v[46:47], v[100:103]
    s_nop 3
    v_mul_f32 v96, v96, v80
    v_mul_f32 v97, v97, v81
    v_mul_f32 v98, v98, v82
    v_mul_f32 v99, v99, v83
    v_cvt_pk_bf16_f32 v32, v96, v97
    v_cvt_pk_bf16_f32 v33, v98, v99
    v_mul_f32 v100, v100, v84
    v_mul_f32 v101, v101, v85
    v_mul_f32 v102, v102, v86
    v_mul_f32 v103, v103, v87
    v_cvt_pk_bf16_f32 v34, v100, v101
    v_cvt_pk_bf16_f32 v35, v102, v103
    v_mfma_f32_4x4x4_16b_bf16 v[80:83], v[56:57], v[32:33], 0
    s_nop 0
    v_mfma_f32_4x4x4_16b_bf16 v[84:87], v[56:57], v[34:35], 0
    s_nop 2
    v_mul_f32 v80, v80, v88
    v_mul_f32 v81, v81, v89
    v_mul_f32 v82, v82, v90
    v_mul_f32 v83, v83, v91
    v_mul_f32 v84, v84, v92
    v_mul_f32 v85, v85, v93
    v_mul_f32 v86, v86, v94
    v_mul_f32 v87, v87, v95
    v_mfma_f32_4x4x4_16b_bf16 v[96:99], v[10:11], v[108:109], v[80:83]
    s_nop 0
    v_mfma_f32_4x4x4_16b_bf16 v[100:103], v[10:11], v[110:111], v[84:87]
    s_nop 2
    v_cvt_pk_bf16_f32 v36, v96, v97
    v_cvt_pk_bf16_f32 v37, v98, v99
    v_cvt_pk_bf16_f32 v38, v100, v101
    v_cvt_pk_bf16_f32 v39, v102, v103
    buffer_store_dwordx4 v[36:39], v120, s[12:15], 0 offen nt
    s_cmp_ge_u32 s32, 4
    s_cbranch_scc1 L2_f6
    v_mfma_f32_4x4x4_16b_bf16 v[96:99], v[10:11], v[60:61], 0
    v_mfma_f32_4x4x4_16b_bf16 v[100:103], v[10:11], v[62:63], 0
    s_nop 0
    v_mfma_f32_4x4x4_16b_bf16 v[96:99], v[10:11], v[64:65], v[96:99]
    v_mfma_f32_4x4x4_16b_bf16 v[100:103], v[10:11], v[66:67], v[100:103]
    s_nop 0
    v_mfma_f32_4x4x4_16b_bf16 v[96:99], v[10:11], v[68:69], v[96:99]
    v_mfma_f32_4x4x4_16b_bf16 v[100:103], v[10:11], v[70:71], v[100:103]
    s_nop 0
    v_mfma_f32_4x4x4_16b_bf16 v[96:99], v[10:11], v[72:73], v[96:99]
    v_mfma_f32_4x4x4_16b_bf16 v[100:103], v[10:11], v[74:75], v[100:103]
    s_nop 3
    v_mul_f32 v96, v96, v16
    v_mul_f32 v97, v97, v17
    v_mul_f32 v98, v98, v18
    v_mul_f32 v99, v99, v19
    v_cvt_pk_bf16_f32 v60, v96, v97
    v_cvt_pk_bf16_f32 v61, v98, v99
    v_mul_f32 v100, v100, v20
    v_mul_f32 v101, v101, v21
    v_mul_f32 v102, v102, v22
    v_mul_f32 v103, v103, v23
    v_cvt_pk_bf16_f32 v62, v100, v101
    v_cvt_pk_bf16_f32 v63, v102, v103
    v_mfma_f32_4x4x4_16b_bf16 v[16:19], v[56:57], v[60:61], 0
    s_nop 0
    v_mfma_f32_4x4x4_16b_bf16 v[20:23], v[56:57], v[62:63], 0
    s_nop 2
    v_mul_f32 v16, v16, v24
    v_mul_f32 v17, v17, v25
    v_mul_f32 v18, v18, v26
    v_mul_f32 v19, v19, v27
    v_mul_f32 v20, v20, v28
    v_mul_f32 v21, v21, v29
    v_mul_f32 v22, v22, v30
    v_mul_f32 v23, v23, v31
    v_mfma_f32_4x4x4_16b_bf16 v[96:99], v[10:11], v[124:125], v[16:19]
    s_nop 0
    v_mfma_f32_4x4x4_16b_bf16 v[100:103], v[10:11], v[126:127], v[20:23]
    s_nop 2
    v_cvt_pk_bf16_f32 v64, v96, v97
    v_cvt_pk_bf16_f32 v65, v98, v99
    v_cvt_pk_bf16_f32 v66, v100, v101
    v_cvt_pk_bf16_f32 v67, v102, v103
    buffer_store_dwordx4 v[64:67], v121, s[12:15], 0 offen nt
L2_f6:
L2_end:
    s_endpgm
L2_slow:
    s_lshr_b32 s35, s42, 2
    s_lshl_b32 s50, s32, 4
    s_and_b32 s3, s42, 3
    s_lshl_b32 s53, s3, 3
    s_add_u32 s53, s53, s39
    s_and_b32 s3, s35, 2
    s_lshl_b32 s3, s3, 1
    s_add_u32 s53, s53, s3
    s_and_b32 s54, s35, 1
    s_lshl_b32 s54, s54, 4
L2_sl_seg:
    s_mul_i32 s55, s50, 173056
    s_and_b32 s3, s50, 3
    s_lshl_b32 s3, s3, 5
    s_add_u32 s3, s3, s55
    s_add_u32 s3, s3, s53
    buffer_load_dword v104, off, s[12:15], s3 sc1
    buffer_load_dword v105, off, s[12:15], s3 offset:32 sc1
    s_waitcnt vmcnt(0)
    v_readfirstlane_b32 s51, v104
    v_readfirstlane_b32 s52, v105
    s_lshr_b32 s51, s51, s54
    s_and_b32 s51, s51, 0xffff
    s_lshr_b32 s52, s52, s54
    s_and_b32 s52, s52, 0xffff
L2_sl_rec:
    s_cmp_ge_u32 s51, s52
    s_cbranch_scc1 L2_sl_next
    v_mbcnt_lo_u32_b32 v102, -1, 0
    v_mbcnt_hi_u32_b32 v102, -1, v102
    v_add_u32 v102, s51, v102
    v_and_b32 v103, -4, v102
    v_lshl_add_u32 v104, v102, 2, v103
    v_lshl_add_u32 v105, v103, 2, v102
    v_cmp_gt_u32 vcc, s52, v102
    s_mov_b64 exec, vcc
    buffer_load_dword v106, v104, s[8:11], s55 offen
    buffer_load_ubyte v107, v105, s[8:11], s55 offen offset:16
    s_waitcnt vmcnt(0)
    v_lshrrev_b32 v98, 14, v106
    v_and_b32 v98, v5, v98
    ds_read_b64 v[100:101], v98
    v_perm_b32 v97, v106, v107, s44
    v_and_b32 v96, v5, v106
    v_bitop3_b32 v103, v106, 0.5, -0.5 bitop3:0xa8
    v_bitop3_b32 v97, v6, v97, v103 bitop3:0xca
    s_waitcnt lgkmcnt(0)
    v_mfma_f32_4x4x4_16b_bf16 v[88:91], v[8:9], v[100:101], 0
    s_nop 4
    v_mul_f32 v88, v97, v88
    v_mul_f32 v89, v97, v89
    v_mul_f32 v90, v97, v90
    v_mul_f32 v91, v97, v91
    v_cvt_pk_bf16_f32 v88, v88, v89
    v_cvt_pk_bf16_f32 v89, v90, v91
    ds_pk_add_bf16 v96, v88 offset:65408
    ds_pk_add_bf16 v96, v89 offset:65412
    s_mov_b64 exec, -1
    s_add_u32 s51, s51, 64
    s_branch L2_sl_rec
L2_sl_next:
    s_add_u32 s50, s50, 1
    s_and_b32 s3, s50, 15
    s_cbranch_scc1 L2_sl_seg
    s_add_u32 s50, s50, 240
    s_cmp_lt_u32 s50, 1280
    s_cbranch_scc1 L2_sl_seg
    s_waitcnt lgkmcnt(0)
    s_cmp_eq_u32 s42, 0
    s_cbranch_scc1 L2_ret0
    s_cmp_eq_u32 s42, 1
    s_cbranch_scc1 L2_ret1
    s_cmp_eq_u32 s42, 14
    s_cbranch_scc1 L2_ret6
    s_cmp_eq_u32 s42, 15
    s_cbranch_scc1 L2_ret7
    s_and_b32 s3, s42, 3
    s_cmp_eq_u32 s3, 2
    s_cbranch_scc1 L2_ret2
    s_cmp_eq_u32 s3, 3
    s_cbranch_scc1 L2_ret3
    s_cmp_eq_u32 s3, 0
    s_cbranch_scc1 L2_ret4
    s_branch L2_ret5
L2_xo3:
    v_cmp_lt_u32 vcc, 20, v99
    s_mov_b32 s101, 1
    s_cbranch_vccz L2_xp3
    v_cmp_lt_u32 vcc, 32, v99
    v_cmp_lt_u32 s[58:59], 31, v88
    s_mov_b32 s101, 2
    s_or_b64 vcc, vcc, s[58:59]
    s_cbranch_scc0 L2_xp3
    s_mov_b32 s37, 0x10000
    s_branch L2_xp3
L2_xa4:
    s_cmp_eq_u32 s101, 1
    s_cbranch_scc1 L2_xc4
    v_lshlrev_b32 v89, 0, v96
    v_add_u32 v90, 140, v97
    v_bitop3_b32 v90, v89, v45, v90 bitop3:0x6a
    ds_write_b32 v98, v90 offset:28
    v_lshlrev_b32 v89, 4, v96
    v_add_u32 v90, 120, v97
    v_bitop3_b32 v90, v89, v45, v90 bitop3:0x6a
    ds_write_b32 v98, v90 offset:24
    v_lshlrev_b32 v89, 8, v96
    v_add_u32 v90, 100, v97
    v_bitop3_b32 v90, v89, v45, v90 bitop3:0x6a
    ds_write_b32 v98, v90 offset:20
L2_xc4:
    v_lshlrev_b32 v89, 12, v96
    v_add_u32 v90, 80, v97
    v_bitop3_b32 v90, v89, v45, v90 bitop3:0x6a
    ds_write_b32 v98, v90 offset:16
    s_branch L2_xb4
L2_xe4:
    v_cmp_lt_u32 vcc, 32, v99
    v_cmp_lt_u32 s[58:59], 31, v88
    v_lshrrev_b32 v89, 16, v96
    v_add_u32 v97, 80, v97
    s_or_b64 vcc, vcc, s[58:59]
    s_cbranch_scc1 L2_xs4
    v_lshlrev_b32 v89, v1, v89
    v_and_b32 v89, v45, v89
    v_cmp_ne_u32 vcc, 0, v89
    v_xor_b32 v90, v97, v89
    s_add_u32 s3, s37, s38
    v_mbcnt_lo_u32_b32 v98, vcc_lo, 0
    v_mbcnt_hi_u32_b32 v98, vcc_hi, v98
    s_bcnt1_i32_b64 s41, vcc
    v_lshl_add_u32 v98, v98, 2, s3
    s_lshl2_add_u32 s37, s41, s37
    s_mov_b64 exec, vcc
    ds_write_b32 v98, v90
    s_mov_b64 exec, -1
    s_branch L2_xr4
L2_xs4:
    s_waitcnt lgkmcnt(0)
    s_mov_b32 s37, 0x10000
    s_branch L2_xw4
L2_xf4:
    s_cmp_gt_u32 s37, 1024
    s_cbranch_scc1 L2_xt4
    s_cmp_lt_u32 s37, 768
    s_cbranch_scc1 L2_xl4
    ds_read_b32 v32, v44 offset:896
    s_add_u32 s3, s42, 0
    s_bitset1_b32 s43, s3
    s_branch L2_xg4
L2_xl4:
    s_waitcnt lgkmcnt(0)
    v_mov_b32 v31, -1
    s_cmp_ge_u32 s37, 512
    s_cbranch_scc1 L2_xg4
    v_mov_b32 v39, -1
    s_cmp_ge_u32 s37, 256
    s_cbranch_scc1 L2_xg4
    v_mov_b32 v27, -1
    s_branch L2_xg4
L2_xt4:
    s_waitcnt lgkmcnt(0)
    v_mov_b32 v21, -1
    v_mov_b32 v27, -1
    v_mov_b32 v39, -1
    v_mov_b32 v31, -1
    s_add_u32 s3, s42, 0
    s_bitset1_b32 s36, s3
    s_branch L2_xg4
L2_xo5:
    v_cmp_lt_u32 vcc, 20, v99
    s_mov_b32 s101, 1
    s_cbranch_vccz L2_xp5
    v_cmp_lt_u32 vcc, 32, v99
    v_cmp_lt_u32 s[58:59], 31, v88
    s_mov_b32 s101, 2
    s_or_b64 vcc, vcc, s[58:59]
    s_cbranch_scc0 L2_xp5
    s_mov_b32 s37, 0x10000
    s_branch L2_xp5
L2_xa6:
    s_cmp_eq_u32 s101, 1
    s_cbranch_scc1 L2_xc6
    v_lshlrev_b32 v89, 0, v96
    v_add_u32 v90, 140, v97
    v_bitop3_b32 v90, v89, v45, v90 bitop3:0x6a
    ds_write_b32 v98, v90 offset:28
    v_lshlrev_b32 v89, 4, v96
    v_add_u32 v90, 120, v97
    v_bitop3_b32 v90, v89, v45, v90 bitop3:0x6a
    ds_write_b32 v98, v90 offset:24
    v_lshlrev_b32 v89, 8, v96
    v_add_u32 v90, 100, v97
    v_bitop3_b32 v90, v89, v45, v90 bitop3:0x6a
    ds_write_b32 v98, v90 offset:20
L2_xc6:
    v_lshlrev_b32 v89, 12, v96
    v_add_u32 v90, 80, v97
    v_bitop3_b32 v90, v89, v45, v90 bitop3:0x6a
    ds_write_b32 v98, v90 offset:16
    s_branch L2_xb6
L2_xe6:
    v_cmp_lt_u32 vcc, 32, v99
    v_cmp_lt_u32 s[58:59], 31, v88
    v_lshrrev_b32 v89, 16, v96
    v_add_u32 v97, 80, v97
    s_or_b64 vcc, vcc, s[58:59]
    s_cbranch_scc1 L2_xs6
    v_lshlrev_b32 v89, v1, v89
    v_and_b32 v89, v45, v89
    v_cmp_ne_u32 vcc, 0, v89
    v_xor_b32 v90, v97, v89
    s_add_u32 s3, s37, s38
    v_mbcnt_lo_u32_b32 v98, vcc_lo, 0
    v_mbcnt_hi_u32_b32 v98, vcc_hi, v98
    s_bcnt1_i32_b64 s41, vcc
    v_lshl_add_u32 v98, v98, 2, s3
    s_lshl2_add_u32 s37, s41, s37
    s_mov_b64 exec, vcc
    ds_write_b32 v98, v90
    s_mov_b64 exec, -1
    s_branch L2_xr6
L2_xs6:
    s_waitcnt lgkmcnt(0)
    s_mov_b32 s37, 0x10000
    s_branch L2_xw6
L2_xf6:
    s_cmp_gt_u32 s37, 1024
    s_cbranch_scc1 L2_xt6
    s_cmp_lt_u32 s37, 768
    s_cbranch_scc1 L2_xl6
    ds_read_b32 v33, v44 offset:896
    s_add_u32 s3, s42, 1
    s_bitset1_b32 s43, s3
    s_branch L2_xg6
L2_xl6:
    s_waitcnt lgkmcnt(0)
    v_mov_b32 v42, -1
    s_cmp_ge_u32 s37, 512
    s_cbranch_scc1 L2_xg6
    v_mov_b32 v43, -1
    s_cmp_ge_u32 s37, 256
    s_cbranch_scc1 L2_xg6
    v_mov_b32 v41, -1
    s_branch L2_xg6
L2_xt6:
    s_waitcnt lgkmcnt(0)
    v_mov_b32 v40, -1
    v_mov_b32 v41, -1
    v_mov_b32 v43, -1
    v_mov_b32 v42, -1
    s_add_u32 s3, s42, 1
    s_bitset1_b32 s36, s3
    s_branch L2_xg6
L2_oa7:
    v_and_b32 v47, 0x0fffffff, v32
    buffer_load_dword v78, v47, s[8:11], 0 offen offset:16
    s_mov_b64 exec, s[6:7]
    v_add_u32 v47, 8, v47
    v_lshrrev_b32 v32, 2, v32
    s_mov_b64 exec, -1
    buffer_load_dwordx2 v[76:77], v47, s[8:11], 0 offen
    s_branch L2_ob7
L2_oa8:
    s_waitcnt vmcnt(0)
    s_mov_b64 exec, s[6:7]
    v_lshrrev_b32 v78, 16, v78
    s_mov_b64 exec, -1
    v_and_b32 v46, 0x10000000, v32
    v_cmpx_eq_u32 vcc, 0, v46
    v_lshrrev_b32 v47, 14, v76
    v_and_b32 v47, v5, v47
    ds_read_b64 v[96:97], v47
    v_perm_b32 v98, v76, v78, s44
    v_bitop3_b32 v99, v76, 0.5, -0.5 bitop3:0xa8
    v_bitop3_b32 v98, v6, v98, v99 bitop3:0xca
    v_and_b32 v47, v5, v76
    s_waitcnt lgkmcnt(0)
    v_mfma_f32_4x4x4_16b_bf16 v[88:91], v[8:9], v[96:97], 0
    s_nop 4
    v_mul_f32 v88, v98, v88
    v_mul_f32 v89, v98, v89
    v_mul_f32 v90, v98, v90
    v_mul_f32 v91, v98, v91
    v_cvt_pk_bf16_f32 v88, v88, v89
    v_cvt_pk_bf16_f32 v89, v90, v91
    ds_pk_add_bf16 v47, v88 offset:65408
    ds_pk_add_bf16 v47, v89 offset:65412
    s_mov_b64 exec, -1
    v_and_b32 v46, 0x20000000, v32
    v_cmpx_eq_u32 vcc, 0, v46
    v_lshrrev_b32 v47, 14, v77
    v_and_b32 v47, v5, v47
    ds_read_b64 v[96:97], v47
    v_perm_b32 v98, v77, v78, s45
    v_bitop3_b32 v99, v77, 0.5, -0.5 bitop3:0xa8
    v_bitop3_b32 v98, v6, v98, v99 bitop3:0xca
    v_and_b32 v47, v5, v77
    s_waitcnt lgkmcnt(0)
    v_mfma_f32_4x4x4_16b_bf16 v[88:91], v[8:9], v[96:97], 0
    s_nop 4
    v_mul_f32 v88, v98, v88
    v_mul_f32 v89, v98, v89
    v_mul_f32 v90, v98, v90
    v_mul_f32 v91, v98, v91
    v_cvt_pk_bf16_f32 v88, v88, v89
    v_cvt_pk_bf16_f32 v89, v90, v91
    ds_pk_add_bf16 v47, v88 offset:65408
    ds_pk_add_bf16 v47, v89 offset:65412
    s_mov_b64 exec, -1
    s_branch L2_ob8
L2_c9:
    s_lshl_b64 s[52:53], s[82:83], 1
    s_andn2_b64 s[52:53], s[52:53], s[80:81]
    s_andn2_b64 s[52:53], s[52:53], s[54:55]
    s_or_b64 s[80:81], s[80:81], s[52:53]
    s_not_b64 vcc, s[52:53]
    s_mov_b64 exec, -1
    v_cndmask_b32_dpp v84, v84, v84, vcc wave_shr:1 row_mask:0xf bank_mask:0xf
    v_cndmask_b32_dpp v85, v85, v85, vcc wave_shr:1 row_mask:0xf bank_mask:0xf
    s_lshr_b64 s[52:53], s[52:53], 1
    v_cndmask_b32_dpp v86, v86, v86, vcc wave_shr:1 row_mask:0xf bank_mask:0xf
    v_cndmask_b32_dpp v87, v87, v87, vcc wave_shr:1 row_mask:0xf bank_mask:0xf
    s_andn2_b64 s[82:83], s[82:83], s[52:53]
    v_cndmask_b32_dpp v7, v7, v7, vcc wave_shr:1 row_mask:0xf bank_mask:0xf
    s_mov_b64 exec, s[54:55]
    s_cbranch_scc0 L2_d9
    s_mov_b64 exec, s[82:83]
    s_nop 1
    v_mfma_f32_4x4x4_16b_bf16 v[88:91], v[12:13], v[84:85], 0
    s_nop 1
    v_mfma_f32_4x4x4_16b_bf16 v[88:91], v[10:11], v[86:87], v[88:91]
    s_nop 4
    v_cvt_pk_bf16_f32 v88, v88, v89
    v_cvt_pk_bf16_f32 v89, v90, v91
    ds_pk_add_bf16 v7, v88 offset:65408
    ds_pk_add_bf16 v7, v89 offset:65412
    s_mov_b64 exec, s[54:55]
    s_branch L2_d9
L2_c10:
    s_lshl_b64 s[52:53], s[82:83], 1
    s_andn2_b64 s[52:53], s[52:53], s[80:81]
    s_andn2_b64 s[52:53], s[52:53], s[50:51]
    s_or_b64 s[80:81], s[80:81], s[52:53]
    s_not_b64 vcc, s[52:53]
    s_mov_b64 exec, -1
    v_cndmask_b32_dpp v84, v84, v84, vcc wave_shr:1 row_mask:0xf bank_mask:0xf
    v_cndmask_b32_dpp v85, v85, v85, vcc wave_shr:1 row_mask:0xf bank_mask:0xf
    s_lshr_b64 s[52:53], s[52:53], 1
    v_cndmask_b32_dpp v86, v86, v86, vcc wave_shr:1 row_mask:0xf bank_mask:0xf
    v_cndmask_b32_dpp v87, v87, v87, vcc wave_shr:1 row_mask:0xf bank_mask:0xf
    s_andn2_b64 s[82:83], s[82:83], s[52:53]
    v_cndmask_b32_dpp v7, v7, v7, vcc wave_shr:1 row_mask:0xf bank_mask:0xf
    s_mov_b64 exec, s[50:51]
    s_cbranch_scc0 L2_d10
    s_mov_b64 exec, s[82:83]
    s_nop 1
    v_mfma_f32_4x4x4_16b_bf16 v[88:91], v[12:13], v[84:85], 0
    s_nop 1
    v_mfma_f32_4x4x4_16b_bf16 v[88:91], v[10:11], v[86:87], v[88:91]
    s_nop 4
    v_cvt_pk_bf16_f32 v88, v88, v89
    v_cvt_pk_bf16_f32 v89, v90, v91
    ds_pk_add_bf16 v7, v88 offset:65408
    ds_pk_add_bf16 v7, v89 offset:65412
    s_mov_b64 exec, s[50:51]
    s_branch L2_d10
L2_c13:
    s_lshl_b64 s[52:53], s[82:83], 1
    s_andn2_b64 s[52:53], s[52:53], s[80:81]
    s_andn2_b64 s[52:53], s[52:53], s[54:55]
    s_or_b64 s[80:81], s[80:81], s[52:53]
    s_not_b64 vcc, s[52:53]
    s_mov_b64 exec, -1
    v_cndmask_b32_dpp v84, v84, v84, vcc wave_shr:1 row_mask:0xf bank_mask:0xf
    v_cndmask_b32_dpp v85, v85, v85, vcc wave_shr:1 row_mask:0xf bank_mask:0xf
    s_lshr_b64 s[52:53], s[52:53], 1
    v_cndmask_b32_dpp v86, v86, v86, vcc wave_shr:1 row_mask:0xf bank_mask:0xf
    v_cndmask_b32_dpp v87, v87, v87, vcc wave_shr:1 row_mask:0xf bank_mask:0xf
    s_andn2_b64 s[82:83], s[82:83], s[52:53]
    v_cndmask_b32_dpp v7, v7, v7, vcc wave_shr:1 row_mask:0xf bank_mask:0xf
    s_mov_b64 exec, s[54:55]
    s_cbranch_scc0 L2_d13
    s_mov_b64 exec, s[82:83]
    s_nop 1
    v_mfma_f32_4x4x4_16b_bf16 v[88:91], v[12:13], v[84:85], 0
    s_nop 1
    v_mfma_f32_4x4x4_16b_bf16 v[88:91], v[10:11], v[86:87], v[88:91]
    s_nop 4
    v_cvt_pk_bf16_f32 v88, v88, v89
    v_cvt_pk_bf16_f32 v89, v90, v91
    ds_pk_add_bf16 v7, v88 offset:65408
    ds_pk_add_bf16 v7, v89 offset:65412
    s_mov_b64 exec, s[54:55]
    s_branch L2_d13
L2_c14:
    s_lshl_b64 s[52:53], s[82:83], 1
    s_andn2_b64 s[52:53], s[52:53], s[80:81]
    s_andn2_b64 s[52:53], s[52:53], s[50:51]
    s_or_b64 s[80:81], s[80:81], s[52:53]
    s_not_b64 vcc, s[52:53]
    s_mov_b64 exec, -1
    v_cndmask_b32_dpp v84, v84, v84, vcc wave_shr:1 row_mask:0xf bank_mask:0xf
    v_cndmask_b32_dpp v85, v85, v85, vcc wave_shr:1 row_mask:0xf bank_mask:0xf
    s_lshr_b64 s[52:53], s[52:53], 1
    v_cndmask_b32_dpp v86, v86, v86, vcc wave_shr:1 row_mask:0xf bank_mask:0xf
    v_cndmask_b32_dpp v87, v87, v87, vcc wave_shr:1 row_mask:0xf bank_mask:0xf
    s_andn2_b64 s[82:83], s[82:83], s[52:53]
    v_cndmask_b32_dpp v7, v7, v7, vcc wave_shr:1 row_mask:0xf bank_mask:0xf
    s_mov_b64 exec, s[50:51]
    s_cbranch_scc0 L2_d14
    s_mov_b64 exec, s[82:83]
    s_nop 1
    v_mfma_f32_4x4x4_16b_bf16 v[88:91], v[12:13], v[84:85], 0
    s_nop 1
    v_mfma_f32_4x4x4_16b_bf16 v[88:91], v[10:11], v[86:87], v[88:91]
    s_nop 4
    v_cvt_pk_bf16_f32 v88, v88, v89
    v_cvt_pk_bf16_f32 v89, v90, v91
    ds_pk_add_bf16 v7, v88 offset:65408
    ds_pk_add_bf16 v7, v89 offset:65412
    s_mov_b64 exec, s[50:51]
    s_branch L2_d14
L2_xo16:
    v_cmp_lt_u32 vcc, 20, v99
    s_mov_b32 s101, 1
    s_cbranch_vccz L2_xp16
    v_cmp_lt_u32 vcc, 32, v99
    v_cmp_lt_u32 s[58:59], 31, v88
    s_mov_b32 s101, 2
    s_or_b64 vcc, vcc, s[58:59]
    s_cbranch_scc0 L2_xp16
    s_mov_b32 s37, 0x10000
    s_branch L2_xp16
L2_c17:
    s_lshl_b64 s[52:53], s[82:83], 1
    s_andn2_b64 s[52:53], s[52:53], s[80:81]
    s_andn2_b64 s[52:53], s[52:53], s[54:55]
    s_or_b64 s[80:81], s[80:81], s[52:53]
    s_not_b64 vcc, s[52:53]
    s_mov_b64 exec, -1
    v_cndmask_b32_dpp v84, v84, v84, vcc wave_shr:1 row_mask:0xf bank_mask:0xf
    v_cndmask_b32_dpp v85, v85, v85, vcc wave_shr:1 row_mask:0xf bank_mask:0xf
    s_lshr_b64 s[52:53], s[52:53], 1
    v_cndmask_b32_dpp v86, v86, v86, vcc wave_shr:1 row_mask:0xf bank_mask:0xf
    v_cndmask_b32_dpp v87, v87, v87, vcc wave_shr:1 row_mask:0xf bank_mask:0xf
    s_andn2_b64 s[82:83], s[82:83], s[52:53]
    v_cndmask_b32_dpp v7, v7, v7, vcc wave_shr:1 row_mask:0xf bank_mask:0xf
    s_mov_b64 exec, s[54:55]
    s_cbranch_scc0 L2_d17
    s_mov_b64 exec, s[82:83]
    s_nop 1
    v_mfma_f32_4x4x4_16b_bf16 v[88:91], v[12:13], v[84:85], 0
    s_nop 1
    v_mfma_f32_4x4x4_16b_bf16 v[88:91], v[10:11], v[86:87], v[88:91]
    s_nop 4
    v_cvt_pk_bf16_f32 v88, v88, v89
    v_cvt_pk_bf16_f32 v89, v90, v91
    ds_pk_add_bf16 v7, v88 offset:65408
    ds_pk_add_bf16 v7, v89 offset:65412
    s_mov_b64 exec, s[54:55]
    s_branch L2_d17
L2_c18:
    s_lshl_b64 s[52:53], s[82:83], 1
    s_andn2_b64 s[52:53], s[52:53], s[80:81]
    s_andn2_b64 s[52:53], s[52:53], s[50:51]
    s_or_b64 s[80:81], s[80:81], s[52:53]
    s_not_b64 vcc, s[52:53]
    s_mov_b64 exec, -1
    v_cndmask_b32_dpp v84, v84, v84, vcc wave_shr:1 row_mask:0xf bank_mask:0xf
    v_cndmask_b32_dpp v85, v85, v85, vcc wave_shr:1 row_mask:0xf bank_mask:0xf
    s_lshr_b64 s[52:53], s[52:53], 1
    v_cndmask_b32_dpp v86, v86, v86, vcc wave_shr:1 row_mask:0xf bank_mask:0xf
    v_cndmask_b32_dpp v87, v87, v87, vcc wave_shr:1 row_mask:0xf bank_mask:0xf
    s_andn2_b64 s[82:83], s[82:83], s[52:53]
    v_cndmask_b32_dpp v7, v7, v7, vcc wave_shr:1 row_mask:0xf bank_mask:0xf
    s_mov_b64 exec, s[50:51]
    s_cbranch_scc0 L2_d18
    s_mov_b64 exec, s[82:83]
    s_nop 1
    v_mfma_f32_4x4x4_16b_bf16 v[88:91], v[12:13], v[84:85], 0
    s_nop 1
    v_mfma_f32_4x4x4_16b_bf16 v[88:91], v[10:11], v[86:87], v[88:91]
    s_nop 4
    v_cvt_pk_bf16_f32 v88, v88, v89
    v_cvt_pk_bf16_f32 v89, v90, v91
    ds_pk_add_bf16 v7, v88 offset:65408
    ds_pk_add_bf16 v7, v89 offset:65412
    s_mov_b64 exec, s[50:51]
    s_branch L2_d18
L2_c21:
    s_lshl_b64 s[52:53], s[82:83], 1
    s_andn2_b64 s[52:53], s[52:53], s[80:81]
    s_andn2_b64 s[52:53], s[52:53], s[54:55]
    s_or_b64 s[80:81], s[80:81], s[52:53]
    s_not_b64 vcc, s[52:53]
    s_mov_b64 exec, -1
    v_cndmask_b32_dpp v84, v84, v84, vcc wave_shr:1 row_mask:0xf bank_mask:0xf
    v_cndmask_b32_dpp v85, v85, v85, vcc wave_shr:1 row_mask:0xf bank_mask:0xf
    s_lshr_b64 s[52:53], s[52:53], 1
    v_cndmask_b32_dpp v86, v86, v86, vcc wave_shr:1 row_mask:0xf bank_mask:0xf
    v_cndmask_b32_dpp v87, v87, v87, vcc wave_shr:1 row_mask:0xf bank_mask:0xf
    s_andn2_b64 s[82:83], s[82:83], s[52:53]
    v_cndmask_b32_dpp v7, v7, v7, vcc wave_shr:1 row_mask:0xf bank_mask:0xf
    s_mov_b64 exec, s[54:55]
    s_cbranch_scc0 L2_d21
    s_mov_b64 exec, s[82:83]
    s_nop 1
    v_mfma_f32_4x4x4_16b_bf16 v[88:91], v[12:13], v[84:85], 0
    s_nop 1
    v_mfma_f32_4x4x4_16b_bf16 v[88:91], v[10:11], v[86:87], v[88:91]
    s_nop 4
    v_cvt_pk_bf16_f32 v88, v88, v89
    v_cvt_pk_bf16_f32 v89, v90, v91
    ds_pk_add_bf16 v7, v88 offset:65408
    ds_pk_add_bf16 v7, v89 offset:65412
    s_mov_b64 exec, s[54:55]
    s_branch L2_d21
L2_c22:
    s_lshl_b64 s[52:53], s[82:83], 1
    s_andn2_b64 s[52:53], s[52:53], s[80:81]
    s_andn2_b64 s[52:53], s[52:53], s[50:51]
    s_or_b64 s[80:81], s[80:81], s[52:53]
    s_not_b64 vcc, s[52:53]
    s_mov_b64 exec, -1
    v_cndmask_b32_dpp v84, v84, v84, vcc wave_shr:1 row_mask:0xf bank_mask:0xf
    v_cndmask_b32_dpp v85, v85, v85, vcc wave_shr:1 row_mask:0xf bank_mask:0xf
    s_lshr_b64 s[52:53], s[52:53], 1
    v_cndmask_b32_dpp v86, v86, v86, vcc wave_shr:1 row_mask:0xf bank_mask:0xf
    v_cndmask_b32_dpp v87, v87, v87, vcc wave_shr:1 row_mask:0xf bank_mask:0xf
    s_andn2_b64 s[82:83], s[82:83], s[52:53]
    v_cndmask_b32_dpp v7, v7, v7, vcc wave_shr:1 row_mask:0xf bank_mask:0xf
    s_mov_b64 exec, s[50:51]
    s_cbranch_scc0 L2_d22
    s_mov_b64 exec, s[82:83]
    s_nop 1
    v_mfma_f32_4x4x4_16b_bf16 v[88:91], v[12:13], v[84:85], 0
    s_nop 1
    v_mfma_f32_4x4x4_16b_bf16 v[88:91], v[10:11], v[86:87], v[88:91]
    s_nop 4
    v_cvt_pk_bf16_f32 v88, v88, v89
    v_cvt_pk_bf16_f32 v89, v90, v91
    ds_pk_add_bf16 v7, v88 offset:65408
    ds_pk_add_bf16 v7, v89 offset:65412
    s_mov_b64 exec, s[50:51]
    s_branch L2_d22
L2_c23:
    s_lshl_b64 s[52:53], s[82:83], 1
    s_andn2_b64 s[52:53], s[52:53], s[80:81]
    s_andn2_b64 s[52:53], s[52:53], s[54:55]
    s_or_b64 s[80:81], s[80:81], s[52:53]
    s_not_b64 vcc, s[52:53]
    s_mov_b64 exec, -1
    v_cndmask_b32_dpp v84, v84, v84, vcc wave_shr:1 row_mask:0xf bank_mask:0xf
    v_cndmask_b32_dpp v85, v85, v85, vcc wave_shr:1 row_mask:0xf bank_mask:0xf
    s_lshr_b64 s[52:53], s[52:53], 1
    v_cndmask_b32_dpp v86, v86, v86, vcc wave_shr:1 row_mask:0xf bank_mask:0xf
    v_cndmask_b32_dpp v87, v87, v87, vcc wave_shr:1 row_mask:0xf bank_mask:0xf
    s_andn2_b64 s[82:83], s[82:83], s[52:53]
    v_cndmask_b32_dpp v7, v7, v7, vcc wave_shr:1 row_mask:0xf bank_mask:0xf
    s_mov_b64 exec, s[54:55]
    s_cbranch_scc0 L2_d23
    s_mov_b64 exec, s[82:83]
    s_nop 1
    v_mfma_f32_4x4x4_16b_bf16 v[88:91], v[12:13], v[84:85], 0
    s_nop 1
    v_mfma_f32_4x4x4_16b_bf16 v[88:91], v[10:11], v[86:87], v[88:91]
    s_nop 4
    v_cvt_pk_bf16_f32 v88, v88, v89
    v_cvt_pk_bf16_f32 v89, v90, v91
    ds_pk_add_bf16 v7, v88 offset:65408
    ds_pk_add_bf16 v7, v89 offset:65412
    s_mov_b64 exec, s[54:55]
    s_branch L2_d23
L2_c24:
    s_lshl_b64 s[52:53], s[82:83], 1
    s_andn2_b64 s[52:53], s[52:53], s[80:81]
    s_andn2_b64 s[52:53], s[52:53], s[50:51]
    s_or_b64 s[80:81], s[80:81], s[52:53]
    s_not_b64 vcc, s[52:53]
    s_mov_b64 exec, -1
    v_cndmask_b32_dpp v84, v84, v84, vcc wave_shr:1 row_mask:0xf bank_mask:0xf
    v_cndmask_b32_dpp v85, v85, v85, vcc wave_shr:1 row_mask:0xf bank_mask:0xf
    s_lshr_b64 s[52:53], s[52:53], 1
    v_cndmask_b32_dpp v86, v86, v86, vcc wave_shr:1 row_mask:0xf bank_mask:0xf
    v_cndmask_b32_dpp v87, v87, v87, vcc wave_shr:1 row_mask:0xf bank_mask:0xf
    s_andn2_b64 s[82:83], s[82:83], s[52:53]
    v_cndmask_b32_dpp v7, v7, v7, vcc wave_shr:1 row_mask:0xf bank_mask:0xf
    s_mov_b64 exec, s[50:51]
    s_cbranch_scc0 L2_d24
    s_mov_b64 exec, s[82:83]
    s_nop 1
    v_mfma_f32_4x4x4_16b_bf16 v[88:91], v[12:13], v[84:85], 0
    s_nop 1
    v_mfma_f32_4x4x4_16b_bf16 v[88:91], v[10:11], v[86:87], v[88:91]
    s_nop 4
    v_cvt_pk_bf16_f32 v88, v88, v89
    v_cvt_pk_bf16_f32 v89, v90, v91
    ds_pk_add_bf16 v7, v88 offset:65408
    ds_pk_add_bf16 v7, v89 offset:65412
    s_mov_b64 exec, s[50:51]
    s_branch L2_d24
L2_xa25:
    s_cmp_eq_u32 s101, 1
    s_cbranch_scc1 L2_xc25
    v_lshlrev_b32 v89, 0, v96
    v_add_u32 v90, 140, v97
    v_bitop3_b32 v90, v89, v45, v90 bitop3:0x6a
    ds_write_b32 v98, v90 offset:28
    v_lshlrev_b32 v89, 4, v96
    v_add_u32 v90, 120, v97
    v_bitop3_b32 v90, v89, v45, v90 bitop3:0x6a
    ds_write_b32 v98, v90 offset:24
    v_lshlrev_b32 v89, 8, v96
    v_add_u32 v90, 100, v97
    v_bitop3_b32 v90, v89, v45, v90 bitop3:0x6a
    ds_write_b32 v98, v90 offset:20
L2_xc25:
    v_lshlrev_b32 v89, 12, v96
    v_add_u32 v90, 80, v97
    v_bitop3_b32 v90, v89, v45, v90 bitop3:0x6a
    ds_write_b32 v98, v90 offset:16
    s_branch L2_xb25
L2_xe25:
    v_cmp_lt_u32 vcc, 32, v99
    v_cmp_lt_u32 s[58:59], 31, v88
    v_lshrrev_b32 v89, 16, v96
    v_add_u32 v97, 80, v97
    s_or_b64 vcc, vcc, s[58:59]
    s_cbranch_scc1 L2_xs25
    v_lshlrev_b32 v89, v1, v89
    v_and_b32 v89, v45, v89
    v_cmp_ne_u32 vcc, 0, v89
    v_xor_b32 v90, v97, v89
    s_add_u32 s3, s37, s38
    v_mbcnt_lo_u32_b32 v98, vcc_lo, 0
    v_mbcnt_hi_u32_b32 v98, vcc_hi, v98
    s_bcnt1_i32_b64 s41, vcc
    v_lshl_add_u32 v98, v98, 2, s3
    s_lshl2_add_u32 s37, s41, s37
    s_mov_b64 exec, vcc
    ds_write_b32 v98, v90
    s_mov_b64 exec, -1
    s_branch L2_xr25
L2_xs25:
    s_waitcnt lgkmcnt(0)
    s_mov_b32 s37, 0x10000
    s_branch L2_xw25
L2_c26:
    s_lshl_b64 s[52:53], s[82:83], 1
    s_andn2_b64 s[52:53], s[52:53], s[80:81]
    s_andn2_b64 s[52:53], s[52:53], s[54:55]
    s_or_b64 s[80:81], s[80:81], s[52:53]
    s_not_b64 vcc, s[52:53]
    s_mov_b64 exec, -1
    v_cndmask_b32_dpp v84, v84, v84, vcc wave_shr:1 row_mask:0xf bank_mask:0xf
    v_cndmask_b32_dpp v85, v85, v85, vcc wave_shr:1 row_mask:0xf bank_mask:0xf
    s_lshr_b64 s[52:53], s[52:53], 1
    v_cndmask_b32_dpp v86, v86, v86, vcc wave_shr:1 row_mask:0xf bank_mask:0xf
    v_cndmask_b32_dpp v87, v87, v87, vcc wave_shr:1 row_mask:0xf bank_mask:0xf
    s_andn2_b64 s[82:83], s[82:83], s[52:53]
    v_cndmask_b32_dpp v7, v7, v7, vcc wave_shr:1 row_mask:0xf bank_mask:0xf
    s_mov_b64 exec, s[54:55]
    s_cbranch_scc0 L2_d26
    s_mov_b64 exec, s[82:83]
    s_nop 1
    v_mfma_f32_4x4x4_16b_bf16 v[88:91], v[12:13], v[84:85], 0
    s_nop 1
    v_mfma_f32_4x4x4_16b_bf16 v[88:91], v[10:11], v[86:87], v[88:91]
    s_nop 4
    v_cvt_pk_bf16_f32 v88, v88, v89
    v_cvt_pk_bf16_f32 v89, v90, v91
    ds_pk_add_bf16 v7, v88 offset:65408
    ds_pk_add_bf16 v7, v89 offset:65412
    s_mov_b64 exec, s[54:55]
    s_branch L2_d26
L2_c27:
    s_lshl_b64 s[52:53], s[82:83], 1
    s_andn2_b64 s[52:53], s[52:53], s[80:81]
    s_andn2_b64 s[52:53], s[52:53], s[50:51]
    s_or_b64 s[80:81], s[80:81], s[52:53]
    s_not_b64 vcc, s[52:53]
    s_mov_b64 exec, -1
    v_cndmask_b32_dpp v84, v84, v84, vcc wave_shr:1 row_mask:0xf bank_mask:0xf
    v_cndmask_b32_dpp v85, v85, v85, vcc wave_shr:1 row_mask:0xf bank_mask:0xf
    s_lshr_b64 s[52:53], s[52:53], 1
    v_cndmask_b32_dpp v86, v86, v86, vcc wave_shr:1 row_mask:0xf bank_mask:0xf
    v_cndmask_b32_dpp v87, v87, v87, vcc wave_shr:1 row_mask:0xf bank_mask:0xf
    s_andn2_b64 s[82:83], s[82:83], s[52:53]
    v_cndmask_b32_dpp v7, v7, v7, vcc wave_shr:1 row_mask:0xf bank_mask:0xf
    s_mov_b64 exec, s[50:51]
    s_cbranch_scc0 L2_d27
    s_mov_b64 exec, s[82:83]
    s_nop 1
    v_mfma_f32_4x4x4_16b_bf16 v[88:91], v[12:13], v[84:85], 0
    s_nop 1
    v_mfma_f32_4x4x4_16b_bf16 v[88:91], v[10:11], v[86:87], v[88:91]
    s_nop 4
    v_cvt_pk_bf16_f32 v88, v88, v89
    v_cvt_pk_bf16_f32 v89, v90, v91
    ds_pk_add_bf16 v7, v88 offset:65408
    ds_pk_add_bf16 v7, v89 offset:65412
    s_mov_b64 exec, s[50:51]
    s_branch L2_d27
L2_xf25:
    s_cmp_gt_u32 s37, 1024
    s_cbranch_scc1 L2_xt25
    s_cmp_lt_u32 s37, 768
    s_cbranch_scc1 L2_xl25
    ds_read_b32 v32, v44 offset:896
    s_add_u32 s3, s42, 2
    s_bitset1_b32 s43, s3
    s_branch L2_xg25
L2_xl25:
    s_waitcnt lgkmcnt(0)
    v_mov_b32 v31, -1
    s_cmp_ge_u32 s37, 512
    s_cbranch_scc1 L2_xg25
    v_mov_b32 v39, -1
    s_cmp_ge_u32 s37, 256
    s_cbranch_scc1 L2_xg25
    v_mov_b32 v27, -1
    s_branch L2_xg25
L2_xt25:
    s_waitcnt lgkmcnt(0)
    v_mov_b32 v21, -1
    v_mov_b32 v27, -1
    v_mov_b32 v39, -1
    v_mov_b32 v31, -1
    s_add_u32 s3, s42, 2
    s_bitset1_b32 s36, s3
    s_branch L2_xg25
L2_oa28:
    v_and_b32 v47, 0x0fffffff, v33
    buffer_load_dword v114, v47, s[8:11], 0 offen offset:16
    s_mov_b64 exec, s[6:7]
    v_add_u32 v47, 8, v47
    v_lshrrev_b32 v33, 2, v33
    s_mov_b64 exec, -1
    buffer_load_dwordx2 v[112:113], v47, s[8:11], 0 offen
    s_branch L2_ob28
L2_c29:
    s_lshl_b64 s[52:53], s[82:83], 1
    s_andn2_b64 s[52:53], s[52:53], s[80:81]
    s_andn2_b64 s[52:53], s[52:53], s[54:55]
    s_or_b64 s[80:81], s[80:81], s[52:53]
    s_not_b64 vcc, s[52:53]
    s_mov_b64 exec, -1
    v_cndmask_b32_dpp v84, v84, v84, vcc wave_shr:1 row_mask:0xf bank_mask:0xf
    v_cndmask_b32_dpp v85, v85, v85, vcc wave_shr:1 row_mask:0xf bank_mask:0xf
    s_lshr_b64 s[52:53], s[52:53], 1
    v_cndmask_b32_dpp v86, v86, v86, vcc wave_shr:1 row_mask:0xf bank_mask:0xf
    v_cndmask_b32_dpp v87, v87, v87, vcc wave_shr:1 row_mask:0xf bank_mask:0xf
    s_andn2_b64 s[82:83], s[82:83], s[52:53]
    v_cndmask_b32_dpp v7, v7, v7, vcc wave_shr:1 row_mask:0xf bank_mask:0xf
    s_mov_b64 exec, s[54:55]
    s_cbranch_scc0 L2_d29
    s_mov_b64 exec, s[82:83]
    s_nop 1
    v_mfma_f32_4x4x4_16b_bf16 v[88:91], v[12:13], v[84:85], 0
    s_nop 1
    v_mfma_f32_4x4x4_16b_bf16 v[88:91], v[10:11], v[86:87], v[88:91]
    s_nop 4
    v_cvt_pk_bf16_f32 v88, v88, v89
    v_cvt_pk_bf16_f32 v89, v90, v91
    ds_pk_add_bf16 v7, v88 offset:65408
    ds_pk_add_bf16 v7, v89 offset:65412
    s_mov_b64 exec, s[54:55]
    s_branch L2_d29
L2_c30:
    s_lshl_b64 s[52:53], s[82:83], 1
    s_andn2_b64 s[52:53], s[52:53], s[80:81]
    s_andn2_b64 s[52:53], s[52:53], s[50:51]
    s_or_b64 s[80:81], s[80:81], s[52:53]
    s_not_b64 vcc, s[52:53]
    s_mov_b64 exec, -1
    v_cndmask_b32_dpp v84, v84, v84, vcc wave_shr:1 row_mask:0xf bank_mask:0xf
    v_cndmask_b32_dpp v85, v85, v85, vcc wave_shr:1 row_mask:0xf bank_mask:0xf
    s_lshr_b64 s[52:53], s[52:53], 1
    v_cndmask_b32_dpp v86, v86, v86, vcc wave_shr:1 row_mask:0xf bank_mask:0xf
    v_cndmask_b32_dpp v87, v87, v87, vcc wave_shr:1 row_mask:0xf bank_mask:0xf
    s_andn2_b64 s[82:83], s[82:83], s[52:53]
    v_cndmask_b32_dpp v7, v7, v7, vcc wave_shr:1 row_mask:0xf bank_mask:0xf
    s_mov_b64 exec, s[50:51]
    s_cbranch_scc0 L2_d30
    s_mov_b64 exec, s[82:83]
    s_nop 1
    v_mfma_f32_4x4x4_16b_bf16 v[88:91], v[12:13], v[84:85], 0
    s_nop 1
    v_mfma_f32_4x4x4_16b_bf16 v[88:91], v[10:11], v[86:87], v[88:91]
    s_nop 4
    v_cvt_pk_bf16_f32 v88, v88, v89
    v_cvt_pk_bf16_f32 v89, v90, v91
    ds_pk_add_bf16 v7, v88 offset:65408
    ds_pk_add_bf16 v7, v89 offset:65412
    s_mov_b64 exec, s[50:51]
    s_branch L2_d30
L2_c31:
    s_lshl_b64 s[52:53], s[82:83], 1
    s_andn2_b64 s[52:53], s[52:53], s[80:81]
    s_andn2_b64 s[52:53], s[52:53], s[54:55]
    s_or_b64 s[80:81], s[80:81], s[52:53]
    s_not_b64 vcc, s[52:53]
    s_mov_b64 exec, -1
    v_cndmask_b32_dpp v84, v84, v84, vcc wave_shr:1 row_mask:0xf bank_mask:0xf
    v_cndmask_b32_dpp v85, v85, v85, vcc wave_shr:1 row_mask:0xf bank_mask:0xf
    s_lshr_b64 s[52:53], s[52:53], 1
    v_cndmask_b32_dpp v86, v86, v86, vcc wave_shr:1 row_mask:0xf bank_mask:0xf
    v_cndmask_b32_dpp v87, v87, v87, vcc wave_shr:1 row_mask:0xf bank_mask:0xf
    s_andn2_b64 s[82:83], s[82:83], s[52:53]
    v_cndmask_b32_dpp v7, v7, v7, vcc wave_shr:1 row_mask:0xf bank_mask:0xf
    s_mov_b64 exec, s[54:55]
    s_cbranch_scc0 L2_d31
    s_mov_b64 exec, s[82:83]
    s_nop 1
    v_mfma_f32_4x4x4_16b_bf16 v[88:91], v[12:13], v[84:85], 0
    s_nop 1
    v_mfma_f32_4x4x4_16b_bf16 v[88:91], v[10:11], v[86:87], v[88:91]
    s_nop 4
    v_cvt_pk_bf16_f32 v88, v88, v89
    v_cvt_pk_bf16_f32 v89, v90, v91
    ds_pk_add_bf16 v7, v88 offset:65408
    ds_pk_add_bf16 v7, v89 offset:65412
    s_mov_b64 exec, s[54:55]
    s_branch L2_d31
L2_c32:
    s_lshl_b64 s[52:53], s[82:83], 1
    s_andn2_b64 s[52:53], s[52:53], s[80:81]
    s_andn2_b64 s[52:53], s[52:53], s[50:51]
    s_or_b64 s[80:81], s[80:81], s[52:53]
    s_not_b64 vcc, s[52:53]
    s_mov_b64 exec, -1
    v_cndmask_b32_dpp v84, v84, v84, vcc wave_shr:1 row_mask:0xf bank_mask:0xf
    v_cndmask_b32_dpp v85, v85, v85, vcc wave_shr:1 row_mask:0xf bank_mask:0xf
    s_lshr_b64 s[52:53], s[52:53], 1
    v_cndmask_b32_dpp v86, v86, v86, vcc wave_shr:1 row_mask:0xf bank_mask:0xf
    v_cndmask_b32_dpp v87, v87, v87, vcc wave_shr:1 row_mask:0xf bank_mask:0xf
    s_andn2_b64 s[82:83], s[82:83], s[52:53]
    v_cndmask_b32_dpp v7, v7, v7, vcc wave_shr:1 row_mask:0xf bank_mask:0xf
    s_mov_b64 exec, s[50:51]
    s_cbranch_scc0 L2_d32
    s_mov_b64 exec, s[82:83]
    s_nop 1
    v_mfma_f32_4x4x4_16b_bf16 v[88:91], v[12:13], v[84:85], 0
    s_nop 1
    v_mfma_f32_4x4x4_16b_bf16 v[88:91], v[10:11], v[86:87], v[88:91]
    s_nop 4
    v_cvt_pk_bf16_f32 v88, v88, v89
    v_cvt_pk_bf16_f32 v89, v90, v91
    ds_pk_add_bf16 v7, v88 offset:65408
    ds_pk_add_bf16 v7, v89 offset:65412
    s_mov_b64 exec, s[50:51]
    s_branch L2_d32
L2_c33:
    s_lshl_b64 s[52:53], s[82:83], 1
    s_andn2_b64 s[52:53], s[52:53], s[80:81]
    s_andn2_b64 s[52:53], s[52:53], s[54:55]
    s_or_b64 s[80:81], s[80:81], s[52:53]
    s_not_b64 vcc, s[52:53]
    s_mov_b64 exec, -1
    v_cndmask_b32_dpp v84, v84, v84, vcc wave_shr:1 row_mask:0xf bank_mask:0xf
    v_cndmask_b32_dpp v85, v85, v85, vcc wave_shr:1 row_mask:0xf bank_mask:0xf
    s_lshr_b64 s[52:53], s[52:53], 1
    v_cndmask_b32_dpp v86, v86, v86, vcc wave_shr:1 row_mask:0xf bank_mask:0xf
    v_cndmask_b32_dpp v87, v87, v87, vcc wave_shr:1 row_mask:0xf bank_mask:0xf
    s_andn2_b64 s[82:83], s[82:83], s[52:53]
    v_cndmask_b32_dpp v7, v7, v7, vcc wave_shr:1 row_mask:0xf bank_mask:0xf
    s_mov_b64 exec, s[54:55]
    s_cbranch_scc0 L2_d33
    s_mov_b64 exec, s[82:83]
    s_nop 1
    v_mfma_f32_4x4x4_16b_bf16 v[88:91], v[12:13], v[84:85], 0
    s_nop 1
    v_mfma_f32_4x4x4_16b_bf16 v[88:91], v[10:11], v[86:87], v[88:91]
    s_nop 4
    v_cvt_pk_bf16_f32 v88, v88, v89
    v_cvt_pk_bf16_f32 v89, v90, v91
    ds_pk_add_bf16 v7, v88 offset:65408
    ds_pk_add_bf16 v7, v89 offset:65412
    s_mov_b64 exec, s[54:55]
    s_branch L2_d33
L2_c34:
    s_lshl_b64 s[52:53], s[82:83], 1
    s_andn2_b64 s[52:53], s[52:53], s[80:81]
    s_andn2_b64 s[52:53], s[52:53], s[50:51]
    s_or_b64 s[80:81], s[80:81], s[52:53]
    s_not_b64 vcc, s[52:53]
    s_mov_b64 exec, -1
    v_cndmask_b32_dpp v84, v84, v84, vcc wave_shr:1 row_mask:0xf bank_mask:0xf
    v_cndmask_b32_dpp v85, v85, v85, vcc wave_shr:1 row_mask:0xf bank_mask:0xf
    s_lshr_b64 s[52:53], s[52:53], 1
    v_cndmask_b32_dpp v86, v86, v86, vcc wave_shr:1 row_mask:0xf bank_mask:0xf
    v_cndmask_b32_dpp v87, v87, v87, vcc wave_shr:1 row_mask:0xf bank_mask:0xf
    s_andn2_b64 s[82:83], s[82:83], s[52:53]
    v_cndmask_b32_dpp v7, v7, v7, vcc wave_shr:1 row_mask:0xf bank_mask:0xf
    s_mov_b64 exec, s[50:51]
    s_cbranch_scc0 L2_d34
    s_mov_b64 exec, s[82:83]
    s_nop 1
    v_mfma_f32_4x4x4_16b_bf16 v[88:91], v[12:13], v[84:85], 0
    s_nop 1
    v_mfma_f32_4x4x4_16b_bf16 v[88:91], v[10:11], v[86:87], v[88:91]
    s_nop 4
    v_cvt_pk_bf16_f32 v88, v88, v89
    v_cvt_pk_bf16_f32 v89, v90, v91
    ds_pk_add_bf16 v7, v88 offset:65408
    ds_pk_add_bf16 v7, v89 offset:65412
    s_mov_b64 exec, s[50:51]
    s_branch L2_d34
L2_oa35:
    s_waitcnt vmcnt(3)
    s_mov_b64 exec, s[6:7]
    v_lshrrev_b32 v114, 16, v114
    s_mov_b64 exec, -1
    v_and_b32 v46, 0x10000000, v33
    v_cmpx_eq_u32 vcc, 0, v46
    v_lshrrev_b32 v47, 14, v112
    v_and_b32 v47, v5, v47
    ds_read_b64 v[96:97], v47
    v_perm_b32 v98, v112, v114, s44
    v_bitop3_b32 v99, v112, 0.5, -0.5 bitop3:0xa8
    v_bitop3_b32 v98, v6, v98, v99 bitop3:0xca
    v_and_b32 v47, v5, v112
    s_waitcnt lgkmcnt(0)
    v_mfma_f32_4x4x4_16b_bf16 v[88:91], v[8:9], v[96:97], 0
    s_nop 4
    v_mul_f32 v88, v98, v88
    v_mul_f32 v89, v98, v89
    v_mul_f32 v90, v98, v90
    v_mul_f32 v91, v98, v91
    v_cvt_pk_bf16_f32 v88, v88, v89
    v_cvt_pk_bf16_f32 v89, v90, v91
    ds_pk_add_bf16 v47, v88 offset:65408
    ds_pk_add_bf16 v47, v89 offset:65412
    s_mov_b64 exec, -1
    v_and_b32 v46, 0x20000000, v33
    v_cmpx_eq_u32 vcc, 0, v46
    v_lshrrev_b32 v47, 14, v113
    v_and_b32 v47, v5, v47
    ds_read_b64 v[96:97], v47
    v_perm_b32 v98, v113, v114, s45
    v_bitop3_b32 v99, v113, 0.5, -0.5 bitop3:0xa8
    v_bitop3_b32 v98, v6, v98, v99 bitop3:0xca
    v_and_b32 v47, v5, v113
    s_waitcnt lgkmcnt(0)
    v_mfma_f32_4x4x4_16b_bf16 v[88:91], v[8:9], v[96:97], 0
    s_nop 4
    v_mul_f32 v88, v98, v88
    v_mul_f32 v89, v98, v89
    v_mul_f32 v90, v98, v90
    v_mul_f32 v91, v98, v91
    v_cvt_pk_bf16_f32 v88, v88, v89
    v_cvt_pk_bf16_f32 v89, v90, v91
    ds_pk_add_bf16 v47, v88 offset:65408
    ds_pk_add_bf16 v47, v89 offset:65412
    s_mov_b64 exec, -1
    s_branch L2_ob35
L2_xo36:
    v_cmp_lt_u32 vcc, 20, v99
    s_mov_b32 s101, 1
    s_cbranch_vccz L2_xp36
    v_cmp_lt_u32 vcc, 32, v99
    v_cmp_lt_u32 s[58:59], 31, v88
    s_mov_b32 s101, 2
    s_or_b64 vcc, vcc, s[58:59]
    s_cbranch_scc0 L2_xp36
    s_mov_b32 s37, 0x10000
    s_branch L2_xp36
L2_c37:
    s_lshl_b64 s[52:53], s[82:83], 1
    s_andn2_b64 s[52:53], s[52:53], s[80:81]
    s_andn2_b64 s[52:53], s[52:53], s[54:55]
    s_or_b64 s[80:81], s[80:81], s[52:53]
    s_not_b64 vcc, s[52:53]
    s_mov_b64 exec, -1
    v_cndmask_b32_dpp v84, v84, v84, vcc wave_shr:1 row_mask:0xf bank_mask:0xf
    v_cndmask_b32_dpp v85, v85, v85, vcc wave_shr:1 row_mask:0xf bank_mask:0xf
    s_lshr_b64 s[52:53], s[52:53], 1
    v_cndmask_b32_dpp v86, v86, v86, vcc wave_shr:1 row_mask:0xf bank_mask:0xf
    v_cndmask_b32_dpp v87, v87, v87, vcc wave_shr:1 row_mask:0xf bank_mask:0xf
    s_andn2_b64 s[82:83], s[82:83], s[52:53]
    v_cndmask_b32_dpp v7, v7, v7, vcc wave_shr:1 row_mask:0xf bank_mask:0xf
    s_mov_b64 exec, s[54:55]
    s_cbranch_scc0 L2_d37
    s_mov_b64 exec, s[82:83]
    s_nop 1
    v_mfma_f32_4x4x4_16b_bf16 v[88:91], v[12:13], v[84:85], 0
    s_nop 1
    v_mfma_f32_4x4x4_16b_bf16 v[88:91], v[10:11], v[86:87], v[88:91]
    s_nop 4
    v_cvt_pk_bf16_f32 v88, v88, v89
    v_cvt_pk_bf16_f32 v89, v90, v91
    ds_pk_add_bf16 v7, v88 offset:65408
    ds_pk_add_bf16 v7, v89 offset:65412
    s_mov_b64 exec, s[54:55]
    s_branch L2_d37
L2_c38:
    s_lshl_b64 s[52:53], s[82:83], 1
    s_andn2_b64 s[52:53], s[52:53], s[80:81]
    s_andn2_b64 s[52:53], s[52:53], s[50:51]
    s_or_b64 s[80:81], s[80:81], s[52:53]
    s_not_b64 vcc, s[52:53]
    s_mov_b64 exec, -1
    v_cndmask_b32_dpp v84, v84, v84, vcc wave_shr:1 row_mask:0xf bank_mask:0xf
    v_cndmask_b32_dpp v85, v85, v85, vcc wave_shr:1 row_mask:0xf bank_mask:0xf
    s_lshr_b64 s[52:53], s[52:53], 1
    v_cndmask_b32_dpp v86, v86, v86, vcc wave_shr:1 row_mask:0xf bank_mask:0xf
    v_cndmask_b32_dpp v87, v87, v87, vcc wave_shr:1 row_mask:0xf bank_mask:0xf
    s_andn2_b64 s[82:83], s[82:83], s[52:53]
    v_cndmask_b32_dpp v7, v7, v7, vcc wave_shr:1 row_mask:0xf bank_mask:0xf
    s_mov_b64 exec, s[50:51]
    s_cbranch_scc0 L2_d38
    s_mov_b64 exec, s[82:83]
    s_nop 1
    v_mfma_f32_4x4x4_16b_bf16 v[88:91], v[12:13], v[84:85], 0
    s_nop 1
    v_mfma_f32_4x4x4_16b_bf16 v[88:91], v[10:11], v[86:87], v[88:91]
    s_nop 4
    v_cvt_pk_bf16_f32 v88, v88, v89
    v_cvt_pk_bf16_f32 v89, v90, v91
    ds_pk_add_bf16 v7, v88 offset:65408
    ds_pk_add_bf16 v7, v89 offset:65412
    s_mov_b64 exec, s[50:51]
    s_branch L2_d38
L2_c39:
    s_lshl_b64 s[52:53], s[82:83], 1
    s_andn2_b64 s[52:53], s[52:53], s[80:81]
    s_andn2_b64 s[52:53], s[52:53], s[54:55]
    s_or_b64 s[80:81], s[80:81], s[52:53]
    s_not_b64 vcc, s[52:53]
    s_mov_b64 exec, -1
    v_cndmask_b32_dpp v84, v84, v84, vcc wave_shr:1 row_mask:0xf bank_mask:0xf
    v_cndmask_b32_dpp v85, v85, v85, vcc wave_shr:1 row_mask:0xf bank_mask:0xf
    s_lshr_b64 s[52:53], s[52:53], 1
    v_cndmask_b32_dpp v86, v86, v86, vcc wave_shr:1 row_mask:0xf bank_mask:0xf
    v_cndmask_b32_dpp v87, v87, v87, vcc wave_shr:1 row_mask:0xf bank_mask:0xf
    s_andn2_b64 s[82:83], s[82:83], s[52:53]
    v_cndmask_b32_dpp v7, v7, v7, vcc wave_shr:1 row_mask:0xf bank_mask:0xf
    s_mov_b64 exec, s[54:55]
    s_cbranch_scc0 L2_d39
    s_mov_b64 exec, s[82:83]
    s_nop 1
    v_mfma_f32_4x4x4_16b_bf16 v[88:91], v[12:13], v[84:85], 0
    s_nop 1
    v_mfma_f32_4x4x4_16b_bf16 v[88:91], v[10:11], v[86:87], v[88:91]
    s_nop 4
    v_cvt_pk_bf16_f32 v88, v88, v89
    v_cvt_pk_bf16_f32 v89, v90, v91
    ds_pk_add_bf16 v7, v88 offset:65408
    ds_pk_add_bf16 v7, v89 offset:65412
    s_mov_b64 exec, s[54:55]
    s_branch L2_d39
L2_c40:
    s_lshl_b64 s[52:53], s[82:83], 1
    s_andn2_b64 s[52:53], s[52:53], s[80:81]
    s_andn2_b64 s[52:53], s[52:53], s[50:51]
    s_or_b64 s[80:81], s[80:81], s[52:53]
    s_not_b64 vcc, s[52:53]
    s_mov_b64 exec, -1
    v_cndmask_b32_dpp v84, v84, v84, vcc wave_shr:1 row_mask:0xf bank_mask:0xf
    v_cndmask_b32_dpp v85, v85, v85, vcc wave_shr:1 row_mask:0xf bank_mask:0xf
    s_lshr_b64 s[52:53], s[52:53], 1
    v_cndmask_b32_dpp v86, v86, v86, vcc wave_shr:1 row_mask:0xf bank_mask:0xf
    v_cndmask_b32_dpp v87, v87, v87, vcc wave_shr:1 row_mask:0xf bank_mask:0xf
    s_andn2_b64 s[82:83], s[82:83], s[52:53]
    v_cndmask_b32_dpp v7, v7, v7, vcc wave_shr:1 row_mask:0xf bank_mask:0xf
    s_mov_b64 exec, s[50:51]
    s_cbranch_scc0 L2_d40
    s_mov_b64 exec, s[82:83]
    s_nop 1
    v_mfma_f32_4x4x4_16b_bf16 v[88:91], v[12:13], v[84:85], 0
    s_nop 1
    v_mfma_f32_4x4x4_16b_bf16 v[88:91], v[10:11], v[86:87], v[88:91]
    s_nop 4
    v_cvt_pk_bf16_f32 v88, v88, v89
    v_cvt_pk_bf16_f32 v89, v90, v91
    ds_pk_add_bf16 v7, v88 offset:65408
    ds_pk_add_bf16 v7, v89 offset:65412
    s_mov_b64 exec, s[50:51]
    s_branch L2_d40
L2_c41:
    s_lshl_b64 s[52:53], s[82:83], 1
    s_andn2_b64 s[52:53], s[52:53], s[80:81]
    s_andn2_b64 s[52:53], s[52:53], s[54:55]
    s_or_b64 s[80:81], s[80:81], s[52:53]
    s_not_b64 vcc, s[52:53]
    s_mov_b64 exec, -1
    v_cndmask_b32_dpp v84, v84, v84, vcc wave_shr:1 row_mask:0xf bank_mask:0xf
    v_cndmask_b32_dpp v85, v85, v85, vcc wave_shr:1 row_mask:0xf bank_mask:0xf
    s_lshr_b64 s[52:53], s[52:53], 1
    v_cndmask_b32_dpp v86, v86, v86, vcc wave_shr:1 row_mask:0xf bank_mask:0xf
    v_cndmask_b32_dpp v87, v87, v87, vcc wave_shr:1 row_mask:0xf bank_mask:0xf
    s_andn2_b64 s[82:83], s[82:83], s[52:53]
    v_cndmask_b32_dpp v7, v7, v7, vcc wave_shr:1 row_mask:0xf bank_mask:0xf
    s_mov_b64 exec, s[54:55]
    s_cbranch_scc0 L2_d41
    s_mov_b64 exec, s[82:83]
    s_nop 1
    v_mfma_f32_4x4x4_16b_bf16 v[88:91], v[12:13], v[84:85], 0
    s_nop 1
    v_mfma_f32_4x4x4_16b_bf16 v[88:91], v[10:11], v[86:87], v[88:91]
    s_nop 4
    v_cvt_pk_bf16_f32 v88, v88, v89
    v_cvt_pk_bf16_f32 v89, v90, v91
    ds_pk_add_bf16 v7, v88 offset:65408
    ds_pk_add_bf16 v7, v89 offset:65412
    s_mov_b64 exec, s[54:55]
    s_branch L2_d41
L2_c42:
    s_lshl_b64 s[52:53], s[82:83], 1
    s_andn2_b64 s[52:53], s[52:53], s[80:81]
    s_andn2_b64 s[52:53], s[52:53], s[50:51]
    s_or_b64 s[80:81], s[80:81], s[52:53]
    s_not_b64 vcc, s[52:53]
    s_mov_b64 exec, -1
    v_cndmask_b32_dpp v84, v84, v84, vcc wave_shr:1 row_mask:0xf bank_mask:0xf
    v_cndmask_b32_dpp v85, v85, v85, vcc wave_shr:1 row_mask:0xf bank_mask:0xf
    s_lshr_b64 s[52:53], s[52:53], 1
    v_cndmask_b32_dpp v86, v86, v86, vcc wave_shr:1 row_mask:0xf bank_mask:0xf
    v_cndmask_b32_dpp v87, v87, v87, vcc wave_shr:1 row_mask:0xf bank_mask:0xf
    s_andn2_b64 s[82:83], s[82:83], s[52:53]
    v_cndmask_b32_dpp v7, v7, v7, vcc wave_shr:1 row_mask:0xf bank_mask:0xf
    s_mov_b64 exec, s[50:51]
    s_cbranch_scc0 L2_d42
    s_mov_b64 exec, s[82:83]
    s_nop 1
    v_mfma_f32_4x4x4_16b_bf16 v[88:91], v[12:13], v[84:85], 0
    s_nop 1
    v_mfma_f32_4x4x4_16b_bf16 v[88:91], v[10:11], v[86:87], v[88:91]
    s_nop 4
    v_cvt_pk_bf16_f32 v88, v88, v89
    v_cvt_pk_bf16_f32 v89, v90, v91
    ds_pk_add_bf16 v7, v88 offset:65408
    ds_pk_add_bf16 v7, v89 offset:65412
    s_mov_b64 exec, s[50:51]
    s_branch L2_d42
L2_xa43:
    s_cmp_eq_u32 s101, 1
    s_cbranch_scc1 L2_xc43
    v_lshlrev_b32 v89, 0, v96
    v_add_u32 v90, 140, v97
    v_bitop3_b32 v90, v89, v45, v90 bitop3:0x6a
    ds_write_b32 v98, v90 offset:28
    v_lshlrev_b32 v89, 4, v96
    v_add_u32 v90, 120, v97
    v_bitop3_b32 v90, v89, v45, v90 bitop3:0x6a
    ds_write_b32 v98, v90 offset:24
    v_lshlrev_b32 v89, 8, v96
    v_add_u32 v90, 100, v97
    v_bitop3_b32 v90, v89, v45, v90 bitop3:0x6a
    ds_write_b32 v98, v90 offset:20
L2_xc43:
    v_lshlrev_b32 v89, 12, v96
    v_add_u32 v90, 80, v97
    v_bitop3_b32 v90, v89, v45, v90 bitop3:0x6a
    ds_write_b32 v98, v90 offset:16
    s_branch L2_xb43
L2_xe43:
    v_cmp_lt_u32 vcc, 32, v99
    v_cmp_lt_u32 s[58:59], 31, v88
    v_lshrrev_b32 v89, 16, v96
    v_add_u32 v97, 80, v97
    s_or_b64 vcc, vcc, s[58:59]
    s_cbranch_scc1 L2_xs43
    v_lshlrev_b32 v89, v1, v89
    v_and_b32 v89, v45, v89
    v_cmp_ne_u32 vcc, 0, v89
    v_xor_b32 v90, v97, v89
    s_add_u32 s3, s37, s38
    v_mbcnt_lo_u32_b32 v98, vcc_lo, 0
    v_mbcnt_hi_u32_b32 v98, vcc_hi, v98
    s_bcnt1_i32_b64 s41, vcc
    v_lshl_add_u32 v98, v98, 2, s3
    s_lshl2_add_u32 s37, s41, s37
    s_mov_b64 exec, vcc
    ds_write_b32 v98, v90
    s_mov_b64 exec, -1
    s_branch L2_xr43
L2_xs43:
    s_waitcnt lgkmcnt(0)
    s_mov_b32 s37, 0x10000
    s_branch L2_xw43
L2_c44:
    s_lshl_b64 s[52:53], s[82:83], 1
    s_andn2_b64 s[52:53], s[52:53], s[80:81]
    s_andn2_b64 s[52:53], s[52:53], s[54:55]
    s_or_b64 s[80:81], s[80:81], s[52:53]
    s_not_b64 vcc, s[52:53]
    s_mov_b64 exec, -1
    v_cndmask_b32_dpp v84, v84, v84, vcc wave_shr:1 row_mask:0xf bank_mask:0xf
    v_cndmask_b32_dpp v85, v85, v85, vcc wave_shr:1 row_mask:0xf bank_mask:0xf
    s_lshr_b64 s[52:53], s[52:53], 1
    v_cndmask_b32_dpp v86, v86, v86, vcc wave_shr:1 row_mask:0xf bank_mask:0xf
    v_cndmask_b32_dpp v87, v87, v87, vcc wave_shr:1 row_mask:0xf bank_mask:0xf
    s_andn2_b64 s[82:83], s[82:83], s[52:53]
    v_cndmask_b32_dpp v7, v7, v7, vcc wave_shr:1 row_mask:0xf bank_mask:0xf
    s_mov_b64 exec, s[54:55]
    s_cbranch_scc0 L2_d44
    s_mov_b64 exec, s[82:83]
    s_nop 1
    v_mfma_f32_4x4x4_16b_bf16 v[88:91], v[12:13], v[84:85], 0
    s_nop 1
    v_mfma_f32_4x4x4_16b_bf16 v[88:91], v[10:11], v[86:87], v[88:91]
    s_nop 4
    v_cvt_pk_bf16_f32 v88, v88, v89
    v_cvt_pk_bf16_f32 v89, v90, v91
    ds_pk_add_bf16 v7, v88 offset:65408
    ds_pk_add_bf16 v7, v89 offset:65412
    s_mov_b64 exec, s[54:55]
    s_branch L2_d44
L2_c45:
    s_lshl_b64 s[52:53], s[82:83], 1
    s_andn2_b64 s[52:53], s[52:53], s[80:81]
    s_andn2_b64 s[52:53], s[52:53], s[50:51]
    s_or_b64 s[80:81], s[80:81], s[52:53]
    s_not_b64 vcc, s[52:53]
    s_mov_b64 exec, -1
    v_cndmask_b32_dpp v84, v84, v84, vcc wave_shr:1 row_mask:0xf bank_mask:0xf
    v_cndmask_b32_dpp v85, v85, v85, vcc wave_shr:1 row_mask:0xf bank_mask:0xf
    s_lshr_b64 s[52:53], s[52:53], 1
    v_cndmask_b32_dpp v86, v86, v86, vcc wave_shr:1 row_mask:0xf bank_mask:0xf
    v_cndmask_b32_dpp v87, v87, v87, vcc wave_shr:1 row_mask:0xf bank_mask:0xf
    s_andn2_b64 s[82:83], s[82:83], s[52:53]
    v_cndmask_b32_dpp v7, v7, v7, vcc wave_shr:1 row_mask:0xf bank_mask:0xf
    s_mov_b64 exec, s[50:51]
    s_cbranch_scc0 L2_d45
    s_mov_b64 exec, s[82:83]
    s_nop 1
    v_mfma_f32_4x4x4_16b_bf16 v[88:91], v[12:13], v[84:85], 0
    s_nop 1
    v_mfma_f32_4x4x4_16b_bf16 v[88:91], v[10:11], v[86:87], v[88:91]
    s_nop 4
    v_cvt_pk_bf16_f32 v88, v88, v89
    v_cvt_pk_bf16_f32 v89, v90, v91
    ds_pk_add_bf16 v7, v88 offset:65408
    ds_pk_add_bf16 v7, v89 offset:65412
    s_mov_b64 exec, s[50:51]
    s_branch L2_d45
L2_xf43:
    s_cmp_gt_u32 s37, 1024
    s_cbranch_scc1 L2_xt43
    s_cmp_lt_u32 s37, 768
    s_cbranch_scc1 L2_xl43
    ds_read_b32 v33, v44 offset:896
    s_add_u32 s3, s42, 2
    s_bitset1_b32 s43, s3
    s_branch L2_xg43
L2_xl43:
    s_waitcnt lgkmcnt(0)
    v_mov_b32 v42, -1
    s_cmp_ge_u32 s37, 512
    s_cbranch_scc1 L2_xg43
    v_mov_b32 v43, -1
    s_cmp_ge_u32 s37, 256
    s_cbranch_scc1 L2_xg43
    v_mov_b32 v41, -1
    s_branch L2_xg43
L2_xt43:
    s_waitcnt lgkmcnt(0)
    v_mov_b32 v40, -1
    v_mov_b32 v41, -1
    v_mov_b32 v43, -1
    v_mov_b32 v42, -1
    s_add_u32 s3, s42, 2
    s_bitset1_b32 s36, s3
    s_branch L2_xg43
L2_oa46:
    v_and_b32 v47, 0x0fffffff, v32
    buffer_load_dword v114, v47, s[8:11], 0 offen offset:16
    s_mov_b64 exec, s[6:7]
    v_add_u32 v47, 8, v47
    v_lshrrev_b32 v32, 2, v32
    s_mov_b64 exec, -1
    buffer_load_dwordx2 v[112:113], v47, s[8:11], 0 offen
    s_branch L2_ob46
L2_c47:
    s_lshl_b64 s[52:53], s[82:83], 1
    s_andn2_b64 s[52:53], s[52:53], s[80:81]
    s_andn2_b64 s[52:53], s[52:53], s[54:55]
    s_or_b64 s[80:81], s[80:81], s[52:53]
    s_not_b64 vcc, s[52:53]
    s_mov_b64 exec, -1
    v_cndmask_b32_dpp v84, v84, v84, vcc wave_shr:1 row_mask:0xf bank_mask:0xf
    v_cndmask_b32_dpp v85, v85, v85, vcc wave_shr:1 row_mask:0xf bank_mask:0xf
    s_lshr_b64 s[52:53], s[52:53], 1
    v_cndmask_b32_dpp v86, v86, v86, vcc wave_shr:1 row_mask:0xf bank_mask:0xf
    v_cndmask_b32_dpp v87, v87, v87, vcc wave_shr:1 row_mask:0xf bank_mask:0xf
    s_andn2_b64 s[82:83], s[82:83], s[52:53]
    v_cndmask_b32_dpp v7, v7, v7, vcc wave_shr:1 row_mask:0xf bank_mask:0xf
    s_mov_b64 exec, s[54:55]
    s_cbranch_scc0 L2_d47
    s_mov_b64 exec, s[82:83]
    s_nop 1
    v_mfma_f32_4x4x4_16b_bf16 v[88:91], v[12:13], v[84:85], 0
    s_nop 1
    v_mfma_f32_4x4x4_16b_bf16 v[88:91], v[10:11], v[86:87], v[88:91]
    s_nop 4
    v_cvt_pk_bf16_f32 v88, v88, v89
    v_cvt_pk_bf16_f32 v89, v90, v91
    ds_pk_add_bf16 v7, v88 offset:65408
    ds_pk_add_bf16 v7, v89 offset:65412
    s_mov_b64 exec, s[54:55]
    s_branch L2_d47
L2_c48:
    s_lshl_b64 s[52:53], s[82:83], 1
    s_andn2_b64 s[52:53], s[52:53], s[80:81]
    s_andn2_b64 s[52:53], s[52:53], s[50:51]
    s_or_b64 s[80:81], s[80:81], s[52:53]
    s_not_b64 vcc, s[52:53]
    s_mov_b64 exec, -1
    v_cndmask_b32_dpp v84, v84, v84, vcc wave_shr:1 row_mask:0xf bank_mask:0xf
    v_cndmask_b32_dpp v85, v85, v85, vcc wave_shr:1 row_mask:0xf bank_mask:0xf
    s_lshr_b64 s[52:53], s[52:53], 1
    v_cndmask_b32_dpp v86, v86, v86, vcc wave_shr:1 row_mask:0xf bank_mask:0xf
    v_cndmask_b32_dpp v87, v87, v87, vcc wave_shr:1 row_mask:0xf bank_mask:0xf
    s_andn2_b64 s[82:83], s[82:83], s[52:53]
    v_cndmask_b32_dpp v7, v7, v7, vcc wave_shr:1 row_mask:0xf bank_mask:0xf
    s_mov_b64 exec, s[50:51]
    s_cbranch_scc0 L2_d48
    s_mov_b64 exec, s[82:83]
    s_nop 1
    v_mfma_f32_4x4x4_16b_bf16 v[88:91], v[12:13], v[84:85], 0
    s_nop 1
    v_mfma_f32_4x4x4_16b_bf16 v[88:91], v[10:11], v[86:87], v[88:91]
    s_nop 4
    v_cvt_pk_bf16_f32 v88, v88, v89
    v_cvt_pk_bf16_f32 v89, v90, v91
    ds_pk_add_bf16 v7, v88 offset:65408
    ds_pk_add_bf16 v7, v89 offset:65412
    s_mov_b64 exec, s[50:51]
    s_branch L2_d48
L2_c49:
    s_lshl_b64 s[52:53], s[82:83], 1
    s_andn2_b64 s[52:53], s[52:53], s[80:81]
    s_andn2_b64 s[52:53], s[52:53], s[54:55]
    s_or_b64 s[80:81], s[80:81], s[52:53]
    s_not_b64 vcc, s[52:53]
    s_mov_b64 exec, -1
    v_cndmask_b32_dpp v84, v84, v84, vcc wave_shr:1 row_mask:0xf bank_mask:0xf
    v_cndmask_b32_dpp v85, v85, v85, vcc wave_shr:1 row_mask:0xf bank_mask:0xf
    s_lshr_b64 s[52:53], s[52:53], 1
    v_cndmask_b32_dpp v86, v86, v86, vcc wave_shr:1 row_mask:0xf bank_mask:0xf
    v_cndmask_b32_dpp v87, v87, v87, vcc wave_shr:1 row_mask:0xf bank_mask:0xf
    s_andn2_b64 s[82:83], s[82:83], s[52:53]
    v_cndmask_b32_dpp v7, v7, v7, vcc wave_shr:1 row_mask:0xf bank_mask:0xf
    s_mov_b64 exec, s[54:55]
    s_cbranch_scc0 L2_d49
    s_mov_b64 exec, s[82:83]
    s_nop 1
    v_mfma_f32_4x4x4_16b_bf16 v[88:91], v[12:13], v[84:85], 0
    s_nop 1
    v_mfma_f32_4x4x4_16b_bf16 v[88:91], v[10:11], v[86:87], v[88:91]
    s_nop 4
    v_cvt_pk_bf16_f32 v88, v88, v89
    v_cvt_pk_bf16_f32 v89, v90, v91
    ds_pk_add_bf16 v7, v88 offset:65408
    ds_pk_add_bf16 v7, v89 offset:65412
    s_mov_b64 exec, s[54:55]
    s_branch L2_d49
L2_c50:
    s_lshl_b64 s[52:53], s[82:83], 1
    s_andn2_b64 s[52:53], s[52:53], s[80:81]
    s_andn2_b64 s[52:53], s[52:53], s[50:51]
    s_or_b64 s[80:81], s[80:81], s[52:53]
    s_not_b64 vcc, s[52:53]
    s_mov_b64 exec, -1
    v_cndmask_b32_dpp v84, v84, v84, vcc wave_shr:1 row_mask:0xf bank_mask:0xf
    v_cndmask_b32_dpp v85, v85, v85, vcc wave_shr:1 row_mask:0xf bank_mask:0xf
    s_lshr_b64 s[52:53], s[52:53], 1
    v_cndmask_b32_dpp v86, v86, v86, vcc wave_shr:1 row_mask:0xf bank_mask:0xf
    v_cndmask_b32_dpp v87, v87, v87, vcc wave_shr:1 row_mask:0xf bank_mask:0xf
    s_andn2_b64 s[82:83], s[82:83], s[52:53]
    v_cndmask_b32_dpp v7, v7, v7, vcc wave_shr:1 row_mask:0xf bank_mask:0xf
    s_mov_b64 exec, s[50:51]
    s_cbranch_scc0 L2_d50
    s_mov_b64 exec, s[82:83]
    s_nop 1
    v_mfma_f32_4x4x4_16b_bf16 v[88:91], v[12:13], v[84:85], 0
    s_nop 1
    v_mfma_f32_4x4x4_16b_bf16 v[88:91], v[10:11], v[86:87], v[88:91]
    s_nop 4
    v_cvt_pk_bf16_f32 v88, v88, v89
    v_cvt_pk_bf16_f32 v89, v90, v91
    ds_pk_add_bf16 v7, v88 offset:65408
    ds_pk_add_bf16 v7, v89 offset:65412
    s_mov_b64 exec, s[50:51]
    s_branch L2_d50
L2_c51:
    s_lshl_b64 s[52:53], s[82:83], 1
    s_andn2_b64 s[52:53], s[52:53], s[80:81]
    s_andn2_b64 s[52:53], s[52:53], s[54:55]
    s_or_b64 s[80:81], s[80:81], s[52:53]
    s_not_b64 vcc, s[52:53]
    s_mov_b64 exec, -1
    v_cndmask_b32_dpp v84, v84, v84, vcc wave_shr:1 row_mask:0xf bank_mask:0xf
    v_cndmask_b32_dpp v85, v85, v85, vcc wave_shr:1 row_mask:0xf bank_mask:0xf
    s_lshr_b64 s[52:53], s[52:53], 1
    v_cndmask_b32_dpp v86, v86, v86, vcc wave_shr:1 row_mask:0xf bank_mask:0xf
    v_cndmask_b32_dpp v87, v87, v87, vcc wave_shr:1 row_mask:0xf bank_mask:0xf
    s_andn2_b64 s[82:83], s[82:83], s[52:53]
    v_cndmask_b32_dpp v7, v7, v7, vcc wave_shr:1 row_mask:0xf bank_mask:0xf
    s_mov_b64 exec, s[54:55]
    s_cbranch_scc0 L2_d51
    s_mov_b64 exec, s[82:83]
    s_nop 1
    v_mfma_f32_4x4x4_16b_bf16 v[88:91], v[12:13], v[84:85], 0
    s_nop 1
    v_mfma_f32_4x4x4_16b_bf16 v[88:91], v[10:11], v[86:87], v[88:91]
    s_nop 4
    v_cvt_pk_bf16_f32 v88, v88, v89
    v_cvt_pk_bf16_f32 v89, v90, v91
    ds_pk_add_bf16 v7, v88 offset:65408
    ds_pk_add_bf16 v7, v89 offset:65412
    s_mov_b64 exec, s[54:55]
    s_branch L2_d51
L2_c52:
    s_lshl_b64 s[52:53], s[82:83], 1
    s_andn2_b64 s[52:53], s[52:53], s[80:81]
    s_andn2_b64 s[52:53], s[52:53], s[50:51]
    s_or_b64 s[80:81], s[80:81], s[52:53]
    s_not_b64 vcc, s[52:53]
    s_mov_b64 exec, -1
    v_cndmask_b32_dpp v84, v84, v84, vcc wave_shr:1 row_mask:0xf bank_mask:0xf
    v_cndmask_b32_dpp v85, v85, v85, vcc wave_shr:1 row_mask:0xf bank_mask:0xf
    s_lshr_b64 s[52:53], s[52:53], 1
    v_cndmask_b32_dpp v86, v86, v86, vcc wave_shr:1 row_mask:0xf bank_mask:0xf
    v_cndmask_b32_dpp v87, v87, v87, vcc wave_shr:1 row_mask:0xf bank_mask:0xf
    s_andn2_b64 s[82:83], s[82:83], s[52:53]
    v_cndmask_b32_dpp v7, v7, v7, vcc wave_shr:1 row_mask:0xf bank_mask:0xf
    s_mov_b64 exec, s[50:51]
    s_cbranch_scc0 L2_d52
    s_mov_b64 exec, s[82:83]
    s_nop 1
    v_mfma_f32_4x4x4_16b_bf16 v[88:91], v[12:13], v[84:85], 0
    s_nop 1
    v_mfma_f32_4x4x4_16b_bf16 v[88:91], v[10:11], v[86:87], v[88:91]
    s_nop 4
    v_cvt_pk_bf16_f32 v88, v88, v89
    v_cvt_pk_bf16_f32 v89, v90, v91
    ds_pk_add_bf16 v7, v88 offset:65408
    ds_pk_add_bf16 v7, v89 offset:65412
    s_mov_b64 exec, s[50:51]
    s_branch L2_d52
L2_oa53:
    s_waitcnt vmcnt(3)
    s_mov_b64 exec, s[6:7]
    v_lshrrev_b32 v114, 16, v114
    s_mov_b64 exec, -1
    v_and_b32 v46, 0x10000000, v32
    v_cmpx_eq_u32 vcc, 0, v46
    v_lshrrev_b32 v47, 14, v112
    v_and_b32 v47, v5, v47
    ds_read_b64 v[96:97], v47
    v_perm_b32 v98, v112, v114, s44
    v_bitop3_b32 v99, v112, 0.5, -0.5 bitop3:0xa8
    v_bitop3_b32 v98, v6, v98, v99 bitop3:0xca
    v_and_b32 v47, v5, v112
    s_waitcnt lgkmcnt(0)
    v_mfma_f32_4x4x4_16b_bf16 v[88:91], v[8:9], v[96:97], 0
    s_nop 4
    v_mul_f32 v88, v98, v88
    v_mul_f32 v89, v98, v89
    v_mul_f32 v90, v98, v90
    v_mul_f32 v91, v98, v91
    v_cvt_pk_bf16_f32 v88, v88, v89
    v_cvt_pk_bf16_f32 v89, v90, v91
    ds_pk_add_bf16 v47, v88 offset:65408
    ds_pk_add_bf16 v47, v89 offset:65412
    s_mov_b64 exec, -1
    v_and_b32 v46, 0x20000000, v32
    v_cmpx_eq_u32 vcc, 0, v46
    v_lshrrev_b32 v47, 14, v113
    v_and_b32 v47, v5, v47
    ds_read_b64 v[96:97], v47
    v_perm_b32 v98, v113, v114, s45
    v_bitop3_b32 v99, v113, 0.5, -0.5 bitop3:0xa8
    v_bitop3_b32 v98, v6, v98, v99 bitop3:0xca
    v_and_b32 v47, v5, v113
    s_waitcnt lgkmcnt(0)
    v_mfma_f32_4x4x4_16b_bf16 v[88:91], v[8:9], v[96:97], 0
    s_nop 4
    v_mul_f32 v88, v98, v88
    v_mul_f32 v89, v98, v89
    v_mul_f32 v90, v98, v90
    v_mul_f32 v91, v98, v91
    v_cvt_pk_bf16_f32 v88, v88, v89
    v_cvt_pk_bf16_f32 v89, v90, v91
    ds_pk_add_bf16 v47, v88 offset:65408
    ds_pk_add_bf16 v47, v89 offset:65412
    s_mov_b64 exec, -1
    s_branch L2_ob53
L2_xo54:
    v_cmp_lt_u32 vcc, 20, v99
    s_mov_b32 s101, 1
    s_cbranch_vccz L2_xp54
    v_cmp_lt_u32 vcc, 32, v99
    v_cmp_lt_u32 s[58:59], 31, v88
    s_mov_b32 s101, 2
    s_or_b64 vcc, vcc, s[58:59]
    s_cbranch_scc0 L2_xp54
    s_mov_b32 s37, 0x10000
    s_branch L2_xp54
L2_c55:
    s_lshl_b64 s[52:53], s[82:83], 1
    s_andn2_b64 s[52:53], s[52:53], s[80:81]
    s_andn2_b64 s[52:53], s[52:53], s[54:55]
    s_or_b64 s[80:81], s[80:81], s[52:53]
    s_not_b64 vcc, s[52:53]
    s_mov_b64 exec, -1
    v_cndmask_b32_dpp v84, v84, v84, vcc wave_shr:1 row_mask:0xf bank_mask:0xf
    v_cndmask_b32_dpp v85, v85, v85, vcc wave_shr:1 row_mask:0xf bank_mask:0xf
    s_lshr_b64 s[52:53], s[52:53], 1
    v_cndmask_b32_dpp v86, v86, v86, vcc wave_shr:1 row_mask:0xf bank_mask:0xf
    v_cndmask_b32_dpp v87, v87, v87, vcc wave_shr:1 row_mask:0xf bank_mask:0xf
    s_andn2_b64 s[82:83], s[82:83], s[52:53]
    v_cndmask_b32_dpp v7, v7, v7, vcc wave_shr:1 row_mask:0xf bank_mask:0xf
    s_mov_b64 exec, s[54:55]
    s_cbranch_scc0 L2_d55
    s_mov_b64 exec, s[82:83]
    s_nop 1
    v_mfma_f32_4x4x4_16b_bf16 v[88:91], v[12:13], v[84:85], 0
    s_nop 1
    v_mfma_f32_4x4x4_16b_bf16 v[88:91], v[10:11], v[86:87], v[88:91]
    s_nop 4
    v_cvt_pk_bf16_f32 v88, v88, v89
    v_cvt_pk_bf16_f32 v89, v90, v91
    ds_pk_add_bf16 v7, v88 offset:65408
    ds_pk_add_bf16 v7, v89 offset:65412
    s_mov_b64 exec, s[54:55]
    s_branch L2_d55
L2_c56:
    s_lshl_b64 s[52:53], s[82:83], 1
    s_andn2_b64 s[52:53], s[52:53], s[80:81]
    s_andn2_b64 s[52:53], s[52:53], s[50:51]
    s_or_b64 s[80:81], s[80:81], s[52:53]
    s_not_b64 vcc, s[52:53]
    s_mov_b64 exec, -1
    v_cndmask_b32_dpp v84, v84, v84, vcc wave_shr:1 row_mask:0xf bank_mask:0xf
    v_cndmask_b32_dpp v85, v85, v85, vcc wave_shr:1 row_mask:0xf bank_mask:0xf
    s_lshr_b64 s[52:53], s[52:53], 1
    v_cndmask_b32_dpp v86, v86, v86, vcc wave_shr:1 row_mask:0xf bank_mask:0xf
    v_cndmask_b32_dpp v87, v87, v87, vcc wave_shr:1 row_mask:0xf bank_mask:0xf
    s_andn2_b64 s[82:83], s[82:83], s[52:53]
    v_cndmask_b32_dpp v7, v7, v7, vcc wave_shr:1 row_mask:0xf bank_mask:0xf
    s_mov_b64 exec, s[50:51]
    s_cbranch_scc0 L2_d56
    s_mov_b64 exec, s[82:83]
    s_nop 1
    v_mfma_f32_4x4x4_16b_bf16 v[88:91], v[12:13], v[84:85], 0
    s_nop 1
    v_mfma_f32_4x4x4_16b_bf16 v[88:91], v[10:11], v[86:87], v[88:91]
    s_nop 4
    v_cvt_pk_bf16_f32 v88, v88, v89
    v_cvt_pk_bf16_f32 v89, v90, v91
    ds_pk_add_bf16 v7, v88 offset:65408
    ds_pk_add_bf16 v7, v89 offset:65412
    s_mov_b64 exec, s[50:51]
    s_branch L2_d56
L2_c57:
    s_lshl_b64 s[52:53], s[82:83], 1
    s_andn2_b64 s[52:53], s[52:53], s[80:81]
    s_andn2_b64 s[52:53], s[52:53], s[54:55]
    s_or_b64 s[80:81], s[80:81], s[52:53]
    s_not_b64 vcc, s[52:53]
    s_mov_b64 exec, -1
    v_cndmask_b32_dpp v84, v84, v84, vcc wave_shr:1 row_mask:0xf bank_mask:0xf
    v_cndmask_b32_dpp v85, v85, v85, vcc wave_shr:1 row_mask:0xf bank_mask:0xf
    s_lshr_b64 s[52:53], s[52:53], 1
    v_cndmask_b32_dpp v86, v86, v86, vcc wave_shr:1 row_mask:0xf bank_mask:0xf
    v_cndmask_b32_dpp v87, v87, v87, vcc wave_shr:1 row_mask:0xf bank_mask:0xf
    s_andn2_b64 s[82:83], s[82:83], s[52:53]
    v_cndmask_b32_dpp v7, v7, v7, vcc wave_shr:1 row_mask:0xf bank_mask:0xf
    s_mov_b64 exec, s[54:55]
    s_cbranch_scc0 L2_d57
    s_mov_b64 exec, s[82:83]
    s_nop 1
    v_mfma_f32_4x4x4_16b_bf16 v[88:91], v[12:13], v[84:85], 0
    s_nop 1
    v_mfma_f32_4x4x4_16b_bf16 v[88:91], v[10:11], v[86:87], v[88:91]
    s_nop 4
    v_cvt_pk_bf16_f32 v88, v88, v89
    v_cvt_pk_bf16_f32 v89, v90, v91
    ds_pk_add_bf16 v7, v88 offset:65408
    ds_pk_add_bf16 v7, v89 offset:65412
    s_mov_b64 exec, s[54:55]
    s_branch L2_d57
L2_c58:
    s_lshl_b64 s[52:53], s[82:83], 1
    s_andn2_b64 s[52:53], s[52:53], s[80:81]
    s_andn2_b64 s[52:53], s[52:53], s[50:51]
    s_or_b64 s[80:81], s[80:81], s[52:53]
    s_not_b64 vcc, s[52:53]
    s_mov_b64 exec, -1
    v_cndmask_b32_dpp v84, v84, v84, vcc wave_shr:1 row_mask:0xf bank_mask:0xf
    v_cndmask_b32_dpp v85, v85, v85, vcc wave_shr:1 row_mask:0xf bank_mask:0xf
    s_lshr_b64 s[52:53], s[52:53], 1
    v_cndmask_b32_dpp v86, v86, v86, vcc wave_shr:1 row_mask:0xf bank_mask:0xf
    v_cndmask_b32_dpp v87, v87, v87, vcc wave_shr:1 row_mask:0xf bank_mask:0xf
    s_andn2_b64 s[82:83], s[82:83], s[52:53]
    v_cndmask_b32_dpp v7, v7, v7, vcc wave_shr:1 row_mask:0xf bank_mask:0xf
    s_mov_b64 exec, s[50:51]
    s_cbranch_scc0 L2_d58
    s_mov_b64 exec, s[82:83]
    s_nop 1
    v_mfma_f32_4x4x4_16b_bf16 v[88:91], v[12:13], v[84:85], 0
    s_nop 1
    v_mfma_f32_4x4x4_16b_bf16 v[88:91], v[10:11], v[86:87], v[88:91]
    s_nop 4
    v_cvt_pk_bf16_f32 v88, v88, v89
    v_cvt_pk_bf16_f32 v89, v90, v91
    ds_pk_add_bf16 v7, v88 offset:65408
    ds_pk_add_bf16 v7, v89 offset:65412
    s_mov_b64 exec, s[50:51]
    s_branch L2_d58
L2_c59:
    s_lshl_b64 s[52:53], s[82:83], 1
    s_andn2_b64 s[52:53], s[52:53], s[80:81]
    s_andn2_b64 s[52:53], s[52:53], s[54:55]
    s_or_b64 s[80:81], s[80:81], s[52:53]
    s_not_b64 vcc, s[52:53]
    s_mov_b64 exec, -1
    v_cndmask_b32_dpp v84, v84, v84, vcc wave_shr:1 row_mask:0xf bank_mask:0xf
    v_cndmask_b32_dpp v85, v85, v85, vcc wave_shr:1 row_mask:0xf bank_mask:0xf
    s_lshr_b64 s[52:53], s[52:53], 1
    v_cndmask_b32_dpp v86, v86, v86, vcc wave_shr:1 row_mask:0xf bank_mask:0xf
    v_cndmask_b32_dpp v87, v87, v87, vcc wave_shr:1 row_mask:0xf bank_mask:0xf
    s_andn2_b64 s[82:83], s[82:83], s[52:53]
    v_cndmask_b32_dpp v7, v7, v7, vcc wave_shr:1 row_mask:0xf bank_mask:0xf
    s_mov_b64 exec, s[54:55]
    s_cbranch_scc0 L2_d59
    s_mov_b64 exec, s[82:83]
    s_nop 1
    v_mfma_f32_4x4x4_16b_bf16 v[88:91], v[12:13], v[84:85], 0
    s_nop 1
    v_mfma_f32_4x4x4_16b_bf16 v[88:91], v[10:11], v[86:87], v[88:91]
    s_nop 4
    v_cvt_pk_bf16_f32 v88, v88, v89
    v_cvt_pk_bf16_f32 v89, v90, v91
    ds_pk_add_bf16 v7, v88 offset:65408
    ds_pk_add_bf16 v7, v89 offset:65412
    s_mov_b64 exec, s[54:55]
    s_branch L2_d59
L2_c60:
    s_lshl_b64 s[52:53], s[82:83], 1
    s_andn2_b64 s[52:53], s[52:53], s[80:81]
    s_andn2_b64 s[52:53], s[52:53], s[50:51]
    s_or_b64 s[80:81], s[80:81], s[52:53]
    s_not_b64 vcc, s[52:53]
    s_mov_b64 exec, -1
    v_cndmask_b32_dpp v84, v84, v84, vcc wave_shr:1 row_mask:0xf bank_mask:0xf
    v_cndmask_b32_dpp v85, v85, v85, vcc wave_shr:1 row_mask:0xf bank_mask:0xf
    s_lshr_b64 s[52:53], s[52:53], 1
    v_cndmask_b32_dpp v86, v86, v86, vcc wave_shr:1 row_mask:0xf bank_mask:0xf
    v_cndmask_b32_dpp v87, v87, v87, vcc wave_shr:1 row_mask:0xf bank_mask:0xf
    s_andn2_b64 s[82:83], s[82:83], s[52:53]
    v_cndmask_b32_dpp v7, v7, v7, vcc wave_shr:1 row_mask:0xf bank_mask:0xf
    s_mov_b64 exec, s[50:51]
    s_cbranch_scc0 L2_d60
    s_mov_b64 exec, s[82:83]
    s_nop 1
    v_mfma_f32_4x4x4_16b_bf16 v[88:91], v[12:13], v[84:85], 0
    s_nop 1
    v_mfma_f32_4x4x4_16b_bf16 v[88:91], v[10:11], v[86:87], v[88:91]
    s_nop 4
    v_cvt_pk_bf16_f32 v88, v88, v89
    v_cvt_pk_bf16_f32 v89, v90, v91
    ds_pk_add_bf16 v7, v88 offset:65408
    ds_pk_add_bf16 v7, v89 offset:65412
    s_mov_b64 exec, s[50:51]
    s_branch L2_d60
L2_xa61:
    s_cmp_eq_u32 s101, 1
    s_cbranch_scc1 L2_xc61
    v_lshlrev_b32 v89, 0, v96
    v_add_u32 v90, 140, v97
    v_bitop3_b32 v90, v89, v45, v90 bitop3:0x6a
    ds_write_b32 v98, v90 offset:28
    v_lshlrev_b32 v89, 4, v96
    v_add_u32 v90, 120, v97
    v_bitop3_b32 v90, v89, v45, v90 bitop3:0x6a
    ds_write_b32 v98, v90 offset:24
    v_lshlrev_b32 v89, 8, v96
    v_add_u32 v90, 100, v97
    v_bitop3_b32 v90, v89, v45, v90 bitop3:0x6a
    ds_write_b32 v98, v90 offset:20
L2_xc61:
    v_lshlrev_b32 v89, 12, v96
    v_add_u32 v90, 80, v97
    v_bitop3_b32 v90, v89, v45, v90 bitop3:0x6a
    ds_write_b32 v98, v90 offset:16
    s_branch L2_xb61
L2_xe61:
    v_cmp_lt_u32 vcc, 32, v99
    v_cmp_lt_u32 s[58:59], 31, v88
    v_lshrrev_b32 v89, 16, v96
    v_add_u32 v97, 80, v97
    s_or_b64 vcc, vcc, s[58:59]
    s_cbranch_scc1 L2_xs61
    v_lshlrev_b32 v89, v1, v89
    v_and_b32 v89, v45, v89
    v_cmp_ne_u32 vcc, 0, v89
    v_xor_b32 v90, v97, v89
    s_add_u32 s3, s37, s38
    v_mbcnt_lo_u32_b32 v98, vcc_lo, 0
    v_mbcnt_hi_u32_b32 v98, vcc_hi, v98
    s_bcnt1_i32_b64 s41, vcc
    v_lshl_add_u32 v98, v98, 2, s3
    s_lshl2_add_u32 s37, s41, s37
    s_mov_b64 exec, vcc
    ds_write_b32 v98, v90
    s_mov_b64 exec, -1
    s_branch L2_xr61
L2_xs61:
    s_waitcnt lgkmcnt(0)
    s_mov_b32 s37, 0x10000
    s_branch L2_xw61
L2_c62:
    s_lshl_b64 s[52:53], s[82:83], 1
    s_andn2_b64 s[52:53], s[52:53], s[80:81]
    s_andn2_b64 s[52:53], s[52:53], s[54:55]
    s_or_b64 s[80:81], s[80:81], s[52:53]
    s_not_b64 vcc, s[52:53]
    s_mov_b64 exec, -1
    v_cndmask_b32_dpp v84, v84, v84, vcc wave_shr:1 row_mask:0xf bank_mask:0xf
    v_cndmask_b32_dpp v85, v85, v85, vcc wave_shr:1 row_mask:0xf bank_mask:0xf
    s_lshr_b64 s[52:53], s[52:53], 1
    v_cndmask_b32_dpp v86, v86, v86, vcc wave_shr:1 row_mask:0xf bank_mask:0xf
    v_cndmask_b32_dpp v87, v87, v87, vcc wave_shr:1 row_mask:0xf bank_mask:0xf
    s_andn2_b64 s[82:83], s[82:83], s[52:53]
    v_cndmask_b32_dpp v7, v7, v7, vcc wave_shr:1 row_mask:0xf bank_mask:0xf
    s_mov_b64 exec, s[54:55]
    s_cbranch_scc0 L2_d62
    s_mov_b64 exec, s[82:83]
    s_nop 1
    v_mfma_f32_4x4x4_16b_bf16 v[88:91], v[12:13], v[84:85], 0
    s_nop 1
    v_mfma_f32_4x4x4_16b_bf16 v[88:91], v[10:11], v[86:87], v[88:91]
    s_nop 4
    v_cvt_pk_bf16_f32 v88, v88, v89
    v_cvt_pk_bf16_f32 v89, v90, v91
    ds_pk_add_bf16 v7, v88 offset:65408
    ds_pk_add_bf16 v7, v89 offset:65412
    s_mov_b64 exec, s[54:55]
    s_branch L2_d62
L2_c63:
    s_lshl_b64 s[52:53], s[82:83], 1
    s_andn2_b64 s[52:53], s[52:53], s[80:81]
    s_andn2_b64 s[52:53], s[52:53], s[50:51]
    s_or_b64 s[80:81], s[80:81], s[52:53]
    s_not_b64 vcc, s[52:53]
    s_mov_b64 exec, -1
    v_cndmask_b32_dpp v84, v84, v84, vcc wave_shr:1 row_mask:0xf bank_mask:0xf
    v_cndmask_b32_dpp v85, v85, v85, vcc wave_shr:1 row_mask:0xf bank_mask:0xf
    s_lshr_b64 s[52:53], s[52:53], 1
    v_cndmask_b32_dpp v86, v86, v86, vcc wave_shr:1 row_mask:0xf bank_mask:0xf
    v_cndmask_b32_dpp v87, v87, v87, vcc wave_shr:1 row_mask:0xf bank_mask:0xf
    s_andn2_b64 s[82:83], s[82:83], s[52:53]
    v_cndmask_b32_dpp v7, v7, v7, vcc wave_shr:1 row_mask:0xf bank_mask:0xf
    s_mov_b64 exec, s[50:51]
    s_cbranch_scc0 L2_d63
    s_mov_b64 exec, s[82:83]
    s_nop 1
    v_mfma_f32_4x4x4_16b_bf16 v[88:91], v[12:13], v[84:85], 0
    s_nop 1
    v_mfma_f32_4x4x4_16b_bf16 v[88:91], v[10:11], v[86:87], v[88:91]
    s_nop 4
    v_cvt_pk_bf16_f32 v88, v88, v89
    v_cvt_pk_bf16_f32 v89, v90, v91
    ds_pk_add_bf16 v7, v88 offset:65408
    ds_pk_add_bf16 v7, v89 offset:65412
    s_mov_b64 exec, s[50:51]
    s_branch L2_d63
L2_xf61:
    s_cmp_gt_u32 s37, 1024
    s_cbranch_scc1 L2_xt61
    s_cmp_lt_u32 s37, 768
    s_cbranch_scc1 L2_xl61
    ds_read_b32 v32, v44 offset:896
    s_add_u32 s3, s42, 2
    s_bitset1_b32 s43, s3
    s_branch L2_xg61
L2_xl61:
    s_waitcnt lgkmcnt(0)
    v_mov_b32 v31, -1
    s_cmp_ge_u32 s37, 512
    s_cbranch_scc1 L2_xg61
    v_mov_b32 v39, -1
    s_cmp_ge_u32 s37, 256
    s_cbranch_scc1 L2_xg61
    v_mov_b32 v27, -1
    s_branch L2_xg61
L2_xt61:
    s_waitcnt lgkmcnt(0)
    v_mov_b32 v21, -1
    v_mov_b32 v27, -1
    v_mov_b32 v39, -1
    v_mov_b32 v31, -1
    s_add_u32 s3, s42, 2
    s_bitset1_b32 s36, s3
    s_branch L2_xg61
L2_oa64:
    v_and_b32 v47, 0x0fffffff, v33
    buffer_load_dword v114, v47, s[8:11], 0 offen offset:16
    s_mov_b64 exec, s[6:7]
    v_add_u32 v47, 8, v47
    v_lshrrev_b32 v33, 2, v33
    s_mov_b64 exec, -1
    buffer_load_dwordx2 v[112:113], v47, s[8:11], 0 offen
    s_branch L2_ob64
L2_c65:
    s_lshl_b64 s[52:53], s[82:83], 1
    s_andn2_b64 s[52:53], s[52:53], s[80:81]
    s_andn2_b64 s[52:53], s[52:53], s[54:55]
    s_or_b64 s[80:81], s[80:81], s[52:53]
    s_not_b64 vcc, s[52:53]
    s_mov_b64 exec, -1
    v_cndmask_b32_dpp v84, v84, v84, vcc wave_shr:1 row_mask:0xf bank_mask:0xf
    v_cndmask_b32_dpp v85, v85, v85, vcc wave_shr:1 row_mask:0xf bank_mask:0xf
    s_lshr_b64 s[52:53], s[52:53], 1
    v_cndmask_b32_dpp v86, v86, v86, vcc wave_shr:1 row_mask:0xf bank_mask:0xf
    v_cndmask_b32_dpp v87, v87, v87, vcc wave_shr:1 row_mask:0xf bank_mask:0xf
    s_andn2_b64 s[82:83], s[82:83], s[52:53]
    v_cndmask_b32_dpp v7, v7, v7, vcc wave_shr:1 row_mask:0xf bank_mask:0xf
    s_mov_b64 exec, s[54:55]
    s_cbranch_scc0 L2_d65
    s_mov_b64 exec, s[82:83]
    s_nop 1
    v_mfma_f32_4x4x4_16b_bf16 v[88:91], v[12:13], v[84:85], 0
    s_nop 1
    v_mfma_f32_4x4x4_16b_bf16 v[88:91], v[10:11], v[86:87], v[88:91]
    s_nop 4
    v_cvt_pk_bf16_f32 v88, v88, v89
    v_cvt_pk_bf16_f32 v89, v90, v91
    ds_pk_add_bf16 v7, v88 offset:65408
    ds_pk_add_bf16 v7, v89 offset:65412
    s_mov_b64 exec, s[54:55]
    s_branch L2_d65
L2_c66:
    s_lshl_b64 s[52:53], s[82:83], 1
    s_andn2_b64 s[52:53], s[52:53], s[80:81]
    s_andn2_b64 s[52:53], s[52:53], s[50:51]
    s_or_b64 s[80:81], s[80:81], s[52:53]
    s_not_b64 vcc, s[52:53]
    s_mov_b64 exec, -1
    v_cndmask_b32_dpp v84, v84, v84, vcc wave_shr:1 row_mask:0xf bank_mask:0xf
    v_cndmask_b32_dpp v85, v85, v85, vcc wave_shr:1 row_mask:0xf bank_mask:0xf
    s_lshr_b64 s[52:53], s[52:53], 1
    v_cndmask_b32_dpp v86, v86, v86, vcc wave_shr:1 row_mask:0xf bank_mask:0xf
    v_cndmask_b32_dpp v87, v87, v87, vcc wave_shr:1 row_mask:0xf bank_mask:0xf
    s_andn2_b64 s[82:83], s[82:83], s[52:53]
    v_cndmask_b32_dpp v7, v7, v7, vcc wave_shr:1 row_mask:0xf bank_mask:0xf
    s_mov_b64 exec, s[50:51]
    s_cbranch_scc0 L2_d66
    s_mov_b64 exec, s[82:83]
    s_nop 1
    v_mfma_f32_4x4x4_16b_bf16 v[88:91], v[12:13], v[84:85], 0
    s_nop 1
    v_mfma_f32_4x4x4_16b_bf16 v[88:91], v[10:11], v[86:87], v[88:91]
    s_nop 4
    v_cvt_pk_bf16_f32 v88, v88, v89
    v_cvt_pk_bf16_f32 v89, v90, v91
    ds_pk_add_bf16 v7, v88 offset:65408
    ds_pk_add_bf16 v7, v89 offset:65412
    s_mov_b64 exec, s[50:51]
    s_branch L2_d66
L2_c67:
    s_lshl_b64 s[52:53], s[82:83], 1
    s_andn2_b64 s[52:53], s[52:53], s[80:81]
    s_andn2_b64 s[52:53], s[52:53], s[54:55]
    s_or_b64 s[80:81], s[80:81], s[52:53]
    s_not_b64 vcc, s[52:53]
    s_mov_b64 exec, -1
    v_cndmask_b32_dpp v84, v84, v84, vcc wave_shr:1 row_mask:0xf bank_mask:0xf
    v_cndmask_b32_dpp v85, v85, v85, vcc wave_shr:1 row_mask:0xf bank_mask:0xf
    s_lshr_b64 s[52:53], s[52:53], 1
    v_cndmask_b32_dpp v86, v86, v86, vcc wave_shr:1 row_mask:0xf bank_mask:0xf
    v_cndmask_b32_dpp v87, v87, v87, vcc wave_shr:1 row_mask:0xf bank_mask:0xf
    s_andn2_b64 s[82:83], s[82:83], s[52:53]
    v_cndmask_b32_dpp v7, v7, v7, vcc wave_shr:1 row_mask:0xf bank_mask:0xf
    s_mov_b64 exec, s[54:55]
    s_cbranch_scc0 L2_d67
    s_mov_b64 exec, s[82:83]
    s_nop 1
    v_mfma_f32_4x4x4_16b_bf16 v[88:91], v[12:13], v[84:85], 0
    s_nop 1
    v_mfma_f32_4x4x4_16b_bf16 v[88:91], v[10:11], v[86:87], v[88:91]
    s_nop 4
    v_cvt_pk_bf16_f32 v88, v88, v89
    v_cvt_pk_bf16_f32 v89, v90, v91
    ds_pk_add_bf16 v7, v88 offset:65408
    ds_pk_add_bf16 v7, v89 offset:65412
    s_mov_b64 exec, s[54:55]
    s_branch L2_d67
L2_c68:
    s_lshl_b64 s[52:53], s[82:83], 1
    s_andn2_b64 s[52:53], s[52:53], s[80:81]
    s_andn2_b64 s[52:53], s[52:53], s[50:51]
    s_or_b64 s[80:81], s[80:81], s[52:53]
    s_not_b64 vcc, s[52:53]
    s_mov_b64 exec, -1
    v_cndmask_b32_dpp v84, v84, v84, vcc wave_shr:1 row_mask:0xf bank_mask:0xf
    v_cndmask_b32_dpp v85, v85, v85, vcc wave_shr:1 row_mask:0xf bank_mask:0xf
    s_lshr_b64 s[52:53], s[52:53], 1
    v_cndmask_b32_dpp v86, v86, v86, vcc wave_shr:1 row_mask:0xf bank_mask:0xf
    v_cndmask_b32_dpp v87, v87, v87, vcc wave_shr:1 row_mask:0xf bank_mask:0xf
    s_andn2_b64 s[82:83], s[82:83], s[52:53]
    v_cndmask_b32_dpp v7, v7, v7, vcc wave_shr:1 row_mask:0xf bank_mask:0xf
    s_mov_b64 exec, s[50:51]
    s_cbranch_scc0 L2_d68
    s_mov_b64 exec, s[82:83]
    s_nop 1
    v_mfma_f32_4x4x4_16b_bf16 v[88:91], v[12:13], v[84:85], 0
    s_nop 1
    v_mfma_f32_4x4x4_16b_bf16 v[88:91], v[10:11], v[86:87], v[88:91]
    s_nop 4
    v_cvt_pk_bf16_f32 v88, v88, v89
    v_cvt_pk_bf16_f32 v89, v90, v91
    ds_pk_add_bf16 v7, v88 offset:65408
    ds_pk_add_bf16 v7, v89 offset:65412
    s_mov_b64 exec, s[50:51]
    s_branch L2_d68
L2_c69:
    s_lshl_b64 s[52:53], s[82:83], 1
    s_andn2_b64 s[52:53], s[52:53], s[80:81]
    s_andn2_b64 s[52:53], s[52:53], s[54:55]
    s_or_b64 s[80:81], s[80:81], s[52:53]
    s_not_b64 vcc, s[52:53]
    s_mov_b64 exec, -1
    v_cndmask_b32_dpp v84, v84, v84, vcc wave_shr:1 row_mask:0xf bank_mask:0xf
    v_cndmask_b32_dpp v85, v85, v85, vcc wave_shr:1 row_mask:0xf bank_mask:0xf
    s_lshr_b64 s[52:53], s[52:53], 1
    v_cndmask_b32_dpp v86, v86, v86, vcc wave_shr:1 row_mask:0xf bank_mask:0xf
    v_cndmask_b32_dpp v87, v87, v87, vcc wave_shr:1 row_mask:0xf bank_mask:0xf
    s_andn2_b64 s[82:83], s[82:83], s[52:53]
    v_cndmask_b32_dpp v7, v7, v7, vcc wave_shr:1 row_mask:0xf bank_mask:0xf
    s_mov_b64 exec, s[54:55]
    s_cbranch_scc0 L2_d69
    s_mov_b64 exec, s[82:83]
    s_nop 1
    v_mfma_f32_4x4x4_16b_bf16 v[88:91], v[12:13], v[84:85], 0
    s_nop 1
    v_mfma_f32_4x4x4_16b_bf16 v[88:91], v[10:11], v[86:87], v[88:91]
    s_nop 4
    v_cvt_pk_bf16_f32 v88, v88, v89
    v_cvt_pk_bf16_f32 v89, v90, v91
    ds_pk_add_bf16 v7, v88 offset:65408
    ds_pk_add_bf16 v7, v89 offset:65412
    s_mov_b64 exec, s[54:55]
    s_branch L2_d69
L2_c70:
    s_lshl_b64 s[52:53], s[82:83], 1
    s_andn2_b64 s[52:53], s[52:53], s[80:81]
    s_andn2_b64 s[52:53], s[52:53], s[50:51]
    s_or_b64 s[80:81], s[80:81], s[52:53]
    s_not_b64 vcc, s[52:53]
    s_mov_b64 exec, -1
    v_cndmask_b32_dpp v84, v84, v84, vcc wave_shr:1 row_mask:0xf bank_mask:0xf
    v_cndmask_b32_dpp v85, v85, v85, vcc wave_shr:1 row_mask:0xf bank_mask:0xf
    s_lshr_b64 s[52:53], s[52:53], 1
    v_cndmask_b32_dpp v86, v86, v86, vcc wave_shr:1 row_mask:0xf bank_mask:0xf
    v_cndmask_b32_dpp v87, v87, v87, vcc wave_shr:1 row_mask:0xf bank_mask:0xf
    s_andn2_b64 s[82:83], s[82:83], s[52:53]
    v_cndmask_b32_dpp v7, v7, v7, vcc wave_shr:1 row_mask:0xf bank_mask:0xf
    s_mov_b64 exec, s[50:51]
    s_cbranch_scc0 L2_d70
    s_mov_b64 exec, s[82:83]
    s_nop 1
    v_mfma_f32_4x4x4_16b_bf16 v[88:91], v[12:13], v[84:85], 0
    s_nop 1
    v_mfma_f32_4x4x4_16b_bf16 v[88:91], v[10:11], v[86:87], v[88:91]
    s_nop 4
    v_cvt_pk_bf16_f32 v88, v88, v89
    v_cvt_pk_bf16_f32 v89, v90, v91
    ds_pk_add_bf16 v7, v88 offset:65408
    ds_pk_add_bf16 v7, v89 offset:65412
    s_mov_b64 exec, s[50:51]
    s_branch L2_d70
L2_oa71:
    s_waitcnt vmcnt(3)
    s_mov_b64 exec, s[6:7]
    v_lshrrev_b32 v114, 16, v114
    s_mov_b64 exec, -1
    v_and_b32 v46, 0x10000000, v33
    v_cmpx_eq_u32 vcc, 0, v46
    v_lshrrev_b32 v47, 14, v112
    v_and_b32 v47, v5, v47
    ds_read_b64 v[96:97], v47
    v_perm_b32 v98, v112, v114, s44
    v_bitop3_b32 v99, v112, 0.5, -0.5 bitop3:0xa8
    v_bitop3_b32 v98, v6, v98, v99 bitop3:0xca
    v_and_b32 v47, v5, v112
    s_waitcnt lgkmcnt(0)
    v_mfma_f32_4x4x4_16b_bf16 v[88:91], v[8:9], v[96:97], 0
    s_nop 4
    v_mul_f32 v88, v98, v88
    v_mul_f32 v89, v98, v89
    v_mul_f32 v90, v98, v90
    v_mul_f32 v91, v98, v91
    v_cvt_pk_bf16_f32 v88, v88, v89
    v_cvt_pk_bf16_f32 v89, v90, v91
    ds_pk_add_bf16 v47, v88 offset:65408
    ds_pk_add_bf16 v47, v89 offset:65412
    s_mov_b64 exec, -1
    v_and_b32 v46, 0x20000000, v33
    v_cmpx_eq_u32 vcc, 0, v46
    v_lshrrev_b32 v47, 14, v113
    v_and_b32 v47, v5, v47
    ds_read_b64 v[96:97], v47
    v_perm_b32 v98, v113, v114, s45
    v_bitop3_b32 v99, v113, 0.5, -0.5 bitop3:0xa8
    v_bitop3_b32 v98, v6, v98, v99 bitop3:0xca
    v_and_b32 v47, v5, v113
    s_waitcnt lgkmcnt(0)
    v_mfma_f32_4x4x4_16b_bf16 v[88:91], v[8:9], v[96:97], 0
    s_nop 4
    v_mul_f32 v88, v98, v88
    v_mul_f32 v89, v98, v89
    v_mul_f32 v90, v98, v90
    v_mul_f32 v91, v98, v91
    v_cvt_pk_bf16_f32 v88, v88, v89
    v_cvt_pk_bf16_f32 v89, v90, v91
    ds_pk_add_bf16 v47, v88 offset:65408
    ds_pk_add_bf16 v47, v89 offset:65412
    s_mov_b64 exec, -1
    s_branch L2_ob71
L2_xo72:
    v_cmp_lt_u32 vcc, 20, v99
    s_mov_b32 s101, 1
    s_cbranch_vccz L2_xp72
    v_cmp_lt_u32 vcc, 32, v99
    v_cmp_lt_u32 s[58:59], 31, v88
    s_mov_b32 s101, 2
    s_or_b64 vcc, vcc, s[58:59]
    s_cbranch_scc0 L2_xp72
    s_mov_b32 s37, 0x10000
    s_branch L2_xp72
L2_c73:
    s_lshl_b64 s[52:53], s[82:83], 1
    s_andn2_b64 s[52:53], s[52:53], s[80:81]
    s_andn2_b64 s[52:53], s[52:53], s[54:55]
    s_or_b64 s[80:81], s[80:81], s[52:53]
    s_not_b64 vcc, s[52:53]
    s_mov_b64 exec, -1
    v_cndmask_b32_dpp v84, v84, v84, vcc wave_shr:1 row_mask:0xf bank_mask:0xf
    v_cndmask_b32_dpp v85, v85, v85, vcc wave_shr:1 row_mask:0xf bank_mask:0xf
    s_lshr_b64 s[52:53], s[52:53], 1
    v_cndmask_b32_dpp v86, v86, v86, vcc wave_shr:1 row_mask:0xf bank_mask:0xf
    v_cndmask_b32_dpp v87, v87, v87, vcc wave_shr:1 row_mask:0xf bank_mask:0xf
    s_andn2_b64 s[82:83], s[82:83], s[52:53]
    v_cndmask_b32_dpp v7, v7, v7, vcc wave_shr:1 row_mask:0xf bank_mask:0xf
    s_mov_b64 exec, s[54:55]
    s_cbranch_scc0 L2_d73
    s_mov_b64 exec, s[82:83]
    s_nop 1
    v_mfma_f32_4x4x4_16b_bf16 v[88:91], v[12:13], v[84:85], 0
    s_nop 1
    v_mfma_f32_4x4x4_16b_bf16 v[88:91], v[10:11], v[86:87], v[88:91]
    s_nop 4
    v_cvt_pk_bf16_f32 v88, v88, v89
    v_cvt_pk_bf16_f32 v89, v90, v91
    ds_pk_add_bf16 v7, v88 offset:65408
    ds_pk_add_bf16 v7, v89 offset:65412
    s_mov_b64 exec, s[54:55]
    s_branch L2_d73
L2_c74:
    s_lshl_b64 s[52:53], s[82:83], 1
    s_andn2_b64 s[52:53], s[52:53], s[80:81]
    s_andn2_b64 s[52:53], s[52:53], s[50:51]
    s_or_b64 s[80:81], s[80:81], s[52:53]
    s_not_b64 vcc, s[52:53]
    s_mov_b64 exec, -1
    v_cndmask_b32_dpp v84, v84, v84, vcc wave_shr:1 row_mask:0xf bank_mask:0xf
    v_cndmask_b32_dpp v85, v85, v85, vcc wave_shr:1 row_mask:0xf bank_mask:0xf
    s_lshr_b64 s[52:53], s[52:53], 1
    v_cndmask_b32_dpp v86, v86, v86, vcc wave_shr:1 row_mask:0xf bank_mask:0xf
    v_cndmask_b32_dpp v87, v87, v87, vcc wave_shr:1 row_mask:0xf bank_mask:0xf
    s_andn2_b64 s[82:83], s[82:83], s[52:53]
    v_cndmask_b32_dpp v7, v7, v7, vcc wave_shr:1 row_mask:0xf bank_mask:0xf
    s_mov_b64 exec, s[50:51]
    s_cbranch_scc0 L2_d74
    s_mov_b64 exec, s[82:83]
    s_nop 1
    v_mfma_f32_4x4x4_16b_bf16 v[88:91], v[12:13], v[84:85], 0
    s_nop 1
    v_mfma_f32_4x4x4_16b_bf16 v[88:91], v[10:11], v[86:87], v[88:91]
    s_nop 4
    v_cvt_pk_bf16_f32 v88, v88, v89
    v_cvt_pk_bf16_f32 v89, v90, v91
    ds_pk_add_bf16 v7, v88 offset:65408
    ds_pk_add_bf16 v7, v89 offset:65412
    s_mov_b64 exec, s[50:51]
    s_branch L2_d74
L2_c75:
    s_lshl_b64 s[52:53], s[82:83], 1
    s_andn2_b64 s[52:53], s[52:53], s[80:81]
    s_andn2_b64 s[52:53], s[52:53], s[54:55]
    s_or_b64 s[80:81], s[80:81], s[52:53]
    s_not_b64 vcc, s[52:53]
    s_mov_b64 exec, -1
    v_cndmask_b32_dpp v84, v84, v84, vcc wave_shr:1 row_mask:0xf bank_mask:0xf
    v_cndmask_b32_dpp v85, v85, v85, vcc wave_shr:1 row_mask:0xf bank_mask:0xf
    s_lshr_b64 s[52:53], s[52:53], 1
    v_cndmask_b32_dpp v86, v86, v86, vcc wave_shr:1 row_mask:0xf bank_mask:0xf
    v_cndmask_b32_dpp v87, v87, v87, vcc wave_shr:1 row_mask:0xf bank_mask:0xf
    s_andn2_b64 s[82:83], s[82:83], s[52:53]
    v_cndmask_b32_dpp v7, v7, v7, vcc wave_shr:1 row_mask:0xf bank_mask:0xf
    s_mov_b64 exec, s[54:55]
    s_cbranch_scc0 L2_d75
    s_mov_b64 exec, s[82:83]
    s_nop 1
    v_mfma_f32_4x4x4_16b_bf16 v[88:91], v[12:13], v[84:85], 0
    s_nop 1
    v_mfma_f32_4x4x4_16b_bf16 v[88:91], v[10:11], v[86:87], v[88:91]
    s_nop 4
    v_cvt_pk_bf16_f32 v88, v88, v89
    v_cvt_pk_bf16_f32 v89, v90, v91
    ds_pk_add_bf16 v7, v88 offset:65408
    ds_pk_add_bf16 v7, v89 offset:65412
    s_mov_b64 exec, s[54:55]
    s_branch L2_d75
L2_c76:
    s_lshl_b64 s[52:53], s[82:83], 1
    s_andn2_b64 s[52:53], s[52:53], s[80:81]
    s_andn2_b64 s[52:53], s[52:53], s[50:51]
    s_or_b64 s[80:81], s[80:81], s[52:53]
    s_not_b64 vcc, s[52:53]
    s_mov_b64 exec, -1
    v_cndmask_b32_dpp v84, v84, v84, vcc wave_shr:1 row_mask:0xf bank_mask:0xf
    v_cndmask_b32_dpp v85, v85, v85, vcc wave_shr:1 row_mask:0xf bank_mask:0xf
    s_lshr_b64 s[52:53], s[52:53], 1
    v_cndmask_b32_dpp v86, v86, v86, vcc wave_shr:1 row_mask:0xf bank_mask:0xf
    v_cndmask_b32_dpp v87, v87, v87, vcc wave_shr:1 row_mask:0xf bank_mask:0xf
    s_andn2_b64 s[82:83], s[82:83], s[52:53]
    v_cndmask_b32_dpp v7, v7, v7, vcc wave_shr:1 row_mask:0xf bank_mask:0xf
    s_mov_b64 exec, s[50:51]
    s_cbranch_scc0 L2_d76
    s_mov_b64 exec, s[82:83]
    s_nop 1
    v_mfma_f32_4x4x4_16b_bf16 v[88:91], v[12:13], v[84:85], 0
    s_nop 1
    v_mfma_f32_4x4x4_16b_bf16 v[88:91], v[10:11], v[86:87], v[88:91]
    s_nop 4
    v_cvt_pk_bf16_f32 v88, v88, v89
    v_cvt_pk_bf16_f32 v89, v90, v91
    ds_pk_add_bf16 v7, v88 offset:65408
    ds_pk_add_bf16 v7, v89 offset:65412
    s_mov_b64 exec, s[50:51]
    s_branch L2_d76
L2_c77:
    s_lshl_b64 s[52:53], s[82:83], 1
    s_andn2_b64 s[52:53], s[52:53], s[80:81]
    s_andn2_b64 s[52:53], s[52:53], s[54:55]
    s_or_b64 s[80:81], s[80:81], s[52:53]
    s_not_b64 vcc, s[52:53]
    s_mov_b64 exec, -1
    v_cndmask_b32_dpp v84, v84, v84, vcc wave_shr:1 row_mask:0xf bank_mask:0xf
    v_cndmask_b32_dpp v85, v85, v85, vcc wave_shr:1 row_mask:0xf bank_mask:0xf
    s_lshr_b64 s[52:53], s[52:53], 1
    v_cndmask_b32_dpp v86, v86, v86, vcc wave_shr:1 row_mask:0xf bank_mask:0xf
    v_cndmask_b32_dpp v87, v87, v87, vcc wave_shr:1 row_mask:0xf bank_mask:0xf
    s_andn2_b64 s[82:83], s[82:83], s[52:53]
    v_cndmask_b32_dpp v7, v7, v7, vcc wave_shr:1 row_mask:0xf bank_mask:0xf
    s_mov_b64 exec, s[54:55]
    s_cbranch_scc0 L2_d77
    s_mov_b64 exec, s[82:83]
    s_nop 1
    v_mfma_f32_4x4x4_16b_bf16 v[88:91], v[12:13], v[84:85], 0
    s_nop 1
    v_mfma_f32_4x4x4_16b_bf16 v[88:91], v[10:11], v[86:87], v[88:91]
    s_nop 4
    v_cvt_pk_bf16_f32 v88, v88, v89
    v_cvt_pk_bf16_f32 v89, v90, v91
    ds_pk_add_bf16 v7, v88 offset:65408
    ds_pk_add_bf16 v7, v89 offset:65412
    s_mov_b64 exec, s[54:55]
    s_branch L2_d77
L2_c78:
    s_lshl_b64 s[52:53], s[82:83], 1
    s_andn2_b64 s[52:53], s[52:53], s[80:81]
    s_andn2_b64 s[52:53], s[52:53], s[50:51]
    s_or_b64 s[80:81], s[80:81], s[52:53]
    s_not_b64 vcc, s[52:53]
    s_mov_b64 exec, -1
    v_cndmask_b32_dpp v84, v84, v84, vcc wave_shr:1 row_mask:0xf bank_mask:0xf
    v_cndmask_b32_dpp v85, v85, v85, vcc wave_shr:1 row_mask:0xf bank_mask:0xf
    s_lshr_b64 s[52:53], s[52:53], 1
    v_cndmask_b32_dpp v86, v86, v86, vcc wave_shr:1 row_mask:0xf bank_mask:0xf
    v_cndmask_b32_dpp v87, v87, v87, vcc wave_shr:1 row_mask:0xf bank_mask:0xf
    s_andn2_b64 s[82:83], s[82:83], s[52:53]
    v_cndmask_b32_dpp v7, v7, v7, vcc wave_shr:1 row_mask:0xf bank_mask:0xf
    s_mov_b64 exec, s[50:51]
    s_cbranch_scc0 L2_d78
    s_mov_b64 exec, s[82:83]
    s_nop 1
    v_mfma_f32_4x4x4_16b_bf16 v[88:91], v[12:13], v[84:85], 0
    s_nop 1
    v_mfma_f32_4x4x4_16b_bf16 v[88:91], v[10:11], v[86:87], v[88:91]
    s_nop 4
    v_cvt_pk_bf16_f32 v88, v88, v89
    v_cvt_pk_bf16_f32 v89, v90, v91
    ds_pk_add_bf16 v7, v88 offset:65408
    ds_pk_add_bf16 v7, v89 offset:65412
    s_mov_b64 exec, s[50:51]
    s_branch L2_d78
L2_xa79:
    s_cmp_eq_u32 s101, 1
    s_cbranch_scc1 L2_xc79
    v_lshlrev_b32 v89, 0, v96
    v_add_u32 v90, 140, v97
    v_bitop3_b32 v90, v89, v45, v90 bitop3:0x6a
    ds_write_b32 v98, v90 offset:28
    v_lshlrev_b32 v89, 4, v96
    v_add_u32 v90, 120, v97
    v_bitop3_b32 v90, v89, v45, v90 bitop3:0x6a
    ds_write_b32 v98, v90 offset:24
    v_lshlrev_b32 v89, 8, v96
    v_add_u32 v90, 100, v97
    v_bitop3_b32 v90, v89, v45, v90 bitop3:0x6a
    ds_write_b32 v98, v90 offset:20
L2_xc79:
    v_lshlrev_b32 v89, 12, v96
    v_add_u32 v90, 80, v97
    v_bitop3_b32 v90, v89, v45, v90 bitop3:0x6a
    ds_write_b32 v98, v90 offset:16
    s_branch L2_xb79
L2_xe79:
    v_cmp_lt_u32 vcc, 32, v99
    v_cmp_lt_u32 s[58:59], 31, v88
    v_lshrrev_b32 v89, 16, v96
    v_add_u32 v97, 80, v97
    s_or_b64 vcc, vcc, s[58:59]
    s_cbranch_scc1 L2_xs79
    v_lshlrev_b32 v89, v1, v89
    v_and_b32 v89, v45, v89
    v_cmp_ne_u32 vcc, 0, v89
    v_xor_b32 v90, v97, v89
    s_add_u32 s3, s37, s38
    v_mbcnt_lo_u32_b32 v98, vcc_lo, 0
    v_mbcnt_hi_u32_b32 v98, vcc_hi, v98
    s_bcnt1_i32_b64 s41, vcc
    v_lshl_add_u32 v98, v98, 2, s3
    s_lshl2_add_u32 s37, s41, s37
    s_mov_b64 exec, vcc
    ds_write_b32 v98, v90
    s_mov_b64 exec, -1
    s_branch L2_xr79
L2_xs79:
    s_waitcnt lgkmcnt(0)
    s_mov_b32 s37, 0x10000
    s_branch L2_xw79
L2_c80:
    s_lshl_b64 s[52:53], s[82:83], 1
    s_andn2_b64 s[52:53], s[52:53], s[80:81]
    s_andn2_b64 s[52:53], s[52:53], s[54:55]
    s_or_b64 s[80:81], s[80:81], s[52:53]
    s_not_b64 vcc, s[52:53]
    s_mov_b64 exec, -1
    v_cndmask_b32_dpp v84, v84, v84, vcc wave_shr:1 row_mask:0xf bank_mask:0xf
    v_cndmask_b32_dpp v85, v85, v85, vcc wave_shr:1 row_mask:0xf bank_mask:0xf
    s_lshr_b64 s[52:53], s[52:53], 1
    v_cndmask_b32_dpp v86, v86, v86, vcc wave_shr:1 row_mask:0xf bank_mask:0xf
    v_cndmask_b32_dpp v87, v87, v87, vcc wave_shr:1 row_mask:0xf bank_mask:0xf
    s_andn2_b64 s[82:83], s[82:83], s[52:53]
    v_cndmask_b32_dpp v7, v7, v7, vcc wave_shr:1 row_mask:0xf bank_mask:0xf
    s_mov_b64 exec, s[54:55]
    s_cbranch_scc0 L2_d80
    s_mov_b64 exec, s[82:83]
    s_nop 1
    v_mfma_f32_4x4x4_16b_bf16 v[88:91], v[12:13], v[84:85], 0
    s_nop 1
    v_mfma_f32_4x4x4_16b_bf16 v[88:91], v[10:11], v[86:87], v[88:91]
    s_nop 4
    v_cvt_pk_bf16_f32 v88, v88, v89
    v_cvt_pk_bf16_f32 v89, v90, v91
    ds_pk_add_bf16 v7, v88 offset:65408
    ds_pk_add_bf16 v7, v89 offset:65412
    s_mov_b64 exec, s[54:55]
    s_branch L2_d80
L2_c81:
    s_lshl_b64 s[52:53], s[82:83], 1
    s_andn2_b64 s[52:53], s[52:53], s[80:81]
    s_andn2_b64 s[52:53], s[52:53], s[50:51]
    s_or_b64 s[80:81], s[80:81], s[52:53]
    s_not_b64 vcc, s[52:53]
    s_mov_b64 exec, -1
    v_cndmask_b32_dpp v84, v84, v84, vcc wave_shr:1 row_mask:0xf bank_mask:0xf
    v_cndmask_b32_dpp v85, v85, v85, vcc wave_shr:1 row_mask:0xf bank_mask:0xf
    s_lshr_b64 s[52:53], s[52:53], 1
    v_cndmask_b32_dpp v86, v86, v86, vcc wave_shr:1 row_mask:0xf bank_mask:0xf
    v_cndmask_b32_dpp v87, v87, v87, vcc wave_shr:1 row_mask:0xf bank_mask:0xf
    s_andn2_b64 s[82:83], s[82:83], s[52:53]
    v_cndmask_b32_dpp v7, v7, v7, vcc wave_shr:1 row_mask:0xf bank_mask:0xf
    s_mov_b64 exec, s[50:51]
    s_cbranch_scc0 L2_d81
    s_mov_b64 exec, s[82:83]
    s_nop 1
    v_mfma_f32_4x4x4_16b_bf16 v[88:91], v[12:13], v[84:85], 0
    s_nop 1
    v_mfma_f32_4x4x4_16b_bf16 v[88:91], v[10:11], v[86:87], v[88:91]
    s_nop 4
    v_cvt_pk_bf16_f32 v88, v88, v89
    v_cvt_pk_bf16_f32 v89, v90, v91
    ds_pk_add_bf16 v7, v88 offset:65408
    ds_pk_add_bf16 v7, v89 offset:65412
    s_mov_b64 exec, s[50:51]
    s_branch L2_d81
L2_xf79:
    s_cmp_gt_u32 s37, 1024
    s_cbranch_scc1 L2_xt79
    s_cmp_lt_u32 s37, 768
    s_cbranch_scc1 L2_xl79
    ds_read_b32 v33, v44 offset:896
    s_add_u32 s3, s42, 2
    s_bitset1_b32 s43, s3
    s_branch L2_xg79
L2_xl79:
    s_waitcnt lgkmcnt(0)
    v_mov_b32 v42, -1
    s_cmp_ge_u32 s37, 512
    s_cbranch_scc1 L2_xg79
    v_mov_b32 v43, -1
    s_cmp_ge_u32 s37, 256
    s_cbranch_scc1 L2_xg79
    v_mov_b32 v41, -1
    s_branch L2_xg79
L2_xt79:
    s_waitcnt lgkmcnt(0)
    v_mov_b32 v40, -1
    v_mov_b32 v41, -1
    v_mov_b32 v43, -1
    v_mov_b32 v42, -1
    s_add_u32 s3, s42, 2
    s_bitset1_b32 s36, s3
    s_branch L2_xg79
L2_oa82:
    v_and_b32 v47, 0x0fffffff, v32
    buffer_load_dword v114, v47, s[8:11], 0 offen offset:16
    s_mov_b64 exec, s[6:7]
    v_add_u32 v47, 8, v47
    v_lshrrev_b32 v32, 2, v32
    s_mov_b64 exec, -1
    buffer_load_dwordx2 v[112:113], v47, s[8:11], 0 offen
    s_branch L2_ob82
L2_c83:
    s_lshl_b64 s[52:53], s[82:83], 1
    s_andn2_b64 s[52:53], s[52:53], s[80:81]
    s_andn2_b64 s[52:53], s[52:53], s[54:55]
    s_or_b64 s[80:81], s[80:81], s[52:53]
    s_not_b64 vcc, s[52:53]
    s_mov_b64 exec, -1
    v_cndmask_b32_dpp v84, v84, v84, vcc wave_shr:1 row_mask:0xf bank_mask:0xf
    v_cndmask_b32_dpp v85, v85, v85, vcc wave_shr:1 row_mask:0xf bank_mask:0xf
    s_lshr_b64 s[52:53], s[52:53], 1
    v_cndmask_b32_dpp v86, v86, v86, vcc wave_shr:1 row_mask:0xf bank_mask:0xf
    v_cndmask_b32_dpp v87, v87, v87, vcc wave_shr:1 row_mask:0xf bank_mask:0xf
    s_andn2_b64 s[82:83], s[82:83], s[52:53]
    v_cndmask_b32_dpp v7, v7, v7, vcc wave_shr:1 row_mask:0xf bank_mask:0xf
    s_mov_b64 exec, s[54:55]
    s_cbranch_scc0 L2_d83
    s_mov_b64 exec, s[82:83]
    s_nop 1
    v_mfma_f32_4x4x4_16b_bf16 v[88:91], v[12:13], v[84:85], 0
    s_nop 1
    v_mfma_f32_4x4x4_16b_bf16 v[88:91], v[10:11], v[86:87], v[88:91]
    s_nop 4
    v_cvt_pk_bf16_f32 v88, v88, v89
    v_cvt_pk_bf16_f32 v89, v90, v91
    ds_pk_add_bf16 v7, v88 offset:65408
    ds_pk_add_bf16 v7, v89 offset:65412
    s_mov_b64 exec, s[54:55]
    s_branch L2_d83
L2_c84:
    s_lshl_b64 s[52:53], s[82:83], 1
    s_andn2_b64 s[52:53], s[52:53], s[80:81]
    s_andn2_b64 s[52:53], s[52:53], s[50:51]
    s_or_b64 s[80:81], s[80:81], s[52:53]
    s_not_b64 vcc, s[52:53]
    s_mov_b64 exec, -1
    v_cndmask_b32_dpp v84, v84, v84, vcc wave_shr:1 row_mask:0xf bank_mask:0xf
    v_cndmask_b32_dpp v85, v85, v85, vcc wave_shr:1 row_mask:0xf bank_mask:0xf
    s_lshr_b64 s[52:53], s[52:53], 1
    v_cndmask_b32_dpp v86, v86, v86, vcc wave_shr:1 row_mask:0xf bank_mask:0xf
    v_cndmask_b32_dpp v87, v87, v87, vcc wave_shr:1 row_mask:0xf bank_mask:0xf
    s_andn2_b64 s[82:83], s[82:83], s[52:53]
    v_cndmask_b32_dpp v7, v7, v7, vcc wave_shr:1 row_mask:0xf bank_mask:0xf
    s_mov_b64 exec, s[50:51]
    s_cbranch_scc0 L2_d84
    s_mov_b64 exec, s[82:83]
    s_nop 1
    v_mfma_f32_4x4x4_16b_bf16 v[88:91], v[12:13], v[84:85], 0
    s_nop 1
    v_mfma_f32_4x4x4_16b_bf16 v[88:91], v[10:11], v[86:87], v[88:91]
    s_nop 4
    v_cvt_pk_bf16_f32 v88, v88, v89
    v_cvt_pk_bf16_f32 v89, v90, v91
    ds_pk_add_bf16 v7, v88 offset:65408
    ds_pk_add_bf16 v7, v89 offset:65412
    s_mov_b64 exec, s[50:51]
    s_branch L2_d84
L2_c85:
    s_lshl_b64 s[52:53], s[82:83], 1
    s_andn2_b64 s[52:53], s[52:53], s[80:81]
    s_andn2_b64 s[52:53], s[52:53], s[54:55]
    s_or_b64 s[80:81], s[80:81], s[52:53]
    s_not_b64 vcc, s[52:53]
    s_mov_b64 exec, -1
    v_cndmask_b32_dpp v84, v84, v84, vcc wave_shr:1 row_mask:0xf bank_mask:0xf
    v_cndmask_b32_dpp v85, v85, v85, vcc wave_shr:1 row_mask:0xf bank_mask:0xf
    s_lshr_b64 s[52:53], s[52:53], 1
    v_cndmask_b32_dpp v86, v86, v86, vcc wave_shr:1 row_mask:0xf bank_mask:0xf
    v_cndmask_b32_dpp v87, v87, v87, vcc wave_shr:1 row_mask:0xf bank_mask:0xf
    s_andn2_b64 s[82:83], s[82:83], s[52:53]
    v_cndmask_b32_dpp v7, v7, v7, vcc wave_shr:1 row_mask:0xf bank_mask:0xf
    s_mov_b64 exec, s[54:55]
    s_cbranch_scc0 L2_d85
    s_mov_b64 exec, s[82:83]
    s_nop 1
    v_mfma_f32_4x4x4_16b_bf16 v[88:91], v[12:13], v[84:85], 0
    s_nop 1
    v_mfma_f32_4x4x4_16b_bf16 v[88:91], v[10:11], v[86:87], v[88:91]
    s_nop 4
    v_cvt_pk_bf16_f32 v88, v88, v89
    v_cvt_pk_bf16_f32 v89, v90, v91
    ds_pk_add_bf16 v7, v88 offset:65408
    ds_pk_add_bf16 v7, v89 offset:65412
    s_mov_b64 exec, s[54:55]
    s_branch L2_d85
L2_c86:
    s_lshl_b64 s[52:53], s[82:83], 1
    s_andn2_b64 s[52:53], s[52:53], s[80:81]
    s_andn2_b64 s[52:53], s[52:53], s[50:51]
    s_or_b64 s[80:81], s[80:81], s[52:53]
    s_not_b64 vcc, s[52:53]
    s_mov_b64 exec, -1
    v_cndmask_b32_dpp v84, v84, v84, vcc wave_shr:1 row_mask:0xf bank_mask:0xf
    v_cndmask_b32_dpp v85, v85, v85, vcc wave_shr:1 row_mask:0xf bank_mask:0xf
    s_lshr_b64 s[52:53], s[52:53], 1
    v_cndmask_b32_dpp v86, v86, v86, vcc wave_shr:1 row_mask:0xf bank_mask:0xf
    v_cndmask_b32_dpp v87, v87, v87, vcc wave_shr:1 row_mask:0xf bank_mask:0xf
    s_andn2_b64 s[82:83], s[82:83], s[52:53]
    v_cndmask_b32_dpp v7, v7, v7, vcc wave_shr:1 row_mask:0xf bank_mask:0xf
    s_mov_b64 exec, s[50:51]
    s_cbranch_scc0 L2_d86
    s_mov_b64 exec, s[82:83]
    s_nop 1
    v_mfma_f32_4x4x4_16b_bf16 v[88:91], v[12:13], v[84:85], 0
    s_nop 1
    v_mfma_f32_4x4x4_16b_bf16 v[88:91], v[10:11], v[86:87], v[88:91]
    s_nop 4
    v_cvt_pk_bf16_f32 v88, v88, v89
    v_cvt_pk_bf16_f32 v89, v90, v91
    ds_pk_add_bf16 v7, v88 offset:65408
    ds_pk_add_bf16 v7, v89 offset:65412
    s_mov_b64 exec, s[50:51]
    s_branch L2_d86
L2_c87:
    s_lshl_b64 s[52:53], s[82:83], 1
    s_andn2_b64 s[52:53], s[52:53], s[80:81]
    s_andn2_b64 s[52:53], s[52:53], s[54:55]
    s_or_b64 s[80:81], s[80:81], s[52:53]
    s_not_b64 vcc, s[52:53]
    s_mov_b64 exec, -1
    v_cndmask_b32_dpp v84, v84, v84, vcc wave_shr:1 row_mask:0xf bank_mask:0xf
    v_cndmask_b32_dpp v85, v85, v85, vcc wave_shr:1 row_mask:0xf bank_mask:0xf
    s_lshr_b64 s[52:53], s[52:53], 1
    v_cndmask_b32_dpp v86, v86, v86, vcc wave_shr:1 row_mask:0xf bank_mask:0xf
    v_cndmask_b32_dpp v87, v87, v87, vcc wave_shr:1 row_mask:0xf bank_mask:0xf
    s_andn2_b64 s[82:83], s[82:83], s[52:53]
    v_cndmask_b32_dpp v7, v7, v7, vcc wave_shr:1 row_mask:0xf bank_mask:0xf
    s_mov_b64 exec, s[54:55]
    s_cbranch_scc0 L2_d87
    s_mov_b64 exec, s[82:83]
    s_nop 1
    v_mfma_f32_4x4x4_16b_bf16 v[88:91], v[12:13], v[84:85], 0
    s_nop 1
    v_mfma_f32_4x4x4_16b_bf16 v[88:91], v[10:11], v[86:87], v[88:91]
    s_nop 4
    v_cvt_pk_bf16_f32 v88, v88, v89
    v_cvt_pk_bf16_f32 v89, v90, v91
    ds_pk_add_bf16 v7, v88 offset:65408
    ds_pk_add_bf16 v7, v89 offset:65412
    s_mov_b64 exec, s[54:55]
    s_branch L2_d87
L2_c88:
    s_lshl_b64 s[52:53], s[82:83], 1
    s_andn2_b64 s[52:53], s[52:53], s[80:81]
    s_andn2_b64 s[52:53], s[52:53], s[50:51]
    s_or_b64 s[80:81], s[80:81], s[52:53]
    s_not_b64 vcc, s[52:53]
    s_mov_b64 exec, -1
    v_cndmask_b32_dpp v84, v84, v84, vcc wave_shr:1 row_mask:0xf bank_mask:0xf
    v_cndmask_b32_dpp v85, v85, v85, vcc wave_shr:1 row_mask:0xf bank_mask:0xf
    s_lshr_b64 s[52:53], s[52:53], 1
    v_cndmask_b32_dpp v86, v86, v86, vcc wave_shr:1 row_mask:0xf bank_mask:0xf
    v_cndmask_b32_dpp v87, v87, v87, vcc wave_shr:1 row_mask:0xf bank_mask:0xf
    s_andn2_b64 s[82:83], s[82:83], s[52:53]
    v_cndmask_b32_dpp v7, v7, v7, vcc wave_shr:1 row_mask:0xf bank_mask:0xf
    s_mov_b64 exec, s[50:51]
    s_cbranch_scc0 L2_d88
    s_mov_b64 exec, s[82:83]
    s_nop 1
    v_mfma_f32_4x4x4_16b_bf16 v[88:91], v[12:13], v[84:85], 0
    s_nop 1
    v_mfma_f32_4x4x4_16b_bf16 v[88:91], v[10:11], v[86:87], v[88:91]
    s_nop 4
    v_cvt_pk_bf16_f32 v88, v88, v89
    v_cvt_pk_bf16_f32 v89, v90, v91
    ds_pk_add_bf16 v7, v88 offset:65408
    ds_pk_add_bf16 v7, v89 offset:65412
    s_mov_b64 exec, s[50:51]
    s_branch L2_d88
L2_oa89:
    s_waitcnt vmcnt(3)
    s_mov_b64 exec, s[6:7]
    v_lshrrev_b32 v114, 16, v114
    s_mov_b64 exec, -1
    v_and_b32 v46, 0x10000000, v32
    v_cmpx_eq_u32 vcc, 0, v46
    v_lshrrev_b32 v47, 14, v112
    v_and_b32 v47, v5, v47
    ds_read_b64 v[96:97], v47
    v_perm_b32 v98, v112, v114, s44
    v_bitop3_b32 v99, v112, 0.5, -0.5 bitop3:0xa8
    v_bitop3_b32 v98, v6, v98, v99 bitop3:0xca
    v_and_b32 v47, v5, v112
    s_waitcnt lgkmcnt(0)
    v_mfma_f32_4x4x4_16b_bf16 v[88:91], v[8:9], v[96:97], 0
    s_nop 4
    v_mul_f32 v88, v98, v88
    v_mul_f32 v89, v98, v89
    v_mul_f32 v90, v98, v90
    v_mul_f32 v91, v98, v91
    v_cvt_pk_bf16_f32 v88, v88, v89
    v_cvt_pk_bf16_f32 v89, v90, v91
    ds_pk_add_bf16 v47, v88 offset:65408
    ds_pk_add_bf16 v47, v89 offset:65412
    s_mov_b64 exec, -1
    v_and_b32 v46, 0x20000000, v32
    v_cmpx_eq_u32 vcc, 0, v46
    v_lshrrev_b32 v47, 14, v113
    v_and_b32 v47, v5, v47
    ds_read_b64 v[96:97], v47
    v_perm_b32 v98, v113, v114, s45
    v_bitop3_b32 v99, v113, 0.5, -0.5 bitop3:0xa8
    v_bitop3_b32 v98, v6, v98, v99 bitop3:0xca
    v_and_b32 v47, v5, v113
    s_waitcnt lgkmcnt(0)
    v_mfma_f32_4x4x4_16b_bf16 v[88:91], v[8:9], v[96:97], 0
    s_nop 4
    v_mul_f32 v88, v98, v88
    v_mul_f32 v89, v98, v89
    v_mul_f32 v90, v98, v90
    v_mul_f32 v91, v98, v91
    v_cvt_pk_bf16_f32 v88, v88, v89
    v_cvt_pk_bf16_f32 v89, v90, v91
    ds_pk_add_bf16 v47, v88 offset:65408
    ds_pk_add_bf16 v47, v89 offset:65412
    s_mov_b64 exec, -1
    s_branch L2_ob89
L2_xo90:
    v_cmp_lt_u32 vcc, 20, v99
    s_mov_b32 s101, 1
    s_cbranch_vccz L2_xp90
    v_cmp_lt_u32 vcc, 32, v99
    v_cmp_lt_u32 s[58:59], 31, v88
    s_mov_b32 s101, 2
    s_or_b64 vcc, vcc, s[58:59]
    s_cbranch_scc0 L2_xp90
    s_mov_b32 s37, 0x10000
    s_branch L2_xp90
L2_c91:
    s_lshl_b64 s[52:53], s[82:83], 1
    s_andn2_b64 s[52:53], s[52:53], s[80:81]
    s_andn2_b64 s[52:53], s[52:53], s[54:55]
    s_or_b64 s[80:81], s[80:81], s[52:53]
    s_not_b64 vcc, s[52:53]
    s_mov_b64 exec, -1
    v_cndmask_b32_dpp v84, v84, v84, vcc wave_shr:1 row_mask:0xf bank_mask:0xf
    v_cndmask_b32_dpp v85, v85, v85, vcc wave_shr:1 row_mask:0xf bank_mask:0xf
    s_lshr_b64 s[52:53], s[52:53], 1
    v_cndmask_b32_dpp v86, v86, v86, vcc wave_shr:1 row_mask:0xf bank_mask:0xf
    v_cndmask_b32_dpp v87, v87, v87, vcc wave_shr:1 row_mask:0xf bank_mask:0xf
    s_andn2_b64 s[82:83], s[82:83], s[52:53]
    v_cndmask_b32_dpp v7, v7, v7, vcc wave_shr:1 row_mask:0xf bank_mask:0xf
    s_mov_b64 exec, s[54:55]
    s_cbranch_scc0 L2_d91
    s_mov_b64 exec, s[82:83]
    s_nop 1
    v_mfma_f32_4x4x4_16b_bf16 v[88:91], v[12:13], v[84:85], 0
    s_nop 1
    v_mfma_f32_4x4x4_16b_bf16 v[88:91], v[10:11], v[86:87], v[88:91]
    s_nop 4
    v_cvt_pk_bf16_f32 v88, v88, v89
    v_cvt_pk_bf16_f32 v89, v90, v91
    ds_pk_add_bf16 v7, v88 offset:65408
    ds_pk_add_bf16 v7, v89 offset:65412
    s_mov_b64 exec, s[54:55]
    s_branch L2_d91
L2_c92:
    s_lshl_b64 s[52:53], s[82:83], 1
    s_andn2_b64 s[52:53], s[52:53], s[80:81]
    s_andn2_b64 s[52:53], s[52:53], s[50:51]
    s_or_b64 s[80:81], s[80:81], s[52:53]
    s_not_b64 vcc, s[52:53]
    s_mov_b64 exec, -1
    v_cndmask_b32_dpp v84, v84, v84, vcc wave_shr:1 row_mask:0xf bank_mask:0xf
    v_cndmask_b32_dpp v85, v85, v85, vcc wave_shr:1 row_mask:0xf bank_mask:0xf
    s_lshr_b64 s[52:53], s[52:53], 1
    v_cndmask_b32_dpp v86, v86, v86, vcc wave_shr:1 row_mask:0xf bank_mask:0xf
    v_cndmask_b32_dpp v87, v87, v87, vcc wave_shr:1 row_mask:0xf bank_mask:0xf
    s_andn2_b64 s[82:83], s[82:83], s[52:53]
    v_cndmask_b32_dpp v7, v7, v7, vcc wave_shr:1 row_mask:0xf bank_mask:0xf
    s_mov_b64 exec, s[50:51]
    s_cbranch_scc0 L2_d92
    s_mov_b64 exec, s[82:83]
    s_nop 1
    v_mfma_f32_4x4x4_16b_bf16 v[88:91], v[12:13], v[84:85], 0
    s_nop 1
    v_mfma_f32_4x4x4_16b_bf16 v[88:91], v[10:11], v[86:87], v[88:91]
    s_nop 4
    v_cvt_pk_bf16_f32 v88, v88, v89
    v_cvt_pk_bf16_f32 v89, v90, v91
    ds_pk_add_bf16 v7, v88 offset:65408
    ds_pk_add_bf16 v7, v89 offset:65412
    s_mov_b64 exec, s[50:51]
    s_branch L2_d92
L2_c93:
    s_lshl_b64 s[52:53], s[82:83], 1
    s_andn2_b64 s[52:53], s[52:53], s[80:81]
    s_andn2_b64 s[52:53], s[52:53], s[54:55]
    s_or_b64 s[80:81], s[80:81], s[52:53]
    s_not_b64 vcc, s[52:53]
    s_mov_b64 exec, -1
    v_cndmask_b32_dpp v84, v84, v84, vcc wave_shr:1 row_mask:0xf bank_mask:0xf
    v_cndmask_b32_dpp v85, v85, v85, vcc wave_shr:1 row_mask:0xf bank_mask:0xf
    s_lshr_b64 s[52:53], s[52:53], 1
    v_cndmask_b32_dpp v86, v86, v86, vcc wave_shr:1 row_mask:0xf bank_mask:0xf
    v_cndmask_b32_dpp v87, v87, v87, vcc wave_shr:1 row_mask:0xf bank_mask:0xf
    s_andn2_b64 s[82:83], s[82:83], s[52:53]
    v_cndmask_b32_dpp v7, v7, v7, vcc wave_shr:1 row_mask:0xf bank_mask:0xf
    s_mov_b64 exec, s[54:55]
    s_cbranch_scc0 L2_d93
    s_mov_b64 exec, s[82:83]
    s_nop 1
    v_mfma_f32_4x4x4_16b_bf16 v[88:91], v[12:13], v[84:85], 0
    s_nop 1
    v_mfma_f32_4x4x4_16b_bf16 v[88:91], v[10:11], v[86:87], v[88:91]
    s_nop 4
    v_cvt_pk_bf16_f32 v88, v88, v89
    v_cvt_pk_bf16_f32 v89, v90, v91
    ds_pk_add_bf16 v7, v88 offset:65408
    ds_pk_add_bf16 v7, v89 offset:65412
    s_mov_b64 exec, s[54:55]
    s_branch L2_d93
L2_c94:
    s_lshl_b64 s[52:53], s[82:83], 1
    s_andn2_b64 s[52:53], s[52:53], s[80:81]
    s_andn2_b64 s[52:53], s[52:53], s[50:51]
    s_or_b64 s[80:81], s[80:81], s[52:53]
    s_not_b64 vcc, s[52:53]
    s_mov_b64 exec, -1
    v_cndmask_b32_dpp v84, v84, v84, vcc wave_shr:1 row_mask:0xf bank_mask:0xf
    v_cndmask_b32_dpp v85, v85, v85, vcc wave_shr:1 row_mask:0xf bank_mask:0xf
    s_lshr_b64 s[52:53], s[52:53], 1
    v_cndmask_b32_dpp v86, v86, v86, vcc wave_shr:1 row_mask:0xf bank_mask:0xf
    v_cndmask_b32_dpp v87, v87, v87, vcc wave_shr:1 row_mask:0xf bank_mask:0xf
    s_andn2_b64 s[82:83], s[82:83], s[52:53]
    v_cndmask_b32_dpp v7, v7, v7, vcc wave_shr:1 row_mask:0xf bank_mask:0xf
    s_mov_b64 exec, s[50:51]
    s_cbranch_scc0 L2_d94
    s_mov_b64 exec, s[82:83]
    s_nop 1
    v_mfma_f32_4x4x4_16b_bf16 v[88:91], v[12:13], v[84:85], 0
    s_nop 1
    v_mfma_f32_4x4x4_16b_bf16 v[88:91], v[10:11], v[86:87], v[88:91]
    s_nop 4
    v_cvt_pk_bf16_f32 v88, v88, v89
    v_cvt_pk_bf16_f32 v89, v90, v91
    ds_pk_add_bf16 v7, v88 offset:65408
    ds_pk_add_bf16 v7, v89 offset:65412
    s_mov_b64 exec, s[50:51]
    s_branch L2_d94
L2_c95:
    s_lshl_b64 s[52:53], s[82:83], 1
    s_andn2_b64 s[52:53], s[52:53], s[80:81]
    s_andn2_b64 s[52:53], s[52:53], s[54:55]
    s_or_b64 s[80:81], s[80:81], s[52:53]
    s_not_b64 vcc, s[52:53]
    s_mov_b64 exec, -1
    v_cndmask_b32_dpp v84, v84, v84, vcc wave_shr:1 row_mask:0xf bank_mask:0xf
    v_cndmask_b32_dpp v85, v85, v85, vcc wave_shr:1 row_mask:0xf bank_mask:0xf
    s_lshr_b64 s[52:53], s[52:53], 1
    v_cndmask_b32_dpp v86, v86, v86, vcc wave_shr:1 row_mask:0xf bank_mask:0xf
    v_cndmask_b32_dpp v87, v87, v87, vcc wave_shr:1 row_mask:0xf bank_mask:0xf
    s_andn2_b64 s[82:83], s[82:83], s[52:53]
    v_cndmask_b32_dpp v7, v7, v7, vcc wave_shr:1 row_mask:0xf bank_mask:0xf
    s_mov_b64 exec, s[54:55]
    s_cbranch_scc0 L2_d95
    s_mov_b64 exec, s[82:83]
    s_nop 1
    v_mfma_f32_4x4x4_16b_bf16 v[88:91], v[12:13], v[84:85], 0
    s_nop 1
    v_mfma_f32_4x4x4_16b_bf16 v[88:91], v[10:11], v[86:87], v[88:91]
    s_nop 4
    v_cvt_pk_bf16_f32 v88, v88, v89
    v_cvt_pk_bf16_f32 v89, v90, v91
    ds_pk_add_bf16 v7, v88 offset:65408
    ds_pk_add_bf16 v7, v89 offset:65412
    s_mov_b64 exec, s[54:55]
    s_branch L2_d95
L2_c96:
    s_lshl_b64 s[52:53], s[82:83], 1
    s_andn2_b64 s[52:53], s[52:53], s[80:81]
    s_andn2_b64 s[52:53], s[52:53], s[50:51]
    s_or_b64 s[80:81], s[80:81], s[52:53]
    s_not_b64 vcc, s[52:53]
    s_mov_b64 exec, -1
    v_cndmask_b32_dpp v84, v84, v84, vcc wave_shr:1 row_mask:0xf bank_mask:0xf
    v_cndmask_b32_dpp v85, v85, v85, vcc wave_shr:1 row_mask:0xf bank_mask:0xf
    s_lshr_b64 s[52:53], s[52:53], 1
    v_cndmask_b32_dpp v86, v86, v86, vcc wave_shr:1 row_mask:0xf bank_mask:0xf
    v_cndmask_b32_dpp v87, v87, v87, vcc wave_shr:1 row_mask:0xf bank_mask:0xf
    s_andn2_b64 s[82:83], s[82:83], s[52:53]
    v_cndmask_b32_dpp v7, v7, v7, vcc wave_shr:1 row_mask:0xf bank_mask:0xf
    s_mov_b64 exec, s[50:51]
    s_cbranch_scc0 L2_d96
    s_mov_b64 exec, s[82:83]
    s_nop 1
    v_mfma_f32_4x4x4_16b_bf16 v[88:91], v[12:13], v[84:85], 0
    s_nop 1
    v_mfma_f32_4x4x4_16b_bf16 v[88:91], v[10:11], v[86:87], v[88:91]
    s_nop 4
    v_cvt_pk_bf16_f32 v88, v88, v89
    v_cvt_pk_bf16_f32 v89, v90, v91
    ds_pk_add_bf16 v7, v88 offset:65408
    ds_pk_add_bf16 v7, v89 offset:65412
    s_mov_b64 exec, s[50:51]
    s_branch L2_d96
L2_xa97:
    s_cmp_eq_u32 s101, 1
    s_cbranch_scc1 L2_xc97
    v_lshlrev_b32 v89, 0, v96
    v_add_u32 v90, 140, v97
    v_bitop3_b32 v90, v89, v45, v90 bitop3:0x6a
    ds_write_b32 v98, v90 offset:28
    v_lshlrev_b32 v89, 4, v96
    v_add_u32 v90, 120, v97
    v_bitop3_b32 v90, v89, v45, v90 bitop3:0x6a
    ds_write_b32 v98, v90 offset:24
    v_lshlrev_b32 v89, 8, v96
    v_add_u32 v90, 100, v97
    v_bitop3_b32 v90, v89, v45, v90 bitop3:0x6a
    ds_write_b32 v98, v90 offset:20
L2_xc97:
    v_lshlrev_b32 v89, 12, v96
    v_add_u32 v90, 80, v97
    v_bitop3_b32 v90, v89, v45, v90 bitop3:0x6a
    ds_write_b32 v98, v90 offset:16
    s_branch L2_xb97
L2_xe97:
    v_cmp_lt_u32 vcc, 32, v99
    v_cmp_lt_u32 s[58:59], 31, v88
    v_lshrrev_b32 v89, 16, v96
    v_add_u32 v97, 80, v97
    s_or_b64 vcc, vcc, s[58:59]
    s_cbranch_scc1 L2_xs97
    v_lshlrev_b32 v89, v1, v89
    v_and_b32 v89, v45, v89
    v_cmp_ne_u32 vcc, 0, v89
    v_xor_b32 v90, v97, v89
    s_add_u32 s3, s37, s38
    v_mbcnt_lo_u32_b32 v98, vcc_lo, 0
    v_mbcnt_hi_u32_b32 v98, vcc_hi, v98
    s_bcnt1_i32_b64 s41, vcc
    v_lshl_add_u32 v98, v98, 2, s3
    s_lshl2_add_u32 s37, s41, s37
    s_mov_b64 exec, vcc
    ds_write_b32 v98, v90
    s_mov_b64 exec, -1
    s_branch L2_xr97
L2_xs97:
    s_waitcnt lgkmcnt(0)
    s_mov_b32 s37, 0x10000
    s_branch L2_xw97
L2_c98:
    s_lshl_b64 s[52:53], s[82:83], 1
    s_andn2_b64 s[52:53], s[52:53], s[80:81]
    s_andn2_b64 s[52:53], s[52:53], s[54:55]
    s_or_b64 s[80:81], s[80:81], s[52:53]
    s_not_b64 vcc, s[52:53]
    s_mov_b64 exec, -1
    v_cndmask_b32_dpp v84, v84, v84, vcc wave_shr:1 row_mask:0xf bank_mask:0xf
    v_cndmask_b32_dpp v85, v85, v85, vcc wave_shr:1 row_mask:0xf bank_mask:0xf
    s_lshr_b64 s[52:53], s[52:53], 1
    v_cndmask_b32_dpp v86, v86, v86, vcc wave_shr:1 row_mask:0xf bank_mask:0xf
    v_cndmask_b32_dpp v87, v87, v87, vcc wave_shr:1 row_mask:0xf bank_mask:0xf
    s_andn2_b64 s[82:83], s[82:83], s[52:53]
    v_cndmask_b32_dpp v7, v7, v7, vcc wave_shr:1 row_mask:0xf bank_mask:0xf
    s_mov_b64 exec, s[54:55]
    s_cbranch_scc0 L2_d98
    s_mov_b64 exec, s[82:83]
    s_nop 1
    v_mfma_f32_4x4x4_16b_bf16 v[88:91], v[12:13], v[84:85], 0
    s_nop 1
    v_mfma_f32_4x4x4_16b_bf16 v[88:91], v[10:11], v[86:87], v[88:91]
    s_nop 4
    v_cvt_pk_bf16_f32 v88, v88, v89
    v_cvt_pk_bf16_f32 v89, v90, v91
    ds_pk_add_bf16 v7, v88 offset:65408
    ds_pk_add_bf16 v7, v89 offset:65412
    s_mov_b64 exec, s[54:55]
    s_branch L2_d98
L2_c99:
    s_lshl_b64 s[52:53], s[82:83], 1
    s_andn2_b64 s[52:53], s[52:53], s[80:81]
    s_andn2_b64 s[52:53], s[52:53], s[50:51]
    s_or_b64 s[80:81], s[80:81], s[52:53]
    s_not_b64 vcc, s[52:53]
    s_mov_b64 exec, -1
    v_cndmask_b32_dpp v84, v84, v84, vcc wave_shr:1 row_mask:0xf bank_mask:0xf
    v_cndmask_b32_dpp v85, v85, v85, vcc wave_shr:1 row_mask:0xf bank_mask:0xf
    s_lshr_b64 s[52:53], s[52:53], 1
    v_cndmask_b32_dpp v86, v86, v86, vcc wave_shr:1 row_mask:0xf bank_mask:0xf
    v_cndmask_b32_dpp v87, v87, v87, vcc wave_shr:1 row_mask:0xf bank_mask:0xf
    s_andn2_b64 s[82:83], s[82:83], s[52:53]
    v_cndmask_b32_dpp v7, v7, v7, vcc wave_shr:1 row_mask:0xf bank_mask:0xf
    s_mov_b64 exec, s[50:51]
    s_cbranch_scc0 L2_d99
    s_mov_b64 exec, s[82:83]
    s_nop 1
    v_mfma_f32_4x4x4_16b_bf16 v[88:91], v[12:13], v[84:85], 0
    s_nop 1
    v_mfma_f32_4x4x4_16b_bf16 v[88:91], v[10:11], v[86:87], v[88:91]
    s_nop 4
    v_cvt_pk_bf16_f32 v88, v88, v89
    v_cvt_pk_bf16_f32 v89, v90, v91
    ds_pk_add_bf16 v7, v88 offset:65408
    ds_pk_add_bf16 v7, v89 offset:65412
    s_mov_b64 exec, s[50:51]
    s_branch L2_d99
L2_xf97:
    s_cmp_gt_u32 s37, 1024
    s_cbranch_scc1 L2_xt97
    s_cmp_lt_u32 s37, 768
    s_cbranch_scc1 L2_xl97
    ds_read_b32 v32, v44 offset:896
    s_add_u32 s3, s42, 2
    s_bitset1_b32 s43, s3
    s_branch L2_xg97
L2_xl97:
    s_waitcnt lgkmcnt(0)
    v_mov_b32 v31, -1
    s_cmp_ge_u32 s37, 512
    s_cbranch_scc1 L2_xg97
    v_mov_b32 v39, -1
    s_cmp_ge_u32 s37, 256
    s_cbranch_scc1 L2_xg97
    v_mov_b32 v27, -1
    s_branch L2_xg97
L2_xt97:
    s_waitcnt lgkmcnt(0)
    v_mov_b32 v21, -1
    v_mov_b32 v27, -1
    v_mov_b32 v39, -1
    v_mov_b32 v31, -1
    s_add_u32 s3, s42, 2
    s_bitset1_b32 s36, s3
    s_branch L2_xg97
L2_oa100:
    v_and_b32 v47, 0x0fffffff, v33
    buffer_load_dword v114, v47, s[8:11], 0 offen offset:16
    s_mov_b64 exec, s[6:7]
    v_add_u32 v47, 8, v47
    v_lshrrev_b32 v33, 2, v33
    s_mov_b64 exec, -1
    buffer_load_dwordx2 v[112:113], v47, s[8:11], 0 offen
    s_branch L2_ob100
L2_c101:
    s_lshl_b64 s[52:53], s[82:83], 1
    s_andn2_b64 s[52:53], s[52:53], s[80:81]
    s_andn2_b64 s[52:53], s[52:53], s[54:55]
    s_or_b64 s[80:81], s[80:81], s[52:53]
    s_not_b64 vcc, s[52:53]
    s_mov_b64 exec, -1
    v_cndmask_b32_dpp v84, v84, v84, vcc wave_shr:1 row_mask:0xf bank_mask:0xf
    v_cndmask_b32_dpp v85, v85, v85, vcc wave_shr:1 row_mask:0xf bank_mask:0xf
    s_lshr_b64 s[52:53], s[52:53], 1
    v_cndmask_b32_dpp v86, v86, v86, vcc wave_shr:1 row_mask:0xf bank_mask:0xf
    v_cndmask_b32_dpp v87, v87, v87, vcc wave_shr:1 row_mask:0xf bank_mask:0xf
    s_andn2_b64 s[82:83], s[82:83], s[52:53]
    v_cndmask_b32_dpp v7, v7, v7, vcc wave_shr:1 row_mask:0xf bank_mask:0xf
    s_mov_b64 exec, s[54:55]
    s_cbranch_scc0 L2_d101
    s_mov_b64 exec, s[82:83]
    s_nop 1
    v_mfma_f32_4x4x4_16b_bf16 v[88:91], v[12:13], v[84:85], 0
    s_nop 1
    v_mfma_f32_4x4x4_16b_bf16 v[88:91], v[10:11], v[86:87], v[88:91]
    s_nop 4
    v_cvt_pk_bf16_f32 v88, v88, v89
    v_cvt_pk_bf16_f32 v89, v90, v91
    ds_pk_add_bf16 v7, v88 offset:65408
    ds_pk_add_bf16 v7, v89 offset:65412
    s_mov_b64 exec, s[54:55]
    s_branch L2_d101
L2_c102:
    s_lshl_b64 s[52:53], s[82:83], 1
    s_andn2_b64 s[52:53], s[52:53], s[80:81]
    s_andn2_b64 s[52:53], s[52:53], s[50:51]
    s_or_b64 s[80:81], s[80:81], s[52:53]
    s_not_b64 vcc, s[52:53]
    s_mov_b64 exec, -1
    v_cndmask_b32_dpp v84, v84, v84, vcc wave_shr:1 row_mask:0xf bank_mask:0xf
    v_cndmask_b32_dpp v85, v85, v85, vcc wave_shr:1 row_mask:0xf bank_mask:0xf
    s_lshr_b64 s[52:53], s[52:53], 1
    v_cndmask_b32_dpp v86, v86, v86, vcc wave_shr:1 row_mask:0xf bank_mask:0xf
    v_cndmask_b32_dpp v87, v87, v87, vcc wave_shr:1 row_mask:0xf bank_mask:0xf
    s_andn2_b64 s[82:83], s[82:83], s[52:53]
    v_cndmask_b32_dpp v7, v7, v7, vcc wave_shr:1 row_mask:0xf bank_mask:0xf
    s_mov_b64 exec, s[50:51]
    s_cbranch_scc0 L2_d102
    s_mov_b64 exec, s[82:83]
    s_nop 1
    v_mfma_f32_4x4x4_16b_bf16 v[88:91], v[12:13], v[84:85], 0
    s_nop 1
    v_mfma_f32_4x4x4_16b_bf16 v[88:91], v[10:11], v[86:87], v[88:91]
    s_nop 4
    v_cvt_pk_bf16_f32 v88, v88, v89
    v_cvt_pk_bf16_f32 v89, v90, v91
    ds_pk_add_bf16 v7, v88 offset:65408
    ds_pk_add_bf16 v7, v89 offset:65412
    s_mov_b64 exec, s[50:51]
    s_branch L2_d102
L2_c103:
    s_lshl_b64 s[52:53], s[82:83], 1
    s_andn2_b64 s[52:53], s[52:53], s[80:81]
    s_andn2_b64 s[52:53], s[52:53], s[54:55]
    s_or_b64 s[80:81], s[80:81], s[52:53]
    s_not_b64 vcc, s[52:53]
    s_mov_b64 exec, -1
    v_cndmask_b32_dpp v84, v84, v84, vcc wave_shr:1 row_mask:0xf bank_mask:0xf
    v_cndmask_b32_dpp v85, v85, v85, vcc wave_shr:1 row_mask:0xf bank_mask:0xf
    s_lshr_b64 s[52:53], s[52:53], 1
    v_cndmask_b32_dpp v86, v86, v86, vcc wave_shr:1 row_mask:0xf bank_mask:0xf
    v_cndmask_b32_dpp v87, v87, v87, vcc wave_shr:1 row_mask:0xf bank_mask:0xf
    s_andn2_b64 s[82:83], s[82:83], s[52:53]
    v_cndmask_b32_dpp v7, v7, v7, vcc wave_shr:1 row_mask:0xf bank_mask:0xf
    s_mov_b64 exec, s[54:55]
    s_cbranch_scc0 L2_d103
    s_mov_b64 exec, s[82:83]
    s_nop 1
    v_mfma_f32_4x4x4_16b_bf16 v[88:91], v[12:13], v[84:85], 0
    s_nop 1
    v_mfma_f32_4x4x4_16b_bf16 v[88:91], v[10:11], v[86:87], v[88:91]
    s_nop 4
    v_cvt_pk_bf16_f32 v88, v88, v89
    v_cvt_pk_bf16_f32 v89, v90, v91
    ds_pk_add_bf16 v7, v88 offset:65408
    ds_pk_add_bf16 v7, v89 offset:65412
    s_mov_b64 exec, s[54:55]
    s_branch L2_d103
L2_c104:
    s_lshl_b64 s[52:53], s[82:83], 1
    s_andn2_b64 s[52:53], s[52:53], s[80:81]
    s_andn2_b64 s[52:53], s[52:53], s[50:51]
    s_or_b64 s[80:81], s[80:81], s[52:53]
    s_not_b64 vcc, s[52:53]
    s_mov_b64 exec, -1
    v_cndmask_b32_dpp v84, v84, v84, vcc wave_shr:1 row_mask:0xf bank_mask:0xf
    v_cndmask_b32_dpp v85, v85, v85, vcc wave_shr:1 row_mask:0xf bank_mask:0xf
    s_lshr_b64 s[52:53], s[52:53], 1
    v_cndmask_b32_dpp v86, v86, v86, vcc wave_shr:1 row_mask:0xf bank_mask:0xf
    v_cndmask_b32_dpp v87, v87, v87, vcc wave_shr:1 row_mask:0xf bank_mask:0xf
    s_andn2_b64 s[82:83], s[82:83], s[52:53]
    v_cndmask_b32_dpp v7, v7, v7, vcc wave_shr:1 row_mask:0xf bank_mask:0xf
    s_mov_b64 exec, s[50:51]
    s_cbranch_scc0 L2_d104
    s_mov_b64 exec, s[82:83]
    s_nop 1
    v_mfma_f32_4x4x4_16b_bf16 v[88:91], v[12:13], v[84:85], 0
    s_nop 1
    v_mfma_f32_4x4x4_16b_bf16 v[88:91], v[10:11], v[86:87], v[88:91]
    s_nop 4
    v_cvt_pk_bf16_f32 v88, v88, v89
    v_cvt_pk_bf16_f32 v89, v90, v91
    ds_pk_add_bf16 v7, v88 offset:65408
    ds_pk_add_bf16 v7, v89 offset:65412
    s_mov_b64 exec, s[50:51]
    s_branch L2_d104
L2_c105:
    s_lshl_b64 s[52:53], s[82:83], 1
    s_andn2_b64 s[52:53], s[52:53], s[80:81]
    s_andn2_b64 s[52:53], s[52:53], s[54:55]
    s_or_b64 s[80:81], s[80:81], s[52:53]
    s_not_b64 vcc, s[52:53]
    s_mov_b64 exec, -1
    v_cndmask_b32_dpp v84, v84, v84, vcc wave_shr:1 row_mask:0xf bank_mask:0xf
    v_cndmask_b32_dpp v85, v85, v85, vcc wave_shr:1 row_mask:0xf bank_mask:0xf
    s_lshr_b64 s[52:53], s[52:53], 1
    v_cndmask_b32_dpp v86, v86, v86, vcc wave_shr:1 row_mask:0xf bank_mask:0xf
    v_cndmask_b32_dpp v87, v87, v87, vcc wave_shr:1 row_mask:0xf bank_mask:0xf
    s_andn2_b64 s[82:83], s[82:83], s[52:53]
    v_cndmask_b32_dpp v7, v7, v7, vcc wave_shr:1 row_mask:0xf bank_mask:0xf
    s_mov_b64 exec, s[54:55]
    s_cbranch_scc0 L2_d105
    s_mov_b64 exec, s[82:83]
    s_nop 1
    v_mfma_f32_4x4x4_16b_bf16 v[88:91], v[12:13], v[84:85], 0
    s_nop 1
    v_mfma_f32_4x4x4_16b_bf16 v[88:91], v[10:11], v[86:87], v[88:91]
    s_nop 4
    v_cvt_pk_bf16_f32 v88, v88, v89
    v_cvt_pk_bf16_f32 v89, v90, v91
    ds_pk_add_bf16 v7, v88 offset:65408
    ds_pk_add_bf16 v7, v89 offset:65412
    s_mov_b64 exec, s[54:55]
    s_branch L2_d105
L2_c106:
    s_lshl_b64 s[52:53], s[82:83], 1
    s_andn2_b64 s[52:53], s[52:53], s[80:81]
    s_andn2_b64 s[52:53], s[52:53], s[50:51]
    s_or_b64 s[80:81], s[80:81], s[52:53]
    s_not_b64 vcc, s[52:53]
    s_mov_b64 exec, -1
    v_cndmask_b32_dpp v84, v84, v84, vcc wave_shr:1 row_mask:0xf bank_mask:0xf
    v_cndmask_b32_dpp v85, v85, v85, vcc wave_shr:1 row_mask:0xf bank_mask:0xf
    s_lshr_b64 s[52:53], s[52:53], 1
    v_cndmask_b32_dpp v86, v86, v86, vcc wave_shr:1 row_mask:0xf bank_mask:0xf
    v_cndmask_b32_dpp v87, v87, v87, vcc wave_shr:1 row_mask:0xf bank_mask:0xf
    s_andn2_b64 s[82:83], s[82:83], s[52:53]
    v_cndmask_b32_dpp v7, v7, v7, vcc wave_shr:1 row_mask:0xf bank_mask:0xf
    s_mov_b64 exec, s[50:51]
    s_cbranch_scc0 L2_d106
    s_mov_b64 exec, s[82:83]
    s_nop 1
    v_mfma_f32_4x4x4_16b_bf16 v[88:91], v[12:13], v[84:85], 0
    s_nop 1
    v_mfma_f32_4x4x4_16b_bf16 v[88:91], v[10:11], v[86:87], v[88:91]
    s_nop 4
    v_cvt_pk_bf16_f32 v88, v88, v89
    v_cvt_pk_bf16_f32 v89, v90, v91
    ds_pk_add_bf16 v7, v88 offset:65408
    ds_pk_add_bf16 v7, v89 offset:65412
    s_mov_b64 exec, s[50:51]
    s_branch L2_d106
L2_oa107:
    s_waitcnt vmcnt(3)
    s_mov_b64 exec, s[6:7]
    v_lshrrev_b32 v114, 16, v114
    s_mov_b64 exec, -1
    v_and_b32 v46, 0x10000000, v33
    v_cmpx_eq_u32 vcc, 0, v46
    v_lshrrev_b32 v47, 14, v112
    v_and_b32 v47, v5, v47
    ds_read_b64 v[96:97], v47
    v_perm_b32 v98, v112, v114, s44
    v_bitop3_b32 v99, v112, 0.5, -0.5 bitop3:0xa8
    v_bitop3_b32 v98, v6, v98, v99 bitop3:0xca
    v_and_b32 v47, v5, v112
    s_waitcnt lgkmcnt(0)
    v_mfma_f32_4x4x4_16b_bf16 v[88:91], v[8:9], v[96:97], 0
    s_nop 4
    v_mul_f32 v88, v98, v88
    v_mul_f32 v89, v98, v89
    v_mul_f32 v90, v98, v90
    v_mul_f32 v91, v98, v91
    v_cvt_pk_bf16_f32 v88, v88, v89
    v_cvt_pk_bf16_f32 v89, v90, v91
    ds_pk_add_bf16 v47, v88 offset:65408
    ds_pk_add_bf16 v47, v89 offset:65412
    s_mov_b64 exec, -1
    v_and_b32 v46, 0x20000000, v33
    v_cmpx_eq_u32 vcc, 0, v46
    v_lshrrev_b32 v47, 14, v113
    v_and_b32 v47, v5, v47
    ds_read_b64 v[96:97], v47
    v_perm_b32 v98, v113, v114, s45
    v_bitop3_b32 v99, v113, 0.5, -0.5 bitop3:0xa8
    v_bitop3_b32 v98, v6, v98, v99 bitop3:0xca
    v_and_b32 v47, v5, v113
    s_waitcnt lgkmcnt(0)
    v_mfma_f32_4x4x4_16b_bf16 v[88:91], v[8:9], v[96:97], 0
    s_nop 4
    v_mul_f32 v88, v98, v88
    v_mul_f32 v89, v98, v89
    v_mul_f32 v90, v98, v90
    v_mul_f32 v91, v98, v91
    v_cvt_pk_bf16_f32 v88, v88, v89
    v_cvt_pk_bf16_f32 v89, v90, v91
    ds_pk_add_bf16 v47, v88 offset:65408
    ds_pk_add_bf16 v47, v89 offset:65412
    s_mov_b64 exec, -1
    s_branch L2_ob107
L2_xo108:
    v_cmp_lt_u32 vcc, 20, v99
    s_mov_b32 s101, 1
    s_cbranch_vccz L2_xp108
    v_cmp_lt_u32 vcc, 32, v99
    v_cmp_lt_u32 s[58:59], 31, v88
    s_mov_b32 s101, 2
    s_or_b64 vcc, vcc, s[58:59]
    s_cbranch_scc0 L2_xp108
    s_mov_b32 s37, 0x10000
    s_branch L2_xp108
L2_c109:
    s_lshl_b64 s[52:53], s[82:83], 1
    s_andn2_b64 s[52:53], s[52:53], s[80:81]
    s_andn2_b64 s[52:53], s[52:53], s[54:55]
    s_or_b64 s[80:81], s[80:81], s[52:53]
    s_not_b64 vcc, s[52:53]
    s_mov_b64 exec, -1
    v_cndmask_b32_dpp v84, v84, v84, vcc wave_shr:1 row_mask:0xf bank_mask:0xf
    v_cndmask_b32_dpp v85, v85, v85, vcc wave_shr:1 row_mask:0xf bank_mask:0xf
    s_lshr_b64 s[52:53], s[52:53], 1
    v_cndmask_b32_dpp v86, v86, v86, vcc wave_shr:1 row_mask:0xf bank_mask:0xf
    v_cndmask_b32_dpp v87, v87, v87, vcc wave_shr:1 row_mask:0xf bank_mask:0xf
    s_andn2_b64 s[82:83], s[82:83], s[52:53]
    v_cndmask_b32_dpp v7, v7, v7, vcc wave_shr:1 row_mask:0xf bank_mask:0xf
    s_mov_b64 exec, s[54:55]
    s_cbranch_scc0 L2_d109
    s_mov_b64 exec, s[82:83]
    s_nop 1
    v_mfma_f32_4x4x4_16b_bf16 v[88:91], v[12:13], v[84:85], 0
    s_nop 1
    v_mfma_f32_4x4x4_16b_bf16 v[88:91], v[10:11], v[86:87], v[88:91]
    s_nop 4
    v_cvt_pk_bf16_f32 v88, v88, v89
    v_cvt_pk_bf16_f32 v89, v90, v91
    ds_pk_add_bf16 v7, v88 offset:65408
    ds_pk_add_bf16 v7, v89 offset:65412
    s_mov_b64 exec, s[54:55]
    s_branch L2_d109
L2_c110:
    s_lshl_b64 s[52:53], s[82:83], 1
    s_andn2_b64 s[52:53], s[52:53], s[80:81]
    s_andn2_b64 s[52:53], s[52:53], s[50:51]
    s_or_b64 s[80:81], s[80:81], s[52:53]
    s_not_b64 vcc, s[52:53]
    s_mov_b64 exec, -1
    v_cndmask_b32_dpp v84, v84, v84, vcc wave_shr:1 row_mask:0xf bank_mask:0xf
    v_cndmask_b32_dpp v85, v85, v85, vcc wave_shr:1 row_mask:0xf bank_mask:0xf
    s_lshr_b64 s[52:53], s[52:53], 1
    v_cndmask_b32_dpp v86, v86, v86, vcc wave_shr:1 row_mask:0xf bank_mask:0xf
    v_cndmask_b32_dpp v87, v87, v87, vcc wave_shr:1 row_mask:0xf bank_mask:0xf
    s_andn2_b64 s[82:83], s[82:83], s[52:53]
    v_cndmask_b32_dpp v7, v7, v7, vcc wave_shr:1 row_mask:0xf bank_mask:0xf
    s_mov_b64 exec, s[50:51]
    s_cbranch_scc0 L2_d110
    s_mov_b64 exec, s[82:83]
    s_nop 1
    v_mfma_f32_4x4x4_16b_bf16 v[88:91], v[12:13], v[84:85], 0
    s_nop 1
    v_mfma_f32_4x4x4_16b_bf16 v[88:91], v[10:11], v[86:87], v[88:91]
    s_nop 4
    v_cvt_pk_bf16_f32 v88, v88, v89
    v_cvt_pk_bf16_f32 v89, v90, v91
    ds_pk_add_bf16 v7, v88 offset:65408
    ds_pk_add_bf16 v7, v89 offset:65412
    s_mov_b64 exec, s[50:51]
    s_branch L2_d110
L2_c111:
    s_lshl_b64 s[52:53], s[82:83], 1
    s_andn2_b64 s[52:53], s[52:53], s[80:81]
    s_andn2_b64 s[52:53], s[52:53], s[54:55]
    s_or_b64 s[80:81], s[80:81], s[52:53]
    s_not_b64 vcc, s[52:53]
    s_mov_b64 exec, -1
    v_cndmask_b32_dpp v84, v84, v84, vcc wave_shr:1 row_mask:0xf bank_mask:0xf
    v_cndmask_b32_dpp v85, v85, v85, vcc wave_shr:1 row_mask:0xf bank_mask:0xf
    s_lshr_b64 s[52:53], s[52:53], 1
    v_cndmask_b32_dpp v86, v86, v86, vcc wave_shr:1 row_mask:0xf bank_mask:0xf
    v_cndmask_b32_dpp v87, v87, v87, vcc wave_shr:1 row_mask:0xf bank_mask:0xf
    s_andn2_b64 s[82:83], s[82:83], s[52:53]
    v_cndmask_b32_dpp v7, v7, v7, vcc wave_shr:1 row_mask:0xf bank_mask:0xf
    s_mov_b64 exec, s[54:55]
    s_cbranch_scc0 L2_d111
    s_mov_b64 exec, s[82:83]
    s_nop 1
    v_mfma_f32_4x4x4_16b_bf16 v[88:91], v[12:13], v[84:85], 0
    s_nop 1
    v_mfma_f32_4x4x4_16b_bf16 v[88:91], v[10:11], v[86:87], v[88:91]
    s_nop 4
    v_cvt_pk_bf16_f32 v88, v88, v89
    v_cvt_pk_bf16_f32 v89, v90, v91
    ds_pk_add_bf16 v7, v88 offset:65408
    ds_pk_add_bf16 v7, v89 offset:65412
    s_mov_b64 exec, s[54:55]
    s_branch L2_d111
L2_c112:
    s_lshl_b64 s[52:53], s[82:83], 1
    s_andn2_b64 s[52:53], s[52:53], s[80:81]
    s_andn2_b64 s[52:53], s[52:53], s[50:51]
    s_or_b64 s[80:81], s[80:81], s[52:53]
    s_not_b64 vcc, s[52:53]
    s_mov_b64 exec, -1
    v_cndmask_b32_dpp v84, v84, v84, vcc wave_shr:1 row_mask:0xf bank_mask:0xf
    v_cndmask_b32_dpp v85, v85, v85, vcc wave_shr:1 row_mask:0xf bank_mask:0xf
    s_lshr_b64 s[52:53], s[52:53], 1
    v_cndmask_b32_dpp v86, v86, v86, vcc wave_shr:1 row_mask:0xf bank_mask:0xf
    v_cndmask_b32_dpp v87, v87, v87, vcc wave_shr:1 row_mask:0xf bank_mask:0xf
    s_andn2_b64 s[82:83], s[82:83], s[52:53]
    v_cndmask_b32_dpp v7, v7, v7, vcc wave_shr:1 row_mask:0xf bank_mask:0xf
    s_mov_b64 exec, s[50:51]
    s_cbranch_scc0 L2_d112
    s_mov_b64 exec, s[82:83]
    s_nop 1
    v_mfma_f32_4x4x4_16b_bf16 v[88:91], v[12:13], v[84:85], 0
    s_nop 1
    v_mfma_f32_4x4x4_16b_bf16 v[88:91], v[10:11], v[86:87], v[88:91]
    s_nop 4
    v_cvt_pk_bf16_f32 v88, v88, v89
    v_cvt_pk_bf16_f32 v89, v90, v91
    ds_pk_add_bf16 v7, v88 offset:65408
    ds_pk_add_bf16 v7, v89 offset:65412
    s_mov_b64 exec, s[50:51]
    s_branch L2_d112
L2_c113:
    s_lshl_b64 s[52:53], s[82:83], 1
    s_andn2_b64 s[52:53], s[52:53], s[80:81]
    s_andn2_b64 s[52:53], s[52:53], s[54:55]
    s_or_b64 s[80:81], s[80:81], s[52:53]
    s_not_b64 vcc, s[52:53]
    s_mov_b64 exec, -1
    v_cndmask_b32_dpp v84, v84, v84, vcc wave_shr:1 row_mask:0xf bank_mask:0xf
    v_cndmask_b32_dpp v85, v85, v85, vcc wave_shr:1 row_mask:0xf bank_mask:0xf
    s_lshr_b64 s[52:53], s[52:53], 1
    v_cndmask_b32_dpp v86, v86, v86, vcc wave_shr:1 row_mask:0xf bank_mask:0xf
    v_cndmask_b32_dpp v87, v87, v87, vcc wave_shr:1 row_mask:0xf bank_mask:0xf
    s_andn2_b64 s[82:83], s[82:83], s[52:53]
    v_cndmask_b32_dpp v7, v7, v7, vcc wave_shr:1 row_mask:0xf bank_mask:0xf
    s_mov_b64 exec, s[54:55]
    s_cbranch_scc0 L2_d113
    s_mov_b64 exec, s[82:83]
    s_nop 1
    v_mfma_f32_4x4x4_16b_bf16 v[88:91], v[12:13], v[84:85], 0
    s_nop 1
    v_mfma_f32_4x4x4_16b_bf16 v[88:91], v[10:11], v[86:87], v[88:91]
    s_nop 4
    v_cvt_pk_bf16_f32 v88, v88, v89
    v_cvt_pk_bf16_f32 v89, v90, v91
    ds_pk_add_bf16 v7, v88 offset:65408
    ds_pk_add_bf16 v7, v89 offset:65412
    s_mov_b64 exec, s[54:55]
    s_branch L2_d113
L2_c114:
    s_lshl_b64 s[52:53], s[82:83], 1
    s_andn2_b64 s[52:53], s[52:53], s[80:81]
    s_andn2_b64 s[52:53], s[52:53], s[50:51]
    s_or_b64 s[80:81], s[80:81], s[52:53]
    s_not_b64 vcc, s[52:53]
    s_mov_b64 exec, -1
    v_cndmask_b32_dpp v84, v84, v84, vcc wave_shr:1 row_mask:0xf bank_mask:0xf
    v_cndmask_b32_dpp v85, v85, v85, vcc wave_shr:1 row_mask:0xf bank_mask:0xf
    s_lshr_b64 s[52:53], s[52:53], 1
    v_cndmask_b32_dpp v86, v86, v86, vcc wave_shr:1 row_mask:0xf bank_mask:0xf
    v_cndmask_b32_dpp v87, v87, v87, vcc wave_shr:1 row_mask:0xf bank_mask:0xf
    s_andn2_b64 s[82:83], s[82:83], s[52:53]
    v_cndmask_b32_dpp v7, v7, v7, vcc wave_shr:1 row_mask:0xf bank_mask:0xf
    s_mov_b64 exec, s[50:51]
    s_cbranch_scc0 L2_d114
    s_mov_b64 exec, s[82:83]
    s_nop 1
    v_mfma_f32_4x4x4_16b_bf16 v[88:91], v[12:13], v[84:85], 0
    s_nop 1
    v_mfma_f32_4x4x4_16b_bf16 v[88:91], v[10:11], v[86:87], v[88:91]
    s_nop 4
    v_cvt_pk_bf16_f32 v88, v88, v89
    v_cvt_pk_bf16_f32 v89, v90, v91
    ds_pk_add_bf16 v7, v88 offset:65408
    ds_pk_add_bf16 v7, v89 offset:65412
    s_mov_b64 exec, s[50:51]
    s_branch L2_d114
L2_xa115:
    s_cmp_eq_u32 s101, 1
    s_cbranch_scc1 L2_xc115
    v_lshlrev_b32 v89, 0, v96
    v_add_u32 v90, 140, v97
    v_bitop3_b32 v90, v89, v45, v90 bitop3:0x6a
    ds_write_b32 v98, v90 offset:28
    v_lshlrev_b32 v89, 4, v96
    v_add_u32 v90, 120, v97
    v_bitop3_b32 v90, v89, v45, v90 bitop3:0x6a
    ds_write_b32 v98, v90 offset:24
    v_lshlrev_b32 v89, 8, v96
    v_add_u32 v90, 100, v97
    v_bitop3_b32 v90, v89, v45, v90 bitop3:0x6a
    ds_write_b32 v98, v90 offset:20
L2_xc115:
    v_lshlrev_b32 v89, 12, v96
    v_add_u32 v90, 80, v97
    v_bitop3_b32 v90, v89, v45, v90 bitop3:0x6a
    ds_write_b32 v98, v90 offset:16
    s_branch L2_xb115
L2_xe115:
    v_cmp_lt_u32 vcc, 32, v99
    v_cmp_lt_u32 s[58:59], 31, v88
    v_lshrrev_b32 v89, 16, v96
    v_add_u32 v97, 80, v97
    s_or_b64 vcc, vcc, s[58:59]
    s_cbranch_scc1 L2_xs115
    v_lshlrev_b32 v89, v1, v89
    v_and_b32 v89, v45, v89
    v_cmp_ne_u32 vcc, 0, v89
    v_xor_b32 v90, v97, v89
    s_add_u32 s3, s37, s38
    v_mbcnt_lo_u32_b32 v98, vcc_lo, 0
    v_mbcnt_hi_u32_b32 v98, vcc_hi, v98
    s_bcnt1_i32_b64 s41, vcc
    v_lshl_add_u32 v98, v98, 2, s3
    s_lshl2_add_u32 s37, s41, s37
    s_mov_b64 exec, vcc
    ds_write_b32 v98, v90
    s_mov_b64 exec, -1
    s_branch L2_xr115
L2_xs115:
    s_waitcnt lgkmcnt(0)
    s_mov_b32 s37, 0x10000
    s_branch L2_xw115
L2_c116:
    s_lshl_b64 s[52:53], s[82:83], 1
    s_andn2_b64 s[52:53], s[52:53], s[80:81]
    s_andn2_b64 s[52:53], s[52:53], s[54:55]
    s_or_b64 s[80:81], s[80:81], s[52:53]
    s_not_b64 vcc, s[52:53]
    s_mov_b64 exec, -1
    v_cndmask_b32_dpp v84, v84, v84, vcc wave_shr:1 row_mask:0xf bank_mask:0xf
    v_cndmask_b32_dpp v85, v85, v85, vcc wave_shr:1 row_mask:0xf bank_mask:0xf
    s_lshr_b64 s[52:53], s[52:53], 1
    v_cndmask_b32_dpp v86, v86, v86, vcc wave_shr:1 row_mask:0xf bank_mask:0xf
    v_cndmask_b32_dpp v87, v87, v87, vcc wave_shr:1 row_mask:0xf bank_mask:0xf
    s_andn2_b64 s[82:83], s[82:83], s[52:53]
    v_cndmask_b32_dpp v7, v7, v7, vcc wave_shr:1 row_mask:0xf bank_mask:0xf
    s_mov_b64 exec, s[54:55]
    s_cbranch_scc0 L2_d116
    s_mov_b64 exec, s[82:83]
    s_nop 1
    v_mfma_f32_4x4x4_16b_bf16 v[88:91], v[12:13], v[84:85], 0
    s_nop 1
    v_mfma_f32_4x4x4_16b_bf16 v[88:91], v[10:11], v[86:87], v[88:91]
    s_nop 4
    v_cvt_pk_bf16_f32 v88, v88, v89
    v_cvt_pk_bf16_f32 v89, v90, v91
    ds_pk_add_bf16 v7, v88 offset:65408
    ds_pk_add_bf16 v7, v89 offset:65412
    s_mov_b64 exec, s[54:55]
    s_branch L2_d116
L2_c117:
    s_lshl_b64 s[52:53], s[82:83], 1
    s_andn2_b64 s[52:53], s[52:53], s[80:81]
    s_andn2_b64 s[52:53], s[52:53], s[50:51]
    s_or_b64 s[80:81], s[80:81], s[52:53]
    s_not_b64 vcc, s[52:53]
    s_mov_b64 exec, -1
    v_cndmask_b32_dpp v84, v84, v84, vcc wave_shr:1 row_mask:0xf bank_mask:0xf
    v_cndmask_b32_dpp v85, v85, v85, vcc wave_shr:1 row_mask:0xf bank_mask:0xf
    s_lshr_b64 s[52:53], s[52:53], 1
    v_cndmask_b32_dpp v86, v86, v86, vcc wave_shr:1 row_mask:0xf bank_mask:0xf
    v_cndmask_b32_dpp v87, v87, v87, vcc wave_shr:1 row_mask:0xf bank_mask:0xf
    s_andn2_b64 s[82:83], s[82:83], s[52:53]
    v_cndmask_b32_dpp v7, v7, v7, vcc wave_shr:1 row_mask:0xf bank_mask:0xf
    s_mov_b64 exec, s[50:51]
    s_cbranch_scc0 L2_d117
    s_mov_b64 exec, s[82:83]
    s_nop 1
    v_mfma_f32_4x4x4_16b_bf16 v[88:91], v[12:13], v[84:85], 0
    s_nop 1
    v_mfma_f32_4x4x4_16b_bf16 v[88:91], v[10:11], v[86:87], v[88:91]
    s_nop 4
    v_cvt_pk_bf16_f32 v88, v88, v89
    v_cvt_pk_bf16_f32 v89, v90, v91
    ds_pk_add_bf16 v7, v88 offset:65408
    ds_pk_add_bf16 v7, v89 offset:65412
    s_mov_b64 exec, s[50:51]
    s_branch L2_d117
L2_xf115:
    s_cmp_gt_u32 s37, 1024
    s_cbranch_scc1 L2_xt115
    s_cmp_lt_u32 s37, 768
    s_cbranch_scc1 L2_xl115
    ds_read_b32 v33, v44 offset:896
    s_add_u32 s3, s42, 2
    s_bitset1_b32 s43, s3
    s_branch L2_xg115
L2_xl115:
    s_waitcnt lgkmcnt(0)
    v_mov_b32 v42, -1
    s_cmp_ge_u32 s37, 512
    s_cbranch_scc1 L2_xg115
    v_mov_b32 v43, -1
    s_cmp_ge_u32 s37, 256
    s_cbranch_scc1 L2_xg115
    v_mov_b32 v41, -1
    s_branch L2_xg115
L2_xt115:
    s_waitcnt lgkmcnt(0)
    v_mov_b32 v40, -1
    v_mov_b32 v41, -1
    v_mov_b32 v43, -1
    v_mov_b32 v42, -1
    s_add_u32 s3, s42, 2
    s_bitset1_b32 s36, s3
    s_branch L2_xg115
L2_oa118:
    v_and_b32 v47, 0x0fffffff, v32
    buffer_load_dword v114, v47, s[8:11], 0 offen offset:16
    s_mov_b64 exec, s[6:7]
    v_add_u32 v47, 8, v47
    v_lshrrev_b32 v32, 2, v32
    s_mov_b64 exec, -1
    buffer_load_dwordx2 v[112:113], v47, s[8:11], 0 offen
    s_branch L2_ob118
L2_c119:
    s_lshl_b64 s[52:53], s[82:83], 1
    s_andn2_b64 s[52:53], s[52:53], s[80:81]
    s_andn2_b64 s[52:53], s[52:53], s[54:55]
    s_or_b64 s[80:81], s[80:81], s[52:53]
    s_not_b64 vcc, s[52:53]
    s_mov_b64 exec, -1
    v_cndmask_b32_dpp v84, v84, v84, vcc wave_shr:1 row_mask:0xf bank_mask:0xf
    v_cndmask_b32_dpp v85, v85, v85, vcc wave_shr:1 row_mask:0xf bank_mask:0xf
    s_lshr_b64 s[52:53], s[52:53], 1
    v_cndmask_b32_dpp v86, v86, v86, vcc wave_shr:1 row_mask:0xf bank_mask:0xf
    v_cndmask_b32_dpp v87, v87, v87, vcc wave_shr:1 row_mask:0xf bank_mask:0xf
    s_andn2_b64 s[82:83], s[82:83], s[52:53]
    v_cndmask_b32_dpp v7, v7, v7, vcc wave_shr:1 row_mask:0xf bank_mask:0xf
    s_mov_b64 exec, s[54:55]
    s_cbranch_scc0 L2_d119
    s_mov_b64 exec, s[82:83]
    s_nop 1
    v_mfma_f32_4x4x4_16b_bf16 v[88:91], v[12:13], v[84:85], 0
    s_nop 1
    v_mfma_f32_4x4x4_16b_bf16 v[88:91], v[10:11], v[86:87], v[88:91]
    s_nop 4
    v_cvt_pk_bf16_f32 v88, v88, v89
    v_cvt_pk_bf16_f32 v89, v90, v91
    ds_pk_add_bf16 v7, v88 offset:65408
    ds_pk_add_bf16 v7, v89 offset:65412
    s_mov_b64 exec, s[54:55]
    s_branch L2_d119
L2_c120:
    s_lshl_b64 s[52:53], s[82:83], 1
    s_andn2_b64 s[52:53], s[52:53], s[80:81]
    s_andn2_b64 s[52:53], s[52:53], s[50:51]
    s_or_b64 s[80:81], s[80:81], s[52:53]
    s_not_b64 vcc, s[52:53]
    s_mov_b64 exec, -1
    v_cndmask_b32_dpp v84, v84, v84, vcc wave_shr:1 row_mask:0xf bank_mask:0xf
    v_cndmask_b32_dpp v85, v85, v85, vcc wave_shr:1 row_mask:0xf bank_mask:0xf
    s_lshr_b64 s[52:53], s[52:53], 1
    v_cndmask_b32_dpp v86, v86, v86, vcc wave_shr:1 row_mask:0xf bank_mask:0xf
    v_cndmask_b32_dpp v87, v87, v87, vcc wave_shr:1 row_mask:0xf bank_mask:0xf
    s_andn2_b64 s[82:83], s[82:83], s[52:53]
    v_cndmask_b32_dpp v7, v7, v7, vcc wave_shr:1 row_mask:0xf bank_mask:0xf
    s_mov_b64 exec, s[50:51]
    s_cbranch_scc0 L2_d120
    s_mov_b64 exec, s[82:83]
    s_nop 1
    v_mfma_f32_4x4x4_16b_bf16 v[88:91], v[12:13], v[84:85], 0
    s_nop 1
    v_mfma_f32_4x4x4_16b_bf16 v[88:91], v[10:11], v[86:87], v[88:91]
    s_nop 4
    v_cvt_pk_bf16_f32 v88, v88, v89
    v_cvt_pk_bf16_f32 v89, v90, v91
    ds_pk_add_bf16 v7, v88 offset:65408
    ds_pk_add_bf16 v7, v89 offset:65412
    s_mov_b64 exec, s[50:51]
    s_branch L2_d120
L2_c121:
    s_lshl_b64 s[52:53], s[82:83], 1
    s_andn2_b64 s[52:53], s[52:53], s[80:81]
    s_andn2_b64 s[52:53], s[52:53], s[54:55]
    s_or_b64 s[80:81], s[80:81], s[52:53]
    s_not_b64 vcc, s[52:53]
    s_mov_b64 exec, -1
    v_cndmask_b32_dpp v84, v84, v84, vcc wave_shr:1 row_mask:0xf bank_mask:0xf
    v_cndmask_b32_dpp v85, v85, v85, vcc wave_shr:1 row_mask:0xf bank_mask:0xf
    s_lshr_b64 s[52:53], s[52:53], 1
    v_cndmask_b32_dpp v86, v86, v86, vcc wave_shr:1 row_mask:0xf bank_mask:0xf
    v_cndmask_b32_dpp v87, v87, v87, vcc wave_shr:1 row_mask:0xf bank_mask:0xf
    s_andn2_b64 s[82:83], s[82:83], s[52:53]
    v_cndmask_b32_dpp v7, v7, v7, vcc wave_shr:1 row_mask:0xf bank_mask:0xf
    s_mov_b64 exec, s[54:55]
    s_cbranch_scc0 L2_d121
    s_mov_b64 exec, s[82:83]
    s_nop 1
    v_mfma_f32_4x4x4_16b_bf16 v[88:91], v[12:13], v[84:85], 0
    s_nop 1
    v_mfma_f32_4x4x4_16b_bf16 v[88:91], v[10:11], v[86:87], v[88:91]
    s_nop 4
    v_cvt_pk_bf16_f32 v88, v88, v89
    v_cvt_pk_bf16_f32 v89, v90, v91
    ds_pk_add_bf16 v7, v88 offset:65408
    ds_pk_add_bf16 v7, v89 offset:65412
    s_mov_b64 exec, s[54:55]
    s_branch L2_d121
L2_c122:
    s_lshl_b64 s[52:53], s[82:83], 1
    s_andn2_b64 s[52:53], s[52:53], s[80:81]
    s_andn2_b64 s[52:53], s[52:53], s[50:51]
    s_or_b64 s[80:81], s[80:81], s[52:53]
    s_not_b64 vcc, s[52:53]
    s_mov_b64 exec, -1
    v_cndmask_b32_dpp v84, v84, v84, vcc wave_shr:1 row_mask:0xf bank_mask:0xf
    v_cndmask_b32_dpp v85, v85, v85, vcc wave_shr:1 row_mask:0xf bank_mask:0xf
    s_lshr_b64 s[52:53], s[52:53], 1
    v_cndmask_b32_dpp v86, v86, v86, vcc wave_shr:1 row_mask:0xf bank_mask:0xf
    v_cndmask_b32_dpp v87, v87, v87, vcc wave_shr:1 row_mask:0xf bank_mask:0xf
    s_andn2_b64 s[82:83], s[82:83], s[52:53]
    v_cndmask_b32_dpp v7, v7, v7, vcc wave_shr:1 row_mask:0xf bank_mask:0xf
    s_mov_b64 exec, s[50:51]
    s_cbranch_scc0 L2_d122
    s_mov_b64 exec, s[82:83]
    s_nop 1
    v_mfma_f32_4x4x4_16b_bf16 v[88:91], v[12:13], v[84:85], 0
    s_nop 1
    v_mfma_f32_4x4x4_16b_bf16 v[88:91], v[10:11], v[86:87], v[88:91]
    s_nop 4
    v_cvt_pk_bf16_f32 v88, v88, v89
    v_cvt_pk_bf16_f32 v89, v90, v91
    ds_pk_add_bf16 v7, v88 offset:65408
    ds_pk_add_bf16 v7, v89 offset:65412
    s_mov_b64 exec, s[50:51]
    s_branch L2_d122
L2_c123:
    s_lshl_b64 s[52:53], s[82:83], 1
    s_andn2_b64 s[52:53], s[52:53], s[80:81]
    s_andn2_b64 s[52:53], s[52:53], s[54:55]
    s_or_b64 s[80:81], s[80:81], s[52:53]
    s_not_b64 vcc, s[52:53]
    s_mov_b64 exec, -1
    v_cndmask_b32_dpp v84, v84, v84, vcc wave_shr:1 row_mask:0xf bank_mask:0xf
    v_cndmask_b32_dpp v85, v85, v85, vcc wave_shr:1 row_mask:0xf bank_mask:0xf
    s_lshr_b64 s[52:53], s[52:53], 1
    v_cndmask_b32_dpp v86, v86, v86, vcc wave_shr:1 row_mask:0xf bank_mask:0xf
    v_cndmask_b32_dpp v87, v87, v87, vcc wave_shr:1 row_mask:0xf bank_mask:0xf
    s_andn2_b64 s[82:83], s[82:83], s[52:53]
    v_cndmask_b32_dpp v7, v7, v7, vcc wave_shr:1 row_mask:0xf bank_mask:0xf
    s_mov_b64 exec, s[54:55]
    s_cbranch_scc0 L2_d123
    s_mov_b64 exec, s[82:83]
    s_nop 1
    v_mfma_f32_4x4x4_16b_bf16 v[88:91], v[12:13], v[84:85], 0
    s_nop 1
    v_mfma_f32_4x4x4_16b_bf16 v[88:91], v[10:11], v[86:87], v[88:91]
    s_nop 4
    v_cvt_pk_bf16_f32 v88, v88, v89
    v_cvt_pk_bf16_f32 v89, v90, v91
    ds_pk_add_bf16 v7, v88 offset:65408
    ds_pk_add_bf16 v7, v89 offset:65412
    s_mov_b64 exec, s[54:55]
    s_branch L2_d123
L2_c124:
    s_lshl_b64 s[52:53], s[82:83], 1
    s_andn2_b64 s[52:53], s[52:53], s[80:81]
    s_andn2_b64 s[52:53], s[52:53], s[50:51]
    s_or_b64 s[80:81], s[80:81], s[52:53]
    s_not_b64 vcc, s[52:53]
    s_mov_b64 exec, -1
    v_cndmask_b32_dpp v84, v84, v84, vcc wave_shr:1 row_mask:0xf bank_mask:0xf
    v_cndmask_b32_dpp v85, v85, v85, vcc wave_shr:1 row_mask:0xf bank_mask:0xf
    s_lshr_b64 s[52:53], s[52:53], 1
    v_cndmask_b32_dpp v86, v86, v86, vcc wave_shr:1 row_mask:0xf bank_mask:0xf
    v_cndmask_b32_dpp v87, v87, v87, vcc wave_shr:1 row_mask:0xf bank_mask:0xf
    s_andn2_b64 s[82:83], s[82:83], s[52:53]
    v_cndmask_b32_dpp v7, v7, v7, vcc wave_shr:1 row_mask:0xf bank_mask:0xf
    s_mov_b64 exec, s[50:51]
    s_cbranch_scc0 L2_d124
    s_mov_b64 exec, s[82:83]
    s_nop 1
    v_mfma_f32_4x4x4_16b_bf16 v[88:91], v[12:13], v[84:85], 0
    s_nop 1
    v_mfma_f32_4x4x4_16b_bf16 v[88:91], v[10:11], v[86:87], v[88:91]
    s_nop 4
    v_cvt_pk_bf16_f32 v88, v88, v89
    v_cvt_pk_bf16_f32 v89, v90, v91
    ds_pk_add_bf16 v7, v88 offset:65408
    ds_pk_add_bf16 v7, v89 offset:65412
    s_mov_b64 exec, s[50:51]
    s_branch L2_d124
L2_oa125:
    s_waitcnt vmcnt(3)
    s_mov_b64 exec, s[6:7]
    v_lshrrev_b32 v114, 16, v114
    s_mov_b64 exec, -1
    v_and_b32 v46, 0x10000000, v32
    v_cmpx_eq_u32 vcc, 0, v46
    v_lshrrev_b32 v47, 14, v112
    v_and_b32 v47, v5, v47
    ds_read_b64 v[96:97], v47
    v_perm_b32 v98, v112, v114, s44
    v_bitop3_b32 v99, v112, 0.5, -0.5 bitop3:0xa8
    v_bitop3_b32 v98, v6, v98, v99 bitop3:0xca
    v_and_b32 v47, v5, v112
    s_waitcnt lgkmcnt(0)
    v_mfma_f32_4x4x4_16b_bf16 v[88:91], v[8:9], v[96:97], 0
    s_nop 4
    v_mul_f32 v88, v98, v88
    v_mul_f32 v89, v98, v89
    v_mul_f32 v90, v98, v90
    v_mul_f32 v91, v98, v91
    v_cvt_pk_bf16_f32 v88, v88, v89
    v_cvt_pk_bf16_f32 v89, v90, v91
    ds_pk_add_bf16 v47, v88 offset:65408
    ds_pk_add_bf16 v47, v89 offset:65412
    s_mov_b64 exec, -1
    v_and_b32 v46, 0x20000000, v32
    v_cmpx_eq_u32 vcc, 0, v46
    v_lshrrev_b32 v47, 14, v113
    v_and_b32 v47, v5, v47
    ds_read_b64 v[96:97], v47
    v_perm_b32 v98, v113, v114, s45
    v_bitop3_b32 v99, v113, 0.5, -0.5 bitop3:0xa8
    v_bitop3_b32 v98, v6, v98, v99 bitop3:0xca
    v_and_b32 v47, v5, v113
    s_waitcnt lgkmcnt(0)
    v_mfma_f32_4x4x4_16b_bf16 v[88:91], v[8:9], v[96:97], 0
    s_nop 4
    v_mul_f32 v88, v98, v88
    v_mul_f32 v89, v98, v89
    v_mul_f32 v90, v98, v90
    v_mul_f32 v91, v98, v91
    v_cvt_pk_bf16_f32 v88, v88, v89
    v_cvt_pk_bf16_f32 v89, v90, v91
    ds_pk_add_bf16 v47, v88 offset:65408
    ds_pk_add_bf16 v47, v89 offset:65412
    s_mov_b64 exec, -1
    s_branch L2_ob125
L2_c126:
    s_lshl_b64 s[52:53], s[82:83], 1
    s_andn2_b64 s[52:53], s[52:53], s[80:81]
    s_andn2_b64 s[52:53], s[52:53], s[54:55]
    s_or_b64 s[80:81], s[80:81], s[52:53]
    s_not_b64 vcc, s[52:53]
    s_mov_b64 exec, -1
    v_cndmask_b32_dpp v84, v84, v84, vcc wave_shr:1 row_mask:0xf bank_mask:0xf
    v_cndmask_b32_dpp v85, v85, v85, vcc wave_shr:1 row_mask:0xf bank_mask:0xf
    s_lshr_b64 s[52:53], s[52:53], 1
    v_cndmask_b32_dpp v86, v86, v86, vcc wave_shr:1 row_mask:0xf bank_mask:0xf
    v_cndmask_b32_dpp v87, v87, v87, vcc wave_shr:1 row_mask:0xf bank_mask:0xf
    s_andn2_b64 s[82:83], s[82:83], s[52:53]
    v_cndmask_b32_dpp v7, v7, v7, vcc wave_shr:1 row_mask:0xf bank_mask:0xf
    s_mov_b64 exec, s[54:55]
    s_cbranch_scc0 L2_d126
    s_mov_b64 exec, s[82:83]
    s_nop 1
    v_mfma_f32_4x4x4_16b_bf16 v[88:91], v[12:13], v[84:85], 0
    s_nop 1
    v_mfma_f32_4x4x4_16b_bf16 v[88:91], v[10:11], v[86:87], v[88:91]
    s_nop 4
    v_cvt_pk_bf16_f32 v88, v88, v89
    v_cvt_pk_bf16_f32 v89, v90, v91
    ds_pk_add_bf16 v7, v88 offset:65408
    ds_pk_add_bf16 v7, v89 offset:65412
    s_mov_b64 exec, s[54:55]
    s_branch L2_d126
L2_c127:
    s_lshl_b64 s[52:53], s[82:83], 1
    s_andn2_b64 s[52:53], s[52:53], s[80:81]
    s_andn2_b64 s[52:53], s[52:53], s[50:51]
    s_or_b64 s[80:81], s[80:81], s[52:53]
    s_not_b64 vcc, s[52:53]
    s_mov_b64 exec, -1
    v_cndmask_b32_dpp v84, v84, v84, vcc wave_shr:1 row_mask:0xf bank_mask:0xf
    v_cndmask_b32_dpp v85, v85, v85, vcc wave_shr:1 row_mask:0xf bank_mask:0xf
    s_lshr_b64 s[52:53], s[52:53], 1
    v_cndmask_b32_dpp v86, v86, v86, vcc wave_shr:1 row_mask:0xf bank_mask:0xf
    v_cndmask_b32_dpp v87, v87, v87, vcc wave_shr:1 row_mask:0xf bank_mask:0xf
    s_andn2_b64 s[82:83], s[82:83], s[52:53]
    v_cndmask_b32_dpp v7, v7, v7, vcc wave_shr:1 row_mask:0xf bank_mask:0xf
    s_mov_b64 exec, s[50:51]
    s_cbranch_scc0 L2_d127
    s_mov_b64 exec, s[82:83]
    s_nop 1
    v_mfma_f32_4x4x4_16b_bf16 v[88:91], v[12:13], v[84:85], 0
    s_nop 1
    v_mfma_f32_4x4x4_16b_bf16 v[88:91], v[10:11], v[86:87], v[88:91]
    s_nop 4
    v_cvt_pk_bf16_f32 v88, v88, v89
    v_cvt_pk_bf16_f32 v89, v90, v91
    ds_pk_add_bf16 v7, v88 offset:65408
    ds_pk_add_bf16 v7, v89 offset:65412
    s_mov_b64 exec, s[50:51]
    s_branch L2_d127
L2_c128:
    s_lshl_b64 s[52:53], s[82:83], 1
    s_andn2_b64 s[52:53], s[52:53], s[80:81]
    s_andn2_b64 s[52:53], s[52:53], s[54:55]
    s_or_b64 s[80:81], s[80:81], s[52:53]
    s_not_b64 vcc, s[52:53]
    s_mov_b64 exec, -1
    v_cndmask_b32_dpp v84, v84, v84, vcc wave_shr:1 row_mask:0xf bank_mask:0xf
    v_cndmask_b32_dpp v85, v85, v85, vcc wave_shr:1 row_mask:0xf bank_mask:0xf
    s_lshr_b64 s[52:53], s[52:53], 1
    v_cndmask_b32_dpp v86, v86, v86, vcc wave_shr:1 row_mask:0xf bank_mask:0xf
    v_cndmask_b32_dpp v87, v87, v87, vcc wave_shr:1 row_mask:0xf bank_mask:0xf
    s_andn2_b64 s[82:83], s[82:83], s[52:53]
    v_cndmask_b32_dpp v7, v7, v7, vcc wave_shr:1 row_mask:0xf bank_mask:0xf
    s_mov_b64 exec, s[54:55]
    s_cbranch_scc0 L2_d128
    s_mov_b64 exec, s[82:83]
    s_nop 1
    v_mfma_f32_4x4x4_16b_bf16 v[88:91], v[12:13], v[84:85], 0
    s_nop 1
    v_mfma_f32_4x4x4_16b_bf16 v[88:91], v[10:11], v[86:87], v[88:91]
    s_nop 4
    v_cvt_pk_bf16_f32 v88, v88, v89
    v_cvt_pk_bf16_f32 v89, v90, v91
    ds_pk_add_bf16 v7, v88 offset:65408
    ds_pk_add_bf16 v7, v89 offset:65412
    s_mov_b64 exec, s[54:55]
    s_branch L2_d128
L2_c129:
    s_lshl_b64 s[52:53], s[82:83], 1
    s_andn2_b64 s[52:53], s[52:53], s[80:81]
    s_andn2_b64 s[52:53], s[52:53], s[50:51]
    s_or_b64 s[80:81], s[80:81], s[52:53]
    s_not_b64 vcc, s[52:53]
    s_mov_b64 exec, -1
    v_cndmask_b32_dpp v84, v84, v84, vcc wave_shr:1 row_mask:0xf bank_mask:0xf
    v_cndmask_b32_dpp v85, v85, v85, vcc wave_shr:1 row_mask:0xf bank_mask:0xf
    s_lshr_b64 s[52:53], s[52:53], 1
    v_cndmask_b32_dpp v86, v86, v86, vcc wave_shr:1 row_mask:0xf bank_mask:0xf
    v_cndmask_b32_dpp v87, v87, v87, vcc wave_shr:1 row_mask:0xf bank_mask:0xf
    s_andn2_b64 s[82:83], s[82:83], s[52:53]
    v_cndmask_b32_dpp v7, v7, v7, vcc wave_shr:1 row_mask:0xf bank_mask:0xf
    s_mov_b64 exec, s[50:51]
    s_cbranch_scc0 L2_d129
    s_mov_b64 exec, s[82:83]
    s_nop 1
    v_mfma_f32_4x4x4_16b_bf16 v[88:91], v[12:13], v[84:85], 0
    s_nop 1
    v_mfma_f32_4x4x4_16b_bf16 v[88:91], v[10:11], v[86:87], v[88:91]
    s_nop 4
    v_cvt_pk_bf16_f32 v88, v88, v89
    v_cvt_pk_bf16_f32 v89, v90, v91
    ds_pk_add_bf16 v7, v88 offset:65408
    ds_pk_add_bf16 v7, v89 offset:65412
    s_mov_b64 exec, s[50:51]
    s_branch L2_d129
L2_c130:
    s_lshl_b64 s[52:53], s[82:83], 1
    s_andn2_b64 s[52:53], s[52:53], s[80:81]
    s_andn2_b64 s[52:53], s[52:53], s[54:55]
    s_or_b64 s[80:81], s[80:81], s[52:53]
    s_not_b64 vcc, s[52:53]
    s_mov_b64 exec, -1
    v_cndmask_b32_dpp v84, v84, v84, vcc wave_shr:1 row_mask:0xf bank_mask:0xf
    v_cndmask_b32_dpp v85, v85, v85, vcc wave_shr:1 row_mask:0xf bank_mask:0xf
    s_lshr_b64 s[52:53], s[52:53], 1
    v_cndmask_b32_dpp v86, v86, v86, vcc wave_shr:1 row_mask:0xf bank_mask:0xf
    v_cndmask_b32_dpp v87, v87, v87, vcc wave_shr:1 row_mask:0xf bank_mask:0xf
    s_andn2_b64 s[82:83], s[82:83], s[52:53]
    v_cndmask_b32_dpp v7, v7, v7, vcc wave_shr:1 row_mask:0xf bank_mask:0xf
    s_mov_b64 exec, s[54:55]
    s_cbranch_scc0 L2_d130
    s_mov_b64 exec, s[82:83]
    s_nop 1
    v_mfma_f32_4x4x4_16b_bf16 v[88:91], v[12:13], v[84:85], 0
    s_nop 1
    v_mfma_f32_4x4x4_16b_bf16 v[88:91], v[10:11], v[86:87], v[88:91]
    s_nop 4
    v_cvt_pk_bf16_f32 v88, v88, v89
    v_cvt_pk_bf16_f32 v89, v90, v91
    ds_pk_add_bf16 v7, v88 offset:65408
    ds_pk_add_bf16 v7, v89 offset:65412
    s_mov_b64 exec, s[54:55]
    s_branch L2_d130
L2_c131:
    s_lshl_b64 s[52:53], s[82:83], 1
    s_andn2_b64 s[52:53], s[52:53], s[80:81]
    s_andn2_b64 s[52:53], s[52:53], s[50:51]
    s_or_b64 s[80:81], s[80:81], s[52:53]
    s_not_b64 vcc, s[52:53]
    s_mov_b64 exec, -1
    v_cndmask_b32_dpp v84, v84, v84, vcc wave_shr:1 row_mask:0xf bank_mask:0xf
    v_cndmask_b32_dpp v85, v85, v85, vcc wave_shr:1 row_mask:0xf bank_mask:0xf
    s_lshr_b64 s[52:53], s[52:53], 1
    v_cndmask_b32_dpp v86, v86, v86, vcc wave_shr:1 row_mask:0xf bank_mask:0xf
    v_cndmask_b32_dpp v87, v87, v87, vcc wave_shr:1 row_mask:0xf bank_mask:0xf
    s_andn2_b64 s[82:83], s[82:83], s[52:53]
    v_cndmask_b32_dpp v7, v7, v7, vcc wave_shr:1 row_mask:0xf bank_mask:0xf
    s_mov_b64 exec, s[50:51]
    s_cbranch_scc0 L2_d131
    s_mov_b64 exec, s[82:83]
    s_nop 1
    v_mfma_f32_4x4x4_16b_bf16 v[88:91], v[12:13], v[84:85], 0
    s_nop 1
    v_mfma_f32_4x4x4_16b_bf16 v[88:91], v[10:11], v[86:87], v[88:91]
    s_nop 4
    v_cvt_pk_bf16_f32 v88, v88, v89
    v_cvt_pk_bf16_f32 v89, v90, v91
    ds_pk_add_bf16 v7, v88 offset:65408
    ds_pk_add_bf16 v7, v89 offset:65412
    s_mov_b64 exec, s[50:51]
    s_branch L2_d131
L2_c132:
    s_lshl_b64 s[52:53], s[82:83], 1
    s_andn2_b64 s[52:53], s[52:53], s[80:81]
    s_andn2_b64 s[52:53], s[52:53], s[54:55]
    s_or_b64 s[80:81], s[80:81], s[52:53]
    s_not_b64 vcc, s[52:53]
    s_mov_b64 exec, -1
    v_cndmask_b32_dpp v84, v84, v84, vcc wave_shr:1 row_mask:0xf bank_mask:0xf
    v_cndmask_b32_dpp v85, v85, v85, vcc wave_shr:1 row_mask:0xf bank_mask:0xf
    s_lshr_b64 s[52:53], s[52:53], 1
    v_cndmask_b32_dpp v86, v86, v86, vcc wave_shr:1 row_mask:0xf bank_mask:0xf
    v_cndmask_b32_dpp v87, v87, v87, vcc wave_shr:1 row_mask:0xf bank_mask:0xf
    s_andn2_b64 s[82:83], s[82:83], s[52:53]
    v_cndmask_b32_dpp v7, v7, v7, vcc wave_shr:1 row_mask:0xf bank_mask:0xf
    s_mov_b64 exec, s[54:55]
    s_cbranch_scc0 L2_d132
    s_mov_b64 exec, s[82:83]
    s_nop 1
    v_mfma_f32_4x4x4_16b_bf16 v[88:91], v[12:13], v[84:85], 0
    s_nop 1
    v_mfma_f32_4x4x4_16b_bf16 v[88:91], v[10:11], v[86:87], v[88:91]
    s_nop 4
    v_cvt_pk_bf16_f32 v88, v88, v89
    v_cvt_pk_bf16_f32 v89, v90, v91
    ds_pk_add_bf16 v7, v88 offset:65408
    ds_pk_add_bf16 v7, v89 offset:65412
    s_mov_b64 exec, s[54:55]
    s_branch L2_d132
L2_c133:
    s_lshl_b64 s[52:53], s[82:83], 1
    s_andn2_b64 s[52:53], s[52:53], s[80:81]
    s_andn2_b64 s[52:53], s[52:53], s[50:51]
    s_or_b64 s[80:81], s[80:81], s[52:53]
    s_not_b64 vcc, s[52:53]
    s_mov_b64 exec, -1
    v_cndmask_b32_dpp v84, v84, v84, vcc wave_shr:1 row_mask:0xf bank_mask:0xf
    v_cndmask_b32_dpp v85, v85, v85, vcc wave_shr:1 row_mask:0xf bank_mask:0xf
    s_lshr_b64 s[52:53], s[52:53], 1
    v_cndmask_b32_dpp v86, v86, v86, vcc wave_shr:1 row_mask:0xf bank_mask:0xf
    v_cndmask_b32_dpp v87, v87, v87, vcc wave_shr:1 row_mask:0xf bank_mask:0xf
    s_andn2_b64 s[82:83], s[82:83], s[52:53]
    v_cndmask_b32_dpp v7, v7, v7, vcc wave_shr:1 row_mask:0xf bank_mask:0xf
    s_mov_b64 exec, s[50:51]
    s_cbranch_scc0 L2_d133
    s_mov_b64 exec, s[82:83]
    s_nop 1
    v_mfma_f32_4x4x4_16b_bf16 v[88:91], v[12:13], v[84:85], 0
    s_nop 1
    v_mfma_f32_4x4x4_16b_bf16 v[88:91], v[10:11], v[86:87], v[88:91]
    s_nop 4
    v_cvt_pk_bf16_f32 v88, v88, v89
    v_cvt_pk_bf16_f32 v89, v90, v91
    ds_pk_add_bf16 v7, v88 offset:65408
    ds_pk_add_bf16 v7, v89 offset:65412
    s_mov_b64 exec, s[50:51]
    s_branch L2_d133
L2_oa134:
    v_and_b32 v47, 0x0fffffff, v33
    buffer_load_dword v114, v47, s[8:11], 0 offen offset:16
    s_mov_b64 exec, s[6:7]
    v_add_u32 v47, 8, v47
    v_lshrrev_b32 v33, 2, v33
    s_mov_b64 exec, -1
    buffer_load_dwordx2 v[112:113], v47, s[8:11], 0 offen
    s_branch L2_ob134
L2_c135:
    s_lshl_b64 s[52:53], s[82:83], 1
    s_andn2_b64 s[52:53], s[52:53], s[80:81]
    s_andn2_b64 s[52:53], s[52:53], s[54:55]
    s_or_b64 s[80:81], s[80:81], s[52:53]
    s_not_b64 vcc, s[52:53]
    s_mov_b64 exec, -1
    v_cndmask_b32_dpp v84, v84, v84, vcc wave_shr:1 row_mask:0xf bank_mask:0xf
    v_cndmask_b32_dpp v85, v85, v85, vcc wave_shr:1 row_mask:0xf bank_mask:0xf
    s_lshr_b64 s[52:53], s[52:53], 1
    v_cndmask_b32_dpp v86, v86, v86, vcc wave_shr:1 row_mask:0xf bank_mask:0xf
    v_cndmask_b32_dpp v87, v87, v87, vcc wave_shr:1 row_mask:0xf bank_mask:0xf
    s_andn2_b64 s[82:83], s[82:83], s[52:53]
    v_cndmask_b32_dpp v7, v7, v7, vcc wave_shr:1 row_mask:0xf bank_mask:0xf
    s_mov_b64 exec, s[54:55]
    s_cbranch_scc0 L2_d135
    s_mov_b64 exec, s[82:83]
    s_nop 1
    v_mfma_f32_4x4x4_16b_bf16 v[88:91], v[12:13], v[84:85], 0
    s_nop 1
    v_mfma_f32_4x4x4_16b_bf16 v[88:91], v[10:11], v[86:87], v[88:91]
    s_nop 4
    v_cvt_pk_bf16_f32 v88, v88, v89
    v_cvt_pk_bf16_f32 v89, v90, v91
    ds_pk_add_bf16 v7, v88 offset:65408
    ds_pk_add_bf16 v7, v89 offset:65412
    s_mov_b64 exec, s[54:55]
    s_branch L2_d135
L2_c136:
    s_lshl_b64 s[52:53], s[82:83], 1
    s_andn2_b64 s[52:53], s[52:53], s[80:81]
    s_andn2_b64 s[52:53], s[52:53], s[50:51]
    s_or_b64 s[80:81], s[80:81], s[52:53]
    s_not_b64 vcc, s[52:53]
    s_mov_b64 exec, -1
    v_cndmask_b32_dpp v84, v84, v84, vcc wave_shr:1 row_mask:0xf bank_mask:0xf
    v_cndmask_b32_dpp v85, v85, v85, vcc wave_shr:1 row_mask:0xf bank_mask:0xf
    s_lshr_b64 s[52:53], s[52:53], 1
    v_cndmask_b32_dpp v86, v86, v86, vcc wave_shr:1 row_mask:0xf bank_mask:0xf
    v_cndmask_b32_dpp v87, v87, v87, vcc wave_shr:1 row_mask:0xf bank_mask:0xf
    s_andn2_b64 s[82:83], s[82:83], s[52:53]
    v_cndmask_b32_dpp v7, v7, v7, vcc wave_shr:1 row_mask:0xf bank_mask:0xf
    s_mov_b64 exec, s[50:51]
    s_cbranch_scc0 L2_d136
    s_mov_b64 exec, s[82:83]
    s_nop 1
    v_mfma_f32_4x4x4_16b_bf16 v[88:91], v[12:13], v[84:85], 0
    s_nop 1
    v_mfma_f32_4x4x4_16b_bf16 v[88:91], v[10:11], v[86:87], v[88:91]
    s_nop 4
    v_cvt_pk_bf16_f32 v88, v88, v89
    v_cvt_pk_bf16_f32 v89, v90, v91
    ds_pk_add_bf16 v7, v88 offset:65408
    ds_pk_add_bf16 v7, v89 offset:65412
    s_mov_b64 exec, s[50:51]
    s_branch L2_d136
L2_c137:
    s_lshl_b64 s[52:53], s[82:83], 1
    s_andn2_b64 s[52:53], s[52:53], s[80:81]
    s_andn2_b64 s[52:53], s[52:53], s[54:55]
    s_or_b64 s[80:81], s[80:81], s[52:53]
    s_not_b64 vcc, s[52:53]
    s_mov_b64 exec, -1
    v_cndmask_b32_dpp v84, v84, v84, vcc wave_shr:1 row_mask:0xf bank_mask:0xf
    v_cndmask_b32_dpp v85, v85, v85, vcc wave_shr:1 row_mask:0xf bank_mask:0xf
    s_lshr_b64 s[52:53], s[52:53], 1
    v_cndmask_b32_dpp v86, v86, v86, vcc wave_shr:1 row_mask:0xf bank_mask:0xf
    v_cndmask_b32_dpp v87, v87, v87, vcc wave_shr:1 row_mask:0xf bank_mask:0xf
    s_andn2_b64 s[82:83], s[82:83], s[52:53]
    v_cndmask_b32_dpp v7, v7, v7, vcc wave_shr:1 row_mask:0xf bank_mask:0xf
    s_mov_b64 exec, s[54:55]
    s_cbranch_scc0 L2_d137
    s_mov_b64 exec, s[82:83]
    s_nop 1
    v_mfma_f32_4x4x4_16b_bf16 v[88:91], v[12:13], v[84:85], 0
    s_nop 1
    v_mfma_f32_4x4x4_16b_bf16 v[88:91], v[10:11], v[86:87], v[88:91]
    s_nop 4
    v_cvt_pk_bf16_f32 v88, v88, v89
    v_cvt_pk_bf16_f32 v89, v90, v91
    ds_pk_add_bf16 v7, v88 offset:65408
    ds_pk_add_bf16 v7, v89 offset:65412
    s_mov_b64 exec, s[54:55]
    s_branch L2_d137
L2_c138:
    s_lshl_b64 s[52:53], s[82:83], 1
    s_andn2_b64 s[52:53], s[52:53], s[80:81]
    s_andn2_b64 s[52:53], s[52:53], s[50:51]
    s_or_b64 s[80:81], s[80:81], s[52:53]
    s_not_b64 vcc, s[52:53]
    s_mov_b64 exec, -1
    v_cndmask_b32_dpp v84, v84, v84, vcc wave_shr:1 row_mask:0xf bank_mask:0xf
    v_cndmask_b32_dpp v85, v85, v85, vcc wave_shr:1 row_mask:0xf bank_mask:0xf
    s_lshr_b64 s[52:53], s[52:53], 1
    v_cndmask_b32_dpp v86, v86, v86, vcc wave_shr:1 row_mask:0xf bank_mask:0xf
    v_cndmask_b32_dpp v87, v87, v87, vcc wave_shr:1 row_mask:0xf bank_mask:0xf
    s_andn2_b64 s[82:83], s[82:83], s[52:53]
    v_cndmask_b32_dpp v7, v7, v7, vcc wave_shr:1 row_mask:0xf bank_mask:0xf
    s_mov_b64 exec, s[50:51]
    s_cbranch_scc0 L2_d138
    s_mov_b64 exec, s[82:83]
    s_nop 1
    v_mfma_f32_4x4x4_16b_bf16 v[88:91], v[12:13], v[84:85], 0
    s_nop 1
    v_mfma_f32_4x4x4_16b_bf16 v[88:91], v[10:11], v[86:87], v[88:91]
    s_nop 4
    v_cvt_pk_bf16_f32 v88, v88, v89
    v_cvt_pk_bf16_f32 v89, v90, v91
    ds_pk_add_bf16 v7, v88 offset:65408
    ds_pk_add_bf16 v7, v89 offset:65412
    s_mov_b64 exec, s[50:51]
    s_branch L2_d138
L2_c139:
    s_lshl_b64 s[52:53], s[82:83], 1
    s_andn2_b64 s[52:53], s[52:53], s[80:81]
    s_andn2_b64 s[52:53], s[52:53], s[54:55]
    s_or_b64 s[80:81], s[80:81], s[52:53]
    s_not_b64 vcc, s[52:53]
    s_mov_b64 exec, -1
    v_cndmask_b32_dpp v84, v84, v84, vcc wave_shr:1 row_mask:0xf bank_mask:0xf
    v_cndmask_b32_dpp v85, v85, v85, vcc wave_shr:1 row_mask:0xf bank_mask:0xf
    s_lshr_b64 s[52:53], s[52:53], 1
    v_cndmask_b32_dpp v86, v86, v86, vcc wave_shr:1 row_mask:0xf bank_mask:0xf
    v_cndmask_b32_dpp v87, v87, v87, vcc wave_shr:1 row_mask:0xf bank_mask:0xf
    s_andn2_b64 s[82:83], s[82:83], s[52:53]
    v_cndmask_b32_dpp v7, v7, v7, vcc wave_shr:1 row_mask:0xf bank_mask:0xf
    s_mov_b64 exec, s[54:55]
    s_cbranch_scc0 L2_d139
    s_mov_b64 exec, s[82:83]
    s_nop 1
    v_mfma_f32_4x4x4_16b_bf16 v[88:91], v[12:13], v[84:85], 0
    s_nop 1
    v_mfma_f32_4x4x4_16b_bf16 v[88:91], v[10:11], v[86:87], v[88:91]
    s_nop 4
    v_cvt_pk_bf16_f32 v88, v88, v89
    v_cvt_pk_bf16_f32 v89, v90, v91
    ds_pk_add_bf16 v7, v88 offset:65408
    ds_pk_add_bf16 v7, v89 offset:65412
    s_mov_b64 exec, s[54:55]
    s_branch L2_d139
L2_c140:
    s_lshl_b64 s[52:53], s[82:83], 1
    s_andn2_b64 s[52:53], s[52:53], s[80:81]
    s_andn2_b64 s[52:53], s[52:53], s[50:51]
    s_or_b64 s[80:81], s[80:81], s[52:53]
    s_not_b64 vcc, s[52:53]
    s_mov_b64 exec, -1
    v_cndmask_b32_dpp v84, v84, v84, vcc wave_shr:1 row_mask:0xf bank_mask:0xf
    v_cndmask_b32_dpp v85, v85, v85, vcc wave_shr:1 row_mask:0xf bank_mask:0xf
    s_lshr_b64 s[52:53], s[52:53], 1
    v_cndmask_b32_dpp v86, v86, v86, vcc wave_shr:1 row_mask:0xf bank_mask:0xf
    v_cndmask_b32_dpp v87, v87, v87, vcc wave_shr:1 row_mask:0xf bank_mask:0xf
    s_andn2_b64 s[82:83], s[82:83], s[52:53]
    v_cndmask_b32_dpp v7, v7, v7, vcc wave_shr:1 row_mask:0xf bank_mask:0xf
    s_mov_b64 exec, s[50:51]
    s_cbranch_scc0 L2_d140
    s_mov_b64 exec, s[82:83]
    s_nop 1
    v_mfma_f32_4x4x4_16b_bf16 v[88:91], v[12:13], v[84:85], 0
    s_nop 1
    v_mfma_f32_4x4x4_16b_bf16 v[88:91], v[10:11], v[86:87], v[88:91]
    s_nop 4
    v_cvt_pk_bf16_f32 v88, v88, v89
    v_cvt_pk_bf16_f32 v89, v90, v91
    ds_pk_add_bf16 v7, v88 offset:65408
    ds_pk_add_bf16 v7, v89 offset:65412
    s_mov_b64 exec, s[50:51]
    s_branch L2_d140
L2_oa141:
    s_waitcnt vmcnt(7)
    s_mov_b64 exec, s[6:7]
    v_lshrrev_b32 v114, 16, v114
    s_mov_b64 exec, -1
    v_and_b32 v46, 0x10000000, v33
    v_cmpx_eq_u32 vcc, 0, v46
    v_lshrrev_b32 v47, 14, v112
    v_and_b32 v47, v5, v47
    ds_read_b64 v[96:97], v47
    v_perm_b32 v98, v112, v114, s44
    v_bitop3_b32 v99, v112, 0.5, -0.5 bitop3:0xa8
    v_bitop3_b32 v98, v6, v98, v99 bitop3:0xca
    v_and_b32 v47, v5, v112
    s_waitcnt lgkmcnt(0)
    v_mfma_f32_4x4x4_16b_bf16 v[88:91], v[8:9], v[96:97], 0
    s_nop 4
    v_mul_f32 v88, v98, v88
    v_mul_f32 v89, v98, v89
    v_mul_f32 v90, v98, v90
    v_mul_f32 v91, v98, v91
    v_cvt_pk_bf16_f32 v88, v88, v89
    v_cvt_pk_bf16_f32 v89, v90, v91
    ds_pk_add_bf16 v47, v88 offset:65408
    ds_pk_add_bf16 v47, v89 offset:65412
    s_mov_b64 exec, -1
    v_and_b32 v46, 0x20000000, v33
    v_cmpx_eq_u32 vcc, 0, v46
    v_lshrrev_b32 v47, 14, v113
    v_and_b32 v47, v5, v47
    ds_read_b64 v[96:97], v47
    v_perm_b32 v98, v113, v114, s45
    v_bitop3_b32 v99, v113, 0.5, -0.5 bitop3:0xa8
    v_bitop3_b32 v98, v6, v98, v99 bitop3:0xca
    v_and_b32 v47, v5, v113
    s_waitcnt lgkmcnt(0)
    v_mfma_f32_4x4x4_16b_bf16 v[88:91], v[8:9], v[96:97], 0
    s_nop 4
    v_mul_f32 v88, v98, v88
    v_mul_f32 v89, v98, v89
    v_mul_f32 v90, v98, v90
    v_mul_f32 v91, v98, v91
    v_cvt_pk_bf16_f32 v88, v88, v89
    v_cvt_pk_bf16_f32 v89, v90, v91
    ds_pk_add_bf16 v47, v88 offset:65408
    ds_pk_add_bf16 v47, v89 offset:65412
    s_mov_b64 exec, -1
    s_branch L2_ob141
L2_c142:
    s_lshl_b64 s[52:53], s[82:83], 1
    s_andn2_b64 s[52:53], s[52:53], s[80:81]
    s_andn2_b64 s[52:53], s[52:53], s[54:55]
    s_or_b64 s[80:81], s[80:81], s[52:53]
    s_not_b64 vcc, s[52:53]
    s_mov_b64 exec, -1
    v_cndmask_b32_dpp v84, v84, v84, vcc wave_shr:1 row_mask:0xf bank_mask:0xf
    v_cndmask_b32_dpp v85, v85, v85, vcc wave_shr:1 row_mask:0xf bank_mask:0xf
    s_lshr_b64 s[52:53], s[52:53], 1
    v_cndmask_b32_dpp v86, v86, v86, vcc wave_shr:1 row_mask:0xf bank_mask:0xf
    v_cndmask_b32_dpp v87, v87, v87, vcc wave_shr:1 row_mask:0xf bank_mask:0xf
    s_andn2_b64 s[82:83], s[82:83], s[52:53]
    v_cndmask_b32_dpp v7, v7, v7, vcc wave_shr:1 row_mask:0xf bank_mask:0xf
    s_mov_b64 exec, s[54:55]
    s_cbranch_scc0 L2_d142
    s_mov_b64 exec, s[82:83]
    s_nop 1
    v_mfma_f32_4x4x4_16b_bf16 v[88:91], v[12:13], v[84:85], 0
    s_nop 1
    v_mfma_f32_4x4x4_16b_bf16 v[88:91], v[10:11], v[86:87], v[88:91]
    s_nop 4
    v_cvt_pk_bf16_f32 v88, v88, v89
    v_cvt_pk_bf16_f32 v89, v90, v91
    ds_pk_add_bf16 v7, v88 offset:65408
    ds_pk_add_bf16 v7, v89 offset:65412
    s_mov_b64 exec, s[54:55]
    s_branch L2_d142
L2_c143:
    s_lshl_b64 s[52:53], s[82:83], 1
    s_andn2_b64 s[52:53], s[52:53], s[80:81]
    s_andn2_b64 s[52:53], s[52:53], s[50:51]
    s_or_b64 s[80:81], s[80:81], s[52:53]
    s_not_b64 vcc, s[52:53]
    s_mov_b64 exec, -1
    v_cndmask_b32_dpp v84, v84, v84, vcc wave_shr:1 row_mask:0xf bank_mask:0xf
    v_cndmask_b32_dpp v85, v85, v85, vcc wave_shr:1 row_mask:0xf bank_mask:0xf
    s_lshr_b64 s[52:53], s[52:53], 1
    v_cndmask_b32_dpp v86, v86, v86, vcc wave_shr:1 row_mask:0xf bank_mask:0xf
    v_cndmask_b32_dpp v87, v87, v87, vcc wave_shr:1 row_mask:0xf bank_mask:0xf
    s_andn2_b64 s[82:83], s[82:83], s[52:53]
    v_cndmask_b32_dpp v7, v7, v7, vcc wave_shr:1 row_mask:0xf bank_mask:0xf
    s_mov_b64 exec, s[50:51]
    s_cbranch_scc0 L2_d143
    s_mov_b64 exec, s[82:83]
    s_nop 1
    v_mfma_f32_4x4x4_16b_bf16 v[88:91], v[12:13], v[84:85], 0
    s_nop 1
    v_mfma_f32_4x4x4_16b_bf16 v[88:91], v[10:11], v[86:87], v[88:91]
    s_nop 4
    v_cvt_pk_bf16_f32 v88, v88, v89
    v_cvt_pk_bf16_f32 v89, v90, v91
    ds_pk_add_bf16 v7, v88 offset:65408
    ds_pk_add_bf16 v7, v89 offset:65412
    s_mov_b64 exec, s[50:51]
    s_branch L2_d143
L2_c144:
    s_lshl_b64 s[52:53], s[82:83], 1
    s_andn2_b64 s[52:53], s[52:53], s[80:81]
    s_andn2_b64 s[52:53], s[52:53], s[54:55]
    s_or_b64 s[80:81], s[80:81], s[52:53]
    s_not_b64 vcc, s[52:53]
    s_mov_b64 exec, -1
    v_cndmask_b32_dpp v84, v84, v84, vcc wave_shr:1 row_mask:0xf bank_mask:0xf
    v_cndmask_b32_dpp v85, v85, v85, vcc wave_shr:1 row_mask:0xf bank_mask:0xf
    s_lshr_b64 s[52:53], s[52:53], 1
    v_cndmask_b32_dpp v86, v86, v86, vcc wave_shr:1 row_mask:0xf bank_mask:0xf
    v_cndmask_b32_dpp v87, v87, v87, vcc wave_shr:1 row_mask:0xf bank_mask:0xf
    s_andn2_b64 s[82:83], s[82:83], s[52:53]
    v_cndmask_b32_dpp v7, v7, v7, vcc wave_shr:1 row_mask:0xf bank_mask:0xf
    s_mov_b64 exec, s[54:55]
    s_cbranch_scc0 L2_d144
    s_mov_b64 exec, s[82:83]
    s_nop 1
    v_mfma_f32_4x4x4_16b_bf16 v[88:91], v[12:13], v[84:85], 0
    s_nop 1
    v_mfma_f32_4x4x4_16b_bf16 v[88:91], v[10:11], v[86:87], v[88:91]
    s_nop 4
    v_cvt_pk_bf16_f32 v88, v88, v89
    v_cvt_pk_bf16_f32 v89, v90, v91
    ds_pk_add_bf16 v7, v88 offset:65408
    ds_pk_add_bf16 v7, v89 offset:65412
    s_mov_b64 exec, s[54:55]
    s_branch L2_d144
L2_c145:
    s_lshl_b64 s[52:53], s[82:83], 1
    s_andn2_b64 s[52:53], s[52:53], s[80:81]
    s_andn2_b64 s[52:53], s[52:53], s[50:51]
    s_or_b64 s[80:81], s[80:81], s[52:53]
    s_not_b64 vcc, s[52:53]
    s_mov_b64 exec, -1
    v_cndmask_b32_dpp v84, v84, v84, vcc wave_shr:1 row_mask:0xf bank_mask:0xf
    v_cndmask_b32_dpp v85, v85, v85, vcc wave_shr:1 row_mask:0xf bank_mask:0xf
    s_lshr_b64 s[52:53], s[52:53], 1
    v_cndmask_b32_dpp v86, v86, v86, vcc wave_shr:1 row_mask:0xf bank_mask:0xf
    v_cndmask_b32_dpp v87, v87, v87, vcc wave_shr:1 row_mask:0xf bank_mask:0xf
    s_andn2_b64 s[82:83], s[82:83], s[52:53]
    v_cndmask_b32_dpp v7, v7, v7, vcc wave_shr:1 row_mask:0xf bank_mask:0xf
    s_mov_b64 exec, s[50:51]
    s_cbranch_scc0 L2_d145
    s_mov_b64 exec, s[82:83]
    s_nop 1
    v_mfma_f32_4x4x4_16b_bf16 v[88:91], v[12:13], v[84:85], 0
    s_nop 1
    v_mfma_f32_4x4x4_16b_bf16 v[88:91], v[10:11], v[86:87], v[88:91]
    s_nop 4
    v_cvt_pk_bf16_f32 v88, v88, v89
    v_cvt_pk_bf16_f32 v89, v90, v91
    ds_pk_add_bf16 v7, v88 offset:65408
    ds_pk_add_bf16 v7, v89 offset:65412
    s_mov_b64 exec, s[50:51]
    s_branch L2_d145
L2_c146:
    s_lshl_b64 s[52:53], s[82:83], 1
    s_andn2_b64 s[52:53], s[52:53], s[80:81]
    s_andn2_b64 s[52:53], s[52:53], s[54:55]
    s_or_b64 s[80:81], s[80:81], s[52:53]
    s_not_b64 vcc, s[52:53]
    s_mov_b64 exec, -1
    v_cndmask_b32_dpp v84, v84, v84, vcc wave_shr:1 row_mask:0xf bank_mask:0xf
    v_cndmask_b32_dpp v85, v85, v85, vcc wave_shr:1 row_mask:0xf bank_mask:0xf
    s_lshr_b64 s[52:53], s[52:53], 1
    v_cndmask_b32_dpp v86, v86, v86, vcc wave_shr:1 row_mask:0xf bank_mask:0xf
    v_cndmask_b32_dpp v87, v87, v87, vcc wave_shr:1 row_mask:0xf bank_mask:0xf
    s_andn2_b64 s[82:83], s[82:83], s[52:53]
    v_cndmask_b32_dpp v7, v7, v7, vcc wave_shr:1 row_mask:0xf bank_mask:0xf
    s_mov_b64 exec, s[54:55]
    s_cbranch_scc0 L2_d146
    s_mov_b64 exec, s[82:83]
    s_nop 1
    v_mfma_f32_4x4x4_16b_bf16 v[88:91], v[12:13], v[84:85], 0
    s_nop 1
    v_mfma_f32_4x4x4_16b_bf16 v[88:91], v[10:11], v[86:87], v[88:91]
    s_nop 4
    v_cvt_pk_bf16_f32 v88, v88, v89
    v_cvt_pk_bf16_f32 v89, v90, v91
    ds_pk_add_bf16 v7, v88 offset:65408
    ds_pk_add_bf16 v7, v89 offset:65412
    s_mov_b64 exec, s[54:55]
    s_branch L2_d146
L2_c147:
    s_lshl_b64 s[52:53], s[82:83], 1
    s_andn2_b64 s[52:53], s[52:53], s[80:81]
    s_andn2_b64 s[52:53], s[52:53], s[50:51]
    s_or_b64 s[80:81], s[80:81], s[52:53]
    s_not_b64 vcc, s[52:53]
    s_mov_b64 exec, -1
    v_cndmask_b32_dpp v84, v84, v84, vcc wave_shr:1 row_mask:0xf bank_mask:0xf
    v_cndmask_b32_dpp v85, v85, v85, vcc wave_shr:1 row_mask:0xf bank_mask:0xf
    s_lshr_b64 s[52:53], s[52:53], 1
    v_cndmask_b32_dpp v86, v86, v86, vcc wave_shr:1 row_mask:0xf bank_mask:0xf
    v_cndmask_b32_dpp v87, v87, v87, vcc wave_shr:1 row_mask:0xf bank_mask:0xf
    s_andn2_b64 s[82:83], s[82:83], s[52:53]
    v_cndmask_b32_dpp v7, v7, v7, vcc wave_shr:1 row_mask:0xf bank_mask:0xf
    s_mov_b64 exec, s[50:51]
    s_cbranch_scc0 L2_d147
    s_mov_b64 exec, s[82:83]
    s_nop 1
    v_mfma_f32_4x4x4_16b_bf16 v[88:91], v[12:13], v[84:85], 0
    s_nop 1
    v_mfma_f32_4x4x4_16b_bf16 v[88:91], v[10:11], v[86:87], v[88:91]
    s_nop 4
    v_cvt_pk_bf16_f32 v88, v88, v89
    v_cvt_pk_bf16_f32 v89, v90, v91
    ds_pk_add_bf16 v7, v88 offset:65408
    ds_pk_add_bf16 v7, v89 offset:65412
    s_mov_b64 exec, s[50:51]
    s_branch L2_d147
L2_c148:
    s_lshl_b64 s[52:53], s[82:83], 1
    s_andn2_b64 s[52:53], s[52:53], s[80:81]
    s_andn2_b64 s[52:53], s[52:53], s[54:55]
    s_or_b64 s[80:81], s[80:81], s[52:53]
    s_not_b64 vcc, s[52:53]
    s_mov_b64 exec, -1
    v_cndmask_b32_dpp v84, v84, v84, vcc wave_shr:1 row_mask:0xf bank_mask:0xf
    v_cndmask_b32_dpp v85, v85, v85, vcc wave_shr:1 row_mask:0xf bank_mask:0xf
    s_lshr_b64 s[52:53], s[52:53], 1
    v_cndmask_b32_dpp v86, v86, v86, vcc wave_shr:1 row_mask:0xf bank_mask:0xf
    v_cndmask_b32_dpp v87, v87, v87, vcc wave_shr:1 row_mask:0xf bank_mask:0xf
    s_andn2_b64 s[82:83], s[82:83], s[52:53]
    v_cndmask_b32_dpp v7, v7, v7, vcc wave_shr:1 row_mask:0xf bank_mask:0xf
    s_mov_b64 exec, s[54:55]
    s_cbranch_scc0 L2_d148
    s_mov_b64 exec, s[82:83]
    s_nop 1
    v_mfma_f32_4x4x4_16b_bf16 v[88:91], v[12:13], v[84:85], 0
    s_nop 1
    v_mfma_f32_4x4x4_16b_bf16 v[88:91], v[10:11], v[86:87], v[88:91]
    s_nop 4
    v_cvt_pk_bf16_f32 v88, v88, v89
    v_cvt_pk_bf16_f32 v89, v90, v91
    ds_pk_add_bf16 v7, v88 offset:65408
    ds_pk_add_bf16 v7, v89 offset:65412
    s_mov_b64 exec, s[54:55]
    s_branch L2_d148
L2_c149:
    s_lshl_b64 s[52:53], s[82:83], 1
    s_andn2_b64 s[52:53], s[52:53], s[80:81]
    s_andn2_b64 s[52:53], s[52:53], s[50:51]
    s_or_b64 s[80:81], s[80:81], s[52:53]
    s_not_b64 vcc, s[52:53]
    s_mov_b64 exec, -1
    v_cndmask_b32_dpp v84, v84, v84, vcc wave_shr:1 row_mask:0xf bank_mask:0xf
    v_cndmask_b32_dpp v85, v85, v85, vcc wave_shr:1 row_mask:0xf bank_mask:0xf
    s_lshr_b64 s[52:53], s[52:53], 1
    v_cndmask_b32_dpp v86, v86, v86, vcc wave_shr:1 row_mask:0xf bank_mask:0xf
    v_cndmask_b32_dpp v87, v87, v87, vcc wave_shr:1 row_mask:0xf bank_mask:0xf
    s_andn2_b64 s[82:83], s[82:83], s[52:53]
    v_cndmask_b32_dpp v7, v7, v7, vcc wave_shr:1 row_mask:0xf bank_mask:0xf
    s_mov_b64 exec, s[50:51]
    s_cbranch_scc0 L2_d149
    s_mov_b64 exec, s[82:83]
    s_nop 1
    v_mfma_f32_4x4x4_16b_bf16 v[88:91], v[12:13], v[84:85], 0
    s_nop 1
    v_mfma_f32_4x4x4_16b_bf16 v[88:91], v[10:11], v[86:87], v[88:91]
    s_nop 4
    v_cvt_pk_bf16_f32 v88, v88, v89
    v_cvt_pk_bf16_f32 v89, v90, v91
    ds_pk_add_bf16 v7, v88 offset:65408
    ds_pk_add_bf16 v7, v89 offset:65412
    s_mov_b64 exec, s[50:51]
    s_branch L2_d149
L2_c150:
    s_lshl_b64 s[52:53], s[82:83], 1
    s_andn2_b64 s[52:53], s[52:53], s[80:81]
    s_andn2_b64 s[52:53], s[52:53], s[54:55]
    s_or_b64 s[80:81], s[80:81], s[52:53]
    s_not_b64 vcc, s[52:53]
    s_mov_b64 exec, -1
    v_cndmask_b32_dpp v84, v84, v84, vcc wave_shr:1 row_mask:0xf bank_mask:0xf
    v_cndmask_b32_dpp v85, v85, v85, vcc wave_shr:1 row_mask:0xf bank_mask:0xf
    s_lshr_b64 s[52:53], s[52:53], 1
    v_cndmask_b32_dpp v86, v86, v86, vcc wave_shr:1 row_mask:0xf bank_mask:0xf
    v_cndmask_b32_dpp v87, v87, v87, vcc wave_shr:1 row_mask:0xf bank_mask:0xf
    s_andn2_b64 s[82:83], s[82:83], s[52:53]
    v_cndmask_b32_dpp v7, v7, v7, vcc wave_shr:1 row_mask:0xf bank_mask:0xf
    s_mov_b64 exec, s[54:55]
    s_cbranch_scc0 L2_d150
    s_mov_b64 exec, s[82:83]
    s_nop 1
    v_mfma_f32_4x4x4_16b_bf16 v[88:91], v[12:13], v[84:85], 0
    s_nop 1
    v_mfma_f32_4x4x4_16b_bf16 v[88:91], v[10:11], v[86:87], v[88:91]
    s_nop 4
    v_cvt_pk_bf16_f32 v88, v88, v89
    v_cvt_pk_bf16_f32 v89, v90, v91
    ds_pk_add_bf16 v7, v88 offset:65408
    ds_pk_add_bf16 v7, v89 offset:65412
    s_mov_b64 exec, s[54:55]
    s_branch L2_d150
L2_c151:
    s_lshl_b64 s[52:53], s[82:83], 1
    s_andn2_b64 s[52:53], s[52:53], s[80:81]
    s_andn2_b64 s[52:53], s[52:53], s[50:51]
    s_or_b64 s[80:81], s[80:81], s[52:53]
    s_not_b64 vcc, s[52:53]
    s_mov_b64 exec, -1
    v_cndmask_b32_dpp v84, v84, v84, vcc wave_shr:1 row_mask:0xf bank_mask:0xf
    v_cndmask_b32_dpp v85, v85, v85, vcc wave_shr:1 row_mask:0xf bank_mask:0xf
    s_lshr_b64 s[52:53], s[52:53], 1
    v_cndmask_b32_dpp v86, v86, v86, vcc wave_shr:1 row_mask:0xf bank_mask:0xf
    v_cndmask_b32_dpp v87, v87, v87, vcc wave_shr:1 row_mask:0xf bank_mask:0xf
    s_andn2_b64 s[82:83], s[82:83], s[52:53]
    v_cndmask_b32_dpp v7, v7, v7, vcc wave_shr:1 row_mask:0xf bank_mask:0xf
    s_mov_b64 exec, s[50:51]
    s_cbranch_scc0 L2_d151
    s_mov_b64 exec, s[82:83]
    s_nop 1
    v_mfma_f32_4x4x4_16b_bf16 v[88:91], v[12:13], v[84:85], 0
    s_nop 1
    v_mfma_f32_4x4x4_16b_bf16 v[88:91], v[10:11], v[86:87], v[88:91]
    s_nop 4
    v_cvt_pk_bf16_f32 v88, v88, v89
    v_cvt_pk_bf16_f32 v89, v90, v91
    ds_pk_add_bf16 v7, v88 offset:65408
    ds_pk_add_bf16 v7, v89 offset:65412
    s_mov_b64 exec, s[50:51]
    s_branch L2_d151
L2_c152:
    s_mov_b64 s[50:51], vcc
    s_lshl_b64 s[52:53], s[82:83], 1
    s_andn2_b64 s[52:53], s[52:53], s[80:81]
    s_andn2_b64 s[52:53], s[52:53], s[50:51]
    s_or_b64 s[80:81], s[80:81], s[52:53]
    s_not_b64 vcc, s[52:53]
    s_mov_b64 exec, -1
    v_cndmask_b32_dpp v84, v84, v84, vcc wave_shr:1 row_mask:0xf bank_mask:0xf
    v_cndmask_b32_dpp v85, v85, v85, vcc wave_shr:1 row_mask:0xf bank_mask:0xf
    s_lshr_b64 s[52:53], s[52:53], 1
    v_cndmask_b32_dpp v86, v86, v86, vcc wave_shr:1 row_mask:0xf bank_mask:0xf
    v_cndmask_b32_dpp v87, v87, v87, vcc wave_shr:1 row_mask:0xf bank_mask:0xf
    s_andn2_b64 s[82:83], s[82:83], s[52:53]
    v_cndmask_b32_dpp v7, v7, v7, vcc wave_shr:1 row_mask:0xf bank_mask:0xf
    s_mov_b64 vcc, s[50:51]
    s_mov_b64 exec, s[50:51]
    s_cbranch_scc0 L2_d152
    s_mov_b64 exec, s[82:83]
    s_nop 1
    v_mfma_f32_4x4x4_16b_bf16 v[88:91], v[12:13], v[84:85], 0
    s_nop 1
    v_mfma_f32_4x4x4_16b_bf16 v[88:91], v[10:11], v[86:87], v[88:91]
    s_nop 4
    v_cvt_pk_bf16_f32 v88, v88, v89
    v_cvt_pk_bf16_f32 v89, v90, v91
    ds_pk_add_bf16 v7, v88 offset:65408
    ds_pk_add_bf16 v7, v89 offset:65412
    s_mov_b64 exec, vcc
    s_branch L2_d152
L2_c153:
    s_mov_b64 s[50:51], vcc
    s_lshl_b64 s[52:53], s[82:83], 1
    s_andn2_b64 s[52:53], s[52:53], s[80:81]
    s_andn2_b64 s[52:53], s[52:53], s[50:51]
    s_or_b64 s[80:81], s[80:81], s[52:53]
    s_not_b64 vcc, s[52:53]
    s_mov_b64 exec, -1
    v_cndmask_b32_dpp v84, v84, v84, vcc wave_shr:1 row_mask:0xf bank_mask:0xf
    v_cndmask_b32_dpp v85, v85, v85, vcc wave_shr:1 row_mask:0xf bank_mask:0xf
    s_lshr_b64 s[52:53], s[52:53], 1
    v_cndmask_b32_dpp v86, v86, v86, vcc wave_shr:1 row_mask:0xf bank_mask:0xf
    v_cndmask_b32_dpp v87, v87, v87, vcc wave_shr:1 row_mask:0xf bank_mask:0xf
    s_andn2_b64 s[82:83], s[82:83], s[52:53]
    v_cndmask_b32_dpp v7, v7, v7, vcc wave_shr:1 row_mask:0xf bank_mask:0xf
    s_mov_b64 vcc, s[50:51]
    s_mov_b64 exec, s[50:51]
    s_cbranch_scc0 L2_d153
    s_mov_b64 exec, s[82:83]
    s_nop 1
    v_mfma_f32_4x4x4_16b_bf16 v[88:91], v[12:13], v[84:85], 0
    s_nop 1
    v_mfma_f32_4x4x4_16b_bf16 v[88:91], v[10:11], v[86:87], v[88:91]
    s_nop 4
    v_cvt_pk_bf16_f32 v88, v88, v89
    v_cvt_pk_bf16_f32 v89, v90, v91
    ds_pk_add_bf16 v7, v88 offset:65408
    ds_pk_add_bf16 v7, v89 offset:65412
    s_mov_b64 exec, vcc
    s_branch L2_d153
L2_f3s:
    s_branch L2_f3
.section .rodata,"a"
.p2align 6
.amdhsa_kernel gather_scatter__molecular_angular_gemnet__graph_kernel
  .amdhsa_next_free_vgpr 128
  .amdhsa_next_free_sgpr 102
  .amdhsa_accum_offset 128
  .amdhsa_group_segment_fixed_size 0
  .amdhsa_kernarg_size 112
  .amdhsa_user_sgpr_count 2
  .amdhsa_user_sgpr_kernarg_segment_ptr 1
  .amdhsa_system_sgpr_workgroup_id_x 1
  .amdhsa_float_denorm_mode_32 3
.end_amdhsa_kernel
```

```asm
; @launch grid=(256,1,1) block=(1024,1,1) lds=163840
.amdgcn_target "amdgcn-amd-amdhsa--gfx950"
.text
.globl gather_scatter__molecular_angular_gemnet__graph_kernel
.p2align 8
.type gather_scatter__molecular_angular_gemnet__graph_kernel,@function
gather_scatter__molecular_angular_gemnet__graph_kernel:
    s_cmp_ge_u32 s2, 256
    s_cbranch_scc0 L1_go
    s_endpgm
L1_go:
    s_load_dwordx2 s[8:9], s[0:1], 8
    s_load_dwordx2 s[12:13], s[0:1], 16
    s_load_dwordx2 s[16:17], s[0:1], 32
    s_load_dwordx2 s[30:31], s[0:1], 104
    s_load_dwordx2 s[56:57], s[0:1], 96
    s_load_dwordx2 s[86:87], s[0:1], 0
    s_load_dwordx4 s[60:63], s[0:1], 56
    s_load_dwordx4 s[64:67], s[0:1], 72
    v_lshrrev_b32 v7, 6, v0
    v_lshlrev_b32 v1, 3, v0
    v_readfirstlane_b32 s32, v7
    v_lshlrev_b32 v0, 4, v0
    v_and_b32 v1, 0x1f8, v1
    s_lshr_b32 s3, s32, 1
    s_and_b32 s44, s32, 1
    s_lshl_b32 s44, s44, 3
    s_or_b32 s3, s3, s44
    s_lshl_b32 s3, s3, 10
    s_lshl_b32 s96, s2, 14
    s_add_u32 s96, s96, s3
    s_mov_b32 s10, 0x9c40000
    s_mov_b32 s11, 0x20000
    s_mov_b32 s14, 0x9c40000
    s_mov_b32 s15, 0x20000
    s_mov_b32 s18, 0x4e20000
    s_mov_b32 s19, 0x20000
    s_waitcnt lgkmcnt(0)
    s_add_u32 s44, s96, 0x0
    v_lshlrev_b32 v16, 1, v1
    buffer_load_dwordx4 v[16:19], v16, s[8:11], s44 offen nt
    s_add_u32 s45, s96, 0x0
    v_lshlrev_b32 v20, 1, v1
    buffer_load_dwordx4 v[20:23], v20, s[12:15], s45 offen nt
    s_add_u32 s46, s96, 0x0
    s_lshr_b32 s46, s46, 1
    buffer_load_dwordx2 v[24:25], v1, s[16:19], s46 offen nt
    s_add_u32 s47, s96, 0x400000
    s_lshr_b32 s47, s47, 1
    buffer_load_dwordx2 v[26:27], v1, s[16:19], s47 offen nt
    s_add_u32 s44, s96, 0x400000
    v_lshlrev_b32 v28, 1, v1
    buffer_load_dwordx4 v[28:31], v28, s[8:11], s44 offen nt
    s_add_u32 s45, s96, 0x400000
    v_lshlrev_b32 v32, 1, v1
    buffer_load_dwordx4 v[32:35], v32, s[12:15], s45 offen nt
    s_add_u32 s46, s96, 0x800000
    v_lshlrev_b32 v36, 1, v1
    buffer_load_dwordx4 v[36:39], v36, s[8:11], s46 offen nt
    s_add_u32 s47, s96, 0x800000
    v_lshlrev_b32 v40, 1, v1
    buffer_load_dwordx4 v[40:43], v40, s[12:15], s47 offen nt
    s_add_u32 s44, s96, 0x800000
    s_lshr_b32 s44, s44, 1
    buffer_load_dwordx2 v[44:45], v1, s[16:19], s44 offen nt
    s_add_u32 s45, s96, 0xc00000
    s_lshr_b32 s45, s45, 1
    buffer_load_dwordx2 v[46:47], v1, s[16:19], s45 offen nt
    s_mov_b32 s68, s62
    s_mov_b32 s69, s63
    s_mov_b32 s70, 0x40
    s_mov_b32 s71, 0x20000
    s_mov_b32 s72, s60
    s_mov_b32 s73, s61
    s_mov_b32 s74, 0x40
    s_mov_b32 s75, 0x20000
    s_mov_b32 s20, s66
    s_mov_b32 s21, s67
    s_mov_b32 s22, 0x20
    s_mov_b32 s23, 0x20000
    s_mov_b32 s80, s64
    s_mov_b32 s81, s65
    s_mov_b32 s82, 0x20
    s_mov_b32 s83, 0x20000
    s_add_u32 s24, s30, 0xec54000
    s_addc_u32 s25, s31, 0
    s_mov_b32 s26, 0x100
    s_mov_b32 s27, 0x20000
    v_lshrrev_b32 v2, 3, v0
    v_and_b32 v2, 6, v2
    v_lshlrev_b32 v3, 2, v0
    s_lshl_b32 s3, s32, 8
    s_add_u32 s3, s3, s2
    s_cmp_lg_u32 s3, 254
    s_cbranch_scc1 L1_wt
    buffer_load_ushort v116, v2, s[68:71], 0 offen offset:0
    buffer_load_ushort v108, v2, s[68:71], 0 offen offset:8
    buffer_load_ushort v117, v2, s[68:71], 0 offen offset:16
    buffer_load_ushort v109, v2, s[68:71], 0 offen offset:24
    buffer_load_ushort v118, v2, s[68:71], 0 offen offset:32
    buffer_load_ushort v110, v2, s[68:71], 0 offen offset:40
    buffer_load_ushort v119, v2, s[68:71], 0 offen offset:48
    buffer_load_ushort v111, v2, s[68:71], 0 offen offset:56
    buffer_load_ushort v120, v2, s[72:75], 0 offen offset:0
    buffer_load_ushort v100, v2, s[72:75], 0 offen offset:8
    buffer_load_ushort v121, v2, s[72:75], 0 offen offset:16
    buffer_load_ushort v101, v2, s[72:75], 0 offen offset:24
    buffer_load_ushort v122, v2, s[72:75], 0 offen offset:32
    buffer_load_ushort v102, v2, s[72:75], 0 offen offset:40
    buffer_load_ushort v123, v2, s[72:75], 0 offen offset:48
    buffer_load_ushort v103, v2, s[72:75], 0 offen offset:56
    buffer_load_ushort v124, v2, s[20:23], 0 offen offset:0
    buffer_load_ushort v112, v2, s[20:23], 0 offen offset:8
    buffer_load_ushort v125, v2, s[20:23], 0 offen offset:16
    buffer_load_ushort v113, v2, s[20:23], 0 offen offset:24
    buffer_load_ushort v126, v2, s[80:83], 0 offen offset:0
    buffer_load_ushort v114, v2, s[80:83], 0 offen offset:8
    buffer_load_ushort v127, v2, s[80:83], 0 offen offset:16
    buffer_load_ushort v115, v2, s[80:83], 0 offen offset:24
    s_waitcnt vmcnt(0)
    v_lshl_or_b32 v116, v108, 16, v116
    v_lshl_or_b32 v117, v109, 16, v117
    v_lshl_or_b32 v118, v110, 16, v118
    v_lshl_or_b32 v119, v111, 16, v119
    v_lshl_or_b32 v120, v100, 16, v120
    v_lshl_or_b32 v121, v101, 16, v121
    v_lshl_or_b32 v122, v102, 16, v122
    v_lshl_or_b32 v123, v103, 16, v123
    v_lshl_or_b32 v124, v112, 16, v124
    v_lshl_or_b32 v125, v113, 16, v125
    v_lshl_or_b32 v126, v114, 16, v126
    v_lshl_or_b32 v127, v115, 16, v127
    buffer_store_dwordx4 v[116:119], v3, s[24:27], 0 offen offset:0 sc1
    buffer_store_dwordx4 v[120:123], v3, s[24:27], 0 offen offset:16 sc1
    buffer_store_dwordx4 v[124:127], v3, s[24:27], 0 offen offset:32 sc1
L1_wt:
    s_mov_b32 s20, s30
    s_mov_b32 s21, s31
    s_mov_b32 s22, 0xd344000
    s_mov_b32 s23, 0x20000
    s_add_u32 s24, s30, 0x2c000
    s_addc_u32 s25, s31, 0
    s_mov_b32 s26, 0xd318000
    s_mov_b32 s27, 0x20000
    s_add_u32 s3, s32, 0
    s_mul_i32 s4, s3, 205
    s_lshr_b32 s4, s4, 10
    s_mul_i32 s5, s4, 5
    s_sub_u32 s5, s3, s5
    s_lshl_b32 s5, s5, 5
    s_add_u32 s4, s4, s5
    s_sub_u32 s4, s4, s32
    s_lshl_b32 s72, s4, 10
    s_add_u32 s3, s32, 16
    s_mul_i32 s4, s3, 205
    s_lshr_b32 s4, s4, 10
    s_mul_i32 s5, s4, 5
    s_sub_u32 s5, s3, s5
    s_lshl_b32 s5, s5, 5
    s_add_u32 s4, s4, s5
    s_sub_u32 s4, s4, s32
    s_lshl_b32 s73, s4, 10
    s_add_u32 s3, s32, 32
    s_mul_i32 s4, s3, 205
    s_lshr_b32 s4, s4, 10
    s_mul_i32 s5, s4, 5
    s_sub_u32 s5, s3, s5
    s_lshl_b32 s5, s5, 5
    s_add_u32 s4, s4, s5
    s_sub_u32 s4, s4, s32
    s_lshl_b32 s85, s4, 10
    s_add_u32 s3, s32, 48
    s_mul_i32 s4, s3, 205
    s_lshr_b32 s4, s4, 10
    s_mul_i32 s5, s4, 5
    s_sub_u32 s5, s3, s5
    s_lshl_b32 s5, s5, 5
    s_add_u32 s4, s4, s5
    s_sub_u32 s4, s4, s32
    s_lshl_b32 s91, s4, 10
    s_add_u32 s3, s32, 64
    s_mul_i32 s4, s3, 205
    s_lshr_b32 s4, s4, 10
    s_mul_i32 s5, s4, 5
    s_sub_u32 s5, s3, s5
    s_lshl_b32 s5, s5, 5
    s_add_u32 s4, s4, s5
    s_sub_u32 s4, s4, s32
    s_lshl_b32 s93, s4, 10
    s_mov_b32 s80, s86
    s_mov_b32 s81, s87
    s_mov_b32 s82, 0x4e2000
    s_mov_b32 s83, 0x20000
    s_mul_i32 s35, s2, 173056
    s_and_b32 s37, s32, 3
    s_lshl_b32 s37, s37, 3
    s_mov_b32 s36, s37
    s_lshr_b32 s37, s32, 2
    s_mul_i32 s37, s37, 2080
    s_add_u32 s36, s36, s37
    s_and_b32 s37, s2, 3
    s_lshl_b32 s37, s37, 5
    s_add_u32 s36, s36, s37
    s_mul_i32 s4, s2, 5
    s_add_u32 s4, s4, 8192
    s_lshl_b32 s38, s4, 14
    s_lshl_b32 s39, s4, 13
    v_mov_b32 v2, 1
    v_mov_b32 v4, 0x80000007
    v_mov_b32 v5, 0xfc
    v_mov_b32 v6, 0x78
    s_mov_b32 s40, 16512
    s_mov_b32 s55, -10000
    s_mov_b32 s41, 0x010c0c01
    s_mov_b32 s42, 0x030c0c03
    v_mov_b32 v8, 0
    v_mov_b32 v9, 0
    v_mov_b32 v10, 0
    v_mov_b32 v11, 0
    ds_write_b128 v0, v[8:11]
    s_add_u32 s60, s30, 0xec5d000
    s_addc_u32 s61, s31, 0
    s_mov_b32 s62, 0x8000
    s_mov_b32 s63, 0x20000
    s_mov_b64 s[66:67], s[56:57]
    s_lshl_b32 s57, s2, 7
    s_add_u32 s68, s30, 0xec55000
    s_addc_u32 s69, s31, 0
    s_mov_b32 s70, 0x80
    s_mov_b32 s71, 0x20000
    s_lshl_b32 s3, s2, 7
    s_add_u32 s68, s68, s3
    s_addc_u32 s69, s69, 0
    s_cmp_lg_u32 s32, 0
    s_cbranch_scc1 L1_fl
    buffer_store_dwordx4 v[8:11], v0, s[68:71], 0 offen sc1
    s_mov_b64 exec, 0xff
    buffer_store_dwordx4 v[8:11], v0, s[60:63], s57 offen sc1
    s_mov_b64 exec, -1
L1_fl:
    s_waitcnt lgkmcnt(0)
    s_barrier
    s_setprio 3
    s_add_u32 s46, s96, 0xc00000
    v_lshlrev_b32 v48, 1, v1
    buffer_load_dwordx4 v[48:51], v48, s[8:11], s46 offen nt
    s_add_u32 s47, s96, 0xc00000
    v_lshlrev_b32 v52, 1, v1
    buffer_load_dwordx4 v[52:55], v52, s[12:15], s47 offen nt
    s_waitcnt vmcnt(8)
    v_lshlrev_b32 v7, 16, v24
    v_and_b32 v8, 0xffff0000, v24
    v_lshlrev_b32 v9, 16, v25
    v_and_b32 v10, 0xffff0000, v25
    v_mul_f32 v7, 0.15915494, v7
    v_mul_f32 v8, 0.15915494, v8
    v_mul_f32 v9, 0.15915494, v9
    v_mul_f32 v10, 0.15915494, v10
    v_mul_hi_u32_u24 v14, 429497, v16
    v_lshrrev_b32 v12, 3, v20
    v_cos_f32 v7, v7
    v_lshlrev_b16 v13, 3, v20
    v_mad_i32_i24 v11, v14, s55, v16
    v_bitop3_b32 v12, v6, v13, v12 bitop3:0xca
    v_lshl_add_u32 v11, v11, 17, s40
    v_lshlrev_b16 v14, 8, v14
    v_lshrrev_b32 v13, 2, v20
    v_add_u32 v16, v12, v11
    v_bitop3_b32 v20, v5, v13, v14 bitop3:0xea
    ds_add_u32 v20, v2
    v_mul_hi_u32_u24 v14, 429497, v17
    v_lshrrev_b32 v12, 3, v21
    v_cos_f32 v8, v8
    v_lshlrev_b16 v13, 3, v21
    v_mad_i32_i24 v11, v14, s55, v17
    v_bitop3_b32 v12, v6, v13, v12 bitop3:0xca
    v_lshl_add_u32 v11, v11, 17, s40
    v_lshlrev_b16 v14, 8, v14
    v_lshrrev_b32 v13, 2, v21
    v_add_u32 v17, v12, v11
    v_bitop3_b32 v21, v5, v13, v14 bitop3:0xea
    ds_add_u32 v21, v2
    v_cvt_pk_bf16_f32 v24, v7, v8
    v_perm_b32 v12, v24, v24, s41
    v_bitop3_b32 v16, v4, v12, v16 bitop3:0xca
    v_perm_b32 v13, v24, v24, s42
    v_bitop3_b32 v17, v4, v13, v17 bitop3:0xca
    v_mul_hi_u32_u24 v14, 429497, v18
    v_lshrrev_b32 v12, 3, v22
    v_cos_f32 v9, v9
    v_lshlrev_b16 v13, 3, v22
    v_mad_i32_i24 v11, v14, s55, v18
    v_bitop3_b32 v12, v6, v13, v12 bitop3:0xca
    v_lshl_add_u32 v11, v11, 17, s40
    v_lshlrev_b16 v14, 8, v14
    v_lshrrev_b32 v13, 2, v22
    v_add_u32 v18, v12, v11
    v_bitop3_b32 v22, v5, v13, v14 bitop3:0xea
    ds_add_u32 v22, v2
    v_mul_hi_u32_u24 v14, 429497, v19
    v_lshrrev_b32 v12, 3, v23
    v_cos_f32 v10, v10
    v_lshlrev_b16 v13, 3, v23
    v_mad_i32_i24 v11, v14, s55, v19
    v_bitop3_b32 v12, v6, v13, v12 bitop3:0xca
    v_lshl_add_u32 v11, v11, 17, s40
    v_lshlrev_b16 v14, 8, v14
    v_lshrrev_b32 v13, 2, v23
    v_add_u32 v19, v12, v11
    v_bitop3_b32 v23, v5, v13, v14 bitop3:0xea
    ds_add_u32 v23, v2
    v_cvt_pk_bf16_f32 v25, v9, v10
    v_perm_b32 v12, v25, v25, s41
    v_bitop3_b32 v18, v4, v12, v18 bitop3:0xca
    v_perm_b32 v13, v25, v25, s42
    v_bitop3_b32 v19, v4, v13, v19 bitop3:0xca
    s_add_u32 s44, s96, 0x1000000
    v_lshlrev_b32 v56, 1, v1
    buffer_load_dwordx4 v[56:59], v56, s[8:11], s44 offen nt
    s_add_u32 s45, s96, 0x1000000
    v_lshlrev_b32 v60, 1, v1
    buffer_load_dwordx4 v[60:63], v60, s[12:15], s45 offen nt
    s_add_u32 s46, s96, 0x1000000
    s_lshr_b32 s46, s46, 1
    buffer_load_dwordx2 v[64:65], v1, s[16:19], s46 offen nt
    s_add_u32 s47, s96, 0x1400000
    s_lshr_b32 s47, s47, 1
    buffer_load_dwordx2 v[66:67], v1, s[16:19], s47 offen nt
    s_waitcnt vmcnt(10)
    v_lshlrev_b32 v7, 16, v26
    v_and_b32 v8, 0xffff0000, v26
    v_lshlrev_b32 v9, 16, v27
    v_and_b32 v10, 0xffff0000, v27
    v_mul_f32 v7, 0.15915494, v7
    v_mul_f32 v8, 0.15915494, v8
    v_mul_f32 v9, 0.15915494, v9
    v_mul_f32 v10, 0.15915494, v10
    v_mul_hi_u32_u24 v14, 429497, v28
    v_lshrrev_b32 v12, 3, v32
    v_cos_f32 v7, v7
    v_lshlrev_b16 v13, 3, v32
    v_mad_i32_i24 v11, v14, s55, v28
    v_bitop3_b32 v12, v6, v13, v12 bitop3:0xca
    v_lshl_add_u32 v11, v11, 17, s40
    v_lshlrev_b16 v14, 8, v14
    v_lshrrev_b32 v13, 2, v32
    v_add_u32 v28, v12, v11
    v_bitop3_b32 v32, v5, v13, v14 bitop3:0xea
    ds_add_u32 v32, v2
    v_mul_hi_u32_u24 v14, 429497, v29
    v_lshrrev_b32 v12, 3, v33
    v_cos_f32 v8, v8
    v_lshlrev_b16 v13, 3, v33
    v_mad_i32_i24 v11, v14, s55, v29
    v_bitop3_b32 v12, v6, v13, v12 bitop3:0xca
    v_lshl_add_u32 v11, v11, 17, s40
    v_lshlrev_b16 v14, 8, v14
    v_lshrrev_b32 v13, 2, v33
    v_add_u32 v29, v12, v11
    v_bitop3_b32 v33, v5, v13, v14 bitop3:0xea
    ds_add_u32 v33, v2
    v_cvt_pk_bf16_f32 v26, v7, v8
    v_perm_b32 v12, v26, v26, s41
    v_bitop3_b32 v28, v4, v12, v28 bitop3:0xca
    v_perm_b32 v13, v26, v26, s42
    v_bitop3_b32 v29, v4, v13, v29 bitop3:0xca
    v_mul_hi_u32_u24 v14, 429497, v30
    v_lshrrev_b32 v12, 3, v34
    v_cos_f32 v9, v9
    v_lshlrev_b16 v13, 3, v34
    v_mad_i32_i24 v11, v14, s55, v30
    v_bitop3_b32 v12, v6, v13, v12 bitop3:0xca
    v_lshl_add_u32 v11, v11, 17, s40
    v_lshlrev_b16 v14, 8, v14
    v_lshrrev_b32 v13, 2, v34
    v_add_u32 v30, v12, v11
    v_bitop3_b32 v34, v5, v13, v14 bitop3:0xea
    ds_add_u32 v34, v2
    v_mul_hi_u32_u24 v14, 429497, v31
    v_lshrrev_b32 v12, 3, v35
    v_cos_f32 v10, v10
    v_lshlrev_b16 v13, 3, v35
    v_mad_i32_i24 v11, v14, s55, v31
    v_bitop3_b32 v12, v6, v13, v12 bitop3:0xca
    v_lshl_add_u32 v11, v11, 17, s40
    v_lshlrev_b16 v14, 8, v14
    v_lshrrev_b32 v13, 2, v35
    v_add_u32 v31, v12, v11
    v_bitop3_b32 v35, v5, v13, v14 bitop3:0xea
    ds_add_u32 v35, v2
    v_cvt_pk_bf16_f32 v27, v9, v10
    v_perm_b32 v12, v27, v27, s41
    v_bitop3_b32 v30, v4, v12, v30 bitop3:0xca
    v_perm_b32 v13, v27, v27, s42
    v_bitop3_b32 v31, v4, v13, v31 bitop3:0xca
    s_setprio 2
    s_add_u32 s44, s96, 0x1400000
    v_lshlrev_b32 v68, 1, v1
    buffer_load_dwordx4 v[68:71], v68, s[8:11], s44 offen nt
    s_add_u32 s45, s96, 0x1400000
    v_lshlrev_b32 v72, 1, v1
    buffer_load_dwordx4 v[72:75], v72, s[12:15], s45 offen nt
    s_waitcnt vmcnt(8)
    v_lshlrev_b32 v7, 16, v44
    v_and_b32 v8, 0xffff0000, v44
    v_lshlrev_b32 v9, 16, v45
    v_and_b32 v10, 0xffff0000, v45
    v_mul_f32 v7, 0.15915494, v7
    v_mul_f32 v8, 0.15915494, v8
    v_mul_f32 v9, 0.15915494, v9
    v_mul_f32 v10, 0.15915494, v10
    v_mul_hi_u32_u24 v14, 429497, v36
    v_lshrrev_b32 v12, 3, v40
    v_cos_f32 v7, v7
    v_lshlrev_b16 v13, 3, v40
    v_mad_i32_i24 v11, v14, s55, v36
    v_bitop3_b32 v12, v6, v13, v12 bitop3:0xca
    v_lshl_add_u32 v11, v11, 17, s40
    v_lshlrev_b16 v14, 8, v14
    v_lshrrev_b32 v13, 2, v40
    v_add_u32 v36, v12, v11
    v_bitop3_b32 v40, v5, v13, v14 bitop3:0xea
    ds_add_u32 v40, v2
    v_mul_hi_u32_u24 v14, 429497, v37
    v_lshrrev_b32 v12, 3, v41
    v_cos_f32 v8, v8
    v_lshlrev_b16 v13, 3, v41
    v_mad_i32_i24 v11, v14, s55, v37
    v_bitop3_b32 v12, v6, v13, v12 bitop3:0xca
    v_lshl_add_u32 v11, v11, 17, s40
    v_lshlrev_b16 v14, 8, v14
    v_lshrrev_b32 v13, 2, v41
    v_add_u32 v37, v12, v11
    v_bitop3_b32 v41, v5, v13, v14 bitop3:0xea
    ds_add_u32 v41, v2
    v_cvt_pk_bf16_f32 v44, v7, v8
    v_perm_b32 v12, v44, v44, s41
    v_bitop3_b32 v36, v4, v12, v36 bitop3:0xca
    v_perm_b32 v13, v44, v44, s42
    v_bitop3_b32 v37, v4, v13, v37 bitop3:0xca
    v_mul_hi_u32_u24 v14, 429497, v38
    v_lshrrev_b32 v12, 3, v42
    v_cos_f32 v9, v9
    v_lshlrev_b16 v13, 3, v42
    v_mad_i32_i24 v11, v14, s55, v38
    v_bitop3_b32 v12, v6, v13, v12 bitop3:0xca
    v_lshl_add_u32 v11, v11, 17, s40
    v_lshlrev_b16 v14, 8, v14
    v_lshrrev_b32 v13, 2, v42
    v_add_u32 v38, v12, v11
    v_bitop3_b32 v42, v5, v13, v14 bitop3:0xea
    ds_add_u32 v42, v2
    v_mul_hi_u32_u24 v14, 429497, v39
    v_lshrrev_b32 v12, 3, v43
    v_cos_f32 v10, v10
    v_lshlrev_b16 v13, 3, v43
    v_mad_i32_i24 v11, v14, s55, v39
    v_bitop3_b32 v12, v6, v13, v12 bitop3:0xca
    v_lshl_add_u32 v11, v11, 17, s40
    v_lshlrev_b16 v14, 8, v14
    v_lshrrev_b32 v13, 2, v43
    v_add_u32 v39, v12, v11
    v_bitop3_b32 v43, v5, v13, v14 bitop3:0xea
    ds_add_u32 v43, v2
    v_cvt_pk_bf16_f32 v45, v9, v10
    v_perm_b32 v12, v45, v45, s41
    v_bitop3_b32 v38, v4, v12, v38 bitop3:0xca
    v_perm_b32 v13, v45, v45, s42
    v_bitop3_b32 v39, v4, v13, v39 bitop3:0xca
    s_add_u32 s46, s96, 0x1800000
    v_lshlrev_b32 v76, 1, v1
    buffer_load_dwordx4 v[76:79], v76, s[8:11], s46 offen nt
    s_add_u32 s47, s96, 0x1800000
    v_lshlrev_b32 v80, 1, v1
    buffer_load_dwordx4 v[80:83], v80, s[12:15], s47 offen nt
    s_add_u32 s44, s96, 0x1800000
    s_lshr_b32 s44, s44, 1
    buffer_load_dwordx2 v[84:85], v1, s[16:19], s44 offen nt
    s_add_u32 s45, s96, 0x1c00000
    s_lshr_b32 s45, s45, 1
    buffer_load_dwordx2 v[86:87], v1, s[16:19], s45 offen nt
    s_waitcnt vmcnt(10)
    v_lshlrev_b32 v7, 16, v46
    v_and_b32 v8, 0xffff0000, v46
    v_lshlrev_b32 v9, 16, v47
    v_and_b32 v10, 0xffff0000, v47
    v_mul_f32 v7, 0.15915494, v7
    v_mul_f32 v8, 0.15915494, v8
    v_mul_f32 v9, 0.15915494, v9
    v_mul_f32 v10, 0.15915494, v10
    v_mul_hi_u32_u24 v14, 429497, v48
    v_lshrrev_b32 v12, 3, v52
    v_cos_f32 v7, v7
    v_lshlrev_b16 v13, 3, v52
    v_mad_i32_i24 v11, v14, s55, v48
    v_bitop3_b32 v12, v6, v13, v12 bitop3:0xca
    v_lshl_add_u32 v11, v11, 17, s40
    v_lshlrev_b16 v14, 8, v14
    v_lshrrev_b32 v13, 2, v52
    v_add_u32 v48, v12, v11
    v_bitop3_b32 v52, v5, v13, v14 bitop3:0xea
    ds_add_u32 v52, v2
    v_mul_hi_u32_u24 v14, 429497, v49
    v_lshrrev_b32 v12, 3, v53
    v_cos_f32 v8, v8
    v_lshlrev_b16 v13, 3, v53
    v_mad_i32_i24 v11, v14, s55, v49
    v_bitop3_b32 v12, v6, v13, v12 bitop3:0xca
    v_lshl_add_u32 v11, v11, 17, s40
    v_lshlrev_b16 v14, 8, v14
    v_lshrrev_b32 v13, 2, v53
    v_add_u32 v49, v12, v11
    v_bitop3_b32 v53, v5, v13, v14 bitop3:0xea
    ds_add_u32 v53, v2
    v_cvt_pk_bf16_f32 v46, v7, v8
    v_perm_b32 v12, v46, v46, s41
    v_bitop3_b32 v48, v4, v12, v48 bitop3:0xca
    v_perm_b32 v13, v46, v46, s42
    v_bitop3_b32 v49, v4, v13, v49 bitop3:0xca
    v_mul_hi_u32_u24 v14, 429497, v50
    v_lshrrev_b32 v12, 3, v54
    v_cos_f32 v9, v9
    v_lshlrev_b16 v13, 3, v54
    v_mad_i32_i24 v11, v14, s55, v50
    v_bitop3_b32 v12, v6, v13, v12 bitop3:0xca
    v_lshl_add_u32 v11, v11, 17, s40
    v_lshlrev_b16 v14, 8, v14
    v_lshrrev_b32 v13, 2, v54
    v_add_u32 v50, v12, v11
    v_bitop3_b32 v54, v5, v13, v14 bitop3:0xea
    ds_add_u32 v54, v2
    v_mul_hi_u32_u24 v14, 429497, v51
    v_lshrrev_b32 v12, 3, v55
    v_cos_f32 v10, v10
    v_lshlrev_b16 v13, 3, v55
    v_mad_i32_i24 v11, v14, s55, v51
    v_bitop3_b32 v12, v6, v13, v12 bitop3:0xca
    v_lshl_add_u32 v11, v11, 17, s40
    v_lshlrev_b16 v14, 8, v14
    v_lshrrev_b32 v13, 2, v55
    v_add_u32 v51, v12, v11
    v_bitop3_b32 v55, v5, v13, v14 bitop3:0xea
    ds_add_u32 v55, v2
    v_cvt_pk_bf16_f32 v47, v9, v10
    v_perm_b32 v12, v47, v47, s41
    v_bitop3_b32 v50, v4, v12, v50 bitop3:0xca
    v_perm_b32 v13, v47, v47, s42
    v_bitop3_b32 v51, v4, v13, v51 bitop3:0xca
    s_setprio 1
    s_add_u32 s46, s96, 0x1c00000
    v_lshlrev_b32 v88, 1, v1
    buffer_load_dwordx4 v[88:91], v88, s[8:11], s46 offen nt
    s_add_u32 s47, s96, 0x1c00000
    v_lshlrev_b32 v92, 1, v1
    buffer_load_dwordx4 v[92:95], v92, s[12:15], s47 offen nt
    s_waitcnt vmcnt(8)
    v_lshlrev_b32 v7, 16, v64
    v_and_b32 v8, 0xffff0000, v64
    v_lshlrev_b32 v9, 16, v65
    v_and_b32 v10, 0xffff0000, v65
    v_mul_f32 v7, 0.15915494, v7
    v_mul_f32 v8, 0.15915494, v8
    v_mul_f32 v9, 0.15915494, v9
    v_mul_f32 v10, 0.15915494, v10
    v_mul_hi_u32_u24 v14, 429497, v56
    v_lshrrev_b32 v12, 3, v60
    v_cos_f32 v7, v7
    v_lshlrev_b16 v13, 3, v60
    v_mad_i32_i24 v11, v14, s55, v56
    v_bitop3_b32 v12, v6, v13, v12 bitop3:0xca
    v_lshl_add_u32 v11, v11, 17, s40
    v_lshlrev_b16 v14, 8, v14
    v_lshrrev_b32 v13, 2, v60
    v_add_u32 v56, v12, v11
    v_bitop3_b32 v60, v5, v13, v14 bitop3:0xea
    ds_add_u32 v60, v2
    v_mul_hi_u32_u24 v14, 429497, v57
    v_lshrrev_b32 v12, 3, v61
    v_cos_f32 v8, v8
    v_lshlrev_b16 v13, 3, v61
    v_mad_i32_i24 v11, v14, s55, v57
    v_bitop3_b32 v12, v6, v13, v12 bitop3:0xca
    v_lshl_add_u32 v11, v11, 17, s40
    v_lshlrev_b16 v14, 8, v14
    v_lshrrev_b32 v13, 2, v61
    v_add_u32 v57, v12, v11
    v_bitop3_b32 v61, v5, v13, v14 bitop3:0xea
    ds_add_u32 v61, v2
    v_cvt_pk_bf16_f32 v64, v7, v8
    v_perm_b32 v12, v64, v64, s41
    v_bitop3_b32 v56, v4, v12, v56 bitop3:0xca
    v_perm_b32 v13, v64, v64, s42
    v_bitop3_b32 v57, v4, v13, v57 bitop3:0xca
    v_mul_hi_u32_u24 v14, 429497, v58
    v_lshrrev_b32 v12, 3, v62
    v_cos_f32 v9, v9
    v_lshlrev_b16 v13, 3, v62
    v_mad_i32_i24 v11, v14, s55, v58
    v_bitop3_b32 v12, v6, v13, v12 bitop3:0xca
    v_lshl_add_u32 v11, v11, 17, s40
    v_lshlrev_b16 v14, 8, v14
    v_lshrrev_b32 v13, 2, v62
    v_add_u32 v58, v12, v11
    v_bitop3_b32 v62, v5, v13, v14 bitop3:0xea
    ds_add_u32 v62, v2
    v_mul_hi_u32_u24 v14, 429497, v59
    v_lshrrev_b32 v12, 3, v63
    v_cos_f32 v10, v10
    v_lshlrev_b16 v13, 3, v63
    v_mad_i32_i24 v11, v14, s55, v59
    v_bitop3_b32 v12, v6, v13, v12 bitop3:0xca
    v_lshl_add_u32 v11, v11, 17, s40
    v_lshlrev_b16 v14, 8, v14
    v_lshrrev_b32 v13, 2, v63
    v_add_u32 v59, v12, v11
    v_bitop3_b32 v63, v5, v13, v14 bitop3:0xea
    ds_add_u32 v63, v2
    v_cvt_pk_bf16_f32 v65, v9, v10
    v_perm_b32 v12, v65, v65, s41
    v_bitop3_b32 v58, v4, v12, v58 bitop3:0xca
    v_perm_b32 v13, v65, v65, s42
    v_bitop3_b32 v59, v4, v13, v59 bitop3:0xca
    s_add_u32 s44, s96, 0x2000000
    v_lshlrev_b32 v96, 1, v1
    buffer_load_dwordx4 v[96:99], v96, s[8:11], s44 offen nt
    s_add_u32 s45, s96, 0x2000000
    v_lshlrev_b32 v104, 1, v1
    buffer_load_dwordx4 v[104:107], v104, s[12:15], s45 offen nt
    s_add_u32 s46, s96, 0x2000000
    s_lshr_b32 s46, s46, 1
    buffer_load_dwordx2 v[108:109], v1, s[16:19], s46 offen nt
    s_add_u32 s47, s96, 0x2400000
    s_lshr_b32 s47, s47, 1
    buffer_load_dwordx2 v[110:111], v1, s[16:19], s47 offen nt
    s_waitcnt vmcnt(10)
    v_lshlrev_b32 v7, 16, v66
    v_and_b32 v8, 0xffff0000, v66
    v_lshlrev_b32 v9, 16, v67
    v_and_b32 v10, 0xffff0000, v67
    v_mul_f32 v7, 0.15915494, v7
    v_mul_f32 v8, 0.15915494, v8
    v_mul_f32 v9, 0.15915494, v9
    v_mul_f32 v10, 0.15915494, v10
    v_mul_hi_u32_u24 v14, 429497, v68
    v_lshrrev_b32 v12, 3, v72
    v_cos_f32 v7, v7
    v_lshlrev_b16 v13, 3, v72
    v_mad_i32_i24 v11, v14, s55, v68
    v_bitop3_b32 v12, v6, v13, v12 bitop3:0xca
    v_lshl_add_u32 v11, v11, 17, s40
    v_lshlrev_b16 v14, 8, v14
    v_lshrrev_b32 v13, 2, v72
    v_add_u32 v68, v12, v11
    v_bitop3_b32 v72, v5, v13, v14 bitop3:0xea
    ds_add_u32 v72, v2
    v_mul_hi_u32_u24 v14, 429497, v69
    v_lshrrev_b32 v12, 3, v73
    v_cos_f32 v8, v8
    v_lshlrev_b16 v13, 3, v73
    v_mad_i32_i24 v11, v14, s55, v69
    v_bitop3_b32 v12, v6, v13, v12 bitop3:0xca
    v_lshl_add_u32 v11, v11, 17, s40
    v_lshlrev_b16 v14, 8, v14
    v_lshrrev_b32 v13, 2, v73
    v_add_u32 v69, v12, v11
    v_bitop3_b32 v73, v5, v13, v14 bitop3:0xea
    ds_add_u32 v73, v2
    v_cvt_pk_bf16_f32 v66, v7, v8
    v_perm_b32 v12, v66, v66, s41
    v_bitop3_b32 v68, v4, v12, v68 bitop3:0xca
    v_perm_b32 v13, v66, v66, s42
    v_bitop3_b32 v69, v4, v13, v69 bitop3:0xca
    v_mul_hi_u32_u24 v14, 429497, v70
    v_lshrrev_b32 v12, 3, v74
    v_cos_f32 v9, v9
    v_lshlrev_b16 v13, 3, v74
    v_mad_i32_i24 v11, v14, s55, v70
    v_bitop3_b32 v12, v6, v13, v12 bitop3:0xca
    v_lshl_add_u32 v11, v11, 17, s40
    v_lshlrev_b16 v14, 8, v14
    v_lshrrev_b32 v13, 2, v74
    v_add_u32 v70, v12, v11
    v_bitop3_b32 v74, v5, v13, v14 bitop3:0xea
    ds_add_u32 v74, v2
    v_mul_hi_u32_u24 v14, 429497, v71
    v_lshrrev_b32 v12, 3, v75
    v_cos_f32 v10, v10
    v_lshlrev_b16 v13, 3, v75
    v_mad_i32_i24 v11, v14, s55, v71
    v_bitop3_b32 v12, v6, v13, v12 bitop3:0xca
    v_lshl_add_u32 v11, v11, 17, s40
    v_lshlrev_b16 v14, 8, v14
    v_lshrrev_b32 v13, 2, v75
    v_add_u32 v71, v12, v11
    v_bitop3_b32 v75, v5, v13, v14 bitop3:0xea
    ds_add_u32 v75, v2
    v_cvt_pk_bf16_f32 v67, v9, v10
    v_perm_b32 v12, v67, v67, s41
    v_bitop3_b32 v70, v4, v12, v70 bitop3:0xca
    v_perm_b32 v13, v67, v67, s42
    v_bitop3_b32 v71, v4, v13, v71 bitop3:0xca
    s_setprio 0
    s_add_u32 s44, s96, 0x2400000
    v_lshlrev_b32 v100, 1, v1
    buffer_load_dwordx4 v[100:103], v100, s[8:11], s44 offen nt
    s_waitcnt vmcnt(7)
    v_lshlrev_b32 v7, 16, v84
    v_and_b32 v8, 0xffff0000, v84
    v_lshlrev_b32 v9, 16, v85
    v_and_b32 v10, 0xffff0000, v85
    v_mul_f32 v7, 0.15915494, v7
    v_mul_f32 v8, 0.15915494, v8
    v_mul_f32 v9, 0.15915494, v9
    v_mul_f32 v10, 0.15915494, v10
    v_mul_hi_u32_u24 v14, 429497, v76
    v_lshrrev_b32 v12, 3, v80
    v_cos_f32 v7, v7
    v_lshlrev_b16 v13, 3, v80
    v_mad_i32_i24 v11, v14, s55, v76
    v_bitop3_b32 v12, v6, v13, v12 bitop3:0xca
    v_lshl_add_u32 v11, v11, 17, s40
    v_lshlrev_b16 v14, 8, v14
    v_lshrrev_b32 v13, 2, v80
    v_add_u32 v76, v12, v11
    v_bitop3_b32 v80, v5, v13, v14 bitop3:0xea
    ds_add_u32 v80, v2
    v_mul_hi_u32_u24 v14, 429497, v77
    v_lshrrev_b32 v12, 3, v81
    v_cos_f32 v8, v8
    v_lshlrev_b16 v13, 3, v81
    v_mad_i32_i24 v11, v14, s55, v77
    v_bitop3_b32 v12, v6, v13, v12 bitop3:0xca
    v_lshl_add_u32 v11, v11, 17, s40
    v_lshlrev_b16 v14, 8, v14
    v_lshrrev_b32 v13, 2, v81
    v_add_u32 v77, v12, v11
    v_bitop3_b32 v81, v5, v13, v14 bitop3:0xea
    ds_add_u32 v81, v2
    v_cvt_pk_bf16_f32 v84, v7, v8
    v_perm_b32 v12, v84, v84, s41
    v_bitop3_b32 v76, v4, v12, v76 bitop3:0xca
    v_perm_b32 v13, v84, v84, s42
    v_bitop3_b32 v77, v4, v13, v77 bitop3:0xca
    v_mul_hi_u32_u24 v14, 429497, v78
    v_lshrrev_b32 v12, 3, v82
    v_cos_f32 v9, v9
    v_lshlrev_b16 v13, 3, v82
    v_mad_i32_i24 v11, v14, s55, v78
    v_bitop3_b32 v12, v6, v13, v12 bitop3:0xca
    v_lshl_add_u32 v11, v11, 17, s40
    v_lshlrev_b16 v14, 8, v14
    v_lshrrev_b32 v13, 2, v82
    v_add_u32 v78, v12, v11
    v_bitop3_b32 v82, v5, v13, v14 bitop3:0xea
    ds_add_u32 v82, v2
    v_mul_hi_u32_u24 v14, 429497, v79
    v_lshrrev_b32 v12, 3, v83
    v_cos_f32 v10, v10
    v_lshlrev_b16 v13, 3, v83
    v_mad_i32_i24 v11, v14, s55, v79
    v_bitop3_b32 v12, v6, v13, v12 bitop3:0xca
    v_lshl_add_u32 v11, v11, 17, s40
    v_lshlrev_b16 v14, 8, v14
    v_lshrrev_b32 v13, 2, v83
    v_add_u32 v79, v12, v11
    v_bitop3_b32 v83, v5, v13, v14 bitop3:0xea
    ds_add_u32 v83, v2
    v_cvt_pk_bf16_f32 v85, v9, v10
    v_perm_b32 v12, v85, v85, s41
    v_bitop3_b32 v78, v4, v12, v78 bitop3:0xca
    v_perm_b32 v13, v85, v85, s42
    v_bitop3_b32 v79, v4, v13, v79 bitop3:0xca
    s_waitcnt vmcnt(5)
    v_lshlrev_b32 v7, 16, v86
    v_and_b32 v8, 0xffff0000, v86
    v_lshlrev_b32 v9, 16, v87
    v_and_b32 v10, 0xffff0000, v87
    v_mul_f32 v7, 0.15915494, v7
    v_mul_f32 v8, 0.15915494, v8
    v_mul_f32 v9, 0.15915494, v9
    v_mul_f32 v10, 0.15915494, v10
    v_mul_hi_u32_u24 v14, 429497, v88
    v_lshrrev_b32 v12, 3, v92
    v_cos_f32 v7, v7
    v_lshlrev_b16 v13, 3, v92
    v_mad_i32_i24 v11, v14, s55, v88
    v_bitop3_b32 v12, v6, v13, v12 bitop3:0xca
    v_lshl_add_u32 v11, v11, 17, s40
    v_lshlrev_b16 v14, 8, v14
    v_lshrrev_b32 v13, 2, v92
    v_add_u32 v88, v12, v11
    v_bitop3_b32 v92, v5, v13, v14 bitop3:0xea
    ds_add_u32 v92, v2
    v_mul_hi_u32_u24 v14, 429497, v89
    v_lshrrev_b32 v12, 3, v93
    v_cos_f32 v8, v8
    v_lshlrev_b16 v13, 3, v93
    v_mad_i32_i24 v11, v14, s55, v89
    v_bitop3_b32 v12, v6, v13, v12 bitop3:0xca
    v_lshl_add_u32 v11, v11, 17, s40
    v_lshlrev_b16 v14, 8, v14
    v_lshrrev_b32 v13, 2, v93
    v_add_u32 v89, v12, v11
    v_bitop3_b32 v93, v5, v13, v14 bitop3:0xea
    ds_add_u32 v93, v2
    v_cvt_pk_bf16_f32 v86, v7, v8
    v_perm_b32 v12, v86, v86, s41
    v_bitop3_b32 v88, v4, v12, v88 bitop3:0xca
    v_perm_b32 v13, v86, v86, s42
    v_bitop3_b32 v89, v4, v13, v89 bitop3:0xca
    v_mul_hi_u32_u24 v14, 429497, v90
    v_lshrrev_b32 v12, 3, v94
    v_cos_f32 v9, v9
    v_lshlrev_b16 v13, 3, v94
    v_mad_i32_i24 v11, v14, s55, v90
    v_bitop3_b32 v12, v6, v13, v12 bitop3:0xca
    v_lshl_add_u32 v11, v11, 17, s40
    v_lshlrev_b16 v14, 8, v14
    v_lshrrev_b32 v13, 2, v94
    v_add_u32 v90, v12, v11
    v_bitop3_b32 v94, v5, v13, v14 bitop3:0xea
    ds_add_u32 v94, v2
    v_mul_hi_u32_u24 v14, 429497, v91
    v_lshrrev_b32 v12, 3, v95
    v_cos_f32 v10, v10
    v_lshlrev_b16 v13, 3, v95
    v_mad_i32_i24 v11, v14, s55, v91
    v_bitop3_b32 v12, v6, v13, v12 bitop3:0xca
    v_lshl_add_u32 v11, v11, 17, s40
    v_lshlrev_b16 v14, 8, v14
    v_lshrrev_b32 v13, 2, v95
    v_add_u32 v91, v12, v11
    v_bitop3_b32 v95, v5, v13, v14 bitop3:0xea
    ds_add_u32 v95, v2
    v_cvt_pk_bf16_f32 v87, v9, v10
    v_perm_b32 v12, v87, v87, s41
    v_bitop3_b32 v90, v4, v12, v90 bitop3:0xca
    v_perm_b32 v13, v87, v87, s42
    v_bitop3_b32 v91, v4, v13, v91 bitop3:0xca
    v_lshrrev_b32 v8, 2, v0
    v_and_b32 v7, 0x3c00, v0
    v_bitop3_b32 v7, v5, v8, v7 bitop3:0xea
    s_waitcnt lgkmcnt(0)
    s_barrier
    ds_read2st64_b32 v[8:9], v7 offset0:0 offset1:1
    ds_read2st64_b32 v[10:11], v7 offset0:2 offset1:3
    s_add_u32 s45, s96, 0x2400000
    v_lshlrev_b32 v112, 1, v1
    buffer_load_dwordx4 v[112:115], v112, s[12:15], s45 offen nt
    s_waitcnt lgkmcnt(0)
    v_lshl_or_b32 v12, v9, 16, v8
    v_lshl_or_b32 v13, v11, 16, v10
    v_mov_b32 v14, v12
    v_mov_b32 v15, v13
    s_nop 0
    v_add_u32_dpp v14, v14, v14 row_shr:1 row_mask:0xf bank_mask:0xf bound_ctrl:1
    v_add_u32_dpp v15, v15, v15 row_shr:1 row_mask:0xf bank_mask:0xf bound_ctrl:1
    s_nop 0
    v_add_u32_dpp v14, v14, v14 row_shr:2 row_mask:0xf bank_mask:0xf bound_ctrl:1
    v_add_u32_dpp v15, v15, v15 row_shr:2 row_mask:0xf bank_mask:0xf bound_ctrl:1
    s_nop 0
    v_add_u32_dpp v14, v14, v14 row_shr:4 row_mask:0xf bank_mask:0xf bound_ctrl:1
    v_add_u32_dpp v15, v15, v15 row_shr:4 row_mask:0xf bank_mask:0xf bound_ctrl:1
    s_nop 0
    v_add_u32_dpp v14, v14, v14 row_shr:8 row_mask:0xf bank_mask:0xf bound_ctrl:1
    v_add_u32_dpp v15, v15, v15 row_shr:8 row_mask:0xf bank_mask:0xf bound_ctrl:1
    s_nop 0
    v_add_u32_dpp v14, v14, v14 row_bcast:15 row_mask:0xa bank_mask:0xf
    v_add_u32_dpp v15, v15, v15 row_bcast:15 row_mask:0xa bank_mask:0xf
    s_nop 0
    v_add_u32_dpp v14, v14, v14 row_bcast:31 row_mask:0xc bank_mask:0xf
    v_add_u32_dpp v15, v15, v15 row_bcast:31 row_mask:0xc bank_mask:0xf
    v_readlane_b32 s48, v14, 63
    v_readlane_b32 s49, v15, 63
    s_lshl_b32 s54, s32, 2
    v_mov_b32 v8, s54
    s_and_b32 s50, s48, 0xffff
    s_lshr_b32 s51, s48, 16
    s_and_b32 s52, s49, 0xffff
    s_lshr_b32 s53, s49, 16
    s_add_u32 s51, s51, s50
    s_add_u32 s52, s52, s51
    s_add_u32 s53, s53, s52
    v_mov_b32 v9, s53
    s_mov_b64 exec, 1
    ds_write_b32 v8, v9 offset:16384
    s_mov_b64 exec, -1
    v_and_b32 v8, 60, v7
    s_waitcnt lgkmcnt(0)
    s_barrier
    ds_read_b32 v9, v8 offset:16384
    s_waitcnt lgkmcnt(0)
    v_add_u32_dpp v9, v9, v9 row_shr:1 row_mask:0xf bank_mask:0xf bound_ctrl:1
    s_nop 1
    v_add_u32_dpp v9, v9, v9 row_shr:2 row_mask:0xf bank_mask:0xf bound_ctrl:1
    s_nop 1
    v_add_u32_dpp v9, v9, v9 row_shr:4 row_mask:0xf bank_mask:0xf bound_ctrl:1
    s_nop 1
    v_add_u32_dpp v9, v9, v9 row_shr:8 row_mask:0xf bank_mask:0xf bound_ctrl:1
    s_nop 0
    v_readlane_b32 s54, v9, s32
    s_sub_u32 s54, s54, s53
    s_add_u32 s50, s50, s54
    s_add_u32 s51, s51, s54
    s_add_u32 s52, s52, s54
    s_pack_ll_b32_b16 s48, s54, s50
    s_pack_ll_b32_b16 s49, s51, s52
    v_add_u32 v14, s48, v14
    v_add_u32 v15, s49, v15
    v_sub_u32 v12, v14, v12
    v_sub_u32 v13, v15, v13
    v_and_b32 v8, 0xffff, v12
    v_lshrrev_b32 v9, 16, v12
    v_and_b32 v10, 0xffff, v13
    v_lshrrev_b32 v11, 16, v13
    ds_write2st64_b32 v7, v8, v9 offset0:0 offset1:1
    ds_write2st64_b32 v7, v10, v11 offset0:2 offset1:3
    v_and_b32 v8, 0x3f0, v0
    v_lshl_add_u32 v8, v8, 1, s36
    ds_write_b64 v8, v[12:13] offset:20480
    s_bitset0_b64 exec, 63
    s_not_b64 exec, exec
    ds_write_b64 v8, v[14:15] offset:20512
    s_mov_b64 exec, -1
    s_waitcnt lgkmcnt(0)
    s_barrier
    s_setprio 3
    ds_add_rtn_u32 v20, v20, v2
    ds_add_rtn_u32 v21, v21, v2
    ds_add_rtn_u32 v22, v22, v2
    ds_add_rtn_u32 v23, v23, v2
    ds_read_b128 v[12:15], v0 offset:20480
    v_cmp_gt_u32 vcc, 8448, v0
    s_add_u32 s46, s96, 0x2800000
    v_lshlrev_b32 v116, 1, v1
    buffer_load_dwordx4 v[116:119], v116, s[8:11], s46 offen nt
    ds_add_rtn_u32 v32, v32, v2
    ds_add_rtn_u32 v33, v33, v2
    ds_add_rtn_u32 v34, v34, v2
    ds_add_rtn_u32 v35, v35, v2
    s_setprio 2
    ds_add_rtn_u32 v40, v40, v2
    ds_add_rtn_u32 v41, v41, v2
    ds_add_rtn_u32 v42, v42, v2
    ds_add_rtn_u32 v43, v43, v2
    s_waitcnt lgkmcnt(8)
    s_cbranch_vccz L1_p1
    s_add_u32 s47, s35, 0x0
    s_mov_b64 exec, vcc
    buffer_store_dwordx4 v[12:15], v0, s[24:27], s47 offen sc1
    s_mov_b64 exec, -1
L1_p1:
    s_add_u32 s44, s96, 0x2800000
    v_lshlrev_b32 v120, 1, v1
    buffer_load_dwordx4 v[120:123], v120, s[12:15], s44 offen nt
    ds_add_rtn_u32 v52, v52, v2
    ds_add_rtn_u32 v53, v53, v2
    ds_add_rtn_u32 v54, v54, v2
    ds_add_rtn_u32 v55, v55, v2
    s_setprio 1
    ds_add_rtn_u32 v60, v60, v2
    ds_add_rtn_u32 v61, v61, v2
    ds_add_rtn_u32 v62, v62, v2
    ds_add_rtn_u32 v63, v63, v2
    ds_add_rtn_u32 v72, v72, v2
    ds_add_rtn_u32 v73, v73, v2
    ds_add_rtn_u32 v74, v74, v2
    ds_add_rtn_u32 v75, v75, v2
    s_add_u32 s45, s96, 0x2800000
    s_lshr_b32 s45, s45, 1
    buffer_load_dwordx2 v[124:125], v1, s[16:19], s45 offen nt
    s_add_u32 s46, s96, 0x2c00000
    s_lshr_b32 s46, s46, 1
    buffer_load_dwordx2 v[126:127], v1, s[16:19], s46 offen nt
    s_setprio 0
    ds_add_rtn_u32 v80, v80, v2
    ds_add_rtn_u32 v81, v81, v2
    ds_add_rtn_u32 v82, v82, v2
    ds_add_rtn_u32 v83, v83, v2
    ds_add_rtn_u32 v92, v92, v2
    ds_add_rtn_u32 v93, v93, v2
    ds_add_rtn_u32 v94, v94, v2
    ds_add_rtn_u32 v95, v95, v2
    s_waitcnt lgkmcnt(0)
    s_barrier
    s_setprio 3
    v_and_b32 v7, -4, v20
    v_lshl_add_u32 v8, v20, 2, v7
    ds_write_b32 v8, v16
    v_lshl_add_u32 v7, v7, 2, v20
    ds_write_b8 v7, v24 offset:16
    v_and_b32 v9, -4, v21
    v_lshl_add_u32 v10, v21, 2, v9
    ds_write_b32 v10, v17
    v_lshl_add_u32 v9, v9, 2, v21
    ds_write_b8_d16_hi v9, v24 offset:16
    v_and_b32 v7, -4, v22
    v_lshl_add_u32 v8, v22, 2, v7
    ds_write_b32 v8, v18
    v_lshl_add_u32 v7, v7, 2, v22
    ds_write_b8 v7, v25 offset:16
    v_and_b32 v9, -4, v23
    v_lshl_add_u32 v10, v23, 2, v9
    ds_write_b32 v10, v19
    v_lshl_add_u32 v9, v9, 2, v23
    ds_write_b8_d16_hi v9, v25 offset:16
    s_add_u32 s47, s96, 0x2c00000
    v_lshlrev_b32 v16, 1, v1
    buffer_load_dwordx4 v[16:19], v16, s[8:11], s47 offen nt
    s_add_u32 s44, s96, 0x2c00000
    v_lshlrev_b32 v20, 1, v1
    buffer_load_dwordx4 v[20:23], v20, s[12:15], s44 offen nt
    v_and_b32 v7, -4, v32
    v_lshl_add_u32 v8, v32, 2, v7
    ds_write_b32 v8, v28
    v_lshl_add_u32 v7, v7, 2, v32
    ds_write_b8 v7, v26 offset:16
    v_and_b32 v9, -4, v33
    v_lshl_add_u32 v10, v33, 2, v9
    ds_write_b32 v10, v29
    v_lshl_add_u32 v9, v9, 2, v33
    ds_write_b8_d16_hi v9, v26 offset:16
    v_and_b32 v7, -4, v34
    v_lshl_add_u32 v8, v34, 2, v7
    ds_write_b32 v8, v30
    v_lshl_add_u32 v7, v7, 2, v34
    ds_write_b8 v7, v27 offset:16
    v_and_b32 v9, -4, v35
    v_lshl_add_u32 v10, v35, 2, v9
    ds_write_b32 v10, v31
    v_lshl_add_u32 v9, v9, 2, v35
    ds_write_b8_d16_hi v9, v27 offset:16
    s_add_u32 s45, s96, 0x3000000
    v_lshlrev_b32 v28, 1, v1
    buffer_load_dwordx4 v[28:31], v28, s[8:11], s45 offen nt
    s_waitcnt vmcnt(9)
    v_lshlrev_b32 v7, 16, v108
    v_and_b32 v8, 0xffff0000, v108
    v_lshlrev_b32 v9, 16, v109
    v_and_b32 v10, 0xffff0000, v109
    v_mul_f32 v7, 0.15915494, v7
    v_mul_f32 v8, 0.15915494, v8
    v_mul_f32 v9, 0.15915494, v9
    v_mul_f32 v10, 0.15915494, v10
    v_mul_hi_u32_u24 v14, 429497, v96
    v_lshrrev_b32 v12, 3, v104
    v_cos_f32 v7, v7
    v_lshlrev_b16 v13, 3, v104
    v_mad_i32_i24 v11, v14, s55, v96
    v_bitop3_b32 v12, v6, v13, v12 bitop3:0xca
    v_lshl_add_u32 v11, v11, 17, s40
    v_lshlrev_b16 v14, 8, v14
    v_lshrrev_b32 v13, 2, v104
    v_add_u32 v96, v12, v11
    v_bitop3_b32 v104, v5, v13, v14 bitop3:0xea
    v_mul_hi_u32_u24 v14, 429497, v97
    v_lshrrev_b32 v12, 3, v105
    v_cos_f32 v8, v8
    v_lshlrev_b16 v13, 3, v105
    v_mad_i32_i24 v11, v14, s55, v97
    v_bitop3_b32 v12, v6, v13, v12 bitop3:0xca
    v_lshl_add_u32 v11, v11, 17, s40
    v_lshlrev_b16 v14, 8, v14
    v_lshrrev_b32 v13, 2, v105
    v_add_u32 v97, v12, v11
    v_bitop3_b32 v105, v5, v13, v14 bitop3:0xea
    v_cvt_pk_bf16_f32 v108, v7, v8
    v_perm_b32 v12, v108, v108, s41
    v_bitop3_b32 v96, v4, v12, v96 bitop3:0xca
    v_perm_b32 v13, v108, v108, s42
    v_bitop3_b32 v97, v4, v13, v97 bitop3:0xca
    v_mul_hi_u32_u24 v14, 429497, v98
    v_lshrrev_b32 v12, 3, v106
    v_cos_f32 v9, v9
    v_lshlrev_b16 v13, 3, v106
    v_mad_i32_i24 v11, v14, s55, v98
    v_bitop3_b32 v12, v6, v13, v12 bitop3:0xca
    v_lshl_add_u32 v11, v11, 17, s40
    v_lshlrev_b16 v14, 8, v14
    v_lshrrev_b32 v13, 2, v106
    v_add_u32 v98, v12, v11
    v_bitop3_b32 v106, v5, v13, v14 bitop3:0xea
    v_mul_hi_u32_u24 v14, 429497, v99
    v_lshrrev_b32 v12, 3, v107
    v_cos_f32 v10, v10
    v_lshlrev_b16 v13, 3, v107
    v_mad_i32_i24 v11, v14, s55, v99
    v_bitop3_b32 v12, v6, v13, v12 bitop3:0xca
    v_lshl_add_u32 v11, v11, 17, s40
    v_lshlrev_b16 v14, 8, v14
    v_lshrrev_b32 v13, 2, v107
    v_add_u32 v99, v12, v11
    v_bitop3_b32 v107, v5, v13, v14 bitop3:0xea
    v_cvt_pk_bf16_f32 v109, v9, v10
    v_perm_b32 v12, v109, v109, s41
    v_bitop3_b32 v98, v4, v12, v98 bitop3:0xca
    v_perm_b32 v13, v109, v109, s42
    v_bitop3_b32 v99, v4, v13, v99 bitop3:0xca
    s_setprio 2
    v_and_b32 v7, -4, v40
    v_lshl_add_u32 v8, v40, 2, v7
    ds_write_b32 v8, v36
    v_lshl_add_u32 v7, v7, 2, v40
    ds_write_b8 v7, v44 offset:16
    v_and_b32 v9, -4, v41
    v_lshl_add_u32 v10, v41, 2, v9
    ds_write_b32 v10, v37
    v_lshl_add_u32 v9, v9, 2, v41
    ds_write_b8_d16_hi v9, v44 offset:16
    v_and_b32 v7, -4, v42
    v_lshl_add_u32 v8, v42, 2, v7
    ds_write_b32 v8, v38
    v_lshl_add_u32 v7, v7, 2, v42
    ds_write_b8 v7, v45 offset:16
    v_and_b32 v9, -4, v43
    v_lshl_add_u32 v10, v43, 2, v9
    ds_write_b32 v10, v39
    v_lshl_add_u32 v9, v9, 2, v43
    ds_write_b8_d16_hi v9, v45 offset:16
    s_add_u32 s46, s96, 0x3000000
    v_lshlrev_b32 v32, 1, v1
    buffer_load_dwordx4 v[32:35], v32, s[12:15], s46 offen nt
    s_waitcnt vmcnt(8)
    v_lshlrev_b32 v7, 16, v110
    v_and_b32 v8, 0xffff0000, v110
    v_lshlrev_b32 v9, 16, v111
    v_and_b32 v10, 0xffff0000, v111
    v_mul_f32 v7, 0.15915494, v7
    v_mul_f32 v8, 0.15915494, v8
    v_mul_f32 v9, 0.15915494, v9
    v_mul_f32 v10, 0.15915494, v10
    v_mul_hi_u32_u24 v14, 429497, v100
    v_lshrrev_b32 v12, 3, v112
    v_cos_f32 v7, v7
    v_lshlrev_b16 v13, 3, v112
    v_mad_i32_i24 v11, v14, s55, v100
    v_bitop3_b32 v12, v6, v13, v12 bitop3:0xca
    v_lshl_add_u32 v11, v11, 17, s40
    v_lshlrev_b16 v14, 8, v14
    v_lshrrev_b32 v13, 2, v112
    v_add_u32 v100, v12, v11
    v_bitop3_b32 v112, v5, v13, v14 bitop3:0xea
    v_mul_hi_u32_u24 v14, 429497, v101
    v_lshrrev_b32 v12, 3, v113
    v_cos_f32 v8, v8
    v_lshlrev_b16 v13, 3, v113
    v_mad_i32_i24 v11, v14, s55, v101
    v_bitop3_b32 v12, v6, v13, v12 bitop3:0xca
    v_lshl_add_u32 v11, v11, 17, s40
    v_lshlrev_b16 v14, 8, v14
    v_lshrrev_b32 v13, 2, v113
    v_add_u32 v101, v12, v11
    v_bitop3_b32 v113, v5, v13, v14 bitop3:0xea
    v_cvt_pk_bf16_f32 v110, v7, v8
    v_perm_b32 v12, v110, v110, s41
    v_bitop3_b32 v100, v4, v12, v100 bitop3:0xca
    v_perm_b32 v13, v110, v110, s42
    v_bitop3_b32 v101, v4, v13, v101 bitop3:0xca
    v_mul_hi_u32_u24 v14, 429497, v102
    v_lshrrev_b32 v12, 3, v114
    v_cos_f32 v9, v9
    v_lshlrev_b16 v13, 3, v114
    v_mad_i32_i24 v11, v14, s55, v102
    v_bitop3_b32 v12, v6, v13, v12 bitop3:0xca
    v_lshl_add_u32 v11, v11, 17, s40
    v_lshlrev_b16 v14, 8, v14
    v_lshrrev_b32 v13, 2, v114
    v_add_u32 v102, v12, v11
    v_bitop3_b32 v114, v5, v13, v14 bitop3:0xea
    v_mul_hi_u32_u24 v14, 429497, v103
    v_lshrrev_b32 v12, 3, v115
    v_cos_f32 v10, v10
    v_lshlrev_b16 v13, 3, v115
    v_mad_i32_i24 v11, v14, s55, v103
    v_bitop3_b32 v12, v6, v13, v12 bitop3:0xca
    v_lshl_add_u32 v11, v11, 17, s40
    v_lshlrev_b16 v14, 8, v14
    v_lshrrev_b32 v13, 2, v115
    v_add_u32 v103, v12, v11
    v_bitop3_b32 v115, v5, v13, v14 bitop3:0xea
    v_cvt_pk_bf16_f32 v111, v9, v10
    v_perm_b32 v12, v111, v111, s41
    v_bitop3_b32 v102, v4, v12, v102 bitop3:0xca
    v_perm_b32 v13, v111, v111, s42
    v_bitop3_b32 v103, v4, v13, v103 bitop3:0xca
    v_and_b32 v7, -4, v52
    v_lshl_add_u32 v8, v52, 2, v7
    ds_write_b32 v8, v48
    v_lshl_add_u32 v7, v7, 2, v52
    ds_write_b8 v7, v46 offset:16
    v_and_b32 v9, -4, v53
    v_lshl_add_u32 v10, v53, 2, v9
    ds_write_b32 v10, v49
    v_lshl_add_u32 v9, v9, 2, v53
    ds_write_b8_d16_hi v9, v46 offset:16
    v_and_b32 v7, -4, v54
    v_lshl_add_u32 v8, v54, 2, v7
    ds_write_b32 v8, v50
    v_lshl_add_u32 v7, v7, 2, v54
    ds_write_b8 v7, v47 offset:16
    v_and_b32 v9, -4, v55
    v_lshl_add_u32 v10, v55, 2, v9
    ds_write_b32 v10, v51
    v_lshl_add_u32 v9, v9, 2, v55
    ds_write_b8_d16_hi v9, v47 offset:16
    s_add_u32 s47, s96, 0x3000000
    s_lshr_b32 s47, s47, 1
    buffer_load_dwordx2 v[24:25], v1, s[16:19], s47 offen nt
    s_add_u32 s44, s96, 0x3400000
    s_lshr_b32 s44, s44, 1
    buffer_load_dwordx2 v[26:27], v1, s[16:19], s44 offen nt
    s_waitcnt vmcnt(6)
    v_lshlrev_b32 v7, 16, v124
    v_and_b32 v8, 0xffff0000, v124
    v_lshlrev_b32 v9, 16, v125
    v_and_b32 v10, 0xffff0000, v125
    v_mul_f32 v7, 0.15915494, v7
    v_mul_f32 v8, 0.15915494, v8
    v_mul_f32 v9, 0.15915494, v9
    v_mul_f32 v10, 0.15915494, v10
    v_mul_hi_u32_u24 v14, 429497, v116
    v_lshrrev_b32 v12, 3, v120
    v_cos_f32 v7, v7
    v_lshlrev_b16 v13, 3, v120
    v_mad_i32_i24 v11, v14, s55, v116
    v_bitop3_b32 v12, v6, v13, v12 bitop3:0xca
    v_lshl_add_u32 v11, v11, 17, s40
    v_lshlrev_b16 v14, 8, v14
    v_lshrrev_b32 v13, 2, v120
    v_add_u32 v116, v12, v11
    v_bitop3_b32 v120, v5, v13, v14 bitop3:0xea
    v_mul_hi_u32_u24 v14, 429497, v117
    v_lshrrev_b32 v12, 3, v121
    v_cos_f32 v8, v8
    v_lshlrev_b16 v13, 3, v121
    v_mad_i32_i24 v11, v14, s55, v117
    v_bitop3_b32 v12, v6, v13, v12 bitop3:0xca
    v_lshl_add_u32 v11, v11, 17, s40
    v_lshlrev_b16 v14, 8, v14
    v_lshrrev_b32 v13, 2, v121
    v_add_u32 v117, v12, v11
    v_bitop3_b32 v121, v5, v13, v14 bitop3:0xea
    v_cvt_pk_bf16_f32 v124, v7, v8
    v_perm_b32 v12, v124, v124, s41
    v_bitop3_b32 v116, v4, v12, v116 bitop3:0xca
    v_perm_b32 v13, v124, v124, s42
    v_bitop3_b32 v117, v4, v13, v117 bitop3:0xca
    v_mul_hi_u32_u24 v14, 429497, v118
    v_lshrrev_b32 v12, 3, v122
    v_cos_f32 v9, v9
    v_lshlrev_b16 v13, 3, v122
    v_mad_i32_i24 v11, v14, s55, v118
    v_bitop3_b32 v12, v6, v13, v12 bitop3:0xca
    v_lshl_add_u32 v11, v11, 17, s40
    v_lshlrev_b16 v14, 8, v14
    v_lshrrev_b32 v13, 2, v122
    v_add_u32 v118, v12, v11
    v_bitop3_b32 v122, v5, v13, v14 bitop3:0xea
    v_mul_hi_u32_u24 v14, 429497, v119
    v_lshrrev_b32 v12, 3, v123
    v_cos_f32 v10, v10
    v_lshlrev_b16 v13, 3, v123
    v_mad_i32_i24 v11, v14, s55, v119
    v_bitop3_b32 v12, v6, v13, v12 bitop3:0xca
    v_lshl_add_u32 v11, v11, 17, s40
    v_lshlrev_b16 v14, 8, v14
    v_lshrrev_b32 v13, 2, v123
    v_add_u32 v119, v12, v11
    v_bitop3_b32 v123, v5, v13, v14 bitop3:0xea
    v_cvt_pk_bf16_f32 v125, v9, v10
    v_perm_b32 v12, v125, v125, s41
    v_bitop3_b32 v118, v4, v12, v118 bitop3:0xca
    v_perm_b32 v13, v125, v125, s42
    v_bitop3_b32 v119, v4, v13, v119 bitop3:0xca
    s_setprio 1
    v_and_b32 v7, -4, v60
    v_lshl_add_u32 v8, v60, 2, v7
    ds_write_b32 v8, v56
    v_lshl_add_u32 v7, v7, 2, v60
    ds_write_b8 v7, v64 offset:16
    v_and_b32 v9, -4, v61
    v_lshl_add_u32 v10, v61, 2, v9
    ds_write_b32 v10, v57
    v_lshl_add_u32 v9, v9, 2, v61
    ds_write_b8_d16_hi v9, v64 offset:16
    v_and_b32 v7, -4, v62
    v_lshl_add_u32 v8, v62, 2, v7
    ds_write_b32 v8, v58
    v_lshl_add_u32 v7, v7, 2, v62
    ds_write_b8 v7, v65 offset:16
    v_and_b32 v9, -4, v63
    v_lshl_add_u32 v10, v63, 2, v9
    ds_write_b32 v10, v59
    v_lshl_add_u32 v9, v9, 2, v63
    ds_write_b8_d16_hi v9, v65 offset:16
    s_add_u32 s45, s96, 0x3400000
    v_lshlrev_b32 v36, 1, v1
    buffer_load_dwordx4 v[36:39], v36, s[8:11], s45 offen nt
    s_add_u32 s46, s96, 0x3400000
    v_lshlrev_b32 v40, 1, v1
    buffer_load_dwordx4 v[40:43], v40, s[12:15], s46 offen nt
    v_and_b32 v7, -4, v72
    v_lshl_add_u32 v8, v72, 2, v7
    ds_write_b32 v8, v68
    v_lshl_add_u32 v7, v7, 2, v72
    ds_write_b8 v7, v66 offset:16
    v_and_b32 v9, -4, v73
    v_lshl_add_u32 v10, v73, 2, v9
    ds_write_b32 v10, v69
    v_lshl_add_u32 v9, v9, 2, v73
    ds_write_b8_d16_hi v9, v66 offset:16
    v_and_b32 v7, -4, v74
    v_lshl_add_u32 v8, v74, 2, v7
    ds_write_b32 v8, v70
    v_lshl_add_u32 v7, v7, 2, v74
    ds_write_b8 v7, v67 offset:16
    v_and_b32 v9, -4, v75
    v_lshl_add_u32 v10, v75, 2, v9
    ds_write_b32 v10, v71
    v_lshl_add_u32 v9, v9, 2, v75
    ds_write_b8_d16_hi v9, v67 offset:16
    s_add_u32 s47, s96, 0x3800000
    v_lshlrev_b32 v48, 1, v1
    buffer_load_dwordx4 v[48:51], v48, s[8:11], s47 offen nt
    s_waitcnt vmcnt(7)
    v_lshlrev_b32 v7, 16, v126
    v_and_b32 v8, 0xffff0000, v126
    v_lshlrev_b32 v9, 16, v127
    v_and_b32 v10, 0xffff0000, v127
    v_mul_f32 v7, 0.15915494, v7
    v_mul_f32 v8, 0.15915494, v8
    v_mul_f32 v9, 0.15915494, v9
    v_mul_f32 v10, 0.15915494, v10
    v_mul_hi_u32_u24 v14, 429497, v16
    v_lshrrev_b32 v12, 3, v20
    v_cos_f32 v7, v7
    v_lshlrev_b16 v13, 3, v20
    v_mad_i32_i24 v11, v14, s55, v16
    v_bitop3_b32 v12, v6, v13, v12 bitop3:0xca
    v_lshl_add_u32 v11, v11, 17, s40
    v_lshlrev_b16 v14, 8, v14
    v_lshrrev_b32 v13, 2, v20
    v_add_u32 v16, v12, v11
    v_bitop3_b32 v20, v5, v13, v14 bitop3:0xea
    v_mul_hi_u32_u24 v14, 429497, v17
    v_lshrrev_b32 v12, 3, v21
    v_cos_f32 v8, v8
    v_lshlrev_b16 v13, 3, v21
    v_mad_i32_i24 v11, v14, s55, v17
    v_bitop3_b32 v12, v6, v13, v12 bitop3:0xca
    v_lshl_add_u32 v11, v11, 17, s40
    v_lshlrev_b16 v14, 8, v14
    v_lshrrev_b32 v13, 2, v21
    v_add_u32 v17, v12, v11
    v_bitop3_b32 v21, v5, v13, v14 bitop3:0xea
    v_cvt_pk_bf16_f32 v126, v7, v8
    v_perm_b32 v12, v126, v126, s41
    v_bitop3_b32 v16, v4, v12, v16 bitop3:0xca
    v_perm_b32 v13, v126, v126, s42
    v_bitop3_b32 v17, v4, v13, v17 bitop3:0xca
    v_mul_hi_u32_u24 v14, 429497, v18
    v_lshrrev_b32 v12, 3, v22
    v_cos_f32 v9, v9
    v_lshlrev_b16 v13, 3, v22
    v_mad_i32_i24 v11, v14, s55, v18
    v_bitop3_b32 v12, v6, v13, v12 bitop3:0xca
    v_lshl_add_u32 v11, v11, 17, s40
    v_lshlrev_b16 v14, 8, v14
    v_lshrrev_b32 v13, 2, v22
    v_add_u32 v18, v12, v11
    v_bitop3_b32 v22, v5, v13, v14 bitop3:0xea
    v_mul_hi_u32_u24 v14, 429497, v19
    v_lshrrev_b32 v12, 3, v23
    v_cos_f32 v10, v10
    v_lshlrev_b16 v13, 3, v23
    v_mad_i32_i24 v11, v14, s55, v19
    v_bitop3_b32 v12, v6, v13, v12 bitop3:0xca
    v_lshl_add_u32 v11, v11, 17, s40
    v_lshlrev_b16 v14, 8, v14
    v_lshrrev_b32 v13, 2, v23
    v_add_u32 v19, v12, v11
    v_bitop3_b32 v23, v5, v13, v14 bitop3:0xea
    v_cvt_pk_bf16_f32 v127, v9, v10
    v_perm_b32 v12, v127, v127, s41
    v_bitop3_b32 v18, v4, v12, v18 bitop3:0xca
    v_perm_b32 v13, v127, v127, s42
    v_bitop3_b32 v19, v4, v13, v19 bitop3:0xca
    s_setprio 0
    v_and_b32 v7, -4, v80
    v_lshl_add_u32 v8, v80, 2, v7
    ds_write_b32 v8, v76
    v_lshl_add_u32 v7, v7, 2, v80
    ds_write_b8 v7, v84 offset:16
    v_and_b32 v9, -4, v81
    v_lshl_add_u32 v10, v81, 2, v9
    ds_write_b32 v10, v77
    v_lshl_add_u32 v9, v9, 2, v81
    ds_write_b8_d16_hi v9, v84 offset:16
    v_and_b32 v7, -4, v82
    v_lshl_add_u32 v8, v82, 2, v7
    ds_write_b32 v8, v78
    v_lshl_add_u32 v7, v7, 2, v82
    ds_write_b8 v7, v85 offset:16
    v_and_b32 v9, -4, v83
    v_lshl_add_u32 v10, v83, 2, v9
    ds_write_b32 v10, v79
    v_lshl_add_u32 v9, v9, 2, v83
    ds_write_b8_d16_hi v9, v85 offset:16
    s_add_u32 s44, s96, 0x3800000
    v_lshlrev_b32 v52, 1, v1
    buffer_load_dwordx4 v[52:55], v52, s[12:15], s44 offen nt
    s_waitcnt vmcnt(4)
    v_lshlrev_b32 v7, 16, v24
    v_and_b32 v8, 0xffff0000, v24
    v_lshlrev_b32 v9, 16, v25
    v_and_b32 v10, 0xffff0000, v25
    v_mul_f32 v7, 0.15915494, v7
    v_mul_f32 v8, 0.15915494, v8
    v_mul_f32 v9, 0.15915494, v9
    v_mul_f32 v10, 0.15915494, v10
    v_mul_hi_u32_u24 v14, 429497, v28
    v_lshrrev_b32 v12, 3, v32
    v_cos_f32 v7, v7
    v_lshlrev_b16 v13, 3, v32
    v_mad_i32_i24 v11, v14, s55, v28
    v_bitop3_b32 v12, v6, v13, v12 bitop3:0xca
    v_lshl_add_u32 v11, v11, 17, s40
    v_lshlrev_b16 v14, 8, v14
    v_lshrrev_b32 v13, 2, v32
    v_add_u32 v28, v12, v11
    v_bitop3_b32 v32, v5, v13, v14 bitop3:0xea
    v_mul_hi_u32_u24 v14, 429497, v29
    v_lshrrev_b32 v12, 3, v33
    v_cos_f32 v8, v8
    v_lshlrev_b16 v13, 3, v33
    v_mad_i32_i24 v11, v14, s55, v29
    v_bitop3_b32 v12, v6, v13, v12 bitop3:0xca
    v_lshl_add_u32 v11, v11, 17, s40
    v_lshlrev_b16 v14, 8, v14
    v_lshrrev_b32 v13, 2, v33
    v_add_u32 v29, v12, v11
    v_bitop3_b32 v33, v5, v13, v14 bitop3:0xea
    v_cvt_pk_bf16_f32 v24, v7, v8
    v_perm_b32 v12, v24, v24, s41
    v_bitop3_b32 v28, v4, v12, v28 bitop3:0xca
    v_perm_b32 v13, v24, v24, s42
    v_bitop3_b32 v29, v4, v13, v29 bitop3:0xca
    v_mul_hi_u32_u24 v14, 429497, v30
    v_lshrrev_b32 v12, 3, v34
    v_cos_f32 v9, v9
    v_lshlrev_b16 v13, 3, v34
    v_mad_i32_i24 v11, v14, s55, v30
    v_bitop3_b32 v12, v6, v13, v12 bitop3:0xca
    v_lshl_add_u32 v11, v11, 17, s40
    v_lshlrev_b16 v14, 8, v14
    v_lshrrev_b32 v13, 2, v34
    v_add_u32 v30, v12, v11
    v_bitop3_b32 v34, v5, v13, v14 bitop3:0xea
    v_mul_hi_u32_u24 v14, 429497, v31
    v_lshrrev_b32 v12, 3, v35
    v_cos_f32 v10, v10
    v_lshlrev_b16 v13, 3, v35
    v_mad_i32_i24 v11, v14, s55, v31
    v_bitop3_b32 v12, v6, v13, v12 bitop3:0xca
    v_lshl_add_u32 v11, v11, 17, s40
    v_lshlrev_b16 v14, 8, v14
    v_lshrrev_b32 v13, 2, v35
    v_add_u32 v31, v12, v11
    v_bitop3_b32 v35, v5, v13, v14 bitop3:0xea
    v_cvt_pk_bf16_f32 v25, v9, v10
    v_perm_b32 v12, v25, v25, s41
    v_bitop3_b32 v30, v4, v12, v30 bitop3:0xca
    v_perm_b32 v13, v25, v25, s42
    v_bitop3_b32 v31, v4, v13, v31 bitop3:0xca
    v_and_b32 v7, -4, v92
    v_lshl_add_u32 v8, v92, 2, v7
    ds_write_b32 v8, v88
    v_lshl_add_u32 v7, v7, 2, v92
    ds_write_b8 v7, v86 offset:16
    v_and_b32 v9, -4, v93
    v_lshl_add_u32 v10, v93, 2, v9
    ds_write_b32 v10, v89
    v_lshl_add_u32 v9, v9, 2, v93
    ds_write_b8_d16_hi v9, v86 offset:16
    v_and_b32 v7, -4, v94
    v_lshl_add_u32 v8, v94, 2, v7
    ds_write_b32 v8, v90
    v_lshl_add_u32 v7, v7, 2, v94
    ds_write_b8 v7, v87 offset:16
    v_and_b32 v9, -4, v95
    v_lshl_add_u32 v10, v95, 2, v9
    ds_write_b32 v10, v91
    v_lshl_add_u32 v9, v9, 2, v95
    ds_write_b8_d16_hi v9, v87 offset:16
    s_add_u32 s45, s96, 0x3800000
    s_lshr_b32 s45, s45, 1
    buffer_load_dwordx2 v[44:45], v1, s[16:19], s45 offen nt
    s_add_u32 s46, s96, 0x3c00000
    s_lshr_b32 s46, s46, 1
    buffer_load_dwordx2 v[46:47], v1, s[16:19], s46 offen nt
    s_waitcnt vmcnt(4)
    v_lshlrev_b32 v7, 16, v26
    v_and_b32 v8, 0xffff0000, v26
    v_lshlrev_b32 v9, 16, v27
    v_and_b32 v10, 0xffff0000, v27
    v_mul_f32 v7, 0.15915494, v7
    v_mul_f32 v8, 0.15915494, v8
    v_mul_f32 v9, 0.15915494, v9
    v_mul_f32 v10, 0.15915494, v10
    v_mul_hi_u32_u24 v14, 429497, v36
    v_lshrrev_b32 v12, 3, v40
    v_cos_f32 v7, v7
    v_lshlrev_b16 v13, 3, v40
    v_mad_i32_i24 v11, v14, s55, v36
    v_bitop3_b32 v12, v6, v13, v12 bitop3:0xca
    v_lshl_add_u32 v11, v11, 17, s40
    v_lshlrev_b16 v14, 8, v14
    v_lshrrev_b32 v13, 2, v40
    v_add_u32 v36, v12, v11
    v_bitop3_b32 v40, v5, v13, v14 bitop3:0xea
    v_mul_hi_u32_u24 v14, 429497, v37
    v_lshrrev_b32 v12, 3, v41
    v_cos_f32 v8, v8
    v_lshlrev_b16 v13, 3, v41
    v_mad_i32_i24 v11, v14, s55, v37
    v_bitop3_b32 v12, v6, v13, v12 bitop3:0xca
    v_lshl_add_u32 v11, v11, 17, s40
    v_lshlrev_b16 v14, 8, v14
    v_lshrrev_b32 v13, 2, v41
    v_add_u32 v37, v12, v11
    v_bitop3_b32 v41, v5, v13, v14 bitop3:0xea
    v_cvt_pk_bf16_f32 v26, v7, v8
    v_perm_b32 v12, v26, v26, s41
    v_bitop3_b32 v36, v4, v12, v36 bitop3:0xca
    v_perm_b32 v13, v26, v26, s42
    v_bitop3_b32 v37, v4, v13, v37 bitop3:0xca
    v_mul_hi_u32_u24 v14, 429497, v38
    v_lshrrev_b32 v12, 3, v42
    v_cos_f32 v9, v9
    v_lshlrev_b16 v13, 3, v42
    v_mad_i32_i24 v11, v14, s55, v38
    v_bitop3_b32 v12, v6, v13, v12 bitop3:0xca
    v_lshl_add_u32 v11, v11, 17, s40
    v_lshlrev_b16 v14, 8, v14
    v_lshrrev_b32 v13, 2, v42
    v_add_u32 v38, v12, v11
    v_bitop3_b32 v42, v5, v13, v14 bitop3:0xea
    v_mul_hi_u32_u24 v14, 429497, v39
    v_lshrrev_b32 v12, 3, v43
    v_cos_f32 v10, v10
    v_lshlrev_b16 v13, 3, v43
    v_mad_i32_i24 v11, v14, s55, v39
    v_bitop3_b32 v12, v6, v13, v12 bitop3:0xca
    v_lshl_add_u32 v11, v11, 17, s40
    v_lshlrev_b16 v14, 8, v14
    v_lshrrev_b32 v13, 2, v43
    v_add_u32 v39, v12, v11
    v_bitop3_b32 v43, v5, v13, v14 bitop3:0xea
    v_cvt_pk_bf16_f32 v27, v9, v10
    v_perm_b32 v12, v27, v27, s41
    v_bitop3_b32 v38, v4, v12, v38 bitop3:0xca
    v_perm_b32 v13, v27, v27, s42
    v_bitop3_b32 v39, v4, v13, v39 bitop3:0xca
    v_add_u32 v7, s72, v0
    v_add_u32 v12, s73, v0
    v_add_u32 v13, s85, v0
    v_add_u32 v14, s91, v0
    v_add_u32 v15, s93, v0
    s_min_i32 s3, s72, s73
    s_min_i32 s3, s3, s85
    s_min_i32 s3, s3, s91
    s_min_i32 s3, s3, s93
    v_add_u32 v3, s3, v0
    v_mov_b32 v8, 0
    v_mov_b32 v9, 0
    v_mov_b32 v10, 0
    v_mov_b32 v11, 0
    s_waitcnt lgkmcnt(0)
    s_barrier
    ds_read_b128 v[56:59], v7 offset:0
    ds_read_b128 v[60:63], v12 offset:0
    ds_read_b128 v[68:71], v13 offset:0
    ds_read_b128 v[72:75], v14 offset:0
    ds_read_b128 v[64:67], v15 offset:0
    ds_write_b128 v3, v[8:11]
    ds_read_b128 v[76:79], v7 offset:16384
    ds_read_b128 v[80:83], v12 offset:16384
    ds_read_b128 v[88:91], v13 offset:16384
    ds_read_b128 v[92:95], v14 offset:16384
    ds_read_b128 v[84:87], v15 offset:16384
    s_waitcnt lgkmcnt(0)
    s_barrier
    s_setprio 3
    s_add_u32 s47, s35, 0x4000
    s_add_u32 s47, s47, s72
    buffer_store_dwordx4 v[56:59], v0, s[20:23], s47 offen sc1
    s_add_u32 s44, s96, 0x3c00000
    s_nop 0
    v_lshlrev_b32 v56, 1, v1
    buffer_load_dwordx4 v[56:59], v56, s[8:11], s44 offen nt
    s_add_u32 s45, s35, 0x4000
    s_add_u32 s45, s45, s73
    buffer_store_dwordx4 v[60:63], v0, s[20:23], s45 offen sc1
    s_add_u32 s46, s96, 0x3c00000
    s_nop 0
    v_lshlrev_b32 v60, 1, v1
    buffer_load_dwordx4 v[60:63], v60, s[12:15], s46 offen nt
    ds_add_u32 v104, v2
    ds_add_u32 v105, v2
    ds_add_u32 v106, v2
    ds_add_u32 v107, v2
    ds_add_u32 v112, v2
    ds_add_u32 v113, v2
    ds_add_u32 v114, v2
    ds_add_u32 v115, v2
    s_setprio 2
    ds_add_u32 v120, v2
    ds_add_u32 v121, v2
    ds_add_u32 v122, v2
    ds_add_u32 v123, v2
    ds_add_u32 v20, v2
    ds_add_u32 v21, v2
    ds_add_u32 v22, v2
    ds_add_u32 v23, v2
    s_setprio 1
    s_add_u32 s47, s35, 0x4000
    s_add_u32 s47, s47, s85
    buffer_store_dwordx4 v[68:71], v0, s[20:23], s47 offen sc1
    s_add_u32 s44, s96, 0x4000000
    s_nop 0
    v_lshlrev_b32 v68, 1, v1
    buffer_load_dwordx4 v[68:71], v68, s[8:11], s44 offen nt
    ds_add_u32 v32, v2
    ds_add_u32 v33, v2
    ds_add_u32 v34, v2
    ds_add_u32 v35, v2
    ds_add_u32 v40, v2
    ds_add_u32 v41, v2
    ds_add_u32 v42, v2
    ds_add_u32 v43, v2
    s_setprio 0
    s_waitcnt vmcnt(6)
    v_lshlrev_b32 v7, 16, v44
    v_and_b32 v8, 0xffff0000, v44
    v_lshlrev_b32 v9, 16, v45
    v_and_b32 v10, 0xffff0000, v45
    v_mul_f32 v7, 0.15915494, v7
    v_mul_f32 v8, 0.15915494, v8
    v_mul_f32 v9, 0.15915494, v9
    v_mul_f32 v10, 0.15915494, v10
    v_mul_hi_u32_u24 v14, 429497, v48
    v_lshrrev_b32 v12, 3, v52
    v_cos_f32 v7, v7
    v_lshlrev_b16 v13, 3, v52
    v_mad_i32_i24 v11, v14, s55, v48
    v_bitop3_b32 v12, v6, v13, v12 bitop3:0xca
    v_lshl_add_u32 v11, v11, 17, s40
    v_lshlrev_b16 v14, 8, v14
    v_lshrrev_b32 v13, 2, v52
    v_add_u32 v48, v12, v11
    v_bitop3_b32 v52, v5, v13, v14 bitop3:0xea
    ds_add_u32 v52, v2
    v_mul_hi_u32_u24 v14, 429497, v49
    v_lshrrev_b32 v12, 3, v53
    v_cos_f32 v8, v8
    v_lshlrev_b16 v13, 3, v53
    v_mad_i32_i24 v11, v14, s55, v49
    v_bitop3_b32 v12, v6, v13, v12 bitop3:0xca
    v_lshl_add_u32 v11, v11, 17, s40
    v_lshlrev_b16 v14, 8, v14
    v_lshrrev_b32 v13, 2, v53
    v_add_u32 v49, v12, v11
    v_bitop3_b32 v53, v5, v13, v14 bitop3:0xea
    ds_add_u32 v53, v2
    v_cvt_pk_bf16_f32 v44, v7, v8
    v_perm_b32 v12, v44, v44, s41
    v_bitop3_b32 v48, v4, v12, v48 bitop3:0xca
    v_perm_b32 v13, v44, v44, s42
    v_bitop3_b32 v49, v4, v13, v49 bitop3:0xca
    v_mul_hi_u32_u24 v14, 429497, v50
    v_lshrrev_b32 v12, 3, v54
    v_cos_f32 v9, v9
    v_lshlrev_b16 v13, 3, v54
    v_mad_i32_i24 v11, v14, s55, v50
    v_bitop3_b32 v12, v6, v13, v12 bitop3:0xca
    v_lshl_add_u32 v11, v11, 17, s40
    v_lshlrev_b16 v14, 8, v14
    v_lshrrev_b32 v13, 2, v54
    v_add_u32 v50, v12, v11
    v_bitop3_b32 v54, v5, v13, v14 bitop3:0xea
    ds_add_u32 v54, v2
    v_mul_hi_u32_u24 v14, 429497, v51
    v_lshrrev_b32 v12, 3, v55
    v_cos_f32 v10, v10
    v_lshlrev_b16 v13, 3, v55
    v_mad_i32_i24 v11, v14, s55, v51
    v_bitop3_b32 v12, v6, v13, v12 bitop3:0xca
    v_lshl_add_u32 v11, v11, 17, s40
    v_lshlrev_b16 v14, 8, v14
    v_lshrrev_b32 v13, 2, v55
    v_add_u32 v51, v12, v11
    v_bitop3_b32 v55, v5, v13, v14 bitop3:0xea
    ds_add_u32 v55, v2
    v_cvt_pk_bf16_f32 v45, v9, v10
    v_perm_b32 v12, v45, v45, s41
    v_bitop3_b32 v50, v4, v12, v50 bitop3:0xca
    v_perm_b32 v13, v45, v45, s42
    v_bitop3_b32 v51, v4, v13, v51 bitop3:0xca
    s_waitcnt vmcnt(2)
    v_lshlrev_b32 v7, 16, v46
    v_and_b32 v8, 0xffff0000, v46
    v_lshlrev_b32 v9, 16, v47
    v_and_b32 v10, 0xffff0000, v47
    v_mul_f32 v7, 0.15915494, v7
    v_mul_f32 v8, 0.15915494, v8
    v_mul_f32 v9, 0.15915494, v9
    v_mul_f32 v10, 0.15915494, v10
    v_mul_hi_u32_u24 v14, 429497, v56
    v_lshrrev_b32 v12, 3, v60
    v_cos_f32 v7, v7
    v_lshlrev_b16 v13, 3, v60
    v_mad_i32_i24 v11, v14, s55, v56
    v_bitop3_b32 v12, v6, v13, v12 bitop3:0xca
    v_lshl_add_u32 v11, v11, 17, s40
    v_lshlrev_b16 v14, 8, v14
    v_lshrrev_b32 v13, 2, v60
    v_add_u32 v56, v12, v11
    v_bitop3_b32 v60, v5, v13, v14 bitop3:0xea
    ds_add_u32 v60, v2
    v_mul_hi_u32_u24 v14, 429497, v57
    v_lshrrev_b32 v12, 3, v61
    v_cos_f32 v8, v8
    v_lshlrev_b16 v13, 3, v61
    v_mad_i32_i24 v11, v14, s55, v57
    v_bitop3_b32 v12, v6, v13, v12 bitop3:0xca
    v_lshl_add_u32 v11, v11, 17, s40
    v_lshlrev_b16 v14, 8, v14
    v_lshrrev_b32 v13, 2, v61
    v_add_u32 v57, v12, v11
    v_bitop3_b32 v61, v5, v13, v14 bitop3:0xea
    ds_add_u32 v61, v2
    v_cvt_pk_bf16_f32 v46, v7, v8
    v_perm_b32 v12, v46, v46, s41
    v_bitop3_b32 v56, v4, v12, v56 bitop3:0xca
    v_perm_b32 v13, v46, v46, s42
    v_bitop3_b32 v57, v4, v13, v57 bitop3:0xca
    v_mul_hi_u32_u24 v14, 429497, v58
    v_lshrrev_b32 v12, 3, v62
    v_cos_f32 v9, v9
    v_lshlrev_b16 v13, 3, v62
    v_mad_i32_i24 v11, v14, s55, v58
    v_bitop3_b32 v12, v6, v13, v12 bitop3:0xca
    v_lshl_add_u32 v11, v11, 17, s40
    v_lshlrev_b16 v14, 8, v14
    v_lshrrev_b32 v13, 2, v62
    v_add_u32 v58, v12, v11
    v_bitop3_b32 v62, v5, v13, v14 bitop3:0xea
    ds_add_u32 v62, v2
    v_mul_hi_u32_u24 v14, 429497, v59
    v_lshrrev_b32 v12, 3, v63
    v_cos_f32 v10, v10
    v_lshlrev_b16 v13, 3, v63
    v_mad_i32_i24 v11, v14, s55, v59
    v_bitop3_b32 v12, v6, v13, v12 bitop3:0xca
    v_lshl_add_u32 v11, v11, 17, s40
    v_lshlrev_b16 v14, 8, v14
    v_lshrrev_b32 v13, 2, v63
    v_add_u32 v59, v12, v11
    v_bitop3_b32 v63, v5, v13, v14 bitop3:0xea
    ds_add_u32 v63, v2
    v_cvt_pk_bf16_f32 v47, v9, v10
    v_perm_b32 v12, v47, v47, s41
    v_bitop3_b32 v58, v4, v12, v58 bitop3:0xca
    v_perm_b32 v13, v47, v47, s42
    v_bitop3_b32 v59, v4, v13, v59 bitop3:0xca
    v_lshrrev_b32 v8, 2, v0
    v_and_b32 v7, 0x3c00, v0
    v_bitop3_b32 v7, v5, v8, v7 bitop3:0xea
    s_waitcnt lgkmcnt(0)
    s_barrier
    ds_read2st64_b32 v[8:9], v7 offset0:0 offset1:1
    ds_read2st64_b32 v[10:11], v7 offset0:2 offset1:3
    s_add_u32 s45, s35, 0x4000
    s_add_u32 s45, s45, s91
    buffer_store_dwordx4 v[72:75], v0, s[20:23], s45 offen sc1
    s_add_u32 s46, s96, 0x4000000
    s_nop 0
    v_lshlrev_b32 v72, 1, v1
    buffer_load_dwordx4 v[72:75], v72, s[12:15], s46 offen nt
    s_waitcnt lgkmcnt(0)
    v_lshl_or_b32 v12, v9, 16, v8
    v_lshl_or_b32 v13, v11, 16, v10
    v_mov_b32 v14, v12
    v_mov_b32 v15, v13
    s_nop 0
    v_add_u32_dpp v14, v14, v14 row_shr:1 row_mask:0xf bank_mask:0xf bound_ctrl:1
    v_add_u32_dpp v15, v15, v15 row_shr:1 row_mask:0xf bank_mask:0xf bound_ctrl:1
    s_nop 0
    v_add_u32_dpp v14, v14, v14 row_shr:2 row_mask:0xf bank_mask:0xf bound_ctrl:1
    v_add_u32_dpp v15, v15, v15 row_shr:2 row_mask:0xf bank_mask:0xf bound_ctrl:1
    s_nop 0
    v_add_u32_dpp v14, v14, v14 row_shr:4 row_mask:0xf bank_mask:0xf bound_ctrl:1
    v_add_u32_dpp v15, v15, v15 row_shr:4 row_mask:0xf bank_mask:0xf bound_ctrl:1
    s_nop 0
    v_add_u32_dpp v14, v14, v14 row_shr:8 row_mask:0xf bank_mask:0xf bound_ctrl:1
    v_add_u32_dpp v15, v15, v15 row_shr:8 row_mask:0xf bank_mask:0xf bound_ctrl:1
    s_nop 0
    v_add_u32_dpp v14, v14, v14 row_bcast:15 row_mask:0xa bank_mask:0xf
    v_add_u32_dpp v15, v15, v15 row_bcast:15 row_mask:0xa bank_mask:0xf
    s_nop 0
    v_add_u32_dpp v14, v14, v14 row_bcast:31 row_mask:0xc bank_mask:0xf
    v_add_u32_dpp v15, v15, v15 row_bcast:31 row_mask:0xc bank_mask:0xf
    v_readlane_b32 s48, v14, 63
    v_readlane_b32 s49, v15, 63
    s_lshl_b32 s54, s32, 2
    v_mov_b32 v8, s54
    s_and_b32 s50, s48, 0xffff
    s_lshr_b32 s51, s48, 16
    s_and_b32 s52, s49, 0xffff
    s_lshr_b32 s53, s49, 16
    s_add_u32 s51, s51, s50
    s_add_u32 s52, s52, s51
    s_add_u32 s53, s53, s52
    v_mov_b32 v9, s53
    s_mov_b64 exec, 1
    ds_write_b32 v8, v9 offset:16384
    s_mov_b64 exec, -1
    v_and_b32 v8, 60, v7
    s_waitcnt lgkmcnt(0)
    s_barrier
    ds_read_b32 v9, v8 offset:16384
    s_waitcnt lgkmcnt(0)
    v_add_u32_dpp v9, v9, v9 row_shr:1 row_mask:0xf bank_mask:0xf bound_ctrl:1
    s_nop 1
    v_add_u32_dpp v9, v9, v9 row_shr:2 row_mask:0xf bank_mask:0xf bound_ctrl:1
    s_nop 1
    v_add_u32_dpp v9, v9, v9 row_shr:4 row_mask:0xf bank_mask:0xf bound_ctrl:1
    s_nop 1
    v_add_u32_dpp v9, v9, v9 row_shr:8 row_mask:0xf bank_mask:0xf bound_ctrl:1
    s_nop 0
    v_readlane_b32 s54, v9, s32
    s_sub_u32 s54, s54, s53
    s_add_u32 s50, s50, s54
    s_add_u32 s51, s51, s54
    s_add_u32 s52, s52, s54
    s_pack_ll_b32_b16 s48, s54, s50
    s_pack_ll_b32_b16 s49, s51, s52
    v_add_u32 v14, s48, v14
    v_add_u32 v15, s49, v15
    v_sub_u32 v12, v14, v12
    v_sub_u32 v13, v15, v13
    v_and_b32 v8, 0xffff, v12
    v_lshrrev_b32 v9, 16, v12
    v_and_b32 v10, 0xffff, v13
    v_lshrrev_b32 v11, 16, v13
    ds_write2st64_b32 v7, v8, v9 offset0:0 offset1:1
    ds_write2st64_b32 v7, v10, v11 offset0:2 offset1:3
    v_and_b32 v8, 0x3f0, v0
    v_lshl_add_u32 v8, v8, 1, s36
    ds_write_b64 v8, v[12:13] offset:20480
    s_bitset0_b64 exec, 63
    s_not_b64 exec, exec
    ds_write_b64 v8, v[14:15] offset:20512
    s_mov_b64 exec, -1
    s_waitcnt lgkmcnt(0)
    s_barrier
    s_setprio 3
    ds_add_rtn_u32 v104, v104, v2
    ds_add_rtn_u32 v105, v105, v2
    ds_add_rtn_u32 v106, v106, v2
    ds_add_rtn_u32 v107, v107, v2
    ds_read_b128 v[12:15], v0 offset:20480
    v_cmp_gt_u32 vcc, 8448, v0
    s_add_u32 s47, s35, 0x4000
    s_add_u32 s47, s47, s93
    buffer_store_dwordx4 v[64:67], v0, s[20:23], s47 offen sc1
    s_add_u32 s44, s96, 0x4000000
    s_lshr_b32 s44, s44, 1
    buffer_load_dwordx2 v[64:65], v1, s[16:19], s44 offen nt
    s_add_u32 s45, s96, 0x4400000
    s_lshr_b32 s45, s45, 1
    buffer_load_dwordx2 v[66:67], v1, s[16:19], s45 offen nt
    ds_add_rtn_u32 v112, v112, v2
    ds_add_rtn_u32 v113, v113, v2
    ds_add_rtn_u32 v114, v114, v2
    ds_add_rtn_u32 v115, v115, v2
    s_setprio 2
    ds_add_rtn_u32 v120, v120, v2
    ds_add_rtn_u32 v121, v121, v2
    ds_add_rtn_u32 v122, v122, v2
    ds_add_rtn_u32 v123, v123, v2
    s_waitcnt lgkmcnt(8)
    s_cbranch_vccz L1_p2
    s_add_u32 s46, s35, 0x2a40000
    s_mov_b64 exec, vcc
    buffer_store_dwordx4 v[12:15], v0, s[24:27], s46 offen sc1
    s_mov_b64 exec, -1
L1_p2:
    s_add_u32 s47, s35, 0x8000
    s_add_u32 s47, s47, s72
    buffer_store_dwordx4 v[76:79], v0, s[20:23], s47 offen sc1
    s_add_u32 s44, s96, 0x4400000
    s_nop 0
    v_lshlrev_b32 v76, 1, v1
    buffer_load_dwordx4 v[76:79], v76, s[8:11], s44 offen nt
    ds_add_rtn_u32 v20, v20, v2
    ds_add_rtn_u32 v21, v21, v2
    ds_add_rtn_u32 v22, v22, v2
    ds_add_rtn_u32 v23, v23, v2
    s_setprio 1
    ds_add_rtn_u32 v32, v32, v2
    ds_add_rtn_u32 v33, v33, v2
    ds_add_rtn_u32 v34, v34, v2
    ds_add_rtn_u32 v35, v35, v2
    ds_add_rtn_u32 v40, v40, v2
    ds_add_rtn_u32 v41, v41, v2
    ds_add_rtn_u32 v42, v42, v2
    ds_add_rtn_u32 v43, v43, v2
    s_add_u32 s45, s35, 0x8000
    s_add_u32 s45, s45, s73
    buffer_store_dwordx4 v[80:83], v0, s[20:23], s45 offen sc1
    s_add_u32 s46, s96, 0x4400000
    s_nop 0
    v_lshlrev_b32 v80, 1, v1
    buffer_load_dwordx4 v[80:83], v80, s[12:15], s46 offen nt
    s_setprio 0
    ds_add_rtn_u32 v52, v52, v2
    ds_add_rtn_u32 v53, v53, v2
    ds_add_rtn_u32 v54, v54, v2
    ds_add_rtn_u32 v55, v55, v2
    ds_add_rtn_u32 v60, v60, v2
    ds_add_rtn_u32 v61, v61, v2
    ds_add_rtn_u32 v62, v62, v2
    ds_add_rtn_u32 v63, v63, v2
    s_waitcnt lgkmcnt(0)
    s_barrier
    s_setprio 3
    v_and_b32 v7, -4, v104
    v_lshl_add_u32 v8, v104, 2, v7
    ds_write_b32 v8, v96
    v_lshl_add_u32 v7, v7, 2, v104
    ds_write_b8 v7, v108 offset:16
    v_and_b32 v9, -4, v105
    v_lshl_add_u32 v10, v105, 2, v9
    ds_write_b32 v10, v97
    v_lshl_add_u32 v9, v9, 2, v105
    ds_write_b8_d16_hi v9, v108 offset:16
    v_and_b32 v7, -4, v106
    v_lshl_add_u32 v8, v106, 2, v7
    ds_write_b32 v8, v98
    v_lshl_add_u32 v7, v7, 2, v106
    ds_write_b8 v7, v109 offset:16
    v_and_b32 v9, -4, v107
    v_lshl_add_u32 v10, v107, 2, v9
    ds_write_b32 v10, v99
    v_lshl_add_u32 v9, v9, 2, v107
    ds_write_b8_d16_hi v9, v109 offset:16
    s_add_u32 s47, s35, 0x8000
    s_add_u32 s47, s47, s85
    buffer_store_dwordx4 v[88:91], v0, s[20:23], s47 offen sc1
    s_add_u32 s44, s96, 0x4800000
    v_lshlrev_b32 v96, 1, v1
    buffer_load_dwordx4 v[96:99], v96, s[8:11], s44 offen nt
    s_add_u32 s45, s96, 0x4800000
    v_lshlrev_b32 v104, 1, v1
    buffer_load_dwordx4 v[104:107], v104, s[12:15], s45 offen nt
    v_and_b32 v7, -4, v112
    v_lshl_add_u32 v8, v112, 2, v7
    ds_write_b32 v8, v100
    v_lshl_add_u32 v7, v7, 2, v112
    ds_write_b8 v7, v110 offset:16
    v_and_b32 v9, -4, v113
    v_lshl_add_u32 v10, v113, 2, v9
    ds_write_b32 v10, v101
    v_lshl_add_u32 v9, v9, 2, v113
    ds_write_b8_d16_hi v9, v110 offset:16
    v_and_b32 v7, -4, v114
    v_lshl_add_u32 v8, v114, 2, v7
    ds_write_b32 v8, v102
    v_lshl_add_u32 v7, v7, 2, v114
    ds_write_b8 v7, v111 offset:16
    v_and_b32 v9, -4, v115
    v_lshl_add_u32 v10, v115, 2, v9
    ds_write_b32 v10, v103
    v_lshl_add_u32 v9, v9, 2, v115
    ds_write_b8_d16_hi v9, v111 offset:16
    s_add_u32 s46, s96, 0x4800000
    s_lshr_b32 s46, s46, 1
    buffer_load_dwordx2 v[88:89], v1, s[16:19], s46 offen nt
    s_add_u32 s47, s96, 0x4c00000
    s_lshr_b32 s47, s47, 1
    buffer_load_dwordx2 v[90:91], v1, s[16:19], s47 offen nt
    s_add_u32 s44, s96, 0x4c00000
    v_lshlrev_b32 v100, 1, v1
    buffer_load_dwordx4 v[100:103], v100, s[8:11], s44 offen nt
    s_waitcnt vmcnt(10)
    v_lshlrev_b32 v7, 16, v64
    v_and_b32 v8, 0xffff0000, v64
    v_lshlrev_b32 v9, 16, v65
    v_and_b32 v10, 0xffff0000, v65
    v_mul_f32 v7, 0.15915494, v7
    v_mul_f32 v8, 0.15915494, v8
    v_mul_f32 v9, 0.15915494, v9
    v_mul_f32 v10, 0.15915494, v10
    v_mul_hi_u32_u24 v14, 429497, v68
    v_lshrrev_b32 v12, 3, v72
    v_cos_f32 v7, v7
    v_lshlrev_b16 v13, 3, v72
    v_mad_i32_i24 v11, v14, s55, v68
    v_bitop3_b32 v12, v6, v13, v12 bitop3:0xca
    v_lshl_add_u32 v11, v11, 17, s40
    v_lshlrev_b16 v14, 8, v14
    v_lshrrev_b32 v13, 2, v72
    v_add_u32 v68, v12, v11
    v_bitop3_b32 v72, v5, v13, v14 bitop3:0xea
    v_mul_hi_u32_u24 v14, 429497, v69
    v_lshrrev_b32 v12, 3, v73
    v_cos_f32 v8, v8
    v_lshlrev_b16 v13, 3, v73
    v_mad_i32_i24 v11, v14, s55, v69
    v_bitop3_b32 v12, v6, v13, v12 bitop3:0xca
    v_lshl_add_u32 v11, v11, 17, s40
    v_lshlrev_b16 v14, 8, v14
    v_lshrrev_b32 v13, 2, v73
    v_add_u32 v69, v12, v11
    v_bitop3_b32 v73, v5, v13, v14 bitop3:0xea
    v_cvt_pk_bf16_f32 v64, v7, v8
    v_perm_b32 v12, v64, v64, s41
    v_bitop3_b32 v68, v4, v12, v68 bitop3:0xca
    v_perm_b32 v13, v64, v64, s42
    v_bitop3_b32 v69, v4, v13, v69 bitop3:0xca
    v_mul_hi_u32_u24 v14, 429497, v70
    v_lshrrev_b32 v12, 3, v74
    v_cos_f32 v9, v9
    v_lshlrev_b16 v13, 3, v74
    v_mad_i32_i24 v11, v14, s55, v70
    v_bitop3_b32 v12, v6, v13, v12 bitop3:0xca
    v_lshl_add_u32 v11, v11, 17, s40
    v_lshlrev_b16 v14, 8, v14
    v_lshrrev_b32 v13, 2, v74
    v_add_u32 v70, v12, v11
    v_bitop3_b32 v74, v5, v13, v14 bitop3:0xea
    v_mul_hi_u32_u24 v14, 429497, v71
    v_lshrrev_b32 v12, 3, v75
    v_cos_f32 v10, v10
    v_lshlrev_b16 v13, 3, v75
    v_mad_i32_i24 v11, v14, s55, v71
    v_bitop3_b32 v12, v6, v13, v12 bitop3:0xca
    v_lshl_add_u32 v11, v11, 17, s40
    v_lshlrev_b16 v14, 8, v14
    v_lshrrev_b32 v13, 2, v75
    v_add_u32 v71, v12, v11
    v_bitop3_b32 v75, v5, v13, v14 bitop3:0xea
    v_cvt_pk_bf16_f32 v65, v9, v10
    v_perm_b32 v12, v65, v65, s41
    v_bitop3_b32 v70, v4, v12, v70 bitop3:0xca
    v_perm_b32 v13, v65, v65, s42
    v_bitop3_b32 v71, v4, v13, v71 bitop3:0xca
    s_setprio 2
    v_and_b32 v7, -4, v120
    v_lshl_add_u32 v8, v120, 2, v7
    ds_write_b32 v8, v116
    v_lshl_add_u32 v7, v7, 2, v120
    ds_write_b8 v7, v124 offset:16
    v_and_b32 v9, -4, v121
    v_lshl_add_u32 v10, v121, 2, v9
    ds_write_b32 v10, v117
    v_lshl_add_u32 v9, v9, 2, v121
    ds_write_b8_d16_hi v9, v124 offset:16
    v_and_b32 v7, -4, v122
    v_lshl_add_u32 v8, v122, 2, v7
    ds_write_b32 v8, v118
    v_lshl_add_u32 v7, v7, 2, v122
    ds_write_b8 v7, v125 offset:16
    v_and_b32 v9, -4, v123
    v_lshl_add_u32 v10, v123, 2, v9
    ds_write_b32 v10, v119
    v_lshl_add_u32 v9, v9, 2, v123
    ds_write_b8_d16_hi v9, v125 offset:16
    s_add_u32 s45, s35, 0x8000
    s_add_u32 s45, s45, s91
    buffer_store_dwordx4 v[92:95], v0, s[20:23], s45 offen sc1
    s_add_u32 s46, s96, 0x4c00000
    v_lshlrev_b32 v112, 1, v1
    buffer_load_dwordx4 v[112:115], v112, s[12:15], s46 offen nt
    s_waitcnt vmcnt(8)
    v_lshlrev_b32 v7, 16, v66
    v_and_b32 v8, 0xffff0000, v66
    v_lshlrev_b32 v9, 16, v67
    v_and_b32 v10, 0xffff0000, v67
    v_mul_f32 v7, 0.15915494, v7
    v_mul_f32 v8, 0.15915494, v8
    v_mul_f32 v9, 0.15915494, v9
    v_mul_f32 v10, 0.15915494, v10
    v_mul_hi_u32_u24 v14, 429497, v76
    v_lshrrev_b32 v12, 3, v80
    v_cos_f32 v7, v7
    v_lshlrev_b16 v13, 3, v80
    v_mad_i32_i24 v11, v14, s55, v76
    v_bitop3_b32 v12, v6, v13, v12 bitop3:0xca
    v_lshl_add_u32 v11, v11, 17, s40
    v_lshlrev_b16 v14, 8, v14
    v_lshrrev_b32 v13, 2, v80
    v_add_u32 v76, v12, v11
    v_bitop3_b32 v80, v5, v13, v14 bitop3:0xea
    v_mul_hi_u32_u24 v14, 429497, v77
    v_lshrrev_b32 v12, 3, v81
    v_cos_f32 v8, v8
    v_lshlrev_b16 v13, 3, v81
    v_mad_i32_i24 v11, v14, s55, v77
    v_bitop3_b32 v12, v6, v13, v12 bitop3:0xca
    v_lshl_add_u32 v11, v11, 17, s40
    v_lshlrev_b16 v14, 8, v14
    v_lshrrev_b32 v13, 2, v81
    v_add_u32 v77, v12, v11
    v_bitop3_b32 v81, v5, v13, v14 bitop3:0xea
    v_cvt_pk_bf16_f32 v66, v7, v8
    v_perm_b32 v12, v66, v66, s41
    v_bitop3_b32 v76, v4, v12, v76 bitop3:0xca
    v_perm_b32 v13, v66, v66, s42
    v_bitop3_b32 v77, v4, v13, v77 bitop3:0xca
    v_mul_hi_u32_u24 v14, 429497, v78
    v_lshrrev_b32 v12, 3, v82
    v_cos_f32 v9, v9
    v_lshlrev_b16 v13, 3, v82
    v_mad_i32_i24 v11, v14, s55, v78
    v_bitop3_b32 v12, v6, v13, v12 bitop3:0xca
    v_lshl_add_u32 v11, v11, 17, s40
    v_lshlrev_b16 v14, 8, v14
    v_lshrrev_b32 v13, 2, v82
    v_add_u32 v78, v12, v11
    v_bitop3_b32 v82, v5, v13, v14 bitop3:0xea
    v_mul_hi_u32_u24 v14, 429497, v79
    v_lshrrev_b32 v12, 3, v83
    v_cos_f32 v10, v10
    v_lshlrev_b16 v13, 3, v83
    v_mad_i32_i24 v11, v14, s55, v79
    v_bitop3_b32 v12, v6, v13, v12 bitop3:0xca
    v_lshl_add_u32 v11, v11, 17, s40
    v_lshlrev_b16 v14, 8, v14
    v_lshrrev_b32 v13, 2, v83
    v_add_u32 v79, v12, v11
    v_bitop3_b32 v83, v5, v13, v14 bitop3:0xea
    v_cvt_pk_bf16_f32 v67, v9, v10
    v_perm_b32 v12, v67, v67, s41
    v_bitop3_b32 v78, v4, v12, v78 bitop3:0xca
    v_perm_b32 v13, v67, v67, s42
    v_bitop3_b32 v79, v4, v13, v79 bitop3:0xca
    v_and_b32 v7, -4, v20
    v_lshl_add_u32 v8, v20, 2, v7
    ds_write_b32 v8, v16
    v_lshl_add_u32 v7, v7, 2, v20
    ds_write_b8 v7, v126 offset:16
    v_and_b32 v9, -4, v21
    v_lshl_add_u32 v10, v21, 2, v9
    ds_write_b32 v10, v17
    v_lshl_add_u32 v9, v9, 2, v21
    ds_write_b8_d16_hi v9, v126 offset:16
    v_and_b32 v7, -4, v22
    v_lshl_add_u32 v8, v22, 2, v7
    ds_write_b32 v8, v18
    v_lshl_add_u32 v7, v7, 2, v22
    ds_write_b8 v7, v127 offset:16
    v_and_b32 v9, -4, v23
    v_lshl_add_u32 v10, v23, 2, v9
    ds_write_b32 v10, v19
    v_lshl_add_u32 v9, v9, 2, v23
    ds_write_b8_d16_hi v9, v127 offset:16
    s_add_u32 s47, s96, 0x5000000
    v_lshlrev_b32 v108, 1, v1
    buffer_load_dwordx4 v[108:111], v108, s[8:11], s47 offen nt
    s_add_u32 s44, s96, 0x5000000
    v_lshlrev_b32 v116, 1, v1
    buffer_load_dwordx4 v[116:119], v116, s[12:15], s44 offen nt
    s_waitcnt vmcnt(5)
    v_lshlrev_b32 v7, 16, v88
    v_and_b32 v8, 0xffff0000, v88
    v_lshlrev_b32 v9, 16, v89
    v_and_b32 v10, 0xffff0000, v89
    v_mul_f32 v7, 0.15915494, v7
    v_mul_f32 v8, 0.15915494, v8
    v_mul_f32 v9, 0.15915494, v9
    v_mul_f32 v10, 0.15915494, v10
    v_mul_hi_u32_u24 v14, 429497, v96
    v_lshrrev_b32 v12, 3, v104
    v_cos_f32 v7, v7
    v_lshlrev_b16 v13, 3, v104
    v_mad_i32_i24 v11, v14, s55, v96
    v_bitop3_b32 v12, v6, v13, v12 bitop3:0xca
    v_lshl_add_u32 v11, v11, 17, s40
    v_lshlrev_b16 v14, 8, v14
    v_lshrrev_b32 v13, 2, v104
    v_add_u32 v96, v12, v11
    v_bitop3_b32 v104, v5, v13, v14 bitop3:0xea
    v_mul_hi_u32_u24 v14, 429497, v97
    v_lshrrev_b32 v12, 3, v105
    v_cos_f32 v8, v8
    v_lshlrev_b16 v13, 3, v105
    v_mad_i32_i24 v11, v14, s55, v97
    v_bitop3_b32 v12, v6, v13, v12 bitop3:0xca
    v_lshl_add_u32 v11, v11, 17, s40
    v_lshlrev_b16 v14, 8, v14
    v_lshrrev_b32 v13, 2, v105
    v_add_u32 v97, v12, v11
    v_bitop3_b32 v105, v5, v13, v14 bitop3:0xea
    v_cvt_pk_bf16_f32 v88, v7, v8
    v_perm_b32 v12, v88, v88, s41
    v_bitop3_b32 v96, v4, v12, v96 bitop3:0xca
    v_perm_b32 v13, v88, v88, s42
    v_bitop3_b32 v97, v4, v13, v97 bitop3:0xca
    v_mul_hi_u32_u24 v14, 429497, v98
    v_lshrrev_b32 v12, 3, v106
    v_cos_f32 v9, v9
    v_lshlrev_b16 v13, 3, v106
    v_mad_i32_i24 v11, v14, s55, v98
    v_bitop3_b32 v12, v6, v13, v12 bitop3:0xca
    v_lshl_add_u32 v11, v11, 17, s40
    v_lshlrev_b16 v14, 8, v14
    v_lshrrev_b32 v13, 2, v106
    v_add_u32 v98, v12, v11
    v_bitop3_b32 v106, v5, v13, v14 bitop3:0xea
    v_mul_hi_u32_u24 v14, 429497, v99
    v_lshrrev_b32 v12, 3, v107
    v_cos_f32 v10, v10
    v_lshlrev_b16 v13, 3, v107
    v_mad_i32_i24 v11, v14, s55, v99
    v_bitop3_b32 v12, v6, v13, v12 bitop3:0xca
    v_lshl_add_u32 v11, v11, 17, s40
    v_lshlrev_b16 v14, 8, v14
    v_lshrrev_b32 v13, 2, v107
    v_add_u32 v99, v12, v11
    v_bitop3_b32 v107, v5, v13, v14 bitop3:0xea
    v_cvt_pk_bf16_f32 v89, v9, v10
    v_perm_b32 v12, v89, v89, s41
    v_bitop3_b32 v98, v4, v12, v98 bitop3:0xca
    v_perm_b32 v13, v89, v89, s42
    v_bitop3_b32 v99, v4, v13, v99 bitop3:0xca
    s_setprio 1
    v_and_b32 v7, -4, v32
    v_lshl_add_u32 v8, v32, 2, v7
    ds_write_b32 v8, v28
    v_lshl_add_u32 v7, v7, 2, v32
    ds_write_b8 v7, v24 offset:16
    v_and_b32 v9, -4, v33
    v_lshl_add_u32 v10, v33, 2, v9
    ds_write_b32 v10, v29
    v_lshl_add_u32 v9, v9, 2, v33
    ds_write_b8_d16_hi v9, v24 offset:16
    v_and_b32 v7, -4, v34
    v_lshl_add_u32 v8, v34, 2, v7
    ds_write_b32 v8, v30
    v_lshl_add_u32 v7, v7, 2, v34
    ds_write_b8 v7, v25 offset:16
    v_and_b32 v9, -4, v35
    v_lshl_add_u32 v10, v35, 2, v9
    ds_write_b32 v10, v31
    v_lshl_add_u32 v9, v9, 2, v35
    ds_write_b8_d16_hi v9, v25 offset:16
    s_add_u32 s45, s96, 0x5000000
    s_lshr_b32 s45, s45, 1
    buffer_load_dwordx2 v[120:121], v1, s[16:19], s45 offen nt
    s_add_u32 s46, s96, 0x5400000
    s_lshr_b32 s46, s46, 1
    buffer_load_dwordx2 v[122:123], v1, s[16:19], s46 offen nt
    s_add_u32 s47, s96, 0x5400000
    v_lshlrev_b32 v92, 1, v1
    buffer_load_dwordx4 v[92:95], v92, s[8:11], s47 offen nt
    v_and_b32 v7, -4, v40
    v_lshl_add_u32 v8, v40, 2, v7
    ds_write_b32 v8, v36
    v_lshl_add_u32 v7, v7, 2, v40
    ds_write_b8 v7, v26 offset:16
    v_and_b32 v9, -4, v41
    v_lshl_add_u32 v10, v41, 2, v9
    ds_write_b32 v10, v37
    v_lshl_add_u32 v9, v9, 2, v41
    ds_write_b8_d16_hi v9, v26 offset:16
    v_and_b32 v7, -4, v42
    v_lshl_add_u32 v8, v42, 2, v7
    ds_write_b32 v8, v38
    v_lshl_add_u32 v7, v7, 2, v42
    ds_write_b8 v7, v27 offset:16
    v_and_b32 v9, -4, v43
    v_lshl_add_u32 v10, v43, 2, v9
    ds_write_b32 v10, v39
    v_lshl_add_u32 v9, v9, 2, v43
    ds_write_b8_d16_hi v9, v27 offset:16
    s_add_u32 s44, s35, 0x8000
    s_add_u32 s44, s44, s93
    buffer_store_dwordx4 v[84:87], v0, s[20:23], s44 offen sc1
    s_add_u32 s45, s96, 0x5400000
    v_lshlrev_b32 v16, 1, v1
    buffer_load_dwordx4 v[16:19], v16, s[12:15], s45 offen nt
    s_waitcnt vmcnt(7)
    v_lshlrev_b32 v7, 16, v90
    v_and_b32 v8, 0xffff0000, v90
    v_lshlrev_b32 v9, 16, v91
    v_and_b32 v10, 0xffff0000, v91
    v_mul_f32 v7, 0.15915494, v7
    v_mul_f32 v8, 0.15915494, v8
    v_mul_f32 v9, 0.15915494, v9
    v_mul_f32 v10, 0.15915494, v10
    v_mul_hi_u32_u24 v14, 429497, v100
    v_lshrrev_b32 v12, 3, v112
    v_cos_f32 v7, v7
    v_lshlrev_b16 v13, 3, v112
    v_mad_i32_i24 v11, v14, s55, v100
    v_bitop3_b32 v12, v6, v13, v12 bitop3:0xca
    v_lshl_add_u32 v11, v11, 17, s40
    v_lshlrev_b16 v14, 8, v14
    v_lshrrev_b32 v13, 2, v112
    v_add_u32 v100, v12, v11
    v_bitop3_b32 v112, v5, v13, v14 bitop3:0xea
    v_mul_hi_u32_u24 v14, 429497, v101
    v_lshrrev_b32 v12, 3, v113
    v_cos_f32 v8, v8
    v_lshlrev_b16 v13, 3, v113
    v_mad_i32_i24 v11, v14, s55, v101
    v_bitop3_b32 v12, v6, v13, v12 bitop3:0xca
    v_lshl_add_u32 v11, v11, 17, s40
    v_lshlrev_b16 v14, 8, v14
    v_lshrrev_b32 v13, 2, v113
    v_add_u32 v101, v12, v11
    v_bitop3_b32 v113, v5, v13, v14 bitop3:0xea
    v_cvt_pk_bf16_f32 v90, v7, v8
    v_perm_b32 v12, v90, v90, s41
    v_bitop3_b32 v100, v4, v12, v100 bitop3:0xca
    v_perm_b32 v13, v90, v90, s42
    v_bitop3_b32 v101, v4, v13, v101 bitop3:0xca
    v_mul_hi_u32_u24 v14, 429497, v102
    v_lshrrev_b32 v12, 3, v114
    v_cos_f32 v9, v9
    v_lshlrev_b16 v13, 3, v114
    v_mad_i32_i24 v11, v14, s55, v102
    v_bitop3_b32 v12, v6, v13, v12 bitop3:0xca
    v_lshl_add_u32 v11, v11, 17, s40
    v_lshlrev_b16 v14, 8, v14
    v_lshrrev_b32 v13, 2, v114
    v_add_u32 v102, v12, v11
    v_bitop3_b32 v114, v5, v13, v14 bitop3:0xea
    v_mul_hi_u32_u24 v14, 429497, v103
    v_lshrrev_b32 v12, 3, v115
    v_cos_f32 v10, v10
    v_lshlrev_b16 v13, 3, v115
    v_mad_i32_i24 v11, v14, s55, v103
    v_bitop3_b32 v12, v6, v13, v12 bitop3:0xca
    v_lshl_add_u32 v11, v11, 17, s40
    v_lshlrev_b16 v14, 8, v14
    v_lshrrev_b32 v13, 2, v115
    v_add_u32 v103, v12, v11
    v_bitop3_b32 v115, v5, v13, v14 bitop3:0xea
    v_cvt_pk_bf16_f32 v91, v9, v10
    v_perm_b32 v12, v91, v91, s41
    v_bitop3_b32 v102, v4, v12, v102 bitop3:0xca
    v_perm_b32 v13, v91, v91, s42
    v_bitop3_b32 v103, v4, v13, v103 bitop3:0xca
    s_setprio 0
    v_and_b32 v7, -4, v52
    v_lshl_add_u32 v8, v52, 2, v7
    ds_write_b32 v8, v48
    v_lshl_add_u32 v7, v7, 2, v52
    ds_write_b8 v7, v44 offset:16
    v_and_b32 v9, -4, v53
    v_lshl_add_u32 v10, v53, 2, v9
    ds_write_b32 v10, v49
    v_lshl_add_u32 v9, v9, 2, v53
    ds_write_b8_d16_hi v9, v44 offset:16
    v_and_b32 v7, -4, v54
    v_lshl_add_u32 v8, v54, 2, v7
    ds_write_b32 v8, v50
    v_lshl_add_u32 v7, v7, 2, v54
    ds_write_b8 v7, v45 offset:16
    v_and_b32 v9, -4, v55
    v_lshl_add_u32 v10, v55, 2, v9
    ds_write_b32 v10, v51
    v_lshl_add_u32 v9, v9, 2, v55
    ds_write_b8_d16_hi v9, v45 offset:16
    s_add_u32 s46, s96, 0x5800000
    v_lshlrev_b32 v20, 1, v1
    buffer_load_dwordx4 v[20:23], v20, s[8:11], s46 offen nt
    s_add_u32 s47, s96, 0x5800000
    v_lshlrev_b32 v124, 1, v1
    buffer_load_dwordx4 v[124:127], v124, s[12:15], s47 offen nt
    s_waitcnt vmcnt(5)
    v_lshlrev_b32 v7, 16, v120
    v_and_b32 v8, 0xffff0000, v120
    v_lshlrev_b32 v9, 16, v121
    v_and_b32 v10, 0xffff0000, v121
    v_mul_f32 v7, 0.15915494, v7
    v_mul_f32 v8, 0.15915494, v8
    v_mul_f32 v9, 0.15915494, v9
    v_mul_f32 v10, 0.15915494, v10
    v_mul_hi_u32_u24 v14, 429497, v108
    v_lshrrev_b32 v12, 3, v116
    v_cos_f32 v7, v7
    v_lshlrev_b16 v13, 3, v116
    v_mad_i32_i24 v11, v14, s55, v108
    v_bitop3_b32 v12, v6, v13, v12 bitop3:0xca
    v_lshl_add_u32 v11, v11, 17, s40
    v_lshlrev_b16 v14, 8, v14
    v_lshrrev_b32 v13, 2, v116
    v_add_u32 v108, v12, v11
    v_bitop3_b32 v116, v5, v13, v14 bitop3:0xea
    v_mul_hi_u32_u24 v14, 429497, v109
    v_lshrrev_b32 v12, 3, v117
    v_cos_f32 v8, v8
    v_lshlrev_b16 v13, 3, v117
    v_mad_i32_i24 v11, v14, s55, v109
    v_bitop3_b32 v12, v6, v13, v12 bitop3:0xca
    v_lshl_add_u32 v11, v11, 17, s40
    v_lshlrev_b16 v14, 8, v14
    v_lshrrev_b32 v13, 2, v117
    v_add_u32 v109, v12, v11
    v_bitop3_b32 v117, v5, v13, v14 bitop3:0xea
    v_cvt_pk_bf16_f32 v120, v7, v8
    v_perm_b32 v12, v120, v120, s41
    v_bitop3_b32 v108, v4, v12, v108 bitop3:0xca
    v_perm_b32 v13, v120, v120, s42
    v_bitop3_b32 v109, v4, v13, v109 bitop3:0xca
    v_mul_hi_u32_u24 v14, 429497, v110
    v_lshrrev_b32 v12, 3, v118
    v_cos_f32 v9, v9
    v_lshlrev_b16 v13, 3, v118
    v_mad_i32_i24 v11, v14, s55, v110
    v_bitop3_b32 v12, v6, v13, v12 bitop3:0xca
    v_lshl_add_u32 v11, v11, 17, s40
    v_lshlrev_b16 v14, 8, v14
    v_lshrrev_b32 v13, 2, v118
    v_add_u32 v110, v12, v11
    v_bitop3_b32 v118, v5, v13, v14 bitop3:0xea
    v_mul_hi_u32_u24 v14, 429497, v111
    v_lshrrev_b32 v12, 3, v119
    v_cos_f32 v10, v10
    v_lshlrev_b16 v13, 3, v119
    v_mad_i32_i24 v11, v14, s55, v111
    v_bitop3_b32 v12, v6, v13, v12 bitop3:0xca
    v_lshl_add_u32 v11, v11, 17, s40
    v_lshlrev_b16 v14, 8, v14
    v_lshrrev_b32 v13, 2, v119
    v_add_u32 v111, v12, v11
    v_bitop3_b32 v119, v5, v13, v14 bitop3:0xea
    v_cvt_pk_bf16_f32 v121, v9, v10
    v_perm_b32 v12, v121, v121, s41
    v_bitop3_b32 v110, v4, v12, v110 bitop3:0xca
    v_perm_b32 v13, v121, v121, s42
    v_bitop3_b32 v111, v4, v13, v111 bitop3:0xca
    v_and_b32 v7, -4, v60
    v_lshl_add_u32 v8, v60, 2, v7
    ds_write_b32 v8, v56
    v_lshl_add_u32 v7, v7, 2, v60
    ds_write_b8 v7, v46 offset:16
    v_and_b32 v9, -4, v61
    v_lshl_add_u32 v10, v61, 2, v9
    ds_write_b32 v10, v57
    v_lshl_add_u32 v9, v9, 2, v61
    ds_write_b8_d16_hi v9, v46 offset:16
    v_and_b32 v7, -4, v62
    v_lshl_add_u32 v8, v62, 2, v7
    ds_write_b32 v8, v58
    v_lshl_add_u32 v7, v7, 2, v62
    ds_write_b8 v7, v47 offset:16
    v_and_b32 v9, -4, v63
    v_lshl_add_u32 v10, v63, 2, v9
    ds_write_b32 v10, v59
    v_lshl_add_u32 v9, v9, 2, v63
    ds_write_b8_d16_hi v9, v47 offset:16
    s_add_u32 s44, s96, 0x5800000
    s_lshr_b32 s44, s44, 1
    buffer_load_dwordx2 v[28:29], v1, s[16:19], s44 offen nt
    s_add_u32 s45, s96, 0x5c00000
    s_lshr_b32 s45, s45, 1
    buffer_load_dwordx2 v[30:31], v1, s[16:19], s45 offen nt
    s_waitcnt vmcnt(4)
    v_lshlrev_b32 v7, 16, v122
    v_and_b32 v8, 0xffff0000, v122
    v_lshlrev_b32 v9, 16, v123
    v_and_b32 v10, 0xffff0000, v123
    v_mul_f32 v7, 0.15915494, v7
    v_mul_f32 v8, 0.15915494, v8
    v_mul_f32 v9, 0.15915494, v9
    v_mul_f32 v10, 0.15915494, v10
    v_mul_hi_u32_u24 v14, 429497, v92
    v_lshrrev_b32 v12, 3, v16
    v_cos_f32 v7, v7
    v_lshlrev_b16 v13, 3, v16
    v_mad_i32_i24 v11, v14, s55, v92
    v_bitop3_b32 v12, v6, v13, v12 bitop3:0xca
    v_lshl_add_u32 v11, v11, 17, s40
    v_lshlrev_b16 v14, 8, v14
    v_lshrrev_b32 v13, 2, v16
    v_add_u32 v92, v12, v11
    v_bitop3_b32 v16, v5, v13, v14 bitop3:0xea
    v_mul_hi_u32_u24 v14, 429497, v93
    v_lshrrev_b32 v12, 3, v17
    v_cos_f32 v8, v8
    v_lshlrev_b16 v13, 3, v17
    v_mad_i32_i24 v11, v14, s55, v93
    v_bitop3_b32 v12, v6, v13, v12 bitop3:0xca
    v_lshl_add_u32 v11, v11, 17, s40
    v_lshlrev_b16 v14, 8, v14
    v_lshrrev_b32 v13, 2, v17
    v_add_u32 v93, v12, v11
    v_bitop3_b32 v17, v5, v13, v14 bitop3:0xea
    v_cvt_pk_bf16_f32 v122, v7, v8
    v_perm_b32 v12, v122, v122, s41
    v_bitop3_b32 v92, v4, v12, v92 bitop3:0xca
    v_perm_b32 v13, v122, v122, s42
    v_bitop3_b32 v93, v4, v13, v93 bitop3:0xca
    v_mul_hi_u32_u24 v14, 429497, v94
    v_lshrrev_b32 v12, 3, v18
    v_cos_f32 v9, v9
    v_lshlrev_b16 v13, 3, v18
    v_mad_i32_i24 v11, v14, s55, v94
    v_bitop3_b32 v12, v6, v13, v12 bitop3:0xca
    v_lshl_add_u32 v11, v11, 17, s40
    v_lshlrev_b16 v14, 8, v14
    v_lshrrev_b32 v13, 2, v18
    v_add_u32 v94, v12, v11
    v_bitop3_b32 v18, v5, v13, v14 bitop3:0xea
    v_mul_hi_u32_u24 v14, 429497, v95
    v_lshrrev_b32 v12, 3, v19
    v_cos_f32 v10, v10
    v_lshlrev_b16 v13, 3, v19
    v_mad_i32_i24 v11, v14, s55, v95
    v_bitop3_b32 v12, v6, v13, v12 bitop3:0xca
    v_lshl_add_u32 v11, v11, 17, s40
    v_lshlrev_b16 v14, 8, v14
    v_lshrrev_b32 v13, 2, v19
    v_add_u32 v95, v12, v11
    v_bitop3_b32 v19, v5, v13, v14 bitop3:0xea
    v_cvt_pk_bf16_f32 v123, v9, v10
    v_perm_b32 v12, v123, v123, s41
    v_bitop3_b32 v94, v4, v12, v94 bitop3:0xca
    v_perm_b32 v13, v123, v123, s42
    v_bitop3_b32 v95, v4, v13, v95 bitop3:0xca
    v_add_u32 v7, s72, v0
    v_add_u32 v12, s73, v0
    v_add_u32 v13, s85, v0
    v_add_u32 v14, s91, v0
    v_add_u32 v15, s93, v0
    s_min_i32 s3, s72, s73
    s_min_i32 s3, s3, s85
    s_min_i32 s3, s3, s91
    s_min_i32 s3, s3, s93
    v_add_u32 v3, s3, v0
    v_mov_b32 v8, 0
    v_mov_b32 v9, 0
    v_mov_b32 v10, 0
    v_mov_b32 v11, 0
    s_waitcnt lgkmcnt(0)
    s_barrier
    ds_read_b128 v[32:35], v7 offset:0
    ds_read_b128 v[36:39], v12 offset:0
    ds_read_b128 v[40:43], v13 offset:0
    ds_read_b128 v[24:27], v14 offset:0
    ds_read_b128 v[84:87], v15 offset:0
    ds_write_b128 v3, v[8:11]
    ds_read_b128 v[48:51], v7 offset:16384
    ds_read_b128 v[52:55], v12 offset:16384
    ds_read_b128 v[56:59], v13 offset:16384
    ds_read_b128 v[60:63], v14 offset:16384
    ds_read_b128 v[44:47], v15 offset:16384
    s_waitcnt lgkmcnt(0)
    s_barrier
    s_setprio 3
    s_add_u32 s46, s35, 0x2a44000
    s_add_u32 s46, s46, s72
    buffer_store_dwordx4 v[32:35], v0, s[20:23], s46 offen sc1
    s_add_u32 s47, s96, 0x5c00000
    s_nop 0
    v_lshlrev_b32 v32, 1, v1
    buffer_load_dwordx4 v[32:35], v32, s[8:11], s47 offen nt
    s_add_u32 s44, s35, 0x2a44000
    s_add_u32 s44, s44, s73
    buffer_store_dwordx4 v[36:39], v0, s[20:23], s44 offen sc1
    s_add_u32 s45, s96, 0x5c00000
    s_nop 0
    v_lshlrev_b32 v36, 1, v1
    buffer_load_dwordx4 v[36:39], v36, s[12:15], s45 offen nt
    ds_add_u32 v72, v2
    ds_add_u32 v73, v2
    ds_add_u32 v74, v2
    ds_add_u32 v75, v2
    ds_add_u32 v80, v2
    ds_add_u32 v81, v2
    ds_add_u32 v82, v2
    ds_add_u32 v83, v2
    s_setprio 2
    ds_add_u32 v104, v2
    ds_add_u32 v105, v2
    ds_add_u32 v106, v2
    ds_add_u32 v107, v2
    ds_add_u32 v112, v2
    ds_add_u32 v113, v2
    ds_add_u32 v114, v2
    ds_add_u32 v115, v2
    s_setprio 1
    s_add_u32 s46, s35, 0x2a44000
    s_add_u32 s46, s46, s85
    buffer_store_dwordx4 v[40:43], v0, s[20:23], s46 offen sc1
    s_add_u32 s47, s96, 0x6000000
    s_nop 0
    v_lshlrev_b32 v40, 1, v1
    buffer_load_dwordx4 v[40:43], v40, s[8:11], s47 offen nt
    ds_add_u32 v116, v2
    ds_add_u32 v117, v2
    ds_add_u32 v118, v2
    ds_add_u32 v119, v2
    ds_add_u32 v16, v2
    ds_add_u32 v17, v2
    ds_add_u32 v18, v2
    ds_add_u32 v19, v2
    s_setprio 0
    s_waitcnt vmcnt(6)
    v_lshlrev_b32 v7, 16, v28
    v_and_b32 v8, 0xffff0000, v28
    v_lshlrev_b32 v9, 16, v29
    v_and_b32 v10, 0xffff0000, v29
    v_mul_f32 v7, 0.15915494, v7
    v_mul_f32 v8, 0.15915494, v8
    v_mul_f32 v9, 0.15915494, v9
    v_mul_f32 v10, 0.15915494, v10
    v_mul_hi_u32_u24 v14, 429497, v20
    v_lshrrev_b32 v12, 3, v124
    v_cos_f32 v7, v7
    v_lshlrev_b16 v13, 3, v124
    v_mad_i32_i24 v11, v14, s55, v20
    v_bitop3_b32 v12, v6, v13, v12 bitop3:0xca
    v_lshl_add_u32 v11, v11, 17, s40
    v_lshlrev_b16 v14, 8, v14
    v_lshrrev_b32 v13, 2, v124
    v_add_u32 v20, v12, v11
    v_bitop3_b32 v124, v5, v13, v14 bitop3:0xea
    ds_add_u32 v124, v2
    v_mul_hi_u32_u24 v14, 429497, v21
    v_lshrrev_b32 v12, 3, v125
    v_cos_f32 v8, v8
    v_lshlrev_b16 v13, 3, v125
    v_mad_i32_i24 v11, v14, s55, v21
    v_bitop3_b32 v12, v6, v13, v12 bitop3:0xca
    v_lshl_add_u32 v11, v11, 17, s40
    v_lshlrev_b16 v14, 8, v14
    v_lshrrev_b32 v13, 2, v125
    v_add_u32 v21, v12, v11
    v_bitop3_b32 v125, v5, v13, v14 bitop3:0xea
    ds_add_u32 v125, v2
    v_cvt_pk_bf16_f32 v28, v7, v8
    v_perm_b32 v12, v28, v28, s41
    v_bitop3_b32 v20, v4, v12, v20 bitop3:0xca
    v_perm_b32 v13, v28, v28, s42
    v_bitop3_b32 v21, v4, v13, v21 bitop3:0xca
    v_mul_hi_u32_u24 v14, 429497, v22
    v_lshrrev_b32 v12, 3, v126
    v_cos_f32 v9, v9
    v_lshlrev_b16 v13, 3, v126
    v_mad_i32_i24 v11, v14, s55, v22
    v_bitop3_b32 v12, v6, v13, v12 bitop3:0xca
    v_lshl_add_u32 v11, v11, 17, s40
    v_lshlrev_b16 v14, 8, v14
    v_lshrrev_b32 v13, 2, v126
    v_add_u32 v22, v12, v11
    v_bitop3_b32 v126, v5, v13, v14 bitop3:0xea
    ds_add_u32 v126, v2
    v_mul_hi_u32_u24 v14, 429497, v23
    v_lshrrev_b32 v12, 3, v127
    v_cos_f32 v10, v10
    v_lshlrev_b16 v13, 3, v127
    v_mad_i32_i24 v11, v14, s55, v23
    v_bitop3_b32 v12, v6, v13, v12 bitop3:0xca
    v_lshl_add_u32 v11, v11, 17, s40
    v_lshlrev_b16 v14, 8, v14
    v_lshrrev_b32 v13, 2, v127
    v_add_u32 v23, v12, v11
    v_bitop3_b32 v127, v5, v13, v14 bitop3:0xea
    ds_add_u32 v127, v2
    v_cvt_pk_bf16_f32 v29, v9, v10
    v_perm_b32 v12, v29, v29, s41
    v_bitop3_b32 v22, v4, v12, v22 bitop3:0xca
    v_perm_b32 v13, v29, v29, s42
    v_bitop3_b32 v23, v4, v13, v23 bitop3:0xca
    s_waitcnt vmcnt(2)
    v_lshlrev_b32 v7, 16, v30
    v_and_b32 v8, 0xffff0000, v30
    v_lshlrev_b32 v9, 16, v31
    v_and_b32 v10, 0xffff0000, v31
    v_mul_f32 v7, 0.15915494, v7
    v_mul_f32 v8, 0.15915494, v8
    v_mul_f32 v9, 0.15915494, v9
    v_mul_f32 v10, 0.15915494, v10
    v_mul_hi_u32_u24 v14, 429497, v32
    v_lshrrev_b32 v12, 3, v36
    v_cos_f32 v7, v7
    v_lshlrev_b16 v13, 3, v36
    v_mad_i32_i24 v11, v14, s55, v32
    v_bitop3_b32 v12, v6, v13, v12 bitop3:0xca
    v_lshl_add_u32 v11, v11, 17, s40
    v_lshlrev_b16 v14, 8, v14
    v_lshrrev_b32 v13, 2, v36
    v_add_u32 v32, v12, v11
    v_bitop3_b32 v36, v5, v13, v14 bitop3:0xea
    ds_add_u32 v36, v2
    v_mul_hi_u32_u24 v14, 429497, v33
    v_lshrrev_b32 v12, 3, v37
    v_cos_f32 v8, v8
    v_lshlrev_b16 v13, 3, v37
    v_mad_i32_i24 v11, v14, s55, v33
    v_bitop3_b32 v12, v6, v13, v12 bitop3:0xca
    v_lshl_add_u32 v11, v11, 17, s40
    v_lshlrev_b16 v14, 8, v14
    v_lshrrev_b32 v13, 2, v37
    v_add_u32 v33, v12, v11
    v_bitop3_b32 v37, v5, v13, v14 bitop3:0xea
    ds_add_u32 v37, v2
    v_cvt_pk_bf16_f32 v30, v7, v8
    v_perm_b32 v12, v30, v30, s41
    v_bitop3_b32 v32, v4, v12, v32 bitop3:0xca
    v_perm_b32 v13, v30, v30, s42
    v_bitop3_b32 v33, v4, v13, v33 bitop3:0xca
    v_mul_hi_u32_u24 v14, 429497, v34
    v_lshrrev_b32 v12, 3, v38
    v_cos_f32 v9, v9
    v_lshlrev_b16 v13, 3, v38
    v_mad_i32_i24 v11, v14, s55, v34
    v_bitop3_b32 v12, v6, v13, v12 bitop3:0xca
    v_lshl_add_u32 v11, v11, 17, s40
    v_lshlrev_b16 v14, 8, v14
    v_lshrrev_b32 v13, 2, v38
    v_add_u32 v34, v12, v11
    v_bitop3_b32 v38, v5, v13, v14 bitop3:0xea
    ds_add_u32 v38, v2
    v_mul_hi_u32_u24 v14, 429497, v35
    v_lshrrev_b32 v12, 3, v39
    v_cos_f32 v10, v10
    v_lshlrev_b16 v13, 3, v39
    v_mad_i32_i24 v11, v14, s55, v35
    v_bitop3_b32 v12, v6, v13, v12 bitop3:0xca
    v_lshl_add_u32 v11, v11, 17, s40
    v_lshlrev_b16 v14, 8, v14
    v_lshrrev_b32 v13, 2, v39
    v_add_u32 v35, v12, v11
    v_bitop3_b32 v39, v5, v13, v14 bitop3:0xea
    ds_add_u32 v39, v2
    v_cvt_pk_bf16_f32 v31, v9, v10
    v_perm_b32 v12, v31, v31, s41
    v_bitop3_b32 v34, v4, v12, v34 bitop3:0xca
    v_perm_b32 v13, v31, v31, s42
    v_bitop3_b32 v35, v4, v13, v35 bitop3:0xca
    v_lshrrev_b32 v8, 2, v0
    v_and_b32 v7, 0x3c00, v0
    v_bitop3_b32 v7, v5, v8, v7 bitop3:0xea
    s_waitcnt lgkmcnt(0)
    s_barrier
    ds_read2st64_b32 v[8:9], v7 offset0:0 offset1:1
    ds_read2st64_b32 v[10:11], v7 offset0:2 offset1:3
    s_add_u32 s44, s35, 0x2a44000
    s_add_u32 s44, s44, s91
    buffer_store_dwordx4 v[24:27], v0, s[20:23], s44 offen sc1
    s_add_u32 s45, s96, 0x6000000
    s_nop 0
    v_lshlrev_b32 v24, 1, v1
    buffer_load_dwordx4 v[24:27], v24, s[12:15], s45 offen nt
    s_waitcnt lgkmcnt(0)
    v_lshl_or_b32 v12, v9, 16, v8
    v_lshl_or_b32 v13, v11, 16, v10
    v_mov_b32 v14, v12
    v_mov_b32 v15, v13
    s_nop 0
    v_add_u32_dpp v14, v14, v14 row_shr:1 row_mask:0xf bank_mask:0xf bound_ctrl:1
    v_add_u32_dpp v15, v15, v15 row_shr:1 row_mask:0xf bank_mask:0xf bound_ctrl:1
    s_nop 0
    v_add_u32_dpp v14, v14, v14 row_shr:2 row_mask:0xf bank_mask:0xf bound_ctrl:1
    v_add_u32_dpp v15, v15, v15 row_shr:2 row_mask:0xf bank_mask:0xf bound_ctrl:1
    s_nop 0
    v_add_u32_dpp v14, v14, v14 row_shr:4 row_mask:0xf bank_mask:0xf bound_ctrl:1
    v_add_u32_dpp v15, v15, v15 row_shr:4 row_mask:0xf bank_mask:0xf bound_ctrl:1
    s_nop 0
    v_add_u32_dpp v14, v14, v14 row_shr:8 row_mask:0xf bank_mask:0xf bound_ctrl:1
    v_add_u32_dpp v15, v15, v15 row_shr:8 row_mask:0xf bank_mask:0xf bound_ctrl:1
    s_nop 0
    v_add_u32_dpp v14, v14, v14 row_bcast:15 row_mask:0xa bank_mask:0xf
    v_add_u32_dpp v15, v15, v15 row_bcast:15 row_mask:0xa bank_mask:0xf
    s_nop 0
    v_add_u32_dpp v14, v14, v14 row_bcast:31 row_mask:0xc bank_mask:0xf
    v_add_u32_dpp v15, v15, v15 row_bcast:31 row_mask:0xc bank_mask:0xf
    v_readlane_b32 s48, v14, 63
    v_readlane_b32 s49, v15, 63
    s_lshl_b32 s54, s32, 2
    v_mov_b32 v8, s54
    s_and_b32 s50, s48, 0xffff
    s_lshr_b32 s51, s48, 16
    s_and_b32 s52, s49, 0xffff
    s_lshr_b32 s53, s49, 16
    s_add_u32 s51, s51, s50
    s_add_u32 s52, s52, s51
    s_add_u32 s53, s53, s52
    v_mov_b32 v9, s53
    s_mov_b64 exec, 1
    ds_write_b32 v8, v9 offset:16384
    s_mov_b64 exec, -1
    v_and_b32 v8, 60, v7
    s_waitcnt lgkmcnt(0)
    s_barrier
    ds_read_b32 v9, v8 offset:16384
    s_waitcnt lgkmcnt(0)
    v_add_u32_dpp v9, v9, v9 row_shr:1 row_mask:0xf bank_mask:0xf bound_ctrl:1
    s_nop 1
    v_add_u32_dpp v9, v9, v9 row_shr:2 row_mask:0xf bank_mask:0xf bound_ctrl:1
    s_nop 1
    v_add_u32_dpp v9, v9, v9 row_shr:4 row_mask:0xf bank_mask:0xf bound_ctrl:1
    s_nop 1
    v_add_u32_dpp v9, v9, v9 row_shr:8 row_mask:0xf bank_mask:0xf bound_ctrl:1
    s_nop 0
    v_readlane_b32 s54, v9, s32
    s_sub_u32 s54, s54, s53
    s_add_u32 s50, s50, s54
    s_add_u32 s51, s51, s54
    s_add_u32 s52, s52, s54
    s_pack_ll_b32_b16 s48, s54, s50
    s_pack_ll_b32_b16 s49, s51, s52
    v_add_u32 v14, s48, v14
    v_add_u32 v15, s49, v15
    v_sub_u32 v12, v14, v12
    v_sub_u32 v13, v15, v13
    v_and_b32 v8, 0xffff, v12
    v_lshrrev_b32 v9, 16, v12
    v_and_b32 v10, 0xffff, v13
    v_lshrrev_b32 v11, 16, v13
    ds_write2st64_b32 v7, v8, v9 offset0:0 offset1:1
    ds_write2st64_b32 v7, v10, v11 offset0:2 offset1:3
    v_and_b32 v8, 0x3f0, v0
    v_lshl_add_u32 v8, v8, 1, s36
    ds_write_b64 v8, v[12:13] offset:20480
    s_bitset0_b64 exec, 63
    s_not_b64 exec, exec
    ds_write_b64 v8, v[14:15] offset:20512
    s_mov_b64 exec, -1
    s_waitcnt lgkmcnt(0)
    s_barrier
    s_setprio 3
    ds_add_rtn_u32 v72, v72, v2
    ds_add_rtn_u32 v73, v73, v2
    ds_add_rtn_u32 v74, v74, v2
    ds_add_rtn_u32 v75, v75, v2
    ds_read_b128 v[12:15], v0 offset:20480
    v_cmp_gt_u32 vcc, 8448, v0
    s_add_u32 s46, s35, 0x2a44000
    s_add_u32 s46, s46, s93
    buffer_store_dwordx4 v[84:87], v0, s[20:23], s46 offen sc1
    s_add_u32 s47, s96, 0x6000000
    s_lshr_b32 s47, s47, 1
    buffer_load_dwordx2 v[84:85], v1, s[16:19], s47 offen nt
    s_add_u32 s44, s96, 0x6400000
    s_lshr_b32 s44, s44, 1
    buffer_load_dwordx2 v[86:87], v1, s[16:19], s44 offen nt
    ds_add_rtn_u32 v80, v80, v2
    ds_add_rtn_u32 v81, v81, v2
    ds_add_rtn_u32 v82, v82, v2
    ds_add_rtn_u32 v83, v83, v2
    s_setprio 2
    ds_add_rtn_u32 v104, v104, v2
    ds_add_rtn_u32 v105, v105, v2
    ds_add_rtn_u32 v106, v106, v2
    ds_add_rtn_u32 v107, v107, v2
    s_waitcnt lgkmcnt(8)
    s_cbranch_vccz L1_p3
    s_add_u32 s45, s35, 0x5480000
    s_mov_b64 exec, vcc
    buffer_store_dwordx4 v[12:15], v0, s[24:27], s45 offen sc1
    s_mov_b64 exec, -1
L1_p3:
    s_add_u32 s46, s35, 0x2a48000
    s_add_u32 s46, s46, s72
    buffer_store_dwordx4 v[48:51], v0, s[20:23], s46 offen sc1
    s_add_u32 s47, s96, 0x6400000
    s_nop 0
    v_lshlrev_b32 v48, 1, v1
    buffer_load_dwordx4 v[48:51], v48, s[8:11], s47 offen nt
    ds_add_rtn_u32 v112, v112, v2
    ds_add_rtn_u32 v113, v113, v2
    ds_add_rtn_u32 v114, v114, v2
    ds_add_rtn_u32 v115, v115, v2
    s_setprio 1
    ds_add_rtn_u32 v116, v116, v2
    ds_add_rtn_u32 v117, v117, v2
    ds_add_rtn_u32 v118, v118, v2
    ds_add_rtn_u32 v119, v119, v2
    ds_add_rtn_u32 v16, v16, v2
    ds_add_rtn_u32 v17, v17, v2
    ds_add_rtn_u32 v18, v18, v2
    ds_add_rtn_u32 v19, v19, v2
    s_add_u32 s44, s35, 0x2a48000
    s_add_u32 s44, s44, s73
    buffer_store_dwordx4 v[52:55], v0, s[20:23], s44 offen sc1
    s_add_u32 s45, s96, 0x6400000
    s_nop 0
    v_lshlrev_b32 v52, 1, v1
    buffer_load_dwordx4 v[52:55], v52, s[12:15], s45 offen nt
    s_setprio 0
    ds_add_rtn_u32 v124, v124, v2
    ds_add_rtn_u32 v125, v125, v2
    ds_add_rtn_u32 v126, v126, v2
    ds_add_rtn_u32 v127, v127, v2
    ds_add_rtn_u32 v36, v36, v2
    ds_add_rtn_u32 v37, v37, v2
    ds_add_rtn_u32 v38, v38, v2
    ds_add_rtn_u32 v39, v39, v2
    s_waitcnt lgkmcnt(0)
    s_barrier
    s_setprio 3
    v_and_b32 v7, -4, v72
    v_lshl_add_u32 v8, v72, 2, v7
    ds_write_b32 v8, v68
    v_lshl_add_u32 v7, v7, 2, v72
    ds_write_b8 v7, v64 offset:16
    v_and_b32 v9, -4, v73
    v_lshl_add_u32 v10, v73, 2, v9
    ds_write_b32 v10, v69
    v_lshl_add_u32 v9, v9, 2, v73
    ds_write_b8_d16_hi v9, v64 offset:16
    v_and_b32 v7, -4, v74
    v_lshl_add_u32 v8, v74, 2, v7
    ds_write_b32 v8, v70
    v_lshl_add_u32 v7, v7, 2, v74
    ds_write_b8 v7, v65 offset:16
    v_and_b32 v9, -4, v75
    v_lshl_add_u32 v10, v75, 2, v9
    ds_write_b32 v10, v71
    v_lshl_add_u32 v9, v9, 2, v75
    ds_write_b8_d16_hi v9, v65 offset:16
    s_add_u32 s46, s35, 0x2a48000
    s_add_u32 s46, s46, s85
    buffer_store_dwordx4 v[56:59], v0, s[20:23], s46 offen sc1
    s_add_u32 s47, s96, 0x6800000
    v_lshlrev_b32 v68, 1, v1
    buffer_load_dwordx4 v[68:71], v68, s[8:11], s47 offen nt
    s_add_u32 s44, s96, 0x6800000
    v_lshlrev_b32 v72, 1, v1
    buffer_load_dwordx4 v[72:75], v72, s[12:15], s44 offen nt
    v_and_b32 v7, -4, v80
    v_lshl_add_u32 v8, v80, 2, v7
    ds_write_b32 v8, v76
    v_lshl_add_u32 v7, v7, 2, v80
    ds_write_b8 v7, v66 offset:16
    v_and_b32 v9, -4, v81
    v_lshl_add_u32 v10, v81, 2, v9
    ds_write_b32 v10, v77
    v_lshl_add_u32 v9, v9, 2, v81
    ds_write_b8_d16_hi v9, v66 offset:16
    v_and_b32 v7, -4, v82
    v_lshl_add_u32 v8, v82, 2, v7
    ds_write_b32 v8, v78
    v_lshl_add_u32 v7, v7, 2, v82
    ds_write_b8 v7, v67 offset:16
    v_and_b32 v9, -4, v83
    v_lshl_add_u32 v10, v83, 2, v9
    ds_write_b32 v10, v79
    v_lshl_add_u32 v9, v9, 2, v83
    ds_write_b8_d16_hi v9, v67 offset:16
    s_add_u32 s45, s96, 0x6800000
    s_lshr_b32 s45, s45, 1
    buffer_load_dwordx2 v[56:57], v1, s[16:19], s45 offen nt
    s_add_u32 s46, s96, 0x6c00000
    s_lshr_b32 s46, s46, 1
    buffer_load_dwordx2 v[58:59], v1, s[16:19], s46 offen nt
    s_add_u32 s47, s96, 0x6c00000
    v_lshlrev_b32 v76, 1, v1
    buffer_load_dwordx4 v[76:79], v76, s[8:11], s47 offen nt
    s_waitcnt vmcnt(10)
    v_lshlrev_b32 v7, 16, v84
    v_and_b32 v8, 0xffff0000, v84
    v_lshlrev_b32 v9, 16, v85
    v_and_b32 v10, 0xffff0000, v85
    v_mul_f32 v7, 0.15915494, v7
    v_mul_f32 v8, 0.15915494, v8
    v_mul_f32 v9, 0.15915494, v9
    v_mul_f32 v10, 0.15915494, v10
    v_mul_hi_u32_u24 v14, 429497, v40
    v_lshrrev_b32 v12, 3, v24
    v_cos_f32 v7, v7
    v_lshlrev_b16 v13, 3, v24
    v_mad_i32_i24 v11, v14, s55, v40
    v_bitop3_b32 v12, v6, v13, v12 bitop3:0xca
    v_lshl_add_u32 v11, v11, 17, s40
    v_lshlrev_b16 v14, 8, v14
    v_lshrrev_b32 v13, 2, v24
    v_add_u32 v40, v12, v11
    v_bitop3_b32 v24, v5, v13, v14 bitop3:0xea
    v_mul_hi_u32_u24 v14, 429497, v41
    v_lshrrev_b32 v12, 3, v25
    v_cos_f32 v8, v8
    v_lshlrev_b16 v13, 3, v25
    v_mad_i32_i24 v11, v14, s55, v41
    v_bitop3_b32 v12, v6, v13, v12 bitop3:0xca
    v_lshl_add_u32 v11, v11, 17, s40
    v_lshlrev_b16 v14, 8, v14
    v_lshrrev_b32 v13, 2, v25
    v_add_u32 v41, v12, v11
    v_bitop3_b32 v25, v5, v13, v14 bitop3:0xea
    v_cvt_pk_bf16_f32 v84, v7, v8
    v_perm_b32 v12, v84, v84, s41
    v_bitop3_b32 v40, v4, v12, v40 bitop3:0xca
    v_perm_b32 v13, v84, v84, s42
    v_bitop3_b32 v41, v4, v13, v41 bitop3:0xca
    v_mul_hi_u32_u24 v14, 429497, v42
    v_lshrrev_b32 v12, 3, v26
    v_cos_f32 v9, v9
    v_lshlrev_b16 v13, 3, v26
    v_mad_i32_i24 v11, v14, s55, v42
    v_bitop3_b32 v12, v6, v13, v12 bitop3:0xca
    v_lshl_add_u32 v11, v11, 17, s40
    v_lshlrev_b16 v14, 8, v14
    v_lshrrev_b32 v13, 2, v26
    v_add_u32 v42, v12, v11
    v_bitop3_b32 v26, v5, v13, v14 bitop3:0xea
    v_mul_hi_u32_u24 v14, 429497, v43
    v_lshrrev_b32 v12, 3, v27
    v_cos_f32 v10, v10
    v_lshlrev_b16 v13, 3, v27
    v_mad_i32_i24 v11, v14, s55, v43
    v_bitop3_b32 v12, v6, v13, v12 bitop3:0xca
    v_lshl_add_u32 v11, v11, 17, s40
    v_lshlrev_b16 v14, 8, v14
    v_lshrrev_b32 v13, 2, v27
    v_add_u32 v43, v12, v11
    v_bitop3_b32 v27, v5, v13, v14 bitop3:0xea
    v_cvt_pk_bf16_f32 v85, v9, v10
    v_perm_b32 v12, v85, v85, s41
    v_bitop3_b32 v42, v4, v12, v42 bitop3:0xca
    v_perm_b32 v13, v85, v85, s42
    v_bitop3_b32 v43, v4, v13, v43 bitop3:0xca
    s_setprio 2
    v_and_b32 v7, -4, v104
    v_lshl_add_u32 v8, v104, 2, v7
    ds_write_b32 v8, v96
    v_lshl_add_u32 v7, v7, 2, v104
    ds_write_b8 v7, v88 offset:16
    v_and_b32 v9, -4, v105
    v_lshl_add_u32 v10, v105, 2, v9
    ds_write_b32 v10, v97
    v_lshl_add_u32 v9, v9, 2, v105
    ds_write_b8_d16_hi v9, v88 offset:16
    v_and_b32 v7, -4, v106
    v_lshl_add_u32 v8, v106, 2, v7
    ds_write_b32 v8, v98
    v_lshl_add_u32 v7, v7, 2, v106
    ds_write_b8 v7, v89 offset:16
    v_and_b32 v9, -4, v107
    v_lshl_add_u32 v10, v107, 2, v9
    ds_write_b32 v10, v99
    v_lshl_add_u32 v9, v9, 2, v107
    ds_write_b8_d16_hi v9, v89 offset:16
    s_add_u32 s44, s35, 0x2a48000
    s_add_u32 s44, s44, s91
    buffer_store_dwordx4 v[60:63], v0, s[20:23], s44 offen sc1
    s_add_u32 s45, s96, 0x6c00000
    v_lshlrev_b32 v80, 1, v1
    buffer_load_dwordx4 v[80:83], v80, s[12:15], s45 offen nt
    s_waitcnt vmcnt(8)
    v_lshlrev_b32 v7, 16, v86
    v_and_b32 v8, 0xffff0000, v86
    v_lshlrev_b32 v9, 16, v87
    v_and_b32 v10, 0xffff0000, v87
    v_mul_f32 v7, 0.15915494, v7
    v_mul_f32 v8, 0.15915494, v8
    v_mul_f32 v9, 0.15915494, v9
    v_mul_f32 v10, 0.15915494, v10
    v_mul_hi_u32_u24 v14, 429497, v48
    v_lshrrev_b32 v12, 3, v52
    v_cos_f32 v7, v7
    v_lshlrev_b16 v13, 3, v52
    v_mad_i32_i24 v11, v14, s55, v48
    v_bitop3_b32 v12, v6, v13, v12 bitop3:0xca
    v_lshl_add_u32 v11, v11, 17, s40
    v_lshlrev_b16 v14, 8, v14
    v_lshrrev_b32 v13, 2, v52
    v_add_u32 v48, v12, v11
    v_bitop3_b32 v52, v5, v13, v14 bitop3:0xea
    v_mul_hi_u32_u24 v14, 429497, v49
    v_lshrrev_b32 v12, 3, v53
    v_cos_f32 v8, v8
    v_lshlrev_b16 v13, 3, v53
    v_mad_i32_i24 v11, v14, s55, v49
    v_bitop3_b32 v12, v6, v13, v12 bitop3:0xca
    v_lshl_add_u32 v11, v11, 17, s40
    v_lshlrev_b16 v14, 8, v14
    v_lshrrev_b32 v13, 2, v53
    v_add_u32 v49, v12, v11
    v_bitop3_b32 v53, v5, v13, v14 bitop3:0xea
    v_cvt_pk_bf16_f32 v86, v7, v8
    v_perm_b32 v12, v86, v86, s41
    v_bitop3_b32 v48, v4, v12, v48 bitop3:0xca
    v_perm_b32 v13, v86, v86, s42
    v_bitop3_b32 v49, v4, v13, v49 bitop3:0xca
    v_mul_hi_u32_u24 v14, 429497, v50
    v_lshrrev_b32 v12, 3, v54
    v_cos_f32 v9, v9
    v_lshlrev_b16 v13, 3, v54
    v_mad_i32_i24 v11, v14, s55, v50
    v_bitop3_b32 v12, v6, v13, v12 bitop3:0xca
    v_lshl_add_u32 v11, v11, 17, s40
    v_lshlrev_b16 v14, 8, v14
    v_lshrrev_b32 v13, 2, v54
    v_add_u32 v50, v12, v11
    v_bitop3_b32 v54, v5, v13, v14 bitop3:0xea
    v_mul_hi_u32_u24 v14, 429497, v51
    v_lshrrev_b32 v12, 3, v55
    v_cos_f32 v10, v10
    v_lshlrev_b16 v13, 3, v55
    v_mad_i32_i24 v11, v14, s55, v51
    v_bitop3_b32 v12, v6, v13, v12 bitop3:0xca
    v_lshl_add_u32 v11, v11, 17, s40
    v_lshlrev_b16 v14, 8, v14
    v_lshrrev_b32 v13, 2, v55
    v_add_u32 v51, v12, v11
    v_bitop3_b32 v55, v5, v13, v14 bitop3:0xea
    v_cvt_pk_bf16_f32 v87, v9, v10
    v_perm_b32 v12, v87, v87, s41
    v_bitop3_b32 v50, v4, v12, v50 bitop3:0xca
    v_perm_b32 v13, v87, v87, s42
    v_bitop3_b32 v51, v4, v13, v51 bitop3:0xca
    v_and_b32 v7, -4, v112
    v_lshl_add_u32 v8, v112, 2, v7
    ds_write_b32 v8, v100
    v_lshl_add_u32 v7, v7, 2, v112
    ds_write_b8 v7, v90 offset:16
    v_and_b32 v9, -4, v113
    v_lshl_add_u32 v10, v113, 2, v9
    ds_write_b32 v10, v101
    v_lshl_add_u32 v9, v9, 2, v113
    ds_write_b8_d16_hi v9, v90 offset:16
    v_and_b32 v7, -4, v114
    v_lshl_add_u32 v8, v114, 2, v7
    ds_write_b32 v8, v102
    v_lshl_add_u32 v7, v7, 2, v114
    ds_write_b8 v7, v91 offset:16
    v_and_b32 v9, -4, v115
    v_lshl_add_u32 v10, v115, 2, v9
    ds_write_b32 v10, v103
    v_lshl_add_u32 v9, v9, 2, v115
    ds_write_b8_d16_hi v9, v91 offset:16
    s_add_u32 s46, s96, 0x7000000
    v_lshlrev_b32 v64, 1, v1
    buffer_load_dwordx4 v[64:67], v64, s[8:11], s46 offen nt
    s_add_u32 s47, s96, 0x7000000
    v_lshlrev_b32 v96, 1, v1
    buffer_load_dwordx4 v[96:99], v96, s[12:15], s47 offen nt
    s_waitcnt vmcnt(5)
    v_lshlrev_b32 v7, 16, v56
    v_and_b32 v8, 0xffff0000, v56
    v_lshlrev_b32 v9, 16, v57
    v_and_b32 v10, 0xffff0000, v57
    v_mul_f32 v7, 0.15915494, v7
    v_mul_f32 v8, 0.15915494, v8
    v_mul_f32 v9, 0.15915494, v9
    v_mul_f32 v10, 0.15915494, v10
    v_mul_hi_u32_u24 v14, 429497, v68
    v_lshrrev_b32 v12, 3, v72
    v_cos_f32 v7, v7
    v_lshlrev_b16 v13, 3, v72
    v_mad_i32_i24 v11, v14, s55, v68
    v_bitop3_b32 v12, v6, v13, v12 bitop3:0xca
    v_lshl_add_u32 v11, v11, 17, s40
    v_lshlrev_b16 v14, 8, v14
    v_lshrrev_b32 v13, 2, v72
    v_add_u32 v68, v12, v11
    v_bitop3_b32 v72, v5, v13, v14 bitop3:0xea
    v_mul_hi_u32_u24 v14, 429497, v69
    v_lshrrev_b32 v12, 3, v73
    v_cos_f32 v8, v8
    v_lshlrev_b16 v13, 3, v73
    v_mad_i32_i24 v11, v14, s55, v69
    v_bitop3_b32 v12, v6, v13, v12 bitop3:0xca
    v_lshl_add_u32 v11, v11, 17, s40
    v_lshlrev_b16 v14, 8, v14
    v_lshrrev_b32 v13, 2, v73
    v_add_u32 v69, v12, v11
    v_bitop3_b32 v73, v5, v13, v14 bitop3:0xea
    v_cvt_pk_bf16_f32 v56, v7, v8
    v_perm_b32 v12, v56, v56, s41
    v_bitop3_b32 v68, v4, v12, v68 bitop3:0xca
    v_perm_b32 v13, v56, v56, s42
    v_bitop3_b32 v69, v4, v13, v69 bitop3:0xca
    v_mul_hi_u32_u24 v14, 429497, v70
    v_lshrrev_b32 v12, 3, v74
    v_cos_f32 v9, v9
    v_lshlrev_b16 v13, 3, v74
    v_mad_i32_i24 v11, v14, s55, v70
    v_bitop3_b32 v12, v6, v13, v12 bitop3:0xca
    v_lshl_add_u32 v11, v11, 17, s40
    v_lshlrev_b16 v14, 8, v14
    v_lshrrev_b32 v13, 2, v74
    v_add_u32 v70, v12, v11
    v_bitop3_b32 v74, v5, v13, v14 bitop3:0xea
    v_mul_hi_u32_u24 v14, 429497, v71
    v_lshrrev_b32 v12, 3, v75
    v_cos_f32 v10, v10
    v_lshlrev_b16 v13, 3, v75
    v_mad_i32_i24 v11, v14, s55, v71
    v_bitop3_b32 v12, v6, v13, v12 bitop3:0xca
    v_lshl_add_u32 v11, v11, 17, s40
    v_lshlrev_b16 v14, 8, v14
    v_lshrrev_b32 v13, 2, v75
    v_add_u32 v71, v12, v11
    v_bitop3_b32 v75, v5, v13, v14 bitop3:0xea
    v_cvt_pk_bf16_f32 v57, v9, v10
    v_perm_b32 v12, v57, v57, s41
    v_bitop3_b32 v70, v4, v12, v70 bitop3:0xca
    v_perm_b32 v13, v57, v57, s42
    v_bitop3_b32 v71, v4, v13, v71 bitop3:0xca
    s_setprio 1
    v_and_b32 v7, -4, v116
    v_lshl_add_u32 v8, v116, 2, v7
    ds_write_b32 v8, v108
    v_lshl_add_u32 v7, v7, 2, v116
    ds_write_b8 v7, v120 offset:16
    v_and_b32 v9, -4, v117
    v_lshl_add_u32 v10, v117, 2, v9
    ds_write_b32 v10, v109
    v_lshl_add_u32 v9, v9, 2, v117
    ds_write_b8_d16_hi v9, v120 offset:16
    v_and_b32 v7, -4, v118
    v_lshl_add_u32 v8, v118, 2, v7
    ds_write_b32 v8, v110
    v_lshl_add_u32 v7, v7, 2, v118
    ds_write_b8 v7, v121 offset:16
    v_and_b32 v9, -4, v119
    v_lshl_add_u32 v10, v119, 2, v9
    ds_write_b32 v10, v111
    v_lshl_add_u32 v9, v9, 2, v119
    ds_write_b8_d16_hi v9, v121 offset:16
    s_add_u32 s44, s96, 0x7000000
    s_lshr_b32 s44, s44, 1
    buffer_load_dwordx2 v[104:105], v1, s[16:19], s44 offen nt
    s_add_u32 s45, s96, 0x7400000
    s_lshr_b32 s45, s45, 1
    buffer_load_dwordx2 v[106:107], v1, s[16:19], s45 offen nt
    s_add_u32 s46, s96, 0x7400000
    v_lshlrev_b32 v60, 1, v1
    buffer_load_dwordx4 v[60:63], v60, s[8:11], s46 offen nt
    v_and_b32 v7, -4, v16
    v_lshl_add_u32 v8, v16, 2, v7
    ds_write_b32 v8, v92
    v_lshl_add_u32 v7, v7, 2, v16
    ds_write_b8 v7, v122 offset:16
    v_and_b32 v9, -4, v17
    v_lshl_add_u32 v10, v17, 2, v9
    ds_write_b32 v10, v93
    v_lshl_add_u32 v9, v9, 2, v17
    ds_write_b8_d16_hi v9, v122 offset:16
    v_and_b32 v7, -4, v18
    v_lshl_add_u32 v8, v18, 2, v7
    ds_write_b32 v8, v94
    v_lshl_add_u32 v7, v7, 2, v18
    ds_write_b8 v7, v123 offset:16
    v_and_b32 v9, -4, v19
    v_lshl_add_u32 v10, v19, 2, v9
    ds_write_b32 v10, v95
    v_lshl_add_u32 v9, v9, 2, v19
    ds_write_b8_d16_hi v9, v123 offset:16
    s_add_u32 s47, s35, 0x2a48000
    s_add_u32 s47, s47, s93
    buffer_store_dwordx4 v[44:47], v0, s[20:23], s47 offen sc1
    s_add_u32 s44, s96, 0x7400000
    v_lshlrev_b32 v100, 1, v1
    buffer_load_dwordx4 v[100:103], v100, s[12:15], s44 offen nt
    s_waitcnt vmcnt(7)
    v_lshlrev_b32 v7, 16, v58
    v_and_b32 v8, 0xffff0000, v58
    v_lshlrev_b32 v9, 16, v59
    v_and_b32 v10, 0xffff0000, v59
    v_mul_f32 v7, 0.15915494, v7
    v_mul_f32 v8, 0.15915494, v8
    v_mul_f32 v9, 0.15915494, v9
    v_mul_f32 v10, 0.15915494, v10
    v_mul_hi_u32_u24 v14, 429497, v76
    v_lshrrev_b32 v12, 3, v80
    v_cos_f32 v7, v7
    v_lshlrev_b16 v13, 3, v80
    v_mad_i32_i24 v11, v14, s55, v76
    v_bitop3_b32 v12, v6, v13, v12 bitop3:0xca
    v_lshl_add_u32 v11, v11, 17, s40
    v_lshlrev_b16 v14, 8, v14
    v_lshrrev_b32 v13, 2, v80
    v_add_u32 v76, v12, v11
    v_bitop3_b32 v80, v5, v13, v14 bitop3:0xea
    v_mul_hi_u32_u24 v14, 429497, v77
    v_lshrrev_b32 v12, 3, v81
    v_cos_f32 v8, v8
    v_lshlrev_b16 v13, 3, v81
    v_mad_i32_i24 v11, v14, s55, v77
    v_bitop3_b32 v12, v6, v13, v12 bitop3:0xca
    v_lshl_add_u32 v11, v11, 17, s40
    v_lshlrev_b16 v14, 8, v14
    v_lshrrev_b32 v13, 2, v81
    v_add_u32 v77, v12, v11
    v_bitop3_b32 v81, v5, v13, v14 bitop3:0xea
    v_cvt_pk_bf16_f32 v58, v7, v8
    v_perm_b32 v12, v58, v58, s41
    v_bitop3_b32 v76, v4, v12, v76 bitop3:0xca
    v_perm_b32 v13, v58, v58, s42
    v_bitop3_b32 v77, v4, v13, v77 bitop3:0xca
    v_mul_hi_u32_u24 v14, 429497, v78
    v_lshrrev_b32 v12, 3, v82
    v_cos_f32 v9, v9
    v_lshlrev_b16 v13, 3, v82
    v_mad_i32_i24 v11, v14, s55, v78
    v_bitop3_b32 v12, v6, v13, v12 bitop3:0xca
    v_lshl_add_u32 v11, v11, 17, s40
    v_lshlrev_b16 v14, 8, v14
    v_lshrrev_b32 v13, 2, v82
    v_add_u32 v78, v12, v11
    v_bitop3_b32 v82, v5, v13, v14 bitop3:0xea
    v_mul_hi_u32_u24 v14, 429497, v79
    v_lshrrev_b32 v12, 3, v83
    v_cos_f32 v10, v10
    v_lshlrev_b16 v13, 3, v83
    v_mad_i32_i24 v11, v14, s55, v79
    v_bitop3_b32 v12, v6, v13, v12 bitop3:0xca
    v_lshl_add_u32 v11, v11, 17, s40
    v_lshlrev_b16 v14, 8, v14
    v_lshrrev_b32 v13, 2, v83
    v_add_u32 v79, v12, v11
    v_bitop3_b32 v83, v5, v13, v14 bitop3:0xea
    v_cvt_pk_bf16_f32 v59, v9, v10
    v_perm_b32 v12, v59, v59, s41
    v_bitop3_b32 v78, v4, v12, v78 bitop3:0xca
    v_perm_b32 v13, v59, v59, s42
    v_bitop3_b32 v79, v4, v13, v79 bitop3:0xca
    s_setprio 0
    v_and_b32 v7, -4, v124
    v_lshl_add_u32 v8, v124, 2, v7
    ds_write_b32 v8, v20
    v_lshl_add_u32 v7, v7, 2, v124
    ds_write_b8 v7, v28 offset:16
    v_and_b32 v9, -4, v125
    v_lshl_add_u32 v10, v125, 2, v9
    ds_write_b32 v10, v21
    v_lshl_add_u32 v9, v9, 2, v125
    ds_write_b8_d16_hi v9, v28 offset:16
    v_and_b32 v7, -4, v126
    v_lshl_add_u32 v8, v126, 2, v7
    ds_write_b32 v8, v22
    v_lshl_add_u32 v7, v7, 2, v126
    ds_write_b8 v7, v29 offset:16
    v_and_b32 v9, -4, v127
    v_lshl_add_u32 v10, v127, 2, v9
    ds_write_b32 v10, v23
    v_lshl_add_u32 v9, v9, 2, v127
    ds_write_b8_d16_hi v9, v29 offset:16
    s_add_u32 s45, s96, 0x7800000
    v_lshlrev_b32 v112, 1, v1
    buffer_load_dwordx4 v[112:115], v112, s[8:11], s45 offen nt
    s_add_u32 s46, s96, 0x7800000
    v_lshlrev_b32 v88, 1, v1
    buffer_load_dwordx4 v[88:91], v88, s[12:15], s46 offen nt
    s_waitcnt vmcnt(5)
    v_lshlrev_b32 v7, 16, v104
    v_and_b32 v8, 0xffff0000, v104
    v_lshlrev_b32 v9, 16, v105
    v_and_b32 v10, 0xffff0000, v105
    v_mul_f32 v7, 0.15915494, v7
    v_mul_f32 v8, 0.15915494, v8
    v_mul_f32 v9, 0.15915494, v9
    v_mul_f32 v10, 0.15915494, v10
    v_mul_hi_u32_u24 v14, 429497, v64
    v_lshrrev_b32 v12, 3, v96
    v_cos_f32 v7, v7
    v_lshlrev_b16 v13, 3, v96
    v_mad_i32_i24 v11, v14, s55, v64
    v_bitop3_b32 v12, v6, v13, v12 bitop3:0xca
    v_lshl_add_u32 v11, v11, 17, s40
    v_lshlrev_b16 v14, 8, v14
    v_lshrrev_b32 v13, 2, v96
    v_add_u32 v64, v12, v11
    v_bitop3_b32 v96, v5, v13, v14 bitop3:0xea
    v_mul_hi_u32_u24 v14, 429497, v65
    v_lshrrev_b32 v12, 3, v97
    v_cos_f32 v8, v8
    v_lshlrev_b16 v13, 3, v97
    v_mad_i32_i24 v11, v14, s55, v65
    v_bitop3_b32 v12, v6, v13, v12 bitop3:0xca
    v_lshl_add_u32 v11, v11, 17, s40
    v_lshlrev_b16 v14, 8, v14
    v_lshrrev_b32 v13, 2, v97
    v_add_u32 v65, v12, v11
    v_bitop3_b32 v97, v5, v13, v14 bitop3:0xea
    v_cvt_pk_bf16_f32 v104, v7, v8
    v_perm_b32 v12, v104, v104, s41
    v_bitop3_b32 v64, v4, v12, v64 bitop3:0xca
    v_perm_b32 v13, v104, v104, s42
    v_bitop3_b32 v65, v4, v13, v65 bitop3:0xca
    v_mul_hi_u32_u24 v14, 429497, v66
    v_lshrrev_b32 v12, 3, v98
    v_cos_f32 v9, v9
    v_lshlrev_b16 v13, 3, v98
    v_mad_i32_i24 v11, v14, s55, v66
    v_bitop3_b32 v12, v6, v13, v12 bitop3:0xca
    v_lshl_add_u32 v11, v11, 17, s40
    v_lshlrev_b16 v14, 8, v14
    v_lshrrev_b32 v13, 2, v98
    v_add_u32 v66, v12, v11
    v_bitop3_b32 v98, v5, v13, v14 bitop3:0xea
    v_mul_hi_u32_u24 v14, 429497, v67
    v_lshrrev_b32 v12, 3, v99
    v_cos_f32 v10, v10
    v_lshlrev_b16 v13, 3, v99
    v_mad_i32_i24 v11, v14, s55, v67
    v_bitop3_b32 v12, v6, v13, v12 bitop3:0xca
    v_lshl_add_u32 v11, v11, 17, s40
    v_lshlrev_b16 v14, 8, v14
    v_lshrrev_b32 v13, 2, v99
    v_add_u32 v67, v12, v11
    v_bitop3_b32 v99, v5, v13, v14 bitop3:0xea
    v_cvt_pk_bf16_f32 v105, v9, v10
    v_perm_b32 v12, v105, v105, s41
    v_bitop3_b32 v66, v4, v12, v66 bitop3:0xca
    v_perm_b32 v13, v105, v105, s42
    v_bitop3_b32 v67, v4, v13, v67 bitop3:0xca
    v_and_b32 v7, -4, v36
    v_lshl_add_u32 v8, v36, 2, v7
    ds_write_b32 v8, v32
    v_lshl_add_u32 v7, v7, 2, v36
    ds_write_b8 v7, v30 offset:16
    v_and_b32 v9, -4, v37
    v_lshl_add_u32 v10, v37, 2, v9
    ds_write_b32 v10, v33
    v_lshl_add_u32 v9, v9, 2, v37
    ds_write_b8_d16_hi v9, v30 offset:16
    v_and_b32 v7, -4, v38
    v_lshl_add_u32 v8, v38, 2, v7
    ds_write_b32 v8, v34
    v_lshl_add_u32 v7, v7, 2, v38
    ds_write_b8 v7, v31 offset:16
    v_and_b32 v9, -4, v39
    v_lshl_add_u32 v10, v39, 2, v9
    ds_write_b32 v10, v35
    v_lshl_add_u32 v9, v9, 2, v39
    ds_write_b8_d16_hi v9, v31 offset:16
    s_add_u32 s47, s96, 0x7800000
    s_lshr_b32 s47, s47, 1
    buffer_load_dwordx2 v[108:109], v1, s[16:19], s47 offen nt
    s_add_u32 s44, s96, 0x7c00000
    s_lshr_b32 s44, s44, 1
    buffer_load_dwordx2 v[110:111], v1, s[16:19], s44 offen nt
    s_waitcnt vmcnt(4)
    v_lshlrev_b32 v7, 16, v106
    v_and_b32 v8, 0xffff0000, v106
    v_lshlrev_b32 v9, 16, v107
    v_and_b32 v10, 0xffff0000, v107
    v_mul_f32 v7, 0.15915494, v7
    v_mul_f32 v8, 0.15915494, v8
    v_mul_f32 v9, 0.15915494, v9
    v_mul_f32 v10, 0.15915494, v10
    v_mul_hi_u32_u24 v14, 429497, v60
    v_lshrrev_b32 v12, 3, v100
    v_cos_f32 v7, v7
    v_lshlrev_b16 v13, 3, v100
    v_mad_i32_i24 v11, v14, s55, v60
    v_bitop3_b32 v12, v6, v13, v12 bitop3:0xca
    v_lshl_add_u32 v11, v11, 17, s40
    v_lshlrev_b16 v14, 8, v14
    v_lshrrev_b32 v13, 2, v100
    v_add_u32 v60, v12, v11
    v_bitop3_b32 v100, v5, v13, v14 bitop3:0xea
    v_mul_hi_u32_u24 v14, 429497, v61
    v_lshrrev_b32 v12, 3, v101
    v_cos_f32 v8, v8
    v_lshlrev_b16 v13, 3, v101
    v_mad_i32_i24 v11, v14, s55, v61
    v_bitop3_b32 v12, v6, v13, v12 bitop3:0xca
    v_lshl_add_u32 v11, v11, 17, s40
    v_lshlrev_b16 v14, 8, v14
    v_lshrrev_b32 v13, 2, v101
    v_add_u32 v61, v12, v11
    v_bitop3_b32 v101, v5, v13, v14 bitop3:0xea
    v_cvt_pk_bf16_f32 v106, v7, v8
    v_perm_b32 v12, v106, v106, s41
    v_bitop3_b32 v60, v4, v12, v60 bitop3:0xca
    v_perm_b32 v13, v106, v106, s42
    v_bitop3_b32 v61, v4, v13, v61 bitop3:0xca
    v_mul_hi_u32_u24 v14, 429497, v62
    v_lshrrev_b32 v12, 3, v102
    v_cos_f32 v9, v9
    v_lshlrev_b16 v13, 3, v102
    v_mad_i32_i24 v11, v14, s55, v62
    v_bitop3_b32 v12, v6, v13, v12 bitop3:0xca
    v_lshl_add_u32 v11, v11, 17, s40
    v_lshlrev_b16 v14, 8, v14
    v_lshrrev_b32 v13, 2, v102
    v_add_u32 v62, v12, v11
    v_bitop3_b32 v102, v5, v13, v14 bitop3:0xea
    v_mul_hi_u32_u24 v14, 429497, v63
    v_lshrrev_b32 v12, 3, v103
    v_cos_f32 v10, v10
    v_lshlrev_b16 v13, 3, v103
    v_mad_i32_i24 v11, v14, s55, v63
    v_bitop3_b32 v12, v6, v13, v12 bitop3:0xca
    v_lshl_add_u32 v11, v11, 17, s40
    v_lshlrev_b16 v14, 8, v14
    v_lshrrev_b32 v13, 2, v103
    v_add_u32 v63, v12, v11
    v_bitop3_b32 v103, v5, v13, v14 bitop3:0xea
    v_cvt_pk_bf16_f32 v107, v9, v10
    v_perm_b32 v12, v107, v107, s41
    v_bitop3_b32 v62, v4, v12, v62 bitop3:0xca
    v_perm_b32 v13, v107, v107, s42
    v_bitop3_b32 v63, v4, v13, v63 bitop3:0xca
    v_add_u32 v7, s72, v0
    v_add_u32 v12, s73, v0
    v_add_u32 v13, s85, v0
    v_add_u32 v14, s91, v0
    v_add_u32 v15, s93, v0
    s_min_i32 s3, s72, s73
    s_min_i32 s3, s3, s85
    s_min_i32 s3, s3, s91
    s_min_i32 s3, s3, s93
    v_add_u32 v3, s3, v0
    v_mov_b32 v8, 0
    v_mov_b32 v9, 0
    v_mov_b32 v10, 0
    v_mov_b32 v11, 0
    s_waitcnt lgkmcnt(0)
    s_barrier
    ds_read_b128 v[116:119], v7 offset:0
    ds_read_b128 v[92:95], v12 offset:0
    ds_read_b128 v[16:19], v13 offset:0
    ds_read_b128 v[120:123], v14 offset:0
    ds_read_b128 v[44:47], v15 offset:0
    ds_write_b128 v3, v[8:11]
    ds_read_b128 v[20:23], v7 offset:16384
    ds_read_b128 v[124:127], v12 offset:16384
    ds_read_b128 v[32:35], v13 offset:16384
    ds_read_b128 v[36:39], v14 offset:16384
    ds_read_b128 v[28:31], v15 offset:16384
    s_waitcnt lgkmcnt(0)
    s_barrier
    s_setprio 3
    s_add_u32 s45, s35, 0x5484000
    s_add_u32 s45, s45, s72
    buffer_store_dwordx4 v[116:119], v0, s[20:23], s45 offen sc1
    s_add_u32 s46, s96, 0x7c00000
    s_nop 0
    v_lshlrev_b32 v116, 1, v1
    buffer_load_dwordx4 v[116:119], v116, s[8:11], s46 offen nt
    s_add_u32 s47, s35, 0x5484000
    s_add_u32 s47, s47, s73
    buffer_store_dwordx4 v[92:95], v0, s[20:23], s47 offen sc1
    s_add_u32 s44, s96, 0x7c00000
    s_nop 0
    v_lshlrev_b32 v92, 1, v1
    buffer_load_dwordx4 v[92:95], v92, s[12:15], s44 offen nt
    ds_add_u32 v24, v2
    ds_add_u32 v25, v2
    ds_add_u32 v26, v2
    ds_add_u32 v27, v2
    ds_add_u32 v52, v2
    ds_add_u32 v53, v2
    ds_add_u32 v54, v2
    ds_add_u32 v55, v2
    s_setprio 2
    ds_add_u32 v72, v2
    ds_add_u32 v73, v2
    ds_add_u32 v74, v2
    ds_add_u32 v75, v2
    ds_add_u32 v80, v2
    ds_add_u32 v81, v2
    ds_add_u32 v82, v2
    ds_add_u32 v83, v2
    s_setprio 1
    s_add_u32 s45, s35, 0x5484000
    s_add_u32 s45, s45, s85
    buffer_store_dwordx4 v[16:19], v0, s[20:23], s45 offen sc1
    s_add_u32 s46, s96, 0x8000000
    s_nop 0
    v_lshlrev_b32 v16, 1, v1
    buffer_load_dwordx4 v[16:19], v16, s[8:11], s46 offen nt
    ds_add_u32 v96, v2
    ds_add_u32 v97, v2
    ds_add_u32 v98, v2
    ds_add_u32 v99, v2
    s_mov_b32 s68, s66
    s_mov_b32 s69, s67
    s_mov_b32 s70, 0x100
    s_mov_b32 s71, 0x20000
    v_mov_b32 v3, 1
    s_cmp_lg_u32 s32, 15
    s_cbranch_scc1 L1_tk
    s_mov_b64 exec, 1
    s_and_b32 s3, s2, 1
    s_lshl_b32 s3, s3, 7
    buffer_atomic_add v3, off, s[68:71], s3 sc0
    s_mov_b64 exec, -1
L1_tk:
    ds_add_u32 v100, v2
    ds_add_u32 v101, v2
    ds_add_u32 v102, v2
    ds_add_u32 v103, v2
    s_setprio 0
    s_waitcnt vmcnt(6)
    v_lshlrev_b32 v7, 16, v108
    v_and_b32 v8, 0xffff0000, v108
    v_lshlrev_b32 v9, 16, v109
    v_and_b32 v10, 0xffff0000, v109
    v_mul_f32 v7, 0.15915494, v7
    v_mul_f32 v8, 0.15915494, v8
    v_mul_f32 v9, 0.15915494, v9
    v_mul_f32 v10, 0.15915494, v10
    v_mul_hi_u32_u24 v14, 429497, v112
    v_lshrrev_b32 v12, 3, v88
    v_cos_f32 v7, v7
    v_lshlrev_b16 v13, 3, v88
    v_mad_i32_i24 v11, v14, s55, v112
    v_bitop3_b32 v12, v6, v13, v12 bitop3:0xca
    v_lshl_add_u32 v11, v11, 17, s40
    v_lshlrev_b16 v14, 8, v14
    v_lshrrev_b32 v13, 2, v88
    v_add_u32 v112, v12, v11
    v_bitop3_b32 v88, v5, v13, v14 bitop3:0xea
    ds_add_u32 v88, v2
    v_mul_hi_u32_u24 v14, 429497, v113
    v_lshrrev_b32 v12, 3, v89
    v_cos_f32 v8, v8
    v_lshlrev_b16 v13, 3, v89
    v_mad_i32_i24 v11, v14, s55, v113
    v_bitop3_b32 v12, v6, v13, v12 bitop3:0xca
    v_lshl_add_u32 v11, v11, 17, s40
    v_lshlrev_b16 v14, 8, v14
    v_lshrrev_b32 v13, 2, v89
    v_add_u32 v113, v12, v11
    v_bitop3_b32 v89, v5, v13, v14 bitop3:0xea
    ds_add_u32 v89, v2
    v_cvt_pk_bf16_f32 v108, v7, v8
    v_perm_b32 v12, v108, v108, s41
    v_bitop3_b32 v112, v4, v12, v112 bitop3:0xca
    v_perm_b32 v13, v108, v108, s42
    v_bitop3_b32 v113, v4, v13, v113 bitop3:0xca
    v_mul_hi_u32_u24 v14, 429497, v114
    v_lshrrev_b32 v12, 3, v90
    v_cos_f32 v9, v9
    v_lshlrev_b16 v13, 3, v90
    v_mad_i32_i24 v11, v14, s55, v114
    v_bitop3_b32 v12, v6, v13, v12 bitop3:0xca
    v_lshl_add_u32 v11, v11, 17, s40
    v_lshlrev_b16 v14, 8, v14
    v_lshrrev_b32 v13, 2, v90
    v_add_u32 v114, v12, v11
    v_bitop3_b32 v90, v5, v13, v14 bitop3:0xea
    ds_add_u32 v90, v2
    v_mul_hi_u32_u24 v14, 429497, v115
    v_lshrrev_b32 v12, 3, v91
    v_cos_f32 v10, v10
    v_lshlrev_b16 v13, 3, v91
    v_mad_i32_i24 v11, v14, s55, v115
    v_bitop3_b32 v12, v6, v13, v12 bitop3:0xca
    v_lshl_add_u32 v11, v11, 17, s40
    v_lshlrev_b16 v14, 8, v14
    v_lshrrev_b32 v13, 2, v91
    v_add_u32 v115, v12, v11
    v_bitop3_b32 v91, v5, v13, v14 bitop3:0xea
    ds_add_u32 v91, v2
    v_cvt_pk_bf16_f32 v109, v9, v10
    v_perm_b32 v12, v109, v109, s41
    v_bitop3_b32 v114, v4, v12, v114 bitop3:0xca
    v_perm_b32 v13, v109, v109, s42
    v_bitop3_b32 v115, v4, v13, v115 bitop3:0xca
    s_waitcnt vmcnt(2)
    v_lshlrev_b32 v7, 16, v110
    v_and_b32 v8, 0xffff0000, v110
    v_lshlrev_b32 v9, 16, v111
    v_and_b32 v10, 0xffff0000, v111
    v_mul_f32 v7, 0.15915494, v7
    v_mul_f32 v8, 0.15915494, v8
    v_mul_f32 v9, 0.15915494, v9
    v_mul_f32 v10, 0.15915494, v10
    v_mul_hi_u32_u24 v14, 429497, v116
    v_lshrrev_b32 v12, 3, v92
    v_cos_f32 v7, v7
    v_lshlrev_b16 v13, 3, v92
    v_mad_i32_i24 v11, v14, s55, v116
    v_bitop3_b32 v12, v6, v13, v12 bitop3:0xca
    v_lshl_add_u32 v11, v11, 17, s40
    v_lshlrev_b16 v14, 8, v14
    v_lshrrev_b32 v13, 2, v92
    v_add_u32 v116, v12, v11
    v_bitop3_b32 v92, v5, v13, v14 bitop3:0xea
    ds_add_u32 v92, v2
    v_mul_hi_u32_u24 v14, 429497, v117
    v_lshrrev_b32 v12, 3, v93
    v_cos_f32 v8, v8
    v_lshlrev_b16 v13, 3, v93
    v_mad_i32_i24 v11, v14, s55, v117
    v_bitop3_b32 v12, v6, v13, v12 bitop3:0xca
    v_lshl_add_u32 v11, v11, 17, s40
    v_lshlrev_b16 v14, 8, v14
    v_lshrrev_b32 v13, 2, v93
    v_add_u32 v117, v12, v11
    v_bitop3_b32 v93, v5, v13, v14 bitop3:0xea
    ds_add_u32 v93, v2
    v_cvt_pk_bf16_f32 v110, v7, v8
    v_perm_b32 v12, v110, v110, s41
    v_bitop3_b32 v116, v4, v12, v116 bitop3:0xca
    v_perm_b32 v13, v110, v110, s42
    v_bitop3_b32 v117, v4, v13, v117 bitop3:0xca
    v_mul_hi_u32_u24 v14, 429497, v118
    v_lshrrev_b32 v12, 3, v94
    v_cos_f32 v9, v9
    v_lshlrev_b16 v13, 3, v94
    v_mad_i32_i24 v11, v14, s55, v118
    v_bitop3_b32 v12, v6, v13, v12 bitop3:0xca
    v_lshl_add_u32 v11, v11, 17, s40
    v_lshlrev_b16 v14, 8, v14
    v_lshrrev_b32 v13, 2, v94
    v_add_u32 v118, v12, v11
    v_bitop3_b32 v94, v5, v13, v14 bitop3:0xea
    ds_add_u32 v94, v2
    v_mul_hi_u32_u24 v14, 429497, v119
    v_lshrrev_b32 v12, 3, v95
    v_cos_f32 v10, v10
    v_lshlrev_b16 v13, 3, v95
    v_mad_i32_i24 v11, v14, s55, v119
    v_bitop3_b32 v12, v6, v13, v12 bitop3:0xca
    v_lshl_add_u32 v11, v11, 17, s40
    v_lshlrev_b16 v14, 8, v14
    v_lshrrev_b32 v13, 2, v95
    v_add_u32 v119, v12, v11
    v_bitop3_b32 v95, v5, v13, v14 bitop3:0xea
    ds_add_u32 v95, v2
    v_cvt_pk_bf16_f32 v111, v9, v10
    v_perm_b32 v12, v111, v111, s41
    v_bitop3_b32 v118, v4, v12, v118 bitop3:0xca
    v_perm_b32 v13, v111, v111, s42
    v_bitop3_b32 v119, v4, v13, v119 bitop3:0xca
    v_lshrrev_b32 v8, 2, v0
    v_and_b32 v7, 0x3c00, v0
    v_bitop3_b32 v7, v5, v8, v7 bitop3:0xea
    s_waitcnt lgkmcnt(0)
    s_barrier
    ds_read2st64_b32 v[8:9], v7 offset0:0 offset1:1
    ds_read2st64_b32 v[10:11], v7 offset0:2 offset1:3
    s_add_u32 s47, s35, 0x5484000
    s_add_u32 s47, s47, s91
    buffer_store_dwordx4 v[120:123], v0, s[20:23], s47 offen sc1
    s_add_u32 s44, s96, 0x8000000
    s_nop 0
    v_lshlrev_b32 v120, 1, v1
    buffer_load_dwordx4 v[120:123], v120, s[12:15], s44 offen nt
    s_waitcnt lgkmcnt(0)
    v_lshl_or_b32 v12, v9, 16, v8
    v_lshl_or_b32 v13, v11, 16, v10
    v_mov_b32 v14, v12
    v_mov_b32 v15, v13
    s_nop 0
    v_add_u32_dpp v14, v14, v14 row_shr:1 row_mask:0xf bank_mask:0xf bound_ctrl:1
    v_add_u32_dpp v15, v15, v15 row_shr:1 row_mask:0xf bank_mask:0xf bound_ctrl:1
    s_nop 0
    v_add_u32_dpp v14, v14, v14 row_shr:2 row_mask:0xf bank_mask:0xf bound_ctrl:1
    v_add_u32_dpp v15, v15, v15 row_shr:2 row_mask:0xf bank_mask:0xf bound_ctrl:1
    s_nop 0
    v_add_u32_dpp v14, v14, v14 row_shr:4 row_mask:0xf bank_mask:0xf bound_ctrl:1
    v_add_u32_dpp v15, v15, v15 row_shr:4 row_mask:0xf bank_mask:0xf bound_ctrl:1
    s_nop 0
    v_add_u32_dpp v14, v14, v14 row_shr:8 row_mask:0xf bank_mask:0xf bound_ctrl:1
    v_add_u32_dpp v15, v15, v15 row_shr:8 row_mask:0xf bank_mask:0xf bound_ctrl:1
    s_nop 0
    v_add_u32_dpp v14, v14, v14 row_bcast:15 row_mask:0xa bank_mask:0xf
    v_add_u32_dpp v15, v15, v15 row_bcast:15 row_mask:0xa bank_mask:0xf
    s_nop 0
    v_add_u32_dpp v14, v14, v14 row_bcast:31 row_mask:0xc bank_mask:0xf
    v_add_u32_dpp v15, v15, v15 row_bcast:31 row_mask:0xc bank_mask:0xf
    v_readlane_b32 s48, v14, 63
    v_readlane_b32 s49, v15, 63
    s_lshl_b32 s54, s32, 2
    v_mov_b32 v8, s54
    s_and_b32 s50, s48, 0xffff
    s_lshr_b32 s51, s48, 16
    s_and_b32 s52, s49, 0xffff
    s_lshr_b32 s53, s49, 16
    s_add_u32 s51, s51, s50
    s_add_u32 s52, s52, s51
    s_add_u32 s53, s53, s52
    v_mov_b32 v9, s53
    s_mov_b64 exec, 1
    ds_write_b32 v8, v9 offset:16384
    s_cmp_lg_u32 s32, 15
    s_cbranch_scc1 L1_tk2
    s_waitcnt vmcnt(1)
L1_tk2:
    ds_write_b32 v8, v3 offset:16448
    s_mov_b64 exec, -1
    v_and_b32 v8, 60, v7
    s_waitcnt lgkmcnt(0)
    s_barrier
    ds_read_b32 v9, v8 offset:16384
    ds_read_b32 v10, v8 offset:16448
    s_waitcnt lgkmcnt(0)
    v_readlane_b32 s84, v10, 15
    s_and_b32 s3, s2, 1
    s_lshl_b32 s3, s3, 7
    s_add_u32 s84, s84, s3
    s_and_b32 s4, s84, 127
    s_lshl_b32 s6, s32, 10
    s_mov_b32 s43, 5
    s_bitcmp1_b32 s2, 0
    s_cselect_b32 s5, 128, 0
    s_mov_b32 s7, 128
    s_cselect_b32 s7, 124, s7
    s_add_u32 s5, s5, s4
    s_add_u32 s5, s5, 9472
    s_lshl_b32 s5, s5, 14
    s_add_u32 s38, s5, s6
    s_cmp_lt_u32 s4, s7
    s_addc_u32 s43, s43, 0
    s_bitcmp1_b32 s2, 0
    s_cselect_b32 s5, 112, 0
    s_mov_b32 s7, 112
    s_cselect_b32 s7, 100, s7
    s_add_u32 s5, s5, s4
    s_add_u32 s5, s5, 9724
    s_lshl_b32 s5, s5, 14
    s_add_u32 s39, s5, s6
    s_cmp_lt_u32 s4, s7
    s_addc_u32 s43, s43, 0
    s_bitcmp1_b32 s2, 0
    s_cselect_b32 s5, 64, 0
    s_mov_b32 s7, 64
    s_cselect_b32 s7, 0, s7
    s_add_u32 s5, s5, s4
    s_add_u32 s5, s5, 9936
    s_lshl_b32 s5, s5, 14
    s_add_u32 s58, s5, s6
    s_cmp_lt_u32 s4, s7
    s_addc_u32 s43, s43, 0
    v_add_u32_dpp v9, v9, v9 row_shr:1 row_mask:0xf bank_mask:0xf bound_ctrl:1
    s_nop 1
    v_add_u32_dpp v9, v9, v9 row_shr:2 row_mask:0xf bank_mask:0xf bound_ctrl:1
    s_nop 1
    v_add_u32_dpp v9, v9, v9 row_shr:4 row_mask:0xf bank_mask:0xf bound_ctrl:1
    s_nop 1
    v_add_u32_dpp v9, v9, v9 row_shr:8 row_mask:0xf bank_mask:0xf bound_ctrl:1
    s_nop 0
    v_readlane_b32 s54, v9, s32
    s_sub_u32 s54, s54, s53
    s_add_u32 s50, s50, s54
    s_add_u32 s51, s51, s54
    s_add_u32 s52, s52, s54
    s_pack_ll_b32_b16 s48, s54, s50
    s_pack_ll_b32_b16 s49, s51, s52
    v_add_u32 v14, s48, v14
    v_add_u32 v15, s49, v15
    v_sub_u32 v12, v14, v12
    v_sub_u32 v13, v15, v13
    v_and_b32 v8, 0xffff, v12
    v_lshrrev_b32 v9, 16, v12
    v_and_b32 v10, 0xffff, v13
    v_lshrrev_b32 v11, 16, v13
    ds_write2st64_b32 v7, v8, v9 offset0:0 offset1:1
    ds_write2st64_b32 v7, v10, v11 offset0:2 offset1:3
    v_and_b32 v8, 0x3f0, v0
    v_lshl_add_u32 v8, v8, 1, s36
    ds_write_b64 v8, v[12:13] offset:20480
    s_bitset0_b64 exec, 63
    s_not_b64 exec, exec
    ds_write_b64 v8, v[14:15] offset:20512
    s_mov_b64 exec, -1
    s_waitcnt lgkmcnt(0)
    s_barrier
    s_setprio 3
    ds_add_rtn_u32 v24, v24, v2
    ds_add_rtn_u32 v25, v25, v2
    ds_add_rtn_u32 v26, v26, v2
    ds_add_rtn_u32 v27, v27, v2
    ds_read_b128 v[12:15], v0 offset:20480
    v_cmp_gt_u32 vcc, 8448, v0
    s_add_u32 s45, s35, 0x5484000
    s_add_u32 s45, s45, s93
    buffer_store_dwordx4 v[44:47], v0, s[20:23], s45 offen sc1
    s_add_u32 s46, s96, 0x8000000
    s_lshr_b32 s46, s46, 1
    buffer_load_dwordx2 v[44:45], v1, s[16:19], s46 offen nt
    s_add_u32 s47, s96, 0x8400000
    s_lshr_b32 s47, s47, 1
    buffer_load_dwordx2 v[46:47], v1, s[16:19], s47 offen nt
    ds_add_rtn_u32 v52, v52, v2
    ds_add_rtn_u32 v53, v53, v2
    ds_add_rtn_u32 v54, v54, v2
    ds_add_rtn_u32 v55, v55, v2
    s_setprio 2
    ds_add_rtn_u32 v72, v72, v2
    ds_add_rtn_u32 v73, v73, v2
    ds_add_rtn_u32 v74, v74, v2
    ds_add_rtn_u32 v75, v75, v2
    s_waitcnt lgkmcnt(8)
    s_cbranch_vccz L1_p4
    s_add_u32 s44, s35, 0x7ec0000
    s_mov_b64 exec, vcc
    buffer_store_dwordx4 v[12:15], v0, s[24:27], s44 offen sc1
    s_mov_b64 exec, -1
L1_p4:
    s_add_u32 s45, s35, 0x5488000
    s_add_u32 s45, s45, s72
    buffer_store_dwordx4 v[20:23], v0, s[20:23], s45 offen sc1
    s_add_u32 s46, s96, 0x8400000
    s_nop 0
    v_lshlrev_b32 v20, 1, v1
    buffer_load_dwordx4 v[20:23], v20, s[8:11], s46 offen nt
    ds_add_rtn_u32 v80, v80, v2
    ds_add_rtn_u32 v81, v81, v2
    ds_add_rtn_u32 v82, v82, v2
    ds_add_rtn_u32 v83, v83, v2
    s_setprio 1
    ds_add_rtn_u32 v96, v96, v2
    ds_add_rtn_u32 v97, v97, v2
    ds_add_rtn_u32 v98, v98, v2
    ds_add_rtn_u32 v99, v99, v2
    ds_add_rtn_u32 v100, v100, v2
    ds_add_rtn_u32 v101, v101, v2
    ds_add_rtn_u32 v102, v102, v2
    ds_add_rtn_u32 v103, v103, v2
    s_add_u32 s47, s35, 0x5488000
    s_add_u32 s47, s47, s73
    buffer_store_dwordx4 v[124:127], v0, s[20:23], s47 offen sc1
    s_add_u32 s44, s96, 0x8400000
    s_nop 0
    v_lshlrev_b32 v124, 1, v1
    buffer_load_dwordx4 v[124:127], v124, s[12:15], s44 offen nt
    s_setprio 0
    ds_add_rtn_u32 v88, v88, v2
    ds_add_rtn_u32 v89, v89, v2
    ds_add_rtn_u32 v90, v90, v2
    ds_add_rtn_u32 v91, v91, v2
    ds_add_rtn_u32 v92, v92, v2
    ds_add_rtn_u32 v93, v93, v2
    ds_add_rtn_u32 v94, v94, v2
    ds_add_rtn_u32 v95, v95, v2
    s_waitcnt lgkmcnt(0)
    s_barrier
    s_setprio 3
    v_and_b32 v7, -4, v24
    v_lshl_add_u32 v8, v24, 2, v7
    ds_write_b32 v8, v40
    v_lshl_add_u32 v7, v7, 2, v24
    ds_write_b8 v7, v84 offset:16
    v_and_b32 v9, -4, v25
    v_lshl_add_u32 v10, v25, 2, v9
    ds_write_b32 v10, v41
    v_lshl_add_u32 v9, v9, 2, v25
    ds_write_b8_d16_hi v9, v84 offset:16
    v_and_b32 v7, -4, v26
    v_lshl_add_u32 v8, v26, 2, v7
    ds_write_b32 v8, v42
    v_lshl_add_u32 v7, v7, 2, v26
    ds_write_b8 v7, v85 offset:16
    v_and_b32 v9, -4, v27
    v_lshl_add_u32 v10, v27, 2, v9
    ds_write_b32 v10, v43
    v_lshl_add_u32 v9, v9, 2, v27
    ds_write_b8_d16_hi v9, v85 offset:16
    s_add_u32 s45, s35, 0x5488000
    s_add_u32 s45, s45, s85
    buffer_store_dwordx4 v[32:35], v0, s[20:23], s45 offen sc1
    s_add_u32 s46, s96, 0x8800000
    v_lshlrev_b32 v40, 1, v1
    buffer_load_dwordx4 v[40:43], v40, s[8:11], s46 offen nt
    s_add_u32 s47, s96, 0x8800000
    v_lshlrev_b32 v24, 1, v1
    buffer_load_dwordx4 v[24:27], v24, s[12:15], s47 offen nt
    v_and_b32 v7, -4, v52
    v_lshl_add_u32 v8, v52, 2, v7
    ds_write_b32 v8, v48
    v_lshl_add_u32 v7, v7, 2, v52
    ds_write_b8 v7, v86 offset:16
    v_and_b32 v9, -4, v53
    v_lshl_add_u32 v10, v53, 2, v9
    ds_write_b32 v10, v49
    v_lshl_add_u32 v9, v9, 2, v53
    ds_write_b8_d16_hi v9, v86 offset:16
    v_and_b32 v7, -4, v54
    v_lshl_add_u32 v8, v54, 2, v7
    ds_write_b32 v8, v50
    v_lshl_add_u32 v7, v7, 2, v54
    ds_write_b8 v7, v87 offset:16
    v_and_b32 v9, -4, v55
    v_lshl_add_u32 v10, v55, 2, v9
    ds_write_b32 v10, v51
    v_lshl_add_u32 v9, v9, 2, v55
    ds_write_b8_d16_hi v9, v87 offset:16
    s_add_u32 s44, s96, 0x8800000
    s_lshr_b32 s44, s44, 1
    buffer_load_dwordx2 v[32:33], v1, s[16:19], s44 offen nt
    s_add_u32 s45, s96, 0x8c00000
    s_lshr_b32 s45, s45, 1
    buffer_load_dwordx2 v[34:35], v1, s[16:19], s45 offen nt
    s_add_u32 s46, s96, 0x8c00000
    v_lshlrev_b32 v48, 1, v1
    buffer_load_dwordx4 v[48:51], v48, s[8:11], s46 offen nt
    s_waitcnt vmcnt(10)
    v_lshlrev_b32 v7, 16, v44
    v_and_b32 v8, 0xffff0000, v44
    v_lshlrev_b32 v9, 16, v45
    v_and_b32 v10, 0xffff0000, v45
    v_mul_f32 v7, 0.15915494, v7
    v_mul_f32 v8, 0.15915494, v8
    v_mul_f32 v9, 0.15915494, v9
    v_mul_f32 v10, 0.15915494, v10
    v_mul_hi_u32_u24 v14, 429497, v16
    v_lshrrev_b32 v12, 3, v120
    v_cos_f32 v7, v7
    v_lshlrev_b16 v13, 3, v120
    v_mad_i32_i24 v11, v14, s55, v16
    v_bitop3_b32 v12, v6, v13, v12 bitop3:0xca
    v_lshl_add_u32 v11, v11, 17, s40
    v_lshlrev_b16 v14, 8, v14
    v_lshrrev_b32 v13, 2, v120
    v_add_u32 v16, v12, v11
    v_bitop3_b32 v120, v5, v13, v14 bitop3:0xea
    v_mul_hi_u32_u24 v14, 429497, v17
    v_lshrrev_b32 v12, 3, v121
    v_cos_f32 v8, v8
    v_lshlrev_b16 v13, 3, v121
    v_mad_i32_i24 v11, v14, s55, v17
    v_bitop3_b32 v12, v6, v13, v12 bitop3:0xca
    v_lshl_add_u32 v11, v11, 17, s40
    v_lshlrev_b16 v14, 8, v14
    v_lshrrev_b32 v13, 2, v121
    v_add_u32 v17, v12, v11
    v_bitop3_b32 v121, v5, v13, v14 bitop3:0xea
    v_cvt_pk_bf16_f32 v44, v7, v8
    v_perm_b32 v12, v44, v44, s41
    v_bitop3_b32 v16, v4, v12, v16 bitop3:0xca
    v_perm_b32 v13, v44, v44, s42
    v_bitop3_b32 v17, v4, v13, v17 bitop3:0xca
    v_mul_hi_u32_u24 v14, 429497, v18
    v_lshrrev_b32 v12, 3, v122
    v_cos_f32 v9, v9
    v_lshlrev_b16 v13, 3, v122
    v_mad_i32_i24 v11, v14, s55, v18
    v_bitop3_b32 v12, v6, v13, v12 bitop3:0xca
    v_lshl_add_u32 v11, v11, 17, s40
    v_lshlrev_b16 v14, 8, v14
    v_lshrrev_b32 v13, 2, v122
    v_add_u32 v18, v12, v11
    v_bitop3_b32 v122, v5, v13, v14 bitop3:0xea
    v_mul_hi_u32_u24 v14, 429497, v19
    v_lshrrev_b32 v12, 3, v123
    v_cos_f32 v10, v10
    v_lshlrev_b16 v13, 3, v123
    v_mad_i32_i24 v11, v14, s55, v19
    v_bitop3_b32 v12, v6, v13, v12 bitop3:0xca
    v_lshl_add_u32 v11, v11, 17, s40
    v_lshlrev_b16 v14, 8, v14
    v_lshrrev_b32 v13, 2, v123
    v_add_u32 v19, v12, v11
    v_bitop3_b32 v123, v5, v13, v14 bitop3:0xea
    v_cvt_pk_bf16_f32 v45, v9, v10
    v_perm_b32 v12, v45, v45, s41
    v_bitop3_b32 v18, v4, v12, v18 bitop3:0xca
    v_perm_b32 v13, v45, v45, s42
    v_bitop3_b32 v19, v4, v13, v19 bitop3:0xca
    s_setprio 2
    v_and_b32 v7, -4, v72
    v_lshl_add_u32 v8, v72, 2, v7
    ds_write_b32 v8, v68
    v_lshl_add_u32 v7, v7, 2, v72
    ds_write_b8 v7, v56 offset:16
    v_and_b32 v9, -4, v73
    v_lshl_add_u32 v10, v73, 2, v9
    ds_write_b32 v10, v69
    v_lshl_add_u32 v9, v9, 2, v73
    ds_write_b8_d16_hi v9, v56 offset:16
    v_and_b32 v7, -4, v74
    v_lshl_add_u32 v8, v74, 2, v7
    ds_write_b32 v8, v70
    v_lshl_add_u32 v7, v7, 2, v74
    ds_write_b8 v7, v57 offset:16
    v_and_b32 v9, -4, v75
    v_lshl_add_u32 v10, v75, 2, v9
    ds_write_b32 v10, v71
    v_lshl_add_u32 v9, v9, 2, v75
    ds_write_b8_d16_hi v9, v57 offset:16
    s_add_u32 s47, s35, 0x5488000
    s_add_u32 s47, s47, s91
    buffer_store_dwordx4 v[36:39], v0, s[20:23], s47 offen sc1
    s_add_u32 s44, s96, 0x8c00000
    v_lshlrev_b32 v52, 1, v1
    buffer_load_dwordx4 v[52:55], v52, s[12:15], s44 offen nt
    s_waitcnt vmcnt(8)
    v_lshlrev_b32 v7, 16, v46
    v_and_b32 v8, 0xffff0000, v46
    v_lshlrev_b32 v9, 16, v47
    v_and_b32 v10, 0xffff0000, v47
    v_mul_f32 v7, 0.15915494, v7
    v_mul_f32 v8, 0.15915494, v8
    v_mul_f32 v9, 0.15915494, v9
    v_mul_f32 v10, 0.15915494, v10
    v_mul_hi_u32_u24 v14, 429497, v20
    v_lshrrev_b32 v12, 3, v124
    v_cos_f32 v7, v7
    v_lshlrev_b16 v13, 3, v124
    v_mad_i32_i24 v11, v14, s55, v20
    v_bitop3_b32 v12, v6, v13, v12 bitop3:0xca
    v_lshl_add_u32 v11, v11, 17, s40
    v_lshlrev_b16 v14, 8, v14
    v_lshrrev_b32 v13, 2, v124
    v_add_u32 v20, v12, v11
    v_bitop3_b32 v124, v5, v13, v14 bitop3:0xea
    v_mul_hi_u32_u24 v14, 429497, v21
    v_lshrrev_b32 v12, 3, v125
    v_cos_f32 v8, v8
    v_lshlrev_b16 v13, 3, v125
    v_mad_i32_i24 v11, v14, s55, v21
    v_bitop3_b32 v12, v6, v13, v12 bitop3:0xca
    v_lshl_add_u32 v11, v11, 17, s40
    v_lshlrev_b16 v14, 8, v14
    v_lshrrev_b32 v13, 2, v125
    v_add_u32 v21, v12, v11
    v_bitop3_b32 v125, v5, v13, v14 bitop3:0xea
    v_cvt_pk_bf16_f32 v46, v7, v8
    v_perm_b32 v12, v46, v46, s41
    v_bitop3_b32 v20, v4, v12, v20 bitop3:0xca
    v_perm_b32 v13, v46, v46, s42
    v_bitop3_b32 v21, v4, v13, v21 bitop3:0xca
    v_mul_hi_u32_u24 v14, 429497, v22
    v_lshrrev_b32 v12, 3, v126
    v_cos_f32 v9, v9
    v_lshlrev_b16 v13, 3, v126
    v_mad_i32_i24 v11, v14, s55, v22
    v_bitop3_b32 v12, v6, v13, v12 bitop3:0xca
    v_lshl_add_u32 v11, v11, 17, s40
    v_lshlrev_b16 v14, 8, v14
    v_lshrrev_b32 v13, 2, v126
    v_add_u32 v22, v12, v11
    v_bitop3_b32 v126, v5, v13, v14 bitop3:0xea
    v_mul_hi_u32_u24 v14, 429497, v23
    v_lshrrev_b32 v12, 3, v127
    v_cos_f32 v10, v10
    v_lshlrev_b16 v13, 3, v127
    v_mad_i32_i24 v11, v14, s55, v23
    v_bitop3_b32 v12, v6, v13, v12 bitop3:0xca
    v_lshl_add_u32 v11, v11, 17, s40
    v_lshlrev_b16 v14, 8, v14
    v_lshrrev_b32 v13, 2, v127
    v_add_u32 v23, v12, v11
    v_bitop3_b32 v127, v5, v13, v14 bitop3:0xea
    v_cvt_pk_bf16_f32 v47, v9, v10
    v_perm_b32 v12, v47, v47, s41
    v_bitop3_b32 v22, v4, v12, v22 bitop3:0xca
    v_perm_b32 v13, v47, v47, s42
    v_bitop3_b32 v23, v4, v13, v23 bitop3:0xca
    v_and_b32 v7, -4, v80
    v_lshl_add_u32 v8, v80, 2, v7
    ds_write_b32 v8, v76
    v_lshl_add_u32 v7, v7, 2, v80
    ds_write_b8 v7, v58 offset:16
    v_and_b32 v9, -4, v81
    v_lshl_add_u32 v10, v81, 2, v9
    ds_write_b32 v10, v77
    v_lshl_add_u32 v9, v9, 2, v81
    ds_write_b8_d16_hi v9, v58 offset:16
    v_and_b32 v7, -4, v82
    v_lshl_add_u32 v8, v82, 2, v7
    ds_write_b32 v8, v78
    v_lshl_add_u32 v7, v7, 2, v82
    ds_write_b8 v7, v59 offset:16
    v_and_b32 v9, -4, v83
    v_lshl_add_u32 v10, v83, 2, v9
    ds_write_b32 v10, v79
    v_lshl_add_u32 v9, v9, 2, v83
    ds_write_b8_d16_hi v9, v59 offset:16
    s_add_u32 s45, s96, 0x9000000
    v_lshlrev_b32 v84, 1, v1
    buffer_load_dwordx4 v[84:87], v84, s[8:11], s45 offen nt
    s_add_u32 s46, s96, 0x9000000
    v_lshlrev_b32 v68, 1, v1
    buffer_load_dwordx4 v[68:71], v68, s[12:15], s46 offen nt
    s_waitcnt vmcnt(5)
    v_lshlrev_b32 v7, 16, v32
    v_and_b32 v8, 0xffff0000, v32
    v_lshlrev_b32 v9, 16, v33
    v_and_b32 v10, 0xffff0000, v33
    v_mul_f32 v7, 0.15915494, v7
    v_mul_f32 v8, 0.15915494, v8
    v_mul_f32 v9, 0.15915494, v9
    v_mul_f32 v10, 0.15915494, v10
    v_mul_hi_u32_u24 v14, 429497, v40
    v_lshrrev_b32 v12, 3, v24
    v_cos_f32 v7, v7
    v_lshlrev_b16 v13, 3, v24
    v_mad_i32_i24 v11, v14, s55, v40
    v_bitop3_b32 v12, v6, v13, v12 bitop3:0xca
    v_lshl_add_u32 v11, v11, 17, s40
    v_lshlrev_b16 v14, 8, v14
    v_lshrrev_b32 v13, 2, v24
    v_add_u32 v40, v12, v11
    v_bitop3_b32 v24, v5, v13, v14 bitop3:0xea
    v_mul_hi_u32_u24 v14, 429497, v41
    v_lshrrev_b32 v12, 3, v25
    v_cos_f32 v8, v8
    v_lshlrev_b16 v13, 3, v25
    v_mad_i32_i24 v11, v14, s55, v41
    v_bitop3_b32 v12, v6, v13, v12 bitop3:0xca
    v_lshl_add_u32 v11, v11, 17, s40
    v_lshlrev_b16 v14, 8, v14
    v_lshrrev_b32 v13, 2, v25
    v_add_u32 v41, v12, v11
    v_bitop3_b32 v25, v5, v13, v14 bitop3:0xea
    v_cvt_pk_bf16_f32 v32, v7, v8
    v_perm_b32 v12, v32, v32, s41
    v_bitop3_b32 v40, v4, v12, v40 bitop3:0xca
    v_perm_b32 v13, v32, v32, s42
    v_bitop3_b32 v41, v4, v13, v41 bitop3:0xca
    v_mul_hi_u32_u24 v14, 429497, v42
    v_lshrrev_b32 v12, 3, v26
    v_cos_f32 v9, v9
    v_lshlrev_b16 v13, 3, v26
    v_mad_i32_i24 v11, v14, s55, v42
    v_bitop3_b32 v12, v6, v13, v12 bitop3:0xca
    v_lshl_add_u32 v11, v11, 17, s40
    v_lshlrev_b16 v14, 8, v14
    v_lshrrev_b32 v13, 2, v26
    v_add_u32 v42, v12, v11
    v_bitop3_b32 v26, v5, v13, v14 bitop3:0xea
    v_mul_hi_u32_u24 v14, 429497, v43
    v_lshrrev_b32 v12, 3, v27
    v_cos_f32 v10, v10
    v_lshlrev_b16 v13, 3, v27
    v_mad_i32_i24 v11, v14, s55, v43
    v_bitop3_b32 v12, v6, v13, v12 bitop3:0xca
    v_lshl_add_u32 v11, v11, 17, s40
    v_lshlrev_b16 v14, 8, v14
    v_lshrrev_b32 v13, 2, v27
    v_add_u32 v43, v12, v11
    v_bitop3_b32 v27, v5, v13, v14 bitop3:0xea
    v_cvt_pk_bf16_f32 v33, v9, v10
    v_perm_b32 v12, v33, v33, s41
    v_bitop3_b32 v42, v4, v12, v42 bitop3:0xca
    v_perm_b32 v13, v33, v33, s42
    v_bitop3_b32 v43, v4, v13, v43 bitop3:0xca
    s_setprio 1
    v_and_b32 v7, -4, v96
    v_lshl_add_u32 v8, v96, 2, v7
    ds_write_b32 v8, v64
    v_lshl_add_u32 v7, v7, 2, v96
    ds_write_b8 v7, v104 offset:16
    v_and_b32 v9, -4, v97
    v_lshl_add_u32 v10, v97, 2, v9
    ds_write_b32 v10, v65
    v_lshl_add_u32 v9, v9, 2, v97
    ds_write_b8_d16_hi v9, v104 offset:16
    v_and_b32 v7, -4, v98
    v_lshl_add_u32 v8, v98, 2, v7
    ds_write_b32 v8, v66
    v_lshl_add_u32 v7, v7, 2, v98
    ds_write_b8 v7, v105 offset:16
    v_and_b32 v9, -4, v99
    v_lshl_add_u32 v10, v99, 2, v9
    ds_write_b32 v10, v67
    v_lshl_add_u32 v9, v9, 2, v99
    ds_write_b8_d16_hi v9, v105 offset:16
    s_add_u32 s47, s96, 0x9000000
    s_lshr_b32 s47, s47, 1
    buffer_load_dwordx2 v[72:73], v1, s[16:19], s47 offen nt
    s_cmp_le_u32 s43, 5
    s_cselect_b32 s18, 0, s18
    s_add_u32 s44, s38, 0x0
    s_lshr_b32 s44, s44, 1
    buffer_load_dwordx2 v[74:75], v1, s[16:19], s44 offen nt
    s_cmp_le_u32 s43, 5
    s_cselect_b32 s10, 0, s10
    s_add_u32 s45, s38, 0x0
    v_lshlrev_b32 v36, 1, v1
    buffer_load_dwordx4 v[36:39], v36, s[8:11], s45 offen nt
    v_and_b32 v7, -4, v100
    v_lshl_add_u32 v8, v100, 2, v7
    ds_write_b32 v8, v60
    v_lshl_add_u32 v7, v7, 2, v100
    ds_write_b8 v7, v106 offset:16
    v_and_b32 v9, -4, v101
    v_lshl_add_u32 v10, v101, 2, v9
    ds_write_b32 v10, v61
    v_lshl_add_u32 v9, v9, 2, v101
    ds_write_b8_d16_hi v9, v106 offset:16
    v_and_b32 v7, -4, v102
    v_lshl_add_u32 v8, v102, 2, v7
    ds_write_b32 v8, v62
    v_lshl_add_u32 v7, v7, 2, v102
    ds_write_b8 v7, v107 offset:16
    v_and_b32 v9, -4, v103
    v_lshl_add_u32 v10, v103, 2, v9
    ds_write_b32 v10, v63
    v_lshl_add_u32 v9, v9, 2, v103
    ds_write_b8_d16_hi v9, v107 offset:16
    s_add_u32 s46, s35, 0x5488000
    s_add_u32 s46, s46, s93
    buffer_store_dwordx4 v[28:31], v0, s[20:23], s46 offen sc1
    s_cmp_le_u32 s43, 5
    s_cselect_b32 s14, 0, s14
    s_add_u32 s47, s38, 0x0
    v_lshlrev_b32 v76, 1, v1
    buffer_load_dwordx4 v[76:79], v76, s[12:15], s47 offen nt
    s_waitcnt vmcnt(7)
    v_lshlrev_b32 v7, 16, v34
    v_and_b32 v8, 0xffff0000, v34
    v_lshlrev_b32 v9, 16, v35
    v_and_b32 v10, 0xffff0000, v35
    v_mul_f32 v7, 0.15915494, v7
    v_mul_f32 v8, 0.15915494, v8
    v_mul_f32 v9, 0.15915494, v9
    v_mul_f32 v10, 0.15915494, v10
    v_mul_hi_u32_u24 v14, 429497, v48
    v_lshrrev_b32 v12, 3, v52
    v_cos_f32 v7, v7
    v_lshlrev_b16 v13, 3, v52
    v_mad_i32_i24 v11, v14, s55, v48
    v_bitop3_b32 v12, v6, v13, v12 bitop3:0xca
    v_lshl_add_u32 v11, v11, 17, s40
    v_lshlrev_b16 v14, 8, v14
    v_lshrrev_b32 v13, 2, v52
    v_add_u32 v48, v12, v11
    v_bitop3_b32 v52, v5, v13, v14 bitop3:0xea
    v_mul_hi_u32_u24 v14, 429497, v49
    v_lshrrev_b32 v12, 3, v53
    v_cos_f32 v8, v8
    v_lshlrev_b16 v13, 3, v53
    v_mad_i32_i24 v11, v14, s55, v49
    v_bitop3_b32 v12, v6, v13, v12 bitop3:0xca
    v_lshl_add_u32 v11, v11, 17, s40
    v_lshlrev_b16 v14, 8, v14
    v_lshrrev_b32 v13, 2, v53
    v_add_u32 v49, v12, v11
    v_bitop3_b32 v53, v5, v13, v14 bitop3:0xea
    v_cvt_pk_bf16_f32 v34, v7, v8
    v_perm_b32 v12, v34, v34, s41
    v_bitop3_b32 v48, v4, v12, v48 bitop3:0xca
    v_perm_b32 v13, v34, v34, s42
    v_bitop3_b32 v49, v4, v13, v49 bitop3:0xca
    v_mul_hi_u32_u24 v14, 429497, v50
    v_lshrrev_b32 v12, 3, v54
    v_cos_f32 v9, v9
    v_lshlrev_b16 v13, 3, v54
    v_mad_i32_i24 v11, v14, s55, v50
    v_bitop3_b32 v12, v6, v13, v12 bitop3:0xca
    v_lshl_add_u32 v11, v11, 17, s40
    v_lshlrev_b16 v14, 8, v14
    v_lshrrev_b32 v13, 2, v54
    v_add_u32 v50, v12, v11
    v_bitop3_b32 v54, v5, v13, v14 bitop3:0xea
    v_mul_hi_u32_u24 v14, 429497, v51
    v_lshrrev_b32 v12, 3, v55
    v_cos_f32 v10, v10
    v_lshlrev_b16 v13, 3, v55
    v_mad_i32_i24 v11, v14, s55, v51
    v_bitop3_b32 v12, v6, v13, v12 bitop3:0xca
    v_lshl_add_u32 v11, v11, 17, s40
    v_lshlrev_b16 v14, 8, v14
    v_lshrrev_b32 v13, 2, v55
    v_add_u32 v51, v12, v11
    v_bitop3_b32 v55, v5, v13, v14 bitop3:0xea
    v_cvt_pk_bf16_f32 v35, v9, v10
    v_perm_b32 v12, v35, v35, s41
    v_bitop3_b32 v50, v4, v12, v50 bitop3:0xca
    v_perm_b32 v13, v35, v35, s42
    v_bitop3_b32 v51, v4, v13, v51 bitop3:0xca
    s_setprio 0
    v_and_b32 v7, -4, v88
    v_lshl_add_u32 v8, v88, 2, v7
    ds_write_b32 v8, v112
    v_lshl_add_u32 v7, v7, 2, v88
    ds_write_b8 v7, v108 offset:16
    v_and_b32 v9, -4, v89
    v_lshl_add_u32 v10, v89, 2, v9
    ds_write_b32 v10, v113
    v_lshl_add_u32 v9, v9, 2, v89
    ds_write_b8_d16_hi v9, v108 offset:16
    v_and_b32 v7, -4, v90
    v_lshl_add_u32 v8, v90, 2, v7
    ds_write_b32 v8, v114
    v_lshl_add_u32 v7, v7, 2, v90
    ds_write_b8 v7, v109 offset:16
    v_and_b32 v9, -4, v91
    v_lshl_add_u32 v10, v91, 2, v9
    ds_write_b32 v10, v115
    v_lshl_add_u32 v9, v9, 2, v91
    ds_write_b8_d16_hi v9, v109 offset:16
    s_cmp_le_u32 s43, 6
    s_cselect_b32 s10, 0, s10
    s_add_u32 s44, s39, 0x0
    v_lshlrev_b32 v80, 1, v1
    buffer_load_dwordx4 v[80:83], v80, s[8:11], s44 offen nt
    s_cmp_le_u32 s43, 6
    s_cselect_b32 s14, 0, s14
    s_add_u32 s45, s39, 0x0
    v_lshlrev_b32 v56, 1, v1
    buffer_load_dwordx4 v[56:59], v56, s[12:15], s45 offen nt
    s_waitcnt vmcnt(5)
    v_lshlrev_b32 v7, 16, v72
    v_and_b32 v8, 0xffff0000, v72
    v_lshlrev_b32 v9, 16, v73
    v_and_b32 v10, 0xffff0000, v73
    v_mul_f32 v7, 0.15915494, v7
    v_mul_f32 v8, 0.15915494, v8
    v_mul_f32 v9, 0.15915494, v9
    v_mul_f32 v10, 0.15915494, v10
    v_mul_hi_u32_u24 v14, 429497, v84
    v_lshrrev_b32 v12, 3, v68
    v_cos_f32 v7, v7
    v_lshlrev_b16 v13, 3, v68
    v_mad_i32_i24 v11, v14, s55, v84
    v_bitop3_b32 v12, v6, v13, v12 bitop3:0xca
    v_lshl_add_u32 v11, v11, 17, s40
    v_lshlrev_b16 v14, 8, v14
    v_lshrrev_b32 v13, 2, v68
    v_add_u32 v84, v12, v11
    v_bitop3_b32 v68, v5, v13, v14 bitop3:0xea
    v_mul_hi_u32_u24 v14, 429497, v85
    v_lshrrev_b32 v12, 3, v69
    v_cos_f32 v8, v8
    v_lshlrev_b16 v13, 3, v69
    v_mad_i32_i24 v11, v14, s55, v85
    v_bitop3_b32 v12, v6, v13, v12 bitop3:0xca
    v_lshl_add_u32 v11, v11, 17, s40
    v_lshlrev_b16 v14, 8, v14
    v_lshrrev_b32 v13, 2, v69
    v_add_u32 v85, v12, v11
    v_bitop3_b32 v69, v5, v13, v14 bitop3:0xea
    v_cvt_pk_bf16_f32 v72, v7, v8
    v_perm_b32 v12, v72, v72, s41
    v_bitop3_b32 v84, v4, v12, v84 bitop3:0xca
    v_perm_b32 v13, v72, v72, s42
    v_bitop3_b32 v85, v4, v13, v85 bitop3:0xca
    v_mul_hi_u32_u24 v14, 429497, v86
    v_lshrrev_b32 v12, 3, v70
    v_cos_f32 v9, v9
    v_lshlrev_b16 v13, 3, v70
    v_mad_i32_i24 v11, v14, s55, v86
    v_bitop3_b32 v12, v6, v13, v12 bitop3:0xca
    v_lshl_add_u32 v11, v11, 17, s40
    v_lshlrev_b16 v14, 8, v14
    v_lshrrev_b32 v13, 2, v70
    v_add_u32 v86, v12, v11
    v_bitop3_b32 v70, v5, v13, v14 bitop3:0xea
    v_mul_hi_u32_u24 v14, 429497, v87
    v_lshrrev_b32 v12, 3, v71
    v_cos_f32 v10, v10
    v_lshlrev_b16 v13, 3, v71
    v_mad_i32_i24 v11, v14, s55, v87
    v_bitop3_b32 v12, v6, v13, v12 bitop3:0xca
    v_lshl_add_u32 v11, v11, 17, s40
    v_lshlrev_b16 v14, 8, v14
    v_lshrrev_b32 v13, 2, v71
    v_add_u32 v87, v12, v11
    v_bitop3_b32 v71, v5, v13, v14 bitop3:0xea
    v_cvt_pk_bf16_f32 v73, v9, v10
    v_perm_b32 v12, v73, v73, s41
    v_bitop3_b32 v86, v4, v12, v86 bitop3:0xca
    v_perm_b32 v13, v73, v73, s42
    v_bitop3_b32 v87, v4, v13, v87 bitop3:0xca
    v_and_b32 v7, -4, v92
    v_lshl_add_u32 v8, v92, 2, v7
    ds_write_b32 v8, v116
    v_lshl_add_u32 v7, v7, 2, v92
    ds_write_b8 v7, v110 offset:16
    v_and_b32 v9, -4, v93
    v_lshl_add_u32 v10, v93, 2, v9
    ds_write_b32 v10, v117
    v_lshl_add_u32 v9, v9, 2, v93
    ds_write_b8_d16_hi v9, v110 offset:16
    v_and_b32 v7, -4, v94
    v_lshl_add_u32 v8, v94, 2, v7
    ds_write_b32 v8, v118
    v_lshl_add_u32 v7, v7, 2, v94
    ds_write_b8 v7, v111 offset:16
    v_and_b32 v9, -4, v95
    v_lshl_add_u32 v10, v95, 2, v9
    ds_write_b32 v10, v119
    v_lshl_add_u32 v9, v9, 2, v95
    ds_write_b8_d16_hi v9, v111 offset:16
    s_cmp_le_u32 s43, 6
    s_cselect_b32 s18, 0, s18
    s_add_u32 s46, s39, 0x0
    s_lshr_b32 s46, s46, 1
    buffer_load_dwordx2 v[64:65], v1, s[16:19], s46 offen nt
    s_cmp_le_u32 s43, 7
    s_cselect_b32 s18, 0, s18
    s_add_u32 s47, s58, 0x0
    s_lshr_b32 s47, s47, 1
    buffer_load_dwordx2 v[66:67], v1, s[16:19], s47 offen nt
    s_waitcnt vmcnt(4)
    s_cmp_le_u32 s43, 5
    s_cbranch_scc1 L1_s5
    v_lshlrev_b32 v7, 16, v74
    v_and_b32 v8, 0xffff0000, v74
    v_lshlrev_b32 v9, 16, v75
    v_and_b32 v10, 0xffff0000, v75
    v_mul_f32 v7, 0.15915494, v7
    v_mul_f32 v8, 0.15915494, v8
    v_mul_f32 v9, 0.15915494, v9
    v_mul_f32 v10, 0.15915494, v10
    v_mul_hi_u32_u24 v14, 429497, v36
    v_lshrrev_b32 v12, 3, v76
    v_cos_f32 v7, v7
    v_lshlrev_b16 v13, 3, v76
    v_mad_i32_i24 v11, v14, s55, v36
    v_bitop3_b32 v12, v6, v13, v12 bitop3:0xca
    v_lshl_add_u32 v11, v11, 17, s40
    v_lshlrev_b16 v14, 8, v14
    v_lshrrev_b32 v13, 2, v76
    v_add_u32 v36, v12, v11
    v_bitop3_b32 v76, v5, v13, v14 bitop3:0xea
    v_mul_hi_u32_u24 v14, 429497, v37
    v_lshrrev_b32 v12, 3, v77
    v_cos_f32 v8, v8
    v_lshlrev_b16 v13, 3, v77
    v_mad_i32_i24 v11, v14, s55, v37
    v_bitop3_b32 v12, v6, v13, v12 bitop3:0xca
    v_lshl_add_u32 v11, v11, 17, s40
    v_lshlrev_b16 v14, 8, v14
    v_lshrrev_b32 v13, 2, v77
    v_add_u32 v37, v12, v11
    v_bitop3_b32 v77, v5, v13, v14 bitop3:0xea
    v_cvt_pk_bf16_f32 v74, v7, v8
    v_perm_b32 v12, v74, v74, s41
    v_bitop3_b32 v36, v4, v12, v36 bitop3:0xca
    v_perm_b32 v13, v74, v74, s42
    v_bitop3_b32 v37, v4, v13, v37 bitop3:0xca
    v_mul_hi_u32_u24 v14, 429497, v38
    v_lshrrev_b32 v12, 3, v78
    v_cos_f32 v9, v9
    v_lshlrev_b16 v13, 3, v78
    v_mad_i32_i24 v11, v14, s55, v38
    v_bitop3_b32 v12, v6, v13, v12 bitop3:0xca
    v_lshl_add_u32 v11, v11, 17, s40
    v_lshlrev_b16 v14, 8, v14
    v_lshrrev_b32 v13, 2, v78
    v_add_u32 v38, v12, v11
    v_bitop3_b32 v78, v5, v13, v14 bitop3:0xea
    v_mul_hi_u32_u24 v14, 429497, v39
    v_lshrrev_b32 v12, 3, v79
    v_cos_f32 v10, v10
    v_lshlrev_b16 v13, 3, v79
    v_mad_i32_i24 v11, v14, s55, v39
    v_bitop3_b32 v12, v6, v13, v12 bitop3:0xca
    v_lshl_add_u32 v11, v11, 17, s40
    v_lshlrev_b16 v14, 8, v14
    v_lshrrev_b32 v13, 2, v79
    v_add_u32 v39, v12, v11
    v_bitop3_b32 v79, v5, v13, v14 bitop3:0xea
    v_cvt_pk_bf16_f32 v75, v9, v10
    v_perm_b32 v12, v75, v75, s41
    v_bitop3_b32 v38, v4, v12, v38 bitop3:0xca
    v_perm_b32 v13, v75, v75, s42
    v_bitop3_b32 v39, v4, v13, v39 bitop3:0xca
L1_s5:
    v_add_u32 v7, s72, v0
    v_add_u32 v12, s73, v0
    v_add_u32 v13, s85, v0
    v_add_u32 v14, s91, v0
    v_add_u32 v15, s93, v0
    s_min_i32 s3, s72, s73
    s_min_i32 s3, s3, s85
    s_min_i32 s3, s3, s91
    s_min_i32 s3, s3, s93
    v_add_u32 v3, s3, v0
    v_mov_b32 v8, 0
    v_mov_b32 v9, 0
    v_mov_b32 v10, 0
    v_mov_b32 v11, 0
    s_waitcnt lgkmcnt(0)
    s_barrier
    ds_read_b128 v[96:99], v7 offset:0
    ds_read_b128 v[60:63], v12 offset:0
    ds_read_b128 v[100:103], v13 offset:0
    ds_read_b128 v[104:107], v14 offset:0
    ds_read_b128 v[28:31], v15 offset:0
    ds_write_b128 v3, v[8:11]
    ds_read_b128 v[112:115], v7 offset:16384
    ds_read_b128 v[88:91], v12 offset:16384
    ds_read_b128 v[116:119], v13 offset:16384
    ds_read_b128 v[92:95], v14 offset:16384
    ds_read_b128 v[108:111], v15 offset:16384
    s_waitcnt lgkmcnt(0)
    s_barrier
    v_lshlrev_b32 v3, 3, v0
    v_and_b32 v3, 0x80, v3
    s_cmp_lg_u32 s32, 15
    s_cbranch_scc1 L2_k0
    s_mov_b64 exec, 3
    buffer_load_dword v3, v3, s[68:71], 0 offen sc1
    s_mov_b64 exec, -1
L2_k0:
    s_add_u32 s44, s35, 0x7ec4000
    s_add_u32 s44, s44, s72
    buffer_store_dwordx4 v[96:99], v0, s[20:23], s44 offen sc1
    s_cmp_le_u32 s43, 7
    s_cselect_b32 s10, 0, s10
    s_add_u32 s45, s58, 0x0
    v_lshlrev_b32 v96, 1, v1
    buffer_load_dwordx4 v[96:99], v96, s[8:11], s45 offen nt
    s_add_u32 s46, s35, 0x7ec4000
    s_add_u32 s46, s46, s73
    buffer_store_dwordx4 v[60:63], v0, s[20:23], s46 offen sc1
    s_cmp_le_u32 s43, 7
    s_cselect_b32 s14, 0, s14
    s_add_u32 s47, s58, 0x0
    v_lshlrev_b32 v60, 1, v1
    buffer_load_dwordx4 v[60:63], v60, s[12:15], s47 offen nt
    s_setprio 3
    ds_add_u32 v120, v2
    ds_add_u32 v121, v2
    ds_add_u32 v122, v2
    ds_add_u32 v123, v2
    ds_add_u32 v124, v2
    ds_add_u32 v125, v2
    ds_add_u32 v126, v2
    ds_add_u32 v127, v2
    s_setprio 2
    s_add_u32 s44, s35, 0x7ec4000
    s_add_u32 s44, s44, s85
    buffer_store_dwordx4 v[100:103], v0, s[20:23], s44 offen sc1
    ds_add_u32 v24, v2
    ds_add_u32 v25, v2
    ds_add_u32 v26, v2
    ds_add_u32 v27, v2
    ds_add_u32 v52, v2
    ds_add_u32 v53, v2
    ds_add_u32 v54, v2
    ds_add_u32 v55, v2
    s_setprio 1
    ds_add_u32 v68, v2
    ds_add_u32 v69, v2
    ds_add_u32 v70, v2
    ds_add_u32 v71, v2
    s_add_u32 s45, s35, 0x7ec4000
    s_add_u32 s45, s45, s91
    buffer_store_dwordx4 v[104:107], v0, s[20:23], s45 offen sc1
    s_cmp_le_u32 s43, 5
    s_cbranch_scc1 L1_s6
    ds_add_u32 v76, v2
    ds_add_u32 v77, v2
    ds_add_u32 v78, v2
    ds_add_u32 v79, v2
L1_s6:
    s_setprio 0
    s_waitcnt vmcnt(6)
    s_cmp_le_u32 s43, 6
    s_cbranch_scc1 L1_s7
    v_lshlrev_b32 v7, 16, v64
    v_and_b32 v8, 0xffff0000, v64
    v_lshlrev_b32 v9, 16, v65
    v_and_b32 v10, 0xffff0000, v65
    v_mul_f32 v7, 0.15915494, v7
    v_mul_f32 v8, 0.15915494, v8
    v_mul_f32 v9, 0.15915494, v9
    v_mul_f32 v10, 0.15915494, v10
    v_mul_hi_u32_u24 v14, 429497, v80
    v_lshrrev_b32 v12, 3, v56
    v_cos_f32 v7, v7
    v_lshlrev_b16 v13, 3, v56
    v_mad_i32_i24 v11, v14, s55, v80
    v_bitop3_b32 v12, v6, v13, v12 bitop3:0xca
    v_lshl_add_u32 v11, v11, 17, s40
    v_lshlrev_b16 v14, 8, v14
    v_lshrrev_b32 v13, 2, v56
    v_add_u32 v80, v12, v11
    v_bitop3_b32 v56, v5, v13, v14 bitop3:0xea
    ds_add_u32 v56, v2
    v_mul_hi_u32_u24 v14, 429497, v81
    v_lshrrev_b32 v12, 3, v57
    v_cos_f32 v8, v8
    v_lshlrev_b16 v13, 3, v57
    v_mad_i32_i24 v11, v14, s55, v81
    v_bitop3_b32 v12, v6, v13, v12 bitop3:0xca
    v_lshl_add_u32 v11, v11, 17, s40
    v_lshlrev_b16 v14, 8, v14
    v_lshrrev_b32 v13, 2, v57
    v_add_u32 v81, v12, v11
    v_bitop3_b32 v57, v5, v13, v14 bitop3:0xea
    ds_add_u32 v57, v2
    v_cvt_pk_bf16_f32 v64, v7, v8
    v_perm_b32 v12, v64, v64, s41
    v_bitop3_b32 v80, v4, v12, v80 bitop3:0xca
    v_perm_b32 v13, v64, v64, s42
    v_bitop3_b32 v81, v4, v13, v81 bitop3:0xca
    v_mul_hi_u32_u24 v14, 429497, v82
    v_lshrrev_b32 v12, 3, v58
    v_cos_f32 v9, v9
    v_lshlrev_b16 v13, 3, v58
    v_mad_i32_i24 v11, v14, s55, v82
    v_bitop3_b32 v12, v6, v13, v12 bitop3:0xca
    v_lshl_add_u32 v11, v11, 17, s40
    v_lshlrev_b16 v14, 8, v14
    v_lshrrev_b32 v13, 2, v58
    v_add_u32 v82, v12, v11
    v_bitop3_b32 v58, v5, v13, v14 bitop3:0xea
    ds_add_u32 v58, v2
    v_mul_hi_u32_u24 v14, 429497, v83
    v_lshrrev_b32 v12, 3, v59
    v_cos_f32 v10, v10
    v_lshlrev_b16 v13, 3, v59
    v_mad_i32_i24 v11, v14, s55, v83
    v_bitop3_b32 v12, v6, v13, v12 bitop3:0xca
    v_lshl_add_u32 v11, v11, 17, s40
    v_lshlrev_b16 v14, 8, v14
    v_lshrrev_b32 v13, 2, v59
    v_add_u32 v83, v12, v11
    v_bitop3_b32 v59, v5, v13, v14 bitop3:0xea
    ds_add_u32 v59, v2
    v_cvt_pk_bf16_f32 v65, v9, v10
    v_perm_b32 v12, v65, v65, s41
    v_bitop3_b32 v82, v4, v12, v82 bitop3:0xca
    v_perm_b32 v13, v65, v65, s42
    v_bitop3_b32 v83, v4, v13, v83 bitop3:0xca
L1_s7:
    s_waitcnt vmcnt(2)
    s_cmp_le_u32 s43, 7
    s_cbranch_scc1 L1_s8
    v_lshlrev_b32 v7, 16, v66
    v_and_b32 v8, 0xffff0000, v66
    v_lshlrev_b32 v9, 16, v67
    v_and_b32 v10, 0xffff0000, v67
    v_mul_f32 v7, 0.15915494, v7
    v_mul_f32 v8, 0.15915494, v8
    v_mul_f32 v9, 0.15915494, v9
    v_mul_f32 v10, 0.15915494, v10
    v_mul_hi_u32_u24 v14, 429497, v96
    v_lshrrev_b32 v12, 3, v60
    v_cos_f32 v7, v7
    v_lshlrev_b16 v13, 3, v60
    v_mad_i32_i24 v11, v14, s55, v96
    v_bitop3_b32 v12, v6, v13, v12 bitop3:0xca
    v_lshl_add_u32 v11, v11, 17, s40
    v_lshlrev_b16 v14, 8, v14
    v_lshrrev_b32 v13, 2, v60
    v_add_u32 v96, v12, v11
    v_bitop3_b32 v60, v5, v13, v14 bitop3:0xea
    ds_add_u32 v60, v2
    v_mul_hi_u32_u24 v14, 429497, v97
    v_lshrrev_b32 v12, 3, v61
    v_cos_f32 v8, v8
    v_lshlrev_b16 v13, 3, v61
    v_mad_i32_i24 v11, v14, s55, v97
    v_bitop3_b32 v12, v6, v13, v12 bitop3:0xca
    v_lshl_add_u32 v11, v11, 17, s40
    v_lshlrev_b16 v14, 8, v14
    v_lshrrev_b32 v13, 2, v61
    v_add_u32 v97, v12, v11
    v_bitop3_b32 v61, v5, v13, v14 bitop3:0xea
    ds_add_u32 v61, v2
    v_cvt_pk_bf16_f32 v66, v7, v8
    v_perm_b32 v12, v66, v66, s41
    v_bitop3_b32 v96, v4, v12, v96 bitop3:0xca
    v_perm_b32 v13, v66, v66, s42
    v_bitop3_b32 v97, v4, v13, v97 bitop3:0xca
    v_mul_hi_u32_u24 v14, 429497, v98
    v_lshrrev_b32 v12, 3, v62
    v_cos_f32 v9, v9
    v_lshlrev_b16 v13, 3, v62
    v_mad_i32_i24 v11, v14, s55, v98
    v_bitop3_b32 v12, v6, v13, v12 bitop3:0xca
    v_lshl_add_u32 v11, v11, 17, s40
    v_lshlrev_b16 v14, 8, v14
    v_lshrrev_b32 v13, 2, v62
    v_add_u32 v98, v12, v11
    v_bitop3_b32 v62, v5, v13, v14 bitop3:0xea
    ds_add_u32 v62, v2
    v_mul_hi_u32_u24 v14, 429497, v99
    v_lshrrev_b32 v12, 3, v63
    v_cos_f32 v10, v10
    v_lshlrev_b16 v13, 3, v63
    v_mad_i32_i24 v11, v14, s55, v99
    v_bitop3_b32 v12, v6, v13, v12 bitop3:0xca
    v_lshl_add_u32 v11, v11, 17, s40
    v_lshlrev_b16 v14, 8, v14
    v_lshrrev_b32 v13, 2, v63
    v_add_u32 v99, v12, v11
    v_bitop3_b32 v63, v5, v13, v14 bitop3:0xea
    ds_add_u32 v63, v2
    v_cvt_pk_bf16_f32 v67, v9, v10
    v_perm_b32 v12, v67, v67, s41
    v_bitop3_b32 v98, v4, v12, v98 bitop3:0xca
    v_perm_b32 v13, v67, v67, s42
    v_bitop3_b32 v99, v4, v13, v99 bitop3:0xca
L1_s8:
    v_lshrrev_b32 v8, 2, v0
    v_and_b32 v7, 0x3c00, v0
    v_bitop3_b32 v7, v5, v8, v7 bitop3:0xea
    s_waitcnt lgkmcnt(0)
    s_barrier
    ds_read2st64_b32 v[8:9], v7 offset0:0 offset1:1
    ds_read2st64_b32 v[10:11], v7 offset0:2 offset1:3
    s_waitcnt lgkmcnt(0)
    v_lshl_or_b32 v12, v9, 16, v8
    v_lshl_or_b32 v13, v11, 16, v10
    v_mov_b32 v14, v12
    v_mov_b32 v15, v13
    s_nop 0
    v_add_u32_dpp v14, v14, v14 row_shr:1 row_mask:0xf bank_mask:0xf bound_ctrl:1
    v_add_u32_dpp v15, v15, v15 row_shr:1 row_mask:0xf bank_mask:0xf bound_ctrl:1
    s_nop 0
    v_add_u32_dpp v14, v14, v14 row_shr:2 row_mask:0xf bank_mask:0xf bound_ctrl:1
    v_add_u32_dpp v15, v15, v15 row_shr:2 row_mask:0xf bank_mask:0xf bound_ctrl:1
    s_nop 0
    v_add_u32_dpp v14, v14, v14 row_shr:4 row_mask:0xf bank_mask:0xf bound_ctrl:1
    v_add_u32_dpp v15, v15, v15 row_shr:4 row_mask:0xf bank_mask:0xf bound_ctrl:1
    s_nop 0
    v_add_u32_dpp v14, v14, v14 row_shr:8 row_mask:0xf bank_mask:0xf bound_ctrl:1
    v_add_u32_dpp v15, v15, v15 row_shr:8 row_mask:0xf bank_mask:0xf bound_ctrl:1
    s_nop 0
    v_add_u32_dpp v14, v14, v14 row_bcast:15 row_mask:0xa bank_mask:0xf
    v_add_u32_dpp v15, v15, v15 row_bcast:15 row_mask:0xa bank_mask:0xf
    s_nop 0
    v_add_u32_dpp v14, v14, v14 row_bcast:31 row_mask:0xc bank_mask:0xf
    v_add_u32_dpp v15, v15, v15 row_bcast:31 row_mask:0xc bank_mask:0xf
    v_readlane_b32 s48, v14, 63
    v_readlane_b32 s49, v15, 63
    s_lshl_b32 s54, s32, 2
    v_mov_b32 v8, s54
    s_and_b32 s50, s48, 0xffff
    s_lshr_b32 s51, s48, 16
    s_and_b32 s52, s49, 0xffff
    s_lshr_b32 s53, s49, 16
    s_add_u32 s51, s51, s50
    s_add_u32 s52, s52, s51
    s_add_u32 s53, s53, s52
    v_mov_b32 v9, s53
    v_and_b32_dpp v3, v3, v3 quad_perm:[1,0,3,2] row_mask:0xf bank_mask:0xf
    s_mov_b64 exec, 1
    ds_write_b32 v8, v9 offset:16384
    ds_write_b32 v8, v3 offset:16448
    s_mov_b64 exec, -1
    v_and_b32 v8, 60, v7
    s_waitcnt lgkmcnt(0)
    s_barrier
    ds_read_b32 v9, v8 offset:16384
    ds_read_b32 v10, v8 offset:16448
    s_waitcnt lgkmcnt(0)
    v_readlane_b32 s56, v10, 15
    s_xor_b32 s56, s56, 0x80
    v_add_u32_dpp v9, v9, v9 row_shr:1 row_mask:0xf bank_mask:0xf bound_ctrl:1
    s_nop 1
    v_add_u32_dpp v9, v9, v9 row_shr:2 row_mask:0xf bank_mask:0xf bound_ctrl:1
    s_nop 1
    v_add_u32_dpp v9, v9, v9 row_shr:4 row_mask:0xf bank_mask:0xf bound_ctrl:1
    s_nop 1
    v_add_u32_dpp v9, v9, v9 row_shr:8 row_mask:0xf bank_mask:0xf bound_ctrl:1
    s_nop 0
    v_readlane_b32 s54, v9, s32
    s_sub_u32 s54, s54, s53
    s_add_u32 s50, s50, s54
    s_add_u32 s51, s51, s54
    s_add_u32 s52, s52, s54
    s_pack_ll_b32_b16 s48, s54, s50
    s_pack_ll_b32_b16 s49, s51, s52
    v_add_u32 v14, s48, v14
    v_add_u32 v15, s49, v15
    v_sub_u32 v12, v14, v12
    v_sub_u32 v13, v15, v13
    v_and_b32 v8, 0xffff, v12
    v_lshrrev_b32 v9, 16, v12
    v_and_b32 v10, 0xffff, v13
    v_lshrrev_b32 v11, 16, v13
    ds_write2st64_b32 v7, v8, v9 offset0:0 offset1:1
    ds_write2st64_b32 v7, v10, v11 offset0:2 offset1:3
    v_and_b32 v8, 0x3f0, v0
    v_lshl_add_u32 v8, v8, 1, s36
    ds_write_b64 v8, v[12:13] offset:20480
    s_bitset0_b64 exec, 63
    s_not_b64 exec, exec
    ds_write_b64 v8, v[14:15] offset:20512
    s_mov_b64 exec, -1
    s_waitcnt lgkmcnt(0)
    s_barrier
    s_setprio 3
    ds_add_rtn_u32 v120, v120, v2
    ds_add_rtn_u32 v121, v121, v2
    ds_add_rtn_u32 v122, v122, v2
    ds_add_rtn_u32 v123, v123, v2
    ds_read_b128 v[12:15], v0 offset:20480
    v_cmp_gt_u32 vcc, 8448, v0
    s_add_u32 s46, s35, 0x7ec4000
    s_add_u32 s46, s46, s93
    buffer_store_dwordx4 v[28:31], v0, s[20:23], s46 offen sc1
    ds_add_rtn_u32 v124, v124, v2
    ds_add_rtn_u32 v125, v125, v2
    ds_add_rtn_u32 v126, v126, v2
    ds_add_rtn_u32 v127, v127, v2
    s_setprio 2
    ds_add_rtn_u32 v24, v24, v2
    ds_add_rtn_u32 v25, v25, v2
    ds_add_rtn_u32 v26, v26, v2
    ds_add_rtn_u32 v27, v27, v2
    s_waitcnt lgkmcnt(8)
    s_cbranch_vccz L1_p9
    s_add_u32 s47, s35, 0xa900000
    s_mov_b64 exec, vcc
    buffer_store_dwordx4 v[12:15], v0, s[24:27], s47 offen sc1
    s_mov_b64 exec, -1
L1_p9:
    s_add_u32 s44, s35, 0x7ec8000
    s_add_u32 s44, s44, s72
    buffer_store_dwordx4 v[112:115], v0, s[20:23], s44 offen sc1
    ds_add_rtn_u32 v52, v52, v2
    ds_add_rtn_u32 v53, v53, v2
    ds_add_rtn_u32 v54, v54, v2
    ds_add_rtn_u32 v55, v55, v2
    s_load_dwordx2 s[28:29], s[0:1], 0
    s_load_dwordx2 s[50:51], s[0:1], 40
    s_load_dwordx2 s[52:53], s[0:1], 24
    s_setprio 1
    ds_add_rtn_u32 v68, v68, v2
    ds_add_rtn_u32 v69, v69, v2
    ds_add_rtn_u32 v70, v70, v2
    ds_add_rtn_u32 v71, v71, v2
    s_cmp_le_u32 s43, 5
    s_cbranch_scc1 L1_s10
    ds_add_rtn_u32 v76, v76, v2
    ds_add_rtn_u32 v77, v77, v2
    ds_add_rtn_u32 v78, v78, v2
    ds_add_rtn_u32 v79, v79, v2
L1_s10:
    s_add_u32 s45, s35, 0x7ec8000
    s_add_u32 s45, s45, s73
    buffer_store_dwordx4 v[88:91], v0, s[20:23], s45 offen sc1
    s_setprio 0
    s_cmp_le_u32 s43, 6
    s_cbranch_scc1 L1_s11
    ds_add_rtn_u32 v56, v56, v2
    ds_add_rtn_u32 v57, v57, v2
    ds_add_rtn_u32 v58, v58, v2
    ds_add_rtn_u32 v59, v59, v2
L1_s11:
    s_cmp_le_u32 s43, 7
    s_cbranch_scc1 L1_s12
    ds_add_rtn_u32 v60, v60, v2
    ds_add_rtn_u32 v61, v61, v2
    ds_add_rtn_u32 v62, v62, v2
    ds_add_rtn_u32 v63, v63, v2
L1_s12:
    s_waitcnt lgkmcnt(0)
    s_barrier
    s_load_dwordx4 s[96:99], s[50:51], 0
    s_mov_b64 s[4:5], s[52:53]
    s_bfe_u32 s33, s2, 0x20001
    s_and_b32 s34, s2, 1
    s_lshl_b32 s34, s34, 5
    s_lshr_b32 s3, s2, 3
    s_add_u32 s34, s34, s3
    s_mul_i32 s39, s33, 2080
    s_lshl_b32 s3, s34, 5
    s_add_u32 s39, s39, s3
    s_mul_i32 s40, s33, 1310720
    s_add_u32 s40, s40, 0x50000
    s_lshl_b32 s38, s32, 11
    s_mul_i32 s100, s32, 3072
    s_add_u32 s8, s30, 0x4000
    s_addc_u32 s9, s31, 0
    s_mov_b32 s10, 0xd340000
    s_mov_b32 s11, 0x20000
    s_add_u32 s12, s30, 0x2c000
    s_addc_u32 s13, s31, 0
    s_mov_b32 s14, 0xd318000
    s_mov_b32 s15, 0x20000
    s_mov_b32 s16, s64
    s_mov_b32 s17, s65
    s_mov_b32 s18, 0x20
    s_mov_b32 s19, 0x20000
    s_mov_b32 s24, s28
    s_mov_b32 s25, s29
    s_mov_b32 s26, 0x4e2000
    s_mov_b32 s27, 0x20000
    s_setprio 3
    v_and_b32 v7, -4, v120
    v_lshl_add_u32 v8, v120, 2, v7
    ds_write_b32 v8, v16
    v_lshl_add_u32 v7, v7, 2, v120
    ds_write_b8 v7, v44 offset:16
    v_and_b32 v9, -4, v121
    v_lshl_add_u32 v10, v121, 2, v9
    ds_write_b32 v10, v17
    v_lshl_add_u32 v9, v9, 2, v121
    ds_write_b8_d16_hi v9, v44 offset:16
    v_and_b32 v7, -4, v122
    v_lshl_add_u32 v8, v122, 2, v7
    ds_write_b32 v8, v18
    v_lshl_add_u32 v7, v7, 2, v122
    ds_write_b8 v7, v45 offset:16
    v_and_b32 v9, -4, v123
    v_lshl_add_u32 v10, v123, 2, v9
    ds_write_b32 v10, v19
    v_lshl_add_u32 v9, v9, 2, v123
    ds_write_b8_d16_hi v9, v45 offset:16
    s_add_u32 s46, s35, 0x7ec8000
    s_add_u32 s46, s46, s85
    buffer_store_dwordx4 v[116:119], v0, s[20:23], s46 offen sc1
    v_and_b32 v13, 0x3f0, v0
    v_and_b32 v14, 0x300, v13
    v_bfe_u32 v15, v13, 4, 4
    s_lshl_b32 s3, s32, 4
    v_add3_u32 v14, v14, v15, s3
    v_mul_u32_u24 v2, 173056, v14
    v_lshrrev_b32 v14, 6, v13
    s_add_u32 s3, s3, 0x400
    v_add_u32 v14, s3, v14
    v_mul_u32_u24 v4, 173056, v14
    v_and_b32 v14, 3, v14
    v_and_b32 v15, 0x30, v13
    v_lshl_add_u32 v14, v14, 5, v15
    v_add_u32 v6, v14, v4
    v_lshl_add_u32 v5, v15, 1, v2
    v_lshrrev_b32 v14, 3, v15
    buffer_load_ushort v100, v14, s[16:19], 0 offen offset:0
    buffer_load_ushort v101, v14, s[16:19], 0 offen offset:8
    buffer_load_ushort v102, v14, s[16:19], 0 offen offset:16
    buffer_load_ushort v103, v14, s[16:19], 0 offen offset:24
    s_mul_i32 s3, s32, 5120
    v_add_u32 v3, s3, v13
    v_lshrrev_b32 v14, 2, v13
    v_add_u32 v14, s38, v14
    v_and_b32 v7, -4, v124
    v_lshl_add_u32 v8, v124, 2, v7
    ds_write_b32 v8, v20
    v_lshl_add_u32 v7, v7, 2, v124
    ds_write_b8 v7, v46 offset:16
    v_and_b32 v9, -4, v125
    v_lshl_add_u32 v10, v125, 2, v9
    ds_write_b32 v10, v21
    v_lshl_add_u32 v9, v9, 2, v125
    ds_write_b8_d16_hi v9, v46 offset:16
    v_and_b32 v7, -4, v126
    v_lshl_add_u32 v8, v126, 2, v7
    ds_write_b32 v8, v22
    v_lshl_add_u32 v7, v7, 2, v126
    ds_write_b8 v7, v47 offset:16
    v_and_b32 v9, -4, v127
    v_lshl_add_u32 v10, v127, 2, v9
    ds_write_b32 v10, v23
    v_lshl_add_u32 v9, v9, 2, v127
    ds_write_b8_d16_hi v9, v47 offset:16
    s_setprio 2
    v_and_b32 v7, -4, v24
    v_lshl_add_u32 v8, v24, 2, v7
    ds_write_b32 v8, v40
    v_lshl_add_u32 v7, v7, 2, v24
    ds_write_b8 v7, v32 offset:16
    v_and_b32 v9, -4, v25
    v_lshl_add_u32 v10, v25, 2, v9
    ds_write_b32 v10, v41
    v_lshl_add_u32 v9, v9, 2, v25
    ds_write_b8_d16_hi v9, v32 offset:16
    v_and_b32 v7, -4, v26
    v_lshl_add_u32 v8, v26, 2, v7
    ds_write_b32 v8, v42
    v_lshl_add_u32 v7, v7, 2, v26
    ds_write_b8 v7, v33 offset:16
    v_and_b32 v9, -4, v27
    v_lshl_add_u32 v10, v27, 2, v9
    ds_write_b32 v10, v43
    v_lshl_add_u32 v9, v9, 2, v27
    ds_write_b8_d16_hi v9, v33 offset:16
    s_add_u32 s47, s35, 0x7ec8000
    s_add_u32 s47, s47, s91
    buffer_store_dwordx4 v[92:95], v0, s[20:23], s47 offen sc1
    v_lshrrev_b32 v11, 2, v0
    v_and_b32 v11, 0xfc, v11
    s_cmp_ge_u32 s84, 128
    s_cselect_b32 s82, 0, s82
    s_mul_i32 s3, s84, 40
    s_add_u32 s3, s3, s32
    s_mul_i32 s76, s3, 52429
    s_lshr_b32 s76, s76, 22
    s_mul_i32 s74, s76, 80
    s_sub_u32 s3, s3, s74
    s_mul_i32 s74, s3, 205
    s_lshr_b32 s74, s74, 10
    s_mul_i32 s75, s74, 5
    s_sub_u32 s75, s3, s75
    s_lshl_b32 s48, s74, 1
    s_add_u32 s48, s48, s75
    s_add_u32 s49, s48, s74
    s_add_u32 s49, s49, 30
    s_cmp_lt_u32 s75, 2
    s_cselect_b32 s48, s48, s49
    s_lshl_b32 s48, s48, 10
    s_mul_i32 s49, s76, 80000
    s_add_u32 s48, s48, s49
    buffer_load_dword v104, v11, s[80:83], s48 offen offset:0
    buffer_load_dword v105, v11, s[80:83], s48 offen offset:256
    buffer_load_dword v106, v11, s[80:83], s48 offen offset:512
    buffer_load_dword v107, v11, s[80:83], s48 offen offset:768
    s_mul_i32 s3, s84, 40
    s_add_u32 s3, s3, s32
    s_add_u32 s3, s3, 16
    s_mul_i32 s76, s3, 52429
    s_lshr_b32 s76, s76, 22
    s_mul_i32 s74, s76, 80
    s_sub_u32 s3, s3, s74
    s_mul_i32 s74, s3, 205
    s_lshr_b32 s74, s74, 10
    s_mul_i32 s75, s74, 5
    s_sub_u32 s75, s3, s75
    s_lshl_b32 s48, s74, 1
    s_add_u32 s48, s48, s75
    s_add_u32 s49, s48, s74
    s_add_u32 s49, s49, 30
    s_cmp_lt_u32 s75, 2
    s_cselect_b32 s48, s48, s49
    s_lshl_b32 s48, s48, 10
    s_mul_i32 s49, s76, 80000
    s_add_u32 s48, s48, s49
    buffer_load_dword v28, v11, s[80:83], s48 offen offset:0
    buffer_load_dword v29, v11, s[80:83], s48 offen offset:256
    buffer_load_dword v30, v11, s[80:83], s48 offen offset:512
    buffer_load_dword v31, v11, s[80:83], s48 offen offset:768
    s_mul_i32 s3, s84, 40
    s_add_u32 s3, s3, s32
    s_add_u32 s3, s3, 32
    s_mul_i32 s76, s3, 52429
    s_lshr_b32 s76, s76, 22
    s_mul_i32 s74, s76, 80
    s_sub_u32 s3, s3, s74
    s_cmp_ge_u32 s32, 8
    s_cselect_b32 s82, 0, s82
    s_mul_i32 s74, s3, 205
    s_lshr_b32 s74, s74, 10
    s_mul_i32 s75, s74, 5
    s_sub_u32 s75, s3, s75
    s_lshl_b32 s48, s74, 1
    s_add_u32 s48, s48, s75
    s_add_u32 s49, s48, s74
    s_add_u32 s49, s49, 30
    s_cmp_lt_u32 s75, 2
    s_cselect_b32 s48, s48, s49
    s_lshl_b32 s48, s48, 10
    s_mul_i32 s49, s76, 80000
    s_add_u32 s48, s48, s49
    buffer_load_dword v112, v11, s[80:83], s48 offen offset:0
    buffer_load_dword v113, v11, s[80:83], s48 offen offset:256
    buffer_load_dword v114, v11, s[80:83], s48 offen offset:512
    buffer_load_dword v115, v11, s[80:83], s48 offen offset:768
    v_and_b32 v7, -4, v52
    v_lshl_add_u32 v8, v52, 2, v7
    ds_write_b32 v8, v48
    v_lshl_add_u32 v7, v7, 2, v52
    ds_write_b8 v7, v34 offset:16
    v_and_b32 v9, -4, v53
    v_lshl_add_u32 v10, v53, 2, v9
    ds_write_b32 v10, v49
    v_lshl_add_u32 v9, v9, 2, v53
    ds_write_b8_d16_hi v9, v34 offset:16
    v_and_b32 v7, -4, v54
    v_lshl_add_u32 v8, v54, 2, v7
    ds_write_b32 v8, v50
    v_lshl_add_u32 v7, v7, 2, v54
    ds_write_b8 v7, v35 offset:16
    v_and_b32 v9, -4, v55
    v_lshl_add_u32 v10, v55, 2, v9
    ds_write_b32 v10, v51
    v_lshl_add_u32 v9, v9, 2, v55
    ds_write_b8_d16_hi v9, v35 offset:16
    s_setprio 1
    v_and_b32 v7, -4, v68
    v_lshl_add_u32 v8, v68, 2, v7
    ds_write_b32 v8, v84
    v_lshl_add_u32 v7, v7, 2, v68
    ds_write_b8 v7, v72 offset:16
    v_and_b32 v9, -4, v69
    v_lshl_add_u32 v10, v69, 2, v9
    ds_write_b32 v10, v85
    v_lshl_add_u32 v9, v9, 2, v69
    ds_write_b8_d16_hi v9, v72 offset:16
    v_and_b32 v7, -4, v70
    v_lshl_add_u32 v8, v70, 2, v7
    ds_write_b32 v8, v86
    v_lshl_add_u32 v7, v7, 2, v70
    ds_write_b8 v7, v73 offset:16
    v_and_b32 v9, -4, v71
    v_lshl_add_u32 v10, v71, 2, v9
    ds_write_b32 v10, v87
    v_lshl_add_u32 v9, v9, 2, v71
    ds_write_b8_d16_hi v9, v73 offset:16
    s_cmp_le_u32 s43, 5
    s_cbranch_scc1 L1_s13
    v_and_b32 v7, -4, v76
    v_lshl_add_u32 v8, v76, 2, v7
    ds_write_b32 v8, v36
    v_lshl_add_u32 v7, v7, 2, v76
    ds_write_b8 v7, v74 offset:16
    v_and_b32 v9, -4, v77
    v_lshl_add_u32 v10, v77, 2, v9
    ds_write_b32 v10, v37
    v_lshl_add_u32 v9, v9, 2, v77
    ds_write_b8_d16_hi v9, v74 offset:16
    v_and_b32 v7, -4, v78
    v_lshl_add_u32 v8, v78, 2, v7
    ds_write_b32 v8, v38
    v_lshl_add_u32 v7, v7, 2, v78
    ds_write_b8 v7, v75 offset:16
    v_and_b32 v9, -4, v79
    v_lshl_add_u32 v10, v79, 2, v9
    ds_write_b32 v10, v39
    v_lshl_add_u32 v9, v9, 2, v79
    ds_write_b8_d16_hi v9, v75 offset:16
L1_s13:
    s_add_u32 s44, s35, 0x7ec8000
    s_add_u32 s44, s44, s93
    buffer_store_dwordx4 v[108:111], v0, s[20:23], s44 offen sc1
    s_setprio 0
    s_cmp_le_u32 s43, 6
    s_cbranch_scc1 L1_s14
    v_and_b32 v7, -4, v56
    v_lshl_add_u32 v8, v56, 2, v7
    ds_write_b32 v8, v80
    v_lshl_add_u32 v7, v7, 2, v56
    ds_write_b8 v7, v64 offset:16
    v_and_b32 v9, -4, v57
    v_lshl_add_u32 v10, v57, 2, v9
    ds_write_b32 v10, v81
    v_lshl_add_u32 v9, v9, 2, v57
    ds_write_b8_d16_hi v9, v64 offset:16
    v_and_b32 v7, -4, v58
    v_lshl_add_u32 v8, v58, 2, v7
    ds_write_b32 v8, v82
    v_lshl_add_u32 v7, v7, 2, v58
    ds_write_b8 v7, v65 offset:16
    v_and_b32 v9, -4, v59
    v_lshl_add_u32 v10, v59, 2, v9
    ds_write_b32 v10, v83
    v_lshl_add_u32 v9, v9, 2, v59
    ds_write_b8_d16_hi v9, v65 offset:16
L1_s14:
    s_cmp_le_u32 s43, 7
    s_cbranch_scc1 L1_s15
    v_and_b32 v7, -4, v60
    v_lshl_add_u32 v8, v60, 2, v7
    ds_write_b32 v8, v96
    v_lshl_add_u32 v7, v7, 2, v60
    ds_write_b8 v7, v66 offset:16
    v_and_b32 v9, -4, v61
    v_lshl_add_u32 v10, v61, 2, v9
    ds_write_b32 v10, v97
    v_lshl_add_u32 v9, v9, 2, v61
    ds_write_b8_d16_hi v9, v66 offset:16
    v_and_b32 v7, -4, v62
    v_lshl_add_u32 v8, v62, 2, v7
    ds_write_b32 v8, v98
    v_lshl_add_u32 v7, v7, 2, v62
    ds_write_b8 v7, v67 offset:16
    v_and_b32 v9, -4, v63
    v_lshl_add_u32 v10, v63, 2, v9
    ds_write_b32 v10, v99
    v_lshl_add_u32 v9, v9, 2, v63
    ds_write_b8_d16_hi v9, v67 offset:16
L1_s15:
    s_add_u32 s80, s30, 0xd344000
    s_addc_u32 s81, s31, 0
    s_mov_b32 s82, 0xa000
    s_mov_b32 s83, 0x20000
    s_min_u32 s3, s84, 127
    s_mul_i32 s3, s3, 40960
    s_add_u32 s80, s80, s3
    s_addc_u32 s81, s81, 0
    s_cmp_ge_u32 s84, 128
    s_cselect_b32 s82, 0, s82
    s_waitcnt vmcnt(1)
    v_add_u32 v11, 0, v0
    buffer_store_dwordx4 v[104:107], v11, s[80:83], 0 offen sc1
    v_add_u32 v11, 16384, v0
    buffer_store_dwordx4 v[28:31], v11, s[80:83], 0 offen sc1
    v_add_u32 v11, 32768, v0
    buffer_store_dwordx4 v[112:115], v11, s[80:83], 0 offen sc1
    v_add_u32 v7, 0x10000, v0
    v_add_u32 v12, 0x20000, v0
    s_waitcnt lgkmcnt(0)
    s_barrier
    ds_read_b128 v[24:27], v0 offset:0
    ds_read_b128 v[28:31], v0 offset:16384
    ds_read_b128 v[32:35], v0 offset:32768
    ds_read_b128 v[36:39], v0 offset:49152
    ds_read_b128 v[76:79], v7 offset:0
    ds_read_b128 v[80:83], v7 offset:16384
    ds_read_b128 v[84:87], v7 offset:32768
    ds_read_b128 v[104:107], v7 offset:49152
    ds_read_b128 v[68:71], v12 offset:0
    ds_read_b128 v[72:75], v12 offset:16384
    s_cmp_lg_u32 s32, 0
    s_cbranch_scc1 L2_sg1
    s_mov_b32 exec_hi, 0
    v_mov_b32 v11, 1
    buffer_store_dword v11, v14, s[60:63], s57 offen sc1
    s_mov_b64 exec, -1
L2_sg1:
    s_waitcnt lgkmcnt(9)
    s_add_u32 s45, s35, 0xa904000
    buffer_store_dwordx4 v[24:27], v0, s[20:23], s45 offen sc1
    s_waitcnt lgkmcnt(8)
    s_add_u32 s46, s35, 0xa908000
    buffer_store_dwordx4 v[28:31], v0, s[20:23], s46 offen sc1
    s_waitcnt lgkmcnt(7)
    s_add_u32 s47, s35, 0xa90c000
    buffer_store_dwordx4 v[32:35], v0, s[20:23], s47 offen sc1
    s_waitcnt lgkmcnt(6)
    s_add_u32 s44, s35, 0xa910000
    buffer_store_dwordx4 v[36:39], v0, s[20:23], s44 offen sc1
    s_waitcnt lgkmcnt(5)
    s_add_u32 s45, s35, 0xa914000
    buffer_store_dwordx4 v[76:79], v0, s[20:23], s45 offen sc1
    s_waitcnt lgkmcnt(4)
    s_add_u32 s46, s35, 0xa918000
    buffer_store_dwordx4 v[80:83], v0, s[20:23], s46 offen sc1
    s_waitcnt lgkmcnt(3)
    s_add_u32 s47, s35, 0xa91c000
    buffer_store_dwordx4 v[84:87], v0, s[20:23], s47 offen sc1
    s_waitcnt lgkmcnt(2)
    s_cmp_le_u32 s43, 5
    s_cbranch_scc1 L1_q16
    s_add_u32 s44, s35, 0xa920000
    buffer_store_dwordx4 v[104:107], v0, s[20:23], s44 offen sc1
L1_q16:
    s_waitcnt lgkmcnt(1)
    s_cmp_le_u32 s43, 6
    s_cbranch_scc1 L1_q17
    s_add_u32 s45, s35, 0xa924000
    buffer_store_dwordx4 v[68:71], v0, s[20:23], s45 offen sc1
L1_q17:
    s_waitcnt lgkmcnt(0)
    s_cmp_le_u32 s43, 7
    s_cbranch_scc1 L1_q18
    s_add_u32 s46, s35, 0xa928000
    buffer_store_dwordx4 v[72:75], v0, s[20:23], s46 offen sc1
L1_q18:
    s_waitcnt lgkmcnt(0)
    s_setprio 3
    v_mov_b32 v92, v0
    v_mov_b32 v93, v6
    v_mov_b32 v94, v13
    v_mov_b32 v95, v5
    v_mov_b32 v0, v14
    v_lshl_add_u32 v7, v13, 3, s38
    v_lshrrev_b32 v16, 2, v15
    v_mad_u32_u24 v4, v16, 5, v4
    v_or_b32 v4, 0xf0000000, v4
    v_or_b32 v2, 0xf0000000, v2
    v_sub_u32 v1, 28, v16
    v_lshrrev_b32 v17, 2, v16
    v_and_b32 v18, 3, v17
    v_lshlrev_b32 v18, 4, v18
    v_mov_b32 v10, 0x3f80
    v_mov_b32 v11, 0
    v_lshlrev_b64 v[10:11], v18, v[10:11]
    v_and_b32 v18, 3, v17
    v_lshlrev_b32 v18, 4, v18
    v_mov_b32 v12, 0xbf80
    v_mov_b32 v13, 0
    v_lshlrev_b64 v[12:13], v18, v[12:13]
    v_mov_b32 v45, 0xf0000000
    v_add_u32 v44, s38, v0
    v_lshrrev_b32 v44, 1, v44
    v_and_b32 v44, -4, v44
    v_mov_b32 v5, 0x1fff8
    v_mov_b32 v6, 0x07ff0000
    v_mov_b32 v16, 0
    v_mov_b32 v17, 0
    v_mov_b32 v18, 0
    v_mov_b32 v19, 0
    v_add_u32 v20, 81920, v92
    v_add_u32 v21, 0x10000, v20
    s_setprio 1
    s_setprio 2
    s_mov_b32 s44, 0x4000c0c
    s_mov_b32 s45, 0x4010c0c
    s_mov_b32 s46, 0x4020c0c
    s_mov_b32 s47, 0x4030c0c
    s_mov_b32 s36, 0
    s_mov_b32 s43, 0
    s_mov_b32 s42, 0
    s_mov_b64 s[80:81], 0
    s_mov_b64 s[48:49], 0
    s_add_u32 s16, s30, 0xd344000
    s_addc_u32 s17, s31, 0
    s_mov_b32 s18, 0x500000
    s_mov_b32 s19, 0x20000
    v_mov_b32 v68, 0
    v_mov_b32 v69, 0
    v_mov_b32 v70, 0
    v_mov_b32 v71, 0
    v_mov_b32 v72, 0
    v_mov_b32 v73, 0
    v_mov_b32 v74, 0
    v_mov_b32 v75, 0
    s_waitcnt vmcnt(0)
    v_lshl_or_b32 v8, v101, 16, v100
    v_lshl_or_b32 v9, v103, 16, v102
    s_barrier
    s_cmp_lg_u32 s32, 0
    s_cbranch_scc1 L2_sg2
    s_mov_b32 exec_hi, 0
    v_mov_b32 v88, 2
    buffer_store_dword v88, v0, s[60:63], s57 offen sc1
    s_mov_b64 exec, -1
L2_sg2:
    s_mov_b64 s[84:85], 0
    s_mul_i32 s3, s33, 1280000
    s_add_u32 s3, s3, s100
    s_add_u32 s3, s3, 32768
    buffer_load_dwordx4 v[124:127], v94, s[24:27], s3 offen offset:2048
    s_mul_i32 s3, s33, 1280000
    s_add_u32 s3, s3, s100
    s_add_u32 s3, s3, 32768
    buffer_load_dwordx4 v[116:119], v94, s[24:27], s3 offen offset:0
    s_mul_i32 s3, s33, 1280000
    s_add_u32 s3, s3, s100
    s_add_u32 s3, s3, 32768
    buffer_load_dwordx4 v[120:123], v94, s[24:27], s3 offen offset:1024
    s_mul_i32 s3, s33, 1280000
    s_add_u32 s3, s3, s38
    s_add_u32 s3, s3, 0
    buffer_load_dwordx4 v[108:111], v94, s[24:27], s3 offen offset:0
    s_mul_i32 s3, s33, 1280000
    s_add_u32 s3, s3, s38
    s_add_u32 s3, s3, 0
    buffer_load_dwordx4 v[112:115], v94, s[24:27], s3 offen offset:1024
    ds_write_b128 v20, v[16:19] offset:0
    ds_write_b128 v20, v[16:19] offset:16384
    ds_write_b128 v20, v[16:19] offset:32768
    ds_write_b128 v20, v[16:19] offset:49152
    ds_write_b128 v21, v[16:19]
    s_cmp_eq_u32 s56, 0
    s_cbranch_scc1 L2_e3
    v_lshlrev_b32 v16, 3, v94
    v_and_b32 v16, 0x80, v16
L2_e4:
    buffer_load_dword v88, v16, s[68:71], 0 offen sc1
    s_waitcnt vmcnt(0)
    v_cmp_gt_u32 vcc, 0x80, v88
    s_cbranch_vccnz L2_e4
L2_e3:
    s_mov_b64 exec, 0xffff
L2_p1:
    buffer_load_dword v88, v7, s[60:63], 0 offen sc1
    s_waitcnt vmcnt(0)
    v_cmpx_gt_u32 vcc, 1, v88
    s_cbranch_vccnz L2_p1
    s_mov_b64 exec, -1
    v_cmp_gt_u32 vcc, 2, v88
    s_and_b32 s56, vcc_lo, 0xffff
    buffer_load_dwordx4 v[48:51], v95, s[12:15], s39 offen offset:0
    buffer_load_dwordx4 v[56:59], v95, s[12:15], s39 offen offset:32
    buffer_load_dwordx4 v[52:55], v95, s[12:15], s39 offen offset:16
    buffer_load_dwordx4 v[60:63], v95, s[12:15], s39 offen offset:48
    buffer_load_dwordx4 v[64:67], v93, s[12:15], s39 offen
    s_waitcnt vmcnt(0)
    v_sub_u16 v88, v56, v48
    v_and_b32 v89, 3, v48
    v_add3_u32 v99, v88, v89, 3
    v_and_b32 v99, -4, v99
    v_max_u32 v99, 4, v99
    v_and_b32 v97, 0xfffc, v48
    v_bfm_b32 v96, v88, v89
    v_add_u32_dpp v91, v99, v99 row_shr:1 row_mask:0xf bank_mask:0xf bound_ctrl:1
    v_mad_u32_u24 v97, v97, 5, v2
    v_cmp_lt_u32 vcc, 16, v99
    v_add_u32_dpp v91, v91, v91 row_shr:2 row_mask:0xf bank_mask:0xf bound_ctrl:1
    v_sub_u32 v98, s38, v99
    v_lshrrev_b64 v[48:49], 16, v[48:49]
    v_add_u32_dpp v91, v91, v91 row_shr:4 row_mask:0xf bank_mask:0xf bound_ctrl:1
    v_lshrrev_b64 v[56:57], 16, v[56:57]
    s_mov_b32 s101, 0
    v_add_u32_dpp v91, v91, v91 row_shr:8 row_mask:0xf bank_mask:0xf bound_ctrl:1
    s_nop 1
    v_add_u32_dpp v91, v91, v91 row_bcast:15 row_mask:0xa bank_mask:0xf
    s_nop 1
    v_add_u32_dpp v91, v91, v91 row_bcast:31 row_mask:0xc bank_mask:0xf
    v_add_u32 v98, v98, v91
    v_readlane_b32 s37, v91, 63
    s_cbranch_vccnz L2_xo3
L2_xp3:
    s_cmp_gt_u32 s37, 1024
    s_cbranch_scc1 L2_xs4
    s_cmp_lg_u32 s101, 0
    s_cbranch_scc1 L2_xa4
L2_xb4:
    v_lshlrev_b32 v89, 16, v96
    v_add_u32 v90, 60, v97
    v_bitop3_b32 v90, v89, v45, v90 bitop3:0x6a
    ds_write_b32 v98, v90 offset:12
    v_lshlrev_b32 v89, 20, v96
    v_add_u32 v90, 40, v97
    v_bitop3_b32 v90, v89, v45, v90 bitop3:0x6a
    ds_write_b32 v98, v90 offset:8
    v_lshlrev_b32 v89, 24, v96
    v_add_u32 v90, 20, v97
    v_bitop3_b32 v90, v89, v45, v90 bitop3:0x6a
    ds_write_b32 v98, v90 offset:4
    v_lshlrev_b32 v89, 28, v96
    v_bitop3_b32 v90, v89, v45, v97 bitop3:0x6a
    ds_write_b32 v98, v90 offset:0
    v_mov_b32_dpp v91, v64 quad_perm:[0,0,0,0] row_mask:0xf bank_mask:0xf
    v_and_b32 v89, 3, v91
    v_and_b32 v97, 0xfffc, v91
    v_sub_u16_dpp v88, v64, v91 quad_perm:[2,2,2,2] row_mask:0xf bank_mask:0xf
    v_mad_u32_u24 v97, v97, 5, v4
    v_add_u32 v99, v88, v89
    v_bfm_b32 v96, v88, v89
    v_cmp_lt_u32 s[58:59], 16, v99
    v_lshlrev_b32 v89, v1, v96
    v_and_b32 v89, v45, v89
    v_cmp_ne_u32 vcc, 0, v89
    v_xor_b32 v90, v97, v89
    s_add_u32 s3, s37, s38
    v_mbcnt_lo_u32_b32 v98, vcc_lo, 0
    v_mbcnt_hi_u32_b32 v98, vcc_hi, v98
    s_bcnt1_i32_b64 s41, vcc
    v_lshl_add_u32 v98, v98, 2, s3
    s_lshl2_add_u32 s37, s41, s37
    s_mov_b64 exec, vcc
    ds_write_b32 v98, v90
    s_mov_b64 exec, -1
    s_cmp_lg_u64 s[58:59], 0
    s_cbranch_scc1 L2_xe4
L2_xr4:
    v_add_u32 v98, s37, v0
    v_mov_b32 v90, -1
    ds_write_b32 v98, v90
L2_xw4:
    ds_read_b32 v21, v0 offset:0
    ds_read_b32 v27, v0 offset:256
    ds_read_b32 v31, v44 offset:768
    ds_read_b32 v39, v0 offset:512
    s_sub_u32 s3, s37, 768
    s_cmp_gt_u32 s3, 128
    s_cbranch_scc1 L2_xf4
L2_xg4:
    v_sub_u16 v88, v58, v50
    v_and_b32 v89, 3, v50
    v_add3_u32 v99, v88, v89, 3
    v_and_b32 v99, -4, v99
    v_max_u32 v99, 4, v99
    v_and_b32 v97, 0xfffc, v50
    v_bfm_b32 v96, v88, v89
    v_add_u32_dpp v91, v99, v99 row_shr:1 row_mask:0xf bank_mask:0xf bound_ctrl:1
    v_mad_u32_u24 v97, v97, 5, v2
    v_cmp_lt_u32 vcc, 16, v99
    v_add_u32_dpp v91, v91, v91 row_shr:2 row_mask:0xf bank_mask:0xf bound_ctrl:1
    v_sub_u32 v98, s38, v99
    v_lshrrev_b64 v[50:51], 16, v[50:51]
    v_add_u32_dpp v91, v91, v91 row_shr:4 row_mask:0xf bank_mask:0xf bound_ctrl:1
    v_lshrrev_b64 v[58:59], 16, v[58:59]
    s_mov_b32 s101, 0
    v_add_u32_dpp v91, v91, v91 row_shr:8 row_mask:0xf bank_mask:0xf bound_ctrl:1
    s_nop 1
    v_add_u32_dpp v91, v91, v91 row_bcast:15 row_mask:0xa bank_mask:0xf
    s_nop 1
    v_add_u32_dpp v91, v91, v91 row_bcast:31 row_mask:0xc bank_mask:0xf
    v_add_u32 v98, v98, v91
    v_readlane_b32 s37, v91, 63
    s_cbranch_vccnz L2_xo5
L2_xp5:
    s_waitcnt lgkmcnt(0)
    s_cmp_gt_u32 s37, 1024
    s_cbranch_scc1 L2_xs6
    s_cmp_lg_u32 s101, 0
    s_cbranch_scc1 L2_xa6
L2_xb6:
    v_lshlrev_b32 v89, 16, v96
    v_add_u32 v90, 60, v97
    v_bitop3_b32 v90, v89, v45, v90 bitop3:0x6a
    ds_write_b32 v98, v90 offset:12
    v_lshlrev_b32 v89, 20, v96
    v_add_u32 v90, 40, v97
    v_bitop3_b32 v90, v89, v45, v90 bitop3:0x6a
    ds_write_b32 v98, v90 offset:8
    v_lshlrev_b32 v89, 24, v96
    v_add_u32 v90, 20, v97
    v_bitop3_b32 v90, v89, v45, v90 bitop3:0x6a
    ds_write_b32 v98, v90 offset:4
    v_lshlrev_b32 v89, 28, v96
    v_bitop3_b32 v90, v89, v45, v97 bitop3:0x6a
    ds_write_b32 v98, v90 offset:0
    v_mov_b32_dpp v91, v66 quad_perm:[0,0,0,0] row_mask:0xf bank_mask:0xf
    v_and_b32 v89, 3, v91
    v_and_b32 v97, 0xfffc, v91
    v_sub_u16_dpp v88, v66, v91 quad_perm:[2,2,2,2] row_mask:0xf bank_mask:0xf
    v_mad_u32_u24 v97, v97, 5, v4
    v_add_u32 v99, v88, v89
    v_bfm_b32 v96, v88, v89
    v_cmp_lt_u32 s[58:59], 16, v99
    v_lshlrev_b32 v89, v1, v96
    v_and_b32 v89, v45, v89
    v_cmp_ne_u32 vcc, 0, v89
    v_xor_b32 v90, v97, v89
    s_add_u32 s3, s37, s38
    v_mbcnt_lo_u32_b32 v98, vcc_lo, 0
    v_mbcnt_hi_u32_b32 v98, vcc_hi, v98
    s_bcnt1_i32_b64 s41, vcc
    v_lshl_add_u32 v98, v98, 2, s3
    s_lshl2_add_u32 s37, s41, s37
    s_mov_b64 exec, vcc
    ds_write_b32 v98, v90
    s_mov_b64 exec, -1
    s_cmp_lg_u64 s[58:59], 0
    s_cbranch_scc1 L2_xe6
L2_xr6:
    v_add_u32 v98, s37, v0
    v_mov_b32 v90, -1
    ds_write_b32 v98, v90
L2_xw6:
    ds_read_b32 v40, v0 offset:0
    ds_read_b32 v41, v0 offset:256
    ds_read_b32 v42, v44 offset:768
    ds_read_b32 v43, v0 offset:512
    s_sub_u32 s3, s37, 768
    s_cmp_gt_u32 s3, 128
    s_cbranch_scc1 L2_xf6
L2_xg6:
    v_subrev_u32 v88, s38, v3
    ds_write_b128 v88, v[124:127] offset:34816
    v_subrev_u32 v88, s38, v3
    ds_write_b128 v88, v[116:119] offset:32768
    v_subrev_u32 v88, s38, v3
    ds_write_b128 v88, v[120:123] offset:33792
    v_subrev_u32 v88, s100, v3
    ds_write_b128 v88, v[108:111] offset:0
    v_subrev_u32 v88, s100, v3
    ds_write_b128 v88, v[112:115] offset:1024
    s_cmp_eq_u32 s56, 0
    s_cbranch_scc1 L2_e2
    s_mov_b32 exec_lo, s56
    s_mov_b32 exec_hi, 0
    buffer_load_dword v88, v7, s[60:63], 0 offen sc1
    s_mov_b64 exec, -1
    s_waitcnt vmcnt(0)
    v_cmp_gt_u32 vcc, 2, v88
    s_and_b32 s56, vcc_lo, s56
    s_cbranch_scc0 L2_e2
    s_mul_i32 s3, s33, 1280000
    s_add_u32 s3, s3, s100
    s_add_u32 s3, s3, 352768
    buffer_load_dwordx4 v[124:127], v94, s[24:27], s3 offen offset:2048
    s_mul_i32 s3, s33, 1280000
    s_add_u32 s3, s3, s100
    s_add_u32 s3, s3, 352768
    buffer_load_dwordx4 v[116:119], v94, s[24:27], s3 offen offset:0
    s_mul_i32 s3, s33, 1280000
    s_add_u32 s3, s3, s100
    s_add_u32 s3, s3, 352768
    buffer_load_dwordx4 v[120:123], v94, s[24:27], s3 offen offset:1024
    s_mul_i32 s3, s33, 1280000
    s_add_u32 s3, s3, s38
    s_add_u32 s3, s3, 320000
    buffer_load_dwordx4 v[108:111], v94, s[24:27], s3 offen offset:0
    s_mul_i32 s3, s33, 1280000
    s_add_u32 s3, s3, s38
    s_add_u32 s3, s3, 320000
    buffer_load_dwordx4 v[112:115], v94, s[24:27], s3 offen offset:1024
    s_mov_b32 exec_lo, s56
    s_mov_b32 exec_hi, 0
L2_p2:
    buffer_load_dword v88, v7, s[60:63], 0 offen sc1
    s_waitcnt vmcnt(0)
    v_cmpx_gt_u32 vcc, 2, v88
    s_cbranch_vccnz L2_p2
    s_mov_b64 exec, -1
L2_e2:
    s_mov_b32 s6, 0xaaaaaaaa
    s_mov_b32 s7, 0xaaaaaaaa
    v_and_b32 v47, 0x0fffffff, v21
    buffer_load_dwordx2 v[16:17], v47, s[8:11], 0 offen
    buffer_load_dwordx3 v[18:20], v47, s[8:11], 0 offen offset:8
    s_setprio 1
    v_and_b32 v47, 0x0fffffff, v27
    buffer_load_dwordx2 v[22:23], v47, s[8:11], 0 offen
    buffer_load_dwordx3 v[24:26], v47, s[8:11], 0 offen offset:8
    s_waitcnt lgkmcnt(0)
    s_barrier
    s_bitcmp1_b32 s36, s42
    s_cbranch_scc1 L2_slow
L2_ret0:
    s_setprio 3
    s_bitcmp1_b32 s43, s42
    s_cbranch_scc1 L2_oa7
L2_ob7:
    s_bitcmp1_b32 s43, s42
    s_cbranch_scc1 L2_oa8
L2_ob8:
    s_waitcnt vmcnt(2)
    v_and_b32 v46, 0x20000000, v21
    v_lshrrev_b32 v47, 14, v17
    v_bitop3_b32 v47, v47, v5, v46 bitop3:0xea
    ds_read_b64 v[102:103], v47
    v_bitop3_b32 v93, v17, v5, v46 bitop3:0xea
    v_and_b32 v46, 0x10000000, v21
    v_lshrrev_b32 v47, 14, v16
    v_bitop3_b32 v47, v47, v5, v46 bitop3:0xea
    ds_read_b64 v[100:101], v47
    v_bitop3_b32 v92, v16, v5, v46 bitop3:0xea
    v_perm_b32 v15, v17, v20, s45
    v_bitop3_b32 v46, v17, 0.5, -0.5 bitop3:0xa8
    v_perm_b32 v14, v16, v20, s44
    v_bitop3_b32 v47, v16, 0.5, -0.5 bitop3:0xa8
    v_bitop3_b32 v15, v6, v15, v46 bitop3:0xca
    v_bitop3_b32 v14, v6, v14, v47 bitop3:0xca
    s_waitcnt lgkmcnt(0)
    v_mfma_f32_4x4x4_16b_bf16 v[80:83], v[8:9], v[102:103], 0
    v_mfma_f32_4x4x4_16b_bf16 v[76:79], v[8:9], v[100:101], 0
    v_cmp_lt_u32 s[84:85], v5, v92
    s_nop 2
    v_pk_mul_f32 v[80:81], v[80:81], v[14:15] op_sel:[0,1] op_sel_hi:[1,1]
    v_pk_mul_f32 v[82:83], v[82:83], v[14:15] op_sel:[0,1] op_sel_hi:[1,1]
    v_pk_mul_f32 v[76:77], v[76:77], v[14:15] op_sel:[0,0] op_sel_hi:[1,0]
    v_pk_mul_f32 v[78:79], v[78:79], v[14:15] op_sel:[0,0] op_sel_hi:[1,0]
    v_and_b32 v47, 0x0fffffff, v39
    buffer_load_dwordx2 v[34:35], v47, s[8:11], 0 offen
    buffer_load_dwordx3 v[36:38], v47, s[8:11], 0 offen offset:8
    v_and_b32 v46, 0x80000000, v21
    v_lshrrev_b32 v47, 14, v19
    v_bitop3_b32 v47, v47, v5, v46 bitop3:0xea
    ds_read_b64 v[106:107], v47
    v_and_b32 v99, 0x40000000, v21
    v_lshrrev_b32 v47, 14, v18
    v_bitop3_b32 v47, v47, v5, v99 bitop3:0xea
    ds_read_b64 v[104:105], v47
    v_cmp_ne_u64 s[50:51], v[72:73], v[68:69]
    v_cmpx_ne_u64 s[54:55], v[74:75], v[70:71]
    s_and_b64 s[82:83], s[54:55], s[80:81]
    s_cbranch_scc1 L2_c9
L2_d9:
    v_mov_b64 v[84:85], v[70:71]
    v_mov_b32 v7, v95
    v_mov_b64 v[86:87], v[74:75]
    s_or_b64 s[80:81], s[80:81], s[54:55]
    s_mov_b64 exec, s[50:51]
    s_and_b64 s[82:83], s[50:51], s[80:81]
    s_cbranch_scc1 L2_c10
L2_d10:
    v_mov_b64 v[84:85], v[68:69]
    v_mov_b32 v7, v94
    v_mov_b64 v[86:87], v[72:73]
    s_mov_b64 exec, -1
    s_or_b64 s[80:81], s[80:81], s[50:51]
    s_and_b64 exec, s[84:85], s[80:81]
    v_mfma_f32_4x4x4_16b_bf16 v[76:79], v[12:13], v[84:85], 0
    v_mov_b32 v92, v7
    s_andn2_b64 s[80:81], s[80:81], s[84:85]
    v_mfma_f32_4x4x4_16b_bf16 v[76:79], v[10:11], v[86:87], v[76:79]
    s_mov_b64 exec, -1
    ds_read_b64 v[70:71], v93 offset:65408
    ds_read_b64 v[68:69], v92 offset:65408
    v_bitop3_b32 v94, v18, v5, v99 bitop3:0xea
    v_bitop3_b32 v95, v19, v5, v46 bitop3:0xea
    v_perm_b32 v15, v19, v20, s47
    v_bitop3_b32 v46, v19, 0.5, -0.5 bitop3:0xa8
    v_perm_b32 v14, v18, v20, s46
    v_bitop3_b32 v47, v18, 0.5, -0.5 bitop3:0xa8
    v_bitop3_b32 v15, v6, v15, v46 bitop3:0xca
    v_bitop3_b32 v14, v6, v14, v47 bitop3:0xca
    s_waitcnt lgkmcnt(1)
    v_mfma_f32_4x4x4_16b_bf16 v[80:83], v[10:11], v[70:71], v[80:83]
    s_waitcnt lgkmcnt(0)
    v_mfma_f32_4x4x4_16b_bf16 v[76:79], v[10:11], v[68:69], v[76:79]
    s_nop 2
    v_cvt_pk_bf16_f32 v80, v80, v81
    v_cvt_pk_bf16_f32 v81, v82, v83
    ds_wrxchg_rtn_b64 v[74:75], v93, v[80:81] offset:65408
    v_cvt_pk_bf16_f32 v76, v76, v77
    v_cvt_pk_bf16_f32 v77, v78, v79
    ds_wrxchg_rtn_b64 v[72:73], v92, v[76:77] offset:65408
    v_mfma_f32_4x4x4_16b_bf16 v[80:83], v[8:9], v[106:107], 0
    v_mfma_f32_4x4x4_16b_bf16 v[76:79], v[8:9], v[104:105], 0
    v_cmp_lt_u32 s[48:49], v5, v95
    s_nop 2
    v_pk_mul_f32 v[80:81], v[80:81], v[14:15] op_sel:[0,1] op_sel_hi:[1,1]
    v_pk_mul_f32 v[82:83], v[82:83], v[14:15] op_sel:[0,1] op_sel_hi:[1,1]
    v_pk_mul_f32 v[76:77], v[76:77], v[14:15] op_sel:[0,0] op_sel_hi:[1,0]
    v_pk_mul_f32 v[78:79], v[78:79], v[14:15] op_sel:[0,0] op_sel_hi:[1,0]
    v_and_b32 v47, 0x0fffffff, v31
    buffer_load_dword v30, v47, s[8:11], 0 offen offset:16
    s_mov_b64 exec, s[6:7]
    v_add_u32 v47, 8, v47
    v_lshrrev_b32 v31, 2, v31
    s_mov_b64 exec, -1
    buffer_load_dwordx2 v[28:29], v47, s[8:11], 0 offen
    v_and_b32 v47, 0x3f0, v3
    s_cmp_lg_u32 s56, 0
    s_cbranch_scc1 L2_m11
    s_mul_i32 s3, s33, 1280000
    s_add_u32 s3, s3, s100
    s_add_u32 s3, s3, 352768
    buffer_load_dwordx4 v[124:127], v47, s[24:27], s3 offen offset:2048
L2_m11:
    v_and_b32 v47, 0x3f0, v3
    s_cmp_lg_u32 s56, 0
    s_cbranch_scc1 L2_m12
    s_mul_i32 s3, s33, 1280000
    s_add_u32 s3, s3, s100
    s_add_u32 s3, s3, 352768
    buffer_load_dwordx4 v[116:119], v47, s[24:27], s3 offen offset:0
L2_m12:
    s_waitcnt vmcnt(4)
    v_and_b32 v46, 0x20000000, v27
    v_lshrrev_b32 v47, 14, v23
    v_bitop3_b32 v47, v47, v5, v46 bitop3:0xea
    ds_read_b64 v[102:103], v47
    v_and_b32 v99, 0x10000000, v27
    v_lshrrev_b32 v47, 14, v22
    v_bitop3_b32 v47, v47, v5, v99 bitop3:0xea
    ds_read_b64 v[100:101], v47
    s_waitcnt lgkmcnt(2)
    v_cmp_ne_u64 s[50:51], v[72:73], v[68:69]
    v_cmpx_ne_u64 s[54:55], v[74:75], v[70:71]
    s_and_b64 s[82:83], s[54:55], s[80:81]
    s_cbranch_scc1 L2_c13
L2_d13:
    v_mov_b64 v[84:85], v[70:71]
    v_mov_b32 v7, v93
    v_mov_b64 v[86:87], v[74:75]
    s_or_b64 s[80:81], s[80:81], s[54:55]
    s_mov_b64 exec, s[50:51]
    s_and_b64 s[82:83], s[50:51], s[80:81]
    s_cbranch_scc1 L2_c14
L2_d14:
    v_mov_b64 v[84:85], v[68:69]
    v_mov_b32 v7, v92
    v_mov_b64 v[86:87], v[72:73]
    s_mov_b64 exec, -1
    s_or_b64 s[80:81], s[80:81], s[50:51]
    s_and_b64 exec, s[48:49], s[80:81]
    v_mfma_f32_4x4x4_16b_bf16 v[80:83], v[12:13], v[84:85], 0
    v_mov_b32 v95, v7
    s_andn2_b64 s[80:81], s[80:81], s[48:49]
    v_mfma_f32_4x4x4_16b_bf16 v[80:83], v[10:11], v[86:87], v[80:83]
    s_mov_b64 exec, -1
    ds_read_b64 v[70:71], v95 offset:65408
    ds_read_b64 v[68:69], v94 offset:65408
    v_bitop3_b32 v92, v22, v5, v99 bitop3:0xea
    v_bitop3_b32 v93, v23, v5, v46 bitop3:0xea
    v_perm_b32 v15, v23, v26, s45
    v_bitop3_b32 v46, v23, 0.5, -0.5 bitop3:0xa8
    v_perm_b32 v14, v22, v26, s44
    v_bitop3_b32 v47, v22, 0.5, -0.5 bitop3:0xa8
    v_bitop3_b32 v15, v6, v15, v46 bitop3:0xca
    v_bitop3_b32 v14, v6, v14, v47 bitop3:0xca
    s_waitcnt lgkmcnt(1)
    v_mfma_f32_4x4x4_16b_bf16 v[80:83], v[10:11], v[70:71], v[80:83]
    s_waitcnt lgkmcnt(0)
    v_mfma_f32_4x4x4_16b_bf16 v[76:79], v[10:11], v[68:69], v[76:79]
    s_nop 2
    v_cvt_pk_bf16_f32 v80, v80, v81
    v_cvt_pk_bf16_f32 v81, v82, v83
    ds_wrxchg_rtn_b64 v[74:75], v95, v[80:81] offset:65408
    v_cvt_pk_bf16_f32 v76, v76, v77
    v_cvt_pk_bf16_f32 v77, v78, v79
    ds_wrxchg_rtn_b64 v[72:73], v94, v[76:77] offset:65408
    s_setprio 2
    v_mfma_f32_4x4x4_16b_bf16 v[80:83], v[8:9], v[102:103], 0
    v_mfma_f32_4x4x4_16b_bf16 v[76:79], v[8:9], v[100:101], 0
    s_nop 3
    v_pk_mul_f32 v[80:81], v[80:81], v[14:15] op_sel:[0,1] op_sel_hi:[1,1]
    v_pk_mul_f32 v[82:83], v[82:83], v[14:15] op_sel:[0,1] op_sel_hi:[1,1]
    v_pk_mul_f32 v[76:77], v[76:77], v[14:15] op_sel:[0,0] op_sel_hi:[1,0]
    v_pk_mul_f32 v[78:79], v[78:79], v[14:15] op_sel:[0,0] op_sel_hi:[1,0]
    v_and_b32 v47, 0x3f0, v3
    s_cmp_lg_u32 s56, 0
    s_cbranch_scc1 L2_m15
    s_mul_i32 s3, s33, 1280000
    s_add_u32 s3, s3, s100
    s_add_u32 s3, s3, 352768
    buffer_load_dwordx4 v[120:123], v47, s[24:27], s3 offen offset:1024
L2_m15:
    v_sub_u16 v88, v60, v52
    v_and_b32 v89, 3, v52
    v_add3_u32 v99, v88, v89, 3
    v_and_b32 v99, -4, v99
    v_max_u32 v99, 4, v99
    v_and_b32 v97, 0xfffc, v52
    v_bfm_b32 v96, v88, v89
    v_add_u32_dpp v91, v99, v99 row_shr:1 row_mask:0xf bank_mask:0xf bound_ctrl:1
    v_mad_u32_u24 v97, v97, 5, v2
    v_cmp_lt_u32 vcc, 16, v99
    v_add_u32_dpp v91, v91, v91 row_shr:2 row_mask:0xf bank_mask:0xf bound_ctrl:1
    v_sub_u32 v98, s38, v99
    v_lshrrev_b64 v[52:53], 16, v[52:53]
    v_add_u32_dpp v91, v91, v91 row_shr:4 row_mask:0xf bank_mask:0xf bound_ctrl:1
    v_lshrrev_b64 v[60:61], 16, v[60:61]
    s_mov_b32 s101, 0
    v_add_u32_dpp v91, v91, v91 row_shr:8 row_mask:0xf bank_mask:0xf bound_ctrl:1
    s_nop 1
    v_add_u32_dpp v91, v91, v91 row_bcast:15 row_mask:0xa bank_mask:0xf
    s_nop 1
    v_add_u32_dpp v91, v91, v91 row_bcast:31 row_mask:0xc bank_mask:0xf
    v_add_u32 v98, v98, v91
    v_readlane_b32 s37, v91, 63
    s_cbranch_vccnz L2_xo16
L2_xp16:
    v_and_b32 v46, 0x80000000, v27
    v_lshrrev_b32 v47, 14, v25
    v_bitop3_b32 v47, v47, v5, v46 bitop3:0xea
    ds_read_b64 v[106:107], v47
    v_and_b32 v99, 0x40000000, v27
    v_lshrrev_b32 v47, 14, v24
    v_bitop3_b32 v47, v47, v5, v99 bitop3:0xea
    ds_read_b64 v[104:105], v47
    s_waitcnt lgkmcnt(2)
    v_cmp_ne_u64 s[50:51], v[72:73], v[68:69]
    v_cmpx_ne_u64 s[54:55], v[74:75], v[70:71]
    s_and_b64 s[82:83], s[54:55], s[80:81]
    s_cbranch_scc1 L2_c17
L2_d17:
    v_mov_b64 v[84:85], v[70:71]
    v_mov_b32 v7, v95
    v_mov_b64 v[86:87], v[74:75]
    s_or_b64 s[80:81], s[80:81], s[54:55]
    s_mov_b64 exec, s[50:51]
    s_and_b64 s[82:83], s[50:51], s[80:81]
    s_cbranch_scc1 L2_c18
L2_d18:
    v_mov_b64 v[84:85], v[68:69]
    v_mov_b32 v7, v94
    v_mov_b64 v[86:87], v[72:73]
    s_mov_b64 exec, -1
    s_or_b64 s[80:81], s[80:81], s[50:51]
    ds_read_b64 v[70:71], v93 offset:65408
    ds_read_b64 v[68:69], v92 offset:65408
    v_bitop3_b32 v94, v24, v5, v99 bitop3:0xea
    v_bitop3_b32 v95, v25, v5, v46 bitop3:0xea
    v_perm_b32 v15, v25, v26, s47
    v_bitop3_b32 v46, v25, 0.5, -0.5 bitop3:0xa8
    v_perm_b32 v14, v24, v26, s46
    v_bitop3_b32 v47, v24, 0.5, -0.5 bitop3:0xa8
    v_bitop3_b32 v15, v6, v15, v46 bitop3:0xca
    v_bitop3_b32 v14, v6, v14, v47 bitop3:0xca
    s_waitcnt lgkmcnt(1)
    v_mfma_f32_4x4x4_16b_bf16 v[80:83], v[10:11], v[70:71], v[80:83]
    s_waitcnt lgkmcnt(0)
    v_mfma_f32_4x4x4_16b_bf16 v[76:79], v[10:11], v[68:69], v[76:79]
    s_nop 2
    v_cvt_pk_bf16_f32 v80, v80, v81
    v_cvt_pk_bf16_f32 v81, v82, v83
    ds_wrxchg_rtn_b64 v[74:75], v93, v[80:81] offset:65408
    v_cvt_pk_bf16_f32 v76, v76, v77
    v_cvt_pk_bf16_f32 v77, v78, v79
    ds_wrxchg_rtn_b64 v[72:73], v92, v[76:77] offset:65408
    s_setprio 1
    v_mfma_f32_4x4x4_16b_bf16 v[80:83], v[8:9], v[106:107], 0
    v_mfma_f32_4x4x4_16b_bf16 v[76:79], v[8:9], v[104:105], 0
    v_cmp_lt_u32 s[84:85], v5, v94
    s_nop 2
    v_pk_mul_f32 v[80:81], v[80:81], v[14:15] op_sel:[0,1] op_sel_hi:[1,1]
    v_pk_mul_f32 v[82:83], v[82:83], v[14:15] op_sel:[0,1] op_sel_hi:[1,1]
    v_pk_mul_f32 v[76:77], v[76:77], v[14:15] op_sel:[0,0] op_sel_hi:[1,0]
    v_pk_mul_f32 v[78:79], v[78:79], v[14:15] op_sel:[0,0] op_sel_hi:[1,0]
    v_and_b32 v47, 0x3f0, v3
    s_cmp_lg_u32 s56, 0
    s_cbranch_scc1 L2_m19
    s_mul_i32 s3, s33, 1280000
    s_add_u32 s3, s3, s38
    s_add_u32 s3, s3, 320000
    buffer_load_dwordx4 v[108:111], v47, s[24:27], s3 offen offset:0
L2_m19:
    v_and_b32 v47, 0x3f0, v3
    s_cmp_lg_u32 s56, 0
    s_cbranch_scc1 L2_m20
    s_mul_i32 s3, s33, 1280000
    s_add_u32 s3, s3, s38
    s_add_u32 s3, s3, 320000
    buffer_load_dwordx4 v[112:115], v47, s[24:27], s3 offen offset:1024
L2_m20:
    v_and_b32 v47, 0x0fffffff, v40
    buffer_load_dwordx2 v[16:17], v47, s[8:11], 0 offen
    buffer_load_dwordx3 v[18:20], v47, s[8:11], 0 offen offset:8
    s_waitcnt vmcnt(2)
    s_mov_b64 exec, s[6:7]
    v_lshrrev_b32 v30, 16, v30
    s_mov_b64 exec, -1
    v_and_b32 v46, 0x20000000, v31
    v_lshrrev_b32 v47, 14, v29
    v_bitop3_b32 v47, v47, v5, v46 bitop3:0xea
    ds_read_b64 v[102:103], v47
    v_and_b32 v99, 0x10000000, v31
    v_lshrrev_b32 v47, 14, v28
    v_bitop3_b32 v47, v47, v5, v99 bitop3:0xea
    ds_read_b64 v[100:101], v47
    s_waitcnt lgkmcnt(2)
    v_cmp_ne_u64 s[50:51], v[72:73], v[68:69]
    v_cmpx_ne_u64 s[54:55], v[74:75], v[70:71]
    s_and_b64 s[82:83], s[54:55], s[80:81]
    s_cbranch_scc1 L2_c21
L2_d21:
    v_mov_b64 v[84:85], v[70:71]
    v_mov_b32 v7, v93
    v_mov_b64 v[86:87], v[74:75]
    s_or_b64 s[80:81], s[80:81], s[54:55]
    s_mov_b64 exec, s[50:51]
    s_and_b64 s[82:83], s[50:51], s[80:81]
    s_cbranch_scc1 L2_c22
L2_d22:
    v_mov_b64 v[84:85], v[68:69]
    v_mov_b32 v7, v92
    v_mov_b64 v[86:87], v[72:73]
    s_mov_b64 exec, -1
    s_or_b64 s[80:81], s[80:81], s[50:51]
    s_and_b64 exec, s[84:85], s[80:81]
    v_mfma_f32_4x4x4_16b_bf16 v[76:79], v[12:13], v[84:85], 0
    v_mov_b32 v94, v7
    s_andn2_b64 s[80:81], s[80:81], s[84:85]
    v_mfma_f32_4x4x4_16b_bf16 v[76:79], v[10:11], v[86:87], v[76:79]
    s_mov_b64 exec, -1
    ds_read_b64 v[70:71], v95 offset:65408
    ds_read_b64 v[68:69], v94 offset:65408
    v_bitop3_b32 v92, v28, v5, v99 bitop3:0xea
    v_bitop3_b32 v93, v29, v5, v46 bitop3:0xea
    v_perm_b32 v15, v29, v30, s45
    v_bitop3_b32 v46, v29, 0.5, -0.5 bitop3:0xa8
    v_perm_b32 v14, v28, v30, s44
    v_bitop3_b32 v47, v28, 0.5, -0.5 bitop3:0xa8
    v_bitop3_b32 v15, v6, v15, v46 bitop3:0xca
    v_bitop3_b32 v14, v6, v14, v47 bitop3:0xca
    s_waitcnt lgkmcnt(1)
    v_mfma_f32_4x4x4_16b_bf16 v[80:83], v[10:11], v[70:71], v[80:83]
    s_waitcnt lgkmcnt(0)
    v_mfma_f32_4x4x4_16b_bf16 v[76:79], v[10:11], v[68:69], v[76:79]
    s_nop 2
    v_cvt_pk_bf16_f32 v80, v80, v81
    v_cvt_pk_bf16_f32 v81, v82, v83
    ds_wrxchg_rtn_b64 v[74:75], v95, v[80:81] offset:65408
    v_cvt_pk_bf16_f32 v76, v76, v77
    v_cvt_pk_bf16_f32 v77, v78, v79
    ds_wrxchg_rtn_b64 v[72:73], v94, v[76:77] offset:65408
    s_setprio 0
    v_mfma_f32_4x4x4_16b_bf16 v[80:83], v[8:9], v[102:103], 0
    v_mfma_f32_4x4x4_16b_bf16 v[76:79], v[8:9], v[100:101], 0
    v_cmp_lt_u32 s[48:49], v5, v93
    s_nop 2
    v_pk_mul_f32 v[80:81], v[80:81], v[14:15] op_sel:[0,1] op_sel_hi:[1,1]
    v_pk_mul_f32 v[82:83], v[82:83], v[14:15] op_sel:[0,1] op_sel_hi:[1,1]
    v_pk_mul_f32 v[76:77], v[76:77], v[14:15] op_sel:[0,0] op_sel_hi:[1,0]
    v_pk_mul_f32 v[78:79], v[78:79], v[14:15] op_sel:[0,0] op_sel_hi:[1,0]
    s_add_u32 s40, s40, 0x50000
    v_and_b32 v47, 0x0fffffff, v41
    buffer_load_dwordx2 v[22:23], v47, s[8:11], 0 offen
    buffer_load_dwordx3 v[24:26], v47, s[8:11], 0 offen offset:8
    v_and_b32 v46, 0x80000000, v39
    v_lshrrev_b32 v47, 14, v37
    v_bitop3_b32 v47, v47, v5, v46 bitop3:0xea
    ds_read_b64 v[102:103], v47
    v_and_b32 v99, 0x40000000, v39
    v_lshrrev_b32 v47, 14, v36
    v_bitop3_b32 v47, v47, v5, v99 bitop3:0xea
    ds_read_b64 v[100:101], v47
    v_and_b32 v46, 0x20000000, v39
    v_lshrrev_b32 v47, 14, v35
    v_bitop3_b32 v47, v47, v5, v46 bitop3:0xea
    ds_read_b64 v[106:107], v47
    v_and_b32 v99, 0x10000000, v39
    v_lshrrev_b32 v47, 14, v34
    v_bitop3_b32 v47, v47, v5, v99 bitop3:0xea
    ds_read_b64 v[104:105], v47
    s_waitcnt lgkmcnt(4)
    v_cmp_ne_u64 s[50:51], v[72:73], v[68:69]
    v_cmpx_ne_u64 s[54:55], v[74:75], v[70:71]
    s_and_b64 s[82:83], s[54:55], s[80:81]
    s_cbranch_scc1 L2_c23
L2_d23:
    v_mov_b64 v[84:85], v[70:71]
    v_mov_b32 v7, v95
    v_mov_b64 v[86:87], v[74:75]
    s_or_b64 s[80:81], s[80:81], s[54:55]
    s_mov_b64 exec, s[50:51]
    s_and_b64 s[82:83], s[50:51], s[80:81]
    s_cbranch_scc1 L2_c24
L2_d24:
    v_mov_b64 v[84:85], v[68:69]
    v_mov_b32 v7, v94
    v_mov_b64 v[86:87], v[72:73]
    s_mov_b64 exec, -1
    s_or_b64 s[80:81], s[80:81], s[50:51]
    s_and_b64 exec, s[48:49], s[80:81]
    v_mfma_f32_4x4x4_16b_bf16 v[80:83], v[12:13], v[84:85], 0
    v_mov_b32 v93, v7
    s_andn2_b64 s[80:81], s[80:81], s[48:49]
    v_mfma_f32_4x4x4_16b_bf16 v[80:83], v[10:11], v[86:87], v[80:83]
    s_mov_b64 exec, -1
    ds_read_b64 v[70:71], v93 offset:65408
    ds_read_b64 v[68:69], v92 offset:65408
    v_bitop3_b32 v94, v34, v5, v99 bitop3:0xea
    v_bitop3_b32 v95, v35, v5, v46 bitop3:0xea
    v_perm_b32 v15, v35, v38, s45
    v_bitop3_b32 v46, v35, 0.5, -0.5 bitop3:0xa8
    v_perm_b32 v14, v34, v38, s44
    v_bitop3_b32 v47, v34, 0.5, -0.5 bitop3:0xa8
    v_bitop3_b32 v15, v6, v15, v46 bitop3:0xca
    v_bitop3_b32 v14, v6, v14, v47 bitop3:0xca
    s_waitcnt lgkmcnt(1)
    v_mfma_f32_4x4x4_16b_bf16 v[80:83], v[10:11], v[70:71], v[80:83]
    s_waitcnt lgkmcnt(0)
    v_mfma_f32_4x4x4_16b_bf16 v[76:79], v[10:11], v[68:69], v[76:79]
    s_nop 2
    v_cvt_pk_bf16_f32 v80, v80, v81
    v_cvt_pk_bf16_f32 v81, v82, v83
    ds_wrxchg_rtn_b64 v[74:75], v93, v[80:81] offset:65408
    v_cvt_pk_bf16_f32 v76, v76, v77
    v_cvt_pk_bf16_f32 v77, v78, v79
    ds_wrxchg_rtn_b64 v[72:73], v92, v[76:77] offset:65408
    s_barrier
    s_setprio 3
    s_waitcnt vmcnt(4)
    v_subrev_u32 v88, s38, v3
    ds_write_b128 v88, v[124:127] offset:34816
    s_add_u32 s3, s40, 4096
    buffer_load_dwordx4 v[124:127], v3, s[16:19], s3 offen sc1
    s_waitcnt vmcnt(5)
    v_subrev_u32 v88, s38, v3
    ds_write_b128 v88, v[116:119] offset:32768
    buffer_load_dwordx4 v[116:119], v3, s[16:19], s40 offen offset:2048 sc1
    s_waitcnt vmcnt(6)
    v_subrev_u32 v88, s38, v3
    ds_write_b128 v88, v[120:123] offset:33792
    buffer_load_dwordx4 v[120:123], v3, s[16:19], s40 offen offset:3072 sc1
    v_mfma_f32_4x4x4_16b_bf16 v[80:83], v[8:9], v[106:107], 0
    v_mfma_f32_4x4x4_16b_bf16 v[76:79], v[8:9], v[104:105], 0
    s_nop 3
    v_pk_mul_f32 v[80:81], v[80:81], v[14:15] op_sel:[0,1] op_sel_hi:[1,1]
    v_pk_mul_f32 v[82:83], v[82:83], v[14:15] op_sel:[0,1] op_sel_hi:[1,1]
    v_pk_mul_f32 v[76:77], v[76:77], v[14:15] op_sel:[0,0] op_sel_hi:[1,0]
    v_pk_mul_f32 v[78:79], v[78:79], v[14:15] op_sel:[0,0] op_sel_hi:[1,0]
    v_and_b32 v47, 0x0fffffff, v42
    buffer_load_dword v30, v47, s[8:11], 0 offen offset:16
    s_mov_b64 exec, s[6:7]
    v_add_u32 v47, 8, v47
    v_lshrrev_b32 v42, 2, v42
    s_mov_b64 exec, -1
    buffer_load_dwordx2 v[28:29], v47, s[8:11], 0 offen
    s_cmp_gt_u32 s37, 1024
    s_cbranch_scc1 L2_xs25
    s_cmp_lg_u32 s101, 0
    s_cbranch_scc1 L2_xa25
L2_xb25:
    v_lshlrev_b32 v89, 16, v96
    v_add_u32 v90, 60, v97
    v_bitop3_b32 v90, v89, v45, v90 bitop3:0x6a
    ds_write_b32 v98, v90 offset:12
    v_lshlrev_b32 v89, 20, v96
    v_add_u32 v90, 40, v97
    v_bitop3_b32 v90, v89, v45, v90 bitop3:0x6a
    ds_write_b32 v98, v90 offset:8
    v_lshlrev_b32 v89, 24, v96
    v_add_u32 v90, 20, v97
    v_bitop3_b32 v90, v89, v45, v90 bitop3:0x6a
    ds_write_b32 v98, v90 offset:4
    v_lshlrev_b32 v89, 28, v96
    v_bitop3_b32 v90, v89, v45, v97 bitop3:0x6a
    ds_write_b32 v98, v90 offset:0
    v_mov_b32_dpp v91, v64 quad_perm:[1,1,1,1] row_mask:0xf bank_mask:0xf
    v_and_b32 v89, 3, v91
    v_and_b32 v97, 0xfffc, v91
    v_sub_u16_dpp v88, v64, v91 quad_perm:[3,3,3,3] row_mask:0xf bank_mask:0xf
    v_mad_u32_u24 v97, v97, 5, v4
    v_add_u32 v99, v88, v89
    v_bfm_b32 v96, v88, v89
    v_cmp_lt_u32 s[58:59], 16, v99
    v_lshlrev_b32 v89, v1, v96
    v_and_b32 v89, v45, v89
    v_cmp_ne_u32 vcc, 0, v89
    v_xor_b32 v90, v97, v89
    s_add_u32 s3, s37, s38
    v_mbcnt_lo_u32_b32 v98, vcc_lo, 0
    v_mbcnt_hi_u32_b32 v98, vcc_hi, v98
    s_bcnt1_i32_b64 s41, vcc
    v_lshl_add_u32 v98, v98, 2, s3
    s_lshl2_add_u32 s37, s41, s37
    s_mov_b64 exec, vcc
    ds_write_b32 v98, v90
    s_mov_b64 exec, -1
    s_cmp_lg_u64 s[58:59], 0
    s_cbranch_scc1 L2_xe25
L2_xr25:
    v_add_u32 v98, s37, v0
    v_mov_b32 v90, -1
    ds_write_b32 v98, v90
L2_xw25:
    s_setprio 2
    s_waitcnt lgkmcnt(9)
    v_cmp_ne_u64 s[50:51], v[72:73], v[68:69]
    v_cmpx_ne_u64 s[54:55], v[74:75], v[70:71]
    s_and_b64 s[82:83], s[54:55], s[80:81]
    s_cbranch_scc1 L2_c26
L2_d26:
    v_mov_b64 v[84:85], v[70:71]
    v_mov_b32 v7, v93
    v_mov_b64 v[86:87], v[74:75]
    s_or_b64 s[80:81], s[80:81], s[54:55]
    s_mov_b64 exec, s[50:51]
    s_and_b64 s[82:83], s[50:51], s[80:81]
    s_cbranch_scc1 L2_c27
L2_d27:
    v_mov_b64 v[84:85], v[68:69]
    v_mov_b32 v7, v92
    v_mov_b64 v[86:87], v[72:73]
    s_mov_b64 exec, -1
    s_or_b64 s[80:81], s[80:81], s[50:51]
    ds_read_b64 v[70:71], v95 offset:65408
    ds_read_b64 v[68:69], v94 offset:65408
    v_and_b32 v46, 0x40000000, v39
    v_bitop3_b32 v92, v36, v5, v46 bitop3:0xea
    v_and_b32 v46, 0x80000000, v39
    v_bitop3_b32 v93, v37, v5, v46 bitop3:0xea
    v_perm_b32 v15, v37, v38, s47
    v_bitop3_b32 v46, v37, 0.5, -0.5 bitop3:0xa8
    v_perm_b32 v14, v36, v38, s46
    v_bitop3_b32 v47, v36, 0.5, -0.5 bitop3:0xa8
    v_bitop3_b32 v15, v6, v15, v46 bitop3:0xca
    v_bitop3_b32 v14, v6, v14, v47 bitop3:0xca
    s_setprio 1
    s_waitcnt lgkmcnt(1)
    v_mfma_f32_4x4x4_16b_bf16 v[80:83], v[10:11], v[70:71], v[80:83]
    s_waitcnt lgkmcnt(0)
    v_mfma_f32_4x4x4_16b_bf16 v[76:79], v[10:11], v[68:69], v[76:79]
    s_nop 2
    v_cvt_pk_bf16_f32 v80, v80, v81
    v_cvt_pk_bf16_f32 v81, v82, v83
    ds_wrxchg_rtn_b64 v[74:75], v95, v[80:81] offset:65408
    v_cvt_pk_bf16_f32 v76, v76, v77
    v_cvt_pk_bf16_f32 v77, v78, v79
    ds_wrxchg_rtn_b64 v[72:73], v94, v[76:77] offset:65408
    ds_read_b32 v21, v0 offset:0
    ds_read_b32 v27, v0 offset:256
    ds_read_b32 v31, v44 offset:768
    ds_read_b32 v39, v0 offset:512
    s_sub_u32 s3, s37, 768
    s_cmp_gt_u32 s3, 128
    s_cbranch_scc1 L2_xf25
L2_xg25:
    v_and_b32 v88, 0x0fffffff, v43
    buffer_load_dwordx2 v[34:35], v88, s[8:11], 0 offen
    buffer_load_dwordx3 v[36:38], v88, s[8:11], 0 offen offset:8
    s_setprio 0
    s_waitcnt vmcnt(11)
    v_subrev_u32 v88, s100, v3
    ds_write_b128 v88, v[108:111] offset:0
    s_waitcnt vmcnt(11)
    v_subrev_u32 v88, s100, v3
    ds_write_b128 v88, v[112:115] offset:1024
    v_mfma_f32_4x4x4_16b_bf16 v[80:83], v[8:9], v[102:103], 0
    v_mfma_f32_4x4x4_16b_bf16 v[76:79], v[8:9], v[100:101], 0
    v_cmp_lt_u32 s[84:85], v5, v92
    s_nop 2
    v_pk_mul_f32 v[80:81], v[80:81], v[14:15] op_sel:[0,1] op_sel_hi:[1,1]
    v_pk_mul_f32 v[82:83], v[82:83], v[14:15] op_sel:[0,1] op_sel_hi:[1,1]
    v_pk_mul_f32 v[76:77], v[76:77], v[14:15] op_sel:[0,0] op_sel_hi:[1,0]
    v_pk_mul_f32 v[78:79], v[78:79], v[14:15] op_sel:[0,0] op_sel_hi:[1,0]
    s_add_u32 s42, s42, 1
    s_waitcnt lgkmcnt(0)
    s_add_u32 s24, s30, 0xec54000
    s_addc_u32 s25, s31, 0
    s_mov_b32 s26, 0x100
    s_mov_b32 s27, 0x20000
    s_barrier
    s_bitcmp1_b32 s36, s42
    s_cbranch_scc1 L2_slow
L2_ret1:
    s_setprio 3
    s_bitcmp1_b32 s43, s42
    s_cbranch_scc1 L2_oa28
L2_ob28:
    s_waitcnt vmcnt(9)
    v_and_b32 v46, 0x20000000, v40
    v_lshrrev_b32 v47, 14, v17
    v_bitop3_b32 v47, v47, v5, v46 bitop3:0xea
    ds_read_b64 v[106:107], v47
    v_and_b32 v99, 0x10000000, v40
    v_lshrrev_b32 v47, 14, v16
    v_bitop3_b32 v47, v47, v5, v99 bitop3:0xea
    ds_read_b64 v[104:105], v47
    v_cmp_ne_u64 s[50:51], v[72:73], v[68:69]
    v_cmpx_ne_u64 s[54:55], v[74:75], v[70:71]
    s_and_b64 s[82:83], s[54:55], s[80:81]
    s_cbranch_scc1 L2_c29
L2_d29:
    v_mov_b64 v[84:85], v[70:71]
    v_mov_b32 v7, v95
    v_mov_b64 v[86:87], v[74:75]
    s_or_b64 s[80:81], s[80:81], s[54:55]
    s_mov_b64 exec, s[50:51]
    s_and_b64 s[82:83], s[50:51], s[80:81]
    s_cbranch_scc1 L2_c30
L2_d30:
    v_mov_b64 v[84:85], v[68:69]
    v_mov_b32 v7, v94
    v_mov_b64 v[86:87], v[72:73]
    s_mov_b64 exec, -1
    s_or_b64 s[80:81], s[80:81], s[50:51]
    s_and_b64 exec, s[84:85], s[80:81]
    v_mfma_f32_4x4x4_16b_bf16 v[76:79], v[12:13], v[84:85], 0
    v_mov_b32 v92, v7
    s_andn2_b64 s[80:81], s[80:81], s[84:85]
    v_mfma_f32_4x4x4_16b_bf16 v[76:79], v[10:11], v[86:87], v[76:79]
    s_mov_b64 exec, -1
    ds_read_b64 v[70:71], v93 offset:65408
    ds_read_b64 v[68:69], v92 offset:65408
    v_bitop3_b32 v94, v16, v5, v99 bitop3:0xea
    v_bitop3_b32 v95, v17, v5, v46 bitop3:0xea
    v_perm_b32 v15, v17, v20, s45
    v_bitop3_b32 v46, v17, 0.5, -0.5 bitop3:0xa8
    v_perm_b32 v14, v16, v20, s44
    v_bitop3_b32 v47, v16, 0.5, -0.5 bitop3:0xa8
    v_bitop3_b32 v15, v6, v15, v46 bitop3:0xca
    v_bitop3_b32 v14, v6, v14, v47 bitop3:0xca
    s_waitcnt lgkmcnt(1)
    v_mfma_f32_4x4x4_16b_bf16 v[80:83], v[10:11], v[70:71], v[80:83]
    s_waitcnt lgkmcnt(0)
    v_mfma_f32_4x4x4_16b_bf16 v[76:79], v[10:11], v[68:69], v[76:79]
    s_nop 2
    v_cvt_pk_bf16_f32 v80, v80, v81
    v_cvt_pk_bf16_f32 v81, v82, v83
    ds_wrxchg_rtn_b64 v[74:75], v93, v[80:81] offset:65408
    v_cvt_pk_bf16_f32 v76, v76, v77
    v_cvt_pk_bf16_f32 v77, v78, v79
    ds_wrxchg_rtn_b64 v[72:73], v92, v[76:77] offset:65408
    v_mfma_f32_4x4x4_16b_bf16 v[80:83], v[8:9], v[106:107], 0
    v_mfma_f32_4x4x4_16b_bf16 v[76:79], v[8:9], v[104:105], 0
    v_cmp_lt_u32 s[84:85], v5, v94
    s_nop 2
    v_pk_mul_f32 v[80:81], v[80:81], v[14:15] op_sel:[0,1] op_sel_hi:[1,1]
    v_pk_mul_f32 v[82:83], v[82:83], v[14:15] op_sel:[0,1] op_sel_hi:[1,1]
    v_pk_mul_f32 v[76:77], v[76:77], v[14:15] op_sel:[0,0] op_sel_hi:[1,0]
    v_pk_mul_f32 v[78:79], v[78:79], v[14:15] op_sel:[0,0] op_sel_hi:[1,0]
    buffer_load_dwordx4 v[108:111], v3, s[16:19], s40 offen offset:0 sc1
    v_and_b32 v46, 0x80000000, v40
    v_lshrrev_b32 v47, 14, v19
    v_bitop3_b32 v47, v47, v5, v46 bitop3:0xea
    ds_read_b64 v[102:103], v47
    v_and_b32 v99, 0x40000000, v40
    v_lshrrev_b32 v47, 14, v18
    v_bitop3_b32 v47, v47, v5, v99 bitop3:0xea
    ds_read_b64 v[100:101], v47
    s_waitcnt lgkmcnt(2)
    v_cmp_ne_u64 s[50:51], v[72:73], v[68:69]
    v_cmpx_ne_u64 s[54:55], v[74:75], v[70:71]
    s_and_b64 s[82:83], s[54:55], s[80:81]
    s_cbranch_scc1 L2_c31
L2_d31:
    v_mov_b64 v[84:85], v[70:71]
    v_mov_b32 v7, v93
    v_mov_b64 v[86:87], v[74:75]
    s_or_b64 s[80:81], s[80:81], s[54:55]
    s_mov_b64 exec, s[50:51]
    s_and_b64 s[82:83], s[50:51], s[80:81]
    s_cbranch_scc1 L2_c32
L2_d32:
    v_mov_b64 v[84:85], v[68:69]
    v_mov_b32 v7, v92
    v_mov_b64 v[86:87], v[72:73]
    s_mov_b64 exec, -1
    s_or_b64 s[80:81], s[80:81], s[50:51]
    s_and_b64 exec, s[84:85], s[80:81]
    v_mfma_f32_4x4x4_16b_bf16 v[76:79], v[12:13], v[84:85], 0
    v_mov_b32 v94, v7
    s_andn2_b64 s[80:81], s[80:81], s[84:85]
    v_mfma_f32_4x4x4_16b_bf16 v[76:79], v[10:11], v[86:87], v[76:79]
    s_mov_b64 exec, -1
    ds_read_b64 v[70:71], v95 offset:65408
    ds_read_b64 v[68:69], v94 offset:65408
    v_bitop3_b32 v92, v18, v5, v99 bitop3:0xea
    v_bitop3_b32 v93, v19, v5, v46 bitop3:0xea
    v_perm_b32 v15, v19, v20, s47
    v_bitop3_b32 v46, v19, 0.5, -0.5 bitop3:0xa8
    v_perm_b32 v14, v18, v20, s46
    v_bitop3_b32 v47, v18, 0.5, -0.5 bitop3:0xa8
    v_bitop3_b32 v15, v6, v15, v46 bitop3:0xca
    v_bitop3_b32 v14, v6, v14, v47 bitop3:0xca
    s_waitcnt lgkmcnt(1)
    v_mfma_f32_4x4x4_16b_bf16 v[80:83], v[10:11], v[70:71], v[80:83]
    s_waitcnt lgkmcnt(0)
    v_mfma_f32_4x4x4_16b_bf16 v[76:79], v[10:11], v[68:69], v[76:79]
    s_nop 2
    v_cvt_pk_bf16_f32 v80, v80, v81
    v_cvt_pk_bf16_f32 v81, v82, v83
    ds_wrxchg_rtn_b64 v[74:75], v95, v[80:81] offset:65408
    v_cvt_pk_bf16_f32 v76, v76, v77
    v_cvt_pk_bf16_f32 v77, v78, v79
    ds_wrxchg_rtn_b64 v[72:73], v94, v[76:77] offset:65408
    v_and_b32 v88, 0x0fffffff, v21
    buffer_load_dwordx2 v[16:17], v88, s[8:11], 0 offen
    buffer_load_dwordx3 v[18:20], v88, s[8:11], 0 offen offset:8
    v_mfma_f32_4x4x4_16b_bf16 v[80:83], v[8:9], v[102:103], 0
    v_mfma_f32_4x4x4_16b_bf16 v[76:79], v[8:9], v[100:101], 0
    v_cmp_lt_u32 s[48:49], v5, v93
    s_nop 2
    v_pk_mul_f32 v[80:81], v[80:81], v[14:15] op_sel:[0,1] op_sel_hi:[1,1]
    v_pk_mul_f32 v[82:83], v[82:83], v[14:15] op_sel:[0,1] op_sel_hi:[1,1]
    v_pk_mul_f32 v[76:77], v[76:77], v[14:15] op_sel:[0,0] op_sel_hi:[1,0]
    v_pk_mul_f32 v[78:79], v[78:79], v[14:15] op_sel:[0,0] op_sel_hi:[1,0]
    s_waitcnt vmcnt(10)
    v_and_b32 v46, 0x20000000, v41
    v_lshrrev_b32 v47, 14, v23
    v_bitop3_b32 v47, v47, v5, v46 bitop3:0xea
    ds_read_b64 v[106:107], v47
    v_and_b32 v99, 0x10000000, v41
    v_lshrrev_b32 v47, 14, v22
    v_bitop3_b32 v47, v47, v5, v99 bitop3:0xea
    ds_read_b64 v[104:105], v47
    s_waitcnt lgkmcnt(2)
    v_cmp_ne_u64 s[50:51], v[72:73], v[68:69]
    v_cmpx_ne_u64 s[54:55], v[74:75], v[70:71]
    s_and_b64 s[82:83], s[54:55], s[80:81]
    s_cbranch_scc1 L2_c33
L2_d33:
    v_mov_b64 v[84:85], v[70:71]
    v_mov_b32 v7, v95
    v_mov_b64 v[86:87], v[74:75]
    s_or_b64 s[80:81], s[80:81], s[54:55]
    s_mov_b64 exec, s[50:51]
    s_and_b64 s[82:83], s[50:51], s[80:81]
    s_cbranch_scc1 L2_c34
L2_d34:
    v_mov_b64 v[84:85], v[68:69]
    v_mov_b32 v7, v94
    v_mov_b64 v[86:87], v[72:73]
    s_mov_b64 exec, -1
    s_or_b64 s[80:81], s[80:81], s[50:51]
    s_and_b64 exec, s[48:49], s[80:81]
    v_mfma_f32_4x4x4_16b_bf16 v[80:83], v[12:13], v[84:85], 0
    v_mov_b32 v93, v7
    s_andn2_b64 s[80:81], s[80:81], s[48:49]
    v_mfma_f32_4x4x4_16b_bf16 v[80:83], v[10:11], v[86:87], v[80:83]
    s_mov_b64 exec, -1
    ds_read_b64 v[70:71], v93 offset:65408
    ds_read_b64 v[68:69], v92 offset:65408
    v_bitop3_b32 v94, v22, v5, v99 bitop3:0xea
    v_bitop3_b32 v95, v23, v5, v46 bitop3:0xea
    v_perm_b32 v15, v23, v26, s45
    v_bitop3_b32 v46, v23, 0.5, -0.5 bitop3:0xa8
    v_perm_b32 v14, v22, v26, s44
    v_bitop3_b32 v47, v22, 0.5, -0.5 bitop3:0xa8
    v_bitop3_b32 v15, v6, v15, v46 bitop3:0xca
    v_bitop3_b32 v14, v6, v14, v47 bitop3:0xca
    s_waitcnt lgkmcnt(1)
    v_mfma_f32_4x4x4_16b_bf16 v[80:83], v[10:11], v[70:71], v[80:83]
    s_waitcnt lgkmcnt(0)
    v_mfma_f32_4x4x4_16b_bf16 v[76:79], v[10:11], v[68:69], v[76:79]
    s_nop 2
    v_cvt_pk_bf16_f32 v80, v80, v81
    v_cvt_pk_bf16_f32 v81, v82, v83
    ds_wrxchg_rtn_b64 v[74:75], v93, v[80:81] offset:65408
    v_cvt_pk_bf16_f32 v76, v76, v77
    v_cvt_pk_bf16_f32 v77, v78, v79
    ds_wrxchg_rtn_b64 v[72:73], v92, v[76:77] offset:65408
    s_setprio 2
    v_mfma_f32_4x4x4_16b_bf16 v[80:83], v[8:9], v[106:107], 0
    v_mfma_f32_4x4x4_16b_bf16 v[76:79], v[8:9], v[104:105], 0
    s_nop 3
    v_pk_mul_f32 v[80:81], v[80:81], v[14:15] op_sel:[0,1] op_sel_hi:[1,1]
    v_pk_mul_f32 v[82:83], v[82:83], v[14:15] op_sel:[0,1] op_sel_hi:[1,1]
    v_pk_mul_f32 v[76:77], v[76:77], v[14:15] op_sel:[0,0] op_sel_hi:[1,0]
    v_pk_mul_f32 v[78:79], v[78:79], v[14:15] op_sel:[0,0] op_sel_hi:[1,0]
    s_bitcmp1_b32 s43, s42
    s_cbranch_scc1 L2_oa35
L2_ob35:
    buffer_load_dwordx4 v[112:115], v3, s[16:19], s40 offen offset:1024 sc1
    v_sub_u16 v88, v62, v54
    v_and_b32 v89, 3, v54
    v_add3_u32 v99, v88, v89, 3
    v_and_b32 v99, -4, v99
    v_max_u32 v99, 4, v99
    v_and_b32 v97, 0xfffc, v54
    v_bfm_b32 v96, v88, v89
    v_add_u32_dpp v91, v99, v99 row_shr:1 row_mask:0xf bank_mask:0xf bound_ctrl:1
    v_mad_u32_u24 v97, v97, 5, v2
    v_cmp_lt_u32 vcc, 16, v99
    v_add_u32_dpp v91, v91, v91 row_shr:2 row_mask:0xf bank_mask:0xf bound_ctrl:1
    v_sub_u32 v98, s38, v99
    v_lshrrev_b64 v[54:55], 16, v[54:55]
    v_add_u32_dpp v91, v91, v91 row_shr:4 row_mask:0xf bank_mask:0xf bound_ctrl:1
    v_lshrrev_b64 v[62:63], 16, v[62:63]
    s_mov_b32 s101, 0
    v_add_u32_dpp v91, v91, v91 row_shr:8 row_mask:0xf bank_mask:0xf bound_ctrl:1
    s_nop 1
    v_add_u32_dpp v91, v91, v91 row_bcast:15 row_mask:0xa bank_mask:0xf
    s_nop 1
    v_add_u32_dpp v91, v91, v91 row_bcast:31 row_mask:0xc bank_mask:0xf
    v_add_u32 v98, v98, v91
    v_readlane_b32 s37, v91, 63
    s_cbranch_vccnz L2_xo36
L2_xp36:
    v_and_b32 v46, 0x80000000, v41
    v_lshrrev_b32 v47, 14, v25
    v_bitop3_b32 v47, v47, v5, v46 bitop3:0xea
    ds_read_b64 v[102:103], v47
    v_and_b32 v99, 0x40000000, v41
    v_lshrrev_b32 v47, 14, v24
    v_bitop3_b32 v47, v47, v5, v99 bitop3:0xea
    ds_read_b64 v[100:101], v47
    s_waitcnt lgkmcnt(2)
    v_cmp_ne_u64 s[50:51], v[72:73], v[68:69]
    v_cmpx_ne_u64 s[54:55], v[74:75], v[70:71]
    s_and_b64 s[82:83], s[54:55], s[80:81]
    s_cbranch_scc1 L2_c37
L2_d37:
    v_mov_b64 v[84:85], v[70:71]
    v_mov_b32 v7, v93
    v_mov_b64 v[86:87], v[74:75]
    s_or_b64 s[80:81], s[80:81], s[54:55]
    s_mov_b64 exec, s[50:51]
    s_and_b64 s[82:83], s[50:51], s[80:81]
    s_cbranch_scc1 L2_c38
L2_d38:
    v_mov_b64 v[84:85], v[68:69]
    v_mov_b32 v7, v92
    v_mov_b64 v[86:87], v[72:73]
    s_mov_b64 exec, -1
    s_or_b64 s[80:81], s[80:81], s[50:51]
    ds_read_b64 v[70:71], v95 offset:65408
    ds_read_b64 v[68:69], v94 offset:65408
    v_bitop3_b32 v92, v24, v5, v99 bitop3:0xea
    v_bitop3_b32 v93, v25, v5, v46 bitop3:0xea
    v_perm_b32 v15, v25, v26, s47
    v_bitop3_b32 v46, v25, 0.5, -0.5 bitop3:0xa8
    v_perm_b32 v14, v24, v26, s46
    v_bitop3_b32 v47, v24, 0.5, -0.5 bitop3:0xa8
    v_bitop3_b32 v15, v6, v15, v46 bitop3:0xca
    v_bitop3_b32 v14, v6, v14, v47 bitop3:0xca
    s_waitcnt lgkmcnt(1)
    v_mfma_f32_4x4x4_16b_bf16 v[80:83], v[10:11], v[70:71], v[80:83]
    s_waitcnt lgkmcnt(0)
    v_mfma_f32_4x4x4_16b_bf16 v[76:79], v[10:11], v[68:69], v[76:79]
    s_nop 2
    v_cvt_pk_bf16_f32 v80, v80, v81
    v_cvt_pk_bf16_f32 v81, v82, v83
    ds_wrxchg_rtn_b64 v[74:75], v95, v[80:81] offset:65408
    v_cvt_pk_bf16_f32 v76, v76, v77
    v_cvt_pk_bf16_f32 v77, v78, v79
    ds_wrxchg_rtn_b64 v[72:73], v94, v[76:77] offset:65408
    v_and_b32 v88, 0x0fffffff, v27
    buffer_load_dwordx2 v[22:23], v88, s[8:11], 0 offen
    buffer_load_dwordx3 v[24:26], v88, s[8:11], 0 offen offset:8
    s_setprio 1
    v_mfma_f32_4x4x4_16b_bf16 v[80:83], v[8:9], v[102:103], 0
    v_mfma_f32_4x4x4_16b_bf16 v[76:79], v[8:9], v[100:101], 0
    v_cmp_lt_u32 s[84:85], v5, v92
    s_nop 2
    v_pk_mul_f32 v[80:81], v[80:81], v[14:15] op_sel:[0,1] op_sel_hi:[1,1]
    v_pk_mul_f32 v[82:83], v[82:83], v[14:15] op_sel:[0,1] op_sel_hi:[1,1]
    v_pk_mul_f32 v[76:77], v[76:77], v[14:15] op_sel:[0,0] op_sel_hi:[1,0]
    v_pk_mul_f32 v[78:79], v[78:79], v[14:15] op_sel:[0,0] op_sel_hi:[1,0]
    s_waitcnt vmcnt(8)
    s_mov_b64 exec, s[6:7]
    v_lshrrev_b32 v30, 16, v30
    s_mov_b64 exec, -1
    v_and_b32 v46, 0x20000000, v42
    v_lshrrev_b32 v47, 14, v29
    v_bitop3_b32 v47, v47, v5, v46 bitop3:0xea
    ds_read_b64 v[106:107], v47
    v_and_b32 v99, 0x10000000, v42
    v_lshrrev_b32 v47, 14, v28
    v_bitop3_b32 v47, v47, v5, v99 bitop3:0xea
    ds_read_b64 v[104:105], v47
    s_waitcnt lgkmcnt(2)
    v_cmp_ne_u64 s[50:51], v[72:73], v[68:69]
    v_cmpx_ne_u64 s[54:55], v[74:75], v[70:71]
    s_and_b64 s[82:83], s[54:55], s[80:81]
    s_cbranch_scc1 L2_c39
L2_d39:
    v_mov_b64 v[84:85], v[70:71]
    v_mov_b32 v7, v95
    v_mov_b64 v[86:87], v[74:75]
    s_or_b64 s[80:81], s[80:81], s[54:55]
    s_mov_b64 exec, s[50:51]
    s_and_b64 s[82:83], s[50:51], s[80:81]
    s_cbranch_scc1 L2_c40
L2_d40:
    v_mov_b64 v[84:85], v[68:69]
    v_mov_b32 v7, v94
    v_mov_b64 v[86:87], v[72:73]
    s_mov_b64 exec, -1
    s_or_b64 s[80:81], s[80:81], s[50:51]
    s_and_b64 exec, s[84:85], s[80:81]
    v_mfma_f32_4x4x4_16b_bf16 v[76:79], v[12:13], v[84:85], 0
    v_mov_b32 v92, v7
    s_andn2_b64 s[80:81], s[80:81], s[84:85]
    v_mfma_f32_4x4x4_16b_bf16 v[76:79], v[10:11], v[86:87], v[76:79]
    s_mov_b64 exec, -1
    ds_read_b64 v[70:71], v93 offset:65408
    ds_read_b64 v[68:69], v92 offset:65408
    v_bitop3_b32 v94, v28, v5, v99 bitop3:0xea
    v_bitop3_b32 v95, v29, v5, v46 bitop3:0xea
    v_perm_b32 v15, v29, v30, s45
    v_bitop3_b32 v46, v29, 0.5, -0.5 bitop3:0xa8
    v_perm_b32 v14, v28, v30, s44
    v_bitop3_b32 v47, v28, 0.5, -0.5 bitop3:0xa8
    v_bitop3_b32 v15, v6, v15, v46 bitop3:0xca
    v_bitop3_b32 v14, v6, v14, v47 bitop3:0xca
    s_waitcnt lgkmcnt(1)
    v_mfma_f32_4x4x4_16b_bf16 v[80:83], v[10:11], v[70:71], v[80:83]
    s_waitcnt lgkmcnt(0)
    v_mfma_f32_4x4x4_16b_bf16 v[76:79], v[10:11], v[68:69], v[76:79]
    s_nop 2
    v_cvt_pk_bf16_f32 v80, v80, v81
    v_cvt_pk_bf16_f32 v81, v82, v83
    ds_wrxchg_rtn_b64 v[74:75], v93, v[80:81] offset:65408
    v_cvt_pk_bf16_f32 v76, v76, v77
    v_cvt_pk_bf16_f32 v77, v78, v79
    ds_wrxchg_rtn_b64 v[72:73], v92, v[76:77] offset:65408
    s_setprio 0
    v_mfma_f32_4x4x4_16b_bf16 v[80:83], v[8:9], v[106:107], 0
    v_mfma_f32_4x4x4_16b_bf16 v[76:79], v[8:9], v[104:105], 0
    v_cmp_lt_u32 s[48:49], v5, v95
    s_nop 2
    v_pk_mul_f32 v[80:81], v[80:81], v[14:15] op_sel:[0,1] op_sel_hi:[1,1]
    v_pk_mul_f32 v[82:83], v[82:83], v[14:15] op_sel:[0,1] op_sel_hi:[1,1]
    v_pk_mul_f32 v[76:77], v[76:77], v[14:15] op_sel:[0,0] op_sel_hi:[1,0]
    v_pk_mul_f32 v[78:79], v[78:79], v[14:15] op_sel:[0,0] op_sel_hi:[1,0]
    s_add_u32 s40, s40, 0x50000
    v_and_b32 v47, 0x0fffffff, v31
    buffer_load_dword v30, v47, s[8:11], 0 offen offset:16
    s_mov_b64 exec, s[6:7]
    v_add_u32 v47, 8, v47
    v_lshrrev_b32 v31, 2, v31
    s_mov_b64 exec, -1
    buffer_load_dwordx2 v[28:29], v47, s[8:11], 0 offen
    s_waitcnt vmcnt(8)
    v_and_b32 v46, 0x80000000, v43
    v_lshrrev_b32 v47, 14, v37
    v_bitop3_b32 v47, v47, v5, v46 bitop3:0xea
    ds_read_b64 v[106:107], v47
    v_and_b32 v99, 0x40000000, v43
    v_lshrrev_b32 v47, 14, v36
    v_bitop3_b32 v47, v47, v5, v99 bitop3:0xea
    ds_read_b64 v[104:105], v47
    v_and_b32 v46, 0x20000000, v43
    v_lshrrev_b32 v47, 14, v35
    v_bitop3_b32 v47, v47, v5, v46 bitop3:0xea
    ds_read_b64 v[102:103], v47
    v_and_b32 v99, 0x10000000, v43
    v_lshrrev_b32 v47, 14, v34
    v_bitop3_b32 v47, v47, v5, v99 bitop3:0xea
    ds_read_b64 v[100:101], v47
    s_waitcnt lgkmcnt(4)
    v_cmp_ne_u64 s[50:51], v[72:73], v[68:69]
    v_cmpx_ne_u64 s[54:55], v[74:75], v[70:71]
    s_and_b64 s[82:83], s[54:55], s[80:81]
    s_cbranch_scc1 L2_c41
L2_d41:
    v_mov_b64 v[84:85], v[70:71]
    v_mov_b32 v7, v93
    v_mov_b64 v[86:87], v[74:75]
    s_or_b64 s[80:81], s[80:81], s[54:55]
    s_mov_b64 exec, s[50:51]
    s_and_b64 s[82:83], s[50:51], s[80:81]
    s_cbranch_scc1 L2_c42
L2_d42:
    v_mov_b64 v[84:85], v[68:69]
    v_mov_b32 v7, v92
    v_mov_b64 v[86:87], v[72:73]
    s_mov_b64 exec, -1
    s_or_b64 s[80:81], s[80:81], s[50:51]
    s_and_b64 exec, s[48:49], s[80:81]
    v_mfma_f32_4x4x4_16b_bf16 v[80:83], v[12:13], v[84:85], 0
    v_mov_b32 v95, v7
    s_andn2_b64 s[80:81], s[80:81], s[48:49]
    v_mfma_f32_4x4x4_16b_bf16 v[80:83], v[10:11], v[86:87], v[80:83]
    s_mov_b64 exec, -1
    ds_read_b64 v[70:71], v95 offset:65408
    ds_read_b64 v[68:69], v94 offset:65408
    v_bitop3_b32 v92, v34, v5, v99 bitop3:0xea
    v_bitop3_b32 v93, v35, v5, v46 bitop3:0xea
    v_perm_b32 v15, v35, v38, s45
    v_bitop3_b32 v46, v35, 0.5, -0.5 bitop3:0xa8
    v_perm_b32 v14, v34, v38, s44
    v_bitop3_b32 v47, v34, 0.5, -0.5 bitop3:0xa8
    v_bitop3_b32 v15, v6, v15, v46 bitop3:0xca
    v_bitop3_b32 v14, v6, v14, v47 bitop3:0xca
    s_waitcnt lgkmcnt(1)
    v_mfma_f32_4x4x4_16b_bf16 v[80:83], v[10:11], v[70:71], v[80:83]
    s_waitcnt lgkmcnt(0)
    v_mfma_f32_4x4x4_16b_bf16 v[76:79], v[10:11], v[68:69], v[76:79]
    s_nop 2
    v_cvt_pk_bf16_f32 v80, v80, v81
    v_cvt_pk_bf16_f32 v81, v82, v83
    ds_wrxchg_rtn_b64 v[74:75], v95, v[80:81] offset:65408
    v_cvt_pk_bf16_f32 v76, v76, v77
    v_cvt_pk_bf16_f32 v77, v78, v79
    ds_wrxchg_rtn_b64 v[72:73], v94, v[76:77] offset:65408
    s_barrier
    s_setprio 3
    s_mov_b32 m0, s100
    s_nop 0
    ds_write_addtid_b32 v124 offset:34816
    ds_write_addtid_b32 v125 offset:35072
    ds_write_addtid_b32 v126 offset:35328
    ds_write_addtid_b32 v127 offset:35584
    s_add_u32 s3, s40, 4096
    buffer_load_dwordx4 v[124:127], v3, s[16:19], s3 offen sc1
    ds_write_addtid_b32 v116 offset:32768
    ds_write_addtid_b32 v117 offset:33024
    ds_write_addtid_b32 v118 offset:33280
    ds_write_addtid_b32 v119 offset:33536
    buffer_load_dwordx4 v[116:119], v3, s[16:19], s40 offen offset:2048 sc1
    ds_write_addtid_b32 v120 offset:33792
    ds_write_addtid_b32 v121 offset:34048
    ds_write_addtid_b32 v122 offset:34304
    ds_write_addtid_b32 v123 offset:34560
    buffer_load_dwordx4 v[120:123], v3, s[16:19], s40 offen offset:3072 sc1
    v_mfma_f32_4x4x4_16b_bf16 v[80:83], v[8:9], v[102:103], 0
    v_mfma_f32_4x4x4_16b_bf16 v[76:79], v[8:9], v[100:101], 0
    s_nop 3
    v_pk_mul_f32 v[80:81], v[80:81], v[14:15] op_sel:[0,1] op_sel_hi:[1,1]
    v_pk_mul_f32 v[82:83], v[82:83], v[14:15] op_sel:[0,1] op_sel_hi:[1,1]
    v_pk_mul_f32 v[76:77], v[76:77], v[14:15] op_sel:[0,0] op_sel_hi:[1,0]
    v_pk_mul_f32 v[78:79], v[78:79], v[14:15] op_sel:[0,0] op_sel_hi:[1,0]
    s_cmp_gt_u32 s37, 1024
    s_cbranch_scc1 L2_xs43
    s_cmp_lg_u32 s101, 0
    s_cbranch_scc1 L2_xa43
L2_xb43:
    v_lshlrev_b32 v89, 16, v96
    v_add_u32 v90, 60, v97
    v_bitop3_b32 v90, v89, v45, v90 bitop3:0x6a
    ds_write_b32 v98, v90 offset:12
    v_lshlrev_b32 v89, 20, v96
    v_add_u32 v90, 40, v97
    v_bitop3_b32 v90, v89, v45, v90 bitop3:0x6a
    ds_write_b32 v98, v90 offset:8
    v_lshlrev_b32 v89, 24, v96
    v_add_u32 v90, 20, v97
    v_bitop3_b32 v90, v89, v45, v90 bitop3:0x6a
    ds_write_b32 v98, v90 offset:4
    v_lshlrev_b32 v89, 28, v96
    v_bitop3_b32 v90, v89, v45, v97 bitop3:0x6a
    ds_write_b32 v98, v90 offset:0
    v_mov_b32_dpp v91, v66 quad_perm:[1,1,1,1] row_mask:0xf bank_mask:0xf
    v_and_b32 v89, 3, v91
    v_and_b32 v97, 0xfffc, v91
    v_sub_u16_dpp v88, v66, v91 quad_perm:[3,3,3,3] row_mask:0xf bank_mask:0xf
    v_mad_u32_u24 v97, v97, 5, v4
    v_add_u32 v99, v88, v89
    v_bfm_b32 v96, v88, v89
    v_cmp_lt_u32 s[58:59], 16, v99
    v_lshlrev_b32 v89, v1, v96
    v_and_b32 v89, v45, v89
    v_cmp_ne_u32 vcc, 0, v89
    v_xor_b32 v90, v97, v89
    s_add_u32 s3, s37, s38
    v_mbcnt_lo_u32_b32 v98, vcc_lo, 0
    v_mbcnt_hi_u32_b32 v98, vcc_hi, v98
    s_bcnt1_i32_b64 s41, vcc
    v_lshl_add_u32 v98, v98, 2, s3
    s_lshl2_add_u32 s37, s41, s37
    s_mov_b64 exec, vcc
    ds_write_b32 v98, v90
    s_mov_b64 exec, -1
    s_cmp_lg_u64 s[58:59], 0
    s_cbranch_scc1 L2_xe43
L2_xr43:
    v_add_u32 v98, s37, v0
    v_mov_b32 v90, -1
    ds_write_b32 v98, v90
L2_xw43:
    s_setprio 2
    s_waitcnt lgkmcnt(14)
    v_cmp_ne_u64 s[50:51], v[72:73], v[68:69]
    v_cmpx_ne_u64 s[54:55], v[74:75], v[70:71]
    s_and_b64 s[82:83], s[54:55], s[80:81]
    s_cbranch_scc1 L2_c44
L2_d44:
    v_mov_b64 v[84:85], v[70:71]
    v_mov_b32 v7, v95
    v_mov_b64 v[86:87], v[74:75]
    s_or_b64 s[80:81], s[80:81], s[54:55]
    s_mov_b64 exec, s[50:51]
    s_and_b64 s[82:83], s[50:51], s[80:81]
    s_cbranch_scc1 L2_c45
L2_d45:
    v_mov_b64 v[84:85], v[68:69]
    v_mov_b32 v7, v94
    v_mov_b64 v[86:87], v[72:73]
    s_mov_b64 exec, -1
    s_or_b64 s[80:81], s[80:81], s[50:51]
    ds_read_b64 v[70:71], v93 offset:65408
    ds_read_b64 v[68:69], v92 offset:65408
    v_and_b32 v46, 0x40000000, v43
    v_bitop3_b32 v94, v36, v5, v46 bitop3:0xea
    v_and_b32 v46, 0x80000000, v43
    v_bitop3_b32 v95, v37, v5, v46 bitop3:0xea
    v_perm_b32 v15, v37, v38, s47
    v_bitop3_b32 v46, v37, 0.5, -0.5 bitop3:0xa8
    v_perm_b32 v14, v36, v38, s46
    v_bitop3_b32 v47, v36, 0.5, -0.5 bitop3:0xa8
    v_bitop3_b32 v15, v6, v15, v46 bitop3:0xca
    v_bitop3_b32 v14, v6, v14, v47 bitop3:0xca
    s_setprio 1
    s_waitcnt lgkmcnt(1)
    v_mfma_f32_4x4x4_16b_bf16 v[80:83], v[10:11], v[70:71], v[80:83]
    s_waitcnt lgkmcnt(0)
    v_mfma_f32_4x4x4_16b_bf16 v[76:79], v[10:11], v[68:69], v[76:79]
    s_nop 2
    v_cvt_pk_bf16_f32 v80, v80, v81
    v_cvt_pk_bf16_f32 v81, v82, v83
    ds_wrxchg_rtn_b64 v[74:75], v93, v[80:81] offset:65408
    v_cvt_pk_bf16_f32 v76, v76, v77
    v_cvt_pk_bf16_f32 v77, v78, v79
    ds_wrxchg_rtn_b64 v[72:73], v92, v[76:77] offset:65408
    ds_read_b32 v40, v0 offset:0
    ds_read_b32 v41, v0 offset:256
    ds_read_b32 v42, v44 offset:768
    ds_read_b32 v43, v0 offset:512
    s_sub_u32 s3, s37, 768
    s_cmp_gt_u32 s3, 128
    s_cbranch_scc1 L2_xf43
L2_xg43:
    v_lshrrev_b64 v[64:65], 16, v[64:65]
    v_lshrrev_b64 v[66:67], 16, v[66:67]
    v_and_b32 v88, 0x0fffffff, v39
    buffer_load_dwordx2 v[34:35], v88, s[8:11], 0 offen
    buffer_load_dwordx3 v[36:38], v88, s[8:11], 0 offen offset:8
    s_setprio 0
    s_waitcnt vmcnt(12)
    s_mov_b32 m0, s38
    s_nop 0
    ds_write_addtid_b32 v108 offset:0
    ds_write_addtid_b32 v109 offset:256
    ds_write_addtid_b32 v110 offset:512
    ds_write_addtid_b32 v111 offset:768
    s_waitcnt vmcnt(9)
    ds_write_addtid_b32 v112 offset:1024
    ds_write_addtid_b32 v113 offset:1280
    ds_write_addtid_b32 v114 offset:1536
    ds_write_addtid_b32 v115 offset:1792
    v_mfma_f32_4x4x4_16b_bf16 v[80:83], v[8:9], v[106:107], 0
    v_mfma_f32_4x4x4_16b_bf16 v[76:79], v[8:9], v[104:105], 0
    v_cmp_lt_u32 s[84:85], v5, v94
    s_nop 2
    v_pk_mul_f32 v[80:81], v[80:81], v[14:15] op_sel:[0,1] op_sel_hi:[1,1]
    v_pk_mul_f32 v[82:83], v[82:83], v[14:15] op_sel:[0,1] op_sel_hi:[1,1]
    v_pk_mul_f32 v[76:77], v[76:77], v[14:15] op_sel:[0,0] op_sel_hi:[1,0]
    v_pk_mul_f32 v[78:79], v[78:79], v[14:15] op_sel:[0,0] op_sel_hi:[1,0]
    s_add_u32 s42, s42, 1
    s_waitcnt lgkmcnt(0)
L2_loop:
    s_barrier
    s_bitcmp1_b32 s36, s42
    s_cbranch_scc1 L2_slow
L2_ret2:
    s_setprio 3
    s_bitcmp1_b32 s43, s42
    s_cbranch_scc1 L2_oa46
L2_ob46:
    v_and_b32 v46, 0x20000000, v21
    v_lshrrev_b32 v47, 14, v17
    v_bitop3_b32 v47, v47, v5, v46 bitop3:0xea
    ds_read_b64 v[102:103], v47
    v_and_b32 v99, 0x10000000, v21
    v_lshrrev_b32 v47, 14, v16
    v_bitop3_b32 v47, v47, v5, v99 bitop3:0xea
    ds_read_b64 v[100:101], v47
    v_cmp_ne_u64 s[50:51], v[72:73], v[68:69]
    v_cmpx_ne_u64 s[54:55], v[74:75], v[70:71]
    s_and_b64 s[82:83], s[54:55], s[80:81]
    s_cbranch_scc1 L2_c47
L2_d47:
    v_mov_b64 v[84:85], v[70:71]
    v_mov_b32 v7, v93
    v_mov_b64 v[86:87], v[74:75]
    s_or_b64 s[80:81], s[80:81], s[54:55]
    s_mov_b64 exec, s[50:51]
    s_and_b64 s[82:83], s[50:51], s[80:81]
    s_cbranch_scc1 L2_c48
L2_d48:
    v_mov_b64 v[84:85], v[68:69]
    v_mov_b32 v7, v92
    v_mov_b64 v[86:87], v[72:73]
    s_mov_b64 exec, -1
    s_or_b64 s[80:81], s[80:81], s[50:51]
    s_and_b64 exec, s[84:85], s[80:81]
    v_mfma_f32_4x4x4_16b_bf16 v[76:79], v[12:13], v[84:85], 0
    v_mov_b32 v94, v7
    s_andn2_b64 s[80:81], s[80:81], s[84:85]
    v_mfma_f32_4x4x4_16b_bf16 v[76:79], v[10:11], v[86:87], v[76:79]
    s_mov_b64 exec, -1
    ds_read_b64 v[70:71], v95 offset:65408
    ds_read_b64 v[68:69], v94 offset:65408
    v_bitop3_b32 v92, v16, v5, v99 bitop3:0xea
    v_bitop3_b32 v93, v17, v5, v46 bitop3:0xea
    v_perm_b32 v15, v17, v20, s45
    v_bitop3_b32 v46, v17, 0.5, -0.5 bitop3:0xa8
    v_perm_b32 v14, v16, v20, s44
    v_bitop3_b32 v47, v16, 0.5, -0.5 bitop3:0xa8
    v_bitop3_b32 v15, v6, v15, v46 bitop3:0xca
    v_bitop3_b32 v14, v6, v14, v47 bitop3:0xca
    s_waitcnt lgkmcnt(1)
    v_mfma_f32_4x4x4_16b_bf16 v[80:83], v[10:11], v[70:71], v[80:83]
    s_waitcnt lgkmcnt(0)
    v_mfma_f32_4x4x4_16b_bf16 v[76:79], v[10:11], v[68:69], v[76:79]
    s_nop 2
    v_cvt_pk_bf16_f32 v80, v80, v81
    v_cvt_pk_bf16_f32 v81, v82, v83
    ds_wrxchg_rtn_b64 v[74:75], v95, v[80:81] offset:65408
    v_cvt_pk_bf16_f32 v76, v76, v77
    v_cvt_pk_bf16_f32 v77, v78, v79
    ds_wrxchg_rtn_b64 v[72:73], v94, v[76:77] offset:65408
    v_mfma_f32_4x4x4_16b_bf16 v[80:83], v[8:9], v[102:103], 0
    v_mfma_f32_4x4x4_16b_bf16 v[76:79], v[8:9], v[100:101], 0
    v_cmp_lt_u32 s[84:85], v5, v92
    s_nop 2
    v_pk_mul_f32 v[80:81], v[80:81], v[14:15] op_sel:[0,1] op_sel_hi:[1,1]
    v_pk_mul_f32 v[82:83], v[82:83], v[14:15] op_sel:[0,1] op_sel_hi:[1,1]
    v_pk_mul_f32 v[76:77], v[76:77], v[14:15] op_sel:[0,0] op_sel_hi:[1,0]
    v_pk_mul_f32 v[78:79], v[78:79], v[14:15] op_sel:[0,0] op_sel_hi:[1,0]
    buffer_load_dwordx4 v[108:111], v3, s[16:19], s40 offen offset:0 sc1
    v_and_b32 v46, 0x80000000, v21
    v_lshrrev_b32 v47, 14, v19
    v_bitop3_b32 v47, v47, v5, v46 bitop3:0xea
    ds_read_b64 v[106:107], v47
    v_and_b32 v99, 0x40000000, v21
    v_lshrrev_b32 v47, 14, v18
    v_bitop3_b32 v47, v47, v5, v99 bitop3:0xea
    ds_read_b64 v[104:105], v47
    s_waitcnt lgkmcnt(2)
    v_cmp_ne_u64 s[50:51], v[72:73], v[68:69]
    v_cmpx_ne_u64 s[54:55], v[74:75], v[70:71]
    s_and_b64 s[82:83], s[54:55], s[80:81]
    s_cbranch_scc1 L2_c49
L2_d49:
    v_mov_b64 v[84:85], v[70:71]
    v_mov_b32 v7, v95
    v_mov_b64 v[86:87], v[74:75]
    s_or_b64 s[80:81], s[80:81], s[54:55]
    s_mov_b64 exec, s[50:51]
    s_and_b64 s[82:83], s[50:51], s[80:81]
    s_cbranch_scc1 L2_c50
L2_d50:
    v_mov_b64 v[84:85], v[68:69]
    v_mov_b32 v7, v94
    v_mov_b64 v[86:87], v[72:73]
    s_mov_b64 exec, -1
    s_or_b64 s[80:81], s[80:81], s[50:51]
    s_and_b64 exec, s[84:85], s[80:81]
    v_mfma_f32_4x4x4_16b_bf16 v[76:79], v[12:13], v[84:85], 0
    v_mov_b32 v92, v7
    s_andn2_b64 s[80:81], s[80:81], s[84:85]
    v_mfma_f32_4x4x4_16b_bf16 v[76:79], v[10:11], v[86:87], v[76:79]
    s_mov_b64 exec, -1
    ds_read_b64 v[70:71], v93 offset:65408
    ds_read_b64 v[68:69], v92 offset:65408
    v_bitop3_b32 v94, v18, v5, v99 bitop3:0xea
    v_bitop3_b32 v95, v19, v5, v46 bitop3:0xea
    v_perm_b32 v15, v19, v20, s47
    v_bitop3_b32 v46, v19, 0.5, -0.5 bitop3:0xa8
    v_perm_b32 v14, v18, v20, s46
    v_bitop3_b32 v47, v18, 0.5, -0.5 bitop3:0xa8
    v_bitop3_b32 v15, v6, v15, v46 bitop3:0xca
    v_bitop3_b32 v14, v6, v14, v47 bitop3:0xca
    s_waitcnt lgkmcnt(1)
    v_mfma_f32_4x4x4_16b_bf16 v[80:83], v[10:11], v[70:71], v[80:83]
    s_waitcnt lgkmcnt(0)
    v_mfma_f32_4x4x4_16b_bf16 v[76:79], v[10:11], v[68:69], v[76:79]
    s_nop 2
    v_cvt_pk_bf16_f32 v80, v80, v81
    v_cvt_pk_bf16_f32 v81, v82, v83
    ds_wrxchg_rtn_b64 v[74:75], v93, v[80:81] offset:65408
    v_cvt_pk_bf16_f32 v76, v76, v77
    v_cvt_pk_bf16_f32 v77, v78, v79
    ds_wrxchg_rtn_b64 v[72:73], v92, v[76:77] offset:65408
    v_and_b32 v88, 0x0fffffff, v40
    buffer_load_dwordx2 v[16:17], v88, s[8:11], 0 offen
    buffer_load_dwordx3 v[18:20], v88, s[8:11], 0 offen offset:8
    v_mfma_f32_4x4x4_16b_bf16 v[80:83], v[8:9], v[106:107], 0
    v_mfma_f32_4x4x4_16b_bf16 v[76:79], v[8:9], v[104:105], 0
    v_cmp_lt_u32 s[48:49], v5, v95
    s_nop 2
    v_pk_mul_f32 v[80:81], v[80:81], v[14:15] op_sel:[0,1] op_sel_hi:[1,1]
    v_pk_mul_f32 v[82:83], v[82:83], v[14:15] op_sel:[0,1] op_sel_hi:[1,1]
    v_pk_mul_f32 v[76:77], v[76:77], v[14:15] op_sel:[0,0] op_sel_hi:[1,0]
    v_pk_mul_f32 v[78:79], v[78:79], v[14:15] op_sel:[0,0] op_sel_hi:[1,0]
    s_waitcnt vmcnt(10)
    v_and_b32 v46, 0x20000000, v27
    v_lshrrev_b32 v47, 14, v23
    v_bitop3_b32 v47, v47, v5, v46 bitop3:0xea
    ds_read_b64 v[102:103], v47
    v_and_b32 v99, 0x10000000, v27
    v_lshrrev_b32 v47, 14, v22
    v_bitop3_b32 v47, v47, v5, v99 bitop3:0xea
    ds_read_b64 v[100:101], v47
    s_waitcnt lgkmcnt(2)
    v_cmp_ne_u64 s[50:51], v[72:73], v[68:69]
    v_cmpx_ne_u64 s[54:55], v[74:75], v[70:71]
    s_and_b64 s[82:83], s[54:55], s[80:81]
    s_cbranch_scc1 L2_c51
L2_d51:
    v_mov_b64 v[84:85], v[70:71]
    v_mov_b32 v7, v93
    v_mov_b64 v[86:87], v[74:75]
    s_or_b64 s[80:81], s[80:81], s[54:55]
    s_mov_b64 exec, s[50:51]
    s_and_b64 s[82:83], s[50:51], s[80:81]
    s_cbranch_scc1 L2_c52
L2_d52:
    v_mov_b64 v[84:85], v[68:69]
    v_mov_b32 v7, v92
    v_mov_b64 v[86:87], v[72:73]
    s_mov_b64 exec, -1
    s_or_b64 s[80:81], s[80:81], s[50:51]
    s_and_b64 exec, s[48:49], s[80:81]
    v_mfma_f32_4x4x4_16b_bf16 v[80:83], v[12:13], v[84:85], 0
    v_mov_b32 v95, v7
    s_andn2_b64 s[80:81], s[80:81], s[48:49]
    v_mfma_f32_4x4x4_16b_bf16 v[80:83], v[10:11], v[86:87], v[80:83]
    s_mov_b64 exec, -1
    ds_read_b64 v[70:71], v95 offset:65408
    ds_read_b64 v[68:69], v94 offset:65408
    v_bitop3_b32 v92, v22, v5, v99 bitop3:0xea
    v_bitop3_b32 v93, v23, v5, v46 bitop3:0xea
    v_perm_b32 v15, v23, v26, s45
    v_bitop3_b32 v46, v23, 0.5, -0.5 bitop3:0xa8
    v_perm_b32 v14, v22, v26, s44
    v_bitop3_b32 v47, v22, 0.5, -0.5 bitop3:0xa8
    v_bitop3_b32 v15, v6, v15, v46 bitop3:0xca
    v_bitop3_b32 v14, v6, v14, v47 bitop3:0xca
    s_waitcnt lgkmcnt(1)
    v_mfma_f32_4x4x4_16b_bf16 v[80:83], v[10:11], v[70:71], v[80:83]
    s_waitcnt lgkmcnt(0)
    v_mfma_f32_4x4x4_16b_bf16 v[76:79], v[10:11], v[68:69], v[76:79]
    s_nop 2
    v_cvt_pk_bf16_f32 v80, v80, v81
    v_cvt_pk_bf16_f32 v81, v82, v83
    ds_wrxchg_rtn_b64 v[74:75], v95, v[80:81] offset:65408
    v_cvt_pk_bf16_f32 v76, v76, v77
    v_cvt_pk_bf16_f32 v77, v78, v79
    ds_wrxchg_rtn_b64 v[72:73], v94, v[76:77] offset:65408
    s_setprio 2
    v_mfma_f32_4x4x4_16b_bf16 v[80:83], v[8:9], v[102:103], 0
    v_mfma_f32_4x4x4_16b_bf16 v[76:79], v[8:9], v[100:101], 0
    s_nop 3
    v_pk_mul_f32 v[80:81], v[80:81], v[14:15] op_sel:[0,1] op_sel_hi:[1,1]
    v_pk_mul_f32 v[82:83], v[82:83], v[14:15] op_sel:[0,1] op_sel_hi:[1,1]
    v_pk_mul_f32 v[76:77], v[76:77], v[14:15] op_sel:[0,0] op_sel_hi:[1,0]
    v_pk_mul_f32 v[78:79], v[78:79], v[14:15] op_sel:[0,0] op_sel_hi:[1,0]
    s_bitcmp1_b32 s43, s42
    s_cbranch_scc1 L2_oa53
L2_ob53:
    buffer_load_dwordx4 v[112:115], v3, s[16:19], s40 offen offset:1024 sc1
    v_sub_u16 v88, v56, v48
    v_and_b32 v89, 3, v48
    v_add3_u32 v99, v88, v89, 3
    v_and_b32 v99, -4, v99
    v_max_u32 v99, 4, v99
    v_and_b32 v97, 0xfffc, v48
    v_bfm_b32 v96, v88, v89
    v_add_u32_dpp v91, v99, v99 row_shr:1 row_mask:0xf bank_mask:0xf bound_ctrl:1
    v_mad_u32_u24 v97, v97, 5, v2
    v_cmp_lt_u32 vcc, 16, v99
    v_add_u32_dpp v91, v91, v91 row_shr:2 row_mask:0xf bank_mask:0xf bound_ctrl:1
    v_sub_u32 v98, s38, v99
    v_lshrrev_b64 v[48:49], 16, v[48:49]
    v_add_u32_dpp v91, v91, v91 row_shr:4 row_mask:0xf bank_mask:0xf bound_ctrl:1
    v_lshrrev_b64 v[56:57], 16, v[56:57]
    s_mov_b32 s101, 0
    v_add_u32_dpp v91, v91, v91 row_shr:8 row_mask:0xf bank_mask:0xf bound_ctrl:1
    s_nop 1
    v_add_u32_dpp v91, v91, v91 row_bcast:15 row_mask:0xa bank_mask:0xf
    s_nop 1
    v_add_u32_dpp v91, v91, v91 row_bcast:31 row_mask:0xc bank_mask:0xf
    v_add_u32 v98, v98, v91
    v_readlane_b32 s37, v91, 63
    s_cbranch_vccnz L2_xo54
L2_xp54:
    v_and_b32 v46, 0x80000000, v27
    v_lshrrev_b32 v47, 14, v25
    v_bitop3_b32 v47, v47, v5, v46 bitop3:0xea
    ds_read_b64 v[106:107], v47
    v_and_b32 v99, 0x40000000, v27
    v_lshrrev_b32 v47, 14, v24
    v_bitop3_b32 v47, v47, v5, v99 bitop3:0xea
    ds_read_b64 v[104:105], v47
    s_waitcnt lgkmcnt(2)
    v_cmp_ne_u64 s[50:51], v[72:73], v[68:69]
    v_cmpx_ne_u64 s[54:55], v[74:75], v[70:71]
    s_and_b64 s[82:83], s[54:55], s[80:81]
    s_cbranch_scc1 L2_c55
L2_d55:
    v_mov_b64 v[84:85], v[70:71]
    v_mov_b32 v7, v95
    v_mov_b64 v[86:87], v[74:75]
    s_or_b64 s[80:81], s[80:81], s[54:55]
    s_mov_b64 exec, s[50:51]
    s_and_b64 s[82:83], s[50:51], s[80:81]
    s_cbranch_scc1 L2_c56
L2_d56:
    v_mov_b64 v[84:85], v[68:69]
    v_mov_b32 v7, v94
    v_mov_b64 v[86:87], v[72:73]
    s_mov_b64 exec, -1
    s_or_b64 s[80:81], s[80:81], s[50:51]
    ds_read_b64 v[70:71], v93 offset:65408
    ds_read_b64 v[68:69], v92 offset:65408
    v_bitop3_b32 v94, v24, v5, v99 bitop3:0xea
    v_bitop3_b32 v95, v25, v5, v46 bitop3:0xea
    v_perm_b32 v15, v25, v26, s47
    v_bitop3_b32 v46, v25, 0.5, -0.5 bitop3:0xa8
    v_perm_b32 v14, v24, v26, s46
    v_bitop3_b32 v47, v24, 0.5, -0.5 bitop3:0xa8
    v_bitop3_b32 v15, v6, v15, v46 bitop3:0xca
    v_bitop3_b32 v14, v6, v14, v47 bitop3:0xca
    s_waitcnt lgkmcnt(1)
    v_mfma_f32_4x4x4_16b_bf16 v[80:83], v[10:11], v[70:71], v[80:83]
    s_waitcnt lgkmcnt(0)
    v_mfma_f32_4x4x4_16b_bf16 v[76:79], v[10:11], v[68:69], v[76:79]
    s_nop 2
    v_cvt_pk_bf16_f32 v80, v80, v81
    v_cvt_pk_bf16_f32 v81, v82, v83
    ds_wrxchg_rtn_b64 v[74:75], v93, v[80:81] offset:65408
    v_cvt_pk_bf16_f32 v76, v76, v77
    v_cvt_pk_bf16_f32 v77, v78, v79
    ds_wrxchg_rtn_b64 v[72:73], v92, v[76:77] offset:65408
    v_and_b32 v88, 0x0fffffff, v41
    buffer_load_dwordx2 v[22:23], v88, s[8:11], 0 offen
    buffer_load_dwordx3 v[24:26], v88, s[8:11], 0 offen offset:8
    s_setprio 1
    v_mfma_f32_4x4x4_16b_bf16 v[80:83], v[8:9], v[106:107], 0
    v_mfma_f32_4x4x4_16b_bf16 v[76:79], v[8:9], v[104:105], 0
    v_cmp_lt_u32 s[84:85], v5, v94
    s_nop 2
    v_pk_mul_f32 v[80:81], v[80:81], v[14:15] op_sel:[0,1] op_sel_hi:[1,1]
    v_pk_mul_f32 v[82:83], v[82:83], v[14:15] op_sel:[0,1] op_sel_hi:[1,1]
    v_pk_mul_f32 v[76:77], v[76:77], v[14:15] op_sel:[0,0] op_sel_hi:[1,0]
    v_pk_mul_f32 v[78:79], v[78:79], v[14:15] op_sel:[0,0] op_sel_hi:[1,0]
    s_waitcnt vmcnt(11)
    s_mov_b64 exec, s[6:7]
    v_lshrrev_b32 v30, 16, v30
    s_mov_b64 exec, -1
    v_and_b32 v46, 0x20000000, v31
    v_lshrrev_b32 v47, 14, v29
    v_bitop3_b32 v47, v47, v5, v46 bitop3:0xea
    ds_read_b64 v[102:103], v47
    v_and_b32 v99, 0x10000000, v31
    v_lshrrev_b32 v47, 14, v28
    v_bitop3_b32 v47, v47, v5, v99 bitop3:0xea
    ds_read_b64 v[100:101], v47
    s_waitcnt lgkmcnt(2)
    v_cmp_ne_u64 s[50:51], v[72:73], v[68:69]
    v_cmpx_ne_u64 s[54:55], v[74:75], v[70:71]
    s_and_b64 s[82:83], s[54:55], s[80:81]
    s_cbranch_scc1 L2_c57
L2_d57:
    v_mov_b64 v[84:85], v[70:71]
    v_mov_b32 v7, v93
    v_mov_b64 v[86:87], v[74:75]
    s_or_b64 s[80:81], s[80:81], s[54:55]
    s_mov_b64 exec, s[50:51]
    s_and_b64 s[82:83], s[50:51], s[80:81]
    s_cbranch_scc1 L2_c58
L2_d58:
    v_mov_b64 v[84:85], v[68:69]
    v_mov_b32 v7, v92
    v_mov_b64 v[86:87], v[72:73]
    s_mov_b64 exec, -1
    s_or_b64 s[80:81], s[80:81], s[50:51]
    s_and_b64 exec, s[84:85], s[80:81]
    v_mfma_f32_4x4x4_16b_bf16 v[76:79], v[12:13], v[84:85], 0
    v_mov_b32 v94, v7
    s_andn2_b64 s[80:81], s[80:81], s[84:85]
    v_mfma_f32_4x4x4_16b_bf16 v[76:79], v[10:11], v[86:87], v[76:79]
    s_mov_b64 exec, -1
    ds_read_b64 v[70:71], v95 offset:65408
    ds_read_b64 v[68:69], v94 offset:65408
    v_bitop3_b32 v92, v28, v5, v99 bitop3:0xea
    v_bitop3_b32 v93, v29, v5, v46 bitop3:0xea
    v_perm_b32 v15, v29, v30, s45
    v_bitop3_b32 v46, v29, 0.5, -0.5 bitop3:0xa8
    v_perm_b32 v14, v28, v30, s44
    v_bitop3_b32 v47, v28, 0.5, -0.5 bitop3:0xa8
    v_bitop3_b32 v15, v6, v15, v46 bitop3:0xca
    v_bitop3_b32 v14, v6, v14, v47 bitop3:0xca
    s_waitcnt lgkmcnt(1)
    v_mfma_f32_4x4x4_16b_bf16 v[80:83], v[10:11], v[70:71], v[80:83]
    s_waitcnt lgkmcnt(0)
    v_mfma_f32_4x4x4_16b_bf16 v[76:79], v[10:11], v[68:69], v[76:79]
    s_nop 2
    v_cvt_pk_bf16_f32 v80, v80, v81
    v_cvt_pk_bf16_f32 v81, v82, v83
    ds_wrxchg_rtn_b64 v[74:75], v95, v[80:81] offset:65408
    v_cvt_pk_bf16_f32 v76, v76, v77
    v_cvt_pk_bf16_f32 v77, v78, v79
    ds_wrxchg_rtn_b64 v[72:73], v94, v[76:77] offset:65408
    s_setprio 0
    v_mfma_f32_4x4x4_16b_bf16 v[80:83], v[8:9], v[102:103], 0
    v_mfma_f32_4x4x4_16b_bf16 v[76:79], v[8:9], v[100:101], 0
    v_cmp_lt_u32 s[48:49], v5, v93
    s_nop 2
    v_pk_mul_f32 v[80:81], v[80:81], v[14:15] op_sel:[0,1] op_sel_hi:[1,1]
    v_pk_mul_f32 v[82:83], v[82:83], v[14:15] op_sel:[0,1] op_sel_hi:[1,1]
    v_pk_mul_f32 v[76:77], v[76:77], v[14:15] op_sel:[0,0] op_sel_hi:[1,0]
    v_pk_mul_f32 v[78:79], v[78:79], v[14:15] op_sel:[0,0] op_sel_hi:[1,0]
    s_add_u32 s40, s40, 0xfff24000
    v_and_b32 v47, 0x0fffffff, v42
    buffer_load_dword v30, v47, s[8:11], 0 offen offset:16
    s_mov_b64 exec, s[6:7]
    v_add_u32 v47, 8, v47
    v_lshrrev_b32 v42, 2, v42
    s_mov_b64 exec, -1
    buffer_load_dwordx2 v[28:29], v47, s[8:11], 0 offen
    s_waitcnt vmcnt(8)
    v_and_b32 v46, 0x80000000, v39
    v_lshrrev_b32 v47, 14, v37
    v_bitop3_b32 v47, v47, v5, v46 bitop3:0xea
    ds_read_b64 v[102:103], v47
    v_and_b32 v99, 0x40000000, v39
    v_lshrrev_b32 v47, 14, v36
    v_bitop3_b32 v47, v47, v5, v99 bitop3:0xea
    ds_read_b64 v[100:101], v47
    v_and_b32 v46, 0x20000000, v39
    v_lshrrev_b32 v47, 14, v35
    v_bitop3_b32 v47, v47, v5, v46 bitop3:0xea
    ds_read_b64 v[106:107], v47
    v_and_b32 v99, 0x10000000, v39
    v_lshrrev_b32 v47, 14, v34
    v_bitop3_b32 v47, v47, v5, v99 bitop3:0xea
    ds_read_b64 v[104:105], v47
    s_waitcnt lgkmcnt(4)
    v_cmp_ne_u64 s[50:51], v[72:73], v[68:69]
    v_cmpx_ne_u64 s[54:55], v[74:75], v[70:71]
    s_and_b64 s[82:83], s[54:55], s[80:81]
    s_cbranch_scc1 L2_c59
L2_d59:
    v_mov_b64 v[84:85], v[70:71]
    v_mov_b32 v7, v95
    v_mov_b64 v[86:87], v[74:75]
    s_or_b64 s[80:81], s[80:81], s[54:55]
    s_mov_b64 exec, s[50:51]
    s_and_b64 s[82:83], s[50:51], s[80:81]
    s_cbranch_scc1 L2_c60
L2_d60:
    v_mov_b64 v[84:85], v[68:69]
    v_mov_b32 v7, v94
    v_mov_b64 v[86:87], v[72:73]
    s_mov_b64 exec, -1
    s_or_b64 s[80:81], s[80:81], s[50:51]
    s_and_b64 exec, s[48:49], s[80:81]
    v_mfma_f32_4x4x4_16b_bf16 v[80:83], v[12:13], v[84:85], 0
    v_mov_b32 v93, v7
    s_andn2_b64 s[80:81], s[80:81], s[48:49]
    v_mfma_f32_4x4x4_16b_bf16 v[80:83], v[10:11], v[86:87], v[80:83]
    s_mov_b64 exec, -1
    ds_read_b64 v[70:71], v93 offset:65408
    ds_read_b64 v[68:69], v92 offset:65408
    v_bitop3_b32 v94, v34, v5, v99 bitop3:0xea
    v_bitop3_b32 v95, v35, v5, v46 bitop3:0xea
    v_perm_b32 v15, v35, v38, s45
    v_bitop3_b32 v46, v35, 0.5, -0.5 bitop3:0xa8
    v_perm_b32 v14, v34, v38, s44
    v_bitop3_b32 v47, v34, 0.5, -0.5 bitop3:0xa8
    v_bitop3_b32 v15, v6, v15, v46 bitop3:0xca
    v_bitop3_b32 v14, v6, v14, v47 bitop3:0xca
    s_waitcnt lgkmcnt(1)
    v_mfma_f32_4x4x4_16b_bf16 v[80:83], v[10:11], v[70:71], v[80:83]
    s_waitcnt lgkmcnt(0)
    v_mfma_f32_4x4x4_16b_bf16 v[76:79], v[10:11], v[68:69], v[76:79]
    s_nop 2
    v_cvt_pk_bf16_f32 v80, v80, v81
    v_cvt_pk_bf16_f32 v81, v82, v83
    ds_wrxchg_rtn_b64 v[74:75], v93, v[80:81] offset:65408
    v_cvt_pk_bf16_f32 v76, v76, v77
    v_cvt_pk_bf16_f32 v77, v78, v79
    ds_wrxchg_rtn_b64 v[72:73], v92, v[76:77] offset:65408
    s_barrier
    s_setprio 3
    s_mov_b32 m0, s100
    s_nop 0
    ds_write_addtid_b32 v124 offset:34816
    ds_write_addtid_b32 v125 offset:35072
    ds_write_addtid_b32 v126 offset:35328
    ds_write_addtid_b32 v127 offset:35584
    s_add_u32 s3, s40, 4096
    buffer_load_dwordx4 v[124:127], v3, s[16:19], s3 offen sc1
    ds_write_addtid_b32 v116 offset:32768
    ds_write_addtid_b32 v117 offset:33024
    ds_write_addtid_b32 v118 offset:33280
    ds_write_addtid_b32 v119 offset:33536
    buffer_load_dwordx4 v[116:119], v3, s[16:19], s40 offen offset:2048 sc1
    ds_write_addtid_b32 v120 offset:33792
    ds_write_addtid_b32 v121 offset:34048
    ds_write_addtid_b32 v122 offset:34304
    ds_write_addtid_b32 v123 offset:34560
    buffer_load_dwordx4 v[120:123], v3, s[16:19], s40 offen offset:3072 sc1
    v_mfma_f32_4x4x4_16b_bf16 v[80:83], v[8:9], v[106:107], 0
    v_mfma_f32_4x4x4_16b_bf16 v[76:79], v[8:9], v[104:105], 0
    s_nop 3
    v_pk_mul_f32 v[80:81], v[80:81], v[14:15] op_sel:[0,1] op_sel_hi:[1,1]
    v_pk_mul_f32 v[82:83], v[82:83], v[14:15] op_sel:[0,1] op_sel_hi:[1,1]
    v_pk_mul_f32 v[76:77], v[76:77], v[14:15] op_sel:[0,0] op_sel_hi:[1,0]
    v_pk_mul_f32 v[78:79], v[78:79], v[14:15] op_sel:[0,0] op_sel_hi:[1,0]
    s_cmp_gt_u32 s37, 1024
    s_cbranch_scc1 L2_xs61
    s_cmp_lg_u32 s101, 0
    s_cbranch_scc1 L2_xa61
L2_xb61:
    v_lshlrev_b32 v89, 16, v96
    v_add_u32 v90, 60, v97
    v_bitop3_b32 v90, v89, v45, v90 bitop3:0x6a
    ds_write_b32 v98, v90 offset:12
    v_lshlrev_b32 v89, 20, v96
    v_add_u32 v90, 40, v97
    v_bitop3_b32 v90, v89, v45, v90 bitop3:0x6a
    ds_write_b32 v98, v90 offset:8
    v_lshlrev_b32 v89, 24, v96
    v_add_u32 v90, 20, v97
    v_bitop3_b32 v90, v89, v45, v90 bitop3:0x6a
    ds_write_b32 v98, v90 offset:4
    v_lshlrev_b32 v89, 28, v96
    v_bitop3_b32 v90, v89, v45, v97 bitop3:0x6a
    ds_write_b32 v98, v90 offset:0
    v_mov_b32_dpp v91, v64 quad_perm:[0,0,0,0] row_mask:0xf bank_mask:0xf
    v_and_b32 v89, 3, v91
    v_and_b32 v97, 0xfffc, v91
    v_sub_u16_dpp v88, v64, v91 quad_perm:[2,2,2,2] row_mask:0xf bank_mask:0xf
    v_mad_u32_u24 v97, v97, 5, v4
    v_add_u32 v99, v88, v89
    v_bfm_b32 v96, v88, v89
    v_cmp_lt_u32 s[58:59], 16, v99
    v_lshlrev_b32 v89, v1, v96
    v_and_b32 v89, v45, v89
    v_cmp_ne_u32 vcc, 0, v89
    v_xor_b32 v90, v97, v89
    s_add_u32 s3, s37, s38
    v_mbcnt_lo_u32_b32 v98, vcc_lo, 0
    v_mbcnt_hi_u32_b32 v98, vcc_hi, v98
    s_bcnt1_i32_b64 s41, vcc
    v_lshl_add_u32 v98, v98, 2, s3
    s_lshl2_add_u32 s37, s41, s37
    s_mov_b64 exec, vcc
    ds_write_b32 v98, v90
    s_mov_b64 exec, -1
    s_cmp_lg_u64 s[58:59], 0
    s_cbranch_scc1 L2_xe61
L2_xr61:
    v_add_u32 v98, s37, v0
    v_mov_b32 v90, -1
    ds_write_b32 v98, v90
L2_xw61:
    s_setprio 2
    s_waitcnt lgkmcnt(14)
    v_cmp_ne_u64 s[50:51], v[72:73], v[68:69]
    v_cmpx_ne_u64 s[54:55], v[74:75], v[70:71]
    s_and_b64 s[82:83], s[54:55], s[80:81]
    s_cbranch_scc1 L2_c62
L2_d62:
    v_mov_b64 v[84:85], v[70:71]
    v_mov_b32 v7, v93
    v_mov_b64 v[86:87], v[74:75]
    s_or_b64 s[80:81], s[80:81], s[54:55]
    s_mov_b64 exec, s[50:51]
    s_and_b64 s[82:83], s[50:51], s[80:81]
    s_cbranch_scc1 L2_c63
L2_d63:
    v_mov_b64 v[84:85], v[68:69]
    v_mov_b32 v7, v92
    v_mov_b64 v[86:87], v[72:73]
    s_mov_b64 exec, -1
    s_or_b64 s[80:81], s[80:81], s[50:51]
    ds_read_b64 v[70:71], v95 offset:65408
    ds_read_b64 v[68:69], v94 offset:65408
    v_and_b32 v46, 0x40000000, v39
    v_bitop3_b32 v92, v36, v5, v46 bitop3:0xea
    v_and_b32 v46, 0x80000000, v39
    v_bitop3_b32 v93, v37, v5, v46 bitop3:0xea
    v_perm_b32 v15, v37, v38, s47
    v_bitop3_b32 v46, v37, 0.5, -0.5 bitop3:0xa8
    v_perm_b32 v14, v36, v38, s46
    v_bitop3_b32 v47, v36, 0.5, -0.5 bitop3:0xa8
    v_bitop3_b32 v15, v6, v15, v46 bitop3:0xca
    v_bitop3_b32 v14, v6, v14, v47 bitop3:0xca
    s_setprio 1
    s_waitcnt lgkmcnt(1)
    v_mfma_f32_4x4x4_16b_bf16 v[80:83], v[10:11], v[70:71], v[80:83]
    s_waitcnt lgkmcnt(0)
    v_mfma_f32_4x4x4_16b_bf16 v[76:79], v[10:11], v[68:69], v[76:79]
    s_nop 2
    v_cvt_pk_bf16_f32 v80, v80, v81
    v_cvt_pk_bf16_f32 v81, v82, v83
    ds_wrxchg_rtn_b64 v[74:75], v95, v[80:81] offset:65408
    v_cvt_pk_bf16_f32 v76, v76, v77
    v_cvt_pk_bf16_f32 v77, v78, v79
    ds_wrxchg_rtn_b64 v[72:73], v94, v[76:77] offset:65408
    ds_read_b32 v21, v0 offset:0
    ds_read_b32 v27, v0 offset:256
    ds_read_b32 v31, v44 offset:768
    ds_read_b32 v39, v0 offset:512
    s_sub_u32 s3, s37, 768
    s_cmp_gt_u32 s3, 128
    s_cbranch_scc1 L2_xf61
L2_xg61:
    v_and_b32 v88, 0x0fffffff, v43
    buffer_load_dwordx2 v[34:35], v88, s[8:11], 0 offen
    buffer_load_dwordx3 v[36:38], v88, s[8:11], 0 offen offset:8
    s_setprio 0
    s_waitcnt vmcnt(12)
    s_mov_b32 m0, s38
    s_nop 0
    ds_write_addtid_b32 v108 offset:0
    ds_write_addtid_b32 v109 offset:256
    ds_write_addtid_b32 v110 offset:512
    ds_write_addtid_b32 v111 offset:768
    s_waitcnt vmcnt(9)
    ds_write_addtid_b32 v112 offset:1024
    ds_write_addtid_b32 v113 offset:1280
    ds_write_addtid_b32 v114 offset:1536
    ds_write_addtid_b32 v115 offset:1792
    v_mfma_f32_4x4x4_16b_bf16 v[80:83], v[8:9], v[102:103], 0
    v_mfma_f32_4x4x4_16b_bf16 v[76:79], v[8:9], v[100:101], 0
    v_cmp_lt_u32 s[84:85], v5, v92
    s_nop 2
    v_pk_mul_f32 v[80:81], v[80:81], v[14:15] op_sel:[0,1] op_sel_hi:[1,1]
    v_pk_mul_f32 v[82:83], v[82:83], v[14:15] op_sel:[0,1] op_sel_hi:[1,1]
    v_pk_mul_f32 v[76:77], v[76:77], v[14:15] op_sel:[0,0] op_sel_hi:[1,0]
    v_pk_mul_f32 v[78:79], v[78:79], v[14:15] op_sel:[0,0] op_sel_hi:[1,0]
    s_add_u32 s42, s42, 1
    s_waitcnt lgkmcnt(0)
    s_barrier
    s_bitcmp1_b32 s36, s42
    s_cbranch_scc1 L2_slow
L2_ret3:
    s_setprio 3
    s_bitcmp1_b32 s43, s42
    s_cbranch_scc1 L2_oa64
L2_ob64:
    v_and_b32 v46, 0x20000000, v40
    v_lshrrev_b32 v47, 14, v17
    v_bitop3_b32 v47, v47, v5, v46 bitop3:0xea
    ds_read_b64 v[106:107], v47
    v_and_b32 v99, 0x10000000, v40
    v_lshrrev_b32 v47, 14, v16
    v_bitop3_b32 v47, v47, v5, v99 bitop3:0xea
    ds_read_b64 v[104:105], v47
    v_cmp_ne_u64 s[50:51], v[72:73], v[68:69]
    v_cmpx_ne_u64 s[54:55], v[74:75], v[70:71]
    s_and_b64 s[82:83], s[54:55], s[80:81]
    s_cbranch_scc1 L2_c65
L2_d65:
    v_mov_b64 v[84:85], v[70:71]
    v_mov_b32 v7, v95
    v_mov_b64 v[86:87], v[74:75]
    s_or_b64 s[80:81], s[80:81], s[54:55]
    s_mov_b64 exec, s[50:51]
    s_and_b64 s[82:83], s[50:51], s[80:81]
    s_cbranch_scc1 L2_c66
L2_d66:
    v_mov_b64 v[84:85], v[68:69]
    v_mov_b32 v7, v94
    v_mov_b64 v[86:87], v[72:73]
    s_mov_b64 exec, -1
    s_or_b64 s[80:81], s[80:81], s[50:51]
    s_and_b64 exec, s[84:85], s[80:81]
    v_mfma_f32_4x4x4_16b_bf16 v[76:79], v[12:13], v[84:85], 0
    v_mov_b32 v92, v7
    s_andn2_b64 s[80:81], s[80:81], s[84:85]
    v_mfma_f32_4x4x4_16b_bf16 v[76:79], v[10:11], v[86:87], v[76:79]
    s_mov_b64 exec, -1
    ds_read_b64 v[70:71], v93 offset:65408
    ds_read_b64 v[68:69], v92 offset:65408
    v_bitop3_b32 v94, v16, v5, v99 bitop3:0xea
    v_bitop3_b32 v95, v17, v5, v46 bitop3:0xea
    v_perm_b32 v15, v17, v20, s45
    v_bitop3_b32 v46, v17, 0.5, -0.5 bitop3:0xa8
    v_perm_b32 v14, v16, v20, s44
    v_bitop3_b32 v47, v16, 0.5, -0.5 bitop3:0xa8
    v_bitop3_b32 v15, v6, v15, v46 bitop3:0xca
    v_bitop3_b32 v14, v6, v14, v47 bitop3:0xca
    s_waitcnt lgkmcnt(1)
    v_mfma_f32_4x4x4_16b_bf16 v[80:83], v[10:11], v[70:71], v[80:83]
    s_waitcnt lgkmcnt(0)
    v_mfma_f32_4x4x4_16b_bf16 v[76:79], v[10:11], v[68:69], v[76:79]
    s_nop 2
    v_cvt_pk_bf16_f32 v80, v80, v81
    v_cvt_pk_bf16_f32 v81, v82, v83
    ds_wrxchg_rtn_b64 v[74:75], v93, v[80:81] offset:65408
    v_cvt_pk_bf16_f32 v76, v76, v77
    v_cvt_pk_bf16_f32 v77, v78, v79
    ds_wrxchg_rtn_b64 v[72:73], v92, v[76:77] offset:65408
    v_mfma_f32_4x4x4_16b_bf16 v[80:83], v[8:9], v[106:107], 0
    v_mfma_f32_4x4x4_16b_bf16 v[76:79], v[8:9], v[104:105], 0
    v_cmp_lt_u32 s[84:85], v5, v94
    s_nop 2
    v_pk_mul_f32 v[80:81], v[80:81], v[14:15] op_sel:[0,1] op_sel_hi:[1,1]
    v_pk_mul_f32 v[82:83], v[82:83], v[14:15] op_sel:[0,1] op_sel_hi:[1,1]
    v_pk_mul_f32 v[76:77], v[76:77], v[14:15] op_sel:[0,0] op_sel_hi:[1,0]
    v_pk_mul_f32 v[78:79], v[78:79], v[14:15] op_sel:[0,0] op_sel_hi:[1,0]
    buffer_load_dwordx4 v[108:111], v3, s[16:19], s40 offen offset:0 sc1
    v_and_b32 v46, 0x80000000, v40
    v_lshrrev_b32 v47, 14, v19
    v_bitop3_b32 v47, v47, v5, v46 bitop3:0xea
    ds_read_b64 v[102:103], v47
    v_and_b32 v99, 0x40000000, v40
    v_lshrrev_b32 v47, 14, v18
    v_bitop3_b32 v47, v47, v5, v99 bitop3:0xea
    ds_read_b64 v[100:101], v47
    s_waitcnt lgkmcnt(2)
    v_cmp_ne_u64 s[50:51], v[72:73], v[68:69]
    v_cmpx_ne_u64 s[54:55], v[74:75], v[70:71]
    s_and_b64 s[82:83], s[54:55], s[80:81]
    s_cbranch_scc1 L2_c67
L2_d67:
    v_mov_b64 v[84:85], v[70:71]
    v_mov_b32 v7, v93
    v_mov_b64 v[86:87], v[74:75]
    s_or_b64 s[80:81], s[80:81], s[54:55]
    s_mov_b64 exec, s[50:51]
    s_and_b64 s[82:83], s[50:51], s[80:81]
    s_cbranch_scc1 L2_c68
L2_d68:
    v_mov_b64 v[84:85], v[68:69]
    v_mov_b32 v7, v92
    v_mov_b64 v[86:87], v[72:73]
    s_mov_b64 exec, -1
    s_or_b64 s[80:81], s[80:81], s[50:51]
    s_and_b64 exec, s[84:85], s[80:81]
    v_mfma_f32_4x4x4_16b_bf16 v[76:79], v[12:13], v[84:85], 0
    v_mov_b32 v94, v7
    s_andn2_b64 s[80:81], s[80:81], s[84:85]
    v_mfma_f32_4x4x4_16b_bf16 v[76:79], v[10:11], v[86:87], v[76:79]
    s_mov_b64 exec, -1
    ds_read_b64 v[70:71], v95 offset:65408
    ds_read_b64 v[68:69], v94 offset:65408
    v_bitop3_b32 v92, v18, v5, v99 bitop3:0xea
    v_bitop3_b32 v93, v19, v5, v46 bitop3:0xea
    v_perm_b32 v15, v19, v20, s47
    v_bitop3_b32 v46, v19, 0.5, -0.5 bitop3:0xa8
    v_perm_b32 v14, v18, v20, s46
    v_bitop3_b32 v47, v18, 0.5, -0.5 bitop3:0xa8
    v_bitop3_b32 v15, v6, v15, v46 bitop3:0xca
    v_bitop3_b32 v14, v6, v14, v47 bitop3:0xca
    s_waitcnt lgkmcnt(1)
    v_mfma_f32_4x4x4_16b_bf16 v[80:83], v[10:11], v[70:71], v[80:83]
    s_waitcnt lgkmcnt(0)
    v_mfma_f32_4x4x4_16b_bf16 v[76:79], v[10:11], v[68:69], v[76:79]
    s_nop 2
    v_cvt_pk_bf16_f32 v80, v80, v81
    v_cvt_pk_bf16_f32 v81, v82, v83
    ds_wrxchg_rtn_b64 v[74:75], v95, v[80:81] offset:65408
    v_cvt_pk_bf16_f32 v76, v76, v77
    v_cvt_pk_bf16_f32 v77, v78, v79
    ds_wrxchg_rtn_b64 v[72:73], v94, v[76:77] offset:65408
    v_and_b32 v88, 0x0fffffff, v21
    buffer_load_dwordx2 v[16:17], v88, s[8:11], 0 offen
    buffer_load_dwordx3 v[18:20], v88, s[8:11], 0 offen offset:8
    v_mfma_f32_4x4x4_16b_bf16 v[80:83], v[8:9], v[102:103], 0
    v_mfma_f32_4x4x4_16b_bf16 v[76:79], v[8:9], v[100:101], 0
    v_cmp_lt_u32 s[48:49], v5, v93
    s_nop 2
    v_pk_mul_f32 v[80:81], v[80:81], v[14:15] op_sel:[0,1] op_sel_hi:[1,1]
    v_pk_mul_f32 v[82:83], v[82:83], v[14:15] op_sel:[0,1] op_sel_hi:[1,1]
    v_pk_mul_f32 v[76:77], v[76:77], v[14:15] op_sel:[0,0] op_sel_hi:[1,0]
    v_pk_mul_f32 v[78:79], v[78:79], v[14:15] op_sel:[0,0] op_sel_hi:[1,0]
    s_waitcnt vmcnt(10)
    v_and_b32 v46, 0x20000000, v41
    v_lshrrev_b32 v47, 14, v23
    v_bitop3_b32 v47, v47, v5, v46 bitop3:0xea
    ds_read_b64 v[106:107], v47
    v_and_b32 v99, 0x10000000, v41
    v_lshrrev_b32 v47, 14, v22
    v_bitop3_b32 v47, v47, v5, v99 bitop3:0xea
    ds_read_b64 v[104:105], v47
    s_waitcnt lgkmcnt(2)
    v_cmp_ne_u64 s[50:51], v[72:73], v[68:69]
    v_cmpx_ne_u64 s[54:55], v[74:75], v[70:71]
    s_and_b64 s[82:83], s[54:55], s[80:81]
    s_cbranch_scc1 L2_c69
L2_d69:
    v_mov_b64 v[84:85], v[70:71]
    v_mov_b32 v7, v95
    v_mov_b64 v[86:87], v[74:75]
    s_or_b64 s[80:81], s[80:81], s[54:55]
    s_mov_b64 exec, s[50:51]
    s_and_b64 s[82:83], s[50:51], s[80:81]
    s_cbranch_scc1 L2_c70
L2_d70:
    v_mov_b64 v[84:85], v[68:69]
    v_mov_b32 v7, v94
    v_mov_b64 v[86:87], v[72:73]
    s_mov_b64 exec, -1
    s_or_b64 s[80:81], s[80:81], s[50:51]
    s_and_b64 exec, s[48:49], s[80:81]
    v_mfma_f32_4x4x4_16b_bf16 v[80:83], v[12:13], v[84:85], 0
    v_mov_b32 v93, v7
    s_andn2_b64 s[80:81], s[80:81], s[48:49]
    v_mfma_f32_4x4x4_16b_bf16 v[80:83], v[10:11], v[86:87], v[80:83]
    s_mov_b64 exec, -1
    ds_read_b64 v[70:71], v93 offset:65408
    ds_read_b64 v[68:69], v92 offset:65408
    v_bitop3_b32 v94, v22, v5, v99 bitop3:0xea
    v_bitop3_b32 v95, v23, v5, v46 bitop3:0xea
    v_perm_b32 v15, v23, v26, s45
    v_bitop3_b32 v46, v23, 0.5, -0.5 bitop3:0xa8
    v_perm_b32 v14, v22, v26, s44
    v_bitop3_b32 v47, v22, 0.5, -0.5 bitop3:0xa8
    v_bitop3_b32 v15, v6, v15, v46 bitop3:0xca
    v_bitop3_b32 v14, v6, v14, v47 bitop3:0xca
    s_waitcnt lgkmcnt(1)
    v_mfma_f32_4x4x4_16b_bf16 v[80:83], v[10:11], v[70:71], v[80:83]
    s_waitcnt lgkmcnt(0)
    v_mfma_f32_4x4x4_16b_bf16 v[76:79], v[10:11], v[68:69], v[76:79]
    s_nop 2
    v_cvt_pk_bf16_f32 v80, v80, v81
    v_cvt_pk_bf16_f32 v81, v82, v83
    ds_wrxchg_rtn_b64 v[74:75], v93, v[80:81] offset:65408
    v_cvt_pk_bf16_f32 v76, v76, v77
    v_cvt_pk_bf16_f32 v77, v78, v79
    ds_wrxchg_rtn_b64 v[72:73], v92, v[76:77] offset:65408
    s_setprio 2
    v_mfma_f32_4x4x4_16b_bf16 v[80:83], v[8:9], v[106:107], 0
    v_mfma_f32_4x4x4_16b_bf16 v[76:79], v[8:9], v[104:105], 0
    s_nop 3
    v_pk_mul_f32 v[80:81], v[80:81], v[14:15] op_sel:[0,1] op_sel_hi:[1,1]
    v_pk_mul_f32 v[82:83], v[82:83], v[14:15] op_sel:[0,1] op_sel_hi:[1,1]
    v_pk_mul_f32 v[76:77], v[76:77], v[14:15] op_sel:[0,0] op_sel_hi:[1,0]
    v_pk_mul_f32 v[78:79], v[78:79], v[14:15] op_sel:[0,0] op_sel_hi:[1,0]
    s_bitcmp1_b32 s43, s42
    s_cbranch_scc1 L2_oa71
L2_ob71:
    buffer_load_dwordx4 v[112:115], v3, s[16:19], s40 offen offset:1024 sc1
    v_sub_u16 v88, v58, v50
    v_and_b32 v89, 3, v50
    v_add3_u32 v99, v88, v89, 3
    v_and_b32 v99, -4, v99
    v_max_u32 v99, 4, v99
    v_and_b32 v97, 0xfffc, v50
    v_bfm_b32 v96, v88, v89
    v_add_u32_dpp v91, v99, v99 row_shr:1 row_mask:0xf bank_mask:0xf bound_ctrl:1
    v_mad_u32_u24 v97, v97, 5, v2
    v_cmp_lt_u32 vcc, 16, v99
    v_add_u32_dpp v91, v91, v91 row_shr:2 row_mask:0xf bank_mask:0xf bound_ctrl:1
    v_sub_u32 v98, s38, v99
    v_lshrrev_b64 v[50:51], 16, v[50:51]
    v_add_u32_dpp v91, v91, v91 row_shr:4 row_mask:0xf bank_mask:0xf bound_ctrl:1
    v_lshrrev_b64 v[58:59], 16, v[58:59]
    s_mov_b32 s101, 0
    v_add_u32_dpp v91, v91, v91 row_shr:8 row_mask:0xf bank_mask:0xf bound_ctrl:1
    s_nop 1
    v_add_u32_dpp v91, v91, v91 row_bcast:15 row_mask:0xa bank_mask:0xf
    s_nop 1
    v_add_u32_dpp v91, v91, v91 row_bcast:31 row_mask:0xc bank_mask:0xf
    v_add_u32 v98, v98, v91
    v_readlane_b32 s37, v91, 63
    s_cbranch_vccnz L2_xo72
L2_xp72:
    v_and_b32 v46, 0x80000000, v41
    v_lshrrev_b32 v47, 14, v25
    v_bitop3_b32 v47, v47, v5, v46 bitop3:0xea
    ds_read_b64 v[102:103], v47
    v_and_b32 v99, 0x40000000, v41
    v_lshrrev_b32 v47, 14, v24
    v_bitop3_b32 v47, v47, v5, v99 bitop3:0xea
    ds_read_b64 v[100:101], v47
    s_waitcnt lgkmcnt(2)
    v_cmp_ne_u64 s[50:51], v[72:73], v[68:69]
    v_cmpx_ne_u64 s[54:55], v[74:75], v[70:71]
    s_and_b64 s[82:83], s[54:55], s[80:81]
    s_cbranch_scc1 L2_c73
L2_d73:
    v_mov_b64 v[84:85], v[70:71]
    v_mov_b32 v7, v93
    v_mov_b64 v[86:87], v[74:75]
    s_or_b64 s[80:81], s[80:81], s[54:55]
    s_mov_b64 exec, s[50:51]
    s_and_b64 s[82:83], s[50:51], s[80:81]
    s_cbranch_scc1 L2_c74
L2_d74:
    v_mov_b64 v[84:85], v[68:69]
    v_mov_b32 v7, v92
    v_mov_b64 v[86:87], v[72:73]
    s_mov_b64 exec, -1
    s_or_b64 s[80:81], s[80:81], s[50:51]
    ds_read_b64 v[70:71], v95 offset:65408
    ds_read_b64 v[68:69], v94 offset:65408
    v_bitop3_b32 v92, v24, v5, v99 bitop3:0xea
    v_bitop3_b32 v93, v25, v5, v46 bitop3:0xea
    v_perm_b32 v15, v25, v26, s47
    v_bitop3_b32 v46, v25, 0.5, -0.5 bitop3:0xa8
    v_perm_b32 v14, v24, v26, s46
    v_bitop3_b32 v47, v24, 0.5, -0.5 bitop3:0xa8
    v_bitop3_b32 v15, v6, v15, v46 bitop3:0xca
    v_bitop3_b32 v14, v6, v14, v47 bitop3:0xca
    s_waitcnt lgkmcnt(1)
    v_mfma_f32_4x4x4_16b_bf16 v[80:83], v[10:11], v[70:71], v[80:83]
    s_waitcnt lgkmcnt(0)
    v_mfma_f32_4x4x4_16b_bf16 v[76:79], v[10:11], v[68:69], v[76:79]
    s_nop 2
    v_cvt_pk_bf16_f32 v80, v80, v81
    v_cvt_pk_bf16_f32 v81, v82, v83
    ds_wrxchg_rtn_b64 v[74:75], v95, v[80:81] offset:65408
    v_cvt_pk_bf16_f32 v76, v76, v77
    v_cvt_pk_bf16_f32 v77, v78, v79
    ds_wrxchg_rtn_b64 v[72:73], v94, v[76:77] offset:65408
    v_and_b32 v88, 0x0fffffff, v27
    buffer_load_dwordx2 v[22:23], v88, s[8:11], 0 offen
    buffer_load_dwordx3 v[24:26], v88, s[8:11], 0 offen offset:8
    s_setprio 1
    v_mfma_f32_4x4x4_16b_bf16 v[80:83], v[8:9], v[102:103], 0
    v_mfma_f32_4x4x4_16b_bf16 v[76:79], v[8:9], v[100:101], 0
    v_cmp_lt_u32 s[84:85], v5, v92
    s_nop 2
    v_pk_mul_f32 v[80:81], v[80:81], v[14:15] op_sel:[0,1] op_sel_hi:[1,1]
    v_pk_mul_f32 v[82:83], v[82:83], v[14:15] op_sel:[0,1] op_sel_hi:[1,1]
    v_pk_mul_f32 v[76:77], v[76:77], v[14:15] op_sel:[0,0] op_sel_hi:[1,0]
    v_pk_mul_f32 v[78:79], v[78:79], v[14:15] op_sel:[0,0] op_sel_hi:[1,0]
    s_waitcnt vmcnt(11)
    s_mov_b64 exec, s[6:7]
    v_lshrrev_b32 v30, 16, v30
    s_mov_b64 exec, -1
    v_and_b32 v46, 0x20000000, v42
    v_lshrrev_b32 v47, 14, v29
    v_bitop3_b32 v47, v47, v5, v46 bitop3:0xea
    ds_read_b64 v[106:107], v47
    v_and_b32 v99, 0x10000000, v42
    v_lshrrev_b32 v47, 14, v28
    v_bitop3_b32 v47, v47, v5, v99 bitop3:0xea
    ds_read_b64 v[104:105], v47
    s_waitcnt lgkmcnt(2)
    v_cmp_ne_u64 s[50:51], v[72:73], v[68:69]
    v_cmpx_ne_u64 s[54:55], v[74:75], v[70:71]
    s_and_b64 s[82:83], s[54:55], s[80:81]
    s_cbranch_scc1 L2_c75
L2_d75:
    v_mov_b64 v[84:85], v[70:71]
    v_mov_b32 v7, v95
    v_mov_b64 v[86:87], v[74:75]
    s_or_b64 s[80:81], s[80:81], s[54:55]
    s_mov_b64 exec, s[50:51]
    s_and_b64 s[82:83], s[50:51], s[80:81]
    s_cbranch_scc1 L2_c76
L2_d76:
    v_mov_b64 v[84:85], v[68:69]
    v_mov_b32 v7, v94
    v_mov_b64 v[86:87], v[72:73]
    s_mov_b64 exec, -1
    s_or_b64 s[80:81], s[80:81], s[50:51]
    s_and_b64 exec, s[84:85], s[80:81]
    v_mfma_f32_4x4x4_16b_bf16 v[76:79], v[12:13], v[84:85], 0
    v_mov_b32 v92, v7
    s_andn2_b64 s[80:81], s[80:81], s[84:85]
    v_mfma_f32_4x4x4_16b_bf16 v[76:79], v[10:11], v[86:87], v[76:79]
    s_mov_b64 exec, -1
    ds_read_b64 v[70:71], v93 offset:65408
    ds_read_b64 v[68:69], v92 offset:65408
    v_bitop3_b32 v94, v28, v5, v99 bitop3:0xea
    v_bitop3_b32 v95, v29, v5, v46 bitop3:0xea
    v_perm_b32 v15, v29, v30, s45
    v_bitop3_b32 v46, v29, 0.5, -0.5 bitop3:0xa8
    v_perm_b32 v14, v28, v30, s44
    v_bitop3_b32 v47, v28, 0.5, -0.5 bitop3:0xa8
    v_bitop3_b32 v15, v6, v15, v46 bitop3:0xca
    v_bitop3_b32 v14, v6, v14, v47 bitop3:0xca
    s_waitcnt lgkmcnt(1)
    v_mfma_f32_4x4x4_16b_bf16 v[80:83], v[10:11], v[70:71], v[80:83]
    s_waitcnt lgkmcnt(0)
    v_mfma_f32_4x4x4_16b_bf16 v[76:79], v[10:11], v[68:69], v[76:79]
    s_nop 2
    v_cvt_pk_bf16_f32 v80, v80, v81
    v_cvt_pk_bf16_f32 v81, v82, v83
    ds_wrxchg_rtn_b64 v[74:75], v93, v[80:81] offset:65408
    v_cvt_pk_bf16_f32 v76, v76, v77
    v_cvt_pk_bf16_f32 v77, v78, v79
    ds_wrxchg_rtn_b64 v[72:73], v92, v[76:77] offset:65408
    s_setprio 0
    v_mfma_f32_4x4x4_16b_bf16 v[80:83], v[8:9], v[106:107], 0
    v_mfma_f32_4x4x4_16b_bf16 v[76:79], v[8:9], v[104:105], 0
    v_cmp_lt_u32 s[48:49], v5, v95
    s_nop 2
    v_pk_mul_f32 v[80:81], v[80:81], v[14:15] op_sel:[0,1] op_sel_hi:[1,1]
    v_pk_mul_f32 v[82:83], v[82:83], v[14:15] op_sel:[0,1] op_sel_hi:[1,1]
    v_pk_mul_f32 v[76:77], v[76:77], v[14:15] op_sel:[0,0] op_sel_hi:[1,0]
    v_pk_mul_f32 v[78:79], v[78:79], v[14:15] op_sel:[0,0] op_sel_hi:[1,0]
    s_add_u32 s40, s40, 0x50000
    v_and_b32 v47, 0x0fffffff, v31
    buffer_load_dword v30, v47, s[8:11], 0 offen offset:16
    s_mov_b64 exec, s[6:7]
    v_add_u32 v47, 8, v47
    v_lshrrev_b32 v31, 2, v31
    s_mov_b64 exec, -1
    buffer_load_dwordx2 v[28:29], v47, s[8:11], 0 offen
    s_waitcnt vmcnt(8)
    v_and_b32 v46, 0x80000000, v43
    v_lshrrev_b32 v47, 14, v37
    v_bitop3_b32 v47, v47, v5, v46 bitop3:0xea
    ds_read_b64 v[106:107], v47
    v_and_b32 v99, 0x40000000, v43
    v_lshrrev_b32 v47, 14, v36
    v_bitop3_b32 v47, v47, v5, v99 bitop3:0xea
    ds_read_b64 v[104:105], v47
    v_and_b32 v46, 0x20000000, v43
    v_lshrrev_b32 v47, 14, v35
    v_bitop3_b32 v47, v47, v5, v46 bitop3:0xea
    ds_read_b64 v[102:103], v47
    v_and_b32 v99, 0x10000000, v43
    v_lshrrev_b32 v47, 14, v34
    v_bitop3_b32 v47, v47, v5, v99 bitop3:0xea
    ds_read_b64 v[100:101], v47
    s_waitcnt lgkmcnt(4)
    v_cmp_ne_u64 s[50:51], v[72:73], v[68:69]
    v_cmpx_ne_u64 s[54:55], v[74:75], v[70:71]
    s_and_b64 s[82:83], s[54:55], s[80:81]
    s_cbranch_scc1 L2_c77
L2_d77:
    v_mov_b64 v[84:85], v[70:71]
    v_mov_b32 v7, v93
    v_mov_b64 v[86:87], v[74:75]
    s_or_b64 s[80:81], s[80:81], s[54:55]
    s_mov_b64 exec, s[50:51]
    s_and_b64 s[82:83], s[50:51], s[80:81]
    s_cbranch_scc1 L2_c78
L2_d78:
    v_mov_b64 v[84:85], v[68:69]
    v_mov_b32 v7, v92
    v_mov_b64 v[86:87], v[72:73]
    s_mov_b64 exec, -1
    s_or_b64 s[80:81], s[80:81], s[50:51]
    s_and_b64 exec, s[48:49], s[80:81]
    v_mfma_f32_4x4x4_16b_bf16 v[80:83], v[12:13], v[84:85], 0
    v_mov_b32 v95, v7
    s_andn2_b64 s[80:81], s[80:81], s[48:49]
    v_mfma_f32_4x4x4_16b_bf16 v[80:83], v[10:11], v[86:87], v[80:83]
    s_mov_b64 exec, -1
    ds_read_b64 v[70:71], v95 offset:65408
    ds_read_b64 v[68:69], v94 offset:65408
    v_bitop3_b32 v92, v34, v5, v99 bitop3:0xea
    v_bitop3_b32 v93, v35, v5, v46 bitop3:0xea
    v_perm_b32 v15, v35, v38, s45
    v_bitop3_b32 v46, v35, 0.5, -0.5 bitop3:0xa8
    v_perm_b32 v14, v34, v38, s44
    v_bitop3_b32 v47, v34, 0.5, -0.5 bitop3:0xa8
    v_bitop3_b32 v15, v6, v15, v46 bitop3:0xca
    v_bitop3_b32 v14, v6, v14, v47 bitop3:0xca
    s_waitcnt lgkmcnt(1)
    v_mfma_f32_4x4x4_16b_bf16 v[80:83], v[10:11], v[70:71], v[80:83]
    s_waitcnt lgkmcnt(0)
    v_mfma_f32_4x4x4_16b_bf16 v[76:79], v[10:11], v[68:69], v[76:79]
    s_nop 2
    v_cvt_pk_bf16_f32 v80, v80, v81
    v_cvt_pk_bf16_f32 v81, v82, v83
    ds_wrxchg_rtn_b64 v[74:75], v95, v[80:81] offset:65408
    v_cvt_pk_bf16_f32 v76, v76, v77
    v_cvt_pk_bf16_f32 v77, v78, v79
    ds_wrxchg_rtn_b64 v[72:73], v94, v[76:77] offset:65408
    s_barrier
    s_setprio 3
    s_mov_b32 m0, s100
    s_nop 0
    ds_write_addtid_b32 v124 offset:34816
    ds_write_addtid_b32 v125 offset:35072
    ds_write_addtid_b32 v126 offset:35328
    ds_write_addtid_b32 v127 offset:35584
    s_add_u32 s3, s40, 4096
    buffer_load_dwordx4 v[124:127], v3, s[16:19], s3 offen sc1
    ds_write_addtid_b32 v116 offset:32768
    ds_write_addtid_b32 v117 offset:33024
    ds_write_addtid_b32 v118 offset:33280
    ds_write_addtid_b32 v119 offset:33536
    buffer_load_dwordx4 v[116:119], v3, s[16:19], s40 offen offset:2048 sc1
    ds_write_addtid_b32 v120 offset:33792
    ds_write_addtid_b32 v121 offset:34048
    ds_write_addtid_b32 v122 offset:34304
    ds_write_addtid_b32 v123 offset:34560
    buffer_load_dwordx4 v[120:123], v3, s[16:19], s40 offen offset:3072 sc1
    v_mfma_f32_4x4x4_16b_bf16 v[80:83], v[8:9], v[102:103], 0
    v_mfma_f32_4x4x4_16b_bf16 v[76:79], v[8:9], v[100:101], 0
    s_nop 3
    v_pk_mul_f32 v[80:81], v[80:81], v[14:15] op_sel:[0,1] op_sel_hi:[1,1]
    v_pk_mul_f32 v[82:83], v[82:83], v[14:15] op_sel:[0,1] op_sel_hi:[1,1]
    v_pk_mul_f32 v[76:77], v[76:77], v[14:15] op_sel:[0,0] op_sel_hi:[1,0]
    v_pk_mul_f32 v[78:79], v[78:79], v[14:15] op_sel:[0,0] op_sel_hi:[1,0]
    s_cmp_gt_u32 s37, 1024
    s_cbranch_scc1 L2_xs79
    s_cmp_lg_u32 s101, 0
    s_cbranch_scc1 L2_xa79
L2_xb79:
    v_lshlrev_b32 v89, 16, v96
    v_add_u32 v90, 60, v97
    v_bitop3_b32 v90, v89, v45, v90 bitop3:0x6a
    ds_write_b32 v98, v90 offset:12
    v_lshlrev_b32 v89, 20, v96
    v_add_u32 v90, 40, v97
    v_bitop3_b32 v90, v89, v45, v90 bitop3:0x6a
    ds_write_b32 v98, v90 offset:8
    v_lshlrev_b32 v89, 24, v96
    v_add_u32 v90, 20, v97
    v_bitop3_b32 v90, v89, v45, v90 bitop3:0x6a
    ds_write_b32 v98, v90 offset:4
    v_lshlrev_b32 v89, 28, v96
    v_bitop3_b32 v90, v89, v45, v97 bitop3:0x6a
    ds_write_b32 v98, v90 offset:0
    v_mov_b32_dpp v91, v66 quad_perm:[0,0,0,0] row_mask:0xf bank_mask:0xf
    v_and_b32 v89, 3, v91
    v_and_b32 v97, 0xfffc, v91
    v_sub_u16_dpp v88, v66, v91 quad_perm:[2,2,2,2] row_mask:0xf bank_mask:0xf
    v_mad_u32_u24 v97, v97, 5, v4
    v_add_u32 v99, v88, v89
    v_bfm_b32 v96, v88, v89
    v_cmp_lt_u32 s[58:59], 16, v99
    v_lshlrev_b32 v89, v1, v96
    v_and_b32 v89, v45, v89
    v_cmp_ne_u32 vcc, 0, v89
    v_xor_b32 v90, v97, v89
    s_add_u32 s3, s37, s38
    v_mbcnt_lo_u32_b32 v98, vcc_lo, 0
    v_mbcnt_hi_u32_b32 v98, vcc_hi, v98
    s_bcnt1_i32_b64 s41, vcc
    v_lshl_add_u32 v98, v98, 2, s3
    s_lshl2_add_u32 s37, s41, s37
    s_mov_b64 exec, vcc
    ds_write_b32 v98, v90
    s_mov_b64 exec, -1
    s_cmp_lg_u64 s[58:59], 0
    s_cbranch_scc1 L2_xe79
L2_xr79:
    v_add_u32 v98, s37, v0
    v_mov_b32 v90, -1
    ds_write_b32 v98, v90
L2_xw79:
    s_setprio 2
    s_waitcnt lgkmcnt(14)
    v_cmp_ne_u64 s[50:51], v[72:73], v[68:69]
    v_cmpx_ne_u64 s[54:55], v[74:75], v[70:71]
    s_and_b64 s[82:83], s[54:55], s[80:81]
    s_cbranch_scc1 L2_c80
L2_d80:
    v_mov_b64 v[84:85], v[70:71]
    v_mov_b32 v7, v95
    v_mov_b64 v[86:87], v[74:75]
    s_or_b64 s[80:81], s[80:81], s[54:55]
    s_mov_b64 exec, s[50:51]
    s_and_b64 s[82:83], s[50:51], s[80:81]
    s_cbranch_scc1 L2_c81
L2_d81:
    v_mov_b64 v[84:85], v[68:69]
    v_mov_b32 v7, v94
    v_mov_b64 v[86:87], v[72:73]
    s_mov_b64 exec, -1
    s_or_b64 s[80:81], s[80:81], s[50:51]
    ds_read_b64 v[70:71], v93 offset:65408
    ds_read_b64 v[68:69], v92 offset:65408
    v_and_b32 v46, 0x40000000, v43
    v_bitop3_b32 v94, v36, v5, v46 bitop3:0xea
    v_and_b32 v46, 0x80000000, v43
    v_bitop3_b32 v95, v37, v5, v46 bitop3:0xea
    v_perm_b32 v15, v37, v38, s47
    v_bitop3_b32 v46, v37, 0.5, -0.5 bitop3:0xa8
    v_perm_b32 v14, v36, v38, s46
    v_bitop3_b32 v47, v36, 0.5, -0.5 bitop3:0xa8
    v_bitop3_b32 v15, v6, v15, v46 bitop3:0xca
    v_bitop3_b32 v14, v6, v14, v47 bitop3:0xca
    s_setprio 1
    s_waitcnt lgkmcnt(1)
    v_mfma_f32_4x4x4_16b_bf16 v[80:83], v[10:11], v[70:71], v[80:83]
    s_waitcnt lgkmcnt(0)
    v_mfma_f32_4x4x4_16b_bf16 v[76:79], v[10:11], v[68:69], v[76:79]
    s_nop 2
    v_cvt_pk_bf16_f32 v80, v80, v81
    v_cvt_pk_bf16_f32 v81, v82, v83
    ds_wrxchg_rtn_b64 v[74:75], v93, v[80:81] offset:65408
    v_cvt_pk_bf16_f32 v76, v76, v77
    v_cvt_pk_bf16_f32 v77, v78, v79
    ds_wrxchg_rtn_b64 v[72:73], v92, v[76:77] offset:65408
    ds_read_b32 v40, v0 offset:0
    ds_read_b32 v41, v0 offset:256
    ds_read_b32 v42, v44 offset:768
    ds_read_b32 v43, v0 offset:512
    s_sub_u32 s3, s37, 768
    s_cmp_gt_u32 s3, 128
    s_cbranch_scc1 L2_xf79
L2_xg79:
    v_and_b32 v88, 0x0fffffff, v39
    buffer_load_dwordx2 v[34:35], v88, s[8:11], 0 offen
    buffer_load_dwordx3 v[36:38], v88, s[8:11], 0 offen offset:8
    s_setprio 0
    s_waitcnt vmcnt(12)
    s_mov_b32 m0, s38
    s_nop 0
    ds_write_addtid_b32 v108 offset:0
    ds_write_addtid_b32 v109 offset:256
    ds_write_addtid_b32 v110 offset:512
    ds_write_addtid_b32 v111 offset:768
    s_waitcnt vmcnt(9)
    ds_write_addtid_b32 v112 offset:1024
    ds_write_addtid_b32 v113 offset:1280
    ds_write_addtid_b32 v114 offset:1536
    ds_write_addtid_b32 v115 offset:1792
    v_mfma_f32_4x4x4_16b_bf16 v[80:83], v[8:9], v[106:107], 0
    v_mfma_f32_4x4x4_16b_bf16 v[76:79], v[8:9], v[104:105], 0
    v_cmp_lt_u32 s[84:85], v5, v94
    s_nop 2
    v_pk_mul_f32 v[80:81], v[80:81], v[14:15] op_sel:[0,1] op_sel_hi:[1,1]
    v_pk_mul_f32 v[82:83], v[82:83], v[14:15] op_sel:[0,1] op_sel_hi:[1,1]
    v_pk_mul_f32 v[76:77], v[76:77], v[14:15] op_sel:[0,0] op_sel_hi:[1,0]
    v_pk_mul_f32 v[78:79], v[78:79], v[14:15] op_sel:[0,0] op_sel_hi:[1,0]
    s_add_u32 s42, s42, 1
    s_waitcnt lgkmcnt(0)
    s_barrier
    s_bitcmp1_b32 s36, s42
    s_cbranch_scc1 L2_slow
L2_ret4:
    s_setprio 3
    s_bitcmp1_b32 s43, s42
    s_cbranch_scc1 L2_oa82
L2_ob82:
    v_and_b32 v46, 0x20000000, v21
    v_lshrrev_b32 v47, 14, v17
    v_bitop3_b32 v47, v47, v5, v46 bitop3:0xea
    ds_read_b64 v[102:103], v47
    v_and_b32 v99, 0x10000000, v21
    v_lshrrev_b32 v47, 14, v16
    v_bitop3_b32 v47, v47, v5, v99 bitop3:0xea
    ds_read_b64 v[100:101], v47
    v_cmp_ne_u64 s[50:51], v[72:73], v[68:69]
    v_cmpx_ne_u64 s[54:55], v[74:75], v[70:71]
    s_and_b64 s[82:83], s[54:55], s[80:81]
    s_cbranch_scc1 L2_c83
L2_d83:
    v_mov_b64 v[84:85], v[70:71]
    v_mov_b32 v7, v93
    v_mov_b64 v[86:87], v[74:75]
    s_or_b64 s[80:81], s[80:81], s[54:55]
    s_mov_b64 exec, s[50:51]
    s_and_b64 s[82:83], s[50:51], s[80:81]
    s_cbranch_scc1 L2_c84
L2_d84:
    v_mov_b64 v[84:85], v[68:69]
    v_mov_b32 v7, v92
    v_mov_b64 v[86:87], v[72:73]
    s_mov_b64 exec, -1
    s_or_b64 s[80:81], s[80:81], s[50:51]
    s_and_b64 exec, s[84:85], s[80:81]
    v_mfma_f32_4x4x4_16b_bf16 v[76:79], v[12:13], v[84:85], 0
    v_mov_b32 v94, v7
    s_andn2_b64 s[80:81], s[80:81], s[84:85]
    v_mfma_f32_4x4x4_16b_bf16 v[76:79], v[10:11], v[86:87], v[76:79]
    s_mov_b64 exec, -1
    ds_read_b64 v[70:71], v95 offset:65408
    ds_read_b64 v[68:69], v94 offset:65408
    v_bitop3_b32 v92, v16, v5, v99 bitop3:0xea
    v_bitop3_b32 v93, v17, v5, v46 bitop3:0xea
    v_perm_b32 v15, v17, v20, s45
    v_bitop3_b32 v46, v17, 0.5, -0.5 bitop3:0xa8
    v_perm_b32 v14, v16, v20, s44
    v_bitop3_b32 v47, v16, 0.5, -0.5 bitop3:0xa8
    v_bitop3_b32 v15, v6, v15, v46 bitop3:0xca
    v_bitop3_b32 v14, v6, v14, v47 bitop3:0xca
    s_waitcnt lgkmcnt(1)
    v_mfma_f32_4x4x4_16b_bf16 v[80:83], v[10:11], v[70:71], v[80:83]
    s_waitcnt lgkmcnt(0)
    v_mfma_f32_4x4x4_16b_bf16 v[76:79], v[10:11], v[68:69], v[76:79]
    s_nop 2
    v_cvt_pk_bf16_f32 v80, v80, v81
    v_cvt_pk_bf16_f32 v81, v82, v83
    ds_wrxchg_rtn_b64 v[74:75], v95, v[80:81] offset:65408
    v_cvt_pk_bf16_f32 v76, v76, v77
    v_cvt_pk_bf16_f32 v77, v78, v79
    ds_wrxchg_rtn_b64 v[72:73], v94, v[76:77] offset:65408
    v_mfma_f32_4x4x4_16b_bf16 v[80:83], v[8:9], v[102:103], 0
    v_mfma_f32_4x4x4_16b_bf16 v[76:79], v[8:9], v[100:101], 0
    v_cmp_lt_u32 s[84:85], v5, v92
    s_nop 2
    v_pk_mul_f32 v[80:81], v[80:81], v[14:15] op_sel:[0,1] op_sel_hi:[1,1]
    v_pk_mul_f32 v[82:83], v[82:83], v[14:15] op_sel:[0,1] op_sel_hi:[1,1]
    v_pk_mul_f32 v[76:77], v[76:77], v[14:15] op_sel:[0,0] op_sel_hi:[1,0]
    v_pk_mul_f32 v[78:79], v[78:79], v[14:15] op_sel:[0,0] op_sel_hi:[1,0]
    buffer_load_dwordx4 v[108:111], v3, s[16:19], s40 offen offset:0 sc1
    v_and_b32 v46, 0x80000000, v21
    v_lshrrev_b32 v47, 14, v19
    v_bitop3_b32 v47, v47, v5, v46 bitop3:0xea
    ds_read_b64 v[106:107], v47
    v_and_b32 v99, 0x40000000, v21
    v_lshrrev_b32 v47, 14, v18
    v_bitop3_b32 v47, v47, v5, v99 bitop3:0xea
    ds_read_b64 v[104:105], v47
    s_waitcnt lgkmcnt(2)
    v_cmp_ne_u64 s[50:51], v[72:73], v[68:69]
    v_cmpx_ne_u64 s[54:55], v[74:75], v[70:71]
    s_and_b64 s[82:83], s[54:55], s[80:81]
    s_cbranch_scc1 L2_c85
L2_d85:
    v_mov_b64 v[84:85], v[70:71]
    v_mov_b32 v7, v95
    v_mov_b64 v[86:87], v[74:75]
    s_or_b64 s[80:81], s[80:81], s[54:55]
    s_mov_b64 exec, s[50:51]
    s_and_b64 s[82:83], s[50:51], s[80:81]
    s_cbranch_scc1 L2_c86
L2_d86:
    v_mov_b64 v[84:85], v[68:69]
    v_mov_b32 v7, v94
    v_mov_b64 v[86:87], v[72:73]
    s_mov_b64 exec, -1
    s_or_b64 s[80:81], s[80:81], s[50:51]
    s_and_b64 exec, s[84:85], s[80:81]
    v_mfma_f32_4x4x4_16b_bf16 v[76:79], v[12:13], v[84:85], 0
    v_mov_b32 v92, v7
    s_andn2_b64 s[80:81], s[80:81], s[84:85]
    v_mfma_f32_4x4x4_16b_bf16 v[76:79], v[10:11], v[86:87], v[76:79]
    s_mov_b64 exec, -1
    ds_read_b64 v[70:71], v93 offset:65408
    ds_read_b64 v[68:69], v92 offset:65408
    v_bitop3_b32 v94, v18, v5, v99 bitop3:0xea
    v_bitop3_b32 v95, v19, v5, v46 bitop3:0xea
    v_perm_b32 v15, v19, v20, s47
    v_bitop3_b32 v46, v19, 0.5, -0.5 bitop3:0xa8
    v_perm_b32 v14, v18, v20, s46
    v_bitop3_b32 v47, v18, 0.5, -0.5 bitop3:0xa8
    v_bitop3_b32 v15, v6, v15, v46 bitop3:0xca
    v_bitop3_b32 v14, v6, v14, v47 bitop3:0xca
    s_waitcnt lgkmcnt(1)
    v_mfma_f32_4x4x4_16b_bf16 v[80:83], v[10:11], v[70:71], v[80:83]
    s_waitcnt lgkmcnt(0)
    v_mfma_f32_4x4x4_16b_bf16 v[76:79], v[10:11], v[68:69], v[76:79]
    s_nop 2
    v_cvt_pk_bf16_f32 v80, v80, v81
    v_cvt_pk_bf16_f32 v81, v82, v83
    ds_wrxchg_rtn_b64 v[74:75], v93, v[80:81] offset:65408
    v_cvt_pk_bf16_f32 v76, v76, v77
    v_cvt_pk_bf16_f32 v77, v78, v79
    ds_wrxchg_rtn_b64 v[72:73], v92, v[76:77] offset:65408
    v_and_b32 v88, 0x0fffffff, v40
    buffer_load_dwordx2 v[16:17], v88, s[8:11], 0 offen
    buffer_load_dwordx3 v[18:20], v88, s[8:11], 0 offen offset:8
    v_mfma_f32_4x4x4_16b_bf16 v[80:83], v[8:9], v[106:107], 0
    v_mfma_f32_4x4x4_16b_bf16 v[76:79], v[8:9], v[104:105], 0
    v_cmp_lt_u32 s[48:49], v5, v95
    s_nop 2
    v_pk_mul_f32 v[80:81], v[80:81], v[14:15] op_sel:[0,1] op_sel_hi:[1,1]
    v_pk_mul_f32 v[82:83], v[82:83], v[14:15] op_sel:[0,1] op_sel_hi:[1,1]
    v_pk_mul_f32 v[76:77], v[76:77], v[14:15] op_sel:[0,0] op_sel_hi:[1,0]
    v_pk_mul_f32 v[78:79], v[78:79], v[14:15] op_sel:[0,0] op_sel_hi:[1,0]
    s_waitcnt vmcnt(10)
    v_and_b32 v46, 0x20000000, v27
    v_lshrrev_b32 v47, 14, v23
    v_bitop3_b32 v47, v47, v5, v46 bitop3:0xea
    ds_read_b64 v[102:103], v47
    v_and_b32 v99, 0x10000000, v27
    v_lshrrev_b32 v47, 14, v22
    v_bitop3_b32 v47, v47, v5, v99 bitop3:0xea
    ds_read_b64 v[100:101], v47
    s_waitcnt lgkmcnt(2)
    v_cmp_ne_u64 s[50:51], v[72:73], v[68:69]
    v_cmpx_ne_u64 s[54:55], v[74:75], v[70:71]
    s_and_b64 s[82:83], s[54:55], s[80:81]
    s_cbranch_scc1 L2_c87
L2_d87:
    v_mov_b64 v[84:85], v[70:71]
    v_mov_b32 v7, v93
    v_mov_b64 v[86:87], v[74:75]
    s_or_b64 s[80:81], s[80:81], s[54:55]
    s_mov_b64 exec, s[50:51]
    s_and_b64 s[82:83], s[50:51], s[80:81]
    s_cbranch_scc1 L2_c88
L2_d88:
    v_mov_b64 v[84:85], v[68:69]
    v_mov_b32 v7, v92
    v_mov_b64 v[86:87], v[72:73]
    s_mov_b64 exec, -1
    s_or_b64 s[80:81], s[80:81], s[50:51]
    s_and_b64 exec, s[48:49], s[80:81]
    v_mfma_f32_4x4x4_16b_bf16 v[80:83], v[12:13], v[84:85], 0
    v_mov_b32 v95, v7
    s_andn2_b64 s[80:81], s[80:81], s[48:49]
    v_mfma_f32_4x4x4_16b_bf16 v[80:83], v[10:11], v[86:87], v[80:83]
    s_mov_b64 exec, -1
    ds_read_b64 v[70:71], v95 offset:65408
    ds_read_b64 v[68:69], v94 offset:65408
    v_bitop3_b32 v92, v22, v5, v99 bitop3:0xea
    v_bitop3_b32 v93, v23, v5, v46 bitop3:0xea
    v_perm_b32 v15, v23, v26, s45
    v_bitop3_b32 v46, v23, 0.5, -0.5 bitop3:0xa8
    v_perm_b32 v14, v22, v26, s44
    v_bitop3_b32 v47, v22, 0.5, -0.5 bitop3:0xa8
    v_bitop3_b32 v15, v6, v15, v46 bitop3:0xca
    v_bitop3_b32 v14, v6, v14, v47 bitop3:0xca
    s_waitcnt lgkmcnt(1)
    v_mfma_f32_4x4x4_16b_bf16 v[80:83], v[10:11], v[70:71], v[80:83]
    s_waitcnt lgkmcnt(0)
    v_mfma_f32_4x4x4_16b_bf16 v[76:79], v[10:11], v[68:69], v[76:79]
    s_nop 2
    v_cvt_pk_bf16_f32 v80, v80, v81
    v_cvt_pk_bf16_f32 v81, v82, v83
    ds_wrxchg_rtn_b64 v[74:75], v95, v[80:81] offset:65408
    v_cvt_pk_bf16_f32 v76, v76, v77
    v_cvt_pk_bf16_f32 v77, v78, v79
    ds_wrxchg_rtn_b64 v[72:73], v94, v[76:77] offset:65408
    s_setprio 2
    v_mfma_f32_4x4x4_16b_bf16 v[80:83], v[8:9], v[102:103], 0
    v_mfma_f32_4x4x4_16b_bf16 v[76:79], v[8:9], v[100:101], 0
    s_nop 3
    v_pk_mul_f32 v[80:81], v[80:81], v[14:15] op_sel:[0,1] op_sel_hi:[1,1]
    v_pk_mul_f32 v[82:83], v[82:83], v[14:15] op_sel:[0,1] op_sel_hi:[1,1]
    v_pk_mul_f32 v[76:77], v[76:77], v[14:15] op_sel:[0,0] op_sel_hi:[1,0]
    v_pk_mul_f32 v[78:79], v[78:79], v[14:15] op_sel:[0,0] op_sel_hi:[1,0]
    s_bitcmp1_b32 s43, s42
    s_cbranch_scc1 L2_oa89
L2_ob89:
    buffer_load_dwordx4 v[112:115], v3, s[16:19], s40 offen offset:1024 sc1
    v_sub_u16 v88, v60, v52
    v_and_b32 v89, 3, v52
    v_add3_u32 v99, v88, v89, 3
    v_and_b32 v99, -4, v99
    v_max_u32 v99, 4, v99
    v_and_b32 v97, 0xfffc, v52
    v_bfm_b32 v96, v88, v89
    v_add_u32_dpp v91, v99, v99 row_shr:1 row_mask:0xf bank_mask:0xf bound_ctrl:1
    v_mad_u32_u24 v97, v97, 5, v2
    v_cmp_lt_u32 vcc, 16, v99
    v_add_u32_dpp v91, v91, v91 row_shr:2 row_mask:0xf bank_mask:0xf bound_ctrl:1
    v_sub_u32 v98, s38, v99
    v_lshrrev_b64 v[52:53], 16, v[52:53]
    v_add_u32_dpp v91, v91, v91 row_shr:4 row_mask:0xf bank_mask:0xf bound_ctrl:1
    v_lshrrev_b64 v[60:61], 16, v[60:61]
    s_mov_b32 s101, 0
    v_add_u32_dpp v91, v91, v91 row_shr:8 row_mask:0xf bank_mask:0xf bound_ctrl:1
    s_nop 1
    v_add_u32_dpp v91, v91, v91 row_bcast:15 row_mask:0xa bank_mask:0xf
    s_nop 1
    v_add_u32_dpp v91, v91, v91 row_bcast:31 row_mask:0xc bank_mask:0xf
    v_add_u32 v98, v98, v91
    v_readlane_b32 s37, v91, 63
    s_cbranch_vccnz L2_xo90
L2_xp90:
    v_and_b32 v46, 0x80000000, v27
    v_lshrrev_b32 v47, 14, v25
    v_bitop3_b32 v47, v47, v5, v46 bitop3:0xea
    ds_read_b64 v[106:107], v47
    v_and_b32 v99, 0x40000000, v27
    v_lshrrev_b32 v47, 14, v24
    v_bitop3_b32 v47, v47, v5, v99 bitop3:0xea
    ds_read_b64 v[104:105], v47
    s_waitcnt lgkmcnt(2)
    v_cmp_ne_u64 s[50:51], v[72:73], v[68:69]
    v_cmpx_ne_u64 s[54:55], v[74:75], v[70:71]
    s_and_b64 s[82:83], s[54:55], s[80:81]
    s_cbranch_scc1 L2_c91
L2_d91:
    v_mov_b64 v[84:85], v[70:71]
    v_mov_b32 v7, v95
    v_mov_b64 v[86:87], v[74:75]
    s_or_b64 s[80:81], s[80:81], s[54:55]
    s_mov_b64 exec, s[50:51]
    s_and_b64 s[82:83], s[50:51], s[80:81]
    s_cbranch_scc1 L2_c92
L2_d92:
    v_mov_b64 v[84:85], v[68:69]
    v_mov_b32 v7, v94
    v_mov_b64 v[86:87], v[72:73]
    s_mov_b64 exec, -1
    s_or_b64 s[80:81], s[80:81], s[50:51]
    ds_read_b64 v[70:71], v93 offset:65408
    ds_read_b64 v[68:69], v92 offset:65408
    v_bitop3_b32 v94, v24, v5, v99 bitop3:0xea
    v_bitop3_b32 v95, v25, v5, v46 bitop3:0xea
    v_perm_b32 v15, v25, v26, s47
    v_bitop3_b32 v46, v25, 0.5, -0.5 bitop3:0xa8
    v_perm_b32 v14, v24, v26, s46
    v_bitop3_b32 v47, v24, 0.5, -0.5 bitop3:0xa8
    v_bitop3_b32 v15, v6, v15, v46 bitop3:0xca
    v_bitop3_b32 v14, v6, v14, v47 bitop3:0xca
    s_waitcnt lgkmcnt(1)
    v_mfma_f32_4x4x4_16b_bf16 v[80:83], v[10:11], v[70:71], v[80:83]
    s_waitcnt lgkmcnt(0)
    v_mfma_f32_4x4x4_16b_bf16 v[76:79], v[10:11], v[68:69], v[76:79]
    s_nop 2
    v_cvt_pk_bf16_f32 v80, v80, v81
    v_cvt_pk_bf16_f32 v81, v82, v83
    ds_wrxchg_rtn_b64 v[74:75], v93, v[80:81] offset:65408
    v_cvt_pk_bf16_f32 v76, v76, v77
    v_cvt_pk_bf16_f32 v77, v78, v79
    ds_wrxchg_rtn_b64 v[72:73], v92, v[76:77] offset:65408
    v_and_b32 v88, 0x0fffffff, v41
    buffer_load_dwordx2 v[22:23], v88, s[8:11], 0 offen
    buffer_load_dwordx3 v[24:26], v88, s[8:11], 0 offen offset:8
    s_setprio 1
    v_mfma_f32_4x4x4_16b_bf16 v[80:83], v[8:9], v[106:107], 0
    v_mfma_f32_4x4x4_16b_bf16 v[76:79], v[8:9], v[104:105], 0
    v_cmp_lt_u32 s[84:85], v5, v94
    s_nop 2
    v_pk_mul_f32 v[80:81], v[80:81], v[14:15] op_sel:[0,1] op_sel_hi:[1,1]
    v_pk_mul_f32 v[82:83], v[82:83], v[14:15] op_sel:[0,1] op_sel_hi:[1,1]
    v_pk_mul_f32 v[76:77], v[76:77], v[14:15] op_sel:[0,0] op_sel_hi:[1,0]
    v_pk_mul_f32 v[78:79], v[78:79], v[14:15] op_sel:[0,0] op_sel_hi:[1,0]
    s_waitcnt vmcnt(11)
    s_mov_b64 exec, s[6:7]
    v_lshrrev_b32 v30, 16, v30
    s_mov_b64 exec, -1
    v_and_b32 v46, 0x20000000, v31
    v_lshrrev_b32 v47, 14, v29
    v_bitop3_b32 v47, v47, v5, v46 bitop3:0xea
    ds_read_b64 v[102:103], v47
    v_and_b32 v99, 0x10000000, v31
    v_lshrrev_b32 v47, 14, v28
    v_bitop3_b32 v47, v47, v5, v99 bitop3:0xea
    ds_read_b64 v[100:101], v47
    s_waitcnt lgkmcnt(2)
    v_cmp_ne_u64 s[50:51], v[72:73], v[68:69]
    v_cmpx_ne_u64 s[54:55], v[74:75], v[70:71]
    s_and_b64 s[82:83], s[54:55], s[80:81]
    s_cbranch_scc1 L2_c93
L2_d93:
    v_mov_b64 v[84:85], v[70:71]
    v_mov_b32 v7, v93
    v_mov_b64 v[86:87], v[74:75]
    s_or_b64 s[80:81], s[80:81], s[54:55]
    s_mov_b64 exec, s[50:51]
    s_and_b64 s[82:83], s[50:51], s[80:81]
    s_cbranch_scc1 L2_c94
L2_d94:
    v_mov_b64 v[84:85], v[68:69]
    v_mov_b32 v7, v92
    v_mov_b64 v[86:87], v[72:73]
    s_mov_b64 exec, -1
    s_or_b64 s[80:81], s[80:81], s[50:51]
    s_and_b64 exec, s[84:85], s[80:81]
    v_mfma_f32_4x4x4_16b_bf16 v[76:79], v[12:13], v[84:85], 0
    v_mov_b32 v94, v7
    s_andn2_b64 s[80:81], s[80:81], s[84:85]
    v_mfma_f32_4x4x4_16b_bf16 v[76:79], v[10:11], v[86:87], v[76:79]
    s_mov_b64 exec, -1
    ds_read_b64 v[70:71], v95 offset:65408
    ds_read_b64 v[68:69], v94 offset:65408
    v_bitop3_b32 v92, v28, v5, v99 bitop3:0xea
    v_bitop3_b32 v93, v29, v5, v46 bitop3:0xea
    v_perm_b32 v15, v29, v30, s45
    v_bitop3_b32 v46, v29, 0.5, -0.5 bitop3:0xa8
    v_perm_b32 v14, v28, v30, s44
    v_bitop3_b32 v47, v28, 0.5, -0.5 bitop3:0xa8
    v_bitop3_b32 v15, v6, v15, v46 bitop3:0xca
    v_bitop3_b32 v14, v6, v14, v47 bitop3:0xca
    s_waitcnt lgkmcnt(1)
    v_mfma_f32_4x4x4_16b_bf16 v[80:83], v[10:11], v[70:71], v[80:83]
    s_waitcnt lgkmcnt(0)
    v_mfma_f32_4x4x4_16b_bf16 v[76:79], v[10:11], v[68:69], v[76:79]
    s_nop 2
    v_cvt_pk_bf16_f32 v80, v80, v81
    v_cvt_pk_bf16_f32 v81, v82, v83
    ds_wrxchg_rtn_b64 v[74:75], v95, v[80:81] offset:65408
    v_cvt_pk_bf16_f32 v76, v76, v77
    v_cvt_pk_bf16_f32 v77, v78, v79
    ds_wrxchg_rtn_b64 v[72:73], v94, v[76:77] offset:65408
    s_setprio 0
    v_mfma_f32_4x4x4_16b_bf16 v[80:83], v[8:9], v[102:103], 0
    v_mfma_f32_4x4x4_16b_bf16 v[76:79], v[8:9], v[100:101], 0
    v_cmp_lt_u32 s[48:49], v5, v93
    s_nop 2
    v_pk_mul_f32 v[80:81], v[80:81], v[14:15] op_sel:[0,1] op_sel_hi:[1,1]
    v_pk_mul_f32 v[82:83], v[82:83], v[14:15] op_sel:[0,1] op_sel_hi:[1,1]
    v_pk_mul_f32 v[76:77], v[76:77], v[14:15] op_sel:[0,0] op_sel_hi:[1,0]
    v_pk_mul_f32 v[78:79], v[78:79], v[14:15] op_sel:[0,0] op_sel_hi:[1,0]
    s_add_u32 s40, s40, 0x50000
    v_and_b32 v47, 0x0fffffff, v42
    buffer_load_dword v30, v47, s[8:11], 0 offen offset:16
    s_mov_b64 exec, s[6:7]
    v_add_u32 v47, 8, v47
    v_lshrrev_b32 v42, 2, v42
    s_mov_b64 exec, -1
    buffer_load_dwordx2 v[28:29], v47, s[8:11], 0 offen
    s_waitcnt vmcnt(8)
    v_and_b32 v46, 0x80000000, v39
    v_lshrrev_b32 v47, 14, v37
    v_bitop3_b32 v47, v47, v5, v46 bitop3:0xea
    ds_read_b64 v[102:103], v47
    v_and_b32 v99, 0x40000000, v39
    v_lshrrev_b32 v47, 14, v36
    v_bitop3_b32 v47, v47, v5, v99 bitop3:0xea
    ds_read_b64 v[100:101], v47
    v_and_b32 v46, 0x20000000, v39
    v_lshrrev_b32 v47, 14, v35
    v_bitop3_b32 v47, v47, v5, v46 bitop3:0xea
    ds_read_b64 v[106:107], v47
    v_and_b32 v99, 0x10000000, v39
    v_lshrrev_b32 v47, 14, v34
    v_bitop3_b32 v47, v47, v5, v99 bitop3:0xea
    ds_read_b64 v[104:105], v47
    s_waitcnt lgkmcnt(4)
    v_cmp_ne_u64 s[50:51], v[72:73], v[68:69]
    v_cmpx_ne_u64 s[54:55], v[74:75], v[70:71]
    s_and_b64 s[82:83], s[54:55], s[80:81]
    s_cbranch_scc1 L2_c95
L2_d95:
    v_mov_b64 v[84:85], v[70:71]
    v_mov_b32 v7, v95
    v_mov_b64 v[86:87], v[74:75]
    s_or_b64 s[80:81], s[80:81], s[54:55]
    s_mov_b64 exec, s[50:51]
    s_and_b64 s[82:83], s[50:51], s[80:81]
    s_cbranch_scc1 L2_c96
L2_d96:
    v_mov_b64 v[84:85], v[68:69]
    v_mov_b32 v7, v94
    v_mov_b64 v[86:87], v[72:73]
    s_mov_b64 exec, -1
    s_or_b64 s[80:81], s[80:81], s[50:51]
    s_and_b64 exec, s[48:49], s[80:81]
    v_mfma_f32_4x4x4_16b_bf16 v[80:83], v[12:13], v[84:85], 0
    v_mov_b32 v93, v7
    s_andn2_b64 s[80:81], s[80:81], s[48:49]
    v_mfma_f32_4x4x4_16b_bf16 v[80:83], v[10:11], v[86:87], v[80:83]
    s_mov_b64 exec, -1
    ds_read_b64 v[70:71], v93 offset:65408
    ds_read_b64 v[68:69], v92 offset:65408
    v_bitop3_b32 v94, v34, v5, v99 bitop3:0xea
    v_bitop3_b32 v95, v35, v5, v46 bitop3:0xea
    v_perm_b32 v15, v35, v38, s45
    v_bitop3_b32 v46, v35, 0.5, -0.5 bitop3:0xa8
    v_perm_b32 v14, v34, v38, s44
    v_bitop3_b32 v47, v34, 0.5, -0.5 bitop3:0xa8
    v_bitop3_b32 v15, v6, v15, v46 bitop3:0xca
    v_bitop3_b32 v14, v6, v14, v47 bitop3:0xca
    s_waitcnt lgkmcnt(1)
    v_mfma_f32_4x4x4_16b_bf16 v[80:83], v[10:11], v[70:71], v[80:83]
    s_waitcnt lgkmcnt(0)
    v_mfma_f32_4x4x4_16b_bf16 v[76:79], v[10:11], v[68:69], v[76:79]
    s_nop 2
    v_cvt_pk_bf16_f32 v80, v80, v81
    v_cvt_pk_bf16_f32 v81, v82, v83
    ds_wrxchg_rtn_b64 v[74:75], v93, v[80:81] offset:65408
    v_cvt_pk_bf16_f32 v76, v76, v77
    v_cvt_pk_bf16_f32 v77, v78, v79
    ds_wrxchg_rtn_b64 v[72:73], v92, v[76:77] offset:65408
    s_barrier
    s_setprio 3
    s_mov_b32 m0, s100
    s_nop 0
    ds_write_addtid_b32 v124 offset:34816
    ds_write_addtid_b32 v125 offset:35072
    ds_write_addtid_b32 v126 offset:35328
    ds_write_addtid_b32 v127 offset:35584
    s_add_u32 s3, s40, 4096
    buffer_load_dwordx4 v[124:127], v3, s[16:19], s3 offen sc1
    ds_write_addtid_b32 v116 offset:32768
    ds_write_addtid_b32 v117 offset:33024
    ds_write_addtid_b32 v118 offset:33280
    ds_write_addtid_b32 v119 offset:33536
    buffer_load_dwordx4 v[116:119], v3, s[16:19], s40 offen offset:2048 sc1
    ds_write_addtid_b32 v120 offset:33792
    ds_write_addtid_b32 v121 offset:34048
    ds_write_addtid_b32 v122 offset:34304
    ds_write_addtid_b32 v123 offset:34560
    buffer_load_dwordx4 v[120:123], v3, s[16:19], s40 offen offset:3072 sc1
    v_mfma_f32_4x4x4_16b_bf16 v[80:83], v[8:9], v[106:107], 0
    v_mfma_f32_4x4x4_16b_bf16 v[76:79], v[8:9], v[104:105], 0
    s_nop 3
    v_pk_mul_f32 v[80:81], v[80:81], v[14:15] op_sel:[0,1] op_sel_hi:[1,1]
    v_pk_mul_f32 v[82:83], v[82:83], v[14:15] op_sel:[0,1] op_sel_hi:[1,1]
    v_pk_mul_f32 v[76:77], v[76:77], v[14:15] op_sel:[0,0] op_sel_hi:[1,0]
    v_pk_mul_f32 v[78:79], v[78:79], v[14:15] op_sel:[0,0] op_sel_hi:[1,0]
    s_cmp_gt_u32 s37, 1024
    s_cbranch_scc1 L2_xs97
    s_cmp_lg_u32 s101, 0
    s_cbranch_scc1 L2_xa97
L2_xb97:
    v_lshlrev_b32 v89, 16, v96
    v_add_u32 v90, 60, v97
    v_bitop3_b32 v90, v89, v45, v90 bitop3:0x6a
    ds_write_b32 v98, v90 offset:12
    v_lshlrev_b32 v89, 20, v96
    v_add_u32 v90, 40, v97
    v_bitop3_b32 v90, v89, v45, v90 bitop3:0x6a
    ds_write_b32 v98, v90 offset:8
    v_lshlrev_b32 v89, 24, v96
    v_add_u32 v90, 20, v97
    v_bitop3_b32 v90, v89, v45, v90 bitop3:0x6a
    ds_write_b32 v98, v90 offset:4
    v_lshlrev_b32 v89, 28, v96
    v_bitop3_b32 v90, v89, v45, v97 bitop3:0x6a
    ds_write_b32 v98, v90 offset:0
    v_mov_b32_dpp v91, v64 quad_perm:[1,1,1,1] row_mask:0xf bank_mask:0xf
    v_and_b32 v89, 3, v91
    v_and_b32 v97, 0xfffc, v91
    v_sub_u16_dpp v88, v64, v91 quad_perm:[3,3,3,3] row_mask:0xf bank_mask:0xf
    v_mad_u32_u24 v97, v97, 5, v4
    v_add_u32 v99, v88, v89
    v_bfm_b32 v96, v88, v89
    v_cmp_lt_u32 s[58:59], 16, v99
    v_lshlrev_b32 v89, v1, v96
    v_and_b32 v89, v45, v89
    v_cmp_ne_u32 vcc, 0, v89
    v_xor_b32 v90, v97, v89
    s_add_u32 s3, s37, s38
    v_mbcnt_lo_u32_b32 v98, vcc_lo, 0
    v_mbcnt_hi_u32_b32 v98, vcc_hi, v98
    s_bcnt1_i32_b64 s41, vcc
    v_lshl_add_u32 v98, v98, 2, s3
    s_lshl2_add_u32 s37, s41, s37
    s_mov_b64 exec, vcc
    ds_write_b32 v98, v90
    s_mov_b64 exec, -1
    s_cmp_lg_u64 s[58:59], 0
    s_cbranch_scc1 L2_xe97
L2_xr97:
    v_add_u32 v98, s37, v0
    v_mov_b32 v90, -1
    ds_write_b32 v98, v90
L2_xw97:
    s_setprio 2
    s_waitcnt lgkmcnt(14)
    v_cmp_ne_u64 s[50:51], v[72:73], v[68:69]
    v_cmpx_ne_u64 s[54:55], v[74:75], v[70:71]
    s_and_b64 s[82:83], s[54:55], s[80:81]
    s_cbranch_scc1 L2_c98
L2_d98:
    v_mov_b64 v[84:85], v[70:71]
    v_mov_b32 v7, v93
    v_mov_b64 v[86:87], v[74:75]
    s_or_b64 s[80:81], s[80:81], s[54:55]
    s_mov_b64 exec, s[50:51]
    s_and_b64 s[82:83], s[50:51], s[80:81]
    s_cbranch_scc1 L2_c99
L2_d99:
    v_mov_b64 v[84:85], v[68:69]
    v_mov_b32 v7, v92
    v_mov_b64 v[86:87], v[72:73]
    s_mov_b64 exec, -1
    s_or_b64 s[80:81], s[80:81], s[50:51]
    ds_read_b64 v[70:71], v95 offset:65408
    ds_read_b64 v[68:69], v94 offset:65408
    v_and_b32 v46, 0x40000000, v39
    v_bitop3_b32 v92, v36, v5, v46 bitop3:0xea
    v_and_b32 v46, 0x80000000, v39
    v_bitop3_b32 v93, v37, v5, v46 bitop3:0xea
    v_perm_b32 v15, v37, v38, s47
    v_bitop3_b32 v46, v37, 0.5, -0.5 bitop3:0xa8
    v_perm_b32 v14, v36, v38, s46
    v_bitop3_b32 v47, v36, 0.5, -0.5 bitop3:0xa8
    v_bitop3_b32 v15, v6, v15, v46 bitop3:0xca
    v_bitop3_b32 v14, v6, v14, v47 bitop3:0xca
    s_setprio 1
    s_waitcnt lgkmcnt(1)
    v_mfma_f32_4x4x4_16b_bf16 v[80:83], v[10:11], v[70:71], v[80:83]
    s_waitcnt lgkmcnt(0)
    v_mfma_f32_4x4x4_16b_bf16 v[76:79], v[10:11], v[68:69], v[76:79]
    s_nop 2
    v_cvt_pk_bf16_f32 v80, v80, v81
    v_cvt_pk_bf16_f32 v81, v82, v83
    ds_wrxchg_rtn_b64 v[74:75], v95, v[80:81] offset:65408
    v_cvt_pk_bf16_f32 v76, v76, v77
    v_cvt_pk_bf16_f32 v77, v78, v79
    ds_wrxchg_rtn_b64 v[72:73], v94, v[76:77] offset:65408
    ds_read_b32 v21, v0 offset:0
    ds_read_b32 v27, v0 offset:256
    ds_read_b32 v31, v44 offset:768
    ds_read_b32 v39, v0 offset:512
    s_sub_u32 s3, s37, 768
    s_cmp_gt_u32 s3, 128
    s_cbranch_scc1 L2_xf97
L2_xg97:
    v_and_b32 v88, 0x0fffffff, v43
    buffer_load_dwordx2 v[34:35], v88, s[8:11], 0 offen
    buffer_load_dwordx3 v[36:38], v88, s[8:11], 0 offen offset:8
    s_setprio 0
    s_waitcnt vmcnt(12)
    s_mov_b32 m0, s38
    s_nop 0
    ds_write_addtid_b32 v108 offset:0
    ds_write_addtid_b32 v109 offset:256
    ds_write_addtid_b32 v110 offset:512
    ds_write_addtid_b32 v111 offset:768
    s_waitcnt vmcnt(9)
    ds_write_addtid_b32 v112 offset:1024
    ds_write_addtid_b32 v113 offset:1280
    ds_write_addtid_b32 v114 offset:1536
    ds_write_addtid_b32 v115 offset:1792
    v_mfma_f32_4x4x4_16b_bf16 v[80:83], v[8:9], v[102:103], 0
    v_mfma_f32_4x4x4_16b_bf16 v[76:79], v[8:9], v[100:101], 0
    v_cmp_lt_u32 s[84:85], v5, v92
    s_nop 2
    v_pk_mul_f32 v[80:81], v[80:81], v[14:15] op_sel:[0,1] op_sel_hi:[1,1]
    v_pk_mul_f32 v[82:83], v[82:83], v[14:15] op_sel:[0,1] op_sel_hi:[1,1]
    v_pk_mul_f32 v[76:77], v[76:77], v[14:15] op_sel:[0,0] op_sel_hi:[1,0]
    v_pk_mul_f32 v[78:79], v[78:79], v[14:15] op_sel:[0,0] op_sel_hi:[1,0]
    s_add_u32 s42, s42, 1
    s_waitcnt lgkmcnt(0)
    s_barrier
    s_bitcmp1_b32 s36, s42
    s_cbranch_scc1 L2_slow
L2_ret5:
    s_setprio 3
    s_bitcmp1_b32 s43, s42
    s_cbranch_scc1 L2_oa100
L2_ob100:
    v_and_b32 v46, 0x20000000, v40
    v_lshrrev_b32 v47, 14, v17
    v_bitop3_b32 v47, v47, v5, v46 bitop3:0xea
    ds_read_b64 v[106:107], v47
    v_and_b32 v99, 0x10000000, v40
    v_lshrrev_b32 v47, 14, v16
    v_bitop3_b32 v47, v47, v5, v99 bitop3:0xea
    ds_read_b64 v[104:105], v47
    v_cmp_ne_u64 s[50:51], v[72:73], v[68:69]
    v_cmpx_ne_u64 s[54:55], v[74:75], v[70:71]
    s_and_b64 s[82:83], s[54:55], s[80:81]
    s_cbranch_scc1 L2_c101
L2_d101:
    v_mov_b64 v[84:85], v[70:71]
    v_mov_b32 v7, v95
    v_mov_b64 v[86:87], v[74:75]
    s_or_b64 s[80:81], s[80:81], s[54:55]
    s_mov_b64 exec, s[50:51]
    s_and_b64 s[82:83], s[50:51], s[80:81]
    s_cbranch_scc1 L2_c102
L2_d102:
    v_mov_b64 v[84:85], v[68:69]
    v_mov_b32 v7, v94
    v_mov_b64 v[86:87], v[72:73]
    s_mov_b64 exec, -1
    s_or_b64 s[80:81], s[80:81], s[50:51]
    s_and_b64 exec, s[84:85], s[80:81]
    v_mfma_f32_4x4x4_16b_bf16 v[76:79], v[12:13], v[84:85], 0
    v_mov_b32 v92, v7
    s_andn2_b64 s[80:81], s[80:81], s[84:85]
    v_mfma_f32_4x4x4_16b_bf16 v[76:79], v[10:11], v[86:87], v[76:79]
    s_mov_b64 exec, -1
    ds_read_b64 v[70:71], v93 offset:65408
    ds_read_b64 v[68:69], v92 offset:65408
    v_bitop3_b32 v94, v16, v5, v99 bitop3:0xea
    v_bitop3_b32 v95, v17, v5, v46 bitop3:0xea
    v_perm_b32 v15, v17, v20, s45
    v_bitop3_b32 v46, v17, 0.5, -0.5 bitop3:0xa8
    v_perm_b32 v14, v16, v20, s44
    v_bitop3_b32 v47, v16, 0.5, -0.5 bitop3:0xa8
    v_bitop3_b32 v15, v6, v15, v46 bitop3:0xca
    v_bitop3_b32 v14, v6, v14, v47 bitop3:0xca
    s_waitcnt lgkmcnt(1)
    v_mfma_f32_4x4x4_16b_bf16 v[80:83], v[10:11], v[70:71], v[80:83]
    s_waitcnt lgkmcnt(0)
    v_mfma_f32_4x4x4_16b_bf16 v[76:79], v[10:11], v[68:69], v[76:79]
    s_nop 2
    v_cvt_pk_bf16_f32 v80, v80, v81
    v_cvt_pk_bf16_f32 v81, v82, v83
    ds_wrxchg_rtn_b64 v[74:75], v93, v[80:81] offset:65408
    v_cvt_pk_bf16_f32 v76, v76, v77
    v_cvt_pk_bf16_f32 v77, v78, v79
    ds_wrxchg_rtn_b64 v[72:73], v92, v[76:77] offset:65408
    v_mfma_f32_4x4x4_16b_bf16 v[80:83], v[8:9], v[106:107], 0
    v_mfma_f32_4x4x4_16b_bf16 v[76:79], v[8:9], v[104:105], 0
    v_cmp_lt_u32 s[84:85], v5, v94
    s_nop 2
    v_pk_mul_f32 v[80:81], v[80:81], v[14:15] op_sel:[0,1] op_sel_hi:[1,1]
    v_pk_mul_f32 v[82:83], v[82:83], v[14:15] op_sel:[0,1] op_sel_hi:[1,1]
    v_pk_mul_f32 v[76:77], v[76:77], v[14:15] op_sel:[0,0] op_sel_hi:[1,0]
    v_pk_mul_f32 v[78:79], v[78:79], v[14:15] op_sel:[0,0] op_sel_hi:[1,0]
    buffer_load_dwordx4 v[108:111], v3, s[16:19], s40 offen offset:0 sc1
    v_and_b32 v46, 0x80000000, v40
    v_lshrrev_b32 v47, 14, v19
    v_bitop3_b32 v47, v47, v5, v46 bitop3:0xea
    ds_read_b64 v[102:103], v47
    v_and_b32 v99, 0x40000000, v40
    v_lshrrev_b32 v47, 14, v18
    v_bitop3_b32 v47, v47, v5, v99 bitop3:0xea
    ds_read_b64 v[100:101], v47
    s_waitcnt lgkmcnt(2)
    v_cmp_ne_u64 s[50:51], v[72:73], v[68:69]
    v_cmpx_ne_u64 s[54:55], v[74:75], v[70:71]
    s_and_b64 s[82:83], s[54:55], s[80:81]
    s_cbranch_scc1 L2_c103
L2_d103:
    v_mov_b64 v[84:85], v[70:71]
    v_mov_b32 v7, v93
    v_mov_b64 v[86:87], v[74:75]
    s_or_b64 s[80:81], s[80:81], s[54:55]
    s_mov_b64 exec, s[50:51]
    s_and_b64 s[82:83], s[50:51], s[80:81]
    s_cbranch_scc1 L2_c104
L2_d104:
    v_mov_b64 v[84:85], v[68:69]
    v_mov_b32 v7, v92
    v_mov_b64 v[86:87], v[72:73]
    s_mov_b64 exec, -1
    s_or_b64 s[80:81], s[80:81], s[50:51]
    s_and_b64 exec, s[84:85], s[80:81]
    v_mfma_f32_4x4x4_16b_bf16 v[76:79], v[12:13], v[84:85], 0
    v_mov_b32 v94, v7
    s_andn2_b64 s[80:81], s[80:81], s[84:85]
    v_mfma_f32_4x4x4_16b_bf16 v[76:79], v[10:11], v[86:87], v[76:79]
    s_mov_b64 exec, -1
    ds_read_b64 v[70:71], v95 offset:65408
    ds_read_b64 v[68:69], v94 offset:65408
    v_bitop3_b32 v92, v18, v5, v99 bitop3:0xea
    v_bitop3_b32 v93, v19, v5, v46 bitop3:0xea
    v_perm_b32 v15, v19, v20, s47
    v_bitop3_b32 v46, v19, 0.5, -0.5 bitop3:0xa8
    v_perm_b32 v14, v18, v20, s46
    v_bitop3_b32 v47, v18, 0.5, -0.5 bitop3:0xa8
    v_bitop3_b32 v15, v6, v15, v46 bitop3:0xca
    v_bitop3_b32 v14, v6, v14, v47 bitop3:0xca
    s_waitcnt lgkmcnt(1)
    v_mfma_f32_4x4x4_16b_bf16 v[80:83], v[10:11], v[70:71], v[80:83]
    s_waitcnt lgkmcnt(0)
    v_mfma_f32_4x4x4_16b_bf16 v[76:79], v[10:11], v[68:69], v[76:79]
    s_nop 2
    v_cvt_pk_bf16_f32 v80, v80, v81
    v_cvt_pk_bf16_f32 v81, v82, v83
    ds_wrxchg_rtn_b64 v[74:75], v95, v[80:81] offset:65408
    v_cvt_pk_bf16_f32 v76, v76, v77
    v_cvt_pk_bf16_f32 v77, v78, v79
    ds_wrxchg_rtn_b64 v[72:73], v94, v[76:77] offset:65408
    v_and_b32 v88, 0x0fffffff, v21
    buffer_load_dwordx2 v[16:17], v88, s[8:11], 0 offen
    buffer_load_dwordx3 v[18:20], v88, s[8:11], 0 offen offset:8
    v_mfma_f32_4x4x4_16b_bf16 v[80:83], v[8:9], v[102:103], 0
    v_mfma_f32_4x4x4_16b_bf16 v[76:79], v[8:9], v[100:101], 0
    v_cmp_lt_u32 s[48:49], v5, v93
    s_nop 2
    v_pk_mul_f32 v[80:81], v[80:81], v[14:15] op_sel:[0,1] op_sel_hi:[1,1]
    v_pk_mul_f32 v[82:83], v[82:83], v[14:15] op_sel:[0,1] op_sel_hi:[1,1]
    v_pk_mul_f32 v[76:77], v[76:77], v[14:15] op_sel:[0,0] op_sel_hi:[1,0]
    v_pk_mul_f32 v[78:79], v[78:79], v[14:15] op_sel:[0,0] op_sel_hi:[1,0]
    s_waitcnt vmcnt(10)
    v_and_b32 v46, 0x20000000, v41
    v_lshrrev_b32 v47, 14, v23
    v_bitop3_b32 v47, v47, v5, v46 bitop3:0xea
    ds_read_b64 v[106:107], v47
    v_and_b32 v99, 0x10000000, v41
    v_lshrrev_b32 v47, 14, v22
    v_bitop3_b32 v47, v47, v5, v99 bitop3:0xea
    ds_read_b64 v[104:105], v47
    s_waitcnt lgkmcnt(2)
    v_cmp_ne_u64 s[50:51], v[72:73], v[68:69]
    v_cmpx_ne_u64 s[54:55], v[74:75], v[70:71]
    s_and_b64 s[82:83], s[54:55], s[80:81]
    s_cbranch_scc1 L2_c105
L2_d105:
    v_mov_b64 v[84:85], v[70:71]
    v_mov_b32 v7, v95
    v_mov_b64 v[86:87], v[74:75]
    s_or_b64 s[80:81], s[80:81], s[54:55]
    s_mov_b64 exec, s[50:51]
    s_and_b64 s[82:83], s[50:51], s[80:81]
    s_cbranch_scc1 L2_c106
L2_d106:
    v_mov_b64 v[84:85], v[68:69]
    v_mov_b32 v7, v94
    v_mov_b64 v[86:87], v[72:73]
    s_mov_b64 exec, -1
    s_or_b64 s[80:81], s[80:81], s[50:51]
    s_and_b64 exec, s[48:49], s[80:81]
    v_mfma_f32_4x4x4_16b_bf16 v[80:83], v[12:13], v[84:85], 0
    v_mov_b32 v93, v7
    s_andn2_b64 s[80:81], s[80:81], s[48:49]
    v_mfma_f32_4x4x4_16b_bf16 v[80:83], v[10:11], v[86:87], v[80:83]
    s_mov_b64 exec, -1
    ds_read_b64 v[70:71], v93 offset:65408
    ds_read_b64 v[68:69], v92 offset:65408
    v_bitop3_b32 v94, v22, v5, v99 bitop3:0xea
    v_bitop3_b32 v95, v23, v5, v46 bitop3:0xea
    v_perm_b32 v15, v23, v26, s45
    v_bitop3_b32 v46, v23, 0.5, -0.5 bitop3:0xa8
    v_perm_b32 v14, v22, v26, s44
    v_bitop3_b32 v47, v22, 0.5, -0.5 bitop3:0xa8
    v_bitop3_b32 v15, v6, v15, v46 bitop3:0xca
    v_bitop3_b32 v14, v6, v14, v47 bitop3:0xca
    s_waitcnt lgkmcnt(1)
    v_mfma_f32_4x4x4_16b_bf16 v[80:83], v[10:11], v[70:71], v[80:83]
    s_waitcnt lgkmcnt(0)
    v_mfma_f32_4x4x4_16b_bf16 v[76:79], v[10:11], v[68:69], v[76:79]
    s_nop 2
    v_cvt_pk_bf16_f32 v80, v80, v81
    v_cvt_pk_bf16_f32 v81, v82, v83
    ds_wrxchg_rtn_b64 v[74:75], v93, v[80:81] offset:65408
    v_cvt_pk_bf16_f32 v76, v76, v77
    v_cvt_pk_bf16_f32 v77, v78, v79
    ds_wrxchg_rtn_b64 v[72:73], v92, v[76:77] offset:65408
    s_setprio 2
    v_mfma_f32_4x4x4_16b_bf16 v[80:83], v[8:9], v[106:107], 0
    v_mfma_f32_4x4x4_16b_bf16 v[76:79], v[8:9], v[104:105], 0
    s_nop 3
    v_pk_mul_f32 v[80:81], v[80:81], v[14:15] op_sel:[0,1] op_sel_hi:[1,1]
    v_pk_mul_f32 v[82:83], v[82:83], v[14:15] op_sel:[0,1] op_sel_hi:[1,1]
    v_pk_mul_f32 v[76:77], v[76:77], v[14:15] op_sel:[0,0] op_sel_hi:[1,0]
    v_pk_mul_f32 v[78:79], v[78:79], v[14:15] op_sel:[0,0] op_sel_hi:[1,0]
    s_bitcmp1_b32 s43, s42
    s_cbranch_scc1 L2_oa107
L2_ob107:
    buffer_load_dwordx4 v[112:115], v3, s[16:19], s40 offen offset:1024 sc1
    v_sub_u16 v88, v62, v54
    v_and_b32 v89, 3, v54
    v_add3_u32 v99, v88, v89, 3
    v_and_b32 v99, -4, v99
    v_max_u32 v99, 4, v99
    v_and_b32 v97, 0xfffc, v54
    v_bfm_b32 v96, v88, v89
    v_add_u32_dpp v91, v99, v99 row_shr:1 row_mask:0xf bank_mask:0xf bound_ctrl:1
    v_mad_u32_u24 v97, v97, 5, v2
    v_cmp_lt_u32 vcc, 16, v99
    v_add_u32_dpp v91, v91, v91 row_shr:2 row_mask:0xf bank_mask:0xf bound_ctrl:1
    v_sub_u32 v98, s38, v99
    v_lshrrev_b64 v[54:55], 16, v[54:55]
    v_add_u32_dpp v91, v91, v91 row_shr:4 row_mask:0xf bank_mask:0xf bound_ctrl:1
    v_lshrrev_b64 v[62:63], 16, v[62:63]
    s_mov_b32 s101, 0
    v_add_u32_dpp v91, v91, v91 row_shr:8 row_mask:0xf bank_mask:0xf bound_ctrl:1
    s_nop 1
    v_add_u32_dpp v91, v91, v91 row_bcast:15 row_mask:0xa bank_mask:0xf
    s_nop 1
    v_add_u32_dpp v91, v91, v91 row_bcast:31 row_mask:0xc bank_mask:0xf
    v_add_u32 v98, v98, v91
    v_readlane_b32 s37, v91, 63
    s_cbranch_vccnz L2_xo108
L2_xp108:
    v_and_b32 v46, 0x80000000, v41
    v_lshrrev_b32 v47, 14, v25
    v_bitop3_b32 v47, v47, v5, v46 bitop3:0xea
    ds_read_b64 v[102:103], v47
    v_and_b32 v99, 0x40000000, v41
    v_lshrrev_b32 v47, 14, v24
    v_bitop3_b32 v47, v47, v5, v99 bitop3:0xea
    ds_read_b64 v[100:101], v47
    s_waitcnt lgkmcnt(2)
    v_cmp_ne_u64 s[50:51], v[72:73], v[68:69]
    v_cmpx_ne_u64 s[54:55], v[74:75], v[70:71]
    s_and_b64 s[82:83], s[54:55], s[80:81]
    s_cbranch_scc1 L2_c109
L2_d109:
    v_mov_b64 v[84:85], v[70:71]
    v_mov_b32 v7, v93
    v_mov_b64 v[86:87], v[74:75]
    s_or_b64 s[80:81], s[80:81], s[54:55]
    s_mov_b64 exec, s[50:51]
    s_and_b64 s[82:83], s[50:51], s[80:81]
    s_cbranch_scc1 L2_c110
L2_d110:
    v_mov_b64 v[84:85], v[68:69]
    v_mov_b32 v7, v92
    v_mov_b64 v[86:87], v[72:73]
    s_mov_b64 exec, -1
    s_or_b64 s[80:81], s[80:81], s[50:51]
    ds_read_b64 v[70:71], v95 offset:65408
    ds_read_b64 v[68:69], v94 offset:65408
    v_bitop3_b32 v92, v24, v5, v99 bitop3:0xea
    v_bitop3_b32 v93, v25, v5, v46 bitop3:0xea
    v_perm_b32 v15, v25, v26, s47
    v_bitop3_b32 v46, v25, 0.5, -0.5 bitop3:0xa8
    v_perm_b32 v14, v24, v26, s46
    v_bitop3_b32 v47, v24, 0.5, -0.5 bitop3:0xa8
    v_bitop3_b32 v15, v6, v15, v46 bitop3:0xca
    v_bitop3_b32 v14, v6, v14, v47 bitop3:0xca
    s_waitcnt lgkmcnt(1)
    v_mfma_f32_4x4x4_16b_bf16 v[80:83], v[10:11], v[70:71], v[80:83]
    s_waitcnt lgkmcnt(0)
    v_mfma_f32_4x4x4_16b_bf16 v[76:79], v[10:11], v[68:69], v[76:79]
    s_nop 2
    v_cvt_pk_bf16_f32 v80, v80, v81
    v_cvt_pk_bf16_f32 v81, v82, v83
    ds_wrxchg_rtn_b64 v[74:75], v95, v[80:81] offset:65408
    v_cvt_pk_bf16_f32 v76, v76, v77
    v_cvt_pk_bf16_f32 v77, v78, v79
    ds_wrxchg_rtn_b64 v[72:73], v94, v[76:77] offset:65408
    v_and_b32 v88, 0x0fffffff, v27
    buffer_load_dwordx2 v[22:23], v88, s[8:11], 0 offen
    buffer_load_dwordx3 v[24:26], v88, s[8:11], 0 offen offset:8
    s_setprio 1
    v_mfma_f32_4x4x4_16b_bf16 v[80:83], v[8:9], v[102:103], 0
    v_mfma_f32_4x4x4_16b_bf16 v[76:79], v[8:9], v[100:101], 0
    v_cmp_lt_u32 s[84:85], v5, v92
    s_nop 2
    v_pk_mul_f32 v[80:81], v[80:81], v[14:15] op_sel:[0,1] op_sel_hi:[1,1]
    v_pk_mul_f32 v[82:83], v[82:83], v[14:15] op_sel:[0,1] op_sel_hi:[1,1]
    v_pk_mul_f32 v[76:77], v[76:77], v[14:15] op_sel:[0,0] op_sel_hi:[1,0]
    v_pk_mul_f32 v[78:79], v[78:79], v[14:15] op_sel:[0,0] op_sel_hi:[1,0]
    s_waitcnt vmcnt(11)
    s_mov_b64 exec, s[6:7]
    v_lshrrev_b32 v30, 16, v30
    s_mov_b64 exec, -1
    v_and_b32 v46, 0x20000000, v42
    v_lshrrev_b32 v47, 14, v29
    v_bitop3_b32 v47, v47, v5, v46 bitop3:0xea
    ds_read_b64 v[106:107], v47
    v_and_b32 v99, 0x10000000, v42
    v_lshrrev_b32 v47, 14, v28
    v_bitop3_b32 v47, v47, v5, v99 bitop3:0xea
    ds_read_b64 v[104:105], v47
    s_waitcnt lgkmcnt(2)
    v_cmp_ne_u64 s[50:51], v[72:73], v[68:69]
    v_cmpx_ne_u64 s[54:55], v[74:75], v[70:71]
    s_and_b64 s[82:83], s[54:55], s[80:81]
    s_cbranch_scc1 L2_c111
L2_d111:
    v_mov_b64 v[84:85], v[70:71]
    v_mov_b32 v7, v95
    v_mov_b64 v[86:87], v[74:75]
    s_or_b64 s[80:81], s[80:81], s[54:55]
    s_mov_b64 exec, s[50:51]
    s_and_b64 s[82:83], s[50:51], s[80:81]
    s_cbranch_scc1 L2_c112
L2_d112:
    v_mov_b64 v[84:85], v[68:69]
    v_mov_b32 v7, v94
    v_mov_b64 v[86:87], v[72:73]
    s_mov_b64 exec, -1
    s_or_b64 s[80:81], s[80:81], s[50:51]
    s_and_b64 exec, s[84:85], s[80:81]
    v_mfma_f32_4x4x4_16b_bf16 v[76:79], v[12:13], v[84:85], 0
    v_mov_b32 v92, v7
    s_andn2_b64 s[80:81], s[80:81], s[84:85]
    v_mfma_f32_4x4x4_16b_bf16 v[76:79], v[10:11], v[86:87], v[76:79]
    s_mov_b64 exec, -1
    ds_read_b64 v[70:71], v93 offset:65408
    ds_read_b64 v[68:69], v92 offset:65408
    v_bitop3_b32 v94, v28, v5, v99 bitop3:0xea
    v_bitop3_b32 v95, v29, v5, v46 bitop3:0xea
    v_perm_b32 v15, v29, v30, s45
    v_bitop3_b32 v46, v29, 0.5, -0.5 bitop3:0xa8
    v_perm_b32 v14, v28, v30, s44
    v_bitop3_b32 v47, v28, 0.5, -0.5 bitop3:0xa8
    v_bitop3_b32 v15, v6, v15, v46 bitop3:0xca
    v_bitop3_b32 v14, v6, v14, v47 bitop3:0xca
    s_waitcnt lgkmcnt(1)
    v_mfma_f32_4x4x4_16b_bf16 v[80:83], v[10:11], v[70:71], v[80:83]
    s_waitcnt lgkmcnt(0)
    v_mfma_f32_4x4x4_16b_bf16 v[76:79], v[10:11], v[68:69], v[76:79]
    s_nop 2
    v_cvt_pk_bf16_f32 v80, v80, v81
    v_cvt_pk_bf16_f32 v81, v82, v83
    ds_wrxchg_rtn_b64 v[74:75], v93, v[80:81] offset:65408
    v_cvt_pk_bf16_f32 v76, v76, v77
    v_cvt_pk_bf16_f32 v77, v78, v79
    ds_wrxchg_rtn_b64 v[72:73], v92, v[76:77] offset:65408
    s_setprio 0
    v_mfma_f32_4x4x4_16b_bf16 v[80:83], v[8:9], v[106:107], 0
    v_mfma_f32_4x4x4_16b_bf16 v[76:79], v[8:9], v[104:105], 0
    v_cmp_lt_u32 s[48:49], v5, v95
    s_nop 2
    v_pk_mul_f32 v[80:81], v[80:81], v[14:15] op_sel:[0,1] op_sel_hi:[1,1]
    v_pk_mul_f32 v[82:83], v[82:83], v[14:15] op_sel:[0,1] op_sel_hi:[1,1]
    v_pk_mul_f32 v[76:77], v[76:77], v[14:15] op_sel:[0,0] op_sel_hi:[1,0]
    v_pk_mul_f32 v[78:79], v[78:79], v[14:15] op_sel:[0,0] op_sel_hi:[1,0]
    s_add_u32 s40, s40, 0x50000
    v_and_b32 v47, 0x0fffffff, v31
    buffer_load_dword v30, v47, s[8:11], 0 offen offset:16
    s_mov_b64 exec, s[6:7]
    v_add_u32 v47, 8, v47
    v_lshrrev_b32 v31, 2, v31
    s_mov_b64 exec, -1
    buffer_load_dwordx2 v[28:29], v47, s[8:11], 0 offen
    s_waitcnt vmcnt(8)
    v_and_b32 v46, 0x80000000, v43
    v_lshrrev_b32 v47, 14, v37
    v_bitop3_b32 v47, v47, v5, v46 bitop3:0xea
    ds_read_b64 v[106:107], v47
    v_and_b32 v99, 0x40000000, v43
    v_lshrrev_b32 v47, 14, v36
    v_bitop3_b32 v47, v47, v5, v99 bitop3:0xea
    ds_read_b64 v[104:105], v47
    v_and_b32 v46, 0x20000000, v43
    v_lshrrev_b32 v47, 14, v35
    v_bitop3_b32 v47, v47, v5, v46 bitop3:0xea
    ds_read_b64 v[102:103], v47
    v_and_b32 v99, 0x10000000, v43
    v_lshrrev_b32 v47, 14, v34
    v_bitop3_b32 v47, v47, v5, v99 bitop3:0xea
    ds_read_b64 v[100:101], v47
    s_waitcnt lgkmcnt(4)
    v_cmp_ne_u64 s[50:51], v[72:73], v[68:69]
    v_cmpx_ne_u64 s[54:55], v[74:75], v[70:71]
    s_and_b64 s[82:83], s[54:55], s[80:81]
    s_cbranch_scc1 L2_c113
L2_d113:
    v_mov_b64 v[84:85], v[70:71]
    v_mov_b32 v7, v93
    v_mov_b64 v[86:87], v[74:75]
    s_or_b64 s[80:81], s[80:81], s[54:55]
    s_mov_b64 exec, s[50:51]
    s_and_b64 s[82:83], s[50:51], s[80:81]
    s_cbranch_scc1 L2_c114
L2_d114:
    v_mov_b64 v[84:85], v[68:69]
    v_mov_b32 v7, v92
    v_mov_b64 v[86:87], v[72:73]
    s_mov_b64 exec, -1
    s_or_b64 s[80:81], s[80:81], s[50:51]
    s_and_b64 exec, s[48:49], s[80:81]
    v_mfma_f32_4x4x4_16b_bf16 v[80:83], v[12:13], v[84:85], 0
    v_mov_b32 v95, v7
    s_andn2_b64 s[80:81], s[80:81], s[48:49]
    v_mfma_f32_4x4x4_16b_bf16 v[80:83], v[10:11], v[86:87], v[80:83]
    s_mov_b64 exec, -1
    ds_read_b64 v[70:71], v95 offset:65408
    ds_read_b64 v[68:69], v94 offset:65408
    v_bitop3_b32 v92, v34, v5, v99 bitop3:0xea
    v_bitop3_b32 v93, v35, v5, v46 bitop3:0xea
    v_perm_b32 v15, v35, v38, s45
    v_bitop3_b32 v46, v35, 0.5, -0.5 bitop3:0xa8
    v_perm_b32 v14, v34, v38, s44
    v_bitop3_b32 v47, v34, 0.5, -0.5 bitop3:0xa8
    v_bitop3_b32 v15, v6, v15, v46 bitop3:0xca
    v_bitop3_b32 v14, v6, v14, v47 bitop3:0xca
    s_waitcnt lgkmcnt(1)
    v_mfma_f32_4x4x4_16b_bf16 v[80:83], v[10:11], v[70:71], v[80:83]
    s_waitcnt lgkmcnt(0)
    v_mfma_f32_4x4x4_16b_bf16 v[76:79], v[10:11], v[68:69], v[76:79]
    s_nop 2
    v_cvt_pk_bf16_f32 v80, v80, v81
    v_cvt_pk_bf16_f32 v81, v82, v83
    ds_wrxchg_rtn_b64 v[74:75], v95, v[80:81] offset:65408
    v_cvt_pk_bf16_f32 v76, v76, v77
    v_cvt_pk_bf16_f32 v77, v78, v79
    ds_wrxchg_rtn_b64 v[72:73], v94, v[76:77] offset:65408
    s_barrier
    s_setprio 3
    s_mov_b32 m0, s100
    s_nop 0
    ds_write_addtid_b32 v124 offset:34816
    ds_write_addtid_b32 v125 offset:35072
    ds_write_addtid_b32 v126 offset:35328
    ds_write_addtid_b32 v127 offset:35584
    s_add_u32 s3, s40, 4096
    buffer_load_dwordx4 v[124:127], v3, s[16:19], s3 offen sc1
    ds_write_addtid_b32 v116 offset:32768
    ds_write_addtid_b32 v117 offset:33024
    ds_write_addtid_b32 v118 offset:33280
    ds_write_addtid_b32 v119 offset:33536
    buffer_load_dwordx4 v[116:119], v3, s[16:19], s40 offen offset:2048 sc1
    ds_write_addtid_b32 v120 offset:33792
    ds_write_addtid_b32 v121 offset:34048
    ds_write_addtid_b32 v122 offset:34304
    ds_write_addtid_b32 v123 offset:34560
    buffer_load_dwordx4 v[120:123], v3, s[16:19], s40 offen offset:3072 sc1
    v_mfma_f32_4x4x4_16b_bf16 v[80:83], v[8:9], v[102:103], 0
    v_mfma_f32_4x4x4_16b_bf16 v[76:79], v[8:9], v[100:101], 0
    s_nop 3
    v_pk_mul_f32 v[80:81], v[80:81], v[14:15] op_sel:[0,1] op_sel_hi:[1,1]
    v_pk_mul_f32 v[82:83], v[82:83], v[14:15] op_sel:[0,1] op_sel_hi:[1,1]
    v_pk_mul_f32 v[76:77], v[76:77], v[14:15] op_sel:[0,0] op_sel_hi:[1,0]
    v_pk_mul_f32 v[78:79], v[78:79], v[14:15] op_sel:[0,0] op_sel_hi:[1,0]
    s_cmp_gt_u32 s37, 1024
    s_cbranch_scc1 L2_xs115
    s_cmp_lg_u32 s101, 0
    s_cbranch_scc1 L2_xa115
L2_xb115:
    v_lshlrev_b32 v89, 16, v96
    v_add_u32 v90, 60, v97
    v_bitop3_b32 v90, v89, v45, v90 bitop3:0x6a
    ds_write_b32 v98, v90 offset:12
    v_lshlrev_b32 v89, 20, v96
    v_add_u32 v90, 40, v97
    v_bitop3_b32 v90, v89, v45, v90 bitop3:0x6a
    ds_write_b32 v98, v90 offset:8
    v_lshlrev_b32 v89, 24, v96
    v_add_u32 v90, 20, v97
    v_bitop3_b32 v90, v89, v45, v90 bitop3:0x6a
    ds_write_b32 v98, v90 offset:4
    v_lshlrev_b32 v89, 28, v96
    v_bitop3_b32 v90, v89, v45, v97 bitop3:0x6a
    ds_write_b32 v98, v90 offset:0
    v_mov_b32_dpp v91, v66 quad_perm:[1,1,1,1] row_mask:0xf bank_mask:0xf
    v_and_b32 v89, 3, v91
    v_and_b32 v97, 0xfffc, v91
    v_sub_u16_dpp v88, v66, v91 quad_perm:[3,3,3,3] row_mask:0xf bank_mask:0xf
    v_mad_u32_u24 v97, v97, 5, v4
    v_add_u32 v99, v88, v89
    v_bfm_b32 v96, v88, v89
    v_cmp_lt_u32 s[58:59], 16, v99
    v_lshlrev_b32 v89, v1, v96
    v_and_b32 v89, v45, v89
    v_cmp_ne_u32 vcc, 0, v89
    v_xor_b32 v90, v97, v89
    s_add_u32 s3, s37, s38
    v_mbcnt_lo_u32_b32 v98, vcc_lo, 0
    v_mbcnt_hi_u32_b32 v98, vcc_hi, v98
    s_bcnt1_i32_b64 s41, vcc
    v_lshl_add_u32 v98, v98, 2, s3
    s_lshl2_add_u32 s37, s41, s37
    s_mov_b64 exec, vcc
    ds_write_b32 v98, v90
    s_mov_b64 exec, -1
    s_cmp_lg_u64 s[58:59], 0
    s_cbranch_scc1 L2_xe115
L2_xr115:
    v_add_u32 v98, s37, v0
    v_mov_b32 v90, -1
    ds_write_b32 v98, v90
L2_xw115:
    s_setprio 2
    s_waitcnt lgkmcnt(14)
    v_cmp_ne_u64 s[50:51], v[72:73], v[68:69]
    v_cmpx_ne_u64 s[54:55], v[74:75], v[70:71]
    s_and_b64 s[82:83], s[54:55], s[80:81]
    s_cbranch_scc1 L2_c116
L2_d116:
    v_mov_b64 v[84:85], v[70:71]
    v_mov_b32 v7, v95
    v_mov_b64 v[86:87], v[74:75]
    s_or_b64 s[80:81], s[80:81], s[54:55]
    s_mov_b64 exec, s[50:51]
    s_and_b64 s[82:83], s[50:51], s[80:81]
    s_cbranch_scc1 L2_c117
L2_d117:
    v_mov_b64 v[84:85], v[68:69]
    v_mov_b32 v7, v94
    v_mov_b64 v[86:87], v[72:73]
    s_mov_b64 exec, -1
    s_or_b64 s[80:81], s[80:81], s[50:51]
    ds_read_b64 v[70:71], v93 offset:65408
    ds_read_b64 v[68:69], v92 offset:65408
    v_and_b32 v46, 0x40000000, v43
    v_bitop3_b32 v94, v36, v5, v46 bitop3:0xea
    v_and_b32 v46, 0x80000000, v43
    v_bitop3_b32 v95, v37, v5, v46 bitop3:0xea
    v_perm_b32 v15, v37, v38, s47
    v_bitop3_b32 v46, v37, 0.5, -0.5 bitop3:0xa8
    v_perm_b32 v14, v36, v38, s46
    v_bitop3_b32 v47, v36, 0.5, -0.5 bitop3:0xa8
    v_bitop3_b32 v15, v6, v15, v46 bitop3:0xca
    v_bitop3_b32 v14, v6, v14, v47 bitop3:0xca
    s_setprio 1
    s_waitcnt lgkmcnt(1)
    v_mfma_f32_4x4x4_16b_bf16 v[80:83], v[10:11], v[70:71], v[80:83]
    s_waitcnt lgkmcnt(0)
    v_mfma_f32_4x4x4_16b_bf16 v[76:79], v[10:11], v[68:69], v[76:79]
    s_nop 2
    v_cvt_pk_bf16_f32 v80, v80, v81
    v_cvt_pk_bf16_f32 v81, v82, v83
    ds_wrxchg_rtn_b64 v[74:75], v93, v[80:81] offset:65408
    v_cvt_pk_bf16_f32 v76, v76, v77
    v_cvt_pk_bf16_f32 v77, v78, v79
    ds_wrxchg_rtn_b64 v[72:73], v92, v[76:77] offset:65408
    ds_read_b32 v40, v0 offset:0
    ds_read_b32 v41, v0 offset:256
    ds_read_b32 v42, v44 offset:768
    ds_read_b32 v43, v0 offset:512
    s_sub_u32 s3, s37, 768
    s_cmp_gt_u32 s3, 128
    s_cbranch_scc1 L2_xf115
L2_xg115:
    v_lshrrev_b64 v[64:65], 16, v[64:65]
    v_lshrrev_b64 v[66:67], 16, v[66:67]
    v_and_b32 v88, 0x0fffffff, v39
    buffer_load_dwordx2 v[34:35], v88, s[8:11], 0 offen
    buffer_load_dwordx3 v[36:38], v88, s[8:11], 0 offen offset:8
    s_setprio 0
    s_waitcnt vmcnt(12)
    s_mov_b32 m0, s38
    s_nop 0
    ds_write_addtid_b32 v108 offset:0
    ds_write_addtid_b32 v109 offset:256
    ds_write_addtid_b32 v110 offset:512
    ds_write_addtid_b32 v111 offset:768
    s_waitcnt vmcnt(9)
    ds_write_addtid_b32 v112 offset:1024
    ds_write_addtid_b32 v113 offset:1280
    ds_write_addtid_b32 v114 offset:1536
    ds_write_addtid_b32 v115 offset:1792
    v_mfma_f32_4x4x4_16b_bf16 v[80:83], v[8:9], v[106:107], 0
    v_mfma_f32_4x4x4_16b_bf16 v[76:79], v[8:9], v[104:105], 0
    v_cmp_lt_u32 s[84:85], v5, v94
    s_nop 2
    v_pk_mul_f32 v[80:81], v[80:81], v[14:15] op_sel:[0,1] op_sel_hi:[1,1]
    v_pk_mul_f32 v[82:83], v[82:83], v[14:15] op_sel:[0,1] op_sel_hi:[1,1]
    v_pk_mul_f32 v[76:77], v[76:77], v[14:15] op_sel:[0,0] op_sel_hi:[1,0]
    v_pk_mul_f32 v[78:79], v[78:79], v[14:15] op_sel:[0,0] op_sel_hi:[1,0]
    s_add_u32 s42, s42, 1
    s_waitcnt lgkmcnt(0)
    s_cmp_lg_u32 s42, 14
    s_cbranch_scc1 L2_loop
    s_barrier
    s_bitcmp1_b32 s36, s42
    s_cbranch_scc1 L2_slow
L2_ret6:
    s_setprio 3
    s_bitcmp1_b32 s43, s42
    s_cbranch_scc1 L2_oa118
L2_ob118:
    v_and_b32 v46, 0x20000000, v21
    v_lshrrev_b32 v47, 14, v17
    v_bitop3_b32 v47, v47, v5, v46 bitop3:0xea
    ds_read_b64 v[102:103], v47
    v_and_b32 v99, 0x10000000, v21
    v_lshrrev_b32 v47, 14, v16
    v_bitop3_b32 v47, v47, v5, v99 bitop3:0xea
    ds_read_b64 v[100:101], v47
    v_cmp_ne_u64 s[50:51], v[72:73], v[68:69]
    v_cmpx_ne_u64 s[54:55], v[74:75], v[70:71]
    s_and_b64 s[82:83], s[54:55], s[80:81]
    s_cbranch_scc1 L2_c119
L2_d119:
    v_mov_b64 v[84:85], v[70:71]
    v_mov_b32 v7, v93
    v_mov_b64 v[86:87], v[74:75]
    s_or_b64 s[80:81], s[80:81], s[54:55]
    s_mov_b64 exec, s[50:51]
    s_and_b64 s[82:83], s[50:51], s[80:81]
    s_cbranch_scc1 L2_c120
L2_d120:
    v_mov_b64 v[84:85], v[68:69]
    v_mov_b32 v7, v92
    v_mov_b64 v[86:87], v[72:73]
    s_mov_b64 exec, -1
    s_or_b64 s[80:81], s[80:81], s[50:51]
    s_and_b64 exec, s[84:85], s[80:81]
    v_mfma_f32_4x4x4_16b_bf16 v[76:79], v[12:13], v[84:85], 0
    v_mov_b32 v94, v7
    s_andn2_b64 s[80:81], s[80:81], s[84:85]
    v_mfma_f32_4x4x4_16b_bf16 v[76:79], v[10:11], v[86:87], v[76:79]
    s_mov_b64 exec, -1
    ds_read_b64 v[70:71], v95 offset:65408
    ds_read_b64 v[68:69], v94 offset:65408
    v_bitop3_b32 v92, v16, v5, v99 bitop3:0xea
    v_bitop3_b32 v93, v17, v5, v46 bitop3:0xea
    v_perm_b32 v15, v17, v20, s45
    v_bitop3_b32 v46, v17, 0.5, -0.5 bitop3:0xa8
    v_perm_b32 v14, v16, v20, s44
    v_bitop3_b32 v47, v16, 0.5, -0.5 bitop3:0xa8
    v_bitop3_b32 v15, v6, v15, v46 bitop3:0xca
    v_bitop3_b32 v14, v6, v14, v47 bitop3:0xca
    s_waitcnt lgkmcnt(1)
    v_mfma_f32_4x4x4_16b_bf16 v[80:83], v[10:11], v[70:71], v[80:83]
    s_waitcnt lgkmcnt(0)
    v_mfma_f32_4x4x4_16b_bf16 v[76:79], v[10:11], v[68:69], v[76:79]
    s_nop 2
    v_cvt_pk_bf16_f32 v80, v80, v81
    v_cvt_pk_bf16_f32 v81, v82, v83
    ds_wrxchg_rtn_b64 v[74:75], v95, v[80:81] offset:65408
    v_cvt_pk_bf16_f32 v76, v76, v77
    v_cvt_pk_bf16_f32 v77, v78, v79
    ds_wrxchg_rtn_b64 v[72:73], v94, v[76:77] offset:65408
    v_mfma_f32_4x4x4_16b_bf16 v[80:83], v[8:9], v[102:103], 0
    v_mfma_f32_4x4x4_16b_bf16 v[76:79], v[8:9], v[100:101], 0
    v_cmp_lt_u32 s[84:85], v5, v92
    s_nop 2
    v_pk_mul_f32 v[80:81], v[80:81], v[14:15] op_sel:[0,1] op_sel_hi:[1,1]
    v_pk_mul_f32 v[82:83], v[82:83], v[14:15] op_sel:[0,1] op_sel_hi:[1,1]
    v_pk_mul_f32 v[76:77], v[76:77], v[14:15] op_sel:[0,0] op_sel_hi:[1,0]
    v_pk_mul_f32 v[78:79], v[78:79], v[14:15] op_sel:[0,0] op_sel_hi:[1,0]
    buffer_load_dwordx4 v[108:111], v3, s[16:19], s40 offen offset:0 sc1
    v_and_b32 v46, 0x80000000, v21
    v_lshrrev_b32 v47, 14, v19
    v_bitop3_b32 v47, v47, v5, v46 bitop3:0xea
    ds_read_b64 v[106:107], v47
    v_and_b32 v99, 0x40000000, v21
    v_lshrrev_b32 v47, 14, v18
    v_bitop3_b32 v47, v47, v5, v99 bitop3:0xea
    ds_read_b64 v[104:105], v47
    s_waitcnt lgkmcnt(2)
    v_cmp_ne_u64 s[50:51], v[72:73], v[68:69]
    v_cmpx_ne_u64 s[54:55], v[74:75], v[70:71]
    s_and_b64 s[82:83], s[54:55], s[80:81]
    s_cbranch_scc1 L2_c121
L2_d121:
    v_mov_b64 v[84:85], v[70:71]
    v_mov_b32 v7, v95
    v_mov_b64 v[86:87], v[74:75]
    s_or_b64 s[80:81], s[80:81], s[54:55]
    s_mov_b64 exec, s[50:51]
    s_and_b64 s[82:83], s[50:51], s[80:81]
    s_cbranch_scc1 L2_c122
L2_d122:
    v_mov_b64 v[84:85], v[68:69]
    v_mov_b32 v7, v94
    v_mov_b64 v[86:87], v[72:73]
    s_mov_b64 exec, -1
    s_or_b64 s[80:81], s[80:81], s[50:51]
    s_and_b64 exec, s[84:85], s[80:81]
    v_mfma_f32_4x4x4_16b_bf16 v[76:79], v[12:13], v[84:85], 0
    v_mov_b32 v92, v7
    s_andn2_b64 s[80:81], s[80:81], s[84:85]
    v_mfma_f32_4x4x4_16b_bf16 v[76:79], v[10:11], v[86:87], v[76:79]
    s_mov_b64 exec, -1
    ds_read_b64 v[70:71], v93 offset:65408
    ds_read_b64 v[68:69], v92 offset:65408
    v_bitop3_b32 v94, v18, v5, v99 bitop3:0xea
    v_bitop3_b32 v95, v19, v5, v46 bitop3:0xea
    v_perm_b32 v15, v19, v20, s47
    v_bitop3_b32 v46, v19, 0.5, -0.5 bitop3:0xa8
    v_perm_b32 v14, v18, v20, s46
    v_bitop3_b32 v47, v18, 0.5, -0.5 bitop3:0xa8
    v_bitop3_b32 v15, v6, v15, v46 bitop3:0xca
    v_bitop3_b32 v14, v6, v14, v47 bitop3:0xca
    s_waitcnt lgkmcnt(1)
    v_mfma_f32_4x4x4_16b_bf16 v[80:83], v[10:11], v[70:71], v[80:83]
    s_waitcnt lgkmcnt(0)
    v_mfma_f32_4x4x4_16b_bf16 v[76:79], v[10:11], v[68:69], v[76:79]
    s_nop 2
    v_cvt_pk_bf16_f32 v80, v80, v81
    v_cvt_pk_bf16_f32 v81, v82, v83
    ds_wrxchg_rtn_b64 v[74:75], v93, v[80:81] offset:65408
    v_cvt_pk_bf16_f32 v76, v76, v77
    v_cvt_pk_bf16_f32 v77, v78, v79
    ds_wrxchg_rtn_b64 v[72:73], v92, v[76:77] offset:65408
    v_and_b32 v88, 0x0fffffff, v40
    buffer_load_dwordx2 v[16:17], v88, s[8:11], 0 offen
    buffer_load_dwordx3 v[18:20], v88, s[8:11], 0 offen offset:8
    v_mfma_f32_4x4x4_16b_bf16 v[80:83], v[8:9], v[106:107], 0
    v_mfma_f32_4x4x4_16b_bf16 v[76:79], v[8:9], v[104:105], 0
    v_cmp_lt_u32 s[48:49], v5, v95
    s_nop 2
    v_pk_mul_f32 v[80:81], v[80:81], v[14:15] op_sel:[0,1] op_sel_hi:[1,1]
    v_pk_mul_f32 v[82:83], v[82:83], v[14:15] op_sel:[0,1] op_sel_hi:[1,1]
    v_pk_mul_f32 v[76:77], v[76:77], v[14:15] op_sel:[0,0] op_sel_hi:[1,0]
    v_pk_mul_f32 v[78:79], v[78:79], v[14:15] op_sel:[0,0] op_sel_hi:[1,0]
    s_waitcnt vmcnt(10)
    v_and_b32 v46, 0x20000000, v27
    v_lshrrev_b32 v47, 14, v23
    v_bitop3_b32 v47, v47, v5, v46 bitop3:0xea
    ds_read_b64 v[102:103], v47
    v_and_b32 v99, 0x10000000, v27
    v_lshrrev_b32 v47, 14, v22
    v_bitop3_b32 v47, v47, v5, v99 bitop3:0xea
    ds_read_b64 v[100:101], v47
    s_waitcnt lgkmcnt(2)
    v_cmp_ne_u64 s[50:51], v[72:73], v[68:69]
    v_cmpx_ne_u64 s[54:55], v[74:75], v[70:71]
    s_and_b64 s[82:83], s[54:55], s[80:81]
    s_cbranch_scc1 L2_c123
L2_d123:
    v_mov_b64 v[84:85], v[70:71]
    v_mov_b32 v7, v93
    v_mov_b64 v[86:87], v[74:75]
    s_or_b64 s[80:81], s[80:81], s[54:55]
    s_mov_b64 exec, s[50:51]
    s_and_b64 s[82:83], s[50:51], s[80:81]
    s_cbranch_scc1 L2_c124
L2_d124:
    v_mov_b64 v[84:85], v[68:69]
    v_mov_b32 v7, v92
    v_mov_b64 v[86:87], v[72:73]
    s_mov_b64 exec, -1
    s_or_b64 s[80:81], s[80:81], s[50:51]
    s_and_b64 exec, s[48:49], s[80:81]
    v_mfma_f32_4x4x4_16b_bf16 v[80:83], v[12:13], v[84:85], 0
    v_mov_b32 v95, v7
    s_andn2_b64 s[80:81], s[80:81], s[48:49]
    v_mfma_f32_4x4x4_16b_bf16 v[80:83], v[10:11], v[86:87], v[80:83]
    s_mov_b64 exec, -1
    ds_read_b64 v[70:71], v95 offset:65408
    ds_read_b64 v[68:69], v94 offset:65408
    v_bitop3_b32 v92, v22, v5, v99 bitop3:0xea
    v_bitop3_b32 v93, v23, v5, v46 bitop3:0xea
    v_perm_b32 v15, v23, v26, s45
    v_bitop3_b32 v46, v23, 0.5, -0.5 bitop3:0xa8
    v_perm_b32 v14, v22, v26, s44
    v_bitop3_b32 v47, v22, 0.5, -0.5 bitop3:0xa8
    v_bitop3_b32 v15, v6, v15, v46 bitop3:0xca
    v_bitop3_b32 v14, v6, v14, v47 bitop3:0xca
    s_waitcnt lgkmcnt(1)
    v_mfma_f32_4x4x4_16b_bf16 v[80:83], v[10:11], v[70:71], v[80:83]
    s_waitcnt lgkmcnt(0)
    v_mfma_f32_4x4x4_16b_bf16 v[76:79], v[10:11], v[68:69], v[76:79]
    s_nop 2
    v_cvt_pk_bf16_f32 v80, v80, v81
    v_cvt_pk_bf16_f32 v81, v82, v83
    ds_wrxchg_rtn_b64 v[74:75], v95, v[80:81] offset:65408
    v_cvt_pk_bf16_f32 v76, v76, v77
    v_cvt_pk_bf16_f32 v77, v78, v79
    ds_wrxchg_rtn_b64 v[72:73], v94, v[76:77] offset:65408
    s_setprio 2
    v_mfma_f32_4x4x4_16b_bf16 v[80:83], v[8:9], v[102:103], 0
    v_mfma_f32_4x4x4_16b_bf16 v[76:79], v[8:9], v[100:101], 0
    s_nop 3
    v_pk_mul_f32 v[80:81], v[80:81], v[14:15] op_sel:[0,1] op_sel_hi:[1,1]
    v_pk_mul_f32 v[82:83], v[82:83], v[14:15] op_sel:[0,1] op_sel_hi:[1,1]
    v_pk_mul_f32 v[76:77], v[76:77], v[14:15] op_sel:[0,0] op_sel_hi:[1,0]
    v_pk_mul_f32 v[78:79], v[78:79], v[14:15] op_sel:[0,0] op_sel_hi:[1,0]
    s_bitcmp1_b32 s43, s42
    s_cbranch_scc1 L2_oa125
L2_ob125:
    buffer_load_dwordx4 v[112:115], v3, s[16:19], s40 offen offset:1024 sc1
    v_and_b32 v46, 0x80000000, v27
    v_lshrrev_b32 v47, 14, v25
    v_bitop3_b32 v47, v47, v5, v46 bitop3:0xea
    ds_read_b64 v[106:107], v47
    v_and_b32 v99, 0x40000000, v27
    v_lshrrev_b32 v47, 14, v24
    v_bitop3_b32 v47, v47, v5, v99 bitop3:0xea
    ds_read_b64 v[104:105], v47
    s_waitcnt lgkmcnt(2)
    v_cmp_ne_u64 s[50:51], v[72:73], v[68:69]
    v_cmpx_ne_u64 s[54:55], v[74:75], v[70:71]
    s_and_b64 s[82:83], s[54:55], s[80:81]
    s_cbranch_scc1 L2_c126
L2_d126:
    v_mov_b64 v[84:85], v[70:71]
    v_mov_b32 v7, v95
    v_mov_b64 v[86:87], v[74:75]
    s_or_b64 s[80:81], s[80:81], s[54:55]
    s_mov_b64 exec, s[50:51]
    s_and_b64 s[82:83], s[50:51], s[80:81]
    s_cbranch_scc1 L2_c127
L2_d127:
    v_mov_b64 v[84:85], v[68:69]
    v_mov_b32 v7, v94
    v_mov_b64 v[86:87], v[72:73]
    s_mov_b64 exec, -1
    s_or_b64 s[80:81], s[80:81], s[50:51]
    ds_read_b64 v[70:71], v93 offset:65408
    ds_read_b64 v[68:69], v92 offset:65408
    v_bitop3_b32 v94, v24, v5, v99 bitop3:0xea
    v_bitop3_b32 v95, v25, v5, v46 bitop3:0xea
    v_perm_b32 v15, v25, v26, s47
    v_bitop3_b32 v46, v25, 0.5, -0.5 bitop3:0xa8
    v_perm_b32 v14, v24, v26, s46
    v_bitop3_b32 v47, v24, 0.5, -0.5 bitop3:0xa8
    v_bitop3_b32 v15, v6, v15, v46 bitop3:0xca
    v_bitop3_b32 v14, v6, v14, v47 bitop3:0xca
    s_waitcnt lgkmcnt(1)
    v_mfma_f32_4x4x4_16b_bf16 v[80:83], v[10:11], v[70:71], v[80:83]
    s_waitcnt lgkmcnt(0)
    v_mfma_f32_4x4x4_16b_bf16 v[76:79], v[10:11], v[68:69], v[76:79]
    s_nop 2
    v_cvt_pk_bf16_f32 v80, v80, v81
    v_cvt_pk_bf16_f32 v81, v82, v83
    ds_wrxchg_rtn_b64 v[74:75], v93, v[80:81] offset:65408
    v_cvt_pk_bf16_f32 v76, v76, v77
    v_cvt_pk_bf16_f32 v77, v78, v79
    ds_wrxchg_rtn_b64 v[72:73], v92, v[76:77] offset:65408
    v_and_b32 v88, 0x0fffffff, v41
    buffer_load_dwordx2 v[22:23], v88, s[8:11], 0 offen
    buffer_load_dwordx3 v[24:26], v88, s[8:11], 0 offen offset:8
    s_setprio 1
    v_mfma_f32_4x4x4_16b_bf16 v[80:83], v[8:9], v[106:107], 0
    v_mfma_f32_4x4x4_16b_bf16 v[76:79], v[8:9], v[104:105], 0
    v_cmp_lt_u32 s[84:85], v5, v94
    s_nop 2
    v_pk_mul_f32 v[80:81], v[80:81], v[14:15] op_sel:[0,1] op_sel_hi:[1,1]
    v_pk_mul_f32 v[82:83], v[82:83], v[14:15] op_sel:[0,1] op_sel_hi:[1,1]
    v_pk_mul_f32 v[76:77], v[76:77], v[14:15] op_sel:[0,0] op_sel_hi:[1,0]
    v_pk_mul_f32 v[78:79], v[78:79], v[14:15] op_sel:[0,0] op_sel_hi:[1,0]
    s_waitcnt vmcnt(11)
    s_mov_b64 exec, s[6:7]
    v_lshrrev_b32 v30, 16, v30
    s_mov_b64 exec, -1
    v_and_b32 v46, 0x20000000, v31
    v_lshrrev_b32 v47, 14, v29
    v_bitop3_b32 v47, v47, v5, v46 bitop3:0xea
    ds_read_b64 v[102:103], v47
    v_and_b32 v99, 0x10000000, v31
    v_lshrrev_b32 v47, 14, v28
    v_bitop3_b32 v47, v47, v5, v99 bitop3:0xea
    ds_read_b64 v[100:101], v47
    s_waitcnt lgkmcnt(2)
    v_cmp_ne_u64 s[50:51], v[72:73], v[68:69]
    v_cmpx_ne_u64 s[54:55], v[74:75], v[70:71]
    s_and_b64 s[82:83], s[54:55], s[80:81]
    s_cbranch_scc1 L2_c128
L2_d128:
    v_mov_b64 v[84:85], v[70:71]
    v_mov_b32 v7, v93
    v_mov_b64 v[86:87], v[74:75]
    s_or_b64 s[80:81], s[80:81], s[54:55]
    s_mov_b64 exec, s[50:51]
    s_and_b64 s[82:83], s[50:51], s[80:81]
    s_cbranch_scc1 L2_c129
L2_d129:
    v_mov_b64 v[84:85], v[68:69]
    v_mov_b32 v7, v92
    v_mov_b64 v[86:87], v[72:73]
    s_mov_b64 exec, -1
    s_or_b64 s[80:81], s[80:81], s[50:51]
    s_and_b64 exec, s[84:85], s[80:81]
    v_mfma_f32_4x4x4_16b_bf16 v[76:79], v[12:13], v[84:85], 0
    v_mov_b32 v94, v7
    s_andn2_b64 s[80:81], s[80:81], s[84:85]
    v_mfma_f32_4x4x4_16b_bf16 v[76:79], v[10:11], v[86:87], v[76:79]
    s_mov_b64 exec, -1
    ds_read_b64 v[70:71], v95 offset:65408
    ds_read_b64 v[68:69], v94 offset:65408
    v_bitop3_b32 v92, v28, v5, v99 bitop3:0xea
    v_bitop3_b32 v93, v29, v5, v46 bitop3:0xea
    v_perm_b32 v15, v29, v30, s45
    v_bitop3_b32 v46, v29, 0.5, -0.5 bitop3:0xa8
    v_perm_b32 v14, v28, v30, s44
    v_bitop3_b32 v47, v28, 0.5, -0.5 bitop3:0xa8
    v_bitop3_b32 v15, v6, v15, v46 bitop3:0xca
    v_bitop3_b32 v14, v6, v14, v47 bitop3:0xca
    s_waitcnt lgkmcnt(1)
    v_mfma_f32_4x4x4_16b_bf16 v[80:83], v[10:11], v[70:71], v[80:83]
    s_waitcnt lgkmcnt(0)
    v_mfma_f32_4x4x4_16b_bf16 v[76:79], v[10:11], v[68:69], v[76:79]
    s_nop 2
    v_cvt_pk_bf16_f32 v80, v80, v81
    v_cvt_pk_bf16_f32 v81, v82, v83
    ds_wrxchg_rtn_b64 v[74:75], v95, v[80:81] offset:65408
    v_cvt_pk_bf16_f32 v76, v76, v77
    v_cvt_pk_bf16_f32 v77, v78, v79
    ds_wrxchg_rtn_b64 v[72:73], v94, v[76:77] offset:65408
    s_setprio 0
    v_mfma_f32_4x4x4_16b_bf16 v[80:83], v[8:9], v[102:103], 0
    v_mfma_f32_4x4x4_16b_bf16 v[76:79], v[8:9], v[100:101], 0
    v_cmp_lt_u32 s[48:49], v5, v93
    s_nop 2
    v_pk_mul_f32 v[80:81], v[80:81], v[14:15] op_sel:[0,1] op_sel_hi:[1,1]
    v_pk_mul_f32 v[82:83], v[82:83], v[14:15] op_sel:[0,1] op_sel_hi:[1,1]
    v_pk_mul_f32 v[76:77], v[76:77], v[14:15] op_sel:[0,0] op_sel_hi:[1,0]
    v_pk_mul_f32 v[78:79], v[78:79], v[14:15] op_sel:[0,0] op_sel_hi:[1,0]
    s_add_u32 s40, s40, 0xfff24000
    v_and_b32 v47, 0x0fffffff, v42
    buffer_load_dword v30, v47, s[8:11], 0 offen offset:16
    s_mov_b64 exec, s[6:7]
    v_add_u32 v47, 8, v47
    v_lshrrev_b32 v42, 2, v42
    s_mov_b64 exec, -1
    buffer_load_dwordx2 v[28:29], v47, s[8:11], 0 offen
    s_waitcnt vmcnt(8)
    v_and_b32 v46, 0x80000000, v39
    v_lshrrev_b32 v47, 14, v37
    v_bitop3_b32 v47, v47, v5, v46 bitop3:0xea
    ds_read_b64 v[102:103], v47
    v_and_b32 v99, 0x40000000, v39
    v_lshrrev_b32 v47, 14, v36
    v_bitop3_b32 v47, v47, v5, v99 bitop3:0xea
    ds_read_b64 v[100:101], v47
    v_and_b32 v46, 0x20000000, v39
    v_lshrrev_b32 v47, 14, v35
    v_bitop3_b32 v47, v47, v5, v46 bitop3:0xea
    ds_read_b64 v[106:107], v47
    v_and_b32 v99, 0x10000000, v39
    v_lshrrev_b32 v47, 14, v34
    v_bitop3_b32 v47, v47, v5, v99 bitop3:0xea
    ds_read_b64 v[104:105], v47
    s_waitcnt lgkmcnt(4)
    v_cmp_ne_u64 s[50:51], v[72:73], v[68:69]
    v_cmpx_ne_u64 s[54:55], v[74:75], v[70:71]
    s_and_b64 s[82:83], s[54:55], s[80:81]
    s_cbranch_scc1 L2_c130
L2_d130:
    v_mov_b64 v[84:85], v[70:71]
    v_mov_b32 v7, v95
    v_mov_b64 v[86:87], v[74:75]
    s_or_b64 s[80:81], s[80:81], s[54:55]
    s_mov_b64 exec, s[50:51]
    s_and_b64 s[82:83], s[50:51], s[80:81]
    s_cbranch_scc1 L2_c131
L2_d131:
    v_mov_b64 v[84:85], v[68:69]
    v_mov_b32 v7, v94
    v_mov_b64 v[86:87], v[72:73]
    s_mov_b64 exec, -1
    s_or_b64 s[80:81], s[80:81], s[50:51]
    s_and_b64 exec, s[48:49], s[80:81]
    v_mfma_f32_4x4x4_16b_bf16 v[80:83], v[12:13], v[84:85], 0
    v_mov_b32 v93, v7
    s_andn2_b64 s[80:81], s[80:81], s[48:49]
    v_mfma_f32_4x4x4_16b_bf16 v[80:83], v[10:11], v[86:87], v[80:83]
    s_mov_b64 exec, -1
    ds_read_b64 v[70:71], v93 offset:65408
    ds_read_b64 v[68:69], v92 offset:65408
    v_bitop3_b32 v94, v34, v5, v99 bitop3:0xea
    v_bitop3_b32 v95, v35, v5, v46 bitop3:0xea
    v_perm_b32 v15, v35, v38, s45
    v_bitop3_b32 v46, v35, 0.5, -0.5 bitop3:0xa8
    v_perm_b32 v14, v34, v38, s44
    v_bitop3_b32 v47, v34, 0.5, -0.5 bitop3:0xa8
    v_bitop3_b32 v15, v6, v15, v46 bitop3:0xca
    v_bitop3_b32 v14, v6, v14, v47 bitop3:0xca
    s_waitcnt lgkmcnt(1)
    v_mfma_f32_4x4x4_16b_bf16 v[80:83], v[10:11], v[70:71], v[80:83]
    s_waitcnt lgkmcnt(0)
    v_mfma_f32_4x4x4_16b_bf16 v[76:79], v[10:11], v[68:69], v[76:79]
    s_nop 2
    v_cvt_pk_bf16_f32 v80, v80, v81
    v_cvt_pk_bf16_f32 v81, v82, v83
    ds_wrxchg_rtn_b64 v[74:75], v93, v[80:81] offset:65408
    v_cvt_pk_bf16_f32 v76, v76, v77
    v_cvt_pk_bf16_f32 v77, v78, v79
    ds_wrxchg_rtn_b64 v[72:73], v92, v[76:77] offset:65408
    s_barrier
    s_setprio 3
    s_mov_b32 m0, s100
    s_nop 0
    ds_write_addtid_b32 v124 offset:34816
    ds_write_addtid_b32 v125 offset:35072
    ds_write_addtid_b32 v126 offset:35328
    ds_write_addtid_b32 v127 offset:35584
    ds_write_addtid_b32 v116 offset:32768
    ds_write_addtid_b32 v117 offset:33024
    ds_write_addtid_b32 v118 offset:33280
    ds_write_addtid_b32 v119 offset:33536
    ds_write_addtid_b32 v120 offset:33792
    ds_write_addtid_b32 v121 offset:34048
    ds_write_addtid_b32 v122 offset:34304
    ds_write_addtid_b32 v123 offset:34560
    v_mfma_f32_4x4x4_16b_bf16 v[80:83], v[8:9], v[106:107], 0
    v_mfma_f32_4x4x4_16b_bf16 v[76:79], v[8:9], v[104:105], 0
    s_nop 3
    v_pk_mul_f32 v[80:81], v[80:81], v[14:15] op_sel:[0,1] op_sel_hi:[1,1]
    v_pk_mul_f32 v[82:83], v[82:83], v[14:15] op_sel:[0,1] op_sel_hi:[1,1]
    v_pk_mul_f32 v[76:77], v[76:77], v[14:15] op_sel:[0,0] op_sel_hi:[1,0]
    v_pk_mul_f32 v[78:79], v[78:79], v[14:15] op_sel:[0,0] op_sel_hi:[1,0]
    s_setprio 2
    s_waitcnt lgkmcnt(12)
    v_cmp_ne_u64 s[50:51], v[72:73], v[68:69]
    v_cmpx_ne_u64 s[54:55], v[74:75], v[70:71]
    s_and_b64 s[82:83], s[54:55], s[80:81]
    s_cbranch_scc1 L2_c132
L2_d132:
    v_mov_b64 v[84:85], v[70:71]
    v_mov_b32 v7, v93
    v_mov_b64 v[86:87], v[74:75]
    s_or_b64 s[80:81], s[80:81], s[54:55]
    s_mov_b64 exec, s[50:51]
    s_and_b64 s[82:83], s[50:51], s[80:81]
    s_cbranch_scc1 L2_c133
L2_d133:
    v_mov_b64 v[84:85], v[68:69]
    v_mov_b32 v7, v92
    v_mov_b64 v[86:87], v[72:73]
    s_mov_b64 exec, -1
    s_or_b64 s[80:81], s[80:81], s[50:51]
    ds_read_b64 v[70:71], v95 offset:65408
    ds_read_b64 v[68:69], v94 offset:65408
    v_and_b32 v46, 0x40000000, v39
    v_bitop3_b32 v92, v36, v5, v46 bitop3:0xea
    v_and_b32 v46, 0x80000000, v39
    v_bitop3_b32 v93, v37, v5, v46 bitop3:0xea
    v_perm_b32 v15, v37, v38, s47
    v_bitop3_b32 v46, v37, 0.5, -0.5 bitop3:0xa8
    v_perm_b32 v14, v36, v38, s46
    v_bitop3_b32 v47, v36, 0.5, -0.5 bitop3:0xa8
    v_bitop3_b32 v15, v6, v15, v46 bitop3:0xca
    v_bitop3_b32 v14, v6, v14, v47 bitop3:0xca
    s_setprio 1
    s_waitcnt lgkmcnt(1)
    v_mfma_f32_4x4x4_16b_bf16 v[80:83], v[10:11], v[70:71], v[80:83]
    s_waitcnt lgkmcnt(0)
    v_mfma_f32_4x4x4_16b_bf16 v[76:79], v[10:11], v[68:69], v[76:79]
    s_nop 2
    v_cvt_pk_bf16_f32 v80, v80, v81
    v_cvt_pk_bf16_f32 v81, v82, v83
    ds_wrxchg_rtn_b64 v[74:75], v95, v[80:81] offset:65408
    v_cvt_pk_bf16_f32 v76, v76, v77
    v_cvt_pk_bf16_f32 v77, v78, v79
    ds_wrxchg_rtn_b64 v[72:73], v94, v[76:77] offset:65408
    v_and_b32 v88, 0x0fffffff, v43
    buffer_load_dwordx2 v[34:35], v88, s[8:11], 0 offen
    buffer_load_dwordx3 v[36:38], v88, s[8:11], 0 offen offset:8
    s_setprio 0
    s_waitcnt vmcnt(9)
    s_mov_b32 m0, s38
    s_nop 0
    ds_write_addtid_b32 v108 offset:0
    ds_write_addtid_b32 v109 offset:256
    ds_write_addtid_b32 v110 offset:512
    ds_write_addtid_b32 v111 offset:768
    s_waitcnt vmcnt(6)
    ds_write_addtid_b32 v112 offset:1024
    ds_write_addtid_b32 v113 offset:1280
    ds_write_addtid_b32 v114 offset:1536
    ds_write_addtid_b32 v115 offset:1792
    v_mfma_f32_4x4x4_16b_bf16 v[80:83], v[8:9], v[102:103], 0
    v_mfma_f32_4x4x4_16b_bf16 v[76:79], v[8:9], v[100:101], 0
    v_cmp_lt_u32 s[84:85], v5, v92
    s_nop 2
    v_pk_mul_f32 v[80:81], v[80:81], v[14:15] op_sel:[0,1] op_sel_hi:[1,1]
    v_pk_mul_f32 v[82:83], v[82:83], v[14:15] op_sel:[0,1] op_sel_hi:[1,1]
    v_pk_mul_f32 v[76:77], v[76:77], v[14:15] op_sel:[0,0] op_sel_hi:[1,0]
    v_pk_mul_f32 v[78:79], v[78:79], v[14:15] op_sel:[0,0] op_sel_hi:[1,0]
    s_add_u32 s42, s42, 1
    s_waitcnt lgkmcnt(0)
    s_barrier
    s_bitcmp1_b32 s36, s42
    s_cbranch_scc1 L2_slow
L2_ret7:
    s_setprio 3
    s_bitcmp1_b32 s43, s42
    s_cbranch_scc1 L2_oa134
L2_ob134:
    v_and_b32 v46, 0x20000000, v40
    v_lshrrev_b32 v47, 14, v17
    v_bitop3_b32 v47, v47, v5, v46 bitop3:0xea
    ds_read_b64 v[106:107], v47
    v_and_b32 v99, 0x10000000, v40
    v_lshrrev_b32 v47, 14, v16
    v_bitop3_b32 v47, v47, v5, v99 bitop3:0xea
    ds_read_b64 v[104:105], v47
    v_cmp_ne_u64 s[50:51], v[72:73], v[68:69]
    v_cmpx_ne_u64 s[54:55], v[74:75], v[70:71]
    s_and_b64 s[82:83], s[54:55], s[80:81]
    s_cbranch_scc1 L2_c135
L2_d135:
    v_mov_b64 v[84:85], v[70:71]
    v_mov_b32 v7, v95
    v_mov_b64 v[86:87], v[74:75]
    s_or_b64 s[80:81], s[80:81], s[54:55]
    s_mov_b64 exec, s[50:51]
    s_and_b64 s[82:83], s[50:51], s[80:81]
    s_cbranch_scc1 L2_c136
L2_d136:
    v_mov_b64 v[84:85], v[68:69]
    v_mov_b32 v7, v94
    v_mov_b64 v[86:87], v[72:73]
    s_mov_b64 exec, -1
    s_or_b64 s[80:81], s[80:81], s[50:51]
    s_and_b64 exec, s[84:85], s[80:81]
    v_mfma_f32_4x4x4_16b_bf16 v[76:79], v[12:13], v[84:85], 0
    v_mov_b32 v92, v7
    s_andn2_b64 s[80:81], s[80:81], s[84:85]
    v_mfma_f32_4x4x4_16b_bf16 v[76:79], v[10:11], v[86:87], v[76:79]
    s_mov_b64 exec, -1
    ds_read_b64 v[70:71], v93 offset:65408
    ds_read_b64 v[68:69], v92 offset:65408
    v_bitop3_b32 v94, v16, v5, v99 bitop3:0xea
    v_bitop3_b32 v95, v17, v5, v46 bitop3:0xea
    v_perm_b32 v15, v17, v20, s45
    v_bitop3_b32 v46, v17, 0.5, -0.5 bitop3:0xa8
    v_perm_b32 v14, v16, v20, s44
    v_bitop3_b32 v47, v16, 0.5, -0.5 bitop3:0xa8
    v_bitop3_b32 v15, v6, v15, v46 bitop3:0xca
    v_bitop3_b32 v14, v6, v14, v47 bitop3:0xca
    s_waitcnt lgkmcnt(1)
    v_mfma_f32_4x4x4_16b_bf16 v[80:83], v[10:11], v[70:71], v[80:83]
    s_waitcnt lgkmcnt(0)
    v_mfma_f32_4x4x4_16b_bf16 v[76:79], v[10:11], v[68:69], v[76:79]
    s_nop 2
    v_cvt_pk_bf16_f32 v80, v80, v81
    v_cvt_pk_bf16_f32 v81, v82, v83
    ds_wrxchg_rtn_b64 v[74:75], v93, v[80:81] offset:65408
    v_cvt_pk_bf16_f32 v76, v76, v77
    v_cvt_pk_bf16_f32 v77, v78, v79
    ds_wrxchg_rtn_b64 v[72:73], v92, v[76:77] offset:65408
    v_mfma_f32_4x4x4_16b_bf16 v[80:83], v[8:9], v[106:107], 0
    v_mfma_f32_4x4x4_16b_bf16 v[76:79], v[8:9], v[104:105], 0
    v_cmp_lt_u32 s[84:85], v5, v94
    s_nop 2
    v_pk_mul_f32 v[80:81], v[80:81], v[14:15] op_sel:[0,1] op_sel_hi:[1,1]
    v_pk_mul_f32 v[82:83], v[82:83], v[14:15] op_sel:[0,1] op_sel_hi:[1,1]
    v_pk_mul_f32 v[76:77], v[76:77], v[14:15] op_sel:[0,0] op_sel_hi:[1,0]
    v_pk_mul_f32 v[78:79], v[78:79], v[14:15] op_sel:[0,0] op_sel_hi:[1,0]
    v_and_b32 v46, 0x80000000, v40
    v_lshrrev_b32 v47, 14, v19
    v_bitop3_b32 v47, v47, v5, v46 bitop3:0xea
    ds_read_b64 v[102:103], v47
    v_and_b32 v99, 0x40000000, v40
    v_lshrrev_b32 v47, 14, v18
    v_bitop3_b32 v47, v47, v5, v99 bitop3:0xea
    ds_read_b64 v[100:101], v47
    s_waitcnt lgkmcnt(2)
    v_cmp_ne_u64 s[50:51], v[72:73], v[68:69]
    v_cmpx_ne_u64 s[54:55], v[74:75], v[70:71]
    s_and_b64 s[82:83], s[54:55], s[80:81]
    s_cbranch_scc1 L2_c137
L2_d137:
    v_mov_b64 v[84:85], v[70:71]
    v_mov_b32 v7, v93
    v_mov_b64 v[86:87], v[74:75]
    s_or_b64 s[80:81], s[80:81], s[54:55]
    s_mov_b64 exec, s[50:51]
    s_and_b64 s[82:83], s[50:51], s[80:81]
    s_cbranch_scc1 L2_c138
L2_d138:
    v_mov_b64 v[84:85], v[68:69]
    v_mov_b32 v7, v92
    v_mov_b64 v[86:87], v[72:73]
    s_mov_b64 exec, -1
    s_or_b64 s[80:81], s[80:81], s[50:51]
    s_and_b64 exec, s[84:85], s[80:81]
    v_mfma_f32_4x4x4_16b_bf16 v[76:79], v[12:13], v[84:85], 0
    v_mov_b32 v94, v7
    s_andn2_b64 s[80:81], s[80:81], s[84:85]
    v_mfma_f32_4x4x4_16b_bf16 v[76:79], v[10:11], v[86:87], v[76:79]
    s_mov_b64 exec, -1
    ds_read_b64 v[70:71], v95 offset:65408
    ds_read_b64 v[68:69], v94 offset:65408
    v_bitop3_b32 v92, v18, v5, v99 bitop3:0xea
    v_bitop3_b32 v93, v19, v5, v46 bitop3:0xea
    v_perm_b32 v15, v19, v20, s47
    v_bitop3_b32 v46, v19, 0.5, -0.5 bitop3:0xa8
    v_perm_b32 v14, v18, v20, s46
    v_bitop3_b32 v47, v18, 0.5, -0.5 bitop3:0xa8
    v_bitop3_b32 v15, v6, v15, v46 bitop3:0xca
    v_bitop3_b32 v14, v6, v14, v47 bitop3:0xca
    s_waitcnt lgkmcnt(1)
    v_mfma_f32_4x4x4_16b_bf16 v[80:83], v[10:11], v[70:71], v[80:83]
    s_waitcnt lgkmcnt(0)
    v_mfma_f32_4x4x4_16b_bf16 v[76:79], v[10:11], v[68:69], v[76:79]
    s_nop 2
    v_cvt_pk_bf16_f32 v80, v80, v81
    v_cvt_pk_bf16_f32 v81, v82, v83
    ds_wrxchg_rtn_b64 v[74:75], v95, v[80:81] offset:65408
    v_cvt_pk_bf16_f32 v76, v76, v77
    v_cvt_pk_bf16_f32 v77, v78, v79
    ds_wrxchg_rtn_b64 v[72:73], v94, v[76:77] offset:65408
    v_mfma_f32_4x4x4_16b_bf16 v[80:83], v[8:9], v[102:103], 0
    v_mfma_f32_4x4x4_16b_bf16 v[76:79], v[8:9], v[100:101], 0
    v_cmp_lt_u32 s[48:49], v5, v93
    s_nop 2
    v_pk_mul_f32 v[80:81], v[80:81], v[14:15] op_sel:[0,1] op_sel_hi:[1,1]
    v_pk_mul_f32 v[82:83], v[82:83], v[14:15] op_sel:[0,1] op_sel_hi:[1,1]
    v_pk_mul_f32 v[76:77], v[76:77], v[14:15] op_sel:[0,0] op_sel_hi:[1,0]
    v_pk_mul_f32 v[78:79], v[78:79], v[14:15] op_sel:[0,0] op_sel_hi:[1,0]
    s_lshl_b32 s3, s32, 12
    v_subrev_u32 v122, s3, v3
    s_mul_i32 s3, s33, 20000
    v_add_u32 v118, s3, v122
    v_add_u32 v119, 0x4000, v118
    s_lshl_b32 s3, s34, 7
    v_lshrrev_b32 v123, 7, v118
    v_and_b32 v120, 0x70, v118
    v_lshl_add_u32 v120, v123, 13, v120
    v_add_u32 v120, s3, v120
    v_lshrrev_b32 v123, 7, v119
    v_and_b32 v121, 0x70, v119
    v_lshl_add_u32 v121, v123, 13, v121
    v_add_u32 v121, s3, v121
    v_cmp_le_u32 vcc, 3616, v122
    s_mov_b64 exec, vcc
    v_mov_b32 v119, 2.0
    v_mov_b32 v121, 2.0
    s_mov_b64 exec, -1
    v_and_b32 v123, 0x30, v122
    v_lshlrev_b32 v123, 2, v123
    buffer_load_dwordx4 v[48:51], v123, s[24:27], 0 offen
    buffer_load_dwordx4 v[52:55], v123, s[24:27], 0 offen offset:16
    buffer_load_dwordx2 v[56:57], v123, s[24:27], 0 offen offset:32
    s_mov_b32 s12, s4
    s_mov_b32 s13, s5
    s_mov_b32 s14, 0x138800
    s_mov_b32 s15, 0x20000
    s_mov_b32 s16, s28
    s_mov_b32 s17, s29
    s_mov_b32 s18, 0x4e2000
    s_mov_b32 s19, 0x20000
    v_lshrrev_b32 v123, 2, v120
    buffer_load_dword v116, v123, s[12:15], 0 offen
    buffer_load_dwordx4 v[108:111], v120, s[16:19], 0 offen
    v_lshrrev_b32 v123, 2, v121
    buffer_load_dword v117, v123, s[12:15], 0 offen
    buffer_load_dwordx4 v[124:127], v121, s[16:19], 0 offen
    s_waitcnt vmcnt(11)
    v_and_b32 v46, 0x20000000, v41
    v_lshrrev_b32 v47, 14, v23
    v_bitop3_b32 v47, v47, v5, v46 bitop3:0xea
    ds_read_b64 v[106:107], v47
    v_and_b32 v99, 0x10000000, v41
    v_lshrrev_b32 v47, 14, v22
    v_bitop3_b32 v47, v47, v5, v99 bitop3:0xea
    ds_read_b64 v[104:105], v47
    s_waitcnt lgkmcnt(2)
    v_cmp_ne_u64 s[50:51], v[72:73], v[68:69]
    v_cmpx_ne_u64 s[54:55], v[74:75], v[70:71]
    s_and_b64 s[82:83], s[54:55], s[80:81]
    s_cbranch_scc1 L2_c139
L2_d139:
    v_mov_b64 v[84:85], v[70:71]
    v_mov_b32 v7, v95
    v_mov_b64 v[86:87], v[74:75]
    s_or_b64 s[80:81], s[80:81], s[54:55]
    s_mov_b64 exec, s[50:51]
    s_and_b64 s[82:83], s[50:51], s[80:81]
    s_cbranch_scc1 L2_c140
L2_d140:
    v_mov_b64 v[84:85], v[68:69]
    v_mov_b32 v7, v94
    v_mov_b64 v[86:87], v[72:73]
    s_mov_b64 exec, -1
    s_or_b64 s[80:81], s[80:81], s[50:51]
    s_and_b64 exec, s[48:49], s[80:81]
    v_mfma_f32_4x4x4_16b_bf16 v[80:83], v[12:13], v[84:85], 0
    v_mov_b32 v93, v7
    s_andn2_b64 s[80:81], s[80:81], s[48:49]
    v_mfma_f32_4x4x4_16b_bf16 v[80:83], v[10:11], v[86:87], v[80:83]
    s_mov_b64 exec, -1
    ds_read_b64 v[70:71], v93 offset:65408
    ds_read_b64 v[68:69], v92 offset:65408
    v_bitop3_b32 v94, v22, v5, v99 bitop3:0xea
    v_bitop3_b32 v95, v23, v5, v46 bitop3:0xea
    v_perm_b32 v15, v23, v26, s45
    v_bitop3_b32 v46, v23, 0.5, -0.5 bitop3:0xa8
    v_perm_b32 v14, v22, v26, s44
    v_bitop3_b32 v47, v22, 0.5, -0.5 bitop3:0xa8
    v_bitop3_b32 v15, v6, v15, v46 bitop3:0xca
    v_bitop3_b32 v14, v6, v14, v47 bitop3:0xca
    s_waitcnt lgkmcnt(1)
    v_mfma_f32_4x4x4_16b_bf16 v[80:83], v[10:11], v[70:71], v[80:83]
    s_waitcnt lgkmcnt(0)
    v_mfma_f32_4x4x4_16b_bf16 v[76:79], v[10:11], v[68:69], v[76:79]
    s_nop 2
    v_cvt_pk_bf16_f32 v80, v80, v81
    v_cvt_pk_bf16_f32 v81, v82, v83
    ds_wrxchg_rtn_b64 v[74:75], v93, v[80:81] offset:65408
    v_cvt_pk_bf16_f32 v76, v76, v77
    v_cvt_pk_bf16_f32 v77, v78, v79
    ds_wrxchg_rtn_b64 v[72:73], v92, v[76:77] offset:65408
    s_setprio 2
    v_mfma_f32_4x4x4_16b_bf16 v[80:83], v[8:9], v[106:107], 0
    v_mfma_f32_4x4x4_16b_bf16 v[76:79], v[8:9], v[104:105], 0
    s_nop 3
    v_pk_mul_f32 v[80:81], v[80:81], v[14:15] op_sel:[0,1] op_sel_hi:[1,1]
    v_pk_mul_f32 v[82:83], v[82:83], v[14:15] op_sel:[0,1] op_sel_hi:[1,1]
    v_pk_mul_f32 v[76:77], v[76:77], v[14:15] op_sel:[0,0] op_sel_hi:[1,0]
    v_pk_mul_f32 v[78:79], v[78:79], v[14:15] op_sel:[0,0] op_sel_hi:[1,0]
    s_bitcmp1_b32 s43, s42
    s_cbranch_scc1 L2_oa141
L2_ob141:
    v_and_b32 v46, 0x80000000, v41
    v_lshrrev_b32 v47, 14, v25
    v_bitop3_b32 v47, v47, v5, v46 bitop3:0xea
    ds_read_b64 v[102:103], v47
    v_and_b32 v99, 0x40000000, v41
    v_lshrrev_b32 v47, 14, v24
    v_bitop3_b32 v47, v47, v5, v99 bitop3:0xea
    ds_read_b64 v[100:101], v47
    s_waitcnt lgkmcnt(2)
    v_cmp_ne_u64 s[50:51], v[72:73], v[68:69]
    v_cmpx_ne_u64 s[54:55], v[74:75], v[70:71]
    s_and_b64 s[82:83], s[54:55], s[80:81]
    s_cbranch_scc1 L2_c142
L2_d142:
    v_mov_b64 v[84:85], v[70:71]
    v_mov_b32 v7, v93
    v_mov_b64 v[86:87], v[74:75]
    s_or_b64 s[80:81], s[80:81], s[54:55]
    s_mov_b64 exec, s[50:51]
    s_and_b64 s[82:83], s[50:51], s[80:81]
    s_cbranch_scc1 L2_c143
L2_d143:
    v_mov_b64 v[84:85], v[68:69]
    v_mov_b32 v7, v92
    v_mov_b64 v[86:87], v[72:73]
    s_mov_b64 exec, -1
    s_or_b64 s[80:81], s[80:81], s[50:51]
    ds_read_b64 v[70:71], v95 offset:65408
    ds_read_b64 v[68:69], v94 offset:65408
    v_bitop3_b32 v92, v24, v5, v99 bitop3:0xea
    v_bitop3_b32 v93, v25, v5, v46 bitop3:0xea
    v_perm_b32 v15, v25, v26, s47
    v_bitop3_b32 v46, v25, 0.5, -0.5 bitop3:0xa8
    v_perm_b32 v14, v24, v26, s46
    v_bitop3_b32 v47, v24, 0.5, -0.5 bitop3:0xa8
    v_bitop3_b32 v15, v6, v15, v46 bitop3:0xca
    v_bitop3_b32 v14, v6, v14, v47 bitop3:0xca
    s_waitcnt lgkmcnt(1)
    v_mfma_f32_4x4x4_16b_bf16 v[80:83], v[10:11], v[70:71], v[80:83]
    s_waitcnt lgkmcnt(0)
    v_mfma_f32_4x4x4_16b_bf16 v[76:79], v[10:11], v[68:69], v[76:79]
    s_nop 2
    v_cvt_pk_bf16_f32 v80, v80, v81
    v_cvt_pk_bf16_f32 v81, v82, v83
    ds_wrxchg_rtn_b64 v[74:75], v95, v[80:81] offset:65408
    v_cvt_pk_bf16_f32 v76, v76, v77
    v_cvt_pk_bf16_f32 v77, v78, v79
    ds_wrxchg_rtn_b64 v[72:73], v94, v[76:77] offset:65408
    s_setprio 1
    v_mfma_f32_4x4x4_16b_bf16 v[80:83], v[8:9], v[102:103], 0
    v_mfma_f32_4x4x4_16b_bf16 v[76:79], v[8:9], v[100:101], 0
    v_cmp_lt_u32 s[84:85], v5, v92
    s_nop 2
    v_pk_mul_f32 v[80:81], v[80:81], v[14:15] op_sel:[0,1] op_sel_hi:[1,1]
    v_pk_mul_f32 v[82:83], v[82:83], v[14:15] op_sel:[0,1] op_sel_hi:[1,1]
    v_pk_mul_f32 v[76:77], v[76:77], v[14:15] op_sel:[0,0] op_sel_hi:[1,0]
    v_pk_mul_f32 v[78:79], v[78:79], v[14:15] op_sel:[0,0] op_sel_hi:[1,0]
    s_waitcnt vmcnt(9)
    s_mov_b64 exec, s[6:7]
    v_lshrrev_b32 v30, 16, v30
    s_mov_b64 exec, -1
    v_and_b32 v46, 0x20000000, v42
    v_lshrrev_b32 v47, 14, v29
    v_bitop3_b32 v47, v47, v5, v46 bitop3:0xea
    ds_read_b64 v[106:107], v47
    v_and_b32 v99, 0x10000000, v42
    v_lshrrev_b32 v47, 14, v28
    v_bitop3_b32 v47, v47, v5, v99 bitop3:0xea
    ds_read_b64 v[104:105], v47
    s_waitcnt lgkmcnt(2)
    v_cmp_ne_u64 s[50:51], v[72:73], v[68:69]
    v_cmpx_ne_u64 s[54:55], v[74:75], v[70:71]
    s_and_b64 s[82:83], s[54:55], s[80:81]
    s_cbranch_scc1 L2_c144
L2_d144:
    v_mov_b64 v[84:85], v[70:71]
    v_mov_b32 v7, v95
    v_mov_b64 v[86:87], v[74:75]
    s_or_b64 s[80:81], s[80:81], s[54:55]
    s_mov_b64 exec, s[50:51]
    s_and_b64 s[82:83], s[50:51], s[80:81]
    s_cbranch_scc1 L2_c145
L2_d145:
    v_mov_b64 v[84:85], v[68:69]
    v_mov_b32 v7, v94
    v_mov_b64 v[86:87], v[72:73]
    s_mov_b64 exec, -1
    s_or_b64 s[80:81], s[80:81], s[50:51]
    s_and_b64 exec, s[84:85], s[80:81]
    v_mfma_f32_4x4x4_16b_bf16 v[76:79], v[12:13], v[84:85], 0
    v_mov_b32 v92, v7
    s_andn2_b64 s[80:81], s[80:81], s[84:85]
    v_mfma_f32_4x4x4_16b_bf16 v[76:79], v[10:11], v[86:87], v[76:79]
    s_mov_b64 exec, -1
    ds_read_b64 v[70:71], v93 offset:65408
    ds_read_b64 v[68:69], v92 offset:65408
    v_bitop3_b32 v94, v28, v5, v99 bitop3:0xea
    v_bitop3_b32 v95, v29, v5, v46 bitop3:0xea
    v_perm_b32 v15, v29, v30, s45
    v_bitop3_b32 v46, v29, 0.5, -0.5 bitop3:0xa8
    v_perm_b32 v14, v28, v30, s44
    v_bitop3_b32 v47, v28, 0.5, -0.5 bitop3:0xa8
    v_bitop3_b32 v15, v6, v15, v46 bitop3:0xca
    v_bitop3_b32 v14, v6, v14, v47 bitop3:0xca
    s_waitcnt lgkmcnt(1)
    v_mfma_f32_4x4x4_16b_bf16 v[80:83], v[10:11], v[70:71], v[80:83]
    s_waitcnt lgkmcnt(0)
    v_mfma_f32_4x4x4_16b_bf16 v[76:79], v[10:11], v[68:69], v[76:79]
    s_nop 2
    v_cvt_pk_bf16_f32 v80, v80, v81
    v_cvt_pk_bf16_f32 v81, v82, v83
    ds_wrxchg_rtn_b64 v[74:75], v93, v[80:81] offset:65408
    v_cvt_pk_bf16_f32 v76, v76, v77
    v_cvt_pk_bf16_f32 v77, v78, v79
    ds_wrxchg_rtn_b64 v[72:73], v92, v[76:77] offset:65408
    s_setprio 0
    v_mfma_f32_4x4x4_16b_bf16 v[80:83], v[8:9], v[106:107], 0
    v_mfma_f32_4x4x4_16b_bf16 v[76:79], v[8:9], v[104:105], 0
    v_cmp_lt_u32 s[48:49], v5, v95
    s_nop 2
    v_pk_mul_f32 v[80:81], v[80:81], v[14:15] op_sel:[0,1] op_sel_hi:[1,1]
    v_pk_mul_f32 v[82:83], v[82:83], v[14:15] op_sel:[0,1] op_sel_hi:[1,1]
    v_pk_mul_f32 v[76:77], v[76:77], v[14:15] op_sel:[0,0] op_sel_hi:[1,0]
    v_pk_mul_f32 v[78:79], v[78:79], v[14:15] op_sel:[0,0] op_sel_hi:[1,0]
    s_waitcnt vmcnt(7)
    v_and_b32 v46, 0x80000000, v43
    v_lshrrev_b32 v47, 14, v37
    v_bitop3_b32 v47, v47, v5, v46 bitop3:0xea
    ds_read_b64 v[106:107], v47
    v_and_b32 v99, 0x40000000, v43
    v_lshrrev_b32 v47, 14, v36
    v_bitop3_b32 v47, v47, v5, v99 bitop3:0xea
    ds_read_b64 v[104:105], v47
    v_and_b32 v46, 0x20000000, v43
    v_lshrrev_b32 v47, 14, v35
    v_bitop3_b32 v47, v47, v5, v46 bitop3:0xea
    ds_read_b64 v[102:103], v47
    v_and_b32 v99, 0x10000000, v43
    v_lshrrev_b32 v47, 14, v34
    v_bitop3_b32 v47, v47, v5, v99 bitop3:0xea
    ds_read_b64 v[100:101], v47
    s_waitcnt lgkmcnt(4)
    v_cmp_ne_u64 s[50:51], v[72:73], v[68:69]
    v_cmpx_ne_u64 s[54:55], v[74:75], v[70:71]
    s_and_b64 s[82:83], s[54:55], s[80:81]
    s_cbranch_scc1 L2_c146
L2_d146:
    v_mov_b64 v[84:85], v[70:71]
    v_mov_b32 v7, v93
    v_mov_b64 v[86:87], v[74:75]
    s_or_b64 s[80:81], s[80:81], s[54:55]
    s_mov_b64 exec, s[50:51]
    s_and_b64 s[82:83], s[50:51], s[80:81]
    s_cbranch_scc1 L2_c147
L2_d147:
    v_mov_b64 v[84:85], v[68:69]
    v_mov_b32 v7, v92
    v_mov_b64 v[86:87], v[72:73]
    s_mov_b64 exec, -1
    s_or_b64 s[80:81], s[80:81], s[50:51]
    s_and_b64 exec, s[48:49], s[80:81]
    v_mfma_f32_4x4x4_16b_bf16 v[80:83], v[12:13], v[84:85], 0
    v_mov_b32 v95, v7
    s_andn2_b64 s[80:81], s[80:81], s[48:49]
    v_mfma_f32_4x4x4_16b_bf16 v[80:83], v[10:11], v[86:87], v[80:83]
    s_mov_b64 exec, -1
    ds_read_b64 v[70:71], v95 offset:65408
    ds_read_b64 v[68:69], v94 offset:65408
    v_bitop3_b32 v92, v34, v5, v99 bitop3:0xea
    v_bitop3_b32 v93, v35, v5, v46 bitop3:0xea
    v_perm_b32 v15, v35, v38, s45
    v_bitop3_b32 v46, v35, 0.5, -0.5 bitop3:0xa8
    v_perm_b32 v14, v34, v38, s44
    v_bitop3_b32 v47, v34, 0.5, -0.5 bitop3:0xa8
    v_bitop3_b32 v15, v6, v15, v46 bitop3:0xca
    v_bitop3_b32 v14, v6, v14, v47 bitop3:0xca
    s_waitcnt lgkmcnt(1)
    v_mfma_f32_4x4x4_16b_bf16 v[80:83], v[10:11], v[70:71], v[80:83]
    s_waitcnt lgkmcnt(0)
    v_mfma_f32_4x4x4_16b_bf16 v[76:79], v[10:11], v[68:69], v[76:79]
    s_nop 2
    v_cvt_pk_bf16_f32 v80, v80, v81
    v_cvt_pk_bf16_f32 v81, v82, v83
    ds_wrxchg_rtn_b64 v[74:75], v95, v[80:81] offset:65408
    v_cvt_pk_bf16_f32 v76, v76, v77
    v_cvt_pk_bf16_f32 v77, v78, v79
    ds_wrxchg_rtn_b64 v[72:73], v94, v[76:77] offset:65408
    v_mfma_f32_4x4x4_16b_bf16 v[80:83], v[8:9], v[102:103], 0
    v_mfma_f32_4x4x4_16b_bf16 v[76:79], v[8:9], v[100:101], 0
    s_nop 3
    v_pk_mul_f32 v[80:81], v[80:81], v[14:15] op_sel:[0,1] op_sel_hi:[1,1]
    v_pk_mul_f32 v[82:83], v[82:83], v[14:15] op_sel:[0,1] op_sel_hi:[1,1]
    v_pk_mul_f32 v[76:77], v[76:77], v[14:15] op_sel:[0,0] op_sel_hi:[1,0]
    v_pk_mul_f32 v[78:79], v[78:79], v[14:15] op_sel:[0,0] op_sel_hi:[1,0]
    s_waitcnt lgkmcnt(0)
    v_cmp_ne_u64 s[50:51], v[72:73], v[68:69]
    v_cmpx_ne_u64 s[54:55], v[74:75], v[70:71]
    s_and_b64 s[82:83], s[54:55], s[80:81]
    s_cbranch_scc1 L2_c148
L2_d148:
    v_mov_b64 v[84:85], v[70:71]
    v_mov_b32 v7, v95
    v_mov_b64 v[86:87], v[74:75]
    s_or_b64 s[80:81], s[80:81], s[54:55]
    s_mov_b64 exec, s[50:51]
    s_and_b64 s[82:83], s[50:51], s[80:81]
    s_cbranch_scc1 L2_c149
L2_d149:
    v_mov_b64 v[84:85], v[68:69]
    v_mov_b32 v7, v94
    v_mov_b64 v[86:87], v[72:73]
    s_mov_b64 exec, -1
    s_or_b64 s[80:81], s[80:81], s[50:51]
    ds_read_b64 v[70:71], v93 offset:65408
    ds_read_b64 v[68:69], v92 offset:65408
    v_and_b32 v46, 0x40000000, v43
    v_bitop3_b32 v94, v36, v5, v46 bitop3:0xea
    v_and_b32 v46, 0x80000000, v43
    v_bitop3_b32 v95, v37, v5, v46 bitop3:0xea
    v_perm_b32 v15, v37, v38, s47
    v_bitop3_b32 v46, v37, 0.5, -0.5 bitop3:0xa8
    v_perm_b32 v14, v36, v38, s46
    v_bitop3_b32 v47, v36, 0.5, -0.5 bitop3:0xa8
    v_bitop3_b32 v15, v6, v15, v46 bitop3:0xca
    v_bitop3_b32 v14, v6, v14, v47 bitop3:0xca
    s_waitcnt lgkmcnt(1)
    v_mfma_f32_4x4x4_16b_bf16 v[80:83], v[10:11], v[70:71], v[80:83]
    s_waitcnt lgkmcnt(0)
    v_mfma_f32_4x4x4_16b_bf16 v[76:79], v[10:11], v[68:69], v[76:79]
    s_nop 2
    v_cvt_pk_bf16_f32 v80, v80, v81
    v_cvt_pk_bf16_f32 v81, v82, v83
    ds_wrxchg_rtn_b64 v[74:75], v93, v[80:81] offset:65408
    v_cvt_pk_bf16_f32 v76, v76, v77
    v_cvt_pk_bf16_f32 v77, v78, v79
    ds_wrxchg_rtn_b64 v[72:73], v92, v[76:77] offset:65408
    v_mfma_f32_4x4x4_16b_bf16 v[80:83], v[8:9], v[106:107], 0
    v_mfma_f32_4x4x4_16b_bf16 v[76:79], v[8:9], v[104:105], 0
    v_cmp_lt_u32 s[84:85], v5, v94
    s_nop 2
    v_pk_mul_f32 v[80:81], v[80:81], v[14:15] op_sel:[0,1] op_sel_hi:[1,1]
    v_pk_mul_f32 v[82:83], v[82:83], v[14:15] op_sel:[0,1] op_sel_hi:[1,1]
    v_pk_mul_f32 v[76:77], v[76:77], v[14:15] op_sel:[0,0] op_sel_hi:[1,0]
    v_pk_mul_f32 v[78:79], v[78:79], v[14:15] op_sel:[0,0] op_sel_hi:[1,0]
    s_waitcnt lgkmcnt(0)
    v_cmp_ne_u64 s[50:51], v[72:73], v[68:69]
    v_cmpx_ne_u64 s[54:55], v[74:75], v[70:71]
    s_and_b64 s[82:83], s[54:55], s[80:81]
    s_cbranch_scc1 L2_c150
L2_d150:
    v_mov_b64 v[84:85], v[70:71]
    v_mov_b32 v7, v93
    v_mov_b64 v[86:87], v[74:75]
    s_or_b64 s[80:81], s[80:81], s[54:55]
    s_mov_b64 exec, s[50:51]
    s_and_b64 s[82:83], s[50:51], s[80:81]
    s_cbranch_scc1 L2_c151
L2_d151:
    v_mov_b64 v[84:85], v[68:69]
    v_mov_b32 v7, v92
    v_mov_b64 v[86:87], v[72:73]
    s_mov_b64 exec, -1
    s_or_b64 s[80:81], s[80:81], s[50:51]
    s_and_b64 exec, s[84:85], s[80:81]
    v_mfma_f32_4x4x4_16b_bf16 v[76:79], v[12:13], v[84:85], 0
    v_mov_b32 v94, v7
    s_andn2_b64 s[80:81], s[80:81], s[84:85]
    v_mfma_f32_4x4x4_16b_bf16 v[76:79], v[10:11], v[86:87], v[76:79]
    s_mov_b64 exec, -1
    ds_read_b64 v[70:71], v95 offset:65408
    ds_read_b64 v[68:69], v94 offset:65408
    s_waitcnt lgkmcnt(1)
    v_mfma_f32_4x4x4_16b_bf16 v[80:83], v[10:11], v[70:71], v[80:83]
    s_waitcnt lgkmcnt(0)
    v_mfma_f32_4x4x4_16b_bf16 v[76:79], v[10:11], v[68:69], v[76:79]
    s_nop 2
    v_cvt_pk_bf16_f32 v80, v80, v81
    v_cvt_pk_bf16_f32 v81, v82, v83
    ds_wrxchg_rtn_b64 v[74:75], v95, v[80:81] offset:65408
    v_cvt_pk_bf16_f32 v76, v76, v77
    v_cvt_pk_bf16_f32 v77, v78, v79
    ds_wrxchg_rtn_b64 v[72:73], v94, v[76:77] offset:65408
    s_waitcnt lgkmcnt(0)
    v_cmpx_ne_u64 vcc, v[74:75], v[70:71]
    s_and_b64 s[82:83], vcc, s[80:81]
    s_cbranch_scc1 L2_c152
L2_d152:
    v_mov_b64 v[84:85], v[70:71]
    v_mov_b32 v7, v95
    v_mov_b64 v[86:87], v[74:75]
    s_mov_b64 exec, -1
    s_or_b64 s[80:81], s[80:81], vcc
    v_cmpx_ne_u64 vcc, v[72:73], v[68:69]
    s_and_b64 s[82:83], vcc, s[80:81]
    s_cbranch_scc1 L2_c153
L2_d153:
    v_mov_b64 v[84:85], v[68:69]
    v_mov_b32 v7, v94
    v_mov_b64 v[86:87], v[72:73]
    s_mov_b64 exec, -1
    s_or_b64 s[80:81], s[80:81], vcc
    s_mov_b64 exec, s[80:81]
    ds_read_b64 v[68:69], v7 offset:65408
    v_mfma_f32_4x4x4_16b_bf16 v[76:79], v[12:13], v[84:85], 0
    s_nop 1
    v_mfma_f32_4x4x4_16b_bf16 v[76:79], v[10:11], v[86:87], v[76:79]
    s_waitcnt lgkmcnt(0)
    s_nop 0
    v_mfma_f32_4x4x4_16b_bf16 v[76:79], v[10:11], v[68:69], v[76:79]
    v_mov_b64 v[84:85], v[68:69]
    s_nop 3
    v_cvt_pk_bf16_f32 v76, v76, v77
    v_cvt_pk_bf16_f32 v77, v78, v79
    ds_wrxchg_rtn_b64 v[86:87], v7, v[76:77] offset:65408
    s_waitcnt lgkmcnt(0)
    v_cmp_ne_u64 s[80:81], v[86:87], v[84:85]
    s_mov_b64 exec, s[80:81]
    s_nop 1
    v_mfma_f32_4x4x4_16b_bf16 v[88:91], v[12:13], v[84:85], 0
    s_nop 1
    v_mfma_f32_4x4x4_16b_bf16 v[88:91], v[10:11], v[86:87], v[88:91]
    s_nop 4
    v_cvt_pk_bf16_f32 v88, v88, v89
    v_cvt_pk_bf16_f32 v89, v90, v91
    ds_pk_add_bf16 v7, v88 offset:65408
    ds_pk_add_bf16 v7, v89 offset:65412
    s_mov_b64 exec, -1
    s_load_dwordx2 s[4:5], s[0:1], 88
    v_add_u32 v123, 0x4000, v122
    s_lshl_b32 s50, s96, 16
    s_and_b32 s51, s96, 0xffff0000
    s_lshl_b32 s52, s97, 16
    s_and_b32 s53, s97, 0xffff0000
    s_lshl_b32 s54, s98, 16
    s_and_b32 s55, s98, 0xffff0000
    s_lshl_b32 s56, s99, 16
    s_and_b32 s57, s99, 0xffff0000
    s_waitcnt vmcnt(0) lgkmcnt(0)
    s_barrier
    s_add_u32 s8, s30, 0xec55000
    s_addc_u32 s9, s31, 0
    s_mov_b32 s10, 0x8000
    s_mov_b32 s11, 0x20000
    s_mov_b32 s12, s4
    s_mov_b32 s13, s5
    s_mov_b32 s14, 0x4e2000
    s_mov_b32 s15, 0x20000
    s_add_u32 s20, s30, 0xd854000
    s_addc_u32 s21, s31, 0
    s_mov_b32 s22, 0x1400000
    s_mov_b32 s23, 0x20000
    s_lshl2_add_u32 s4, s34, s33
    s_mul_i32 s4, s4, 81920
    s_add_u32 s3, s33, 1
    s_and_b32 s3, s3, 3
    s_mul_i32 s36, s3, 20000
    s_add_u32 s36, s36, 81920
    s_mul_i32 s40, s3, 20480
    s_add_u32 s40, s40, s4
    s_lshl2_add_u32 s3, s34, s3
    s_mul_i32 s3, s3, 81920
    s_mul_i32 s44, s33, 20480
    s_add_u32 s44, s44, s3
    s_add_u32 s3, s33, 2
    s_and_b32 s3, s3, 3
    s_mul_i32 s37, s3, 20000
    s_add_u32 s37, s37, 81920
    s_mul_i32 s41, s3, 20480
    s_add_u32 s41, s41, s4
    s_lshl2_add_u32 s3, s34, s3
    s_mul_i32 s3, s3, 81920
    s_mul_i32 s45, s33, 20480
    s_add_u32 s45, s45, s3
    s_add_u32 s3, s33, 3
    s_and_b32 s3, s3, 3
    s_mul_i32 s38, s3, 20000
    s_add_u32 s38, s38, 81920
    s_mul_i32 s42, s3, 20480
    s_add_u32 s42, s42, s4
    s_lshl2_add_u32 s3, s34, s3
    s_mul_i32 s3, s3, 81920
    s_mul_i32 s46, s33, 20480
    s_add_u32 s46, s46, s3
    v_add_u32 v104, s36, v122
    ds_read_b128 v[16:19], v104
    v_add_u32 v104, s37, v122
    ds_read_b128 v[20:23], v104
    v_add_u32 v104, s38, v122
    ds_read_b128 v[24:27], v104
    s_waitcnt lgkmcnt(2)
    buffer_store_dwordx4 v[16:19], v122, s[20:23], s40 offen sc1
    s_waitcnt lgkmcnt(1)
    buffer_store_dwordx4 v[20:23], v122, s[20:23], s41 offen sc1
    s_waitcnt lgkmcnt(0)
    buffer_store_dwordx4 v[24:27], v122, s[20:23], s42 offen sc1
    s_cmp_ge_u32 s32, 4
    s_cbranch_scc1 L2_g0
    v_add_u32 v104, s36, v123
    ds_read_b128 v[36:39], v104
    v_add_u32 v104, s37, v123
    ds_read_b128 v[40:43], v104
    v_add_u32 v104, s38, v123
    ds_read_b128 v[44:47], v104
    s_waitcnt lgkmcnt(2)
    buffer_store_dwordx4 v[36:39], v123, s[20:23], s40 offen sc1
    s_waitcnt lgkmcnt(1)
    buffer_store_dwordx4 v[40:43], v123, s[20:23], s41 offen sc1
    s_waitcnt lgkmcnt(0)
    buffer_store_dwordx4 v[44:47], v123, s[20:23], s42 offen sc1
L2_g0:
    v_lshlrev_b32 v80, 16, v116
    v_subrev_f32 v60, s50, v80
    v_subrev_f32 v61, s51, v80
    v_subrev_f32 v62, s52, v80
    v_subrev_f32 v63, s53, v80
    v_subrev_f32 v64, s54, v80
    v_subrev_f32 v65, s55, v80
    v_subrev_f32 v66, s56, v80
    v_subrev_f32 v67, s57, v80
    v_cvt_pk_bf16_f32 v68, v60, v61
    v_cvt_pk_bf16_f32 v69, v62, v63
    v_cvt_pk_bf16_f32 v70, v64, v65
    v_cvt_pk_bf16_f32 v71, v66, v67
    v_lshlrev_b32 v60, 16, v68
    v_and_b32 v61, 0xffff0000, v68
    v_lshlrev_b32 v62, 16, v69
    v_and_b32 v63, 0xffff0000, v69
    v_lshlrev_b32 v64, 16, v70
    v_and_b32 v65, 0xffff0000, v70
    v_lshlrev_b32 v66, 16, v71
    v_and_b32 v67, 0xffff0000, v71
    v_mul_f32 v60, v60, v60
    v_mul_f32 v61, v61, v61
    v_mul_f32 v62, v62, v62
    v_mul_f32 v63, v63, v63
    v_mul_f32 v64, v64, v64
    v_mul_f32 v65, v65, v65
    v_mul_f32 v66, v66, v66
    v_mul_f32 v67, v67, v67
    v_cvt_pk_bf16_f32 v68, v60, v61
    v_cvt_pk_bf16_f32 v69, v62, v63
    v_cvt_pk_bf16_f32 v70, v64, v65
    v_cvt_pk_bf16_f32 v71, v66, v67
    v_lshlrev_b32 v60, 16, v68
    v_and_b32 v61, 0xffff0000, v68
    v_lshlrev_b32 v62, 16, v69
    v_and_b32 v63, 0xffff0000, v69
    v_lshlrev_b32 v64, 16, v70
    v_and_b32 v65, 0xffff0000, v70
    v_lshlrev_b32 v66, 16, v71
    v_and_b32 v67, 0xffff0000, v71
    v_mul_f32 v60, 0xc1200000, v60
    v_mul_f32 v61, 0xc1200000, v61
    v_mul_f32 v62, 0xc1200000, v62
    v_mul_f32 v63, 0xc1200000, v63
    v_mul_f32 v64, 0xc1200000, v64
    v_mul_f32 v65, 0xc1200000, v65
    v_mul_f32 v66, 0xc1200000, v66
    v_mul_f32 v67, 0xc1200000, v67
    v_cvt_pk_bf16_f32 v68, v60, v61
    v_cvt_pk_bf16_f32 v69, v62, v63
    v_cvt_pk_bf16_f32 v70, v64, v65
    v_cvt_pk_bf16_f32 v71, v66, v67
    v_lshlrev_b32 v60, 16, v68
    v_and_b32 v61, 0xffff0000, v68
    v_lshlrev_b32 v62, 16, v69
    v_and_b32 v63, 0xffff0000, v69
    v_lshlrev_b32 v64, 16, v70
    v_and_b32 v65, 0xffff0000, v70
    v_lshlrev_b32 v66, 16, v71
    v_and_b32 v67, 0xffff0000, v71
    v_mul_f32 v60, 0x3fb8aa3b, v60
    v_mul_f32 v61, 0x3fb8aa3b, v61
    v_mul_f32 v62, 0x3fb8aa3b, v62
    v_mul_f32 v63, 0x3fb8aa3b, v63
    v_mul_f32 v64, 0x3fb8aa3b, v64
    v_mul_f32 v65, 0x3fb8aa3b, v65
    v_mul_f32 v66, 0x3fb8aa3b, v66
    v_mul_f32 v67, 0x3fb8aa3b, v67
    v_exp_f32 v60, v60
    v_exp_f32 v61, v61
    v_exp_f32 v62, v62
    v_exp_f32 v63, v63
    v_exp_f32 v64, v64
    v_exp_f32 v65, v65
    v_exp_f32 v66, v66
    v_exp_f32 v67, v67
    v_cvt_pk_bf16_f32 v72, v60, v61
    v_cvt_pk_bf16_f32 v73, v62, v63
    v_cvt_pk_bf16_f32 v74, v64, v65
    v_cvt_pk_bf16_f32 v75, v66, v67
    v_and_b32 v84, 0xffff0000, v116
    v_subrev_f32 v60, s50, v84
    v_subrev_f32 v61, s51, v84
    v_subrev_f32 v62, s52, v84
    v_subrev_f32 v63, s53, v84
    v_subrev_f32 v64, s54, v84
    v_subrev_f32 v65, s55, v84
    v_subrev_f32 v66, s56, v84
    v_subrev_f32 v67, s57, v84
    v_cvt_pk_bf16_f32 v68, v60, v61
    v_cvt_pk_bf16_f32 v69, v62, v63
    v_cvt_pk_bf16_f32 v70, v64, v65
    v_cvt_pk_bf16_f32 v71, v66, v67
    v_lshlrev_b32 v60, 16, v68
    v_and_b32 v61, 0xffff0000, v68
    v_lshlrev_b32 v62, 16, v69
    v_and_b32 v63, 0xffff0000, v69
    v_lshlrev_b32 v64, 16, v70
    v_and_b32 v65, 0xffff0000, v70
    v_lshlrev_b32 v66, 16, v71
    v_and_b32 v67, 0xffff0000, v71
    v_mul_f32 v60, v60, v60
    v_mul_f32 v61, v61, v61
    v_mul_f32 v62, v62, v62
    v_mul_f32 v63, v63, v63
    v_mul_f32 v64, v64, v64
    v_mul_f32 v65, v65, v65
    v_mul_f32 v66, v66, v66
    v_mul_f32 v67, v67, v67
    v_cvt_pk_bf16_f32 v68, v60, v61
    v_cvt_pk_bf16_f32 v69, v62, v63
    v_cvt_pk_bf16_f32 v70, v64, v65
    v_cvt_pk_bf16_f32 v71, v66, v67
    v_lshlrev_b32 v60, 16, v68
    v_and_b32 v61, 0xffff0000, v68
    v_lshlrev_b32 v62, 16, v69
    v_and_b32 v63, 0xffff0000, v69
    v_lshlrev_b32 v64, 16, v70
    v_and_b32 v65, 0xffff0000, v70
    v_lshlrev_b32 v66, 16, v71
    v_and_b32 v67, 0xffff0000, v71
    v_mul_f32 v60, 0xc1200000, v60
    v_mul_f32 v61, 0xc1200000, v61
    v_mul_f32 v62, 0xc1200000, v62
    v_mul_f32 v63, 0xc1200000, v63
    v_mul_f32 v64, 0xc1200000, v64
    v_mul_f32 v65, 0xc1200000, v65
    v_mul_f32 v66, 0xc1200000, v66
    v_mul_f32 v67, 0xc1200000, v67
    v_cvt_pk_bf16_f32 v68, v60, v61
    v_cvt_pk_bf16_f32 v69, v62, v63
    v_cvt_pk_bf16_f32 v70, v64, v65
    v_cvt_pk_bf16_f32 v71, v66, v67
    v_lshlrev_b32 v60, 16, v68
    v_and_b32 v61, 0xffff0000, v68
    v_lshlrev_b32 v62, 16, v69
    v_and_b32 v63, 0xffff0000, v69
    v_lshlrev_b32 v64, 16, v70
    v_and_b32 v65, 0xffff0000, v70
    v_lshlrev_b32 v66, 16, v71
    v_and_b32 v67, 0xffff0000, v71
    v_mul_f32 v60, 0x3fb8aa3b, v60
    v_mul_f32 v61, 0x3fb8aa3b, v61
    v_mul_f32 v62, 0x3fb8aa3b, v62
    v_mul_f32 v63, 0x3fb8aa3b, v63
    v_mul_f32 v64, 0x3fb8aa3b, v64
    v_mul_f32 v65, 0x3fb8aa3b, v65
    v_mul_f32 v66, 0x3fb8aa3b, v66
    v_mul_f32 v67, 0x3fb8aa3b, v67
    v_exp_f32 v60, v60
    v_exp_f32 v61, v61
    v_exp_f32 v62, v62
    v_exp_f32 v63, v63
    v_exp_f32 v64, v64
    v_exp_f32 v65, v65
    v_exp_f32 v66, v66
    v_exp_f32 v67, v67
    v_cvt_pk_bf16_f32 v76, v60, v61
    v_cvt_pk_bf16_f32 v77, v62, v63
    v_cvt_pk_bf16_f32 v78, v64, v65
    v_cvt_pk_bf16_f32 v79, v66, v67
    v_mfma_f32_4x4x4_16b_bf16 v[80:83], v[48:49], v[72:73], 0
    v_mfma_f32_4x4x4_16b_bf16 v[88:91], v[52:53], v[72:73], 0
    v_mfma_f32_4x4x4_16b_bf16 v[84:87], v[48:49], v[76:77], 0
    v_mfma_f32_4x4x4_16b_bf16 v[92:95], v[52:53], v[76:77], 0
    v_mfma_f32_4x4x4_16b_bf16 v[80:83], v[50:51], v[74:75], v[80:83]
    v_mfma_f32_4x4x4_16b_bf16 v[88:91], v[54:55], v[74:75], v[88:91]
    v_mfma_f32_4x4x4_16b_bf16 v[84:87], v[50:51], v[78:79], v[84:87]
    v_mfma_f32_4x4x4_16b_bf16 v[92:95], v[54:55], v[78:79], v[92:95]
    s_lshl_b32 s3, s34, 9
    s_lshl_b32 s4, s33, 7
    s_add_u32 s4, s4, s3
    v_mov_b32 v104, 1
    v_and_b32 v105, 0x3f0, v122
    v_lshlrev_b32 v105, 3, v105
    v_add_u32 v106, 81920, v118
    ds_read_b128 v[32:35], v106
    v_add_u32 v106, 81920, v119
    ds_read_b128 v[60:63], v106
    s_waitcnt vmcnt(0)
    s_barrier
    s_cmp_lg_u32 s32, 0
    s_cbranch_scc1 L2_f2
    s_mov_b64 exec, 1
    buffer_store_dword v104, off, s[8:11], s4 sc1
    s_mov_b64 exec, 15
    s_bitset0_b64 exec, s33
L2_f3:
    buffer_load_dword v104, v105, s[8:11], s3 offen sc1
    s_waitcnt vmcnt(0)
    v_cmp_ne_u32 vcc, 1, v104
    s_cbranch_vccnz L2_f3s
    s_mov_b64 exec, -1
L2_f2:
    s_barrier
    buffer_load_dwordx4 v[36:39], v122, s[20:23], s44 offen sc1
    buffer_load_dwordx4 v[40:43], v122, s[20:23], s45 offen sc1
    buffer_load_dwordx4 v[44:47], v122, s[20:23], s46 offen sc1
    s_cmp_ge_u32 s32, 4
    s_cbranch_scc1 L2_f5
    buffer_load_dwordx4 v[64:67], v123, s[20:23], s44 offen sc1
    buffer_load_dwordx4 v[68:71], v123, s[20:23], s45 offen sc1
    buffer_load_dwordx4 v[72:75], v123, s[20:23], s46 offen sc1
    v_lshlrev_b32 v16, 16, v117
    v_subrev_f32 v96, s50, v16
    v_subrev_f32 v97, s51, v16
    v_subrev_f32 v98, s52, v16
    v_subrev_f32 v99, s53, v16
    v_subrev_f32 v100, s54, v16
    v_subrev_f32 v101, s55, v16
    v_subrev_f32 v102, s56, v16
    v_subrev_f32 v103, s57, v16
    v_cvt_pk_bf16_f32 v0, v96, v97
    v_cvt_pk_bf16_f32 v1, v98, v99
    v_cvt_pk_bf16_f32 v2, v100, v101
    v_cvt_pk_bf16_f32 v3, v102, v103
    v_lshlrev_b32 v96, 16, v0
    v_and_b32 v97, 0xffff0000, v0
    v_lshlrev_b32 v98, 16, v1
    v_and_b32 v99, 0xffff0000, v1
    v_lshlrev_b32 v100, 16, v2
    v_and_b32 v101, 0xffff0000, v2
    v_lshlrev_b32 v102, 16, v3
    v_and_b32 v103, 0xffff0000, v3
    v_mul_f32 v96, v96, v96
    v_mul_f32 v97, v97, v97
    v_mul_f32 v98, v98, v98
    v_mul_f32 v99, v99, v99
    v_mul_f32 v100, v100, v100
    v_mul_f32 v101, v101, v101
    v_mul_f32 v102, v102, v102
    v_mul_f32 v103, v103, v103
    v_cvt_pk_bf16_f32 v0, v96, v97
    v_cvt_pk_bf16_f32 v1, v98, v99
    v_cvt_pk_bf16_f32 v2, v100, v101
    v_cvt_pk_bf16_f32 v3, v102, v103
    v_lshlrev_b32 v96, 16, v0
    v_and_b32 v97, 0xffff0000, v0
    v_lshlrev_b32 v98, 16, v1
    v_and_b32 v99, 0xffff0000, v1
    v_lshlrev_b32 v100, 16, v2
    v_and_b32 v101, 0xffff0000, v2
    v_lshlrev_b32 v102, 16, v3
    v_and_b32 v103, 0xffff0000, v3
    v_mul_f32 v96, 0xc1200000, v96
    v_mul_f32 v97, 0xc1200000, v97
    v_mul_f32 v98, 0xc1200000, v98
    v_mul_f32 v99, 0xc1200000, v99
    v_mul_f32 v100, 0xc1200000, v100
    v_mul_f32 v101, 0xc1200000, v101
    v_mul_f32 v102, 0xc1200000, v102
    v_mul_f32 v103, 0xc1200000, v103
    v_cvt_pk_bf16_f32 v0, v96, v97
    v_cvt_pk_bf16_f32 v1, v98, v99
    v_cvt_pk_bf16_f32 v2, v100, v101
    v_cvt_pk_bf16_f32 v3, v102, v103
    v_lshlrev_b32 v96, 16, v0
    v_and_b32 v97, 0xffff0000, v0
    v_lshlrev_b32 v98, 16, v1
    v_and_b32 v99, 0xffff0000, v1
    v_lshlrev_b32 v100, 16, v2
    v_and_b32 v101, 0xffff0000, v2
    v_lshlrev_b32 v102, 16, v3
    v_and_b32 v103, 0xffff0000, v3
    v_mul_f32 v96, 0x3fb8aa3b, v96
    v_mul_f32 v97, 0x3fb8aa3b, v97
    v_mul_f32 v98, 0x3fb8aa3b, v98
    v_mul_f32 v99, 0x3fb8aa3b, v99
    v_mul_f32 v100, 0x3fb8aa3b, v100
    v_mul_f32 v101, 0x3fb8aa3b, v101
    v_mul_f32 v102, 0x3fb8aa3b, v102
    v_mul_f32 v103, 0x3fb8aa3b, v103
    v_exp_f32 v96, v96
    v_exp_f32 v97, v97
    v_exp_f32 v98, v98
    v_exp_f32 v99, v99
    v_exp_f32 v100, v100
    v_exp_f32 v101, v101
    v_exp_f32 v102, v102
    v_exp_f32 v103, v103
    v_cvt_pk_bf16_f32 v104, v96, v97
    v_cvt_pk_bf16_f32 v105, v98, v99
    v_cvt_pk_bf16_f32 v106, v100, v101
    v_cvt_pk_bf16_f32 v107, v102, v103
    v_and_b32 v20, 0xffff0000, v117
    v_subrev_f32 v96, s50, v20
    v_subrev_f32 v97, s51, v20
    v_subrev_f32 v98, s52, v20
    v_subrev_f32 v99, s53, v20
    v_subrev_f32 v100, s54, v20
    v_subrev_f32 v101, s55, v20
    v_subrev_f32 v102, s56, v20
    v_subrev_f32 v103, s57, v20
    v_cvt_pk_bf16_f32 v0, v96, v97
    v_cvt_pk_bf16_f32 v1, v98, v99
    v_cvt_pk_bf16_f32 v2, v100, v101
    v_cvt_pk_bf16_f32 v3, v102, v103
    v_lshlrev_b32 v96, 16, v0
    v_and_b32 v97, 0xffff0000, v0
    v_lshlrev_b32 v98, 16, v1
    v_and_b32 v99, 0xffff0000, v1
    v_lshlrev_b32 v100, 16, v2
    v_and_b32 v101, 0xffff0000, v2
    v_lshlrev_b32 v102, 16, v3
    v_and_b32 v103, 0xffff0000, v3
    v_mul_f32 v96, v96, v96
    v_mul_f32 v97, v97, v97
    v_mul_f32 v98, v98, v98
    v_mul_f32 v99, v99, v99
    v_mul_f32 v100, v100, v100
    v_mul_f32 v101, v101, v101
    v_mul_f32 v102, v102, v102
    v_mul_f32 v103, v103, v103
    v_cvt_pk_bf16_f32 v0, v96, v97
    v_cvt_pk_bf16_f32 v1, v98, v99
    v_cvt_pk_bf16_f32 v2, v100, v101
    v_cvt_pk_bf16_f32 v3, v102, v103
    v_lshlrev_b32 v96, 16, v0
    v_and_b32 v97, 0xffff0000, v0
    v_lshlrev_b32 v98, 16, v1
    v_and_b32 v99, 0xffff0000, v1
    v_lshlrev_b32 v100, 16, v2
    v_and_b32 v101, 0xffff0000, v2
    v_lshlrev_b32 v102, 16, v3
    v_and_b32 v103, 0xffff0000, v3
    v_mul_f32 v96, 0xc1200000, v96
    v_mul_f32 v97, 0xc1200000, v97
    v_mul_f32 v98, 0xc1200000, v98
    v_mul_f32 v99, 0xc1200000, v99
    v_mul_f32 v100, 0xc1200000, v100
    v_mul_f32 v101, 0xc1200000, v101
    v_mul_f32 v102, 0xc1200000, v102
    v_mul_f32 v103, 0xc1200000, v103
    v_cvt_pk_bf16_f32 v0, v96, v97
    v_cvt_pk_bf16_f32 v1, v98, v99
    v_cvt_pk_bf16_f32 v2, v100, v101
    v_cvt_pk_bf16_f32 v3, v102, v103
    v_lshlrev_b32 v96, 16, v0
    v_and_b32 v97, 0xffff0000, v0
    v_lshlrev_b32 v98, 16, v1
    v_and_b32 v99, 0xffff0000, v1
    v_lshlrev_b32 v100, 16, v2
    v_and_b32 v101, 0xffff0000, v2
    v_lshlrev_b32 v102, 16, v3
    v_and_b32 v103, 0xffff0000, v3
    v_mul_f32 v96, 0x3fb8aa3b, v96
    v_mul_f32 v97, 0x3fb8aa3b, v97
    v_mul_f32 v98, 0x3fb8aa3b, v98
    v_mul_f32 v99, 0x3fb8aa3b, v99
    v_mul_f32 v100, 0x3fb8aa3b, v100
    v_mul_f32 v101, 0x3fb8aa3b, v101
    v_mul_f32 v102, 0x3fb8aa3b, v102
    v_mul_f32 v103, 0x3fb8aa3b, v103
    v_exp_f32 v96, v96
    v_exp_f32 v97, v97
    v_exp_f32 v98, v98
    v_exp_f32 v99, v99
    v_exp_f32 v100, v100
    v_exp_f32 v101, v101
    v_exp_f32 v102, v102
    v_exp_f32 v103, v103
    v_cvt_pk_bf16_f32 v76, v96, v97
    v_cvt_pk_bf16_f32 v77, v98, v99
    v_cvt_pk_bf16_f32 v78, v100, v101
    v_cvt_pk_bf16_f32 v79, v102, v103
    v_mfma_f32_4x4x4_16b_bf16 v[16:19], v[48:49], v[104:105], 0
    v_mfma_f32_4x4x4_16b_bf16 v[24:27], v[52:53], v[104:105], 0
    v_mfma_f32_4x4x4_16b_bf16 v[20:23], v[48:49], v[76:77], 0
    v_mfma_f32_4x4x4_16b_bf16 v[28:31], v[52:53], v[76:77], 0
    v_mfma_f32_4x4x4_16b_bf16 v[16:19], v[50:51], v[106:107], v[16:19]
    v_mfma_f32_4x4x4_16b_bf16 v[24:27], v[54:55], v[106:107], v[24:27]
    v_mfma_f32_4x4x4_16b_bf16 v[20:23], v[50:51], v[78:79], v[20:23]
    v_mfma_f32_4x4x4_16b_bf16 v[28:31], v[54:55], v[78:79], v[28:31]
L2_f5:
    s_waitcnt vmcnt(0) lgkmcnt(0)
    v_mfma_f32_4x4x4_16b_bf16 v[96:99], v[10:11], v[32:33], 0
    v_mfma_f32_4x4x4_16b_bf16 v[100:103], v[10:11], v[34:35], 0
    s_nop 0
    v_mfma_f32_4x4x4_16b_bf16 v[96:99], v[10:11], v[36:37], v[96:99]
    v_mfma_f32_4x4x4_16b_bf16 v[100:103], v[10:11], v[38:39], v[100:103]
    s_nop 0
    v_mfma_f32_4x4x4_16b_bf16 v[96:99], v[10:11], v[40:41], v[96:99]
    v_mfma_f32_4x4x4_16b_bf16 v[100:103], v[10:11], v[42:43], v[100:103]
    s_nop 0
    v_mfma_f32_4x4x4_16b_bf16 v[96:99], v[10:11], v[44:45], v[96:99]
    v_mfma_f32_4x4x4_16b_bf16 v[100:103], v[10:11], v[46:47], v[100:103]
    s_nop 3
    v_mul_f32 v96, v96, v80
    v_mul_f32 v97, v97, v81
    v_mul_f32 v98, v98, v82
    v_mul_f32 v99, v99, v83
    v_cvt_pk_bf16_f32 v32, v96, v97
    v_cvt_pk_bf16_f32 v33, v98, v99
    v_mul_f32 v100, v100, v84
    v_mul_f32 v101, v101, v85
    v_mul_f32 v102, v102, v86
    v_mul_f32 v103, v103, v87
    v_cvt_pk_bf16_f32 v34, v100, v101
    v_cvt_pk_bf16_f32 v35, v102, v103
    v_mfma_f32_4x4x4_16b_bf16 v[80:83], v[56:57], v[32:33], 0
    s_nop 0
    v_mfma_f32_4x4x4_16b_bf16 v[84:87], v[56:57], v[34:35], 0
    s_nop 2
    v_mul_f32 v80, v80, v88
    v_mul_f32 v81, v81, v89
    v_mul_f32 v82, v82, v90
    v_mul_f32 v83, v83, v91
    v_mul_f32 v84, v84, v92
    v_mul_f32 v85, v85, v93
    v_mul_f32 v86, v86, v94
    v_mul_f32 v87, v87, v95
    v_mfma_f32_4x4x4_16b_bf16 v[96:99], v[10:11], v[108:109], v[80:83]
    s_nop 0
    v_mfma_f32_4x4x4_16b_bf16 v[100:103], v[10:11], v[110:111], v[84:87]
    s_nop 2
    v_cvt_pk_bf16_f32 v36, v96, v97
    v_cvt_pk_bf16_f32 v37, v98, v99
    v_cvt_pk_bf16_f32 v38, v100, v101
    v_cvt_pk_bf16_f32 v39, v102, v103
    buffer_store_dwordx4 v[36:39], v120, s[12:15], 0 offen nt
    s_cmp_ge_u32 s32, 4
    s_cbranch_scc1 L2_f6
    v_mfma_f32_4x4x4_16b_bf16 v[96:99], v[10:11], v[60:61], 0
    v_mfma_f32_4x4x4_16b_bf16 v[100:103], v[10:11], v[62:63], 0
    s_nop 0
    v_mfma_f32_4x4x4_16b_bf16 v[96:99], v[10:11], v[64:65], v[96:99]
    v_mfma_f32_4x4x4_16b_bf16 v[100:103], v[10:11], v[66:67], v[100:103]
    s_nop 0
    v_mfma_f32_4x4x4_16b_bf16 v[96:99], v[10:11], v[68:69], v[96:99]
    v_mfma_f32_4x4x4_16b_bf16 v[100:103], v[10:11], v[70:71], v[100:103]
    s_nop 0
    v_mfma_f32_4x4x4_16b_bf16 v[96:99], v[10:11], v[72:73], v[96:99]
    v_mfma_f32_4x4x4_16b_bf16 v[100:103], v[10:11], v[74:75], v[100:103]
    s_nop 3
    v_mul_f32 v96, v96, v16
    v_mul_f32 v97, v97, v17
    v_mul_f32 v98, v98, v18
    v_mul_f32 v99, v99, v19
    v_cvt_pk_bf16_f32 v60, v96, v97
    v_cvt_pk_bf16_f32 v61, v98, v99
    v_mul_f32 v100, v100, v20
    v_mul_f32 v101, v101, v21
    v_mul_f32 v102, v102, v22
    v_mul_f32 v103, v103, v23
    v_cvt_pk_bf16_f32 v62, v100, v101
    v_cvt_pk_bf16_f32 v63, v102, v103
    v_mfma_f32_4x4x4_16b_bf16 v[16:19], v[56:57], v[60:61], 0
    s_nop 0
    v_mfma_f32_4x4x4_16b_bf16 v[20:23], v[56:57], v[62:63], 0
    s_nop 2
    v_mul_f32 v16, v16, v24
    v_mul_f32 v17, v17, v25
    v_mul_f32 v18, v18, v26
    v_mul_f32 v19, v19, v27
    v_mul_f32 v20, v20, v28
    v_mul_f32 v21, v21, v29
    v_mul_f32 v22, v22, v30
    v_mul_f32 v23, v23, v31
    v_mfma_f32_4x4x4_16b_bf16 v[96:99], v[10:11], v[124:125], v[16:19]
    s_nop 0
    v_mfma_f32_4x4x4_16b_bf16 v[100:103], v[10:11], v[126:127], v[20:23]
    s_nop 2
    v_cvt_pk_bf16_f32 v64, v96, v97
    v_cvt_pk_bf16_f32 v65, v98, v99
    v_cvt_pk_bf16_f32 v66, v100, v101
    v_cvt_pk_bf16_f32 v67, v102, v103
    buffer_store_dwordx4 v[64:67], v121, s[12:15], 0 offen nt
L2_f6:
L2_end:
    s_endpgm
L2_slow:
    s_lshr_b32 s35, s42, 2
    s_lshl_b32 s50, s32, 4
    s_and_b32 s3, s42, 3
    s_lshl_b32 s53, s3, 3
    s_add_u32 s53, s53, s39
    s_and_b32 s3, s35, 2
    s_lshl_b32 s3, s3, 1
    s_add_u32 s53, s53, s3
    s_and_b32 s54, s35, 1
    s_lshl_b32 s54, s54, 4
L2_sl_seg:
    s_mul_i32 s55, s50, 173056
    s_and_b32 s3, s50, 3
    s_lshl_b32 s3, s3, 5
    s_add_u32 s3, s3, s55
    s_add_u32 s3, s3, s53
    buffer_load_dword v104, off, s[12:15], s3 sc1
    buffer_load_dword v105, off, s[12:15], s3 offset:32 sc1
    s_waitcnt vmcnt(0)
    v_readfirstlane_b32 s51, v104
    v_readfirstlane_b32 s52, v105
    s_lshr_b32 s51, s51, s54
    s_and_b32 s51, s51, 0xffff
    s_lshr_b32 s52, s52, s54
    s_and_b32 s52, s52, 0xffff
L2_sl_rec:
    s_cmp_ge_u32 s51, s52
    s_cbranch_scc1 L2_sl_next
    v_mbcnt_lo_u32_b32 v102, -1, 0
    v_mbcnt_hi_u32_b32 v102, -1, v102
    v_add_u32 v102, s51, v102
    v_and_b32 v103, -4, v102
    v_lshl_add_u32 v104, v102, 2, v103
    v_lshl_add_u32 v105, v103, 2, v102
    v_cmp_gt_u32 vcc, s52, v102
    s_mov_b64 exec, vcc
    buffer_load_dword v106, v104, s[8:11], s55 offen
    buffer_load_ubyte v107, v105, s[8:11], s55 offen offset:16
    s_waitcnt vmcnt(0)
    v_lshrrev_b32 v98, 14, v106
    v_and_b32 v98, v5, v98
    ds_read_b64 v[100:101], v98
    v_perm_b32 v97, v106, v107, s44
    v_and_b32 v96, v5, v106
    v_bitop3_b32 v103, v106, 0.5, -0.5 bitop3:0xa8
    v_bitop3_b32 v97, v6, v97, v103 bitop3:0xca
    s_waitcnt lgkmcnt(0)
    v_mfma_f32_4x4x4_16b_bf16 v[88:91], v[8:9], v[100:101], 0
    s_nop 4
    v_mul_f32 v88, v97, v88
    v_mul_f32 v89, v97, v89
    v_mul_f32 v90, v97, v90
    v_mul_f32 v91, v97, v91
    v_cvt_pk_bf16_f32 v88, v88, v89
    v_cvt_pk_bf16_f32 v89, v90, v91
    ds_pk_add_bf16 v96, v88 offset:65408
    ds_pk_add_bf16 v96, v89 offset:65412
    s_mov_b64 exec, -1
    s_add_u32 s51, s51, 64
    s_branch L2_sl_rec
L2_sl_next:
    s_add_u32 s50, s50, 1
    s_and_b32 s3, s50, 15
    s_cbranch_scc1 L2_sl_seg
    s_add_u32 s50, s50, 240
    s_cmp_lt_u32 s50, 1280
    s_cbranch_scc1 L2_sl_seg
    s_waitcnt lgkmcnt(0)
    s_cmp_eq_u32 s42, 0
    s_cbranch_scc1 L2_ret0
    s_cmp_eq_u32 s42, 1
    s_cbranch_scc1 L2_ret1
    s_cmp_eq_u32 s42, 14
    s_cbranch_scc1 L2_ret6
    s_cmp_eq_u32 s42, 15
    s_cbranch_scc1 L2_ret7
    s_and_b32 s3, s42, 3
    s_cmp_eq_u32 s3, 2
    s_cbranch_scc1 L2_ret2
    s_cmp_eq_u32 s3, 3
    s_cbranch_scc1 L2_ret3
    s_cmp_eq_u32 s3, 0
    s_cbranch_scc1 L2_ret4
    s_branch L2_ret5
L2_xo3:
    v_cmp_lt_u32 vcc, 20, v99
    s_mov_b32 s101, 1
    s_cbranch_vccz L2_xp3
    v_cmp_lt_u32 vcc, 32, v99
    v_cmp_lt_u32 s[58:59], 31, v88
    s_mov_b32 s101, 2
    s_or_b64 vcc, vcc, s[58:59]
    s_cbranch_scc0 L2_xp3
    s_mov_b32 s37, 0x10000
    s_branch L2_xp3
L2_xa4:
    s_cmp_eq_u32 s101, 1
    s_cbranch_scc1 L2_xc4
    v_lshlrev_b32 v89, 0, v96
    v_add_u32 v90, 140, v97
    v_bitop3_b32 v90, v89, v45, v90 bitop3:0x6a
    ds_write_b32 v98, v90 offset:28
    v_lshlrev_b32 v89, 4, v96
    v_add_u32 v90, 120, v97
    v_bitop3_b32 v90, v89, v45, v90 bitop3:0x6a
    ds_write_b32 v98, v90 offset:24
    v_lshlrev_b32 v89, 8, v96
    v_add_u32 v90, 100, v97
    v_bitop3_b32 v90, v89, v45, v90 bitop3:0x6a
    ds_write_b32 v98, v90 offset:20
L2_xc4:
    v_lshlrev_b32 v89, 12, v96
    v_add_u32 v90, 80, v97
    v_bitop3_b32 v90, v89, v45, v90 bitop3:0x6a
    ds_write_b32 v98, v90 offset:16
    s_branch L2_xb4
L2_xe4:
    v_cmp_lt_u32 vcc, 32, v99
    v_cmp_lt_u32 s[58:59], 31, v88
    v_lshrrev_b32 v89, 16, v96
    v_add_u32 v97, 80, v97
    s_or_b64 vcc, vcc, s[58:59]
    s_cbranch_scc1 L2_xs4
    v_lshlrev_b32 v89, v1, v89
    v_and_b32 v89, v45, v89
    v_cmp_ne_u32 vcc, 0, v89
    v_xor_b32 v90, v97, v89
    s_add_u32 s3, s37, s38
    v_mbcnt_lo_u32_b32 v98, vcc_lo, 0
    v_mbcnt_hi_u32_b32 v98, vcc_hi, v98
    s_bcnt1_i32_b64 s41, vcc
    v_lshl_add_u32 v98, v98, 2, s3
    s_lshl2_add_u32 s37, s41, s37
    s_mov_b64 exec, vcc
    ds_write_b32 v98, v90
    s_mov_b64 exec, -1
    s_branch L2_xr4
L2_xs4:
    s_waitcnt lgkmcnt(0)
    s_mov_b32 s37, 0x10000
    s_branch L2_xw4
L2_xf4:
    s_cmp_gt_u32 s37, 1024
    s_cbranch_scc1 L2_xt4
    s_cmp_lt_u32 s37, 768
    s_cbranch_scc1 L2_xl4
    ds_read_b32 v32, v44 offset:896
    s_add_u32 s3, s42, 0
    s_bitset1_b32 s43, s3
    s_branch L2_xg4
L2_xl4:
    s_waitcnt lgkmcnt(0)
    v_mov_b32 v31, -1
    s_cmp_ge_u32 s37, 512
    s_cbranch_scc1 L2_xg4
    v_mov_b32 v39, -1
    s_cmp_ge_u32 s37, 256
    s_cbranch_scc1 L2_xg4
    v_mov_b32 v27, -1
    s_branch L2_xg4
L2_xt4:
    s_waitcnt lgkmcnt(0)
    v_mov_b32 v21, -1
    v_mov_b32 v27, -1
    v_mov_b32 v39, -1
    v_mov_b32 v31, -1
    s_add_u32 s3, s42, 0
    s_bitset1_b32 s36, s3
    s_branch L2_xg4
L2_xo5:
    v_cmp_lt_u32 vcc, 20, v99
    s_mov_b32 s101, 1
    s_cbranch_vccz L2_xp5
    v_cmp_lt_u32 vcc, 32, v99
    v_cmp_lt_u32 s[58:59], 31, v88
    s_mov_b32 s101, 2
    s_or_b64 vcc, vcc, s[58:59]
    s_cbranch_scc0 L2_xp5
    s_mov_b32 s37, 0x10000
    s_branch L2_xp5
L2_xa6:
    s_cmp_eq_u32 s101, 1
    s_cbranch_scc1 L2_xc6
    v_lshlrev_b32 v89, 0, v96
    v_add_u32 v90, 140, v97
    v_bitop3_b32 v90, v89, v45, v90 bitop3:0x6a
    ds_write_b32 v98, v90 offset:28
    v_lshlrev_b32 v89, 4, v96
    v_add_u32 v90, 120, v97
    v_bitop3_b32 v90, v89, v45, v90 bitop3:0x6a
    ds_write_b32 v98, v90 offset:24
    v_lshlrev_b32 v89, 8, v96
    v_add_u32 v90, 100, v97
    v_bitop3_b32 v90, v89, v45, v90 bitop3:0x6a
    ds_write_b32 v98, v90 offset:20
L2_xc6:
    v_lshlrev_b32 v89, 12, v96
    v_add_u32 v90, 80, v97
    v_bitop3_b32 v90, v89, v45, v90 bitop3:0x6a
    ds_write_b32 v98, v90 offset:16
    s_branch L2_xb6
L2_xe6:
    v_cmp_lt_u32 vcc, 32, v99
    v_cmp_lt_u32 s[58:59], 31, v88
    v_lshrrev_b32 v89, 16, v96
    v_add_u32 v97, 80, v97
    s_or_b64 vcc, vcc, s[58:59]
    s_cbranch_scc1 L2_xs6
    v_lshlrev_b32 v89, v1, v89
    v_and_b32 v89, v45, v89
    v_cmp_ne_u32 vcc, 0, v89
    v_xor_b32 v90, v97, v89
    s_add_u32 s3, s37, s38
    v_mbcnt_lo_u32_b32 v98, vcc_lo, 0
    v_mbcnt_hi_u32_b32 v98, vcc_hi, v98
    s_bcnt1_i32_b64 s41, vcc
    v_lshl_add_u32 v98, v98, 2, s3
    s_lshl2_add_u32 s37, s41, s37
    s_mov_b64 exec, vcc
    ds_write_b32 v98, v90
    s_mov_b64 exec, -1
    s_branch L2_xr6
L2_xs6:
    s_waitcnt lgkmcnt(0)
    s_mov_b32 s37, 0x10000
    s_branch L2_xw6
L2_xf6:
    s_cmp_gt_u32 s37, 1024
    s_cbranch_scc1 L2_xt6
    s_cmp_lt_u32 s37, 768
    s_cbranch_scc1 L2_xl6
    ds_read_b32 v33, v44 offset:896
    s_add_u32 s3, s42, 1
    s_bitset1_b32 s43, s3
    s_branch L2_xg6
L2_xl6:
    s_waitcnt lgkmcnt(0)
    v_mov_b32 v42, -1
    s_cmp_ge_u32 s37, 512
    s_cbranch_scc1 L2_xg6
    v_mov_b32 v43, -1
    s_cmp_ge_u32 s37, 256
    s_cbranch_scc1 L2_xg6
    v_mov_b32 v41, -1
    s_branch L2_xg6
L2_xt6:
    s_waitcnt lgkmcnt(0)
    v_mov_b32 v40, -1
    v_mov_b32 v41, -1
    v_mov_b32 v43, -1
    v_mov_b32 v42, -1
    s_add_u32 s3, s42, 1
    s_bitset1_b32 s36, s3
    s_branch L2_xg6
L2_oa7:
    v_and_b32 v47, 0x0fffffff, v32
    buffer_load_dword v78, v47, s[8:11], 0 offen offset:16
    s_mov_b64 exec, s[6:7]
    v_add_u32 v47, 8, v47
    v_lshrrev_b32 v32, 2, v32
    s_mov_b64 exec, -1
    buffer_load_dwordx2 v[76:77], v47, s[8:11], 0 offen
    s_branch L2_ob7
L2_oa8:
    s_waitcnt vmcnt(0)
    s_mov_b64 exec, s[6:7]
    v_lshrrev_b32 v78, 16, v78
    s_mov_b64 exec, -1
    v_and_b32 v46, 0x10000000, v32
    v_cmpx_eq_u32 vcc, 0, v46
    v_lshrrev_b32 v47, 14, v76
    v_and_b32 v47, v5, v47
    ds_read_b64 v[96:97], v47
    v_perm_b32 v98, v76, v78, s44
    v_bitop3_b32 v99, v76, 0.5, -0.5 bitop3:0xa8
    v_bitop3_b32 v98, v6, v98, v99 bitop3:0xca
    v_and_b32 v47, v5, v76
    s_waitcnt lgkmcnt(0)
    v_mfma_f32_4x4x4_16b_bf16 v[88:91], v[8:9], v[96:97], 0
    s_nop 4
    v_mul_f32 v88, v98, v88
    v_mul_f32 v89, v98, v89
    v_mul_f32 v90, v98, v90
    v_mul_f32 v91, v98, v91
    v_cvt_pk_bf16_f32 v88, v88, v89
    v_cvt_pk_bf16_f32 v89, v90, v91
    ds_pk_add_bf16 v47, v88 offset:65408
    ds_pk_add_bf16 v47, v89 offset:65412
    s_mov_b64 exec, -1
    v_and_b32 v46, 0x20000000, v32
    v_cmpx_eq_u32 vcc, 0, v46
    v_lshrrev_b32 v47, 14, v77
    v_and_b32 v47, v5, v47
    ds_read_b64 v[96:97], v47
    v_perm_b32 v98, v77, v78, s45
    v_bitop3_b32 v99, v77, 0.5, -0.5 bitop3:0xa8
    v_bitop3_b32 v98, v6, v98, v99 bitop3:0xca
    v_and_b32 v47, v5, v77
    s_waitcnt lgkmcnt(0)
    v_mfma_f32_4x4x4_16b_bf16 v[88:91], v[8:9], v[96:97], 0
    s_nop 4
    v_mul_f32 v88, v98, v88
    v_mul_f32 v89, v98, v89
    v_mul_f32 v90, v98, v90
    v_mul_f32 v91, v98, v91
    v_cvt_pk_bf16_f32 v88, v88, v89
    v_cvt_pk_bf16_f32 v89, v90, v91
    ds_pk_add_bf16 v47, v88 offset:65408
    ds_pk_add_bf16 v47, v89 offset:65412
    s_mov_b64 exec, -1
    s_branch L2_ob8
L2_c9:
    s_lshl_b64 s[52:53], s[82:83], 1
    s_andn2_b64 s[52:53], s[52:53], s[80:81]
    s_andn2_b64 s[52:53], s[52:53], s[54:55]
    s_or_b64 s[80:81], s[80:81], s[52:53]
    s_not_b64 vcc, s[52:53]
    s_mov_b64 exec, -1
    v_cndmask_b32_dpp v84, v84, v84, vcc wave_shr:1 row_mask:0xf bank_mask:0xf
    v_cndmask_b32_dpp v85, v85, v85, vcc wave_shr:1 row_mask:0xf bank_mask:0xf
    s_lshr_b64 s[52:53], s[52:53], 1
    v_cndmask_b32_dpp v86, v86, v86, vcc wave_shr:1 row_mask:0xf bank_mask:0xf
    v_cndmask_b32_dpp v87, v87, v87, vcc wave_shr:1 row_mask:0xf bank_mask:0xf
    s_andn2_b64 s[82:83], s[82:83], s[52:53]
    v_cndmask_b32_dpp v7, v7, v7, vcc wave_shr:1 row_mask:0xf bank_mask:0xf
    s_mov_b64 exec, s[54:55]
    s_cbranch_scc0 L2_d9
    s_mov_b64 exec, s[82:83]
    s_nop 1
    v_mfma_f32_4x4x4_16b_bf16 v[88:91], v[12:13], v[84:85], 0
    s_nop 1
    v_mfma_f32_4x4x4_16b_bf16 v[88:91], v[10:11], v[86:87], v[88:91]
    s_nop 4
    v_cvt_pk_bf16_f32 v88, v88, v89
    v_cvt_pk_bf16_f32 v89, v90, v91
    ds_pk_add_bf16 v7, v88 offset:65408
    ds_pk_add_bf16 v7, v89 offset:65412
    s_mov_b64 exec, s[54:55]
    s_branch L2_d9
L2_c10:
    s_lshl_b64 s[52:53], s[82:83], 1
    s_andn2_b64 s[52:53], s[52:53], s[80:81]
    s_andn2_b64 s[52:53], s[52:53], s[50:51]
    s_or_b64 s[80:81], s[80:81], s[52:53]
    s_not_b64 vcc, s[52:53]
    s_mov_b64 exec, -1
    v_cndmask_b32_dpp v84, v84, v84, vcc wave_shr:1 row_mask:0xf bank_mask:0xf
    v_cndmask_b32_dpp v85, v85, v85, vcc wave_shr:1 row_mask:0xf bank_mask:0xf
    s_lshr_b64 s[52:53], s[52:53], 1
    v_cndmask_b32_dpp v86, v86, v86, vcc wave_shr:1 row_mask:0xf bank_mask:0xf
    v_cndmask_b32_dpp v87, v87, v87, vcc wave_shr:1 row_mask:0xf bank_mask:0xf
    s_andn2_b64 s[82:83], s[82:83], s[52:53]
    v_cndmask_b32_dpp v7, v7, v7, vcc wave_shr:1 row_mask:0xf bank_mask:0xf
    s_mov_b64 exec, s[50:51]
    s_cbranch_scc0 L2_d10
    s_mov_b64 exec, s[82:83]
    s_nop 1
    v_mfma_f32_4x4x4_16b_bf16 v[88:91], v[12:13], v[84:85], 0
    s_nop 1
    v_mfma_f32_4x4x4_16b_bf16 v[88:91], v[10:11], v[86:87], v[88:91]
    s_nop 4
    v_cvt_pk_bf16_f32 v88, v88, v89
    v_cvt_pk_bf16_f32 v89, v90, v91
    ds_pk_add_bf16 v7, v88 offset:65408
    ds_pk_add_bf16 v7, v89 offset:65412
    s_mov_b64 exec, s[50:51]
    s_branch L2_d10
L2_c13:
    s_lshl_b64 s[52:53], s[82:83], 1
    s_andn2_b64 s[52:53], s[52:53], s[80:81]
    s_andn2_b64 s[52:53], s[52:53], s[54:55]
    s_or_b64 s[80:81], s[80:81], s[52:53]
    s_not_b64 vcc, s[52:53]
    s_mov_b64 exec, -1
    v_cndmask_b32_dpp v84, v84, v84, vcc wave_shr:1 row_mask:0xf bank_mask:0xf
    v_cndmask_b32_dpp v85, v85, v85, vcc wave_shr:1 row_mask:0xf bank_mask:0xf
    s_lshr_b64 s[52:53], s[52:53], 1
    v_cndmask_b32_dpp v86, v86, v86, vcc wave_shr:1 row_mask:0xf bank_mask:0xf
    v_cndmask_b32_dpp v87, v87, v87, vcc wave_shr:1 row_mask:0xf bank_mask:0xf
    s_andn2_b64 s[82:83], s[82:83], s[52:53]
    v_cndmask_b32_dpp v7, v7, v7, vcc wave_shr:1 row_mask:0xf bank_mask:0xf
    s_mov_b64 exec, s[54:55]
    s_cbranch_scc0 L2_d13
    s_mov_b64 exec, s[82:83]
    s_nop 1
    v_mfma_f32_4x4x4_16b_bf16 v[88:91], v[12:13], v[84:85], 0
    s_nop 1
    v_mfma_f32_4x4x4_16b_bf16 v[88:91], v[10:11], v[86:87], v[88:91]
    s_nop 4
    v_cvt_pk_bf16_f32 v88, v88, v89
    v_cvt_pk_bf16_f32 v89, v90, v91
    ds_pk_add_bf16 v7, v88 offset:65408
    ds_pk_add_bf16 v7, v89 offset:65412
    s_mov_b64 exec, s[54:55]
    s_branch L2_d13
L2_c14:
    s_lshl_b64 s[52:53], s[82:83], 1
    s_andn2_b64 s[52:53], s[52:53], s[80:81]
    s_andn2_b64 s[52:53], s[52:53], s[50:51]
    s_or_b64 s[80:81], s[80:81], s[52:53]
    s_not_b64 vcc, s[52:53]
    s_mov_b64 exec, -1
    v_cndmask_b32_dpp v84, v84, v84, vcc wave_shr:1 row_mask:0xf bank_mask:0xf
    v_cndmask_b32_dpp v85, v85, v85, vcc wave_shr:1 row_mask:0xf bank_mask:0xf
    s_lshr_b64 s[52:53], s[52:53], 1
    v_cndmask_b32_dpp v86, v86, v86, vcc wave_shr:1 row_mask:0xf bank_mask:0xf
    v_cndmask_b32_dpp v87, v87, v87, vcc wave_shr:1 row_mask:0xf bank_mask:0xf
    s_andn2_b64 s[82:83], s[82:83], s[52:53]
    v_cndmask_b32_dpp v7, v7, v7, vcc wave_shr:1 row_mask:0xf bank_mask:0xf
    s_mov_b64 exec, s[50:51]
    s_cbranch_scc0 L2_d14
    s_mov_b64 exec, s[82:83]
    s_nop 1
    v_mfma_f32_4x4x4_16b_bf16 v[88:91], v[12:13], v[84:85], 0
    s_nop 1
    v_mfma_f32_4x4x4_16b_bf16 v[88:91], v[10:11], v[86:87], v[88:91]
    s_nop 4
    v_cvt_pk_bf16_f32 v88, v88, v89
    v_cvt_pk_bf16_f32 v89, v90, v91
    ds_pk_add_bf16 v7, v88 offset:65408
    ds_pk_add_bf16 v7, v89 offset:65412
    s_mov_b64 exec, s[50:51]
    s_branch L2_d14
L2_xo16:
    v_cmp_lt_u32 vcc, 20, v99
    s_mov_b32 s101, 1
    s_cbranch_vccz L2_xp16
    v_cmp_lt_u32 vcc, 32, v99
    v_cmp_lt_u32 s[58:59], 31, v88
    s_mov_b32 s101, 2
    s_or_b64 vcc, vcc, s[58:59]
    s_cbranch_scc0 L2_xp16
    s_mov_b32 s37, 0x10000
    s_branch L2_xp16
L2_c17:
    s_lshl_b64 s[52:53], s[82:83], 1
    s_andn2_b64 s[52:53], s[52:53], s[80:81]
    s_andn2_b64 s[52:53], s[52:53], s[54:55]
    s_or_b64 s[80:81], s[80:81], s[52:53]
    s_not_b64 vcc, s[52:53]
    s_mov_b64 exec, -1
    v_cndmask_b32_dpp v84, v84, v84, vcc wave_shr:1 row_mask:0xf bank_mask:0xf
    v_cndmask_b32_dpp v85, v85, v85, vcc wave_shr:1 row_mask:0xf bank_mask:0xf
    s_lshr_b64 s[52:53], s[52:53], 1
    v_cndmask_b32_dpp v86, v86, v86, vcc wave_shr:1 row_mask:0xf bank_mask:0xf
    v_cndmask_b32_dpp v87, v87, v87, vcc wave_shr:1 row_mask:0xf bank_mask:0xf
    s_andn2_b64 s[82:83], s[82:83], s[52:53]
    v_cndmask_b32_dpp v7, v7, v7, vcc wave_shr:1 row_mask:0xf bank_mask:0xf
    s_mov_b64 exec, s[54:55]
    s_cbranch_scc0 L2_d17
    s_mov_b64 exec, s[82:83]
    s_nop 1
    v_mfma_f32_4x4x4_16b_bf16 v[88:91], v[12:13], v[84:85], 0
    s_nop 1
    v_mfma_f32_4x4x4_16b_bf16 v[88:91], v[10:11], v[86:87], v[88:91]
    s_nop 4
    v_cvt_pk_bf16_f32 v88, v88, v89
    v_cvt_pk_bf16_f32 v89, v90, v91
    ds_pk_add_bf16 v7, v88 offset:65408
    ds_pk_add_bf16 v7, v89 offset:65412
    s_mov_b64 exec, s[54:55]
    s_branch L2_d17
L2_c18:
    s_lshl_b64 s[52:53], s[82:83], 1
    s_andn2_b64 s[52:53], s[52:53], s[80:81]
    s_andn2_b64 s[52:53], s[52:53], s[50:51]
    s_or_b64 s[80:81], s[80:81], s[52:53]
    s_not_b64 vcc, s[52:53]
    s_mov_b64 exec, -1
    v_cndmask_b32_dpp v84, v84, v84, vcc wave_shr:1 row_mask:0xf bank_mask:0xf
    v_cndmask_b32_dpp v85, v85, v85, vcc wave_shr:1 row_mask:0xf bank_mask:0xf
    s_lshr_b64 s[52:53], s[52:53], 1
    v_cndmask_b32_dpp v86, v86, v86, vcc wave_shr:1 row_mask:0xf bank_mask:0xf
    v_cndmask_b32_dpp v87, v87, v87, vcc wave_shr:1 row_mask:0xf bank_mask:0xf
    s_andn2_b64 s[82:83], s[82:83], s[52:53]
    v_cndmask_b32_dpp v7, v7, v7, vcc wave_shr:1 row_mask:0xf bank_mask:0xf
    s_mov_b64 exec, s[50:51]
    s_cbranch_scc0 L2_d18
    s_mov_b64 exec, s[82:83]
    s_nop 1
    v_mfma_f32_4x4x4_16b_bf16 v[88:91], v[12:13], v[84:85], 0
    s_nop 1
    v_mfma_f32_4x4x4_16b_bf16 v[88:91], v[10:11], v[86:87], v[88:91]
    s_nop 4
    v_cvt_pk_bf16_f32 v88, v88, v89
    v_cvt_pk_bf16_f32 v89, v90, v91
    ds_pk_add_bf16 v7, v88 offset:65408
    ds_pk_add_bf16 v7, v89 offset:65412
    s_mov_b64 exec, s[50:51]
    s_branch L2_d18
L2_c21:
    s_lshl_b64 s[52:53], s[82:83], 1
    s_andn2_b64 s[52:53], s[52:53], s[80:81]
    s_andn2_b64 s[52:53], s[52:53], s[54:55]
    s_or_b64 s[80:81], s[80:81], s[52:53]
    s_not_b64 vcc, s[52:53]
    s_mov_b64 exec, -1
    v_cndmask_b32_dpp v84, v84, v84, vcc wave_shr:1 row_mask:0xf bank_mask:0xf
    v_cndmask_b32_dpp v85, v85, v85, vcc wave_shr:1 row_mask:0xf bank_mask:0xf
    s_lshr_b64 s[52:53], s[52:53], 1
    v_cndmask_b32_dpp v86, v86, v86, vcc wave_shr:1 row_mask:0xf bank_mask:0xf
    v_cndmask_b32_dpp v87, v87, v87, vcc wave_shr:1 row_mask:0xf bank_mask:0xf
    s_andn2_b64 s[82:83], s[82:83], s[52:53]
    v_cndmask_b32_dpp v7, v7, v7, vcc wave_shr:1 row_mask:0xf bank_mask:0xf
    s_mov_b64 exec, s[54:55]
    s_cbranch_scc0 L2_d21
    s_mov_b64 exec, s[82:83]
    s_nop 1
    v_mfma_f32_4x4x4_16b_bf16 v[88:91], v[12:13], v[84:85], 0
    s_nop 1
    v_mfma_f32_4x4x4_16b_bf16 v[88:91], v[10:11], v[86:87], v[88:91]
    s_nop 4
    v_cvt_pk_bf16_f32 v88, v88, v89
    v_cvt_pk_bf16_f32 v89, v90, v91
    ds_pk_add_bf16 v7, v88 offset:65408
    ds_pk_add_bf16 v7, v89 offset:65412
    s_mov_b64 exec, s[54:55]
    s_branch L2_d21
L2_c22:
    s_lshl_b64 s[52:53], s[82:83], 1
    s_andn2_b64 s[52:53], s[52:53], s[80:81]
    s_andn2_b64 s[52:53], s[52:53], s[50:51]
    s_or_b64 s[80:81], s[80:81], s[52:53]
    s_not_b64 vcc, s[52:53]
    s_mov_b64 exec, -1
    v_cndmask_b32_dpp v84, v84, v84, vcc wave_shr:1 row_mask:0xf bank_mask:0xf
    v_cndmask_b32_dpp v85, v85, v85, vcc wave_shr:1 row_mask:0xf bank_mask:0xf
    s_lshr_b64 s[52:53], s[52:53], 1
    v_cndmask_b32_dpp v86, v86, v86, vcc wave_shr:1 row_mask:0xf bank_mask:0xf
    v_cndmask_b32_dpp v87, v87, v87, vcc wave_shr:1 row_mask:0xf bank_mask:0xf
    s_andn2_b64 s[82:83], s[82:83], s[52:53]
    v_cndmask_b32_dpp v7, v7, v7, vcc wave_shr:1 row_mask:0xf bank_mask:0xf
    s_mov_b64 exec, s[50:51]
    s_cbranch_scc0 L2_d22
    s_mov_b64 exec, s[82:83]
    s_nop 1
    v_mfma_f32_4x4x4_16b_bf16 v[88:91], v[12:13], v[84:85], 0
    s_nop 1
    v_mfma_f32_4x4x4_16b_bf16 v[88:91], v[10:11], v[86:87], v[88:91]
    s_nop 4
    v_cvt_pk_bf16_f32 v88, v88, v89
    v_cvt_pk_bf16_f32 v89, v90, v91
    ds_pk_add_bf16 v7, v88 offset:65408
    ds_pk_add_bf16 v7, v89 offset:65412
    s_mov_b64 exec, s[50:51]
    s_branch L2_d22
L2_c23:
    s_lshl_b64 s[52:53], s[82:83], 1
    s_andn2_b64 s[52:53], s[52:53], s[80:81]
    s_andn2_b64 s[52:53], s[52:53], s[54:55]
    s_or_b64 s[80:81], s[80:81], s[52:53]
    s_not_b64 vcc, s[52:53]
    s_mov_b64 exec, -1
    v_cndmask_b32_dpp v84, v84, v84, vcc wave_shr:1 row_mask:0xf bank_mask:0xf
    v_cndmask_b32_dpp v85, v85, v85, vcc wave_shr:1 row_mask:0xf bank_mask:0xf
    s_lshr_b64 s[52:53], s[52:53], 1
    v_cndmask_b32_dpp v86, v86, v86, vcc wave_shr:1 row_mask:0xf bank_mask:0xf
    v_cndmask_b32_dpp v87, v87, v87, vcc wave_shr:1 row_mask:0xf bank_mask:0xf
    s_andn2_b64 s[82:83], s[82:83], s[52:53]
    v_cndmask_b32_dpp v7, v7, v7, vcc wave_shr:1 row_mask:0xf bank_mask:0xf
    s_mov_b64 exec, s[54:55]
    s_cbranch_scc0 L2_d23
    s_mov_b64 exec, s[82:83]
    s_nop 1
    v_mfma_f32_4x4x4_16b_bf16 v[88:91], v[12:13], v[84:85], 0
    s_nop 1
    v_mfma_f32_4x4x4_16b_bf16 v[88:91], v[10:11], v[86:87], v[88:91]
    s_nop 4
    v_cvt_pk_bf16_f32 v88, v88, v89
    v_cvt_pk_bf16_f32 v89, v90, v91
    ds_pk_add_bf16 v7, v88 offset:65408
    ds_pk_add_bf16 v7, v89 offset:65412
    s_mov_b64 exec, s[54:55]
    s_branch L2_d23
L2_c24:
    s_lshl_b64 s[52:53], s[82:83], 1
    s_andn2_b64 s[52:53], s[52:53], s[80:81]
    s_andn2_b64 s[52:53], s[52:53], s[50:51]
    s_or_b64 s[80:81], s[80:81], s[52:53]
    s_not_b64 vcc, s[52:53]
    s_mov_b64 exec, -1
    v_cndmask_b32_dpp v84, v84, v84, vcc wave_shr:1 row_mask:0xf bank_mask:0xf
    v_cndmask_b32_dpp v85, v85, v85, vcc wave_shr:1 row_mask:0xf bank_mask:0xf
    s_lshr_b64 s[52:53], s[52:53], 1
    v_cndmask_b32_dpp v86, v86, v86, vcc wave_shr:1 row_mask:0xf bank_mask:0xf
    v_cndmask_b32_dpp v87, v87, v87, vcc wave_shr:1 row_mask:0xf bank_mask:0xf
    s_andn2_b64 s[82:83], s[82:83], s[52:53]
    v_cndmask_b32_dpp v7, v7, v7, vcc wave_shr:1 row_mask:0xf bank_mask:0xf
    s_mov_b64 exec, s[50:51]
    s_cbranch_scc0 L2_d24
    s_mov_b64 exec, s[82:83]
    s_nop 1
    v_mfma_f32_4x4x4_16b_bf16 v[88:91], v[12:13], v[84:85], 0
    s_nop 1
    v_mfma_f32_4x4x4_16b_bf16 v[88:91], v[10:11], v[86:87], v[88:91]
    s_nop 4
    v_cvt_pk_bf16_f32 v88, v88, v89
    v_cvt_pk_bf16_f32 v89, v90, v91
    ds_pk_add_bf16 v7, v88 offset:65408
    ds_pk_add_bf16 v7, v89 offset:65412
    s_mov_b64 exec, s[50:51]
    s_branch L2_d24
L2_xa25:
    s_cmp_eq_u32 s101, 1
    s_cbranch_scc1 L2_xc25
    v_lshlrev_b32 v89, 0, v96
    v_add_u32 v90, 140, v97
    v_bitop3_b32 v90, v89, v45, v90 bitop3:0x6a
    ds_write_b32 v98, v90 offset:28
    v_lshlrev_b32 v89, 4, v96
    v_add_u32 v90, 120, v97
    v_bitop3_b32 v90, v89, v45, v90 bitop3:0x6a
    ds_write_b32 v98, v90 offset:24
    v_lshlrev_b32 v89, 8, v96
    v_add_u32 v90, 100, v97
    v_bitop3_b32 v90, v89, v45, v90 bitop3:0x6a
    ds_write_b32 v98, v90 offset:20
L2_xc25:
    v_lshlrev_b32 v89, 12, v96
    v_add_u32 v90, 80, v97
    v_bitop3_b32 v90, v89, v45, v90 bitop3:0x6a
    ds_write_b32 v98, v90 offset:16
    s_branch L2_xb25
L2_xe25:
    v_cmp_lt_u32 vcc, 32, v99
    v_cmp_lt_u32 s[58:59], 31, v88
    v_lshrrev_b32 v89, 16, v96
    v_add_u32 v97, 80, v97
    s_or_b64 vcc, vcc, s[58:59]
    s_cbranch_scc1 L2_xs25
    v_lshlrev_b32 v89, v1, v89
    v_and_b32 v89, v45, v89
    v_cmp_ne_u32 vcc, 0, v89
    v_xor_b32 v90, v97, v89
    s_add_u32 s3, s37, s38
    v_mbcnt_lo_u32_b32 v98, vcc_lo, 0
    v_mbcnt_hi_u32_b32 v98, vcc_hi, v98
    s_bcnt1_i32_b64 s41, vcc
    v_lshl_add_u32 v98, v98, 2, s3
    s_lshl2_add_u32 s37, s41, s37
    s_mov_b64 exec, vcc
    ds_write_b32 v98, v90
    s_mov_b64 exec, -1
    s_branch L2_xr25
L2_xs25:
    s_waitcnt lgkmcnt(0)
    s_mov_b32 s37, 0x10000
    s_branch L2_xw25
L2_c26:
    s_lshl_b64 s[52:53], s[82:83], 1
    s_andn2_b64 s[52:53], s[52:53], s[80:81]
    s_andn2_b64 s[52:53], s[52:53], s[54:55]
    s_or_b64 s[80:81], s[80:81], s[52:53]
    s_not_b64 vcc, s[52:53]
    s_mov_b64 exec, -1
    v_cndmask_b32_dpp v84, v84, v84, vcc wave_shr:1 row_mask:0xf bank_mask:0xf
    v_cndmask_b32_dpp v85, v85, v85, vcc wave_shr:1 row_mask:0xf bank_mask:0xf
    s_lshr_b64 s[52:53], s[52:53], 1
    v_cndmask_b32_dpp v86, v86, v86, vcc wave_shr:1 row_mask:0xf bank_mask:0xf
    v_cndmask_b32_dpp v87, v87, v87, vcc wave_shr:1 row_mask:0xf bank_mask:0xf
    s_andn2_b64 s[82:83], s[82:83], s[52:53]
    v_cndmask_b32_dpp v7, v7, v7, vcc wave_shr:1 row_mask:0xf bank_mask:0xf
    s_mov_b64 exec, s[54:55]
    s_cbranch_scc0 L2_d26
    s_mov_b64 exec, s[82:83]
    s_nop 1
    v_mfma_f32_4x4x4_16b_bf16 v[88:91], v[12:13], v[84:85], 0
    s_nop 1
    v_mfma_f32_4x4x4_16b_bf16 v[88:91], v[10:11], v[86:87], v[88:91]
    s_nop 4
    v_cvt_pk_bf16_f32 v88, v88, v89
    v_cvt_pk_bf16_f32 v89, v90, v91
    ds_pk_add_bf16 v7, v88 offset:65408
    ds_pk_add_bf16 v7, v89 offset:65412
    s_mov_b64 exec, s[54:55]
    s_branch L2_d26
L2_c27:
    s_lshl_b64 s[52:53], s[82:83], 1
    s_andn2_b64 s[52:53], s[52:53], s[80:81]
    s_andn2_b64 s[52:53], s[52:53], s[50:51]
    s_or_b64 s[80:81], s[80:81], s[52:53]
    s_not_b64 vcc, s[52:53]
    s_mov_b64 exec, -1
    v_cndmask_b32_dpp v84, v84, v84, vcc wave_shr:1 row_mask:0xf bank_mask:0xf
    v_cndmask_b32_dpp v85, v85, v85, vcc wave_shr:1 row_mask:0xf bank_mask:0xf
    s_lshr_b64 s[52:53], s[52:53], 1
    v_cndmask_b32_dpp v86, v86, v86, vcc wave_shr:1 row_mask:0xf bank_mask:0xf
    v_cndmask_b32_dpp v87, v87, v87, vcc wave_shr:1 row_mask:0xf bank_mask:0xf
    s_andn2_b64 s[82:83], s[82:83], s[52:53]
    v_cndmask_b32_dpp v7, v7, v7, vcc wave_shr:1 row_mask:0xf bank_mask:0xf
    s_mov_b64 exec, s[50:51]
    s_cbranch_scc0 L2_d27
    s_mov_b64 exec, s[82:83]
    s_nop 1
    v_mfma_f32_4x4x4_16b_bf16 v[88:91], v[12:13], v[84:85], 0
    s_nop 1
    v_mfma_f32_4x4x4_16b_bf16 v[88:91], v[10:11], v[86:87], v[88:91]
    s_nop 4
    v_cvt_pk_bf16_f32 v88, v88, v89
    v_cvt_pk_bf16_f32 v89, v90, v91
    ds_pk_add_bf16 v7, v88 offset:65408
    ds_pk_add_bf16 v7, v89 offset:65412
    s_mov_b64 exec, s[50:51]
    s_branch L2_d27
L2_xf25:
    s_cmp_gt_u32 s37, 1024
    s_cbranch_scc1 L2_xt25
    s_cmp_lt_u32 s37, 768
    s_cbranch_scc1 L2_xl25
    ds_read_b32 v32, v44 offset:896
    s_add_u32 s3, s42, 2
    s_bitset1_b32 s43, s3
    s_branch L2_xg25
L2_xl25:
    s_waitcnt lgkmcnt(0)
    v_mov_b32 v31, -1
    s_cmp_ge_u32 s37, 512
    s_cbranch_scc1 L2_xg25
    v_mov_b32 v39, -1
    s_cmp_ge_u32 s37, 256
    s_cbranch_scc1 L2_xg25
    v_mov_b32 v27, -1
    s_branch L2_xg25
L2_xt25:
    s_waitcnt lgkmcnt(0)
    v_mov_b32 v21, -1
    v_mov_b32 v27, -1
    v_mov_b32 v39, -1
    v_mov_b32 v31, -1
    s_add_u32 s3, s42, 2
    s_bitset1_b32 s36, s3
    s_branch L2_xg25
L2_oa28:
    v_and_b32 v47, 0x0fffffff, v33
    buffer_load_dword v114, v47, s[8:11], 0 offen offset:16
    s_mov_b64 exec, s[6:7]
    v_add_u32 v47, 8, v47
    v_lshrrev_b32 v33, 2, v33
    s_mov_b64 exec, -1
    buffer_load_dwordx2 v[112:113], v47, s[8:11], 0 offen
    s_branch L2_ob28
L2_c29:
    s_lshl_b64 s[52:53], s[82:83], 1
    s_andn2_b64 s[52:53], s[52:53], s[80:81]
    s_andn2_b64 s[52:53], s[52:53], s[54:55]
    s_or_b64 s[80:81], s[80:81], s[52:53]
    s_not_b64 vcc, s[52:53]
    s_mov_b64 exec, -1
    v_cndmask_b32_dpp v84, v84, v84, vcc wave_shr:1 row_mask:0xf bank_mask:0xf
    v_cndmask_b32_dpp v85, v85, v85, vcc wave_shr:1 row_mask:0xf bank_mask:0xf
    s_lshr_b64 s[52:53], s[52:53], 1
    v_cndmask_b32_dpp v86, v86, v86, vcc wave_shr:1 row_mask:0xf bank_mask:0xf
    v_cndmask_b32_dpp v87, v87, v87, vcc wave_shr:1 row_mask:0xf bank_mask:0xf
    s_andn2_b64 s[82:83], s[82:83], s[52:53]
    v_cndmask_b32_dpp v7, v7, v7, vcc wave_shr:1 row_mask:0xf bank_mask:0xf
    s_mov_b64 exec, s[54:55]
    s_cbranch_scc0 L2_d29
    s_mov_b64 exec, s[82:83]
    s_nop 1
    v_mfma_f32_4x4x4_16b_bf16 v[88:91], v[12:13], v[84:85], 0
    s_nop 1
    v_mfma_f32_4x4x4_16b_bf16 v[88:91], v[10:11], v[86:87], v[88:91]
    s_nop 4
    v_cvt_pk_bf16_f32 v88, v88, v89
    v_cvt_pk_bf16_f32 v89, v90, v91
    ds_pk_add_bf16 v7, v88 offset:65408
    ds_pk_add_bf16 v7, v89 offset:65412
    s_mov_b64 exec, s[54:55]
    s_branch L2_d29
L2_c30:
    s_lshl_b64 s[52:53], s[82:83], 1
    s_andn2_b64 s[52:53], s[52:53], s[80:81]
    s_andn2_b64 s[52:53], s[52:53], s[50:51]
    s_or_b64 s[80:81], s[80:81], s[52:53]
    s_not_b64 vcc, s[52:53]
    s_mov_b64 exec, -1
    v_cndmask_b32_dpp v84, v84, v84, vcc wave_shr:1 row_mask:0xf bank_mask:0xf
    v_cndmask_b32_dpp v85, v85, v85, vcc wave_shr:1 row_mask:0xf bank_mask:0xf
    s_lshr_b64 s[52:53], s[52:53], 1
    v_cndmask_b32_dpp v86, v86, v86, vcc wave_shr:1 row_mask:0xf bank_mask:0xf
    v_cndmask_b32_dpp v87, v87, v87, vcc wave_shr:1 row_mask:0xf bank_mask:0xf
    s_andn2_b64 s[82:83], s[82:83], s[52:53]
    v_cndmask_b32_dpp v7, v7, v7, vcc wave_shr:1 row_mask:0xf bank_mask:0xf
    s_mov_b64 exec, s[50:51]
    s_cbranch_scc0 L2_d30
    s_mov_b64 exec, s[82:83]
    s_nop 1
    v_mfma_f32_4x4x4_16b_bf16 v[88:91], v[12:13], v[84:85], 0
    s_nop 1
    v_mfma_f32_4x4x4_16b_bf16 v[88:91], v[10:11], v[86:87], v[88:91]
    s_nop 4
    v_cvt_pk_bf16_f32 v88, v88, v89
    v_cvt_pk_bf16_f32 v89, v90, v91
    ds_pk_add_bf16 v7, v88 offset:65408
    ds_pk_add_bf16 v7, v89 offset:65412
    s_mov_b64 exec, s[50:51]
    s_branch L2_d30
L2_c31:
    s_lshl_b64 s[52:53], s[82:83], 1
    s_andn2_b64 s[52:53], s[52:53], s[80:81]
    s_andn2_b64 s[52:53], s[52:53], s[54:55]
    s_or_b64 s[80:81], s[80:81], s[52:53]
    s_not_b64 vcc, s[52:53]
    s_mov_b64 exec, -1
    v_cndmask_b32_dpp v84, v84, v84, vcc wave_shr:1 row_mask:0xf bank_mask:0xf
    v_cndmask_b32_dpp v85, v85, v85, vcc wave_shr:1 row_mask:0xf bank_mask:0xf
    s_lshr_b64 s[52:53], s[52:53], 1
    v_cndmask_b32_dpp v86, v86, v86, vcc wave_shr:1 row_mask:0xf bank_mask:0xf
    v_cndmask_b32_dpp v87, v87, v87, vcc wave_shr:1 row_mask:0xf bank_mask:0xf
    s_andn2_b64 s[82:83], s[82:83], s[52:53]
    v_cndmask_b32_dpp v7, v7, v7, vcc wave_shr:1 row_mask:0xf bank_mask:0xf
    s_mov_b64 exec, s[54:55]
    s_cbranch_scc0 L2_d31
    s_mov_b64 exec, s[82:83]
    s_nop 1
    v_mfma_f32_4x4x4_16b_bf16 v[88:91], v[12:13], v[84:85], 0
    s_nop 1
    v_mfma_f32_4x4x4_16b_bf16 v[88:91], v[10:11], v[86:87], v[88:91]
    s_nop 4
    v_cvt_pk_bf16_f32 v88, v88, v89
    v_cvt_pk_bf16_f32 v89, v90, v91
    ds_pk_add_bf16 v7, v88 offset:65408
    ds_pk_add_bf16 v7, v89 offset:65412
    s_mov_b64 exec, s[54:55]
    s_branch L2_d31
L2_c32:
    s_lshl_b64 s[52:53], s[82:83], 1
    s_andn2_b64 s[52:53], s[52:53], s[80:81]
    s_andn2_b64 s[52:53], s[52:53], s[50:51]
    s_or_b64 s[80:81], s[80:81], s[52:53]
    s_not_b64 vcc, s[52:53]
    s_mov_b64 exec, -1
    v_cndmask_b32_dpp v84, v84, v84, vcc wave_shr:1 row_mask:0xf bank_mask:0xf
    v_cndmask_b32_dpp v85, v85, v85, vcc wave_shr:1 row_mask:0xf bank_mask:0xf
    s_lshr_b64 s[52:53], s[52:53], 1
    v_cndmask_b32_dpp v86, v86, v86, vcc wave_shr:1 row_mask:0xf bank_mask:0xf
    v_cndmask_b32_dpp v87, v87, v87, vcc wave_shr:1 row_mask:0xf bank_mask:0xf
    s_andn2_b64 s[82:83], s[82:83], s[52:53]
    v_cndmask_b32_dpp v7, v7, v7, vcc wave_shr:1 row_mask:0xf bank_mask:0xf
    s_mov_b64 exec, s[50:51]
    s_cbranch_scc0 L2_d32
    s_mov_b64 exec, s[82:83]
    s_nop 1
    v_mfma_f32_4x4x4_16b_bf16 v[88:91], v[12:13], v[84:85], 0
    s_nop 1
    v_mfma_f32_4x4x4_16b_bf16 v[88:91], v[10:11], v[86:87], v[88:91]
    s_nop 4
    v_cvt_pk_bf16_f32 v88, v88, v89
    v_cvt_pk_bf16_f32 v89, v90, v91
    ds_pk_add_bf16 v7, v88 offset:65408
    ds_pk_add_bf16 v7, v89 offset:65412
    s_mov_b64 exec, s[50:51]
    s_branch L2_d32
L2_c33:
    s_lshl_b64 s[52:53], s[82:83], 1
    s_andn2_b64 s[52:53], s[52:53], s[80:81]
    s_andn2_b64 s[52:53], s[52:53], s[54:55]
    s_or_b64 s[80:81], s[80:81], s[52:53]
    s_not_b64 vcc, s[52:53]
    s_mov_b64 exec, -1
    v_cndmask_b32_dpp v84, v84, v84, vcc wave_shr:1 row_mask:0xf bank_mask:0xf
    v_cndmask_b32_dpp v85, v85, v85, vcc wave_shr:1 row_mask:0xf bank_mask:0xf
    s_lshr_b64 s[52:53], s[52:53], 1
    v_cndmask_b32_dpp v86, v86, v86, vcc wave_shr:1 row_mask:0xf bank_mask:0xf
    v_cndmask_b32_dpp v87, v87, v87, vcc wave_shr:1 row_mask:0xf bank_mask:0xf
    s_andn2_b64 s[82:83], s[82:83], s[52:53]
    v_cndmask_b32_dpp v7, v7, v7, vcc wave_shr:1 row_mask:0xf bank_mask:0xf
    s_mov_b64 exec, s[54:55]
    s_cbranch_scc0 L2_d33
    s_mov_b64 exec, s[82:83]
    s_nop 1
    v_mfma_f32_4x4x4_16b_bf16 v[88:91], v[12:13], v[84:85], 0
    s_nop 1
    v_mfma_f32_4x4x4_16b_bf16 v[88:91], v[10:11], v[86:87], v[88:91]
    s_nop 4
    v_cvt_pk_bf16_f32 v88, v88, v89
    v_cvt_pk_bf16_f32 v89, v90, v91
    ds_pk_add_bf16 v7, v88 offset:65408
    ds_pk_add_bf16 v7, v89 offset:65412
    s_mov_b64 exec, s[54:55]
    s_branch L2_d33
L2_c34:
    s_lshl_b64 s[52:53], s[82:83], 1
    s_andn2_b64 s[52:53], s[52:53], s[80:81]
    s_andn2_b64 s[52:53], s[52:53], s[50:51]
    s_or_b64 s[80:81], s[80:81], s[52:53]
    s_not_b64 vcc, s[52:53]
    s_mov_b64 exec, -1
    v_cndmask_b32_dpp v84, v84, v84, vcc wave_shr:1 row_mask:0xf bank_mask:0xf
    v_cndmask_b32_dpp v85, v85, v85, vcc wave_shr:1 row_mask:0xf bank_mask:0xf
    s_lshr_b64 s[52:53], s[52:53], 1
    v_cndmask_b32_dpp v86, v86, v86, vcc wave_shr:1 row_mask:0xf bank_mask:0xf
    v_cndmask_b32_dpp v87, v87, v87, vcc wave_shr:1 row_mask:0xf bank_mask:0xf
    s_andn2_b64 s[82:83], s[82:83], s[52:53]
    v_cndmask_b32_dpp v7, v7, v7, vcc wave_shr:1 row_mask:0xf bank_mask:0xf
    s_mov_b64 exec, s[50:51]
    s_cbranch_scc0 L2_d34
    s_mov_b64 exec, s[82:83]
    s_nop 1
    v_mfma_f32_4x4x4_16b_bf16 v[88:91], v[12:13], v[84:85], 0
    s_nop 1
    v_mfma_f32_4x4x4_16b_bf16 v[88:91], v[10:11], v[86:87], v[88:91]
    s_nop 4
    v_cvt_pk_bf16_f32 v88, v88, v89
    v_cvt_pk_bf16_f32 v89, v90, v91
    ds_pk_add_bf16 v7, v88 offset:65408
    ds_pk_add_bf16 v7, v89 offset:65412
    s_mov_b64 exec, s[50:51]
    s_branch L2_d34
L2_oa35:
    s_waitcnt vmcnt(3)
    s_mov_b64 exec, s[6:7]
    v_lshrrev_b32 v114, 16, v114
    s_mov_b64 exec, -1
    v_and_b32 v46, 0x10000000, v33
    v_cmpx_eq_u32 vcc, 0, v46
    v_lshrrev_b32 v47, 14, v112
    v_and_b32 v47, v5, v47
    ds_read_b64 v[96:97], v47
    v_perm_b32 v98, v112, v114, s44
    v_bitop3_b32 v99, v112, 0.5, -0.5 bitop3:0xa8
    v_bitop3_b32 v98, v6, v98, v99 bitop3:0xca
    v_and_b32 v47, v5, v112
    s_waitcnt lgkmcnt(0)
    v_mfma_f32_4x4x4_16b_bf16 v[88:91], v[8:9], v[96:97], 0
    s_nop 4
    v_mul_f32 v88, v98, v88
    v_mul_f32 v89, v98, v89
    v_mul_f32 v90, v98, v90
    v_mul_f32 v91, v98, v91
    v_cvt_pk_bf16_f32 v88, v88, v89
    v_cvt_pk_bf16_f32 v89, v90, v91
    ds_pk_add_bf16 v47, v88 offset:65408
    ds_pk_add_bf16 v47, v89 offset:65412
    s_mov_b64 exec, -1
    v_and_b32 v46, 0x20000000, v33
    v_cmpx_eq_u32 vcc, 0, v46
    v_lshrrev_b32 v47, 14, v113
    v_and_b32 v47, v5, v47
    ds_read_b64 v[96:97], v47
    v_perm_b32 v98, v113, v114, s45
    v_bitop3_b32 v99, v113, 0.5, -0.5 bitop3:0xa8
    v_bitop3_b32 v98, v6, v98, v99 bitop3:0xca
    v_and_b32 v47, v5, v113
    s_waitcnt lgkmcnt(0)
    v_mfma_f32_4x4x4_16b_bf16 v[88:91], v[8:9], v[96:97], 0
    s_nop 4
    v_mul_f32 v88, v98, v88
    v_mul_f32 v89, v98, v89
    v_mul_f32 v90, v98, v90
    v_mul_f32 v91, v98, v91
    v_cvt_pk_bf16_f32 v88, v88, v89
    v_cvt_pk_bf16_f32 v89, v90, v91
    ds_pk_add_bf16 v47, v88 offset:65408
    ds_pk_add_bf16 v47, v89 offset:65412
    s_mov_b64 exec, -1
    s_branch L2_ob35
L2_xo36:
    v_cmp_lt_u32 vcc, 20, v99
    s_mov_b32 s101, 1
    s_cbranch_vccz L2_xp36
    v_cmp_lt_u32 vcc, 32, v99
    v_cmp_lt_u32 s[58:59], 31, v88
    s_mov_b32 s101, 2
    s_or_b64 vcc, vcc, s[58:59]
    s_cbranch_scc0 L2_xp36
    s_mov_b32 s37, 0x10000
    s_branch L2_xp36
L2_c37:
    s_lshl_b64 s[52:53], s[82:83], 1
    s_andn2_b64 s[52:53], s[52:53], s[80:81]
    s_andn2_b64 s[52:53], s[52:53], s[54:55]
    s_or_b64 s[80:81], s[80:81], s[52:53]
    s_not_b64 vcc, s[52:53]
    s_mov_b64 exec, -1
    v_cndmask_b32_dpp v84, v84, v84, vcc wave_shr:1 row_mask:0xf bank_mask:0xf
    v_cndmask_b32_dpp v85, v85, v85, vcc wave_shr:1 row_mask:0xf bank_mask:0xf
    s_lshr_b64 s[52:53], s[52:53], 1
    v_cndmask_b32_dpp v86, v86, v86, vcc wave_shr:1 row_mask:0xf bank_mask:0xf
    v_cndmask_b32_dpp v87, v87, v87, vcc wave_shr:1 row_mask:0xf bank_mask:0xf
    s_andn2_b64 s[82:83], s[82:83], s[52:53]
    v_cndmask_b32_dpp v7, v7, v7, vcc wave_shr:1 row_mask:0xf bank_mask:0xf
    s_mov_b64 exec, s[54:55]
    s_cbranch_scc0 L2_d37
    s_mov_b64 exec, s[82:83]
    s_nop 1
    v_mfma_f32_4x4x4_16b_bf16 v[88:91], v[12:13], v[84:85], 0
    s_nop 1
    v_mfma_f32_4x4x4_16b_bf16 v[88:91], v[10:11], v[86:87], v[88:91]
    s_nop 4
    v_cvt_pk_bf16_f32 v88, v88, v89
    v_cvt_pk_bf16_f32 v89, v90, v91
    ds_pk_add_bf16 v7, v88 offset:65408
    ds_pk_add_bf16 v7, v89 offset:65412
    s_mov_b64 exec, s[54:55]
    s_branch L2_d37
L2_c38:
    s_lshl_b64 s[52:53], s[82:83], 1
    s_andn2_b64 s[52:53], s[52:53], s[80:81]
    s_andn2_b64 s[52:53], s[52:53], s[50:51]
    s_or_b64 s[80:81], s[80:81], s[52:53]
    s_not_b64 vcc, s[52:53]
    s_mov_b64 exec, -1
    v_cndmask_b32_dpp v84, v84, v84, vcc wave_shr:1 row_mask:0xf bank_mask:0xf
    v_cndmask_b32_dpp v85, v85, v85, vcc wave_shr:1 row_mask:0xf bank_mask:0xf
    s_lshr_b64 s[52:53], s[52:53], 1
    v_cndmask_b32_dpp v86, v86, v86, vcc wave_shr:1 row_mask:0xf bank_mask:0xf
    v_cndmask_b32_dpp v87, v87, v87, vcc wave_shr:1 row_mask:0xf bank_mask:0xf
    s_andn2_b64 s[82:83], s[82:83], s[52:53]
    v_cndmask_b32_dpp v7, v7, v7, vcc wave_shr:1 row_mask:0xf bank_mask:0xf
    s_mov_b64 exec, s[50:51]
    s_cbranch_scc0 L2_d38
    s_mov_b64 exec, s[82:83]
    s_nop 1
    v_mfma_f32_4x4x4_16b_bf16 v[88:91], v[12:13], v[84:85], 0
    s_nop 1
    v_mfma_f32_4x4x4_16b_bf16 v[88:91], v[10:11], v[86:87], v[88:91]
    s_nop 4
    v_cvt_pk_bf16_f32 v88, v88, v89
    v_cvt_pk_bf16_f32 v89, v90, v91
    ds_pk_add_bf16 v7, v88 offset:65408
    ds_pk_add_bf16 v7, v89 offset:65412
    s_mov_b64 exec, s[50:51]
    s_branch L2_d38
L2_c39:
    s_lshl_b64 s[52:53], s[82:83], 1
    s_andn2_b64 s[52:53], s[52:53], s[80:81]
    s_andn2_b64 s[52:53], s[52:53], s[54:55]
    s_or_b64 s[80:81], s[80:81], s[52:53]
    s_not_b64 vcc, s[52:53]
    s_mov_b64 exec, -1
    v_cndmask_b32_dpp v84, v84, v84, vcc wave_shr:1 row_mask:0xf bank_mask:0xf
    v_cndmask_b32_dpp v85, v85, v85, vcc wave_shr:1 row_mask:0xf bank_mask:0xf
    s_lshr_b64 s[52:53], s[52:53], 1
    v_cndmask_b32_dpp v86, v86, v86, vcc wave_shr:1 row_mask:0xf bank_mask:0xf
    v_cndmask_b32_dpp v87, v87, v87, vcc wave_shr:1 row_mask:0xf bank_mask:0xf
    s_andn2_b64 s[82:83], s[82:83], s[52:53]
    v_cndmask_b32_dpp v7, v7, v7, vcc wave_shr:1 row_mask:0xf bank_mask:0xf
    s_mov_b64 exec, s[54:55]
    s_cbranch_scc0 L2_d39
    s_mov_b64 exec, s[82:83]
    s_nop 1
    v_mfma_f32_4x4x4_16b_bf16 v[88:91], v[12:13], v[84:85], 0
    s_nop 1
    v_mfma_f32_4x4x4_16b_bf16 v[88:91], v[10:11], v[86:87], v[88:91]
    s_nop 4
    v_cvt_pk_bf16_f32 v88, v88, v89
    v_cvt_pk_bf16_f32 v89, v90, v91
    ds_pk_add_bf16 v7, v88 offset:65408
    ds_pk_add_bf16 v7, v89 offset:65412
    s_mov_b64 exec, s[54:55]
    s_branch L2_d39
L2_c40:
    s_lshl_b64 s[52:53], s[82:83], 1
    s_andn2_b64 s[52:53], s[52:53], s[80:81]
    s_andn2_b64 s[52:53], s[52:53], s[50:51]
    s_or_b64 s[80:81], s[80:81], s[52:53]
    s_not_b64 vcc, s[52:53]
    s_mov_b64 exec, -1
    v_cndmask_b32_dpp v84, v84, v84, vcc wave_shr:1 row_mask:0xf bank_mask:0xf
    v_cndmask_b32_dpp v85, v85, v85, vcc wave_shr:1 row_mask:0xf bank_mask:0xf
    s_lshr_b64 s[52:53], s[52:53], 1
    v_cndmask_b32_dpp v86, v86, v86, vcc wave_shr:1 row_mask:0xf bank_mask:0xf
    v_cndmask_b32_dpp v87, v87, v87, vcc wave_shr:1 row_mask:0xf bank_mask:0xf
    s_andn2_b64 s[82:83], s[82:83], s[52:53]
    v_cndmask_b32_dpp v7, v7, v7, vcc wave_shr:1 row_mask:0xf bank_mask:0xf
    s_mov_b64 exec, s[50:51]
    s_cbranch_scc0 L2_d40
    s_mov_b64 exec, s[82:83]
    s_nop 1
    v_mfma_f32_4x4x4_16b_bf16 v[88:91], v[12:13], v[84:85], 0
    s_nop 1
    v_mfma_f32_4x4x4_16b_bf16 v[88:91], v[10:11], v[86:87], v[88:91]
    s_nop 4
    v_cvt_pk_bf16_f32 v88, v88, v89
    v_cvt_pk_bf16_f32 v89, v90, v91
    ds_pk_add_bf16 v7, v88 offset:65408
    ds_pk_add_bf16 v7, v89 offset:65412
    s_mov_b64 exec, s[50:51]
    s_branch L2_d40
L2_c41:
    s_lshl_b64 s[52:53], s[82:83], 1
    s_andn2_b64 s[52:53], s[52:53], s[80:81]
    s_andn2_b64 s[52:53], s[52:53], s[54:55]
    s_or_b64 s[80:81], s[80:81], s[52:53]
    s_not_b64 vcc, s[52:53]
    s_mov_b64 exec, -1
    v_cndmask_b32_dpp v84, v84, v84, vcc wave_shr:1 row_mask:0xf bank_mask:0xf
    v_cndmask_b32_dpp v85, v85, v85, vcc wave_shr:1 row_mask:0xf bank_mask:0xf
    s_lshr_b64 s[52:53], s[52:53], 1
    v_cndmask_b32_dpp v86, v86, v86, vcc wave_shr:1 row_mask:0xf bank_mask:0xf
    v_cndmask_b32_dpp v87, v87, v87, vcc wave_shr:1 row_mask:0xf bank_mask:0xf
    s_andn2_b64 s[82:83], s[82:83], s[52:53]
    v_cndmask_b32_dpp v7, v7, v7, vcc wave_shr:1 row_mask:0xf bank_mask:0xf
    s_mov_b64 exec, s[54:55]
    s_cbranch_scc0 L2_d41
    s_mov_b64 exec, s[82:83]
    s_nop 1
    v_mfma_f32_4x4x4_16b_bf16 v[88:91], v[12:13], v[84:85], 0
    s_nop 1
    v_mfma_f32_4x4x4_16b_bf16 v[88:91], v[10:11], v[86:87], v[88:91]
    s_nop 4
    v_cvt_pk_bf16_f32 v88, v88, v89
    v_cvt_pk_bf16_f32 v89, v90, v91
    ds_pk_add_bf16 v7, v88 offset:65408
    ds_pk_add_bf16 v7, v89 offset:65412
    s_mov_b64 exec, s[54:55]
    s_branch L2_d41
L2_c42:
    s_lshl_b64 s[52:53], s[82:83], 1
    s_andn2_b64 s[52:53], s[52:53], s[80:81]
    s_andn2_b64 s[52:53], s[52:53], s[50:51]
    s_or_b64 s[80:81], s[80:81], s[52:53]
    s_not_b64 vcc, s[52:53]
    s_mov_b64 exec, -1
    v_cndmask_b32_dpp v84, v84, v84, vcc wave_shr:1 row_mask:0xf bank_mask:0xf
    v_cndmask_b32_dpp v85, v85, v85, vcc wave_shr:1 row_mask:0xf bank_mask:0xf
    s_lshr_b64 s[52:53], s[52:53], 1
    v_cndmask_b32_dpp v86, v86, v86, vcc wave_shr:1 row_mask:0xf bank_mask:0xf
    v_cndmask_b32_dpp v87, v87, v87, vcc wave_shr:1 row_mask:0xf bank_mask:0xf
    s_andn2_b64 s[82:83], s[82:83], s[52:53]
    v_cndmask_b32_dpp v7, v7, v7, vcc wave_shr:1 row_mask:0xf bank_mask:0xf
    s_mov_b64 exec, s[50:51]
    s_cbranch_scc0 L2_d42
    s_mov_b64 exec, s[82:83]
    s_nop 1
    v_mfma_f32_4x4x4_16b_bf16 v[88:91], v[12:13], v[84:85], 0
    s_nop 1
    v_mfma_f32_4x4x4_16b_bf16 v[88:91], v[10:11], v[86:87], v[88:91]
    s_nop 4
    v_cvt_pk_bf16_f32 v88, v88, v89
    v_cvt_pk_bf16_f32 v89, v90, v91
    ds_pk_add_bf16 v7, v88 offset:65408
    ds_pk_add_bf16 v7, v89 offset:65412
    s_mov_b64 exec, s[50:51]
    s_branch L2_d42
L2_xa43:
    s_cmp_eq_u32 s101, 1
    s_cbranch_scc1 L2_xc43
    v_lshlrev_b32 v89, 0, v96
    v_add_u32 v90, 140, v97
    v_bitop3_b32 v90, v89, v45, v90 bitop3:0x6a
    ds_write_b32 v98, v90 offset:28
    v_lshlrev_b32 v89, 4, v96
    v_add_u32 v90, 120, v97
    v_bitop3_b32 v90, v89, v45, v90 bitop3:0x6a
    ds_write_b32 v98, v90 offset:24
    v_lshlrev_b32 v89, 8, v96
    v_add_u32 v90, 100, v97
    v_bitop3_b32 v90, v89, v45, v90 bitop3:0x6a
    ds_write_b32 v98, v90 offset:20
L2_xc43:
    v_lshlrev_b32 v89, 12, v96
    v_add_u32 v90, 80, v97
    v_bitop3_b32 v90, v89, v45, v90 bitop3:0x6a
    ds_write_b32 v98, v90 offset:16
    s_branch L2_xb43
L2_xe43:
    v_cmp_lt_u32 vcc, 32, v99
    v_cmp_lt_u32 s[58:59], 31, v88
    v_lshrrev_b32 v89, 16, v96
    v_add_u32 v97, 80, v97
    s_or_b64 vcc, vcc, s[58:59]
    s_cbranch_scc1 L2_xs43
    v_lshlrev_b32 v89, v1, v89
    v_and_b32 v89, v45, v89
    v_cmp_ne_u32 vcc, 0, v89
    v_xor_b32 v90, v97, v89
    s_add_u32 s3, s37, s38
    v_mbcnt_lo_u32_b32 v98, vcc_lo, 0
    v_mbcnt_hi_u32_b32 v98, vcc_hi, v98
    s_bcnt1_i32_b64 s41, vcc
    v_lshl_add_u32 v98, v98, 2, s3
    s_lshl2_add_u32 s37, s41, s37
    s_mov_b64 exec, vcc
    ds_write_b32 v98, v90
    s_mov_b64 exec, -1
    s_branch L2_xr43
L2_xs43:
    s_waitcnt lgkmcnt(0)
    s_mov_b32 s37, 0x10000
    s_branch L2_xw43
L2_c44:
    s_lshl_b64 s[52:53], s[82:83], 1
    s_andn2_b64 s[52:53], s[52:53], s[80:81]
    s_andn2_b64 s[52:53], s[52:53], s[54:55]
    s_or_b64 s[80:81], s[80:81], s[52:53]
    s_not_b64 vcc, s[52:53]
    s_mov_b64 exec, -1
    v_cndmask_b32_dpp v84, v84, v84, vcc wave_shr:1 row_mask:0xf bank_mask:0xf
    v_cndmask_b32_dpp v85, v85, v85, vcc wave_shr:1 row_mask:0xf bank_mask:0xf
    s_lshr_b64 s[52:53], s[52:53], 1
    v_cndmask_b32_dpp v86, v86, v86, vcc wave_shr:1 row_mask:0xf bank_mask:0xf
    v_cndmask_b32_dpp v87, v87, v87, vcc wave_shr:1 row_mask:0xf bank_mask:0xf
    s_andn2_b64 s[82:83], s[82:83], s[52:53]
    v_cndmask_b32_dpp v7, v7, v7, vcc wave_shr:1 row_mask:0xf bank_mask:0xf
    s_mov_b64 exec, s[54:55]
    s_cbranch_scc0 L2_d44
    s_mov_b64 exec, s[82:83]
    s_nop 1
    v_mfma_f32_4x4x4_16b_bf16 v[88:91], v[12:13], v[84:85], 0
    s_nop 1
    v_mfma_f32_4x4x4_16b_bf16 v[88:91], v[10:11], v[86:87], v[88:91]
    s_nop 4
    v_cvt_pk_bf16_f32 v88, v88, v89
    v_cvt_pk_bf16_f32 v89, v90, v91
    ds_pk_add_bf16 v7, v88 offset:65408
    ds_pk_add_bf16 v7, v89 offset:65412
    s_mov_b64 exec, s[54:55]
    s_branch L2_d44
L2_c45:
    s_lshl_b64 s[52:53], s[82:83], 1
    s_andn2_b64 s[52:53], s[52:53], s[80:81]
    s_andn2_b64 s[52:53], s[52:53], s[50:51]
    s_or_b64 s[80:81], s[80:81], s[52:53]
    s_not_b64 vcc, s[52:53]
    s_mov_b64 exec, -1
    v_cndmask_b32_dpp v84, v84, v84, vcc wave_shr:1 row_mask:0xf bank_mask:0xf
    v_cndmask_b32_dpp v85, v85, v85, vcc wave_shr:1 row_mask:0xf bank_mask:0xf
    s_lshr_b64 s[52:53], s[52:53], 1
    v_cndmask_b32_dpp v86, v86, v86, vcc wave_shr:1 row_mask:0xf bank_mask:0xf
    v_cndmask_b32_dpp v87, v87, v87, vcc wave_shr:1 row_mask:0xf bank_mask:0xf
    s_andn2_b64 s[82:83], s[82:83], s[52:53]
    v_cndmask_b32_dpp v7, v7, v7, vcc wave_shr:1 row_mask:0xf bank_mask:0xf
    s_mov_b64 exec, s[50:51]
    s_cbranch_scc0 L2_d45
    s_mov_b64 exec, s[82:83]
    s_nop 1
    v_mfma_f32_4x4x4_16b_bf16 v[88:91], v[12:13], v[84:85], 0
    s_nop 1
    v_mfma_f32_4x4x4_16b_bf16 v[88:91], v[10:11], v[86:87], v[88:91]
    s_nop 4
    v_cvt_pk_bf16_f32 v88, v88, v89
    v_cvt_pk_bf16_f32 v89, v90, v91
    ds_pk_add_bf16 v7, v88 offset:65408
    ds_pk_add_bf16 v7, v89 offset:65412
    s_mov_b64 exec, s[50:51]
    s_branch L2_d45
L2_xf43:
    s_cmp_gt_u32 s37, 1024
    s_cbranch_scc1 L2_xt43
    s_cmp_lt_u32 s37, 768
    s_cbranch_scc1 L2_xl43
    ds_read_b32 v33, v44 offset:896
    s_add_u32 s3, s42, 2
    s_bitset1_b32 s43, s3
    s_branch L2_xg43
L2_xl43:
    s_waitcnt lgkmcnt(0)
    v_mov_b32 v42, -1
    s_cmp_ge_u32 s37, 512
    s_cbranch_scc1 L2_xg43
    v_mov_b32 v43, -1
    s_cmp_ge_u32 s37, 256
    s_cbranch_scc1 L2_xg43
    v_mov_b32 v41, -1
    s_branch L2_xg43
L2_xt43:
    s_waitcnt lgkmcnt(0)
    v_mov_b32 v40, -1
    v_mov_b32 v41, -1
    v_mov_b32 v43, -1
    v_mov_b32 v42, -1
    s_add_u32 s3, s42, 2
    s_bitset1_b32 s36, s3
    s_branch L2_xg43
L2_oa46:
    v_and_b32 v47, 0x0fffffff, v32
    buffer_load_dword v114, v47, s[8:11], 0 offen offset:16
    s_mov_b64 exec, s[6:7]
    v_add_u32 v47, 8, v47
    v_lshrrev_b32 v32, 2, v32
    s_mov_b64 exec, -1
    buffer_load_dwordx2 v[112:113], v47, s[8:11], 0 offen
    s_branch L2_ob46
L2_c47:
    s_lshl_b64 s[52:53], s[82:83], 1
    s_andn2_b64 s[52:53], s[52:53], s[80:81]
    s_andn2_b64 s[52:53], s[52:53], s[54:55]
    s_or_b64 s[80:81], s[80:81], s[52:53]
    s_not_b64 vcc, s[52:53]
    s_mov_b64 exec, -1
    v_cndmask_b32_dpp v84, v84, v84, vcc wave_shr:1 row_mask:0xf bank_mask:0xf
    v_cndmask_b32_dpp v85, v85, v85, vcc wave_shr:1 row_mask:0xf bank_mask:0xf
    s_lshr_b64 s[52:53], s[52:53], 1
    v_cndmask_b32_dpp v86, v86, v86, vcc wave_shr:1 row_mask:0xf bank_mask:0xf
    v_cndmask_b32_dpp v87, v87, v87, vcc wave_shr:1 row_mask:0xf bank_mask:0xf
    s_andn2_b64 s[82:83], s[82:83], s[52:53]
    v_cndmask_b32_dpp v7, v7, v7, vcc wave_shr:1 row_mask:0xf bank_mask:0xf
    s_mov_b64 exec, s[54:55]
    s_cbranch_scc0 L2_d47
    s_mov_b64 exec, s[82:83]
    s_nop 1
    v_mfma_f32_4x4x4_16b_bf16 v[88:91], v[12:13], v[84:85], 0
    s_nop 1
    v_mfma_f32_4x4x4_16b_bf16 v[88:91], v[10:11], v[86:87], v[88:91]
    s_nop 4
    v_cvt_pk_bf16_f32 v88, v88, v89
    v_cvt_pk_bf16_f32 v89, v90, v91
    ds_pk_add_bf16 v7, v88 offset:65408
    ds_pk_add_bf16 v7, v89 offset:65412
    s_mov_b64 exec, s[54:55]
    s_branch L2_d47
L2_c48:
    s_lshl_b64 s[52:53], s[82:83], 1
    s_andn2_b64 s[52:53], s[52:53], s[80:81]
    s_andn2_b64 s[52:53], s[52:53], s[50:51]
    s_or_b64 s[80:81], s[80:81], s[52:53]
    s_not_b64 vcc, s[52:53]
    s_mov_b64 exec, -1
    v_cndmask_b32_dpp v84, v84, v84, vcc wave_shr:1 row_mask:0xf bank_mask:0xf
    v_cndmask_b32_dpp v85, v85, v85, vcc wave_shr:1 row_mask:0xf bank_mask:0xf
    s_lshr_b64 s[52:53], s[52:53], 1
    v_cndmask_b32_dpp v86, v86, v86, vcc wave_shr:1 row_mask:0xf bank_mask:0xf
    v_cndmask_b32_dpp v87, v87, v87, vcc wave_shr:1 row_mask:0xf bank_mask:0xf
    s_andn2_b64 s[82:83], s[82:83], s[52:53]
    v_cndmask_b32_dpp v7, v7, v7, vcc wave_shr:1 row_mask:0xf bank_mask:0xf
    s_mov_b64 exec, s[50:51]
    s_cbranch_scc0 L2_d48
    s_mov_b64 exec, s[82:83]
    s_nop 1
    v_mfma_f32_4x4x4_16b_bf16 v[88:91], v[12:13], v[84:85], 0
    s_nop 1
    v_mfma_f32_4x4x4_16b_bf16 v[88:91], v[10:11], v[86:87], v[88:91]
    s_nop 4
    v_cvt_pk_bf16_f32 v88, v88, v89
    v_cvt_pk_bf16_f32 v89, v90, v91
    ds_pk_add_bf16 v7, v88 offset:65408
    ds_pk_add_bf16 v7, v89 offset:65412
    s_mov_b64 exec, s[50:51]
    s_branch L2_d48
L2_c49:
    s_lshl_b64 s[52:53], s[82:83], 1
    s_andn2_b64 s[52:53], s[52:53], s[80:81]
    s_andn2_b64 s[52:53], s[52:53], s[54:55]
    s_or_b64 s[80:81], s[80:81], s[52:53]
    s_not_b64 vcc, s[52:53]
    s_mov_b64 exec, -1
    v_cndmask_b32_dpp v84, v84, v84, vcc wave_shr:1 row_mask:0xf bank_mask:0xf
    v_cndmask_b32_dpp v85, v85, v85, vcc wave_shr:1 row_mask:0xf bank_mask:0xf
    s_lshr_b64 s[52:53], s[52:53], 1
    v_cndmask_b32_dpp v86, v86, v86, vcc wave_shr:1 row_mask:0xf bank_mask:0xf
    v_cndmask_b32_dpp v87, v87, v87, vcc wave_shr:1 row_mask:0xf bank_mask:0xf
    s_andn2_b64 s[82:83], s[82:83], s[52:53]
    v_cndmask_b32_dpp v7, v7, v7, vcc wave_shr:1 row_mask:0xf bank_mask:0xf
    s_mov_b64 exec, s[54:55]
    s_cbranch_scc0 L2_d49
    s_mov_b64 exec, s[82:83]
    s_nop 1
    v_mfma_f32_4x4x4_16b_bf16 v[88:91], v[12:13], v[84:85], 0
    s_nop 1
    v_mfma_f32_4x4x4_16b_bf16 v[88:91], v[10:11], v[86:87], v[88:91]
    s_nop 4
    v_cvt_pk_bf16_f32 v88, v88, v89
    v_cvt_pk_bf16_f32 v89, v90, v91
    ds_pk_add_bf16 v7, v88 offset:65408
    ds_pk_add_bf16 v7, v89 offset:65412
    s_mov_b64 exec, s[54:55]
    s_branch L2_d49
L2_c50:
    s_lshl_b64 s[52:53], s[82:83], 1
    s_andn2_b64 s[52:53], s[52:53], s[80:81]
    s_andn2_b64 s[52:53], s[52:53], s[50:51]
    s_or_b64 s[80:81], s[80:81], s[52:53]
    s_not_b64 vcc, s[52:53]
    s_mov_b64 exec, -1
    v_cndmask_b32_dpp v84, v84, v84, vcc wave_shr:1 row_mask:0xf bank_mask:0xf
    v_cndmask_b32_dpp v85, v85, v85, vcc wave_shr:1 row_mask:0xf bank_mask:0xf
    s_lshr_b64 s[52:53], s[52:53], 1
    v_cndmask_b32_dpp v86, v86, v86, vcc wave_shr:1 row_mask:0xf bank_mask:0xf
    v_cndmask_b32_dpp v87, v87, v87, vcc wave_shr:1 row_mask:0xf bank_mask:0xf
    s_andn2_b64 s[82:83], s[82:83], s[52:53]
    v_cndmask_b32_dpp v7, v7, v7, vcc wave_shr:1 row_mask:0xf bank_mask:0xf
    s_mov_b64 exec, s[50:51]
    s_cbranch_scc0 L2_d50
    s_mov_b64 exec, s[82:83]
    s_nop 1
    v_mfma_f32_4x4x4_16b_bf16 v[88:91], v[12:13], v[84:85], 0
    s_nop 1
    v_mfma_f32_4x4x4_16b_bf16 v[88:91], v[10:11], v[86:87], v[88:91]
    s_nop 4
    v_cvt_pk_bf16_f32 v88, v88, v89
    v_cvt_pk_bf16_f32 v89, v90, v91
    ds_pk_add_bf16 v7, v88 offset:65408
    ds_pk_add_bf16 v7, v89 offset:65412
    s_mov_b64 exec, s[50:51]
    s_branch L2_d50
L2_c51:
    s_lshl_b64 s[52:53], s[82:83], 1
    s_andn2_b64 s[52:53], s[52:53], s[80:81]
    s_andn2_b64 s[52:53], s[52:53], s[54:55]
    s_or_b64 s[80:81], s[80:81], s[52:53]
    s_not_b64 vcc, s[52:53]
    s_mov_b64 exec, -1
    v_cndmask_b32_dpp v84, v84, v84, vcc wave_shr:1 row_mask:0xf bank_mask:0xf
    v_cndmask_b32_dpp v85, v85, v85, vcc wave_shr:1 row_mask:0xf bank_mask:0xf
    s_lshr_b64 s[52:53], s[52:53], 1
    v_cndmask_b32_dpp v86, v86, v86, vcc wave_shr:1 row_mask:0xf bank_mask:0xf
    v_cndmask_b32_dpp v87, v87, v87, vcc wave_shr:1 row_mask:0xf bank_mask:0xf
    s_andn2_b64 s[82:83], s[82:83], s[52:53]
    v_cndmask_b32_dpp v7, v7, v7, vcc wave_shr:1 row_mask:0xf bank_mask:0xf
    s_mov_b64 exec, s[54:55]
    s_cbranch_scc0 L2_d51
    s_mov_b64 exec, s[82:83]
    s_nop 1
    v_mfma_f32_4x4x4_16b_bf16 v[88:91], v[12:13], v[84:85], 0
    s_nop 1
    v_mfma_f32_4x4x4_16b_bf16 v[88:91], v[10:11], v[86:87], v[88:91]
    s_nop 4
    v_cvt_pk_bf16_f32 v88, v88, v89
    v_cvt_pk_bf16_f32 v89, v90, v91
    ds_pk_add_bf16 v7, v88 offset:65408
    ds_pk_add_bf16 v7, v89 offset:65412
    s_mov_b64 exec, s[54:55]
    s_branch L2_d51
L2_c52:
    s_lshl_b64 s[52:53], s[82:83], 1
    s_andn2_b64 s[52:53], s[52:53], s[80:81]
    s_andn2_b64 s[52:53], s[52:53], s[50:51]
    s_or_b64 s[80:81], s[80:81], s[52:53]
    s_not_b64 vcc, s[52:53]
    s_mov_b64 exec, -1
    v_cndmask_b32_dpp v84, v84, v84, vcc wave_shr:1 row_mask:0xf bank_mask:0xf
    v_cndmask_b32_dpp v85, v85, v85, vcc wave_shr:1 row_mask:0xf bank_mask:0xf
    s_lshr_b64 s[52:53], s[52:53], 1
    v_cndmask_b32_dpp v86, v86, v86, vcc wave_shr:1 row_mask:0xf bank_mask:0xf
    v_cndmask_b32_dpp v87, v87, v87, vcc wave_shr:1 row_mask:0xf bank_mask:0xf
    s_andn2_b64 s[82:83], s[82:83], s[52:53]
    v_cndmask_b32_dpp v7, v7, v7, vcc wave_shr:1 row_mask:0xf bank_mask:0xf
    s_mov_b64 exec, s[50:51]
    s_cbranch_scc0 L2_d52
    s_mov_b64 exec, s[82:83]
    s_nop 1
    v_mfma_f32_4x4x4_16b_bf16 v[88:91], v[12:13], v[84:85], 0
    s_nop 1
    v_mfma_f32_4x4x4_16b_bf16 v[88:91], v[10:11], v[86:87], v[88:91]
    s_nop 4
    v_cvt_pk_bf16_f32 v88, v88, v89
    v_cvt_pk_bf16_f32 v89, v90, v91
    ds_pk_add_bf16 v7, v88 offset:65408
    ds_pk_add_bf16 v7, v89 offset:65412
    s_mov_b64 exec, s[50:51]
    s_branch L2_d52
L2_oa53:
    s_waitcnt vmcnt(3)
    s_mov_b64 exec, s[6:7]
    v_lshrrev_b32 v114, 16, v114
    s_mov_b64 exec, -1
    v_and_b32 v46, 0x10000000, v32
    v_cmpx_eq_u32 vcc, 0, v46
    v_lshrrev_b32 v47, 14, v112
    v_and_b32 v47, v5, v47
    ds_read_b64 v[96:97], v47
    v_perm_b32 v98, v112, v114, s44
    v_bitop3_b32 v99, v112, 0.5, -0.5 bitop3:0xa8
    v_bitop3_b32 v98, v6, v98, v99 bitop3:0xca
    v_and_b32 v47, v5, v112
    s_waitcnt lgkmcnt(0)
    v_mfma_f32_4x4x4_16b_bf16 v[88:91], v[8:9], v[96:97], 0
    s_nop 4
    v_mul_f32 v88, v98, v88
    v_mul_f32 v89, v98, v89
    v_mul_f32 v90, v98, v90
    v_mul_f32 v91, v98, v91
    v_cvt_pk_bf16_f32 v88, v88, v89
    v_cvt_pk_bf16_f32 v89, v90, v91
    ds_pk_add_bf16 v47, v88 offset:65408
    ds_pk_add_bf16 v47, v89 offset:65412
    s_mov_b64 exec, -1
    v_and_b32 v46, 0x20000000, v32
    v_cmpx_eq_u32 vcc, 0, v46
    v_lshrrev_b32 v47, 14, v113
    v_and_b32 v47, v5, v47
    ds_read_b64 v[96:97], v47
    v_perm_b32 v98, v113, v114, s45
    v_bitop3_b32 v99, v113, 0.5, -0.5 bitop3:0xa8
    v_bitop3_b32 v98, v6, v98, v99 bitop3:0xca
    v_and_b32 v47, v5, v113
    s_waitcnt lgkmcnt(0)
    v_mfma_f32_4x4x4_16b_bf16 v[88:91], v[8:9], v[96:97], 0
    s_nop 4
    v_mul_f32 v88, v98, v88
    v_mul_f32 v89, v98, v89
    v_mul_f32 v90, v98, v90
    v_mul_f32 v91, v98, v91
    v_cvt_pk_bf16_f32 v88, v88, v89
    v_cvt_pk_bf16_f32 v89, v90, v91
    ds_pk_add_bf16 v47, v88 offset:65408
    ds_pk_add_bf16 v47, v89 offset:65412
    s_mov_b64 exec, -1
    s_branch L2_ob53
L2_xo54:
    v_cmp_lt_u32 vcc, 20, v99
    s_mov_b32 s101, 1
    s_cbranch_vccz L2_xp54
    v_cmp_lt_u32 vcc, 32, v99
    v_cmp_lt_u32 s[58:59], 31, v88
    s_mov_b32 s101, 2
    s_or_b64 vcc, vcc, s[58:59]
    s_cbranch_scc0 L2_xp54
    s_mov_b32 s37, 0x10000
    s_branch L2_xp54
L2_c55:
    s_lshl_b64 s[52:53], s[82:83], 1
    s_andn2_b64 s[52:53], s[52:53], s[80:81]
    s_andn2_b64 s[52:53], s[52:53], s[54:55]
    s_or_b64 s[80:81], s[80:81], s[52:53]
    s_not_b64 vcc, s[52:53]
    s_mov_b64 exec, -1
    v_cndmask_b32_dpp v84, v84, v84, vcc wave_shr:1 row_mask:0xf bank_mask:0xf
    v_cndmask_b32_dpp v85, v85, v85, vcc wave_shr:1 row_mask:0xf bank_mask:0xf
    s_lshr_b64 s[52:53], s[52:53], 1
    v_cndmask_b32_dpp v86, v86, v86, vcc wave_shr:1 row_mask:0xf bank_mask:0xf
    v_cndmask_b32_dpp v87, v87, v87, vcc wave_shr:1 row_mask:0xf bank_mask:0xf
    s_andn2_b64 s[82:83], s[82:83], s[52:53]
    v_cndmask_b32_dpp v7, v7, v7, vcc wave_shr:1 row_mask:0xf bank_mask:0xf
    s_mov_b64 exec, s[54:55]
    s_cbranch_scc0 L2_d55
    s_mov_b64 exec, s[82:83]
    s_nop 1
    v_mfma_f32_4x4x4_16b_bf16 v[88:91], v[12:13], v[84:85], 0
    s_nop 1
    v_mfma_f32_4x4x4_16b_bf16 v[88:91], v[10:11], v[86:87], v[88:91]
    s_nop 4
    v_cvt_pk_bf16_f32 v88, v88, v89
    v_cvt_pk_bf16_f32 v89, v90, v91
    ds_pk_add_bf16 v7, v88 offset:65408
    ds_pk_add_bf16 v7, v89 offset:65412
    s_mov_b64 exec, s[54:55]
    s_branch L2_d55
L2_c56:
    s_lshl_b64 s[52:53], s[82:83], 1
    s_andn2_b64 s[52:53], s[52:53], s[80:81]
    s_andn2_b64 s[52:53], s[52:53], s[50:51]
    s_or_b64 s[80:81], s[80:81], s[52:53]
    s_not_b64 vcc, s[52:53]
    s_mov_b64 exec, -1
    v_cndmask_b32_dpp v84, v84, v84, vcc wave_shr:1 row_mask:0xf bank_mask:0xf
    v_cndmask_b32_dpp v85, v85, v85, vcc wave_shr:1 row_mask:0xf bank_mask:0xf
    s_lshr_b64 s[52:53], s[52:53], 1
    v_cndmask_b32_dpp v86, v86, v86, vcc wave_shr:1 row_mask:0xf bank_mask:0xf
    v_cndmask_b32_dpp v87, v87, v87, vcc wave_shr:1 row_mask:0xf bank_mask:0xf
    s_andn2_b64 s[82:83], s[82:83], s[52:53]
    v_cndmask_b32_dpp v7, v7, v7, vcc wave_shr:1 row_mask:0xf bank_mask:0xf
    s_mov_b64 exec, s[50:51]
    s_cbranch_scc0 L2_d56
    s_mov_b64 exec, s[82:83]
    s_nop 1
    v_mfma_f32_4x4x4_16b_bf16 v[88:91], v[12:13], v[84:85], 0
    s_nop 1
    v_mfma_f32_4x4x4_16b_bf16 v[88:91], v[10:11], v[86:87], v[88:91]
    s_nop 4
    v_cvt_pk_bf16_f32 v88, v88, v89
    v_cvt_pk_bf16_f32 v89, v90, v91
    ds_pk_add_bf16 v7, v88 offset:65408
    ds_pk_add_bf16 v7, v89 offset:65412
    s_mov_b64 exec, s[50:51]
    s_branch L2_d56
L2_c57:
    s_lshl_b64 s[52:53], s[82:83], 1
    s_andn2_b64 s[52:53], s[52:53], s[80:81]
    s_andn2_b64 s[52:53], s[52:53], s[54:55]
    s_or_b64 s[80:81], s[80:81], s[52:53]
    s_not_b64 vcc, s[52:53]
    s_mov_b64 exec, -1
    v_cndmask_b32_dpp v84, v84, v84, vcc wave_shr:1 row_mask:0xf bank_mask:0xf
    v_cndmask_b32_dpp v85, v85, v85, vcc wave_shr:1 row_mask:0xf bank_mask:0xf
    s_lshr_b64 s[52:53], s[52:53], 1
    v_cndmask_b32_dpp v86, v86, v86, vcc wave_shr:1 row_mask:0xf bank_mask:0xf
    v_cndmask_b32_dpp v87, v87, v87, vcc wave_shr:1 row_mask:0xf bank_mask:0xf
    s_andn2_b64 s[82:83], s[82:83], s[52:53]
    v_cndmask_b32_dpp v7, v7, v7, vcc wave_shr:1 row_mask:0xf bank_mask:0xf
    s_mov_b64 exec, s[54:55]
    s_cbranch_scc0 L2_d57
    s_mov_b64 exec, s[82:83]
    s_nop 1
    v_mfma_f32_4x4x4_16b_bf16 v[88:91], v[12:13], v[84:85], 0
    s_nop 1
    v_mfma_f32_4x4x4_16b_bf16 v[88:91], v[10:11], v[86:87], v[88:91]
    s_nop 4
    v_cvt_pk_bf16_f32 v88, v88, v89
    v_cvt_pk_bf16_f32 v89, v90, v91
    ds_pk_add_bf16 v7, v88 offset:65408
    ds_pk_add_bf16 v7, v89 offset:65412
    s_mov_b64 exec, s[54:55]
    s_branch L2_d57
L2_c58:
    s_lshl_b64 s[52:53], s[82:83], 1
    s_andn2_b64 s[52:53], s[52:53], s[80:81]
    s_andn2_b64 s[52:53], s[52:53], s[50:51]
    s_or_b64 s[80:81], s[80:81], s[52:53]
    s_not_b64 vcc, s[52:53]
    s_mov_b64 exec, -1
    v_cndmask_b32_dpp v84, v84, v84, vcc wave_shr:1 row_mask:0xf bank_mask:0xf
    v_cndmask_b32_dpp v85, v85, v85, vcc wave_shr:1 row_mask:0xf bank_mask:0xf
    s_lshr_b64 s[52:53], s[52:53], 1
    v_cndmask_b32_dpp v86, v86, v86, vcc wave_shr:1 row_mask:0xf bank_mask:0xf
    v_cndmask_b32_dpp v87, v87, v87, vcc wave_shr:1 row_mask:0xf bank_mask:0xf
    s_andn2_b64 s[82:83], s[82:83], s[52:53]
    v_cndmask_b32_dpp v7, v7, v7, vcc wave_shr:1 row_mask:0xf bank_mask:0xf
    s_mov_b64 exec, s[50:51]
    s_cbranch_scc0 L2_d58
    s_mov_b64 exec, s[82:83]
    s_nop 1
    v_mfma_f32_4x4x4_16b_bf16 v[88:91], v[12:13], v[84:85], 0
    s_nop 1
    v_mfma_f32_4x4x4_16b_bf16 v[88:91], v[10:11], v[86:87], v[88:91]
    s_nop 4
    v_cvt_pk_bf16_f32 v88, v88, v89
    v_cvt_pk_bf16_f32 v89, v90, v91
    ds_pk_add_bf16 v7, v88 offset:65408
    ds_pk_add_bf16 v7, v89 offset:65412
    s_mov_b64 exec, s[50:51]
    s_branch L2_d58
L2_c59:
    s_lshl_b64 s[52:53], s[82:83], 1
    s_andn2_b64 s[52:53], s[52:53], s[80:81]
    s_andn2_b64 s[52:53], s[52:53], s[54:55]
    s_or_b64 s[80:81], s[80:81], s[52:53]
    s_not_b64 vcc, s[52:53]
    s_mov_b64 exec, -1
    v_cndmask_b32_dpp v84, v84, v84, vcc wave_shr:1 row_mask:0xf bank_mask:0xf
    v_cndmask_b32_dpp v85, v85, v85, vcc wave_shr:1 row_mask:0xf bank_mask:0xf
    s_lshr_b64 s[52:53], s[52:53], 1
    v_cndmask_b32_dpp v86, v86, v86, vcc wave_shr:1 row_mask:0xf bank_mask:0xf
    v_cndmask_b32_dpp v87, v87, v87, vcc wave_shr:1 row_mask:0xf bank_mask:0xf
    s_andn2_b64 s[82:83], s[82:83], s[52:53]
    v_cndmask_b32_dpp v7, v7, v7, vcc wave_shr:1 row_mask:0xf bank_mask:0xf
    s_mov_b64 exec, s[54:55]
    s_cbranch_scc0 L2_d59
    s_mov_b64 exec, s[82:83]
    s_nop 1
    v_mfma_f32_4x4x4_16b_bf16 v[88:91], v[12:13], v[84:85], 0
    s_nop 1
    v_mfma_f32_4x4x4_16b_bf16 v[88:91], v[10:11], v[86:87], v[88:91]
    s_nop 4
    v_cvt_pk_bf16_f32 v88, v88, v89
    v_cvt_pk_bf16_f32 v89, v90, v91
    ds_pk_add_bf16 v7, v88 offset:65408
    ds_pk_add_bf16 v7, v89 offset:65412
    s_mov_b64 exec, s[54:55]
    s_branch L2_d59
L2_c60:
    s_lshl_b64 s[52:53], s[82:83], 1
    s_andn2_b64 s[52:53], s[52:53], s[80:81]
    s_andn2_b64 s[52:53], s[52:53], s[50:51]
    s_or_b64 s[80:81], s[80:81], s[52:53]
    s_not_b64 vcc, s[52:53]
    s_mov_b64 exec, -1
    v_cndmask_b32_dpp v84, v84, v84, vcc wave_shr:1 row_mask:0xf bank_mask:0xf
    v_cndmask_b32_dpp v85, v85, v85, vcc wave_shr:1 row_mask:0xf bank_mask:0xf
    s_lshr_b64 s[52:53], s[52:53], 1
    v_cndmask_b32_dpp v86, v86, v86, vcc wave_shr:1 row_mask:0xf bank_mask:0xf
    v_cndmask_b32_dpp v87, v87, v87, vcc wave_shr:1 row_mask:0xf bank_mask:0xf
    s_andn2_b64 s[82:83], s[82:83], s[52:53]
    v_cndmask_b32_dpp v7, v7, v7, vcc wave_shr:1 row_mask:0xf bank_mask:0xf
    s_mov_b64 exec, s[50:51]
    s_cbranch_scc0 L2_d60
    s_mov_b64 exec, s[82:83]
    s_nop 1
    v_mfma_f32_4x4x4_16b_bf16 v[88:91], v[12:13], v[84:85], 0
    s_nop 1
    v_mfma_f32_4x4x4_16b_bf16 v[88:91], v[10:11], v[86:87], v[88:91]
    s_nop 4
    v_cvt_pk_bf16_f32 v88, v88, v89
    v_cvt_pk_bf16_f32 v89, v90, v91
    ds_pk_add_bf16 v7, v88 offset:65408
    ds_pk_add_bf16 v7, v89 offset:65412
    s_mov_b64 exec, s[50:51]
    s_branch L2_d60
L2_xa61:
    s_cmp_eq_u32 s101, 1
    s_cbranch_scc1 L2_xc61
    v_lshlrev_b32 v89, 0, v96
    v_add_u32 v90, 140, v97
    v_bitop3_b32 v90, v89, v45, v90 bitop3:0x6a
    ds_write_b32 v98, v90 offset:28
    v_lshlrev_b32 v89, 4, v96
    v_add_u32 v90, 120, v97
    v_bitop3_b32 v90, v89, v45, v90 bitop3:0x6a
    ds_write_b32 v98, v90 offset:24
    v_lshlrev_b32 v89, 8, v96
    v_add_u32 v90, 100, v97
    v_bitop3_b32 v90, v89, v45, v90 bitop3:0x6a
    ds_write_b32 v98, v90 offset:20
L2_xc61:
    v_lshlrev_b32 v89, 12, v96
    v_add_u32 v90, 80, v97
    v_bitop3_b32 v90, v89, v45, v90 bitop3:0x6a
    ds_write_b32 v98, v90 offset:16
    s_branch L2_xb61
L2_xe61:
    v_cmp_lt_u32 vcc, 32, v99
    v_cmp_lt_u32 s[58:59], 31, v88
    v_lshrrev_b32 v89, 16, v96
    v_add_u32 v97, 80, v97
    s_or_b64 vcc, vcc, s[58:59]
    s_cbranch_scc1 L2_xs61
    v_lshlrev_b32 v89, v1, v89
    v_and_b32 v89, v45, v89
    v_cmp_ne_u32 vcc, 0, v89
    v_xor_b32 v90, v97, v89
    s_add_u32 s3, s37, s38
    v_mbcnt_lo_u32_b32 v98, vcc_lo, 0
    v_mbcnt_hi_u32_b32 v98, vcc_hi, v98
    s_bcnt1_i32_b64 s41, vcc
    v_lshl_add_u32 v98, v98, 2, s3
    s_lshl2_add_u32 s37, s41, s37
    s_mov_b64 exec, vcc
    ds_write_b32 v98, v90
    s_mov_b64 exec, -1
    s_branch L2_xr61
L2_xs61:
    s_waitcnt lgkmcnt(0)
    s_mov_b32 s37, 0x10000
    s_branch L2_xw61
L2_c62:
    s_lshl_b64 s[52:53], s[82:83], 1
    s_andn2_b64 s[52:53], s[52:53], s[80:81]
    s_andn2_b64 s[52:53], s[52:53], s[54:55]
    s_or_b64 s[80:81], s[80:81], s[52:53]
    s_not_b64 vcc, s[52:53]
    s_mov_b64 exec, -1
    v_cndmask_b32_dpp v84, v84, v84, vcc wave_shr:1 row_mask:0xf bank_mask:0xf
    v_cndmask_b32_dpp v85, v85, v85, vcc wave_shr:1 row_mask:0xf bank_mask:0xf
    s_lshr_b64 s[52:53], s[52:53], 1
    v_cndmask_b32_dpp v86, v86, v86, vcc wave_shr:1 row_mask:0xf bank_mask:0xf
    v_cndmask_b32_dpp v87, v87, v87, vcc wave_shr:1 row_mask:0xf bank_mask:0xf
    s_andn2_b64 s[82:83], s[82:83], s[52:53]
    v_cndmask_b32_dpp v7, v7, v7, vcc wave_shr:1 row_mask:0xf bank_mask:0xf
    s_mov_b64 exec, s[54:55]
    s_cbranch_scc0 L2_d62
    s_mov_b64 exec, s[82:83]
    s_nop 1
    v_mfma_f32_4x4x4_16b_bf16 v[88:91], v[12:13], v[84:85], 0
    s_nop 1
    v_mfma_f32_4x4x4_16b_bf16 v[88:91], v[10:11], v[86:87], v[88:91]
    s_nop 4
    v_cvt_pk_bf16_f32 v88, v88, v89
    v_cvt_pk_bf16_f32 v89, v90, v91
    ds_pk_add_bf16 v7, v88 offset:65408
    ds_pk_add_bf16 v7, v89 offset:65412
    s_mov_b64 exec, s[54:55]
    s_branch L2_d62
L2_c63:
    s_lshl_b64 s[52:53], s[82:83], 1
    s_andn2_b64 s[52:53], s[52:53], s[80:81]
    s_andn2_b64 s[52:53], s[52:53], s[50:51]
    s_or_b64 s[80:81], s[80:81], s[52:53]
    s_not_b64 vcc, s[52:53]
    s_mov_b64 exec, -1
    v_cndmask_b32_dpp v84, v84, v84, vcc wave_shr:1 row_mask:0xf bank_mask:0xf
    v_cndmask_b32_dpp v85, v85, v85, vcc wave_shr:1 row_mask:0xf bank_mask:0xf
    s_lshr_b64 s[52:53], s[52:53], 1
    v_cndmask_b32_dpp v86, v86, v86, vcc wave_shr:1 row_mask:0xf bank_mask:0xf
    v_cndmask_b32_dpp v87, v87, v87, vcc wave_shr:1 row_mask:0xf bank_mask:0xf
    s_andn2_b64 s[82:83], s[82:83], s[52:53]
    v_cndmask_b32_dpp v7, v7, v7, vcc wave_shr:1 row_mask:0xf bank_mask:0xf
    s_mov_b64 exec, s[50:51]
    s_cbranch_scc0 L2_d63
    s_mov_b64 exec, s[82:83]
    s_nop 1
    v_mfma_f32_4x4x4_16b_bf16 v[88:91], v[12:13], v[84:85], 0
    s_nop 1
    v_mfma_f32_4x4x4_16b_bf16 v[88:91], v[10:11], v[86:87], v[88:91]
    s_nop 4
    v_cvt_pk_bf16_f32 v88, v88, v89
    v_cvt_pk_bf16_f32 v89, v90, v91
    ds_pk_add_bf16 v7, v88 offset:65408
    ds_pk_add_bf16 v7, v89 offset:65412
    s_mov_b64 exec, s[50:51]
    s_branch L2_d63
L2_xf61:
    s_cmp_gt_u32 s37, 1024
    s_cbranch_scc1 L2_xt61
    s_cmp_lt_u32 s37, 768
    s_cbranch_scc1 L2_xl61
    ds_read_b32 v32, v44 offset:896
    s_add_u32 s3, s42, 2
    s_bitset1_b32 s43, s3
    s_branch L2_xg61
L2_xl61:
    s_waitcnt lgkmcnt(0)
    v_mov_b32 v31, -1
    s_cmp_ge_u32 s37, 512
    s_cbranch_scc1 L2_xg61
    v_mov_b32 v39, -1
    s_cmp_ge_u32 s37, 256
    s_cbranch_scc1 L2_xg61
    v_mov_b32 v27, -1
    s_branch L2_xg61
L2_xt61:
    s_waitcnt lgkmcnt(0)
    v_mov_b32 v21, -1
    v_mov_b32 v27, -1
    v_mov_b32 v39, -1
    v_mov_b32 v31, -1
    s_add_u32 s3, s42, 2
    s_bitset1_b32 s36, s3
    s_branch L2_xg61
L2_oa64:
    v_and_b32 v47, 0x0fffffff, v33
    buffer_load_dword v114, v47, s[8:11], 0 offen offset:16
    s_mov_b64 exec, s[6:7]
    v_add_u32 v47, 8, v47
    v_lshrrev_b32 v33, 2, v33
    s_mov_b64 exec, -1
    buffer_load_dwordx2 v[112:113], v47, s[8:11], 0 offen
    s_branch L2_ob64
L2_c65:
    s_lshl_b64 s[52:53], s[82:83], 1
    s_andn2_b64 s[52:53], s[52:53], s[80:81]
    s_andn2_b64 s[52:53], s[52:53], s[54:55]
    s_or_b64 s[80:81], s[80:81], s[52:53]
    s_not_b64 vcc, s[52:53]
    s_mov_b64 exec, -1
    v_cndmask_b32_dpp v84, v84, v84, vcc wave_shr:1 row_mask:0xf bank_mask:0xf
    v_cndmask_b32_dpp v85, v85, v85, vcc wave_shr:1 row_mask:0xf bank_mask:0xf
    s_lshr_b64 s[52:53], s[52:53], 1
    v_cndmask_b32_dpp v86, v86, v86, vcc wave_shr:1 row_mask:0xf bank_mask:0xf
    v_cndmask_b32_dpp v87, v87, v87, vcc wave_shr:1 row_mask:0xf bank_mask:0xf
    s_andn2_b64 s[82:83], s[82:83], s[52:53]
    v_cndmask_b32_dpp v7, v7, v7, vcc wave_shr:1 row_mask:0xf bank_mask:0xf
    s_mov_b64 exec, s[54:55]
    s_cbranch_scc0 L2_d65
    s_mov_b64 exec, s[82:83]
    s_nop 1
    v_mfma_f32_4x4x4_16b_bf16 v[88:91], v[12:13], v[84:85], 0
    s_nop 1
    v_mfma_f32_4x4x4_16b_bf16 v[88:91], v[10:11], v[86:87], v[88:91]
    s_nop 4
    v_cvt_pk_bf16_f32 v88, v88, v89
    v_cvt_pk_bf16_f32 v89, v90, v91
    ds_pk_add_bf16 v7, v88 offset:65408
    ds_pk_add_bf16 v7, v89 offset:65412
    s_mov_b64 exec, s[54:55]
    s_branch L2_d65
L2_c66:
    s_lshl_b64 s[52:53], s[82:83], 1
    s_andn2_b64 s[52:53], s[52:53], s[80:81]
    s_andn2_b64 s[52:53], s[52:53], s[50:51]
    s_or_b64 s[80:81], s[80:81], s[52:53]
    s_not_b64 vcc, s[52:53]
    s_mov_b64 exec, -1
    v_cndmask_b32_dpp v84, v84, v84, vcc wave_shr:1 row_mask:0xf bank_mask:0xf
    v_cndmask_b32_dpp v85, v85, v85, vcc wave_shr:1 row_mask:0xf bank_mask:0xf
    s_lshr_b64 s[52:53], s[52:53], 1
    v_cndmask_b32_dpp v86, v86, v86, vcc wave_shr:1 row_mask:0xf bank_mask:0xf
    v_cndmask_b32_dpp v87, v87, v87, vcc wave_shr:1 row_mask:0xf bank_mask:0xf
    s_andn2_b64 s[82:83], s[82:83], s[52:53]
    v_cndmask_b32_dpp v7, v7, v7, vcc wave_shr:1 row_mask:0xf bank_mask:0xf
    s_mov_b64 exec, s[50:51]
    s_cbranch_scc0 L2_d66
    s_mov_b64 exec, s[82:83]
    s_nop 1
    v_mfma_f32_4x4x4_16b_bf16 v[88:91], v[12:13], v[84:85], 0
    s_nop 1
    v_mfma_f32_4x4x4_16b_bf16 v[88:91], v[10:11], v[86:87], v[88:91]
    s_nop 4
    v_cvt_pk_bf16_f32 v88, v88, v89
    v_cvt_pk_bf16_f32 v89, v90, v91
    ds_pk_add_bf16 v7, v88 offset:65408
    ds_pk_add_bf16 v7, v89 offset:65412
    s_mov_b64 exec, s[50:51]
    s_branch L2_d66
L2_c67:
    s_lshl_b64 s[52:53], s[82:83], 1
    s_andn2_b64 s[52:53], s[52:53], s[80:81]
    s_andn2_b64 s[52:53], s[52:53], s[54:55]
    s_or_b64 s[80:81], s[80:81], s[52:53]
    s_not_b64 vcc, s[52:53]
    s_mov_b64 exec, -1
    v_cndmask_b32_dpp v84, v84, v84, vcc wave_shr:1 row_mask:0xf bank_mask:0xf
    v_cndmask_b32_dpp v85, v85, v85, vcc wave_shr:1 row_mask:0xf bank_mask:0xf
    s_lshr_b64 s[52:53], s[52:53], 1
    v_cndmask_b32_dpp v86, v86, v86, vcc wave_shr:1 row_mask:0xf bank_mask:0xf
    v_cndmask_b32_dpp v87, v87, v87, vcc wave_shr:1 row_mask:0xf bank_mask:0xf
    s_andn2_b64 s[82:83], s[82:83], s[52:53]
    v_cndmask_b32_dpp v7, v7, v7, vcc wave_shr:1 row_mask:0xf bank_mask:0xf
    s_mov_b64 exec, s[54:55]
    s_cbranch_scc0 L2_d67
    s_mov_b64 exec, s[82:83]
    s_nop 1
    v_mfma_f32_4x4x4_16b_bf16 v[88:91], v[12:13], v[84:85], 0
    s_nop 1
    v_mfma_f32_4x4x4_16b_bf16 v[88:91], v[10:11], v[86:87], v[88:91]
    s_nop 4
    v_cvt_pk_bf16_f32 v88, v88, v89
    v_cvt_pk_bf16_f32 v89, v90, v91
    ds_pk_add_bf16 v7, v88 offset:65408
    ds_pk_add_bf16 v7, v89 offset:65412
    s_mov_b64 exec, s[54:55]
    s_branch L2_d67
L2_c68:
    s_lshl_b64 s[52:53], s[82:83], 1
    s_andn2_b64 s[52:53], s[52:53], s[80:81]
    s_andn2_b64 s[52:53], s[52:53], s[50:51]
    s_or_b64 s[80:81], s[80:81], s[52:53]
    s_not_b64 vcc, s[52:53]
    s_mov_b64 exec, -1
    v_cndmask_b32_dpp v84, v84, v84, vcc wave_shr:1 row_mask:0xf bank_mask:0xf
    v_cndmask_b32_dpp v85, v85, v85, vcc wave_shr:1 row_mask:0xf bank_mask:0xf
    s_lshr_b64 s[52:53], s[52:53], 1
    v_cndmask_b32_dpp v86, v86, v86, vcc wave_shr:1 row_mask:0xf bank_mask:0xf
    v_cndmask_b32_dpp v87, v87, v87, vcc wave_shr:1 row_mask:0xf bank_mask:0xf
    s_andn2_b64 s[82:83], s[82:83], s[52:53]
    v_cndmask_b32_dpp v7, v7, v7, vcc wave_shr:1 row_mask:0xf bank_mask:0xf
    s_mov_b64 exec, s[50:51]
    s_cbranch_scc0 L2_d68
    s_mov_b64 exec, s[82:83]
    s_nop 1
    v_mfma_f32_4x4x4_16b_bf16 v[88:91], v[12:13], v[84:85], 0
    s_nop 1
    v_mfma_f32_4x4x4_16b_bf16 v[88:91], v[10:11], v[86:87], v[88:91]
    s_nop 4
    v_cvt_pk_bf16_f32 v88, v88, v89
    v_cvt_pk_bf16_f32 v89, v90, v91
    ds_pk_add_bf16 v7, v88 offset:65408
    ds_pk_add_bf16 v7, v89 offset:65412
    s_mov_b64 exec, s[50:51]
    s_branch L2_d68
L2_c69:
    s_lshl_b64 s[52:53], s[82:83], 1
    s_andn2_b64 s[52:53], s[52:53], s[80:81]
    s_andn2_b64 s[52:53], s[52:53], s[54:55]
    s_or_b64 s[80:81], s[80:81], s[52:53]
    s_not_b64 vcc, s[52:53]
    s_mov_b64 exec, -1
    v_cndmask_b32_dpp v84, v84, v84, vcc wave_shr:1 row_mask:0xf bank_mask:0xf
    v_cndmask_b32_dpp v85, v85, v85, vcc wave_shr:1 row_mask:0xf bank_mask:0xf
    s_lshr_b64 s[52:53], s[52:53], 1
    v_cndmask_b32_dpp v86, v86, v86, vcc wave_shr:1 row_mask:0xf bank_mask:0xf
    v_cndmask_b32_dpp v87, v87, v87, vcc wave_shr:1 row_mask:0xf bank_mask:0xf
    s_andn2_b64 s[82:83], s[82:83], s[52:53]
    v_cndmask_b32_dpp v7, v7, v7, vcc wave_shr:1 row_mask:0xf bank_mask:0xf
    s_mov_b64 exec, s[54:55]
    s_cbranch_scc0 L2_d69
    s_mov_b64 exec, s[82:83]
    s_nop 1
    v_mfma_f32_4x4x4_16b_bf16 v[88:91], v[12:13], v[84:85], 0
    s_nop 1
    v_mfma_f32_4x4x4_16b_bf16 v[88:91], v[10:11], v[86:87], v[88:91]
    s_nop 4
    v_cvt_pk_bf16_f32 v88, v88, v89
    v_cvt_pk_bf16_f32 v89, v90, v91
    ds_pk_add_bf16 v7, v88 offset:65408
    ds_pk_add_bf16 v7, v89 offset:65412
    s_mov_b64 exec, s[54:55]
    s_branch L2_d69
L2_c70:
    s_lshl_b64 s[52:53], s[82:83], 1
    s_andn2_b64 s[52:53], s[52:53], s[80:81]
    s_andn2_b64 s[52:53], s[52:53], s[50:51]
    s_or_b64 s[80:81], s[80:81], s[52:53]
    s_not_b64 vcc, s[52:53]
    s_mov_b64 exec, -1
    v_cndmask_b32_dpp v84, v84, v84, vcc wave_shr:1 row_mask:0xf bank_mask:0xf
    v_cndmask_b32_dpp v85, v85, v85, vcc wave_shr:1 row_mask:0xf bank_mask:0xf
    s_lshr_b64 s[52:53], s[52:53], 1
    v_cndmask_b32_dpp v86, v86, v86, vcc wave_shr:1 row_mask:0xf bank_mask:0xf
    v_cndmask_b32_dpp v87, v87, v87, vcc wave_shr:1 row_mask:0xf bank_mask:0xf
    s_andn2_b64 s[82:83], s[82:83], s[52:53]
    v_cndmask_b32_dpp v7, v7, v7, vcc wave_shr:1 row_mask:0xf bank_mask:0xf
    s_mov_b64 exec, s[50:51]
    s_cbranch_scc0 L2_d70
    s_mov_b64 exec, s[82:83]
    s_nop 1
    v_mfma_f32_4x4x4_16b_bf16 v[88:91], v[12:13], v[84:85], 0
    s_nop 1
    v_mfma_f32_4x4x4_16b_bf16 v[88:91], v[10:11], v[86:87], v[88:91]
    s_nop 4
    v_cvt_pk_bf16_f32 v88, v88, v89
    v_cvt_pk_bf16_f32 v89, v90, v91
    ds_pk_add_bf16 v7, v88 offset:65408
    ds_pk_add_bf16 v7, v89 offset:65412
    s_mov_b64 exec, s[50:51]
    s_branch L2_d70
L2_oa71:
    s_waitcnt vmcnt(3)
    s_mov_b64 exec, s[6:7]
    v_lshrrev_b32 v114, 16, v114
    s_mov_b64 exec, -1
    v_and_b32 v46, 0x10000000, v33
    v_cmpx_eq_u32 vcc, 0, v46
    v_lshrrev_b32 v47, 14, v112
    v_and_b32 v47, v5, v47
    ds_read_b64 v[96:97], v47
    v_perm_b32 v98, v112, v114, s44
    v_bitop3_b32 v99, v112, 0.5, -0.5 bitop3:0xa8
    v_bitop3_b32 v98, v6, v98, v99 bitop3:0xca
    v_and_b32 v47, v5, v112
    s_waitcnt lgkmcnt(0)
    v_mfma_f32_4x4x4_16b_bf16 v[88:91], v[8:9], v[96:97], 0
    s_nop 4
    v_mul_f32 v88, v98, v88
    v_mul_f32 v89, v98, v89
    v_mul_f32 v90, v98, v90
    v_mul_f32 v91, v98, v91
    v_cvt_pk_bf16_f32 v88, v88, v89
    v_cvt_pk_bf16_f32 v89, v90, v91
    ds_pk_add_bf16 v47, v88 offset:65408
    ds_pk_add_bf16 v47, v89 offset:65412
    s_mov_b64 exec, -1
    v_and_b32 v46, 0x20000000, v33
    v_cmpx_eq_u32 vcc, 0, v46
    v_lshrrev_b32 v47, 14, v113
    v_and_b32 v47, v5, v47
    ds_read_b64 v[96:97], v47
    v_perm_b32 v98, v113, v114, s45
    v_bitop3_b32 v99, v113, 0.5, -0.5 bitop3:0xa8
    v_bitop3_b32 v98, v6, v98, v99 bitop3:0xca
    v_and_b32 v47, v5, v113
    s_waitcnt lgkmcnt(0)
    v_mfma_f32_4x4x4_16b_bf16 v[88:91], v[8:9], v[96:97], 0
    s_nop 4
    v_mul_f32 v88, v98, v88
    v_mul_f32 v89, v98, v89
    v_mul_f32 v90, v98, v90
    v_mul_f32 v91, v98, v91
    v_cvt_pk_bf16_f32 v88, v88, v89
    v_cvt_pk_bf16_f32 v89, v90, v91
    ds_pk_add_bf16 v47, v88 offset:65408
    ds_pk_add_bf16 v47, v89 offset:65412
    s_mov_b64 exec, -1
    s_branch L2_ob71
L2_xo72:
    v_cmp_lt_u32 vcc, 20, v99
    s_mov_b32 s101, 1
    s_cbranch_vccz L2_xp72
    v_cmp_lt_u32 vcc, 32, v99
    v_cmp_lt_u32 s[58:59], 31, v88
    s_mov_b32 s101, 2
    s_or_b64 vcc, vcc, s[58:59]
    s_cbranch_scc0 L2_xp72
    s_mov_b32 s37, 0x10000
    s_branch L2_xp72
L2_c73:
    s_lshl_b64 s[52:53], s[82:83], 1
    s_andn2_b64 s[52:53], s[52:53], s[80:81]
    s_andn2_b64 s[52:53], s[52:53], s[54:55]
    s_or_b64 s[80:81], s[80:81], s[52:53]
    s_not_b64 vcc, s[52:53]
    s_mov_b64 exec, -1
    v_cndmask_b32_dpp v84, v84, v84, vcc wave_shr:1 row_mask:0xf bank_mask:0xf
    v_cndmask_b32_dpp v85, v85, v85, vcc wave_shr:1 row_mask:0xf bank_mask:0xf
    s_lshr_b64 s[52:53], s[52:53], 1
    v_cndmask_b32_dpp v86, v86, v86, vcc wave_shr:1 row_mask:0xf bank_mask:0xf
    v_cndmask_b32_dpp v87, v87, v87, vcc wave_shr:1 row_mask:0xf bank_mask:0xf
    s_andn2_b64 s[82:83], s[82:83], s[52:53]
    v_cndmask_b32_dpp v7, v7, v7, vcc wave_shr:1 row_mask:0xf bank_mask:0xf
    s_mov_b64 exec, s[54:55]
    s_cbranch_scc0 L2_d73
    s_mov_b64 exec, s[82:83]
    s_nop 1
    v_mfma_f32_4x4x4_16b_bf16 v[88:91], v[12:13], v[84:85], 0
    s_nop 1
    v_mfma_f32_4x4x4_16b_bf16 v[88:91], v[10:11], v[86:87], v[88:91]
    s_nop 4
    v_cvt_pk_bf16_f32 v88, v88, v89
    v_cvt_pk_bf16_f32 v89, v90, v91
    ds_pk_add_bf16 v7, v88 offset:65408
    ds_pk_add_bf16 v7, v89 offset:65412
    s_mov_b64 exec, s[54:55]
    s_branch L2_d73
L2_c74:
    s_lshl_b64 s[52:53], s[82:83], 1
    s_andn2_b64 s[52:53], s[52:53], s[80:81]
    s_andn2_b64 s[52:53], s[52:53], s[50:51]
    s_or_b64 s[80:81], s[80:81], s[52:53]
    s_not_b64 vcc, s[52:53]
    s_mov_b64 exec, -1
    v_cndmask_b32_dpp v84, v84, v84, vcc wave_shr:1 row_mask:0xf bank_mask:0xf
    v_cndmask_b32_dpp v85, v85, v85, vcc wave_shr:1 row_mask:0xf bank_mask:0xf
    s_lshr_b64 s[52:53], s[52:53], 1
    v_cndmask_b32_dpp v86, v86, v86, vcc wave_shr:1 row_mask:0xf bank_mask:0xf
    v_cndmask_b32_dpp v87, v87, v87, vcc wave_shr:1 row_mask:0xf bank_mask:0xf
    s_andn2_b64 s[82:83], s[82:83], s[52:53]
    v_cndmask_b32_dpp v7, v7, v7, vcc wave_shr:1 row_mask:0xf bank_mask:0xf
    s_mov_b64 exec, s[50:51]
    s_cbranch_scc0 L2_d74
    s_mov_b64 exec, s[82:83]
    s_nop 1
    v_mfma_f32_4x4x4_16b_bf16 v[88:91], v[12:13], v[84:85], 0
    s_nop 1
    v_mfma_f32_4x4x4_16b_bf16 v[88:91], v[10:11], v[86:87], v[88:91]
    s_nop 4
    v_cvt_pk_bf16_f32 v88, v88, v89
    v_cvt_pk_bf16_f32 v89, v90, v91
    ds_pk_add_bf16 v7, v88 offset:65408
    ds_pk_add_bf16 v7, v89 offset:65412
    s_mov_b64 exec, s[50:51]
    s_branch L2_d74
L2_c75:
    s_lshl_b64 s[52:53], s[82:83], 1
    s_andn2_b64 s[52:53], s[52:53], s[80:81]
    s_andn2_b64 s[52:53], s[52:53], s[54:55]
    s_or_b64 s[80:81], s[80:81], s[52:53]
    s_not_b64 vcc, s[52:53]
    s_mov_b64 exec, -1
    v_cndmask_b32_dpp v84, v84, v84, vcc wave_shr:1 row_mask:0xf bank_mask:0xf
    v_cndmask_b32_dpp v85, v85, v85, vcc wave_shr:1 row_mask:0xf bank_mask:0xf
    s_lshr_b64 s[52:53], s[52:53], 1
    v_cndmask_b32_dpp v86, v86, v86, vcc wave_shr:1 row_mask:0xf bank_mask:0xf
    v_cndmask_b32_dpp v87, v87, v87, vcc wave_shr:1 row_mask:0xf bank_mask:0xf
    s_andn2_b64 s[82:83], s[82:83], s[52:53]
    v_cndmask_b32_dpp v7, v7, v7, vcc wave_shr:1 row_mask:0xf bank_mask:0xf
    s_mov_b64 exec, s[54:55]
    s_cbranch_scc0 L2_d75
    s_mov_b64 exec, s[82:83]
    s_nop 1
    v_mfma_f32_4x4x4_16b_bf16 v[88:91], v[12:13], v[84:85], 0
    s_nop 1
    v_mfma_f32_4x4x4_16b_bf16 v[88:91], v[10:11], v[86:87], v[88:91]
    s_nop 4
    v_cvt_pk_bf16_f32 v88, v88, v89
    v_cvt_pk_bf16_f32 v89, v90, v91
    ds_pk_add_bf16 v7, v88 offset:65408
    ds_pk_add_bf16 v7, v89 offset:65412
    s_mov_b64 exec, s[54:55]
    s_branch L2_d75
L2_c76:
    s_lshl_b64 s[52:53], s[82:83], 1
    s_andn2_b64 s[52:53], s[52:53], s[80:81]
    s_andn2_b64 s[52:53], s[52:53], s[50:51]
    s_or_b64 s[80:81], s[80:81], s[52:53]
    s_not_b64 vcc, s[52:53]
    s_mov_b64 exec, -1
    v_cndmask_b32_dpp v84, v84, v84, vcc wave_shr:1 row_mask:0xf bank_mask:0xf
    v_cndmask_b32_dpp v85, v85, v85, vcc wave_shr:1 row_mask:0xf bank_mask:0xf
    s_lshr_b64 s[52:53], s[52:53], 1
    v_cndmask_b32_dpp v86, v86, v86, vcc wave_shr:1 row_mask:0xf bank_mask:0xf
    v_cndmask_b32_dpp v87, v87, v87, vcc wave_shr:1 row_mask:0xf bank_mask:0xf
    s_andn2_b64 s[82:83], s[82:83], s[52:53]
    v_cndmask_b32_dpp v7, v7, v7, vcc wave_shr:1 row_mask:0xf bank_mask:0xf
    s_mov_b64 exec, s[50:51]
    s_cbranch_scc0 L2_d76
    s_mov_b64 exec, s[82:83]
    s_nop 1
    v_mfma_f32_4x4x4_16b_bf16 v[88:91], v[12:13], v[84:85], 0
    s_nop 1
    v_mfma_f32_4x4x4_16b_bf16 v[88:91], v[10:11], v[86:87], v[88:91]
    s_nop 4
    v_cvt_pk_bf16_f32 v88, v88, v89
    v_cvt_pk_bf16_f32 v89, v90, v91
    ds_pk_add_bf16 v7, v88 offset:65408
    ds_pk_add_bf16 v7, v89 offset:65412
    s_mov_b64 exec, s[50:51]
    s_branch L2_d76
L2_c77:
    s_lshl_b64 s[52:53], s[82:83], 1
    s_andn2_b64 s[52:53], s[52:53], s[80:81]
    s_andn2_b64 s[52:53], s[52:53], s[54:55]
    s_or_b64 s[80:81], s[80:81], s[52:53]
    s_not_b64 vcc, s[52:53]
    s_mov_b64 exec, -1
    v_cndmask_b32_dpp v84, v84, v84, vcc wave_shr:1 row_mask:0xf bank_mask:0xf
    v_cndmask_b32_dpp v85, v85, v85, vcc wave_shr:1 row_mask:0xf bank_mask:0xf
    s_lshr_b64 s[52:53], s[52:53], 1
    v_cndmask_b32_dpp v86, v86, v86, vcc wave_shr:1 row_mask:0xf bank_mask:0xf
    v_cndmask_b32_dpp v87, v87, v87, vcc wave_shr:1 row_mask:0xf bank_mask:0xf
    s_andn2_b64 s[82:83], s[82:83], s[52:53]
    v_cndmask_b32_dpp v7, v7, v7, vcc wave_shr:1 row_mask:0xf bank_mask:0xf
    s_mov_b64 exec, s[54:55]
    s_cbranch_scc0 L2_d77
    s_mov_b64 exec, s[82:83]
    s_nop 1
    v_mfma_f32_4x4x4_16b_bf16 v[88:91], v[12:13], v[84:85], 0
    s_nop 1
    v_mfma_f32_4x4x4_16b_bf16 v[88:91], v[10:11], v[86:87], v[88:91]
    s_nop 4
    v_cvt_pk_bf16_f32 v88, v88, v89
    v_cvt_pk_bf16_f32 v89, v90, v91
    ds_pk_add_bf16 v7, v88 offset:65408
    ds_pk_add_bf16 v7, v89 offset:65412
    s_mov_b64 exec, s[54:55]
    s_branch L2_d77
L2_c78:
    s_lshl_b64 s[52:53], s[82:83], 1
    s_andn2_b64 s[52:53], s[52:53], s[80:81]
    s_andn2_b64 s[52:53], s[52:53], s[50:51]
    s_or_b64 s[80:81], s[80:81], s[52:53]
    s_not_b64 vcc, s[52:53]
    s_mov_b64 exec, -1
    v_cndmask_b32_dpp v84, v84, v84, vcc wave_shr:1 row_mask:0xf bank_mask:0xf
    v_cndmask_b32_dpp v85, v85, v85, vcc wave_shr:1 row_mask:0xf bank_mask:0xf
    s_lshr_b64 s[52:53], s[52:53], 1
    v_cndmask_b32_dpp v86, v86, v86, vcc wave_shr:1 row_mask:0xf bank_mask:0xf
    v_cndmask_b32_dpp v87, v87, v87, vcc wave_shr:1 row_mask:0xf bank_mask:0xf
    s_andn2_b64 s[82:83], s[82:83], s[52:53]
    v_cndmask_b32_dpp v7, v7, v7, vcc wave_shr:1 row_mask:0xf bank_mask:0xf
    s_mov_b64 exec, s[50:51]
    s_cbranch_scc0 L2_d78
    s_mov_b64 exec, s[82:83]
    s_nop 1
    v_mfma_f32_4x4x4_16b_bf16 v[88:91], v[12:13], v[84:85], 0
    s_nop 1
    v_mfma_f32_4x4x4_16b_bf16 v[88:91], v[10:11], v[86:87], v[88:91]
    s_nop 4
    v_cvt_pk_bf16_f32 v88, v88, v89
    v_cvt_pk_bf16_f32 v89, v90, v91
    ds_pk_add_bf16 v7, v88 offset:65408
    ds_pk_add_bf16 v7, v89 offset:65412
    s_mov_b64 exec, s[50:51]
    s_branch L2_d78
L2_xa79:
    s_cmp_eq_u32 s101, 1
    s_cbranch_scc1 L2_xc79
    v_lshlrev_b32 v89, 0, v96
    v_add_u32 v90, 140, v97
    v_bitop3_b32 v90, v89, v45, v90 bitop3:0x6a
    ds_write_b32 v98, v90 offset:28
    v_lshlrev_b32 v89, 4, v96
    v_add_u32 v90, 120, v97
    v_bitop3_b32 v90, v89, v45, v90 bitop3:0x6a
    ds_write_b32 v98, v90 offset:24
    v_lshlrev_b32 v89, 8, v96
    v_add_u32 v90, 100, v97
    v_bitop3_b32 v90, v89, v45, v90 bitop3:0x6a
    ds_write_b32 v98, v90 offset:20
L2_xc79:
    v_lshlrev_b32 v89, 12, v96
    v_add_u32 v90, 80, v97
    v_bitop3_b32 v90, v89, v45, v90 bitop3:0x6a
    ds_write_b32 v98, v90 offset:16
    s_branch L2_xb79
L2_xe79:
    v_cmp_lt_u32 vcc, 32, v99
    v_cmp_lt_u32 s[58:59], 31, v88
    v_lshrrev_b32 v89, 16, v96
    v_add_u32 v97, 80, v97
    s_or_b64 vcc, vcc, s[58:59]
    s_cbranch_scc1 L2_xs79
    v_lshlrev_b32 v89, v1, v89
    v_and_b32 v89, v45, v89
    v_cmp_ne_u32 vcc, 0, v89
    v_xor_b32 v90, v97, v89
    s_add_u32 s3, s37, s38
    v_mbcnt_lo_u32_b32 v98, vcc_lo, 0
    v_mbcnt_hi_u32_b32 v98, vcc_hi, v98
    s_bcnt1_i32_b64 s41, vcc
    v_lshl_add_u32 v98, v98, 2, s3
    s_lshl2_add_u32 s37, s41, s37
    s_mov_b64 exec, vcc
    ds_write_b32 v98, v90
    s_mov_b64 exec, -1
    s_branch L2_xr79
L2_xs79:
    s_waitcnt lgkmcnt(0)
    s_mov_b32 s37, 0x10000
    s_branch L2_xw79
L2_c80:
    s_lshl_b64 s[52:53], s[82:83], 1
    s_andn2_b64 s[52:53], s[52:53], s[80:81]
    s_andn2_b64 s[52:53], s[52:53], s[54:55]
    s_or_b64 s[80:81], s[80:81], s[52:53]
    s_not_b64 vcc, s[52:53]
    s_mov_b64 exec, -1
    v_cndmask_b32_dpp v84, v84, v84, vcc wave_shr:1 row_mask:0xf bank_mask:0xf
    v_cndmask_b32_dpp v85, v85, v85, vcc wave_shr:1 row_mask:0xf bank_mask:0xf
    s_lshr_b64 s[52:53], s[52:53], 1
    v_cndmask_b32_dpp v86, v86, v86, vcc wave_shr:1 row_mask:0xf bank_mask:0xf
    v_cndmask_b32_dpp v87, v87, v87, vcc wave_shr:1 row_mask:0xf bank_mask:0xf
    s_andn2_b64 s[82:83], s[82:83], s[52:53]
    v_cndmask_b32_dpp v7, v7, v7, vcc wave_shr:1 row_mask:0xf bank_mask:0xf
    s_mov_b64 exec, s[54:55]
    s_cbranch_scc0 L2_d80
    s_mov_b64 exec, s[82:83]
    s_nop 1
    v_mfma_f32_4x4x4_16b_bf16 v[88:91], v[12:13], v[84:85], 0
    s_nop 1
    v_mfma_f32_4x4x4_16b_bf16 v[88:91], v[10:11], v[86:87], v[88:91]
    s_nop 4
    v_cvt_pk_bf16_f32 v88, v88, v89
    v_cvt_pk_bf16_f32 v89, v90, v91
    ds_pk_add_bf16 v7, v88 offset:65408
    ds_pk_add_bf16 v7, v89 offset:65412
    s_mov_b64 exec, s[54:55]
    s_branch L2_d80
L2_c81:
    s_lshl_b64 s[52:53], s[82:83], 1
    s_andn2_b64 s[52:53], s[52:53], s[80:81]
    s_andn2_b64 s[52:53], s[52:53], s[50:51]
    s_or_b64 s[80:81], s[80:81], s[52:53]
    s_not_b64 vcc, s[52:53]
    s_mov_b64 exec, -1
    v_cndmask_b32_dpp v84, v84, v84, vcc wave_shr:1 row_mask:0xf bank_mask:0xf
    v_cndmask_b32_dpp v85, v85, v85, vcc wave_shr:1 row_mask:0xf bank_mask:0xf
    s_lshr_b64 s[52:53], s[52:53], 1
    v_cndmask_b32_dpp v86, v86, v86, vcc wave_shr:1 row_mask:0xf bank_mask:0xf
    v_cndmask_b32_dpp v87, v87, v87, vcc wave_shr:1 row_mask:0xf bank_mask:0xf
    s_andn2_b64 s[82:83], s[82:83], s[52:53]
    v_cndmask_b32_dpp v7, v7, v7, vcc wave_shr:1 row_mask:0xf bank_mask:0xf
    s_mov_b64 exec, s[50:51]
    s_cbranch_scc0 L2_d81
    s_mov_b64 exec, s[82:83]
    s_nop 1
    v_mfma_f32_4x4x4_16b_bf16 v[88:91], v[12:13], v[84:85], 0
    s_nop 1
    v_mfma_f32_4x4x4_16b_bf16 v[88:91], v[10:11], v[86:87], v[88:91]
    s_nop 4
    v_cvt_pk_bf16_f32 v88, v88, v89
    v_cvt_pk_bf16_f32 v89, v90, v91
    ds_pk_add_bf16 v7, v88 offset:65408
    ds_pk_add_bf16 v7, v89 offset:65412
    s_mov_b64 exec, s[50:51]
    s_branch L2_d81
L2_xf79:
    s_cmp_gt_u32 s37, 1024
    s_cbranch_scc1 L2_xt79
    s_cmp_lt_u32 s37, 768
    s_cbranch_scc1 L2_xl79
    ds_read_b32 v33, v44 offset:896
    s_add_u32 s3, s42, 2
    s_bitset1_b32 s43, s3
    s_branch L2_xg79
L2_xl79:
    s_waitcnt lgkmcnt(0)
    v_mov_b32 v42, -1
    s_cmp_ge_u32 s37, 512
    s_cbranch_scc1 L2_xg79
    v_mov_b32 v43, -1
    s_cmp_ge_u32 s37, 256
    s_cbranch_scc1 L2_xg79
    v_mov_b32 v41, -1
    s_branch L2_xg79
L2_xt79:
    s_waitcnt lgkmcnt(0)
    v_mov_b32 v40, -1
    v_mov_b32 v41, -1
    v_mov_b32 v43, -1
    v_mov_b32 v42, -1
    s_add_u32 s3, s42, 2
    s_bitset1_b32 s36, s3
    s_branch L2_xg79
L2_oa82:
    v_and_b32 v47, 0x0fffffff, v32
    buffer_load_dword v114, v47, s[8:11], 0 offen offset:16
    s_mov_b64 exec, s[6:7]
    v_add_u32 v47, 8, v47
    v_lshrrev_b32 v32, 2, v32
    s_mov_b64 exec, -1
    buffer_load_dwordx2 v[112:113], v47, s[8:11], 0 offen
    s_branch L2_ob82
L2_c83:
    s_lshl_b64 s[52:53], s[82:83], 1
    s_andn2_b64 s[52:53], s[52:53], s[80:81]
    s_andn2_b64 s[52:53], s[52:53], s[54:55]
    s_or_b64 s[80:81], s[80:81], s[52:53]
    s_not_b64 vcc, s[52:53]
    s_mov_b64 exec, -1
    v_cndmask_b32_dpp v84, v84, v84, vcc wave_shr:1 row_mask:0xf bank_mask:0xf
    v_cndmask_b32_dpp v85, v85, v85, vcc wave_shr:1 row_mask:0xf bank_mask:0xf
    s_lshr_b64 s[52:53], s[52:53], 1
    v_cndmask_b32_dpp v86, v86, v86, vcc wave_shr:1 row_mask:0xf bank_mask:0xf
    v_cndmask_b32_dpp v87, v87, v87, vcc wave_shr:1 row_mask:0xf bank_mask:0xf
    s_andn2_b64 s[82:83], s[82:83], s[52:53]
    v_cndmask_b32_dpp v7, v7, v7, vcc wave_shr:1 row_mask:0xf bank_mask:0xf
    s_mov_b64 exec, s[54:55]
    s_cbranch_scc0 L2_d83
    s_mov_b64 exec, s[82:83]
    s_nop 1
    v_mfma_f32_4x4x4_16b_bf16 v[88:91], v[12:13], v[84:85], 0
    s_nop 1
    v_mfma_f32_4x4x4_16b_bf16 v[88:91], v[10:11], v[86:87], v[88:91]
    s_nop 4
    v_cvt_pk_bf16_f32 v88, v88, v89
    v_cvt_pk_bf16_f32 v89, v90, v91
    ds_pk_add_bf16 v7, v88 offset:65408
    ds_pk_add_bf16 v7, v89 offset:65412
    s_mov_b64 exec, s[54:55]
    s_branch L2_d83
L2_c84:
    s_lshl_b64 s[52:53], s[82:83], 1
    s_andn2_b64 s[52:53], s[52:53], s[80:81]
    s_andn2_b64 s[52:53], s[52:53], s[50:51]
    s_or_b64 s[80:81], s[80:81], s[52:53]
    s_not_b64 vcc, s[52:53]
    s_mov_b64 exec, -1
    v_cndmask_b32_dpp v84, v84, v84, vcc wave_shr:1 row_mask:0xf bank_mask:0xf
    v_cndmask_b32_dpp v85, v85, v85, vcc wave_shr:1 row_mask:0xf bank_mask:0xf
    s_lshr_b64 s[52:53], s[52:53], 1
    v_cndmask_b32_dpp v86, v86, v86, vcc wave_shr:1 row_mask:0xf bank_mask:0xf
    v_cndmask_b32_dpp v87, v87, v87, vcc wave_shr:1 row_mask:0xf bank_mask:0xf
    s_andn2_b64 s[82:83], s[82:83], s[52:53]
    v_cndmask_b32_dpp v7, v7, v7, vcc wave_shr:1 row_mask:0xf bank_mask:0xf
    s_mov_b64 exec, s[50:51]
    s_cbranch_scc0 L2_d84
    s_mov_b64 exec, s[82:83]
    s_nop 1
    v_mfma_f32_4x4x4_16b_bf16 v[88:91], v[12:13], v[84:85], 0
    s_nop 1
    v_mfma_f32_4x4x4_16b_bf16 v[88:91], v[10:11], v[86:87], v[88:91]
    s_nop 4
    v_cvt_pk_bf16_f32 v88, v88, v89
    v_cvt_pk_bf16_f32 v89, v90, v91
    ds_pk_add_bf16 v7, v88 offset:65408
    ds_pk_add_bf16 v7, v89 offset:65412
    s_mov_b64 exec, s[50:51]
    s_branch L2_d84
L2_c85:
    s_lshl_b64 s[52:53], s[82:83], 1
    s_andn2_b64 s[52:53], s[52:53], s[80:81]
    s_andn2_b64 s[52:53], s[52:53], s[54:55]
    s_or_b64 s[80:81], s[80:81], s[52:53]
    s_not_b64 vcc, s[52:53]
    s_mov_b64 exec, -1
    v_cndmask_b32_dpp v84, v84, v84, vcc wave_shr:1 row_mask:0xf bank_mask:0xf
    v_cndmask_b32_dpp v85, v85, v85, vcc wave_shr:1 row_mask:0xf bank_mask:0xf
    s_lshr_b64 s[52:53], s[52:53], 1
    v_cndmask_b32_dpp v86, v86, v86, vcc wave_shr:1 row_mask:0xf bank_mask:0xf
    v_cndmask_b32_dpp v87, v87, v87, vcc wave_shr:1 row_mask:0xf bank_mask:0xf
    s_andn2_b64 s[82:83], s[82:83], s[52:53]
    v_cndmask_b32_dpp v7, v7, v7, vcc wave_shr:1 row_mask:0xf bank_mask:0xf
    s_mov_b64 exec, s[54:55]
    s_cbranch_scc0 L2_d85
    s_mov_b64 exec, s[82:83]
    s_nop 1
    v_mfma_f32_4x4x4_16b_bf16 v[88:91], v[12:13], v[84:85], 0
    s_nop 1
    v_mfma_f32_4x4x4_16b_bf16 v[88:91], v[10:11], v[86:87], v[88:91]
    s_nop 4
    v_cvt_pk_bf16_f32 v88, v88, v89
    v_cvt_pk_bf16_f32 v89, v90, v91
    ds_pk_add_bf16 v7, v88 offset:65408
    ds_pk_add_bf16 v7, v89 offset:65412
    s_mov_b64 exec, s[54:55]
    s_branch L2_d85
L2_c86:
    s_lshl_b64 s[52:53], s[82:83], 1
    s_andn2_b64 s[52:53], s[52:53], s[80:81]
    s_andn2_b64 s[52:53], s[52:53], s[50:51]
    s_or_b64 s[80:81], s[80:81], s[52:53]
    s_not_b64 vcc, s[52:53]
    s_mov_b64 exec, -1
    v_cndmask_b32_dpp v84, v84, v84, vcc wave_shr:1 row_mask:0xf bank_mask:0xf
    v_cndmask_b32_dpp v85, v85, v85, vcc wave_shr:1 row_mask:0xf bank_mask:0xf
    s_lshr_b64 s[52:53], s[52:53], 1
    v_cndmask_b32_dpp v86, v86, v86, vcc wave_shr:1 row_mask:0xf bank_mask:0xf
    v_cndmask_b32_dpp v87, v87, v87, vcc wave_shr:1 row_mask:0xf bank_mask:0xf
    s_andn2_b64 s[82:83], s[82:83], s[52:53]
    v_cndmask_b32_dpp v7, v7, v7, vcc wave_shr:1 row_mask:0xf bank_mask:0xf
    s_mov_b64 exec, s[50:51]
    s_cbranch_scc0 L2_d86
    s_mov_b64 exec, s[82:83]
    s_nop 1
    v_mfma_f32_4x4x4_16b_bf16 v[88:91], v[12:13], v[84:85], 0
    s_nop 1
    v_mfma_f32_4x4x4_16b_bf16 v[88:91], v[10:11], v[86:87], v[88:91]
    s_nop 4
    v_cvt_pk_bf16_f32 v88, v88, v89
    v_cvt_pk_bf16_f32 v89, v90, v91
    ds_pk_add_bf16 v7, v88 offset:65408
    ds_pk_add_bf16 v7, v89 offset:65412
    s_mov_b64 exec, s[50:51]
    s_branch L2_d86
L2_c87:
    s_lshl_b64 s[52:53], s[82:83], 1
    s_andn2_b64 s[52:53], s[52:53], s[80:81]
    s_andn2_b64 s[52:53], s[52:53], s[54:55]
    s_or_b64 s[80:81], s[80:81], s[52:53]
    s_not_b64 vcc, s[52:53]
    s_mov_b64 exec, -1
    v_cndmask_b32_dpp v84, v84, v84, vcc wave_shr:1 row_mask:0xf bank_mask:0xf
    v_cndmask_b32_dpp v85, v85, v85, vcc wave_shr:1 row_mask:0xf bank_mask:0xf
    s_lshr_b64 s[52:53], s[52:53], 1
    v_cndmask_b32_dpp v86, v86, v86, vcc wave_shr:1 row_mask:0xf bank_mask:0xf
    v_cndmask_b32_dpp v87, v87, v87, vcc wave_shr:1 row_mask:0xf bank_mask:0xf
    s_andn2_b64 s[82:83], s[82:83], s[52:53]
    v_cndmask_b32_dpp v7, v7, v7, vcc wave_shr:1 row_mask:0xf bank_mask:0xf
    s_mov_b64 exec, s[54:55]
    s_cbranch_scc0 L2_d87
    s_mov_b64 exec, s[82:83]
    s_nop 1
    v_mfma_f32_4x4x4_16b_bf16 v[88:91], v[12:13], v[84:85], 0
    s_nop 1
    v_mfma_f32_4x4x4_16b_bf16 v[88:91], v[10:11], v[86:87], v[88:91]
    s_nop 4
    v_cvt_pk_bf16_f32 v88, v88, v89
    v_cvt_pk_bf16_f32 v89, v90, v91
    ds_pk_add_bf16 v7, v88 offset:65408
    ds_pk_add_bf16 v7, v89 offset:65412
    s_mov_b64 exec, s[54:55]
    s_branch L2_d87
L2_c88:
    s_lshl_b64 s[52:53], s[82:83], 1
    s_andn2_b64 s[52:53], s[52:53], s[80:81]
    s_andn2_b64 s[52:53], s[52:53], s[50:51]
    s_or_b64 s[80:81], s[80:81], s[52:53]
    s_not_b64 vcc, s[52:53]
    s_mov_b64 exec, -1
    v_cndmask_b32_dpp v84, v84, v84, vcc wave_shr:1 row_mask:0xf bank_mask:0xf
    v_cndmask_b32_dpp v85, v85, v85, vcc wave_shr:1 row_mask:0xf bank_mask:0xf
    s_lshr_b64 s[52:53], s[52:53], 1
    v_cndmask_b32_dpp v86, v86, v86, vcc wave_shr:1 row_mask:0xf bank_mask:0xf
    v_cndmask_b32_dpp v87, v87, v87, vcc wave_shr:1 row_mask:0xf bank_mask:0xf
    s_andn2_b64 s[82:83], s[82:83], s[52:53]
    v_cndmask_b32_dpp v7, v7, v7, vcc wave_shr:1 row_mask:0xf bank_mask:0xf
    s_mov_b64 exec, s[50:51]
    s_cbranch_scc0 L2_d88
    s_mov_b64 exec, s[82:83]
    s_nop 1
    v_mfma_f32_4x4x4_16b_bf16 v[88:91], v[12:13], v[84:85], 0
    s_nop 1
    v_mfma_f32_4x4x4_16b_bf16 v[88:91], v[10:11], v[86:87], v[88:91]
    s_nop 4
    v_cvt_pk_bf16_f32 v88, v88, v89
    v_cvt_pk_bf16_f32 v89, v90, v91
    ds_pk_add_bf16 v7, v88 offset:65408
    ds_pk_add_bf16 v7, v89 offset:65412
    s_mov_b64 exec, s[50:51]
    s_branch L2_d88
L2_oa89:
    s_waitcnt vmcnt(3)
    s_mov_b64 exec, s[6:7]
    v_lshrrev_b32 v114, 16, v114
    s_mov_b64 exec, -1
    v_and_b32 v46, 0x10000000, v32
    v_cmpx_eq_u32 vcc, 0, v46
    v_lshrrev_b32 v47, 14, v112
    v_and_b32 v47, v5, v47
    ds_read_b64 v[96:97], v47
    v_perm_b32 v98, v112, v114, s44
    v_bitop3_b32 v99, v112, 0.5, -0.5 bitop3:0xa8
    v_bitop3_b32 v98, v6, v98, v99 bitop3:0xca
    v_and_b32 v47, v5, v112
    s_waitcnt lgkmcnt(0)
    v_mfma_f32_4x4x4_16b_bf16 v[88:91], v[8:9], v[96:97], 0
    s_nop 4
    v_mul_f32 v88, v98, v88
    v_mul_f32 v89, v98, v89
    v_mul_f32 v90, v98, v90
    v_mul_f32 v91, v98, v91
    v_cvt_pk_bf16_f32 v88, v88, v89
    v_cvt_pk_bf16_f32 v89, v90, v91
    ds_pk_add_bf16 v47, v88 offset:65408
    ds_pk_add_bf16 v47, v89 offset:65412
    s_mov_b64 exec, -1
    v_and_b32 v46, 0x20000000, v32
    v_cmpx_eq_u32 vcc, 0, v46
    v_lshrrev_b32 v47, 14, v113
    v_and_b32 v47, v5, v47
    ds_read_b64 v[96:97], v47
    v_perm_b32 v98, v113, v114, s45
    v_bitop3_b32 v99, v113, 0.5, -0.5 bitop3:0xa8
    v_bitop3_b32 v98, v6, v98, v99 bitop3:0xca
    v_and_b32 v47, v5, v113
    s_waitcnt lgkmcnt(0)
    v_mfma_f32_4x4x4_16b_bf16 v[88:91], v[8:9], v[96:97], 0
    s_nop 4
    v_mul_f32 v88, v98, v88
    v_mul_f32 v89, v98, v89
    v_mul_f32 v90, v98, v90
    v_mul_f32 v91, v98, v91
    v_cvt_pk_bf16_f32 v88, v88, v89
    v_cvt_pk_bf16_f32 v89, v90, v91
    ds_pk_add_bf16 v47, v88 offset:65408
    ds_pk_add_bf16 v47, v89 offset:65412
    s_mov_b64 exec, -1
    s_branch L2_ob89
L2_xo90:
    v_cmp_lt_u32 vcc, 20, v99
    s_mov_b32 s101, 1
    s_cbranch_vccz L2_xp90
    v_cmp_lt_u32 vcc, 32, v99
    v_cmp_lt_u32 s[58:59], 31, v88
    s_mov_b32 s101, 2
    s_or_b64 vcc, vcc, s[58:59]
    s_cbranch_scc0 L2_xp90
    s_mov_b32 s37, 0x10000
    s_branch L2_xp90
L2_c91:
    s_lshl_b64 s[52:53], s[82:83], 1
    s_andn2_b64 s[52:53], s[52:53], s[80:81]
    s_andn2_b64 s[52:53], s[52:53], s[54:55]
    s_or_b64 s[80:81], s[80:81], s[52:53]
    s_not_b64 vcc, s[52:53]
    s_mov_b64 exec, -1
    v_cndmask_b32_dpp v84, v84, v84, vcc wave_shr:1 row_mask:0xf bank_mask:0xf
    v_cndmask_b32_dpp v85, v85, v85, vcc wave_shr:1 row_mask:0xf bank_mask:0xf
    s_lshr_b64 s[52:53], s[52:53], 1
    v_cndmask_b32_dpp v86, v86, v86, vcc wave_shr:1 row_mask:0xf bank_mask:0xf
    v_cndmask_b32_dpp v87, v87, v87, vcc wave_shr:1 row_mask:0xf bank_mask:0xf
    s_andn2_b64 s[82:83], s[82:83], s[52:53]
    v_cndmask_b32_dpp v7, v7, v7, vcc wave_shr:1 row_mask:0xf bank_mask:0xf
    s_mov_b64 exec, s[54:55]
    s_cbranch_scc0 L2_d91
    s_mov_b64 exec, s[82:83]
    s_nop 1
    v_mfma_f32_4x4x4_16b_bf16 v[88:91], v[12:13], v[84:85], 0
    s_nop 1
    v_mfma_f32_4x4x4_16b_bf16 v[88:91], v[10:11], v[86:87], v[88:91]
    s_nop 4
    v_cvt_pk_bf16_f32 v88, v88, v89
    v_cvt_pk_bf16_f32 v89, v90, v91
    ds_pk_add_bf16 v7, v88 offset:65408
    ds_pk_add_bf16 v7, v89 offset:65412
    s_mov_b64 exec, s[54:55]
    s_branch L2_d91
L2_c92:
    s_lshl_b64 s[52:53], s[82:83], 1
    s_andn2_b64 s[52:53], s[52:53], s[80:81]
    s_andn2_b64 s[52:53], s[52:53], s[50:51]
    s_or_b64 s[80:81], s[80:81], s[52:53]
    s_not_b64 vcc, s[52:53]
    s_mov_b64 exec, -1
    v_cndmask_b32_dpp v84, v84, v84, vcc wave_shr:1 row_mask:0xf bank_mask:0xf
    v_cndmask_b32_dpp v85, v85, v85, vcc wave_shr:1 row_mask:0xf bank_mask:0xf
    s_lshr_b64 s[52:53], s[52:53], 1
    v_cndmask_b32_dpp v86, v86, v86, vcc wave_shr:1 row_mask:0xf bank_mask:0xf
    v_cndmask_b32_dpp v87, v87, v87, vcc wave_shr:1 row_mask:0xf bank_mask:0xf
    s_andn2_b64 s[82:83], s[82:83], s[52:53]
    v_cndmask_b32_dpp v7, v7, v7, vcc wave_shr:1 row_mask:0xf bank_mask:0xf
    s_mov_b64 exec, s[50:51]
    s_cbranch_scc0 L2_d92
    s_mov_b64 exec, s[82:83]
    s_nop 1
    v_mfma_f32_4x4x4_16b_bf16 v[88:91], v[12:13], v[84:85], 0
    s_nop 1
    v_mfma_f32_4x4x4_16b_bf16 v[88:91], v[10:11], v[86:87], v[88:91]
    s_nop 4
    v_cvt_pk_bf16_f32 v88, v88, v89
    v_cvt_pk_bf16_f32 v89, v90, v91
    ds_pk_add_bf16 v7, v88 offset:65408
    ds_pk_add_bf16 v7, v89 offset:65412
    s_mov_b64 exec, s[50:51]
    s_branch L2_d92
L2_c93:
    s_lshl_b64 s[52:53], s[82:83], 1
    s_andn2_b64 s[52:53], s[52:53], s[80:81]
    s_andn2_b64 s[52:53], s[52:53], s[54:55]
    s_or_b64 s[80:81], s[80:81], s[52:53]
    s_not_b64 vcc, s[52:53]
    s_mov_b64 exec, -1
    v_cndmask_b32_dpp v84, v84, v84, vcc wave_shr:1 row_mask:0xf bank_mask:0xf
    v_cndmask_b32_dpp v85, v85, v85, vcc wave_shr:1 row_mask:0xf bank_mask:0xf
    s_lshr_b64 s[52:53], s[52:53], 1
    v_cndmask_b32_dpp v86, v86, v86, vcc wave_shr:1 row_mask:0xf bank_mask:0xf
    v_cndmask_b32_dpp v87, v87, v87, vcc wave_shr:1 row_mask:0xf bank_mask:0xf
    s_andn2_b64 s[82:83], s[82:83], s[52:53]
    v_cndmask_b32_dpp v7, v7, v7, vcc wave_shr:1 row_mask:0xf bank_mask:0xf
    s_mov_b64 exec, s[54:55]
    s_cbranch_scc0 L2_d93
    s_mov_b64 exec, s[82:83]
    s_nop 1
    v_mfma_f32_4x4x4_16b_bf16 v[88:91], v[12:13], v[84:85], 0
    s_nop 1
    v_mfma_f32_4x4x4_16b_bf16 v[88:91], v[10:11], v[86:87], v[88:91]
    s_nop 4
    v_cvt_pk_bf16_f32 v88, v88, v89
    v_cvt_pk_bf16_f32 v89, v90, v91
    ds_pk_add_bf16 v7, v88 offset:65408
    ds_pk_add_bf16 v7, v89 offset:65412
    s_mov_b64 exec, s[54:55]
    s_branch L2_d93
L2_c94:
    s_lshl_b64 s[52:53], s[82:83], 1
    s_andn2_b64 s[52:53], s[52:53], s[80:81]
    s_andn2_b64 s[52:53], s[52:53], s[50:51]
    s_or_b64 s[80:81], s[80:81], s[52:53]
    s_not_b64 vcc, s[52:53]
    s_mov_b64 exec, -1
    v_cndmask_b32_dpp v84, v84, v84, vcc wave_shr:1 row_mask:0xf bank_mask:0xf
    v_cndmask_b32_dpp v85, v85, v85, vcc wave_shr:1 row_mask:0xf bank_mask:0xf
    s_lshr_b64 s[52:53], s[52:53], 1
    v_cndmask_b32_dpp v86, v86, v86, vcc wave_shr:1 row_mask:0xf bank_mask:0xf
    v_cndmask_b32_dpp v87, v87, v87, vcc wave_shr:1 row_mask:0xf bank_mask:0xf
    s_andn2_b64 s[82:83], s[82:83], s[52:53]
    v_cndmask_b32_dpp v7, v7, v7, vcc wave_shr:1 row_mask:0xf bank_mask:0xf
    s_mov_b64 exec, s[50:51]
    s_cbranch_scc0 L2_d94
    s_mov_b64 exec, s[82:83]
    s_nop 1
    v_mfma_f32_4x4x4_16b_bf16 v[88:91], v[12:13], v[84:85], 0
    s_nop 1
    v_mfma_f32_4x4x4_16b_bf16 v[88:91], v[10:11], v[86:87], v[88:91]
    s_nop 4
    v_cvt_pk_bf16_f32 v88, v88, v89
    v_cvt_pk_bf16_f32 v89, v90, v91
    ds_pk_add_bf16 v7, v88 offset:65408
    ds_pk_add_bf16 v7, v89 offset:65412
    s_mov_b64 exec, s[50:51]
    s_branch L2_d94
L2_c95:
    s_lshl_b64 s[52:53], s[82:83], 1
    s_andn2_b64 s[52:53], s[52:53], s[80:81]
    s_andn2_b64 s[52:53], s[52:53], s[54:55]
    s_or_b64 s[80:81], s[80:81], s[52:53]
    s_not_b64 vcc, s[52:53]
    s_mov_b64 exec, -1
    v_cndmask_b32_dpp v84, v84, v84, vcc wave_shr:1 row_mask:0xf bank_mask:0xf
    v_cndmask_b32_dpp v85, v85, v85, vcc wave_shr:1 row_mask:0xf bank_mask:0xf
    s_lshr_b64 s[52:53], s[52:53], 1
    v_cndmask_b32_dpp v86, v86, v86, vcc wave_shr:1 row_mask:0xf bank_mask:0xf
    v_cndmask_b32_dpp v87, v87, v87, vcc wave_shr:1 row_mask:0xf bank_mask:0xf
    s_andn2_b64 s[82:83], s[82:83], s[52:53]
    v_cndmask_b32_dpp v7, v7, v7, vcc wave_shr:1 row_mask:0xf bank_mask:0xf
    s_mov_b64 exec, s[54:55]
    s_cbranch_scc0 L2_d95
    s_mov_b64 exec, s[82:83]
    s_nop 1
    v_mfma_f32_4x4x4_16b_bf16 v[88:91], v[12:13], v[84:85], 0
    s_nop 1
    v_mfma_f32_4x4x4_16b_bf16 v[88:91], v[10:11], v[86:87], v[88:91]
    s_nop 4
    v_cvt_pk_bf16_f32 v88, v88, v89
    v_cvt_pk_bf16_f32 v89, v90, v91
    ds_pk_add_bf16 v7, v88 offset:65408
    ds_pk_add_bf16 v7, v89 offset:65412
    s_mov_b64 exec, s[54:55]
    s_branch L2_d95
L2_c96:
    s_lshl_b64 s[52:53], s[82:83], 1
    s_andn2_b64 s[52:53], s[52:53], s[80:81]
    s_andn2_b64 s[52:53], s[52:53], s[50:51]
    s_or_b64 s[80:81], s[80:81], s[52:53]
    s_not_b64 vcc, s[52:53]
    s_mov_b64 exec, -1
    v_cndmask_b32_dpp v84, v84, v84, vcc wave_shr:1 row_mask:0xf bank_mask:0xf
    v_cndmask_b32_dpp v85, v85, v85, vcc wave_shr:1 row_mask:0xf bank_mask:0xf
    s_lshr_b64 s[52:53], s[52:53], 1
    v_cndmask_b32_dpp v86, v86, v86, vcc wave_shr:1 row_mask:0xf bank_mask:0xf
    v_cndmask_b32_dpp v87, v87, v87, vcc wave_shr:1 row_mask:0xf bank_mask:0xf
    s_andn2_b64 s[82:83], s[82:83], s[52:53]
    v_cndmask_b32_dpp v7, v7, v7, vcc wave_shr:1 row_mask:0xf bank_mask:0xf
    s_mov_b64 exec, s[50:51]
    s_cbranch_scc0 L2_d96
    s_mov_b64 exec, s[82:83]
    s_nop 1
    v_mfma_f32_4x4x4_16b_bf16 v[88:91], v[12:13], v[84:85], 0
    s_nop 1
    v_mfma_f32_4x4x4_16b_bf16 v[88:91], v[10:11], v[86:87], v[88:91]
    s_nop 4
    v_cvt_pk_bf16_f32 v88, v88, v89
    v_cvt_pk_bf16_f32 v89, v90, v91
    ds_pk_add_bf16 v7, v88 offset:65408
    ds_pk_add_bf16 v7, v89 offset:65412
    s_mov_b64 exec, s[50:51]
    s_branch L2_d96
L2_xa97:
    s_cmp_eq_u32 s101, 1
    s_cbranch_scc1 L2_xc97
    v_lshlrev_b32 v89, 0, v96
    v_add_u32 v90, 140, v97
    v_bitop3_b32 v90, v89, v45, v90 bitop3:0x6a
    ds_write_b32 v98, v90 offset:28
    v_lshlrev_b32 v89, 4, v96
    v_add_u32 v90, 120, v97
    v_bitop3_b32 v90, v89, v45, v90 bitop3:0x6a
    ds_write_b32 v98, v90 offset:24
    v_lshlrev_b32 v89, 8, v96
    v_add_u32 v90, 100, v97
    v_bitop3_b32 v90, v89, v45, v90 bitop3:0x6a
    ds_write_b32 v98, v90 offset:20
L2_xc97:
    v_lshlrev_b32 v89, 12, v96
    v_add_u32 v90, 80, v97
    v_bitop3_b32 v90, v89, v45, v90 bitop3:0x6a
    ds_write_b32 v98, v90 offset:16
    s_branch L2_xb97
L2_xe97:
    v_cmp_lt_u32 vcc, 32, v99
    v_cmp_lt_u32 s[58:59], 31, v88
    v_lshrrev_b32 v89, 16, v96
    v_add_u32 v97, 80, v97
    s_or_b64 vcc, vcc, s[58:59]
    s_cbranch_scc1 L2_xs97
    v_lshlrev_b32 v89, v1, v89
    v_and_b32 v89, v45, v89
    v_cmp_ne_u32 vcc, 0, v89
    v_xor_b32 v90, v97, v89
    s_add_u32 s3, s37, s38
    v_mbcnt_lo_u32_b32 v98, vcc_lo, 0
    v_mbcnt_hi_u32_b32 v98, vcc_hi, v98
    s_bcnt1_i32_b64 s41, vcc
    v_lshl_add_u32 v98, v98, 2, s3
    s_lshl2_add_u32 s37, s41, s37
    s_mov_b64 exec, vcc
    ds_write_b32 v98, v90
    s_mov_b64 exec, -1
    s_branch L2_xr97
L2_xs97:
    s_waitcnt lgkmcnt(0)
    s_mov_b32 s37, 0x10000
    s_branch L2_xw97
L2_c98:
    s_lshl_b64 s[52:53], s[82:83], 1
    s_andn2_b64 s[52:53], s[52:53], s[80:81]
    s_andn2_b64 s[52:53], s[52:53], s[54:55]
    s_or_b64 s[80:81], s[80:81], s[52:53]
    s_not_b64 vcc, s[52:53]
    s_mov_b64 exec, -1
    v_cndmask_b32_dpp v84, v84, v84, vcc wave_shr:1 row_mask:0xf bank_mask:0xf
    v_cndmask_b32_dpp v85, v85, v85, vcc wave_shr:1 row_mask:0xf bank_mask:0xf
    s_lshr_b64 s[52:53], s[52:53], 1
    v_cndmask_b32_dpp v86, v86, v86, vcc wave_shr:1 row_mask:0xf bank_mask:0xf
    v_cndmask_b32_dpp v87, v87, v87, vcc wave_shr:1 row_mask:0xf bank_mask:0xf
    s_andn2_b64 s[82:83], s[82:83], s[52:53]
    v_cndmask_b32_dpp v7, v7, v7, vcc wave_shr:1 row_mask:0xf bank_mask:0xf
    s_mov_b64 exec, s[54:55]
    s_cbranch_scc0 L2_d98
    s_mov_b64 exec, s[82:83]
    s_nop 1
    v_mfma_f32_4x4x4_16b_bf16 v[88:91], v[12:13], v[84:85], 0
    s_nop 1
    v_mfma_f32_4x4x4_16b_bf16 v[88:91], v[10:11], v[86:87], v[88:91]
    s_nop 4
    v_cvt_pk_bf16_f32 v88, v88, v89
    v_cvt_pk_bf16_f32 v89, v90, v91
    ds_pk_add_bf16 v7, v88 offset:65408
    ds_pk_add_bf16 v7, v89 offset:65412
    s_mov_b64 exec, s[54:55]
    s_branch L2_d98
L2_c99:
    s_lshl_b64 s[52:53], s[82:83], 1
    s_andn2_b64 s[52:53], s[52:53], s[80:81]
    s_andn2_b64 s[52:53], s[52:53], s[50:51]
    s_or_b64 s[80:81], s[80:81], s[52:53]
    s_not_b64 vcc, s[52:53]
    s_mov_b64 exec, -1
    v_cndmask_b32_dpp v84, v84, v84, vcc wave_shr:1 row_mask:0xf bank_mask:0xf
    v_cndmask_b32_dpp v85, v85, v85, vcc wave_shr:1 row_mask:0xf bank_mask:0xf
    s_lshr_b64 s[52:53], s[52:53], 1
    v_cndmask_b32_dpp v86, v86, v86, vcc wave_shr:1 row_mask:0xf bank_mask:0xf
    v_cndmask_b32_dpp v87, v87, v87, vcc wave_shr:1 row_mask:0xf bank_mask:0xf
    s_andn2_b64 s[82:83], s[82:83], s[52:53]
    v_cndmask_b32_dpp v7, v7, v7, vcc wave_shr:1 row_mask:0xf bank_mask:0xf
    s_mov_b64 exec, s[50:51]
    s_cbranch_scc0 L2_d99
    s_mov_b64 exec, s[82:83]
    s_nop 1
    v_mfma_f32_4x4x4_16b_bf16 v[88:91], v[12:13], v[84:85], 0
    s_nop 1
    v_mfma_f32_4x4x4_16b_bf16 v[88:91], v[10:11], v[86:87], v[88:91]
    s_nop 4
    v_cvt_pk_bf16_f32 v88, v88, v89
    v_cvt_pk_bf16_f32 v89, v90, v91
    ds_pk_add_bf16 v7, v88 offset:65408
    ds_pk_add_bf16 v7, v89 offset:65412
    s_mov_b64 exec, s[50:51]
    s_branch L2_d99
L2_xf97:
    s_cmp_gt_u32 s37, 1024
    s_cbranch_scc1 L2_xt97
    s_cmp_lt_u32 s37, 768
    s_cbranch_scc1 L2_xl97
    ds_read_b32 v32, v44 offset:896
    s_add_u32 s3, s42, 2
    s_bitset1_b32 s43, s3
    s_branch L2_xg97
L2_xl97:
    s_waitcnt lgkmcnt(0)
    v_mov_b32 v31, -1
    s_cmp_ge_u32 s37, 512
    s_cbranch_scc1 L2_xg97
    v_mov_b32 v39, -1
    s_cmp_ge_u32 s37, 256
    s_cbranch_scc1 L2_xg97
    v_mov_b32 v27, -1
    s_branch L2_xg97
L2_xt97:
    s_waitcnt lgkmcnt(0)
    v_mov_b32 v21, -1
    v_mov_b32 v27, -1
    v_mov_b32 v39, -1
    v_mov_b32 v31, -1
    s_add_u32 s3, s42, 2
    s_bitset1_b32 s36, s3
    s_branch L2_xg97
L2_oa100:
    v_and_b32 v47, 0x0fffffff, v33
    buffer_load_dword v114, v47, s[8:11], 0 offen offset:16
    s_mov_b64 exec, s[6:7]
    v_add_u32 v47, 8, v47
    v_lshrrev_b32 v33, 2, v33
    s_mov_b64 exec, -1
    buffer_load_dwordx2 v[112:113], v47, s[8:11], 0 offen
    s_branch L2_ob100
L2_c101:
    s_lshl_b64 s[52:53], s[82:83], 1
    s_andn2_b64 s[52:53], s[52:53], s[80:81]
    s_andn2_b64 s[52:53], s[52:53], s[54:55]
    s_or_b64 s[80:81], s[80:81], s[52:53]
    s_not_b64 vcc, s[52:53]
    s_mov_b64 exec, -1
    v_cndmask_b32_dpp v84, v84, v84, vcc wave_shr:1 row_mask:0xf bank_mask:0xf
    v_cndmask_b32_dpp v85, v85, v85, vcc wave_shr:1 row_mask:0xf bank_mask:0xf
    s_lshr_b64 s[52:53], s[52:53], 1
    v_cndmask_b32_dpp v86, v86, v86, vcc wave_shr:1 row_mask:0xf bank_mask:0xf
    v_cndmask_b32_dpp v87, v87, v87, vcc wave_shr:1 row_mask:0xf bank_mask:0xf
    s_andn2_b64 s[82:83], s[82:83], s[52:53]
    v_cndmask_b32_dpp v7, v7, v7, vcc wave_shr:1 row_mask:0xf bank_mask:0xf
    s_mov_b64 exec, s[54:55]
    s_cbranch_scc0 L2_d101
    s_mov_b64 exec, s[82:83]
    s_nop 1
    v_mfma_f32_4x4x4_16b_bf16 v[88:91], v[12:13], v[84:85], 0
    s_nop 1
    v_mfma_f32_4x4x4_16b_bf16 v[88:91], v[10:11], v[86:87], v[88:91]
    s_nop 4
    v_cvt_pk_bf16_f32 v88, v88, v89
    v_cvt_pk_bf16_f32 v89, v90, v91
    ds_pk_add_bf16 v7, v88 offset:65408
    ds_pk_add_bf16 v7, v89 offset:65412
    s_mov_b64 exec, s[54:55]
    s_branch L2_d101
L2_c102:
    s_lshl_b64 s[52:53], s[82:83], 1
    s_andn2_b64 s[52:53], s[52:53], s[80:81]
    s_andn2_b64 s[52:53], s[52:53], s[50:51]
    s_or_b64 s[80:81], s[80:81], s[52:53]
    s_not_b64 vcc, s[52:53]
    s_mov_b64 exec, -1
    v_cndmask_b32_dpp v84, v84, v84, vcc wave_shr:1 row_mask:0xf bank_mask:0xf
    v_cndmask_b32_dpp v85, v85, v85, vcc wave_shr:1 row_mask:0xf bank_mask:0xf
    s_lshr_b64 s[52:53], s[52:53], 1
    v_cndmask_b32_dpp v86, v86, v86, vcc wave_shr:1 row_mask:0xf bank_mask:0xf
    v_cndmask_b32_dpp v87, v87, v87, vcc wave_shr:1 row_mask:0xf bank_mask:0xf
    s_andn2_b64 s[82:83], s[82:83], s[52:53]
    v_cndmask_b32_dpp v7, v7, v7, vcc wave_shr:1 row_mask:0xf bank_mask:0xf
    s_mov_b64 exec, s[50:51]
    s_cbranch_scc0 L2_d102
    s_mov_b64 exec, s[82:83]
    s_nop 1
    v_mfma_f32_4x4x4_16b_bf16 v[88:91], v[12:13], v[84:85], 0
    s_nop 1
    v_mfma_f32_4x4x4_16b_bf16 v[88:91], v[10:11], v[86:87], v[88:91]
    s_nop 4
    v_cvt_pk_bf16_f32 v88, v88, v89
    v_cvt_pk_bf16_f32 v89, v90, v91
    ds_pk_add_bf16 v7, v88 offset:65408
    ds_pk_add_bf16 v7, v89 offset:65412
    s_mov_b64 exec, s[50:51]
    s_branch L2_d102
L2_c103:
    s_lshl_b64 s[52:53], s[82:83], 1
    s_andn2_b64 s[52:53], s[52:53], s[80:81]
    s_andn2_b64 s[52:53], s[52:53], s[54:55]
    s_or_b64 s[80:81], s[80:81], s[52:53]
    s_not_b64 vcc, s[52:53]
    s_mov_b64 exec, -1
    v_cndmask_b32_dpp v84, v84, v84, vcc wave_shr:1 row_mask:0xf bank_mask:0xf
    v_cndmask_b32_dpp v85, v85, v85, vcc wave_shr:1 row_mask:0xf bank_mask:0xf
    s_lshr_b64 s[52:53], s[52:53], 1
    v_cndmask_b32_dpp v86, v86, v86, vcc wave_shr:1 row_mask:0xf bank_mask:0xf
    v_cndmask_b32_dpp v87, v87, v87, vcc wave_shr:1 row_mask:0xf bank_mask:0xf
    s_andn2_b64 s[82:83], s[82:83], s[52:53]
    v_cndmask_b32_dpp v7, v7, v7, vcc wave_shr:1 row_mask:0xf bank_mask:0xf
    s_mov_b64 exec, s[54:55]
    s_cbranch_scc0 L2_d103
    s_mov_b64 exec, s[82:83]
    s_nop 1
    v_mfma_f32_4x4x4_16b_bf16 v[88:91], v[12:13], v[84:85], 0
    s_nop 1
    v_mfma_f32_4x4x4_16b_bf16 v[88:91], v[10:11], v[86:87], v[88:91]
    s_nop 4
    v_cvt_pk_bf16_f32 v88, v88, v89
    v_cvt_pk_bf16_f32 v89, v90, v91
    ds_pk_add_bf16 v7, v88 offset:65408
    ds_pk_add_bf16 v7, v89 offset:65412
    s_mov_b64 exec, s[54:55]
    s_branch L2_d103
L2_c104:
    s_lshl_b64 s[52:53], s[82:83], 1
    s_andn2_b64 s[52:53], s[52:53], s[80:81]
    s_andn2_b64 s[52:53], s[52:53], s[50:51]
    s_or_b64 s[80:81], s[80:81], s[52:53]
    s_not_b64 vcc, s[52:53]
    s_mov_b64 exec, -1
    v_cndmask_b32_dpp v84, v84, v84, vcc wave_shr:1 row_mask:0xf bank_mask:0xf
    v_cndmask_b32_dpp v85, v85, v85, vcc wave_shr:1 row_mask:0xf bank_mask:0xf
    s_lshr_b64 s[52:53], s[52:53], 1
    v_cndmask_b32_dpp v86, v86, v86, vcc wave_shr:1 row_mask:0xf bank_mask:0xf
    v_cndmask_b32_dpp v87, v87, v87, vcc wave_shr:1 row_mask:0xf bank_mask:0xf
    s_andn2_b64 s[82:83], s[82:83], s[52:53]
    v_cndmask_b32_dpp v7, v7, v7, vcc wave_shr:1 row_mask:0xf bank_mask:0xf
    s_mov_b64 exec, s[50:51]
    s_cbranch_scc0 L2_d104
    s_mov_b64 exec, s[82:83]
    s_nop 1
    v_mfma_f32_4x4x4_16b_bf16 v[88:91], v[12:13], v[84:85], 0
    s_nop 1
    v_mfma_f32_4x4x4_16b_bf16 v[88:91], v[10:11], v[86:87], v[88:91]
    s_nop 4
    v_cvt_pk_bf16_f32 v88, v88, v89
    v_cvt_pk_bf16_f32 v89, v90, v91
    ds_pk_add_bf16 v7, v88 offset:65408
    ds_pk_add_bf16 v7, v89 offset:65412
    s_mov_b64 exec, s[50:51]
    s_branch L2_d104
L2_c105:
    s_lshl_b64 s[52:53], s[82:83], 1
    s_andn2_b64 s[52:53], s[52:53], s[80:81]
    s_andn2_b64 s[52:53], s[52:53], s[54:55]
    s_or_b64 s[80:81], s[80:81], s[52:53]
    s_not_b64 vcc, s[52:53]
    s_mov_b64 exec, -1
    v_cndmask_b32_dpp v84, v84, v84, vcc wave_shr:1 row_mask:0xf bank_mask:0xf
    v_cndmask_b32_dpp v85, v85, v85, vcc wave_shr:1 row_mask:0xf bank_mask:0xf
    s_lshr_b64 s[52:53], s[52:53], 1
    v_cndmask_b32_dpp v86, v86, v86, vcc wave_shr:1 row_mask:0xf bank_mask:0xf
    v_cndmask_b32_dpp v87, v87, v87, vcc wave_shr:1 row_mask:0xf bank_mask:0xf
    s_andn2_b64 s[82:83], s[82:83], s[52:53]
    v_cndmask_b32_dpp v7, v7, v7, vcc wave_shr:1 row_mask:0xf bank_mask:0xf
    s_mov_b64 exec, s[54:55]
    s_cbranch_scc0 L2_d105
    s_mov_b64 exec, s[82:83]
    s_nop 1
    v_mfma_f32_4x4x4_16b_bf16 v[88:91], v[12:13], v[84:85], 0
    s_nop 1
    v_mfma_f32_4x4x4_16b_bf16 v[88:91], v[10:11], v[86:87], v[88:91]
    s_nop 4
    v_cvt_pk_bf16_f32 v88, v88, v89
    v_cvt_pk_bf16_f32 v89, v90, v91
    ds_pk_add_bf16 v7, v88 offset:65408
    ds_pk_add_bf16 v7, v89 offset:65412
    s_mov_b64 exec, s[54:55]
    s_branch L2_d105
L2_c106:
    s_lshl_b64 s[52:53], s[82:83], 1
    s_andn2_b64 s[52:53], s[52:53], s[80:81]
    s_andn2_b64 s[52:53], s[52:53], s[50:51]
    s_or_b64 s[80:81], s[80:81], s[52:53]
    s_not_b64 vcc, s[52:53]
    s_mov_b64 exec, -1
    v_cndmask_b32_dpp v84, v84, v84, vcc wave_shr:1 row_mask:0xf bank_mask:0xf
    v_cndmask_b32_dpp v85, v85, v85, vcc wave_shr:1 row_mask:0xf bank_mask:0xf
    s_lshr_b64 s[52:53], s[52:53], 1
    v_cndmask_b32_dpp v86, v86, v86, vcc wave_shr:1 row_mask:0xf bank_mask:0xf
    v_cndmask_b32_dpp v87, v87, v87, vcc wave_shr:1 row_mask:0xf bank_mask:0xf
    s_andn2_b64 s[82:83], s[82:83], s[52:53]
    v_cndmask_b32_dpp v7, v7, v7, vcc wave_shr:1 row_mask:0xf bank_mask:0xf
    s_mov_b64 exec, s[50:51]
    s_cbranch_scc0 L2_d106
    s_mov_b64 exec, s[82:83]
    s_nop 1
    v_mfma_f32_4x4x4_16b_bf16 v[88:91], v[12:13], v[84:85], 0
    s_nop 1
    v_mfma_f32_4x4x4_16b_bf16 v[88:91], v[10:11], v[86:87], v[88:91]
    s_nop 4
    v_cvt_pk_bf16_f32 v88, v88, v89
    v_cvt_pk_bf16_f32 v89, v90, v91
    ds_pk_add_bf16 v7, v88 offset:65408
    ds_pk_add_bf16 v7, v89 offset:65412
    s_mov_b64 exec, s[50:51]
    s_branch L2_d106
L2_oa107:
    s_waitcnt vmcnt(3)
    s_mov_b64 exec, s[6:7]
    v_lshrrev_b32 v114, 16, v114
    s_mov_b64 exec, -1
    v_and_b32 v46, 0x10000000, v33
    v_cmpx_eq_u32 vcc, 0, v46
    v_lshrrev_b32 v47, 14, v112
    v_and_b32 v47, v5, v47
    ds_read_b64 v[96:97], v47
    v_perm_b32 v98, v112, v114, s44
    v_bitop3_b32 v99, v112, 0.5, -0.5 bitop3:0xa8
    v_bitop3_b32 v98, v6, v98, v99 bitop3:0xca
    v_and_b32 v47, v5, v112
    s_waitcnt lgkmcnt(0)
    v_mfma_f32_4x4x4_16b_bf16 v[88:91], v[8:9], v[96:97], 0
    s_nop 4
    v_mul_f32 v88, v98, v88
    v_mul_f32 v89, v98, v89
    v_mul_f32 v90, v98, v90
    v_mul_f32 v91, v98, v91
    v_cvt_pk_bf16_f32 v88, v88, v89
    v_cvt_pk_bf16_f32 v89, v90, v91
    ds_pk_add_bf16 v47, v88 offset:65408
    ds_pk_add_bf16 v47, v89 offset:65412
    s_mov_b64 exec, -1
    v_and_b32 v46, 0x20000000, v33
    v_cmpx_eq_u32 vcc, 0, v46
    v_lshrrev_b32 v47, 14, v113
    v_and_b32 v47, v5, v47
    ds_read_b64 v[96:97], v47
    v_perm_b32 v98, v113, v114, s45
    v_bitop3_b32 v99, v113, 0.5, -0.5 bitop3:0xa8
    v_bitop3_b32 v98, v6, v98, v99 bitop3:0xca
    v_and_b32 v47, v5, v113
    s_waitcnt lgkmcnt(0)
    v_mfma_f32_4x4x4_16b_bf16 v[88:91], v[8:9], v[96:97], 0
    s_nop 4
    v_mul_f32 v88, v98, v88
    v_mul_f32 v89, v98, v89
    v_mul_f32 v90, v98, v90
    v_mul_f32 v91, v98, v91
    v_cvt_pk_bf16_f32 v88, v88, v89
    v_cvt_pk_bf16_f32 v89, v90, v91
    ds_pk_add_bf16 v47, v88 offset:65408
    ds_pk_add_bf16 v47, v89 offset:65412
    s_mov_b64 exec, -1
    s_branch L2_ob107
L2_xo108:
    v_cmp_lt_u32 vcc, 20, v99
    s_mov_b32 s101, 1
    s_cbranch_vccz L2_xp108
    v_cmp_lt_u32 vcc, 32, v99
    v_cmp_lt_u32 s[58:59], 31, v88
    s_mov_b32 s101, 2
    s_or_b64 vcc, vcc, s[58:59]
    s_cbranch_scc0 L2_xp108
    s_mov_b32 s37, 0x10000
    s_branch L2_xp108
L2_c109:
    s_lshl_b64 s[52:53], s[82:83], 1
    s_andn2_b64 s[52:53], s[52:53], s[80:81]
    s_andn2_b64 s[52:53], s[52:53], s[54:55]
    s_or_b64 s[80:81], s[80:81], s[52:53]
    s_not_b64 vcc, s[52:53]
    s_mov_b64 exec, -1
    v_cndmask_b32_dpp v84, v84, v84, vcc wave_shr:1 row_mask:0xf bank_mask:0xf
    v_cndmask_b32_dpp v85, v85, v85, vcc wave_shr:1 row_mask:0xf bank_mask:0xf
    s_lshr_b64 s[52:53], s[52:53], 1
    v_cndmask_b32_dpp v86, v86, v86, vcc wave_shr:1 row_mask:0xf bank_mask:0xf
    v_cndmask_b32_dpp v87, v87, v87, vcc wave_shr:1 row_mask:0xf bank_mask:0xf
    s_andn2_b64 s[82:83], s[82:83], s[52:53]
    v_cndmask_b32_dpp v7, v7, v7, vcc wave_shr:1 row_mask:0xf bank_mask:0xf
    s_mov_b64 exec, s[54:55]
    s_cbranch_scc0 L2_d109
    s_mov_b64 exec, s[82:83]
    s_nop 1
    v_mfma_f32_4x4x4_16b_bf16 v[88:91], v[12:13], v[84:85], 0
    s_nop 1
    v_mfma_f32_4x4x4_16b_bf16 v[88:91], v[10:11], v[86:87], v[88:91]
    s_nop 4
    v_cvt_pk_bf16_f32 v88, v88, v89
    v_cvt_pk_bf16_f32 v89, v90, v91
    ds_pk_add_bf16 v7, v88 offset:65408
    ds_pk_add_bf16 v7, v89 offset:65412
    s_mov_b64 exec, s[54:55]
    s_branch L2_d109
L2_c110:
    s_lshl_b64 s[52:53], s[82:83], 1
    s_andn2_b64 s[52:53], s[52:53], s[80:81]
    s_andn2_b64 s[52:53], s[52:53], s[50:51]
    s_or_b64 s[80:81], s[80:81], s[52:53]
    s_not_b64 vcc, s[52:53]
    s_mov_b64 exec, -1
    v_cndmask_b32_dpp v84, v84, v84, vcc wave_shr:1 row_mask:0xf bank_mask:0xf
    v_cndmask_b32_dpp v85, v85, v85, vcc wave_shr:1 row_mask:0xf bank_mask:0xf
    s_lshr_b64 s[52:53], s[52:53], 1
    v_cndmask_b32_dpp v86, v86, v86, vcc wave_shr:1 row_mask:0xf bank_mask:0xf
    v_cndmask_b32_dpp v87, v87, v87, vcc wave_shr:1 row_mask:0xf bank_mask:0xf
    s_andn2_b64 s[82:83], s[82:83], s[52:53]
    v_cndmask_b32_dpp v7, v7, v7, vcc wave_shr:1 row_mask:0xf bank_mask:0xf
    s_mov_b64 exec, s[50:51]
    s_cbranch_scc0 L2_d110
    s_mov_b64 exec, s[82:83]
    s_nop 1
    v_mfma_f32_4x4x4_16b_bf16 v[88:91], v[12:13], v[84:85], 0
    s_nop 1
    v_mfma_f32_4x4x4_16b_bf16 v[88:91], v[10:11], v[86:87], v[88:91]
    s_nop 4
    v_cvt_pk_bf16_f32 v88, v88, v89
    v_cvt_pk_bf16_f32 v89, v90, v91
    ds_pk_add_bf16 v7, v88 offset:65408
    ds_pk_add_bf16 v7, v89 offset:65412
    s_mov_b64 exec, s[50:51]
    s_branch L2_d110
L2_c111:
    s_lshl_b64 s[52:53], s[82:83], 1
    s_andn2_b64 s[52:53], s[52:53], s[80:81]
    s_andn2_b64 s[52:53], s[52:53], s[54:55]
    s_or_b64 s[80:81], s[80:81], s[52:53]
    s_not_b64 vcc, s[52:53]
    s_mov_b64 exec, -1
    v_cndmask_b32_dpp v84, v84, v84, vcc wave_shr:1 row_mask:0xf bank_mask:0xf
    v_cndmask_b32_dpp v85, v85, v85, vcc wave_shr:1 row_mask:0xf bank_mask:0xf
    s_lshr_b64 s[52:53], s[52:53], 1
    v_cndmask_b32_dpp v86, v86, v86, vcc wave_shr:1 row_mask:0xf bank_mask:0xf
    v_cndmask_b32_dpp v87, v87, v87, vcc wave_shr:1 row_mask:0xf bank_mask:0xf
    s_andn2_b64 s[82:83], s[82:83], s[52:53]
    v_cndmask_b32_dpp v7, v7, v7, vcc wave_shr:1 row_mask:0xf bank_mask:0xf
    s_mov_b64 exec, s[54:55]
    s_cbranch_scc0 L2_d111
    s_mov_b64 exec, s[82:83]
    s_nop 1
    v_mfma_f32_4x4x4_16b_bf16 v[88:91], v[12:13], v[84:85], 0
    s_nop 1
    v_mfma_f32_4x4x4_16b_bf16 v[88:91], v[10:11], v[86:87], v[88:91]
    s_nop 4
    v_cvt_pk_bf16_f32 v88, v88, v89
    v_cvt_pk_bf16_f32 v89, v90, v91
    ds_pk_add_bf16 v7, v88 offset:65408
    ds_pk_add_bf16 v7, v89 offset:65412
    s_mov_b64 exec, s[54:55]
    s_branch L2_d111
L2_c112:
    s_lshl_b64 s[52:53], s[82:83], 1
    s_andn2_b64 s[52:53], s[52:53], s[80:81]
    s_andn2_b64 s[52:53], s[52:53], s[50:51]
    s_or_b64 s[80:81], s[80:81], s[52:53]
    s_not_b64 vcc, s[52:53]
    s_mov_b64 exec, -1
    v_cndmask_b32_dpp v84, v84, v84, vcc wave_shr:1 row_mask:0xf bank_mask:0xf
    v_cndmask_b32_dpp v85, v85, v85, vcc wave_shr:1 row_mask:0xf bank_mask:0xf
    s_lshr_b64 s[52:53], s[52:53], 1
    v_cndmask_b32_dpp v86, v86, v86, vcc wave_shr:1 row_mask:0xf bank_mask:0xf
    v_cndmask_b32_dpp v87, v87, v87, vcc wave_shr:1 row_mask:0xf bank_mask:0xf
    s_andn2_b64 s[82:83], s[82:83], s[52:53]
    v_cndmask_b32_dpp v7, v7, v7, vcc wave_shr:1 row_mask:0xf bank_mask:0xf
    s_mov_b64 exec, s[50:51]
    s_cbranch_scc0 L2_d112
    s_mov_b64 exec, s[82:83]
    s_nop 1
    v_mfma_f32_4x4x4_16b_bf16 v[88:91], v[12:13], v[84:85], 0
    s_nop 1
    v_mfma_f32_4x4x4_16b_bf16 v[88:91], v[10:11], v[86:87], v[88:91]
    s_nop 4
    v_cvt_pk_bf16_f32 v88, v88, v89
    v_cvt_pk_bf16_f32 v89, v90, v91
    ds_pk_add_bf16 v7, v88 offset:65408
    ds_pk_add_bf16 v7, v89 offset:65412
    s_mov_b64 exec, s[50:51]
    s_branch L2_d112
L2_c113:
    s_lshl_b64 s[52:53], s[82:83], 1
    s_andn2_b64 s[52:53], s[52:53], s[80:81]
    s_andn2_b64 s[52:53], s[52:53], s[54:55]
    s_or_b64 s[80:81], s[80:81], s[52:53]
    s_not_b64 vcc, s[52:53]
    s_mov_b64 exec, -1
    v_cndmask_b32_dpp v84, v84, v84, vcc wave_shr:1 row_mask:0xf bank_mask:0xf
    v_cndmask_b32_dpp v85, v85, v85, vcc wave_shr:1 row_mask:0xf bank_mask:0xf
    s_lshr_b64 s[52:53], s[52:53], 1
    v_cndmask_b32_dpp v86, v86, v86, vcc wave_shr:1 row_mask:0xf bank_mask:0xf
    v_cndmask_b32_dpp v87, v87, v87, vcc wave_shr:1 row_mask:0xf bank_mask:0xf
    s_andn2_b64 s[82:83], s[82:83], s[52:53]
    v_cndmask_b32_dpp v7, v7, v7, vcc wave_shr:1 row_mask:0xf bank_mask:0xf
    s_mov_b64 exec, s[54:55]
    s_cbranch_scc0 L2_d113
    s_mov_b64 exec, s[82:83]
    s_nop 1
    v_mfma_f32_4x4x4_16b_bf16 v[88:91], v[12:13], v[84:85], 0
    s_nop 1
    v_mfma_f32_4x4x4_16b_bf16 v[88:91], v[10:11], v[86:87], v[88:91]
    s_nop 4
    v_cvt_pk_bf16_f32 v88, v88, v89
    v_cvt_pk_bf16_f32 v89, v90, v91
    ds_pk_add_bf16 v7, v88 offset:65408
    ds_pk_add_bf16 v7, v89 offset:65412
    s_mov_b64 exec, s[54:55]
    s_branch L2_d113
L2_c114:
    s_lshl_b64 s[52:53], s[82:83], 1
    s_andn2_b64 s[52:53], s[52:53], s[80:81]
    s_andn2_b64 s[52:53], s[52:53], s[50:51]
    s_or_b64 s[80:81], s[80:81], s[52:53]
    s_not_b64 vcc, s[52:53]
    s_mov_b64 exec, -1
    v_cndmask_b32_dpp v84, v84, v84, vcc wave_shr:1 row_mask:0xf bank_mask:0xf
    v_cndmask_b32_dpp v85, v85, v85, vcc wave_shr:1 row_mask:0xf bank_mask:0xf
    s_lshr_b64 s[52:53], s[52:53], 1
    v_cndmask_b32_dpp v86, v86, v86, vcc wave_shr:1 row_mask:0xf bank_mask:0xf
    v_cndmask_b32_dpp v87, v87, v87, vcc wave_shr:1 row_mask:0xf bank_mask:0xf
    s_andn2_b64 s[82:83], s[82:83], s[52:53]
    v_cndmask_b32_dpp v7, v7, v7, vcc wave_shr:1 row_mask:0xf bank_mask:0xf
    s_mov_b64 exec, s[50:51]
    s_cbranch_scc0 L2_d114
    s_mov_b64 exec, s[82:83]
    s_nop 1
    v_mfma_f32_4x4x4_16b_bf16 v[88:91], v[12:13], v[84:85], 0
    s_nop 1
    v_mfma_f32_4x4x4_16b_bf16 v[88:91], v[10:11], v[86:87], v[88:91]
    s_nop 4
    v_cvt_pk_bf16_f32 v88, v88, v89
    v_cvt_pk_bf16_f32 v89, v90, v91
    ds_pk_add_bf16 v7, v88 offset:65408
    ds_pk_add_bf16 v7, v89 offset:65412
    s_mov_b64 exec, s[50:51]
    s_branch L2_d114
L2_xa115:
    s_cmp_eq_u32 s101, 1
    s_cbranch_scc1 L2_xc115
    v_lshlrev_b32 v89, 0, v96
    v_add_u32 v90, 140, v97
    v_bitop3_b32 v90, v89, v45, v90 bitop3:0x6a
    ds_write_b32 v98, v90 offset:28
    v_lshlrev_b32 v89, 4, v96
    v_add_u32 v90, 120, v97
    v_bitop3_b32 v90, v89, v45, v90 bitop3:0x6a
    ds_write_b32 v98, v90 offset:24
    v_lshlrev_b32 v89, 8, v96
    v_add_u32 v90, 100, v97
    v_bitop3_b32 v90, v89, v45, v90 bitop3:0x6a
    ds_write_b32 v98, v90 offset:20
L2_xc115:
    v_lshlrev_b32 v89, 12, v96
    v_add_u32 v90, 80, v97
    v_bitop3_b32 v90, v89, v45, v90 bitop3:0x6a
    ds_write_b32 v98, v90 offset:16
    s_branch L2_xb115
L2_xe115:
    v_cmp_lt_u32 vcc, 32, v99
    v_cmp_lt_u32 s[58:59], 31, v88
    v_lshrrev_b32 v89, 16, v96
    v_add_u32 v97, 80, v97
    s_or_b64 vcc, vcc, s[58:59]
    s_cbranch_scc1 L2_xs115
    v_lshlrev_b32 v89, v1, v89
    v_and_b32 v89, v45, v89
    v_cmp_ne_u32 vcc, 0, v89
    v_xor_b32 v90, v97, v89
    s_add_u32 s3, s37, s38
    v_mbcnt_lo_u32_b32 v98, vcc_lo, 0
    v_mbcnt_hi_u32_b32 v98, vcc_hi, v98
    s_bcnt1_i32_b64 s41, vcc
    v_lshl_add_u32 v98, v98, 2, s3
    s_lshl2_add_u32 s37, s41, s37
    s_mov_b64 exec, vcc
    ds_write_b32 v98, v90
    s_mov_b64 exec, -1
    s_branch L2_xr115
L2_xs115:
    s_waitcnt lgkmcnt(0)
    s_mov_b32 s37, 0x10000
    s_branch L2_xw115
L2_c116:
    s_lshl_b64 s[52:53], s[82:83], 1
    s_andn2_b64 s[52:53], s[52:53], s[80:81]
    s_andn2_b64 s[52:53], s[52:53], s[54:55]
    s_or_b64 s[80:81], s[80:81], s[52:53]
    s_not_b64 vcc, s[52:53]
    s_mov_b64 exec, -1
    v_cndmask_b32_dpp v84, v84, v84, vcc wave_shr:1 row_mask:0xf bank_mask:0xf
    v_cndmask_b32_dpp v85, v85, v85, vcc wave_shr:1 row_mask:0xf bank_mask:0xf
    s_lshr_b64 s[52:53], s[52:53], 1
    v_cndmask_b32_dpp v86, v86, v86, vcc wave_shr:1 row_mask:0xf bank_mask:0xf
    v_cndmask_b32_dpp v87, v87, v87, vcc wave_shr:1 row_mask:0xf bank_mask:0xf
    s_andn2_b64 s[82:83], s[82:83], s[52:53]
    v_cndmask_b32_dpp v7, v7, v7, vcc wave_shr:1 row_mask:0xf bank_mask:0xf
    s_mov_b64 exec, s[54:55]
    s_cbranch_scc0 L2_d116
    s_mov_b64 exec, s[82:83]
    s_nop 1
    v_mfma_f32_4x4x4_16b_bf16 v[88:91], v[12:13], v[84:85], 0
    s_nop 1
    v_mfma_f32_4x4x4_16b_bf16 v[88:91], v[10:11], v[86:87], v[88:91]
    s_nop 4
    v_cvt_pk_bf16_f32 v88, v88, v89
    v_cvt_pk_bf16_f32 v89, v90, v91
    ds_pk_add_bf16 v7, v88 offset:65408
    ds_pk_add_bf16 v7, v89 offset:65412
    s_mov_b64 exec, s[54:55]
    s_branch L2_d116
L2_c117:
    s_lshl_b64 s[52:53], s[82:83], 1
    s_andn2_b64 s[52:53], s[52:53], s[80:81]
    s_andn2_b64 s[52:53], s[52:53], s[50:51]
    s_or_b64 s[80:81], s[80:81], s[52:53]
    s_not_b64 vcc, s[52:53]
    s_mov_b64 exec, -1
    v_cndmask_b32_dpp v84, v84, v84, vcc wave_shr:1 row_mask:0xf bank_mask:0xf
    v_cndmask_b32_dpp v85, v85, v85, vcc wave_shr:1 row_mask:0xf bank_mask:0xf
    s_lshr_b64 s[52:53], s[52:53], 1
    v_cndmask_b32_dpp v86, v86, v86, vcc wave_shr:1 row_mask:0xf bank_mask:0xf
    v_cndmask_b32_dpp v87, v87, v87, vcc wave_shr:1 row_mask:0xf bank_mask:0xf
    s_andn2_b64 s[82:83], s[82:83], s[52:53]
    v_cndmask_b32_dpp v7, v7, v7, vcc wave_shr:1 row_mask:0xf bank_mask:0xf
    s_mov_b64 exec, s[50:51]
    s_cbranch_scc0 L2_d117
    s_mov_b64 exec, s[82:83]
    s_nop 1
    v_mfma_f32_4x4x4_16b_bf16 v[88:91], v[12:13], v[84:85], 0
    s_nop 1
    v_mfma_f32_4x4x4_16b_bf16 v[88:91], v[10:11], v[86:87], v[88:91]
    s_nop 4
    v_cvt_pk_bf16_f32 v88, v88, v89
    v_cvt_pk_bf16_f32 v89, v90, v91
    ds_pk_add_bf16 v7, v88 offset:65408
    ds_pk_add_bf16 v7, v89 offset:65412
    s_mov_b64 exec, s[50:51]
    s_branch L2_d117
L2_xf115:
    s_cmp_gt_u32 s37, 1024
    s_cbranch_scc1 L2_xt115
    s_cmp_lt_u32 s37, 768
    s_cbranch_scc1 L2_xl115
    ds_read_b32 v33, v44 offset:896
    s_add_u32 s3, s42, 2
    s_bitset1_b32 s43, s3
    s_branch L2_xg115
L2_xl115:
    s_waitcnt lgkmcnt(0)
    v_mov_b32 v42, -1
    s_cmp_ge_u32 s37, 512
    s_cbranch_scc1 L2_xg115
    v_mov_b32 v43, -1
    s_cmp_ge_u32 s37, 256
    s_cbranch_scc1 L2_xg115
    v_mov_b32 v41, -1
    s_branch L2_xg115
L2_xt115:
    s_waitcnt lgkmcnt(0)
    v_mov_b32 v40, -1
    v_mov_b32 v41, -1
    v_mov_b32 v43, -1
    v_mov_b32 v42, -1
    s_add_u32 s3, s42, 2
    s_bitset1_b32 s36, s3
    s_branch L2_xg115
L2_oa118:
    v_and_b32 v47, 0x0fffffff, v32
    buffer_load_dword v114, v47, s[8:11], 0 offen offset:16
    s_mov_b64 exec, s[6:7]
    v_add_u32 v47, 8, v47
    v_lshrrev_b32 v32, 2, v32
    s_mov_b64 exec, -1
    buffer_load_dwordx2 v[112:113], v47, s[8:11], 0 offen
    s_branch L2_ob118
L2_c119:
    s_lshl_b64 s[52:53], s[82:83], 1
    s_andn2_b64 s[52:53], s[52:53], s[80:81]
    s_andn2_b64 s[52:53], s[52:53], s[54:55]
    s_or_b64 s[80:81], s[80:81], s[52:53]
    s_not_b64 vcc, s[52:53]
    s_mov_b64 exec, -1
    v_cndmask_b32_dpp v84, v84, v84, vcc wave_shr:1 row_mask:0xf bank_mask:0xf
    v_cndmask_b32_dpp v85, v85, v85, vcc wave_shr:1 row_mask:0xf bank_mask:0xf
    s_lshr_b64 s[52:53], s[52:53], 1
    v_cndmask_b32_dpp v86, v86, v86, vcc wave_shr:1 row_mask:0xf bank_mask:0xf
    v_cndmask_b32_dpp v87, v87, v87, vcc wave_shr:1 row_mask:0xf bank_mask:0xf
    s_andn2_b64 s[82:83], s[82:83], s[52:53]
    v_cndmask_b32_dpp v7, v7, v7, vcc wave_shr:1 row_mask:0xf bank_mask:0xf
    s_mov_b64 exec, s[54:55]
    s_cbranch_scc0 L2_d119
    s_mov_b64 exec, s[82:83]
    s_nop 1
    v_mfma_f32_4x4x4_16b_bf16 v[88:91], v[12:13], v[84:85], 0
    s_nop 1
    v_mfma_f32_4x4x4_16b_bf16 v[88:91], v[10:11], v[86:87], v[88:91]
    s_nop 4
    v_cvt_pk_bf16_f32 v88, v88, v89
    v_cvt_pk_bf16_f32 v89, v90, v91
    ds_pk_add_bf16 v7, v88 offset:65408
    ds_pk_add_bf16 v7, v89 offset:65412
    s_mov_b64 exec, s[54:55]
    s_branch L2_d119
L2_c120:
    s_lshl_b64 s[52:53], s[82:83], 1
    s_andn2_b64 s[52:53], s[52:53], s[80:81]
    s_andn2_b64 s[52:53], s[52:53], s[50:51]
    s_or_b64 s[80:81], s[80:81], s[52:53]
    s_not_b64 vcc, s[52:53]
    s_mov_b64 exec, -1
    v_cndmask_b32_dpp v84, v84, v84, vcc wave_shr:1 row_mask:0xf bank_mask:0xf
    v_cndmask_b32_dpp v85, v85, v85, vcc wave_shr:1 row_mask:0xf bank_mask:0xf
    s_lshr_b64 s[52:53], s[52:53], 1
    v_cndmask_b32_dpp v86, v86, v86, vcc wave_shr:1 row_mask:0xf bank_mask:0xf
    v_cndmask_b32_dpp v87, v87, v87, vcc wave_shr:1 row_mask:0xf bank_mask:0xf
    s_andn2_b64 s[82:83], s[82:83], s[52:53]
    v_cndmask_b32_dpp v7, v7, v7, vcc wave_shr:1 row_mask:0xf bank_mask:0xf
    s_mov_b64 exec, s[50:51]
    s_cbranch_scc0 L2_d120
    s_mov_b64 exec, s[82:83]
    s_nop 1
    v_mfma_f32_4x4x4_16b_bf16 v[88:91], v[12:13], v[84:85], 0
    s_nop 1
    v_mfma_f32_4x4x4_16b_bf16 v[88:91], v[10:11], v[86:87], v[88:91]
    s_nop 4
    v_cvt_pk_bf16_f32 v88, v88, v89
    v_cvt_pk_bf16_f32 v89, v90, v91
    ds_pk_add_bf16 v7, v88 offset:65408
    ds_pk_add_bf16 v7, v89 offset:65412
    s_mov_b64 exec, s[50:51]
    s_branch L2_d120
L2_c121:
    s_lshl_b64 s[52:53], s[82:83], 1
    s_andn2_b64 s[52:53], s[52:53], s[80:81]
    s_andn2_b64 s[52:53], s[52:53], s[54:55]
    s_or_b64 s[80:81], s[80:81], s[52:53]
    s_not_b64 vcc, s[52:53]
    s_mov_b64 exec, -1
    v_cndmask_b32_dpp v84, v84, v84, vcc wave_shr:1 row_mask:0xf bank_mask:0xf
    v_cndmask_b32_dpp v85, v85, v85, vcc wave_shr:1 row_mask:0xf bank_mask:0xf
    s_lshr_b64 s[52:53], s[52:53], 1
    v_cndmask_b32_dpp v86, v86, v86, vcc wave_shr:1 row_mask:0xf bank_mask:0xf
    v_cndmask_b32_dpp v87, v87, v87, vcc wave_shr:1 row_mask:0xf bank_mask:0xf
    s_andn2_b64 s[82:83], s[82:83], s[52:53]
    v_cndmask_b32_dpp v7, v7, v7, vcc wave_shr:1 row_mask:0xf bank_mask:0xf
    s_mov_b64 exec, s[54:55]
    s_cbranch_scc0 L2_d121
    s_mov_b64 exec, s[82:83]
    s_nop 1
    v_mfma_f32_4x4x4_16b_bf16 v[88:91], v[12:13], v[84:85], 0
    s_nop 1
    v_mfma_f32_4x4x4_16b_bf16 v[88:91], v[10:11], v[86:87], v[88:91]
    s_nop 4
    v_cvt_pk_bf16_f32 v88, v88, v89
    v_cvt_pk_bf16_f32 v89, v90, v91
    ds_pk_add_bf16 v7, v88 offset:65408
    ds_pk_add_bf16 v7, v89 offset:65412
    s_mov_b64 exec, s[54:55]
    s_branch L2_d121
L2_c122:
    s_lshl_b64 s[52:53], s[82:83], 1
    s_andn2_b64 s[52:53], s[52:53], s[80:81]
    s_andn2_b64 s[52:53], s[52:53], s[50:51]
    s_or_b64 s[80:81], s[80:81], s[52:53]
    s_not_b64 vcc, s[52:53]
    s_mov_b64 exec, -1
    v_cndmask_b32_dpp v84, v84, v84, vcc wave_shr:1 row_mask:0xf bank_mask:0xf
    v_cndmask_b32_dpp v85, v85, v85, vcc wave_shr:1 row_mask:0xf bank_mask:0xf
    s_lshr_b64 s[52:53], s[52:53], 1
    v_cndmask_b32_dpp v86, v86, v86, vcc wave_shr:1 row_mask:0xf bank_mask:0xf
    v_cndmask_b32_dpp v87, v87, v87, vcc wave_shr:1 row_mask:0xf bank_mask:0xf
    s_andn2_b64 s[82:83], s[82:83], s[52:53]
    v_cndmask_b32_dpp v7, v7, v7, vcc wave_shr:1 row_mask:0xf bank_mask:0xf
    s_mov_b64 exec, s[50:51]
    s_cbranch_scc0 L2_d122
    s_mov_b64 exec, s[82:83]
    s_nop 1
    v_mfma_f32_4x4x4_16b_bf16 v[88:91], v[12:13], v[84:85], 0
    s_nop 1
    v_mfma_f32_4x4x4_16b_bf16 v[88:91], v[10:11], v[86:87], v[88:91]
    s_nop 4
    v_cvt_pk_bf16_f32 v88, v88, v89
    v_cvt_pk_bf16_f32 v89, v90, v91
    ds_pk_add_bf16 v7, v88 offset:65408
    ds_pk_add_bf16 v7, v89 offset:65412
    s_mov_b64 exec, s[50:51]
    s_branch L2_d122
L2_c123:
    s_lshl_b64 s[52:53], s[82:83], 1
    s_andn2_b64 s[52:53], s[52:53], s[80:81]
    s_andn2_b64 s[52:53], s[52:53], s[54:55]
    s_or_b64 s[80:81], s[80:81], s[52:53]
    s_not_b64 vcc, s[52:53]
    s_mov_b64 exec, -1
    v_cndmask_b32_dpp v84, v84, v84, vcc wave_shr:1 row_mask:0xf bank_mask:0xf
    v_cndmask_b32_dpp v85, v85, v85, vcc wave_shr:1 row_mask:0xf bank_mask:0xf
    s_lshr_b64 s[52:53], s[52:53], 1
    v_cndmask_b32_dpp v86, v86, v86, vcc wave_shr:1 row_mask:0xf bank_mask:0xf
    v_cndmask_b32_dpp v87, v87, v87, vcc wave_shr:1 row_mask:0xf bank_mask:0xf
    s_andn2_b64 s[82:83], s[82:83], s[52:53]
    v_cndmask_b32_dpp v7, v7, v7, vcc wave_shr:1 row_mask:0xf bank_mask:0xf
    s_mov_b64 exec, s[54:55]
    s_cbranch_scc0 L2_d123
    s_mov_b64 exec, s[82:83]
    s_nop 1
    v_mfma_f32_4x4x4_16b_bf16 v[88:91], v[12:13], v[84:85], 0
    s_nop 1
    v_mfma_f32_4x4x4_16b_bf16 v[88:91], v[10:11], v[86:87], v[88:91]
    s_nop 4
    v_cvt_pk_bf16_f32 v88, v88, v89
    v_cvt_pk_bf16_f32 v89, v90, v91
    ds_pk_add_bf16 v7, v88 offset:65408
    ds_pk_add_bf16 v7, v89 offset:65412
    s_mov_b64 exec, s[54:55]
    s_branch L2_d123
L2_c124:
    s_lshl_b64 s[52:53], s[82:83], 1
    s_andn2_b64 s[52:53], s[52:53], s[80:81]
    s_andn2_b64 s[52:53], s[52:53], s[50:51]
    s_or_b64 s[80:81], s[80:81], s[52:53]
    s_not_b64 vcc, s[52:53]
    s_mov_b64 exec, -1
    v_cndmask_b32_dpp v84, v84, v84, vcc wave_shr:1 row_mask:0xf bank_mask:0xf
    v_cndmask_b32_dpp v85, v85, v85, vcc wave_shr:1 row_mask:0xf bank_mask:0xf
    s_lshr_b64 s[52:53], s[52:53], 1
    v_cndmask_b32_dpp v86, v86, v86, vcc wave_shr:1 row_mask:0xf bank_mask:0xf
    v_cndmask_b32_dpp v87, v87, v87, vcc wave_shr:1 row_mask:0xf bank_mask:0xf
    s_andn2_b64 s[82:83], s[82:83], s[52:53]
    v_cndmask_b32_dpp v7, v7, v7, vcc wave_shr:1 row_mask:0xf bank_mask:0xf
    s_mov_b64 exec, s[50:51]
    s_cbranch_scc0 L2_d124
    s_mov_b64 exec, s[82:83]
    s_nop 1
    v_mfma_f32_4x4x4_16b_bf16 v[88:91], v[12:13], v[84:85], 0
    s_nop 1
    v_mfma_f32_4x4x4_16b_bf16 v[88:91], v[10:11], v[86:87], v[88:91]
    s_nop 4
    v_cvt_pk_bf16_f32 v88, v88, v89
    v_cvt_pk_bf16_f32 v89, v90, v91
    ds_pk_add_bf16 v7, v88 offset:65408
    ds_pk_add_bf16 v7, v89 offset:65412
    s_mov_b64 exec, s[50:51]
    s_branch L2_d124
L2_oa125:
    s_waitcnt vmcnt(3)
    s_mov_b64 exec, s[6:7]
    v_lshrrev_b32 v114, 16, v114
    s_mov_b64 exec, -1
    v_and_b32 v46, 0x10000000, v32
    v_cmpx_eq_u32 vcc, 0, v46
    v_lshrrev_b32 v47, 14, v112
    v_and_b32 v47, v5, v47
    ds_read_b64 v[96:97], v47
    v_perm_b32 v98, v112, v114, s44
    v_bitop3_b32 v99, v112, 0.5, -0.5 bitop3:0xa8
    v_bitop3_b32 v98, v6, v98, v99 bitop3:0xca
    v_and_b32 v47, v5, v112
    s_waitcnt lgkmcnt(0)
    v_mfma_f32_4x4x4_16b_bf16 v[88:91], v[8:9], v[96:97], 0
    s_nop 4
    v_mul_f32 v88, v98, v88
    v_mul_f32 v89, v98, v89
    v_mul_f32 v90, v98, v90
    v_mul_f32 v91, v98, v91
    v_cvt_pk_bf16_f32 v88, v88, v89
    v_cvt_pk_bf16_f32 v89, v90, v91
    ds_pk_add_bf16 v47, v88 offset:65408
    ds_pk_add_bf16 v47, v89 offset:65412
    s_mov_b64 exec, -1
    v_and_b32 v46, 0x20000000, v32
    v_cmpx_eq_u32 vcc, 0, v46
    v_lshrrev_b32 v47, 14, v113
    v_and_b32 v47, v5, v47
    ds_read_b64 v[96:97], v47
    v_perm_b32 v98, v113, v114, s45
    v_bitop3_b32 v99, v113, 0.5, -0.5 bitop3:0xa8
    v_bitop3_b32 v98, v6, v98, v99 bitop3:0xca
    v_and_b32 v47, v5, v113
    s_waitcnt lgkmcnt(0)
    v_mfma_f32_4x4x4_16b_bf16 v[88:91], v[8:9], v[96:97], 0
    s_nop 4
    v_mul_f32 v88, v98, v88
    v_mul_f32 v89, v98, v89
    v_mul_f32 v90, v98, v90
    v_mul_f32 v91, v98, v91
    v_cvt_pk_bf16_f32 v88, v88, v89
    v_cvt_pk_bf16_f32 v89, v90, v91
    ds_pk_add_bf16 v47, v88 offset:65408
    ds_pk_add_bf16 v47, v89 offset:65412
    s_mov_b64 exec, -1
    s_branch L2_ob125
L2_c126:
    s_lshl_b64 s[52:53], s[82:83], 1
    s_andn2_b64 s[52:53], s[52:53], s[80:81]
    s_andn2_b64 s[52:53], s[52:53], s[54:55]
    s_or_b64 s[80:81], s[80:81], s[52:53]
    s_not_b64 vcc, s[52:53]
    s_mov_b64 exec, -1
    v_cndmask_b32_dpp v84, v84, v84, vcc wave_shr:1 row_mask:0xf bank_mask:0xf
    v_cndmask_b32_dpp v85, v85, v85, vcc wave_shr:1 row_mask:0xf bank_mask:0xf
    s_lshr_b64 s[52:53], s[52:53], 1
    v_cndmask_b32_dpp v86, v86, v86, vcc wave_shr:1 row_mask:0xf bank_mask:0xf
    v_cndmask_b32_dpp v87, v87, v87, vcc wave_shr:1 row_mask:0xf bank_mask:0xf
    s_andn2_b64 s[82:83], s[82:83], s[52:53]
    v_cndmask_b32_dpp v7, v7, v7, vcc wave_shr:1 row_mask:0xf bank_mask:0xf
    s_mov_b64 exec, s[54:55]
    s_cbranch_scc0 L2_d126
    s_mov_b64 exec, s[82:83]
    s_nop 1
    v_mfma_f32_4x4x4_16b_bf16 v[88:91], v[12:13], v[84:85], 0
    s_nop 1
    v_mfma_f32_4x4x4_16b_bf16 v[88:91], v[10:11], v[86:87], v[88:91]
    s_nop 4
    v_cvt_pk_bf16_f32 v88, v88, v89
    v_cvt_pk_bf16_f32 v89, v90, v91
    ds_pk_add_bf16 v7, v88 offset:65408
    ds_pk_add_bf16 v7, v89 offset:65412
    s_mov_b64 exec, s[54:55]
    s_branch L2_d126
L2_c127:
    s_lshl_b64 s[52:53], s[82:83], 1
    s_andn2_b64 s[52:53], s[52:53], s[80:81]
    s_andn2_b64 s[52:53], s[52:53], s[50:51]
    s_or_b64 s[80:81], s[80:81], s[52:53]
    s_not_b64 vcc, s[52:53]
    s_mov_b64 exec, -1
    v_cndmask_b32_dpp v84, v84, v84, vcc wave_shr:1 row_mask:0xf bank_mask:0xf
    v_cndmask_b32_dpp v85, v85, v85, vcc wave_shr:1 row_mask:0xf bank_mask:0xf
    s_lshr_b64 s[52:53], s[52:53], 1
    v_cndmask_b32_dpp v86, v86, v86, vcc wave_shr:1 row_mask:0xf bank_mask:0xf
    v_cndmask_b32_dpp v87, v87, v87, vcc wave_shr:1 row_mask:0xf bank_mask:0xf
    s_andn2_b64 s[82:83], s[82:83], s[52:53]
    v_cndmask_b32_dpp v7, v7, v7, vcc wave_shr:1 row_mask:0xf bank_mask:0xf
    s_mov_b64 exec, s[50:51]
    s_cbranch_scc0 L2_d127
    s_mov_b64 exec, s[82:83]
    s_nop 1
    v_mfma_f32_4x4x4_16b_bf16 v[88:91], v[12:13], v[84:85], 0
    s_nop 1
    v_mfma_f32_4x4x4_16b_bf16 v[88:91], v[10:11], v[86:87], v[88:91]
    s_nop 4
    v_cvt_pk_bf16_f32 v88, v88, v89
    v_cvt_pk_bf16_f32 v89, v90, v91
    ds_pk_add_bf16 v7, v88 offset:65408
    ds_pk_add_bf16 v7, v89 offset:65412
    s_mov_b64 exec, s[50:51]
    s_branch L2_d127
L2_c128:
    s_lshl_b64 s[52:53], s[82:83], 1
    s_andn2_b64 s[52:53], s[52:53], s[80:81]
    s_andn2_b64 s[52:53], s[52:53], s[54:55]
    s_or_b64 s[80:81], s[80:81], s[52:53]
    s_not_b64 vcc, s[52:53]
    s_mov_b64 exec, -1
    v_cndmask_b32_dpp v84, v84, v84, vcc wave_shr:1 row_mask:0xf bank_mask:0xf
    v_cndmask_b32_dpp v85, v85, v85, vcc wave_shr:1 row_mask:0xf bank_mask:0xf
    s_lshr_b64 s[52:53], s[52:53], 1
    v_cndmask_b32_dpp v86, v86, v86, vcc wave_shr:1 row_mask:0xf bank_mask:0xf
    v_cndmask_b32_dpp v87, v87, v87, vcc wave_shr:1 row_mask:0xf bank_mask:0xf
    s_andn2_b64 s[82:83], s[82:83], s[52:53]
    v_cndmask_b32_dpp v7, v7, v7, vcc wave_shr:1 row_mask:0xf bank_mask:0xf
    s_mov_b64 exec, s[54:55]
    s_cbranch_scc0 L2_d128
    s_mov_b64 exec, s[82:83]
    s_nop 1
    v_mfma_f32_4x4x4_16b_bf16 v[88:91], v[12:13], v[84:85], 0
    s_nop 1
    v_mfma_f32_4x4x4_16b_bf16 v[88:91], v[10:11], v[86:87], v[88:91]
    s_nop 4
    v_cvt_pk_bf16_f32 v88, v88, v89
    v_cvt_pk_bf16_f32 v89, v90, v91
    ds_pk_add_bf16 v7, v88 offset:65408
    ds_pk_add_bf16 v7, v89 offset:65412
    s_mov_b64 exec, s[54:55]
    s_branch L2_d128
L2_c129:
    s_lshl_b64 s[52:53], s[82:83], 1
    s_andn2_b64 s[52:53], s[52:53], s[80:81]
    s_andn2_b64 s[52:53], s[52:53], s[50:51]
    s_or_b64 s[80:81], s[80:81], s[52:53]
    s_not_b64 vcc, s[52:53]
    s_mov_b64 exec, -1
    v_cndmask_b32_dpp v84, v84, v84, vcc wave_shr:1 row_mask:0xf bank_mask:0xf
    v_cndmask_b32_dpp v85, v85, v85, vcc wave_shr:1 row_mask:0xf bank_mask:0xf
    s_lshr_b64 s[52:53], s[52:53], 1
    v_cndmask_b32_dpp v86, v86, v86, vcc wave_shr:1 row_mask:0xf bank_mask:0xf
    v_cndmask_b32_dpp v87, v87, v87, vcc wave_shr:1 row_mask:0xf bank_mask:0xf
    s_andn2_b64 s[82:83], s[82:83], s[52:53]
    v_cndmask_b32_dpp v7, v7, v7, vcc wave_shr:1 row_mask:0xf bank_mask:0xf
    s_mov_b64 exec, s[50:51]
    s_cbranch_scc0 L2_d129
    s_mov_b64 exec, s[82:83]
    s_nop 1
    v_mfma_f32_4x4x4_16b_bf16 v[88:91], v[12:13], v[84:85], 0
    s_nop 1
    v_mfma_f32_4x4x4_16b_bf16 v[88:91], v[10:11], v[86:87], v[88:91]
    s_nop 4
    v_cvt_pk_bf16_f32 v88, v88, v89
    v_cvt_pk_bf16_f32 v89, v90, v91
    ds_pk_add_bf16 v7, v88 offset:65408
    ds_pk_add_bf16 v7, v89 offset:65412
    s_mov_b64 exec, s[50:51]
    s_branch L2_d129
L2_c130:
    s_lshl_b64 s[52:53], s[82:83], 1
    s_andn2_b64 s[52:53], s[52:53], s[80:81]
    s_andn2_b64 s[52:53], s[52:53], s[54:55]
    s_or_b64 s[80:81], s[80:81], s[52:53]
    s_not_b64 vcc, s[52:53]
    s_mov_b64 exec, -1
    v_cndmask_b32_dpp v84, v84, v84, vcc wave_shr:1 row_mask:0xf bank_mask:0xf
    v_cndmask_b32_dpp v85, v85, v85, vcc wave_shr:1 row_mask:0xf bank_mask:0xf
    s_lshr_b64 s[52:53], s[52:53], 1
    v_cndmask_b32_dpp v86, v86, v86, vcc wave_shr:1 row_mask:0xf bank_mask:0xf
    v_cndmask_b32_dpp v87, v87, v87, vcc wave_shr:1 row_mask:0xf bank_mask:0xf
    s_andn2_b64 s[82:83], s[82:83], s[52:53]
    v_cndmask_b32_dpp v7, v7, v7, vcc wave_shr:1 row_mask:0xf bank_mask:0xf
    s_mov_b64 exec, s[54:55]
    s_cbranch_scc0 L2_d130
    s_mov_b64 exec, s[82:83]
    s_nop 1
    v_mfma_f32_4x4x4_16b_bf16 v[88:91], v[12:13], v[84:85], 0
    s_nop 1
    v_mfma_f32_4x4x4_16b_bf16 v[88:91], v[10:11], v[86:87], v[88:91]
    s_nop 4
    v_cvt_pk_bf16_f32 v88, v88, v89
    v_cvt_pk_bf16_f32 v89, v90, v91
    ds_pk_add_bf16 v7, v88 offset:65408
    ds_pk_add_bf16 v7, v89 offset:65412
    s_mov_b64 exec, s[54:55]
    s_branch L2_d130
L2_c131:
    s_lshl_b64 s[52:53], s[82:83], 1
    s_andn2_b64 s[52:53], s[52:53], s[80:81]
    s_andn2_b64 s[52:53], s[52:53], s[50:51]
    s_or_b64 s[80:81], s[80:81], s[52:53]
    s_not_b64 vcc, s[52:53]
    s_mov_b64 exec, -1
    v_cndmask_b32_dpp v84, v84, v84, vcc wave_shr:1 row_mask:0xf bank_mask:0xf
    v_cndmask_b32_dpp v85, v85, v85, vcc wave_shr:1 row_mask:0xf bank_mask:0xf
    s_lshr_b64 s[52:53], s[52:53], 1
    v_cndmask_b32_dpp v86, v86, v86, vcc wave_shr:1 row_mask:0xf bank_mask:0xf
    v_cndmask_b32_dpp v87, v87, v87, vcc wave_shr:1 row_mask:0xf bank_mask:0xf
    s_andn2_b64 s[82:83], s[82:83], s[52:53]
    v_cndmask_b32_dpp v7, v7, v7, vcc wave_shr:1 row_mask:0xf bank_mask:0xf
    s_mov_b64 exec, s[50:51]
    s_cbranch_scc0 L2_d131
    s_mov_b64 exec, s[82:83]
    s_nop 1
    v_mfma_f32_4x4x4_16b_bf16 v[88:91], v[12:13], v[84:85], 0
    s_nop 1
    v_mfma_f32_4x4x4_16b_bf16 v[88:91], v[10:11], v[86:87], v[88:91]
    s_nop 4
    v_cvt_pk_bf16_f32 v88, v88, v89
    v_cvt_pk_bf16_f32 v89, v90, v91
    ds_pk_add_bf16 v7, v88 offset:65408
    ds_pk_add_bf16 v7, v89 offset:65412
    s_mov_b64 exec, s[50:51]
    s_branch L2_d131
L2_c132:
    s_lshl_b64 s[52:53], s[82:83], 1
    s_andn2_b64 s[52:53], s[52:53], s[80:81]
    s_andn2_b64 s[52:53], s[52:53], s[54:55]
    s_or_b64 s[80:81], s[80:81], s[52:53]
    s_not_b64 vcc, s[52:53]
    s_mov_b64 exec, -1
    v_cndmask_b32_dpp v84, v84, v84, vcc wave_shr:1 row_mask:0xf bank_mask:0xf
    v_cndmask_b32_dpp v85, v85, v85, vcc wave_shr:1 row_mask:0xf bank_mask:0xf
    s_lshr_b64 s[52:53], s[52:53], 1
    v_cndmask_b32_dpp v86, v86, v86, vcc wave_shr:1 row_mask:0xf bank_mask:0xf
    v_cndmask_b32_dpp v87, v87, v87, vcc wave_shr:1 row_mask:0xf bank_mask:0xf
    s_andn2_b64 s[82:83], s[82:83], s[52:53]
    v_cndmask_b32_dpp v7, v7, v7, vcc wave_shr:1 row_mask:0xf bank_mask:0xf
    s_mov_b64 exec, s[54:55]
    s_cbranch_scc0 L2_d132
    s_mov_b64 exec, s[82:83]
    s_nop 1
    v_mfma_f32_4x4x4_16b_bf16 v[88:91], v[12:13], v[84:85], 0
    s_nop 1
    v_mfma_f32_4x4x4_16b_bf16 v[88:91], v[10:11], v[86:87], v[88:91]
    s_nop 4
    v_cvt_pk_bf16_f32 v88, v88, v89
    v_cvt_pk_bf16_f32 v89, v90, v91
    ds_pk_add_bf16 v7, v88 offset:65408
    ds_pk_add_bf16 v7, v89 offset:65412
    s_mov_b64 exec, s[54:55]
    s_branch L2_d132
L2_c133:
    s_lshl_b64 s[52:53], s[82:83], 1
    s_andn2_b64 s[52:53], s[52:53], s[80:81]
    s_andn2_b64 s[52:53], s[52:53], s[50:51]
    s_or_b64 s[80:81], s[80:81], s[52:53]
    s_not_b64 vcc, s[52:53]
    s_mov_b64 exec, -1
    v_cndmask_b32_dpp v84, v84, v84, vcc wave_shr:1 row_mask:0xf bank_mask:0xf
    v_cndmask_b32_dpp v85, v85, v85, vcc wave_shr:1 row_mask:0xf bank_mask:0xf
    s_lshr_b64 s[52:53], s[52:53], 1
    v_cndmask_b32_dpp v86, v86, v86, vcc wave_shr:1 row_mask:0xf bank_mask:0xf
    v_cndmask_b32_dpp v87, v87, v87, vcc wave_shr:1 row_mask:0xf bank_mask:0xf
    s_andn2_b64 s[82:83], s[82:83], s[52:53]
    v_cndmask_b32_dpp v7, v7, v7, vcc wave_shr:1 row_mask:0xf bank_mask:0xf
    s_mov_b64 exec, s[50:51]
    s_cbranch_scc0 L2_d133
    s_mov_b64 exec, s[82:83]
    s_nop 1
    v_mfma_f32_4x4x4_16b_bf16 v[88:91], v[12:13], v[84:85], 0
    s_nop 1
    v_mfma_f32_4x4x4_16b_bf16 v[88:91], v[10:11], v[86:87], v[88:91]
    s_nop 4
    v_cvt_pk_bf16_f32 v88, v88, v89
    v_cvt_pk_bf16_f32 v89, v90, v91
    ds_pk_add_bf16 v7, v88 offset:65408
    ds_pk_add_bf16 v7, v89 offset:65412
    s_mov_b64 exec, s[50:51]
    s_branch L2_d133
L2_oa134:
    v_and_b32 v47, 0x0fffffff, v33
    buffer_load_dword v114, v47, s[8:11], 0 offen offset:16
    s_mov_b64 exec, s[6:7]
    v_add_u32 v47, 8, v47
    v_lshrrev_b32 v33, 2, v33
    s_mov_b64 exec, -1
    buffer_load_dwordx2 v[112:113], v47, s[8:11], 0 offen
    s_branch L2_ob134
L2_c135:
    s_lshl_b64 s[52:53], s[82:83], 1
    s_andn2_b64 s[52:53], s[52:53], s[80:81]
    s_andn2_b64 s[52:53], s[52:53], s[54:55]
    s_or_b64 s[80:81], s[80:81], s[52:53]
    s_not_b64 vcc, s[52:53]
    s_mov_b64 exec, -1
    v_cndmask_b32_dpp v84, v84, v84, vcc wave_shr:1 row_mask:0xf bank_mask:0xf
    v_cndmask_b32_dpp v85, v85, v85, vcc wave_shr:1 row_mask:0xf bank_mask:0xf
    s_lshr_b64 s[52:53], s[52:53], 1
    v_cndmask_b32_dpp v86, v86, v86, vcc wave_shr:1 row_mask:0xf bank_mask:0xf
    v_cndmask_b32_dpp v87, v87, v87, vcc wave_shr:1 row_mask:0xf bank_mask:0xf
    s_andn2_b64 s[82:83], s[82:83], s[52:53]
    v_cndmask_b32_dpp v7, v7, v7, vcc wave_shr:1 row_mask:0xf bank_mask:0xf
    s_mov_b64 exec, s[54:55]
    s_cbranch_scc0 L2_d135
    s_mov_b64 exec, s[82:83]
    s_nop 1
    v_mfma_f32_4x4x4_16b_bf16 v[88:91], v[12:13], v[84:85], 0
    s_nop 1
    v_mfma_f32_4x4x4_16b_bf16 v[88:91], v[10:11], v[86:87], v[88:91]
    s_nop 4
    v_cvt_pk_bf16_f32 v88, v88, v89
    v_cvt_pk_bf16_f32 v89, v90, v91
    ds_pk_add_bf16 v7, v88 offset:65408
    ds_pk_add_bf16 v7, v89 offset:65412
    s_mov_b64 exec, s[54:55]
    s_branch L2_d135
L2_c136:
    s_lshl_b64 s[52:53], s[82:83], 1
    s_andn2_b64 s[52:53], s[52:53], s[80:81]
    s_andn2_b64 s[52:53], s[52:53], s[50:51]
    s_or_b64 s[80:81], s[80:81], s[52:53]
    s_not_b64 vcc, s[52:53]
    s_mov_b64 exec, -1
    v_cndmask_b32_dpp v84, v84, v84, vcc wave_shr:1 row_mask:0xf bank_mask:0xf
    v_cndmask_b32_dpp v85, v85, v85, vcc wave_shr:1 row_mask:0xf bank_mask:0xf
    s_lshr_b64 s[52:53], s[52:53], 1
    v_cndmask_b32_dpp v86, v86, v86, vcc wave_shr:1 row_mask:0xf bank_mask:0xf
    v_cndmask_b32_dpp v87, v87, v87, vcc wave_shr:1 row_mask:0xf bank_mask:0xf
    s_andn2_b64 s[82:83], s[82:83], s[52:53]
    v_cndmask_b32_dpp v7, v7, v7, vcc wave_shr:1 row_mask:0xf bank_mask:0xf
    s_mov_b64 exec, s[50:51]
    s_cbranch_scc0 L2_d136
    s_mov_b64 exec, s[82:83]
    s_nop 1
    v_mfma_f32_4x4x4_16b_bf16 v[88:91], v[12:13], v[84:85], 0
    s_nop 1
    v_mfma_f32_4x4x4_16b_bf16 v[88:91], v[10:11], v[86:87], v[88:91]
    s_nop 4
    v_cvt_pk_bf16_f32 v88, v88, v89
    v_cvt_pk_bf16_f32 v89, v90, v91
    ds_pk_add_bf16 v7, v88 offset:65408
    ds_pk_add_bf16 v7, v89 offset:65412
    s_mov_b64 exec, s[50:51]
    s_branch L2_d136
L2_c137:
    s_lshl_b64 s[52:53], s[82:83], 1
    s_andn2_b64 s[52:53], s[52:53], s[80:81]
    s_andn2_b64 s[52:53], s[52:53], s[54:55]
    s_or_b64 s[80:81], s[80:81], s[52:53]
    s_not_b64 vcc, s[52:53]
    s_mov_b64 exec, -1
    v_cndmask_b32_dpp v84, v84, v84, vcc wave_shr:1 row_mask:0xf bank_mask:0xf
    v_cndmask_b32_dpp v85, v85, v85, vcc wave_shr:1 row_mask:0xf bank_mask:0xf
    s_lshr_b64 s[52:53], s[52:53], 1
    v_cndmask_b32_dpp v86, v86, v86, vcc wave_shr:1 row_mask:0xf bank_mask:0xf
    v_cndmask_b32_dpp v87, v87, v87, vcc wave_shr:1 row_mask:0xf bank_mask:0xf
    s_andn2_b64 s[82:83], s[82:83], s[52:53]
    v_cndmask_b32_dpp v7, v7, v7, vcc wave_shr:1 row_mask:0xf bank_mask:0xf
    s_mov_b64 exec, s[54:55]
    s_cbranch_scc0 L2_d137
    s_mov_b64 exec, s[82:83]
    s_nop 1
    v_mfma_f32_4x4x4_16b_bf16 v[88:91], v[12:13], v[84:85], 0
    s_nop 1
    v_mfma_f32_4x4x4_16b_bf16 v[88:91], v[10:11], v[86:87], v[88:91]
    s_nop 4
    v_cvt_pk_bf16_f32 v88, v88, v89
    v_cvt_pk_bf16_f32 v89, v90, v91
    ds_pk_add_bf16 v7, v88 offset:65408
    ds_pk_add_bf16 v7, v89 offset:65412
    s_mov_b64 exec, s[54:55]
    s_branch L2_d137
L2_c138:
    s_lshl_b64 s[52:53], s[82:83], 1
    s_andn2_b64 s[52:53], s[52:53], s[80:81]
    s_andn2_b64 s[52:53], s[52:53], s[50:51]
    s_or_b64 s[80:81], s[80:81], s[52:53]
    s_not_b64 vcc, s[52:53]
    s_mov_b64 exec, -1
    v_cndmask_b32_dpp v84, v84, v84, vcc wave_shr:1 row_mask:0xf bank_mask:0xf
    v_cndmask_b32_dpp v85, v85, v85, vcc wave_shr:1 row_mask:0xf bank_mask:0xf
    s_lshr_b64 s[52:53], s[52:53], 1
    v_cndmask_b32_dpp v86, v86, v86, vcc wave_shr:1 row_mask:0xf bank_mask:0xf
    v_cndmask_b32_dpp v87, v87, v87, vcc wave_shr:1 row_mask:0xf bank_mask:0xf
    s_andn2_b64 s[82:83], s[82:83], s[52:53]
    v_cndmask_b32_dpp v7, v7, v7, vcc wave_shr:1 row_mask:0xf bank_mask:0xf
    s_mov_b64 exec, s[50:51]
    s_cbranch_scc0 L2_d138
    s_mov_b64 exec, s[82:83]
    s_nop 1
    v_mfma_f32_4x4x4_16b_bf16 v[88:91], v[12:13], v[84:85], 0
    s_nop 1
    v_mfma_f32_4x4x4_16b_bf16 v[88:91], v[10:11], v[86:87], v[88:91]
    s_nop 4
    v_cvt_pk_bf16_f32 v88, v88, v89
    v_cvt_pk_bf16_f32 v89, v90, v91
    ds_pk_add_bf16 v7, v88 offset:65408
    ds_pk_add_bf16 v7, v89 offset:65412
    s_mov_b64 exec, s[50:51]
    s_branch L2_d138
L2_c139:
    s_lshl_b64 s[52:53], s[82:83], 1
    s_andn2_b64 s[52:53], s[52:53], s[80:81]
    s_andn2_b64 s[52:53], s[52:53], s[54:55]
    s_or_b64 s[80:81], s[80:81], s[52:53]
    s_not_b64 vcc, s[52:53]
    s_mov_b64 exec, -1
    v_cndmask_b32_dpp v84, v84, v84, vcc wave_shr:1 row_mask:0xf bank_mask:0xf
    v_cndmask_b32_dpp v85, v85, v85, vcc wave_shr:1 row_mask:0xf bank_mask:0xf
    s_lshr_b64 s[52:53], s[52:53], 1
    v_cndmask_b32_dpp v86, v86, v86, vcc wave_shr:1 row_mask:0xf bank_mask:0xf
    v_cndmask_b32_dpp v87, v87, v87, vcc wave_shr:1 row_mask:0xf bank_mask:0xf
    s_andn2_b64 s[82:83], s[82:83], s[52:53]
    v_cndmask_b32_dpp v7, v7, v7, vcc wave_shr:1 row_mask:0xf bank_mask:0xf
    s_mov_b64 exec, s[54:55]
    s_cbranch_scc0 L2_d139
    s_mov_b64 exec, s[82:83]
    s_nop 1
    v_mfma_f32_4x4x4_16b_bf16 v[88:91], v[12:13], v[84:85], 0
    s_nop 1
    v_mfma_f32_4x4x4_16b_bf16 v[88:91], v[10:11], v[86:87], v[88:91]
    s_nop 4
    v_cvt_pk_bf16_f32 v88, v88, v89
    v_cvt_pk_bf16_f32 v89, v90, v91
    ds_pk_add_bf16 v7, v88 offset:65408
    ds_pk_add_bf16 v7, v89 offset:65412
    s_mov_b64 exec, s[54:55]
    s_branch L2_d139
L2_c140:
    s_lshl_b64 s[52:53], s[82:83], 1
    s_andn2_b64 s[52:53], s[52:53], s[80:81]
    s_andn2_b64 s[52:53], s[52:53], s[50:51]
    s_or_b64 s[80:81], s[80:81], s[52:53]
    s_not_b64 vcc, s[52:53]
    s_mov_b64 exec, -1
    v_cndmask_b32_dpp v84, v84, v84, vcc wave_shr:1 row_mask:0xf bank_mask:0xf
    v_cndmask_b32_dpp v85, v85, v85, vcc wave_shr:1 row_mask:0xf bank_mask:0xf
    s_lshr_b64 s[52:53], s[52:53], 1
    v_cndmask_b32_dpp v86, v86, v86, vcc wave_shr:1 row_mask:0xf bank_mask:0xf
    v_cndmask_b32_dpp v87, v87, v87, vcc wave_shr:1 row_mask:0xf bank_mask:0xf
    s_andn2_b64 s[82:83], s[82:83], s[52:53]
    v_cndmask_b32_dpp v7, v7, v7, vcc wave_shr:1 row_mask:0xf bank_mask:0xf
    s_mov_b64 exec, s[50:51]
    s_cbranch_scc0 L2_d140
    s_mov_b64 exec, s[82:83]
    s_nop 1
    v_mfma_f32_4x4x4_16b_bf16 v[88:91], v[12:13], v[84:85], 0
    s_nop 1
    v_mfma_f32_4x4x4_16b_bf16 v[88:91], v[10:11], v[86:87], v[88:91]
    s_nop 4
    v_cvt_pk_bf16_f32 v88, v88, v89
    v_cvt_pk_bf16_f32 v89, v90, v91
    ds_pk_add_bf16 v7, v88 offset:65408
    ds_pk_add_bf16 v7, v89 offset:65412
    s_mov_b64 exec, s[50:51]
    s_branch L2_d140
L2_oa141:
    s_waitcnt vmcnt(7)
    s_mov_b64 exec, s[6:7]
    v_lshrrev_b32 v114, 16, v114
    s_mov_b64 exec, -1
    v_and_b32 v46, 0x10000000, v33
    v_cmpx_eq_u32 vcc, 0, v46
    v_lshrrev_b32 v47, 14, v112
    v_and_b32 v47, v5, v47
    ds_read_b64 v[96:97], v47
    v_perm_b32 v98, v112, v114, s44
    v_bitop3_b32 v99, v112, 0.5, -0.5 bitop3:0xa8
    v_bitop3_b32 v98, v6, v98, v99 bitop3:0xca
    v_and_b32 v47, v5, v112
    s_waitcnt lgkmcnt(0)
    v_mfma_f32_4x4x4_16b_bf16 v[88:91], v[8:9], v[96:97], 0
    s_nop 4
    v_mul_f32 v88, v98, v88
    v_mul_f32 v89, v98, v89
    v_mul_f32 v90, v98, v90
    v_mul_f32 v91, v98, v91
    v_cvt_pk_bf16_f32 v88, v88, v89
    v_cvt_pk_bf16_f32 v89, v90, v91
    ds_pk_add_bf16 v47, v88 offset:65408
    ds_pk_add_bf16 v47, v89 offset:65412
    s_mov_b64 exec, -1
    v_and_b32 v46, 0x20000000, v33
    v_cmpx_eq_u32 vcc, 0, v46
    v_lshrrev_b32 v47, 14, v113
    v_and_b32 v47, v5, v47
    ds_read_b64 v[96:97], v47
    v_perm_b32 v98, v113, v114, s45
    v_bitop3_b32 v99, v113, 0.5, -0.5 bitop3:0xa8
    v_bitop3_b32 v98, v6, v98, v99 bitop3:0xca
    v_and_b32 v47, v5, v113
    s_waitcnt lgkmcnt(0)
    v_mfma_f32_4x4x4_16b_bf16 v[88:91], v[8:9], v[96:97], 0
    s_nop 4
    v_mul_f32 v88, v98, v88
    v_mul_f32 v89, v98, v89
    v_mul_f32 v90, v98, v90
    v_mul_f32 v91, v98, v91
    v_cvt_pk_bf16_f32 v88, v88, v89
    v_cvt_pk_bf16_f32 v89, v90, v91
    ds_pk_add_bf16 v47, v88 offset:65408
    ds_pk_add_bf16 v47, v89 offset:65412
    s_mov_b64 exec, -1
    s_branch L2_ob141
L2_c142:
    s_lshl_b64 s[52:53], s[82:83], 1
    s_andn2_b64 s[52:53], s[52:53], s[80:81]
    s_andn2_b64 s[52:53], s[52:53], s[54:55]
    s_or_b64 s[80:81], s[80:81], s[52:53]
    s_not_b64 vcc, s[52:53]
    s_mov_b64 exec, -1
    v_cndmask_b32_dpp v84, v84, v84, vcc wave_shr:1 row_mask:0xf bank_mask:0xf
    v_cndmask_b32_dpp v85, v85, v85, vcc wave_shr:1 row_mask:0xf bank_mask:0xf
    s_lshr_b64 s[52:53], s[52:53], 1
    v_cndmask_b32_dpp v86, v86, v86, vcc wave_shr:1 row_mask:0xf bank_mask:0xf
    v_cndmask_b32_dpp v87, v87, v87, vcc wave_shr:1 row_mask:0xf bank_mask:0xf
    s_andn2_b64 s[82:83], s[82:83], s[52:53]
    v_cndmask_b32_dpp v7, v7, v7, vcc wave_shr:1 row_mask:0xf bank_mask:0xf
    s_mov_b64 exec, s[54:55]
    s_cbranch_scc0 L2_d142
    s_mov_b64 exec, s[82:83]
    s_nop 1
    v_mfma_f32_4x4x4_16b_bf16 v[88:91], v[12:13], v[84:85], 0
    s_nop 1
    v_mfma_f32_4x4x4_16b_bf16 v[88:91], v[10:11], v[86:87], v[88:91]
    s_nop 4
    v_cvt_pk_bf16_f32 v88, v88, v89
    v_cvt_pk_bf16_f32 v89, v90, v91
    ds_pk_add_bf16 v7, v88 offset:65408
    ds_pk_add_bf16 v7, v89 offset:65412
    s_mov_b64 exec, s[54:55]
    s_branch L2_d142
L2_c143:
    s_lshl_b64 s[52:53], s[82:83], 1
    s_andn2_b64 s[52:53], s[52:53], s[80:81]
    s_andn2_b64 s[52:53], s[52:53], s[50:51]
    s_or_b64 s[80:81], s[80:81], s[52:53]
    s_not_b64 vcc, s[52:53]
    s_mov_b64 exec, -1
    v_cndmask_b32_dpp v84, v84, v84, vcc wave_shr:1 row_mask:0xf bank_mask:0xf
    v_cndmask_b32_dpp v85, v85, v85, vcc wave_shr:1 row_mask:0xf bank_mask:0xf
    s_lshr_b64 s[52:53], s[52:53], 1
    v_cndmask_b32_dpp v86, v86, v86, vcc wave_shr:1 row_mask:0xf bank_mask:0xf
    v_cndmask_b32_dpp v87, v87, v87, vcc wave_shr:1 row_mask:0xf bank_mask:0xf
    s_andn2_b64 s[82:83], s[82:83], s[52:53]
    v_cndmask_b32_dpp v7, v7, v7, vcc wave_shr:1 row_mask:0xf bank_mask:0xf
    s_mov_b64 exec, s[50:51]
    s_cbranch_scc0 L2_d143
    s_mov_b64 exec, s[82:83]
    s_nop 1
    v_mfma_f32_4x4x4_16b_bf16 v[88:91], v[12:13], v[84:85], 0
    s_nop 1
    v_mfma_f32_4x4x4_16b_bf16 v[88:91], v[10:11], v[86:87], v[88:91]
    s_nop 4
    v_cvt_pk_bf16_f32 v88, v88, v89
    v_cvt_pk_bf16_f32 v89, v90, v91
    ds_pk_add_bf16 v7, v88 offset:65408
    ds_pk_add_bf16 v7, v89 offset:65412
    s_mov_b64 exec, s[50:51]
    s_branch L2_d143
L2_c144:
    s_lshl_b64 s[52:53], s[82:83], 1
    s_andn2_b64 s[52:53], s[52:53], s[80:81]
    s_andn2_b64 s[52:53], s[52:53], s[54:55]
    s_or_b64 s[80:81], s[80:81], s[52:53]
    s_not_b64 vcc, s[52:53]
    s_mov_b64 exec, -1
    v_cndmask_b32_dpp v84, v84, v84, vcc wave_shr:1 row_mask:0xf bank_mask:0xf
    v_cndmask_b32_dpp v85, v85, v85, vcc wave_shr:1 row_mask:0xf bank_mask:0xf
    s_lshr_b64 s[52:53], s[52:53], 1
    v_cndmask_b32_dpp v86, v86, v86, vcc wave_shr:1 row_mask:0xf bank_mask:0xf
    v_cndmask_b32_dpp v87, v87, v87, vcc wave_shr:1 row_mask:0xf bank_mask:0xf
    s_andn2_b64 s[82:83], s[82:83], s[52:53]
    v_cndmask_b32_dpp v7, v7, v7, vcc wave_shr:1 row_mask:0xf bank_mask:0xf
    s_mov_b64 exec, s[54:55]
    s_cbranch_scc0 L2_d144
    s_mov_b64 exec, s[82:83]
    s_nop 1
    v_mfma_f32_4x4x4_16b_bf16 v[88:91], v[12:13], v[84:85], 0
    s_nop 1
    v_mfma_f32_4x4x4_16b_bf16 v[88:91], v[10:11], v[86:87], v[88:91]
    s_nop 4
    v_cvt_pk_bf16_f32 v88, v88, v89
    v_cvt_pk_bf16_f32 v89, v90, v91
    ds_pk_add_bf16 v7, v88 offset:65408
    ds_pk_add_bf16 v7, v89 offset:65412
    s_mov_b64 exec, s[54:55]
    s_branch L2_d144
L2_c145:
    s_lshl_b64 s[52:53], s[82:83], 1
    s_andn2_b64 s[52:53], s[52:53], s[80:81]
    s_andn2_b64 s[52:53], s[52:53], s[50:51]
    s_or_b64 s[80:81], s[80:81], s[52:53]
    s_not_b64 vcc, s[52:53]
    s_mov_b64 exec, -1
    v_cndmask_b32_dpp v84, v84, v84, vcc wave_shr:1 row_mask:0xf bank_mask:0xf
    v_cndmask_b32_dpp v85, v85, v85, vcc wave_shr:1 row_mask:0xf bank_mask:0xf
    s_lshr_b64 s[52:53], s[52:53], 1
    v_cndmask_b32_dpp v86, v86, v86, vcc wave_shr:1 row_mask:0xf bank_mask:0xf
    v_cndmask_b32_dpp v87, v87, v87, vcc wave_shr:1 row_mask:0xf bank_mask:0xf
    s_andn2_b64 s[82:83], s[82:83], s[52:53]
    v_cndmask_b32_dpp v7, v7, v7, vcc wave_shr:1 row_mask:0xf bank_mask:0xf
    s_mov_b64 exec, s[50:51]
    s_cbranch_scc0 L2_d145
    s_mov_b64 exec, s[82:83]
    s_nop 1
    v_mfma_f32_4x4x4_16b_bf16 v[88:91], v[12:13], v[84:85], 0
    s_nop 1
    v_mfma_f32_4x4x4_16b_bf16 v[88:91], v[10:11], v[86:87], v[88:91]
    s_nop 4
    v_cvt_pk_bf16_f32 v88, v88, v89
    v_cvt_pk_bf16_f32 v89, v90, v91
    ds_pk_add_bf16 v7, v88 offset:65408
    ds_pk_add_bf16 v7, v89 offset:65412
    s_mov_b64 exec, s[50:51]
    s_branch L2_d145
L2_c146:
    s_lshl_b64 s[52:53], s[82:83], 1
    s_andn2_b64 s[52:53], s[52:53], s[80:81]
    s_andn2_b64 s[52:53], s[52:53], s[54:55]
    s_or_b64 s[80:81], s[80:81], s[52:53]
    s_not_b64 vcc, s[52:53]
    s_mov_b64 exec, -1
    v_cndmask_b32_dpp v84, v84, v84, vcc wave_shr:1 row_mask:0xf bank_mask:0xf
    v_cndmask_b32_dpp v85, v85, v85, vcc wave_shr:1 row_mask:0xf bank_mask:0xf
    s_lshr_b64 s[52:53], s[52:53], 1
    v_cndmask_b32_dpp v86, v86, v86, vcc wave_shr:1 row_mask:0xf bank_mask:0xf
    v_cndmask_b32_dpp v87, v87, v87, vcc wave_shr:1 row_mask:0xf bank_mask:0xf
    s_andn2_b64 s[82:83], s[82:83], s[52:53]
    v_cndmask_b32_dpp v7, v7, v7, vcc wave_shr:1 row_mask:0xf bank_mask:0xf
    s_mov_b64 exec, s[54:55]
    s_cbranch_scc0 L2_d146
    s_mov_b64 exec, s[82:83]
    s_nop 1
    v_mfma_f32_4x4x4_16b_bf16 v[88:91], v[12:13], v[84:85], 0
    s_nop 1
    v_mfma_f32_4x4x4_16b_bf16 v[88:91], v[10:11], v[86:87], v[88:91]
    s_nop 4
    v_cvt_pk_bf16_f32 v88, v88, v89
    v_cvt_pk_bf16_f32 v89, v90, v91
    ds_pk_add_bf16 v7, v88 offset:65408
    ds_pk_add_bf16 v7, v89 offset:65412
    s_mov_b64 exec, s[54:55]
    s_branch L2_d146
L2_c147:
    s_lshl_b64 s[52:53], s[82:83], 1
    s_andn2_b64 s[52:53], s[52:53], s[80:81]
    s_andn2_b64 s[52:53], s[52:53], s[50:51]
    s_or_b64 s[80:81], s[80:81], s[52:53]
    s_not_b64 vcc, s[52:53]
    s_mov_b64 exec, -1
    v_cndmask_b32_dpp v84, v84, v84, vcc wave_shr:1 row_mask:0xf bank_mask:0xf
    v_cndmask_b32_dpp v85, v85, v85, vcc wave_shr:1 row_mask:0xf bank_mask:0xf
    s_lshr_b64 s[52:53], s[52:53], 1
    v_cndmask_b32_dpp v86, v86, v86, vcc wave_shr:1 row_mask:0xf bank_mask:0xf
    v_cndmask_b32_dpp v87, v87, v87, vcc wave_shr:1 row_mask:0xf bank_mask:0xf
    s_andn2_b64 s[82:83], s[82:83], s[52:53]
    v_cndmask_b32_dpp v7, v7, v7, vcc wave_shr:1 row_mask:0xf bank_mask:0xf
    s_mov_b64 exec, s[50:51]
    s_cbranch_scc0 L2_d147
    s_mov_b64 exec, s[82:83]
    s_nop 1
    v_mfma_f32_4x4x4_16b_bf16 v[88:91], v[12:13], v[84:85], 0
    s_nop 1
    v_mfma_f32_4x4x4_16b_bf16 v[88:91], v[10:11], v[86:87], v[88:91]
    s_nop 4
    v_cvt_pk_bf16_f32 v88, v88, v89
    v_cvt_pk_bf16_f32 v89, v90, v91
    ds_pk_add_bf16 v7, v88 offset:65408
    ds_pk_add_bf16 v7, v89 offset:65412
    s_mov_b64 exec, s[50:51]
    s_branch L2_d147
L2_c148:
    s_lshl_b64 s[52:53], s[82:83], 1
    s_andn2_b64 s[52:53], s[52:53], s[80:81]
    s_andn2_b64 s[52:53], s[52:53], s[54:55]
    s_or_b64 s[80:81], s[80:81], s[52:53]
    s_not_b64 vcc, s[52:53]
    s_mov_b64 exec, -1
    v_cndmask_b32_dpp v84, v84, v84, vcc wave_shr:1 row_mask:0xf bank_mask:0xf
    v_cndmask_b32_dpp v85, v85, v85, vcc wave_shr:1 row_mask:0xf bank_mask:0xf
    s_lshr_b64 s[52:53], s[52:53], 1
    v_cndmask_b32_dpp v86, v86, v86, vcc wave_shr:1 row_mask:0xf bank_mask:0xf
    v_cndmask_b32_dpp v87, v87, v87, vcc wave_shr:1 row_mask:0xf bank_mask:0xf
    s_andn2_b64 s[82:83], s[82:83], s[52:53]
    v_cndmask_b32_dpp v7, v7, v7, vcc wave_shr:1 row_mask:0xf bank_mask:0xf
    s_mov_b64 exec, s[54:55]
    s_cbranch_scc0 L2_d148
    s_mov_b64 exec, s[82:83]
    s_nop 1
    v_mfma_f32_4x4x4_16b_bf16 v[88:91], v[12:13], v[84:85], 0
    s_nop 1
    v_mfma_f32_4x4x4_16b_bf16 v[88:91], v[10:11], v[86:87], v[88:91]
    s_nop 4
    v_cvt_pk_bf16_f32 v88, v88, v89
    v_cvt_pk_bf16_f32 v89, v90, v91
    ds_pk_add_bf16 v7, v88 offset:65408
    ds_pk_add_bf16 v7, v89 offset:65412
    s_mov_b64 exec, s[54:55]
    s_branch L2_d148
L2_c149:
    s_lshl_b64 s[52:53], s[82:83], 1
    s_andn2_b64 s[52:53], s[52:53], s[80:81]
    s_andn2_b64 s[52:53], s[52:53], s[50:51]
    s_or_b64 s[80:81], s[80:81], s[52:53]
    s_not_b64 vcc, s[52:53]
    s_mov_b64 exec, -1
    v_cndmask_b32_dpp v84, v84, v84, vcc wave_shr:1 row_mask:0xf bank_mask:0xf
    v_cndmask_b32_dpp v85, v85, v85, vcc wave_shr:1 row_mask:0xf bank_mask:0xf
    s_lshr_b64 s[52:53], s[52:53], 1
    v_cndmask_b32_dpp v86, v86, v86, vcc wave_shr:1 row_mask:0xf bank_mask:0xf
    v_cndmask_b32_dpp v87, v87, v87, vcc wave_shr:1 row_mask:0xf bank_mask:0xf
    s_andn2_b64 s[82:83], s[82:83], s[52:53]
    v_cndmask_b32_dpp v7, v7, v7, vcc wave_shr:1 row_mask:0xf bank_mask:0xf
    s_mov_b64 exec, s[50:51]
    s_cbranch_scc0 L2_d149
    s_mov_b64 exec, s[82:83]
    s_nop 1
    v_mfma_f32_4x4x4_16b_bf16 v[88:91], v[12:13], v[84:85], 0
    s_nop 1
    v_mfma_f32_4x4x4_16b_bf16 v[88:91], v[10:11], v[86:87], v[88:91]
    s_nop 4
    v_cvt_pk_bf16_f32 v88, v88, v89
    v_cvt_pk_bf16_f32 v89, v90, v91
    ds_pk_add_bf16 v7, v88 offset:65408
    ds_pk_add_bf16 v7, v89 offset:65412
    s_mov_b64 exec, s[50:51]
    s_branch L2_d149
L2_c150:
    s_lshl_b64 s[52:53], s[82:83], 1
    s_andn2_b64 s[52:53], s[52:53], s[80:81]
    s_andn2_b64 s[52:53], s[52:53], s[54:55]
    s_or_b64 s[80:81], s[80:81], s[52:53]
    s_not_b64 vcc, s[52:53]
    s_mov_b64 exec, -1
    v_cndmask_b32_dpp v84, v84, v84, vcc wave_shr:1 row_mask:0xf bank_mask:0xf
    v_cndmask_b32_dpp v85, v85, v85, vcc wave_shr:1 row_mask:0xf bank_mask:0xf
    s_lshr_b64 s[52:53], s[52:53], 1
    v_cndmask_b32_dpp v86, v86, v86, vcc wave_shr:1 row_mask:0xf bank_mask:0xf
    v_cndmask_b32_dpp v87, v87, v87, vcc wave_shr:1 row_mask:0xf bank_mask:0xf
    s_andn2_b64 s[82:83], s[82:83], s[52:53]
    v_cndmask_b32_dpp v7, v7, v7, vcc wave_shr:1 row_mask:0xf bank_mask:0xf
    s_mov_b64 exec, s[54:55]
    s_cbranch_scc0 L2_d150
    s_mov_b64 exec, s[82:83]
    s_nop 1
    v_mfma_f32_4x4x4_16b_bf16 v[88:91], v[12:13], v[84:85], 0
    s_nop 1
    v_mfma_f32_4x4x4_16b_bf16 v[88:91], v[10:11], v[86:87], v[88:91]
    s_nop 4
    v_cvt_pk_bf16_f32 v88, v88, v89
    v_cvt_pk_bf16_f32 v89, v90, v91
    ds_pk_add_bf16 v7, v88 offset:65408
    ds_pk_add_bf16 v7, v89 offset:65412
    s_mov_b64 exec, s[54:55]
    s_branch L2_d150
L2_c151:
    s_lshl_b64 s[52:53], s[82:83], 1
    s_andn2_b64 s[52:53], s[52:53], s[80:81]
    s_andn2_b64 s[52:53], s[52:53], s[50:51]
    s_or_b64 s[80:81], s[80:81], s[52:53]
    s_not_b64 vcc, s[52:53]
    s_mov_b64 exec, -1
    v_cndmask_b32_dpp v84, v84, v84, vcc wave_shr:1 row_mask:0xf bank_mask:0xf
    v_cndmask_b32_dpp v85, v85, v85, vcc wave_shr:1 row_mask:0xf bank_mask:0xf
    s_lshr_b64 s[52:53], s[52:53], 1
    v_cndmask_b32_dpp v86, v86, v86, vcc wave_shr:1 row_mask:0xf bank_mask:0xf
    v_cndmask_b32_dpp v87, v87, v87, vcc wave_shr:1 row_mask:0xf bank_mask:0xf
    s_andn2_b64 s[82:83], s[82:83], s[52:53]
    v_cndmask_b32_dpp v7, v7, v7, vcc wave_shr:1 row_mask:0xf bank_mask:0xf
    s_mov_b64 exec, s[50:51]
    s_cbranch_scc0 L2_d151
    s_mov_b64 exec, s[82:83]
    s_nop 1
    v_mfma_f32_4x4x4_16b_bf16 v[88:91], v[12:13], v[84:85], 0
    s_nop 1
    v_mfma_f32_4x4x4_16b_bf16 v[88:91], v[10:11], v[86:87], v[88:91]
    s_nop 4
    v_cvt_pk_bf16_f32 v88, v88, v89
    v_cvt_pk_bf16_f32 v89, v90, v91
    ds_pk_add_bf16 v7, v88 offset:65408
    ds_pk_add_bf16 v7, v89 offset:65412
    s_mov_b64 exec, s[50:51]
    s_branch L2_d151
L2_c152:
    s_mov_b64 s[50:51], vcc
    s_lshl_b64 s[52:53], s[82:83], 1
    s_andn2_b64 s[52:53], s[52:53], s[80:81]
    s_andn2_b64 s[52:53], s[52:53], s[50:51]
    s_or_b64 s[80:81], s[80:81], s[52:53]
    s_not_b64 vcc, s[52:53]
    s_mov_b64 exec, -1
    v_cndmask_b32_dpp v84, v84, v84, vcc wave_shr:1 row_mask:0xf bank_mask:0xf
    v_cndmask_b32_dpp v85, v85, v85, vcc wave_shr:1 row_mask:0xf bank_mask:0xf
    s_lshr_b64 s[52:53], s[52:53], 1
    v_cndmask_b32_dpp v86, v86, v86, vcc wave_shr:1 row_mask:0xf bank_mask:0xf
    v_cndmask_b32_dpp v87, v87, v87, vcc wave_shr:1 row_mask:0xf bank_mask:0xf
    s_andn2_b64 s[82:83], s[82:83], s[52:53]
    v_cndmask_b32_dpp v7, v7, v7, vcc wave_shr:1 row_mask:0xf bank_mask:0xf
    s_mov_b64 vcc, s[50:51]
    s_mov_b64 exec, s[50:51]
    s_cbranch_scc0 L2_d152
    s_mov_b64 exec, s[82:83]
    s_nop 1
    v_mfma_f32_4x4x4_16b_bf16 v[88:91], v[12:13], v[84:85], 0
    s_nop 1
    v_mfma_f32_4x4x4_16b_bf16 v[88:91], v[10:11], v[86:87], v[88:91]
    s_nop 4
    v_cvt_pk_bf16_f32 v88, v88, v89
    v_cvt_pk_bf16_f32 v89, v90, v91
    ds_pk_add_bf16 v7, v88 offset:65408
    ds_pk_add_bf16 v7, v89 offset:65412
    s_mov_b64 exec, vcc
    s_branch L2_d152
L2_c153:
    s_mov_b64 s[50:51], vcc
    s_lshl_b64 s[52:53], s[82:83], 1
    s_andn2_b64 s[52:53], s[52:53], s[80:81]
    s_andn2_b64 s[52:53], s[52:53], s[50:51]
    s_or_b64 s[80:81], s[80:81], s[52:53]
    s_not_b64 vcc, s[52:53]
    s_mov_b64 exec, -1
    v_cndmask_b32_dpp v84, v84, v84, vcc wave_shr:1 row_mask:0xf bank_mask:0xf
    v_cndmask_b32_dpp v85, v85, v85, vcc wave_shr:1 row_mask:0xf bank_mask:0xf
    s_lshr_b64 s[52:53], s[52:53], 1
    v_cndmask_b32_dpp v86, v86, v86, vcc wave_shr:1 row_mask:0xf bank_mask:0xf
    v_cndmask_b32_dpp v87, v87, v87, vcc wave_shr:1 row_mask:0xf bank_mask:0xf
    s_andn2_b64 s[82:83], s[82:83], s[52:53]
    v_cndmask_b32_dpp v7, v7, v7, vcc wave_shr:1 row_mask:0xf bank_mask:0xf
    s_mov_b64 vcc, s[50:51]
    s_mov_b64 exec, s[50:51]
    s_cbranch_scc0 L2_d153
    s_mov_b64 exec, s[82:83]
    s_nop 1
    v_mfma_f32_4x4x4_16b_bf16 v[88:91], v[12:13], v[84:85], 0
    s_nop 1
    v_mfma_f32_4x4x4_16b_bf16 v[88:91], v[10:11], v[86:87], v[88:91]
    s_nop 4
    v_cvt_pk_bf16_f32 v88, v88, v89
    v_cvt_pk_bf16_f32 v89, v90, v91
    ds_pk_add_bf16 v7, v88 offset:65408
    ds_pk_add_bf16 v7, v89 offset:65412
    s_mov_b64 exec, vcc
    s_branch L2_d153
L2_f3s:
    s_branch L2_f3
.section .rodata,"a"
.p2align 6
.amdhsa_kernel gather_scatter__molecular_angular_gemnet__graph_kernel
  .amdhsa_next_free_vgpr 128
  .amdhsa_next_free_sgpr 102
  .amdhsa_accum_offset 128
  .amdhsa_group_segment_fixed_size 0
  .amdhsa_kernarg_size 112
  .amdhsa_user_sgpr_count 2
  .amdhsa_user_sgpr_kernarg_segment_ptr 1
  .amdhsa_system_sgpr_workgroup_id_x 1
  .amdhsa_float_denorm_mode_32 3
.end_amdhsa_kernel
```

```asm
; @launch grid=(256,1,1) block=(1024,1,1) lds=163840
.amdgcn_target "amdgcn-amd-amdhsa--gfx950"
.text
.globl gather_scatter__molecular_angular_gemnet__graph_kernel
.p2align 8
.type gather_scatter__molecular_angular_gemnet__graph_kernel,@function
gather_scatter__molecular_angular_gemnet__graph_kernel:
    s_cmp_ge_u32 s2, 256
    s_cbranch_scc0 L1_go
    s_endpgm
L1_go:
    s_load_dwordx2 s[8:9], s[0:1], 8
    s_load_dwordx2 s[12:13], s[0:1], 16
    s_load_dwordx2 s[16:17], s[0:1], 32
    s_load_dwordx2 s[30:31], s[0:1], 104
    s_load_dwordx2 s[56:57], s[0:1], 96
    s_load_dwordx2 s[86:87], s[0:1], 0
    s_load_dwordx4 s[60:63], s[0:1], 56
    s_load_dwordx4 s[64:67], s[0:1], 72
    v_lshrrev_b32 v7, 6, v0
    v_lshlrev_b32 v1, 3, v0
    v_readfirstlane_b32 s32, v7
    v_lshlrev_b32 v0, 4, v0
    v_and_b32 v1, 0x1f8, v1
    s_lshr_b32 s3, s32, 1
    s_and_b32 s44, s32, 1
    s_lshl_b32 s44, s44, 3
    s_or_b32 s3, s3, s44
    s_lshl_b32 s3, s3, 10
    s_lshl_b32 s96, s2, 14
    s_add_u32 s96, s96, s3
    s_mov_b32 s10, 0x9c40000
    s_mov_b32 s11, 0x20000
    s_mov_b32 s14, 0x9c40000
    s_mov_b32 s15, 0x20000
    s_mov_b32 s18, 0x4e20000
    s_mov_b32 s19, 0x20000
    s_waitcnt lgkmcnt(0)
    s_add_u32 s44, s96, 0x0
    v_lshlrev_b32 v16, 1, v1
    buffer_load_dwordx4 v[16:19], v16, s[8:11], s44 offen nt
    s_add_u32 s45, s96, 0x0
    v_lshlrev_b32 v20, 1, v1
    buffer_load_dwordx4 v[20:23], v20, s[12:15], s45 offen nt
    s_add_u32 s46, s96, 0x0
    s_lshr_b32 s46, s46, 1
    buffer_load_dwordx2 v[24:25], v1, s[16:19], s46 offen nt
    s_add_u32 s47, s96, 0x400000
    s_lshr_b32 s47, s47, 1
    buffer_load_dwordx2 v[26:27], v1, s[16:19], s47 offen nt
    s_add_u32 s44, s96, 0x400000
    v_lshlrev_b32 v28, 1, v1
    buffer_load_dwordx4 v[28:31], v28, s[8:11], s44 offen nt
    s_add_u32 s45, s96, 0x400000
    v_lshlrev_b32 v32, 1, v1
    buffer_load_dwordx4 v[32:35], v32, s[12:15], s45 offen nt
    s_add_u32 s46, s96, 0x800000
    v_lshlrev_b32 v36, 1, v1
    buffer_load_dwordx4 v[36:39], v36, s[8:11], s46 offen nt
    s_add_u32 s47, s96, 0x800000
    v_lshlrev_b32 v40, 1, v1
    buffer_load_dwordx4 v[40:43], v40, s[12:15], s47 offen nt
    s_add_u32 s44, s96, 0x800000
    s_lshr_b32 s44, s44, 1
    buffer_load_dwordx2 v[44:45], v1, s[16:19], s44 offen nt
    s_add_u32 s45, s96, 0xc00000
    s_lshr_b32 s45, s45, 1
    buffer_load_dwordx2 v[46:47], v1, s[16:19], s45 offen nt
    s_mov_b32 s68, s62
    s_mov_b32 s69, s63
    s_mov_b32 s70, 0x40
    s_mov_b32 s71, 0x20000
    s_mov_b32 s72, s60
    s_mov_b32 s73, s61
    s_mov_b32 s74, 0x40
    s_mov_b32 s75, 0x20000
    s_mov_b32 s20, s66
    s_mov_b32 s21, s67
    s_mov_b32 s22, 0x20
    s_mov_b32 s23, 0x20000
    s_mov_b32 s80, s64
    s_mov_b32 s81, s65
    s_mov_b32 s82, 0x20
    s_mov_b32 s83, 0x20000
    s_add_u32 s24, s30, 0xec54000
    s_addc_u32 s25, s31, 0
    s_mov_b32 s26, 0x100
    s_mov_b32 s27, 0x20000
    v_lshrrev_b32 v2, 3, v0
    v_and_b32 v2, 6, v2
    v_lshlrev_b32 v3, 2, v0
    s_lshl_b32 s3, s32, 8
    s_add_u32 s3, s3, s2
    s_cmp_lg_u32 s3, 254
    s_cbranch_scc1 L1_wt
    buffer_load_ushort v116, v2, s[68:71], 0 offen offset:0
    buffer_load_ushort v108, v2, s[68:71], 0 offen offset:8
    buffer_load_ushort v117, v2, s[68:71], 0 offen offset:16
    buffer_load_ushort v109, v2, s[68:71], 0 offen offset:24
    buffer_load_ushort v118, v2, s[68:71], 0 offen offset:32
    buffer_load_ushort v110, v2, s[68:71], 0 offen offset:40
    buffer_load_ushort v119, v2, s[68:71], 0 offen offset:48
    buffer_load_ushort v111, v2, s[68:71], 0 offen offset:56
    buffer_load_ushort v120, v2, s[72:75], 0 offen offset:0
    buffer_load_ushort v100, v2, s[72:75], 0 offen offset:8
    buffer_load_ushort v121, v2, s[72:75], 0 offen offset:16
    buffer_load_ushort v101, v2, s[72:75], 0 offen offset:24
    buffer_load_ushort v122, v2, s[72:75], 0 offen offset:32
    buffer_load_ushort v102, v2, s[72:75], 0 offen offset:40
    buffer_load_ushort v123, v2, s[72:75], 0 offen offset:48
    buffer_load_ushort v103, v2, s[72:75], 0 offen offset:56
    buffer_load_ushort v124, v2, s[20:23], 0 offen offset:0
    buffer_load_ushort v112, v2, s[20:23], 0 offen offset:8
    buffer_load_ushort v125, v2, s[20:23], 0 offen offset:16
    buffer_load_ushort v113, v2, s[20:23], 0 offen offset:24
    buffer_load_ushort v126, v2, s[80:83], 0 offen offset:0
    buffer_load_ushort v114, v2, s[80:83], 0 offen offset:8
    buffer_load_ushort v127, v2, s[80:83], 0 offen offset:16
    buffer_load_ushort v115, v2, s[80:83], 0 offen offset:24
    s_waitcnt vmcnt(0)
    v_lshl_or_b32 v116, v108, 16, v116
    v_lshl_or_b32 v117, v109, 16, v117
    v_lshl_or_b32 v118, v110, 16, v118
    v_lshl_or_b32 v119, v111, 16, v119
    v_lshl_or_b32 v120, v100, 16, v120
    v_lshl_or_b32 v121, v101, 16, v121
    v_lshl_or_b32 v122, v102, 16, v122
    v_lshl_or_b32 v123, v103, 16, v123
    v_lshl_or_b32 v124, v112, 16, v124
    v_lshl_or_b32 v125, v113, 16, v125
    v_lshl_or_b32 v126, v114, 16, v126
    v_lshl_or_b32 v127, v115, 16, v127
    buffer_store_dwordx4 v[116:119], v3, s[24:27], 0 offen offset:0 sc1
    buffer_store_dwordx4 v[120:123], v3, s[24:27], 0 offen offset:16 sc1
    buffer_store_dwordx4 v[124:127], v3, s[24:27], 0 offen offset:32 sc1
L1_wt:
    s_mov_b32 s20, s30
    s_mov_b32 s21, s31
    s_mov_b32 s22, 0xd344000
    s_mov_b32 s23, 0x20000
    s_add_u32 s24, s30, 0x2c000
    s_addc_u32 s25, s31, 0
    s_mov_b32 s26, 0xd318000
    s_mov_b32 s27, 0x20000
    s_add_u32 s3, s32, 0
    s_mul_i32 s4, s3, 205
    s_lshr_b32 s4, s4, 10
    s_mul_i32 s5, s4, 5
    s_sub_u32 s5, s3, s5
    s_lshl_b32 s5, s5, 5
    s_add_u32 s4, s4, s5
    s_sub_u32 s4, s4, s32
    s_lshl_b32 s72, s4, 10
    s_add_u32 s3, s32, 16
    s_mul_i32 s4, s3, 205
    s_lshr_b32 s4, s4, 10
    s_mul_i32 s5, s4, 5
    s_sub_u32 s5, s3, s5
    s_lshl_b32 s5, s5, 5
    s_add_u32 s4, s4, s5
    s_sub_u32 s4, s4, s32
    s_lshl_b32 s73, s4, 10
    s_add_u32 s3, s32, 32
    s_mul_i32 s4, s3, 205
    s_lshr_b32 s4, s4, 10
    s_mul_i32 s5, s4, 5
    s_sub_u32 s5, s3, s5
    s_lshl_b32 s5, s5, 5
    s_add_u32 s4, s4, s5
    s_sub_u32 s4, s4, s32
    s_lshl_b32 s85, s4, 10
    s_add_u32 s3, s32, 48
    s_mul_i32 s4, s3, 205
    s_lshr_b32 s4, s4, 10
    s_mul_i32 s5, s4, 5
    s_sub_u32 s5, s3, s5
    s_lshl_b32 s5, s5, 5
    s_add_u32 s4, s4, s5
    s_sub_u32 s4, s4, s32
    s_lshl_b32 s91, s4, 10
    s_add_u32 s3, s32, 64
    s_mul_i32 s4, s3, 205
    s_lshr_b32 s4, s4, 10
    s_mul_i32 s5, s4, 5
    s_sub_u32 s5, s3, s5
    s_lshl_b32 s5, s5, 5
    s_add_u32 s4, s4, s5
    s_sub_u32 s4, s4, s32
    s_lshl_b32 s93, s4, 10
    s_mov_b32 s80, s86
    s_mov_b32 s81, s87
    s_mov_b32 s82, 0x4e2000
    s_mov_b32 s83, 0x20000
    s_mul_i32 s35, s2, 173056
    s_and_b32 s37, s32, 3
    s_lshl_b32 s37, s37, 3
    s_mov_b32 s36, s37
    s_lshr_b32 s37, s32, 2
    s_mul_i32 s37, s37, 2080
    s_add_u32 s36, s36, s37
    s_and_b32 s37, s2, 3
    s_lshl_b32 s37, s37, 5
    s_add_u32 s36, s36, s37
    s_mul_i32 s4, s2, 5
    s_add_u32 s4, s4, 8192
    s_lshl_b32 s38, s4, 14
    s_lshl_b32 s39, s4, 13
    v_mov_b32 v2, 1
    v_mov_b32 v4, 0x80000007
    v_mov_b32 v5, 0xfc
    v_mov_b32 v6, 0x78
    s_mov_b32 s40, 16512
    s_mov_b32 s55, -10000
    s_mov_b32 s41, 0x010c0c01
    s_mov_b32 s42, 0x030c0c03
    v_mov_b32 v8, 0
    v_mov_b32 v9, 0
    v_mov_b32 v10, 0
    v_mov_b32 v11, 0
    ds_write_b128 v0, v[8:11]
    s_add_u32 s60, s30, 0xec5d000
    s_addc_u32 s61, s31, 0
    s_mov_b32 s62, 0x8000
    s_mov_b32 s63, 0x20000
    s_mov_b64 s[66:67], s[56:57]
    s_lshl_b32 s57, s2, 7
    s_add_u32 s68, s30, 0xec55000
    s_addc_u32 s69, s31, 0
    s_mov_b32 s70, 0x80
    s_mov_b32 s71, 0x20000
    s_lshl_b32 s3, s2, 7
    s_add_u32 s68, s68, s3
    s_addc_u32 s69, s69, 0
    s_cmp_lg_u32 s32, 0
    s_cbranch_scc1 L1_fl
    buffer_store_dwordx4 v[8:11], v0, s[68:71], 0 offen sc1
    s_mov_b64 exec, 0xff
    buffer_store_dwordx4 v[8:11], v0, s[60:63], s57 offen sc1
    s_mov_b64 exec, -1
L1_fl:
    s_waitcnt lgkmcnt(0)
    s_barrier
    s_setprio 3
    s_add_u32 s46, s96, 0xc00000
    v_lshlrev_b32 v48, 1, v1
    buffer_load_dwordx4 v[48:51], v48, s[8:11], s46 offen nt
    s_add_u32 s47, s96, 0xc00000
    v_lshlrev_b32 v52, 1, v1
    buffer_load_dwordx4 v[52:55], v52, s[12:15], s47 offen nt
    s_waitcnt vmcnt(8)
    v_lshlrev_b32 v7, 16, v24
    v_and_b32 v8, 0xffff0000, v24
    v_lshlrev_b32 v9, 16, v25
    v_and_b32 v10, 0xffff0000, v25
    v_mul_f32 v7, 0.15915494, v7
    v_mul_f32 v8, 0.15915494, v8
    v_mul_f32 v9, 0.15915494, v9
    v_mul_f32 v10, 0.15915494, v10
    v_mul_hi_u32_u24 v14, 429497, v16
    v_lshrrev_b32 v12, 3, v20
    v_cos_f32 v7, v7
    v_lshlrev_b16 v13, 3, v20
    v_mad_i32_i24 v11, v14, s55, v16
    v_bitop3_b32 v12, v6, v13, v12 bitop3:0xca
    v_lshl_add_u32 v11, v11, 17, s40
    v_lshlrev_b16 v14, 8, v14
    v_lshrrev_b32 v13, 2, v20
    v_add_u32 v16, v12, v11
    v_bitop3_b32 v20, v5, v13, v14 bitop3:0xea
    ds_add_u32 v20, v2
    v_mul_hi_u32_u24 v14, 429497, v17
    v_lshrrev_b32 v12, 3, v21
    v_cos_f32 v8, v8
    v_lshlrev_b16 v13, 3, v21
    v_mad_i32_i24 v11, v14, s55, v17
    v_bitop3_b32 v12, v6, v13, v12 bitop3:0xca
    v_lshl_add_u32 v11, v11, 17, s40
    v_lshlrev_b16 v14, 8, v14
    v_lshrrev_b32 v13, 2, v21
    v_add_u32 v17, v12, v11
    v_bitop3_b32 v21, v5, v13, v14 bitop3:0xea
    ds_add_u32 v21, v2
    v_cvt_pk_bf16_f32 v24, v7, v8
    v_perm_b32 v12, v24, v24, s41
    v_bitop3_b32 v16, v4, v12, v16 bitop3:0xca
    v_perm_b32 v13, v24, v24, s42
    v_bitop3_b32 v17, v4, v13, v17 bitop3:0xca
    v_mul_hi_u32_u24 v14, 429497, v18
    v_lshrrev_b32 v12, 3, v22
    v_cos_f32 v9, v9
    v_lshlrev_b16 v13, 3, v22
    v_mad_i32_i24 v11, v14, s55, v18
    v_bitop3_b32 v12, v6, v13, v12 bitop3:0xca
    v_lshl_add_u32 v11, v11, 17, s40
    v_lshlrev_b16 v14, 8, v14
    v_lshrrev_b32 v13, 2, v22
    v_add_u32 v18, v12, v11
    v_bitop3_b32 v22, v5, v13, v14 bitop3:0xea
    ds_add_u32 v22, v2
    v_mul_hi_u32_u24 v14, 429497, v19
    v_lshrrev_b32 v12, 3, v23
    v_cos_f32 v10, v10
    v_lshlrev_b16 v13, 3, v23
    v_mad_i32_i24 v11, v14, s55, v19
    v_bitop3_b32 v12, v6, v13, v12 bitop3:0xca
    v_lshl_add_u32 v11, v11, 17, s40
    v_lshlrev_b16 v14, 8, v14
    v_lshrrev_b32 v13, 2, v23
    v_add_u32 v19, v12, v11
    v_bitop3_b32 v23, v5, v13, v14 bitop3:0xea
    ds_add_u32 v23, v2
    v_cvt_pk_bf16_f32 v25, v9, v10
    v_perm_b32 v12, v25, v25, s41
    v_bitop3_b32 v18, v4, v12, v18 bitop3:0xca
    v_perm_b32 v13, v25, v25, s42
    v_bitop3_b32 v19, v4, v13, v19 bitop3:0xca
    s_add_u32 s44, s96, 0x1000000
    v_lshlrev_b32 v56, 1, v1
    buffer_load_dwordx4 v[56:59], v56, s[8:11], s44 offen nt
    s_add_u32 s45, s96, 0x1000000
    v_lshlrev_b32 v60, 1, v1
    buffer_load_dwordx4 v[60:63], v60, s[12:15], s45 offen nt
    s_add_u32 s46, s96, 0x1000000
    s_lshr_b32 s46, s46, 1
    buffer_load_dwordx2 v[64:65], v1, s[16:19], s46 offen nt
    s_add_u32 s47, s96, 0x1400000
    s_lshr_b32 s47, s47, 1
    buffer_load_dwordx2 v[66:67], v1, s[16:19], s47 offen nt
    s_waitcnt vmcnt(10)
    v_lshlrev_b32 v7, 16, v26
    v_and_b32 v8, 0xffff0000, v26
    v_lshlrev_b32 v9, 16, v27
    v_and_b32 v10, 0xffff0000, v27
    v_mul_f32 v7, 0.15915494, v7
    v_mul_f32 v8, 0.15915494, v8
    v_mul_f32 v9, 0.15915494, v9
    v_mul_f32 v10, 0.15915494, v10
    v_mul_hi_u32_u24 v14, 429497, v28
    v_lshrrev_b32 v12, 3, v32
    v_cos_f32 v7, v7
    v_lshlrev_b16 v13, 3, v32
    v_mad_i32_i24 v11, v14, s55, v28
    v_bitop3_b32 v12, v6, v13, v12 bitop3:0xca
    v_lshl_add_u32 v11, v11, 17, s40
    v_lshlrev_b16 v14, 8, v14
    v_lshrrev_b32 v13, 2, v32
    v_add_u32 v28, v12, v11
    v_bitop3_b32 v32, v5, v13, v14 bitop3:0xea
    ds_add_u32 v32, v2
    v_mul_hi_u32_u24 v14, 429497, v29
    v_lshrrev_b32 v12, 3, v33
    v_cos_f32 v8, v8
    v_lshlrev_b16 v13, 3, v33
    v_mad_i32_i24 v11, v14, s55, v29
    v_bitop3_b32 v12, v6, v13, v12 bitop3:0xca
    v_lshl_add_u32 v11, v11, 17, s40
    v_lshlrev_b16 v14, 8, v14
    v_lshrrev_b32 v13, 2, v33
    v_add_u32 v29, v12, v11
    v_bitop3_b32 v33, v5, v13, v14 bitop3:0xea
    ds_add_u32 v33, v2
    v_cvt_pk_bf16_f32 v26, v7, v8
    v_perm_b32 v12, v26, v26, s41
    v_bitop3_b32 v28, v4, v12, v28 bitop3:0xca
    v_perm_b32 v13, v26, v26, s42
    v_bitop3_b32 v29, v4, v13, v29 bitop3:0xca
    v_mul_hi_u32_u24 v14, 429497, v30
    v_lshrrev_b32 v12, 3, v34
    v_cos_f32 v9, v9
    v_lshlrev_b16 v13, 3, v34
    v_mad_i32_i24 v11, v14, s55, v30
    v_bitop3_b32 v12, v6, v13, v12 bitop3:0xca
    v_lshl_add_u32 v11, v11, 17, s40
    v_lshlrev_b16 v14, 8, v14
    v_lshrrev_b32 v13, 2, v34
    v_add_u32 v30, v12, v11
    v_bitop3_b32 v34, v5, v13, v14 bitop3:0xea
    ds_add_u32 v34, v2
    v_mul_hi_u32_u24 v14, 429497, v31
    v_lshrrev_b32 v12, 3, v35
    v_cos_f32 v10, v10
    v_lshlrev_b16 v13, 3, v35
    v_mad_i32_i24 v11, v14, s55, v31
    v_bitop3_b32 v12, v6, v13, v12 bitop3:0xca
    v_lshl_add_u32 v11, v11, 17, s40
    v_lshlrev_b16 v14, 8, v14
    v_lshrrev_b32 v13, 2, v35
    v_add_u32 v31, v12, v11
    v_bitop3_b32 v35, v5, v13, v14 bitop3:0xea
    ds_add_u32 v35, v2
    v_cvt_pk_bf16_f32 v27, v9, v10
    v_perm_b32 v12, v27, v27, s41
    v_bitop3_b32 v30, v4, v12, v30 bitop3:0xca
    v_perm_b32 v13, v27, v27, s42
    v_bitop3_b32 v31, v4, v13, v31 bitop3:0xca
    s_setprio 2
    s_add_u32 s44, s96, 0x1400000
    v_lshlrev_b32 v68, 1, v1
    buffer_load_dwordx4 v[68:71], v68, s[8:11], s44 offen nt
    s_add_u32 s45, s96, 0x1400000
    v_lshlrev_b32 v72, 1, v1
    buffer_load_dwordx4 v[72:75], v72, s[12:15], s45 offen nt
    s_waitcnt vmcnt(8)
    v_lshlrev_b32 v7, 16, v44
    v_and_b32 v8, 0xffff0000, v44
    v_lshlrev_b32 v9, 16, v45
    v_and_b32 v10, 0xffff0000, v45
    v_mul_f32 v7, 0.15915494, v7
    v_mul_f32 v8, 0.15915494, v8
    v_mul_f32 v9, 0.15915494, v9
    v_mul_f32 v10, 0.15915494, v10
    v_mul_hi_u32_u24 v14, 429497, v36
    v_lshrrev_b32 v12, 3, v40
    v_cos_f32 v7, v7
    v_lshlrev_b16 v13, 3, v40
    v_mad_i32_i24 v11, v14, s55, v36
    v_bitop3_b32 v12, v6, v13, v12 bitop3:0xca
    v_lshl_add_u32 v11, v11, 17, s40
    v_lshlrev_b16 v14, 8, v14
    v_lshrrev_b32 v13, 2, v40
    v_add_u32 v36, v12, v11
    v_bitop3_b32 v40, v5, v13, v14 bitop3:0xea
    ds_add_u32 v40, v2
    v_mul_hi_u32_u24 v14, 429497, v37
    v_lshrrev_b32 v12, 3, v41
    v_cos_f32 v8, v8
    v_lshlrev_b16 v13, 3, v41
    v_mad_i32_i24 v11, v14, s55, v37
    v_bitop3_b32 v12, v6, v13, v12 bitop3:0xca
    v_lshl_add_u32 v11, v11, 17, s40
    v_lshlrev_b16 v14, 8, v14
    v_lshrrev_b32 v13, 2, v41
    v_add_u32 v37, v12, v11
    v_bitop3_b32 v41, v5, v13, v14 bitop3:0xea
    ds_add_u32 v41, v2
    v_cvt_pk_bf16_f32 v44, v7, v8
    v_perm_b32 v12, v44, v44, s41
    v_bitop3_b32 v36, v4, v12, v36 bitop3:0xca
    v_perm_b32 v13, v44, v44, s42
    v_bitop3_b32 v37, v4, v13, v37 bitop3:0xca
    v_mul_hi_u32_u24 v14, 429497, v38
    v_lshrrev_b32 v12, 3, v42
    v_cos_f32 v9, v9
    v_lshlrev_b16 v13, 3, v42
    v_mad_i32_i24 v11, v14, s55, v38
    v_bitop3_b32 v12, v6, v13, v12 bitop3:0xca
    v_lshl_add_u32 v11, v11, 17, s40
    v_lshlrev_b16 v14, 8, v14
    v_lshrrev_b32 v13, 2, v42
    v_add_u32 v38, v12, v11
    v_bitop3_b32 v42, v5, v13, v14 bitop3:0xea
    ds_add_u32 v42, v2
    v_mul_hi_u32_u24 v14, 429497, v39
    v_lshrrev_b32 v12, 3, v43
    v_cos_f32 v10, v10
    v_lshlrev_b16 v13, 3, v43
    v_mad_i32_i24 v11, v14, s55, v39
    v_bitop3_b32 v12, v6, v13, v12 bitop3:0xca
    v_lshl_add_u32 v11, v11, 17, s40
    v_lshlrev_b16 v14, 8, v14
    v_lshrrev_b32 v13, 2, v43
    v_add_u32 v39, v12, v11
    v_bitop3_b32 v43, v5, v13, v14 bitop3:0xea
    ds_add_u32 v43, v2
    v_cvt_pk_bf16_f32 v45, v9, v10
    v_perm_b32 v12, v45, v45, s41
    v_bitop3_b32 v38, v4, v12, v38 bitop3:0xca
    v_perm_b32 v13, v45, v45, s42
    v_bitop3_b32 v39, v4, v13, v39 bitop3:0xca
    s_add_u32 s46, s96, 0x1800000
    v_lshlrev_b32 v76, 1, v1
    buffer_load_dwordx4 v[76:79], v76, s[8:11], s46 offen nt
    s_add_u32 s47, s96, 0x1800000
    v_lshlrev_b32 v80, 1, v1
    buffer_load_dwordx4 v[80:83], v80, s[12:15], s47 offen nt
    s_add_u32 s44, s96, 0x1800000
    s_lshr_b32 s44, s44, 1
    buffer_load_dwordx2 v[84:85], v1, s[16:19], s44 offen nt
    s_add_u32 s45, s96, 0x1c00000
    s_lshr_b32 s45, s45, 1
    buffer_load_dwordx2 v[86:87], v1, s[16:19], s45 offen nt
    s_waitcnt vmcnt(10)
    v_lshlrev_b32 v7, 16, v46
    v_and_b32 v8, 0xffff0000, v46
    v_lshlrev_b32 v9, 16, v47
    v_and_b32 v10, 0xffff0000, v47
    v_mul_f32 v7, 0.15915494, v7
    v_mul_f32 v8, 0.15915494, v8
    v_mul_f32 v9, 0.15915494, v9
    v_mul_f32 v10, 0.15915494, v10
    v_mul_hi_u32_u24 v14, 429497, v48
    v_lshrrev_b32 v12, 3, v52
    v_cos_f32 v7, v7
    v_lshlrev_b16 v13, 3, v52
    v_mad_i32_i24 v11, v14, s55, v48
    v_bitop3_b32 v12, v6, v13, v12 bitop3:0xca
    v_lshl_add_u32 v11, v11, 17, s40
    v_lshlrev_b16 v14, 8, v14
    v_lshrrev_b32 v13, 2, v52
    v_add_u32 v48, v12, v11
    v_bitop3_b32 v52, v5, v13, v14 bitop3:0xea
    ds_add_u32 v52, v2
    v_mul_hi_u32_u24 v14, 429497, v49
    v_lshrrev_b32 v12, 3, v53
    v_cos_f32 v8, v8
    v_lshlrev_b16 v13, 3, v53
    v_mad_i32_i24 v11, v14, s55, v49
    v_bitop3_b32 v12, v6, v13, v12 bitop3:0xca
    v_lshl_add_u32 v11, v11, 17, s40
    v_lshlrev_b16 v14, 8, v14
    v_lshrrev_b32 v13, 2, v53
    v_add_u32 v49, v12, v11
    v_bitop3_b32 v53, v5, v13, v14 bitop3:0xea
    ds_add_u32 v53, v2
    v_cvt_pk_bf16_f32 v46, v7, v8
    v_perm_b32 v12, v46, v46, s41
    v_bitop3_b32 v48, v4, v12, v48 bitop3:0xca
    v_perm_b32 v13, v46, v46, s42
    v_bitop3_b32 v49, v4, v13, v49 bitop3:0xca
    v_mul_hi_u32_u24 v14, 429497, v50
    v_lshrrev_b32 v12, 3, v54
    v_cos_f32 v9, v9
    v_lshlrev_b16 v13, 3, v54
    v_mad_i32_i24 v11, v14, s55, v50
    v_bitop3_b32 v12, v6, v13, v12 bitop3:0xca
    v_lshl_add_u32 v11, v11, 17, s40
    v_lshlrev_b16 v14, 8, v14
    v_lshrrev_b32 v13, 2, v54
    v_add_u32 v50, v12, v11
    v_bitop3_b32 v54, v5, v13, v14 bitop3:0xea
    ds_add_u32 v54, v2
    v_mul_hi_u32_u24 v14, 429497, v51
    v_lshrrev_b32 v12, 3, v55
    v_cos_f32 v10, v10
    v_lshlrev_b16 v13, 3, v55
    v_mad_i32_i24 v11, v14, s55, v51
    v_bitop3_b32 v12, v6, v13, v12 bitop3:0xca
    v_lshl_add_u32 v11, v11, 17, s40
    v_lshlrev_b16 v14, 8, v14
    v_lshrrev_b32 v13, 2, v55
    v_add_u32 v51, v12, v11
    v_bitop3_b32 v55, v5, v13, v14 bitop3:0xea
    ds_add_u32 v55, v2
    v_cvt_pk_bf16_f32 v47, v9, v10
    v_perm_b32 v12, v47, v47, s41
    v_bitop3_b32 v50, v4, v12, v50 bitop3:0xca
    v_perm_b32 v13, v47, v47, s42
    v_bitop3_b32 v51, v4, v13, v51 bitop3:0xca
    s_setprio 1
    s_add_u32 s46, s96, 0x1c00000
    v_lshlrev_b32 v88, 1, v1
    buffer_load_dwordx4 v[88:91], v88, s[8:11], s46 offen nt
    s_add_u32 s47, s96, 0x1c00000
    v_lshlrev_b32 v92, 1, v1
    buffer_load_dwordx4 v[92:95], v92, s[12:15], s47 offen nt
    s_waitcnt vmcnt(8)
    v_lshlrev_b32 v7, 16, v64
    v_and_b32 v8, 0xffff0000, v64
    v_lshlrev_b32 v9, 16, v65
    v_and_b32 v10, 0xffff0000, v65
    v_mul_f32 v7, 0.15915494, v7
    v_mul_f32 v8, 0.15915494, v8
    v_mul_f32 v9, 0.15915494, v9
    v_mul_f32 v10, 0.15915494, v10
    v_mul_hi_u32_u24 v14, 429497, v56
    v_lshrrev_b32 v12, 3, v60
    v_cos_f32 v7, v7
    v_lshlrev_b16 v13, 3, v60
    v_mad_i32_i24 v11, v14, s55, v56
    v_bitop3_b32 v12, v6, v13, v12 bitop3:0xca
    v_lshl_add_u32 v11, v11, 17, s40
    v_lshlrev_b16 v14, 8, v14
    v_lshrrev_b32 v13, 2, v60
    v_add_u32 v56, v12, v11
    v_bitop3_b32 v60, v5, v13, v14 bitop3:0xea
    ds_add_u32 v60, v2
    v_mul_hi_u32_u24 v14, 429497, v57
    v_lshrrev_b32 v12, 3, v61
    v_cos_f32 v8, v8
    v_lshlrev_b16 v13, 3, v61
    v_mad_i32_i24 v11, v14, s55, v57
    v_bitop3_b32 v12, v6, v13, v12 bitop3:0xca
    v_lshl_add_u32 v11, v11, 17, s40
    v_lshlrev_b16 v14, 8, v14
    v_lshrrev_b32 v13, 2, v61
    v_add_u32 v57, v12, v11
    v_bitop3_b32 v61, v5, v13, v14 bitop3:0xea
    ds_add_u32 v61, v2
    v_cvt_pk_bf16_f32 v64, v7, v8
    v_perm_b32 v12, v64, v64, s41
    v_bitop3_b32 v56, v4, v12, v56 bitop3:0xca
    v_perm_b32 v13, v64, v64, s42
    v_bitop3_b32 v57, v4, v13, v57 bitop3:0xca
    v_mul_hi_u32_u24 v14, 429497, v58
    v_lshrrev_b32 v12, 3, v62
    v_cos_f32 v9, v9
    v_lshlrev_b16 v13, 3, v62
    v_mad_i32_i24 v11, v14, s55, v58
    v_bitop3_b32 v12, v6, v13, v12 bitop3:0xca
    v_lshl_add_u32 v11, v11, 17, s40
    v_lshlrev_b16 v14, 8, v14
    v_lshrrev_b32 v13, 2, v62
    v_add_u32 v58, v12, v11
    v_bitop3_b32 v62, v5, v13, v14 bitop3:0xea
    ds_add_u32 v62, v2
    v_mul_hi_u32_u24 v14, 429497, v59
    v_lshrrev_b32 v12, 3, v63
    v_cos_f32 v10, v10
    v_lshlrev_b16 v13, 3, v63
    v_mad_i32_i24 v11, v14, s55, v59
    v_bitop3_b32 v12, v6, v13, v12 bitop3:0xca
    v_lshl_add_u32 v11, v11, 17, s40
    v_lshlrev_b16 v14, 8, v14
    v_lshrrev_b32 v13, 2, v63
    v_add_u32 v59, v12, v11
    v_bitop3_b32 v63, v5, v13, v14 bitop3:0xea
    ds_add_u32 v63, v2
    v_cvt_pk_bf16_f32 v65, v9, v10
    v_perm_b32 v12, v65, v65, s41
    v_bitop3_b32 v58, v4, v12, v58 bitop3:0xca
    v_perm_b32 v13, v65, v65, s42
    v_bitop3_b32 v59, v4, v13, v59 bitop3:0xca
    s_add_u32 s44, s96, 0x2000000
    v_lshlrev_b32 v96, 1, v1
    buffer_load_dwordx4 v[96:99], v96, s[8:11], s44 offen nt
    s_add_u32 s45, s96, 0x2000000
    v_lshlrev_b32 v104, 1, v1
    buffer_load_dwordx4 v[104:107], v104, s[12:15], s45 offen nt
    s_add_u32 s46, s96, 0x2000000
    s_lshr_b32 s46, s46, 1
    buffer_load_dwordx2 v[108:109], v1, s[16:19], s46 offen nt
    s_add_u32 s47, s96, 0x2400000
    s_lshr_b32 s47, s47, 1
    buffer_load_dwordx2 v[110:111], v1, s[16:19], s47 offen nt
    s_waitcnt vmcnt(10)
    v_lshlrev_b32 v7, 16, v66
    v_and_b32 v8, 0xffff0000, v66
    v_lshlrev_b32 v9, 16, v67
    v_and_b32 v10, 0xffff0000, v67
    v_mul_f32 v7, 0.15915494, v7
    v_mul_f32 v8, 0.15915494, v8
    v_mul_f32 v9, 0.15915494, v9
    v_mul_f32 v10, 0.15915494, v10
    v_mul_hi_u32_u24 v14, 429497, v68
    v_lshrrev_b32 v12, 3, v72
    v_cos_f32 v7, v7
    v_lshlrev_b16 v13, 3, v72
    v_mad_i32_i24 v11, v14, s55, v68
    v_bitop3_b32 v12, v6, v13, v12 bitop3:0xca
    v_lshl_add_u32 v11, v11, 17, s40
    v_lshlrev_b16 v14, 8, v14
    v_lshrrev_b32 v13, 2, v72
    v_add_u32 v68, v12, v11
    v_bitop3_b32 v72, v5, v13, v14 bitop3:0xea
    ds_add_u32 v72, v2
    v_mul_hi_u32_u24 v14, 429497, v69
    v_lshrrev_b32 v12, 3, v73
    v_cos_f32 v8, v8
    v_lshlrev_b16 v13, 3, v73
    v_mad_i32_i24 v11, v14, s55, v69
    v_bitop3_b32 v12, v6, v13, v12 bitop3:0xca
    v_lshl_add_u32 v11, v11, 17, s40
    v_lshlrev_b16 v14, 8, v14
    v_lshrrev_b32 v13, 2, v73
    v_add_u32 v69, v12, v11
    v_bitop3_b32 v73, v5, v13, v14 bitop3:0xea
    ds_add_u32 v73, v2
    v_cvt_pk_bf16_f32 v66, v7, v8
    v_perm_b32 v12, v66, v66, s41
    v_bitop3_b32 v68, v4, v12, v68 bitop3:0xca
    v_perm_b32 v13, v66, v66, s42
    v_bitop3_b32 v69, v4, v13, v69 bitop3:0xca
    v_mul_hi_u32_u24 v14, 429497, v70
    v_lshrrev_b32 v12, 3, v74
    v_cos_f32 v9, v9
    v_lshlrev_b16 v13, 3, v74
    v_mad_i32_i24 v11, v14, s55, v70
    v_bitop3_b32 v12, v6, v13, v12 bitop3:0xca
    v_lshl_add_u32 v11, v11, 17, s40
    v_lshlrev_b16 v14, 8, v14
    v_lshrrev_b32 v13, 2, v74
    v_add_u32 v70, v12, v11
    v_bitop3_b32 v74, v5, v13, v14 bitop3:0xea
    ds_add_u32 v74, v2
    v_mul_hi_u32_u24 v14, 429497, v71
    v_lshrrev_b32 v12, 3, v75
    v_cos_f32 v10, v10
    v_lshlrev_b16 v13, 3, v75
    v_mad_i32_i24 v11, v14, s55, v71
    v_bitop3_b32 v12, v6, v13, v12 bitop3:0xca
    v_lshl_add_u32 v11, v11, 17, s40
    v_lshlrev_b16 v14, 8, v14
    v_lshrrev_b32 v13, 2, v75
    v_add_u32 v71, v12, v11
    v_bitop3_b32 v75, v5, v13, v14 bitop3:0xea
    ds_add_u32 v75, v2
    v_cvt_pk_bf16_f32 v67, v9, v10
    v_perm_b32 v12, v67, v67, s41
    v_bitop3_b32 v70, v4, v12, v70 bitop3:0xca
    v_perm_b32 v13, v67, v67, s42
    v_bitop3_b32 v71, v4, v13, v71 bitop3:0xca
    s_setprio 0
    s_add_u32 s44, s96, 0x2400000
    v_lshlrev_b32 v100, 1, v1
    buffer_load_dwordx4 v[100:103], v100, s[8:11], s44 offen nt
    s_waitcnt vmcnt(7)
    v_lshlrev_b32 v7, 16, v84
    v_and_b32 v8, 0xffff0000, v84
    v_lshlrev_b32 v9, 16, v85
    v_and_b32 v10, 0xffff0000, v85
    v_mul_f32 v7, 0.15915494, v7
    v_mul_f32 v8, 0.15915494, v8
    v_mul_f32 v9, 0.15915494, v9
    v_mul_f32 v10, 0.15915494, v10
    v_mul_hi_u32_u24 v14, 429497, v76
    v_lshrrev_b32 v12, 3, v80
    v_cos_f32 v7, v7
    v_lshlrev_b16 v13, 3, v80
    v_mad_i32_i24 v11, v14, s55, v76
    v_bitop3_b32 v12, v6, v13, v12 bitop3:0xca
    v_lshl_add_u32 v11, v11, 17, s40
    v_lshlrev_b16 v14, 8, v14
    v_lshrrev_b32 v13, 2, v80
    v_add_u32 v76, v12, v11
    v_bitop3_b32 v80, v5, v13, v14 bitop3:0xea
    ds_add_u32 v80, v2
    v_mul_hi_u32_u24 v14, 429497, v77
    v_lshrrev_b32 v12, 3, v81
    v_cos_f32 v8, v8
    v_lshlrev_b16 v13, 3, v81
    v_mad_i32_i24 v11, v14, s55, v77
    v_bitop3_b32 v12, v6, v13, v12 bitop3:0xca
    v_lshl_add_u32 v11, v11, 17, s40
    v_lshlrev_b16 v14, 8, v14
    v_lshrrev_b32 v13, 2, v81
    v_add_u32 v77, v12, v11
    v_bitop3_b32 v81, v5, v13, v14 bitop3:0xea
    ds_add_u32 v81, v2
    v_cvt_pk_bf16_f32 v84, v7, v8
    v_perm_b32 v12, v84, v84, s41
    v_bitop3_b32 v76, v4, v12, v76 bitop3:0xca
    v_perm_b32 v13, v84, v84, s42
    v_bitop3_b32 v77, v4, v13, v77 bitop3:0xca
    v_mul_hi_u32_u24 v14, 429497, v78
    v_lshrrev_b32 v12, 3, v82
    v_cos_f32 v9, v9
    v_lshlrev_b16 v13, 3, v82
    v_mad_i32_i24 v11, v14, s55, v78
    v_bitop3_b32 v12, v6, v13, v12 bitop3:0xca
    v_lshl_add_u32 v11, v11, 17, s40
    v_lshlrev_b16 v14, 8, v14
    v_lshrrev_b32 v13, 2, v82
    v_add_u32 v78, v12, v11
    v_bitop3_b32 v82, v5, v13, v14 bitop3:0xea
    ds_add_u32 v82, v2
    v_mul_hi_u32_u24 v14, 429497, v79
    v_lshrrev_b32 v12, 3, v83
    v_cos_f32 v10, v10
    v_lshlrev_b16 v13, 3, v83
    v_mad_i32_i24 v11, v14, s55, v79
    v_bitop3_b32 v12, v6, v13, v12 bitop3:0xca
    v_lshl_add_u32 v11, v11, 17, s40
    v_lshlrev_b16 v14, 8, v14
    v_lshrrev_b32 v13, 2, v83
    v_add_u32 v79, v12, v11
    v_bitop3_b32 v83, v5, v13, v14 bitop3:0xea
    ds_add_u32 v83, v2
    v_cvt_pk_bf16_f32 v85, v9, v10
    v_perm_b32 v12, v85, v85, s41
    v_bitop3_b32 v78, v4, v12, v78 bitop3:0xca
    v_perm_b32 v13, v85, v85, s42
    v_bitop3_b32 v79, v4, v13, v79 bitop3:0xca
    s_waitcnt vmcnt(5)
    v_lshlrev_b32 v7, 16, v86
    v_and_b32 v8, 0xffff0000, v86
    v_lshlrev_b32 v9, 16, v87
    v_and_b32 v10, 0xffff0000, v87
    v_mul_f32 v7, 0.15915494, v7
    v_mul_f32 v8, 0.15915494, v8
    v_mul_f32 v9, 0.15915494, v9
    v_mul_f32 v10, 0.15915494, v10
    v_mul_hi_u32_u24 v14, 429497, v88
    v_lshrrev_b32 v12, 3, v92
    v_cos_f32 v7, v7
    v_lshlrev_b16 v13, 3, v92
    v_mad_i32_i24 v11, v14, s55, v88
    v_bitop3_b32 v12, v6, v13, v12 bitop3:0xca
    v_lshl_add_u32 v11, v11, 17, s40
    v_lshlrev_b16 v14, 8, v14
    v_lshrrev_b32 v13, 2, v92
    v_add_u32 v88, v12, v11
    v_bitop3_b32 v92, v5, v13, v14 bitop3:0xea
    ds_add_u32 v92, v2
    v_mul_hi_u32_u24 v14, 429497, v89
    v_lshrrev_b32 v12, 3, v93
    v_cos_f32 v8, v8
    v_lshlrev_b16 v13, 3, v93
    v_mad_i32_i24 v11, v14, s55, v89
    v_bitop3_b32 v12, v6, v13, v12 bitop3:0xca
    v_lshl_add_u32 v11, v11, 17, s40
    v_lshlrev_b16 v14, 8, v14
    v_lshrrev_b32 v13, 2, v93
    v_add_u32 v89, v12, v11
    v_bitop3_b32 v93, v5, v13, v14 bitop3:0xea
    ds_add_u32 v93, v2
    v_cvt_pk_bf16_f32 v86, v7, v8
    v_perm_b32 v12, v86, v86, s41
    v_bitop3_b32 v88, v4, v12, v88 bitop3:0xca
    v_perm_b32 v13, v86, v86, s42
    v_bitop3_b32 v89, v4, v13, v89 bitop3:0xca
    v_mul_hi_u32_u24 v14, 429497, v90
    v_lshrrev_b32 v12, 3, v94
    v_cos_f32 v9, v9
    v_lshlrev_b16 v13, 3, v94
    v_mad_i32_i24 v11, v14, s55, v90
    v_bitop3_b32 v12, v6, v13, v12 bitop3:0xca
    v_lshl_add_u32 v11, v11, 17, s40
    v_lshlrev_b16 v14, 8, v14
    v_lshrrev_b32 v13, 2, v94
    v_add_u32 v90, v12, v11
    v_bitop3_b32 v94, v5, v13, v14 bitop3:0xea
    ds_add_u32 v94, v2
    v_mul_hi_u32_u24 v14, 429497, v91
    v_lshrrev_b32 v12, 3, v95
    v_cos_f32 v10, v10
    v_lshlrev_b16 v13, 3, v95
    v_mad_i32_i24 v11, v14, s55, v91
    v_bitop3_b32 v12, v6, v13, v12 bitop3:0xca
    v_lshl_add_u32 v11, v11, 17, s40
    v_lshlrev_b16 v14, 8, v14
    v_lshrrev_b32 v13, 2, v95
    v_add_u32 v91, v12, v11
    v_bitop3_b32 v95, v5, v13, v14 bitop3:0xea
    ds_add_u32 v95, v2
    v_cvt_pk_bf16_f32 v87, v9, v10
    v_perm_b32 v12, v87, v87, s41
    v_bitop3_b32 v90, v4, v12, v90 bitop3:0xca
    v_perm_b32 v13, v87, v87, s42
    v_bitop3_b32 v91, v4, v13, v91 bitop3:0xca
    v_lshrrev_b32 v8, 2, v0
    v_and_b32 v7, 0x3c00, v0
    v_bitop3_b32 v7, v5, v8, v7 bitop3:0xea
    s_waitcnt lgkmcnt(0)
    s_barrier
    ds_read2st64_b32 v[8:9], v7 offset0:0 offset1:1
    ds_read2st64_b32 v[10:11], v7 offset0:2 offset1:3
    s_add_u32 s45, s96, 0x2400000
    v_lshlrev_b32 v112, 1, v1
    buffer_load_dwordx4 v[112:115], v112, s[12:15], s45 offen nt
    s_waitcnt lgkmcnt(0)
    v_lshl_or_b32 v12, v9, 16, v8
    v_lshl_or_b32 v13, v11, 16, v10
    v_mov_b32 v14, v12
    v_mov_b32 v15, v13
    s_nop 0
    v_add_u32_dpp v14, v14, v14 row_shr:1 row_mask:0xf bank_mask:0xf bound_ctrl:1
    v_add_u32_dpp v15, v15, v15 row_shr:1 row_mask:0xf bank_mask:0xf bound_ctrl:1
    s_nop 0
    v_add_u32_dpp v14, v14, v14 row_shr:2 row_mask:0xf bank_mask:0xf bound_ctrl:1
    v_add_u32_dpp v15, v15, v15 row_shr:2 row_mask:0xf bank_mask:0xf bound_ctrl:1
    s_nop 0
    v_add_u32_dpp v14, v14, v14 row_shr:4 row_mask:0xf bank_mask:0xf bound_ctrl:1
    v_add_u32_dpp v15, v15, v15 row_shr:4 row_mask:0xf bank_mask:0xf bound_ctrl:1
    s_nop 0
    v_add_u32_dpp v14, v14, v14 row_shr:8 row_mask:0xf bank_mask:0xf bound_ctrl:1
    v_add_u32_dpp v15, v15, v15 row_shr:8 row_mask:0xf bank_mask:0xf bound_ctrl:1
    s_nop 0
    v_add_u32_dpp v14, v14, v14 row_bcast:15 row_mask:0xa bank_mask:0xf
    v_add_u32_dpp v15, v15, v15 row_bcast:15 row_mask:0xa bank_mask:0xf
    s_nop 0
    v_add_u32_dpp v14, v14, v14 row_bcast:31 row_mask:0xc bank_mask:0xf
    v_add_u32_dpp v15, v15, v15 row_bcast:31 row_mask:0xc bank_mask:0xf
    v_readlane_b32 s48, v14, 63
    v_readlane_b32 s49, v15, 63
    s_lshl_b32 s54, s32, 2
    v_mov_b32 v8, s54
    s_and_b32 s50, s48, 0xffff
    s_lshr_b32 s51, s48, 16
    s_and_b32 s52, s49, 0xffff
    s_lshr_b32 s53, s49, 16
    s_add_u32 s51, s51, s50
    s_add_u32 s52, s52, s51
    s_add_u32 s53, s53, s52
    v_mov_b32 v9, s53
    s_mov_b64 exec, 1
    ds_write_b32 v8, v9 offset:16384
    s_mov_b64 exec, -1
    v_and_b32 v8, 60, v7
    s_waitcnt lgkmcnt(0)
    s_barrier
    ds_read_b32 v9, v8 offset:16384
    s_waitcnt lgkmcnt(0)
    v_add_u32_dpp v9, v9, v9 row_shr:1 row_mask:0xf bank_mask:0xf bound_ctrl:1
    s_nop 1
    v_add_u32_dpp v9, v9, v9 row_shr:2 row_mask:0xf bank_mask:0xf bound_ctrl:1
    s_nop 1
    v_add_u32_dpp v9, v9, v9 row_shr:4 row_mask:0xf bank_mask:0xf bound_ctrl:1
    s_nop 1
    v_add_u32_dpp v9, v9, v9 row_shr:8 row_mask:0xf bank_mask:0xf bound_ctrl:1
    s_nop 0
    v_readlane_b32 s54, v9, s32
    s_sub_u32 s54, s54, s53
    s_add_u32 s50, s50, s54
    s_add_u32 s51, s51, s54
    s_add_u32 s52, s52, s54
    s_pack_ll_b32_b16 s48, s54, s50
    s_pack_ll_b32_b16 s49, s51, s52
    v_add_u32 v14, s48, v14
    v_add_u32 v15, s49, v15
    v_sub_u32 v12, v14, v12
    v_sub_u32 v13, v15, v13
    v_and_b32 v8, 0xffff, v12
    v_lshrrev_b32 v9, 16, v12
    v_and_b32 v10, 0xffff, v13
    v_lshrrev_b32 v11, 16, v13
    ds_write2st64_b32 v7, v8, v9 offset0:0 offset1:1
    ds_write2st64_b32 v7, v10, v11 offset0:2 offset1:3
    v_and_b32 v8, 0x3f0, v0
    v_lshl_add_u32 v8, v8, 1, s36
    ds_write_b64 v8, v[12:13] offset:20480
    s_bitset0_b64 exec, 63
    s_not_b64 exec, exec
    ds_write_b64 v8, v[14:15] offset:20512
    s_mov_b64 exec, -1
    s_waitcnt lgkmcnt(0)
    s_barrier
    s_setprio 3
    ds_add_rtn_u32 v20, v20, v2
    ds_add_rtn_u32 v21, v21, v2
    ds_add_rtn_u32 v22, v22, v2
    ds_add_rtn_u32 v23, v23, v2
    ds_read_b128 v[12:15], v0 offset:20480
    v_cmp_gt_u32 vcc, 8448, v0
    s_add_u32 s46, s96, 0x2800000
    v_lshlrev_b32 v116, 1, v1
    buffer_load_dwordx4 v[116:119], v116, s[8:11], s46 offen nt
    ds_add_rtn_u32 v32, v32, v2
    ds_add_rtn_u32 v33, v33, v2
    ds_add_rtn_u32 v34, v34, v2
    ds_add_rtn_u32 v35, v35, v2
    s_setprio 2
    ds_add_rtn_u32 v40, v40, v2
    ds_add_rtn_u32 v41, v41, v2
    ds_add_rtn_u32 v42, v42, v2
    ds_add_rtn_u32 v43, v43, v2
    s_waitcnt lgkmcnt(8)
    s_cbranch_vccz L1_p1
    s_add_u32 s47, s35, 0x0
    s_mov_b64 exec, vcc
    buffer_store_dwordx4 v[12:15], v0, s[24:27], s47 offen sc1
    s_mov_b64 exec, -1
L1_p1:
    s_add_u32 s44, s96, 0x2800000
    v_lshlrev_b32 v120, 1, v1
    buffer_load_dwordx4 v[120:123], v120, s[12:15], s44 offen nt
    ds_add_rtn_u32 v52, v52, v2
    ds_add_rtn_u32 v53, v53, v2
    ds_add_rtn_u32 v54, v54, v2
    ds_add_rtn_u32 v55, v55, v2
    s_setprio 1
    ds_add_rtn_u32 v60, v60, v2
    ds_add_rtn_u32 v61, v61, v2
    ds_add_rtn_u32 v62, v62, v2
    ds_add_rtn_u32 v63, v63, v2
    ds_add_rtn_u32 v72, v72, v2
    ds_add_rtn_u32 v73, v73, v2
    ds_add_rtn_u32 v74, v74, v2
    ds_add_rtn_u32 v75, v75, v2
    s_add_u32 s45, s96, 0x2800000
    s_lshr_b32 s45, s45, 1
    buffer_load_dwordx2 v[124:125], v1, s[16:19], s45 offen nt
    s_add_u32 s46, s96, 0x2c00000
    s_lshr_b32 s46, s46, 1
    buffer_load_dwordx2 v[126:127], v1, s[16:19], s46 offen nt
    s_setprio 0
    ds_add_rtn_u32 v80, v80, v2
    ds_add_rtn_u32 v81, v81, v2
    ds_add_rtn_u32 v82, v82, v2
    ds_add_rtn_u32 v83, v83, v2
    ds_add_rtn_u32 v92, v92, v2
    ds_add_rtn_u32 v93, v93, v2
    ds_add_rtn_u32 v94, v94, v2
    ds_add_rtn_u32 v95, v95, v2
    s_waitcnt lgkmcnt(0)
    s_barrier
    s_setprio 3
    v_and_b32 v7, -4, v20
    v_lshl_add_u32 v8, v20, 2, v7
    ds_write_b32 v8, v16
    v_lshl_add_u32 v7, v7, 2, v20
    ds_write_b8 v7, v24 offset:16
    v_and_b32 v9, -4, v21
    v_lshl_add_u32 v10, v21, 2, v9
    ds_write_b32 v10, v17
    v_lshl_add_u32 v9, v9, 2, v21
    ds_write_b8_d16_hi v9, v24 offset:16
    v_and_b32 v7, -4, v22
    v_lshl_add_u32 v8, v22, 2, v7
    ds_write_b32 v8, v18
    v_lshl_add_u32 v7, v7, 2, v22
    ds_write_b8 v7, v25 offset:16
    v_and_b32 v9, -4, v23
    v_lshl_add_u32 v10, v23, 2, v9
    ds_write_b32 v10, v19
    v_lshl_add_u32 v9, v9, 2, v23
    ds_write_b8_d16_hi v9, v25 offset:16
    s_add_u32 s47, s96, 0x2c00000
    v_lshlrev_b32 v16, 1, v1
    buffer_load_dwordx4 v[16:19], v16, s[8:11], s47 offen nt
    s_add_u32 s44, s96, 0x2c00000
    v_lshlrev_b32 v20, 1, v1
    buffer_load_dwordx4 v[20:23], v20, s[12:15], s44 offen nt
    v_and_b32 v7, -4, v32
    v_lshl_add_u32 v8, v32, 2, v7
    ds_write_b32 v8, v28
    v_lshl_add_u32 v7, v7, 2, v32
    ds_write_b8 v7, v26 offset:16
    v_and_b32 v9, -4, v33
    v_lshl_add_u32 v10, v33, 2, v9
    ds_write_b32 v10, v29
    v_lshl_add_u32 v9, v9, 2, v33
    ds_write_b8_d16_hi v9, v26 offset:16
    v_and_b32 v7, -4, v34
    v_lshl_add_u32 v8, v34, 2, v7
    ds_write_b32 v8, v30
    v_lshl_add_u32 v7, v7, 2, v34
    ds_write_b8 v7, v27 offset:16
    v_and_b32 v9, -4, v35
    v_lshl_add_u32 v10, v35, 2, v9
    ds_write_b32 v10, v31
    v_lshl_add_u32 v9, v9, 2, v35
    ds_write_b8_d16_hi v9, v27 offset:16
    s_add_u32 s45, s96, 0x3000000
    v_lshlrev_b32 v28, 1, v1
    buffer_load_dwordx4 v[28:31], v28, s[8:11], s45 offen nt
    s_waitcnt vmcnt(9)
    v_lshlrev_b32 v7, 16, v108
    v_and_b32 v8, 0xffff0000, v108
    v_lshlrev_b32 v9, 16, v109
    v_and_b32 v10, 0xffff0000, v109
    v_mul_f32 v7, 0.15915494, v7
    v_mul_f32 v8, 0.15915494, v8
    v_mul_f32 v9, 0.15915494, v9
    v_mul_f32 v10, 0.15915494, v10
    v_mul_hi_u32_u24 v14, 429497, v96
    v_lshrrev_b32 v12, 3, v104
    v_cos_f32 v7, v7
    v_lshlrev_b16 v13, 3, v104
    v_mad_i32_i24 v11, v14, s55, v96
    v_bitop3_b32 v12, v6, v13, v12 bitop3:0xca
    v_lshl_add_u32 v11, v11, 17, s40
    v_lshlrev_b16 v14, 8, v14
    v_lshrrev_b32 v13, 2, v104
    v_add_u32 v96, v12, v11
    v_bitop3_b32 v104, v5, v13, v14 bitop3:0xea
    v_mul_hi_u32_u24 v14, 429497, v97
    v_lshrrev_b32 v12, 3, v105
    v_cos_f32 v8, v8
    v_lshlrev_b16 v13, 3, v105
    v_mad_i32_i24 v11, v14, s55, v97
    v_bitop3_b32 v12, v6, v13, v12 bitop3:0xca
    v_lshl_add_u32 v11, v11, 17, s40
    v_lshlrev_b16 v14, 8, v14
    v_lshrrev_b32 v13, 2, v105
    v_add_u32 v97, v12, v11
    v_bitop3_b32 v105, v5, v13, v14 bitop3:0xea
    v_cvt_pk_bf16_f32 v108, v7, v8
    v_perm_b32 v12, v108, v108, s41
    v_bitop3_b32 v96, v4, v12, v96 bitop3:0xca
    v_perm_b32 v13, v108, v108, s42
    v_bitop3_b32 v97, v4, v13, v97 bitop3:0xca
    v_mul_hi_u32_u24 v14, 429497, v98
    v_lshrrev_b32 v12, 3, v106
    v_cos_f32 v9, v9
    v_lshlrev_b16 v13, 3, v106
    v_mad_i32_i24 v11, v14, s55, v98
    v_bitop3_b32 v12, v6, v13, v12 bitop3:0xca
    v_lshl_add_u32 v11, v11, 17, s40
    v_lshlrev_b16 v14, 8, v14
    v_lshrrev_b32 v13, 2, v106
    v_add_u32 v98, v12, v11
    v_bitop3_b32 v106, v5, v13, v14 bitop3:0xea
    v_mul_hi_u32_u24 v14, 429497, v99
    v_lshrrev_b32 v12, 3, v107
    v_cos_f32 v10, v10
    v_lshlrev_b16 v13, 3, v107
    v_mad_i32_i24 v11, v14, s55, v99
    v_bitop3_b32 v12, v6, v13, v12 bitop3:0xca
    v_lshl_add_u32 v11, v11, 17, s40
    v_lshlrev_b16 v14, 8, v14
    v_lshrrev_b32 v13, 2, v107
    v_add_u32 v99, v12, v11
    v_bitop3_b32 v107, v5, v13, v14 bitop3:0xea
    v_cvt_pk_bf16_f32 v109, v9, v10
    v_perm_b32 v12, v109, v109, s41
    v_bitop3_b32 v98, v4, v12, v98 bitop3:0xca
    v_perm_b32 v13, v109, v109, s42
    v_bitop3_b32 v99, v4, v13, v99 bitop3:0xca
    s_setprio 2
    v_and_b32 v7, -4, v40
    v_lshl_add_u32 v8, v40, 2, v7
    ds_write_b32 v8, v36
    v_lshl_add_u32 v7, v7, 2, v40
    ds_write_b8 v7, v44 offset:16
    v_and_b32 v9, -4, v41
    v_lshl_add_u32 v10, v41, 2, v9
    ds_write_b32 v10, v37
    v_lshl_add_u32 v9, v9, 2, v41
    ds_write_b8_d16_hi v9, v44 offset:16
    v_and_b32 v7, -4, v42
    v_lshl_add_u32 v8, v42, 2, v7
    ds_write_b32 v8, v38
    v_lshl_add_u32 v7, v7, 2, v42
    ds_write_b8 v7, v45 offset:16
    v_and_b32 v9, -4, v43
    v_lshl_add_u32 v10, v43, 2, v9
    ds_write_b32 v10, v39
    v_lshl_add_u32 v9, v9, 2, v43
    ds_write_b8_d16_hi v9, v45 offset:16
    s_add_u32 s46, s96, 0x3000000
    v_lshlrev_b32 v32, 1, v1
    buffer_load_dwordx4 v[32:35], v32, s[12:15], s46 offen nt
    s_waitcnt vmcnt(8)
    v_lshlrev_b32 v7, 16, v110
    v_and_b32 v8, 0xffff0000, v110
    v_lshlrev_b32 v9, 16, v111
    v_and_b32 v10, 0xffff0000, v111
    v_mul_f32 v7, 0.15915494, v7
    v_mul_f32 v8, 0.15915494, v8
    v_mul_f32 v9, 0.15915494, v9
    v_mul_f32 v10, 0.15915494, v10
    v_mul_hi_u32_u24 v14, 429497, v100
    v_lshrrev_b32 v12, 3, v112
    v_cos_f32 v7, v7
    v_lshlrev_b16 v13, 3, v112
    v_mad_i32_i24 v11, v14, s55, v100
    v_bitop3_b32 v12, v6, v13, v12 bitop3:0xca
    v_lshl_add_u32 v11, v11, 17, s40
    v_lshlrev_b16 v14, 8, v14
    v_lshrrev_b32 v13, 2, v112
    v_add_u32 v100, v12, v11
    v_bitop3_b32 v112, v5, v13, v14 bitop3:0xea
    v_mul_hi_u32_u24 v14, 429497, v101
    v_lshrrev_b32 v12, 3, v113
    v_cos_f32 v8, v8
    v_lshlrev_b16 v13, 3, v113
    v_mad_i32_i24 v11, v14, s55, v101
    v_bitop3_b32 v12, v6, v13, v12 bitop3:0xca
    v_lshl_add_u32 v11, v11, 17, s40
    v_lshlrev_b16 v14, 8, v14
    v_lshrrev_b32 v13, 2, v113
    v_add_u32 v101, v12, v11
    v_bitop3_b32 v113, v5, v13, v14 bitop3:0xea
    v_cvt_pk_bf16_f32 v110, v7, v8
    v_perm_b32 v12, v110, v110, s41
    v_bitop3_b32 v100, v4, v12, v100 bitop3:0xca
    v_perm_b32 v13, v110, v110, s42
    v_bitop3_b32 v101, v4, v13, v101 bitop3:0xca
    v_mul_hi_u32_u24 v14, 429497, v102
    v_lshrrev_b32 v12, 3, v114
    v_cos_f32 v9, v9
    v_lshlrev_b16 v13, 3, v114
    v_mad_i32_i24 v11, v14, s55, v102
    v_bitop3_b32 v12, v6, v13, v12 bitop3:0xca
    v_lshl_add_u32 v11, v11, 17, s40
    v_lshlrev_b16 v14, 8, v14
    v_lshrrev_b32 v13, 2, v114
    v_add_u32 v102, v12, v11
    v_bitop3_b32 v114, v5, v13, v14 bitop3:0xea
    v_mul_hi_u32_u24 v14, 429497, v103
    v_lshrrev_b32 v12, 3, v115
    v_cos_f32 v10, v10
    v_lshlrev_b16 v13, 3, v115
    v_mad_i32_i24 v11, v14, s55, v103
    v_bitop3_b32 v12, v6, v13, v12 bitop3:0xca
    v_lshl_add_u32 v11, v11, 17, s40
    v_lshlrev_b16 v14, 8, v14
    v_lshrrev_b32 v13, 2, v115
    v_add_u32 v103, v12, v11
    v_bitop3_b32 v115, v5, v13, v14 bitop3:0xea
    v_cvt_pk_bf16_f32 v111, v9, v10
    v_perm_b32 v12, v111, v111, s41
    v_bitop3_b32 v102, v4, v12, v102 bitop3:0xca
    v_perm_b32 v13, v111, v111, s42
    v_bitop3_b32 v103, v4, v13, v103 bitop3:0xca
    v_and_b32 v7, -4, v52
    v_lshl_add_u32 v8, v52, 2, v7
    ds_write_b32 v8, v48
    v_lshl_add_u32 v7, v7, 2, v52
    ds_write_b8 v7, v46 offset:16
    v_and_b32 v9, -4, v53
    v_lshl_add_u32 v10, v53, 2, v9
    ds_write_b32 v10, v49
    v_lshl_add_u32 v9, v9, 2, v53
    ds_write_b8_d16_hi v9, v46 offset:16
    v_and_b32 v7, -4, v54
    v_lshl_add_u32 v8, v54, 2, v7
    ds_write_b32 v8, v50
    v_lshl_add_u32 v7, v7, 2, v54
    ds_write_b8 v7, v47 offset:16
    v_and_b32 v9, -4, v55
    v_lshl_add_u32 v10, v55, 2, v9
    ds_write_b32 v10, v51
    v_lshl_add_u32 v9, v9, 2, v55
    ds_write_b8_d16_hi v9, v47 offset:16
    s_add_u32 s47, s96, 0x3000000
    s_lshr_b32 s47, s47, 1
    buffer_load_dwordx2 v[24:25], v1, s[16:19], s47 offen nt
    s_add_u32 s44, s96, 0x3400000
    s_lshr_b32 s44, s44, 1
    buffer_load_dwordx2 v[26:27], v1, s[16:19], s44 offen nt
    s_waitcnt vmcnt(6)
    v_lshlrev_b32 v7, 16, v124
    v_and_b32 v8, 0xffff0000, v124
    v_lshlrev_b32 v9, 16, v125
    v_and_b32 v10, 0xffff0000, v125
    v_mul_f32 v7, 0.15915494, v7
    v_mul_f32 v8, 0.15915494, v8
    v_mul_f32 v9, 0.15915494, v9
    v_mul_f32 v10, 0.15915494, v10
    v_mul_hi_u32_u24 v14, 429497, v116
    v_lshrrev_b32 v12, 3, v120
    v_cos_f32 v7, v7
    v_lshlrev_b16 v13, 3, v120
    v_mad_i32_i24 v11, v14, s55, v116
    v_bitop3_b32 v12, v6, v13, v12 bitop3:0xca
    v_lshl_add_u32 v11, v11, 17, s40
    v_lshlrev_b16 v14, 8, v14
    v_lshrrev_b32 v13, 2, v120
    v_add_u32 v116, v12, v11
    v_bitop3_b32 v120, v5, v13, v14 bitop3:0xea
    v_mul_hi_u32_u24 v14, 429497, v117
    v_lshrrev_b32 v12, 3, v121
    v_cos_f32 v8, v8
    v_lshlrev_b16 v13, 3, v121
    v_mad_i32_i24 v11, v14, s55, v117
    v_bitop3_b32 v12, v6, v13, v12 bitop3:0xca
    v_lshl_add_u32 v11, v11, 17, s40
    v_lshlrev_b16 v14, 8, v14
    v_lshrrev_b32 v13, 2, v121
    v_add_u32 v117, v12, v11
    v_bitop3_b32 v121, v5, v13, v14 bitop3:0xea
    v_cvt_pk_bf16_f32 v124, v7, v8
    v_perm_b32 v12, v124, v124, s41
    v_bitop3_b32 v116, v4, v12, v116 bitop3:0xca
    v_perm_b32 v13, v124, v124, s42
    v_bitop3_b32 v117, v4, v13, v117 bitop3:0xca
    v_mul_hi_u32_u24 v14, 429497, v118
    v_lshrrev_b32 v12, 3, v122
    v_cos_f32 v9, v9
    v_lshlrev_b16 v13, 3, v122
    v_mad_i32_i24 v11, v14, s55, v118
    v_bitop3_b32 v12, v6, v13, v12 bitop3:0xca
    v_lshl_add_u32 v11, v11, 17, s40
    v_lshlrev_b16 v14, 8, v14
    v_lshrrev_b32 v13, 2, v122
    v_add_u32 v118, v12, v11
    v_bitop3_b32 v122, v5, v13, v14 bitop3:0xea
    v_mul_hi_u32_u24 v14, 429497, v119
    v_lshrrev_b32 v12, 3, v123
    v_cos_f32 v10, v10
    v_lshlrev_b16 v13, 3, v123
    v_mad_i32_i24 v11, v14, s55, v119
    v_bitop3_b32 v12, v6, v13, v12 bitop3:0xca
    v_lshl_add_u32 v11, v11, 17, s40
    v_lshlrev_b16 v14, 8, v14
    v_lshrrev_b32 v13, 2, v123
    v_add_u32 v119, v12, v11
    v_bitop3_b32 v123, v5, v13, v14 bitop3:0xea
    v_cvt_pk_bf16_f32 v125, v9, v10
    v_perm_b32 v12, v125, v125, s41
    v_bitop3_b32 v118, v4, v12, v118 bitop3:0xca
    v_perm_b32 v13, v125, v125, s42
    v_bitop3_b32 v119, v4, v13, v119 bitop3:0xca
    s_setprio 1
    v_and_b32 v7, -4, v60
    v_lshl_add_u32 v8, v60, 2, v7
    ds_write_b32 v8, v56
    v_lshl_add_u32 v7, v7, 2, v60
    ds_write_b8 v7, v64 offset:16
    v_and_b32 v9, -4, v61
    v_lshl_add_u32 v10, v61, 2, v9
    ds_write_b32 v10, v57
    v_lshl_add_u32 v9, v9, 2, v61
    ds_write_b8_d16_hi v9, v64 offset:16
    v_and_b32 v7, -4, v62
    v_lshl_add_u32 v8, v62, 2, v7
    ds_write_b32 v8, v58
    v_lshl_add_u32 v7, v7, 2, v62
    ds_write_b8 v7, v65 offset:16
    v_and_b32 v9, -4, v63
    v_lshl_add_u32 v10, v63, 2, v9
    ds_write_b32 v10, v59
    v_lshl_add_u32 v9, v9, 2, v63
    ds_write_b8_d16_hi v9, v65 offset:16
    s_add_u32 s45, s96, 0x3400000
    v_lshlrev_b32 v36, 1, v1
    buffer_load_dwordx4 v[36:39], v36, s[8:11], s45 offen nt
    s_add_u32 s46, s96, 0x3400000
    v_lshlrev_b32 v40, 1, v1
    buffer_load_dwordx4 v[40:43], v40, s[12:15], s46 offen nt
    v_and_b32 v7, -4, v72
    v_lshl_add_u32 v8, v72, 2, v7
    ds_write_b32 v8, v68
    v_lshl_add_u32 v7, v7, 2, v72
    ds_write_b8 v7, v66 offset:16
    v_and_b32 v9, -4, v73
    v_lshl_add_u32 v10, v73, 2, v9
    ds_write_b32 v10, v69
    v_lshl_add_u32 v9, v9, 2, v73
    ds_write_b8_d16_hi v9, v66 offset:16
    v_and_b32 v7, -4, v74
    v_lshl_add_u32 v8, v74, 2, v7
    ds_write_b32 v8, v70
    v_lshl_add_u32 v7, v7, 2, v74
    ds_write_b8 v7, v67 offset:16
    v_and_b32 v9, -4, v75
    v_lshl_add_u32 v10, v75, 2, v9
    ds_write_b32 v10, v71
    v_lshl_add_u32 v9, v9, 2, v75
    ds_write_b8_d16_hi v9, v67 offset:16
    s_add_u32 s47, s96, 0x3800000
    v_lshlrev_b32 v48, 1, v1
    buffer_load_dwordx4 v[48:51], v48, s[8:11], s47 offen nt
    s_waitcnt vmcnt(7)
    v_lshlrev_b32 v7, 16, v126
    v_and_b32 v8, 0xffff0000, v126
    v_lshlrev_b32 v9, 16, v127
    v_and_b32 v10, 0xffff0000, v127
    v_mul_f32 v7, 0.15915494, v7
    v_mul_f32 v8, 0.15915494, v8
    v_mul_f32 v9, 0.15915494, v9
    v_mul_f32 v10, 0.15915494, v10
    v_mul_hi_u32_u24 v14, 429497, v16
    v_lshrrev_b32 v12, 3, v20
    v_cos_f32 v7, v7
    v_lshlrev_b16 v13, 3, v20
    v_mad_i32_i24 v11, v14, s55, v16
    v_bitop3_b32 v12, v6, v13, v12 bitop3:0xca
    v_lshl_add_u32 v11, v11, 17, s40
    v_lshlrev_b16 v14, 8, v14
    v_lshrrev_b32 v13, 2, v20
    v_add_u32 v16, v12, v11
    v_bitop3_b32 v20, v5, v13, v14 bitop3:0xea
    v_mul_hi_u32_u24 v14, 429497, v17
    v_lshrrev_b32 v12, 3, v21
    v_cos_f32 v8, v8
    v_lshlrev_b16 v13, 3, v21
    v_mad_i32_i24 v11, v14, s55, v17
    v_bitop3_b32 v12, v6, v13, v12 bitop3:0xca
    v_lshl_add_u32 v11, v11, 17, s40
    v_lshlrev_b16 v14, 8, v14
    v_lshrrev_b32 v13, 2, v21
    v_add_u32 v17, v12, v11
    v_bitop3_b32 v21, v5, v13, v14 bitop3:0xea
    v_cvt_pk_bf16_f32 v126, v7, v8
    v_perm_b32 v12, v126, v126, s41
    v_bitop3_b32 v16, v4, v12, v16 bitop3:0xca
    v_perm_b32 v13, v126, v126, s42
    v_bitop3_b32 v17, v4, v13, v17 bitop3:0xca
    v_mul_hi_u32_u24 v14, 429497, v18
    v_lshrrev_b32 v12, 3, v22
    v_cos_f32 v9, v9
    v_lshlrev_b16 v13, 3, v22
    v_mad_i32_i24 v11, v14, s55, v18
    v_bitop3_b32 v12, v6, v13, v12 bitop3:0xca
    v_lshl_add_u32 v11, v11, 17, s40
    v_lshlrev_b16 v14, 8, v14
    v_lshrrev_b32 v13, 2, v22
    v_add_u32 v18, v12, v11
    v_bitop3_b32 v22, v5, v13, v14 bitop3:0xea
    v_mul_hi_u32_u24 v14, 429497, v19
    v_lshrrev_b32 v12, 3, v23
    v_cos_f32 v10, v10
    v_lshlrev_b16 v13, 3, v23
    v_mad_i32_i24 v11, v14, s55, v19
    v_bitop3_b32 v12, v6, v13, v12 bitop3:0xca
    v_lshl_add_u32 v11, v11, 17, s40
    v_lshlrev_b16 v14, 8, v14
    v_lshrrev_b32 v13, 2, v23
    v_add_u32 v19, v12, v11
    v_bitop3_b32 v23, v5, v13, v14 bitop3:0xea
    v_cvt_pk_bf16_f32 v127, v9, v10
    v_perm_b32 v12, v127, v127, s41
    v_bitop3_b32 v18, v4, v12, v18 bitop3:0xca
    v_perm_b32 v13, v127, v127, s42
    v_bitop3_b32 v19, v4, v13, v19 bitop3:0xca
    s_setprio 0
    v_and_b32 v7, -4, v80
    v_lshl_add_u32 v8, v80, 2, v7
    ds_write_b32 v8, v76
    v_lshl_add_u32 v7, v7, 2, v80
    ds_write_b8 v7, v84 offset:16
    v_and_b32 v9, -4, v81
    v_lshl_add_u32 v10, v81, 2, v9
    ds_write_b32 v10, v77
    v_lshl_add_u32 v9, v9, 2, v81
    ds_write_b8_d16_hi v9, v84 offset:16
    v_and_b32 v7, -4, v82
    v_lshl_add_u32 v8, v82, 2, v7
    ds_write_b32 v8, v78
    v_lshl_add_u32 v7, v7, 2, v82
    ds_write_b8 v7, v85 offset:16
    v_and_b32 v9, -4, v83
    v_lshl_add_u32 v10, v83, 2, v9
    ds_write_b32 v10, v79
    v_lshl_add_u32 v9, v9, 2, v83
    ds_write_b8_d16_hi v9, v85 offset:16
    s_add_u32 s44, s96, 0x3800000
    v_lshlrev_b32 v52, 1, v1
    buffer_load_dwordx4 v[52:55], v52, s[12:15], s44 offen nt
    s_waitcnt vmcnt(4)
    v_lshlrev_b32 v7, 16, v24
    v_and_b32 v8, 0xffff0000, v24
    v_lshlrev_b32 v9, 16, v25
    v_and_b32 v10, 0xffff0000, v25
    v_mul_f32 v7, 0.15915494, v7
    v_mul_f32 v8, 0.15915494, v8
    v_mul_f32 v9, 0.15915494, v9
    v_mul_f32 v10, 0.15915494, v10
    v_mul_hi_u32_u24 v14, 429497, v28
    v_lshrrev_b32 v12, 3, v32
    v_cos_f32 v7, v7
    v_lshlrev_b16 v13, 3, v32
    v_mad_i32_i24 v11, v14, s55, v28
    v_bitop3_b32 v12, v6, v13, v12 bitop3:0xca
    v_lshl_add_u32 v11, v11, 17, s40
    v_lshlrev_b16 v14, 8, v14
    v_lshrrev_b32 v13, 2, v32
    v_add_u32 v28, v12, v11
    v_bitop3_b32 v32, v5, v13, v14 bitop3:0xea
    v_mul_hi_u32_u24 v14, 429497, v29
    v_lshrrev_b32 v12, 3, v33
    v_cos_f32 v8, v8
    v_lshlrev_b16 v13, 3, v33
    v_mad_i32_i24 v11, v14, s55, v29
    v_bitop3_b32 v12, v6, v13, v12 bitop3:0xca
    v_lshl_add_u32 v11, v11, 17, s40
    v_lshlrev_b16 v14, 8, v14
    v_lshrrev_b32 v13, 2, v33
    v_add_u32 v29, v12, v11
    v_bitop3_b32 v33, v5, v13, v14 bitop3:0xea
    v_cvt_pk_bf16_f32 v24, v7, v8
    v_perm_b32 v12, v24, v24, s41
    v_bitop3_b32 v28, v4, v12, v28 bitop3:0xca
    v_perm_b32 v13, v24, v24, s42
    v_bitop3_b32 v29, v4, v13, v29 bitop3:0xca
    v_mul_hi_u32_u24 v14, 429497, v30
    v_lshrrev_b32 v12, 3, v34
    v_cos_f32 v9, v9
    v_lshlrev_b16 v13, 3, v34
    v_mad_i32_i24 v11, v14, s55, v30
    v_bitop3_b32 v12, v6, v13, v12 bitop3:0xca
    v_lshl_add_u32 v11, v11, 17, s40
    v_lshlrev_b16 v14, 8, v14
    v_lshrrev_b32 v13, 2, v34
    v_add_u32 v30, v12, v11
    v_bitop3_b32 v34, v5, v13, v14 bitop3:0xea
    v_mul_hi_u32_u24 v14, 429497, v31
    v_lshrrev_b32 v12, 3, v35
    v_cos_f32 v10, v10
    v_lshlrev_b16 v13, 3, v35
    v_mad_i32_i24 v11, v14, s55, v31
    v_bitop3_b32 v12, v6, v13, v12 bitop3:0xca
    v_lshl_add_u32 v11, v11, 17, s40
    v_lshlrev_b16 v14, 8, v14
    v_lshrrev_b32 v13, 2, v35
    v_add_u32 v31, v12, v11
    v_bitop3_b32 v35, v5, v13, v14 bitop3:0xea
    v_cvt_pk_bf16_f32 v25, v9, v10
    v_perm_b32 v12, v25, v25, s41
    v_bitop3_b32 v30, v4, v12, v30 bitop3:0xca
    v_perm_b32 v13, v25, v25, s42
    v_bitop3_b32 v31, v4, v13, v31 bitop3:0xca
    v_and_b32 v7, -4, v92
    v_lshl_add_u32 v8, v92, 2, v7
    ds_write_b32 v8, v88
    v_lshl_add_u32 v7, v7, 2, v92
    ds_write_b8 v7, v86 offset:16
    v_and_b32 v9, -4, v93
    v_lshl_add_u32 v10, v93, 2, v9
    ds_write_b32 v10, v89
    v_lshl_add_u32 v9, v9, 2, v93
    ds_write_b8_d16_hi v9, v86 offset:16
    v_and_b32 v7, -4, v94
    v_lshl_add_u32 v8, v94, 2, v7
    ds_write_b32 v8, v90
    v_lshl_add_u32 v7, v7, 2, v94
    ds_write_b8 v7, v87 offset:16
    v_and_b32 v9, -4, v95
    v_lshl_add_u32 v10, v95, 2, v9
    ds_write_b32 v10, v91
    v_lshl_add_u32 v9, v9, 2, v95
    ds_write_b8_d16_hi v9, v87 offset:16
    s_add_u32 s45, s96, 0x3800000
    s_lshr_b32 s45, s45, 1
    buffer_load_dwordx2 v[44:45], v1, s[16:19], s45 offen nt
    s_add_u32 s46, s96, 0x3c00000
    s_lshr_b32 s46, s46, 1
    buffer_load_dwordx2 v[46:47], v1, s[16:19], s46 offen nt
    s_waitcnt vmcnt(4)
    v_lshlrev_b32 v7, 16, v26
    v_and_b32 v8, 0xffff0000, v26
    v_lshlrev_b32 v9, 16, v27
    v_and_b32 v10, 0xffff0000, v27
    v_mul_f32 v7, 0.15915494, v7
    v_mul_f32 v8, 0.15915494, v8
    v_mul_f32 v9, 0.15915494, v9
    v_mul_f32 v10, 0.15915494, v10
    v_mul_hi_u32_u24 v14, 429497, v36
    v_lshrrev_b32 v12, 3, v40
    v_cos_f32 v7, v7
    v_lshlrev_b16 v13, 3, v40
    v_mad_i32_i24 v11, v14, s55, v36
    v_bitop3_b32 v12, v6, v13, v12 bitop3:0xca
    v_lshl_add_u32 v11, v11, 17, s40
    v_lshlrev_b16 v14, 8, v14
    v_lshrrev_b32 v13, 2, v40
    v_add_u32 v36, v12, v11
    v_bitop3_b32 v40, v5, v13, v14 bitop3:0xea
    v_mul_hi_u32_u24 v14, 429497, v37
    v_lshrrev_b32 v12, 3, v41
    v_cos_f32 v8, v8
    v_lshlrev_b16 v13, 3, v41
    v_mad_i32_i24 v11, v14, s55, v37
    v_bitop3_b32 v12, v6, v13, v12 bitop3:0xca
    v_lshl_add_u32 v11, v11, 17, s40
    v_lshlrev_b16 v14, 8, v14
    v_lshrrev_b32 v13, 2, v41
    v_add_u32 v37, v12, v11
    v_bitop3_b32 v41, v5, v13, v14 bitop3:0xea
    v_cvt_pk_bf16_f32 v26, v7, v8
    v_perm_b32 v12, v26, v26, s41
    v_bitop3_b32 v36, v4, v12, v36 bitop3:0xca
    v_perm_b32 v13, v26, v26, s42
    v_bitop3_b32 v37, v4, v13, v37 bitop3:0xca
    v_mul_hi_u32_u24 v14, 429497, v38
    v_lshrrev_b32 v12, 3, v42
    v_cos_f32 v9, v9
    v_lshlrev_b16 v13, 3, v42
    v_mad_i32_i24 v11, v14, s55, v38
    v_bitop3_b32 v12, v6, v13, v12 bitop3:0xca
    v_lshl_add_u32 v11, v11, 17, s40
    v_lshlrev_b16 v14, 8, v14
    v_lshrrev_b32 v13, 2, v42
    v_add_u32 v38, v12, v11
    v_bitop3_b32 v42, v5, v13, v14 bitop3:0xea
    v_mul_hi_u32_u24 v14, 429497, v39
    v_lshrrev_b32 v12, 3, v43
    v_cos_f32 v10, v10
    v_lshlrev_b16 v13, 3, v43
    v_mad_i32_i24 v11, v14, s55, v39
    v_bitop3_b32 v12, v6, v13, v12 bitop3:0xca
    v_lshl_add_u32 v11, v11, 17, s40
    v_lshlrev_b16 v14, 8, v14
    v_lshrrev_b32 v13, 2, v43
    v_add_u32 v39, v12, v11
    v_bitop3_b32 v43, v5, v13, v14 bitop3:0xea
    v_cvt_pk_bf16_f32 v27, v9, v10
    v_perm_b32 v12, v27, v27, s41
    v_bitop3_b32 v38, v4, v12, v38 bitop3:0xca
    v_perm_b32 v13, v27, v27, s42
    v_bitop3_b32 v39, v4, v13, v39 bitop3:0xca
    v_add_u32 v7, s72, v0
    v_add_u32 v12, s73, v0
    v_add_u32 v13, s85, v0
    v_add_u32 v14, s91, v0
    v_add_u32 v15, s93, v0
    s_min_i32 s3, s72, s73
    s_min_i32 s3, s3, s85
    s_min_i32 s3, s3, s91
    s_min_i32 s3, s3, s93
    v_add_u32 v3, s3, v0
    v_mov_b32 v8, 0
    v_mov_b32 v9, 0
    v_mov_b32 v10, 0
    v_mov_b32 v11, 0
    s_waitcnt lgkmcnt(0)
    s_barrier
    ds_read_b128 v[56:59], v7 offset:0
    ds_read_b128 v[60:63], v12 offset:0
    ds_read_b128 v[68:71], v13 offset:0
    ds_read_b128 v[72:75], v14 offset:0
    ds_read_b128 v[64:67], v15 offset:0
    ds_write_b128 v3, v[8:11]
    ds_read_b128 v[76:79], v7 offset:16384
    ds_read_b128 v[80:83], v12 offset:16384
    ds_read_b128 v[88:91], v13 offset:16384
    ds_read_b128 v[92:95], v14 offset:16384
    ds_read_b128 v[84:87], v15 offset:16384
    s_waitcnt lgkmcnt(0)
    s_barrier
    s_setprio 3
    s_add_u32 s47, s35, 0x4000
    s_add_u32 s47, s47, s72
    buffer_store_dwordx4 v[56:59], v0, s[20:23], s47 offen sc1
    s_add_u32 s44, s96, 0x3c00000
    s_nop 0
    v_lshlrev_b32 v56, 1, v1
    buffer_load_dwordx4 v[56:59], v56, s[8:11], s44 offen nt
    s_add_u32 s45, s35, 0x4000
    s_add_u32 s45, s45, s73
    buffer_store_dwordx4 v[60:63], v0, s[20:23], s45 offen sc1
    s_add_u32 s46, s96, 0x3c00000
    s_nop 0
    v_lshlrev_b32 v60, 1, v1
    buffer_load_dwordx4 v[60:63], v60, s[12:15], s46 offen nt
    ds_add_u32 v104, v2
    ds_add_u32 v105, v2
    ds_add_u32 v106, v2
    ds_add_u32 v107, v2
    ds_add_u32 v112, v2
    ds_add_u32 v113, v2
    ds_add_u32 v114, v2
    ds_add_u32 v115, v2
    s_setprio 2
    ds_add_u32 v120, v2
    ds_add_u32 v121, v2
    ds_add_u32 v122, v2
    ds_add_u32 v123, v2
    ds_add_u32 v20, v2
    ds_add_u32 v21, v2
    ds_add_u32 v22, v2
    ds_add_u32 v23, v2
    s_setprio 1
    s_add_u32 s47, s35, 0x4000
    s_add_u32 s47, s47, s85
    buffer_store_dwordx4 v[68:71], v0, s[20:23], s47 offen sc1
    s_add_u32 s44, s96, 0x4000000
    s_nop 0
    v_lshlrev_b32 v68, 1, v1
    buffer_load_dwordx4 v[68:71], v68, s[8:11], s44 offen nt
    ds_add_u32 v32, v2
    ds_add_u32 v33, v2
    ds_add_u32 v34, v2
    ds_add_u32 v35, v2
    ds_add_u32 v40, v2
    ds_add_u32 v41, v2
    ds_add_u32 v42, v2
    ds_add_u32 v43, v2
    s_setprio 0
    s_waitcnt vmcnt(6)
    v_lshlrev_b32 v7, 16, v44
    v_and_b32 v8, 0xffff0000, v44
    v_lshlrev_b32 v9, 16, v45
    v_and_b32 v10, 0xffff0000, v45
    v_mul_f32 v7, 0.15915494, v7
    v_mul_f32 v8, 0.15915494, v8
    v_mul_f32 v9, 0.15915494, v9
    v_mul_f32 v10, 0.15915494, v10
    v_mul_hi_u32_u24 v14, 429497, v48
    v_lshrrev_b32 v12, 3, v52
    v_cos_f32 v7, v7
    v_lshlrev_b16 v13, 3, v52
    v_mad_i32_i24 v11, v14, s55, v48
    v_bitop3_b32 v12, v6, v13, v12 bitop3:0xca
    v_lshl_add_u32 v11, v11, 17, s40
    v_lshlrev_b16 v14, 8, v14
    v_lshrrev_b32 v13, 2, v52
    v_add_u32 v48, v12, v11
    v_bitop3_b32 v52, v5, v13, v14 bitop3:0xea
    ds_add_u32 v52, v2
    v_mul_hi_u32_u24 v14, 429497, v49
    v_lshrrev_b32 v12, 3, v53
    v_cos_f32 v8, v8
    v_lshlrev_b16 v13, 3, v53
    v_mad_i32_i24 v11, v14, s55, v49
    v_bitop3_b32 v12, v6, v13, v12 bitop3:0xca
    v_lshl_add_u32 v11, v11, 17, s40
    v_lshlrev_b16 v14, 8, v14
    v_lshrrev_b32 v13, 2, v53
    v_add_u32 v49, v12, v11
    v_bitop3_b32 v53, v5, v13, v14 bitop3:0xea
    ds_add_u32 v53, v2
    v_cvt_pk_bf16_f32 v44, v7, v8
    v_perm_b32 v12, v44, v44, s41
    v_bitop3_b32 v48, v4, v12, v48 bitop3:0xca
    v_perm_b32 v13, v44, v44, s42
    v_bitop3_b32 v49, v4, v13, v49 bitop3:0xca
    v_mul_hi_u32_u24 v14, 429497, v50
    v_lshrrev_b32 v12, 3, v54
    v_cos_f32 v9, v9
    v_lshlrev_b16 v13, 3, v54
    v_mad_i32_i24 v11, v14, s55, v50
    v_bitop3_b32 v12, v6, v13, v12 bitop3:0xca
    v_lshl_add_u32 v11, v11, 17, s40
    v_lshlrev_b16 v14, 8, v14
    v_lshrrev_b32 v13, 2, v54
    v_add_u32 v50, v12, v11
    v_bitop3_b32 v54, v5, v13, v14 bitop3:0xea
    ds_add_u32 v54, v2
    v_mul_hi_u32_u24 v14, 429497, v51
    v_lshrrev_b32 v12, 3, v55
    v_cos_f32 v10, v10
    v_lshlrev_b16 v13, 3, v55
    v_mad_i32_i24 v11, v14, s55, v51
    v_bitop3_b32 v12, v6, v13, v12 bitop3:0xca
    v_lshl_add_u32 v11, v11, 17, s40
    v_lshlrev_b16 v14, 8, v14
    v_lshrrev_b32 v13, 2, v55
    v_add_u32 v51, v12, v11
    v_bitop3_b32 v55, v5, v13, v14 bitop3:0xea
    ds_add_u32 v55, v2
    v_cvt_pk_bf16_f32 v45, v9, v10
    v_perm_b32 v12, v45, v45, s41
    v_bitop3_b32 v50, v4, v12, v50 bitop3:0xca
    v_perm_b32 v13, v45, v45, s42
    v_bitop3_b32 v51, v4, v13, v51 bitop3:0xca
    s_waitcnt vmcnt(2)
    v_lshlrev_b32 v7, 16, v46
    v_and_b32 v8, 0xffff0000, v46
    v_lshlrev_b32 v9, 16, v47
    v_and_b32 v10, 0xffff0000, v47
    v_mul_f32 v7, 0.15915494, v7
    v_mul_f32 v8, 0.15915494, v8
    v_mul_f32 v9, 0.15915494, v9
    v_mul_f32 v10, 0.15915494, v10
    v_mul_hi_u32_u24 v14, 429497, v56
    v_lshrrev_b32 v12, 3, v60
    v_cos_f32 v7, v7
    v_lshlrev_b16 v13, 3, v60
    v_mad_i32_i24 v11, v14, s55, v56
    v_bitop3_b32 v12, v6, v13, v12 bitop3:0xca
    v_lshl_add_u32 v11, v11, 17, s40
    v_lshlrev_b16 v14, 8, v14
    v_lshrrev_b32 v13, 2, v60
    v_add_u32 v56, v12, v11
    v_bitop3_b32 v60, v5, v13, v14 bitop3:0xea
    ds_add_u32 v60, v2
    v_mul_hi_u32_u24 v14, 429497, v57
    v_lshrrev_b32 v12, 3, v61
    v_cos_f32 v8, v8
    v_lshlrev_b16 v13, 3, v61
    v_mad_i32_i24 v11, v14, s55, v57
    v_bitop3_b32 v12, v6, v13, v12 bitop3:0xca
    v_lshl_add_u32 v11, v11, 17, s40
    v_lshlrev_b16 v14, 8, v14
    v_lshrrev_b32 v13, 2, v61
    v_add_u32 v57, v12, v11
    v_bitop3_b32 v61, v5, v13, v14 bitop3:0xea
    ds_add_u32 v61, v2
    v_cvt_pk_bf16_f32 v46, v7, v8
    v_perm_b32 v12, v46, v46, s41
    v_bitop3_b32 v56, v4, v12, v56 bitop3:0xca
    v_perm_b32 v13, v46, v46, s42
    v_bitop3_b32 v57, v4, v13, v57 bitop3:0xca
    v_mul_hi_u32_u24 v14, 429497, v58
    v_lshrrev_b32 v12, 3, v62
    v_cos_f32 v9, v9
    v_lshlrev_b16 v13, 3, v62
    v_mad_i32_i24 v11, v14, s55, v58
    v_bitop3_b32 v12, v6, v13, v12 bitop3:0xca
    v_lshl_add_u32 v11, v11, 17, s40
    v_lshlrev_b16 v14, 8, v14
    v_lshrrev_b32 v13, 2, v62
    v_add_u32 v58, v12, v11
    v_bitop3_b32 v62, v5, v13, v14 bitop3:0xea
    ds_add_u32 v62, v2
    v_mul_hi_u32_u24 v14, 429497, v59
    v_lshrrev_b32 v12, 3, v63
    v_cos_f32 v10, v10
    v_lshlrev_b16 v13, 3, v63
    v_mad_i32_i24 v11, v14, s55, v59
    v_bitop3_b32 v12, v6, v13, v12 bitop3:0xca
    v_lshl_add_u32 v11, v11, 17, s40
    v_lshlrev_b16 v14, 8, v14
    v_lshrrev_b32 v13, 2, v63
    v_add_u32 v59, v12, v11
    v_bitop3_b32 v63, v5, v13, v14 bitop3:0xea
    ds_add_u32 v63, v2
    v_cvt_pk_bf16_f32 v47, v9, v10
    v_perm_b32 v12, v47, v47, s41
    v_bitop3_b32 v58, v4, v12, v58 bitop3:0xca
    v_perm_b32 v13, v47, v47, s42
    v_bitop3_b32 v59, v4, v13, v59 bitop3:0xca
    v_lshrrev_b32 v8, 2, v0
    v_and_b32 v7, 0x3c00, v0
    v_bitop3_b32 v7, v5, v8, v7 bitop3:0xea
    s_waitcnt lgkmcnt(0)
    s_barrier
    ds_read2st64_b32 v[8:9], v7 offset0:0 offset1:1
    ds_read2st64_b32 v[10:11], v7 offset0:2 offset1:3
    s_add_u32 s45, s35, 0x4000
    s_add_u32 s45, s45, s91
    buffer_store_dwordx4 v[72:75], v0, s[20:23], s45 offen sc1
    s_add_u32 s46, s96, 0x4000000
    s_nop 0
    v_lshlrev_b32 v72, 1, v1
    buffer_load_dwordx4 v[72:75], v72, s[12:15], s46 offen nt
    s_waitcnt lgkmcnt(0)
    v_lshl_or_b32 v12, v9, 16, v8
    v_lshl_or_b32 v13, v11, 16, v10
    v_mov_b32 v14, v12
    v_mov_b32 v15, v13
    s_nop 0
    v_add_u32_dpp v14, v14, v14 row_shr:1 row_mask:0xf bank_mask:0xf bound_ctrl:1
    v_add_u32_dpp v15, v15, v15 row_shr:1 row_mask:0xf bank_mask:0xf bound_ctrl:1
    s_nop 0
    v_add_u32_dpp v14, v14, v14 row_shr:2 row_mask:0xf bank_mask:0xf bound_ctrl:1
    v_add_u32_dpp v15, v15, v15 row_shr:2 row_mask:0xf bank_mask:0xf bound_ctrl:1
    s_nop 0
    v_add_u32_dpp v14, v14, v14 row_shr:4 row_mask:0xf bank_mask:0xf bound_ctrl:1
    v_add_u32_dpp v15, v15, v15 row_shr:4 row_mask:0xf bank_mask:0xf bound_ctrl:1
    s_nop 0
    v_add_u32_dpp v14, v14, v14 row_shr:8 row_mask:0xf bank_mask:0xf bound_ctrl:1
    v_add_u32_dpp v15, v15, v15 row_shr:8 row_mask:0xf bank_mask:0xf bound_ctrl:1
    s_nop 0
    v_add_u32_dpp v14, v14, v14 row_bcast:15 row_mask:0xa bank_mask:0xf
    v_add_u32_dpp v15, v15, v15 row_bcast:15 row_mask:0xa bank_mask:0xf
    s_nop 0
    v_add_u32_dpp v14, v14, v14 row_bcast:31 row_mask:0xc bank_mask:0xf
    v_add_u32_dpp v15, v15, v15 row_bcast:31 row_mask:0xc bank_mask:0xf
    v_readlane_b32 s48, v14, 63
    v_readlane_b32 s49, v15, 63
    s_lshl_b32 s54, s32, 2
    v_mov_b32 v8, s54
    s_and_b32 s50, s48, 0xffff
    s_lshr_b32 s51, s48, 16
    s_and_b32 s52, s49, 0xffff
    s_lshr_b32 s53, s49, 16
    s_add_u32 s51, s51, s50
    s_add_u32 s52, s52, s51
    s_add_u32 s53, s53, s52
    v_mov_b32 v9, s53
    s_mov_b64 exec, 1
    ds_write_b32 v8, v9 offset:16384
    s_mov_b64 exec, -1
    v_and_b32 v8, 60, v7
    s_waitcnt lgkmcnt(0)
    s_barrier
    ds_read_b32 v9, v8 offset:16384
    s_waitcnt lgkmcnt(0)
    v_add_u32_dpp v9, v9, v9 row_shr:1 row_mask:0xf bank_mask:0xf bound_ctrl:1
    s_nop 1
    v_add_u32_dpp v9, v9, v9 row_shr:2 row_mask:0xf bank_mask:0xf bound_ctrl:1
    s_nop 1
    v_add_u32_dpp v9, v9, v9 row_shr:4 row_mask:0xf bank_mask:0xf bound_ctrl:1
    s_nop 1
    v_add_u32_dpp v9, v9, v9 row_shr:8 row_mask:0xf bank_mask:0xf bound_ctrl:1
    s_nop 0
    v_readlane_b32 s54, v9, s32
    s_sub_u32 s54, s54, s53
    s_add_u32 s50, s50, s54
    s_add_u32 s51, s51, s54
    s_add_u32 s52, s52, s54
    s_pack_ll_b32_b16 s48, s54, s50
    s_pack_ll_b32_b16 s49, s51, s52
    v_add_u32 v14, s48, v14
    v_add_u32 v15, s49, v15
    v_sub_u32 v12, v14, v12
    v_sub_u32 v13, v15, v13
    v_and_b32 v8, 0xffff, v12
    v_lshrrev_b32 v9, 16, v12
    v_and_b32 v10, 0xffff, v13
    v_lshrrev_b32 v11, 16, v13
    ds_write2st64_b32 v7, v8, v9 offset0:0 offset1:1
    ds_write2st64_b32 v7, v10, v11 offset0:2 offset1:3
    v_and_b32 v8, 0x3f0, v0
    v_lshl_add_u32 v8, v8, 1, s36
    ds_write_b64 v8, v[12:13] offset:20480
    s_bitset0_b64 exec, 63
    s_not_b64 exec, exec
    ds_write_b64 v8, v[14:15] offset:20512
    s_mov_b64 exec, -1
    s_waitcnt lgkmcnt(0)
    s_barrier
    s_setprio 3
    ds_add_rtn_u32 v104, v104, v2
    ds_add_rtn_u32 v105, v105, v2
    ds_add_rtn_u32 v106, v106, v2
    ds_add_rtn_u32 v107, v107, v2
    ds_read_b128 v[12:15], v0 offset:20480
    v_cmp_gt_u32 vcc, 8448, v0
    s_add_u32 s47, s35, 0x4000
    s_add_u32 s47, s47, s93
    buffer_store_dwordx4 v[64:67], v0, s[20:23], s47 offen sc1
    s_add_u32 s44, s96, 0x4000000
    s_lshr_b32 s44, s44, 1
    buffer_load_dwordx2 v[64:65], v1, s[16:19], s44 offen nt
    s_add_u32 s45, s96, 0x4400000
    s_lshr_b32 s45, s45, 1
    buffer_load_dwordx2 v[66:67], v1, s[16:19], s45 offen nt
    ds_add_rtn_u32 v112, v112, v2
    ds_add_rtn_u32 v113, v113, v2
    ds_add_rtn_u32 v114, v114, v2
    ds_add_rtn_u32 v115, v115, v2
    s_setprio 2
    ds_add_rtn_u32 v120, v120, v2
    ds_add_rtn_u32 v121, v121, v2
    ds_add_rtn_u32 v122, v122, v2
    ds_add_rtn_u32 v123, v123, v2
    s_waitcnt lgkmcnt(8)
    s_cbranch_vccz L1_p2
    s_add_u32 s46, s35, 0x2a40000
    s_mov_b64 exec, vcc
    buffer_store_dwordx4 v[12:15], v0, s[24:27], s46 offen sc1
    s_mov_b64 exec, -1
L1_p2:
    s_add_u32 s47, s35, 0x8000
    s_add_u32 s47, s47, s72
    buffer_store_dwordx4 v[76:79], v0, s[20:23], s47 offen sc1
    s_add_u32 s44, s96, 0x4400000
    s_nop 0
    v_lshlrev_b32 v76, 1, v1
    buffer_load_dwordx4 v[76:79], v76, s[8:11], s44 offen nt
    ds_add_rtn_u32 v20, v20, v2
    ds_add_rtn_u32 v21, v21, v2
    ds_add_rtn_u32 v22, v22, v2
    ds_add_rtn_u32 v23, v23, v2
    s_setprio 1
    ds_add_rtn_u32 v32, v32, v2
    ds_add_rtn_u32 v33, v33, v2
    ds_add_rtn_u32 v34, v34, v2
    ds_add_rtn_u32 v35, v35, v2
    ds_add_rtn_u32 v40, v40, v2
    ds_add_rtn_u32 v41, v41, v2
    ds_add_rtn_u32 v42, v42, v2
    ds_add_rtn_u32 v43, v43, v2
    s_add_u32 s45, s35, 0x8000
    s_add_u32 s45, s45, s73
    buffer_store_dwordx4 v[80:83], v0, s[20:23], s45 offen sc1
    s_add_u32 s46, s96, 0x4400000
    s_nop 0
    v_lshlrev_b32 v80, 1, v1
    buffer_load_dwordx4 v[80:83], v80, s[12:15], s46 offen nt
    s_setprio 0
    ds_add_rtn_u32 v52, v52, v2
    ds_add_rtn_u32 v53, v53, v2
    ds_add_rtn_u32 v54, v54, v2
    ds_add_rtn_u32 v55, v55, v2
    ds_add_rtn_u32 v60, v60, v2
    ds_add_rtn_u32 v61, v61, v2
    ds_add_rtn_u32 v62, v62, v2
    ds_add_rtn_u32 v63, v63, v2
    s_waitcnt lgkmcnt(0)
    s_barrier
    s_setprio 3
    v_and_b32 v7, -4, v104
    v_lshl_add_u32 v8, v104, 2, v7
    ds_write_b32 v8, v96
    v_lshl_add_u32 v7, v7, 2, v104
    ds_write_b8 v7, v108 offset:16
    v_and_b32 v9, -4, v105
    v_lshl_add_u32 v10, v105, 2, v9
    ds_write_b32 v10, v97
    v_lshl_add_u32 v9, v9, 2, v105
    ds_write_b8_d16_hi v9, v108 offset:16
    v_and_b32 v7, -4, v106
    v_lshl_add_u32 v8, v106, 2, v7
    ds_write_b32 v8, v98
    v_lshl_add_u32 v7, v7, 2, v106
    ds_write_b8 v7, v109 offset:16
    v_and_b32 v9, -4, v107
    v_lshl_add_u32 v10, v107, 2, v9
    ds_write_b32 v10, v99
    v_lshl_add_u32 v9, v9, 2, v107
    ds_write_b8_d16_hi v9, v109 offset:16
    s_add_u32 s47, s35, 0x8000
    s_add_u32 s47, s47, s85
    buffer_store_dwordx4 v[88:91], v0, s[20:23], s47 offen sc1
    s_add_u32 s44, s96, 0x4800000
    v_lshlrev_b32 v96, 1, v1
    buffer_load_dwordx4 v[96:99], v96, s[8:11], s44 offen nt
    s_add_u32 s45, s96, 0x4800000
    v_lshlrev_b32 v104, 1, v1
    buffer_load_dwordx4 v[104:107], v104, s[12:15], s45 offen nt
    v_and_b32 v7, -4, v112
    v_lshl_add_u32 v8, v112, 2, v7
    ds_write_b32 v8, v100
    v_lshl_add_u32 v7, v7, 2, v112
    ds_write_b8 v7, v110 offset:16
    v_and_b32 v9, -4, v113
    v_lshl_add_u32 v10, v113, 2, v9
    ds_write_b32 v10, v101
    v_lshl_add_u32 v9, v9, 2, v113
    ds_write_b8_d16_hi v9, v110 offset:16
    v_and_b32 v7, -4, v114
    v_lshl_add_u32 v8, v114, 2, v7
    ds_write_b32 v8, v102
    v_lshl_add_u32 v7, v7, 2, v114
    ds_write_b8 v7, v111 offset:16
    v_and_b32 v9, -4, v115
    v_lshl_add_u32 v10, v115, 2, v9
    ds_write_b32 v10, v103
    v_lshl_add_u32 v9, v9, 2, v115
    ds_write_b8_d16_hi v9, v111 offset:16
    s_add_u32 s46, s96, 0x4800000
    s_lshr_b32 s46, s46, 1
    buffer_load_dwordx2 v[88:89], v1, s[16:19], s46 offen nt
    s_add_u32 s47, s96, 0x4c00000
    s_lshr_b32 s47, s47, 1
    buffer_load_dwordx2 v[90:91], v1, s[16:19], s47 offen nt
    s_add_u32 s44, s96, 0x4c00000
    v_lshlrev_b32 v100, 1, v1
    buffer_load_dwordx4 v[100:103], v100, s[8:11], s44 offen nt
    s_waitcnt vmcnt(10)
    v_lshlrev_b32 v7, 16, v64
    v_and_b32 v8, 0xffff0000, v64
    v_lshlrev_b32 v9, 16, v65
    v_and_b32 v10, 0xffff0000, v65
    v_mul_f32 v7, 0.15915494, v7
    v_mul_f32 v8, 0.15915494, v8
    v_mul_f32 v9, 0.15915494, v9
    v_mul_f32 v10, 0.15915494, v10
    v_mul_hi_u32_u24 v14, 429497, v68
    v_lshrrev_b32 v12, 3, v72
    v_cos_f32 v7, v7
    v_lshlrev_b16 v13, 3, v72
    v_mad_i32_i24 v11, v14, s55, v68
    v_bitop3_b32 v12, v6, v13, v12 bitop3:0xca
    v_lshl_add_u32 v11, v11, 17, s40
    v_lshlrev_b16 v14, 8, v14
    v_lshrrev_b32 v13, 2, v72
    v_add_u32 v68, v12, v11
    v_bitop3_b32 v72, v5, v13, v14 bitop3:0xea
    v_mul_hi_u32_u24 v14, 429497, v69
    v_lshrrev_b32 v12, 3, v73
    v_cos_f32 v8, v8
    v_lshlrev_b16 v13, 3, v73
    v_mad_i32_i24 v11, v14, s55, v69
    v_bitop3_b32 v12, v6, v13, v12 bitop3:0xca
    v_lshl_add_u32 v11, v11, 17, s40
    v_lshlrev_b16 v14, 8, v14
    v_lshrrev_b32 v13, 2, v73
    v_add_u32 v69, v12, v11
    v_bitop3_b32 v73, v5, v13, v14 bitop3:0xea
    v_cvt_pk_bf16_f32 v64, v7, v8
    v_perm_b32 v12, v64, v64, s41
    v_bitop3_b32 v68, v4, v12, v68 bitop3:0xca
    v_perm_b32 v13, v64, v64, s42
    v_bitop3_b32 v69, v4, v13, v69 bitop3:0xca
    v_mul_hi_u32_u24 v14, 429497, v70
    v_lshrrev_b32 v12, 3, v74
    v_cos_f32 v9, v9
    v_lshlrev_b16 v13, 3, v74
    v_mad_i32_i24 v11, v14, s55, v70
    v_bitop3_b32 v12, v6, v13, v12 bitop3:0xca
    v_lshl_add_u32 v11, v11, 17, s40
    v_lshlrev_b16 v14, 8, v14
    v_lshrrev_b32 v13, 2, v74
    v_add_u32 v70, v12, v11
    v_bitop3_b32 v74, v5, v13, v14 bitop3:0xea
    v_mul_hi_u32_u24 v14, 429497, v71
    v_lshrrev_b32 v12, 3, v75
    v_cos_f32 v10, v10
    v_lshlrev_b16 v13, 3, v75
    v_mad_i32_i24 v11, v14, s55, v71
    v_bitop3_b32 v12, v6, v13, v12 bitop3:0xca
    v_lshl_add_u32 v11, v11, 17, s40
    v_lshlrev_b16 v14, 8, v14
    v_lshrrev_b32 v13, 2, v75
    v_add_u32 v71, v12, v11
    v_bitop3_b32 v75, v5, v13, v14 bitop3:0xea
    v_cvt_pk_bf16_f32 v65, v9, v10
    v_perm_b32 v12, v65, v65, s41
    v_bitop3_b32 v70, v4, v12, v70 bitop3:0xca
    v_perm_b32 v13, v65, v65, s42
    v_bitop3_b32 v71, v4, v13, v71 bitop3:0xca
    s_setprio 2
    v_and_b32 v7, -4, v120
    v_lshl_add_u32 v8, v120, 2, v7
    ds_write_b32 v8, v116
    v_lshl_add_u32 v7, v7, 2, v120
    ds_write_b8 v7, v124 offset:16
    v_and_b32 v9, -4, v121
    v_lshl_add_u32 v10, v121, 2, v9
    ds_write_b32 v10, v117
    v_lshl_add_u32 v9, v9, 2, v121
    ds_write_b8_d16_hi v9, v124 offset:16
    v_and_b32 v7, -4, v122
    v_lshl_add_u32 v8, v122, 2, v7
    ds_write_b32 v8, v118
    v_lshl_add_u32 v7, v7, 2, v122
    ds_write_b8 v7, v125 offset:16
    v_and_b32 v9, -4, v123
    v_lshl_add_u32 v10, v123, 2, v9
    ds_write_b32 v10, v119
    v_lshl_add_u32 v9, v9, 2, v123
    ds_write_b8_d16_hi v9, v125 offset:16
    s_add_u32 s45, s35, 0x8000
    s_add_u32 s45, s45, s91
    buffer_store_dwordx4 v[92:95], v0, s[20:23], s45 offen sc1
    s_add_u32 s46, s96, 0x4c00000
    v_lshlrev_b32 v112, 1, v1
    buffer_load_dwordx4 v[112:115], v112, s[12:15], s46 offen nt
    s_waitcnt vmcnt(8)
    v_lshlrev_b32 v7, 16, v66
    v_and_b32 v8, 0xffff0000, v66
    v_lshlrev_b32 v9, 16, v67
    v_and_b32 v10, 0xffff0000, v67
    v_mul_f32 v7, 0.15915494, v7
    v_mul_f32 v8, 0.15915494, v8
    v_mul_f32 v9, 0.15915494, v9
    v_mul_f32 v10, 0.15915494, v10
    v_mul_hi_u32_u24 v14, 429497, v76
    v_lshrrev_b32 v12, 3, v80
    v_cos_f32 v7, v7
    v_lshlrev_b16 v13, 3, v80
    v_mad_i32_i24 v11, v14, s55, v76
    v_bitop3_b32 v12, v6, v13, v12 bitop3:0xca
    v_lshl_add_u32 v11, v11, 17, s40
    v_lshlrev_b16 v14, 8, v14
    v_lshrrev_b32 v13, 2, v80
    v_add_u32 v76, v12, v11
    v_bitop3_b32 v80, v5, v13, v14 bitop3:0xea
    v_mul_hi_u32_u24 v14, 429497, v77
    v_lshrrev_b32 v12, 3, v81
    v_cos_f32 v8, v8
    v_lshlrev_b16 v13, 3, v81
    v_mad_i32_i24 v11, v14, s55, v77
    v_bitop3_b32 v12, v6, v13, v12 bitop3:0xca
    v_lshl_add_u32 v11, v11, 17, s40
    v_lshlrev_b16 v14, 8, v14
    v_lshrrev_b32 v13, 2, v81
    v_add_u32 v77, v12, v11
    v_bitop3_b32 v81, v5, v13, v14 bitop3:0xea
    v_cvt_pk_bf16_f32 v66, v7, v8
    v_perm_b32 v12, v66, v66, s41
    v_bitop3_b32 v76, v4, v12, v76 bitop3:0xca
    v_perm_b32 v13, v66, v66, s42
    v_bitop3_b32 v77, v4, v13, v77 bitop3:0xca
    v_mul_hi_u32_u24 v14, 429497, v78
    v_lshrrev_b32 v12, 3, v82
    v_cos_f32 v9, v9
    v_lshlrev_b16 v13, 3, v82
    v_mad_i32_i24 v11, v14, s55, v78
    v_bitop3_b32 v12, v6, v13, v12 bitop3:0xca
    v_lshl_add_u32 v11, v11, 17, s40
    v_lshlrev_b16 v14, 8, v14
    v_lshrrev_b32 v13, 2, v82
    v_add_u32 v78, v12, v11
    v_bitop3_b32 v82, v5, v13, v14 bitop3:0xea
    v_mul_hi_u32_u24 v14, 429497, v79
    v_lshrrev_b32 v12, 3, v83
    v_cos_f32 v10, v10
    v_lshlrev_b16 v13, 3, v83
    v_mad_i32_i24 v11, v14, s55, v79
    v_bitop3_b32 v12, v6, v13, v12 bitop3:0xca
    v_lshl_add_u32 v11, v11, 17, s40
    v_lshlrev_b16 v14, 8, v14
    v_lshrrev_b32 v13, 2, v83
    v_add_u32 v79, v12, v11
    v_bitop3_b32 v83, v5, v13, v14 bitop3:0xea
    v_cvt_pk_bf16_f32 v67, v9, v10
    v_perm_b32 v12, v67, v67, s41
    v_bitop3_b32 v78, v4, v12, v78 bitop3:0xca
    v_perm_b32 v13, v67, v67, s42
    v_bitop3_b32 v79, v4, v13, v79 bitop3:0xca
    v_and_b32 v7, -4, v20
    v_lshl_add_u32 v8, v20, 2, v7
    ds_write_b32 v8, v16
    v_lshl_add_u32 v7, v7, 2, v20
    ds_write_b8 v7, v126 offset:16
    v_and_b32 v9, -4, v21
    v_lshl_add_u32 v10, v21, 2, v9
    ds_write_b32 v10, v17
    v_lshl_add_u32 v9, v9, 2, v21
    ds_write_b8_d16_hi v9, v126 offset:16
    v_and_b32 v7, -4, v22
    v_lshl_add_u32 v8, v22, 2, v7
    ds_write_b32 v8, v18
    v_lshl_add_u32 v7, v7, 2, v22
    ds_write_b8 v7, v127 offset:16
    v_and_b32 v9, -4, v23
    v_lshl_add_u32 v10, v23, 2, v9
    ds_write_b32 v10, v19
    v_lshl_add_u32 v9, v9, 2, v23
    ds_write_b8_d16_hi v9, v127 offset:16
    s_add_u32 s47, s96, 0x5000000
    v_lshlrev_b32 v108, 1, v1
    buffer_load_dwordx4 v[108:111], v108, s[8:11], s47 offen nt
    s_add_u32 s44, s96, 0x5000000
    v_lshlrev_b32 v116, 1, v1
    buffer_load_dwordx4 v[116:119], v116, s[12:15], s44 offen nt
    s_waitcnt vmcnt(5)
    v_lshlrev_b32 v7, 16, v88
    v_and_b32 v8, 0xffff0000, v88
    v_lshlrev_b32 v9, 16, v89
    v_and_b32 v10, 0xffff0000, v89
    v_mul_f32 v7, 0.15915494, v7
    v_mul_f32 v8, 0.15915494, v8
    v_mul_f32 v9, 0.15915494, v9
    v_mul_f32 v10, 0.15915494, v10
    v_mul_hi_u32_u24 v14, 429497, v96
    v_lshrrev_b32 v12, 3, v104
    v_cos_f32 v7, v7
    v_lshlrev_b16 v13, 3, v104
    v_mad_i32_i24 v11, v14, s55, v96
    v_bitop3_b32 v12, v6, v13, v12 bitop3:0xca
    v_lshl_add_u32 v11, v11, 17, s40
    v_lshlrev_b16 v14, 8, v14
    v_lshrrev_b32 v13, 2, v104
    v_add_u32 v96, v12, v11
    v_bitop3_b32 v104, v5, v13, v14 bitop3:0xea
    v_mul_hi_u32_u24 v14, 429497, v97
    v_lshrrev_b32 v12, 3, v105
    v_cos_f32 v8, v8
    v_lshlrev_b16 v13, 3, v105
    v_mad_i32_i24 v11, v14, s55, v97
    v_bitop3_b32 v12, v6, v13, v12 bitop3:0xca
    v_lshl_add_u32 v11, v11, 17, s40
    v_lshlrev_b16 v14, 8, v14
    v_lshrrev_b32 v13, 2, v105
    v_add_u32 v97, v12, v11
    v_bitop3_b32 v105, v5, v13, v14 bitop3:0xea
    v_cvt_pk_bf16_f32 v88, v7, v8
    v_perm_b32 v12, v88, v88, s41
    v_bitop3_b32 v96, v4, v12, v96 bitop3:0xca
    v_perm_b32 v13, v88, v88, s42
    v_bitop3_b32 v97, v4, v13, v97 bitop3:0xca
    v_mul_hi_u32_u24 v14, 429497, v98
    v_lshrrev_b32 v12, 3, v106
    v_cos_f32 v9, v9
    v_lshlrev_b16 v13, 3, v106
    v_mad_i32_i24 v11, v14, s55, v98
    v_bitop3_b32 v12, v6, v13, v12 bitop3:0xca
    v_lshl_add_u32 v11, v11, 17, s40
    v_lshlrev_b16 v14, 8, v14
    v_lshrrev_b32 v13, 2, v106
    v_add_u32 v98, v12, v11
    v_bitop3_b32 v106, v5, v13, v14 bitop3:0xea
    v_mul_hi_u32_u24 v14, 429497, v99
    v_lshrrev_b32 v12, 3, v107
    v_cos_f32 v10, v10
    v_lshlrev_b16 v13, 3, v107
    v_mad_i32_i24 v11, v14, s55, v99
    v_bitop3_b32 v12, v6, v13, v12 bitop3:0xca
    v_lshl_add_u32 v11, v11, 17, s40
    v_lshlrev_b16 v14, 8, v14
    v_lshrrev_b32 v13, 2, v107
    v_add_u32 v99, v12, v11
    v_bitop3_b32 v107, v5, v13, v14 bitop3:0xea
    v_cvt_pk_bf16_f32 v89, v9, v10
    v_perm_b32 v12, v89, v89, s41
    v_bitop3_b32 v98, v4, v12, v98 bitop3:0xca
    v_perm_b32 v13, v89, v89, s42
    v_bitop3_b32 v99, v4, v13, v99 bitop3:0xca
    s_setprio 1
    v_and_b32 v7, -4, v32
    v_lshl_add_u32 v8, v32, 2, v7
    ds_write_b32 v8, v28
    v_lshl_add_u32 v7, v7, 2, v32
    ds_write_b8 v7, v24 offset:16
    v_and_b32 v9, -4, v33
    v_lshl_add_u32 v10, v33, 2, v9
    ds_write_b32 v10, v29
    v_lshl_add_u32 v9, v9, 2, v33
    ds_write_b8_d16_hi v9, v24 offset:16
    v_and_b32 v7, -4, v34
    v_lshl_add_u32 v8, v34, 2, v7
    ds_write_b32 v8, v30
    v_lshl_add_u32 v7, v7, 2, v34
    ds_write_b8 v7, v25 offset:16
    v_and_b32 v9, -4, v35
    v_lshl_add_u32 v10, v35, 2, v9
    ds_write_b32 v10, v31
    v_lshl_add_u32 v9, v9, 2, v35
    ds_write_b8_d16_hi v9, v25 offset:16
    s_add_u32 s45, s96, 0x5000000
    s_lshr_b32 s45, s45, 1
    buffer_load_dwordx2 v[120:121], v1, s[16:19], s45 offen nt
    s_add_u32 s46, s96, 0x5400000
    s_lshr_b32 s46, s46, 1
    buffer_load_dwordx2 v[122:123], v1, s[16:19], s46 offen nt
    s_add_u32 s47, s96, 0x5400000
    v_lshlrev_b32 v92, 1, v1
    buffer_load_dwordx4 v[92:95], v92, s[8:11], s47 offen nt
    v_and_b32 v7, -4, v40
    v_lshl_add_u32 v8, v40, 2, v7
    ds_write_b32 v8, v36
    v_lshl_add_u32 v7, v7, 2, v40
    ds_write_b8 v7, v26 offset:16
    v_and_b32 v9, -4, v41
    v_lshl_add_u32 v10, v41, 2, v9
    ds_write_b32 v10, v37
    v_lshl_add_u32 v9, v9, 2, v41
    ds_write_b8_d16_hi v9, v26 offset:16
    v_and_b32 v7, -4, v42
    v_lshl_add_u32 v8, v42, 2, v7
    ds_write_b32 v8, v38
    v_lshl_add_u32 v7, v7, 2, v42
    ds_write_b8 v7, v27 offset:16
    v_and_b32 v9, -4, v43
    v_lshl_add_u32 v10, v43, 2, v9
    ds_write_b32 v10, v39
    v_lshl_add_u32 v9, v9, 2, v43
    ds_write_b8_d16_hi v9, v27 offset:16
    s_add_u32 s44, s35, 0x8000
    s_add_u32 s44, s44, s93
    buffer_store_dwordx4 v[84:87], v0, s[20:23], s44 offen sc1
    s_add_u32 s45, s96, 0x5400000
    v_lshlrev_b32 v16, 1, v1
    buffer_load_dwordx4 v[16:19], v16, s[12:15], s45 offen nt
    s_waitcnt vmcnt(7)
    v_lshlrev_b32 v7, 16, v90
    v_and_b32 v8, 0xffff0000, v90
    v_lshlrev_b32 v9, 16, v91
    v_and_b32 v10, 0xffff0000, v91
    v_mul_f32 v7, 0.15915494, v7
    v_mul_f32 v8, 0.15915494, v8
    v_mul_f32 v9, 0.15915494, v9
    v_mul_f32 v10, 0.15915494, v10
    v_mul_hi_u32_u24 v14, 429497, v100
    v_lshrrev_b32 v12, 3, v112
    v_cos_f32 v7, v7
    v_lshlrev_b16 v13, 3, v112
    v_mad_i32_i24 v11, v14, s55, v100
    v_bitop3_b32 v12, v6, v13, v12 bitop3:0xca
    v_lshl_add_u32 v11, v11, 17, s40
    v_lshlrev_b16 v14, 8, v14
    v_lshrrev_b32 v13, 2, v112
    v_add_u32 v100, v12, v11
    v_bitop3_b32 v112, v5, v13, v14 bitop3:0xea
    v_mul_hi_u32_u24 v14, 429497, v101
    v_lshrrev_b32 v12, 3, v113
    v_cos_f32 v8, v8
    v_lshlrev_b16 v13, 3, v113
    v_mad_i32_i24 v11, v14, s55, v101
    v_bitop3_b32 v12, v6, v13, v12 bitop3:0xca
    v_lshl_add_u32 v11, v11, 17, s40
    v_lshlrev_b16 v14, 8, v14
    v_lshrrev_b32 v13, 2, v113
    v_add_u32 v101, v12, v11
    v_bitop3_b32 v113, v5, v13, v14 bitop3:0xea
    v_cvt_pk_bf16_f32 v90, v7, v8
    v_perm_b32 v12, v90, v90, s41
    v_bitop3_b32 v100, v4, v12, v100 bitop3:0xca
    v_perm_b32 v13, v90, v90, s42
    v_bitop3_b32 v101, v4, v13, v101 bitop3:0xca
    v_mul_hi_u32_u24 v14, 429497, v102
    v_lshrrev_b32 v12, 3, v114
    v_cos_f32 v9, v9
    v_lshlrev_b16 v13, 3, v114
    v_mad_i32_i24 v11, v14, s55, v102
    v_bitop3_b32 v12, v6, v13, v12 bitop3:0xca
    v_lshl_add_u32 v11, v11, 17, s40
    v_lshlrev_b16 v14, 8, v14
    v_lshrrev_b32 v13, 2, v114
    v_add_u32 v102, v12, v11
    v_bitop3_b32 v114, v5, v13, v14 bitop3:0xea
    v_mul_hi_u32_u24 v14, 429497, v103
    v_lshrrev_b32 v12, 3, v115
    v_cos_f32 v10, v10
    v_lshlrev_b16 v13, 3, v115
    v_mad_i32_i24 v11, v14, s55, v103
    v_bitop3_b32 v12, v6, v13, v12 bitop3:0xca
    v_lshl_add_u32 v11, v11, 17, s40
    v_lshlrev_b16 v14, 8, v14
    v_lshrrev_b32 v13, 2, v115
    v_add_u32 v103, v12, v11
    v_bitop3_b32 v115, v5, v13, v14 bitop3:0xea
    v_cvt_pk_bf16_f32 v91, v9, v10
    v_perm_b32 v12, v91, v91, s41
    v_bitop3_b32 v102, v4, v12, v102 bitop3:0xca
    v_perm_b32 v13, v91, v91, s42
    v_bitop3_b32 v103, v4, v13, v103 bitop3:0xca
    s_setprio 0
    v_and_b32 v7, -4, v52
    v_lshl_add_u32 v8, v52, 2, v7
    ds_write_b32 v8, v48
    v_lshl_add_u32 v7, v7, 2, v52
    ds_write_b8 v7, v44 offset:16
    v_and_b32 v9, -4, v53
    v_lshl_add_u32 v10, v53, 2, v9
    ds_write_b32 v10, v49
    v_lshl_add_u32 v9, v9, 2, v53
    ds_write_b8_d16_hi v9, v44 offset:16
    v_and_b32 v7, -4, v54
    v_lshl_add_u32 v8, v54, 2, v7
    ds_write_b32 v8, v50
    v_lshl_add_u32 v7, v7, 2, v54
    ds_write_b8 v7, v45 offset:16
    v_and_b32 v9, -4, v55
    v_lshl_add_u32 v10, v55, 2, v9
    ds_write_b32 v10, v51
    v_lshl_add_u32 v9, v9, 2, v55
    ds_write_b8_d16_hi v9, v45 offset:16
    s_add_u32 s46, s96, 0x5800000
    v_lshlrev_b32 v20, 1, v1
    buffer_load_dwordx4 v[20:23], v20, s[8:11], s46 offen nt
    s_add_u32 s47, s96, 0x5800000
    v_lshlrev_b32 v124, 1, v1
    buffer_load_dwordx4 v[124:127], v124, s[12:15], s47 offen nt
    s_waitcnt vmcnt(5)
    v_lshlrev_b32 v7, 16, v120
    v_and_b32 v8, 0xffff0000, v120
    v_lshlrev_b32 v9, 16, v121
    v_and_b32 v10, 0xffff0000, v121
    v_mul_f32 v7, 0.15915494, v7
    v_mul_f32 v8, 0.15915494, v8
    v_mul_f32 v9, 0.15915494, v9
    v_mul_f32 v10, 0.15915494, v10
    v_mul_hi_u32_u24 v14, 429497, v108
    v_lshrrev_b32 v12, 3, v116
    v_cos_f32 v7, v7
    v_lshlrev_b16 v13, 3, v116
    v_mad_i32_i24 v11, v14, s55, v108
    v_bitop3_b32 v12, v6, v13, v12 bitop3:0xca
    v_lshl_add_u32 v11, v11, 17, s40
    v_lshlrev_b16 v14, 8, v14
    v_lshrrev_b32 v13, 2, v116
    v_add_u32 v108, v12, v11
    v_bitop3_b32 v116, v5, v13, v14 bitop3:0xea
    v_mul_hi_u32_u24 v14, 429497, v109
    v_lshrrev_b32 v12, 3, v117
    v_cos_f32 v8, v8
    v_lshlrev_b16 v13, 3, v117
    v_mad_i32_i24 v11, v14, s55, v109
    v_bitop3_b32 v12, v6, v13, v12 bitop3:0xca
    v_lshl_add_u32 v11, v11, 17, s40
    v_lshlrev_b16 v14, 8, v14
    v_lshrrev_b32 v13, 2, v117
    v_add_u32 v109, v12, v11
    v_bitop3_b32 v117, v5, v13, v14 bitop3:0xea
    v_cvt_pk_bf16_f32 v120, v7, v8
    v_perm_b32 v12, v120, v120, s41
    v_bitop3_b32 v108, v4, v12, v108 bitop3:0xca
    v_perm_b32 v13, v120, v120, s42
    v_bitop3_b32 v109, v4, v13, v109 bitop3:0xca
    v_mul_hi_u32_u24 v14, 429497, v110
    v_lshrrev_b32 v12, 3, v118
    v_cos_f32 v9, v9
    v_lshlrev_b16 v13, 3, v118
    v_mad_i32_i24 v11, v14, s55, v110
    v_bitop3_b32 v12, v6, v13, v12 bitop3:0xca
    v_lshl_add_u32 v11, v11, 17, s40
    v_lshlrev_b16 v14, 8, v14
    v_lshrrev_b32 v13, 2, v118
    v_add_u32 v110, v12, v11
    v_bitop3_b32 v118, v5, v13, v14 bitop3:0xea
    v_mul_hi_u32_u24 v14, 429497, v111
    v_lshrrev_b32 v12, 3, v119
    v_cos_f32 v10, v10
    v_lshlrev_b16 v13, 3, v119
    v_mad_i32_i24 v11, v14, s55, v111
    v_bitop3_b32 v12, v6, v13, v12 bitop3:0xca
    v_lshl_add_u32 v11, v11, 17, s40
    v_lshlrev_b16 v14, 8, v14
    v_lshrrev_b32 v13, 2, v119
    v_add_u32 v111, v12, v11
    v_bitop3_b32 v119, v5, v13, v14 bitop3:0xea
    v_cvt_pk_bf16_f32 v121, v9, v10
    v_perm_b32 v12, v121, v121, s41
    v_bitop3_b32 v110, v4, v12, v110 bitop3:0xca
    v_perm_b32 v13, v121, v121, s42
    v_bitop3_b32 v111, v4, v13, v111 bitop3:0xca
    v_and_b32 v7, -4, v60
    v_lshl_add_u32 v8, v60, 2, v7
    ds_write_b32 v8, v56
    v_lshl_add_u32 v7, v7, 2, v60
    ds_write_b8 v7, v46 offset:16
    v_and_b32 v9, -4, v61
    v_lshl_add_u32 v10, v61, 2, v9
    ds_write_b32 v10, v57
    v_lshl_add_u32 v9, v9, 2, v61
    ds_write_b8_d16_hi v9, v46 offset:16
    v_and_b32 v7, -4, v62
    v_lshl_add_u32 v8, v62, 2, v7
    ds_write_b32 v8, v58
    v_lshl_add_u32 v7, v7, 2, v62
    ds_write_b8 v7, v47 offset:16
    v_and_b32 v9, -4, v63
    v_lshl_add_u32 v10, v63, 2, v9
    ds_write_b32 v10, v59
    v_lshl_add_u32 v9, v9, 2, v63
    ds_write_b8_d16_hi v9, v47 offset:16
    s_add_u32 s44, s96, 0x5800000
    s_lshr_b32 s44, s44, 1
    buffer_load_dwordx2 v[28:29], v1, s[16:19], s44 offen nt
    s_add_u32 s45, s96, 0x5c00000
    s_lshr_b32 s45, s45, 1
    buffer_load_dwordx2 v[30:31], v1, s[16:19], s45 offen nt
    s_waitcnt vmcnt(4)
    v_lshlrev_b32 v7, 16, v122
    v_and_b32 v8, 0xffff0000, v122
    v_lshlrev_b32 v9, 16, v123
    v_and_b32 v10, 0xffff0000, v123
    v_mul_f32 v7, 0.15915494, v7
    v_mul_f32 v8, 0.15915494, v8
    v_mul_f32 v9, 0.15915494, v9
    v_mul_f32 v10, 0.15915494, v10
    v_mul_hi_u32_u24 v14, 429497, v92
    v_lshrrev_b32 v12, 3, v16
    v_cos_f32 v7, v7
    v_lshlrev_b16 v13, 3, v16
    v_mad_i32_i24 v11, v14, s55, v92
    v_bitop3_b32 v12, v6, v13, v12 bitop3:0xca
    v_lshl_add_u32 v11, v11, 17, s40
    v_lshlrev_b16 v14, 8, v14
    v_lshrrev_b32 v13, 2, v16
    v_add_u32 v92, v12, v11
    v_bitop3_b32 v16, v5, v13, v14 bitop3:0xea
    v_mul_hi_u32_u24 v14, 429497, v93
    v_lshrrev_b32 v12, 3, v17
    v_cos_f32 v8, v8
    v_lshlrev_b16 v13, 3, v17
    v_mad_i32_i24 v11, v14, s55, v93
    v_bitop3_b32 v12, v6, v13, v12 bitop3:0xca
    v_lshl_add_u32 v11, v11, 17, s40
    v_lshlrev_b16 v14, 8, v14
    v_lshrrev_b32 v13, 2, v17
    v_add_u32 v93, v12, v11
    v_bitop3_b32 v17, v5, v13, v14 bitop3:0xea
    v_cvt_pk_bf16_f32 v122, v7, v8
    v_perm_b32 v12, v122, v122, s41
    v_bitop3_b32 v92, v4, v12, v92 bitop3:0xca
    v_perm_b32 v13, v122, v122, s42
    v_bitop3_b32 v93, v4, v13, v93 bitop3:0xca
    v_mul_hi_u32_u24 v14, 429497, v94
    v_lshrrev_b32 v12, 3, v18
    v_cos_f32 v9, v9
    v_lshlrev_b16 v13, 3, v18
    v_mad_i32_i24 v11, v14, s55, v94
    v_bitop3_b32 v12, v6, v13, v12 bitop3:0xca
    v_lshl_add_u32 v11, v11, 17, s40
    v_lshlrev_b16 v14, 8, v14
    v_lshrrev_b32 v13, 2, v18
    v_add_u32 v94, v12, v11
    v_bitop3_b32 v18, v5, v13, v14 bitop3:0xea
    v_mul_hi_u32_u24 v14, 429497, v95
    v_lshrrev_b32 v12, 3, v19
    v_cos_f32 v10, v10
    v_lshlrev_b16 v13, 3, v19
    v_mad_i32_i24 v11, v14, s55, v95
    v_bitop3_b32 v12, v6, v13, v12 bitop3:0xca
    v_lshl_add_u32 v11, v11, 17, s40
    v_lshlrev_b16 v14, 8, v14
    v_lshrrev_b32 v13, 2, v19
    v_add_u32 v95, v12, v11
    v_bitop3_b32 v19, v5, v13, v14 bitop3:0xea
    v_cvt_pk_bf16_f32 v123, v9, v10
    v_perm_b32 v12, v123, v123, s41
    v_bitop3_b32 v94, v4, v12, v94 bitop3:0xca
    v_perm_b32 v13, v123, v123, s42
    v_bitop3_b32 v95, v4, v13, v95 bitop3:0xca
    v_add_u32 v7, s72, v0
    v_add_u32 v12, s73, v0
    v_add_u32 v13, s85, v0
    v_add_u32 v14, s91, v0
    v_add_u32 v15, s93, v0
    s_min_i32 s3, s72, s73
    s_min_i32 s3, s3, s85
    s_min_i32 s3, s3, s91
    s_min_i32 s3, s3, s93
    v_add_u32 v3, s3, v0
    v_mov_b32 v8, 0
    v_mov_b32 v9, 0
    v_mov_b32 v10, 0
    v_mov_b32 v11, 0
    s_waitcnt lgkmcnt(0)
    s_barrier
    ds_read_b128 v[32:35], v7 offset:0
    ds_read_b128 v[36:39], v12 offset:0
    ds_read_b128 v[40:43], v13 offset:0
    ds_read_b128 v[24:27], v14 offset:0
    ds_read_b128 v[84:87], v15 offset:0
    ds_write_b128 v3, v[8:11]
    ds_read_b128 v[48:51], v7 offset:16384
    ds_read_b128 v[52:55], v12 offset:16384
    ds_read_b128 v[56:59], v13 offset:16384
    ds_read_b128 v[60:63], v14 offset:16384
    ds_read_b128 v[44:47], v15 offset:16384
    s_waitcnt lgkmcnt(0)
    s_barrier
    s_setprio 3
    s_add_u32 s46, s35, 0x2a44000
    s_add_u32 s46, s46, s72
    buffer_store_dwordx4 v[32:35], v0, s[20:23], s46 offen sc1
    s_add_u32 s47, s96, 0x5c00000
    s_nop 0
    v_lshlrev_b32 v32, 1, v1
    buffer_load_dwordx4 v[32:35], v32, s[8:11], s47 offen nt
    s_add_u32 s44, s35, 0x2a44000
    s_add_u32 s44, s44, s73
    buffer_store_dwordx4 v[36:39], v0, s[20:23], s44 offen sc1
    s_add_u32 s45, s96, 0x5c00000
    s_nop 0
    v_lshlrev_b32 v36, 1, v1
    buffer_load_dwordx4 v[36:39], v36, s[12:15], s45 offen nt
    ds_add_u32 v72, v2
    ds_add_u32 v73, v2
    ds_add_u32 v74, v2
    ds_add_u32 v75, v2
    ds_add_u32 v80, v2
    ds_add_u32 v81, v2
    ds_add_u32 v82, v2
    ds_add_u32 v83, v2
    s_setprio 2
    ds_add_u32 v104, v2
    ds_add_u32 v105, v2
    ds_add_u32 v106, v2
    ds_add_u32 v107, v2
    ds_add_u32 v112, v2
    ds_add_u32 v113, v2
    ds_add_u32 v114, v2
    ds_add_u32 v115, v2
    s_setprio 1
    s_add_u32 s46, s35, 0x2a44000
    s_add_u32 s46, s46, s85
    buffer_store_dwordx4 v[40:43], v0, s[20:23], s46 offen sc1
    s_add_u32 s47, s96, 0x6000000
    s_nop 0
    v_lshlrev_b32 v40, 1, v1
    buffer_load_dwordx4 v[40:43], v40, s[8:11], s47 offen nt
    ds_add_u32 v116, v2
    ds_add_u32 v117, v2
    ds_add_u32 v118, v2
    ds_add_u32 v119, v2
    ds_add_u32 v16, v2
    ds_add_u32 v17, v2
    ds_add_u32 v18, v2
    ds_add_u32 v19, v2
    s_setprio 0
    s_waitcnt vmcnt(6)
    v_lshlrev_b32 v7, 16, v28
    v_and_b32 v8, 0xffff0000, v28
    v_lshlrev_b32 v9, 16, v29
    v_and_b32 v10, 0xffff0000, v29
    v_mul_f32 v7, 0.15915494, v7
    v_mul_f32 v8, 0.15915494, v8
    v_mul_f32 v9, 0.15915494, v9
    v_mul_f32 v10, 0.15915494, v10
    v_mul_hi_u32_u24 v14, 429497, v20
    v_lshrrev_b32 v12, 3, v124
    v_cos_f32 v7, v7
    v_lshlrev_b16 v13, 3, v124
    v_mad_i32_i24 v11, v14, s55, v20
    v_bitop3_b32 v12, v6, v13, v12 bitop3:0xca
    v_lshl_add_u32 v11, v11, 17, s40
    v_lshlrev_b16 v14, 8, v14
    v_lshrrev_b32 v13, 2, v124
    v_add_u32 v20, v12, v11
    v_bitop3_b32 v124, v5, v13, v14 bitop3:0xea
    ds_add_u32 v124, v2
    v_mul_hi_u32_u24 v14, 429497, v21
    v_lshrrev_b32 v12, 3, v125
    v_cos_f32 v8, v8
    v_lshlrev_b16 v13, 3, v125
    v_mad_i32_i24 v11, v14, s55, v21
    v_bitop3_b32 v12, v6, v13, v12 bitop3:0xca
    v_lshl_add_u32 v11, v11, 17, s40
    v_lshlrev_b16 v14, 8, v14
    v_lshrrev_b32 v13, 2, v125
    v_add_u32 v21, v12, v11
    v_bitop3_b32 v125, v5, v13, v14 bitop3:0xea
    ds_add_u32 v125, v2
    v_cvt_pk_bf16_f32 v28, v7, v8
    v_perm_b32 v12, v28, v28, s41
    v_bitop3_b32 v20, v4, v12, v20 bitop3:0xca
    v_perm_b32 v13, v28, v28, s42
    v_bitop3_b32 v21, v4, v13, v21 bitop3:0xca
    v_mul_hi_u32_u24 v14, 429497, v22
    v_lshrrev_b32 v12, 3, v126
    v_cos_f32 v9, v9
    v_lshlrev_b16 v13, 3, v126
    v_mad_i32_i24 v11, v14, s55, v22
    v_bitop3_b32 v12, v6, v13, v12 bitop3:0xca
    v_lshl_add_u32 v11, v11, 17, s40
    v_lshlrev_b16 v14, 8, v14
    v_lshrrev_b32 v13, 2, v126
    v_add_u32 v22, v12, v11
    v_bitop3_b32 v126, v5, v13, v14 bitop3:0xea
    ds_add_u32 v126, v2
    v_mul_hi_u32_u24 v14, 429497, v23
    v_lshrrev_b32 v12, 3, v127
    v_cos_f32 v10, v10
    v_lshlrev_b16 v13, 3, v127
    v_mad_i32_i24 v11, v14, s55, v23
    v_bitop3_b32 v12, v6, v13, v12 bitop3:0xca
    v_lshl_add_u32 v11, v11, 17, s40
    v_lshlrev_b16 v14, 8, v14
    v_lshrrev_b32 v13, 2, v127
    v_add_u32 v23, v12, v11
    v_bitop3_b32 v127, v5, v13, v14 bitop3:0xea
    ds_add_u32 v127, v2
    v_cvt_pk_bf16_f32 v29, v9, v10
    v_perm_b32 v12, v29, v29, s41
    v_bitop3_b32 v22, v4, v12, v22 bitop3:0xca
    v_perm_b32 v13, v29, v29, s42
    v_bitop3_b32 v23, v4, v13, v23 bitop3:0xca
    s_waitcnt vmcnt(2)
    v_lshlrev_b32 v7, 16, v30
    v_and_b32 v8, 0xffff0000, v30
    v_lshlrev_b32 v9, 16, v31
    v_and_b32 v10, 0xffff0000, v31
    v_mul_f32 v7, 0.15915494, v7
    v_mul_f32 v8, 0.15915494, v8
    v_mul_f32 v9, 0.15915494, v9
    v_mul_f32 v10, 0.15915494, v10
    v_mul_hi_u32_u24 v14, 429497, v32
    v_lshrrev_b32 v12, 3, v36
    v_cos_f32 v7, v7
    v_lshlrev_b16 v13, 3, v36
    v_mad_i32_i24 v11, v14, s55, v32
    v_bitop3_b32 v12, v6, v13, v12 bitop3:0xca
    v_lshl_add_u32 v11, v11, 17, s40
    v_lshlrev_b16 v14, 8, v14
    v_lshrrev_b32 v13, 2, v36
    v_add_u32 v32, v12, v11
    v_bitop3_b32 v36, v5, v13, v14 bitop3:0xea
    ds_add_u32 v36, v2
    v_mul_hi_u32_u24 v14, 429497, v33
    v_lshrrev_b32 v12, 3, v37
    v_cos_f32 v8, v8
    v_lshlrev_b16 v13, 3, v37
    v_mad_i32_i24 v11, v14, s55, v33
    v_bitop3_b32 v12, v6, v13, v12 bitop3:0xca
    v_lshl_add_u32 v11, v11, 17, s40
    v_lshlrev_b16 v14, 8, v14
    v_lshrrev_b32 v13, 2, v37
    v_add_u32 v33, v12, v11
    v_bitop3_b32 v37, v5, v13, v14 bitop3:0xea
    ds_add_u32 v37, v2
    v_cvt_pk_bf16_f32 v30, v7, v8
    v_perm_b32 v12, v30, v30, s41
    v_bitop3_b32 v32, v4, v12, v32 bitop3:0xca
    v_perm_b32 v13, v30, v30, s42
    v_bitop3_b32 v33, v4, v13, v33 bitop3:0xca
    v_mul_hi_u32_u24 v14, 429497, v34
    v_lshrrev_b32 v12, 3, v38
    v_cos_f32 v9, v9
    v_lshlrev_b16 v13, 3, v38
    v_mad_i32_i24 v11, v14, s55, v34
    v_bitop3_b32 v12, v6, v13, v12 bitop3:0xca
    v_lshl_add_u32 v11, v11, 17, s40
    v_lshlrev_b16 v14, 8, v14
    v_lshrrev_b32 v13, 2, v38
    v_add_u32 v34, v12, v11
    v_bitop3_b32 v38, v5, v13, v14 bitop3:0xea
    ds_add_u32 v38, v2
    v_mul_hi_u32_u24 v14, 429497, v35
    v_lshrrev_b32 v12, 3, v39
    v_cos_f32 v10, v10
    v_lshlrev_b16 v13, 3, v39
    v_mad_i32_i24 v11, v14, s55, v35
    v_bitop3_b32 v12, v6, v13, v12 bitop3:0xca
    v_lshl_add_u32 v11, v11, 17, s40
    v_lshlrev_b16 v14, 8, v14
    v_lshrrev_b32 v13, 2, v39
    v_add_u32 v35, v12, v11
    v_bitop3_b32 v39, v5, v13, v14 bitop3:0xea
    ds_add_u32 v39, v2
    v_cvt_pk_bf16_f32 v31, v9, v10
    v_perm_b32 v12, v31, v31, s41
    v_bitop3_b32 v34, v4, v12, v34 bitop3:0xca
    v_perm_b32 v13, v31, v31, s42
    v_bitop3_b32 v35, v4, v13, v35 bitop3:0xca
    v_lshrrev_b32 v8, 2, v0
    v_and_b32 v7, 0x3c00, v0
    v_bitop3_b32 v7, v5, v8, v7 bitop3:0xea
    s_waitcnt lgkmcnt(0)
    s_barrier
    ds_read2st64_b32 v[8:9], v7 offset0:0 offset1:1
    ds_read2st64_b32 v[10:11], v7 offset0:2 offset1:3
    s_add_u32 s44, s35, 0x2a44000
    s_add_u32 s44, s44, s91
    buffer_store_dwordx4 v[24:27], v0, s[20:23], s44 offen sc1
    s_add_u32 s45, s96, 0x6000000
    s_nop 0
    v_lshlrev_b32 v24, 1, v1
    buffer_load_dwordx4 v[24:27], v24, s[12:15], s45 offen nt
    s_waitcnt lgkmcnt(0)
    v_lshl_or_b32 v12, v9, 16, v8
    v_lshl_or_b32 v13, v11, 16, v10
    v_mov_b32 v14, v12
    v_mov_b32 v15, v13
    s_nop 0
    v_add_u32_dpp v14, v14, v14 row_shr:1 row_mask:0xf bank_mask:0xf bound_ctrl:1
    v_add_u32_dpp v15, v15, v15 row_shr:1 row_mask:0xf bank_mask:0xf bound_ctrl:1
    s_nop 0
    v_add_u32_dpp v14, v14, v14 row_shr:2 row_mask:0xf bank_mask:0xf bound_ctrl:1
    v_add_u32_dpp v15, v15, v15 row_shr:2 row_mask:0xf bank_mask:0xf bound_ctrl:1
    s_nop 0
    v_add_u32_dpp v14, v14, v14 row_shr:4 row_mask:0xf bank_mask:0xf bound_ctrl:1
    v_add_u32_dpp v15, v15, v15 row_shr:4 row_mask:0xf bank_mask:0xf bound_ctrl:1
    s_nop 0
    v_add_u32_dpp v14, v14, v14 row_shr:8 row_mask:0xf bank_mask:0xf bound_ctrl:1
    v_add_u32_dpp v15, v15, v15 row_shr:8 row_mask:0xf bank_mask:0xf bound_ctrl:1
    s_nop 0
    v_add_u32_dpp v14, v14, v14 row_bcast:15 row_mask:0xa bank_mask:0xf
    v_add_u32_dpp v15, v15, v15 row_bcast:15 row_mask:0xa bank_mask:0xf
    s_nop 0
    v_add_u32_dpp v14, v14, v14 row_bcast:31 row_mask:0xc bank_mask:0xf
    v_add_u32_dpp v15, v15, v15 row_bcast:31 row_mask:0xc bank_mask:0xf
    v_readlane_b32 s48, v14, 63
    v_readlane_b32 s49, v15, 63
    s_lshl_b32 s54, s32, 2
    v_mov_b32 v8, s54
    s_and_b32 s50, s48, 0xffff
    s_lshr_b32 s51, s48, 16
    s_and_b32 s52, s49, 0xffff
    s_lshr_b32 s53, s49, 16
    s_add_u32 s51, s51, s50
    s_add_u32 s52, s52, s51
    s_add_u32 s53, s53, s52
    v_mov_b32 v9, s53
    s_mov_b64 exec, 1
    ds_write_b32 v8, v9 offset:16384
    s_mov_b64 exec, -1
    v_and_b32 v8, 60, v7
    s_waitcnt lgkmcnt(0)
    s_barrier
    ds_read_b32 v9, v8 offset:16384
    s_waitcnt lgkmcnt(0)
    v_add_u32_dpp v9, v9, v9 row_shr:1 row_mask:0xf bank_mask:0xf bound_ctrl:1
    s_nop 1
    v_add_u32_dpp v9, v9, v9 row_shr:2 row_mask:0xf bank_mask:0xf bound_ctrl:1
    s_nop 1
    v_add_u32_dpp v9, v9, v9 row_shr:4 row_mask:0xf bank_mask:0xf bound_ctrl:1
    s_nop 1
    v_add_u32_dpp v9, v9, v9 row_shr:8 row_mask:0xf bank_mask:0xf bound_ctrl:1
    s_nop 0
    v_readlane_b32 s54, v9, s32
    s_sub_u32 s54, s54, s53
    s_add_u32 s50, s50, s54
    s_add_u32 s51, s51, s54
    s_add_u32 s52, s52, s54
    s_pack_ll_b32_b16 s48, s54, s50
    s_pack_ll_b32_b16 s49, s51, s52
    v_add_u32 v14, s48, v14
    v_add_u32 v15, s49, v15
    v_sub_u32 v12, v14, v12
    v_sub_u32 v13, v15, v13
    v_and_b32 v8, 0xffff, v12
    v_lshrrev_b32 v9, 16, v12
    v_and_b32 v10, 0xffff, v13
    v_lshrrev_b32 v11, 16, v13
    ds_write2st64_b32 v7, v8, v9 offset0:0 offset1:1
    ds_write2st64_b32 v7, v10, v11 offset0:2 offset1:3
    v_and_b32 v8, 0x3f0, v0
    v_lshl_add_u32 v8, v8, 1, s36
    ds_write_b64 v8, v[12:13] offset:20480
    s_bitset0_b64 exec, 63
    s_not_b64 exec, exec
    ds_write_b64 v8, v[14:15] offset:20512
    s_mov_b64 exec, -1
    s_waitcnt lgkmcnt(0)
    s_barrier
    s_setprio 3
    ds_add_rtn_u32 v72, v72, v2
    ds_add_rtn_u32 v73, v73, v2
    ds_add_rtn_u32 v74, v74, v2
    ds_add_rtn_u32 v75, v75, v2
    ds_read_b128 v[12:15], v0 offset:20480
    v_cmp_gt_u32 vcc, 8448, v0
    s_add_u32 s46, s35, 0x2a44000
    s_add_u32 s46, s46, s93
    buffer_store_dwordx4 v[84:87], v0, s[20:23], s46 offen sc1
    s_add_u32 s47, s96, 0x6000000
    s_lshr_b32 s47, s47, 1
    buffer_load_dwordx2 v[84:85], v1, s[16:19], s47 offen nt
    s_add_u32 s44, s96, 0x6400000
    s_lshr_b32 s44, s44, 1
    buffer_load_dwordx2 v[86:87], v1, s[16:19], s44 offen nt
    ds_add_rtn_u32 v80, v80, v2
    ds_add_rtn_u32 v81, v81, v2
    ds_add_rtn_u32 v82, v82, v2
    ds_add_rtn_u32 v83, v83, v2
    s_setprio 2
    ds_add_rtn_u32 v104, v104, v2
    ds_add_rtn_u32 v105, v105, v2
    ds_add_rtn_u32 v106, v106, v2
    ds_add_rtn_u32 v107, v107, v2
    s_waitcnt lgkmcnt(8)
    s_cbranch_vccz L1_p3
    s_add_u32 s45, s35, 0x5480000
    s_mov_b64 exec, vcc
    buffer_store_dwordx4 v[12:15], v0, s[24:27], s45 offen sc1
    s_mov_b64 exec, -1
L1_p3:
    s_add_u32 s46, s35, 0x2a48000
    s_add_u32 s46, s46, s72
    buffer_store_dwordx4 v[48:51], v0, s[20:23], s46 offen sc1
    s_add_u32 s47, s96, 0x6400000
    s_nop 0
    v_lshlrev_b32 v48, 1, v1
    buffer_load_dwordx4 v[48:51], v48, s[8:11], s47 offen nt
    ds_add_rtn_u32 v112, v112, v2
    ds_add_rtn_u32 v113, v113, v2
    ds_add_rtn_u32 v114, v114, v2
    ds_add_rtn_u32 v115, v115, v2
    s_setprio 1
    ds_add_rtn_u32 v116, v116, v2
    ds_add_rtn_u32 v117, v117, v2
    ds_add_rtn_u32 v118, v118, v2
    ds_add_rtn_u32 v119, v119, v2
    ds_add_rtn_u32 v16, v16, v2
    ds_add_rtn_u32 v17, v17, v2
    ds_add_rtn_u32 v18, v18, v2
    ds_add_rtn_u32 v19, v19, v2
    s_add_u32 s44, s35, 0x2a48000
    s_add_u32 s44, s44, s73
    buffer_store_dwordx4 v[52:55], v0, s[20:23], s44 offen sc1
    s_add_u32 s45, s96, 0x6400000
    s_nop 0
    v_lshlrev_b32 v52, 1, v1
    buffer_load_dwordx4 v[52:55], v52, s[12:15], s45 offen nt
    s_setprio 0
    ds_add_rtn_u32 v124, v124, v2
    ds_add_rtn_u32 v125, v125, v2
    ds_add_rtn_u32 v126, v126, v2
    ds_add_rtn_u32 v127, v127, v2
    ds_add_rtn_u32 v36, v36, v2
    ds_add_rtn_u32 v37, v37, v2
    ds_add_rtn_u32 v38, v38, v2
    ds_add_rtn_u32 v39, v39, v2
    s_waitcnt lgkmcnt(0)
    s_barrier
    s_setprio 3
    v_and_b32 v7, -4, v72
    v_lshl_add_u32 v8, v72, 2, v7
    ds_write_b32 v8, v68
    v_lshl_add_u32 v7, v7, 2, v72
    ds_write_b8 v7, v64 offset:16
    v_and_b32 v9, -4, v73
    v_lshl_add_u32 v10, v73, 2, v9
    ds_write_b32 v10, v69
    v_lshl_add_u32 v9, v9, 2, v73
    ds_write_b8_d16_hi v9, v64 offset:16
    v_and_b32 v7, -4, v74
    v_lshl_add_u32 v8, v74, 2, v7
    ds_write_b32 v8, v70
    v_lshl_add_u32 v7, v7, 2, v74
    ds_write_b8 v7, v65 offset:16
    v_and_b32 v9, -4, v75
    v_lshl_add_u32 v10, v75, 2, v9
    ds_write_b32 v10, v71
    v_lshl_add_u32 v9, v9, 2, v75
    ds_write_b8_d16_hi v9, v65 offset:16
    s_add_u32 s46, s35, 0x2a48000
    s_add_u32 s46, s46, s85
    buffer_store_dwordx4 v[56:59], v0, s[20:23], s46 offen sc1
    s_add_u32 s47, s96, 0x6800000
    v_lshlrev_b32 v68, 1, v1
    buffer_load_dwordx4 v[68:71], v68, s[8:11], s47 offen nt
    s_add_u32 s44, s96, 0x6800000
    v_lshlrev_b32 v72, 1, v1
    buffer_load_dwordx4 v[72:75], v72, s[12:15], s44 offen nt
    v_and_b32 v7, -4, v80
    v_lshl_add_u32 v8, v80, 2, v7
    ds_write_b32 v8, v76
    v_lshl_add_u32 v7, v7, 2, v80
    ds_write_b8 v7, v66 offset:16
    v_and_b32 v9, -4, v81
    v_lshl_add_u32 v10, v81, 2, v9
    ds_write_b32 v10, v77
    v_lshl_add_u32 v9, v9, 2, v81
    ds_write_b8_d16_hi v9, v66 offset:16
    v_and_b32 v7, -4, v82
    v_lshl_add_u32 v8, v82, 2, v7
    ds_write_b32 v8, v78
    v_lshl_add_u32 v7, v7, 2, v82
    ds_write_b8 v7, v67 offset:16
    v_and_b32 v9, -4, v83
    v_lshl_add_u32 v10, v83, 2, v9
    ds_write_b32 v10, v79
    v_lshl_add_u32 v9, v9, 2, v83
    ds_write_b8_d16_hi v9, v67 offset:16
    s_add_u32 s45, s96, 0x6800000
    s_lshr_b32 s45, s45, 1
    buffer_load_dwordx2 v[56:57], v1, s[16:19], s45 offen nt
    s_add_u32 s46, s96, 0x6c00000
    s_lshr_b32 s46, s46, 1
    buffer_load_dwordx2 v[58:59], v1, s[16:19], s46 offen nt
    s_add_u32 s47, s96, 0x6c00000
    v_lshlrev_b32 v76, 1, v1
    buffer_load_dwordx4 v[76:79], v76, s[8:11], s47 offen nt
    s_waitcnt vmcnt(10)
    v_lshlrev_b32 v7, 16, v84
    v_and_b32 v8, 0xffff0000, v84
    v_lshlrev_b32 v9, 16, v85
    v_and_b32 v10, 0xffff0000, v85
    v_mul_f32 v7, 0.15915494, v7
    v_mul_f32 v8, 0.15915494, v8
    v_mul_f32 v9, 0.15915494, v9
    v_mul_f32 v10, 0.15915494, v10
    v_mul_hi_u32_u24 v14, 429497, v40
    v_lshrrev_b32 v12, 3, v24
    v_cos_f32 v7, v7
    v_lshlrev_b16 v13, 3, v24
    v_mad_i32_i24 v11, v14, s55, v40
    v_bitop3_b32 v12, v6, v13, v12 bitop3:0xca
    v_lshl_add_u32 v11, v11, 17, s40
    v_lshlrev_b16 v14, 8, v14
    v_lshrrev_b32 v13, 2, v24
    v_add_u32 v40, v12, v11
    v_bitop3_b32 v24, v5, v13, v14 bitop3:0xea
    v_mul_hi_u32_u24 v14, 429497, v41
    v_lshrrev_b32 v12, 3, v25
    v_cos_f32 v8, v8
    v_lshlrev_b16 v13, 3, v25
    v_mad_i32_i24 v11, v14, s55, v41
    v_bitop3_b32 v12, v6, v13, v12 bitop3:0xca
    v_lshl_add_u32 v11, v11, 17, s40
    v_lshlrev_b16 v14, 8, v14
    v_lshrrev_b32 v13, 2, v25
    v_add_u32 v41, v12, v11
    v_bitop3_b32 v25, v5, v13, v14 bitop3:0xea
    v_cvt_pk_bf16_f32 v84, v7, v8
    v_perm_b32 v12, v84, v84, s41
    v_bitop3_b32 v40, v4, v12, v40 bitop3:0xca
    v_perm_b32 v13, v84, v84, s42
    v_bitop3_b32 v41, v4, v13, v41 bitop3:0xca
    v_mul_hi_u32_u24 v14, 429497, v42
    v_lshrrev_b32 v12, 3, v26
    v_cos_f32 v9, v9
    v_lshlrev_b16 v13, 3, v26
    v_mad_i32_i24 v11, v14, s55, v42
    v_bitop3_b32 v12, v6, v13, v12 bitop3:0xca
    v_lshl_add_u32 v11, v11, 17, s40
    v_lshlrev_b16 v14, 8, v14
    v_lshrrev_b32 v13, 2, v26
    v_add_u32 v42, v12, v11
    v_bitop3_b32 v26, v5, v13, v14 bitop3:0xea
    v_mul_hi_u32_u24 v14, 429497, v43
    v_lshrrev_b32 v12, 3, v27
    v_cos_f32 v10, v10
    v_lshlrev_b16 v13, 3, v27
    v_mad_i32_i24 v11, v14, s55, v43
    v_bitop3_b32 v12, v6, v13, v12 bitop3:0xca
    v_lshl_add_u32 v11, v11, 17, s40
    v_lshlrev_b16 v14, 8, v14
    v_lshrrev_b32 v13, 2, v27
    v_add_u32 v43, v12, v11
    v_bitop3_b32 v27, v5, v13, v14 bitop3:0xea
    v_cvt_pk_bf16_f32 v85, v9, v10
    v_perm_b32 v12, v85, v85, s41
    v_bitop3_b32 v42, v4, v12, v42 bitop3:0xca
    v_perm_b32 v13, v85, v85, s42
    v_bitop3_b32 v43, v4, v13, v43 bitop3:0xca
    s_setprio 2
    v_and_b32 v7, -4, v104
    v_lshl_add_u32 v8, v104, 2, v7
    ds_write_b32 v8, v96
    v_lshl_add_u32 v7, v7, 2, v104
    ds_write_b8 v7, v88 offset:16
    v_and_b32 v9, -4, v105
    v_lshl_add_u32 v10, v105, 2, v9
    ds_write_b32 v10, v97
    v_lshl_add_u32 v9, v9, 2, v105
    ds_write_b8_d16_hi v9, v88 offset:16
    v_and_b32 v7, -4, v106
    v_lshl_add_u32 v8, v106, 2, v7
    ds_write_b32 v8, v98
    v_lshl_add_u32 v7, v7, 2, v106
    ds_write_b8 v7, v89 offset:16
    v_and_b32 v9, -4, v107
    v_lshl_add_u32 v10, v107, 2, v9
    ds_write_b32 v10, v99
    v_lshl_add_u32 v9, v9, 2, v107
    ds_write_b8_d16_hi v9, v89 offset:16
    s_add_u32 s44, s35, 0x2a48000
    s_add_u32 s44, s44, s91
    buffer_store_dwordx4 v[60:63], v0, s[20:23], s44 offen sc1
    s_add_u32 s45, s96, 0x6c00000
    v_lshlrev_b32 v80, 1, v1
    buffer_load_dwordx4 v[80:83], v80, s[12:15], s45 offen nt
    s_waitcnt vmcnt(8)
    v_lshlrev_b32 v7, 16, v86
    v_and_b32 v8, 0xffff0000, v86
    v_lshlrev_b32 v9, 16, v87
    v_and_b32 v10, 0xffff0000, v87
    v_mul_f32 v7, 0.15915494, v7
    v_mul_f32 v8, 0.15915494, v8
    v_mul_f32 v9, 0.15915494, v9
    v_mul_f32 v10, 0.15915494, v10
    v_mul_hi_u32_u24 v14, 429497, v48
    v_lshrrev_b32 v12, 3, v52
    v_cos_f32 v7, v7
    v_lshlrev_b16 v13, 3, v52
    v_mad_i32_i24 v11, v14, s55, v48
    v_bitop3_b32 v12, v6, v13, v12 bitop3:0xca
    v_lshl_add_u32 v11, v11, 17, s40
    v_lshlrev_b16 v14, 8, v14
    v_lshrrev_b32 v13, 2, v52
    v_add_u32 v48, v12, v11
    v_bitop3_b32 v52, v5, v13, v14 bitop3:0xea
    v_mul_hi_u32_u24 v14, 429497, v49
    v_lshrrev_b32 v12, 3, v53
    v_cos_f32 v8, v8
    v_lshlrev_b16 v13, 3, v53
    v_mad_i32_i24 v11, v14, s55, v49
    v_bitop3_b32 v12, v6, v13, v12 bitop3:0xca
    v_lshl_add_u32 v11, v11, 17, s40
    v_lshlrev_b16 v14, 8, v14
    v_lshrrev_b32 v13, 2, v53
    v_add_u32 v49, v12, v11
    v_bitop3_b32 v53, v5, v13, v14 bitop3:0xea
    v_cvt_pk_bf16_f32 v86, v7, v8
    v_perm_b32 v12, v86, v86, s41
    v_bitop3_b32 v48, v4, v12, v48 bitop3:0xca
    v_perm_b32 v13, v86, v86, s42
    v_bitop3_b32 v49, v4, v13, v49 bitop3:0xca
    v_mul_hi_u32_u24 v14, 429497, v50
    v_lshrrev_b32 v12, 3, v54
    v_cos_f32 v9, v9
    v_lshlrev_b16 v13, 3, v54
    v_mad_i32_i24 v11, v14, s55, v50
    v_bitop3_b32 v12, v6, v13, v12 bitop3:0xca
    v_lshl_add_u32 v11, v11, 17, s40
    v_lshlrev_b16 v14, 8, v14
    v_lshrrev_b32 v13, 2, v54
    v_add_u32 v50, v12, v11
    v_bitop3_b32 v54, v5, v13, v14 bitop3:0xea
    v_mul_hi_u32_u24 v14, 429497, v51
    v_lshrrev_b32 v12, 3, v55
    v_cos_f32 v10, v10
    v_lshlrev_b16 v13, 3, v55
    v_mad_i32_i24 v11, v14, s55, v51
    v_bitop3_b32 v12, v6, v13, v12 bitop3:0xca
    v_lshl_add_u32 v11, v11, 17, s40
    v_lshlrev_b16 v14, 8, v14
    v_lshrrev_b32 v13, 2, v55
    v_add_u32 v51, v12, v11
    v_bitop3_b32 v55, v5, v13, v14 bitop3:0xea
    v_cvt_pk_bf16_f32 v87, v9, v10
    v_perm_b32 v12, v87, v87, s41
    v_bitop3_b32 v50, v4, v12, v50 bitop3:0xca
    v_perm_b32 v13, v87, v87, s42
    v_bitop3_b32 v51, v4, v13, v51 bitop3:0xca
    v_and_b32 v7, -4, v112
    v_lshl_add_u32 v8, v112, 2, v7
    ds_write_b32 v8, v100
    v_lshl_add_u32 v7, v7, 2, v112
    ds_write_b8 v7, v90 offset:16
    v_and_b32 v9, -4, v113
    v_lshl_add_u32 v10, v113, 2, v9
    ds_write_b32 v10, v101
    v_lshl_add_u32 v9, v9, 2, v113
    ds_write_b8_d16_hi v9, v90 offset:16
    v_and_b32 v7, -4, v114
    v_lshl_add_u32 v8, v114, 2, v7
    ds_write_b32 v8, v102
    v_lshl_add_u32 v7, v7, 2, v114
    ds_write_b8 v7, v91 offset:16
    v_and_b32 v9, -4, v115
    v_lshl_add_u32 v10, v115, 2, v9
    ds_write_b32 v10, v103
    v_lshl_add_u32 v9, v9, 2, v115
    ds_write_b8_d16_hi v9, v91 offset:16
    s_add_u32 s46, s96, 0x7000000
    v_lshlrev_b32 v64, 1, v1
    buffer_load_dwordx4 v[64:67], v64, s[8:11], s46 offen nt
    s_add_u32 s47, s96, 0x7000000
    v_lshlrev_b32 v96, 1, v1
    buffer_load_dwordx4 v[96:99], v96, s[12:15], s47 offen nt
    s_waitcnt vmcnt(5)
    v_lshlrev_b32 v7, 16, v56
    v_and_b32 v8, 0xffff0000, v56
    v_lshlrev_b32 v9, 16, v57
    v_and_b32 v10, 0xffff0000, v57
    v_mul_f32 v7, 0.15915494, v7
    v_mul_f32 v8, 0.15915494, v8
    v_mul_f32 v9, 0.15915494, v9
    v_mul_f32 v10, 0.15915494, v10
    v_mul_hi_u32_u24 v14, 429497, v68
    v_lshrrev_b32 v12, 3, v72
    v_cos_f32 v7, v7
    v_lshlrev_b16 v13, 3, v72
    v_mad_i32_i24 v11, v14, s55, v68
    v_bitop3_b32 v12, v6, v13, v12 bitop3:0xca
    v_lshl_add_u32 v11, v11, 17, s40
    v_lshlrev_b16 v14, 8, v14
    v_lshrrev_b32 v13, 2, v72
    v_add_u32 v68, v12, v11
    v_bitop3_b32 v72, v5, v13, v14 bitop3:0xea
    v_mul_hi_u32_u24 v14, 429497, v69
    v_lshrrev_b32 v12, 3, v73
    v_cos_f32 v8, v8
    v_lshlrev_b16 v13, 3, v73
    v_mad_i32_i24 v11, v14, s55, v69
    v_bitop3_b32 v12, v6, v13, v12 bitop3:0xca
    v_lshl_add_u32 v11, v11, 17, s40
    v_lshlrev_b16 v14, 8, v14
    v_lshrrev_b32 v13, 2, v73
    v_add_u32 v69, v12, v11
    v_bitop3_b32 v73, v5, v13, v14 bitop3:0xea
    v_cvt_pk_bf16_f32 v56, v7, v8
    v_perm_b32 v12, v56, v56, s41
    v_bitop3_b32 v68, v4, v12, v68 bitop3:0xca
    v_perm_b32 v13, v56, v56, s42
    v_bitop3_b32 v69, v4, v13, v69 bitop3:0xca
    v_mul_hi_u32_u24 v14, 429497, v70
    v_lshrrev_b32 v12, 3, v74
    v_cos_f32 v9, v9
    v_lshlrev_b16 v13, 3, v74
    v_mad_i32_i24 v11, v14, s55, v70
    v_bitop3_b32 v12, v6, v13, v12 bitop3:0xca
    v_lshl_add_u32 v11, v11, 17, s40
    v_lshlrev_b16 v14, 8, v14
    v_lshrrev_b32 v13, 2, v74
    v_add_u32 v70, v12, v11
    v_bitop3_b32 v74, v5, v13, v14 bitop3:0xea
    v_mul_hi_u32_u24 v14, 429497, v71
    v_lshrrev_b32 v12, 3, v75
    v_cos_f32 v10, v10
    v_lshlrev_b16 v13, 3, v75
    v_mad_i32_i24 v11, v14, s55, v71
    v_bitop3_b32 v12, v6, v13, v12 bitop3:0xca
    v_lshl_add_u32 v11, v11, 17, s40
    v_lshlrev_b16 v14, 8, v14
    v_lshrrev_b32 v13, 2, v75
    v_add_u32 v71, v12, v11
    v_bitop3_b32 v75, v5, v13, v14 bitop3:0xea
    v_cvt_pk_bf16_f32 v57, v9, v10
    v_perm_b32 v12, v57, v57, s41
    v_bitop3_b32 v70, v4, v12, v70 bitop3:0xca
    v_perm_b32 v13, v57, v57, s42
    v_bitop3_b32 v71, v4, v13, v71 bitop3:0xca
    s_setprio 1
    v_and_b32 v7, -4, v116
    v_lshl_add_u32 v8, v116, 2, v7
    ds_write_b32 v8, v108
    v_lshl_add_u32 v7, v7, 2, v116
    ds_write_b8 v7, v120 offset:16
    v_and_b32 v9, -4, v117
    v_lshl_add_u32 v10, v117, 2, v9
    ds_write_b32 v10, v109
    v_lshl_add_u32 v9, v9, 2, v117
    ds_write_b8_d16_hi v9, v120 offset:16
    v_and_b32 v7, -4, v118
    v_lshl_add_u32 v8, v118, 2, v7
    ds_write_b32 v8, v110
    v_lshl_add_u32 v7, v7, 2, v118
    ds_write_b8 v7, v121 offset:16
    v_and_b32 v9, -4, v119
    v_lshl_add_u32 v10, v119, 2, v9
    ds_write_b32 v10, v111
    v_lshl_add_u32 v9, v9, 2, v119
    ds_write_b8_d16_hi v9, v121 offset:16
    s_add_u32 s44, s96, 0x7000000
    s_lshr_b32 s44, s44, 1
    buffer_load_dwordx2 v[104:105], v1, s[16:19], s44 offen nt
    s_add_u32 s45, s96, 0x7400000
    s_lshr_b32 s45, s45, 1
    buffer_load_dwordx2 v[106:107], v1, s[16:19], s45 offen nt
    s_add_u32 s46, s96, 0x7400000
    v_lshlrev_b32 v60, 1, v1
    buffer_load_dwordx4 v[60:63], v60, s[8:11], s46 offen nt
    v_and_b32 v7, -4, v16
    v_lshl_add_u32 v8, v16, 2, v7
    ds_write_b32 v8, v92
    v_lshl_add_u32 v7, v7, 2, v16
    ds_write_b8 v7, v122 offset:16
    v_and_b32 v9, -4, v17
    v_lshl_add_u32 v10, v17, 2, v9
    ds_write_b32 v10, v93
    v_lshl_add_u32 v9, v9, 2, v17
    ds_write_b8_d16_hi v9, v122 offset:16
    v_and_b32 v7, -4, v18
    v_lshl_add_u32 v8, v18, 2, v7
    ds_write_b32 v8, v94
    v_lshl_add_u32 v7, v7, 2, v18
    ds_write_b8 v7, v123 offset:16
    v_and_b32 v9, -4, v19
    v_lshl_add_u32 v10, v19, 2, v9
    ds_write_b32 v10, v95
    v_lshl_add_u32 v9, v9, 2, v19
    ds_write_b8_d16_hi v9, v123 offset:16
    s_add_u32 s47, s35, 0x2a48000
    s_add_u32 s47, s47, s93
    buffer_store_dwordx4 v[44:47], v0, s[20:23], s47 offen sc1
    s_add_u32 s44, s96, 0x7400000
    v_lshlrev_b32 v100, 1, v1
    buffer_load_dwordx4 v[100:103], v100, s[12:15], s44 offen nt
    s_waitcnt vmcnt(7)
    v_lshlrev_b32 v7, 16, v58
    v_and_b32 v8, 0xffff0000, v58
    v_lshlrev_b32 v9, 16, v59
    v_and_b32 v10, 0xffff0000, v59
    v_mul_f32 v7, 0.15915494, v7
    v_mul_f32 v8, 0.15915494, v8
    v_mul_f32 v9, 0.15915494, v9
    v_mul_f32 v10, 0.15915494, v10
    v_mul_hi_u32_u24 v14, 429497, v76
    v_lshrrev_b32 v12, 3, v80
    v_cos_f32 v7, v7
    v_lshlrev_b16 v13, 3, v80
    v_mad_i32_i24 v11, v14, s55, v76
    v_bitop3_b32 v12, v6, v13, v12 bitop3:0xca
    v_lshl_add_u32 v11, v11, 17, s40
    v_lshlrev_b16 v14, 8, v14
    v_lshrrev_b32 v13, 2, v80
    v_add_u32 v76, v12, v11
    v_bitop3_b32 v80, v5, v13, v14 bitop3:0xea
    v_mul_hi_u32_u24 v14, 429497, v77
    v_lshrrev_b32 v12, 3, v81
    v_cos_f32 v8, v8
    v_lshlrev_b16 v13, 3, v81
    v_mad_i32_i24 v11, v14, s55, v77
    v_bitop3_b32 v12, v6, v13, v12 bitop3:0xca
    v_lshl_add_u32 v11, v11, 17, s40
    v_lshlrev_b16 v14, 8, v14
    v_lshrrev_b32 v13, 2, v81
    v_add_u32 v77, v12, v11
    v_bitop3_b32 v81, v5, v13, v14 bitop3:0xea
    v_cvt_pk_bf16_f32 v58, v7, v8
    v_perm_b32 v12, v58, v58, s41
    v_bitop3_b32 v76, v4, v12, v76 bitop3:0xca
    v_perm_b32 v13, v58, v58, s42
    v_bitop3_b32 v77, v4, v13, v77 bitop3:0xca
    v_mul_hi_u32_u24 v14, 429497, v78
    v_lshrrev_b32 v12, 3, v82
    v_cos_f32 v9, v9
    v_lshlrev_b16 v13, 3, v82
    v_mad_i32_i24 v11, v14, s55, v78
    v_bitop3_b32 v12, v6, v13, v12 bitop3:0xca
    v_lshl_add_u32 v11, v11, 17, s40
    v_lshlrev_b16 v14, 8, v14
    v_lshrrev_b32 v13, 2, v82
    v_add_u32 v78, v12, v11
    v_bitop3_b32 v82, v5, v13, v14 bitop3:0xea
    v_mul_hi_u32_u24 v14, 429497, v79
    v_lshrrev_b32 v12, 3, v83
    v_cos_f32 v10, v10
    v_lshlrev_b16 v13, 3, v83
    v_mad_i32_i24 v11, v14, s55, v79
    v_bitop3_b32 v12, v6, v13, v12 bitop3:0xca
    v_lshl_add_u32 v11, v11, 17, s40
    v_lshlrev_b16 v14, 8, v14
    v_lshrrev_b32 v13, 2, v83
    v_add_u32 v79, v12, v11
    v_bitop3_b32 v83, v5, v13, v14 bitop3:0xea
    v_cvt_pk_bf16_f32 v59, v9, v10
    v_perm_b32 v12, v59, v59, s41
    v_bitop3_b32 v78, v4, v12, v78 bitop3:0xca
    v_perm_b32 v13, v59, v59, s42
    v_bitop3_b32 v79, v4, v13, v79 bitop3:0xca
    s_setprio 0
    v_and_b32 v7, -4, v124
    v_lshl_add_u32 v8, v124, 2, v7
    ds_write_b32 v8, v20
    v_lshl_add_u32 v7, v7, 2, v124
    ds_write_b8 v7, v28 offset:16
    v_and_b32 v9, -4, v125
    v_lshl_add_u32 v10, v125, 2, v9
    ds_write_b32 v10, v21
    v_lshl_add_u32 v9, v9, 2, v125
    ds_write_b8_d16_hi v9, v28 offset:16
    v_and_b32 v7, -4, v126
    v_lshl_add_u32 v8, v126, 2, v7
    ds_write_b32 v8, v22
    v_lshl_add_u32 v7, v7, 2, v126
    ds_write_b8 v7, v29 offset:16
    v_and_b32 v9, -4, v127
    v_lshl_add_u32 v10, v127, 2, v9
    ds_write_b32 v10, v23
    v_lshl_add_u32 v9, v9, 2, v127
    ds_write_b8_d16_hi v9, v29 offset:16
    s_add_u32 s45, s96, 0x7800000
    v_lshlrev_b32 v112, 1, v1
    buffer_load_dwordx4 v[112:115], v112, s[8:11], s45 offen nt
    s_add_u32 s46, s96, 0x7800000
    v_lshlrev_b32 v88, 1, v1
    buffer_load_dwordx4 v[88:91], v88, s[12:15], s46 offen nt
    s_waitcnt vmcnt(5)
    v_lshlrev_b32 v7, 16, v104
    v_and_b32 v8, 0xffff0000, v104
    v_lshlrev_b32 v9, 16, v105
    v_and_b32 v10, 0xffff0000, v105
    v_mul_f32 v7, 0.15915494, v7
    v_mul_f32 v8, 0.15915494, v8
    v_mul_f32 v9, 0.15915494, v9
    v_mul_f32 v10, 0.15915494, v10
    v_mul_hi_u32_u24 v14, 429497, v64
    v_lshrrev_b32 v12, 3, v96
    v_cos_f32 v7, v7
    v_lshlrev_b16 v13, 3, v96
    v_mad_i32_i24 v11, v14, s55, v64
    v_bitop3_b32 v12, v6, v13, v12 bitop3:0xca
    v_lshl_add_u32 v11, v11, 17, s40
    v_lshlrev_b16 v14, 8, v14
    v_lshrrev_b32 v13, 2, v96
    v_add_u32 v64, v12, v11
    v_bitop3_b32 v96, v5, v13, v14 bitop3:0xea
    v_mul_hi_u32_u24 v14, 429497, v65
    v_lshrrev_b32 v12, 3, v97
    v_cos_f32 v8, v8
    v_lshlrev_b16 v13, 3, v97
    v_mad_i32_i24 v11, v14, s55, v65
    v_bitop3_b32 v12, v6, v13, v12 bitop3:0xca
    v_lshl_add_u32 v11, v11, 17, s40
    v_lshlrev_b16 v14, 8, v14
    v_lshrrev_b32 v13, 2, v97
    v_add_u32 v65, v12, v11
    v_bitop3_b32 v97, v5, v13, v14 bitop3:0xea
    v_cvt_pk_bf16_f32 v104, v7, v8
    v_perm_b32 v12, v104, v104, s41
    v_bitop3_b32 v64, v4, v12, v64 bitop3:0xca
    v_perm_b32 v13, v104, v104, s42
    v_bitop3_b32 v65, v4, v13, v65 bitop3:0xca
    v_mul_hi_u32_u24 v14, 429497, v66
    v_lshrrev_b32 v12, 3, v98
    v_cos_f32 v9, v9
    v_lshlrev_b16 v13, 3, v98
    v_mad_i32_i24 v11, v14, s55, v66
    v_bitop3_b32 v12, v6, v13, v12 bitop3:0xca
    v_lshl_add_u32 v11, v11, 17, s40
    v_lshlrev_b16 v14, 8, v14
    v_lshrrev_b32 v13, 2, v98
    v_add_u32 v66, v12, v11
    v_bitop3_b32 v98, v5, v13, v14 bitop3:0xea
    v_mul_hi_u32_u24 v14, 429497, v67
    v_lshrrev_b32 v12, 3, v99
    v_cos_f32 v10, v10
    v_lshlrev_b16 v13, 3, v99
    v_mad_i32_i24 v11, v14, s55, v67
    v_bitop3_b32 v12, v6, v13, v12 bitop3:0xca
    v_lshl_add_u32 v11, v11, 17, s40
    v_lshlrev_b16 v14, 8, v14
    v_lshrrev_b32 v13, 2, v99
    v_add_u32 v67, v12, v11
    v_bitop3_b32 v99, v5, v13, v14 bitop3:0xea
    v_cvt_pk_bf16_f32 v105, v9, v10
    v_perm_b32 v12, v105, v105, s41
    v_bitop3_b32 v66, v4, v12, v66 bitop3:0xca
    v_perm_b32 v13, v105, v105, s42
    v_bitop3_b32 v67, v4, v13, v67 bitop3:0xca
    v_and_b32 v7, -4, v36
    v_lshl_add_u32 v8, v36, 2, v7
    ds_write_b32 v8, v32
    v_lshl_add_u32 v7, v7, 2, v36
    ds_write_b8 v7, v30 offset:16
    v_and_b32 v9, -4, v37
    v_lshl_add_u32 v10, v37, 2, v9
    ds_write_b32 v10, v33
    v_lshl_add_u32 v9, v9, 2, v37
    ds_write_b8_d16_hi v9, v30 offset:16
    v_and_b32 v7, -4, v38
    v_lshl_add_u32 v8, v38, 2, v7
    ds_write_b32 v8, v34
    v_lshl_add_u32 v7, v7, 2, v38
    ds_write_b8 v7, v31 offset:16
    v_and_b32 v9, -4, v39
    v_lshl_add_u32 v10, v39, 2, v9
    ds_write_b32 v10, v35
    v_lshl_add_u32 v9, v9, 2, v39
    ds_write_b8_d16_hi v9, v31 offset:16
    s_add_u32 s47, s96, 0x7800000
    s_lshr_b32 s47, s47, 1
    buffer_load_dwordx2 v[108:109], v1, s[16:19], s47 offen nt
    s_add_u32 s44, s96, 0x7c00000
    s_lshr_b32 s44, s44, 1
    buffer_load_dwordx2 v[110:111], v1, s[16:19], s44 offen nt
    s_waitcnt vmcnt(4)
    v_lshlrev_b32 v7, 16, v106
    v_and_b32 v8, 0xffff0000, v106
    v_lshlrev_b32 v9, 16, v107
    v_and_b32 v10, 0xffff0000, v107
    v_mul_f32 v7, 0.15915494, v7
    v_mul_f32 v8, 0.15915494, v8
    v_mul_f32 v9, 0.15915494, v9
    v_mul_f32 v10, 0.15915494, v10
    v_mul_hi_u32_u24 v14, 429497, v60
    v_lshrrev_b32 v12, 3, v100
    v_cos_f32 v7, v7
    v_lshlrev_b16 v13, 3, v100
    v_mad_i32_i24 v11, v14, s55, v60
    v_bitop3_b32 v12, v6, v13, v12 bitop3:0xca
    v_lshl_add_u32 v11, v11, 17, s40
    v_lshlrev_b16 v14, 8, v14
    v_lshrrev_b32 v13, 2, v100
    v_add_u32 v60, v12, v11
    v_bitop3_b32 v100, v5, v13, v14 bitop3:0xea
    v_mul_hi_u32_u24 v14, 429497, v61
    v_lshrrev_b32 v12, 3, v101
    v_cos_f32 v8, v8
    v_lshlrev_b16 v13, 3, v101
    v_mad_i32_i24 v11, v14, s55, v61
    v_bitop3_b32 v12, v6, v13, v12 bitop3:0xca
    v_lshl_add_u32 v11, v11, 17, s40
    v_lshlrev_b16 v14, 8, v14
    v_lshrrev_b32 v13, 2, v101
    v_add_u32 v61, v12, v11
    v_bitop3_b32 v101, v5, v13, v14 bitop3:0xea
    v_cvt_pk_bf16_f32 v106, v7, v8
    v_perm_b32 v12, v106, v106, s41
    v_bitop3_b32 v60, v4, v12, v60 bitop3:0xca
    v_perm_b32 v13, v106, v106, s42
    v_bitop3_b32 v61, v4, v13, v61 bitop3:0xca
    v_mul_hi_u32_u24 v14, 429497, v62
    v_lshrrev_b32 v12, 3, v102
    v_cos_f32 v9, v9
    v_lshlrev_b16 v13, 3, v102
    v_mad_i32_i24 v11, v14, s55, v62
    v_bitop3_b32 v12, v6, v13, v12 bitop3:0xca
    v_lshl_add_u32 v11, v11, 17, s40
    v_lshlrev_b16 v14, 8, v14
    v_lshrrev_b32 v13, 2, v102
    v_add_u32 v62, v12, v11
    v_bitop3_b32 v102, v5, v13, v14 bitop3:0xea
    v_mul_hi_u32_u24 v14, 429497, v63
    v_lshrrev_b32 v12, 3, v103
    v_cos_f32 v10, v10
    v_lshlrev_b16 v13, 3, v103
    v_mad_i32_i24 v11, v14, s55, v63
    v_bitop3_b32 v12, v6, v13, v12 bitop3:0xca
    v_lshl_add_u32 v11, v11, 17, s40
    v_lshlrev_b16 v14, 8, v14
    v_lshrrev_b32 v13, 2, v103
    v_add_u32 v63, v12, v11
    v_bitop3_b32 v103, v5, v13, v14 bitop3:0xea
    v_cvt_pk_bf16_f32 v107, v9, v10
    v_perm_b32 v12, v107, v107, s41
    v_bitop3_b32 v62, v4, v12, v62 bitop3:0xca
    v_perm_b32 v13, v107, v107, s42
    v_bitop3_b32 v63, v4, v13, v63 bitop3:0xca
    v_add_u32 v7, s72, v0
    v_add_u32 v12, s73, v0
    v_add_u32 v13, s85, v0
    v_add_u32 v14, s91, v0
    v_add_u32 v15, s93, v0
    s_min_i32 s3, s72, s73
    s_min_i32 s3, s3, s85
    s_min_i32 s3, s3, s91
    s_min_i32 s3, s3, s93
    v_add_u32 v3, s3, v0
    v_mov_b32 v8, 0
    v_mov_b32 v9, 0
    v_mov_b32 v10, 0
    v_mov_b32 v11, 0
    s_waitcnt lgkmcnt(0)
    s_barrier
    ds_read_b128 v[116:119], v7 offset:0
    ds_read_b128 v[92:95], v12 offset:0
    ds_read_b128 v[16:19], v13 offset:0
    ds_read_b128 v[120:123], v14 offset:0
    ds_read_b128 v[44:47], v15 offset:0
    ds_write_b128 v3, v[8:11]
    ds_read_b128 v[20:23], v7 offset:16384
    ds_read_b128 v[124:127], v12 offset:16384
    ds_read_b128 v[32:35], v13 offset:16384
    ds_read_b128 v[36:39], v14 offset:16384
    ds_read_b128 v[28:31], v15 offset:16384
    s_waitcnt lgkmcnt(0)
    s_barrier
    s_setprio 3
    s_add_u32 s45, s35, 0x5484000
    s_add_u32 s45, s45, s72
    buffer_store_dwordx4 v[116:119], v0, s[20:23], s45 offen sc1
    s_add_u32 s46, s96, 0x7c00000
    s_nop 0
    v_lshlrev_b32 v116, 1, v1
    buffer_load_dwordx4 v[116:119], v116, s[8:11], s46 offen nt
    s_add_u32 s47, s35, 0x5484000
    s_add_u32 s47, s47, s73
    buffer_store_dwordx4 v[92:95], v0, s[20:23], s47 offen sc1
    s_add_u32 s44, s96, 0x7c00000
    s_nop 0
    v_lshlrev_b32 v92, 1, v1
    buffer_load_dwordx4 v[92:95], v92, s[12:15], s44 offen nt
    ds_add_u32 v24, v2
    ds_add_u32 v25, v2
    ds_add_u32 v26, v2
    ds_add_u32 v27, v2
    ds_add_u32 v52, v2
    ds_add_u32 v53, v2
    ds_add_u32 v54, v2
    ds_add_u32 v55, v2
    s_setprio 2
    ds_add_u32 v72, v2
    ds_add_u32 v73, v2
    ds_add_u32 v74, v2
    ds_add_u32 v75, v2
    ds_add_u32 v80, v2
    ds_add_u32 v81, v2
    ds_add_u32 v82, v2
    ds_add_u32 v83, v2
    s_setprio 1
    s_add_u32 s45, s35, 0x5484000
    s_add_u32 s45, s45, s85
    buffer_store_dwordx4 v[16:19], v0, s[20:23], s45 offen sc1
    s_add_u32 s46, s96, 0x8000000
    s_nop 0
    v_lshlrev_b32 v16, 1, v1
    buffer_load_dwordx4 v[16:19], v16, s[8:11], s46 offen nt
    ds_add_u32 v96, v2
    ds_add_u32 v97, v2
    ds_add_u32 v98, v2
    ds_add_u32 v99, v2
    s_mov_b32 s68, s66
    s_mov_b32 s69, s67
    s_mov_b32 s70, 0x100
    s_mov_b32 s71, 0x20000
    v_mov_b32 v3, 1
    s_cmp_lg_u32 s32, 15
    s_cbranch_scc1 L1_tk
    s_mov_b64 exec, 1
    s_and_b32 s3, s2, 1
    s_lshl_b32 s3, s3, 7
    buffer_atomic_add v3, off, s[68:71], s3 sc0
    s_mov_b64 exec, -1
L1_tk:
    ds_add_u32 v100, v2
    ds_add_u32 v101, v2
    ds_add_u32 v102, v2
    ds_add_u32 v103, v2
    s_setprio 0
    s_waitcnt vmcnt(6)
    v_lshlrev_b32 v7, 16, v108
    v_and_b32 v8, 0xffff0000, v108
    v_lshlrev_b32 v9, 16, v109
    v_and_b32 v10, 0xffff0000, v109
    v_mul_f32 v7, 0.15915494, v7
    v_mul_f32 v8, 0.15915494, v8
    v_mul_f32 v9, 0.15915494, v9
    v_mul_f32 v10, 0.15915494, v10
    v_mul_hi_u32_u24 v14, 429497, v112
    v_lshrrev_b32 v12, 3, v88
    v_cos_f32 v7, v7
    v_lshlrev_b16 v13, 3, v88
    v_mad_i32_i24 v11, v14, s55, v112
    v_bitop3_b32 v12, v6, v13, v12 bitop3:0xca
    v_lshl_add_u32 v11, v11, 17, s40
    v_lshlrev_b16 v14, 8, v14
    v_lshrrev_b32 v13, 2, v88
    v_add_u32 v112, v12, v11
    v_bitop3_b32 v88, v5, v13, v14 bitop3:0xea
    ds_add_u32 v88, v2
    v_mul_hi_u32_u24 v14, 429497, v113
    v_lshrrev_b32 v12, 3, v89
    v_cos_f32 v8, v8
    v_lshlrev_b16 v13, 3, v89
    v_mad_i32_i24 v11, v14, s55, v113
    v_bitop3_b32 v12, v6, v13, v12 bitop3:0xca
    v_lshl_add_u32 v11, v11, 17, s40
    v_lshlrev_b16 v14, 8, v14
    v_lshrrev_b32 v13, 2, v89
    v_add_u32 v113, v12, v11
    v_bitop3_b32 v89, v5, v13, v14 bitop3:0xea
    ds_add_u32 v89, v2
    v_cvt_pk_bf16_f32 v108, v7, v8
    v_perm_b32 v12, v108, v108, s41
    v_bitop3_b32 v112, v4, v12, v112 bitop3:0xca
    v_perm_b32 v13, v108, v108, s42
    v_bitop3_b32 v113, v4, v13, v113 bitop3:0xca
    v_mul_hi_u32_u24 v14, 429497, v114
    v_lshrrev_b32 v12, 3, v90
    v_cos_f32 v9, v9
    v_lshlrev_b16 v13, 3, v90
    v_mad_i32_i24 v11, v14, s55, v114
    v_bitop3_b32 v12, v6, v13, v12 bitop3:0xca
    v_lshl_add_u32 v11, v11, 17, s40
    v_lshlrev_b16 v14, 8, v14
    v_lshrrev_b32 v13, 2, v90
    v_add_u32 v114, v12, v11
    v_bitop3_b32 v90, v5, v13, v14 bitop3:0xea
    ds_add_u32 v90, v2
    v_mul_hi_u32_u24 v14, 429497, v115
    v_lshrrev_b32 v12, 3, v91
    v_cos_f32 v10, v10
    v_lshlrev_b16 v13, 3, v91
    v_mad_i32_i24 v11, v14, s55, v115
    v_bitop3_b32 v12, v6, v13, v12 bitop3:0xca
    v_lshl_add_u32 v11, v11, 17, s40
    v_lshlrev_b16 v14, 8, v14
    v_lshrrev_b32 v13, 2, v91
    v_add_u32 v115, v12, v11
    v_bitop3_b32 v91, v5, v13, v14 bitop3:0xea
    ds_add_u32 v91, v2
    v_cvt_pk_bf16_f32 v109, v9, v10
    v_perm_b32 v12, v109, v109, s41
    v_bitop3_b32 v114, v4, v12, v114 bitop3:0xca
    v_perm_b32 v13, v109, v109, s42
    v_bitop3_b32 v115, v4, v13, v115 bitop3:0xca
    s_waitcnt vmcnt(2)
    v_lshlrev_b32 v7, 16, v110
    v_and_b32 v8, 0xffff0000, v110
    v_lshlrev_b32 v9, 16, v111
    v_and_b32 v10, 0xffff0000, v111
    v_mul_f32 v7, 0.15915494, v7
    v_mul_f32 v8, 0.15915494, v8
    v_mul_f32 v9, 0.15915494, v9
    v_mul_f32 v10, 0.15915494, v10
    v_mul_hi_u32_u24 v14, 429497, v116
    v_lshrrev_b32 v12, 3, v92
    v_cos_f32 v7, v7
    v_lshlrev_b16 v13, 3, v92
    v_mad_i32_i24 v11, v14, s55, v116
    v_bitop3_b32 v12, v6, v13, v12 bitop3:0xca
    v_lshl_add_u32 v11, v11, 17, s40
    v_lshlrev_b16 v14, 8, v14
    v_lshrrev_b32 v13, 2, v92
    v_add_u32 v116, v12, v11
    v_bitop3_b32 v92, v5, v13, v14 bitop3:0xea
    ds_add_u32 v92, v2
    v_mul_hi_u32_u24 v14, 429497, v117
    v_lshrrev_b32 v12, 3, v93
    v_cos_f32 v8, v8
    v_lshlrev_b16 v13, 3, v93
    v_mad_i32_i24 v11, v14, s55, v117
    v_bitop3_b32 v12, v6, v13, v12 bitop3:0xca
    v_lshl_add_u32 v11, v11, 17, s40
    v_lshlrev_b16 v14, 8, v14
    v_lshrrev_b32 v13, 2, v93
    v_add_u32 v117, v12, v11
    v_bitop3_b32 v93, v5, v13, v14 bitop3:0xea
    ds_add_u32 v93, v2
    v_cvt_pk_bf16_f32 v110, v7, v8
    v_perm_b32 v12, v110, v110, s41
    v_bitop3_b32 v116, v4, v12, v116 bitop3:0xca
    v_perm_b32 v13, v110, v110, s42
    v_bitop3_b32 v117, v4, v13, v117 bitop3:0xca
    v_mul_hi_u32_u24 v14, 429497, v118
    v_lshrrev_b32 v12, 3, v94
    v_cos_f32 v9, v9
    v_lshlrev_b16 v13, 3, v94
    v_mad_i32_i24 v11, v14, s55, v118
    v_bitop3_b32 v12, v6, v13, v12 bitop3:0xca
    v_lshl_add_u32 v11, v11, 17, s40
    v_lshlrev_b16 v14, 8, v14
    v_lshrrev_b32 v13, 2, v94
    v_add_u32 v118, v12, v11
    v_bitop3_b32 v94, v5, v13, v14 bitop3:0xea
    ds_add_u32 v94, v2
    v_mul_hi_u32_u24 v14, 429497, v119
    v_lshrrev_b32 v12, 3, v95
    v_cos_f32 v10, v10
    v_lshlrev_b16 v13, 3, v95
    v_mad_i32_i24 v11, v14, s55, v119
    v_bitop3_b32 v12, v6, v13, v12 bitop3:0xca
    v_lshl_add_u32 v11, v11, 17, s40
    v_lshlrev_b16 v14, 8, v14
    v_lshrrev_b32 v13, 2, v95
    v_add_u32 v119, v12, v11
    v_bitop3_b32 v95, v5, v13, v14 bitop3:0xea
    ds_add_u32 v95, v2
    v_cvt_pk_bf16_f32 v111, v9, v10
    v_perm_b32 v12, v111, v111, s41
    v_bitop3_b32 v118, v4, v12, v118 bitop3:0xca
    v_perm_b32 v13, v111, v111, s42
    v_bitop3_b32 v119, v4, v13, v119 bitop3:0xca
    v_lshrrev_b32 v8, 2, v0
    v_and_b32 v7, 0x3c00, v0
    v_bitop3_b32 v7, v5, v8, v7 bitop3:0xea
    s_waitcnt lgkmcnt(0)
    s_barrier
    ds_read2st64_b32 v[8:9], v7 offset0:0 offset1:1
    ds_read2st64_b32 v[10:11], v7 offset0:2 offset1:3
    s_add_u32 s47, s35, 0x5484000
    s_add_u32 s47, s47, s91
    buffer_store_dwordx4 v[120:123], v0, s[20:23], s47 offen sc1
    s_add_u32 s44, s96, 0x8000000
    s_nop 0
    v_lshlrev_b32 v120, 1, v1
    buffer_load_dwordx4 v[120:123], v120, s[12:15], s44 offen nt
    s_waitcnt lgkmcnt(0)
    v_lshl_or_b32 v12, v9, 16, v8
    v_lshl_or_b32 v13, v11, 16, v10
    v_mov_b32 v14, v12
    v_mov_b32 v15, v13
    s_nop 0
    v_add_u32_dpp v14, v14, v14 row_shr:1 row_mask:0xf bank_mask:0xf bound_ctrl:1
    v_add_u32_dpp v15, v15, v15 row_shr:1 row_mask:0xf bank_mask:0xf bound_ctrl:1
    s_nop 0
    v_add_u32_dpp v14, v14, v14 row_shr:2 row_mask:0xf bank_mask:0xf bound_ctrl:1
    v_add_u32_dpp v15, v15, v15 row_shr:2 row_mask:0xf bank_mask:0xf bound_ctrl:1
    s_nop 0
    v_add_u32_dpp v14, v14, v14 row_shr:4 row_mask:0xf bank_mask:0xf bound_ctrl:1
    v_add_u32_dpp v15, v15, v15 row_shr:4 row_mask:0xf bank_mask:0xf bound_ctrl:1
    s_nop 0
    v_add_u32_dpp v14, v14, v14 row_shr:8 row_mask:0xf bank_mask:0xf bound_ctrl:1
    v_add_u32_dpp v15, v15, v15 row_shr:8 row_mask:0xf bank_mask:0xf bound_ctrl:1
    s_nop 0
    v_add_u32_dpp v14, v14, v14 row_bcast:15 row_mask:0xa bank_mask:0xf
    v_add_u32_dpp v15, v15, v15 row_bcast:15 row_mask:0xa bank_mask:0xf
    s_nop 0
    v_add_u32_dpp v14, v14, v14 row_bcast:31 row_mask:0xc bank_mask:0xf
    v_add_u32_dpp v15, v15, v15 row_bcast:31 row_mask:0xc bank_mask:0xf
    v_readlane_b32 s48, v14, 63
    v_readlane_b32 s49, v15, 63
    s_lshl_b32 s54, s32, 2
    v_mov_b32 v8, s54
    s_and_b32 s50, s48, 0xffff
    s_lshr_b32 s51, s48, 16
    s_and_b32 s52, s49, 0xffff
    s_lshr_b32 s53, s49, 16
    s_add_u32 s51, s51, s50
    s_add_u32 s52, s52, s51
    s_add_u32 s53, s53, s52
    v_mov_b32 v9, s53
    s_mov_b64 exec, 1
    ds_write_b32 v8, v9 offset:16384
    s_cmp_lg_u32 s32, 15
    s_cbranch_scc1 L1_tk2
    s_waitcnt vmcnt(1)
L1_tk2:
    ds_write_b32 v8, v3 offset:16448
    s_mov_b64 exec, -1
    v_and_b32 v8, 60, v7
    s_waitcnt lgkmcnt(0)
    s_barrier
    ds_read_b32 v9, v8 offset:16384
    ds_read_b32 v10, v8 offset:16448
    s_waitcnt lgkmcnt(0)
    v_readlane_b32 s84, v10, 15
    s_and_b32 s3, s2, 1
    s_lshl_b32 s3, s3, 7
    s_add_u32 s84, s84, s3
    s_and_b32 s4, s84, 127
    s_lshl_b32 s6, s32, 10
    s_mov_b32 s43, 5
    s_bitcmp1_b32 s2, 0
    s_cselect_b32 s5, 128, 0
    s_mov_b32 s7, 128
    s_cselect_b32 s7, 124, s7
    s_add_u32 s5, s5, s4
    s_add_u32 s5, s5, 9472
    s_lshl_b32 s5, s5, 14
    s_add_u32 s38, s5, s6
    s_cmp_lt_u32 s4, s7
    s_addc_u32 s43, s43, 0
    s_bitcmp1_b32 s2, 0
    s_cselect_b32 s5, 112, 0
    s_mov_b32 s7, 112
    s_cselect_b32 s7, 100, s7
    s_add_u32 s5, s5, s4
    s_add_u32 s5, s5, 9724
    s_lshl_b32 s5, s5, 14
    s_add_u32 s39, s5, s6
    s_cmp_lt_u32 s4, s7
    s_addc_u32 s43, s43, 0
    s_bitcmp1_b32 s2, 0
    s_cselect_b32 s5, 64, 0
    s_mov_b32 s7, 64
    s_cselect_b32 s7, 0, s7
    s_add_u32 s5, s5, s4
    s_add_u32 s5, s5, 9936
    s_lshl_b32 s5, s5, 14
    s_add_u32 s58, s5, s6
    s_cmp_lt_u32 s4, s7
    s_addc_u32 s43, s43, 0
    v_add_u32_dpp v9, v9, v9 row_shr:1 row_mask:0xf bank_mask:0xf bound_ctrl:1
    s_nop 1
    v_add_u32_dpp v9, v9, v9 row_shr:2 row_mask:0xf bank_mask:0xf bound_ctrl:1
    s_nop 1
    v_add_u32_dpp v9, v9, v9 row_shr:4 row_mask:0xf bank_mask:0xf bound_ctrl:1
    s_nop 1
    v_add_u32_dpp v9, v9, v9 row_shr:8 row_mask:0xf bank_mask:0xf bound_ctrl:1
    s_nop 0
    v_readlane_b32 s54, v9, s32
    s_sub_u32 s54, s54, s53
    s_add_u32 s50, s50, s54
    s_add_u32 s51, s51, s54
    s_add_u32 s52, s52, s54
    s_pack_ll_b32_b16 s48, s54, s50
    s_pack_ll_b32_b16 s49, s51, s52
    v_add_u32 v14, s48, v14
    v_add_u32 v15, s49, v15
    v_sub_u32 v12, v14, v12
    v_sub_u32 v13, v15, v13
    v_and_b32 v8, 0xffff, v12
    v_lshrrev_b32 v9, 16, v12
    v_and_b32 v10, 0xffff, v13
    v_lshrrev_b32 v11, 16, v13
    ds_write2st64_b32 v7, v8, v9 offset0:0 offset1:1
    ds_write2st64_b32 v7, v10, v11 offset0:2 offset1:3
    v_and_b32 v8, 0x3f0, v0
    v_lshl_add_u32 v8, v8, 1, s36
    ds_write_b64 v8, v[12:13] offset:20480
    s_bitset0_b64 exec, 63
    s_not_b64 exec, exec
    ds_write_b64 v8, v[14:15] offset:20512
    s_mov_b64 exec, -1
    s_waitcnt lgkmcnt(0)
    s_barrier
    s_setprio 3
    ds_add_rtn_u32 v24, v24, v2
    ds_add_rtn_u32 v25, v25, v2
    ds_add_rtn_u32 v26, v26, v2
    ds_add_rtn_u32 v27, v27, v2
    ds_read_b128 v[12:15], v0 offset:20480
    v_cmp_gt_u32 vcc, 8448, v0
    s_add_u32 s45, s35, 0x5484000
    s_add_u32 s45, s45, s93
    buffer_store_dwordx4 v[44:47], v0, s[20:23], s45 offen sc1
    s_add_u32 s46, s96, 0x8000000
    s_lshr_b32 s46, s46, 1
    buffer_load_dwordx2 v[44:45], v1, s[16:19], s46 offen nt
    s_add_u32 s47, s96, 0x8400000
    s_lshr_b32 s47, s47, 1
    buffer_load_dwordx2 v[46:47], v1, s[16:19], s47 offen nt
    ds_add_rtn_u32 v52, v52, v2
    ds_add_rtn_u32 v53, v53, v2
    ds_add_rtn_u32 v54, v54, v2
    ds_add_rtn_u32 v55, v55, v2
    s_setprio 2
    ds_add_rtn_u32 v72, v72, v2
    ds_add_rtn_u32 v73, v73, v2
    ds_add_rtn_u32 v74, v74, v2
    ds_add_rtn_u32 v75, v75, v2
    s_waitcnt lgkmcnt(8)
    s_cbranch_vccz L1_p4
    s_add_u32 s44, s35, 0x7ec0000
    s_mov_b64 exec, vcc
    buffer_store_dwordx4 v[12:15], v0, s[24:27], s44 offen sc1
    s_mov_b64 exec, -1
L1_p4:
    s_add_u32 s45, s35, 0x5488000
    s_add_u32 s45, s45, s72
    buffer_store_dwordx4 v[20:23], v0, s[20:23], s45 offen sc1
    s_add_u32 s46, s96, 0x8400000
    s_nop 0
    v_lshlrev_b32 v20, 1, v1
    buffer_load_dwordx4 v[20:23], v20, s[8:11], s46 offen nt
    ds_add_rtn_u32 v80, v80, v2
    ds_add_rtn_u32 v81, v81, v2
    ds_add_rtn_u32 v82, v82, v2
    ds_add_rtn_u32 v83, v83, v2
    s_setprio 1
    ds_add_rtn_u32 v96, v96, v2
    ds_add_rtn_u32 v97, v97, v2
    ds_add_rtn_u32 v98, v98, v2
    ds_add_rtn_u32 v99, v99, v2
    ds_add_rtn_u32 v100, v100, v2
    ds_add_rtn_u32 v101, v101, v2
    ds_add_rtn_u32 v102, v102, v2
    ds_add_rtn_u32 v103, v103, v2
    s_add_u32 s47, s35, 0x5488000
    s_add_u32 s47, s47, s73
    buffer_store_dwordx4 v[124:127], v0, s[20:23], s47 offen sc1
    s_add_u32 s44, s96, 0x8400000
    s_nop 0
    v_lshlrev_b32 v124, 1, v1
    buffer_load_dwordx4 v[124:127], v124, s[12:15], s44 offen nt
    s_setprio 0
    ds_add_rtn_u32 v88, v88, v2
    ds_add_rtn_u32 v89, v89, v2
    ds_add_rtn_u32 v90, v90, v2
    ds_add_rtn_u32 v91, v91, v2
    ds_add_rtn_u32 v92, v92, v2
    ds_add_rtn_u32 v93, v93, v2
    ds_add_rtn_u32 v94, v94, v2
    ds_add_rtn_u32 v95, v95, v2
    s_waitcnt lgkmcnt(0)
    s_barrier
    s_setprio 3
    v_and_b32 v7, -4, v24
    v_lshl_add_u32 v8, v24, 2, v7
    ds_write_b32 v8, v40
    v_lshl_add_u32 v7, v7, 2, v24
    ds_write_b8 v7, v84 offset:16
    v_and_b32 v9, -4, v25
    v_lshl_add_u32 v10, v25, 2, v9
    ds_write_b32 v10, v41
    v_lshl_add_u32 v9, v9, 2, v25
    ds_write_b8_d16_hi v9, v84 offset:16
    v_and_b32 v7, -4, v26
    v_lshl_add_u32 v8, v26, 2, v7
    ds_write_b32 v8, v42
    v_lshl_add_u32 v7, v7, 2, v26
    ds_write_b8 v7, v85 offset:16
    v_and_b32 v9, -4, v27
    v_lshl_add_u32 v10, v27, 2, v9
    ds_write_b32 v10, v43
    v_lshl_add_u32 v9, v9, 2, v27
    ds_write_b8_d16_hi v9, v85 offset:16
    s_add_u32 s45, s35, 0x5488000
    s_add_u32 s45, s45, s85
    buffer_store_dwordx4 v[32:35], v0, s[20:23], s45 offen sc1
    s_add_u32 s46, s96, 0x8800000
    v_lshlrev_b32 v40, 1, v1
    buffer_load_dwordx4 v[40:43], v40, s[8:11], s46 offen nt
    s_add_u32 s47, s96, 0x8800000
    v_lshlrev_b32 v24, 1, v1
    buffer_load_dwordx4 v[24:27], v24, s[12:15], s47 offen nt
    v_and_b32 v7, -4, v52
    v_lshl_add_u32 v8, v52, 2, v7
    ds_write_b32 v8, v48
    v_lshl_add_u32 v7, v7, 2, v52
    ds_write_b8 v7, v86 offset:16
    v_and_b32 v9, -4, v53
    v_lshl_add_u32 v10, v53, 2, v9
    ds_write_b32 v10, v49
    v_lshl_add_u32 v9, v9, 2, v53
    ds_write_b8_d16_hi v9, v86 offset:16
    v_and_b32 v7, -4, v54
    v_lshl_add_u32 v8, v54, 2, v7
    ds_write_b32 v8, v50
    v_lshl_add_u32 v7, v7, 2, v54
    ds_write_b8 v7, v87 offset:16
    v_and_b32 v9, -4, v55
    v_lshl_add_u32 v10, v55, 2, v9
    ds_write_b32 v10, v51
    v_lshl_add_u32 v9, v9, 2, v55
    ds_write_b8_d16_hi v9, v87 offset:16
    s_add_u32 s44, s96, 0x8800000
    s_lshr_b32 s44, s44, 1
    buffer_load_dwordx2 v[32:33], v1, s[16:19], s44 offen nt
    s_add_u32 s45, s96, 0x8c00000
    s_lshr_b32 s45, s45, 1
    buffer_load_dwordx2 v[34:35], v1, s[16:19], s45 offen nt
    s_add_u32 s46, s96, 0x8c00000
    v_lshlrev_b32 v48, 1, v1
    buffer_load_dwordx4 v[48:51], v48, s[8:11], s46 offen nt
    s_waitcnt vmcnt(10)
    v_lshlrev_b32 v7, 16, v44
    v_and_b32 v8, 0xffff0000, v44
    v_lshlrev_b32 v9, 16, v45
    v_and_b32 v10, 0xffff0000, v45
    v_mul_f32 v7, 0.15915494, v7
    v_mul_f32 v8, 0.15915494, v8
    v_mul_f32 v9, 0.15915494, v9
    v_mul_f32 v10, 0.15915494, v10
    v_mul_hi_u32_u24 v14, 429497, v16
    v_lshrrev_b32 v12, 3, v120
    v_cos_f32 v7, v7
    v_lshlrev_b16 v13, 3, v120
    v_mad_i32_i24 v11, v14, s55, v16
    v_bitop3_b32 v12, v6, v13, v12 bitop3:0xca
    v_lshl_add_u32 v11, v11, 17, s40
    v_lshlrev_b16 v14, 8, v14
    v_lshrrev_b32 v13, 2, v120
    v_add_u32 v16, v12, v11
    v_bitop3_b32 v120, v5, v13, v14 bitop3:0xea
    v_mul_hi_u32_u24 v14, 429497, v17
    v_lshrrev_b32 v12, 3, v121
    v_cos_f32 v8, v8
    v_lshlrev_b16 v13, 3, v121
    v_mad_i32_i24 v11, v14, s55, v17
    v_bitop3_b32 v12, v6, v13, v12 bitop3:0xca
    v_lshl_add_u32 v11, v11, 17, s40
    v_lshlrev_b16 v14, 8, v14
    v_lshrrev_b32 v13, 2, v121
    v_add_u32 v17, v12, v11
    v_bitop3_b32 v121, v5, v13, v14 bitop3:0xea
    v_cvt_pk_bf16_f32 v44, v7, v8
    v_perm_b32 v12, v44, v44, s41
    v_bitop3_b32 v16, v4, v12, v16 bitop3:0xca
    v_perm_b32 v13, v44, v44, s42
    v_bitop3_b32 v17, v4, v13, v17 bitop3:0xca
    v_mul_hi_u32_u24 v14, 429497, v18
    v_lshrrev_b32 v12, 3, v122
    v_cos_f32 v9, v9
    v_lshlrev_b16 v13, 3, v122
    v_mad_i32_i24 v11, v14, s55, v18
    v_bitop3_b32 v12, v6, v13, v12 bitop3:0xca
    v_lshl_add_u32 v11, v11, 17, s40
    v_lshlrev_b16 v14, 8, v14
    v_lshrrev_b32 v13, 2, v122
    v_add_u32 v18, v12, v11
    v_bitop3_b32 v122, v5, v13, v14 bitop3:0xea
    v_mul_hi_u32_u24 v14, 429497, v19
    v_lshrrev_b32 v12, 3, v123
    v_cos_f32 v10, v10
    v_lshlrev_b16 v13, 3, v123
    v_mad_i32_i24 v11, v14, s55, v19
    v_bitop3_b32 v12, v6, v13, v12 bitop3:0xca
    v_lshl_add_u32 v11, v11, 17, s40
    v_lshlrev_b16 v14, 8, v14
    v_lshrrev_b32 v13, 2, v123
    v_add_u32 v19, v12, v11
    v_bitop3_b32 v123, v5, v13, v14 bitop3:0xea
    v_cvt_pk_bf16_f32 v45, v9, v10
    v_perm_b32 v12, v45, v45, s41
    v_bitop3_b32 v18, v4, v12, v18 bitop3:0xca
    v_perm_b32 v13, v45, v45, s42
    v_bitop3_b32 v19, v4, v13, v19 bitop3:0xca
    s_setprio 2
    v_and_b32 v7, -4, v72
    v_lshl_add_u32 v8, v72, 2, v7
    ds_write_b32 v8, v68
    v_lshl_add_u32 v7, v7, 2, v72
    ds_write_b8 v7, v56 offset:16
    v_and_b32 v9, -4, v73
    v_lshl_add_u32 v10, v73, 2, v9
    ds_write_b32 v10, v69
    v_lshl_add_u32 v9, v9, 2, v73
    ds_write_b8_d16_hi v9, v56 offset:16
    v_and_b32 v7, -4, v74
    v_lshl_add_u32 v8, v74, 2, v7
    ds_write_b32 v8, v70
    v_lshl_add_u32 v7, v7, 2, v74
    ds_write_b8 v7, v57 offset:16
    v_and_b32 v9, -4, v75
    v_lshl_add_u32 v10, v75, 2, v9
    ds_write_b32 v10, v71
    v_lshl_add_u32 v9, v9, 2, v75
    ds_write_b8_d16_hi v9, v57 offset:16
    s_add_u32 s47, s35, 0x5488000
    s_add_u32 s47, s47, s91
    buffer_store_dwordx4 v[36:39], v0, s[20:23], s47 offen sc1
    s_add_u32 s44, s96, 0x8c00000
    v_lshlrev_b32 v52, 1, v1
    buffer_load_dwordx4 v[52:55], v52, s[12:15], s44 offen nt
    s_waitcnt vmcnt(8)
    v_lshlrev_b32 v7, 16, v46
    v_and_b32 v8, 0xffff0000, v46
    v_lshlrev_b32 v9, 16, v47
    v_and_b32 v10, 0xffff0000, v47
    v_mul_f32 v7, 0.15915494, v7
    v_mul_f32 v8, 0.15915494, v8
    v_mul_f32 v9, 0.15915494, v9
    v_mul_f32 v10, 0.15915494, v10
    v_mul_hi_u32_u24 v14, 429497, v20
    v_lshrrev_b32 v12, 3, v124
    v_cos_f32 v7, v7
    v_lshlrev_b16 v13, 3, v124
    v_mad_i32_i24 v11, v14, s55, v20
    v_bitop3_b32 v12, v6, v13, v12 bitop3:0xca
    v_lshl_add_u32 v11, v11, 17, s40
    v_lshlrev_b16 v14, 8, v14
    v_lshrrev_b32 v13, 2, v124
    v_add_u32 v20, v12, v11
    v_bitop3_b32 v124, v5, v13, v14 bitop3:0xea
    v_mul_hi_u32_u24 v14, 429497, v21
    v_lshrrev_b32 v12, 3, v125
    v_cos_f32 v8, v8
    v_lshlrev_b16 v13, 3, v125
    v_mad_i32_i24 v11, v14, s55, v21
    v_bitop3_b32 v12, v6, v13, v12 bitop3:0xca
    v_lshl_add_u32 v11, v11, 17, s40
    v_lshlrev_b16 v14, 8, v14
    v_lshrrev_b32 v13, 2, v125
    v_add_u32 v21, v12, v11
    v_bitop3_b32 v125, v5, v13, v14 bitop3:0xea
    v_cvt_pk_bf16_f32 v46, v7, v8
    v_perm_b32 v12, v46, v46, s41
    v_bitop3_b32 v20, v4, v12, v20 bitop3:0xca
    v_perm_b32 v13, v46, v46, s42
    v_bitop3_b32 v21, v4, v13, v21 bitop3:0xca
    v_mul_hi_u32_u24 v14, 429497, v22
    v_lshrrev_b32 v12, 3, v126
    v_cos_f32 v9, v9
    v_lshlrev_b16 v13, 3, v126
    v_mad_i32_i24 v11, v14, s55, v22
    v_bitop3_b32 v12, v6, v13, v12 bitop3:0xca
    v_lshl_add_u32 v11, v11, 17, s40
    v_lshlrev_b16 v14, 8, v14
    v_lshrrev_b32 v13, 2, v126
    v_add_u32 v22, v12, v11
    v_bitop3_b32 v126, v5, v13, v14 bitop3:0xea
    v_mul_hi_u32_u24 v14, 429497, v23
    v_lshrrev_b32 v12, 3, v127
    v_cos_f32 v10, v10
    v_lshlrev_b16 v13, 3, v127
    v_mad_i32_i24 v11, v14, s55, v23
    v_bitop3_b32 v12, v6, v13, v12 bitop3:0xca
    v_lshl_add_u32 v11, v11, 17, s40
    v_lshlrev_b16 v14, 8, v14
    v_lshrrev_b32 v13, 2, v127
    v_add_u32 v23, v12, v11
    v_bitop3_b32 v127, v5, v13, v14 bitop3:0xea
    v_cvt_pk_bf16_f32 v47, v9, v10
    v_perm_b32 v12, v47, v47, s41
    v_bitop3_b32 v22, v4, v12, v22 bitop3:0xca
    v_perm_b32 v13, v47, v47, s42
    v_bitop3_b32 v23, v4, v13, v23 bitop3:0xca
    v_and_b32 v7, -4, v80
    v_lshl_add_u32 v8, v80, 2, v7
    ds_write_b32 v8, v76
    v_lshl_add_u32 v7, v7, 2, v80
    ds_write_b8 v7, v58 offset:16
    v_and_b32 v9, -4, v81
    v_lshl_add_u32 v10, v81, 2, v9
    ds_write_b32 v10, v77
    v_lshl_add_u32 v9, v9, 2, v81
    ds_write_b8_d16_hi v9, v58 offset:16
    v_and_b32 v7, -4, v82
    v_lshl_add_u32 v8, v82, 2, v7
    ds_write_b32 v8, v78
    v_lshl_add_u32 v7, v7, 2, v82
    ds_write_b8 v7, v59 offset:16
    v_and_b32 v9, -4, v83
    v_lshl_add_u32 v10, v83, 2, v9
    ds_write_b32 v10, v79
    v_lshl_add_u32 v9, v9, 2, v83
    ds_write_b8_d16_hi v9, v59 offset:16
    s_add_u32 s45, s96, 0x9000000
    v_lshlrev_b32 v84, 1, v1
    buffer_load_dwordx4 v[84:87], v84, s[8:11], s45 offen nt
    s_add_u32 s46, s96, 0x9000000
    v_lshlrev_b32 v68, 1, v1
    buffer_load_dwordx4 v[68:71], v68, s[12:15], s46 offen nt
    s_waitcnt vmcnt(5)
    v_lshlrev_b32 v7, 16, v32
    v_and_b32 v8, 0xffff0000, v32
    v_lshlrev_b32 v9, 16, v33
    v_and_b32 v10, 0xffff0000, v33
    v_mul_f32 v7, 0.15915494, v7
    v_mul_f32 v8, 0.15915494, v8
    v_mul_f32 v9, 0.15915494, v9
    v_mul_f32 v10, 0.15915494, v10
    v_mul_hi_u32_u24 v14, 429497, v40
    v_lshrrev_b32 v12, 3, v24
    v_cos_f32 v7, v7
    v_lshlrev_b16 v13, 3, v24
    v_mad_i32_i24 v11, v14, s55, v40
    v_bitop3_b32 v12, v6, v13, v12 bitop3:0xca
    v_lshl_add_u32 v11, v11, 17, s40
    v_lshlrev_b16 v14, 8, v14
    v_lshrrev_b32 v13, 2, v24
    v_add_u32 v40, v12, v11
    v_bitop3_b32 v24, v5, v13, v14 bitop3:0xea
    v_mul_hi_u32_u24 v14, 429497, v41
    v_lshrrev_b32 v12, 3, v25
    v_cos_f32 v8, v8
    v_lshlrev_b16 v13, 3, v25
    v_mad_i32_i24 v11, v14, s55, v41
    v_bitop3_b32 v12, v6, v13, v12 bitop3:0xca
    v_lshl_add_u32 v11, v11, 17, s40
    v_lshlrev_b16 v14, 8, v14
    v_lshrrev_b32 v13, 2, v25
    v_add_u32 v41, v12, v11
    v_bitop3_b32 v25, v5, v13, v14 bitop3:0xea
    v_cvt_pk_bf16_f32 v32, v7, v8
    v_perm_b32 v12, v32, v32, s41
    v_bitop3_b32 v40, v4, v12, v40 bitop3:0xca
    v_perm_b32 v13, v32, v32, s42
    v_bitop3_b32 v41, v4, v13, v41 bitop3:0xca
    v_mul_hi_u32_u24 v14, 429497, v42
    v_lshrrev_b32 v12, 3, v26
    v_cos_f32 v9, v9
    v_lshlrev_b16 v13, 3, v26
    v_mad_i32_i24 v11, v14, s55, v42
    v_bitop3_b32 v12, v6, v13, v12 bitop3:0xca
    v_lshl_add_u32 v11, v11, 17, s40
    v_lshlrev_b16 v14, 8, v14
    v_lshrrev_b32 v13, 2, v26
    v_add_u32 v42, v12, v11
    v_bitop3_b32 v26, v5, v13, v14 bitop3:0xea
    v_mul_hi_u32_u24 v14, 429497, v43
    v_lshrrev_b32 v12, 3, v27
    v_cos_f32 v10, v10
    v_lshlrev_b16 v13, 3, v27
    v_mad_i32_i24 v11, v14, s55, v43
    v_bitop3_b32 v12, v6, v13, v12 bitop3:0xca
    v_lshl_add_u32 v11, v11, 17, s40
    v_lshlrev_b16 v14, 8, v14
    v_lshrrev_b32 v13, 2, v27
    v_add_u32 v43, v12, v11
    v_bitop3_b32 v27, v5, v13, v14 bitop3:0xea
    v_cvt_pk_bf16_f32 v33, v9, v10
    v_perm_b32 v12, v33, v33, s41
    v_bitop3_b32 v42, v4, v12, v42 bitop3:0xca
    v_perm_b32 v13, v33, v33, s42
    v_bitop3_b32 v43, v4, v13, v43 bitop3:0xca
    s_setprio 1
    v_and_b32 v7, -4, v96
    v_lshl_add_u32 v8, v96, 2, v7
    ds_write_b32 v8, v64
    v_lshl_add_u32 v7, v7, 2, v96
    ds_write_b8 v7, v104 offset:16
    v_and_b32 v9, -4, v97
    v_lshl_add_u32 v10, v97, 2, v9
    ds_write_b32 v10, v65
    v_lshl_add_u32 v9, v9, 2, v97
    ds_write_b8_d16_hi v9, v104 offset:16
    v_and_b32 v7, -4, v98
    v_lshl_add_u32 v8, v98, 2, v7
    ds_write_b32 v8, v66
    v_lshl_add_u32 v7, v7, 2, v98
    ds_write_b8 v7, v105 offset:16
    v_and_b32 v9, -4, v99
    v_lshl_add_u32 v10, v99, 2, v9
    ds_write_b32 v10, v67
    v_lshl_add_u32 v9, v9, 2, v99
    ds_write_b8_d16_hi v9, v105 offset:16
    s_add_u32 s47, s96, 0x9000000
    s_lshr_b32 s47, s47, 1
    buffer_load_dwordx2 v[72:73], v1, s[16:19], s47 offen nt
    s_cmp_le_u32 s43, 5
    s_cselect_b32 s18, 0, s18
    s_add_u32 s44, s38, 0x0
    s_lshr_b32 s44, s44, 1
    buffer_load_dwordx2 v[74:75], v1, s[16:19], s44 offen nt
    s_cmp_le_u32 s43, 5
    s_cselect_b32 s10, 0, s10
    s_add_u32 s45, s38, 0x0
    v_lshlrev_b32 v36, 1, v1
    buffer_load_dwordx4 v[36:39], v36, s[8:11], s45 offen nt
    v_and_b32 v7, -4, v100
    v_lshl_add_u32 v8, v100, 2, v7
    ds_write_b32 v8, v60
    v_lshl_add_u32 v7, v7, 2, v100
    ds_write_b8 v7, v106 offset:16
    v_and_b32 v9, -4, v101
    v_lshl_add_u32 v10, v101, 2, v9
    ds_write_b32 v10, v61
    v_lshl_add_u32 v9, v9, 2, v101
    ds_write_b8_d16_hi v9, v106 offset:16
    v_and_b32 v7, -4, v102
    v_lshl_add_u32 v8, v102, 2, v7
    ds_write_b32 v8, v62
    v_lshl_add_u32 v7, v7, 2, v102
    ds_write_b8 v7, v107 offset:16
    v_and_b32 v9, -4, v103
    v_lshl_add_u32 v10, v103, 2, v9
    ds_write_b32 v10, v63
    v_lshl_add_u32 v9, v9, 2, v103
    ds_write_b8_d16_hi v9, v107 offset:16
    s_add_u32 s46, s35, 0x5488000
    s_add_u32 s46, s46, s93
    buffer_store_dwordx4 v[28:31], v0, s[20:23], s46 offen sc1
    s_cmp_le_u32 s43, 5
    s_cselect_b32 s14, 0, s14
    s_add_u32 s47, s38, 0x0
    v_lshlrev_b32 v76, 1, v1
    buffer_load_dwordx4 v[76:79], v76, s[12:15], s47 offen nt
    s_waitcnt vmcnt(7)
    v_lshlrev_b32 v7, 16, v34
    v_and_b32 v8, 0xffff0000, v34
    v_lshlrev_b32 v9, 16, v35
    v_and_b32 v10, 0xffff0000, v35
    v_mul_f32 v7, 0.15915494, v7
    v_mul_f32 v8, 0.15915494, v8
    v_mul_f32 v9, 0.15915494, v9
    v_mul_f32 v10, 0.15915494, v10
    v_mul_hi_u32_u24 v14, 429497, v48
    v_lshrrev_b32 v12, 3, v52
    v_cos_f32 v7, v7
    v_lshlrev_b16 v13, 3, v52
    v_mad_i32_i24 v11, v14, s55, v48
    v_bitop3_b32 v12, v6, v13, v12 bitop3:0xca
    v_lshl_add_u32 v11, v11, 17, s40
    v_lshlrev_b16 v14, 8, v14
    v_lshrrev_b32 v13, 2, v52
    v_add_u32 v48, v12, v11
    v_bitop3_b32 v52, v5, v13, v14 bitop3:0xea
    v_mul_hi_u32_u24 v14, 429497, v49
    v_lshrrev_b32 v12, 3, v53
    v_cos_f32 v8, v8
    v_lshlrev_b16 v13, 3, v53
    v_mad_i32_i24 v11, v14, s55, v49
    v_bitop3_b32 v12, v6, v13, v12 bitop3:0xca
    v_lshl_add_u32 v11, v11, 17, s40
    v_lshlrev_b16 v14, 8, v14
    v_lshrrev_b32 v13, 2, v53
    v_add_u32 v49, v12, v11
    v_bitop3_b32 v53, v5, v13, v14 bitop3:0xea
    v_cvt_pk_bf16_f32 v34, v7, v8
    v_perm_b32 v12, v34, v34, s41
    v_bitop3_b32 v48, v4, v12, v48 bitop3:0xca
    v_perm_b32 v13, v34, v34, s42
    v_bitop3_b32 v49, v4, v13, v49 bitop3:0xca
    v_mul_hi_u32_u24 v14, 429497, v50
    v_lshrrev_b32 v12, 3, v54
    v_cos_f32 v9, v9
    v_lshlrev_b16 v13, 3, v54
    v_mad_i32_i24 v11, v14, s55, v50
    v_bitop3_b32 v12, v6, v13, v12 bitop3:0xca
    v_lshl_add_u32 v11, v11, 17, s40
    v_lshlrev_b16 v14, 8, v14
    v_lshrrev_b32 v13, 2, v54
    v_add_u32 v50, v12, v11
    v_bitop3_b32 v54, v5, v13, v14 bitop3:0xea
    v_mul_hi_u32_u24 v14, 429497, v51
    v_lshrrev_b32 v12, 3, v55
    v_cos_f32 v10, v10
    v_lshlrev_b16 v13, 3, v55
    v_mad_i32_i24 v11, v14, s55, v51
    v_bitop3_b32 v12, v6, v13, v12 bitop3:0xca
    v_lshl_add_u32 v11, v11, 17, s40
    v_lshlrev_b16 v14, 8, v14
    v_lshrrev_b32 v13, 2, v55
    v_add_u32 v51, v12, v11
    v_bitop3_b32 v55, v5, v13, v14 bitop3:0xea
    v_cvt_pk_bf16_f32 v35, v9, v10
    v_perm_b32 v12, v35, v35, s41
    v_bitop3_b32 v50, v4, v12, v50 bitop3:0xca
    v_perm_b32 v13, v35, v35, s42
    v_bitop3_b32 v51, v4, v13, v51 bitop3:0xca
    s_setprio 0
    v_and_b32 v7, -4, v88
    v_lshl_add_u32 v8, v88, 2, v7
    ds_write_b32 v8, v112
    v_lshl_add_u32 v7, v7, 2, v88
    ds_write_b8 v7, v108 offset:16
    v_and_b32 v9, -4, v89
    v_lshl_add_u32 v10, v89, 2, v9
    ds_write_b32 v10, v113
    v_lshl_add_u32 v9, v9, 2, v89
    ds_write_b8_d16_hi v9, v108 offset:16
    v_and_b32 v7, -4, v90
    v_lshl_add_u32 v8, v90, 2, v7
    ds_write_b32 v8, v114
    v_lshl_add_u32 v7, v7, 2, v90
    ds_write_b8 v7, v109 offset:16
    v_and_b32 v9, -4, v91
    v_lshl_add_u32 v10, v91, 2, v9
    ds_write_b32 v10, v115
    v_lshl_add_u32 v9, v9, 2, v91
    ds_write_b8_d16_hi v9, v109 offset:16
    s_cmp_le_u32 s43, 6
    s_cselect_b32 s10, 0, s10
    s_add_u32 s44, s39, 0x0
    v_lshlrev_b32 v80, 1, v1
    buffer_load_dwordx4 v[80:83], v80, s[8:11], s44 offen nt
    s_cmp_le_u32 s43, 6
    s_cselect_b32 s14, 0, s14
    s_add_u32 s45, s39, 0x0
    v_lshlrev_b32 v56, 1, v1
    buffer_load_dwordx4 v[56:59], v56, s[12:15], s45 offen nt
    s_waitcnt vmcnt(5)
    v_lshlrev_b32 v7, 16, v72
    v_and_b32 v8, 0xffff0000, v72
    v_lshlrev_b32 v9, 16, v73
    v_and_b32 v10, 0xffff0000, v73
    v_mul_f32 v7, 0.15915494, v7
    v_mul_f32 v8, 0.15915494, v8
    v_mul_f32 v9, 0.15915494, v9
    v_mul_f32 v10, 0.15915494, v10
    v_mul_hi_u32_u24 v14, 429497, v84
    v_lshrrev_b32 v12, 3, v68
    v_cos_f32 v7, v7
    v_lshlrev_b16 v13, 3, v68
    v_mad_i32_i24 v11, v14, s55, v84
    v_bitop3_b32 v12, v6, v13, v12 bitop3:0xca
    v_lshl_add_u32 v11, v11, 17, s40
    v_lshlrev_b16 v14, 8, v14
    v_lshrrev_b32 v13, 2, v68
    v_add_u32 v84, v12, v11
    v_bitop3_b32 v68, v5, v13, v14 bitop3:0xea
    v_mul_hi_u32_u24 v14, 429497, v85
    v_lshrrev_b32 v12, 3, v69
    v_cos_f32 v8, v8
    v_lshlrev_b16 v13, 3, v69
    v_mad_i32_i24 v11, v14, s55, v85
    v_bitop3_b32 v12, v6, v13, v12 bitop3:0xca
    v_lshl_add_u32 v11, v11, 17, s40
    v_lshlrev_b16 v14, 8, v14
    v_lshrrev_b32 v13, 2, v69
    v_add_u32 v85, v12, v11
    v_bitop3_b32 v69, v5, v13, v14 bitop3:0xea
    v_cvt_pk_bf16_f32 v72, v7, v8
    v_perm_b32 v12, v72, v72, s41
    v_bitop3_b32 v84, v4, v12, v84 bitop3:0xca
    v_perm_b32 v13, v72, v72, s42
    v_bitop3_b32 v85, v4, v13, v85 bitop3:0xca
    v_mul_hi_u32_u24 v14, 429497, v86
    v_lshrrev_b32 v12, 3, v70
    v_cos_f32 v9, v9
    v_lshlrev_b16 v13, 3, v70
    v_mad_i32_i24 v11, v14, s55, v86
    v_bitop3_b32 v12, v6, v13, v12 bitop3:0xca
    v_lshl_add_u32 v11, v11, 17, s40
    v_lshlrev_b16 v14, 8, v14
    v_lshrrev_b32 v13, 2, v70
    v_add_u32 v86, v12, v11
    v_bitop3_b32 v70, v5, v13, v14 bitop3:0xea
    v_mul_hi_u32_u24 v14, 429497, v87
    v_lshrrev_b32 v12, 3, v71
    v_cos_f32 v10, v10
    v_lshlrev_b16 v13, 3, v71
    v_mad_i32_i24 v11, v14, s55, v87
    v_bitop3_b32 v12, v6, v13, v12 bitop3:0xca
    v_lshl_add_u32 v11, v11, 17, s40
    v_lshlrev_b16 v14, 8, v14
    v_lshrrev_b32 v13, 2, v71
    v_add_u32 v87, v12, v11
    v_bitop3_b32 v71, v5, v13, v14 bitop3:0xea
    v_cvt_pk_bf16_f32 v73, v9, v10
    v_perm_b32 v12, v73, v73, s41
    v_bitop3_b32 v86, v4, v12, v86 bitop3:0xca
    v_perm_b32 v13, v73, v73, s42
    v_bitop3_b32 v87, v4, v13, v87 bitop3:0xca
    v_and_b32 v7, -4, v92
    v_lshl_add_u32 v8, v92, 2, v7
    ds_write_b32 v8, v116
    v_lshl_add_u32 v7, v7, 2, v92
    ds_write_b8 v7, v110 offset:16
    v_and_b32 v9, -4, v93
    v_lshl_add_u32 v10, v93, 2, v9
    ds_write_b32 v10, v117
    v_lshl_add_u32 v9, v9, 2, v93
    ds_write_b8_d16_hi v9, v110 offset:16
    v_and_b32 v7, -4, v94
    v_lshl_add_u32 v8, v94, 2, v7
    ds_write_b32 v8, v118
    v_lshl_add_u32 v7, v7, 2, v94
    ds_write_b8 v7, v111 offset:16
    v_and_b32 v9, -4, v95
    v_lshl_add_u32 v10, v95, 2, v9
    ds_write_b32 v10, v119
    v_lshl_add_u32 v9, v9, 2, v95
    ds_write_b8_d16_hi v9, v111 offset:16
    s_cmp_le_u32 s43, 6
    s_cselect_b32 s18, 0, s18
    s_add_u32 s46, s39, 0x0
    s_lshr_b32 s46, s46, 1
    buffer_load_dwordx2 v[64:65], v1, s[16:19], s46 offen nt
    s_cmp_le_u32 s43, 7
    s_cselect_b32 s18, 0, s18
    s_add_u32 s47, s58, 0x0
    s_lshr_b32 s47, s47, 1
    buffer_load_dwordx2 v[66:67], v1, s[16:19], s47 offen nt
    s_waitcnt vmcnt(4)
    s_cmp_le_u32 s43, 5
    s_cbranch_scc1 L1_s5
    v_lshlrev_b32 v7, 16, v74
    v_and_b32 v8, 0xffff0000, v74
    v_lshlrev_b32 v9, 16, v75
    v_and_b32 v10, 0xffff0000, v75
    v_mul_f32 v7, 0.15915494, v7
    v_mul_f32 v8, 0.15915494, v8
    v_mul_f32 v9, 0.15915494, v9
    v_mul_f32 v10, 0.15915494, v10
    v_mul_hi_u32_u24 v14, 429497, v36
    v_lshrrev_b32 v12, 3, v76
    v_cos_f32 v7, v7
    v_lshlrev_b16 v13, 3, v76
    v_mad_i32_i24 v11, v14, s55, v36
    v_bitop3_b32 v12, v6, v13, v12 bitop3:0xca
    v_lshl_add_u32 v11, v11, 17, s40
    v_lshlrev_b16 v14, 8, v14
    v_lshrrev_b32 v13, 2, v76
    v_add_u32 v36, v12, v11
    v_bitop3_b32 v76, v5, v13, v14 bitop3:0xea
    v_mul_hi_u32_u24 v14, 429497, v37
    v_lshrrev_b32 v12, 3, v77
    v_cos_f32 v8, v8
    v_lshlrev_b16 v13, 3, v77
    v_mad_i32_i24 v11, v14, s55, v37
    v_bitop3_b32 v12, v6, v13, v12 bitop3:0xca
    v_lshl_add_u32 v11, v11, 17, s40
    v_lshlrev_b16 v14, 8, v14
    v_lshrrev_b32 v13, 2, v77
    v_add_u32 v37, v12, v11
    v_bitop3_b32 v77, v5, v13, v14 bitop3:0xea
    v_cvt_pk_bf16_f32 v74, v7, v8
    v_perm_b32 v12, v74, v74, s41
    v_bitop3_b32 v36, v4, v12, v36 bitop3:0xca
    v_perm_b32 v13, v74, v74, s42
    v_bitop3_b32 v37, v4, v13, v37 bitop3:0xca
    v_mul_hi_u32_u24 v14, 429497, v38
    v_lshrrev_b32 v12, 3, v78
    v_cos_f32 v9, v9
    v_lshlrev_b16 v13, 3, v78
    v_mad_i32_i24 v11, v14, s55, v38
    v_bitop3_b32 v12, v6, v13, v12 bitop3:0xca
    v_lshl_add_u32 v11, v11, 17, s40
    v_lshlrev_b16 v14, 8, v14
    v_lshrrev_b32 v13, 2, v78
    v_add_u32 v38, v12, v11
    v_bitop3_b32 v78, v5, v13, v14 bitop3:0xea
    v_mul_hi_u32_u24 v14, 429497, v39
    v_lshrrev_b32 v12, 3, v79
    v_cos_f32 v10, v10
    v_lshlrev_b16 v13, 3, v79
    v_mad_i32_i24 v11, v14, s55, v39
    v_bitop3_b32 v12, v6, v13, v12 bitop3:0xca
    v_lshl_add_u32 v11, v11, 17, s40
    v_lshlrev_b16 v14, 8, v14
    v_lshrrev_b32 v13, 2, v79
    v_add_u32 v39, v12, v11
    v_bitop3_b32 v79, v5, v13, v14 bitop3:0xea
    v_cvt_pk_bf16_f32 v75, v9, v10
    v_perm_b32 v12, v75, v75, s41
    v_bitop3_b32 v38, v4, v12, v38 bitop3:0xca
    v_perm_b32 v13, v75, v75, s42
    v_bitop3_b32 v39, v4, v13, v39 bitop3:0xca
L1_s5:
    v_add_u32 v7, s72, v0
    v_add_u32 v12, s73, v0
    v_add_u32 v13, s85, v0
    v_add_u32 v14, s91, v0
    v_add_u32 v15, s93, v0
    s_min_i32 s3, s72, s73
    s_min_i32 s3, s3, s85
    s_min_i32 s3, s3, s91
    s_min_i32 s3, s3, s93
    v_add_u32 v3, s3, v0
    v_mov_b32 v8, 0
    v_mov_b32 v9, 0
    v_mov_b32 v10, 0
    v_mov_b32 v11, 0
    s_waitcnt lgkmcnt(0)
    s_barrier
    ds_read_b128 v[96:99], v7 offset:0
    ds_read_b128 v[60:63], v12 offset:0
    ds_read_b128 v[100:103], v13 offset:0
    ds_read_b128 v[104:107], v14 offset:0
    ds_read_b128 v[28:31], v15 offset:0
    ds_write_b128 v3, v[8:11]
    ds_read_b128 v[112:115], v7 offset:16384
    ds_read_b128 v[88:91], v12 offset:16384
    ds_read_b128 v[116:119], v13 offset:16384
    ds_read_b128 v[92:95], v14 offset:16384
    ds_read_b128 v[108:111], v15 offset:16384
    s_waitcnt lgkmcnt(0)
    s_barrier
    v_lshlrev_b32 v3, 3, v0
    v_and_b32 v3, 0x80, v3
    s_cmp_lg_u32 s32, 15
    s_cbranch_scc1 L2_k0
    s_mov_b64 exec, 3
    buffer_load_dword v3, v3, s[68:71], 0 offen sc1
    s_mov_b64 exec, -1
L2_k0:
    s_add_u32 s44, s35, 0x7ec4000
    s_add_u32 s44, s44, s72
    buffer_store_dwordx4 v[96:99], v0, s[20:23], s44 offen sc1
    s_cmp_le_u32 s43, 7
    s_cselect_b32 s10, 0, s10
    s_add_u32 s45, s58, 0x0
    v_lshlrev_b32 v96, 1, v1
    buffer_load_dwordx4 v[96:99], v96, s[8:11], s45 offen nt
    s_add_u32 s46, s35, 0x7ec4000
    s_add_u32 s46, s46, s73
    buffer_store_dwordx4 v[60:63], v0, s[20:23], s46 offen sc1
    s_cmp_le_u32 s43, 7
    s_cselect_b32 s14, 0, s14
    s_add_u32 s47, s58, 0x0
    v_lshlrev_b32 v60, 1, v1
    buffer_load_dwordx4 v[60:63], v60, s[12:15], s47 offen nt
    s_setprio 3
    ds_add_u32 v120, v2
    ds_add_u32 v121, v2
    ds_add_u32 v122, v2
    ds_add_u32 v123, v2
    ds_add_u32 v124, v2
    ds_add_u32 v125, v2
    ds_add_u32 v126, v2
    ds_add_u32 v127, v2
    s_setprio 2
    s_add_u32 s44, s35, 0x7ec4000
    s_add_u32 s44, s44, s85
    buffer_store_dwordx4 v[100:103], v0, s[20:23], s44 offen sc1
    ds_add_u32 v24, v2
    ds_add_u32 v25, v2
    ds_add_u32 v26, v2
    ds_add_u32 v27, v2
    ds_add_u32 v52, v2
    ds_add_u32 v53, v2
    ds_add_u32 v54, v2
    ds_add_u32 v55, v2
    s_setprio 1
    ds_add_u32 v68, v2
    ds_add_u32 v69, v2
    ds_add_u32 v70, v2
    ds_add_u32 v71, v2
    s_add_u32 s45, s35, 0x7ec4000
    s_add_u32 s45, s45, s91
    buffer_store_dwordx4 v[104:107], v0, s[20:23], s45 offen sc1
    s_cmp_le_u32 s43, 5
    s_cbranch_scc1 L1_s6
    ds_add_u32 v76, v2
    ds_add_u32 v77, v2
    ds_add_u32 v78, v2
    ds_add_u32 v79, v2
L1_s6:
    s_setprio 0
    s_waitcnt vmcnt(6)
    s_cmp_le_u32 s43, 6
    s_cbranch_scc1 L1_s7
    v_lshlrev_b32 v7, 16, v64
    v_and_b32 v8, 0xffff0000, v64
    v_lshlrev_b32 v9, 16, v65
    v_and_b32 v10, 0xffff0000, v65
    v_mul_f32 v7, 0.15915494, v7
    v_mul_f32 v8, 0.15915494, v8
    v_mul_f32 v9, 0.15915494, v9
    v_mul_f32 v10, 0.15915494, v10
    v_mul_hi_u32_u24 v14, 429497, v80
    v_lshrrev_b32 v12, 3, v56
    v_cos_f32 v7, v7
    v_lshlrev_b16 v13, 3, v56
    v_mad_i32_i24 v11, v14, s55, v80
    v_bitop3_b32 v12, v6, v13, v12 bitop3:0xca
    v_lshl_add_u32 v11, v11, 17, s40
    v_lshlrev_b16 v14, 8, v14
    v_lshrrev_b32 v13, 2, v56
    v_add_u32 v80, v12, v11
    v_bitop3_b32 v56, v5, v13, v14 bitop3:0xea
    ds_add_u32 v56, v2
    v_mul_hi_u32_u24 v14, 429497, v81
    v_lshrrev_b32 v12, 3, v57
    v_cos_f32 v8, v8
    v_lshlrev_b16 v13, 3, v57
    v_mad_i32_i24 v11, v14, s55, v81
    v_bitop3_b32 v12, v6, v13, v12 bitop3:0xca
    v_lshl_add_u32 v11, v11, 17, s40
    v_lshlrev_b16 v14, 8, v14
    v_lshrrev_b32 v13, 2, v57
    v_add_u32 v81, v12, v11
    v_bitop3_b32 v57, v5, v13, v14 bitop3:0xea
    ds_add_u32 v57, v2
    v_cvt_pk_bf16_f32 v64, v7, v8
    v_perm_b32 v12, v64, v64, s41
    v_bitop3_b32 v80, v4, v12, v80 bitop3:0xca
    v_perm_b32 v13, v64, v64, s42
    v_bitop3_b32 v81, v4, v13, v81 bitop3:0xca
    v_mul_hi_u32_u24 v14, 429497, v82
    v_lshrrev_b32 v12, 3, v58
    v_cos_f32 v9, v9
    v_lshlrev_b16 v13, 3, v58
    v_mad_i32_i24 v11, v14, s55, v82
    v_bitop3_b32 v12, v6, v13, v12 bitop3:0xca
    v_lshl_add_u32 v11, v11, 17, s40
    v_lshlrev_b16 v14, 8, v14
    v_lshrrev_b32 v13, 2, v58
    v_add_u32 v82, v12, v11
    v_bitop3_b32 v58, v5, v13, v14 bitop3:0xea
    ds_add_u32 v58, v2
    v_mul_hi_u32_u24 v14, 429497, v83
    v_lshrrev_b32 v12, 3, v59
    v_cos_f32 v10, v10
    v_lshlrev_b16 v13, 3, v59
    v_mad_i32_i24 v11, v14, s55, v83
    v_bitop3_b32 v12, v6, v13, v12 bitop3:0xca
    v_lshl_add_u32 v11, v11, 17, s40
    v_lshlrev_b16 v14, 8, v14
    v_lshrrev_b32 v13, 2, v59
    v_add_u32 v83, v12, v11
    v_bitop3_b32 v59, v5, v13, v14 bitop3:0xea
    ds_add_u32 v59, v2
    v_cvt_pk_bf16_f32 v65, v9, v10
    v_perm_b32 v12, v65, v65, s41
    v_bitop3_b32 v82, v4, v12, v82 bitop3:0xca
    v_perm_b32 v13, v65, v65, s42
    v_bitop3_b32 v83, v4, v13, v83 bitop3:0xca
L1_s7:
    s_waitcnt vmcnt(2)
    s_cmp_le_u32 s43, 7
    s_cbranch_scc1 L1_s8
    v_lshlrev_b32 v7, 16, v66
    v_and_b32 v8, 0xffff0000, v66
    v_lshlrev_b32 v9, 16, v67
    v_and_b32 v10, 0xffff0000, v67
    v_mul_f32 v7, 0.15915494, v7
    v_mul_f32 v8, 0.15915494, v8
    v_mul_f32 v9, 0.15915494, v9
    v_mul_f32 v10, 0.15915494, v10
    v_mul_hi_u32_u24 v14, 429497, v96
    v_lshrrev_b32 v12, 3, v60
    v_cos_f32 v7, v7
    v_lshlrev_b16 v13, 3, v60
    v_mad_i32_i24 v11, v14, s55, v96
    v_bitop3_b32 v12, v6, v13, v12 bitop3:0xca
    v_lshl_add_u32 v11, v11, 17, s40
    v_lshlrev_b16 v14, 8, v14
    v_lshrrev_b32 v13, 2, v60
    v_add_u32 v96, v12, v11
    v_bitop3_b32 v60, v5, v13, v14 bitop3:0xea
    ds_add_u32 v60, v2
    v_mul_hi_u32_u24 v14, 429497, v97
    v_lshrrev_b32 v12, 3, v61
    v_cos_f32 v8, v8
    v_lshlrev_b16 v13, 3, v61
    v_mad_i32_i24 v11, v14, s55, v97
    v_bitop3_b32 v12, v6, v13, v12 bitop3:0xca
    v_lshl_add_u32 v11, v11, 17, s40
    v_lshlrev_b16 v14, 8, v14
    v_lshrrev_b32 v13, 2, v61
    v_add_u32 v97, v12, v11
    v_bitop3_b32 v61, v5, v13, v14 bitop3:0xea
    ds_add_u32 v61, v2
    v_cvt_pk_bf16_f32 v66, v7, v8
    v_perm_b32 v12, v66, v66, s41
    v_bitop3_b32 v96, v4, v12, v96 bitop3:0xca
    v_perm_b32 v13, v66, v66, s42
    v_bitop3_b32 v97, v4, v13, v97 bitop3:0xca
    v_mul_hi_u32_u24 v14, 429497, v98
    v_lshrrev_b32 v12, 3, v62
    v_cos_f32 v9, v9
    v_lshlrev_b16 v13, 3, v62
    v_mad_i32_i24 v11, v14, s55, v98
    v_bitop3_b32 v12, v6, v13, v12 bitop3:0xca
    v_lshl_add_u32 v11, v11, 17, s40
    v_lshlrev_b16 v14, 8, v14
    v_lshrrev_b32 v13, 2, v62
    v_add_u32 v98, v12, v11
    v_bitop3_b32 v62, v5, v13, v14 bitop3:0xea
    ds_add_u32 v62, v2
    v_mul_hi_u32_u24 v14, 429497, v99
    v_lshrrev_b32 v12, 3, v63
    v_cos_f32 v10, v10
    v_lshlrev_b16 v13, 3, v63
    v_mad_i32_i24 v11, v14, s55, v99
    v_bitop3_b32 v12, v6, v13, v12 bitop3:0xca
    v_lshl_add_u32 v11, v11, 17, s40
    v_lshlrev_b16 v14, 8, v14
    v_lshrrev_b32 v13, 2, v63
    v_add_u32 v99, v12, v11
    v_bitop3_b32 v63, v5, v13, v14 bitop3:0xea
    ds_add_u32 v63, v2
    v_cvt_pk_bf16_f32 v67, v9, v10
    v_perm_b32 v12, v67, v67, s41
    v_bitop3_b32 v98, v4, v12, v98 bitop3:0xca
    v_perm_b32 v13, v67, v67, s42
    v_bitop3_b32 v99, v4, v13, v99 bitop3:0xca
L1_s8:
    v_lshrrev_b32 v8, 2, v0
    v_and_b32 v7, 0x3c00, v0
    v_bitop3_b32 v7, v5, v8, v7 bitop3:0xea
    s_waitcnt lgkmcnt(0)
    s_barrier
    ds_read2st64_b32 v[8:9], v7 offset0:0 offset1:1
    ds_read2st64_b32 v[10:11], v7 offset0:2 offset1:3
    s_waitcnt lgkmcnt(0)
    v_lshl_or_b32 v12, v9, 16, v8
    v_lshl_or_b32 v13, v11, 16, v10
    v_mov_b32 v14, v12
    v_mov_b32 v15, v13
    s_nop 0
    v_add_u32_dpp v14, v14, v14 row_shr:1 row_mask:0xf bank_mask:0xf bound_ctrl:1
    v_add_u32_dpp v15, v15, v15 row_shr:1 row_mask:0xf bank_mask:0xf bound_ctrl:1
    s_nop 0
    v_add_u32_dpp v14, v14, v14 row_shr:2 row_mask:0xf bank_mask:0xf bound_ctrl:1
    v_add_u32_dpp v15, v15, v15 row_shr:2 row_mask:0xf bank_mask:0xf bound_ctrl:1
    s_nop 0
    v_add_u32_dpp v14, v14, v14 row_shr:4 row_mask:0xf bank_mask:0xf bound_ctrl:1
    v_add_u32_dpp v15, v15, v15 row_shr:4 row_mask:0xf bank_mask:0xf bound_ctrl:1
    s_nop 0
    v_add_u32_dpp v14, v14, v14 row_shr:8 row_mask:0xf bank_mask:0xf bound_ctrl:1
    v_add_u32_dpp v15, v15, v15 row_shr:8 row_mask:0xf bank_mask:0xf bound_ctrl:1
    s_nop 0
    v_add_u32_dpp v14, v14, v14 row_bcast:15 row_mask:0xa bank_mask:0xf
    v_add_u32_dpp v15, v15, v15 row_bcast:15 row_mask:0xa bank_mask:0xf
    s_nop 0
    v_add_u32_dpp v14, v14, v14 row_bcast:31 row_mask:0xc bank_mask:0xf
    v_add_u32_dpp v15, v15, v15 row_bcast:31 row_mask:0xc bank_mask:0xf
    v_readlane_b32 s48, v14, 63
    v_readlane_b32 s49, v15, 63
    s_lshl_b32 s54, s32, 2
    v_mov_b32 v8, s54
    s_and_b32 s50, s48, 0xffff
    s_lshr_b32 s51, s48, 16
    s_and_b32 s52, s49, 0xffff
    s_lshr_b32 s53, s49, 16
    s_add_u32 s51, s51, s50
    s_add_u32 s52, s52, s51
    s_add_u32 s53, s53, s52
    v_mov_b32 v9, s53
    v_and_b32_dpp v3, v3, v3 quad_perm:[1,0,3,2] row_mask:0xf bank_mask:0xf
    s_mov_b64 exec, 1
    ds_write_b32 v8, v9 offset:16384
    ds_write_b32 v8, v3 offset:16448
    s_mov_b64 exec, -1
    v_and_b32 v8, 60, v7
    s_waitcnt lgkmcnt(0)
    s_barrier
    ds_read_b32 v9, v8 offset:16384
    ds_read_b32 v10, v8 offset:16448
    s_waitcnt lgkmcnt(0)
    v_readlane_b32 s56, v10, 15
    s_xor_b32 s56, s56, 0x80
    v_add_u32_dpp v9, v9, v9 row_shr:1 row_mask:0xf bank_mask:0xf bound_ctrl:1
    s_nop 1
    v_add_u32_dpp v9, v9, v9 row_shr:2 row_mask:0xf bank_mask:0xf bound_ctrl:1
    s_nop 1
    v_add_u32_dpp v9, v9, v9 row_shr:4 row_mask:0xf bank_mask:0xf bound_ctrl:1
    s_nop 1
    v_add_u32_dpp v9, v9, v9 row_shr:8 row_mask:0xf bank_mask:0xf bound_ctrl:1
    s_nop 0
    v_readlane_b32 s54, v9, s32
    s_sub_u32 s54, s54, s53
    s_add_u32 s50, s50, s54
    s_add_u32 s51, s51, s54
    s_add_u32 s52, s52, s54
    s_pack_ll_b32_b16 s48, s54, s50
    s_pack_ll_b32_b16 s49, s51, s52
    v_add_u32 v14, s48, v14
    v_add_u32 v15, s49, v15
    v_sub_u32 v12, v14, v12
    v_sub_u32 v13, v15, v13
    v_and_b32 v8, 0xffff, v12
    v_lshrrev_b32 v9, 16, v12
    v_and_b32 v10, 0xffff, v13
    v_lshrrev_b32 v11, 16, v13
    ds_write2st64_b32 v7, v8, v9 offset0:0 offset1:1
    ds_write2st64_b32 v7, v10, v11 offset0:2 offset1:3
    v_and_b32 v8, 0x3f0, v0
    v_lshl_add_u32 v8, v8, 1, s36
    ds_write_b64 v8, v[12:13] offset:20480
    s_bitset0_b64 exec, 63
    s_not_b64 exec, exec
    ds_write_b64 v8, v[14:15] offset:20512
    s_mov_b64 exec, -1
    s_waitcnt lgkmcnt(0)
    s_barrier
    s_setprio 3
    ds_add_rtn_u32 v120, v120, v2
    ds_add_rtn_u32 v121, v121, v2
    ds_add_rtn_u32 v122, v122, v2
    ds_add_rtn_u32 v123, v123, v2
    ds_read_b128 v[12:15], v0 offset:20480
    v_cmp_gt_u32 vcc, 8448, v0
    s_add_u32 s46, s35, 0x7ec4000
    s_add_u32 s46, s46, s93
    buffer_store_dwordx4 v[28:31], v0, s[20:23], s46 offen sc1
    ds_add_rtn_u32 v124, v124, v2
    ds_add_rtn_u32 v125, v125, v2
    ds_add_rtn_u32 v126, v126, v2
    ds_add_rtn_u32 v127, v127, v2
    s_setprio 2
    ds_add_rtn_u32 v24, v24, v2
    ds_add_rtn_u32 v25, v25, v2
    ds_add_rtn_u32 v26, v26, v2
    ds_add_rtn_u32 v27, v27, v2
    s_waitcnt lgkmcnt(8)
    s_cbranch_vccz L1_p9
    s_add_u32 s47, s35, 0xa900000
    s_mov_b64 exec, vcc
    buffer_store_dwordx4 v[12:15], v0, s[24:27], s47 offen sc1
    s_mov_b64 exec, -1
L1_p9:
    s_add_u32 s44, s35, 0x7ec8000
    s_add_u32 s44, s44, s72
    buffer_store_dwordx4 v[112:115], v0, s[20:23], s44 offen sc1
    ds_add_rtn_u32 v52, v52, v2
    ds_add_rtn_u32 v53, v53, v2
    ds_add_rtn_u32 v54, v54, v2
    ds_add_rtn_u32 v55, v55, v2
    s_load_dwordx2 s[28:29], s[0:1], 0
    s_load_dwordx2 s[50:51], s[0:1], 40
    s_load_dwordx2 s[52:53], s[0:1], 24
    s_setprio 1
    ds_add_rtn_u32 v68, v68, v2
    ds_add_rtn_u32 v69, v69, v2
    ds_add_rtn_u32 v70, v70, v2
    ds_add_rtn_u32 v71, v71, v2
    s_cmp_le_u32 s43, 5
    s_cbranch_scc1 L1_s10
    ds_add_rtn_u32 v76, v76, v2
    ds_add_rtn_u32 v77, v77, v2
    ds_add_rtn_u32 v78, v78, v2
    ds_add_rtn_u32 v79, v79, v2
L1_s10:
    s_add_u32 s45, s35, 0x7ec8000
    s_add_u32 s45, s45, s73
    buffer_store_dwordx4 v[88:91], v0, s[20:23], s45 offen sc1
    s_setprio 0
    s_cmp_le_u32 s43, 6
    s_cbranch_scc1 L1_s11
    ds_add_rtn_u32 v56, v56, v2
    ds_add_rtn_u32 v57, v57, v2
    ds_add_rtn_u32 v58, v58, v2
    ds_add_rtn_u32 v59, v59, v2
L1_s11:
    s_cmp_le_u32 s43, 7
    s_cbranch_scc1 L1_s12
    ds_add_rtn_u32 v60, v60, v2
    ds_add_rtn_u32 v61, v61, v2
    ds_add_rtn_u32 v62, v62, v2
    ds_add_rtn_u32 v63, v63, v2
L1_s12:
    s_waitcnt lgkmcnt(0)
    s_barrier
    s_load_dwordx4 s[96:99], s[50:51], 0
    s_mov_b64 s[4:5], s[52:53]
    s_bfe_u32 s33, s2, 0x20001
    s_and_b32 s34, s2, 1
    s_lshl_b32 s34, s34, 5
    s_lshr_b32 s3, s2, 3
    s_add_u32 s34, s34, s3
    s_mul_i32 s39, s33, 2080
    s_lshl_b32 s3, s34, 5
    s_add_u32 s39, s39, s3
    s_mul_i32 s40, s33, 1310720
    s_add_u32 s40, s40, 0x50000
    s_lshl_b32 s38, s32, 11
    s_mul_i32 s100, s32, 3072
    s_add_u32 s8, s30, 0x4000
    s_addc_u32 s9, s31, 0
    s_mov_b32 s10, 0xd340000
    s_mov_b32 s11, 0x20000
    s_add_u32 s12, s30, 0x2c000
    s_addc_u32 s13, s31, 0
    s_mov_b32 s14, 0xd318000
    s_mov_b32 s15, 0x20000
    s_mov_b32 s16, s64
    s_mov_b32 s17, s65
    s_mov_b32 s18, 0x20
    s_mov_b32 s19, 0x20000
    s_mov_b32 s24, s28
    s_mov_b32 s25, s29
    s_mov_b32 s26, 0x4e2000
    s_mov_b32 s27, 0x20000
    s_setprio 3
    v_and_b32 v7, -4, v120
    v_lshl_add_u32 v8, v120, 2, v7
    ds_write_b32 v8, v16
    v_lshl_add_u32 v7, v7, 2, v120
    ds_write_b8 v7, v44 offset:16
    v_and_b32 v9, -4, v121
    v_lshl_add_u32 v10, v121, 2, v9
    ds_write_b32 v10, v17
    v_lshl_add_u32 v9, v9, 2, v121
    ds_write_b8_d16_hi v9, v44 offset:16
    v_and_b32 v7, -4, v122
    v_lshl_add_u32 v8, v122, 2, v7
    ds_write_b32 v8, v18
    v_lshl_add_u32 v7, v7, 2, v122
    ds_write_b8 v7, v45 offset:16
    v_and_b32 v9, -4, v123
    v_lshl_add_u32 v10, v123, 2, v9
    ds_write_b32 v10, v19
    v_lshl_add_u32 v9, v9, 2, v123
    ds_write_b8_d16_hi v9, v45 offset:16
    s_add_u32 s46, s35, 0x7ec8000
    s_add_u32 s46, s46, s85
    buffer_store_dwordx4 v[116:119], v0, s[20:23], s46 offen sc1
    v_and_b32 v13, 0x3f0, v0
    v_and_b32 v14, 0x300, v13
    v_bfe_u32 v15, v13, 4, 4
    s_lshl_b32 s3, s32, 4
    v_add3_u32 v14, v14, v15, s3
    v_mul_u32_u24 v2, 173056, v14
    v_lshrrev_b32 v14, 6, v13
    s_add_u32 s3, s3, 0x400
    v_add_u32 v14, s3, v14
    v_mul_u32_u24 v4, 173056, v14
    v_and_b32 v14, 3, v14
    v_and_b32 v15, 0x30, v13
    v_lshl_add_u32 v14, v14, 5, v15
    v_add_u32 v6, v14, v4
    v_lshl_add_u32 v5, v15, 1, v2
    v_lshrrev_b32 v14, 3, v15
    buffer_load_ushort v100, v14, s[16:19], 0 offen offset:0
    buffer_load_ushort v101, v14, s[16:19], 0 offen offset:8
    buffer_load_ushort v102, v14, s[16:19], 0 offen offset:16
    buffer_load_ushort v103, v14, s[16:19], 0 offen offset:24
    s_mul_i32 s3, s32, 5120
    v_add_u32 v3, s3, v13
    v_lshrrev_b32 v14, 2, v13
    v_add_u32 v14, s38, v14
    v_and_b32 v7, -4, v124
    v_lshl_add_u32 v8, v124, 2, v7
    ds_write_b32 v8, v20
    v_lshl_add_u32 v7, v7, 2, v124
    ds_write_b8 v7, v46 offset:16
    v_and_b32 v9, -4, v125
    v_lshl_add_u32 v10, v125, 2, v9
    ds_write_b32 v10, v21
    v_lshl_add_u32 v9, v9, 2, v125
    ds_write_b8_d16_hi v9, v46 offset:16
    v_and_b32 v7, -4, v126
    v_lshl_add_u32 v8, v126, 2, v7
    ds_write_b32 v8, v22
    v_lshl_add_u32 v7, v7, 2, v126
    ds_write_b8 v7, v47 offset:16
    v_and_b32 v9, -4, v127
    v_lshl_add_u32 v10, v127, 2, v9
    ds_write_b32 v10, v23
    v_lshl_add_u32 v9, v9, 2, v127
    ds_write_b8_d16_hi v9, v47 offset:16
    s_setprio 2
    v_and_b32 v7, -4, v24
    v_lshl_add_u32 v8, v24, 2, v7
    ds_write_b32 v8, v40
    v_lshl_add_u32 v7, v7, 2, v24
    ds_write_b8 v7, v32 offset:16
    v_and_b32 v9, -4, v25
    v_lshl_add_u32 v10, v25, 2, v9
    ds_write_b32 v10, v41
    v_lshl_add_u32 v9, v9, 2, v25
    ds_write_b8_d16_hi v9, v32 offset:16
    v_and_b32 v7, -4, v26
    v_lshl_add_u32 v8, v26, 2, v7
    ds_write_b32 v8, v42
    v_lshl_add_u32 v7, v7, 2, v26
    ds_write_b8 v7, v33 offset:16
    v_and_b32 v9, -4, v27
    v_lshl_add_u32 v10, v27, 2, v9
    ds_write_b32 v10, v43
    v_lshl_add_u32 v9, v9, 2, v27
    ds_write_b8_d16_hi v9, v33 offset:16
    s_add_u32 s47, s35, 0x7ec8000
    s_add_u32 s47, s47, s91
    buffer_store_dwordx4 v[92:95], v0, s[20:23], s47 offen sc1
    v_lshrrev_b32 v11, 2, v0
    v_and_b32 v11, 0xfc, v11
    s_cmp_ge_u32 s84, 128
    s_cselect_b32 s82, 0, s82
    s_mul_i32 s3, s84, 40
    s_add_u32 s3, s3, s32
    s_mul_i32 s76, s3, 52429
    s_lshr_b32 s76, s76, 22
    s_mul_i32 s74, s76, 80
    s_sub_u32 s3, s3, s74
    s_mul_i32 s74, s3, 205
    s_lshr_b32 s74, s74, 10
    s_mul_i32 s75, s74, 5
    s_sub_u32 s75, s3, s75
    s_lshl_b32 s48, s74, 1
    s_add_u32 s48, s48, s75
    s_add_u32 s49, s48, s74
    s_add_u32 s49, s49, 30
    s_cmp_lt_u32 s75, 2
    s_cselect_b32 s48, s48, s49
    s_lshl_b32 s48, s48, 10
    s_mul_i32 s49, s76, 80000
    s_add_u32 s48, s48, s49
    buffer_load_dword v104, v11, s[80:83], s48 offen offset:0
    buffer_load_dword v105, v11, s[80:83], s48 offen offset:256
    buffer_load_dword v106, v11, s[80:83], s48 offen offset:512
    buffer_load_dword v107, v11, s[80:83], s48 offen offset:768
    s_mul_i32 s3, s84, 40
    s_add_u32 s3, s3, s32
    s_add_u32 s3, s3, 16
    s_mul_i32 s76, s3, 52429
    s_lshr_b32 s76, s76, 22
    s_mul_i32 s74, s76, 80
    s_sub_u32 s3, s3, s74
    s_mul_i32 s74, s3, 205
    s_lshr_b32 s74, s74, 10
    s_mul_i32 s75, s74, 5
    s_sub_u32 s75, s3, s75
    s_lshl_b32 s48, s74, 1
    s_add_u32 s48, s48, s75
    s_add_u32 s49, s48, s74
    s_add_u32 s49, s49, 30
    s_cmp_lt_u32 s75, 2
    s_cselect_b32 s48, s48, s49
    s_lshl_b32 s48, s48, 10
    s_mul_i32 s49, s76, 80000
    s_add_u32 s48, s48, s49
    buffer_load_dword v28, v11, s[80:83], s48 offen offset:0
    buffer_load_dword v29, v11, s[80:83], s48 offen offset:256
    buffer_load_dword v30, v11, s[80:83], s48 offen offset:512
    buffer_load_dword v31, v11, s[80:83], s48 offen offset:768
    s_mul_i32 s3, s84, 40
    s_add_u32 s3, s3, s32
    s_add_u32 s3, s3, 32
    s_mul_i32 s76, s3, 52429
    s_lshr_b32 s76, s76, 22
    s_mul_i32 s74, s76, 80
    s_sub_u32 s3, s3, s74
    s_cmp_ge_u32 s32, 8
    s_cselect_b32 s82, 0, s82
    s_mul_i32 s74, s3, 205
    s_lshr_b32 s74, s74, 10
    s_mul_i32 s75, s74, 5
    s_sub_u32 s75, s3, s75
    s_lshl_b32 s48, s74, 1
    s_add_u32 s48, s48, s75
    s_add_u32 s49, s48, s74
    s_add_u32 s49, s49, 30
    s_cmp_lt_u32 s75, 2
    s_cselect_b32 s48, s48, s49
    s_lshl_b32 s48, s48, 10
    s_mul_i32 s49, s76, 80000
    s_add_u32 s48, s48, s49
    buffer_load_dword v112, v11, s[80:83], s48 offen offset:0
    buffer_load_dword v113, v11, s[80:83], s48 offen offset:256
    buffer_load_dword v114, v11, s[80:83], s48 offen offset:512
    buffer_load_dword v115, v11, s[80:83], s48 offen offset:768
    v_and_b32 v7, -4, v52
    v_lshl_add_u32 v8, v52, 2, v7
    ds_write_b32 v8, v48
    v_lshl_add_u32 v7, v7, 2, v52
    ds_write_b8 v7, v34 offset:16
    v_and_b32 v9, -4, v53
    v_lshl_add_u32 v10, v53, 2, v9
    ds_write_b32 v10, v49
    v_lshl_add_u32 v9, v9, 2, v53
    ds_write_b8_d16_hi v9, v34 offset:16
    v_and_b32 v7, -4, v54
    v_lshl_add_u32 v8, v54, 2, v7
    ds_write_b32 v8, v50
    v_lshl_add_u32 v7, v7, 2, v54
    ds_write_b8 v7, v35 offset:16
    v_and_b32 v9, -4, v55
    v_lshl_add_u32 v10, v55, 2, v9
    ds_write_b32 v10, v51
    v_lshl_add_u32 v9, v9, 2, v55
    ds_write_b8_d16_hi v9, v35 offset:16
    s_setprio 1
    v_and_b32 v7, -4, v68
    v_lshl_add_u32 v8, v68, 2, v7
    ds_write_b32 v8, v84
    v_lshl_add_u32 v7, v7, 2, v68
    ds_write_b8 v7, v72 offset:16
    v_and_b32 v9, -4, v69
    v_lshl_add_u32 v10, v69, 2, v9
    ds_write_b32 v10, v85
    v_lshl_add_u32 v9, v9, 2, v69
    ds_write_b8_d16_hi v9, v72 offset:16
    v_and_b32 v7, -4, v70
    v_lshl_add_u32 v8, v70, 2, v7
    ds_write_b32 v8, v86
    v_lshl_add_u32 v7, v7, 2, v70
    ds_write_b8 v7, v73 offset:16
    v_and_b32 v9, -4, v71
    v_lshl_add_u32 v10, v71, 2, v9
    ds_write_b32 v10, v87
    v_lshl_add_u32 v9, v9, 2, v71
    ds_write_b8_d16_hi v9, v73 offset:16
    s_cmp_le_u32 s43, 5
    s_cbranch_scc1 L1_s13
    v_and_b32 v7, -4, v76
    v_lshl_add_u32 v8, v76, 2, v7
    ds_write_b32 v8, v36
    v_lshl_add_u32 v7, v7, 2, v76
    ds_write_b8 v7, v74 offset:16
    v_and_b32 v9, -4, v77
    v_lshl_add_u32 v10, v77, 2, v9
    ds_write_b32 v10, v37
    v_lshl_add_u32 v9, v9, 2, v77
    ds_write_b8_d16_hi v9, v74 offset:16
    v_and_b32 v7, -4, v78
    v_lshl_add_u32 v8, v78, 2, v7
    ds_write_b32 v8, v38
    v_lshl_add_u32 v7, v7, 2, v78
    ds_write_b8 v7, v75 offset:16
    v_and_b32 v9, -4, v79
    v_lshl_add_u32 v10, v79, 2, v9
    ds_write_b32 v10, v39
    v_lshl_add_u32 v9, v9, 2, v79
    ds_write_b8_d16_hi v9, v75 offset:16
L1_s13:
    s_add_u32 s44, s35, 0x7ec8000
    s_add_u32 s44, s44, s93
    buffer_store_dwordx4 v[108:111], v0, s[20:23], s44 offen sc1
    s_setprio 0
    s_cmp_le_u32 s43, 6
    s_cbranch_scc1 L1_s14
    v_and_b32 v7, -4, v56
    v_lshl_add_u32 v8, v56, 2, v7
    ds_write_b32 v8, v80
    v_lshl_add_u32 v7, v7, 2, v56
    ds_write_b8 v7, v64 offset:16
    v_and_b32 v9, -4, v57
    v_lshl_add_u32 v10, v57, 2, v9
    ds_write_b32 v10, v81
    v_lshl_add_u32 v9, v9, 2, v57
    ds_write_b8_d16_hi v9, v64 offset:16
    v_and_b32 v7, -4, v58
    v_lshl_add_u32 v8, v58, 2, v7
    ds_write_b32 v8, v82
    v_lshl_add_u32 v7, v7, 2, v58
    ds_write_b8 v7, v65 offset:16
    v_and_b32 v9, -4, v59
    v_lshl_add_u32 v10, v59, 2, v9
    ds_write_b32 v10, v83
    v_lshl_add_u32 v9, v9, 2, v59
    ds_write_b8_d16_hi v9, v65 offset:16
L1_s14:
    s_cmp_le_u32 s43, 7
    s_cbranch_scc1 L1_s15
    v_and_b32 v7, -4, v60
    v_lshl_add_u32 v8, v60, 2, v7
    ds_write_b32 v8, v96
    v_lshl_add_u32 v7, v7, 2, v60
    ds_write_b8 v7, v66 offset:16
    v_and_b32 v9, -4, v61
    v_lshl_add_u32 v10, v61, 2, v9
    ds_write_b32 v10, v97
    v_lshl_add_u32 v9, v9, 2, v61
    ds_write_b8_d16_hi v9, v66 offset:16
    v_and_b32 v7, -4, v62
    v_lshl_add_u32 v8, v62, 2, v7
    ds_write_b32 v8, v98
    v_lshl_add_u32 v7, v7, 2, v62
    ds_write_b8 v7, v67 offset:16
    v_and_b32 v9, -4, v63
    v_lshl_add_u32 v10, v63, 2, v9
    ds_write_b32 v10, v99
    v_lshl_add_u32 v9, v9, 2, v63
    ds_write_b8_d16_hi v9, v67 offset:16
L1_s15:
    s_add_u32 s80, s30, 0xd344000
    s_addc_u32 s81, s31, 0
    s_mov_b32 s82, 0xa000
    s_mov_b32 s83, 0x20000
    s_min_u32 s3, s84, 127
    s_mul_i32 s3, s3, 40960
    s_add_u32 s80, s80, s3
    s_addc_u32 s81, s81, 0
    s_cmp_ge_u32 s84, 128
    s_cselect_b32 s82, 0, s82
    s_waitcnt vmcnt(1)
    v_add_u32 v11, 0, v0
    buffer_store_dwordx4 v[104:107], v11, s[80:83], 0 offen sc1
    v_add_u32 v11, 16384, v0
    buffer_store_dwordx4 v[28:31], v11, s[80:83], 0 offen sc1
    v_add_u32 v11, 32768, v0
    buffer_store_dwordx4 v[112:115], v11, s[80:83], 0 offen sc1
    v_add_u32 v7, 0x10000, v0
    v_add_u32 v12, 0x20000, v0
    s_waitcnt lgkmcnt(0)
    s_barrier
    ds_read_b128 v[24:27], v0 offset:0
    ds_read_b128 v[28:31], v0 offset:16384
    ds_read_b128 v[32:35], v0 offset:32768
    ds_read_b128 v[36:39], v0 offset:49152
    ds_read_b128 v[76:79], v7 offset:0
    ds_read_b128 v[80:83], v7 offset:16384
    ds_read_b128 v[84:87], v7 offset:32768
    ds_read_b128 v[104:107], v7 offset:49152
    ds_read_b128 v[68:71], v12 offset:0
    ds_read_b128 v[72:75], v12 offset:16384
    s_cmp_lg_u32 s32, 0
    s_cbranch_scc1 L2_sg1
    s_mov_b32 exec_hi, 0
    v_mov_b32 v11, 1
    buffer_store_dword v11, v14, s[60:63], s57 offen sc1
    s_mov_b64 exec, -1
L2_sg1:
    s_waitcnt lgkmcnt(9)
    s_add_u32 s45, s35, 0xa904000
    buffer_store_dwordx4 v[24:27], v0, s[20:23], s45 offen sc1
    s_waitcnt lgkmcnt(8)
    s_add_u32 s46, s35, 0xa908000
    buffer_store_dwordx4 v[28:31], v0, s[20:23], s46 offen sc1
    s_waitcnt lgkmcnt(7)
    s_add_u32 s47, s35, 0xa90c000
    buffer_store_dwordx4 v[32:35], v0, s[20:23], s47 offen sc1
    s_waitcnt lgkmcnt(6)
    s_add_u32 s44, s35, 0xa910000
    buffer_store_dwordx4 v[36:39], v0, s[20:23], s44 offen sc1
    s_waitcnt lgkmcnt(5)
    s_add_u32 s45, s35, 0xa914000
    buffer_store_dwordx4 v[76:79], v0, s[20:23], s45 offen sc1
    s_waitcnt lgkmcnt(4)
    s_add_u32 s46, s35, 0xa918000
    buffer_store_dwordx4 v[80:83], v0, s[20:23], s46 offen sc1
    s_waitcnt lgkmcnt(3)
    s_add_u32 s47, s35, 0xa91c000
    buffer_store_dwordx4 v[84:87], v0, s[20:23], s47 offen sc1
    s_waitcnt lgkmcnt(2)
    s_cmp_le_u32 s43, 5
    s_cbranch_scc1 L1_q16
    s_add_u32 s44, s35, 0xa920000
    buffer_store_dwordx4 v[104:107], v0, s[20:23], s44 offen sc1
L1_q16:
    s_waitcnt lgkmcnt(1)
    s_cmp_le_u32 s43, 6
    s_cbranch_scc1 L1_q17
    s_add_u32 s45, s35, 0xa924000
    buffer_store_dwordx4 v[68:71], v0, s[20:23], s45 offen sc1
L1_q17:
    s_waitcnt lgkmcnt(0)
    s_cmp_le_u32 s43, 7
    s_cbranch_scc1 L1_q18
    s_add_u32 s46, s35, 0xa928000
    buffer_store_dwordx4 v[72:75], v0, s[20:23], s46 offen sc1
L1_q18:
    s_waitcnt lgkmcnt(0)
    s_setprio 3
    v_mov_b32 v92, v0
    v_mov_b32 v93, v6
    v_mov_b32 v94, v13
    v_mov_b32 v95, v5
    v_mov_b32 v0, v14
    v_lshl_add_u32 v7, v13, 3, s38
    v_lshrrev_b32 v16, 2, v15
    v_mad_u32_u24 v4, v16, 5, v4
    v_or_b32 v4, 0xf0000000, v4
    v_or_b32 v2, 0xf0000000, v2
    v_sub_u32 v1, 28, v16
    v_lshrrev_b32 v17, 2, v16
    v_and_b32 v18, 3, v17
    v_lshlrev_b32 v18, 4, v18
    v_mov_b32 v10, 0x3f80
    v_mov_b32 v11, 0
    v_lshlrev_b64 v[10:11], v18, v[10:11]
    v_and_b32 v18, 3, v17
    v_lshlrev_b32 v18, 4, v18
    v_mov_b32 v12, 0xbf80
    v_mov_b32 v13, 0
    v_lshlrev_b64 v[12:13], v18, v[12:13]
    v_mov_b32 v45, 0xf0000000
    v_add_u32 v44, s38, v0
    v_lshrrev_b32 v44, 1, v44
    v_and_b32 v44, -4, v44
    v_mov_b32 v5, 0x1fff8
    v_mov_b32 v6, 0x07ff0000
    v_mov_b32 v16, 0
    v_mov_b32 v17, 0
    v_mov_b32 v18, 0
    v_mov_b32 v19, 0
    v_add_u32 v20, 81920, v92
    v_add_u32 v21, 0x10000, v20
    s_setprio 1
    s_setprio 2
    s_mov_b32 s44, 0x4000c0c
    s_mov_b32 s45, 0x4010c0c
    s_mov_b32 s46, 0x4020c0c
    s_mov_b32 s47, 0x4030c0c
    s_mov_b32 s36, 0
    s_mov_b32 s43, 0
    s_mov_b32 s42, 0
    s_mov_b64 s[80:81], 0
    s_mov_b64 s[48:49], 0
    s_add_u32 s16, s30, 0xd344000
    s_addc_u32 s17, s31, 0
    s_mov_b32 s18, 0x500000
    s_mov_b32 s19, 0x20000
    v_mov_b32 v68, 0
    v_mov_b32 v69, 0
    v_mov_b32 v70, 0
    v_mov_b32 v71, 0
    v_mov_b32 v72, 0
    v_mov_b32 v73, 0
    v_mov_b32 v74, 0
    v_mov_b32 v75, 0
    s_waitcnt vmcnt(0)
    v_lshl_or_b32 v8, v101, 16, v100
    v_lshl_or_b32 v9, v103, 16, v102
    s_barrier
    s_cmp_lg_u32 s32, 0
    s_cbranch_scc1 L2_sg2
    s_mov_b32 exec_hi, 0
    v_mov_b32 v88, 2
    buffer_store_dword v88, v0, s[60:63], s57 offen sc1
    s_mov_b64 exec, -1
L2_sg2:
    s_mov_b64 s[84:85], 0
    s_mul_i32 s3, s33, 1280000
    s_add_u32 s3, s3, s100
    s_add_u32 s3, s3, 32768
    buffer_load_dwordx4 v[124:127], v94, s[24:27], s3 offen offset:2048
    s_mul_i32 s3, s33, 1280000
    s_add_u32 s3, s3, s100
    s_add_u32 s3, s3, 32768
    buffer_load_dwordx4 v[116:119], v94, s[24:27], s3 offen offset:0
    s_mul_i32 s3, s33, 1280000
    s_add_u32 s3, s3, s100
    s_add_u32 s3, s3, 32768
    buffer_load_dwordx4 v[120:123], v94, s[24:27], s3 offen offset:1024
    s_mul_i32 s3, s33, 1280000
    s_add_u32 s3, s3, s38
    s_add_u32 s3, s3, 0
    buffer_load_dwordx4 v[108:111], v94, s[24:27], s3 offen offset:0
    s_mul_i32 s3, s33, 1280000
    s_add_u32 s3, s3, s38
    s_add_u32 s3, s3, 0
    buffer_load_dwordx4 v[112:115], v94, s[24:27], s3 offen offset:1024
    ds_write_b128 v20, v[16:19] offset:0
    ds_write_b128 v20, v[16:19] offset:16384
    ds_write_b128 v20, v[16:19] offset:32768
    ds_write_b128 v20, v[16:19] offset:49152
    ds_write_b128 v21, v[16:19]
    s_cmp_eq_u32 s56, 0
    s_cbranch_scc1 L2_e3
    v_lshlrev_b32 v16, 3, v94
    v_and_b32 v16, 0x80, v16
L2_e4:
    buffer_load_dword v88, v16, s[68:71], 0 offen sc1
    s_waitcnt vmcnt(0)
    v_cmp_gt_u32 vcc, 0x80, v88
    s_cbranch_vccnz L2_e4
L2_e3:
    s_mov_b64 exec, 0xffff
L2_p1:
    buffer_load_dword v88, v7, s[60:63], 0 offen sc1
    s_waitcnt vmcnt(0)
    v_cmpx_gt_u32 vcc, 1, v88
    s_cbranch_vccnz L2_p1
    s_mov_b64 exec, -1
    v_cmp_gt_u32 vcc, 2, v88
    s_and_b32 s56, vcc_lo, 0xffff
    buffer_load_dwordx4 v[48:51], v95, s[12:15], s39 offen offset:0
    buffer_load_dwordx4 v[56:59], v95, s[12:15], s39 offen offset:32
    buffer_load_dwordx4 v[52:55], v95, s[12:15], s39 offen offset:16
    buffer_load_dwordx4 v[60:63], v95, s[12:15], s39 offen offset:48
    buffer_load_dwordx4 v[64:67], v93, s[12:15], s39 offen
    s_waitcnt vmcnt(0)
    v_sub_u16 v88, v56, v48
    v_and_b32 v89, 3, v48
    v_add3_u32 v99, v88, v89, 3
    v_and_b32 v99, -4, v99
    v_max_u32 v99, 4, v99
    v_and_b32 v97, 0xfffc, v48
    v_bfm_b32 v96, v88, v89
    v_add_u32_dpp v91, v99, v99 row_shr:1 row_mask:0xf bank_mask:0xf bound_ctrl:1
    v_mad_u32_u24 v97, v97, 5, v2
    v_cmp_lt_u32 vcc, 16, v99
    v_add_u32_dpp v91, v91, v91 row_shr:2 row_mask:0xf bank_mask:0xf bound_ctrl:1
    v_sub_u32 v98, s38, v99
    v_lshrrev_b64 v[48:49], 16, v[48:49]
    v_add_u32_dpp v91, v91, v91 row_shr:4 row_mask:0xf bank_mask:0xf bound_ctrl:1
    v_lshrrev_b64 v[56:57], 16, v[56:57]
    s_mov_b32 s101, 0
    v_add_u32_dpp v91, v91, v91 row_shr:8 row_mask:0xf bank_mask:0xf bound_ctrl:1
    s_nop 1
    v_add_u32_dpp v91, v91, v91 row_bcast:15 row_mask:0xa bank_mask:0xf
    s_nop 1
    v_add_u32_dpp v91, v91, v91 row_bcast:31 row_mask:0xc bank_mask:0xf
    v_add_u32 v98, v98, v91
    v_readlane_b32 s37, v91, 63
    s_cbranch_vccnz L2_xo3
L2_xp3:
    s_cmp_gt_u32 s37, 1024
    s_cbranch_scc1 L2_xs4
    s_cmp_lg_u32 s101, 0
    s_cbranch_scc1 L2_xa4
L2_xb4:
    v_lshlrev_b32 v89, 16, v96
    v_add_u32 v90, 60, v97
    v_bitop3_b32 v90, v89, v45, v90 bitop3:0x6a
    ds_write_b32 v98, v90 offset:12
    v_lshlrev_b32 v89, 20, v96
    v_add_u32 v90, 40, v97
    v_bitop3_b32 v90, v89, v45, v90 bitop3:0x6a
    ds_write_b32 v98, v90 offset:8
    v_lshlrev_b32 v89, 24, v96
    v_add_u32 v90, 20, v97
    v_bitop3_b32 v90, v89, v45, v90 bitop3:0x6a
    ds_write_b32 v98, v90 offset:4
    v_lshlrev_b32 v89, 28, v96
    v_bitop3_b32 v90, v89, v45, v97 bitop3:0x6a
    ds_write_b32 v98, v90 offset:0
    v_mov_b32_dpp v91, v64 quad_perm:[0,0,0,0] row_mask:0xf bank_mask:0xf
    v_and_b32 v89, 3, v91
    v_and_b32 v97, 0xfffc, v91
    v_sub_u16_dpp v88, v64, v91 quad_perm:[2,2,2,2] row_mask:0xf bank_mask:0xf
    v_mad_u32_u24 v97, v97, 5, v4
    v_add_u32 v99, v88, v89
    v_bfm_b32 v96, v88, v89
    v_cmp_lt_u32 s[58:59], 16, v99
    v_lshlrev_b32 v89, v1, v96
    v_and_b32 v89, v45, v89
    v_cmp_ne_u32 vcc, 0, v89
    v_xor_b32 v90, v97, v89
    s_add_u32 s3, s37, s38
    v_mbcnt_lo_u32_b32 v98, vcc_lo, 0
    v_mbcnt_hi_u32_b32 v98, vcc_hi, v98
    s_bcnt1_i32_b64 s41, vcc
    v_lshl_add_u32 v98, v98, 2, s3
    s_lshl2_add_u32 s37, s41, s37
    s_mov_b64 exec, vcc
    ds_write_b32 v98, v90
    s_mov_b64 exec, -1
    s_cmp_lg_u64 s[58:59], 0
    s_cbranch_scc1 L2_xe4
L2_xr4:
    v_add_u32 v98, s37, v0
    v_mov_b32 v90, -1
    ds_write_b32 v98, v90
L2_xw4:
    ds_read_b32 v19, v44 offset:768
    ds_read_b32 v27, v0 offset:0
    ds_read_b32 v33, v0 offset:256
    ds_read_b32 v39, v0 offset:512
    s_sub_u32 s3, s37, 768
    s_cmp_gt_u32 s3, 128
    s_cbranch_scc1 L2_xf4
L2_xg4:
    v_sub_u16 v88, v58, v50
    v_and_b32 v89, 3, v50
    v_add3_u32 v99, v88, v89, 3
    v_and_b32 v99, -4, v99
    v_max_u32 v99, 4, v99
    v_and_b32 v97, 0xfffc, v50
    v_bfm_b32 v96, v88, v89
    v_add_u32_dpp v91, v99, v99 row_shr:1 row_mask:0xf bank_mask:0xf bound_ctrl:1
    v_mad_u32_u24 v97, v97, 5, v2
    v_cmp_lt_u32 vcc, 16, v99
    v_add_u32_dpp v91, v91, v91 row_shr:2 row_mask:0xf bank_mask:0xf bound_ctrl:1
    v_sub_u32 v98, s38, v99
    v_lshrrev_b64 v[50:51], 16, v[50:51]
    v_add_u32_dpp v91, v91, v91 row_shr:4 row_mask:0xf bank_mask:0xf bound_ctrl:1
    v_lshrrev_b64 v[58:59], 16, v[58:59]
    s_mov_b32 s101, 0
    v_add_u32_dpp v91, v91, v91 row_shr:8 row_mask:0xf bank_mask:0xf bound_ctrl:1
    s_nop 1
    v_add_u32_dpp v91, v91, v91 row_bcast:15 row_mask:0xa bank_mask:0xf
    s_nop 1
    v_add_u32_dpp v91, v91, v91 row_bcast:31 row_mask:0xc bank_mask:0xf
    v_add_u32 v98, v98, v91
    v_readlane_b32 s37, v91, 63
    s_cbranch_vccnz L2_xo5
L2_xp5:
    s_waitcnt lgkmcnt(0)
    s_cmp_gt_u32 s37, 1024
    s_cbranch_scc1 L2_xs6
    s_cmp_lg_u32 s101, 0
    s_cbranch_scc1 L2_xa6
L2_xb6:
    v_lshlrev_b32 v89, 16, v96
    v_add_u32 v90, 60, v97
    v_bitop3_b32 v90, v89, v45, v90 bitop3:0x6a
    ds_write_b32 v98, v90 offset:12
    v_lshlrev_b32 v89, 20, v96
    v_add_u32 v90, 40, v97
    v_bitop3_b32 v90, v89, v45, v90 bitop3:0x6a
    ds_write_b32 v98, v90 offset:8
    v_lshlrev_b32 v89, 24, v96
    v_add_u32 v90, 20, v97
    v_bitop3_b32 v90, v89, v45, v90 bitop3:0x6a
    ds_write_b32 v98, v90 offset:4
    v_lshlrev_b32 v89, 28, v96
    v_bitop3_b32 v90, v89, v45, v97 bitop3:0x6a
    ds_write_b32 v98, v90 offset:0
    v_mov_b32_dpp v91, v66 quad_perm:[0,0,0,0] row_mask:0xf bank_mask:0xf
    v_and_b32 v89, 3, v91
    v_and_b32 v97, 0xfffc, v91
    v_sub_u16_dpp v88, v66, v91 quad_perm:[2,2,2,2] row_mask:0xf bank_mask:0xf
    v_mad_u32_u24 v97, v97, 5, v4
    v_add_u32 v99, v88, v89
    v_bfm_b32 v96, v88, v89
    v_cmp_lt_u32 s[58:59], 16, v99
    v_lshlrev_b32 v89, v1, v96
    v_and_b32 v89, v45, v89
    v_cmp_ne_u32 vcc, 0, v89
    v_xor_b32 v90, v97, v89
    s_add_u32 s3, s37, s38
    v_mbcnt_lo_u32_b32 v98, vcc_lo, 0
    v_mbcnt_hi_u32_b32 v98, vcc_hi, v98
    s_bcnt1_i32_b64 s41, vcc
    v_lshl_add_u32 v98, v98, 2, s3
    s_lshl2_add_u32 s37, s41, s37
    s_mov_b64 exec, vcc
    ds_write_b32 v98, v90
    s_mov_b64 exec, -1
    s_cmp_lg_u64 s[58:59], 0
    s_cbranch_scc1 L2_xe6
L2_xr6:
    v_add_u32 v98, s37, v0
    v_mov_b32 v90, -1
    ds_write_b32 v98, v90
L2_xw6:
    ds_read_b32 v40, v44 offset:768
    ds_read_b32 v41, v0 offset:0
    ds_read_b32 v42, v0 offset:256
    ds_read_b32 v43, v0 offset:512
    s_sub_u32 s3, s37, 768
    s_cmp_gt_u32 s3, 128
    s_cbranch_scc1 L2_xf6
L2_xg6:
    v_subrev_u32 v88, s38, v3
    ds_write_b128 v88, v[124:127] offset:34816
    v_subrev_u32 v88, s38, v3
    ds_write_b128 v88, v[116:119] offset:32768
    v_subrev_u32 v88, s38, v3
    ds_write_b128 v88, v[120:123] offset:33792
    v_subrev_u32 v88, s100, v3
    ds_write_b128 v88, v[108:111] offset:0
    v_subrev_u32 v88, s100, v3
    ds_write_b128 v88, v[112:115] offset:1024
    s_cmp_eq_u32 s56, 0
    s_cbranch_scc1 L2_e2
    s_mov_b32 exec_lo, s56
    s_mov_b32 exec_hi, 0
    buffer_load_dword v88, v7, s[60:63], 0 offen sc1
    s_mov_b64 exec, -1
    s_waitcnt vmcnt(0)
    v_cmp_gt_u32 vcc, 2, v88
    s_and_b32 s56, vcc_lo, s56
    s_cbranch_scc0 L2_e2
    s_mul_i32 s3, s33, 1280000
    s_add_u32 s3, s3, s100
    s_add_u32 s3, s3, 352768
    buffer_load_dwordx4 v[124:127], v94, s[24:27], s3 offen offset:2048
    s_mul_i32 s3, s33, 1280000
    s_add_u32 s3, s3, s100
    s_add_u32 s3, s3, 352768
    buffer_load_dwordx4 v[116:119], v94, s[24:27], s3 offen offset:0
    s_mul_i32 s3, s33, 1280000
    s_add_u32 s3, s3, s100
    s_add_u32 s3, s3, 352768
    buffer_load_dwordx4 v[120:123], v94, s[24:27], s3 offen offset:1024
    s_mul_i32 s3, s33, 1280000
    s_add_u32 s3, s3, s38
    s_add_u32 s3, s3, 320000
    buffer_load_dwordx4 v[108:111], v94, s[24:27], s3 offen offset:0
    s_mul_i32 s3, s33, 1280000
    s_add_u32 s3, s3, s38
    s_add_u32 s3, s3, 320000
    buffer_load_dwordx4 v[112:115], v94, s[24:27], s3 offen offset:1024
    s_mov_b32 exec_lo, s56
    s_mov_b32 exec_hi, 0
L2_p2:
    buffer_load_dword v88, v7, s[60:63], 0 offen sc1
    s_waitcnt vmcnt(0)
    v_cmpx_gt_u32 vcc, 2, v88
    s_cbranch_vccnz L2_p2
    s_mov_b64 exec, -1
L2_e2:
    s_mov_b32 s6, 0xaaaaaaaa
    s_mov_b32 s7, 0xaaaaaaaa
    v_and_b32 v47, 0x0fffffff, v19
    buffer_load_dword v18, v47, s[8:11], 0 offen offset:16
    s_mov_b64 exec, s[6:7]
    v_add_u32 v47, 8, v47
    v_lshrrev_b32 v19, 2, v19
    s_mov_b64 exec, -1
    buffer_load_dwordx2 v[16:17], v47, s[8:11], 0 offen
    s_setprio 1
    v_and_b32 v47, 0x0fffffff, v27
    buffer_load_dwordx2 v[22:23], v47, s[8:11], 0 offen
    buffer_load_dwordx3 v[24:26], v47, s[8:11], 0 offen offset:8
    s_waitcnt lgkmcnt(0)
    s_barrier
    s_bitcmp1_b32 s36, s42
    s_cbranch_scc1 L2_slow
L2_ret0:
    s_setprio 3
    s_bitcmp1_b32 s43, s42
    s_cbranch_scc1 L2_oa7
L2_ob7:
    s_bitcmp1_b32 s43, s42
    s_cbranch_scc1 L2_oa8
L2_ob8:
    v_and_b32 v47, 0x0fffffff, v33
    buffer_load_dwordx2 v[28:29], v47, s[8:11], 0 offen
    buffer_load_dwordx3 v[30:32], v47, s[8:11], 0 offen offset:8
    s_waitcnt vmcnt(4)
    s_mov_b64 exec, s[6:7]
    v_lshrrev_b32 v18, 16, v18
    s_mov_b64 exec, -1
    v_and_b32 v46, 0x20000000, v19
    v_lshrrev_b32 v47, 14, v17
    v_bitop3_b32 v47, v47, v5, v46 bitop3:0xea
    ds_read_b64 v[102:103], v47
    v_bitop3_b32 v93, v17, v5, v46 bitop3:0xea
    v_and_b32 v46, 0x10000000, v19
    v_lshrrev_b32 v47, 14, v16
    v_bitop3_b32 v47, v47, v5, v46 bitop3:0xea
    ds_read_b64 v[100:101], v47
    v_bitop3_b32 v92, v16, v5, v46 bitop3:0xea
    v_perm_b32 v15, v17, v18, s45
    v_bitop3_b32 v46, v17, 0.5, -0.5 bitop3:0xa8
    v_perm_b32 v14, v16, v18, s44
    v_bitop3_b32 v47, v16, 0.5, -0.5 bitop3:0xa8
    v_bitop3_b32 v15, v6, v15, v46 bitop3:0xca
    v_bitop3_b32 v14, v6, v14, v47 bitop3:0xca
    s_waitcnt lgkmcnt(0)
    v_mfma_f32_4x4x4_16b_bf16 v[80:83], v[8:9], v[102:103], 0
    v_mfma_f32_4x4x4_16b_bf16 v[76:79], v[8:9], v[100:101], 0
    v_cmp_lt_u32 s[84:85], v5, v92
    s_nop 2
    v_pk_mul_f32 v[80:81], v[80:81], v[14:15] op_sel:[0,1] op_sel_hi:[1,1]
    v_pk_mul_f32 v[82:83], v[82:83], v[14:15] op_sel:[0,1] op_sel_hi:[1,1]
    v_pk_mul_f32 v[76:77], v[76:77], v[14:15] op_sel:[0,0] op_sel_hi:[1,0]
    v_pk_mul_f32 v[78:79], v[78:79], v[14:15] op_sel:[0,0] op_sel_hi:[1,0]
    v_and_b32 v47, 0x0fffffff, v39
    buffer_load_dwordx2 v[34:35], v47, s[8:11], 0 offen
    buffer_load_dwordx3 v[36:38], v47, s[8:11], 0 offen offset:8
    s_waitcnt vmcnt(4)
    v_and_b32 v46, 0x20000000, v27
    v_lshrrev_b32 v47, 14, v23
    v_bitop3_b32 v47, v47, v5, v46 bitop3:0xea
    ds_read_b64 v[106:107], v47
    v_and_b32 v99, 0x10000000, v27
    v_lshrrev_b32 v47, 14, v22
    v_bitop3_b32 v47, v47, v5, v99 bitop3:0xea
    ds_read_b64 v[104:105], v47
    v_cmp_ne_u64 s[50:51], v[72:73], v[68:69]
    v_cmpx_ne_u64 s[54:55], v[74:75], v[70:71]
    s_and_b64 s[82:83], s[54:55], s[80:81]
    s_cbranch_scc1 L2_c9
L2_d9:
    v_mov_b64 v[84:85], v[70:71]
    v_mov_b32 v7, v95
    v_mov_b64 v[86:87], v[74:75]
    s_or_b64 s[80:81], s[80:81], s[54:55]
    s_mov_b64 exec, s[50:51]
    s_and_b64 s[82:83], s[50:51], s[80:81]
    s_cbranch_scc1 L2_c10
L2_d10:
    v_mov_b64 v[84:85], v[68:69]
    v_mov_b32 v7, v94
    v_mov_b64 v[86:87], v[72:73]
    s_mov_b64 exec, -1
    s_or_b64 s[80:81], s[80:81], s[50:51]
    s_and_b64 exec, s[84:85], s[80:81]
    v_mfma_f32_4x4x4_16b_bf16 v[76:79], v[12:13], v[84:85], 0
    v_mov_b32 v92, v7
    s_andn2_b64 s[80:81], s[80:81], s[84:85]
    v_mfma_f32_4x4x4_16b_bf16 v[76:79], v[10:11], v[86:87], v[76:79]
    s_mov_b64 exec, -1
    ds_read_b64 v[70:71], v93 offset:65408
    ds_read_b64 v[68:69], v92 offset:65408
    v_bitop3_b32 v94, v22, v5, v99 bitop3:0xea
    v_bitop3_b32 v95, v23, v5, v46 bitop3:0xea
    v_perm_b32 v15, v23, v26, s45
    v_bitop3_b32 v46, v23, 0.5, -0.5 bitop3:0xa8
    v_perm_b32 v14, v22, v26, s44
    v_bitop3_b32 v47, v22, 0.5, -0.5 bitop3:0xa8
    v_bitop3_b32 v15, v6, v15, v46 bitop3:0xca
    v_bitop3_b32 v14, v6, v14, v47 bitop3:0xca
    s_waitcnt lgkmcnt(1)
    v_mfma_f32_4x4x4_16b_bf16 v[80:83], v[10:11], v[70:71], v[80:83]
    s_waitcnt lgkmcnt(0)
    v_mfma_f32_4x4x4_16b_bf16 v[76:79], v[10:11], v[68:69], v[76:79]
    s_nop 2
    v_cvt_pk_bf16_f32 v80, v80, v81
    v_cvt_pk_bf16_f32 v81, v82, v83
    ds_wrxchg_rtn_b64 v[74:75], v93, v[80:81] offset:65408
    v_cvt_pk_bf16_f32 v76, v76, v77
    v_cvt_pk_bf16_f32 v77, v78, v79
    ds_wrxchg_rtn_b64 v[72:73], v92, v[76:77] offset:65408
    v_mfma_f32_4x4x4_16b_bf16 v[80:83], v[8:9], v[106:107], 0
    v_mfma_f32_4x4x4_16b_bf16 v[76:79], v[8:9], v[104:105], 0
    v_cmp_lt_u32 s[48:49], v5, v95
    s_nop 2
    v_pk_mul_f32 v[80:81], v[80:81], v[14:15] op_sel:[0,1] op_sel_hi:[1,1]
    v_pk_mul_f32 v[82:83], v[82:83], v[14:15] op_sel:[0,1] op_sel_hi:[1,1]
    v_pk_mul_f32 v[76:77], v[76:77], v[14:15] op_sel:[0,0] op_sel_hi:[1,0]
    v_pk_mul_f32 v[78:79], v[78:79], v[14:15] op_sel:[0,0] op_sel_hi:[1,0]
    v_and_b32 v47, 0x3f0, v3
    s_cmp_lg_u32 s56, 0
    s_cbranch_scc1 L2_m11
    s_mul_i32 s3, s33, 1280000
    s_add_u32 s3, s3, s100
    s_add_u32 s3, s3, 352768
    buffer_load_dwordx4 v[124:127], v47, s[24:27], s3 offen offset:2048
L2_m11:
    v_and_b32 v47, 0x3f0, v3
    s_cmp_lg_u32 s56, 0
    s_cbranch_scc1 L2_m12
    s_mul_i32 s3, s33, 1280000
    s_add_u32 s3, s3, s100
    s_add_u32 s3, s3, 352768
    buffer_load_dwordx4 v[116:119], v47, s[24:27], s3 offen offset:0
L2_m12:
    v_and_b32 v46, 0x80000000, v27
    v_lshrrev_b32 v47, 14, v25
    v_bitop3_b32 v47, v47, v5, v46 bitop3:0xea
    ds_read_b64 v[102:103], v47
    v_and_b32 v99, 0x40000000, v27
    v_lshrrev_b32 v47, 14, v24
    v_bitop3_b32 v47, v47, v5, v99 bitop3:0xea
    ds_read_b64 v[100:101], v47
    s_waitcnt lgkmcnt(2)
    v_cmp_ne_u64 s[50:51], v[72:73], v[68:69]
    v_cmpx_ne_u64 s[54:55], v[74:75], v[70:71]
    s_and_b64 s[82:83], s[54:55], s[80:81]
    s_cbranch_scc1 L2_c13
L2_d13:
    v_mov_b64 v[84:85], v[70:71]
    v_mov_b32 v7, v93
    v_mov_b64 v[86:87], v[74:75]
    s_or_b64 s[80:81], s[80:81], s[54:55]
    s_mov_b64 exec, s[50:51]
    s_and_b64 s[82:83], s[50:51], s[80:81]
    s_cbranch_scc1 L2_c14
L2_d14:
    v_mov_b64 v[84:85], v[68:69]
    v_mov_b32 v7, v92
    v_mov_b64 v[86:87], v[72:73]
    s_mov_b64 exec, -1
    s_or_b64 s[80:81], s[80:81], s[50:51]
    s_and_b64 exec, s[48:49], s[80:81]
    v_mfma_f32_4x4x4_16b_bf16 v[80:83], v[12:13], v[84:85], 0
    v_mov_b32 v95, v7
    s_andn2_b64 s[80:81], s[80:81], s[48:49]
    v_mfma_f32_4x4x4_16b_bf16 v[80:83], v[10:11], v[86:87], v[80:83]
    s_mov_b64 exec, -1
    ds_read_b64 v[70:71], v95 offset:65408
    ds_read_b64 v[68:69], v94 offset:65408
    v_bitop3_b32 v92, v24, v5, v99 bitop3:0xea
    v_bitop3_b32 v93, v25, v5, v46 bitop3:0xea
    v_perm_b32 v15, v25, v26, s47
    v_bitop3_b32 v46, v25, 0.5, -0.5 bitop3:0xa8
    v_perm_b32 v14, v24, v26, s46
    v_bitop3_b32 v47, v24, 0.5, -0.5 bitop3:0xa8
    v_bitop3_b32 v15, v6, v15, v46 bitop3:0xca
    v_bitop3_b32 v14, v6, v14, v47 bitop3:0xca
    s_waitcnt lgkmcnt(1)
    v_mfma_f32_4x4x4_16b_bf16 v[80:83], v[10:11], v[70:71], v[80:83]
    s_waitcnt lgkmcnt(0)
    v_mfma_f32_4x4x4_16b_bf16 v[76:79], v[10:11], v[68:69], v[76:79]
    s_nop 2
    v_cvt_pk_bf16_f32 v80, v80, v81
    v_cvt_pk_bf16_f32 v81, v82, v83
    ds_wrxchg_rtn_b64 v[74:75], v95, v[80:81] offset:65408
    v_cvt_pk_bf16_f32 v76, v76, v77
    v_cvt_pk_bf16_f32 v77, v78, v79
    ds_wrxchg_rtn_b64 v[72:73], v94, v[76:77] offset:65408
    s_setprio 2
    v_mfma_f32_4x4x4_16b_bf16 v[80:83], v[8:9], v[102:103], 0
    v_mfma_f32_4x4x4_16b_bf16 v[76:79], v[8:9], v[100:101], 0
    s_nop 3
    v_pk_mul_f32 v[80:81], v[80:81], v[14:15] op_sel:[0,1] op_sel_hi:[1,1]
    v_pk_mul_f32 v[82:83], v[82:83], v[14:15] op_sel:[0,1] op_sel_hi:[1,1]
    v_pk_mul_f32 v[76:77], v[76:77], v[14:15] op_sel:[0,0] op_sel_hi:[1,0]
    v_pk_mul_f32 v[78:79], v[78:79], v[14:15] op_sel:[0,0] op_sel_hi:[1,0]
    v_and_b32 v47, 0x3f0, v3
    s_cmp_lg_u32 s56, 0
    s_cbranch_scc1 L2_m15
    s_mul_i32 s3, s33, 1280000
    s_add_u32 s3, s3, s100
    s_add_u32 s3, s3, 352768
    buffer_load_dwordx4 v[120:123], v47, s[24:27], s3 offen offset:1024
L2_m15:
    v_and_b32 v47, 0x0fffffff, v40
    buffer_load_dword v18, v47, s[8:11], 0 offen offset:16
    s_mov_b64 exec, s[6:7]
    v_add_u32 v47, 8, v47
    v_lshrrev_b32 v40, 2, v40
    s_mov_b64 exec, -1
    buffer_load_dwordx2 v[16:17], v47, s[8:11], 0 offen
    s_waitcnt vmcnt(4)
    v_and_b32 v46, 0x20000000, v33
    v_lshrrev_b32 v47, 14, v29
    v_bitop3_b32 v47, v47, v5, v46 bitop3:0xea
    ds_read_b64 v[106:107], v47
    v_and_b32 v99, 0x10000000, v33
    v_lshrrev_b32 v47, 14, v28
    v_bitop3_b32 v47, v47, v5, v99 bitop3:0xea
    ds_read_b64 v[104:105], v47
    s_waitcnt lgkmcnt(2)
    v_cmp_ne_u64 s[50:51], v[72:73], v[68:69]
    v_cmpx_ne_u64 s[54:55], v[74:75], v[70:71]
    s_and_b64 s[82:83], s[54:55], s[80:81]
    s_cbranch_scc1 L2_c16
L2_d16:
    v_mov_b64 v[84:85], v[70:71]
    v_mov_b32 v7, v95
    v_mov_b64 v[86:87], v[74:75]
    s_or_b64 s[80:81], s[80:81], s[54:55]
    s_mov_b64 exec, s[50:51]
    s_and_b64 s[82:83], s[50:51], s[80:81]
    s_cbranch_scc1 L2_c17
L2_d17:
    v_mov_b64 v[84:85], v[68:69]
    v_mov_b32 v7, v94
    v_mov_b64 v[86:87], v[72:73]
    s_mov_b64 exec, -1
    s_or_b64 s[80:81], s[80:81], s[50:51]
    ds_read_b64 v[70:71], v93 offset:65408
    ds_read_b64 v[68:69], v92 offset:65408
    v_bitop3_b32 v94, v28, v5, v99 bitop3:0xea
    v_bitop3_b32 v95, v29, v5, v46 bitop3:0xea
    v_perm_b32 v15, v29, v32, s45
    v_bitop3_b32 v46, v29, 0.5, -0.5 bitop3:0xa8
    v_perm_b32 v14, v28, v32, s44
    v_bitop3_b32 v47, v28, 0.5, -0.5 bitop3:0xa8
    v_bitop3_b32 v15, v6, v15, v46 bitop3:0xca
    v_bitop3_b32 v14, v6, v14, v47 bitop3:0xca
    s_waitcnt lgkmcnt(1)
    v_mfma_f32_4x4x4_16b_bf16 v[80:83], v[10:11], v[70:71], v[80:83]
    s_waitcnt lgkmcnt(0)
    v_mfma_f32_4x4x4_16b_bf16 v[76:79], v[10:11], v[68:69], v[76:79]
    s_nop 2
    v_cvt_pk_bf16_f32 v80, v80, v81
    v_cvt_pk_bf16_f32 v81, v82, v83
    ds_wrxchg_rtn_b64 v[74:75], v93, v[80:81] offset:65408
    v_cvt_pk_bf16_f32 v76, v76, v77
    v_cvt_pk_bf16_f32 v77, v78, v79
    ds_wrxchg_rtn_b64 v[72:73], v92, v[76:77] offset:65408
    s_setprio 1
    v_mfma_f32_4x4x4_16b_bf16 v[80:83], v[8:9], v[106:107], 0
    v_mfma_f32_4x4x4_16b_bf16 v[76:79], v[8:9], v[104:105], 0
    v_cmp_lt_u32 s[84:85], v5, v94
    s_nop 2
    v_pk_mul_f32 v[80:81], v[80:81], v[14:15] op_sel:[0,1] op_sel_hi:[1,1]
    v_pk_mul_f32 v[82:83], v[82:83], v[14:15] op_sel:[0,1] op_sel_hi:[1,1]
    v_pk_mul_f32 v[76:77], v[76:77], v[14:15] op_sel:[0,0] op_sel_hi:[1,0]
    v_pk_mul_f32 v[78:79], v[78:79], v[14:15] op_sel:[0,0] op_sel_hi:[1,0]
    v_and_b32 v47, 0x3f0, v3
    s_cmp_lg_u32 s56, 0
    s_cbranch_scc1 L2_m18
    s_mul_i32 s3, s33, 1280000
    s_add_u32 s3, s3, s38
    s_add_u32 s3, s3, 320000
    buffer_load_dwordx4 v[108:111], v47, s[24:27], s3 offen offset:0
L2_m18:
    v_and_b32 v47, 0x3f0, v3
    s_cmp_lg_u32 s56, 0
    s_cbranch_scc1 L2_m19
    s_mul_i32 s3, s33, 1280000
    s_add_u32 s3, s3, s38
    s_add_u32 s3, s3, 320000
    buffer_load_dwordx4 v[112:115], v47, s[24:27], s3 offen offset:1024
L2_m19:
    v_and_b32 v47, 0x0fffffff, v41
    buffer_load_dwordx2 v[22:23], v47, s[8:11], 0 offen
    buffer_load_dwordx3 v[24:26], v47, s[8:11], 0 offen offset:8
    v_sub_u16 v88, v60, v52
    v_and_b32 v89, 3, v52
    v_add3_u32 v99, v88, v89, 3
    v_and_b32 v99, -4, v99
    v_max_u32 v99, 4, v99
    v_and_b32 v97, 0xfffc, v52
    v_bfm_b32 v96, v88, v89
    v_add_u32_dpp v91, v99, v99 row_shr:1 row_mask:0xf bank_mask:0xf bound_ctrl:1
    v_mad_u32_u24 v97, v97, 5, v2
    v_cmp_lt_u32 vcc, 16, v99
    v_add_u32_dpp v91, v91, v91 row_shr:2 row_mask:0xf bank_mask:0xf bound_ctrl:1
    v_sub_u32 v98, s38, v99
    v_lshrrev_b64 v[52:53], 16, v[52:53]
    v_add_u32_dpp v91, v91, v91 row_shr:4 row_mask:0xf bank_mask:0xf bound_ctrl:1
    v_lshrrev_b64 v[60:61], 16, v[60:61]
    s_mov_b32 s101, 0
    v_add_u32_dpp v91, v91, v91 row_shr:8 row_mask:0xf bank_mask:0xf bound_ctrl:1
    s_nop 1
    v_add_u32_dpp v91, v91, v91 row_bcast:15 row_mask:0xa bank_mask:0xf
    s_nop 1
    v_add_u32_dpp v91, v91, v91 row_bcast:31 row_mask:0xc bank_mask:0xf
    v_add_u32 v98, v98, v91
    v_readlane_b32 s37, v91, 63
    s_cbranch_vccnz L2_xo20
L2_xp20:
    v_and_b32 v46, 0x80000000, v33
    v_lshrrev_b32 v47, 14, v31
    v_bitop3_b32 v47, v47, v5, v46 bitop3:0xea
    ds_read_b64 v[102:103], v47
    v_and_b32 v99, 0x40000000, v33
    v_lshrrev_b32 v47, 14, v30
    v_bitop3_b32 v47, v47, v5, v99 bitop3:0xea
    ds_read_b64 v[100:101], v47
    s_waitcnt lgkmcnt(2)
    v_cmp_ne_u64 s[50:51], v[72:73], v[68:69]
    v_cmpx_ne_u64 s[54:55], v[74:75], v[70:71]
    s_and_b64 s[82:83], s[54:55], s[80:81]
    s_cbranch_scc1 L2_c21
L2_d21:
    v_mov_b64 v[84:85], v[70:71]
    v_mov_b32 v7, v93
    v_mov_b64 v[86:87], v[74:75]
    s_or_b64 s[80:81], s[80:81], s[54:55]
    s_mov_b64 exec, s[50:51]
    s_and_b64 s[82:83], s[50:51], s[80:81]
    s_cbranch_scc1 L2_c22
L2_d22:
    v_mov_b64 v[84:85], v[68:69]
    v_mov_b32 v7, v92
    v_mov_b64 v[86:87], v[72:73]
    s_mov_b64 exec, -1
    s_or_b64 s[80:81], s[80:81], s[50:51]
    s_and_b64 exec, s[84:85], s[80:81]
    v_mfma_f32_4x4x4_16b_bf16 v[76:79], v[12:13], v[84:85], 0
    v_mov_b32 v94, v7
    s_andn2_b64 s[80:81], s[80:81], s[84:85]
    v_mfma_f32_4x4x4_16b_bf16 v[76:79], v[10:11], v[86:87], v[76:79]
    s_mov_b64 exec, -1
    ds_read_b64 v[70:71], v95 offset:65408
    ds_read_b64 v[68:69], v94 offset:65408
    v_bitop3_b32 v92, v30, v5, v99 bitop3:0xea
    v_bitop3_b32 v93, v31, v5, v46 bitop3:0xea
    v_perm_b32 v15, v31, v32, s47
    v_bitop3_b32 v46, v31, 0.5, -0.5 bitop3:0xa8
    v_perm_b32 v14, v30, v32, s46
    v_bitop3_b32 v47, v30, 0.5, -0.5 bitop3:0xa8
    v_bitop3_b32 v15, v6, v15, v46 bitop3:0xca
    v_bitop3_b32 v14, v6, v14, v47 bitop3:0xca
    s_waitcnt lgkmcnt(1)
    v_mfma_f32_4x4x4_16b_bf16 v[80:83], v[10:11], v[70:71], v[80:83]
    s_waitcnt lgkmcnt(0)
    v_mfma_f32_4x4x4_16b_bf16 v[76:79], v[10:11], v[68:69], v[76:79]
    s_nop 2
    v_cvt_pk_bf16_f32 v80, v80, v81
    v_cvt_pk_bf16_f32 v81, v82, v83
    ds_wrxchg_rtn_b64 v[74:75], v95, v[80:81] offset:65408
    v_cvt_pk_bf16_f32 v76, v76, v77
    v_cvt_pk_bf16_f32 v77, v78, v79
    ds_wrxchg_rtn_b64 v[72:73], v94, v[76:77] offset:65408
    s_setprio 0
    v_mfma_f32_4x4x4_16b_bf16 v[80:83], v[8:9], v[102:103], 0
    v_mfma_f32_4x4x4_16b_bf16 v[76:79], v[8:9], v[100:101], 0
    v_cmp_lt_u32 s[48:49], v5, v93
    s_nop 2
    v_pk_mul_f32 v[80:81], v[80:81], v[14:15] op_sel:[0,1] op_sel_hi:[1,1]
    v_pk_mul_f32 v[82:83], v[82:83], v[14:15] op_sel:[0,1] op_sel_hi:[1,1]
    v_pk_mul_f32 v[76:77], v[76:77], v[14:15] op_sel:[0,0] op_sel_hi:[1,0]
    v_pk_mul_f32 v[78:79], v[78:79], v[14:15] op_sel:[0,0] op_sel_hi:[1,0]
    s_add_u32 s40, s40, 0x50000
    s_waitcnt vmcnt(4)
    v_and_b32 v46, 0x80000000, v39
    v_lshrrev_b32 v47, 14, v37
    v_bitop3_b32 v47, v47, v5, v46 bitop3:0xea
    ds_read_b64 v[102:103], v47
    v_and_b32 v99, 0x40000000, v39
    v_lshrrev_b32 v47, 14, v36
    v_bitop3_b32 v47, v47, v5, v99 bitop3:0xea
    ds_read_b64 v[100:101], v47
    v_and_b32 v46, 0x20000000, v39
    v_lshrrev_b32 v47, 14, v35
    v_bitop3_b32 v47, v47, v5, v46 bitop3:0xea
    ds_read_b64 v[106:107], v47
    v_and_b32 v99, 0x10000000, v39
    v_lshrrev_b32 v47, 14, v34
    v_bitop3_b32 v47, v47, v5, v99 bitop3:0xea
    ds_read_b64 v[104:105], v47
    s_waitcnt lgkmcnt(4)
    v_cmp_ne_u64 s[50:51], v[72:73], v[68:69]
    v_cmpx_ne_u64 s[54:55], v[74:75], v[70:71]
    s_and_b64 s[82:83], s[54:55], s[80:81]
    s_cbranch_scc1 L2_c23
L2_d23:
    v_mov_b64 v[84:85], v[70:71]
    v_mov_b32 v7, v95
    v_mov_b64 v[86:87], v[74:75]
    s_or_b64 s[80:81], s[80:81], s[54:55]
    s_mov_b64 exec, s[50:51]
    s_and_b64 s[82:83], s[50:51], s[80:81]
    s_cbranch_scc1 L2_c24
L2_d24:
    v_mov_b64 v[84:85], v[68:69]
    v_mov_b32 v7, v94
    v_mov_b64 v[86:87], v[72:73]
    s_mov_b64 exec, -1
    s_or_b64 s[80:81], s[80:81], s[50:51]
    s_and_b64 exec, s[48:49], s[80:81]
    v_mfma_f32_4x4x4_16b_bf16 v[80:83], v[12:13], v[84:85], 0
    v_mov_b32 v93, v7
    s_andn2_b64 s[80:81], s[80:81], s[48:49]
    v_mfma_f32_4x4x4_16b_bf16 v[80:83], v[10:11], v[86:87], v[80:83]
    s_mov_b64 exec, -1
    ds_read_b64 v[70:71], v93 offset:65408
    ds_read_b64 v[68:69], v92 offset:65408
    v_bitop3_b32 v94, v34, v5, v99 bitop3:0xea
    v_bitop3_b32 v95, v35, v5, v46 bitop3:0xea
    v_perm_b32 v15, v35, v38, s45
    v_bitop3_b32 v46, v35, 0.5, -0.5 bitop3:0xa8
    v_perm_b32 v14, v34, v38, s44
    v_bitop3_b32 v47, v34, 0.5, -0.5 bitop3:0xa8
    v_bitop3_b32 v15, v6, v15, v46 bitop3:0xca
    v_bitop3_b32 v14, v6, v14, v47 bitop3:0xca
    s_waitcnt lgkmcnt(1)
    v_mfma_f32_4x4x4_16b_bf16 v[80:83], v[10:11], v[70:71], v[80:83]
    s_waitcnt lgkmcnt(0)
    v_mfma_f32_4x4x4_16b_bf16 v[76:79], v[10:11], v[68:69], v[76:79]
    s_nop 2
    v_cvt_pk_bf16_f32 v80, v80, v81
    v_cvt_pk_bf16_f32 v81, v82, v83
    ds_wrxchg_rtn_b64 v[74:75], v93, v[80:81] offset:65408
    v_cvt_pk_bf16_f32 v76, v76, v77
    v_cvt_pk_bf16_f32 v77, v78, v79
    ds_wrxchg_rtn_b64 v[72:73], v92, v[76:77] offset:65408
    s_barrier
    s_setprio 3
    s_waitcnt vmcnt(4)
    v_subrev_u32 v88, s38, v3
    ds_write_b128 v88, v[124:127] offset:34816
    s_add_u32 s3, s40, 4096
    buffer_load_dwordx4 v[124:127], v3, s[16:19], s3 offen sc1
    s_waitcnt vmcnt(5)
    v_subrev_u32 v88, s38, v3
    ds_write_b128 v88, v[116:119] offset:32768
    buffer_load_dwordx4 v[116:119], v3, s[16:19], s40 offen offset:2048 sc1
    s_waitcnt vmcnt(6)
    v_subrev_u32 v88, s38, v3
    ds_write_b128 v88, v[120:123] offset:33792
    buffer_load_dwordx4 v[120:123], v3, s[16:19], s40 offen offset:3072 sc1
    v_mfma_f32_4x4x4_16b_bf16 v[80:83], v[8:9], v[106:107], 0
    v_mfma_f32_4x4x4_16b_bf16 v[76:79], v[8:9], v[104:105], 0
    s_nop 3
    v_pk_mul_f32 v[80:81], v[80:81], v[14:15] op_sel:[0,1] op_sel_hi:[1,1]
    v_pk_mul_f32 v[82:83], v[82:83], v[14:15] op_sel:[0,1] op_sel_hi:[1,1]
    v_pk_mul_f32 v[76:77], v[76:77], v[14:15] op_sel:[0,0] op_sel_hi:[1,0]
    v_pk_mul_f32 v[78:79], v[78:79], v[14:15] op_sel:[0,0] op_sel_hi:[1,0]
    v_and_b32 v47, 0x0fffffff, v42
    buffer_load_dwordx2 v[28:29], v47, s[8:11], 0 offen
    buffer_load_dwordx3 v[30:32], v47, s[8:11], 0 offen offset:8
    s_cmp_gt_u32 s37, 1024
    s_cbranch_scc1 L2_xs25
    s_cmp_lg_u32 s101, 0
    s_cbranch_scc1 L2_xa25
L2_xb25:
    v_lshlrev_b32 v89, 16, v96
    v_add_u32 v90, 60, v97
    v_bitop3_b32 v90, v89, v45, v90 bitop3:0x6a
    ds_write_b32 v98, v90 offset:12
    v_lshlrev_b32 v89, 20, v96
    v_add_u32 v90, 40, v97
    v_bitop3_b32 v90, v89, v45, v90 bitop3:0x6a
    ds_write_b32 v98, v90 offset:8
    v_lshlrev_b32 v89, 24, v96
    v_add_u32 v90, 20, v97
    v_bitop3_b32 v90, v89, v45, v90 bitop3:0x6a
    ds_write_b32 v98, v90 offset:4
    v_lshlrev_b32 v89, 28, v96
    v_bitop3_b32 v90, v89, v45, v97 bitop3:0x6a
    ds_write_b32 v98, v90 offset:0
    v_mov_b32_dpp v91, v64 quad_perm:[1,1,1,1] row_mask:0xf bank_mask:0xf
    v_and_b32 v89, 3, v91
    v_and_b32 v97, 0xfffc, v91
    v_sub_u16_dpp v88, v64, v91 quad_perm:[3,3,3,3] row_mask:0xf bank_mask:0xf
    v_mad_u32_u24 v97, v97, 5, v4
    v_add_u32 v99, v88, v89
    v_bfm_b32 v96, v88, v89
    v_cmp_lt_u32 s[58:59], 16, v99
    v_lshlrev_b32 v89, v1, v96
    v_and_b32 v89, v45, v89
    v_cmp_ne_u32 vcc, 0, v89
    v_xor_b32 v90, v97, v89
    s_add_u32 s3, s37, s38
    v_mbcnt_lo_u32_b32 v98, vcc_lo, 0
    v_mbcnt_hi_u32_b32 v98, vcc_hi, v98
    s_bcnt1_i32_b64 s41, vcc
    v_lshl_add_u32 v98, v98, 2, s3
    s_lshl2_add_u32 s37, s41, s37
    s_mov_b64 exec, vcc
    ds_write_b32 v98, v90
    s_mov_b64 exec, -1
    s_cmp_lg_u64 s[58:59], 0
    s_cbranch_scc1 L2_xe25
L2_xr25:
    v_add_u32 v98, s37, v0
    v_mov_b32 v90, -1
    ds_write_b32 v98, v90
L2_xw25:
    s_setprio 2
    s_waitcnt lgkmcnt(9)
    v_cmp_ne_u64 s[50:51], v[72:73], v[68:69]
    v_cmpx_ne_u64 s[54:55], v[74:75], v[70:71]
    s_and_b64 s[82:83], s[54:55], s[80:81]
    s_cbranch_scc1 L2_c26
L2_d26:
    v_mov_b64 v[84:85], v[70:71]
    v_mov_b32 v7, v93
    v_mov_b64 v[86:87], v[74:75]
    s_or_b64 s[80:81], s[80:81], s[54:55]
    s_mov_b64 exec, s[50:51]
    s_and_b64 s[82:83], s[50:51], s[80:81]
    s_cbranch_scc1 L2_c27
L2_d27:
    v_mov_b64 v[84:85], v[68:69]
    v_mov_b32 v7, v92
    v_mov_b64 v[86:87], v[72:73]
    s_mov_b64 exec, -1
    s_or_b64 s[80:81], s[80:81], s[50:51]
    ds_read_b64 v[70:71], v95 offset:65408
    ds_read_b64 v[68:69], v94 offset:65408
    v_and_b32 v46, 0x40000000, v39
    v_bitop3_b32 v92, v36, v5, v46 bitop3:0xea
    v_and_b32 v46, 0x80000000, v39
    v_bitop3_b32 v93, v37, v5, v46 bitop3:0xea
    v_perm_b32 v15, v37, v38, s47
    v_bitop3_b32 v46, v37, 0.5, -0.5 bitop3:0xa8
    v_perm_b32 v14, v36, v38, s46
    v_bitop3_b32 v47, v36, 0.5, -0.5 bitop3:0xa8
    v_bitop3_b32 v15, v6, v15, v46 bitop3:0xca
    v_bitop3_b32 v14, v6, v14, v47 bitop3:0xca
    s_setprio 1
    s_waitcnt lgkmcnt(1)
    v_mfma_f32_4x4x4_16b_bf16 v[80:83], v[10:11], v[70:71], v[80:83]
    s_waitcnt lgkmcnt(0)
    v_mfma_f32_4x4x4_16b_bf16 v[76:79], v[10:11], v[68:69], v[76:79]
    s_nop 2
    v_cvt_pk_bf16_f32 v80, v80, v81
    v_cvt_pk_bf16_f32 v81, v82, v83
    ds_wrxchg_rtn_b64 v[74:75], v95, v[80:81] offset:65408
    v_cvt_pk_bf16_f32 v76, v76, v77
    v_cvt_pk_bf16_f32 v77, v78, v79
    ds_wrxchg_rtn_b64 v[72:73], v94, v[76:77] offset:65408
    ds_read_b32 v19, v44 offset:768
    ds_read_b32 v27, v0 offset:0
    ds_read_b32 v33, v0 offset:256
    ds_read_b32 v39, v0 offset:512
    s_sub_u32 s3, s37, 768
    s_cmp_gt_u32 s3, 128
    s_cbranch_scc1 L2_xf25
L2_xg25:
    v_and_b32 v88, 0x0fffffff, v43
    buffer_load_dwordx2 v[34:35], v88, s[8:11], 0 offen
    buffer_load_dwordx3 v[36:38], v88, s[8:11], 0 offen offset:8
    s_setprio 0
    s_waitcnt vmcnt(9)
    v_subrev_u32 v88, s100, v3
    ds_write_b128 v88, v[108:111] offset:0
    s_waitcnt vmcnt(9)
    v_subrev_u32 v88, s100, v3
    ds_write_b128 v88, v[112:115] offset:1024
    v_mfma_f32_4x4x4_16b_bf16 v[80:83], v[8:9], v[102:103], 0
    v_mfma_f32_4x4x4_16b_bf16 v[76:79], v[8:9], v[100:101], 0
    v_cmp_lt_u32 s[84:85], v5, v92
    s_nop 2
    v_pk_mul_f32 v[80:81], v[80:81], v[14:15] op_sel:[0,1] op_sel_hi:[1,1]
    v_pk_mul_f32 v[82:83], v[82:83], v[14:15] op_sel:[0,1] op_sel_hi:[1,1]
    v_pk_mul_f32 v[76:77], v[76:77], v[14:15] op_sel:[0,0] op_sel_hi:[1,0]
    v_pk_mul_f32 v[78:79], v[78:79], v[14:15] op_sel:[0,0] op_sel_hi:[1,0]
    s_add_u32 s42, s42, 1
    s_waitcnt lgkmcnt(0)
    s_add_u32 s24, s30, 0xec54000
    s_addc_u32 s25, s31, 0
    s_mov_b32 s26, 0x100
    s_mov_b32 s27, 0x20000
    s_barrier
    s_bitcmp1_b32 s36, s42
    s_cbranch_scc1 L2_slow
L2_ret1:
    s_setprio 3
    s_bitcmp1_b32 s43, s42
    s_cbranch_scc1 L2_oa28
L2_ob28:
    s_mov_b64 exec, s[6:7]
    v_lshrrev_b32 v18, 16, v18
    s_mov_b64 exec, -1
    v_and_b32 v46, 0x20000000, v40
    v_lshrrev_b32 v47, 14, v17
    v_bitop3_b32 v47, v47, v5, v46 bitop3:0xea
    ds_read_b64 v[106:107], v47
    v_and_b32 v99, 0x10000000, v40
    v_lshrrev_b32 v47, 14, v16
    v_bitop3_b32 v47, v47, v5, v99 bitop3:0xea
    ds_read_b64 v[104:105], v47
    v_cmp_ne_u64 s[50:51], v[72:73], v[68:69]
    v_cmpx_ne_u64 s[54:55], v[74:75], v[70:71]
    s_and_b64 s[82:83], s[54:55], s[80:81]
    s_cbranch_scc1 L2_c29
L2_d29:
    v_mov_b64 v[84:85], v[70:71]
    v_mov_b32 v7, v95
    v_mov_b64 v[86:87], v[74:75]
    s_or_b64 s[80:81], s[80:81], s[54:55]
    s_mov_b64 exec, s[50:51]
    s_and_b64 s[82:83], s[50:51], s[80:81]
    s_cbranch_scc1 L2_c30
L2_d30:
    v_mov_b64 v[84:85], v[68:69]
    v_mov_b32 v7, v94
    v_mov_b64 v[86:87], v[72:73]
    s_mov_b64 exec, -1
    s_or_b64 s[80:81], s[80:81], s[50:51]
    s_and_b64 exec, s[84:85], s[80:81]
    v_mfma_f32_4x4x4_16b_bf16 v[76:79], v[12:13], v[84:85], 0
    v_mov_b32 v92, v7
    s_andn2_b64 s[80:81], s[80:81], s[84:85]
    v_mfma_f32_4x4x4_16b_bf16 v[76:79], v[10:11], v[86:87], v[76:79]
    s_mov_b64 exec, -1
    ds_read_b64 v[70:71], v93 offset:65408
    ds_read_b64 v[68:69], v92 offset:65408
    v_bitop3_b32 v94, v16, v5, v99 bitop3:0xea
    v_bitop3_b32 v95, v17, v5, v46 bitop3:0xea
    v_perm_b32 v15, v17, v18, s45
    v_bitop3_b32 v46, v17, 0.5, -0.5 bitop3:0xa8
    v_perm_b32 v14, v16, v18, s44
    v_bitop3_b32 v47, v16, 0.5, -0.5 bitop3:0xa8
    v_bitop3_b32 v15, v6, v15, v46 bitop3:0xca
    v_bitop3_b32 v14, v6, v14, v47 bitop3:0xca
    s_waitcnt lgkmcnt(1)
    v_mfma_f32_4x4x4_16b_bf16 v[80:83], v[10:11], v[70:71], v[80:83]
    s_waitcnt lgkmcnt(0)
    v_mfma_f32_4x4x4_16b_bf16 v[76:79], v[10:11], v[68:69], v[76:79]
    s_nop 2
    v_cvt_pk_bf16_f32 v80, v80, v81
    v_cvt_pk_bf16_f32 v81, v82, v83
    ds_wrxchg_rtn_b64 v[74:75], v93, v[80:81] offset:65408
    v_cvt_pk_bf16_f32 v76, v76, v77
    v_cvt_pk_bf16_f32 v77, v78, v79
    ds_wrxchg_rtn_b64 v[72:73], v92, v[76:77] offset:65408
    v_mfma_f32_4x4x4_16b_bf16 v[80:83], v[8:9], v[106:107], 0
    v_mfma_f32_4x4x4_16b_bf16 v[76:79], v[8:9], v[104:105], 0
    v_cmp_lt_u32 s[84:85], v5, v94
    s_nop 2
    v_pk_mul_f32 v[80:81], v[80:81], v[14:15] op_sel:[0,1] op_sel_hi:[1,1]
    v_pk_mul_f32 v[82:83], v[82:83], v[14:15] op_sel:[0,1] op_sel_hi:[1,1]
    v_pk_mul_f32 v[76:77], v[76:77], v[14:15] op_sel:[0,0] op_sel_hi:[1,0]
    v_pk_mul_f32 v[78:79], v[78:79], v[14:15] op_sel:[0,0] op_sel_hi:[1,0]
    v_and_b32 v47, 0x0fffffff, v19
    buffer_load_dword v18, v47, s[8:11], 0 offen offset:16
    s_mov_b64 exec, s[6:7]
    v_add_u32 v47, 8, v47
    v_lshrrev_b32 v19, 2, v19
    s_mov_b64 exec, -1
    buffer_load_dwordx2 v[16:17], v47, s[8:11], 0 offen
    s_waitcnt vmcnt(9)
    v_and_b32 v46, 0x20000000, v41
    v_lshrrev_b32 v47, 14, v23
    v_bitop3_b32 v47, v47, v5, v46 bitop3:0xea
    ds_read_b64 v[102:103], v47
    v_and_b32 v99, 0x10000000, v41
    v_lshrrev_b32 v47, 14, v22
    v_bitop3_b32 v47, v47, v5, v99 bitop3:0xea
    ds_read_b64 v[100:101], v47
    s_waitcnt lgkmcnt(2)
    v_cmp_ne_u64 s[50:51], v[72:73], v[68:69]
    v_cmpx_ne_u64 s[54:55], v[74:75], v[70:71]
    s_and_b64 s[82:83], s[54:55], s[80:81]
    s_cbranch_scc1 L2_c31
L2_d31:
    v_mov_b64 v[84:85], v[70:71]
    v_mov_b32 v7, v93
    v_mov_b64 v[86:87], v[74:75]
    s_or_b64 s[80:81], s[80:81], s[54:55]
    s_mov_b64 exec, s[50:51]
    s_and_b64 s[82:83], s[50:51], s[80:81]
    s_cbranch_scc1 L2_c32
L2_d32:
    v_mov_b64 v[84:85], v[68:69]
    v_mov_b32 v7, v92
    v_mov_b64 v[86:87], v[72:73]
    s_mov_b64 exec, -1
    s_or_b64 s[80:81], s[80:81], s[50:51]
    s_and_b64 exec, s[84:85], s[80:81]
    v_mfma_f32_4x4x4_16b_bf16 v[76:79], v[12:13], v[84:85], 0
    v_mov_b32 v94, v7
    s_andn2_b64 s[80:81], s[80:81], s[84:85]
    v_mfma_f32_4x4x4_16b_bf16 v[76:79], v[10:11], v[86:87], v[76:79]
    s_mov_b64 exec, -1
    ds_read_b64 v[70:71], v95 offset:65408
    ds_read_b64 v[68:69], v94 offset:65408
    v_bitop3_b32 v92, v22, v5, v99 bitop3:0xea
    v_bitop3_b32 v93, v23, v5, v46 bitop3:0xea
    v_perm_b32 v15, v23, v26, s45
    v_bitop3_b32 v46, v23, 0.5, -0.5 bitop3:0xa8
    v_perm_b32 v14, v22, v26, s44
    v_bitop3_b32 v47, v22, 0.5, -0.5 bitop3:0xa8
    v_bitop3_b32 v15, v6, v15, v46 bitop3:0xca
    v_bitop3_b32 v14, v6, v14, v47 bitop3:0xca
    s_waitcnt lgkmcnt(1)
    v_mfma_f32_4x4x4_16b_bf16 v[80:83], v[10:11], v[70:71], v[80:83]
    s_waitcnt lgkmcnt(0)
    v_mfma_f32_4x4x4_16b_bf16 v[76:79], v[10:11], v[68:69], v[76:79]
    s_nop 2
    v_cvt_pk_bf16_f32 v80, v80, v81
    v_cvt_pk_bf16_f32 v81, v82, v83
    ds_wrxchg_rtn_b64 v[74:75], v95, v[80:81] offset:65408
    v_cvt_pk_bf16_f32 v76, v76, v77
    v_cvt_pk_bf16_f32 v77, v78, v79
    ds_wrxchg_rtn_b64 v[72:73], v94, v[76:77] offset:65408
    v_mfma_f32_4x4x4_16b_bf16 v[80:83], v[8:9], v[102:103], 0
    v_mfma_f32_4x4x4_16b_bf16 v[76:79], v[8:9], v[100:101], 0
    v_cmp_lt_u32 s[48:49], v5, v93
    s_nop 2
    v_pk_mul_f32 v[80:81], v[80:81], v[14:15] op_sel:[0,1] op_sel_hi:[1,1]
    v_pk_mul_f32 v[82:83], v[82:83], v[14:15] op_sel:[0,1] op_sel_hi:[1,1]
    v_pk_mul_f32 v[76:77], v[76:77], v[14:15] op_sel:[0,0] op_sel_hi:[1,0]
    v_pk_mul_f32 v[78:79], v[78:79], v[14:15] op_sel:[0,0] op_sel_hi:[1,0]
    buffer_load_dwordx4 v[108:111], v3, s[16:19], s40 offen offset:0 sc1
    v_and_b32 v46, 0x80000000, v41
    v_lshrrev_b32 v47, 14, v25
    v_bitop3_b32 v47, v47, v5, v46 bitop3:0xea
    ds_read_b64 v[106:107], v47
    v_and_b32 v99, 0x40000000, v41
    v_lshrrev_b32 v47, 14, v24
    v_bitop3_b32 v47, v47, v5, v99 bitop3:0xea
    ds_read_b64 v[104:105], v47
    s_waitcnt lgkmcnt(2)
    v_cmp_ne_u64 s[50:51], v[72:73], v[68:69]
    v_cmpx_ne_u64 s[54:55], v[74:75], v[70:71]
    s_and_b64 s[82:83], s[54:55], s[80:81]
    s_cbranch_scc1 L2_c33
L2_d33:
    v_mov_b64 v[84:85], v[70:71]
    v_mov_b32 v7, v95
    v_mov_b64 v[86:87], v[74:75]
    s_or_b64 s[80:81], s[80:81], s[54:55]
    s_mov_b64 exec, s[50:51]
    s_and_b64 s[82:83], s[50:51], s[80:81]
    s_cbranch_scc1 L2_c34
L2_d34:
    v_mov_b64 v[84:85], v[68:69]
    v_mov_b32 v7, v94
    v_mov_b64 v[86:87], v[72:73]
    s_mov_b64 exec, -1
    s_or_b64 s[80:81], s[80:81], s[50:51]
    s_and_b64 exec, s[48:49], s[80:81]
    v_mfma_f32_4x4x4_16b_bf16 v[80:83], v[12:13], v[84:85], 0
    v_mov_b32 v93, v7
    s_andn2_b64 s[80:81], s[80:81], s[48:49]
    v_mfma_f32_4x4x4_16b_bf16 v[80:83], v[10:11], v[86:87], v[80:83]
    s_mov_b64 exec, -1
    ds_read_b64 v[70:71], v93 offset:65408
    ds_read_b64 v[68:69], v92 offset:65408
    v_bitop3_b32 v94, v24, v5, v99 bitop3:0xea
    v_bitop3_b32 v95, v25, v5, v46 bitop3:0xea
    v_perm_b32 v15, v25, v26, s47
    v_bitop3_b32 v46, v25, 0.5, -0.5 bitop3:0xa8
    v_perm_b32 v14, v24, v26, s46
    v_bitop3_b32 v47, v24, 0.5, -0.5 bitop3:0xa8
    v_bitop3_b32 v15, v6, v15, v46 bitop3:0xca
    v_bitop3_b32 v14, v6, v14, v47 bitop3:0xca
    s_waitcnt lgkmcnt(1)
    v_mfma_f32_4x4x4_16b_bf16 v[80:83], v[10:11], v[70:71], v[80:83]
    s_waitcnt lgkmcnt(0)
    v_mfma_f32_4x4x4_16b_bf16 v[76:79], v[10:11], v[68:69], v[76:79]
    s_nop 2
    v_cvt_pk_bf16_f32 v80, v80, v81
    v_cvt_pk_bf16_f32 v81, v82, v83
    ds_wrxchg_rtn_b64 v[74:75], v93, v[80:81] offset:65408
    v_cvt_pk_bf16_f32 v76, v76, v77
    v_cvt_pk_bf16_f32 v77, v78, v79
    ds_wrxchg_rtn_b64 v[72:73], v92, v[76:77] offset:65408
    v_and_b32 v88, 0x0fffffff, v27
    buffer_load_dwordx2 v[22:23], v88, s[8:11], 0 offen
    buffer_load_dwordx3 v[24:26], v88, s[8:11], 0 offen offset:8
    s_setprio 2
    v_mfma_f32_4x4x4_16b_bf16 v[80:83], v[8:9], v[106:107], 0
    v_mfma_f32_4x4x4_16b_bf16 v[76:79], v[8:9], v[104:105], 0
    s_nop 3
    v_pk_mul_f32 v[80:81], v[80:81], v[14:15] op_sel:[0,1] op_sel_hi:[1,1]
    v_pk_mul_f32 v[82:83], v[82:83], v[14:15] op_sel:[0,1] op_sel_hi:[1,1]
    v_pk_mul_f32 v[76:77], v[76:77], v[14:15] op_sel:[0,0] op_sel_hi:[1,0]
    v_pk_mul_f32 v[78:79], v[78:79], v[14:15] op_sel:[0,0] op_sel_hi:[1,0]
    s_waitcnt vmcnt(7)
    v_and_b32 v46, 0x20000000, v42
    v_lshrrev_b32 v47, 14, v29
    v_bitop3_b32 v47, v47, v5, v46 bitop3:0xea
    ds_read_b64 v[102:103], v47
    v_and_b32 v99, 0x10000000, v42
    v_lshrrev_b32 v47, 14, v28
    v_bitop3_b32 v47, v47, v5, v99 bitop3:0xea
    ds_read_b64 v[100:101], v47
    s_waitcnt lgkmcnt(2)
    v_cmp_ne_u64 s[50:51], v[72:73], v[68:69]
    v_cmpx_ne_u64 s[54:55], v[74:75], v[70:71]
    s_and_b64 s[82:83], s[54:55], s[80:81]
    s_cbranch_scc1 L2_c35
L2_d35:
    v_mov_b64 v[84:85], v[70:71]
    v_mov_b32 v7, v93
    v_mov_b64 v[86:87], v[74:75]
    s_or_b64 s[80:81], s[80:81], s[54:55]
    s_mov_b64 exec, s[50:51]
    s_and_b64 s[82:83], s[50:51], s[80:81]
    s_cbranch_scc1 L2_c36
L2_d36:
    v_mov_b64 v[84:85], v[68:69]
    v_mov_b32 v7, v92
    v_mov_b64 v[86:87], v[72:73]
    s_mov_b64 exec, -1
    s_or_b64 s[80:81], s[80:81], s[50:51]
    ds_read_b64 v[70:71], v95 offset:65408
    ds_read_b64 v[68:69], v94 offset:65408
    v_bitop3_b32 v92, v28, v5, v99 bitop3:0xea
    v_bitop3_b32 v93, v29, v5, v46 bitop3:0xea
    v_perm_b32 v15, v29, v32, s45
    v_bitop3_b32 v46, v29, 0.5, -0.5 bitop3:0xa8
    v_perm_b32 v14, v28, v32, s44
    v_bitop3_b32 v47, v28, 0.5, -0.5 bitop3:0xa8
    v_bitop3_b32 v15, v6, v15, v46 bitop3:0xca
    v_bitop3_b32 v14, v6, v14, v47 bitop3:0xca
    s_waitcnt lgkmcnt(1)
    v_mfma_f32_4x4x4_16b_bf16 v[80:83], v[10:11], v[70:71], v[80:83]
    s_waitcnt lgkmcnt(0)
    v_mfma_f32_4x4x4_16b_bf16 v[76:79], v[10:11], v[68:69], v[76:79]
    s_nop 2
    v_cvt_pk_bf16_f32 v80, v80, v81
    v_cvt_pk_bf16_f32 v81, v82, v83
    ds_wrxchg_rtn_b64 v[74:75], v95, v[80:81] offset:65408
    v_cvt_pk_bf16_f32 v76, v76, v77
    v_cvt_pk_bf16_f32 v77, v78, v79
    ds_wrxchg_rtn_b64 v[72:73], v94, v[76:77] offset:65408
    s_setprio 1
    v_mfma_f32_4x4x4_16b_bf16 v[80:83], v[8:9], v[102:103], 0
    v_mfma_f32_4x4x4_16b_bf16 v[76:79], v[8:9], v[100:101], 0
    v_cmp_lt_u32 s[84:85], v5, v92
    s_nop 2
    v_pk_mul_f32 v[80:81], v[80:81], v[14:15] op_sel:[0,1] op_sel_hi:[1,1]
    v_pk_mul_f32 v[82:83], v[82:83], v[14:15] op_sel:[0,1] op_sel_hi:[1,1]
    v_pk_mul_f32 v[76:77], v[76:77], v[14:15] op_sel:[0,0] op_sel_hi:[1,0]
    v_pk_mul_f32 v[78:79], v[78:79], v[14:15] op_sel:[0,0] op_sel_hi:[1,0]
    s_bitcmp1_b32 s43, s42
    s_cbranch_scc1 L2_oa37
L2_ob37:
    buffer_load_dwordx4 v[112:115], v3, s[16:19], s40 offen offset:1024 sc1
    v_sub_u16 v88, v62, v54
    v_and_b32 v89, 3, v54
    v_add3_u32 v99, v88, v89, 3
    v_and_b32 v99, -4, v99
    v_max_u32 v99, 4, v99
    v_and_b32 v97, 0xfffc, v54
    v_bfm_b32 v96, v88, v89
    v_add_u32_dpp v91, v99, v99 row_shr:1 row_mask:0xf bank_mask:0xf bound_ctrl:1
    v_mad_u32_u24 v97, v97, 5, v2
    v_cmp_lt_u32 vcc, 16, v99
    v_add_u32_dpp v91, v91, v91 row_shr:2 row_mask:0xf bank_mask:0xf bound_ctrl:1
    v_sub_u32 v98, s38, v99
    v_lshrrev_b64 v[54:55], 16, v[54:55]
    v_add_u32_dpp v91, v91, v91 row_shr:4 row_mask:0xf bank_mask:0xf bound_ctrl:1
    v_lshrrev_b64 v[62:63], 16, v[62:63]
    s_mov_b32 s101, 0
    v_add_u32_dpp v91, v91, v91 row_shr:8 row_mask:0xf bank_mask:0xf bound_ctrl:1
    s_nop 1
    v_add_u32_dpp v91, v91, v91 row_bcast:15 row_mask:0xa bank_mask:0xf
    s_nop 1
    v_add_u32_dpp v91, v91, v91 row_bcast:31 row_mask:0xc bank_mask:0xf
    v_add_u32 v98, v98, v91
    v_readlane_b32 s37, v91, 63
    s_cbranch_vccnz L2_xo38
L2_xp38:
    v_and_b32 v46, 0x80000000, v42
    v_lshrrev_b32 v47, 14, v31
    v_bitop3_b32 v47, v47, v5, v46 bitop3:0xea
    ds_read_b64 v[106:107], v47
    v_and_b32 v99, 0x40000000, v42
    v_lshrrev_b32 v47, 14, v30
    v_bitop3_b32 v47, v47, v5, v99 bitop3:0xea
    ds_read_b64 v[104:105], v47
    s_waitcnt lgkmcnt(2)
    v_cmp_ne_u64 s[50:51], v[72:73], v[68:69]
    v_cmpx_ne_u64 s[54:55], v[74:75], v[70:71]
    s_and_b64 s[82:83], s[54:55], s[80:81]
    s_cbranch_scc1 L2_c39
L2_d39:
    v_mov_b64 v[84:85], v[70:71]
    v_mov_b32 v7, v95
    v_mov_b64 v[86:87], v[74:75]
    s_or_b64 s[80:81], s[80:81], s[54:55]
    s_mov_b64 exec, s[50:51]
    s_and_b64 s[82:83], s[50:51], s[80:81]
    s_cbranch_scc1 L2_c40
L2_d40:
    v_mov_b64 v[84:85], v[68:69]
    v_mov_b32 v7, v94
    v_mov_b64 v[86:87], v[72:73]
    s_mov_b64 exec, -1
    s_or_b64 s[80:81], s[80:81], s[50:51]
    s_and_b64 exec, s[84:85], s[80:81]
    v_mfma_f32_4x4x4_16b_bf16 v[76:79], v[12:13], v[84:85], 0
    v_mov_b32 v92, v7
    s_andn2_b64 s[80:81], s[80:81], s[84:85]
    v_mfma_f32_4x4x4_16b_bf16 v[76:79], v[10:11], v[86:87], v[76:79]
    s_mov_b64 exec, -1
    ds_read_b64 v[70:71], v93 offset:65408
    ds_read_b64 v[68:69], v92 offset:65408
    v_bitop3_b32 v94, v30, v5, v99 bitop3:0xea
    v_bitop3_b32 v95, v31, v5, v46 bitop3:0xea
    v_perm_b32 v15, v31, v32, s47
    v_bitop3_b32 v46, v31, 0.5, -0.5 bitop3:0xa8
    v_perm_b32 v14, v30, v32, s46
    v_bitop3_b32 v47, v30, 0.5, -0.5 bitop3:0xa8
    v_bitop3_b32 v15, v6, v15, v46 bitop3:0xca
    v_bitop3_b32 v14, v6, v14, v47 bitop3:0xca
    s_waitcnt lgkmcnt(1)
    v_mfma_f32_4x4x4_16b_bf16 v[80:83], v[10:11], v[70:71], v[80:83]
    s_waitcnt lgkmcnt(0)
    v_mfma_f32_4x4x4_16b_bf16 v[76:79], v[10:11], v[68:69], v[76:79]
    s_nop 2
    v_cvt_pk_bf16_f32 v80, v80, v81
    v_cvt_pk_bf16_f32 v81, v82, v83
    ds_wrxchg_rtn_b64 v[74:75], v93, v[80:81] offset:65408
    v_cvt_pk_bf16_f32 v76, v76, v77
    v_cvt_pk_bf16_f32 v77, v78, v79
    ds_wrxchg_rtn_b64 v[72:73], v92, v[76:77] offset:65408
    v_and_b32 v88, 0x0fffffff, v33
    buffer_load_dwordx2 v[28:29], v88, s[8:11], 0 offen
    buffer_load_dwordx3 v[30:32], v88, s[8:11], 0 offen offset:8
    s_setprio 0
    v_mfma_f32_4x4x4_16b_bf16 v[80:83], v[8:9], v[106:107], 0
    v_mfma_f32_4x4x4_16b_bf16 v[76:79], v[8:9], v[104:105], 0
    v_cmp_lt_u32 s[48:49], v5, v95
    s_nop 2
    v_pk_mul_f32 v[80:81], v[80:81], v[14:15] op_sel:[0,1] op_sel_hi:[1,1]
    v_pk_mul_f32 v[82:83], v[82:83], v[14:15] op_sel:[0,1] op_sel_hi:[1,1]
    v_pk_mul_f32 v[76:77], v[76:77], v[14:15] op_sel:[0,0] op_sel_hi:[1,0]
    v_pk_mul_f32 v[78:79], v[78:79], v[14:15] op_sel:[0,0] op_sel_hi:[1,0]
    s_add_u32 s40, s40, 0x50000
    s_waitcnt vmcnt(8)
    v_and_b32 v46, 0x80000000, v43
    v_lshrrev_b32 v47, 14, v37
    v_bitop3_b32 v47, v47, v5, v46 bitop3:0xea
    ds_read_b64 v[106:107], v47
    v_and_b32 v99, 0x40000000, v43
    v_lshrrev_b32 v47, 14, v36
    v_bitop3_b32 v47, v47, v5, v99 bitop3:0xea
    ds_read_b64 v[104:105], v47
    v_and_b32 v46, 0x20000000, v43
    v_lshrrev_b32 v47, 14, v35
    v_bitop3_b32 v47, v47, v5, v46 bitop3:0xea
    ds_read_b64 v[102:103], v47
    v_and_b32 v99, 0x10000000, v43
    v_lshrrev_b32 v47, 14, v34
    v_bitop3_b32 v47, v47, v5, v99 bitop3:0xea
    ds_read_b64 v[100:101], v47
    s_waitcnt lgkmcnt(4)
    v_cmp_ne_u64 s[50:51], v[72:73], v[68:69]
    v_cmpx_ne_u64 s[54:55], v[74:75], v[70:71]
    s_and_b64 s[82:83], s[54:55], s[80:81]
    s_cbranch_scc1 L2_c41
L2_d41:
    v_mov_b64 v[84:85], v[70:71]
    v_mov_b32 v7, v93
    v_mov_b64 v[86:87], v[74:75]
    s_or_b64 s[80:81], s[80:81], s[54:55]
    s_mov_b64 exec, s[50:51]
    s_and_b64 s[82:83], s[50:51], s[80:81]
    s_cbranch_scc1 L2_c42
L2_d42:
    v_mov_b64 v[84:85], v[68:69]
    v_mov_b32 v7, v92
    v_mov_b64 v[86:87], v[72:73]
    s_mov_b64 exec, -1
    s_or_b64 s[80:81], s[80:81], s[50:51]
    s_and_b64 exec, s[48:49], s[80:81]
    v_mfma_f32_4x4x4_16b_bf16 v[80:83], v[12:13], v[84:85], 0
    v_mov_b32 v95, v7
    s_andn2_b64 s[80:81], s[80:81], s[48:49]
    v_mfma_f32_4x4x4_16b_bf16 v[80:83], v[10:11], v[86:87], v[80:83]
    s_mov_b64 exec, -1
    ds_read_b64 v[70:71], v95 offset:65408
    ds_read_b64 v[68:69], v94 offset:65408
    v_bitop3_b32 v92, v34, v5, v99 bitop3:0xea
    v_bitop3_b32 v93, v35, v5, v46 bitop3:0xea
    v_perm_b32 v15, v35, v38, s45
    v_bitop3_b32 v46, v35, 0.5, -0.5 bitop3:0xa8
    v_perm_b32 v14, v34, v38, s44
    v_bitop3_b32 v47, v34, 0.5, -0.5 bitop3:0xa8
    v_bitop3_b32 v15, v6, v15, v46 bitop3:0xca
    v_bitop3_b32 v14, v6, v14, v47 bitop3:0xca
    s_waitcnt lgkmcnt(1)
    v_mfma_f32_4x4x4_16b_bf16 v[80:83], v[10:11], v[70:71], v[80:83]
    s_waitcnt lgkmcnt(0)
    v_mfma_f32_4x4x4_16b_bf16 v[76:79], v[10:11], v[68:69], v[76:79]
    s_nop 2
    v_cvt_pk_bf16_f32 v80, v80, v81
    v_cvt_pk_bf16_f32 v81, v82, v83
    ds_wrxchg_rtn_b64 v[74:75], v95, v[80:81] offset:65408
    v_cvt_pk_bf16_f32 v76, v76, v77
    v_cvt_pk_bf16_f32 v77, v78, v79
    ds_wrxchg_rtn_b64 v[72:73], v94, v[76:77] offset:65408
    s_barrier
    s_setprio 3
    s_mov_b32 m0, s100
    s_nop 0
    ds_write_addtid_b32 v124 offset:34816
    ds_write_addtid_b32 v125 offset:35072
    ds_write_addtid_b32 v126 offset:35328
    ds_write_addtid_b32 v127 offset:35584
    s_add_u32 s3, s40, 4096
    buffer_load_dwordx4 v[124:127], v3, s[16:19], s3 offen sc1
    ds_write_addtid_b32 v116 offset:32768
    ds_write_addtid_b32 v117 offset:33024
    ds_write_addtid_b32 v118 offset:33280
    ds_write_addtid_b32 v119 offset:33536
    buffer_load_dwordx4 v[116:119], v3, s[16:19], s40 offen offset:2048 sc1
    ds_write_addtid_b32 v120 offset:33792
    ds_write_addtid_b32 v121 offset:34048
    ds_write_addtid_b32 v122 offset:34304
    ds_write_addtid_b32 v123 offset:34560
    buffer_load_dwordx4 v[120:123], v3, s[16:19], s40 offen offset:3072 sc1
    v_mfma_f32_4x4x4_16b_bf16 v[80:83], v[8:9], v[102:103], 0
    v_mfma_f32_4x4x4_16b_bf16 v[76:79], v[8:9], v[100:101], 0
    s_nop 3
    v_pk_mul_f32 v[80:81], v[80:81], v[14:15] op_sel:[0,1] op_sel_hi:[1,1]
    v_pk_mul_f32 v[82:83], v[82:83], v[14:15] op_sel:[0,1] op_sel_hi:[1,1]
    v_pk_mul_f32 v[76:77], v[76:77], v[14:15] op_sel:[0,0] op_sel_hi:[1,0]
    v_pk_mul_f32 v[78:79], v[78:79], v[14:15] op_sel:[0,0] op_sel_hi:[1,0]
    s_cmp_gt_u32 s37, 1024
    s_cbranch_scc1 L2_xs43
    s_cmp_lg_u32 s101, 0
    s_cbranch_scc1 L2_xa43
L2_xb43:
    v_lshlrev_b32 v89, 16, v96
    v_add_u32 v90, 60, v97
    v_bitop3_b32 v90, v89, v45, v90 bitop3:0x6a
    ds_write_b32 v98, v90 offset:12
    v_lshlrev_b32 v89, 20, v96
    v_add_u32 v90, 40, v97
    v_bitop3_b32 v90, v89, v45, v90 bitop3:0x6a
    ds_write_b32 v98, v90 offset:8
    v_lshlrev_b32 v89, 24, v96
    v_add_u32 v90, 20, v97
    v_bitop3_b32 v90, v89, v45, v90 bitop3:0x6a
    ds_write_b32 v98, v90 offset:4
    v_lshlrev_b32 v89, 28, v96
    v_bitop3_b32 v90, v89, v45, v97 bitop3:0x6a
    ds_write_b32 v98, v90 offset:0
    v_mov_b32_dpp v91, v66 quad_perm:[1,1,1,1] row_mask:0xf bank_mask:0xf
    v_and_b32 v89, 3, v91
    v_and_b32 v97, 0xfffc, v91
    v_sub_u16_dpp v88, v66, v91 quad_perm:[3,3,3,3] row_mask:0xf bank_mask:0xf
    v_mad_u32_u24 v97, v97, 5, v4
    v_add_u32 v99, v88, v89
    v_bfm_b32 v96, v88, v89
    v_cmp_lt_u32 s[58:59], 16, v99
    v_lshlrev_b32 v89, v1, v96
    v_and_b32 v89, v45, v89
    v_cmp_ne_u32 vcc, 0, v89
    v_xor_b32 v90, v97, v89
    s_add_u32 s3, s37, s38
    v_mbcnt_lo_u32_b32 v98, vcc_lo, 0
    v_mbcnt_hi_u32_b32 v98, vcc_hi, v98
    s_bcnt1_i32_b64 s41, vcc
    v_lshl_add_u32 v98, v98, 2, s3
    s_lshl2_add_u32 s37, s41, s37
    s_mov_b64 exec, vcc
    ds_write_b32 v98, v90
    s_mov_b64 exec, -1
    s_cmp_lg_u64 s[58:59], 0
    s_cbranch_scc1 L2_xe43
L2_xr43:
    v_add_u32 v98, s37, v0
    v_mov_b32 v90, -1
    ds_write_b32 v98, v90
L2_xw43:
    s_setprio 2
    s_waitcnt lgkmcnt(14)
    v_cmp_ne_u64 s[50:51], v[72:73], v[68:69]
    v_cmpx_ne_u64 s[54:55], v[74:75], v[70:71]
    s_and_b64 s[82:83], s[54:55], s[80:81]
    s_cbranch_scc1 L2_c44
L2_d44:
    v_mov_b64 v[84:85], v[70:71]
    v_mov_b32 v7, v95
    v_mov_b64 v[86:87], v[74:75]
    s_or_b64 s[80:81], s[80:81], s[54:55]
    s_mov_b64 exec, s[50:51]
    s_and_b64 s[82:83], s[50:51], s[80:81]
    s_cbranch_scc1 L2_c45
L2_d45:
    v_mov_b64 v[84:85], v[68:69]
    v_mov_b32 v7, v94
    v_mov_b64 v[86:87], v[72:73]
    s_mov_b64 exec, -1
    s_or_b64 s[80:81], s[80:81], s[50:51]
    ds_read_b64 v[70:71], v93 offset:65408
    ds_read_b64 v[68:69], v92 offset:65408
    v_and_b32 v46, 0x40000000, v43
    v_bitop3_b32 v94, v36, v5, v46 bitop3:0xea
    v_and_b32 v46, 0x80000000, v43
    v_bitop3_b32 v95, v37, v5, v46 bitop3:0xea
    v_perm_b32 v15, v37, v38, s47
    v_bitop3_b32 v46, v37, 0.5, -0.5 bitop3:0xa8
    v_perm_b32 v14, v36, v38, s46
    v_bitop3_b32 v47, v36, 0.5, -0.5 bitop3:0xa8
    v_bitop3_b32 v15, v6, v15, v46 bitop3:0xca
    v_bitop3_b32 v14, v6, v14, v47 bitop3:0xca
    s_setprio 1
    s_waitcnt lgkmcnt(1)
    v_mfma_f32_4x4x4_16b_bf16 v[80:83], v[10:11], v[70:71], v[80:83]
    s_waitcnt lgkmcnt(0)
    v_mfma_f32_4x4x4_16b_bf16 v[76:79], v[10:11], v[68:69], v[76:79]
    s_nop 2
    v_cvt_pk_bf16_f32 v80, v80, v81
    v_cvt_pk_bf16_f32 v81, v82, v83
    ds_wrxchg_rtn_b64 v[74:75], v93, v[80:81] offset:65408
    v_cvt_pk_bf16_f32 v76, v76, v77
    v_cvt_pk_bf16_f32 v77, v78, v79
    ds_wrxchg_rtn_b64 v[72:73], v92, v[76:77] offset:65408
    ds_read_b32 v40, v44 offset:768
    ds_read_b32 v41, v0 offset:0
    ds_read_b32 v42, v0 offset:256
    ds_read_b32 v43, v0 offset:512
    s_sub_u32 s3, s37, 768
    s_cmp_gt_u32 s3, 128
    s_cbranch_scc1 L2_xf43
L2_xg43:
    v_lshrrev_b64 v[64:65], 16, v[64:65]
    v_lshrrev_b64 v[66:67], 16, v[66:67]
    v_and_b32 v88, 0x0fffffff, v39
    buffer_load_dwordx2 v[34:35], v88, s[8:11], 0 offen
    buffer_load_dwordx3 v[36:38], v88, s[8:11], 0 offen offset:8
    s_setprio 0
    s_waitcnt vmcnt(10)
    s_mov_b32 m0, s38
    s_nop 0
    ds_write_addtid_b32 v108 offset:0
    ds_write_addtid_b32 v109 offset:256
    ds_write_addtid_b32 v110 offset:512
    ds_write_addtid_b32 v111 offset:768
    s_waitcnt vmcnt(7)
    ds_write_addtid_b32 v112 offset:1024
    ds_write_addtid_b32 v113 offset:1280
    ds_write_addtid_b32 v114 offset:1536
    ds_write_addtid_b32 v115 offset:1792
    v_mfma_f32_4x4x4_16b_bf16 v[80:83], v[8:9], v[106:107], 0
    v_mfma_f32_4x4x4_16b_bf16 v[76:79], v[8:9], v[104:105], 0
    v_cmp_lt_u32 s[84:85], v5, v94
    s_nop 2
    v_pk_mul_f32 v[80:81], v[80:81], v[14:15] op_sel:[0,1] op_sel_hi:[1,1]
    v_pk_mul_f32 v[82:83], v[82:83], v[14:15] op_sel:[0,1] op_sel_hi:[1,1]
    v_pk_mul_f32 v[76:77], v[76:77], v[14:15] op_sel:[0,0] op_sel_hi:[1,0]
    v_pk_mul_f32 v[78:79], v[78:79], v[14:15] op_sel:[0,0] op_sel_hi:[1,0]
    s_add_u32 s42, s42, 1
    s_waitcnt lgkmcnt(0)
L2_loop:
    s_barrier
    s_bitcmp1_b32 s36, s42
    s_cbranch_scc1 L2_slow
L2_ret2:
    s_setprio 3
    s_bitcmp1_b32 s43, s42
    s_cbranch_scc1 L2_oa46
L2_ob46:
    s_mov_b64 exec, s[6:7]
    v_lshrrev_b32 v18, 16, v18
    s_mov_b64 exec, -1
    v_and_b32 v46, 0x20000000, v19
    v_lshrrev_b32 v47, 14, v17
    v_bitop3_b32 v47, v47, v5, v46 bitop3:0xea
    ds_read_b64 v[102:103], v47
    v_and_b32 v99, 0x10000000, v19
    v_lshrrev_b32 v47, 14, v16
    v_bitop3_b32 v47, v47, v5, v99 bitop3:0xea
    ds_read_b64 v[100:101], v47
    v_cmp_ne_u64 s[50:51], v[72:73], v[68:69]
    v_cmpx_ne_u64 s[54:55], v[74:75], v[70:71]
    s_and_b64 s[82:83], s[54:55], s[80:81]
    s_cbranch_scc1 L2_c47
L2_d47:
    v_mov_b64 v[84:85], v[70:71]
    v_mov_b32 v7, v93
    v_mov_b64 v[86:87], v[74:75]
    s_or_b64 s[80:81], s[80:81], s[54:55]
    s_mov_b64 exec, s[50:51]
    s_and_b64 s[82:83], s[50:51], s[80:81]
    s_cbranch_scc1 L2_c48
L2_d48:
    v_mov_b64 v[84:85], v[68:69]
    v_mov_b32 v7, v92
    v_mov_b64 v[86:87], v[72:73]
    s_mov_b64 exec, -1
    s_or_b64 s[80:81], s[80:81], s[50:51]
    s_and_b64 exec, s[84:85], s[80:81]
    v_mfma_f32_4x4x4_16b_bf16 v[76:79], v[12:13], v[84:85], 0
    v_mov_b32 v94, v7
    s_andn2_b64 s[80:81], s[80:81], s[84:85]
    v_mfma_f32_4x4x4_16b_bf16 v[76:79], v[10:11], v[86:87], v[76:79]
    s_mov_b64 exec, -1
    ds_read_b64 v[70:71], v95 offset:65408
    ds_read_b64 v[68:69], v94 offset:65408
    v_bitop3_b32 v92, v16, v5, v99 bitop3:0xea
    v_bitop3_b32 v93, v17, v5, v46 bitop3:0xea
    v_perm_b32 v15, v17, v18, s45
    v_bitop3_b32 v46, v17, 0.5, -0.5 bitop3:0xa8
    v_perm_b32 v14, v16, v18, s44
    v_bitop3_b32 v47, v16, 0.5, -0.5 bitop3:0xa8
    v_bitop3_b32 v15, v6, v15, v46 bitop3:0xca
    v_bitop3_b32 v14, v6, v14, v47 bitop3:0xca
    s_waitcnt lgkmcnt(1)
    v_mfma_f32_4x4x4_16b_bf16 v[80:83], v[10:11], v[70:71], v[80:83]
    s_waitcnt lgkmcnt(0)
    v_mfma_f32_4x4x4_16b_bf16 v[76:79], v[10:11], v[68:69], v[76:79]
    s_nop 2
    v_cvt_pk_bf16_f32 v80, v80, v81
    v_cvt_pk_bf16_f32 v81, v82, v83
    ds_wrxchg_rtn_b64 v[74:75], v95, v[80:81] offset:65408
    v_cvt_pk_bf16_f32 v76, v76, v77
    v_cvt_pk_bf16_f32 v77, v78, v79
    ds_wrxchg_rtn_b64 v[72:73], v94, v[76:77] offset:65408
    v_mfma_f32_4x4x4_16b_bf16 v[80:83], v[8:9], v[102:103], 0
    v_mfma_f32_4x4x4_16b_bf16 v[76:79], v[8:9], v[100:101], 0
    v_cmp_lt_u32 s[84:85], v5, v92
    s_nop 2
    v_pk_mul_f32 v[80:81], v[80:81], v[14:15] op_sel:[0,1] op_sel_hi:[1,1]
    v_pk_mul_f32 v[82:83], v[82:83], v[14:15] op_sel:[0,1] op_sel_hi:[1,1]
    v_pk_mul_f32 v[76:77], v[76:77], v[14:15] op_sel:[0,0] op_sel_hi:[1,0]
    v_pk_mul_f32 v[78:79], v[78:79], v[14:15] op_sel:[0,0] op_sel_hi:[1,0]
    v_and_b32 v47, 0x0fffffff, v40
    buffer_load_dword v18, v47, s[8:11], 0 offen offset:16
    s_mov_b64 exec, s[6:7]
    v_add_u32 v47, 8, v47
    v_lshrrev_b32 v40, 2, v40
    s_mov_b64 exec, -1
    buffer_load_dwordx2 v[16:17], v47, s[8:11], 0 offen
    v_and_b32 v46, 0x20000000, v27
    v_lshrrev_b32 v47, 14, v23
    v_bitop3_b32 v47, v47, v5, v46 bitop3:0xea
    ds_read_b64 v[106:107], v47
    v_and_b32 v99, 0x10000000, v27
    v_lshrrev_b32 v47, 14, v22
    v_bitop3_b32 v47, v47, v5, v99 bitop3:0xea
    ds_read_b64 v[104:105], v47
    s_waitcnt lgkmcnt(2)
    v_cmp_ne_u64 s[50:51], v[72:73], v[68:69]
    v_cmpx_ne_u64 s[54:55], v[74:75], v[70:71]
    s_and_b64 s[82:83], s[54:55], s[80:81]
    s_cbranch_scc1 L2_c49
L2_d49:
    v_mov_b64 v[84:85], v[70:71]
    v_mov_b32 v7, v95
    v_mov_b64 v[86:87], v[74:75]
    s_or_b64 s[80:81], s[80:81], s[54:55]
    s_mov_b64 exec, s[50:51]
    s_and_b64 s[82:83], s[50:51], s[80:81]
    s_cbranch_scc1 L2_c50
L2_d50:
    v_mov_b64 v[84:85], v[68:69]
    v_mov_b32 v7, v94
    v_mov_b64 v[86:87], v[72:73]
    s_mov_b64 exec, -1
    s_or_b64 s[80:81], s[80:81], s[50:51]
    s_and_b64 exec, s[84:85], s[80:81]
    v_mfma_f32_4x4x4_16b_bf16 v[76:79], v[12:13], v[84:85], 0
    v_mov_b32 v92, v7
    s_andn2_b64 s[80:81], s[80:81], s[84:85]
    v_mfma_f32_4x4x4_16b_bf16 v[76:79], v[10:11], v[86:87], v[76:79]
    s_mov_b64 exec, -1
    ds_read_b64 v[70:71], v93 offset:65408
    ds_read_b64 v[68:69], v92 offset:65408
    v_bitop3_b32 v94, v22, v5, v99 bitop3:0xea
    v_bitop3_b32 v95, v23, v5, v46 bitop3:0xea
    v_perm_b32 v15, v23, v26, s45
    v_bitop3_b32 v46, v23, 0.5, -0.5 bitop3:0xa8
    v_perm_b32 v14, v22, v26, s44
    v_bitop3_b32 v47, v22, 0.5, -0.5 bitop3:0xa8
    v_bitop3_b32 v15, v6, v15, v46 bitop3:0xca
    v_bitop3_b32 v14, v6, v14, v47 bitop3:0xca
    s_waitcnt lgkmcnt(1)
    v_mfma_f32_4x4x4_16b_bf16 v[80:83], v[10:11], v[70:71], v[80:83]
    s_waitcnt lgkmcnt(0)
    v_mfma_f32_4x4x4_16b_bf16 v[76:79], v[10:11], v[68:69], v[76:79]
    s_nop 2
    v_cvt_pk_bf16_f32 v80, v80, v81
    v_cvt_pk_bf16_f32 v81, v82, v83
    ds_wrxchg_rtn_b64 v[74:75], v93, v[80:81] offset:65408
    v_cvt_pk_bf16_f32 v76, v76, v77
    v_cvt_pk_bf16_f32 v77, v78, v79
    ds_wrxchg_rtn_b64 v[72:73], v92, v[76:77] offset:65408
    v_mfma_f32_4x4x4_16b_bf16 v[80:83], v[8:9], v[106:107], 0
    v_mfma_f32_4x4x4_16b_bf16 v[76:79], v[8:9], v[104:105], 0
    v_cmp_lt_u32 s[48:49], v5, v95
    s_nop 2
    v_pk_mul_f32 v[80:81], v[80:81], v[14:15] op_sel:[0,1] op_sel_hi:[1,1]
    v_pk_mul_f32 v[82:83], v[82:83], v[14:15] op_sel:[0,1] op_sel_hi:[1,1]
    v_pk_mul_f32 v[76:77], v[76:77], v[14:15] op_sel:[0,0] op_sel_hi:[1,0]
    v_pk_mul_f32 v[78:79], v[78:79], v[14:15] op_sel:[0,0] op_sel_hi:[1,0]
    buffer_load_dwordx4 v[108:111], v3, s[16:19], s40 offen offset:0 sc1
    v_and_b32 v46, 0x80000000, v27
    v_lshrrev_b32 v47, 14, v25
    v_bitop3_b32 v47, v47, v5, v46 bitop3:0xea
    ds_read_b64 v[102:103], v47
    v_and_b32 v99, 0x40000000, v27
    v_lshrrev_b32 v47, 14, v24
    v_bitop3_b32 v47, v47, v5, v99 bitop3:0xea
    ds_read_b64 v[100:101], v47
    s_waitcnt lgkmcnt(2)
    v_cmp_ne_u64 s[50:51], v[72:73], v[68:69]
    v_cmpx_ne_u64 s[54:55], v[74:75], v[70:71]
    s_and_b64 s[82:83], s[54:55], s[80:81]
    s_cbranch_scc1 L2_c51
L2_d51:
    v_mov_b64 v[84:85], v[70:71]
    v_mov_b32 v7, v93
    v_mov_b64 v[86:87], v[74:75]
    s_or_b64 s[80:81], s[80:81], s[54:55]
    s_mov_b64 exec, s[50:51]
    s_and_b64 s[82:83], s[50:51], s[80:81]
    s_cbranch_scc1 L2_c52
L2_d52:
    v_mov_b64 v[84:85], v[68:69]
    v_mov_b32 v7, v92
    v_mov_b64 v[86:87], v[72:73]
    s_mov_b64 exec, -1
    s_or_b64 s[80:81], s[80:81], s[50:51]
    s_and_b64 exec, s[48:49], s[80:81]
    v_mfma_f32_4x4x4_16b_bf16 v[80:83], v[12:13], v[84:85], 0
    v_mov_b32 v95, v7
    s_andn2_b64 s[80:81], s[80:81], s[48:49]
    v_mfma_f32_4x4x4_16b_bf16 v[80:83], v[10:11], v[86:87], v[80:83]
    s_mov_b64 exec, -1
    ds_read_b64 v[70:71], v95 offset:65408
    ds_read_b64 v[68:69], v94 offset:65408
    v_bitop3_b32 v92, v24, v5, v99 bitop3:0xea
    v_bitop3_b32 v93, v25, v5, v46 bitop3:0xea
    v_perm_b32 v15, v25, v26, s47
    v_bitop3_b32 v46, v25, 0.5, -0.5 bitop3:0xa8
    v_perm_b32 v14, v24, v26, s46
    v_bitop3_b32 v47, v24, 0.5, -0.5 bitop3:0xa8
    v_bitop3_b32 v15, v6, v15, v46 bitop3:0xca
    v_bitop3_b32 v14, v6, v14, v47 bitop3:0xca
    s_waitcnt lgkmcnt(1)
    v_mfma_f32_4x4x4_16b_bf16 v[80:83], v[10:11], v[70:71], v[80:83]
    s_waitcnt lgkmcnt(0)
    v_mfma_f32_4x4x4_16b_bf16 v[76:79], v[10:11], v[68:69], v[76:79]
    s_nop 2
    v_cvt_pk_bf16_f32 v80, v80, v81
    v_cvt_pk_bf16_f32 v81, v82, v83
    ds_wrxchg_rtn_b64 v[74:75], v95, v[80:81] offset:65408
    v_cvt_pk_bf16_f32 v76, v76, v77
    v_cvt_pk_bf16_f32 v77, v78, v79
    ds_wrxchg_rtn_b64 v[72:73], v94, v[76:77] offset:65408
    v_and_b32 v88, 0x0fffffff, v41
    buffer_load_dwordx2 v[22:23], v88, s[8:11], 0 offen
    buffer_load_dwordx3 v[24:26], v88, s[8:11], 0 offen offset:8
    s_setprio 2
    v_mfma_f32_4x4x4_16b_bf16 v[80:83], v[8:9], v[102:103], 0
    v_mfma_f32_4x4x4_16b_bf16 v[76:79], v[8:9], v[100:101], 0
    s_nop 3
    v_pk_mul_f32 v[80:81], v[80:81], v[14:15] op_sel:[0,1] op_sel_hi:[1,1]
    v_pk_mul_f32 v[82:83], v[82:83], v[14:15] op_sel:[0,1] op_sel_hi:[1,1]
    v_pk_mul_f32 v[76:77], v[76:77], v[14:15] op_sel:[0,0] op_sel_hi:[1,0]
    v_pk_mul_f32 v[78:79], v[78:79], v[14:15] op_sel:[0,0] op_sel_hi:[1,0]
    s_waitcnt vmcnt(10)
    v_and_b32 v46, 0x20000000, v33
    v_lshrrev_b32 v47, 14, v29
    v_bitop3_b32 v47, v47, v5, v46 bitop3:0xea
    ds_read_b64 v[106:107], v47
    v_and_b32 v99, 0x10000000, v33
    v_lshrrev_b32 v47, 14, v28
    v_bitop3_b32 v47, v47, v5, v99 bitop3:0xea
    ds_read_b64 v[104:105], v47
    s_waitcnt lgkmcnt(2)
    v_cmp_ne_u64 s[50:51], v[72:73], v[68:69]
    v_cmpx_ne_u64 s[54:55], v[74:75], v[70:71]
    s_and_b64 s[82:83], s[54:55], s[80:81]
    s_cbranch_scc1 L2_c53
L2_d53:
    v_mov_b64 v[84:85], v[70:71]
    v_mov_b32 v7, v95
    v_mov_b64 v[86:87], v[74:75]
    s_or_b64 s[80:81], s[80:81], s[54:55]
    s_mov_b64 exec, s[50:51]
    s_and_b64 s[82:83], s[50:51], s[80:81]
    s_cbranch_scc1 L2_c54
L2_d54:
    v_mov_b64 v[84:85], v[68:69]
    v_mov_b32 v7, v94
    v_mov_b64 v[86:87], v[72:73]
    s_mov_b64 exec, -1
    s_or_b64 s[80:81], s[80:81], s[50:51]
    ds_read_b64 v[70:71], v93 offset:65408
    ds_read_b64 v[68:69], v92 offset:65408
    v_bitop3_b32 v94, v28, v5, v99 bitop3:0xea
    v_bitop3_b32 v95, v29, v5, v46 bitop3:0xea
    v_perm_b32 v15, v29, v32, s45
    v_bitop3_b32 v46, v29, 0.5, -0.5 bitop3:0xa8
    v_perm_b32 v14, v28, v32, s44
    v_bitop3_b32 v47, v28, 0.5, -0.5 bitop3:0xa8
    v_bitop3_b32 v15, v6, v15, v46 bitop3:0xca
    v_bitop3_b32 v14, v6, v14, v47 bitop3:0xca
    s_waitcnt lgkmcnt(1)
    v_mfma_f32_4x4x4_16b_bf16 v[80:83], v[10:11], v[70:71], v[80:83]
    s_waitcnt lgkmcnt(0)
    v_mfma_f32_4x4x4_16b_bf16 v[76:79], v[10:11], v[68:69], v[76:79]
    s_nop 2
    v_cvt_pk_bf16_f32 v80, v80, v81
    v_cvt_pk_bf16_f32 v81, v82, v83
    ds_wrxchg_rtn_b64 v[74:75], v93, v[80:81] offset:65408
    v_cvt_pk_bf16_f32 v76, v76, v77
    v_cvt_pk_bf16_f32 v77, v78, v79
    ds_wrxchg_rtn_b64 v[72:73], v92, v[76:77] offset:65408
    s_setprio 1
    v_mfma_f32_4x4x4_16b_bf16 v[80:83], v[8:9], v[106:107], 0
    v_mfma_f32_4x4x4_16b_bf16 v[76:79], v[8:9], v[104:105], 0
    v_cmp_lt_u32 s[84:85], v5, v94
    s_nop 2
    v_pk_mul_f32 v[80:81], v[80:81], v[14:15] op_sel:[0,1] op_sel_hi:[1,1]
    v_pk_mul_f32 v[82:83], v[82:83], v[14:15] op_sel:[0,1] op_sel_hi:[1,1]
    v_pk_mul_f32 v[76:77], v[76:77], v[14:15] op_sel:[0,0] op_sel_hi:[1,0]
    v_pk_mul_f32 v[78:79], v[78:79], v[14:15] op_sel:[0,0] op_sel_hi:[1,0]
    s_bitcmp1_b32 s43, s42
    s_cbranch_scc1 L2_oa55
L2_ob55:
    buffer_load_dwordx4 v[112:115], v3, s[16:19], s40 offen offset:1024 sc1
    v_sub_u16 v88, v56, v48
    v_and_b32 v89, 3, v48
    v_add3_u32 v99, v88, v89, 3
    v_and_b32 v99, -4, v99
    v_max_u32 v99, 4, v99
    v_and_b32 v97, 0xfffc, v48
    v_bfm_b32 v96, v88, v89
    v_add_u32_dpp v91, v99, v99 row_shr:1 row_mask:0xf bank_mask:0xf bound_ctrl:1
    v_mad_u32_u24 v97, v97, 5, v2
    v_cmp_lt_u32 vcc, 16, v99
    v_add_u32_dpp v91, v91, v91 row_shr:2 row_mask:0xf bank_mask:0xf bound_ctrl:1
    v_sub_u32 v98, s38, v99
    v_lshrrev_b64 v[48:49], 16, v[48:49]
    v_add_u32_dpp v91, v91, v91 row_shr:4 row_mask:0xf bank_mask:0xf bound_ctrl:1
    v_lshrrev_b64 v[56:57], 16, v[56:57]
    s_mov_b32 s101, 0
    v_add_u32_dpp v91, v91, v91 row_shr:8 row_mask:0xf bank_mask:0xf bound_ctrl:1
    s_nop 1
    v_add_u32_dpp v91, v91, v91 row_bcast:15 row_mask:0xa bank_mask:0xf
    s_nop 1
    v_add_u32_dpp v91, v91, v91 row_bcast:31 row_mask:0xc bank_mask:0xf
    v_add_u32 v98, v98, v91
    v_readlane_b32 s37, v91, 63
    s_cbranch_vccnz L2_xo56
L2_xp56:
    v_and_b32 v46, 0x80000000, v33
    v_lshrrev_b32 v47, 14, v31
    v_bitop3_b32 v47, v47, v5, v46 bitop3:0xea
    ds_read_b64 v[102:103], v47
    v_and_b32 v99, 0x40000000, v33
    v_lshrrev_b32 v47, 14, v30
    v_bitop3_b32 v47, v47, v5, v99 bitop3:0xea
    ds_read_b64 v[100:101], v47
    s_waitcnt lgkmcnt(2)
    v_cmp_ne_u64 s[50:51], v[72:73], v[68:69]
    v_cmpx_ne_u64 s[54:55], v[74:75], v[70:71]
    s_and_b64 s[82:83], s[54:55], s[80:81]
    s_cbranch_scc1 L2_c57
L2_d57:
    v_mov_b64 v[84:85], v[70:71]
    v_mov_b32 v7, v93
    v_mov_b64 v[86:87], v[74:75]
    s_or_b64 s[80:81], s[80:81], s[54:55]
    s_mov_b64 exec, s[50:51]
    s_and_b64 s[82:83], s[50:51], s[80:81]
    s_cbranch_scc1 L2_c58
L2_d58:
    v_mov_b64 v[84:85], v[68:69]
    v_mov_b32 v7, v92
    v_mov_b64 v[86:87], v[72:73]
    s_mov_b64 exec, -1
    s_or_b64 s[80:81], s[80:81], s[50:51]
    s_and_b64 exec, s[84:85], s[80:81]
    v_mfma_f32_4x4x4_16b_bf16 v[76:79], v[12:13], v[84:85], 0
    v_mov_b32 v94, v7
    s_andn2_b64 s[80:81], s[80:81], s[84:85]
    v_mfma_f32_4x4x4_16b_bf16 v[76:79], v[10:11], v[86:87], v[76:79]
    s_mov_b64 exec, -1
    ds_read_b64 v[70:71], v95 offset:65408
    ds_read_b64 v[68:69], v94 offset:65408
    v_bitop3_b32 v92, v30, v5, v99 bitop3:0xea
    v_bitop3_b32 v93, v31, v5, v46 bitop3:0xea
    v_perm_b32 v15, v31, v32, s47
    v_bitop3_b32 v46, v31, 0.5, -0.5 bitop3:0xa8
    v_perm_b32 v14, v30, v32, s46
    v_bitop3_b32 v47, v30, 0.5, -0.5 bitop3:0xa8
    v_bitop3_b32 v15, v6, v15, v46 bitop3:0xca
    v_bitop3_b32 v14, v6, v14, v47 bitop3:0xca
    s_waitcnt lgkmcnt(1)
    v_mfma_f32_4x4x4_16b_bf16 v[80:83], v[10:11], v[70:71], v[80:83]
    s_waitcnt lgkmcnt(0)
    v_mfma_f32_4x4x4_16b_bf16 v[76:79], v[10:11], v[68:69], v[76:79]
    s_nop 2
    v_cvt_pk_bf16_f32 v80, v80, v81
    v_cvt_pk_bf16_f32 v81, v82, v83
    ds_wrxchg_rtn_b64 v[74:75], v95, v[80:81] offset:65408
    v_cvt_pk_bf16_f32 v76, v76, v77
    v_cvt_pk_bf16_f32 v77, v78, v79
    ds_wrxchg_rtn_b64 v[72:73], v94, v[76:77] offset:65408
    v_and_b32 v88, 0x0fffffff, v42
    buffer_load_dwordx2 v[28:29], v88, s[8:11], 0 offen
    buffer_load_dwordx3 v[30:32], v88, s[8:11], 0 offen offset:8
    s_setprio 0
    v_mfma_f32_4x4x4_16b_bf16 v[80:83], v[8:9], v[102:103], 0
    v_mfma_f32_4x4x4_16b_bf16 v[76:79], v[8:9], v[100:101], 0
    v_cmp_lt_u32 s[48:49], v5, v93
    s_nop 2
    v_pk_mul_f32 v[80:81], v[80:81], v[14:15] op_sel:[0,1] op_sel_hi:[1,1]
    v_pk_mul_f32 v[82:83], v[82:83], v[14:15] op_sel:[0,1] op_sel_hi:[1,1]
    v_pk_mul_f32 v[76:77], v[76:77], v[14:15] op_sel:[0,0] op_sel_hi:[1,0]
    v_pk_mul_f32 v[78:79], v[78:79], v[14:15] op_sel:[0,0] op_sel_hi:[1,0]
    s_add_u32 s40, s40, 0xfff24000
    s_waitcnt vmcnt(8)
    v_and_b32 v46, 0x80000000, v39
    v_lshrrev_b32 v47, 14, v37
    v_bitop3_b32 v47, v47, v5, v46 bitop3:0xea
    ds_read_b64 v[102:103], v47
    v_and_b32 v99, 0x40000000, v39
    v_lshrrev_b32 v47, 14, v36
    v_bitop3_b32 v47, v47, v5, v99 bitop3:0xea
    ds_read_b64 v[100:101], v47
    v_and_b32 v46, 0x20000000, v39
    v_lshrrev_b32 v47, 14, v35
    v_bitop3_b32 v47, v47, v5, v46 bitop3:0xea
    ds_read_b64 v[106:107], v47
    v_and_b32 v99, 0x10000000, v39
    v_lshrrev_b32 v47, 14, v34
    v_bitop3_b32 v47, v47, v5, v99 bitop3:0xea
    ds_read_b64 v[104:105], v47
    s_waitcnt lgkmcnt(4)
    v_cmp_ne_u64 s[50:51], v[72:73], v[68:69]
    v_cmpx_ne_u64 s[54:55], v[74:75], v[70:71]
    s_and_b64 s[82:83], s[54:55], s[80:81]
    s_cbranch_scc1 L2_c59
L2_d59:
    v_mov_b64 v[84:85], v[70:71]
    v_mov_b32 v7, v95
    v_mov_b64 v[86:87], v[74:75]
    s_or_b64 s[80:81], s[80:81], s[54:55]
    s_mov_b64 exec, s[50:51]
    s_and_b64 s[82:83], s[50:51], s[80:81]
    s_cbranch_scc1 L2_c60
L2_d60:
    v_mov_b64 v[84:85], v[68:69]
    v_mov_b32 v7, v94
    v_mov_b64 v[86:87], v[72:73]
    s_mov_b64 exec, -1
    s_or_b64 s[80:81], s[80:81], s[50:51]
    s_and_b64 exec, s[48:49], s[80:81]
    v_mfma_f32_4x4x4_16b_bf16 v[80:83], v[12:13], v[84:85], 0
    v_mov_b32 v93, v7
    s_andn2_b64 s[80:81], s[80:81], s[48:49]
    v_mfma_f32_4x4x4_16b_bf16 v[80:83], v[10:11], v[86:87], v[80:83]
    s_mov_b64 exec, -1
    ds_read_b64 v[70:71], v93 offset:65408
    ds_read_b64 v[68:69], v92 offset:65408
    v_bitop3_b32 v94, v34, v5, v99 bitop3:0xea
    v_bitop3_b32 v95, v35, v5, v46 bitop3:0xea
    v_perm_b32 v15, v35, v38, s45
    v_bitop3_b32 v46, v35, 0.5, -0.5 bitop3:0xa8
    v_perm_b32 v14, v34, v38, s44
    v_bitop3_b32 v47, v34, 0.5, -0.5 bitop3:0xa8
    v_bitop3_b32 v15, v6, v15, v46 bitop3:0xca
    v_bitop3_b32 v14, v6, v14, v47 bitop3:0xca
    s_waitcnt lgkmcnt(1)
    v_mfma_f32_4x4x4_16b_bf16 v[80:83], v[10:11], v[70:71], v[80:83]
    s_waitcnt lgkmcnt(0)
    v_mfma_f32_4x4x4_16b_bf16 v[76:79], v[10:11], v[68:69], v[76:79]
    s_nop 2
    v_cvt_pk_bf16_f32 v80, v80, v81
    v_cvt_pk_bf16_f32 v81, v82, v83
    ds_wrxchg_rtn_b64 v[74:75], v93, v[80:81] offset:65408
    v_cvt_pk_bf16_f32 v76, v76, v77
    v_cvt_pk_bf16_f32 v77, v78, v79
    ds_wrxchg_rtn_b64 v[72:73], v92, v[76:77] offset:65408
    s_barrier
    s_setprio 3
    s_mov_b32 m0, s100
    s_nop 0
    ds_write_addtid_b32 v124 offset:34816
    ds_write_addtid_b32 v125 offset:35072
    ds_write_addtid_b32 v126 offset:35328
    ds_write_addtid_b32 v127 offset:35584
    s_add_u32 s3, s40, 4096
    buffer_load_dwordx4 v[124:127], v3, s[16:19], s3 offen sc1
    ds_write_addtid_b32 v116 offset:32768
    ds_write_addtid_b32 v117 offset:33024
    ds_write_addtid_b32 v118 offset:33280
    ds_write_addtid_b32 v119 offset:33536
    buffer_load_dwordx4 v[116:119], v3, s[16:19], s40 offen offset:2048 sc1
    ds_write_addtid_b32 v120 offset:33792
    ds_write_addtid_b32 v121 offset:34048
    ds_write_addtid_b32 v122 offset:34304
    ds_write_addtid_b32 v123 offset:34560
    buffer_load_dwordx4 v[120:123], v3, s[16:19], s40 offen offset:3072 sc1
    v_mfma_f32_4x4x4_16b_bf16 v[80:83], v[8:9], v[106:107], 0
    v_mfma_f32_4x4x4_16b_bf16 v[76:79], v[8:9], v[104:105], 0
    s_nop 3
    v_pk_mul_f32 v[80:81], v[80:81], v[14:15] op_sel:[0,1] op_sel_hi:[1,1]
    v_pk_mul_f32 v[82:83], v[82:83], v[14:15] op_sel:[0,1] op_sel_hi:[1,1]
    v_pk_mul_f32 v[76:77], v[76:77], v[14:15] op_sel:[0,0] op_sel_hi:[1,0]
    v_pk_mul_f32 v[78:79], v[78:79], v[14:15] op_sel:[0,0] op_sel_hi:[1,0]
    s_cmp_gt_u32 s37, 1024
    s_cbranch_scc1 L2_xs61
    s_cmp_lg_u32 s101, 0
    s_cbranch_scc1 L2_xa61
L2_xb61:
    v_lshlrev_b32 v89, 16, v96
    v_add_u32 v90, 60, v97
    v_bitop3_b32 v90, v89, v45, v90 bitop3:0x6a
    ds_write_b32 v98, v90 offset:12
    v_lshlrev_b32 v89, 20, v96
    v_add_u32 v90, 40, v97
    v_bitop3_b32 v90, v89, v45, v90 bitop3:0x6a
    ds_write_b32 v98, v90 offset:8
    v_lshlrev_b32 v89, 24, v96
    v_add_u32 v90, 20, v97
    v_bitop3_b32 v90, v89, v45, v90 bitop3:0x6a
    ds_write_b32 v98, v90 offset:4
    v_lshlrev_b32 v89, 28, v96
    v_bitop3_b32 v90, v89, v45, v97 bitop3:0x6a
    ds_write_b32 v98, v90 offset:0
    v_mov_b32_dpp v91, v64 quad_perm:[0,0,0,0] row_mask:0xf bank_mask:0xf
    v_and_b32 v89, 3, v91
    v_and_b32 v97, 0xfffc, v91
    v_sub_u16_dpp v88, v64, v91 quad_perm:[2,2,2,2] row_mask:0xf bank_mask:0xf
    v_mad_u32_u24 v97, v97, 5, v4
    v_add_u32 v99, v88, v89
    v_bfm_b32 v96, v88, v89
    v_cmp_lt_u32 s[58:59], 16, v99
    v_lshlrev_b32 v89, v1, v96
    v_and_b32 v89, v45, v89
    v_cmp_ne_u32 vcc, 0, v89
    v_xor_b32 v90, v97, v89
    s_add_u32 s3, s37, s38
    v_mbcnt_lo_u32_b32 v98, vcc_lo, 0
    v_mbcnt_hi_u32_b32 v98, vcc_hi, v98
    s_bcnt1_i32_b64 s41, vcc
    v_lshl_add_u32 v98, v98, 2, s3
    s_lshl2_add_u32 s37, s41, s37
    s_mov_b64 exec, vcc
    ds_write_b32 v98, v90
    s_mov_b64 exec, -1
    s_cmp_lg_u64 s[58:59], 0
    s_cbranch_scc1 L2_xe61
L2_xr61:
    v_add_u32 v98, s37, v0
    v_mov_b32 v90, -1
    ds_write_b32 v98, v90
L2_xw61:
    s_setprio 2
    s_waitcnt lgkmcnt(14)
    v_cmp_ne_u64 s[50:51], v[72:73], v[68:69]
    v_cmpx_ne_u64 s[54:55], v[74:75], v[70:71]
    s_and_b64 s[82:83], s[54:55], s[80:81]
    s_cbranch_scc1 L2_c62
L2_d62:
    v_mov_b64 v[84:85], v[70:71]
    v_mov_b32 v7, v93
    v_mov_b64 v[86:87], v[74:75]
    s_or_b64 s[80:81], s[80:81], s[54:55]
    s_mov_b64 exec, s[50:51]
    s_and_b64 s[82:83], s[50:51], s[80:81]
    s_cbranch_scc1 L2_c63
L2_d63:
    v_mov_b64 v[84:85], v[68:69]
    v_mov_b32 v7, v92
    v_mov_b64 v[86:87], v[72:73]
    s_mov_b64 exec, -1
    s_or_b64 s[80:81], s[80:81], s[50:51]
    ds_read_b64 v[70:71], v95 offset:65408
    ds_read_b64 v[68:69], v94 offset:65408
    v_and_b32 v46, 0x40000000, v39
    v_bitop3_b32 v92, v36, v5, v46 bitop3:0xea
    v_and_b32 v46, 0x80000000, v39
    v_bitop3_b32 v93, v37, v5, v46 bitop3:0xea
    v_perm_b32 v15, v37, v38, s47
    v_bitop3_b32 v46, v37, 0.5, -0.5 bitop3:0xa8
    v_perm_b32 v14, v36, v38, s46
    v_bitop3_b32 v47, v36, 0.5, -0.5 bitop3:0xa8
    v_bitop3_b32 v15, v6, v15, v46 bitop3:0xca
    v_bitop3_b32 v14, v6, v14, v47 bitop3:0xca
    s_setprio 1
    s_waitcnt lgkmcnt(1)
    v_mfma_f32_4x4x4_16b_bf16 v[80:83], v[10:11], v[70:71], v[80:83]
    s_waitcnt lgkmcnt(0)
    v_mfma_f32_4x4x4_16b_bf16 v[76:79], v[10:11], v[68:69], v[76:79]
    s_nop 2
    v_cvt_pk_bf16_f32 v80, v80, v81
    v_cvt_pk_bf16_f32 v81, v82, v83
    ds_wrxchg_rtn_b64 v[74:75], v95, v[80:81] offset:65408
    v_cvt_pk_bf16_f32 v76, v76, v77
    v_cvt_pk_bf16_f32 v77, v78, v79
    ds_wrxchg_rtn_b64 v[72:73], v94, v[76:77] offset:65408
    ds_read_b32 v19, v44 offset:768
    ds_read_b32 v27, v0 offset:0
    ds_read_b32 v33, v0 offset:256
    ds_read_b32 v39, v0 offset:512
    s_sub_u32 s3, s37, 768
    s_cmp_gt_u32 s3, 128
    s_cbranch_scc1 L2_xf61
L2_xg61:
    v_and_b32 v88, 0x0fffffff, v43
    buffer_load_dwordx2 v[34:35], v88, s[8:11], 0 offen
    buffer_load_dwordx3 v[36:38], v88, s[8:11], 0 offen offset:8
    s_setprio 0
    s_waitcnt vmcnt(10)
    s_mov_b32 m0, s38
    s_nop 0
    ds_write_addtid_b32 v108 offset:0
    ds_write_addtid_b32 v109 offset:256
    ds_write_addtid_b32 v110 offset:512
    ds_write_addtid_b32 v111 offset:768
    s_waitcnt vmcnt(7)
    ds_write_addtid_b32 v112 offset:1024
    ds_write_addtid_b32 v113 offset:1280
    ds_write_addtid_b32 v114 offset:1536
    ds_write_addtid_b32 v115 offset:1792
    v_mfma_f32_4x4x4_16b_bf16 v[80:83], v[8:9], v[102:103], 0
    v_mfma_f32_4x4x4_16b_bf16 v[76:79], v[8:9], v[100:101], 0
    v_cmp_lt_u32 s[84:85], v5, v92
    s_nop 2
    v_pk_mul_f32 v[80:81], v[80:81], v[14:15] op_sel:[0,1] op_sel_hi:[1,1]
    v_pk_mul_f32 v[82:83], v[82:83], v[14:15] op_sel:[0,1] op_sel_hi:[1,1]
    v_pk_mul_f32 v[76:77], v[76:77], v[14:15] op_sel:[0,0] op_sel_hi:[1,0]
    v_pk_mul_f32 v[78:79], v[78:79], v[14:15] op_sel:[0,0] op_sel_hi:[1,0]
    s_add_u32 s42, s42, 1
    s_waitcnt lgkmcnt(0)
    s_barrier
    s_bitcmp1_b32 s36, s42
    s_cbranch_scc1 L2_slow
L2_ret3:
    s_setprio 3
    s_bitcmp1_b32 s43, s42
    s_cbranch_scc1 L2_oa64
L2_ob64:
    s_mov_b64 exec, s[6:7]
    v_lshrrev_b32 v18, 16, v18
    s_mov_b64 exec, -1
    v_and_b32 v46, 0x20000000, v40
    v_lshrrev_b32 v47, 14, v17
    v_bitop3_b32 v47, v47, v5, v46 bitop3:0xea
    ds_read_b64 v[106:107], v47
    v_and_b32 v99, 0x10000000, v40
    v_lshrrev_b32 v47, 14, v16
    v_bitop3_b32 v47, v47, v5, v99 bitop3:0xea
    ds_read_b64 v[104:105], v47
    v_cmp_ne_u64 s[50:51], v[72:73], v[68:69]
    v_cmpx_ne_u64 s[54:55], v[74:75], v[70:71]
    s_and_b64 s[82:83], s[54:55], s[80:81]
    s_cbranch_scc1 L2_c65
L2_d65:
    v_mov_b64 v[84:85], v[70:71]
    v_mov_b32 v7, v95
    v_mov_b64 v[86:87], v[74:75]
    s_or_b64 s[80:81], s[80:81], s[54:55]
    s_mov_b64 exec, s[50:51]
    s_and_b64 s[82:83], s[50:51], s[80:81]
    s_cbranch_scc1 L2_c66
L2_d66:
    v_mov_b64 v[84:85], v[68:69]
    v_mov_b32 v7, v94
    v_mov_b64 v[86:87], v[72:73]
    s_mov_b64 exec, -1
    s_or_b64 s[80:81], s[80:81], s[50:51]
    s_and_b64 exec, s[84:85], s[80:81]
    v_mfma_f32_4x4x4_16b_bf16 v[76:79], v[12:13], v[84:85], 0
    v_mov_b32 v92, v7
    s_andn2_b64 s[80:81], s[80:81], s[84:85]
    v_mfma_f32_4x4x4_16b_bf16 v[76:79], v[10:11], v[86:87], v[76:79]
    s_mov_b64 exec, -1
    ds_read_b64 v[70:71], v93 offset:65408
    ds_read_b64 v[68:69], v92 offset:65408
    v_bitop3_b32 v94, v16, v5, v99 bitop3:0xea
    v_bitop3_b32 v95, v17, v5, v46 bitop3:0xea
    v_perm_b32 v15, v17, v18, s45
    v_bitop3_b32 v46, v17, 0.5, -0.5 bitop3:0xa8
    v_perm_b32 v14, v16, v18, s44
    v_bitop3_b32 v47, v16, 0.5, -0.5 bitop3:0xa8
    v_bitop3_b32 v15, v6, v15, v46 bitop3:0xca
    v_bitop3_b32 v14, v6, v14, v47 bitop3:0xca
    s_waitcnt lgkmcnt(1)
    v_mfma_f32_4x4x4_16b_bf16 v[80:83], v[10:11], v[70:71], v[80:83]
    s_waitcnt lgkmcnt(0)
    v_mfma_f32_4x4x4_16b_bf16 v[76:79], v[10:11], v[68:69], v[76:79]
    s_nop 2
    v_cvt_pk_bf16_f32 v80, v80, v81
    v_cvt_pk_bf16_f32 v81, v82, v83
    ds_wrxchg_rtn_b64 v[74:75], v93, v[80:81] offset:65408
    v_cvt_pk_bf16_f32 v76, v76, v77
    v_cvt_pk_bf16_f32 v77, v78, v79
    ds_wrxchg_rtn_b64 v[72:73], v92, v[76:77] offset:65408
    v_mfma_f32_4x4x4_16b_bf16 v[80:83], v[8:9], v[106:107], 0
    v_mfma_f32_4x4x4_16b_bf16 v[76:79], v[8:9], v[104:105], 0
    v_cmp_lt_u32 s[84:85], v5, v94
    s_nop 2
    v_pk_mul_f32 v[80:81], v[80:81], v[14:15] op_sel:[0,1] op_sel_hi:[1,1]
    v_pk_mul_f32 v[82:83], v[82:83], v[14:15] op_sel:[0,1] op_sel_hi:[1,1]
    v_pk_mul_f32 v[76:77], v[76:77], v[14:15] op_sel:[0,0] op_sel_hi:[1,0]
    v_pk_mul_f32 v[78:79], v[78:79], v[14:15] op_sel:[0,0] op_sel_hi:[1,0]
    v_and_b32 v47, 0x0fffffff, v19
    buffer_load_dword v18, v47, s[8:11], 0 offen offset:16
    s_mov_b64 exec, s[6:7]
    v_add_u32 v47, 8, v47
    v_lshrrev_b32 v19, 2, v19
    s_mov_b64 exec, -1
    buffer_load_dwordx2 v[16:17], v47, s[8:11], 0 offen
    v_and_b32 v46, 0x20000000, v41
    v_lshrrev_b32 v47, 14, v23
    v_bitop3_b32 v47, v47, v5, v46 bitop3:0xea
    ds_read_b64 v[102:103], v47
    v_and_b32 v99, 0x10000000, v41
    v_lshrrev_b32 v47, 14, v22
    v_bitop3_b32 v47, v47, v5, v99 bitop3:0xea
    ds_read_b64 v[100:101], v47
    s_waitcnt lgkmcnt(2)
    v_cmp_ne_u64 s[50:51], v[72:73], v[68:69]
    v_cmpx_ne_u64 s[54:55], v[74:75], v[70:71]
    s_and_b64 s[82:83], s[54:55], s[80:81]
    s_cbranch_scc1 L2_c67
L2_d67:
    v_mov_b64 v[84:85], v[70:71]
    v_mov_b32 v7, v93
    v_mov_b64 v[86:87], v[74:75]
    s_or_b64 s[80:81], s[80:81], s[54:55]
    s_mov_b64 exec, s[50:51]
    s_and_b64 s[82:83], s[50:51], s[80:81]
    s_cbranch_scc1 L2_c68
L2_d68:
    v_mov_b64 v[84:85], v[68:69]
    v_mov_b32 v7, v92
    v_mov_b64 v[86:87], v[72:73]
    s_mov_b64 exec, -1
    s_or_b64 s[80:81], s[80:81], s[50:51]
    s_and_b64 exec, s[84:85], s[80:81]
    v_mfma_f32_4x4x4_16b_bf16 v[76:79], v[12:13], v[84:85], 0
    v_mov_b32 v94, v7
    s_andn2_b64 s[80:81], s[80:81], s[84:85]
    v_mfma_f32_4x4x4_16b_bf16 v[76:79], v[10:11], v[86:87], v[76:79]
    s_mov_b64 exec, -1
    ds_read_b64 v[70:71], v95 offset:65408
    ds_read_b64 v[68:69], v94 offset:65408
    v_bitop3_b32 v92, v22, v5, v99 bitop3:0xea
    v_bitop3_b32 v93, v23, v5, v46 bitop3:0xea
    v_perm_b32 v15, v23, v26, s45
    v_bitop3_b32 v46, v23, 0.5, -0.5 bitop3:0xa8
    v_perm_b32 v14, v22, v26, s44
    v_bitop3_b32 v47, v22, 0.5, -0.5 bitop3:0xa8
    v_bitop3_b32 v15, v6, v15, v46 bitop3:0xca
    v_bitop3_b32 v14, v6, v14, v47 bitop3:0xca
    s_waitcnt lgkmcnt(1)
    v_mfma_f32_4x4x4_16b_bf16 v[80:83], v[10:11], v[70:71], v[80:83]
    s_waitcnt lgkmcnt(0)
    v_mfma_f32_4x4x4_16b_bf16 v[76:79], v[10:11], v[68:69], v[76:79]
    s_nop 2
    v_cvt_pk_bf16_f32 v80, v80, v81
    v_cvt_pk_bf16_f32 v81, v82, v83
    ds_wrxchg_rtn_b64 v[74:75], v95, v[80:81] offset:65408
    v_cvt_pk_bf16_f32 v76, v76, v77
    v_cvt_pk_bf16_f32 v77, v78, v79
    ds_wrxchg_rtn_b64 v[72:73], v94, v[76:77] offset:65408
    v_mfma_f32_4x4x4_16b_bf16 v[80:83], v[8:9], v[102:103], 0
    v_mfma_f32_4x4x4_16b_bf16 v[76:79], v[8:9], v[100:101], 0
    v_cmp_lt_u32 s[48:49], v5, v93
    s_nop 2
    v_pk_mul_f32 v[80:81], v[80:81], v[14:15] op_sel:[0,1] op_sel_hi:[1,1]
    v_pk_mul_f32 v[82:83], v[82:83], v[14:15] op_sel:[0,1] op_sel_hi:[1,1]
    v_pk_mul_f32 v[76:77], v[76:77], v[14:15] op_sel:[0,0] op_sel_hi:[1,0]
    v_pk_mul_f32 v[78:79], v[78:79], v[14:15] op_sel:[0,0] op_sel_hi:[1,0]
    buffer_load_dwordx4 v[108:111], v3, s[16:19], s40 offen offset:0 sc1
    v_and_b32 v46, 0x80000000, v41
    v_lshrrev_b32 v47, 14, v25
    v_bitop3_b32 v47, v47, v5, v46 bitop3:0xea
    ds_read_b64 v[106:107], v47
    v_and_b32 v99, 0x40000000, v41
    v_lshrrev_b32 v47, 14, v24
    v_bitop3_b32 v47, v47, v5, v99 bitop3:0xea
    ds_read_b64 v[104:105], v47
    s_waitcnt lgkmcnt(2)
    v_cmp_ne_u64 s[50:51], v[72:73], v[68:69]
    v_cmpx_ne_u64 s[54:55], v[74:75], v[70:71]
    s_and_b64 s[82:83], s[54:55], s[80:81]
    s_cbranch_scc1 L2_c69
L2_d69:
    v_mov_b64 v[84:85], v[70:71]
    v_mov_b32 v7, v95
    v_mov_b64 v[86:87], v[74:75]
    s_or_b64 s[80:81], s[80:81], s[54:55]
    s_mov_b64 exec, s[50:51]
    s_and_b64 s[82:83], s[50:51], s[80:81]
    s_cbranch_scc1 L2_c70
L2_d70:
    v_mov_b64 v[84:85], v[68:69]
    v_mov_b32 v7, v94
    v_mov_b64 v[86:87], v[72:73]
    s_mov_b64 exec, -1
    s_or_b64 s[80:81], s[80:81], s[50:51]
    s_and_b64 exec, s[48:49], s[80:81]
    v_mfma_f32_4x4x4_16b_bf16 v[80:83], v[12:13], v[84:85], 0
    v_mov_b32 v93, v7
    s_andn2_b64 s[80:81], s[80:81], s[48:49]
    v_mfma_f32_4x4x4_16b_bf16 v[80:83], v[10:11], v[86:87], v[80:83]
    s_mov_b64 exec, -1
    ds_read_b64 v[70:71], v93 offset:65408
    ds_read_b64 v[68:69], v92 offset:65408
    v_bitop3_b32 v94, v24, v5, v99 bitop3:0xea
    v_bitop3_b32 v95, v25, v5, v46 bitop3:0xea
    v_perm_b32 v15, v25, v26, s47
    v_bitop3_b32 v46, v25, 0.5, -0.5 bitop3:0xa8
    v_perm_b32 v14, v24, v26, s46
    v_bitop3_b32 v47, v24, 0.5, -0.5 bitop3:0xa8
    v_bitop3_b32 v15, v6, v15, v46 bitop3:0xca
    v_bitop3_b32 v14, v6, v14, v47 bitop3:0xca
    s_waitcnt lgkmcnt(1)
    v_mfma_f32_4x4x4_16b_bf16 v[80:83], v[10:11], v[70:71], v[80:83]
    s_waitcnt lgkmcnt(0)
    v_mfma_f32_4x4x4_16b_bf16 v[76:79], v[10:11], v[68:69], v[76:79]
    s_nop 2
    v_cvt_pk_bf16_f32 v80, v80, v81
    v_cvt_pk_bf16_f32 v81, v82, v83
    ds_wrxchg_rtn_b64 v[74:75], v93, v[80:81] offset:65408
    v_cvt_pk_bf16_f32 v76, v76, v77
    v_cvt_pk_bf16_f32 v77, v78, v79
    ds_wrxchg_rtn_b64 v[72:73], v92, v[76:77] offset:65408
    v_and_b32 v88, 0x0fffffff, v27
    buffer_load_dwordx2 v[22:23], v88, s[8:11], 0 offen
    buffer_load_dwordx3 v[24:26], v88, s[8:11], 0 offen offset:8
    s_setprio 2
    v_mfma_f32_4x4x4_16b_bf16 v[80:83], v[8:9], v[106:107], 0
    v_mfma_f32_4x4x4_16b_bf16 v[76:79], v[8:9], v[104:105], 0
    s_nop 3
    v_pk_mul_f32 v[80:81], v[80:81], v[14:15] op_sel:[0,1] op_sel_hi:[1,1]
    v_pk_mul_f32 v[82:83], v[82:83], v[14:15] op_sel:[0,1] op_sel_hi:[1,1]
    v_pk_mul_f32 v[76:77], v[76:77], v[14:15] op_sel:[0,0] op_sel_hi:[1,0]
    v_pk_mul_f32 v[78:79], v[78:79], v[14:15] op_sel:[0,0] op_sel_hi:[1,0]
    s_waitcnt vmcnt(10)
    v_and_b32 v46, 0x20000000, v42
    v_lshrrev_b32 v47, 14, v29
    v_bitop3_b32 v47, v47, v5, v46 bitop3:0xea
    ds_read_b64 v[102:103], v47
    v_and_b32 v99, 0x10000000, v42
    v_lshrrev_b32 v47, 14, v28
    v_bitop3_b32 v47, v47, v5, v99 bitop3:0xea
    ds_read_b64 v[100:101], v47
    s_waitcnt lgkmcnt(2)
    v_cmp_ne_u64 s[50:51], v[72:73], v[68:69]
    v_cmpx_ne_u64 s[54:55], v[74:75], v[70:71]
    s_and_b64 s[82:83], s[54:55], s[80:81]
    s_cbranch_scc1 L2_c71
L2_d71:
    v_mov_b64 v[84:85], v[70:71]
    v_mov_b32 v7, v93
    v_mov_b64 v[86:87], v[74:75]
    s_or_b64 s[80:81], s[80:81], s[54:55]
    s_mov_b64 exec, s[50:51]
    s_and_b64 s[82:83], s[50:51], s[80:81]
    s_cbranch_scc1 L2_c72
L2_d72:
    v_mov_b64 v[84:85], v[68:69]
    v_mov_b32 v7, v92
    v_mov_b64 v[86:87], v[72:73]
    s_mov_b64 exec, -1
    s_or_b64 s[80:81], s[80:81], s[50:51]
    ds_read_b64 v[70:71], v95 offset:65408
    ds_read_b64 v[68:69], v94 offset:65408
    v_bitop3_b32 v92, v28, v5, v99 bitop3:0xea
    v_bitop3_b32 v93, v29, v5, v46 bitop3:0xea
    v_perm_b32 v15, v29, v32, s45
    v_bitop3_b32 v46, v29, 0.5, -0.5 bitop3:0xa8
    v_perm_b32 v14, v28, v32, s44
    v_bitop3_b32 v47, v28, 0.5, -0.5 bitop3:0xa8
    v_bitop3_b32 v15, v6, v15, v46 bitop3:0xca
    v_bitop3_b32 v14, v6, v14, v47 bitop3:0xca
    s_waitcnt lgkmcnt(1)
    v_mfma_f32_4x4x4_16b_bf16 v[80:83], v[10:11], v[70:71], v[80:83]
    s_waitcnt lgkmcnt(0)
    v_mfma_f32_4x4x4_16b_bf16 v[76:79], v[10:11], v[68:69], v[76:79]
    s_nop 2
    v_cvt_pk_bf16_f32 v80, v80, v81
    v_cvt_pk_bf16_f32 v81, v82, v83
    ds_wrxchg_rtn_b64 v[74:75], v95, v[80:81] offset:65408
    v_cvt_pk_bf16_f32 v76, v76, v77
    v_cvt_pk_bf16_f32 v77, v78, v79
    ds_wrxchg_rtn_b64 v[72:73], v94, v[76:77] offset:65408
    s_setprio 1
    v_mfma_f32_4x4x4_16b_bf16 v[80:83], v[8:9], v[102:103], 0
    v_mfma_f32_4x4x4_16b_bf16 v[76:79], v[8:9], v[100:101], 0
    v_cmp_lt_u32 s[84:85], v5, v92
    s_nop 2
    v_pk_mul_f32 v[80:81], v[80:81], v[14:15] op_sel:[0,1] op_sel_hi:[1,1]
    v_pk_mul_f32 v[82:83], v[82:83], v[14:15] op_sel:[0,1] op_sel_hi:[1,1]
    v_pk_mul_f32 v[76:77], v[76:77], v[14:15] op_sel:[0,0] op_sel_hi:[1,0]
    v_pk_mul_f32 v[78:79], v[78:79], v[14:15] op_sel:[0,0] op_sel_hi:[1,0]
    s_bitcmp1_b32 s43, s42
    s_cbranch_scc1 L2_oa73
L2_ob73:
    buffer_load_dwordx4 v[112:115], v3, s[16:19], s40 offen offset:1024 sc1
    v_sub_u16 v88, v58, v50
    v_and_b32 v89, 3, v50
    v_add3_u32 v99, v88, v89, 3
    v_and_b32 v99, -4, v99
    v_max_u32 v99, 4, v99
    v_and_b32 v97, 0xfffc, v50
    v_bfm_b32 v96, v88, v89
    v_add_u32_dpp v91, v99, v99 row_shr:1 row_mask:0xf bank_mask:0xf bound_ctrl:1
    v_mad_u32_u24 v97, v97, 5, v2
    v_cmp_lt_u32 vcc, 16, v99
    v_add_u32_dpp v91, v91, v91 row_shr:2 row_mask:0xf bank_mask:0xf bound_ctrl:1
    v_sub_u32 v98, s38, v99
    v_lshrrev_b64 v[50:51], 16, v[50:51]
    v_add_u32_dpp v91, v91, v91 row_shr:4 row_mask:0xf bank_mask:0xf bound_ctrl:1
    v_lshrrev_b64 v[58:59], 16, v[58:59]
    s_mov_b32 s101, 0
    v_add_u32_dpp v91, v91, v91 row_shr:8 row_mask:0xf bank_mask:0xf bound_ctrl:1
    s_nop 1
    v_add_u32_dpp v91, v91, v91 row_bcast:15 row_mask:0xa bank_mask:0xf
    s_nop 1
    v_add_u32_dpp v91, v91, v91 row_bcast:31 row_mask:0xc bank_mask:0xf
    v_add_u32 v98, v98, v91
    v_readlane_b32 s37, v91, 63
    s_cbranch_vccnz L2_xo74
L2_xp74:
    v_and_b32 v46, 0x80000000, v42
    v_lshrrev_b32 v47, 14, v31
    v_bitop3_b32 v47, v47, v5, v46 bitop3:0xea
    ds_read_b64 v[106:107], v47
    v_and_b32 v99, 0x40000000, v42
    v_lshrrev_b32 v47, 14, v30
    v_bitop3_b32 v47, v47, v5, v99 bitop3:0xea
    ds_read_b64 v[104:105], v47
    s_waitcnt lgkmcnt(2)
    v_cmp_ne_u64 s[50:51], v[72:73], v[68:69]
    v_cmpx_ne_u64 s[54:55], v[74:75], v[70:71]
    s_and_b64 s[82:83], s[54:55], s[80:81]
    s_cbranch_scc1 L2_c75
L2_d75:
    v_mov_b64 v[84:85], v[70:71]
    v_mov_b32 v7, v95
    v_mov_b64 v[86:87], v[74:75]
    s_or_b64 s[80:81], s[80:81], s[54:55]
    s_mov_b64 exec, s[50:51]
    s_and_b64 s[82:83], s[50:51], s[80:81]
    s_cbranch_scc1 L2_c76
L2_d76:
    v_mov_b64 v[84:85], v[68:69]
    v_mov_b32 v7, v94
    v_mov_b64 v[86:87], v[72:73]
    s_mov_b64 exec, -1
    s_or_b64 s[80:81], s[80:81], s[50:51]
    s_and_b64 exec, s[84:85], s[80:81]
    v_mfma_f32_4x4x4_16b_bf16 v[76:79], v[12:13], v[84:85], 0
    v_mov_b32 v92, v7
    s_andn2_b64 s[80:81], s[80:81], s[84:85]
    v_mfma_f32_4x4x4_16b_bf16 v[76:79], v[10:11], v[86:87], v[76:79]
    s_mov_b64 exec, -1
    ds_read_b64 v[70:71], v93 offset:65408
    ds_read_b64 v[68:69], v92 offset:65408
    v_bitop3_b32 v94, v30, v5, v99 bitop3:0xea
    v_bitop3_b32 v95, v31, v5, v46 bitop3:0xea
    v_perm_b32 v15, v31, v32, s47
    v_bitop3_b32 v46, v31, 0.5, -0.5 bitop3:0xa8
    v_perm_b32 v14, v30, v32, s46
    v_bitop3_b32 v47, v30, 0.5, -0.5 bitop3:0xa8
    v_bitop3_b32 v15, v6, v15, v46 bitop3:0xca
    v_bitop3_b32 v14, v6, v14, v47 bitop3:0xca
    s_waitcnt lgkmcnt(1)
    v_mfma_f32_4x4x4_16b_bf16 v[80:83], v[10:11], v[70:71], v[80:83]
    s_waitcnt lgkmcnt(0)
    v_mfma_f32_4x4x4_16b_bf16 v[76:79], v[10:11], v[68:69], v[76:79]
    s_nop 2
    v_cvt_pk_bf16_f32 v80, v80, v81
    v_cvt_pk_bf16_f32 v81, v82, v83
    ds_wrxchg_rtn_b64 v[74:75], v93, v[80:81] offset:65408
    v_cvt_pk_bf16_f32 v76, v76, v77
    v_cvt_pk_bf16_f32 v77, v78, v79
    ds_wrxchg_rtn_b64 v[72:73], v92, v[76:77] offset:65408
    v_and_b32 v88, 0x0fffffff, v33
    buffer_load_dwordx2 v[28:29], v88, s[8:11], 0 offen
    buffer_load_dwordx3 v[30:32], v88, s[8:11], 0 offen offset:8
    s_setprio 0
    v_mfma_f32_4x4x4_16b_bf16 v[80:83], v[8:9], v[106:107], 0
    v_mfma_f32_4x4x4_16b_bf16 v[76:79], v[8:9], v[104:105], 0
    v_cmp_lt_u32 s[48:49], v5, v95
    s_nop 2
    v_pk_mul_f32 v[80:81], v[80:81], v[14:15] op_sel:[0,1] op_sel_hi:[1,1]
    v_pk_mul_f32 v[82:83], v[82:83], v[14:15] op_sel:[0,1] op_sel_hi:[1,1]
    v_pk_mul_f32 v[76:77], v[76:77], v[14:15] op_sel:[0,0] op_sel_hi:[1,0]
    v_pk_mul_f32 v[78:79], v[78:79], v[14:15] op_sel:[0,0] op_sel_hi:[1,0]
    s_add_u32 s40, s40, 0x50000
    s_waitcnt vmcnt(8)
    v_and_b32 v46, 0x80000000, v43
    v_lshrrev_b32 v47, 14, v37
    v_bitop3_b32 v47, v47, v5, v46 bitop3:0xea
    ds_read_b64 v[106:107], v47
    v_and_b32 v99, 0x40000000, v43
    v_lshrrev_b32 v47, 14, v36
    v_bitop3_b32 v47, v47, v5, v99 bitop3:0xea
    ds_read_b64 v[104:105], v47
    v_and_b32 v46, 0x20000000, v43
    v_lshrrev_b32 v47, 14, v35
    v_bitop3_b32 v47, v47, v5, v46 bitop3:0xea
    ds_read_b64 v[102:103], v47
    v_and_b32 v99, 0x10000000, v43
    v_lshrrev_b32 v47, 14, v34
    v_bitop3_b32 v47, v47, v5, v99 bitop3:0xea
    ds_read_b64 v[100:101], v47
    s_waitcnt lgkmcnt(4)
    v_cmp_ne_u64 s[50:51], v[72:73], v[68:69]
    v_cmpx_ne_u64 s[54:55], v[74:75], v[70:71]
    s_and_b64 s[82:83], s[54:55], s[80:81]
    s_cbranch_scc1 L2_c77
L2_d77:
    v_mov_b64 v[84:85], v[70:71]
    v_mov_b32 v7, v93
    v_mov_b64 v[86:87], v[74:75]
    s_or_b64 s[80:81], s[80:81], s[54:55]
    s_mov_b64 exec, s[50:51]
    s_and_b64 s[82:83], s[50:51], s[80:81]
    s_cbranch_scc1 L2_c78
L2_d78:
    v_mov_b64 v[84:85], v[68:69]
    v_mov_b32 v7, v92
    v_mov_b64 v[86:87], v[72:73]
    s_mov_b64 exec, -1
    s_or_b64 s[80:81], s[80:81], s[50:51]
    s_and_b64 exec, s[48:49], s[80:81]
    v_mfma_f32_4x4x4_16b_bf16 v[80:83], v[12:13], v[84:85], 0
    v_mov_b32 v95, v7
    s_andn2_b64 s[80:81], s[80:81], s[48:49]
    v_mfma_f32_4x4x4_16b_bf16 v[80:83], v[10:11], v[86:87], v[80:83]
    s_mov_b64 exec, -1
    ds_read_b64 v[70:71], v95 offset:65408
    ds_read_b64 v[68:69], v94 offset:65408
    v_bitop3_b32 v92, v34, v5, v99 bitop3:0xea
    v_bitop3_b32 v93, v35, v5, v46 bitop3:0xea
    v_perm_b32 v15, v35, v38, s45
    v_bitop3_b32 v46, v35, 0.5, -0.5 bitop3:0xa8
    v_perm_b32 v14, v34, v38, s44
    v_bitop3_b32 v47, v34, 0.5, -0.5 bitop3:0xa8
    v_bitop3_b32 v15, v6, v15, v46 bitop3:0xca
    v_bitop3_b32 v14, v6, v14, v47 bitop3:0xca
    s_waitcnt lgkmcnt(1)
    v_mfma_f32_4x4x4_16b_bf16 v[80:83], v[10:11], v[70:71], v[80:83]
    s_waitcnt lgkmcnt(0)
    v_mfma_f32_4x4x4_16b_bf16 v[76:79], v[10:11], v[68:69], v[76:79]
    s_nop 2
    v_cvt_pk_bf16_f32 v80, v80, v81
    v_cvt_pk_bf16_f32 v81, v82, v83
    ds_wrxchg_rtn_b64 v[74:75], v95, v[80:81] offset:65408
    v_cvt_pk_bf16_f32 v76, v76, v77
    v_cvt_pk_bf16_f32 v77, v78, v79
    ds_wrxchg_rtn_b64 v[72:73], v94, v[76:77] offset:65408
    s_barrier
    s_setprio 3
    s_mov_b32 m0, s100
    s_nop 0
    ds_write_addtid_b32 v124 offset:34816
    ds_write_addtid_b32 v125 offset:35072
    ds_write_addtid_b32 v126 offset:35328
    ds_write_addtid_b32 v127 offset:35584
    s_add_u32 s3, s40, 4096
    buffer_load_dwordx4 v[124:127], v3, s[16:19], s3 offen sc1
    ds_write_addtid_b32 v116 offset:32768
    ds_write_addtid_b32 v117 offset:33024
    ds_write_addtid_b32 v118 offset:33280
    ds_write_addtid_b32 v119 offset:33536
    buffer_load_dwordx4 v[116:119], v3, s[16:19], s40 offen offset:2048 sc1
    ds_write_addtid_b32 v120 offset:33792
    ds_write_addtid_b32 v121 offset:34048
    ds_write_addtid_b32 v122 offset:34304
    ds_write_addtid_b32 v123 offset:34560
    buffer_load_dwordx4 v[120:123], v3, s[16:19], s40 offen offset:3072 sc1
    v_mfma_f32_4x4x4_16b_bf16 v[80:83], v[8:9], v[102:103], 0
    v_mfma_f32_4x4x4_16b_bf16 v[76:79], v[8:9], v[100:101], 0
    s_nop 3
    v_pk_mul_f32 v[80:81], v[80:81], v[14:15] op_sel:[0,1] op_sel_hi:[1,1]
    v_pk_mul_f32 v[82:83], v[82:83], v[14:15] op_sel:[0,1] op_sel_hi:[1,1]
    v_pk_mul_f32 v[76:77], v[76:77], v[14:15] op_sel:[0,0] op_sel_hi:[1,0]
    v_pk_mul_f32 v[78:79], v[78:79], v[14:15] op_sel:[0,0] op_sel_hi:[1,0]
    s_cmp_gt_u32 s37, 1024
    s_cbranch_scc1 L2_xs79
    s_cmp_lg_u32 s101, 0
    s_cbranch_scc1 L2_xa79
L2_xb79:
    v_lshlrev_b32 v89, 16, v96
    v_add_u32 v90, 60, v97
    v_bitop3_b32 v90, v89, v45, v90 bitop3:0x6a
    ds_write_b32 v98, v90 offset:12
    v_lshlrev_b32 v89, 20, v96
    v_add_u32 v90, 40, v97
    v_bitop3_b32 v90, v89, v45, v90 bitop3:0x6a
    ds_write_b32 v98, v90 offset:8
    v_lshlrev_b32 v89, 24, v96
    v_add_u32 v90, 20, v97
    v_bitop3_b32 v90, v89, v45, v90 bitop3:0x6a
    ds_write_b32 v98, v90 offset:4
    v_lshlrev_b32 v89, 28, v96
    v_bitop3_b32 v90, v89, v45, v97 bitop3:0x6a
    ds_write_b32 v98, v90 offset:0
    v_mov_b32_dpp v91, v66 quad_perm:[0,0,0,0] row_mask:0xf bank_mask:0xf
    v_and_b32 v89, 3, v91
    v_and_b32 v97, 0xfffc, v91
    v_sub_u16_dpp v88, v66, v91 quad_perm:[2,2,2,2] row_mask:0xf bank_mask:0xf
    v_mad_u32_u24 v97, v97, 5, v4
    v_add_u32 v99, v88, v89
    v_bfm_b32 v96, v88, v89
    v_cmp_lt_u32 s[58:59], 16, v99
    v_lshlrev_b32 v89, v1, v96
    v_and_b32 v89, v45, v89
    v_cmp_ne_u32 vcc, 0, v89
    v_xor_b32 v90, v97, v89
    s_add_u32 s3, s37, s38
    v_mbcnt_lo_u32_b32 v98, vcc_lo, 0
    v_mbcnt_hi_u32_b32 v98, vcc_hi, v98
    s_bcnt1_i32_b64 s41, vcc
    v_lshl_add_u32 v98, v98, 2, s3
    s_lshl2_add_u32 s37, s41, s37
    s_mov_b64 exec, vcc
    ds_write_b32 v98, v90
    s_mov_b64 exec, -1
    s_cmp_lg_u64 s[58:59], 0
    s_cbranch_scc1 L2_xe79
L2_xr79:
    v_add_u32 v98, s37, v0
    v_mov_b32 v90, -1
    ds_write_b32 v98, v90
L2_xw79:
    s_setprio 2
    s_waitcnt lgkmcnt(14)
    v_cmp_ne_u64 s[50:51], v[72:73], v[68:69]
    v_cmpx_ne_u64 s[54:55], v[74:75], v[70:71]
    s_and_b64 s[82:83], s[54:55], s[80:81]
    s_cbranch_scc1 L2_c80
L2_d80:
    v_mov_b64 v[84:85], v[70:71]
    v_mov_b32 v7, v95
    v_mov_b64 v[86:87], v[74:75]
    s_or_b64 s[80:81], s[80:81], s[54:55]
    s_mov_b64 exec, s[50:51]
    s_and_b64 s[82:83], s[50:51], s[80:81]
    s_cbranch_scc1 L2_c81
L2_d81:
    v_mov_b64 v[84:85], v[68:69]
    v_mov_b32 v7, v94
    v_mov_b64 v[86:87], v[72:73]
    s_mov_b64 exec, -1
    s_or_b64 s[80:81], s[80:81], s[50:51]
    ds_read_b64 v[70:71], v93 offset:65408
    ds_read_b64 v[68:69], v92 offset:65408
    v_and_b32 v46, 0x40000000, v43
    v_bitop3_b32 v94, v36, v5, v46 bitop3:0xea
    v_and_b32 v46, 0x80000000, v43
    v_bitop3_b32 v95, v37, v5, v46 bitop3:0xea
    v_perm_b32 v15, v37, v38, s47
    v_bitop3_b32 v46, v37, 0.5, -0.5 bitop3:0xa8
    v_perm_b32 v14, v36, v38, s46
    v_bitop3_b32 v47, v36, 0.5, -0.5 bitop3:0xa8
    v_bitop3_b32 v15, v6, v15, v46 bitop3:0xca
    v_bitop3_b32 v14, v6, v14, v47 bitop3:0xca
    s_setprio 1
    s_waitcnt lgkmcnt(1)
    v_mfma_f32_4x4x4_16b_bf16 v[80:83], v[10:11], v[70:71], v[80:83]
    s_waitcnt lgkmcnt(0)
    v_mfma_f32_4x4x4_16b_bf16 v[76:79], v[10:11], v[68:69], v[76:79]
    s_nop 2
    v_cvt_pk_bf16_f32 v80, v80, v81
    v_cvt_pk_bf16_f32 v81, v82, v83
    ds_wrxchg_rtn_b64 v[74:75], v93, v[80:81] offset:65408
    v_cvt_pk_bf16_f32 v76, v76, v77
    v_cvt_pk_bf16_f32 v77, v78, v79
    ds_wrxchg_rtn_b64 v[72:73], v92, v[76:77] offset:65408
    ds_read_b32 v40, v44 offset:768
    ds_read_b32 v41, v0 offset:0
    ds_read_b32 v42, v0 offset:256
    ds_read_b32 v43, v0 offset:512
    s_sub_u32 s3, s37, 768
    s_cmp_gt_u32 s3, 128
    s_cbranch_scc1 L2_xf79
L2_xg79:
    v_and_b32 v88, 0x0fffffff, v39
    buffer_load_dwordx2 v[34:35], v88, s[8:11], 0 offen
    buffer_load_dwordx3 v[36:38], v88, s[8:11], 0 offen offset:8
    s_setprio 0
    s_waitcnt vmcnt(10)
    s_mov_b32 m0, s38
    s_nop 0
    ds_write_addtid_b32 v108 offset:0
    ds_write_addtid_b32 v109 offset:256
    ds_write_addtid_b32 v110 offset:512
    ds_write_addtid_b32 v111 offset:768
    s_waitcnt vmcnt(7)
    ds_write_addtid_b32 v112 offset:1024
    ds_write_addtid_b32 v113 offset:1280
    ds_write_addtid_b32 v114 offset:1536
    ds_write_addtid_b32 v115 offset:1792
    v_mfma_f32_4x4x4_16b_bf16 v[80:83], v[8:9], v[106:107], 0
    v_mfma_f32_4x4x4_16b_bf16 v[76:79], v[8:9], v[104:105], 0
    v_cmp_lt_u32 s[84:85], v5, v94
    s_nop 2
    v_pk_mul_f32 v[80:81], v[80:81], v[14:15] op_sel:[0,1] op_sel_hi:[1,1]
    v_pk_mul_f32 v[82:83], v[82:83], v[14:15] op_sel:[0,1] op_sel_hi:[1,1]
    v_pk_mul_f32 v[76:77], v[76:77], v[14:15] op_sel:[0,0] op_sel_hi:[1,0]
    v_pk_mul_f32 v[78:79], v[78:79], v[14:15] op_sel:[0,0] op_sel_hi:[1,0]
    s_add_u32 s42, s42, 1
    s_waitcnt lgkmcnt(0)
    s_barrier
    s_bitcmp1_b32 s36, s42
    s_cbranch_scc1 L2_slow
L2_ret4:
    s_setprio 3
    s_bitcmp1_b32 s43, s42
    s_cbranch_scc1 L2_oa82
L2_ob82:
    s_mov_b64 exec, s[6:7]
    v_lshrrev_b32 v18, 16, v18
    s_mov_b64 exec, -1
    v_and_b32 v46, 0x20000000, v19
    v_lshrrev_b32 v47, 14, v17
    v_bitop3_b32 v47, v47, v5, v46 bitop3:0xea
    ds_read_b64 v[102:103], v47
    v_and_b32 v99, 0x10000000, v19
    v_lshrrev_b32 v47, 14, v16
    v_bitop3_b32 v47, v47, v5, v99 bitop3:0xea
    ds_read_b64 v[100:101], v47
    v_cmp_ne_u64 s[50:51], v[72:73], v[68:69]
    v_cmpx_ne_u64 s[54:55], v[74:75], v[70:71]
    s_and_b64 s[82:83], s[54:55], s[80:81]
    s_cbranch_scc1 L2_c83
L2_d83:
    v_mov_b64 v[84:85], v[70:71]
    v_mov_b32 v7, v93
    v_mov_b64 v[86:87], v[74:75]
    s_or_b64 s[80:81], s[80:81], s[54:55]
    s_mov_b64 exec, s[50:51]
    s_and_b64 s[82:83], s[50:51], s[80:81]
    s_cbranch_scc1 L2_c84
L2_d84:
    v_mov_b64 v[84:85], v[68:69]
    v_mov_b32 v7, v92
    v_mov_b64 v[86:87], v[72:73]
    s_mov_b64 exec, -1
    s_or_b64 s[80:81], s[80:81], s[50:51]
    s_and_b64 exec, s[84:85], s[80:81]
    v_mfma_f32_4x4x4_16b_bf16 v[76:79], v[12:13], v[84:85], 0
    v_mov_b32 v94, v7
    s_andn2_b64 s[80:81], s[80:81], s[84:85]
    v_mfma_f32_4x4x4_16b_bf16 v[76:79], v[10:11], v[86:87], v[76:79]
    s_mov_b64 exec, -1
    ds_read_b64 v[70:71], v95 offset:65408
    ds_read_b64 v[68:69], v94 offset:65408
    v_bitop3_b32 v92, v16, v5, v99 bitop3:0xea
    v_bitop3_b32 v93, v17, v5, v46 bitop3:0xea
    v_perm_b32 v15, v17, v18, s45
    v_bitop3_b32 v46, v17, 0.5, -0.5 bitop3:0xa8
    v_perm_b32 v14, v16, v18, s44
    v_bitop3_b32 v47, v16, 0.5, -0.5 bitop3:0xa8
    v_bitop3_b32 v15, v6, v15, v46 bitop3:0xca
    v_bitop3_b32 v14, v6, v14, v47 bitop3:0xca
    s_waitcnt lgkmcnt(1)
    v_mfma_f32_4x4x4_16b_bf16 v[80:83], v[10:11], v[70:71], v[80:83]
    s_waitcnt lgkmcnt(0)
    v_mfma_f32_4x4x4_16b_bf16 v[76:79], v[10:11], v[68:69], v[76:79]
    s_nop 2
    v_cvt_pk_bf16_f32 v80, v80, v81
    v_cvt_pk_bf16_f32 v81, v82, v83
    ds_wrxchg_rtn_b64 v[74:75], v95, v[80:81] offset:65408
    v_cvt_pk_bf16_f32 v76, v76, v77
    v_cvt_pk_bf16_f32 v77, v78, v79
    ds_wrxchg_rtn_b64 v[72:73], v94, v[76:77] offset:65408
    v_mfma_f32_4x4x4_16b_bf16 v[80:83], v[8:9], v[102:103], 0
    v_mfma_f32_4x4x4_16b_bf16 v[76:79], v[8:9], v[100:101], 0
    v_cmp_lt_u32 s[84:85], v5, v92
    s_nop 2
    v_pk_mul_f32 v[80:81], v[80:81], v[14:15] op_sel:[0,1] op_sel_hi:[1,1]
    v_pk_mul_f32 v[82:83], v[82:83], v[14:15] op_sel:[0,1] op_sel_hi:[1,1]
    v_pk_mul_f32 v[76:77], v[76:77], v[14:15] op_sel:[0,0] op_sel_hi:[1,0]
    v_pk_mul_f32 v[78:79], v[78:79], v[14:15] op_sel:[0,0] op_sel_hi:[1,0]
    v_and_b32 v47, 0x0fffffff, v40
    buffer_load_dword v18, v47, s[8:11], 0 offen offset:16
    s_mov_b64 exec, s[6:7]
    v_add_u32 v47, 8, v47
    v_lshrrev_b32 v40, 2, v40
    s_mov_b64 exec, -1
    buffer_load_dwordx2 v[16:17], v47, s[8:11], 0 offen
    v_and_b32 v46, 0x20000000, v27
    v_lshrrev_b32 v47, 14, v23
    v_bitop3_b32 v47, v47, v5, v46 bitop3:0xea
    ds_read_b64 v[106:107], v47
    v_and_b32 v99, 0x10000000, v27
    v_lshrrev_b32 v47, 14, v22
    v_bitop3_b32 v47, v47, v5, v99 bitop3:0xea
    ds_read_b64 v[104:105], v47
    s_waitcnt lgkmcnt(2)
    v_cmp_ne_u64 s[50:51], v[72:73], v[68:69]
    v_cmpx_ne_u64 s[54:55], v[74:75], v[70:71]
    s_and_b64 s[82:83], s[54:55], s[80:81]
    s_cbranch_scc1 L2_c85
L2_d85:
    v_mov_b64 v[84:85], v[70:71]
    v_mov_b32 v7, v95
    v_mov_b64 v[86:87], v[74:75]
    s_or_b64 s[80:81], s[80:81], s[54:55]
    s_mov_b64 exec, s[50:51]
    s_and_b64 s[82:83], s[50:51], s[80:81]
    s_cbranch_scc1 L2_c86
L2_d86:
    v_mov_b64 v[84:85], v[68:69]
    v_mov_b32 v7, v94
    v_mov_b64 v[86:87], v[72:73]
    s_mov_b64 exec, -1
    s_or_b64 s[80:81], s[80:81], s[50:51]
    s_and_b64 exec, s[84:85], s[80:81]
    v_mfma_f32_4x4x4_16b_bf16 v[76:79], v[12:13], v[84:85], 0
    v_mov_b32 v92, v7
    s_andn2_b64 s[80:81], s[80:81], s[84:85]
    v_mfma_f32_4x4x4_16b_bf16 v[76:79], v[10:11], v[86:87], v[76:79]
    s_mov_b64 exec, -1
    ds_read_b64 v[70:71], v93 offset:65408
    ds_read_b64 v[68:69], v92 offset:65408
    v_bitop3_b32 v94, v22, v5, v99 bitop3:0xea
    v_bitop3_b32 v95, v23, v5, v46 bitop3:0xea
    v_perm_b32 v15, v23, v26, s45
    v_bitop3_b32 v46, v23, 0.5, -0.5 bitop3:0xa8
    v_perm_b32 v14, v22, v26, s44
    v_bitop3_b32 v47, v22, 0.5, -0.5 bitop3:0xa8
    v_bitop3_b32 v15, v6, v15, v46 bitop3:0xca
    v_bitop3_b32 v14, v6, v14, v47 bitop3:0xca
    s_waitcnt lgkmcnt(1)
    v_mfma_f32_4x4x4_16b_bf16 v[80:83], v[10:11], v[70:71], v[80:83]
    s_waitcnt lgkmcnt(0)
    v_mfma_f32_4x4x4_16b_bf16 v[76:79], v[10:11], v[68:69], v[76:79]
    s_nop 2
    v_cvt_pk_bf16_f32 v80, v80, v81
    v_cvt_pk_bf16_f32 v81, v82, v83
    ds_wrxchg_rtn_b64 v[74:75], v93, v[80:81] offset:65408
    v_cvt_pk_bf16_f32 v76, v76, v77
    v_cvt_pk_bf16_f32 v77, v78, v79
    ds_wrxchg_rtn_b64 v[72:73], v92, v[76:77] offset:65408
    v_mfma_f32_4x4x4_16b_bf16 v[80:83], v[8:9], v[106:107], 0
    v_mfma_f32_4x4x4_16b_bf16 v[76:79], v[8:9], v[104:105], 0
    v_cmp_lt_u32 s[48:49], v5, v95
    s_nop 2
    v_pk_mul_f32 v[80:81], v[80:81], v[14:15] op_sel:[0,1] op_sel_hi:[1,1]
    v_pk_mul_f32 v[82:83], v[82:83], v[14:15] op_sel:[0,1] op_sel_hi:[1,1]
    v_pk_mul_f32 v[76:77], v[76:77], v[14:15] op_sel:[0,0] op_sel_hi:[1,0]
    v_pk_mul_f32 v[78:79], v[78:79], v[14:15] op_sel:[0,0] op_sel_hi:[1,0]
    buffer_load_dwordx4 v[108:111], v3, s[16:19], s40 offen offset:0 sc1
    v_and_b32 v46, 0x80000000, v27
    v_lshrrev_b32 v47, 14, v25
    v_bitop3_b32 v47, v47, v5, v46 bitop3:0xea
    ds_read_b64 v[102:103], v47
    v_and_b32 v99, 0x40000000, v27
    v_lshrrev_b32 v47, 14, v24
    v_bitop3_b32 v47, v47, v5, v99 bitop3:0xea
    ds_read_b64 v[100:101], v47
    s_waitcnt lgkmcnt(2)
    v_cmp_ne_u64 s[50:51], v[72:73], v[68:69]
    v_cmpx_ne_u64 s[54:55], v[74:75], v[70:71]
    s_and_b64 s[82:83], s[54:55], s[80:81]
    s_cbranch_scc1 L2_c87
L2_d87:
    v_mov_b64 v[84:85], v[70:71]
    v_mov_b32 v7, v93
    v_mov_b64 v[86:87], v[74:75]
    s_or_b64 s[80:81], s[80:81], s[54:55]
    s_mov_b64 exec, s[50:51]
    s_and_b64 s[82:83], s[50:51], s[80:81]
    s_cbranch_scc1 L2_c88
L2_d88:
    v_mov_b64 v[84:85], v[68:69]
    v_mov_b32 v7, v92
    v_mov_b64 v[86:87], v[72:73]
    s_mov_b64 exec, -1
    s_or_b64 s[80:81], s[80:81], s[50:51]
    s_and_b64 exec, s[48:49], s[80:81]
    v_mfma_f32_4x4x4_16b_bf16 v[80:83], v[12:13], v[84:85], 0
    v_mov_b32 v95, v7
    s_andn2_b64 s[80:81], s[80:81], s[48:49]
    v_mfma_f32_4x4x4_16b_bf16 v[80:83], v[10:11], v[86:87], v[80:83]
    s_mov_b64 exec, -1
    ds_read_b64 v[70:71], v95 offset:65408
    ds_read_b64 v[68:69], v94 offset:65408
    v_bitop3_b32 v92, v24, v5, v99 bitop3:0xea
    v_bitop3_b32 v93, v25, v5, v46 bitop3:0xea
    v_perm_b32 v15, v25, v26, s47
    v_bitop3_b32 v46, v25, 0.5, -0.5 bitop3:0xa8
    v_perm_b32 v14, v24, v26, s46
    v_bitop3_b32 v47, v24, 0.5, -0.5 bitop3:0xa8
    v_bitop3_b32 v15, v6, v15, v46 bitop3:0xca
    v_bitop3_b32 v14, v6, v14, v47 bitop3:0xca
    s_waitcnt lgkmcnt(1)
    v_mfma_f32_4x4x4_16b_bf16 v[80:83], v[10:11], v[70:71], v[80:83]
    s_waitcnt lgkmcnt(0)
    v_mfma_f32_4x4x4_16b_bf16 v[76:79], v[10:11], v[68:69], v[76:79]
    s_nop 2
    v_cvt_pk_bf16_f32 v80, v80, v81
    v_cvt_pk_bf16_f32 v81, v82, v83
    ds_wrxchg_rtn_b64 v[74:75], v95, v[80:81] offset:65408
    v_cvt_pk_bf16_f32 v76, v76, v77
    v_cvt_pk_bf16_f32 v77, v78, v79
    ds_wrxchg_rtn_b64 v[72:73], v94, v[76:77] offset:65408
    v_and_b32 v88, 0x0fffffff, v41
    buffer_load_dwordx2 v[22:23], v88, s[8:11], 0 offen
    buffer_load_dwordx3 v[24:26], v88, s[8:11], 0 offen offset:8
    s_setprio 2
    v_mfma_f32_4x4x4_16b_bf16 v[80:83], v[8:9], v[102:103], 0
    v_mfma_f32_4x4x4_16b_bf16 v[76:79], v[8:9], v[100:101], 0
    s_nop 3
    v_pk_mul_f32 v[80:81], v[80:81], v[14:15] op_sel:[0,1] op_sel_hi:[1,1]
    v_pk_mul_f32 v[82:83], v[82:83], v[14:15] op_sel:[0,1] op_sel_hi:[1,1]
    v_pk_mul_f32 v[76:77], v[76:77], v[14:15] op_sel:[0,0] op_sel_hi:[1,0]
    v_pk_mul_f32 v[78:79], v[78:79], v[14:15] op_sel:[0,0] op_sel_hi:[1,0]
    s_waitcnt vmcnt(10)
    v_and_b32 v46, 0x20000000, v33
    v_lshrrev_b32 v47, 14, v29
    v_bitop3_b32 v47, v47, v5, v46 bitop3:0xea
    ds_read_b64 v[106:107], v47
    v_and_b32 v99, 0x10000000, v33
    v_lshrrev_b32 v47, 14, v28
    v_bitop3_b32 v47, v47, v5, v99 bitop3:0xea
    ds_read_b64 v[104:105], v47
    s_waitcnt lgkmcnt(2)
    v_cmp_ne_u64 s[50:51], v[72:73], v[68:69]
    v_cmpx_ne_u64 s[54:55], v[74:75], v[70:71]
    s_and_b64 s[82:83], s[54:55], s[80:81]
    s_cbranch_scc1 L2_c89
L2_d89:
    v_mov_b64 v[84:85], v[70:71]
    v_mov_b32 v7, v95
    v_mov_b64 v[86:87], v[74:75]
    s_or_b64 s[80:81], s[80:81], s[54:55]
    s_mov_b64 exec, s[50:51]
    s_and_b64 s[82:83], s[50:51], s[80:81]
    s_cbranch_scc1 L2_c90
L2_d90:
    v_mov_b64 v[84:85], v[68:69]
    v_mov_b32 v7, v94
    v_mov_b64 v[86:87], v[72:73]
    s_mov_b64 exec, -1
    s_or_b64 s[80:81], s[80:81], s[50:51]
    ds_read_b64 v[70:71], v93 offset:65408
    ds_read_b64 v[68:69], v92 offset:65408
    v_bitop3_b32 v94, v28, v5, v99 bitop3:0xea
    v_bitop3_b32 v95, v29, v5, v46 bitop3:0xea
    v_perm_b32 v15, v29, v32, s45
    v_bitop3_b32 v46, v29, 0.5, -0.5 bitop3:0xa8
    v_perm_b32 v14, v28, v32, s44
    v_bitop3_b32 v47, v28, 0.5, -0.5 bitop3:0xa8
    v_bitop3_b32 v15, v6, v15, v46 bitop3:0xca
    v_bitop3_b32 v14, v6, v14, v47 bitop3:0xca
    s_waitcnt lgkmcnt(1)
    v_mfma_f32_4x4x4_16b_bf16 v[80:83], v[10:11], v[70:71], v[80:83]
    s_waitcnt lgkmcnt(0)
    v_mfma_f32_4x4x4_16b_bf16 v[76:79], v[10:11], v[68:69], v[76:79]
    s_nop 2
    v_cvt_pk_bf16_f32 v80, v80, v81
    v_cvt_pk_bf16_f32 v81, v82, v83
    ds_wrxchg_rtn_b64 v[74:75], v93, v[80:81] offset:65408
    v_cvt_pk_bf16_f32 v76, v76, v77
    v_cvt_pk_bf16_f32 v77, v78, v79
    ds_wrxchg_rtn_b64 v[72:73], v92, v[76:77] offset:65408
    s_setprio 1
    v_mfma_f32_4x4x4_16b_bf16 v[80:83], v[8:9], v[106:107], 0
    v_mfma_f32_4x4x4_16b_bf16 v[76:79], v[8:9], v[104:105], 0
    v_cmp_lt_u32 s[84:85], v5, v94
    s_nop 2
    v_pk_mul_f32 v[80:81], v[80:81], v[14:15] op_sel:[0,1] op_sel_hi:[1,1]
    v_pk_mul_f32 v[82:83], v[82:83], v[14:15] op_sel:[0,1] op_sel_hi:[1,1]
    v_pk_mul_f32 v[76:77], v[76:77], v[14:15] op_sel:[0,0] op_sel_hi:[1,0]
    v_pk_mul_f32 v[78:79], v[78:79], v[14:15] op_sel:[0,0] op_sel_hi:[1,0]
    s_bitcmp1_b32 s43, s42
    s_cbranch_scc1 L2_oa91
L2_ob91:
    buffer_load_dwordx4 v[112:115], v3, s[16:19], s40 offen offset:1024 sc1
    v_sub_u16 v88, v60, v52
    v_and_b32 v89, 3, v52
    v_add3_u32 v99, v88, v89, 3
    v_and_b32 v99, -4, v99
    v_max_u32 v99, 4, v99
    v_and_b32 v97, 0xfffc, v52
    v_bfm_b32 v96, v88, v89
    v_add_u32_dpp v91, v99, v99 row_shr:1 row_mask:0xf bank_mask:0xf bound_ctrl:1
    v_mad_u32_u24 v97, v97, 5, v2
    v_cmp_lt_u32 vcc, 16, v99
    v_add_u32_dpp v91, v91, v91 row_shr:2 row_mask:0xf bank_mask:0xf bound_ctrl:1
    v_sub_u32 v98, s38, v99
    v_lshrrev_b64 v[52:53], 16, v[52:53]
    v_add_u32_dpp v91, v91, v91 row_shr:4 row_mask:0xf bank_mask:0xf bound_ctrl:1
    v_lshrrev_b64 v[60:61], 16, v[60:61]
    s_mov_b32 s101, 0
    v_add_u32_dpp v91, v91, v91 row_shr:8 row_mask:0xf bank_mask:0xf bound_ctrl:1
    s_nop 1
    v_add_u32_dpp v91, v91, v91 row_bcast:15 row_mask:0xa bank_mask:0xf
    s_nop 1
    v_add_u32_dpp v91, v91, v91 row_bcast:31 row_mask:0xc bank_mask:0xf
    v_add_u32 v98, v98, v91
    v_readlane_b32 s37, v91, 63
    s_cbranch_vccnz L2_xo92
L2_xp92:
    v_and_b32 v46, 0x80000000, v33
    v_lshrrev_b32 v47, 14, v31
    v_bitop3_b32 v47, v47, v5, v46 bitop3:0xea
    ds_read_b64 v[102:103], v47
    v_and_b32 v99, 0x40000000, v33
    v_lshrrev_b32 v47, 14, v30
    v_bitop3_b32 v47, v47, v5, v99 bitop3:0xea
    ds_read_b64 v[100:101], v47
    s_waitcnt lgkmcnt(2)
    v_cmp_ne_u64 s[50:51], v[72:73], v[68:69]
    v_cmpx_ne_u64 s[54:55], v[74:75], v[70:71]
    s_and_b64 s[82:83], s[54:55], s[80:81]
    s_cbranch_scc1 L2_c93
L2_d93:
    v_mov_b64 v[84:85], v[70:71]
    v_mov_b32 v7, v93
    v_mov_b64 v[86:87], v[74:75]
    s_or_b64 s[80:81], s[80:81], s[54:55]
    s_mov_b64 exec, s[50:51]
    s_and_b64 s[82:83], s[50:51], s[80:81]
    s_cbranch_scc1 L2_c94
L2_d94:
    v_mov_b64 v[84:85], v[68:69]
    v_mov_b32 v7, v92
    v_mov_b64 v[86:87], v[72:73]
    s_mov_b64 exec, -1
    s_or_b64 s[80:81], s[80:81], s[50:51]
    s_and_b64 exec, s[84:85], s[80:81]
    v_mfma_f32_4x4x4_16b_bf16 v[76:79], v[12:13], v[84:85], 0
    v_mov_b32 v94, v7
    s_andn2_b64 s[80:81], s[80:81], s[84:85]
    v_mfma_f32_4x4x4_16b_bf16 v[76:79], v[10:11], v[86:87], v[76:79]
    s_mov_b64 exec, -1
    ds_read_b64 v[70:71], v95 offset:65408
    ds_read_b64 v[68:69], v94 offset:65408
    v_bitop3_b32 v92, v30, v5, v99 bitop3:0xea
    v_bitop3_b32 v93, v31, v5, v46 bitop3:0xea
    v_perm_b32 v15, v31, v32, s47
    v_bitop3_b32 v46, v31, 0.5, -0.5 bitop3:0xa8
    v_perm_b32 v14, v30, v32, s46
    v_bitop3_b32 v47, v30, 0.5, -0.5 bitop3:0xa8
    v_bitop3_b32 v15, v6, v15, v46 bitop3:0xca
    v_bitop3_b32 v14, v6, v14, v47 bitop3:0xca
    s_waitcnt lgkmcnt(1)
    v_mfma_f32_4x4x4_16b_bf16 v[80:83], v[10:11], v[70:71], v[80:83]
    s_waitcnt lgkmcnt(0)
    v_mfma_f32_4x4x4_16b_bf16 v[76:79], v[10:11], v[68:69], v[76:79]
    s_nop 2
    v_cvt_pk_bf16_f32 v80, v80, v81
    v_cvt_pk_bf16_f32 v81, v82, v83
    ds_wrxchg_rtn_b64 v[74:75], v95, v[80:81] offset:65408
    v_cvt_pk_bf16_f32 v76, v76, v77
    v_cvt_pk_bf16_f32 v77, v78, v79
    ds_wrxchg_rtn_b64 v[72:73], v94, v[76:77] offset:65408
    v_and_b32 v88, 0x0fffffff, v42
    buffer_load_dwordx2 v[28:29], v88, s[8:11], 0 offen
    buffer_load_dwordx3 v[30:32], v88, s[8:11], 0 offen offset:8
    s_setprio 0
    v_mfma_f32_4x4x4_16b_bf16 v[80:83], v[8:9], v[102:103], 0
    v_mfma_f32_4x4x4_16b_bf16 v[76:79], v[8:9], v[100:101], 0
    v_cmp_lt_u32 s[48:49], v5, v93
    s_nop 2
    v_pk_mul_f32 v[80:81], v[80:81], v[14:15] op_sel:[0,1] op_sel_hi:[1,1]
    v_pk_mul_f32 v[82:83], v[82:83], v[14:15] op_sel:[0,1] op_sel_hi:[1,1]
    v_pk_mul_f32 v[76:77], v[76:77], v[14:15] op_sel:[0,0] op_sel_hi:[1,0]
    v_pk_mul_f32 v[78:79], v[78:79], v[14:15] op_sel:[0,0] op_sel_hi:[1,0]
    s_add_u32 s40, s40, 0x50000
    s_waitcnt vmcnt(8)
    v_and_b32 v46, 0x80000000, v39
    v_lshrrev_b32 v47, 14, v37
    v_bitop3_b32 v47, v47, v5, v46 bitop3:0xea
    ds_read_b64 v[102:103], v47
    v_and_b32 v99, 0x40000000, v39
    v_lshrrev_b32 v47, 14, v36
    v_bitop3_b32 v47, v47, v5, v99 bitop3:0xea
    ds_read_b64 v[100:101], v47
    v_and_b32 v46, 0x20000000, v39
    v_lshrrev_b32 v47, 14, v35
    v_bitop3_b32 v47, v47, v5, v46 bitop3:0xea
    ds_read_b64 v[106:107], v47
    v_and_b32 v99, 0x10000000, v39
    v_lshrrev_b32 v47, 14, v34
    v_bitop3_b32 v47, v47, v5, v99 bitop3:0xea
    ds_read_b64 v[104:105], v47
    s_waitcnt lgkmcnt(4)
    v_cmp_ne_u64 s[50:51], v[72:73], v[68:69]
    v_cmpx_ne_u64 s[54:55], v[74:75], v[70:71]
    s_and_b64 s[82:83], s[54:55], s[80:81]
    s_cbranch_scc1 L2_c95
L2_d95:
    v_mov_b64 v[84:85], v[70:71]
    v_mov_b32 v7, v95
    v_mov_b64 v[86:87], v[74:75]
    s_or_b64 s[80:81], s[80:81], s[54:55]
    s_mov_b64 exec, s[50:51]
    s_and_b64 s[82:83], s[50:51], s[80:81]
    s_cbranch_scc1 L2_c96
L2_d96:
    v_mov_b64 v[84:85], v[68:69]
    v_mov_b32 v7, v94
    v_mov_b64 v[86:87], v[72:73]
    s_mov_b64 exec, -1
    s_or_b64 s[80:81], s[80:81], s[50:51]
    s_and_b64 exec, s[48:49], s[80:81]
    v_mfma_f32_4x4x4_16b_bf16 v[80:83], v[12:13], v[84:85], 0
    v_mov_b32 v93, v7
    s_andn2_b64 s[80:81], s[80:81], s[48:49]
    v_mfma_f32_4x4x4_16b_bf16 v[80:83], v[10:11], v[86:87], v[80:83]
    s_mov_b64 exec, -1
    ds_read_b64 v[70:71], v93 offset:65408
    ds_read_b64 v[68:69], v92 offset:65408
    v_bitop3_b32 v94, v34, v5, v99 bitop3:0xea
    v_bitop3_b32 v95, v35, v5, v46 bitop3:0xea
    v_perm_b32 v15, v35, v38, s45
    v_bitop3_b32 v46, v35, 0.5, -0.5 bitop3:0xa8
    v_perm_b32 v14, v34, v38, s44
    v_bitop3_b32 v47, v34, 0.5, -0.5 bitop3:0xa8
    v_bitop3_b32 v15, v6, v15, v46 bitop3:0xca
    v_bitop3_b32 v14, v6, v14, v47 bitop3:0xca
    s_waitcnt lgkmcnt(1)
    v_mfma_f32_4x4x4_16b_bf16 v[80:83], v[10:11], v[70:71], v[80:83]
    s_waitcnt lgkmcnt(0)
    v_mfma_f32_4x4x4_16b_bf16 v[76:79], v[10:11], v[68:69], v[76:79]
    s_nop 2
    v_cvt_pk_bf16_f32 v80, v80, v81
    v_cvt_pk_bf16_f32 v81, v82, v83
    ds_wrxchg_rtn_b64 v[74:75], v93, v[80:81] offset:65408
    v_cvt_pk_bf16_f32 v76, v76, v77
    v_cvt_pk_bf16_f32 v77, v78, v79
    ds_wrxchg_rtn_b64 v[72:73], v92, v[76:77] offset:65408
    s_barrier
    s_setprio 3
    s_mov_b32 m0, s100
    s_nop 0
    ds_write_addtid_b32 v124 offset:34816
    ds_write_addtid_b32 v125 offset:35072
    ds_write_addtid_b32 v126 offset:35328
    ds_write_addtid_b32 v127 offset:35584
    s_add_u32 s3, s40, 4096
    buffer_load_dwordx4 v[124:127], v3, s[16:19], s3 offen sc1
    ds_write_addtid_b32 v116 offset:32768
    ds_write_addtid_b32 v117 offset:33024
    ds_write_addtid_b32 v118 offset:33280
    ds_write_addtid_b32 v119 offset:33536
    buffer_load_dwordx4 v[116:119], v3, s[16:19], s40 offen offset:2048 sc1
    ds_write_addtid_b32 v120 offset:33792
    ds_write_addtid_b32 v121 offset:34048
    ds_write_addtid_b32 v122 offset:34304
    ds_write_addtid_b32 v123 offset:34560
    buffer_load_dwordx4 v[120:123], v3, s[16:19], s40 offen offset:3072 sc1
    v_mfma_f32_4x4x4_16b_bf16 v[80:83], v[8:9], v[106:107], 0
    v_mfma_f32_4x4x4_16b_bf16 v[76:79], v[8:9], v[104:105], 0
    s_nop 3
    v_pk_mul_f32 v[80:81], v[80:81], v[14:15] op_sel:[0,1] op_sel_hi:[1,1]
    v_pk_mul_f32 v[82:83], v[82:83], v[14:15] op_sel:[0,1] op_sel_hi:[1,1]
    v_pk_mul_f32 v[76:77], v[76:77], v[14:15] op_sel:[0,0] op_sel_hi:[1,0]
    v_pk_mul_f32 v[78:79], v[78:79], v[14:15] op_sel:[0,0] op_sel_hi:[1,0]
    s_cmp_gt_u32 s37, 1024
    s_cbranch_scc1 L2_xs97
    s_cmp_lg_u32 s101, 0
    s_cbranch_scc1 L2_xa97
L2_xb97:
    v_lshlrev_b32 v89, 16, v96
    v_add_u32 v90, 60, v97
    v_bitop3_b32 v90, v89, v45, v90 bitop3:0x6a
    ds_write_b32 v98, v90 offset:12
    v_lshlrev_b32 v89, 20, v96
    v_add_u32 v90, 40, v97
    v_bitop3_b32 v90, v89, v45, v90 bitop3:0x6a
    ds_write_b32 v98, v90 offset:8
    v_lshlrev_b32 v89, 24, v96
    v_add_u32 v90, 20, v97
    v_bitop3_b32 v90, v89, v45, v90 bitop3:0x6a
    ds_write_b32 v98, v90 offset:4
    v_lshlrev_b32 v89, 28, v96
    v_bitop3_b32 v90, v89, v45, v97 bitop3:0x6a
    ds_write_b32 v98, v90 offset:0
    v_mov_b32_dpp v91, v64 quad_perm:[1,1,1,1] row_mask:0xf bank_mask:0xf
    v_and_b32 v89, 3, v91
    v_and_b32 v97, 0xfffc, v91
    v_sub_u16_dpp v88, v64, v91 quad_perm:[3,3,3,3] row_mask:0xf bank_mask:0xf
    v_mad_u32_u24 v97, v97, 5, v4
    v_add_u32 v99, v88, v89
    v_bfm_b32 v96, v88, v89
    v_cmp_lt_u32 s[58:59], 16, v99
    v_lshlrev_b32 v89, v1, v96
    v_and_b32 v89, v45, v89
    v_cmp_ne_u32 vcc, 0, v89
    v_xor_b32 v90, v97, v89
    s_add_u32 s3, s37, s38
    v_mbcnt_lo_u32_b32 v98, vcc_lo, 0
    v_mbcnt_hi_u32_b32 v98, vcc_hi, v98
    s_bcnt1_i32_b64 s41, vcc
    v_lshl_add_u32 v98, v98, 2, s3
    s_lshl2_add_u32 s37, s41, s37
    s_mov_b64 exec, vcc
    ds_write_b32 v98, v90
    s_mov_b64 exec, -1
    s_cmp_lg_u64 s[58:59], 0
    s_cbranch_scc1 L2_xe97
L2_xr97:
    v_add_u32 v98, s37, v0
    v_mov_b32 v90, -1
    ds_write_b32 v98, v90
L2_xw97:
    s_setprio 2
    s_waitcnt lgkmcnt(14)
    v_cmp_ne_u64 s[50:51], v[72:73], v[68:69]
    v_cmpx_ne_u64 s[54:55], v[74:75], v[70:71]
    s_and_b64 s[82:83], s[54:55], s[80:81]
    s_cbranch_scc1 L2_c98
L2_d98:
    v_mov_b64 v[84:85], v[70:71]
    v_mov_b32 v7, v93
    v_mov_b64 v[86:87], v[74:75]
    s_or_b64 s[80:81], s[80:81], s[54:55]
    s_mov_b64 exec, s[50:51]
    s_and_b64 s[82:83], s[50:51], s[80:81]
    s_cbranch_scc1 L2_c99
L2_d99:
    v_mov_b64 v[84:85], v[68:69]
    v_mov_b32 v7, v92
    v_mov_b64 v[86:87], v[72:73]
    s_mov_b64 exec, -1
    s_or_b64 s[80:81], s[80:81], s[50:51]
    ds_read_b64 v[70:71], v95 offset:65408
    ds_read_b64 v[68:69], v94 offset:65408
    v_and_b32 v46, 0x40000000, v39
    v_bitop3_b32 v92, v36, v5, v46 bitop3:0xea
    v_and_b32 v46, 0x80000000, v39
    v_bitop3_b32 v93, v37, v5, v46 bitop3:0xea
    v_perm_b32 v15, v37, v38, s47
    v_bitop3_b32 v46, v37, 0.5, -0.5 bitop3:0xa8
    v_perm_b32 v14, v36, v38, s46
    v_bitop3_b32 v47, v36, 0.5, -0.5 bitop3:0xa8
    v_bitop3_b32 v15, v6, v15, v46 bitop3:0xca
    v_bitop3_b32 v14, v6, v14, v47 bitop3:0xca
    s_setprio 1
    s_waitcnt lgkmcnt(1)
    v_mfma_f32_4x4x4_16b_bf16 v[80:83], v[10:11], v[70:71], v[80:83]
    s_waitcnt lgkmcnt(0)
    v_mfma_f32_4x4x4_16b_bf16 v[76:79], v[10:11], v[68:69], v[76:79]
    s_nop 2
    v_cvt_pk_bf16_f32 v80, v80, v81
    v_cvt_pk_bf16_f32 v81, v82, v83
    ds_wrxchg_rtn_b64 v[74:75], v95, v[80:81] offset:65408
    v_cvt_pk_bf16_f32 v76, v76, v77
    v_cvt_pk_bf16_f32 v77, v78, v79
    ds_wrxchg_rtn_b64 v[72:73], v94, v[76:77] offset:65408
    ds_read_b32 v19, v44 offset:768
    ds_read_b32 v27, v0 offset:0
    ds_read_b32 v33, v0 offset:256
    ds_read_b32 v39, v0 offset:512
    s_sub_u32 s3, s37, 768
    s_cmp_gt_u32 s3, 128
    s_cbranch_scc1 L2_xf97
L2_xg97:
    v_and_b32 v88, 0x0fffffff, v43
    buffer_load_dwordx2 v[34:35], v88, s[8:11], 0 offen
    buffer_load_dwordx3 v[36:38], v88, s[8:11], 0 offen offset:8
    s_setprio 0
    s_waitcnt vmcnt(10)
    s_mov_b32 m0, s38
    s_nop 0
    ds_write_addtid_b32 v108 offset:0
    ds_write_addtid_b32 v109 offset:256
    ds_write_addtid_b32 v110 offset:512
    ds_write_addtid_b32 v111 offset:768
    s_waitcnt vmcnt(7)
    ds_write_addtid_b32 v112 offset:1024
    ds_write_addtid_b32 v113 offset:1280
    ds_write_addtid_b32 v114 offset:1536
    ds_write_addtid_b32 v115 offset:1792
    v_mfma_f32_4x4x4_16b_bf16 v[80:83], v[8:9], v[102:103], 0
    v_mfma_f32_4x4x4_16b_bf16 v[76:79], v[8:9], v[100:101], 0
    v_cmp_lt_u32 s[84:85], v5, v92
    s_nop 2
    v_pk_mul_f32 v[80:81], v[80:81], v[14:15] op_sel:[0,1] op_sel_hi:[1,1]
    v_pk_mul_f32 v[82:83], v[82:83], v[14:15] op_sel:[0,1] op_sel_hi:[1,1]
    v_pk_mul_f32 v[76:77], v[76:77], v[14:15] op_sel:[0,0] op_sel_hi:[1,0]
    v_pk_mul_f32 v[78:79], v[78:79], v[14:15] op_sel:[0,0] op_sel_hi:[1,0]
    s_add_u32 s42, s42, 1
    s_waitcnt lgkmcnt(0)
    s_barrier
    s_bitcmp1_b32 s36, s42
    s_cbranch_scc1 L2_slow
L2_ret5:
    s_setprio 3
    s_bitcmp1_b32 s43, s42
    s_cbranch_scc1 L2_oa100
L2_ob100:
    s_mov_b64 exec, s[6:7]
    v_lshrrev_b32 v18, 16, v18
    s_mov_b64 exec, -1
    v_and_b32 v46, 0x20000000, v40
    v_lshrrev_b32 v47, 14, v17
    v_bitop3_b32 v47, v47, v5, v46 bitop3:0xea
    ds_read_b64 v[106:107], v47
    v_and_b32 v99, 0x10000000, v40
    v_lshrrev_b32 v47, 14, v16
    v_bitop3_b32 v47, v47, v5, v99 bitop3:0xea
    ds_read_b64 v[104:105], v47
    v_cmp_ne_u64 s[50:51], v[72:73], v[68:69]
    v_cmpx_ne_u64 s[54:55], v[74:75], v[70:71]
    s_and_b64 s[82:83], s[54:55], s[80:81]
    s_cbranch_scc1 L2_c101
L2_d101:
    v_mov_b64 v[84:85], v[70:71]
    v_mov_b32 v7, v95
    v_mov_b64 v[86:87], v[74:75]
    s_or_b64 s[80:81], s[80:81], s[54:55]
    s_mov_b64 exec, s[50:51]
    s_and_b64 s[82:83], s[50:51], s[80:81]
    s_cbranch_scc1 L2_c102
L2_d102:
    v_mov_b64 v[84:85], v[68:69]
    v_mov_b32 v7, v94
    v_mov_b64 v[86:87], v[72:73]
    s_mov_b64 exec, -1
    s_or_b64 s[80:81], s[80:81], s[50:51]
    s_and_b64 exec, s[84:85], s[80:81]
    v_mfma_f32_4x4x4_16b_bf16 v[76:79], v[12:13], v[84:85], 0
    v_mov_b32 v92, v7
    s_andn2_b64 s[80:81], s[80:81], s[84:85]
    v_mfma_f32_4x4x4_16b_bf16 v[76:79], v[10:11], v[86:87], v[76:79]
    s_mov_b64 exec, -1
    ds_read_b64 v[70:71], v93 offset:65408
    ds_read_b64 v[68:69], v92 offset:65408
    v_bitop3_b32 v94, v16, v5, v99 bitop3:0xea
    v_bitop3_b32 v95, v17, v5, v46 bitop3:0xea
    v_perm_b32 v15, v17, v18, s45
    v_bitop3_b32 v46, v17, 0.5, -0.5 bitop3:0xa8
    v_perm_b32 v14, v16, v18, s44
    v_bitop3_b32 v47, v16, 0.5, -0.5 bitop3:0xa8
    v_bitop3_b32 v15, v6, v15, v46 bitop3:0xca
    v_bitop3_b32 v14, v6, v14, v47 bitop3:0xca
    s_waitcnt lgkmcnt(1)
    v_mfma_f32_4x4x4_16b_bf16 v[80:83], v[10:11], v[70:71], v[80:83]
    s_waitcnt lgkmcnt(0)
    v_mfma_f32_4x4x4_16b_bf16 v[76:79], v[10:11], v[68:69], v[76:79]
    s_nop 2
    v_cvt_pk_bf16_f32 v80, v80, v81
    v_cvt_pk_bf16_f32 v81, v82, v83
    ds_wrxchg_rtn_b64 v[74:75], v93, v[80:81] offset:65408
    v_cvt_pk_bf16_f32 v76, v76, v77
    v_cvt_pk_bf16_f32 v77, v78, v79
    ds_wrxchg_rtn_b64 v[72:73], v92, v[76:77] offset:65408
    v_mfma_f32_4x4x4_16b_bf16 v[80:83], v[8:9], v[106:107], 0
    v_mfma_f32_4x4x4_16b_bf16 v[76:79], v[8:9], v[104:105], 0
    v_cmp_lt_u32 s[84:85], v5, v94
    s_nop 2
    v_pk_mul_f32 v[80:81], v[80:81], v[14:15] op_sel:[0,1] op_sel_hi:[1,1]
    v_pk_mul_f32 v[82:83], v[82:83], v[14:15] op_sel:[0,1] op_sel_hi:[1,1]
    v_pk_mul_f32 v[76:77], v[76:77], v[14:15] op_sel:[0,0] op_sel_hi:[1,0]
    v_pk_mul_f32 v[78:79], v[78:79], v[14:15] op_sel:[0,0] op_sel_hi:[1,0]
    v_and_b32 v47, 0x0fffffff, v19
    buffer_load_dword v18, v47, s[8:11], 0 offen offset:16
    s_mov_b64 exec, s[6:7]
    v_add_u32 v47, 8, v47
    v_lshrrev_b32 v19, 2, v19
    s_mov_b64 exec, -1
    buffer_load_dwordx2 v[16:17], v47, s[8:11], 0 offen
    v_and_b32 v46, 0x20000000, v41
    v_lshrrev_b32 v47, 14, v23
    v_bitop3_b32 v47, v47, v5, v46 bitop3:0xea
    ds_read_b64 v[102:103], v47
    v_and_b32 v99, 0x10000000, v41
    v_lshrrev_b32 v47, 14, v22
    v_bitop3_b32 v47, v47, v5, v99 bitop3:0xea
    ds_read_b64 v[100:101], v47
    s_waitcnt lgkmcnt(2)
    v_cmp_ne_u64 s[50:51], v[72:73], v[68:69]
    v_cmpx_ne_u64 s[54:55], v[74:75], v[70:71]
    s_and_b64 s[82:83], s[54:55], s[80:81]
    s_cbranch_scc1 L2_c103
L2_d103:
    v_mov_b64 v[84:85], v[70:71]
    v_mov_b32 v7, v93
    v_mov_b64 v[86:87], v[74:75]
    s_or_b64 s[80:81], s[80:81], s[54:55]
    s_mov_b64 exec, s[50:51]
    s_and_b64 s[82:83], s[50:51], s[80:81]
    s_cbranch_scc1 L2_c104
L2_d104:
    v_mov_b64 v[84:85], v[68:69]
    v_mov_b32 v7, v92
    v_mov_b64 v[86:87], v[72:73]
    s_mov_b64 exec, -1
    s_or_b64 s[80:81], s[80:81], s[50:51]
    s_and_b64 exec, s[84:85], s[80:81]
    v_mfma_f32_4x4x4_16b_bf16 v[76:79], v[12:13], v[84:85], 0
    v_mov_b32 v94, v7
    s_andn2_b64 s[80:81], s[80:81], s[84:85]
    v_mfma_f32_4x4x4_16b_bf16 v[76:79], v[10:11], v[86:87], v[76:79]
    s_mov_b64 exec, -1
    ds_read_b64 v[70:71], v95 offset:65408
    ds_read_b64 v[68:69], v94 offset:65408
    v_bitop3_b32 v92, v22, v5, v99 bitop3:0xea
    v_bitop3_b32 v93, v23, v5, v46 bitop3:0xea
    v_perm_b32 v15, v23, v26, s45
    v_bitop3_b32 v46, v23, 0.5, -0.5 bitop3:0xa8
    v_perm_b32 v14, v22, v26, s44
    v_bitop3_b32 v47, v22, 0.5, -0.5 bitop3:0xa8
    v_bitop3_b32 v15, v6, v15, v46 bitop3:0xca
    v_bitop3_b32 v14, v6, v14, v47 bitop3:0xca
    s_waitcnt lgkmcnt(1)
    v_mfma_f32_4x4x4_16b_bf16 v[80:83], v[10:11], v[70:71], v[80:83]
    s_waitcnt lgkmcnt(0)
    v_mfma_f32_4x4x4_16b_bf16 v[76:79], v[10:11], v[68:69], v[76:79]
    s_nop 2
    v_cvt_pk_bf16_f32 v80, v80, v81
    v_cvt_pk_bf16_f32 v81, v82, v83
    ds_wrxchg_rtn_b64 v[74:75], v95, v[80:81] offset:65408
    v_cvt_pk_bf16_f32 v76, v76, v77
    v_cvt_pk_bf16_f32 v77, v78, v79
    ds_wrxchg_rtn_b64 v[72:73], v94, v[76:77] offset:65408
    v_mfma_f32_4x4x4_16b_bf16 v[80:83], v[8:9], v[102:103], 0
    v_mfma_f32_4x4x4_16b_bf16 v[76:79], v[8:9], v[100:101], 0
    v_cmp_lt_u32 s[48:49], v5, v93
    s_nop 2
    v_pk_mul_f32 v[80:81], v[80:81], v[14:15] op_sel:[0,1] op_sel_hi:[1,1]
    v_pk_mul_f32 v[82:83], v[82:83], v[14:15] op_sel:[0,1] op_sel_hi:[1,1]
    v_pk_mul_f32 v[76:77], v[76:77], v[14:15] op_sel:[0,0] op_sel_hi:[1,0]
    v_pk_mul_f32 v[78:79], v[78:79], v[14:15] op_sel:[0,0] op_sel_hi:[1,0]
    buffer_load_dwordx4 v[108:111], v3, s[16:19], s40 offen offset:0 sc1
    v_and_b32 v46, 0x80000000, v41
    v_lshrrev_b32 v47, 14, v25
    v_bitop3_b32 v47, v47, v5, v46 bitop3:0xea
    ds_read_b64 v[106:107], v47
    v_and_b32 v99, 0x40000000, v41
    v_lshrrev_b32 v47, 14, v24
    v_bitop3_b32 v47, v47, v5, v99 bitop3:0xea
    ds_read_b64 v[104:105], v47
    s_waitcnt lgkmcnt(2)
    v_cmp_ne_u64 s[50:51], v[72:73], v[68:69]
    v_cmpx_ne_u64 s[54:55], v[74:75], v[70:71]
    s_and_b64 s[82:83], s[54:55], s[80:81]
    s_cbranch_scc1 L2_c105
L2_d105:
    v_mov_b64 v[84:85], v[70:71]
    v_mov_b32 v7, v95
    v_mov_b64 v[86:87], v[74:75]
    s_or_b64 s[80:81], s[80:81], s[54:55]
    s_mov_b64 exec, s[50:51]
    s_and_b64 s[82:83], s[50:51], s[80:81]
    s_cbranch_scc1 L2_c106
L2_d106:
    v_mov_b64 v[84:85], v[68:69]
    v_mov_b32 v7, v94
    v_mov_b64 v[86:87], v[72:73]
    s_mov_b64 exec, -1
    s_or_b64 s[80:81], s[80:81], s[50:51]
    s_and_b64 exec, s[48:49], s[80:81]
    v_mfma_f32_4x4x4_16b_bf16 v[80:83], v[12:13], v[84:85], 0
    v_mov_b32 v93, v7
    s_andn2_b64 s[80:81], s[80:81], s[48:49]
    v_mfma_f32_4x4x4_16b_bf16 v[80:83], v[10:11], v[86:87], v[80:83]
    s_mov_b64 exec, -1
    ds_read_b64 v[70:71], v93 offset:65408
    ds_read_b64 v[68:69], v92 offset:65408
    v_bitop3_b32 v94, v24, v5, v99 bitop3:0xea
    v_bitop3_b32 v95, v25, v5, v46 bitop3:0xea
    v_perm_b32 v15, v25, v26, s47
    v_bitop3_b32 v46, v25, 0.5, -0.5 bitop3:0xa8
    v_perm_b32 v14, v24, v26, s46
    v_bitop3_b32 v47, v24, 0.5, -0.5 bitop3:0xa8
    v_bitop3_b32 v15, v6, v15, v46 bitop3:0xca
    v_bitop3_b32 v14, v6, v14, v47 bitop3:0xca
    s_waitcnt lgkmcnt(1)
    v_mfma_f32_4x4x4_16b_bf16 v[80:83], v[10:11], v[70:71], v[80:83]
    s_waitcnt lgkmcnt(0)
    v_mfma_f32_4x4x4_16b_bf16 v[76:79], v[10:11], v[68:69], v[76:79]
    s_nop 2
    v_cvt_pk_bf16_f32 v80, v80, v81
    v_cvt_pk_bf16_f32 v81, v82, v83
    ds_wrxchg_rtn_b64 v[74:75], v93, v[80:81] offset:65408
    v_cvt_pk_bf16_f32 v76, v76, v77
    v_cvt_pk_bf16_f32 v77, v78, v79
    ds_wrxchg_rtn_b64 v[72:73], v92, v[76:77] offset:65408
    v_and_b32 v88, 0x0fffffff, v27
    buffer_load_dwordx2 v[22:23], v88, s[8:11], 0 offen
    buffer_load_dwordx3 v[24:26], v88, s[8:11], 0 offen offset:8
    s_setprio 2
    v_mfma_f32_4x4x4_16b_bf16 v[80:83], v[8:9], v[106:107], 0
    v_mfma_f32_4x4x4_16b_bf16 v[76:79], v[8:9], v[104:105], 0
    s_nop 3
    v_pk_mul_f32 v[80:81], v[80:81], v[14:15] op_sel:[0,1] op_sel_hi:[1,1]
    v_pk_mul_f32 v[82:83], v[82:83], v[14:15] op_sel:[0,1] op_sel_hi:[1,1]
    v_pk_mul_f32 v[76:77], v[76:77], v[14:15] op_sel:[0,0] op_sel_hi:[1,0]
    v_pk_mul_f32 v[78:79], v[78:79], v[14:15] op_sel:[0,0] op_sel_hi:[1,0]
    s_waitcnt vmcnt(10)
    v_and_b32 v46, 0x20000000, v42
    v_lshrrev_b32 v47, 14, v29
    v_bitop3_b32 v47, v47, v5, v46 bitop3:0xea
    ds_read_b64 v[102:103], v47
    v_and_b32 v99, 0x10000000, v42
    v_lshrrev_b32 v47, 14, v28
    v_bitop3_b32 v47, v47, v5, v99 bitop3:0xea
    ds_read_b64 v[100:101], v47
    s_waitcnt lgkmcnt(2)
    v_cmp_ne_u64 s[50:51], v[72:73], v[68:69]
    v_cmpx_ne_u64 s[54:55], v[74:75], v[70:71]
    s_and_b64 s[82:83], s[54:55], s[80:81]
    s_cbranch_scc1 L2_c107
L2_d107:
    v_mov_b64 v[84:85], v[70:71]
    v_mov_b32 v7, v93
    v_mov_b64 v[86:87], v[74:75]
    s_or_b64 s[80:81], s[80:81], s[54:55]
    s_mov_b64 exec, s[50:51]
    s_and_b64 s[82:83], s[50:51], s[80:81]
    s_cbranch_scc1 L2_c108
L2_d108:
    v_mov_b64 v[84:85], v[68:69]
    v_mov_b32 v7, v92
    v_mov_b64 v[86:87], v[72:73]
    s_mov_b64 exec, -1
    s_or_b64 s[80:81], s[80:81], s[50:51]
    ds_read_b64 v[70:71], v95 offset:65408
    ds_read_b64 v[68:69], v94 offset:65408
    v_bitop3_b32 v92, v28, v5, v99 bitop3:0xea
    v_bitop3_b32 v93, v29, v5, v46 bitop3:0xea
    v_perm_b32 v15, v29, v32, s45
    v_bitop3_b32 v46, v29, 0.5, -0.5 bitop3:0xa8
    v_perm_b32 v14, v28, v32, s44
    v_bitop3_b32 v47, v28, 0.5, -0.5 bitop3:0xa8
    v_bitop3_b32 v15, v6, v15, v46 bitop3:0xca
    v_bitop3_b32 v14, v6, v14, v47 bitop3:0xca
    s_waitcnt lgkmcnt(1)
    v_mfma_f32_4x4x4_16b_bf16 v[80:83], v[10:11], v[70:71], v[80:83]
    s_waitcnt lgkmcnt(0)
    v_mfma_f32_4x4x4_16b_bf16 v[76:79], v[10:11], v[68:69], v[76:79]
    s_nop 2
    v_cvt_pk_bf16_f32 v80, v80, v81
    v_cvt_pk_bf16_f32 v81, v82, v83
    ds_wrxchg_rtn_b64 v[74:75], v95, v[80:81] offset:65408
    v_cvt_pk_bf16_f32 v76, v76, v77
    v_cvt_pk_bf16_f32 v77, v78, v79
    ds_wrxchg_rtn_b64 v[72:73], v94, v[76:77] offset:65408
    s_setprio 1
    v_mfma_f32_4x4x4_16b_bf16 v[80:83], v[8:9], v[102:103], 0
    v_mfma_f32_4x4x4_16b_bf16 v[76:79], v[8:9], v[100:101], 0
    v_cmp_lt_u32 s[84:85], v5, v92
    s_nop 2
    v_pk_mul_f32 v[80:81], v[80:81], v[14:15] op_sel:[0,1] op_sel_hi:[1,1]
    v_pk_mul_f32 v[82:83], v[82:83], v[14:15] op_sel:[0,1] op_sel_hi:[1,1]
    v_pk_mul_f32 v[76:77], v[76:77], v[14:15] op_sel:[0,0] op_sel_hi:[1,0]
    v_pk_mul_f32 v[78:79], v[78:79], v[14:15] op_sel:[0,0] op_sel_hi:[1,0]
    s_bitcmp1_b32 s43, s42
    s_cbranch_scc1 L2_oa109
L2_ob109:
    buffer_load_dwordx4 v[112:115], v3, s[16:19], s40 offen offset:1024 sc1
    v_sub_u16 v88, v62, v54
    v_and_b32 v89, 3, v54
    v_add3_u32 v99, v88, v89, 3
    v_and_b32 v99, -4, v99
    v_max_u32 v99, 4, v99
    v_and_b32 v97, 0xfffc, v54
    v_bfm_b32 v96, v88, v89
    v_add_u32_dpp v91, v99, v99 row_shr:1 row_mask:0xf bank_mask:0xf bound_ctrl:1
    v_mad_u32_u24 v97, v97, 5, v2
    v_cmp_lt_u32 vcc, 16, v99
    v_add_u32_dpp v91, v91, v91 row_shr:2 row_mask:0xf bank_mask:0xf bound_ctrl:1
    v_sub_u32 v98, s38, v99
    v_lshrrev_b64 v[54:55], 16, v[54:55]
    v_add_u32_dpp v91, v91, v91 row_shr:4 row_mask:0xf bank_mask:0xf bound_ctrl:1
    v_lshrrev_b64 v[62:63], 16, v[62:63]
    s_mov_b32 s101, 0
    v_add_u32_dpp v91, v91, v91 row_shr:8 row_mask:0xf bank_mask:0xf bound_ctrl:1
    s_nop 1
    v_add_u32_dpp v91, v91, v91 row_bcast:15 row_mask:0xa bank_mask:0xf
    s_nop 1
    v_add_u32_dpp v91, v91, v91 row_bcast:31 row_mask:0xc bank_mask:0xf
    v_add_u32 v98, v98, v91
    v_readlane_b32 s37, v91, 63
    s_cbranch_vccnz L2_xo110
L2_xp110:
    v_and_b32 v46, 0x80000000, v42
    v_lshrrev_b32 v47, 14, v31
    v_bitop3_b32 v47, v47, v5, v46 bitop3:0xea
    ds_read_b64 v[106:107], v47
    v_and_b32 v99, 0x40000000, v42
    v_lshrrev_b32 v47, 14, v30
    v_bitop3_b32 v47, v47, v5, v99 bitop3:0xea
    ds_read_b64 v[104:105], v47
    s_waitcnt lgkmcnt(2)
    v_cmp_ne_u64 s[50:51], v[72:73], v[68:69]
    v_cmpx_ne_u64 s[54:55], v[74:75], v[70:71]
    s_and_b64 s[82:83], s[54:55], s[80:81]
    s_cbranch_scc1 L2_c111
L2_d111:
    v_mov_b64 v[84:85], v[70:71]
    v_mov_b32 v7, v95
    v_mov_b64 v[86:87], v[74:75]
    s_or_b64 s[80:81], s[80:81], s[54:55]
    s_mov_b64 exec, s[50:51]
    s_and_b64 s[82:83], s[50:51], s[80:81]
    s_cbranch_scc1 L2_c112
L2_d112:
    v_mov_b64 v[84:85], v[68:69]
    v_mov_b32 v7, v94
    v_mov_b64 v[86:87], v[72:73]
    s_mov_b64 exec, -1
    s_or_b64 s[80:81], s[80:81], s[50:51]
    s_and_b64 exec, s[84:85], s[80:81]
    v_mfma_f32_4x4x4_16b_bf16 v[76:79], v[12:13], v[84:85], 0
    v_mov_b32 v92, v7
    s_andn2_b64 s[80:81], s[80:81], s[84:85]
    v_mfma_f32_4x4x4_16b_bf16 v[76:79], v[10:11], v[86:87], v[76:79]
    s_mov_b64 exec, -1
    ds_read_b64 v[70:71], v93 offset:65408
    ds_read_b64 v[68:69], v92 offset:65408
    v_bitop3_b32 v94, v30, v5, v99 bitop3:0xea
    v_bitop3_b32 v95, v31, v5, v46 bitop3:0xea
    v_perm_b32 v15, v31, v32, s47
    v_bitop3_b32 v46, v31, 0.5, -0.5 bitop3:0xa8
    v_perm_b32 v14, v30, v32, s46
    v_bitop3_b32 v47, v30, 0.5, -0.5 bitop3:0xa8
    v_bitop3_b32 v15, v6, v15, v46 bitop3:0xca
    v_bitop3_b32 v14, v6, v14, v47 bitop3:0xca
    s_waitcnt lgkmcnt(1)
    v_mfma_f32_4x4x4_16b_bf16 v[80:83], v[10:11], v[70:71], v[80:83]
    s_waitcnt lgkmcnt(0)
    v_mfma_f32_4x4x4_16b_bf16 v[76:79], v[10:11], v[68:69], v[76:79]
    s_nop 2
    v_cvt_pk_bf16_f32 v80, v80, v81
    v_cvt_pk_bf16_f32 v81, v82, v83
    ds_wrxchg_rtn_b64 v[74:75], v93, v[80:81] offset:65408
    v_cvt_pk_bf16_f32 v76, v76, v77
    v_cvt_pk_bf16_f32 v77, v78, v79
    ds_wrxchg_rtn_b64 v[72:73], v92, v[76:77] offset:65408
    v_and_b32 v88, 0x0fffffff, v33
    buffer_load_dwordx2 v[28:29], v88, s[8:11], 0 offen
    buffer_load_dwordx3 v[30:32], v88, s[8:11], 0 offen offset:8
    s_setprio 0
    v_mfma_f32_4x4x4_16b_bf16 v[80:83], v[8:9], v[106:107], 0
    v_mfma_f32_4x4x4_16b_bf16 v[76:79], v[8:9], v[104:105], 0
    v_cmp_lt_u32 s[48:49], v5, v95
    s_nop 2
    v_pk_mul_f32 v[80:81], v[80:81], v[14:15] op_sel:[0,1] op_sel_hi:[1,1]
    v_pk_mul_f32 v[82:83], v[82:83], v[14:15] op_sel:[0,1] op_sel_hi:[1,1]
    v_pk_mul_f32 v[76:77], v[76:77], v[14:15] op_sel:[0,0] op_sel_hi:[1,0]
    v_pk_mul_f32 v[78:79], v[78:79], v[14:15] op_sel:[0,0] op_sel_hi:[1,0]
    s_add_u32 s40, s40, 0x50000
    s_waitcnt vmcnt(8)
    v_and_b32 v46, 0x80000000, v43
    v_lshrrev_b32 v47, 14, v37
    v_bitop3_b32 v47, v47, v5, v46 bitop3:0xea
    ds_read_b64 v[106:107], v47
    v_and_b32 v99, 0x40000000, v43
    v_lshrrev_b32 v47, 14, v36
    v_bitop3_b32 v47, v47, v5, v99 bitop3:0xea
    ds_read_b64 v[104:105], v47
    v_and_b32 v46, 0x20000000, v43
    v_lshrrev_b32 v47, 14, v35
    v_bitop3_b32 v47, v47, v5, v46 bitop3:0xea
    ds_read_b64 v[102:103], v47
    v_and_b32 v99, 0x10000000, v43
    v_lshrrev_b32 v47, 14, v34
    v_bitop3_b32 v47, v47, v5, v99 bitop3:0xea
    ds_read_b64 v[100:101], v47
    s_waitcnt lgkmcnt(4)
    v_cmp_ne_u64 s[50:51], v[72:73], v[68:69]
    v_cmpx_ne_u64 s[54:55], v[74:75], v[70:71]
    s_and_b64 s[82:83], s[54:55], s[80:81]
    s_cbranch_scc1 L2_c113
L2_d113:
    v_mov_b64 v[84:85], v[70:71]
    v_mov_b32 v7, v93
    v_mov_b64 v[86:87], v[74:75]
    s_or_b64 s[80:81], s[80:81], s[54:55]
    s_mov_b64 exec, s[50:51]
    s_and_b64 s[82:83], s[50:51], s[80:81]
    s_cbranch_scc1 L2_c114
L2_d114:
    v_mov_b64 v[84:85], v[68:69]
    v_mov_b32 v7, v92
    v_mov_b64 v[86:87], v[72:73]
    s_mov_b64 exec, -1
    s_or_b64 s[80:81], s[80:81], s[50:51]
    s_and_b64 exec, s[48:49], s[80:81]
    v_mfma_f32_4x4x4_16b_bf16 v[80:83], v[12:13], v[84:85], 0
    v_mov_b32 v95, v7
    s_andn2_b64 s[80:81], s[80:81], s[48:49]
    v_mfma_f32_4x4x4_16b_bf16 v[80:83], v[10:11], v[86:87], v[80:83]
    s_mov_b64 exec, -1
    ds_read_b64 v[70:71], v95 offset:65408
    ds_read_b64 v[68:69], v94 offset:65408
    v_bitop3_b32 v92, v34, v5, v99 bitop3:0xea
    v_bitop3_b32 v93, v35, v5, v46 bitop3:0xea
    v_perm_b32 v15, v35, v38, s45
    v_bitop3_b32 v46, v35, 0.5, -0.5 bitop3:0xa8
    v_perm_b32 v14, v34, v38, s44
    v_bitop3_b32 v47, v34, 0.5, -0.5 bitop3:0xa8
    v_bitop3_b32 v15, v6, v15, v46 bitop3:0xca
    v_bitop3_b32 v14, v6, v14, v47 bitop3:0xca
    s_waitcnt lgkmcnt(1)
    v_mfma_f32_4x4x4_16b_bf16 v[80:83], v[10:11], v[70:71], v[80:83]
    s_waitcnt lgkmcnt(0)
    v_mfma_f32_4x4x4_16b_bf16 v[76:79], v[10:11], v[68:69], v[76:79]
    s_nop 2
    v_cvt_pk_bf16_f32 v80, v80, v81
    v_cvt_pk_bf16_f32 v81, v82, v83
    ds_wrxchg_rtn_b64 v[74:75], v95, v[80:81] offset:65408
    v_cvt_pk_bf16_f32 v76, v76, v77
    v_cvt_pk_bf16_f32 v77, v78, v79
    ds_wrxchg_rtn_b64 v[72:73], v94, v[76:77] offset:65408
    s_barrier
    s_setprio 3
    s_mov_b32 m0, s100
    s_nop 0
    ds_write_addtid_b32 v124 offset:34816
    ds_write_addtid_b32 v125 offset:35072
    ds_write_addtid_b32 v126 offset:35328
    ds_write_addtid_b32 v127 offset:35584
    s_add_u32 s3, s40, 4096
    buffer_load_dwordx4 v[124:127], v3, s[16:19], s3 offen sc1
    ds_write_addtid_b32 v116 offset:32768
    ds_write_addtid_b32 v117 offset:33024
    ds_write_addtid_b32 v118 offset:33280
    ds_write_addtid_b32 v119 offset:33536
    buffer_load_dwordx4 v[116:119], v3, s[16:19], s40 offen offset:2048 sc1
    ds_write_addtid_b32 v120 offset:33792
    ds_write_addtid_b32 v121 offset:34048
    ds_write_addtid_b32 v122 offset:34304
    ds_write_addtid_b32 v123 offset:34560
    buffer_load_dwordx4 v[120:123], v3, s[16:19], s40 offen offset:3072 sc1
    v_mfma_f32_4x4x4_16b_bf16 v[80:83], v[8:9], v[102:103], 0
    v_mfma_f32_4x4x4_16b_bf16 v[76:79], v[8:9], v[100:101], 0
    s_nop 3
    v_pk_mul_f32 v[80:81], v[80:81], v[14:15] op_sel:[0,1] op_sel_hi:[1,1]
    v_pk_mul_f32 v[82:83], v[82:83], v[14:15] op_sel:[0,1] op_sel_hi:[1,1]
    v_pk_mul_f32 v[76:77], v[76:77], v[14:15] op_sel:[0,0] op_sel_hi:[1,0]
    v_pk_mul_f32 v[78:79], v[78:79], v[14:15] op_sel:[0,0] op_sel_hi:[1,0]
    s_cmp_gt_u32 s37, 1024
    s_cbranch_scc1 L2_xs115
    s_cmp_lg_u32 s101, 0
    s_cbranch_scc1 L2_xa115
L2_xb115:
    v_lshlrev_b32 v89, 16, v96
    v_add_u32 v90, 60, v97
    v_bitop3_b32 v90, v89, v45, v90 bitop3:0x6a
    ds_write_b32 v98, v90 offset:12
    v_lshlrev_b32 v89, 20, v96
    v_add_u32 v90, 40, v97
    v_bitop3_b32 v90, v89, v45, v90 bitop3:0x6a
    ds_write_b32 v98, v90 offset:8
    v_lshlrev_b32 v89, 24, v96
    v_add_u32 v90, 20, v97
    v_bitop3_b32 v90, v89, v45, v90 bitop3:0x6a
    ds_write_b32 v98, v90 offset:4
    v_lshlrev_b32 v89, 28, v96
    v_bitop3_b32 v90, v89, v45, v97 bitop3:0x6a
    ds_write_b32 v98, v90 offset:0
    v_mov_b32_dpp v91, v66 quad_perm:[1,1,1,1] row_mask:0xf bank_mask:0xf
    v_and_b32 v89, 3, v91
    v_and_b32 v97, 0xfffc, v91
    v_sub_u16_dpp v88, v66, v91 quad_perm:[3,3,3,3] row_mask:0xf bank_mask:0xf
    v_mad_u32_u24 v97, v97, 5, v4
    v_add_u32 v99, v88, v89
    v_bfm_b32 v96, v88, v89
    v_cmp_lt_u32 s[58:59], 16, v99
    v_lshlrev_b32 v89, v1, v96
    v_and_b32 v89, v45, v89
    v_cmp_ne_u32 vcc, 0, v89
    v_xor_b32 v90, v97, v89
    s_add_u32 s3, s37, s38
    v_mbcnt_lo_u32_b32 v98, vcc_lo, 0
    v_mbcnt_hi_u32_b32 v98, vcc_hi, v98
    s_bcnt1_i32_b64 s41, vcc
    v_lshl_add_u32 v98, v98, 2, s3
    s_lshl2_add_u32 s37, s41, s37
    s_mov_b64 exec, vcc
    ds_write_b32 v98, v90
    s_mov_b64 exec, -1
    s_cmp_lg_u64 s[58:59], 0
    s_cbranch_scc1 L2_xe115
L2_xr115:
    v_add_u32 v98, s37, v0
    v_mov_b32 v90, -1
    ds_write_b32 v98, v90
L2_xw115:
    s_setprio 2
    s_waitcnt lgkmcnt(14)
    v_cmp_ne_u64 s[50:51], v[72:73], v[68:69]
    v_cmpx_ne_u64 s[54:55], v[74:75], v[70:71]
    s_and_b64 s[82:83], s[54:55], s[80:81]
    s_cbranch_scc1 L2_c116
L2_d116:
    v_mov_b64 v[84:85], v[70:71]
    v_mov_b32 v7, v95
    v_mov_b64 v[86:87], v[74:75]
    s_or_b64 s[80:81], s[80:81], s[54:55]
    s_mov_b64 exec, s[50:51]
    s_and_b64 s[82:83], s[50:51], s[80:81]
    s_cbranch_scc1 L2_c117
L2_d117:
    v_mov_b64 v[84:85], v[68:69]
    v_mov_b32 v7, v94
    v_mov_b64 v[86:87], v[72:73]
    s_mov_b64 exec, -1
    s_or_b64 s[80:81], s[80:81], s[50:51]
    ds_read_b64 v[70:71], v93 offset:65408
    ds_read_b64 v[68:69], v92 offset:65408
    v_and_b32 v46, 0x40000000, v43
    v_bitop3_b32 v94, v36, v5, v46 bitop3:0xea
    v_and_b32 v46, 0x80000000, v43
    v_bitop3_b32 v95, v37, v5, v46 bitop3:0xea
    v_perm_b32 v15, v37, v38, s47
    v_bitop3_b32 v46, v37, 0.5, -0.5 bitop3:0xa8
    v_perm_b32 v14, v36, v38, s46
    v_bitop3_b32 v47, v36, 0.5, -0.5 bitop3:0xa8
    v_bitop3_b32 v15, v6, v15, v46 bitop3:0xca
    v_bitop3_b32 v14, v6, v14, v47 bitop3:0xca
    s_setprio 1
    s_waitcnt lgkmcnt(1)
    v_mfma_f32_4x4x4_16b_bf16 v[80:83], v[10:11], v[70:71], v[80:83]
    s_waitcnt lgkmcnt(0)
    v_mfma_f32_4x4x4_16b_bf16 v[76:79], v[10:11], v[68:69], v[76:79]
    s_nop 2
    v_cvt_pk_bf16_f32 v80, v80, v81
    v_cvt_pk_bf16_f32 v81, v82, v83
    ds_wrxchg_rtn_b64 v[74:75], v93, v[80:81] offset:65408
    v_cvt_pk_bf16_f32 v76, v76, v77
    v_cvt_pk_bf16_f32 v77, v78, v79
    ds_wrxchg_rtn_b64 v[72:73], v92, v[76:77] offset:65408
    ds_read_b32 v40, v44 offset:768
    ds_read_b32 v41, v0 offset:0
    ds_read_b32 v42, v0 offset:256
    ds_read_b32 v43, v0 offset:512
    s_sub_u32 s3, s37, 768
    s_cmp_gt_u32 s3, 128
    s_cbranch_scc1 L2_xf115
L2_xg115:
    v_lshrrev_b64 v[64:65], 16, v[64:65]
    v_lshrrev_b64 v[66:67], 16, v[66:67]
    v_and_b32 v88, 0x0fffffff, v39
    buffer_load_dwordx2 v[34:35], v88, s[8:11], 0 offen
    buffer_load_dwordx3 v[36:38], v88, s[8:11], 0 offen offset:8
    s_setprio 0
    s_waitcnt vmcnt(10)
    s_mov_b32 m0, s38
    s_nop 0
    ds_write_addtid_b32 v108 offset:0
    ds_write_addtid_b32 v109 offset:256
    ds_write_addtid_b32 v110 offset:512
    ds_write_addtid_b32 v111 offset:768
    s_waitcnt vmcnt(7)
    ds_write_addtid_b32 v112 offset:1024
    ds_write_addtid_b32 v113 offset:1280
    ds_write_addtid_b32 v114 offset:1536
    ds_write_addtid_b32 v115 offset:1792
    v_mfma_f32_4x4x4_16b_bf16 v[80:83], v[8:9], v[106:107], 0
    v_mfma_f32_4x4x4_16b_bf16 v[76:79], v[8:9], v[104:105], 0
    v_cmp_lt_u32 s[84:85], v5, v94
    s_nop 2
    v_pk_mul_f32 v[80:81], v[80:81], v[14:15] op_sel:[0,1] op_sel_hi:[1,1]
    v_pk_mul_f32 v[82:83], v[82:83], v[14:15] op_sel:[0,1] op_sel_hi:[1,1]
    v_pk_mul_f32 v[76:77], v[76:77], v[14:15] op_sel:[0,0] op_sel_hi:[1,0]
    v_pk_mul_f32 v[78:79], v[78:79], v[14:15] op_sel:[0,0] op_sel_hi:[1,0]
    s_add_u32 s42, s42, 1
    s_waitcnt lgkmcnt(0)
    s_cmp_lg_u32 s42, 14
    s_cbranch_scc1 L2_loop
    s_barrier
    s_bitcmp1_b32 s36, s42
    s_cbranch_scc1 L2_slow
L2_ret6:
    s_setprio 3
    s_bitcmp1_b32 s43, s42
    s_cbranch_scc1 L2_oa118
L2_ob118:
    s_mov_b64 exec, s[6:7]
    v_lshrrev_b32 v18, 16, v18
    s_mov_b64 exec, -1
    v_and_b32 v46, 0x20000000, v19
    v_lshrrev_b32 v47, 14, v17
    v_bitop3_b32 v47, v47, v5, v46 bitop3:0xea
    ds_read_b64 v[102:103], v47
    v_and_b32 v99, 0x10000000, v19
    v_lshrrev_b32 v47, 14, v16
    v_bitop3_b32 v47, v47, v5, v99 bitop3:0xea
    ds_read_b64 v[100:101], v47
    v_cmp_ne_u64 s[50:51], v[72:73], v[68:69]
    v_cmpx_ne_u64 s[54:55], v[74:75], v[70:71]
    s_and_b64 s[82:83], s[54:55], s[80:81]
    s_cbranch_scc1 L2_c119
L2_d119:
    v_mov_b64 v[84:85], v[70:71]
    v_mov_b32 v7, v93
    v_mov_b64 v[86:87], v[74:75]
    s_or_b64 s[80:81], s[80:81], s[54:55]
    s_mov_b64 exec, s[50:51]
    s_and_b64 s[82:83], s[50:51], s[80:81]
    s_cbranch_scc1 L2_c120
L2_d120:
    v_mov_b64 v[84:85], v[68:69]
    v_mov_b32 v7, v92
    v_mov_b64 v[86:87], v[72:73]
    s_mov_b64 exec, -1
    s_or_b64 s[80:81], s[80:81], s[50:51]
    s_and_b64 exec, s[84:85], s[80:81]
    v_mfma_f32_4x4x4_16b_bf16 v[76:79], v[12:13], v[84:85], 0
    v_mov_b32 v94, v7
    s_andn2_b64 s[80:81], s[80:81], s[84:85]
    v_mfma_f32_4x4x4_16b_bf16 v[76:79], v[10:11], v[86:87], v[76:79]
    s_mov_b64 exec, -1
    ds_read_b64 v[70:71], v95 offset:65408
    ds_read_b64 v[68:69], v94 offset:65408
    v_bitop3_b32 v92, v16, v5, v99 bitop3:0xea
    v_bitop3_b32 v93, v17, v5, v46 bitop3:0xea
    v_perm_b32 v15, v17, v18, s45
    v_bitop3_b32 v46, v17, 0.5, -0.5 bitop3:0xa8
    v_perm_b32 v14, v16, v18, s44
    v_bitop3_b32 v47, v16, 0.5, -0.5 bitop3:0xa8
    v_bitop3_b32 v15, v6, v15, v46 bitop3:0xca
    v_bitop3_b32 v14, v6, v14, v47 bitop3:0xca
    s_waitcnt lgkmcnt(1)
    v_mfma_f32_4x4x4_16b_bf16 v[80:83], v[10:11], v[70:71], v[80:83]
    s_waitcnt lgkmcnt(0)
    v_mfma_f32_4x4x4_16b_bf16 v[76:79], v[10:11], v[68:69], v[76:79]
    s_nop 2
    v_cvt_pk_bf16_f32 v80, v80, v81
    v_cvt_pk_bf16_f32 v81, v82, v83
    ds_wrxchg_rtn_b64 v[74:75], v95, v[80:81] offset:65408
    v_cvt_pk_bf16_f32 v76, v76, v77
    v_cvt_pk_bf16_f32 v77, v78, v79
    ds_wrxchg_rtn_b64 v[72:73], v94, v[76:77] offset:65408
    v_mfma_f32_4x4x4_16b_bf16 v[80:83], v[8:9], v[102:103], 0
    v_mfma_f32_4x4x4_16b_bf16 v[76:79], v[8:9], v[100:101], 0
    v_cmp_lt_u32 s[84:85], v5, v92
    s_nop 2
    v_pk_mul_f32 v[80:81], v[80:81], v[14:15] op_sel:[0,1] op_sel_hi:[1,1]
    v_pk_mul_f32 v[82:83], v[82:83], v[14:15] op_sel:[0,1] op_sel_hi:[1,1]
    v_pk_mul_f32 v[76:77], v[76:77], v[14:15] op_sel:[0,0] op_sel_hi:[1,0]
    v_pk_mul_f32 v[78:79], v[78:79], v[14:15] op_sel:[0,0] op_sel_hi:[1,0]
    v_and_b32 v47, 0x0fffffff, v40
    buffer_load_dword v18, v47, s[8:11], 0 offen offset:16
    s_mov_b64 exec, s[6:7]
    v_add_u32 v47, 8, v47
    v_lshrrev_b32 v40, 2, v40
    s_mov_b64 exec, -1
    buffer_load_dwordx2 v[16:17], v47, s[8:11], 0 offen
    v_and_b32 v46, 0x20000000, v27
    v_lshrrev_b32 v47, 14, v23
    v_bitop3_b32 v47, v47, v5, v46 bitop3:0xea
    ds_read_b64 v[106:107], v47
    v_and_b32 v99, 0x10000000, v27
    v_lshrrev_b32 v47, 14, v22
    v_bitop3_b32 v47, v47, v5, v99 bitop3:0xea
    ds_read_b64 v[104:105], v47
    s_waitcnt lgkmcnt(2)
    v_cmp_ne_u64 s[50:51], v[72:73], v[68:69]
    v_cmpx_ne_u64 s[54:55], v[74:75], v[70:71]
    s_and_b64 s[82:83], s[54:55], s[80:81]
    s_cbranch_scc1 L2_c121
L2_d121:
    v_mov_b64 v[84:85], v[70:71]
    v_mov_b32 v7, v95
    v_mov_b64 v[86:87], v[74:75]
    s_or_b64 s[80:81], s[80:81], s[54:55]
    s_mov_b64 exec, s[50:51]
    s_and_b64 s[82:83], s[50:51], s[80:81]
    s_cbranch_scc1 L2_c122
L2_d122:
    v_mov_b64 v[84:85], v[68:69]
    v_mov_b32 v7, v94
    v_mov_b64 v[86:87], v[72:73]
    s_mov_b64 exec, -1
    s_or_b64 s[80:81], s[80:81], s[50:51]
    s_and_b64 exec, s[84:85], s[80:81]
    v_mfma_f32_4x4x4_16b_bf16 v[76:79], v[12:13], v[84:85], 0
    v_mov_b32 v92, v7
    s_andn2_b64 s[80:81], s[80:81], s[84:85]
    v_mfma_f32_4x4x4_16b_bf16 v[76:79], v[10:11], v[86:87], v[76:79]
    s_mov_b64 exec, -1
    ds_read_b64 v[70:71], v93 offset:65408
    ds_read_b64 v[68:69], v92 offset:65408
    v_bitop3_b32 v94, v22, v5, v99 bitop3:0xea
    v_bitop3_b32 v95, v23, v5, v46 bitop3:0xea
    v_perm_b32 v15, v23, v26, s45
    v_bitop3_b32 v46, v23, 0.5, -0.5 bitop3:0xa8
    v_perm_b32 v14, v22, v26, s44
    v_bitop3_b32 v47, v22, 0.5, -0.5 bitop3:0xa8
    v_bitop3_b32 v15, v6, v15, v46 bitop3:0xca
    v_bitop3_b32 v14, v6, v14, v47 bitop3:0xca
    s_waitcnt lgkmcnt(1)
    v_mfma_f32_4x4x4_16b_bf16 v[80:83], v[10:11], v[70:71], v[80:83]
    s_waitcnt lgkmcnt(0)
    v_mfma_f32_4x4x4_16b_bf16 v[76:79], v[10:11], v[68:69], v[76:79]
    s_nop 2
    v_cvt_pk_bf16_f32 v80, v80, v81
    v_cvt_pk_bf16_f32 v81, v82, v83
    ds_wrxchg_rtn_b64 v[74:75], v93, v[80:81] offset:65408
    v_cvt_pk_bf16_f32 v76, v76, v77
    v_cvt_pk_bf16_f32 v77, v78, v79
    ds_wrxchg_rtn_b64 v[72:73], v92, v[76:77] offset:65408
    v_mfma_f32_4x4x4_16b_bf16 v[80:83], v[8:9], v[106:107], 0
    v_mfma_f32_4x4x4_16b_bf16 v[76:79], v[8:9], v[104:105], 0
    v_cmp_lt_u32 s[48:49], v5, v95
    s_nop 2
    v_pk_mul_f32 v[80:81], v[80:81], v[14:15] op_sel:[0,1] op_sel_hi:[1,1]
    v_pk_mul_f32 v[82:83], v[82:83], v[14:15] op_sel:[0,1] op_sel_hi:[1,1]
    v_pk_mul_f32 v[76:77], v[76:77], v[14:15] op_sel:[0,0] op_sel_hi:[1,0]
    v_pk_mul_f32 v[78:79], v[78:79], v[14:15] op_sel:[0,0] op_sel_hi:[1,0]
    buffer_load_dwordx4 v[108:111], v3, s[16:19], s40 offen offset:0 sc1
    v_and_b32 v46, 0x80000000, v27
    v_lshrrev_b32 v47, 14, v25
    v_bitop3_b32 v47, v47, v5, v46 bitop3:0xea
    ds_read_b64 v[102:103], v47
    v_and_b32 v99, 0x40000000, v27
    v_lshrrev_b32 v47, 14, v24
    v_bitop3_b32 v47, v47, v5, v99 bitop3:0xea
    ds_read_b64 v[100:101], v47
    s_waitcnt lgkmcnt(2)
    v_cmp_ne_u64 s[50:51], v[72:73], v[68:69]
    v_cmpx_ne_u64 s[54:55], v[74:75], v[70:71]
    s_and_b64 s[82:83], s[54:55], s[80:81]
    s_cbranch_scc1 L2_c123
L2_d123:
    v_mov_b64 v[84:85], v[70:71]
    v_mov_b32 v7, v93
    v_mov_b64 v[86:87], v[74:75]
    s_or_b64 s[80:81], s[80:81], s[54:55]
    s_mov_b64 exec, s[50:51]
    s_and_b64 s[82:83], s[50:51], s[80:81]
    s_cbranch_scc1 L2_c124
L2_d124:
    v_mov_b64 v[84:85], v[68:69]
    v_mov_b32 v7, v92
    v_mov_b64 v[86:87], v[72:73]
    s_mov_b64 exec, -1
    s_or_b64 s[80:81], s[80:81], s[50:51]
    s_and_b64 exec, s[48:49], s[80:81]
    v_mfma_f32_4x4x4_16b_bf16 v[80:83], v[12:13], v[84:85], 0
    v_mov_b32 v95, v7
    s_andn2_b64 s[80:81], s[80:81], s[48:49]
    v_mfma_f32_4x4x4_16b_bf16 v[80:83], v[10:11], v[86:87], v[80:83]
    s_mov_b64 exec, -1
    ds_read_b64 v[70:71], v95 offset:65408
    ds_read_b64 v[68:69], v94 offset:65408
    v_bitop3_b32 v92, v24, v5, v99 bitop3:0xea
    v_bitop3_b32 v93, v25, v5, v46 bitop3:0xea
    v_perm_b32 v15, v25, v26, s47
    v_bitop3_b32 v46, v25, 0.5, -0.5 bitop3:0xa8
    v_perm_b32 v14, v24, v26, s46
    v_bitop3_b32 v47, v24, 0.5, -0.5 bitop3:0xa8
    v_bitop3_b32 v15, v6, v15, v46 bitop3:0xca
    v_bitop3_b32 v14, v6, v14, v47 bitop3:0xca
    s_waitcnt lgkmcnt(1)
    v_mfma_f32_4x4x4_16b_bf16 v[80:83], v[10:11], v[70:71], v[80:83]
    s_waitcnt lgkmcnt(0)
    v_mfma_f32_4x4x4_16b_bf16 v[76:79], v[10:11], v[68:69], v[76:79]
    s_nop 2
    v_cvt_pk_bf16_f32 v80, v80, v81
    v_cvt_pk_bf16_f32 v81, v82, v83
    ds_wrxchg_rtn_b64 v[74:75], v95, v[80:81] offset:65408
    v_cvt_pk_bf16_f32 v76, v76, v77
    v_cvt_pk_bf16_f32 v77, v78, v79
    ds_wrxchg_rtn_b64 v[72:73], v94, v[76:77] offset:65408
    v_and_b32 v88, 0x0fffffff, v41
    buffer_load_dwordx2 v[22:23], v88, s[8:11], 0 offen
    buffer_load_dwordx3 v[24:26], v88, s[8:11], 0 offen offset:8
    s_setprio 2
    v_mfma_f32_4x4x4_16b_bf16 v[80:83], v[8:9], v[102:103], 0
    v_mfma_f32_4x4x4_16b_bf16 v[76:79], v[8:9], v[100:101], 0
    s_nop 3
    v_pk_mul_f32 v[80:81], v[80:81], v[14:15] op_sel:[0,1] op_sel_hi:[1,1]
    v_pk_mul_f32 v[82:83], v[82:83], v[14:15] op_sel:[0,1] op_sel_hi:[1,1]
    v_pk_mul_f32 v[76:77], v[76:77], v[14:15] op_sel:[0,0] op_sel_hi:[1,0]
    v_pk_mul_f32 v[78:79], v[78:79], v[14:15] op_sel:[0,0] op_sel_hi:[1,0]
    s_waitcnt vmcnt(10)
    v_and_b32 v46, 0x20000000, v33
    v_lshrrev_b32 v47, 14, v29
    v_bitop3_b32 v47, v47, v5, v46 bitop3:0xea
    ds_read_b64 v[106:107], v47
    v_and_b32 v99, 0x10000000, v33
    v_lshrrev_b32 v47, 14, v28
    v_bitop3_b32 v47, v47, v5, v99 bitop3:0xea
    ds_read_b64 v[104:105], v47
    s_waitcnt lgkmcnt(2)
    v_cmp_ne_u64 s[50:51], v[72:73], v[68:69]
    v_cmpx_ne_u64 s[54:55], v[74:75], v[70:71]
    s_and_b64 s[82:83], s[54:55], s[80:81]
    s_cbranch_scc1 L2_c125
L2_d125:
    v_mov_b64 v[84:85], v[70:71]
    v_mov_b32 v7, v95
    v_mov_b64 v[86:87], v[74:75]
    s_or_b64 s[80:81], s[80:81], s[54:55]
    s_mov_b64 exec, s[50:51]
    s_and_b64 s[82:83], s[50:51], s[80:81]
    s_cbranch_scc1 L2_c126
L2_d126:
    v_mov_b64 v[84:85], v[68:69]
    v_mov_b32 v7, v94
    v_mov_b64 v[86:87], v[72:73]
    s_mov_b64 exec, -1
    s_or_b64 s[80:81], s[80:81], s[50:51]
    ds_read_b64 v[70:71], v93 offset:65408
    ds_read_b64 v[68:69], v92 offset:65408
    v_bitop3_b32 v94, v28, v5, v99 bitop3:0xea
    v_bitop3_b32 v95, v29, v5, v46 bitop3:0xea
    v_perm_b32 v15, v29, v32, s45
    v_bitop3_b32 v46, v29, 0.5, -0.5 bitop3:0xa8
    v_perm_b32 v14, v28, v32, s44
    v_bitop3_b32 v47, v28, 0.5, -0.5 bitop3:0xa8
    v_bitop3_b32 v15, v6, v15, v46 bitop3:0xca
    v_bitop3_b32 v14, v6, v14, v47 bitop3:0xca
    s_waitcnt lgkmcnt(1)
    v_mfma_f32_4x4x4_16b_bf16 v[80:83], v[10:11], v[70:71], v[80:83]
    s_waitcnt lgkmcnt(0)
    v_mfma_f32_4x4x4_16b_bf16 v[76:79], v[10:11], v[68:69], v[76:79]
    s_nop 2
    v_cvt_pk_bf16_f32 v80, v80, v81
    v_cvt_pk_bf16_f32 v81, v82, v83
    ds_wrxchg_rtn_b64 v[74:75], v93, v[80:81] offset:65408
    v_cvt_pk_bf16_f32 v76, v76, v77
    v_cvt_pk_bf16_f32 v77, v78, v79
    ds_wrxchg_rtn_b64 v[72:73], v92, v[76:77] offset:65408
    s_setprio 1
    v_mfma_f32_4x4x4_16b_bf16 v[80:83], v[8:9], v[106:107], 0
    v_mfma_f32_4x4x4_16b_bf16 v[76:79], v[8:9], v[104:105], 0
    v_cmp_lt_u32 s[84:85], v5, v94
    s_nop 2
    v_pk_mul_f32 v[80:81], v[80:81], v[14:15] op_sel:[0,1] op_sel_hi:[1,1]
    v_pk_mul_f32 v[82:83], v[82:83], v[14:15] op_sel:[0,1] op_sel_hi:[1,1]
    v_pk_mul_f32 v[76:77], v[76:77], v[14:15] op_sel:[0,0] op_sel_hi:[1,0]
    v_pk_mul_f32 v[78:79], v[78:79], v[14:15] op_sel:[0,0] op_sel_hi:[1,0]
    s_bitcmp1_b32 s43, s42
    s_cbranch_scc1 L2_oa127
L2_ob127:
    buffer_load_dwordx4 v[112:115], v3, s[16:19], s40 offen offset:1024 sc1
    v_and_b32 v46, 0x80000000, v33
    v_lshrrev_b32 v47, 14, v31
    v_bitop3_b32 v47, v47, v5, v46 bitop3:0xea
    ds_read_b64 v[102:103], v47
    v_and_b32 v99, 0x40000000, v33
    v_lshrrev_b32 v47, 14, v30
    v_bitop3_b32 v47, v47, v5, v99 bitop3:0xea
    ds_read_b64 v[100:101], v47
    s_waitcnt lgkmcnt(2)
    v_cmp_ne_u64 s[50:51], v[72:73], v[68:69]
    v_cmpx_ne_u64 s[54:55], v[74:75], v[70:71]
    s_and_b64 s[82:83], s[54:55], s[80:81]
    s_cbranch_scc1 L2_c128
L2_d128:
    v_mov_b64 v[84:85], v[70:71]
    v_mov_b32 v7, v93
    v_mov_b64 v[86:87], v[74:75]
    s_or_b64 s[80:81], s[80:81], s[54:55]
    s_mov_b64 exec, s[50:51]
    s_and_b64 s[82:83], s[50:51], s[80:81]
    s_cbranch_scc1 L2_c129
L2_d129:
    v_mov_b64 v[84:85], v[68:69]
    v_mov_b32 v7, v92
    v_mov_b64 v[86:87], v[72:73]
    s_mov_b64 exec, -1
    s_or_b64 s[80:81], s[80:81], s[50:51]
    s_and_b64 exec, s[84:85], s[80:81]
    v_mfma_f32_4x4x4_16b_bf16 v[76:79], v[12:13], v[84:85], 0
    v_mov_b32 v94, v7
    s_andn2_b64 s[80:81], s[80:81], s[84:85]
    v_mfma_f32_4x4x4_16b_bf16 v[76:79], v[10:11], v[86:87], v[76:79]
    s_mov_b64 exec, -1
    ds_read_b64 v[70:71], v95 offset:65408
    ds_read_b64 v[68:69], v94 offset:65408
    v_bitop3_b32 v92, v30, v5, v99 bitop3:0xea
    v_bitop3_b32 v93, v31, v5, v46 bitop3:0xea
    v_perm_b32 v15, v31, v32, s47
    v_bitop3_b32 v46, v31, 0.5, -0.5 bitop3:0xa8
    v_perm_b32 v14, v30, v32, s46
    v_bitop3_b32 v47, v30, 0.5, -0.5 bitop3:0xa8
    v_bitop3_b32 v15, v6, v15, v46 bitop3:0xca
    v_bitop3_b32 v14, v6, v14, v47 bitop3:0xca
    s_waitcnt lgkmcnt(1)
    v_mfma_f32_4x4x4_16b_bf16 v[80:83], v[10:11], v[70:71], v[80:83]
    s_waitcnt lgkmcnt(0)
    v_mfma_f32_4x4x4_16b_bf16 v[76:79], v[10:11], v[68:69], v[76:79]
    s_nop 2
    v_cvt_pk_bf16_f32 v80, v80, v81
    v_cvt_pk_bf16_f32 v81, v82, v83
    ds_wrxchg_rtn_b64 v[74:75], v95, v[80:81] offset:65408
    v_cvt_pk_bf16_f32 v76, v76, v77
    v_cvt_pk_bf16_f32 v77, v78, v79
    ds_wrxchg_rtn_b64 v[72:73], v94, v[76:77] offset:65408
    v_and_b32 v88, 0x0fffffff, v42
    buffer_load_dwordx2 v[28:29], v88, s[8:11], 0 offen
    buffer_load_dwordx3 v[30:32], v88, s[8:11], 0 offen offset:8
    s_setprio 0
    v_mfma_f32_4x4x4_16b_bf16 v[80:83], v[8:9], v[102:103], 0
    v_mfma_f32_4x4x4_16b_bf16 v[76:79], v[8:9], v[100:101], 0
    v_cmp_lt_u32 s[48:49], v5, v93
    s_nop 2
    v_pk_mul_f32 v[80:81], v[80:81], v[14:15] op_sel:[0,1] op_sel_hi:[1,1]
    v_pk_mul_f32 v[82:83], v[82:83], v[14:15] op_sel:[0,1] op_sel_hi:[1,1]
    v_pk_mul_f32 v[76:77], v[76:77], v[14:15] op_sel:[0,0] op_sel_hi:[1,0]
    v_pk_mul_f32 v[78:79], v[78:79], v[14:15] op_sel:[0,0] op_sel_hi:[1,0]
    s_add_u32 s40, s40, 0xfff24000
    s_waitcnt vmcnt(8)
    v_and_b32 v46, 0x80000000, v39
    v_lshrrev_b32 v47, 14, v37
    v_bitop3_b32 v47, v47, v5, v46 bitop3:0xea
    ds_read_b64 v[102:103], v47
    v_and_b32 v99, 0x40000000, v39
    v_lshrrev_b32 v47, 14, v36
    v_bitop3_b32 v47, v47, v5, v99 bitop3:0xea
    ds_read_b64 v[100:101], v47
    v_and_b32 v46, 0x20000000, v39
    v_lshrrev_b32 v47, 14, v35
    v_bitop3_b32 v47, v47, v5, v46 bitop3:0xea
    ds_read_b64 v[106:107], v47
    v_and_b32 v99, 0x10000000, v39
    v_lshrrev_b32 v47, 14, v34
    v_bitop3_b32 v47, v47, v5, v99 bitop3:0xea
    ds_read_b64 v[104:105], v47
    s_waitcnt lgkmcnt(4)
    v_cmp_ne_u64 s[50:51], v[72:73], v[68:69]
    v_cmpx_ne_u64 s[54:55], v[74:75], v[70:71]
    s_and_b64 s[82:83], s[54:55], s[80:81]
    s_cbranch_scc1 L2_c130
L2_d130:
    v_mov_b64 v[84:85], v[70:71]
    v_mov_b32 v7, v95
    v_mov_b64 v[86:87], v[74:75]
    s_or_b64 s[80:81], s[80:81], s[54:55]
    s_mov_b64 exec, s[50:51]
    s_and_b64 s[82:83], s[50:51], s[80:81]
    s_cbranch_scc1 L2_c131
L2_d131:
    v_mov_b64 v[84:85], v[68:69]
    v_mov_b32 v7, v94
    v_mov_b64 v[86:87], v[72:73]
    s_mov_b64 exec, -1
    s_or_b64 s[80:81], s[80:81], s[50:51]
    s_and_b64 exec, s[48:49], s[80:81]
    v_mfma_f32_4x4x4_16b_bf16 v[80:83], v[12:13], v[84:85], 0
    v_mov_b32 v93, v7
    s_andn2_b64 s[80:81], s[80:81], s[48:49]
    v_mfma_f32_4x4x4_16b_bf16 v[80:83], v[10:11], v[86:87], v[80:83]
    s_mov_b64 exec, -1
    ds_read_b64 v[70:71], v93 offset:65408
    ds_read_b64 v[68:69], v92 offset:65408
    v_bitop3_b32 v94, v34, v5, v99 bitop3:0xea
    v_bitop3_b32 v95, v35, v5, v46 bitop3:0xea
    v_perm_b32 v15, v35, v38, s45
    v_bitop3_b32 v46, v35, 0.5, -0.5 bitop3:0xa8
    v_perm_b32 v14, v34, v38, s44
    v_bitop3_b32 v47, v34, 0.5, -0.5 bitop3:0xa8
    v_bitop3_b32 v15, v6, v15, v46 bitop3:0xca
    v_bitop3_b32 v14, v6, v14, v47 bitop3:0xca
    s_waitcnt lgkmcnt(1)
    v_mfma_f32_4x4x4_16b_bf16 v[80:83], v[10:11], v[70:71], v[80:83]
    s_waitcnt lgkmcnt(0)
    v_mfma_f32_4x4x4_16b_bf16 v[76:79], v[10:11], v[68:69], v[76:79]
    s_nop 2
    v_cvt_pk_bf16_f32 v80, v80, v81
    v_cvt_pk_bf16_f32 v81, v82, v83
    ds_wrxchg_rtn_b64 v[74:75], v93, v[80:81] offset:65408
    v_cvt_pk_bf16_f32 v76, v76, v77
    v_cvt_pk_bf16_f32 v77, v78, v79
    ds_wrxchg_rtn_b64 v[72:73], v92, v[76:77] offset:65408
    s_barrier
    s_setprio 3
    s_mov_b32 m0, s100
    s_nop 0
    ds_write_addtid_b32 v124 offset:34816
    ds_write_addtid_b32 v125 offset:35072
    ds_write_addtid_b32 v126 offset:35328
    ds_write_addtid_b32 v127 offset:35584
    ds_write_addtid_b32 v116 offset:32768
    ds_write_addtid_b32 v117 offset:33024
    ds_write_addtid_b32 v118 offset:33280
    ds_write_addtid_b32 v119 offset:33536
    ds_write_addtid_b32 v120 offset:33792
    ds_write_addtid_b32 v121 offset:34048
    ds_write_addtid_b32 v122 offset:34304
    ds_write_addtid_b32 v123 offset:34560
    v_mfma_f32_4x4x4_16b_bf16 v[80:83], v[8:9], v[106:107], 0
    v_mfma_f32_4x4x4_16b_bf16 v[76:79], v[8:9], v[104:105], 0
    s_nop 3
    v_pk_mul_f32 v[80:81], v[80:81], v[14:15] op_sel:[0,1] op_sel_hi:[1,1]
    v_pk_mul_f32 v[82:83], v[82:83], v[14:15] op_sel:[0,1] op_sel_hi:[1,1]
    v_pk_mul_f32 v[76:77], v[76:77], v[14:15] op_sel:[0,0] op_sel_hi:[1,0]
    v_pk_mul_f32 v[78:79], v[78:79], v[14:15] op_sel:[0,0] op_sel_hi:[1,0]
    s_setprio 2
    s_waitcnt lgkmcnt(12)
    v_cmp_ne_u64 s[50:51], v[72:73], v[68:69]
    v_cmpx_ne_u64 s[54:55], v[74:75], v[70:71]
    s_and_b64 s[82:83], s[54:55], s[80:81]
    s_cbranch_scc1 L2_c132
L2_d132:
    v_mov_b64 v[84:85], v[70:71]
    v_mov_b32 v7, v93
    v_mov_b64 v[86:87], v[74:75]
    s_or_b64 s[80:81], s[80:81], s[54:55]
    s_mov_b64 exec, s[50:51]
    s_and_b64 s[82:83], s[50:51], s[80:81]
    s_cbranch_scc1 L2_c133
L2_d133:
    v_mov_b64 v[84:85], v[68:69]
    v_mov_b32 v7, v92
    v_mov_b64 v[86:87], v[72:73]
    s_mov_b64 exec, -1
    s_or_b64 s[80:81], s[80:81], s[50:51]
    ds_read_b64 v[70:71], v95 offset:65408
    ds_read_b64 v[68:69], v94 offset:65408
    v_and_b32 v46, 0x40000000, v39
    v_bitop3_b32 v92, v36, v5, v46 bitop3:0xea
    v_and_b32 v46, 0x80000000, v39
    v_bitop3_b32 v93, v37, v5, v46 bitop3:0xea
    v_perm_b32 v15, v37, v38, s47
    v_bitop3_b32 v46, v37, 0.5, -0.5 bitop3:0xa8
    v_perm_b32 v14, v36, v38, s46
    v_bitop3_b32 v47, v36, 0.5, -0.5 bitop3:0xa8
    v_bitop3_b32 v15, v6, v15, v46 bitop3:0xca
    v_bitop3_b32 v14, v6, v14, v47 bitop3:0xca
    s_setprio 1
    s_waitcnt lgkmcnt(1)
    v_mfma_f32_4x4x4_16b_bf16 v[80:83], v[10:11], v[70:71], v[80:83]
    s_waitcnt lgkmcnt(0)
    v_mfma_f32_4x4x4_16b_bf16 v[76:79], v[10:11], v[68:69], v[76:79]
    s_nop 2
    v_cvt_pk_bf16_f32 v80, v80, v81
    v_cvt_pk_bf16_f32 v81, v82, v83
    ds_wrxchg_rtn_b64 v[74:75], v95, v[80:81] offset:65408
    v_cvt_pk_bf16_f32 v76, v76, v77
    v_cvt_pk_bf16_f32 v77, v78, v79
    ds_wrxchg_rtn_b64 v[72:73], v94, v[76:77] offset:65408
    v_and_b32 v88, 0x0fffffff, v43
    buffer_load_dwordx2 v[34:35], v88, s[8:11], 0 offen
    buffer_load_dwordx3 v[36:38], v88, s[8:11], 0 offen offset:8
    s_setprio 0
    s_waitcnt vmcnt(7)
    s_mov_b32 m0, s38
    s_nop 0
    ds_write_addtid_b32 v108 offset:0
    ds_write_addtid_b32 v109 offset:256
    ds_write_addtid_b32 v110 offset:512
    ds_write_addtid_b32 v111 offset:768
    s_waitcnt vmcnt(4)
    ds_write_addtid_b32 v112 offset:1024
    ds_write_addtid_b32 v113 offset:1280
    ds_write_addtid_b32 v114 offset:1536
    ds_write_addtid_b32 v115 offset:1792
    v_mfma_f32_4x4x4_16b_bf16 v[80:83], v[8:9], v[102:103], 0
    v_mfma_f32_4x4x4_16b_bf16 v[76:79], v[8:9], v[100:101], 0
    v_cmp_lt_u32 s[84:85], v5, v92
    s_nop 2
    v_pk_mul_f32 v[80:81], v[80:81], v[14:15] op_sel:[0,1] op_sel_hi:[1,1]
    v_pk_mul_f32 v[82:83], v[82:83], v[14:15] op_sel:[0,1] op_sel_hi:[1,1]
    v_pk_mul_f32 v[76:77], v[76:77], v[14:15] op_sel:[0,0] op_sel_hi:[1,0]
    v_pk_mul_f32 v[78:79], v[78:79], v[14:15] op_sel:[0,0] op_sel_hi:[1,0]
    s_add_u32 s42, s42, 1
    s_waitcnt lgkmcnt(0)
    s_barrier
    s_bitcmp1_b32 s36, s42
    s_cbranch_scc1 L2_slow
L2_ret7:
    s_setprio 3
    s_bitcmp1_b32 s43, s42
    s_cbranch_scc1 L2_oa134
L2_ob134:
    s_mov_b64 exec, s[6:7]
    v_lshrrev_b32 v18, 16, v18
    s_mov_b64 exec, -1
    v_and_b32 v46, 0x20000000, v40
    v_lshrrev_b32 v47, 14, v17
    v_bitop3_b32 v47, v47, v5, v46 bitop3:0xea
    ds_read_b64 v[106:107], v47
    v_and_b32 v99, 0x10000000, v40
    v_lshrrev_b32 v47, 14, v16
    v_bitop3_b32 v47, v47, v5, v99 bitop3:0xea
    ds_read_b64 v[104:105], v47
    v_cmp_ne_u64 s[50:51], v[72:73], v[68:69]
    v_cmpx_ne_u64 s[54:55], v[74:75], v[70:71]
    s_and_b64 s[82:83], s[54:55], s[80:81]
    s_cbranch_scc1 L2_c135
L2_d135:
    v_mov_b64 v[84:85], v[70:71]
    v_mov_b32 v7, v95
    v_mov_b64 v[86:87], v[74:75]
    s_or_b64 s[80:81], s[80:81], s[54:55]
    s_mov_b64 exec, s[50:51]
    s_and_b64 s[82:83], s[50:51], s[80:81]
    s_cbranch_scc1 L2_c136
L2_d136:
    v_mov_b64 v[84:85], v[68:69]
    v_mov_b32 v7, v94
    v_mov_b64 v[86:87], v[72:73]
    s_mov_b64 exec, -1
    s_or_b64 s[80:81], s[80:81], s[50:51]
    s_and_b64 exec, s[84:85], s[80:81]
    v_mfma_f32_4x4x4_16b_bf16 v[76:79], v[12:13], v[84:85], 0
    v_mov_b32 v92, v7
    s_andn2_b64 s[80:81], s[80:81], s[84:85]
    v_mfma_f32_4x4x4_16b_bf16 v[76:79], v[10:11], v[86:87], v[76:79]
    s_mov_b64 exec, -1
    ds_read_b64 v[70:71], v93 offset:65408
    ds_read_b64 v[68:69], v92 offset:65408
    v_bitop3_b32 v94, v16, v5, v99 bitop3:0xea
    v_bitop3_b32 v95, v17, v5, v46 bitop3:0xea
    v_perm_b32 v15, v17, v18, s45
    v_bitop3_b32 v46, v17, 0.5, -0.5 bitop3:0xa8
    v_perm_b32 v14, v16, v18, s44
    v_bitop3_b32 v47, v16, 0.5, -0.5 bitop3:0xa8
    v_bitop3_b32 v15, v6, v15, v46 bitop3:0xca
    v_bitop3_b32 v14, v6, v14, v47 bitop3:0xca
    s_waitcnt lgkmcnt(1)
    v_mfma_f32_4x4x4_16b_bf16 v[80:83], v[10:11], v[70:71], v[80:83]
    s_waitcnt lgkmcnt(0)
    v_mfma_f32_4x4x4_16b_bf16 v[76:79], v[10:11], v[68:69], v[76:79]
    s_nop 2
    v_cvt_pk_bf16_f32 v80, v80, v81
    v_cvt_pk_bf16_f32 v81, v82, v83
    ds_wrxchg_rtn_b64 v[74:75], v93, v[80:81] offset:65408
    v_cvt_pk_bf16_f32 v76, v76, v77
    v_cvt_pk_bf16_f32 v77, v78, v79
    ds_wrxchg_rtn_b64 v[72:73], v92, v[76:77] offset:65408
    v_mfma_f32_4x4x4_16b_bf16 v[80:83], v[8:9], v[106:107], 0
    v_mfma_f32_4x4x4_16b_bf16 v[76:79], v[8:9], v[104:105], 0
    v_cmp_lt_u32 s[84:85], v5, v94
    s_nop 2
    v_pk_mul_f32 v[80:81], v[80:81], v[14:15] op_sel:[0,1] op_sel_hi:[1,1]
    v_pk_mul_f32 v[82:83], v[82:83], v[14:15] op_sel:[0,1] op_sel_hi:[1,1]
    v_pk_mul_f32 v[76:77], v[76:77], v[14:15] op_sel:[0,0] op_sel_hi:[1,0]
    v_pk_mul_f32 v[78:79], v[78:79], v[14:15] op_sel:[0,0] op_sel_hi:[1,0]
    v_and_b32 v46, 0x20000000, v41
    v_lshrrev_b32 v47, 14, v23
    v_bitop3_b32 v47, v47, v5, v46 bitop3:0xea
    ds_read_b64 v[102:103], v47
    v_and_b32 v99, 0x10000000, v41
    v_lshrrev_b32 v47, 14, v22
    v_bitop3_b32 v47, v47, v5, v99 bitop3:0xea
    ds_read_b64 v[100:101], v47
    s_waitcnt lgkmcnt(2)
    v_cmp_ne_u64 s[50:51], v[72:73], v[68:69]
    v_cmpx_ne_u64 s[54:55], v[74:75], v[70:71]
    s_and_b64 s[82:83], s[54:55], s[80:81]
    s_cbranch_scc1 L2_c137
L2_d137:
    v_mov_b64 v[84:85], v[70:71]
    v_mov_b32 v7, v93
    v_mov_b64 v[86:87], v[74:75]
    s_or_b64 s[80:81], s[80:81], s[54:55]
    s_mov_b64 exec, s[50:51]
    s_and_b64 s[82:83], s[50:51], s[80:81]
    s_cbranch_scc1 L2_c138
L2_d138:
    v_mov_b64 v[84:85], v[68:69]
    v_mov_b32 v7, v92
    v_mov_b64 v[86:87], v[72:73]
    s_mov_b64 exec, -1
    s_or_b64 s[80:81], s[80:81], s[50:51]
    s_and_b64 exec, s[84:85], s[80:81]
    v_mfma_f32_4x4x4_16b_bf16 v[76:79], v[12:13], v[84:85], 0
    v_mov_b32 v94, v7
    s_andn2_b64 s[80:81], s[80:81], s[84:85]
    v_mfma_f32_4x4x4_16b_bf16 v[76:79], v[10:11], v[86:87], v[76:79]
    s_mov_b64 exec, -1
    ds_read_b64 v[70:71], v95 offset:65408
    ds_read_b64 v[68:69], v94 offset:65408
    v_bitop3_b32 v92, v22, v5, v99 bitop3:0xea
    v_bitop3_b32 v93, v23, v5, v46 bitop3:0xea
    v_perm_b32 v15, v23, v26, s45
    v_bitop3_b32 v46, v23, 0.5, -0.5 bitop3:0xa8
    v_perm_b32 v14, v22, v26, s44
    v_bitop3_b32 v47, v22, 0.5, -0.5 bitop3:0xa8
    v_bitop3_b32 v15, v6, v15, v46 bitop3:0xca
    v_bitop3_b32 v14, v6, v14, v47 bitop3:0xca
    s_waitcnt lgkmcnt(1)
    v_mfma_f32_4x4x4_16b_bf16 v[80:83], v[10:11], v[70:71], v[80:83]
    s_waitcnt lgkmcnt(0)
    v_mfma_f32_4x4x4_16b_bf16 v[76:79], v[10:11], v[68:69], v[76:79]
    s_nop 2
    v_cvt_pk_bf16_f32 v80, v80, v81
    v_cvt_pk_bf16_f32 v81, v82, v83
    ds_wrxchg_rtn_b64 v[74:75], v95, v[80:81] offset:65408
    v_cvt_pk_bf16_f32 v76, v76, v77
    v_cvt_pk_bf16_f32 v77, v78, v79
    ds_wrxchg_rtn_b64 v[72:73], v94, v[76:77] offset:65408
    v_mfma_f32_4x4x4_16b_bf16 v[80:83], v[8:9], v[102:103], 0
    v_mfma_f32_4x4x4_16b_bf16 v[76:79], v[8:9], v[100:101], 0
    v_cmp_lt_u32 s[48:49], v5, v93
    s_nop 2
    v_pk_mul_f32 v[80:81], v[80:81], v[14:15] op_sel:[0,1] op_sel_hi:[1,1]
    v_pk_mul_f32 v[82:83], v[82:83], v[14:15] op_sel:[0,1] op_sel_hi:[1,1]
    v_pk_mul_f32 v[76:77], v[76:77], v[14:15] op_sel:[0,0] op_sel_hi:[1,0]
    v_pk_mul_f32 v[78:79], v[78:79], v[14:15] op_sel:[0,0] op_sel_hi:[1,0]
    s_lshl_b32 s3, s32, 12
    v_subrev_u32 v122, s3, v3
    s_mul_i32 s3, s33, 20000
    v_add_u32 v118, s3, v122
    v_add_u32 v119, 0x4000, v118
    s_lshl_b32 s3, s34, 7
    v_lshrrev_b32 v123, 7, v118
    v_and_b32 v120, 0x70, v118
    v_lshl_add_u32 v120, v123, 13, v120
    v_add_u32 v120, s3, v120
    v_lshrrev_b32 v123, 7, v119
    v_and_b32 v121, 0x70, v119
    v_lshl_add_u32 v121, v123, 13, v121
    v_add_u32 v121, s3, v121
    v_cmp_le_u32 vcc, 3616, v122
    s_mov_b64 exec, vcc
    v_mov_b32 v119, 2.0
    v_mov_b32 v121, 2.0
    s_mov_b64 exec, -1
    v_and_b32 v123, 0x30, v122
    v_lshlrev_b32 v123, 2, v123
    buffer_load_dwordx4 v[48:51], v123, s[24:27], 0 offen
    buffer_load_dwordx4 v[52:55], v123, s[24:27], 0 offen offset:16
    buffer_load_dwordx2 v[56:57], v123, s[24:27], 0 offen offset:32
    s_mov_b32 s12, s4
    s_mov_b32 s13, s5
    s_mov_b32 s14, 0x138800
    s_mov_b32 s15, 0x20000
    s_mov_b32 s16, s28
    s_mov_b32 s17, s29
    s_mov_b32 s18, 0x4e2000
    s_mov_b32 s19, 0x20000
    v_lshrrev_b32 v123, 2, v120
    buffer_load_dword v116, v123, s[12:15], 0 offen
    buffer_load_dwordx4 v[108:111], v120, s[16:19], 0 offen
    v_lshrrev_b32 v123, 2, v121
    buffer_load_dword v117, v123, s[12:15], 0 offen
    buffer_load_dwordx4 v[124:127], v121, s[16:19], 0 offen
    v_and_b32 v46, 0x80000000, v41
    v_lshrrev_b32 v47, 14, v25
    v_bitop3_b32 v47, v47, v5, v46 bitop3:0xea
    ds_read_b64 v[106:107], v47
    v_and_b32 v99, 0x40000000, v41
    v_lshrrev_b32 v47, 14, v24
    v_bitop3_b32 v47, v47, v5, v99 bitop3:0xea
    ds_read_b64 v[104:105], v47
    s_waitcnt lgkmcnt(2)
    v_cmp_ne_u64 s[50:51], v[72:73], v[68:69]
    v_cmpx_ne_u64 s[54:55], v[74:75], v[70:71]
    s_and_b64 s[82:83], s[54:55], s[80:81]
    s_cbranch_scc1 L2_c139
L2_d139:
    v_mov_b64 v[84:85], v[70:71]
    v_mov_b32 v7, v95
    v_mov_b64 v[86:87], v[74:75]
    s_or_b64 s[80:81], s[80:81], s[54:55]
    s_mov_b64 exec, s[50:51]
    s_and_b64 s[82:83], s[50:51], s[80:81]
    s_cbranch_scc1 L2_c140
L2_d140:
    v_mov_b64 v[84:85], v[68:69]
    v_mov_b32 v7, v94
    v_mov_b64 v[86:87], v[72:73]
    s_mov_b64 exec, -1
    s_or_b64 s[80:81], s[80:81], s[50:51]
    s_and_b64 exec, s[48:49], s[80:81]
    v_mfma_f32_4x4x4_16b_bf16 v[80:83], v[12:13], v[84:85], 0
    v_mov_b32 v93, v7
    s_andn2_b64 s[80:81], s[80:81], s[48:49]
    v_mfma_f32_4x4x4_16b_bf16 v[80:83], v[10:11], v[86:87], v[80:83]
    s_mov_b64 exec, -1
    ds_read_b64 v[70:71], v93 offset:65408
    ds_read_b64 v[68:69], v92 offset:65408
    v_bitop3_b32 v94, v24, v5, v99 bitop3:0xea
    v_bitop3_b32 v95, v25, v5, v46 bitop3:0xea
    v_perm_b32 v15, v25, v26, s47
    v_bitop3_b32 v46, v25, 0.5, -0.5 bitop3:0xa8
    v_perm_b32 v14, v24, v26, s46
    v_bitop3_b32 v47, v24, 0.5, -0.5 bitop3:0xa8
    v_bitop3_b32 v15, v6, v15, v46 bitop3:0xca
    v_bitop3_b32 v14, v6, v14, v47 bitop3:0xca
    s_waitcnt lgkmcnt(1)
    v_mfma_f32_4x4x4_16b_bf16 v[80:83], v[10:11], v[70:71], v[80:83]
    s_waitcnt lgkmcnt(0)
    v_mfma_f32_4x4x4_16b_bf16 v[76:79], v[10:11], v[68:69], v[76:79]
    s_nop 2
    v_cvt_pk_bf16_f32 v80, v80, v81
    v_cvt_pk_bf16_f32 v81, v82, v83
    ds_wrxchg_rtn_b64 v[74:75], v93, v[80:81] offset:65408
    v_cvt_pk_bf16_f32 v76, v76, v77
    v_cvt_pk_bf16_f32 v77, v78, v79
    ds_wrxchg_rtn_b64 v[72:73], v92, v[76:77] offset:65408
    s_setprio 2
    v_mfma_f32_4x4x4_16b_bf16 v[80:83], v[8:9], v[106:107], 0
    v_mfma_f32_4x4x4_16b_bf16 v[76:79], v[8:9], v[104:105], 0
    s_nop 3
    v_pk_mul_f32 v[80:81], v[80:81], v[14:15] op_sel:[0,1] op_sel_hi:[1,1]
    v_pk_mul_f32 v[82:83], v[82:83], v[14:15] op_sel:[0,1] op_sel_hi:[1,1]
    v_pk_mul_f32 v[76:77], v[76:77], v[14:15] op_sel:[0,0] op_sel_hi:[1,0]
    v_pk_mul_f32 v[78:79], v[78:79], v[14:15] op_sel:[0,0] op_sel_hi:[1,0]
    s_waitcnt vmcnt(9)
    v_and_b32 v46, 0x20000000, v42
    v_lshrrev_b32 v47, 14, v29
    v_bitop3_b32 v47, v47, v5, v46 bitop3:0xea
    ds_read_b64 v[102:103], v47
    v_and_b32 v99, 0x10000000, v42
    v_lshrrev_b32 v47, 14, v28
    v_bitop3_b32 v47, v47, v5, v99 bitop3:0xea
    ds_read_b64 v[100:101], v47
    s_waitcnt lgkmcnt(2)
    v_cmp_ne_u64 s[50:51], v[72:73], v[68:69]
    v_cmpx_ne_u64 s[54:55], v[74:75], v[70:71]
    s_and_b64 s[82:83], s[54:55], s[80:81]
    s_cbranch_scc1 L2_c141
L2_d141:
    v_mov_b64 v[84:85], v[70:71]
    v_mov_b32 v7, v93
    v_mov_b64 v[86:87], v[74:75]
    s_or_b64 s[80:81], s[80:81], s[54:55]
    s_mov_b64 exec, s[50:51]
    s_and_b64 s[82:83], s[50:51], s[80:81]
    s_cbranch_scc1 L2_c142
L2_d142:
    v_mov_b64 v[84:85], v[68:69]
    v_mov_b32 v7, v92
    v_mov_b64 v[86:87], v[72:73]
    s_mov_b64 exec, -1
    s_or_b64 s[80:81], s[80:81], s[50:51]
    ds_read_b64 v[70:71], v95 offset:65408
    ds_read_b64 v[68:69], v94 offset:65408
    v_bitop3_b32 v92, v28, v5, v99 bitop3:0xea
    v_bitop3_b32 v93, v29, v5, v46 bitop3:0xea
    v_perm_b32 v15, v29, v32, s45
    v_bitop3_b32 v46, v29, 0.5, -0.5 bitop3:0xa8
    v_perm_b32 v14, v28, v32, s44
    v_bitop3_b32 v47, v28, 0.5, -0.5 bitop3:0xa8
    v_bitop3_b32 v15, v6, v15, v46 bitop3:0xca
    v_bitop3_b32 v14, v6, v14, v47 bitop3:0xca
    s_waitcnt lgkmcnt(1)
    v_mfma_f32_4x4x4_16b_bf16 v[80:83], v[10:11], v[70:71], v[80:83]
    s_waitcnt lgkmcnt(0)
    v_mfma_f32_4x4x4_16b_bf16 v[76:79], v[10:11], v[68:69], v[76:79]
    s_nop 2
    v_cvt_pk_bf16_f32 v80, v80, v81
    v_cvt_pk_bf16_f32 v81, v82, v83
    ds_wrxchg_rtn_b64 v[74:75], v95, v[80:81] offset:65408
    v_cvt_pk_bf16_f32 v76, v76, v77
    v_cvt_pk_bf16_f32 v77, v78, v79
    ds_wrxchg_rtn_b64 v[72:73], v94, v[76:77] offset:65408
    s_setprio 1
    v_mfma_f32_4x4x4_16b_bf16 v[80:83], v[8:9], v[102:103], 0
    v_mfma_f32_4x4x4_16b_bf16 v[76:79], v[8:9], v[100:101], 0
    v_cmp_lt_u32 s[84:85], v5, v92
    s_nop 2
    v_pk_mul_f32 v[80:81], v[80:81], v[14:15] op_sel:[0,1] op_sel_hi:[1,1]
    v_pk_mul_f32 v[82:83], v[82:83], v[14:15] op_sel:[0,1] op_sel_hi:[1,1]
    v_pk_mul_f32 v[76:77], v[76:77], v[14:15] op_sel:[0,0] op_sel_hi:[1,0]
    v_pk_mul_f32 v[78:79], v[78:79], v[14:15] op_sel:[0,0] op_sel_hi:[1,0]
    s_bitcmp1_b32 s43, s42
    s_cbranch_scc1 L2_oa143
L2_ob143:
    v_and_b32 v46, 0x80000000, v42
    v_lshrrev_b32 v47, 14, v31
    v_bitop3_b32 v47, v47, v5, v46 bitop3:0xea
    ds_read_b64 v[106:107], v47
    v_and_b32 v99, 0x40000000, v42
    v_lshrrev_b32 v47, 14, v30
    v_bitop3_b32 v47, v47, v5, v99 bitop3:0xea
    ds_read_b64 v[104:105], v47
    s_waitcnt lgkmcnt(2)
    v_cmp_ne_u64 s[50:51], v[72:73], v[68:69]
    v_cmpx_ne_u64 s[54:55], v[74:75], v[70:71]
    s_and_b64 s[82:83], s[54:55], s[80:81]
    s_cbranch_scc1 L2_c144
L2_d144:
    v_mov_b64 v[84:85], v[70:71]
    v_mov_b32 v7, v95
    v_mov_b64 v[86:87], v[74:75]
    s_or_b64 s[80:81], s[80:81], s[54:55]
    s_mov_b64 exec, s[50:51]
    s_and_b64 s[82:83], s[50:51], s[80:81]
    s_cbranch_scc1 L2_c145
L2_d145:
    v_mov_b64 v[84:85], v[68:69]
    v_mov_b32 v7, v94
    v_mov_b64 v[86:87], v[72:73]
    s_mov_b64 exec, -1
    s_or_b64 s[80:81], s[80:81], s[50:51]
    s_and_b64 exec, s[84:85], s[80:81]
    v_mfma_f32_4x4x4_16b_bf16 v[76:79], v[12:13], v[84:85], 0
    v_mov_b32 v92, v7
    s_andn2_b64 s[80:81], s[80:81], s[84:85]
    v_mfma_f32_4x4x4_16b_bf16 v[76:79], v[10:11], v[86:87], v[76:79]
    s_mov_b64 exec, -1
    ds_read_b64 v[70:71], v93 offset:65408
    ds_read_b64 v[68:69], v92 offset:65408
    v_bitop3_b32 v94, v30, v5, v99 bitop3:0xea
    v_bitop3_b32 v95, v31, v5, v46 bitop3:0xea
    v_perm_b32 v15, v31, v32, s47
    v_bitop3_b32 v46, v31, 0.5, -0.5 bitop3:0xa8
    v_perm_b32 v14, v30, v32, s46
    v_bitop3_b32 v47, v30, 0.5, -0.5 bitop3:0xa8
    v_bitop3_b32 v15, v6, v15, v46 bitop3:0xca
    v_bitop3_b32 v14, v6, v14, v47 bitop3:0xca
    s_waitcnt lgkmcnt(1)
    v_mfma_f32_4x4x4_16b_bf16 v[80:83], v[10:11], v[70:71], v[80:83]
    s_waitcnt lgkmcnt(0)
    v_mfma_f32_4x4x4_16b_bf16 v[76:79], v[10:11], v[68:69], v[76:79]
    s_nop 2
    v_cvt_pk_bf16_f32 v80, v80, v81
    v_cvt_pk_bf16_f32 v81, v82, v83
    ds_wrxchg_rtn_b64 v[74:75], v93, v[80:81] offset:65408
    v_cvt_pk_bf16_f32 v76, v76, v77
    v_cvt_pk_bf16_f32 v77, v78, v79
    ds_wrxchg_rtn_b64 v[72:73], v92, v[76:77] offset:65408
    s_setprio 0
    v_mfma_f32_4x4x4_16b_bf16 v[80:83], v[8:9], v[106:107], 0
    v_mfma_f32_4x4x4_16b_bf16 v[76:79], v[8:9], v[104:105], 0
    v_cmp_lt_u32 s[48:49], v5, v95
    s_nop 2
    v_pk_mul_f32 v[80:81], v[80:81], v[14:15] op_sel:[0,1] op_sel_hi:[1,1]
    v_pk_mul_f32 v[82:83], v[82:83], v[14:15] op_sel:[0,1] op_sel_hi:[1,1]
    v_pk_mul_f32 v[76:77], v[76:77], v[14:15] op_sel:[0,0] op_sel_hi:[1,0]
    v_pk_mul_f32 v[78:79], v[78:79], v[14:15] op_sel:[0,0] op_sel_hi:[1,0]
    s_waitcnt vmcnt(7)
    v_and_b32 v46, 0x80000000, v43
    v_lshrrev_b32 v47, 14, v37
    v_bitop3_b32 v47, v47, v5, v46 bitop3:0xea
    ds_read_b64 v[106:107], v47
    v_and_b32 v99, 0x40000000, v43
    v_lshrrev_b32 v47, 14, v36
    v_bitop3_b32 v47, v47, v5, v99 bitop3:0xea
    ds_read_b64 v[104:105], v47
    v_and_b32 v46, 0x20000000, v43
    v_lshrrev_b32 v47, 14, v35
    v_bitop3_b32 v47, v47, v5, v46 bitop3:0xea
    ds_read_b64 v[102:103], v47
    v_and_b32 v99, 0x10000000, v43
    v_lshrrev_b32 v47, 14, v34
    v_bitop3_b32 v47, v47, v5, v99 bitop3:0xea
    ds_read_b64 v[100:101], v47
    s_waitcnt lgkmcnt(4)
    v_cmp_ne_u64 s[50:51], v[72:73], v[68:69]
    v_cmpx_ne_u64 s[54:55], v[74:75], v[70:71]
    s_and_b64 s[82:83], s[54:55], s[80:81]
    s_cbranch_scc1 L2_c146
L2_d146:
    v_mov_b64 v[84:85], v[70:71]
    v_mov_b32 v7, v93
    v_mov_b64 v[86:87], v[74:75]
    s_or_b64 s[80:81], s[80:81], s[54:55]
    s_mov_b64 exec, s[50:51]
    s_and_b64 s[82:83], s[50:51], s[80:81]
    s_cbranch_scc1 L2_c147
L2_d147:
    v_mov_b64 v[84:85], v[68:69]
    v_mov_b32 v7, v92
    v_mov_b64 v[86:87], v[72:73]
    s_mov_b64 exec, -1
    s_or_b64 s[80:81], s[80:81], s[50:51]
    s_and_b64 exec, s[48:49], s[80:81]
    v_mfma_f32_4x4x4_16b_bf16 v[80:83], v[12:13], v[84:85], 0
    v_mov_b32 v95, v7
    s_andn2_b64 s[80:81], s[80:81], s[48:49]
    v_mfma_f32_4x4x4_16b_bf16 v[80:83], v[10:11], v[86:87], v[80:83]
    s_mov_b64 exec, -1
    ds_read_b64 v[70:71], v95 offset:65408
    ds_read_b64 v[68:69], v94 offset:65408
    v_bitop3_b32 v92, v34, v5, v99 bitop3:0xea
    v_bitop3_b32 v93, v35, v5, v46 bitop3:0xea
    v_perm_b32 v15, v35, v38, s45
    v_bitop3_b32 v46, v35, 0.5, -0.5 bitop3:0xa8
    v_perm_b32 v14, v34, v38, s44
    v_bitop3_b32 v47, v34, 0.5, -0.5 bitop3:0xa8
    v_bitop3_b32 v15, v6, v15, v46 bitop3:0xca
    v_bitop3_b32 v14, v6, v14, v47 bitop3:0xca
    s_waitcnt lgkmcnt(1)
    v_mfma_f32_4x4x4_16b_bf16 v[80:83], v[10:11], v[70:71], v[80:83]
    s_waitcnt lgkmcnt(0)
    v_mfma_f32_4x4x4_16b_bf16 v[76:79], v[10:11], v[68:69], v[76:79]
    s_nop 2
    v_cvt_pk_bf16_f32 v80, v80, v81
    v_cvt_pk_bf16_f32 v81, v82, v83
    ds_wrxchg_rtn_b64 v[74:75], v95, v[80:81] offset:65408
    v_cvt_pk_bf16_f32 v76, v76, v77
    v_cvt_pk_bf16_f32 v77, v78, v79
    ds_wrxchg_rtn_b64 v[72:73], v94, v[76:77] offset:65408
    v_mfma_f32_4x4x4_16b_bf16 v[80:83], v[8:9], v[102:103], 0
    v_mfma_f32_4x4x4_16b_bf16 v[76:79], v[8:9], v[100:101], 0
    s_nop 3
    v_pk_mul_f32 v[80:81], v[80:81], v[14:15] op_sel:[0,1] op_sel_hi:[1,1]
    v_pk_mul_f32 v[82:83], v[82:83], v[14:15] op_sel:[0,1] op_sel_hi:[1,1]
    v_pk_mul_f32 v[76:77], v[76:77], v[14:15] op_sel:[0,0] op_sel_hi:[1,0]
    v_pk_mul_f32 v[78:79], v[78:79], v[14:15] op_sel:[0,0] op_sel_hi:[1,0]
    s_waitcnt lgkmcnt(0)
    v_cmp_ne_u64 s[50:51], v[72:73], v[68:69]
    v_cmpx_ne_u64 s[54:55], v[74:75], v[70:71]
    s_and_b64 s[82:83], s[54:55], s[80:81]
    s_cbranch_scc1 L2_c148
L2_d148:
    v_mov_b64 v[84:85], v[70:71]
    v_mov_b32 v7, v95
    v_mov_b64 v[86:87], v[74:75]
    s_or_b64 s[80:81], s[80:81], s[54:55]
    s_mov_b64 exec, s[50:51]
    s_and_b64 s[82:83], s[50:51], s[80:81]
    s_cbranch_scc1 L2_c149
L2_d149:
    v_mov_b64 v[84:85], v[68:69]
    v_mov_b32 v7, v94
    v_mov_b64 v[86:87], v[72:73]
    s_mov_b64 exec, -1
    s_or_b64 s[80:81], s[80:81], s[50:51]
    ds_read_b64 v[70:71], v93 offset:65408
    ds_read_b64 v[68:69], v92 offset:65408
    v_and_b32 v46, 0x40000000, v43
    v_bitop3_b32 v94, v36, v5, v46 bitop3:0xea
    v_and_b32 v46, 0x80000000, v43
    v_bitop3_b32 v95, v37, v5, v46 bitop3:0xea
    v_perm_b32 v15, v37, v38, s47
    v_bitop3_b32 v46, v37, 0.5, -0.5 bitop3:0xa8
    v_perm_b32 v14, v36, v38, s46
    v_bitop3_b32 v47, v36, 0.5, -0.5 bitop3:0xa8
    v_bitop3_b32 v15, v6, v15, v46 bitop3:0xca
    v_bitop3_b32 v14, v6, v14, v47 bitop3:0xca
    s_waitcnt lgkmcnt(1)
    v_mfma_f32_4x4x4_16b_bf16 v[80:83], v[10:11], v[70:71], v[80:83]
    s_waitcnt lgkmcnt(0)
    v_mfma_f32_4x4x4_16b_bf16 v[76:79], v[10:11], v[68:69], v[76:79]
    s_nop 2
    v_cvt_pk_bf16_f32 v80, v80, v81
    v_cvt_pk_bf16_f32 v81, v82, v83
    ds_wrxchg_rtn_b64 v[74:75], v93, v[80:81] offset:65408
    v_cvt_pk_bf16_f32 v76, v76, v77
    v_cvt_pk_bf16_f32 v77, v78, v79
    ds_wrxchg_rtn_b64 v[72:73], v92, v[76:77] offset:65408
    v_mfma_f32_4x4x4_16b_bf16 v[80:83], v[8:9], v[106:107], 0
    v_mfma_f32_4x4x4_16b_bf16 v[76:79], v[8:9], v[104:105], 0
    v_cmp_lt_u32 s[84:85], v5, v94
    s_nop 2
    v_pk_mul_f32 v[80:81], v[80:81], v[14:15] op_sel:[0,1] op_sel_hi:[1,1]
    v_pk_mul_f32 v[82:83], v[82:83], v[14:15] op_sel:[0,1] op_sel_hi:[1,1]
    v_pk_mul_f32 v[76:77], v[76:77], v[14:15] op_sel:[0,0] op_sel_hi:[1,0]
    v_pk_mul_f32 v[78:79], v[78:79], v[14:15] op_sel:[0,0] op_sel_hi:[1,0]
    s_waitcnt lgkmcnt(0)
    v_cmp_ne_u64 s[50:51], v[72:73], v[68:69]
    v_cmpx_ne_u64 s[54:55], v[74:75], v[70:71]
    s_and_b64 s[82:83], s[54:55], s[80:81]
    s_cbranch_scc1 L2_c150
L2_d150:
    v_mov_b64 v[84:85], v[70:71]
    v_mov_b32 v7, v93
    v_mov_b64 v[86:87], v[74:75]
    s_or_b64 s[80:81], s[80:81], s[54:55]
    s_mov_b64 exec, s[50:51]
    s_and_b64 s[82:83], s[50:51], s[80:81]
    s_cbranch_scc1 L2_c151
L2_d151:
    v_mov_b64 v[84:85], v[68:69]
    v_mov_b32 v7, v92
    v_mov_b64 v[86:87], v[72:73]
    s_mov_b64 exec, -1
    s_or_b64 s[80:81], s[80:81], s[50:51]
    s_and_b64 exec, s[84:85], s[80:81]
    v_mfma_f32_4x4x4_16b_bf16 v[76:79], v[12:13], v[84:85], 0
    v_mov_b32 v94, v7
    s_andn2_b64 s[80:81], s[80:81], s[84:85]
    v_mfma_f32_4x4x4_16b_bf16 v[76:79], v[10:11], v[86:87], v[76:79]
    s_mov_b64 exec, -1
    ds_read_b64 v[70:71], v95 offset:65408
    ds_read_b64 v[68:69], v94 offset:65408
    s_waitcnt lgkmcnt(1)
    v_mfma_f32_4x4x4_16b_bf16 v[80:83], v[10:11], v[70:71], v[80:83]
    s_waitcnt lgkmcnt(0)
    v_mfma_f32_4x4x4_16b_bf16 v[76:79], v[10:11], v[68:69], v[76:79]
    s_nop 2
    v_cvt_pk_bf16_f32 v80, v80, v81
    v_cvt_pk_bf16_f32 v81, v82, v83
    ds_wrxchg_rtn_b64 v[74:75], v95, v[80:81] offset:65408
    v_cvt_pk_bf16_f32 v76, v76, v77
    v_cvt_pk_bf16_f32 v77, v78, v79
    ds_wrxchg_rtn_b64 v[72:73], v94, v[76:77] offset:65408
    s_waitcnt lgkmcnt(0)
    v_cmpx_ne_u64 vcc, v[74:75], v[70:71]
    s_and_b64 s[82:83], vcc, s[80:81]
    s_cbranch_scc1 L2_c152
L2_d152:
    v_mov_b64 v[84:85], v[70:71]
    v_mov_b32 v7, v95
    v_mov_b64 v[86:87], v[74:75]
    s_mov_b64 exec, -1
    s_or_b64 s[80:81], s[80:81], vcc
    v_cmpx_ne_u64 vcc, v[72:73], v[68:69]
    s_and_b64 s[82:83], vcc, s[80:81]
    s_cbranch_scc1 L2_c153
L2_d153:
    v_mov_b64 v[84:85], v[68:69]
    v_mov_b32 v7, v94
    v_mov_b64 v[86:87], v[72:73]
    s_mov_b64 exec, -1
    s_or_b64 s[80:81], s[80:81], vcc
    s_mov_b64 exec, s[80:81]
    ds_read_b64 v[68:69], v7 offset:65408
    v_mfma_f32_4x4x4_16b_bf16 v[76:79], v[12:13], v[84:85], 0
    s_nop 1
    v_mfma_f32_4x4x4_16b_bf16 v[76:79], v[10:11], v[86:87], v[76:79]
    s_waitcnt lgkmcnt(0)
    s_nop 0
    v_mfma_f32_4x4x4_16b_bf16 v[76:79], v[10:11], v[68:69], v[76:79]
    v_mov_b64 v[84:85], v[68:69]
    s_nop 3
    v_cvt_pk_bf16_f32 v76, v76, v77
    v_cvt_pk_bf16_f32 v77, v78, v79
    ds_wrxchg_rtn_b64 v[86:87], v7, v[76:77] offset:65408
    s_waitcnt lgkmcnt(0)
    v_cmp_ne_u64 s[80:81], v[86:87], v[84:85]
    s_mov_b64 exec, s[80:81]
    s_nop 1
    v_mfma_f32_4x4x4_16b_bf16 v[88:91], v[12:13], v[84:85], 0
    s_nop 1
    v_mfma_f32_4x4x4_16b_bf16 v[88:91], v[10:11], v[86:87], v[88:91]
    s_nop 4
    v_cvt_pk_bf16_f32 v88, v88, v89
    v_cvt_pk_bf16_f32 v89, v90, v91
    ds_pk_add_bf16 v7, v88 offset:65408
    ds_pk_add_bf16 v7, v89 offset:65412
    s_mov_b64 exec, -1
    s_load_dwordx2 s[4:5], s[0:1], 88
    v_add_u32 v123, 0x4000, v122
    s_lshl_b32 s50, s96, 16
    s_and_b32 s51, s96, 0xffff0000
    s_lshl_b32 s52, s97, 16
    s_and_b32 s53, s97, 0xffff0000
    s_lshl_b32 s54, s98, 16
    s_and_b32 s55, s98, 0xffff0000
    s_lshl_b32 s56, s99, 16
    s_and_b32 s57, s99, 0xffff0000
    s_waitcnt vmcnt(0) lgkmcnt(0)
    s_barrier
    s_add_u32 s8, s30, 0xec55000
    s_addc_u32 s9, s31, 0
    s_mov_b32 s10, 0x8000
    s_mov_b32 s11, 0x20000
    s_mov_b32 s12, s4
    s_mov_b32 s13, s5
    s_mov_b32 s14, 0x4e2000
    s_mov_b32 s15, 0x20000
    s_add_u32 s20, s30, 0xd854000
    s_addc_u32 s21, s31, 0
    s_mov_b32 s22, 0x1400000
    s_mov_b32 s23, 0x20000
    s_lshl2_add_u32 s4, s34, s33
    s_mul_i32 s4, s4, 81920
    s_add_u32 s3, s33, 1
    s_and_b32 s3, s3, 3
    s_mul_i32 s36, s3, 20000
    s_add_u32 s36, s36, 81920
    s_mul_i32 s40, s3, 20480
    s_add_u32 s40, s40, s4
    s_lshl2_add_u32 s3, s34, s3
    s_mul_i32 s3, s3, 81920
    s_mul_i32 s44, s33, 20480
    s_add_u32 s44, s44, s3
    s_add_u32 s3, s33, 2
    s_and_b32 s3, s3, 3
    s_mul_i32 s37, s3, 20000
    s_add_u32 s37, s37, 81920
    s_mul_i32 s41, s3, 20480
    s_add_u32 s41, s41, s4
    s_lshl2_add_u32 s3, s34, s3
    s_mul_i32 s3, s3, 81920
    s_mul_i32 s45, s33, 20480
    s_add_u32 s45, s45, s3
    s_add_u32 s3, s33, 3
    s_and_b32 s3, s3, 3
    s_mul_i32 s38, s3, 20000
    s_add_u32 s38, s38, 81920
    s_mul_i32 s42, s3, 20480
    s_add_u32 s42, s42, s4
    s_lshl2_add_u32 s3, s34, s3
    s_mul_i32 s3, s3, 81920
    s_mul_i32 s46, s33, 20480
    s_add_u32 s46, s46, s3
    v_add_u32 v104, s36, v122
    ds_read_b128 v[16:19], v104
    v_add_u32 v104, s37, v122
    ds_read_b128 v[20:23], v104
    v_add_u32 v104, s38, v122
    ds_read_b128 v[24:27], v104
    s_waitcnt lgkmcnt(2)
    buffer_store_dwordx4 v[16:19], v122, s[20:23], s40 offen sc1
    s_waitcnt lgkmcnt(1)
    buffer_store_dwordx4 v[20:23], v122, s[20:23], s41 offen sc1
    s_waitcnt lgkmcnt(0)
    buffer_store_dwordx4 v[24:27], v122, s[20:23], s42 offen sc1
    s_cmp_ge_u32 s32, 4
    s_cbranch_scc1 L2_g0
    v_add_u32 v104, s36, v123
    ds_read_b128 v[36:39], v104
    v_add_u32 v104, s37, v123
    ds_read_b128 v[40:43], v104
    v_add_u32 v104, s38, v123
    ds_read_b128 v[44:47], v104
    s_waitcnt lgkmcnt(2)
    buffer_store_dwordx4 v[36:39], v123, s[20:23], s40 offen sc1
    s_waitcnt lgkmcnt(1)
    buffer_store_dwordx4 v[40:43], v123, s[20:23], s41 offen sc1
    s_waitcnt lgkmcnt(0)
    buffer_store_dwordx4 v[44:47], v123, s[20:23], s42 offen sc1
L2_g0:
    v_lshlrev_b32 v80, 16, v116
    v_subrev_f32 v60, s50, v80
    v_subrev_f32 v61, s51, v80
    v_subrev_f32 v62, s52, v80
    v_subrev_f32 v63, s53, v80
    v_subrev_f32 v64, s54, v80
    v_subrev_f32 v65, s55, v80
    v_subrev_f32 v66, s56, v80
    v_subrev_f32 v67, s57, v80
    v_cvt_pk_bf16_f32 v68, v60, v61
    v_cvt_pk_bf16_f32 v69, v62, v63
    v_cvt_pk_bf16_f32 v70, v64, v65
    v_cvt_pk_bf16_f32 v71, v66, v67
    v_lshlrev_b32 v60, 16, v68
    v_and_b32 v61, 0xffff0000, v68
    v_lshlrev_b32 v62, 16, v69
    v_and_b32 v63, 0xffff0000, v69
    v_lshlrev_b32 v64, 16, v70
    v_and_b32 v65, 0xffff0000, v70
    v_lshlrev_b32 v66, 16, v71
    v_and_b32 v67, 0xffff0000, v71
    v_mul_f32 v60, v60, v60
    v_mul_f32 v61, v61, v61
    v_mul_f32 v62, v62, v62
    v_mul_f32 v63, v63, v63
    v_mul_f32 v64, v64, v64
    v_mul_f32 v65, v65, v65
    v_mul_f32 v66, v66, v66
    v_mul_f32 v67, v67, v67
    v_cvt_pk_bf16_f32 v68, v60, v61
    v_cvt_pk_bf16_f32 v69, v62, v63
    v_cvt_pk_bf16_f32 v70, v64, v65
    v_cvt_pk_bf16_f32 v71, v66, v67
    v_lshlrev_b32 v60, 16, v68
    v_and_b32 v61, 0xffff0000, v68
    v_lshlrev_b32 v62, 16, v69
    v_and_b32 v63, 0xffff0000, v69
    v_lshlrev_b32 v64, 16, v70
    v_and_b32 v65, 0xffff0000, v70
    v_lshlrev_b32 v66, 16, v71
    v_and_b32 v67, 0xffff0000, v71
    v_mul_f32 v60, 0xc1200000, v60
    v_mul_f32 v61, 0xc1200000, v61
    v_mul_f32 v62, 0xc1200000, v62
    v_mul_f32 v63, 0xc1200000, v63
    v_mul_f32 v64, 0xc1200000, v64
    v_mul_f32 v65, 0xc1200000, v65
    v_mul_f32 v66, 0xc1200000, v66
    v_mul_f32 v67, 0xc1200000, v67
    v_cvt_pk_bf16_f32 v68, v60, v61
    v_cvt_pk_bf16_f32 v69, v62, v63
    v_cvt_pk_bf16_f32 v70, v64, v65
    v_cvt_pk_bf16_f32 v71, v66, v67
    v_lshlrev_b32 v60, 16, v68
    v_and_b32 v61, 0xffff0000, v68
    v_lshlrev_b32 v62, 16, v69
    v_and_b32 v63, 0xffff0000, v69
    v_lshlrev_b32 v64, 16, v70
    v_and_b32 v65, 0xffff0000, v70
    v_lshlrev_b32 v66, 16, v71
    v_and_b32 v67, 0xffff0000, v71
    v_mul_f32 v60, 0x3fb8aa3b, v60
    v_mul_f32 v61, 0x3fb8aa3b, v61
    v_mul_f32 v62, 0x3fb8aa3b, v62
    v_mul_f32 v63, 0x3fb8aa3b, v63
    v_mul_f32 v64, 0x3fb8aa3b, v64
    v_mul_f32 v65, 0x3fb8aa3b, v65
    v_mul_f32 v66, 0x3fb8aa3b, v66
    v_mul_f32 v67, 0x3fb8aa3b, v67
    v_exp_f32 v60, v60
    v_exp_f32 v61, v61
    v_exp_f32 v62, v62
    v_exp_f32 v63, v63
    v_exp_f32 v64, v64
    v_exp_f32 v65, v65
    v_exp_f32 v66, v66
    v_exp_f32 v67, v67
    v_cvt_pk_bf16_f32 v72, v60, v61
    v_cvt_pk_bf16_f32 v73, v62, v63
    v_cvt_pk_bf16_f32 v74, v64, v65
    v_cvt_pk_bf16_f32 v75, v66, v67
    v_and_b32 v84, 0xffff0000, v116
    v_subrev_f32 v60, s50, v84
    v_subrev_f32 v61, s51, v84
    v_subrev_f32 v62, s52, v84
    v_subrev_f32 v63, s53, v84
    v_subrev_f32 v64, s54, v84
    v_subrev_f32 v65, s55, v84
    v_subrev_f32 v66, s56, v84
    v_subrev_f32 v67, s57, v84
    v_cvt_pk_bf16_f32 v68, v60, v61
    v_cvt_pk_bf16_f32 v69, v62, v63
    v_cvt_pk_bf16_f32 v70, v64, v65
    v_cvt_pk_bf16_f32 v71, v66, v67
    v_lshlrev_b32 v60, 16, v68
    v_and_b32 v61, 0xffff0000, v68
    v_lshlrev_b32 v62, 16, v69
    v_and_b32 v63, 0xffff0000, v69
    v_lshlrev_b32 v64, 16, v70
    v_and_b32 v65, 0xffff0000, v70
    v_lshlrev_b32 v66, 16, v71
    v_and_b32 v67, 0xffff0000, v71
    v_mul_f32 v60, v60, v60
    v_mul_f32 v61, v61, v61
    v_mul_f32 v62, v62, v62
    v_mul_f32 v63, v63, v63
    v_mul_f32 v64, v64, v64
    v_mul_f32 v65, v65, v65
    v_mul_f32 v66, v66, v66
    v_mul_f32 v67, v67, v67
    v_cvt_pk_bf16_f32 v68, v60, v61
    v_cvt_pk_bf16_f32 v69, v62, v63
    v_cvt_pk_bf16_f32 v70, v64, v65
    v_cvt_pk_bf16_f32 v71, v66, v67
    v_lshlrev_b32 v60, 16, v68
    v_and_b32 v61, 0xffff0000, v68
    v_lshlrev_b32 v62, 16, v69
    v_and_b32 v63, 0xffff0000, v69
    v_lshlrev_b32 v64, 16, v70
    v_and_b32 v65, 0xffff0000, v70
    v_lshlrev_b32 v66, 16, v71
    v_and_b32 v67, 0xffff0000, v71
    v_mul_f32 v60, 0xc1200000, v60
    v_mul_f32 v61, 0xc1200000, v61
    v_mul_f32 v62, 0xc1200000, v62
    v_mul_f32 v63, 0xc1200000, v63
    v_mul_f32 v64, 0xc1200000, v64
    v_mul_f32 v65, 0xc1200000, v65
    v_mul_f32 v66, 0xc1200000, v66
    v_mul_f32 v67, 0xc1200000, v67
    v_cvt_pk_bf16_f32 v68, v60, v61
    v_cvt_pk_bf16_f32 v69, v62, v63
    v_cvt_pk_bf16_f32 v70, v64, v65
    v_cvt_pk_bf16_f32 v71, v66, v67
    v_lshlrev_b32 v60, 16, v68
    v_and_b32 v61, 0xffff0000, v68
    v_lshlrev_b32 v62, 16, v69
    v_and_b32 v63, 0xffff0000, v69
    v_lshlrev_b32 v64, 16, v70
    v_and_b32 v65, 0xffff0000, v70
    v_lshlrev_b32 v66, 16, v71
    v_and_b32 v67, 0xffff0000, v71
    v_mul_f32 v60, 0x3fb8aa3b, v60
    v_mul_f32 v61, 0x3fb8aa3b, v61
    v_mul_f32 v62, 0x3fb8aa3b, v62
    v_mul_f32 v63, 0x3fb8aa3b, v63
    v_mul_f32 v64, 0x3fb8aa3b, v64
    v_mul_f32 v65, 0x3fb8aa3b, v65
    v_mul_f32 v66, 0x3fb8aa3b, v66
    v_mul_f32 v67, 0x3fb8aa3b, v67
    v_exp_f32 v60, v60
    v_exp_f32 v61, v61
    v_exp_f32 v62, v62
    v_exp_f32 v63, v63
    v_exp_f32 v64, v64
    v_exp_f32 v65, v65
    v_exp_f32 v66, v66
    v_exp_f32 v67, v67
    v_cvt_pk_bf16_f32 v76, v60, v61
    v_cvt_pk_bf16_f32 v77, v62, v63
    v_cvt_pk_bf16_f32 v78, v64, v65
    v_cvt_pk_bf16_f32 v79, v66, v67
    v_mfma_f32_4x4x4_16b_bf16 v[80:83], v[48:49], v[72:73], 0
    v_mfma_f32_4x4x4_16b_bf16 v[88:91], v[52:53], v[72:73], 0
    v_mfma_f32_4x4x4_16b_bf16 v[84:87], v[48:49], v[76:77], 0
    v_mfma_f32_4x4x4_16b_bf16 v[92:95], v[52:53], v[76:77], 0
    v_mfma_f32_4x4x4_16b_bf16 v[80:83], v[50:51], v[74:75], v[80:83]
    v_mfma_f32_4x4x4_16b_bf16 v[88:91], v[54:55], v[74:75], v[88:91]
    v_mfma_f32_4x4x4_16b_bf16 v[84:87], v[50:51], v[78:79], v[84:87]
    v_mfma_f32_4x4x4_16b_bf16 v[92:95], v[54:55], v[78:79], v[92:95]
    s_lshl_b32 s3, s34, 9
    s_lshl_b32 s4, s33, 7
    s_add_u32 s4, s4, s3
    v_mov_b32 v104, 1
    v_and_b32 v105, 0x3f0, v122
    v_lshlrev_b32 v105, 3, v105
    v_add_u32 v106, 81920, v118
    ds_read_b128 v[32:35], v106
    v_add_u32 v106, 81920, v119
    ds_read_b128 v[60:63], v106
    s_waitcnt vmcnt(0)
    s_barrier
    s_cmp_lg_u32 s32, 0
    s_cbranch_scc1 L2_f2
    s_mov_b64 exec, 1
    buffer_store_dword v104, off, s[8:11], s4 sc1
    s_mov_b64 exec, 15
    s_bitset0_b64 exec, s33
L2_f3:
    buffer_load_dword v104, v105, s[8:11], s3 offen sc1
    s_waitcnt vmcnt(0)
    v_cmp_ne_u32 vcc, 1, v104
    s_cbranch_vccnz L2_f3s
    s_mov_b64 exec, -1
L2_f2:
    s_barrier
    buffer_load_dwordx4 v[36:39], v122, s[20:23], s44 offen sc1
    buffer_load_dwordx4 v[40:43], v122, s[20:23], s45 offen sc1
    buffer_load_dwordx4 v[44:47], v122, s[20:23], s46 offen sc1
    s_cmp_ge_u32 s32, 4
    s_cbranch_scc1 L2_f5
    buffer_load_dwordx4 v[64:67], v123, s[20:23], s44 offen sc1
    buffer_load_dwordx4 v[68:71], v123, s[20:23], s45 offen sc1
    buffer_load_dwordx4 v[72:75], v123, s[20:23], s46 offen sc1
    v_lshlrev_b32 v16, 16, v117
    v_subrev_f32 v96, s50, v16
    v_subrev_f32 v97, s51, v16
    v_subrev_f32 v98, s52, v16
    v_subrev_f32 v99, s53, v16
    v_subrev_f32 v100, s54, v16
    v_subrev_f32 v101, s55, v16
    v_subrev_f32 v102, s56, v16
    v_subrev_f32 v103, s57, v16
    v_cvt_pk_bf16_f32 v0, v96, v97
    v_cvt_pk_bf16_f32 v1, v98, v99
    v_cvt_pk_bf16_f32 v2, v100, v101
    v_cvt_pk_bf16_f32 v3, v102, v103
    v_lshlrev_b32 v96, 16, v0
    v_and_b32 v97, 0xffff0000, v0
    v_lshlrev_b32 v98, 16, v1
    v_and_b32 v99, 0xffff0000, v1
    v_lshlrev_b32 v100, 16, v2
    v_and_b32 v101, 0xffff0000, v2
    v_lshlrev_b32 v102, 16, v3
    v_and_b32 v103, 0xffff0000, v3
    v_mul_f32 v96, v96, v96
    v_mul_f32 v97, v97, v97
    v_mul_f32 v98, v98, v98
    v_mul_f32 v99, v99, v99
    v_mul_f32 v100, v100, v100
    v_mul_f32 v101, v101, v101
    v_mul_f32 v102, v102, v102
    v_mul_f32 v103, v103, v103
    v_cvt_pk_bf16_f32 v0, v96, v97
    v_cvt_pk_bf16_f32 v1, v98, v99
    v_cvt_pk_bf16_f32 v2, v100, v101
    v_cvt_pk_bf16_f32 v3, v102, v103
    v_lshlrev_b32 v96, 16, v0
    v_and_b32 v97, 0xffff0000, v0
    v_lshlrev_b32 v98, 16, v1
    v_and_b32 v99, 0xffff0000, v1
    v_lshlrev_b32 v100, 16, v2
    v_and_b32 v101, 0xffff0000, v2
    v_lshlrev_b32 v102, 16, v3
    v_and_b32 v103, 0xffff0000, v3
    v_mul_f32 v96, 0xc1200000, v96
    v_mul_f32 v97, 0xc1200000, v97
    v_mul_f32 v98, 0xc1200000, v98
    v_mul_f32 v99, 0xc1200000, v99
    v_mul_f32 v100, 0xc1200000, v100
    v_mul_f32 v101, 0xc1200000, v101
    v_mul_f32 v102, 0xc1200000, v102
    v_mul_f32 v103, 0xc1200000, v103
    v_cvt_pk_bf16_f32 v0, v96, v97
    v_cvt_pk_bf16_f32 v1, v98, v99
    v_cvt_pk_bf16_f32 v2, v100, v101
    v_cvt_pk_bf16_f32 v3, v102, v103
    v_lshlrev_b32 v96, 16, v0
    v_and_b32 v97, 0xffff0000, v0
    v_lshlrev_b32 v98, 16, v1
    v_and_b32 v99, 0xffff0000, v1
    v_lshlrev_b32 v100, 16, v2
    v_and_b32 v101, 0xffff0000, v2
    v_lshlrev_b32 v102, 16, v3
    v_and_b32 v103, 0xffff0000, v3
    v_mul_f32 v96, 0x3fb8aa3b, v96
    v_mul_f32 v97, 0x3fb8aa3b, v97
    v_mul_f32 v98, 0x3fb8aa3b, v98
    v_mul_f32 v99, 0x3fb8aa3b, v99
    v_mul_f32 v100, 0x3fb8aa3b, v100
    v_mul_f32 v101, 0x3fb8aa3b, v101
    v_mul_f32 v102, 0x3fb8aa3b, v102
    v_mul_f32 v103, 0x3fb8aa3b, v103
    v_exp_f32 v96, v96
    v_exp_f32 v97, v97
    v_exp_f32 v98, v98
    v_exp_f32 v99, v99
    v_exp_f32 v100, v100
    v_exp_f32 v101, v101
    v_exp_f32 v102, v102
    v_exp_f32 v103, v103
    v_cvt_pk_bf16_f32 v104, v96, v97
    v_cvt_pk_bf16_f32 v105, v98, v99
    v_cvt_pk_bf16_f32 v106, v100, v101
    v_cvt_pk_bf16_f32 v107, v102, v103
    v_and_b32 v20, 0xffff0000, v117
    v_subrev_f32 v96, s50, v20
    v_subrev_f32 v97, s51, v20
    v_subrev_f32 v98, s52, v20
    v_subrev_f32 v99, s53, v20
    v_subrev_f32 v100, s54, v20
    v_subrev_f32 v101, s55, v20
    v_subrev_f32 v102, s56, v20
    v_subrev_f32 v103, s57, v20
    v_cvt_pk_bf16_f32 v0, v96, v97
    v_cvt_pk_bf16_f32 v1, v98, v99
    v_cvt_pk_bf16_f32 v2, v100, v101
    v_cvt_pk_bf16_f32 v3, v102, v103
    v_lshlrev_b32 v96, 16, v0
    v_and_b32 v97, 0xffff0000, v0
    v_lshlrev_b32 v98, 16, v1
    v_and_b32 v99, 0xffff0000, v1
    v_lshlrev_b32 v100, 16, v2
    v_and_b32 v101, 0xffff0000, v2
    v_lshlrev_b32 v102, 16, v3
    v_and_b32 v103, 0xffff0000, v3
    v_mul_f32 v96, v96, v96
    v_mul_f32 v97, v97, v97
    v_mul_f32 v98, v98, v98
    v_mul_f32 v99, v99, v99
    v_mul_f32 v100, v100, v100
    v_mul_f32 v101, v101, v101
    v_mul_f32 v102, v102, v102
    v_mul_f32 v103, v103, v103
    v_cvt_pk_bf16_f32 v0, v96, v97
    v_cvt_pk_bf16_f32 v1, v98, v99
    v_cvt_pk_bf16_f32 v2, v100, v101
    v_cvt_pk_bf16_f32 v3, v102, v103
    v_lshlrev_b32 v96, 16, v0
    v_and_b32 v97, 0xffff0000, v0
    v_lshlrev_b32 v98, 16, v1
    v_and_b32 v99, 0xffff0000, v1
    v_lshlrev_b32 v100, 16, v2
    v_and_b32 v101, 0xffff0000, v2
    v_lshlrev_b32 v102, 16, v3
    v_and_b32 v103, 0xffff0000, v3
    v_mul_f32 v96, 0xc1200000, v96
    v_mul_f32 v97, 0xc1200000, v97
    v_mul_f32 v98, 0xc1200000, v98
    v_mul_f32 v99, 0xc1200000, v99
    v_mul_f32 v100, 0xc1200000, v100
    v_mul_f32 v101, 0xc1200000, v101
    v_mul_f32 v102, 0xc1200000, v102
    v_mul_f32 v103, 0xc1200000, v103
    v_cvt_pk_bf16_f32 v0, v96, v97
    v_cvt_pk_bf16_f32 v1, v98, v99
    v_cvt_pk_bf16_f32 v2, v100, v101
    v_cvt_pk_bf16_f32 v3, v102, v103
    v_lshlrev_b32 v96, 16, v0
    v_and_b32 v97, 0xffff0000, v0
    v_lshlrev_b32 v98, 16, v1
    v_and_b32 v99, 0xffff0000, v1
    v_lshlrev_b32 v100, 16, v2
    v_and_b32 v101, 0xffff0000, v2
    v_lshlrev_b32 v102, 16, v3
    v_and_b32 v103, 0xffff0000, v3
    v_mul_f32 v96, 0x3fb8aa3b, v96
    v_mul_f32 v97, 0x3fb8aa3b, v97
    v_mul_f32 v98, 0x3fb8aa3b, v98
    v_mul_f32 v99, 0x3fb8aa3b, v99
    v_mul_f32 v100, 0x3fb8aa3b, v100
    v_mul_f32 v101, 0x3fb8aa3b, v101
    v_mul_f32 v102, 0x3fb8aa3b, v102
    v_mul_f32 v103, 0x3fb8aa3b, v103
    v_exp_f32 v96, v96
    v_exp_f32 v97, v97
    v_exp_f32 v98, v98
    v_exp_f32 v99, v99
    v_exp_f32 v100, v100
    v_exp_f32 v101, v101
    v_exp_f32 v102, v102
    v_exp_f32 v103, v103
    v_cvt_pk_bf16_f32 v76, v96, v97
    v_cvt_pk_bf16_f32 v77, v98, v99
    v_cvt_pk_bf16_f32 v78, v100, v101
    v_cvt_pk_bf16_f32 v79, v102, v103
    v_mfma_f32_4x4x4_16b_bf16 v[16:19], v[48:49], v[104:105], 0
    v_mfma_f32_4x4x4_16b_bf16 v[24:27], v[52:53], v[104:105], 0
    v_mfma_f32_4x4x4_16b_bf16 v[20:23], v[48:49], v[76:77], 0
    v_mfma_f32_4x4x4_16b_bf16 v[28:31], v[52:53], v[76:77], 0
    v_mfma_f32_4x4x4_16b_bf16 v[16:19], v[50:51], v[106:107], v[16:19]
    v_mfma_f32_4x4x4_16b_bf16 v[24:27], v[54:55], v[106:107], v[24:27]
    v_mfma_f32_4x4x4_16b_bf16 v[20:23], v[50:51], v[78:79], v[20:23]
    v_mfma_f32_4x4x4_16b_bf16 v[28:31], v[54:55], v[78:79], v[28:31]
L2_f5:
    s_waitcnt vmcnt(0) lgkmcnt(0)
    v_mfma_f32_4x4x4_16b_bf16 v[96:99], v[10:11], v[32:33], 0
    v_mfma_f32_4x4x4_16b_bf16 v[100:103], v[10:11], v[34:35], 0
    s_nop 0
    v_mfma_f32_4x4x4_16b_bf16 v[96:99], v[10:11], v[36:37], v[96:99]
    v_mfma_f32_4x4x4_16b_bf16 v[100:103], v[10:11], v[38:39], v[100:103]
    s_nop 0
    v_mfma_f32_4x4x4_16b_bf16 v[96:99], v[10:11], v[40:41], v[96:99]
    v_mfma_f32_4x4x4_16b_bf16 v[100:103], v[10:11], v[42:43], v[100:103]
    s_nop 0
    v_mfma_f32_4x4x4_16b_bf16 v[96:99], v[10:11], v[44:45], v[96:99]
    v_mfma_f32_4x4x4_16b_bf16 v[100:103], v[10:11], v[46:47], v[100:103]
    s_nop 3
    v_mul_f32 v96, v96, v80
    v_mul_f32 v97, v97, v81
    v_mul_f32 v98, v98, v82
    v_mul_f32 v99, v99, v83
    v_cvt_pk_bf16_f32 v32, v96, v97
    v_cvt_pk_bf16_f32 v33, v98, v99
    v_mul_f32 v100, v100, v84
    v_mul_f32 v101, v101, v85
    v_mul_f32 v102, v102, v86
    v_mul_f32 v103, v103, v87
    v_cvt_pk_bf16_f32 v34, v100, v101
    v_cvt_pk_bf16_f32 v35, v102, v103
    v_mfma_f32_4x4x4_16b_bf16 v[80:83], v[56:57], v[32:33], 0
    s_nop 0
    v_mfma_f32_4x4x4_16b_bf16 v[84:87], v[56:57], v[34:35], 0
    s_nop 2
    v_mul_f32 v80, v80, v88
    v_mul_f32 v81, v81, v89
    v_mul_f32 v82, v82, v90
    v_mul_f32 v83, v83, v91
    v_mul_f32 v84, v84, v92
    v_mul_f32 v85, v85, v93
    v_mul_f32 v86, v86, v94
    v_mul_f32 v87, v87, v95
    v_mfma_f32_4x4x4_16b_bf16 v[96:99], v[10:11], v[108:109], v[80:83]
    s_nop 0
    v_mfma_f32_4x4x4_16b_bf16 v[100:103], v[10:11], v[110:111], v[84:87]
    s_nop 2
    v_cvt_pk_bf16_f32 v36, v96, v97
    v_cvt_pk_bf16_f32 v37, v98, v99
    v_cvt_pk_bf16_f32 v38, v100, v101
    v_cvt_pk_bf16_f32 v39, v102, v103
    buffer_store_dwordx4 v[36:39], v120, s[12:15], 0 offen nt
    s_cmp_ge_u32 s32, 4
    s_cbranch_scc1 L2_f6
    v_mfma_f32_4x4x4_16b_bf16 v[96:99], v[10:11], v[60:61], 0
    v_mfma_f32_4x4x4_16b_bf16 v[100:103], v[10:11], v[62:63], 0
    s_nop 0
    v_mfma_f32_4x4x4_16b_bf16 v[96:99], v[10:11], v[64:65], v[96:99]
    v_mfma_f32_4x4x4_16b_bf16 v[100:103], v[10:11], v[66:67], v[100:103]
    s_nop 0
    v_mfma_f32_4x4x4_16b_bf16 v[96:99], v[10:11], v[68:69], v[96:99]
    v_mfma_f32_4x4x4_16b_bf16 v[100:103], v[10:11], v[70:71], v[100:103]
    s_nop 0
    v_mfma_f32_4x4x4_16b_bf16 v[96:99], v[10:11], v[72:73], v[96:99]
    v_mfma_f32_4x4x4_16b_bf16 v[100:103], v[10:11], v[74:75], v[100:103]
    s_nop 3
    v_mul_f32 v96, v96, v16
    v_mul_f32 v97, v97, v17
    v_mul_f32 v98, v98, v18
    v_mul_f32 v99, v99, v19
    v_cvt_pk_bf16_f32 v60, v96, v97
    v_cvt_pk_bf16_f32 v61, v98, v99
    v_mul_f32 v100, v100, v20
    v_mul_f32 v101, v101, v21
    v_mul_f32 v102, v102, v22
    v_mul_f32 v103, v103, v23
    v_cvt_pk_bf16_f32 v62, v100, v101
    v_cvt_pk_bf16_f32 v63, v102, v103
    v_mfma_f32_4x4x4_16b_bf16 v[16:19], v[56:57], v[60:61], 0
    s_nop 0
    v_mfma_f32_4x4x4_16b_bf16 v[20:23], v[56:57], v[62:63], 0
    s_nop 2
    v_mul_f32 v16, v16, v24
    v_mul_f32 v17, v17, v25
    v_mul_f32 v18, v18, v26
    v_mul_f32 v19, v19, v27
    v_mul_f32 v20, v20, v28
    v_mul_f32 v21, v21, v29
    v_mul_f32 v22, v22, v30
    v_mul_f32 v23, v23, v31
    v_mfma_f32_4x4x4_16b_bf16 v[96:99], v[10:11], v[124:125], v[16:19]
    s_nop 0
    v_mfma_f32_4x4x4_16b_bf16 v[100:103], v[10:11], v[126:127], v[20:23]
    s_nop 2
    v_cvt_pk_bf16_f32 v64, v96, v97
    v_cvt_pk_bf16_f32 v65, v98, v99
    v_cvt_pk_bf16_f32 v66, v100, v101
    v_cvt_pk_bf16_f32 v67, v102, v103
    buffer_store_dwordx4 v[64:67], v121, s[12:15], 0 offen nt
L2_f6:
L2_end:
    s_endpgm
L2_slow:
    s_lshr_b32 s35, s42, 2
    s_lshl_b32 s50, s32, 4
    s_and_b32 s3, s42, 3
    s_lshl_b32 s53, s3, 3
    s_add_u32 s53, s53, s39
    s_and_b32 s3, s35, 2
    s_lshl_b32 s3, s3, 1
    s_add_u32 s53, s53, s3
    s_and_b32 s54, s35, 1
    s_lshl_b32 s54, s54, 4
L2_sl_seg:
    s_mul_i32 s55, s50, 173056
    s_and_b32 s3, s50, 3
    s_lshl_b32 s3, s3, 5
    s_add_u32 s3, s3, s55
    s_add_u32 s3, s3, s53
    buffer_load_dword v104, off, s[12:15], s3 sc1
    buffer_load_dword v105, off, s[12:15], s3 offset:32 sc1
    s_waitcnt vmcnt(0)
    v_readfirstlane_b32 s51, v104
    v_readfirstlane_b32 s52, v105
    s_lshr_b32 s51, s51, s54
    s_and_b32 s51, s51, 0xffff
    s_lshr_b32 s52, s52, s54
    s_and_b32 s52, s52, 0xffff
L2_sl_rec:
    s_cmp_ge_u32 s51, s52
    s_cbranch_scc1 L2_sl_next
    v_mbcnt_lo_u32_b32 v102, -1, 0
    v_mbcnt_hi_u32_b32 v102, -1, v102
    v_add_u32 v102, s51, v102
    v_and_b32 v103, -4, v102
    v_lshl_add_u32 v104, v102, 2, v103
    v_lshl_add_u32 v105, v103, 2, v102
    v_cmp_gt_u32 vcc, s52, v102
    s_mov_b64 exec, vcc
    buffer_load_dword v106, v104, s[8:11], s55 offen
    buffer_load_ubyte v107, v105, s[8:11], s55 offen offset:16
    s_waitcnt vmcnt(0)
    v_lshrrev_b32 v98, 14, v106
    v_and_b32 v98, v5, v98
    ds_read_b64 v[100:101], v98
    v_perm_b32 v97, v106, v107, s44
    v_and_b32 v96, v5, v106
    v_bitop3_b32 v103, v106, 0.5, -0.5 bitop3:0xa8
    v_bitop3_b32 v97, v6, v97, v103 bitop3:0xca
    s_waitcnt lgkmcnt(0)
    v_mfma_f32_4x4x4_16b_bf16 v[88:91], v[8:9], v[100:101], 0
    s_nop 4
    v_mul_f32 v88, v97, v88
    v_mul_f32 v89, v97, v89
    v_mul_f32 v90, v97, v90
    v_mul_f32 v91, v97, v91
    v_cvt_pk_bf16_f32 v88, v88, v89
    v_cvt_pk_bf16_f32 v89, v90, v91
    ds_pk_add_bf16 v96, v88 offset:65408
    ds_pk_add_bf16 v96, v89 offset:65412
    s_mov_b64 exec, -1
    s_add_u32 s51, s51, 64
    s_branch L2_sl_rec
L2_sl_next:
    s_add_u32 s50, s50, 1
    s_and_b32 s3, s50, 15
    s_cbranch_scc1 L2_sl_seg
    s_add_u32 s50, s50, 240
    s_cmp_lt_u32 s50, 1280
    s_cbranch_scc1 L2_sl_seg
    s_waitcnt lgkmcnt(0)
    s_cmp_eq_u32 s42, 0
    s_cbranch_scc1 L2_ret0
    s_cmp_eq_u32 s42, 1
    s_cbranch_scc1 L2_ret1
    s_cmp_eq_u32 s42, 14
    s_cbranch_scc1 L2_ret6
    s_cmp_eq_u32 s42, 15
    s_cbranch_scc1 L2_ret7
    s_and_b32 s3, s42, 3
    s_cmp_eq_u32 s3, 2
    s_cbranch_scc1 L2_ret2
    s_cmp_eq_u32 s3, 3
    s_cbranch_scc1 L2_ret3
    s_cmp_eq_u32 s3, 0
    s_cbranch_scc1 L2_ret4
    s_branch L2_ret5
L2_xo3:
    v_cmp_lt_u32 vcc, 20, v99
    s_mov_b32 s101, 1
    s_cbranch_vccz L2_xp3
    v_cmp_lt_u32 vcc, 32, v99
    v_cmp_lt_u32 s[58:59], 31, v88
    s_mov_b32 s101, 2
    s_or_b64 vcc, vcc, s[58:59]
    s_cbranch_scc0 L2_xp3
    s_mov_b32 s37, 0x10000
    s_branch L2_xp3
L2_xa4:
    s_cmp_eq_u32 s101, 1
    s_cbranch_scc1 L2_xc4
    v_lshlrev_b32 v89, 0, v96
    v_add_u32 v90, 140, v97
    v_bitop3_b32 v90, v89, v45, v90 bitop3:0x6a
    ds_write_b32 v98, v90 offset:28
    v_lshlrev_b32 v89, 4, v96
    v_add_u32 v90, 120, v97
    v_bitop3_b32 v90, v89, v45, v90 bitop3:0x6a
    ds_write_b32 v98, v90 offset:24
    v_lshlrev_b32 v89, 8, v96
    v_add_u32 v90, 100, v97
    v_bitop3_b32 v90, v89, v45, v90 bitop3:0x6a
    ds_write_b32 v98, v90 offset:20
L2_xc4:
    v_lshlrev_b32 v89, 12, v96
    v_add_u32 v90, 80, v97
    v_bitop3_b32 v90, v89, v45, v90 bitop3:0x6a
    ds_write_b32 v98, v90 offset:16
    s_branch L2_xb4
L2_xe4:
    v_cmp_lt_u32 vcc, 32, v99
    v_cmp_lt_u32 s[58:59], 31, v88
    v_lshrrev_b32 v89, 16, v96
    v_add_u32 v97, 80, v97
    s_or_b64 vcc, vcc, s[58:59]
    s_cbranch_scc1 L2_xs4
    v_lshlrev_b32 v89, v1, v89
    v_and_b32 v89, v45, v89
    v_cmp_ne_u32 vcc, 0, v89
    v_xor_b32 v90, v97, v89
    s_add_u32 s3, s37, s38
    v_mbcnt_lo_u32_b32 v98, vcc_lo, 0
    v_mbcnt_hi_u32_b32 v98, vcc_hi, v98
    s_bcnt1_i32_b64 s41, vcc
    v_lshl_add_u32 v98, v98, 2, s3
    s_lshl2_add_u32 s37, s41, s37
    s_mov_b64 exec, vcc
    ds_write_b32 v98, v90
    s_mov_b64 exec, -1
    s_branch L2_xr4
L2_xs4:
    s_waitcnt lgkmcnt(0)
    s_mov_b32 s37, 0x10000
    s_branch L2_xw4
L2_xf4:
    s_cmp_gt_u32 s37, 1024
    s_cbranch_scc1 L2_xt4
    s_cmp_lt_u32 s37, 768
    s_cbranch_scc1 L2_xl4
    ds_read_b32 v20, v44 offset:896
    s_add_u32 s3, s42, 0
    s_bitset1_b32 s43, s3
    s_branch L2_xg4
L2_xl4:
    s_waitcnt lgkmcnt(0)
    v_mov_b32 v19, -1
    s_cmp_ge_u32 s37, 512
    s_cbranch_scc1 L2_xg4
    v_mov_b32 v39, -1
    s_cmp_ge_u32 s37, 256
    s_cbranch_scc1 L2_xg4
    v_mov_b32 v33, -1
    s_branch L2_xg4
L2_xt4:
    s_waitcnt lgkmcnt(0)
    v_mov_b32 v27, -1
    v_mov_b32 v33, -1
    v_mov_b32 v39, -1
    v_mov_b32 v19, -1
    s_add_u32 s3, s42, 0
    s_bitset1_b32 s36, s3
    s_branch L2_xg4
L2_xo5:
    v_cmp_lt_u32 vcc, 20, v99
    s_mov_b32 s101, 1
    s_cbranch_vccz L2_xp5
    v_cmp_lt_u32 vcc, 32, v99
    v_cmp_lt_u32 s[58:59], 31, v88
    s_mov_b32 s101, 2
    s_or_b64 vcc, vcc, s[58:59]
    s_cbranch_scc0 L2_xp5
    s_mov_b32 s37, 0x10000
    s_branch L2_xp5
L2_xa6:
    s_cmp_eq_u32 s101, 1
    s_cbranch_scc1 L2_xc6
    v_lshlrev_b32 v89, 0, v96
    v_add_u32 v90, 140, v97
    v_bitop3_b32 v90, v89, v45, v90 bitop3:0x6a
    ds_write_b32 v98, v90 offset:28
    v_lshlrev_b32 v89, 4, v96
    v_add_u32 v90, 120, v97
    v_bitop3_b32 v90, v89, v45, v90 bitop3:0x6a
    ds_write_b32 v98, v90 offset:24
    v_lshlrev_b32 v89, 8, v96
    v_add_u32 v90, 100, v97
    v_bitop3_b32 v90, v89, v45, v90 bitop3:0x6a
    ds_write_b32 v98, v90 offset:20
L2_xc6:
    v_lshlrev_b32 v89, 12, v96
    v_add_u32 v90, 80, v97
    v_bitop3_b32 v90, v89, v45, v90 bitop3:0x6a
    ds_write_b32 v98, v90 offset:16
    s_branch L2_xb6
L2_xe6:
    v_cmp_lt_u32 vcc, 32, v99
    v_cmp_lt_u32 s[58:59], 31, v88
    v_lshrrev_b32 v89, 16, v96
    v_add_u32 v97, 80, v97
    s_or_b64 vcc, vcc, s[58:59]
    s_cbranch_scc1 L2_xs6
    v_lshlrev_b32 v89, v1, v89
    v_and_b32 v89, v45, v89
    v_cmp_ne_u32 vcc, 0, v89
    v_xor_b32 v90, v97, v89
    s_add_u32 s3, s37, s38
    v_mbcnt_lo_u32_b32 v98, vcc_lo, 0
    v_mbcnt_hi_u32_b32 v98, vcc_hi, v98
    s_bcnt1_i32_b64 s41, vcc
    v_lshl_add_u32 v98, v98, 2, s3
    s_lshl2_add_u32 s37, s41, s37
    s_mov_b64 exec, vcc
    ds_write_b32 v98, v90
    s_mov_b64 exec, -1
    s_branch L2_xr6
L2_xs6:
    s_waitcnt lgkmcnt(0)
    s_mov_b32 s37, 0x10000
    s_branch L2_xw6
L2_xf6:
    s_cmp_gt_u32 s37, 1024
    s_cbranch_scc1 L2_xt6
    s_cmp_lt_u32 s37, 768
    s_cbranch_scc1 L2_xl6
    ds_read_b32 v21, v44 offset:896
    s_add_u32 s3, s42, 1
    s_bitset1_b32 s43, s3
    s_branch L2_xg6
L2_xl6:
    s_waitcnt lgkmcnt(0)
    v_mov_b32 v40, -1
    s_cmp_ge_u32 s37, 512
    s_cbranch_scc1 L2_xg6
    v_mov_b32 v43, -1
    s_cmp_ge_u32 s37, 256
    s_cbranch_scc1 L2_xg6
    v_mov_b32 v42, -1
    s_branch L2_xg6
L2_xt6:
    s_waitcnt lgkmcnt(0)
    v_mov_b32 v41, -1
    v_mov_b32 v42, -1
    v_mov_b32 v43, -1
    v_mov_b32 v40, -1
    s_add_u32 s3, s42, 1
    s_bitset1_b32 s36, s3
    s_branch L2_xg6
L2_oa7:
    v_and_b32 v47, 0x0fffffff, v20
    buffer_load_dword v78, v47, s[8:11], 0 offen offset:16
    s_mov_b64 exec, s[6:7]
    v_add_u32 v47, 8, v47
    v_lshrrev_b32 v20, 2, v20
    s_mov_b64 exec, -1
    buffer_load_dwordx2 v[76:77], v47, s[8:11], 0 offen
    s_branch L2_ob7
L2_oa8:
    s_waitcnt vmcnt(0)
    s_mov_b64 exec, s[6:7]
    v_lshrrev_b32 v78, 16, v78
    s_mov_b64 exec, -1
    v_and_b32 v46, 0x10000000, v20
    v_cmpx_eq_u32 vcc, 0, v46
    v_lshrrev_b32 v47, 14, v76
    v_and_b32 v47, v5, v47
    ds_read_b64 v[96:97], v47
    v_perm_b32 v98, v76, v78, s44
    v_bitop3_b32 v99, v76, 0.5, -0.5 bitop3:0xa8
    v_bitop3_b32 v98, v6, v98, v99 bitop3:0xca
    v_and_b32 v47, v5, v76
    s_waitcnt lgkmcnt(0)
    v_mfma_f32_4x4x4_16b_bf16 v[88:91], v[8:9], v[96:97], 0
    s_nop 4
    v_mul_f32 v88, v98, v88
    v_mul_f32 v89, v98, v89
    v_mul_f32 v90, v98, v90
    v_mul_f32 v91, v98, v91
    v_cvt_pk_bf16_f32 v88, v88, v89
    v_cvt_pk_bf16_f32 v89, v90, v91
    ds_pk_add_bf16 v47, v88 offset:65408
    ds_pk_add_bf16 v47, v89 offset:65412
    s_mov_b64 exec, -1
    v_and_b32 v46, 0x20000000, v20
    v_cmpx_eq_u32 vcc, 0, v46
    v_lshrrev_b32 v47, 14, v77
    v_and_b32 v47, v5, v47
    ds_read_b64 v[96:97], v47
    v_perm_b32 v98, v77, v78, s45
    v_bitop3_b32 v99, v77, 0.5, -0.5 bitop3:0xa8
    v_bitop3_b32 v98, v6, v98, v99 bitop3:0xca
    v_and_b32 v47, v5, v77
    s_waitcnt lgkmcnt(0)
    v_mfma_f32_4x4x4_16b_bf16 v[88:91], v[8:9], v[96:97], 0
    s_nop 4
    v_mul_f32 v88, v98, v88
    v_mul_f32 v89, v98, v89
    v_mul_f32 v90, v98, v90
    v_mul_f32 v91, v98, v91
    v_cvt_pk_bf16_f32 v88, v88, v89
    v_cvt_pk_bf16_f32 v89, v90, v91
    ds_pk_add_bf16 v47, v88 offset:65408
    ds_pk_add_bf16 v47, v89 offset:65412
    s_mov_b64 exec, -1
    s_branch L2_ob8
L2_c9:
    s_lshl_b64 s[52:53], s[82:83], 1
    s_andn2_b64 s[52:53], s[52:53], s[80:81]
    s_andn2_b64 s[52:53], s[52:53], s[54:55]
    s_or_b64 s[80:81], s[80:81], s[52:53]
    s_not_b64 vcc, s[52:53]
    s_mov_b64 exec, -1
    v_cndmask_b32_dpp v84, v84, v84, vcc wave_shr:1 row_mask:0xf bank_mask:0xf
    v_cndmask_b32_dpp v85, v85, v85, vcc wave_shr:1 row_mask:0xf bank_mask:0xf
    s_lshr_b64 s[52:53], s[52:53], 1
    v_cndmask_b32_dpp v86, v86, v86, vcc wave_shr:1 row_mask:0xf bank_mask:0xf
    v_cndmask_b32_dpp v87, v87, v87, vcc wave_shr:1 row_mask:0xf bank_mask:0xf
    s_andn2_b64 s[82:83], s[82:83], s[52:53]
    v_cndmask_b32_dpp v7, v7, v7, vcc wave_shr:1 row_mask:0xf bank_mask:0xf
    s_mov_b64 exec, s[54:55]
    s_cbranch_scc0 L2_d9
    s_mov_b64 exec, s[82:83]
    s_nop 1
    v_mfma_f32_4x4x4_16b_bf16 v[88:91], v[12:13], v[84:85], 0
    s_nop 1
    v_mfma_f32_4x4x4_16b_bf16 v[88:91], v[10:11], v[86:87], v[88:91]
    s_nop 4
    v_cvt_pk_bf16_f32 v88, v88, v89
    v_cvt_pk_bf16_f32 v89, v90, v91
    ds_pk_add_bf16 v7, v88 offset:65408
    ds_pk_add_bf16 v7, v89 offset:65412
    s_mov_b64 exec, s[54:55]
    s_branch L2_d9
L2_c10:
    s_lshl_b64 s[52:53], s[82:83], 1
    s_andn2_b64 s[52:53], s[52:53], s[80:81]
    s_andn2_b64 s[52:53], s[52:53], s[50:51]
    s_or_b64 s[80:81], s[80:81], s[52:53]
    s_not_b64 vcc, s[52:53]
    s_mov_b64 exec, -1
    v_cndmask_b32_dpp v84, v84, v84, vcc wave_shr:1 row_mask:0xf bank_mask:0xf
    v_cndmask_b32_dpp v85, v85, v85, vcc wave_shr:1 row_mask:0xf bank_mask:0xf
    s_lshr_b64 s[52:53], s[52:53], 1
    v_cndmask_b32_dpp v86, v86, v86, vcc wave_shr:1 row_mask:0xf bank_mask:0xf
    v_cndmask_b32_dpp v87, v87, v87, vcc wave_shr:1 row_mask:0xf bank_mask:0xf
    s_andn2_b64 s[82:83], s[82:83], s[52:53]
    v_cndmask_b32_dpp v7, v7, v7, vcc wave_shr:1 row_mask:0xf bank_mask:0xf
    s_mov_b64 exec, s[50:51]
    s_cbranch_scc0 L2_d10
    s_mov_b64 exec, s[82:83]
    s_nop 1
    v_mfma_f32_4x4x4_16b_bf16 v[88:91], v[12:13], v[84:85], 0
    s_nop 1
    v_mfma_f32_4x4x4_16b_bf16 v[88:91], v[10:11], v[86:87], v[88:91]
    s_nop 4
    v_cvt_pk_bf16_f32 v88, v88, v89
    v_cvt_pk_bf16_f32 v89, v90, v91
    ds_pk_add_bf16 v7, v88 offset:65408
    ds_pk_add_bf16 v7, v89 offset:65412
    s_mov_b64 exec, s[50:51]
    s_branch L2_d10
L2_c13:
    s_lshl_b64 s[52:53], s[82:83], 1
    s_andn2_b64 s[52:53], s[52:53], s[80:81]
    s_andn2_b64 s[52:53], s[52:53], s[54:55]
    s_or_b64 s[80:81], s[80:81], s[52:53]
    s_not_b64 vcc, s[52:53]
    s_mov_b64 exec, -1
    v_cndmask_b32_dpp v84, v84, v84, vcc wave_shr:1 row_mask:0xf bank_mask:0xf
    v_cndmask_b32_dpp v85, v85, v85, vcc wave_shr:1 row_mask:0xf bank_mask:0xf
    s_lshr_b64 s[52:53], s[52:53], 1
    v_cndmask_b32_dpp v86, v86, v86, vcc wave_shr:1 row_mask:0xf bank_mask:0xf
    v_cndmask_b32_dpp v87, v87, v87, vcc wave_shr:1 row_mask:0xf bank_mask:0xf
    s_andn2_b64 s[82:83], s[82:83], s[52:53]
    v_cndmask_b32_dpp v7, v7, v7, vcc wave_shr:1 row_mask:0xf bank_mask:0xf
    s_mov_b64 exec, s[54:55]
    s_cbranch_scc0 L2_d13
    s_mov_b64 exec, s[82:83]
    s_nop 1
    v_mfma_f32_4x4x4_16b_bf16 v[88:91], v[12:13], v[84:85], 0
    s_nop 1
    v_mfma_f32_4x4x4_16b_bf16 v[88:91], v[10:11], v[86:87], v[88:91]
    s_nop 4
    v_cvt_pk_bf16_f32 v88, v88, v89
    v_cvt_pk_bf16_f32 v89, v90, v91
    ds_pk_add_bf16 v7, v88 offset:65408
    ds_pk_add_bf16 v7, v89 offset:65412
    s_mov_b64 exec, s[54:55]
    s_branch L2_d13
L2_c14:
    s_lshl_b64 s[52:53], s[82:83], 1
    s_andn2_b64 s[52:53], s[52:53], s[80:81]
    s_andn2_b64 s[52:53], s[52:53], s[50:51]
    s_or_b64 s[80:81], s[80:81], s[52:53]
    s_not_b64 vcc, s[52:53]
    s_mov_b64 exec, -1
    v_cndmask_b32_dpp v84, v84, v84, vcc wave_shr:1 row_mask:0xf bank_mask:0xf
    v_cndmask_b32_dpp v85, v85, v85, vcc wave_shr:1 row_mask:0xf bank_mask:0xf
    s_lshr_b64 s[52:53], s[52:53], 1
    v_cndmask_b32_dpp v86, v86, v86, vcc wave_shr:1 row_mask:0xf bank_mask:0xf
    v_cndmask_b32_dpp v87, v87, v87, vcc wave_shr:1 row_mask:0xf bank_mask:0xf
    s_andn2_b64 s[82:83], s[82:83], s[52:53]
    v_cndmask_b32_dpp v7, v7, v7, vcc wave_shr:1 row_mask:0xf bank_mask:0xf
    s_mov_b64 exec, s[50:51]
    s_cbranch_scc0 L2_d14
    s_mov_b64 exec, s[82:83]
    s_nop 1
    v_mfma_f32_4x4x4_16b_bf16 v[88:91], v[12:13], v[84:85], 0
    s_nop 1
    v_mfma_f32_4x4x4_16b_bf16 v[88:91], v[10:11], v[86:87], v[88:91]
    s_nop 4
    v_cvt_pk_bf16_f32 v88, v88, v89
    v_cvt_pk_bf16_f32 v89, v90, v91
    ds_pk_add_bf16 v7, v88 offset:65408
    ds_pk_add_bf16 v7, v89 offset:65412
    s_mov_b64 exec, s[50:51]
    s_branch L2_d14
L2_c16:
    s_lshl_b64 s[52:53], s[82:83], 1
    s_andn2_b64 s[52:53], s[52:53], s[80:81]
    s_andn2_b64 s[52:53], s[52:53], s[54:55]
    s_or_b64 s[80:81], s[80:81], s[52:53]
    s_not_b64 vcc, s[52:53]
    s_mov_b64 exec, -1
    v_cndmask_b32_dpp v84, v84, v84, vcc wave_shr:1 row_mask:0xf bank_mask:0xf
    v_cndmask_b32_dpp v85, v85, v85, vcc wave_shr:1 row_mask:0xf bank_mask:0xf
    s_lshr_b64 s[52:53], s[52:53], 1
    v_cndmask_b32_dpp v86, v86, v86, vcc wave_shr:1 row_mask:0xf bank_mask:0xf
    v_cndmask_b32_dpp v87, v87, v87, vcc wave_shr:1 row_mask:0xf bank_mask:0xf
    s_andn2_b64 s[82:83], s[82:83], s[52:53]
    v_cndmask_b32_dpp v7, v7, v7, vcc wave_shr:1 row_mask:0xf bank_mask:0xf
    s_mov_b64 exec, s[54:55]
    s_cbranch_scc0 L2_d16
    s_mov_b64 exec, s[82:83]
    s_nop 1
    v_mfma_f32_4x4x4_16b_bf16 v[88:91], v[12:13], v[84:85], 0
    s_nop 1
    v_mfma_f32_4x4x4_16b_bf16 v[88:91], v[10:11], v[86:87], v[88:91]
    s_nop 4
    v_cvt_pk_bf16_f32 v88, v88, v89
    v_cvt_pk_bf16_f32 v89, v90, v91
    ds_pk_add_bf16 v7, v88 offset:65408
    ds_pk_add_bf16 v7, v89 offset:65412
    s_mov_b64 exec, s[54:55]
    s_branch L2_d16
L2_c17:
    s_lshl_b64 s[52:53], s[82:83], 1
    s_andn2_b64 s[52:53], s[52:53], s[80:81]
    s_andn2_b64 s[52:53], s[52:53], s[50:51]
    s_or_b64 s[80:81], s[80:81], s[52:53]
    s_not_b64 vcc, s[52:53]
    s_mov_b64 exec, -1
    v_cndmask_b32_dpp v84, v84, v84, vcc wave_shr:1 row_mask:0xf bank_mask:0xf
    v_cndmask_b32_dpp v85, v85, v85, vcc wave_shr:1 row_mask:0xf bank_mask:0xf
    s_lshr_b64 s[52:53], s[52:53], 1
    v_cndmask_b32_dpp v86, v86, v86, vcc wave_shr:1 row_mask:0xf bank_mask:0xf
    v_cndmask_b32_dpp v87, v87, v87, vcc wave_shr:1 row_mask:0xf bank_mask:0xf
    s_andn2_b64 s[82:83], s[82:83], s[52:53]
    v_cndmask_b32_dpp v7, v7, v7, vcc wave_shr:1 row_mask:0xf bank_mask:0xf
    s_mov_b64 exec, s[50:51]
    s_cbranch_scc0 L2_d17
    s_mov_b64 exec, s[82:83]
    s_nop 1
    v_mfma_f32_4x4x4_16b_bf16 v[88:91], v[12:13], v[84:85], 0
    s_nop 1
    v_mfma_f32_4x4x4_16b_bf16 v[88:91], v[10:11], v[86:87], v[88:91]
    s_nop 4
    v_cvt_pk_bf16_f32 v88, v88, v89
    v_cvt_pk_bf16_f32 v89, v90, v91
    ds_pk_add_bf16 v7, v88 offset:65408
    ds_pk_add_bf16 v7, v89 offset:65412
    s_mov_b64 exec, s[50:51]
    s_branch L2_d17
L2_xo20:
    v_cmp_lt_u32 vcc, 20, v99
    s_mov_b32 s101, 1
    s_cbranch_vccz L2_xp20
    v_cmp_lt_u32 vcc, 32, v99
    v_cmp_lt_u32 s[58:59], 31, v88
    s_mov_b32 s101, 2
    s_or_b64 vcc, vcc, s[58:59]
    s_cbranch_scc0 L2_xp20
    s_mov_b32 s37, 0x10000
    s_branch L2_xp20
L2_c21:
    s_lshl_b64 s[52:53], s[82:83], 1
    s_andn2_b64 s[52:53], s[52:53], s[80:81]
    s_andn2_b64 s[52:53], s[52:53], s[54:55]
    s_or_b64 s[80:81], s[80:81], s[52:53]
    s_not_b64 vcc, s[52:53]
    s_mov_b64 exec, -1
    v_cndmask_b32_dpp v84, v84, v84, vcc wave_shr:1 row_mask:0xf bank_mask:0xf
    v_cndmask_b32_dpp v85, v85, v85, vcc wave_shr:1 row_mask:0xf bank_mask:0xf
    s_lshr_b64 s[52:53], s[52:53], 1
    v_cndmask_b32_dpp v86, v86, v86, vcc wave_shr:1 row_mask:0xf bank_mask:0xf
    v_cndmask_b32_dpp v87, v87, v87, vcc wave_shr:1 row_mask:0xf bank_mask:0xf
    s_andn2_b64 s[82:83], s[82:83], s[52:53]
    v_cndmask_b32_dpp v7, v7, v7, vcc wave_shr:1 row_mask:0xf bank_mask:0xf
    s_mov_b64 exec, s[54:55]
    s_cbranch_scc0 L2_d21
    s_mov_b64 exec, s[82:83]
    s_nop 1
    v_mfma_f32_4x4x4_16b_bf16 v[88:91], v[12:13], v[84:85], 0
    s_nop 1
    v_mfma_f32_4x4x4_16b_bf16 v[88:91], v[10:11], v[86:87], v[88:91]
    s_nop 4
    v_cvt_pk_bf16_f32 v88, v88, v89
    v_cvt_pk_bf16_f32 v89, v90, v91
    ds_pk_add_bf16 v7, v88 offset:65408
    ds_pk_add_bf16 v7, v89 offset:65412
    s_mov_b64 exec, s[54:55]
    s_branch L2_d21
L2_c22:
    s_lshl_b64 s[52:53], s[82:83], 1
    s_andn2_b64 s[52:53], s[52:53], s[80:81]
    s_andn2_b64 s[52:53], s[52:53], s[50:51]
    s_or_b64 s[80:81], s[80:81], s[52:53]
    s_not_b64 vcc, s[52:53]
    s_mov_b64 exec, -1
    v_cndmask_b32_dpp v84, v84, v84, vcc wave_shr:1 row_mask:0xf bank_mask:0xf
    v_cndmask_b32_dpp v85, v85, v85, vcc wave_shr:1 row_mask:0xf bank_mask:0xf
    s_lshr_b64 s[52:53], s[52:53], 1
    v_cndmask_b32_dpp v86, v86, v86, vcc wave_shr:1 row_mask:0xf bank_mask:0xf
    v_cndmask_b32_dpp v87, v87, v87, vcc wave_shr:1 row_mask:0xf bank_mask:0xf
    s_andn2_b64 s[82:83], s[82:83], s[52:53]
    v_cndmask_b32_dpp v7, v7, v7, vcc wave_shr:1 row_mask:0xf bank_mask:0xf
    s_mov_b64 exec, s[50:51]
    s_cbranch_scc0 L2_d22
    s_mov_b64 exec, s[82:83]
    s_nop 1
    v_mfma_f32_4x4x4_16b_bf16 v[88:91], v[12:13], v[84:85], 0
    s_nop 1
    v_mfma_f32_4x4x4_16b_bf16 v[88:91], v[10:11], v[86:87], v[88:91]
    s_nop 4
    v_cvt_pk_bf16_f32 v88, v88, v89
    v_cvt_pk_bf16_f32 v89, v90, v91
    ds_pk_add_bf16 v7, v88 offset:65408
    ds_pk_add_bf16 v7, v89 offset:65412
    s_mov_b64 exec, s[50:51]
    s_branch L2_d22
L2_c23:
    s_lshl_b64 s[52:53], s[82:83], 1
    s_andn2_b64 s[52:53], s[52:53], s[80:81]
    s_andn2_b64 s[52:53], s[52:53], s[54:55]
    s_or_b64 s[80:81], s[80:81], s[52:53]
    s_not_b64 vcc, s[52:53]
    s_mov_b64 exec, -1
    v_cndmask_b32_dpp v84, v84, v84, vcc wave_shr:1 row_mask:0xf bank_mask:0xf
    v_cndmask_b32_dpp v85, v85, v85, vcc wave_shr:1 row_mask:0xf bank_mask:0xf
    s_lshr_b64 s[52:53], s[52:53], 1
    v_cndmask_b32_dpp v86, v86, v86, vcc wave_shr:1 row_mask:0xf bank_mask:0xf
    v_cndmask_b32_dpp v87, v87, v87, vcc wave_shr:1 row_mask:0xf bank_mask:0xf
    s_andn2_b64 s[82:83], s[82:83], s[52:53]
    v_cndmask_b32_dpp v7, v7, v7, vcc wave_shr:1 row_mask:0xf bank_mask:0xf
    s_mov_b64 exec, s[54:55]
    s_cbranch_scc0 L2_d23
    s_mov_b64 exec, s[82:83]
    s_nop 1
    v_mfma_f32_4x4x4_16b_bf16 v[88:91], v[12:13], v[84:85], 0
    s_nop 1
    v_mfma_f32_4x4x4_16b_bf16 v[88:91], v[10:11], v[86:87], v[88:91]
    s_nop 4
    v_cvt_pk_bf16_f32 v88, v88, v89
    v_cvt_pk_bf16_f32 v89, v90, v91
    ds_pk_add_bf16 v7, v88 offset:65408
    ds_pk_add_bf16 v7, v89 offset:65412
    s_mov_b64 exec, s[54:55]
    s_branch L2_d23
L2_c24:
    s_lshl_b64 s[52:53], s[82:83], 1
    s_andn2_b64 s[52:53], s[52:53], s[80:81]
    s_andn2_b64 s[52:53], s[52:53], s[50:51]
    s_or_b64 s[80:81], s[80:81], s[52:53]
    s_not_b64 vcc, s[52:53]
    s_mov_b64 exec, -1
    v_cndmask_b32_dpp v84, v84, v84, vcc wave_shr:1 row_mask:0xf bank_mask:0xf
    v_cndmask_b32_dpp v85, v85, v85, vcc wave_shr:1 row_mask:0xf bank_mask:0xf
    s_lshr_b64 s[52:53], s[52:53], 1
    v_cndmask_b32_dpp v86, v86, v86, vcc wave_shr:1 row_mask:0xf bank_mask:0xf
    v_cndmask_b32_dpp v87, v87, v87, vcc wave_shr:1 row_mask:0xf bank_mask:0xf
    s_andn2_b64 s[82:83], s[82:83], s[52:53]
    v_cndmask_b32_dpp v7, v7, v7, vcc wave_shr:1 row_mask:0xf bank_mask:0xf
    s_mov_b64 exec, s[50:51]
    s_cbranch_scc0 L2_d24
    s_mov_b64 exec, s[82:83]
    s_nop 1
    v_mfma_f32_4x4x4_16b_bf16 v[88:91], v[12:13], v[84:85], 0
    s_nop 1
    v_mfma_f32_4x4x4_16b_bf16 v[88:91], v[10:11], v[86:87], v[88:91]
    s_nop 4
    v_cvt_pk_bf16_f32 v88, v88, v89
    v_cvt_pk_bf16_f32 v89, v90, v91
    ds_pk_add_bf16 v7, v88 offset:65408
    ds_pk_add_bf16 v7, v89 offset:65412
    s_mov_b64 exec, s[50:51]
    s_branch L2_d24
L2_xa25:
    s_cmp_eq_u32 s101, 1
    s_cbranch_scc1 L2_xc25
    v_lshlrev_b32 v89, 0, v96
    v_add_u32 v90, 140, v97
    v_bitop3_b32 v90, v89, v45, v90 bitop3:0x6a
    ds_write_b32 v98, v90 offset:28
    v_lshlrev_b32 v89, 4, v96
    v_add_u32 v90, 120, v97
    v_bitop3_b32 v90, v89, v45, v90 bitop3:0x6a
    ds_write_b32 v98, v90 offset:24
    v_lshlrev_b32 v89, 8, v96
    v_add_u32 v90, 100, v97
    v_bitop3_b32 v90, v89, v45, v90 bitop3:0x6a
    ds_write_b32 v98, v90 offset:20
L2_xc25:
    v_lshlrev_b32 v89, 12, v96
    v_add_u32 v90, 80, v97
    v_bitop3_b32 v90, v89, v45, v90 bitop3:0x6a
    ds_write_b32 v98, v90 offset:16
    s_branch L2_xb25
L2_xe25:
    v_cmp_lt_u32 vcc, 32, v99
    v_cmp_lt_u32 s[58:59], 31, v88
    v_lshrrev_b32 v89, 16, v96
    v_add_u32 v97, 80, v97
    s_or_b64 vcc, vcc, s[58:59]
    s_cbranch_scc1 L2_xs25
    v_lshlrev_b32 v89, v1, v89
    v_and_b32 v89, v45, v89
    v_cmp_ne_u32 vcc, 0, v89
    v_xor_b32 v90, v97, v89
    s_add_u32 s3, s37, s38
    v_mbcnt_lo_u32_b32 v98, vcc_lo, 0
    v_mbcnt_hi_u32_b32 v98, vcc_hi, v98
    s_bcnt1_i32_b64 s41, vcc
    v_lshl_add_u32 v98, v98, 2, s3
    s_lshl2_add_u32 s37, s41, s37
    s_mov_b64 exec, vcc
    ds_write_b32 v98, v90
    s_mov_b64 exec, -1
    s_branch L2_xr25
L2_xs25:
    s_waitcnt lgkmcnt(0)
    s_mov_b32 s37, 0x10000
    s_branch L2_xw25
L2_c26:
    s_lshl_b64 s[52:53], s[82:83], 1
    s_andn2_b64 s[52:53], s[52:53], s[80:81]
    s_andn2_b64 s[52:53], s[52:53], s[54:55]
    s_or_b64 s[80:81], s[80:81], s[52:53]
    s_not_b64 vcc, s[52:53]
    s_mov_b64 exec, -1
    v_cndmask_b32_dpp v84, v84, v84, vcc wave_shr:1 row_mask:0xf bank_mask:0xf
    v_cndmask_b32_dpp v85, v85, v85, vcc wave_shr:1 row_mask:0xf bank_mask:0xf
    s_lshr_b64 s[52:53], s[52:53], 1
    v_cndmask_b32_dpp v86, v86, v86, vcc wave_shr:1 row_mask:0xf bank_mask:0xf
    v_cndmask_b32_dpp v87, v87, v87, vcc wave_shr:1 row_mask:0xf bank_mask:0xf
    s_andn2_b64 s[82:83], s[82:83], s[52:53]
    v_cndmask_b32_dpp v7, v7, v7, vcc wave_shr:1 row_mask:0xf bank_mask:0xf
    s_mov_b64 exec, s[54:55]
    s_cbranch_scc0 L2_d26
    s_mov_b64 exec, s[82:83]
    s_nop 1
    v_mfma_f32_4x4x4_16b_bf16 v[88:91], v[12:13], v[84:85], 0
    s_nop 1
    v_mfma_f32_4x4x4_16b_bf16 v[88:91], v[10:11], v[86:87], v[88:91]
    s_nop 4
    v_cvt_pk_bf16_f32 v88, v88, v89
    v_cvt_pk_bf16_f32 v89, v90, v91
    ds_pk_add_bf16 v7, v88 offset:65408
    ds_pk_add_bf16 v7, v89 offset:65412
    s_mov_b64 exec, s[54:55]
    s_branch L2_d26
L2_c27:
    s_lshl_b64 s[52:53], s[82:83], 1
    s_andn2_b64 s[52:53], s[52:53], s[80:81]
    s_andn2_b64 s[52:53], s[52:53], s[50:51]
    s_or_b64 s[80:81], s[80:81], s[52:53]
    s_not_b64 vcc, s[52:53]
    s_mov_b64 exec, -1
    v_cndmask_b32_dpp v84, v84, v84, vcc wave_shr:1 row_mask:0xf bank_mask:0xf
    v_cndmask_b32_dpp v85, v85, v85, vcc wave_shr:1 row_mask:0xf bank_mask:0xf
    s_lshr_b64 s[52:53], s[52:53], 1
    v_cndmask_b32_dpp v86, v86, v86, vcc wave_shr:1 row_mask:0xf bank_mask:0xf
    v_cndmask_b32_dpp v87, v87, v87, vcc wave_shr:1 row_mask:0xf bank_mask:0xf
    s_andn2_b64 s[82:83], s[82:83], s[52:53]
    v_cndmask_b32_dpp v7, v7, v7, vcc wave_shr:1 row_mask:0xf bank_mask:0xf
    s_mov_b64 exec, s[50:51]
    s_cbranch_scc0 L2_d27
    s_mov_b64 exec, s[82:83]
    s_nop 1
    v_mfma_f32_4x4x4_16b_bf16 v[88:91], v[12:13], v[84:85], 0
    s_nop 1
    v_mfma_f32_4x4x4_16b_bf16 v[88:91], v[10:11], v[86:87], v[88:91]
    s_nop 4
    v_cvt_pk_bf16_f32 v88, v88, v89
    v_cvt_pk_bf16_f32 v89, v90, v91
    ds_pk_add_bf16 v7, v88 offset:65408
    ds_pk_add_bf16 v7, v89 offset:65412
    s_mov_b64 exec, s[50:51]
    s_branch L2_d27
L2_xf25:
    s_cmp_gt_u32 s37, 1024
    s_cbranch_scc1 L2_xt25
    s_cmp_lt_u32 s37, 768
    s_cbranch_scc1 L2_xl25
    ds_read_b32 v20, v44 offset:896
    s_add_u32 s3, s42, 2
    s_bitset1_b32 s43, s3
    s_branch L2_xg25
L2_xl25:
    s_waitcnt lgkmcnt(0)
    v_mov_b32 v19, -1
    s_cmp_ge_u32 s37, 512
    s_cbranch_scc1 L2_xg25
    v_mov_b32 v39, -1
    s_cmp_ge_u32 s37, 256
    s_cbranch_scc1 L2_xg25
    v_mov_b32 v33, -1
    s_branch L2_xg25
L2_xt25:
    s_waitcnt lgkmcnt(0)
    v_mov_b32 v27, -1
    v_mov_b32 v33, -1
    v_mov_b32 v39, -1
    v_mov_b32 v19, -1
    s_add_u32 s3, s42, 2
    s_bitset1_b32 s36, s3
    s_branch L2_xg25
L2_oa28:
    v_and_b32 v47, 0x0fffffff, v21
    buffer_load_dword v114, v47, s[8:11], 0 offen offset:16
    s_mov_b64 exec, s[6:7]
    v_add_u32 v47, 8, v47
    v_lshrrev_b32 v21, 2, v21
    s_mov_b64 exec, -1
    buffer_load_dwordx2 v[112:113], v47, s[8:11], 0 offen
    s_branch L2_ob28
L2_c29:
    s_lshl_b64 s[52:53], s[82:83], 1
    s_andn2_b64 s[52:53], s[52:53], s[80:81]
    s_andn2_b64 s[52:53], s[52:53], s[54:55]
    s_or_b64 s[80:81], s[80:81], s[52:53]
    s_not_b64 vcc, s[52:53]
    s_mov_b64 exec, -1
    v_cndmask_b32_dpp v84, v84, v84, vcc wave_shr:1 row_mask:0xf bank_mask:0xf
    v_cndmask_b32_dpp v85, v85, v85, vcc wave_shr:1 row_mask:0xf bank_mask:0xf
    s_lshr_b64 s[52:53], s[52:53], 1
    v_cndmask_b32_dpp v86, v86, v86, vcc wave_shr:1 row_mask:0xf bank_mask:0xf
    v_cndmask_b32_dpp v87, v87, v87, vcc wave_shr:1 row_mask:0xf bank_mask:0xf
    s_andn2_b64 s[82:83], s[82:83], s[52:53]
    v_cndmask_b32_dpp v7, v7, v7, vcc wave_shr:1 row_mask:0xf bank_mask:0xf
    s_mov_b64 exec, s[54:55]
    s_cbranch_scc0 L2_d29
    s_mov_b64 exec, s[82:83]
    s_nop 1
    v_mfma_f32_4x4x4_16b_bf16 v[88:91], v[12:13], v[84:85], 0
    s_nop 1
    v_mfma_f32_4x4x4_16b_bf16 v[88:91], v[10:11], v[86:87], v[88:91]
    s_nop 4
    v_cvt_pk_bf16_f32 v88, v88, v89
    v_cvt_pk_bf16_f32 v89, v90, v91
    ds_pk_add_bf16 v7, v88 offset:65408
    ds_pk_add_bf16 v7, v89 offset:65412
    s_mov_b64 exec, s[54:55]
    s_branch L2_d29
L2_c30:
    s_lshl_b64 s[52:53], s[82:83], 1
    s_andn2_b64 s[52:53], s[52:53], s[80:81]
    s_andn2_b64 s[52:53], s[52:53], s[50:51]
    s_or_b64 s[80:81], s[80:81], s[52:53]
    s_not_b64 vcc, s[52:53]
    s_mov_b64 exec, -1
    v_cndmask_b32_dpp v84, v84, v84, vcc wave_shr:1 row_mask:0xf bank_mask:0xf
    v_cndmask_b32_dpp v85, v85, v85, vcc wave_shr:1 row_mask:0xf bank_mask:0xf
    s_lshr_b64 s[52:53], s[52:53], 1
    v_cndmask_b32_dpp v86, v86, v86, vcc wave_shr:1 row_mask:0xf bank_mask:0xf
    v_cndmask_b32_dpp v87, v87, v87, vcc wave_shr:1 row_mask:0xf bank_mask:0xf
    s_andn2_b64 s[82:83], s[82:83], s[52:53]
    v_cndmask_b32_dpp v7, v7, v7, vcc wave_shr:1 row_mask:0xf bank_mask:0xf
    s_mov_b64 exec, s[50:51]
    s_cbranch_scc0 L2_d30
    s_mov_b64 exec, s[82:83]
    s_nop 1
    v_mfma_f32_4x4x4_16b_bf16 v[88:91], v[12:13], v[84:85], 0
    s_nop 1
    v_mfma_f32_4x4x4_16b_bf16 v[88:91], v[10:11], v[86:87], v[88:91]
    s_nop 4
    v_cvt_pk_bf16_f32 v88, v88, v89
    v_cvt_pk_bf16_f32 v89, v90, v91
    ds_pk_add_bf16 v7, v88 offset:65408
    ds_pk_add_bf16 v7, v89 offset:65412
    s_mov_b64 exec, s[50:51]
    s_branch L2_d30
L2_c31:
    s_lshl_b64 s[52:53], s[82:83], 1
    s_andn2_b64 s[52:53], s[52:53], s[80:81]
    s_andn2_b64 s[52:53], s[52:53], s[54:55]
    s_or_b64 s[80:81], s[80:81], s[52:53]
    s_not_b64 vcc, s[52:53]
    s_mov_b64 exec, -1
    v_cndmask_b32_dpp v84, v84, v84, vcc wave_shr:1 row_mask:0xf bank_mask:0xf
    v_cndmask_b32_dpp v85, v85, v85, vcc wave_shr:1 row_mask:0xf bank_mask:0xf
    s_lshr_b64 s[52:53], s[52:53], 1
    v_cndmask_b32_dpp v86, v86, v86, vcc wave_shr:1 row_mask:0xf bank_mask:0xf
    v_cndmask_b32_dpp v87, v87, v87, vcc wave_shr:1 row_mask:0xf bank_mask:0xf
    s_andn2_b64 s[82:83], s[82:83], s[52:53]
    v_cndmask_b32_dpp v7, v7, v7, vcc wave_shr:1 row_mask:0xf bank_mask:0xf
    s_mov_b64 exec, s[54:55]
    s_cbranch_scc0 L2_d31
    s_mov_b64 exec, s[82:83]
    s_nop 1
    v_mfma_f32_4x4x4_16b_bf16 v[88:91], v[12:13], v[84:85], 0
    s_nop 1
    v_mfma_f32_4x4x4_16b_bf16 v[88:91], v[10:11], v[86:87], v[88:91]
    s_nop 4
    v_cvt_pk_bf16_f32 v88, v88, v89
    v_cvt_pk_bf16_f32 v89, v90, v91
    ds_pk_add_bf16 v7, v88 offset:65408
    ds_pk_add_bf16 v7, v89 offset:65412
    s_mov_b64 exec, s[54:55]
    s_branch L2_d31
L2_c32:
    s_lshl_b64 s[52:53], s[82:83], 1
    s_andn2_b64 s[52:53], s[52:53], s[80:81]
    s_andn2_b64 s[52:53], s[52:53], s[50:51]
    s_or_b64 s[80:81], s[80:81], s[52:53]
    s_not_b64 vcc, s[52:53]
    s_mov_b64 exec, -1
    v_cndmask_b32_dpp v84, v84, v84, vcc wave_shr:1 row_mask:0xf bank_mask:0xf
    v_cndmask_b32_dpp v85, v85, v85, vcc wave_shr:1 row_mask:0xf bank_mask:0xf
    s_lshr_b64 s[52:53], s[52:53], 1
    v_cndmask_b32_dpp v86, v86, v86, vcc wave_shr:1 row_mask:0xf bank_mask:0xf
    v_cndmask_b32_dpp v87, v87, v87, vcc wave_shr:1 row_mask:0xf bank_mask:0xf
    s_andn2_b64 s[82:83], s[82:83], s[52:53]
    v_cndmask_b32_dpp v7, v7, v7, vcc wave_shr:1 row_mask:0xf bank_mask:0xf
    s_mov_b64 exec, s[50:51]
    s_cbranch_scc0 L2_d32
    s_mov_b64 exec, s[82:83]
    s_nop 1
    v_mfma_f32_4x4x4_16b_bf16 v[88:91], v[12:13], v[84:85], 0
    s_nop 1
    v_mfma_f32_4x4x4_16b_bf16 v[88:91], v[10:11], v[86:87], v[88:91]
    s_nop 4
    v_cvt_pk_bf16_f32 v88, v88, v89
    v_cvt_pk_bf16_f32 v89, v90, v91
    ds_pk_add_bf16 v7, v88 offset:65408
    ds_pk_add_bf16 v7, v89 offset:65412
    s_mov_b64 exec, s[50:51]
    s_branch L2_d32
L2_c33:
    s_lshl_b64 s[52:53], s[82:83], 1
    s_andn2_b64 s[52:53], s[52:53], s[80:81]
    s_andn2_b64 s[52:53], s[52:53], s[54:55]
    s_or_b64 s[80:81], s[80:81], s[52:53]
    s_not_b64 vcc, s[52:53]
    s_mov_b64 exec, -1
    v_cndmask_b32_dpp v84, v84, v84, vcc wave_shr:1 row_mask:0xf bank_mask:0xf
    v_cndmask_b32_dpp v85, v85, v85, vcc wave_shr:1 row_mask:0xf bank_mask:0xf
    s_lshr_b64 s[52:53], s[52:53], 1
    v_cndmask_b32_dpp v86, v86, v86, vcc wave_shr:1 row_mask:0xf bank_mask:0xf
    v_cndmask_b32_dpp v87, v87, v87, vcc wave_shr:1 row_mask:0xf bank_mask:0xf
    s_andn2_b64 s[82:83], s[82:83], s[52:53]
    v_cndmask_b32_dpp v7, v7, v7, vcc wave_shr:1 row_mask:0xf bank_mask:0xf
    s_mov_b64 exec, s[54:55]
    s_cbranch_scc0 L2_d33
    s_mov_b64 exec, s[82:83]
    s_nop 1
    v_mfma_f32_4x4x4_16b_bf16 v[88:91], v[12:13], v[84:85], 0
    s_nop 1
    v_mfma_f32_4x4x4_16b_bf16 v[88:91], v[10:11], v[86:87], v[88:91]
    s_nop 4
    v_cvt_pk_bf16_f32 v88, v88, v89
    v_cvt_pk_bf16_f32 v89, v90, v91
    ds_pk_add_bf16 v7, v88 offset:65408
    ds_pk_add_bf16 v7, v89 offset:65412
    s_mov_b64 exec, s[54:55]
    s_branch L2_d33
L2_c34:
    s_lshl_b64 s[52:53], s[82:83], 1
    s_andn2_b64 s[52:53], s[52:53], s[80:81]
    s_andn2_b64 s[52:53], s[52:53], s[50:51]
    s_or_b64 s[80:81], s[80:81], s[52:53]
    s_not_b64 vcc, s[52:53]
    s_mov_b64 exec, -1
    v_cndmask_b32_dpp v84, v84, v84, vcc wave_shr:1 row_mask:0xf bank_mask:0xf
    v_cndmask_b32_dpp v85, v85, v85, vcc wave_shr:1 row_mask:0xf bank_mask:0xf
    s_lshr_b64 s[52:53], s[52:53], 1
    v_cndmask_b32_dpp v86, v86, v86, vcc wave_shr:1 row_mask:0xf bank_mask:0xf
    v_cndmask_b32_dpp v87, v87, v87, vcc wave_shr:1 row_mask:0xf bank_mask:0xf
    s_andn2_b64 s[82:83], s[82:83], s[52:53]
    v_cndmask_b32_dpp v7, v7, v7, vcc wave_shr:1 row_mask:0xf bank_mask:0xf
    s_mov_b64 exec, s[50:51]
    s_cbranch_scc0 L2_d34
    s_mov_b64 exec, s[82:83]
    s_nop 1
    v_mfma_f32_4x4x4_16b_bf16 v[88:91], v[12:13], v[84:85], 0
    s_nop 1
    v_mfma_f32_4x4x4_16b_bf16 v[88:91], v[10:11], v[86:87], v[88:91]
    s_nop 4
    v_cvt_pk_bf16_f32 v88, v88, v89
    v_cvt_pk_bf16_f32 v89, v90, v91
    ds_pk_add_bf16 v7, v88 offset:65408
    ds_pk_add_bf16 v7, v89 offset:65412
    s_mov_b64 exec, s[50:51]
    s_branch L2_d34
L2_c35:
    s_lshl_b64 s[52:53], s[82:83], 1
    s_andn2_b64 s[52:53], s[52:53], s[80:81]
    s_andn2_b64 s[52:53], s[52:53], s[54:55]
    s_or_b64 s[80:81], s[80:81], s[52:53]
    s_not_b64 vcc, s[52:53]
    s_mov_b64 exec, -1
    v_cndmask_b32_dpp v84, v84, v84, vcc wave_shr:1 row_mask:0xf bank_mask:0xf
    v_cndmask_b32_dpp v85, v85, v85, vcc wave_shr:1 row_mask:0xf bank_mask:0xf
    s_lshr_b64 s[52:53], s[52:53], 1
    v_cndmask_b32_dpp v86, v86, v86, vcc wave_shr:1 row_mask:0xf bank_mask:0xf
    v_cndmask_b32_dpp v87, v87, v87, vcc wave_shr:1 row_mask:0xf bank_mask:0xf
    s_andn2_b64 s[82:83], s[82:83], s[52:53]
    v_cndmask_b32_dpp v7, v7, v7, vcc wave_shr:1 row_mask:0xf bank_mask:0xf
    s_mov_b64 exec, s[54:55]
    s_cbranch_scc0 L2_d35
    s_mov_b64 exec, s[82:83]
    s_nop 1
    v_mfma_f32_4x4x4_16b_bf16 v[88:91], v[12:13], v[84:85], 0
    s_nop 1
    v_mfma_f32_4x4x4_16b_bf16 v[88:91], v[10:11], v[86:87], v[88:91]
    s_nop 4
    v_cvt_pk_bf16_f32 v88, v88, v89
    v_cvt_pk_bf16_f32 v89, v90, v91
    ds_pk_add_bf16 v7, v88 offset:65408
    ds_pk_add_bf16 v7, v89 offset:65412
    s_mov_b64 exec, s[54:55]
    s_branch L2_d35
L2_c36:
    s_lshl_b64 s[52:53], s[82:83], 1
    s_andn2_b64 s[52:53], s[52:53], s[80:81]
    s_andn2_b64 s[52:53], s[52:53], s[50:51]
    s_or_b64 s[80:81], s[80:81], s[52:53]
    s_not_b64 vcc, s[52:53]
    s_mov_b64 exec, -1
    v_cndmask_b32_dpp v84, v84, v84, vcc wave_shr:1 row_mask:0xf bank_mask:0xf
    v_cndmask_b32_dpp v85, v85, v85, vcc wave_shr:1 row_mask:0xf bank_mask:0xf
    s_lshr_b64 s[52:53], s[52:53], 1
    v_cndmask_b32_dpp v86, v86, v86, vcc wave_shr:1 row_mask:0xf bank_mask:0xf
    v_cndmask_b32_dpp v87, v87, v87, vcc wave_shr:1 row_mask:0xf bank_mask:0xf
    s_andn2_b64 s[82:83], s[82:83], s[52:53]
    v_cndmask_b32_dpp v7, v7, v7, vcc wave_shr:1 row_mask:0xf bank_mask:0xf
    s_mov_b64 exec, s[50:51]
    s_cbranch_scc0 L2_d36
    s_mov_b64 exec, s[82:83]
    s_nop 1
    v_mfma_f32_4x4x4_16b_bf16 v[88:91], v[12:13], v[84:85], 0
    s_nop 1
    v_mfma_f32_4x4x4_16b_bf16 v[88:91], v[10:11], v[86:87], v[88:91]
    s_nop 4
    v_cvt_pk_bf16_f32 v88, v88, v89
    v_cvt_pk_bf16_f32 v89, v90, v91
    ds_pk_add_bf16 v7, v88 offset:65408
    ds_pk_add_bf16 v7, v89 offset:65412
    s_mov_b64 exec, s[50:51]
    s_branch L2_d36
L2_oa37:
    s_waitcnt vmcnt(5)
    s_mov_b64 exec, s[6:7]
    v_lshrrev_b32 v114, 16, v114
    s_mov_b64 exec, -1
    v_and_b32 v46, 0x10000000, v21
    v_cmpx_eq_u32 vcc, 0, v46
    v_lshrrev_b32 v47, 14, v112
    v_and_b32 v47, v5, v47
    ds_read_b64 v[96:97], v47
    v_perm_b32 v98, v112, v114, s44
    v_bitop3_b32 v99, v112, 0.5, -0.5 bitop3:0xa8
    v_bitop3_b32 v98, v6, v98, v99 bitop3:0xca
    v_and_b32 v47, v5, v112
    s_waitcnt lgkmcnt(0)
    v_mfma_f32_4x4x4_16b_bf16 v[88:91], v[8:9], v[96:97], 0
    s_nop 4
    v_mul_f32 v88, v98, v88
    v_mul_f32 v89, v98, v89
    v_mul_f32 v90, v98, v90
    v_mul_f32 v91, v98, v91
    v_cvt_pk_bf16_f32 v88, v88, v89
    v_cvt_pk_bf16_f32 v89, v90, v91
    ds_pk_add_bf16 v47, v88 offset:65408
    ds_pk_add_bf16 v47, v89 offset:65412
    s_mov_b64 exec, -1
    v_and_b32 v46, 0x20000000, v21
    v_cmpx_eq_u32 vcc, 0, v46
    v_lshrrev_b32 v47, 14, v113
    v_and_b32 v47, v5, v47
    ds_read_b64 v[96:97], v47
    v_perm_b32 v98, v113, v114, s45
    v_bitop3_b32 v99, v113, 0.5, -0.5 bitop3:0xa8
    v_bitop3_b32 v98, v6, v98, v99 bitop3:0xca
    v_and_b32 v47, v5, v113
    s_waitcnt lgkmcnt(0)
    v_mfma_f32_4x4x4_16b_bf16 v[88:91], v[8:9], v[96:97], 0
    s_nop 4
    v_mul_f32 v88, v98, v88
    v_mul_f32 v89, v98, v89
    v_mul_f32 v90, v98, v90
    v_mul_f32 v91, v98, v91
    v_cvt_pk_bf16_f32 v88, v88, v89
    v_cvt_pk_bf16_f32 v89, v90, v91
    ds_pk_add_bf16 v47, v88 offset:65408
    ds_pk_add_bf16 v47, v89 offset:65412
    s_mov_b64 exec, -1
    s_branch L2_ob37
L2_xo38:
    v_cmp_lt_u32 vcc, 20, v99
    s_mov_b32 s101, 1
    s_cbranch_vccz L2_xp38
    v_cmp_lt_u32 vcc, 32, v99
    v_cmp_lt_u32 s[58:59], 31, v88
    s_mov_b32 s101, 2
    s_or_b64 vcc, vcc, s[58:59]
    s_cbranch_scc0 L2_xp38
    s_mov_b32 s37, 0x10000
    s_branch L2_xp38
L2_c39:
    s_lshl_b64 s[52:53], s[82:83], 1
    s_andn2_b64 s[52:53], s[52:53], s[80:81]
    s_andn2_b64 s[52:53], s[52:53], s[54:55]
    s_or_b64 s[80:81], s[80:81], s[52:53]
    s_not_b64 vcc, s[52:53]
    s_mov_b64 exec, -1
    v_cndmask_b32_dpp v84, v84, v84, vcc wave_shr:1 row_mask:0xf bank_mask:0xf
    v_cndmask_b32_dpp v85, v85, v85, vcc wave_shr:1 row_mask:0xf bank_mask:0xf
    s_lshr_b64 s[52:53], s[52:53], 1
    v_cndmask_b32_dpp v86, v86, v86, vcc wave_shr:1 row_mask:0xf bank_mask:0xf
    v_cndmask_b32_dpp v87, v87, v87, vcc wave_shr:1 row_mask:0xf bank_mask:0xf
    s_andn2_b64 s[82:83], s[82:83], s[52:53]
    v_cndmask_b32_dpp v7, v7, v7, vcc wave_shr:1 row_mask:0xf bank_mask:0xf
    s_mov_b64 exec, s[54:55]
    s_cbranch_scc0 L2_d39
    s_mov_b64 exec, s[82:83]
    s_nop 1
    v_mfma_f32_4x4x4_16b_bf16 v[88:91], v[12:13], v[84:85], 0
    s_nop 1
    v_mfma_f32_4x4x4_16b_bf16 v[88:91], v[10:11], v[86:87], v[88:91]
    s_nop 4
    v_cvt_pk_bf16_f32 v88, v88, v89
    v_cvt_pk_bf16_f32 v89, v90, v91
    ds_pk_add_bf16 v7, v88 offset:65408
    ds_pk_add_bf16 v7, v89 offset:65412
    s_mov_b64 exec, s[54:55]
    s_branch L2_d39
L2_c40:
    s_lshl_b64 s[52:53], s[82:83], 1
    s_andn2_b64 s[52:53], s[52:53], s[80:81]
    s_andn2_b64 s[52:53], s[52:53], s[50:51]
    s_or_b64 s[80:81], s[80:81], s[52:53]
    s_not_b64 vcc, s[52:53]
    s_mov_b64 exec, -1
    v_cndmask_b32_dpp v84, v84, v84, vcc wave_shr:1 row_mask:0xf bank_mask:0xf
    v_cndmask_b32_dpp v85, v85, v85, vcc wave_shr:1 row_mask:0xf bank_mask:0xf
    s_lshr_b64 s[52:53], s[52:53], 1
    v_cndmask_b32_dpp v86, v86, v86, vcc wave_shr:1 row_mask:0xf bank_mask:0xf
    v_cndmask_b32_dpp v87, v87, v87, vcc wave_shr:1 row_mask:0xf bank_mask:0xf
    s_andn2_b64 s[82:83], s[82:83], s[52:53]
    v_cndmask_b32_dpp v7, v7, v7, vcc wave_shr:1 row_mask:0xf bank_mask:0xf
    s_mov_b64 exec, s[50:51]
    s_cbranch_scc0 L2_d40
    s_mov_b64 exec, s[82:83]
    s_nop 1
    v_mfma_f32_4x4x4_16b_bf16 v[88:91], v[12:13], v[84:85], 0
    s_nop 1
    v_mfma_f32_4x4x4_16b_bf16 v[88:91], v[10:11], v[86:87], v[88:91]
    s_nop 4
    v_cvt_pk_bf16_f32 v88, v88, v89
    v_cvt_pk_bf16_f32 v89, v90, v91
    ds_pk_add_bf16 v7, v88 offset:65408
    ds_pk_add_bf16 v7, v89 offset:65412
    s_mov_b64 exec, s[50:51]
    s_branch L2_d40
L2_c41:
    s_lshl_b64 s[52:53], s[82:83], 1
    s_andn2_b64 s[52:53], s[52:53], s[80:81]
    s_andn2_b64 s[52:53], s[52:53], s[54:55]
    s_or_b64 s[80:81], s[80:81], s[52:53]
    s_not_b64 vcc, s[52:53]
    s_mov_b64 exec, -1
    v_cndmask_b32_dpp v84, v84, v84, vcc wave_shr:1 row_mask:0xf bank_mask:0xf
    v_cndmask_b32_dpp v85, v85, v85, vcc wave_shr:1 row_mask:0xf bank_mask:0xf
    s_lshr_b64 s[52:53], s[52:53], 1
    v_cndmask_b32_dpp v86, v86, v86, vcc wave_shr:1 row_mask:0xf bank_mask:0xf
    v_cndmask_b32_dpp v87, v87, v87, vcc wave_shr:1 row_mask:0xf bank_mask:0xf
    s_andn2_b64 s[82:83], s[82:83], s[52:53]
    v_cndmask_b32_dpp v7, v7, v7, vcc wave_shr:1 row_mask:0xf bank_mask:0xf
    s_mov_b64 exec, s[54:55]
    s_cbranch_scc0 L2_d41
    s_mov_b64 exec, s[82:83]
    s_nop 1
    v_mfma_f32_4x4x4_16b_bf16 v[88:91], v[12:13], v[84:85], 0
    s_nop 1
    v_mfma_f32_4x4x4_16b_bf16 v[88:91], v[10:11], v[86:87], v[88:91]
    s_nop 4
    v_cvt_pk_bf16_f32 v88, v88, v89
    v_cvt_pk_bf16_f32 v89, v90, v91
    ds_pk_add_bf16 v7, v88 offset:65408
    ds_pk_add_bf16 v7, v89 offset:65412
    s_mov_b64 exec, s[54:55]
    s_branch L2_d41
L2_c42:
    s_lshl_b64 s[52:53], s[82:83], 1
    s_andn2_b64 s[52:53], s[52:53], s[80:81]
    s_andn2_b64 s[52:53], s[52:53], s[50:51]
    s_or_b64 s[80:81], s[80:81], s[52:53]
    s_not_b64 vcc, s[52:53]
    s_mov_b64 exec, -1
    v_cndmask_b32_dpp v84, v84, v84, vcc wave_shr:1 row_mask:0xf bank_mask:0xf
    v_cndmask_b32_dpp v85, v85, v85, vcc wave_shr:1 row_mask:0xf bank_mask:0xf
    s_lshr_b64 s[52:53], s[52:53], 1
    v_cndmask_b32_dpp v86, v86, v86, vcc wave_shr:1 row_mask:0xf bank_mask:0xf
    v_cndmask_b32_dpp v87, v87, v87, vcc wave_shr:1 row_mask:0xf bank_mask:0xf
    s_andn2_b64 s[82:83], s[82:83], s[52:53]
    v_cndmask_b32_dpp v7, v7, v7, vcc wave_shr:1 row_mask:0xf bank_mask:0xf
    s_mov_b64 exec, s[50:51]
    s_cbranch_scc0 L2_d42
    s_mov_b64 exec, s[82:83]
    s_nop 1
    v_mfma_f32_4x4x4_16b_bf16 v[88:91], v[12:13], v[84:85], 0
    s_nop 1
    v_mfma_f32_4x4x4_16b_bf16 v[88:91], v[10:11], v[86:87], v[88:91]
    s_nop 4
    v_cvt_pk_bf16_f32 v88, v88, v89
    v_cvt_pk_bf16_f32 v89, v90, v91
    ds_pk_add_bf16 v7, v88 offset:65408
    ds_pk_add_bf16 v7, v89 offset:65412
    s_mov_b64 exec, s[50:51]
    s_branch L2_d42
L2_xa43:
    s_cmp_eq_u32 s101, 1
    s_cbranch_scc1 L2_xc43
    v_lshlrev_b32 v89, 0, v96
    v_add_u32 v90, 140, v97
    v_bitop3_b32 v90, v89, v45, v90 bitop3:0x6a
    ds_write_b32 v98, v90 offset:28
    v_lshlrev_b32 v89, 4, v96
    v_add_u32 v90, 120, v97
    v_bitop3_b32 v90, v89, v45, v90 bitop3:0x6a
    ds_write_b32 v98, v90 offset:24
    v_lshlrev_b32 v89, 8, v96
    v_add_u32 v90, 100, v97
    v_bitop3_b32 v90, v89, v45, v90 bitop3:0x6a
    ds_write_b32 v98, v90 offset:20
L2_xc43:
    v_lshlrev_b32 v89, 12, v96
    v_add_u32 v90, 80, v97
    v_bitop3_b32 v90, v89, v45, v90 bitop3:0x6a
    ds_write_b32 v98, v90 offset:16
    s_branch L2_xb43
L2_xe43:
    v_cmp_lt_u32 vcc, 32, v99
    v_cmp_lt_u32 s[58:59], 31, v88
    v_lshrrev_b32 v89, 16, v96
    v_add_u32 v97, 80, v97
    s_or_b64 vcc, vcc, s[58:59]
    s_cbranch_scc1 L2_xs43
    v_lshlrev_b32 v89, v1, v89
    v_and_b32 v89, v45, v89
    v_cmp_ne_u32 vcc, 0, v89
    v_xor_b32 v90, v97, v89
    s_add_u32 s3, s37, s38
    v_mbcnt_lo_u32_b32 v98, vcc_lo, 0
    v_mbcnt_hi_u32_b32 v98, vcc_hi, v98
    s_bcnt1_i32_b64 s41, vcc
    v_lshl_add_u32 v98, v98, 2, s3
    s_lshl2_add_u32 s37, s41, s37
    s_mov_b64 exec, vcc
    ds_write_b32 v98, v90
    s_mov_b64 exec, -1
    s_branch L2_xr43
L2_xs43:
    s_waitcnt lgkmcnt(0)
    s_mov_b32 s37, 0x10000
    s_branch L2_xw43
L2_c44:
    s_lshl_b64 s[52:53], s[82:83], 1
    s_andn2_b64 s[52:53], s[52:53], s[80:81]
    s_andn2_b64 s[52:53], s[52:53], s[54:55]
    s_or_b64 s[80:81], s[80:81], s[52:53]
    s_not_b64 vcc, s[52:53]
    s_mov_b64 exec, -1
    v_cndmask_b32_dpp v84, v84, v84, vcc wave_shr:1 row_mask:0xf bank_mask:0xf
    v_cndmask_b32_dpp v85, v85, v85, vcc wave_shr:1 row_mask:0xf bank_mask:0xf
    s_lshr_b64 s[52:53], s[52:53], 1
    v_cndmask_b32_dpp v86, v86, v86, vcc wave_shr:1 row_mask:0xf bank_mask:0xf
    v_cndmask_b32_dpp v87, v87, v87, vcc wave_shr:1 row_mask:0xf bank_mask:0xf
    s_andn2_b64 s[82:83], s[82:83], s[52:53]
    v_cndmask_b32_dpp v7, v7, v7, vcc wave_shr:1 row_mask:0xf bank_mask:0xf
    s_mov_b64 exec, s[54:55]
    s_cbranch_scc0 L2_d44
    s_mov_b64 exec, s[82:83]
    s_nop 1
    v_mfma_f32_4x4x4_16b_bf16 v[88:91], v[12:13], v[84:85], 0
    s_nop 1
    v_mfma_f32_4x4x4_16b_bf16 v[88:91], v[10:11], v[86:87], v[88:91]
    s_nop 4
    v_cvt_pk_bf16_f32 v88, v88, v89
    v_cvt_pk_bf16_f32 v89, v90, v91
    ds_pk_add_bf16 v7, v88 offset:65408
    ds_pk_add_bf16 v7, v89 offset:65412
    s_mov_b64 exec, s[54:55]
    s_branch L2_d44
L2_c45:
    s_lshl_b64 s[52:53], s[82:83], 1
    s_andn2_b64 s[52:53], s[52:53], s[80:81]
    s_andn2_b64 s[52:53], s[52:53], s[50:51]
    s_or_b64 s[80:81], s[80:81], s[52:53]
    s_not_b64 vcc, s[52:53]
    s_mov_b64 exec, -1
    v_cndmask_b32_dpp v84, v84, v84, vcc wave_shr:1 row_mask:0xf bank_mask:0xf
    v_cndmask_b32_dpp v85, v85, v85, vcc wave_shr:1 row_mask:0xf bank_mask:0xf
    s_lshr_b64 s[52:53], s[52:53], 1
    v_cndmask_b32_dpp v86, v86, v86, vcc wave_shr:1 row_mask:0xf bank_mask:0xf
    v_cndmask_b32_dpp v87, v87, v87, vcc wave_shr:1 row_mask:0xf bank_mask:0xf
    s_andn2_b64 s[82:83], s[82:83], s[52:53]
    v_cndmask_b32_dpp v7, v7, v7, vcc wave_shr:1 row_mask:0xf bank_mask:0xf
    s_mov_b64 exec, s[50:51]
    s_cbranch_scc0 L2_d45
    s_mov_b64 exec, s[82:83]
    s_nop 1
    v_mfma_f32_4x4x4_16b_bf16 v[88:91], v[12:13], v[84:85], 0
    s_nop 1
    v_mfma_f32_4x4x4_16b_bf16 v[88:91], v[10:11], v[86:87], v[88:91]
    s_nop 4
    v_cvt_pk_bf16_f32 v88, v88, v89
    v_cvt_pk_bf16_f32 v89, v90, v91
    ds_pk_add_bf16 v7, v88 offset:65408
    ds_pk_add_bf16 v7, v89 offset:65412
    s_mov_b64 exec, s[50:51]
    s_branch L2_d45
L2_xf43:
    s_cmp_gt_u32 s37, 1024
    s_cbranch_scc1 L2_xt43
    s_cmp_lt_u32 s37, 768
    s_cbranch_scc1 L2_xl43
    ds_read_b32 v21, v44 offset:896
    s_add_u32 s3, s42, 2
    s_bitset1_b32 s43, s3
    s_branch L2_xg43
L2_xl43:
    s_waitcnt lgkmcnt(0)
    v_mov_b32 v40, -1
    s_cmp_ge_u32 s37, 512
    s_cbranch_scc1 L2_xg43
    v_mov_b32 v43, -1
    s_cmp_ge_u32 s37, 256
    s_cbranch_scc1 L2_xg43
    v_mov_b32 v42, -1
    s_branch L2_xg43
L2_xt43:
    s_waitcnt lgkmcnt(0)
    v_mov_b32 v41, -1
    v_mov_b32 v42, -1
    v_mov_b32 v43, -1
    v_mov_b32 v40, -1
    s_add_u32 s3, s42, 2
    s_bitset1_b32 s36, s3
    s_branch L2_xg43
L2_oa46:
    v_and_b32 v47, 0x0fffffff, v20
    buffer_load_dword v114, v47, s[8:11], 0 offen offset:16
    s_mov_b64 exec, s[6:7]
    v_add_u32 v47, 8, v47
    v_lshrrev_b32 v20, 2, v20
    s_mov_b64 exec, -1
    buffer_load_dwordx2 v[112:113], v47, s[8:11], 0 offen
    s_branch L2_ob46
L2_c47:
    s_lshl_b64 s[52:53], s[82:83], 1
    s_andn2_b64 s[52:53], s[52:53], s[80:81]
    s_andn2_b64 s[52:53], s[52:53], s[54:55]
    s_or_b64 s[80:81], s[80:81], s[52:53]
    s_not_b64 vcc, s[52:53]
    s_mov_b64 exec, -1
    v_cndmask_b32_dpp v84, v84, v84, vcc wave_shr:1 row_mask:0xf bank_mask:0xf
    v_cndmask_b32_dpp v85, v85, v85, vcc wave_shr:1 row_mask:0xf bank_mask:0xf
    s_lshr_b64 s[52:53], s[52:53], 1
    v_cndmask_b32_dpp v86, v86, v86, vcc wave_shr:1 row_mask:0xf bank_mask:0xf
    v_cndmask_b32_dpp v87, v87, v87, vcc wave_shr:1 row_mask:0xf bank_mask:0xf
    s_andn2_b64 s[82:83], s[82:83], s[52:53]
    v_cndmask_b32_dpp v7, v7, v7, vcc wave_shr:1 row_mask:0xf bank_mask:0xf
    s_mov_b64 exec, s[54:55]
    s_cbranch_scc0 L2_d47
    s_mov_b64 exec, s[82:83]
    s_nop 1
    v_mfma_f32_4x4x4_16b_bf16 v[88:91], v[12:13], v[84:85], 0
    s_nop 1
    v_mfma_f32_4x4x4_16b_bf16 v[88:91], v[10:11], v[86:87], v[88:91]
    s_nop 4
    v_cvt_pk_bf16_f32 v88, v88, v89
    v_cvt_pk_bf16_f32 v89, v90, v91
    ds_pk_add_bf16 v7, v88 offset:65408
    ds_pk_add_bf16 v7, v89 offset:65412
    s_mov_b64 exec, s[54:55]
    s_branch L2_d47
L2_c48:
    s_lshl_b64 s[52:53], s[82:83], 1
    s_andn2_b64 s[52:53], s[52:53], s[80:81]
    s_andn2_b64 s[52:53], s[52:53], s[50:51]
    s_or_b64 s[80:81], s[80:81], s[52:53]
    s_not_b64 vcc, s[52:53]
    s_mov_b64 exec, -1
    v_cndmask_b32_dpp v84, v84, v84, vcc wave_shr:1 row_mask:0xf bank_mask:0xf
    v_cndmask_b32_dpp v85, v85, v85, vcc wave_shr:1 row_mask:0xf bank_mask:0xf
    s_lshr_b64 s[52:53], s[52:53], 1
    v_cndmask_b32_dpp v86, v86, v86, vcc wave_shr:1 row_mask:0xf bank_mask:0xf
    v_cndmask_b32_dpp v87, v87, v87, vcc wave_shr:1 row_mask:0xf bank_mask:0xf
    s_andn2_b64 s[82:83], s[82:83], s[52:53]
    v_cndmask_b32_dpp v7, v7, v7, vcc wave_shr:1 row_mask:0xf bank_mask:0xf
    s_mov_b64 exec, s[50:51]
    s_cbranch_scc0 L2_d48
    s_mov_b64 exec, s[82:83]
    s_nop 1
    v_mfma_f32_4x4x4_16b_bf16 v[88:91], v[12:13], v[84:85], 0
    s_nop 1
    v_mfma_f32_4x4x4_16b_bf16 v[88:91], v[10:11], v[86:87], v[88:91]
    s_nop 4
    v_cvt_pk_bf16_f32 v88, v88, v89
    v_cvt_pk_bf16_f32 v89, v90, v91
    ds_pk_add_bf16 v7, v88 offset:65408
    ds_pk_add_bf16 v7, v89 offset:65412
    s_mov_b64 exec, s[50:51]
    s_branch L2_d48
L2_c49:
    s_lshl_b64 s[52:53], s[82:83], 1
    s_andn2_b64 s[52:53], s[52:53], s[80:81]
    s_andn2_b64 s[52:53], s[52:53], s[54:55]
    s_or_b64 s[80:81], s[80:81], s[52:53]
    s_not_b64 vcc, s[52:53]
    s_mov_b64 exec, -1
    v_cndmask_b32_dpp v84, v84, v84, vcc wave_shr:1 row_mask:0xf bank_mask:0xf
    v_cndmask_b32_dpp v85, v85, v85, vcc wave_shr:1 row_mask:0xf bank_mask:0xf
    s_lshr_b64 s[52:53], s[52:53], 1
    v_cndmask_b32_dpp v86, v86, v86, vcc wave_shr:1 row_mask:0xf bank_mask:0xf
    v_cndmask_b32_dpp v87, v87, v87, vcc wave_shr:1 row_mask:0xf bank_mask:0xf
    s_andn2_b64 s[82:83], s[82:83], s[52:53]
    v_cndmask_b32_dpp v7, v7, v7, vcc wave_shr:1 row_mask:0xf bank_mask:0xf
    s_mov_b64 exec, s[54:55]
    s_cbranch_scc0 L2_d49
    s_mov_b64 exec, s[82:83]
    s_nop 1
    v_mfma_f32_4x4x4_16b_bf16 v[88:91], v[12:13], v[84:85], 0
    s_nop 1
    v_mfma_f32_4x4x4_16b_bf16 v[88:91], v[10:11], v[86:87], v[88:91]
    s_nop 4
    v_cvt_pk_bf16_f32 v88, v88, v89
    v_cvt_pk_bf16_f32 v89, v90, v91
    ds_pk_add_bf16 v7, v88 offset:65408
    ds_pk_add_bf16 v7, v89 offset:65412
    s_mov_b64 exec, s[54:55]
    s_branch L2_d49
L2_c50:
    s_lshl_b64 s[52:53], s[82:83], 1
    s_andn2_b64 s[52:53], s[52:53], s[80:81]
    s_andn2_b64 s[52:53], s[52:53], s[50:51]
    s_or_b64 s[80:81], s[80:81], s[52:53]
    s_not_b64 vcc, s[52:53]
    s_mov_b64 exec, -1
    v_cndmask_b32_dpp v84, v84, v84, vcc wave_shr:1 row_mask:0xf bank_mask:0xf
    v_cndmask_b32_dpp v85, v85, v85, vcc wave_shr:1 row_mask:0xf bank_mask:0xf
    s_lshr_b64 s[52:53], s[52:53], 1
    v_cndmask_b32_dpp v86, v86, v86, vcc wave_shr:1 row_mask:0xf bank_mask:0xf
    v_cndmask_b32_dpp v87, v87, v87, vcc wave_shr:1 row_mask:0xf bank_mask:0xf
    s_andn2_b64 s[82:83], s[82:83], s[52:53]
    v_cndmask_b32_dpp v7, v7, v7, vcc wave_shr:1 row_mask:0xf bank_mask:0xf
    s_mov_b64 exec, s[50:51]
    s_cbranch_scc0 L2_d50
    s_mov_b64 exec, s[82:83]
    s_nop 1
    v_mfma_f32_4x4x4_16b_bf16 v[88:91], v[12:13], v[84:85], 0
    s_nop 1
    v_mfma_f32_4x4x4_16b_bf16 v[88:91], v[10:11], v[86:87], v[88:91]
    s_nop 4
    v_cvt_pk_bf16_f32 v88, v88, v89
    v_cvt_pk_bf16_f32 v89, v90, v91
    ds_pk_add_bf16 v7, v88 offset:65408
    ds_pk_add_bf16 v7, v89 offset:65412
    s_mov_b64 exec, s[50:51]
    s_branch L2_d50
L2_c51:
    s_lshl_b64 s[52:53], s[82:83], 1
    s_andn2_b64 s[52:53], s[52:53], s[80:81]
    s_andn2_b64 s[52:53], s[52:53], s[54:55]
    s_or_b64 s[80:81], s[80:81], s[52:53]
    s_not_b64 vcc, s[52:53]
    s_mov_b64 exec, -1
    v_cndmask_b32_dpp v84, v84, v84, vcc wave_shr:1 row_mask:0xf bank_mask:0xf
    v_cndmask_b32_dpp v85, v85, v85, vcc wave_shr:1 row_mask:0xf bank_mask:0xf
    s_lshr_b64 s[52:53], s[52:53], 1
    v_cndmask_b32_dpp v86, v86, v86, vcc wave_shr:1 row_mask:0xf bank_mask:0xf
    v_cndmask_b32_dpp v87, v87, v87, vcc wave_shr:1 row_mask:0xf bank_mask:0xf
    s_andn2_b64 s[82:83], s[82:83], s[52:53]
    v_cndmask_b32_dpp v7, v7, v7, vcc wave_shr:1 row_mask:0xf bank_mask:0xf
    s_mov_b64 exec, s[54:55]
    s_cbranch_scc0 L2_d51
    s_mov_b64 exec, s[82:83]
    s_nop 1
    v_mfma_f32_4x4x4_16b_bf16 v[88:91], v[12:13], v[84:85], 0
    s_nop 1
    v_mfma_f32_4x4x4_16b_bf16 v[88:91], v[10:11], v[86:87], v[88:91]
    s_nop 4
    v_cvt_pk_bf16_f32 v88, v88, v89
    v_cvt_pk_bf16_f32 v89, v90, v91
    ds_pk_add_bf16 v7, v88 offset:65408
    ds_pk_add_bf16 v7, v89 offset:65412
    s_mov_b64 exec, s[54:55]
    s_branch L2_d51
L2_c52:
    s_lshl_b64 s[52:53], s[82:83], 1
    s_andn2_b64 s[52:53], s[52:53], s[80:81]
    s_andn2_b64 s[52:53], s[52:53], s[50:51]
    s_or_b64 s[80:81], s[80:81], s[52:53]
    s_not_b64 vcc, s[52:53]
    s_mov_b64 exec, -1
    v_cndmask_b32_dpp v84, v84, v84, vcc wave_shr:1 row_mask:0xf bank_mask:0xf
    v_cndmask_b32_dpp v85, v85, v85, vcc wave_shr:1 row_mask:0xf bank_mask:0xf
    s_lshr_b64 s[52:53], s[52:53], 1
    v_cndmask_b32_dpp v86, v86, v86, vcc wave_shr:1 row_mask:0xf bank_mask:0xf
    v_cndmask_b32_dpp v87, v87, v87, vcc wave_shr:1 row_mask:0xf bank_mask:0xf
    s_andn2_b64 s[82:83], s[82:83], s[52:53]
    v_cndmask_b32_dpp v7, v7, v7, vcc wave_shr:1 row_mask:0xf bank_mask:0xf
    s_mov_b64 exec, s[50:51]
    s_cbranch_scc0 L2_d52
    s_mov_b64 exec, s[82:83]
    s_nop 1
    v_mfma_f32_4x4x4_16b_bf16 v[88:91], v[12:13], v[84:85], 0
    s_nop 1
    v_mfma_f32_4x4x4_16b_bf16 v[88:91], v[10:11], v[86:87], v[88:91]
    s_nop 4
    v_cvt_pk_bf16_f32 v88, v88, v89
    v_cvt_pk_bf16_f32 v89, v90, v91
    ds_pk_add_bf16 v7, v88 offset:65408
    ds_pk_add_bf16 v7, v89 offset:65412
    s_mov_b64 exec, s[50:51]
    s_branch L2_d52
L2_c53:
    s_lshl_b64 s[52:53], s[82:83], 1
    s_andn2_b64 s[52:53], s[52:53], s[80:81]
    s_andn2_b64 s[52:53], s[52:53], s[54:55]
    s_or_b64 s[80:81], s[80:81], s[52:53]
    s_not_b64 vcc, s[52:53]
    s_mov_b64 exec, -1
    v_cndmask_b32_dpp v84, v84, v84, vcc wave_shr:1 row_mask:0xf bank_mask:0xf
    v_cndmask_b32_dpp v85, v85, v85, vcc wave_shr:1 row_mask:0xf bank_mask:0xf
    s_lshr_b64 s[52:53], s[52:53], 1
    v_cndmask_b32_dpp v86, v86, v86, vcc wave_shr:1 row_mask:0xf bank_mask:0xf
    v_cndmask_b32_dpp v87, v87, v87, vcc wave_shr:1 row_mask:0xf bank_mask:0xf
    s_andn2_b64 s[82:83], s[82:83], s[52:53]
    v_cndmask_b32_dpp v7, v7, v7, vcc wave_shr:1 row_mask:0xf bank_mask:0xf
    s_mov_b64 exec, s[54:55]
    s_cbranch_scc0 L2_d53
    s_mov_b64 exec, s[82:83]
    s_nop 1
    v_mfma_f32_4x4x4_16b_bf16 v[88:91], v[12:13], v[84:85], 0
    s_nop 1
    v_mfma_f32_4x4x4_16b_bf16 v[88:91], v[10:11], v[86:87], v[88:91]
    s_nop 4
    v_cvt_pk_bf16_f32 v88, v88, v89
    v_cvt_pk_bf16_f32 v89, v90, v91
    ds_pk_add_bf16 v7, v88 offset:65408
    ds_pk_add_bf16 v7, v89 offset:65412
    s_mov_b64 exec, s[54:55]
    s_branch L2_d53
L2_c54:
    s_lshl_b64 s[52:53], s[82:83], 1
    s_andn2_b64 s[52:53], s[52:53], s[80:81]
    s_andn2_b64 s[52:53], s[52:53], s[50:51]
    s_or_b64 s[80:81], s[80:81], s[52:53]
    s_not_b64 vcc, s[52:53]
    s_mov_b64 exec, -1
    v_cndmask_b32_dpp v84, v84, v84, vcc wave_shr:1 row_mask:0xf bank_mask:0xf
    v_cndmask_b32_dpp v85, v85, v85, vcc wave_shr:1 row_mask:0xf bank_mask:0xf
    s_lshr_b64 s[52:53], s[52:53], 1
    v_cndmask_b32_dpp v86, v86, v86, vcc wave_shr:1 row_mask:0xf bank_mask:0xf
    v_cndmask_b32_dpp v87, v87, v87, vcc wave_shr:1 row_mask:0xf bank_mask:0xf
    s_andn2_b64 s[82:83], s[82:83], s[52:53]
    v_cndmask_b32_dpp v7, v7, v7, vcc wave_shr:1 row_mask:0xf bank_mask:0xf
    s_mov_b64 exec, s[50:51]
    s_cbranch_scc0 L2_d54
    s_mov_b64 exec, s[82:83]
    s_nop 1
    v_mfma_f32_4x4x4_16b_bf16 v[88:91], v[12:13], v[84:85], 0
    s_nop 1
    v_mfma_f32_4x4x4_16b_bf16 v[88:91], v[10:11], v[86:87], v[88:91]
    s_nop 4
    v_cvt_pk_bf16_f32 v88, v88, v89
    v_cvt_pk_bf16_f32 v89, v90, v91
    ds_pk_add_bf16 v7, v88 offset:65408
    ds_pk_add_bf16 v7, v89 offset:65412
    s_mov_b64 exec, s[50:51]
    s_branch L2_d54
L2_oa55:
    s_waitcnt vmcnt(5)
    s_mov_b64 exec, s[6:7]
    v_lshrrev_b32 v114, 16, v114
    s_mov_b64 exec, -1
    v_and_b32 v46, 0x10000000, v20
    v_cmpx_eq_u32 vcc, 0, v46
    v_lshrrev_b32 v47, 14, v112
    v_and_b32 v47, v5, v47
    ds_read_b64 v[96:97], v47
    v_perm_b32 v98, v112, v114, s44
    v_bitop3_b32 v99, v112, 0.5, -0.5 bitop3:0xa8
    v_bitop3_b32 v98, v6, v98, v99 bitop3:0xca
    v_and_b32 v47, v5, v112
    s_waitcnt lgkmcnt(0)
    v_mfma_f32_4x4x4_16b_bf16 v[88:91], v[8:9], v[96:97], 0
    s_nop 4
    v_mul_f32 v88, v98, v88
    v_mul_f32 v89, v98, v89
    v_mul_f32 v90, v98, v90
    v_mul_f32 v91, v98, v91
    v_cvt_pk_bf16_f32 v88, v88, v89
    v_cvt_pk_bf16_f32 v89, v90, v91
    ds_pk_add_bf16 v47, v88 offset:65408
    ds_pk_add_bf16 v47, v89 offset:65412
    s_mov_b64 exec, -1
    v_and_b32 v46, 0x20000000, v20
    v_cmpx_eq_u32 vcc, 0, v46
    v_lshrrev_b32 v47, 14, v113
    v_and_b32 v47, v5, v47
    ds_read_b64 v[96:97], v47
    v_perm_b32 v98, v113, v114, s45
    v_bitop3_b32 v99, v113, 0.5, -0.5 bitop3:0xa8
    v_bitop3_b32 v98, v6, v98, v99 bitop3:0xca
    v_and_b32 v47, v5, v113
    s_waitcnt lgkmcnt(0)
    v_mfma_f32_4x4x4_16b_bf16 v[88:91], v[8:9], v[96:97], 0
    s_nop 4
    v_mul_f32 v88, v98, v88
    v_mul_f32 v89, v98, v89
    v_mul_f32 v90, v98, v90
    v_mul_f32 v91, v98, v91
    v_cvt_pk_bf16_f32 v88, v88, v89
    v_cvt_pk_bf16_f32 v89, v90, v91
    ds_pk_add_bf16 v47, v88 offset:65408
    ds_pk_add_bf16 v47, v89 offset:65412
    s_mov_b64 exec, -1
    s_branch L2_ob55
L2_xo56:
    v_cmp_lt_u32 vcc, 20, v99
    s_mov_b32 s101, 1
    s_cbranch_vccz L2_xp56
    v_cmp_lt_u32 vcc, 32, v99
    v_cmp_lt_u32 s[58:59], 31, v88
    s_mov_b32 s101, 2
    s_or_b64 vcc, vcc, s[58:59]
    s_cbranch_scc0 L2_xp56
    s_mov_b32 s37, 0x10000
    s_branch L2_xp56
L2_c57:
    s_lshl_b64 s[52:53], s[82:83], 1
    s_andn2_b64 s[52:53], s[52:53], s[80:81]
    s_andn2_b64 s[52:53], s[52:53], s[54:55]
    s_or_b64 s[80:81], s[80:81], s[52:53]
    s_not_b64 vcc, s[52:53]
    s_mov_b64 exec, -1
    v_cndmask_b32_dpp v84, v84, v84, vcc wave_shr:1 row_mask:0xf bank_mask:0xf
    v_cndmask_b32_dpp v85, v85, v85, vcc wave_shr:1 row_mask:0xf bank_mask:0xf
    s_lshr_b64 s[52:53], s[52:53], 1
    v_cndmask_b32_dpp v86, v86, v86, vcc wave_shr:1 row_mask:0xf bank_mask:0xf
    v_cndmask_b32_dpp v87, v87, v87, vcc wave_shr:1 row_mask:0xf bank_mask:0xf
    s_andn2_b64 s[82:83], s[82:83], s[52:53]
    v_cndmask_b32_dpp v7, v7, v7, vcc wave_shr:1 row_mask:0xf bank_mask:0xf
    s_mov_b64 exec, s[54:55]
    s_cbranch_scc0 L2_d57
    s_mov_b64 exec, s[82:83]
    s_nop 1
    v_mfma_f32_4x4x4_16b_bf16 v[88:91], v[12:13], v[84:85], 0
    s_nop 1
    v_mfma_f32_4x4x4_16b_bf16 v[88:91], v[10:11], v[86:87], v[88:91]
    s_nop 4
    v_cvt_pk_bf16_f32 v88, v88, v89
    v_cvt_pk_bf16_f32 v89, v90, v91
    ds_pk_add_bf16 v7, v88 offset:65408
    ds_pk_add_bf16 v7, v89 offset:65412
    s_mov_b64 exec, s[54:55]
    s_branch L2_d57
L2_c58:
    s_lshl_b64 s[52:53], s[82:83], 1
    s_andn2_b64 s[52:53], s[52:53], s[80:81]
    s_andn2_b64 s[52:53], s[52:53], s[50:51]
    s_or_b64 s[80:81], s[80:81], s[52:53]
    s_not_b64 vcc, s[52:53]
    s_mov_b64 exec, -1
    v_cndmask_b32_dpp v84, v84, v84, vcc wave_shr:1 row_mask:0xf bank_mask:0xf
    v_cndmask_b32_dpp v85, v85, v85, vcc wave_shr:1 row_mask:0xf bank_mask:0xf
    s_lshr_b64 s[52:53], s[52:53], 1
    v_cndmask_b32_dpp v86, v86, v86, vcc wave_shr:1 row_mask:0xf bank_mask:0xf
    v_cndmask_b32_dpp v87, v87, v87, vcc wave_shr:1 row_mask:0xf bank_mask:0xf
    s_andn2_b64 s[82:83], s[82:83], s[52:53]
    v_cndmask_b32_dpp v7, v7, v7, vcc wave_shr:1 row_mask:0xf bank_mask:0xf
    s_mov_b64 exec, s[50:51]
    s_cbranch_scc0 L2_d58
    s_mov_b64 exec, s[82:83]
    s_nop 1
    v_mfma_f32_4x4x4_16b_bf16 v[88:91], v[12:13], v[84:85], 0
    s_nop 1
    v_mfma_f32_4x4x4_16b_bf16 v[88:91], v[10:11], v[86:87], v[88:91]
    s_nop 4
    v_cvt_pk_bf16_f32 v88, v88, v89
    v_cvt_pk_bf16_f32 v89, v90, v91
    ds_pk_add_bf16 v7, v88 offset:65408
    ds_pk_add_bf16 v7, v89 offset:65412
    s_mov_b64 exec, s[50:51]
    s_branch L2_d58
L2_c59:
    s_lshl_b64 s[52:53], s[82:83], 1
    s_andn2_b64 s[52:53], s[52:53], s[80:81]
    s_andn2_b64 s[52:53], s[52:53], s[54:55]
    s_or_b64 s[80:81], s[80:81], s[52:53]
    s_not_b64 vcc, s[52:53]
    s_mov_b64 exec, -1
    v_cndmask_b32_dpp v84, v84, v84, vcc wave_shr:1 row_mask:0xf bank_mask:0xf
    v_cndmask_b32_dpp v85, v85, v85, vcc wave_shr:1 row_mask:0xf bank_mask:0xf
    s_lshr_b64 s[52:53], s[52:53], 1
    v_cndmask_b32_dpp v86, v86, v86, vcc wave_shr:1 row_mask:0xf bank_mask:0xf
    v_cndmask_b32_dpp v87, v87, v87, vcc wave_shr:1 row_mask:0xf bank_mask:0xf
    s_andn2_b64 s[82:83], s[82:83], s[52:53]
    v_cndmask_b32_dpp v7, v7, v7, vcc wave_shr:1 row_mask:0xf bank_mask:0xf
    s_mov_b64 exec, s[54:55]
    s_cbranch_scc0 L2_d59
    s_mov_b64 exec, s[82:83]
    s_nop 1
    v_mfma_f32_4x4x4_16b_bf16 v[88:91], v[12:13], v[84:85], 0
    s_nop 1
    v_mfma_f32_4x4x4_16b_bf16 v[88:91], v[10:11], v[86:87], v[88:91]
    s_nop 4
    v_cvt_pk_bf16_f32 v88, v88, v89
    v_cvt_pk_bf16_f32 v89, v90, v91
    ds_pk_add_bf16 v7, v88 offset:65408
    ds_pk_add_bf16 v7, v89 offset:65412
    s_mov_b64 exec, s[54:55]
    s_branch L2_d59
L2_c60:
    s_lshl_b64 s[52:53], s[82:83], 1
    s_andn2_b64 s[52:53], s[52:53], s[80:81]
    s_andn2_b64 s[52:53], s[52:53], s[50:51]
    s_or_b64 s[80:81], s[80:81], s[52:53]
    s_not_b64 vcc, s[52:53]
    s_mov_b64 exec, -1
    v_cndmask_b32_dpp v84, v84, v84, vcc wave_shr:1 row_mask:0xf bank_mask:0xf
    v_cndmask_b32_dpp v85, v85, v85, vcc wave_shr:1 row_mask:0xf bank_mask:0xf
    s_lshr_b64 s[52:53], s[52:53], 1
    v_cndmask_b32_dpp v86, v86, v86, vcc wave_shr:1 row_mask:0xf bank_mask:0xf
    v_cndmask_b32_dpp v87, v87, v87, vcc wave_shr:1 row_mask:0xf bank_mask:0xf
    s_andn2_b64 s[82:83], s[82:83], s[52:53]
    v_cndmask_b32_dpp v7, v7, v7, vcc wave_shr:1 row_mask:0xf bank_mask:0xf
    s_mov_b64 exec, s[50:51]
    s_cbranch_scc0 L2_d60
    s_mov_b64 exec, s[82:83]
    s_nop 1
    v_mfma_f32_4x4x4_16b_bf16 v[88:91], v[12:13], v[84:85], 0
    s_nop 1
    v_mfma_f32_4x4x4_16b_bf16 v[88:91], v[10:11], v[86:87], v[88:91]
    s_nop 4
    v_cvt_pk_bf16_f32 v88, v88, v89
    v_cvt_pk_bf16_f32 v89, v90, v91
    ds_pk_add_bf16 v7, v88 offset:65408
    ds_pk_add_bf16 v7, v89 offset:65412
    s_mov_b64 exec, s[50:51]
    s_branch L2_d60
L2_xa61:
    s_cmp_eq_u32 s101, 1
    s_cbranch_scc1 L2_xc61
    v_lshlrev_b32 v89, 0, v96
    v_add_u32 v90, 140, v97
    v_bitop3_b32 v90, v89, v45, v90 bitop3:0x6a
    ds_write_b32 v98, v90 offset:28
    v_lshlrev_b32 v89, 4, v96
    v_add_u32 v90, 120, v97
    v_bitop3_b32 v90, v89, v45, v90 bitop3:0x6a
    ds_write_b32 v98, v90 offset:24
    v_lshlrev_b32 v89, 8, v96
    v_add_u32 v90, 100, v97
    v_bitop3_b32 v90, v89, v45, v90 bitop3:0x6a
    ds_write_b32 v98, v90 offset:20
L2_xc61:
    v_lshlrev_b32 v89, 12, v96
    v_add_u32 v90, 80, v97
    v_bitop3_b32 v90, v89, v45, v90 bitop3:0x6a
    ds_write_b32 v98, v90 offset:16
    s_branch L2_xb61
L2_xe61:
    v_cmp_lt_u32 vcc, 32, v99
    v_cmp_lt_u32 s[58:59], 31, v88
    v_lshrrev_b32 v89, 16, v96
    v_add_u32 v97, 80, v97
    s_or_b64 vcc, vcc, s[58:59]
    s_cbranch_scc1 L2_xs61
    v_lshlrev_b32 v89, v1, v89
    v_and_b32 v89, v45, v89
    v_cmp_ne_u32 vcc, 0, v89
    v_xor_b32 v90, v97, v89
    s_add_u32 s3, s37, s38
    v_mbcnt_lo_u32_b32 v98, vcc_lo, 0
    v_mbcnt_hi_u32_b32 v98, vcc_hi, v98
    s_bcnt1_i32_b64 s41, vcc
    v_lshl_add_u32 v98, v98, 2, s3
    s_lshl2_add_u32 s37, s41, s37
    s_mov_b64 exec, vcc
    ds_write_b32 v98, v90
    s_mov_b64 exec, -1
    s_branch L2_xr61
L2_xs61:
    s_waitcnt lgkmcnt(0)
    s_mov_b32 s37, 0x10000
    s_branch L2_xw61
L2_c62:
    s_lshl_b64 s[52:53], s[82:83], 1
    s_andn2_b64 s[52:53], s[52:53], s[80:81]
    s_andn2_b64 s[52:53], s[52:53], s[54:55]
    s_or_b64 s[80:81], s[80:81], s[52:53]
    s_not_b64 vcc, s[52:53]
    s_mov_b64 exec, -1
    v_cndmask_b32_dpp v84, v84, v84, vcc wave_shr:1 row_mask:0xf bank_mask:0xf
    v_cndmask_b32_dpp v85, v85, v85, vcc wave_shr:1 row_mask:0xf bank_mask:0xf
    s_lshr_b64 s[52:53], s[52:53], 1
    v_cndmask_b32_dpp v86, v86, v86, vcc wave_shr:1 row_mask:0xf bank_mask:0xf
    v_cndmask_b32_dpp v87, v87, v87, vcc wave_shr:1 row_mask:0xf bank_mask:0xf
    s_andn2_b64 s[82:83], s[82:83], s[52:53]
    v_cndmask_b32_dpp v7, v7, v7, vcc wave_shr:1 row_mask:0xf bank_mask:0xf
    s_mov_b64 exec, s[54:55]
    s_cbranch_scc0 L2_d62
    s_mov_b64 exec, s[82:83]
    s_nop 1
    v_mfma_f32_4x4x4_16b_bf16 v[88:91], v[12:13], v[84:85], 0
    s_nop 1
    v_mfma_f32_4x4x4_16b_bf16 v[88:91], v[10:11], v[86:87], v[88:91]
    s_nop 4
    v_cvt_pk_bf16_f32 v88, v88, v89
    v_cvt_pk_bf16_f32 v89, v90, v91
    ds_pk_add_bf16 v7, v88 offset:65408
    ds_pk_add_bf16 v7, v89 offset:65412
    s_mov_b64 exec, s[54:55]
    s_branch L2_d62
L2_c63:
    s_lshl_b64 s[52:53], s[82:83], 1
    s_andn2_b64 s[52:53], s[52:53], s[80:81]
    s_andn2_b64 s[52:53], s[52:53], s[50:51]
    s_or_b64 s[80:81], s[80:81], s[52:53]
    s_not_b64 vcc, s[52:53]
    s_mov_b64 exec, -1
    v_cndmask_b32_dpp v84, v84, v84, vcc wave_shr:1 row_mask:0xf bank_mask:0xf
    v_cndmask_b32_dpp v85, v85, v85, vcc wave_shr:1 row_mask:0xf bank_mask:0xf
    s_lshr_b64 s[52:53], s[52:53], 1
    v_cndmask_b32_dpp v86, v86, v86, vcc wave_shr:1 row_mask:0xf bank_mask:0xf
    v_cndmask_b32_dpp v87, v87, v87, vcc wave_shr:1 row_mask:0xf bank_mask:0xf
    s_andn2_b64 s[82:83], s[82:83], s[52:53]
    v_cndmask_b32_dpp v7, v7, v7, vcc wave_shr:1 row_mask:0xf bank_mask:0xf
    s_mov_b64 exec, s[50:51]
    s_cbranch_scc0 L2_d63
    s_mov_b64 exec, s[82:83]
    s_nop 1
    v_mfma_f32_4x4x4_16b_bf16 v[88:91], v[12:13], v[84:85], 0
    s_nop 1
    v_mfma_f32_4x4x4_16b_bf16 v[88:91], v[10:11], v[86:87], v[88:91]
    s_nop 4
    v_cvt_pk_bf16_f32 v88, v88, v89
    v_cvt_pk_bf16_f32 v89, v90, v91
    ds_pk_add_bf16 v7, v88 offset:65408
    ds_pk_add_bf16 v7, v89 offset:65412
    s_mov_b64 exec, s[50:51]
    s_branch L2_d63
L2_xf61:
    s_cmp_gt_u32 s37, 1024
    s_cbranch_scc1 L2_xt61
    s_cmp_lt_u32 s37, 768
    s_cbranch_scc1 L2_xl61
    ds_read_b32 v20, v44 offset:896
    s_add_u32 s3, s42, 2
    s_bitset1_b32 s43, s3
    s_branch L2_xg61
L2_xl61:
    s_waitcnt lgkmcnt(0)
    v_mov_b32 v19, -1
    s_cmp_ge_u32 s37, 512
    s_cbranch_scc1 L2_xg61
    v_mov_b32 v39, -1
    s_cmp_ge_u32 s37, 256
    s_cbranch_scc1 L2_xg61
    v_mov_b32 v33, -1
    s_branch L2_xg61
L2_xt61:
    s_waitcnt lgkmcnt(0)
    v_mov_b32 v27, -1
    v_mov_b32 v33, -1
    v_mov_b32 v39, -1
    v_mov_b32 v19, -1
    s_add_u32 s3, s42, 2
    s_bitset1_b32 s36, s3
    s_branch L2_xg61
L2_oa64:
    v_and_b32 v47, 0x0fffffff, v21
    buffer_load_dword v114, v47, s[8:11], 0 offen offset:16
    s_mov_b64 exec, s[6:7]
    v_add_u32 v47, 8, v47
    v_lshrrev_b32 v21, 2, v21
    s_mov_b64 exec, -1
    buffer_load_dwordx2 v[112:113], v47, s[8:11], 0 offen
    s_branch L2_ob64
L2_c65:
    s_lshl_b64 s[52:53], s[82:83], 1
    s_andn2_b64 s[52:53], s[52:53], s[80:81]
    s_andn2_b64 s[52:53], s[52:53], s[54:55]
    s_or_b64 s[80:81], s[80:81], s[52:53]
    s_not_b64 vcc, s[52:53]
    s_mov_b64 exec, -1
    v_cndmask_b32_dpp v84, v84, v84, vcc wave_shr:1 row_mask:0xf bank_mask:0xf
    v_cndmask_b32_dpp v85, v85, v85, vcc wave_shr:1 row_mask:0xf bank_mask:0xf
    s_lshr_b64 s[52:53], s[52:53], 1
    v_cndmask_b32_dpp v86, v86, v86, vcc wave_shr:1 row_mask:0xf bank_mask:0xf
    v_cndmask_b32_dpp v87, v87, v87, vcc wave_shr:1 row_mask:0xf bank_mask:0xf
    s_andn2_b64 s[82:83], s[82:83], s[52:53]
    v_cndmask_b32_dpp v7, v7, v7, vcc wave_shr:1 row_mask:0xf bank_mask:0xf
    s_mov_b64 exec, s[54:55]
    s_cbranch_scc0 L2_d65
    s_mov_b64 exec, s[82:83]
    s_nop 1
    v_mfma_f32_4x4x4_16b_bf16 v[88:91], v[12:13], v[84:85], 0
    s_nop 1
    v_mfma_f32_4x4x4_16b_bf16 v[88:91], v[10:11], v[86:87], v[88:91]
    s_nop 4
    v_cvt_pk_bf16_f32 v88, v88, v89
    v_cvt_pk_bf16_f32 v89, v90, v91
    ds_pk_add_bf16 v7, v88 offset:65408
    ds_pk_add_bf16 v7, v89 offset:65412
    s_mov_b64 exec, s[54:55]
    s_branch L2_d65
L2_c66:
    s_lshl_b64 s[52:53], s[82:83], 1
    s_andn2_b64 s[52:53], s[52:53], s[80:81]
    s_andn2_b64 s[52:53], s[52:53], s[50:51]
    s_or_b64 s[80:81], s[80:81], s[52:53]
    s_not_b64 vcc, s[52:53]
    s_mov_b64 exec, -1
    v_cndmask_b32_dpp v84, v84, v84, vcc wave_shr:1 row_mask:0xf bank_mask:0xf
    v_cndmask_b32_dpp v85, v85, v85, vcc wave_shr:1 row_mask:0xf bank_mask:0xf
    s_lshr_b64 s[52:53], s[52:53], 1
    v_cndmask_b32_dpp v86, v86, v86, vcc wave_shr:1 row_mask:0xf bank_mask:0xf
    v_cndmask_b32_dpp v87, v87, v87, vcc wave_shr:1 row_mask:0xf bank_mask:0xf
    s_andn2_b64 s[82:83], s[82:83], s[52:53]
    v_cndmask_b32_dpp v7, v7, v7, vcc wave_shr:1 row_mask:0xf bank_mask:0xf
    s_mov_b64 exec, s[50:51]
    s_cbranch_scc0 L2_d66
    s_mov_b64 exec, s[82:83]
    s_nop 1
    v_mfma_f32_4x4x4_16b_bf16 v[88:91], v[12:13], v[84:85], 0
    s_nop 1
    v_mfma_f32_4x4x4_16b_bf16 v[88:91], v[10:11], v[86:87], v[88:91]
    s_nop 4
    v_cvt_pk_bf16_f32 v88, v88, v89
    v_cvt_pk_bf16_f32 v89, v90, v91
    ds_pk_add_bf16 v7, v88 offset:65408
    ds_pk_add_bf16 v7, v89 offset:65412
    s_mov_b64 exec, s[50:51]
    s_branch L2_d66
L2_c67:
    s_lshl_b64 s[52:53], s[82:83], 1
    s_andn2_b64 s[52:53], s[52:53], s[80:81]
    s_andn2_b64 s[52:53], s[52:53], s[54:55]
    s_or_b64 s[80:81], s[80:81], s[52:53]
    s_not_b64 vcc, s[52:53]
    s_mov_b64 exec, -1
    v_cndmask_b32_dpp v84, v84, v84, vcc wave_shr:1 row_mask:0xf bank_mask:0xf
    v_cndmask_b32_dpp v85, v85, v85, vcc wave_shr:1 row_mask:0xf bank_mask:0xf
    s_lshr_b64 s[52:53], s[52:53], 1
    v_cndmask_b32_dpp v86, v86, v86, vcc wave_shr:1 row_mask:0xf bank_mask:0xf
    v_cndmask_b32_dpp v87, v87, v87, vcc wave_shr:1 row_mask:0xf bank_mask:0xf
    s_andn2_b64 s[82:83], s[82:83], s[52:53]
    v_cndmask_b32_dpp v7, v7, v7, vcc wave_shr:1 row_mask:0xf bank_mask:0xf
    s_mov_b64 exec, s[54:55]
    s_cbranch_scc0 L2_d67
    s_mov_b64 exec, s[82:83]
    s_nop 1
    v_mfma_f32_4x4x4_16b_bf16 v[88:91], v[12:13], v[84:85], 0
    s_nop 1
    v_mfma_f32_4x4x4_16b_bf16 v[88:91], v[10:11], v[86:87], v[88:91]
    s_nop 4
    v_cvt_pk_bf16_f32 v88, v88, v89
    v_cvt_pk_bf16_f32 v89, v90, v91
    ds_pk_add_bf16 v7, v88 offset:65408
    ds_pk_add_bf16 v7, v89 offset:65412
    s_mov_b64 exec, s[54:55]
    s_branch L2_d67
L2_c68:
    s_lshl_b64 s[52:53], s[82:83], 1
    s_andn2_b64 s[52:53], s[52:53], s[80:81]
    s_andn2_b64 s[52:53], s[52:53], s[50:51]
    s_or_b64 s[80:81], s[80:81], s[52:53]
    s_not_b64 vcc, s[52:53]
    s_mov_b64 exec, -1
    v_cndmask_b32_dpp v84, v84, v84, vcc wave_shr:1 row_mask:0xf bank_mask:0xf
    v_cndmask_b32_dpp v85, v85, v85, vcc wave_shr:1 row_mask:0xf bank_mask:0xf
    s_lshr_b64 s[52:53], s[52:53], 1
    v_cndmask_b32_dpp v86, v86, v86, vcc wave_shr:1 row_mask:0xf bank_mask:0xf
    v_cndmask_b32_dpp v87, v87, v87, vcc wave_shr:1 row_mask:0xf bank_mask:0xf
    s_andn2_b64 s[82:83], s[82:83], s[52:53]
    v_cndmask_b32_dpp v7, v7, v7, vcc wave_shr:1 row_mask:0xf bank_mask:0xf
    s_mov_b64 exec, s[50:51]
    s_cbranch_scc0 L2_d68
    s_mov_b64 exec, s[82:83]
    s_nop 1
    v_mfma_f32_4x4x4_16b_bf16 v[88:91], v[12:13], v[84:85], 0
    s_nop 1
    v_mfma_f32_4x4x4_16b_bf16 v[88:91], v[10:11], v[86:87], v[88:91]
    s_nop 4
    v_cvt_pk_bf16_f32 v88, v88, v89
    v_cvt_pk_bf16_f32 v89, v90, v91
    ds_pk_add_bf16 v7, v88 offset:65408
    ds_pk_add_bf16 v7, v89 offset:65412
    s_mov_b64 exec, s[50:51]
    s_branch L2_d68
L2_c69:
    s_lshl_b64 s[52:53], s[82:83], 1
    s_andn2_b64 s[52:53], s[52:53], s[80:81]
    s_andn2_b64 s[52:53], s[52:53], s[54:55]
    s_or_b64 s[80:81], s[80:81], s[52:53]
    s_not_b64 vcc, s[52:53]
    s_mov_b64 exec, -1
    v_cndmask_b32_dpp v84, v84, v84, vcc wave_shr:1 row_mask:0xf bank_mask:0xf
    v_cndmask_b32_dpp v85, v85, v85, vcc wave_shr:1 row_mask:0xf bank_mask:0xf
    s_lshr_b64 s[52:53], s[52:53], 1
    v_cndmask_b32_dpp v86, v86, v86, vcc wave_shr:1 row_mask:0xf bank_mask:0xf
    v_cndmask_b32_dpp v87, v87, v87, vcc wave_shr:1 row_mask:0xf bank_mask:0xf
    s_andn2_b64 s[82:83], s[82:83], s[52:53]
    v_cndmask_b32_dpp v7, v7, v7, vcc wave_shr:1 row_mask:0xf bank_mask:0xf
    s_mov_b64 exec, s[54:55]
    s_cbranch_scc0 L2_d69
    s_mov_b64 exec, s[82:83]
    s_nop 1
    v_mfma_f32_4x4x4_16b_bf16 v[88:91], v[12:13], v[84:85], 0
    s_nop 1
    v_mfma_f32_4x4x4_16b_bf16 v[88:91], v[10:11], v[86:87], v[88:91]
    s_nop 4
    v_cvt_pk_bf16_f32 v88, v88, v89
    v_cvt_pk_bf16_f32 v89, v90, v91
    ds_pk_add_bf16 v7, v88 offset:65408
    ds_pk_add_bf16 v7, v89 offset:65412
    s_mov_b64 exec, s[54:55]
    s_branch L2_d69
L2_c70:
    s_lshl_b64 s[52:53], s[82:83], 1
    s_andn2_b64 s[52:53], s[52:53], s[80:81]
    s_andn2_b64 s[52:53], s[52:53], s[50:51]
    s_or_b64 s[80:81], s[80:81], s[52:53]
    s_not_b64 vcc, s[52:53]
    s_mov_b64 exec, -1
    v_cndmask_b32_dpp v84, v84, v84, vcc wave_shr:1 row_mask:0xf bank_mask:0xf
    v_cndmask_b32_dpp v85, v85, v85, vcc wave_shr:1 row_mask:0xf bank_mask:0xf
    s_lshr_b64 s[52:53], s[52:53], 1
    v_cndmask_b32_dpp v86, v86, v86, vcc wave_shr:1 row_mask:0xf bank_mask:0xf
    v_cndmask_b32_dpp v87, v87, v87, vcc wave_shr:1 row_mask:0xf bank_mask:0xf
    s_andn2_b64 s[82:83], s[82:83], s[52:53]
    v_cndmask_b32_dpp v7, v7, v7, vcc wave_shr:1 row_mask:0xf bank_mask:0xf
    s_mov_b64 exec, s[50:51]
    s_cbranch_scc0 L2_d70
    s_mov_b64 exec, s[82:83]
    s_nop 1
    v_mfma_f32_4x4x4_16b_bf16 v[88:91], v[12:13], v[84:85], 0
    s_nop 1
    v_mfma_f32_4x4x4_16b_bf16 v[88:91], v[10:11], v[86:87], v[88:91]
    s_nop 4
    v_cvt_pk_bf16_f32 v88, v88, v89
    v_cvt_pk_bf16_f32 v89, v90, v91
    ds_pk_add_bf16 v7, v88 offset:65408
    ds_pk_add_bf16 v7, v89 offset:65412
    s_mov_b64 exec, s[50:51]
    s_branch L2_d70
L2_c71:
    s_lshl_b64 s[52:53], s[82:83], 1
    s_andn2_b64 s[52:53], s[52:53], s[80:81]
    s_andn2_b64 s[52:53], s[52:53], s[54:55]
    s_or_b64 s[80:81], s[80:81], s[52:53]
    s_not_b64 vcc, s[52:53]
    s_mov_b64 exec, -1
    v_cndmask_b32_dpp v84, v84, v84, vcc wave_shr:1 row_mask:0xf bank_mask:0xf
    v_cndmask_b32_dpp v85, v85, v85, vcc wave_shr:1 row_mask:0xf bank_mask:0xf
    s_lshr_b64 s[52:53], s[52:53], 1
    v_cndmask_b32_dpp v86, v86, v86, vcc wave_shr:1 row_mask:0xf bank_mask:0xf
    v_cndmask_b32_dpp v87, v87, v87, vcc wave_shr:1 row_mask:0xf bank_mask:0xf
    s_andn2_b64 s[82:83], s[82:83], s[52:53]
    v_cndmask_b32_dpp v7, v7, v7, vcc wave_shr:1 row_mask:0xf bank_mask:0xf
    s_mov_b64 exec, s[54:55]
    s_cbranch_scc0 L2_d71
    s_mov_b64 exec, s[82:83]
    s_nop 1
    v_mfma_f32_4x4x4_16b_bf16 v[88:91], v[12:13], v[84:85], 0
    s_nop 1
    v_mfma_f32_4x4x4_16b_bf16 v[88:91], v[10:11], v[86:87], v[88:91]
    s_nop 4
    v_cvt_pk_bf16_f32 v88, v88, v89
    v_cvt_pk_bf16_f32 v89, v90, v91
    ds_pk_add_bf16 v7, v88 offset:65408
    ds_pk_add_bf16 v7, v89 offset:65412
    s_mov_b64 exec, s[54:55]
    s_branch L2_d71
L2_c72:
    s_lshl_b64 s[52:53], s[82:83], 1
    s_andn2_b64 s[52:53], s[52:53], s[80:81]
    s_andn2_b64 s[52:53], s[52:53], s[50:51]
    s_or_b64 s[80:81], s[80:81], s[52:53]
    s_not_b64 vcc, s[52:53]
    s_mov_b64 exec, -1
    v_cndmask_b32_dpp v84, v84, v84, vcc wave_shr:1 row_mask:0xf bank_mask:0xf
    v_cndmask_b32_dpp v85, v85, v85, vcc wave_shr:1 row_mask:0xf bank_mask:0xf
    s_lshr_b64 s[52:53], s[52:53], 1
    v_cndmask_b32_dpp v86, v86, v86, vcc wave_shr:1 row_mask:0xf bank_mask:0xf
    v_cndmask_b32_dpp v87, v87, v87, vcc wave_shr:1 row_mask:0xf bank_mask:0xf
    s_andn2_b64 s[82:83], s[82:83], s[52:53]
    v_cndmask_b32_dpp v7, v7, v7, vcc wave_shr:1 row_mask:0xf bank_mask:0xf
    s_mov_b64 exec, s[50:51]
    s_cbranch_scc0 L2_d72
    s_mov_b64 exec, s[82:83]
    s_nop 1
    v_mfma_f32_4x4x4_16b_bf16 v[88:91], v[12:13], v[84:85], 0
    s_nop 1
    v_mfma_f32_4x4x4_16b_bf16 v[88:91], v[10:11], v[86:87], v[88:91]
    s_nop 4
    v_cvt_pk_bf16_f32 v88, v88, v89
    v_cvt_pk_bf16_f32 v89, v90, v91
    ds_pk_add_bf16 v7, v88 offset:65408
    ds_pk_add_bf16 v7, v89 offset:65412
    s_mov_b64 exec, s[50:51]
    s_branch L2_d72
L2_oa73:
    s_waitcnt vmcnt(5)
    s_mov_b64 exec, s[6:7]
    v_lshrrev_b32 v114, 16, v114
    s_mov_b64 exec, -1
    v_and_b32 v46, 0x10000000, v21
    v_cmpx_eq_u32 vcc, 0, v46
    v_lshrrev_b32 v47, 14, v112
    v_and_b32 v47, v5, v47
    ds_read_b64 v[96:97], v47
    v_perm_b32 v98, v112, v114, s44
    v_bitop3_b32 v99, v112, 0.5, -0.5 bitop3:0xa8
    v_bitop3_b32 v98, v6, v98, v99 bitop3:0xca
    v_and_b32 v47, v5, v112
    s_waitcnt lgkmcnt(0)
    v_mfma_f32_4x4x4_16b_bf16 v[88:91], v[8:9], v[96:97], 0
    s_nop 4
    v_mul_f32 v88, v98, v88
    v_mul_f32 v89, v98, v89
    v_mul_f32 v90, v98, v90
    v_mul_f32 v91, v98, v91
    v_cvt_pk_bf16_f32 v88, v88, v89
    v_cvt_pk_bf16_f32 v89, v90, v91
    ds_pk_add_bf16 v47, v88 offset:65408
    ds_pk_add_bf16 v47, v89 offset:65412
    s_mov_b64 exec, -1
    v_and_b32 v46, 0x20000000, v21
    v_cmpx_eq_u32 vcc, 0, v46
    v_lshrrev_b32 v47, 14, v113
    v_and_b32 v47, v5, v47
    ds_read_b64 v[96:97], v47
    v_perm_b32 v98, v113, v114, s45
    v_bitop3_b32 v99, v113, 0.5, -0.5 bitop3:0xa8
    v_bitop3_b32 v98, v6, v98, v99 bitop3:0xca
    v_and_b32 v47, v5, v113
    s_waitcnt lgkmcnt(0)
    v_mfma_f32_4x4x4_16b_bf16 v[88:91], v[8:9], v[96:97], 0
    s_nop 4
    v_mul_f32 v88, v98, v88
    v_mul_f32 v89, v98, v89
    v_mul_f32 v90, v98, v90
    v_mul_f32 v91, v98, v91
    v_cvt_pk_bf16_f32 v88, v88, v89
    v_cvt_pk_bf16_f32 v89, v90, v91
    ds_pk_add_bf16 v47, v88 offset:65408
    ds_pk_add_bf16 v47, v89 offset:65412
    s_mov_b64 exec, -1
    s_branch L2_ob73
L2_xo74:
    v_cmp_lt_u32 vcc, 20, v99
    s_mov_b32 s101, 1
    s_cbranch_vccz L2_xp74
    v_cmp_lt_u32 vcc, 32, v99
    v_cmp_lt_u32 s[58:59], 31, v88
    s_mov_b32 s101, 2
    s_or_b64 vcc, vcc, s[58:59]
    s_cbranch_scc0 L2_xp74
    s_mov_b32 s37, 0x10000
    s_branch L2_xp74
L2_c75:
    s_lshl_b64 s[52:53], s[82:83], 1
    s_andn2_b64 s[52:53], s[52:53], s[80:81]
    s_andn2_b64 s[52:53], s[52:53], s[54:55]
    s_or_b64 s[80:81], s[80:81], s[52:53]
    s_not_b64 vcc, s[52:53]
    s_mov_b64 exec, -1
    v_cndmask_b32_dpp v84, v84, v84, vcc wave_shr:1 row_mask:0xf bank_mask:0xf
    v_cndmask_b32_dpp v85, v85, v85, vcc wave_shr:1 row_mask:0xf bank_mask:0xf
    s_lshr_b64 s[52:53], s[52:53], 1
    v_cndmask_b32_dpp v86, v86, v86, vcc wave_shr:1 row_mask:0xf bank_mask:0xf
    v_cndmask_b32_dpp v87, v87, v87, vcc wave_shr:1 row_mask:0xf bank_mask:0xf
    s_andn2_b64 s[82:83], s[82:83], s[52:53]
    v_cndmask_b32_dpp v7, v7, v7, vcc wave_shr:1 row_mask:0xf bank_mask:0xf
    s_mov_b64 exec, s[54:55]
    s_cbranch_scc0 L2_d75
    s_mov_b64 exec, s[82:83]
    s_nop 1
    v_mfma_f32_4x4x4_16b_bf16 v[88:91], v[12:13], v[84:85], 0
    s_nop 1
    v_mfma_f32_4x4x4_16b_bf16 v[88:91], v[10:11], v[86:87], v[88:91]
    s_nop 4
    v_cvt_pk_bf16_f32 v88, v88, v89
    v_cvt_pk_bf16_f32 v89, v90, v91
    ds_pk_add_bf16 v7, v88 offset:65408
    ds_pk_add_bf16 v7, v89 offset:65412
    s_mov_b64 exec, s[54:55]
    s_branch L2_d75
L2_c76:
    s_lshl_b64 s[52:53], s[82:83], 1
    s_andn2_b64 s[52:53], s[52:53], s[80:81]
    s_andn2_b64 s[52:53], s[52:53], s[50:51]
    s_or_b64 s[80:81], s[80:81], s[52:53]
    s_not_b64 vcc, s[52:53]
    s_mov_b64 exec, -1
    v_cndmask_b32_dpp v84, v84, v84, vcc wave_shr:1 row_mask:0xf bank_mask:0xf
    v_cndmask_b32_dpp v85, v85, v85, vcc wave_shr:1 row_mask:0xf bank_mask:0xf
    s_lshr_b64 s[52:53], s[52:53], 1
    v_cndmask_b32_dpp v86, v86, v86, vcc wave_shr:1 row_mask:0xf bank_mask:0xf
    v_cndmask_b32_dpp v87, v87, v87, vcc wave_shr:1 row_mask:0xf bank_mask:0xf
    s_andn2_b64 s[82:83], s[82:83], s[52:53]
    v_cndmask_b32_dpp v7, v7, v7, vcc wave_shr:1 row_mask:0xf bank_mask:0xf
    s_mov_b64 exec, s[50:51]
    s_cbranch_scc0 L2_d76
    s_mov_b64 exec, s[82:83]
    s_nop 1
    v_mfma_f32_4x4x4_16b_bf16 v[88:91], v[12:13], v[84:85], 0
    s_nop 1
    v_mfma_f32_4x4x4_16b_bf16 v[88:91], v[10:11], v[86:87], v[88:91]
    s_nop 4
    v_cvt_pk_bf16_f32 v88, v88, v89
    v_cvt_pk_bf16_f32 v89, v90, v91
    ds_pk_add_bf16 v7, v88 offset:65408
    ds_pk_add_bf16 v7, v89 offset:65412
    s_mov_b64 exec, s[50:51]
    s_branch L2_d76
L2_c77:
    s_lshl_b64 s[52:53], s[82:83], 1
    s_andn2_b64 s[52:53], s[52:53], s[80:81]
    s_andn2_b64 s[52:53], s[52:53], s[54:55]
    s_or_b64 s[80:81], s[80:81], s[52:53]
    s_not_b64 vcc, s[52:53]
    s_mov_b64 exec, -1
    v_cndmask_b32_dpp v84, v84, v84, vcc wave_shr:1 row_mask:0xf bank_mask:0xf
    v_cndmask_b32_dpp v85, v85, v85, vcc wave_shr:1 row_mask:0xf bank_mask:0xf
    s_lshr_b64 s[52:53], s[52:53], 1
    v_cndmask_b32_dpp v86, v86, v86, vcc wave_shr:1 row_mask:0xf bank_mask:0xf
    v_cndmask_b32_dpp v87, v87, v87, vcc wave_shr:1 row_mask:0xf bank_mask:0xf
    s_andn2_b64 s[82:83], s[82:83], s[52:53]
    v_cndmask_b32_dpp v7, v7, v7, vcc wave_shr:1 row_mask:0xf bank_mask:0xf
    s_mov_b64 exec, s[54:55]
    s_cbranch_scc0 L2_d77
    s_mov_b64 exec, s[82:83]
    s_nop 1
    v_mfma_f32_4x4x4_16b_bf16 v[88:91], v[12:13], v[84:85], 0
    s_nop 1
    v_mfma_f32_4x4x4_16b_bf16 v[88:91], v[10:11], v[86:87], v[88:91]
    s_nop 4
    v_cvt_pk_bf16_f32 v88, v88, v89
    v_cvt_pk_bf16_f32 v89, v90, v91
    ds_pk_add_bf16 v7, v88 offset:65408
    ds_pk_add_bf16 v7, v89 offset:65412
    s_mov_b64 exec, s[54:55]
    s_branch L2_d77
L2_c78:
    s_lshl_b64 s[52:53], s[82:83], 1
    s_andn2_b64 s[52:53], s[52:53], s[80:81]
    s_andn2_b64 s[52:53], s[52:53], s[50:51]
    s_or_b64 s[80:81], s[80:81], s[52:53]
    s_not_b64 vcc, s[52:53]
    s_mov_b64 exec, -1
    v_cndmask_b32_dpp v84, v84, v84, vcc wave_shr:1 row_mask:0xf bank_mask:0xf
    v_cndmask_b32_dpp v85, v85, v85, vcc wave_shr:1 row_mask:0xf bank_mask:0xf
    s_lshr_b64 s[52:53], s[52:53], 1
    v_cndmask_b32_dpp v86, v86, v86, vcc wave_shr:1 row_mask:0xf bank_mask:0xf
    v_cndmask_b32_dpp v87, v87, v87, vcc wave_shr:1 row_mask:0xf bank_mask:0xf
    s_andn2_b64 s[82:83], s[82:83], s[52:53]
    v_cndmask_b32_dpp v7, v7, v7, vcc wave_shr:1 row_mask:0xf bank_mask:0xf
    s_mov_b64 exec, s[50:51]
    s_cbranch_scc0 L2_d78
    s_mov_b64 exec, s[82:83]
    s_nop 1
    v_mfma_f32_4x4x4_16b_bf16 v[88:91], v[12:13], v[84:85], 0
    s_nop 1
    v_mfma_f32_4x4x4_16b_bf16 v[88:91], v[10:11], v[86:87], v[88:91]
    s_nop 4
    v_cvt_pk_bf16_f32 v88, v88, v89
    v_cvt_pk_bf16_f32 v89, v90, v91
    ds_pk_add_bf16 v7, v88 offset:65408
    ds_pk_add_bf16 v7, v89 offset:65412
    s_mov_b64 exec, s[50:51]
    s_branch L2_d78
L2_xa79:
    s_cmp_eq_u32 s101, 1
    s_cbranch_scc1 L2_xc79
    v_lshlrev_b32 v89, 0, v96
    v_add_u32 v90, 140, v97
    v_bitop3_b32 v90, v89, v45, v90 bitop3:0x6a
    ds_write_b32 v98, v90 offset:28
    v_lshlrev_b32 v89, 4, v96
    v_add_u32 v90, 120, v97
    v_bitop3_b32 v90, v89, v45, v90 bitop3:0x6a
    ds_write_b32 v98, v90 offset:24
    v_lshlrev_b32 v89, 8, v96
    v_add_u32 v90, 100, v97
    v_bitop3_b32 v90, v89, v45, v90 bitop3:0x6a
    ds_write_b32 v98, v90 offset:20
L2_xc79:
    v_lshlrev_b32 v89, 12, v96
    v_add_u32 v90, 80, v97
    v_bitop3_b32 v90, v89, v45, v90 bitop3:0x6a
    ds_write_b32 v98, v90 offset:16
    s_branch L2_xb79
L2_xe79:
    v_cmp_lt_u32 vcc, 32, v99
    v_cmp_lt_u32 s[58:59], 31, v88
    v_lshrrev_b32 v89, 16, v96
    v_add_u32 v97, 80, v97
    s_or_b64 vcc, vcc, s[58:59]
    s_cbranch_scc1 L2_xs79
    v_lshlrev_b32 v89, v1, v89
    v_and_b32 v89, v45, v89
    v_cmp_ne_u32 vcc, 0, v89
    v_xor_b32 v90, v97, v89
    s_add_u32 s3, s37, s38
    v_mbcnt_lo_u32_b32 v98, vcc_lo, 0
    v_mbcnt_hi_u32_b32 v98, vcc_hi, v98
    s_bcnt1_i32_b64 s41, vcc
    v_lshl_add_u32 v98, v98, 2, s3
    s_lshl2_add_u32 s37, s41, s37
    s_mov_b64 exec, vcc
    ds_write_b32 v98, v90
    s_mov_b64 exec, -1
    s_branch L2_xr79
L2_xs79:
    s_waitcnt lgkmcnt(0)
    s_mov_b32 s37, 0x10000
    s_branch L2_xw79
L2_c80:
    s_lshl_b64 s[52:53], s[82:83], 1
    s_andn2_b64 s[52:53], s[52:53], s[80:81]
    s_andn2_b64 s[52:53], s[52:53], s[54:55]
    s_or_b64 s[80:81], s[80:81], s[52:53]
    s_not_b64 vcc, s[52:53]
    s_mov_b64 exec, -1
    v_cndmask_b32_dpp v84, v84, v84, vcc wave_shr:1 row_mask:0xf bank_mask:0xf
    v_cndmask_b32_dpp v85, v85, v85, vcc wave_shr:1 row_mask:0xf bank_mask:0xf
    s_lshr_b64 s[52:53], s[52:53], 1
    v_cndmask_b32_dpp v86, v86, v86, vcc wave_shr:1 row_mask:0xf bank_mask:0xf
    v_cndmask_b32_dpp v87, v87, v87, vcc wave_shr:1 row_mask:0xf bank_mask:0xf
    s_andn2_b64 s[82:83], s[82:83], s[52:53]
    v_cndmask_b32_dpp v7, v7, v7, vcc wave_shr:1 row_mask:0xf bank_mask:0xf
    s_mov_b64 exec, s[54:55]
    s_cbranch_scc0 L2_d80
    s_mov_b64 exec, s[82:83]
    s_nop 1
    v_mfma_f32_4x4x4_16b_bf16 v[88:91], v[12:13], v[84:85], 0
    s_nop 1
    v_mfma_f32_4x4x4_16b_bf16 v[88:91], v[10:11], v[86:87], v[88:91]
    s_nop 4
    v_cvt_pk_bf16_f32 v88, v88, v89
    v_cvt_pk_bf16_f32 v89, v90, v91
    ds_pk_add_bf16 v7, v88 offset:65408
    ds_pk_add_bf16 v7, v89 offset:65412
    s_mov_b64 exec, s[54:55]
    s_branch L2_d80
L2_c81:
    s_lshl_b64 s[52:53], s[82:83], 1
    s_andn2_b64 s[52:53], s[52:53], s[80:81]
    s_andn2_b64 s[52:53], s[52:53], s[50:51]
    s_or_b64 s[80:81], s[80:81], s[52:53]
    s_not_b64 vcc, s[52:53]
    s_mov_b64 exec, -1
    v_cndmask_b32_dpp v84, v84, v84, vcc wave_shr:1 row_mask:0xf bank_mask:0xf
    v_cndmask_b32_dpp v85, v85, v85, vcc wave_shr:1 row_mask:0xf bank_mask:0xf
    s_lshr_b64 s[52:53], s[52:53], 1
    v_cndmask_b32_dpp v86, v86, v86, vcc wave_shr:1 row_mask:0xf bank_mask:0xf
    v_cndmask_b32_dpp v87, v87, v87, vcc wave_shr:1 row_mask:0xf bank_mask:0xf
    s_andn2_b64 s[82:83], s[82:83], s[52:53]
    v_cndmask_b32_dpp v7, v7, v7, vcc wave_shr:1 row_mask:0xf bank_mask:0xf
    s_mov_b64 exec, s[50:51]
    s_cbranch_scc0 L2_d81
    s_mov_b64 exec, s[82:83]
    s_nop 1
    v_mfma_f32_4x4x4_16b_bf16 v[88:91], v[12:13], v[84:85], 0
    s_nop 1
    v_mfma_f32_4x4x4_16b_bf16 v[88:91], v[10:11], v[86:87], v[88:91]
    s_nop 4
    v_cvt_pk_bf16_f32 v88, v88, v89
    v_cvt_pk_bf16_f32 v89, v90, v91
    ds_pk_add_bf16 v7, v88 offset:65408
    ds_pk_add_bf16 v7, v89 offset:65412
    s_mov_b64 exec, s[50:51]
    s_branch L2_d81
L2_xf79:
    s_cmp_gt_u32 s37, 1024
    s_cbranch_scc1 L2_xt79
    s_cmp_lt_u32 s37, 768
    s_cbranch_scc1 L2_xl79
    ds_read_b32 v21, v44 offset:896
    s_add_u32 s3, s42, 2
    s_bitset1_b32 s43, s3
    s_branch L2_xg79
L2_xl79:
    s_waitcnt lgkmcnt(0)
    v_mov_b32 v40, -1
    s_cmp_ge_u32 s37, 512
    s_cbranch_scc1 L2_xg79
    v_mov_b32 v43, -1
    s_cmp_ge_u32 s37, 256
    s_cbranch_scc1 L2_xg79
    v_mov_b32 v42, -1
    s_branch L2_xg79
L2_xt79:
    s_waitcnt lgkmcnt(0)
    v_mov_b32 v41, -1
    v_mov_b32 v42, -1
    v_mov_b32 v43, -1
    v_mov_b32 v40, -1
    s_add_u32 s3, s42, 2
    s_bitset1_b32 s36, s3
    s_branch L2_xg79
L2_oa82:
    v_and_b32 v47, 0x0fffffff, v20
    buffer_load_dword v114, v47, s[8:11], 0 offen offset:16
    s_mov_b64 exec, s[6:7]
    v_add_u32 v47, 8, v47
    v_lshrrev_b32 v20, 2, v20
    s_mov_b64 exec, -1
    buffer_load_dwordx2 v[112:113], v47, s[8:11], 0 offen
    s_branch L2_ob82
L2_c83:
    s_lshl_b64 s[52:53], s[82:83], 1
    s_andn2_b64 s[52:53], s[52:53], s[80:81]
    s_andn2_b64 s[52:53], s[52:53], s[54:55]
    s_or_b64 s[80:81], s[80:81], s[52:53]
    s_not_b64 vcc, s[52:53]
    s_mov_b64 exec, -1
    v_cndmask_b32_dpp v84, v84, v84, vcc wave_shr:1 row_mask:0xf bank_mask:0xf
    v_cndmask_b32_dpp v85, v85, v85, vcc wave_shr:1 row_mask:0xf bank_mask:0xf
    s_lshr_b64 s[52:53], s[52:53], 1
    v_cndmask_b32_dpp v86, v86, v86, vcc wave_shr:1 row_mask:0xf bank_mask:0xf
    v_cndmask_b32_dpp v87, v87, v87, vcc wave_shr:1 row_mask:0xf bank_mask:0xf
    s_andn2_b64 s[82:83], s[82:83], s[52:53]
    v_cndmask_b32_dpp v7, v7, v7, vcc wave_shr:1 row_mask:0xf bank_mask:0xf
    s_mov_b64 exec, s[54:55]
    s_cbranch_scc0 L2_d83
    s_mov_b64 exec, s[82:83]
    s_nop 1
    v_mfma_f32_4x4x4_16b_bf16 v[88:91], v[12:13], v[84:85], 0
    s_nop 1
    v_mfma_f32_4x4x4_16b_bf16 v[88:91], v[10:11], v[86:87], v[88:91]
    s_nop 4
    v_cvt_pk_bf16_f32 v88, v88, v89
    v_cvt_pk_bf16_f32 v89, v90, v91
    ds_pk_add_bf16 v7, v88 offset:65408
    ds_pk_add_bf16 v7, v89 offset:65412
    s_mov_b64 exec, s[54:55]
    s_branch L2_d83
L2_c84:
    s_lshl_b64 s[52:53], s[82:83], 1
    s_andn2_b64 s[52:53], s[52:53], s[80:81]
    s_andn2_b64 s[52:53], s[52:53], s[50:51]
    s_or_b64 s[80:81], s[80:81], s[52:53]
    s_not_b64 vcc, s[52:53]
    s_mov_b64 exec, -1
    v_cndmask_b32_dpp v84, v84, v84, vcc wave_shr:1 row_mask:0xf bank_mask:0xf
    v_cndmask_b32_dpp v85, v85, v85, vcc wave_shr:1 row_mask:0xf bank_mask:0xf
    s_lshr_b64 s[52:53], s[52:53], 1
    v_cndmask_b32_dpp v86, v86, v86, vcc wave_shr:1 row_mask:0xf bank_mask:0xf
    v_cndmask_b32_dpp v87, v87, v87, vcc wave_shr:1 row_mask:0xf bank_mask:0xf
    s_andn2_b64 s[82:83], s[82:83], s[52:53]
    v_cndmask_b32_dpp v7, v7, v7, vcc wave_shr:1 row_mask:0xf bank_mask:0xf
    s_mov_b64 exec, s[50:51]
    s_cbranch_scc0 L2_d84
    s_mov_b64 exec, s[82:83]
    s_nop 1
    v_mfma_f32_4x4x4_16b_bf16 v[88:91], v[12:13], v[84:85], 0
    s_nop 1
    v_mfma_f32_4x4x4_16b_bf16 v[88:91], v[10:11], v[86:87], v[88:91]
    s_nop 4
    v_cvt_pk_bf16_f32 v88, v88, v89
    v_cvt_pk_bf16_f32 v89, v90, v91
    ds_pk_add_bf16 v7, v88 offset:65408
    ds_pk_add_bf16 v7, v89 offset:65412
    s_mov_b64 exec, s[50:51]
    s_branch L2_d84
L2_c85:
    s_lshl_b64 s[52:53], s[82:83], 1
    s_andn2_b64 s[52:53], s[52:53], s[80:81]
    s_andn2_b64 s[52:53], s[52:53], s[54:55]
    s_or_b64 s[80:81], s[80:81], s[52:53]
    s_not_b64 vcc, s[52:53]
    s_mov_b64 exec, -1
    v_cndmask_b32_dpp v84, v84, v84, vcc wave_shr:1 row_mask:0xf bank_mask:0xf
    v_cndmask_b32_dpp v85, v85, v85, vcc wave_shr:1 row_mask:0xf bank_mask:0xf
    s_lshr_b64 s[52:53], s[52:53], 1
    v_cndmask_b32_dpp v86, v86, v86, vcc wave_shr:1 row_mask:0xf bank_mask:0xf
    v_cndmask_b32_dpp v87, v87, v87, vcc wave_shr:1 row_mask:0xf bank_mask:0xf
    s_andn2_b64 s[82:83], s[82:83], s[52:53]
    v_cndmask_b32_dpp v7, v7, v7, vcc wave_shr:1 row_mask:0xf bank_mask:0xf
    s_mov_b64 exec, s[54:55]
    s_cbranch_scc0 L2_d85
    s_mov_b64 exec, s[82:83]
    s_nop 1
    v_mfma_f32_4x4x4_16b_bf16 v[88:91], v[12:13], v[84:85], 0
    s_nop 1
    v_mfma_f32_4x4x4_16b_bf16 v[88:91], v[10:11], v[86:87], v[88:91]
    s_nop 4
    v_cvt_pk_bf16_f32 v88, v88, v89
    v_cvt_pk_bf16_f32 v89, v90, v91
    ds_pk_add_bf16 v7, v88 offset:65408
    ds_pk_add_bf16 v7, v89 offset:65412
    s_mov_b64 exec, s[54:55]
    s_branch L2_d85
L2_c86:
    s_lshl_b64 s[52:53], s[82:83], 1
    s_andn2_b64 s[52:53], s[52:53], s[80:81]
    s_andn2_b64 s[52:53], s[52:53], s[50:51]
    s_or_b64 s[80:81], s[80:81], s[52:53]
    s_not_b64 vcc, s[52:53]
    s_mov_b64 exec, -1
    v_cndmask_b32_dpp v84, v84, v84, vcc wave_shr:1 row_mask:0xf bank_mask:0xf
    v_cndmask_b32_dpp v85, v85, v85, vcc wave_shr:1 row_mask:0xf bank_mask:0xf
    s_lshr_b64 s[52:53], s[52:53], 1
    v_cndmask_b32_dpp v86, v86, v86, vcc wave_shr:1 row_mask:0xf bank_mask:0xf
    v_cndmask_b32_dpp v87, v87, v87, vcc wave_shr:1 row_mask:0xf bank_mask:0xf
    s_andn2_b64 s[82:83], s[82:83], s[52:53]
    v_cndmask_b32_dpp v7, v7, v7, vcc wave_shr:1 row_mask:0xf bank_mask:0xf
    s_mov_b64 exec, s[50:51]
    s_cbranch_scc0 L2_d86
    s_mov_b64 exec, s[82:83]
    s_nop 1
    v_mfma_f32_4x4x4_16b_bf16 v[88:91], v[12:13], v[84:85], 0
    s_nop 1
    v_mfma_f32_4x4x4_16b_bf16 v[88:91], v[10:11], v[86:87], v[88:91]
    s_nop 4
    v_cvt_pk_bf16_f32 v88, v88, v89
    v_cvt_pk_bf16_f32 v89, v90, v91
    ds_pk_add_bf16 v7, v88 offset:65408
    ds_pk_add_bf16 v7, v89 offset:65412
    s_mov_b64 exec, s[50:51]
    s_branch L2_d86
L2_c87:
    s_lshl_b64 s[52:53], s[82:83], 1
    s_andn2_b64 s[52:53], s[52:53], s[80:81]
    s_andn2_b64 s[52:53], s[52:53], s[54:55]
    s_or_b64 s[80:81], s[80:81], s[52:53]
    s_not_b64 vcc, s[52:53]
    s_mov_b64 exec, -1
    v_cndmask_b32_dpp v84, v84, v84, vcc wave_shr:1 row_mask:0xf bank_mask:0xf
    v_cndmask_b32_dpp v85, v85, v85, vcc wave_shr:1 row_mask:0xf bank_mask:0xf
    s_lshr_b64 s[52:53], s[52:53], 1
    v_cndmask_b32_dpp v86, v86, v86, vcc wave_shr:1 row_mask:0xf bank_mask:0xf
    v_cndmask_b32_dpp v87, v87, v87, vcc wave_shr:1 row_mask:0xf bank_mask:0xf
    s_andn2_b64 s[82:83], s[82:83], s[52:53]
    v_cndmask_b32_dpp v7, v7, v7, vcc wave_shr:1 row_mask:0xf bank_mask:0xf
    s_mov_b64 exec, s[54:55]
    s_cbranch_scc0 L2_d87
    s_mov_b64 exec, s[82:83]
    s_nop 1
    v_mfma_f32_4x4x4_16b_bf16 v[88:91], v[12:13], v[84:85], 0
    s_nop 1
    v_mfma_f32_4x4x4_16b_bf16 v[88:91], v[10:11], v[86:87], v[88:91]
    s_nop 4
    v_cvt_pk_bf16_f32 v88, v88, v89
    v_cvt_pk_bf16_f32 v89, v90, v91
    ds_pk_add_bf16 v7, v88 offset:65408
    ds_pk_add_bf16 v7, v89 offset:65412
    s_mov_b64 exec, s[54:55]
    s_branch L2_d87
L2_c88:
    s_lshl_b64 s[52:53], s[82:83], 1
    s_andn2_b64 s[52:53], s[52:53], s[80:81]
    s_andn2_b64 s[52:53], s[52:53], s[50:51]
    s_or_b64 s[80:81], s[80:81], s[52:53]
    s_not_b64 vcc, s[52:53]
    s_mov_b64 exec, -1
    v_cndmask_b32_dpp v84, v84, v84, vcc wave_shr:1 row_mask:0xf bank_mask:0xf
    v_cndmask_b32_dpp v85, v85, v85, vcc wave_shr:1 row_mask:0xf bank_mask:0xf
    s_lshr_b64 s[52:53], s[52:53], 1
    v_cndmask_b32_dpp v86, v86, v86, vcc wave_shr:1 row_mask:0xf bank_mask:0xf
    v_cndmask_b32_dpp v87, v87, v87, vcc wave_shr:1 row_mask:0xf bank_mask:0xf
    s_andn2_b64 s[82:83], s[82:83], s[52:53]
    v_cndmask_b32_dpp v7, v7, v7, vcc wave_shr:1 row_mask:0xf bank_mask:0xf
    s_mov_b64 exec, s[50:51]
    s_cbranch_scc0 L2_d88
    s_mov_b64 exec, s[82:83]
    s_nop 1
    v_mfma_f32_4x4x4_16b_bf16 v[88:91], v[12:13], v[84:85], 0
    s_nop 1
    v_mfma_f32_4x4x4_16b_bf16 v[88:91], v[10:11], v[86:87], v[88:91]
    s_nop 4
    v_cvt_pk_bf16_f32 v88, v88, v89
    v_cvt_pk_bf16_f32 v89, v90, v91
    ds_pk_add_bf16 v7, v88 offset:65408
    ds_pk_add_bf16 v7, v89 offset:65412
    s_mov_b64 exec, s[50:51]
    s_branch L2_d88
L2_c89:
    s_lshl_b64 s[52:53], s[82:83], 1
    s_andn2_b64 s[52:53], s[52:53], s[80:81]
    s_andn2_b64 s[52:53], s[52:53], s[54:55]
    s_or_b64 s[80:81], s[80:81], s[52:53]
    s_not_b64 vcc, s[52:53]
    s_mov_b64 exec, -1
    v_cndmask_b32_dpp v84, v84, v84, vcc wave_shr:1 row_mask:0xf bank_mask:0xf
    v_cndmask_b32_dpp v85, v85, v85, vcc wave_shr:1 row_mask:0xf bank_mask:0xf
    s_lshr_b64 s[52:53], s[52:53], 1
    v_cndmask_b32_dpp v86, v86, v86, vcc wave_shr:1 row_mask:0xf bank_mask:0xf
    v_cndmask_b32_dpp v87, v87, v87, vcc wave_shr:1 row_mask:0xf bank_mask:0xf
    s_andn2_b64 s[82:83], s[82:83], s[52:53]
    v_cndmask_b32_dpp v7, v7, v7, vcc wave_shr:1 row_mask:0xf bank_mask:0xf
    s_mov_b64 exec, s[54:55]
    s_cbranch_scc0 L2_d89
    s_mov_b64 exec, s[82:83]
    s_nop 1
    v_mfma_f32_4x4x4_16b_bf16 v[88:91], v[12:13], v[84:85], 0
    s_nop 1
    v_mfma_f32_4x4x4_16b_bf16 v[88:91], v[10:11], v[86:87], v[88:91]
    s_nop 4
    v_cvt_pk_bf16_f32 v88, v88, v89
    v_cvt_pk_bf16_f32 v89, v90, v91
    ds_pk_add_bf16 v7, v88 offset:65408
    ds_pk_add_bf16 v7, v89 offset:65412
    s_mov_b64 exec, s[54:55]
    s_branch L2_d89
L2_c90:
    s_lshl_b64 s[52:53], s[82:83], 1
    s_andn2_b64 s[52:53], s[52:53], s[80:81]
    s_andn2_b64 s[52:53], s[52:53], s[50:51]
    s_or_b64 s[80:81], s[80:81], s[52:53]
    s_not_b64 vcc, s[52:53]
    s_mov_b64 exec, -1
    v_cndmask_b32_dpp v84, v84, v84, vcc wave_shr:1 row_mask:0xf bank_mask:0xf
    v_cndmask_b32_dpp v85, v85, v85, vcc wave_shr:1 row_mask:0xf bank_mask:0xf
    s_lshr_b64 s[52:53], s[52:53], 1
    v_cndmask_b32_dpp v86, v86, v86, vcc wave_shr:1 row_mask:0xf bank_mask:0xf
    v_cndmask_b32_dpp v87, v87, v87, vcc wave_shr:1 row_mask:0xf bank_mask:0xf
    s_andn2_b64 s[82:83], s[82:83], s[52:53]
    v_cndmask_b32_dpp v7, v7, v7, vcc wave_shr:1 row_mask:0xf bank_mask:0xf
    s_mov_b64 exec, s[50:51]
    s_cbranch_scc0 L2_d90
    s_mov_b64 exec, s[82:83]
    s_nop 1
    v_mfma_f32_4x4x4_16b_bf16 v[88:91], v[12:13], v[84:85], 0
    s_nop 1
    v_mfma_f32_4x4x4_16b_bf16 v[88:91], v[10:11], v[86:87], v[88:91]
    s_nop 4
    v_cvt_pk_bf16_f32 v88, v88, v89
    v_cvt_pk_bf16_f32 v89, v90, v91
    ds_pk_add_bf16 v7, v88 offset:65408
    ds_pk_add_bf16 v7, v89 offset:65412
    s_mov_b64 exec, s[50:51]
    s_branch L2_d90
L2_oa91:
    s_waitcnt vmcnt(5)
    s_mov_b64 exec, s[6:7]
    v_lshrrev_b32 v114, 16, v114
    s_mov_b64 exec, -1
    v_and_b32 v46, 0x10000000, v20
    v_cmpx_eq_u32 vcc, 0, v46
    v_lshrrev_b32 v47, 14, v112
    v_and_b32 v47, v5, v47
    ds_read_b64 v[96:97], v47
    v_perm_b32 v98, v112, v114, s44
    v_bitop3_b32 v99, v112, 0.5, -0.5 bitop3:0xa8
    v_bitop3_b32 v98, v6, v98, v99 bitop3:0xca
    v_and_b32 v47, v5, v112
    s_waitcnt lgkmcnt(0)
    v_mfma_f32_4x4x4_16b_bf16 v[88:91], v[8:9], v[96:97], 0
    s_nop 4
    v_mul_f32 v88, v98, v88
    v_mul_f32 v89, v98, v89
    v_mul_f32 v90, v98, v90
    v_mul_f32 v91, v98, v91
    v_cvt_pk_bf16_f32 v88, v88, v89
    v_cvt_pk_bf16_f32 v89, v90, v91
    ds_pk_add_bf16 v47, v88 offset:65408
    ds_pk_add_bf16 v47, v89 offset:65412
    s_mov_b64 exec, -1
    v_and_b32 v46, 0x20000000, v20
    v_cmpx_eq_u32 vcc, 0, v46
    v_lshrrev_b32 v47, 14, v113
    v_and_b32 v47, v5, v47
    ds_read_b64 v[96:97], v47
    v_perm_b32 v98, v113, v114, s45
    v_bitop3_b32 v99, v113, 0.5, -0.5 bitop3:0xa8
    v_bitop3_b32 v98, v6, v98, v99 bitop3:0xca
    v_and_b32 v47, v5, v113
    s_waitcnt lgkmcnt(0)
    v_mfma_f32_4x4x4_16b_bf16 v[88:91], v[8:9], v[96:97], 0
    s_nop 4
    v_mul_f32 v88, v98, v88
    v_mul_f32 v89, v98, v89
    v_mul_f32 v90, v98, v90
    v_mul_f32 v91, v98, v91
    v_cvt_pk_bf16_f32 v88, v88, v89
    v_cvt_pk_bf16_f32 v89, v90, v91
    ds_pk_add_bf16 v47, v88 offset:65408
    ds_pk_add_bf16 v47, v89 offset:65412
    s_mov_b64 exec, -1
    s_branch L2_ob91
L2_xo92:
    v_cmp_lt_u32 vcc, 20, v99
    s_mov_b32 s101, 1
    s_cbranch_vccz L2_xp92
    v_cmp_lt_u32 vcc, 32, v99
    v_cmp_lt_u32 s[58:59], 31, v88
    s_mov_b32 s101, 2
    s_or_b64 vcc, vcc, s[58:59]
    s_cbranch_scc0 L2_xp92
    s_mov_b32 s37, 0x10000
    s_branch L2_xp92
L2_c93:
    s_lshl_b64 s[52:53], s[82:83], 1
    s_andn2_b64 s[52:53], s[52:53], s[80:81]
    s_andn2_b64 s[52:53], s[52:53], s[54:55]
    s_or_b64 s[80:81], s[80:81], s[52:53]
    s_not_b64 vcc, s[52:53]
    s_mov_b64 exec, -1
    v_cndmask_b32_dpp v84, v84, v84, vcc wave_shr:1 row_mask:0xf bank_mask:0xf
    v_cndmask_b32_dpp v85, v85, v85, vcc wave_shr:1 row_mask:0xf bank_mask:0xf
    s_lshr_b64 s[52:53], s[52:53], 1
    v_cndmask_b32_dpp v86, v86, v86, vcc wave_shr:1 row_mask:0xf bank_mask:0xf
    v_cndmask_b32_dpp v87, v87, v87, vcc wave_shr:1 row_mask:0xf bank_mask:0xf
    s_andn2_b64 s[82:83], s[82:83], s[52:53]
    v_cndmask_b32_dpp v7, v7, v7, vcc wave_shr:1 row_mask:0xf bank_mask:0xf
    s_mov_b64 exec, s[54:55]
    s_cbranch_scc0 L2_d93
    s_mov_b64 exec, s[82:83]
    s_nop 1
    v_mfma_f32_4x4x4_16b_bf16 v[88:91], v[12:13], v[84:85], 0
    s_nop 1
    v_mfma_f32_4x4x4_16b_bf16 v[88:91], v[10:11], v[86:87], v[88:91]
    s_nop 4
    v_cvt_pk_bf16_f32 v88, v88, v89
    v_cvt_pk_bf16_f32 v89, v90, v91
    ds_pk_add_bf16 v7, v88 offset:65408
    ds_pk_add_bf16 v7, v89 offset:65412
    s_mov_b64 exec, s[54:55]
    s_branch L2_d93
L2_c94:
    s_lshl_b64 s[52:53], s[82:83], 1
    s_andn2_b64 s[52:53], s[52:53], s[80:81]
    s_andn2_b64 s[52:53], s[52:53], s[50:51]
    s_or_b64 s[80:81], s[80:81], s[52:53]
    s_not_b64 vcc, s[52:53]
    s_mov_b64 exec, -1
    v_cndmask_b32_dpp v84, v84, v84, vcc wave_shr:1 row_mask:0xf bank_mask:0xf
    v_cndmask_b32_dpp v85, v85, v85, vcc wave_shr:1 row_mask:0xf bank_mask:0xf
    s_lshr_b64 s[52:53], s[52:53], 1
    v_cndmask_b32_dpp v86, v86, v86, vcc wave_shr:1 row_mask:0xf bank_mask:0xf
    v_cndmask_b32_dpp v87, v87, v87, vcc wave_shr:1 row_mask:0xf bank_mask:0xf
    s_andn2_b64 s[82:83], s[82:83], s[52:53]
    v_cndmask_b32_dpp v7, v7, v7, vcc wave_shr:1 row_mask:0xf bank_mask:0xf
    s_mov_b64 exec, s[50:51]
    s_cbranch_scc0 L2_d94
    s_mov_b64 exec, s[82:83]
    s_nop 1
    v_mfma_f32_4x4x4_16b_bf16 v[88:91], v[12:13], v[84:85], 0
    s_nop 1
    v_mfma_f32_4x4x4_16b_bf16 v[88:91], v[10:11], v[86:87], v[88:91]
    s_nop 4
    v_cvt_pk_bf16_f32 v88, v88, v89
    v_cvt_pk_bf16_f32 v89, v90, v91
    ds_pk_add_bf16 v7, v88 offset:65408
    ds_pk_add_bf16 v7, v89 offset:65412
    s_mov_b64 exec, s[50:51]
    s_branch L2_d94
L2_c95:
    s_lshl_b64 s[52:53], s[82:83], 1
    s_andn2_b64 s[52:53], s[52:53], s[80:81]
    s_andn2_b64 s[52:53], s[52:53], s[54:55]
    s_or_b64 s[80:81], s[80:81], s[52:53]
    s_not_b64 vcc, s[52:53]
    s_mov_b64 exec, -1
    v_cndmask_b32_dpp v84, v84, v84, vcc wave_shr:1 row_mask:0xf bank_mask:0xf
    v_cndmask_b32_dpp v85, v85, v85, vcc wave_shr:1 row_mask:0xf bank_mask:0xf
    s_lshr_b64 s[52:53], s[52:53], 1
    v_cndmask_b32_dpp v86, v86, v86, vcc wave_shr:1 row_mask:0xf bank_mask:0xf
    v_cndmask_b32_dpp v87, v87, v87, vcc wave_shr:1 row_mask:0xf bank_mask:0xf
    s_andn2_b64 s[82:83], s[82:83], s[52:53]
    v_cndmask_b32_dpp v7, v7, v7, vcc wave_shr:1 row_mask:0xf bank_mask:0xf
    s_mov_b64 exec, s[54:55]
    s_cbranch_scc0 L2_d95
    s_mov_b64 exec, s[82:83]
    s_nop 1
    v_mfma_f32_4x4x4_16b_bf16 v[88:91], v[12:13], v[84:85], 0
    s_nop 1
    v_mfma_f32_4x4x4_16b_bf16 v[88:91], v[10:11], v[86:87], v[88:91]
    s_nop 4
    v_cvt_pk_bf16_f32 v88, v88, v89
    v_cvt_pk_bf16_f32 v89, v90, v91
    ds_pk_add_bf16 v7, v88 offset:65408
    ds_pk_add_bf16 v7, v89 offset:65412
    s_mov_b64 exec, s[54:55]
    s_branch L2_d95
L2_c96:
    s_lshl_b64 s[52:53], s[82:83], 1
    s_andn2_b64 s[52:53], s[52:53], s[80:81]
    s_andn2_b64 s[52:53], s[52:53], s[50:51]
    s_or_b64 s[80:81], s[80:81], s[52:53]
    s_not_b64 vcc, s[52:53]
    s_mov_b64 exec, -1
    v_cndmask_b32_dpp v84, v84, v84, vcc wave_shr:1 row_mask:0xf bank_mask:0xf
    v_cndmask_b32_dpp v85, v85, v85, vcc wave_shr:1 row_mask:0xf bank_mask:0xf
    s_lshr_b64 s[52:53], s[52:53], 1
    v_cndmask_b32_dpp v86, v86, v86, vcc wave_shr:1 row_mask:0xf bank_mask:0xf
    v_cndmask_b32_dpp v87, v87, v87, vcc wave_shr:1 row_mask:0xf bank_mask:0xf
    s_andn2_b64 s[82:83], s[82:83], s[52:53]
    v_cndmask_b32_dpp v7, v7, v7, vcc wave_shr:1 row_mask:0xf bank_mask:0xf
    s_mov_b64 exec, s[50:51]
    s_cbranch_scc0 L2_d96
    s_mov_b64 exec, s[82:83]
    s_nop 1
    v_mfma_f32_4x4x4_16b_bf16 v[88:91], v[12:13], v[84:85], 0
    s_nop 1
    v_mfma_f32_4x4x4_16b_bf16 v[88:91], v[10:11], v[86:87], v[88:91]
    s_nop 4
    v_cvt_pk_bf16_f32 v88, v88, v89
    v_cvt_pk_bf16_f32 v89, v90, v91
    ds_pk_add_bf16 v7, v88 offset:65408
    ds_pk_add_bf16 v7, v89 offset:65412
    s_mov_b64 exec, s[50:51]
    s_branch L2_d96
L2_xa97:
    s_cmp_eq_u32 s101, 1
    s_cbranch_scc1 L2_xc97
    v_lshlrev_b32 v89, 0, v96
    v_add_u32 v90, 140, v97
    v_bitop3_b32 v90, v89, v45, v90 bitop3:0x6a
    ds_write_b32 v98, v90 offset:28
    v_lshlrev_b32 v89, 4, v96
    v_add_u32 v90, 120, v97
    v_bitop3_b32 v90, v89, v45, v90 bitop3:0x6a
    ds_write_b32 v98, v90 offset:24
    v_lshlrev_b32 v89, 8, v96
    v_add_u32 v90, 100, v97
    v_bitop3_b32 v90, v89, v45, v90 bitop3:0x6a
    ds_write_b32 v98, v90 offset:20
L2_xc97:
    v_lshlrev_b32 v89, 12, v96
    v_add_u32 v90, 80, v97
    v_bitop3_b32 v90, v89, v45, v90 bitop3:0x6a
    ds_write_b32 v98, v90 offset:16
    s_branch L2_xb97
L2_xe97:
    v_cmp_lt_u32 vcc, 32, v99
    v_cmp_lt_u32 s[58:59], 31, v88
    v_lshrrev_b32 v89, 16, v96
    v_add_u32 v97, 80, v97
    s_or_b64 vcc, vcc, s[58:59]
    s_cbranch_scc1 L2_xs97
    v_lshlrev_b32 v89, v1, v89
    v_and_b32 v89, v45, v89
    v_cmp_ne_u32 vcc, 0, v89
    v_xor_b32 v90, v97, v89
    s_add_u32 s3, s37, s38
    v_mbcnt_lo_u32_b32 v98, vcc_lo, 0
    v_mbcnt_hi_u32_b32 v98, vcc_hi, v98
    s_bcnt1_i32_b64 s41, vcc
    v_lshl_add_u32 v98, v98, 2, s3
    s_lshl2_add_u32 s37, s41, s37
    s_mov_b64 exec, vcc
    ds_write_b32 v98, v90
    s_mov_b64 exec, -1
    s_branch L2_xr97
L2_xs97:
    s_waitcnt lgkmcnt(0)
    s_mov_b32 s37, 0x10000
    s_branch L2_xw97
L2_c98:
    s_lshl_b64 s[52:53], s[82:83], 1
    s_andn2_b64 s[52:53], s[52:53], s[80:81]
    s_andn2_b64 s[52:53], s[52:53], s[54:55]
    s_or_b64 s[80:81], s[80:81], s[52:53]
    s_not_b64 vcc, s[52:53]
    s_mov_b64 exec, -1
    v_cndmask_b32_dpp v84, v84, v84, vcc wave_shr:1 row_mask:0xf bank_mask:0xf
    v_cndmask_b32_dpp v85, v85, v85, vcc wave_shr:1 row_mask:0xf bank_mask:0xf
    s_lshr_b64 s[52:53], s[52:53], 1
    v_cndmask_b32_dpp v86, v86, v86, vcc wave_shr:1 row_mask:0xf bank_mask:0xf
    v_cndmask_b32_dpp v87, v87, v87, vcc wave_shr:1 row_mask:0xf bank_mask:0xf
    s_andn2_b64 s[82:83], s[82:83], s[52:53]
    v_cndmask_b32_dpp v7, v7, v7, vcc wave_shr:1 row_mask:0xf bank_mask:0xf
    s_mov_b64 exec, s[54:55]
    s_cbranch_scc0 L2_d98
    s_mov_b64 exec, s[82:83]
    s_nop 1
    v_mfma_f32_4x4x4_16b_bf16 v[88:91], v[12:13], v[84:85], 0
    s_nop 1
    v_mfma_f32_4x4x4_16b_bf16 v[88:91], v[10:11], v[86:87], v[88:91]
    s_nop 4
    v_cvt_pk_bf16_f32 v88, v88, v89
    v_cvt_pk_bf16_f32 v89, v90, v91
    ds_pk_add_bf16 v7, v88 offset:65408
    ds_pk_add_bf16 v7, v89 offset:65412
    s_mov_b64 exec, s[54:55]
    s_branch L2_d98
L2_c99:
    s_lshl_b64 s[52:53], s[82:83], 1
    s_andn2_b64 s[52:53], s[52:53], s[80:81]
    s_andn2_b64 s[52:53], s[52:53], s[50:51]
    s_or_b64 s[80:81], s[80:81], s[52:53]
    s_not_b64 vcc, s[52:53]
    s_mov_b64 exec, -1
    v_cndmask_b32_dpp v84, v84, v84, vcc wave_shr:1 row_mask:0xf bank_mask:0xf
    v_cndmask_b32_dpp v85, v85, v85, vcc wave_shr:1 row_mask:0xf bank_mask:0xf
    s_lshr_b64 s[52:53], s[52:53], 1
    v_cndmask_b32_dpp v86, v86, v86, vcc wave_shr:1 row_mask:0xf bank_mask:0xf
    v_cndmask_b32_dpp v87, v87, v87, vcc wave_shr:1 row_mask:0xf bank_mask:0xf
    s_andn2_b64 s[82:83], s[82:83], s[52:53]
    v_cndmask_b32_dpp v7, v7, v7, vcc wave_shr:1 row_mask:0xf bank_mask:0xf
    s_mov_b64 exec, s[50:51]
    s_cbranch_scc0 L2_d99
    s_mov_b64 exec, s[82:83]
    s_nop 1
    v_mfma_f32_4x4x4_16b_bf16 v[88:91], v[12:13], v[84:85], 0
    s_nop 1
    v_mfma_f32_4x4x4_16b_bf16 v[88:91], v[10:11], v[86:87], v[88:91]
    s_nop 4
    v_cvt_pk_bf16_f32 v88, v88, v89
    v_cvt_pk_bf16_f32 v89, v90, v91
    ds_pk_add_bf16 v7, v88 offset:65408
    ds_pk_add_bf16 v7, v89 offset:65412
    s_mov_b64 exec, s[50:51]
    s_branch L2_d99
L2_xf97:
    s_cmp_gt_u32 s37, 1024
    s_cbranch_scc1 L2_xt97
    s_cmp_lt_u32 s37, 768
    s_cbranch_scc1 L2_xl97
    ds_read_b32 v20, v44 offset:896
    s_add_u32 s3, s42, 2
    s_bitset1_b32 s43, s3
    s_branch L2_xg97
L2_xl97:
    s_waitcnt lgkmcnt(0)
    v_mov_b32 v19, -1
    s_cmp_ge_u32 s37, 512
    s_cbranch_scc1 L2_xg97
    v_mov_b32 v39, -1
    s_cmp_ge_u32 s37, 256
    s_cbranch_scc1 L2_xg97
    v_mov_b32 v33, -1
    s_branch L2_xg97
L2_xt97:
    s_waitcnt lgkmcnt(0)
    v_mov_b32 v27, -1
    v_mov_b32 v33, -1
    v_mov_b32 v39, -1
    v_mov_b32 v19, -1
    s_add_u32 s3, s42, 2
    s_bitset1_b32 s36, s3
    s_branch L2_xg97
L2_oa100:
    v_and_b32 v47, 0x0fffffff, v21
    buffer_load_dword v114, v47, s[8:11], 0 offen offset:16
    s_mov_b64 exec, s[6:7]
    v_add_u32 v47, 8, v47
    v_lshrrev_b32 v21, 2, v21
    s_mov_b64 exec, -1
    buffer_load_dwordx2 v[112:113], v47, s[8:11], 0 offen
    s_branch L2_ob100
L2_c101:
    s_lshl_b64 s[52:53], s[82:83], 1
    s_andn2_b64 s[52:53], s[52:53], s[80:81]
    s_andn2_b64 s[52:53], s[52:53], s[54:55]
    s_or_b64 s[80:81], s[80:81], s[52:53]
    s_not_b64 vcc, s[52:53]
    s_mov_b64 exec, -1
    v_cndmask_b32_dpp v84, v84, v84, vcc wave_shr:1 row_mask:0xf bank_mask:0xf
    v_cndmask_b32_dpp v85, v85, v85, vcc wave_shr:1 row_mask:0xf bank_mask:0xf
    s_lshr_b64 s[52:53], s[52:53], 1
    v_cndmask_b32_dpp v86, v86, v86, vcc wave_shr:1 row_mask:0xf bank_mask:0xf
    v_cndmask_b32_dpp v87, v87, v87, vcc wave_shr:1 row_mask:0xf bank_mask:0xf
    s_andn2_b64 s[82:83], s[82:83], s[52:53]
    v_cndmask_b32_dpp v7, v7, v7, vcc wave_shr:1 row_mask:0xf bank_mask:0xf
    s_mov_b64 exec, s[54:55]
    s_cbranch_scc0 L2_d101
    s_mov_b64 exec, s[82:83]
    s_nop 1
    v_mfma_f32_4x4x4_16b_bf16 v[88:91], v[12:13], v[84:85], 0
    s_nop 1
    v_mfma_f32_4x4x4_16b_bf16 v[88:91], v[10:11], v[86:87], v[88:91]
    s_nop 4
    v_cvt_pk_bf16_f32 v88, v88, v89
    v_cvt_pk_bf16_f32 v89, v90, v91
    ds_pk_add_bf16 v7, v88 offset:65408
    ds_pk_add_bf16 v7, v89 offset:65412
    s_mov_b64 exec, s[54:55]
    s_branch L2_d101
L2_c102:
    s_lshl_b64 s[52:53], s[82:83], 1
    s_andn2_b64 s[52:53], s[52:53], s[80:81]
    s_andn2_b64 s[52:53], s[52:53], s[50:51]
    s_or_b64 s[80:81], s[80:81], s[52:53]
    s_not_b64 vcc, s[52:53]
    s_mov_b64 exec, -1
    v_cndmask_b32_dpp v84, v84, v84, vcc wave_shr:1 row_mask:0xf bank_mask:0xf
    v_cndmask_b32_dpp v85, v85, v85, vcc wave_shr:1 row_mask:0xf bank_mask:0xf
    s_lshr_b64 s[52:53], s[52:53], 1
    v_cndmask_b32_dpp v86, v86, v86, vcc wave_shr:1 row_mask:0xf bank_mask:0xf
    v_cndmask_b32_dpp v87, v87, v87, vcc wave_shr:1 row_mask:0xf bank_mask:0xf
    s_andn2_b64 s[82:83], s[82:83], s[52:53]
    v_cndmask_b32_dpp v7, v7, v7, vcc wave_shr:1 row_mask:0xf bank_mask:0xf
    s_mov_b64 exec, s[50:51]
    s_cbranch_scc0 L2_d102
    s_mov_b64 exec, s[82:83]
    s_nop 1
    v_mfma_f32_4x4x4_16b_bf16 v[88:91], v[12:13], v[84:85], 0
    s_nop 1
    v_mfma_f32_4x4x4_16b_bf16 v[88:91], v[10:11], v[86:87], v[88:91]
    s_nop 4
    v_cvt_pk_bf16_f32 v88, v88, v89
    v_cvt_pk_bf16_f32 v89, v90, v91
    ds_pk_add_bf16 v7, v88 offset:65408
    ds_pk_add_bf16 v7, v89 offset:65412
    s_mov_b64 exec, s[50:51]
    s_branch L2_d102
L2_c103:
    s_lshl_b64 s[52:53], s[82:83], 1
    s_andn2_b64 s[52:53], s[52:53], s[80:81]
    s_andn2_b64 s[52:53], s[52:53], s[54:55]
    s_or_b64 s[80:81], s[80:81], s[52:53]
    s_not_b64 vcc, s[52:53]
    s_mov_b64 exec, -1
    v_cndmask_b32_dpp v84, v84, v84, vcc wave_shr:1 row_mask:0xf bank_mask:0xf
    v_cndmask_b32_dpp v85, v85, v85, vcc wave_shr:1 row_mask:0xf bank_mask:0xf
    s_lshr_b64 s[52:53], s[52:53], 1
    v_cndmask_b32_dpp v86, v86, v86, vcc wave_shr:1 row_mask:0xf bank_mask:0xf
    v_cndmask_b32_dpp v87, v87, v87, vcc wave_shr:1 row_mask:0xf bank_mask:0xf
    s_andn2_b64 s[82:83], s[82:83], s[52:53]
    v_cndmask_b32_dpp v7, v7, v7, vcc wave_shr:1 row_mask:0xf bank_mask:0xf
    s_mov_b64 exec, s[54:55]
    s_cbranch_scc0 L2_d103
    s_mov_b64 exec, s[82:83]
    s_nop 1
    v_mfma_f32_4x4x4_16b_bf16 v[88:91], v[12:13], v[84:85], 0
    s_nop 1
    v_mfma_f32_4x4x4_16b_bf16 v[88:91], v[10:11], v[86:87], v[88:91]
    s_nop 4
    v_cvt_pk_bf16_f32 v88, v88, v89
    v_cvt_pk_bf16_f32 v89, v90, v91
    ds_pk_add_bf16 v7, v88 offset:65408
    ds_pk_add_bf16 v7, v89 offset:65412
    s_mov_b64 exec, s[54:55]
    s_branch L2_d103
L2_c104:
    s_lshl_b64 s[52:53], s[82:83], 1
    s_andn2_b64 s[52:53], s[52:53], s[80:81]
    s_andn2_b64 s[52:53], s[52:53], s[50:51]
    s_or_b64 s[80:81], s[80:81], s[52:53]
    s_not_b64 vcc, s[52:53]
    s_mov_b64 exec, -1
    v_cndmask_b32_dpp v84, v84, v84, vcc wave_shr:1 row_mask:0xf bank_mask:0xf
    v_cndmask_b32_dpp v85, v85, v85, vcc wave_shr:1 row_mask:0xf bank_mask:0xf
    s_lshr_b64 s[52:53], s[52:53], 1
    v_cndmask_b32_dpp v86, v86, v86, vcc wave_shr:1 row_mask:0xf bank_mask:0xf
    v_cndmask_b32_dpp v87, v87, v87, vcc wave_shr:1 row_mask:0xf bank_mask:0xf
    s_andn2_b64 s[82:83], s[82:83], s[52:53]
    v_cndmask_b32_dpp v7, v7, v7, vcc wave_shr:1 row_mask:0xf bank_mask:0xf
    s_mov_b64 exec, s[50:51]
    s_cbranch_scc0 L2_d104
    s_mov_b64 exec, s[82:83]
    s_nop 1
    v_mfma_f32_4x4x4_16b_bf16 v[88:91], v[12:13], v[84:85], 0
    s_nop 1
    v_mfma_f32_4x4x4_16b_bf16 v[88:91], v[10:11], v[86:87], v[88:91]
    s_nop 4
    v_cvt_pk_bf16_f32 v88, v88, v89
    v_cvt_pk_bf16_f32 v89, v90, v91
    ds_pk_add_bf16 v7, v88 offset:65408
    ds_pk_add_bf16 v7, v89 offset:65412
    s_mov_b64 exec, s[50:51]
    s_branch L2_d104
L2_c105:
    s_lshl_b64 s[52:53], s[82:83], 1
    s_andn2_b64 s[52:53], s[52:53], s[80:81]
    s_andn2_b64 s[52:53], s[52:53], s[54:55]
    s_or_b64 s[80:81], s[80:81], s[52:53]
    s_not_b64 vcc, s[52:53]
    s_mov_b64 exec, -1
    v_cndmask_b32_dpp v84, v84, v84, vcc wave_shr:1 row_mask:0xf bank_mask:0xf
    v_cndmask_b32_dpp v85, v85, v85, vcc wave_shr:1 row_mask:0xf bank_mask:0xf
    s_lshr_b64 s[52:53], s[52:53], 1
    v_cndmask_b32_dpp v86, v86, v86, vcc wave_shr:1 row_mask:0xf bank_mask:0xf
    v_cndmask_b32_dpp v87, v87, v87, vcc wave_shr:1 row_mask:0xf bank_mask:0xf
    s_andn2_b64 s[82:83], s[82:83], s[52:53]
    v_cndmask_b32_dpp v7, v7, v7, vcc wave_shr:1 row_mask:0xf bank_mask:0xf
    s_mov_b64 exec, s[54:55]
    s_cbranch_scc0 L2_d105
    s_mov_b64 exec, s[82:83]
    s_nop 1
    v_mfma_f32_4x4x4_16b_bf16 v[88:91], v[12:13], v[84:85], 0
    s_nop 1
    v_mfma_f32_4x4x4_16b_bf16 v[88:91], v[10:11], v[86:87], v[88:91]
    s_nop 4
    v_cvt_pk_bf16_f32 v88, v88, v89
    v_cvt_pk_bf16_f32 v89, v90, v91
    ds_pk_add_bf16 v7, v88 offset:65408
    ds_pk_add_bf16 v7, v89 offset:65412
    s_mov_b64 exec, s[54:55]
    s_branch L2_d105
L2_c106:
    s_lshl_b64 s[52:53], s[82:83], 1
    s_andn2_b64 s[52:53], s[52:53], s[80:81]
    s_andn2_b64 s[52:53], s[52:53], s[50:51]
    s_or_b64 s[80:81], s[80:81], s[52:53]
    s_not_b64 vcc, s[52:53]
    s_mov_b64 exec, -1
    v_cndmask_b32_dpp v84, v84, v84, vcc wave_shr:1 row_mask:0xf bank_mask:0xf
    v_cndmask_b32_dpp v85, v85, v85, vcc wave_shr:1 row_mask:0xf bank_mask:0xf
    s_lshr_b64 s[52:53], s[52:53], 1
    v_cndmask_b32_dpp v86, v86, v86, vcc wave_shr:1 row_mask:0xf bank_mask:0xf
    v_cndmask_b32_dpp v87, v87, v87, vcc wave_shr:1 row_mask:0xf bank_mask:0xf
    s_andn2_b64 s[82:83], s[82:83], s[52:53]
    v_cndmask_b32_dpp v7, v7, v7, vcc wave_shr:1 row_mask:0xf bank_mask:0xf
    s_mov_b64 exec, s[50:51]
    s_cbranch_scc0 L2_d106
    s_mov_b64 exec, s[82:83]
    s_nop 1
    v_mfma_f32_4x4x4_16b_bf16 v[88:91], v[12:13], v[84:85], 0
    s_nop 1
    v_mfma_f32_4x4x4_16b_bf16 v[88:91], v[10:11], v[86:87], v[88:91]
    s_nop 4
    v_cvt_pk_bf16_f32 v88, v88, v89
    v_cvt_pk_bf16_f32 v89, v90, v91
    ds_pk_add_bf16 v7, v88 offset:65408
    ds_pk_add_bf16 v7, v89 offset:65412
    s_mov_b64 exec, s[50:51]
    s_branch L2_d106
L2_c107:
    s_lshl_b64 s[52:53], s[82:83], 1
    s_andn2_b64 s[52:53], s[52:53], s[80:81]
    s_andn2_b64 s[52:53], s[52:53], s[54:55]
    s_or_b64 s[80:81], s[80:81], s[52:53]
    s_not_b64 vcc, s[52:53]
    s_mov_b64 exec, -1
    v_cndmask_b32_dpp v84, v84, v84, vcc wave_shr:1 row_mask:0xf bank_mask:0xf
    v_cndmask_b32_dpp v85, v85, v85, vcc wave_shr:1 row_mask:0xf bank_mask:0xf
    s_lshr_b64 s[52:53], s[52:53], 1
    v_cndmask_b32_dpp v86, v86, v86, vcc wave_shr:1 row_mask:0xf bank_mask:0xf
    v_cndmask_b32_dpp v87, v87, v87, vcc wave_shr:1 row_mask:0xf bank_mask:0xf
    s_andn2_b64 s[82:83], s[82:83], s[52:53]
    v_cndmask_b32_dpp v7, v7, v7, vcc wave_shr:1 row_mask:0xf bank_mask:0xf
    s_mov_b64 exec, s[54:55]
    s_cbranch_scc0 L2_d107
    s_mov_b64 exec, s[82:83]
    s_nop 1
    v_mfma_f32_4x4x4_16b_bf16 v[88:91], v[12:13], v[84:85], 0
    s_nop 1
    v_mfma_f32_4x4x4_16b_bf16 v[88:91], v[10:11], v[86:87], v[88:91]
    s_nop 4
    v_cvt_pk_bf16_f32 v88, v88, v89
    v_cvt_pk_bf16_f32 v89, v90, v91
    ds_pk_add_bf16 v7, v88 offset:65408
    ds_pk_add_bf16 v7, v89 offset:65412
    s_mov_b64 exec, s[54:55]
    s_branch L2_d107
L2_c108:
    s_lshl_b64 s[52:53], s[82:83], 1
    s_andn2_b64 s[52:53], s[52:53], s[80:81]
    s_andn2_b64 s[52:53], s[52:53], s[50:51]
    s_or_b64 s[80:81], s[80:81], s[52:53]
    s_not_b64 vcc, s[52:53]
    s_mov_b64 exec, -1
    v_cndmask_b32_dpp v84, v84, v84, vcc wave_shr:1 row_mask:0xf bank_mask:0xf
    v_cndmask_b32_dpp v85, v85, v85, vcc wave_shr:1 row_mask:0xf bank_mask:0xf
    s_lshr_b64 s[52:53], s[52:53], 1
    v_cndmask_b32_dpp v86, v86, v86, vcc wave_shr:1 row_mask:0xf bank_mask:0xf
    v_cndmask_b32_dpp v87, v87, v87, vcc wave_shr:1 row_mask:0xf bank_mask:0xf
    s_andn2_b64 s[82:83], s[82:83], s[52:53]
    v_cndmask_b32_dpp v7, v7, v7, vcc wave_shr:1 row_mask:0xf bank_mask:0xf
    s_mov_b64 exec, s[50:51]
    s_cbranch_scc0 L2_d108
    s_mov_b64 exec, s[82:83]
    s_nop 1
    v_mfma_f32_4x4x4_16b_bf16 v[88:91], v[12:13], v[84:85], 0
    s_nop 1
    v_mfma_f32_4x4x4_16b_bf16 v[88:91], v[10:11], v[86:87], v[88:91]
    s_nop 4
    v_cvt_pk_bf16_f32 v88, v88, v89
    v_cvt_pk_bf16_f32 v89, v90, v91
    ds_pk_add_bf16 v7, v88 offset:65408
    ds_pk_add_bf16 v7, v89 offset:65412
    s_mov_b64 exec, s[50:51]
    s_branch L2_d108
L2_oa109:
    s_waitcnt vmcnt(5)
    s_mov_b64 exec, s[6:7]
    v_lshrrev_b32 v114, 16, v114
    s_mov_b64 exec, -1
    v_and_b32 v46, 0x10000000, v21
    v_cmpx_eq_u32 vcc, 0, v46
    v_lshrrev_b32 v47, 14, v112
    v_and_b32 v47, v5, v47
    ds_read_b64 v[96:97], v47
    v_perm_b32 v98, v112, v114, s44
    v_bitop3_b32 v99, v112, 0.5, -0.5 bitop3:0xa8
    v_bitop3_b32 v98, v6, v98, v99 bitop3:0xca
    v_and_b32 v47, v5, v112
    s_waitcnt lgkmcnt(0)
    v_mfma_f32_4x4x4_16b_bf16 v[88:91], v[8:9], v[96:97], 0
    s_nop 4
    v_mul_f32 v88, v98, v88
    v_mul_f32 v89, v98, v89
    v_mul_f32 v90, v98, v90
    v_mul_f32 v91, v98, v91
    v_cvt_pk_bf16_f32 v88, v88, v89
    v_cvt_pk_bf16_f32 v89, v90, v91
    ds_pk_add_bf16 v47, v88 offset:65408
    ds_pk_add_bf16 v47, v89 offset:65412
    s_mov_b64 exec, -1
    v_and_b32 v46, 0x20000000, v21
    v_cmpx_eq_u32 vcc, 0, v46
    v_lshrrev_b32 v47, 14, v113
    v_and_b32 v47, v5, v47
    ds_read_b64 v[96:97], v47
    v_perm_b32 v98, v113, v114, s45
    v_bitop3_b32 v99, v113, 0.5, -0.5 bitop3:0xa8
    v_bitop3_b32 v98, v6, v98, v99 bitop3:0xca
    v_and_b32 v47, v5, v113
    s_waitcnt lgkmcnt(0)
    v_mfma_f32_4x4x4_16b_bf16 v[88:91], v[8:9], v[96:97], 0
    s_nop 4
    v_mul_f32 v88, v98, v88
    v_mul_f32 v89, v98, v89
    v_mul_f32 v90, v98, v90
    v_mul_f32 v91, v98, v91
    v_cvt_pk_bf16_f32 v88, v88, v89
    v_cvt_pk_bf16_f32 v89, v90, v91
    ds_pk_add_bf16 v47, v88 offset:65408
    ds_pk_add_bf16 v47, v89 offset:65412
    s_mov_b64 exec, -1
    s_branch L2_ob109
L2_xo110:
    v_cmp_lt_u32 vcc, 20, v99
    s_mov_b32 s101, 1
    s_cbranch_vccz L2_xp110
    v_cmp_lt_u32 vcc, 32, v99
    v_cmp_lt_u32 s[58:59], 31, v88
    s_mov_b32 s101, 2
    s_or_b64 vcc, vcc, s[58:59]
    s_cbranch_scc0 L2_xp110
    s_mov_b32 s37, 0x10000
    s_branch L2_xp110
L2_c111:
    s_lshl_b64 s[52:53], s[82:83], 1
    s_andn2_b64 s[52:53], s[52:53], s[80:81]
    s_andn2_b64 s[52:53], s[52:53], s[54:55]
    s_or_b64 s[80:81], s[80:81], s[52:53]
    s_not_b64 vcc, s[52:53]
    s_mov_b64 exec, -1
    v_cndmask_b32_dpp v84, v84, v84, vcc wave_shr:1 row_mask:0xf bank_mask:0xf
    v_cndmask_b32_dpp v85, v85, v85, vcc wave_shr:1 row_mask:0xf bank_mask:0xf
    s_lshr_b64 s[52:53], s[52:53], 1
    v_cndmask_b32_dpp v86, v86, v86, vcc wave_shr:1 row_mask:0xf bank_mask:0xf
    v_cndmask_b32_dpp v87, v87, v87, vcc wave_shr:1 row_mask:0xf bank_mask:0xf
    s_andn2_b64 s[82:83], s[82:83], s[52:53]
    v_cndmask_b32_dpp v7, v7, v7, vcc wave_shr:1 row_mask:0xf bank_mask:0xf
    s_mov_b64 exec, s[54:55]
    s_cbranch_scc0 L2_d111
    s_mov_b64 exec, s[82:83]
    s_nop 1
    v_mfma_f32_4x4x4_16b_bf16 v[88:91], v[12:13], v[84:85], 0
    s_nop 1
    v_mfma_f32_4x4x4_16b_bf16 v[88:91], v[10:11], v[86:87], v[88:91]
    s_nop 4
    v_cvt_pk_bf16_f32 v88, v88, v89
    v_cvt_pk_bf16_f32 v89, v90, v91
    ds_pk_add_bf16 v7, v88 offset:65408
    ds_pk_add_bf16 v7, v89 offset:65412
    s_mov_b64 exec, s[54:55]
    s_branch L2_d111
L2_c112:
    s_lshl_b64 s[52:53], s[82:83], 1
    s_andn2_b64 s[52:53], s[52:53], s[80:81]
    s_andn2_b64 s[52:53], s[52:53], s[50:51]
    s_or_b64 s[80:81], s[80:81], s[52:53]
    s_not_b64 vcc, s[52:53]
    s_mov_b64 exec, -1
    v_cndmask_b32_dpp v84, v84, v84, vcc wave_shr:1 row_mask:0xf bank_mask:0xf
    v_cndmask_b32_dpp v85, v85, v85, vcc wave_shr:1 row_mask:0xf bank_mask:0xf
    s_lshr_b64 s[52:53], s[52:53], 1
    v_cndmask_b32_dpp v86, v86, v86, vcc wave_shr:1 row_mask:0xf bank_mask:0xf
    v_cndmask_b32_dpp v87, v87, v87, vcc wave_shr:1 row_mask:0xf bank_mask:0xf
    s_andn2_b64 s[82:83], s[82:83], s[52:53]
    v_cndmask_b32_dpp v7, v7, v7, vcc wave_shr:1 row_mask:0xf bank_mask:0xf
    s_mov_b64 exec, s[50:51]
    s_cbranch_scc0 L2_d112
    s_mov_b64 exec, s[82:83]
    s_nop 1
    v_mfma_f32_4x4x4_16b_bf16 v[88:91], v[12:13], v[84:85], 0
    s_nop 1
    v_mfma_f32_4x4x4_16b_bf16 v[88:91], v[10:11], v[86:87], v[88:91]
    s_nop 4
    v_cvt_pk_bf16_f32 v88, v88, v89
    v_cvt_pk_bf16_f32 v89, v90, v91
    ds_pk_add_bf16 v7, v88 offset:65408
    ds_pk_add_bf16 v7, v89 offset:65412
    s_mov_b64 exec, s[50:51]
    s_branch L2_d112
L2_c113:
    s_lshl_b64 s[52:53], s[82:83], 1
    s_andn2_b64 s[52:53], s[52:53], s[80:81]
    s_andn2_b64 s[52:53], s[52:53], s[54:55]
    s_or_b64 s[80:81], s[80:81], s[52:53]
    s_not_b64 vcc, s[52:53]
    s_mov_b64 exec, -1
    v_cndmask_b32_dpp v84, v84, v84, vcc wave_shr:1 row_mask:0xf bank_mask:0xf
    v_cndmask_b32_dpp v85, v85, v85, vcc wave_shr:1 row_mask:0xf bank_mask:0xf
    s_lshr_b64 s[52:53], s[52:53], 1
    v_cndmask_b32_dpp v86, v86, v86, vcc wave_shr:1 row_mask:0xf bank_mask:0xf
    v_cndmask_b32_dpp v87, v87, v87, vcc wave_shr:1 row_mask:0xf bank_mask:0xf
    s_andn2_b64 s[82:83], s[82:83], s[52:53]
    v_cndmask_b32_dpp v7, v7, v7, vcc wave_shr:1 row_mask:0xf bank_mask:0xf
    s_mov_b64 exec, s[54:55]
    s_cbranch_scc0 L2_d113
    s_mov_b64 exec, s[82:83]
    s_nop 1
    v_mfma_f32_4x4x4_16b_bf16 v[88:91], v[12:13], v[84:85], 0
    s_nop 1
    v_mfma_f32_4x4x4_16b_bf16 v[88:91], v[10:11], v[86:87], v[88:91]
    s_nop 4
    v_cvt_pk_bf16_f32 v88, v88, v89
    v_cvt_pk_bf16_f32 v89, v90, v91
    ds_pk_add_bf16 v7, v88 offset:65408
    ds_pk_add_bf16 v7, v89 offset:65412
    s_mov_b64 exec, s[54:55]
    s_branch L2_d113
L2_c114:
    s_lshl_b64 s[52:53], s[82:83], 1
    s_andn2_b64 s[52:53], s[52:53], s[80:81]
    s_andn2_b64 s[52:53], s[52:53], s[50:51]
    s_or_b64 s[80:81], s[80:81], s[52:53]
    s_not_b64 vcc, s[52:53]
    s_mov_b64 exec, -1
    v_cndmask_b32_dpp v84, v84, v84, vcc wave_shr:1 row_mask:0xf bank_mask:0xf
    v_cndmask_b32_dpp v85, v85, v85, vcc wave_shr:1 row_mask:0xf bank_mask:0xf
    s_lshr_b64 s[52:53], s[52:53], 1
    v_cndmask_b32_dpp v86, v86, v86, vcc wave_shr:1 row_mask:0xf bank_mask:0xf
    v_cndmask_b32_dpp v87, v87, v87, vcc wave_shr:1 row_mask:0xf bank_mask:0xf
    s_andn2_b64 s[82:83], s[82:83], s[52:53]
    v_cndmask_b32_dpp v7, v7, v7, vcc wave_shr:1 row_mask:0xf bank_mask:0xf
    s_mov_b64 exec, s[50:51]
    s_cbranch_scc0 L2_d114
    s_mov_b64 exec, s[82:83]
    s_nop 1
    v_mfma_f32_4x4x4_16b_bf16 v[88:91], v[12:13], v[84:85], 0
    s_nop 1
    v_mfma_f32_4x4x4_16b_bf16 v[88:91], v[10:11], v[86:87], v[88:91]
    s_nop 4
    v_cvt_pk_bf16_f32 v88, v88, v89
    v_cvt_pk_bf16_f32 v89, v90, v91
    ds_pk_add_bf16 v7, v88 offset:65408
    ds_pk_add_bf16 v7, v89 offset:65412
    s_mov_b64 exec, s[50:51]
    s_branch L2_d114
L2_xa115:
    s_cmp_eq_u32 s101, 1
    s_cbranch_scc1 L2_xc115
    v_lshlrev_b32 v89, 0, v96
    v_add_u32 v90, 140, v97
    v_bitop3_b32 v90, v89, v45, v90 bitop3:0x6a
    ds_write_b32 v98, v90 offset:28
    v_lshlrev_b32 v89, 4, v96
    v_add_u32 v90, 120, v97
    v_bitop3_b32 v90, v89, v45, v90 bitop3:0x6a
    ds_write_b32 v98, v90 offset:24
    v_lshlrev_b32 v89, 8, v96
    v_add_u32 v90, 100, v97
    v_bitop3_b32 v90, v89, v45, v90 bitop3:0x6a
    ds_write_b32 v98, v90 offset:20
L2_xc115:
    v_lshlrev_b32 v89, 12, v96
    v_add_u32 v90, 80, v97
    v_bitop3_b32 v90, v89, v45, v90 bitop3:0x6a
    ds_write_b32 v98, v90 offset:16
    s_branch L2_xb115
L2_xe115:
    v_cmp_lt_u32 vcc, 32, v99
    v_cmp_lt_u32 s[58:59], 31, v88
    v_lshrrev_b32 v89, 16, v96
    v_add_u32 v97, 80, v97
    s_or_b64 vcc, vcc, s[58:59]
    s_cbranch_scc1 L2_xs115
    v_lshlrev_b32 v89, v1, v89
    v_and_b32 v89, v45, v89
    v_cmp_ne_u32 vcc, 0, v89
    v_xor_b32 v90, v97, v89
    s_add_u32 s3, s37, s38
    v_mbcnt_lo_u32_b32 v98, vcc_lo, 0
    v_mbcnt_hi_u32_b32 v98, vcc_hi, v98
    s_bcnt1_i32_b64 s41, vcc
    v_lshl_add_u32 v98, v98, 2, s3
    s_lshl2_add_u32 s37, s41, s37
    s_mov_b64 exec, vcc
    ds_write_b32 v98, v90
    s_mov_b64 exec, -1
    s_branch L2_xr115
L2_xs115:
    s_waitcnt lgkmcnt(0)
    s_mov_b32 s37, 0x10000
    s_branch L2_xw115
L2_c116:
    s_lshl_b64 s[52:53], s[82:83], 1
    s_andn2_b64 s[52:53], s[52:53], s[80:81]
    s_andn2_b64 s[52:53], s[52:53], s[54:55]
    s_or_b64 s[80:81], s[80:81], s[52:53]
    s_not_b64 vcc, s[52:53]
    s_mov_b64 exec, -1
    v_cndmask_b32_dpp v84, v84, v84, vcc wave_shr:1 row_mask:0xf bank_mask:0xf
    v_cndmask_b32_dpp v85, v85, v85, vcc wave_shr:1 row_mask:0xf bank_mask:0xf
    s_lshr_b64 s[52:53], s[52:53], 1
    v_cndmask_b32_dpp v86, v86, v86, vcc wave_shr:1 row_mask:0xf bank_mask:0xf
    v_cndmask_b32_dpp v87, v87, v87, vcc wave_shr:1 row_mask:0xf bank_mask:0xf
    s_andn2_b64 s[82:83], s[82:83], s[52:53]
    v_cndmask_b32_dpp v7, v7, v7, vcc wave_shr:1 row_mask:0xf bank_mask:0xf
    s_mov_b64 exec, s[54:55]
    s_cbranch_scc0 L2_d116
    s_mov_b64 exec, s[82:83]
    s_nop 1
    v_mfma_f32_4x4x4_16b_bf16 v[88:91], v[12:13], v[84:85], 0
    s_nop 1
    v_mfma_f32_4x4x4_16b_bf16 v[88:91], v[10:11], v[86:87], v[88:91]
    s_nop 4
    v_cvt_pk_bf16_f32 v88, v88, v89
    v_cvt_pk_bf16_f32 v89, v90, v91
    ds_pk_add_bf16 v7, v88 offset:65408
    ds_pk_add_bf16 v7, v89 offset:65412
    s_mov_b64 exec, s[54:55]
    s_branch L2_d116
L2_c117:
    s_lshl_b64 s[52:53], s[82:83], 1
    s_andn2_b64 s[52:53], s[52:53], s[80:81]
    s_andn2_b64 s[52:53], s[52:53], s[50:51]
    s_or_b64 s[80:81], s[80:81], s[52:53]
    s_not_b64 vcc, s[52:53]
    s_mov_b64 exec, -1
    v_cndmask_b32_dpp v84, v84, v84, vcc wave_shr:1 row_mask:0xf bank_mask:0xf
    v_cndmask_b32_dpp v85, v85, v85, vcc wave_shr:1 row_mask:0xf bank_mask:0xf
    s_lshr_b64 s[52:53], s[52:53], 1
    v_cndmask_b32_dpp v86, v86, v86, vcc wave_shr:1 row_mask:0xf bank_mask:0xf
    v_cndmask_b32_dpp v87, v87, v87, vcc wave_shr:1 row_mask:0xf bank_mask:0xf
    s_andn2_b64 s[82:83], s[82:83], s[52:53]
    v_cndmask_b32_dpp v7, v7, v7, vcc wave_shr:1 row_mask:0xf bank_mask:0xf
    s_mov_b64 exec, s[50:51]
    s_cbranch_scc0 L2_d117
    s_mov_b64 exec, s[82:83]
    s_nop 1
    v_mfma_f32_4x4x4_16b_bf16 v[88:91], v[12:13], v[84:85], 0
    s_nop 1
    v_mfma_f32_4x4x4_16b_bf16 v[88:91], v[10:11], v[86:87], v[88:91]
    s_nop 4
    v_cvt_pk_bf16_f32 v88, v88, v89
    v_cvt_pk_bf16_f32 v89, v90, v91
    ds_pk_add_bf16 v7, v88 offset:65408
    ds_pk_add_bf16 v7, v89 offset:65412
    s_mov_b64 exec, s[50:51]
    s_branch L2_d117
L2_xf115:
    s_cmp_gt_u32 s37, 1024
    s_cbranch_scc1 L2_xt115
    s_cmp_lt_u32 s37, 768
    s_cbranch_scc1 L2_xl115
    ds_read_b32 v21, v44 offset:896
    s_add_u32 s3, s42, 2
    s_bitset1_b32 s43, s3
    s_branch L2_xg115
L2_xl115:
    s_waitcnt lgkmcnt(0)
    v_mov_b32 v40, -1
    s_cmp_ge_u32 s37, 512
    s_cbranch_scc1 L2_xg115
    v_mov_b32 v43, -1
    s_cmp_ge_u32 s37, 256
    s_cbranch_scc1 L2_xg115
    v_mov_b32 v42, -1
    s_branch L2_xg115
L2_xt115:
    s_waitcnt lgkmcnt(0)
    v_mov_b32 v41, -1
    v_mov_b32 v42, -1
    v_mov_b32 v43, -1
    v_mov_b32 v40, -1
    s_add_u32 s3, s42, 2
    s_bitset1_b32 s36, s3
    s_branch L2_xg115
L2_oa118:
    v_and_b32 v47, 0x0fffffff, v20
    buffer_load_dword v114, v47, s[8:11], 0 offen offset:16
    s_mov_b64 exec, s[6:7]
    v_add_u32 v47, 8, v47
    v_lshrrev_b32 v20, 2, v20
    s_mov_b64 exec, -1
    buffer_load_dwordx2 v[112:113], v47, s[8:11], 0 offen
    s_branch L2_ob118
L2_c119:
    s_lshl_b64 s[52:53], s[82:83], 1
    s_andn2_b64 s[52:53], s[52:53], s[80:81]
    s_andn2_b64 s[52:53], s[52:53], s[54:55]
    s_or_b64 s[80:81], s[80:81], s[52:53]
    s_not_b64 vcc, s[52:53]
    s_mov_b64 exec, -1
    v_cndmask_b32_dpp v84, v84, v84, vcc wave_shr:1 row_mask:0xf bank_mask:0xf
    v_cndmask_b32_dpp v85, v85, v85, vcc wave_shr:1 row_mask:0xf bank_mask:0xf
    s_lshr_b64 s[52:53], s[52:53], 1
    v_cndmask_b32_dpp v86, v86, v86, vcc wave_shr:1 row_mask:0xf bank_mask:0xf
    v_cndmask_b32_dpp v87, v87, v87, vcc wave_shr:1 row_mask:0xf bank_mask:0xf
    s_andn2_b64 s[82:83], s[82:83], s[52:53]
    v_cndmask_b32_dpp v7, v7, v7, vcc wave_shr:1 row_mask:0xf bank_mask:0xf
    s_mov_b64 exec, s[54:55]
    s_cbranch_scc0 L2_d119
    s_mov_b64 exec, s[82:83]
    s_nop 1
    v_mfma_f32_4x4x4_16b_bf16 v[88:91], v[12:13], v[84:85], 0
    s_nop 1
    v_mfma_f32_4x4x4_16b_bf16 v[88:91], v[10:11], v[86:87], v[88:91]
    s_nop 4
    v_cvt_pk_bf16_f32 v88, v88, v89
    v_cvt_pk_bf16_f32 v89, v90, v91
    ds_pk_add_bf16 v7, v88 offset:65408
    ds_pk_add_bf16 v7, v89 offset:65412
    s_mov_b64 exec, s[54:55]
    s_branch L2_d119
L2_c120:
    s_lshl_b64 s[52:53], s[82:83], 1
    s_andn2_b64 s[52:53], s[52:53], s[80:81]
    s_andn2_b64 s[52:53], s[52:53], s[50:51]
    s_or_b64 s[80:81], s[80:81], s[52:53]
    s_not_b64 vcc, s[52:53]
    s_mov_b64 exec, -1
    v_cndmask_b32_dpp v84, v84, v84, vcc wave_shr:1 row_mask:0xf bank_mask:0xf
    v_cndmask_b32_dpp v85, v85, v85, vcc wave_shr:1 row_mask:0xf bank_mask:0xf
    s_lshr_b64 s[52:53], s[52:53], 1
    v_cndmask_b32_dpp v86, v86, v86, vcc wave_shr:1 row_mask:0xf bank_mask:0xf
    v_cndmask_b32_dpp v87, v87, v87, vcc wave_shr:1 row_mask:0xf bank_mask:0xf
    s_andn2_b64 s[82:83], s[82:83], s[52:53]
    v_cndmask_b32_dpp v7, v7, v7, vcc wave_shr:1 row_mask:0xf bank_mask:0xf
    s_mov_b64 exec, s[50:51]
    s_cbranch_scc0 L2_d120
    s_mov_b64 exec, s[82:83]
    s_nop 1
    v_mfma_f32_4x4x4_16b_bf16 v[88:91], v[12:13], v[84:85], 0
    s_nop 1
    v_mfma_f32_4x4x4_16b_bf16 v[88:91], v[10:11], v[86:87], v[88:91]
    s_nop 4
    v_cvt_pk_bf16_f32 v88, v88, v89
    v_cvt_pk_bf16_f32 v89, v90, v91
    ds_pk_add_bf16 v7, v88 offset:65408
    ds_pk_add_bf16 v7, v89 offset:65412
    s_mov_b64 exec, s[50:51]
    s_branch L2_d120
L2_c121:
    s_lshl_b64 s[52:53], s[82:83], 1
    s_andn2_b64 s[52:53], s[52:53], s[80:81]
    s_andn2_b64 s[52:53], s[52:53], s[54:55]
    s_or_b64 s[80:81], s[80:81], s[52:53]
    s_not_b64 vcc, s[52:53]
    s_mov_b64 exec, -1
    v_cndmask_b32_dpp v84, v84, v84, vcc wave_shr:1 row_mask:0xf bank_mask:0xf
    v_cndmask_b32_dpp v85, v85, v85, vcc wave_shr:1 row_mask:0xf bank_mask:0xf
    s_lshr_b64 s[52:53], s[52:53], 1
    v_cndmask_b32_dpp v86, v86, v86, vcc wave_shr:1 row_mask:0xf bank_mask:0xf
    v_cndmask_b32_dpp v87, v87, v87, vcc wave_shr:1 row_mask:0xf bank_mask:0xf
    s_andn2_b64 s[82:83], s[82:83], s[52:53]
    v_cndmask_b32_dpp v7, v7, v7, vcc wave_shr:1 row_mask:0xf bank_mask:0xf
    s_mov_b64 exec, s[54:55]
    s_cbranch_scc0 L2_d121
    s_mov_b64 exec, s[82:83]
    s_nop 1
    v_mfma_f32_4x4x4_16b_bf16 v[88:91], v[12:13], v[84:85], 0
    s_nop 1
    v_mfma_f32_4x4x4_16b_bf16 v[88:91], v[10:11], v[86:87], v[88:91]
    s_nop 4
    v_cvt_pk_bf16_f32 v88, v88, v89
    v_cvt_pk_bf16_f32 v89, v90, v91
    ds_pk_add_bf16 v7, v88 offset:65408
    ds_pk_add_bf16 v7, v89 offset:65412
    s_mov_b64 exec, s[54:55]
    s_branch L2_d121
L2_c122:
    s_lshl_b64 s[52:53], s[82:83], 1
    s_andn2_b64 s[52:53], s[52:53], s[80:81]
    s_andn2_b64 s[52:53], s[52:53], s[50:51]
    s_or_b64 s[80:81], s[80:81], s[52:53]
    s_not_b64 vcc, s[52:53]
    s_mov_b64 exec, -1
    v_cndmask_b32_dpp v84, v84, v84, vcc wave_shr:1 row_mask:0xf bank_mask:0xf
    v_cndmask_b32_dpp v85, v85, v85, vcc wave_shr:1 row_mask:0xf bank_mask:0xf
    s_lshr_b64 s[52:53], s[52:53], 1
    v_cndmask_b32_dpp v86, v86, v86, vcc wave_shr:1 row_mask:0xf bank_mask:0xf
    v_cndmask_b32_dpp v87, v87, v87, vcc wave_shr:1 row_mask:0xf bank_mask:0xf
    s_andn2_b64 s[82:83], s[82:83], s[52:53]
    v_cndmask_b32_dpp v7, v7, v7, vcc wave_shr:1 row_mask:0xf bank_mask:0xf
    s_mov_b64 exec, s[50:51]
    s_cbranch_scc0 L2_d122
    s_mov_b64 exec, s[82:83]
    s_nop 1
    v_mfma_f32_4x4x4_16b_bf16 v[88:91], v[12:13], v[84:85], 0
    s_nop 1
    v_mfma_f32_4x4x4_16b_bf16 v[88:91], v[10:11], v[86:87], v[88:91]
    s_nop 4
    v_cvt_pk_bf16_f32 v88, v88, v89
    v_cvt_pk_bf16_f32 v89, v90, v91
    ds_pk_add_bf16 v7, v88 offset:65408
    ds_pk_add_bf16 v7, v89 offset:65412
    s_mov_b64 exec, s[50:51]
    s_branch L2_d122
L2_c123:
    s_lshl_b64 s[52:53], s[82:83], 1
    s_andn2_b64 s[52:53], s[52:53], s[80:81]
    s_andn2_b64 s[52:53], s[52:53], s[54:55]
    s_or_b64 s[80:81], s[80:81], s[52:53]
    s_not_b64 vcc, s[52:53]
    s_mov_b64 exec, -1
    v_cndmask_b32_dpp v84, v84, v84, vcc wave_shr:1 row_mask:0xf bank_mask:0xf
    v_cndmask_b32_dpp v85, v85, v85, vcc wave_shr:1 row_mask:0xf bank_mask:0xf
    s_lshr_b64 s[52:53], s[52:53], 1
    v_cndmask_b32_dpp v86, v86, v86, vcc wave_shr:1 row_mask:0xf bank_mask:0xf
    v_cndmask_b32_dpp v87, v87, v87, vcc wave_shr:1 row_mask:0xf bank_mask:0xf
    s_andn2_b64 s[82:83], s[82:83], s[52:53]
    v_cndmask_b32_dpp v7, v7, v7, vcc wave_shr:1 row_mask:0xf bank_mask:0xf
    s_mov_b64 exec, s[54:55]
    s_cbranch_scc0 L2_d123
    s_mov_b64 exec, s[82:83]
    s_nop 1
    v_mfma_f32_4x4x4_16b_bf16 v[88:91], v[12:13], v[84:85], 0
    s_nop 1
    v_mfma_f32_4x4x4_16b_bf16 v[88:91], v[10:11], v[86:87], v[88:91]
    s_nop 4
    v_cvt_pk_bf16_f32 v88, v88, v89
    v_cvt_pk_bf16_f32 v89, v90, v91
    ds_pk_add_bf16 v7, v88 offset:65408
    ds_pk_add_bf16 v7, v89 offset:65412
    s_mov_b64 exec, s[54:55]
    s_branch L2_d123
L2_c124:
    s_lshl_b64 s[52:53], s[82:83], 1
    s_andn2_b64 s[52:53], s[52:53], s[80:81]
    s_andn2_b64 s[52:53], s[52:53], s[50:51]
    s_or_b64 s[80:81], s[80:81], s[52:53]
    s_not_b64 vcc, s[52:53]
    s_mov_b64 exec, -1
    v_cndmask_b32_dpp v84, v84, v84, vcc wave_shr:1 row_mask:0xf bank_mask:0xf
    v_cndmask_b32_dpp v85, v85, v85, vcc wave_shr:1 row_mask:0xf bank_mask:0xf
    s_lshr_b64 s[52:53], s[52:53], 1
    v_cndmask_b32_dpp v86, v86, v86, vcc wave_shr:1 row_mask:0xf bank_mask:0xf
    v_cndmask_b32_dpp v87, v87, v87, vcc wave_shr:1 row_mask:0xf bank_mask:0xf
    s_andn2_b64 s[82:83], s[82:83], s[52:53]
    v_cndmask_b32_dpp v7, v7, v7, vcc wave_shr:1 row_mask:0xf bank_mask:0xf
    s_mov_b64 exec, s[50:51]
    s_cbranch_scc0 L2_d124
    s_mov_b64 exec, s[82:83]
    s_nop 1
    v_mfma_f32_4x4x4_16b_bf16 v[88:91], v[12:13], v[84:85], 0
    s_nop 1
    v_mfma_f32_4x4x4_16b_bf16 v[88:91], v[10:11], v[86:87], v[88:91]
    s_nop 4
    v_cvt_pk_bf16_f32 v88, v88, v89
    v_cvt_pk_bf16_f32 v89, v90, v91
    ds_pk_add_bf16 v7, v88 offset:65408
    ds_pk_add_bf16 v7, v89 offset:65412
    s_mov_b64 exec, s[50:51]
    s_branch L2_d124
L2_c125:
    s_lshl_b64 s[52:53], s[82:83], 1
    s_andn2_b64 s[52:53], s[52:53], s[80:81]
    s_andn2_b64 s[52:53], s[52:53], s[54:55]
    s_or_b64 s[80:81], s[80:81], s[52:53]
    s_not_b64 vcc, s[52:53]
    s_mov_b64 exec, -1
    v_cndmask_b32_dpp v84, v84, v84, vcc wave_shr:1 row_mask:0xf bank_mask:0xf
    v_cndmask_b32_dpp v85, v85, v85, vcc wave_shr:1 row_mask:0xf bank_mask:0xf
    s_lshr_b64 s[52:53], s[52:53], 1
    v_cndmask_b32_dpp v86, v86, v86, vcc wave_shr:1 row_mask:0xf bank_mask:0xf
    v_cndmask_b32_dpp v87, v87, v87, vcc wave_shr:1 row_mask:0xf bank_mask:0xf
    s_andn2_b64 s[82:83], s[82:83], s[52:53]
    v_cndmask_b32_dpp v7, v7, v7, vcc wave_shr:1 row_mask:0xf bank_mask:0xf
    s_mov_b64 exec, s[54:55]
    s_cbranch_scc0 L2_d125
    s_mov_b64 exec, s[82:83]
    s_nop 1
    v_mfma_f32_4x4x4_16b_bf16 v[88:91], v[12:13], v[84:85], 0
    s_nop 1
    v_mfma_f32_4x4x4_16b_bf16 v[88:91], v[10:11], v[86:87], v[88:91]
    s_nop 4
    v_cvt_pk_bf16_f32 v88, v88, v89
    v_cvt_pk_bf16_f32 v89, v90, v91
    ds_pk_add_bf16 v7, v88 offset:65408
    ds_pk_add_bf16 v7, v89 offset:65412
    s_mov_b64 exec, s[54:55]
    s_branch L2_d125
L2_c126:
    s_lshl_b64 s[52:53], s[82:83], 1
    s_andn2_b64 s[52:53], s[52:53], s[80:81]
    s_andn2_b64 s[52:53], s[52:53], s[50:51]
    s_or_b64 s[80:81], s[80:81], s[52:53]
    s_not_b64 vcc, s[52:53]
    s_mov_b64 exec, -1
    v_cndmask_b32_dpp v84, v84, v84, vcc wave_shr:1 row_mask:0xf bank_mask:0xf
    v_cndmask_b32_dpp v85, v85, v85, vcc wave_shr:1 row_mask:0xf bank_mask:0xf
    s_lshr_b64 s[52:53], s[52:53], 1
    v_cndmask_b32_dpp v86, v86, v86, vcc wave_shr:1 row_mask:0xf bank_mask:0xf
    v_cndmask_b32_dpp v87, v87, v87, vcc wave_shr:1 row_mask:0xf bank_mask:0xf
    s_andn2_b64 s[82:83], s[82:83], s[52:53]
    v_cndmask_b32_dpp v7, v7, v7, vcc wave_shr:1 row_mask:0xf bank_mask:0xf
    s_mov_b64 exec, s[50:51]
    s_cbranch_scc0 L2_d126
    s_mov_b64 exec, s[82:83]
    s_nop 1
    v_mfma_f32_4x4x4_16b_bf16 v[88:91], v[12:13], v[84:85], 0
    s_nop 1
    v_mfma_f32_4x4x4_16b_bf16 v[88:91], v[10:11], v[86:87], v[88:91]
    s_nop 4
    v_cvt_pk_bf16_f32 v88, v88, v89
    v_cvt_pk_bf16_f32 v89, v90, v91
    ds_pk_add_bf16 v7, v88 offset:65408
    ds_pk_add_bf16 v7, v89 offset:65412
    s_mov_b64 exec, s[50:51]
    s_branch L2_d126
L2_oa127:
    s_waitcnt vmcnt(5)
    s_mov_b64 exec, s[6:7]
    v_lshrrev_b32 v114, 16, v114
    s_mov_b64 exec, -1
    v_and_b32 v46, 0x10000000, v20
    v_cmpx_eq_u32 vcc, 0, v46
    v_lshrrev_b32 v47, 14, v112
    v_and_b32 v47, v5, v47
    ds_read_b64 v[96:97], v47
    v_perm_b32 v98, v112, v114, s44
    v_bitop3_b32 v99, v112, 0.5, -0.5 bitop3:0xa8
    v_bitop3_b32 v98, v6, v98, v99 bitop3:0xca
    v_and_b32 v47, v5, v112
    s_waitcnt lgkmcnt(0)
    v_mfma_f32_4x4x4_16b_bf16 v[88:91], v[8:9], v[96:97], 0
    s_nop 4
    v_mul_f32 v88, v98, v88
    v_mul_f32 v89, v98, v89
    v_mul_f32 v90, v98, v90
    v_mul_f32 v91, v98, v91
    v_cvt_pk_bf16_f32 v88, v88, v89
    v_cvt_pk_bf16_f32 v89, v90, v91
    ds_pk_add_bf16 v47, v88 offset:65408
    ds_pk_add_bf16 v47, v89 offset:65412
    s_mov_b64 exec, -1
    v_and_b32 v46, 0x20000000, v20
    v_cmpx_eq_u32 vcc, 0, v46
    v_lshrrev_b32 v47, 14, v113
    v_and_b32 v47, v5, v47
    ds_read_b64 v[96:97], v47
    v_perm_b32 v98, v113, v114, s45
    v_bitop3_b32 v99, v113, 0.5, -0.5 bitop3:0xa8
    v_bitop3_b32 v98, v6, v98, v99 bitop3:0xca
    v_and_b32 v47, v5, v113
    s_waitcnt lgkmcnt(0)
    v_mfma_f32_4x4x4_16b_bf16 v[88:91], v[8:9], v[96:97], 0
    s_nop 4
    v_mul_f32 v88, v98, v88
    v_mul_f32 v89, v98, v89
    v_mul_f32 v90, v98, v90
    v_mul_f32 v91, v98, v91
    v_cvt_pk_bf16_f32 v88, v88, v89
    v_cvt_pk_bf16_f32 v89, v90, v91
    ds_pk_add_bf16 v47, v88 offset:65408
    ds_pk_add_bf16 v47, v89 offset:65412
    s_mov_b64 exec, -1
    s_branch L2_ob127
L2_c128:
    s_lshl_b64 s[52:53], s[82:83], 1
    s_andn2_b64 s[52:53], s[52:53], s[80:81]
    s_andn2_b64 s[52:53], s[52:53], s[54:55]
    s_or_b64 s[80:81], s[80:81], s[52:53]
    s_not_b64 vcc, s[52:53]
    s_mov_b64 exec, -1
    v_cndmask_b32_dpp v84, v84, v84, vcc wave_shr:1 row_mask:0xf bank_mask:0xf
    v_cndmask_b32_dpp v85, v85, v85, vcc wave_shr:1 row_mask:0xf bank_mask:0xf
    s_lshr_b64 s[52:53], s[52:53], 1
    v_cndmask_b32_dpp v86, v86, v86, vcc wave_shr:1 row_mask:0xf bank_mask:0xf
    v_cndmask_b32_dpp v87, v87, v87, vcc wave_shr:1 row_mask:0xf bank_mask:0xf
    s_andn2_b64 s[82:83], s[82:83], s[52:53]
    v_cndmask_b32_dpp v7, v7, v7, vcc wave_shr:1 row_mask:0xf bank_mask:0xf
    s_mov_b64 exec, s[54:55]
    s_cbranch_scc0 L2_d128
    s_mov_b64 exec, s[82:83]
    s_nop 1
    v_mfma_f32_4x4x4_16b_bf16 v[88:91], v[12:13], v[84:85], 0
    s_nop 1
    v_mfma_f32_4x4x4_16b_bf16 v[88:91], v[10:11], v[86:87], v[88:91]
    s_nop 4
    v_cvt_pk_bf16_f32 v88, v88, v89
    v_cvt_pk_bf16_f32 v89, v90, v91
    ds_pk_add_bf16 v7, v88 offset:65408
    ds_pk_add_bf16 v7, v89 offset:65412
    s_mov_b64 exec, s[54:55]
    s_branch L2_d128
L2_c129:
    s_lshl_b64 s[52:53], s[82:83], 1
    s_andn2_b64 s[52:53], s[52:53], s[80:81]
    s_andn2_b64 s[52:53], s[52:53], s[50:51]
    s_or_b64 s[80:81], s[80:81], s[52:53]
    s_not_b64 vcc, s[52:53]
    s_mov_b64 exec, -1
    v_cndmask_b32_dpp v84, v84, v84, vcc wave_shr:1 row_mask:0xf bank_mask:0xf
    v_cndmask_b32_dpp v85, v85, v85, vcc wave_shr:1 row_mask:0xf bank_mask:0xf
    s_lshr_b64 s[52:53], s[52:53], 1
    v_cndmask_b32_dpp v86, v86, v86, vcc wave_shr:1 row_mask:0xf bank_mask:0xf
    v_cndmask_b32_dpp v87, v87, v87, vcc wave_shr:1 row_mask:0xf bank_mask:0xf
    s_andn2_b64 s[82:83], s[82:83], s[52:53]
    v_cndmask_b32_dpp v7, v7, v7, vcc wave_shr:1 row_mask:0xf bank_mask:0xf
    s_mov_b64 exec, s[50:51]
    s_cbranch_scc0 L2_d129
    s_mov_b64 exec, s[82:83]
    s_nop 1
    v_mfma_f32_4x4x4_16b_bf16 v[88:91], v[12:13], v[84:85], 0
    s_nop 1
    v_mfma_f32_4x4x4_16b_bf16 v[88:91], v[10:11], v[86:87], v[88:91]
    s_nop 4
    v_cvt_pk_bf16_f32 v88, v88, v89
    v_cvt_pk_bf16_f32 v89, v90, v91
    ds_pk_add_bf16 v7, v88 offset:65408
    ds_pk_add_bf16 v7, v89 offset:65412
    s_mov_b64 exec, s[50:51]
    s_branch L2_d129
L2_c130:
    s_lshl_b64 s[52:53], s[82:83], 1
    s_andn2_b64 s[52:53], s[52:53], s[80:81]
    s_andn2_b64 s[52:53], s[52:53], s[54:55]
    s_or_b64 s[80:81], s[80:81], s[52:53]
    s_not_b64 vcc, s[52:53]
    s_mov_b64 exec, -1
    v_cndmask_b32_dpp v84, v84, v84, vcc wave_shr:1 row_mask:0xf bank_mask:0xf
    v_cndmask_b32_dpp v85, v85, v85, vcc wave_shr:1 row_mask:0xf bank_mask:0xf
    s_lshr_b64 s[52:53], s[52:53], 1
    v_cndmask_b32_dpp v86, v86, v86, vcc wave_shr:1 row_mask:0xf bank_mask:0xf
    v_cndmask_b32_dpp v87, v87, v87, vcc wave_shr:1 row_mask:0xf bank_mask:0xf
    s_andn2_b64 s[82:83], s[82:83], s[52:53]
    v_cndmask_b32_dpp v7, v7, v7, vcc wave_shr:1 row_mask:0xf bank_mask:0xf
    s_mov_b64 exec, s[54:55]
    s_cbranch_scc0 L2_d130
    s_mov_b64 exec, s[82:83]
    s_nop 1
    v_mfma_f32_4x4x4_16b_bf16 v[88:91], v[12:13], v[84:85], 0
    s_nop 1
    v_mfma_f32_4x4x4_16b_bf16 v[88:91], v[10:11], v[86:87], v[88:91]
    s_nop 4
    v_cvt_pk_bf16_f32 v88, v88, v89
    v_cvt_pk_bf16_f32 v89, v90, v91
    ds_pk_add_bf16 v7, v88 offset:65408
    ds_pk_add_bf16 v7, v89 offset:65412
    s_mov_b64 exec, s[54:55]
    s_branch L2_d130
L2_c131:
    s_lshl_b64 s[52:53], s[82:83], 1
    s_andn2_b64 s[52:53], s[52:53], s[80:81]
    s_andn2_b64 s[52:53], s[52:53], s[50:51]
    s_or_b64 s[80:81], s[80:81], s[52:53]
    s_not_b64 vcc, s[52:53]
    s_mov_b64 exec, -1
    v_cndmask_b32_dpp v84, v84, v84, vcc wave_shr:1 row_mask:0xf bank_mask:0xf
    v_cndmask_b32_dpp v85, v85, v85, vcc wave_shr:1 row_mask:0xf bank_mask:0xf
    s_lshr_b64 s[52:53], s[52:53], 1
    v_cndmask_b32_dpp v86, v86, v86, vcc wave_shr:1 row_mask:0xf bank_mask:0xf
    v_cndmask_b32_dpp v87, v87, v87, vcc wave_shr:1 row_mask:0xf bank_mask:0xf
    s_andn2_b64 s[82:83], s[82:83], s[52:53]
    v_cndmask_b32_dpp v7, v7, v7, vcc wave_shr:1 row_mask:0xf bank_mask:0xf
    s_mov_b64 exec, s[50:51]
    s_cbranch_scc0 L2_d131
    s_mov_b64 exec, s[82:83]
    s_nop 1
    v_mfma_f32_4x4x4_16b_bf16 v[88:91], v[12:13], v[84:85], 0
    s_nop 1
    v_mfma_f32_4x4x4_16b_bf16 v[88:91], v[10:11], v[86:87], v[88:91]
    s_nop 4
    v_cvt_pk_bf16_f32 v88, v88, v89
    v_cvt_pk_bf16_f32 v89, v90, v91
    ds_pk_add_bf16 v7, v88 offset:65408
    ds_pk_add_bf16 v7, v89 offset:65412
    s_mov_b64 exec, s[50:51]
    s_branch L2_d131
L2_c132:
    s_lshl_b64 s[52:53], s[82:83], 1
    s_andn2_b64 s[52:53], s[52:53], s[80:81]
    s_andn2_b64 s[52:53], s[52:53], s[54:55]
    s_or_b64 s[80:81], s[80:81], s[52:53]
    s_not_b64 vcc, s[52:53]
    s_mov_b64 exec, -1
    v_cndmask_b32_dpp v84, v84, v84, vcc wave_shr:1 row_mask:0xf bank_mask:0xf
    v_cndmask_b32_dpp v85, v85, v85, vcc wave_shr:1 row_mask:0xf bank_mask:0xf
    s_lshr_b64 s[52:53], s[52:53], 1
    v_cndmask_b32_dpp v86, v86, v86, vcc wave_shr:1 row_mask:0xf bank_mask:0xf
    v_cndmask_b32_dpp v87, v87, v87, vcc wave_shr:1 row_mask:0xf bank_mask:0xf
    s_andn2_b64 s[82:83], s[82:83], s[52:53]
    v_cndmask_b32_dpp v7, v7, v7, vcc wave_shr:1 row_mask:0xf bank_mask:0xf
    s_mov_b64 exec, s[54:55]
    s_cbranch_scc0 L2_d132
    s_mov_b64 exec, s[82:83]
    s_nop 1
    v_mfma_f32_4x4x4_16b_bf16 v[88:91], v[12:13], v[84:85], 0
    s_nop 1
    v_mfma_f32_4x4x4_16b_bf16 v[88:91], v[10:11], v[86:87], v[88:91]
    s_nop 4
    v_cvt_pk_bf16_f32 v88, v88, v89
    v_cvt_pk_bf16_f32 v89, v90, v91
    ds_pk_add_bf16 v7, v88 offset:65408
    ds_pk_add_bf16 v7, v89 offset:65412
    s_mov_b64 exec, s[54:55]
    s_branch L2_d132
L2_c133:
    s_lshl_b64 s[52:53], s[82:83], 1
    s_andn2_b64 s[52:53], s[52:53], s[80:81]
    s_andn2_b64 s[52:53], s[52:53], s[50:51]
    s_or_b64 s[80:81], s[80:81], s[52:53]
    s_not_b64 vcc, s[52:53]
    s_mov_b64 exec, -1
    v_cndmask_b32_dpp v84, v84, v84, vcc wave_shr:1 row_mask:0xf bank_mask:0xf
    v_cndmask_b32_dpp v85, v85, v85, vcc wave_shr:1 row_mask:0xf bank_mask:0xf
    s_lshr_b64 s[52:53], s[52:53], 1
    v_cndmask_b32_dpp v86, v86, v86, vcc wave_shr:1 row_mask:0xf bank_mask:0xf
    v_cndmask_b32_dpp v87, v87, v87, vcc wave_shr:1 row_mask:0xf bank_mask:0xf
    s_andn2_b64 s[82:83], s[82:83], s[52:53]
    v_cndmask_b32_dpp v7, v7, v7, vcc wave_shr:1 row_mask:0xf bank_mask:0xf
    s_mov_b64 exec, s[50:51]
    s_cbranch_scc0 L2_d133
    s_mov_b64 exec, s[82:83]
    s_nop 1
    v_mfma_f32_4x4x4_16b_bf16 v[88:91], v[12:13], v[84:85], 0
    s_nop 1
    v_mfma_f32_4x4x4_16b_bf16 v[88:91], v[10:11], v[86:87], v[88:91]
    s_nop 4
    v_cvt_pk_bf16_f32 v88, v88, v89
    v_cvt_pk_bf16_f32 v89, v90, v91
    ds_pk_add_bf16 v7, v88 offset:65408
    ds_pk_add_bf16 v7, v89 offset:65412
    s_mov_b64 exec, s[50:51]
    s_branch L2_d133
L2_oa134:
    v_and_b32 v47, 0x0fffffff, v21
    buffer_load_dword v114, v47, s[8:11], 0 offen offset:16
    s_mov_b64 exec, s[6:7]
    v_add_u32 v47, 8, v47
    v_lshrrev_b32 v21, 2, v21
    s_mov_b64 exec, -1
    buffer_load_dwordx2 v[112:113], v47, s[8:11], 0 offen
    s_branch L2_ob134
L2_c135:
    s_lshl_b64 s[52:53], s[82:83], 1
    s_andn2_b64 s[52:53], s[52:53], s[80:81]
    s_andn2_b64 s[52:53], s[52:53], s[54:55]
    s_or_b64 s[80:81], s[80:81], s[52:53]
    s_not_b64 vcc, s[52:53]
    s_mov_b64 exec, -1
    v_cndmask_b32_dpp v84, v84, v84, vcc wave_shr:1 row_mask:0xf bank_mask:0xf
    v_cndmask_b32_dpp v85, v85, v85, vcc wave_shr:1 row_mask:0xf bank_mask:0xf
    s_lshr_b64 s[52:53], s[52:53], 1
    v_cndmask_b32_dpp v86, v86, v86, vcc wave_shr:1 row_mask:0xf bank_mask:0xf
    v_cndmask_b32_dpp v87, v87, v87, vcc wave_shr:1 row_mask:0xf bank_mask:0xf
    s_andn2_b64 s[82:83], s[82:83], s[52:53]
    v_cndmask_b32_dpp v7, v7, v7, vcc wave_shr:1 row_mask:0xf bank_mask:0xf
    s_mov_b64 exec, s[54:55]
    s_cbranch_scc0 L2_d135
    s_mov_b64 exec, s[82:83]
    s_nop 1
    v_mfma_f32_4x4x4_16b_bf16 v[88:91], v[12:13], v[84:85], 0
    s_nop 1
    v_mfma_f32_4x4x4_16b_bf16 v[88:91], v[10:11], v[86:87], v[88:91]
    s_nop 4
    v_cvt_pk_bf16_f32 v88, v88, v89
    v_cvt_pk_bf16_f32 v89, v90, v91
    ds_pk_add_bf16 v7, v88 offset:65408
    ds_pk_add_bf16 v7, v89 offset:65412
    s_mov_b64 exec, s[54:55]
    s_branch L2_d135
L2_c136:
    s_lshl_b64 s[52:53], s[82:83], 1
    s_andn2_b64 s[52:53], s[52:53], s[80:81]
    s_andn2_b64 s[52:53], s[52:53], s[50:51]
    s_or_b64 s[80:81], s[80:81], s[52:53]
    s_not_b64 vcc, s[52:53]
    s_mov_b64 exec, -1
    v_cndmask_b32_dpp v84, v84, v84, vcc wave_shr:1 row_mask:0xf bank_mask:0xf
    v_cndmask_b32_dpp v85, v85, v85, vcc wave_shr:1 row_mask:0xf bank_mask:0xf
    s_lshr_b64 s[52:53], s[52:53], 1
    v_cndmask_b32_dpp v86, v86, v86, vcc wave_shr:1 row_mask:0xf bank_mask:0xf
    v_cndmask_b32_dpp v87, v87, v87, vcc wave_shr:1 row_mask:0xf bank_mask:0xf
    s_andn2_b64 s[82:83], s[82:83], s[52:53]
    v_cndmask_b32_dpp v7, v7, v7, vcc wave_shr:1 row_mask:0xf bank_mask:0xf
    s_mov_b64 exec, s[50:51]
    s_cbranch_scc0 L2_d136
    s_mov_b64 exec, s[82:83]
    s_nop 1
    v_mfma_f32_4x4x4_16b_bf16 v[88:91], v[12:13], v[84:85], 0
    s_nop 1
    v_mfma_f32_4x4x4_16b_bf16 v[88:91], v[10:11], v[86:87], v[88:91]
    s_nop 4
    v_cvt_pk_bf16_f32 v88, v88, v89
    v_cvt_pk_bf16_f32 v89, v90, v91
    ds_pk_add_bf16 v7, v88 offset:65408
    ds_pk_add_bf16 v7, v89 offset:65412
    s_mov_b64 exec, s[50:51]
    s_branch L2_d136
L2_c137:
    s_lshl_b64 s[52:53], s[82:83], 1
    s_andn2_b64 s[52:53], s[52:53], s[80:81]
    s_andn2_b64 s[52:53], s[52:53], s[54:55]
    s_or_b64 s[80:81], s[80:81], s[52:53]
    s_not_b64 vcc, s[52:53]
    s_mov_b64 exec, -1
    v_cndmask_b32_dpp v84, v84, v84, vcc wave_shr:1 row_mask:0xf bank_mask:0xf
    v_cndmask_b32_dpp v85, v85, v85, vcc wave_shr:1 row_mask:0xf bank_mask:0xf
    s_lshr_b64 s[52:53], s[52:53], 1
    v_cndmask_b32_dpp v86, v86, v86, vcc wave_shr:1 row_mask:0xf bank_mask:0xf
    v_cndmask_b32_dpp v87, v87, v87, vcc wave_shr:1 row_mask:0xf bank_mask:0xf
    s_andn2_b64 s[82:83], s[82:83], s[52:53]
    v_cndmask_b32_dpp v7, v7, v7, vcc wave_shr:1 row_mask:0xf bank_mask:0xf
    s_mov_b64 exec, s[54:55]
    s_cbranch_scc0 L2_d137
    s_mov_b64 exec, s[82:83]
    s_nop 1
    v_mfma_f32_4x4x4_16b_bf16 v[88:91], v[12:13], v[84:85], 0
    s_nop 1
    v_mfma_f32_4x4x4_16b_bf16 v[88:91], v[10:11], v[86:87], v[88:91]
    s_nop 4
    v_cvt_pk_bf16_f32 v88, v88, v89
    v_cvt_pk_bf16_f32 v89, v90, v91
    ds_pk_add_bf16 v7, v88 offset:65408
    ds_pk_add_bf16 v7, v89 offset:65412
    s_mov_b64 exec, s[54:55]
    s_branch L2_d137
L2_c138:
    s_lshl_b64 s[52:53], s[82:83], 1
    s_andn2_b64 s[52:53], s[52:53], s[80:81]
    s_andn2_b64 s[52:53], s[52:53], s[50:51]
    s_or_b64 s[80:81], s[80:81], s[52:53]
    s_not_b64 vcc, s[52:53]
    s_mov_b64 exec, -1
    v_cndmask_b32_dpp v84, v84, v84, vcc wave_shr:1 row_mask:0xf bank_mask:0xf
    v_cndmask_b32_dpp v85, v85, v85, vcc wave_shr:1 row_mask:0xf bank_mask:0xf
    s_lshr_b64 s[52:53], s[52:53], 1
    v_cndmask_b32_dpp v86, v86, v86, vcc wave_shr:1 row_mask:0xf bank_mask:0xf
    v_cndmask_b32_dpp v87, v87, v87, vcc wave_shr:1 row_mask:0xf bank_mask:0xf
    s_andn2_b64 s[82:83], s[82:83], s[52:53]
    v_cndmask_b32_dpp v7, v7, v7, vcc wave_shr:1 row_mask:0xf bank_mask:0xf
    s_mov_b64 exec, s[50:51]
    s_cbranch_scc0 L2_d138
    s_mov_b64 exec, s[82:83]
    s_nop 1
    v_mfma_f32_4x4x4_16b_bf16 v[88:91], v[12:13], v[84:85], 0
    s_nop 1
    v_mfma_f32_4x4x4_16b_bf16 v[88:91], v[10:11], v[86:87], v[88:91]
    s_nop 4
    v_cvt_pk_bf16_f32 v88, v88, v89
    v_cvt_pk_bf16_f32 v89, v90, v91
    ds_pk_add_bf16 v7, v88 offset:65408
    ds_pk_add_bf16 v7, v89 offset:65412
    s_mov_b64 exec, s[50:51]
    s_branch L2_d138
L2_c139:
    s_lshl_b64 s[52:53], s[82:83], 1
    s_andn2_b64 s[52:53], s[52:53], s[80:81]
    s_andn2_b64 s[52:53], s[52:53], s[54:55]
    s_or_b64 s[80:81], s[80:81], s[52:53]
    s_not_b64 vcc, s[52:53]
    s_mov_b64 exec, -1
    v_cndmask_b32_dpp v84, v84, v84, vcc wave_shr:1 row_mask:0xf bank_mask:0xf
    v_cndmask_b32_dpp v85, v85, v85, vcc wave_shr:1 row_mask:0xf bank_mask:0xf
    s_lshr_b64 s[52:53], s[52:53], 1
    v_cndmask_b32_dpp v86, v86, v86, vcc wave_shr:1 row_mask:0xf bank_mask:0xf
    v_cndmask_b32_dpp v87, v87, v87, vcc wave_shr:1 row_mask:0xf bank_mask:0xf
    s_andn2_b64 s[82:83], s[82:83], s[52:53]
    v_cndmask_b32_dpp v7, v7, v7, vcc wave_shr:1 row_mask:0xf bank_mask:0xf
    s_mov_b64 exec, s[54:55]
    s_cbranch_scc0 L2_d139
    s_mov_b64 exec, s[82:83]
    s_nop 1
    v_mfma_f32_4x4x4_16b_bf16 v[88:91], v[12:13], v[84:85], 0
    s_nop 1
    v_mfma_f32_4x4x4_16b_bf16 v[88:91], v[10:11], v[86:87], v[88:91]
    s_nop 4
    v_cvt_pk_bf16_f32 v88, v88, v89
    v_cvt_pk_bf16_f32 v89, v90, v91
    ds_pk_add_bf16 v7, v88 offset:65408
    ds_pk_add_bf16 v7, v89 offset:65412
    s_mov_b64 exec, s[54:55]
    s_branch L2_d139
L2_c140:
    s_lshl_b64 s[52:53], s[82:83], 1
    s_andn2_b64 s[52:53], s[52:53], s[80:81]
    s_andn2_b64 s[52:53], s[52:53], s[50:51]
    s_or_b64 s[80:81], s[80:81], s[52:53]
    s_not_b64 vcc, s[52:53]
    s_mov_b64 exec, -1
    v_cndmask_b32_dpp v84, v84, v84, vcc wave_shr:1 row_mask:0xf bank_mask:0xf
    v_cndmask_b32_dpp v85, v85, v85, vcc wave_shr:1 row_mask:0xf bank_mask:0xf
    s_lshr_b64 s[52:53], s[52:53], 1
    v_cndmask_b32_dpp v86, v86, v86, vcc wave_shr:1 row_mask:0xf bank_mask:0xf
    v_cndmask_b32_dpp v87, v87, v87, vcc wave_shr:1 row_mask:0xf bank_mask:0xf
    s_andn2_b64 s[82:83], s[82:83], s[52:53]
    v_cndmask_b32_dpp v7, v7, v7, vcc wave_shr:1 row_mask:0xf bank_mask:0xf
    s_mov_b64 exec, s[50:51]
    s_cbranch_scc0 L2_d140
    s_mov_b64 exec, s[82:83]
    s_nop 1
    v_mfma_f32_4x4x4_16b_bf16 v[88:91], v[12:13], v[84:85], 0
    s_nop 1
    v_mfma_f32_4x4x4_16b_bf16 v[88:91], v[10:11], v[86:87], v[88:91]
    s_nop 4
    v_cvt_pk_bf16_f32 v88, v88, v89
    v_cvt_pk_bf16_f32 v89, v90, v91
    ds_pk_add_bf16 v7, v88 offset:65408
    ds_pk_add_bf16 v7, v89 offset:65412
    s_mov_b64 exec, s[50:51]
    s_branch L2_d140
L2_c141:
    s_lshl_b64 s[52:53], s[82:83], 1
    s_andn2_b64 s[52:53], s[52:53], s[80:81]
    s_andn2_b64 s[52:53], s[52:53], s[54:55]
    s_or_b64 s[80:81], s[80:81], s[52:53]
    s_not_b64 vcc, s[52:53]
    s_mov_b64 exec, -1
    v_cndmask_b32_dpp v84, v84, v84, vcc wave_shr:1 row_mask:0xf bank_mask:0xf
    v_cndmask_b32_dpp v85, v85, v85, vcc wave_shr:1 row_mask:0xf bank_mask:0xf
    s_lshr_b64 s[52:53], s[52:53], 1
    v_cndmask_b32_dpp v86, v86, v86, vcc wave_shr:1 row_mask:0xf bank_mask:0xf
    v_cndmask_b32_dpp v87, v87, v87, vcc wave_shr:1 row_mask:0xf bank_mask:0xf
    s_andn2_b64 s[82:83], s[82:83], s[52:53]
    v_cndmask_b32_dpp v7, v7, v7, vcc wave_shr:1 row_mask:0xf bank_mask:0xf
    s_mov_b64 exec, s[54:55]
    s_cbranch_scc0 L2_d141
    s_mov_b64 exec, s[82:83]
    s_nop 1
    v_mfma_f32_4x4x4_16b_bf16 v[88:91], v[12:13], v[84:85], 0
    s_nop 1
    v_mfma_f32_4x4x4_16b_bf16 v[88:91], v[10:11], v[86:87], v[88:91]
    s_nop 4
    v_cvt_pk_bf16_f32 v88, v88, v89
    v_cvt_pk_bf16_f32 v89, v90, v91
    ds_pk_add_bf16 v7, v88 offset:65408
    ds_pk_add_bf16 v7, v89 offset:65412
    s_mov_b64 exec, s[54:55]
    s_branch L2_d141
L2_c142:
    s_lshl_b64 s[52:53], s[82:83], 1
    s_andn2_b64 s[52:53], s[52:53], s[80:81]
    s_andn2_b64 s[52:53], s[52:53], s[50:51]
    s_or_b64 s[80:81], s[80:81], s[52:53]
    s_not_b64 vcc, s[52:53]
    s_mov_b64 exec, -1
    v_cndmask_b32_dpp v84, v84, v84, vcc wave_shr:1 row_mask:0xf bank_mask:0xf
    v_cndmask_b32_dpp v85, v85, v85, vcc wave_shr:1 row_mask:0xf bank_mask:0xf
    s_lshr_b64 s[52:53], s[52:53], 1
    v_cndmask_b32_dpp v86, v86, v86, vcc wave_shr:1 row_mask:0xf bank_mask:0xf
    v_cndmask_b32_dpp v87, v87, v87, vcc wave_shr:1 row_mask:0xf bank_mask:0xf
    s_andn2_b64 s[82:83], s[82:83], s[52:53]
    v_cndmask_b32_dpp v7, v7, v7, vcc wave_shr:1 row_mask:0xf bank_mask:0xf
    s_mov_b64 exec, s[50:51]
    s_cbranch_scc0 L2_d142
    s_mov_b64 exec, s[82:83]
    s_nop 1
    v_mfma_f32_4x4x4_16b_bf16 v[88:91], v[12:13], v[84:85], 0
    s_nop 1
    v_mfma_f32_4x4x4_16b_bf16 v[88:91], v[10:11], v[86:87], v[88:91]
    s_nop 4
    v_cvt_pk_bf16_f32 v88, v88, v89
    v_cvt_pk_bf16_f32 v89, v90, v91
    ds_pk_add_bf16 v7, v88 offset:65408
    ds_pk_add_bf16 v7, v89 offset:65412
    s_mov_b64 exec, s[50:51]
    s_branch L2_d142
L2_oa143:
    s_waitcnt vmcnt(7)
    s_mov_b64 exec, s[6:7]
    v_lshrrev_b32 v114, 16, v114
    s_mov_b64 exec, -1
    v_and_b32 v46, 0x10000000, v21
    v_cmpx_eq_u32 vcc, 0, v46
    v_lshrrev_b32 v47, 14, v112
    v_and_b32 v47, v5, v47
    ds_read_b64 v[96:97], v47
    v_perm_b32 v98, v112, v114, s44
    v_bitop3_b32 v99, v112, 0.5, -0.5 bitop3:0xa8
    v_bitop3_b32 v98, v6, v98, v99 bitop3:0xca
    v_and_b32 v47, v5, v112
    s_waitcnt lgkmcnt(0)
    v_mfma_f32_4x4x4_16b_bf16 v[88:91], v[8:9], v[96:97], 0
    s_nop 4
    v_mul_f32 v88, v98, v88
    v_mul_f32 v89, v98, v89
    v_mul_f32 v90, v98, v90
    v_mul_f32 v91, v98, v91
    v_cvt_pk_bf16_f32 v88, v88, v89
    v_cvt_pk_bf16_f32 v89, v90, v91
    ds_pk_add_bf16 v47, v88 offset:65408
    ds_pk_add_bf16 v47, v89 offset:65412
    s_mov_b64 exec, -1
    v_and_b32 v46, 0x20000000, v21
    v_cmpx_eq_u32 vcc, 0, v46
    v_lshrrev_b32 v47, 14, v113
    v_and_b32 v47, v5, v47
    ds_read_b64 v[96:97], v47
    v_perm_b32 v98, v113, v114, s45
    v_bitop3_b32 v99, v113, 0.5, -0.5 bitop3:0xa8
    v_bitop3_b32 v98, v6, v98, v99 bitop3:0xca
    v_and_b32 v47, v5, v113
    s_waitcnt lgkmcnt(0)
    v_mfma_f32_4x4x4_16b_bf16 v[88:91], v[8:9], v[96:97], 0
    s_nop 4
    v_mul_f32 v88, v98, v88
    v_mul_f32 v89, v98, v89
    v_mul_f32 v90, v98, v90
    v_mul_f32 v91, v98, v91
    v_cvt_pk_bf16_f32 v88, v88, v89
    v_cvt_pk_bf16_f32 v89, v90, v91
    ds_pk_add_bf16 v47, v88 offset:65408
    ds_pk_add_bf16 v47, v89 offset:65412
    s_mov_b64 exec, -1
    s_branch L2_ob143
L2_c144:
    s_lshl_b64 s[52:53], s[82:83], 1
    s_andn2_b64 s[52:53], s[52:53], s[80:81]
    s_andn2_b64 s[52:53], s[52:53], s[54:55]
    s_or_b64 s[80:81], s[80:81], s[52:53]
    s_not_b64 vcc, s[52:53]
    s_mov_b64 exec, -1
    v_cndmask_b32_dpp v84, v84, v84, vcc wave_shr:1 row_mask:0xf bank_mask:0xf
    v_cndmask_b32_dpp v85, v85, v85, vcc wave_shr:1 row_mask:0xf bank_mask:0xf
    s_lshr_b64 s[52:53], s[52:53], 1
    v_cndmask_b32_dpp v86, v86, v86, vcc wave_shr:1 row_mask:0xf bank_mask:0xf
    v_cndmask_b32_dpp v87, v87, v87, vcc wave_shr:1 row_mask:0xf bank_mask:0xf
    s_andn2_b64 s[82:83], s[82:83], s[52:53]
    v_cndmask_b32_dpp v7, v7, v7, vcc wave_shr:1 row_mask:0xf bank_mask:0xf
    s_mov_b64 exec, s[54:55]
    s_cbranch_scc0 L2_d144
    s_mov_b64 exec, s[82:83]
    s_nop 1
    v_mfma_f32_4x4x4_16b_bf16 v[88:91], v[12:13], v[84:85], 0
    s_nop 1
    v_mfma_f32_4x4x4_16b_bf16 v[88:91], v[10:11], v[86:87], v[88:91]
    s_nop 4
    v_cvt_pk_bf16_f32 v88, v88, v89
    v_cvt_pk_bf16_f32 v89, v90, v91
    ds_pk_add_bf16 v7, v88 offset:65408
    ds_pk_add_bf16 v7, v89 offset:65412
    s_mov_b64 exec, s[54:55]
    s_branch L2_d144
L2_c145:
    s_lshl_b64 s[52:53], s[82:83], 1
    s_andn2_b64 s[52:53], s[52:53], s[80:81]
    s_andn2_b64 s[52:53], s[52:53], s[50:51]
    s_or_b64 s[80:81], s[80:81], s[52:53]
    s_not_b64 vcc, s[52:53]
    s_mov_b64 exec, -1
    v_cndmask_b32_dpp v84, v84, v84, vcc wave_shr:1 row_mask:0xf bank_mask:0xf
    v_cndmask_b32_dpp v85, v85, v85, vcc wave_shr:1 row_mask:0xf bank_mask:0xf
    s_lshr_b64 s[52:53], s[52:53], 1
    v_cndmask_b32_dpp v86, v86, v86, vcc wave_shr:1 row_mask:0xf bank_mask:0xf
    v_cndmask_b32_dpp v87, v87, v87, vcc wave_shr:1 row_mask:0xf bank_mask:0xf
    s_andn2_b64 s[82:83], s[82:83], s[52:53]
    v_cndmask_b32_dpp v7, v7, v7, vcc wave_shr:1 row_mask:0xf bank_mask:0xf
    s_mov_b64 exec, s[50:51]
    s_cbranch_scc0 L2_d145
    s_mov_b64 exec, s[82:83]
    s_nop 1
    v_mfma_f32_4x4x4_16b_bf16 v[88:91], v[12:13], v[84:85], 0
    s_nop 1
    v_mfma_f32_4x4x4_16b_bf16 v[88:91], v[10:11], v[86:87], v[88:91]
    s_nop 4
    v_cvt_pk_bf16_f32 v88, v88, v89
    v_cvt_pk_bf16_f32 v89, v90, v91
    ds_pk_add_bf16 v7, v88 offset:65408
    ds_pk_add_bf16 v7, v89 offset:65412
    s_mov_b64 exec, s[50:51]
    s_branch L2_d145
L2_c146:
    s_lshl_b64 s[52:53], s[82:83], 1
    s_andn2_b64 s[52:53], s[52:53], s[80:81]
    s_andn2_b64 s[52:53], s[52:53], s[54:55]
    s_or_b64 s[80:81], s[80:81], s[52:53]
    s_not_b64 vcc, s[52:53]
    s_mov_b64 exec, -1
    v_cndmask_b32_dpp v84, v84, v84, vcc wave_shr:1 row_mask:0xf bank_mask:0xf
    v_cndmask_b32_dpp v85, v85, v85, vcc wave_shr:1 row_mask:0xf bank_mask:0xf
    s_lshr_b64 s[52:53], s[52:53], 1
    v_cndmask_b32_dpp v86, v86, v86, vcc wave_shr:1 row_mask:0xf bank_mask:0xf
    v_cndmask_b32_dpp v87, v87, v87, vcc wave_shr:1 row_mask:0xf bank_mask:0xf
    s_andn2_b64 s[82:83], s[82:83], s[52:53]
    v_cndmask_b32_dpp v7, v7, v7, vcc wave_shr:1 row_mask:0xf bank_mask:0xf
    s_mov_b64 exec, s[54:55]
    s_cbranch_scc0 L2_d146
    s_mov_b64 exec, s[82:83]
    s_nop 1
    v_mfma_f32_4x4x4_16b_bf16 v[88:91], v[12:13], v[84:85], 0
    s_nop 1
    v_mfma_f32_4x4x4_16b_bf16 v[88:91], v[10:11], v[86:87], v[88:91]
    s_nop 4
    v_cvt_pk_bf16_f32 v88, v88, v89
    v_cvt_pk_bf16_f32 v89, v90, v91
    ds_pk_add_bf16 v7, v88 offset:65408
    ds_pk_add_bf16 v7, v89 offset:65412
    s_mov_b64 exec, s[54:55]
    s_branch L2_d146
L2_c147:
    s_lshl_b64 s[52:53], s[82:83], 1
    s_andn2_b64 s[52:53], s[52:53], s[80:81]
    s_andn2_b64 s[52:53], s[52:53], s[50:51]
    s_or_b64 s[80:81], s[80:81], s[52:53]
    s_not_b64 vcc, s[52:53]
    s_mov_b64 exec, -1
    v_cndmask_b32_dpp v84, v84, v84, vcc wave_shr:1 row_mask:0xf bank_mask:0xf
    v_cndmask_b32_dpp v85, v85, v85, vcc wave_shr:1 row_mask:0xf bank_mask:0xf
    s_lshr_b64 s[52:53], s[52:53], 1
    v_cndmask_b32_dpp v86, v86, v86, vcc wave_shr:1 row_mask:0xf bank_mask:0xf
    v_cndmask_b32_dpp v87, v87, v87, vcc wave_shr:1 row_mask:0xf bank_mask:0xf
    s_andn2_b64 s[82:83], s[82:83], s[52:53]
    v_cndmask_b32_dpp v7, v7, v7, vcc wave_shr:1 row_mask:0xf bank_mask:0xf
    s_mov_b64 exec, s[50:51]
    s_cbranch_scc0 L2_d147
    s_mov_b64 exec, s[82:83]
    s_nop 1
    v_mfma_f32_4x4x4_16b_bf16 v[88:91], v[12:13], v[84:85], 0
    s_nop 1
    v_mfma_f32_4x4x4_16b_bf16 v[88:91], v[10:11], v[86:87], v[88:91]
    s_nop 4
    v_cvt_pk_bf16_f32 v88, v88, v89
    v_cvt_pk_bf16_f32 v89, v90, v91
    ds_pk_add_bf16 v7, v88 offset:65408
    ds_pk_add_bf16 v7, v89 offset:65412
    s_mov_b64 exec, s[50:51]
    s_branch L2_d147
L2_c148:
    s_lshl_b64 s[52:53], s[82:83], 1
    s_andn2_b64 s[52:53], s[52:53], s[80:81]
    s_andn2_b64 s[52:53], s[52:53], s[54:55]
    s_or_b64 s[80:81], s[80:81], s[52:53]
    s_not_b64 vcc, s[52:53]
    s_mov_b64 exec, -1
    v_cndmask_b32_dpp v84, v84, v84, vcc wave_shr:1 row_mask:0xf bank_mask:0xf
    v_cndmask_b32_dpp v85, v85, v85, vcc wave_shr:1 row_mask:0xf bank_mask:0xf
    s_lshr_b64 s[52:53], s[52:53], 1
    v_cndmask_b32_dpp v86, v86, v86, vcc wave_shr:1 row_mask:0xf bank_mask:0xf
    v_cndmask_b32_dpp v87, v87, v87, vcc wave_shr:1 row_mask:0xf bank_mask:0xf
    s_andn2_b64 s[82:83], s[82:83], s[52:53]
    v_cndmask_b32_dpp v7, v7, v7, vcc wave_shr:1 row_mask:0xf bank_mask:0xf
    s_mov_b64 exec, s[54:55]
    s_cbranch_scc0 L2_d148
    s_mov_b64 exec, s[82:83]
    s_nop 1
    v_mfma_f32_4x4x4_16b_bf16 v[88:91], v[12:13], v[84:85], 0
    s_nop 1
    v_mfma_f32_4x4x4_16b_bf16 v[88:91], v[10:11], v[86:87], v[88:91]
    s_nop 4
    v_cvt_pk_bf16_f32 v88, v88, v89
    v_cvt_pk_bf16_f32 v89, v90, v91
    ds_pk_add_bf16 v7, v88 offset:65408
    ds_pk_add_bf16 v7, v89 offset:65412
    s_mov_b64 exec, s[54:55]
    s_branch L2_d148
L2_c149:
    s_lshl_b64 s[52:53], s[82:83], 1
    s_andn2_b64 s[52:53], s[52:53], s[80:81]
    s_andn2_b64 s[52:53], s[52:53], s[50:51]
    s_or_b64 s[80:81], s[80:81], s[52:53]
    s_not_b64 vcc, s[52:53]
    s_mov_b64 exec, -1
    v_cndmask_b32_dpp v84, v84, v84, vcc wave_shr:1 row_mask:0xf bank_mask:0xf
    v_cndmask_b32_dpp v85, v85, v85, vcc wave_shr:1 row_mask:0xf bank_mask:0xf
    s_lshr_b64 s[52:53], s[52:53], 1
    v_cndmask_b32_dpp v86, v86, v86, vcc wave_shr:1 row_mask:0xf bank_mask:0xf
    v_cndmask_b32_dpp v87, v87, v87, vcc wave_shr:1 row_mask:0xf bank_mask:0xf
    s_andn2_b64 s[82:83], s[82:83], s[52:53]
    v_cndmask_b32_dpp v7, v7, v7, vcc wave_shr:1 row_mask:0xf bank_mask:0xf
    s_mov_b64 exec, s[50:51]
    s_cbranch_scc0 L2_d149
    s_mov_b64 exec, s[82:83]
    s_nop 1
    v_mfma_f32_4x4x4_16b_bf16 v[88:91], v[12:13], v[84:85], 0
    s_nop 1
    v_mfma_f32_4x4x4_16b_bf16 v[88:91], v[10:11], v[86:87], v[88:91]
    s_nop 4
    v_cvt_pk_bf16_f32 v88, v88, v89
    v_cvt_pk_bf16_f32 v89, v90, v91
    ds_pk_add_bf16 v7, v88 offset:65408
    ds_pk_add_bf16 v7, v89 offset:65412
    s_mov_b64 exec, s[50:51]
    s_branch L2_d149
L2_c150:
    s_lshl_b64 s[52:53], s[82:83], 1
    s_andn2_b64 s[52:53], s[52:53], s[80:81]
    s_andn2_b64 s[52:53], s[52:53], s[54:55]
    s_or_b64 s[80:81], s[80:81], s[52:53]
    s_not_b64 vcc, s[52:53]
    s_mov_b64 exec, -1
    v_cndmask_b32_dpp v84, v84, v84, vcc wave_shr:1 row_mask:0xf bank_mask:0xf
    v_cndmask_b32_dpp v85, v85, v85, vcc wave_shr:1 row_mask:0xf bank_mask:0xf
    s_lshr_b64 s[52:53], s[52:53], 1
    v_cndmask_b32_dpp v86, v86, v86, vcc wave_shr:1 row_mask:0xf bank_mask:0xf
    v_cndmask_b32_dpp v87, v87, v87, vcc wave_shr:1 row_mask:0xf bank_mask:0xf
    s_andn2_b64 s[82:83], s[82:83], s[52:53]
    v_cndmask_b32_dpp v7, v7, v7, vcc wave_shr:1 row_mask:0xf bank_mask:0xf
    s_mov_b64 exec, s[54:55]
    s_cbranch_scc0 L2_d150
    s_mov_b64 exec, s[82:83]
    s_nop 1
    v_mfma_f32_4x4x4_16b_bf16 v[88:91], v[12:13], v[84:85], 0
    s_nop 1
    v_mfma_f32_4x4x4_16b_bf16 v[88:91], v[10:11], v[86:87], v[88:91]
    s_nop 4
    v_cvt_pk_bf16_f32 v88, v88, v89
    v_cvt_pk_bf16_f32 v89, v90, v91
    ds_pk_add_bf16 v7, v88 offset:65408
    ds_pk_add_bf16 v7, v89 offset:65412
    s_mov_b64 exec, s[54:55]
    s_branch L2_d150
L2_c151:
    s_lshl_b64 s[52:53], s[82:83], 1
    s_andn2_b64 s[52:53], s[52:53], s[80:81]
    s_andn2_b64 s[52:53], s[52:53], s[50:51]
    s_or_b64 s[80:81], s[80:81], s[52:53]
    s_not_b64 vcc, s[52:53]
    s_mov_b64 exec, -1
    v_cndmask_b32_dpp v84, v84, v84, vcc wave_shr:1 row_mask:0xf bank_mask:0xf
    v_cndmask_b32_dpp v85, v85, v85, vcc wave_shr:1 row_mask:0xf bank_mask:0xf
    s_lshr_b64 s[52:53], s[52:53], 1
    v_cndmask_b32_dpp v86, v86, v86, vcc wave_shr:1 row_mask:0xf bank_mask:0xf
    v_cndmask_b32_dpp v87, v87, v87, vcc wave_shr:1 row_mask:0xf bank_mask:0xf
    s_andn2_b64 s[82:83], s[82:83], s[52:53]
    v_cndmask_b32_dpp v7, v7, v7, vcc wave_shr:1 row_mask:0xf bank_mask:0xf
    s_mov_b64 exec, s[50:51]
    s_cbranch_scc0 L2_d151
    s_mov_b64 exec, s[82:83]
    s_nop 1
    v_mfma_f32_4x4x4_16b_bf16 v[88:91], v[12:13], v[84:85], 0
    s_nop 1
    v_mfma_f32_4x4x4_16b_bf16 v[88:91], v[10:11], v[86:87], v[88:91]
    s_nop 4
    v_cvt_pk_bf16_f32 v88, v88, v89
    v_cvt_pk_bf16_f32 v89, v90, v91
    ds_pk_add_bf16 v7, v88 offset:65408
    ds_pk_add_bf16 v7, v89 offset:65412
    s_mov_b64 exec, s[50:51]
    s_branch L2_d151
L2_c152:
    s_mov_b64 s[50:51], vcc
    s_lshl_b64 s[52:53], s[82:83], 1
    s_andn2_b64 s[52:53], s[52:53], s[80:81]
    s_andn2_b64 s[52:53], s[52:53], s[50:51]
    s_or_b64 s[80:81], s[80:81], s[52:53]
    s_not_b64 vcc, s[52:53]
    s_mov_b64 exec, -1
    v_cndmask_b32_dpp v84, v84, v84, vcc wave_shr:1 row_mask:0xf bank_mask:0xf
    v_cndmask_b32_dpp v85, v85, v85, vcc wave_shr:1 row_mask:0xf bank_mask:0xf
    s_lshr_b64 s[52:53], s[52:53], 1
    v_cndmask_b32_dpp v86, v86, v86, vcc wave_shr:1 row_mask:0xf bank_mask:0xf
    v_cndmask_b32_dpp v87, v87, v87, vcc wave_shr:1 row_mask:0xf bank_mask:0xf
    s_andn2_b64 s[82:83], s[82:83], s[52:53]
    v_cndmask_b32_dpp v7, v7, v7, vcc wave_shr:1 row_mask:0xf bank_mask:0xf
    s_mov_b64 vcc, s[50:51]
    s_mov_b64 exec, s[50:51]
    s_cbranch_scc0 L2_d152
    s_mov_b64 exec, s[82:83]
    s_nop 1
    v_mfma_f32_4x4x4_16b_bf16 v[88:91], v[12:13], v[84:85], 0
    s_nop 1
    v_mfma_f32_4x4x4_16b_bf16 v[88:91], v[10:11], v[86:87], v[88:91]
    s_nop 4
    v_cvt_pk_bf16_f32 v88, v88, v89
    v_cvt_pk_bf16_f32 v89, v90, v91
    ds_pk_add_bf16 v7, v88 offset:65408
    ds_pk_add_bf16 v7, v89 offset:65412
    s_mov_b64 exec, vcc
    s_branch L2_d152
L2_c153:
    s_mov_b64 s[50:51], vcc
    s_lshl_b64 s[52:53], s[82:83], 1
    s_andn2_b64 s[52:53], s[52:53], s[80:81]
    s_andn2_b64 s[52:53], s[52:53], s[50:51]
    s_or_b64 s[80:81], s[80:81], s[52:53]
    s_not_b64 vcc, s[52:53]
    s_mov_b64 exec, -1
    v_cndmask_b32_dpp v84, v84, v84, vcc wave_shr:1 row_mask:0xf bank_mask:0xf
    v_cndmask_b32_dpp v85, v85, v85, vcc wave_shr:1 row_mask:0xf bank_mask:0xf
    s_lshr_b64 s[52:53], s[52:53], 1
    v_cndmask_b32_dpp v86, v86, v86, vcc wave_shr:1 row_mask:0xf bank_mask:0xf
    v_cndmask_b32_dpp v87, v87, v87, vcc wave_shr:1 row_mask:0xf bank_mask:0xf
    s_andn2_b64 s[82:83], s[82:83], s[52:53]
    v_cndmask_b32_dpp v7, v7, v7, vcc wave_shr:1 row_mask:0xf bank_mask:0xf
    s_mov_b64 vcc, s[50:51]
    s_mov_b64 exec, s[50:51]
    s_cbranch_scc0 L2_d153
    s_mov_b64 exec, s[82:83]
    s_nop 1
    v_mfma_f32_4x4x4_16b_bf16 v[88:91], v[12:13], v[84:85], 0
    s_nop 1
    v_mfma_f32_4x4x4_16b_bf16 v[88:91], v[10:11], v[86:87], v[88:91]
    s_nop 4
    v_cvt_pk_bf16_f32 v88, v88, v89
    v_cvt_pk_bf16_f32 v89, v90, v91
    ds_pk_add_bf16 v7, v88 offset:65408
    ds_pk_add_bf16 v7, v89 offset:65412
    s_mov_b64 exec, vcc
    s_branch L2_d153
L2_f3s:
    s_branch L2_f3
.section .rodata,"a"
.p2align 6
.amdhsa_kernel gather_scatter__molecular_angular_gemnet__graph_kernel
  .amdhsa_next_free_vgpr 128
  .amdhsa_next_free_sgpr 102
  .amdhsa_accum_offset 128
  .amdhsa_group_segment_fixed_size 0
  .amdhsa_kernarg_size 112
  .amdhsa_user_sgpr_count 2
  .amdhsa_user_sgpr_kernarg_segment_ptr 1
  .amdhsa_system_sgpr_workgroup_id_x 1
  .amdhsa_float_denorm_mode_32 3
.end_amdhsa_kernel
```

```asm
; @launch grid=(256,1,1) block=(1024,1,1) lds=163840
.amdgcn_target "amdgcn-amd-amdhsa--gfx950"
.text
.globl gather_scatter__molecular_angular_gemnet__graph_kernel
.p2align 8
.type gather_scatter__molecular_angular_gemnet__graph_kernel,@function
gather_scatter__molecular_angular_gemnet__graph_kernel:
    s_cmp_ge_u32 s2, 256
    s_cbranch_scc0 L1_go
    s_endpgm
L1_go:
    s_load_dwordx2 s[8:9], s[0:1], 8
    s_load_dwordx2 s[12:13], s[0:1], 16
    s_load_dwordx2 s[16:17], s[0:1], 32
    s_load_dwordx2 s[30:31], s[0:1], 104
    s_load_dwordx2 s[56:57], s[0:1], 96
    s_load_dwordx2 s[86:87], s[0:1], 0
    s_load_dwordx4 s[60:63], s[0:1], 56
    s_load_dwordx4 s[64:67], s[0:1], 72
    v_lshrrev_b32 v7, 6, v0
    v_lshlrev_b32 v1, 3, v0
    v_readfirstlane_b32 s32, v7
    v_lshlrev_b32 v0, 4, v0
    v_and_b32 v1, 0x1f8, v1
    s_lshr_b32 s3, s32, 1
    s_and_b32 s44, s32, 1
    s_lshl_b32 s44, s44, 3
    s_or_b32 s3, s3, s44
    s_lshl_b32 s3, s3, 10
    s_lshl_b32 s96, s2, 14
    s_add_u32 s96, s96, s3
    s_mov_b32 s10, 0x9c40000
    s_mov_b32 s11, 0x20000
    s_mov_b32 s14, 0x9c40000
    s_mov_b32 s15, 0x20000
    s_mov_b32 s18, 0x4e20000
    s_mov_b32 s19, 0x20000
    s_waitcnt lgkmcnt(0)
    s_add_u32 s44, s96, 0x0
    v_lshlrev_b32 v16, 1, v1
    buffer_load_dwordx4 v[16:19], v16, s[8:11], s44 offen nt
    s_add_u32 s45, s96, 0x0
    v_lshlrev_b32 v20, 1, v1
    buffer_load_dwordx4 v[20:23], v20, s[12:15], s45 offen nt
    s_add_u32 s46, s96, 0x0
    s_lshr_b32 s46, s46, 1
    buffer_load_dwordx2 v[24:25], v1, s[16:19], s46 offen nt
    s_add_u32 s47, s96, 0x400000
    s_lshr_b32 s47, s47, 1
    buffer_load_dwordx2 v[26:27], v1, s[16:19], s47 offen nt
    s_add_u32 s44, s96, 0x400000
    v_lshlrev_b32 v28, 1, v1
    buffer_load_dwordx4 v[28:31], v28, s[8:11], s44 offen nt
    s_add_u32 s45, s96, 0x400000
    v_lshlrev_b32 v32, 1, v1
    buffer_load_dwordx4 v[32:35], v32, s[12:15], s45 offen nt
    s_add_u32 s46, s96, 0x800000
    v_lshlrev_b32 v36, 1, v1
    buffer_load_dwordx4 v[36:39], v36, s[8:11], s46 offen nt
    s_add_u32 s47, s96, 0x800000
    v_lshlrev_b32 v40, 1, v1
    buffer_load_dwordx4 v[40:43], v40, s[12:15], s47 offen nt
    s_add_u32 s44, s96, 0x800000
    s_lshr_b32 s44, s44, 1
    buffer_load_dwordx2 v[44:45], v1, s[16:19], s44 offen nt
    s_add_u32 s45, s96, 0xc00000
    s_lshr_b32 s45, s45, 1
    buffer_load_dwordx2 v[46:47], v1, s[16:19], s45 offen nt
    s_mov_b32 s68, s62
    s_mov_b32 s69, s63
    s_mov_b32 s70, 0x40
    s_mov_b32 s71, 0x20000
    s_mov_b32 s72, s60
    s_mov_b32 s73, s61
    s_mov_b32 s74, 0x40
    s_mov_b32 s75, 0x20000
    s_mov_b32 s20, s66
    s_mov_b32 s21, s67
    s_mov_b32 s22, 0x20
    s_mov_b32 s23, 0x20000
    s_mov_b32 s80, s64
    s_mov_b32 s81, s65
    s_mov_b32 s82, 0x20
    s_mov_b32 s83, 0x20000
    s_add_u32 s24, s30, 0xec54000
    s_addc_u32 s25, s31, 0
    s_mov_b32 s26, 0x100
    s_mov_b32 s27, 0x20000
    v_lshrrev_b32 v2, 3, v0
    v_and_b32 v2, 6, v2
    v_lshlrev_b32 v3, 2, v0
    s_lshl_b32 s3, s32, 8
    s_add_u32 s3, s3, s2
    s_cmp_lg_u32 s3, 254
    s_cbranch_scc1 L1_wt
    buffer_load_ushort v116, v2, s[68:71], 0 offen offset:0
    buffer_load_ushort v108, v2, s[68:71], 0 offen offset:8
    buffer_load_ushort v117, v2, s[68:71], 0 offen offset:16
    buffer_load_ushort v109, v2, s[68:71], 0 offen offset:24
    buffer_load_ushort v118, v2, s[68:71], 0 offen offset:32
    buffer_load_ushort v110, v2, s[68:71], 0 offen offset:40
    buffer_load_ushort v119, v2, s[68:71], 0 offen offset:48
    buffer_load_ushort v111, v2, s[68:71], 0 offen offset:56
    buffer_load_ushort v120, v2, s[72:75], 0 offen offset:0
    buffer_load_ushort v100, v2, s[72:75], 0 offen offset:8
    buffer_load_ushort v121, v2, s[72:75], 0 offen offset:16
    buffer_load_ushort v101, v2, s[72:75], 0 offen offset:24
    buffer_load_ushort v122, v2, s[72:75], 0 offen offset:32
    buffer_load_ushort v102, v2, s[72:75], 0 offen offset:40
    buffer_load_ushort v123, v2, s[72:75], 0 offen offset:48
    buffer_load_ushort v103, v2, s[72:75], 0 offen offset:56
    buffer_load_ushort v124, v2, s[20:23], 0 offen offset:0
    buffer_load_ushort v112, v2, s[20:23], 0 offen offset:8
    buffer_load_ushort v125, v2, s[20:23], 0 offen offset:16
    buffer_load_ushort v113, v2, s[20:23], 0 offen offset:24
    buffer_load_ushort v126, v2, s[80:83], 0 offen offset:0
    buffer_load_ushort v114, v2, s[80:83], 0 offen offset:8
    buffer_load_ushort v127, v2, s[80:83], 0 offen offset:16
    buffer_load_ushort v115, v2, s[80:83], 0 offen offset:24
    s_waitcnt vmcnt(0)
    v_lshl_or_b32 v116, v108, 16, v116
    v_lshl_or_b32 v117, v109, 16, v117
    v_lshl_or_b32 v118, v110, 16, v118
    v_lshl_or_b32 v119, v111, 16, v119
    v_lshl_or_b32 v120, v100, 16, v120
    v_lshl_or_b32 v121, v101, 16, v121
    v_lshl_or_b32 v122, v102, 16, v122
    v_lshl_or_b32 v123, v103, 16, v123
    v_lshl_or_b32 v124, v112, 16, v124
    v_lshl_or_b32 v125, v113, 16, v125
    v_lshl_or_b32 v126, v114, 16, v126
    v_lshl_or_b32 v127, v115, 16, v127
    buffer_store_dwordx4 v[116:119], v3, s[24:27], 0 offen offset:0 sc1
    buffer_store_dwordx4 v[120:123], v3, s[24:27], 0 offen offset:16 sc1
    buffer_store_dwordx4 v[124:127], v3, s[24:27], 0 offen offset:32 sc1
L1_wt:
    s_mov_b32 s20, s30
    s_mov_b32 s21, s31
    s_mov_b32 s22, 0xd344000
    s_mov_b32 s23, 0x20000
    s_add_u32 s24, s30, 0x2c000
    s_addc_u32 s25, s31, 0
    s_mov_b32 s26, 0xd318000
    s_mov_b32 s27, 0x20000
    s_add_u32 s3, s32, 0
    s_mul_i32 s4, s3, 205
    s_lshr_b32 s4, s4, 10
    s_mul_i32 s5, s4, 5
    s_sub_u32 s5, s3, s5
    s_lshl_b32 s5, s5, 5
    s_add_u32 s4, s4, s5
    s_sub_u32 s4, s4, s32
    s_lshl_b32 s72, s4, 10
    s_add_u32 s3, s32, 16
    s_mul_i32 s4, s3, 205
    s_lshr_b32 s4, s4, 10
    s_mul_i32 s5, s4, 5
    s_sub_u32 s5, s3, s5
    s_lshl_b32 s5, s5, 5
    s_add_u32 s4, s4, s5
    s_sub_u32 s4, s4, s32
    s_lshl_b32 s73, s4, 10
    s_add_u32 s3, s32, 32
    s_mul_i32 s4, s3, 205
    s_lshr_b32 s4, s4, 10
    s_mul_i32 s5, s4, 5
    s_sub_u32 s5, s3, s5
    s_lshl_b32 s5, s5, 5
    s_add_u32 s4, s4, s5
    s_sub_u32 s4, s4, s32
    s_lshl_b32 s85, s4, 10
    s_add_u32 s3, s32, 48
    s_mul_i32 s4, s3, 205
    s_lshr_b32 s4, s4, 10
    s_mul_i32 s5, s4, 5
    s_sub_u32 s5, s3, s5
    s_lshl_b32 s5, s5, 5
    s_add_u32 s4, s4, s5
    s_sub_u32 s4, s4, s32
    s_lshl_b32 s91, s4, 10
    s_add_u32 s3, s32, 64
    s_mul_i32 s4, s3, 205
    s_lshr_b32 s4, s4, 10
    s_mul_i32 s5, s4, 5
    s_sub_u32 s5, s3, s5
    s_lshl_b32 s5, s5, 5
    s_add_u32 s4, s4, s5
    s_sub_u32 s4, s4, s32
    s_lshl_b32 s93, s4, 10
    s_mov_b32 s80, s86
    s_mov_b32 s81, s87
    s_mov_b32 s82, 0x4e2000
    s_mov_b32 s83, 0x20000
    s_mul_i32 s35, s2, 173056
    s_and_b32 s37, s32, 3
    s_lshl_b32 s37, s37, 3
    s_mov_b32 s36, s37
    s_lshr_b32 s37, s32, 2
    s_mul_i32 s37, s37, 2080
    s_add_u32 s36, s36, s37
    s_and_b32 s37, s2, 3
    s_lshl_b32 s37, s37, 5
    s_add_u32 s36, s36, s37
    s_mul_i32 s4, s2, 5
    s_add_u32 s4, s4, 8192
    s_lshl_b32 s38, s4, 14
    s_lshl_b32 s39, s4, 13
    v_mov_b32 v2, 1
    v_mov_b32 v4, 0x80000007
    v_mov_b32 v5, 0xfc
    v_mov_b32 v6, 0x78
    s_mov_b32 s40, 16512
    s_mov_b32 s55, -10000
    s_mov_b32 s41, 0x010c0c01
    s_mov_b32 s42, 0x030c0c03
    v_mov_b32 v8, 0
    v_mov_b32 v9, 0
    v_mov_b32 v10, 0
    v_mov_b32 v11, 0
    ds_write_b128 v0, v[8:11]
    s_add_u32 s60, s30, 0xec5d000
    s_addc_u32 s61, s31, 0
    s_mov_b32 s62, 0x8000
    s_mov_b32 s63, 0x20000
    s_mov_b64 s[66:67], s[56:57]
    s_lshl_b32 s57, s2, 7
    s_add_u32 s68, s30, 0xec55000
    s_addc_u32 s69, s31, 0
    s_mov_b32 s70, 0x80
    s_mov_b32 s71, 0x20000
    s_lshl_b32 s3, s2, 7
    s_add_u32 s68, s68, s3
    s_addc_u32 s69, s69, 0
    s_cmp_lg_u32 s32, 0
    s_cbranch_scc1 L1_fl
    buffer_store_dwordx4 v[8:11], v0, s[68:71], 0 offen sc1
    s_mov_b64 exec, 0xff
    buffer_store_dwordx4 v[8:11], v0, s[60:63], s57 offen sc1
    s_mov_b64 exec, -1
L1_fl:
    s_waitcnt lgkmcnt(0)
    s_barrier
    s_setprio 3
    s_add_u32 s46, s96, 0xc00000
    v_lshlrev_b32 v48, 1, v1
    buffer_load_dwordx4 v[48:51], v48, s[8:11], s46 offen nt
    s_add_u32 s47, s96, 0xc00000
    v_lshlrev_b32 v52, 1, v1
    buffer_load_dwordx4 v[52:55], v52, s[12:15], s47 offen nt
    s_waitcnt vmcnt(8)
    v_lshlrev_b32 v7, 16, v24
    v_and_b32 v8, 0xffff0000, v24
    v_lshlrev_b32 v9, 16, v25
    v_and_b32 v10, 0xffff0000, v25
    v_mul_f32 v7, 0.15915494, v7
    v_mul_f32 v8, 0.15915494, v8
    v_mul_f32 v9, 0.15915494, v9
    v_mul_f32 v10, 0.15915494, v10
    v_mul_hi_u32_u24 v14, 429497, v16
    v_lshrrev_b32 v12, 3, v20
    v_cos_f32 v7, v7
    v_lshlrev_b16 v13, 3, v20
    v_mad_i32_i24 v11, v14, s55, v16
    v_bitop3_b32 v12, v6, v13, v12 bitop3:0xca
    v_lshl_add_u32 v11, v11, 17, s40
    v_lshlrev_b16 v14, 8, v14
    v_lshrrev_b32 v13, 2, v20
    v_add_u32 v16, v12, v11
    v_bitop3_b32 v20, v5, v13, v14 bitop3:0xea
    ds_add_u32 v20, v2
    v_mul_hi_u32_u24 v14, 429497, v17
    v_lshrrev_b32 v12, 3, v21
    v_cos_f32 v8, v8
    v_lshlrev_b16 v13, 3, v21
    v_mad_i32_i24 v11, v14, s55, v17
    v_bitop3_b32 v12, v6, v13, v12 bitop3:0xca
    v_lshl_add_u32 v11, v11, 17, s40
    v_lshlrev_b16 v14, 8, v14
    v_lshrrev_b32 v13, 2, v21
    v_add_u32 v17, v12, v11
    v_bitop3_b32 v21, v5, v13, v14 bitop3:0xea
    ds_add_u32 v21, v2
    v_cvt_pk_bf16_f32 v24, v7, v8
    v_perm_b32 v12, v24, v24, s41
    v_bitop3_b32 v16, v4, v12, v16 bitop3:0xca
    v_perm_b32 v13, v24, v24, s42
    v_bitop3_b32 v17, v4, v13, v17 bitop3:0xca
    v_mul_hi_u32_u24 v14, 429497, v18
    v_lshrrev_b32 v12, 3, v22
    v_cos_f32 v9, v9
    v_lshlrev_b16 v13, 3, v22
    v_mad_i32_i24 v11, v14, s55, v18
    v_bitop3_b32 v12, v6, v13, v12 bitop3:0xca
    v_lshl_add_u32 v11, v11, 17, s40
    v_lshlrev_b16 v14, 8, v14
    v_lshrrev_b32 v13, 2, v22
    v_add_u32 v18, v12, v11
    v_bitop3_b32 v22, v5, v13, v14 bitop3:0xea
    ds_add_u32 v22, v2
    v_mul_hi_u32_u24 v14, 429497, v19
    v_lshrrev_b32 v12, 3, v23
    v_cos_f32 v10, v10
    v_lshlrev_b16 v13, 3, v23
    v_mad_i32_i24 v11, v14, s55, v19
    v_bitop3_b32 v12, v6, v13, v12 bitop3:0xca
    v_lshl_add_u32 v11, v11, 17, s40
    v_lshlrev_b16 v14, 8, v14
    v_lshrrev_b32 v13, 2, v23
    v_add_u32 v19, v12, v11
    v_bitop3_b32 v23, v5, v13, v14 bitop3:0xea
    ds_add_u32 v23, v2
    v_cvt_pk_bf16_f32 v25, v9, v10
    v_perm_b32 v12, v25, v25, s41
    v_bitop3_b32 v18, v4, v12, v18 bitop3:0xca
    v_perm_b32 v13, v25, v25, s42
    v_bitop3_b32 v19, v4, v13, v19 bitop3:0xca
    s_add_u32 s44, s96, 0x1000000
    v_lshlrev_b32 v56, 1, v1
    buffer_load_dwordx4 v[56:59], v56, s[8:11], s44 offen nt
    s_add_u32 s45, s96, 0x1000000
    v_lshlrev_b32 v60, 1, v1
    buffer_load_dwordx4 v[60:63], v60, s[12:15], s45 offen nt
    s_add_u32 s46, s96, 0x1000000
    s_lshr_b32 s46, s46, 1
    buffer_load_dwordx2 v[64:65], v1, s[16:19], s46 offen nt
    s_add_u32 s47, s96, 0x1400000
    s_lshr_b32 s47, s47, 1
    buffer_load_dwordx2 v[66:67], v1, s[16:19], s47 offen nt
    s_waitcnt vmcnt(10)
    v_lshlrev_b32 v7, 16, v26
    v_and_b32 v8, 0xffff0000, v26
    v_lshlrev_b32 v9, 16, v27
    v_and_b32 v10, 0xffff0000, v27
    v_mul_f32 v7, 0.15915494, v7
    v_mul_f32 v8, 0.15915494, v8
    v_mul_f32 v9, 0.15915494, v9
    v_mul_f32 v10, 0.15915494, v10
    v_mul_hi_u32_u24 v14, 429497, v28
    v_lshrrev_b32 v12, 3, v32
    v_cos_f32 v7, v7
    v_lshlrev_b16 v13, 3, v32
    v_mad_i32_i24 v11, v14, s55, v28
    v_bitop3_b32 v12, v6, v13, v12 bitop3:0xca
    v_lshl_add_u32 v11, v11, 17, s40
    v_lshlrev_b16 v14, 8, v14
    v_lshrrev_b32 v13, 2, v32
    v_add_u32 v28, v12, v11
    v_bitop3_b32 v32, v5, v13, v14 bitop3:0xea
    ds_add_u32 v32, v2
    v_mul_hi_u32_u24 v14, 429497, v29
    v_lshrrev_b32 v12, 3, v33
    v_cos_f32 v8, v8
    v_lshlrev_b16 v13, 3, v33
    v_mad_i32_i24 v11, v14, s55, v29
    v_bitop3_b32 v12, v6, v13, v12 bitop3:0xca
    v_lshl_add_u32 v11, v11, 17, s40
    v_lshlrev_b16 v14, 8, v14
    v_lshrrev_b32 v13, 2, v33
    v_add_u32 v29, v12, v11
    v_bitop3_b32 v33, v5, v13, v14 bitop3:0xea
    ds_add_u32 v33, v2
    v_cvt_pk_bf16_f32 v26, v7, v8
    v_perm_b32 v12, v26, v26, s41
    v_bitop3_b32 v28, v4, v12, v28 bitop3:0xca
    v_perm_b32 v13, v26, v26, s42
    v_bitop3_b32 v29, v4, v13, v29 bitop3:0xca
    v_mul_hi_u32_u24 v14, 429497, v30
    v_lshrrev_b32 v12, 3, v34
    v_cos_f32 v9, v9
    v_lshlrev_b16 v13, 3, v34
    v_mad_i32_i24 v11, v14, s55, v30
    v_bitop3_b32 v12, v6, v13, v12 bitop3:0xca
    v_lshl_add_u32 v11, v11, 17, s40
    v_lshlrev_b16 v14, 8, v14
    v_lshrrev_b32 v13, 2, v34
    v_add_u32 v30, v12, v11
    v_bitop3_b32 v34, v5, v13, v14 bitop3:0xea
    ds_add_u32 v34, v2
    v_mul_hi_u32_u24 v14, 429497, v31
    v_lshrrev_b32 v12, 3, v35
    v_cos_f32 v10, v10
    v_lshlrev_b16 v13, 3, v35
    v_mad_i32_i24 v11, v14, s55, v31
    v_bitop3_b32 v12, v6, v13, v12 bitop3:0xca
    v_lshl_add_u32 v11, v11, 17, s40
    v_lshlrev_b16 v14, 8, v14
    v_lshrrev_b32 v13, 2, v35
    v_add_u32 v31, v12, v11
    v_bitop3_b32 v35, v5, v13, v14 bitop3:0xea
    ds_add_u32 v35, v2
    v_cvt_pk_bf16_f32 v27, v9, v10
    v_perm_b32 v12, v27, v27, s41
    v_bitop3_b32 v30, v4, v12, v30 bitop3:0xca
    v_perm_b32 v13, v27, v27, s42
    v_bitop3_b32 v31, v4, v13, v31 bitop3:0xca
    s_setprio 2
    s_add_u32 s44, s96, 0x1400000
    v_lshlrev_b32 v68, 1, v1
    buffer_load_dwordx4 v[68:71], v68, s[8:11], s44 offen nt
    s_add_u32 s45, s96, 0x1400000
    v_lshlrev_b32 v72, 1, v1
    buffer_load_dwordx4 v[72:75], v72, s[12:15], s45 offen nt
    s_waitcnt vmcnt(8)
    v_lshlrev_b32 v7, 16, v44
    v_and_b32 v8, 0xffff0000, v44
    v_lshlrev_b32 v9, 16, v45
    v_and_b32 v10, 0xffff0000, v45
    v_mul_f32 v7, 0.15915494, v7
    v_mul_f32 v8, 0.15915494, v8
    v_mul_f32 v9, 0.15915494, v9
    v_mul_f32 v10, 0.15915494, v10
    v_mul_hi_u32_u24 v14, 429497, v36
    v_lshrrev_b32 v12, 3, v40
    v_cos_f32 v7, v7
    v_lshlrev_b16 v13, 3, v40
    v_mad_i32_i24 v11, v14, s55, v36
    v_bitop3_b32 v12, v6, v13, v12 bitop3:0xca
    v_lshl_add_u32 v11, v11, 17, s40
    v_lshlrev_b16 v14, 8, v14
    v_lshrrev_b32 v13, 2, v40
    v_add_u32 v36, v12, v11
    v_bitop3_b32 v40, v5, v13, v14 bitop3:0xea
    ds_add_u32 v40, v2
    v_mul_hi_u32_u24 v14, 429497, v37
    v_lshrrev_b32 v12, 3, v41
    v_cos_f32 v8, v8
    v_lshlrev_b16 v13, 3, v41
    v_mad_i32_i24 v11, v14, s55, v37
    v_bitop3_b32 v12, v6, v13, v12 bitop3:0xca
    v_lshl_add_u32 v11, v11, 17, s40
    v_lshlrev_b16 v14, 8, v14
    v_lshrrev_b32 v13, 2, v41
    v_add_u32 v37, v12, v11
    v_bitop3_b32 v41, v5, v13, v14 bitop3:0xea
    ds_add_u32 v41, v2
    v_cvt_pk_bf16_f32 v44, v7, v8
    v_perm_b32 v12, v44, v44, s41
    v_bitop3_b32 v36, v4, v12, v36 bitop3:0xca
    v_perm_b32 v13, v44, v44, s42
    v_bitop3_b32 v37, v4, v13, v37 bitop3:0xca
    v_mul_hi_u32_u24 v14, 429497, v38
    v_lshrrev_b32 v12, 3, v42
    v_cos_f32 v9, v9
    v_lshlrev_b16 v13, 3, v42
    v_mad_i32_i24 v11, v14, s55, v38
    v_bitop3_b32 v12, v6, v13, v12 bitop3:0xca
    v_lshl_add_u32 v11, v11, 17, s40
    v_lshlrev_b16 v14, 8, v14
    v_lshrrev_b32 v13, 2, v42
    v_add_u32 v38, v12, v11
    v_bitop3_b32 v42, v5, v13, v14 bitop3:0xea
    ds_add_u32 v42, v2
    v_mul_hi_u32_u24 v14, 429497, v39
    v_lshrrev_b32 v12, 3, v43
    v_cos_f32 v10, v10
    v_lshlrev_b16 v13, 3, v43
    v_mad_i32_i24 v11, v14, s55, v39
    v_bitop3_b32 v12, v6, v13, v12 bitop3:0xca
    v_lshl_add_u32 v11, v11, 17, s40
    v_lshlrev_b16 v14, 8, v14
    v_lshrrev_b32 v13, 2, v43
    v_add_u32 v39, v12, v11
    v_bitop3_b32 v43, v5, v13, v14 bitop3:0xea
    ds_add_u32 v43, v2
    v_cvt_pk_bf16_f32 v45, v9, v10
    v_perm_b32 v12, v45, v45, s41
    v_bitop3_b32 v38, v4, v12, v38 bitop3:0xca
    v_perm_b32 v13, v45, v45, s42
    v_bitop3_b32 v39, v4, v13, v39 bitop3:0xca
    s_add_u32 s46, s96, 0x1800000
    v_lshlrev_b32 v76, 1, v1
    buffer_load_dwordx4 v[76:79], v76, s[8:11], s46 offen nt
    s_add_u32 s47, s96, 0x1800000
    v_lshlrev_b32 v80, 1, v1
    buffer_load_dwordx4 v[80:83], v80, s[12:15], s47 offen nt
    s_add_u32 s44, s96, 0x1800000
    s_lshr_b32 s44, s44, 1
    buffer_load_dwordx2 v[84:85], v1, s[16:19], s44 offen nt
    s_add_u32 s45, s96, 0x1c00000
    s_lshr_b32 s45, s45, 1
    buffer_load_dwordx2 v[86:87], v1, s[16:19], s45 offen nt
    s_waitcnt vmcnt(10)
    v_lshlrev_b32 v7, 16, v46
    v_and_b32 v8, 0xffff0000, v46
    v_lshlrev_b32 v9, 16, v47
    v_and_b32 v10, 0xffff0000, v47
    v_mul_f32 v7, 0.15915494, v7
    v_mul_f32 v8, 0.15915494, v8
    v_mul_f32 v9, 0.15915494, v9
    v_mul_f32 v10, 0.15915494, v10
    v_mul_hi_u32_u24 v14, 429497, v48
    v_lshrrev_b32 v12, 3, v52
    v_cos_f32 v7, v7
    v_lshlrev_b16 v13, 3, v52
    v_mad_i32_i24 v11, v14, s55, v48
    v_bitop3_b32 v12, v6, v13, v12 bitop3:0xca
    v_lshl_add_u32 v11, v11, 17, s40
    v_lshlrev_b16 v14, 8, v14
    v_lshrrev_b32 v13, 2, v52
    v_add_u32 v48, v12, v11
    v_bitop3_b32 v52, v5, v13, v14 bitop3:0xea
    ds_add_u32 v52, v2
    v_mul_hi_u32_u24 v14, 429497, v49
    v_lshrrev_b32 v12, 3, v53
    v_cos_f32 v8, v8
    v_lshlrev_b16 v13, 3, v53
    v_mad_i32_i24 v11, v14, s55, v49
    v_bitop3_b32 v12, v6, v13, v12 bitop3:0xca
    v_lshl_add_u32 v11, v11, 17, s40
    v_lshlrev_b16 v14, 8, v14
    v_lshrrev_b32 v13, 2, v53
    v_add_u32 v49, v12, v11
    v_bitop3_b32 v53, v5, v13, v14 bitop3:0xea
    ds_add_u32 v53, v2
    v_cvt_pk_bf16_f32 v46, v7, v8
    v_perm_b32 v12, v46, v46, s41
    v_bitop3_b32 v48, v4, v12, v48 bitop3:0xca
    v_perm_b32 v13, v46, v46, s42
    v_bitop3_b32 v49, v4, v13, v49 bitop3:0xca
    v_mul_hi_u32_u24 v14, 429497, v50
    v_lshrrev_b32 v12, 3, v54
    v_cos_f32 v9, v9
    v_lshlrev_b16 v13, 3, v54
    v_mad_i32_i24 v11, v14, s55, v50
    v_bitop3_b32 v12, v6, v13, v12 bitop3:0xca
    v_lshl_add_u32 v11, v11, 17, s40
    v_lshlrev_b16 v14, 8, v14
    v_lshrrev_b32 v13, 2, v54
    v_add_u32 v50, v12, v11
    v_bitop3_b32 v54, v5, v13, v14 bitop3:0xea
    ds_add_u32 v54, v2
    v_mul_hi_u32_u24 v14, 429497, v51
    v_lshrrev_b32 v12, 3, v55
    v_cos_f32 v10, v10
    v_lshlrev_b16 v13, 3, v55
    v_mad_i32_i24 v11, v14, s55, v51
    v_bitop3_b32 v12, v6, v13, v12 bitop3:0xca
    v_lshl_add_u32 v11, v11, 17, s40
    v_lshlrev_b16 v14, 8, v14
    v_lshrrev_b32 v13, 2, v55
    v_add_u32 v51, v12, v11
    v_bitop3_b32 v55, v5, v13, v14 bitop3:0xea
    ds_add_u32 v55, v2
    v_cvt_pk_bf16_f32 v47, v9, v10
    v_perm_b32 v12, v47, v47, s41
    v_bitop3_b32 v50, v4, v12, v50 bitop3:0xca
    v_perm_b32 v13, v47, v47, s42
    v_bitop3_b32 v51, v4, v13, v51 bitop3:0xca
    s_setprio 1
    s_add_u32 s46, s96, 0x1c00000
    v_lshlrev_b32 v88, 1, v1
    buffer_load_dwordx4 v[88:91], v88, s[8:11], s46 offen nt
    s_add_u32 s47, s96, 0x1c00000
    v_lshlrev_b32 v92, 1, v1
    buffer_load_dwordx4 v[92:95], v92, s[12:15], s47 offen nt
    s_waitcnt vmcnt(8)
    v_lshlrev_b32 v7, 16, v64
    v_and_b32 v8, 0xffff0000, v64
    v_lshlrev_b32 v9, 16, v65
    v_and_b32 v10, 0xffff0000, v65
    v_mul_f32 v7, 0.15915494, v7
    v_mul_f32 v8, 0.15915494, v8
    v_mul_f32 v9, 0.15915494, v9
    v_mul_f32 v10, 0.15915494, v10
    v_mul_hi_u32_u24 v14, 429497, v56
    v_lshrrev_b32 v12, 3, v60
    v_cos_f32 v7, v7
    v_lshlrev_b16 v13, 3, v60
    v_mad_i32_i24 v11, v14, s55, v56
    v_bitop3_b32 v12, v6, v13, v12 bitop3:0xca
    v_lshl_add_u32 v11, v11, 17, s40
    v_lshlrev_b16 v14, 8, v14
    v_lshrrev_b32 v13, 2, v60
    v_add_u32 v56, v12, v11
    v_bitop3_b32 v60, v5, v13, v14 bitop3:0xea
    ds_add_u32 v60, v2
    v_mul_hi_u32_u24 v14, 429497, v57
    v_lshrrev_b32 v12, 3, v61
    v_cos_f32 v8, v8
    v_lshlrev_b16 v13, 3, v61
    v_mad_i32_i24 v11, v14, s55, v57
    v_bitop3_b32 v12, v6, v13, v12 bitop3:0xca
    v_lshl_add_u32 v11, v11, 17, s40
    v_lshlrev_b16 v14, 8, v14
    v_lshrrev_b32 v13, 2, v61
    v_add_u32 v57, v12, v11
    v_bitop3_b32 v61, v5, v13, v14 bitop3:0xea
    ds_add_u32 v61, v2
    v_cvt_pk_bf16_f32 v64, v7, v8
    v_perm_b32 v12, v64, v64, s41
    v_bitop3_b32 v56, v4, v12, v56 bitop3:0xca
    v_perm_b32 v13, v64, v64, s42
    v_bitop3_b32 v57, v4, v13, v57 bitop3:0xca
    v_mul_hi_u32_u24 v14, 429497, v58
    v_lshrrev_b32 v12, 3, v62
    v_cos_f32 v9, v9
    v_lshlrev_b16 v13, 3, v62
    v_mad_i32_i24 v11, v14, s55, v58
    v_bitop3_b32 v12, v6, v13, v12 bitop3:0xca
    v_lshl_add_u32 v11, v11, 17, s40
    v_lshlrev_b16 v14, 8, v14
    v_lshrrev_b32 v13, 2, v62
    v_add_u32 v58, v12, v11
    v_bitop3_b32 v62, v5, v13, v14 bitop3:0xea
    ds_add_u32 v62, v2
    v_mul_hi_u32_u24 v14, 429497, v59
    v_lshrrev_b32 v12, 3, v63
    v_cos_f32 v10, v10
    v_lshlrev_b16 v13, 3, v63
    v_mad_i32_i24 v11, v14, s55, v59
    v_bitop3_b32 v12, v6, v13, v12 bitop3:0xca
    v_lshl_add_u32 v11, v11, 17, s40
    v_lshlrev_b16 v14, 8, v14
    v_lshrrev_b32 v13, 2, v63
    v_add_u32 v59, v12, v11
    v_bitop3_b32 v63, v5, v13, v14 bitop3:0xea
    ds_add_u32 v63, v2
    v_cvt_pk_bf16_f32 v65, v9, v10
    v_perm_b32 v12, v65, v65, s41
    v_bitop3_b32 v58, v4, v12, v58 bitop3:0xca
    v_perm_b32 v13, v65, v65, s42
    v_bitop3_b32 v59, v4, v13, v59 bitop3:0xca
    s_add_u32 s44, s96, 0x2000000
    v_lshlrev_b32 v96, 1, v1
    buffer_load_dwordx4 v[96:99], v96, s[8:11], s44 offen nt
    s_add_u32 s45, s96, 0x2000000
    v_lshlrev_b32 v104, 1, v1
    buffer_load_dwordx4 v[104:107], v104, s[12:15], s45 offen nt
    s_add_u32 s46, s96, 0x2000000
    s_lshr_b32 s46, s46, 1
    buffer_load_dwordx2 v[108:109], v1, s[16:19], s46 offen nt
    s_add_u32 s47, s96, 0x2400000
    s_lshr_b32 s47, s47, 1
    buffer_load_dwordx2 v[110:111], v1, s[16:19], s47 offen nt
    s_waitcnt vmcnt(10)
    v_lshlrev_b32 v7, 16, v66
    v_and_b32 v8, 0xffff0000, v66
    v_lshlrev_b32 v9, 16, v67
    v_and_b32 v10, 0xffff0000, v67
    v_mul_f32 v7, 0.15915494, v7
    v_mul_f32 v8, 0.15915494, v8
    v_mul_f32 v9, 0.15915494, v9
    v_mul_f32 v10, 0.15915494, v10
    v_mul_hi_u32_u24 v14, 429497, v68
    v_lshrrev_b32 v12, 3, v72
    v_cos_f32 v7, v7
    v_lshlrev_b16 v13, 3, v72
    v_mad_i32_i24 v11, v14, s55, v68
    v_bitop3_b32 v12, v6, v13, v12 bitop3:0xca
    v_lshl_add_u32 v11, v11, 17, s40
    v_lshlrev_b16 v14, 8, v14
    v_lshrrev_b32 v13, 2, v72
    v_add_u32 v68, v12, v11
    v_bitop3_b32 v72, v5, v13, v14 bitop3:0xea
    ds_add_u32 v72, v2
    v_mul_hi_u32_u24 v14, 429497, v69
    v_lshrrev_b32 v12, 3, v73
    v_cos_f32 v8, v8
    v_lshlrev_b16 v13, 3, v73
    v_mad_i32_i24 v11, v14, s55, v69
    v_bitop3_b32 v12, v6, v13, v12 bitop3:0xca
    v_lshl_add_u32 v11, v11, 17, s40
    v_lshlrev_b16 v14, 8, v14
    v_lshrrev_b32 v13, 2, v73
    v_add_u32 v69, v12, v11
    v_bitop3_b32 v73, v5, v13, v14 bitop3:0xea
    ds_add_u32 v73, v2
    v_cvt_pk_bf16_f32 v66, v7, v8
    v_perm_b32 v12, v66, v66, s41
    v_bitop3_b32 v68, v4, v12, v68 bitop3:0xca
    v_perm_b32 v13, v66, v66, s42
    v_bitop3_b32 v69, v4, v13, v69 bitop3:0xca
    v_mul_hi_u32_u24 v14, 429497, v70
    v_lshrrev_b32 v12, 3, v74
    v_cos_f32 v9, v9
    v_lshlrev_b16 v13, 3, v74
    v_mad_i32_i24 v11, v14, s55, v70
    v_bitop3_b32 v12, v6, v13, v12 bitop3:0xca
    v_lshl_add_u32 v11, v11, 17, s40
    v_lshlrev_b16 v14, 8, v14
    v_lshrrev_b32 v13, 2, v74
    v_add_u32 v70, v12, v11
    v_bitop3_b32 v74, v5, v13, v14 bitop3:0xea
    ds_add_u32 v74, v2
    v_mul_hi_u32_u24 v14, 429497, v71
    v_lshrrev_b32 v12, 3, v75
    v_cos_f32 v10, v10
    v_lshlrev_b16 v13, 3, v75
    v_mad_i32_i24 v11, v14, s55, v71
    v_bitop3_b32 v12, v6, v13, v12 bitop3:0xca
    v_lshl_add_u32 v11, v11, 17, s40
    v_lshlrev_b16 v14, 8, v14
    v_lshrrev_b32 v13, 2, v75
    v_add_u32 v71, v12, v11
    v_bitop3_b32 v75, v5, v13, v14 bitop3:0xea
    ds_add_u32 v75, v2
    v_cvt_pk_bf16_f32 v67, v9, v10
    v_perm_b32 v12, v67, v67, s41
    v_bitop3_b32 v70, v4, v12, v70 bitop3:0xca
    v_perm_b32 v13, v67, v67, s42
    v_bitop3_b32 v71, v4, v13, v71 bitop3:0xca
    s_setprio 0
    s_add_u32 s44, s96, 0x2400000
    v_lshlrev_b32 v100, 1, v1
    buffer_load_dwordx4 v[100:103], v100, s[8:11], s44 offen nt
    s_waitcnt vmcnt(7)
    v_lshlrev_b32 v7, 16, v84
    v_and_b32 v8, 0xffff0000, v84
    v_lshlrev_b32 v9, 16, v85
    v_and_b32 v10, 0xffff0000, v85
    v_mul_f32 v7, 0.15915494, v7
    v_mul_f32 v8, 0.15915494, v8
    v_mul_f32 v9, 0.15915494, v9
    v_mul_f32 v10, 0.15915494, v10
    v_mul_hi_u32_u24 v14, 429497, v76
    v_lshrrev_b32 v12, 3, v80
    v_cos_f32 v7, v7
    v_lshlrev_b16 v13, 3, v80
    v_mad_i32_i24 v11, v14, s55, v76
    v_bitop3_b32 v12, v6, v13, v12 bitop3:0xca
    v_lshl_add_u32 v11, v11, 17, s40
    v_lshlrev_b16 v14, 8, v14
    v_lshrrev_b32 v13, 2, v80
    v_add_u32 v76, v12, v11
    v_bitop3_b32 v80, v5, v13, v14 bitop3:0xea
    ds_add_u32 v80, v2
    v_mul_hi_u32_u24 v14, 429497, v77
    v_lshrrev_b32 v12, 3, v81
    v_cos_f32 v8, v8
    v_lshlrev_b16 v13, 3, v81
    v_mad_i32_i24 v11, v14, s55, v77
    v_bitop3_b32 v12, v6, v13, v12 bitop3:0xca
    v_lshl_add_u32 v11, v11, 17, s40
    v_lshlrev_b16 v14, 8, v14
    v_lshrrev_b32 v13, 2, v81
    v_add_u32 v77, v12, v11
    v_bitop3_b32 v81, v5, v13, v14 bitop3:0xea
    ds_add_u32 v81, v2
    v_cvt_pk_bf16_f32 v84, v7, v8
    v_perm_b32 v12, v84, v84, s41
    v_bitop3_b32 v76, v4, v12, v76 bitop3:0xca
    v_perm_b32 v13, v84, v84, s42
    v_bitop3_b32 v77, v4, v13, v77 bitop3:0xca
    v_mul_hi_u32_u24 v14, 429497, v78
    v_lshrrev_b32 v12, 3, v82
    v_cos_f32 v9, v9
    v_lshlrev_b16 v13, 3, v82
    v_mad_i32_i24 v11, v14, s55, v78
    v_bitop3_b32 v12, v6, v13, v12 bitop3:0xca
    v_lshl_add_u32 v11, v11, 17, s40
    v_lshlrev_b16 v14, 8, v14
    v_lshrrev_b32 v13, 2, v82
    v_add_u32 v78, v12, v11
    v_bitop3_b32 v82, v5, v13, v14 bitop3:0xea
    ds_add_u32 v82, v2
    v_mul_hi_u32_u24 v14, 429497, v79
    v_lshrrev_b32 v12, 3, v83
    v_cos_f32 v10, v10
    v_lshlrev_b16 v13, 3, v83
    v_mad_i32_i24 v11, v14, s55, v79
    v_bitop3_b32 v12, v6, v13, v12 bitop3:0xca
    v_lshl_add_u32 v11, v11, 17, s40
    v_lshlrev_b16 v14, 8, v14
    v_lshrrev_b32 v13, 2, v83
    v_add_u32 v79, v12, v11
    v_bitop3_b32 v83, v5, v13, v14 bitop3:0xea
    ds_add_u32 v83, v2
    v_cvt_pk_bf16_f32 v85, v9, v10
    v_perm_b32 v12, v85, v85, s41
    v_bitop3_b32 v78, v4, v12, v78 bitop3:0xca
    v_perm_b32 v13, v85, v85, s42
    v_bitop3_b32 v79, v4, v13, v79 bitop3:0xca
    s_waitcnt vmcnt(5)
    v_lshlrev_b32 v7, 16, v86
    v_and_b32 v8, 0xffff0000, v86
    v_lshlrev_b32 v9, 16, v87
    v_and_b32 v10, 0xffff0000, v87
    v_mul_f32 v7, 0.15915494, v7
    v_mul_f32 v8, 0.15915494, v8
    v_mul_f32 v9, 0.15915494, v9
    v_mul_f32 v10, 0.15915494, v10
    v_mul_hi_u32_u24 v14, 429497, v88
    v_lshrrev_b32 v12, 3, v92
    v_cos_f32 v7, v7
    v_lshlrev_b16 v13, 3, v92
    v_mad_i32_i24 v11, v14, s55, v88
    v_bitop3_b32 v12, v6, v13, v12 bitop3:0xca
    v_lshl_add_u32 v11, v11, 17, s40
    v_lshlrev_b16 v14, 8, v14
    v_lshrrev_b32 v13, 2, v92
    v_add_u32 v88, v12, v11
    v_bitop3_b32 v92, v5, v13, v14 bitop3:0xea
    ds_add_u32 v92, v2
    v_mul_hi_u32_u24 v14, 429497, v89
    v_lshrrev_b32 v12, 3, v93
    v_cos_f32 v8, v8
    v_lshlrev_b16 v13, 3, v93
    v_mad_i32_i24 v11, v14, s55, v89
    v_bitop3_b32 v12, v6, v13, v12 bitop3:0xca
    v_lshl_add_u32 v11, v11, 17, s40
    v_lshlrev_b16 v14, 8, v14
    v_lshrrev_b32 v13, 2, v93
    v_add_u32 v89, v12, v11
    v_bitop3_b32 v93, v5, v13, v14 bitop3:0xea
    ds_add_u32 v93, v2
    v_cvt_pk_bf16_f32 v86, v7, v8
    v_perm_b32 v12, v86, v86, s41
    v_bitop3_b32 v88, v4, v12, v88 bitop3:0xca
    v_perm_b32 v13, v86, v86, s42
    v_bitop3_b32 v89, v4, v13, v89 bitop3:0xca
    v_mul_hi_u32_u24 v14, 429497, v90
    v_lshrrev_b32 v12, 3, v94
    v_cos_f32 v9, v9
    v_lshlrev_b16 v13, 3, v94
    v_mad_i32_i24 v11, v14, s55, v90
    v_bitop3_b32 v12, v6, v13, v12 bitop3:0xca
    v_lshl_add_u32 v11, v11, 17, s40
    v_lshlrev_b16 v14, 8, v14
    v_lshrrev_b32 v13, 2, v94
    v_add_u32 v90, v12, v11
    v_bitop3_b32 v94, v5, v13, v14 bitop3:0xea
    ds_add_u32 v94, v2
    v_mul_hi_u32_u24 v14, 429497, v91
    v_lshrrev_b32 v12, 3, v95
    v_cos_f32 v10, v10
    v_lshlrev_b16 v13, 3, v95
    v_mad_i32_i24 v11, v14, s55, v91
    v_bitop3_b32 v12, v6, v13, v12 bitop3:0xca
    v_lshl_add_u32 v11, v11, 17, s40
    v_lshlrev_b16 v14, 8, v14
    v_lshrrev_b32 v13, 2, v95
    v_add_u32 v91, v12, v11
    v_bitop3_b32 v95, v5, v13, v14 bitop3:0xea
    ds_add_u32 v95, v2
    v_cvt_pk_bf16_f32 v87, v9, v10
    v_perm_b32 v12, v87, v87, s41
    v_bitop3_b32 v90, v4, v12, v90 bitop3:0xca
    v_perm_b32 v13, v87, v87, s42
    v_bitop3_b32 v91, v4, v13, v91 bitop3:0xca
    v_lshrrev_b32 v8, 2, v0
    v_and_b32 v7, 0x3c00, v0
    v_bitop3_b32 v7, v5, v8, v7 bitop3:0xea
    s_waitcnt lgkmcnt(0)
    s_barrier
    ds_read2st64_b32 v[8:9], v7 offset0:0 offset1:1
    ds_read2st64_b32 v[10:11], v7 offset0:2 offset1:3
    s_add_u32 s45, s96, 0x2400000
    v_lshlrev_b32 v112, 1, v1
    buffer_load_dwordx4 v[112:115], v112, s[12:15], s45 offen nt
    s_waitcnt lgkmcnt(0)
    v_lshl_or_b32 v12, v9, 16, v8
    v_lshl_or_b32 v13, v11, 16, v10
    v_mov_b32 v14, v12
    v_mov_b32 v15, v13
    s_nop 0
    v_add_u32_dpp v14, v14, v14 row_shr:1 row_mask:0xf bank_mask:0xf bound_ctrl:1
    v_add_u32_dpp v15, v15, v15 row_shr:1 row_mask:0xf bank_mask:0xf bound_ctrl:1
    s_nop 0
    v_add_u32_dpp v14, v14, v14 row_shr:2 row_mask:0xf bank_mask:0xf bound_ctrl:1
    v_add_u32_dpp v15, v15, v15 row_shr:2 row_mask:0xf bank_mask:0xf bound_ctrl:1
    s_nop 0
    v_add_u32_dpp v14, v14, v14 row_shr:4 row_mask:0xf bank_mask:0xf bound_ctrl:1
    v_add_u32_dpp v15, v15, v15 row_shr:4 row_mask:0xf bank_mask:0xf bound_ctrl:1
    s_nop 0
    v_add_u32_dpp v14, v14, v14 row_shr:8 row_mask:0xf bank_mask:0xf bound_ctrl:1
    v_add_u32_dpp v15, v15, v15 row_shr:8 row_mask:0xf bank_mask:0xf bound_ctrl:1
    s_nop 0
    v_add_u32_dpp v14, v14, v14 row_bcast:15 row_mask:0xa bank_mask:0xf
    v_add_u32_dpp v15, v15, v15 row_bcast:15 row_mask:0xa bank_mask:0xf
    s_nop 0
    v_add_u32_dpp v14, v14, v14 row_bcast:31 row_mask:0xc bank_mask:0xf
    v_add_u32_dpp v15, v15, v15 row_bcast:31 row_mask:0xc bank_mask:0xf
    v_readlane_b32 s48, v14, 63
    v_readlane_b32 s49, v15, 63
    s_lshl_b32 s54, s32, 2
    v_mov_b32 v8, s54
    s_and_b32 s50, s48, 0xffff
    s_lshr_b32 s51, s48, 16
    s_and_b32 s52, s49, 0xffff
    s_lshr_b32 s53, s49, 16
    s_add_u32 s51, s51, s50
    s_add_u32 s52, s52, s51
    s_add_u32 s53, s53, s52
    v_mov_b32 v9, s53
    s_mov_b64 exec, 1
    ds_write_b32 v8, v9 offset:16384
    s_mov_b64 exec, -1
    v_and_b32 v8, 60, v7
    s_waitcnt lgkmcnt(0)
    s_barrier
    ds_read_b32 v9, v8 offset:16384
    s_waitcnt lgkmcnt(0)
    v_add_u32_dpp v9, v9, v9 row_shr:1 row_mask:0xf bank_mask:0xf bound_ctrl:1
    s_nop 1
    v_add_u32_dpp v9, v9, v9 row_shr:2 row_mask:0xf bank_mask:0xf bound_ctrl:1
    s_nop 1
    v_add_u32_dpp v9, v9, v9 row_shr:4 row_mask:0xf bank_mask:0xf bound_ctrl:1
    s_nop 1
    v_add_u32_dpp v9, v9, v9 row_shr:8 row_mask:0xf bank_mask:0xf bound_ctrl:1
    s_nop 0
    v_readlane_b32 s54, v9, s32
    s_sub_u32 s54, s54, s53
    s_add_u32 s50, s50, s54
    s_add_u32 s51, s51, s54
    s_add_u32 s52, s52, s54
    s_pack_ll_b32_b16 s48, s54, s50
    s_pack_ll_b32_b16 s49, s51, s52
    v_add_u32 v14, s48, v14
    v_add_u32 v15, s49, v15
    v_sub_u32 v12, v14, v12
    v_sub_u32 v13, v15, v13
    v_and_b32 v8, 0xffff, v12
    v_lshrrev_b32 v9, 16, v12
    v_and_b32 v10, 0xffff, v13
    v_lshrrev_b32 v11, 16, v13
    ds_write2st64_b32 v7, v8, v9 offset0:0 offset1:1
    ds_write2st64_b32 v7, v10, v11 offset0:2 offset1:3
    v_and_b32 v8, 0x3f0, v0
    v_lshl_add_u32 v8, v8, 1, s36
    ds_write_b64 v8, v[12:13] offset:20480
    s_bitset0_b64 exec, 63
    s_not_b64 exec, exec
    ds_write_b64 v8, v[14:15] offset:20512
    s_mov_b64 exec, -1
    s_waitcnt lgkmcnt(0)
    s_barrier
    s_setprio 3
    ds_add_rtn_u32 v20, v20, v2
    ds_add_rtn_u32 v21, v21, v2
    ds_add_rtn_u32 v22, v22, v2
    ds_add_rtn_u32 v23, v23, v2
    ds_read_b128 v[12:15], v0 offset:20480
    v_cmp_gt_u32 vcc, 8448, v0
    s_add_u32 s46, s96, 0x2800000
    v_lshlrev_b32 v116, 1, v1
    buffer_load_dwordx4 v[116:119], v116, s[8:11], s46 offen nt
    ds_add_rtn_u32 v32, v32, v2
    ds_add_rtn_u32 v33, v33, v2
    ds_add_rtn_u32 v34, v34, v2
    ds_add_rtn_u32 v35, v35, v2
    s_setprio 2
    ds_add_rtn_u32 v40, v40, v2
    ds_add_rtn_u32 v41, v41, v2
    ds_add_rtn_u32 v42, v42, v2
    ds_add_rtn_u32 v43, v43, v2
    s_waitcnt lgkmcnt(8)
    s_cbranch_vccz L1_p1
    s_add_u32 s47, s35, 0x0
    s_mov_b64 exec, vcc
    buffer_store_dwordx4 v[12:15], v0, s[24:27], s47 offen sc1
    s_mov_b64 exec, -1
L1_p1:
    s_add_u32 s44, s96, 0x2800000
    v_lshlrev_b32 v120, 1, v1
    buffer_load_dwordx4 v[120:123], v120, s[12:15], s44 offen nt
    ds_add_rtn_u32 v52, v52, v2
    ds_add_rtn_u32 v53, v53, v2
    ds_add_rtn_u32 v54, v54, v2
    ds_add_rtn_u32 v55, v55, v2
    s_setprio 1
    ds_add_rtn_u32 v60, v60, v2
    ds_add_rtn_u32 v61, v61, v2
    ds_add_rtn_u32 v62, v62, v2
    ds_add_rtn_u32 v63, v63, v2
    ds_add_rtn_u32 v72, v72, v2
    ds_add_rtn_u32 v73, v73, v2
    ds_add_rtn_u32 v74, v74, v2
    ds_add_rtn_u32 v75, v75, v2
    s_add_u32 s45, s96, 0x2800000
    s_lshr_b32 s45, s45, 1
    buffer_load_dwordx2 v[124:125], v1, s[16:19], s45 offen nt
    s_add_u32 s46, s96, 0x2c00000
    s_lshr_b32 s46, s46, 1
    buffer_load_dwordx2 v[126:127], v1, s[16:19], s46 offen nt
    s_setprio 0
    ds_add_rtn_u32 v80, v80, v2
    ds_add_rtn_u32 v81, v81, v2
    ds_add_rtn_u32 v82, v82, v2
    ds_add_rtn_u32 v83, v83, v2
    ds_add_rtn_u32 v92, v92, v2
    ds_add_rtn_u32 v93, v93, v2
    ds_add_rtn_u32 v94, v94, v2
    ds_add_rtn_u32 v95, v95, v2
    s_waitcnt lgkmcnt(0)
    s_barrier
    s_setprio 3
    v_and_b32 v7, -4, v20
    v_lshl_add_u32 v8, v20, 2, v7
    ds_write_b32 v8, v16
    v_lshl_add_u32 v7, v7, 2, v20
    ds_write_b8 v7, v24 offset:16
    v_and_b32 v9, -4, v21
    v_lshl_add_u32 v10, v21, 2, v9
    ds_write_b32 v10, v17
    v_lshl_add_u32 v9, v9, 2, v21
    ds_write_b8_d16_hi v9, v24 offset:16
    v_and_b32 v7, -4, v22
    v_lshl_add_u32 v8, v22, 2, v7
    ds_write_b32 v8, v18
    v_lshl_add_u32 v7, v7, 2, v22
    ds_write_b8 v7, v25 offset:16
    v_and_b32 v9, -4, v23
    v_lshl_add_u32 v10, v23, 2, v9
    ds_write_b32 v10, v19
    v_lshl_add_u32 v9, v9, 2, v23
    ds_write_b8_d16_hi v9, v25 offset:16
    s_add_u32 s47, s96, 0x2c00000
    v_lshlrev_b32 v16, 1, v1
    buffer_load_dwordx4 v[16:19], v16, s[8:11], s47 offen nt
    s_add_u32 s44, s96, 0x2c00000
    v_lshlrev_b32 v20, 1, v1
    buffer_load_dwordx4 v[20:23], v20, s[12:15], s44 offen nt
    v_and_b32 v7, -4, v32
    v_lshl_add_u32 v8, v32, 2, v7
    ds_write_b32 v8, v28
    v_lshl_add_u32 v7, v7, 2, v32
    ds_write_b8 v7, v26 offset:16
    v_and_b32 v9, -4, v33
    v_lshl_add_u32 v10, v33, 2, v9
    ds_write_b32 v10, v29
    v_lshl_add_u32 v9, v9, 2, v33
    ds_write_b8_d16_hi v9, v26 offset:16
    v_and_b32 v7, -4, v34
    v_lshl_add_u32 v8, v34, 2, v7
    ds_write_b32 v8, v30
    v_lshl_add_u32 v7, v7, 2, v34
    ds_write_b8 v7, v27 offset:16
    v_and_b32 v9, -4, v35
    v_lshl_add_u32 v10, v35, 2, v9
    ds_write_b32 v10, v31
    v_lshl_add_u32 v9, v9, 2, v35
    ds_write_b8_d16_hi v9, v27 offset:16
    s_add_u32 s45, s96, 0x3000000
    v_lshlrev_b32 v28, 1, v1
    buffer_load_dwordx4 v[28:31], v28, s[8:11], s45 offen nt
    s_waitcnt vmcnt(9)
    v_lshlrev_b32 v7, 16, v108
    v_and_b32 v8, 0xffff0000, v108
    v_lshlrev_b32 v9, 16, v109
    v_and_b32 v10, 0xffff0000, v109
    v_mul_f32 v7, 0.15915494, v7
    v_mul_f32 v8, 0.15915494, v8
    v_mul_f32 v9, 0.15915494, v9
    v_mul_f32 v10, 0.15915494, v10
    v_mul_hi_u32_u24 v14, 429497, v96
    v_lshrrev_b32 v12, 3, v104
    v_cos_f32 v7, v7
    v_lshlrev_b16 v13, 3, v104
    v_mad_i32_i24 v11, v14, s55, v96
    v_bitop3_b32 v12, v6, v13, v12 bitop3:0xca
    v_lshl_add_u32 v11, v11, 17, s40
    v_lshlrev_b16 v14, 8, v14
    v_lshrrev_b32 v13, 2, v104
    v_add_u32 v96, v12, v11
    v_bitop3_b32 v104, v5, v13, v14 bitop3:0xea
    v_mul_hi_u32_u24 v14, 429497, v97
    v_lshrrev_b32 v12, 3, v105
    v_cos_f32 v8, v8
    v_lshlrev_b16 v13, 3, v105
    v_mad_i32_i24 v11, v14, s55, v97
    v_bitop3_b32 v12, v6, v13, v12 bitop3:0xca
    v_lshl_add_u32 v11, v11, 17, s40
    v_lshlrev_b16 v14, 8, v14
    v_lshrrev_b32 v13, 2, v105
    v_add_u32 v97, v12, v11
    v_bitop3_b32 v105, v5, v13, v14 bitop3:0xea
    v_cvt_pk_bf16_f32 v108, v7, v8
    v_perm_b32 v12, v108, v108, s41
    v_bitop3_b32 v96, v4, v12, v96 bitop3:0xca
    v_perm_b32 v13, v108, v108, s42
    v_bitop3_b32 v97, v4, v13, v97 bitop3:0xca
    v_mul_hi_u32_u24 v14, 429497, v98
    v_lshrrev_b32 v12, 3, v106
    v_cos_f32 v9, v9
    v_lshlrev_b16 v13, 3, v106
    v_mad_i32_i24 v11, v14, s55, v98
    v_bitop3_b32 v12, v6, v13, v12 bitop3:0xca
    v_lshl_add_u32 v11, v11, 17, s40
    v_lshlrev_b16 v14, 8, v14
    v_lshrrev_b32 v13, 2, v106
    v_add_u32 v98, v12, v11
    v_bitop3_b32 v106, v5, v13, v14 bitop3:0xea
    v_mul_hi_u32_u24 v14, 429497, v99
    v_lshrrev_b32 v12, 3, v107
    v_cos_f32 v10, v10
    v_lshlrev_b16 v13, 3, v107
    v_mad_i32_i24 v11, v14, s55, v99
    v_bitop3_b32 v12, v6, v13, v12 bitop3:0xca
    v_lshl_add_u32 v11, v11, 17, s40
    v_lshlrev_b16 v14, 8, v14
    v_lshrrev_b32 v13, 2, v107
    v_add_u32 v99, v12, v11
    v_bitop3_b32 v107, v5, v13, v14 bitop3:0xea
    v_cvt_pk_bf16_f32 v109, v9, v10
    v_perm_b32 v12, v109, v109, s41
    v_bitop3_b32 v98, v4, v12, v98 bitop3:0xca
    v_perm_b32 v13, v109, v109, s42
    v_bitop3_b32 v99, v4, v13, v99 bitop3:0xca
    s_setprio 2
    v_and_b32 v7, -4, v40
    v_lshl_add_u32 v8, v40, 2, v7
    ds_write_b32 v8, v36
    v_lshl_add_u32 v7, v7, 2, v40
    ds_write_b8 v7, v44 offset:16
    v_and_b32 v9, -4, v41
    v_lshl_add_u32 v10, v41, 2, v9
    ds_write_b32 v10, v37
    v_lshl_add_u32 v9, v9, 2, v41
    ds_write_b8_d16_hi v9, v44 offset:16
    v_and_b32 v7, -4, v42
    v_lshl_add_u32 v8, v42, 2, v7
    ds_write_b32 v8, v38
    v_lshl_add_u32 v7, v7, 2, v42
    ds_write_b8 v7, v45 offset:16
    v_and_b32 v9, -4, v43
    v_lshl_add_u32 v10, v43, 2, v9
    ds_write_b32 v10, v39
    v_lshl_add_u32 v9, v9, 2, v43
    ds_write_b8_d16_hi v9, v45 offset:16
    s_add_u32 s46, s96, 0x3000000
    v_lshlrev_b32 v32, 1, v1
    buffer_load_dwordx4 v[32:35], v32, s[12:15], s46 offen nt
    s_waitcnt vmcnt(8)
    v_lshlrev_b32 v7, 16, v110
    v_and_b32 v8, 0xffff0000, v110
    v_lshlrev_b32 v9, 16, v111
    v_and_b32 v10, 0xffff0000, v111
    v_mul_f32 v7, 0.15915494, v7
    v_mul_f32 v8, 0.15915494, v8
    v_mul_f32 v9, 0.15915494, v9
    v_mul_f32 v10, 0.15915494, v10
    v_mul_hi_u32_u24 v14, 429497, v100
    v_lshrrev_b32 v12, 3, v112
    v_cos_f32 v7, v7
    v_lshlrev_b16 v13, 3, v112
    v_mad_i32_i24 v11, v14, s55, v100
    v_bitop3_b32 v12, v6, v13, v12 bitop3:0xca
    v_lshl_add_u32 v11, v11, 17, s40
    v_lshlrev_b16 v14, 8, v14
    v_lshrrev_b32 v13, 2, v112
    v_add_u32 v100, v12, v11
    v_bitop3_b32 v112, v5, v13, v14 bitop3:0xea
    v_mul_hi_u32_u24 v14, 429497, v101
    v_lshrrev_b32 v12, 3, v113
    v_cos_f32 v8, v8
    v_lshlrev_b16 v13, 3, v113
    v_mad_i32_i24 v11, v14, s55, v101
    v_bitop3_b32 v12, v6, v13, v12 bitop3:0xca
    v_lshl_add_u32 v11, v11, 17, s40
    v_lshlrev_b16 v14, 8, v14
    v_lshrrev_b32 v13, 2, v113
    v_add_u32 v101, v12, v11
    v_bitop3_b32 v113, v5, v13, v14 bitop3:0xea
    v_cvt_pk_bf16_f32 v110, v7, v8
    v_perm_b32 v12, v110, v110, s41
    v_bitop3_b32 v100, v4, v12, v100 bitop3:0xca
    v_perm_b32 v13, v110, v110, s42
    v_bitop3_b32 v101, v4, v13, v101 bitop3:0xca
    v_mul_hi_u32_u24 v14, 429497, v102
    v_lshrrev_b32 v12, 3, v114
    v_cos_f32 v9, v9
    v_lshlrev_b16 v13, 3, v114
    v_mad_i32_i24 v11, v14, s55, v102
    v_bitop3_b32 v12, v6, v13, v12 bitop3:0xca
    v_lshl_add_u32 v11, v11, 17, s40
    v_lshlrev_b16 v14, 8, v14
    v_lshrrev_b32 v13, 2, v114
    v_add_u32 v102, v12, v11
    v_bitop3_b32 v114, v5, v13, v14 bitop3:0xea
    v_mul_hi_u32_u24 v14, 429497, v103
    v_lshrrev_b32 v12, 3, v115
    v_cos_f32 v10, v10
    v_lshlrev_b16 v13, 3, v115
    v_mad_i32_i24 v11, v14, s55, v103
    v_bitop3_b32 v12, v6, v13, v12 bitop3:0xca
    v_lshl_add_u32 v11, v11, 17, s40
    v_lshlrev_b16 v14, 8, v14
    v_lshrrev_b32 v13, 2, v115
    v_add_u32 v103, v12, v11
    v_bitop3_b32 v115, v5, v13, v14 bitop3:0xea
    v_cvt_pk_bf16_f32 v111, v9, v10
    v_perm_b32 v12, v111, v111, s41
    v_bitop3_b32 v102, v4, v12, v102 bitop3:0xca
    v_perm_b32 v13, v111, v111, s42
    v_bitop3_b32 v103, v4, v13, v103 bitop3:0xca
    v_and_b32 v7, -4, v52
    v_lshl_add_u32 v8, v52, 2, v7
    ds_write_b32 v8, v48
    v_lshl_add_u32 v7, v7, 2, v52
    ds_write_b8 v7, v46 offset:16
    v_and_b32 v9, -4, v53
    v_lshl_add_u32 v10, v53, 2, v9
    ds_write_b32 v10, v49
    v_lshl_add_u32 v9, v9, 2, v53
    ds_write_b8_d16_hi v9, v46 offset:16
    v_and_b32 v7, -4, v54
    v_lshl_add_u32 v8, v54, 2, v7
    ds_write_b32 v8, v50
    v_lshl_add_u32 v7, v7, 2, v54
    ds_write_b8 v7, v47 offset:16
    v_and_b32 v9, -4, v55
    v_lshl_add_u32 v10, v55, 2, v9
    ds_write_b32 v10, v51
    v_lshl_add_u32 v9, v9, 2, v55
    ds_write_b8_d16_hi v9, v47 offset:16
    s_add_u32 s47, s96, 0x3000000
    s_lshr_b32 s47, s47, 1
    buffer_load_dwordx2 v[24:25], v1, s[16:19], s47 offen nt
    s_add_u32 s44, s96, 0x3400000
    s_lshr_b32 s44, s44, 1
    buffer_load_dwordx2 v[26:27], v1, s[16:19], s44 offen nt
    s_waitcnt vmcnt(6)
    v_lshlrev_b32 v7, 16, v124
    v_and_b32 v8, 0xffff0000, v124
    v_lshlrev_b32 v9, 16, v125
    v_and_b32 v10, 0xffff0000, v125
    v_mul_f32 v7, 0.15915494, v7
    v_mul_f32 v8, 0.15915494, v8
    v_mul_f32 v9, 0.15915494, v9
    v_mul_f32 v10, 0.15915494, v10
    v_mul_hi_u32_u24 v14, 429497, v116
    v_lshrrev_b32 v12, 3, v120
    v_cos_f32 v7, v7
    v_lshlrev_b16 v13, 3, v120
    v_mad_i32_i24 v11, v14, s55, v116
    v_bitop3_b32 v12, v6, v13, v12 bitop3:0xca
    v_lshl_add_u32 v11, v11, 17, s40
    v_lshlrev_b16 v14, 8, v14
    v_lshrrev_b32 v13, 2, v120
    v_add_u32 v116, v12, v11
    v_bitop3_b32 v120, v5, v13, v14 bitop3:0xea
    v_mul_hi_u32_u24 v14, 429497, v117
    v_lshrrev_b32 v12, 3, v121
    v_cos_f32 v8, v8
    v_lshlrev_b16 v13, 3, v121
    v_mad_i32_i24 v11, v14, s55, v117
    v_bitop3_b32 v12, v6, v13, v12 bitop3:0xca
    v_lshl_add_u32 v11, v11, 17, s40
    v_lshlrev_b16 v14, 8, v14
    v_lshrrev_b32 v13, 2, v121
    v_add_u32 v117, v12, v11
    v_bitop3_b32 v121, v5, v13, v14 bitop3:0xea
    v_cvt_pk_bf16_f32 v124, v7, v8
    v_perm_b32 v12, v124, v124, s41
    v_bitop3_b32 v116, v4, v12, v116 bitop3:0xca
    v_perm_b32 v13, v124, v124, s42
    v_bitop3_b32 v117, v4, v13, v117 bitop3:0xca
    v_mul_hi_u32_u24 v14, 429497, v118
    v_lshrrev_b32 v12, 3, v122
    v_cos_f32 v9, v9
    v_lshlrev_b16 v13, 3, v122
    v_mad_i32_i24 v11, v14, s55, v118
    v_bitop3_b32 v12, v6, v13, v12 bitop3:0xca
    v_lshl_add_u32 v11, v11, 17, s40
    v_lshlrev_b16 v14, 8, v14
    v_lshrrev_b32 v13, 2, v122
    v_add_u32 v118, v12, v11
    v_bitop3_b32 v122, v5, v13, v14 bitop3:0xea
    v_mul_hi_u32_u24 v14, 429497, v119
    v_lshrrev_b32 v12, 3, v123
    v_cos_f32 v10, v10
    v_lshlrev_b16 v13, 3, v123
    v_mad_i32_i24 v11, v14, s55, v119
    v_bitop3_b32 v12, v6, v13, v12 bitop3:0xca
    v_lshl_add_u32 v11, v11, 17, s40
    v_lshlrev_b16 v14, 8, v14
    v_lshrrev_b32 v13, 2, v123
    v_add_u32 v119, v12, v11
    v_bitop3_b32 v123, v5, v13, v14 bitop3:0xea
    v_cvt_pk_bf16_f32 v125, v9, v10
    v_perm_b32 v12, v125, v125, s41
    v_bitop3_b32 v118, v4, v12, v118 bitop3:0xca
    v_perm_b32 v13, v125, v125, s42
    v_bitop3_b32 v119, v4, v13, v119 bitop3:0xca
    s_setprio 1
    v_and_b32 v7, -4, v60
    v_lshl_add_u32 v8, v60, 2, v7
    ds_write_b32 v8, v56
    v_lshl_add_u32 v7, v7, 2, v60
    ds_write_b8 v7, v64 offset:16
    v_and_b32 v9, -4, v61
    v_lshl_add_u32 v10, v61, 2, v9
    ds_write_b32 v10, v57
    v_lshl_add_u32 v9, v9, 2, v61
    ds_write_b8_d16_hi v9, v64 offset:16
    v_and_b32 v7, -4, v62
    v_lshl_add_u32 v8, v62, 2, v7
    ds_write_b32 v8, v58
    v_lshl_add_u32 v7, v7, 2, v62
    ds_write_b8 v7, v65 offset:16
    v_and_b32 v9, -4, v63
    v_lshl_add_u32 v10, v63, 2, v9
    ds_write_b32 v10, v59
    v_lshl_add_u32 v9, v9, 2, v63
    ds_write_b8_d16_hi v9, v65 offset:16
    s_add_u32 s45, s96, 0x3400000
    v_lshlrev_b32 v36, 1, v1
    buffer_load_dwordx4 v[36:39], v36, s[8:11], s45 offen nt
    s_add_u32 s46, s96, 0x3400000
    v_lshlrev_b32 v40, 1, v1
    buffer_load_dwordx4 v[40:43], v40, s[12:15], s46 offen nt
    v_and_b32 v7, -4, v72
    v_lshl_add_u32 v8, v72, 2, v7
    ds_write_b32 v8, v68
    v_lshl_add_u32 v7, v7, 2, v72
    ds_write_b8 v7, v66 offset:16
    v_and_b32 v9, -4, v73
    v_lshl_add_u32 v10, v73, 2, v9
    ds_write_b32 v10, v69
    v_lshl_add_u32 v9, v9, 2, v73
    ds_write_b8_d16_hi v9, v66 offset:16
    v_and_b32 v7, -4, v74
    v_lshl_add_u32 v8, v74, 2, v7
    ds_write_b32 v8, v70
    v_lshl_add_u32 v7, v7, 2, v74
    ds_write_b8 v7, v67 offset:16
    v_and_b32 v9, -4, v75
    v_lshl_add_u32 v10, v75, 2, v9
    ds_write_b32 v10, v71
    v_lshl_add_u32 v9, v9, 2, v75
    ds_write_b8_d16_hi v9, v67 offset:16
    s_add_u32 s47, s96, 0x3800000
    v_lshlrev_b32 v48, 1, v1
    buffer_load_dwordx4 v[48:51], v48, s[8:11], s47 offen nt
    s_waitcnt vmcnt(7)
    v_lshlrev_b32 v7, 16, v126
    v_and_b32 v8, 0xffff0000, v126
    v_lshlrev_b32 v9, 16, v127
    v_and_b32 v10, 0xffff0000, v127
    v_mul_f32 v7, 0.15915494, v7
    v_mul_f32 v8, 0.15915494, v8
    v_mul_f32 v9, 0.15915494, v9
    v_mul_f32 v10, 0.15915494, v10
    v_mul_hi_u32_u24 v14, 429497, v16
    v_lshrrev_b32 v12, 3, v20
    v_cos_f32 v7, v7
    v_lshlrev_b16 v13, 3, v20
    v_mad_i32_i24 v11, v14, s55, v16
    v_bitop3_b32 v12, v6, v13, v12 bitop3:0xca
    v_lshl_add_u32 v11, v11, 17, s40
    v_lshlrev_b16 v14, 8, v14
    v_lshrrev_b32 v13, 2, v20
    v_add_u32 v16, v12, v11
    v_bitop3_b32 v20, v5, v13, v14 bitop3:0xea
    v_mul_hi_u32_u24 v14, 429497, v17
    v_lshrrev_b32 v12, 3, v21
    v_cos_f32 v8, v8
    v_lshlrev_b16 v13, 3, v21
    v_mad_i32_i24 v11, v14, s55, v17
    v_bitop3_b32 v12, v6, v13, v12 bitop3:0xca
    v_lshl_add_u32 v11, v11, 17, s40
    v_lshlrev_b16 v14, 8, v14
    v_lshrrev_b32 v13, 2, v21
    v_add_u32 v17, v12, v11
    v_bitop3_b32 v21, v5, v13, v14 bitop3:0xea
    v_cvt_pk_bf16_f32 v126, v7, v8
    v_perm_b32 v12, v126, v126, s41
    v_bitop3_b32 v16, v4, v12, v16 bitop3:0xca
    v_perm_b32 v13, v126, v126, s42
    v_bitop3_b32 v17, v4, v13, v17 bitop3:0xca
    v_mul_hi_u32_u24 v14, 429497, v18
    v_lshrrev_b32 v12, 3, v22
    v_cos_f32 v9, v9
    v_lshlrev_b16 v13, 3, v22
    v_mad_i32_i24 v11, v14, s55, v18
    v_bitop3_b32 v12, v6, v13, v12 bitop3:0xca
    v_lshl_add_u32 v11, v11, 17, s40
    v_lshlrev_b16 v14, 8, v14
    v_lshrrev_b32 v13, 2, v22
    v_add_u32 v18, v12, v11
    v_bitop3_b32 v22, v5, v13, v14 bitop3:0xea
    v_mul_hi_u32_u24 v14, 429497, v19
    v_lshrrev_b32 v12, 3, v23
    v_cos_f32 v10, v10
    v_lshlrev_b16 v13, 3, v23
    v_mad_i32_i24 v11, v14, s55, v19
    v_bitop3_b32 v12, v6, v13, v12 bitop3:0xca
    v_lshl_add_u32 v11, v11, 17, s40
    v_lshlrev_b16 v14, 8, v14
    v_lshrrev_b32 v13, 2, v23
    v_add_u32 v19, v12, v11
    v_bitop3_b32 v23, v5, v13, v14 bitop3:0xea
    v_cvt_pk_bf16_f32 v127, v9, v10
    v_perm_b32 v12, v127, v127, s41
    v_bitop3_b32 v18, v4, v12, v18 bitop3:0xca
    v_perm_b32 v13, v127, v127, s42
    v_bitop3_b32 v19, v4, v13, v19 bitop3:0xca
    s_setprio 0
    v_and_b32 v7, -4, v80
    v_lshl_add_u32 v8, v80, 2, v7
    ds_write_b32 v8, v76
    v_lshl_add_u32 v7, v7, 2, v80
    ds_write_b8 v7, v84 offset:16
    v_and_b32 v9, -4, v81
    v_lshl_add_u32 v10, v81, 2, v9
    ds_write_b32 v10, v77
    v_lshl_add_u32 v9, v9, 2, v81
    ds_write_b8_d16_hi v9, v84 offset:16
    v_and_b32 v7, -4, v82
    v_lshl_add_u32 v8, v82, 2, v7
    ds_write_b32 v8, v78
    v_lshl_add_u32 v7, v7, 2, v82
    ds_write_b8 v7, v85 offset:16
    v_and_b32 v9, -4, v83
    v_lshl_add_u32 v10, v83, 2, v9
    ds_write_b32 v10, v79
    v_lshl_add_u32 v9, v9, 2, v83
    ds_write_b8_d16_hi v9, v85 offset:16
    s_add_u32 s44, s96, 0x3800000
    v_lshlrev_b32 v52, 1, v1
    buffer_load_dwordx4 v[52:55], v52, s[12:15], s44 offen nt
    s_waitcnt vmcnt(4)
    v_lshlrev_b32 v7, 16, v24
    v_and_b32 v8, 0xffff0000, v24
    v_lshlrev_b32 v9, 16, v25
    v_and_b32 v10, 0xffff0000, v25
    v_mul_f32 v7, 0.15915494, v7
    v_mul_f32 v8, 0.15915494, v8
    v_mul_f32 v9, 0.15915494, v9
    v_mul_f32 v10, 0.15915494, v10
    v_mul_hi_u32_u24 v14, 429497, v28
    v_lshrrev_b32 v12, 3, v32
    v_cos_f32 v7, v7
    v_lshlrev_b16 v13, 3, v32
    v_mad_i32_i24 v11, v14, s55, v28
    v_bitop3_b32 v12, v6, v13, v12 bitop3:0xca
    v_lshl_add_u32 v11, v11, 17, s40
    v_lshlrev_b16 v14, 8, v14
    v_lshrrev_b32 v13, 2, v32
    v_add_u32 v28, v12, v11
    v_bitop3_b32 v32, v5, v13, v14 bitop3:0xea
    v_mul_hi_u32_u24 v14, 429497, v29
    v_lshrrev_b32 v12, 3, v33
    v_cos_f32 v8, v8
    v_lshlrev_b16 v13, 3, v33
    v_mad_i32_i24 v11, v14, s55, v29
    v_bitop3_b32 v12, v6, v13, v12 bitop3:0xca
    v_lshl_add_u32 v11, v11, 17, s40
    v_lshlrev_b16 v14, 8, v14
    v_lshrrev_b32 v13, 2, v33
    v_add_u32 v29, v12, v11
    v_bitop3_b32 v33, v5, v13, v14 bitop3:0xea
    v_cvt_pk_bf16_f32 v24, v7, v8
    v_perm_b32 v12, v24, v24, s41
    v_bitop3_b32 v28, v4, v12, v28 bitop3:0xca
    v_perm_b32 v13, v24, v24, s42
    v_bitop3_b32 v29, v4, v13, v29 bitop3:0xca
    v_mul_hi_u32_u24 v14, 429497, v30
    v_lshrrev_b32 v12, 3, v34
    v_cos_f32 v9, v9
    v_lshlrev_b16 v13, 3, v34
    v_mad_i32_i24 v11, v14, s55, v30
    v_bitop3_b32 v12, v6, v13, v12 bitop3:0xca
    v_lshl_add_u32 v11, v11, 17, s40
    v_lshlrev_b16 v14, 8, v14
    v_lshrrev_b32 v13, 2, v34
    v_add_u32 v30, v12, v11
    v_bitop3_b32 v34, v5, v13, v14 bitop3:0xea
    v_mul_hi_u32_u24 v14, 429497, v31
    v_lshrrev_b32 v12, 3, v35
    v_cos_f32 v10, v10
    v_lshlrev_b16 v13, 3, v35
    v_mad_i32_i24 v11, v14, s55, v31
    v_bitop3_b32 v12, v6, v13, v12 bitop3:0xca
    v_lshl_add_u32 v11, v11, 17, s40
    v_lshlrev_b16 v14, 8, v14
    v_lshrrev_b32 v13, 2, v35
    v_add_u32 v31, v12, v11
    v_bitop3_b32 v35, v5, v13, v14 bitop3:0xea
    v_cvt_pk_bf16_f32 v25, v9, v10
    v_perm_b32 v12, v25, v25, s41
    v_bitop3_b32 v30, v4, v12, v30 bitop3:0xca
    v_perm_b32 v13, v25, v25, s42
    v_bitop3_b32 v31, v4, v13, v31 bitop3:0xca
    v_and_b32 v7, -4, v92
    v_lshl_add_u32 v8, v92, 2, v7
    ds_write_b32 v8, v88
    v_lshl_add_u32 v7, v7, 2, v92
    ds_write_b8 v7, v86 offset:16
    v_and_b32 v9, -4, v93
    v_lshl_add_u32 v10, v93, 2, v9
    ds_write_b32 v10, v89
    v_lshl_add_u32 v9, v9, 2, v93
    ds_write_b8_d16_hi v9, v86 offset:16
    v_and_b32 v7, -4, v94
    v_lshl_add_u32 v8, v94, 2, v7
    ds_write_b32 v8, v90
    v_lshl_add_u32 v7, v7, 2, v94
    ds_write_b8 v7, v87 offset:16
    v_and_b32 v9, -4, v95
    v_lshl_add_u32 v10, v95, 2, v9
    ds_write_b32 v10, v91
    v_lshl_add_u32 v9, v9, 2, v95
    ds_write_b8_d16_hi v9, v87 offset:16
    s_add_u32 s45, s96, 0x3800000
    s_lshr_b32 s45, s45, 1
    buffer_load_dwordx2 v[44:45], v1, s[16:19], s45 offen nt
    s_add_u32 s46, s96, 0x3c00000
    s_lshr_b32 s46, s46, 1
    buffer_load_dwordx2 v[46:47], v1, s[16:19], s46 offen nt
    s_waitcnt vmcnt(4)
    v_lshlrev_b32 v7, 16, v26
    v_and_b32 v8, 0xffff0000, v26
    v_lshlrev_b32 v9, 16, v27
    v_and_b32 v10, 0xffff0000, v27
    v_mul_f32 v7, 0.15915494, v7
    v_mul_f32 v8, 0.15915494, v8
    v_mul_f32 v9, 0.15915494, v9
    v_mul_f32 v10, 0.15915494, v10
    v_mul_hi_u32_u24 v14, 429497, v36
    v_lshrrev_b32 v12, 3, v40
    v_cos_f32 v7, v7
    v_lshlrev_b16 v13, 3, v40
    v_mad_i32_i24 v11, v14, s55, v36
    v_bitop3_b32 v12, v6, v13, v12 bitop3:0xca
    v_lshl_add_u32 v11, v11, 17, s40
    v_lshlrev_b16 v14, 8, v14
    v_lshrrev_b32 v13, 2, v40
    v_add_u32 v36, v12, v11
    v_bitop3_b32 v40, v5, v13, v14 bitop3:0xea
    v_mul_hi_u32_u24 v14, 429497, v37
    v_lshrrev_b32 v12, 3, v41
    v_cos_f32 v8, v8
    v_lshlrev_b16 v13, 3, v41
    v_mad_i32_i24 v11, v14, s55, v37
    v_bitop3_b32 v12, v6, v13, v12 bitop3:0xca
    v_lshl_add_u32 v11, v11, 17, s40
    v_lshlrev_b16 v14, 8, v14
    v_lshrrev_b32 v13, 2, v41
    v_add_u32 v37, v12, v11
    v_bitop3_b32 v41, v5, v13, v14 bitop3:0xea
    v_cvt_pk_bf16_f32 v26, v7, v8
    v_perm_b32 v12, v26, v26, s41
    v_bitop3_b32 v36, v4, v12, v36 bitop3:0xca
    v_perm_b32 v13, v26, v26, s42
    v_bitop3_b32 v37, v4, v13, v37 bitop3:0xca
    v_mul_hi_u32_u24 v14, 429497, v38
    v_lshrrev_b32 v12, 3, v42
    v_cos_f32 v9, v9
    v_lshlrev_b16 v13, 3, v42
    v_mad_i32_i24 v11, v14, s55, v38
    v_bitop3_b32 v12, v6, v13, v12 bitop3:0xca
    v_lshl_add_u32 v11, v11, 17, s40
    v_lshlrev_b16 v14, 8, v14
    v_lshrrev_b32 v13, 2, v42
    v_add_u32 v38, v12, v11
    v_bitop3_b32 v42, v5, v13, v14 bitop3:0xea
    v_mul_hi_u32_u24 v14, 429497, v39
    v_lshrrev_b32 v12, 3, v43
    v_cos_f32 v10, v10
    v_lshlrev_b16 v13, 3, v43
    v_mad_i32_i24 v11, v14, s55, v39
    v_bitop3_b32 v12, v6, v13, v12 bitop3:0xca
    v_lshl_add_u32 v11, v11, 17, s40
    v_lshlrev_b16 v14, 8, v14
    v_lshrrev_b32 v13, 2, v43
    v_add_u32 v39, v12, v11
    v_bitop3_b32 v43, v5, v13, v14 bitop3:0xea
    v_cvt_pk_bf16_f32 v27, v9, v10
    v_perm_b32 v12, v27, v27, s41
    v_bitop3_b32 v38, v4, v12, v38 bitop3:0xca
    v_perm_b32 v13, v27, v27, s42
    v_bitop3_b32 v39, v4, v13, v39 bitop3:0xca
    v_add_u32 v7, s72, v0
    v_add_u32 v12, s73, v0
    v_add_u32 v13, s85, v0
    v_add_u32 v14, s91, v0
    v_add_u32 v15, s93, v0
    s_min_i32 s3, s72, s73
    s_min_i32 s3, s3, s85
    s_min_i32 s3, s3, s91
    s_min_i32 s3, s3, s93
    v_add_u32 v3, s3, v0
    v_mov_b32 v8, 0
    v_mov_b32 v9, 0
    v_mov_b32 v10, 0
    v_mov_b32 v11, 0
    s_waitcnt lgkmcnt(0)
    s_barrier
    ds_read_b128 v[56:59], v7 offset:0
    ds_read_b128 v[60:63], v12 offset:0
    ds_read_b128 v[68:71], v13 offset:0
    ds_read_b128 v[72:75], v14 offset:0
    ds_read_b128 v[64:67], v15 offset:0
    ds_write_b128 v3, v[8:11]
    ds_read_b128 v[76:79], v7 offset:16384
    ds_read_b128 v[80:83], v12 offset:16384
    ds_read_b128 v[88:91], v13 offset:16384
    ds_read_b128 v[92:95], v14 offset:16384
    ds_read_b128 v[84:87], v15 offset:16384
    s_waitcnt lgkmcnt(0)
    s_barrier
    s_setprio 3
    s_add_u32 s47, s35, 0x4000
    s_add_u32 s47, s47, s72
    buffer_store_dwordx4 v[56:59], v0, s[20:23], s47 offen sc1
    s_add_u32 s44, s96, 0x3c00000
    s_nop 0
    v_lshlrev_b32 v56, 1, v1
    buffer_load_dwordx4 v[56:59], v56, s[8:11], s44 offen nt
    s_add_u32 s45, s35, 0x4000
    s_add_u32 s45, s45, s73
    buffer_store_dwordx4 v[60:63], v0, s[20:23], s45 offen sc1
    s_add_u32 s46, s96, 0x3c00000
    s_nop 0
    v_lshlrev_b32 v60, 1, v1
    buffer_load_dwordx4 v[60:63], v60, s[12:15], s46 offen nt
    ds_add_u32 v104, v2
    ds_add_u32 v105, v2
    ds_add_u32 v106, v2
    ds_add_u32 v107, v2
    ds_add_u32 v112, v2
    ds_add_u32 v113, v2
    ds_add_u32 v114, v2
    ds_add_u32 v115, v2
    s_setprio 2
    ds_add_u32 v120, v2
    ds_add_u32 v121, v2
    ds_add_u32 v122, v2
    ds_add_u32 v123, v2
    ds_add_u32 v20, v2
    ds_add_u32 v21, v2
    ds_add_u32 v22, v2
    ds_add_u32 v23, v2
    s_setprio 1
    s_add_u32 s47, s35, 0x4000
    s_add_u32 s47, s47, s85
    buffer_store_dwordx4 v[68:71], v0, s[20:23], s47 offen sc1
    s_add_u32 s44, s96, 0x4000000
    s_nop 0
    v_lshlrev_b32 v68, 1, v1
    buffer_load_dwordx4 v[68:71], v68, s[8:11], s44 offen nt
    ds_add_u32 v32, v2
    ds_add_u32 v33, v2
    ds_add_u32 v34, v2
    ds_add_u32 v35, v2
    ds_add_u32 v40, v2
    ds_add_u32 v41, v2
    ds_add_u32 v42, v2
    ds_add_u32 v43, v2
    s_setprio 0
    s_waitcnt vmcnt(6)
    v_lshlrev_b32 v7, 16, v44
    v_and_b32 v8, 0xffff0000, v44
    v_lshlrev_b32 v9, 16, v45
    v_and_b32 v10, 0xffff0000, v45
    v_mul_f32 v7, 0.15915494, v7
    v_mul_f32 v8, 0.15915494, v8
    v_mul_f32 v9, 0.15915494, v9
    v_mul_f32 v10, 0.15915494, v10
    v_mul_hi_u32_u24 v14, 429497, v48
    v_lshrrev_b32 v12, 3, v52
    v_cos_f32 v7, v7
    v_lshlrev_b16 v13, 3, v52
    v_mad_i32_i24 v11, v14, s55, v48
    v_bitop3_b32 v12, v6, v13, v12 bitop3:0xca
    v_lshl_add_u32 v11, v11, 17, s40
    v_lshlrev_b16 v14, 8, v14
    v_lshrrev_b32 v13, 2, v52
    v_add_u32 v48, v12, v11
    v_bitop3_b32 v52, v5, v13, v14 bitop3:0xea
    ds_add_u32 v52, v2
    v_mul_hi_u32_u24 v14, 429497, v49
    v_lshrrev_b32 v12, 3, v53
    v_cos_f32 v8, v8
    v_lshlrev_b16 v13, 3, v53
    v_mad_i32_i24 v11, v14, s55, v49
    v_bitop3_b32 v12, v6, v13, v12 bitop3:0xca
    v_lshl_add_u32 v11, v11, 17, s40
    v_lshlrev_b16 v14, 8, v14
    v_lshrrev_b32 v13, 2, v53
    v_add_u32 v49, v12, v11
    v_bitop3_b32 v53, v5, v13, v14 bitop3:0xea
    ds_add_u32 v53, v2
    v_cvt_pk_bf16_f32 v44, v7, v8
    v_perm_b32 v12, v44, v44, s41
    v_bitop3_b32 v48, v4, v12, v48 bitop3:0xca
    v_perm_b32 v13, v44, v44, s42
    v_bitop3_b32 v49, v4, v13, v49 bitop3:0xca
    v_mul_hi_u32_u24 v14, 429497, v50
    v_lshrrev_b32 v12, 3, v54
    v_cos_f32 v9, v9
    v_lshlrev_b16 v13, 3, v54
    v_mad_i32_i24 v11, v14, s55, v50
    v_bitop3_b32 v12, v6, v13, v12 bitop3:0xca
    v_lshl_add_u32 v11, v11, 17, s40
    v_lshlrev_b16 v14, 8, v14
    v_lshrrev_b32 v13, 2, v54
    v_add_u32 v50, v12, v11
    v_bitop3_b32 v54, v5, v13, v14 bitop3:0xea
    ds_add_u32 v54, v2
    v_mul_hi_u32_u24 v14, 429497, v51
    v_lshrrev_b32 v12, 3, v55
    v_cos_f32 v10, v10
    v_lshlrev_b16 v13, 3, v55
    v_mad_i32_i24 v11, v14, s55, v51
    v_bitop3_b32 v12, v6, v13, v12 bitop3:0xca
    v_lshl_add_u32 v11, v11, 17, s40
    v_lshlrev_b16 v14, 8, v14
    v_lshrrev_b32 v13, 2, v55
    v_add_u32 v51, v12, v11
    v_bitop3_b32 v55, v5, v13, v14 bitop3:0xea
    ds_add_u32 v55, v2
    v_cvt_pk_bf16_f32 v45, v9, v10
    v_perm_b32 v12, v45, v45, s41
    v_bitop3_b32 v50, v4, v12, v50 bitop3:0xca
    v_perm_b32 v13, v45, v45, s42
    v_bitop3_b32 v51, v4, v13, v51 bitop3:0xca
    s_waitcnt vmcnt(2)
    v_lshlrev_b32 v7, 16, v46
    v_and_b32 v8, 0xffff0000, v46
    v_lshlrev_b32 v9, 16, v47
    v_and_b32 v10, 0xffff0000, v47
    v_mul_f32 v7, 0.15915494, v7
    v_mul_f32 v8, 0.15915494, v8
    v_mul_f32 v9, 0.15915494, v9
    v_mul_f32 v10, 0.15915494, v10
    v_mul_hi_u32_u24 v14, 429497, v56
    v_lshrrev_b32 v12, 3, v60
    v_cos_f32 v7, v7
    v_lshlrev_b16 v13, 3, v60
    v_mad_i32_i24 v11, v14, s55, v56
    v_bitop3_b32 v12, v6, v13, v12 bitop3:0xca
    v_lshl_add_u32 v11, v11, 17, s40
    v_lshlrev_b16 v14, 8, v14
    v_lshrrev_b32 v13, 2, v60
    v_add_u32 v56, v12, v11
    v_bitop3_b32 v60, v5, v13, v14 bitop3:0xea
    ds_add_u32 v60, v2
    v_mul_hi_u32_u24 v14, 429497, v57
    v_lshrrev_b32 v12, 3, v61
    v_cos_f32 v8, v8
    v_lshlrev_b16 v13, 3, v61
    v_mad_i32_i24 v11, v14, s55, v57
    v_bitop3_b32 v12, v6, v13, v12 bitop3:0xca
    v_lshl_add_u32 v11, v11, 17, s40
    v_lshlrev_b16 v14, 8, v14
    v_lshrrev_b32 v13, 2, v61
    v_add_u32 v57, v12, v11
    v_bitop3_b32 v61, v5, v13, v14 bitop3:0xea
    ds_add_u32 v61, v2
    v_cvt_pk_bf16_f32 v46, v7, v8
    v_perm_b32 v12, v46, v46, s41
    v_bitop3_b32 v56, v4, v12, v56 bitop3:0xca
    v_perm_b32 v13, v46, v46, s42
    v_bitop3_b32 v57, v4, v13, v57 bitop3:0xca
    v_mul_hi_u32_u24 v14, 429497, v58
    v_lshrrev_b32 v12, 3, v62
    v_cos_f32 v9, v9
    v_lshlrev_b16 v13, 3, v62
    v_mad_i32_i24 v11, v14, s55, v58
    v_bitop3_b32 v12, v6, v13, v12 bitop3:0xca
    v_lshl_add_u32 v11, v11, 17, s40
    v_lshlrev_b16 v14, 8, v14
    v_lshrrev_b32 v13, 2, v62
    v_add_u32 v58, v12, v11
    v_bitop3_b32 v62, v5, v13, v14 bitop3:0xea
    ds_add_u32 v62, v2
    v_mul_hi_u32_u24 v14, 429497, v59
    v_lshrrev_b32 v12, 3, v63
    v_cos_f32 v10, v10
    v_lshlrev_b16 v13, 3, v63
    v_mad_i32_i24 v11, v14, s55, v59
    v_bitop3_b32 v12, v6, v13, v12 bitop3:0xca
    v_lshl_add_u32 v11, v11, 17, s40
    v_lshlrev_b16 v14, 8, v14
    v_lshrrev_b32 v13, 2, v63
    v_add_u32 v59, v12, v11
    v_bitop3_b32 v63, v5, v13, v14 bitop3:0xea
    ds_add_u32 v63, v2
    v_cvt_pk_bf16_f32 v47, v9, v10
    v_perm_b32 v12, v47, v47, s41
    v_bitop3_b32 v58, v4, v12, v58 bitop3:0xca
    v_perm_b32 v13, v47, v47, s42
    v_bitop3_b32 v59, v4, v13, v59 bitop3:0xca
    v_lshrrev_b32 v8, 2, v0
    v_and_b32 v7, 0x3c00, v0
    v_bitop3_b32 v7, v5, v8, v7 bitop3:0xea
    s_waitcnt lgkmcnt(0)
    s_barrier
    ds_read2st64_b32 v[8:9], v7 offset0:0 offset1:1
    ds_read2st64_b32 v[10:11], v7 offset0:2 offset1:3
    s_add_u32 s45, s35, 0x4000
    s_add_u32 s45, s45, s91
    buffer_store_dwordx4 v[72:75], v0, s[20:23], s45 offen sc1
    s_add_u32 s46, s96, 0x4000000
    s_nop 0
    v_lshlrev_b32 v72, 1, v1
    buffer_load_dwordx4 v[72:75], v72, s[12:15], s46 offen nt
    s_waitcnt lgkmcnt(0)
    v_lshl_or_b32 v12, v9, 16, v8
    v_lshl_or_b32 v13, v11, 16, v10
    v_mov_b32 v14, v12
    v_mov_b32 v15, v13
    s_nop 0
    v_add_u32_dpp v14, v14, v14 row_shr:1 row_mask:0xf bank_mask:0xf bound_ctrl:1
    v_add_u32_dpp v15, v15, v15 row_shr:1 row_mask:0xf bank_mask:0xf bound_ctrl:1
    s_nop 0
    v_add_u32_dpp v14, v14, v14 row_shr:2 row_mask:0xf bank_mask:0xf bound_ctrl:1
    v_add_u32_dpp v15, v15, v15 row_shr:2 row_mask:0xf bank_mask:0xf bound_ctrl:1
    s_nop 0
    v_add_u32_dpp v14, v14, v14 row_shr:4 row_mask:0xf bank_mask:0xf bound_ctrl:1
    v_add_u32_dpp v15, v15, v15 row_shr:4 row_mask:0xf bank_mask:0xf bound_ctrl:1
    s_nop 0
    v_add_u32_dpp v14, v14, v14 row_shr:8 row_mask:0xf bank_mask:0xf bound_ctrl:1
    v_add_u32_dpp v15, v15, v15 row_shr:8 row_mask:0xf bank_mask:0xf bound_ctrl:1
    s_nop 0
    v_add_u32_dpp v14, v14, v14 row_bcast:15 row_mask:0xa bank_mask:0xf
    v_add_u32_dpp v15, v15, v15 row_bcast:15 row_mask:0xa bank_mask:0xf
    s_nop 0
    v_add_u32_dpp v14, v14, v14 row_bcast:31 row_mask:0xc bank_mask:0xf
    v_add_u32_dpp v15, v15, v15 row_bcast:31 row_mask:0xc bank_mask:0xf
    v_readlane_b32 s48, v14, 63
    v_readlane_b32 s49, v15, 63
    s_lshl_b32 s54, s32, 2
    v_mov_b32 v8, s54
    s_and_b32 s50, s48, 0xffff
    s_lshr_b32 s51, s48, 16
    s_and_b32 s52, s49, 0xffff
    s_lshr_b32 s53, s49, 16
    s_add_u32 s51, s51, s50
    s_add_u32 s52, s52, s51
    s_add_u32 s53, s53, s52
    v_mov_b32 v9, s53
    s_mov_b64 exec, 1
    ds_write_b32 v8, v9 offset:16384
    s_mov_b64 exec, -1
    v_and_b32 v8, 60, v7
    s_waitcnt lgkmcnt(0)
    s_barrier
    ds_read_b32 v9, v8 offset:16384
    s_waitcnt lgkmcnt(0)
    v_add_u32_dpp v9, v9, v9 row_shr:1 row_mask:0xf bank_mask:0xf bound_ctrl:1
    s_nop 1
    v_add_u32_dpp v9, v9, v9 row_shr:2 row_mask:0xf bank_mask:0xf bound_ctrl:1
    s_nop 1
    v_add_u32_dpp v9, v9, v9 row_shr:4 row_mask:0xf bank_mask:0xf bound_ctrl:1
    s_nop 1
    v_add_u32_dpp v9, v9, v9 row_shr:8 row_mask:0xf bank_mask:0xf bound_ctrl:1
    s_nop 0
    v_readlane_b32 s54, v9, s32
    s_sub_u32 s54, s54, s53
    s_add_u32 s50, s50, s54
    s_add_u32 s51, s51, s54
    s_add_u32 s52, s52, s54
    s_pack_ll_b32_b16 s48, s54, s50
    s_pack_ll_b32_b16 s49, s51, s52
    v_add_u32 v14, s48, v14
    v_add_u32 v15, s49, v15
    v_sub_u32 v12, v14, v12
    v_sub_u32 v13, v15, v13
    v_and_b32 v8, 0xffff, v12
    v_lshrrev_b32 v9, 16, v12
    v_and_b32 v10, 0xffff, v13
    v_lshrrev_b32 v11, 16, v13
    ds_write2st64_b32 v7, v8, v9 offset0:0 offset1:1
    ds_write2st64_b32 v7, v10, v11 offset0:2 offset1:3
    v_and_b32 v8, 0x3f0, v0
    v_lshl_add_u32 v8, v8, 1, s36
    ds_write_b64 v8, v[12:13] offset:20480
    s_bitset0_b64 exec, 63
    s_not_b64 exec, exec
    ds_write_b64 v8, v[14:15] offset:20512
    s_mov_b64 exec, -1
    s_waitcnt lgkmcnt(0)
    s_barrier
    s_setprio 3
    ds_add_rtn_u32 v104, v104, v2
    ds_add_rtn_u32 v105, v105, v2
    ds_add_rtn_u32 v106, v106, v2
    ds_add_rtn_u32 v107, v107, v2
    ds_read_b128 v[12:15], v0 offset:20480
    v_cmp_gt_u32 vcc, 8448, v0
    s_add_u32 s47, s35, 0x4000
    s_add_u32 s47, s47, s93
    buffer_store_dwordx4 v[64:67], v0, s[20:23], s47 offen sc1
    s_add_u32 s44, s96, 0x4000000
    s_lshr_b32 s44, s44, 1
    buffer_load_dwordx2 v[64:65], v1, s[16:19], s44 offen nt
    s_add_u32 s45, s96, 0x4400000
    s_lshr_b32 s45, s45, 1
    buffer_load_dwordx2 v[66:67], v1, s[16:19], s45 offen nt
    ds_add_rtn_u32 v112, v112, v2
    ds_add_rtn_u32 v113, v113, v2
    ds_add_rtn_u32 v114, v114, v2
    ds_add_rtn_u32 v115, v115, v2
    s_setprio 2
    ds_add_rtn_u32 v120, v120, v2
    ds_add_rtn_u32 v121, v121, v2
    ds_add_rtn_u32 v122, v122, v2
    ds_add_rtn_u32 v123, v123, v2
    s_waitcnt lgkmcnt(8)
    s_cbranch_vccz L1_p2
    s_add_u32 s46, s35, 0x2a40000
    s_mov_b64 exec, vcc
    buffer_store_dwordx4 v[12:15], v0, s[24:27], s46 offen sc1
    s_mov_b64 exec, -1
L1_p2:
    s_add_u32 s47, s35, 0x8000
    s_add_u32 s47, s47, s72
    buffer_store_dwordx4 v[76:79], v0, s[20:23], s47 offen sc1
    s_add_u32 s44, s96, 0x4400000
    s_nop 0
    v_lshlrev_b32 v76, 1, v1
    buffer_load_dwordx4 v[76:79], v76, s[8:11], s44 offen nt
    ds_add_rtn_u32 v20, v20, v2
    ds_add_rtn_u32 v21, v21, v2
    ds_add_rtn_u32 v22, v22, v2
    ds_add_rtn_u32 v23, v23, v2
    s_setprio 1
    ds_add_rtn_u32 v32, v32, v2
    ds_add_rtn_u32 v33, v33, v2
    ds_add_rtn_u32 v34, v34, v2
    ds_add_rtn_u32 v35, v35, v2
    ds_add_rtn_u32 v40, v40, v2
    ds_add_rtn_u32 v41, v41, v2
    ds_add_rtn_u32 v42, v42, v2
    ds_add_rtn_u32 v43, v43, v2
    s_add_u32 s45, s35, 0x8000
    s_add_u32 s45, s45, s73
    buffer_store_dwordx4 v[80:83], v0, s[20:23], s45 offen sc1
    s_add_u32 s46, s96, 0x4400000
    s_nop 0
    v_lshlrev_b32 v80, 1, v1
    buffer_load_dwordx4 v[80:83], v80, s[12:15], s46 offen nt
    s_setprio 0
    ds_add_rtn_u32 v52, v52, v2
    ds_add_rtn_u32 v53, v53, v2
    ds_add_rtn_u32 v54, v54, v2
    ds_add_rtn_u32 v55, v55, v2
    ds_add_rtn_u32 v60, v60, v2
    ds_add_rtn_u32 v61, v61, v2
    ds_add_rtn_u32 v62, v62, v2
    ds_add_rtn_u32 v63, v63, v2
    s_waitcnt lgkmcnt(0)
    s_barrier
    s_setprio 3
    v_and_b32 v7, -4, v104
    v_lshl_add_u32 v8, v104, 2, v7
    ds_write_b32 v8, v96
    v_lshl_add_u32 v7, v7, 2, v104
    ds_write_b8 v7, v108 offset:16
    v_and_b32 v9, -4, v105
    v_lshl_add_u32 v10, v105, 2, v9
    ds_write_b32 v10, v97
    v_lshl_add_u32 v9, v9, 2, v105
    ds_write_b8_d16_hi v9, v108 offset:16
    v_and_b32 v7, -4, v106
    v_lshl_add_u32 v8, v106, 2, v7
    ds_write_b32 v8, v98
    v_lshl_add_u32 v7, v7, 2, v106
    ds_write_b8 v7, v109 offset:16
    v_and_b32 v9, -4, v107
    v_lshl_add_u32 v10, v107, 2, v9
    ds_write_b32 v10, v99
    v_lshl_add_u32 v9, v9, 2, v107
    ds_write_b8_d16_hi v9, v109 offset:16
    s_add_u32 s47, s35, 0x8000
    s_add_u32 s47, s47, s85
    buffer_store_dwordx4 v[88:91], v0, s[20:23], s47 offen sc1
    s_add_u32 s44, s96, 0x4800000
    v_lshlrev_b32 v96, 1, v1
    buffer_load_dwordx4 v[96:99], v96, s[8:11], s44 offen nt
    s_add_u32 s45, s96, 0x4800000
    v_lshlrev_b32 v104, 1, v1
    buffer_load_dwordx4 v[104:107], v104, s[12:15], s45 offen nt
    v_and_b32 v7, -4, v112
    v_lshl_add_u32 v8, v112, 2, v7
    ds_write_b32 v8, v100
    v_lshl_add_u32 v7, v7, 2, v112
    ds_write_b8 v7, v110 offset:16
    v_and_b32 v9, -4, v113
    v_lshl_add_u32 v10, v113, 2, v9
    ds_write_b32 v10, v101
    v_lshl_add_u32 v9, v9, 2, v113
    ds_write_b8_d16_hi v9, v110 offset:16
    v_and_b32 v7, -4, v114
    v_lshl_add_u32 v8, v114, 2, v7
    ds_write_b32 v8, v102
    v_lshl_add_u32 v7, v7, 2, v114
    ds_write_b8 v7, v111 offset:16
    v_and_b32 v9, -4, v115
    v_lshl_add_u32 v10, v115, 2, v9
    ds_write_b32 v10, v103
    v_lshl_add_u32 v9, v9, 2, v115
    ds_write_b8_d16_hi v9, v111 offset:16
    s_add_u32 s46, s96, 0x4800000
    s_lshr_b32 s46, s46, 1
    buffer_load_dwordx2 v[88:89], v1, s[16:19], s46 offen nt
    s_add_u32 s47, s96, 0x4c00000
    s_lshr_b32 s47, s47, 1
    buffer_load_dwordx2 v[90:91], v1, s[16:19], s47 offen nt
    s_add_u32 s44, s96, 0x4c00000
    v_lshlrev_b32 v100, 1, v1
    buffer_load_dwordx4 v[100:103], v100, s[8:11], s44 offen nt
    s_waitcnt vmcnt(10)
    v_lshlrev_b32 v7, 16, v64
    v_and_b32 v8, 0xffff0000, v64
    v_lshlrev_b32 v9, 16, v65
    v_and_b32 v10, 0xffff0000, v65
    v_mul_f32 v7, 0.15915494, v7
    v_mul_f32 v8, 0.15915494, v8
    v_mul_f32 v9, 0.15915494, v9
    v_mul_f32 v10, 0.15915494, v10
    v_mul_hi_u32_u24 v14, 429497, v68
    v_lshrrev_b32 v12, 3, v72
    v_cos_f32 v7, v7
    v_lshlrev_b16 v13, 3, v72
    v_mad_i32_i24 v11, v14, s55, v68
    v_bitop3_b32 v12, v6, v13, v12 bitop3:0xca
    v_lshl_add_u32 v11, v11, 17, s40
    v_lshlrev_b16 v14, 8, v14
    v_lshrrev_b32 v13, 2, v72
    v_add_u32 v68, v12, v11
    v_bitop3_b32 v72, v5, v13, v14 bitop3:0xea
    v_mul_hi_u32_u24 v14, 429497, v69
    v_lshrrev_b32 v12, 3, v73
    v_cos_f32 v8, v8
    v_lshlrev_b16 v13, 3, v73
    v_mad_i32_i24 v11, v14, s55, v69
    v_bitop3_b32 v12, v6, v13, v12 bitop3:0xca
    v_lshl_add_u32 v11, v11, 17, s40
    v_lshlrev_b16 v14, 8, v14
    v_lshrrev_b32 v13, 2, v73
    v_add_u32 v69, v12, v11
    v_bitop3_b32 v73, v5, v13, v14 bitop3:0xea
    v_cvt_pk_bf16_f32 v64, v7, v8
    v_perm_b32 v12, v64, v64, s41
    v_bitop3_b32 v68, v4, v12, v68 bitop3:0xca
    v_perm_b32 v13, v64, v64, s42
    v_bitop3_b32 v69, v4, v13, v69 bitop3:0xca
    v_mul_hi_u32_u24 v14, 429497, v70
    v_lshrrev_b32 v12, 3, v74
    v_cos_f32 v9, v9
    v_lshlrev_b16 v13, 3, v74
    v_mad_i32_i24 v11, v14, s55, v70
    v_bitop3_b32 v12, v6, v13, v12 bitop3:0xca
    v_lshl_add_u32 v11, v11, 17, s40
    v_lshlrev_b16 v14, 8, v14
    v_lshrrev_b32 v13, 2, v74
    v_add_u32 v70, v12, v11
    v_bitop3_b32 v74, v5, v13, v14 bitop3:0xea
    v_mul_hi_u32_u24 v14, 429497, v71
    v_lshrrev_b32 v12, 3, v75
    v_cos_f32 v10, v10
    v_lshlrev_b16 v13, 3, v75
    v_mad_i32_i24 v11, v14, s55, v71
    v_bitop3_b32 v12, v6, v13, v12 bitop3:0xca
    v_lshl_add_u32 v11, v11, 17, s40
    v_lshlrev_b16 v14, 8, v14
    v_lshrrev_b32 v13, 2, v75
    v_add_u32 v71, v12, v11
    v_bitop3_b32 v75, v5, v13, v14 bitop3:0xea
    v_cvt_pk_bf16_f32 v65, v9, v10
    v_perm_b32 v12, v65, v65, s41
    v_bitop3_b32 v70, v4, v12, v70 bitop3:0xca
    v_perm_b32 v13, v65, v65, s42
    v_bitop3_b32 v71, v4, v13, v71 bitop3:0xca
    s_setprio 2
    v_and_b32 v7, -4, v120
    v_lshl_add_u32 v8, v120, 2, v7
    ds_write_b32 v8, v116
    v_lshl_add_u32 v7, v7, 2, v120
    ds_write_b8 v7, v124 offset:16
    v_and_b32 v9, -4, v121
    v_lshl_add_u32 v10, v121, 2, v9
    ds_write_b32 v10, v117
    v_lshl_add_u32 v9, v9, 2, v121
    ds_write_b8_d16_hi v9, v124 offset:16
    v_and_b32 v7, -4, v122
    v_lshl_add_u32 v8, v122, 2, v7
    ds_write_b32 v8, v118
    v_lshl_add_u32 v7, v7, 2, v122
    ds_write_b8 v7, v125 offset:16
    v_and_b32 v9, -4, v123
    v_lshl_add_u32 v10, v123, 2, v9
    ds_write_b32 v10, v119
    v_lshl_add_u32 v9, v9, 2, v123
    ds_write_b8_d16_hi v9, v125 offset:16
    s_add_u32 s45, s35, 0x8000
    s_add_u32 s45, s45, s91
    buffer_store_dwordx4 v[92:95], v0, s[20:23], s45 offen sc1
    s_add_u32 s46, s96, 0x4c00000
    v_lshlrev_b32 v112, 1, v1
    buffer_load_dwordx4 v[112:115], v112, s[12:15], s46 offen nt
    s_waitcnt vmcnt(8)
    v_lshlrev_b32 v7, 16, v66
    v_and_b32 v8, 0xffff0000, v66
    v_lshlrev_b32 v9, 16, v67
    v_and_b32 v10, 0xffff0000, v67
    v_mul_f32 v7, 0.15915494, v7
    v_mul_f32 v8, 0.15915494, v8
    v_mul_f32 v9, 0.15915494, v9
    v_mul_f32 v10, 0.15915494, v10
    v_mul_hi_u32_u24 v14, 429497, v76
    v_lshrrev_b32 v12, 3, v80
    v_cos_f32 v7, v7
    v_lshlrev_b16 v13, 3, v80
    v_mad_i32_i24 v11, v14, s55, v76
    v_bitop3_b32 v12, v6, v13, v12 bitop3:0xca
    v_lshl_add_u32 v11, v11, 17, s40
    v_lshlrev_b16 v14, 8, v14
    v_lshrrev_b32 v13, 2, v80
    v_add_u32 v76, v12, v11
    v_bitop3_b32 v80, v5, v13, v14 bitop3:0xea
    v_mul_hi_u32_u24 v14, 429497, v77
    v_lshrrev_b32 v12, 3, v81
    v_cos_f32 v8, v8
    v_lshlrev_b16 v13, 3, v81
    v_mad_i32_i24 v11, v14, s55, v77
    v_bitop3_b32 v12, v6, v13, v12 bitop3:0xca
    v_lshl_add_u32 v11, v11, 17, s40
    v_lshlrev_b16 v14, 8, v14
    v_lshrrev_b32 v13, 2, v81
    v_add_u32 v77, v12, v11
    v_bitop3_b32 v81, v5, v13, v14 bitop3:0xea
    v_cvt_pk_bf16_f32 v66, v7, v8
    v_perm_b32 v12, v66, v66, s41
    v_bitop3_b32 v76, v4, v12, v76 bitop3:0xca
    v_perm_b32 v13, v66, v66, s42
    v_bitop3_b32 v77, v4, v13, v77 bitop3:0xca
    v_mul_hi_u32_u24 v14, 429497, v78
    v_lshrrev_b32 v12, 3, v82
    v_cos_f32 v9, v9
    v_lshlrev_b16 v13, 3, v82
    v_mad_i32_i24 v11, v14, s55, v78
    v_bitop3_b32 v12, v6, v13, v12 bitop3:0xca
    v_lshl_add_u32 v11, v11, 17, s40
    v_lshlrev_b16 v14, 8, v14
    v_lshrrev_b32 v13, 2, v82
    v_add_u32 v78, v12, v11
    v_bitop3_b32 v82, v5, v13, v14 bitop3:0xea
    v_mul_hi_u32_u24 v14, 429497, v79
    v_lshrrev_b32 v12, 3, v83
    v_cos_f32 v10, v10
    v_lshlrev_b16 v13, 3, v83
    v_mad_i32_i24 v11, v14, s55, v79
    v_bitop3_b32 v12, v6, v13, v12 bitop3:0xca
    v_lshl_add_u32 v11, v11, 17, s40
    v_lshlrev_b16 v14, 8, v14
    v_lshrrev_b32 v13, 2, v83
    v_add_u32 v79, v12, v11
    v_bitop3_b32 v83, v5, v13, v14 bitop3:0xea
    v_cvt_pk_bf16_f32 v67, v9, v10
    v_perm_b32 v12, v67, v67, s41
    v_bitop3_b32 v78, v4, v12, v78 bitop3:0xca
    v_perm_b32 v13, v67, v67, s42
    v_bitop3_b32 v79, v4, v13, v79 bitop3:0xca
    v_and_b32 v7, -4, v20
    v_lshl_add_u32 v8, v20, 2, v7
    ds_write_b32 v8, v16
    v_lshl_add_u32 v7, v7, 2, v20
    ds_write_b8 v7, v126 offset:16
    v_and_b32 v9, -4, v21
    v_lshl_add_u32 v10, v21, 2, v9
    ds_write_b32 v10, v17
    v_lshl_add_u32 v9, v9, 2, v21
    ds_write_b8_d16_hi v9, v126 offset:16
    v_and_b32 v7, -4, v22
    v_lshl_add_u32 v8, v22, 2, v7
    ds_write_b32 v8, v18
    v_lshl_add_u32 v7, v7, 2, v22
    ds_write_b8 v7, v127 offset:16
    v_and_b32 v9, -4, v23
    v_lshl_add_u32 v10, v23, 2, v9
    ds_write_b32 v10, v19
    v_lshl_add_u32 v9, v9, 2, v23
    ds_write_b8_d16_hi v9, v127 offset:16
    s_add_u32 s47, s96, 0x5000000
    v_lshlrev_b32 v108, 1, v1
    buffer_load_dwordx4 v[108:111], v108, s[8:11], s47 offen nt
    s_add_u32 s44, s96, 0x5000000
    v_lshlrev_b32 v116, 1, v1
    buffer_load_dwordx4 v[116:119], v116, s[12:15], s44 offen nt
    s_waitcnt vmcnt(5)
    v_lshlrev_b32 v7, 16, v88
    v_and_b32 v8, 0xffff0000, v88
    v_lshlrev_b32 v9, 16, v89
    v_and_b32 v10, 0xffff0000, v89
    v_mul_f32 v7, 0.15915494, v7
    v_mul_f32 v8, 0.15915494, v8
    v_mul_f32 v9, 0.15915494, v9
    v_mul_f32 v10, 0.15915494, v10
    v_mul_hi_u32_u24 v14, 429497, v96
    v_lshrrev_b32 v12, 3, v104
    v_cos_f32 v7, v7
    v_lshlrev_b16 v13, 3, v104
    v_mad_i32_i24 v11, v14, s55, v96
    v_bitop3_b32 v12, v6, v13, v12 bitop3:0xca
    v_lshl_add_u32 v11, v11, 17, s40
    v_lshlrev_b16 v14, 8, v14
    v_lshrrev_b32 v13, 2, v104
    v_add_u32 v96, v12, v11
    v_bitop3_b32 v104, v5, v13, v14 bitop3:0xea
    v_mul_hi_u32_u24 v14, 429497, v97
    v_lshrrev_b32 v12, 3, v105
    v_cos_f32 v8, v8
    v_lshlrev_b16 v13, 3, v105
    v_mad_i32_i24 v11, v14, s55, v97
    v_bitop3_b32 v12, v6, v13, v12 bitop3:0xca
    v_lshl_add_u32 v11, v11, 17, s40
    v_lshlrev_b16 v14, 8, v14
    v_lshrrev_b32 v13, 2, v105
    v_add_u32 v97, v12, v11
    v_bitop3_b32 v105, v5, v13, v14 bitop3:0xea
    v_cvt_pk_bf16_f32 v88, v7, v8
    v_perm_b32 v12, v88, v88, s41
    v_bitop3_b32 v96, v4, v12, v96 bitop3:0xca
    v_perm_b32 v13, v88, v88, s42
    v_bitop3_b32 v97, v4, v13, v97 bitop3:0xca
    v_mul_hi_u32_u24 v14, 429497, v98
    v_lshrrev_b32 v12, 3, v106
    v_cos_f32 v9, v9
    v_lshlrev_b16 v13, 3, v106
    v_mad_i32_i24 v11, v14, s55, v98
    v_bitop3_b32 v12, v6, v13, v12 bitop3:0xca
    v_lshl_add_u32 v11, v11, 17, s40
    v_lshlrev_b16 v14, 8, v14
    v_lshrrev_b32 v13, 2, v106
    v_add_u32 v98, v12, v11
    v_bitop3_b32 v106, v5, v13, v14 bitop3:0xea
    v_mul_hi_u32_u24 v14, 429497, v99
    v_lshrrev_b32 v12, 3, v107
    v_cos_f32 v10, v10
    v_lshlrev_b16 v13, 3, v107
    v_mad_i32_i24 v11, v14, s55, v99
    v_bitop3_b32 v12, v6, v13, v12 bitop3:0xca
    v_lshl_add_u32 v11, v11, 17, s40
    v_lshlrev_b16 v14, 8, v14
    v_lshrrev_b32 v13, 2, v107
    v_add_u32 v99, v12, v11
    v_bitop3_b32 v107, v5, v13, v14 bitop3:0xea
    v_cvt_pk_bf16_f32 v89, v9, v10
    v_perm_b32 v12, v89, v89, s41
    v_bitop3_b32 v98, v4, v12, v98 bitop3:0xca
    v_perm_b32 v13, v89, v89, s42
    v_bitop3_b32 v99, v4, v13, v99 bitop3:0xca
    s_setprio 1
    v_and_b32 v7, -4, v32
    v_lshl_add_u32 v8, v32, 2, v7
    ds_write_b32 v8, v28
    v_lshl_add_u32 v7, v7, 2, v32
    ds_write_b8 v7, v24 offset:16
    v_and_b32 v9, -4, v33
    v_lshl_add_u32 v10, v33, 2, v9
    ds_write_b32 v10, v29
    v_lshl_add_u32 v9, v9, 2, v33
    ds_write_b8_d16_hi v9, v24 offset:16
    v_and_b32 v7, -4, v34
    v_lshl_add_u32 v8, v34, 2, v7
    ds_write_b32 v8, v30
    v_lshl_add_u32 v7, v7, 2, v34
    ds_write_b8 v7, v25 offset:16
    v_and_b32 v9, -4, v35
    v_lshl_add_u32 v10, v35, 2, v9
    ds_write_b32 v10, v31
    v_lshl_add_u32 v9, v9, 2, v35
    ds_write_b8_d16_hi v9, v25 offset:16
    s_add_u32 s45, s96, 0x5000000
    s_lshr_b32 s45, s45, 1
    buffer_load_dwordx2 v[120:121], v1, s[16:19], s45 offen nt
    s_add_u32 s46, s96, 0x5400000
    s_lshr_b32 s46, s46, 1
    buffer_load_dwordx2 v[122:123], v1, s[16:19], s46 offen nt
    s_add_u32 s47, s96, 0x5400000
    v_lshlrev_b32 v92, 1, v1
    buffer_load_dwordx4 v[92:95], v92, s[8:11], s47 offen nt
    v_and_b32 v7, -4, v40
    v_lshl_add_u32 v8, v40, 2, v7
    ds_write_b32 v8, v36
    v_lshl_add_u32 v7, v7, 2, v40
    ds_write_b8 v7, v26 offset:16
    v_and_b32 v9, -4, v41
    v_lshl_add_u32 v10, v41, 2, v9
    ds_write_b32 v10, v37
    v_lshl_add_u32 v9, v9, 2, v41
    ds_write_b8_d16_hi v9, v26 offset:16
    v_and_b32 v7, -4, v42
    v_lshl_add_u32 v8, v42, 2, v7
    ds_write_b32 v8, v38
    v_lshl_add_u32 v7, v7, 2, v42
    ds_write_b8 v7, v27 offset:16
    v_and_b32 v9, -4, v43
    v_lshl_add_u32 v10, v43, 2, v9
    ds_write_b32 v10, v39
    v_lshl_add_u32 v9, v9, 2, v43
    ds_write_b8_d16_hi v9, v27 offset:16
    s_add_u32 s44, s35, 0x8000
    s_add_u32 s44, s44, s93
    buffer_store_dwordx4 v[84:87], v0, s[20:23], s44 offen sc1
    s_add_u32 s45, s96, 0x5400000
    v_lshlrev_b32 v16, 1, v1
    buffer_load_dwordx4 v[16:19], v16, s[12:15], s45 offen nt
    s_waitcnt vmcnt(7)
    v_lshlrev_b32 v7, 16, v90
    v_and_b32 v8, 0xffff0000, v90
    v_lshlrev_b32 v9, 16, v91
    v_and_b32 v10, 0xffff0000, v91
    v_mul_f32 v7, 0.15915494, v7
    v_mul_f32 v8, 0.15915494, v8
    v_mul_f32 v9, 0.15915494, v9
    v_mul_f32 v10, 0.15915494, v10
    v_mul_hi_u32_u24 v14, 429497, v100
    v_lshrrev_b32 v12, 3, v112
    v_cos_f32 v7, v7
    v_lshlrev_b16 v13, 3, v112
    v_mad_i32_i24 v11, v14, s55, v100
    v_bitop3_b32 v12, v6, v13, v12 bitop3:0xca
    v_lshl_add_u32 v11, v11, 17, s40
    v_lshlrev_b16 v14, 8, v14
    v_lshrrev_b32 v13, 2, v112
    v_add_u32 v100, v12, v11
    v_bitop3_b32 v112, v5, v13, v14 bitop3:0xea
    v_mul_hi_u32_u24 v14, 429497, v101
    v_lshrrev_b32 v12, 3, v113
    v_cos_f32 v8, v8
    v_lshlrev_b16 v13, 3, v113
    v_mad_i32_i24 v11, v14, s55, v101
    v_bitop3_b32 v12, v6, v13, v12 bitop3:0xca
    v_lshl_add_u32 v11, v11, 17, s40
    v_lshlrev_b16 v14, 8, v14
    v_lshrrev_b32 v13, 2, v113
    v_add_u32 v101, v12, v11
    v_bitop3_b32 v113, v5, v13, v14 bitop3:0xea
    v_cvt_pk_bf16_f32 v90, v7, v8
    v_perm_b32 v12, v90, v90, s41
    v_bitop3_b32 v100, v4, v12, v100 bitop3:0xca
    v_perm_b32 v13, v90, v90, s42
    v_bitop3_b32 v101, v4, v13, v101 bitop3:0xca
    v_mul_hi_u32_u24 v14, 429497, v102
    v_lshrrev_b32 v12, 3, v114
    v_cos_f32 v9, v9
    v_lshlrev_b16 v13, 3, v114
    v_mad_i32_i24 v11, v14, s55, v102
    v_bitop3_b32 v12, v6, v13, v12 bitop3:0xca
    v_lshl_add_u32 v11, v11, 17, s40
    v_lshlrev_b16 v14, 8, v14
    v_lshrrev_b32 v13, 2, v114
    v_add_u32 v102, v12, v11
    v_bitop3_b32 v114, v5, v13, v14 bitop3:0xea
    v_mul_hi_u32_u24 v14, 429497, v103
    v_lshrrev_b32 v12, 3, v115
    v_cos_f32 v10, v10
    v_lshlrev_b16 v13, 3, v115
    v_mad_i32_i24 v11, v14, s55, v103
    v_bitop3_b32 v12, v6, v13, v12 bitop3:0xca
    v_lshl_add_u32 v11, v11, 17, s40
    v_lshlrev_b16 v14, 8, v14
    v_lshrrev_b32 v13, 2, v115
    v_add_u32 v103, v12, v11
    v_bitop3_b32 v115, v5, v13, v14 bitop3:0xea
    v_cvt_pk_bf16_f32 v91, v9, v10
    v_perm_b32 v12, v91, v91, s41
    v_bitop3_b32 v102, v4, v12, v102 bitop3:0xca
    v_perm_b32 v13, v91, v91, s42
    v_bitop3_b32 v103, v4, v13, v103 bitop3:0xca
    s_setprio 0
    v_and_b32 v7, -4, v52
    v_lshl_add_u32 v8, v52, 2, v7
    ds_write_b32 v8, v48
    v_lshl_add_u32 v7, v7, 2, v52
    ds_write_b8 v7, v44 offset:16
    v_and_b32 v9, -4, v53
    v_lshl_add_u32 v10, v53, 2, v9
    ds_write_b32 v10, v49
    v_lshl_add_u32 v9, v9, 2, v53
    ds_write_b8_d16_hi v9, v44 offset:16
    v_and_b32 v7, -4, v54
    v_lshl_add_u32 v8, v54, 2, v7
    ds_write_b32 v8, v50
    v_lshl_add_u32 v7, v7, 2, v54
    ds_write_b8 v7, v45 offset:16
    v_and_b32 v9, -4, v55
    v_lshl_add_u32 v10, v55, 2, v9
    ds_write_b32 v10, v51
    v_lshl_add_u32 v9, v9, 2, v55
    ds_write_b8_d16_hi v9, v45 offset:16
    s_add_u32 s46, s96, 0x5800000
    v_lshlrev_b32 v20, 1, v1
    buffer_load_dwordx4 v[20:23], v20, s[8:11], s46 offen nt
    s_add_u32 s47, s96, 0x5800000
    v_lshlrev_b32 v124, 1, v1
    buffer_load_dwordx4 v[124:127], v124, s[12:15], s47 offen nt
    s_waitcnt vmcnt(5)
    v_lshlrev_b32 v7, 16, v120
    v_and_b32 v8, 0xffff0000, v120
    v_lshlrev_b32 v9, 16, v121
    v_and_b32 v10, 0xffff0000, v121
    v_mul_f32 v7, 0.15915494, v7
    v_mul_f32 v8, 0.15915494, v8
    v_mul_f32 v9, 0.15915494, v9
    v_mul_f32 v10, 0.15915494, v10
    v_mul_hi_u32_u24 v14, 429497, v108
    v_lshrrev_b32 v12, 3, v116
    v_cos_f32 v7, v7
    v_lshlrev_b16 v13, 3, v116
    v_mad_i32_i24 v11, v14, s55, v108
    v_bitop3_b32 v12, v6, v13, v12 bitop3:0xca
    v_lshl_add_u32 v11, v11, 17, s40
    v_lshlrev_b16 v14, 8, v14
    v_lshrrev_b32 v13, 2, v116
    v_add_u32 v108, v12, v11
    v_bitop3_b32 v116, v5, v13, v14 bitop3:0xea
    v_mul_hi_u32_u24 v14, 429497, v109
    v_lshrrev_b32 v12, 3, v117
    v_cos_f32 v8, v8
    v_lshlrev_b16 v13, 3, v117
    v_mad_i32_i24 v11, v14, s55, v109
    v_bitop3_b32 v12, v6, v13, v12 bitop3:0xca
    v_lshl_add_u32 v11, v11, 17, s40
    v_lshlrev_b16 v14, 8, v14
    v_lshrrev_b32 v13, 2, v117
    v_add_u32 v109, v12, v11
    v_bitop3_b32 v117, v5, v13, v14 bitop3:0xea
    v_cvt_pk_bf16_f32 v120, v7, v8
    v_perm_b32 v12, v120, v120, s41
    v_bitop3_b32 v108, v4, v12, v108 bitop3:0xca
    v_perm_b32 v13, v120, v120, s42
    v_bitop3_b32 v109, v4, v13, v109 bitop3:0xca
    v_mul_hi_u32_u24 v14, 429497, v110
    v_lshrrev_b32 v12, 3, v118
    v_cos_f32 v9, v9
    v_lshlrev_b16 v13, 3, v118
    v_mad_i32_i24 v11, v14, s55, v110
    v_bitop3_b32 v12, v6, v13, v12 bitop3:0xca
    v_lshl_add_u32 v11, v11, 17, s40
    v_lshlrev_b16 v14, 8, v14
    v_lshrrev_b32 v13, 2, v118
    v_add_u32 v110, v12, v11
    v_bitop3_b32 v118, v5, v13, v14 bitop3:0xea
    v_mul_hi_u32_u24 v14, 429497, v111
    v_lshrrev_b32 v12, 3, v119
    v_cos_f32 v10, v10
    v_lshlrev_b16 v13, 3, v119
    v_mad_i32_i24 v11, v14, s55, v111
    v_bitop3_b32 v12, v6, v13, v12 bitop3:0xca
    v_lshl_add_u32 v11, v11, 17, s40
    v_lshlrev_b16 v14, 8, v14
    v_lshrrev_b32 v13, 2, v119
    v_add_u32 v111, v12, v11
    v_bitop3_b32 v119, v5, v13, v14 bitop3:0xea
    v_cvt_pk_bf16_f32 v121, v9, v10
    v_perm_b32 v12, v121, v121, s41
    v_bitop3_b32 v110, v4, v12, v110 bitop3:0xca
    v_perm_b32 v13, v121, v121, s42
    v_bitop3_b32 v111, v4, v13, v111 bitop3:0xca
    v_and_b32 v7, -4, v60
    v_lshl_add_u32 v8, v60, 2, v7
    ds_write_b32 v8, v56
    v_lshl_add_u32 v7, v7, 2, v60
    ds_write_b8 v7, v46 offset:16
    v_and_b32 v9, -4, v61
    v_lshl_add_u32 v10, v61, 2, v9
    ds_write_b32 v10, v57
    v_lshl_add_u32 v9, v9, 2, v61
    ds_write_b8_d16_hi v9, v46 offset:16
    v_and_b32 v7, -4, v62
    v_lshl_add_u32 v8, v62, 2, v7
    ds_write_b32 v8, v58
    v_lshl_add_u32 v7, v7, 2, v62
    ds_write_b8 v7, v47 offset:16
    v_and_b32 v9, -4, v63
    v_lshl_add_u32 v10, v63, 2, v9
    ds_write_b32 v10, v59
    v_lshl_add_u32 v9, v9, 2, v63
    ds_write_b8_d16_hi v9, v47 offset:16
    s_add_u32 s44, s96, 0x5800000
    s_lshr_b32 s44, s44, 1
    buffer_load_dwordx2 v[28:29], v1, s[16:19], s44 offen nt
    s_add_u32 s45, s96, 0x5c00000
    s_lshr_b32 s45, s45, 1
    buffer_load_dwordx2 v[30:31], v1, s[16:19], s45 offen nt
    s_waitcnt vmcnt(4)
    v_lshlrev_b32 v7, 16, v122
    v_and_b32 v8, 0xffff0000, v122
    v_lshlrev_b32 v9, 16, v123
    v_and_b32 v10, 0xffff0000, v123
    v_mul_f32 v7, 0.15915494, v7
    v_mul_f32 v8, 0.15915494, v8
    v_mul_f32 v9, 0.15915494, v9
    v_mul_f32 v10, 0.15915494, v10
    v_mul_hi_u32_u24 v14, 429497, v92
    v_lshrrev_b32 v12, 3, v16
    v_cos_f32 v7, v7
    v_lshlrev_b16 v13, 3, v16
    v_mad_i32_i24 v11, v14, s55, v92
    v_bitop3_b32 v12, v6, v13, v12 bitop3:0xca
    v_lshl_add_u32 v11, v11, 17, s40
    v_lshlrev_b16 v14, 8, v14
    v_lshrrev_b32 v13, 2, v16
    v_add_u32 v92, v12, v11
    v_bitop3_b32 v16, v5, v13, v14 bitop3:0xea
    v_mul_hi_u32_u24 v14, 429497, v93
    v_lshrrev_b32 v12, 3, v17
    v_cos_f32 v8, v8
    v_lshlrev_b16 v13, 3, v17
    v_mad_i32_i24 v11, v14, s55, v93
    v_bitop3_b32 v12, v6, v13, v12 bitop3:0xca
    v_lshl_add_u32 v11, v11, 17, s40
    v_lshlrev_b16 v14, 8, v14
    v_lshrrev_b32 v13, 2, v17
    v_add_u32 v93, v12, v11
    v_bitop3_b32 v17, v5, v13, v14 bitop3:0xea
    v_cvt_pk_bf16_f32 v122, v7, v8
    v_perm_b32 v12, v122, v122, s41
    v_bitop3_b32 v92, v4, v12, v92 bitop3:0xca
    v_perm_b32 v13, v122, v122, s42
    v_bitop3_b32 v93, v4, v13, v93 bitop3:0xca
    v_mul_hi_u32_u24 v14, 429497, v94
    v_lshrrev_b32 v12, 3, v18
    v_cos_f32 v9, v9
    v_lshlrev_b16 v13, 3, v18
    v_mad_i32_i24 v11, v14, s55, v94
    v_bitop3_b32 v12, v6, v13, v12 bitop3:0xca
    v_lshl_add_u32 v11, v11, 17, s40
    v_lshlrev_b16 v14, 8, v14
    v_lshrrev_b32 v13, 2, v18
    v_add_u32 v94, v12, v11
    v_bitop3_b32 v18, v5, v13, v14 bitop3:0xea
    v_mul_hi_u32_u24 v14, 429497, v95
    v_lshrrev_b32 v12, 3, v19
    v_cos_f32 v10, v10
    v_lshlrev_b16 v13, 3, v19
    v_mad_i32_i24 v11, v14, s55, v95
    v_bitop3_b32 v12, v6, v13, v12 bitop3:0xca
    v_lshl_add_u32 v11, v11, 17, s40
    v_lshlrev_b16 v14, 8, v14
    v_lshrrev_b32 v13, 2, v19
    v_add_u32 v95, v12, v11
    v_bitop3_b32 v19, v5, v13, v14 bitop3:0xea
    v_cvt_pk_bf16_f32 v123, v9, v10
    v_perm_b32 v12, v123, v123, s41
    v_bitop3_b32 v94, v4, v12, v94 bitop3:0xca
    v_perm_b32 v13, v123, v123, s42
    v_bitop3_b32 v95, v4, v13, v95 bitop3:0xca
    v_add_u32 v7, s72, v0
    v_add_u32 v12, s73, v0
    v_add_u32 v13, s85, v0
    v_add_u32 v14, s91, v0
    v_add_u32 v15, s93, v0
    s_min_i32 s3, s72, s73
    s_min_i32 s3, s3, s85
    s_min_i32 s3, s3, s91
    s_min_i32 s3, s3, s93
    v_add_u32 v3, s3, v0
    v_mov_b32 v8, 0
    v_mov_b32 v9, 0
    v_mov_b32 v10, 0
    v_mov_b32 v11, 0
    s_waitcnt lgkmcnt(0)
    s_barrier
    ds_read_b128 v[32:35], v7 offset:0
    ds_read_b128 v[36:39], v12 offset:0
    ds_read_b128 v[40:43], v13 offset:0
    ds_read_b128 v[24:27], v14 offset:0
    ds_read_b128 v[84:87], v15 offset:0
    ds_write_b128 v3, v[8:11]
    ds_read_b128 v[48:51], v7 offset:16384
    ds_read_b128 v[52:55], v12 offset:16384
    ds_read_b128 v[56:59], v13 offset:16384
    ds_read_b128 v[60:63], v14 offset:16384
    ds_read_b128 v[44:47], v15 offset:16384
    s_waitcnt lgkmcnt(0)
    s_barrier
    s_setprio 3
    s_add_u32 s46, s35, 0x2a44000
    s_add_u32 s46, s46, s72
    buffer_store_dwordx4 v[32:35], v0, s[20:23], s46 offen sc1
    s_add_u32 s47, s96, 0x5c00000
    s_nop 0
    v_lshlrev_b32 v32, 1, v1
    buffer_load_dwordx4 v[32:35], v32, s[8:11], s47 offen nt
    s_add_u32 s44, s35, 0x2a44000
    s_add_u32 s44, s44, s73
    buffer_store_dwordx4 v[36:39], v0, s[20:23], s44 offen sc1
    s_add_u32 s45, s96, 0x5c00000
    s_nop 0
    v_lshlrev_b32 v36, 1, v1
    buffer_load_dwordx4 v[36:39], v36, s[12:15], s45 offen nt
    ds_add_u32 v72, v2
    ds_add_u32 v73, v2
    ds_add_u32 v74, v2
    ds_add_u32 v75, v2
    ds_add_u32 v80, v2
    ds_add_u32 v81, v2
    ds_add_u32 v82, v2
    ds_add_u32 v83, v2
    s_setprio 2
    ds_add_u32 v104, v2
    ds_add_u32 v105, v2
    ds_add_u32 v106, v2
    ds_add_u32 v107, v2
    ds_add_u32 v112, v2
    ds_add_u32 v113, v2
    ds_add_u32 v114, v2
    ds_add_u32 v115, v2
    s_setprio 1
    s_add_u32 s46, s35, 0x2a44000
    s_add_u32 s46, s46, s85
    buffer_store_dwordx4 v[40:43], v0, s[20:23], s46 offen sc1
    s_add_u32 s47, s96, 0x6000000
    s_nop 0
    v_lshlrev_b32 v40, 1, v1
    buffer_load_dwordx4 v[40:43], v40, s[8:11], s47 offen nt
    ds_add_u32 v116, v2
    ds_add_u32 v117, v2
    ds_add_u32 v118, v2
    ds_add_u32 v119, v2
    ds_add_u32 v16, v2
    ds_add_u32 v17, v2
    ds_add_u32 v18, v2
    ds_add_u32 v19, v2
    s_setprio 0
    s_waitcnt vmcnt(6)
    v_lshlrev_b32 v7, 16, v28
    v_and_b32 v8, 0xffff0000, v28
    v_lshlrev_b32 v9, 16, v29
    v_and_b32 v10, 0xffff0000, v29
    v_mul_f32 v7, 0.15915494, v7
    v_mul_f32 v8, 0.15915494, v8
    v_mul_f32 v9, 0.15915494, v9
    v_mul_f32 v10, 0.15915494, v10
    v_mul_hi_u32_u24 v14, 429497, v20
    v_lshrrev_b32 v12, 3, v124
    v_cos_f32 v7, v7
    v_lshlrev_b16 v13, 3, v124
    v_mad_i32_i24 v11, v14, s55, v20
    v_bitop3_b32 v12, v6, v13, v12 bitop3:0xca
    v_lshl_add_u32 v11, v11, 17, s40
    v_lshlrev_b16 v14, 8, v14
    v_lshrrev_b32 v13, 2, v124
    v_add_u32 v20, v12, v11
    v_bitop3_b32 v124, v5, v13, v14 bitop3:0xea
    ds_add_u32 v124, v2
    v_mul_hi_u32_u24 v14, 429497, v21
    v_lshrrev_b32 v12, 3, v125
    v_cos_f32 v8, v8
    v_lshlrev_b16 v13, 3, v125
    v_mad_i32_i24 v11, v14, s55, v21
    v_bitop3_b32 v12, v6, v13, v12 bitop3:0xca
    v_lshl_add_u32 v11, v11, 17, s40
    v_lshlrev_b16 v14, 8, v14
    v_lshrrev_b32 v13, 2, v125
    v_add_u32 v21, v12, v11
    v_bitop3_b32 v125, v5, v13, v14 bitop3:0xea
    ds_add_u32 v125, v2
    v_cvt_pk_bf16_f32 v28, v7, v8
    v_perm_b32 v12, v28, v28, s41
    v_bitop3_b32 v20, v4, v12, v20 bitop3:0xca
    v_perm_b32 v13, v28, v28, s42
    v_bitop3_b32 v21, v4, v13, v21 bitop3:0xca
    v_mul_hi_u32_u24 v14, 429497, v22
    v_lshrrev_b32 v12, 3, v126
    v_cos_f32 v9, v9
    v_lshlrev_b16 v13, 3, v126
    v_mad_i32_i24 v11, v14, s55, v22
    v_bitop3_b32 v12, v6, v13, v12 bitop3:0xca
    v_lshl_add_u32 v11, v11, 17, s40
    v_lshlrev_b16 v14, 8, v14
    v_lshrrev_b32 v13, 2, v126
    v_add_u32 v22, v12, v11
    v_bitop3_b32 v126, v5, v13, v14 bitop3:0xea
    ds_add_u32 v126, v2
    v_mul_hi_u32_u24 v14, 429497, v23
    v_lshrrev_b32 v12, 3, v127
    v_cos_f32 v10, v10
    v_lshlrev_b16 v13, 3, v127
    v_mad_i32_i24 v11, v14, s55, v23
    v_bitop3_b32 v12, v6, v13, v12 bitop3:0xca
    v_lshl_add_u32 v11, v11, 17, s40
    v_lshlrev_b16 v14, 8, v14
    v_lshrrev_b32 v13, 2, v127
    v_add_u32 v23, v12, v11
    v_bitop3_b32 v127, v5, v13, v14 bitop3:0xea
    ds_add_u32 v127, v2
    v_cvt_pk_bf16_f32 v29, v9, v10
    v_perm_b32 v12, v29, v29, s41
    v_bitop3_b32 v22, v4, v12, v22 bitop3:0xca
    v_perm_b32 v13, v29, v29, s42
    v_bitop3_b32 v23, v4, v13, v23 bitop3:0xca
    s_waitcnt vmcnt(2)
    v_lshlrev_b32 v7, 16, v30
    v_and_b32 v8, 0xffff0000, v30
    v_lshlrev_b32 v9, 16, v31
    v_and_b32 v10, 0xffff0000, v31
    v_mul_f32 v7, 0.15915494, v7
    v_mul_f32 v8, 0.15915494, v8
    v_mul_f32 v9, 0.15915494, v9
    v_mul_f32 v10, 0.15915494, v10
    v_mul_hi_u32_u24 v14, 429497, v32
    v_lshrrev_b32 v12, 3, v36
    v_cos_f32 v7, v7
    v_lshlrev_b16 v13, 3, v36
    v_mad_i32_i24 v11, v14, s55, v32
    v_bitop3_b32 v12, v6, v13, v12 bitop3:0xca
    v_lshl_add_u32 v11, v11, 17, s40
    v_lshlrev_b16 v14, 8, v14
    v_lshrrev_b32 v13, 2, v36
    v_add_u32 v32, v12, v11
    v_bitop3_b32 v36, v5, v13, v14 bitop3:0xea
    ds_add_u32 v36, v2
    v_mul_hi_u32_u24 v14, 429497, v33
    v_lshrrev_b32 v12, 3, v37
    v_cos_f32 v8, v8
    v_lshlrev_b16 v13, 3, v37
    v_mad_i32_i24 v11, v14, s55, v33
    v_bitop3_b32 v12, v6, v13, v12 bitop3:0xca
    v_lshl_add_u32 v11, v11, 17, s40
    v_lshlrev_b16 v14, 8, v14
    v_lshrrev_b32 v13, 2, v37
    v_add_u32 v33, v12, v11
    v_bitop3_b32 v37, v5, v13, v14 bitop3:0xea
    ds_add_u32 v37, v2
    v_cvt_pk_bf16_f32 v30, v7, v8
    v_perm_b32 v12, v30, v30, s41
    v_bitop3_b32 v32, v4, v12, v32 bitop3:0xca
    v_perm_b32 v13, v30, v30, s42
    v_bitop3_b32 v33, v4, v13, v33 bitop3:0xca
    v_mul_hi_u32_u24 v14, 429497, v34
    v_lshrrev_b32 v12, 3, v38
    v_cos_f32 v9, v9
    v_lshlrev_b16 v13, 3, v38
    v_mad_i32_i24 v11, v14, s55, v34
    v_bitop3_b32 v12, v6, v13, v12 bitop3:0xca
    v_lshl_add_u32 v11, v11, 17, s40
    v_lshlrev_b16 v14, 8, v14
    v_lshrrev_b32 v13, 2, v38
    v_add_u32 v34, v12, v11
    v_bitop3_b32 v38, v5, v13, v14 bitop3:0xea
    ds_add_u32 v38, v2
    v_mul_hi_u32_u24 v14, 429497, v35
    v_lshrrev_b32 v12, 3, v39
    v_cos_f32 v10, v10
    v_lshlrev_b16 v13, 3, v39
    v_mad_i32_i24 v11, v14, s55, v35
    v_bitop3_b32 v12, v6, v13, v12 bitop3:0xca
    v_lshl_add_u32 v11, v11, 17, s40
    v_lshlrev_b16 v14, 8, v14
    v_lshrrev_b32 v13, 2, v39
    v_add_u32 v35, v12, v11
    v_bitop3_b32 v39, v5, v13, v14 bitop3:0xea
    ds_add_u32 v39, v2
    v_cvt_pk_bf16_f32 v31, v9, v10
    v_perm_b32 v12, v31, v31, s41
    v_bitop3_b32 v34, v4, v12, v34 bitop3:0xca
    v_perm_b32 v13, v31, v31, s42
    v_bitop3_b32 v35, v4, v13, v35 bitop3:0xca
    v_lshrrev_b32 v8, 2, v0
    v_and_b32 v7, 0x3c00, v0
    v_bitop3_b32 v7, v5, v8, v7 bitop3:0xea
    s_waitcnt lgkmcnt(0)
    s_barrier
    ds_read2st64_b32 v[8:9], v7 offset0:0 offset1:1
    ds_read2st64_b32 v[10:11], v7 offset0:2 offset1:3
    s_add_u32 s44, s35, 0x2a44000
    s_add_u32 s44, s44, s91
    buffer_store_dwordx4 v[24:27], v0, s[20:23], s44 offen sc1
    s_add_u32 s45, s96, 0x6000000
    s_nop 0
    v_lshlrev_b32 v24, 1, v1
    buffer_load_dwordx4 v[24:27], v24, s[12:15], s45 offen nt
    s_waitcnt lgkmcnt(0)
    v_lshl_or_b32 v12, v9, 16, v8
    v_lshl_or_b32 v13, v11, 16, v10
    v_mov_b32 v14, v12
    v_mov_b32 v15, v13
    s_nop 0
    v_add_u32_dpp v14, v14, v14 row_shr:1 row_mask:0xf bank_mask:0xf bound_ctrl:1
    v_add_u32_dpp v15, v15, v15 row_shr:1 row_mask:0xf bank_mask:0xf bound_ctrl:1
    s_nop 0
    v_add_u32_dpp v14, v14, v14 row_shr:2 row_mask:0xf bank_mask:0xf bound_ctrl:1
    v_add_u32_dpp v15, v15, v15 row_shr:2 row_mask:0xf bank_mask:0xf bound_ctrl:1
    s_nop 0
    v_add_u32_dpp v14, v14, v14 row_shr:4 row_mask:0xf bank_mask:0xf bound_ctrl:1
    v_add_u32_dpp v15, v15, v15 row_shr:4 row_mask:0xf bank_mask:0xf bound_ctrl:1
    s_nop 0
    v_add_u32_dpp v14, v14, v14 row_shr:8 row_mask:0xf bank_mask:0xf bound_ctrl:1
    v_add_u32_dpp v15, v15, v15 row_shr:8 row_mask:0xf bank_mask:0xf bound_ctrl:1
    s_nop 0
    v_add_u32_dpp v14, v14, v14 row_bcast:15 row_mask:0xa bank_mask:0xf
    v_add_u32_dpp v15, v15, v15 row_bcast:15 row_mask:0xa bank_mask:0xf
    s_nop 0
    v_add_u32_dpp v14, v14, v14 row_bcast:31 row_mask:0xc bank_mask:0xf
    v_add_u32_dpp v15, v15, v15 row_bcast:31 row_mask:0xc bank_mask:0xf
    v_readlane_b32 s48, v14, 63
    v_readlane_b32 s49, v15, 63
    s_lshl_b32 s54, s32, 2
    v_mov_b32 v8, s54
    s_and_b32 s50, s48, 0xffff
    s_lshr_b32 s51, s48, 16
    s_and_b32 s52, s49, 0xffff
    s_lshr_b32 s53, s49, 16
    s_add_u32 s51, s51, s50
    s_add_u32 s52, s52, s51
    s_add_u32 s53, s53, s52
    v_mov_b32 v9, s53
    s_mov_b64 exec, 1
    ds_write_b32 v8, v9 offset:16384
    s_mov_b64 exec, -1
    v_and_b32 v8, 60, v7
    s_waitcnt lgkmcnt(0)
    s_barrier
    ds_read_b32 v9, v8 offset:16384
    s_waitcnt lgkmcnt(0)
    v_add_u32_dpp v9, v9, v9 row_shr:1 row_mask:0xf bank_mask:0xf bound_ctrl:1
    s_nop 1
    v_add_u32_dpp v9, v9, v9 row_shr:2 row_mask:0xf bank_mask:0xf bound_ctrl:1
    s_nop 1
    v_add_u32_dpp v9, v9, v9 row_shr:4 row_mask:0xf bank_mask:0xf bound_ctrl:1
    s_nop 1
    v_add_u32_dpp v9, v9, v9 row_shr:8 row_mask:0xf bank_mask:0xf bound_ctrl:1
    s_nop 0
    v_readlane_b32 s54, v9, s32
    s_sub_u32 s54, s54, s53
    s_add_u32 s50, s50, s54
    s_add_u32 s51, s51, s54
    s_add_u32 s52, s52, s54
    s_pack_ll_b32_b16 s48, s54, s50
    s_pack_ll_b32_b16 s49, s51, s52
    v_add_u32 v14, s48, v14
    v_add_u32 v15, s49, v15
    v_sub_u32 v12, v14, v12
    v_sub_u32 v13, v15, v13
    v_and_b32 v8, 0xffff, v12
    v_lshrrev_b32 v9, 16, v12
    v_and_b32 v10, 0xffff, v13
    v_lshrrev_b32 v11, 16, v13
    ds_write2st64_b32 v7, v8, v9 offset0:0 offset1:1
    ds_write2st64_b32 v7, v10, v11 offset0:2 offset1:3
    v_and_b32 v8, 0x3f0, v0
    v_lshl_add_u32 v8, v8, 1, s36
    ds_write_b64 v8, v[12:13] offset:20480
    s_bitset0_b64 exec, 63
    s_not_b64 exec, exec
    ds_write_b64 v8, v[14:15] offset:20512
    s_mov_b64 exec, -1
    s_waitcnt lgkmcnt(0)
    s_barrier
    s_setprio 3
    ds_add_rtn_u32 v72, v72, v2
    ds_add_rtn_u32 v73, v73, v2
    ds_add_rtn_u32 v74, v74, v2
    ds_add_rtn_u32 v75, v75, v2
    ds_read_b128 v[12:15], v0 offset:20480
    v_cmp_gt_u32 vcc, 8448, v0
    s_add_u32 s46, s35, 0x2a44000
    s_add_u32 s46, s46, s93
    buffer_store_dwordx4 v[84:87], v0, s[20:23], s46 offen sc1
    s_add_u32 s47, s96, 0x6000000
    s_lshr_b32 s47, s47, 1
    buffer_load_dwordx2 v[84:85], v1, s[16:19], s47 offen nt
    s_add_u32 s44, s96, 0x6400000
    s_lshr_b32 s44, s44, 1
    buffer_load_dwordx2 v[86:87], v1, s[16:19], s44 offen nt
    ds_add_rtn_u32 v80, v80, v2
    ds_add_rtn_u32 v81, v81, v2
    ds_add_rtn_u32 v82, v82, v2
    ds_add_rtn_u32 v83, v83, v2
    s_setprio 2
    ds_add_rtn_u32 v104, v104, v2
    ds_add_rtn_u32 v105, v105, v2
    ds_add_rtn_u32 v106, v106, v2
    ds_add_rtn_u32 v107, v107, v2
    s_waitcnt lgkmcnt(8)
    s_cbranch_vccz L1_p3
    s_add_u32 s45, s35, 0x5480000
    s_mov_b64 exec, vcc
    buffer_store_dwordx4 v[12:15], v0, s[24:27], s45 offen sc1
    s_mov_b64 exec, -1
L1_p3:
    s_add_u32 s46, s35, 0x2a48000
    s_add_u32 s46, s46, s72
    buffer_store_dwordx4 v[48:51], v0, s[20:23], s46 offen sc1
    s_add_u32 s47, s96, 0x6400000
    s_nop 0
    v_lshlrev_b32 v48, 1, v1
    buffer_load_dwordx4 v[48:51], v48, s[8:11], s47 offen nt
    ds_add_rtn_u32 v112, v112, v2
    ds_add_rtn_u32 v113, v113, v2
    ds_add_rtn_u32 v114, v114, v2
    ds_add_rtn_u32 v115, v115, v2
    s_setprio 1
    ds_add_rtn_u32 v116, v116, v2
    ds_add_rtn_u32 v117, v117, v2
    ds_add_rtn_u32 v118, v118, v2
    ds_add_rtn_u32 v119, v119, v2
    ds_add_rtn_u32 v16, v16, v2
    ds_add_rtn_u32 v17, v17, v2
    ds_add_rtn_u32 v18, v18, v2
    ds_add_rtn_u32 v19, v19, v2
    s_add_u32 s44, s35, 0x2a48000
    s_add_u32 s44, s44, s73
    buffer_store_dwordx4 v[52:55], v0, s[20:23], s44 offen sc1
    s_add_u32 s45, s96, 0x6400000
    s_nop 0
    v_lshlrev_b32 v52, 1, v1
    buffer_load_dwordx4 v[52:55], v52, s[12:15], s45 offen nt
    s_setprio 0
    ds_add_rtn_u32 v124, v124, v2
    ds_add_rtn_u32 v125, v125, v2
    ds_add_rtn_u32 v126, v126, v2
    ds_add_rtn_u32 v127, v127, v2
    ds_add_rtn_u32 v36, v36, v2
    ds_add_rtn_u32 v37, v37, v2
    ds_add_rtn_u32 v38, v38, v2
    ds_add_rtn_u32 v39, v39, v2
    s_waitcnt lgkmcnt(0)
    s_barrier
    s_setprio 3
    v_and_b32 v7, -4, v72
    v_lshl_add_u32 v8, v72, 2, v7
    ds_write_b32 v8, v68
    v_lshl_add_u32 v7, v7, 2, v72
    ds_write_b8 v7, v64 offset:16
    v_and_b32 v9, -4, v73
    v_lshl_add_u32 v10, v73, 2, v9
    ds_write_b32 v10, v69
    v_lshl_add_u32 v9, v9, 2, v73
    ds_write_b8_d16_hi v9, v64 offset:16
    v_and_b32 v7, -4, v74
    v_lshl_add_u32 v8, v74, 2, v7
    ds_write_b32 v8, v70
    v_lshl_add_u32 v7, v7, 2, v74
    ds_write_b8 v7, v65 offset:16
    v_and_b32 v9, -4, v75
    v_lshl_add_u32 v10, v75, 2, v9
    ds_write_b32 v10, v71
    v_lshl_add_u32 v9, v9, 2, v75
    ds_write_b8_d16_hi v9, v65 offset:16
    s_add_u32 s46, s35, 0x2a48000
    s_add_u32 s46, s46, s85
    buffer_store_dwordx4 v[56:59], v0, s[20:23], s46 offen sc1
    s_add_u32 s47, s96, 0x6800000
    v_lshlrev_b32 v68, 1, v1
    buffer_load_dwordx4 v[68:71], v68, s[8:11], s47 offen nt
    s_add_u32 s44, s96, 0x6800000
    v_lshlrev_b32 v72, 1, v1
    buffer_load_dwordx4 v[72:75], v72, s[12:15], s44 offen nt
    v_and_b32 v7, -4, v80
    v_lshl_add_u32 v8, v80, 2, v7
    ds_write_b32 v8, v76
    v_lshl_add_u32 v7, v7, 2, v80
    ds_write_b8 v7, v66 offset:16
    v_and_b32 v9, -4, v81
    v_lshl_add_u32 v10, v81, 2, v9
    ds_write_b32 v10, v77
    v_lshl_add_u32 v9, v9, 2, v81
    ds_write_b8_d16_hi v9, v66 offset:16
    v_and_b32 v7, -4, v82
    v_lshl_add_u32 v8, v82, 2, v7
    ds_write_b32 v8, v78
    v_lshl_add_u32 v7, v7, 2, v82
    ds_write_b8 v7, v67 offset:16
    v_and_b32 v9, -4, v83
    v_lshl_add_u32 v10, v83, 2, v9
    ds_write_b32 v10, v79
    v_lshl_add_u32 v9, v9, 2, v83
    ds_write_b8_d16_hi v9, v67 offset:16
    s_add_u32 s45, s96, 0x6800000
    s_lshr_b32 s45, s45, 1
    buffer_load_dwordx2 v[56:57], v1, s[16:19], s45 offen nt
    s_add_u32 s46, s96, 0x6c00000
    s_lshr_b32 s46, s46, 1
    buffer_load_dwordx2 v[58:59], v1, s[16:19], s46 offen nt
    s_add_u32 s47, s96, 0x6c00000
    v_lshlrev_b32 v76, 1, v1
    buffer_load_dwordx4 v[76:79], v76, s[8:11], s47 offen nt
    s_waitcnt vmcnt(10)
    v_lshlrev_b32 v7, 16, v84
    v_and_b32 v8, 0xffff0000, v84
    v_lshlrev_b32 v9, 16, v85
    v_and_b32 v10, 0xffff0000, v85
    v_mul_f32 v7, 0.15915494, v7
    v_mul_f32 v8, 0.15915494, v8
    v_mul_f32 v9, 0.15915494, v9
    v_mul_f32 v10, 0.15915494, v10
    v_mul_hi_u32_u24 v14, 429497, v40
    v_lshrrev_b32 v12, 3, v24
    v_cos_f32 v7, v7
    v_lshlrev_b16 v13, 3, v24
    v_mad_i32_i24 v11, v14, s55, v40
    v_bitop3_b32 v12, v6, v13, v12 bitop3:0xca
    v_lshl_add_u32 v11, v11, 17, s40
    v_lshlrev_b16 v14, 8, v14
    v_lshrrev_b32 v13, 2, v24
    v_add_u32 v40, v12, v11
    v_bitop3_b32 v24, v5, v13, v14 bitop3:0xea
    v_mul_hi_u32_u24 v14, 429497, v41
    v_lshrrev_b32 v12, 3, v25
    v_cos_f32 v8, v8
    v_lshlrev_b16 v13, 3, v25
    v_mad_i32_i24 v11, v14, s55, v41
    v_bitop3_b32 v12, v6, v13, v12 bitop3:0xca
    v_lshl_add_u32 v11, v11, 17, s40
    v_lshlrev_b16 v14, 8, v14
    v_lshrrev_b32 v13, 2, v25
    v_add_u32 v41, v12, v11
    v_bitop3_b32 v25, v5, v13, v14 bitop3:0xea
    v_cvt_pk_bf16_f32 v84, v7, v8
    v_perm_b32 v12, v84, v84, s41
    v_bitop3_b32 v40, v4, v12, v40 bitop3:0xca
    v_perm_b32 v13, v84, v84, s42
    v_bitop3_b32 v41, v4, v13, v41 bitop3:0xca
    v_mul_hi_u32_u24 v14, 429497, v42
    v_lshrrev_b32 v12, 3, v26
    v_cos_f32 v9, v9
    v_lshlrev_b16 v13, 3, v26
    v_mad_i32_i24 v11, v14, s55, v42
    v_bitop3_b32 v12, v6, v13, v12 bitop3:0xca
    v_lshl_add_u32 v11, v11, 17, s40
    v_lshlrev_b16 v14, 8, v14
    v_lshrrev_b32 v13, 2, v26
    v_add_u32 v42, v12, v11
    v_bitop3_b32 v26, v5, v13, v14 bitop3:0xea
    v_mul_hi_u32_u24 v14, 429497, v43
    v_lshrrev_b32 v12, 3, v27
    v_cos_f32 v10, v10
    v_lshlrev_b16 v13, 3, v27
    v_mad_i32_i24 v11, v14, s55, v43
    v_bitop3_b32 v12, v6, v13, v12 bitop3:0xca
    v_lshl_add_u32 v11, v11, 17, s40
    v_lshlrev_b16 v14, 8, v14
    v_lshrrev_b32 v13, 2, v27
    v_add_u32 v43, v12, v11
    v_bitop3_b32 v27, v5, v13, v14 bitop3:0xea
    v_cvt_pk_bf16_f32 v85, v9, v10
    v_perm_b32 v12, v85, v85, s41
    v_bitop3_b32 v42, v4, v12, v42 bitop3:0xca
    v_perm_b32 v13, v85, v85, s42
    v_bitop3_b32 v43, v4, v13, v43 bitop3:0xca
    s_setprio 2
    v_and_b32 v7, -4, v104
    v_lshl_add_u32 v8, v104, 2, v7
    ds_write_b32 v8, v96
    v_lshl_add_u32 v7, v7, 2, v104
    ds_write_b8 v7, v88 offset:16
    v_and_b32 v9, -4, v105
    v_lshl_add_u32 v10, v105, 2, v9
    ds_write_b32 v10, v97
    v_lshl_add_u32 v9, v9, 2, v105
    ds_write_b8_d16_hi v9, v88 offset:16
    v_and_b32 v7, -4, v106
    v_lshl_add_u32 v8, v106, 2, v7
    ds_write_b32 v8, v98
    v_lshl_add_u32 v7, v7, 2, v106
    ds_write_b8 v7, v89 offset:16
    v_and_b32 v9, -4, v107
    v_lshl_add_u32 v10, v107, 2, v9
    ds_write_b32 v10, v99
    v_lshl_add_u32 v9, v9, 2, v107
    ds_write_b8_d16_hi v9, v89 offset:16
    s_add_u32 s44, s35, 0x2a48000
    s_add_u32 s44, s44, s91
    buffer_store_dwordx4 v[60:63], v0, s[20:23], s44 offen sc1
    s_add_u32 s45, s96, 0x6c00000
    v_lshlrev_b32 v80, 1, v1
    buffer_load_dwordx4 v[80:83], v80, s[12:15], s45 offen nt
    s_waitcnt vmcnt(8)
    v_lshlrev_b32 v7, 16, v86
    v_and_b32 v8, 0xffff0000, v86
    v_lshlrev_b32 v9, 16, v87
    v_and_b32 v10, 0xffff0000, v87
    v_mul_f32 v7, 0.15915494, v7
    v_mul_f32 v8, 0.15915494, v8
    v_mul_f32 v9, 0.15915494, v9
    v_mul_f32 v10, 0.15915494, v10
    v_mul_hi_u32_u24 v14, 429497, v48
    v_lshrrev_b32 v12, 3, v52
    v_cos_f32 v7, v7
    v_lshlrev_b16 v13, 3, v52
    v_mad_i32_i24 v11, v14, s55, v48
    v_bitop3_b32 v12, v6, v13, v12 bitop3:0xca
    v_lshl_add_u32 v11, v11, 17, s40
    v_lshlrev_b16 v14, 8, v14
    v_lshrrev_b32 v13, 2, v52
    v_add_u32 v48, v12, v11
    v_bitop3_b32 v52, v5, v13, v14 bitop3:0xea
    v_mul_hi_u32_u24 v14, 429497, v49
    v_lshrrev_b32 v12, 3, v53
    v_cos_f32 v8, v8
    v_lshlrev_b16 v13, 3, v53
    v_mad_i32_i24 v11, v14, s55, v49
    v_bitop3_b32 v12, v6, v13, v12 bitop3:0xca
    v_lshl_add_u32 v11, v11, 17, s40
    v_lshlrev_b16 v14, 8, v14
    v_lshrrev_b32 v13, 2, v53
    v_add_u32 v49, v12, v11
    v_bitop3_b32 v53, v5, v13, v14 bitop3:0xea
    v_cvt_pk_bf16_f32 v86, v7, v8
    v_perm_b32 v12, v86, v86, s41
    v_bitop3_b32 v48, v4, v12, v48 bitop3:0xca
    v_perm_b32 v13, v86, v86, s42
    v_bitop3_b32 v49, v4, v13, v49 bitop3:0xca
    v_mul_hi_u32_u24 v14, 429497, v50
    v_lshrrev_b32 v12, 3, v54
    v_cos_f32 v9, v9
    v_lshlrev_b16 v13, 3, v54
    v_mad_i32_i24 v11, v14, s55, v50
    v_bitop3_b32 v12, v6, v13, v12 bitop3:0xca
    v_lshl_add_u32 v11, v11, 17, s40
    v_lshlrev_b16 v14, 8, v14
    v_lshrrev_b32 v13, 2, v54
    v_add_u32 v50, v12, v11
    v_bitop3_b32 v54, v5, v13, v14 bitop3:0xea
    v_mul_hi_u32_u24 v14, 429497, v51
    v_lshrrev_b32 v12, 3, v55
    v_cos_f32 v10, v10
    v_lshlrev_b16 v13, 3, v55
    v_mad_i32_i24 v11, v14, s55, v51
    v_bitop3_b32 v12, v6, v13, v12 bitop3:0xca
    v_lshl_add_u32 v11, v11, 17, s40
    v_lshlrev_b16 v14, 8, v14
    v_lshrrev_b32 v13, 2, v55
    v_add_u32 v51, v12, v11
    v_bitop3_b32 v55, v5, v13, v14 bitop3:0xea
    v_cvt_pk_bf16_f32 v87, v9, v10
    v_perm_b32 v12, v87, v87, s41
    v_bitop3_b32 v50, v4, v12, v50 bitop3:0xca
    v_perm_b32 v13, v87, v87, s42
    v_bitop3_b32 v51, v4, v13, v51 bitop3:0xca
    v_and_b32 v7, -4, v112
    v_lshl_add_u32 v8, v112, 2, v7
    ds_write_b32 v8, v100
    v_lshl_add_u32 v7, v7, 2, v112
    ds_write_b8 v7, v90 offset:16
    v_and_b32 v9, -4, v113
    v_lshl_add_u32 v10, v113, 2, v9
    ds_write_b32 v10, v101
    v_lshl_add_u32 v9, v9, 2, v113
    ds_write_b8_d16_hi v9, v90 offset:16
    v_and_b32 v7, -4, v114
    v_lshl_add_u32 v8, v114, 2, v7
    ds_write_b32 v8, v102
    v_lshl_add_u32 v7, v7, 2, v114
    ds_write_b8 v7, v91 offset:16
    v_and_b32 v9, -4, v115
    v_lshl_add_u32 v10, v115, 2, v9
    ds_write_b32 v10, v103
    v_lshl_add_u32 v9, v9, 2, v115
    ds_write_b8_d16_hi v9, v91 offset:16
    s_add_u32 s46, s96, 0x7000000
    v_lshlrev_b32 v64, 1, v1
    buffer_load_dwordx4 v[64:67], v64, s[8:11], s46 offen nt
    s_add_u32 s47, s96, 0x7000000
    v_lshlrev_b32 v96, 1, v1
    buffer_load_dwordx4 v[96:99], v96, s[12:15], s47 offen nt
    s_waitcnt vmcnt(5)
    v_lshlrev_b32 v7, 16, v56
    v_and_b32 v8, 0xffff0000, v56
    v_lshlrev_b32 v9, 16, v57
    v_and_b32 v10, 0xffff0000, v57
    v_mul_f32 v7, 0.15915494, v7
    v_mul_f32 v8, 0.15915494, v8
    v_mul_f32 v9, 0.15915494, v9
    v_mul_f32 v10, 0.15915494, v10
    v_mul_hi_u32_u24 v14, 429497, v68
    v_lshrrev_b32 v12, 3, v72
    v_cos_f32 v7, v7
    v_lshlrev_b16 v13, 3, v72
    v_mad_i32_i24 v11, v14, s55, v68
    v_bitop3_b32 v12, v6, v13, v12 bitop3:0xca
    v_lshl_add_u32 v11, v11, 17, s40
    v_lshlrev_b16 v14, 8, v14
    v_lshrrev_b32 v13, 2, v72
    v_add_u32 v68, v12, v11
    v_bitop3_b32 v72, v5, v13, v14 bitop3:0xea
    v_mul_hi_u32_u24 v14, 429497, v69
    v_lshrrev_b32 v12, 3, v73
    v_cos_f32 v8, v8
    v_lshlrev_b16 v13, 3, v73
    v_mad_i32_i24 v11, v14, s55, v69
    v_bitop3_b32 v12, v6, v13, v12 bitop3:0xca
    v_lshl_add_u32 v11, v11, 17, s40
    v_lshlrev_b16 v14, 8, v14
    v_lshrrev_b32 v13, 2, v73
    v_add_u32 v69, v12, v11
    v_bitop3_b32 v73, v5, v13, v14 bitop3:0xea
    v_cvt_pk_bf16_f32 v56, v7, v8
    v_perm_b32 v12, v56, v56, s41
    v_bitop3_b32 v68, v4, v12, v68 bitop3:0xca
    v_perm_b32 v13, v56, v56, s42
    v_bitop3_b32 v69, v4, v13, v69 bitop3:0xca
    v_mul_hi_u32_u24 v14, 429497, v70
    v_lshrrev_b32 v12, 3, v74
    v_cos_f32 v9, v9
    v_lshlrev_b16 v13, 3, v74
    v_mad_i32_i24 v11, v14, s55, v70
    v_bitop3_b32 v12, v6, v13, v12 bitop3:0xca
    v_lshl_add_u32 v11, v11, 17, s40
    v_lshlrev_b16 v14, 8, v14
    v_lshrrev_b32 v13, 2, v74
    v_add_u32 v70, v12, v11
    v_bitop3_b32 v74, v5, v13, v14 bitop3:0xea
    v_mul_hi_u32_u24 v14, 429497, v71
    v_lshrrev_b32 v12, 3, v75
    v_cos_f32 v10, v10
    v_lshlrev_b16 v13, 3, v75
    v_mad_i32_i24 v11, v14, s55, v71
    v_bitop3_b32 v12, v6, v13, v12 bitop3:0xca
    v_lshl_add_u32 v11, v11, 17, s40
    v_lshlrev_b16 v14, 8, v14
    v_lshrrev_b32 v13, 2, v75
    v_add_u32 v71, v12, v11
    v_bitop3_b32 v75, v5, v13, v14 bitop3:0xea
    v_cvt_pk_bf16_f32 v57, v9, v10
    v_perm_b32 v12, v57, v57, s41
    v_bitop3_b32 v70, v4, v12, v70 bitop3:0xca
    v_perm_b32 v13, v57, v57, s42
    v_bitop3_b32 v71, v4, v13, v71 bitop3:0xca
    s_setprio 1
    v_and_b32 v7, -4, v116
    v_lshl_add_u32 v8, v116, 2, v7
    ds_write_b32 v8, v108
    v_lshl_add_u32 v7, v7, 2, v116
    ds_write_b8 v7, v120 offset:16
    v_and_b32 v9, -4, v117
    v_lshl_add_u32 v10, v117, 2, v9
    ds_write_b32 v10, v109
    v_lshl_add_u32 v9, v9, 2, v117
    ds_write_b8_d16_hi v9, v120 offset:16
    v_and_b32 v7, -4, v118
    v_lshl_add_u32 v8, v118, 2, v7
    ds_write_b32 v8, v110
    v_lshl_add_u32 v7, v7, 2, v118
    ds_write_b8 v7, v121 offset:16
    v_and_b32 v9, -4, v119
    v_lshl_add_u32 v10, v119, 2, v9
    ds_write_b32 v10, v111
    v_lshl_add_u32 v9, v9, 2, v119
    ds_write_b8_d16_hi v9, v121 offset:16
    s_add_u32 s44, s96, 0x7000000
    s_lshr_b32 s44, s44, 1
    buffer_load_dwordx2 v[104:105], v1, s[16:19], s44 offen nt
    s_add_u32 s45, s96, 0x7400000
    s_lshr_b32 s45, s45, 1
    buffer_load_dwordx2 v[106:107], v1, s[16:19], s45 offen nt
    s_add_u32 s46, s96, 0x7400000
    v_lshlrev_b32 v60, 1, v1
    buffer_load_dwordx4 v[60:63], v60, s[8:11], s46 offen nt
    v_and_b32 v7, -4, v16
    v_lshl_add_u32 v8, v16, 2, v7
    ds_write_b32 v8, v92
    v_lshl_add_u32 v7, v7, 2, v16
    ds_write_b8 v7, v122 offset:16
    v_and_b32 v9, -4, v17
    v_lshl_add_u32 v10, v17, 2, v9
    ds_write_b32 v10, v93
    v_lshl_add_u32 v9, v9, 2, v17
    ds_write_b8_d16_hi v9, v122 offset:16
    v_and_b32 v7, -4, v18
    v_lshl_add_u32 v8, v18, 2, v7
    ds_write_b32 v8, v94
    v_lshl_add_u32 v7, v7, 2, v18
    ds_write_b8 v7, v123 offset:16
    v_and_b32 v9, -4, v19
    v_lshl_add_u32 v10, v19, 2, v9
    ds_write_b32 v10, v95
    v_lshl_add_u32 v9, v9, 2, v19
    ds_write_b8_d16_hi v9, v123 offset:16
    s_add_u32 s47, s35, 0x2a48000
    s_add_u32 s47, s47, s93
    buffer_store_dwordx4 v[44:47], v0, s[20:23], s47 offen sc1
    s_add_u32 s44, s96, 0x7400000
    v_lshlrev_b32 v100, 1, v1
    buffer_load_dwordx4 v[100:103], v100, s[12:15], s44 offen nt
    s_waitcnt vmcnt(7)
    v_lshlrev_b32 v7, 16, v58
    v_and_b32 v8, 0xffff0000, v58
    v_lshlrev_b32 v9, 16, v59
    v_and_b32 v10, 0xffff0000, v59
    v_mul_f32 v7, 0.15915494, v7
    v_mul_f32 v8, 0.15915494, v8
    v_mul_f32 v9, 0.15915494, v9
    v_mul_f32 v10, 0.15915494, v10
    v_mul_hi_u32_u24 v14, 429497, v76
    v_lshrrev_b32 v12, 3, v80
    v_cos_f32 v7, v7
    v_lshlrev_b16 v13, 3, v80
    v_mad_i32_i24 v11, v14, s55, v76
    v_bitop3_b32 v12, v6, v13, v12 bitop3:0xca
    v_lshl_add_u32 v11, v11, 17, s40
    v_lshlrev_b16 v14, 8, v14
    v_lshrrev_b32 v13, 2, v80
    v_add_u32 v76, v12, v11
    v_bitop3_b32 v80, v5, v13, v14 bitop3:0xea
    v_mul_hi_u32_u24 v14, 429497, v77
    v_lshrrev_b32 v12, 3, v81
    v_cos_f32 v8, v8
    v_lshlrev_b16 v13, 3, v81
    v_mad_i32_i24 v11, v14, s55, v77
    v_bitop3_b32 v12, v6, v13, v12 bitop3:0xca
    v_lshl_add_u32 v11, v11, 17, s40
    v_lshlrev_b16 v14, 8, v14
    v_lshrrev_b32 v13, 2, v81
    v_add_u32 v77, v12, v11
    v_bitop3_b32 v81, v5, v13, v14 bitop3:0xea
    v_cvt_pk_bf16_f32 v58, v7, v8
    v_perm_b32 v12, v58, v58, s41
    v_bitop3_b32 v76, v4, v12, v76 bitop3:0xca
    v_perm_b32 v13, v58, v58, s42
    v_bitop3_b32 v77, v4, v13, v77 bitop3:0xca
    v_mul_hi_u32_u24 v14, 429497, v78
    v_lshrrev_b32 v12, 3, v82
    v_cos_f32 v9, v9
    v_lshlrev_b16 v13, 3, v82
    v_mad_i32_i24 v11, v14, s55, v78
    v_bitop3_b32 v12, v6, v13, v12 bitop3:0xca
    v_lshl_add_u32 v11, v11, 17, s40
    v_lshlrev_b16 v14, 8, v14
    v_lshrrev_b32 v13, 2, v82
    v_add_u32 v78, v12, v11
    v_bitop3_b32 v82, v5, v13, v14 bitop3:0xea
    v_mul_hi_u32_u24 v14, 429497, v79
    v_lshrrev_b32 v12, 3, v83
    v_cos_f32 v10, v10
    v_lshlrev_b16 v13, 3, v83
    v_mad_i32_i24 v11, v14, s55, v79
    v_bitop3_b32 v12, v6, v13, v12 bitop3:0xca
    v_lshl_add_u32 v11, v11, 17, s40
    v_lshlrev_b16 v14, 8, v14
    v_lshrrev_b32 v13, 2, v83
    v_add_u32 v79, v12, v11
    v_bitop3_b32 v83, v5, v13, v14 bitop3:0xea
    v_cvt_pk_bf16_f32 v59, v9, v10
    v_perm_b32 v12, v59, v59, s41
    v_bitop3_b32 v78, v4, v12, v78 bitop3:0xca
    v_perm_b32 v13, v59, v59, s42
    v_bitop3_b32 v79, v4, v13, v79 bitop3:0xca
    s_setprio 0
    v_and_b32 v7, -4, v124
    v_lshl_add_u32 v8, v124, 2, v7
    ds_write_b32 v8, v20
    v_lshl_add_u32 v7, v7, 2, v124
    ds_write_b8 v7, v28 offset:16
    v_and_b32 v9, -4, v125
    v_lshl_add_u32 v10, v125, 2, v9
    ds_write_b32 v10, v21
    v_lshl_add_u32 v9, v9, 2, v125
    ds_write_b8_d16_hi v9, v28 offset:16
    v_and_b32 v7, -4, v126
    v_lshl_add_u32 v8, v126, 2, v7
    ds_write_b32 v8, v22
    v_lshl_add_u32 v7, v7, 2, v126
    ds_write_b8 v7, v29 offset:16
    v_and_b32 v9, -4, v127
    v_lshl_add_u32 v10, v127, 2, v9
    ds_write_b32 v10, v23
    v_lshl_add_u32 v9, v9, 2, v127
    ds_write_b8_d16_hi v9, v29 offset:16
    s_add_u32 s45, s96, 0x7800000
    v_lshlrev_b32 v112, 1, v1
    buffer_load_dwordx4 v[112:115], v112, s[8:11], s45 offen nt
    s_add_u32 s46, s96, 0x7800000
    v_lshlrev_b32 v88, 1, v1
    buffer_load_dwordx4 v[88:91], v88, s[12:15], s46 offen nt
    s_waitcnt vmcnt(5)
    v_lshlrev_b32 v7, 16, v104
    v_and_b32 v8, 0xffff0000, v104
    v_lshlrev_b32 v9, 16, v105
    v_and_b32 v10, 0xffff0000, v105
    v_mul_f32 v7, 0.15915494, v7
    v_mul_f32 v8, 0.15915494, v8
    v_mul_f32 v9, 0.15915494, v9
    v_mul_f32 v10, 0.15915494, v10
    v_mul_hi_u32_u24 v14, 429497, v64
    v_lshrrev_b32 v12, 3, v96
    v_cos_f32 v7, v7
    v_lshlrev_b16 v13, 3, v96
    v_mad_i32_i24 v11, v14, s55, v64
    v_bitop3_b32 v12, v6, v13, v12 bitop3:0xca
    v_lshl_add_u32 v11, v11, 17, s40
    v_lshlrev_b16 v14, 8, v14
    v_lshrrev_b32 v13, 2, v96
    v_add_u32 v64, v12, v11
    v_bitop3_b32 v96, v5, v13, v14 bitop3:0xea
    v_mul_hi_u32_u24 v14, 429497, v65
    v_lshrrev_b32 v12, 3, v97
    v_cos_f32 v8, v8
    v_lshlrev_b16 v13, 3, v97
    v_mad_i32_i24 v11, v14, s55, v65
    v_bitop3_b32 v12, v6, v13, v12 bitop3:0xca
    v_lshl_add_u32 v11, v11, 17, s40
    v_lshlrev_b16 v14, 8, v14
    v_lshrrev_b32 v13, 2, v97
    v_add_u32 v65, v12, v11
    v_bitop3_b32 v97, v5, v13, v14 bitop3:0xea
    v_cvt_pk_bf16_f32 v104, v7, v8
    v_perm_b32 v12, v104, v104, s41
    v_bitop3_b32 v64, v4, v12, v64 bitop3:0xca
    v_perm_b32 v13, v104, v104, s42
    v_bitop3_b32 v65, v4, v13, v65 bitop3:0xca
    v_mul_hi_u32_u24 v14, 429497, v66
    v_lshrrev_b32 v12, 3, v98
    v_cos_f32 v9, v9
    v_lshlrev_b16 v13, 3, v98
    v_mad_i32_i24 v11, v14, s55, v66
    v_bitop3_b32 v12, v6, v13, v12 bitop3:0xca
    v_lshl_add_u32 v11, v11, 17, s40
    v_lshlrev_b16 v14, 8, v14
    v_lshrrev_b32 v13, 2, v98
    v_add_u32 v66, v12, v11
    v_bitop3_b32 v98, v5, v13, v14 bitop3:0xea
    v_mul_hi_u32_u24 v14, 429497, v67
    v_lshrrev_b32 v12, 3, v99
    v_cos_f32 v10, v10
    v_lshlrev_b16 v13, 3, v99
    v_mad_i32_i24 v11, v14, s55, v67
    v_bitop3_b32 v12, v6, v13, v12 bitop3:0xca
    v_lshl_add_u32 v11, v11, 17, s40
    v_lshlrev_b16 v14, 8, v14
    v_lshrrev_b32 v13, 2, v99
    v_add_u32 v67, v12, v11
    v_bitop3_b32 v99, v5, v13, v14 bitop3:0xea
    v_cvt_pk_bf16_f32 v105, v9, v10
    v_perm_b32 v12, v105, v105, s41
    v_bitop3_b32 v66, v4, v12, v66 bitop3:0xca
    v_perm_b32 v13, v105, v105, s42
    v_bitop3_b32 v67, v4, v13, v67 bitop3:0xca
    v_and_b32 v7, -4, v36
    v_lshl_add_u32 v8, v36, 2, v7
    ds_write_b32 v8, v32
    v_lshl_add_u32 v7, v7, 2, v36
    ds_write_b8 v7, v30 offset:16
    v_and_b32 v9, -4, v37
    v_lshl_add_u32 v10, v37, 2, v9
    ds_write_b32 v10, v33
    v_lshl_add_u32 v9, v9, 2, v37
    ds_write_b8_d16_hi v9, v30 offset:16
    v_and_b32 v7, -4, v38
    v_lshl_add_u32 v8, v38, 2, v7
    ds_write_b32 v8, v34
    v_lshl_add_u32 v7, v7, 2, v38
    ds_write_b8 v7, v31 offset:16
    v_and_b32 v9, -4, v39
    v_lshl_add_u32 v10, v39, 2, v9
    ds_write_b32 v10, v35
    v_lshl_add_u32 v9, v9, 2, v39
    ds_write_b8_d16_hi v9, v31 offset:16
    s_add_u32 s47, s96, 0x7800000
    s_lshr_b32 s47, s47, 1
    buffer_load_dwordx2 v[108:109], v1, s[16:19], s47 offen nt
    s_add_u32 s44, s96, 0x7c00000
    s_lshr_b32 s44, s44, 1
    buffer_load_dwordx2 v[110:111], v1, s[16:19], s44 offen nt
    s_waitcnt vmcnt(4)
    v_lshlrev_b32 v7, 16, v106
    v_and_b32 v8, 0xffff0000, v106
    v_lshlrev_b32 v9, 16, v107
    v_and_b32 v10, 0xffff0000, v107
    v_mul_f32 v7, 0.15915494, v7
    v_mul_f32 v8, 0.15915494, v8
    v_mul_f32 v9, 0.15915494, v9
    v_mul_f32 v10, 0.15915494, v10
    v_mul_hi_u32_u24 v14, 429497, v60
    v_lshrrev_b32 v12, 3, v100
    v_cos_f32 v7, v7
    v_lshlrev_b16 v13, 3, v100
    v_mad_i32_i24 v11, v14, s55, v60
    v_bitop3_b32 v12, v6, v13, v12 bitop3:0xca
    v_lshl_add_u32 v11, v11, 17, s40
    v_lshlrev_b16 v14, 8, v14
    v_lshrrev_b32 v13, 2, v100
    v_add_u32 v60, v12, v11
    v_bitop3_b32 v100, v5, v13, v14 bitop3:0xea
    v_mul_hi_u32_u24 v14, 429497, v61
    v_lshrrev_b32 v12, 3, v101
    v_cos_f32 v8, v8
    v_lshlrev_b16 v13, 3, v101
    v_mad_i32_i24 v11, v14, s55, v61
    v_bitop3_b32 v12, v6, v13, v12 bitop3:0xca
    v_lshl_add_u32 v11, v11, 17, s40
    v_lshlrev_b16 v14, 8, v14
    v_lshrrev_b32 v13, 2, v101
    v_add_u32 v61, v12, v11
    v_bitop3_b32 v101, v5, v13, v14 bitop3:0xea
    v_cvt_pk_bf16_f32 v106, v7, v8
    v_perm_b32 v12, v106, v106, s41
    v_bitop3_b32 v60, v4, v12, v60 bitop3:0xca
    v_perm_b32 v13, v106, v106, s42
    v_bitop3_b32 v61, v4, v13, v61 bitop3:0xca
    v_mul_hi_u32_u24 v14, 429497, v62
    v_lshrrev_b32 v12, 3, v102
    v_cos_f32 v9, v9
    v_lshlrev_b16 v13, 3, v102
    v_mad_i32_i24 v11, v14, s55, v62
    v_bitop3_b32 v12, v6, v13, v12 bitop3:0xca
    v_lshl_add_u32 v11, v11, 17, s40
    v_lshlrev_b16 v14, 8, v14
    v_lshrrev_b32 v13, 2, v102
    v_add_u32 v62, v12, v11
    v_bitop3_b32 v102, v5, v13, v14 bitop3:0xea
    v_mul_hi_u32_u24 v14, 429497, v63
    v_lshrrev_b32 v12, 3, v103
    v_cos_f32 v10, v10
    v_lshlrev_b16 v13, 3, v103
    v_mad_i32_i24 v11, v14, s55, v63
    v_bitop3_b32 v12, v6, v13, v12 bitop3:0xca
    v_lshl_add_u32 v11, v11, 17, s40
    v_lshlrev_b16 v14, 8, v14
    v_lshrrev_b32 v13, 2, v103
    v_add_u32 v63, v12, v11
    v_bitop3_b32 v103, v5, v13, v14 bitop3:0xea
    v_cvt_pk_bf16_f32 v107, v9, v10
    v_perm_b32 v12, v107, v107, s41
    v_bitop3_b32 v62, v4, v12, v62 bitop3:0xca
    v_perm_b32 v13, v107, v107, s42
    v_bitop3_b32 v63, v4, v13, v63 bitop3:0xca
    v_add_u32 v7, s72, v0
    v_add_u32 v12, s73, v0
    v_add_u32 v13, s85, v0
    v_add_u32 v14, s91, v0
    v_add_u32 v15, s93, v0
    s_min_i32 s3, s72, s73
    s_min_i32 s3, s3, s85
    s_min_i32 s3, s3, s91
    s_min_i32 s3, s3, s93
    v_add_u32 v3, s3, v0
    v_mov_b32 v8, 0
    v_mov_b32 v9, 0
    v_mov_b32 v10, 0
    v_mov_b32 v11, 0
    s_waitcnt lgkmcnt(0)
    s_barrier
    ds_read_b128 v[116:119], v7 offset:0
    ds_read_b128 v[92:95], v12 offset:0
    ds_read_b128 v[16:19], v13 offset:0
    ds_read_b128 v[120:123], v14 offset:0
    ds_read_b128 v[44:47], v15 offset:0
    ds_write_b128 v3, v[8:11]
    ds_read_b128 v[20:23], v7 offset:16384
    ds_read_b128 v[124:127], v12 offset:16384
    ds_read_b128 v[32:35], v13 offset:16384
    ds_read_b128 v[36:39], v14 offset:16384
    ds_read_b128 v[28:31], v15 offset:16384
    s_waitcnt lgkmcnt(0)
    s_barrier
    s_setprio 3
    s_add_u32 s45, s35, 0x5484000
    s_add_u32 s45, s45, s72
    buffer_store_dwordx4 v[116:119], v0, s[20:23], s45 offen sc1
    s_add_u32 s46, s96, 0x7c00000
    s_nop 0
    v_lshlrev_b32 v116, 1, v1
    buffer_load_dwordx4 v[116:119], v116, s[8:11], s46 offen nt
    s_add_u32 s47, s35, 0x5484000
    s_add_u32 s47, s47, s73
    buffer_store_dwordx4 v[92:95], v0, s[20:23], s47 offen sc1
    s_add_u32 s44, s96, 0x7c00000
    s_nop 0
    v_lshlrev_b32 v92, 1, v1
    buffer_load_dwordx4 v[92:95], v92, s[12:15], s44 offen nt
    ds_add_u32 v24, v2
    ds_add_u32 v25, v2
    ds_add_u32 v26, v2
    ds_add_u32 v27, v2
    ds_add_u32 v52, v2
    ds_add_u32 v53, v2
    ds_add_u32 v54, v2
    ds_add_u32 v55, v2
    s_setprio 2
    ds_add_u32 v72, v2
    ds_add_u32 v73, v2
    ds_add_u32 v74, v2
    ds_add_u32 v75, v2
    ds_add_u32 v80, v2
    ds_add_u32 v81, v2
    ds_add_u32 v82, v2
    ds_add_u32 v83, v2
    s_setprio 1
    s_add_u32 s45, s35, 0x5484000
    s_add_u32 s45, s45, s85
    buffer_store_dwordx4 v[16:19], v0, s[20:23], s45 offen sc1
    s_add_u32 s46, s96, 0x8000000
    s_nop 0
    v_lshlrev_b32 v16, 1, v1
    buffer_load_dwordx4 v[16:19], v16, s[8:11], s46 offen nt
    ds_add_u32 v96, v2
    ds_add_u32 v97, v2
    ds_add_u32 v98, v2
    ds_add_u32 v99, v2
    s_mov_b32 s68, s66
    s_mov_b32 s69, s67
    s_mov_b32 s70, 0x100
    s_mov_b32 s71, 0x20000
    v_mov_b32 v3, 1
    s_cmp_lg_u32 s32, 15
    s_cbranch_scc1 L1_tk
    s_mov_b64 exec, 1
    s_and_b32 s3, s2, 1
    s_lshl_b32 s3, s3, 7
    buffer_atomic_add v3, off, s[68:71], s3 sc0
    s_mov_b64 exec, -1
L1_tk:
    ds_add_u32 v100, v2
    ds_add_u32 v101, v2
    ds_add_u32 v102, v2
    ds_add_u32 v103, v2
    s_setprio 0
    s_waitcnt vmcnt(6)
    v_lshlrev_b32 v7, 16, v108
    v_and_b32 v8, 0xffff0000, v108
    v_lshlrev_b32 v9, 16, v109
    v_and_b32 v10, 0xffff0000, v109
    v_mul_f32 v7, 0.15915494, v7
    v_mul_f32 v8, 0.15915494, v8
    v_mul_f32 v9, 0.15915494, v9
    v_mul_f32 v10, 0.15915494, v10
    v_mul_hi_u32_u24 v14, 429497, v112
    v_lshrrev_b32 v12, 3, v88
    v_cos_f32 v7, v7
    v_lshlrev_b16 v13, 3, v88
    v_mad_i32_i24 v11, v14, s55, v112
    v_bitop3_b32 v12, v6, v13, v12 bitop3:0xca
    v_lshl_add_u32 v11, v11, 17, s40
    v_lshlrev_b16 v14, 8, v14
    v_lshrrev_b32 v13, 2, v88
    v_add_u32 v112, v12, v11
    v_bitop3_b32 v88, v5, v13, v14 bitop3:0xea
    ds_add_u32 v88, v2
    v_mul_hi_u32_u24 v14, 429497, v113
    v_lshrrev_b32 v12, 3, v89
    v_cos_f32 v8, v8
    v_lshlrev_b16 v13, 3, v89
    v_mad_i32_i24 v11, v14, s55, v113
    v_bitop3_b32 v12, v6, v13, v12 bitop3:0xca
    v_lshl_add_u32 v11, v11, 17, s40
    v_lshlrev_b16 v14, 8, v14
    v_lshrrev_b32 v13, 2, v89
    v_add_u32 v113, v12, v11
    v_bitop3_b32 v89, v5, v13, v14 bitop3:0xea
    ds_add_u32 v89, v2
    v_cvt_pk_bf16_f32 v108, v7, v8
    v_perm_b32 v12, v108, v108, s41
    v_bitop3_b32 v112, v4, v12, v112 bitop3:0xca
    v_perm_b32 v13, v108, v108, s42
    v_bitop3_b32 v113, v4, v13, v113 bitop3:0xca
    v_mul_hi_u32_u24 v14, 429497, v114
    v_lshrrev_b32 v12, 3, v90
    v_cos_f32 v9, v9
    v_lshlrev_b16 v13, 3, v90
    v_mad_i32_i24 v11, v14, s55, v114
    v_bitop3_b32 v12, v6, v13, v12 bitop3:0xca
    v_lshl_add_u32 v11, v11, 17, s40
    v_lshlrev_b16 v14, 8, v14
    v_lshrrev_b32 v13, 2, v90
    v_add_u32 v114, v12, v11
    v_bitop3_b32 v90, v5, v13, v14 bitop3:0xea
    ds_add_u32 v90, v2
    v_mul_hi_u32_u24 v14, 429497, v115
    v_lshrrev_b32 v12, 3, v91
    v_cos_f32 v10, v10
    v_lshlrev_b16 v13, 3, v91
    v_mad_i32_i24 v11, v14, s55, v115
    v_bitop3_b32 v12, v6, v13, v12 bitop3:0xca
    v_lshl_add_u32 v11, v11, 17, s40
    v_lshlrev_b16 v14, 8, v14
    v_lshrrev_b32 v13, 2, v91
    v_add_u32 v115, v12, v11
    v_bitop3_b32 v91, v5, v13, v14 bitop3:0xea
    ds_add_u32 v91, v2
    v_cvt_pk_bf16_f32 v109, v9, v10
    v_perm_b32 v12, v109, v109, s41
    v_bitop3_b32 v114, v4, v12, v114 bitop3:0xca
    v_perm_b32 v13, v109, v109, s42
    v_bitop3_b32 v115, v4, v13, v115 bitop3:0xca
    s_waitcnt vmcnt(2)
    v_lshlrev_b32 v7, 16, v110
    v_and_b32 v8, 0xffff0000, v110
    v_lshlrev_b32 v9, 16, v111
    v_and_b32 v10, 0xffff0000, v111
    v_mul_f32 v7, 0.15915494, v7
    v_mul_f32 v8, 0.15915494, v8
    v_mul_f32 v9, 0.15915494, v9
    v_mul_f32 v10, 0.15915494, v10
    v_mul_hi_u32_u24 v14, 429497, v116
    v_lshrrev_b32 v12, 3, v92
    v_cos_f32 v7, v7
    v_lshlrev_b16 v13, 3, v92
    v_mad_i32_i24 v11, v14, s55, v116
    v_bitop3_b32 v12, v6, v13, v12 bitop3:0xca
    v_lshl_add_u32 v11, v11, 17, s40
    v_lshlrev_b16 v14, 8, v14
    v_lshrrev_b32 v13, 2, v92
    v_add_u32 v116, v12, v11
    v_bitop3_b32 v92, v5, v13, v14 bitop3:0xea
    ds_add_u32 v92, v2
    v_mul_hi_u32_u24 v14, 429497, v117
    v_lshrrev_b32 v12, 3, v93
    v_cos_f32 v8, v8
    v_lshlrev_b16 v13, 3, v93
    v_mad_i32_i24 v11, v14, s55, v117
    v_bitop3_b32 v12, v6, v13, v12 bitop3:0xca
    v_lshl_add_u32 v11, v11, 17, s40
    v_lshlrev_b16 v14, 8, v14
    v_lshrrev_b32 v13, 2, v93
    v_add_u32 v117, v12, v11
    v_bitop3_b32 v93, v5, v13, v14 bitop3:0xea
    ds_add_u32 v93, v2
    v_cvt_pk_bf16_f32 v110, v7, v8
    v_perm_b32 v12, v110, v110, s41
    v_bitop3_b32 v116, v4, v12, v116 bitop3:0xca
    v_perm_b32 v13, v110, v110, s42
    v_bitop3_b32 v117, v4, v13, v117 bitop3:0xca
    v_mul_hi_u32_u24 v14, 429497, v118
    v_lshrrev_b32 v12, 3, v94
    v_cos_f32 v9, v9
    v_lshlrev_b16 v13, 3, v94
    v_mad_i32_i24 v11, v14, s55, v118
    v_bitop3_b32 v12, v6, v13, v12 bitop3:0xca
    v_lshl_add_u32 v11, v11, 17, s40
    v_lshlrev_b16 v14, 8, v14
    v_lshrrev_b32 v13, 2, v94
    v_add_u32 v118, v12, v11
    v_bitop3_b32 v94, v5, v13, v14 bitop3:0xea
    ds_add_u32 v94, v2
    v_mul_hi_u32_u24 v14, 429497, v119
    v_lshrrev_b32 v12, 3, v95
    v_cos_f32 v10, v10
    v_lshlrev_b16 v13, 3, v95
    v_mad_i32_i24 v11, v14, s55, v119
    v_bitop3_b32 v12, v6, v13, v12 bitop3:0xca
    v_lshl_add_u32 v11, v11, 17, s40
    v_lshlrev_b16 v14, 8, v14
    v_lshrrev_b32 v13, 2, v95
    v_add_u32 v119, v12, v11
    v_bitop3_b32 v95, v5, v13, v14 bitop3:0xea
    ds_add_u32 v95, v2
    v_cvt_pk_bf16_f32 v111, v9, v10
    v_perm_b32 v12, v111, v111, s41
    v_bitop3_b32 v118, v4, v12, v118 bitop3:0xca
    v_perm_b32 v13, v111, v111, s42
    v_bitop3_b32 v119, v4, v13, v119 bitop3:0xca
    v_lshrrev_b32 v8, 2, v0
    v_and_b32 v7, 0x3c00, v0
    v_bitop3_b32 v7, v5, v8, v7 bitop3:0xea
    s_waitcnt lgkmcnt(0)
    s_barrier
    ds_read2st64_b32 v[8:9], v7 offset0:0 offset1:1
    ds_read2st64_b32 v[10:11], v7 offset0:2 offset1:3
    s_add_u32 s47, s35, 0x5484000
    s_add_u32 s47, s47, s91
    buffer_store_dwordx4 v[120:123], v0, s[20:23], s47 offen sc1
    s_add_u32 s44, s96, 0x8000000
    s_nop 0
    v_lshlrev_b32 v120, 1, v1
    buffer_load_dwordx4 v[120:123], v120, s[12:15], s44 offen nt
    s_waitcnt lgkmcnt(0)
    v_lshl_or_b32 v12, v9, 16, v8
    v_lshl_or_b32 v13, v11, 16, v10
    v_mov_b32 v14, v12
    v_mov_b32 v15, v13
    s_nop 0
    v_add_u32_dpp v14, v14, v14 row_shr:1 row_mask:0xf bank_mask:0xf bound_ctrl:1
    v_add_u32_dpp v15, v15, v15 row_shr:1 row_mask:0xf bank_mask:0xf bound_ctrl:1
    s_nop 0
    v_add_u32_dpp v14, v14, v14 row_shr:2 row_mask:0xf bank_mask:0xf bound_ctrl:1
    v_add_u32_dpp v15, v15, v15 row_shr:2 row_mask:0xf bank_mask:0xf bound_ctrl:1
    s_nop 0
    v_add_u32_dpp v14, v14, v14 row_shr:4 row_mask:0xf bank_mask:0xf bound_ctrl:1
    v_add_u32_dpp v15, v15, v15 row_shr:4 row_mask:0xf bank_mask:0xf bound_ctrl:1
    s_nop 0
    v_add_u32_dpp v14, v14, v14 row_shr:8 row_mask:0xf bank_mask:0xf bound_ctrl:1
    v_add_u32_dpp v15, v15, v15 row_shr:8 row_mask:0xf bank_mask:0xf bound_ctrl:1
    s_nop 0
    v_add_u32_dpp v14, v14, v14 row_bcast:15 row_mask:0xa bank_mask:0xf
    v_add_u32_dpp v15, v15, v15 row_bcast:15 row_mask:0xa bank_mask:0xf
    s_nop 0
    v_add_u32_dpp v14, v14, v14 row_bcast:31 row_mask:0xc bank_mask:0xf
    v_add_u32_dpp v15, v15, v15 row_bcast:31 row_mask:0xc bank_mask:0xf
    v_readlane_b32 s48, v14, 63
    v_readlane_b32 s49, v15, 63
    s_lshl_b32 s54, s32, 2
    v_mov_b32 v8, s54
    s_and_b32 s50, s48, 0xffff
    s_lshr_b32 s51, s48, 16
    s_and_b32 s52, s49, 0xffff
    s_lshr_b32 s53, s49, 16
    s_add_u32 s51, s51, s50
    s_add_u32 s52, s52, s51
    s_add_u32 s53, s53, s52
    v_mov_b32 v9, s53
    s_mov_b64 exec, 1
    ds_write_b32 v8, v9 offset:16384
    s_cmp_lg_u32 s32, 15
    s_cbranch_scc1 L1_tk2
    s_waitcnt vmcnt(1)
L1_tk2:
    ds_write_b32 v8, v3 offset:16448
    s_mov_b64 exec, -1
    v_and_b32 v8, 60, v7
    s_waitcnt lgkmcnt(0)
    s_barrier
    ds_read_b32 v9, v8 offset:16384
    ds_read_b32 v10, v8 offset:16448
    s_waitcnt lgkmcnt(0)
    v_readlane_b32 s84, v10, 15
    s_and_b32 s3, s2, 1
    s_lshl_b32 s3, s3, 7
    s_add_u32 s84, s84, s3
    s_and_b32 s4, s84, 127
    s_lshl_b32 s6, s32, 10
    s_mov_b32 s43, 5
    s_bitcmp1_b32 s2, 0
    s_cselect_b32 s5, 128, 0
    s_mov_b32 s7, 128
    s_cselect_b32 s7, 124, s7
    s_add_u32 s5, s5, s4
    s_add_u32 s5, s5, 9472
    s_lshl_b32 s5, s5, 14
    s_add_u32 s38, s5, s6
    s_cmp_lt_u32 s4, s7
    s_addc_u32 s43, s43, 0
    s_bitcmp1_b32 s2, 0
    s_cselect_b32 s5, 112, 0
    s_mov_b32 s7, 112
    s_cselect_b32 s7, 100, s7
    s_add_u32 s5, s5, s4
    s_add_u32 s5, s5, 9724
    s_lshl_b32 s5, s5, 14
    s_add_u32 s39, s5, s6
    s_cmp_lt_u32 s4, s7
    s_addc_u32 s43, s43, 0
    s_bitcmp1_b32 s2, 0
    s_cselect_b32 s5, 64, 0
    s_mov_b32 s7, 64
    s_cselect_b32 s7, 0, s7
    s_add_u32 s5, s5, s4
    s_add_u32 s5, s5, 9936
    s_lshl_b32 s5, s5, 14
    s_add_u32 s58, s5, s6
    s_cmp_lt_u32 s4, s7
    s_addc_u32 s43, s43, 0
    v_add_u32_dpp v9, v9, v9 row_shr:1 row_mask:0xf bank_mask:0xf bound_ctrl:1
    s_nop 1
    v_add_u32_dpp v9, v9, v9 row_shr:2 row_mask:0xf bank_mask:0xf bound_ctrl:1
    s_nop 1
    v_add_u32_dpp v9, v9, v9 row_shr:4 row_mask:0xf bank_mask:0xf bound_ctrl:1
    s_nop 1
    v_add_u32_dpp v9, v9, v9 row_shr:8 row_mask:0xf bank_mask:0xf bound_ctrl:1
    s_nop 0
    v_readlane_b32 s54, v9, s32
    s_sub_u32 s54, s54, s53
    s_add_u32 s50, s50, s54
    s_add_u32 s51, s51, s54
    s_add_u32 s52, s52, s54
    s_pack_ll_b32_b16 s48, s54, s50
    s_pack_ll_b32_b16 s49, s51, s52
    v_add_u32 v14, s48, v14
    v_add_u32 v15, s49, v15
    v_sub_u32 v12, v14, v12
    v_sub_u32 v13, v15, v13
    v_and_b32 v8, 0xffff, v12
    v_lshrrev_b32 v9, 16, v12
    v_and_b32 v10, 0xffff, v13
    v_lshrrev_b32 v11, 16, v13
    ds_write2st64_b32 v7, v8, v9 offset0:0 offset1:1
    ds_write2st64_b32 v7, v10, v11 offset0:2 offset1:3
    v_and_b32 v8, 0x3f0, v0
    v_lshl_add_u32 v8, v8, 1, s36
    ds_write_b64 v8, v[12:13] offset:20480
    s_bitset0_b64 exec, 63
    s_not_b64 exec, exec
    ds_write_b64 v8, v[14:15] offset:20512
    s_mov_b64 exec, -1
    s_waitcnt lgkmcnt(0)
    s_barrier
    s_setprio 3
    ds_add_rtn_u32 v24, v24, v2
    ds_add_rtn_u32 v25, v25, v2
    ds_add_rtn_u32 v26, v26, v2
    ds_add_rtn_u32 v27, v27, v2
    ds_read_b128 v[12:15], v0 offset:20480
    v_cmp_gt_u32 vcc, 8448, v0
    s_add_u32 s45, s35, 0x5484000
    s_add_u32 s45, s45, s93
    buffer_store_dwordx4 v[44:47], v0, s[20:23], s45 offen sc1
    s_add_u32 s46, s96, 0x8000000
    s_lshr_b32 s46, s46, 1
    buffer_load_dwordx2 v[44:45], v1, s[16:19], s46 offen nt
    s_add_u32 s47, s96, 0x8400000
    s_lshr_b32 s47, s47, 1
    buffer_load_dwordx2 v[46:47], v1, s[16:19], s47 offen nt
    ds_add_rtn_u32 v52, v52, v2
    ds_add_rtn_u32 v53, v53, v2
    ds_add_rtn_u32 v54, v54, v2
    ds_add_rtn_u32 v55, v55, v2
    s_setprio 2
    ds_add_rtn_u32 v72, v72, v2
    ds_add_rtn_u32 v73, v73, v2
    ds_add_rtn_u32 v74, v74, v2
    ds_add_rtn_u32 v75, v75, v2
    s_waitcnt lgkmcnt(8)
    s_cbranch_vccz L1_p4
    s_add_u32 s44, s35, 0x7ec0000
    s_mov_b64 exec, vcc
    buffer_store_dwordx4 v[12:15], v0, s[24:27], s44 offen sc1
    s_mov_b64 exec, -1
L1_p4:
    s_add_u32 s45, s35, 0x5488000
    s_add_u32 s45, s45, s72
    buffer_store_dwordx4 v[20:23], v0, s[20:23], s45 offen sc1
    s_add_u32 s46, s96, 0x8400000
    s_nop 0
    v_lshlrev_b32 v20, 1, v1
    buffer_load_dwordx4 v[20:23], v20, s[8:11], s46 offen nt
    ds_add_rtn_u32 v80, v80, v2
    ds_add_rtn_u32 v81, v81, v2
    ds_add_rtn_u32 v82, v82, v2
    ds_add_rtn_u32 v83, v83, v2
    s_setprio 1
    ds_add_rtn_u32 v96, v96, v2
    ds_add_rtn_u32 v97, v97, v2
    ds_add_rtn_u32 v98, v98, v2
    ds_add_rtn_u32 v99, v99, v2
    ds_add_rtn_u32 v100, v100, v2
    ds_add_rtn_u32 v101, v101, v2
    ds_add_rtn_u32 v102, v102, v2
    ds_add_rtn_u32 v103, v103, v2
    s_add_u32 s47, s35, 0x5488000
    s_add_u32 s47, s47, s73
    buffer_store_dwordx4 v[124:127], v0, s[20:23], s47 offen sc1
    s_add_u32 s44, s96, 0x8400000
    s_nop 0
    v_lshlrev_b32 v124, 1, v1
    buffer_load_dwordx4 v[124:127], v124, s[12:15], s44 offen nt
    s_setprio 0
    ds_add_rtn_u32 v88, v88, v2
    ds_add_rtn_u32 v89, v89, v2
    ds_add_rtn_u32 v90, v90, v2
    ds_add_rtn_u32 v91, v91, v2
    ds_add_rtn_u32 v92, v92, v2
    ds_add_rtn_u32 v93, v93, v2
    ds_add_rtn_u32 v94, v94, v2
    ds_add_rtn_u32 v95, v95, v2
    s_waitcnt lgkmcnt(0)
    s_barrier
    s_setprio 3
    v_and_b32 v7, -4, v24
    v_lshl_add_u32 v8, v24, 2, v7
    ds_write_b32 v8, v40
    v_lshl_add_u32 v7, v7, 2, v24
    ds_write_b8 v7, v84 offset:16
    v_and_b32 v9, -4, v25
    v_lshl_add_u32 v10, v25, 2, v9
    ds_write_b32 v10, v41
    v_lshl_add_u32 v9, v9, 2, v25
    ds_write_b8_d16_hi v9, v84 offset:16
    v_and_b32 v7, -4, v26
    v_lshl_add_u32 v8, v26, 2, v7
    ds_write_b32 v8, v42
    v_lshl_add_u32 v7, v7, 2, v26
    ds_write_b8 v7, v85 offset:16
    v_and_b32 v9, -4, v27
    v_lshl_add_u32 v10, v27, 2, v9
    ds_write_b32 v10, v43
    v_lshl_add_u32 v9, v9, 2, v27
    ds_write_b8_d16_hi v9, v85 offset:16
    s_add_u32 s45, s35, 0x5488000
    s_add_u32 s45, s45, s85
    buffer_store_dwordx4 v[32:35], v0, s[20:23], s45 offen sc1
    s_add_u32 s46, s96, 0x8800000
    v_lshlrev_b32 v40, 1, v1
    buffer_load_dwordx4 v[40:43], v40, s[8:11], s46 offen nt
    s_add_u32 s47, s96, 0x8800000
    v_lshlrev_b32 v24, 1, v1
    buffer_load_dwordx4 v[24:27], v24, s[12:15], s47 offen nt
    v_and_b32 v7, -4, v52
    v_lshl_add_u32 v8, v52, 2, v7
    ds_write_b32 v8, v48
    v_lshl_add_u32 v7, v7, 2, v52
    ds_write_b8 v7, v86 offset:16
    v_and_b32 v9, -4, v53
    v_lshl_add_u32 v10, v53, 2, v9
    ds_write_b32 v10, v49
    v_lshl_add_u32 v9, v9, 2, v53
    ds_write_b8_d16_hi v9, v86 offset:16
    v_and_b32 v7, -4, v54
    v_lshl_add_u32 v8, v54, 2, v7
    ds_write_b32 v8, v50
    v_lshl_add_u32 v7, v7, 2, v54
    ds_write_b8 v7, v87 offset:16
    v_and_b32 v9, -4, v55
    v_lshl_add_u32 v10, v55, 2, v9
    ds_write_b32 v10, v51
    v_lshl_add_u32 v9, v9, 2, v55
    ds_write_b8_d16_hi v9, v87 offset:16
    s_add_u32 s44, s96, 0x8800000
    s_lshr_b32 s44, s44, 1
    buffer_load_dwordx2 v[32:33], v1, s[16:19], s44 offen nt
    s_add_u32 s45, s96, 0x8c00000
    s_lshr_b32 s45, s45, 1
    buffer_load_dwordx2 v[34:35], v1, s[16:19], s45 offen nt
    s_add_u32 s46, s96, 0x8c00000
    v_lshlrev_b32 v48, 1, v1
    buffer_load_dwordx4 v[48:51], v48, s[8:11], s46 offen nt
    s_waitcnt vmcnt(10)
    v_lshlrev_b32 v7, 16, v44
    v_and_b32 v8, 0xffff0000, v44
    v_lshlrev_b32 v9, 16, v45
    v_and_b32 v10, 0xffff0000, v45
    v_mul_f32 v7, 0.15915494, v7
    v_mul_f32 v8, 0.15915494, v8
    v_mul_f32 v9, 0.15915494, v9
    v_mul_f32 v10, 0.15915494, v10
    v_mul_hi_u32_u24 v14, 429497, v16
    v_lshrrev_b32 v12, 3, v120
    v_cos_f32 v7, v7
    v_lshlrev_b16 v13, 3, v120
    v_mad_i32_i24 v11, v14, s55, v16
    v_bitop3_b32 v12, v6, v13, v12 bitop3:0xca
    v_lshl_add_u32 v11, v11, 17, s40
    v_lshlrev_b16 v14, 8, v14
    v_lshrrev_b32 v13, 2, v120
    v_add_u32 v16, v12, v11
    v_bitop3_b32 v120, v5, v13, v14 bitop3:0xea
    v_mul_hi_u32_u24 v14, 429497, v17
    v_lshrrev_b32 v12, 3, v121
    v_cos_f32 v8, v8
    v_lshlrev_b16 v13, 3, v121
    v_mad_i32_i24 v11, v14, s55, v17
    v_bitop3_b32 v12, v6, v13, v12 bitop3:0xca
    v_lshl_add_u32 v11, v11, 17, s40
    v_lshlrev_b16 v14, 8, v14
    v_lshrrev_b32 v13, 2, v121
    v_add_u32 v17, v12, v11
    v_bitop3_b32 v121, v5, v13, v14 bitop3:0xea
    v_cvt_pk_bf16_f32 v44, v7, v8
    v_perm_b32 v12, v44, v44, s41
    v_bitop3_b32 v16, v4, v12, v16 bitop3:0xca
    v_perm_b32 v13, v44, v44, s42
    v_bitop3_b32 v17, v4, v13, v17 bitop3:0xca
    v_mul_hi_u32_u24 v14, 429497, v18
    v_lshrrev_b32 v12, 3, v122
    v_cos_f32 v9, v9
    v_lshlrev_b16 v13, 3, v122
    v_mad_i32_i24 v11, v14, s55, v18
    v_bitop3_b32 v12, v6, v13, v12 bitop3:0xca
    v_lshl_add_u32 v11, v11, 17, s40
    v_lshlrev_b16 v14, 8, v14
    v_lshrrev_b32 v13, 2, v122
    v_add_u32 v18, v12, v11
    v_bitop3_b32 v122, v5, v13, v14 bitop3:0xea
    v_mul_hi_u32_u24 v14, 429497, v19
    v_lshrrev_b32 v12, 3, v123
    v_cos_f32 v10, v10
    v_lshlrev_b16 v13, 3, v123
    v_mad_i32_i24 v11, v14, s55, v19
    v_bitop3_b32 v12, v6, v13, v12 bitop3:0xca
    v_lshl_add_u32 v11, v11, 17, s40
    v_lshlrev_b16 v14, 8, v14
    v_lshrrev_b32 v13, 2, v123
    v_add_u32 v19, v12, v11
    v_bitop3_b32 v123, v5, v13, v14 bitop3:0xea
    v_cvt_pk_bf16_f32 v45, v9, v10
    v_perm_b32 v12, v45, v45, s41
    v_bitop3_b32 v18, v4, v12, v18 bitop3:0xca
    v_perm_b32 v13, v45, v45, s42
    v_bitop3_b32 v19, v4, v13, v19 bitop3:0xca
    s_setprio 2
    v_and_b32 v7, -4, v72
    v_lshl_add_u32 v8, v72, 2, v7
    ds_write_b32 v8, v68
    v_lshl_add_u32 v7, v7, 2, v72
    ds_write_b8 v7, v56 offset:16
    v_and_b32 v9, -4, v73
    v_lshl_add_u32 v10, v73, 2, v9
    ds_write_b32 v10, v69
    v_lshl_add_u32 v9, v9, 2, v73
    ds_write_b8_d16_hi v9, v56 offset:16
    v_and_b32 v7, -4, v74
    v_lshl_add_u32 v8, v74, 2, v7
    ds_write_b32 v8, v70
    v_lshl_add_u32 v7, v7, 2, v74
    ds_write_b8 v7, v57 offset:16
    v_and_b32 v9, -4, v75
    v_lshl_add_u32 v10, v75, 2, v9
    ds_write_b32 v10, v71
    v_lshl_add_u32 v9, v9, 2, v75
    ds_write_b8_d16_hi v9, v57 offset:16
    s_add_u32 s47, s35, 0x5488000
    s_add_u32 s47, s47, s91
    buffer_store_dwordx4 v[36:39], v0, s[20:23], s47 offen sc1
    s_add_u32 s44, s96, 0x8c00000
    v_lshlrev_b32 v52, 1, v1
    buffer_load_dwordx4 v[52:55], v52, s[12:15], s44 offen nt
    s_waitcnt vmcnt(8)
    v_lshlrev_b32 v7, 16, v46
    v_and_b32 v8, 0xffff0000, v46
    v_lshlrev_b32 v9, 16, v47
    v_and_b32 v10, 0xffff0000, v47
    v_mul_f32 v7, 0.15915494, v7
    v_mul_f32 v8, 0.15915494, v8
    v_mul_f32 v9, 0.15915494, v9
    v_mul_f32 v10, 0.15915494, v10
    v_mul_hi_u32_u24 v14, 429497, v20
    v_lshrrev_b32 v12, 3, v124
    v_cos_f32 v7, v7
    v_lshlrev_b16 v13, 3, v124
    v_mad_i32_i24 v11, v14, s55, v20
    v_bitop3_b32 v12, v6, v13, v12 bitop3:0xca
    v_lshl_add_u32 v11, v11, 17, s40
    v_lshlrev_b16 v14, 8, v14
    v_lshrrev_b32 v13, 2, v124
    v_add_u32 v20, v12, v11
    v_bitop3_b32 v124, v5, v13, v14 bitop3:0xea
    v_mul_hi_u32_u24 v14, 429497, v21
    v_lshrrev_b32 v12, 3, v125
    v_cos_f32 v8, v8
    v_lshlrev_b16 v13, 3, v125
    v_mad_i32_i24 v11, v14, s55, v21
    v_bitop3_b32 v12, v6, v13, v12 bitop3:0xca
    v_lshl_add_u32 v11, v11, 17, s40
    v_lshlrev_b16 v14, 8, v14
    v_lshrrev_b32 v13, 2, v125
    v_add_u32 v21, v12, v11
    v_bitop3_b32 v125, v5, v13, v14 bitop3:0xea
    v_cvt_pk_bf16_f32 v46, v7, v8
    v_perm_b32 v12, v46, v46, s41
    v_bitop3_b32 v20, v4, v12, v20 bitop3:0xca
    v_perm_b32 v13, v46, v46, s42
    v_bitop3_b32 v21, v4, v13, v21 bitop3:0xca
    v_mul_hi_u32_u24 v14, 429497, v22
    v_lshrrev_b32 v12, 3, v126
    v_cos_f32 v9, v9
    v_lshlrev_b16 v13, 3, v126
    v_mad_i32_i24 v11, v14, s55, v22
    v_bitop3_b32 v12, v6, v13, v12 bitop3:0xca
    v_lshl_add_u32 v11, v11, 17, s40
    v_lshlrev_b16 v14, 8, v14
    v_lshrrev_b32 v13, 2, v126
    v_add_u32 v22, v12, v11
    v_bitop3_b32 v126, v5, v13, v14 bitop3:0xea
    v_mul_hi_u32_u24 v14, 429497, v23
    v_lshrrev_b32 v12, 3, v127
    v_cos_f32 v10, v10
    v_lshlrev_b16 v13, 3, v127
    v_mad_i32_i24 v11, v14, s55, v23
    v_bitop3_b32 v12, v6, v13, v12 bitop3:0xca
    v_lshl_add_u32 v11, v11, 17, s40
    v_lshlrev_b16 v14, 8, v14
    v_lshrrev_b32 v13, 2, v127
    v_add_u32 v23, v12, v11
    v_bitop3_b32 v127, v5, v13, v14 bitop3:0xea
    v_cvt_pk_bf16_f32 v47, v9, v10
    v_perm_b32 v12, v47, v47, s41
    v_bitop3_b32 v22, v4, v12, v22 bitop3:0xca
    v_perm_b32 v13, v47, v47, s42
    v_bitop3_b32 v23, v4, v13, v23 bitop3:0xca
    v_and_b32 v7, -4, v80
    v_lshl_add_u32 v8, v80, 2, v7
    ds_write_b32 v8, v76
    v_lshl_add_u32 v7, v7, 2, v80
    ds_write_b8 v7, v58 offset:16
    v_and_b32 v9, -4, v81
    v_lshl_add_u32 v10, v81, 2, v9
    ds_write_b32 v10, v77
    v_lshl_add_u32 v9, v9, 2, v81
    ds_write_b8_d16_hi v9, v58 offset:16
    v_and_b32 v7, -4, v82
    v_lshl_add_u32 v8, v82, 2, v7
    ds_write_b32 v8, v78
    v_lshl_add_u32 v7, v7, 2, v82
    ds_write_b8 v7, v59 offset:16
    v_and_b32 v9, -4, v83
    v_lshl_add_u32 v10, v83, 2, v9
    ds_write_b32 v10, v79
    v_lshl_add_u32 v9, v9, 2, v83
    ds_write_b8_d16_hi v9, v59 offset:16
    s_add_u32 s45, s96, 0x9000000
    v_lshlrev_b32 v84, 1, v1
    buffer_load_dwordx4 v[84:87], v84, s[8:11], s45 offen nt
    s_add_u32 s46, s96, 0x9000000
    v_lshlrev_b32 v68, 1, v1
    buffer_load_dwordx4 v[68:71], v68, s[12:15], s46 offen nt
    s_waitcnt vmcnt(5)
    v_lshlrev_b32 v7, 16, v32
    v_and_b32 v8, 0xffff0000, v32
    v_lshlrev_b32 v9, 16, v33
    v_and_b32 v10, 0xffff0000, v33
    v_mul_f32 v7, 0.15915494, v7
    v_mul_f32 v8, 0.15915494, v8
    v_mul_f32 v9, 0.15915494, v9
    v_mul_f32 v10, 0.15915494, v10
    v_mul_hi_u32_u24 v14, 429497, v40
    v_lshrrev_b32 v12, 3, v24
    v_cos_f32 v7, v7
    v_lshlrev_b16 v13, 3, v24
    v_mad_i32_i24 v11, v14, s55, v40
    v_bitop3_b32 v12, v6, v13, v12 bitop3:0xca
    v_lshl_add_u32 v11, v11, 17, s40
    v_lshlrev_b16 v14, 8, v14
    v_lshrrev_b32 v13, 2, v24
    v_add_u32 v40, v12, v11
    v_bitop3_b32 v24, v5, v13, v14 bitop3:0xea
    v_mul_hi_u32_u24 v14, 429497, v41
    v_lshrrev_b32 v12, 3, v25
    v_cos_f32 v8, v8
    v_lshlrev_b16 v13, 3, v25
    v_mad_i32_i24 v11, v14, s55, v41
    v_bitop3_b32 v12, v6, v13, v12 bitop3:0xca
    v_lshl_add_u32 v11, v11, 17, s40
    v_lshlrev_b16 v14, 8, v14
    v_lshrrev_b32 v13, 2, v25
    v_add_u32 v41, v12, v11
    v_bitop3_b32 v25, v5, v13, v14 bitop3:0xea
    v_cvt_pk_bf16_f32 v32, v7, v8
    v_perm_b32 v12, v32, v32, s41
    v_bitop3_b32 v40, v4, v12, v40 bitop3:0xca
    v_perm_b32 v13, v32, v32, s42
    v_bitop3_b32 v41, v4, v13, v41 bitop3:0xca
    v_mul_hi_u32_u24 v14, 429497, v42
    v_lshrrev_b32 v12, 3, v26
    v_cos_f32 v9, v9
    v_lshlrev_b16 v13, 3, v26
    v_mad_i32_i24 v11, v14, s55, v42
    v_bitop3_b32 v12, v6, v13, v12 bitop3:0xca
    v_lshl_add_u32 v11, v11, 17, s40
    v_lshlrev_b16 v14, 8, v14
    v_lshrrev_b32 v13, 2, v26
    v_add_u32 v42, v12, v11
    v_bitop3_b32 v26, v5, v13, v14 bitop3:0xea
    v_mul_hi_u32_u24 v14, 429497, v43
    v_lshrrev_b32 v12, 3, v27
    v_cos_f32 v10, v10
    v_lshlrev_b16 v13, 3, v27
    v_mad_i32_i24 v11, v14, s55, v43
    v_bitop3_b32 v12, v6, v13, v12 bitop3:0xca
    v_lshl_add_u32 v11, v11, 17, s40
    v_lshlrev_b16 v14, 8, v14
    v_lshrrev_b32 v13, 2, v27
    v_add_u32 v43, v12, v11
    v_bitop3_b32 v27, v5, v13, v14 bitop3:0xea
    v_cvt_pk_bf16_f32 v33, v9, v10
    v_perm_b32 v12, v33, v33, s41
    v_bitop3_b32 v42, v4, v12, v42 bitop3:0xca
    v_perm_b32 v13, v33, v33, s42
    v_bitop3_b32 v43, v4, v13, v43 bitop3:0xca
    s_setprio 1
    v_and_b32 v7, -4, v96
    v_lshl_add_u32 v8, v96, 2, v7
    ds_write_b32 v8, v64
    v_lshl_add_u32 v7, v7, 2, v96
    ds_write_b8 v7, v104 offset:16
    v_and_b32 v9, -4, v97
    v_lshl_add_u32 v10, v97, 2, v9
    ds_write_b32 v10, v65
    v_lshl_add_u32 v9, v9, 2, v97
    ds_write_b8_d16_hi v9, v104 offset:16
    v_and_b32 v7, -4, v98
    v_lshl_add_u32 v8, v98, 2, v7
    ds_write_b32 v8, v66
    v_lshl_add_u32 v7, v7, 2, v98
    ds_write_b8 v7, v105 offset:16
    v_and_b32 v9, -4, v99
    v_lshl_add_u32 v10, v99, 2, v9
    ds_write_b32 v10, v67
    v_lshl_add_u32 v9, v9, 2, v99
    ds_write_b8_d16_hi v9, v105 offset:16
    s_add_u32 s47, s96, 0x9000000
    s_lshr_b32 s47, s47, 1
    buffer_load_dwordx2 v[72:73], v1, s[16:19], s47 offen nt
    s_cmp_le_u32 s43, 5
    s_cselect_b32 s18, 0, s18
    s_add_u32 s44, s38, 0x0
    s_lshr_b32 s44, s44, 1
    buffer_load_dwordx2 v[74:75], v1, s[16:19], s44 offen nt
    s_cmp_le_u32 s43, 5
    s_cselect_b32 s10, 0, s10
    s_add_u32 s45, s38, 0x0
    v_lshlrev_b32 v36, 1, v1
    buffer_load_dwordx4 v[36:39], v36, s[8:11], s45 offen nt
    v_and_b32 v7, -4, v100
    v_lshl_add_u32 v8, v100, 2, v7
    ds_write_b32 v8, v60
    v_lshl_add_u32 v7, v7, 2, v100
    ds_write_b8 v7, v106 offset:16
    v_and_b32 v9, -4, v101
    v_lshl_add_u32 v10, v101, 2, v9
    ds_write_b32 v10, v61
    v_lshl_add_u32 v9, v9, 2, v101
    ds_write_b8_d16_hi v9, v106 offset:16
    v_and_b32 v7, -4, v102
    v_lshl_add_u32 v8, v102, 2, v7
    ds_write_b32 v8, v62
    v_lshl_add_u32 v7, v7, 2, v102
    ds_write_b8 v7, v107 offset:16
    v_and_b32 v9, -4, v103
    v_lshl_add_u32 v10, v103, 2, v9
    ds_write_b32 v10, v63
    v_lshl_add_u32 v9, v9, 2, v103
    ds_write_b8_d16_hi v9, v107 offset:16
    s_add_u32 s46, s35, 0x5488000
    s_add_u32 s46, s46, s93
    buffer_store_dwordx4 v[28:31], v0, s[20:23], s46 offen sc1
    s_cmp_le_u32 s43, 5
    s_cselect_b32 s14, 0, s14
    s_add_u32 s47, s38, 0x0
    v_lshlrev_b32 v76, 1, v1
    buffer_load_dwordx4 v[76:79], v76, s[12:15], s47 offen nt
    s_waitcnt vmcnt(7)
    v_lshlrev_b32 v7, 16, v34
    v_and_b32 v8, 0xffff0000, v34
    v_lshlrev_b32 v9, 16, v35
    v_and_b32 v10, 0xffff0000, v35
    v_mul_f32 v7, 0.15915494, v7
    v_mul_f32 v8, 0.15915494, v8
    v_mul_f32 v9, 0.15915494, v9
    v_mul_f32 v10, 0.15915494, v10
    v_mul_hi_u32_u24 v14, 429497, v48
    v_lshrrev_b32 v12, 3, v52
    v_cos_f32 v7, v7
    v_lshlrev_b16 v13, 3, v52
    v_mad_i32_i24 v11, v14, s55, v48
    v_bitop3_b32 v12, v6, v13, v12 bitop3:0xca
    v_lshl_add_u32 v11, v11, 17, s40
    v_lshlrev_b16 v14, 8, v14
    v_lshrrev_b32 v13, 2, v52
    v_add_u32 v48, v12, v11
    v_bitop3_b32 v52, v5, v13, v14 bitop3:0xea
    v_mul_hi_u32_u24 v14, 429497, v49
    v_lshrrev_b32 v12, 3, v53
    v_cos_f32 v8, v8
    v_lshlrev_b16 v13, 3, v53
    v_mad_i32_i24 v11, v14, s55, v49
    v_bitop3_b32 v12, v6, v13, v12 bitop3:0xca
    v_lshl_add_u32 v11, v11, 17, s40
    v_lshlrev_b16 v14, 8, v14
    v_lshrrev_b32 v13, 2, v53
    v_add_u32 v49, v12, v11
    v_bitop3_b32 v53, v5, v13, v14 bitop3:0xea
    v_cvt_pk_bf16_f32 v34, v7, v8
    v_perm_b32 v12, v34, v34, s41
    v_bitop3_b32 v48, v4, v12, v48 bitop3:0xca
    v_perm_b32 v13, v34, v34, s42
    v_bitop3_b32 v49, v4, v13, v49 bitop3:0xca
    v_mul_hi_u32_u24 v14, 429497, v50
    v_lshrrev_b32 v12, 3, v54
    v_cos_f32 v9, v9
    v_lshlrev_b16 v13, 3, v54
    v_mad_i32_i24 v11, v14, s55, v50
    v_bitop3_b32 v12, v6, v13, v12 bitop3:0xca
    v_lshl_add_u32 v11, v11, 17, s40
    v_lshlrev_b16 v14, 8, v14
    v_lshrrev_b32 v13, 2, v54
    v_add_u32 v50, v12, v11
    v_bitop3_b32 v54, v5, v13, v14 bitop3:0xea
    v_mul_hi_u32_u24 v14, 429497, v51
    v_lshrrev_b32 v12, 3, v55
    v_cos_f32 v10, v10
    v_lshlrev_b16 v13, 3, v55
    v_mad_i32_i24 v11, v14, s55, v51
    v_bitop3_b32 v12, v6, v13, v12 bitop3:0xca
    v_lshl_add_u32 v11, v11, 17, s40
    v_lshlrev_b16 v14, 8, v14
    v_lshrrev_b32 v13, 2, v55
    v_add_u32 v51, v12, v11
    v_bitop3_b32 v55, v5, v13, v14 bitop3:0xea
    v_cvt_pk_bf16_f32 v35, v9, v10
    v_perm_b32 v12, v35, v35, s41
    v_bitop3_b32 v50, v4, v12, v50 bitop3:0xca
    v_perm_b32 v13, v35, v35, s42
    v_bitop3_b32 v51, v4, v13, v51 bitop3:0xca
    s_setprio 0
    v_and_b32 v7, -4, v88
    v_lshl_add_u32 v8, v88, 2, v7
    ds_write_b32 v8, v112
    v_lshl_add_u32 v7, v7, 2, v88
    ds_write_b8 v7, v108 offset:16
    v_and_b32 v9, -4, v89
    v_lshl_add_u32 v10, v89, 2, v9
    ds_write_b32 v10, v113
    v_lshl_add_u32 v9, v9, 2, v89
    ds_write_b8_d16_hi v9, v108 offset:16
    v_and_b32 v7, -4, v90
    v_lshl_add_u32 v8, v90, 2, v7
    ds_write_b32 v8, v114
    v_lshl_add_u32 v7, v7, 2, v90
    ds_write_b8 v7, v109 offset:16
    v_and_b32 v9, -4, v91
    v_lshl_add_u32 v10, v91, 2, v9
    ds_write_b32 v10, v115
    v_lshl_add_u32 v9, v9, 2, v91
    ds_write_b8_d16_hi v9, v109 offset:16
    s_cmp_le_u32 s43, 6
    s_cselect_b32 s10, 0, s10
    s_add_u32 s44, s39, 0x0
    v_lshlrev_b32 v80, 1, v1
    buffer_load_dwordx4 v[80:83], v80, s[8:11], s44 offen nt
    s_cmp_le_u32 s43, 6
    s_cselect_b32 s14, 0, s14
    s_add_u32 s45, s39, 0x0
    v_lshlrev_b32 v56, 1, v1
    buffer_load_dwordx4 v[56:59], v56, s[12:15], s45 offen nt
    s_waitcnt vmcnt(5)
    v_lshlrev_b32 v7, 16, v72
    v_and_b32 v8, 0xffff0000, v72
    v_lshlrev_b32 v9, 16, v73
    v_and_b32 v10, 0xffff0000, v73
    v_mul_f32 v7, 0.15915494, v7
    v_mul_f32 v8, 0.15915494, v8
    v_mul_f32 v9, 0.15915494, v9
    v_mul_f32 v10, 0.15915494, v10
    v_mul_hi_u32_u24 v14, 429497, v84
    v_lshrrev_b32 v12, 3, v68
    v_cos_f32 v7, v7
    v_lshlrev_b16 v13, 3, v68
    v_mad_i32_i24 v11, v14, s55, v84
    v_bitop3_b32 v12, v6, v13, v12 bitop3:0xca
    v_lshl_add_u32 v11, v11, 17, s40
    v_lshlrev_b16 v14, 8, v14
    v_lshrrev_b32 v13, 2, v68
    v_add_u32 v84, v12, v11
    v_bitop3_b32 v68, v5, v13, v14 bitop3:0xea
    v_mul_hi_u32_u24 v14, 429497, v85
    v_lshrrev_b32 v12, 3, v69
    v_cos_f32 v8, v8
    v_lshlrev_b16 v13, 3, v69
    v_mad_i32_i24 v11, v14, s55, v85
    v_bitop3_b32 v12, v6, v13, v12 bitop3:0xca
    v_lshl_add_u32 v11, v11, 17, s40
    v_lshlrev_b16 v14, 8, v14
    v_lshrrev_b32 v13, 2, v69
    v_add_u32 v85, v12, v11
    v_bitop3_b32 v69, v5, v13, v14 bitop3:0xea
    v_cvt_pk_bf16_f32 v72, v7, v8
    v_perm_b32 v12, v72, v72, s41
    v_bitop3_b32 v84, v4, v12, v84 bitop3:0xca
    v_perm_b32 v13, v72, v72, s42
    v_bitop3_b32 v85, v4, v13, v85 bitop3:0xca
    v_mul_hi_u32_u24 v14, 429497, v86
    v_lshrrev_b32 v12, 3, v70
    v_cos_f32 v9, v9
    v_lshlrev_b16 v13, 3, v70
    v_mad_i32_i24 v11, v14, s55, v86
    v_bitop3_b32 v12, v6, v13, v12 bitop3:0xca
    v_lshl_add_u32 v11, v11, 17, s40
    v_lshlrev_b16 v14, 8, v14
    v_lshrrev_b32 v13, 2, v70
    v_add_u32 v86, v12, v11
    v_bitop3_b32 v70, v5, v13, v14 bitop3:0xea
    v_mul_hi_u32_u24 v14, 429497, v87
    v_lshrrev_b32 v12, 3, v71
    v_cos_f32 v10, v10
    v_lshlrev_b16 v13, 3, v71
    v_mad_i32_i24 v11, v14, s55, v87
    v_bitop3_b32 v12, v6, v13, v12 bitop3:0xca
    v_lshl_add_u32 v11, v11, 17, s40
    v_lshlrev_b16 v14, 8, v14
    v_lshrrev_b32 v13, 2, v71
    v_add_u32 v87, v12, v11
    v_bitop3_b32 v71, v5, v13, v14 bitop3:0xea
    v_cvt_pk_bf16_f32 v73, v9, v10
    v_perm_b32 v12, v73, v73, s41
    v_bitop3_b32 v86, v4, v12, v86 bitop3:0xca
    v_perm_b32 v13, v73, v73, s42
    v_bitop3_b32 v87, v4, v13, v87 bitop3:0xca
    v_and_b32 v7, -4, v92
    v_lshl_add_u32 v8, v92, 2, v7
    ds_write_b32 v8, v116
    v_lshl_add_u32 v7, v7, 2, v92
    ds_write_b8 v7, v110 offset:16
    v_and_b32 v9, -4, v93
    v_lshl_add_u32 v10, v93, 2, v9
    ds_write_b32 v10, v117
    v_lshl_add_u32 v9, v9, 2, v93
    ds_write_b8_d16_hi v9, v110 offset:16
    v_and_b32 v7, -4, v94
    v_lshl_add_u32 v8, v94, 2, v7
    ds_write_b32 v8, v118
    v_lshl_add_u32 v7, v7, 2, v94
    ds_write_b8 v7, v111 offset:16
    v_and_b32 v9, -4, v95
    v_lshl_add_u32 v10, v95, 2, v9
    ds_write_b32 v10, v119
    v_lshl_add_u32 v9, v9, 2, v95
    ds_write_b8_d16_hi v9, v111 offset:16
    s_cmp_le_u32 s43, 6
    s_cselect_b32 s18, 0, s18
    s_add_u32 s46, s39, 0x0
    s_lshr_b32 s46, s46, 1
    buffer_load_dwordx2 v[64:65], v1, s[16:19], s46 offen nt
    s_cmp_le_u32 s43, 7
    s_cselect_b32 s18, 0, s18
    s_add_u32 s47, s58, 0x0
    s_lshr_b32 s47, s47, 1
    buffer_load_dwordx2 v[66:67], v1, s[16:19], s47 offen nt
    s_waitcnt vmcnt(4)
    s_cmp_le_u32 s43, 5
    s_cbranch_scc1 L1_s5
    v_lshlrev_b32 v7, 16, v74
    v_and_b32 v8, 0xffff0000, v74
    v_lshlrev_b32 v9, 16, v75
    v_and_b32 v10, 0xffff0000, v75
    v_mul_f32 v7, 0.15915494, v7
    v_mul_f32 v8, 0.15915494, v8
    v_mul_f32 v9, 0.15915494, v9
    v_mul_f32 v10, 0.15915494, v10
    v_mul_hi_u32_u24 v14, 429497, v36
    v_lshrrev_b32 v12, 3, v76
    v_cos_f32 v7, v7
    v_lshlrev_b16 v13, 3, v76
    v_mad_i32_i24 v11, v14, s55, v36
    v_bitop3_b32 v12, v6, v13, v12 bitop3:0xca
    v_lshl_add_u32 v11, v11, 17, s40
    v_lshlrev_b16 v14, 8, v14
    v_lshrrev_b32 v13, 2, v76
    v_add_u32 v36, v12, v11
    v_bitop3_b32 v76, v5, v13, v14 bitop3:0xea
    v_mul_hi_u32_u24 v14, 429497, v37
    v_lshrrev_b32 v12, 3, v77
    v_cos_f32 v8, v8
    v_lshlrev_b16 v13, 3, v77
    v_mad_i32_i24 v11, v14, s55, v37
    v_bitop3_b32 v12, v6, v13, v12 bitop3:0xca
    v_lshl_add_u32 v11, v11, 17, s40
    v_lshlrev_b16 v14, 8, v14
    v_lshrrev_b32 v13, 2, v77
    v_add_u32 v37, v12, v11
    v_bitop3_b32 v77, v5, v13, v14 bitop3:0xea
    v_cvt_pk_bf16_f32 v74, v7, v8
    v_perm_b32 v12, v74, v74, s41
    v_bitop3_b32 v36, v4, v12, v36 bitop3:0xca
    v_perm_b32 v13, v74, v74, s42
    v_bitop3_b32 v37, v4, v13, v37 bitop3:0xca
    v_mul_hi_u32_u24 v14, 429497, v38
    v_lshrrev_b32 v12, 3, v78
    v_cos_f32 v9, v9
    v_lshlrev_b16 v13, 3, v78
    v_mad_i32_i24 v11, v14, s55, v38
    v_bitop3_b32 v12, v6, v13, v12 bitop3:0xca
    v_lshl_add_u32 v11, v11, 17, s40
    v_lshlrev_b16 v14, 8, v14
    v_lshrrev_b32 v13, 2, v78
    v_add_u32 v38, v12, v11
    v_bitop3_b32 v78, v5, v13, v14 bitop3:0xea
    v_mul_hi_u32_u24 v14, 429497, v39
    v_lshrrev_b32 v12, 3, v79
    v_cos_f32 v10, v10
    v_lshlrev_b16 v13, 3, v79
    v_mad_i32_i24 v11, v14, s55, v39
    v_bitop3_b32 v12, v6, v13, v12 bitop3:0xca
    v_lshl_add_u32 v11, v11, 17, s40
    v_lshlrev_b16 v14, 8, v14
    v_lshrrev_b32 v13, 2, v79
    v_add_u32 v39, v12, v11
    v_bitop3_b32 v79, v5, v13, v14 bitop3:0xea
    v_cvt_pk_bf16_f32 v75, v9, v10
    v_perm_b32 v12, v75, v75, s41
    v_bitop3_b32 v38, v4, v12, v38 bitop3:0xca
    v_perm_b32 v13, v75, v75, s42
    v_bitop3_b32 v39, v4, v13, v39 bitop3:0xca
L1_s5:
    v_add_u32 v7, s72, v0
    v_add_u32 v12, s73, v0
    v_add_u32 v13, s85, v0
    v_add_u32 v14, s91, v0
    v_add_u32 v15, s93, v0
    s_min_i32 s3, s72, s73
    s_min_i32 s3, s3, s85
    s_min_i32 s3, s3, s91
    s_min_i32 s3, s3, s93
    v_add_u32 v3, s3, v0
    v_mov_b32 v8, 0
    v_mov_b32 v9, 0
    v_mov_b32 v10, 0
    v_mov_b32 v11, 0
    s_waitcnt lgkmcnt(0)
    s_barrier
    ds_read_b128 v[96:99], v7 offset:0
    ds_read_b128 v[60:63], v12 offset:0
    ds_read_b128 v[100:103], v13 offset:0
    ds_read_b128 v[104:107], v14 offset:0
    ds_read_b128 v[28:31], v15 offset:0
    ds_write_b128 v3, v[8:11]
    ds_read_b128 v[112:115], v7 offset:16384
    ds_read_b128 v[88:91], v12 offset:16384
    ds_read_b128 v[116:119], v13 offset:16384
    ds_read_b128 v[92:95], v14 offset:16384
    ds_read_b128 v[108:111], v15 offset:16384
    s_waitcnt lgkmcnt(0)
    s_barrier
    v_lshlrev_b32 v3, 3, v0
    v_and_b32 v3, 0x80, v3
    s_cmp_lg_u32 s32, 15
    s_cbranch_scc1 L2_k0
    s_mov_b64 exec, 3
    buffer_load_dword v3, v3, s[68:71], 0 offen sc1
    s_mov_b64 exec, -1
L2_k0:
    s_add_u32 s44, s35, 0x7ec4000
    s_add_u32 s44, s44, s72
    buffer_store_dwordx4 v[96:99], v0, s[20:23], s44 offen sc1
    s_cmp_le_u32 s43, 7
    s_cselect_b32 s10, 0, s10
    s_add_u32 s45, s58, 0x0
    v_lshlrev_b32 v96, 1, v1
    buffer_load_dwordx4 v[96:99], v96, s[8:11], s45 offen nt
    s_add_u32 s46, s35, 0x7ec4000
    s_add_u32 s46, s46, s73
    buffer_store_dwordx4 v[60:63], v0, s[20:23], s46 offen sc1
    s_cmp_le_u32 s43, 7
    s_cselect_b32 s14, 0, s14
    s_add_u32 s47, s58, 0x0
    v_lshlrev_b32 v60, 1, v1
    buffer_load_dwordx4 v[60:63], v60, s[12:15], s47 offen nt
    s_setprio 3
    ds_add_u32 v120, v2
    ds_add_u32 v121, v2
    ds_add_u32 v122, v2
    ds_add_u32 v123, v2
    ds_add_u32 v124, v2
    ds_add_u32 v125, v2
    ds_add_u32 v126, v2
    ds_add_u32 v127, v2
    s_setprio 2
    s_add_u32 s44, s35, 0x7ec4000
    s_add_u32 s44, s44, s85
    buffer_store_dwordx4 v[100:103], v0, s[20:23], s44 offen sc1
    ds_add_u32 v24, v2
    ds_add_u32 v25, v2
    ds_add_u32 v26, v2
    ds_add_u32 v27, v2
    ds_add_u32 v52, v2
    ds_add_u32 v53, v2
    ds_add_u32 v54, v2
    ds_add_u32 v55, v2
    s_setprio 1
    ds_add_u32 v68, v2
    ds_add_u32 v69, v2
    ds_add_u32 v70, v2
    ds_add_u32 v71, v2
    s_add_u32 s45, s35, 0x7ec4000
    s_add_u32 s45, s45, s91
    buffer_store_dwordx4 v[104:107], v0, s[20:23], s45 offen sc1
    s_cmp_le_u32 s43, 5
    s_cbranch_scc1 L1_s6
    ds_add_u32 v76, v2
    ds_add_u32 v77, v2
    ds_add_u32 v78, v2
    ds_add_u32 v79, v2
L1_s6:
    s_setprio 0
    s_waitcnt vmcnt(6)
    s_cmp_le_u32 s43, 6
    s_cbranch_scc1 L1_s7
    v_lshlrev_b32 v7, 16, v64
    v_and_b32 v8, 0xffff0000, v64
    v_lshlrev_b32 v9, 16, v65
    v_and_b32 v10, 0xffff0000, v65
    v_mul_f32 v7, 0.15915494, v7
    v_mul_f32 v8, 0.15915494, v8
    v_mul_f32 v9, 0.15915494, v9
    v_mul_f32 v10, 0.15915494, v10
    v_mul_hi_u32_u24 v14, 429497, v80
    v_lshrrev_b32 v12, 3, v56
    v_cos_f32 v7, v7
    v_lshlrev_b16 v13, 3, v56
    v_mad_i32_i24 v11, v14, s55, v80
    v_bitop3_b32 v12, v6, v13, v12 bitop3:0xca
    v_lshl_add_u32 v11, v11, 17, s40
    v_lshlrev_b16 v14, 8, v14
    v_lshrrev_b32 v13, 2, v56
    v_add_u32 v80, v12, v11
    v_bitop3_b32 v56, v5, v13, v14 bitop3:0xea
    ds_add_u32 v56, v2
    v_mul_hi_u32_u24 v14, 429497, v81
    v_lshrrev_b32 v12, 3, v57
    v_cos_f32 v8, v8
    v_lshlrev_b16 v13, 3, v57
    v_mad_i32_i24 v11, v14, s55, v81
    v_bitop3_b32 v12, v6, v13, v12 bitop3:0xca
    v_lshl_add_u32 v11, v11, 17, s40
    v_lshlrev_b16 v14, 8, v14
    v_lshrrev_b32 v13, 2, v57
    v_add_u32 v81, v12, v11
    v_bitop3_b32 v57, v5, v13, v14 bitop3:0xea
    ds_add_u32 v57, v2
    v_cvt_pk_bf16_f32 v64, v7, v8
    v_perm_b32 v12, v64, v64, s41
    v_bitop3_b32 v80, v4, v12, v80 bitop3:0xca
    v_perm_b32 v13, v64, v64, s42
    v_bitop3_b32 v81, v4, v13, v81 bitop3:0xca
    v_mul_hi_u32_u24 v14, 429497, v82
    v_lshrrev_b32 v12, 3, v58
    v_cos_f32 v9, v9
    v_lshlrev_b16 v13, 3, v58
    v_mad_i32_i24 v11, v14, s55, v82
    v_bitop3_b32 v12, v6, v13, v12 bitop3:0xca
    v_lshl_add_u32 v11, v11, 17, s40
    v_lshlrev_b16 v14, 8, v14
    v_lshrrev_b32 v13, 2, v58
    v_add_u32 v82, v12, v11
    v_bitop3_b32 v58, v5, v13, v14 bitop3:0xea
    ds_add_u32 v58, v2
    v_mul_hi_u32_u24 v14, 429497, v83
    v_lshrrev_b32 v12, 3, v59
    v_cos_f32 v10, v10
    v_lshlrev_b16 v13, 3, v59
    v_mad_i32_i24 v11, v14, s55, v83
    v_bitop3_b32 v12, v6, v13, v12 bitop3:0xca
    v_lshl_add_u32 v11, v11, 17, s40
    v_lshlrev_b16 v14, 8, v14
    v_lshrrev_b32 v13, 2, v59
    v_add_u32 v83, v12, v11
    v_bitop3_b32 v59, v5, v13, v14 bitop3:0xea
    ds_add_u32 v59, v2
    v_cvt_pk_bf16_f32 v65, v9, v10
    v_perm_b32 v12, v65, v65, s41
    v_bitop3_b32 v82, v4, v12, v82 bitop3:0xca
    v_perm_b32 v13, v65, v65, s42
    v_bitop3_b32 v83, v4, v13, v83 bitop3:0xca
L1_s7:
    s_waitcnt vmcnt(2)
    s_cmp_le_u32 s43, 7
    s_cbranch_scc1 L1_s8
    v_lshlrev_b32 v7, 16, v66
    v_and_b32 v8, 0xffff0000, v66
    v_lshlrev_b32 v9, 16, v67
    v_and_b32 v10, 0xffff0000, v67
    v_mul_f32 v7, 0.15915494, v7
    v_mul_f32 v8, 0.15915494, v8
    v_mul_f32 v9, 0.15915494, v9
    v_mul_f32 v10, 0.15915494, v10
    v_mul_hi_u32_u24 v14, 429497, v96
    v_lshrrev_b32 v12, 3, v60
    v_cos_f32 v7, v7
    v_lshlrev_b16 v13, 3, v60
    v_mad_i32_i24 v11, v14, s55, v96
    v_bitop3_b32 v12, v6, v13, v12 bitop3:0xca
    v_lshl_add_u32 v11, v11, 17, s40
    v_lshlrev_b16 v14, 8, v14
    v_lshrrev_b32 v13, 2, v60
    v_add_u32 v96, v12, v11
    v_bitop3_b32 v60, v5, v13, v14 bitop3:0xea
    ds_add_u32 v60, v2
    v_mul_hi_u32_u24 v14, 429497, v97
    v_lshrrev_b32 v12, 3, v61
    v_cos_f32 v8, v8
    v_lshlrev_b16 v13, 3, v61
    v_mad_i32_i24 v11, v14, s55, v97
    v_bitop3_b32 v12, v6, v13, v12 bitop3:0xca
    v_lshl_add_u32 v11, v11, 17, s40
    v_lshlrev_b16 v14, 8, v14
    v_lshrrev_b32 v13, 2, v61
    v_add_u32 v97, v12, v11
    v_bitop3_b32 v61, v5, v13, v14 bitop3:0xea
    ds_add_u32 v61, v2
    v_cvt_pk_bf16_f32 v66, v7, v8
    v_perm_b32 v12, v66, v66, s41
    v_bitop3_b32 v96, v4, v12, v96 bitop3:0xca
    v_perm_b32 v13, v66, v66, s42
    v_bitop3_b32 v97, v4, v13, v97 bitop3:0xca
    v_mul_hi_u32_u24 v14, 429497, v98
    v_lshrrev_b32 v12, 3, v62
    v_cos_f32 v9, v9
    v_lshlrev_b16 v13, 3, v62
    v_mad_i32_i24 v11, v14, s55, v98
    v_bitop3_b32 v12, v6, v13, v12 bitop3:0xca
    v_lshl_add_u32 v11, v11, 17, s40
    v_lshlrev_b16 v14, 8, v14
    v_lshrrev_b32 v13, 2, v62
    v_add_u32 v98, v12, v11
    v_bitop3_b32 v62, v5, v13, v14 bitop3:0xea
    ds_add_u32 v62, v2
    v_mul_hi_u32_u24 v14, 429497, v99
    v_lshrrev_b32 v12, 3, v63
    v_cos_f32 v10, v10
    v_lshlrev_b16 v13, 3, v63
    v_mad_i32_i24 v11, v14, s55, v99
    v_bitop3_b32 v12, v6, v13, v12 bitop3:0xca
    v_lshl_add_u32 v11, v11, 17, s40
    v_lshlrev_b16 v14, 8, v14
    v_lshrrev_b32 v13, 2, v63
    v_add_u32 v99, v12, v11
    v_bitop3_b32 v63, v5, v13, v14 bitop3:0xea
    ds_add_u32 v63, v2
    v_cvt_pk_bf16_f32 v67, v9, v10
    v_perm_b32 v12, v67, v67, s41
    v_bitop3_b32 v98, v4, v12, v98 bitop3:0xca
    v_perm_b32 v13, v67, v67, s42
    v_bitop3_b32 v99, v4, v13, v99 bitop3:0xca
L1_s8:
    v_lshrrev_b32 v8, 2, v0
    v_and_b32 v7, 0x3c00, v0
    v_bitop3_b32 v7, v5, v8, v7 bitop3:0xea
    s_waitcnt lgkmcnt(0)
    s_barrier
    ds_read2st64_b32 v[8:9], v7 offset0:0 offset1:1
    ds_read2st64_b32 v[10:11], v7 offset0:2 offset1:3
    s_waitcnt lgkmcnt(0)
    v_lshl_or_b32 v12, v9, 16, v8
    v_lshl_or_b32 v13, v11, 16, v10
    v_mov_b32 v14, v12
    v_mov_b32 v15, v13
    s_nop 0
    v_add_u32_dpp v14, v14, v14 row_shr:1 row_mask:0xf bank_mask:0xf bound_ctrl:1
    v_add_u32_dpp v15, v15, v15 row_shr:1 row_mask:0xf bank_mask:0xf bound_ctrl:1
    s_nop 0
    v_add_u32_dpp v14, v14, v14 row_shr:2 row_mask:0xf bank_mask:0xf bound_ctrl:1
    v_add_u32_dpp v15, v15, v15 row_shr:2 row_mask:0xf bank_mask:0xf bound_ctrl:1
    s_nop 0
    v_add_u32_dpp v14, v14, v14 row_shr:4 row_mask:0xf bank_mask:0xf bound_ctrl:1
    v_add_u32_dpp v15, v15, v15 row_shr:4 row_mask:0xf bank_mask:0xf bound_ctrl:1
    s_nop 0
    v_add_u32_dpp v14, v14, v14 row_shr:8 row_mask:0xf bank_mask:0xf bound_ctrl:1
    v_add_u32_dpp v15, v15, v15 row_shr:8 row_mask:0xf bank_mask:0xf bound_ctrl:1
    s_nop 0
    v_add_u32_dpp v14, v14, v14 row_bcast:15 row_mask:0xa bank_mask:0xf
    v_add_u32_dpp v15, v15, v15 row_bcast:15 row_mask:0xa bank_mask:0xf
    s_nop 0
    v_add_u32_dpp v14, v14, v14 row_bcast:31 row_mask:0xc bank_mask:0xf
    v_add_u32_dpp v15, v15, v15 row_bcast:31 row_mask:0xc bank_mask:0xf
    v_readlane_b32 s48, v14, 63
    v_readlane_b32 s49, v15, 63
    s_lshl_b32 s54, s32, 2
    v_mov_b32 v8, s54
    s_and_b32 s50, s48, 0xffff
    s_lshr_b32 s51, s48, 16
    s_and_b32 s52, s49, 0xffff
    s_lshr_b32 s53, s49, 16
    s_add_u32 s51, s51, s50
    s_add_u32 s52, s52, s51
    s_add_u32 s53, s53, s52
    v_mov_b32 v9, s53
    v_and_b32_dpp v3, v3, v3 quad_perm:[1,0,3,2] row_mask:0xf bank_mask:0xf
    s_mov_b64 exec, 1
    ds_write_b32 v8, v9 offset:16384
    ds_write_b32 v8, v3 offset:16448
    s_mov_b64 exec, -1
    v_and_b32 v8, 60, v7
    s_waitcnt lgkmcnt(0)
    s_barrier
    ds_read_b32 v9, v8 offset:16384
    ds_read_b32 v10, v8 offset:16448
    s_waitcnt lgkmcnt(0)
    v_readlane_b32 s56, v10, 15
    s_xor_b32 s56, s56, 0x80
    v_add_u32_dpp v9, v9, v9 row_shr:1 row_mask:0xf bank_mask:0xf bound_ctrl:1
    s_nop 1
    v_add_u32_dpp v9, v9, v9 row_shr:2 row_mask:0xf bank_mask:0xf bound_ctrl:1
    s_nop 1
    v_add_u32_dpp v9, v9, v9 row_shr:4 row_mask:0xf bank_mask:0xf bound_ctrl:1
    s_nop 1
    v_add_u32_dpp v9, v9, v9 row_shr:8 row_mask:0xf bank_mask:0xf bound_ctrl:1
    s_nop 0
    v_readlane_b32 s54, v9, s32
    s_sub_u32 s54, s54, s53
    s_add_u32 s50, s50, s54
    s_add_u32 s51, s51, s54
    s_add_u32 s52, s52, s54
    s_pack_ll_b32_b16 s48, s54, s50
    s_pack_ll_b32_b16 s49, s51, s52
    v_add_u32 v14, s48, v14
    v_add_u32 v15, s49, v15
    v_sub_u32 v12, v14, v12
    v_sub_u32 v13, v15, v13
    v_and_b32 v8, 0xffff, v12
    v_lshrrev_b32 v9, 16, v12
    v_and_b32 v10, 0xffff, v13
    v_lshrrev_b32 v11, 16, v13
    ds_write2st64_b32 v7, v8, v9 offset0:0 offset1:1
    ds_write2st64_b32 v7, v10, v11 offset0:2 offset1:3
    v_and_b32 v8, 0x3f0, v0
    v_lshl_add_u32 v8, v8, 1, s36
    ds_write_b64 v8, v[12:13] offset:20480
    s_bitset0_b64 exec, 63
    s_not_b64 exec, exec
    ds_write_b64 v8, v[14:15] offset:20512
    s_mov_b64 exec, -1
    s_waitcnt lgkmcnt(0)
    s_barrier
    s_setprio 3
    ds_add_rtn_u32 v120, v120, v2
    ds_add_rtn_u32 v121, v121, v2
    ds_add_rtn_u32 v122, v122, v2
    ds_add_rtn_u32 v123, v123, v2
    ds_read_b128 v[12:15], v0 offset:20480
    v_cmp_gt_u32 vcc, 8448, v0
    s_add_u32 s46, s35, 0x7ec4000
    s_add_u32 s46, s46, s93
    buffer_store_dwordx4 v[28:31], v0, s[20:23], s46 offen sc1
    ds_add_rtn_u32 v124, v124, v2
    ds_add_rtn_u32 v125, v125, v2
    ds_add_rtn_u32 v126, v126, v2
    ds_add_rtn_u32 v127, v127, v2
    s_setprio 2
    ds_add_rtn_u32 v24, v24, v2
    ds_add_rtn_u32 v25, v25, v2
    ds_add_rtn_u32 v26, v26, v2
    ds_add_rtn_u32 v27, v27, v2
    s_waitcnt lgkmcnt(8)
    s_cbranch_vccz L1_p9
    s_add_u32 s47, s35, 0xa900000
    s_mov_b64 exec, vcc
    buffer_store_dwordx4 v[12:15], v0, s[24:27], s47 offen sc1
    s_mov_b64 exec, -1
L1_p9:
    s_add_u32 s44, s35, 0x7ec8000
    s_add_u32 s44, s44, s72
    buffer_store_dwordx4 v[112:115], v0, s[20:23], s44 offen sc1
    ds_add_rtn_u32 v52, v52, v2
    ds_add_rtn_u32 v53, v53, v2
    ds_add_rtn_u32 v54, v54, v2
    ds_add_rtn_u32 v55, v55, v2
    s_load_dwordx2 s[28:29], s[0:1], 0
    s_load_dwordx2 s[50:51], s[0:1], 40
    s_load_dwordx2 s[52:53], s[0:1], 24
    s_setprio 1
    ds_add_rtn_u32 v68, v68, v2
    ds_add_rtn_u32 v69, v69, v2
    ds_add_rtn_u32 v70, v70, v2
    ds_add_rtn_u32 v71, v71, v2
    s_cmp_le_u32 s43, 5
    s_cbranch_scc1 L1_s10
    ds_add_rtn_u32 v76, v76, v2
    ds_add_rtn_u32 v77, v77, v2
    ds_add_rtn_u32 v78, v78, v2
    ds_add_rtn_u32 v79, v79, v2
L1_s10:
    s_add_u32 s45, s35, 0x7ec8000
    s_add_u32 s45, s45, s73
    buffer_store_dwordx4 v[88:91], v0, s[20:23], s45 offen sc1
    s_setprio 0
    s_cmp_le_u32 s43, 6
    s_cbranch_scc1 L1_s11
    ds_add_rtn_u32 v56, v56, v2
    ds_add_rtn_u32 v57, v57, v2
    ds_add_rtn_u32 v58, v58, v2
    ds_add_rtn_u32 v59, v59, v2
L1_s11:
    s_cmp_le_u32 s43, 7
    s_cbranch_scc1 L1_s12
    ds_add_rtn_u32 v60, v60, v2
    ds_add_rtn_u32 v61, v61, v2
    ds_add_rtn_u32 v62, v62, v2
    ds_add_rtn_u32 v63, v63, v2
L1_s12:
    s_waitcnt lgkmcnt(0)
    s_barrier
    s_load_dwordx4 s[96:99], s[50:51], 0
    s_mov_b64 s[4:5], s[52:53]
    s_bfe_u32 s33, s2, 0x20001
    s_and_b32 s34, s2, 1
    s_lshl_b32 s34, s34, 5
    s_lshr_b32 s3, s2, 3
    s_add_u32 s34, s34, s3
    s_mul_i32 s39, s33, 2080
    s_lshl_b32 s3, s34, 5
    s_add_u32 s39, s39, s3
    s_mul_i32 s40, s33, 1310720
    s_add_u32 s40, s40, 0x50000
    s_lshl_b32 s38, s32, 11
    s_mul_i32 s100, s32, 3072
    s_add_u32 s8, s30, 0x4000
    s_addc_u32 s9, s31, 0
    s_mov_b32 s10, 0xd340000
    s_mov_b32 s11, 0x20000
    s_add_u32 s12, s30, 0x2c000
    s_addc_u32 s13, s31, 0
    s_mov_b32 s14, 0xd318000
    s_mov_b32 s15, 0x20000
    s_mov_b32 s16, s64
    s_mov_b32 s17, s65
    s_mov_b32 s18, 0x20
    s_mov_b32 s19, 0x20000
    s_mov_b32 s24, s28
    s_mov_b32 s25, s29
    s_mov_b32 s26, 0x4e2000
    s_mov_b32 s27, 0x20000
    s_setprio 3
    v_and_b32 v7, -4, v120
    v_lshl_add_u32 v8, v120, 2, v7
    ds_write_b32 v8, v16
    v_lshl_add_u32 v7, v7, 2, v120
    ds_write_b8 v7, v44 offset:16
    v_and_b32 v9, -4, v121
    v_lshl_add_u32 v10, v121, 2, v9
    ds_write_b32 v10, v17
    v_lshl_add_u32 v9, v9, 2, v121
    ds_write_b8_d16_hi v9, v44 offset:16
    v_and_b32 v7, -4, v122
    v_lshl_add_u32 v8, v122, 2, v7
    ds_write_b32 v8, v18
    v_lshl_add_u32 v7, v7, 2, v122
    ds_write_b8 v7, v45 offset:16
    v_and_b32 v9, -4, v123
    v_lshl_add_u32 v10, v123, 2, v9
    ds_write_b32 v10, v19
    v_lshl_add_u32 v9, v9, 2, v123
    ds_write_b8_d16_hi v9, v45 offset:16
    s_add_u32 s46, s35, 0x7ec8000
    s_add_u32 s46, s46, s85
    buffer_store_dwordx4 v[116:119], v0, s[20:23], s46 offen sc1
    v_and_b32 v13, 0x3f0, v0
    v_and_b32 v14, 0x300, v13
    v_bfe_u32 v15, v13, 4, 4
    s_lshl_b32 s3, s32, 4
    v_add3_u32 v14, v14, v15, s3
    v_mul_u32_u24 v2, 173056, v14
    v_lshrrev_b32 v14, 6, v13
    s_add_u32 s3, s3, 0x400
    v_add_u32 v14, s3, v14
    v_mul_u32_u24 v4, 173056, v14
    v_and_b32 v14, 3, v14
    v_and_b32 v15, 0x30, v13
    v_lshl_add_u32 v14, v14, 5, v15
    v_add_u32 v6, v14, v4
    v_lshl_add_u32 v5, v15, 1, v2
    v_lshrrev_b32 v14, 3, v15
    buffer_load_ushort v100, v14, s[16:19], 0 offen offset:0
    buffer_load_ushort v101, v14, s[16:19], 0 offen offset:8
    buffer_load_ushort v102, v14, s[16:19], 0 offen offset:16
    buffer_load_ushort v103, v14, s[16:19], 0 offen offset:24
    s_mul_i32 s3, s32, 5120
    v_add_u32 v3, s3, v13
    v_lshrrev_b32 v14, 2, v13
    v_add_u32 v14, s38, v14
    v_and_b32 v7, -4, v124
    v_lshl_add_u32 v8, v124, 2, v7
    ds_write_b32 v8, v20
    v_lshl_add_u32 v7, v7, 2, v124
    ds_write_b8 v7, v46 offset:16
    v_and_b32 v9, -4, v125
    v_lshl_add_u32 v10, v125, 2, v9
    ds_write_b32 v10, v21
    v_lshl_add_u32 v9, v9, 2, v125
    ds_write_b8_d16_hi v9, v46 offset:16
    v_and_b32 v7, -4, v126
    v_lshl_add_u32 v8, v126, 2, v7
    ds_write_b32 v8, v22
    v_lshl_add_u32 v7, v7, 2, v126
    ds_write_b8 v7, v47 offset:16
    v_and_b32 v9, -4, v127
    v_lshl_add_u32 v10, v127, 2, v9
    ds_write_b32 v10, v23
    v_lshl_add_u32 v9, v9, 2, v127
    ds_write_b8_d16_hi v9, v47 offset:16
    s_setprio 2
    v_and_b32 v7, -4, v24
    v_lshl_add_u32 v8, v24, 2, v7
    ds_write_b32 v8, v40
    v_lshl_add_u32 v7, v7, 2, v24
    ds_write_b8 v7, v32 offset:16
    v_and_b32 v9, -4, v25
    v_lshl_add_u32 v10, v25, 2, v9
    ds_write_b32 v10, v41
    v_lshl_add_u32 v9, v9, 2, v25
    ds_write_b8_d16_hi v9, v32 offset:16
    v_and_b32 v7, -4, v26
    v_lshl_add_u32 v8, v26, 2, v7
    ds_write_b32 v8, v42
    v_lshl_add_u32 v7, v7, 2, v26
    ds_write_b8 v7, v33 offset:16
    v_and_b32 v9, -4, v27
    v_lshl_add_u32 v10, v27, 2, v9
    ds_write_b32 v10, v43
    v_lshl_add_u32 v9, v9, 2, v27
    ds_write_b8_d16_hi v9, v33 offset:16
    s_add_u32 s47, s35, 0x7ec8000
    s_add_u32 s47, s47, s91
    buffer_store_dwordx4 v[92:95], v0, s[20:23], s47 offen sc1
    v_lshrrev_b32 v11, 2, v0
    v_and_b32 v11, 0xfc, v11
    s_cmp_ge_u32 s84, 128
    s_cselect_b32 s82, 0, s82
    s_mul_i32 s3, s84, 40
    s_add_u32 s3, s3, s32
    s_mul_i32 s76, s3, 52429
    s_lshr_b32 s76, s76, 22
    s_mul_i32 s74, s76, 80
    s_sub_u32 s3, s3, s74
    s_mul_i32 s74, s3, 205
    s_lshr_b32 s74, s74, 10
    s_mul_i32 s75, s74, 5
    s_sub_u32 s75, s3, s75
    s_lshl_b32 s48, s74, 1
    s_add_u32 s48, s48, s75
    s_add_u32 s49, s48, s74
    s_add_u32 s49, s49, 30
    s_cmp_lt_u32 s75, 2
    s_cselect_b32 s48, s48, s49
    s_lshl_b32 s48, s48, 10
    s_mul_i32 s49, s76, 80000
    s_add_u32 s48, s48, s49
    buffer_load_dword v104, v11, s[80:83], s48 offen offset:0
    buffer_load_dword v105, v11, s[80:83], s48 offen offset:256
    buffer_load_dword v106, v11, s[80:83], s48 offen offset:512
    buffer_load_dword v107, v11, s[80:83], s48 offen offset:768
    s_mul_i32 s3, s84, 40
    s_add_u32 s3, s3, s32
    s_add_u32 s3, s3, 16
    s_mul_i32 s76, s3, 52429
    s_lshr_b32 s76, s76, 22
    s_mul_i32 s74, s76, 80
    s_sub_u32 s3, s3, s74
    s_mul_i32 s74, s3, 205
    s_lshr_b32 s74, s74, 10
    s_mul_i32 s75, s74, 5
    s_sub_u32 s75, s3, s75
    s_lshl_b32 s48, s74, 1
    s_add_u32 s48, s48, s75
    s_add_u32 s49, s48, s74
    s_add_u32 s49, s49, 30
    s_cmp_lt_u32 s75, 2
    s_cselect_b32 s48, s48, s49
    s_lshl_b32 s48, s48, 10
    s_mul_i32 s49, s76, 80000
    s_add_u32 s48, s48, s49
    buffer_load_dword v28, v11, s[80:83], s48 offen offset:0
    buffer_load_dword v29, v11, s[80:83], s48 offen offset:256
    buffer_load_dword v30, v11, s[80:83], s48 offen offset:512
    buffer_load_dword v31, v11, s[80:83], s48 offen offset:768
    s_mul_i32 s3, s84, 40
    s_add_u32 s3, s3, s32
    s_add_u32 s3, s3, 32
    s_mul_i32 s76, s3, 52429
    s_lshr_b32 s76, s76, 22
    s_mul_i32 s74, s76, 80
    s_sub_u32 s3, s3, s74
    s_cmp_ge_u32 s32, 8
    s_cselect_b32 s82, 0, s82
    s_mul_i32 s74, s3, 205
    s_lshr_b32 s74, s74, 10
    s_mul_i32 s75, s74, 5
    s_sub_u32 s75, s3, s75
    s_lshl_b32 s48, s74, 1
    s_add_u32 s48, s48, s75
    s_add_u32 s49, s48, s74
    s_add_u32 s49, s49, 30
    s_cmp_lt_u32 s75, 2
    s_cselect_b32 s48, s48, s49
    s_lshl_b32 s48, s48, 10
    s_mul_i32 s49, s76, 80000
    s_add_u32 s48, s48, s49
    buffer_load_dword v112, v11, s[80:83], s48 offen offset:0
    buffer_load_dword v113, v11, s[80:83], s48 offen offset:256
    buffer_load_dword v114, v11, s[80:83], s48 offen offset:512
    buffer_load_dword v115, v11, s[80:83], s48 offen offset:768
    v_and_b32 v7, -4, v52
    v_lshl_add_u32 v8, v52, 2, v7
    ds_write_b32 v8, v48
    v_lshl_add_u32 v7, v7, 2, v52
    ds_write_b8 v7, v34 offset:16
    v_and_b32 v9, -4, v53
    v_lshl_add_u32 v10, v53, 2, v9
    ds_write_b32 v10, v49
    v_lshl_add_u32 v9, v9, 2, v53
    ds_write_b8_d16_hi v9, v34 offset:16
    v_and_b32 v7, -4, v54
    v_lshl_add_u32 v8, v54, 2, v7
    ds_write_b32 v8, v50
    v_lshl_add_u32 v7, v7, 2, v54
    ds_write_b8 v7, v35 offset:16
    v_and_b32 v9, -4, v55
    v_lshl_add_u32 v10, v55, 2, v9
    ds_write_b32 v10, v51
    v_lshl_add_u32 v9, v9, 2, v55
    ds_write_b8_d16_hi v9, v35 offset:16
    s_setprio 1
    v_and_b32 v7, -4, v68
    v_lshl_add_u32 v8, v68, 2, v7
    ds_write_b32 v8, v84
    v_lshl_add_u32 v7, v7, 2, v68
    ds_write_b8 v7, v72 offset:16
    v_and_b32 v9, -4, v69
    v_lshl_add_u32 v10, v69, 2, v9
    ds_write_b32 v10, v85
    v_lshl_add_u32 v9, v9, 2, v69
    ds_write_b8_d16_hi v9, v72 offset:16
    v_and_b32 v7, -4, v70
    v_lshl_add_u32 v8, v70, 2, v7
    ds_write_b32 v8, v86
    v_lshl_add_u32 v7, v7, 2, v70
    ds_write_b8 v7, v73 offset:16
    v_and_b32 v9, -4, v71
    v_lshl_add_u32 v10, v71, 2, v9
    ds_write_b32 v10, v87
    v_lshl_add_u32 v9, v9, 2, v71
    ds_write_b8_d16_hi v9, v73 offset:16
    s_cmp_le_u32 s43, 5
    s_cbranch_scc1 L1_s13
    v_and_b32 v7, -4, v76
    v_lshl_add_u32 v8, v76, 2, v7
    ds_write_b32 v8, v36
    v_lshl_add_u32 v7, v7, 2, v76
    ds_write_b8 v7, v74 offset:16
    v_and_b32 v9, -4, v77
    v_lshl_add_u32 v10, v77, 2, v9
    ds_write_b32 v10, v37
    v_lshl_add_u32 v9, v9, 2, v77
    ds_write_b8_d16_hi v9, v74 offset:16
    v_and_b32 v7, -4, v78
    v_lshl_add_u32 v8, v78, 2, v7
    ds_write_b32 v8, v38
    v_lshl_add_u32 v7, v7, 2, v78
    ds_write_b8 v7, v75 offset:16
    v_and_b32 v9, -4, v79
    v_lshl_add_u32 v10, v79, 2, v9
    ds_write_b32 v10, v39
    v_lshl_add_u32 v9, v9, 2, v79
    ds_write_b8_d16_hi v9, v75 offset:16
L1_s13:
    s_add_u32 s44, s35, 0x7ec8000
    s_add_u32 s44, s44, s93
    buffer_store_dwordx4 v[108:111], v0, s[20:23], s44 offen sc1
    s_setprio 0
    s_cmp_le_u32 s43, 6
    s_cbranch_scc1 L1_s14
    v_and_b32 v7, -4, v56
    v_lshl_add_u32 v8, v56, 2, v7
    ds_write_b32 v8, v80
    v_lshl_add_u32 v7, v7, 2, v56
    ds_write_b8 v7, v64 offset:16
    v_and_b32 v9, -4, v57
    v_lshl_add_u32 v10, v57, 2, v9
    ds_write_b32 v10, v81
    v_lshl_add_u32 v9, v9, 2, v57
    ds_write_b8_d16_hi v9, v64 offset:16
    v_and_b32 v7, -4, v58
    v_lshl_add_u32 v8, v58, 2, v7
    ds_write_b32 v8, v82
    v_lshl_add_u32 v7, v7, 2, v58
    ds_write_b8 v7, v65 offset:16
    v_and_b32 v9, -4, v59
    v_lshl_add_u32 v10, v59, 2, v9
    ds_write_b32 v10, v83
    v_lshl_add_u32 v9, v9, 2, v59
    ds_write_b8_d16_hi v9, v65 offset:16
L1_s14:
    s_cmp_le_u32 s43, 7
    s_cbranch_scc1 L1_s15
    v_and_b32 v7, -4, v60
    v_lshl_add_u32 v8, v60, 2, v7
    ds_write_b32 v8, v96
    v_lshl_add_u32 v7, v7, 2, v60
    ds_write_b8 v7, v66 offset:16
    v_and_b32 v9, -4, v61
    v_lshl_add_u32 v10, v61, 2, v9
    ds_write_b32 v10, v97
    v_lshl_add_u32 v9, v9, 2, v61
    ds_write_b8_d16_hi v9, v66 offset:16
    v_and_b32 v7, -4, v62
    v_lshl_add_u32 v8, v62, 2, v7
    ds_write_b32 v8, v98
    v_lshl_add_u32 v7, v7, 2, v62
    ds_write_b8 v7, v67 offset:16
    v_and_b32 v9, -4, v63
    v_lshl_add_u32 v10, v63, 2, v9
    ds_write_b32 v10, v99
    v_lshl_add_u32 v9, v9, 2, v63
    ds_write_b8_d16_hi v9, v67 offset:16
L1_s15:
    s_add_u32 s80, s30, 0xd344000
    s_addc_u32 s81, s31, 0
    s_mov_b32 s82, 0xa000
    s_mov_b32 s83, 0x20000
    s_min_u32 s3, s84, 127
    s_mul_i32 s3, s3, 40960
    s_add_u32 s80, s80, s3
    s_addc_u32 s81, s81, 0
    s_cmp_ge_u32 s84, 128
    s_cselect_b32 s82, 0, s82
    s_waitcnt vmcnt(1)
    v_add_u32 v11, 0, v0
    buffer_store_dwordx4 v[104:107], v11, s[80:83], 0 offen sc1
    v_add_u32 v11, 16384, v0
    buffer_store_dwordx4 v[28:31], v11, s[80:83], 0 offen sc1
    v_add_u32 v11, 32768, v0
    buffer_store_dwordx4 v[112:115], v11, s[80:83], 0 offen sc1
    v_add_u32 v7, 0x10000, v0
    v_add_u32 v12, 0x20000, v0
    s_waitcnt lgkmcnt(0)
    s_barrier
    ds_read_b128 v[24:27], v0 offset:0
    ds_read_b128 v[28:31], v0 offset:16384
    ds_read_b128 v[32:35], v0 offset:32768
    ds_read_b128 v[36:39], v0 offset:49152
    ds_read_b128 v[76:79], v7 offset:0
    ds_read_b128 v[80:83], v7 offset:16384
    ds_read_b128 v[84:87], v7 offset:32768
    ds_read_b128 v[104:107], v7 offset:49152
    ds_read_b128 v[68:71], v12 offset:0
    ds_read_b128 v[72:75], v12 offset:16384
    s_cmp_lg_u32 s32, 0
    s_cbranch_scc1 L2_sg1
    s_mov_b32 exec_hi, 0
    v_mov_b32 v11, 1
    buffer_store_dword v11, v14, s[60:63], s57 offen sc1
    s_mov_b64 exec, -1
L2_sg1:
    s_waitcnt lgkmcnt(9)
    s_add_u32 s45, s35, 0xa904000
    buffer_store_dwordx4 v[24:27], v0, s[20:23], s45 offen sc1
    s_waitcnt lgkmcnt(8)
    s_add_u32 s46, s35, 0xa908000
    buffer_store_dwordx4 v[28:31], v0, s[20:23], s46 offen sc1
    s_waitcnt lgkmcnt(7)
    s_add_u32 s47, s35, 0xa90c000
    buffer_store_dwordx4 v[32:35], v0, s[20:23], s47 offen sc1
    s_waitcnt lgkmcnt(6)
    s_add_u32 s44, s35, 0xa910000
    buffer_store_dwordx4 v[36:39], v0, s[20:23], s44 offen sc1
    s_waitcnt lgkmcnt(5)
    s_add_u32 s45, s35, 0xa914000
    buffer_store_dwordx4 v[76:79], v0, s[20:23], s45 offen sc1
    s_waitcnt lgkmcnt(4)
    s_add_u32 s46, s35, 0xa918000
    buffer_store_dwordx4 v[80:83], v0, s[20:23], s46 offen sc1
    s_waitcnt lgkmcnt(3)
    s_add_u32 s47, s35, 0xa91c000
    buffer_store_dwordx4 v[84:87], v0, s[20:23], s47 offen sc1
    s_waitcnt lgkmcnt(2)
    s_cmp_le_u32 s43, 5
    s_cbranch_scc1 L1_q16
    s_add_u32 s44, s35, 0xa920000
    buffer_store_dwordx4 v[104:107], v0, s[20:23], s44 offen sc1
L1_q16:
    s_waitcnt lgkmcnt(1)
    s_cmp_le_u32 s43, 6
    s_cbranch_scc1 L1_q17
    s_add_u32 s45, s35, 0xa924000
    buffer_store_dwordx4 v[68:71], v0, s[20:23], s45 offen sc1
L1_q17:
    s_waitcnt lgkmcnt(0)
    s_cmp_le_u32 s43, 7
    s_cbranch_scc1 L1_q18
    s_add_u32 s46, s35, 0xa928000
    buffer_store_dwordx4 v[72:75], v0, s[20:23], s46 offen sc1
L1_q18:
    s_waitcnt lgkmcnt(0)
    s_setprio 3
    v_mov_b32 v92, v0
    v_mov_b32 v93, v6
    v_mov_b32 v94, v13
    v_mov_b32 v95, v5
    v_mov_b32 v0, v14
    v_lshl_add_u32 v7, v13, 3, s38
    v_lshrrev_b32 v16, 2, v15
    v_mad_u32_u24 v4, v16, 5, v4
    v_or_b32 v4, 0xf0000000, v4
    v_or_b32 v2, 0xf0000000, v2
    v_sub_u32 v1, 28, v16
    v_lshrrev_b32 v17, 2, v16
    v_and_b32 v18, 3, v17
    v_lshlrev_b32 v18, 4, v18
    v_mov_b32 v10, 0x3f80
    v_mov_b32 v11, 0
    v_lshlrev_b64 v[10:11], v18, v[10:11]
    v_and_b32 v18, 3, v17
    v_lshlrev_b32 v18, 4, v18
    v_mov_b32 v12, 0xbf80
    v_mov_b32 v13, 0
    v_lshlrev_b64 v[12:13], v18, v[12:13]
    v_mov_b32 v45, 0xf0000000
    v_add_u32 v44, s38, v0
    v_lshrrev_b32 v44, 1, v44
    v_and_b32 v44, -4, v44
    v_mov_b32 v5, 0x1fff8
    v_mov_b32 v6, 0x07ff0000
    v_mov_b32 v16, 0
    v_mov_b32 v17, 0
    v_mov_b32 v18, 0
    v_mov_b32 v19, 0
    v_add_u32 v20, 81920, v92
    v_add_u32 v21, 0x10000, v20
    s_setprio 1
    s_setprio 2
    s_mov_b32 s44, 0x4000c0c
    s_mov_b32 s45, 0x4010c0c
    s_mov_b32 s46, 0x4020c0c
    s_mov_b32 s47, 0x4030c0c
    s_mov_b32 s36, 0
    s_mov_b32 s43, 0
    s_mov_b32 s42, 0
    s_mov_b64 s[80:81], 0
    s_mov_b64 s[48:49], 0
    s_add_u32 s16, s30, 0xd344000
    s_addc_u32 s17, s31, 0
    s_mov_b32 s18, 0x500000
    s_mov_b32 s19, 0x20000
    v_mov_b32 v68, 0
    v_mov_b32 v69, 0
    v_mov_b32 v70, 0
    v_mov_b32 v71, 0
    v_mov_b32 v72, 0
    v_mov_b32 v73, 0
    v_mov_b32 v74, 0
    v_mov_b32 v75, 0
    s_waitcnt vmcnt(0)
    v_lshl_or_b32 v8, v101, 16, v100
    v_lshl_or_b32 v9, v103, 16, v102
    s_barrier
    s_cmp_lg_u32 s32, 0
    s_cbranch_scc1 L2_sg2
    s_mov_b32 exec_hi, 0
    v_mov_b32 v88, 2
    buffer_store_dword v88, v0, s[60:63], s57 offen sc1
    s_mov_b64 exec, -1
L2_sg2:
    s_mov_b64 s[84:85], 0
    s_mul_i32 s3, s33, 1280000
    s_add_u32 s3, s3, s100
    s_add_u32 s3, s3, 32768
    buffer_load_dwordx4 v[124:127], v94, s[24:27], s3 offen offset:2048
    s_mul_i32 s3, s33, 1280000
    s_add_u32 s3, s3, s100
    s_add_u32 s3, s3, 32768
    buffer_load_dwordx4 v[116:119], v94, s[24:27], s3 offen offset:0
    s_mul_i32 s3, s33, 1280000
    s_add_u32 s3, s3, s100
    s_add_u32 s3, s3, 32768
    buffer_load_dwordx4 v[120:123], v94, s[24:27], s3 offen offset:1024
    s_mul_i32 s3, s33, 1280000
    s_add_u32 s3, s3, s38
    s_add_u32 s3, s3, 0
    buffer_load_dwordx4 v[108:111], v94, s[24:27], s3 offen offset:0
    s_mul_i32 s3, s33, 1280000
    s_add_u32 s3, s3, s38
    s_add_u32 s3, s3, 0
    buffer_load_dwordx4 v[112:115], v94, s[24:27], s3 offen offset:1024
    ds_write_b128 v20, v[16:19] offset:0
    ds_write_b128 v20, v[16:19] offset:16384
    ds_write_b128 v20, v[16:19] offset:32768
    ds_write_b128 v20, v[16:19] offset:49152
    ds_write_b128 v21, v[16:19]
    s_cmp_eq_u32 s56, 0
    s_cbranch_scc1 L2_e3
    v_lshlrev_b32 v16, 3, v94
    v_and_b32 v16, 0x80, v16
L2_e4:
    buffer_load_dword v88, v16, s[68:71], 0 offen sc1
    s_waitcnt vmcnt(0)
    v_cmp_gt_u32 vcc, 0x80, v88
    s_cbranch_vccnz L2_e4
L2_e3:
    s_mov_b64 exec, 0xffff
L2_p1:
    buffer_load_dword v88, v7, s[60:63], 0 offen sc1
    s_waitcnt vmcnt(0)
    v_cmpx_gt_u32 vcc, 1, v88
    s_cbranch_vccnz L2_p1
    s_mov_b64 exec, -1
    v_cmp_gt_u32 vcc, 2, v88
    s_and_b32 s56, vcc_lo, 0xffff
    buffer_load_dwordx4 v[48:51], v95, s[12:15], s39 offen offset:0
    buffer_load_dwordx4 v[56:59], v95, s[12:15], s39 offen offset:32
    buffer_load_dwordx4 v[52:55], v95, s[12:15], s39 offen offset:16
    buffer_load_dwordx4 v[60:63], v95, s[12:15], s39 offen offset:48
    buffer_load_dwordx4 v[64:67], v93, s[12:15], s39 offen
    s_waitcnt vmcnt(0)
    v_sub_u16 v88, v56, v48
    v_and_b32 v89, 3, v48
    v_add3_u32 v99, v88, v89, 3
    v_and_b32 v99, -4, v99
    v_max_u32 v99, 4, v99
    v_and_b32 v97, 0xfffc, v48
    v_bfm_b32 v96, v88, v89
    v_add_u32_dpp v91, v99, v99 row_shr:1 row_mask:0xf bank_mask:0xf bound_ctrl:1
    v_mad_u32_u24 v97, v97, 5, v2
    v_cmp_lt_u32 vcc, 16, v99
    v_add_u32_dpp v91, v91, v91 row_shr:2 row_mask:0xf bank_mask:0xf bound_ctrl:1
    v_sub_u32 v98, s38, v99
    v_lshrrev_b64 v[48:49], 16, v[48:49]
    v_add_u32_dpp v91, v91, v91 row_shr:4 row_mask:0xf bank_mask:0xf bound_ctrl:1
    v_lshrrev_b64 v[56:57], 16, v[56:57]
    s_mov_b32 s101, 0
    v_add_u32_dpp v91, v91, v91 row_shr:8 row_mask:0xf bank_mask:0xf bound_ctrl:1
    s_nop 1
    v_add_u32_dpp v91, v91, v91 row_bcast:15 row_mask:0xa bank_mask:0xf
    s_nop 1
    v_add_u32_dpp v91, v91, v91 row_bcast:31 row_mask:0xc bank_mask:0xf
    v_add_u32 v98, v98, v91
    v_readlane_b32 s37, v91, 63
    s_cbranch_vccnz L2_xo3
L2_xp3:
    s_cmp_gt_u32 s37, 1024
    s_cbranch_scc1 L2_xs4
    s_cmp_lg_u32 s101, 0
    s_cbranch_scc1 L2_xa4
L2_xb4:
    v_lshlrev_b32 v89, 16, v96
    v_add_u32 v90, 60, v97
    v_bitop3_b32 v90, v89, v45, v90 bitop3:0x6a
    ds_write_b32 v98, v90 offset:12
    v_lshlrev_b32 v89, 20, v96
    v_add_u32 v90, 40, v97
    v_bitop3_b32 v90, v89, v45, v90 bitop3:0x6a
    ds_write_b32 v98, v90 offset:8
    v_lshlrev_b32 v89, 24, v96
    v_add_u32 v90, 20, v97
    v_bitop3_b32 v90, v89, v45, v90 bitop3:0x6a
    ds_write_b32 v98, v90 offset:4
    v_lshlrev_b32 v89, 28, v96
    v_bitop3_b32 v90, v89, v45, v97 bitop3:0x6a
    ds_write_b32 v98, v90 offset:0
    v_mov_b32_dpp v91, v64 quad_perm:[0,0,0,0] row_mask:0xf bank_mask:0xf
    v_and_b32 v89, 3, v91
    v_and_b32 v97, 0xfffc, v91
    v_sub_u16_dpp v88, v64, v91 quad_perm:[2,2,2,2] row_mask:0xf bank_mask:0xf
    v_mad_u32_u24 v97, v97, 5, v4
    v_add_u32 v99, v88, v89
    v_bfm_b32 v96, v88, v89
    v_cmp_lt_u32 s[58:59], 16, v99
    v_lshlrev_b32 v89, v1, v96
    v_and_b32 v89, v45, v89
    v_cmp_ne_u32 vcc, 0, v89
    v_xor_b32 v90, v97, v89
    s_add_u32 s3, s37, s38
    v_mbcnt_lo_u32_b32 v98, vcc_lo, 0
    v_mbcnt_hi_u32_b32 v98, vcc_hi, v98
    s_bcnt1_i32_b64 s41, vcc
    v_lshl_add_u32 v98, v98, 2, s3
    s_lshl2_add_u32 s37, s41, s37
    s_mov_b64 exec, vcc
    ds_write_b32 v98, v90
    s_mov_b64 exec, -1
    s_cmp_lg_u64 s[58:59], 0
    s_cbranch_scc1 L2_xe4
L2_xr4:
    v_add_u32 v98, s37, v0
    v_mov_b32 v90, -1
    ds_write_b32 v98, v90
L2_xw4:
    ds_read_b32 v19, v44 offset:768
    ds_read_b32 v27, v0 offset:0
    ds_read_b32 v33, v0 offset:256
    ds_read_b32 v39, v0 offset:512
    s_sub_u32 s3, s37, 768
    s_cmp_gt_u32 s3, 128
    s_cbranch_scc1 L2_xf4
L2_xg4:
    v_sub_u16 v88, v58, v50
    v_and_b32 v89, 3, v50
    v_add3_u32 v99, v88, v89, 3
    v_and_b32 v99, -4, v99
    v_max_u32 v99, 4, v99
    v_and_b32 v97, 0xfffc, v50
    v_bfm_b32 v96, v88, v89
    v_add_u32_dpp v91, v99, v99 row_shr:1 row_mask:0xf bank_mask:0xf bound_ctrl:1
    v_mad_u32_u24 v97, v97, 5, v2
    v_cmp_lt_u32 vcc, 16, v99
    v_add_u32_dpp v91, v91, v91 row_shr:2 row_mask:0xf bank_mask:0xf bound_ctrl:1
    v_sub_u32 v98, s38, v99
    v_lshrrev_b64 v[50:51], 16, v[50:51]
    v_add_u32_dpp v91, v91, v91 row_shr:4 row_mask:0xf bank_mask:0xf bound_ctrl:1
    v_lshrrev_b64 v[58:59], 16, v[58:59]
    s_mov_b32 s101, 0
    v_add_u32_dpp v91, v91, v91 row_shr:8 row_mask:0xf bank_mask:0xf bound_ctrl:1
    s_nop 1
    v_add_u32_dpp v91, v91, v91 row_bcast:15 row_mask:0xa bank_mask:0xf
    s_nop 1
    v_add_u32_dpp v91, v91, v91 row_bcast:31 row_mask:0xc bank_mask:0xf
    v_add_u32 v98, v98, v91
    v_readlane_b32 s37, v91, 63
    s_cbranch_vccnz L2_xo5
L2_xp5:
    s_waitcnt lgkmcnt(0)
    s_cmp_gt_u32 s37, 1024
    s_cbranch_scc1 L2_xs6
    s_cmp_lg_u32 s101, 0
    s_cbranch_scc1 L2_xa6
L2_xb6:
    v_lshlrev_b32 v89, 16, v96
    v_add_u32 v90, 60, v97
    v_bitop3_b32 v90, v89, v45, v90 bitop3:0x6a
    ds_write_b32 v98, v90 offset:12
    v_lshlrev_b32 v89, 20, v96
    v_add_u32 v90, 40, v97
    v_bitop3_b32 v90, v89, v45, v90 bitop3:0x6a
    ds_write_b32 v98, v90 offset:8
    v_lshlrev_b32 v89, 24, v96
    v_add_u32 v90, 20, v97
    v_bitop3_b32 v90, v89, v45, v90 bitop3:0x6a
    ds_write_b32 v98, v90 offset:4
    v_lshlrev_b32 v89, 28, v96
    v_bitop3_b32 v90, v89, v45, v97 bitop3:0x6a
    ds_write_b32 v98, v90 offset:0
    v_mov_b32_dpp v91, v66 quad_perm:[0,0,0,0] row_mask:0xf bank_mask:0xf
    v_and_b32 v89, 3, v91
    v_and_b32 v97, 0xfffc, v91
    v_sub_u16_dpp v88, v66, v91 quad_perm:[2,2,2,2] row_mask:0xf bank_mask:0xf
    v_mad_u32_u24 v97, v97, 5, v4
    v_add_u32 v99, v88, v89
    v_bfm_b32 v96, v88, v89
    v_cmp_lt_u32 s[58:59], 16, v99
    v_lshlrev_b32 v89, v1, v96
    v_and_b32 v89, v45, v89
    v_cmp_ne_u32 vcc, 0, v89
    v_xor_b32 v90, v97, v89
    s_add_u32 s3, s37, s38
    v_mbcnt_lo_u32_b32 v98, vcc_lo, 0
    v_mbcnt_hi_u32_b32 v98, vcc_hi, v98
    s_bcnt1_i32_b64 s41, vcc
    v_lshl_add_u32 v98, v98, 2, s3
    s_lshl2_add_u32 s37, s41, s37
    s_mov_b64 exec, vcc
    ds_write_b32 v98, v90
    s_mov_b64 exec, -1
    s_cmp_lg_u64 s[58:59], 0
    s_cbranch_scc1 L2_xe6
L2_xr6:
    v_add_u32 v98, s37, v0
    v_mov_b32 v90, -1
    ds_write_b32 v98, v90
L2_xw6:
    ds_read_b32 v40, v44 offset:768
    ds_read_b32 v41, v0 offset:0
    ds_read_b32 v42, v0 offset:256
    ds_read_b32 v43, v0 offset:512
    s_sub_u32 s3, s37, 768
    s_cmp_gt_u32 s3, 128
    s_cbranch_scc1 L2_xf6
L2_xg6:
    v_subrev_u32 v88, s38, v3
    ds_write_b128 v88, v[124:127] offset:34816
    v_subrev_u32 v88, s38, v3
    ds_write_b128 v88, v[116:119] offset:32768
    v_subrev_u32 v88, s38, v3
    ds_write_b128 v88, v[120:123] offset:33792
    v_subrev_u32 v88, s100, v3
    ds_write_b128 v88, v[108:111] offset:0
    v_subrev_u32 v88, s100, v3
    ds_write_b128 v88, v[112:115] offset:1024
    s_cmp_eq_u32 s56, 0
    s_cbranch_scc1 L2_e2
    s_mov_b32 exec_lo, s56
    s_mov_b32 exec_hi, 0
    buffer_load_dword v88, v7, s[60:63], 0 offen sc1
    s_mov_b64 exec, -1
    s_waitcnt vmcnt(0)
    v_cmp_gt_u32 vcc, 2, v88
    s_and_b32 s56, vcc_lo, s56
    s_cbranch_scc0 L2_e2
    s_mul_i32 s3, s33, 1280000
    s_add_u32 s3, s3, s100
    s_add_u32 s3, s3, 352768
    buffer_load_dwordx4 v[124:127], v94, s[24:27], s3 offen offset:2048
    s_mul_i32 s3, s33, 1280000
    s_add_u32 s3, s3, s100
    s_add_u32 s3, s3, 352768
    buffer_load_dwordx4 v[116:119], v94, s[24:27], s3 offen offset:0
    s_mul_i32 s3, s33, 1280000
    s_add_u32 s3, s3, s100
    s_add_u32 s3, s3, 352768
    buffer_load_dwordx4 v[120:123], v94, s[24:27], s3 offen offset:1024
    s_mul_i32 s3, s33, 1280000
    s_add_u32 s3, s3, s38
    s_add_u32 s3, s3, 320000
    buffer_load_dwordx4 v[108:111], v94, s[24:27], s3 offen offset:0
    s_mul_i32 s3, s33, 1280000
    s_add_u32 s3, s3, s38
    s_add_u32 s3, s3, 320000
    buffer_load_dwordx4 v[112:115], v94, s[24:27], s3 offen offset:1024
    s_mov_b32 exec_lo, s56
    s_mov_b32 exec_hi, 0
L2_p2:
    buffer_load_dword v88, v7, s[60:63], 0 offen sc1
    s_waitcnt vmcnt(0)
    v_cmpx_gt_u32 vcc, 2, v88
    s_cbranch_vccnz L2_p2
    s_mov_b64 exec, -1
L2_e2:
    s_mov_b32 s6, 0xaaaaaaaa
    s_mov_b32 s7, 0xaaaaaaaa
    v_and_b32 v47, 0x0fffffff, v19
    buffer_load_dword v18, v47, s[8:11], 0 offen offset:16
    s_mov_b64 exec, s[6:7]
    v_add_u32 v47, 8, v47
    v_lshrrev_b32 v19, 2, v19
    s_mov_b64 exec, -1
    buffer_load_dwordx2 v[16:17], v47, s[8:11], 0 offen
    s_setprio 1
    v_and_b32 v47, 0x0fffffff, v27
    buffer_load_dwordx2 v[22:23], v47, s[8:11], 0 offen
    buffer_load_dwordx3 v[24:26], v47, s[8:11], 0 offen offset:8
    s_setprio 0
    v_and_b32 v47, 0x0fffffff, v33
    buffer_load_dwordx2 v[28:29], v47, s[8:11], 0 offen
    buffer_load_dwordx3 v[30:32], v47, s[8:11], 0 offen offset:8
    s_setprio 0
    v_and_b32 v47, 0x0fffffff, v39
    buffer_load_dwordx2 v[34:35], v47, s[8:11], 0 offen
    buffer_load_dwordx3 v[36:38], v47, s[8:11], 0 offen offset:8
    s_waitcnt lgkmcnt(0)
    s_barrier
    s_bitcmp1_b32 s36, s42
    s_cbranch_scc1 L2_slow
L2_ret0:
    s_setprio 3
    s_bitcmp1_b32 s43, s42
    s_cbranch_scc1 L2_oa7
L2_ob7:
    s_bitcmp1_b32 s43, s42
    s_cbranch_scc1 L2_oa8
L2_ob8:
    s_waitcnt vmcnt(6)
    s_mov_b64 exec, s[6:7]
    v_lshrrev_b32 v18, 16, v18
    s_mov_b64 exec, -1
    v_and_b32 v46, 0x20000000, v19
    v_lshrrev_b32 v47, 14, v17
    v_bitop3_b32 v47, v47, v5, v46 bitop3:0xea
    ds_read_b64 v[102:103], v47
    v_bitop3_b32 v93, v17, v5, v46 bitop3:0xea
    v_and_b32 v46, 0x10000000, v19
    v_lshrrev_b32 v47, 14, v16
    v_bitop3_b32 v47, v47, v5, v46 bitop3:0xea
    ds_read_b64 v[100:101], v47
    v_bitop3_b32 v92, v16, v5, v46 bitop3:0xea
    v_perm_b32 v15, v17, v18, s45
    v_bitop3_b32 v46, v17, 0.5, -0.5 bitop3:0xa8
    v_perm_b32 v14, v16, v18, s44
    v_bitop3_b32 v47, v16, 0.5, -0.5 bitop3:0xa8
    v_bitop3_b32 v15, v6, v15, v46 bitop3:0xca
    v_bitop3_b32 v14, v6, v14, v47 bitop3:0xca
    s_waitcnt lgkmcnt(0)
    v_mfma_f32_4x4x4_16b_bf16 v[80:83], v[8:9], v[102:103], 0
    v_mfma_f32_4x4x4_16b_bf16 v[76:79], v[8:9], v[100:101], 0
    v_cmp_lt_u32 s[84:85], v5, v92
    s_nop 2
    v_pk_mul_f32 v[80:81], v[80:81], v[14:15] op_sel:[0,1] op_sel_hi:[1,1]
    v_pk_mul_f32 v[82:83], v[82:83], v[14:15] op_sel:[0,1] op_sel_hi:[1,1]
    v_pk_mul_f32 v[76:77], v[76:77], v[14:15] op_sel:[0,0] op_sel_hi:[1,0]
    v_pk_mul_f32 v[78:79], v[78:79], v[14:15] op_sel:[0,0] op_sel_hi:[1,0]
    v_and_b32 v47, 0x0fffffff, v40
    buffer_load_dword v18, v47, s[8:11], 0 offen offset:16
    s_mov_b64 exec, s[6:7]
    v_add_u32 v47, 8, v47
    v_lshrrev_b32 v40, 2, v40
    s_mov_b64 exec, -1
    buffer_load_dwordx2 v[16:17], v47, s[8:11], 0 offen
    s_waitcnt vmcnt(6)
    v_and_b32 v46, 0x20000000, v27
    v_lshrrev_b32 v47, 14, v23
    v_bitop3_b32 v47, v47, v5, v46 bitop3:0xea
    ds_read_b64 v[106:107], v47
    v_and_b32 v99, 0x10000000, v27
    v_lshrrev_b32 v47, 14, v22
    v_bitop3_b32 v47, v47, v5, v99 bitop3:0xea
    ds_read_b64 v[104:105], v47
    v_cmp_ne_u64 s[50:51], v[72:73], v[68:69]
    v_cmpx_ne_u64 s[54:55], v[74:75], v[70:71]
    s_and_b64 s[82:83], s[54:55], s[80:81]
    s_cbranch_scc1 L2_c9
L2_d9:
    v_mov_b64 v[84:85], v[70:71]
    v_mov_b32 v7, v95
    v_mov_b64 v[86:87], v[74:75]
    s_or_b64 s[80:81], s[80:81], s[54:55]
    s_mov_b64 exec, s[50:51]
    s_and_b64 s[82:83], s[50:51], s[80:81]
    s_cbranch_scc1 L2_c10
L2_d10:
    v_mov_b64 v[84:85], v[68:69]
    v_mov_b32 v7, v94
    v_mov_b64 v[86:87], v[72:73]
    s_mov_b64 exec, -1
    s_or_b64 s[80:81], s[80:81], s[50:51]
    s_and_b64 exec, s[84:85], s[80:81]
    v_mfma_f32_4x4x4_16b_bf16 v[76:79], v[12:13], v[84:85], 0
    v_mov_b32 v92, v7
    s_andn2_b64 s[80:81], s[80:81], s[84:85]
    v_mfma_f32_4x4x4_16b_bf16 v[76:79], v[10:11], v[86:87], v[76:79]
    s_mov_b64 exec, -1
    ds_read_b64 v[70:71], v93 offset:65408
    ds_read_b64 v[68:69], v92 offset:65408
    v_bitop3_b32 v94, v22, v5, v99 bitop3:0xea
    v_bitop3_b32 v95, v23, v5, v46 bitop3:0xea
    v_perm_b32 v15, v23, v26, s45
    v_bitop3_b32 v46, v23, 0.5, -0.5 bitop3:0xa8
    v_perm_b32 v14, v22, v26, s44
    v_bitop3_b32 v47, v22, 0.5, -0.5 bitop3:0xa8
    v_bitop3_b32 v15, v6, v15, v46 bitop3:0xca
    v_bitop3_b32 v14, v6, v14, v47 bitop3:0xca
    s_waitcnt lgkmcnt(1)
    v_mfma_f32_4x4x4_16b_bf16 v[80:83], v[10:11], v[70:71], v[80:83]
    s_waitcnt lgkmcnt(0)
    v_mfma_f32_4x4x4_16b_bf16 v[76:79], v[10:11], v[68:69], v[76:79]
    s_nop 2
    v_cvt_pk_bf16_f32 v80, v80, v81
    v_cvt_pk_bf16_f32 v81, v82, v83
    ds_wrxchg_rtn_b64 v[74:75], v93, v[80:81] offset:65408
    v_cvt_pk_bf16_f32 v76, v76, v77
    v_cvt_pk_bf16_f32 v77, v78, v79
    ds_wrxchg_rtn_b64 v[72:73], v92, v[76:77] offset:65408
    v_mfma_f32_4x4x4_16b_bf16 v[80:83], v[8:9], v[106:107], 0
    v_mfma_f32_4x4x4_16b_bf16 v[76:79], v[8:9], v[104:105], 0
    v_cmp_lt_u32 s[48:49], v5, v95
    s_nop 2
    v_pk_mul_f32 v[80:81], v[80:81], v[14:15] op_sel:[0,1] op_sel_hi:[1,1]
    v_pk_mul_f32 v[82:83], v[82:83], v[14:15] op_sel:[0,1] op_sel_hi:[1,1]
    v_pk_mul_f32 v[76:77], v[76:77], v[14:15] op_sel:[0,0] op_sel_hi:[1,0]
    v_pk_mul_f32 v[78:79], v[78:79], v[14:15] op_sel:[0,0] op_sel_hi:[1,0]
    v_and_b32 v47, 0x3f0, v3
    s_cmp_lg_u32 s56, 0
    s_cbranch_scc1 L2_m11
    s_mul_i32 s3, s33, 1280000
    s_add_u32 s3, s3, s100
    s_add_u32 s3, s3, 352768
    buffer_load_dwordx4 v[124:127], v47, s[24:27], s3 offen offset:2048
L2_m11:
    v_and_b32 v47, 0x3f0, v3
    s_cmp_lg_u32 s56, 0
    s_cbranch_scc1 L2_m12
    s_mul_i32 s3, s33, 1280000
    s_add_u32 s3, s3, s100
    s_add_u32 s3, s3, 352768
    buffer_load_dwordx4 v[116:119], v47, s[24:27], s3 offen offset:0
L2_m12:
    v_and_b32 v46, 0x80000000, v27
    v_lshrrev_b32 v47, 14, v25
    v_bitop3_b32 v47, v47, v5, v46 bitop3:0xea
    ds_read_b64 v[102:103], v47
    v_and_b32 v99, 0x40000000, v27
    v_lshrrev_b32 v47, 14, v24
    v_bitop3_b32 v47, v47, v5, v99 bitop3:0xea
    ds_read_b64 v[100:101], v47
    s_waitcnt lgkmcnt(2)
    v_cmp_ne_u64 s[50:51], v[72:73], v[68:69]
    v_cmpx_ne_u64 s[54:55], v[74:75], v[70:71]
    s_and_b64 s[82:83], s[54:55], s[80:81]
    s_cbranch_scc1 L2_c13
L2_d13:
    v_mov_b64 v[84:85], v[70:71]
    v_mov_b32 v7, v93
    v_mov_b64 v[86:87], v[74:75]
    s_or_b64 s[80:81], s[80:81], s[54:55]
    s_mov_b64 exec, s[50:51]
    s_and_b64 s[82:83], s[50:51], s[80:81]
    s_cbranch_scc1 L2_c14
L2_d14:
    v_mov_b64 v[84:85], v[68:69]
    v_mov_b32 v7, v92
    v_mov_b64 v[86:87], v[72:73]
    s_mov_b64 exec, -1
    s_or_b64 s[80:81], s[80:81], s[50:51]
    s_and_b64 exec, s[48:49], s[80:81]
    v_mfma_f32_4x4x4_16b_bf16 v[80:83], v[12:13], v[84:85], 0
    v_mov_b32 v95, v7
    s_andn2_b64 s[80:81], s[80:81], s[48:49]
    v_mfma_f32_4x4x4_16b_bf16 v[80:83], v[10:11], v[86:87], v[80:83]
    s_mov_b64 exec, -1
    ds_read_b64 v[70:71], v95 offset:65408
    ds_read_b64 v[68:69], v94 offset:65408
    v_bitop3_b32 v92, v24, v5, v99 bitop3:0xea
    v_bitop3_b32 v93, v25, v5, v46 bitop3:0xea
    v_perm_b32 v15, v25, v26, s47
    v_bitop3_b32 v46, v25, 0.5, -0.5 bitop3:0xa8
    v_perm_b32 v14, v24, v26, s46
    v_bitop3_b32 v47, v24, 0.5, -0.5 bitop3:0xa8
    v_bitop3_b32 v15, v6, v15, v46 bitop3:0xca
    v_bitop3_b32 v14, v6, v14, v47 bitop3:0xca
    s_waitcnt lgkmcnt(1)
    v_mfma_f32_4x4x4_16b_bf16 v[80:83], v[10:11], v[70:71], v[80:83]
    s_waitcnt lgkmcnt(0)
    v_mfma_f32_4x4x4_16b_bf16 v[76:79], v[10:11], v[68:69], v[76:79]
    s_nop 2
    v_cvt_pk_bf16_f32 v80, v80, v81
    v_cvt_pk_bf16_f32 v81, v82, v83
    ds_wrxchg_rtn_b64 v[74:75], v95, v[80:81] offset:65408
    v_cvt_pk_bf16_f32 v76, v76, v77
    v_cvt_pk_bf16_f32 v77, v78, v79
    ds_wrxchg_rtn_b64 v[72:73], v94, v[76:77] offset:65408
    v_and_b32 v88, 0x0fffffff, v41
    buffer_load_dwordx2 v[22:23], v88, s[8:11], 0 offen
    buffer_load_dwordx3 v[24:26], v88, s[8:11], 0 offen offset:8
    s_setprio 2
    v_mfma_f32_4x4x4_16b_bf16 v[80:83], v[8:9], v[102:103], 0
    v_mfma_f32_4x4x4_16b_bf16 v[76:79], v[8:9], v[100:101], 0
    s_nop 3
    v_pk_mul_f32 v[80:81], v[80:81], v[14:15] op_sel:[0,1] op_sel_hi:[1,1]
    v_pk_mul_f32 v[82:83], v[82:83], v[14:15] op_sel:[0,1] op_sel_hi:[1,1]
    v_pk_mul_f32 v[76:77], v[76:77], v[14:15] op_sel:[0,0] op_sel_hi:[1,0]
    v_pk_mul_f32 v[78:79], v[78:79], v[14:15] op_sel:[0,0] op_sel_hi:[1,0]
    v_and_b32 v47, 0x3f0, v3
    s_cmp_lg_u32 s56, 0
    s_cbranch_scc1 L2_m15
    s_mul_i32 s3, s33, 1280000
    s_add_u32 s3, s3, s100
    s_add_u32 s3, s3, 352768
    buffer_load_dwordx4 v[120:123], v47, s[24:27], s3 offen offset:1024
L2_m15:
    s_waitcnt vmcnt(6)
    v_and_b32 v46, 0x20000000, v33
    v_lshrrev_b32 v47, 14, v29
    v_bitop3_b32 v47, v47, v5, v46 bitop3:0xea
    ds_read_b64 v[106:107], v47
    v_and_b32 v99, 0x10000000, v33
    v_lshrrev_b32 v47, 14, v28
    v_bitop3_b32 v47, v47, v5, v99 bitop3:0xea
    ds_read_b64 v[104:105], v47
    s_waitcnt lgkmcnt(2)
    v_cmp_ne_u64 s[50:51], v[72:73], v[68:69]
    v_cmpx_ne_u64 s[54:55], v[74:75], v[70:71]
    s_and_b64 s[82:83], s[54:55], s[80:81]
    s_cbranch_scc1 L2_c16
L2_d16:
    v_mov_b64 v[84:85], v[70:71]
    v_mov_b32 v7, v95
    v_mov_b64 v[86:87], v[74:75]
    s_or_b64 s[80:81], s[80:81], s[54:55]
    s_mov_b64 exec, s[50:51]
    s_and_b64 s[82:83], s[50:51], s[80:81]
    s_cbranch_scc1 L2_c17
L2_d17:
    v_mov_b64 v[84:85], v[68:69]
    v_mov_b32 v7, v94
    v_mov_b64 v[86:87], v[72:73]
    s_mov_b64 exec, -1
    s_or_b64 s[80:81], s[80:81], s[50:51]
    ds_read_b64 v[70:71], v93 offset:65408
    ds_read_b64 v[68:69], v92 offset:65408
    v_bitop3_b32 v94, v28, v5, v99 bitop3:0xea
    v_bitop3_b32 v95, v29, v5, v46 bitop3:0xea
    v_perm_b32 v15, v29, v32, s45
    v_bitop3_b32 v46, v29, 0.5, -0.5 bitop3:0xa8
    v_perm_b32 v14, v28, v32, s44
    v_bitop3_b32 v47, v28, 0.5, -0.5 bitop3:0xa8
    v_bitop3_b32 v15, v6, v15, v46 bitop3:0xca
    v_bitop3_b32 v14, v6, v14, v47 bitop3:0xca
    s_waitcnt lgkmcnt(1)
    v_mfma_f32_4x4x4_16b_bf16 v[80:83], v[10:11], v[70:71], v[80:83]
    s_waitcnt lgkmcnt(0)
    v_mfma_f32_4x4x4_16b_bf16 v[76:79], v[10:11], v[68:69], v[76:79]
    s_nop 2
    v_cvt_pk_bf16_f32 v80, v80, v81
    v_cvt_pk_bf16_f32 v81, v82, v83
    ds_wrxchg_rtn_b64 v[74:75], v93, v[80:81] offset:65408
    v_cvt_pk_bf16_f32 v76, v76, v77
    v_cvt_pk_bf16_f32 v77, v78, v79
    ds_wrxchg_rtn_b64 v[72:73], v92, v[76:77] offset:65408
    s_setprio 1
    v_mfma_f32_4x4x4_16b_bf16 v[80:83], v[8:9], v[106:107], 0
    v_mfma_f32_4x4x4_16b_bf16 v[76:79], v[8:9], v[104:105], 0
    v_cmp_lt_u32 s[84:85], v5, v94
    s_nop 2
    v_pk_mul_f32 v[80:81], v[80:81], v[14:15] op_sel:[0,1] op_sel_hi:[1,1]
    v_pk_mul_f32 v[82:83], v[82:83], v[14:15] op_sel:[0,1] op_sel_hi:[1,1]
    v_pk_mul_f32 v[76:77], v[76:77], v[14:15] op_sel:[0,0] op_sel_hi:[1,0]
    v_pk_mul_f32 v[78:79], v[78:79], v[14:15] op_sel:[0,0] op_sel_hi:[1,0]
    v_and_b32 v47, 0x3f0, v3
    s_cmp_lg_u32 s56, 0
    s_cbranch_scc1 L2_m18
    s_mul_i32 s3, s33, 1280000
    s_add_u32 s3, s3, s38
    s_add_u32 s3, s3, 320000
    buffer_load_dwordx4 v[108:111], v47, s[24:27], s3 offen offset:0
L2_m18:
    v_and_b32 v47, 0x3f0, v3
    s_cmp_lg_u32 s56, 0
    s_cbranch_scc1 L2_m19
    s_mul_i32 s3, s33, 1280000
    s_add_u32 s3, s3, s38
    s_add_u32 s3, s3, 320000
    buffer_load_dwordx4 v[112:115], v47, s[24:27], s3 offen offset:1024
L2_m19:
    v_sub_u16 v88, v60, v52
    v_and_b32 v89, 3, v52
    v_add3_u32 v99, v88, v89, 3
    v_and_b32 v99, -4, v99
    v_max_u32 v99, 4, v99
    v_and_b32 v97, 0xfffc, v52
    v_bfm_b32 v96, v88, v89
    v_add_u32_dpp v91, v99, v99 row_shr:1 row_mask:0xf bank_mask:0xf bound_ctrl:1
    v_mad_u32_u24 v97, v97, 5, v2
    v_cmp_lt_u32 vcc, 16, v99
    v_add_u32_dpp v91, v91, v91 row_shr:2 row_mask:0xf bank_mask:0xf bound_ctrl:1
    v_sub_u32 v98, s38, v99
    v_lshrrev_b64 v[52:53], 16, v[52:53]
    v_add_u32_dpp v91, v91, v91 row_shr:4 row_mask:0xf bank_mask:0xf bound_ctrl:1
    v_lshrrev_b64 v[60:61], 16, v[60:61]
    s_mov_b32 s101, 0
    v_add_u32_dpp v91, v91, v91 row_shr:8 row_mask:0xf bank_mask:0xf bound_ctrl:1
    s_nop 1
    v_add_u32_dpp v91, v91, v91 row_bcast:15 row_mask:0xa bank_mask:0xf
    s_nop 1
    v_add_u32_dpp v91, v91, v91 row_bcast:31 row_mask:0xc bank_mask:0xf
    v_add_u32 v98, v98, v91
    v_readlane_b32 s37, v91, 63
    s_cbranch_vccnz L2_xo20
L2_xp20:
    v_and_b32 v46, 0x80000000, v33
    v_lshrrev_b32 v47, 14, v31
    v_bitop3_b32 v47, v47, v5, v46 bitop3:0xea
    ds_read_b64 v[102:103], v47
    v_and_b32 v99, 0x40000000, v33
    v_lshrrev_b32 v47, 14, v30
    v_bitop3_b32 v47, v47, v5, v99 bitop3:0xea
    ds_read_b64 v[100:101], v47
    s_waitcnt lgkmcnt(2)
    v_cmp_ne_u64 s[50:51], v[72:73], v[68:69]
    v_cmpx_ne_u64 s[54:55], v[74:75], v[70:71]
    s_and_b64 s[82:83], s[54:55], s[80:81]
    s_cbranch_scc1 L2_c21
L2_d21:
    v_mov_b64 v[84:85], v[70:71]
    v_mov_b32 v7, v93
    v_mov_b64 v[86:87], v[74:75]
    s_or_b64 s[80:81], s[80:81], s[54:55]
    s_mov_b64 exec, s[50:51]
    s_and_b64 s[82:83], s[50:51], s[80:81]
    s_cbranch_scc1 L2_c22
L2_d22:
    v_mov_b64 v[84:85], v[68:69]
    v_mov_b32 v7, v92
    v_mov_b64 v[86:87], v[72:73]
    s_mov_b64 exec, -1
    s_or_b64 s[80:81], s[80:81], s[50:51]
    s_and_b64 exec, s[84:85], s[80:81]
    v_mfma_f32_4x4x4_16b_bf16 v[76:79], v[12:13], v[84:85], 0
    v_mov_b32 v94, v7
    s_andn2_b64 s[80:81], s[80:81], s[84:85]
    v_mfma_f32_4x4x4_16b_bf16 v[76:79], v[10:11], v[86:87], v[76:79]
    s_mov_b64 exec, -1
    ds_read_b64 v[70:71], v95 offset:65408
    ds_read_b64 v[68:69], v94 offset:65408
    v_bitop3_b32 v92, v30, v5, v99 bitop3:0xea
    v_bitop3_b32 v93, v31, v5, v46 bitop3:0xea
    v_perm_b32 v15, v31, v32, s47
    v_bitop3_b32 v46, v31, 0.5, -0.5 bitop3:0xa8
    v_perm_b32 v14, v30, v32, s46
    v_bitop3_b32 v47, v30, 0.5, -0.5 bitop3:0xa8
    v_bitop3_b32 v15, v6, v15, v46 bitop3:0xca
    v_bitop3_b32 v14, v6, v14, v47 bitop3:0xca
    s_waitcnt lgkmcnt(1)
    v_mfma_f32_4x4x4_16b_bf16 v[80:83], v[10:11], v[70:71], v[80:83]
    s_waitcnt lgkmcnt(0)
    v_mfma_f32_4x4x4_16b_bf16 v[76:79], v[10:11], v[68:69], v[76:79]
    s_nop 2
    v_cvt_pk_bf16_f32 v80, v80, v81
    v_cvt_pk_bf16_f32 v81, v82, v83
    ds_wrxchg_rtn_b64 v[74:75], v95, v[80:81] offset:65408
    v_cvt_pk_bf16_f32 v76, v76, v77
    v_cvt_pk_bf16_f32 v77, v78, v79
    ds_wrxchg_rtn_b64 v[72:73], v94, v[76:77] offset:65408
    v_and_b32 v88, 0x0fffffff, v42
    buffer_load_dwordx2 v[28:29], v88, s[8:11], 0 offen
    buffer_load_dwordx3 v[30:32], v88, s[8:11], 0 offen offset:8
    s_setprio 0
    v_mfma_f32_4x4x4_16b_bf16 v[80:83], v[8:9], v[102:103], 0
    v_mfma_f32_4x4x4_16b_bf16 v[76:79], v[8:9], v[100:101], 0
    v_cmp_lt_u32 s[48:49], v5, v93
    s_nop 2
    v_pk_mul_f32 v[80:81], v[80:81], v[14:15] op_sel:[0,1] op_sel_hi:[1,1]
    v_pk_mul_f32 v[82:83], v[82:83], v[14:15] op_sel:[0,1] op_sel_hi:[1,1]
    v_pk_mul_f32 v[76:77], v[76:77], v[14:15] op_sel:[0,0] op_sel_hi:[1,0]
    v_pk_mul_f32 v[78:79], v[78:79], v[14:15] op_sel:[0,0] op_sel_hi:[1,0]
    s_add_u32 s40, s40, 0x50000
    s_waitcnt vmcnt(6)
    v_and_b32 v46, 0x80000000, v39
    v_lshrrev_b32 v47, 14, v37
    v_bitop3_b32 v47, v47, v5, v46 bitop3:0xea
    ds_read_b64 v[102:103], v47
    v_and_b32 v99, 0x40000000, v39
    v_lshrrev_b32 v47, 14, v36
    v_bitop3_b32 v47, v47, v5, v99 bitop3:0xea
    ds_read_b64 v[100:101], v47
    v_and_b32 v46, 0x20000000, v39
    v_lshrrev_b32 v47, 14, v35
    v_bitop3_b32 v47, v47, v5, v46 bitop3:0xea
    ds_read_b64 v[106:107], v47
    v_and_b32 v99, 0x10000000, v39
    v_lshrrev_b32 v47, 14, v34
    v_bitop3_b32 v47, v47, v5, v99 bitop3:0xea
    ds_read_b64 v[104:105], v47
    s_waitcnt lgkmcnt(4)
    v_cmp_ne_u64 s[50:51], v[72:73], v[68:69]
    v_cmpx_ne_u64 s[54:55], v[74:75], v[70:71]
    s_and_b64 s[82:83], s[54:55], s[80:81]
    s_cbranch_scc1 L2_c23
L2_d23:
    v_mov_b64 v[84:85], v[70:71]
    v_mov_b32 v7, v95
    v_mov_b64 v[86:87], v[74:75]
    s_or_b64 s[80:81], s[80:81], s[54:55]
    s_mov_b64 exec, s[50:51]
    s_and_b64 s[82:83], s[50:51], s[80:81]
    s_cbranch_scc1 L2_c24
L2_d24:
    v_mov_b64 v[84:85], v[68:69]
    v_mov_b32 v7, v94
    v_mov_b64 v[86:87], v[72:73]
    s_mov_b64 exec, -1
    s_or_b64 s[80:81], s[80:81], s[50:51]
    s_and_b64 exec, s[48:49], s[80:81]
    v_mfma_f32_4x4x4_16b_bf16 v[80:83], v[12:13], v[84:85], 0
    v_mov_b32 v93, v7
    s_andn2_b64 s[80:81], s[80:81], s[48:49]
    v_mfma_f32_4x4x4_16b_bf16 v[80:83], v[10:11], v[86:87], v[80:83]
    s_mov_b64 exec, -1
    ds_read_b64 v[70:71], v93 offset:65408
    ds_read_b64 v[68:69], v92 offset:65408
    v_bitop3_b32 v94, v34, v5, v99 bitop3:0xea
    v_bitop3_b32 v95, v35, v5, v46 bitop3:0xea
    v_perm_b32 v15, v35, v38, s45
    v_bitop3_b32 v46, v35, 0.5, -0.5 bitop3:0xa8
    v_perm_b32 v14, v34, v38, s44
    v_bitop3_b32 v47, v34, 0.5, -0.5 bitop3:0xa8
    v_bitop3_b32 v15, v6, v15, v46 bitop3:0xca
    v_bitop3_b32 v14, v6, v14, v47 bitop3:0xca
    s_waitcnt lgkmcnt(1)
    v_mfma_f32_4x4x4_16b_bf16 v[80:83], v[10:11], v[70:71], v[80:83]
    s_waitcnt lgkmcnt(0)
    v_mfma_f32_4x4x4_16b_bf16 v[76:79], v[10:11], v[68:69], v[76:79]
    s_nop 2
    v_cvt_pk_bf16_f32 v80, v80, v81
    v_cvt_pk_bf16_f32 v81, v82, v83
    ds_wrxchg_rtn_b64 v[74:75], v93, v[80:81] offset:65408
    v_cvt_pk_bf16_f32 v76, v76, v77
    v_cvt_pk_bf16_f32 v77, v78, v79
    ds_wrxchg_rtn_b64 v[72:73], v92, v[76:77] offset:65408
    s_barrier
    s_setprio 3
    s_waitcnt vmcnt(4)
    v_subrev_u32 v88, s38, v3
    ds_write_b128 v88, v[124:127] offset:34816
    s_add_u32 s3, s40, 4096
    buffer_load_dwordx4 v[124:127], v3, s[16:19], s3 offen sc1
    s_waitcnt vmcnt(5)
    v_subrev_u32 v88, s38, v3
    ds_write_b128 v88, v[116:119] offset:32768
    buffer_load_dwordx4 v[116:119], v3, s[16:19], s40 offen offset:2048 sc1
    s_waitcnt vmcnt(4)
    v_subrev_u32 v88, s38, v3
    ds_write_b128 v88, v[120:123] offset:33792
    buffer_load_dwordx4 v[120:123], v3, s[16:19], s40 offen offset:3072 sc1
    v_mfma_f32_4x4x4_16b_bf16 v[80:83], v[8:9], v[106:107], 0
    v_mfma_f32_4x4x4_16b_bf16 v[76:79], v[8:9], v[104:105], 0
    s_nop 3
    v_pk_mul_f32 v[80:81], v[80:81], v[14:15] op_sel:[0,1] op_sel_hi:[1,1]
    v_pk_mul_f32 v[82:83], v[82:83], v[14:15] op_sel:[0,1] op_sel_hi:[1,1]
    v_pk_mul_f32 v[76:77], v[76:77], v[14:15] op_sel:[0,0] op_sel_hi:[1,0]
    v_pk_mul_f32 v[78:79], v[78:79], v[14:15] op_sel:[0,0] op_sel_hi:[1,0]
    s_cmp_gt_u32 s37, 1024
    s_cbranch_scc1 L2_xs25
    s_cmp_lg_u32 s101, 0
    s_cbranch_scc1 L2_xa25
L2_xb25:
    v_lshlrev_b32 v89, 16, v96
    v_add_u32 v90, 60, v97
    v_bitop3_b32 v90, v89, v45, v90 bitop3:0x6a
    ds_write_b32 v98, v90 offset:12
    v_lshlrev_b32 v89, 20, v96
    v_add_u32 v90, 40, v97
    v_bitop3_b32 v90, v89, v45, v90 bitop3:0x6a
    ds_write_b32 v98, v90 offset:8
    v_lshlrev_b32 v89, 24, v96
    v_add_u32 v90, 20, v97
    v_bitop3_b32 v90, v89, v45, v90 bitop3:0x6a
    ds_write_b32 v98, v90 offset:4
    v_lshlrev_b32 v89, 28, v96
    v_bitop3_b32 v90, v89, v45, v97 bitop3:0x6a
    ds_write_b32 v98, v90 offset:0
    v_mov_b32_dpp v91, v64 quad_perm:[1,1,1,1] row_mask:0xf bank_mask:0xf
    v_and_b32 v89, 3, v91
    v_and_b32 v97, 0xfffc, v91
    v_sub_u16_dpp v88, v64, v91 quad_perm:[3,3,3,3] row_mask:0xf bank_mask:0xf
    v_mad_u32_u24 v97, v97, 5, v4
    v_add_u32 v99, v88, v89
    v_bfm_b32 v96, v88, v89
    v_cmp_lt_u32 s[58:59], 16, v99
    v_lshlrev_b32 v89, v1, v96
    v_and_b32 v89, v45, v89
    v_cmp_ne_u32 vcc, 0, v89
    v_xor_b32 v90, v97, v89
    s_add_u32 s3, s37, s38
    v_mbcnt_lo_u32_b32 v98, vcc_lo, 0
    v_mbcnt_hi_u32_b32 v98, vcc_hi, v98
    s_bcnt1_i32_b64 s41, vcc
    v_lshl_add_u32 v98, v98, 2, s3
    s_lshl2_add_u32 s37, s41, s37
    s_mov_b64 exec, vcc
    ds_write_b32 v98, v90
    s_mov_b64 exec, -1
    s_cmp_lg_u64 s[58:59], 0
    s_cbranch_scc1 L2_xe25
L2_xr25:
    v_add_u32 v98, s37, v0
    v_mov_b32 v90, -1
    ds_write_b32 v98, v90
L2_xw25:
    s_setprio 2
    s_waitcnt lgkmcnt(9)
    v_cmp_ne_u64 s[50:51], v[72:73], v[68:69]
    v_cmpx_ne_u64 s[54:55], v[74:75], v[70:71]
    s_and_b64 s[82:83], s[54:55], s[80:81]
    s_cbranch_scc1 L2_c26
L2_d26:
    v_mov_b64 v[84:85], v[70:71]
    v_mov_b32 v7, v93
    v_mov_b64 v[86:87], v[74:75]
    s_or_b64 s[80:81], s[80:81], s[54:55]
    s_mov_b64 exec, s[50:51]
    s_and_b64 s[82:83], s[50:51], s[80:81]
    s_cbranch_scc1 L2_c27
L2_d27:
    v_mov_b64 v[84:85], v[68:69]
    v_mov_b32 v7, v92
    v_mov_b64 v[86:87], v[72:73]
    s_mov_b64 exec, -1
    s_or_b64 s[80:81], s[80:81], s[50:51]
    ds_read_b64 v[70:71], v95 offset:65408
    ds_read_b64 v[68:69], v94 offset:65408
    v_and_b32 v46, 0x40000000, v39
    v_bitop3_b32 v92, v36, v5, v46 bitop3:0xea
    v_and_b32 v46, 0x80000000, v39
    v_bitop3_b32 v93, v37, v5, v46 bitop3:0xea
    v_perm_b32 v15, v37, v38, s47
    v_bitop3_b32 v46, v37, 0.5, -0.5 bitop3:0xa8
    v_perm_b32 v14, v36, v38, s46
    v_bitop3_b32 v47, v36, 0.5, -0.5 bitop3:0xa8
    v_bitop3_b32 v15, v6, v15, v46 bitop3:0xca
    v_bitop3_b32 v14, v6, v14, v47 bitop3:0xca
    s_setprio 1
    s_waitcnt lgkmcnt(1)
    v_mfma_f32_4x4x4_16b_bf16 v[80:83], v[10:11], v[70:71], v[80:83]
    s_waitcnt lgkmcnt(0)
    v_mfma_f32_4x4x4_16b_bf16 v[76:79], v[10:11], v[68:69], v[76:79]
    s_nop 2
    v_cvt_pk_bf16_f32 v80, v80, v81
    v_cvt_pk_bf16_f32 v81, v82, v83
    ds_wrxchg_rtn_b64 v[74:75], v95, v[80:81] offset:65408
    v_cvt_pk_bf16_f32 v76, v76, v77
    v_cvt_pk_bf16_f32 v77, v78, v79
    ds_wrxchg_rtn_b64 v[72:73], v94, v[76:77] offset:65408
    ds_read_b32 v19, v44 offset:768
    ds_read_b32 v27, v0 offset:0
    ds_read_b32 v33, v0 offset:256
    ds_read_b32 v39, v0 offset:512
    s_sub_u32 s3, s37, 768
    s_cmp_gt_u32 s3, 128
    s_cbranch_scc1 L2_xf25
L2_xg25:
    v_and_b32 v88, 0x0fffffff, v43
    buffer_load_dwordx2 v[34:35], v88, s[8:11], 0 offen
    buffer_load_dwordx3 v[36:38], v88, s[8:11], 0 offen offset:8
    s_setprio 0
    s_waitcnt vmcnt(7)
    v_subrev_u32 v88, s100, v3
    ds_write_b128 v88, v[108:111] offset:0
    s_waitcnt vmcnt(7)
    v_subrev_u32 v88, s100, v3
    ds_write_b128 v88, v[112:115] offset:1024
    v_mfma_f32_4x4x4_16b_bf16 v[80:83], v[8:9], v[102:103], 0
    v_mfma_f32_4x4x4_16b_bf16 v[76:79], v[8:9], v[100:101], 0
    v_cmp_lt_u32 s[84:85], v5, v92
    s_nop 2
    v_pk_mul_f32 v[80:81], v[80:81], v[14:15] op_sel:[0,1] op_sel_hi:[1,1]
    v_pk_mul_f32 v[82:83], v[82:83], v[14:15] op_sel:[0,1] op_sel_hi:[1,1]
    v_pk_mul_f32 v[76:77], v[76:77], v[14:15] op_sel:[0,0] op_sel_hi:[1,0]
    v_pk_mul_f32 v[78:79], v[78:79], v[14:15] op_sel:[0,0] op_sel_hi:[1,0]
    s_add_u32 s42, s42, 1
    s_waitcnt lgkmcnt(0)
    s_add_u32 s24, s30, 0xec54000
    s_addc_u32 s25, s31, 0
    s_mov_b32 s26, 0x100
    s_mov_b32 s27, 0x20000
    s_barrier
    s_bitcmp1_b32 s36, s42
    s_cbranch_scc1 L2_slow
L2_ret1:
    s_setprio 3
    s_bitcmp1_b32 s43, s42
    s_cbranch_scc1 L2_oa28
L2_ob28:
    s_mov_b64 exec, s[6:7]
    v_lshrrev_b32 v18, 16, v18
    s_mov_b64 exec, -1
    v_and_b32 v46, 0x20000000, v40
    v_lshrrev_b32 v47, 14, v17
    v_bitop3_b32 v47, v47, v5, v46 bitop3:0xea
    ds_read_b64 v[106:107], v47
    v_and_b32 v99, 0x10000000, v40
    v_lshrrev_b32 v47, 14, v16
    v_bitop3_b32 v47, v47, v5, v99 bitop3:0xea
    ds_read_b64 v[104:105], v47
    v_cmp_ne_u64 s[50:51], v[72:73], v[68:69]
    v_cmpx_ne_u64 s[54:55], v[74:75], v[70:71]
    s_and_b64 s[82:83], s[54:55], s[80:81]
    s_cbranch_scc1 L2_c29
L2_d29:
    v_mov_b64 v[84:85], v[70:71]
    v_mov_b32 v7, v95
    v_mov_b64 v[86:87], v[74:75]
    s_or_b64 s[80:81], s[80:81], s[54:55]
    s_mov_b64 exec, s[50:51]
    s_and_b64 s[82:83], s[50:51], s[80:81]
    s_cbranch_scc1 L2_c30
L2_d30:
    v_mov_b64 v[84:85], v[68:69]
    v_mov_b32 v7, v94
    v_mov_b64 v[86:87], v[72:73]
    s_mov_b64 exec, -1
    s_or_b64 s[80:81], s[80:81], s[50:51]
    s_and_b64 exec, s[84:85], s[80:81]
    v_mfma_f32_4x4x4_16b_bf16 v[76:79], v[12:13], v[84:85], 0
    v_mov_b32 v92, v7
    s_andn2_b64 s[80:81], s[80:81], s[84:85]
    v_mfma_f32_4x4x4_16b_bf16 v[76:79], v[10:11], v[86:87], v[76:79]
    s_mov_b64 exec, -1
    ds_read_b64 v[70:71], v93 offset:65408
    ds_read_b64 v[68:69], v92 offset:65408
    v_bitop3_b32 v94, v16, v5, v99 bitop3:0xea
    v_bitop3_b32 v95, v17, v5, v46 bitop3:0xea
    v_perm_b32 v15, v17, v18, s45
    v_bitop3_b32 v46, v17, 0.5, -0.5 bitop3:0xa8
    v_perm_b32 v14, v16, v18, s44
    v_bitop3_b32 v47, v16, 0.5, -0.5 bitop3:0xa8
    v_bitop3_b32 v15, v6, v15, v46 bitop3:0xca
    v_bitop3_b32 v14, v6, v14, v47 bitop3:0xca
    s_waitcnt lgkmcnt(1)
    v_mfma_f32_4x4x4_16b_bf16 v[80:83], v[10:11], v[70:71], v[80:83]
    s_waitcnt lgkmcnt(0)
    v_mfma_f32_4x4x4_16b_bf16 v[76:79], v[10:11], v[68:69], v[76:79]
    s_nop 2
    v_cvt_pk_bf16_f32 v80, v80, v81
    v_cvt_pk_bf16_f32 v81, v82, v83
    ds_wrxchg_rtn_b64 v[74:75], v93, v[80:81] offset:65408
    v_cvt_pk_bf16_f32 v76, v76, v77
    v_cvt_pk_bf16_f32 v77, v78, v79
    ds_wrxchg_rtn_b64 v[72:73], v92, v[76:77] offset:65408
    v_mfma_f32_4x4x4_16b_bf16 v[80:83], v[8:9], v[106:107], 0
    v_mfma_f32_4x4x4_16b_bf16 v[76:79], v[8:9], v[104:105], 0
    v_cmp_lt_u32 s[84:85], v5, v94
    s_nop 2
    v_pk_mul_f32 v[80:81], v[80:81], v[14:15] op_sel:[0,1] op_sel_hi:[1,1]
    v_pk_mul_f32 v[82:83], v[82:83], v[14:15] op_sel:[0,1] op_sel_hi:[1,1]
    v_pk_mul_f32 v[76:77], v[76:77], v[14:15] op_sel:[0,0] op_sel_hi:[1,0]
    v_pk_mul_f32 v[78:79], v[78:79], v[14:15] op_sel:[0,0] op_sel_hi:[1,0]
    v_and_b32 v47, 0x0fffffff, v19
    buffer_load_dword v18, v47, s[8:11], 0 offen offset:16
    s_mov_b64 exec, s[6:7]
    v_add_u32 v47, 8, v47
    v_lshrrev_b32 v19, 2, v19
    s_mov_b64 exec, -1
    buffer_load_dwordx2 v[16:17], v47, s[8:11], 0 offen
    v_and_b32 v46, 0x20000000, v41
    v_lshrrev_b32 v47, 14, v23
    v_bitop3_b32 v47, v47, v5, v46 bitop3:0xea
    ds_read_b64 v[102:103], v47
    v_and_b32 v99, 0x10000000, v41
    v_lshrrev_b32 v47, 14, v22
    v_bitop3_b32 v47, v47, v5, v99 bitop3:0xea
    ds_read_b64 v[100:101], v47
    s_waitcnt lgkmcnt(2)
    v_cmp_ne_u64 s[50:51], v[72:73], v[68:69]
    v_cmpx_ne_u64 s[54:55], v[74:75], v[70:71]
    s_and_b64 s[82:83], s[54:55], s[80:81]
    s_cbranch_scc1 L2_c31
L2_d31:
    v_mov_b64 v[84:85], v[70:71]
    v_mov_b32 v7, v93
    v_mov_b64 v[86:87], v[74:75]
    s_or_b64 s[80:81], s[80:81], s[54:55]
    s_mov_b64 exec, s[50:51]
    s_and_b64 s[82:83], s[50:51], s[80:81]
    s_cbranch_scc1 L2_c32
L2_d32:
    v_mov_b64 v[84:85], v[68:69]
    v_mov_b32 v7, v92
    v_mov_b64 v[86:87], v[72:73]
    s_mov_b64 exec, -1
    s_or_b64 s[80:81], s[80:81], s[50:51]
    s_and_b64 exec, s[84:85], s[80:81]
    v_mfma_f32_4x4x4_16b_bf16 v[76:79], v[12:13], v[84:85], 0
    v_mov_b32 v94, v7
    s_andn2_b64 s[80:81], s[80:81], s[84:85]
    v_mfma_f32_4x4x4_16b_bf16 v[76:79], v[10:11], v[86:87], v[76:79]
    s_mov_b64 exec, -1
    ds_read_b64 v[70:71], v95 offset:65408
    ds_read_b64 v[68:69], v94 offset:65408
    v_bitop3_b32 v92, v22, v5, v99 bitop3:0xea
    v_bitop3_b32 v93, v23, v5, v46 bitop3:0xea
    v_perm_b32 v15, v23, v26, s45
    v_bitop3_b32 v46, v23, 0.5, -0.5 bitop3:0xa8
    v_perm_b32 v14, v22, v26, s44
    v_bitop3_b32 v47, v22, 0.5, -0.5 bitop3:0xa8
    v_bitop3_b32 v15, v6, v15, v46 bitop3:0xca
    v_bitop3_b32 v14, v6, v14, v47 bitop3:0xca
    s_waitcnt lgkmcnt(1)
    v_mfma_f32_4x4x4_16b_bf16 v[80:83], v[10:11], v[70:71], v[80:83]
    s_waitcnt lgkmcnt(0)
    v_mfma_f32_4x4x4_16b_bf16 v[76:79], v[10:11], v[68:69], v[76:79]
    s_nop 2
    v_cvt_pk_bf16_f32 v80, v80, v81
    v_cvt_pk_bf16_f32 v81, v82, v83
    ds_wrxchg_rtn_b64 v[74:75], v95, v[80:81] offset:65408
    v_cvt_pk_bf16_f32 v76, v76, v77
    v_cvt_pk_bf16_f32 v77, v78, v79
    ds_wrxchg_rtn_b64 v[72:73], v94, v[76:77] offset:65408
    v_mfma_f32_4x4x4_16b_bf16 v[80:83], v[8:9], v[102:103], 0
    v_mfma_f32_4x4x4_16b_bf16 v[76:79], v[8:9], v[100:101], 0
    v_cmp_lt_u32 s[48:49], v5, v93
    s_nop 2
    v_pk_mul_f32 v[80:81], v[80:81], v[14:15] op_sel:[0,1] op_sel_hi:[1,1]
    v_pk_mul_f32 v[82:83], v[82:83], v[14:15] op_sel:[0,1] op_sel_hi:[1,1]
    v_pk_mul_f32 v[76:77], v[76:77], v[14:15] op_sel:[0,0] op_sel_hi:[1,0]
    v_pk_mul_f32 v[78:79], v[78:79], v[14:15] op_sel:[0,0] op_sel_hi:[1,0]
    buffer_load_dwordx4 v[108:111], v3, s[16:19], s40 offen offset:0 sc1
    v_and_b32 v46, 0x80000000, v41
    v_lshrrev_b32 v47, 14, v25
    v_bitop3_b32 v47, v47, v5, v46 bitop3:0xea
    ds_read_b64 v[106:107], v47
    v_and_b32 v99, 0x40000000, v41
    v_lshrrev_b32 v47, 14, v24
    v_bitop3_b32 v47, v47, v5, v99 bitop3:0xea
    ds_read_b64 v[104:105], v47
    s_waitcnt lgkmcnt(2)
    v_cmp_ne_u64 s[50:51], v[72:73], v[68:69]
    v_cmpx_ne_u64 s[54:55], v[74:75], v[70:71]
    s_and_b64 s[82:83], s[54:55], s[80:81]
    s_cbranch_scc1 L2_c33
L2_d33:
    v_mov_b64 v[84:85], v[70:71]
    v_mov_b32 v7, v95
    v_mov_b64 v[86:87], v[74:75]
    s_or_b64 s[80:81], s[80:81], s[54:55]
    s_mov_b64 exec, s[50:51]
    s_and_b64 s[82:83], s[50:51], s[80:81]
    s_cbranch_scc1 L2_c34
L2_d34:
    v_mov_b64 v[84:85], v[68:69]
    v_mov_b32 v7, v94
    v_mov_b64 v[86:87], v[72:73]
    s_mov_b64 exec, -1
    s_or_b64 s[80:81], s[80:81], s[50:51]
    s_and_b64 exec, s[48:49], s[80:81]
    v_mfma_f32_4x4x4_16b_bf16 v[80:83], v[12:13], v[84:85], 0
    v_mov_b32 v93, v7
    s_andn2_b64 s[80:81], s[80:81], s[48:49]
    v_mfma_f32_4x4x4_16b_bf16 v[80:83], v[10:11], v[86:87], v[80:83]
    s_mov_b64 exec, -1
    ds_read_b64 v[70:71], v93 offset:65408
    ds_read_b64 v[68:69], v92 offset:65408
    v_bitop3_b32 v94, v24, v5, v99 bitop3:0xea
    v_bitop3_b32 v95, v25, v5, v46 bitop3:0xea
    v_perm_b32 v15, v25, v26, s47
    v_bitop3_b32 v46, v25, 0.5, -0.5 bitop3:0xa8
    v_perm_b32 v14, v24, v26, s46
    v_bitop3_b32 v47, v24, 0.5, -0.5 bitop3:0xa8
    v_bitop3_b32 v15, v6, v15, v46 bitop3:0xca
    v_bitop3_b32 v14, v6, v14, v47 bitop3:0xca
    s_waitcnt lgkmcnt(1)
    v_mfma_f32_4x4x4_16b_bf16 v[80:83], v[10:11], v[70:71], v[80:83]
    s_waitcnt lgkmcnt(0)
    v_mfma_f32_4x4x4_16b_bf16 v[76:79], v[10:11], v[68:69], v[76:79]
    s_nop 2
    v_cvt_pk_bf16_f32 v80, v80, v81
    v_cvt_pk_bf16_f32 v81, v82, v83
    ds_wrxchg_rtn_b64 v[74:75], v93, v[80:81] offset:65408
    v_cvt_pk_bf16_f32 v76, v76, v77
    v_cvt_pk_bf16_f32 v77, v78, v79
    ds_wrxchg_rtn_b64 v[72:73], v92, v[76:77] offset:65408
    v_and_b32 v88, 0x0fffffff, v27
    buffer_load_dwordx2 v[22:23], v88, s[8:11], 0 offen
    buffer_load_dwordx3 v[24:26], v88, s[8:11], 0 offen offset:8
    s_setprio 2
    v_mfma_f32_4x4x4_16b_bf16 v[80:83], v[8:9], v[106:107], 0
    v_mfma_f32_4x4x4_16b_bf16 v[76:79], v[8:9], v[104:105], 0
    s_nop 3
    v_pk_mul_f32 v[80:81], v[80:81], v[14:15] op_sel:[0,1] op_sel_hi:[1,1]
    v_pk_mul_f32 v[82:83], v[82:83], v[14:15] op_sel:[0,1] op_sel_hi:[1,1]
    v_pk_mul_f32 v[76:77], v[76:77], v[14:15] op_sel:[0,0] op_sel_hi:[1,0]
    v_pk_mul_f32 v[78:79], v[78:79], v[14:15] op_sel:[0,0] op_sel_hi:[1,0]
    s_waitcnt vmcnt(10)
    v_and_b32 v46, 0x20000000, v42
    v_lshrrev_b32 v47, 14, v29
    v_bitop3_b32 v47, v47, v5, v46 bitop3:0xea
    ds_read_b64 v[102:103], v47
    v_and_b32 v99, 0x10000000, v42
    v_lshrrev_b32 v47, 14, v28
    v_bitop3_b32 v47, v47, v5, v99 bitop3:0xea
    ds_read_b64 v[100:101], v47
    s_waitcnt lgkmcnt(2)
    v_cmp_ne_u64 s[50:51], v[72:73], v[68:69]
    v_cmpx_ne_u64 s[54:55], v[74:75], v[70:71]
    s_and_b64 s[82:83], s[54:55], s[80:81]
    s_cbranch_scc1 L2_c35
L2_d35:
    v_mov_b64 v[84:85], v[70:71]
    v_mov_b32 v7, v93
    v_mov_b64 v[86:87], v[74:75]
    s_or_b64 s[80:81], s[80:81], s[54:55]
    s_mov_b64 exec, s[50:51]
    s_and_b64 s[82:83], s[50:51], s[80:81]
    s_cbranch_scc1 L2_c36
L2_d36:
    v_mov_b64 v[84:85], v[68:69]
    v_mov_b32 v7, v92
    v_mov_b64 v[86:87], v[72:73]
    s_mov_b64 exec, -1
    s_or_b64 s[80:81], s[80:81], s[50:51]
    ds_read_b64 v[70:71], v95 offset:65408
    ds_read_b64 v[68:69], v94 offset:65408
    v_bitop3_b32 v92, v28, v5, v99 bitop3:0xea
    v_bitop3_b32 v93, v29, v5, v46 bitop3:0xea
    v_perm_b32 v15, v29, v32, s45
    v_bitop3_b32 v46, v29, 0.5, -0.5 bitop3:0xa8
    v_perm_b32 v14, v28, v32, s44
    v_bitop3_b32 v47, v28, 0.5, -0.5 bitop3:0xa8
    v_bitop3_b32 v15, v6, v15, v46 bitop3:0xca
    v_bitop3_b32 v14, v6, v14, v47 bitop3:0xca
    s_waitcnt lgkmcnt(1)
    v_mfma_f32_4x4x4_16b_bf16 v[80:83], v[10:11], v[70:71], v[80:83]
    s_waitcnt lgkmcnt(0)
    v_mfma_f32_4x4x4_16b_bf16 v[76:79], v[10:11], v[68:69], v[76:79]
    s_nop 2
    v_cvt_pk_bf16_f32 v80, v80, v81
    v_cvt_pk_bf16_f32 v81, v82, v83
    ds_wrxchg_rtn_b64 v[74:75], v95, v[80:81] offset:65408
    v_cvt_pk_bf16_f32 v76, v76, v77
    v_cvt_pk_bf16_f32 v77, v78, v79
    ds_wrxchg_rtn_b64 v[72:73], v94, v[76:77] offset:65408
    s_setprio 1
    v_mfma_f32_4x4x4_16b_bf16 v[80:83], v[8:9], v[102:103], 0
    v_mfma_f32_4x4x4_16b_bf16 v[76:79], v[8:9], v[100:101], 0
    v_cmp_lt_u32 s[84:85], v5, v92
    s_nop 2
    v_pk_mul_f32 v[80:81], v[80:81], v[14:15] op_sel:[0,1] op_sel_hi:[1,1]
    v_pk_mul_f32 v[82:83], v[82:83], v[14:15] op_sel:[0,1] op_sel_hi:[1,1]
    v_pk_mul_f32 v[76:77], v[76:77], v[14:15] op_sel:[0,0] op_sel_hi:[1,0]
    v_pk_mul_f32 v[78:79], v[78:79], v[14:15] op_sel:[0,0] op_sel_hi:[1,0]
    s_bitcmp1_b32 s43, s42
    s_cbranch_scc1 L2_oa37
L2_ob37:
    buffer_load_dwordx4 v[112:115], v3, s[16:19], s40 offen offset:1024 sc1
    v_sub_u16 v88, v62, v54
    v_and_b32 v89, 3, v54
    v_add3_u32 v99, v88, v89, 3
    v_and_b32 v99, -4, v99
    v_max_u32 v99, 4, v99
    v_and_b32 v97, 0xfffc, v54
    v_bfm_b32 v96, v88, v89
    v_add_u32_dpp v91, v99, v99 row_shr:1 row_mask:0xf bank_mask:0xf bound_ctrl:1
    v_mad_u32_u24 v97, v97, 5, v2
    v_cmp_lt_u32 vcc, 16, v99
    v_add_u32_dpp v91, v91, v91 row_shr:2 row_mask:0xf bank_mask:0xf bound_ctrl:1
    v_sub_u32 v98, s38, v99
    v_lshrrev_b64 v[54:55], 16, v[54:55]
    v_add_u32_dpp v91, v91, v91 row_shr:4 row_mask:0xf bank_mask:0xf bound_ctrl:1
    v_lshrrev_b64 v[62:63], 16, v[62:63]
    s_mov_b32 s101, 0
    v_add_u32_dpp v91, v91, v91 row_shr:8 row_mask:0xf bank_mask:0xf bound_ctrl:1
    s_nop 1
    v_add_u32_dpp v91, v91, v91 row_bcast:15 row_mask:0xa bank_mask:0xf
    s_nop 1
    v_add_u32_dpp v91, v91, v91 row_bcast:31 row_mask:0xc bank_mask:0xf
    v_add_u32 v98, v98, v91
    v_readlane_b32 s37, v91, 63
    s_cbranch_vccnz L2_xo38
L2_xp38:
    v_and_b32 v46, 0x80000000, v42
    v_lshrrev_b32 v47, 14, v31
    v_bitop3_b32 v47, v47, v5, v46 bitop3:0xea
    ds_read_b64 v[106:107], v47
    v_and_b32 v99, 0x40000000, v42
    v_lshrrev_b32 v47, 14, v30
    v_bitop3_b32 v47, v47, v5, v99 bitop3:0xea
    ds_read_b64 v[104:105], v47
    s_waitcnt lgkmcnt(2)
    v_cmp_ne_u64 s[50:51], v[72:73], v[68:69]
    v_cmpx_ne_u64 s[54:55], v[74:75], v[70:71]
    s_and_b64 s[82:83], s[54:55], s[80:81]
    s_cbranch_scc1 L2_c39
L2_d39:
    v_mov_b64 v[84:85], v[70:71]
    v_mov_b32 v7, v95
    v_mov_b64 v[86:87], v[74:75]
    s_or_b64 s[80:81], s[80:81], s[54:55]
    s_mov_b64 exec, s[50:51]
    s_and_b64 s[82:83], s[50:51], s[80:81]
    s_cbranch_scc1 L2_c40
L2_d40:
    v_mov_b64 v[84:85], v[68:69]
    v_mov_b32 v7, v94
    v_mov_b64 v[86:87], v[72:73]
    s_mov_b64 exec, -1
    s_or_b64 s[80:81], s[80:81], s[50:51]
    s_and_b64 exec, s[84:85], s[80:81]
    v_mfma_f32_4x4x4_16b_bf16 v[76:79], v[12:13], v[84:85], 0
    v_mov_b32 v92, v7
    s_andn2_b64 s[80:81], s[80:81], s[84:85]
    v_mfma_f32_4x4x4_16b_bf16 v[76:79], v[10:11], v[86:87], v[76:79]
    s_mov_b64 exec, -1
    ds_read_b64 v[70:71], v93 offset:65408
    ds_read_b64 v[68:69], v92 offset:65408
    v_bitop3_b32 v94, v30, v5, v99 bitop3:0xea
    v_bitop3_b32 v95, v31, v5, v46 bitop3:0xea
    v_perm_b32 v15, v31, v32, s47
    v_bitop3_b32 v46, v31, 0.5, -0.5 bitop3:0xa8
    v_perm_b32 v14, v30, v32, s46
    v_bitop3_b32 v47, v30, 0.5, -0.5 bitop3:0xa8
    v_bitop3_b32 v15, v6, v15, v46 bitop3:0xca
    v_bitop3_b32 v14, v6, v14, v47 bitop3:0xca
    s_waitcnt lgkmcnt(1)
    v_mfma_f32_4x4x4_16b_bf16 v[80:83], v[10:11], v[70:71], v[80:83]
    s_waitcnt lgkmcnt(0)
    v_mfma_f32_4x4x4_16b_bf16 v[76:79], v[10:11], v[68:69], v[76:79]
    s_nop 2
    v_cvt_pk_bf16_f32 v80, v80, v81
    v_cvt_pk_bf16_f32 v81, v82, v83
    ds_wrxchg_rtn_b64 v[74:75], v93, v[80:81] offset:65408
    v_cvt_pk_bf16_f32 v76, v76, v77
    v_cvt_pk_bf16_f32 v77, v78, v79
    ds_wrxchg_rtn_b64 v[72:73], v92, v[76:77] offset:65408
    v_and_b32 v88, 0x0fffffff, v33
    buffer_load_dwordx2 v[28:29], v88, s[8:11], 0 offen
    buffer_load_dwordx3 v[30:32], v88, s[8:11], 0 offen offset:8
    s_setprio 0
    v_mfma_f32_4x4x4_16b_bf16 v[80:83], v[8:9], v[106:107], 0
    v_mfma_f32_4x4x4_16b_bf16 v[76:79], v[8:9], v[104:105], 0
    v_cmp_lt_u32 s[48:49], v5, v95
    s_nop 2
    v_pk_mul_f32 v[80:81], v[80:81], v[14:15] op_sel:[0,1] op_sel_hi:[1,1]
    v_pk_mul_f32 v[82:83], v[82:83], v[14:15] op_sel:[0,1] op_sel_hi:[1,1]
    v_pk_mul_f32 v[76:77], v[76:77], v[14:15] op_sel:[0,0] op_sel_hi:[1,0]
    v_pk_mul_f32 v[78:79], v[78:79], v[14:15] op_sel:[0,0] op_sel_hi:[1,0]
    s_add_u32 s40, s40, 0x50000
    s_waitcnt vmcnt(8)
    v_and_b32 v46, 0x80000000, v43
    v_lshrrev_b32 v47, 14, v37
    v_bitop3_b32 v47, v47, v5, v46 bitop3:0xea
    ds_read_b64 v[106:107], v47
    v_and_b32 v99, 0x40000000, v43
    v_lshrrev_b32 v47, 14, v36
    v_bitop3_b32 v47, v47, v5, v99 bitop3:0xea
    ds_read_b64 v[104:105], v47
    v_and_b32 v46, 0x20000000, v43
    v_lshrrev_b32 v47, 14, v35
    v_bitop3_b32 v47, v47, v5, v46 bitop3:0xea
    ds_read_b64 v[102:103], v47
    v_and_b32 v99, 0x10000000, v43
    v_lshrrev_b32 v47, 14, v34
    v_bitop3_b32 v47, v47, v5, v99 bitop3:0xea
    ds_read_b64 v[100:101], v47
    s_waitcnt lgkmcnt(4)
    v_cmp_ne_u64 s[50:51], v[72:73], v[68:69]
    v_cmpx_ne_u64 s[54:55], v[74:75], v[70:71]
    s_and_b64 s[82:83], s[54:55], s[80:81]
    s_cbranch_scc1 L2_c41
L2_d41:
    v_mov_b64 v[84:85], v[70:71]
    v_mov_b32 v7, v93
    v_mov_b64 v[86:87], v[74:75]
    s_or_b64 s[80:81], s[80:81], s[54:55]
    s_mov_b64 exec, s[50:51]
    s_and_b64 s[82:83], s[50:51], s[80:81]
    s_cbranch_scc1 L2_c42
L2_d42:
    v_mov_b64 v[84:85], v[68:69]
    v_mov_b32 v7, v92
    v_mov_b64 v[86:87], v[72:73]
    s_mov_b64 exec, -1
    s_or_b64 s[80:81], s[80:81], s[50:51]
    s_and_b64 exec, s[48:49], s[80:81]
    v_mfma_f32_4x4x4_16b_bf16 v[80:83], v[12:13], v[84:85], 0
    v_mov_b32 v95, v7
    s_andn2_b64 s[80:81], s[80:81], s[48:49]
    v_mfma_f32_4x4x4_16b_bf16 v[80:83], v[10:11], v[86:87], v[80:83]
    s_mov_b64 exec, -1
    ds_read_b64 v[70:71], v95 offset:65408
    ds_read_b64 v[68:69], v94 offset:65408
    v_bitop3_b32 v92, v34, v5, v99 bitop3:0xea
    v_bitop3_b32 v93, v35, v5, v46 bitop3:0xea
    v_perm_b32 v15, v35, v38, s45
    v_bitop3_b32 v46, v35, 0.5, -0.5 bitop3:0xa8
    v_perm_b32 v14, v34, v38, s44
    v_bitop3_b32 v47, v34, 0.5, -0.5 bitop3:0xa8
    v_bitop3_b32 v15, v6, v15, v46 bitop3:0xca
    v_bitop3_b32 v14, v6, v14, v47 bitop3:0xca
    s_waitcnt lgkmcnt(1)
    v_mfma_f32_4x4x4_16b_bf16 v[80:83], v[10:11], v[70:71], v[80:83]
    s_waitcnt lgkmcnt(0)
    v_mfma_f32_4x4x4_16b_bf16 v[76:79], v[10:11], v[68:69], v[76:79]
    s_nop 2
    v_cvt_pk_bf16_f32 v80, v80, v81
    v_cvt_pk_bf16_f32 v81, v82, v83
    ds_wrxchg_rtn_b64 v[74:75], v95, v[80:81] offset:65408
    v_cvt_pk_bf16_f32 v76, v76, v77
    v_cvt_pk_bf16_f32 v77, v78, v79
    ds_wrxchg_rtn_b64 v[72:73], v94, v[76:77] offset:65408
    s_barrier
    s_setprio 3
    s_mov_b32 m0, s100
    s_nop 0
    ds_write_addtid_b32 v124 offset:34816
    ds_write_addtid_b32 v125 offset:35072
    ds_write_addtid_b32 v126 offset:35328
    ds_write_addtid_b32 v127 offset:35584
    s_add_u32 s3, s40, 4096
    buffer_load_dwordx4 v[124:127], v3, s[16:19], s3 offen sc1
    ds_write_addtid_b32 v116 offset:32768
    ds_write_addtid_b32 v117 offset:33024
    ds_write_addtid_b32 v118 offset:33280
    ds_write_addtid_b32 v119 offset:33536
    buffer_load_dwordx4 v[116:119], v3, s[16:19], s40 offen offset:2048 sc1
    ds_write_addtid_b32 v120 offset:33792
    ds_write_addtid_b32 v121 offset:34048
    ds_write_addtid_b32 v122 offset:34304
    ds_write_addtid_b32 v123 offset:34560
    buffer_load_dwordx4 v[120:123], v3, s[16:19], s40 offen offset:3072 sc1
    v_mfma_f32_4x4x4_16b_bf16 v[80:83], v[8:9], v[102:103], 0
    v_mfma_f32_4x4x4_16b_bf16 v[76:79], v[8:9], v[100:101], 0
    s_nop 3
    v_pk_mul_f32 v[80:81], v[80:81], v[14:15] op_sel:[0,1] op_sel_hi:[1,1]
    v_pk_mul_f32 v[82:83], v[82:83], v[14:15] op_sel:[0,1] op_sel_hi:[1,1]
    v_pk_mul_f32 v[76:77], v[76:77], v[14:15] op_sel:[0,0] op_sel_hi:[1,0]
    v_pk_mul_f32 v[78:79], v[78:79], v[14:15] op_sel:[0,0] op_sel_hi:[1,0]
    s_cmp_gt_u32 s37, 1024
    s_cbranch_scc1 L2_xs43
    s_cmp_lg_u32 s101, 0
    s_cbranch_scc1 L2_xa43
L2_xb43:
    v_lshlrev_b32 v89, 16, v96
    v_add_u32 v90, 60, v97
    v_bitop3_b32 v90, v89, v45, v90 bitop3:0x6a
    ds_write_b32 v98, v90 offset:12
    v_lshlrev_b32 v89, 20, v96
    v_add_u32 v90, 40, v97
    v_bitop3_b32 v90, v89, v45, v90 bitop3:0x6a
    ds_write_b32 v98, v90 offset:8
    v_lshlrev_b32 v89, 24, v96
    v_add_u32 v90, 20, v97
    v_bitop3_b32 v90, v89, v45, v90 bitop3:0x6a
    ds_write_b32 v98, v90 offset:4
    v_lshlrev_b32 v89, 28, v96
    v_bitop3_b32 v90, v89, v45, v97 bitop3:0x6a
    ds_write_b32 v98, v90 offset:0
    v_mov_b32_dpp v91, v66 quad_perm:[1,1,1,1] row_mask:0xf bank_mask:0xf
    v_and_b32 v89, 3, v91
    v_and_b32 v97, 0xfffc, v91
    v_sub_u16_dpp v88, v66, v91 quad_perm:[3,3,3,3] row_mask:0xf bank_mask:0xf
    v_mad_u32_u24 v97, v97, 5, v4
    v_add_u32 v99, v88, v89
    v_bfm_b32 v96, v88, v89
    v_cmp_lt_u32 s[58:59], 16, v99
    v_lshlrev_b32 v89, v1, v96
    v_and_b32 v89, v45, v89
    v_cmp_ne_u32 vcc, 0, v89
    v_xor_b32 v90, v97, v89
    s_add_u32 s3, s37, s38
    v_mbcnt_lo_u32_b32 v98, vcc_lo, 0
    v_mbcnt_hi_u32_b32 v98, vcc_hi, v98
    s_bcnt1_i32_b64 s41, vcc
    v_lshl_add_u32 v98, v98, 2, s3
    s_lshl2_add_u32 s37, s41, s37
    s_mov_b64 exec, vcc
    ds_write_b32 v98, v90
    s_mov_b64 exec, -1
    s_cmp_lg_u64 s[58:59], 0
    s_cbranch_scc1 L2_xe43
L2_xr43:
    v_add_u32 v98, s37, v0
    v_mov_b32 v90, -1
    ds_write_b32 v98, v90
L2_xw43:
    s_setprio 2
    s_waitcnt lgkmcnt(14)
    v_cmp_ne_u64 s[50:51], v[72:73], v[68:69]
    v_cmpx_ne_u64 s[54:55], v[74:75], v[70:71]
    s_and_b64 s[82:83], s[54:55], s[80:81]
    s_cbranch_scc1 L2_c44
L2_d44:
    v_mov_b64 v[84:85], v[70:71]
    v_mov_b32 v7, v95
    v_mov_b64 v[86:87], v[74:75]
    s_or_b64 s[80:81], s[80:81], s[54:55]
    s_mov_b64 exec, s[50:51]
    s_and_b64 s[82:83], s[50:51], s[80:81]
    s_cbranch_scc1 L2_c45
L2_d45:
    v_mov_b64 v[84:85], v[68:69]
    v_mov_b32 v7, v94
    v_mov_b64 v[86:87], v[72:73]
    s_mov_b64 exec, -1
    s_or_b64 s[80:81], s[80:81], s[50:51]
    ds_read_b64 v[70:71], v93 offset:65408
    ds_read_b64 v[68:69], v92 offset:65408
    v_and_b32 v46, 0x40000000, v43
    v_bitop3_b32 v94, v36, v5, v46 bitop3:0xea
    v_and_b32 v46, 0x80000000, v43
    v_bitop3_b32 v95, v37, v5, v46 bitop3:0xea
    v_perm_b32 v15, v37, v38, s47
    v_bitop3_b32 v46, v37, 0.5, -0.5 bitop3:0xa8
    v_perm_b32 v14, v36, v38, s46
    v_bitop3_b32 v47, v36, 0.5, -0.5 bitop3:0xa8
    v_bitop3_b32 v15, v6, v15, v46 bitop3:0xca
    v_bitop3_b32 v14, v6, v14, v47 bitop3:0xca
    s_setprio 1
    s_waitcnt lgkmcnt(1)
    v_mfma_f32_4x4x4_16b_bf16 v[80:83], v[10:11], v[70:71], v[80:83]
    s_waitcnt lgkmcnt(0)
    v_mfma_f32_4x4x4_16b_bf16 v[76:79], v[10:11], v[68:69], v[76:79]
    s_nop 2
    v_cvt_pk_bf16_f32 v80, v80, v81
    v_cvt_pk_bf16_f32 v81, v82, v83
    ds_wrxchg_rtn_b64 v[74:75], v93, v[80:81] offset:65408
    v_cvt_pk_bf16_f32 v76, v76, v77
    v_cvt_pk_bf16_f32 v77, v78, v79
    ds_wrxchg_rtn_b64 v[72:73], v92, v[76:77] offset:65408
    ds_read_b32 v40, v44 offset:768
    ds_read_b32 v41, v0 offset:0
    ds_read_b32 v42, v0 offset:256
    ds_read_b32 v43, v0 offset:512
    s_sub_u32 s3, s37, 768
    s_cmp_gt_u32 s3, 128
    s_cbranch_scc1 L2_xf43
L2_xg43:
    v_lshrrev_b64 v[64:65], 16, v[64:65]
    v_lshrrev_b64 v[66:67], 16, v[66:67]
    v_and_b32 v88, 0x0fffffff, v39
    buffer_load_dwordx2 v[34:35], v88, s[8:11], 0 offen
    buffer_load_dwordx3 v[36:38], v88, s[8:11], 0 offen offset:8
    s_setprio 0
    s_waitcnt vmcnt(10)
    s_mov_b32 m0, s38
    s_nop 0
    ds_write_addtid_b32 v108 offset:0
    ds_write_addtid_b32 v109 offset:256
    ds_write_addtid_b32 v110 offset:512
    ds_write_addtid_b32 v111 offset:768
    s_waitcnt vmcnt(7)
    ds_write_addtid_b32 v112 offset:1024
    ds_write_addtid_b32 v113 offset:1280
    ds_write_addtid_b32 v114 offset:1536
    ds_write_addtid_b32 v115 offset:1792
    v_mfma_f32_4x4x4_16b_bf16 v[80:83], v[8:9], v[106:107], 0
    v_mfma_f32_4x4x4_16b_bf16 v[76:79], v[8:9], v[104:105], 0
    v_cmp_lt_u32 s[84:85], v5, v94
    s_nop 2
    v_pk_mul_f32 v[80:81], v[80:81], v[14:15] op_sel:[0,1] op_sel_hi:[1,1]
    v_pk_mul_f32 v[82:83], v[82:83], v[14:15] op_sel:[0,1] op_sel_hi:[1,1]
    v_pk_mul_f32 v[76:77], v[76:77], v[14:15] op_sel:[0,0] op_sel_hi:[1,0]
    v_pk_mul_f32 v[78:79], v[78:79], v[14:15] op_sel:[0,0] op_sel_hi:[1,0]
    s_add_u32 s42, s42, 1
    s_waitcnt lgkmcnt(0)
L2_loop:
    s_barrier
    s_bitcmp1_b32 s36, s42
    s_cbranch_scc1 L2_slow
L2_ret2:
    s_setprio 3
    s_bitcmp1_b32 s43, s42
    s_cbranch_scc1 L2_oa46
L2_ob46:
    s_mov_b64 exec, s[6:7]
    v_lshrrev_b32 v18, 16, v18
    s_mov_b64 exec, -1
    v_and_b32 v46, 0x20000000, v19
    v_lshrrev_b32 v47, 14, v17
    v_bitop3_b32 v47, v47, v5, v46 bitop3:0xea
    ds_read_b64 v[102:103], v47
    v_and_b32 v99, 0x10000000, v19
    v_lshrrev_b32 v47, 14, v16
    v_bitop3_b32 v47, v47, v5, v99 bitop3:0xea
    ds_read_b64 v[100:101], v47
    v_cmp_ne_u64 s[50:51], v[72:73], v[68:69]
    v_cmpx_ne_u64 s[54:55], v[74:75], v[70:71]
    s_and_b64 s[82:83], s[54:55], s[80:81]
    s_cbranch_scc1 L2_c47
L2_d47:
    v_mov_b64 v[84:85], v[70:71]
    v_mov_b32 v7, v93
    v_mov_b64 v[86:87], v[74:75]
    s_or_b64 s[80:81], s[80:81], s[54:55]
    s_mov_b64 exec, s[50:51]
    s_and_b64 s[82:83], s[50:51], s[80:81]
    s_cbranch_scc1 L2_c48
L2_d48:
    v_mov_b64 v[84:85], v[68:69]
    v_mov_b32 v7, v92
    v_mov_b64 v[86:87], v[72:73]
    s_mov_b64 exec, -1
    s_or_b64 s[80:81], s[80:81], s[50:51]
    s_and_b64 exec, s[84:85], s[80:81]
    v_mfma_f32_4x4x4_16b_bf16 v[76:79], v[12:13], v[84:85], 0
    v_mov_b32 v94, v7
    s_andn2_b64 s[80:81], s[80:81], s[84:85]
    v_mfma_f32_4x4x4_16b_bf16 v[76:79], v[10:11], v[86:87], v[76:79]
    s_mov_b64 exec, -1
    ds_read_b64 v[70:71], v95 offset:65408
    ds_read_b64 v[68:69], v94 offset:65408
    v_bitop3_b32 v92, v16, v5, v99 bitop3:0xea
    v_bitop3_b32 v93, v17, v5, v46 bitop3:0xea
    v_perm_b32 v15, v17, v18, s45
    v_bitop3_b32 v46, v17, 0.5, -0.5 bitop3:0xa8
    v_perm_b32 v14, v16, v18, s44
    v_bitop3_b32 v47, v16, 0.5, -0.5 bitop3:0xa8
    v_bitop3_b32 v15, v6, v15, v46 bitop3:0xca
    v_bitop3_b32 v14, v6, v14, v47 bitop3:0xca
    s_waitcnt lgkmcnt(1)
    v_mfma_f32_4x4x4_16b_bf16 v[80:83], v[10:11], v[70:71], v[80:83]
    s_waitcnt lgkmcnt(0)
    v_mfma_f32_4x4x4_16b_bf16 v[76:79], v[10:11], v[68:69], v[76:79]
    s_nop 2
    v_cvt_pk_bf16_f32 v80, v80, v81
    v_cvt_pk_bf16_f32 v81, v82, v83
    ds_wrxchg_rtn_b64 v[74:75], v95, v[80:81] offset:65408
    v_cvt_pk_bf16_f32 v76, v76, v77
    v_cvt_pk_bf16_f32 v77, v78, v79
    ds_wrxchg_rtn_b64 v[72:73], v94, v[76:77] offset:65408
    v_mfma_f32_4x4x4_16b_bf16 v[80:83], v[8:9], v[102:103], 0
    v_mfma_f32_4x4x4_16b_bf16 v[76:79], v[8:9], v[100:101], 0
    v_cmp_lt_u32 s[84:85], v5, v92
    s_nop 2
    v_pk_mul_f32 v[80:81], v[80:81], v[14:15] op_sel:[0,1] op_sel_hi:[1,1]
    v_pk_mul_f32 v[82:83], v[82:83], v[14:15] op_sel:[0,1] op_sel_hi:[1,1]
    v_pk_mul_f32 v[76:77], v[76:77], v[14:15] op_sel:[0,0] op_sel_hi:[1,0]
    v_pk_mul_f32 v[78:79], v[78:79], v[14:15] op_sel:[0,0] op_sel_hi:[1,0]
    v_and_b32 v47, 0x0fffffff, v40
    buffer_load_dword v18, v47, s[8:11], 0 offen offset:16
    s_mov_b64 exec, s[6:7]
    v_add_u32 v47, 8, v47
    v_lshrrev_b32 v40, 2, v40
    s_mov_b64 exec, -1
    buffer_load_dwordx2 v[16:17], v47, s[8:11], 0 offen
    v_and_b32 v46, 0x20000000, v27
    v_lshrrev_b32 v47, 14, v23
    v_bitop3_b32 v47, v47, v5, v46 bitop3:0xea
    ds_read_b64 v[106:107], v47
    v_and_b32 v99, 0x10000000, v27
    v_lshrrev_b32 v47, 14, v22
    v_bitop3_b32 v47, v47, v5, v99 bitop3:0xea
    ds_read_b64 v[104:105], v47
    s_waitcnt lgkmcnt(2)
    v_cmp_ne_u64 s[50:51], v[72:73], v[68:69]
    v_cmpx_ne_u64 s[54:55], v[74:75], v[70:71]
    s_and_b64 s[82:83], s[54:55], s[80:81]
    s_cbranch_scc1 L2_c49
L2_d49:
    v_mov_b64 v[84:85], v[70:71]
    v_mov_b32 v7, v95
    v_mov_b64 v[86:87], v[74:75]
    s_or_b64 s[80:81], s[80:81], s[54:55]
    s_mov_b64 exec, s[50:51]
    s_and_b64 s[82:83], s[50:51], s[80:81]
    s_cbranch_scc1 L2_c50
L2_d50:
    v_mov_b64 v[84:85], v[68:69]
    v_mov_b32 v7, v94
    v_mov_b64 v[86:87], v[72:73]
    s_mov_b64 exec, -1
    s_or_b64 s[80:81], s[80:81], s[50:51]
    s_and_b64 exec, s[84:85], s[80:81]
    v_mfma_f32_4x4x4_16b_bf16 v[76:79], v[12:13], v[84:85], 0
    v_mov_b32 v92, v7
    s_andn2_b64 s[80:81], s[80:81], s[84:85]
    v_mfma_f32_4x4x4_16b_bf16 v[76:79], v[10:11], v[86:87], v[76:79]
    s_mov_b64 exec, -1
    ds_read_b64 v[70:71], v93 offset:65408
    ds_read_b64 v[68:69], v92 offset:65408
    v_bitop3_b32 v94, v22, v5, v99 bitop3:0xea
    v_bitop3_b32 v95, v23, v5, v46 bitop3:0xea
    v_perm_b32 v15, v23, v26, s45
    v_bitop3_b32 v46, v23, 0.5, -0.5 bitop3:0xa8
    v_perm_b32 v14, v22, v26, s44
    v_bitop3_b32 v47, v22, 0.5, -0.5 bitop3:0xa8
    v_bitop3_b32 v15, v6, v15, v46 bitop3:0xca
    v_bitop3_b32 v14, v6, v14, v47 bitop3:0xca
    s_waitcnt lgkmcnt(1)
    v_mfma_f32_4x4x4_16b_bf16 v[80:83], v[10:11], v[70:71], v[80:83]
    s_waitcnt lgkmcnt(0)
    v_mfma_f32_4x4x4_16b_bf16 v[76:79], v[10:11], v[68:69], v[76:79]
    s_nop 2
    v_cvt_pk_bf16_f32 v80, v80, v81
    v_cvt_pk_bf16_f32 v81, v82, v83
    ds_wrxchg_rtn_b64 v[74:75], v93, v[80:81] offset:65408
    v_cvt_pk_bf16_f32 v76, v76, v77
    v_cvt_pk_bf16_f32 v77, v78, v79
    ds_wrxchg_rtn_b64 v[72:73], v92, v[76:77] offset:65408
    v_mfma_f32_4x4x4_16b_bf16 v[80:83], v[8:9], v[106:107], 0
    v_mfma_f32_4x4x4_16b_bf16 v[76:79], v[8:9], v[104:105], 0
    v_cmp_lt_u32 s[48:49], v5, v95
    s_nop 2
    v_pk_mul_f32 v[80:81], v[80:81], v[14:15] op_sel:[0,1] op_sel_hi:[1,1]
    v_pk_mul_f32 v[82:83], v[82:83], v[14:15] op_sel:[0,1] op_sel_hi:[1,1]
    v_pk_mul_f32 v[76:77], v[76:77], v[14:15] op_sel:[0,0] op_sel_hi:[1,0]
    v_pk_mul_f32 v[78:79], v[78:79], v[14:15] op_sel:[0,0] op_sel_hi:[1,0]
    buffer_load_dwordx4 v[108:111], v3, s[16:19], s40 offen offset:0 sc1
    v_and_b32 v46, 0x80000000, v27
    v_lshrrev_b32 v47, 14, v25
    v_bitop3_b32 v47, v47, v5, v46 bitop3:0xea
    ds_read_b64 v[102:103], v47
    v_and_b32 v99, 0x40000000, v27
    v_lshrrev_b32 v47, 14, v24
    v_bitop3_b32 v47, v47, v5, v99 bitop3:0xea
    ds_read_b64 v[100:101], v47
    s_waitcnt lgkmcnt(2)
    v_cmp_ne_u64 s[50:51], v[72:73], v[68:69]
    v_cmpx_ne_u64 s[54:55], v[74:75], v[70:71]
    s_and_b64 s[82:83], s[54:55], s[80:81]
    s_cbranch_scc1 L2_c51
L2_d51:
    v_mov_b64 v[84:85], v[70:71]
    v_mov_b32 v7, v93
    v_mov_b64 v[86:87], v[74:75]
    s_or_b64 s[80:81], s[80:81], s[54:55]
    s_mov_b64 exec, s[50:51]
    s_and_b64 s[82:83], s[50:51], s[80:81]
    s_cbranch_scc1 L2_c52
L2_d52:
    v_mov_b64 v[84:85], v[68:69]
    v_mov_b32 v7, v92
    v_mov_b64 v[86:87], v[72:73]
    s_mov_b64 exec, -1
    s_or_b64 s[80:81], s[80:81], s[50:51]
    s_and_b64 exec, s[48:49], s[80:81]
    v_mfma_f32_4x4x4_16b_bf16 v[80:83], v[12:13], v[84:85], 0
    v_mov_b32 v95, v7
    s_andn2_b64 s[80:81], s[80:81], s[48:49]
    v_mfma_f32_4x4x4_16b_bf16 v[80:83], v[10:11], v[86:87], v[80:83]
    s_mov_b64 exec, -1
    ds_read_b64 v[70:71], v95 offset:65408
    ds_read_b64 v[68:69], v94 offset:65408
    v_bitop3_b32 v92, v24, v5, v99 bitop3:0xea
    v_bitop3_b32 v93, v25, v5, v46 bitop3:0xea
    v_perm_b32 v15, v25, v26, s47
    v_bitop3_b32 v46, v25, 0.5, -0.5 bitop3:0xa8
    v_perm_b32 v14, v24, v26, s46
    v_bitop3_b32 v47, v24, 0.5, -0.5 bitop3:0xa8
    v_bitop3_b32 v15, v6, v15, v46 bitop3:0xca
    v_bitop3_b32 v14, v6, v14, v47 bitop3:0xca
    s_waitcnt lgkmcnt(1)
    v_mfma_f32_4x4x4_16b_bf16 v[80:83], v[10:11], v[70:71], v[80:83]
    s_waitcnt lgkmcnt(0)
    v_mfma_f32_4x4x4_16b_bf16 v[76:79], v[10:11], v[68:69], v[76:79]
    s_nop 2
    v_cvt_pk_bf16_f32 v80, v80, v81
    v_cvt_pk_bf16_f32 v81, v82, v83
    ds_wrxchg_rtn_b64 v[74:75], v95, v[80:81] offset:65408
    v_cvt_pk_bf16_f32 v76, v76, v77
    v_cvt_pk_bf16_f32 v77, v78, v79
    ds_wrxchg_rtn_b64 v[72:73], v94, v[76:77] offset:65408
    v_and_b32 v88, 0x0fffffff, v41
    buffer_load_dwordx2 v[22:23], v88, s[8:11], 0 offen
    buffer_load_dwordx3 v[24:26], v88, s[8:11], 0 offen offset:8
    s_setprio 2
    v_mfma_f32_4x4x4_16b_bf16 v[80:83], v[8:9], v[102:103], 0
    v_mfma_f32_4x4x4_16b_bf16 v[76:79], v[8:9], v[100:101], 0
    s_nop 3
    v_pk_mul_f32 v[80:81], v[80:81], v[14:15] op_sel:[0,1] op_sel_hi:[1,1]
    v_pk_mul_f32 v[82:83], v[82:83], v[14:15] op_sel:[0,1] op_sel_hi:[1,1]
    v_pk_mul_f32 v[76:77], v[76:77], v[14:15] op_sel:[0,0] op_sel_hi:[1,0]
    v_pk_mul_f32 v[78:79], v[78:79], v[14:15] op_sel:[0,0] op_sel_hi:[1,0]
    s_waitcnt vmcnt(10)
    v_and_b32 v46, 0x20000000, v33
    v_lshrrev_b32 v47, 14, v29
    v_bitop3_b32 v47, v47, v5, v46 bitop3:0xea
    ds_read_b64 v[106:107], v47
    v_and_b32 v99, 0x10000000, v33
    v_lshrrev_b32 v47, 14, v28
    v_bitop3_b32 v47, v47, v5, v99 bitop3:0xea
    ds_read_b64 v[104:105], v47
    s_waitcnt lgkmcnt(2)
    v_cmp_ne_u64 s[50:51], v[72:73], v[68:69]
    v_cmpx_ne_u64 s[54:55], v[74:75], v[70:71]
    s_and_b64 s[82:83], s[54:55], s[80:81]
    s_cbranch_scc1 L2_c53
L2_d53:
    v_mov_b64 v[84:85], v[70:71]
    v_mov_b32 v7, v95
    v_mov_b64 v[86:87], v[74:75]
    s_or_b64 s[80:81], s[80:81], s[54:55]
    s_mov_b64 exec, s[50:51]
    s_and_b64 s[82:83], s[50:51], s[80:81]
    s_cbranch_scc1 L2_c54
L2_d54:
    v_mov_b64 v[84:85], v[68:69]
    v_mov_b32 v7, v94
    v_mov_b64 v[86:87], v[72:73]
    s_mov_b64 exec, -1
    s_or_b64 s[80:81], s[80:81], s[50:51]
    ds_read_b64 v[70:71], v93 offset:65408
    ds_read_b64 v[68:69], v92 offset:65408
    v_bitop3_b32 v94, v28, v5, v99 bitop3:0xea
    v_bitop3_b32 v95, v29, v5, v46 bitop3:0xea
    v_perm_b32 v15, v29, v32, s45
    v_bitop3_b32 v46, v29, 0.5, -0.5 bitop3:0xa8
    v_perm_b32 v14, v28, v32, s44
    v_bitop3_b32 v47, v28, 0.5, -0.5 bitop3:0xa8
    v_bitop3_b32 v15, v6, v15, v46 bitop3:0xca
    v_bitop3_b32 v14, v6, v14, v47 bitop3:0xca
    s_waitcnt lgkmcnt(1)
    v_mfma_f32_4x4x4_16b_bf16 v[80:83], v[10:11], v[70:71], v[80:83]
    s_waitcnt lgkmcnt(0)
    v_mfma_f32_4x4x4_16b_bf16 v[76:79], v[10:11], v[68:69], v[76:79]
    s_nop 2
    v_cvt_pk_bf16_f32 v80, v80, v81
    v_cvt_pk_bf16_f32 v81, v82, v83
    ds_wrxchg_rtn_b64 v[74:75], v93, v[80:81] offset:65408
    v_cvt_pk_bf16_f32 v76, v76, v77
    v_cvt_pk_bf16_f32 v77, v78, v79
    ds_wrxchg_rtn_b64 v[72:73], v92, v[76:77] offset:65408
    s_setprio 1
    v_mfma_f32_4x4x4_16b_bf16 v[80:83], v[8:9], v[106:107], 0
    v_mfma_f32_4x4x4_16b_bf16 v[76:79], v[8:9], v[104:105], 0
    v_cmp_lt_u32 s[84:85], v5, v94
    s_nop 2
    v_pk_mul_f32 v[80:81], v[80:81], v[14:15] op_sel:[0,1] op_sel_hi:[1,1]
    v_pk_mul_f32 v[82:83], v[82:83], v[14:15] op_sel:[0,1] op_sel_hi:[1,1]
    v_pk_mul_f32 v[76:77], v[76:77], v[14:15] op_sel:[0,0] op_sel_hi:[1,0]
    v_pk_mul_f32 v[78:79], v[78:79], v[14:15] op_sel:[0,0] op_sel_hi:[1,0]
    s_bitcmp1_b32 s43, s42
    s_cbranch_scc1 L2_oa55
L2_ob55:
    buffer_load_dwordx4 v[112:115], v3, s[16:19], s40 offen offset:1024 sc1
    v_sub_u16 v88, v56, v48
    v_and_b32 v89, 3, v48
    v_add3_u32 v99, v88, v89, 3
    v_and_b32 v99, -4, v99
    v_max_u32 v99, 4, v99
    v_and_b32 v97, 0xfffc, v48
    v_bfm_b32 v96, v88, v89
    v_add_u32_dpp v91, v99, v99 row_shr:1 row_mask:0xf bank_mask:0xf bound_ctrl:1
    v_mad_u32_u24 v97, v97, 5, v2
    v_cmp_lt_u32 vcc, 16, v99
    v_add_u32_dpp v91, v91, v91 row_shr:2 row_mask:0xf bank_mask:0xf bound_ctrl:1
    v_sub_u32 v98, s38, v99
    v_lshrrev_b64 v[48:49], 16, v[48:49]
    v_add_u32_dpp v91, v91, v91 row_shr:4 row_mask:0xf bank_mask:0xf bound_ctrl:1
    v_lshrrev_b64 v[56:57], 16, v[56:57]
    s_mov_b32 s101, 0
    v_add_u32_dpp v91, v91, v91 row_shr:8 row_mask:0xf bank_mask:0xf bound_ctrl:1
    s_nop 1
    v_add_u32_dpp v91, v91, v91 row_bcast:15 row_mask:0xa bank_mask:0xf
    s_nop 1
    v_add_u32_dpp v91, v91, v91 row_bcast:31 row_mask:0xc bank_mask:0xf
    v_add_u32 v98, v98, v91
    v_readlane_b32 s37, v91, 63
    s_cbranch_vccnz L2_xo56
L2_xp56:
    v_and_b32 v46, 0x80000000, v33
    v_lshrrev_b32 v47, 14, v31
    v_bitop3_b32 v47, v47, v5, v46 bitop3:0xea
    ds_read_b64 v[102:103], v47
    v_and_b32 v99, 0x40000000, v33
    v_lshrrev_b32 v47, 14, v30
    v_bitop3_b32 v47, v47, v5, v99 bitop3:0xea
    ds_read_b64 v[100:101], v47
    s_waitcnt lgkmcnt(2)
    v_cmp_ne_u64 s[50:51], v[72:73], v[68:69]
    v_cmpx_ne_u64 s[54:55], v[74:75], v[70:71]
    s_and_b64 s[82:83], s[54:55], s[80:81]
    s_cbranch_scc1 L2_c57
L2_d57:
    v_mov_b64 v[84:85], v[70:71]
    v_mov_b32 v7, v93
    v_mov_b64 v[86:87], v[74:75]
    s_or_b64 s[80:81], s[80:81], s[54:55]
    s_mov_b64 exec, s[50:51]
    s_and_b64 s[82:83], s[50:51], s[80:81]
    s_cbranch_scc1 L2_c58
L2_d58:
    v_mov_b64 v[84:85], v[68:69]
    v_mov_b32 v7, v92
    v_mov_b64 v[86:87], v[72:73]
    s_mov_b64 exec, -1
    s_or_b64 s[80:81], s[80:81], s[50:51]
    s_and_b64 exec, s[84:85], s[80:81]
    v_mfma_f32_4x4x4_16b_bf16 v[76:79], v[12:13], v[84:85], 0
    v_mov_b32 v94, v7
    s_andn2_b64 s[80:81], s[80:81], s[84:85]
    v_mfma_f32_4x4x4_16b_bf16 v[76:79], v[10:11], v[86:87], v[76:79]
    s_mov_b64 exec, -1
    ds_read_b64 v[70:71], v95 offset:65408
    ds_read_b64 v[68:69], v94 offset:65408
    v_bitop3_b32 v92, v30, v5, v99 bitop3:0xea
    v_bitop3_b32 v93, v31, v5, v46 bitop3:0xea
    v_perm_b32 v15, v31, v32, s47
    v_bitop3_b32 v46, v31, 0.5, -0.5 bitop3:0xa8
    v_perm_b32 v14, v30, v32, s46
    v_bitop3_b32 v47, v30, 0.5, -0.5 bitop3:0xa8
    v_bitop3_b32 v15, v6, v15, v46 bitop3:0xca
    v_bitop3_b32 v14, v6, v14, v47 bitop3:0xca
    s_waitcnt lgkmcnt(1)
    v_mfma_f32_4x4x4_16b_bf16 v[80:83], v[10:11], v[70:71], v[80:83]
    s_waitcnt lgkmcnt(0)
    v_mfma_f32_4x4x4_16b_bf16 v[76:79], v[10:11], v[68:69], v[76:79]
    s_nop 2
    v_cvt_pk_bf16_f32 v80, v80, v81
    v_cvt_pk_bf16_f32 v81, v82, v83
    ds_wrxchg_rtn_b64 v[74:75], v95, v[80:81] offset:65408
    v_cvt_pk_bf16_f32 v76, v76, v77
    v_cvt_pk_bf16_f32 v77, v78, v79
    ds_wrxchg_rtn_b64 v[72:73], v94, v[76:77] offset:65408
    v_and_b32 v88, 0x0fffffff, v42
    buffer_load_dwordx2 v[28:29], v88, s[8:11], 0 offen
    buffer_load_dwordx3 v[30:32], v88, s[8:11], 0 offen offset:8
    s_setprio 0
    v_mfma_f32_4x4x4_16b_bf16 v[80:83], v[8:9], v[102:103], 0
    v_mfma_f32_4x4x4_16b_bf16 v[76:79], v[8:9], v[100:101], 0
    v_cmp_lt_u32 s[48:49], v5, v93
    s_nop 2
    v_pk_mul_f32 v[80:81], v[80:81], v[14:15] op_sel:[0,1] op_sel_hi:[1,1]
    v_pk_mul_f32 v[82:83], v[82:83], v[14:15] op_sel:[0,1] op_sel_hi:[1,1]
    v_pk_mul_f32 v[76:77], v[76:77], v[14:15] op_sel:[0,0] op_sel_hi:[1,0]
    v_pk_mul_f32 v[78:79], v[78:79], v[14:15] op_sel:[0,0] op_sel_hi:[1,0]
    s_add_u32 s40, s40, 0xfff24000
    s_waitcnt vmcnt(8)
    v_and_b32 v46, 0x80000000, v39
    v_lshrrev_b32 v47, 14, v37
    v_bitop3_b32 v47, v47, v5, v46 bitop3:0xea
    ds_read_b64 v[102:103], v47
    v_and_b32 v99, 0x40000000, v39
    v_lshrrev_b32 v47, 14, v36
    v_bitop3_b32 v47, v47, v5, v99 bitop3:0xea
    ds_read_b64 v[100:101], v47
    v_and_b32 v46, 0x20000000, v39
    v_lshrrev_b32 v47, 14, v35
    v_bitop3_b32 v47, v47, v5, v46 bitop3:0xea
    ds_read_b64 v[106:107], v47
    v_and_b32 v99, 0x10000000, v39
    v_lshrrev_b32 v47, 14, v34
    v_bitop3_b32 v47, v47, v5, v99 bitop3:0xea
    ds_read_b64 v[104:105], v47
    s_waitcnt lgkmcnt(4)
    v_cmp_ne_u64 s[50:51], v[72:73], v[68:69]
    v_cmpx_ne_u64 s[54:55], v[74:75], v[70:71]
    s_and_b64 s[82:83], s[54:55], s[80:81]
    s_cbranch_scc1 L2_c59
L2_d59:
    v_mov_b64 v[84:85], v[70:71]
    v_mov_b32 v7, v95
    v_mov_b64 v[86:87], v[74:75]
    s_or_b64 s[80:81], s[80:81], s[54:55]
    s_mov_b64 exec, s[50:51]
    s_and_b64 s[82:83], s[50:51], s[80:81]
    s_cbranch_scc1 L2_c60
L2_d60:
    v_mov_b64 v[84:85], v[68:69]
    v_mov_b32 v7, v94
    v_mov_b64 v[86:87], v[72:73]
    s_mov_b64 exec, -1
    s_or_b64 s[80:81], s[80:81], s[50:51]
    s_and_b64 exec, s[48:49], s[80:81]
    v_mfma_f32_4x4x4_16b_bf16 v[80:83], v[12:13], v[84:85], 0
    v_mov_b32 v93, v7
    s_andn2_b64 s[80:81], s[80:81], s[48:49]
    v_mfma_f32_4x4x4_16b_bf16 v[80:83], v[10:11], v[86:87], v[80:83]
    s_mov_b64 exec, -1
    ds_read_b64 v[70:71], v93 offset:65408
    ds_read_b64 v[68:69], v92 offset:65408
    v_bitop3_b32 v94, v34, v5, v99 bitop3:0xea
    v_bitop3_b32 v95, v35, v5, v46 bitop3:0xea
    v_perm_b32 v15, v35, v38, s45
    v_bitop3_b32 v46, v35, 0.5, -0.5 bitop3:0xa8
    v_perm_b32 v14, v34, v38, s44
    v_bitop3_b32 v47, v34, 0.5, -0.5 bitop3:0xa8
    v_bitop3_b32 v15, v6, v15, v46 bitop3:0xca
    v_bitop3_b32 v14, v6, v14, v47 bitop3:0xca
    s_waitcnt lgkmcnt(1)
    v_mfma_f32_4x4x4_16b_bf16 v[80:83], v[10:11], v[70:71], v[80:83]
    s_waitcnt lgkmcnt(0)
    v_mfma_f32_4x4x4_16b_bf16 v[76:79], v[10:11], v[68:69], v[76:79]
    s_nop 2
    v_cvt_pk_bf16_f32 v80, v80, v81
    v_cvt_pk_bf16_f32 v81, v82, v83
    ds_wrxchg_rtn_b64 v[74:75], v93, v[80:81] offset:65408
    v_cvt_pk_bf16_f32 v76, v76, v77
    v_cvt_pk_bf16_f32 v77, v78, v79
    ds_wrxchg_rtn_b64 v[72:73], v92, v[76:77] offset:65408
    s_barrier
    s_setprio 3
    s_mov_b32 m0, s100
    s_nop 0
    ds_write_addtid_b32 v124 offset:34816
    ds_write_addtid_b32 v125 offset:35072
    ds_write_addtid_b32 v126 offset:35328
    ds_write_addtid_b32 v127 offset:35584
    s_add_u32 s3, s40, 4096
    buffer_load_dwordx4 v[124:127], v3, s[16:19], s3 offen sc1
    ds_write_addtid_b32 v116 offset:32768
    ds_write_addtid_b32 v117 offset:33024
    ds_write_addtid_b32 v118 offset:33280
    ds_write_addtid_b32 v119 offset:33536
    buffer_load_dwordx4 v[116:119], v3, s[16:19], s40 offen offset:2048 sc1
    ds_write_addtid_b32 v120 offset:33792
    ds_write_addtid_b32 v121 offset:34048
    ds_write_addtid_b32 v122 offset:34304
    ds_write_addtid_b32 v123 offset:34560
    buffer_load_dwordx4 v[120:123], v3, s[16:19], s40 offen offset:3072 sc1
    v_mfma_f32_4x4x4_16b_bf16 v[80:83], v[8:9], v[106:107], 0
    v_mfma_f32_4x4x4_16b_bf16 v[76:79], v[8:9], v[104:105], 0
    s_nop 3
    v_pk_mul_f32 v[80:81], v[80:81], v[14:15] op_sel:[0,1] op_sel_hi:[1,1]
    v_pk_mul_f32 v[82:83], v[82:83], v[14:15] op_sel:[0,1] op_sel_hi:[1,1]
    v_pk_mul_f32 v[76:77], v[76:77], v[14:15] op_sel:[0,0] op_sel_hi:[1,0]
    v_pk_mul_f32 v[78:79], v[78:79], v[14:15] op_sel:[0,0] op_sel_hi:[1,0]
    s_cmp_gt_u32 s37, 1024
    s_cbranch_scc1 L2_xs61
    s_cmp_lg_u32 s101, 0
    s_cbranch_scc1 L2_xa61
L2_xb61:
    v_lshlrev_b32 v89, 16, v96
    v_add_u32 v90, 60, v97
    v_bitop3_b32 v90, v89, v45, v90 bitop3:0x6a
    ds_write_b32 v98, v90 offset:12
    v_lshlrev_b32 v89, 20, v96
    v_add_u32 v90, 40, v97
    v_bitop3_b32 v90, v89, v45, v90 bitop3:0x6a
    ds_write_b32 v98, v90 offset:8
    v_lshlrev_b32 v89, 24, v96
    v_add_u32 v90, 20, v97
    v_bitop3_b32 v90, v89, v45, v90 bitop3:0x6a
    ds_write_b32 v98, v90 offset:4
    v_lshlrev_b32 v89, 28, v96
    v_bitop3_b32 v90, v89, v45, v97 bitop3:0x6a
    ds_write_b32 v98, v90 offset:0
    v_mov_b32_dpp v91, v64 quad_perm:[0,0,0,0] row_mask:0xf bank_mask:0xf
    v_and_b32 v89, 3, v91
    v_and_b32 v97, 0xfffc, v91
    v_sub_u16_dpp v88, v64, v91 quad_perm:[2,2,2,2] row_mask:0xf bank_mask:0xf
    v_mad_u32_u24 v97, v97, 5, v4
    v_add_u32 v99, v88, v89
    v_bfm_b32 v96, v88, v89
    v_cmp_lt_u32 s[58:59], 16, v99
    v_lshlrev_b32 v89, v1, v96
    v_and_b32 v89, v45, v89
    v_cmp_ne_u32 vcc, 0, v89
    v_xor_b32 v90, v97, v89
    s_add_u32 s3, s37, s38
    v_mbcnt_lo_u32_b32 v98, vcc_lo, 0
    v_mbcnt_hi_u32_b32 v98, vcc_hi, v98
    s_bcnt1_i32_b64 s41, vcc
    v_lshl_add_u32 v98, v98, 2, s3
    s_lshl2_add_u32 s37, s41, s37
    s_mov_b64 exec, vcc
    ds_write_b32 v98, v90
    s_mov_b64 exec, -1
    s_cmp_lg_u64 s[58:59], 0
    s_cbranch_scc1 L2_xe61
L2_xr61:
    v_add_u32 v98, s37, v0
    v_mov_b32 v90, -1
    ds_write_b32 v98, v90
L2_xw61:
    s_setprio 2
    s_waitcnt lgkmcnt(14)
    v_cmp_ne_u64 s[50:51], v[72:73], v[68:69]
    v_cmpx_ne_u64 s[54:55], v[74:75], v[70:71]
    s_and_b64 s[82:83], s[54:55], s[80:81]
    s_cbranch_scc1 L2_c62
L2_d62:
    v_mov_b64 v[84:85], v[70:71]
    v_mov_b32 v7, v93
    v_mov_b64 v[86:87], v[74:75]
    s_or_b64 s[80:81], s[80:81], s[54:55]
    s_mov_b64 exec, s[50:51]
    s_and_b64 s[82:83], s[50:51], s[80:81]
    s_cbranch_scc1 L2_c63
L2_d63:
    v_mov_b64 v[84:85], v[68:69]
    v_mov_b32 v7, v92
    v_mov_b64 v[86:87], v[72:73]
    s_mov_b64 exec, -1
    s_or_b64 s[80:81], s[80:81], s[50:51]
    ds_read_b64 v[70:71], v95 offset:65408
    ds_read_b64 v[68:69], v94 offset:65408
    v_and_b32 v46, 0x40000000, v39
    v_bitop3_b32 v92, v36, v5, v46 bitop3:0xea
    v_and_b32 v46, 0x80000000, v39
    v_bitop3_b32 v93, v37, v5, v46 bitop3:0xea
    v_perm_b32 v15, v37, v38, s47
    v_bitop3_b32 v46, v37, 0.5, -0.5 bitop3:0xa8
    v_perm_b32 v14, v36, v38, s46
    v_bitop3_b32 v47, v36, 0.5, -0.5 bitop3:0xa8
    v_bitop3_b32 v15, v6, v15, v46 bitop3:0xca
    v_bitop3_b32 v14, v6, v14, v47 bitop3:0xca
    s_setprio 1
    s_waitcnt lgkmcnt(1)
    v_mfma_f32_4x4x4_16b_bf16 v[80:83], v[10:11], v[70:71], v[80:83]
    s_waitcnt lgkmcnt(0)
    v_mfma_f32_4x4x4_16b_bf16 v[76:79], v[10:11], v[68:69], v[76:79]
    s_nop 2
    v_cvt_pk_bf16_f32 v80, v80, v81
    v_cvt_pk_bf16_f32 v81, v82, v83
    ds_wrxchg_rtn_b64 v[74:75], v95, v[80:81] offset:65408
    v_cvt_pk_bf16_f32 v76, v76, v77
    v_cvt_pk_bf16_f32 v77, v78, v79
    ds_wrxchg_rtn_b64 v[72:73], v94, v[76:77] offset:65408
    ds_read_b32 v19, v44 offset:768
    ds_read_b32 v27, v0 offset:0
    ds_read_b32 v33, v0 offset:256
    ds_read_b32 v39, v0 offset:512
    s_sub_u32 s3, s37, 768
    s_cmp_gt_u32 s3, 128
    s_cbranch_scc1 L2_xf61
L2_xg61:
    v_and_b32 v88, 0x0fffffff, v43
    buffer_load_dwordx2 v[34:35], v88, s[8:11], 0 offen
    buffer_load_dwordx3 v[36:38], v88, s[8:11], 0 offen offset:8
    s_setprio 0
    s_waitcnt vmcnt(10)
    s_mov_b32 m0, s38
    s_nop 0
    ds_write_addtid_b32 v108 offset:0
    ds_write_addtid_b32 v109 offset:256
    ds_write_addtid_b32 v110 offset:512
    ds_write_addtid_b32 v111 offset:768
    s_waitcnt vmcnt(7)
    ds_write_addtid_b32 v112 offset:1024
    ds_write_addtid_b32 v113 offset:1280
    ds_write_addtid_b32 v114 offset:1536
    ds_write_addtid_b32 v115 offset:1792
    v_mfma_f32_4x4x4_16b_bf16 v[80:83], v[8:9], v[102:103], 0
    v_mfma_f32_4x4x4_16b_bf16 v[76:79], v[8:9], v[100:101], 0
    v_cmp_lt_u32 s[84:85], v5, v92
    s_nop 2
    v_pk_mul_f32 v[80:81], v[80:81], v[14:15] op_sel:[0,1] op_sel_hi:[1,1]
    v_pk_mul_f32 v[82:83], v[82:83], v[14:15] op_sel:[0,1] op_sel_hi:[1,1]
    v_pk_mul_f32 v[76:77], v[76:77], v[14:15] op_sel:[0,0] op_sel_hi:[1,0]
    v_pk_mul_f32 v[78:79], v[78:79], v[14:15] op_sel:[0,0] op_sel_hi:[1,0]
    s_add_u32 s42, s42, 1
    s_waitcnt lgkmcnt(0)
    s_barrier
    s_bitcmp1_b32 s36, s42
    s_cbranch_scc1 L2_slow
L2_ret3:
    s_setprio 3
    s_bitcmp1_b32 s43, s42
    s_cbranch_scc1 L2_oa64
L2_ob64:
    s_mov_b64 exec, s[6:7]
    v_lshrrev_b32 v18, 16, v18
    s_mov_b64 exec, -1
    v_and_b32 v46, 0x20000000, v40
    v_lshrrev_b32 v47, 14, v17
    v_bitop3_b32 v47, v47, v5, v46 bitop3:0xea
    ds_read_b64 v[106:107], v47
    v_and_b32 v99, 0x10000000, v40
    v_lshrrev_b32 v47, 14, v16
    v_bitop3_b32 v47, v47, v5, v99 bitop3:0xea
    ds_read_b64 v[104:105], v47
    v_cmp_ne_u64 s[50:51], v[72:73], v[68:69]
    v_cmpx_ne_u64 s[54:55], v[74:75], v[70:71]
    s_and_b64 s[82:83], s[54:55], s[80:81]
    s_cbranch_scc1 L2_c65
L2_d65:
    v_mov_b64 v[84:85], v[70:71]
    v_mov_b32 v7, v95
    v_mov_b64 v[86:87], v[74:75]
    s_or_b64 s[80:81], s[80:81], s[54:55]
    s_mov_b64 exec, s[50:51]
    s_and_b64 s[82:83], s[50:51], s[80:81]
    s_cbranch_scc1 L2_c66
L2_d66:
    v_mov_b64 v[84:85], v[68:69]
    v_mov_b32 v7, v94
    v_mov_b64 v[86:87], v[72:73]
    s_mov_b64 exec, -1
    s_or_b64 s[80:81], s[80:81], s[50:51]
    s_and_b64 exec, s[84:85], s[80:81]
    v_mfma_f32_4x4x4_16b_bf16 v[76:79], v[12:13], v[84:85], 0
    v_mov_b32 v92, v7
    s_andn2_b64 s[80:81], s[80:81], s[84:85]
    v_mfma_f32_4x4x4_16b_bf16 v[76:79], v[10:11], v[86:87], v[76:79]
    s_mov_b64 exec, -1
    ds_read_b64 v[70:71], v93 offset:65408
    ds_read_b64 v[68:69], v92 offset:65408
    v_bitop3_b32 v94, v16, v5, v99 bitop3:0xea
    v_bitop3_b32 v95, v17, v5, v46 bitop3:0xea
    v_perm_b32 v15, v17, v18, s45
    v_bitop3_b32 v46, v17, 0.5, -0.5 bitop3:0xa8
    v_perm_b32 v14, v16, v18, s44
    v_bitop3_b32 v47, v16, 0.5, -0.5 bitop3:0xa8
    v_bitop3_b32 v15, v6, v15, v46 bitop3:0xca
    v_bitop3_b32 v14, v6, v14, v47 bitop3:0xca
    s_waitcnt lgkmcnt(1)
    v_mfma_f32_4x4x4_16b_bf16 v[80:83], v[10:11], v[70:71], v[80:83]
    s_waitcnt lgkmcnt(0)
    v_mfma_f32_4x4x4_16b_bf16 v[76:79], v[10:11], v[68:69], v[76:79]
    s_nop 2
    v_cvt_pk_bf16_f32 v80, v80, v81
    v_cvt_pk_bf16_f32 v81, v82, v83
    ds_wrxchg_rtn_b64 v[74:75], v93, v[80:81] offset:65408
    v_cvt_pk_bf16_f32 v76, v76, v77
    v_cvt_pk_bf16_f32 v77, v78, v79
    ds_wrxchg_rtn_b64 v[72:73], v92, v[76:77] offset:65408
    v_mfma_f32_4x4x4_16b_bf16 v[80:83], v[8:9], v[106:107], 0
    v_mfma_f32_4x4x4_16b_bf16 v[76:79], v[8:9], v[104:105], 0
    v_cmp_lt_u32 s[84:85], v5, v94
    s_nop 2
    v_pk_mul_f32 v[80:81], v[80:81], v[14:15] op_sel:[0,1] op_sel_hi:[1,1]
    v_pk_mul_f32 v[82:83], v[82:83], v[14:15] op_sel:[0,1] op_sel_hi:[1,1]
    v_pk_mul_f32 v[76:77], v[76:77], v[14:15] op_sel:[0,0] op_sel_hi:[1,0]
    v_pk_mul_f32 v[78:79], v[78:79], v[14:15] op_sel:[0,0] op_sel_hi:[1,0]
    v_and_b32 v47, 0x0fffffff, v19
    buffer_load_dword v18, v47, s[8:11], 0 offen offset:16
    s_mov_b64 exec, s[6:7]
    v_add_u32 v47, 8, v47
    v_lshrrev_b32 v19, 2, v19
    s_mov_b64 exec, -1
    buffer_load_dwordx2 v[16:17], v47, s[8:11], 0 offen
    v_and_b32 v46, 0x20000000, v41
    v_lshrrev_b32 v47, 14, v23
    v_bitop3_b32 v47, v47, v5, v46 bitop3:0xea
    ds_read_b64 v[102:103], v47
    v_and_b32 v99, 0x10000000, v41
    v_lshrrev_b32 v47, 14, v22
    v_bitop3_b32 v47, v47, v5, v99 bitop3:0xea
    ds_read_b64 v[100:101], v47
    s_waitcnt lgkmcnt(2)
    v_cmp_ne_u64 s[50:51], v[72:73], v[68:69]
    v_cmpx_ne_u64 s[54:55], v[74:75], v[70:71]
    s_and_b64 s[82:83], s[54:55], s[80:81]
    s_cbranch_scc1 L2_c67
L2_d67:
    v_mov_b64 v[84:85], v[70:71]
    v_mov_b32 v7, v93
    v_mov_b64 v[86:87], v[74:75]
    s_or_b64 s[80:81], s[80:81], s[54:55]
    s_mov_b64 exec, s[50:51]
    s_and_b64 s[82:83], s[50:51], s[80:81]
    s_cbranch_scc1 L2_c68
L2_d68:
    v_mov_b64 v[84:85], v[68:69]
    v_mov_b32 v7, v92
    v_mov_b64 v[86:87], v[72:73]
    s_mov_b64 exec, -1
    s_or_b64 s[80:81], s[80:81], s[50:51]
    s_and_b64 exec, s[84:85], s[80:81]
    v_mfma_f32_4x4x4_16b_bf16 v[76:79], v[12:13], v[84:85], 0
    v_mov_b32 v94, v7
    s_andn2_b64 s[80:81], s[80:81], s[84:85]
    v_mfma_f32_4x4x4_16b_bf16 v[76:79], v[10:11], v[86:87], v[76:79]
    s_mov_b64 exec, -1
    ds_read_b64 v[70:71], v95 offset:65408
    ds_read_b64 v[68:69], v94 offset:65408
    v_bitop3_b32 v92, v22, v5, v99 bitop3:0xea
    v_bitop3_b32 v93, v23, v5, v46 bitop3:0xea
    v_perm_b32 v15, v23, v26, s45
    v_bitop3_b32 v46, v23, 0.5, -0.5 bitop3:0xa8
    v_perm_b32 v14, v22, v26, s44
    v_bitop3_b32 v47, v22, 0.5, -0.5 bitop3:0xa8
    v_bitop3_b32 v15, v6, v15, v46 bitop3:0xca
    v_bitop3_b32 v14, v6, v14, v47 bitop3:0xca
    s_waitcnt lgkmcnt(1)
    v_mfma_f32_4x4x4_16b_bf16 v[80:83], v[10:11], v[70:71], v[80:83]
    s_waitcnt lgkmcnt(0)
    v_mfma_f32_4x4x4_16b_bf16 v[76:79], v[10:11], v[68:69], v[76:79]
    s_nop 2
    v_cvt_pk_bf16_f32 v80, v80, v81
    v_cvt_pk_bf16_f32 v81, v82, v83
    ds_wrxchg_rtn_b64 v[74:75], v95, v[80:81] offset:65408
    v_cvt_pk_bf16_f32 v76, v76, v77
    v_cvt_pk_bf16_f32 v77, v78, v79
    ds_wrxchg_rtn_b64 v[72:73], v94, v[76:77] offset:65408
    v_mfma_f32_4x4x4_16b_bf16 v[80:83], v[8:9], v[102:103], 0
    v_mfma_f32_4x4x4_16b_bf16 v[76:79], v[8:9], v[100:101], 0
    v_cmp_lt_u32 s[48:49], v5, v93
    s_nop 2
    v_pk_mul_f32 v[80:81], v[80:81], v[14:15] op_sel:[0,1] op_sel_hi:[1,1]
    v_pk_mul_f32 v[82:83], v[82:83], v[14:15] op_sel:[0,1] op_sel_hi:[1,1]
    v_pk_mul_f32 v[76:77], v[76:77], v[14:15] op_sel:[0,0] op_sel_hi:[1,0]
    v_pk_mul_f32 v[78:79], v[78:79], v[14:15] op_sel:[0,0] op_sel_hi:[1,0]
    buffer_load_dwordx4 v[108:111], v3, s[16:19], s40 offen offset:0 sc1
    v_and_b32 v46, 0x80000000, v41
    v_lshrrev_b32 v47, 14, v25
    v_bitop3_b32 v47, v47, v5, v46 bitop3:0xea
    ds_read_b64 v[106:107], v47
    v_and_b32 v99, 0x40000000, v41
    v_lshrrev_b32 v47, 14, v24
    v_bitop3_b32 v47, v47, v5, v99 bitop3:0xea
    ds_read_b64 v[104:105], v47
    s_waitcnt lgkmcnt(2)
    v_cmp_ne_u64 s[50:51], v[72:73], v[68:69]
    v_cmpx_ne_u64 s[54:55], v[74:75], v[70:71]
    s_and_b64 s[82:83], s[54:55], s[80:81]
    s_cbranch_scc1 L2_c69
L2_d69:
    v_mov_b64 v[84:85], v[70:71]
    v_mov_b32 v7, v95
    v_mov_b64 v[86:87], v[74:75]
    s_or_b64 s[80:81], s[80:81], s[54:55]
    s_mov_b64 exec, s[50:51]
    s_and_b64 s[82:83], s[50:51], s[80:81]
    s_cbranch_scc1 L2_c70
L2_d70:
    v_mov_b64 v[84:85], v[68:69]
    v_mov_b32 v7, v94
    v_mov_b64 v[86:87], v[72:73]
    s_mov_b64 exec, -1
    s_or_b64 s[80:81], s[80:81], s[50:51]
    s_and_b64 exec, s[48:49], s[80:81]
    v_mfma_f32_4x4x4_16b_bf16 v[80:83], v[12:13], v[84:85], 0
    v_mov_b32 v93, v7
    s_andn2_b64 s[80:81], s[80:81], s[48:49]
    v_mfma_f32_4x4x4_16b_bf16 v[80:83], v[10:11], v[86:87], v[80:83]
    s_mov_b64 exec, -1
    ds_read_b64 v[70:71], v93 offset:65408
    ds_read_b64 v[68:69], v92 offset:65408
    v_bitop3_b32 v94, v24, v5, v99 bitop3:0xea
    v_bitop3_b32 v95, v25, v5, v46 bitop3:0xea
    v_perm_b32 v15, v25, v26, s47
    v_bitop3_b32 v46, v25, 0.5, -0.5 bitop3:0xa8
    v_perm_b32 v14, v24, v26, s46
    v_bitop3_b32 v47, v24, 0.5, -0.5 bitop3:0xa8
    v_bitop3_b32 v15, v6, v15, v46 bitop3:0xca
    v_bitop3_b32 v14, v6, v14, v47 bitop3:0xca
    s_waitcnt lgkmcnt(1)
    v_mfma_f32_4x4x4_16b_bf16 v[80:83], v[10:11], v[70:71], v[80:83]
    s_waitcnt lgkmcnt(0)
    v_mfma_f32_4x4x4_16b_bf16 v[76:79], v[10:11], v[68:69], v[76:79]
    s_nop 2
    v_cvt_pk_bf16_f32 v80, v80, v81
    v_cvt_pk_bf16_f32 v81, v82, v83
    ds_wrxchg_rtn_b64 v[74:75], v93, v[80:81] offset:65408
    v_cvt_pk_bf16_f32 v76, v76, v77
    v_cvt_pk_bf16_f32 v77, v78, v79
    ds_wrxchg_rtn_b64 v[72:73], v92, v[76:77] offset:65408
    v_and_b32 v88, 0x0fffffff, v27
    buffer_load_dwordx2 v[22:23], v88, s[8:11], 0 offen
    buffer_load_dwordx3 v[24:26], v88, s[8:11], 0 offen offset:8
    s_setprio 2
    v_mfma_f32_4x4x4_16b_bf16 v[80:83], v[8:9], v[106:107], 0
    v_mfma_f32_4x4x4_16b_bf16 v[76:79], v[8:9], v[104:105], 0
    s_nop 3
    v_pk_mul_f32 v[80:81], v[80:81], v[14:15] op_sel:[0,1] op_sel_hi:[1,1]
    v_pk_mul_f32 v[82:83], v[82:83], v[14:15] op_sel:[0,1] op_sel_hi:[1,1]
    v_pk_mul_f32 v[76:77], v[76:77], v[14:15] op_sel:[0,0] op_sel_hi:[1,0]
    v_pk_mul_f32 v[78:79], v[78:79], v[14:15] op_sel:[0,0] op_sel_hi:[1,0]
    s_waitcnt vmcnt(10)
    v_and_b32 v46, 0x20000000, v42
    v_lshrrev_b32 v47, 14, v29
    v_bitop3_b32 v47, v47, v5, v46 bitop3:0xea
    ds_read_b64 v[102:103], v47
    v_and_b32 v99, 0x10000000, v42
    v_lshrrev_b32 v47, 14, v28
    v_bitop3_b32 v47, v47, v5, v99 bitop3:0xea
    ds_read_b64 v[100:101], v47
    s_waitcnt lgkmcnt(2)
    v_cmp_ne_u64 s[50:51], v[72:73], v[68:69]
    v_cmpx_ne_u64 s[54:55], v[74:75], v[70:71]
    s_and_b64 s[82:83], s[54:55], s[80:81]
    s_cbranch_scc1 L2_c71
L2_d71:
    v_mov_b64 v[84:85], v[70:71]
    v_mov_b32 v7, v93
    v_mov_b64 v[86:87], v[74:75]
    s_or_b64 s[80:81], s[80:81], s[54:55]
    s_mov_b64 exec, s[50:51]
    s_and_b64 s[82:83], s[50:51], s[80:81]
    s_cbranch_scc1 L2_c72
L2_d72:
    v_mov_b64 v[84:85], v[68:69]
    v_mov_b32 v7, v92
    v_mov_b64 v[86:87], v[72:73]
    s_mov_b64 exec, -1
    s_or_b64 s[80:81], s[80:81], s[50:51]
    ds_read_b64 v[70:71], v95 offset:65408
    ds_read_b64 v[68:69], v94 offset:65408
    v_bitop3_b32 v92, v28, v5, v99 bitop3:0xea
    v_bitop3_b32 v93, v29, v5, v46 bitop3:0xea
    v_perm_b32 v15, v29, v32, s45
    v_bitop3_b32 v46, v29, 0.5, -0.5 bitop3:0xa8
    v_perm_b32 v14, v28, v32, s44
    v_bitop3_b32 v47, v28, 0.5, -0.5 bitop3:0xa8
    v_bitop3_b32 v15, v6, v15, v46 bitop3:0xca
    v_bitop3_b32 v14, v6, v14, v47 bitop3:0xca
    s_waitcnt lgkmcnt(1)
    v_mfma_f32_4x4x4_16b_bf16 v[80:83], v[10:11], v[70:71], v[80:83]
    s_waitcnt lgkmcnt(0)
    v_mfma_f32_4x4x4_16b_bf16 v[76:79], v[10:11], v[68:69], v[76:79]
    s_nop 2
    v_cvt_pk_bf16_f32 v80, v80, v81
    v_cvt_pk_bf16_f32 v81, v82, v83
    ds_wrxchg_rtn_b64 v[74:75], v95, v[80:81] offset:65408
    v_cvt_pk_bf16_f32 v76, v76, v77
    v_cvt_pk_bf16_f32 v77, v78, v79
    ds_wrxchg_rtn_b64 v[72:73], v94, v[76:77] offset:65408
    s_setprio 1
    v_mfma_f32_4x4x4_16b_bf16 v[80:83], v[8:9], v[102:103], 0
    v_mfma_f32_4x4x4_16b_bf16 v[76:79], v[8:9], v[100:101], 0
    v_cmp_lt_u32 s[84:85], v5, v92
    s_nop 2
    v_pk_mul_f32 v[80:81], v[80:81], v[14:15] op_sel:[0,1] op_sel_hi:[1,1]
    v_pk_mul_f32 v[82:83], v[82:83], v[14:15] op_sel:[0,1] op_sel_hi:[1,1]
    v_pk_mul_f32 v[76:77], v[76:77], v[14:15] op_sel:[0,0] op_sel_hi:[1,0]
    v_pk_mul_f32 v[78:79], v[78:79], v[14:15] op_sel:[0,0] op_sel_hi:[1,0]
    s_bitcmp1_b32 s43, s42
    s_cbranch_scc1 L2_oa73
L2_ob73:
    buffer_load_dwordx4 v[112:115], v3, s[16:19], s40 offen offset:1024 sc1
    v_sub_u16 v88, v58, v50
    v_and_b32 v89, 3, v50
    v_add3_u32 v99, v88, v89, 3
    v_and_b32 v99, -4, v99
    v_max_u32 v99, 4, v99
    v_and_b32 v97, 0xfffc, v50
    v_bfm_b32 v96, v88, v89
    v_add_u32_dpp v91, v99, v99 row_shr:1 row_mask:0xf bank_mask:0xf bound_ctrl:1
    v_mad_u32_u24 v97, v97, 5, v2
    v_cmp_lt_u32 vcc, 16, v99
    v_add_u32_dpp v91, v91, v91 row_shr:2 row_mask:0xf bank_mask:0xf bound_ctrl:1
    v_sub_u32 v98, s38, v99
    v_lshrrev_b64 v[50:51], 16, v[50:51]
    v_add_u32_dpp v91, v91, v91 row_shr:4 row_mask:0xf bank_mask:0xf bound_ctrl:1
    v_lshrrev_b64 v[58:59], 16, v[58:59]
    s_mov_b32 s101, 0
    v_add_u32_dpp v91, v91, v91 row_shr:8 row_mask:0xf bank_mask:0xf bound_ctrl:1
    s_nop 1
    v_add_u32_dpp v91, v91, v91 row_bcast:15 row_mask:0xa bank_mask:0xf
    s_nop 1
    v_add_u32_dpp v91, v91, v91 row_bcast:31 row_mask:0xc bank_mask:0xf
    v_add_u32 v98, v98, v91
    v_readlane_b32 s37, v91, 63
    s_cbranch_vccnz L2_xo74
L2_xp74:
    v_and_b32 v46, 0x80000000, v42
    v_lshrrev_b32 v47, 14, v31
    v_bitop3_b32 v47, v47, v5, v46 bitop3:0xea
    ds_read_b64 v[106:107], v47
    v_and_b32 v99, 0x40000000, v42
    v_lshrrev_b32 v47, 14, v30
    v_bitop3_b32 v47, v47, v5, v99 bitop3:0xea
    ds_read_b64 v[104:105], v47
    s_waitcnt lgkmcnt(2)
    v_cmp_ne_u64 s[50:51], v[72:73], v[68:69]
    v_cmpx_ne_u64 s[54:55], v[74:75], v[70:71]
    s_and_b64 s[82:83], s[54:55], s[80:81]
    s_cbranch_scc1 L2_c75
L2_d75:
    v_mov_b64 v[84:85], v[70:71]
    v_mov_b32 v7, v95
    v_mov_b64 v[86:87], v[74:75]
    s_or_b64 s[80:81], s[80:81], s[54:55]
    s_mov_b64 exec, s[50:51]
    s_and_b64 s[82:83], s[50:51], s[80:81]
    s_cbranch_scc1 L2_c76
L2_d76:
    v_mov_b64 v[84:85], v[68:69]
    v_mov_b32 v7, v94
    v_mov_b64 v[86:87], v[72:73]
    s_mov_b64 exec, -1
    s_or_b64 s[80:81], s[80:81], s[50:51]
    s_and_b64 exec, s[84:85], s[80:81]
    v_mfma_f32_4x4x4_16b_bf16 v[76:79], v[12:13], v[84:85], 0
    v_mov_b32 v92, v7
    s_andn2_b64 s[80:81], s[80:81], s[84:85]
    v_mfma_f32_4x4x4_16b_bf16 v[76:79], v[10:11], v[86:87], v[76:79]
    s_mov_b64 exec, -1
    ds_read_b64 v[70:71], v93 offset:65408
    ds_read_b64 v[68:69], v92 offset:65408
    v_bitop3_b32 v94, v30, v5, v99 bitop3:0xea
    v_bitop3_b32 v95, v31, v5, v46 bitop3:0xea
    v_perm_b32 v15, v31, v32, s47
    v_bitop3_b32 v46, v31, 0.5, -0.5 bitop3:0xa8
    v_perm_b32 v14, v30, v32, s46
    v_bitop3_b32 v47, v30, 0.5, -0.5 bitop3:0xa8
    v_bitop3_b32 v15, v6, v15, v46 bitop3:0xca
    v_bitop3_b32 v14, v6, v14, v47 bitop3:0xca
    s_waitcnt lgkmcnt(1)
    v_mfma_f32_4x4x4_16b_bf16 v[80:83], v[10:11], v[70:71], v[80:83]
    s_waitcnt lgkmcnt(0)
    v_mfma_f32_4x4x4_16b_bf16 v[76:79], v[10:11], v[68:69], v[76:79]
    s_nop 2
    v_cvt_pk_bf16_f32 v80, v80, v81
    v_cvt_pk_bf16_f32 v81, v82, v83
    ds_wrxchg_rtn_b64 v[74:75], v93, v[80:81] offset:65408
    v_cvt_pk_bf16_f32 v76, v76, v77
    v_cvt_pk_bf16_f32 v77, v78, v79
    ds_wrxchg_rtn_b64 v[72:73], v92, v[76:77] offset:65408
    v_and_b32 v88, 0x0fffffff, v33
    buffer_load_dwordx2 v[28:29], v88, s[8:11], 0 offen
    buffer_load_dwordx3 v[30:32], v88, s[8:11], 0 offen offset:8
    s_setprio 0
    v_mfma_f32_4x4x4_16b_bf16 v[80:83], v[8:9], v[106:107], 0
    v_mfma_f32_4x4x4_16b_bf16 v[76:79], v[8:9], v[104:105], 0
    v_cmp_lt_u32 s[48:49], v5, v95
    s_nop 2
    v_pk_mul_f32 v[80:81], v[80:81], v[14:15] op_sel:[0,1] op_sel_hi:[1,1]
    v_pk_mul_f32 v[82:83], v[82:83], v[14:15] op_sel:[0,1] op_sel_hi:[1,1]
    v_pk_mul_f32 v[76:77], v[76:77], v[14:15] op_sel:[0,0] op_sel_hi:[1,0]
    v_pk_mul_f32 v[78:79], v[78:79], v[14:15] op_sel:[0,0] op_sel_hi:[1,0]
    s_add_u32 s40, s40, 0x50000
    s_waitcnt vmcnt(8)
    v_and_b32 v46, 0x80000000, v43
    v_lshrrev_b32 v47, 14, v37
    v_bitop3_b32 v47, v47, v5, v46 bitop3:0xea
    ds_read_b64 v[106:107], v47
    v_and_b32 v99, 0x40000000, v43
    v_lshrrev_b32 v47, 14, v36
    v_bitop3_b32 v47, v47, v5, v99 bitop3:0xea
    ds_read_b64 v[104:105], v47
    v_and_b32 v46, 0x20000000, v43
    v_lshrrev_b32 v47, 14, v35
    v_bitop3_b32 v47, v47, v5, v46 bitop3:0xea
    ds_read_b64 v[102:103], v47
    v_and_b32 v99, 0x10000000, v43
    v_lshrrev_b32 v47, 14, v34
    v_bitop3_b32 v47, v47, v5, v99 bitop3:0xea
    ds_read_b64 v[100:101], v47
    s_waitcnt lgkmcnt(4)
    v_cmp_ne_u64 s[50:51], v[72:73], v[68:69]
    v_cmpx_ne_u64 s[54:55], v[74:75], v[70:71]
    s_and_b64 s[82:83], s[54:55], s[80:81]
    s_cbranch_scc1 L2_c77
L2_d77:
    v_mov_b64 v[84:85], v[70:71]
    v_mov_b32 v7, v93
    v_mov_b64 v[86:87], v[74:75]
    s_or_b64 s[80:81], s[80:81], s[54:55]
    s_mov_b64 exec, s[50:51]
    s_and_b64 s[82:83], s[50:51], s[80:81]
    s_cbranch_scc1 L2_c78
L2_d78:
    v_mov_b64 v[84:85], v[68:69]
    v_mov_b32 v7, v92
    v_mov_b64 v[86:87], v[72:73]
    s_mov_b64 exec, -1
    s_or_b64 s[80:81], s[80:81], s[50:51]
    s_and_b64 exec, s[48:49], s[80:81]
    v_mfma_f32_4x4x4_16b_bf16 v[80:83], v[12:13], v[84:85], 0
    v_mov_b32 v95, v7
    s_andn2_b64 s[80:81], s[80:81], s[48:49]
    v_mfma_f32_4x4x4_16b_bf16 v[80:83], v[10:11], v[86:87], v[80:83]
    s_mov_b64 exec, -1
    ds_read_b64 v[70:71], v95 offset:65408
    ds_read_b64 v[68:69], v94 offset:65408
    v_bitop3_b32 v92, v34, v5, v99 bitop3:0xea
    v_bitop3_b32 v93, v35, v5, v46 bitop3:0xea
    v_perm_b32 v15, v35, v38, s45
    v_bitop3_b32 v46, v35, 0.5, -0.5 bitop3:0xa8
    v_perm_b32 v14, v34, v38, s44
    v_bitop3_b32 v47, v34, 0.5, -0.5 bitop3:0xa8
    v_bitop3_b32 v15, v6, v15, v46 bitop3:0xca
    v_bitop3_b32 v14, v6, v14, v47 bitop3:0xca
    s_waitcnt lgkmcnt(1)
    v_mfma_f32_4x4x4_16b_bf16 v[80:83], v[10:11], v[70:71], v[80:83]
    s_waitcnt lgkmcnt(0)
    v_mfma_f32_4x4x4_16b_bf16 v[76:79], v[10:11], v[68:69], v[76:79]
    s_nop 2
    v_cvt_pk_bf16_f32 v80, v80, v81
    v_cvt_pk_bf16_f32 v81, v82, v83
    ds_wrxchg_rtn_b64 v[74:75], v95, v[80:81] offset:65408
    v_cvt_pk_bf16_f32 v76, v76, v77
    v_cvt_pk_bf16_f32 v77, v78, v79
    ds_wrxchg_rtn_b64 v[72:73], v94, v[76:77] offset:65408
    s_barrier
    s_setprio 3
    s_mov_b32 m0, s100
    s_nop 0
    ds_write_addtid_b32 v124 offset:34816
    ds_write_addtid_b32 v125 offset:35072
    ds_write_addtid_b32 v126 offset:35328
    ds_write_addtid_b32 v127 offset:35584
    s_add_u32 s3, s40, 4096
    buffer_load_dwordx4 v[124:127], v3, s[16:19], s3 offen sc1
    ds_write_addtid_b32 v116 offset:32768
    ds_write_addtid_b32 v117 offset:33024
    ds_write_addtid_b32 v118 offset:33280
    ds_write_addtid_b32 v119 offset:33536
    buffer_load_dwordx4 v[116:119], v3, s[16:19], s40 offen offset:2048 sc1
    ds_write_addtid_b32 v120 offset:33792
    ds_write_addtid_b32 v121 offset:34048
    ds_write_addtid_b32 v122 offset:34304
    ds_write_addtid_b32 v123 offset:34560
    buffer_load_dwordx4 v[120:123], v3, s[16:19], s40 offen offset:3072 sc1
    v_mfma_f32_4x4x4_16b_bf16 v[80:83], v[8:9], v[102:103], 0
    v_mfma_f32_4x4x4_16b_bf16 v[76:79], v[8:9], v[100:101], 0
    s_nop 3
    v_pk_mul_f32 v[80:81], v[80:81], v[14:15] op_sel:[0,1] op_sel_hi:[1,1]
    v_pk_mul_f32 v[82:83], v[82:83], v[14:15] op_sel:[0,1] op_sel_hi:[1,1]
    v_pk_mul_f32 v[76:77], v[76:77], v[14:15] op_sel:[0,0] op_sel_hi:[1,0]
    v_pk_mul_f32 v[78:79], v[78:79], v[14:15] op_sel:[0,0] op_sel_hi:[1,0]
    s_cmp_gt_u32 s37, 1024
    s_cbranch_scc1 L2_xs79
    s_cmp_lg_u32 s101, 0
    s_cbranch_scc1 L2_xa79
L2_xb79:
    v_lshlrev_b32 v89, 16, v96
    v_add_u32 v90, 60, v97
    v_bitop3_b32 v90, v89, v45, v90 bitop3:0x6a
    ds_write_b32 v98, v90 offset:12
    v_lshlrev_b32 v89, 20, v96
    v_add_u32 v90, 40, v97
    v_bitop3_b32 v90, v89, v45, v90 bitop3:0x6a
    ds_write_b32 v98, v90 offset:8
    v_lshlrev_b32 v89, 24, v96
    v_add_u32 v90, 20, v97
    v_bitop3_b32 v90, v89, v45, v90 bitop3:0x6a
    ds_write_b32 v98, v90 offset:4
    v_lshlrev_b32 v89, 28, v96
    v_bitop3_b32 v90, v89, v45, v97 bitop3:0x6a
    ds_write_b32 v98, v90 offset:0
    v_mov_b32_dpp v91, v66 quad_perm:[0,0,0,0] row_mask:0xf bank_mask:0xf
    v_and_b32 v89, 3, v91
    v_and_b32 v97, 0xfffc, v91
    v_sub_u16_dpp v88, v66, v91 quad_perm:[2,2,2,2] row_mask:0xf bank_mask:0xf
    v_mad_u32_u24 v97, v97, 5, v4
    v_add_u32 v99, v88, v89
    v_bfm_b32 v96, v88, v89
    v_cmp_lt_u32 s[58:59], 16, v99
    v_lshlrev_b32 v89, v1, v96
    v_and_b32 v89, v45, v89
    v_cmp_ne_u32 vcc, 0, v89
    v_xor_b32 v90, v97, v89
    s_add_u32 s3, s37, s38
    v_mbcnt_lo_u32_b32 v98, vcc_lo, 0
    v_mbcnt_hi_u32_b32 v98, vcc_hi, v98
    s_bcnt1_i32_b64 s41, vcc
    v_lshl_add_u32 v98, v98, 2, s3
    s_lshl2_add_u32 s37, s41, s37
    s_mov_b64 exec, vcc
    ds_write_b32 v98, v90
    s_mov_b64 exec, -1
    s_cmp_lg_u64 s[58:59], 0
    s_cbranch_scc1 L2_xe79
L2_xr79:
    v_add_u32 v98, s37, v0
    v_mov_b32 v90, -1
    ds_write_b32 v98, v90
L2_xw79:
    s_setprio 2
    s_waitcnt lgkmcnt(14)
    v_cmp_ne_u64 s[50:51], v[72:73], v[68:69]
    v_cmpx_ne_u64 s[54:55], v[74:75], v[70:71]
    s_and_b64 s[82:83], s[54:55], s[80:81]
    s_cbranch_scc1 L2_c80
L2_d80:
    v_mov_b64 v[84:85], v[70:71]
    v_mov_b32 v7, v95
    v_mov_b64 v[86:87], v[74:75]
    s_or_b64 s[80:81], s[80:81], s[54:55]
    s_mov_b64 exec, s[50:51]
    s_and_b64 s[82:83], s[50:51], s[80:81]
    s_cbranch_scc1 L2_c81
L2_d81:
    v_mov_b64 v[84:85], v[68:69]
    v_mov_b32 v7, v94
    v_mov_b64 v[86:87], v[72:73]
    s_mov_b64 exec, -1
    s_or_b64 s[80:81], s[80:81], s[50:51]
    ds_read_b64 v[70:71], v93 offset:65408
    ds_read_b64 v[68:69], v92 offset:65408
    v_and_b32 v46, 0x40000000, v43
    v_bitop3_b32 v94, v36, v5, v46 bitop3:0xea
    v_and_b32 v46, 0x80000000, v43
    v_bitop3_b32 v95, v37, v5, v46 bitop3:0xea
    v_perm_b32 v15, v37, v38, s47
    v_bitop3_b32 v46, v37, 0.5, -0.5 bitop3:0xa8
    v_perm_b32 v14, v36, v38, s46
    v_bitop3_b32 v47, v36, 0.5, -0.5 bitop3:0xa8
    v_bitop3_b32 v15, v6, v15, v46 bitop3:0xca
    v_bitop3_b32 v14, v6, v14, v47 bitop3:0xca
    s_setprio 1
    s_waitcnt lgkmcnt(1)
    v_mfma_f32_4x4x4_16b_bf16 v[80:83], v[10:11], v[70:71], v[80:83]
    s_waitcnt lgkmcnt(0)
    v_mfma_f32_4x4x4_16b_bf16 v[76:79], v[10:11], v[68:69], v[76:79]
    s_nop 2
    v_cvt_pk_bf16_f32 v80, v80, v81
    v_cvt_pk_bf16_f32 v81, v82, v83
    ds_wrxchg_rtn_b64 v[74:75], v93, v[80:81] offset:65408
    v_cvt_pk_bf16_f32 v76, v76, v77
    v_cvt_pk_bf16_f32 v77, v78, v79
    ds_wrxchg_rtn_b64 v[72:73], v92, v[76:77] offset:65408
    ds_read_b32 v40, v44 offset:768
    ds_read_b32 v41, v0 offset:0
    ds_read_b32 v42, v0 offset:256
    ds_read_b32 v43, v0 offset:512
    s_sub_u32 s3, s37, 768
    s_cmp_gt_u32 s3, 128
    s_cbranch_scc1 L2_xf79
L2_xg79:
    v_and_b32 v88, 0x0fffffff, v39
    buffer_load_dwordx2 v[34:35], v88, s[8:11], 0 offen
    buffer_load_dwordx3 v[36:38], v88, s[8:11], 0 offen offset:8
    s_setprio 0
    s_waitcnt vmcnt(10)
    s_mov_b32 m0, s38
    s_nop 0
    ds_write_addtid_b32 v108 offset:0
    ds_write_addtid_b32 v109 offset:256
    ds_write_addtid_b32 v110 offset:512
    ds_write_addtid_b32 v111 offset:768
    s_waitcnt vmcnt(7)
    ds_write_addtid_b32 v112 offset:1024
    ds_write_addtid_b32 v113 offset:1280
    ds_write_addtid_b32 v114 offset:1536
    ds_write_addtid_b32 v115 offset:1792
    v_mfma_f32_4x4x4_16b_bf16 v[80:83], v[8:9], v[106:107], 0
    v_mfma_f32_4x4x4_16b_bf16 v[76:79], v[8:9], v[104:105], 0
    v_cmp_lt_u32 s[84:85], v5, v94
    s_nop 2
    v_pk_mul_f32 v[80:81], v[80:81], v[14:15] op_sel:[0,1] op_sel_hi:[1,1]
    v_pk_mul_f32 v[82:83], v[82:83], v[14:15] op_sel:[0,1] op_sel_hi:[1,1]
    v_pk_mul_f32 v[76:77], v[76:77], v[14:15] op_sel:[0,0] op_sel_hi:[1,0]
    v_pk_mul_f32 v[78:79], v[78:79], v[14:15] op_sel:[0,0] op_sel_hi:[1,0]
    s_add_u32 s42, s42, 1
    s_waitcnt lgkmcnt(0)
    s_barrier
    s_bitcmp1_b32 s36, s42
    s_cbranch_scc1 L2_slow
L2_ret4:
    s_setprio 3
    s_bitcmp1_b32 s43, s42
    s_cbranch_scc1 L2_oa82
L2_ob82:
    s_mov_b64 exec, s[6:7]
    v_lshrrev_b32 v18, 16, v18
    s_mov_b64 exec, -1
    v_and_b32 v46, 0x20000000, v19
    v_lshrrev_b32 v47, 14, v17
    v_bitop3_b32 v47, v47, v5, v46 bitop3:0xea
    ds_read_b64 v[102:103], v47
    v_and_b32 v99, 0x10000000, v19
    v_lshrrev_b32 v47, 14, v16
    v_bitop3_b32 v47, v47, v5, v99 bitop3:0xea
    ds_read_b64 v[100:101], v47
    v_cmp_ne_u64 s[50:51], v[72:73], v[68:69]
    v_cmpx_ne_u64 s[54:55], v[74:75], v[70:71]
    s_and_b64 s[82:83], s[54:55], s[80:81]
    s_cbranch_scc1 L2_c83
L2_d83:
    v_mov_b64 v[84:85], v[70:71]
    v_mov_b32 v7, v93
    v_mov_b64 v[86:87], v[74:75]
    s_or_b64 s[80:81], s[80:81], s[54:55]
    s_mov_b64 exec, s[50:51]
    s_and_b64 s[82:83], s[50:51], s[80:81]
    s_cbranch_scc1 L2_c84
L2_d84:
    v_mov_b64 v[84:85], v[68:69]
    v_mov_b32 v7, v92
    v_mov_b64 v[86:87], v[72:73]
    s_mov_b64 exec, -1
    s_or_b64 s[80:81], s[80:81], s[50:51]
    s_and_b64 exec, s[84:85], s[80:81]
    v_mfma_f32_4x4x4_16b_bf16 v[76:79], v[12:13], v[84:85], 0
    v_mov_b32 v94, v7
    s_andn2_b64 s[80:81], s[80:81], s[84:85]
    v_mfma_f32_4x4x4_16b_bf16 v[76:79], v[10:11], v[86:87], v[76:79]
    s_mov_b64 exec, -1
    ds_read_b64 v[70:71], v95 offset:65408
    ds_read_b64 v[68:69], v94 offset:65408
    v_bitop3_b32 v92, v16, v5, v99 bitop3:0xea
    v_bitop3_b32 v93, v17, v5, v46 bitop3:0xea
    v_perm_b32 v15, v17, v18, s45
    v_bitop3_b32 v46, v17, 0.5, -0.5 bitop3:0xa8
    v_perm_b32 v14, v16, v18, s44
    v_bitop3_b32 v47, v16, 0.5, -0.5 bitop3:0xa8
    v_bitop3_b32 v15, v6, v15, v46 bitop3:0xca
    v_bitop3_b32 v14, v6, v14, v47 bitop3:0xca
    s_waitcnt lgkmcnt(1)
    v_mfma_f32_4x4x4_16b_bf16 v[80:83], v[10:11], v[70:71], v[80:83]
    s_waitcnt lgkmcnt(0)
    v_mfma_f32_4x4x4_16b_bf16 v[76:79], v[10:11], v[68:69], v[76:79]
    s_nop 2
    v_cvt_pk_bf16_f32 v80, v80, v81
    v_cvt_pk_bf16_f32 v81, v82, v83
    ds_wrxchg_rtn_b64 v[74:75], v95, v[80:81] offset:65408
    v_cvt_pk_bf16_f32 v76, v76, v77
    v_cvt_pk_bf16_f32 v77, v78, v79
    ds_wrxchg_rtn_b64 v[72:73], v94, v[76:77] offset:65408
    v_mfma_f32_4x4x4_16b_bf16 v[80:83], v[8:9], v[102:103], 0
    v_mfma_f32_4x4x4_16b_bf16 v[76:79], v[8:9], v[100:101], 0
    v_cmp_lt_u32 s[84:85], v5, v92
    s_nop 2
    v_pk_mul_f32 v[80:81], v[80:81], v[14:15] op_sel:[0,1] op_sel_hi:[1,1]
    v_pk_mul_f32 v[82:83], v[82:83], v[14:15] op_sel:[0,1] op_sel_hi:[1,1]
    v_pk_mul_f32 v[76:77], v[76:77], v[14:15] op_sel:[0,0] op_sel_hi:[1,0]
    v_pk_mul_f32 v[78:79], v[78:79], v[14:15] op_sel:[0,0] op_sel_hi:[1,0]
    v_and_b32 v47, 0x0fffffff, v40
    buffer_load_dword v18, v47, s[8:11], 0 offen offset:16
    s_mov_b64 exec, s[6:7]
    v_add_u32 v47, 8, v47
    v_lshrrev_b32 v40, 2, v40
    s_mov_b64 exec, -1
    buffer_load_dwordx2 v[16:17], v47, s[8:11], 0 offen
    v_and_b32 v46, 0x20000000, v27
    v_lshrrev_b32 v47, 14, v23
    v_bitop3_b32 v47, v47, v5, v46 bitop3:0xea
    ds_read_b64 v[106:107], v47
    v_and_b32 v99, 0x10000000, v27
    v_lshrrev_b32 v47, 14, v22
    v_bitop3_b32 v47, v47, v5, v99 bitop3:0xea
    ds_read_b64 v[104:105], v47
    s_waitcnt lgkmcnt(2)
    v_cmp_ne_u64 s[50:51], v[72:73], v[68:69]
    v_cmpx_ne_u64 s[54:55], v[74:75], v[70:71]
    s_and_b64 s[82:83], s[54:55], s[80:81]
    s_cbranch_scc1 L2_c85
L2_d85:
    v_mov_b64 v[84:85], v[70:71]
    v_mov_b32 v7, v95
    v_mov_b64 v[86:87], v[74:75]
    s_or_b64 s[80:81], s[80:81], s[54:55]
    s_mov_b64 exec, s[50:51]
    s_and_b64 s[82:83], s[50:51], s[80:81]
    s_cbranch_scc1 L2_c86
L2_d86:
    v_mov_b64 v[84:85], v[68:69]
    v_mov_b32 v7, v94
    v_mov_b64 v[86:87], v[72:73]
    s_mov_b64 exec, -1
    s_or_b64 s[80:81], s[80:81], s[50:51]
    s_and_b64 exec, s[84:85], s[80:81]
    v_mfma_f32_4x4x4_16b_bf16 v[76:79], v[12:13], v[84:85], 0
    v_mov_b32 v92, v7
    s_andn2_b64 s[80:81], s[80:81], s[84:85]
    v_mfma_f32_4x4x4_16b_bf16 v[76:79], v[10:11], v[86:87], v[76:79]
    s_mov_b64 exec, -1
    ds_read_b64 v[70:71], v93 offset:65408
    ds_read_b64 v[68:69], v92 offset:65408
    v_bitop3_b32 v94, v22, v5, v99 bitop3:0xea
    v_bitop3_b32 v95, v23, v5, v46 bitop3:0xea
    v_perm_b32 v15, v23, v26, s45
    v_bitop3_b32 v46, v23, 0.5, -0.5 bitop3:0xa8
    v_perm_b32 v14, v22, v26, s44
    v_bitop3_b32 v47, v22, 0.5, -0.5 bitop3:0xa8
    v_bitop3_b32 v15, v6, v15, v46 bitop3:0xca
    v_bitop3_b32 v14, v6, v14, v47 bitop3:0xca
    s_waitcnt lgkmcnt(1)
    v_mfma_f32_4x4x4_16b_bf16 v[80:83], v[10:11], v[70:71], v[80:83]
    s_waitcnt lgkmcnt(0)
    v_mfma_f32_4x4x4_16b_bf16 v[76:79], v[10:11], v[68:69], v[76:79]
    s_nop 2
    v_cvt_pk_bf16_f32 v80, v80, v81
    v_cvt_pk_bf16_f32 v81, v82, v83
    ds_wrxchg_rtn_b64 v[74:75], v93, v[80:81] offset:65408
    v_cvt_pk_bf16_f32 v76, v76, v77
    v_cvt_pk_bf16_f32 v77, v78, v79
    ds_wrxchg_rtn_b64 v[72:73], v92, v[76:77] offset:65408
    v_mfma_f32_4x4x4_16b_bf16 v[80:83], v[8:9], v[106:107], 0
    v_mfma_f32_4x4x4_16b_bf16 v[76:79], v[8:9], v[104:105], 0
    v_cmp_lt_u32 s[48:49], v5, v95
    s_nop 2
    v_pk_mul_f32 v[80:81], v[80:81], v[14:15] op_sel:[0,1] op_sel_hi:[1,1]
    v_pk_mul_f32 v[82:83], v[82:83], v[14:15] op_sel:[0,1] op_sel_hi:[1,1]
    v_pk_mul_f32 v[76:77], v[76:77], v[14:15] op_sel:[0,0] op_sel_hi:[1,0]
    v_pk_mul_f32 v[78:79], v[78:79], v[14:15] op_sel:[0,0] op_sel_hi:[1,0]
    buffer_load_dwordx4 v[108:111], v3, s[16:19], s40 offen offset:0 sc1
    v_and_b32 v46, 0x80000000, v27
    v_lshrrev_b32 v47, 14, v25
    v_bitop3_b32 v47, v47, v5, v46 bitop3:0xea
    ds_read_b64 v[102:103], v47
    v_and_b32 v99, 0x40000000, v27
    v_lshrrev_b32 v47, 14, v24
    v_bitop3_b32 v47, v47, v5, v99 bitop3:0xea
    ds_read_b64 v[100:101], v47
    s_waitcnt lgkmcnt(2)
    v_cmp_ne_u64 s[50:51], v[72:73], v[68:69]
    v_cmpx_ne_u64 s[54:55], v[74:75], v[70:71]
    s_and_b64 s[82:83], s[54:55], s[80:81]
    s_cbranch_scc1 L2_c87
L2_d87:
    v_mov_b64 v[84:85], v[70:71]
    v_mov_b32 v7, v93
    v_mov_b64 v[86:87], v[74:75]
    s_or_b64 s[80:81], s[80:81], s[54:55]
    s_mov_b64 exec, s[50:51]
    s_and_b64 s[82:83], s[50:51], s[80:81]
    s_cbranch_scc1 L2_c88
L2_d88:
    v_mov_b64 v[84:85], v[68:69]
    v_mov_b32 v7, v92
    v_mov_b64 v[86:87], v[72:73]
    s_mov_b64 exec, -1
    s_or_b64 s[80:81], s[80:81], s[50:51]
    s_and_b64 exec, s[48:49], s[80:81]
    v_mfma_f32_4x4x4_16b_bf16 v[80:83], v[12:13], v[84:85], 0
    v_mov_b32 v95, v7
    s_andn2_b64 s[80:81], s[80:81], s[48:49]
    v_mfma_f32_4x4x4_16b_bf16 v[80:83], v[10:11], v[86:87], v[80:83]
    s_mov_b64 exec, -1
    ds_read_b64 v[70:71], v95 offset:65408
    ds_read_b64 v[68:69], v94 offset:65408
    v_bitop3_b32 v92, v24, v5, v99 bitop3:0xea
    v_bitop3_b32 v93, v25, v5, v46 bitop3:0xea
    v_perm_b32 v15, v25, v26, s47
    v_bitop3_b32 v46, v25, 0.5, -0.5 bitop3:0xa8
    v_perm_b32 v14, v24, v26, s46
    v_bitop3_b32 v47, v24, 0.5, -0.5 bitop3:0xa8
    v_bitop3_b32 v15, v6, v15, v46 bitop3:0xca
    v_bitop3_b32 v14, v6, v14, v47 bitop3:0xca
    s_waitcnt lgkmcnt(1)
    v_mfma_f32_4x4x4_16b_bf16 v[80:83], v[10:11], v[70:71], v[80:83]
    s_waitcnt lgkmcnt(0)
    v_mfma_f32_4x4x4_16b_bf16 v[76:79], v[10:11], v[68:69], v[76:79]
    s_nop 2
    v_cvt_pk_bf16_f32 v80, v80, v81
    v_cvt_pk_bf16_f32 v81, v82, v83
    ds_wrxchg_rtn_b64 v[74:75], v95, v[80:81] offset:65408
    v_cvt_pk_bf16_f32 v76, v76, v77
    v_cvt_pk_bf16_f32 v77, v78, v79
    ds_wrxchg_rtn_b64 v[72:73], v94, v[76:77] offset:65408
    v_and_b32 v88, 0x0fffffff, v41
    buffer_load_dwordx2 v[22:23], v88, s[8:11], 0 offen
    buffer_load_dwordx3 v[24:26], v88, s[8:11], 0 offen offset:8
    s_setprio 2
    v_mfma_f32_4x4x4_16b_bf16 v[80:83], v[8:9], v[102:103], 0
    v_mfma_f32_4x4x4_16b_bf16 v[76:79], v[8:9], v[100:101], 0
    s_nop 3
    v_pk_mul_f32 v[80:81], v[80:81], v[14:15] op_sel:[0,1] op_sel_hi:[1,1]
    v_pk_mul_f32 v[82:83], v[82:83], v[14:15] op_sel:[0,1] op_sel_hi:[1,1]
    v_pk_mul_f32 v[76:77], v[76:77], v[14:15] op_sel:[0,0] op_sel_hi:[1,0]
    v_pk_mul_f32 v[78:79], v[78:79], v[14:15] op_sel:[0,0] op_sel_hi:[1,0]
    s_waitcnt vmcnt(10)
    v_and_b32 v46, 0x20000000, v33
    v_lshrrev_b32 v47, 14, v29
    v_bitop3_b32 v47, v47, v5, v46 bitop3:0xea
    ds_read_b64 v[106:107], v47
    v_and_b32 v99, 0x10000000, v33
    v_lshrrev_b32 v47, 14, v28
    v_bitop3_b32 v47, v47, v5, v99 bitop3:0xea
    ds_read_b64 v[104:105], v47
    s_waitcnt lgkmcnt(2)
    v_cmp_ne_u64 s[50:51], v[72:73], v[68:69]
    v_cmpx_ne_u64 s[54:55], v[74:75], v[70:71]
    s_and_b64 s[82:83], s[54:55], s[80:81]
    s_cbranch_scc1 L2_c89
L2_d89:
    v_mov_b64 v[84:85], v[70:71]
    v_mov_b32 v7, v95
    v_mov_b64 v[86:87], v[74:75]
    s_or_b64 s[80:81], s[80:81], s[54:55]
    s_mov_b64 exec, s[50:51]
    s_and_b64 s[82:83], s[50:51], s[80:81]
    s_cbranch_scc1 L2_c90
L2_d90:
    v_mov_b64 v[84:85], v[68:69]
    v_mov_b32 v7, v94
    v_mov_b64 v[86:87], v[72:73]
    s_mov_b64 exec, -1
    s_or_b64 s[80:81], s[80:81], s[50:51]
    ds_read_b64 v[70:71], v93 offset:65408
    ds_read_b64 v[68:69], v92 offset:65408
    v_bitop3_b32 v94, v28, v5, v99 bitop3:0xea
    v_bitop3_b32 v95, v29, v5, v46 bitop3:0xea
    v_perm_b32 v15, v29, v32, s45
    v_bitop3_b32 v46, v29, 0.5, -0.5 bitop3:0xa8
    v_perm_b32 v14, v28, v32, s44
    v_bitop3_b32 v47, v28, 0.5, -0.5 bitop3:0xa8
    v_bitop3_b32 v15, v6, v15, v46 bitop3:0xca
    v_bitop3_b32 v14, v6, v14, v47 bitop3:0xca
    s_waitcnt lgkmcnt(1)
    v_mfma_f32_4x4x4_16b_bf16 v[80:83], v[10:11], v[70:71], v[80:83]
    s_waitcnt lgkmcnt(0)
    v_mfma_f32_4x4x4_16b_bf16 v[76:79], v[10:11], v[68:69], v[76:79]
    s_nop 2
    v_cvt_pk_bf16_f32 v80, v80, v81
    v_cvt_pk_bf16_f32 v81, v82, v83
    ds_wrxchg_rtn_b64 v[74:75], v93, v[80:81] offset:65408
    v_cvt_pk_bf16_f32 v76, v76, v77
    v_cvt_pk_bf16_f32 v77, v78, v79
    ds_wrxchg_rtn_b64 v[72:73], v92, v[76:77] offset:65408
    s_setprio 1
    v_mfma_f32_4x4x4_16b_bf16 v[80:83], v[8:9], v[106:107], 0
    v_mfma_f32_4x4x4_16b_bf16 v[76:79], v[8:9], v[104:105], 0
    v_cmp_lt_u32 s[84:85], v5, v94
    s_nop 2
    v_pk_mul_f32 v[80:81], v[80:81], v[14:15] op_sel:[0,1] op_sel_hi:[1,1]
    v_pk_mul_f32 v[82:83], v[82:83], v[14:15] op_sel:[0,1] op_sel_hi:[1,1]
    v_pk_mul_f32 v[76:77], v[76:77], v[14:15] op_sel:[0,0] op_sel_hi:[1,0]
    v_pk_mul_f32 v[78:79], v[78:79], v[14:15] op_sel:[0,0] op_sel_hi:[1,0]
    s_bitcmp1_b32 s43, s42
    s_cbranch_scc1 L2_oa91
L2_ob91:
    buffer_load_dwordx4 v[112:115], v3, s[16:19], s40 offen offset:1024 sc1
    v_sub_u16 v88, v60, v52
    v_and_b32 v89, 3, v52
    v_add3_u32 v99, v88, v89, 3
    v_and_b32 v99, -4, v99
    v_max_u32 v99, 4, v99
    v_and_b32 v97, 0xfffc, v52
    v_bfm_b32 v96, v88, v89
    v_add_u32_dpp v91, v99, v99 row_shr:1 row_mask:0xf bank_mask:0xf bound_ctrl:1
    v_mad_u32_u24 v97, v97, 5, v2
    v_cmp_lt_u32 vcc, 16, v99
    v_add_u32_dpp v91, v91, v91 row_shr:2 row_mask:0xf bank_mask:0xf bound_ctrl:1
    v_sub_u32 v98, s38, v99
    v_lshrrev_b64 v[52:53], 16, v[52:53]
    v_add_u32_dpp v91, v91, v91 row_shr:4 row_mask:0xf bank_mask:0xf bound_ctrl:1
    v_lshrrev_b64 v[60:61], 16, v[60:61]
    s_mov_b32 s101, 0
    v_add_u32_dpp v91, v91, v91 row_shr:8 row_mask:0xf bank_mask:0xf bound_ctrl:1
    s_nop 1
    v_add_u32_dpp v91, v91, v91 row_bcast:15 row_mask:0xa bank_mask:0xf
    s_nop 1
    v_add_u32_dpp v91, v91, v91 row_bcast:31 row_mask:0xc bank_mask:0xf
    v_add_u32 v98, v98, v91
    v_readlane_b32 s37, v91, 63
    s_cbranch_vccnz L2_xo92
L2_xp92:
    v_and_b32 v46, 0x80000000, v33
    v_lshrrev_b32 v47, 14, v31
    v_bitop3_b32 v47, v47, v5, v46 bitop3:0xea
    ds_read_b64 v[102:103], v47
    v_and_b32 v99, 0x40000000, v33
    v_lshrrev_b32 v47, 14, v30
    v_bitop3_b32 v47, v47, v5, v99 bitop3:0xea
    ds_read_b64 v[100:101], v47
    s_waitcnt lgkmcnt(2)
    v_cmp_ne_u64 s[50:51], v[72:73], v[68:69]
    v_cmpx_ne_u64 s[54:55], v[74:75], v[70:71]
    s_and_b64 s[82:83], s[54:55], s[80:81]
    s_cbranch_scc1 L2_c93
L2_d93:
    v_mov_b64 v[84:85], v[70:71]
    v_mov_b32 v7, v93
    v_mov_b64 v[86:87], v[74:75]
    s_or_b64 s[80:81], s[80:81], s[54:55]
    s_mov_b64 exec, s[50:51]
    s_and_b64 s[82:83], s[50:51], s[80:81]
    s_cbranch_scc1 L2_c94
L2_d94:
    v_mov_b64 v[84:85], v[68:69]
    v_mov_b32 v7, v92
    v_mov_b64 v[86:87], v[72:73]
    s_mov_b64 exec, -1
    s_or_b64 s[80:81], s[80:81], s[50:51]
    s_and_b64 exec, s[84:85], s[80:81]
    v_mfma_f32_4x4x4_16b_bf16 v[76:79], v[12:13], v[84:85], 0
    v_mov_b32 v94, v7
    s_andn2_b64 s[80:81], s[80:81], s[84:85]
    v_mfma_f32_4x4x4_16b_bf16 v[76:79], v[10:11], v[86:87], v[76:79]
    s_mov_b64 exec, -1
    ds_read_b64 v[70:71], v95 offset:65408
    ds_read_b64 v[68:69], v94 offset:65408
    v_bitop3_b32 v92, v30, v5, v99 bitop3:0xea
    v_bitop3_b32 v93, v31, v5, v46 bitop3:0xea
    v_perm_b32 v15, v31, v32, s47
    v_bitop3_b32 v46, v31, 0.5, -0.5 bitop3:0xa8
    v_perm_b32 v14, v30, v32, s46
    v_bitop3_b32 v47, v30, 0.5, -0.5 bitop3:0xa8
    v_bitop3_b32 v15, v6, v15, v46 bitop3:0xca
    v_bitop3_b32 v14, v6, v14, v47 bitop3:0xca
    s_waitcnt lgkmcnt(1)
    v_mfma_f32_4x4x4_16b_bf16 v[80:83], v[10:11], v[70:71], v[80:83]
    s_waitcnt lgkmcnt(0)
    v_mfma_f32_4x4x4_16b_bf16 v[76:79], v[10:11], v[68:69], v[76:79]
    s_nop 2
    v_cvt_pk_bf16_f32 v80, v80, v81
    v_cvt_pk_bf16_f32 v81, v82, v83
    ds_wrxchg_rtn_b64 v[74:75], v95, v[80:81] offset:65408
    v_cvt_pk_bf16_f32 v76, v76, v77
    v_cvt_pk_bf16_f32 v77, v78, v79
    ds_wrxchg_rtn_b64 v[72:73], v94, v[76:77] offset:65408
    v_and_b32 v88, 0x0fffffff, v42
    buffer_load_dwordx2 v[28:29], v88, s[8:11], 0 offen
    buffer_load_dwordx3 v[30:32], v88, s[8:11], 0 offen offset:8
    s_setprio 0
    v_mfma_f32_4x4x4_16b_bf16 v[80:83], v[8:9], v[102:103], 0
    v_mfma_f32_4x4x4_16b_bf16 v[76:79], v[8:9], v[100:101], 0
    v_cmp_lt_u32 s[48:49], v5, v93
    s_nop 2
    v_pk_mul_f32 v[80:81], v[80:81], v[14:15] op_sel:[0,1] op_sel_hi:[1,1]
    v_pk_mul_f32 v[82:83], v[82:83], v[14:15] op_sel:[0,1] op_sel_hi:[1,1]
    v_pk_mul_f32 v[76:77], v[76:77], v[14:15] op_sel:[0,0] op_sel_hi:[1,0]
    v_pk_mul_f32 v[78:79], v[78:79], v[14:15] op_sel:[0,0] op_sel_hi:[1,0]
    s_add_u32 s40, s40, 0x50000
    s_waitcnt vmcnt(8)
    v_and_b32 v46, 0x80000000, v39
    v_lshrrev_b32 v47, 14, v37
    v_bitop3_b32 v47, v47, v5, v46 bitop3:0xea
    ds_read_b64 v[102:103], v47
    v_and_b32 v99, 0x40000000, v39
    v_lshrrev_b32 v47, 14, v36
    v_bitop3_b32 v47, v47, v5, v99 bitop3:0xea
    ds_read_b64 v[100:101], v47
    v_and_b32 v46, 0x20000000, v39
    v_lshrrev_b32 v47, 14, v35
    v_bitop3_b32 v47, v47, v5, v46 bitop3:0xea
    ds_read_b64 v[106:107], v47
    v_and_b32 v99, 0x10000000, v39
    v_lshrrev_b32 v47, 14, v34
    v_bitop3_b32 v47, v47, v5, v99 bitop3:0xea
    ds_read_b64 v[104:105], v47
    s_waitcnt lgkmcnt(4)
    v_cmp_ne_u64 s[50:51], v[72:73], v[68:69]
    v_cmpx_ne_u64 s[54:55], v[74:75], v[70:71]
    s_and_b64 s[82:83], s[54:55], s[80:81]
    s_cbranch_scc1 L2_c95
L2_d95:
    v_mov_b64 v[84:85], v[70:71]
    v_mov_b32 v7, v95
    v_mov_b64 v[86:87], v[74:75]
    s_or_b64 s[80:81], s[80:81], s[54:55]
    s_mov_b64 exec, s[50:51]
    s_and_b64 s[82:83], s[50:51], s[80:81]
    s_cbranch_scc1 L2_c96
L2_d96:
    v_mov_b64 v[84:85], v[68:69]
    v_mov_b32 v7, v94
    v_mov_b64 v[86:87], v[72:73]
    s_mov_b64 exec, -1
    s_or_b64 s[80:81], s[80:81], s[50:51]
    s_and_b64 exec, s[48:49], s[80:81]
    v_mfma_f32_4x4x4_16b_bf16 v[80:83], v[12:13], v[84:85], 0
    v_mov_b32 v93, v7
    s_andn2_b64 s[80:81], s[80:81], s[48:49]
    v_mfma_f32_4x4x4_16b_bf16 v[80:83], v[10:11], v[86:87], v[80:83]
    s_mov_b64 exec, -1
    ds_read_b64 v[70:71], v93 offset:65408
    ds_read_b64 v[68:69], v92 offset:65408
    v_bitop3_b32 v94, v34, v5, v99 bitop3:0xea
    v_bitop3_b32 v95, v35, v5, v46 bitop3:0xea
    v_perm_b32 v15, v35, v38, s45
    v_bitop3_b32 v46, v35, 0.5, -0.5 bitop3:0xa8
    v_perm_b32 v14, v34, v38, s44
    v_bitop3_b32 v47, v34, 0.5, -0.5 bitop3:0xa8
    v_bitop3_b32 v15, v6, v15, v46 bitop3:0xca
    v_bitop3_b32 v14, v6, v14, v47 bitop3:0xca
    s_waitcnt lgkmcnt(1)
    v_mfma_f32_4x4x4_16b_bf16 v[80:83], v[10:11], v[70:71], v[80:83]
    s_waitcnt lgkmcnt(0)
    v_mfma_f32_4x4x4_16b_bf16 v[76:79], v[10:11], v[68:69], v[76:79]
    s_nop 2
    v_cvt_pk_bf16_f32 v80, v80, v81
    v_cvt_pk_bf16_f32 v81, v82, v83
    ds_wrxchg_rtn_b64 v[74:75], v93, v[80:81] offset:65408
    v_cvt_pk_bf16_f32 v76, v76, v77
    v_cvt_pk_bf16_f32 v77, v78, v79
    ds_wrxchg_rtn_b64 v[72:73], v92, v[76:77] offset:65408
    s_barrier
    s_setprio 3
    s_mov_b32 m0, s100
    s_nop 0
    ds_write_addtid_b32 v124 offset:34816
    ds_write_addtid_b32 v125 offset:35072
    ds_write_addtid_b32 v126 offset:35328
    ds_write_addtid_b32 v127 offset:35584
    s_add_u32 s3, s40, 4096
    buffer_load_dwordx4 v[124:127], v3, s[16:19], s3 offen sc1
    ds_write_addtid_b32 v116 offset:32768
    ds_write_addtid_b32 v117 offset:33024
    ds_write_addtid_b32 v118 offset:33280
    ds_write_addtid_b32 v119 offset:33536
    buffer_load_dwordx4 v[116:119], v3, s[16:19], s40 offen offset:2048 sc1
    ds_write_addtid_b32 v120 offset:33792
    ds_write_addtid_b32 v121 offset:34048
    ds_write_addtid_b32 v122 offset:34304
    ds_write_addtid_b32 v123 offset:34560
    buffer_load_dwordx4 v[120:123], v3, s[16:19], s40 offen offset:3072 sc1
    v_mfma_f32_4x4x4_16b_bf16 v[80:83], v[8:9], v[106:107], 0
    v_mfma_f32_4x4x4_16b_bf16 v[76:79], v[8:9], v[104:105], 0
    s_nop 3
    v_pk_mul_f32 v[80:81], v[80:81], v[14:15] op_sel:[0,1] op_sel_hi:[1,1]
    v_pk_mul_f32 v[82:83], v[82:83], v[14:15] op_sel:[0,1] op_sel_hi:[1,1]
    v_pk_mul_f32 v[76:77], v[76:77], v[14:15] op_sel:[0,0] op_sel_hi:[1,0]
    v_pk_mul_f32 v[78:79], v[78:79], v[14:15] op_sel:[0,0] op_sel_hi:[1,0]
    s_cmp_gt_u32 s37, 1024
    s_cbranch_scc1 L2_xs97
    s_cmp_lg_u32 s101, 0
    s_cbranch_scc1 L2_xa97
L2_xb97:
    v_lshlrev_b32 v89, 16, v96
    v_add_u32 v90, 60, v97
    v_bitop3_b32 v90, v89, v45, v90 bitop3:0x6a
    ds_write_b32 v98, v90 offset:12
    v_lshlrev_b32 v89, 20, v96
    v_add_u32 v90, 40, v97
    v_bitop3_b32 v90, v89, v45, v90 bitop3:0x6a
    ds_write_b32 v98, v90 offset:8
    v_lshlrev_b32 v89, 24, v96
    v_add_u32 v90, 20, v97
    v_bitop3_b32 v90, v89, v45, v90 bitop3:0x6a
    ds_write_b32 v98, v90 offset:4
    v_lshlrev_b32 v89, 28, v96
    v_bitop3_b32 v90, v89, v45, v97 bitop3:0x6a
    ds_write_b32 v98, v90 offset:0
    v_mov_b32_dpp v91, v64 quad_perm:[1,1,1,1] row_mask:0xf bank_mask:0xf
    v_and_b32 v89, 3, v91
    v_and_b32 v97, 0xfffc, v91
    v_sub_u16_dpp v88, v64, v91 quad_perm:[3,3,3,3] row_mask:0xf bank_mask:0xf
    v_mad_u32_u24 v97, v97, 5, v4
    v_add_u32 v99, v88, v89
    v_bfm_b32 v96, v88, v89
    v_cmp_lt_u32 s[58:59], 16, v99
    v_lshlrev_b32 v89, v1, v96
    v_and_b32 v89, v45, v89
    v_cmp_ne_u32 vcc, 0, v89
    v_xor_b32 v90, v97, v89
    s_add_u32 s3, s37, s38
    v_mbcnt_lo_u32_b32 v98, vcc_lo, 0
    v_mbcnt_hi_u32_b32 v98, vcc_hi, v98
    s_bcnt1_i32_b64 s41, vcc
    v_lshl_add_u32 v98, v98, 2, s3
    s_lshl2_add_u32 s37, s41, s37
    s_mov_b64 exec, vcc
    ds_write_b32 v98, v90
    s_mov_b64 exec, -1
    s_cmp_lg_u64 s[58:59], 0
    s_cbranch_scc1 L2_xe97
L2_xr97:
    v_add_u32 v98, s37, v0
    v_mov_b32 v90, -1
    ds_write_b32 v98, v90
L2_xw97:
    s_setprio 2
    s_waitcnt lgkmcnt(14)
    v_cmp_ne_u64 s[50:51], v[72:73], v[68:69]
    v_cmpx_ne_u64 s[54:55], v[74:75], v[70:71]
    s_and_b64 s[82:83], s[54:55], s[80:81]
    s_cbranch_scc1 L2_c98
L2_d98:
    v_mov_b64 v[84:85], v[70:71]
    v_mov_b32 v7, v93
    v_mov_b64 v[86:87], v[74:75]
    s_or_b64 s[80:81], s[80:81], s[54:55]
    s_mov_b64 exec, s[50:51]
    s_and_b64 s[82:83], s[50:51], s[80:81]
    s_cbranch_scc1 L2_c99
L2_d99:
    v_mov_b64 v[84:85], v[68:69]
    v_mov_b32 v7, v92
    v_mov_b64 v[86:87], v[72:73]
    s_mov_b64 exec, -1
    s_or_b64 s[80:81], s[80:81], s[50:51]
    ds_read_b64 v[70:71], v95 offset:65408
    ds_read_b64 v[68:69], v94 offset:65408
    v_and_b32 v46, 0x40000000, v39
    v_bitop3_b32 v92, v36, v5, v46 bitop3:0xea
    v_and_b32 v46, 0x80000000, v39
    v_bitop3_b32 v93, v37, v5, v46 bitop3:0xea
    v_perm_b32 v15, v37, v38, s47
    v_bitop3_b32 v46, v37, 0.5, -0.5 bitop3:0xa8
    v_perm_b32 v14, v36, v38, s46
    v_bitop3_b32 v47, v36, 0.5, -0.5 bitop3:0xa8
    v_bitop3_b32 v15, v6, v15, v46 bitop3:0xca
    v_bitop3_b32 v14, v6, v14, v47 bitop3:0xca
    s_setprio 1
    s_waitcnt lgkmcnt(1)
    v_mfma_f32_4x4x4_16b_bf16 v[80:83], v[10:11], v[70:71], v[80:83]
    s_waitcnt lgkmcnt(0)
    v_mfma_f32_4x4x4_16b_bf16 v[76:79], v[10:11], v[68:69], v[76:79]
    s_nop 2
    v_cvt_pk_bf16_f32 v80, v80, v81
    v_cvt_pk_bf16_f32 v81, v82, v83
    ds_wrxchg_rtn_b64 v[74:75], v95, v[80:81] offset:65408
    v_cvt_pk_bf16_f32 v76, v76, v77
    v_cvt_pk_bf16_f32 v77, v78, v79
    ds_wrxchg_rtn_b64 v[72:73], v94, v[76:77] offset:65408
    ds_read_b32 v19, v44 offset:768
    ds_read_b32 v27, v0 offset:0
    ds_read_b32 v33, v0 offset:256
    ds_read_b32 v39, v0 offset:512
    s_sub_u32 s3, s37, 768
    s_cmp_gt_u32 s3, 128
    s_cbranch_scc1 L2_xf97
L2_xg97:
    v_and_b32 v88, 0x0fffffff, v43
    buffer_load_dwordx2 v[34:35], v88, s[8:11], 0 offen
    buffer_load_dwordx3 v[36:38], v88, s[8:11], 0 offen offset:8
    s_setprio 0
    s_waitcnt vmcnt(10)
    s_mov_b32 m0, s38
    s_nop 0
    ds_write_addtid_b32 v108 offset:0
    ds_write_addtid_b32 v109 offset:256
    ds_write_addtid_b32 v110 offset:512
    ds_write_addtid_b32 v111 offset:768
    s_waitcnt vmcnt(7)
    ds_write_addtid_b32 v112 offset:1024
    ds_write_addtid_b32 v113 offset:1280
    ds_write_addtid_b32 v114 offset:1536
    ds_write_addtid_b32 v115 offset:1792
    v_mfma_f32_4x4x4_16b_bf16 v[80:83], v[8:9], v[102:103], 0
    v_mfma_f32_4x4x4_16b_bf16 v[76:79], v[8:9], v[100:101], 0
    v_cmp_lt_u32 s[84:85], v5, v92
    s_nop 2
    v_pk_mul_f32 v[80:81], v[80:81], v[14:15] op_sel:[0,1] op_sel_hi:[1,1]
    v_pk_mul_f32 v[82:83], v[82:83], v[14:15] op_sel:[0,1] op_sel_hi:[1,1]
    v_pk_mul_f32 v[76:77], v[76:77], v[14:15] op_sel:[0,0] op_sel_hi:[1,0]
    v_pk_mul_f32 v[78:79], v[78:79], v[14:15] op_sel:[0,0] op_sel_hi:[1,0]
    s_add_u32 s42, s42, 1
    s_waitcnt lgkmcnt(0)
    s_barrier
    s_bitcmp1_b32 s36, s42
    s_cbranch_scc1 L2_slow
L2_ret5:
    s_setprio 3
    s_bitcmp1_b32 s43, s42
    s_cbranch_scc1 L2_oa100
L2_ob100:
    s_mov_b64 exec, s[6:7]
    v_lshrrev_b32 v18, 16, v18
    s_mov_b64 exec, -1
    v_and_b32 v46, 0x20000000, v40
    v_lshrrev_b32 v47, 14, v17
    v_bitop3_b32 v47, v47, v5, v46 bitop3:0xea
    ds_read_b64 v[106:107], v47
    v_and_b32 v99, 0x10000000, v40
    v_lshrrev_b32 v47, 14, v16
    v_bitop3_b32 v47, v47, v5, v99 bitop3:0xea
    ds_read_b64 v[104:105], v47
    v_cmp_ne_u64 s[50:51], v[72:73], v[68:69]
    v_cmpx_ne_u64 s[54:55], v[74:75], v[70:71]
    s_and_b64 s[82:83], s[54:55], s[80:81]
    s_cbranch_scc1 L2_c101
L2_d101:
    v_mov_b64 v[84:85], v[70:71]
    v_mov_b32 v7, v95
    v_mov_b64 v[86:87], v[74:75]
    s_or_b64 s[80:81], s[80:81], s[54:55]
    s_mov_b64 exec, s[50:51]
    s_and_b64 s[82:83], s[50:51], s[80:81]
    s_cbranch_scc1 L2_c102
L2_d102:
    v_mov_b64 v[84:85], v[68:69]
    v_mov_b32 v7, v94
    v_mov_b64 v[86:87], v[72:73]
    s_mov_b64 exec, -1
    s_or_b64 s[80:81], s[80:81], s[50:51]
    s_and_b64 exec, s[84:85], s[80:81]
    v_mfma_f32_4x4x4_16b_bf16 v[76:79], v[12:13], v[84:85], 0
    v_mov_b32 v92, v7
    s_andn2_b64 s[80:81], s[80:81], s[84:85]
    v_mfma_f32_4x4x4_16b_bf16 v[76:79], v[10:11], v[86:87], v[76:79]
    s_mov_b64 exec, -1
    ds_read_b64 v[70:71], v93 offset:65408
    ds_read_b64 v[68:69], v92 offset:65408
    v_bitop3_b32 v94, v16, v5, v99 bitop3:0xea
    v_bitop3_b32 v95, v17, v5, v46 bitop3:0xea
    v_perm_b32 v15, v17, v18, s45
    v_bitop3_b32 v46, v17, 0.5, -0.5 bitop3:0xa8
    v_perm_b32 v14, v16, v18, s44
    v_bitop3_b32 v47, v16, 0.5, -0.5 bitop3:0xa8
    v_bitop3_b32 v15, v6, v15, v46 bitop3:0xca
    v_bitop3_b32 v14, v6, v14, v47 bitop3:0xca
    s_waitcnt lgkmcnt(1)
    v_mfma_f32_4x4x4_16b_bf16 v[80:83], v[10:11], v[70:71], v[80:83]
    s_waitcnt lgkmcnt(0)
    v_mfma_f32_4x4x4_16b_bf16 v[76:79], v[10:11], v[68:69], v[76:79]
    s_nop 2
    v_cvt_pk_bf16_f32 v80, v80, v81
    v_cvt_pk_bf16_f32 v81, v82, v83
    ds_wrxchg_rtn_b64 v[74:75], v93, v[80:81] offset:65408
    v_cvt_pk_bf16_f32 v76, v76, v77
    v_cvt_pk_bf16_f32 v77, v78, v79
    ds_wrxchg_rtn_b64 v[72:73], v92, v[76:77] offset:65408
    v_mfma_f32_4x4x4_16b_bf16 v[80:83], v[8:9], v[106:107], 0
    v_mfma_f32_4x4x4_16b_bf16 v[76:79], v[8:9], v[104:105], 0
    v_cmp_lt_u32 s[84:85], v5, v94
    s_nop 2
    v_pk_mul_f32 v[80:81], v[80:81], v[14:15] op_sel:[0,1] op_sel_hi:[1,1]
    v_pk_mul_f32 v[82:83], v[82:83], v[14:15] op_sel:[0,1] op_sel_hi:[1,1]
    v_pk_mul_f32 v[76:77], v[76:77], v[14:15] op_sel:[0,0] op_sel_hi:[1,0]
    v_pk_mul_f32 v[78:79], v[78:79], v[14:15] op_sel:[0,0] op_sel_hi:[1,0]
    v_and_b32 v47, 0x0fffffff, v19
    buffer_load_dword v18, v47, s[8:11], 0 offen offset:16
    s_mov_b64 exec, s[6:7]
    v_add_u32 v47, 8, v47
    v_lshrrev_b32 v19, 2, v19
    s_mov_b64 exec, -1
    buffer_load_dwordx2 v[16:17], v47, s[8:11], 0 offen
    v_and_b32 v46, 0x20000000, v41
    v_lshrrev_b32 v47, 14, v23
    v_bitop3_b32 v47, v47, v5, v46 bitop3:0xea
    ds_read_b64 v[102:103], v47
    v_and_b32 v99, 0x10000000, v41
    v_lshrrev_b32 v47, 14, v22
    v_bitop3_b32 v47, v47, v5, v99 bitop3:0xea
    ds_read_b64 v[100:101], v47
    s_waitcnt lgkmcnt(2)
    v_cmp_ne_u64 s[50:51], v[72:73], v[68:69]
    v_cmpx_ne_u64 s[54:55], v[74:75], v[70:71]
    s_and_b64 s[82:83], s[54:55], s[80:81]
    s_cbranch_scc1 L2_c103
L2_d103:
    v_mov_b64 v[84:85], v[70:71]
    v_mov_b32 v7, v93
    v_mov_b64 v[86:87], v[74:75]
    s_or_b64 s[80:81], s[80:81], s[54:55]
    s_mov_b64 exec, s[50:51]
    s_and_b64 s[82:83], s[50:51], s[80:81]
    s_cbranch_scc1 L2_c104
L2_d104:
    v_mov_b64 v[84:85], v[68:69]
    v_mov_b32 v7, v92
    v_mov_b64 v[86:87], v[72:73]
    s_mov_b64 exec, -1
    s_or_b64 s[80:81], s[80:81], s[50:51]
    s_and_b64 exec, s[84:85], s[80:81]
    v_mfma_f32_4x4x4_16b_bf16 v[76:79], v[12:13], v[84:85], 0
    v_mov_b32 v94, v7
    s_andn2_b64 s[80:81], s[80:81], s[84:85]
    v_mfma_f32_4x4x4_16b_bf16 v[76:79], v[10:11], v[86:87], v[76:79]
    s_mov_b64 exec, -1
    ds_read_b64 v[70:71], v95 offset:65408
    ds_read_b64 v[68:69], v94 offset:65408
    v_bitop3_b32 v92, v22, v5, v99 bitop3:0xea
    v_bitop3_b32 v93, v23, v5, v46 bitop3:0xea
    v_perm_b32 v15, v23, v26, s45
    v_bitop3_b32 v46, v23, 0.5, -0.5 bitop3:0xa8
    v_perm_b32 v14, v22, v26, s44
    v_bitop3_b32 v47, v22, 0.5, -0.5 bitop3:0xa8
    v_bitop3_b32 v15, v6, v15, v46 bitop3:0xca
    v_bitop3_b32 v14, v6, v14, v47 bitop3:0xca
    s_waitcnt lgkmcnt(1)
    v_mfma_f32_4x4x4_16b_bf16 v[80:83], v[10:11], v[70:71], v[80:83]
    s_waitcnt lgkmcnt(0)
    v_mfma_f32_4x4x4_16b_bf16 v[76:79], v[10:11], v[68:69], v[76:79]
    s_nop 2
    v_cvt_pk_bf16_f32 v80, v80, v81
    v_cvt_pk_bf16_f32 v81, v82, v83
    ds_wrxchg_rtn_b64 v[74:75], v95, v[80:81] offset:65408
    v_cvt_pk_bf16_f32 v76, v76, v77
    v_cvt_pk_bf16_f32 v77, v78, v79
    ds_wrxchg_rtn_b64 v[72:73], v94, v[76:77] offset:65408
    v_mfma_f32_4x4x4_16b_bf16 v[80:83], v[8:9], v[102:103], 0
    v_mfma_f32_4x4x4_16b_bf16 v[76:79], v[8:9], v[100:101], 0
    v_cmp_lt_u32 s[48:49], v5, v93
    s_nop 2
    v_pk_mul_f32 v[80:81], v[80:81], v[14:15] op_sel:[0,1] op_sel_hi:[1,1]
    v_pk_mul_f32 v[82:83], v[82:83], v[14:15] op_sel:[0,1] op_sel_hi:[1,1]
    v_pk_mul_f32 v[76:77], v[76:77], v[14:15] op_sel:[0,0] op_sel_hi:[1,0]
    v_pk_mul_f32 v[78:79], v[78:79], v[14:15] op_sel:[0,0] op_sel_hi:[1,0]
    buffer_load_dwordx4 v[108:111], v3, s[16:19], s40 offen offset:0 sc1
    v_and_b32 v46, 0x80000000, v41
    v_lshrrev_b32 v47, 14, v25
    v_bitop3_b32 v47, v47, v5, v46 bitop3:0xea
    ds_read_b64 v[106:107], v47
    v_and_b32 v99, 0x40000000, v41
    v_lshrrev_b32 v47, 14, v24
    v_bitop3_b32 v47, v47, v5, v99 bitop3:0xea
    ds_read_b64 v[104:105], v47
    s_waitcnt lgkmcnt(2)
    v_cmp_ne_u64 s[50:51], v[72:73], v[68:69]
    v_cmpx_ne_u64 s[54:55], v[74:75], v[70:71]
    s_and_b64 s[82:83], s[54:55], s[80:81]
    s_cbranch_scc1 L2_c105
L2_d105:
    v_mov_b64 v[84:85], v[70:71]
    v_mov_b32 v7, v95
    v_mov_b64 v[86:87], v[74:75]
    s_or_b64 s[80:81], s[80:81], s[54:55]
    s_mov_b64 exec, s[50:51]
    s_and_b64 s[82:83], s[50:51], s[80:81]
    s_cbranch_scc1 L2_c106
L2_d106:
    v_mov_b64 v[84:85], v[68:69]
    v_mov_b32 v7, v94
    v_mov_b64 v[86:87], v[72:73]
    s_mov_b64 exec, -1
    s_or_b64 s[80:81], s[80:81], s[50:51]
    s_and_b64 exec, s[48:49], s[80:81]
    v_mfma_f32_4x4x4_16b_bf16 v[80:83], v[12:13], v[84:85], 0
    v_mov_b32 v93, v7
    s_andn2_b64 s[80:81], s[80:81], s[48:49]
    v_mfma_f32_4x4x4_16b_bf16 v[80:83], v[10:11], v[86:87], v[80:83]
    s_mov_b64 exec, -1
    ds_read_b64 v[70:71], v93 offset:65408
    ds_read_b64 v[68:69], v92 offset:65408
    v_bitop3_b32 v94, v24, v5, v99 bitop3:0xea
    v_bitop3_b32 v95, v25, v5, v46 bitop3:0xea
    v_perm_b32 v15, v25, v26, s47
    v_bitop3_b32 v46, v25, 0.5, -0.5 bitop3:0xa8
    v_perm_b32 v14, v24, v26, s46
    v_bitop3_b32 v47, v24, 0.5, -0.5 bitop3:0xa8
    v_bitop3_b32 v15, v6, v15, v46 bitop3:0xca
    v_bitop3_b32 v14, v6, v14, v47 bitop3:0xca
    s_waitcnt lgkmcnt(1)
    v_mfma_f32_4x4x4_16b_bf16 v[80:83], v[10:11], v[70:71], v[80:83]
    s_waitcnt lgkmcnt(0)
    v_mfma_f32_4x4x4_16b_bf16 v[76:79], v[10:11], v[68:69], v[76:79]
    s_nop 2
    v_cvt_pk_bf16_f32 v80, v80, v81
    v_cvt_pk_bf16_f32 v81, v82, v83
    ds_wrxchg_rtn_b64 v[74:75], v93, v[80:81] offset:65408
    v_cvt_pk_bf16_f32 v76, v76, v77
    v_cvt_pk_bf16_f32 v77, v78, v79
    ds_wrxchg_rtn_b64 v[72:73], v92, v[76:77] offset:65408
    v_and_b32 v88, 0x0fffffff, v27
    buffer_load_dwordx2 v[22:23], v88, s[8:11], 0 offen
    buffer_load_dwordx3 v[24:26], v88, s[8:11], 0 offen offset:8
    s_setprio 2
    v_mfma_f32_4x4x4_16b_bf16 v[80:83], v[8:9], v[106:107], 0
    v_mfma_f32_4x4x4_16b_bf16 v[76:79], v[8:9], v[104:105], 0
    s_nop 3
    v_pk_mul_f32 v[80:81], v[80:81], v[14:15] op_sel:[0,1] op_sel_hi:[1,1]
    v_pk_mul_f32 v[82:83], v[82:83], v[14:15] op_sel:[0,1] op_sel_hi:[1,1]
    v_pk_mul_f32 v[76:77], v[76:77], v[14:15] op_sel:[0,0] op_sel_hi:[1,0]
    v_pk_mul_f32 v[78:79], v[78:79], v[14:15] op_sel:[0,0] op_sel_hi:[1,0]
    s_waitcnt vmcnt(10)
    v_and_b32 v46, 0x20000000, v42
    v_lshrrev_b32 v47, 14, v29
    v_bitop3_b32 v47, v47, v5, v46 bitop3:0xea
    ds_read_b64 v[102:103], v47
    v_and_b32 v99, 0x10000000, v42
    v_lshrrev_b32 v47, 14, v28
    v_bitop3_b32 v47, v47, v5, v99 bitop3:0xea
    ds_read_b64 v[100:101], v47
    s_waitcnt lgkmcnt(2)
    v_cmp_ne_u64 s[50:51], v[72:73], v[68:69]
    v_cmpx_ne_u64 s[54:55], v[74:75], v[70:71]
    s_and_b64 s[82:83], s[54:55], s[80:81]
    s_cbranch_scc1 L2_c107
L2_d107:
    v_mov_b64 v[84:85], v[70:71]
    v_mov_b32 v7, v93
    v_mov_b64 v[86:87], v[74:75]
    s_or_b64 s[80:81], s[80:81], s[54:55]
    s_mov_b64 exec, s[50:51]
    s_and_b64 s[82:83], s[50:51], s[80:81]
    s_cbranch_scc1 L2_c108
L2_d108:
    v_mov_b64 v[84:85], v[68:69]
    v_mov_b32 v7, v92
    v_mov_b64 v[86:87], v[72:73]
    s_mov_b64 exec, -1
    s_or_b64 s[80:81], s[80:81], s[50:51]
    ds_read_b64 v[70:71], v95 offset:65408
    ds_read_b64 v[68:69], v94 offset:65408
    v_bitop3_b32 v92, v28, v5, v99 bitop3:0xea
    v_bitop3_b32 v93, v29, v5, v46 bitop3:0xea
    v_perm_b32 v15, v29, v32, s45
    v_bitop3_b32 v46, v29, 0.5, -0.5 bitop3:0xa8
    v_perm_b32 v14, v28, v32, s44
    v_bitop3_b32 v47, v28, 0.5, -0.5 bitop3:0xa8
    v_bitop3_b32 v15, v6, v15, v46 bitop3:0xca
    v_bitop3_b32 v14, v6, v14, v47 bitop3:0xca
    s_waitcnt lgkmcnt(1)
    v_mfma_f32_4x4x4_16b_bf16 v[80:83], v[10:11], v[70:71], v[80:83]
    s_waitcnt lgkmcnt(0)
    v_mfma_f32_4x4x4_16b_bf16 v[76:79], v[10:11], v[68:69], v[76:79]
    s_nop 2
    v_cvt_pk_bf16_f32 v80, v80, v81
    v_cvt_pk_bf16_f32 v81, v82, v83
    ds_wrxchg_rtn_b64 v[74:75], v95, v[80:81] offset:65408
    v_cvt_pk_bf16_f32 v76, v76, v77
    v_cvt_pk_bf16_f32 v77, v78, v79
    ds_wrxchg_rtn_b64 v[72:73], v94, v[76:77] offset:65408
    s_setprio 1
    v_mfma_f32_4x4x4_16b_bf16 v[80:83], v[8:9], v[102:103], 0
    v_mfma_f32_4x4x4_16b_bf16 v[76:79], v[8:9], v[100:101], 0
    v_cmp_lt_u32 s[84:85], v5, v92
    s_nop 2
    v_pk_mul_f32 v[80:81], v[80:81], v[14:15] op_sel:[0,1] op_sel_hi:[1,1]
    v_pk_mul_f32 v[82:83], v[82:83], v[14:15] op_sel:[0,1] op_sel_hi:[1,1]
    v_pk_mul_f32 v[76:77], v[76:77], v[14:15] op_sel:[0,0] op_sel_hi:[1,0]
    v_pk_mul_f32 v[78:79], v[78:79], v[14:15] op_sel:[0,0] op_sel_hi:[1,0]
    s_bitcmp1_b32 s43, s42
    s_cbranch_scc1 L2_oa109
L2_ob109:
    buffer_load_dwordx4 v[112:115], v3, s[16:19], s40 offen offset:1024 sc1
    v_sub_u16 v88, v62, v54
    v_and_b32 v89, 3, v54
    v_add3_u32 v99, v88, v89, 3
    v_and_b32 v99, -4, v99
    v_max_u32 v99, 4, v99
    v_and_b32 v97, 0xfffc, v54
    v_bfm_b32 v96, v88, v89
    v_add_u32_dpp v91, v99, v99 row_shr:1 row_mask:0xf bank_mask:0xf bound_ctrl:1
    v_mad_u32_u24 v97, v97, 5, v2
    v_cmp_lt_u32 vcc, 16, v99
    v_add_u32_dpp v91, v91, v91 row_shr:2 row_mask:0xf bank_mask:0xf bound_ctrl:1
    v_sub_u32 v98, s38, v99
    v_lshrrev_b64 v[54:55], 16, v[54:55]
    v_add_u32_dpp v91, v91, v91 row_shr:4 row_mask:0xf bank_mask:0xf bound_ctrl:1
    v_lshrrev_b64 v[62:63], 16, v[62:63]
    s_mov_b32 s101, 0
    v_add_u32_dpp v91, v91, v91 row_shr:8 row_mask:0xf bank_mask:0xf bound_ctrl:1
    s_nop 1
    v_add_u32_dpp v91, v91, v91 row_bcast:15 row_mask:0xa bank_mask:0xf
    s_nop 1
    v_add_u32_dpp v91, v91, v91 row_bcast:31 row_mask:0xc bank_mask:0xf
    v_add_u32 v98, v98, v91
    v_readlane_b32 s37, v91, 63
    s_cbranch_vccnz L2_xo110
L2_xp110:
    v_and_b32 v46, 0x80000000, v42
    v_lshrrev_b32 v47, 14, v31
    v_bitop3_b32 v47, v47, v5, v46 bitop3:0xea
    ds_read_b64 v[106:107], v47
    v_and_b32 v99, 0x40000000, v42
    v_lshrrev_b32 v47, 14, v30
    v_bitop3_b32 v47, v47, v5, v99 bitop3:0xea
    ds_read_b64 v[104:105], v47
    s_waitcnt lgkmcnt(2)
    v_cmp_ne_u64 s[50:51], v[72:73], v[68:69]
    v_cmpx_ne_u64 s[54:55], v[74:75], v[70:71]
    s_and_b64 s[82:83], s[54:55], s[80:81]
    s_cbranch_scc1 L2_c111
L2_d111:
    v_mov_b64 v[84:85], v[70:71]
    v_mov_b32 v7, v95
    v_mov_b64 v[86:87], v[74:75]
    s_or_b64 s[80:81], s[80:81], s[54:55]
    s_mov_b64 exec, s[50:51]
    s_and_b64 s[82:83], s[50:51], s[80:81]
    s_cbranch_scc1 L2_c112
L2_d112:
    v_mov_b64 v[84:85], v[68:69]
    v_mov_b32 v7, v94
    v_mov_b64 v[86:87], v[72:73]
    s_mov_b64 exec, -1
    s_or_b64 s[80:81], s[80:81], s[50:51]
    s_and_b64 exec, s[84:85], s[80:81]
    v_mfma_f32_4x4x4_16b_bf16 v[76:79], v[12:13], v[84:85], 0
    v_mov_b32 v92, v7
    s_andn2_b64 s[80:81], s[80:81], s[84:85]
    v_mfma_f32_4x4x4_16b_bf16 v[76:79], v[10:11], v[86:87], v[76:79]
    s_mov_b64 exec, -1
    ds_read_b64 v[70:71], v93 offset:65408
    ds_read_b64 v[68:69], v92 offset:65408
    v_bitop3_b32 v94, v30, v5, v99 bitop3:0xea
    v_bitop3_b32 v95, v31, v5, v46 bitop3:0xea
    v_perm_b32 v15, v31, v32, s47
    v_bitop3_b32 v46, v31, 0.5, -0.5 bitop3:0xa8
    v_perm_b32 v14, v30, v32, s46
    v_bitop3_b32 v47, v30, 0.5, -0.5 bitop3:0xa8
    v_bitop3_b32 v15, v6, v15, v46 bitop3:0xca
    v_bitop3_b32 v14, v6, v14, v47 bitop3:0xca
    s_waitcnt lgkmcnt(1)
    v_mfma_f32_4x4x4_16b_bf16 v[80:83], v[10:11], v[70:71], v[80:83]
    s_waitcnt lgkmcnt(0)
    v_mfma_f32_4x4x4_16b_bf16 v[76:79], v[10:11], v[68:69], v[76:79]
    s_nop 2
    v_cvt_pk_bf16_f32 v80, v80, v81
    v_cvt_pk_bf16_f32 v81, v82, v83
    ds_wrxchg_rtn_b64 v[74:75], v93, v[80:81] offset:65408
    v_cvt_pk_bf16_f32 v76, v76, v77
    v_cvt_pk_bf16_f32 v77, v78, v79
    ds_wrxchg_rtn_b64 v[72:73], v92, v[76:77] offset:65408
    v_and_b32 v88, 0x0fffffff, v33
    buffer_load_dwordx2 v[28:29], v88, s[8:11], 0 offen
    buffer_load_dwordx3 v[30:32], v88, s[8:11], 0 offen offset:8
    s_setprio 0
    v_mfma_f32_4x4x4_16b_bf16 v[80:83], v[8:9], v[106:107], 0
    v_mfma_f32_4x4x4_16b_bf16 v[76:79], v[8:9], v[104:105], 0
    v_cmp_lt_u32 s[48:49], v5, v95
    s_nop 2
    v_pk_mul_f32 v[80:81], v[80:81], v[14:15] op_sel:[0,1] op_sel_hi:[1,1]
    v_pk_mul_f32 v[82:83], v[82:83], v[14:15] op_sel:[0,1] op_sel_hi:[1,1]
    v_pk_mul_f32 v[76:77], v[76:77], v[14:15] op_sel:[0,0] op_sel_hi:[1,0]
    v_pk_mul_f32 v[78:79], v[78:79], v[14:15] op_sel:[0,0] op_sel_hi:[1,0]
    s_add_u32 s40, s40, 0x50000
    s_waitcnt vmcnt(8)
    v_and_b32 v46, 0x80000000, v43
    v_lshrrev_b32 v47, 14, v37
    v_bitop3_b32 v47, v47, v5, v46 bitop3:0xea
    ds_read_b64 v[106:107], v47
    v_and_b32 v99, 0x40000000, v43
    v_lshrrev_b32 v47, 14, v36
    v_bitop3_b32 v47, v47, v5, v99 bitop3:0xea
    ds_read_b64 v[104:105], v47
    v_and_b32 v46, 0x20000000, v43
    v_lshrrev_b32 v47, 14, v35
    v_bitop3_b32 v47, v47, v5, v46 bitop3:0xea
    ds_read_b64 v[102:103], v47
    v_and_b32 v99, 0x10000000, v43
    v_lshrrev_b32 v47, 14, v34
    v_bitop3_b32 v47, v47, v5, v99 bitop3:0xea
    ds_read_b64 v[100:101], v47
    s_waitcnt lgkmcnt(4)
    v_cmp_ne_u64 s[50:51], v[72:73], v[68:69]
    v_cmpx_ne_u64 s[54:55], v[74:75], v[70:71]
    s_and_b64 s[82:83], s[54:55], s[80:81]
    s_cbranch_scc1 L2_c113
L2_d113:
    v_mov_b64 v[84:85], v[70:71]
    v_mov_b32 v7, v93
    v_mov_b64 v[86:87], v[74:75]
    s_or_b64 s[80:81], s[80:81], s[54:55]
    s_mov_b64 exec, s[50:51]
    s_and_b64 s[82:83], s[50:51], s[80:81]
    s_cbranch_scc1 L2_c114
L2_d114:
    v_mov_b64 v[84:85], v[68:69]
    v_mov_b32 v7, v92
    v_mov_b64 v[86:87], v[72:73]
    s_mov_b64 exec, -1
    s_or_b64 s[80:81], s[80:81], s[50:51]
    s_and_b64 exec, s[48:49], s[80:81]
    v_mfma_f32_4x4x4_16b_bf16 v[80:83], v[12:13], v[84:85], 0
    v_mov_b32 v95, v7
    s_andn2_b64 s[80:81], s[80:81], s[48:49]
    v_mfma_f32_4x4x4_16b_bf16 v[80:83], v[10:11], v[86:87], v[80:83]
    s_mov_b64 exec, -1
    ds_read_b64 v[70:71], v95 offset:65408
    ds_read_b64 v[68:69], v94 offset:65408
    v_bitop3_b32 v92, v34, v5, v99 bitop3:0xea
    v_bitop3_b32 v93, v35, v5, v46 bitop3:0xea
    v_perm_b32 v15, v35, v38, s45
    v_bitop3_b32 v46, v35, 0.5, -0.5 bitop3:0xa8
    v_perm_b32 v14, v34, v38, s44
    v_bitop3_b32 v47, v34, 0.5, -0.5 bitop3:0xa8
    v_bitop3_b32 v15, v6, v15, v46 bitop3:0xca
    v_bitop3_b32 v14, v6, v14, v47 bitop3:0xca
    s_waitcnt lgkmcnt(1)
    v_mfma_f32_4x4x4_16b_bf16 v[80:83], v[10:11], v[70:71], v[80:83]
    s_waitcnt lgkmcnt(0)
    v_mfma_f32_4x4x4_16b_bf16 v[76:79], v[10:11], v[68:69], v[76:79]
    s_nop 2
    v_cvt_pk_bf16_f32 v80, v80, v81
    v_cvt_pk_bf16_f32 v81, v82, v83
    ds_wrxchg_rtn_b64 v[74:75], v95, v[80:81] offset:65408
    v_cvt_pk_bf16_f32 v76, v76, v77
    v_cvt_pk_bf16_f32 v77, v78, v79
    ds_wrxchg_rtn_b64 v[72:73], v94, v[76:77] offset:65408
    s_barrier
    s_setprio 3
    s_mov_b32 m0, s100
    s_nop 0
    ds_write_addtid_b32 v124 offset:34816
    ds_write_addtid_b32 v125 offset:35072
    ds_write_addtid_b32 v126 offset:35328
    ds_write_addtid_b32 v127 offset:35584
    s_add_u32 s3, s40, 4096
    buffer_load_dwordx4 v[124:127], v3, s[16:19], s3 offen sc1
    ds_write_addtid_b32 v116 offset:32768
    ds_write_addtid_b32 v117 offset:33024
    ds_write_addtid_b32 v118 offset:33280
    ds_write_addtid_b32 v119 offset:33536
    buffer_load_dwordx4 v[116:119], v3, s[16:19], s40 offen offset:2048 sc1
    ds_write_addtid_b32 v120 offset:33792
    ds_write_addtid_b32 v121 offset:34048
    ds_write_addtid_b32 v122 offset:34304
    ds_write_addtid_b32 v123 offset:34560
    buffer_load_dwordx4 v[120:123], v3, s[16:19], s40 offen offset:3072 sc1
    v_mfma_f32_4x4x4_16b_bf16 v[80:83], v[8:9], v[102:103], 0
    v_mfma_f32_4x4x4_16b_bf16 v[76:79], v[8:9], v[100:101], 0
    s_nop 3
    v_pk_mul_f32 v[80:81], v[80:81], v[14:15] op_sel:[0,1] op_sel_hi:[1,1]
    v_pk_mul_f32 v[82:83], v[82:83], v[14:15] op_sel:[0,1] op_sel_hi:[1,1]
    v_pk_mul_f32 v[76:77], v[76:77], v[14:15] op_sel:[0,0] op_sel_hi:[1,0]
    v_pk_mul_f32 v[78:79], v[78:79], v[14:15] op_sel:[0,0] op_sel_hi:[1,0]
    s_cmp_gt_u32 s37, 1024
    s_cbranch_scc1 L2_xs115
    s_cmp_lg_u32 s101, 0
    s_cbranch_scc1 L2_xa115
L2_xb115:
    v_lshlrev_b32 v89, 16, v96
    v_add_u32 v90, 60, v97
    v_bitop3_b32 v90, v89, v45, v90 bitop3:0x6a
    ds_write_b32 v98, v90 offset:12
    v_lshlrev_b32 v89, 20, v96
    v_add_u32 v90, 40, v97
    v_bitop3_b32 v90, v89, v45, v90 bitop3:0x6a
    ds_write_b32 v98, v90 offset:8
    v_lshlrev_b32 v89, 24, v96
    v_add_u32 v90, 20, v97
    v_bitop3_b32 v90, v89, v45, v90 bitop3:0x6a
    ds_write_b32 v98, v90 offset:4
    v_lshlrev_b32 v89, 28, v96
    v_bitop3_b32 v90, v89, v45, v97 bitop3:0x6a
    ds_write_b32 v98, v90 offset:0
    v_mov_b32_dpp v91, v66 quad_perm:[1,1,1,1] row_mask:0xf bank_mask:0xf
    v_and_b32 v89, 3, v91
    v_and_b32 v97, 0xfffc, v91
    v_sub_u16_dpp v88, v66, v91 quad_perm:[3,3,3,3] row_mask:0xf bank_mask:0xf
    v_mad_u32_u24 v97, v97, 5, v4
    v_add_u32 v99, v88, v89
    v_bfm_b32 v96, v88, v89
    v_cmp_lt_u32 s[58:59], 16, v99
    v_lshlrev_b32 v89, v1, v96
    v_and_b32 v89, v45, v89
    v_cmp_ne_u32 vcc, 0, v89
    v_xor_b32 v90, v97, v89
    s_add_u32 s3, s37, s38
    v_mbcnt_lo_u32_b32 v98, vcc_lo, 0
    v_mbcnt_hi_u32_b32 v98, vcc_hi, v98
    s_bcnt1_i32_b64 s41, vcc
    v_lshl_add_u32 v98, v98, 2, s3
    s_lshl2_add_u32 s37, s41, s37
    s_mov_b64 exec, vcc
    ds_write_b32 v98, v90
    s_mov_b64 exec, -1
    s_cmp_lg_u64 s[58:59], 0
    s_cbranch_scc1 L2_xe115
L2_xr115:
    v_add_u32 v98, s37, v0
    v_mov_b32 v90, -1
    ds_write_b32 v98, v90
L2_xw115:
    s_setprio 2
    s_waitcnt lgkmcnt(14)
    v_cmp_ne_u64 s[50:51], v[72:73], v[68:69]
    v_cmpx_ne_u64 s[54:55], v[74:75], v[70:71]
    s_and_b64 s[82:83], s[54:55], s[80:81]
    s_cbranch_scc1 L2_c116
L2_d116:
    v_mov_b64 v[84:85], v[70:71]
    v_mov_b32 v7, v95
    v_mov_b64 v[86:87], v[74:75]
    s_or_b64 s[80:81], s[80:81], s[54:55]
    s_mov_b64 exec, s[50:51]
    s_and_b64 s[82:83], s[50:51], s[80:81]
    s_cbranch_scc1 L2_c117
L2_d117:
    v_mov_b64 v[84:85], v[68:69]
    v_mov_b32 v7, v94
    v_mov_b64 v[86:87], v[72:73]
    s_mov_b64 exec, -1
    s_or_b64 s[80:81], s[80:81], s[50:51]
    ds_read_b64 v[70:71], v93 offset:65408
    ds_read_b64 v[68:69], v92 offset:65408
    v_and_b32 v46, 0x40000000, v43
    v_bitop3_b32 v94, v36, v5, v46 bitop3:0xea
    v_and_b32 v46, 0x80000000, v43
    v_bitop3_b32 v95, v37, v5, v46 bitop3:0xea
    v_perm_b32 v15, v37, v38, s47
    v_bitop3_b32 v46, v37, 0.5, -0.5 bitop3:0xa8
    v_perm_b32 v14, v36, v38, s46
    v_bitop3_b32 v47, v36, 0.5, -0.5 bitop3:0xa8
    v_bitop3_b32 v15, v6, v15, v46 bitop3:0xca
    v_bitop3_b32 v14, v6, v14, v47 bitop3:0xca
    s_setprio 1
    s_waitcnt lgkmcnt(1)
    v_mfma_f32_4x4x4_16b_bf16 v[80:83], v[10:11], v[70:71], v[80:83]
    s_waitcnt lgkmcnt(0)
    v_mfma_f32_4x4x4_16b_bf16 v[76:79], v[10:11], v[68:69], v[76:79]
    s_nop 2
    v_cvt_pk_bf16_f32 v80, v80, v81
    v_cvt_pk_bf16_f32 v81, v82, v83
    ds_wrxchg_rtn_b64 v[74:75], v93, v[80:81] offset:65408
    v_cvt_pk_bf16_f32 v76, v76, v77
    v_cvt_pk_bf16_f32 v77, v78, v79
    ds_wrxchg_rtn_b64 v[72:73], v92, v[76:77] offset:65408
    ds_read_b32 v40, v44 offset:768
    ds_read_b32 v41, v0 offset:0
    ds_read_b32 v42, v0 offset:256
    ds_read_b32 v43, v0 offset:512
    s_sub_u32 s3, s37, 768
    s_cmp_gt_u32 s3, 128
    s_cbranch_scc1 L2_xf115
L2_xg115:
    v_lshrrev_b64 v[64:65], 16, v[64:65]
    v_lshrrev_b64 v[66:67], 16, v[66:67]
    v_and_b32 v88, 0x0fffffff, v39
    buffer_load_dwordx2 v[34:35], v88, s[8:11], 0 offen
    buffer_load_dwordx3 v[36:38], v88, s[8:11], 0 offen offset:8
    s_setprio 0
    s_waitcnt vmcnt(10)
    s_mov_b32 m0, s38
    s_nop 0
    ds_write_addtid_b32 v108 offset:0
    ds_write_addtid_b32 v109 offset:256
    ds_write_addtid_b32 v110 offset:512
    ds_write_addtid_b32 v111 offset:768
    s_waitcnt vmcnt(7)
    ds_write_addtid_b32 v112 offset:1024
    ds_write_addtid_b32 v113 offset:1280
    ds_write_addtid_b32 v114 offset:1536
    ds_write_addtid_b32 v115 offset:1792
    v_mfma_f32_4x4x4_16b_bf16 v[80:83], v[8:9], v[106:107], 0
    v_mfma_f32_4x4x4_16b_bf16 v[76:79], v[8:9], v[104:105], 0
    v_cmp_lt_u32 s[84:85], v5, v94
    s_nop 2
    v_pk_mul_f32 v[80:81], v[80:81], v[14:15] op_sel:[0,1] op_sel_hi:[1,1]
    v_pk_mul_f32 v[82:83], v[82:83], v[14:15] op_sel:[0,1] op_sel_hi:[1,1]
    v_pk_mul_f32 v[76:77], v[76:77], v[14:15] op_sel:[0,0] op_sel_hi:[1,0]
    v_pk_mul_f32 v[78:79], v[78:79], v[14:15] op_sel:[0,0] op_sel_hi:[1,0]
    s_add_u32 s42, s42, 1
    s_waitcnt lgkmcnt(0)
    s_cmp_lg_u32 s42, 14
    s_cbranch_scc1 L2_loop
    s_barrier
    s_bitcmp1_b32 s36, s42
    s_cbranch_scc1 L2_slow
L2_ret6:
    s_setprio 3
    s_bitcmp1_b32 s43, s42
    s_cbranch_scc1 L2_oa118
L2_ob118:
    s_mov_b64 exec, s[6:7]
    v_lshrrev_b32 v18, 16, v18
    s_mov_b64 exec, -1
    v_and_b32 v46, 0x20000000, v19
    v_lshrrev_b32 v47, 14, v17
    v_bitop3_b32 v47, v47, v5, v46 bitop3:0xea
    ds_read_b64 v[102:103], v47
    v_and_b32 v99, 0x10000000, v19
    v_lshrrev_b32 v47, 14, v16
    v_bitop3_b32 v47, v47, v5, v99 bitop3:0xea
    ds_read_b64 v[100:101], v47
    v_cmp_ne_u64 s[50:51], v[72:73], v[68:69]
    v_cmpx_ne_u64 s[54:55], v[74:75], v[70:71]
    s_and_b64 s[82:83], s[54:55], s[80:81]
    s_cbranch_scc1 L2_c119
L2_d119:
    v_mov_b64 v[84:85], v[70:71]
    v_mov_b32 v7, v93
    v_mov_b64 v[86:87], v[74:75]
    s_or_b64 s[80:81], s[80:81], s[54:55]
    s_mov_b64 exec, s[50:51]
    s_and_b64 s[82:83], s[50:51], s[80:81]
    s_cbranch_scc1 L2_c120
L2_d120:
    v_mov_b64 v[84:85], v[68:69]
    v_mov_b32 v7, v92
    v_mov_b64 v[86:87], v[72:73]
    s_mov_b64 exec, -1
    s_or_b64 s[80:81], s[80:81], s[50:51]
    s_and_b64 exec, s[84:85], s[80:81]
    v_mfma_f32_4x4x4_16b_bf16 v[76:79], v[12:13], v[84:85], 0
    v_mov_b32 v94, v7
    s_andn2_b64 s[80:81], s[80:81], s[84:85]
    v_mfma_f32_4x4x4_16b_bf16 v[76:79], v[10:11], v[86:87], v[76:79]
    s_mov_b64 exec, -1
    ds_read_b64 v[70:71], v95 offset:65408
    ds_read_b64 v[68:69], v94 offset:65408
    v_bitop3_b32 v92, v16, v5, v99 bitop3:0xea
    v_bitop3_b32 v93, v17, v5, v46 bitop3:0xea
    v_perm_b32 v15, v17, v18, s45
    v_bitop3_b32 v46, v17, 0.5, -0.5 bitop3:0xa8
    v_perm_b32 v14, v16, v18, s44
    v_bitop3_b32 v47, v16, 0.5, -0.5 bitop3:0xa8
    v_bitop3_b32 v15, v6, v15, v46 bitop3:0xca
    v_bitop3_b32 v14, v6, v14, v47 bitop3:0xca
    s_waitcnt lgkmcnt(1)
    v_mfma_f32_4x4x4_16b_bf16 v[80:83], v[10:11], v[70:71], v[80:83]
    s_waitcnt lgkmcnt(0)
    v_mfma_f32_4x4x4_16b_bf16 v[76:79], v[10:11], v[68:69], v[76:79]
    s_nop 2
    v_cvt_pk_bf16_f32 v80, v80, v81
    v_cvt_pk_bf16_f32 v81, v82, v83
    ds_wrxchg_rtn_b64 v[74:75], v95, v[80:81] offset:65408
    v_cvt_pk_bf16_f32 v76, v76, v77
    v_cvt_pk_bf16_f32 v77, v78, v79
    ds_wrxchg_rtn_b64 v[72:73], v94, v[76:77] offset:65408
    v_mfma_f32_4x4x4_16b_bf16 v[80:83], v[8:9], v[102:103], 0
    v_mfma_f32_4x4x4_16b_bf16 v[76:79], v[8:9], v[100:101], 0
    v_cmp_lt_u32 s[84:85], v5, v92
    s_nop 2
    v_pk_mul_f32 v[80:81], v[80:81], v[14:15] op_sel:[0,1] op_sel_hi:[1,1]
    v_pk_mul_f32 v[82:83], v[82:83], v[14:15] op_sel:[0,1] op_sel_hi:[1,1]
    v_pk_mul_f32 v[76:77], v[76:77], v[14:15] op_sel:[0,0] op_sel_hi:[1,0]
    v_pk_mul_f32 v[78:79], v[78:79], v[14:15] op_sel:[0,0] op_sel_hi:[1,0]
    v_and_b32 v47, 0x0fffffff, v40
    buffer_load_dword v18, v47, s[8:11], 0 offen offset:16
    s_mov_b64 exec, s[6:7]
    v_add_u32 v47, 8, v47
    v_lshrrev_b32 v40, 2, v40
    s_mov_b64 exec, -1
    buffer_load_dwordx2 v[16:17], v47, s[8:11], 0 offen
    v_and_b32 v46, 0x20000000, v27
    v_lshrrev_b32 v47, 14, v23
    v_bitop3_b32 v47, v47, v5, v46 bitop3:0xea
    ds_read_b64 v[106:107], v47
    v_and_b32 v99, 0x10000000, v27
    v_lshrrev_b32 v47, 14, v22
    v_bitop3_b32 v47, v47, v5, v99 bitop3:0xea
    ds_read_b64 v[104:105], v47
    s_waitcnt lgkmcnt(2)
    v_cmp_ne_u64 s[50:51], v[72:73], v[68:69]
    v_cmpx_ne_u64 s[54:55], v[74:75], v[70:71]
    s_and_b64 s[82:83], s[54:55], s[80:81]
    s_cbranch_scc1 L2_c121
L2_d121:
    v_mov_b64 v[84:85], v[70:71]
    v_mov_b32 v7, v95
    v_mov_b64 v[86:87], v[74:75]
    s_or_b64 s[80:81], s[80:81], s[54:55]
    s_mov_b64 exec, s[50:51]
    s_and_b64 s[82:83], s[50:51], s[80:81]
    s_cbranch_scc1 L2_c122
L2_d122:
    v_mov_b64 v[84:85], v[68:69]
    v_mov_b32 v7, v94
    v_mov_b64 v[86:87], v[72:73]
    s_mov_b64 exec, -1
    s_or_b64 s[80:81], s[80:81], s[50:51]
    s_and_b64 exec, s[84:85], s[80:81]
    v_mfma_f32_4x4x4_16b_bf16 v[76:79], v[12:13], v[84:85], 0
    v_mov_b32 v92, v7
    s_andn2_b64 s[80:81], s[80:81], s[84:85]
    v_mfma_f32_4x4x4_16b_bf16 v[76:79], v[10:11], v[86:87], v[76:79]
    s_mov_b64 exec, -1
    ds_read_b64 v[70:71], v93 offset:65408
    ds_read_b64 v[68:69], v92 offset:65408
    v_bitop3_b32 v94, v22, v5, v99 bitop3:0xea
    v_bitop3_b32 v95, v23, v5, v46 bitop3:0xea
    v_perm_b32 v15, v23, v26, s45
    v_bitop3_b32 v46, v23, 0.5, -0.5 bitop3:0xa8
    v_perm_b32 v14, v22, v26, s44
    v_bitop3_b32 v47, v22, 0.5, -0.5 bitop3:0xa8
    v_bitop3_b32 v15, v6, v15, v46 bitop3:0xca
    v_bitop3_b32 v14, v6, v14, v47 bitop3:0xca
    s_waitcnt lgkmcnt(1)
    v_mfma_f32_4x4x4_16b_bf16 v[80:83], v[10:11], v[70:71], v[80:83]
    s_waitcnt lgkmcnt(0)
    v_mfma_f32_4x4x4_16b_bf16 v[76:79], v[10:11], v[68:69], v[76:79]
    s_nop 2
    v_cvt_pk_bf16_f32 v80, v80, v81
    v_cvt_pk_bf16_f32 v81, v82, v83
    ds_wrxchg_rtn_b64 v[74:75], v93, v[80:81] offset:65408
    v_cvt_pk_bf16_f32 v76, v76, v77
    v_cvt_pk_bf16_f32 v77, v78, v79
    ds_wrxchg_rtn_b64 v[72:73], v92, v[76:77] offset:65408
    v_mfma_f32_4x4x4_16b_bf16 v[80:83], v[8:9], v[106:107], 0
    v_mfma_f32_4x4x4_16b_bf16 v[76:79], v[8:9], v[104:105], 0
    v_cmp_lt_u32 s[48:49], v5, v95
    s_nop 2
    v_pk_mul_f32 v[80:81], v[80:81], v[14:15] op_sel:[0,1] op_sel_hi:[1,1]
    v_pk_mul_f32 v[82:83], v[82:83], v[14:15] op_sel:[0,1] op_sel_hi:[1,1]
    v_pk_mul_f32 v[76:77], v[76:77], v[14:15] op_sel:[0,0] op_sel_hi:[1,0]
    v_pk_mul_f32 v[78:79], v[78:79], v[14:15] op_sel:[0,0] op_sel_hi:[1,0]
    buffer_load_dwordx4 v[108:111], v3, s[16:19], s40 offen offset:0 sc1
    v_and_b32 v46, 0x80000000, v27
    v_lshrrev_b32 v47, 14, v25
    v_bitop3_b32 v47, v47, v5, v46 bitop3:0xea
    ds_read_b64 v[102:103], v47
    v_and_b32 v99, 0x40000000, v27
    v_lshrrev_b32 v47, 14, v24
    v_bitop3_b32 v47, v47, v5, v99 bitop3:0xea
    ds_read_b64 v[100:101], v47
    s_waitcnt lgkmcnt(2)
    v_cmp_ne_u64 s[50:51], v[72:73], v[68:69]
    v_cmpx_ne_u64 s[54:55], v[74:75], v[70:71]
    s_and_b64 s[82:83], s[54:55], s[80:81]
    s_cbranch_scc1 L2_c123
L2_d123:
    v_mov_b64 v[84:85], v[70:71]
    v_mov_b32 v7, v93
    v_mov_b64 v[86:87], v[74:75]
    s_or_b64 s[80:81], s[80:81], s[54:55]
    s_mov_b64 exec, s[50:51]
    s_and_b64 s[82:83], s[50:51], s[80:81]
    s_cbranch_scc1 L2_c124
L2_d124:
    v_mov_b64 v[84:85], v[68:69]
    v_mov_b32 v7, v92
    v_mov_b64 v[86:87], v[72:73]
    s_mov_b64 exec, -1
    s_or_b64 s[80:81], s[80:81], s[50:51]
    s_and_b64 exec, s[48:49], s[80:81]
    v_mfma_f32_4x4x4_16b_bf16 v[80:83], v[12:13], v[84:85], 0
    v_mov_b32 v95, v7
    s_andn2_b64 s[80:81], s[80:81], s[48:49]
    v_mfma_f32_4x4x4_16b_bf16 v[80:83], v[10:11], v[86:87], v[80:83]
    s_mov_b64 exec, -1
    ds_read_b64 v[70:71], v95 offset:65408
    ds_read_b64 v[68:69], v94 offset:65408
    v_bitop3_b32 v92, v24, v5, v99 bitop3:0xea
    v_bitop3_b32 v93, v25, v5, v46 bitop3:0xea
    v_perm_b32 v15, v25, v26, s47
    v_bitop3_b32 v46, v25, 0.5, -0.5 bitop3:0xa8
    v_perm_b32 v14, v24, v26, s46
    v_bitop3_b32 v47, v24, 0.5, -0.5 bitop3:0xa8
    v_bitop3_b32 v15, v6, v15, v46 bitop3:0xca
    v_bitop3_b32 v14, v6, v14, v47 bitop3:0xca
    s_waitcnt lgkmcnt(1)
    v_mfma_f32_4x4x4_16b_bf16 v[80:83], v[10:11], v[70:71], v[80:83]
    s_waitcnt lgkmcnt(0)
    v_mfma_f32_4x4x4_16b_bf16 v[76:79], v[10:11], v[68:69], v[76:79]
    s_nop 2
    v_cvt_pk_bf16_f32 v80, v80, v81
    v_cvt_pk_bf16_f32 v81, v82, v83
    ds_wrxchg_rtn_b64 v[74:75], v95, v[80:81] offset:65408
    v_cvt_pk_bf16_f32 v76, v76, v77
    v_cvt_pk_bf16_f32 v77, v78, v79
    ds_wrxchg_rtn_b64 v[72:73], v94, v[76:77] offset:65408
    v_and_b32 v88, 0x0fffffff, v41
    buffer_load_dwordx2 v[22:23], v88, s[8:11], 0 offen
    buffer_load_dwordx3 v[24:26], v88, s[8:11], 0 offen offset:8
    s_setprio 2
    v_mfma_f32_4x4x4_16b_bf16 v[80:83], v[8:9], v[102:103], 0
    v_mfma_f32_4x4x4_16b_bf16 v[76:79], v[8:9], v[100:101], 0
    s_nop 3
    v_pk_mul_f32 v[80:81], v[80:81], v[14:15] op_sel:[0,1] op_sel_hi:[1,1]
    v_pk_mul_f32 v[82:83], v[82:83], v[14:15] op_sel:[0,1] op_sel_hi:[1,1]
    v_pk_mul_f32 v[76:77], v[76:77], v[14:15] op_sel:[0,0] op_sel_hi:[1,0]
    v_pk_mul_f32 v[78:79], v[78:79], v[14:15] op_sel:[0,0] op_sel_hi:[1,0]
    s_waitcnt vmcnt(10)
    v_and_b32 v46, 0x20000000, v33
    v_lshrrev_b32 v47, 14, v29
    v_bitop3_b32 v47, v47, v5, v46 bitop3:0xea
    ds_read_b64 v[106:107], v47
    v_and_b32 v99, 0x10000000, v33
    v_lshrrev_b32 v47, 14, v28
    v_bitop3_b32 v47, v47, v5, v99 bitop3:0xea
    ds_read_b64 v[104:105], v47
    s_waitcnt lgkmcnt(2)
    v_cmp_ne_u64 s[50:51], v[72:73], v[68:69]
    v_cmpx_ne_u64 s[54:55], v[74:75], v[70:71]
    s_and_b64 s[82:83], s[54:55], s[80:81]
    s_cbranch_scc1 L2_c125
L2_d125:
    v_mov_b64 v[84:85], v[70:71]
    v_mov_b32 v7, v95
    v_mov_b64 v[86:87], v[74:75]
    s_or_b64 s[80:81], s[80:81], s[54:55]
    s_mov_b64 exec, s[50:51]
    s_and_b64 s[82:83], s[50:51], s[80:81]
    s_cbranch_scc1 L2_c126
L2_d126:
    v_mov_b64 v[84:85], v[68:69]
    v_mov_b32 v7, v94
    v_mov_b64 v[86:87], v[72:73]
    s_mov_b64 exec, -1
    s_or_b64 s[80:81], s[80:81], s[50:51]
    ds_read_b64 v[70:71], v93 offset:65408
    ds_read_b64 v[68:69], v92 offset:65408
    v_bitop3_b32 v94, v28, v5, v99 bitop3:0xea
    v_bitop3_b32 v95, v29, v5, v46 bitop3:0xea
    v_perm_b32 v15, v29, v32, s45
    v_bitop3_b32 v46, v29, 0.5, -0.5 bitop3:0xa8
    v_perm_b32 v14, v28, v32, s44
    v_bitop3_b32 v47, v28, 0.5, -0.5 bitop3:0xa8
    v_bitop3_b32 v15, v6, v15, v46 bitop3:0xca
    v_bitop3_b32 v14, v6, v14, v47 bitop3:0xca
    s_waitcnt lgkmcnt(1)
    v_mfma_f32_4x4x4_16b_bf16 v[80:83], v[10:11], v[70:71], v[80:83]
    s_waitcnt lgkmcnt(0)
    v_mfma_f32_4x4x4_16b_bf16 v[76:79], v[10:11], v[68:69], v[76:79]
    s_nop 2
    v_cvt_pk_bf16_f32 v80, v80, v81
    v_cvt_pk_bf16_f32 v81, v82, v83
    ds_wrxchg_rtn_b64 v[74:75], v93, v[80:81] offset:65408
    v_cvt_pk_bf16_f32 v76, v76, v77
    v_cvt_pk_bf16_f32 v77, v78, v79
    ds_wrxchg_rtn_b64 v[72:73], v92, v[76:77] offset:65408
    s_setprio 1
    v_mfma_f32_4x4x4_16b_bf16 v[80:83], v[8:9], v[106:107], 0
    v_mfma_f32_4x4x4_16b_bf16 v[76:79], v[8:9], v[104:105], 0
    v_cmp_lt_u32 s[84:85], v5, v94
    s_nop 2
    v_pk_mul_f32 v[80:81], v[80:81], v[14:15] op_sel:[0,1] op_sel_hi:[1,1]
    v_pk_mul_f32 v[82:83], v[82:83], v[14:15] op_sel:[0,1] op_sel_hi:[1,1]
    v_pk_mul_f32 v[76:77], v[76:77], v[14:15] op_sel:[0,0] op_sel_hi:[1,0]
    v_pk_mul_f32 v[78:79], v[78:79], v[14:15] op_sel:[0,0] op_sel_hi:[1,0]
    s_bitcmp1_b32 s43, s42
    s_cbranch_scc1 L2_oa127
L2_ob127:
    buffer_load_dwordx4 v[112:115], v3, s[16:19], s40 offen offset:1024 sc1
    v_and_b32 v46, 0x80000000, v33
    v_lshrrev_b32 v47, 14, v31
    v_bitop3_b32 v47, v47, v5, v46 bitop3:0xea
    ds_read_b64 v[102:103], v47
    v_and_b32 v99, 0x40000000, v33
    v_lshrrev_b32 v47, 14, v30
    v_bitop3_b32 v47, v47, v5, v99 bitop3:0xea
    ds_read_b64 v[100:101], v47
    s_waitcnt lgkmcnt(2)
    v_cmp_ne_u64 s[50:51], v[72:73], v[68:69]
    v_cmpx_ne_u64 s[54:55], v[74:75], v[70:71]
    s_and_b64 s[82:83], s[54:55], s[80:81]
    s_cbranch_scc1 L2_c128
L2_d128:
    v_mov_b64 v[84:85], v[70:71]
    v_mov_b32 v7, v93
    v_mov_b64 v[86:87], v[74:75]
    s_or_b64 s[80:81], s[80:81], s[54:55]
    s_mov_b64 exec, s[50:51]
    s_and_b64 s[82:83], s[50:51], s[80:81]
    s_cbranch_scc1 L2_c129
L2_d129:
    v_mov_b64 v[84:85], v[68:69]
    v_mov_b32 v7, v92
    v_mov_b64 v[86:87], v[72:73]
    s_mov_b64 exec, -1
    s_or_b64 s[80:81], s[80:81], s[50:51]
    s_and_b64 exec, s[84:85], s[80:81]
    v_mfma_f32_4x4x4_16b_bf16 v[76:79], v[12:13], v[84:85], 0
    v_mov_b32 v94, v7
    s_andn2_b64 s[80:81], s[80:81], s[84:85]
    v_mfma_f32_4x4x4_16b_bf16 v[76:79], v[10:11], v[86:87], v[76:79]
    s_mov_b64 exec, -1
    ds_read_b64 v[70:71], v95 offset:65408
    ds_read_b64 v[68:69], v94 offset:65408
    v_bitop3_b32 v92, v30, v5, v99 bitop3:0xea
    v_bitop3_b32 v93, v31, v5, v46 bitop3:0xea
    v_perm_b32 v15, v31, v32, s47
    v_bitop3_b32 v46, v31, 0.5, -0.5 bitop3:0xa8
    v_perm_b32 v14, v30, v32, s46
    v_bitop3_b32 v47, v30, 0.5, -0.5 bitop3:0xa8
    v_bitop3_b32 v15, v6, v15, v46 bitop3:0xca
    v_bitop3_b32 v14, v6, v14, v47 bitop3:0xca
    s_waitcnt lgkmcnt(1)
    v_mfma_f32_4x4x4_16b_bf16 v[80:83], v[10:11], v[70:71], v[80:83]
    s_waitcnt lgkmcnt(0)
    v_mfma_f32_4x4x4_16b_bf16 v[76:79], v[10:11], v[68:69], v[76:79]
    s_nop 2
    v_cvt_pk_bf16_f32 v80, v80, v81
    v_cvt_pk_bf16_f32 v81, v82, v83
    ds_wrxchg_rtn_b64 v[74:75], v95, v[80:81] offset:65408
    v_cvt_pk_bf16_f32 v76, v76, v77
    v_cvt_pk_bf16_f32 v77, v78, v79
    ds_wrxchg_rtn_b64 v[72:73], v94, v[76:77] offset:65408
    v_and_b32 v88, 0x0fffffff, v42
    buffer_load_dwordx2 v[28:29], v88, s[8:11], 0 offen
    buffer_load_dwordx3 v[30:32], v88, s[8:11], 0 offen offset:8
    s_setprio 0
    v_mfma_f32_4x4x4_16b_bf16 v[80:83], v[8:9], v[102:103], 0
    v_mfma_f32_4x4x4_16b_bf16 v[76:79], v[8:9], v[100:101], 0
    v_cmp_lt_u32 s[48:49], v5, v93
    s_nop 2
    v_pk_mul_f32 v[80:81], v[80:81], v[14:15] op_sel:[0,1] op_sel_hi:[1,1]
    v_pk_mul_f32 v[82:83], v[82:83], v[14:15] op_sel:[0,1] op_sel_hi:[1,1]
    v_pk_mul_f32 v[76:77], v[76:77], v[14:15] op_sel:[0,0] op_sel_hi:[1,0]
    v_pk_mul_f32 v[78:79], v[78:79], v[14:15] op_sel:[0,0] op_sel_hi:[1,0]
    s_add_u32 s40, s40, 0xfff24000
    s_waitcnt vmcnt(8)
    v_and_b32 v46, 0x80000000, v39
    v_lshrrev_b32 v47, 14, v37
    v_bitop3_b32 v47, v47, v5, v46 bitop3:0xea
    ds_read_b64 v[102:103], v47
    v_and_b32 v99, 0x40000000, v39
    v_lshrrev_b32 v47, 14, v36
    v_bitop3_b32 v47, v47, v5, v99 bitop3:0xea
    ds_read_b64 v[100:101], v47
    v_and_b32 v46, 0x20000000, v39
    v_lshrrev_b32 v47, 14, v35
    v_bitop3_b32 v47, v47, v5, v46 bitop3:0xea
    ds_read_b64 v[106:107], v47
    v_and_b32 v99, 0x10000000, v39
    v_lshrrev_b32 v47, 14, v34
    v_bitop3_b32 v47, v47, v5, v99 bitop3:0xea
    ds_read_b64 v[104:105], v47
    s_waitcnt lgkmcnt(4)
    v_cmp_ne_u64 s[50:51], v[72:73], v[68:69]
    v_cmpx_ne_u64 s[54:55], v[74:75], v[70:71]
    s_and_b64 s[82:83], s[54:55], s[80:81]
    s_cbranch_scc1 L2_c130
L2_d130:
    v_mov_b64 v[84:85], v[70:71]
    v_mov_b32 v7, v95
    v_mov_b64 v[86:87], v[74:75]
    s_or_b64 s[80:81], s[80:81], s[54:55]
    s_mov_b64 exec, s[50:51]
    s_and_b64 s[82:83], s[50:51], s[80:81]
    s_cbranch_scc1 L2_c131
L2_d131:
    v_mov_b64 v[84:85], v[68:69]
    v_mov_b32 v7, v94
    v_mov_b64 v[86:87], v[72:73]
    s_mov_b64 exec, -1
    s_or_b64 s[80:81], s[80:81], s[50:51]
    s_and_b64 exec, s[48:49], s[80:81]
    v_mfma_f32_4x4x4_16b_bf16 v[80:83], v[12:13], v[84:85], 0
    v_mov_b32 v93, v7
    s_andn2_b64 s[80:81], s[80:81], s[48:49]
    v_mfma_f32_4x4x4_16b_bf16 v[80:83], v[10:11], v[86:87], v[80:83]
    s_mov_b64 exec, -1
    ds_read_b64 v[70:71], v93 offset:65408
    ds_read_b64 v[68:69], v92 offset:65408
    v_bitop3_b32 v94, v34, v5, v99 bitop3:0xea
    v_bitop3_b32 v95, v35, v5, v46 bitop3:0xea
    v_perm_b32 v15, v35, v38, s45
    v_bitop3_b32 v46, v35, 0.5, -0.5 bitop3:0xa8
    v_perm_b32 v14, v34, v38, s44
    v_bitop3_b32 v47, v34, 0.5, -0.5 bitop3:0xa8
    v_bitop3_b32 v15, v6, v15, v46 bitop3:0xca
    v_bitop3_b32 v14, v6, v14, v47 bitop3:0xca
    s_waitcnt lgkmcnt(1)
    v_mfma_f32_4x4x4_16b_bf16 v[80:83], v[10:11], v[70:71], v[80:83]
    s_waitcnt lgkmcnt(0)
    v_mfma_f32_4x4x4_16b_bf16 v[76:79], v[10:11], v[68:69], v[76:79]
    s_nop 2
    v_cvt_pk_bf16_f32 v80, v80, v81
    v_cvt_pk_bf16_f32 v81, v82, v83
    ds_wrxchg_rtn_b64 v[74:75], v93, v[80:81] offset:65408
    v_cvt_pk_bf16_f32 v76, v76, v77
    v_cvt_pk_bf16_f32 v77, v78, v79
    ds_wrxchg_rtn_b64 v[72:73], v92, v[76:77] offset:65408
    s_barrier
    s_setprio 3
    s_mov_b32 m0, s100
    s_nop 0
    ds_write_addtid_b32 v124 offset:34816
    ds_write_addtid_b32 v125 offset:35072
    ds_write_addtid_b32 v126 offset:35328
    ds_write_addtid_b32 v127 offset:35584
    ds_write_addtid_b32 v116 offset:32768
    ds_write_addtid_b32 v117 offset:33024
    ds_write_addtid_b32 v118 offset:33280
    ds_write_addtid_b32 v119 offset:33536
    ds_write_addtid_b32 v120 offset:33792
    ds_write_addtid_b32 v121 offset:34048
    ds_write_addtid_b32 v122 offset:34304
    ds_write_addtid_b32 v123 offset:34560
    v_mfma_f32_4x4x4_16b_bf16 v[80:83], v[8:9], v[106:107], 0
    v_mfma_f32_4x4x4_16b_bf16 v[76:79], v[8:9], v[104:105], 0
    s_nop 3
    v_pk_mul_f32 v[80:81], v[80:81], v[14:15] op_sel:[0,1] op_sel_hi:[1,1]
    v_pk_mul_f32 v[82:83], v[82:83], v[14:15] op_sel:[0,1] op_sel_hi:[1,1]
    v_pk_mul_f32 v[76:77], v[76:77], v[14:15] op_sel:[0,0] op_sel_hi:[1,0]
    v_pk_mul_f32 v[78:79], v[78:79], v[14:15] op_sel:[0,0] op_sel_hi:[1,0]
    s_setprio 2
    s_waitcnt lgkmcnt(12)
    v_cmp_ne_u64 s[50:51], v[72:73], v[68:69]
    v_cmpx_ne_u64 s[54:55], v[74:75], v[70:71]
    s_and_b64 s[82:83], s[54:55], s[80:81]
    s_cbranch_scc1 L2_c132
L2_d132:
    v_mov_b64 v[84:85], v[70:71]
    v_mov_b32 v7, v93
    v_mov_b64 v[86:87], v[74:75]
    s_or_b64 s[80:81], s[80:81], s[54:55]
    s_mov_b64 exec, s[50:51]
    s_and_b64 s[82:83], s[50:51], s[80:81]
    s_cbranch_scc1 L2_c133
L2_d133:
    v_mov_b64 v[84:85], v[68:69]
    v_mov_b32 v7, v92
    v_mov_b64 v[86:87], v[72:73]
    s_mov_b64 exec, -1
    s_or_b64 s[80:81], s[80:81], s[50:51]
    ds_read_b64 v[70:71], v95 offset:65408
    ds_read_b64 v[68:69], v94 offset:65408
    v_and_b32 v46, 0x40000000, v39
    v_bitop3_b32 v92, v36, v5, v46 bitop3:0xea
    v_and_b32 v46, 0x80000000, v39
    v_bitop3_b32 v93, v37, v5, v46 bitop3:0xea
    v_perm_b32 v15, v37, v38, s47
    v_bitop3_b32 v46, v37, 0.5, -0.5 bitop3:0xa8
    v_perm_b32 v14, v36, v38, s46
    v_bitop3_b32 v47, v36, 0.5, -0.5 bitop3:0xa8
    v_bitop3_b32 v15, v6, v15, v46 bitop3:0xca
    v_bitop3_b32 v14, v6, v14, v47 bitop3:0xca
    s_setprio 1
    s_waitcnt lgkmcnt(1)
    v_mfma_f32_4x4x4_16b_bf16 v[80:83], v[10:11], v[70:71], v[80:83]
    s_waitcnt lgkmcnt(0)
    v_mfma_f32_4x4x4_16b_bf16 v[76:79], v[10:11], v[68:69], v[76:79]
    s_nop 2
    v_cvt_pk_bf16_f32 v80, v80, v81
    v_cvt_pk_bf16_f32 v81, v82, v83
    ds_wrxchg_rtn_b64 v[74:75], v95, v[80:81] offset:65408
    v_cvt_pk_bf16_f32 v76, v76, v77
    v_cvt_pk_bf16_f32 v77, v78, v79
    ds_wrxchg_rtn_b64 v[72:73], v94, v[76:77] offset:65408
    v_and_b32 v88, 0x0fffffff, v43
    buffer_load_dwordx2 v[34:35], v88, s[8:11], 0 offen
    buffer_load_dwordx3 v[36:38], v88, s[8:11], 0 offen offset:8
    s_setprio 0
    s_waitcnt vmcnt(7)
    s_mov_b32 m0, s38
    s_nop 0
    ds_write_addtid_b32 v108 offset:0
    ds_write_addtid_b32 v109 offset:256
    ds_write_addtid_b32 v110 offset:512
    ds_write_addtid_b32 v111 offset:768
    s_waitcnt vmcnt(4)
    ds_write_addtid_b32 v112 offset:1024
    ds_write_addtid_b32 v113 offset:1280
    ds_write_addtid_b32 v114 offset:1536
    ds_write_addtid_b32 v115 offset:1792
    v_mfma_f32_4x4x4_16b_bf16 v[80:83], v[8:9], v[102:103], 0
    v_mfma_f32_4x4x4_16b_bf16 v[76:79], v[8:9], v[100:101], 0
    v_cmp_lt_u32 s[84:85], v5, v92
    s_nop 2
    v_pk_mul_f32 v[80:81], v[80:81], v[14:15] op_sel:[0,1] op_sel_hi:[1,1]
    v_pk_mul_f32 v[82:83], v[82:83], v[14:15] op_sel:[0,1] op_sel_hi:[1,1]
    v_pk_mul_f32 v[76:77], v[76:77], v[14:15] op_sel:[0,0] op_sel_hi:[1,0]
    v_pk_mul_f32 v[78:79], v[78:79], v[14:15] op_sel:[0,0] op_sel_hi:[1,0]
    s_add_u32 s42, s42, 1
    s_waitcnt lgkmcnt(0)
    s_barrier
    s_bitcmp1_b32 s36, s42
    s_cbranch_scc1 L2_slow
L2_ret7:
    s_setprio 3
    s_bitcmp1_b32 s43, s42
    s_cbranch_scc1 L2_oa134
L2_ob134:
    s_mov_b64 exec, s[6:7]
    v_lshrrev_b32 v18, 16, v18
    s_mov_b64 exec, -1
    v_and_b32 v46, 0x20000000, v40
    v_lshrrev_b32 v47, 14, v17
    v_bitop3_b32 v47, v47, v5, v46 bitop3:0xea
    ds_read_b64 v[106:107], v47
    v_and_b32 v99, 0x10000000, v40
    v_lshrrev_b32 v47, 14, v16
    v_bitop3_b32 v47, v47, v5, v99 bitop3:0xea
    ds_read_b64 v[104:105], v47
    v_cmp_ne_u64 s[50:51], v[72:73], v[68:69]
    v_cmpx_ne_u64 s[54:55], v[74:75], v[70:71]
    s_and_b64 s[82:83], s[54:55], s[80:81]
    s_cbranch_scc1 L2_c135
L2_d135:
    v_mov_b64 v[84:85], v[70:71]
    v_mov_b32 v7, v95
    v_mov_b64 v[86:87], v[74:75]
    s_or_b64 s[80:81], s[80:81], s[54:55]
    s_mov_b64 exec, s[50:51]
    s_and_b64 s[82:83], s[50:51], s[80:81]
    s_cbranch_scc1 L2_c136
L2_d136:
    v_mov_b64 v[84:85], v[68:69]
    v_mov_b32 v7, v94
    v_mov_b64 v[86:87], v[72:73]
    s_mov_b64 exec, -1
    s_or_b64 s[80:81], s[80:81], s[50:51]
    s_and_b64 exec, s[84:85], s[80:81]
    v_mfma_f32_4x4x4_16b_bf16 v[76:79], v[12:13], v[84:85], 0
    v_mov_b32 v92, v7
    s_andn2_b64 s[80:81], s[80:81], s[84:85]
    v_mfma_f32_4x4x4_16b_bf16 v[76:79], v[10:11], v[86:87], v[76:79]
    s_mov_b64 exec, -1
    ds_read_b64 v[70:71], v93 offset:65408
    ds_read_b64 v[68:69], v92 offset:65408
    v_bitop3_b32 v94, v16, v5, v99 bitop3:0xea
    v_bitop3_b32 v95, v17, v5, v46 bitop3:0xea
    v_perm_b32 v15, v17, v18, s45
    v_bitop3_b32 v46, v17, 0.5, -0.5 bitop3:0xa8
    v_perm_b32 v14, v16, v18, s44
    v_bitop3_b32 v47, v16, 0.5, -0.5 bitop3:0xa8
    v_bitop3_b32 v15, v6, v15, v46 bitop3:0xca
    v_bitop3_b32 v14, v6, v14, v47 bitop3:0xca
    s_waitcnt lgkmcnt(1)
    v_mfma_f32_4x4x4_16b_bf16 v[80:83], v[10:11], v[70:71], v[80:83]
    s_waitcnt lgkmcnt(0)
    v_mfma_f32_4x4x4_16b_bf16 v[76:79], v[10:11], v[68:69], v[76:79]
    s_nop 2
    v_cvt_pk_bf16_f32 v80, v80, v81
    v_cvt_pk_bf16_f32 v81, v82, v83
    ds_wrxchg_rtn_b64 v[74:75], v93, v[80:81] offset:65408
    v_cvt_pk_bf16_f32 v76, v76, v77
    v_cvt_pk_bf16_f32 v77, v78, v79
    ds_wrxchg_rtn_b64 v[72:73], v92, v[76:77] offset:65408
    v_mfma_f32_4x4x4_16b_bf16 v[80:83], v[8:9], v[106:107], 0
    v_mfma_f32_4x4x4_16b_bf16 v[76:79], v[8:9], v[104:105], 0
    v_cmp_lt_u32 s[84:85], v5, v94
    s_nop 2
    v_pk_mul_f32 v[80:81], v[80:81], v[14:15] op_sel:[0,1] op_sel_hi:[1,1]
    v_pk_mul_f32 v[82:83], v[82:83], v[14:15] op_sel:[0,1] op_sel_hi:[1,1]
    v_pk_mul_f32 v[76:77], v[76:77], v[14:15] op_sel:[0,0] op_sel_hi:[1,0]
    v_pk_mul_f32 v[78:79], v[78:79], v[14:15] op_sel:[0,0] op_sel_hi:[1,0]
    v_and_b32 v46, 0x20000000, v41
    v_lshrrev_b32 v47, 14, v23
    v_bitop3_b32 v47, v47, v5, v46 bitop3:0xea
    ds_read_b64 v[102:103], v47
    v_and_b32 v99, 0x10000000, v41
    v_lshrrev_b32 v47, 14, v22
    v_bitop3_b32 v47, v47, v5, v99 bitop3:0xea
    ds_read_b64 v[100:101], v47
    s_waitcnt lgkmcnt(2)
    v_cmp_ne_u64 s[50:51], v[72:73], v[68:69]
    v_cmpx_ne_u64 s[54:55], v[74:75], v[70:71]
    s_and_b64 s[82:83], s[54:55], s[80:81]
    s_cbranch_scc1 L2_c137
L2_d137:
    v_mov_b64 v[84:85], v[70:71]
    v_mov_b32 v7, v93
    v_mov_b64 v[86:87], v[74:75]
    s_or_b64 s[80:81], s[80:81], s[54:55]
    s_mov_b64 exec, s[50:51]
    s_and_b64 s[82:83], s[50:51], s[80:81]
    s_cbranch_scc1 L2_c138
L2_d138:
    v_mov_b64 v[84:85], v[68:69]
    v_mov_b32 v7, v92
    v_mov_b64 v[86:87], v[72:73]
    s_mov_b64 exec, -1
    s_or_b64 s[80:81], s[80:81], s[50:51]
    s_and_b64 exec, s[84:85], s[80:81]
    v_mfma_f32_4x4x4_16b_bf16 v[76:79], v[12:13], v[84:85], 0
    v_mov_b32 v94, v7
    s_andn2_b64 s[80:81], s[80:81], s[84:85]
    v_mfma_f32_4x4x4_16b_bf16 v[76:79], v[10:11], v[86:87], v[76:79]
    s_mov_b64 exec, -1
    ds_read_b64 v[70:71], v95 offset:65408
    ds_read_b64 v[68:69], v94 offset:65408
    v_bitop3_b32 v92, v22, v5, v99 bitop3:0xea
    v_bitop3_b32 v93, v23, v5, v46 bitop3:0xea
    v_perm_b32 v15, v23, v26, s45
    v_bitop3_b32 v46, v23, 0.5, -0.5 bitop3:0xa8
    v_perm_b32 v14, v22, v26, s44
    v_bitop3_b32 v47, v22, 0.5, -0.5 bitop3:0xa8
    v_bitop3_b32 v15, v6, v15, v46 bitop3:0xca
    v_bitop3_b32 v14, v6, v14, v47 bitop3:0xca
    s_waitcnt lgkmcnt(1)
    v_mfma_f32_4x4x4_16b_bf16 v[80:83], v[10:11], v[70:71], v[80:83]
    s_waitcnt lgkmcnt(0)
    v_mfma_f32_4x4x4_16b_bf16 v[76:79], v[10:11], v[68:69], v[76:79]
    s_nop 2
    v_cvt_pk_bf16_f32 v80, v80, v81
    v_cvt_pk_bf16_f32 v81, v82, v83
    ds_wrxchg_rtn_b64 v[74:75], v95, v[80:81] offset:65408
    v_cvt_pk_bf16_f32 v76, v76, v77
    v_cvt_pk_bf16_f32 v77, v78, v79
    ds_wrxchg_rtn_b64 v[72:73], v94, v[76:77] offset:65408
    v_mfma_f32_4x4x4_16b_bf16 v[80:83], v[8:9], v[102:103], 0
    v_mfma_f32_4x4x4_16b_bf16 v[76:79], v[8:9], v[100:101], 0
    v_cmp_lt_u32 s[48:49], v5, v93
    s_nop 2
    v_pk_mul_f32 v[80:81], v[80:81], v[14:15] op_sel:[0,1] op_sel_hi:[1,1]
    v_pk_mul_f32 v[82:83], v[82:83], v[14:15] op_sel:[0,1] op_sel_hi:[1,1]
    v_pk_mul_f32 v[76:77], v[76:77], v[14:15] op_sel:[0,0] op_sel_hi:[1,0]
    v_pk_mul_f32 v[78:79], v[78:79], v[14:15] op_sel:[0,0] op_sel_hi:[1,0]
    s_lshl_b32 s3, s32, 12
    v_subrev_u32 v122, s3, v3
    s_mul_i32 s3, s33, 20000
    v_add_u32 v118, s3, v122
    v_add_u32 v119, 0x4000, v118
    s_lshl_b32 s3, s34, 7
    v_lshrrev_b32 v123, 7, v118
    v_and_b32 v120, 0x70, v118
    v_lshl_add_u32 v120, v123, 13, v120
    v_add_u32 v120, s3, v120
    v_lshrrev_b32 v123, 7, v119
    v_and_b32 v121, 0x70, v119
    v_lshl_add_u32 v121, v123, 13, v121
    v_add_u32 v121, s3, v121
    v_cmp_le_u32 vcc, 3616, v122
    s_mov_b64 exec, vcc
    v_mov_b32 v119, 2.0
    v_mov_b32 v121, 2.0
    s_mov_b64 exec, -1
    v_and_b32 v123, 0x30, v122
    v_lshlrev_b32 v123, 2, v123
    buffer_load_dwordx4 v[48:51], v123, s[24:27], 0 offen
    buffer_load_dwordx4 v[52:55], v123, s[24:27], 0 offen offset:16
    buffer_load_dwordx2 v[56:57], v123, s[24:27], 0 offen offset:32
    s_mov_b32 s12, s4
    s_mov_b32 s13, s5
    s_mov_b32 s14, 0x138800
    s_mov_b32 s15, 0x20000
    s_mov_b32 s16, s28
    s_mov_b32 s17, s29
    s_mov_b32 s18, 0x4e2000
    s_mov_b32 s19, 0x20000
    v_lshrrev_b32 v123, 2, v120
    buffer_load_dword v116, v123, s[12:15], 0 offen
    buffer_load_dwordx4 v[108:111], v120, s[16:19], 0 offen
    v_lshrrev_b32 v123, 2, v121
    buffer_load_dword v117, v123, s[12:15], 0 offen
    buffer_load_dwordx4 v[124:127], v121, s[16:19], 0 offen
    v_and_b32 v46, 0x80000000, v41
    v_lshrrev_b32 v47, 14, v25
    v_bitop3_b32 v47, v47, v5, v46 bitop3:0xea
    ds_read_b64 v[106:107], v47
    v_and_b32 v99, 0x40000000, v41
    v_lshrrev_b32 v47, 14, v24
    v_bitop3_b32 v47, v47, v5, v99 bitop3:0xea
    ds_read_b64 v[104:105], v47
    s_waitcnt lgkmcnt(2)
    v_cmp_ne_u64 s[50:51], v[72:73], v[68:69]
    v_cmpx_ne_u64 s[54:55], v[74:75], v[70:71]
    s_and_b64 s[82:83], s[54:55], s[80:81]
    s_cbranch_scc1 L2_c139
L2_d139:
    v_mov_b64 v[84:85], v[70:71]
    v_mov_b32 v7, v95
    v_mov_b64 v[86:87], v[74:75]
    s_or_b64 s[80:81], s[80:81], s[54:55]
    s_mov_b64 exec, s[50:51]
    s_and_b64 s[82:83], s[50:51], s[80:81]
    s_cbranch_scc1 L2_c140
L2_d140:
    v_mov_b64 v[84:85], v[68:69]
    v_mov_b32 v7, v94
    v_mov_b64 v[86:87], v[72:73]
    s_mov_b64 exec, -1
    s_or_b64 s[80:81], s[80:81], s[50:51]
    s_and_b64 exec, s[48:49], s[80:81]
    v_mfma_f32_4x4x4_16b_bf16 v[80:83], v[12:13], v[84:85], 0
    v_mov_b32 v93, v7
    s_andn2_b64 s[80:81], s[80:81], s[48:49]
    v_mfma_f32_4x4x4_16b_bf16 v[80:83], v[10:11], v[86:87], v[80:83]
    s_mov_b64 exec, -1
    ds_read_b64 v[70:71], v93 offset:65408
    ds_read_b64 v[68:69], v92 offset:65408
    v_bitop3_b32 v94, v24, v5, v99 bitop3:0xea
    v_bitop3_b32 v95, v25, v5, v46 bitop3:0xea
    v_perm_b32 v15, v25, v26, s47
    v_bitop3_b32 v46, v25, 0.5, -0.5 bitop3:0xa8
    v_perm_b32 v14, v24, v26, s46
    v_bitop3_b32 v47, v24, 0.5, -0.5 bitop3:0xa8
    v_bitop3_b32 v15, v6, v15, v46 bitop3:0xca
    v_bitop3_b32 v14, v6, v14, v47 bitop3:0xca
    s_waitcnt lgkmcnt(1)
    v_mfma_f32_4x4x4_16b_bf16 v[80:83], v[10:11], v[70:71], v[80:83]
    s_waitcnt lgkmcnt(0)
    v_mfma_f32_4x4x4_16b_bf16 v[76:79], v[10:11], v[68:69], v[76:79]
    s_nop 2
    v_cvt_pk_bf16_f32 v80, v80, v81
    v_cvt_pk_bf16_f32 v81, v82, v83
    ds_wrxchg_rtn_b64 v[74:75], v93, v[80:81] offset:65408
    v_cvt_pk_bf16_f32 v76, v76, v77
    v_cvt_pk_bf16_f32 v77, v78, v79
    ds_wrxchg_rtn_b64 v[72:73], v92, v[76:77] offset:65408
    s_setprio 2
    v_mfma_f32_4x4x4_16b_bf16 v[80:83], v[8:9], v[106:107], 0
    v_mfma_f32_4x4x4_16b_bf16 v[76:79], v[8:9], v[104:105], 0
    s_nop 3
    v_pk_mul_f32 v[80:81], v[80:81], v[14:15] op_sel:[0,1] op_sel_hi:[1,1]
    v_pk_mul_f32 v[82:83], v[82:83], v[14:15] op_sel:[0,1] op_sel_hi:[1,1]
    v_pk_mul_f32 v[76:77], v[76:77], v[14:15] op_sel:[0,0] op_sel_hi:[1,0]
    v_pk_mul_f32 v[78:79], v[78:79], v[14:15] op_sel:[0,0] op_sel_hi:[1,0]
    s_waitcnt vmcnt(9)
    v_and_b32 v46, 0x20000000, v42
    v_lshrrev_b32 v47, 14, v29
    v_bitop3_b32 v47, v47, v5, v46 bitop3:0xea
    ds_read_b64 v[102:103], v47
    v_and_b32 v99, 0x10000000, v42
    v_lshrrev_b32 v47, 14, v28
    v_bitop3_b32 v47, v47, v5, v99 bitop3:0xea
    ds_read_b64 v[100:101], v47
    s_waitcnt lgkmcnt(2)
    v_cmp_ne_u64 s[50:51], v[72:73], v[68:69]
    v_cmpx_ne_u64 s[54:55], v[74:75], v[70:71]
    s_and_b64 s[82:83], s[54:55], s[80:81]
    s_cbranch_scc1 L2_c141
L2_d141:
    v_mov_b64 v[84:85], v[70:71]
    v_mov_b32 v7, v93
    v_mov_b64 v[86:87], v[74:75]
    s_or_b64 s[80:81], s[80:81], s[54:55]
    s_mov_b64 exec, s[50:51]
    s_and_b64 s[82:83], s[50:51], s[80:81]
    s_cbranch_scc1 L2_c142
L2_d142:
    v_mov_b64 v[84:85], v[68:69]
    v_mov_b32 v7, v92
    v_mov_b64 v[86:87], v[72:73]
    s_mov_b64 exec, -1
    s_or_b64 s[80:81], s[80:81], s[50:51]
    ds_read_b64 v[70:71], v95 offset:65408
    ds_read_b64 v[68:69], v94 offset:65408
    v_bitop3_b32 v92, v28, v5, v99 bitop3:0xea
    v_bitop3_b32 v93, v29, v5, v46 bitop3:0xea
    v_perm_b32 v15, v29, v32, s45
    v_bitop3_b32 v46, v29, 0.5, -0.5 bitop3:0xa8
    v_perm_b32 v14, v28, v32, s44
    v_bitop3_b32 v47, v28, 0.5, -0.5 bitop3:0xa8
    v_bitop3_b32 v15, v6, v15, v46 bitop3:0xca
    v_bitop3_b32 v14, v6, v14, v47 bitop3:0xca
    s_waitcnt lgkmcnt(1)
    v_mfma_f32_4x4x4_16b_bf16 v[80:83], v[10:11], v[70:71], v[80:83]
    s_waitcnt lgkmcnt(0)
    v_mfma_f32_4x4x4_16b_bf16 v[76:79], v[10:11], v[68:69], v[76:79]
    s_nop 2
    v_cvt_pk_bf16_f32 v80, v80, v81
    v_cvt_pk_bf16_f32 v81, v82, v83
    ds_wrxchg_rtn_b64 v[74:75], v95, v[80:81] offset:65408
    v_cvt_pk_bf16_f32 v76, v76, v77
    v_cvt_pk_bf16_f32 v77, v78, v79
    ds_wrxchg_rtn_b64 v[72:73], v94, v[76:77] offset:65408
    s_setprio 1
    v_mfma_f32_4x4x4_16b_bf16 v[80:83], v[8:9], v[102:103], 0
    v_mfma_f32_4x4x4_16b_bf16 v[76:79], v[8:9], v[100:101], 0
    v_cmp_lt_u32 s[84:85], v5, v92
    s_nop 2
    v_pk_mul_f32 v[80:81], v[80:81], v[14:15] op_sel:[0,1] op_sel_hi:[1,1]
    v_pk_mul_f32 v[82:83], v[82:83], v[14:15] op_sel:[0,1] op_sel_hi:[1,1]
    v_pk_mul_f32 v[76:77], v[76:77], v[14:15] op_sel:[0,0] op_sel_hi:[1,0]
    v_pk_mul_f32 v[78:79], v[78:79], v[14:15] op_sel:[0,0] op_sel_hi:[1,0]
    s_bitcmp1_b32 s43, s42
    s_cbranch_scc1 L2_oa143
L2_ob143:
    v_and_b32 v46, 0x80000000, v42
    v_lshrrev_b32 v47, 14, v31
    v_bitop3_b32 v47, v47, v5, v46 bitop3:0xea
    ds_read_b64 v[106:107], v47
    v_and_b32 v99, 0x40000000, v42
    v_lshrrev_b32 v47, 14, v30
    v_bitop3_b32 v47, v47, v5, v99 bitop3:0xea
    ds_read_b64 v[104:105], v47
    s_waitcnt lgkmcnt(2)
    v_cmp_ne_u64 s[50:51], v[72:73], v[68:69]
    v_cmpx_ne_u64 s[54:55], v[74:75], v[70:71]
    s_and_b64 s[82:83], s[54:55], s[80:81]
    s_cbranch_scc1 L2_c144
L2_d144:
    v_mov_b64 v[84:85], v[70:71]
    v_mov_b32 v7, v95
    v_mov_b64 v[86:87], v[74:75]
    s_or_b64 s[80:81], s[80:81], s[54:55]
    s_mov_b64 exec, s[50:51]
    s_and_b64 s[82:83], s[50:51], s[80:81]
    s_cbranch_scc1 L2_c145
L2_d145:
    v_mov_b64 v[84:85], v[68:69]
    v_mov_b32 v7, v94
    v_mov_b64 v[86:87], v[72:73]
    s_mov_b64 exec, -1
    s_or_b64 s[80:81], s[80:81], s[50:51]
    s_and_b64 exec, s[84:85], s[80:81]
    v_mfma_f32_4x4x4_16b_bf16 v[76:79], v[12:13], v[84:85], 0
    v_mov_b32 v92, v7
    s_andn2_b64 s[80:81], s[80:81], s[84:85]
    v_mfma_f32_4x4x4_16b_bf16 v[76:79], v[10:11], v[86:87], v[76:79]
    s_mov_b64 exec, -1
    ds_read_b64 v[70:71], v93 offset:65408
    ds_read_b64 v[68:69], v92 offset:65408
    v_bitop3_b32 v94, v30, v5, v99 bitop3:0xea
    v_bitop3_b32 v95, v31, v5, v46 bitop3:0xea
    v_perm_b32 v15, v31, v32, s47
    v_bitop3_b32 v46, v31, 0.5, -0.5 bitop3:0xa8
    v_perm_b32 v14, v30, v32, s46
    v_bitop3_b32 v47, v30, 0.5, -0.5 bitop3:0xa8
    v_bitop3_b32 v15, v6, v15, v46 bitop3:0xca
    v_bitop3_b32 v14, v6, v14, v47 bitop3:0xca
    s_waitcnt lgkmcnt(1)
    v_mfma_f32_4x4x4_16b_bf16 v[80:83], v[10:11], v[70:71], v[80:83]
    s_waitcnt lgkmcnt(0)
    v_mfma_f32_4x4x4_16b_bf16 v[76:79], v[10:11], v[68:69], v[76:79]
    s_nop 2
    v_cvt_pk_bf16_f32 v80, v80, v81
    v_cvt_pk_bf16_f32 v81, v82, v83
    ds_wrxchg_rtn_b64 v[74:75], v93, v[80:81] offset:65408
    v_cvt_pk_bf16_f32 v76, v76, v77
    v_cvt_pk_bf16_f32 v77, v78, v79
    ds_wrxchg_rtn_b64 v[72:73], v92, v[76:77] offset:65408
    s_setprio 0
    v_mfma_f32_4x4x4_16b_bf16 v[80:83], v[8:9], v[106:107], 0
    v_mfma_f32_4x4x4_16b_bf16 v[76:79], v[8:9], v[104:105], 0
    v_cmp_lt_u32 s[48:49], v5, v95
    s_nop 2
    v_pk_mul_f32 v[80:81], v[80:81], v[14:15] op_sel:[0,1] op_sel_hi:[1,1]
    v_pk_mul_f32 v[82:83], v[82:83], v[14:15] op_sel:[0,1] op_sel_hi:[1,1]
    v_pk_mul_f32 v[76:77], v[76:77], v[14:15] op_sel:[0,0] op_sel_hi:[1,0]
    v_pk_mul_f32 v[78:79], v[78:79], v[14:15] op_sel:[0,0] op_sel_hi:[1,0]
    s_waitcnt vmcnt(7)
    v_and_b32 v46, 0x80000000, v43
    v_lshrrev_b32 v47, 14, v37
    v_bitop3_b32 v47, v47, v5, v46 bitop3:0xea
    ds_read_b64 v[106:107], v47
    v_and_b32 v99, 0x40000000, v43
    v_lshrrev_b32 v47, 14, v36
    v_bitop3_b32 v47, v47, v5, v99 bitop3:0xea
    ds_read_b64 v[104:105], v47
    v_and_b32 v46, 0x20000000, v43
    v_lshrrev_b32 v47, 14, v35
    v_bitop3_b32 v47, v47, v5, v46 bitop3:0xea
    ds_read_b64 v[102:103], v47
    v_and_b32 v99, 0x10000000, v43
    v_lshrrev_b32 v47, 14, v34
    v_bitop3_b32 v47, v47, v5, v99 bitop3:0xea
    ds_read_b64 v[100:101], v47
    s_waitcnt lgkmcnt(4)
    v_cmp_ne_u64 s[50:51], v[72:73], v[68:69]
    v_cmpx_ne_u64 s[54:55], v[74:75], v[70:71]
    s_and_b64 s[82:83], s[54:55], s[80:81]
    s_cbranch_scc1 L2_c146
L2_d146:
    v_mov_b64 v[84:85], v[70:71]
    v_mov_b32 v7, v93
    v_mov_b64 v[86:87], v[74:75]
    s_or_b64 s[80:81], s[80:81], s[54:55]
    s_mov_b64 exec, s[50:51]
    s_and_b64 s[82:83], s[50:51], s[80:81]
    s_cbranch_scc1 L2_c147
L2_d147:
    v_mov_b64 v[84:85], v[68:69]
    v_mov_b32 v7, v92
    v_mov_b64 v[86:87], v[72:73]
    s_mov_b64 exec, -1
    s_or_b64 s[80:81], s[80:81], s[50:51]
    s_and_b64 exec, s[48:49], s[80:81]
    v_mfma_f32_4x4x4_16b_bf16 v[80:83], v[12:13], v[84:85], 0
    v_mov_b32 v95, v7
    s_andn2_b64 s[80:81], s[80:81], s[48:49]
    v_mfma_f32_4x4x4_16b_bf16 v[80:83], v[10:11], v[86:87], v[80:83]
    s_mov_b64 exec, -1
    ds_read_b64 v[70:71], v95 offset:65408
    ds_read_b64 v[68:69], v94 offset:65408
    v_bitop3_b32 v92, v34, v5, v99 bitop3:0xea
    v_bitop3_b32 v93, v35, v5, v46 bitop3:0xea
    v_perm_b32 v15, v35, v38, s45
    v_bitop3_b32 v46, v35, 0.5, -0.5 bitop3:0xa8
    v_perm_b32 v14, v34, v38, s44
    v_bitop3_b32 v47, v34, 0.5, -0.5 bitop3:0xa8
    v_bitop3_b32 v15, v6, v15, v46 bitop3:0xca
    v_bitop3_b32 v14, v6, v14, v47 bitop3:0xca
    s_waitcnt lgkmcnt(1)
    v_mfma_f32_4x4x4_16b_bf16 v[80:83], v[10:11], v[70:71], v[80:83]
    s_waitcnt lgkmcnt(0)
    v_mfma_f32_4x4x4_16b_bf16 v[76:79], v[10:11], v[68:69], v[76:79]
    s_nop 2
    v_cvt_pk_bf16_f32 v80, v80, v81
    v_cvt_pk_bf16_f32 v81, v82, v83
    ds_wrxchg_rtn_b64 v[74:75], v95, v[80:81] offset:65408
    v_cvt_pk_bf16_f32 v76, v76, v77
    v_cvt_pk_bf16_f32 v77, v78, v79
    ds_wrxchg_rtn_b64 v[72:73], v94, v[76:77] offset:65408
    v_mfma_f32_4x4x4_16b_bf16 v[80:83], v[8:9], v[102:103], 0
    v_mfma_f32_4x4x4_16b_bf16 v[76:79], v[8:9], v[100:101], 0
    s_nop 3
    v_pk_mul_f32 v[80:81], v[80:81], v[14:15] op_sel:[0,1] op_sel_hi:[1,1]
    v_pk_mul_f32 v[82:83], v[82:83], v[14:15] op_sel:[0,1] op_sel_hi:[1,1]
    v_pk_mul_f32 v[76:77], v[76:77], v[14:15] op_sel:[0,0] op_sel_hi:[1,0]
    v_pk_mul_f32 v[78:79], v[78:79], v[14:15] op_sel:[0,0] op_sel_hi:[1,0]
    s_waitcnt lgkmcnt(0)
    v_cmp_ne_u64 s[50:51], v[72:73], v[68:69]
    v_cmpx_ne_u64 s[54:55], v[74:75], v[70:71]
    s_and_b64 s[82:83], s[54:55], s[80:81]
    s_cbranch_scc1 L2_c148
L2_d148:
    v_mov_b64 v[84:85], v[70:71]
    v_mov_b32 v7, v95
    v_mov_b64 v[86:87], v[74:75]
    s_or_b64 s[80:81], s[80:81], s[54:55]
    s_mov_b64 exec, s[50:51]
    s_and_b64 s[82:83], s[50:51], s[80:81]
    s_cbranch_scc1 L2_c149
L2_d149:
    v_mov_b64 v[84:85], v[68:69]
    v_mov_b32 v7, v94
    v_mov_b64 v[86:87], v[72:73]
    s_mov_b64 exec, -1
    s_or_b64 s[80:81], s[80:81], s[50:51]
    ds_read_b64 v[70:71], v93 offset:65408
    ds_read_b64 v[68:69], v92 offset:65408
    v_and_b32 v46, 0x40000000, v43
    v_bitop3_b32 v94, v36, v5, v46 bitop3:0xea
    v_and_b32 v46, 0x80000000, v43
    v_bitop3_b32 v95, v37, v5, v46 bitop3:0xea
    v_perm_b32 v15, v37, v38, s47
    v_bitop3_b32 v46, v37, 0.5, -0.5 bitop3:0xa8
    v_perm_b32 v14, v36, v38, s46
    v_bitop3_b32 v47, v36, 0.5, -0.5 bitop3:0xa8
    v_bitop3_b32 v15, v6, v15, v46 bitop3:0xca
    v_bitop3_b32 v14, v6, v14, v47 bitop3:0xca
    s_waitcnt lgkmcnt(1)
    v_mfma_f32_4x4x4_16b_bf16 v[80:83], v[10:11], v[70:71], v[80:83]
    s_waitcnt lgkmcnt(0)
    v_mfma_f32_4x4x4_16b_bf16 v[76:79], v[10:11], v[68:69], v[76:79]
    s_nop 2
    v_cvt_pk_bf16_f32 v80, v80, v81
    v_cvt_pk_bf16_f32 v81, v82, v83
    ds_wrxchg_rtn_b64 v[74:75], v93, v[80:81] offset:65408
    v_cvt_pk_bf16_f32 v76, v76, v77
    v_cvt_pk_bf16_f32 v77, v78, v79
    ds_wrxchg_rtn_b64 v[72:73], v92, v[76:77] offset:65408
    v_mfma_f32_4x4x4_16b_bf16 v[80:83], v[8:9], v[106:107], 0
    v_mfma_f32_4x4x4_16b_bf16 v[76:79], v[8:9], v[104:105], 0
    v_cmp_lt_u32 s[84:85], v5, v94
    s_nop 2
    v_pk_mul_f32 v[80:81], v[80:81], v[14:15] op_sel:[0,1] op_sel_hi:[1,1]
    v_pk_mul_f32 v[82:83], v[82:83], v[14:15] op_sel:[0,1] op_sel_hi:[1,1]
    v_pk_mul_f32 v[76:77], v[76:77], v[14:15] op_sel:[0,0] op_sel_hi:[1,0]
    v_pk_mul_f32 v[78:79], v[78:79], v[14:15] op_sel:[0,0] op_sel_hi:[1,0]
    s_waitcnt lgkmcnt(0)
    v_cmp_ne_u64 s[50:51], v[72:73], v[68:69]
    v_cmpx_ne_u64 s[54:55], v[74:75], v[70:71]
    s_and_b64 s[82:83], s[54:55], s[80:81]
    s_cbranch_scc1 L2_c150
L2_d150:
    v_mov_b64 v[84:85], v[70:71]
    v_mov_b32 v7, v93
    v_mov_b64 v[86:87], v[74:75]
    s_or_b64 s[80:81], s[80:81], s[54:55]
    s_mov_b64 exec, s[50:51]
    s_and_b64 s[82:83], s[50:51], s[80:81]
    s_cbranch_scc1 L2_c151
L2_d151:
    v_mov_b64 v[84:85], v[68:69]
    v_mov_b32 v7, v92
    v_mov_b64 v[86:87], v[72:73]
    s_mov_b64 exec, -1
    s_or_b64 s[80:81], s[80:81], s[50:51]
    s_and_b64 exec, s[84:85], s[80:81]
    v_mfma_f32_4x4x4_16b_bf16 v[76:79], v[12:13], v[84:85], 0
    v_mov_b32 v94, v7
    s_andn2_b64 s[80:81], s[80:81], s[84:85]
    v_mfma_f32_4x4x4_16b_bf16 v[76:79], v[10:11], v[86:87], v[76:79]
    s_mov_b64 exec, -1
    ds_read_b64 v[70:71], v95 offset:65408
    ds_read_b64 v[68:69], v94 offset:65408
    s_waitcnt lgkmcnt(1)
    v_mfma_f32_4x4x4_16b_bf16 v[80:83], v[10:11], v[70:71], v[80:83]
    s_waitcnt lgkmcnt(0)
    v_mfma_f32_4x4x4_16b_bf16 v[76:79], v[10:11], v[68:69], v[76:79]
    s_nop 2
    v_cvt_pk_bf16_f32 v80, v80, v81
    v_cvt_pk_bf16_f32 v81, v82, v83
    ds_wrxchg_rtn_b64 v[74:75], v95, v[80:81] offset:65408
    v_cvt_pk_bf16_f32 v76, v76, v77
    v_cvt_pk_bf16_f32 v77, v78, v79
    ds_wrxchg_rtn_b64 v[72:73], v94, v[76:77] offset:65408
    s_waitcnt lgkmcnt(0)
    v_cmpx_ne_u64 vcc, v[74:75], v[70:71]
    s_and_b64 s[82:83], vcc, s[80:81]
    s_cbranch_scc1 L2_c152
L2_d152:
    v_mov_b64 v[84:85], v[70:71]
    v_mov_b32 v7, v95
    v_mov_b64 v[86:87], v[74:75]
    s_mov_b64 exec, -1
    s_or_b64 s[80:81], s[80:81], vcc
    v_cmpx_ne_u64 vcc, v[72:73], v[68:69]
    s_and_b64 s[82:83], vcc, s[80:81]
    s_cbranch_scc1 L2_c153
L2_d153:
    v_mov_b64 v[84:85], v[68:69]
    v_mov_b32 v7, v94
    v_mov_b64 v[86:87], v[72:73]
    s_mov_b64 exec, -1
    s_or_b64 s[80:81], s[80:81], vcc
    s_mov_b64 exec, s[80:81]
    ds_read_b64 v[68:69], v7 offset:65408
    v_mfma_f32_4x4x4_16b_bf16 v[76:79], v[12:13], v[84:85], 0
    s_nop 1
    v_mfma_f32_4x4x4_16b_bf16 v[76:79], v[10:11], v[86:87], v[76:79]
    s_waitcnt lgkmcnt(0)
    s_nop 0
    v_mfma_f32_4x4x4_16b_bf16 v[76:79], v[10:11], v[68:69], v[76:79]
    v_mov_b64 v[84:85], v[68:69]
    s_nop 3
    v_cvt_pk_bf16_f32 v76, v76, v77
    v_cvt_pk_bf16_f32 v77, v78, v79
    ds_wrxchg_rtn_b64 v[86:87], v7, v[76:77] offset:65408
    s_waitcnt lgkmcnt(0)
    v_cmp_ne_u64 s[80:81], v[86:87], v[84:85]
    s_mov_b64 exec, s[80:81]
    s_nop 1
    v_mfma_f32_4x4x4_16b_bf16 v[88:91], v[12:13], v[84:85], 0
    s_nop 1
    v_mfma_f32_4x4x4_16b_bf16 v[88:91], v[10:11], v[86:87], v[88:91]
    s_nop 4
    v_cvt_pk_bf16_f32 v88, v88, v89
    v_cvt_pk_bf16_f32 v89, v90, v91
    ds_pk_add_bf16 v7, v88 offset:65408
    ds_pk_add_bf16 v7, v89 offset:65412
    s_mov_b64 exec, -1
    s_load_dwordx2 s[4:5], s[0:1], 88
    v_add_u32 v123, 0x4000, v122
    s_lshl_b32 s50, s96, 16
    s_and_b32 s51, s96, 0xffff0000
    s_lshl_b32 s52, s97, 16
    s_and_b32 s53, s97, 0xffff0000
    s_lshl_b32 s54, s98, 16
    s_and_b32 s55, s98, 0xffff0000
    s_lshl_b32 s56, s99, 16
    s_and_b32 s57, s99, 0xffff0000
    s_waitcnt vmcnt(0) lgkmcnt(0)
    s_barrier
    s_add_u32 s8, s30, 0xec55000
    s_addc_u32 s9, s31, 0
    s_mov_b32 s10, 0x8000
    s_mov_b32 s11, 0x20000
    s_mov_b32 s12, s4
    s_mov_b32 s13, s5
    s_mov_b32 s14, 0x4e2000
    s_mov_b32 s15, 0x20000
    s_add_u32 s20, s30, 0xd854000
    s_addc_u32 s21, s31, 0
    s_mov_b32 s22, 0x1400000
    s_mov_b32 s23, 0x20000
    s_lshl2_add_u32 s4, s34, s33
    s_mul_i32 s4, s4, 81920
    s_add_u32 s3, s33, 1
    s_and_b32 s3, s3, 3
    s_mul_i32 s36, s3, 20000
    s_add_u32 s36, s36, 81920
    s_mul_i32 s40, s3, 20480
    s_add_u32 s40, s40, s4
    s_lshl2_add_u32 s3, s34, s3
    s_mul_i32 s3, s3, 81920
    s_mul_i32 s44, s33, 20480
    s_add_u32 s44, s44, s3
    s_add_u32 s3, s33, 2
    s_and_b32 s3, s3, 3
    s_mul_i32 s37, s3, 20000
    s_add_u32 s37, s37, 81920
    s_mul_i32 s41, s3, 20480
    s_add_u32 s41, s41, s4
    s_lshl2_add_u32 s3, s34, s3
    s_mul_i32 s3, s3, 81920
    s_mul_i32 s45, s33, 20480
    s_add_u32 s45, s45, s3
    s_add_u32 s3, s33, 3
    s_and_b32 s3, s3, 3
    s_mul_i32 s38, s3, 20000
    s_add_u32 s38, s38, 81920
    s_mul_i32 s42, s3, 20480
    s_add_u32 s42, s42, s4
    s_lshl2_add_u32 s3, s34, s3
    s_mul_i32 s3, s3, 81920
    s_mul_i32 s46, s33, 20480
    s_add_u32 s46, s46, s3
    v_add_u32 v104, s36, v122
    ds_read_b128 v[16:19], v104
    v_add_u32 v104, s37, v122
    ds_read_b128 v[20:23], v104
    v_add_u32 v104, s38, v122
    ds_read_b128 v[24:27], v104
    s_waitcnt lgkmcnt(2)
    buffer_store_dwordx4 v[16:19], v122, s[20:23], s40 offen sc1
    s_waitcnt lgkmcnt(1)
    buffer_store_dwordx4 v[20:23], v122, s[20:23], s41 offen sc1
    s_waitcnt lgkmcnt(0)
    buffer_store_dwordx4 v[24:27], v122, s[20:23], s42 offen sc1
    s_cmp_ge_u32 s32, 4
    s_cbranch_scc1 L2_g0
    v_add_u32 v104, s36, v123
    ds_read_b128 v[36:39], v104
    v_add_u32 v104, s37, v123
    ds_read_b128 v[40:43], v104
    v_add_u32 v104, s38, v123
    ds_read_b128 v[44:47], v104
    s_waitcnt lgkmcnt(2)
    buffer_store_dwordx4 v[36:39], v123, s[20:23], s40 offen sc1
    s_waitcnt lgkmcnt(1)
    buffer_store_dwordx4 v[40:43], v123, s[20:23], s41 offen sc1
    s_waitcnt lgkmcnt(0)
    buffer_store_dwordx4 v[44:47], v123, s[20:23], s42 offen sc1
L2_g0:
    v_lshlrev_b32 v80, 16, v116
    v_subrev_f32 v60, s50, v80
    v_subrev_f32 v61, s51, v80
    v_subrev_f32 v62, s52, v80
    v_subrev_f32 v63, s53, v80
    v_subrev_f32 v64, s54, v80
    v_subrev_f32 v65, s55, v80
    v_subrev_f32 v66, s56, v80
    v_subrev_f32 v67, s57, v80
    v_cvt_pk_bf16_f32 v68, v60, v61
    v_cvt_pk_bf16_f32 v69, v62, v63
    v_cvt_pk_bf16_f32 v70, v64, v65
    v_cvt_pk_bf16_f32 v71, v66, v67
    v_lshlrev_b32 v60, 16, v68
    v_and_b32 v61, 0xffff0000, v68
    v_lshlrev_b32 v62, 16, v69
    v_and_b32 v63, 0xffff0000, v69
    v_lshlrev_b32 v64, 16, v70
    v_and_b32 v65, 0xffff0000, v70
    v_lshlrev_b32 v66, 16, v71
    v_and_b32 v67, 0xffff0000, v71
    v_mul_f32 v60, v60, v60
    v_mul_f32 v61, v61, v61
    v_mul_f32 v62, v62, v62
    v_mul_f32 v63, v63, v63
    v_mul_f32 v64, v64, v64
    v_mul_f32 v65, v65, v65
    v_mul_f32 v66, v66, v66
    v_mul_f32 v67, v67, v67
    v_cvt_pk_bf16_f32 v68, v60, v61
    v_cvt_pk_bf16_f32 v69, v62, v63
    v_cvt_pk_bf16_f32 v70, v64, v65
    v_cvt_pk_bf16_f32 v71, v66, v67
    v_lshlrev_b32 v60, 16, v68
    v_and_b32 v61, 0xffff0000, v68
    v_lshlrev_b32 v62, 16, v69
    v_and_b32 v63, 0xffff0000, v69
    v_lshlrev_b32 v64, 16, v70
    v_and_b32 v65, 0xffff0000, v70
    v_lshlrev_b32 v66, 16, v71
    v_and_b32 v67, 0xffff0000, v71
    v_mul_f32 v60, 0xc1200000, v60
    v_mul_f32 v61, 0xc1200000, v61
    v_mul_f32 v62, 0xc1200000, v62
    v_mul_f32 v63, 0xc1200000, v63
    v_mul_f32 v64, 0xc1200000, v64
    v_mul_f32 v65, 0xc1200000, v65
    v_mul_f32 v66, 0xc1200000, v66
    v_mul_f32 v67, 0xc1200000, v67
    v_cvt_pk_bf16_f32 v68, v60, v61
    v_cvt_pk_bf16_f32 v69, v62, v63
    v_cvt_pk_bf16_f32 v70, v64, v65
    v_cvt_pk_bf16_f32 v71, v66, v67
    v_lshlrev_b32 v60, 16, v68
    v_and_b32 v61, 0xffff0000, v68
    v_lshlrev_b32 v62, 16, v69
    v_and_b32 v63, 0xffff0000, v69
    v_lshlrev_b32 v64, 16, v70
    v_and_b32 v65, 0xffff0000, v70
    v_lshlrev_b32 v66, 16, v71
    v_and_b32 v67, 0xffff0000, v71
    v_mul_f32 v60, 0x3fb8aa3b, v60
    v_mul_f32 v61, 0x3fb8aa3b, v61
    v_mul_f32 v62, 0x3fb8aa3b, v62
    v_mul_f32 v63, 0x3fb8aa3b, v63
    v_mul_f32 v64, 0x3fb8aa3b, v64
    v_mul_f32 v65, 0x3fb8aa3b, v65
    v_mul_f32 v66, 0x3fb8aa3b, v66
    v_mul_f32 v67, 0x3fb8aa3b, v67
    v_exp_f32 v60, v60
    v_exp_f32 v61, v61
    v_exp_f32 v62, v62
    v_exp_f32 v63, v63
    v_exp_f32 v64, v64
    v_exp_f32 v65, v65
    v_exp_f32 v66, v66
    v_exp_f32 v67, v67
    v_cvt_pk_bf16_f32 v72, v60, v61
    v_cvt_pk_bf16_f32 v73, v62, v63
    v_cvt_pk_bf16_f32 v74, v64, v65
    v_cvt_pk_bf16_f32 v75, v66, v67
    v_and_b32 v84, 0xffff0000, v116
    v_subrev_f32 v60, s50, v84
    v_subrev_f32 v61, s51, v84
    v_subrev_f32 v62, s52, v84
    v_subrev_f32 v63, s53, v84
    v_subrev_f32 v64, s54, v84
    v_subrev_f32 v65, s55, v84
    v_subrev_f32 v66, s56, v84
    v_subrev_f32 v67, s57, v84
    v_cvt_pk_bf16_f32 v68, v60, v61
    v_cvt_pk_bf16_f32 v69, v62, v63
    v_cvt_pk_bf16_f32 v70, v64, v65
    v_cvt_pk_bf16_f32 v71, v66, v67
    v_lshlrev_b32 v60, 16, v68
    v_and_b32 v61, 0xffff0000, v68
    v_lshlrev_b32 v62, 16, v69
    v_and_b32 v63, 0xffff0000, v69
    v_lshlrev_b32 v64, 16, v70
    v_and_b32 v65, 0xffff0000, v70
    v_lshlrev_b32 v66, 16, v71
    v_and_b32 v67, 0xffff0000, v71
    v_mul_f32 v60, v60, v60
    v_mul_f32 v61, v61, v61
    v_mul_f32 v62, v62, v62
    v_mul_f32 v63, v63, v63
    v_mul_f32 v64, v64, v64
    v_mul_f32 v65, v65, v65
    v_mul_f32 v66, v66, v66
    v_mul_f32 v67, v67, v67
    v_cvt_pk_bf16_f32 v68, v60, v61
    v_cvt_pk_bf16_f32 v69, v62, v63
    v_cvt_pk_bf16_f32 v70, v64, v65
    v_cvt_pk_bf16_f32 v71, v66, v67
    v_lshlrev_b32 v60, 16, v68
    v_and_b32 v61, 0xffff0000, v68
    v_lshlrev_b32 v62, 16, v69
    v_and_b32 v63, 0xffff0000, v69
    v_lshlrev_b32 v64, 16, v70
    v_and_b32 v65, 0xffff0000, v70
    v_lshlrev_b32 v66, 16, v71
    v_and_b32 v67, 0xffff0000, v71
    v_mul_f32 v60, 0xc1200000, v60
    v_mul_f32 v61, 0xc1200000, v61
    v_mul_f32 v62, 0xc1200000, v62
    v_mul_f32 v63, 0xc1200000, v63
    v_mul_f32 v64, 0xc1200000, v64
    v_mul_f32 v65, 0xc1200000, v65
    v_mul_f32 v66, 0xc1200000, v66
    v_mul_f32 v67, 0xc1200000, v67
    v_cvt_pk_bf16_f32 v68, v60, v61
    v_cvt_pk_bf16_f32 v69, v62, v63
    v_cvt_pk_bf16_f32 v70, v64, v65
    v_cvt_pk_bf16_f32 v71, v66, v67
    v_lshlrev_b32 v60, 16, v68
    v_and_b32 v61, 0xffff0000, v68
    v_lshlrev_b32 v62, 16, v69
    v_and_b32 v63, 0xffff0000, v69
    v_lshlrev_b32 v64, 16, v70
    v_and_b32 v65, 0xffff0000, v70
    v_lshlrev_b32 v66, 16, v71
    v_and_b32 v67, 0xffff0000, v71
    v_mul_f32 v60, 0x3fb8aa3b, v60
    v_mul_f32 v61, 0x3fb8aa3b, v61
    v_mul_f32 v62, 0x3fb8aa3b, v62
    v_mul_f32 v63, 0x3fb8aa3b, v63
    v_mul_f32 v64, 0x3fb8aa3b, v64
    v_mul_f32 v65, 0x3fb8aa3b, v65
    v_mul_f32 v66, 0x3fb8aa3b, v66
    v_mul_f32 v67, 0x3fb8aa3b, v67
    v_exp_f32 v60, v60
    v_exp_f32 v61, v61
    v_exp_f32 v62, v62
    v_exp_f32 v63, v63
    v_exp_f32 v64, v64
    v_exp_f32 v65, v65
    v_exp_f32 v66, v66
    v_exp_f32 v67, v67
    v_cvt_pk_bf16_f32 v76, v60, v61
    v_cvt_pk_bf16_f32 v77, v62, v63
    v_cvt_pk_bf16_f32 v78, v64, v65
    v_cvt_pk_bf16_f32 v79, v66, v67
    v_mfma_f32_4x4x4_16b_bf16 v[80:83], v[48:49], v[72:73], 0
    v_mfma_f32_4x4x4_16b_bf16 v[88:91], v[52:53], v[72:73], 0
    v_mfma_f32_4x4x4_16b_bf16 v[84:87], v[48:49], v[76:77], 0
    v_mfma_f32_4x4x4_16b_bf16 v[92:95], v[52:53], v[76:77], 0
    v_mfma_f32_4x4x4_16b_bf16 v[80:83], v[50:51], v[74:75], v[80:83]
    v_mfma_f32_4x4x4_16b_bf16 v[88:91], v[54:55], v[74:75], v[88:91]
    v_mfma_f32_4x4x4_16b_bf16 v[84:87], v[50:51], v[78:79], v[84:87]
    v_mfma_f32_4x4x4_16b_bf16 v[92:95], v[54:55], v[78:79], v[92:95]
    s_lshl_b32 s3, s34, 9
    s_lshl_b32 s4, s33, 7
    s_add_u32 s4, s4, s3
    v_mov_b32 v104, 1
    v_and_b32 v105, 0x3f0, v122
    v_lshlrev_b32 v105, 3, v105
    v_add_u32 v106, 81920, v118
    ds_read_b128 v[32:35], v106
    v_add_u32 v106, 81920, v119
    ds_read_b128 v[60:63], v106
    s_waitcnt vmcnt(0)
    s_barrier
    s_cmp_lg_u32 s32, 0
    s_cbranch_scc1 L2_f2
    s_mov_b64 exec, 1
    buffer_store_dword v104, off, s[8:11], s4 sc1
    s_mov_b64 exec, 15
    s_bitset0_b64 exec, s33
L2_f3:
    buffer_load_dword v104, v105, s[8:11], s3 offen sc1
    s_waitcnt vmcnt(0)
    v_cmp_ne_u32 vcc, 1, v104
    s_cbranch_vccnz L2_f3s
    s_mov_b64 exec, -1
L2_f2:
    s_barrier
    buffer_load_dwordx4 v[36:39], v122, s[20:23], s44 offen sc1
    buffer_load_dwordx4 v[40:43], v122, s[20:23], s45 offen sc1
    buffer_load_dwordx4 v[44:47], v122, s[20:23], s46 offen sc1
    s_cmp_ge_u32 s32, 4
    s_cbranch_scc1 L2_f5
    buffer_load_dwordx4 v[64:67], v123, s[20:23], s44 offen sc1
    buffer_load_dwordx4 v[68:71], v123, s[20:23], s45 offen sc1
    buffer_load_dwordx4 v[72:75], v123, s[20:23], s46 offen sc1
    v_lshlrev_b32 v16, 16, v117
    v_subrev_f32 v96, s50, v16
    v_subrev_f32 v97, s51, v16
    v_subrev_f32 v98, s52, v16
    v_subrev_f32 v99, s53, v16
    v_subrev_f32 v100, s54, v16
    v_subrev_f32 v101, s55, v16
    v_subrev_f32 v102, s56, v16
    v_subrev_f32 v103, s57, v16
    v_cvt_pk_bf16_f32 v0, v96, v97
    v_cvt_pk_bf16_f32 v1, v98, v99
    v_cvt_pk_bf16_f32 v2, v100, v101
    v_cvt_pk_bf16_f32 v3, v102, v103
    v_lshlrev_b32 v96, 16, v0
    v_and_b32 v97, 0xffff0000, v0
    v_lshlrev_b32 v98, 16, v1
    v_and_b32 v99, 0xffff0000, v1
    v_lshlrev_b32 v100, 16, v2
    v_and_b32 v101, 0xffff0000, v2
    v_lshlrev_b32 v102, 16, v3
    v_and_b32 v103, 0xffff0000, v3
    v_mul_f32 v96, v96, v96
    v_mul_f32 v97, v97, v97
    v_mul_f32 v98, v98, v98
    v_mul_f32 v99, v99, v99
    v_mul_f32 v100, v100, v100
    v_mul_f32 v101, v101, v101
    v_mul_f32 v102, v102, v102
    v_mul_f32 v103, v103, v103
    v_cvt_pk_bf16_f32 v0, v96, v97
    v_cvt_pk_bf16_f32 v1, v98, v99
    v_cvt_pk_bf16_f32 v2, v100, v101
    v_cvt_pk_bf16_f32 v3, v102, v103
    v_lshlrev_b32 v96, 16, v0
    v_and_b32 v97, 0xffff0000, v0
    v_lshlrev_b32 v98, 16, v1
    v_and_b32 v99, 0xffff0000, v1
    v_lshlrev_b32 v100, 16, v2
    v_and_b32 v101, 0xffff0000, v2
    v_lshlrev_b32 v102, 16, v3
    v_and_b32 v103, 0xffff0000, v3
    v_mul_f32 v96, 0xc1200000, v96
    v_mul_f32 v97, 0xc1200000, v97
    v_mul_f32 v98, 0xc1200000, v98
    v_mul_f32 v99, 0xc1200000, v99
    v_mul_f32 v100, 0xc1200000, v100
    v_mul_f32 v101, 0xc1200000, v101
    v_mul_f32 v102, 0xc1200000, v102
    v_mul_f32 v103, 0xc1200000, v103
    v_cvt_pk_bf16_f32 v0, v96, v97
    v_cvt_pk_bf16_f32 v1, v98, v99
    v_cvt_pk_bf16_f32 v2, v100, v101
    v_cvt_pk_bf16_f32 v3, v102, v103
    v_lshlrev_b32 v96, 16, v0
    v_and_b32 v97, 0xffff0000, v0
    v_lshlrev_b32 v98, 16, v1
    v_and_b32 v99, 0xffff0000, v1
    v_lshlrev_b32 v100, 16, v2
    v_and_b32 v101, 0xffff0000, v2
    v_lshlrev_b32 v102, 16, v3
    v_and_b32 v103, 0xffff0000, v3
    v_mul_f32 v96, 0x3fb8aa3b, v96
    v_mul_f32 v97, 0x3fb8aa3b, v97
    v_mul_f32 v98, 0x3fb8aa3b, v98
    v_mul_f32 v99, 0x3fb8aa3b, v99
    v_mul_f32 v100, 0x3fb8aa3b, v100
    v_mul_f32 v101, 0x3fb8aa3b, v101
    v_mul_f32 v102, 0x3fb8aa3b, v102
    v_mul_f32 v103, 0x3fb8aa3b, v103
    v_exp_f32 v96, v96
    v_exp_f32 v97, v97
    v_exp_f32 v98, v98
    v_exp_f32 v99, v99
    v_exp_f32 v100, v100
    v_exp_f32 v101, v101
    v_exp_f32 v102, v102
    v_exp_f32 v103, v103
    v_cvt_pk_bf16_f32 v104, v96, v97
    v_cvt_pk_bf16_f32 v105, v98, v99
    v_cvt_pk_bf16_f32 v106, v100, v101
    v_cvt_pk_bf16_f32 v107, v102, v103
    v_and_b32 v20, 0xffff0000, v117
    v_subrev_f32 v96, s50, v20
    v_subrev_f32 v97, s51, v20
    v_subrev_f32 v98, s52, v20
    v_subrev_f32 v99, s53, v20
    v_subrev_f32 v100, s54, v20
    v_subrev_f32 v101, s55, v20
    v_subrev_f32 v102, s56, v20
    v_subrev_f32 v103, s57, v20
    v_cvt_pk_bf16_f32 v0, v96, v97
    v_cvt_pk_bf16_f32 v1, v98, v99
    v_cvt_pk_bf16_f32 v2, v100, v101
    v_cvt_pk_bf16_f32 v3, v102, v103
    v_lshlrev_b32 v96, 16, v0
    v_and_b32 v97, 0xffff0000, v0
    v_lshlrev_b32 v98, 16, v1
    v_and_b32 v99, 0xffff0000, v1
    v_lshlrev_b32 v100, 16, v2
    v_and_b32 v101, 0xffff0000, v2
    v_lshlrev_b32 v102, 16, v3
    v_and_b32 v103, 0xffff0000, v3
    v_mul_f32 v96, v96, v96
    v_mul_f32 v97, v97, v97
    v_mul_f32 v98, v98, v98
    v_mul_f32 v99, v99, v99
    v_mul_f32 v100, v100, v100
    v_mul_f32 v101, v101, v101
    v_mul_f32 v102, v102, v102
    v_mul_f32 v103, v103, v103
    v_cvt_pk_bf16_f32 v0, v96, v97
    v_cvt_pk_bf16_f32 v1, v98, v99
    v_cvt_pk_bf16_f32 v2, v100, v101
    v_cvt_pk_bf16_f32 v3, v102, v103
    v_lshlrev_b32 v96, 16, v0
    v_and_b32 v97, 0xffff0000, v0
    v_lshlrev_b32 v98, 16, v1
    v_and_b32 v99, 0xffff0000, v1
    v_lshlrev_b32 v100, 16, v2
    v_and_b32 v101, 0xffff0000, v2
    v_lshlrev_b32 v102, 16, v3
    v_and_b32 v103, 0xffff0000, v3
    v_mul_f32 v96, 0xc1200000, v96
    v_mul_f32 v97, 0xc1200000, v97
    v_mul_f32 v98, 0xc1200000, v98
    v_mul_f32 v99, 0xc1200000, v99
    v_mul_f32 v100, 0xc1200000, v100
    v_mul_f32 v101, 0xc1200000, v101
    v_mul_f32 v102, 0xc1200000, v102
    v_mul_f32 v103, 0xc1200000, v103
    v_cvt_pk_bf16_f32 v0, v96, v97
    v_cvt_pk_bf16_f32 v1, v98, v99
    v_cvt_pk_bf16_f32 v2, v100, v101
    v_cvt_pk_bf16_f32 v3, v102, v103
    v_lshlrev_b32 v96, 16, v0
    v_and_b32 v97, 0xffff0000, v0
    v_lshlrev_b32 v98, 16, v1
    v_and_b32 v99, 0xffff0000, v1
    v_lshlrev_b32 v100, 16, v2
    v_and_b32 v101, 0xffff0000, v2
    v_lshlrev_b32 v102, 16, v3
    v_and_b32 v103, 0xffff0000, v3
    v_mul_f32 v96, 0x3fb8aa3b, v96
    v_mul_f32 v97, 0x3fb8aa3b, v97
    v_mul_f32 v98, 0x3fb8aa3b, v98
    v_mul_f32 v99, 0x3fb8aa3b, v99
    v_mul_f32 v100, 0x3fb8aa3b, v100
    v_mul_f32 v101, 0x3fb8aa3b, v101
    v_mul_f32 v102, 0x3fb8aa3b, v102
    v_mul_f32 v103, 0x3fb8aa3b, v103
    v_exp_f32 v96, v96
    v_exp_f32 v97, v97
    v_exp_f32 v98, v98
    v_exp_f32 v99, v99
    v_exp_f32 v100, v100
    v_exp_f32 v101, v101
    v_exp_f32 v102, v102
    v_exp_f32 v103, v103
    v_cvt_pk_bf16_f32 v76, v96, v97
    v_cvt_pk_bf16_f32 v77, v98, v99
    v_cvt_pk_bf16_f32 v78, v100, v101
    v_cvt_pk_bf16_f32 v79, v102, v103
    v_mfma_f32_4x4x4_16b_bf16 v[16:19], v[48:49], v[104:105], 0
    v_mfma_f32_4x4x4_16b_bf16 v[24:27], v[52:53], v[104:105], 0
    v_mfma_f32_4x4x4_16b_bf16 v[20:23], v[48:49], v[76:77], 0
    v_mfma_f32_4x4x4_16b_bf16 v[28:31], v[52:53], v[76:77], 0
    v_mfma_f32_4x4x4_16b_bf16 v[16:19], v[50:51], v[106:107], v[16:19]
    v_mfma_f32_4x4x4_16b_bf16 v[24:27], v[54:55], v[106:107], v[24:27]
    v_mfma_f32_4x4x4_16b_bf16 v[20:23], v[50:51], v[78:79], v[20:23]
    v_mfma_f32_4x4x4_16b_bf16 v[28:31], v[54:55], v[78:79], v[28:31]
L2_f5:
    s_waitcnt vmcnt(0) lgkmcnt(0)
    v_mfma_f32_4x4x4_16b_bf16 v[96:99], v[10:11], v[32:33], 0
    v_mfma_f32_4x4x4_16b_bf16 v[100:103], v[10:11], v[34:35], 0
    s_nop 0
    v_mfma_f32_4x4x4_16b_bf16 v[96:99], v[10:11], v[36:37], v[96:99]
    v_mfma_f32_4x4x4_16b_bf16 v[100:103], v[10:11], v[38:39], v[100:103]
    s_nop 0
    v_mfma_f32_4x4x4_16b_bf16 v[96:99], v[10:11], v[40:41], v[96:99]
    v_mfma_f32_4x4x4_16b_bf16 v[100:103], v[10:11], v[42:43], v[100:103]
    s_nop 0
    v_mfma_f32_4x4x4_16b_bf16 v[96:99], v[10:11], v[44:45], v[96:99]
    v_mfma_f32_4x4x4_16b_bf16 v[100:103], v[10:11], v[46:47], v[100:103]
    s_nop 3
    v_mul_f32 v96, v96, v80
    v_mul_f32 v97, v97, v81
    v_mul_f32 v98, v98, v82
    v_mul_f32 v99, v99, v83
    v_cvt_pk_bf16_f32 v32, v96, v97
    v_cvt_pk_bf16_f32 v33, v98, v99
    v_mul_f32 v100, v100, v84
    v_mul_f32 v101, v101, v85
    v_mul_f32 v102, v102, v86
    v_mul_f32 v103, v103, v87
    v_cvt_pk_bf16_f32 v34, v100, v101
    v_cvt_pk_bf16_f32 v35, v102, v103
    v_mfma_f32_4x4x4_16b_bf16 v[80:83], v[56:57], v[32:33], 0
    s_nop 0
    v_mfma_f32_4x4x4_16b_bf16 v[84:87], v[56:57], v[34:35], 0
    s_nop 2
    v_mul_f32 v80, v80, v88
    v_mul_f32 v81, v81, v89
    v_mul_f32 v82, v82, v90
    v_mul_f32 v83, v83, v91
    v_mul_f32 v84, v84, v92
    v_mul_f32 v85, v85, v93
    v_mul_f32 v86, v86, v94
    v_mul_f32 v87, v87, v95
    v_mfma_f32_4x4x4_16b_bf16 v[96:99], v[10:11], v[108:109], v[80:83]
    s_nop 0
    v_mfma_f32_4x4x4_16b_bf16 v[100:103], v[10:11], v[110:111], v[84:87]
    s_nop 2
    v_cvt_pk_bf16_f32 v36, v96, v97
    v_cvt_pk_bf16_f32 v37, v98, v99
    v_cvt_pk_bf16_f32 v38, v100, v101
    v_cvt_pk_bf16_f32 v39, v102, v103
    buffer_store_dwordx4 v[36:39], v120, s[12:15], 0 offen nt
    s_cmp_ge_u32 s32, 4
    s_cbranch_scc1 L2_f6
    v_mfma_f32_4x4x4_16b_bf16 v[96:99], v[10:11], v[60:61], 0
    v_mfma_f32_4x4x4_16b_bf16 v[100:103], v[10:11], v[62:63], 0
    s_nop 0
    v_mfma_f32_4x4x4_16b_bf16 v[96:99], v[10:11], v[64:65], v[96:99]
    v_mfma_f32_4x4x4_16b_bf16 v[100:103], v[10:11], v[66:67], v[100:103]
    s_nop 0
    v_mfma_f32_4x4x4_16b_bf16 v[96:99], v[10:11], v[68:69], v[96:99]
    v_mfma_f32_4x4x4_16b_bf16 v[100:103], v[10:11], v[70:71], v[100:103]
    s_nop 0
    v_mfma_f32_4x4x4_16b_bf16 v[96:99], v[10:11], v[72:73], v[96:99]
    v_mfma_f32_4x4x4_16b_bf16 v[100:103], v[10:11], v[74:75], v[100:103]
    s_nop 3
    v_mul_f32 v96, v96, v16
    v_mul_f32 v97, v97, v17
    v_mul_f32 v98, v98, v18
    v_mul_f32 v99, v99, v19
    v_cvt_pk_bf16_f32 v60, v96, v97
    v_cvt_pk_bf16_f32 v61, v98, v99
    v_mul_f32 v100, v100, v20
    v_mul_f32 v101, v101, v21
    v_mul_f32 v102, v102, v22
    v_mul_f32 v103, v103, v23
    v_cvt_pk_bf16_f32 v62, v100, v101
    v_cvt_pk_bf16_f32 v63, v102, v103
    v_mfma_f32_4x4x4_16b_bf16 v[16:19], v[56:57], v[60:61], 0
    s_nop 0
    v_mfma_f32_4x4x4_16b_bf16 v[20:23], v[56:57], v[62:63], 0
    s_nop 2
    v_mul_f32 v16, v16, v24
    v_mul_f32 v17, v17, v25
    v_mul_f32 v18, v18, v26
    v_mul_f32 v19, v19, v27
    v_mul_f32 v20, v20, v28
    v_mul_f32 v21, v21, v29
    v_mul_f32 v22, v22, v30
    v_mul_f32 v23, v23, v31
    v_mfma_f32_4x4x4_16b_bf16 v[96:99], v[10:11], v[124:125], v[16:19]
    s_nop 0
    v_mfma_f32_4x4x4_16b_bf16 v[100:103], v[10:11], v[126:127], v[20:23]
    s_nop 2
    v_cvt_pk_bf16_f32 v64, v96, v97
    v_cvt_pk_bf16_f32 v65, v98, v99
    v_cvt_pk_bf16_f32 v66, v100, v101
    v_cvt_pk_bf16_f32 v67, v102, v103
    buffer_store_dwordx4 v[64:67], v121, s[12:15], 0 offen nt
L2_f6:
L2_end:
    s_endpgm
L2_slow:
    s_lshr_b32 s35, s42, 2
    s_lshl_b32 s50, s32, 4
    s_and_b32 s3, s42, 3
    s_lshl_b32 s53, s3, 3
    s_add_u32 s53, s53, s39
    s_and_b32 s3, s35, 2
    s_lshl_b32 s3, s3, 1
    s_add_u32 s53, s53, s3
    s_and_b32 s54, s35, 1
    s_lshl_b32 s54, s54, 4
L2_sl_seg:
    s_mul_i32 s55, s50, 173056
    s_and_b32 s3, s50, 3
    s_lshl_b32 s3, s3, 5
    s_add_u32 s3, s3, s55
    s_add_u32 s3, s3, s53
    buffer_load_dword v104, off, s[12:15], s3 sc1
    buffer_load_dword v105, off, s[12:15], s3 offset:32 sc1
    s_waitcnt vmcnt(0)
    v_readfirstlane_b32 s51, v104
    v_readfirstlane_b32 s52, v105
    s_lshr_b32 s51, s51, s54
    s_and_b32 s51, s51, 0xffff
    s_lshr_b32 s52, s52, s54
    s_and_b32 s52, s52, 0xffff
L2_sl_rec:
    s_cmp_ge_u32 s51, s52
    s_cbranch_scc1 L2_sl_next
    v_mbcnt_lo_u32_b32 v102, -1, 0
    v_mbcnt_hi_u32_b32 v102, -1, v102
    v_add_u32 v102, s51, v102
    v_and_b32 v103, -4, v102
    v_lshl_add_u32 v104, v102, 2, v103
    v_lshl_add_u32 v105, v103, 2, v102
    v_cmp_gt_u32 vcc, s52, v102
    s_mov_b64 exec, vcc
    buffer_load_dword v106, v104, s[8:11], s55 offen
    buffer_load_ubyte v107, v105, s[8:11], s55 offen offset:16
    s_waitcnt vmcnt(0)
    v_lshrrev_b32 v98, 14, v106
    v_and_b32 v98, v5, v98
    ds_read_b64 v[100:101], v98
    v_perm_b32 v97, v106, v107, s44
    v_and_b32 v96, v5, v106
    v_bitop3_b32 v103, v106, 0.5, -0.5 bitop3:0xa8
    v_bitop3_b32 v97, v6, v97, v103 bitop3:0xca
    s_waitcnt lgkmcnt(0)
    v_mfma_f32_4x4x4_16b_bf16 v[88:91], v[8:9], v[100:101], 0
    s_nop 4
    v_mul_f32 v88, v97, v88
    v_mul_f32 v89, v97, v89
    v_mul_f32 v90, v97, v90
    v_mul_f32 v91, v97, v91
    v_cvt_pk_bf16_f32 v88, v88, v89
    v_cvt_pk_bf16_f32 v89, v90, v91
    ds_pk_add_bf16 v96, v88 offset:65408
    ds_pk_add_bf16 v96, v89 offset:65412
    s_mov_b64 exec, -1
    s_add_u32 s51, s51, 64
    s_branch L2_sl_rec
L2_sl_next:
    s_add_u32 s50, s50, 1
    s_and_b32 s3, s50, 15
    s_cbranch_scc1 L2_sl_seg
    s_add_u32 s50, s50, 240
    s_cmp_lt_u32 s50, 1280
    s_cbranch_scc1 L2_sl_seg
    s_waitcnt lgkmcnt(0)
    s_cmp_eq_u32 s42, 0
    s_cbranch_scc1 L2_ret0
    s_cmp_eq_u32 s42, 1
    s_cbranch_scc1 L2_ret1
    s_cmp_eq_u32 s42, 14
    s_cbranch_scc1 L2_ret6
    s_cmp_eq_u32 s42, 15
    s_cbranch_scc1 L2_ret7
    s_and_b32 s3, s42, 3
    s_cmp_eq_u32 s3, 2
    s_cbranch_scc1 L2_ret2
    s_cmp_eq_u32 s3, 3
    s_cbranch_scc1 L2_ret3
    s_cmp_eq_u32 s3, 0
    s_cbranch_scc1 L2_ret4
    s_branch L2_ret5
L2_xo3:
    v_cmp_lt_u32 vcc, 20, v99
    s_mov_b32 s101, 1
    s_cbranch_vccz L2_xp3
    v_cmp_lt_u32 vcc, 32, v99
    v_cmp_lt_u32 s[58:59], 31, v88
    s_mov_b32 s101, 2
    s_or_b64 vcc, vcc, s[58:59]
    s_cbranch_scc0 L2_xp3
    s_mov_b32 s37, 0x10000
    s_branch L2_xp3
L2_xa4:
    s_cmp_eq_u32 s101, 1
    s_cbranch_scc1 L2_xc4
    v_lshlrev_b32 v89, 0, v96
    v_add_u32 v90, 140, v97
    v_bitop3_b32 v90, v89, v45, v90 bitop3:0x6a
    ds_write_b32 v98, v90 offset:28
    v_lshlrev_b32 v89, 4, v96
    v_add_u32 v90, 120, v97
    v_bitop3_b32 v90, v89, v45, v90 bitop3:0x6a
    ds_write_b32 v98, v90 offset:24
    v_lshlrev_b32 v89, 8, v96
    v_add_u32 v90, 100, v97
    v_bitop3_b32 v90, v89, v45, v90 bitop3:0x6a
    ds_write_b32 v98, v90 offset:20
L2_xc4:
    v_lshlrev_b32 v89, 12, v96
    v_add_u32 v90, 80, v97
    v_bitop3_b32 v90, v89, v45, v90 bitop3:0x6a
    ds_write_b32 v98, v90 offset:16
    s_branch L2_xb4
L2_xe4:
    v_cmp_lt_u32 vcc, 32, v99
    v_cmp_lt_u32 s[58:59], 31, v88
    v_lshrrev_b32 v89, 16, v96
    v_add_u32 v97, 80, v97
    s_or_b64 vcc, vcc, s[58:59]
    s_cbranch_scc1 L2_xs4
    v_lshlrev_b32 v89, v1, v89
    v_and_b32 v89, v45, v89
    v_cmp_ne_u32 vcc, 0, v89
    v_xor_b32 v90, v97, v89
    s_add_u32 s3, s37, s38
    v_mbcnt_lo_u32_b32 v98, vcc_lo, 0
    v_mbcnt_hi_u32_b32 v98, vcc_hi, v98
    s_bcnt1_i32_b64 s41, vcc
    v_lshl_add_u32 v98, v98, 2, s3
    s_lshl2_add_u32 s37, s41, s37
    s_mov_b64 exec, vcc
    ds_write_b32 v98, v90
    s_mov_b64 exec, -1
    s_branch L2_xr4
L2_xs4:
    s_waitcnt lgkmcnt(0)
    s_mov_b32 s37, 0x10000
    s_branch L2_xw4
L2_xf4:
    s_cmp_gt_u32 s37, 1024
    s_cbranch_scc1 L2_xt4
    s_cmp_lt_u32 s37, 768
    s_cbranch_scc1 L2_xl4
    ds_read_b32 v20, v44 offset:896
    s_add_u32 s3, s42, 0
    s_bitset1_b32 s43, s3
    s_branch L2_xg4
L2_xl4:
    s_waitcnt lgkmcnt(0)
    v_mov_b32 v19, -1
    s_cmp_ge_u32 s37, 512
    s_cbranch_scc1 L2_xg4
    v_mov_b32 v39, -1
    s_cmp_ge_u32 s37, 256
    s_cbranch_scc1 L2_xg4
    v_mov_b32 v33, -1
    s_branch L2_xg4
L2_xt4:
    s_waitcnt lgkmcnt(0)
    v_mov_b32 v27, -1
    v_mov_b32 v33, -1
    v_mov_b32 v39, -1
    v_mov_b32 v19, -1
    s_add_u32 s3, s42, 0
    s_bitset1_b32 s36, s3
    s_branch L2_xg4
L2_xo5:
    v_cmp_lt_u32 vcc, 20, v99
    s_mov_b32 s101, 1
    s_cbranch_vccz L2_xp5
    v_cmp_lt_u32 vcc, 32, v99
    v_cmp_lt_u32 s[58:59], 31, v88
    s_mov_b32 s101, 2
    s_or_b64 vcc, vcc, s[58:59]
    s_cbranch_scc0 L2_xp5
    s_mov_b32 s37, 0x10000
    s_branch L2_xp5
L2_xa6:
    s_cmp_eq_u32 s101, 1
    s_cbranch_scc1 L2_xc6
    v_lshlrev_b32 v89, 0, v96
    v_add_u32 v90, 140, v97
    v_bitop3_b32 v90, v89, v45, v90 bitop3:0x6a
    ds_write_b32 v98, v90 offset:28
    v_lshlrev_b32 v89, 4, v96
    v_add_u32 v90, 120, v97
    v_bitop3_b32 v90, v89, v45, v90 bitop3:0x6a
    ds_write_b32 v98, v90 offset:24
    v_lshlrev_b32 v89, 8, v96
    v_add_u32 v90, 100, v97
    v_bitop3_b32 v90, v89, v45, v90 bitop3:0x6a
    ds_write_b32 v98, v90 offset:20
L2_xc6:
    v_lshlrev_b32 v89, 12, v96
    v_add_u32 v90, 80, v97
    v_bitop3_b32 v90, v89, v45, v90 bitop3:0x6a
    ds_write_b32 v98, v90 offset:16
    s_branch L2_xb6
L2_xe6:
    v_cmp_lt_u32 vcc, 32, v99
    v_cmp_lt_u32 s[58:59], 31, v88
    v_lshrrev_b32 v89, 16, v96
    v_add_u32 v97, 80, v97
    s_or_b64 vcc, vcc, s[58:59]
    s_cbranch_scc1 L2_xs6
    v_lshlrev_b32 v89, v1, v89
    v_and_b32 v89, v45, v89
    v_cmp_ne_u32 vcc, 0, v89
    v_xor_b32 v90, v97, v89
    s_add_u32 s3, s37, s38
    v_mbcnt_lo_u32_b32 v98, vcc_lo, 0
    v_mbcnt_hi_u32_b32 v98, vcc_hi, v98
    s_bcnt1_i32_b64 s41, vcc
    v_lshl_add_u32 v98, v98, 2, s3
    s_lshl2_add_u32 s37, s41, s37
    s_mov_b64 exec, vcc
    ds_write_b32 v98, v90
    s_mov_b64 exec, -1
    s_branch L2_xr6
L2_xs6:
    s_waitcnt lgkmcnt(0)
    s_mov_b32 s37, 0x10000
    s_branch L2_xw6
L2_xf6:
    s_cmp_gt_u32 s37, 1024
    s_cbranch_scc1 L2_xt6
    s_cmp_lt_u32 s37, 768
    s_cbranch_scc1 L2_xl6
    ds_read_b32 v21, v44 offset:896
    s_add_u32 s3, s42, 1
    s_bitset1_b32 s43, s3
    s_branch L2_xg6
L2_xl6:
    s_waitcnt lgkmcnt(0)
    v_mov_b32 v40, -1
    s_cmp_ge_u32 s37, 512
    s_cbranch_scc1 L2_xg6
    v_mov_b32 v43, -1
    s_cmp_ge_u32 s37, 256
    s_cbranch_scc1 L2_xg6
    v_mov_b32 v42, -1
    s_branch L2_xg6
L2_xt6:
    s_waitcnt lgkmcnt(0)
    v_mov_b32 v41, -1
    v_mov_b32 v42, -1
    v_mov_b32 v43, -1
    v_mov_b32 v40, -1
    s_add_u32 s3, s42, 1
    s_bitset1_b32 s36, s3
    s_branch L2_xg6
L2_oa7:
    v_and_b32 v47, 0x0fffffff, v20
    buffer_load_dword v78, v47, s[8:11], 0 offen offset:16
    s_mov_b64 exec, s[6:7]
    v_add_u32 v47, 8, v47
    v_lshrrev_b32 v20, 2, v20
    s_mov_b64 exec, -1
    buffer_load_dwordx2 v[76:77], v47, s[8:11], 0 offen
    s_branch L2_ob7
L2_oa8:
    s_waitcnt vmcnt(0)
    s_mov_b64 exec, s[6:7]
    v_lshrrev_b32 v78, 16, v78
    s_mov_b64 exec, -1
    v_and_b32 v46, 0x10000000, v20
    v_cmpx_eq_u32 vcc, 0, v46
    v_lshrrev_b32 v47, 14, v76
    v_and_b32 v47, v5, v47
    ds_read_b64 v[96:97], v47
    v_perm_b32 v98, v76, v78, s44
    v_bitop3_b32 v99, v76, 0.5, -0.5 bitop3:0xa8
    v_bitop3_b32 v98, v6, v98, v99 bitop3:0xca
    v_and_b32 v47, v5, v76
    s_waitcnt lgkmcnt(0)
    v_mfma_f32_4x4x4_16b_bf16 v[88:91], v[8:9], v[96:97], 0
    s_nop 4
    v_mul_f32 v88, v98, v88
    v_mul_f32 v89, v98, v89
    v_mul_f32 v90, v98, v90
    v_mul_f32 v91, v98, v91
    v_cvt_pk_bf16_f32 v88, v88, v89
    v_cvt_pk_bf16_f32 v89, v90, v91
    ds_pk_add_bf16 v47, v88 offset:65408
    ds_pk_add_bf16 v47, v89 offset:65412
    s_mov_b64 exec, -1
    v_and_b32 v46, 0x20000000, v20
    v_cmpx_eq_u32 vcc, 0, v46
    v_lshrrev_b32 v47, 14, v77
    v_and_b32 v47, v5, v47
    ds_read_b64 v[96:97], v47
    v_perm_b32 v98, v77, v78, s45
    v_bitop3_b32 v99, v77, 0.5, -0.5 bitop3:0xa8
    v_bitop3_b32 v98, v6, v98, v99 bitop3:0xca
    v_and_b32 v47, v5, v77
    s_waitcnt lgkmcnt(0)
    v_mfma_f32_4x4x4_16b_bf16 v[88:91], v[8:9], v[96:97], 0
    s_nop 4
    v_mul_f32 v88, v98, v88
    v_mul_f32 v89, v98, v89
    v_mul_f32 v90, v98, v90
    v_mul_f32 v91, v98, v91
    v_cvt_pk_bf16_f32 v88, v88, v89
    v_cvt_pk_bf16_f32 v89, v90, v91
    ds_pk_add_bf16 v47, v88 offset:65408
    ds_pk_add_bf16 v47, v89 offset:65412
    s_mov_b64 exec, -1
    s_branch L2_ob8
L2_c9:
    s_lshl_b64 s[52:53], s[82:83], 1
    s_andn2_b64 s[52:53], s[52:53], s[80:81]
    s_andn2_b64 s[52:53], s[52:53], s[54:55]
    s_or_b64 s[80:81], s[80:81], s[52:53]
    s_not_b64 vcc, s[52:53]
    s_mov_b64 exec, -1
    v_cndmask_b32_dpp v84, v84, v84, vcc wave_shr:1 row_mask:0xf bank_mask:0xf
    v_cndmask_b32_dpp v85, v85, v85, vcc wave_shr:1 row_mask:0xf bank_mask:0xf
    s_lshr_b64 s[52:53], s[52:53], 1
    v_cndmask_b32_dpp v86, v86, v86, vcc wave_shr:1 row_mask:0xf bank_mask:0xf
    v_cndmask_b32_dpp v87, v87, v87, vcc wave_shr:1 row_mask:0xf bank_mask:0xf
    s_andn2_b64 s[82:83], s[82:83], s[52:53]
    v_cndmask_b32_dpp v7, v7, v7, vcc wave_shr:1 row_mask:0xf bank_mask:0xf
    s_mov_b64 exec, s[54:55]
    s_cbranch_scc0 L2_d9
    s_mov_b64 exec, s[82:83]
    s_nop 1
    v_mfma_f32_4x4x4_16b_bf16 v[88:91], v[12:13], v[84:85], 0
    s_nop 1
    v_mfma_f32_4x4x4_16b_bf16 v[88:91], v[10:11], v[86:87], v[88:91]
    s_nop 4
    v_cvt_pk_bf16_f32 v88, v88, v89
    v_cvt_pk_bf16_f32 v89, v90, v91
    ds_pk_add_bf16 v7, v88 offset:65408
    ds_pk_add_bf16 v7, v89 offset:65412
    s_mov_b64 exec, s[54:55]
    s_branch L2_d9
L2_c10:
    s_lshl_b64 s[52:53], s[82:83], 1
    s_andn2_b64 s[52:53], s[52:53], s[80:81]
    s_andn2_b64 s[52:53], s[52:53], s[50:51]
    s_or_b64 s[80:81], s[80:81], s[52:53]
    s_not_b64 vcc, s[52:53]
    s_mov_b64 exec, -1
    v_cndmask_b32_dpp v84, v84, v84, vcc wave_shr:1 row_mask:0xf bank_mask:0xf
    v_cndmask_b32_dpp v85, v85, v85, vcc wave_shr:1 row_mask:0xf bank_mask:0xf
    s_lshr_b64 s[52:53], s[52:53], 1
    v_cndmask_b32_dpp v86, v86, v86, vcc wave_shr:1 row_mask:0xf bank_mask:0xf
    v_cndmask_b32_dpp v87, v87, v87, vcc wave_shr:1 row_mask:0xf bank_mask:0xf
    s_andn2_b64 s[82:83], s[82:83], s[52:53]
    v_cndmask_b32_dpp v7, v7, v7, vcc wave_shr:1 row_mask:0xf bank_mask:0xf
    s_mov_b64 exec, s[50:51]
    s_cbranch_scc0 L2_d10
    s_mov_b64 exec, s[82:83]
    s_nop 1
    v_mfma_f32_4x4x4_16b_bf16 v[88:91], v[12:13], v[84:85], 0
    s_nop 1
    v_mfma_f32_4x4x4_16b_bf16 v[88:91], v[10:11], v[86:87], v[88:91]
    s_nop 4
    v_cvt_pk_bf16_f32 v88, v88, v89
    v_cvt_pk_bf16_f32 v89, v90, v91
    ds_pk_add_bf16 v7, v88 offset:65408
    ds_pk_add_bf16 v7, v89 offset:65412
    s_mov_b64 exec, s[50:51]
    s_branch L2_d10
L2_c13:
    s_lshl_b64 s[52:53], s[82:83], 1
    s_andn2_b64 s[52:53], s[52:53], s[80:81]
    s_andn2_b64 s[52:53], s[52:53], s[54:55]
    s_or_b64 s[80:81], s[80:81], s[52:53]
    s_not_b64 vcc, s[52:53]
    s_mov_b64 exec, -1
    v_cndmask_b32_dpp v84, v84, v84, vcc wave_shr:1 row_mask:0xf bank_mask:0xf
    v_cndmask_b32_dpp v85, v85, v85, vcc wave_shr:1 row_mask:0xf bank_mask:0xf
    s_lshr_b64 s[52:53], s[52:53], 1
    v_cndmask_b32_dpp v86, v86, v86, vcc wave_shr:1 row_mask:0xf bank_mask:0xf
    v_cndmask_b32_dpp v87, v87, v87, vcc wave_shr:1 row_mask:0xf bank_mask:0xf
    s_andn2_b64 s[82:83], s[82:83], s[52:53]
    v_cndmask_b32_dpp v7, v7, v7, vcc wave_shr:1 row_mask:0xf bank_mask:0xf
    s_mov_b64 exec, s[54:55]
    s_cbranch_scc0 L2_d13
    s_mov_b64 exec, s[82:83]
    s_nop 1
    v_mfma_f32_4x4x4_16b_bf16 v[88:91], v[12:13], v[84:85], 0
    s_nop 1
    v_mfma_f32_4x4x4_16b_bf16 v[88:91], v[10:11], v[86:87], v[88:91]
    s_nop 4
    v_cvt_pk_bf16_f32 v88, v88, v89
    v_cvt_pk_bf16_f32 v89, v90, v91
    ds_pk_add_bf16 v7, v88 offset:65408
    ds_pk_add_bf16 v7, v89 offset:65412
    s_mov_b64 exec, s[54:55]
    s_branch L2_d13
L2_c14:
    s_lshl_b64 s[52:53], s[82:83], 1
    s_andn2_b64 s[52:53], s[52:53], s[80:81]
    s_andn2_b64 s[52:53], s[52:53], s[50:51]
    s_or_b64 s[80:81], s[80:81], s[52:53]
    s_not_b64 vcc, s[52:53]
    s_mov_b64 exec, -1
    v_cndmask_b32_dpp v84, v84, v84, vcc wave_shr:1 row_mask:0xf bank_mask:0xf
    v_cndmask_b32_dpp v85, v85, v85, vcc wave_shr:1 row_mask:0xf bank_mask:0xf
    s_lshr_b64 s[52:53], s[52:53], 1
    v_cndmask_b32_dpp v86, v86, v86, vcc wave_shr:1 row_mask:0xf bank_mask:0xf
    v_cndmask_b32_dpp v87, v87, v87, vcc wave_shr:1 row_mask:0xf bank_mask:0xf
    s_andn2_b64 s[82:83], s[82:83], s[52:53]
    v_cndmask_b32_dpp v7, v7, v7, vcc wave_shr:1 row_mask:0xf bank_mask:0xf
    s_mov_b64 exec, s[50:51]
    s_cbranch_scc0 L2_d14
    s_mov_b64 exec, s[82:83]
    s_nop 1
    v_mfma_f32_4x4x4_16b_bf16 v[88:91], v[12:13], v[84:85], 0
    s_nop 1
    v_mfma_f32_4x4x4_16b_bf16 v[88:91], v[10:11], v[86:87], v[88:91]
    s_nop 4
    v_cvt_pk_bf16_f32 v88, v88, v89
    v_cvt_pk_bf16_f32 v89, v90, v91
    ds_pk_add_bf16 v7, v88 offset:65408
    ds_pk_add_bf16 v7, v89 offset:65412
    s_mov_b64 exec, s[50:51]
    s_branch L2_d14
L2_c16:
    s_lshl_b64 s[52:53], s[82:83], 1
    s_andn2_b64 s[52:53], s[52:53], s[80:81]
    s_andn2_b64 s[52:53], s[52:53], s[54:55]
    s_or_b64 s[80:81], s[80:81], s[52:53]
    s_not_b64 vcc, s[52:53]
    s_mov_b64 exec, -1
    v_cndmask_b32_dpp v84, v84, v84, vcc wave_shr:1 row_mask:0xf bank_mask:0xf
    v_cndmask_b32_dpp v85, v85, v85, vcc wave_shr:1 row_mask:0xf bank_mask:0xf
    s_lshr_b64 s[52:53], s[52:53], 1
    v_cndmask_b32_dpp v86, v86, v86, vcc wave_shr:1 row_mask:0xf bank_mask:0xf
    v_cndmask_b32_dpp v87, v87, v87, vcc wave_shr:1 row_mask:0xf bank_mask:0xf
    s_andn2_b64 s[82:83], s[82:83], s[52:53]
    v_cndmask_b32_dpp v7, v7, v7, vcc wave_shr:1 row_mask:0xf bank_mask:0xf
    s_mov_b64 exec, s[54:55]
    s_cbranch_scc0 L2_d16
    s_mov_b64 exec, s[82:83]
    s_nop 1
    v_mfma_f32_4x4x4_16b_bf16 v[88:91], v[12:13], v[84:85], 0
    s_nop 1
    v_mfma_f32_4x4x4_16b_bf16 v[88:91], v[10:11], v[86:87], v[88:91]
    s_nop 4
    v_cvt_pk_bf16_f32 v88, v88, v89
    v_cvt_pk_bf16_f32 v89, v90, v91
    ds_pk_add_bf16 v7, v88 offset:65408
    ds_pk_add_bf16 v7, v89 offset:65412
    s_mov_b64 exec, s[54:55]
    s_branch L2_d16
L2_c17:
    s_lshl_b64 s[52:53], s[82:83], 1
    s_andn2_b64 s[52:53], s[52:53], s[80:81]
    s_andn2_b64 s[52:53], s[52:53], s[50:51]
    s_or_b64 s[80:81], s[80:81], s[52:53]
    s_not_b64 vcc, s[52:53]
    s_mov_b64 exec, -1
    v_cndmask_b32_dpp v84, v84, v84, vcc wave_shr:1 row_mask:0xf bank_mask:0xf
    v_cndmask_b32_dpp v85, v85, v85, vcc wave_shr:1 row_mask:0xf bank_mask:0xf
    s_lshr_b64 s[52:53], s[52:53], 1
    v_cndmask_b32_dpp v86, v86, v86, vcc wave_shr:1 row_mask:0xf bank_mask:0xf
    v_cndmask_b32_dpp v87, v87, v87, vcc wave_shr:1 row_mask:0xf bank_mask:0xf
    s_andn2_b64 s[82:83], s[82:83], s[52:53]
    v_cndmask_b32_dpp v7, v7, v7, vcc wave_shr:1 row_mask:0xf bank_mask:0xf
    s_mov_b64 exec, s[50:51]
    s_cbranch_scc0 L2_d17
    s_mov_b64 exec, s[82:83]
    s_nop 1
    v_mfma_f32_4x4x4_16b_bf16 v[88:91], v[12:13], v[84:85], 0
    s_nop 1
    v_mfma_f32_4x4x4_16b_bf16 v[88:91], v[10:11], v[86:87], v[88:91]
    s_nop 4
    v_cvt_pk_bf16_f32 v88, v88, v89
    v_cvt_pk_bf16_f32 v89, v90, v91
    ds_pk_add_bf16 v7, v88 offset:65408
    ds_pk_add_bf16 v7, v89 offset:65412
    s_mov_b64 exec, s[50:51]
    s_branch L2_d17
L2_xo20:
    v_cmp_lt_u32 vcc, 20, v99
    s_mov_b32 s101, 1
    s_cbranch_vccz L2_xp20
    v_cmp_lt_u32 vcc, 32, v99
    v_cmp_lt_u32 s[58:59], 31, v88
    s_mov_b32 s101, 2
    s_or_b64 vcc, vcc, s[58:59]
    s_cbranch_scc0 L2_xp20
    s_mov_b32 s37, 0x10000
    s_branch L2_xp20
L2_c21:
    s_lshl_b64 s[52:53], s[82:83], 1
    s_andn2_b64 s[52:53], s[52:53], s[80:81]
    s_andn2_b64 s[52:53], s[52:53], s[54:55]
    s_or_b64 s[80:81], s[80:81], s[52:53]
    s_not_b64 vcc, s[52:53]
    s_mov_b64 exec, -1
    v_cndmask_b32_dpp v84, v84, v84, vcc wave_shr:1 row_mask:0xf bank_mask:0xf
    v_cndmask_b32_dpp v85, v85, v85, vcc wave_shr:1 row_mask:0xf bank_mask:0xf
    s_lshr_b64 s[52:53], s[52:53], 1
    v_cndmask_b32_dpp v86, v86, v86, vcc wave_shr:1 row_mask:0xf bank_mask:0xf
    v_cndmask_b32_dpp v87, v87, v87, vcc wave_shr:1 row_mask:0xf bank_mask:0xf
    s_andn2_b64 s[82:83], s[82:83], s[52:53]
    v_cndmask_b32_dpp v7, v7, v7, vcc wave_shr:1 row_mask:0xf bank_mask:0xf
    s_mov_b64 exec, s[54:55]
    s_cbranch_scc0 L2_d21
    s_mov_b64 exec, s[82:83]
    s_nop 1
    v_mfma_f32_4x4x4_16b_bf16 v[88:91], v[12:13], v[84:85], 0
    s_nop 1
    v_mfma_f32_4x4x4_16b_bf16 v[88:91], v[10:11], v[86:87], v[88:91]
    s_nop 4
    v_cvt_pk_bf16_f32 v88, v88, v89
    v_cvt_pk_bf16_f32 v89, v90, v91
    ds_pk_add_bf16 v7, v88 offset:65408
    ds_pk_add_bf16 v7, v89 offset:65412
    s_mov_b64 exec, s[54:55]
    s_branch L2_d21
L2_c22:
    s_lshl_b64 s[52:53], s[82:83], 1
    s_andn2_b64 s[52:53], s[52:53], s[80:81]
    s_andn2_b64 s[52:53], s[52:53], s[50:51]
    s_or_b64 s[80:81], s[80:81], s[52:53]
    s_not_b64 vcc, s[52:53]
    s_mov_b64 exec, -1
    v_cndmask_b32_dpp v84, v84, v84, vcc wave_shr:1 row_mask:0xf bank_mask:0xf
    v_cndmask_b32_dpp v85, v85, v85, vcc wave_shr:1 row_mask:0xf bank_mask:0xf
    s_lshr_b64 s[52:53], s[52:53], 1
    v_cndmask_b32_dpp v86, v86, v86, vcc wave_shr:1 row_mask:0xf bank_mask:0xf
    v_cndmask_b32_dpp v87, v87, v87, vcc wave_shr:1 row_mask:0xf bank_mask:0xf
    s_andn2_b64 s[82:83], s[82:83], s[52:53]
    v_cndmask_b32_dpp v7, v7, v7, vcc wave_shr:1 row_mask:0xf bank_mask:0xf
    s_mov_b64 exec, s[50:51]
    s_cbranch_scc0 L2_d22
    s_mov_b64 exec, s[82:83]
    s_nop 1
    v_mfma_f32_4x4x4_16b_bf16 v[88:91], v[12:13], v[84:85], 0
    s_nop 1
    v_mfma_f32_4x4x4_16b_bf16 v[88:91], v[10:11], v[86:87], v[88:91]
    s_nop 4
    v_cvt_pk_bf16_f32 v88, v88, v89
    v_cvt_pk_bf16_f32 v89, v90, v91
    ds_pk_add_bf16 v7, v88 offset:65408
    ds_pk_add_bf16 v7, v89 offset:65412
    s_mov_b64 exec, s[50:51]
    s_branch L2_d22
L2_c23:
    s_lshl_b64 s[52:53], s[82:83], 1
    s_andn2_b64 s[52:53], s[52:53], s[80:81]
    s_andn2_b64 s[52:53], s[52:53], s[54:55]
    s_or_b64 s[80:81], s[80:81], s[52:53]
    s_not_b64 vcc, s[52:53]
    s_mov_b64 exec, -1
    v_cndmask_b32_dpp v84, v84, v84, vcc wave_shr:1 row_mask:0xf bank_mask:0xf
    v_cndmask_b32_dpp v85, v85, v85, vcc wave_shr:1 row_mask:0xf bank_mask:0xf
    s_lshr_b64 s[52:53], s[52:53], 1
    v_cndmask_b32_dpp v86, v86, v86, vcc wave_shr:1 row_mask:0xf bank_mask:0xf
    v_cndmask_b32_dpp v87, v87, v87, vcc wave_shr:1 row_mask:0xf bank_mask:0xf
    s_andn2_b64 s[82:83], s[82:83], s[52:53]
    v_cndmask_b32_dpp v7, v7, v7, vcc wave_shr:1 row_mask:0xf bank_mask:0xf
    s_mov_b64 exec, s[54:55]
    s_cbranch_scc0 L2_d23
    s_mov_b64 exec, s[82:83]
    s_nop 1
    v_mfma_f32_4x4x4_16b_bf16 v[88:91], v[12:13], v[84:85], 0
    s_nop 1
    v_mfma_f32_4x4x4_16b_bf16 v[88:91], v[10:11], v[86:87], v[88:91]
    s_nop 4
    v_cvt_pk_bf16_f32 v88, v88, v89
    v_cvt_pk_bf16_f32 v89, v90, v91
    ds_pk_add_bf16 v7, v88 offset:65408
    ds_pk_add_bf16 v7, v89 offset:65412
    s_mov_b64 exec, s[54:55]
    s_branch L2_d23
L2_c24:
    s_lshl_b64 s[52:53], s[82:83], 1
    s_andn2_b64 s[52:53], s[52:53], s[80:81]
    s_andn2_b64 s[52:53], s[52:53], s[50:51]
    s_or_b64 s[80:81], s[80:81], s[52:53]
    s_not_b64 vcc, s[52:53]
    s_mov_b64 exec, -1
    v_cndmask_b32_dpp v84, v84, v84, vcc wave_shr:1 row_mask:0xf bank_mask:0xf
    v_cndmask_b32_dpp v85, v85, v85, vcc wave_shr:1 row_mask:0xf bank_mask:0xf
    s_lshr_b64 s[52:53], s[52:53], 1
    v_cndmask_b32_dpp v86, v86, v86, vcc wave_shr:1 row_mask:0xf bank_mask:0xf
    v_cndmask_b32_dpp v87, v87, v87, vcc wave_shr:1 row_mask:0xf bank_mask:0xf
    s_andn2_b64 s[82:83], s[82:83], s[52:53]
    v_cndmask_b32_dpp v7, v7, v7, vcc wave_shr:1 row_mask:0xf bank_mask:0xf
    s_mov_b64 exec, s[50:51]
    s_cbranch_scc0 L2_d24
    s_mov_b64 exec, s[82:83]
    s_nop 1
    v_mfma_f32_4x4x4_16b_bf16 v[88:91], v[12:13], v[84:85], 0
    s_nop 1
    v_mfma_f32_4x4x4_16b_bf16 v[88:91], v[10:11], v[86:87], v[88:91]
    s_nop 4
    v_cvt_pk_bf16_f32 v88, v88, v89
    v_cvt_pk_bf16_f32 v89, v90, v91
    ds_pk_add_bf16 v7, v88 offset:65408
    ds_pk_add_bf16 v7, v89 offset:65412
    s_mov_b64 exec, s[50:51]
    s_branch L2_d24
L2_xa25:
    s_cmp_eq_u32 s101, 1
    s_cbranch_scc1 L2_xc25
    v_lshlrev_b32 v89, 0, v96
    v_add_u32 v90, 140, v97
    v_bitop3_b32 v90, v89, v45, v90 bitop3:0x6a
    ds_write_b32 v98, v90 offset:28
    v_lshlrev_b32 v89, 4, v96
    v_add_u32 v90, 120, v97
    v_bitop3_b32 v90, v89, v45, v90 bitop3:0x6a
    ds_write_b32 v98, v90 offset:24
    v_lshlrev_b32 v89, 8, v96
    v_add_u32 v90, 100, v97
    v_bitop3_b32 v90, v89, v45, v90 bitop3:0x6a
    ds_write_b32 v98, v90 offset:20
L2_xc25:
    v_lshlrev_b32 v89, 12, v96
    v_add_u32 v90, 80, v97
    v_bitop3_b32 v90, v89, v45, v90 bitop3:0x6a
    ds_write_b32 v98, v90 offset:16
    s_branch L2_xb25
L2_xe25:
    v_cmp_lt_u32 vcc, 32, v99
    v_cmp_lt_u32 s[58:59], 31, v88
    v_lshrrev_b32 v89, 16, v96
    v_add_u32 v97, 80, v97
    s_or_b64 vcc, vcc, s[58:59]
    s_cbranch_scc1 L2_xs25
    v_lshlrev_b32 v89, v1, v89
    v_and_b32 v89, v45, v89
    v_cmp_ne_u32 vcc, 0, v89
    v_xor_b32 v90, v97, v89
    s_add_u32 s3, s37, s38
    v_mbcnt_lo_u32_b32 v98, vcc_lo, 0
    v_mbcnt_hi_u32_b32 v98, vcc_hi, v98
    s_bcnt1_i32_b64 s41, vcc
    v_lshl_add_u32 v98, v98, 2, s3
    s_lshl2_add_u32 s37, s41, s37
    s_mov_b64 exec, vcc
    ds_write_b32 v98, v90
    s_mov_b64 exec, -1
    s_branch L2_xr25
L2_xs25:
    s_waitcnt lgkmcnt(0)
    s_mov_b32 s37, 0x10000
    s_branch L2_xw25
L2_c26:
    s_lshl_b64 s[52:53], s[82:83], 1
    s_andn2_b64 s[52:53], s[52:53], s[80:81]
    s_andn2_b64 s[52:53], s[52:53], s[54:55]
    s_or_b64 s[80:81], s[80:81], s[52:53]
    s_not_b64 vcc, s[52:53]
    s_mov_b64 exec, -1
    v_cndmask_b32_dpp v84, v84, v84, vcc wave_shr:1 row_mask:0xf bank_mask:0xf
    v_cndmask_b32_dpp v85, v85, v85, vcc wave_shr:1 row_mask:0xf bank_mask:0xf
    s_lshr_b64 s[52:53], s[52:53], 1
    v_cndmask_b32_dpp v86, v86, v86, vcc wave_shr:1 row_mask:0xf bank_mask:0xf
    v_cndmask_b32_dpp v87, v87, v87, vcc wave_shr:1 row_mask:0xf bank_mask:0xf
    s_andn2_b64 s[82:83], s[82:83], s[52:53]
    v_cndmask_b32_dpp v7, v7, v7, vcc wave_shr:1 row_mask:0xf bank_mask:0xf
    s_mov_b64 exec, s[54:55]
    s_cbranch_scc0 L2_d26
    s_mov_b64 exec, s[82:83]
    s_nop 1
    v_mfma_f32_4x4x4_16b_bf16 v[88:91], v[12:13], v[84:85], 0
    s_nop 1
    v_mfma_f32_4x4x4_16b_bf16 v[88:91], v[10:11], v[86:87], v[88:91]
    s_nop 4
    v_cvt_pk_bf16_f32 v88, v88, v89
    v_cvt_pk_bf16_f32 v89, v90, v91
    ds_pk_add_bf16 v7, v88 offset:65408
    ds_pk_add_bf16 v7, v89 offset:65412
    s_mov_b64 exec, s[54:55]
    s_branch L2_d26
L2_c27:
    s_lshl_b64 s[52:53], s[82:83], 1
    s_andn2_b64 s[52:53], s[52:53], s[80:81]
    s_andn2_b64 s[52:53], s[52:53], s[50:51]
    s_or_b64 s[80:81], s[80:81], s[52:53]
    s_not_b64 vcc, s[52:53]
    s_mov_b64 exec, -1
    v_cndmask_b32_dpp v84, v84, v84, vcc wave_shr:1 row_mask:0xf bank_mask:0xf
    v_cndmask_b32_dpp v85, v85, v85, vcc wave_shr:1 row_mask:0xf bank_mask:0xf
    s_lshr_b64 s[52:53], s[52:53], 1
    v_cndmask_b32_dpp v86, v86, v86, vcc wave_shr:1 row_mask:0xf bank_mask:0xf
    v_cndmask_b32_dpp v87, v87, v87, vcc wave_shr:1 row_mask:0xf bank_mask:0xf
    s_andn2_b64 s[82:83], s[82:83], s[52:53]
    v_cndmask_b32_dpp v7, v7, v7, vcc wave_shr:1 row_mask:0xf bank_mask:0xf
    s_mov_b64 exec, s[50:51]
    s_cbranch_scc0 L2_d27
    s_mov_b64 exec, s[82:83]
    s_nop 1
    v_mfma_f32_4x4x4_16b_bf16 v[88:91], v[12:13], v[84:85], 0
    s_nop 1
    v_mfma_f32_4x4x4_16b_bf16 v[88:91], v[10:11], v[86:87], v[88:91]
    s_nop 4
    v_cvt_pk_bf16_f32 v88, v88, v89
    v_cvt_pk_bf16_f32 v89, v90, v91
    ds_pk_add_bf16 v7, v88 offset:65408
    ds_pk_add_bf16 v7, v89 offset:65412
    s_mov_b64 exec, s[50:51]
    s_branch L2_d27
L2_xf25:
    s_cmp_gt_u32 s37, 1024
    s_cbranch_scc1 L2_xt25
    s_cmp_lt_u32 s37, 768
    s_cbranch_scc1 L2_xl25
    ds_read_b32 v20, v44 offset:896
    s_add_u32 s3, s42, 2
    s_bitset1_b32 s43, s3
    s_branch L2_xg25
L2_xl25:
    s_waitcnt lgkmcnt(0)
    v_mov_b32 v19, -1
    s_cmp_ge_u32 s37, 512
    s_cbranch_scc1 L2_xg25
    v_mov_b32 v39, -1
    s_cmp_ge_u32 s37, 256
    s_cbranch_scc1 L2_xg25
    v_mov_b32 v33, -1
    s_branch L2_xg25
L2_xt25:
    s_waitcnt lgkmcnt(0)
    v_mov_b32 v27, -1
    v_mov_b32 v33, -1
    v_mov_b32 v39, -1
    v_mov_b32 v19, -1
    s_add_u32 s3, s42, 2
    s_bitset1_b32 s36, s3
    s_branch L2_xg25
L2_oa28:
    v_and_b32 v47, 0x0fffffff, v21
    buffer_load_dword v114, v47, s[8:11], 0 offen offset:16
    s_mov_b64 exec, s[6:7]
    v_add_u32 v47, 8, v47
    v_lshrrev_b32 v21, 2, v21
    s_mov_b64 exec, -1
    buffer_load_dwordx2 v[112:113], v47, s[8:11], 0 offen
    s_branch L2_ob28
L2_c29:
    s_lshl_b64 s[52:53], s[82:83], 1
    s_andn2_b64 s[52:53], s[52:53], s[80:81]
    s_andn2_b64 s[52:53], s[52:53], s[54:55]
    s_or_b64 s[80:81], s[80:81], s[52:53]
    s_not_b64 vcc, s[52:53]
    s_mov_b64 exec, -1
    v_cndmask_b32_dpp v84, v84, v84, vcc wave_shr:1 row_mask:0xf bank_mask:0xf
    v_cndmask_b32_dpp v85, v85, v85, vcc wave_shr:1 row_mask:0xf bank_mask:0xf
    s_lshr_b64 s[52:53], s[52:53], 1
    v_cndmask_b32_dpp v86, v86, v86, vcc wave_shr:1 row_mask:0xf bank_mask:0xf
    v_cndmask_b32_dpp v87, v87, v87, vcc wave_shr:1 row_mask:0xf bank_mask:0xf
    s_andn2_b64 s[82:83], s[82:83], s[52:53]
    v_cndmask_b32_dpp v7, v7, v7, vcc wave_shr:1 row_mask:0xf bank_mask:0xf
    s_mov_b64 exec, s[54:55]
    s_cbranch_scc0 L2_d29
    s_mov_b64 exec, s[82:83]
    s_nop 1
    v_mfma_f32_4x4x4_16b_bf16 v[88:91], v[12:13], v[84:85], 0
    s_nop 1
    v_mfma_f32_4x4x4_16b_bf16 v[88:91], v[10:11], v[86:87], v[88:91]
    s_nop 4
    v_cvt_pk_bf16_f32 v88, v88, v89
    v_cvt_pk_bf16_f32 v89, v90, v91
    ds_pk_add_bf16 v7, v88 offset:65408
    ds_pk_add_bf16 v7, v89 offset:65412
    s_mov_b64 exec, s[54:55]
    s_branch L2_d29
L2_c30:
    s_lshl_b64 s[52:53], s[82:83], 1
    s_andn2_b64 s[52:53], s[52:53], s[80:81]
    s_andn2_b64 s[52:53], s[52:53], s[50:51]
    s_or_b64 s[80:81], s[80:81], s[52:53]
    s_not_b64 vcc, s[52:53]
    s_mov_b64 exec, -1
    v_cndmask_b32_dpp v84, v84, v84, vcc wave_shr:1 row_mask:0xf bank_mask:0xf
    v_cndmask_b32_dpp v85, v85, v85, vcc wave_shr:1 row_mask:0xf bank_mask:0xf
    s_lshr_b64 s[52:53], s[52:53], 1
    v_cndmask_b32_dpp v86, v86, v86, vcc wave_shr:1 row_mask:0xf bank_mask:0xf
    v_cndmask_b32_dpp v87, v87, v87, vcc wave_shr:1 row_mask:0xf bank_mask:0xf
    s_andn2_b64 s[82:83], s[82:83], s[52:53]
    v_cndmask_b32_dpp v7, v7, v7, vcc wave_shr:1 row_mask:0xf bank_mask:0xf
    s_mov_b64 exec, s[50:51]
    s_cbranch_scc0 L2_d30
    s_mov_b64 exec, s[82:83]
    s_nop 1
    v_mfma_f32_4x4x4_16b_bf16 v[88:91], v[12:13], v[84:85], 0
    s_nop 1
    v_mfma_f32_4x4x4_16b_bf16 v[88:91], v[10:11], v[86:87], v[88:91]
    s_nop 4
    v_cvt_pk_bf16_f32 v88, v88, v89
    v_cvt_pk_bf16_f32 v89, v90, v91
    ds_pk_add_bf16 v7, v88 offset:65408
    ds_pk_add_bf16 v7, v89 offset:65412
    s_mov_b64 exec, s[50:51]
    s_branch L2_d30
L2_c31:
    s_lshl_b64 s[52:53], s[82:83], 1
    s_andn2_b64 s[52:53], s[52:53], s[80:81]
    s_andn2_b64 s[52:53], s[52:53], s[54:55]
    s_or_b64 s[80:81], s[80:81], s[52:53]
    s_not_b64 vcc, s[52:53]
    s_mov_b64 exec, -1
    v_cndmask_b32_dpp v84, v84, v84, vcc wave_shr:1 row_mask:0xf bank_mask:0xf
    v_cndmask_b32_dpp v85, v85, v85, vcc wave_shr:1 row_mask:0xf bank_mask:0xf
    s_lshr_b64 s[52:53], s[52:53], 1
    v_cndmask_b32_dpp v86, v86, v86, vcc wave_shr:1 row_mask:0xf bank_mask:0xf
    v_cndmask_b32_dpp v87, v87, v87, vcc wave_shr:1 row_mask:0xf bank_mask:0xf
    s_andn2_b64 s[82:83], s[82:83], s[52:53]
    v_cndmask_b32_dpp v7, v7, v7, vcc wave_shr:1 row_mask:0xf bank_mask:0xf
    s_mov_b64 exec, s[54:55]
    s_cbranch_scc0 L2_d31
    s_mov_b64 exec, s[82:83]
    s_nop 1
    v_mfma_f32_4x4x4_16b_bf16 v[88:91], v[12:13], v[84:85], 0
    s_nop 1
    v_mfma_f32_4x4x4_16b_bf16 v[88:91], v[10:11], v[86:87], v[88:91]
    s_nop 4
    v_cvt_pk_bf16_f32 v88, v88, v89
    v_cvt_pk_bf16_f32 v89, v90, v91
    ds_pk_add_bf16 v7, v88 offset:65408
    ds_pk_add_bf16 v7, v89 offset:65412
    s_mov_b64 exec, s[54:55]
    s_branch L2_d31
L2_c32:
    s_lshl_b64 s[52:53], s[82:83], 1
    s_andn2_b64 s[52:53], s[52:53], s[80:81]
    s_andn2_b64 s[52:53], s[52:53], s[50:51]
    s_or_b64 s[80:81], s[80:81], s[52:53]
    s_not_b64 vcc, s[52:53]
    s_mov_b64 exec, -1
    v_cndmask_b32_dpp v84, v84, v84, vcc wave_shr:1 row_mask:0xf bank_mask:0xf
    v_cndmask_b32_dpp v85, v85, v85, vcc wave_shr:1 row_mask:0xf bank_mask:0xf
    s_lshr_b64 s[52:53], s[52:53], 1
    v_cndmask_b32_dpp v86, v86, v86, vcc wave_shr:1 row_mask:0xf bank_mask:0xf
    v_cndmask_b32_dpp v87, v87, v87, vcc wave_shr:1 row_mask:0xf bank_mask:0xf
    s_andn2_b64 s[82:83], s[82:83], s[52:53]
    v_cndmask_b32_dpp v7, v7, v7, vcc wave_shr:1 row_mask:0xf bank_mask:0xf
    s_mov_b64 exec, s[50:51]
    s_cbranch_scc0 L2_d32
    s_mov_b64 exec, s[82:83]
    s_nop 1
    v_mfma_f32_4x4x4_16b_bf16 v[88:91], v[12:13], v[84:85], 0
    s_nop 1
    v_mfma_f32_4x4x4_16b_bf16 v[88:91], v[10:11], v[86:87], v[88:91]
    s_nop 4
    v_cvt_pk_bf16_f32 v88, v88, v89
    v_cvt_pk_bf16_f32 v89, v90, v91
    ds_pk_add_bf16 v7, v88 offset:65408
    ds_pk_add_bf16 v7, v89 offset:65412
    s_mov_b64 exec, s[50:51]
    s_branch L2_d32
L2_c33:
    s_lshl_b64 s[52:53], s[82:83], 1
    s_andn2_b64 s[52:53], s[52:53], s[80:81]
    s_andn2_b64 s[52:53], s[52:53], s[54:55]
    s_or_b64 s[80:81], s[80:81], s[52:53]
    s_not_b64 vcc, s[52:53]
    s_mov_b64 exec, -1
    v_cndmask_b32_dpp v84, v84, v84, vcc wave_shr:1 row_mask:0xf bank_mask:0xf
    v_cndmask_b32_dpp v85, v85, v85, vcc wave_shr:1 row_mask:0xf bank_mask:0xf
    s_lshr_b64 s[52:53], s[52:53], 1
    v_cndmask_b32_dpp v86, v86, v86, vcc wave_shr:1 row_mask:0xf bank_mask:0xf
    v_cndmask_b32_dpp v87, v87, v87, vcc wave_shr:1 row_mask:0xf bank_mask:0xf
    s_andn2_b64 s[82:83], s[82:83], s[52:53]
    v_cndmask_b32_dpp v7, v7, v7, vcc wave_shr:1 row_mask:0xf bank_mask:0xf
    s_mov_b64 exec, s[54:55]
    s_cbranch_scc0 L2_d33
    s_mov_b64 exec, s[82:83]
    s_nop 1
    v_mfma_f32_4x4x4_16b_bf16 v[88:91], v[12:13], v[84:85], 0
    s_nop 1
    v_mfma_f32_4x4x4_16b_bf16 v[88:91], v[10:11], v[86:87], v[88:91]
    s_nop 4
    v_cvt_pk_bf16_f32 v88, v88, v89
    v_cvt_pk_bf16_f32 v89, v90, v91
    ds_pk_add_bf16 v7, v88 offset:65408
    ds_pk_add_bf16 v7, v89 offset:65412
    s_mov_b64 exec, s[54:55]
    s_branch L2_d33
L2_c34:
    s_lshl_b64 s[52:53], s[82:83], 1
    s_andn2_b64 s[52:53], s[52:53], s[80:81]
    s_andn2_b64 s[52:53], s[52:53], s[50:51]
    s_or_b64 s[80:81], s[80:81], s[52:53]
    s_not_b64 vcc, s[52:53]
    s_mov_b64 exec, -1
    v_cndmask_b32_dpp v84, v84, v84, vcc wave_shr:1 row_mask:0xf bank_mask:0xf
    v_cndmask_b32_dpp v85, v85, v85, vcc wave_shr:1 row_mask:0xf bank_mask:0xf
    s_lshr_b64 s[52:53], s[52:53], 1
    v_cndmask_b32_dpp v86, v86, v86, vcc wave_shr:1 row_mask:0xf bank_mask:0xf
    v_cndmask_b32_dpp v87, v87, v87, vcc wave_shr:1 row_mask:0xf bank_mask:0xf
    s_andn2_b64 s[82:83], s[82:83], s[52:53]
    v_cndmask_b32_dpp v7, v7, v7, vcc wave_shr:1 row_mask:0xf bank_mask:0xf
    s_mov_b64 exec, s[50:51]
    s_cbranch_scc0 L2_d34
    s_mov_b64 exec, s[82:83]
    s_nop 1
    v_mfma_f32_4x4x4_16b_bf16 v[88:91], v[12:13], v[84:85], 0
    s_nop 1
    v_mfma_f32_4x4x4_16b_bf16 v[88:91], v[10:11], v[86:87], v[88:91]
    s_nop 4
    v_cvt_pk_bf16_f32 v88, v88, v89
    v_cvt_pk_bf16_f32 v89, v90, v91
    ds_pk_add_bf16 v7, v88 offset:65408
    ds_pk_add_bf16 v7, v89 offset:65412
    s_mov_b64 exec, s[50:51]
    s_branch L2_d34
L2_c35:
    s_lshl_b64 s[52:53], s[82:83], 1
    s_andn2_b64 s[52:53], s[52:53], s[80:81]
    s_andn2_b64 s[52:53], s[52:53], s[54:55]
    s_or_b64 s[80:81], s[80:81], s[52:53]
    s_not_b64 vcc, s[52:53]
    s_mov_b64 exec, -1
    v_cndmask_b32_dpp v84, v84, v84, vcc wave_shr:1 row_mask:0xf bank_mask:0xf
    v_cndmask_b32_dpp v85, v85, v85, vcc wave_shr:1 row_mask:0xf bank_mask:0xf
    s_lshr_b64 s[52:53], s[52:53], 1
    v_cndmask_b32_dpp v86, v86, v86, vcc wave_shr:1 row_mask:0xf bank_mask:0xf
    v_cndmask_b32_dpp v87, v87, v87, vcc wave_shr:1 row_mask:0xf bank_mask:0xf
    s_andn2_b64 s[82:83], s[82:83], s[52:53]
    v_cndmask_b32_dpp v7, v7, v7, vcc wave_shr:1 row_mask:0xf bank_mask:0xf
    s_mov_b64 exec, s[54:55]
    s_cbranch_scc0 L2_d35
    s_mov_b64 exec, s[82:83]
    s_nop 1
    v_mfma_f32_4x4x4_16b_bf16 v[88:91], v[12:13], v[84:85], 0
    s_nop 1
    v_mfma_f32_4x4x4_16b_bf16 v[88:91], v[10:11], v[86:87], v[88:91]
    s_nop 4
    v_cvt_pk_bf16_f32 v88, v88, v89
    v_cvt_pk_bf16_f32 v89, v90, v91
    ds_pk_add_bf16 v7, v88 offset:65408
    ds_pk_add_bf16 v7, v89 offset:65412
    s_mov_b64 exec, s[54:55]
    s_branch L2_d35
L2_c36:
    s_lshl_b64 s[52:53], s[82:83], 1
    s_andn2_b64 s[52:53], s[52:53], s[80:81]
    s_andn2_b64 s[52:53], s[52:53], s[50:51]
    s_or_b64 s[80:81], s[80:81], s[52:53]
    s_not_b64 vcc, s[52:53]
    s_mov_b64 exec, -1
    v_cndmask_b32_dpp v84, v84, v84, vcc wave_shr:1 row_mask:0xf bank_mask:0xf
    v_cndmask_b32_dpp v85, v85, v85, vcc wave_shr:1 row_mask:0xf bank_mask:0xf
    s_lshr_b64 s[52:53], s[52:53], 1
    v_cndmask_b32_dpp v86, v86, v86, vcc wave_shr:1 row_mask:0xf bank_mask:0xf
    v_cndmask_b32_dpp v87, v87, v87, vcc wave_shr:1 row_mask:0xf bank_mask:0xf
    s_andn2_b64 s[82:83], s[82:83], s[52:53]
    v_cndmask_b32_dpp v7, v7, v7, vcc wave_shr:1 row_mask:0xf bank_mask:0xf
    s_mov_b64 exec, s[50:51]
    s_cbranch_scc0 L2_d36
    s_mov_b64 exec, s[82:83]
    s_nop 1
    v_mfma_f32_4x4x4_16b_bf16 v[88:91], v[12:13], v[84:85], 0
    s_nop 1
    v_mfma_f32_4x4x4_16b_bf16 v[88:91], v[10:11], v[86:87], v[88:91]
    s_nop 4
    v_cvt_pk_bf16_f32 v88, v88, v89
    v_cvt_pk_bf16_f32 v89, v90, v91
    ds_pk_add_bf16 v7, v88 offset:65408
    ds_pk_add_bf16 v7, v89 offset:65412
    s_mov_b64 exec, s[50:51]
    s_branch L2_d36
L2_oa37:
    s_waitcnt vmcnt(5)
    s_mov_b64 exec, s[6:7]
    v_lshrrev_b32 v114, 16, v114
    s_mov_b64 exec, -1
    v_and_b32 v46, 0x10000000, v21
    v_cmpx_eq_u32 vcc, 0, v46
    v_lshrrev_b32 v47, 14, v112
    v_and_b32 v47, v5, v47
    ds_read_b64 v[96:97], v47
    v_perm_b32 v98, v112, v114, s44
    v_bitop3_b32 v99, v112, 0.5, -0.5 bitop3:0xa8
    v_bitop3_b32 v98, v6, v98, v99 bitop3:0xca
    v_and_b32 v47, v5, v112
    s_waitcnt lgkmcnt(0)
    v_mfma_f32_4x4x4_16b_bf16 v[88:91], v[8:9], v[96:97], 0
    s_nop 4
    v_mul_f32 v88, v98, v88
    v_mul_f32 v89, v98, v89
    v_mul_f32 v90, v98, v90
    v_mul_f32 v91, v98, v91
    v_cvt_pk_bf16_f32 v88, v88, v89
    v_cvt_pk_bf16_f32 v89, v90, v91
    ds_pk_add_bf16 v47, v88 offset:65408
    ds_pk_add_bf16 v47, v89 offset:65412
    s_mov_b64 exec, -1
    v_and_b32 v46, 0x20000000, v21
    v_cmpx_eq_u32 vcc, 0, v46
    v_lshrrev_b32 v47, 14, v113
    v_and_b32 v47, v5, v47
    ds_read_b64 v[96:97], v47
    v_perm_b32 v98, v113, v114, s45
    v_bitop3_b32 v99, v113, 0.5, -0.5 bitop3:0xa8
    v_bitop3_b32 v98, v6, v98, v99 bitop3:0xca
    v_and_b32 v47, v5, v113
    s_waitcnt lgkmcnt(0)
    v_mfma_f32_4x4x4_16b_bf16 v[88:91], v[8:9], v[96:97], 0
    s_nop 4
    v_mul_f32 v88, v98, v88
    v_mul_f32 v89, v98, v89
    v_mul_f32 v90, v98, v90
    v_mul_f32 v91, v98, v91
    v_cvt_pk_bf16_f32 v88, v88, v89
    v_cvt_pk_bf16_f32 v89, v90, v91
    ds_pk_add_bf16 v47, v88 offset:65408
    ds_pk_add_bf16 v47, v89 offset:65412
    s_mov_b64 exec, -1
    s_branch L2_ob37
L2_xo38:
    v_cmp_lt_u32 vcc, 20, v99
    s_mov_b32 s101, 1
    s_cbranch_vccz L2_xp38
    v_cmp_lt_u32 vcc, 32, v99
    v_cmp_lt_u32 s[58:59], 31, v88
    s_mov_b32 s101, 2
    s_or_b64 vcc, vcc, s[58:59]
    s_cbranch_scc0 L2_xp38
    s_mov_b32 s37, 0x10000
    s_branch L2_xp38
L2_c39:
    s_lshl_b64 s[52:53], s[82:83], 1
    s_andn2_b64 s[52:53], s[52:53], s[80:81]
    s_andn2_b64 s[52:53], s[52:53], s[54:55]
    s_or_b64 s[80:81], s[80:81], s[52:53]
    s_not_b64 vcc, s[52:53]
    s_mov_b64 exec, -1
    v_cndmask_b32_dpp v84, v84, v84, vcc wave_shr:1 row_mask:0xf bank_mask:0xf
    v_cndmask_b32_dpp v85, v85, v85, vcc wave_shr:1 row_mask:0xf bank_mask:0xf
    s_lshr_b64 s[52:53], s[52:53], 1
    v_cndmask_b32_dpp v86, v86, v86, vcc wave_shr:1 row_mask:0xf bank_mask:0xf
    v_cndmask_b32_dpp v87, v87, v87, vcc wave_shr:1 row_mask:0xf bank_mask:0xf
    s_andn2_b64 s[82:83], s[82:83], s[52:53]
    v_cndmask_b32_dpp v7, v7, v7, vcc wave_shr:1 row_mask:0xf bank_mask:0xf
    s_mov_b64 exec, s[54:55]
    s_cbranch_scc0 L2_d39
    s_mov_b64 exec, s[82:83]
    s_nop 1
    v_mfma_f32_4x4x4_16b_bf16 v[88:91], v[12:13], v[84:85], 0
    s_nop 1
    v_mfma_f32_4x4x4_16b_bf16 v[88:91], v[10:11], v[86:87], v[88:91]
    s_nop 4
    v_cvt_pk_bf16_f32 v88, v88, v89
    v_cvt_pk_bf16_f32 v89, v90, v91
    ds_pk_add_bf16 v7, v88 offset:65408
    ds_pk_add_bf16 v7, v89 offset:65412
    s_mov_b64 exec, s[54:55]
    s_branch L2_d39
L2_c40:
    s_lshl_b64 s[52:53], s[82:83], 1
    s_andn2_b64 s[52:53], s[52:53], s[80:81]
    s_andn2_b64 s[52:53], s[52:53], s[50:51]
    s_or_b64 s[80:81], s[80:81], s[52:53]
    s_not_b64 vcc, s[52:53]
    s_mov_b64 exec, -1
    v_cndmask_b32_dpp v84, v84, v84, vcc wave_shr:1 row_mask:0xf bank_mask:0xf
    v_cndmask_b32_dpp v85, v85, v85, vcc wave_shr:1 row_mask:0xf bank_mask:0xf
    s_lshr_b64 s[52:53], s[52:53], 1
    v_cndmask_b32_dpp v86, v86, v86, vcc wave_shr:1 row_mask:0xf bank_mask:0xf
    v_cndmask_b32_dpp v87, v87, v87, vcc wave_shr:1 row_mask:0xf bank_mask:0xf
    s_andn2_b64 s[82:83], s[82:83], s[52:53]
    v_cndmask_b32_dpp v7, v7, v7, vcc wave_shr:1 row_mask:0xf bank_mask:0xf
    s_mov_b64 exec, s[50:51]
    s_cbranch_scc0 L2_d40
    s_mov_b64 exec, s[82:83]
    s_nop 1
    v_mfma_f32_4x4x4_16b_bf16 v[88:91], v[12:13], v[84:85], 0
    s_nop 1
    v_mfma_f32_4x4x4_16b_bf16 v[88:91], v[10:11], v[86:87], v[88:91]
    s_nop 4
    v_cvt_pk_bf16_f32 v88, v88, v89
    v_cvt_pk_bf16_f32 v89, v90, v91
    ds_pk_add_bf16 v7, v88 offset:65408
    ds_pk_add_bf16 v7, v89 offset:65412
    s_mov_b64 exec, s[50:51]
    s_branch L2_d40
L2_c41:
    s_lshl_b64 s[52:53], s[82:83], 1
    s_andn2_b64 s[52:53], s[52:53], s[80:81]
    s_andn2_b64 s[52:53], s[52:53], s[54:55]
    s_or_b64 s[80:81], s[80:81], s[52:53]
    s_not_b64 vcc, s[52:53]
    s_mov_b64 exec, -1
    v_cndmask_b32_dpp v84, v84, v84, vcc wave_shr:1 row_mask:0xf bank_mask:0xf
    v_cndmask_b32_dpp v85, v85, v85, vcc wave_shr:1 row_mask:0xf bank_mask:0xf
    s_lshr_b64 s[52:53], s[52:53], 1
    v_cndmask_b32_dpp v86, v86, v86, vcc wave_shr:1 row_mask:0xf bank_mask:0xf
    v_cndmask_b32_dpp v87, v87, v87, vcc wave_shr:1 row_mask:0xf bank_mask:0xf
    s_andn2_b64 s[82:83], s[82:83], s[52:53]
    v_cndmask_b32_dpp v7, v7, v7, vcc wave_shr:1 row_mask:0xf bank_mask:0xf
    s_mov_b64 exec, s[54:55]
    s_cbranch_scc0 L2_d41
    s_mov_b64 exec, s[82:83]
    s_nop 1
    v_mfma_f32_4x4x4_16b_bf16 v[88:91], v[12:13], v[84:85], 0
    s_nop 1
    v_mfma_f32_4x4x4_16b_bf16 v[88:91], v[10:11], v[86:87], v[88:91]
    s_nop 4
    v_cvt_pk_bf16_f32 v88, v88, v89
    v_cvt_pk_bf16_f32 v89, v90, v91
    ds_pk_add_bf16 v7, v88 offset:65408
    ds_pk_add_bf16 v7, v89 offset:65412
    s_mov_b64 exec, s[54:55]
    s_branch L2_d41
L2_c42:
    s_lshl_b64 s[52:53], s[82:83], 1
    s_andn2_b64 s[52:53], s[52:53], s[80:81]
    s_andn2_b64 s[52:53], s[52:53], s[50:51]
    s_or_b64 s[80:81], s[80:81], s[52:53]
    s_not_b64 vcc, s[52:53]
    s_mov_b64 exec, -1
    v_cndmask_b32_dpp v84, v84, v84, vcc wave_shr:1 row_mask:0xf bank_mask:0xf
    v_cndmask_b32_dpp v85, v85, v85, vcc wave_shr:1 row_mask:0xf bank_mask:0xf
    s_lshr_b64 s[52:53], s[52:53], 1
    v_cndmask_b32_dpp v86, v86, v86, vcc wave_shr:1 row_mask:0xf bank_mask:0xf
    v_cndmask_b32_dpp v87, v87, v87, vcc wave_shr:1 row_mask:0xf bank_mask:0xf
    s_andn2_b64 s[82:83], s[82:83], s[52:53]
    v_cndmask_b32_dpp v7, v7, v7, vcc wave_shr:1 row_mask:0xf bank_mask:0xf
    s_mov_b64 exec, s[50:51]
    s_cbranch_scc0 L2_d42
    s_mov_b64 exec, s[82:83]
    s_nop 1
    v_mfma_f32_4x4x4_16b_bf16 v[88:91], v[12:13], v[84:85], 0
    s_nop 1
    v_mfma_f32_4x4x4_16b_bf16 v[88:91], v[10:11], v[86:87], v[88:91]
    s_nop 4
    v_cvt_pk_bf16_f32 v88, v88, v89
    v_cvt_pk_bf16_f32 v89, v90, v91
    ds_pk_add_bf16 v7, v88 offset:65408
    ds_pk_add_bf16 v7, v89 offset:65412
    s_mov_b64 exec, s[50:51]
    s_branch L2_d42
L2_xa43:
    s_cmp_eq_u32 s101, 1
    s_cbranch_scc1 L2_xc43
    v_lshlrev_b32 v89, 0, v96
    v_add_u32 v90, 140, v97
    v_bitop3_b32 v90, v89, v45, v90 bitop3:0x6a
    ds_write_b32 v98, v90 offset:28
    v_lshlrev_b32 v89, 4, v96
    v_add_u32 v90, 120, v97
    v_bitop3_b32 v90, v89, v45, v90 bitop3:0x6a
    ds_write_b32 v98, v90 offset:24
    v_lshlrev_b32 v89, 8, v96
    v_add_u32 v90, 100, v97
    v_bitop3_b32 v90, v89, v45, v90 bitop3:0x6a
    ds_write_b32 v98, v90 offset:20
L2_xc43:
    v_lshlrev_b32 v89, 12, v96
    v_add_u32 v90, 80, v97
    v_bitop3_b32 v90, v89, v45, v90 bitop3:0x6a
    ds_write_b32 v98, v90 offset:16
    s_branch L2_xb43
L2_xe43:
    v_cmp_lt_u32 vcc, 32, v99
    v_cmp_lt_u32 s[58:59], 31, v88
    v_lshrrev_b32 v89, 16, v96
    v_add_u32 v97, 80, v97
    s_or_b64 vcc, vcc, s[58:59]
    s_cbranch_scc1 L2_xs43
    v_lshlrev_b32 v89, v1, v89
    v_and_b32 v89, v45, v89
    v_cmp_ne_u32 vcc, 0, v89
    v_xor_b32 v90, v97, v89
    s_add_u32 s3, s37, s38
    v_mbcnt_lo_u32_b32 v98, vcc_lo, 0
    v_mbcnt_hi_u32_b32 v98, vcc_hi, v98
    s_bcnt1_i32_b64 s41, vcc
    v_lshl_add_u32 v98, v98, 2, s3
    s_lshl2_add_u32 s37, s41, s37
    s_mov_b64 exec, vcc
    ds_write_b32 v98, v90
    s_mov_b64 exec, -1
    s_branch L2_xr43
L2_xs43:
    s_waitcnt lgkmcnt(0)
    s_mov_b32 s37, 0x10000
    s_branch L2_xw43
L2_c44:
    s_lshl_b64 s[52:53], s[82:83], 1
    s_andn2_b64 s[52:53], s[52:53], s[80:81]
    s_andn2_b64 s[52:53], s[52:53], s[54:55]
    s_or_b64 s[80:81], s[80:81], s[52:53]
    s_not_b64 vcc, s[52:53]
    s_mov_b64 exec, -1
    v_cndmask_b32_dpp v84, v84, v84, vcc wave_shr:1 row_mask:0xf bank_mask:0xf
    v_cndmask_b32_dpp v85, v85, v85, vcc wave_shr:1 row_mask:0xf bank_mask:0xf
    s_lshr_b64 s[52:53], s[52:53], 1
    v_cndmask_b32_dpp v86, v86, v86, vcc wave_shr:1 row_mask:0xf bank_mask:0xf
    v_cndmask_b32_dpp v87, v87, v87, vcc wave_shr:1 row_mask:0xf bank_mask:0xf
    s_andn2_b64 s[82:83], s[82:83], s[52:53]
    v_cndmask_b32_dpp v7, v7, v7, vcc wave_shr:1 row_mask:0xf bank_mask:0xf
    s_mov_b64 exec, s[54:55]
    s_cbranch_scc0 L2_d44
    s_mov_b64 exec, s[82:83]
    s_nop 1
    v_mfma_f32_4x4x4_16b_bf16 v[88:91], v[12:13], v[84:85], 0
    s_nop 1
    v_mfma_f32_4x4x4_16b_bf16 v[88:91], v[10:11], v[86:87], v[88:91]
    s_nop 4
    v_cvt_pk_bf16_f32 v88, v88, v89
    v_cvt_pk_bf16_f32 v89, v90, v91
    ds_pk_add_bf16 v7, v88 offset:65408
    ds_pk_add_bf16 v7, v89 offset:65412
    s_mov_b64 exec, s[54:55]
    s_branch L2_d44
L2_c45:
    s_lshl_b64 s[52:53], s[82:83], 1
    s_andn2_b64 s[52:53], s[52:53], s[80:81]
    s_andn2_b64 s[52:53], s[52:53], s[50:51]
    s_or_b64 s[80:81], s[80:81], s[52:53]
    s_not_b64 vcc, s[52:53]
    s_mov_b64 exec, -1
    v_cndmask_b32_dpp v84, v84, v84, vcc wave_shr:1 row_mask:0xf bank_mask:0xf
    v_cndmask_b32_dpp v85, v85, v85, vcc wave_shr:1 row_mask:0xf bank_mask:0xf
    s_lshr_b64 s[52:53], s[52:53], 1
    v_cndmask_b32_dpp v86, v86, v86, vcc wave_shr:1 row_mask:0xf bank_mask:0xf
    v_cndmask_b32_dpp v87, v87, v87, vcc wave_shr:1 row_mask:0xf bank_mask:0xf
    s_andn2_b64 s[82:83], s[82:83], s[52:53]
    v_cndmask_b32_dpp v7, v7, v7, vcc wave_shr:1 row_mask:0xf bank_mask:0xf
    s_mov_b64 exec, s[50:51]
    s_cbranch_scc0 L2_d45
    s_mov_b64 exec, s[82:83]
    s_nop 1
    v_mfma_f32_4x4x4_16b_bf16 v[88:91], v[12:13], v[84:85], 0
    s_nop 1
    v_mfma_f32_4x4x4_16b_bf16 v[88:91], v[10:11], v[86:87], v[88:91]
    s_nop 4
    v_cvt_pk_bf16_f32 v88, v88, v89
    v_cvt_pk_bf16_f32 v89, v90, v91
    ds_pk_add_bf16 v7, v88 offset:65408
    ds_pk_add_bf16 v7, v89 offset:65412
    s_mov_b64 exec, s[50:51]
    s_branch L2_d45
L2_xf43:
    s_cmp_gt_u32 s37, 1024
    s_cbranch_scc1 L2_xt43
    s_cmp_lt_u32 s37, 768
    s_cbranch_scc1 L2_xl43
    ds_read_b32 v21, v44 offset:896
    s_add_u32 s3, s42, 2
    s_bitset1_b32 s43, s3
    s_branch L2_xg43
L2_xl43:
    s_waitcnt lgkmcnt(0)
    v_mov_b32 v40, -1
    s_cmp_ge_u32 s37, 512
    s_cbranch_scc1 L2_xg43
    v_mov_b32 v43, -1
    s_cmp_ge_u32 s37, 256
    s_cbranch_scc1 L2_xg43
    v_mov_b32 v42, -1
    s_branch L2_xg43
L2_xt43:
    s_waitcnt lgkmcnt(0)
    v_mov_b32 v41, -1
    v_mov_b32 v42, -1
    v_mov_b32 v43, -1
    v_mov_b32 v40, -1
    s_add_u32 s3, s42, 2
    s_bitset1_b32 s36, s3
    s_branch L2_xg43
L2_oa46:
    v_and_b32 v47, 0x0fffffff, v20
    buffer_load_dword v114, v47, s[8:11], 0 offen offset:16
    s_mov_b64 exec, s[6:7]
    v_add_u32 v47, 8, v47
    v_lshrrev_b32 v20, 2, v20
    s_mov_b64 exec, -1
    buffer_load_dwordx2 v[112:113], v47, s[8:11], 0 offen
    s_branch L2_ob46
L2_c47:
    s_lshl_b64 s[52:53], s[82:83], 1
    s_andn2_b64 s[52:53], s[52:53], s[80:81]
    s_andn2_b64 s[52:53], s[52:53], s[54:55]
    s_or_b64 s[80:81], s[80:81], s[52:53]
    s_not_b64 vcc, s[52:53]
    s_mov_b64 exec, -1
    v_cndmask_b32_dpp v84, v84, v84, vcc wave_shr:1 row_mask:0xf bank_mask:0xf
    v_cndmask_b32_dpp v85, v85, v85, vcc wave_shr:1 row_mask:0xf bank_mask:0xf
    s_lshr_b64 s[52:53], s[52:53], 1
    v_cndmask_b32_dpp v86, v86, v86, vcc wave_shr:1 row_mask:0xf bank_mask:0xf
    v_cndmask_b32_dpp v87, v87, v87, vcc wave_shr:1 row_mask:0xf bank_mask:0xf
    s_andn2_b64 s[82:83], s[82:83], s[52:53]
    v_cndmask_b32_dpp v7, v7, v7, vcc wave_shr:1 row_mask:0xf bank_mask:0xf
    s_mov_b64 exec, s[54:55]
    s_cbranch_scc0 L2_d47
    s_mov_b64 exec, s[82:83]
    s_nop 1
    v_mfma_f32_4x4x4_16b_bf16 v[88:91], v[12:13], v[84:85], 0
    s_nop 1
    v_mfma_f32_4x4x4_16b_bf16 v[88:91], v[10:11], v[86:87], v[88:91]
    s_nop 4
    v_cvt_pk_bf16_f32 v88, v88, v89
    v_cvt_pk_bf16_f32 v89, v90, v91
    ds_pk_add_bf16 v7, v88 offset:65408
    ds_pk_add_bf16 v7, v89 offset:65412
    s_mov_b64 exec, s[54:55]
    s_branch L2_d47
L2_c48:
    s_lshl_b64 s[52:53], s[82:83], 1
    s_andn2_b64 s[52:53], s[52:53], s[80:81]
    s_andn2_b64 s[52:53], s[52:53], s[50:51]
    s_or_b64 s[80:81], s[80:81], s[52:53]
    s_not_b64 vcc, s[52:53]
    s_mov_b64 exec, -1
    v_cndmask_b32_dpp v84, v84, v84, vcc wave_shr:1 row_mask:0xf bank_mask:0xf
    v_cndmask_b32_dpp v85, v85, v85, vcc wave_shr:1 row_mask:0xf bank_mask:0xf
    s_lshr_b64 s[52:53], s[52:53], 1
    v_cndmask_b32_dpp v86, v86, v86, vcc wave_shr:1 row_mask:0xf bank_mask:0xf
    v_cndmask_b32_dpp v87, v87, v87, vcc wave_shr:1 row_mask:0xf bank_mask:0xf
    s_andn2_b64 s[82:83], s[82:83], s[52:53]
    v_cndmask_b32_dpp v7, v7, v7, vcc wave_shr:1 row_mask:0xf bank_mask:0xf
    s_mov_b64 exec, s[50:51]
    s_cbranch_scc0 L2_d48
    s_mov_b64 exec, s[82:83]
    s_nop 1
    v_mfma_f32_4x4x4_16b_bf16 v[88:91], v[12:13], v[84:85], 0
    s_nop 1
    v_mfma_f32_4x4x4_16b_bf16 v[88:91], v[10:11], v[86:87], v[88:91]
    s_nop 4
    v_cvt_pk_bf16_f32 v88, v88, v89
    v_cvt_pk_bf16_f32 v89, v90, v91
    ds_pk_add_bf16 v7, v88 offset:65408
    ds_pk_add_bf16 v7, v89 offset:65412
    s_mov_b64 exec, s[50:51]
    s_branch L2_d48
L2_c49:
    s_lshl_b64 s[52:53], s[82:83], 1
    s_andn2_b64 s[52:53], s[52:53], s[80:81]
    s_andn2_b64 s[52:53], s[52:53], s[54:55]
    s_or_b64 s[80:81], s[80:81], s[52:53]
    s_not_b64 vcc, s[52:53]
    s_mov_b64 exec, -1
    v_cndmask_b32_dpp v84, v84, v84, vcc wave_shr:1 row_mask:0xf bank_mask:0xf
    v_cndmask_b32_dpp v85, v85, v85, vcc wave_shr:1 row_mask:0xf bank_mask:0xf
    s_lshr_b64 s[52:53], s[52:53], 1
    v_cndmask_b32_dpp v86, v86, v86, vcc wave_shr:1 row_mask:0xf bank_mask:0xf
    v_cndmask_b32_dpp v87, v87, v87, vcc wave_shr:1 row_mask:0xf bank_mask:0xf
    s_andn2_b64 s[82:83], s[82:83], s[52:53]
    v_cndmask_b32_dpp v7, v7, v7, vcc wave_shr:1 row_mask:0xf bank_mask:0xf
    s_mov_b64 exec, s[54:55]
    s_cbranch_scc0 L2_d49
    s_mov_b64 exec, s[82:83]
    s_nop 1
    v_mfma_f32_4x4x4_16b_bf16 v[88:91], v[12:13], v[84:85], 0
    s_nop 1
    v_mfma_f32_4x4x4_16b_bf16 v[88:91], v[10:11], v[86:87], v[88:91]
    s_nop 4
    v_cvt_pk_bf16_f32 v88, v88, v89
    v_cvt_pk_bf16_f32 v89, v90, v91
    ds_pk_add_bf16 v7, v88 offset:65408
    ds_pk_add_bf16 v7, v89 offset:65412
    s_mov_b64 exec, s[54:55]
    s_branch L2_d49
L2_c50:
    s_lshl_b64 s[52:53], s[82:83], 1
    s_andn2_b64 s[52:53], s[52:53], s[80:81]
    s_andn2_b64 s[52:53], s[52:53], s[50:51]
    s_or_b64 s[80:81], s[80:81], s[52:53]
    s_not_b64 vcc, s[52:53]
    s_mov_b64 exec, -1
    v_cndmask_b32_dpp v84, v84, v84, vcc wave_shr:1 row_mask:0xf bank_mask:0xf
    v_cndmask_b32_dpp v85, v85, v85, vcc wave_shr:1 row_mask:0xf bank_mask:0xf
    s_lshr_b64 s[52:53], s[52:53], 1
    v_cndmask_b32_dpp v86, v86, v86, vcc wave_shr:1 row_mask:0xf bank_mask:0xf
    v_cndmask_b32_dpp v87, v87, v87, vcc wave_shr:1 row_mask:0xf bank_mask:0xf
    s_andn2_b64 s[82:83], s[82:83], s[52:53]
    v_cndmask_b32_dpp v7, v7, v7, vcc wave_shr:1 row_mask:0xf bank_mask:0xf
    s_mov_b64 exec, s[50:51]
    s_cbranch_scc0 L2_d50
    s_mov_b64 exec, s[82:83]
    s_nop 1
    v_mfma_f32_4x4x4_16b_bf16 v[88:91], v[12:13], v[84:85], 0
    s_nop 1
    v_mfma_f32_4x4x4_16b_bf16 v[88:91], v[10:11], v[86:87], v[88:91]
    s_nop 4
    v_cvt_pk_bf16_f32 v88, v88, v89
    v_cvt_pk_bf16_f32 v89, v90, v91
    ds_pk_add_bf16 v7, v88 offset:65408
    ds_pk_add_bf16 v7, v89 offset:65412
    s_mov_b64 exec, s[50:51]
    s_branch L2_d50
L2_c51:
    s_lshl_b64 s[52:53], s[82:83], 1
    s_andn2_b64 s[52:53], s[52:53], s[80:81]
    s_andn2_b64 s[52:53], s[52:53], s[54:55]
    s_or_b64 s[80:81], s[80:81], s[52:53]
    s_not_b64 vcc, s[52:53]
    s_mov_b64 exec, -1
    v_cndmask_b32_dpp v84, v84, v84, vcc wave_shr:1 row_mask:0xf bank_mask:0xf
    v_cndmask_b32_dpp v85, v85, v85, vcc wave_shr:1 row_mask:0xf bank_mask:0xf
    s_lshr_b64 s[52:53], s[52:53], 1
    v_cndmask_b32_dpp v86, v86, v86, vcc wave_shr:1 row_mask:0xf bank_mask:0xf
    v_cndmask_b32_dpp v87, v87, v87, vcc wave_shr:1 row_mask:0xf bank_mask:0xf
    s_andn2_b64 s[82:83], s[82:83], s[52:53]
    v_cndmask_b32_dpp v7, v7, v7, vcc wave_shr:1 row_mask:0xf bank_mask:0xf
    s_mov_b64 exec, s[54:55]
    s_cbranch_scc0 L2_d51
    s_mov_b64 exec, s[82:83]
    s_nop 1
    v_mfma_f32_4x4x4_16b_bf16 v[88:91], v[12:13], v[84:85], 0
    s_nop 1
    v_mfma_f32_4x4x4_16b_bf16 v[88:91], v[10:11], v[86:87], v[88:91]
    s_nop 4
    v_cvt_pk_bf16_f32 v88, v88, v89
    v_cvt_pk_bf16_f32 v89, v90, v91
    ds_pk_add_bf16 v7, v88 offset:65408
    ds_pk_add_bf16 v7, v89 offset:65412
    s_mov_b64 exec, s[54:55]
    s_branch L2_d51
L2_c52:
    s_lshl_b64 s[52:53], s[82:83], 1
    s_andn2_b64 s[52:53], s[52:53], s[80:81]
    s_andn2_b64 s[52:53], s[52:53], s[50:51]
    s_or_b64 s[80:81], s[80:81], s[52:53]
    s_not_b64 vcc, s[52:53]
    s_mov_b64 exec, -1
    v_cndmask_b32_dpp v84, v84, v84, vcc wave_shr:1 row_mask:0xf bank_mask:0xf
    v_cndmask_b32_dpp v85, v85, v85, vcc wave_shr:1 row_mask:0xf bank_mask:0xf
    s_lshr_b64 s[52:53], s[52:53], 1
    v_cndmask_b32_dpp v86, v86, v86, vcc wave_shr:1 row_mask:0xf bank_mask:0xf
    v_cndmask_b32_dpp v87, v87, v87, vcc wave_shr:1 row_mask:0xf bank_mask:0xf
    s_andn2_b64 s[82:83], s[82:83], s[52:53]
    v_cndmask_b32_dpp v7, v7, v7, vcc wave_shr:1 row_mask:0xf bank_mask:0xf
    s_mov_b64 exec, s[50:51]
    s_cbranch_scc0 L2_d52
    s_mov_b64 exec, s[82:83]
    s_nop 1
    v_mfma_f32_4x4x4_16b_bf16 v[88:91], v[12:13], v[84:85], 0
    s_nop 1
    v_mfma_f32_4x4x4_16b_bf16 v[88:91], v[10:11], v[86:87], v[88:91]
    s_nop 4
    v_cvt_pk_bf16_f32 v88, v88, v89
    v_cvt_pk_bf16_f32 v89, v90, v91
    ds_pk_add_bf16 v7, v88 offset:65408
    ds_pk_add_bf16 v7, v89 offset:65412
    s_mov_b64 exec, s[50:51]
    s_branch L2_d52
L2_c53:
    s_lshl_b64 s[52:53], s[82:83], 1
    s_andn2_b64 s[52:53], s[52:53], s[80:81]
    s_andn2_b64 s[52:53], s[52:53], s[54:55]
    s_or_b64 s[80:81], s[80:81], s[52:53]
    s_not_b64 vcc, s[52:53]
    s_mov_b64 exec, -1
    v_cndmask_b32_dpp v84, v84, v84, vcc wave_shr:1 row_mask:0xf bank_mask:0xf
    v_cndmask_b32_dpp v85, v85, v85, vcc wave_shr:1 row_mask:0xf bank_mask:0xf
    s_lshr_b64 s[52:53], s[52:53], 1
    v_cndmask_b32_dpp v86, v86, v86, vcc wave_shr:1 row_mask:0xf bank_mask:0xf
    v_cndmask_b32_dpp v87, v87, v87, vcc wave_shr:1 row_mask:0xf bank_mask:0xf
    s_andn2_b64 s[82:83], s[82:83], s[52:53]
    v_cndmask_b32_dpp v7, v7, v7, vcc wave_shr:1 row_mask:0xf bank_mask:0xf
    s_mov_b64 exec, s[54:55]
    s_cbranch_scc0 L2_d53
    s_mov_b64 exec, s[82:83]
    s_nop 1
    v_mfma_f32_4x4x4_16b_bf16 v[88:91], v[12:13], v[84:85], 0
    s_nop 1
    v_mfma_f32_4x4x4_16b_bf16 v[88:91], v[10:11], v[86:87], v[88:91]
    s_nop 4
    v_cvt_pk_bf16_f32 v88, v88, v89
    v_cvt_pk_bf16_f32 v89, v90, v91
    ds_pk_add_bf16 v7, v88 offset:65408
    ds_pk_add_bf16 v7, v89 offset:65412
    s_mov_b64 exec, s[54:55]
    s_branch L2_d53
L2_c54:
    s_lshl_b64 s[52:53], s[82:83], 1
    s_andn2_b64 s[52:53], s[52:53], s[80:81]
    s_andn2_b64 s[52:53], s[52:53], s[50:51]
    s_or_b64 s[80:81], s[80:81], s[52:53]
    s_not_b64 vcc, s[52:53]
    s_mov_b64 exec, -1
    v_cndmask_b32_dpp v84, v84, v84, vcc wave_shr:1 row_mask:0xf bank_mask:0xf
    v_cndmask_b32_dpp v85, v85, v85, vcc wave_shr:1 row_mask:0xf bank_mask:0xf
    s_lshr_b64 s[52:53], s[52:53], 1
    v_cndmask_b32_dpp v86, v86, v86, vcc wave_shr:1 row_mask:0xf bank_mask:0xf
    v_cndmask_b32_dpp v87, v87, v87, vcc wave_shr:1 row_mask:0xf bank_mask:0xf
    s_andn2_b64 s[82:83], s[82:83], s[52:53]
    v_cndmask_b32_dpp v7, v7, v7, vcc wave_shr:1 row_mask:0xf bank_mask:0xf
    s_mov_b64 exec, s[50:51]
    s_cbranch_scc0 L2_d54
    s_mov_b64 exec, s[82:83]
    s_nop 1
    v_mfma_f32_4x4x4_16b_bf16 v[88:91], v[12:13], v[84:85], 0
    s_nop 1
    v_mfma_f32_4x4x4_16b_bf16 v[88:91], v[10:11], v[86:87], v[88:91]
    s_nop 4
    v_cvt_pk_bf16_f32 v88, v88, v89
    v_cvt_pk_bf16_f32 v89, v90, v91
    ds_pk_add_bf16 v7, v88 offset:65408
    ds_pk_add_bf16 v7, v89 offset:65412
    s_mov_b64 exec, s[50:51]
    s_branch L2_d54
L2_oa55:
    s_waitcnt vmcnt(5)
    s_mov_b64 exec, s[6:7]
    v_lshrrev_b32 v114, 16, v114
    s_mov_b64 exec, -1
    v_and_b32 v46, 0x10000000, v20
    v_cmpx_eq_u32 vcc, 0, v46
    v_lshrrev_b32 v47, 14, v112
    v_and_b32 v47, v5, v47
    ds_read_b64 v[96:97], v47
    v_perm_b32 v98, v112, v114, s44
    v_bitop3_b32 v99, v112, 0.5, -0.5 bitop3:0xa8
    v_bitop3_b32 v98, v6, v98, v99 bitop3:0xca
    v_and_b32 v47, v5, v112
    s_waitcnt lgkmcnt(0)
    v_mfma_f32_4x4x4_16b_bf16 v[88:91], v[8:9], v[96:97], 0
    s_nop 4
    v_mul_f32 v88, v98, v88
    v_mul_f32 v89, v98, v89
    v_mul_f32 v90, v98, v90
    v_mul_f32 v91, v98, v91
    v_cvt_pk_bf16_f32 v88, v88, v89
    v_cvt_pk_bf16_f32 v89, v90, v91
    ds_pk_add_bf16 v47, v88 offset:65408
    ds_pk_add_bf16 v47, v89 offset:65412
    s_mov_b64 exec, -1
    v_and_b32 v46, 0x20000000, v20
    v_cmpx_eq_u32 vcc, 0, v46
    v_lshrrev_b32 v47, 14, v113
    v_and_b32 v47, v5, v47
    ds_read_b64 v[96:97], v47
    v_perm_b32 v98, v113, v114, s45
    v_bitop3_b32 v99, v113, 0.5, -0.5 bitop3:0xa8
    v_bitop3_b32 v98, v6, v98, v99 bitop3:0xca
    v_and_b32 v47, v5, v113
    s_waitcnt lgkmcnt(0)
    v_mfma_f32_4x4x4_16b_bf16 v[88:91], v[8:9], v[96:97], 0
    s_nop 4
    v_mul_f32 v88, v98, v88
    v_mul_f32 v89, v98, v89
    v_mul_f32 v90, v98, v90
    v_mul_f32 v91, v98, v91
    v_cvt_pk_bf16_f32 v88, v88, v89
    v_cvt_pk_bf16_f32 v89, v90, v91
    ds_pk_add_bf16 v47, v88 offset:65408
    ds_pk_add_bf16 v47, v89 offset:65412
    s_mov_b64 exec, -1
    s_branch L2_ob55
L2_xo56:
    v_cmp_lt_u32 vcc, 20, v99
    s_mov_b32 s101, 1
    s_cbranch_vccz L2_xp56
    v_cmp_lt_u32 vcc, 32, v99
    v_cmp_lt_u32 s[58:59], 31, v88
    s_mov_b32 s101, 2
    s_or_b64 vcc, vcc, s[58:59]
    s_cbranch_scc0 L2_xp56
    s_mov_b32 s37, 0x10000
    s_branch L2_xp56
L2_c57:
    s_lshl_b64 s[52:53], s[82:83], 1
    s_andn2_b64 s[52:53], s[52:53], s[80:81]
    s_andn2_b64 s[52:53], s[52:53], s[54:55]
    s_or_b64 s[80:81], s[80:81], s[52:53]
    s_not_b64 vcc, s[52:53]
    s_mov_b64 exec, -1
    v_cndmask_b32_dpp v84, v84, v84, vcc wave_shr:1 row_mask:0xf bank_mask:0xf
    v_cndmask_b32_dpp v85, v85, v85, vcc wave_shr:1 row_mask:0xf bank_mask:0xf
    s_lshr_b64 s[52:53], s[52:53], 1
    v_cndmask_b32_dpp v86, v86, v86, vcc wave_shr:1 row_mask:0xf bank_mask:0xf
    v_cndmask_b32_dpp v87, v87, v87, vcc wave_shr:1 row_mask:0xf bank_mask:0xf
    s_andn2_b64 s[82:83], s[82:83], s[52:53]
    v_cndmask_b32_dpp v7, v7, v7, vcc wave_shr:1 row_mask:0xf bank_mask:0xf
    s_mov_b64 exec, s[54:55]
    s_cbranch_scc0 L2_d57
    s_mov_b64 exec, s[82:83]
    s_nop 1
    v_mfma_f32_4x4x4_16b_bf16 v[88:91], v[12:13], v[84:85], 0
    s_nop 1
    v_mfma_f32_4x4x4_16b_bf16 v[88:91], v[10:11], v[86:87], v[88:91]
    s_nop 4
    v_cvt_pk_bf16_f32 v88, v88, v89
    v_cvt_pk_bf16_f32 v89, v90, v91
    ds_pk_add_bf16 v7, v88 offset:65408
    ds_pk_add_bf16 v7, v89 offset:65412
    s_mov_b64 exec, s[54:55]
    s_branch L2_d57
L2_c58:
    s_lshl_b64 s[52:53], s[82:83], 1
    s_andn2_b64 s[52:53], s[52:53], s[80:81]
    s_andn2_b64 s[52:53], s[52:53], s[50:51]
    s_or_b64 s[80:81], s[80:81], s[52:53]
    s_not_b64 vcc, s[52:53]
    s_mov_b64 exec, -1
    v_cndmask_b32_dpp v84, v84, v84, vcc wave_shr:1 row_mask:0xf bank_mask:0xf
    v_cndmask_b32_dpp v85, v85, v85, vcc wave_shr:1 row_mask:0xf bank_mask:0xf
    s_lshr_b64 s[52:53], s[52:53], 1
    v_cndmask_b32_dpp v86, v86, v86, vcc wave_shr:1 row_mask:0xf bank_mask:0xf
    v_cndmask_b32_dpp v87, v87, v87, vcc wave_shr:1 row_mask:0xf bank_mask:0xf
    s_andn2_b64 s[82:83], s[82:83], s[52:53]
    v_cndmask_b32_dpp v7, v7, v7, vcc wave_shr:1 row_mask:0xf bank_mask:0xf
    s_mov_b64 exec, s[50:51]
    s_cbranch_scc0 L2_d58
    s_mov_b64 exec, s[82:83]
    s_nop 1
    v_mfma_f32_4x4x4_16b_bf16 v[88:91], v[12:13], v[84:85], 0
    s_nop 1
    v_mfma_f32_4x4x4_16b_bf16 v[88:91], v[10:11], v[86:87], v[88:91]
    s_nop 4
    v_cvt_pk_bf16_f32 v88, v88, v89
    v_cvt_pk_bf16_f32 v89, v90, v91
    ds_pk_add_bf16 v7, v88 offset:65408
    ds_pk_add_bf16 v7, v89 offset:65412
    s_mov_b64 exec, s[50:51]
    s_branch L2_d58
L2_c59:
    s_lshl_b64 s[52:53], s[82:83], 1
    s_andn2_b64 s[52:53], s[52:53], s[80:81]
    s_andn2_b64 s[52:53], s[52:53], s[54:55]
    s_or_b64 s[80:81], s[80:81], s[52:53]
    s_not_b64 vcc, s[52:53]
    s_mov_b64 exec, -1
    v_cndmask_b32_dpp v84, v84, v84, vcc wave_shr:1 row_mask:0xf bank_mask:0xf
    v_cndmask_b32_dpp v85, v85, v85, vcc wave_shr:1 row_mask:0xf bank_mask:0xf
    s_lshr_b64 s[52:53], s[52:53], 1
    v_cndmask_b32_dpp v86, v86, v86, vcc wave_shr:1 row_mask:0xf bank_mask:0xf
    v_cndmask_b32_dpp v87, v87, v87, vcc wave_shr:1 row_mask:0xf bank_mask:0xf
    s_andn2_b64 s[82:83], s[82:83], s[52:53]
    v_cndmask_b32_dpp v7, v7, v7, vcc wave_shr:1 row_mask:0xf bank_mask:0xf
    s_mov_b64 exec, s[54:55]
    s_cbranch_scc0 L2_d59
    s_mov_b64 exec, s[82:83]
    s_nop 1
    v_mfma_f32_4x4x4_16b_bf16 v[88:91], v[12:13], v[84:85], 0
    s_nop 1
    v_mfma_f32_4x4x4_16b_bf16 v[88:91], v[10:11], v[86:87], v[88:91]
    s_nop 4
    v_cvt_pk_bf16_f32 v88, v88, v89
    v_cvt_pk_bf16_f32 v89, v90, v91
    ds_pk_add_bf16 v7, v88 offset:65408
    ds_pk_add_bf16 v7, v89 offset:65412
    s_mov_b64 exec, s[54:55]
    s_branch L2_d59
L2_c60:
    s_lshl_b64 s[52:53], s[82:83], 1
    s_andn2_b64 s[52:53], s[52:53], s[80:81]
    s_andn2_b64 s[52:53], s[52:53], s[50:51]
    s_or_b64 s[80:81], s[80:81], s[52:53]
    s_not_b64 vcc, s[52:53]
    s_mov_b64 exec, -1
    v_cndmask_b32_dpp v84, v84, v84, vcc wave_shr:1 row_mask:0xf bank_mask:0xf
    v_cndmask_b32_dpp v85, v85, v85, vcc wave_shr:1 row_mask:0xf bank_mask:0xf
    s_lshr_b64 s[52:53], s[52:53], 1
    v_cndmask_b32_dpp v86, v86, v86, vcc wave_shr:1 row_mask:0xf bank_mask:0xf
    v_cndmask_b32_dpp v87, v87, v87, vcc wave_shr:1 row_mask:0xf bank_mask:0xf
    s_andn2_b64 s[82:83], s[82:83], s[52:53]
    v_cndmask_b32_dpp v7, v7, v7, vcc wave_shr:1 row_mask:0xf bank_mask:0xf
    s_mov_b64 exec, s[50:51]
    s_cbranch_scc0 L2_d60
    s_mov_b64 exec, s[82:83]
    s_nop 1
    v_mfma_f32_4x4x4_16b_bf16 v[88:91], v[12:13], v[84:85], 0
    s_nop 1
    v_mfma_f32_4x4x4_16b_bf16 v[88:91], v[10:11], v[86:87], v[88:91]
    s_nop 4
    v_cvt_pk_bf16_f32 v88, v88, v89
    v_cvt_pk_bf16_f32 v89, v90, v91
    ds_pk_add_bf16 v7, v88 offset:65408
    ds_pk_add_bf16 v7, v89 offset:65412
    s_mov_b64 exec, s[50:51]
    s_branch L2_d60
L2_xa61:
    s_cmp_eq_u32 s101, 1
    s_cbranch_scc1 L2_xc61
    v_lshlrev_b32 v89, 0, v96
    v_add_u32 v90, 140, v97
    v_bitop3_b32 v90, v89, v45, v90 bitop3:0x6a
    ds_write_b32 v98, v90 offset:28
    v_lshlrev_b32 v89, 4, v96
    v_add_u32 v90, 120, v97
    v_bitop3_b32 v90, v89, v45, v90 bitop3:0x6a
    ds_write_b32 v98, v90 offset:24
    v_lshlrev_b32 v89, 8, v96
    v_add_u32 v90, 100, v97
    v_bitop3_b32 v90, v89, v45, v90 bitop3:0x6a
    ds_write_b32 v98, v90 offset:20
L2_xc61:
    v_lshlrev_b32 v89, 12, v96
    v_add_u32 v90, 80, v97
    v_bitop3_b32 v90, v89, v45, v90 bitop3:0x6a
    ds_write_b32 v98, v90 offset:16
    s_branch L2_xb61
L2_xe61:
    v_cmp_lt_u32 vcc, 32, v99
    v_cmp_lt_u32 s[58:59], 31, v88
    v_lshrrev_b32 v89, 16, v96
    v_add_u32 v97, 80, v97
    s_or_b64 vcc, vcc, s[58:59]
    s_cbranch_scc1 L2_xs61
    v_lshlrev_b32 v89, v1, v89
    v_and_b32 v89, v45, v89
    v_cmp_ne_u32 vcc, 0, v89
    v_xor_b32 v90, v97, v89
    s_add_u32 s3, s37, s38
    v_mbcnt_lo_u32_b32 v98, vcc_lo, 0
    v_mbcnt_hi_u32_b32 v98, vcc_hi, v98
    s_bcnt1_i32_b64 s41, vcc
    v_lshl_add_u32 v98, v98, 2, s3
    s_lshl2_add_u32 s37, s41, s37
    s_mov_b64 exec, vcc
    ds_write_b32 v98, v90
    s_mov_b64 exec, -1
    s_branch L2_xr61
L2_xs61:
    s_waitcnt lgkmcnt(0)
    s_mov_b32 s37, 0x10000
    s_branch L2_xw61
L2_c62:
    s_lshl_b64 s[52:53], s[82:83], 1
    s_andn2_b64 s[52:53], s[52:53], s[80:81]
    s_andn2_b64 s[52:53], s[52:53], s[54:55]
    s_or_b64 s[80:81], s[80:81], s[52:53]
    s_not_b64 vcc, s[52:53]
    s_mov_b64 exec, -1
    v_cndmask_b32_dpp v84, v84, v84, vcc wave_shr:1 row_mask:0xf bank_mask:0xf
    v_cndmask_b32_dpp v85, v85, v85, vcc wave_shr:1 row_mask:0xf bank_mask:0xf
    s_lshr_b64 s[52:53], s[52:53], 1
    v_cndmask_b32_dpp v86, v86, v86, vcc wave_shr:1 row_mask:0xf bank_mask:0xf
    v_cndmask_b32_dpp v87, v87, v87, vcc wave_shr:1 row_mask:0xf bank_mask:0xf
    s_andn2_b64 s[82:83], s[82:83], s[52:53]
    v_cndmask_b32_dpp v7, v7, v7, vcc wave_shr:1 row_mask:0xf bank_mask:0xf
    s_mov_b64 exec, s[54:55]
    s_cbranch_scc0 L2_d62
    s_mov_b64 exec, s[82:83]
    s_nop 1
    v_mfma_f32_4x4x4_16b_bf16 v[88:91], v[12:13], v[84:85], 0
    s_nop 1
    v_mfma_f32_4x4x4_16b_bf16 v[88:91], v[10:11], v[86:87], v[88:91]
    s_nop 4
    v_cvt_pk_bf16_f32 v88, v88, v89
    v_cvt_pk_bf16_f32 v89, v90, v91
    ds_pk_add_bf16 v7, v88 offset:65408
    ds_pk_add_bf16 v7, v89 offset:65412
    s_mov_b64 exec, s[54:55]
    s_branch L2_d62
L2_c63:
    s_lshl_b64 s[52:53], s[82:83], 1
    s_andn2_b64 s[52:53], s[52:53], s[80:81]
    s_andn2_b64 s[52:53], s[52:53], s[50:51]
    s_or_b64 s[80:81], s[80:81], s[52:53]
    s_not_b64 vcc, s[52:53]
    s_mov_b64 exec, -1
    v_cndmask_b32_dpp v84, v84, v84, vcc wave_shr:1 row_mask:0xf bank_mask:0xf
    v_cndmask_b32_dpp v85, v85, v85, vcc wave_shr:1 row_mask:0xf bank_mask:0xf
    s_lshr_b64 s[52:53], s[52:53], 1
    v_cndmask_b32_dpp v86, v86, v86, vcc wave_shr:1 row_mask:0xf bank_mask:0xf
    v_cndmask_b32_dpp v87, v87, v87, vcc wave_shr:1 row_mask:0xf bank_mask:0xf
    s_andn2_b64 s[82:83], s[82:83], s[52:53]
    v_cndmask_b32_dpp v7, v7, v7, vcc wave_shr:1 row_mask:0xf bank_mask:0xf
    s_mov_b64 exec, s[50:51]
    s_cbranch_scc0 L2_d63
    s_mov_b64 exec, s[82:83]
    s_nop 1
    v_mfma_f32_4x4x4_16b_bf16 v[88:91], v[12:13], v[84:85], 0
    s_nop 1
    v_mfma_f32_4x4x4_16b_bf16 v[88:91], v[10:11], v[86:87], v[88:91]
    s_nop 4
    v_cvt_pk_bf16_f32 v88, v88, v89
    v_cvt_pk_bf16_f32 v89, v90, v91
    ds_pk_add_bf16 v7, v88 offset:65408
    ds_pk_add_bf16 v7, v89 offset:65412
    s_mov_b64 exec, s[50:51]
    s_branch L2_d63
L2_xf61:
    s_cmp_gt_u32 s37, 1024
    s_cbranch_scc1 L2_xt61
    s_cmp_lt_u32 s37, 768
    s_cbranch_scc1 L2_xl61
    ds_read_b32 v20, v44 offset:896
    s_add_u32 s3, s42, 2
    s_bitset1_b32 s43, s3
    s_branch L2_xg61
L2_xl61:
    s_waitcnt lgkmcnt(0)
    v_mov_b32 v19, -1
    s_cmp_ge_u32 s37, 512
    s_cbranch_scc1 L2_xg61
    v_mov_b32 v39, -1
    s_cmp_ge_u32 s37, 256
    s_cbranch_scc1 L2_xg61
    v_mov_b32 v33, -1
    s_branch L2_xg61
L2_xt61:
    s_waitcnt lgkmcnt(0)
    v_mov_b32 v27, -1
    v_mov_b32 v33, -1
    v_mov_b32 v39, -1
    v_mov_b32 v19, -1
    s_add_u32 s3, s42, 2
    s_bitset1_b32 s36, s3
    s_branch L2_xg61
L2_oa64:
    v_and_b32 v47, 0x0fffffff, v21
    buffer_load_dword v114, v47, s[8:11], 0 offen offset:16
    s_mov_b64 exec, s[6:7]
    v_add_u32 v47, 8, v47
    v_lshrrev_b32 v21, 2, v21
    s_mov_b64 exec, -1
    buffer_load_dwordx2 v[112:113], v47, s[8:11], 0 offen
    s_branch L2_ob64
L2_c65:
    s_lshl_b64 s[52:53], s[82:83], 1
    s_andn2_b64 s[52:53], s[52:53], s[80:81]
    s_andn2_b64 s[52:53], s[52:53], s[54:55]
    s_or_b64 s[80:81], s[80:81], s[52:53]
    s_not_b64 vcc, s[52:53]
    s_mov_b64 exec, -1
    v_cndmask_b32_dpp v84, v84, v84, vcc wave_shr:1 row_mask:0xf bank_mask:0xf
    v_cndmask_b32_dpp v85, v85, v85, vcc wave_shr:1 row_mask:0xf bank_mask:0xf
    s_lshr_b64 s[52:53], s[52:53], 1
    v_cndmask_b32_dpp v86, v86, v86, vcc wave_shr:1 row_mask:0xf bank_mask:0xf
    v_cndmask_b32_dpp v87, v87, v87, vcc wave_shr:1 row_mask:0xf bank_mask:0xf
    s_andn2_b64 s[82:83], s[82:83], s[52:53]
    v_cndmask_b32_dpp v7, v7, v7, vcc wave_shr:1 row_mask:0xf bank_mask:0xf
    s_mov_b64 exec, s[54:55]
    s_cbranch_scc0 L2_d65
    s_mov_b64 exec, s[82:83]
    s_nop 1
    v_mfma_f32_4x4x4_16b_bf16 v[88:91], v[12:13], v[84:85], 0
    s_nop 1
    v_mfma_f32_4x4x4_16b_bf16 v[88:91], v[10:11], v[86:87], v[88:91]
    s_nop 4
    v_cvt_pk_bf16_f32 v88, v88, v89
    v_cvt_pk_bf16_f32 v89, v90, v91
    ds_pk_add_bf16 v7, v88 offset:65408
    ds_pk_add_bf16 v7, v89 offset:65412
    s_mov_b64 exec, s[54:55]
    s_branch L2_d65
L2_c66:
    s_lshl_b64 s[52:53], s[82:83], 1
    s_andn2_b64 s[52:53], s[52:53], s[80:81]
    s_andn2_b64 s[52:53], s[52:53], s[50:51]
    s_or_b64 s[80:81], s[80:81], s[52:53]
    s_not_b64 vcc, s[52:53]
    s_mov_b64 exec, -1
    v_cndmask_b32_dpp v84, v84, v84, vcc wave_shr:1 row_mask:0xf bank_mask:0xf
    v_cndmask_b32_dpp v85, v85, v85, vcc wave_shr:1 row_mask:0xf bank_mask:0xf
    s_lshr_b64 s[52:53], s[52:53], 1
    v_cndmask_b32_dpp v86, v86, v86, vcc wave_shr:1 row_mask:0xf bank_mask:0xf
    v_cndmask_b32_dpp v87, v87, v87, vcc wave_shr:1 row_mask:0xf bank_mask:0xf
    s_andn2_b64 s[82:83], s[82:83], s[52:53]
    v_cndmask_b32_dpp v7, v7, v7, vcc wave_shr:1 row_mask:0xf bank_mask:0xf
    s_mov_b64 exec, s[50:51]
    s_cbranch_scc0 L2_d66
    s_mov_b64 exec, s[82:83]
    s_nop 1
    v_mfma_f32_4x4x4_16b_bf16 v[88:91], v[12:13], v[84:85], 0
    s_nop 1
    v_mfma_f32_4x4x4_16b_bf16 v[88:91], v[10:11], v[86:87], v[88:91]
    s_nop 4
    v_cvt_pk_bf16_f32 v88, v88, v89
    v_cvt_pk_bf16_f32 v89, v90, v91
    ds_pk_add_bf16 v7, v88 offset:65408
    ds_pk_add_bf16 v7, v89 offset:65412
    s_mov_b64 exec, s[50:51]
    s_branch L2_d66
L2_c67:
    s_lshl_b64 s[52:53], s[82:83], 1
    s_andn2_b64 s[52:53], s[52:53], s[80:81]
    s_andn2_b64 s[52:53], s[52:53], s[54:55]
    s_or_b64 s[80:81], s[80:81], s[52:53]
    s_not_b64 vcc, s[52:53]
    s_mov_b64 exec, -1
    v_cndmask_b32_dpp v84, v84, v84, vcc wave_shr:1 row_mask:0xf bank_mask:0xf
    v_cndmask_b32_dpp v85, v85, v85, vcc wave_shr:1 row_mask:0xf bank_mask:0xf
    s_lshr_b64 s[52:53], s[52:53], 1
    v_cndmask_b32_dpp v86, v86, v86, vcc wave_shr:1 row_mask:0xf bank_mask:0xf
    v_cndmask_b32_dpp v87, v87, v87, vcc wave_shr:1 row_mask:0xf bank_mask:0xf
    s_andn2_b64 s[82:83], s[82:83], s[52:53]
    v_cndmask_b32_dpp v7, v7, v7, vcc wave_shr:1 row_mask:0xf bank_mask:0xf
    s_mov_b64 exec, s[54:55]
    s_cbranch_scc0 L2_d67
    s_mov_b64 exec, s[82:83]
    s_nop 1
    v_mfma_f32_4x4x4_16b_bf16 v[88:91], v[12:13], v[84:85], 0
    s_nop 1
    v_mfma_f32_4x4x4_16b_bf16 v[88:91], v[10:11], v[86:87], v[88:91]
    s_nop 4
    v_cvt_pk_bf16_f32 v88, v88, v89
    v_cvt_pk_bf16_f32 v89, v90, v91
    ds_pk_add_bf16 v7, v88 offset:65408
    ds_pk_add_bf16 v7, v89 offset:65412
    s_mov_b64 exec, s[54:55]
    s_branch L2_d67
L2_c68:
    s_lshl_b64 s[52:53], s[82:83], 1
    s_andn2_b64 s[52:53], s[52:53], s[80:81]
    s_andn2_b64 s[52:53], s[52:53], s[50:51]
    s_or_b64 s[80:81], s[80:81], s[52:53]
    s_not_b64 vcc, s[52:53]
    s_mov_b64 exec, -1
    v_cndmask_b32_dpp v84, v84, v84, vcc wave_shr:1 row_mask:0xf bank_mask:0xf
    v_cndmask_b32_dpp v85, v85, v85, vcc wave_shr:1 row_mask:0xf bank_mask:0xf
    s_lshr_b64 s[52:53], s[52:53], 1
    v_cndmask_b32_dpp v86, v86, v86, vcc wave_shr:1 row_mask:0xf bank_mask:0xf
    v_cndmask_b32_dpp v87, v87, v87, vcc wave_shr:1 row_mask:0xf bank_mask:0xf
    s_andn2_b64 s[82:83], s[82:83], s[52:53]
    v_cndmask_b32_dpp v7, v7, v7, vcc wave_shr:1 row_mask:0xf bank_mask:0xf
    s_mov_b64 exec, s[50:51]
    s_cbranch_scc0 L2_d68
    s_mov_b64 exec, s[82:83]
    s_nop 1
    v_mfma_f32_4x4x4_16b_bf16 v[88:91], v[12:13], v[84:85], 0
    s_nop 1
    v_mfma_f32_4x4x4_16b_bf16 v[88:91], v[10:11], v[86:87], v[88:91]
    s_nop 4
    v_cvt_pk_bf16_f32 v88, v88, v89
    v_cvt_pk_bf16_f32 v89, v90, v91
    ds_pk_add_bf16 v7, v88 offset:65408
    ds_pk_add_bf16 v7, v89 offset:65412
    s_mov_b64 exec, s[50:51]
    s_branch L2_d68
L2_c69:
    s_lshl_b64 s[52:53], s[82:83], 1
    s_andn2_b64 s[52:53], s[52:53], s[80:81]
    s_andn2_b64 s[52:53], s[52:53], s[54:55]
    s_or_b64 s[80:81], s[80:81], s[52:53]
    s_not_b64 vcc, s[52:53]
    s_mov_b64 exec, -1
    v_cndmask_b32_dpp v84, v84, v84, vcc wave_shr:1 row_mask:0xf bank_mask:0xf
    v_cndmask_b32_dpp v85, v85, v85, vcc wave_shr:1 row_mask:0xf bank_mask:0xf
    s_lshr_b64 s[52:53], s[52:53], 1
    v_cndmask_b32_dpp v86, v86, v86, vcc wave_shr:1 row_mask:0xf bank_mask:0xf
    v_cndmask_b32_dpp v87, v87, v87, vcc wave_shr:1 row_mask:0xf bank_mask:0xf
    s_andn2_b64 s[82:83], s[82:83], s[52:53]
    v_cndmask_b32_dpp v7, v7, v7, vcc wave_shr:1 row_mask:0xf bank_mask:0xf
    s_mov_b64 exec, s[54:55]
    s_cbranch_scc0 L2_d69
    s_mov_b64 exec, s[82:83]
    s_nop 1
    v_mfma_f32_4x4x4_16b_bf16 v[88:91], v[12:13], v[84:85], 0
    s_nop 1
    v_mfma_f32_4x4x4_16b_bf16 v[88:91], v[10:11], v[86:87], v[88:91]
    s_nop 4
    v_cvt_pk_bf16_f32 v88, v88, v89
    v_cvt_pk_bf16_f32 v89, v90, v91
    ds_pk_add_bf16 v7, v88 offset:65408
    ds_pk_add_bf16 v7, v89 offset:65412
    s_mov_b64 exec, s[54:55]
    s_branch L2_d69
L2_c70:
    s_lshl_b64 s[52:53], s[82:83], 1
    s_andn2_b64 s[52:53], s[52:53], s[80:81]
    s_andn2_b64 s[52:53], s[52:53], s[50:51]
    s_or_b64 s[80:81], s[80:81], s[52:53]
    s_not_b64 vcc, s[52:53]
    s_mov_b64 exec, -1
    v_cndmask_b32_dpp v84, v84, v84, vcc wave_shr:1 row_mask:0xf bank_mask:0xf
    v_cndmask_b32_dpp v85, v85, v85, vcc wave_shr:1 row_mask:0xf bank_mask:0xf
    s_lshr_b64 s[52:53], s[52:53], 1
    v_cndmask_b32_dpp v86, v86, v86, vcc wave_shr:1 row_mask:0xf bank_mask:0xf
    v_cndmask_b32_dpp v87, v87, v87, vcc wave_shr:1 row_mask:0xf bank_mask:0xf
    s_andn2_b64 s[82:83], s[82:83], s[52:53]
    v_cndmask_b32_dpp v7, v7, v7, vcc wave_shr:1 row_mask:0xf bank_mask:0xf
    s_mov_b64 exec, s[50:51]
    s_cbranch_scc0 L2_d70
    s_mov_b64 exec, s[82:83]
    s_nop 1
    v_mfma_f32_4x4x4_16b_bf16 v[88:91], v[12:13], v[84:85], 0
    s_nop 1
    v_mfma_f32_4x4x4_16b_bf16 v[88:91], v[10:11], v[86:87], v[88:91]
    s_nop 4
    v_cvt_pk_bf16_f32 v88, v88, v89
    v_cvt_pk_bf16_f32 v89, v90, v91
    ds_pk_add_bf16 v7, v88 offset:65408
    ds_pk_add_bf16 v7, v89 offset:65412
    s_mov_b64 exec, s[50:51]
    s_branch L2_d70
L2_c71:
    s_lshl_b64 s[52:53], s[82:83], 1
    s_andn2_b64 s[52:53], s[52:53], s[80:81]
    s_andn2_b64 s[52:53], s[52:53], s[54:55]
    s_or_b64 s[80:81], s[80:81], s[52:53]
    s_not_b64 vcc, s[52:53]
    s_mov_b64 exec, -1
    v_cndmask_b32_dpp v84, v84, v84, vcc wave_shr:1 row_mask:0xf bank_mask:0xf
    v_cndmask_b32_dpp v85, v85, v85, vcc wave_shr:1 row_mask:0xf bank_mask:0xf
    s_lshr_b64 s[52:53], s[52:53], 1
    v_cndmask_b32_dpp v86, v86, v86, vcc wave_shr:1 row_mask:0xf bank_mask:0xf
    v_cndmask_b32_dpp v87, v87, v87, vcc wave_shr:1 row_mask:0xf bank_mask:0xf
    s_andn2_b64 s[82:83], s[82:83], s[52:53]
    v_cndmask_b32_dpp v7, v7, v7, vcc wave_shr:1 row_mask:0xf bank_mask:0xf
    s_mov_b64 exec, s[54:55]
    s_cbranch_scc0 L2_d71
    s_mov_b64 exec, s[82:83]
    s_nop 1
    v_mfma_f32_4x4x4_16b_bf16 v[88:91], v[12:13], v[84:85], 0
    s_nop 1
    v_mfma_f32_4x4x4_16b_bf16 v[88:91], v[10:11], v[86:87], v[88:91]
    s_nop 4
    v_cvt_pk_bf16_f32 v88, v88, v89
    v_cvt_pk_bf16_f32 v89, v90, v91
    ds_pk_add_bf16 v7, v88 offset:65408
    ds_pk_add_bf16 v7, v89 offset:65412
    s_mov_b64 exec, s[54:55]
    s_branch L2_d71
L2_c72:
    s_lshl_b64 s[52:53], s[82:83], 1
    s_andn2_b64 s[52:53], s[52:53], s[80:81]
    s_andn2_b64 s[52:53], s[52:53], s[50:51]
    s_or_b64 s[80:81], s[80:81], s[52:53]
    s_not_b64 vcc, s[52:53]
    s_mov_b64 exec, -1
    v_cndmask_b32_dpp v84, v84, v84, vcc wave_shr:1 row_mask:0xf bank_mask:0xf
    v_cndmask_b32_dpp v85, v85, v85, vcc wave_shr:1 row_mask:0xf bank_mask:0xf
    s_lshr_b64 s[52:53], s[52:53], 1
    v_cndmask_b32_dpp v86, v86, v86, vcc wave_shr:1 row_mask:0xf bank_mask:0xf
    v_cndmask_b32_dpp v87, v87, v87, vcc wave_shr:1 row_mask:0xf bank_mask:0xf
    s_andn2_b64 s[82:83], s[82:83], s[52:53]
    v_cndmask_b32_dpp v7, v7, v7, vcc wave_shr:1 row_mask:0xf bank_mask:0xf
    s_mov_b64 exec, s[50:51]
    s_cbranch_scc0 L2_d72
    s_mov_b64 exec, s[82:83]
    s_nop 1
    v_mfma_f32_4x4x4_16b_bf16 v[88:91], v[12:13], v[84:85], 0
    s_nop 1
    v_mfma_f32_4x4x4_16b_bf16 v[88:91], v[10:11], v[86:87], v[88:91]
    s_nop 4
    v_cvt_pk_bf16_f32 v88, v88, v89
    v_cvt_pk_bf16_f32 v89, v90, v91
    ds_pk_add_bf16 v7, v88 offset:65408
    ds_pk_add_bf16 v7, v89 offset:65412
    s_mov_b64 exec, s[50:51]
    s_branch L2_d72
L2_oa73:
    s_waitcnt vmcnt(5)
    s_mov_b64 exec, s[6:7]
    v_lshrrev_b32 v114, 16, v114
    s_mov_b64 exec, -1
    v_and_b32 v46, 0x10000000, v21
    v_cmpx_eq_u32 vcc, 0, v46
    v_lshrrev_b32 v47, 14, v112
    v_and_b32 v47, v5, v47
    ds_read_b64 v[96:97], v47
    v_perm_b32 v98, v112, v114, s44
    v_bitop3_b32 v99, v112, 0.5, -0.5 bitop3:0xa8
    v_bitop3_b32 v98, v6, v98, v99 bitop3:0xca
    v_and_b32 v47, v5, v112
    s_waitcnt lgkmcnt(0)
    v_mfma_f32_4x4x4_16b_bf16 v[88:91], v[8:9], v[96:97], 0
    s_nop 4
    v_mul_f32 v88, v98, v88
    v_mul_f32 v89, v98, v89
    v_mul_f32 v90, v98, v90
    v_mul_f32 v91, v98, v91
    v_cvt_pk_bf16_f32 v88, v88, v89
    v_cvt_pk_bf16_f32 v89, v90, v91
    ds_pk_add_bf16 v47, v88 offset:65408
    ds_pk_add_bf16 v47, v89 offset:65412
    s_mov_b64 exec, -1
    v_and_b32 v46, 0x20000000, v21
    v_cmpx_eq_u32 vcc, 0, v46
    v_lshrrev_b32 v47, 14, v113
    v_and_b32 v47, v5, v47
    ds_read_b64 v[96:97], v47
    v_perm_b32 v98, v113, v114, s45
    v_bitop3_b32 v99, v113, 0.5, -0.5 bitop3:0xa8
    v_bitop3_b32 v98, v6, v98, v99 bitop3:0xca
    v_and_b32 v47, v5, v113
    s_waitcnt lgkmcnt(0)
    v_mfma_f32_4x4x4_16b_bf16 v[88:91], v[8:9], v[96:97], 0
    s_nop 4
    v_mul_f32 v88, v98, v88
    v_mul_f32 v89, v98, v89
    v_mul_f32 v90, v98, v90
    v_mul_f32 v91, v98, v91
    v_cvt_pk_bf16_f32 v88, v88, v89
    v_cvt_pk_bf16_f32 v89, v90, v91
    ds_pk_add_bf16 v47, v88 offset:65408
    ds_pk_add_bf16 v47, v89 offset:65412
    s_mov_b64 exec, -1
    s_branch L2_ob73
L2_xo74:
    v_cmp_lt_u32 vcc, 20, v99
    s_mov_b32 s101, 1
    s_cbranch_vccz L2_xp74
    v_cmp_lt_u32 vcc, 32, v99
    v_cmp_lt_u32 s[58:59], 31, v88
    s_mov_b32 s101, 2
    s_or_b64 vcc, vcc, s[58:59]
    s_cbranch_scc0 L2_xp74
    s_mov_b32 s37, 0x10000
    s_branch L2_xp74
L2_c75:
    s_lshl_b64 s[52:53], s[82:83], 1
    s_andn2_b64 s[52:53], s[52:53], s[80:81]
    s_andn2_b64 s[52:53], s[52:53], s[54:55]
    s_or_b64 s[80:81], s[80:81], s[52:53]
    s_not_b64 vcc, s[52:53]
    s_mov_b64 exec, -1
    v_cndmask_b32_dpp v84, v84, v84, vcc wave_shr:1 row_mask:0xf bank_mask:0xf
    v_cndmask_b32_dpp v85, v85, v85, vcc wave_shr:1 row_mask:0xf bank_mask:0xf
    s_lshr_b64 s[52:53], s[52:53], 1
    v_cndmask_b32_dpp v86, v86, v86, vcc wave_shr:1 row_mask:0xf bank_mask:0xf
    v_cndmask_b32_dpp v87, v87, v87, vcc wave_shr:1 row_mask:0xf bank_mask:0xf
    s_andn2_b64 s[82:83], s[82:83], s[52:53]
    v_cndmask_b32_dpp v7, v7, v7, vcc wave_shr:1 row_mask:0xf bank_mask:0xf
    s_mov_b64 exec, s[54:55]
    s_cbranch_scc0 L2_d75
    s_mov_b64 exec, s[82:83]
    s_nop 1
    v_mfma_f32_4x4x4_16b_bf16 v[88:91], v[12:13], v[84:85], 0
    s_nop 1
    v_mfma_f32_4x4x4_16b_bf16 v[88:91], v[10:11], v[86:87], v[88:91]
    s_nop 4
    v_cvt_pk_bf16_f32 v88, v88, v89
    v_cvt_pk_bf16_f32 v89, v90, v91
    ds_pk_add_bf16 v7, v88 offset:65408
    ds_pk_add_bf16 v7, v89 offset:65412
    s_mov_b64 exec, s[54:55]
    s_branch L2_d75
L2_c76:
    s_lshl_b64 s[52:53], s[82:83], 1
    s_andn2_b64 s[52:53], s[52:53], s[80:81]
    s_andn2_b64 s[52:53], s[52:53], s[50:51]
    s_or_b64 s[80:81], s[80:81], s[52:53]
    s_not_b64 vcc, s[52:53]
    s_mov_b64 exec, -1
    v_cndmask_b32_dpp v84, v84, v84, vcc wave_shr:1 row_mask:0xf bank_mask:0xf
    v_cndmask_b32_dpp v85, v85, v85, vcc wave_shr:1 row_mask:0xf bank_mask:0xf
    s_lshr_b64 s[52:53], s[52:53], 1
    v_cndmask_b32_dpp v86, v86, v86, vcc wave_shr:1 row_mask:0xf bank_mask:0xf
    v_cndmask_b32_dpp v87, v87, v87, vcc wave_shr:1 row_mask:0xf bank_mask:0xf
    s_andn2_b64 s[82:83], s[82:83], s[52:53]
    v_cndmask_b32_dpp v7, v7, v7, vcc wave_shr:1 row_mask:0xf bank_mask:0xf
    s_mov_b64 exec, s[50:51]
    s_cbranch_scc0 L2_d76
    s_mov_b64 exec, s[82:83]
    s_nop 1
    v_mfma_f32_4x4x4_16b_bf16 v[88:91], v[12:13], v[84:85], 0
    s_nop 1
    v_mfma_f32_4x4x4_16b_bf16 v[88:91], v[10:11], v[86:87], v[88:91]
    s_nop 4
    v_cvt_pk_bf16_f32 v88, v88, v89
    v_cvt_pk_bf16_f32 v89, v90, v91
    ds_pk_add_bf16 v7, v88 offset:65408
    ds_pk_add_bf16 v7, v89 offset:65412
    s_mov_b64 exec, s[50:51]
    s_branch L2_d76
L2_c77:
    s_lshl_b64 s[52:53], s[82:83], 1
    s_andn2_b64 s[52:53], s[52:53], s[80:81]
    s_andn2_b64 s[52:53], s[52:53], s[54:55]
    s_or_b64 s[80:81], s[80:81], s[52:53]
    s_not_b64 vcc, s[52:53]
    s_mov_b64 exec, -1
    v_cndmask_b32_dpp v84, v84, v84, vcc wave_shr:1 row_mask:0xf bank_mask:0xf
    v_cndmask_b32_dpp v85, v85, v85, vcc wave_shr:1 row_mask:0xf bank_mask:0xf
    s_lshr_b64 s[52:53], s[52:53], 1
    v_cndmask_b32_dpp v86, v86, v86, vcc wave_shr:1 row_mask:0xf bank_mask:0xf
    v_cndmask_b32_dpp v87, v87, v87, vcc wave_shr:1 row_mask:0xf bank_mask:0xf
    s_andn2_b64 s[82:83], s[82:83], s[52:53]
    v_cndmask_b32_dpp v7, v7, v7, vcc wave_shr:1 row_mask:0xf bank_mask:0xf
    s_mov_b64 exec, s[54:55]
    s_cbranch_scc0 L2_d77
    s_mov_b64 exec, s[82:83]
    s_nop 1
    v_mfma_f32_4x4x4_16b_bf16 v[88:91], v[12:13], v[84:85], 0
    s_nop 1
    v_mfma_f32_4x4x4_16b_bf16 v[88:91], v[10:11], v[86:87], v[88:91]
    s_nop 4
    v_cvt_pk_bf16_f32 v88, v88, v89
    v_cvt_pk_bf16_f32 v89, v90, v91
    ds_pk_add_bf16 v7, v88 offset:65408
    ds_pk_add_bf16 v7, v89 offset:65412
    s_mov_b64 exec, s[54:55]
    s_branch L2_d77
L2_c78:
    s_lshl_b64 s[52:53], s[82:83], 1
    s_andn2_b64 s[52:53], s[52:53], s[80:81]
    s_andn2_b64 s[52:53], s[52:53], s[50:51]
    s_or_b64 s[80:81], s[80:81], s[52:53]
    s_not_b64 vcc, s[52:53]
    s_mov_b64 exec, -1
    v_cndmask_b32_dpp v84, v84, v84, vcc wave_shr:1 row_mask:0xf bank_mask:0xf
    v_cndmask_b32_dpp v85, v85, v85, vcc wave_shr:1 row_mask:0xf bank_mask:0xf
    s_lshr_b64 s[52:53], s[52:53], 1
    v_cndmask_b32_dpp v86, v86, v86, vcc wave_shr:1 row_mask:0xf bank_mask:0xf
    v_cndmask_b32_dpp v87, v87, v87, vcc wave_shr:1 row_mask:0xf bank_mask:0xf
    s_andn2_b64 s[82:83], s[82:83], s[52:53]
    v_cndmask_b32_dpp v7, v7, v7, vcc wave_shr:1 row_mask:0xf bank_mask:0xf
    s_mov_b64 exec, s[50:51]
    s_cbranch_scc0 L2_d78
    s_mov_b64 exec, s[82:83]
    s_nop 1
    v_mfma_f32_4x4x4_16b_bf16 v[88:91], v[12:13], v[84:85], 0
    s_nop 1
    v_mfma_f32_4x4x4_16b_bf16 v[88:91], v[10:11], v[86:87], v[88:91]
    s_nop 4
    v_cvt_pk_bf16_f32 v88, v88, v89
    v_cvt_pk_bf16_f32 v89, v90, v91
    ds_pk_add_bf16 v7, v88 offset:65408
    ds_pk_add_bf16 v7, v89 offset:65412
    s_mov_b64 exec, s[50:51]
    s_branch L2_d78
L2_xa79:
    s_cmp_eq_u32 s101, 1
    s_cbranch_scc1 L2_xc79
    v_lshlrev_b32 v89, 0, v96
    v_add_u32 v90, 140, v97
    v_bitop3_b32 v90, v89, v45, v90 bitop3:0x6a
    ds_write_b32 v98, v90 offset:28
    v_lshlrev_b32 v89, 4, v96
    v_add_u32 v90, 120, v97
    v_bitop3_b32 v90, v89, v45, v90 bitop3:0x6a
    ds_write_b32 v98, v90 offset:24
    v_lshlrev_b32 v89, 8, v96
    v_add_u32 v90, 100, v97
    v_bitop3_b32 v90, v89, v45, v90 bitop3:0x6a
    ds_write_b32 v98, v90 offset:20
L2_xc79:
    v_lshlrev_b32 v89, 12, v96
    v_add_u32 v90, 80, v97
    v_bitop3_b32 v90, v89, v45, v90 bitop3:0x6a
    ds_write_b32 v98, v90 offset:16
    s_branch L2_xb79
L2_xe79:
    v_cmp_lt_u32 vcc, 32, v99
    v_cmp_lt_u32 s[58:59], 31, v88
    v_lshrrev_b32 v89, 16, v96
    v_add_u32 v97, 80, v97
    s_or_b64 vcc, vcc, s[58:59]
    s_cbranch_scc1 L2_xs79
    v_lshlrev_b32 v89, v1, v89
    v_and_b32 v89, v45, v89
    v_cmp_ne_u32 vcc, 0, v89
    v_xor_b32 v90, v97, v89
    s_add_u32 s3, s37, s38
    v_mbcnt_lo_u32_b32 v98, vcc_lo, 0
    v_mbcnt_hi_u32_b32 v98, vcc_hi, v98
    s_bcnt1_i32_b64 s41, vcc
    v_lshl_add_u32 v98, v98, 2, s3
    s_lshl2_add_u32 s37, s41, s37
    s_mov_b64 exec, vcc
    ds_write_b32 v98, v90
    s_mov_b64 exec, -1
    s_branch L2_xr79
L2_xs79:
    s_waitcnt lgkmcnt(0)
    s_mov_b32 s37, 0x10000
    s_branch L2_xw79
L2_c80:
    s_lshl_b64 s[52:53], s[82:83], 1
    s_andn2_b64 s[52:53], s[52:53], s[80:81]
    s_andn2_b64 s[52:53], s[52:53], s[54:55]
    s_or_b64 s[80:81], s[80:81], s[52:53]
    s_not_b64 vcc, s[52:53]
    s_mov_b64 exec, -1
    v_cndmask_b32_dpp v84, v84, v84, vcc wave_shr:1 row_mask:0xf bank_mask:0xf
    v_cndmask_b32_dpp v85, v85, v85, vcc wave_shr:1 row_mask:0xf bank_mask:0xf
    s_lshr_b64 s[52:53], s[52:53], 1
    v_cndmask_b32_dpp v86, v86, v86, vcc wave_shr:1 row_mask:0xf bank_mask:0xf
    v_cndmask_b32_dpp v87, v87, v87, vcc wave_shr:1 row_mask:0xf bank_mask:0xf
    s_andn2_b64 s[82:83], s[82:83], s[52:53]
    v_cndmask_b32_dpp v7, v7, v7, vcc wave_shr:1 row_mask:0xf bank_mask:0xf
    s_mov_b64 exec, s[54:55]
    s_cbranch_scc0 L2_d80
    s_mov_b64 exec, s[82:83]
    s_nop 1
    v_mfma_f32_4x4x4_16b_bf16 v[88:91], v[12:13], v[84:85], 0
    s_nop 1
    v_mfma_f32_4x4x4_16b_bf16 v[88:91], v[10:11], v[86:87], v[88:91]
    s_nop 4
    v_cvt_pk_bf16_f32 v88, v88, v89
    v_cvt_pk_bf16_f32 v89, v90, v91
    ds_pk_add_bf16 v7, v88 offset:65408
    ds_pk_add_bf16 v7, v89 offset:65412
    s_mov_b64 exec, s[54:55]
    s_branch L2_d80
L2_c81:
    s_lshl_b64 s[52:53], s[82:83], 1
    s_andn2_b64 s[52:53], s[52:53], s[80:81]
    s_andn2_b64 s[52:53], s[52:53], s[50:51]
    s_or_b64 s[80:81], s[80:81], s[52:53]
    s_not_b64 vcc, s[52:53]
    s_mov_b64 exec, -1
    v_cndmask_b32_dpp v84, v84, v84, vcc wave_shr:1 row_mask:0xf bank_mask:0xf
    v_cndmask_b32_dpp v85, v85, v85, vcc wave_shr:1 row_mask:0xf bank_mask:0xf
    s_lshr_b64 s[52:53], s[52:53], 1
    v_cndmask_b32_dpp v86, v86, v86, vcc wave_shr:1 row_mask:0xf bank_mask:0xf
    v_cndmask_b32_dpp v87, v87, v87, vcc wave_shr:1 row_mask:0xf bank_mask:0xf
    s_andn2_b64 s[82:83], s[82:83], s[52:53]
    v_cndmask_b32_dpp v7, v7, v7, vcc wave_shr:1 row_mask:0xf bank_mask:0xf
    s_mov_b64 exec, s[50:51]
    s_cbranch_scc0 L2_d81
    s_mov_b64 exec, s[82:83]
    s_nop 1
    v_mfma_f32_4x4x4_16b_bf16 v[88:91], v[12:13], v[84:85], 0
    s_nop 1
    v_mfma_f32_4x4x4_16b_bf16 v[88:91], v[10:11], v[86:87], v[88:91]
    s_nop 4
    v_cvt_pk_bf16_f32 v88, v88, v89
    v_cvt_pk_bf16_f32 v89, v90, v91
    ds_pk_add_bf16 v7, v88 offset:65408
    ds_pk_add_bf16 v7, v89 offset:65412
    s_mov_b64 exec, s[50:51]
    s_branch L2_d81
L2_xf79:
    s_cmp_gt_u32 s37, 1024
    s_cbranch_scc1 L2_xt79
    s_cmp_lt_u32 s37, 768
    s_cbranch_scc1 L2_xl79
    ds_read_b32 v21, v44 offset:896
    s_add_u32 s3, s42, 2
    s_bitset1_b32 s43, s3
    s_branch L2_xg79
L2_xl79:
    s_waitcnt lgkmcnt(0)
    v_mov_b32 v40, -1
    s_cmp_ge_u32 s37, 512
    s_cbranch_scc1 L2_xg79
    v_mov_b32 v43, -1
    s_cmp_ge_u32 s37, 256
    s_cbranch_scc1 L2_xg79
    v_mov_b32 v42, -1
    s_branch L2_xg79
L2_xt79:
    s_waitcnt lgkmcnt(0)
    v_mov_b32 v41, -1
    v_mov_b32 v42, -1
    v_mov_b32 v43, -1
    v_mov_b32 v40, -1
    s_add_u32 s3, s42, 2
    s_bitset1_b32 s36, s3
    s_branch L2_xg79
L2_oa82:
    v_and_b32 v47, 0x0fffffff, v20
    buffer_load_dword v114, v47, s[8:11], 0 offen offset:16
    s_mov_b64 exec, s[6:7]
    v_add_u32 v47, 8, v47
    v_lshrrev_b32 v20, 2, v20
    s_mov_b64 exec, -1
    buffer_load_dwordx2 v[112:113], v47, s[8:11], 0 offen
    s_branch L2_ob82
L2_c83:
    s_lshl_b64 s[52:53], s[82:83], 1
    s_andn2_b64 s[52:53], s[52:53], s[80:81]
    s_andn2_b64 s[52:53], s[52:53], s[54:55]
    s_or_b64 s[80:81], s[80:81], s[52:53]
    s_not_b64 vcc, s[52:53]
    s_mov_b64 exec, -1
    v_cndmask_b32_dpp v84, v84, v84, vcc wave_shr:1 row_mask:0xf bank_mask:0xf
    v_cndmask_b32_dpp v85, v85, v85, vcc wave_shr:1 row_mask:0xf bank_mask:0xf
    s_lshr_b64 s[52:53], s[52:53], 1
    v_cndmask_b32_dpp v86, v86, v86, vcc wave_shr:1 row_mask:0xf bank_mask:0xf
    v_cndmask_b32_dpp v87, v87, v87, vcc wave_shr:1 row_mask:0xf bank_mask:0xf
    s_andn2_b64 s[82:83], s[82:83], s[52:53]
    v_cndmask_b32_dpp v7, v7, v7, vcc wave_shr:1 row_mask:0xf bank_mask:0xf
    s_mov_b64 exec, s[54:55]
    s_cbranch_scc0 L2_d83
    s_mov_b64 exec, s[82:83]
    s_nop 1
    v_mfma_f32_4x4x4_16b_bf16 v[88:91], v[12:13], v[84:85], 0
    s_nop 1
    v_mfma_f32_4x4x4_16b_bf16 v[88:91], v[10:11], v[86:87], v[88:91]
    s_nop 4
    v_cvt_pk_bf16_f32 v88, v88, v89
    v_cvt_pk_bf16_f32 v89, v90, v91
    ds_pk_add_bf16 v7, v88 offset:65408
    ds_pk_add_bf16 v7, v89 offset:65412
    s_mov_b64 exec, s[54:55]
    s_branch L2_d83
L2_c84:
    s_lshl_b64 s[52:53], s[82:83], 1
    s_andn2_b64 s[52:53], s[52:53], s[80:81]
    s_andn2_b64 s[52:53], s[52:53], s[50:51]
    s_or_b64 s[80:81], s[80:81], s[52:53]
    s_not_b64 vcc, s[52:53]
    s_mov_b64 exec, -1
    v_cndmask_b32_dpp v84, v84, v84, vcc wave_shr:1 row_mask:0xf bank_mask:0xf
    v_cndmask_b32_dpp v85, v85, v85, vcc wave_shr:1 row_mask:0xf bank_mask:0xf
    s_lshr_b64 s[52:53], s[52:53], 1
    v_cndmask_b32_dpp v86, v86, v86, vcc wave_shr:1 row_mask:0xf bank_mask:0xf
    v_cndmask_b32_dpp v87, v87, v87, vcc wave_shr:1 row_mask:0xf bank_mask:0xf
    s_andn2_b64 s[82:83], s[82:83], s[52:53]
    v_cndmask_b32_dpp v7, v7, v7, vcc wave_shr:1 row_mask:0xf bank_mask:0xf
    s_mov_b64 exec, s[50:51]
    s_cbranch_scc0 L2_d84
    s_mov_b64 exec, s[82:83]
    s_nop 1
    v_mfma_f32_4x4x4_16b_bf16 v[88:91], v[12:13], v[84:85], 0
    s_nop 1
    v_mfma_f32_4x4x4_16b_bf16 v[88:91], v[10:11], v[86:87], v[88:91]
    s_nop 4
    v_cvt_pk_bf16_f32 v88, v88, v89
    v_cvt_pk_bf16_f32 v89, v90, v91
    ds_pk_add_bf16 v7, v88 offset:65408
    ds_pk_add_bf16 v7, v89 offset:65412
    s_mov_b64 exec, s[50:51]
    s_branch L2_d84
L2_c85:
    s_lshl_b64 s[52:53], s[82:83], 1
    s_andn2_b64 s[52:53], s[52:53], s[80:81]
    s_andn2_b64 s[52:53], s[52:53], s[54:55]
    s_or_b64 s[80:81], s[80:81], s[52:53]
    s_not_b64 vcc, s[52:53]
    s_mov_b64 exec, -1
    v_cndmask_b32_dpp v84, v84, v84, vcc wave_shr:1 row_mask:0xf bank_mask:0xf
    v_cndmask_b32_dpp v85, v85, v85, vcc wave_shr:1 row_mask:0xf bank_mask:0xf
    s_lshr_b64 s[52:53], s[52:53], 1
    v_cndmask_b32_dpp v86, v86, v86, vcc wave_shr:1 row_mask:0xf bank_mask:0xf
    v_cndmask_b32_dpp v87, v87, v87, vcc wave_shr:1 row_mask:0xf bank_mask:0xf
    s_andn2_b64 s[82:83], s[82:83], s[52:53]
    v_cndmask_b32_dpp v7, v7, v7, vcc wave_shr:1 row_mask:0xf bank_mask:0xf
    s_mov_b64 exec, s[54:55]
    s_cbranch_scc0 L2_d85
    s_mov_b64 exec, s[82:83]
    s_nop 1
    v_mfma_f32_4x4x4_16b_bf16 v[88:91], v[12:13], v[84:85], 0
    s_nop 1
    v_mfma_f32_4x4x4_16b_bf16 v[88:91], v[10:11], v[86:87], v[88:91]
    s_nop 4
    v_cvt_pk_bf16_f32 v88, v88, v89
    v_cvt_pk_bf16_f32 v89, v90, v91
    ds_pk_add_bf16 v7, v88 offset:65408
    ds_pk_add_bf16 v7, v89 offset:65412
    s_mov_b64 exec, s[54:55]
    s_branch L2_d85
L2_c86:
    s_lshl_b64 s[52:53], s[82:83], 1
    s_andn2_b64 s[52:53], s[52:53], s[80:81]
    s_andn2_b64 s[52:53], s[52:53], s[50:51]
    s_or_b64 s[80:81], s[80:81], s[52:53]
    s_not_b64 vcc, s[52:53]
    s_mov_b64 exec, -1
    v_cndmask_b32_dpp v84, v84, v84, vcc wave_shr:1 row_mask:0xf bank_mask:0xf
    v_cndmask_b32_dpp v85, v85, v85, vcc wave_shr:1 row_mask:0xf bank_mask:0xf
    s_lshr_b64 s[52:53], s[52:53], 1
    v_cndmask_b32_dpp v86, v86, v86, vcc wave_shr:1 row_mask:0xf bank_mask:0xf
    v_cndmask_b32_dpp v87, v87, v87, vcc wave_shr:1 row_mask:0xf bank_mask:0xf
    s_andn2_b64 s[82:83], s[82:83], s[52:53]
    v_cndmask_b32_dpp v7, v7, v7, vcc wave_shr:1 row_mask:0xf bank_mask:0xf
    s_mov_b64 exec, s[50:51]
    s_cbranch_scc0 L2_d86
    s_mov_b64 exec, s[82:83]
    s_nop 1
    v_mfma_f32_4x4x4_16b_bf16 v[88:91], v[12:13], v[84:85], 0
    s_nop 1
    v_mfma_f32_4x4x4_16b_bf16 v[88:91], v[10:11], v[86:87], v[88:91]
    s_nop 4
    v_cvt_pk_bf16_f32 v88, v88, v89
    v_cvt_pk_bf16_f32 v89, v90, v91
    ds_pk_add_bf16 v7, v88 offset:65408
    ds_pk_add_bf16 v7, v89 offset:65412
    s_mov_b64 exec, s[50:51]
    s_branch L2_d86
L2_c87:
    s_lshl_b64 s[52:53], s[82:83], 1
    s_andn2_b64 s[52:53], s[52:53], s[80:81]
    s_andn2_b64 s[52:53], s[52:53], s[54:55]
    s_or_b64 s[80:81], s[80:81], s[52:53]
    s_not_b64 vcc, s[52:53]
    s_mov_b64 exec, -1
    v_cndmask_b32_dpp v84, v84, v84, vcc wave_shr:1 row_mask:0xf bank_mask:0xf
    v_cndmask_b32_dpp v85, v85, v85, vcc wave_shr:1 row_mask:0xf bank_mask:0xf
    s_lshr_b64 s[52:53], s[52:53], 1
    v_cndmask_b32_dpp v86, v86, v86, vcc wave_shr:1 row_mask:0xf bank_mask:0xf
    v_cndmask_b32_dpp v87, v87, v87, vcc wave_shr:1 row_mask:0xf bank_mask:0xf
    s_andn2_b64 s[82:83], s[82:83], s[52:53]
    v_cndmask_b32_dpp v7, v7, v7, vcc wave_shr:1 row_mask:0xf bank_mask:0xf
    s_mov_b64 exec, s[54:55]
    s_cbranch_scc0 L2_d87
    s_mov_b64 exec, s[82:83]
    s_nop 1
    v_mfma_f32_4x4x4_16b_bf16 v[88:91], v[12:13], v[84:85], 0
    s_nop 1
    v_mfma_f32_4x4x4_16b_bf16 v[88:91], v[10:11], v[86:87], v[88:91]
    s_nop 4
    v_cvt_pk_bf16_f32 v88, v88, v89
    v_cvt_pk_bf16_f32 v89, v90, v91
    ds_pk_add_bf16 v7, v88 offset:65408
    ds_pk_add_bf16 v7, v89 offset:65412
    s_mov_b64 exec, s[54:55]
    s_branch L2_d87
L2_c88:
    s_lshl_b64 s[52:53], s[82:83], 1
    s_andn2_b64 s[52:53], s[52:53], s[80:81]
    s_andn2_b64 s[52:53], s[52:53], s[50:51]
    s_or_b64 s[80:81], s[80:81], s[52:53]
    s_not_b64 vcc, s[52:53]
    s_mov_b64 exec, -1
    v_cndmask_b32_dpp v84, v84, v84, vcc wave_shr:1 row_mask:0xf bank_mask:0xf
    v_cndmask_b32_dpp v85, v85, v85, vcc wave_shr:1 row_mask:0xf bank_mask:0xf
    s_lshr_b64 s[52:53], s[52:53], 1
    v_cndmask_b32_dpp v86, v86, v86, vcc wave_shr:1 row_mask:0xf bank_mask:0xf
    v_cndmask_b32_dpp v87, v87, v87, vcc wave_shr:1 row_mask:0xf bank_mask:0xf
    s_andn2_b64 s[82:83], s[82:83], s[52:53]
    v_cndmask_b32_dpp v7, v7, v7, vcc wave_shr:1 row_mask:0xf bank_mask:0xf
    s_mov_b64 exec, s[50:51]
    s_cbranch_scc0 L2_d88
    s_mov_b64 exec, s[82:83]
    s_nop 1
    v_mfma_f32_4x4x4_16b_bf16 v[88:91], v[12:13], v[84:85], 0
    s_nop 1
    v_mfma_f32_4x4x4_16b_bf16 v[88:91], v[10:11], v[86:87], v[88:91]
    s_nop 4
    v_cvt_pk_bf16_f32 v88, v88, v89
    v_cvt_pk_bf16_f32 v89, v90, v91
    ds_pk_add_bf16 v7, v88 offset:65408
    ds_pk_add_bf16 v7, v89 offset:65412
    s_mov_b64 exec, s[50:51]
    s_branch L2_d88
L2_c89:
    s_lshl_b64 s[52:53], s[82:83], 1
    s_andn2_b64 s[52:53], s[52:53], s[80:81]
    s_andn2_b64 s[52:53], s[52:53], s[54:55]
    s_or_b64 s[80:81], s[80:81], s[52:53]
    s_not_b64 vcc, s[52:53]
    s_mov_b64 exec, -1
    v_cndmask_b32_dpp v84, v84, v84, vcc wave_shr:1 row_mask:0xf bank_mask:0xf
    v_cndmask_b32_dpp v85, v85, v85, vcc wave_shr:1 row_mask:0xf bank_mask:0xf
    s_lshr_b64 s[52:53], s[52:53], 1
    v_cndmask_b32_dpp v86, v86, v86, vcc wave_shr:1 row_mask:0xf bank_mask:0xf
    v_cndmask_b32_dpp v87, v87, v87, vcc wave_shr:1 row_mask:0xf bank_mask:0xf
    s_andn2_b64 s[82:83], s[82:83], s[52:53]
    v_cndmask_b32_dpp v7, v7, v7, vcc wave_shr:1 row_mask:0xf bank_mask:0xf
    s_mov_b64 exec, s[54:55]
    s_cbranch_scc0 L2_d89
    s_mov_b64 exec, s[82:83]
    s_nop 1
    v_mfma_f32_4x4x4_16b_bf16 v[88:91], v[12:13], v[84:85], 0
    s_nop 1
    v_mfma_f32_4x4x4_16b_bf16 v[88:91], v[10:11], v[86:87], v[88:91]
    s_nop 4
    v_cvt_pk_bf16_f32 v88, v88, v89
    v_cvt_pk_bf16_f32 v89, v90, v91
    ds_pk_add_bf16 v7, v88 offset:65408
    ds_pk_add_bf16 v7, v89 offset:65412
    s_mov_b64 exec, s[54:55]
    s_branch L2_d89
L2_c90:
    s_lshl_b64 s[52:53], s[82:83], 1
    s_andn2_b64 s[52:53], s[52:53], s[80:81]
    s_andn2_b64 s[52:53], s[52:53], s[50:51]
    s_or_b64 s[80:81], s[80:81], s[52:53]
    s_not_b64 vcc, s[52:53]
    s_mov_b64 exec, -1
    v_cndmask_b32_dpp v84, v84, v84, vcc wave_shr:1 row_mask:0xf bank_mask:0xf
    v_cndmask_b32_dpp v85, v85, v85, vcc wave_shr:1 row_mask:0xf bank_mask:0xf
    s_lshr_b64 s[52:53], s[52:53], 1
    v_cndmask_b32_dpp v86, v86, v86, vcc wave_shr:1 row_mask:0xf bank_mask:0xf
    v_cndmask_b32_dpp v87, v87, v87, vcc wave_shr:1 row_mask:0xf bank_mask:0xf
    s_andn2_b64 s[82:83], s[82:83], s[52:53]
    v_cndmask_b32_dpp v7, v7, v7, vcc wave_shr:1 row_mask:0xf bank_mask:0xf
    s_mov_b64 exec, s[50:51]
    s_cbranch_scc0 L2_d90
    s_mov_b64 exec, s[82:83]
    s_nop 1
    v_mfma_f32_4x4x4_16b_bf16 v[88:91], v[12:13], v[84:85], 0
    s_nop 1
    v_mfma_f32_4x4x4_16b_bf16 v[88:91], v[10:11], v[86:87], v[88:91]
    s_nop 4
    v_cvt_pk_bf16_f32 v88, v88, v89
    v_cvt_pk_bf16_f32 v89, v90, v91
    ds_pk_add_bf16 v7, v88 offset:65408
    ds_pk_add_bf16 v7, v89 offset:65412
    s_mov_b64 exec, s[50:51]
    s_branch L2_d90
L2_oa91:
    s_waitcnt vmcnt(5)
    s_mov_b64 exec, s[6:7]
    v_lshrrev_b32 v114, 16, v114
    s_mov_b64 exec, -1
    v_and_b32 v46, 0x10000000, v20
    v_cmpx_eq_u32 vcc, 0, v46
    v_lshrrev_b32 v47, 14, v112
    v_and_b32 v47, v5, v47
    ds_read_b64 v[96:97], v47
    v_perm_b32 v98, v112, v114, s44
    v_bitop3_b32 v99, v112, 0.5, -0.5 bitop3:0xa8
    v_bitop3_b32 v98, v6, v98, v99 bitop3:0xca
    v_and_b32 v47, v5, v112
    s_waitcnt lgkmcnt(0)
    v_mfma_f32_4x4x4_16b_bf16 v[88:91], v[8:9], v[96:97], 0
    s_nop 4
    v_mul_f32 v88, v98, v88
    v_mul_f32 v89, v98, v89
    v_mul_f32 v90, v98, v90
    v_mul_f32 v91, v98, v91
    v_cvt_pk_bf16_f32 v88, v88, v89
    v_cvt_pk_bf16_f32 v89, v90, v91
    ds_pk_add_bf16 v47, v88 offset:65408
    ds_pk_add_bf16 v47, v89 offset:65412
    s_mov_b64 exec, -1
    v_and_b32 v46, 0x20000000, v20
    v_cmpx_eq_u32 vcc, 0, v46
    v_lshrrev_b32 v47, 14, v113
    v_and_b32 v47, v5, v47
    ds_read_b64 v[96:97], v47
    v_perm_b32 v98, v113, v114, s45
    v_bitop3_b32 v99, v113, 0.5, -0.5 bitop3:0xa8
    v_bitop3_b32 v98, v6, v98, v99 bitop3:0xca
    v_and_b32 v47, v5, v113
    s_waitcnt lgkmcnt(0)
    v_mfma_f32_4x4x4_16b_bf16 v[88:91], v[8:9], v[96:97], 0
    s_nop 4
    v_mul_f32 v88, v98, v88
    v_mul_f32 v89, v98, v89
    v_mul_f32 v90, v98, v90
    v_mul_f32 v91, v98, v91
    v_cvt_pk_bf16_f32 v88, v88, v89
    v_cvt_pk_bf16_f32 v89, v90, v91
    ds_pk_add_bf16 v47, v88 offset:65408
    ds_pk_add_bf16 v47, v89 offset:65412
    s_mov_b64 exec, -1
    s_branch L2_ob91
L2_xo92:
    v_cmp_lt_u32 vcc, 20, v99
    s_mov_b32 s101, 1
    s_cbranch_vccz L2_xp92
    v_cmp_lt_u32 vcc, 32, v99
    v_cmp_lt_u32 s[58:59], 31, v88
    s_mov_b32 s101, 2
    s_or_b64 vcc, vcc, s[58:59]
    s_cbranch_scc0 L2_xp92
    s_mov_b32 s37, 0x10000
    s_branch L2_xp92
L2_c93:
    s_lshl_b64 s[52:53], s[82:83], 1
    s_andn2_b64 s[52:53], s[52:53], s[80:81]
    s_andn2_b64 s[52:53], s[52:53], s[54:55]
    s_or_b64 s[80:81], s[80:81], s[52:53]
    s_not_b64 vcc, s[52:53]
    s_mov_b64 exec, -1
    v_cndmask_b32_dpp v84, v84, v84, vcc wave_shr:1 row_mask:0xf bank_mask:0xf
    v_cndmask_b32_dpp v85, v85, v85, vcc wave_shr:1 row_mask:0xf bank_mask:0xf
    s_lshr_b64 s[52:53], s[52:53], 1
    v_cndmask_b32_dpp v86, v86, v86, vcc wave_shr:1 row_mask:0xf bank_mask:0xf
    v_cndmask_b32_dpp v87, v87, v87, vcc wave_shr:1 row_mask:0xf bank_mask:0xf
    s_andn2_b64 s[82:83], s[82:83], s[52:53]
    v_cndmask_b32_dpp v7, v7, v7, vcc wave_shr:1 row_mask:0xf bank_mask:0xf
    s_mov_b64 exec, s[54:55]
    s_cbranch_scc0 L2_d93
    s_mov_b64 exec, s[82:83]
    s_nop 1
    v_mfma_f32_4x4x4_16b_bf16 v[88:91], v[12:13], v[84:85], 0
    s_nop 1
    v_mfma_f32_4x4x4_16b_bf16 v[88:91], v[10:11], v[86:87], v[88:91]
    s_nop 4
    v_cvt_pk_bf16_f32 v88, v88, v89
    v_cvt_pk_bf16_f32 v89, v90, v91
    ds_pk_add_bf16 v7, v88 offset:65408
    ds_pk_add_bf16 v7, v89 offset:65412
    s_mov_b64 exec, s[54:55]
    s_branch L2_d93
L2_c94:
    s_lshl_b64 s[52:53], s[82:83], 1
    s_andn2_b64 s[52:53], s[52:53], s[80:81]
    s_andn2_b64 s[52:53], s[52:53], s[50:51]
    s_or_b64 s[80:81], s[80:81], s[52:53]
    s_not_b64 vcc, s[52:53]
    s_mov_b64 exec, -1
    v_cndmask_b32_dpp v84, v84, v84, vcc wave_shr:1 row_mask:0xf bank_mask:0xf
    v_cndmask_b32_dpp v85, v85, v85, vcc wave_shr:1 row_mask:0xf bank_mask:0xf
    s_lshr_b64 s[52:53], s[52:53], 1
    v_cndmask_b32_dpp v86, v86, v86, vcc wave_shr:1 row_mask:0xf bank_mask:0xf
    v_cndmask_b32_dpp v87, v87, v87, vcc wave_shr:1 row_mask:0xf bank_mask:0xf
    s_andn2_b64 s[82:83], s[82:83], s[52:53]
    v_cndmask_b32_dpp v7, v7, v7, vcc wave_shr:1 row_mask:0xf bank_mask:0xf
    s_mov_b64 exec, s[50:51]
    s_cbranch_scc0 L2_d94
    s_mov_b64 exec, s[82:83]
    s_nop 1
    v_mfma_f32_4x4x4_16b_bf16 v[88:91], v[12:13], v[84:85], 0
    s_nop 1
    v_mfma_f32_4x4x4_16b_bf16 v[88:91], v[10:11], v[86:87], v[88:91]
    s_nop 4
    v_cvt_pk_bf16_f32 v88, v88, v89
    v_cvt_pk_bf16_f32 v89, v90, v91
    ds_pk_add_bf16 v7, v88 offset:65408
    ds_pk_add_bf16 v7, v89 offset:65412
    s_mov_b64 exec, s[50:51]
    s_branch L2_d94
L2_c95:
    s_lshl_b64 s[52:53], s[82:83], 1
    s_andn2_b64 s[52:53], s[52:53], s[80:81]
    s_andn2_b64 s[52:53], s[52:53], s[54:55]
    s_or_b64 s[80:81], s[80:81], s[52:53]
    s_not_b64 vcc, s[52:53]
    s_mov_b64 exec, -1
    v_cndmask_b32_dpp v84, v84, v84, vcc wave_shr:1 row_mask:0xf bank_mask:0xf
    v_cndmask_b32_dpp v85, v85, v85, vcc wave_shr:1 row_mask:0xf bank_mask:0xf
    s_lshr_b64 s[52:53], s[52:53], 1
    v_cndmask_b32_dpp v86, v86, v86, vcc wave_shr:1 row_mask:0xf bank_mask:0xf
    v_cndmask_b32_dpp v87, v87, v87, vcc wave_shr:1 row_mask:0xf bank_mask:0xf
    s_andn2_b64 s[82:83], s[82:83], s[52:53]
    v_cndmask_b32_dpp v7, v7, v7, vcc wave_shr:1 row_mask:0xf bank_mask:0xf
    s_mov_b64 exec, s[54:55]
    s_cbranch_scc0 L2_d95
    s_mov_b64 exec, s[82:83]
    s_nop 1
    v_mfma_f32_4x4x4_16b_bf16 v[88:91], v[12:13], v[84:85], 0
    s_nop 1
    v_mfma_f32_4x4x4_16b_bf16 v[88:91], v[10:11], v[86:87], v[88:91]
    s_nop 4
    v_cvt_pk_bf16_f32 v88, v88, v89
    v_cvt_pk_bf16_f32 v89, v90, v91
    ds_pk_add_bf16 v7, v88 offset:65408
    ds_pk_add_bf16 v7, v89 offset:65412
    s_mov_b64 exec, s[54:55]
    s_branch L2_d95
L2_c96:
    s_lshl_b64 s[52:53], s[82:83], 1
    s_andn2_b64 s[52:53], s[52:53], s[80:81]
    s_andn2_b64 s[52:53], s[52:53], s[50:51]
    s_or_b64 s[80:81], s[80:81], s[52:53]
    s_not_b64 vcc, s[52:53]
    s_mov_b64 exec, -1
    v_cndmask_b32_dpp v84, v84, v84, vcc wave_shr:1 row_mask:0xf bank_mask:0xf
    v_cndmask_b32_dpp v85, v85, v85, vcc wave_shr:1 row_mask:0xf bank_mask:0xf
    s_lshr_b64 s[52:53], s[52:53], 1
    v_cndmask_b32_dpp v86, v86, v86, vcc wave_shr:1 row_mask:0xf bank_mask:0xf
    v_cndmask_b32_dpp v87, v87, v87, vcc wave_shr:1 row_mask:0xf bank_mask:0xf
    s_andn2_b64 s[82:83], s[82:83], s[52:53]
    v_cndmask_b32_dpp v7, v7, v7, vcc wave_shr:1 row_mask:0xf bank_mask:0xf
    s_mov_b64 exec, s[50:51]
    s_cbranch_scc0 L2_d96
    s_mov_b64 exec, s[82:83]
    s_nop 1
    v_mfma_f32_4x4x4_16b_bf16 v[88:91], v[12:13], v[84:85], 0
    s_nop 1
    v_mfma_f32_4x4x4_16b_bf16 v[88:91], v[10:11], v[86:87], v[88:91]
    s_nop 4
    v_cvt_pk_bf16_f32 v88, v88, v89
    v_cvt_pk_bf16_f32 v89, v90, v91
    ds_pk_add_bf16 v7, v88 offset:65408
    ds_pk_add_bf16 v7, v89 offset:65412
    s_mov_b64 exec, s[50:51]
    s_branch L2_d96
L2_xa97:
    s_cmp_eq_u32 s101, 1
    s_cbranch_scc1 L2_xc97
    v_lshlrev_b32 v89, 0, v96
    v_add_u32 v90, 140, v97
    v_bitop3_b32 v90, v89, v45, v90 bitop3:0x6a
    ds_write_b32 v98, v90 offset:28
    v_lshlrev_b32 v89, 4, v96
    v_add_u32 v90, 120, v97
    v_bitop3_b32 v90, v89, v45, v90 bitop3:0x6a
    ds_write_b32 v98, v90 offset:24
    v_lshlrev_b32 v89, 8, v96
    v_add_u32 v90, 100, v97
    v_bitop3_b32 v90, v89, v45, v90 bitop3:0x6a
    ds_write_b32 v98, v90 offset:20
L2_xc97:
    v_lshlrev_b32 v89, 12, v96
    v_add_u32 v90, 80, v97
    v_bitop3_b32 v90, v89, v45, v90 bitop3:0x6a
    ds_write_b32 v98, v90 offset:16
    s_branch L2_xb97
L2_xe97:
    v_cmp_lt_u32 vcc, 32, v99
    v_cmp_lt_u32 s[58:59], 31, v88
    v_lshrrev_b32 v89, 16, v96
    v_add_u32 v97, 80, v97
    s_or_b64 vcc, vcc, s[58:59]
    s_cbranch_scc1 L2_xs97
    v_lshlrev_b32 v89, v1, v89
    v_and_b32 v89, v45, v89
    v_cmp_ne_u32 vcc, 0, v89
    v_xor_b32 v90, v97, v89
    s_add_u32 s3, s37, s38
    v_mbcnt_lo_u32_b32 v98, vcc_lo, 0
    v_mbcnt_hi_u32_b32 v98, vcc_hi, v98
    s_bcnt1_i32_b64 s41, vcc
    v_lshl_add_u32 v98, v98, 2, s3
    s_lshl2_add_u32 s37, s41, s37
    s_mov_b64 exec, vcc
    ds_write_b32 v98, v90
    s_mov_b64 exec, -1
    s_branch L2_xr97
L2_xs97:
    s_waitcnt lgkmcnt(0)
    s_mov_b32 s37, 0x10000
    s_branch L2_xw97
L2_c98:
    s_lshl_b64 s[52:53], s[82:83], 1
    s_andn2_b64 s[52:53], s[52:53], s[80:81]
    s_andn2_b64 s[52:53], s[52:53], s[54:55]
    s_or_b64 s[80:81], s[80:81], s[52:53]
    s_not_b64 vcc, s[52:53]
    s_mov_b64 exec, -1
    v_cndmask_b32_dpp v84, v84, v84, vcc wave_shr:1 row_mask:0xf bank_mask:0xf
    v_cndmask_b32_dpp v85, v85, v85, vcc wave_shr:1 row_mask:0xf bank_mask:0xf
    s_lshr_b64 s[52:53], s[52:53], 1
    v_cndmask_b32_dpp v86, v86, v86, vcc wave_shr:1 row_mask:0xf bank_mask:0xf
    v_cndmask_b32_dpp v87, v87, v87, vcc wave_shr:1 row_mask:0xf bank_mask:0xf
    s_andn2_b64 s[82:83], s[82:83], s[52:53]
    v_cndmask_b32_dpp v7, v7, v7, vcc wave_shr:1 row_mask:0xf bank_mask:0xf
    s_mov_b64 exec, s[54:55]
    s_cbranch_scc0 L2_d98
    s_mov_b64 exec, s[82:83]
    s_nop 1
    v_mfma_f32_4x4x4_16b_bf16 v[88:91], v[12:13], v[84:85], 0
    s_nop 1
    v_mfma_f32_4x4x4_16b_bf16 v[88:91], v[10:11], v[86:87], v[88:91]
    s_nop 4
    v_cvt_pk_bf16_f32 v88, v88, v89
    v_cvt_pk_bf16_f32 v89, v90, v91
    ds_pk_add_bf16 v7, v88 offset:65408
    ds_pk_add_bf16 v7, v89 offset:65412
    s_mov_b64 exec, s[54:55]
    s_branch L2_d98
L2_c99:
    s_lshl_b64 s[52:53], s[82:83], 1
    s_andn2_b64 s[52:53], s[52:53], s[80:81]
    s_andn2_b64 s[52:53], s[52:53], s[50:51]
    s_or_b64 s[80:81], s[80:81], s[52:53]
    s_not_b64 vcc, s[52:53]
    s_mov_b64 exec, -1
    v_cndmask_b32_dpp v84, v84, v84, vcc wave_shr:1 row_mask:0xf bank_mask:0xf
    v_cndmask_b32_dpp v85, v85, v85, vcc wave_shr:1 row_mask:0xf bank_mask:0xf
    s_lshr_b64 s[52:53], s[52:53], 1
    v_cndmask_b32_dpp v86, v86, v86, vcc wave_shr:1 row_mask:0xf bank_mask:0xf
    v_cndmask_b32_dpp v87, v87, v87, vcc wave_shr:1 row_mask:0xf bank_mask:0xf
    s_andn2_b64 s[82:83], s[82:83], s[52:53]
    v_cndmask_b32_dpp v7, v7, v7, vcc wave_shr:1 row_mask:0xf bank_mask:0xf
    s_mov_b64 exec, s[50:51]
    s_cbranch_scc0 L2_d99
    s_mov_b64 exec, s[82:83]
    s_nop 1
    v_mfma_f32_4x4x4_16b_bf16 v[88:91], v[12:13], v[84:85], 0
    s_nop 1
    v_mfma_f32_4x4x4_16b_bf16 v[88:91], v[10:11], v[86:87], v[88:91]
    s_nop 4
    v_cvt_pk_bf16_f32 v88, v88, v89
    v_cvt_pk_bf16_f32 v89, v90, v91
    ds_pk_add_bf16 v7, v88 offset:65408
    ds_pk_add_bf16 v7, v89 offset:65412
    s_mov_b64 exec, s[50:51]
    s_branch L2_d99
L2_xf97:
    s_cmp_gt_u32 s37, 1024
    s_cbranch_scc1 L2_xt97
    s_cmp_lt_u32 s37, 768
    s_cbranch_scc1 L2_xl97
    ds_read_b32 v20, v44 offset:896
    s_add_u32 s3, s42, 2
    s_bitset1_b32 s43, s3
    s_branch L2_xg97
L2_xl97:
    s_waitcnt lgkmcnt(0)
    v_mov_b32 v19, -1
    s_cmp_ge_u32 s37, 512
    s_cbranch_scc1 L2_xg97
    v_mov_b32 v39, -1
    s_cmp_ge_u32 s37, 256
    s_cbranch_scc1 L2_xg97
    v_mov_b32 v33, -1
    s_branch L2_xg97
L2_xt97:
    s_waitcnt lgkmcnt(0)
    v_mov_b32 v27, -1
    v_mov_b32 v33, -1
    v_mov_b32 v39, -1
    v_mov_b32 v19, -1
    s_add_u32 s3, s42, 2
    s_bitset1_b32 s36, s3
    s_branch L2_xg97
L2_oa100:
    v_and_b32 v47, 0x0fffffff, v21
    buffer_load_dword v114, v47, s[8:11], 0 offen offset:16
    s_mov_b64 exec, s[6:7]
    v_add_u32 v47, 8, v47
    v_lshrrev_b32 v21, 2, v21
    s_mov_b64 exec, -1
    buffer_load_dwordx2 v[112:113], v47, s[8:11], 0 offen
    s_branch L2_ob100
L2_c101:
    s_lshl_b64 s[52:53], s[82:83], 1
    s_andn2_b64 s[52:53], s[52:53], s[80:81]
    s_andn2_b64 s[52:53], s[52:53], s[54:55]
    s_or_b64 s[80:81], s[80:81], s[52:53]
    s_not_b64 vcc, s[52:53]
    s_mov_b64 exec, -1
    v_cndmask_b32_dpp v84, v84, v84, vcc wave_shr:1 row_mask:0xf bank_mask:0xf
    v_cndmask_b32_dpp v85, v85, v85, vcc wave_shr:1 row_mask:0xf bank_mask:0xf
    s_lshr_b64 s[52:53], s[52:53], 1
    v_cndmask_b32_dpp v86, v86, v86, vcc wave_shr:1 row_mask:0xf bank_mask:0xf
    v_cndmask_b32_dpp v87, v87, v87, vcc wave_shr:1 row_mask:0xf bank_mask:0xf
    s_andn2_b64 s[82:83], s[82:83], s[52:53]
    v_cndmask_b32_dpp v7, v7, v7, vcc wave_shr:1 row_mask:0xf bank_mask:0xf
    s_mov_b64 exec, s[54:55]
    s_cbranch_scc0 L2_d101
    s_mov_b64 exec, s[82:83]
    s_nop 1
    v_mfma_f32_4x4x4_16b_bf16 v[88:91], v[12:13], v[84:85], 0
    s_nop 1
    v_mfma_f32_4x4x4_16b_bf16 v[88:91], v[10:11], v[86:87], v[88:91]
    s_nop 4
    v_cvt_pk_bf16_f32 v88, v88, v89
    v_cvt_pk_bf16_f32 v89, v90, v91
    ds_pk_add_bf16 v7, v88 offset:65408
    ds_pk_add_bf16 v7, v89 offset:65412
    s_mov_b64 exec, s[54:55]
    s_branch L2_d101
L2_c102:
    s_lshl_b64 s[52:53], s[82:83], 1
    s_andn2_b64 s[52:53], s[52:53], s[80:81]
    s_andn2_b64 s[52:53], s[52:53], s[50:51]
    s_or_b64 s[80:81], s[80:81], s[52:53]
    s_not_b64 vcc, s[52:53]
    s_mov_b64 exec, -1
    v_cndmask_b32_dpp v84, v84, v84, vcc wave_shr:1 row_mask:0xf bank_mask:0xf
    v_cndmask_b32_dpp v85, v85, v85, vcc wave_shr:1 row_mask:0xf bank_mask:0xf
    s_lshr_b64 s[52:53], s[52:53], 1
    v_cndmask_b32_dpp v86, v86, v86, vcc wave_shr:1 row_mask:0xf bank_mask:0xf
    v_cndmask_b32_dpp v87, v87, v87, vcc wave_shr:1 row_mask:0xf bank_mask:0xf
    s_andn2_b64 s[82:83], s[82:83], s[52:53]
    v_cndmask_b32_dpp v7, v7, v7, vcc wave_shr:1 row_mask:0xf bank_mask:0xf
    s_mov_b64 exec, s[50:51]
    s_cbranch_scc0 L2_d102
    s_mov_b64 exec, s[82:83]
    s_nop 1
    v_mfma_f32_4x4x4_16b_bf16 v[88:91], v[12:13], v[84:85], 0
    s_nop 1
    v_mfma_f32_4x4x4_16b_bf16 v[88:91], v[10:11], v[86:87], v[88:91]
    s_nop 4
    v_cvt_pk_bf16_f32 v88, v88, v89
    v_cvt_pk_bf16_f32 v89, v90, v91
    ds_pk_add_bf16 v7, v88 offset:65408
    ds_pk_add_bf16 v7, v89 offset:65412
    s_mov_b64 exec, s[50:51]
    s_branch L2_d102
L2_c103:
    s_lshl_b64 s[52:53], s[82:83], 1
    s_andn2_b64 s[52:53], s[52:53], s[80:81]
    s_andn2_b64 s[52:53], s[52:53], s[54:55]
    s_or_b64 s[80:81], s[80:81], s[52:53]
    s_not_b64 vcc, s[52:53]
    s_mov_b64 exec, -1
    v_cndmask_b32_dpp v84, v84, v84, vcc wave_shr:1 row_mask:0xf bank_mask:0xf
    v_cndmask_b32_dpp v85, v85, v85, vcc wave_shr:1 row_mask:0xf bank_mask:0xf
    s_lshr_b64 s[52:53], s[52:53], 1
    v_cndmask_b32_dpp v86, v86, v86, vcc wave_shr:1 row_mask:0xf bank_mask:0xf
    v_cndmask_b32_dpp v87, v87, v87, vcc wave_shr:1 row_mask:0xf bank_mask:0xf
    s_andn2_b64 s[82:83], s[82:83], s[52:53]
    v_cndmask_b32_dpp v7, v7, v7, vcc wave_shr:1 row_mask:0xf bank_mask:0xf
    s_mov_b64 exec, s[54:55]
    s_cbranch_scc0 L2_d103
    s_mov_b64 exec, s[82:83]
    s_nop 1
    v_mfma_f32_4x4x4_16b_bf16 v[88:91], v[12:13], v[84:85], 0
    s_nop 1
    v_mfma_f32_4x4x4_16b_bf16 v[88:91], v[10:11], v[86:87], v[88:91]
    s_nop 4
    v_cvt_pk_bf16_f32 v88, v88, v89
    v_cvt_pk_bf16_f32 v89, v90, v91
    ds_pk_add_bf16 v7, v88 offset:65408
    ds_pk_add_bf16 v7, v89 offset:65412
    s_mov_b64 exec, s[54:55]
    s_branch L2_d103
L2_c104:
    s_lshl_b64 s[52:53], s[82:83], 1
    s_andn2_b64 s[52:53], s[52:53], s[80:81]
    s_andn2_b64 s[52:53], s[52:53], s[50:51]
    s_or_b64 s[80:81], s[80:81], s[52:53]
    s_not_b64 vcc, s[52:53]
    s_mov_b64 exec, -1
    v_cndmask_b32_dpp v84, v84, v84, vcc wave_shr:1 row_mask:0xf bank_mask:0xf
    v_cndmask_b32_dpp v85, v85, v85, vcc wave_shr:1 row_mask:0xf bank_mask:0xf
    s_lshr_b64 s[52:53], s[52:53], 1
    v_cndmask_b32_dpp v86, v86, v86, vcc wave_shr:1 row_mask:0xf bank_mask:0xf
    v_cndmask_b32_dpp v87, v87, v87, vcc wave_shr:1 row_mask:0xf bank_mask:0xf
    s_andn2_b64 s[82:83], s[82:83], s[52:53]
    v_cndmask_b32_dpp v7, v7, v7, vcc wave_shr:1 row_mask:0xf bank_mask:0xf
    s_mov_b64 exec, s[50:51]
    s_cbranch_scc0 L2_d104
    s_mov_b64 exec, s[82:83]
    s_nop 1
    v_mfma_f32_4x4x4_16b_bf16 v[88:91], v[12:13], v[84:85], 0
    s_nop 1
    v_mfma_f32_4x4x4_16b_bf16 v[88:91], v[10:11], v[86:87], v[88:91]
    s_nop 4
    v_cvt_pk_bf16_f32 v88, v88, v89
    v_cvt_pk_bf16_f32 v89, v90, v91
    ds_pk_add_bf16 v7, v88 offset:65408
    ds_pk_add_bf16 v7, v89 offset:65412
    s_mov_b64 exec, s[50:51]
    s_branch L2_d104
L2_c105:
    s_lshl_b64 s[52:53], s[82:83], 1
    s_andn2_b64 s[52:53], s[52:53], s[80:81]
    s_andn2_b64 s[52:53], s[52:53], s[54:55]
    s_or_b64 s[80:81], s[80:81], s[52:53]
    s_not_b64 vcc, s[52:53]
    s_mov_b64 exec, -1
    v_cndmask_b32_dpp v84, v84, v84, vcc wave_shr:1 row_mask:0xf bank_mask:0xf
    v_cndmask_b32_dpp v85, v85, v85, vcc wave_shr:1 row_mask:0xf bank_mask:0xf
    s_lshr_b64 s[52:53], s[52:53], 1
    v_cndmask_b32_dpp v86, v86, v86, vcc wave_shr:1 row_mask:0xf bank_mask:0xf
    v_cndmask_b32_dpp v87, v87, v87, vcc wave_shr:1 row_mask:0xf bank_mask:0xf
    s_andn2_b64 s[82:83], s[82:83], s[52:53]
    v_cndmask_b32_dpp v7, v7, v7, vcc wave_shr:1 row_mask:0xf bank_mask:0xf
    s_mov_b64 exec, s[54:55]
    s_cbranch_scc0 L2_d105
    s_mov_b64 exec, s[82:83]
    s_nop 1
    v_mfma_f32_4x4x4_16b_bf16 v[88:91], v[12:13], v[84:85], 0
    s_nop 1
    v_mfma_f32_4x4x4_16b_bf16 v[88:91], v[10:11], v[86:87], v[88:91]
    s_nop 4
    v_cvt_pk_bf16_f32 v88, v88, v89
    v_cvt_pk_bf16_f32 v89, v90, v91
    ds_pk_add_bf16 v7, v88 offset:65408
    ds_pk_add_bf16 v7, v89 offset:65412
    s_mov_b64 exec, s[54:55]
    s_branch L2_d105
L2_c106:
    s_lshl_b64 s[52:53], s[82:83], 1
    s_andn2_b64 s[52:53], s[52:53], s[80:81]
    s_andn2_b64 s[52:53], s[52:53], s[50:51]
    s_or_b64 s[80:81], s[80:81], s[52:53]
    s_not_b64 vcc, s[52:53]
    s_mov_b64 exec, -1
    v_cndmask_b32_dpp v84, v84, v84, vcc wave_shr:1 row_mask:0xf bank_mask:0xf
    v_cndmask_b32_dpp v85, v85, v85, vcc wave_shr:1 row_mask:0xf bank_mask:0xf
    s_lshr_b64 s[52:53], s[52:53], 1
    v_cndmask_b32_dpp v86, v86, v86, vcc wave_shr:1 row_mask:0xf bank_mask:0xf
    v_cndmask_b32_dpp v87, v87, v87, vcc wave_shr:1 row_mask:0xf bank_mask:0xf
    s_andn2_b64 s[82:83], s[82:83], s[52:53]
    v_cndmask_b32_dpp v7, v7, v7, vcc wave_shr:1 row_mask:0xf bank_mask:0xf
    s_mov_b64 exec, s[50:51]
    s_cbranch_scc0 L2_d106
    s_mov_b64 exec, s[82:83]
    s_nop 1
    v_mfma_f32_4x4x4_16b_bf16 v[88:91], v[12:13], v[84:85], 0
    s_nop 1
    v_mfma_f32_4x4x4_16b_bf16 v[88:91], v[10:11], v[86:87], v[88:91]
    s_nop 4
    v_cvt_pk_bf16_f32 v88, v88, v89
    v_cvt_pk_bf16_f32 v89, v90, v91
    ds_pk_add_bf16 v7, v88 offset:65408
    ds_pk_add_bf16 v7, v89 offset:65412
    s_mov_b64 exec, s[50:51]
    s_branch L2_d106
L2_c107:
    s_lshl_b64 s[52:53], s[82:83], 1
    s_andn2_b64 s[52:53], s[52:53], s[80:81]
    s_andn2_b64 s[52:53], s[52:53], s[54:55]
    s_or_b64 s[80:81], s[80:81], s[52:53]
    s_not_b64 vcc, s[52:53]
    s_mov_b64 exec, -1
    v_cndmask_b32_dpp v84, v84, v84, vcc wave_shr:1 row_mask:0xf bank_mask:0xf
    v_cndmask_b32_dpp v85, v85, v85, vcc wave_shr:1 row_mask:0xf bank_mask:0xf
    s_lshr_b64 s[52:53], s[52:53], 1
    v_cndmask_b32_dpp v86, v86, v86, vcc wave_shr:1 row_mask:0xf bank_mask:0xf
    v_cndmask_b32_dpp v87, v87, v87, vcc wave_shr:1 row_mask:0xf bank_mask:0xf
    s_andn2_b64 s[82:83], s[82:83], s[52:53]
    v_cndmask_b32_dpp v7, v7, v7, vcc wave_shr:1 row_mask:0xf bank_mask:0xf
    s_mov_b64 exec, s[54:55]
    s_cbranch_scc0 L2_d107
    s_mov_b64 exec, s[82:83]
    s_nop 1
    v_mfma_f32_4x4x4_16b_bf16 v[88:91], v[12:13], v[84:85], 0
    s_nop 1
    v_mfma_f32_4x4x4_16b_bf16 v[88:91], v[10:11], v[86:87], v[88:91]
    s_nop 4
    v_cvt_pk_bf16_f32 v88, v88, v89
    v_cvt_pk_bf16_f32 v89, v90, v91
    ds_pk_add_bf16 v7, v88 offset:65408
    ds_pk_add_bf16 v7, v89 offset:65412
    s_mov_b64 exec, s[54:55]
    s_branch L2_d107
L2_c108:
    s_lshl_b64 s[52:53], s[82:83], 1
    s_andn2_b64 s[52:53], s[52:53], s[80:81]
    s_andn2_b64 s[52:53], s[52:53], s[50:51]
    s_or_b64 s[80:81], s[80:81], s[52:53]
    s_not_b64 vcc, s[52:53]
    s_mov_b64 exec, -1
    v_cndmask_b32_dpp v84, v84, v84, vcc wave_shr:1 row_mask:0xf bank_mask:0xf
    v_cndmask_b32_dpp v85, v85, v85, vcc wave_shr:1 row_mask:0xf bank_mask:0xf
    s_lshr_b64 s[52:53], s[52:53], 1
    v_cndmask_b32_dpp v86, v86, v86, vcc wave_shr:1 row_mask:0xf bank_mask:0xf
    v_cndmask_b32_dpp v87, v87, v87, vcc wave_shr:1 row_mask:0xf bank_mask:0xf
    s_andn2_b64 s[82:83], s[82:83], s[52:53]
    v_cndmask_b32_dpp v7, v7, v7, vcc wave_shr:1 row_mask:0xf bank_mask:0xf
    s_mov_b64 exec, s[50:51]
    s_cbranch_scc0 L2_d108
    s_mov_b64 exec, s[82:83]
    s_nop 1
    v_mfma_f32_4x4x4_16b_bf16 v[88:91], v[12:13], v[84:85], 0
    s_nop 1
    v_mfma_f32_4x4x4_16b_bf16 v[88:91], v[10:11], v[86:87], v[88:91]
    s_nop 4
    v_cvt_pk_bf16_f32 v88, v88, v89
    v_cvt_pk_bf16_f32 v89, v90, v91
    ds_pk_add_bf16 v7, v88 offset:65408
    ds_pk_add_bf16 v7, v89 offset:65412
    s_mov_b64 exec, s[50:51]
    s_branch L2_d108
L2_oa109:
    s_waitcnt vmcnt(5)
    s_mov_b64 exec, s[6:7]
    v_lshrrev_b32 v114, 16, v114
    s_mov_b64 exec, -1
    v_and_b32 v46, 0x10000000, v21
    v_cmpx_eq_u32 vcc, 0, v46
    v_lshrrev_b32 v47, 14, v112
    v_and_b32 v47, v5, v47
    ds_read_b64 v[96:97], v47
    v_perm_b32 v98, v112, v114, s44
    v_bitop3_b32 v99, v112, 0.5, -0.5 bitop3:0xa8
    v_bitop3_b32 v98, v6, v98, v99 bitop3:0xca
    v_and_b32 v47, v5, v112
    s_waitcnt lgkmcnt(0)
    v_mfma_f32_4x4x4_16b_bf16 v[88:91], v[8:9], v[96:97], 0
    s_nop 4
    v_mul_f32 v88, v98, v88
    v_mul_f32 v89, v98, v89
    v_mul_f32 v90, v98, v90
    v_mul_f32 v91, v98, v91
    v_cvt_pk_bf16_f32 v88, v88, v89
    v_cvt_pk_bf16_f32 v89, v90, v91
    ds_pk_add_bf16 v47, v88 offset:65408
    ds_pk_add_bf16 v47, v89 offset:65412
    s_mov_b64 exec, -1
    v_and_b32 v46, 0x20000000, v21
    v_cmpx_eq_u32 vcc, 0, v46
    v_lshrrev_b32 v47, 14, v113
    v_and_b32 v47, v5, v47
    ds_read_b64 v[96:97], v47
    v_perm_b32 v98, v113, v114, s45
    v_bitop3_b32 v99, v113, 0.5, -0.5 bitop3:0xa8
    v_bitop3_b32 v98, v6, v98, v99 bitop3:0xca
    v_and_b32 v47, v5, v113
    s_waitcnt lgkmcnt(0)
    v_mfma_f32_4x4x4_16b_bf16 v[88:91], v[8:9], v[96:97], 0
    s_nop 4
    v_mul_f32 v88, v98, v88
    v_mul_f32 v89, v98, v89
    v_mul_f32 v90, v98, v90
    v_mul_f32 v91, v98, v91
    v_cvt_pk_bf16_f32 v88, v88, v89
    v_cvt_pk_bf16_f32 v89, v90, v91
    ds_pk_add_bf16 v47, v88 offset:65408
    ds_pk_add_bf16 v47, v89 offset:65412
    s_mov_b64 exec, -1
    s_branch L2_ob109
L2_xo110:
    v_cmp_lt_u32 vcc, 20, v99
    s_mov_b32 s101, 1
    s_cbranch_vccz L2_xp110
    v_cmp_lt_u32 vcc, 32, v99
    v_cmp_lt_u32 s[58:59], 31, v88
    s_mov_b32 s101, 2
    s_or_b64 vcc, vcc, s[58:59]
    s_cbranch_scc0 L2_xp110
    s_mov_b32 s37, 0x10000
    s_branch L2_xp110
L2_c111:
    s_lshl_b64 s[52:53], s[82:83], 1
    s_andn2_b64 s[52:53], s[52:53], s[80:81]
    s_andn2_b64 s[52:53], s[52:53], s[54:55]
    s_or_b64 s[80:81], s[80:81], s[52:53]
    s_not_b64 vcc, s[52:53]
    s_mov_b64 exec, -1
    v_cndmask_b32_dpp v84, v84, v84, vcc wave_shr:1 row_mask:0xf bank_mask:0xf
    v_cndmask_b32_dpp v85, v85, v85, vcc wave_shr:1 row_mask:0xf bank_mask:0xf
    s_lshr_b64 s[52:53], s[52:53], 1
    v_cndmask_b32_dpp v86, v86, v86, vcc wave_shr:1 row_mask:0xf bank_mask:0xf
    v_cndmask_b32_dpp v87, v87, v87, vcc wave_shr:1 row_mask:0xf bank_mask:0xf
    s_andn2_b64 s[82:83], s[82:83], s[52:53]
    v_cndmask_b32_dpp v7, v7, v7, vcc wave_shr:1 row_mask:0xf bank_mask:0xf
    s_mov_b64 exec, s[54:55]
    s_cbranch_scc0 L2_d111
    s_mov_b64 exec, s[82:83]
    s_nop 1
    v_mfma_f32_4x4x4_16b_bf16 v[88:91], v[12:13], v[84:85], 0
    s_nop 1
    v_mfma_f32_4x4x4_16b_bf16 v[88:91], v[10:11], v[86:87], v[88:91]
    s_nop 4
    v_cvt_pk_bf16_f32 v88, v88, v89
    v_cvt_pk_bf16_f32 v89, v90, v91
    ds_pk_add_bf16 v7, v88 offset:65408
    ds_pk_add_bf16 v7, v89 offset:65412
    s_mov_b64 exec, s[54:55]
    s_branch L2_d111
L2_c112:
    s_lshl_b64 s[52:53], s[82:83], 1
    s_andn2_b64 s[52:53], s[52:53], s[80:81]
    s_andn2_b64 s[52:53], s[52:53], s[50:51]
    s_or_b64 s[80:81], s[80:81], s[52:53]
    s_not_b64 vcc, s[52:53]
    s_mov_b64 exec, -1
    v_cndmask_b32_dpp v84, v84, v84, vcc wave_shr:1 row_mask:0xf bank_mask:0xf
    v_cndmask_b32_dpp v85, v85, v85, vcc wave_shr:1 row_mask:0xf bank_mask:0xf
    s_lshr_b64 s[52:53], s[52:53], 1
    v_cndmask_b32_dpp v86, v86, v86, vcc wave_shr:1 row_mask:0xf bank_mask:0xf
    v_cndmask_b32_dpp v87, v87, v87, vcc wave_shr:1 row_mask:0xf bank_mask:0xf
    s_andn2_b64 s[82:83], s[82:83], s[52:53]
    v_cndmask_b32_dpp v7, v7, v7, vcc wave_shr:1 row_mask:0xf bank_mask:0xf
    s_mov_b64 exec, s[50:51]
    s_cbranch_scc0 L2_d112
    s_mov_b64 exec, s[82:83]
    s_nop 1
    v_mfma_f32_4x4x4_16b_bf16 v[88:91], v[12:13], v[84:85], 0
    s_nop 1
    v_mfma_f32_4x4x4_16b_bf16 v[88:91], v[10:11], v[86:87], v[88:91]
    s_nop 4
    v_cvt_pk_bf16_f32 v88, v88, v89
    v_cvt_pk_bf16_f32 v89, v90, v91
    ds_pk_add_bf16 v7, v88 offset:65408
    ds_pk_add_bf16 v7, v89 offset:65412
    s_mov_b64 exec, s[50:51]
    s_branch L2_d112
L2_c113:
    s_lshl_b64 s[52:53], s[82:83], 1
    s_andn2_b64 s[52:53], s[52:53], s[80:81]
    s_andn2_b64 s[52:53], s[52:53], s[54:55]
    s_or_b64 s[80:81], s[80:81], s[52:53]
    s_not_b64 vcc, s[52:53]
    s_mov_b64 exec, -1
    v_cndmask_b32_dpp v84, v84, v84, vcc wave_shr:1 row_mask:0xf bank_mask:0xf
    v_cndmask_b32_dpp v85, v85, v85, vcc wave_shr:1 row_mask:0xf bank_mask:0xf
    s_lshr_b64 s[52:53], s[52:53], 1
    v_cndmask_b32_dpp v86, v86, v86, vcc wave_shr:1 row_mask:0xf bank_mask:0xf
    v_cndmask_b32_dpp v87, v87, v87, vcc wave_shr:1 row_mask:0xf bank_mask:0xf
    s_andn2_b64 s[82:83], s[82:83], s[52:53]
    v_cndmask_b32_dpp v7, v7, v7, vcc wave_shr:1 row_mask:0xf bank_mask:0xf
    s_mov_b64 exec, s[54:55]
    s_cbranch_scc0 L2_d113
    s_mov_b64 exec, s[82:83]
    s_nop 1
    v_mfma_f32_4x4x4_16b_bf16 v[88:91], v[12:13], v[84:85], 0
    s_nop 1
    v_mfma_f32_4x4x4_16b_bf16 v[88:91], v[10:11], v[86:87], v[88:91]
    s_nop 4
    v_cvt_pk_bf16_f32 v88, v88, v89
    v_cvt_pk_bf16_f32 v89, v90, v91
    ds_pk_add_bf16 v7, v88 offset:65408
    ds_pk_add_bf16 v7, v89 offset:65412
    s_mov_b64 exec, s[54:55]
    s_branch L2_d113
L2_c114:
    s_lshl_b64 s[52:53], s[82:83], 1
    s_andn2_b64 s[52:53], s[52:53], s[80:81]
    s_andn2_b64 s[52:53], s[52:53], s[50:51]
    s_or_b64 s[80:81], s[80:81], s[52:53]
    s_not_b64 vcc, s[52:53]
    s_mov_b64 exec, -1
    v_cndmask_b32_dpp v84, v84, v84, vcc wave_shr:1 row_mask:0xf bank_mask:0xf
    v_cndmask_b32_dpp v85, v85, v85, vcc wave_shr:1 row_mask:0xf bank_mask:0xf
    s_lshr_b64 s[52:53], s[52:53], 1
    v_cndmask_b32_dpp v86, v86, v86, vcc wave_shr:1 row_mask:0xf bank_mask:0xf
    v_cndmask_b32_dpp v87, v87, v87, vcc wave_shr:1 row_mask:0xf bank_mask:0xf
    s_andn2_b64 s[82:83], s[82:83], s[52:53]
    v_cndmask_b32_dpp v7, v7, v7, vcc wave_shr:1 row_mask:0xf bank_mask:0xf
    s_mov_b64 exec, s[50:51]
    s_cbranch_scc0 L2_d114
    s_mov_b64 exec, s[82:83]
    s_nop 1
    v_mfma_f32_4x4x4_16b_bf16 v[88:91], v[12:13], v[84:85], 0
    s_nop 1
    v_mfma_f32_4x4x4_16b_bf16 v[88:91], v[10:11], v[86:87], v[88:91]
    s_nop 4
    v_cvt_pk_bf16_f32 v88, v88, v89
    v_cvt_pk_bf16_f32 v89, v90, v91
    ds_pk_add_bf16 v7, v88 offset:65408
    ds_pk_add_bf16 v7, v89 offset:65412
    s_mov_b64 exec, s[50:51]
    s_branch L2_d114
L2_xa115:
    s_cmp_eq_u32 s101, 1
    s_cbranch_scc1 L2_xc115
    v_lshlrev_b32 v89, 0, v96
    v_add_u32 v90, 140, v97
    v_bitop3_b32 v90, v89, v45, v90 bitop3:0x6a
    ds_write_b32 v98, v90 offset:28
    v_lshlrev_b32 v89, 4, v96
    v_add_u32 v90, 120, v97
    v_bitop3_b32 v90, v89, v45, v90 bitop3:0x6a
    ds_write_b32 v98, v90 offset:24
    v_lshlrev_b32 v89, 8, v96
    v_add_u32 v90, 100, v97
    v_bitop3_b32 v90, v89, v45, v90 bitop3:0x6a
    ds_write_b32 v98, v90 offset:20
L2_xc115:
    v_lshlrev_b32 v89, 12, v96
    v_add_u32 v90, 80, v97
    v_bitop3_b32 v90, v89, v45, v90 bitop3:0x6a
    ds_write_b32 v98, v90 offset:16
    s_branch L2_xb115
L2_xe115:
    v_cmp_lt_u32 vcc, 32, v99
    v_cmp_lt_u32 s[58:59], 31, v88
    v_lshrrev_b32 v89, 16, v96
    v_add_u32 v97, 80, v97
    s_or_b64 vcc, vcc, s[58:59]
    s_cbranch_scc1 L2_xs115
    v_lshlrev_b32 v89, v1, v89
    v_and_b32 v89, v45, v89
    v_cmp_ne_u32 vcc, 0, v89
    v_xor_b32 v90, v97, v89
    s_add_u32 s3, s37, s38
    v_mbcnt_lo_u32_b32 v98, vcc_lo, 0
    v_mbcnt_hi_u32_b32 v98, vcc_hi, v98
    s_bcnt1_i32_b64 s41, vcc
    v_lshl_add_u32 v98, v98, 2, s3
    s_lshl2_add_u32 s37, s41, s37
    s_mov_b64 exec, vcc
    ds_write_b32 v98, v90
    s_mov_b64 exec, -1
    s_branch L2_xr115
L2_xs115:
    s_waitcnt lgkmcnt(0)
    s_mov_b32 s37, 0x10000
    s_branch L2_xw115
L2_c116:
    s_lshl_b64 s[52:53], s[82:83], 1
    s_andn2_b64 s[52:53], s[52:53], s[80:81]
    s_andn2_b64 s[52:53], s[52:53], s[54:55]
    s_or_b64 s[80:81], s[80:81], s[52:53]
    s_not_b64 vcc, s[52:53]
    s_mov_b64 exec, -1
    v_cndmask_b32_dpp v84, v84, v84, vcc wave_shr:1 row_mask:0xf bank_mask:0xf
    v_cndmask_b32_dpp v85, v85, v85, vcc wave_shr:1 row_mask:0xf bank_mask:0xf
    s_lshr_b64 s[52:53], s[52:53], 1
    v_cndmask_b32_dpp v86, v86, v86, vcc wave_shr:1 row_mask:0xf bank_mask:0xf
    v_cndmask_b32_dpp v87, v87, v87, vcc wave_shr:1 row_mask:0xf bank_mask:0xf
    s_andn2_b64 s[82:83], s[82:83], s[52:53]
    v_cndmask_b32_dpp v7, v7, v7, vcc wave_shr:1 row_mask:0xf bank_mask:0xf
    s_mov_b64 exec, s[54:55]
    s_cbranch_scc0 L2_d116
    s_mov_b64 exec, s[82:83]
    s_nop 1
    v_mfma_f32_4x4x4_16b_bf16 v[88:91], v[12:13], v[84:85], 0
    s_nop 1
    v_mfma_f32_4x4x4_16b_bf16 v[88:91], v[10:11], v[86:87], v[88:91]
    s_nop 4
    v_cvt_pk_bf16_f32 v88, v88, v89
    v_cvt_pk_bf16_f32 v89, v90, v91
    ds_pk_add_bf16 v7, v88 offset:65408
    ds_pk_add_bf16 v7, v89 offset:65412
    s_mov_b64 exec, s[54:55]
    s_branch L2_d116
L2_c117:
    s_lshl_b64 s[52:53], s[82:83], 1
    s_andn2_b64 s[52:53], s[52:53], s[80:81]
    s_andn2_b64 s[52:53], s[52:53], s[50:51]
    s_or_b64 s[80:81], s[80:81], s[52:53]
    s_not_b64 vcc, s[52:53]
    s_mov_b64 exec, -1
    v_cndmask_b32_dpp v84, v84, v84, vcc wave_shr:1 row_mask:0xf bank_mask:0xf
    v_cndmask_b32_dpp v85, v85, v85, vcc wave_shr:1 row_mask:0xf bank_mask:0xf
    s_lshr_b64 s[52:53], s[52:53], 1
    v_cndmask_b32_dpp v86, v86, v86, vcc wave_shr:1 row_mask:0xf bank_mask:0xf
    v_cndmask_b32_dpp v87, v87, v87, vcc wave_shr:1 row_mask:0xf bank_mask:0xf
    s_andn2_b64 s[82:83], s[82:83], s[52:53]
    v_cndmask_b32_dpp v7, v7, v7, vcc wave_shr:1 row_mask:0xf bank_mask:0xf
    s_mov_b64 exec, s[50:51]
    s_cbranch_scc0 L2_d117
    s_mov_b64 exec, s[82:83]
    s_nop 1
    v_mfma_f32_4x4x4_16b_bf16 v[88:91], v[12:13], v[84:85], 0
    s_nop 1
    v_mfma_f32_4x4x4_16b_bf16 v[88:91], v[10:11], v[86:87], v[88:91]
    s_nop 4
    v_cvt_pk_bf16_f32 v88, v88, v89
    v_cvt_pk_bf16_f32 v89, v90, v91
    ds_pk_add_bf16 v7, v88 offset:65408
    ds_pk_add_bf16 v7, v89 offset:65412
    s_mov_b64 exec, s[50:51]
    s_branch L2_d117
L2_xf115:
    s_cmp_gt_u32 s37, 1024
    s_cbranch_scc1 L2_xt115
    s_cmp_lt_u32 s37, 768
    s_cbranch_scc1 L2_xl115
    ds_read_b32 v21, v44 offset:896
    s_add_u32 s3, s42, 2
    s_bitset1_b32 s43, s3
    s_branch L2_xg115
L2_xl115:
    s_waitcnt lgkmcnt(0)
    v_mov_b32 v40, -1
    s_cmp_ge_u32 s37, 512
    s_cbranch_scc1 L2_xg115
    v_mov_b32 v43, -1
    s_cmp_ge_u32 s37, 256
    s_cbranch_scc1 L2_xg115
    v_mov_b32 v42, -1
    s_branch L2_xg115
L2_xt115:
    s_waitcnt lgkmcnt(0)
    v_mov_b32 v41, -1
    v_mov_b32 v42, -1
    v_mov_b32 v43, -1
    v_mov_b32 v40, -1
    s_add_u32 s3, s42, 2
    s_bitset1_b32 s36, s3
    s_branch L2_xg115
L2_oa118:
    v_and_b32 v47, 0x0fffffff, v20
    buffer_load_dword v114, v47, s[8:11], 0 offen offset:16
    s_mov_b64 exec, s[6:7]
    v_add_u32 v47, 8, v47
    v_lshrrev_b32 v20, 2, v20
    s_mov_b64 exec, -1
    buffer_load_dwordx2 v[112:113], v47, s[8:11], 0 offen
    s_branch L2_ob118
L2_c119:
    s_lshl_b64 s[52:53], s[82:83], 1
    s_andn2_b64 s[52:53], s[52:53], s[80:81]
    s_andn2_b64 s[52:53], s[52:53], s[54:55]
    s_or_b64 s[80:81], s[80:81], s[52:53]
    s_not_b64 vcc, s[52:53]
    s_mov_b64 exec, -1
    v_cndmask_b32_dpp v84, v84, v84, vcc wave_shr:1 row_mask:0xf bank_mask:0xf
    v_cndmask_b32_dpp v85, v85, v85, vcc wave_shr:1 row_mask:0xf bank_mask:0xf
    s_lshr_b64 s[52:53], s[52:53], 1
    v_cndmask_b32_dpp v86, v86, v86, vcc wave_shr:1 row_mask:0xf bank_mask:0xf
    v_cndmask_b32_dpp v87, v87, v87, vcc wave_shr:1 row_mask:0xf bank_mask:0xf
    s_andn2_b64 s[82:83], s[82:83], s[52:53]
    v_cndmask_b32_dpp v7, v7, v7, vcc wave_shr:1 row_mask:0xf bank_mask:0xf
    s_mov_b64 exec, s[54:55]
    s_cbranch_scc0 L2_d119
    s_mov_b64 exec, s[82:83]
    s_nop 1
    v_mfma_f32_4x4x4_16b_bf16 v[88:91], v[12:13], v[84:85], 0
    s_nop 1
    v_mfma_f32_4x4x4_16b_bf16 v[88:91], v[10:11], v[86:87], v[88:91]
    s_nop 4
    v_cvt_pk_bf16_f32 v88, v88, v89
    v_cvt_pk_bf16_f32 v89, v90, v91
    ds_pk_add_bf16 v7, v88 offset:65408
    ds_pk_add_bf16 v7, v89 offset:65412
    s_mov_b64 exec, s[54:55]
    s_branch L2_d119
L2_c120:
    s_lshl_b64 s[52:53], s[82:83], 1
    s_andn2_b64 s[52:53], s[52:53], s[80:81]
    s_andn2_b64 s[52:53], s[52:53], s[50:51]
    s_or_b64 s[80:81], s[80:81], s[52:53]
    s_not_b64 vcc, s[52:53]
    s_mov_b64 exec, -1
    v_cndmask_b32_dpp v84, v84, v84, vcc wave_shr:1 row_mask:0xf bank_mask:0xf
    v_cndmask_b32_dpp v85, v85, v85, vcc wave_shr:1 row_mask:0xf bank_mask:0xf
    s_lshr_b64 s[52:53], s[52:53], 1
    v_cndmask_b32_dpp v86, v86, v86, vcc wave_shr:1 row_mask:0xf bank_mask:0xf
    v_cndmask_b32_dpp v87, v87, v87, vcc wave_shr:1 row_mask:0xf bank_mask:0xf
    s_andn2_b64 s[82:83], s[82:83], s[52:53]
    v_cndmask_b32_dpp v7, v7, v7, vcc wave_shr:1 row_mask:0xf bank_mask:0xf
    s_mov_b64 exec, s[50:51]
    s_cbranch_scc0 L2_d120
    s_mov_b64 exec, s[82:83]
    s_nop 1
    v_mfma_f32_4x4x4_16b_bf16 v[88:91], v[12:13], v[84:85], 0
    s_nop 1
    v_mfma_f32_4x4x4_16b_bf16 v[88:91], v[10:11], v[86:87], v[88:91]
    s_nop 4
    v_cvt_pk_bf16_f32 v88, v88, v89
    v_cvt_pk_bf16_f32 v89, v90, v91
    ds_pk_add_bf16 v7, v88 offset:65408
    ds_pk_add_bf16 v7, v89 offset:65412
    s_mov_b64 exec, s[50:51]
    s_branch L2_d120
L2_c121:
    s_lshl_b64 s[52:53], s[82:83], 1
    s_andn2_b64 s[52:53], s[52:53], s[80:81]
    s_andn2_b64 s[52:53], s[52:53], s[54:55]
    s_or_b64 s[80:81], s[80:81], s[52:53]
    s_not_b64 vcc, s[52:53]
    s_mov_b64 exec, -1
    v_cndmask_b32_dpp v84, v84, v84, vcc wave_shr:1 row_mask:0xf bank_mask:0xf
    v_cndmask_b32_dpp v85, v85, v85, vcc wave_shr:1 row_mask:0xf bank_mask:0xf
    s_lshr_b64 s[52:53], s[52:53], 1
    v_cndmask_b32_dpp v86, v86, v86, vcc wave_shr:1 row_mask:0xf bank_mask:0xf
    v_cndmask_b32_dpp v87, v87, v87, vcc wave_shr:1 row_mask:0xf bank_mask:0xf
    s_andn2_b64 s[82:83], s[82:83], s[52:53]
    v_cndmask_b32_dpp v7, v7, v7, vcc wave_shr:1 row_mask:0xf bank_mask:0xf
    s_mov_b64 exec, s[54:55]
    s_cbranch_scc0 L2_d121
    s_mov_b64 exec, s[82:83]
    s_nop 1
    v_mfma_f32_4x4x4_16b_bf16 v[88:91], v[12:13], v[84:85], 0
    s_nop 1
    v_mfma_f32_4x4x4_16b_bf16 v[88:91], v[10:11], v[86:87], v[88:91]
    s_nop 4
    v_cvt_pk_bf16_f32 v88, v88, v89
    v_cvt_pk_bf16_f32 v89, v90, v91
    ds_pk_add_bf16 v7, v88 offset:65408
    ds_pk_add_bf16 v7, v89 offset:65412
    s_mov_b64 exec, s[54:55]
    s_branch L2_d121
L2_c122:
    s_lshl_b64 s[52:53], s[82:83], 1
    s_andn2_b64 s[52:53], s[52:53], s[80:81]
    s_andn2_b64 s[52:53], s[52:53], s[50:51]
    s_or_b64 s[80:81], s[80:81], s[52:53]
    s_not_b64 vcc, s[52:53]
    s_mov_b64 exec, -1
    v_cndmask_b32_dpp v84, v84, v84, vcc wave_shr:1 row_mask:0xf bank_mask:0xf
    v_cndmask_b32_dpp v85, v85, v85, vcc wave_shr:1 row_mask:0xf bank_mask:0xf
    s_lshr_b64 s[52:53], s[52:53], 1
    v_cndmask_b32_dpp v86, v86, v86, vcc wave_shr:1 row_mask:0xf bank_mask:0xf
    v_cndmask_b32_dpp v87, v87, v87, vcc wave_shr:1 row_mask:0xf bank_mask:0xf
    s_andn2_b64 s[82:83], s[82:83], s[52:53]
    v_cndmask_b32_dpp v7, v7, v7, vcc wave_shr:1 row_mask:0xf bank_mask:0xf
    s_mov_b64 exec, s[50:51]
    s_cbranch_scc0 L2_d122
    s_mov_b64 exec, s[82:83]
    s_nop 1
    v_mfma_f32_4x4x4_16b_bf16 v[88:91], v[12:13], v[84:85], 0
    s_nop 1
    v_mfma_f32_4x4x4_16b_bf16 v[88:91], v[10:11], v[86:87], v[88:91]
    s_nop 4
    v_cvt_pk_bf16_f32 v88, v88, v89
    v_cvt_pk_bf16_f32 v89, v90, v91
    ds_pk_add_bf16 v7, v88 offset:65408
    ds_pk_add_bf16 v7, v89 offset:65412
    s_mov_b64 exec, s[50:51]
    s_branch L2_d122
L2_c123:
    s_lshl_b64 s[52:53], s[82:83], 1
    s_andn2_b64 s[52:53], s[52:53], s[80:81]
    s_andn2_b64 s[52:53], s[52:53], s[54:55]
    s_or_b64 s[80:81], s[80:81], s[52:53]
    s_not_b64 vcc, s[52:53]
    s_mov_b64 exec, -1
    v_cndmask_b32_dpp v84, v84, v84, vcc wave_shr:1 row_mask:0xf bank_mask:0xf
    v_cndmask_b32_dpp v85, v85, v85, vcc wave_shr:1 row_mask:0xf bank_mask:0xf
    s_lshr_b64 s[52:53], s[52:53], 1
    v_cndmask_b32_dpp v86, v86, v86, vcc wave_shr:1 row_mask:0xf bank_mask:0xf
    v_cndmask_b32_dpp v87, v87, v87, vcc wave_shr:1 row_mask:0xf bank_mask:0xf
    s_andn2_b64 s[82:83], s[82:83], s[52:53]
    v_cndmask_b32_dpp v7, v7, v7, vcc wave_shr:1 row_mask:0xf bank_mask:0xf
    s_mov_b64 exec, s[54:55]
    s_cbranch_scc0 L2_d123
    s_mov_b64 exec, s[82:83]
    s_nop 1
    v_mfma_f32_4x4x4_16b_bf16 v[88:91], v[12:13], v[84:85], 0
    s_nop 1
    v_mfma_f32_4x4x4_16b_bf16 v[88:91], v[10:11], v[86:87], v[88:91]
    s_nop 4
    v_cvt_pk_bf16_f32 v88, v88, v89
    v_cvt_pk_bf16_f32 v89, v90, v91
    ds_pk_add_bf16 v7, v88 offset:65408
    ds_pk_add_bf16 v7, v89 offset:65412
    s_mov_b64 exec, s[54:55]
    s_branch L2_d123
L2_c124:
    s_lshl_b64 s[52:53], s[82:83], 1
    s_andn2_b64 s[52:53], s[52:53], s[80:81]
    s_andn2_b64 s[52:53], s[52:53], s[50:51]
    s_or_b64 s[80:81], s[80:81], s[52:53]
    s_not_b64 vcc, s[52:53]
    s_mov_b64 exec, -1
    v_cndmask_b32_dpp v84, v84, v84, vcc wave_shr:1 row_mask:0xf bank_mask:0xf
    v_cndmask_b32_dpp v85, v85, v85, vcc wave_shr:1 row_mask:0xf bank_mask:0xf
    s_lshr_b64 s[52:53], s[52:53], 1
    v_cndmask_b32_dpp v86, v86, v86, vcc wave_shr:1 row_mask:0xf bank_mask:0xf
    v_cndmask_b32_dpp v87, v87, v87, vcc wave_shr:1 row_mask:0xf bank_mask:0xf
    s_andn2_b64 s[82:83], s[82:83], s[52:53]
    v_cndmask_b32_dpp v7, v7, v7, vcc wave_shr:1 row_mask:0xf bank_mask:0xf
    s_mov_b64 exec, s[50:51]
    s_cbranch_scc0 L2_d124
    s_mov_b64 exec, s[82:83]
    s_nop 1
    v_mfma_f32_4x4x4_16b_bf16 v[88:91], v[12:13], v[84:85], 0
    s_nop 1
    v_mfma_f32_4x4x4_16b_bf16 v[88:91], v[10:11], v[86:87], v[88:91]
    s_nop 4
    v_cvt_pk_bf16_f32 v88, v88, v89
    v_cvt_pk_bf16_f32 v89, v90, v91
    ds_pk_add_bf16 v7, v88 offset:65408
    ds_pk_add_bf16 v7, v89 offset:65412
    s_mov_b64 exec, s[50:51]
    s_branch L2_d124
L2_c125:
    s_lshl_b64 s[52:53], s[82:83], 1
    s_andn2_b64 s[52:53], s[52:53], s[80:81]
    s_andn2_b64 s[52:53], s[52:53], s[54:55]
    s_or_b64 s[80:81], s[80:81], s[52:53]
    s_not_b64 vcc, s[52:53]
    s_mov_b64 exec, -1
    v_cndmask_b32_dpp v84, v84, v84, vcc wave_shr:1 row_mask:0xf bank_mask:0xf
    v_cndmask_b32_dpp v85, v85, v85, vcc wave_shr:1 row_mask:0xf bank_mask:0xf
    s_lshr_b64 s[52:53], s[52:53], 1
    v_cndmask_b32_dpp v86, v86, v86, vcc wave_shr:1 row_mask:0xf bank_mask:0xf
    v_cndmask_b32_dpp v87, v87, v87, vcc wave_shr:1 row_mask:0xf bank_mask:0xf
    s_andn2_b64 s[82:83], s[82:83], s[52:53]
    v_cndmask_b32_dpp v7, v7, v7, vcc wave_shr:1 row_mask:0xf bank_mask:0xf
    s_mov_b64 exec, s[54:55]
    s_cbranch_scc0 L2_d125
    s_mov_b64 exec, s[82:83]
    s_nop 1
    v_mfma_f32_4x4x4_16b_bf16 v[88:91], v[12:13], v[84:85], 0
    s_nop 1
    v_mfma_f32_4x4x4_16b_bf16 v[88:91], v[10:11], v[86:87], v[88:91]
    s_nop 4
    v_cvt_pk_bf16_f32 v88, v88, v89
    v_cvt_pk_bf16_f32 v89, v90, v91
    ds_pk_add_bf16 v7, v88 offset:65408
    ds_pk_add_bf16 v7, v89 offset:65412
    s_mov_b64 exec, s[54:55]
    s_branch L2_d125
L2_c126:
    s_lshl_b64 s[52:53], s[82:83], 1
    s_andn2_b64 s[52:53], s[52:53], s[80:81]
    s_andn2_b64 s[52:53], s[52:53], s[50:51]
    s_or_b64 s[80:81], s[80:81], s[52:53]
    s_not_b64 vcc, s[52:53]
    s_mov_b64 exec, -1
    v_cndmask_b32_dpp v84, v84, v84, vcc wave_shr:1 row_mask:0xf bank_mask:0xf
    v_cndmask_b32_dpp v85, v85, v85, vcc wave_shr:1 row_mask:0xf bank_mask:0xf
    s_lshr_b64 s[52:53], s[52:53], 1
    v_cndmask_b32_dpp v86, v86, v86, vcc wave_shr:1 row_mask:0xf bank_mask:0xf
    v_cndmask_b32_dpp v87, v87, v87, vcc wave_shr:1 row_mask:0xf bank_mask:0xf
    s_andn2_b64 s[82:83], s[82:83], s[52:53]
    v_cndmask_b32_dpp v7, v7, v7, vcc wave_shr:1 row_mask:0xf bank_mask:0xf
    s_mov_b64 exec, s[50:51]
    s_cbranch_scc0 L2_d126
    s_mov_b64 exec, s[82:83]
    s_nop 1
    v_mfma_f32_4x4x4_16b_bf16 v[88:91], v[12:13], v[84:85], 0
    s_nop 1
    v_mfma_f32_4x4x4_16b_bf16 v[88:91], v[10:11], v[86:87], v[88:91]
    s_nop 4
    v_cvt_pk_bf16_f32 v88, v88, v89
    v_cvt_pk_bf16_f32 v89, v90, v91
    ds_pk_add_bf16 v7, v88 offset:65408
    ds_pk_add_bf16 v7, v89 offset:65412
    s_mov_b64 exec, s[50:51]
    s_branch L2_d126
L2_oa127:
    s_waitcnt vmcnt(5)
    s_mov_b64 exec, s[6:7]
    v_lshrrev_b32 v114, 16, v114
    s_mov_b64 exec, -1
    v_and_b32 v46, 0x10000000, v20
    v_cmpx_eq_u32 vcc, 0, v46
    v_lshrrev_b32 v47, 14, v112
    v_and_b32 v47, v5, v47
    ds_read_b64 v[96:97], v47
    v_perm_b32 v98, v112, v114, s44
    v_bitop3_b32 v99, v112, 0.5, -0.5 bitop3:0xa8
    v_bitop3_b32 v98, v6, v98, v99 bitop3:0xca
    v_and_b32 v47, v5, v112
    s_waitcnt lgkmcnt(0)
    v_mfma_f32_4x4x4_16b_bf16 v[88:91], v[8:9], v[96:97], 0
    s_nop 4
    v_mul_f32 v88, v98, v88
    v_mul_f32 v89, v98, v89
    v_mul_f32 v90, v98, v90
    v_mul_f32 v91, v98, v91
    v_cvt_pk_bf16_f32 v88, v88, v89
    v_cvt_pk_bf16_f32 v89, v90, v91
    ds_pk_add_bf16 v47, v88 offset:65408
    ds_pk_add_bf16 v47, v89 offset:65412
    s_mov_b64 exec, -1
    v_and_b32 v46, 0x20000000, v20
    v_cmpx_eq_u32 vcc, 0, v46
    v_lshrrev_b32 v47, 14, v113
    v_and_b32 v47, v5, v47
    ds_read_b64 v[96:97], v47
    v_perm_b32 v98, v113, v114, s45
    v_bitop3_b32 v99, v113, 0.5, -0.5 bitop3:0xa8
    v_bitop3_b32 v98, v6, v98, v99 bitop3:0xca
    v_and_b32 v47, v5, v113
    s_waitcnt lgkmcnt(0)
    v_mfma_f32_4x4x4_16b_bf16 v[88:91], v[8:9], v[96:97], 0
    s_nop 4
    v_mul_f32 v88, v98, v88
    v_mul_f32 v89, v98, v89
    v_mul_f32 v90, v98, v90
    v_mul_f32 v91, v98, v91
    v_cvt_pk_bf16_f32 v88, v88, v89
    v_cvt_pk_bf16_f32 v89, v90, v91
    ds_pk_add_bf16 v47, v88 offset:65408
    ds_pk_add_bf16 v47, v89 offset:65412
    s_mov_b64 exec, -1
    s_branch L2_ob127
L2_c128:
    s_lshl_b64 s[52:53], s[82:83], 1
    s_andn2_b64 s[52:53], s[52:53], s[80:81]
    s_andn2_b64 s[52:53], s[52:53], s[54:55]
    s_or_b64 s[80:81], s[80:81], s[52:53]
    s_not_b64 vcc, s[52:53]
    s_mov_b64 exec, -1
    v_cndmask_b32_dpp v84, v84, v84, vcc wave_shr:1 row_mask:0xf bank_mask:0xf
    v_cndmask_b32_dpp v85, v85, v85, vcc wave_shr:1 row_mask:0xf bank_mask:0xf
    s_lshr_b64 s[52:53], s[52:53], 1
    v_cndmask_b32_dpp v86, v86, v86, vcc wave_shr:1 row_mask:0xf bank_mask:0xf
    v_cndmask_b32_dpp v87, v87, v87, vcc wave_shr:1 row_mask:0xf bank_mask:0xf
    s_andn2_b64 s[82:83], s[82:83], s[52:53]
    v_cndmask_b32_dpp v7, v7, v7, vcc wave_shr:1 row_mask:0xf bank_mask:0xf
    s_mov_b64 exec, s[54:55]
    s_cbranch_scc0 L2_d128
    s_mov_b64 exec, s[82:83]
    s_nop 1
    v_mfma_f32_4x4x4_16b_bf16 v[88:91], v[12:13], v[84:85], 0
    s_nop 1
    v_mfma_f32_4x4x4_16b_bf16 v[88:91], v[10:11], v[86:87], v[88:91]
    s_nop 4
    v_cvt_pk_bf16_f32 v88, v88, v89
    v_cvt_pk_bf16_f32 v89, v90, v91
    ds_pk_add_bf16 v7, v88 offset:65408
    ds_pk_add_bf16 v7, v89 offset:65412
    s_mov_b64 exec, s[54:55]
    s_branch L2_d128
L2_c129:
    s_lshl_b64 s[52:53], s[82:83], 1
    s_andn2_b64 s[52:53], s[52:53], s[80:81]
    s_andn2_b64 s[52:53], s[52:53], s[50:51]
    s_or_b64 s[80:81], s[80:81], s[52:53]
    s_not_b64 vcc, s[52:53]
    s_mov_b64 exec, -1
    v_cndmask_b32_dpp v84, v84, v84, vcc wave_shr:1 row_mask:0xf bank_mask:0xf
    v_cndmask_b32_dpp v85, v85, v85, vcc wave_shr:1 row_mask:0xf bank_mask:0xf
    s_lshr_b64 s[52:53], s[52:53], 1
    v_cndmask_b32_dpp v86, v86, v86, vcc wave_shr:1 row_mask:0xf bank_mask:0xf
    v_cndmask_b32_dpp v87, v87, v87, vcc wave_shr:1 row_mask:0xf bank_mask:0xf
    s_andn2_b64 s[82:83], s[82:83], s[52:53]
    v_cndmask_b32_dpp v7, v7, v7, vcc wave_shr:1 row_mask:0xf bank_mask:0xf
    s_mov_b64 exec, s[50:51]
    s_cbranch_scc0 L2_d129
    s_mov_b64 exec, s[82:83]
    s_nop 1
    v_mfma_f32_4x4x4_16b_bf16 v[88:91], v[12:13], v[84:85], 0
    s_nop 1
    v_mfma_f32_4x4x4_16b_bf16 v[88:91], v[10:11], v[86:87], v[88:91]
    s_nop 4
    v_cvt_pk_bf16_f32 v88, v88, v89
    v_cvt_pk_bf16_f32 v89, v90, v91
    ds_pk_add_bf16 v7, v88 offset:65408
    ds_pk_add_bf16 v7, v89 offset:65412
    s_mov_b64 exec, s[50:51]
    s_branch L2_d129
L2_c130:
    s_lshl_b64 s[52:53], s[82:83], 1
    s_andn2_b64 s[52:53], s[52:53], s[80:81]
    s_andn2_b64 s[52:53], s[52:53], s[54:55]
    s_or_b64 s[80:81], s[80:81], s[52:53]
    s_not_b64 vcc, s[52:53]
    s_mov_b64 exec, -1
    v_cndmask_b32_dpp v84, v84, v84, vcc wave_shr:1 row_mask:0xf bank_mask:0xf
    v_cndmask_b32_dpp v85, v85, v85, vcc wave_shr:1 row_mask:0xf bank_mask:0xf
    s_lshr_b64 s[52:53], s[52:53], 1
    v_cndmask_b32_dpp v86, v86, v86, vcc wave_shr:1 row_mask:0xf bank_mask:0xf
    v_cndmask_b32_dpp v87, v87, v87, vcc wave_shr:1 row_mask:0xf bank_mask:0xf
    s_andn2_b64 s[82:83], s[82:83], s[52:53]
    v_cndmask_b32_dpp v7, v7, v7, vcc wave_shr:1 row_mask:0xf bank_mask:0xf
    s_mov_b64 exec, s[54:55]
    s_cbranch_scc0 L2_d130
    s_mov_b64 exec, s[82:83]
    s_nop 1
    v_mfma_f32_4x4x4_16b_bf16 v[88:91], v[12:13], v[84:85], 0
    s_nop 1
    v_mfma_f32_4x4x4_16b_bf16 v[88:91], v[10:11], v[86:87], v[88:91]
    s_nop 4
    v_cvt_pk_bf16_f32 v88, v88, v89
    v_cvt_pk_bf16_f32 v89, v90, v91
    ds_pk_add_bf16 v7, v88 offset:65408
    ds_pk_add_bf16 v7, v89 offset:65412
    s_mov_b64 exec, s[54:55]
    s_branch L2_d130
L2_c131:
    s_lshl_b64 s[52:53], s[82:83], 1
    s_andn2_b64 s[52:53], s[52:53], s[80:81]
    s_andn2_b64 s[52:53], s[52:53], s[50:51]
    s_or_b64 s[80:81], s[80:81], s[52:53]
    s_not_b64 vcc, s[52:53]
    s_mov_b64 exec, -1
    v_cndmask_b32_dpp v84, v84, v84, vcc wave_shr:1 row_mask:0xf bank_mask:0xf
    v_cndmask_b32_dpp v85, v85, v85, vcc wave_shr:1 row_mask:0xf bank_mask:0xf
    s_lshr_b64 s[52:53], s[52:53], 1
    v_cndmask_b32_dpp v86, v86, v86, vcc wave_shr:1 row_mask:0xf bank_mask:0xf
    v_cndmask_b32_dpp v87, v87, v87, vcc wave_shr:1 row_mask:0xf bank_mask:0xf
    s_andn2_b64 s[82:83], s[82:83], s[52:53]
    v_cndmask_b32_dpp v7, v7, v7, vcc wave_shr:1 row_mask:0xf bank_mask:0xf
    s_mov_b64 exec, s[50:51]
    s_cbranch_scc0 L2_d131
    s_mov_b64 exec, s[82:83]
    s_nop 1
    v_mfma_f32_4x4x4_16b_bf16 v[88:91], v[12:13], v[84:85], 0
    s_nop 1
    v_mfma_f32_4x4x4_16b_bf16 v[88:91], v[10:11], v[86:87], v[88:91]
    s_nop 4
    v_cvt_pk_bf16_f32 v88, v88, v89
    v_cvt_pk_bf16_f32 v89, v90, v91
    ds_pk_add_bf16 v7, v88 offset:65408
    ds_pk_add_bf16 v7, v89 offset:65412
    s_mov_b64 exec, s[50:51]
    s_branch L2_d131
L2_c132:
    s_lshl_b64 s[52:53], s[82:83], 1
    s_andn2_b64 s[52:53], s[52:53], s[80:81]
    s_andn2_b64 s[52:53], s[52:53], s[54:55]
    s_or_b64 s[80:81], s[80:81], s[52:53]
    s_not_b64 vcc, s[52:53]
    s_mov_b64 exec, -1
    v_cndmask_b32_dpp v84, v84, v84, vcc wave_shr:1 row_mask:0xf bank_mask:0xf
    v_cndmask_b32_dpp v85, v85, v85, vcc wave_shr:1 row_mask:0xf bank_mask:0xf
    s_lshr_b64 s[52:53], s[52:53], 1
    v_cndmask_b32_dpp v86, v86, v86, vcc wave_shr:1 row_mask:0xf bank_mask:0xf
    v_cndmask_b32_dpp v87, v87, v87, vcc wave_shr:1 row_mask:0xf bank_mask:0xf
    s_andn2_b64 s[82:83], s[82:83], s[52:53]
    v_cndmask_b32_dpp v7, v7, v7, vcc wave_shr:1 row_mask:0xf bank_mask:0xf
    s_mov_b64 exec, s[54:55]
    s_cbranch_scc0 L2_d132
    s_mov_b64 exec, s[82:83]
    s_nop 1
    v_mfma_f32_4x4x4_16b_bf16 v[88:91], v[12:13], v[84:85], 0
    s_nop 1
    v_mfma_f32_4x4x4_16b_bf16 v[88:91], v[10:11], v[86:87], v[88:91]
    s_nop 4
    v_cvt_pk_bf16_f32 v88, v88, v89
    v_cvt_pk_bf16_f32 v89, v90, v91
    ds_pk_add_bf16 v7, v88 offset:65408
    ds_pk_add_bf16 v7, v89 offset:65412
    s_mov_b64 exec, s[54:55]
    s_branch L2_d132
L2_c133:
    s_lshl_b64 s[52:53], s[82:83], 1
    s_andn2_b64 s[52:53], s[52:53], s[80:81]
    s_andn2_b64 s[52:53], s[52:53], s[50:51]
    s_or_b64 s[80:81], s[80:81], s[52:53]
    s_not_b64 vcc, s[52:53]
    s_mov_b64 exec, -1
    v_cndmask_b32_dpp v84, v84, v84, vcc wave_shr:1 row_mask:0xf bank_mask:0xf
    v_cndmask_b32_dpp v85, v85, v85, vcc wave_shr:1 row_mask:0xf bank_mask:0xf
    s_lshr_b64 s[52:53], s[52:53], 1
    v_cndmask_b32_dpp v86, v86, v86, vcc wave_shr:1 row_mask:0xf bank_mask:0xf
    v_cndmask_b32_dpp v87, v87, v87, vcc wave_shr:1 row_mask:0xf bank_mask:0xf
    s_andn2_b64 s[82:83], s[82:83], s[52:53]
    v_cndmask_b32_dpp v7, v7, v7, vcc wave_shr:1 row_mask:0xf bank_mask:0xf
    s_mov_b64 exec, s[50:51]
    s_cbranch_scc0 L2_d133
    s_mov_b64 exec, s[82:83]
    s_nop 1
    v_mfma_f32_4x4x4_16b_bf16 v[88:91], v[12:13], v[84:85], 0
    s_nop 1
    v_mfma_f32_4x4x4_16b_bf16 v[88:91], v[10:11], v[86:87], v[88:91]
    s_nop 4
    v_cvt_pk_bf16_f32 v88, v88, v89
    v_cvt_pk_bf16_f32 v89, v90, v91
    ds_pk_add_bf16 v7, v88 offset:65408
    ds_pk_add_bf16 v7, v89 offset:65412
    s_mov_b64 exec, s[50:51]
    s_branch L2_d133
L2_oa134:
    v_and_b32 v47, 0x0fffffff, v21
    buffer_load_dword v114, v47, s[8:11], 0 offen offset:16
    s_mov_b64 exec, s[6:7]
    v_add_u32 v47, 8, v47
    v_lshrrev_b32 v21, 2, v21
    s_mov_b64 exec, -1
    buffer_load_dwordx2 v[112:113], v47, s[8:11], 0 offen
    s_branch L2_ob134
L2_c135:
    s_lshl_b64 s[52:53], s[82:83], 1
    s_andn2_b64 s[52:53], s[52:53], s[80:81]
    s_andn2_b64 s[52:53], s[52:53], s[54:55]
    s_or_b64 s[80:81], s[80:81], s[52:53]
    s_not_b64 vcc, s[52:53]
    s_mov_b64 exec, -1
    v_cndmask_b32_dpp v84, v84, v84, vcc wave_shr:1 row_mask:0xf bank_mask:0xf
    v_cndmask_b32_dpp v85, v85, v85, vcc wave_shr:1 row_mask:0xf bank_mask:0xf
    s_lshr_b64 s[52:53], s[52:53], 1
    v_cndmask_b32_dpp v86, v86, v86, vcc wave_shr:1 row_mask:0xf bank_mask:0xf
    v_cndmask_b32_dpp v87, v87, v87, vcc wave_shr:1 row_mask:0xf bank_mask:0xf
    s_andn2_b64 s[82:83], s[82:83], s[52:53]
    v_cndmask_b32_dpp v7, v7, v7, vcc wave_shr:1 row_mask:0xf bank_mask:0xf
    s_mov_b64 exec, s[54:55]
    s_cbranch_scc0 L2_d135
    s_mov_b64 exec, s[82:83]
    s_nop 1
    v_mfma_f32_4x4x4_16b_bf16 v[88:91], v[12:13], v[84:85], 0
    s_nop 1
    v_mfma_f32_4x4x4_16b_bf16 v[88:91], v[10:11], v[86:87], v[88:91]
    s_nop 4
    v_cvt_pk_bf16_f32 v88, v88, v89
    v_cvt_pk_bf16_f32 v89, v90, v91
    ds_pk_add_bf16 v7, v88 offset:65408
    ds_pk_add_bf16 v7, v89 offset:65412
    s_mov_b64 exec, s[54:55]
    s_branch L2_d135
L2_c136:
    s_lshl_b64 s[52:53], s[82:83], 1
    s_andn2_b64 s[52:53], s[52:53], s[80:81]
    s_andn2_b64 s[52:53], s[52:53], s[50:51]
    s_or_b64 s[80:81], s[80:81], s[52:53]
    s_not_b64 vcc, s[52:53]
    s_mov_b64 exec, -1
    v_cndmask_b32_dpp v84, v84, v84, vcc wave_shr:1 row_mask:0xf bank_mask:0xf
    v_cndmask_b32_dpp v85, v85, v85, vcc wave_shr:1 row_mask:0xf bank_mask:0xf
    s_lshr_b64 s[52:53], s[52:53], 1
    v_cndmask_b32_dpp v86, v86, v86, vcc wave_shr:1 row_mask:0xf bank_mask:0xf
    v_cndmask_b32_dpp v87, v87, v87, vcc wave_shr:1 row_mask:0xf bank_mask:0xf
    s_andn2_b64 s[82:83], s[82:83], s[52:53]
    v_cndmask_b32_dpp v7, v7, v7, vcc wave_shr:1 row_mask:0xf bank_mask:0xf
    s_mov_b64 exec, s[50:51]
    s_cbranch_scc0 L2_d136
    s_mov_b64 exec, s[82:83]
    s_nop 1
    v_mfma_f32_4x4x4_16b_bf16 v[88:91], v[12:13], v[84:85], 0
    s_nop 1
    v_mfma_f32_4x4x4_16b_bf16 v[88:91], v[10:11], v[86:87], v[88:91]
    s_nop 4
    v_cvt_pk_bf16_f32 v88, v88, v89
    v_cvt_pk_bf16_f32 v89, v90, v91
    ds_pk_add_bf16 v7, v88 offset:65408
    ds_pk_add_bf16 v7, v89 offset:65412
    s_mov_b64 exec, s[50:51]
    s_branch L2_d136
L2_c137:
    s_lshl_b64 s[52:53], s[82:83], 1
    s_andn2_b64 s[52:53], s[52:53], s[80:81]
    s_andn2_b64 s[52:53], s[52:53], s[54:55]
    s_or_b64 s[80:81], s[80:81], s[52:53]
    s_not_b64 vcc, s[52:53]
    s_mov_b64 exec, -1
    v_cndmask_b32_dpp v84, v84, v84, vcc wave_shr:1 row_mask:0xf bank_mask:0xf
    v_cndmask_b32_dpp v85, v85, v85, vcc wave_shr:1 row_mask:0xf bank_mask:0xf
    s_lshr_b64 s[52:53], s[52:53], 1
    v_cndmask_b32_dpp v86, v86, v86, vcc wave_shr:1 row_mask:0xf bank_mask:0xf
    v_cndmask_b32_dpp v87, v87, v87, vcc wave_shr:1 row_mask:0xf bank_mask:0xf
    s_andn2_b64 s[82:83], s[82:83], s[52:53]
    v_cndmask_b32_dpp v7, v7, v7, vcc wave_shr:1 row_mask:0xf bank_mask:0xf
    s_mov_b64 exec, s[54:55]
    s_cbranch_scc0 L2_d137
    s_mov_b64 exec, s[82:83]
    s_nop 1
    v_mfma_f32_4x4x4_16b_bf16 v[88:91], v[12:13], v[84:85], 0
    s_nop 1
    v_mfma_f32_4x4x4_16b_bf16 v[88:91], v[10:11], v[86:87], v[88:91]
    s_nop 4
    v_cvt_pk_bf16_f32 v88, v88, v89
    v_cvt_pk_bf16_f32 v89, v90, v91
    ds_pk_add_bf16 v7, v88 offset:65408
    ds_pk_add_bf16 v7, v89 offset:65412
    s_mov_b64 exec, s[54:55]
    s_branch L2_d137
L2_c138:
    s_lshl_b64 s[52:53], s[82:83], 1
    s_andn2_b64 s[52:53], s[52:53], s[80:81]
    s_andn2_b64 s[52:53], s[52:53], s[50:51]
    s_or_b64 s[80:81], s[80:81], s[52:53]
    s_not_b64 vcc, s[52:53]
    s_mov_b64 exec, -1
    v_cndmask_b32_dpp v84, v84, v84, vcc wave_shr:1 row_mask:0xf bank_mask:0xf
    v_cndmask_b32_dpp v85, v85, v85, vcc wave_shr:1 row_mask:0xf bank_mask:0xf
    s_lshr_b64 s[52:53], s[52:53], 1
    v_cndmask_b32_dpp v86, v86, v86, vcc wave_shr:1 row_mask:0xf bank_mask:0xf
    v_cndmask_b32_dpp v87, v87, v87, vcc wave_shr:1 row_mask:0xf bank_mask:0xf
    s_andn2_b64 s[82:83], s[82:83], s[52:53]
    v_cndmask_b32_dpp v7, v7, v7, vcc wave_shr:1 row_mask:0xf bank_mask:0xf
    s_mov_b64 exec, s[50:51]
    s_cbranch_scc0 L2_d138
    s_mov_b64 exec, s[82:83]
    s_nop 1
    v_mfma_f32_4x4x4_16b_bf16 v[88:91], v[12:13], v[84:85], 0
    s_nop 1
    v_mfma_f32_4x4x4_16b_bf16 v[88:91], v[10:11], v[86:87], v[88:91]
    s_nop 4
    v_cvt_pk_bf16_f32 v88, v88, v89
    v_cvt_pk_bf16_f32 v89, v90, v91
    ds_pk_add_bf16 v7, v88 offset:65408
    ds_pk_add_bf16 v7, v89 offset:65412
    s_mov_b64 exec, s[50:51]
    s_branch L2_d138
L2_c139:
    s_lshl_b64 s[52:53], s[82:83], 1
    s_andn2_b64 s[52:53], s[52:53], s[80:81]
    s_andn2_b64 s[52:53], s[52:53], s[54:55]
    s_or_b64 s[80:81], s[80:81], s[52:53]
    s_not_b64 vcc, s[52:53]
    s_mov_b64 exec, -1
    v_cndmask_b32_dpp v84, v84, v84, vcc wave_shr:1 row_mask:0xf bank_mask:0xf
    v_cndmask_b32_dpp v85, v85, v85, vcc wave_shr:1 row_mask:0xf bank_mask:0xf
    s_lshr_b64 s[52:53], s[52:53], 1
    v_cndmask_b32_dpp v86, v86, v86, vcc wave_shr:1 row_mask:0xf bank_mask:0xf
    v_cndmask_b32_dpp v87, v87, v87, vcc wave_shr:1 row_mask:0xf bank_mask:0xf
    s_andn2_b64 s[82:83], s[82:83], s[52:53]
    v_cndmask_b32_dpp v7, v7, v7, vcc wave_shr:1 row_mask:0xf bank_mask:0xf
    s_mov_b64 exec, s[54:55]
    s_cbranch_scc0 L2_d139
    s_mov_b64 exec, s[82:83]
    s_nop 1
    v_mfma_f32_4x4x4_16b_bf16 v[88:91], v[12:13], v[84:85], 0
    s_nop 1
    v_mfma_f32_4x4x4_16b_bf16 v[88:91], v[10:11], v[86:87], v[88:91]
    s_nop 4
    v_cvt_pk_bf16_f32 v88, v88, v89
    v_cvt_pk_bf16_f32 v89, v90, v91
    ds_pk_add_bf16 v7, v88 offset:65408
    ds_pk_add_bf16 v7, v89 offset:65412
    s_mov_b64 exec, s[54:55]
    s_branch L2_d139
L2_c140:
    s_lshl_b64 s[52:53], s[82:83], 1
    s_andn2_b64 s[52:53], s[52:53], s[80:81]
    s_andn2_b64 s[52:53], s[52:53], s[50:51]
    s_or_b64 s[80:81], s[80:81], s[52:53]
    s_not_b64 vcc, s[52:53]
    s_mov_b64 exec, -1
    v_cndmask_b32_dpp v84, v84, v84, vcc wave_shr:1 row_mask:0xf bank_mask:0xf
    v_cndmask_b32_dpp v85, v85, v85, vcc wave_shr:1 row_mask:0xf bank_mask:0xf
    s_lshr_b64 s[52:53], s[52:53], 1
    v_cndmask_b32_dpp v86, v86, v86, vcc wave_shr:1 row_mask:0xf bank_mask:0xf
    v_cndmask_b32_dpp v87, v87, v87, vcc wave_shr:1 row_mask:0xf bank_mask:0xf
    s_andn2_b64 s[82:83], s[82:83], s[52:53]
    v_cndmask_b32_dpp v7, v7, v7, vcc wave_shr:1 row_mask:0xf bank_mask:0xf
    s_mov_b64 exec, s[50:51]
    s_cbranch_scc0 L2_d140
    s_mov_b64 exec, s[82:83]
    s_nop 1
    v_mfma_f32_4x4x4_16b_bf16 v[88:91], v[12:13], v[84:85], 0
    s_nop 1
    v_mfma_f32_4x4x4_16b_bf16 v[88:91], v[10:11], v[86:87], v[88:91]
    s_nop 4
    v_cvt_pk_bf16_f32 v88, v88, v89
    v_cvt_pk_bf16_f32 v89, v90, v91
    ds_pk_add_bf16 v7, v88 offset:65408
    ds_pk_add_bf16 v7, v89 offset:65412
    s_mov_b64 exec, s[50:51]
    s_branch L2_d140
L2_c141:
    s_lshl_b64 s[52:53], s[82:83], 1
    s_andn2_b64 s[52:53], s[52:53], s[80:81]
    s_andn2_b64 s[52:53], s[52:53], s[54:55]
    s_or_b64 s[80:81], s[80:81], s[52:53]
    s_not_b64 vcc, s[52:53]
    s_mov_b64 exec, -1
    v_cndmask_b32_dpp v84, v84, v84, vcc wave_shr:1 row_mask:0xf bank_mask:0xf
    v_cndmask_b32_dpp v85, v85, v85, vcc wave_shr:1 row_mask:0xf bank_mask:0xf
    s_lshr_b64 s[52:53], s[52:53], 1
    v_cndmask_b32_dpp v86, v86, v86, vcc wave_shr:1 row_mask:0xf bank_mask:0xf
    v_cndmask_b32_dpp v87, v87, v87, vcc wave_shr:1 row_mask:0xf bank_mask:0xf
    s_andn2_b64 s[82:83], s[82:83], s[52:53]
    v_cndmask_b32_dpp v7, v7, v7, vcc wave_shr:1 row_mask:0xf bank_mask:0xf
    s_mov_b64 exec, s[54:55]
    s_cbranch_scc0 L2_d141
    s_mov_b64 exec, s[82:83]
    s_nop 1
    v_mfma_f32_4x4x4_16b_bf16 v[88:91], v[12:13], v[84:85], 0
    s_nop 1
    v_mfma_f32_4x4x4_16b_bf16 v[88:91], v[10:11], v[86:87], v[88:91]
    s_nop 4
    v_cvt_pk_bf16_f32 v88, v88, v89
    v_cvt_pk_bf16_f32 v89, v90, v91
    ds_pk_add_bf16 v7, v88 offset:65408
    ds_pk_add_bf16 v7, v89 offset:65412
    s_mov_b64 exec, s[54:55]
    s_branch L2_d141
L2_c142:
    s_lshl_b64 s[52:53], s[82:83], 1
    s_andn2_b64 s[52:53], s[52:53], s[80:81]
    s_andn2_b64 s[52:53], s[52:53], s[50:51]
    s_or_b64 s[80:81], s[80:81], s[52:53]
    s_not_b64 vcc, s[52:53]
    s_mov_b64 exec, -1
    v_cndmask_b32_dpp v84, v84, v84, vcc wave_shr:1 row_mask:0xf bank_mask:0xf
    v_cndmask_b32_dpp v85, v85, v85, vcc wave_shr:1 row_mask:0xf bank_mask:0xf
    s_lshr_b64 s[52:53], s[52:53], 1
    v_cndmask_b32_dpp v86, v86, v86, vcc wave_shr:1 row_mask:0xf bank_mask:0xf
    v_cndmask_b32_dpp v87, v87, v87, vcc wave_shr:1 row_mask:0xf bank_mask:0xf
    s_andn2_b64 s[82:83], s[82:83], s[52:53]
    v_cndmask_b32_dpp v7, v7, v7, vcc wave_shr:1 row_mask:0xf bank_mask:0xf
    s_mov_b64 exec, s[50:51]
    s_cbranch_scc0 L2_d142
    s_mov_b64 exec, s[82:83]
    s_nop 1
    v_mfma_f32_4x4x4_16b_bf16 v[88:91], v[12:13], v[84:85], 0
    s_nop 1
    v_mfma_f32_4x4x4_16b_bf16 v[88:91], v[10:11], v[86:87], v[88:91]
    s_nop 4
    v_cvt_pk_bf16_f32 v88, v88, v89
    v_cvt_pk_bf16_f32 v89, v90, v91
    ds_pk_add_bf16 v7, v88 offset:65408
    ds_pk_add_bf16 v7, v89 offset:65412
    s_mov_b64 exec, s[50:51]
    s_branch L2_d142
L2_oa143:
    s_waitcnt vmcnt(7)
    s_mov_b64 exec, s[6:7]
    v_lshrrev_b32 v114, 16, v114
    s_mov_b64 exec, -1
    v_and_b32 v46, 0x10000000, v21
    v_cmpx_eq_u32 vcc, 0, v46
    v_lshrrev_b32 v47, 14, v112
    v_and_b32 v47, v5, v47
    ds_read_b64 v[96:97], v47
    v_perm_b32 v98, v112, v114, s44
    v_bitop3_b32 v99, v112, 0.5, -0.5 bitop3:0xa8
    v_bitop3_b32 v98, v6, v98, v99 bitop3:0xca
    v_and_b32 v47, v5, v112
    s_waitcnt lgkmcnt(0)
    v_mfma_f32_4x4x4_16b_bf16 v[88:91], v[8:9], v[96:97], 0
    s_nop 4
    v_mul_f32 v88, v98, v88
    v_mul_f32 v89, v98, v89
    v_mul_f32 v90, v98, v90
    v_mul_f32 v91, v98, v91
    v_cvt_pk_bf16_f32 v88, v88, v89
    v_cvt_pk_bf16_f32 v89, v90, v91
    ds_pk_add_bf16 v47, v88 offset:65408
    ds_pk_add_bf16 v47, v89 offset:65412
    s_mov_b64 exec, -1
    v_and_b32 v46, 0x20000000, v21
    v_cmpx_eq_u32 vcc, 0, v46
    v_lshrrev_b32 v47, 14, v113
    v_and_b32 v47, v5, v47
    ds_read_b64 v[96:97], v47
    v_perm_b32 v98, v113, v114, s45
    v_bitop3_b32 v99, v113, 0.5, -0.5 bitop3:0xa8
    v_bitop3_b32 v98, v6, v98, v99 bitop3:0xca
    v_and_b32 v47, v5, v113
    s_waitcnt lgkmcnt(0)
    v_mfma_f32_4x4x4_16b_bf16 v[88:91], v[8:9], v[96:97], 0
    s_nop 4
    v_mul_f32 v88, v98, v88
    v_mul_f32 v89, v98, v89
    v_mul_f32 v90, v98, v90
    v_mul_f32 v91, v98, v91
    v_cvt_pk_bf16_f32 v88, v88, v89
    v_cvt_pk_bf16_f32 v89, v90, v91
    ds_pk_add_bf16 v47, v88 offset:65408
    ds_pk_add_bf16 v47, v89 offset:65412
    s_mov_b64 exec, -1
    s_branch L2_ob143
L2_c144:
    s_lshl_b64 s[52:53], s[82:83], 1
    s_andn2_b64 s[52:53], s[52:53], s[80:81]
    s_andn2_b64 s[52:53], s[52:53], s[54:55]
    s_or_b64 s[80:81], s[80:81], s[52:53]
    s_not_b64 vcc, s[52:53]
    s_mov_b64 exec, -1
    v_cndmask_b32_dpp v84, v84, v84, vcc wave_shr:1 row_mask:0xf bank_mask:0xf
    v_cndmask_b32_dpp v85, v85, v85, vcc wave_shr:1 row_mask:0xf bank_mask:0xf
    s_lshr_b64 s[52:53], s[52:53], 1
    v_cndmask_b32_dpp v86, v86, v86, vcc wave_shr:1 row_mask:0xf bank_mask:0xf
    v_cndmask_b32_dpp v87, v87, v87, vcc wave_shr:1 row_mask:0xf bank_mask:0xf
    s_andn2_b64 s[82:83], s[82:83], s[52:53]
    v_cndmask_b32_dpp v7, v7, v7, vcc wave_shr:1 row_mask:0xf bank_mask:0xf
    s_mov_b64 exec, s[54:55]
    s_cbranch_scc0 L2_d144
    s_mov_b64 exec, s[82:83]
    s_nop 1
    v_mfma_f32_4x4x4_16b_bf16 v[88:91], v[12:13], v[84:85], 0
    s_nop 1
    v_mfma_f32_4x4x4_16b_bf16 v[88:91], v[10:11], v[86:87], v[88:91]
    s_nop 4
    v_cvt_pk_bf16_f32 v88, v88, v89
    v_cvt_pk_bf16_f32 v89, v90, v91
    ds_pk_add_bf16 v7, v88 offset:65408
    ds_pk_add_bf16 v7, v89 offset:65412
    s_mov_b64 exec, s[54:55]
    s_branch L2_d144
L2_c145:
    s_lshl_b64 s[52:53], s[82:83], 1
    s_andn2_b64 s[52:53], s[52:53], s[80:81]
    s_andn2_b64 s[52:53], s[52:53], s[50:51]
    s_or_b64 s[80:81], s[80:81], s[52:53]
    s_not_b64 vcc, s[52:53]
    s_mov_b64 exec, -1
    v_cndmask_b32_dpp v84, v84, v84, vcc wave_shr:1 row_mask:0xf bank_mask:0xf
    v_cndmask_b32_dpp v85, v85, v85, vcc wave_shr:1 row_mask:0xf bank_mask:0xf
    s_lshr_b64 s[52:53], s[52:53], 1
    v_cndmask_b32_dpp v86, v86, v86, vcc wave_shr:1 row_mask:0xf bank_mask:0xf
    v_cndmask_b32_dpp v87, v87, v87, vcc wave_shr:1 row_mask:0xf bank_mask:0xf
    s_andn2_b64 s[82:83], s[82:83], s[52:53]
    v_cndmask_b32_dpp v7, v7, v7, vcc wave_shr:1 row_mask:0xf bank_mask:0xf
    s_mov_b64 exec, s[50:51]
    s_cbranch_scc0 L2_d145
    s_mov_b64 exec, s[82:83]
    s_nop 1
    v_mfma_f32_4x4x4_16b_bf16 v[88:91], v[12:13], v[84:85], 0
    s_nop 1
    v_mfma_f32_4x4x4_16b_bf16 v[88:91], v[10:11], v[86:87], v[88:91]
    s_nop 4
    v_cvt_pk_bf16_f32 v88, v88, v89
    v_cvt_pk_bf16_f32 v89, v90, v91
    ds_pk_add_bf16 v7, v88 offset:65408
    ds_pk_add_bf16 v7, v89 offset:65412
    s_mov_b64 exec, s[50:51]
    s_branch L2_d145
L2_c146:
    s_lshl_b64 s[52:53], s[82:83], 1
    s_andn2_b64 s[52:53], s[52:53], s[80:81]
    s_andn2_b64 s[52:53], s[52:53], s[54:55]
    s_or_b64 s[80:81], s[80:81], s[52:53]
    s_not_b64 vcc, s[52:53]
    s_mov_b64 exec, -1
    v_cndmask_b32_dpp v84, v84, v84, vcc wave_shr:1 row_mask:0xf bank_mask:0xf
    v_cndmask_b32_dpp v85, v85, v85, vcc wave_shr:1 row_mask:0xf bank_mask:0xf
    s_lshr_b64 s[52:53], s[52:53], 1
    v_cndmask_b32_dpp v86, v86, v86, vcc wave_shr:1 row_mask:0xf bank_mask:0xf
    v_cndmask_b32_dpp v87, v87, v87, vcc wave_shr:1 row_mask:0xf bank_mask:0xf
    s_andn2_b64 s[82:83], s[82:83], s[52:53]
    v_cndmask_b32_dpp v7, v7, v7, vcc wave_shr:1 row_mask:0xf bank_mask:0xf
    s_mov_b64 exec, s[54:55]
    s_cbranch_scc0 L2_d146
    s_mov_b64 exec, s[82:83]
    s_nop 1
    v_mfma_f32_4x4x4_16b_bf16 v[88:91], v[12:13], v[84:85], 0
    s_nop 1
    v_mfma_f32_4x4x4_16b_bf16 v[88:91], v[10:11], v[86:87], v[88:91]
    s_nop 4
    v_cvt_pk_bf16_f32 v88, v88, v89
    v_cvt_pk_bf16_f32 v89, v90, v91
    ds_pk_add_bf16 v7, v88 offset:65408
    ds_pk_add_bf16 v7, v89 offset:65412
    s_mov_b64 exec, s[54:55]
    s_branch L2_d146
L2_c147:
    s_lshl_b64 s[52:53], s[82:83], 1
    s_andn2_b64 s[52:53], s[52:53], s[80:81]
    s_andn2_b64 s[52:53], s[52:53], s[50:51]
    s_or_b64 s[80:81], s[80:81], s[52:53]
    s_not_b64 vcc, s[52:53]
    s_mov_b64 exec, -1
    v_cndmask_b32_dpp v84, v84, v84, vcc wave_shr:1 row_mask:0xf bank_mask:0xf
    v_cndmask_b32_dpp v85, v85, v85, vcc wave_shr:1 row_mask:0xf bank_mask:0xf
    s_lshr_b64 s[52:53], s[52:53], 1
    v_cndmask_b32_dpp v86, v86, v86, vcc wave_shr:1 row_mask:0xf bank_mask:0xf
    v_cndmask_b32_dpp v87, v87, v87, vcc wave_shr:1 row_mask:0xf bank_mask:0xf
    s_andn2_b64 s[82:83], s[82:83], s[52:53]
    v_cndmask_b32_dpp v7, v7, v7, vcc wave_shr:1 row_mask:0xf bank_mask:0xf
    s_mov_b64 exec, s[50:51]
    s_cbranch_scc0 L2_d147
    s_mov_b64 exec, s[82:83]
    s_nop 1
    v_mfma_f32_4x4x4_16b_bf16 v[88:91], v[12:13], v[84:85], 0
    s_nop 1
    v_mfma_f32_4x4x4_16b_bf16 v[88:91], v[10:11], v[86:87], v[88:91]
    s_nop 4
    v_cvt_pk_bf16_f32 v88, v88, v89
    v_cvt_pk_bf16_f32 v89, v90, v91
    ds_pk_add_bf16 v7, v88 offset:65408
    ds_pk_add_bf16 v7, v89 offset:65412
    s_mov_b64 exec, s[50:51]
    s_branch L2_d147
L2_c148:
    s_lshl_b64 s[52:53], s[82:83], 1
    s_andn2_b64 s[52:53], s[52:53], s[80:81]
    s_andn2_b64 s[52:53], s[52:53], s[54:55]
    s_or_b64 s[80:81], s[80:81], s[52:53]
    s_not_b64 vcc, s[52:53]
    s_mov_b64 exec, -1
    v_cndmask_b32_dpp v84, v84, v84, vcc wave_shr:1 row_mask:0xf bank_mask:0xf
    v_cndmask_b32_dpp v85, v85, v85, vcc wave_shr:1 row_mask:0xf bank_mask:0xf
    s_lshr_b64 s[52:53], s[52:53], 1
    v_cndmask_b32_dpp v86, v86, v86, vcc wave_shr:1 row_mask:0xf bank_mask:0xf
    v_cndmask_b32_dpp v87, v87, v87, vcc wave_shr:1 row_mask:0xf bank_mask:0xf
    s_andn2_b64 s[82:83], s[82:83], s[52:53]
    v_cndmask_b32_dpp v7, v7, v7, vcc wave_shr:1 row_mask:0xf bank_mask:0xf
    s_mov_b64 exec, s[54:55]
    s_cbranch_scc0 L2_d148
    s_mov_b64 exec, s[82:83]
    s_nop 1
    v_mfma_f32_4x4x4_16b_bf16 v[88:91], v[12:13], v[84:85], 0
    s_nop 1
    v_mfma_f32_4x4x4_16b_bf16 v[88:91], v[10:11], v[86:87], v[88:91]
    s_nop 4
    v_cvt_pk_bf16_f32 v88, v88, v89
    v_cvt_pk_bf16_f32 v89, v90, v91
    ds_pk_add_bf16 v7, v88 offset:65408
    ds_pk_add_bf16 v7, v89 offset:65412
    s_mov_b64 exec, s[54:55]
    s_branch L2_d148
L2_c149:
    s_lshl_b64 s[52:53], s[82:83], 1
    s_andn2_b64 s[52:53], s[52:53], s[80:81]
    s_andn2_b64 s[52:53], s[52:53], s[50:51]
    s_or_b64 s[80:81], s[80:81], s[52:53]
    s_not_b64 vcc, s[52:53]
    s_mov_b64 exec, -1
    v_cndmask_b32_dpp v84, v84, v84, vcc wave_shr:1 row_mask:0xf bank_mask:0xf
    v_cndmask_b32_dpp v85, v85, v85, vcc wave_shr:1 row_mask:0xf bank_mask:0xf
    s_lshr_b64 s[52:53], s[52:53], 1
    v_cndmask_b32_dpp v86, v86, v86, vcc wave_shr:1 row_mask:0xf bank_mask:0xf
    v_cndmask_b32_dpp v87, v87, v87, vcc wave_shr:1 row_mask:0xf bank_mask:0xf
    s_andn2_b64 s[82:83], s[82:83], s[52:53]
    v_cndmask_b32_dpp v7, v7, v7, vcc wave_shr:1 row_mask:0xf bank_mask:0xf
    s_mov_b64 exec, s[50:51]
    s_cbranch_scc0 L2_d149
    s_mov_b64 exec, s[82:83]
    s_nop 1
    v_mfma_f32_4x4x4_16b_bf16 v[88:91], v[12:13], v[84:85], 0
    s_nop 1
    v_mfma_f32_4x4x4_16b_bf16 v[88:91], v[10:11], v[86:87], v[88:91]
    s_nop 4
    v_cvt_pk_bf16_f32 v88, v88, v89
    v_cvt_pk_bf16_f32 v89, v90, v91
    ds_pk_add_bf16 v7, v88 offset:65408
    ds_pk_add_bf16 v7, v89 offset:65412
    s_mov_b64 exec, s[50:51]
    s_branch L2_d149
L2_c150:
    s_lshl_b64 s[52:53], s[82:83], 1
    s_andn2_b64 s[52:53], s[52:53], s[80:81]
    s_andn2_b64 s[52:53], s[52:53], s[54:55]
    s_or_b64 s[80:81], s[80:81], s[52:53]
    s_not_b64 vcc, s[52:53]
    s_mov_b64 exec, -1
    v_cndmask_b32_dpp v84, v84, v84, vcc wave_shr:1 row_mask:0xf bank_mask:0xf
    v_cndmask_b32_dpp v85, v85, v85, vcc wave_shr:1 row_mask:0xf bank_mask:0xf
    s_lshr_b64 s[52:53], s[52:53], 1
    v_cndmask_b32_dpp v86, v86, v86, vcc wave_shr:1 row_mask:0xf bank_mask:0xf
    v_cndmask_b32_dpp v87, v87, v87, vcc wave_shr:1 row_mask:0xf bank_mask:0xf
    s_andn2_b64 s[82:83], s[82:83], s[52:53]
    v_cndmask_b32_dpp v7, v7, v7, vcc wave_shr:1 row_mask:0xf bank_mask:0xf
    s_mov_b64 exec, s[54:55]
    s_cbranch_scc0 L2_d150
    s_mov_b64 exec, s[82:83]
    s_nop 1
    v_mfma_f32_4x4x4_16b_bf16 v[88:91], v[12:13], v[84:85], 0
    s_nop 1
    v_mfma_f32_4x4x4_16b_bf16 v[88:91], v[10:11], v[86:87], v[88:91]
    s_nop 4
    v_cvt_pk_bf16_f32 v88, v88, v89
    v_cvt_pk_bf16_f32 v89, v90, v91
    ds_pk_add_bf16 v7, v88 offset:65408
    ds_pk_add_bf16 v7, v89 offset:65412
    s_mov_b64 exec, s[54:55]
    s_branch L2_d150
L2_c151:
    s_lshl_b64 s[52:53], s[82:83], 1
    s_andn2_b64 s[52:53], s[52:53], s[80:81]
    s_andn2_b64 s[52:53], s[52:53], s[50:51]
    s_or_b64 s[80:81], s[80:81], s[52:53]
    s_not_b64 vcc, s[52:53]
    s_mov_b64 exec, -1
    v_cndmask_b32_dpp v84, v84, v84, vcc wave_shr:1 row_mask:0xf bank_mask:0xf
    v_cndmask_b32_dpp v85, v85, v85, vcc wave_shr:1 row_mask:0xf bank_mask:0xf
    s_lshr_b64 s[52:53], s[52:53], 1
    v_cndmask_b32_dpp v86, v86, v86, vcc wave_shr:1 row_mask:0xf bank_mask:0xf
    v_cndmask_b32_dpp v87, v87, v87, vcc wave_shr:1 row_mask:0xf bank_mask:0xf
    s_andn2_b64 s[82:83], s[82:83], s[52:53]
    v_cndmask_b32_dpp v7, v7, v7, vcc wave_shr:1 row_mask:0xf bank_mask:0xf
    s_mov_b64 exec, s[50:51]
    s_cbranch_scc0 L2_d151
    s_mov_b64 exec, s[82:83]
    s_nop 1
    v_mfma_f32_4x4x4_16b_bf16 v[88:91], v[12:13], v[84:85], 0
    s_nop 1
    v_mfma_f32_4x4x4_16b_bf16 v[88:91], v[10:11], v[86:87], v[88:91]
    s_nop 4
    v_cvt_pk_bf16_f32 v88, v88, v89
    v_cvt_pk_bf16_f32 v89, v90, v91
    ds_pk_add_bf16 v7, v88 offset:65408
    ds_pk_add_bf16 v7, v89 offset:65412
    s_mov_b64 exec, s[50:51]
    s_branch L2_d151
L2_c152:
    s_mov_b64 s[50:51], vcc
    s_lshl_b64 s[52:53], s[82:83], 1
    s_andn2_b64 s[52:53], s[52:53], s[80:81]
    s_andn2_b64 s[52:53], s[52:53], s[50:51]
    s_or_b64 s[80:81], s[80:81], s[52:53]
    s_not_b64 vcc, s[52:53]
    s_mov_b64 exec, -1
    v_cndmask_b32_dpp v84, v84, v84, vcc wave_shr:1 row_mask:0xf bank_mask:0xf
    v_cndmask_b32_dpp v85, v85, v85, vcc wave_shr:1 row_mask:0xf bank_mask:0xf
    s_lshr_b64 s[52:53], s[52:53], 1
    v_cndmask_b32_dpp v86, v86, v86, vcc wave_shr:1 row_mask:0xf bank_mask:0xf
    v_cndmask_b32_dpp v87, v87, v87, vcc wave_shr:1 row_mask:0xf bank_mask:0xf
    s_andn2_b64 s[82:83], s[82:83], s[52:53]
    v_cndmask_b32_dpp v7, v7, v7, vcc wave_shr:1 row_mask:0xf bank_mask:0xf
    s_mov_b64 vcc, s[50:51]
    s_mov_b64 exec, s[50:51]
    s_cbranch_scc0 L2_d152
    s_mov_b64 exec, s[82:83]
    s_nop 1
    v_mfma_f32_4x4x4_16b_bf16 v[88:91], v[12:13], v[84:85], 0
    s_nop 1
    v_mfma_f32_4x4x4_16b_bf16 v[88:91], v[10:11], v[86:87], v[88:91]
    s_nop 4
    v_cvt_pk_bf16_f32 v88, v88, v89
    v_cvt_pk_bf16_f32 v89, v90, v91
    ds_pk_add_bf16 v7, v88 offset:65408
    ds_pk_add_bf16 v7, v89 offset:65412
    s_mov_b64 exec, vcc
    s_branch L2_d152
L2_c153:
    s_mov_b64 s[50:51], vcc
    s_lshl_b64 s[52:53], s[82:83], 1
    s_andn2_b64 s[52:53], s[52:53], s[80:81]
    s_andn2_b64 s[52:53], s[52:53], s[50:51]
    s_or_b64 s[80:81], s[80:81], s[52:53]
    s_not_b64 vcc, s[52:53]
    s_mov_b64 exec, -1
    v_cndmask_b32_dpp v84, v84, v84, vcc wave_shr:1 row_mask:0xf bank_mask:0xf
    v_cndmask_b32_dpp v85, v85, v85, vcc wave_shr:1 row_mask:0xf bank_mask:0xf
    s_lshr_b64 s[52:53], s[52:53], 1
    v_cndmask_b32_dpp v86, v86, v86, vcc wave_shr:1 row_mask:0xf bank_mask:0xf
    v_cndmask_b32_dpp v87, v87, v87, vcc wave_shr:1 row_mask:0xf bank_mask:0xf
    s_andn2_b64 s[82:83], s[82:83], s[52:53]
    v_cndmask_b32_dpp v7, v7, v7, vcc wave_shr:1 row_mask:0xf bank_mask:0xf
    s_mov_b64 vcc, s[50:51]
    s_mov_b64 exec, s[50:51]
    s_cbranch_scc0 L2_d153
    s_mov_b64 exec, s[82:83]
    s_nop 1
    v_mfma_f32_4x4x4_16b_bf16 v[88:91], v[12:13], v[84:85], 0
    s_nop 1
    v_mfma_f32_4x4x4_16b_bf16 v[88:91], v[10:11], v[86:87], v[88:91]
    s_nop 4
    v_cvt_pk_bf16_f32 v88, v88, v89
    v_cvt_pk_bf16_f32 v89, v90, v91
    ds_pk_add_bf16 v7, v88 offset:65408
    ds_pk_add_bf16 v7, v89 offset:65412
    s_mov_b64 exec, vcc
    s_branch L2_d153
L2_f3s:
    s_branch L2_f3
.section .rodata,"a"
.p2align 6
.amdhsa_kernel gather_scatter__molecular_angular_gemnet__graph_kernel
  .amdhsa_next_free_vgpr 128
  .amdhsa_next_free_sgpr 102
  .amdhsa_accum_offset 128
  .amdhsa_group_segment_fixed_size 0
  .amdhsa_kernarg_size 112
  .amdhsa_user_sgpr_count 2
  .amdhsa_user_sgpr_kernarg_segment_ptr 1
  .amdhsa_system_sgpr_workgroup_id_x 1
  .amdhsa_float_denorm_mode_32 3
.end_amdhsa_kernel
```
